```python
import torch

def _softmax(x, axis=-1):
    return torch.softmax(x, dim=axis)
def _gelu(x):
    return torch.nn.functional.gelu(x, approximate="tanh")
def _silu(x):
    return torch.nn.functional.silu(x)
def _sigmoid(x):
    return torch.sigmoid(x)
def _layernorm(x, axis=-1, eps=1e-5):
    m = x.mean(dim=axis, keepdim=True)
    v = x.var(dim=axis, keepdim=True, unbiased=False)
    return (x - m) / torch.sqrt(v + eps)
def _scatter_add(tgt, idx, src, axis=0):
    return tgt.clone().index_add_(axis, idx, src)
def _segment_sum(src, seg, n):
    out = torch.zeros((n,) + src.shape[1:], dtype=src.dtype)
    return out.index_add_(0, seg, src)
def _pad(x, pw):
    flat = tuple(v for pair in reversed(pw) for v in pair)
    return torch.nn.functional.pad(x, flat)

kernel_name = 'concat_heads__ssm_conv_h3__compressed_kv_cla__prompt'

def setup_inputs():

    _w = (lambda a: (lambda t: t.to(torch.bfloat16) if t.is_floating_point() else t)(torch.as_tensor(a)))
    def _A_setup():
        B, S, D = 1, 2048, 448
        ks = 4
        return {
            "q": _w((lambda *s: torch.randn(*s, dtype=torch.bfloat16) * 0.05)(B, S, D)),
            "k": _w((lambda *s: torch.randn(*s, dtype=torch.bfloat16) * 0.1)(B, S, D)),
            "v": _w((lambda *s: torch.randn(*s, dtype=torch.bfloat16) * 0.1)(B, S, D)),
            "shift_k": _w((lambda *s: torch.randn(*s, dtype=torch.bfloat16) * 0.1)(D, ks) * 0.5),
            "ssm_k": _w((lambda *s: torch.randn(*s, dtype=torch.bfloat16) * 0.1)(D, S) * (1.0 / S ** 0.5)),
            "ssm_D": _w((lambda *s: torch.randn(*s, dtype=torch.bfloat16) * 0.1)(D)),
        }
    _A_in = _A_setup()

    def _B_setup():
        B, H, Sq, Sk, D, M = 1, 16, 2048, 2048, 256, 448
        Dc = 4 * D
        return {
            "x": _w((lambda *s: torch.randn(*s, dtype=torch.bfloat16) * 3.2)(B, Sq, M)),
            "c_kv": _w((lambda *s: torch.randn(*s, dtype=torch.bfloat16) * 0.05)(B, Sk, Dc)),
            "w_q": _w((lambda *s: torch.randn(*s, dtype=torch.bfloat16) * 3.2)(M, H, D) * (M ** -0.5)),
            "w_uk": _w((lambda *s: torch.randn(*s, dtype=torch.bfloat16) * 3.2)(Dc, H, D) * (Dc ** -0.5)),
            "w_uv": _w((lambda *s: torch.randn(*s, dtype=torch.bfloat16) * 0.05)(Dc, H, D) * (Dc ** -0.5)),
            "w_o": _w((lambda *s: torch.randn(*s, dtype=torch.bfloat16) * 0.05)(H, D, M) * ((H * D) ** -0.5)),
        }
    _B_in = _B_setup()

    return {
        "A_q": _A_in["q"],
        "A_k": _A_in["k"],
        "A_v": _A_in["v"],
        "A_shift_k": _A_in["shift_k"],
        "A_ssm_k": _A_in["ssm_k"],
        "A_ssm_D": _A_in["ssm_D"],
        "B_x": _B_in["x"],
        "B_c_kv": _B_in["c_kv"],
        "B_w_q": _B_in["w_q"],
        "B_w_uk": _B_in["w_uk"],
        "B_w_uv": _B_in["w_uv"],
        "B_w_o": _B_in["w_o"],
    }

def reference(A_q, A_k, A_v, A_shift_k, A_ssm_k, A_ssm_D, B_x, B_c_kv, B_w_q, B_w_uk, B_w_uv, B_w_o):
    def _A_ref(q, k, v, shift_k, ssm_k, ssm_D):
        B, S, D = q.shape
        ks = shift_k.shape[-1]
        k_pad = _pad(k, ((0, 0), (ks - 1, 0), (0, 0)))
        k_shift = torch.zeros_like(k)
        for t in range(ks):
            k_shift = k_shift + k_pad[:, t:t + S, :] * shift_k[:, ks - 1 - t][None, None, :]
        kv = k_shift * v
        L = 2 * S
        kv_pad = _pad(kv, ((0, 0), (0, S), (0, 0)))
        kf_pad = _pad(ssm_k, ((0, 0), (0, S)))
        kv_f = (lambda x, axes=(-2,-1): torch.fft.rfft2(x.float(), dim=axes))(kv_pad[:, None, :, :], axes=(1, 2))
        kf_f = (lambda x, axes=(-2,-1): torch.fft.rfft2(x.float(), dim=axes))(kf_pad[:, None, :], axes=(1, 2))
        kf_f = (lambda x, *d: x.permute(*d))(kf_f, 1, 2, 0)
        y_f = kv_f * kf_f[None, :, :, :]
        y = (lambda x, s, axes=(-2,-1): torch.fft.irfft2(x, s=s, dim=axes).to(torch.bfloat16))(y_f, (1, L), axes=(1, 2))[:, 0, :S, :]
        y = y + kv * ssm_D[None, None, :]
        return q * y

    def _B_ref(x, c_kv, w_q, w_uk, w_uv, w_o):
        B, Sq, M = x.shape[0], x.shape[1], x.shape[2]
        Sk = c_kv.shape[1]
        H, D = w_q.shape[1], w_q.shape[2]
        q = torch.einsum("bqm,mhd->bhqd", x, w_q)
        k = torch.einsum("bkc,chd->bhkd", c_kv, w_uk)
        v = torch.einsum("bkc,chd->bhkd", c_kv, w_uv)
        scores = torch.einsum("bhqd,bhkd->bhqk", q, k) * (D ** -0.5)
        off = Sk - Sq
        qi = torch.arange(Sq)[:, None]
        kj = torch.arange(Sk)[None, :]
        cmask = kj <= (qi + off)
        scores = torch.where(cmask[None, None], scores, -1e9)
        p = _softmax(scores, axis=-1)
        ctx = torch.einsum("bhqk,bhkd->bhqd", p, v)
        return torch.einsum("bhqd,hdm->bqm", ctx, w_o)

    a = _A_ref(A_q, A_k, A_v, A_shift_k, A_ssm_k, A_ssm_D)
    b = _B_ref(B_x, B_c_kv, B_w_q, B_w_uk, B_w_uv, B_w_o)
    return torch.concatenate([a, b], axis=-1)
```

```asm
; @launch kernel=p1_kernel grid=(256,1,1) block=(256,1,1) lds=131072
; @launch kernel=p2_kernel grid=(256,1,1) block=(256,1,1) lds=131072
; @launch kernel=p3_kernel grid=(256,1,1) block=(256,1,1) lds=150528
.amdgcn_target "amdgcn-amd-amdhsa--gfx950"
.text
.globl p1_kernel
.p2align 8
.type p1_kernel,@function
p1_kernel:
    s_cmp_ge_u32 s2, 256
    s_cbranch_scc1 K1_end
    s_load_dwordx4 s[32:35], s[0:1], 48
    s_load_dwordx4 s[36:39], s[0:1], 64
    s_load_dwordx2 s[40:41], s[0:1], 80
    s_load_dwordx2 s[42:43], s[0:1], 112
    v_lshrrev_b32 v1, 6, v0
    s_and_b32 s24, s2, 7
    s_lshl_b32 s24, s24, 1
    v_readfirstlane_b32 s23, v1
    s_bfe_u32 s27, s2, 0x10003
    s_add_u32 s24, s24, s27
    s_lshr_b32 s25, s2, 5
    v_and_b32 v22, 63, v0
    v_and_b32 v23, 15, v22
    v_lshrrev_b32 v24, 4, v22
    v_lshrrev_b32 v25, 1, v23
    v_xor_b32 v25, v24, v25
    v_lshlrev_b32 v25, 4, v25
    v_lshl_add_u32 v2, v23, 7, v25
    s_lshr_b32 s27, s23, 1
    s_lshl_b32 s27, s27, 14
    v_add_u32 v2, s27, v2
    v_xor_b32 v3, 64, v2
    v_lshrrev_b32 v25, 2, v23
    v_and_b32 v26, 1, v24
    v_lshl_or_b32 v26, v26, 2, v25
    v_lshl_add_u32 v25, v24, 3, v25
    v_lshlrev_b32 v25, 9, v25
    v_lshl_add_u32 v25, v26, 5, v25
    v_and_b32 v26, 3, v22
    v_lshl_add_u32 v25, v26, 3, v25
    v_add_u32 v25, 0x10000, v25
    s_and_b32 s27, s23, 1
    s_lshl_b32 s27, s27, 8
    v_xor_b32 v4, s27, v25
    v_xor_b32 v5, 32, v4
    v_xor_b32 v6, 64, v4
    v_xor_b32 v7, 96, v4
    v_xor_b32 v8, 128, v4
    v_xor_b32 v9, 160, v4
    v_xor_b32 v10, 192, v4
    v_xor_b32 v11, 224, v4
    v_lshrrev_b32 v25, 3, v22
    v_and_b32 v26, 7, v22
    v_lshrrev_b32 v27, 1, v25
    v_xor_b32 v26, v26, v27
    v_lshlrev_b32 v26, 4, v26
    v_mul_u32_u24 v25, 2048, v25
    v_add_u32 v12, v25, v26
    v_xor_b32 v26, 64, v26
    v_add_u32 v25, v25, v26
    v_add_u32 v13, 15360, v25
    v_add_u32 v14, 30720, v12
    v_add_u32 v15, 46080, v25
    v_lshrrev_b32 v25, 5, v22
    v_and_b32 v26, 31, v22
    s_and_b32 s27, s23, 1
    s_lshl_b32 s27, s27, 2
    v_or_b32 v27, s27, v25
    v_lshlrev_b32 v27, 1, v27
    v_xor_b32 v26, v26, v27
    v_lshlrev_b32 v26, 4, v26
    v_lshl_add_u32 v16, v25, 13, v26
    v_xor_b32 v25, 64, v16
    v_add_u32 v17, 15360, v25
    v_add_u32 v18, 30720, v16
    v_add_u32 v19, 46080, v25
    v_lshlrev_b32 v20, 4, v22
    s_lshl_b32 s20, s23, 13
    s_lshl_b32 s21, s23, 12
    s_lshl_b32 s16, s25, 19
    s_lshl_b32 s27, s23, 17
    s_add_u32 s16, s16, s27
    s_add_u32 s17, s16, 65536
    s_lshl_b32 s18, s23, 16
    s_lshl_b32 s27, s24, 9
    s_add_u32 s18, s18, s27
    s_add_u32 s19, s18, 262144
    s_waitcnt lgkmcnt(0)
    s_mov_b32 s4, s34
    s_mov_b32 s5, s35
    s_mov_b32 s6, 4194304
    s_mov_b32 s7, 0x20000
    s_mov_b32 s12, s42
    s_mov_b32 s13, s43
    s_mov_b32 s14, 268435456
    s_mov_b32 s15, 0x20000
    s_lshl_b32 s27, s2, 7
    s_add_u32 s27, s27, 94371840
    v_mov_b32 v22, 0
    s_mov_b64 exec, 1
    buffer_store_dword v22, v22, s[12:15], s27 offen
    s_mov_b64 exec, -1
    s_bitcmp1_b32 s2, 4
    s_cbranch_scc1 K1_V
    s_mov_b32 s8, s38
    s_mov_b32 s9, s39
    s_mov_b32 s10, 8388608
    s_mov_b32 s11, 0x20000
    s_add_u32 m0, s20, 0
    s_nop 0
    buffer_load_dwordx4 v12, s[4:7], s16 offen offset:0 lds
    buffer_load_dwordx4 v13, s[4:7], s16 offen offset:1024 lds
    buffer_load_dwordx4 v14, s[4:7], s16 offen offset:2048 lds
    buffer_load_dwordx4 v15, s[4:7], s16 offen offset:3072 lds
    s_add_u32 s16, s16, 128
    s_add_u32 m0, s20, 4096
    s_nop 0
    buffer_load_dwordx4 v12, s[4:7], s17 offen offset:0 lds
    buffer_load_dwordx4 v13, s[4:7], s17 offen offset:1024 lds
    buffer_load_dwordx4 v14, s[4:7], s17 offen offset:2048 lds
    buffer_load_dwordx4 v15, s[4:7], s17 offen offset:3072 lds
    s_add_u32 s17, s17, 128
    s_add_u32 m0, s21, 65536
    s_nop 0
    buffer_load_dwordx4 v16, s[8:11], s18 offen offset:0 lds
    buffer_load_dwordx4 v17, s[8:11], s18 offen offset:1024 lds
    buffer_load_dwordx4 v18, s[8:11], s18 offen offset:2048 lds
    buffer_load_dwordx4 v19, s[8:11], s18 offen offset:3072 lds
    s_add_u32 s18, s18, 524288
    s_add_u32 m0, s21, 81920
    s_nop 0
    buffer_load_dwordx4 v16, s[8:11], s19 offen offset:0 lds
    buffer_load_dwordx4 v17, s[8:11], s19 offen offset:1024 lds
    buffer_load_dwordx4 v18, s[8:11], s19 offen offset:2048 lds
    buffer_load_dwordx4 v19, s[8:11], s19 offen offset:3072 lds
    s_add_u32 s19, s19, 524288
    s_add_u32 m0, s20, 32768
    s_nop 0
    buffer_load_dwordx4 v12, s[4:7], s16 offen offset:0 lds
    buffer_load_dwordx4 v13, s[4:7], s16 offen offset:1024 lds
    buffer_load_dwordx4 v14, s[4:7], s16 offen offset:2048 lds
    buffer_load_dwordx4 v15, s[4:7], s16 offen offset:3072 lds
    s_add_u32 s16, s16, 128
    s_add_u32 m0, s20, 36864
    s_nop 0
    buffer_load_dwordx4 v12, s[4:7], s17 offen offset:0 lds
    buffer_load_dwordx4 v13, s[4:7], s17 offen offset:1024 lds
    buffer_load_dwordx4 v14, s[4:7], s17 offen offset:2048 lds
    buffer_load_dwordx4 v15, s[4:7], s17 offen offset:3072 lds
    s_add_u32 s17, s17, 128
    s_add_u32 m0, s21, 98304
    s_nop 0
    buffer_load_dwordx4 v16, s[8:11], s18 offen offset:0 lds
    buffer_load_dwordx4 v17, s[8:11], s18 offen offset:1024 lds
    buffer_load_dwordx4 v18, s[8:11], s18 offen offset:2048 lds
    buffer_load_dwordx4 v19, s[8:11], s18 offen offset:3072 lds
    s_add_u32 s18, s18, 524288
    s_waitcnt vmcnt(12)
    s_barrier
    ds_read_b128 a[0:3], v2 offset:0
    ds_read_b128 a[4:7], v3 offset:0
    ds_read_b128 a[8:11], v2 offset:2048
    ds_read_b128 a[12:15], v3 offset:2048
    ds_read_b128 a[16:19], v2 offset:4096
    ds_read_b128 a[20:23], v3 offset:4096
    ds_read_b128 a[24:27], v2 offset:6144
    ds_read_b128 a[28:31], v3 offset:6144
    ds_read_b128 a[32:35], v2 offset:8192
    ds_read_b128 a[36:39], v3 offset:8192
    ds_read_b128 a[40:43], v2 offset:10240
    ds_read_b128 a[44:47], v3 offset:10240
    ds_read_b128 a[48:51], v2 offset:12288
    ds_read_b128 a[52:55], v3 offset:12288
    ds_read_b128 a[56:59], v2 offset:14336
    ds_read_b128 a[60:63], v3 offset:14336
    ds_read_b64_tr_b16 a[128:129], v4 offset:0
    ds_read_b64_tr_b16 a[130:131], v4 offset:2048
    ds_read_b64_tr_b16 a[132:133], v4 offset:16384
    ds_read_b64_tr_b16 a[134:135], v4 offset:18432
    s_waitcnt vmcnt(4) lgkmcnt(0)
    s_barrier
    s_mov_b32 s22, 6
    v_mfma_f32_16x16x32_bf16 v[32:35], a[128:131], a[0:3], 0
    s_add_u32 m0, s21, 114688
    ds_read_b64_tr_b16 a[136:137], v5 offset:0
    v_mfma_f32_16x16x32_bf16 v[32:35], a[132:135], a[4:7], v[32:35]
    buffer_load_dwordx4 v16, s[8:11], s19 offen offset:0 lds
    v_mfma_f32_16x16x32_bf16 v[36:39], a[128:131], a[8:11], 0
    ds_read_b64_tr_b16 a[138:139], v5 offset:2048
    v_mfma_f32_16x16x32_bf16 v[36:39], a[132:135], a[12:15], v[36:39]
    ds_read_b128 a[64:67], v2 offset:32768
    v_mfma_f32_16x16x32_bf16 v[40:43], a[128:131], a[16:19], 0
    ds_read_b64_tr_b16 a[140:141], v5 offset:16384
    v_mfma_f32_16x16x32_bf16 v[40:43], a[132:135], a[20:23], v[40:43]
    buffer_load_dwordx4 v17, s[8:11], s19 offen offset:1024 lds
    v_mfma_f32_16x16x32_bf16 v[44:47], a[128:131], a[24:27], 0
    ds_read_b64_tr_b16 a[142:143], v5 offset:18432
    v_mfma_f32_16x16x32_bf16 v[44:47], a[132:135], a[28:31], v[44:47]
    v_mfma_f32_16x16x32_bf16 v[48:51], a[128:131], a[32:35], 0
    v_mfma_f32_16x16x32_bf16 v[48:51], a[132:135], a[36:39], v[48:51]
    buffer_load_dwordx4 v18, s[8:11], s19 offen offset:2048 lds
    v_mfma_f32_16x16x32_bf16 v[52:55], a[128:131], a[40:43], 0
    v_mfma_f32_16x16x32_bf16 v[52:55], a[132:135], a[44:47], v[52:55]
    ds_read_b128 a[68:71], v3 offset:32768
    v_mfma_f32_16x16x32_bf16 v[56:59], a[128:131], a[48:51], 0
    v_mfma_f32_16x16x32_bf16 v[56:59], a[132:135], a[52:55], v[56:59]
    buffer_load_dwordx4 v19, s[8:11], s19 offen offset:3072 lds
    v_mfma_f32_16x16x32_bf16 v[60:63], a[128:131], a[56:59], 0
    s_add_u32 s19, s19, 524288
    v_mfma_f32_16x16x32_bf16 v[60:63], a[132:135], a[60:63], v[60:63]
    s_waitcnt lgkmcnt(4)
    v_mfma_f32_16x16x32_bf16 v[64:67], a[136:139], a[0:3], 0
    s_waitcnt lgkmcnt(1)
    s_add_u32 m0, s20, 0
    ds_read_b64_tr_b16 a[128:129], v6 offset:0
    v_mfma_f32_16x16x32_bf16 v[64:67], a[140:143], a[4:7], v[64:67]
    buffer_load_dwordx4 v12, s[4:7], s16 offen offset:0 lds
    v_mfma_f32_16x16x32_bf16 v[68:71], a[136:139], a[8:11], 0
    ds_read_b64_tr_b16 a[130:131], v6 offset:2048
    v_mfma_f32_16x16x32_bf16 v[68:71], a[140:143], a[12:15], v[68:71]
    ds_read_b128 a[72:75], v2 offset:34816
    v_mfma_f32_16x16x32_bf16 v[72:75], a[136:139], a[16:19], 0
    ds_read_b64_tr_b16 a[132:133], v6 offset:16384
    v_mfma_f32_16x16x32_bf16 v[72:75], a[140:143], a[20:23], v[72:75]
    buffer_load_dwordx4 v13, s[4:7], s16 offen offset:1024 lds
    v_mfma_f32_16x16x32_bf16 v[76:79], a[136:139], a[24:27], 0
    ds_read_b64_tr_b16 a[134:135], v6 offset:18432
    v_mfma_f32_16x16x32_bf16 v[76:79], a[140:143], a[28:31], v[76:79]
    v_mfma_f32_16x16x32_bf16 v[80:83], a[136:139], a[32:35], 0
    v_mfma_f32_16x16x32_bf16 v[80:83], a[140:143], a[36:39], v[80:83]
    buffer_load_dwordx4 v14, s[4:7], s16 offen offset:2048 lds
    v_mfma_f32_16x16x32_bf16 v[84:87], a[136:139], a[40:43], 0
    v_mfma_f32_16x16x32_bf16 v[84:87], a[140:143], a[44:47], v[84:87]
    ds_read_b128 a[76:79], v3 offset:34816
    v_mfma_f32_16x16x32_bf16 v[88:91], a[136:139], a[48:51], 0
    v_mfma_f32_16x16x32_bf16 v[88:91], a[140:143], a[52:55], v[88:91]
    buffer_load_dwordx4 v15, s[4:7], s16 offen offset:3072 lds
    v_mfma_f32_16x16x32_bf16 v[92:95], a[136:139], a[56:59], 0
    s_add_u32 s16, s16, 128
    v_mfma_f32_16x16x32_bf16 v[92:95], a[140:143], a[60:63], v[92:95]
    s_waitcnt lgkmcnt(4)
    v_mfma_f32_16x16x32_bf16 v[96:99], a[128:131], a[0:3], 0
    s_waitcnt lgkmcnt(1)
    s_add_u32 m0, s20, 4096
    ds_read_b64_tr_b16 a[136:137], v7 offset:0
    v_mfma_f32_16x16x32_bf16 v[96:99], a[132:135], a[4:7], v[96:99]
    buffer_load_dwordx4 v12, s[4:7], s17 offen offset:0 lds
    v_mfma_f32_16x16x32_bf16 v[100:103], a[128:131], a[8:11], 0
    ds_read_b64_tr_b16 a[138:139], v7 offset:2048
    v_mfma_f32_16x16x32_bf16 v[100:103], a[132:135], a[12:15], v[100:103]
    ds_read_b128 a[80:83], v2 offset:36864
    v_mfma_f32_16x16x32_bf16 v[104:107], a[128:131], a[16:19], 0
    ds_read_b64_tr_b16 a[140:141], v7 offset:16384
    v_mfma_f32_16x16x32_bf16 v[104:107], a[132:135], a[20:23], v[104:107]
    buffer_load_dwordx4 v13, s[4:7], s17 offen offset:1024 lds
    v_mfma_f32_16x16x32_bf16 v[108:111], a[128:131], a[24:27], 0
    ds_read_b64_tr_b16 a[142:143], v7 offset:18432
    v_mfma_f32_16x16x32_bf16 v[108:111], a[132:135], a[28:31], v[108:111]
    v_mfma_f32_16x16x32_bf16 v[112:115], a[128:131], a[32:35], 0
    v_mfma_f32_16x16x32_bf16 v[112:115], a[132:135], a[36:39], v[112:115]
    buffer_load_dwordx4 v14, s[4:7], s17 offen offset:2048 lds
    v_mfma_f32_16x16x32_bf16 v[116:119], a[128:131], a[40:43], 0
    v_mfma_f32_16x16x32_bf16 v[116:119], a[132:135], a[44:47], v[116:119]
    ds_read_b128 a[84:87], v3 offset:36864
    v_mfma_f32_16x16x32_bf16 v[120:123], a[128:131], a[48:51], 0
    v_mfma_f32_16x16x32_bf16 v[120:123], a[132:135], a[52:55], v[120:123]
    buffer_load_dwordx4 v15, s[4:7], s17 offen offset:3072 lds
    v_mfma_f32_16x16x32_bf16 v[124:127], a[128:131], a[56:59], 0
    s_add_u32 s17, s17, 128
    v_mfma_f32_16x16x32_bf16 v[124:127], a[132:135], a[60:63], v[124:127]
    s_waitcnt lgkmcnt(4)
    v_mfma_f32_16x16x32_bf16 v[128:131], a[136:139], a[0:3], 0
    s_waitcnt lgkmcnt(1)
    ds_read_b64_tr_b16 a[128:129], v8 offset:0
    v_mfma_f32_16x16x32_bf16 v[128:131], a[140:143], a[4:7], v[128:131]
    ds_read_b128 a[88:91], v2 offset:38912
    v_mfma_f32_16x16x32_bf16 v[132:135], a[136:139], a[8:11], 0
    ds_read_b64_tr_b16 a[130:131], v8 offset:2048
    v_mfma_f32_16x16x32_bf16 v[132:135], a[140:143], a[12:15], v[132:135]
    v_mfma_f32_16x16x32_bf16 v[136:139], a[136:139], a[16:19], 0
    ds_read_b64_tr_b16 a[132:133], v8 offset:16384
    v_mfma_f32_16x16x32_bf16 v[136:139], a[140:143], a[20:23], v[136:139]
    v_mfma_f32_16x16x32_bf16 v[140:143], a[136:139], a[24:27], 0
    ds_read_b64_tr_b16 a[134:135], v8 offset:18432
    v_mfma_f32_16x16x32_bf16 v[140:143], a[140:143], a[28:31], v[140:143]
    v_mfma_f32_16x16x32_bf16 v[144:147], a[136:139], a[32:35], 0
    ds_read_b128 a[92:95], v3 offset:38912
    v_mfma_f32_16x16x32_bf16 v[144:147], a[140:143], a[36:39], v[144:147]
    v_mfma_f32_16x16x32_bf16 v[148:151], a[136:139], a[40:43], 0
    v_mfma_f32_16x16x32_bf16 v[148:151], a[140:143], a[44:47], v[148:151]
    v_mfma_f32_16x16x32_bf16 v[152:155], a[136:139], a[48:51], 0
    ds_read_b128 a[96:99], v2 offset:40960
    v_mfma_f32_16x16x32_bf16 v[152:155], a[140:143], a[52:55], v[152:155]
    v_mfma_f32_16x16x32_bf16 v[156:159], a[136:139], a[56:59], 0
    v_mfma_f32_16x16x32_bf16 v[156:159], a[140:143], a[60:63], v[156:159]
    s_waitcnt lgkmcnt(4)
    v_mfma_f32_16x16x32_bf16 v[160:163], a[128:131], a[0:3], 0
    s_waitcnt lgkmcnt(2)
    ds_read_b64_tr_b16 a[136:137], v9 offset:0
    v_mfma_f32_16x16x32_bf16 v[160:163], a[132:135], a[4:7], v[160:163]
    ds_read_b128 a[100:103], v3 offset:40960
    v_mfma_f32_16x16x32_bf16 v[164:167], a[128:131], a[8:11], 0
    ds_read_b64_tr_b16 a[138:139], v9 offset:2048
    v_mfma_f32_16x16x32_bf16 v[164:167], a[132:135], a[12:15], v[164:167]
    v_mfma_f32_16x16x32_bf16 v[168:171], a[128:131], a[16:19], 0
    ds_read_b64_tr_b16 a[140:141], v9 offset:16384
    v_mfma_f32_16x16x32_bf16 v[168:171], a[132:135], a[20:23], v[168:171]
    v_mfma_f32_16x16x32_bf16 v[172:175], a[128:131], a[24:27], 0
    ds_read_b64_tr_b16 a[142:143], v9 offset:18432
    v_mfma_f32_16x16x32_bf16 v[172:175], a[132:135], a[28:31], v[172:175]
    v_mfma_f32_16x16x32_bf16 v[176:179], a[128:131], a[32:35], 0
    ds_read_b128 a[104:107], v2 offset:43008
    v_mfma_f32_16x16x32_bf16 v[176:179], a[132:135], a[36:39], v[176:179]
    v_mfma_f32_16x16x32_bf16 v[180:183], a[128:131], a[40:43], 0
    v_mfma_f32_16x16x32_bf16 v[180:183], a[132:135], a[44:47], v[180:183]
    v_mfma_f32_16x16x32_bf16 v[184:187], a[128:131], a[48:51], 0
    ds_read_b128 a[108:111], v3 offset:43008
    v_mfma_f32_16x16x32_bf16 v[184:187], a[132:135], a[52:55], v[184:187]
    v_mfma_f32_16x16x32_bf16 v[188:191], a[128:131], a[56:59], 0
    v_mfma_f32_16x16x32_bf16 v[188:191], a[132:135], a[60:63], v[188:191]
    s_waitcnt lgkmcnt(4)
    v_mfma_f32_16x16x32_bf16 v[192:195], a[136:139], a[0:3], 0
    s_waitcnt lgkmcnt(2)
    ds_read_b64_tr_b16 a[128:129], v10 offset:0
    v_mfma_f32_16x16x32_bf16 v[192:195], a[140:143], a[4:7], v[192:195]
    ds_read_b128 a[112:115], v2 offset:45056
    v_mfma_f32_16x16x32_bf16 v[196:199], a[136:139], a[8:11], 0
    ds_read_b64_tr_b16 a[130:131], v10 offset:2048
    v_mfma_f32_16x16x32_bf16 v[196:199], a[140:143], a[12:15], v[196:199]
    v_mfma_f32_16x16x32_bf16 v[200:203], a[136:139], a[16:19], 0
    ds_read_b64_tr_b16 a[132:133], v10 offset:16384
    v_mfma_f32_16x16x32_bf16 v[200:203], a[140:143], a[20:23], v[200:203]
    v_mfma_f32_16x16x32_bf16 v[204:207], a[136:139], a[24:27], 0
    ds_read_b64_tr_b16 a[134:135], v10 offset:18432
    v_mfma_f32_16x16x32_bf16 v[204:207], a[140:143], a[28:31], v[204:207]
    v_mfma_f32_16x16x32_bf16 v[208:211], a[136:139], a[32:35], 0
    ds_read_b128 a[116:119], v3 offset:45056
    v_mfma_f32_16x16x32_bf16 v[208:211], a[140:143], a[36:39], v[208:211]
    v_mfma_f32_16x16x32_bf16 v[212:215], a[136:139], a[40:43], 0
    v_mfma_f32_16x16x32_bf16 v[212:215], a[140:143], a[44:47], v[212:215]
    v_mfma_f32_16x16x32_bf16 v[216:219], a[136:139], a[48:51], 0
    ds_read_b128 a[120:123], v2 offset:47104
    v_mfma_f32_16x16x32_bf16 v[216:219], a[140:143], a[52:55], v[216:219]
    v_mfma_f32_16x16x32_bf16 v[220:223], a[136:139], a[56:59], 0
    v_mfma_f32_16x16x32_bf16 v[220:223], a[140:143], a[60:63], v[220:223]
    s_waitcnt lgkmcnt(4)
    v_mfma_f32_16x16x32_bf16 v[224:227], a[128:131], a[0:3], 0
    s_waitcnt lgkmcnt(2)
    ds_read_b64_tr_b16 a[136:137], v11 offset:0
    v_mfma_f32_16x16x32_bf16 v[224:227], a[132:135], a[4:7], v[224:227]
    ds_read_b128 a[124:127], v3 offset:47104
    v_mfma_f32_16x16x32_bf16 v[228:231], a[128:131], a[8:11], 0
    ds_read_b64_tr_b16 a[138:139], v11 offset:2048
    v_mfma_f32_16x16x32_bf16 v[228:231], a[132:135], a[12:15], v[228:231]
    v_mfma_f32_16x16x32_bf16 v[232:235], a[128:131], a[16:19], 0
    ds_read_b64_tr_b16 a[140:141], v11 offset:16384
    v_mfma_f32_16x16x32_bf16 v[232:235], a[132:135], a[20:23], v[232:235]
    v_mfma_f32_16x16x32_bf16 v[236:239], a[128:131], a[24:27], 0
    ds_read_b64_tr_b16 a[142:143], v11 offset:18432
    v_mfma_f32_16x16x32_bf16 v[236:239], a[132:135], a[28:31], v[236:239]
    v_mfma_f32_16x16x32_bf16 v[240:243], a[128:131], a[32:35], 0
    v_mfma_f32_16x16x32_bf16 v[240:243], a[132:135], a[36:39], v[240:243]
    v_mfma_f32_16x16x32_bf16 v[244:247], a[128:131], a[40:43], 0
    v_mfma_f32_16x16x32_bf16 v[244:247], a[132:135], a[44:47], v[244:247]
    v_mfma_f32_16x16x32_bf16 v[248:251], a[128:131], a[48:51], 0
    v_mfma_f32_16x16x32_bf16 v[248:251], a[132:135], a[52:55], v[248:251]
    v_mfma_f32_16x16x32_bf16 v[252:255], a[128:131], a[56:59], 0
    v_mfma_f32_16x16x32_bf16 v[252:255], a[132:135], a[60:63], v[252:255]
    s_waitcnt vmcnt(0) lgkmcnt(0)
    s_barrier
    v_mfma_f32_16x16x32_bf16 a[224:227], a[136:139], a[0:3], 0
    s_add_u32 m0, s21, 65536
    ds_read_b64_tr_b16 a[128:129], v4 offset:32768
    v_mfma_f32_16x16x32_bf16 a[224:227], a[140:143], a[4:7], a[224:227]
    buffer_load_dwordx4 v16, s[8:11], s18 offen offset:0 lds
    v_mfma_f32_16x16x32_bf16 a[228:231], a[136:139], a[8:11], 0
    ds_read_b64_tr_b16 a[130:131], v4 offset:34816
    v_mfma_f32_16x16x32_bf16 a[228:231], a[140:143], a[12:15], a[228:231]
    v_mfma_f32_16x16x32_bf16 a[232:235], a[136:139], a[16:19], 0
    ds_read_b64_tr_b16 a[132:133], v4 offset:49152
    v_mfma_f32_16x16x32_bf16 a[232:235], a[140:143], a[20:23], a[232:235]
    buffer_load_dwordx4 v17, s[8:11], s18 offen offset:1024 lds
    v_mfma_f32_16x16x32_bf16 a[236:239], a[136:139], a[24:27], 0
    ds_read_b64_tr_b16 a[134:135], v4 offset:51200
    v_mfma_f32_16x16x32_bf16 a[236:239], a[140:143], a[28:31], a[236:239]
    v_mfma_f32_16x16x32_bf16 a[240:243], a[136:139], a[32:35], 0
    v_mfma_f32_16x16x32_bf16 a[240:243], a[140:143], a[36:39], a[240:243]
    buffer_load_dwordx4 v18, s[8:11], s18 offen offset:2048 lds
    v_mfma_f32_16x16x32_bf16 a[244:247], a[136:139], a[40:43], 0
    v_mfma_f32_16x16x32_bf16 a[244:247], a[140:143], a[44:47], a[244:247]
    v_mfma_f32_16x16x32_bf16 a[248:251], a[136:139], a[48:51], 0
    v_mfma_f32_16x16x32_bf16 a[248:251], a[140:143], a[52:55], a[248:251]
    buffer_load_dwordx4 v19, s[8:11], s18 offen offset:3072 lds
    v_mfma_f32_16x16x32_bf16 a[252:255], a[136:139], a[56:59], 0
    s_add_u32 s18, s18, 524288
    v_mfma_f32_16x16x32_bf16 a[252:255], a[140:143], a[60:63], a[252:255]
    s_waitcnt lgkmcnt(2)
ALg_1:
    v_mfma_f32_16x16x32_bf16 v[32:35], a[128:131], a[64:67], v[32:35]
    s_waitcnt lgkmcnt(0)
    s_add_u32 m0, s21, 81920
    ds_read_b64_tr_b16 a[136:137], v5 offset:32768
    v_mfma_f32_16x16x32_bf16 v[32:35], a[132:135], a[68:71], v[32:35]
    buffer_load_dwordx4 v16, s[8:11], s19 offen offset:0 lds
    v_mfma_f32_16x16x32_bf16 v[36:39], a[128:131], a[72:75], v[36:39]
    ds_read_b64_tr_b16 a[138:139], v5 offset:34816
    v_mfma_f32_16x16x32_bf16 v[36:39], a[132:135], a[76:79], v[36:39]
    ds_read_b128 a[0:3], v2 offset:0
    v_mfma_f32_16x16x32_bf16 v[40:43], a[128:131], a[80:83], v[40:43]
    ds_read_b64_tr_b16 a[140:141], v5 offset:49152
    v_mfma_f32_16x16x32_bf16 v[40:43], a[132:135], a[84:87], v[40:43]
    buffer_load_dwordx4 v17, s[8:11], s19 offen offset:1024 lds
    v_mfma_f32_16x16x32_bf16 v[44:47], a[128:131], a[88:91], v[44:47]
    ds_read_b64_tr_b16 a[142:143], v5 offset:51200
    v_mfma_f32_16x16x32_bf16 v[44:47], a[132:135], a[92:95], v[44:47]
    v_mfma_f32_16x16x32_bf16 v[48:51], a[128:131], a[96:99], v[48:51]
    v_mfma_f32_16x16x32_bf16 v[48:51], a[132:135], a[100:103], v[48:51]
    buffer_load_dwordx4 v18, s[8:11], s19 offen offset:2048 lds
    v_mfma_f32_16x16x32_bf16 v[52:55], a[128:131], a[104:107], v[52:55]
    v_mfma_f32_16x16x32_bf16 v[52:55], a[132:135], a[108:111], v[52:55]
    ds_read_b128 a[4:7], v3 offset:0
    v_mfma_f32_16x16x32_bf16 v[56:59], a[128:131], a[112:115], v[56:59]
    v_mfma_f32_16x16x32_bf16 v[56:59], a[132:135], a[116:119], v[56:59]
    buffer_load_dwordx4 v19, s[8:11], s19 offen offset:3072 lds
    v_mfma_f32_16x16x32_bf16 v[60:63], a[128:131], a[120:123], v[60:63]
    s_add_u32 s19, s19, 524288
    v_mfma_f32_16x16x32_bf16 v[60:63], a[132:135], a[124:127], v[60:63]
    s_waitcnt lgkmcnt(4)
    v_mfma_f32_16x16x32_bf16 v[64:67], a[136:139], a[64:67], v[64:67]
    s_waitcnt lgkmcnt(1)
    s_add_u32 m0, s20, 32768
    ds_read_b64_tr_b16 a[128:129], v6 offset:32768
    v_mfma_f32_16x16x32_bf16 v[64:67], a[140:143], a[68:71], v[64:67]
    buffer_load_dwordx4 v12, s[4:7], s16 offen offset:0 lds
    v_mfma_f32_16x16x32_bf16 v[68:71], a[136:139], a[72:75], v[68:71]
    ds_read_b64_tr_b16 a[130:131], v6 offset:34816
    v_mfma_f32_16x16x32_bf16 v[68:71], a[140:143], a[76:79], v[68:71]
    ds_read_b128 a[8:11], v2 offset:2048
    v_mfma_f32_16x16x32_bf16 v[72:75], a[136:139], a[80:83], v[72:75]
    ds_read_b64_tr_b16 a[132:133], v6 offset:49152
    v_mfma_f32_16x16x32_bf16 v[72:75], a[140:143], a[84:87], v[72:75]
    buffer_load_dwordx4 v13, s[4:7], s16 offen offset:1024 lds
    v_mfma_f32_16x16x32_bf16 v[76:79], a[136:139], a[88:91], v[76:79]
    ds_read_b64_tr_b16 a[134:135], v6 offset:51200
    v_mfma_f32_16x16x32_bf16 v[76:79], a[140:143], a[92:95], v[76:79]
    v_mfma_f32_16x16x32_bf16 v[80:83], a[136:139], a[96:99], v[80:83]
    v_mfma_f32_16x16x32_bf16 v[80:83], a[140:143], a[100:103], v[80:83]
    buffer_load_dwordx4 v14, s[4:7], s16 offen offset:2048 lds
    v_mfma_f32_16x16x32_bf16 v[84:87], a[136:139], a[104:107], v[84:87]
    v_mfma_f32_16x16x32_bf16 v[84:87], a[140:143], a[108:111], v[84:87]
    ds_read_b128 a[12:15], v3 offset:2048
    v_mfma_f32_16x16x32_bf16 v[88:91], a[136:139], a[112:115], v[88:91]
    v_mfma_f32_16x16x32_bf16 v[88:91], a[140:143], a[116:119], v[88:91]
    buffer_load_dwordx4 v15, s[4:7], s16 offen offset:3072 lds
    v_mfma_f32_16x16x32_bf16 v[92:95], a[136:139], a[120:123], v[92:95]
    s_add_u32 s16, s16, 128
    v_mfma_f32_16x16x32_bf16 v[92:95], a[140:143], a[124:127], v[92:95]
    s_waitcnt lgkmcnt(4)
    v_mfma_f32_16x16x32_bf16 v[96:99], a[128:131], a[64:67], v[96:99]
    s_waitcnt lgkmcnt(1)
    s_add_u32 m0, s20, 36864
    ds_read_b64_tr_b16 a[136:137], v7 offset:32768
    v_mfma_f32_16x16x32_bf16 v[96:99], a[132:135], a[68:71], v[96:99]
    buffer_load_dwordx4 v12, s[4:7], s17 offen offset:0 lds
    v_mfma_f32_16x16x32_bf16 v[100:103], a[128:131], a[72:75], v[100:103]
    ds_read_b64_tr_b16 a[138:139], v7 offset:34816
    v_mfma_f32_16x16x32_bf16 v[100:103], a[132:135], a[76:79], v[100:103]
    ds_read_b128 a[16:19], v2 offset:4096
    v_mfma_f32_16x16x32_bf16 v[104:107], a[128:131], a[80:83], v[104:107]
    ds_read_b64_tr_b16 a[140:141], v7 offset:49152
    v_mfma_f32_16x16x32_bf16 v[104:107], a[132:135], a[84:87], v[104:107]
    buffer_load_dwordx4 v13, s[4:7], s17 offen offset:1024 lds
    v_mfma_f32_16x16x32_bf16 v[108:111], a[128:131], a[88:91], v[108:111]
    ds_read_b64_tr_b16 a[142:143], v7 offset:51200
    v_mfma_f32_16x16x32_bf16 v[108:111], a[132:135], a[92:95], v[108:111]
    v_mfma_f32_16x16x32_bf16 v[112:115], a[128:131], a[96:99], v[112:115]
    v_mfma_f32_16x16x32_bf16 v[112:115], a[132:135], a[100:103], v[112:115]
    buffer_load_dwordx4 v14, s[4:7], s17 offen offset:2048 lds
    v_mfma_f32_16x16x32_bf16 v[116:119], a[128:131], a[104:107], v[116:119]
    v_mfma_f32_16x16x32_bf16 v[116:119], a[132:135], a[108:111], v[116:119]
    ds_read_b128 a[20:23], v3 offset:4096
    v_mfma_f32_16x16x32_bf16 v[120:123], a[128:131], a[112:115], v[120:123]
    v_mfma_f32_16x16x32_bf16 v[120:123], a[132:135], a[116:119], v[120:123]
    buffer_load_dwordx4 v15, s[4:7], s17 offen offset:3072 lds
    v_mfma_f32_16x16x32_bf16 v[124:127], a[128:131], a[120:123], v[124:127]
    s_add_u32 s17, s17, 128
    v_mfma_f32_16x16x32_bf16 v[124:127], a[132:135], a[124:127], v[124:127]
    s_waitcnt lgkmcnt(4)
    v_mfma_f32_16x16x32_bf16 v[128:131], a[136:139], a[64:67], v[128:131]
    s_waitcnt lgkmcnt(1)
    ds_read_b64_tr_b16 a[128:129], v8 offset:32768
    v_mfma_f32_16x16x32_bf16 v[128:131], a[140:143], a[68:71], v[128:131]
    ds_read_b128 a[24:27], v2 offset:6144
    v_mfma_f32_16x16x32_bf16 v[132:135], a[136:139], a[72:75], v[132:135]
    ds_read_b64_tr_b16 a[130:131], v8 offset:34816
    v_mfma_f32_16x16x32_bf16 v[132:135], a[140:143], a[76:79], v[132:135]
    v_mfma_f32_16x16x32_bf16 v[136:139], a[136:139], a[80:83], v[136:139]
    ds_read_b64_tr_b16 a[132:133], v8 offset:49152
    v_mfma_f32_16x16x32_bf16 v[136:139], a[140:143], a[84:87], v[136:139]
    v_mfma_f32_16x16x32_bf16 v[140:143], a[136:139], a[88:91], v[140:143]
    ds_read_b64_tr_b16 a[134:135], v8 offset:51200
    v_mfma_f32_16x16x32_bf16 v[140:143], a[140:143], a[92:95], v[140:143]
    v_mfma_f32_16x16x32_bf16 v[144:147], a[136:139], a[96:99], v[144:147]
    ds_read_b128 a[28:31], v3 offset:6144
    v_mfma_f32_16x16x32_bf16 v[144:147], a[140:143], a[100:103], v[144:147]
    v_mfma_f32_16x16x32_bf16 v[148:151], a[136:139], a[104:107], v[148:151]
    v_mfma_f32_16x16x32_bf16 v[148:151], a[140:143], a[108:111], v[148:151]
    v_mfma_f32_16x16x32_bf16 v[152:155], a[136:139], a[112:115], v[152:155]
    ds_read_b128 a[32:35], v2 offset:8192
    v_mfma_f32_16x16x32_bf16 v[152:155], a[140:143], a[116:119], v[152:155]
    v_mfma_f32_16x16x32_bf16 v[156:159], a[136:139], a[120:123], v[156:159]
    v_mfma_f32_16x16x32_bf16 v[156:159], a[140:143], a[124:127], v[156:159]
    s_waitcnt lgkmcnt(4)
    v_mfma_f32_16x16x32_bf16 v[160:163], a[128:131], a[64:67], v[160:163]
    s_waitcnt lgkmcnt(2)
    ds_read_b64_tr_b16 a[136:137], v9 offset:32768
    v_mfma_f32_16x16x32_bf16 v[160:163], a[132:135], a[68:71], v[160:163]
    ds_read_b128 a[36:39], v3 offset:8192
    v_mfma_f32_16x16x32_bf16 v[164:167], a[128:131], a[72:75], v[164:167]
    ds_read_b64_tr_b16 a[138:139], v9 offset:34816
    v_mfma_f32_16x16x32_bf16 v[164:167], a[132:135], a[76:79], v[164:167]
    v_mfma_f32_16x16x32_bf16 v[168:171], a[128:131], a[80:83], v[168:171]
    ds_read_b64_tr_b16 a[140:141], v9 offset:49152
    v_mfma_f32_16x16x32_bf16 v[168:171], a[132:135], a[84:87], v[168:171]
    v_mfma_f32_16x16x32_bf16 v[172:175], a[128:131], a[88:91], v[172:175]
    ds_read_b64_tr_b16 a[142:143], v9 offset:51200
    v_mfma_f32_16x16x32_bf16 v[172:175], a[132:135], a[92:95], v[172:175]
    v_mfma_f32_16x16x32_bf16 v[176:179], a[128:131], a[96:99], v[176:179]
    ds_read_b128 a[40:43], v2 offset:10240
    v_mfma_f32_16x16x32_bf16 v[176:179], a[132:135], a[100:103], v[176:179]
    v_mfma_f32_16x16x32_bf16 v[180:183], a[128:131], a[104:107], v[180:183]
    v_mfma_f32_16x16x32_bf16 v[180:183], a[132:135], a[108:111], v[180:183]
    v_mfma_f32_16x16x32_bf16 v[184:187], a[128:131], a[112:115], v[184:187]
    ds_read_b128 a[44:47], v3 offset:10240
    v_mfma_f32_16x16x32_bf16 v[184:187], a[132:135], a[116:119], v[184:187]
    v_mfma_f32_16x16x32_bf16 v[188:191], a[128:131], a[120:123], v[188:191]
    v_mfma_f32_16x16x32_bf16 v[188:191], a[132:135], a[124:127], v[188:191]
    s_waitcnt lgkmcnt(4)
    v_mfma_f32_16x16x32_bf16 v[192:195], a[136:139], a[64:67], v[192:195]
    s_waitcnt lgkmcnt(2)
    ds_read_b64_tr_b16 a[128:129], v10 offset:32768
    v_mfma_f32_16x16x32_bf16 v[192:195], a[140:143], a[68:71], v[192:195]
    ds_read_b128 a[48:51], v2 offset:12288
    v_mfma_f32_16x16x32_bf16 v[196:199], a[136:139], a[72:75], v[196:199]
    ds_read_b64_tr_b16 a[130:131], v10 offset:34816
    v_mfma_f32_16x16x32_bf16 v[196:199], a[140:143], a[76:79], v[196:199]
    v_mfma_f32_16x16x32_bf16 v[200:203], a[136:139], a[80:83], v[200:203]
    ds_read_b64_tr_b16 a[132:133], v10 offset:49152
    v_mfma_f32_16x16x32_bf16 v[200:203], a[140:143], a[84:87], v[200:203]
    v_mfma_f32_16x16x32_bf16 v[204:207], a[136:139], a[88:91], v[204:207]
    ds_read_b64_tr_b16 a[134:135], v10 offset:51200
    v_mfma_f32_16x16x32_bf16 v[204:207], a[140:143], a[92:95], v[204:207]
    v_mfma_f32_16x16x32_bf16 v[208:211], a[136:139], a[96:99], v[208:211]
    ds_read_b128 a[52:55], v3 offset:12288
    v_mfma_f32_16x16x32_bf16 v[208:211], a[140:143], a[100:103], v[208:211]
    v_mfma_f32_16x16x32_bf16 v[212:215], a[136:139], a[104:107], v[212:215]
    v_mfma_f32_16x16x32_bf16 v[212:215], a[140:143], a[108:111], v[212:215]
    v_mfma_f32_16x16x32_bf16 v[216:219], a[136:139], a[112:115], v[216:219]
    ds_read_b128 a[56:59], v2 offset:14336
    v_mfma_f32_16x16x32_bf16 v[216:219], a[140:143], a[116:119], v[216:219]
    v_mfma_f32_16x16x32_bf16 v[220:223], a[136:139], a[120:123], v[220:223]
    v_mfma_f32_16x16x32_bf16 v[220:223], a[140:143], a[124:127], v[220:223]
    s_waitcnt lgkmcnt(4)
    v_mfma_f32_16x16x32_bf16 v[224:227], a[128:131], a[64:67], v[224:227]
    s_waitcnt lgkmcnt(2)
    ds_read_b64_tr_b16 a[136:137], v11 offset:32768
    v_mfma_f32_16x16x32_bf16 v[224:227], a[132:135], a[68:71], v[224:227]
    ds_read_b128 a[60:63], v3 offset:14336
    v_mfma_f32_16x16x32_bf16 v[228:231], a[128:131], a[72:75], v[228:231]
    ds_read_b64_tr_b16 a[138:139], v11 offset:34816
    v_mfma_f32_16x16x32_bf16 v[228:231], a[132:135], a[76:79], v[228:231]
    v_mfma_f32_16x16x32_bf16 v[232:235], a[128:131], a[80:83], v[232:235]
    ds_read_b64_tr_b16 a[140:141], v11 offset:49152
    v_mfma_f32_16x16x32_bf16 v[232:235], a[132:135], a[84:87], v[232:235]
    v_mfma_f32_16x16x32_bf16 v[236:239], a[128:131], a[88:91], v[236:239]
    ds_read_b64_tr_b16 a[142:143], v11 offset:51200
    v_mfma_f32_16x16x32_bf16 v[236:239], a[132:135], a[92:95], v[236:239]
    v_mfma_f32_16x16x32_bf16 v[240:243], a[128:131], a[96:99], v[240:243]
    v_mfma_f32_16x16x32_bf16 v[240:243], a[132:135], a[100:103], v[240:243]
    v_mfma_f32_16x16x32_bf16 v[244:247], a[128:131], a[104:107], v[244:247]
    v_mfma_f32_16x16x32_bf16 v[244:247], a[132:135], a[108:111], v[244:247]
    v_mfma_f32_16x16x32_bf16 v[248:251], a[128:131], a[112:115], v[248:251]
    v_mfma_f32_16x16x32_bf16 v[248:251], a[132:135], a[116:119], v[248:251]
    v_mfma_f32_16x16x32_bf16 v[252:255], a[128:131], a[120:123], v[252:255]
    v_mfma_f32_16x16x32_bf16 v[252:255], a[132:135], a[124:127], v[252:255]
    s_waitcnt vmcnt(0) lgkmcnt(0)
    s_barrier
    v_mfma_f32_16x16x32_bf16 a[224:227], a[136:139], a[64:67], a[224:227]
    s_add_u32 m0, s21, 98304
    ds_read_b64_tr_b16 a[128:129], v4 offset:0
    v_mfma_f32_16x16x32_bf16 a[224:227], a[140:143], a[68:71], a[224:227]
    buffer_load_dwordx4 v16, s[8:11], s18 offen offset:0 lds
    v_mfma_f32_16x16x32_bf16 a[228:231], a[136:139], a[72:75], a[228:231]
    ds_read_b64_tr_b16 a[130:131], v4 offset:2048
    v_mfma_f32_16x16x32_bf16 a[228:231], a[140:143], a[76:79], a[228:231]
    v_mfma_f32_16x16x32_bf16 a[232:235], a[136:139], a[80:83], a[232:235]
    ds_read_b64_tr_b16 a[132:133], v4 offset:16384
    v_mfma_f32_16x16x32_bf16 a[232:235], a[140:143], a[84:87], a[232:235]
    buffer_load_dwordx4 v17, s[8:11], s18 offen offset:1024 lds
    v_mfma_f32_16x16x32_bf16 a[236:239], a[136:139], a[88:91], a[236:239]
    ds_read_b64_tr_b16 a[134:135], v4 offset:18432
    v_mfma_f32_16x16x32_bf16 a[236:239], a[140:143], a[92:95], a[236:239]
    v_mfma_f32_16x16x32_bf16 a[240:243], a[136:139], a[96:99], a[240:243]
    v_mfma_f32_16x16x32_bf16 a[240:243], a[140:143], a[100:103], a[240:243]
    buffer_load_dwordx4 v18, s[8:11], s18 offen offset:2048 lds
    v_mfma_f32_16x16x32_bf16 a[244:247], a[136:139], a[104:107], a[244:247]
    v_mfma_f32_16x16x32_bf16 a[244:247], a[140:143], a[108:111], a[244:247]
    v_mfma_f32_16x16x32_bf16 a[248:251], a[136:139], a[112:115], a[248:251]
    v_mfma_f32_16x16x32_bf16 a[248:251], a[140:143], a[116:119], a[248:251]
    buffer_load_dwordx4 v19, s[8:11], s18 offen offset:3072 lds
    v_mfma_f32_16x16x32_bf16 a[252:255], a[136:139], a[120:123], a[252:255]
    s_add_u32 s18, s18, 524288
    v_mfma_f32_16x16x32_bf16 a[252:255], a[140:143], a[124:127], a[252:255]
    s_waitcnt lgkmcnt(2)
    v_mfma_f32_16x16x32_bf16 v[32:35], a[128:131], a[0:3], v[32:35]
    s_waitcnt lgkmcnt(0)
    s_add_u32 m0, s21, 114688
    ds_read_b64_tr_b16 a[136:137], v5 offset:0
    v_mfma_f32_16x16x32_bf16 v[32:35], a[132:135], a[4:7], v[32:35]
    buffer_load_dwordx4 v16, s[8:11], s19 offen offset:0 lds
    v_mfma_f32_16x16x32_bf16 v[36:39], a[128:131], a[8:11], v[36:39]
    ds_read_b64_tr_b16 a[138:139], v5 offset:2048
    v_mfma_f32_16x16x32_bf16 v[36:39], a[132:135], a[12:15], v[36:39]
    ds_read_b128 a[64:67], v2 offset:32768
    v_mfma_f32_16x16x32_bf16 v[40:43], a[128:131], a[16:19], v[40:43]
    ds_read_b64_tr_b16 a[140:141], v5 offset:16384
    v_mfma_f32_16x16x32_bf16 v[40:43], a[132:135], a[20:23], v[40:43]
    buffer_load_dwordx4 v17, s[8:11], s19 offen offset:1024 lds
    v_mfma_f32_16x16x32_bf16 v[44:47], a[128:131], a[24:27], v[44:47]
    ds_read_b64_tr_b16 a[142:143], v5 offset:18432
    v_mfma_f32_16x16x32_bf16 v[44:47], a[132:135], a[28:31], v[44:47]
    v_mfma_f32_16x16x32_bf16 v[48:51], a[128:131], a[32:35], v[48:51]
    v_mfma_f32_16x16x32_bf16 v[48:51], a[132:135], a[36:39], v[48:51]
    buffer_load_dwordx4 v18, s[8:11], s19 offen offset:2048 lds
    v_mfma_f32_16x16x32_bf16 v[52:55], a[128:131], a[40:43], v[52:55]
    v_mfma_f32_16x16x32_bf16 v[52:55], a[132:135], a[44:47], v[52:55]
    ds_read_b128 a[68:71], v3 offset:32768
    v_mfma_f32_16x16x32_bf16 v[56:59], a[128:131], a[48:51], v[56:59]
    v_mfma_f32_16x16x32_bf16 v[56:59], a[132:135], a[52:55], v[56:59]
    buffer_load_dwordx4 v19, s[8:11], s19 offen offset:3072 lds
    v_mfma_f32_16x16x32_bf16 v[60:63], a[128:131], a[56:59], v[60:63]
    s_add_u32 s19, s19, 524288
    v_mfma_f32_16x16x32_bf16 v[60:63], a[132:135], a[60:63], v[60:63]
    s_waitcnt lgkmcnt(4)
    v_mfma_f32_16x16x32_bf16 v[64:67], a[136:139], a[0:3], v[64:67]
    s_waitcnt lgkmcnt(1)
    s_add_u32 m0, s20, 0
    ds_read_b64_tr_b16 a[128:129], v6 offset:0
    v_mfma_f32_16x16x32_bf16 v[64:67], a[140:143], a[4:7], v[64:67]
    buffer_load_dwordx4 v12, s[4:7], s16 offen offset:0 lds
    v_mfma_f32_16x16x32_bf16 v[68:71], a[136:139], a[8:11], v[68:71]
    ds_read_b64_tr_b16 a[130:131], v6 offset:2048
    v_mfma_f32_16x16x32_bf16 v[68:71], a[140:143], a[12:15], v[68:71]
    ds_read_b128 a[72:75], v2 offset:34816
    v_mfma_f32_16x16x32_bf16 v[72:75], a[136:139], a[16:19], v[72:75]
    ds_read_b64_tr_b16 a[132:133], v6 offset:16384
    v_mfma_f32_16x16x32_bf16 v[72:75], a[140:143], a[20:23], v[72:75]
    buffer_load_dwordx4 v13, s[4:7], s16 offen offset:1024 lds
    v_mfma_f32_16x16x32_bf16 v[76:79], a[136:139], a[24:27], v[76:79]
    ds_read_b64_tr_b16 a[134:135], v6 offset:18432
    v_mfma_f32_16x16x32_bf16 v[76:79], a[140:143], a[28:31], v[76:79]
    v_mfma_f32_16x16x32_bf16 v[80:83], a[136:139], a[32:35], v[80:83]
    v_mfma_f32_16x16x32_bf16 v[80:83], a[140:143], a[36:39], v[80:83]
    buffer_load_dwordx4 v14, s[4:7], s16 offen offset:2048 lds
    v_mfma_f32_16x16x32_bf16 v[84:87], a[136:139], a[40:43], v[84:87]
    v_mfma_f32_16x16x32_bf16 v[84:87], a[140:143], a[44:47], v[84:87]
    ds_read_b128 a[76:79], v3 offset:34816
    v_mfma_f32_16x16x32_bf16 v[88:91], a[136:139], a[48:51], v[88:91]
    v_mfma_f32_16x16x32_bf16 v[88:91], a[140:143], a[52:55], v[88:91]
    buffer_load_dwordx4 v15, s[4:7], s16 offen offset:3072 lds
    v_mfma_f32_16x16x32_bf16 v[92:95], a[136:139], a[56:59], v[92:95]
    s_add_u32 s16, s16, 128
    v_mfma_f32_16x16x32_bf16 v[92:95], a[140:143], a[60:63], v[92:95]
    s_waitcnt lgkmcnt(4)
    v_mfma_f32_16x16x32_bf16 v[96:99], a[128:131], a[0:3], v[96:99]
    s_waitcnt lgkmcnt(1)
    s_add_u32 m0, s20, 4096
    ds_read_b64_tr_b16 a[136:137], v7 offset:0
    v_mfma_f32_16x16x32_bf16 v[96:99], a[132:135], a[4:7], v[96:99]
    buffer_load_dwordx4 v12, s[4:7], s17 offen offset:0 lds
    v_mfma_f32_16x16x32_bf16 v[100:103], a[128:131], a[8:11], v[100:103]
    ds_read_b64_tr_b16 a[138:139], v7 offset:2048
    v_mfma_f32_16x16x32_bf16 v[100:103], a[132:135], a[12:15], v[100:103]
    ds_read_b128 a[80:83], v2 offset:36864
    v_mfma_f32_16x16x32_bf16 v[104:107], a[128:131], a[16:19], v[104:107]
    ds_read_b64_tr_b16 a[140:141], v7 offset:16384
    v_mfma_f32_16x16x32_bf16 v[104:107], a[132:135], a[20:23], v[104:107]
    buffer_load_dwordx4 v13, s[4:7], s17 offen offset:1024 lds
    v_mfma_f32_16x16x32_bf16 v[108:111], a[128:131], a[24:27], v[108:111]
    ds_read_b64_tr_b16 a[142:143], v7 offset:18432
    v_mfma_f32_16x16x32_bf16 v[108:111], a[132:135], a[28:31], v[108:111]
    v_mfma_f32_16x16x32_bf16 v[112:115], a[128:131], a[32:35], v[112:115]
    v_mfma_f32_16x16x32_bf16 v[112:115], a[132:135], a[36:39], v[112:115]
    buffer_load_dwordx4 v14, s[4:7], s17 offen offset:2048 lds
    v_mfma_f32_16x16x32_bf16 v[116:119], a[128:131], a[40:43], v[116:119]
    v_mfma_f32_16x16x32_bf16 v[116:119], a[132:135], a[44:47], v[116:119]
    ds_read_b128 a[84:87], v3 offset:36864
    v_mfma_f32_16x16x32_bf16 v[120:123], a[128:131], a[48:51], v[120:123]
    v_mfma_f32_16x16x32_bf16 v[120:123], a[132:135], a[52:55], v[120:123]
    buffer_load_dwordx4 v15, s[4:7], s17 offen offset:3072 lds
    v_mfma_f32_16x16x32_bf16 v[124:127], a[128:131], a[56:59], v[124:127]
    s_add_u32 s17, s17, 128
    v_mfma_f32_16x16x32_bf16 v[124:127], a[132:135], a[60:63], v[124:127]
    s_waitcnt lgkmcnt(4)
    v_mfma_f32_16x16x32_bf16 v[128:131], a[136:139], a[0:3], v[128:131]
    s_waitcnt lgkmcnt(1)
    ds_read_b64_tr_b16 a[128:129], v8 offset:0
    v_mfma_f32_16x16x32_bf16 v[128:131], a[140:143], a[4:7], v[128:131]
    ds_read_b128 a[88:91], v2 offset:38912
    v_mfma_f32_16x16x32_bf16 v[132:135], a[136:139], a[8:11], v[132:135]
    ds_read_b64_tr_b16 a[130:131], v8 offset:2048
    v_mfma_f32_16x16x32_bf16 v[132:135], a[140:143], a[12:15], v[132:135]
    v_mfma_f32_16x16x32_bf16 v[136:139], a[136:139], a[16:19], v[136:139]
    ds_read_b64_tr_b16 a[132:133], v8 offset:16384
    v_mfma_f32_16x16x32_bf16 v[136:139], a[140:143], a[20:23], v[136:139]
    v_mfma_f32_16x16x32_bf16 v[140:143], a[136:139], a[24:27], v[140:143]
    ds_read_b64_tr_b16 a[134:135], v8 offset:18432
    v_mfma_f32_16x16x32_bf16 v[140:143], a[140:143], a[28:31], v[140:143]
    v_mfma_f32_16x16x32_bf16 v[144:147], a[136:139], a[32:35], v[144:147]
    ds_read_b128 a[92:95], v3 offset:38912
    v_mfma_f32_16x16x32_bf16 v[144:147], a[140:143], a[36:39], v[144:147]
    v_mfma_f32_16x16x32_bf16 v[148:151], a[136:139], a[40:43], v[148:151]
    v_mfma_f32_16x16x32_bf16 v[148:151], a[140:143], a[44:47], v[148:151]
    v_mfma_f32_16x16x32_bf16 v[152:155], a[136:139], a[48:51], v[152:155]
    ds_read_b128 a[96:99], v2 offset:40960
    v_mfma_f32_16x16x32_bf16 v[152:155], a[140:143], a[52:55], v[152:155]
    v_mfma_f32_16x16x32_bf16 v[156:159], a[136:139], a[56:59], v[156:159]
    v_mfma_f32_16x16x32_bf16 v[156:159], a[140:143], a[60:63], v[156:159]
    s_waitcnt lgkmcnt(4)
    v_mfma_f32_16x16x32_bf16 v[160:163], a[128:131], a[0:3], v[160:163]
    s_waitcnt lgkmcnt(2)
    ds_read_b64_tr_b16 a[136:137], v9 offset:0
    v_mfma_f32_16x16x32_bf16 v[160:163], a[132:135], a[4:7], v[160:163]
    ds_read_b128 a[100:103], v3 offset:40960
    v_mfma_f32_16x16x32_bf16 v[164:167], a[128:131], a[8:11], v[164:167]
    ds_read_b64_tr_b16 a[138:139], v9 offset:2048
    v_mfma_f32_16x16x32_bf16 v[164:167], a[132:135], a[12:15], v[164:167]
    v_mfma_f32_16x16x32_bf16 v[168:171], a[128:131], a[16:19], v[168:171]
    ds_read_b64_tr_b16 a[140:141], v9 offset:16384
    v_mfma_f32_16x16x32_bf16 v[168:171], a[132:135], a[20:23], v[168:171]
    v_mfma_f32_16x16x32_bf16 v[172:175], a[128:131], a[24:27], v[172:175]
    ds_read_b64_tr_b16 a[142:143], v9 offset:18432
    v_mfma_f32_16x16x32_bf16 v[172:175], a[132:135], a[28:31], v[172:175]
    v_mfma_f32_16x16x32_bf16 v[176:179], a[128:131], a[32:35], v[176:179]
    ds_read_b128 a[104:107], v2 offset:43008
    v_mfma_f32_16x16x32_bf16 v[176:179], a[132:135], a[36:39], v[176:179]
    v_mfma_f32_16x16x32_bf16 v[180:183], a[128:131], a[40:43], v[180:183]
    v_mfma_f32_16x16x32_bf16 v[180:183], a[132:135], a[44:47], v[180:183]
    v_mfma_f32_16x16x32_bf16 v[184:187], a[128:131], a[48:51], v[184:187]
    ds_read_b128 a[108:111], v3 offset:43008
    v_mfma_f32_16x16x32_bf16 v[184:187], a[132:135], a[52:55], v[184:187]
    v_mfma_f32_16x16x32_bf16 v[188:191], a[128:131], a[56:59], v[188:191]
    v_mfma_f32_16x16x32_bf16 v[188:191], a[132:135], a[60:63], v[188:191]
    s_waitcnt lgkmcnt(4)
    v_mfma_f32_16x16x32_bf16 v[192:195], a[136:139], a[0:3], v[192:195]
    s_waitcnt lgkmcnt(2)
    ds_read_b64_tr_b16 a[128:129], v10 offset:0
    v_mfma_f32_16x16x32_bf16 v[192:195], a[140:143], a[4:7], v[192:195]
    ds_read_b128 a[112:115], v2 offset:45056
    v_mfma_f32_16x16x32_bf16 v[196:199], a[136:139], a[8:11], v[196:199]
    ds_read_b64_tr_b16 a[130:131], v10 offset:2048
    v_mfma_f32_16x16x32_bf16 v[196:199], a[140:143], a[12:15], v[196:199]
    v_mfma_f32_16x16x32_bf16 v[200:203], a[136:139], a[16:19], v[200:203]
    ds_read_b64_tr_b16 a[132:133], v10 offset:16384
    v_mfma_f32_16x16x32_bf16 v[200:203], a[140:143], a[20:23], v[200:203]
    v_mfma_f32_16x16x32_bf16 v[204:207], a[136:139], a[24:27], v[204:207]
    ds_read_b64_tr_b16 a[134:135], v10 offset:18432
    v_mfma_f32_16x16x32_bf16 v[204:207], a[140:143], a[28:31], v[204:207]
    v_mfma_f32_16x16x32_bf16 v[208:211], a[136:139], a[32:35], v[208:211]
    ds_read_b128 a[116:119], v3 offset:45056
    v_mfma_f32_16x16x32_bf16 v[208:211], a[140:143], a[36:39], v[208:211]
    v_mfma_f32_16x16x32_bf16 v[212:215], a[136:139], a[40:43], v[212:215]
    v_mfma_f32_16x16x32_bf16 v[212:215], a[140:143], a[44:47], v[212:215]
    v_mfma_f32_16x16x32_bf16 v[216:219], a[136:139], a[48:51], v[216:219]
    ds_read_b128 a[120:123], v2 offset:47104
    v_mfma_f32_16x16x32_bf16 v[216:219], a[140:143], a[52:55], v[216:219]
    v_mfma_f32_16x16x32_bf16 v[220:223], a[136:139], a[56:59], v[220:223]
    v_mfma_f32_16x16x32_bf16 v[220:223], a[140:143], a[60:63], v[220:223]
    s_waitcnt lgkmcnt(4)
    v_mfma_f32_16x16x32_bf16 v[224:227], a[128:131], a[0:3], v[224:227]
    s_waitcnt lgkmcnt(2)
    ds_read_b64_tr_b16 a[136:137], v11 offset:0
    v_mfma_f32_16x16x32_bf16 v[224:227], a[132:135], a[4:7], v[224:227]
    ds_read_b128 a[124:127], v3 offset:47104
    v_mfma_f32_16x16x32_bf16 v[228:231], a[128:131], a[8:11], v[228:231]
    ds_read_b64_tr_b16 a[138:139], v11 offset:2048
    v_mfma_f32_16x16x32_bf16 v[228:231], a[132:135], a[12:15], v[228:231]
    v_mfma_f32_16x16x32_bf16 v[232:235], a[128:131], a[16:19], v[232:235]
    ds_read_b64_tr_b16 a[140:141], v11 offset:16384
    v_mfma_f32_16x16x32_bf16 v[232:235], a[132:135], a[20:23], v[232:235]
    v_mfma_f32_16x16x32_bf16 v[236:239], a[128:131], a[24:27], v[236:239]
    ds_read_b64_tr_b16 a[142:143], v11 offset:18432
    v_mfma_f32_16x16x32_bf16 v[236:239], a[132:135], a[28:31], v[236:239]
    v_mfma_f32_16x16x32_bf16 v[240:243], a[128:131], a[32:35], v[240:243]
    v_mfma_f32_16x16x32_bf16 v[240:243], a[132:135], a[36:39], v[240:243]
    v_mfma_f32_16x16x32_bf16 v[244:247], a[128:131], a[40:43], v[244:247]
    v_mfma_f32_16x16x32_bf16 v[244:247], a[132:135], a[44:47], v[244:247]
    v_mfma_f32_16x16x32_bf16 v[248:251], a[128:131], a[48:51], v[248:251]
    v_mfma_f32_16x16x32_bf16 v[248:251], a[132:135], a[52:55], v[248:251]
    v_mfma_f32_16x16x32_bf16 v[252:255], a[128:131], a[56:59], v[252:255]
    v_mfma_f32_16x16x32_bf16 v[252:255], a[132:135], a[60:63], v[252:255]
    s_waitcnt vmcnt(0) lgkmcnt(0)
    s_barrier
    v_mfma_f32_16x16x32_bf16 a[224:227], a[136:139], a[0:3], a[224:227]
    s_add_u32 m0, s21, 65536
    ds_read_b64_tr_b16 a[128:129], v4 offset:32768
    v_mfma_f32_16x16x32_bf16 a[224:227], a[140:143], a[4:7], a[224:227]
    buffer_load_dwordx4 v16, s[8:11], s18 offen offset:0 lds
    v_mfma_f32_16x16x32_bf16 a[228:231], a[136:139], a[8:11], a[228:231]
    ds_read_b64_tr_b16 a[130:131], v4 offset:34816
    v_mfma_f32_16x16x32_bf16 a[228:231], a[140:143], a[12:15], a[228:231]
    v_mfma_f32_16x16x32_bf16 a[232:235], a[136:139], a[16:19], a[232:235]
    ds_read_b64_tr_b16 a[132:133], v4 offset:49152
    v_mfma_f32_16x16x32_bf16 a[232:235], a[140:143], a[20:23], a[232:235]
    buffer_load_dwordx4 v17, s[8:11], s18 offen offset:1024 lds
    v_mfma_f32_16x16x32_bf16 a[236:239], a[136:139], a[24:27], a[236:239]
    ds_read_b64_tr_b16 a[134:135], v4 offset:51200
    v_mfma_f32_16x16x32_bf16 a[236:239], a[140:143], a[28:31], a[236:239]
    v_mfma_f32_16x16x32_bf16 a[240:243], a[136:139], a[32:35], a[240:243]
    v_mfma_f32_16x16x32_bf16 a[240:243], a[140:143], a[36:39], a[240:243]
    buffer_load_dwordx4 v18, s[8:11], s18 offen offset:2048 lds
    v_mfma_f32_16x16x32_bf16 a[244:247], a[136:139], a[40:43], a[244:247]
    v_mfma_f32_16x16x32_bf16 a[244:247], a[140:143], a[44:47], a[244:247]
    v_mfma_f32_16x16x32_bf16 a[248:251], a[136:139], a[48:51], a[248:251]
    s_sub_u32 s22, s22, 1
    v_mfma_f32_16x16x32_bf16 a[248:251], a[140:143], a[52:55], a[248:251]
    buffer_load_dwordx4 v19, s[8:11], s18 offen offset:3072 lds
    v_mfma_f32_16x16x32_bf16 a[252:255], a[136:139], a[56:59], a[252:255]
    s_add_u32 s18, s18, 524288
    v_mfma_f32_16x16x32_bf16 a[252:255], a[140:143], a[60:63], a[252:255]
    s_waitcnt lgkmcnt(2)
    s_cmp_lg_u32 s22, 0
    s_cbranch_scc1 ALg_1
    v_mfma_f32_16x16x32_bf16 v[32:35], a[128:131], a[64:67], v[32:35]
    s_waitcnt lgkmcnt(0)
    s_add_u32 m0, s21, 81920
    ds_read_b64_tr_b16 a[136:137], v5 offset:32768
    v_mfma_f32_16x16x32_bf16 v[32:35], a[132:135], a[68:71], v[32:35]
    buffer_load_dwordx4 v16, s[8:11], s19 offen offset:0 lds
    v_mfma_f32_16x16x32_bf16 v[36:39], a[128:131], a[72:75], v[36:39]
    ds_read_b64_tr_b16 a[138:139], v5 offset:34816
    v_mfma_f32_16x16x32_bf16 v[36:39], a[132:135], a[76:79], v[36:39]
    ds_read_b128 a[0:3], v2 offset:0
    v_mfma_f32_16x16x32_bf16 v[40:43], a[128:131], a[80:83], v[40:43]
    ds_read_b64_tr_b16 a[140:141], v5 offset:49152
    v_mfma_f32_16x16x32_bf16 v[40:43], a[132:135], a[84:87], v[40:43]
    buffer_load_dwordx4 v17, s[8:11], s19 offen offset:1024 lds
    v_mfma_f32_16x16x32_bf16 v[44:47], a[128:131], a[88:91], v[44:47]
    ds_read_b64_tr_b16 a[142:143], v5 offset:51200
    v_mfma_f32_16x16x32_bf16 v[44:47], a[132:135], a[92:95], v[44:47]
    v_mfma_f32_16x16x32_bf16 v[48:51], a[128:131], a[96:99], v[48:51]
    v_mfma_f32_16x16x32_bf16 v[48:51], a[132:135], a[100:103], v[48:51]
    buffer_load_dwordx4 v18, s[8:11], s19 offen offset:2048 lds
    v_mfma_f32_16x16x32_bf16 v[52:55], a[128:131], a[104:107], v[52:55]
    v_mfma_f32_16x16x32_bf16 v[52:55], a[132:135], a[108:111], v[52:55]
    ds_read_b128 a[4:7], v3 offset:0
    v_mfma_f32_16x16x32_bf16 v[56:59], a[128:131], a[112:115], v[56:59]
    v_mfma_f32_16x16x32_bf16 v[56:59], a[132:135], a[116:119], v[56:59]
    buffer_load_dwordx4 v19, s[8:11], s19 offen offset:3072 lds
    v_mfma_f32_16x16x32_bf16 v[60:63], a[128:131], a[120:123], v[60:63]
    s_add_u32 s19, s19, 524288
    v_mfma_f32_16x16x32_bf16 v[60:63], a[132:135], a[124:127], v[60:63]
    s_waitcnt lgkmcnt(4)
    v_mfma_f32_16x16x32_bf16 v[64:67], a[136:139], a[64:67], v[64:67]
    s_waitcnt lgkmcnt(1)
    s_add_u32 m0, s20, 32768
    ds_read_b64_tr_b16 a[128:129], v6 offset:32768
    v_mfma_f32_16x16x32_bf16 v[64:67], a[140:143], a[68:71], v[64:67]
    buffer_load_dwordx4 v12, s[4:7], s16 offen offset:0 lds
    v_mfma_f32_16x16x32_bf16 v[68:71], a[136:139], a[72:75], v[68:71]
    ds_read_b64_tr_b16 a[130:131], v6 offset:34816
    v_mfma_f32_16x16x32_bf16 v[68:71], a[140:143], a[76:79], v[68:71]
    ds_read_b128 a[8:11], v2 offset:2048
    v_mfma_f32_16x16x32_bf16 v[72:75], a[136:139], a[80:83], v[72:75]
    ds_read_b64_tr_b16 a[132:133], v6 offset:49152
    v_mfma_f32_16x16x32_bf16 v[72:75], a[140:143], a[84:87], v[72:75]
    buffer_load_dwordx4 v13, s[4:7], s16 offen offset:1024 lds
    v_mfma_f32_16x16x32_bf16 v[76:79], a[136:139], a[88:91], v[76:79]
    ds_read_b64_tr_b16 a[134:135], v6 offset:51200
    v_mfma_f32_16x16x32_bf16 v[76:79], a[140:143], a[92:95], v[76:79]
    v_mfma_f32_16x16x32_bf16 v[80:83], a[136:139], a[96:99], v[80:83]
    v_mfma_f32_16x16x32_bf16 v[80:83], a[140:143], a[100:103], v[80:83]
    buffer_load_dwordx4 v14, s[4:7], s16 offen offset:2048 lds
    v_mfma_f32_16x16x32_bf16 v[84:87], a[136:139], a[104:107], v[84:87]
    v_mfma_f32_16x16x32_bf16 v[84:87], a[140:143], a[108:111], v[84:87]
    ds_read_b128 a[12:15], v3 offset:2048
    v_mfma_f32_16x16x32_bf16 v[88:91], a[136:139], a[112:115], v[88:91]
    v_mfma_f32_16x16x32_bf16 v[88:91], a[140:143], a[116:119], v[88:91]
    buffer_load_dwordx4 v15, s[4:7], s16 offen offset:3072 lds
    v_mfma_f32_16x16x32_bf16 v[92:95], a[136:139], a[120:123], v[92:95]
    s_add_u32 s16, s16, 128
    v_mfma_f32_16x16x32_bf16 v[92:95], a[140:143], a[124:127], v[92:95]
    s_waitcnt lgkmcnt(4)
    v_mfma_f32_16x16x32_bf16 v[96:99], a[128:131], a[64:67], v[96:99]
    s_waitcnt lgkmcnt(1)
    s_add_u32 m0, s20, 36864
    ds_read_b64_tr_b16 a[136:137], v7 offset:32768
    v_mfma_f32_16x16x32_bf16 v[96:99], a[132:135], a[68:71], v[96:99]
    buffer_load_dwordx4 v12, s[4:7], s17 offen offset:0 lds
    v_mfma_f32_16x16x32_bf16 v[100:103], a[128:131], a[72:75], v[100:103]
    ds_read_b64_tr_b16 a[138:139], v7 offset:34816
    v_mfma_f32_16x16x32_bf16 v[100:103], a[132:135], a[76:79], v[100:103]
    ds_read_b128 a[16:19], v2 offset:4096
    v_mfma_f32_16x16x32_bf16 v[104:107], a[128:131], a[80:83], v[104:107]
    ds_read_b64_tr_b16 a[140:141], v7 offset:49152
    v_mfma_f32_16x16x32_bf16 v[104:107], a[132:135], a[84:87], v[104:107]
    buffer_load_dwordx4 v13, s[4:7], s17 offen offset:1024 lds
    v_mfma_f32_16x16x32_bf16 v[108:111], a[128:131], a[88:91], v[108:111]
    ds_read_b64_tr_b16 a[142:143], v7 offset:51200
    v_mfma_f32_16x16x32_bf16 v[108:111], a[132:135], a[92:95], v[108:111]
    v_mfma_f32_16x16x32_bf16 v[112:115], a[128:131], a[96:99], v[112:115]
    v_mfma_f32_16x16x32_bf16 v[112:115], a[132:135], a[100:103], v[112:115]
    buffer_load_dwordx4 v14, s[4:7], s17 offen offset:2048 lds
    v_mfma_f32_16x16x32_bf16 v[116:119], a[128:131], a[104:107], v[116:119]
    v_mfma_f32_16x16x32_bf16 v[116:119], a[132:135], a[108:111], v[116:119]
    ds_read_b128 a[20:23], v3 offset:4096
    v_mfma_f32_16x16x32_bf16 v[120:123], a[128:131], a[112:115], v[120:123]
    v_mfma_f32_16x16x32_bf16 v[120:123], a[132:135], a[116:119], v[120:123]
    buffer_load_dwordx4 v15, s[4:7], s17 offen offset:3072 lds
    v_mfma_f32_16x16x32_bf16 v[124:127], a[128:131], a[120:123], v[124:127]
    s_add_u32 s17, s17, 128
    v_mfma_f32_16x16x32_bf16 v[124:127], a[132:135], a[124:127], v[124:127]
    s_waitcnt lgkmcnt(4)
    v_mfma_f32_16x16x32_bf16 v[128:131], a[136:139], a[64:67], v[128:131]
    s_waitcnt lgkmcnt(1)
    ds_read_b64_tr_b16 a[128:129], v8 offset:32768
    v_mfma_f32_16x16x32_bf16 v[128:131], a[140:143], a[68:71], v[128:131]
    ds_read_b128 a[24:27], v2 offset:6144
    v_mfma_f32_16x16x32_bf16 v[132:135], a[136:139], a[72:75], v[132:135]
    ds_read_b64_tr_b16 a[130:131], v8 offset:34816
    v_mfma_f32_16x16x32_bf16 v[132:135], a[140:143], a[76:79], v[132:135]
    v_mfma_f32_16x16x32_bf16 v[136:139], a[136:139], a[80:83], v[136:139]
    ds_read_b64_tr_b16 a[132:133], v8 offset:49152
    v_mfma_f32_16x16x32_bf16 v[136:139], a[140:143], a[84:87], v[136:139]
    v_mfma_f32_16x16x32_bf16 v[140:143], a[136:139], a[88:91], v[140:143]
    ds_read_b64_tr_b16 a[134:135], v8 offset:51200
    v_mfma_f32_16x16x32_bf16 v[140:143], a[140:143], a[92:95], v[140:143]
    v_mfma_f32_16x16x32_bf16 v[144:147], a[136:139], a[96:99], v[144:147]
    ds_read_b128 a[28:31], v3 offset:6144
    v_mfma_f32_16x16x32_bf16 v[144:147], a[140:143], a[100:103], v[144:147]
    v_mfma_f32_16x16x32_bf16 v[148:151], a[136:139], a[104:107], v[148:151]
    v_mfma_f32_16x16x32_bf16 v[148:151], a[140:143], a[108:111], v[148:151]
    v_mfma_f32_16x16x32_bf16 v[152:155], a[136:139], a[112:115], v[152:155]
    ds_read_b128 a[32:35], v2 offset:8192
    v_mfma_f32_16x16x32_bf16 v[152:155], a[140:143], a[116:119], v[152:155]
    v_mfma_f32_16x16x32_bf16 v[156:159], a[136:139], a[120:123], v[156:159]
    v_mfma_f32_16x16x32_bf16 v[156:159], a[140:143], a[124:127], v[156:159]
    s_waitcnt lgkmcnt(4)
    v_mfma_f32_16x16x32_bf16 v[160:163], a[128:131], a[64:67], v[160:163]
    s_waitcnt lgkmcnt(2)
    ds_read_b64_tr_b16 a[136:137], v9 offset:32768
    v_mfma_f32_16x16x32_bf16 v[160:163], a[132:135], a[68:71], v[160:163]
    ds_read_b128 a[36:39], v3 offset:8192
    v_mfma_f32_16x16x32_bf16 v[164:167], a[128:131], a[72:75], v[164:167]
    ds_read_b64_tr_b16 a[138:139], v9 offset:34816
    v_mfma_f32_16x16x32_bf16 v[164:167], a[132:135], a[76:79], v[164:167]
    v_mfma_f32_16x16x32_bf16 v[168:171], a[128:131], a[80:83], v[168:171]
    ds_read_b64_tr_b16 a[140:141], v9 offset:49152
    v_mfma_f32_16x16x32_bf16 v[168:171], a[132:135], a[84:87], v[168:171]
    v_mfma_f32_16x16x32_bf16 v[172:175], a[128:131], a[88:91], v[172:175]
    ds_read_b64_tr_b16 a[142:143], v9 offset:51200
    v_mfma_f32_16x16x32_bf16 v[172:175], a[132:135], a[92:95], v[172:175]
    v_mfma_f32_16x16x32_bf16 v[176:179], a[128:131], a[96:99], v[176:179]
    ds_read_b128 a[40:43], v2 offset:10240
    v_mfma_f32_16x16x32_bf16 v[176:179], a[132:135], a[100:103], v[176:179]
    v_mfma_f32_16x16x32_bf16 v[180:183], a[128:131], a[104:107], v[180:183]
    v_mfma_f32_16x16x32_bf16 v[180:183], a[132:135], a[108:111], v[180:183]
    v_mfma_f32_16x16x32_bf16 v[184:187], a[128:131], a[112:115], v[184:187]
    ds_read_b128 a[44:47], v3 offset:10240
    v_mfma_f32_16x16x32_bf16 v[184:187], a[132:135], a[116:119], v[184:187]
    v_mfma_f32_16x16x32_bf16 v[188:191], a[128:131], a[120:123], v[188:191]
    v_mfma_f32_16x16x32_bf16 v[188:191], a[132:135], a[124:127], v[188:191]
    s_waitcnt lgkmcnt(4)
    v_mfma_f32_16x16x32_bf16 v[192:195], a[136:139], a[64:67], v[192:195]
    s_waitcnt lgkmcnt(2)
    ds_read_b64_tr_b16 a[128:129], v10 offset:32768
    v_mfma_f32_16x16x32_bf16 v[192:195], a[140:143], a[68:71], v[192:195]
    ds_read_b128 a[48:51], v2 offset:12288
    v_mfma_f32_16x16x32_bf16 v[196:199], a[136:139], a[72:75], v[196:199]
    ds_read_b64_tr_b16 a[130:131], v10 offset:34816
    v_mfma_f32_16x16x32_bf16 v[196:199], a[140:143], a[76:79], v[196:199]
    v_mfma_f32_16x16x32_bf16 v[200:203], a[136:139], a[80:83], v[200:203]
    ds_read_b64_tr_b16 a[132:133], v10 offset:49152
    v_mfma_f32_16x16x32_bf16 v[200:203], a[140:143], a[84:87], v[200:203]
    v_mfma_f32_16x16x32_bf16 v[204:207], a[136:139], a[88:91], v[204:207]
    ds_read_b64_tr_b16 a[134:135], v10 offset:51200
    v_mfma_f32_16x16x32_bf16 v[204:207], a[140:143], a[92:95], v[204:207]
    v_mfma_f32_16x16x32_bf16 v[208:211], a[136:139], a[96:99], v[208:211]
    ds_read_b128 a[52:55], v3 offset:12288
    v_mfma_f32_16x16x32_bf16 v[208:211], a[140:143], a[100:103], v[208:211]
    v_mfma_f32_16x16x32_bf16 v[212:215], a[136:139], a[104:107], v[212:215]
    v_mfma_f32_16x16x32_bf16 v[212:215], a[140:143], a[108:111], v[212:215]
    v_mfma_f32_16x16x32_bf16 v[216:219], a[136:139], a[112:115], v[216:219]
    ds_read_b128 a[56:59], v2 offset:14336
    v_mfma_f32_16x16x32_bf16 v[216:219], a[140:143], a[116:119], v[216:219]
    v_mfma_f32_16x16x32_bf16 v[220:223], a[136:139], a[120:123], v[220:223]
    v_mfma_f32_16x16x32_bf16 v[220:223], a[140:143], a[124:127], v[220:223]
    s_waitcnt lgkmcnt(4)
    v_mfma_f32_16x16x32_bf16 v[224:227], a[128:131], a[64:67], v[224:227]
    s_waitcnt lgkmcnt(2)
    ds_read_b64_tr_b16 a[136:137], v11 offset:32768
    v_mfma_f32_16x16x32_bf16 v[224:227], a[132:135], a[68:71], v[224:227]
    ds_read_b128 a[60:63], v3 offset:14336
    v_mfma_f32_16x16x32_bf16 v[228:231], a[128:131], a[72:75], v[228:231]
    ds_read_b64_tr_b16 a[138:139], v11 offset:34816
    v_mfma_f32_16x16x32_bf16 v[228:231], a[132:135], a[76:79], v[228:231]
    v_mfma_f32_16x16x32_bf16 v[232:235], a[128:131], a[80:83], v[232:235]
    ds_read_b64_tr_b16 a[140:141], v11 offset:49152
    v_mfma_f32_16x16x32_bf16 v[232:235], a[132:135], a[84:87], v[232:235]
    v_mfma_f32_16x16x32_bf16 v[236:239], a[128:131], a[88:91], v[236:239]
    ds_read_b64_tr_b16 a[142:143], v11 offset:51200
    v_mfma_f32_16x16x32_bf16 v[236:239], a[132:135], a[92:95], v[236:239]
    v_mfma_f32_16x16x32_bf16 v[240:243], a[128:131], a[96:99], v[240:243]
    v_mfma_f32_16x16x32_bf16 v[240:243], a[132:135], a[100:103], v[240:243]
    v_mfma_f32_16x16x32_bf16 v[244:247], a[128:131], a[104:107], v[244:247]
    v_mfma_f32_16x16x32_bf16 v[244:247], a[132:135], a[108:111], v[244:247]
    v_mfma_f32_16x16x32_bf16 v[248:251], a[128:131], a[112:115], v[248:251]
    v_mfma_f32_16x16x32_bf16 v[248:251], a[132:135], a[116:119], v[248:251]
    v_mfma_f32_16x16x32_bf16 v[252:255], a[128:131], a[120:123], v[252:255]
    v_mfma_f32_16x16x32_bf16 v[252:255], a[132:135], a[124:127], v[252:255]
    s_waitcnt vmcnt(0) lgkmcnt(0)
    s_barrier
    v_mfma_f32_16x16x32_bf16 a[224:227], a[136:139], a[64:67], a[224:227]
    s_add_u32 m0, s21, 98304
    ds_read_b64_tr_b16 a[128:129], v4 offset:0
    v_mfma_f32_16x16x32_bf16 a[224:227], a[140:143], a[68:71], a[224:227]
    buffer_load_dwordx4 v16, s[8:11], s18 offen offset:0 lds
    v_mfma_f32_16x16x32_bf16 a[228:231], a[136:139], a[72:75], a[228:231]
    ds_read_b64_tr_b16 a[130:131], v4 offset:2048
    v_mfma_f32_16x16x32_bf16 a[228:231], a[140:143], a[76:79], a[228:231]
    v_mfma_f32_16x16x32_bf16 a[232:235], a[136:139], a[80:83], a[232:235]
    ds_read_b64_tr_b16 a[132:133], v4 offset:16384
    v_mfma_f32_16x16x32_bf16 a[232:235], a[140:143], a[84:87], a[232:235]
    buffer_load_dwordx4 v17, s[8:11], s18 offen offset:1024 lds
    v_mfma_f32_16x16x32_bf16 a[236:239], a[136:139], a[88:91], a[236:239]
    ds_read_b64_tr_b16 a[134:135], v4 offset:18432
    v_mfma_f32_16x16x32_bf16 a[236:239], a[140:143], a[92:95], a[236:239]
    v_mfma_f32_16x16x32_bf16 a[240:243], a[136:139], a[96:99], a[240:243]
    v_mfma_f32_16x16x32_bf16 a[240:243], a[140:143], a[100:103], a[240:243]
    buffer_load_dwordx4 v18, s[8:11], s18 offen offset:2048 lds
    v_mfma_f32_16x16x32_bf16 a[244:247], a[136:139], a[104:107], a[244:247]
    v_mfma_f32_16x16x32_bf16 a[244:247], a[140:143], a[108:111], a[244:247]
    v_mfma_f32_16x16x32_bf16 a[248:251], a[136:139], a[112:115], a[248:251]
    v_mfma_f32_16x16x32_bf16 a[248:251], a[140:143], a[116:119], a[248:251]
    buffer_load_dwordx4 v19, s[8:11], s18 offen offset:3072 lds
    v_mfma_f32_16x16x32_bf16 a[252:255], a[136:139], a[120:123], a[252:255]
    s_add_u32 s18, s18, 524288
    v_mfma_f32_16x16x32_bf16 a[252:255], a[140:143], a[124:127], a[252:255]
    s_waitcnt lgkmcnt(2)
    v_mfma_f32_16x16x32_bf16 v[32:35], a[128:131], a[0:3], v[32:35]
    s_waitcnt lgkmcnt(0)
    s_add_u32 m0, s21, 114688
    ds_read_b64_tr_b16 a[136:137], v5 offset:0
    v_mfma_f32_16x16x32_bf16 v[32:35], a[132:135], a[4:7], v[32:35]
    buffer_load_dwordx4 v16, s[8:11], s19 offen offset:0 lds
    v_mfma_f32_16x16x32_bf16 v[36:39], a[128:131], a[8:11], v[36:39]
    ds_read_b64_tr_b16 a[138:139], v5 offset:2048
    v_mfma_f32_16x16x32_bf16 v[36:39], a[132:135], a[12:15], v[36:39]
    ds_read_b128 a[64:67], v2 offset:32768
    v_mfma_f32_16x16x32_bf16 v[40:43], a[128:131], a[16:19], v[40:43]
    ds_read_b64_tr_b16 a[140:141], v5 offset:16384
    v_mfma_f32_16x16x32_bf16 v[40:43], a[132:135], a[20:23], v[40:43]
    buffer_load_dwordx4 v17, s[8:11], s19 offen offset:1024 lds
    v_mfma_f32_16x16x32_bf16 v[44:47], a[128:131], a[24:27], v[44:47]
    ds_read_b64_tr_b16 a[142:143], v5 offset:18432
    v_mfma_f32_16x16x32_bf16 v[44:47], a[132:135], a[28:31], v[44:47]
    v_mfma_f32_16x16x32_bf16 v[48:51], a[128:131], a[32:35], v[48:51]
    v_mfma_f32_16x16x32_bf16 v[48:51], a[132:135], a[36:39], v[48:51]
    buffer_load_dwordx4 v18, s[8:11], s19 offen offset:2048 lds
    v_mfma_f32_16x16x32_bf16 v[52:55], a[128:131], a[40:43], v[52:55]
    v_mfma_f32_16x16x32_bf16 v[52:55], a[132:135], a[44:47], v[52:55]
    ds_read_b128 a[68:71], v3 offset:32768
    v_mfma_f32_16x16x32_bf16 v[56:59], a[128:131], a[48:51], v[56:59]
    v_mfma_f32_16x16x32_bf16 v[56:59], a[132:135], a[52:55], v[56:59]
    buffer_load_dwordx4 v19, s[8:11], s19 offen offset:3072 lds
    v_mfma_f32_16x16x32_bf16 v[60:63], a[128:131], a[56:59], v[60:63]
    s_add_u32 s19, s19, 524288
    v_mfma_f32_16x16x32_bf16 v[60:63], a[132:135], a[60:63], v[60:63]
    s_waitcnt lgkmcnt(4)
    v_mfma_f32_16x16x32_bf16 v[64:67], a[136:139], a[0:3], v[64:67]
    s_waitcnt lgkmcnt(1)
    ds_read_b64_tr_b16 a[128:129], v6 offset:0
    v_mfma_f32_16x16x32_bf16 v[64:67], a[140:143], a[4:7], v[64:67]
    v_mfma_f32_16x16x32_bf16 v[68:71], a[136:139], a[8:11], v[68:71]
    ds_read_b64_tr_b16 a[130:131], v6 offset:2048
    v_mfma_f32_16x16x32_bf16 v[68:71], a[140:143], a[12:15], v[68:71]
    ds_read_b128 a[72:75], v2 offset:34816
    v_mfma_f32_16x16x32_bf16 v[72:75], a[136:139], a[16:19], v[72:75]
    ds_read_b64_tr_b16 a[132:133], v6 offset:16384
    v_mfma_f32_16x16x32_bf16 v[72:75], a[140:143], a[20:23], v[72:75]
    v_mfma_f32_16x16x32_bf16 v[76:79], a[136:139], a[24:27], v[76:79]
    ds_read_b64_tr_b16 a[134:135], v6 offset:18432
    v_mfma_f32_16x16x32_bf16 v[76:79], a[140:143], a[28:31], v[76:79]
    v_mfma_f32_16x16x32_bf16 v[80:83], a[136:139], a[32:35], v[80:83]
    v_mfma_f32_16x16x32_bf16 v[80:83], a[140:143], a[36:39], v[80:83]
    ds_read_b128 a[76:79], v3 offset:34816
    v_mfma_f32_16x16x32_bf16 v[84:87], a[136:139], a[40:43], v[84:87]
    v_mfma_f32_16x16x32_bf16 v[84:87], a[140:143], a[44:47], v[84:87]
    v_mfma_f32_16x16x32_bf16 v[88:91], a[136:139], a[48:51], v[88:91]
    v_mfma_f32_16x16x32_bf16 v[88:91], a[140:143], a[52:55], v[88:91]
    v_mfma_f32_16x16x32_bf16 v[92:95], a[136:139], a[56:59], v[92:95]
    ds_read_b128 a[80:83], v2 offset:36864
    v_mfma_f32_16x16x32_bf16 v[92:95], a[140:143], a[60:63], v[92:95]
    s_waitcnt lgkmcnt(5)
    v_mfma_f32_16x16x32_bf16 v[96:99], a[128:131], a[0:3], v[96:99]
    s_waitcnt lgkmcnt(2)
    ds_read_b64_tr_b16 a[136:137], v7 offset:0
    v_mfma_f32_16x16x32_bf16 v[96:99], a[132:135], a[4:7], v[96:99]
    v_mfma_f32_16x16x32_bf16 v[100:103], a[128:131], a[8:11], v[100:103]
    ds_read_b64_tr_b16 a[138:139], v7 offset:2048
    v_mfma_f32_16x16x32_bf16 v[100:103], a[132:135], a[12:15], v[100:103]
    v_mfma_f32_16x16x32_bf16 v[104:107], a[128:131], a[16:19], v[104:107]
    ds_read_b64_tr_b16 a[140:141], v7 offset:16384
    v_mfma_f32_16x16x32_bf16 v[104:107], a[132:135], a[20:23], v[104:107]
    ds_read_b128 a[84:87], v3 offset:36864
    v_mfma_f32_16x16x32_bf16 v[108:111], a[128:131], a[24:27], v[108:111]
    ds_read_b64_tr_b16 a[142:143], v7 offset:18432
    v_mfma_f32_16x16x32_bf16 v[108:111], a[132:135], a[28:31], v[108:111]
    v_mfma_f32_16x16x32_bf16 v[112:115], a[128:131], a[32:35], v[112:115]
    v_mfma_f32_16x16x32_bf16 v[112:115], a[132:135], a[36:39], v[112:115]
    v_mfma_f32_16x16x32_bf16 v[116:119], a[128:131], a[40:43], v[116:119]
    v_mfma_f32_16x16x32_bf16 v[116:119], a[132:135], a[44:47], v[116:119]
    ds_read_b128 a[88:91], v2 offset:38912
    v_mfma_f32_16x16x32_bf16 v[120:123], a[128:131], a[48:51], v[120:123]
    v_mfma_f32_16x16x32_bf16 v[120:123], a[132:135], a[52:55], v[120:123]
    v_mfma_f32_16x16x32_bf16 v[124:127], a[128:131], a[56:59], v[124:127]
    v_mfma_f32_16x16x32_bf16 v[124:127], a[132:135], a[60:63], v[124:127]
    s_waitcnt lgkmcnt(4)
    ds_read_b128 a[92:95], v3 offset:38912
    v_mfma_f32_16x16x32_bf16 v[128:131], a[136:139], a[0:3], v[128:131]
    s_waitcnt lgkmcnt(2)
    ds_read_b64_tr_b16 a[128:129], v8 offset:0
    v_mfma_f32_16x16x32_bf16 v[128:131], a[140:143], a[4:7], v[128:131]
    v_mfma_f32_16x16x32_bf16 v[132:135], a[136:139], a[8:11], v[132:135]
    ds_read_b64_tr_b16 a[130:131], v8 offset:2048
    v_mfma_f32_16x16x32_bf16 v[132:135], a[140:143], a[12:15], v[132:135]
    v_mfma_f32_16x16x32_bf16 v[136:139], a[136:139], a[16:19], v[136:139]
    ds_read_b64_tr_b16 a[132:133], v8 offset:16384
    v_mfma_f32_16x16x32_bf16 v[136:139], a[140:143], a[20:23], v[136:139]
    v_mfma_f32_16x16x32_bf16 v[140:143], a[136:139], a[24:27], v[140:143]
    ds_read_b64_tr_b16 a[134:135], v8 offset:18432
    v_mfma_f32_16x16x32_bf16 v[140:143], a[140:143], a[28:31], v[140:143]
    v_mfma_f32_16x16x32_bf16 v[144:147], a[136:139], a[32:35], v[144:147]
    ds_read_b128 a[96:99], v2 offset:40960
    v_mfma_f32_16x16x32_bf16 v[144:147], a[140:143], a[36:39], v[144:147]
    v_mfma_f32_16x16x32_bf16 v[148:151], a[136:139], a[40:43], v[148:151]
    v_mfma_f32_16x16x32_bf16 v[148:151], a[140:143], a[44:47], v[148:151]
    v_mfma_f32_16x16x32_bf16 v[152:155], a[136:139], a[48:51], v[152:155]
    v_mfma_f32_16x16x32_bf16 v[152:155], a[140:143], a[52:55], v[152:155]
    ds_read_b128 a[100:103], v3 offset:40960
    v_mfma_f32_16x16x32_bf16 v[156:159], a[136:139], a[56:59], v[156:159]
    v_mfma_f32_16x16x32_bf16 v[156:159], a[140:143], a[60:63], v[156:159]
    s_waitcnt lgkmcnt(4)
    v_mfma_f32_16x16x32_bf16 v[160:163], a[128:131], a[0:3], v[160:163]
    s_waitcnt lgkmcnt(2)
    ds_read_b64_tr_b16 a[136:137], v9 offset:0
    v_mfma_f32_16x16x32_bf16 v[160:163], a[132:135], a[4:7], v[160:163]
    v_mfma_f32_16x16x32_bf16 v[164:167], a[128:131], a[8:11], v[164:167]
    ds_read_b64_tr_b16 a[138:139], v9 offset:2048
    v_mfma_f32_16x16x32_bf16 v[164:167], a[132:135], a[12:15], v[164:167]
    ds_read_b128 a[104:107], v2 offset:43008
    v_mfma_f32_16x16x32_bf16 v[168:171], a[128:131], a[16:19], v[168:171]
    ds_read_b64_tr_b16 a[140:141], v9 offset:16384
    v_mfma_f32_16x16x32_bf16 v[168:171], a[132:135], a[20:23], v[168:171]
    v_mfma_f32_16x16x32_bf16 v[172:175], a[128:131], a[24:27], v[172:175]
    ds_read_b64_tr_b16 a[142:143], v9 offset:18432
    v_mfma_f32_16x16x32_bf16 v[172:175], a[132:135], a[28:31], v[172:175]
    v_mfma_f32_16x16x32_bf16 v[176:179], a[128:131], a[32:35], v[176:179]
    v_mfma_f32_16x16x32_bf16 v[176:179], a[132:135], a[36:39], v[176:179]
    v_mfma_f32_16x16x32_bf16 v[180:183], a[128:131], a[40:43], v[180:183]
    ds_read_b128 a[108:111], v3 offset:43008
    v_mfma_f32_16x16x32_bf16 v[180:183], a[132:135], a[44:47], v[180:183]
    v_mfma_f32_16x16x32_bf16 v[184:187], a[128:131], a[48:51], v[184:187]
    v_mfma_f32_16x16x32_bf16 v[184:187], a[132:135], a[52:55], v[184:187]
    v_mfma_f32_16x16x32_bf16 v[188:191], a[128:131], a[56:59], v[188:191]
    ds_read_b128 a[112:115], v2 offset:45056
    v_mfma_f32_16x16x32_bf16 v[188:191], a[132:135], a[60:63], v[188:191]
    s_waitcnt lgkmcnt(5)
    v_mfma_f32_16x16x32_bf16 v[192:195], a[136:139], a[0:3], v[192:195]
    s_waitcnt lgkmcnt(2)
    ds_read_b64_tr_b16 a[128:129], v10 offset:0
    v_mfma_f32_16x16x32_bf16 v[192:195], a[140:143], a[4:7], v[192:195]
    v_mfma_f32_16x16x32_bf16 v[196:199], a[136:139], a[8:11], v[196:199]
    ds_read_b64_tr_b16 a[130:131], v10 offset:2048
    v_mfma_f32_16x16x32_bf16 v[196:199], a[140:143], a[12:15], v[196:199]
    v_mfma_f32_16x16x32_bf16 v[200:203], a[136:139], a[16:19], v[200:203]
    ds_read_b64_tr_b16 a[132:133], v10 offset:16384
    v_mfma_f32_16x16x32_bf16 v[200:203], a[140:143], a[20:23], v[200:203]
    v_mfma_f32_16x16x32_bf16 v[204:207], a[136:139], a[24:27], v[204:207]
    ds_read_b64_tr_b16 a[134:135], v10 offset:18432
    v_mfma_f32_16x16x32_bf16 v[204:207], a[140:143], a[28:31], v[204:207]
    ds_read_b128 a[116:119], v3 offset:45056
    v_mfma_f32_16x16x32_bf16 v[208:211], a[136:139], a[32:35], v[208:211]
    v_mfma_f32_16x16x32_bf16 v[208:211], a[140:143], a[36:39], v[208:211]
    v_mfma_f32_16x16x32_bf16 v[212:215], a[136:139], a[40:43], v[212:215]
    v_mfma_f32_16x16x32_bf16 v[212:215], a[140:143], a[44:47], v[212:215]
    ds_read_b128 a[120:123], v2 offset:47104
    v_mfma_f32_16x16x32_bf16 v[216:219], a[136:139], a[48:51], v[216:219]
    v_mfma_f32_16x16x32_bf16 v[216:219], a[140:143], a[52:55], v[216:219]
    v_mfma_f32_16x16x32_bf16 v[220:223], a[136:139], a[56:59], v[220:223]
    v_mfma_f32_16x16x32_bf16 v[220:223], a[140:143], a[60:63], v[220:223]
    s_waitcnt lgkmcnt(4)
    v_mfma_f32_16x16x32_bf16 v[224:227], a[128:131], a[0:3], v[224:227]
    s_waitcnt lgkmcnt(2)
    ds_read_b64_tr_b16 a[136:137], v11 offset:0
    v_mfma_f32_16x16x32_bf16 v[224:227], a[132:135], a[4:7], v[224:227]
    ds_read_b128 a[124:127], v3 offset:47104
    v_mfma_f32_16x16x32_bf16 v[228:231], a[128:131], a[8:11], v[228:231]
    ds_read_b64_tr_b16 a[138:139], v11 offset:2048
    v_mfma_f32_16x16x32_bf16 v[228:231], a[132:135], a[12:15], v[228:231]
    v_mfma_f32_16x16x32_bf16 v[232:235], a[128:131], a[16:19], v[232:235]
    ds_read_b64_tr_b16 a[140:141], v11 offset:16384
    v_mfma_f32_16x16x32_bf16 v[232:235], a[132:135], a[20:23], v[232:235]
    v_mfma_f32_16x16x32_bf16 v[236:239], a[128:131], a[24:27], v[236:239]
    ds_read_b64_tr_b16 a[142:143], v11 offset:18432
    v_mfma_f32_16x16x32_bf16 v[236:239], a[132:135], a[28:31], v[236:239]
    v_mfma_f32_16x16x32_bf16 v[240:243], a[128:131], a[32:35], v[240:243]
    v_mfma_f32_16x16x32_bf16 v[240:243], a[132:135], a[36:39], v[240:243]
    v_mfma_f32_16x16x32_bf16 v[244:247], a[128:131], a[40:43], v[244:247]
    v_mfma_f32_16x16x32_bf16 v[244:247], a[132:135], a[44:47], v[244:247]
    v_mfma_f32_16x16x32_bf16 v[248:251], a[128:131], a[48:51], v[248:251]
    v_mfma_f32_16x16x32_bf16 v[248:251], a[132:135], a[52:55], v[248:251]
    v_mfma_f32_16x16x32_bf16 v[252:255], a[128:131], a[56:59], v[252:255]
    v_mfma_f32_16x16x32_bf16 v[252:255], a[132:135], a[60:63], v[252:255]
    s_waitcnt vmcnt(0) lgkmcnt(0)
    s_barrier
    v_mfma_f32_16x16x32_bf16 a[224:227], a[136:139], a[0:3], a[224:227]
    ds_read_b64_tr_b16 a[128:129], v4 offset:32768
    v_mfma_f32_16x16x32_bf16 a[224:227], a[140:143], a[4:7], a[224:227]
    v_mfma_f32_16x16x32_bf16 a[228:231], a[136:139], a[8:11], a[228:231]
    ds_read_b64_tr_b16 a[130:131], v4 offset:34816
    v_mfma_f32_16x16x32_bf16 a[228:231], a[140:143], a[12:15], a[228:231]
    v_mfma_f32_16x16x32_bf16 a[232:235], a[136:139], a[16:19], a[232:235]
    ds_read_b64_tr_b16 a[132:133], v4 offset:49152
    v_mfma_f32_16x16x32_bf16 a[232:235], a[140:143], a[20:23], a[232:235]
    v_mfma_f32_16x16x32_bf16 a[236:239], a[136:139], a[24:27], a[236:239]
    ds_read_b64_tr_b16 a[134:135], v4 offset:51200
    v_mfma_f32_16x16x32_bf16 a[236:239], a[140:143], a[28:31], a[236:239]
    v_mfma_f32_16x16x32_bf16 a[240:243], a[136:139], a[32:35], a[240:243]
    v_mfma_f32_16x16x32_bf16 a[240:243], a[140:143], a[36:39], a[240:243]
    v_mfma_f32_16x16x32_bf16 a[244:247], a[136:139], a[40:43], a[244:247]
    v_mfma_f32_16x16x32_bf16 a[244:247], a[140:143], a[44:47], a[244:247]
    v_mfma_f32_16x16x32_bf16 a[248:251], a[136:139], a[48:51], a[248:251]
    v_mfma_f32_16x16x32_bf16 a[248:251], a[140:143], a[52:55], a[248:251]
    v_mfma_f32_16x16x32_bf16 a[252:255], a[136:139], a[56:59], a[252:255]
    v_mfma_f32_16x16x32_bf16 a[252:255], a[140:143], a[60:63], a[252:255]
    s_waitcnt lgkmcnt(2)
    v_mfma_f32_16x16x32_bf16 v[32:35], a[128:131], a[64:67], v[32:35]
    s_waitcnt lgkmcnt(0)
    ds_read_b64_tr_b16 a[136:137], v5 offset:32768
    v_mfma_f32_16x16x32_bf16 v[32:35], a[132:135], a[68:71], v[32:35]
    v_mfma_f32_16x16x32_bf16 v[36:39], a[128:131], a[72:75], v[36:39]
    ds_read_b64_tr_b16 a[138:139], v5 offset:34816
    v_mfma_f32_16x16x32_bf16 v[36:39], a[132:135], a[76:79], v[36:39]
    v_mfma_f32_16x16x32_bf16 v[40:43], a[128:131], a[80:83], v[40:43]
    ds_read_b64_tr_b16 a[140:141], v5 offset:49152
    v_mfma_f32_16x16x32_bf16 v[40:43], a[132:135], a[84:87], v[40:43]
    v_mfma_f32_16x16x32_bf16 v[44:47], a[128:131], a[88:91], v[44:47]
    ds_read_b64_tr_b16 a[142:143], v5 offset:51200
    v_mfma_f32_16x16x32_bf16 v[44:47], a[132:135], a[92:95], v[44:47]
    v_mfma_f32_16x16x32_bf16 v[48:51], a[128:131], a[96:99], v[48:51]
    v_mfma_f32_16x16x32_bf16 v[48:51], a[132:135], a[100:103], v[48:51]
    v_mfma_f32_16x16x32_bf16 v[52:55], a[128:131], a[104:107], v[52:55]
    v_mfma_f32_16x16x32_bf16 v[52:55], a[132:135], a[108:111], v[52:55]
    v_mfma_f32_16x16x32_bf16 v[56:59], a[128:131], a[112:115], v[56:59]
    v_mfma_f32_16x16x32_bf16 v[56:59], a[132:135], a[116:119], v[56:59]
    v_mfma_f32_16x16x32_bf16 v[60:63], a[128:131], a[120:123], v[60:63]
    v_mfma_f32_16x16x32_bf16 v[60:63], a[132:135], a[124:127], v[60:63]
    s_waitcnt lgkmcnt(2)
    v_mfma_f32_16x16x32_bf16 v[64:67], a[136:139], a[64:67], v[64:67]
    s_waitcnt lgkmcnt(0)
    ds_read_b64_tr_b16 a[128:129], v6 offset:32768
    v_mfma_f32_16x16x32_bf16 v[64:67], a[140:143], a[68:71], v[64:67]
    v_mfma_f32_16x16x32_bf16 v[68:71], a[136:139], a[72:75], v[68:71]
    ds_read_b64_tr_b16 a[130:131], v6 offset:34816
    v_mfma_f32_16x16x32_bf16 v[68:71], a[140:143], a[76:79], v[68:71]
    v_mfma_f32_16x16x32_bf16 v[72:75], a[136:139], a[80:83], v[72:75]
    ds_read_b64_tr_b16 a[132:133], v6 offset:49152
    v_mfma_f32_16x16x32_bf16 v[72:75], a[140:143], a[84:87], v[72:75]
    v_mfma_f32_16x16x32_bf16 v[76:79], a[136:139], a[88:91], v[76:79]
    ds_read_b64_tr_b16 a[134:135], v6 offset:51200
    v_mfma_f32_16x16x32_bf16 v[76:79], a[140:143], a[92:95], v[76:79]
    v_mfma_f32_16x16x32_bf16 v[80:83], a[136:139], a[96:99], v[80:83]
    v_mfma_f32_16x16x32_bf16 v[80:83], a[140:143], a[100:103], v[80:83]
    v_mfma_f32_16x16x32_bf16 v[84:87], a[136:139], a[104:107], v[84:87]
    v_mfma_f32_16x16x32_bf16 v[84:87], a[140:143], a[108:111], v[84:87]
    v_mfma_f32_16x16x32_bf16 v[88:91], a[136:139], a[112:115], v[88:91]
    v_mfma_f32_16x16x32_bf16 v[88:91], a[140:143], a[116:119], v[88:91]
    v_mfma_f32_16x16x32_bf16 v[92:95], a[136:139], a[120:123], v[92:95]
    v_mfma_f32_16x16x32_bf16 v[92:95], a[140:143], a[124:127], v[92:95]
    s_waitcnt lgkmcnt(2)
    v_mfma_f32_16x16x32_bf16 v[96:99], a[128:131], a[64:67], v[96:99]
    s_waitcnt lgkmcnt(0)
    ds_read_b64_tr_b16 a[136:137], v7 offset:32768
    v_mfma_f32_16x16x32_bf16 v[96:99], a[132:135], a[68:71], v[96:99]
    v_mfma_f32_16x16x32_bf16 v[100:103], a[128:131], a[72:75], v[100:103]
    ds_read_b64_tr_b16 a[138:139], v7 offset:34816
    v_mfma_f32_16x16x32_bf16 v[100:103], a[132:135], a[76:79], v[100:103]
    v_mfma_f32_16x16x32_bf16 v[104:107], a[128:131], a[80:83], v[104:107]
    ds_read_b64_tr_b16 a[140:141], v7 offset:49152
    v_mfma_f32_16x16x32_bf16 v[104:107], a[132:135], a[84:87], v[104:107]
    v_mfma_f32_16x16x32_bf16 v[108:111], a[128:131], a[88:91], v[108:111]
    ds_read_b64_tr_b16 a[142:143], v7 offset:51200
    v_mfma_f32_16x16x32_bf16 v[108:111], a[132:135], a[92:95], v[108:111]
    v_mfma_f32_16x16x32_bf16 v[112:115], a[128:131], a[96:99], v[112:115]
    v_mfma_f32_16x16x32_bf16 v[112:115], a[132:135], a[100:103], v[112:115]
    v_mfma_f32_16x16x32_bf16 v[116:119], a[128:131], a[104:107], v[116:119]
    v_mfma_f32_16x16x32_bf16 v[116:119], a[132:135], a[108:111], v[116:119]
    v_mfma_f32_16x16x32_bf16 v[120:123], a[128:131], a[112:115], v[120:123]
    v_mfma_f32_16x16x32_bf16 v[120:123], a[132:135], a[116:119], v[120:123]
    v_mfma_f32_16x16x32_bf16 v[124:127], a[128:131], a[120:123], v[124:127]
    v_mfma_f32_16x16x32_bf16 v[124:127], a[132:135], a[124:127], v[124:127]
    s_waitcnt lgkmcnt(2)
    v_mfma_f32_16x16x32_bf16 v[128:131], a[136:139], a[64:67], v[128:131]
    s_waitcnt lgkmcnt(0)
    ds_read_b64_tr_b16 a[128:129], v8 offset:32768
    v_mfma_f32_16x16x32_bf16 v[128:131], a[140:143], a[68:71], v[128:131]
    v_mfma_f32_16x16x32_bf16 v[132:135], a[136:139], a[72:75], v[132:135]
    ds_read_b64_tr_b16 a[130:131], v8 offset:34816
    v_mfma_f32_16x16x32_bf16 v[132:135], a[140:143], a[76:79], v[132:135]
    v_mfma_f32_16x16x32_bf16 v[136:139], a[136:139], a[80:83], v[136:139]
    ds_read_b64_tr_b16 a[132:133], v8 offset:49152
    v_mfma_f32_16x16x32_bf16 v[136:139], a[140:143], a[84:87], v[136:139]
    v_mfma_f32_16x16x32_bf16 v[140:143], a[136:139], a[88:91], v[140:143]
    ds_read_b64_tr_b16 a[134:135], v8 offset:51200
    v_mfma_f32_16x16x32_bf16 v[140:143], a[140:143], a[92:95], v[140:143]
    v_mfma_f32_16x16x32_bf16 v[144:147], a[136:139], a[96:99], v[144:147]
    v_mfma_f32_16x16x32_bf16 v[144:147], a[140:143], a[100:103], v[144:147]
    v_mfma_f32_16x16x32_bf16 v[148:151], a[136:139], a[104:107], v[148:151]
    v_mfma_f32_16x16x32_bf16 v[148:151], a[140:143], a[108:111], v[148:151]
    v_mfma_f32_16x16x32_bf16 v[152:155], a[136:139], a[112:115], v[152:155]
    v_mfma_f32_16x16x32_bf16 v[152:155], a[140:143], a[116:119], v[152:155]
    v_mfma_f32_16x16x32_bf16 v[156:159], a[136:139], a[120:123], v[156:159]
    v_mfma_f32_16x16x32_bf16 v[156:159], a[140:143], a[124:127], v[156:159]
    s_waitcnt lgkmcnt(2)
    v_mfma_f32_16x16x32_bf16 v[160:163], a[128:131], a[64:67], v[160:163]
    s_waitcnt lgkmcnt(0)
    ds_read_b64_tr_b16 a[136:137], v9 offset:32768
    v_mfma_f32_16x16x32_bf16 v[160:163], a[132:135], a[68:71], v[160:163]
    v_mfma_f32_16x16x32_bf16 v[164:167], a[128:131], a[72:75], v[164:167]
    ds_read_b64_tr_b16 a[138:139], v9 offset:34816
    v_mfma_f32_16x16x32_bf16 v[164:167], a[132:135], a[76:79], v[164:167]
    v_mfma_f32_16x16x32_bf16 v[168:171], a[128:131], a[80:83], v[168:171]
    ds_read_b64_tr_b16 a[140:141], v9 offset:49152
    v_mfma_f32_16x16x32_bf16 v[168:171], a[132:135], a[84:87], v[168:171]
    v_mfma_f32_16x16x32_bf16 v[172:175], a[128:131], a[88:91], v[172:175]
    ds_read_b64_tr_b16 a[142:143], v9 offset:51200
    v_mfma_f32_16x16x32_bf16 v[172:175], a[132:135], a[92:95], v[172:175]
    v_mfma_f32_16x16x32_bf16 v[176:179], a[128:131], a[96:99], v[176:179]
    v_mfma_f32_16x16x32_bf16 v[176:179], a[132:135], a[100:103], v[176:179]
    v_mfma_f32_16x16x32_bf16 v[180:183], a[128:131], a[104:107], v[180:183]
    v_mfma_f32_16x16x32_bf16 v[180:183], a[132:135], a[108:111], v[180:183]
    v_mfma_f32_16x16x32_bf16 v[184:187], a[128:131], a[112:115], v[184:187]
    v_mfma_f32_16x16x32_bf16 v[184:187], a[132:135], a[116:119], v[184:187]
    v_mfma_f32_16x16x32_bf16 v[188:191], a[128:131], a[120:123], v[188:191]
    v_mfma_f32_16x16x32_bf16 v[188:191], a[132:135], a[124:127], v[188:191]
    s_waitcnt lgkmcnt(2)
    v_mfma_f32_16x16x32_bf16 v[192:195], a[136:139], a[64:67], v[192:195]
    s_waitcnt lgkmcnt(0)
    ds_read_b64_tr_b16 a[128:129], v10 offset:32768
    v_mfma_f32_16x16x32_bf16 v[192:195], a[140:143], a[68:71], v[192:195]
    v_mfma_f32_16x16x32_bf16 v[196:199], a[136:139], a[72:75], v[196:199]
    ds_read_b64_tr_b16 a[130:131], v10 offset:34816
    v_mfma_f32_16x16x32_bf16 v[196:199], a[140:143], a[76:79], v[196:199]
    v_mfma_f32_16x16x32_bf16 v[200:203], a[136:139], a[80:83], v[200:203]
    ds_read_b64_tr_b16 a[132:133], v10 offset:49152
    v_mfma_f32_16x16x32_bf16 v[200:203], a[140:143], a[84:87], v[200:203]
    v_mfma_f32_16x16x32_bf16 v[204:207], a[136:139], a[88:91], v[204:207]
    ds_read_b64_tr_b16 a[134:135], v10 offset:51200
    v_mfma_f32_16x16x32_bf16 v[204:207], a[140:143], a[92:95], v[204:207]
    v_mfma_f32_16x16x32_bf16 v[208:211], a[136:139], a[96:99], v[208:211]
    v_mfma_f32_16x16x32_bf16 v[208:211], a[140:143], a[100:103], v[208:211]
    v_mfma_f32_16x16x32_bf16 v[212:215], a[136:139], a[104:107], v[212:215]
    v_mfma_f32_16x16x32_bf16 v[212:215], a[140:143], a[108:111], v[212:215]
    v_mfma_f32_16x16x32_bf16 v[216:219], a[136:139], a[112:115], v[216:219]
    v_mfma_f32_16x16x32_bf16 v[216:219], a[140:143], a[116:119], v[216:219]
    v_mfma_f32_16x16x32_bf16 v[220:223], a[136:139], a[120:123], v[220:223]
    v_mfma_f32_16x16x32_bf16 v[220:223], a[140:143], a[124:127], v[220:223]
    s_waitcnt lgkmcnt(2)
    v_mfma_f32_16x16x32_bf16 v[224:227], a[128:131], a[64:67], v[224:227]
    s_waitcnt lgkmcnt(0)
    ds_read_b64_tr_b16 a[136:137], v11 offset:32768
    v_mfma_f32_16x16x32_bf16 v[224:227], a[132:135], a[68:71], v[224:227]
    v_mfma_f32_16x16x32_bf16 v[228:231], a[128:131], a[72:75], v[228:231]
    ds_read_b64_tr_b16 a[138:139], v11 offset:34816
    v_mfma_f32_16x16x32_bf16 v[228:231], a[132:135], a[76:79], v[228:231]
    v_mfma_f32_16x16x32_bf16 v[232:235], a[128:131], a[80:83], v[232:235]
    ds_read_b64_tr_b16 a[140:141], v11 offset:49152
    v_mfma_f32_16x16x32_bf16 v[232:235], a[132:135], a[84:87], v[232:235]
    v_mfma_f32_16x16x32_bf16 v[236:239], a[128:131], a[88:91], v[236:239]
    ds_read_b64_tr_b16 a[142:143], v11 offset:51200
    v_mfma_f32_16x16x32_bf16 v[236:239], a[132:135], a[92:95], v[236:239]
    v_mfma_f32_16x16x32_bf16 v[240:243], a[128:131], a[96:99], v[240:243]
    v_mfma_f32_16x16x32_bf16 v[240:243], a[132:135], a[100:103], v[240:243]
    v_mfma_f32_16x16x32_bf16 v[244:247], a[128:131], a[104:107], v[244:247]
    v_mfma_f32_16x16x32_bf16 v[244:247], a[132:135], a[108:111], v[244:247]
    v_mfma_f32_16x16x32_bf16 v[248:251], a[128:131], a[112:115], v[248:251]
    v_mfma_f32_16x16x32_bf16 v[248:251], a[132:135], a[116:119], v[248:251]
    v_mfma_f32_16x16x32_bf16 v[252:255], a[128:131], a[120:123], v[252:255]
    v_mfma_f32_16x16x32_bf16 v[252:255], a[132:135], a[124:127], v[252:255]
    s_waitcnt lgkmcnt(2)
    v_mfma_f32_16x16x32_bf16 a[224:227], a[136:139], a[64:67], a[224:227]
    s_waitcnt lgkmcnt(0)
    v_mfma_f32_16x16x32_bf16 a[224:227], a[140:143], a[68:71], a[224:227]
    v_mfma_f32_16x16x32_bf16 a[228:231], a[136:139], a[72:75], a[228:231]
    v_mfma_f32_16x16x32_bf16 a[228:231], a[140:143], a[76:79], a[228:231]
    v_mfma_f32_16x16x32_bf16 a[232:235], a[136:139], a[80:83], a[232:235]
    v_mfma_f32_16x16x32_bf16 a[232:235], a[140:143], a[84:87], a[232:235]
    v_mfma_f32_16x16x32_bf16 a[236:239], a[136:139], a[88:91], a[236:239]
    v_mfma_f32_16x16x32_bf16 a[236:239], a[140:143], a[92:95], a[236:239]
    v_mfma_f32_16x16x32_bf16 a[240:243], a[136:139], a[96:99], a[240:243]
    v_mfma_f32_16x16x32_bf16 a[240:243], a[140:143], a[100:103], a[240:243]
    v_mfma_f32_16x16x32_bf16 a[244:247], a[136:139], a[104:107], a[244:247]
    v_mfma_f32_16x16x32_bf16 a[244:247], a[140:143], a[108:111], a[244:247]
    v_mfma_f32_16x16x32_bf16 a[248:251], a[136:139], a[112:115], a[248:251]
    v_mfma_f32_16x16x32_bf16 a[248:251], a[140:143], a[116:119], a[248:251]
    v_mfma_f32_16x16x32_bf16 a[252:255], a[136:139], a[120:123], a[252:255]
    v_mfma_f32_16x16x32_bf16 a[252:255], a[140:143], a[124:127], a[252:255]
    s_lshl_b32 s26, s24, 20
    s_lshl_b32 s27, s25, 17
    s_add_u32 s26, s26, s27
    s_lshr_b32 s27, s23, 1
    s_lshl_b32 s27, s27, 16
    s_add_u32 s26, s26, s27
    s_and_b32 s27, s23, 1
    s_lshl_b32 s27, s27, 12
    s_add_u32 s26, s26, s27
    v_cvt_pk_bf16_f32 v32, v32, v33
    v_cvt_pk_bf16_f32 v33, v34, v35
    v_cvt_pk_bf16_f32 v34, v64, v65
    v_cvt_pk_bf16_f32 v35, v66, v67
    s_add_u32 s27, s26, 0
    buffer_store_dwordx4 v[32:35], v20, s[12:15], s27 offen offset:0
    v_cvt_pk_bf16_f32 v96, v96, v97
    v_cvt_pk_bf16_f32 v97, v98, v99
    v_cvt_pk_bf16_f32 v98, v128, v129
    v_cvt_pk_bf16_f32 v99, v130, v131
    buffer_store_dwordx4 v[96:99], v20, s[12:15], s27 offen offset:1024
    v_cvt_pk_bf16_f32 v160, v160, v161
    v_cvt_pk_bf16_f32 v161, v162, v163
    v_cvt_pk_bf16_f32 v162, v192, v193
    v_cvt_pk_bf16_f32 v163, v194, v195
    buffer_store_dwordx4 v[160:163], v20, s[12:15], s27 offen offset:2048
    v_accvgpr_read_b32 v28, a224
    v_accvgpr_read_b32 v29, a225
    v_accvgpr_read_b32 v30, a226
    v_accvgpr_read_b32 v31, a227
    v_cvt_pk_bf16_f32 v224, v224, v225
    v_cvt_pk_bf16_f32 v225, v226, v227
    v_cvt_pk_bf16_f32 v226, v28, v29
    v_cvt_pk_bf16_f32 v227, v30, v31
    buffer_store_dwordx4 v[224:227], v20, s[12:15], s27 offen offset:3072
    v_cvt_pk_bf16_f32 v36, v36, v37
    v_cvt_pk_bf16_f32 v37, v38, v39
    v_cvt_pk_bf16_f32 v38, v68, v69
    v_cvt_pk_bf16_f32 v39, v70, v71
    s_add_u32 s27, s26, 8192
    buffer_store_dwordx4 v[36:39], v20, s[12:15], s27 offen offset:0
    v_cvt_pk_bf16_f32 v100, v100, v101
    v_cvt_pk_bf16_f32 v101, v102, v103
    v_cvt_pk_bf16_f32 v102, v132, v133
    v_cvt_pk_bf16_f32 v103, v134, v135
    buffer_store_dwordx4 v[100:103], v20, s[12:15], s27 offen offset:1024
    v_cvt_pk_bf16_f32 v164, v164, v165
    v_cvt_pk_bf16_f32 v165, v166, v167
    v_cvt_pk_bf16_f32 v166, v196, v197
    v_cvt_pk_bf16_f32 v167, v198, v199
    buffer_store_dwordx4 v[164:167], v20, s[12:15], s27 offen offset:2048
    v_accvgpr_read_b32 v28, a228
    v_accvgpr_read_b32 v29, a229
    v_accvgpr_read_b32 v30, a230
    v_accvgpr_read_b32 v31, a231
    v_cvt_pk_bf16_f32 v228, v228, v229
    v_cvt_pk_bf16_f32 v229, v230, v231
    v_cvt_pk_bf16_f32 v230, v28, v29
    v_cvt_pk_bf16_f32 v231, v30, v31
    buffer_store_dwordx4 v[228:231], v20, s[12:15], s27 offen offset:3072
    v_cvt_pk_bf16_f32 v40, v40, v41
    v_cvt_pk_bf16_f32 v41, v42, v43
    v_cvt_pk_bf16_f32 v42, v72, v73
    v_cvt_pk_bf16_f32 v43, v74, v75
    s_add_u32 s27, s26, 16384
    buffer_store_dwordx4 v[40:43], v20, s[12:15], s27 offen offset:0
    v_cvt_pk_bf16_f32 v104, v104, v105
    v_cvt_pk_bf16_f32 v105, v106, v107
    v_cvt_pk_bf16_f32 v106, v136, v137
    v_cvt_pk_bf16_f32 v107, v138, v139
    buffer_store_dwordx4 v[104:107], v20, s[12:15], s27 offen offset:1024
    v_cvt_pk_bf16_f32 v168, v168, v169
    v_cvt_pk_bf16_f32 v169, v170, v171
    v_cvt_pk_bf16_f32 v170, v200, v201
    v_cvt_pk_bf16_f32 v171, v202, v203
    buffer_store_dwordx4 v[168:171], v20, s[12:15], s27 offen offset:2048
    v_accvgpr_read_b32 v28, a232
    v_accvgpr_read_b32 v29, a233
    v_accvgpr_read_b32 v30, a234
    v_accvgpr_read_b32 v31, a235
    v_cvt_pk_bf16_f32 v232, v232, v233
    v_cvt_pk_bf16_f32 v233, v234, v235
    v_cvt_pk_bf16_f32 v234, v28, v29
    v_cvt_pk_bf16_f32 v235, v30, v31
    buffer_store_dwordx4 v[232:235], v20, s[12:15], s27 offen offset:3072
    v_cvt_pk_bf16_f32 v44, v44, v45
    v_cvt_pk_bf16_f32 v45, v46, v47
    v_cvt_pk_bf16_f32 v46, v76, v77
    v_cvt_pk_bf16_f32 v47, v78, v79
    s_add_u32 s27, s26, 24576
    buffer_store_dwordx4 v[44:47], v20, s[12:15], s27 offen offset:0
    v_cvt_pk_bf16_f32 v108, v108, v109
    v_cvt_pk_bf16_f32 v109, v110, v111
    v_cvt_pk_bf16_f32 v110, v140, v141
    v_cvt_pk_bf16_f32 v111, v142, v143
    buffer_store_dwordx4 v[108:111], v20, s[12:15], s27 offen offset:1024
    v_cvt_pk_bf16_f32 v172, v172, v173
    v_cvt_pk_bf16_f32 v173, v174, v175
    v_cvt_pk_bf16_f32 v174, v204, v205
    v_cvt_pk_bf16_f32 v175, v206, v207
    buffer_store_dwordx4 v[172:175], v20, s[12:15], s27 offen offset:2048
    v_accvgpr_read_b32 v28, a236
    v_accvgpr_read_b32 v29, a237
    v_accvgpr_read_b32 v30, a238
    v_accvgpr_read_b32 v31, a239
    v_cvt_pk_bf16_f32 v236, v236, v237
    v_cvt_pk_bf16_f32 v237, v238, v239
    v_cvt_pk_bf16_f32 v238, v28, v29
    v_cvt_pk_bf16_f32 v239, v30, v31
    buffer_store_dwordx4 v[236:239], v20, s[12:15], s27 offen offset:3072
    v_cvt_pk_bf16_f32 v48, v48, v49
    v_cvt_pk_bf16_f32 v49, v50, v51
    v_cvt_pk_bf16_f32 v50, v80, v81
    v_cvt_pk_bf16_f32 v51, v82, v83
    s_add_u32 s27, s26, 32768
    buffer_store_dwordx4 v[48:51], v20, s[12:15], s27 offen offset:0
    v_cvt_pk_bf16_f32 v112, v112, v113
    v_cvt_pk_bf16_f32 v113, v114, v115
    v_cvt_pk_bf16_f32 v114, v144, v145
    v_cvt_pk_bf16_f32 v115, v146, v147
    buffer_store_dwordx4 v[112:115], v20, s[12:15], s27 offen offset:1024
    v_cvt_pk_bf16_f32 v176, v176, v177
    v_cvt_pk_bf16_f32 v177, v178, v179
    v_cvt_pk_bf16_f32 v178, v208, v209
    v_cvt_pk_bf16_f32 v179, v210, v211
    buffer_store_dwordx4 v[176:179], v20, s[12:15], s27 offen offset:2048
    v_accvgpr_read_b32 v28, a240
    v_accvgpr_read_b32 v29, a241
    v_accvgpr_read_b32 v30, a242
    v_accvgpr_read_b32 v31, a243
    v_cvt_pk_bf16_f32 v240, v240, v241
    v_cvt_pk_bf16_f32 v241, v242, v243
    v_cvt_pk_bf16_f32 v242, v28, v29
    v_cvt_pk_bf16_f32 v243, v30, v31
    buffer_store_dwordx4 v[240:243], v20, s[12:15], s27 offen offset:3072
    v_cvt_pk_bf16_f32 v52, v52, v53
    v_cvt_pk_bf16_f32 v53, v54, v55
    v_cvt_pk_bf16_f32 v54, v84, v85
    v_cvt_pk_bf16_f32 v55, v86, v87
    s_add_u32 s27, s26, 40960
    buffer_store_dwordx4 v[52:55], v20, s[12:15], s27 offen offset:0
    v_cvt_pk_bf16_f32 v116, v116, v117
    v_cvt_pk_bf16_f32 v117, v118, v119
    v_cvt_pk_bf16_f32 v118, v148, v149
    v_cvt_pk_bf16_f32 v119, v150, v151
    buffer_store_dwordx4 v[116:119], v20, s[12:15], s27 offen offset:1024
    v_cvt_pk_bf16_f32 v180, v180, v181
    v_cvt_pk_bf16_f32 v181, v182, v183
    v_cvt_pk_bf16_f32 v182, v212, v213
    v_cvt_pk_bf16_f32 v183, v214, v215
    buffer_store_dwordx4 v[180:183], v20, s[12:15], s27 offen offset:2048
    v_accvgpr_read_b32 v28, a244
    v_accvgpr_read_b32 v29, a245
    v_accvgpr_read_b32 v30, a246
    v_accvgpr_read_b32 v31, a247
    v_cvt_pk_bf16_f32 v244, v244, v245
    v_cvt_pk_bf16_f32 v245, v246, v247
    v_cvt_pk_bf16_f32 v246, v28, v29
    v_cvt_pk_bf16_f32 v247, v30, v31
    buffer_store_dwordx4 v[244:247], v20, s[12:15], s27 offen offset:3072
    v_cvt_pk_bf16_f32 v56, v56, v57
    v_cvt_pk_bf16_f32 v57, v58, v59
    v_cvt_pk_bf16_f32 v58, v88, v89
    v_cvt_pk_bf16_f32 v59, v90, v91
    s_add_u32 s27, s26, 49152
    buffer_store_dwordx4 v[56:59], v20, s[12:15], s27 offen offset:0
    v_cvt_pk_bf16_f32 v120, v120, v121
    v_cvt_pk_bf16_f32 v121, v122, v123
    v_cvt_pk_bf16_f32 v122, v152, v153
    v_cvt_pk_bf16_f32 v123, v154, v155
    buffer_store_dwordx4 v[120:123], v20, s[12:15], s27 offen offset:1024
    v_cvt_pk_bf16_f32 v184, v184, v185
    v_cvt_pk_bf16_f32 v185, v186, v187
    v_cvt_pk_bf16_f32 v186, v216, v217
    v_cvt_pk_bf16_f32 v187, v218, v219
    buffer_store_dwordx4 v[184:187], v20, s[12:15], s27 offen offset:2048
    v_accvgpr_read_b32 v28, a248
    v_accvgpr_read_b32 v29, a249
    v_accvgpr_read_b32 v30, a250
    v_accvgpr_read_b32 v31, a251
    v_cvt_pk_bf16_f32 v248, v248, v249
    v_cvt_pk_bf16_f32 v249, v250, v251
    v_cvt_pk_bf16_f32 v250, v28, v29
    v_cvt_pk_bf16_f32 v251, v30, v31
    buffer_store_dwordx4 v[248:251], v20, s[12:15], s27 offen offset:3072
    v_cvt_pk_bf16_f32 v60, v60, v61
    v_cvt_pk_bf16_f32 v61, v62, v63
    v_cvt_pk_bf16_f32 v62, v92, v93
    v_cvt_pk_bf16_f32 v63, v94, v95
    s_add_u32 s27, s26, 57344
    buffer_store_dwordx4 v[60:63], v20, s[12:15], s27 offen offset:0
    v_cvt_pk_bf16_f32 v124, v124, v125
    v_cvt_pk_bf16_f32 v125, v126, v127
    v_cvt_pk_bf16_f32 v126, v156, v157
    v_cvt_pk_bf16_f32 v127, v158, v159
    buffer_store_dwordx4 v[124:127], v20, s[12:15], s27 offen offset:1024
    v_cvt_pk_bf16_f32 v188, v188, v189
    v_cvt_pk_bf16_f32 v189, v190, v191
    v_cvt_pk_bf16_f32 v190, v220, v221
    v_cvt_pk_bf16_f32 v191, v222, v223
    buffer_store_dwordx4 v[188:191], v20, s[12:15], s27 offen offset:2048
    v_accvgpr_read_b32 v28, a252
    v_accvgpr_read_b32 v29, a253
    v_accvgpr_read_b32 v30, a254
    v_accvgpr_read_b32 v31, a255
    v_cvt_pk_bf16_f32 v252, v252, v253
    v_cvt_pk_bf16_f32 v253, v254, v255
    v_cvt_pk_bf16_f32 v254, v28, v29
    v_cvt_pk_bf16_f32 v255, v30, v31
    buffer_store_dwordx4 v[252:255], v20, s[12:15], s27 offen offset:3072
    s_branch K1_Q
K1_V:
    s_mov_b32 s8, s40
    s_mov_b32 s9, s41
    s_mov_b32 s10, 8388608
    s_mov_b32 s11, 0x20000
    s_add_u32 m0, s20, 0
    s_nop 0
    buffer_load_dwordx4 v12, s[4:7], s16 offen offset:0 lds
    buffer_load_dwordx4 v13, s[4:7], s16 offen offset:1024 lds
    buffer_load_dwordx4 v14, s[4:7], s16 offen offset:2048 lds
    buffer_load_dwordx4 v15, s[4:7], s16 offen offset:3072 lds
    s_add_u32 s16, s16, 128
    s_add_u32 m0, s20, 4096
    s_nop 0
    buffer_load_dwordx4 v12, s[4:7], s17 offen offset:0 lds
    buffer_load_dwordx4 v13, s[4:7], s17 offen offset:1024 lds
    buffer_load_dwordx4 v14, s[4:7], s17 offen offset:2048 lds
    buffer_load_dwordx4 v15, s[4:7], s17 offen offset:3072 lds
    s_add_u32 s17, s17, 128
    s_add_u32 m0, s21, 65536
    s_nop 0
    buffer_load_dwordx4 v16, s[8:11], s18 offen offset:0 lds
    buffer_load_dwordx4 v17, s[8:11], s18 offen offset:1024 lds
    buffer_load_dwordx4 v18, s[8:11], s18 offen offset:2048 lds
    buffer_load_dwordx4 v19, s[8:11], s18 offen offset:3072 lds
    s_add_u32 s18, s18, 524288
    s_add_u32 m0, s21, 81920
    s_nop 0
    buffer_load_dwordx4 v16, s[8:11], s19 offen offset:0 lds
    buffer_load_dwordx4 v17, s[8:11], s19 offen offset:1024 lds
    buffer_load_dwordx4 v18, s[8:11], s19 offen offset:2048 lds
    buffer_load_dwordx4 v19, s[8:11], s19 offen offset:3072 lds
    s_add_u32 s19, s19, 524288
    s_add_u32 m0, s20, 32768
    s_nop 0
    buffer_load_dwordx4 v12, s[4:7], s16 offen offset:0 lds
    buffer_load_dwordx4 v13, s[4:7], s16 offen offset:1024 lds
    buffer_load_dwordx4 v14, s[4:7], s16 offen offset:2048 lds
    buffer_load_dwordx4 v15, s[4:7], s16 offen offset:3072 lds
    s_add_u32 s16, s16, 128
    s_add_u32 m0, s20, 36864
    s_nop 0
    buffer_load_dwordx4 v12, s[4:7], s17 offen offset:0 lds
    buffer_load_dwordx4 v13, s[4:7], s17 offen offset:1024 lds
    buffer_load_dwordx4 v14, s[4:7], s17 offen offset:2048 lds
    buffer_load_dwordx4 v15, s[4:7], s17 offen offset:3072 lds
    s_add_u32 s17, s17, 128
    s_add_u32 m0, s21, 98304
    s_nop 0
    buffer_load_dwordx4 v16, s[8:11], s18 offen offset:0 lds
    buffer_load_dwordx4 v17, s[8:11], s18 offen offset:1024 lds
    buffer_load_dwordx4 v18, s[8:11], s18 offen offset:2048 lds
    buffer_load_dwordx4 v19, s[8:11], s18 offen offset:3072 lds
    s_add_u32 s18, s18, 524288
    s_waitcnt vmcnt(12)
    s_barrier
    ds_read_b128 a[0:3], v2 offset:0
    ds_read_b128 a[4:7], v3 offset:0
    ds_read_b128 a[8:11], v2 offset:2048
    ds_read_b128 a[12:15], v3 offset:2048
    ds_read_b128 a[16:19], v2 offset:4096
    ds_read_b128 a[20:23], v3 offset:4096
    ds_read_b128 a[24:27], v2 offset:6144
    ds_read_b128 a[28:31], v3 offset:6144
    ds_read_b128 a[32:35], v2 offset:8192
    ds_read_b128 a[36:39], v3 offset:8192
    ds_read_b128 a[40:43], v2 offset:10240
    ds_read_b128 a[44:47], v3 offset:10240
    ds_read_b128 a[48:51], v2 offset:12288
    ds_read_b128 a[52:55], v3 offset:12288
    ds_read_b128 a[56:59], v2 offset:14336
    ds_read_b128 a[60:63], v3 offset:14336
    ds_read_b64_tr_b16 a[128:129], v4 offset:0
    ds_read_b64_tr_b16 a[130:131], v4 offset:2048
    ds_read_b64_tr_b16 a[132:133], v4 offset:16384
    ds_read_b64_tr_b16 a[134:135], v4 offset:18432
    s_waitcnt vmcnt(4) lgkmcnt(0)
    s_barrier
    s_mov_b32 s22, 6
    v_mfma_f32_16x16x32_bf16 v[32:35], a[0:3], a[128:131], 0
    s_add_u32 m0, s21, 114688
    ds_read_b64_tr_b16 a[136:137], v5 offset:0
    v_mfma_f32_16x16x32_bf16 v[32:35], a[4:7], a[132:135], v[32:35]
    buffer_load_dwordx4 v16, s[8:11], s19 offen offset:0 lds
    v_mfma_f32_16x16x32_bf16 v[36:39], a[8:11], a[128:131], 0
    ds_read_b64_tr_b16 a[138:139], v5 offset:2048
    v_mfma_f32_16x16x32_bf16 v[36:39], a[12:15], a[132:135], v[36:39]
    ds_read_b128 a[64:67], v2 offset:32768
    v_mfma_f32_16x16x32_bf16 v[40:43], a[16:19], a[128:131], 0
    ds_read_b64_tr_b16 a[140:141], v5 offset:16384
    v_mfma_f32_16x16x32_bf16 v[40:43], a[20:23], a[132:135], v[40:43]
    buffer_load_dwordx4 v17, s[8:11], s19 offen offset:1024 lds
    v_mfma_f32_16x16x32_bf16 v[44:47], a[24:27], a[128:131], 0
    ds_read_b64_tr_b16 a[142:143], v5 offset:18432
    v_mfma_f32_16x16x32_bf16 v[44:47], a[28:31], a[132:135], v[44:47]
    v_mfma_f32_16x16x32_bf16 v[48:51], a[32:35], a[128:131], 0
    v_mfma_f32_16x16x32_bf16 v[48:51], a[36:39], a[132:135], v[48:51]
    buffer_load_dwordx4 v18, s[8:11], s19 offen offset:2048 lds
    v_mfma_f32_16x16x32_bf16 v[52:55], a[40:43], a[128:131], 0
    v_mfma_f32_16x16x32_bf16 v[52:55], a[44:47], a[132:135], v[52:55]
    ds_read_b128 a[68:71], v3 offset:32768
    v_mfma_f32_16x16x32_bf16 v[56:59], a[48:51], a[128:131], 0
    v_mfma_f32_16x16x32_bf16 v[56:59], a[52:55], a[132:135], v[56:59]
    buffer_load_dwordx4 v19, s[8:11], s19 offen offset:3072 lds
    v_mfma_f32_16x16x32_bf16 v[60:63], a[56:59], a[128:131], 0
    s_add_u32 s19, s19, 524288
    v_mfma_f32_16x16x32_bf16 v[60:63], a[60:63], a[132:135], v[60:63]
    s_waitcnt lgkmcnt(4)
    v_mfma_f32_16x16x32_bf16 v[64:67], a[0:3], a[136:139], 0
    s_waitcnt lgkmcnt(1)
    s_add_u32 m0, s20, 0
    ds_read_b64_tr_b16 a[128:129], v6 offset:0
    v_mfma_f32_16x16x32_bf16 v[64:67], a[4:7], a[140:143], v[64:67]
    buffer_load_dwordx4 v12, s[4:7], s16 offen offset:0 lds
    v_mfma_f32_16x16x32_bf16 v[68:71], a[8:11], a[136:139], 0
    ds_read_b64_tr_b16 a[130:131], v6 offset:2048
    v_mfma_f32_16x16x32_bf16 v[68:71], a[12:15], a[140:143], v[68:71]
    ds_read_b128 a[72:75], v2 offset:34816
    v_mfma_f32_16x16x32_bf16 v[72:75], a[16:19], a[136:139], 0
    ds_read_b64_tr_b16 a[132:133], v6 offset:16384
    v_mfma_f32_16x16x32_bf16 v[72:75], a[20:23], a[140:143], v[72:75]
    buffer_load_dwordx4 v13, s[4:7], s16 offen offset:1024 lds
    v_mfma_f32_16x16x32_bf16 v[76:79], a[24:27], a[136:139], 0
    ds_read_b64_tr_b16 a[134:135], v6 offset:18432
    v_mfma_f32_16x16x32_bf16 v[76:79], a[28:31], a[140:143], v[76:79]
    v_mfma_f32_16x16x32_bf16 v[80:83], a[32:35], a[136:139], 0
    v_mfma_f32_16x16x32_bf16 v[80:83], a[36:39], a[140:143], v[80:83]
    buffer_load_dwordx4 v14, s[4:7], s16 offen offset:2048 lds
    v_mfma_f32_16x16x32_bf16 v[84:87], a[40:43], a[136:139], 0
    v_mfma_f32_16x16x32_bf16 v[84:87], a[44:47], a[140:143], v[84:87]
    ds_read_b128 a[76:79], v3 offset:34816
    v_mfma_f32_16x16x32_bf16 v[88:91], a[48:51], a[136:139], 0
    v_mfma_f32_16x16x32_bf16 v[88:91], a[52:55], a[140:143], v[88:91]
    buffer_load_dwordx4 v15, s[4:7], s16 offen offset:3072 lds
    v_mfma_f32_16x16x32_bf16 v[92:95], a[56:59], a[136:139], 0
    s_add_u32 s16, s16, 128
    v_mfma_f32_16x16x32_bf16 v[92:95], a[60:63], a[140:143], v[92:95]
    s_waitcnt lgkmcnt(4)
    v_mfma_f32_16x16x32_bf16 v[96:99], a[0:3], a[128:131], 0
    s_waitcnt lgkmcnt(1)
    s_add_u32 m0, s20, 4096
    ds_read_b64_tr_b16 a[136:137], v7 offset:0
    v_mfma_f32_16x16x32_bf16 v[96:99], a[4:7], a[132:135], v[96:99]
    buffer_load_dwordx4 v12, s[4:7], s17 offen offset:0 lds
    v_mfma_f32_16x16x32_bf16 v[100:103], a[8:11], a[128:131], 0
    ds_read_b64_tr_b16 a[138:139], v7 offset:2048
    v_mfma_f32_16x16x32_bf16 v[100:103], a[12:15], a[132:135], v[100:103]
    ds_read_b128 a[80:83], v2 offset:36864
    v_mfma_f32_16x16x32_bf16 v[104:107], a[16:19], a[128:131], 0
    ds_read_b64_tr_b16 a[140:141], v7 offset:16384
    v_mfma_f32_16x16x32_bf16 v[104:107], a[20:23], a[132:135], v[104:107]
    buffer_load_dwordx4 v13, s[4:7], s17 offen offset:1024 lds
    v_mfma_f32_16x16x32_bf16 v[108:111], a[24:27], a[128:131], 0
    ds_read_b64_tr_b16 a[142:143], v7 offset:18432
    v_mfma_f32_16x16x32_bf16 v[108:111], a[28:31], a[132:135], v[108:111]
    v_mfma_f32_16x16x32_bf16 v[112:115], a[32:35], a[128:131], 0
    v_mfma_f32_16x16x32_bf16 v[112:115], a[36:39], a[132:135], v[112:115]
    buffer_load_dwordx4 v14, s[4:7], s17 offen offset:2048 lds
    v_mfma_f32_16x16x32_bf16 v[116:119], a[40:43], a[128:131], 0
    v_mfma_f32_16x16x32_bf16 v[116:119], a[44:47], a[132:135], v[116:119]
    ds_read_b128 a[84:87], v3 offset:36864
    v_mfma_f32_16x16x32_bf16 v[120:123], a[48:51], a[128:131], 0
    v_mfma_f32_16x16x32_bf16 v[120:123], a[52:55], a[132:135], v[120:123]
    buffer_load_dwordx4 v15, s[4:7], s17 offen offset:3072 lds
    v_mfma_f32_16x16x32_bf16 v[124:127], a[56:59], a[128:131], 0
    s_add_u32 s17, s17, 128
    v_mfma_f32_16x16x32_bf16 v[124:127], a[60:63], a[132:135], v[124:127]
    s_waitcnt lgkmcnt(4)
    v_mfma_f32_16x16x32_bf16 v[128:131], a[0:3], a[136:139], 0
    s_waitcnt lgkmcnt(1)
    ds_read_b64_tr_b16 a[128:129], v8 offset:0
    v_mfma_f32_16x16x32_bf16 v[128:131], a[4:7], a[140:143], v[128:131]
    ds_read_b128 a[88:91], v2 offset:38912
    v_mfma_f32_16x16x32_bf16 v[132:135], a[8:11], a[136:139], 0
    ds_read_b64_tr_b16 a[130:131], v8 offset:2048
    v_mfma_f32_16x16x32_bf16 v[132:135], a[12:15], a[140:143], v[132:135]
    v_mfma_f32_16x16x32_bf16 v[136:139], a[16:19], a[136:139], 0
    ds_read_b64_tr_b16 a[132:133], v8 offset:16384
    v_mfma_f32_16x16x32_bf16 v[136:139], a[20:23], a[140:143], v[136:139]
    v_mfma_f32_16x16x32_bf16 v[140:143], a[24:27], a[136:139], 0
    ds_read_b64_tr_b16 a[134:135], v8 offset:18432
    v_mfma_f32_16x16x32_bf16 v[140:143], a[28:31], a[140:143], v[140:143]
    v_mfma_f32_16x16x32_bf16 v[144:147], a[32:35], a[136:139], 0
    ds_read_b128 a[92:95], v3 offset:38912
    v_mfma_f32_16x16x32_bf16 v[144:147], a[36:39], a[140:143], v[144:147]
    v_mfma_f32_16x16x32_bf16 v[148:151], a[40:43], a[136:139], 0
    v_mfma_f32_16x16x32_bf16 v[148:151], a[44:47], a[140:143], v[148:151]
    v_mfma_f32_16x16x32_bf16 v[152:155], a[48:51], a[136:139], 0
    ds_read_b128 a[96:99], v2 offset:40960
    v_mfma_f32_16x16x32_bf16 v[152:155], a[52:55], a[140:143], v[152:155]
    v_mfma_f32_16x16x32_bf16 v[156:159], a[56:59], a[136:139], 0
    v_mfma_f32_16x16x32_bf16 v[156:159], a[60:63], a[140:143], v[156:159]
    s_waitcnt lgkmcnt(4)
    v_mfma_f32_16x16x32_bf16 v[160:163], a[0:3], a[128:131], 0
    s_waitcnt lgkmcnt(2)
    ds_read_b64_tr_b16 a[136:137], v9 offset:0
    v_mfma_f32_16x16x32_bf16 v[160:163], a[4:7], a[132:135], v[160:163]
    ds_read_b128 a[100:103], v3 offset:40960
    v_mfma_f32_16x16x32_bf16 v[164:167], a[8:11], a[128:131], 0
    ds_read_b64_tr_b16 a[138:139], v9 offset:2048
    v_mfma_f32_16x16x32_bf16 v[164:167], a[12:15], a[132:135], v[164:167]
    v_mfma_f32_16x16x32_bf16 v[168:171], a[16:19], a[128:131], 0
    ds_read_b64_tr_b16 a[140:141], v9 offset:16384
    v_mfma_f32_16x16x32_bf16 v[168:171], a[20:23], a[132:135], v[168:171]
    v_mfma_f32_16x16x32_bf16 v[172:175], a[24:27], a[128:131], 0
    ds_read_b64_tr_b16 a[142:143], v9 offset:18432
    v_mfma_f32_16x16x32_bf16 v[172:175], a[28:31], a[132:135], v[172:175]
    v_mfma_f32_16x16x32_bf16 v[176:179], a[32:35], a[128:131], 0
    ds_read_b128 a[104:107], v2 offset:43008
    v_mfma_f32_16x16x32_bf16 v[176:179], a[36:39], a[132:135], v[176:179]
    v_mfma_f32_16x16x32_bf16 v[180:183], a[40:43], a[128:131], 0
    v_mfma_f32_16x16x32_bf16 v[180:183], a[44:47], a[132:135], v[180:183]
    v_mfma_f32_16x16x32_bf16 v[184:187], a[48:51], a[128:131], 0
    ds_read_b128 a[108:111], v3 offset:43008
    v_mfma_f32_16x16x32_bf16 v[184:187], a[52:55], a[132:135], v[184:187]
    v_mfma_f32_16x16x32_bf16 v[188:191], a[56:59], a[128:131], 0
    v_mfma_f32_16x16x32_bf16 v[188:191], a[60:63], a[132:135], v[188:191]
    s_waitcnt lgkmcnt(4)
    v_mfma_f32_16x16x32_bf16 v[192:195], a[0:3], a[136:139], 0
    s_waitcnt lgkmcnt(2)
    ds_read_b64_tr_b16 a[128:129], v10 offset:0
    v_mfma_f32_16x16x32_bf16 v[192:195], a[4:7], a[140:143], v[192:195]
    ds_read_b128 a[112:115], v2 offset:45056
    v_mfma_f32_16x16x32_bf16 v[196:199], a[8:11], a[136:139], 0
    ds_read_b64_tr_b16 a[130:131], v10 offset:2048
    v_mfma_f32_16x16x32_bf16 v[196:199], a[12:15], a[140:143], v[196:199]
    v_mfma_f32_16x16x32_bf16 v[200:203], a[16:19], a[136:139], 0
    ds_read_b64_tr_b16 a[132:133], v10 offset:16384
    v_mfma_f32_16x16x32_bf16 v[200:203], a[20:23], a[140:143], v[200:203]
    v_mfma_f32_16x16x32_bf16 v[204:207], a[24:27], a[136:139], 0
    ds_read_b64_tr_b16 a[134:135], v10 offset:18432
    v_mfma_f32_16x16x32_bf16 v[204:207], a[28:31], a[140:143], v[204:207]
    v_mfma_f32_16x16x32_bf16 v[208:211], a[32:35], a[136:139], 0
    ds_read_b128 a[116:119], v3 offset:45056
    v_mfma_f32_16x16x32_bf16 v[208:211], a[36:39], a[140:143], v[208:211]
    v_mfma_f32_16x16x32_bf16 v[212:215], a[40:43], a[136:139], 0
    v_mfma_f32_16x16x32_bf16 v[212:215], a[44:47], a[140:143], v[212:215]
    v_mfma_f32_16x16x32_bf16 v[216:219], a[48:51], a[136:139], 0
    ds_read_b128 a[120:123], v2 offset:47104
    v_mfma_f32_16x16x32_bf16 v[216:219], a[52:55], a[140:143], v[216:219]
    v_mfma_f32_16x16x32_bf16 v[220:223], a[56:59], a[136:139], 0
    v_mfma_f32_16x16x32_bf16 v[220:223], a[60:63], a[140:143], v[220:223]
    s_waitcnt lgkmcnt(4)
    v_mfma_f32_16x16x32_bf16 v[224:227], a[0:3], a[128:131], 0
    s_waitcnt lgkmcnt(2)
    ds_read_b64_tr_b16 a[136:137], v11 offset:0
    v_mfma_f32_16x16x32_bf16 v[224:227], a[4:7], a[132:135], v[224:227]
    ds_read_b128 a[124:127], v3 offset:47104
    v_mfma_f32_16x16x32_bf16 v[228:231], a[8:11], a[128:131], 0
    ds_read_b64_tr_b16 a[138:139], v11 offset:2048
    v_mfma_f32_16x16x32_bf16 v[228:231], a[12:15], a[132:135], v[228:231]
    v_mfma_f32_16x16x32_bf16 v[232:235], a[16:19], a[128:131], 0
    ds_read_b64_tr_b16 a[140:141], v11 offset:16384
    v_mfma_f32_16x16x32_bf16 v[232:235], a[20:23], a[132:135], v[232:235]
    v_mfma_f32_16x16x32_bf16 v[236:239], a[24:27], a[128:131], 0
    ds_read_b64_tr_b16 a[142:143], v11 offset:18432
    v_mfma_f32_16x16x32_bf16 v[236:239], a[28:31], a[132:135], v[236:239]
    v_mfma_f32_16x16x32_bf16 v[240:243], a[32:35], a[128:131], 0
    v_mfma_f32_16x16x32_bf16 v[240:243], a[36:39], a[132:135], v[240:243]
    v_mfma_f32_16x16x32_bf16 v[244:247], a[40:43], a[128:131], 0
    v_mfma_f32_16x16x32_bf16 v[244:247], a[44:47], a[132:135], v[244:247]
    v_mfma_f32_16x16x32_bf16 v[248:251], a[48:51], a[128:131], 0
    v_mfma_f32_16x16x32_bf16 v[248:251], a[52:55], a[132:135], v[248:251]
    v_mfma_f32_16x16x32_bf16 v[252:255], a[56:59], a[128:131], 0
    v_mfma_f32_16x16x32_bf16 v[252:255], a[60:63], a[132:135], v[252:255]
    s_waitcnt vmcnt(0) lgkmcnt(0)
    s_barrier
    v_mfma_f32_16x16x32_bf16 a[224:227], a[0:3], a[136:139], 0
    s_add_u32 m0, s21, 65536
    ds_read_b64_tr_b16 a[128:129], v4 offset:32768
    v_mfma_f32_16x16x32_bf16 a[224:227], a[4:7], a[140:143], a[224:227]
    buffer_load_dwordx4 v16, s[8:11], s18 offen offset:0 lds
    v_mfma_f32_16x16x32_bf16 a[228:231], a[8:11], a[136:139], 0
    ds_read_b64_tr_b16 a[130:131], v4 offset:34816
    v_mfma_f32_16x16x32_bf16 a[228:231], a[12:15], a[140:143], a[228:231]
    v_mfma_f32_16x16x32_bf16 a[232:235], a[16:19], a[136:139], 0
    ds_read_b64_tr_b16 a[132:133], v4 offset:49152
    v_mfma_f32_16x16x32_bf16 a[232:235], a[20:23], a[140:143], a[232:235]
    buffer_load_dwordx4 v17, s[8:11], s18 offen offset:1024 lds
    v_mfma_f32_16x16x32_bf16 a[236:239], a[24:27], a[136:139], 0
    ds_read_b64_tr_b16 a[134:135], v4 offset:51200
    v_mfma_f32_16x16x32_bf16 a[236:239], a[28:31], a[140:143], a[236:239]
    v_mfma_f32_16x16x32_bf16 a[240:243], a[32:35], a[136:139], 0
    v_mfma_f32_16x16x32_bf16 a[240:243], a[36:39], a[140:143], a[240:243]
    buffer_load_dwordx4 v18, s[8:11], s18 offen offset:2048 lds
    v_mfma_f32_16x16x32_bf16 a[244:247], a[40:43], a[136:139], 0
    v_mfma_f32_16x16x32_bf16 a[244:247], a[44:47], a[140:143], a[244:247]
    v_mfma_f32_16x16x32_bf16 a[248:251], a[48:51], a[136:139], 0
    v_mfma_f32_16x16x32_bf16 a[248:251], a[52:55], a[140:143], a[248:251]
    buffer_load_dwordx4 v19, s[8:11], s18 offen offset:3072 lds
    v_mfma_f32_16x16x32_bf16 a[252:255], a[56:59], a[136:139], 0
    s_add_u32 s18, s18, 524288
    v_mfma_f32_16x16x32_bf16 a[252:255], a[60:63], a[140:143], a[252:255]
    s_waitcnt lgkmcnt(2)
ALg_2:
    v_mfma_f32_16x16x32_bf16 v[32:35], a[64:67], a[128:131], v[32:35]
    s_waitcnt lgkmcnt(0)
    s_add_u32 m0, s21, 81920
    ds_read_b64_tr_b16 a[136:137], v5 offset:32768
    v_mfma_f32_16x16x32_bf16 v[32:35], a[68:71], a[132:135], v[32:35]
    buffer_load_dwordx4 v16, s[8:11], s19 offen offset:0 lds
    v_mfma_f32_16x16x32_bf16 v[36:39], a[72:75], a[128:131], v[36:39]
    ds_read_b64_tr_b16 a[138:139], v5 offset:34816
    v_mfma_f32_16x16x32_bf16 v[36:39], a[76:79], a[132:135], v[36:39]
    ds_read_b128 a[0:3], v2 offset:0
    v_mfma_f32_16x16x32_bf16 v[40:43], a[80:83], a[128:131], v[40:43]
    ds_read_b64_tr_b16 a[140:141], v5 offset:49152
    v_mfma_f32_16x16x32_bf16 v[40:43], a[84:87], a[132:135], v[40:43]
    buffer_load_dwordx4 v17, s[8:11], s19 offen offset:1024 lds
    v_mfma_f32_16x16x32_bf16 v[44:47], a[88:91], a[128:131], v[44:47]
    ds_read_b64_tr_b16 a[142:143], v5 offset:51200
    v_mfma_f32_16x16x32_bf16 v[44:47], a[92:95], a[132:135], v[44:47]
    v_mfma_f32_16x16x32_bf16 v[48:51], a[96:99], a[128:131], v[48:51]
    v_mfma_f32_16x16x32_bf16 v[48:51], a[100:103], a[132:135], v[48:51]
    buffer_load_dwordx4 v18, s[8:11], s19 offen offset:2048 lds
    v_mfma_f32_16x16x32_bf16 v[52:55], a[104:107], a[128:131], v[52:55]
    v_mfma_f32_16x16x32_bf16 v[52:55], a[108:111], a[132:135], v[52:55]
    ds_read_b128 a[4:7], v3 offset:0
    v_mfma_f32_16x16x32_bf16 v[56:59], a[112:115], a[128:131], v[56:59]
    v_mfma_f32_16x16x32_bf16 v[56:59], a[116:119], a[132:135], v[56:59]
    buffer_load_dwordx4 v19, s[8:11], s19 offen offset:3072 lds
    v_mfma_f32_16x16x32_bf16 v[60:63], a[120:123], a[128:131], v[60:63]
    s_add_u32 s19, s19, 524288
    v_mfma_f32_16x16x32_bf16 v[60:63], a[124:127], a[132:135], v[60:63]
    s_waitcnt lgkmcnt(4)
    v_mfma_f32_16x16x32_bf16 v[64:67], a[64:67], a[136:139], v[64:67]
    s_waitcnt lgkmcnt(1)
    s_add_u32 m0, s20, 32768
    ds_read_b64_tr_b16 a[128:129], v6 offset:32768
    v_mfma_f32_16x16x32_bf16 v[64:67], a[68:71], a[140:143], v[64:67]
    buffer_load_dwordx4 v12, s[4:7], s16 offen offset:0 lds
    v_mfma_f32_16x16x32_bf16 v[68:71], a[72:75], a[136:139], v[68:71]
    ds_read_b64_tr_b16 a[130:131], v6 offset:34816
    v_mfma_f32_16x16x32_bf16 v[68:71], a[76:79], a[140:143], v[68:71]
    ds_read_b128 a[8:11], v2 offset:2048
    v_mfma_f32_16x16x32_bf16 v[72:75], a[80:83], a[136:139], v[72:75]
    ds_read_b64_tr_b16 a[132:133], v6 offset:49152
    v_mfma_f32_16x16x32_bf16 v[72:75], a[84:87], a[140:143], v[72:75]
    buffer_load_dwordx4 v13, s[4:7], s16 offen offset:1024 lds
    v_mfma_f32_16x16x32_bf16 v[76:79], a[88:91], a[136:139], v[76:79]
    ds_read_b64_tr_b16 a[134:135], v6 offset:51200
    v_mfma_f32_16x16x32_bf16 v[76:79], a[92:95], a[140:143], v[76:79]
    v_mfma_f32_16x16x32_bf16 v[80:83], a[96:99], a[136:139], v[80:83]
    v_mfma_f32_16x16x32_bf16 v[80:83], a[100:103], a[140:143], v[80:83]
    buffer_load_dwordx4 v14, s[4:7], s16 offen offset:2048 lds
    v_mfma_f32_16x16x32_bf16 v[84:87], a[104:107], a[136:139], v[84:87]
    v_mfma_f32_16x16x32_bf16 v[84:87], a[108:111], a[140:143], v[84:87]
    ds_read_b128 a[12:15], v3 offset:2048
    v_mfma_f32_16x16x32_bf16 v[88:91], a[112:115], a[136:139], v[88:91]
    v_mfma_f32_16x16x32_bf16 v[88:91], a[116:119], a[140:143], v[88:91]
    buffer_load_dwordx4 v15, s[4:7], s16 offen offset:3072 lds
    v_mfma_f32_16x16x32_bf16 v[92:95], a[120:123], a[136:139], v[92:95]
    s_add_u32 s16, s16, 128
    v_mfma_f32_16x16x32_bf16 v[92:95], a[124:127], a[140:143], v[92:95]
    s_waitcnt lgkmcnt(4)
    v_mfma_f32_16x16x32_bf16 v[96:99], a[64:67], a[128:131], v[96:99]
    s_waitcnt lgkmcnt(1)
    s_add_u32 m0, s20, 36864
    ds_read_b64_tr_b16 a[136:137], v7 offset:32768
    v_mfma_f32_16x16x32_bf16 v[96:99], a[68:71], a[132:135], v[96:99]
    buffer_load_dwordx4 v12, s[4:7], s17 offen offset:0 lds
    v_mfma_f32_16x16x32_bf16 v[100:103], a[72:75], a[128:131], v[100:103]
    ds_read_b64_tr_b16 a[138:139], v7 offset:34816
    v_mfma_f32_16x16x32_bf16 v[100:103], a[76:79], a[132:135], v[100:103]
    ds_read_b128 a[16:19], v2 offset:4096
    v_mfma_f32_16x16x32_bf16 v[104:107], a[80:83], a[128:131], v[104:107]
    ds_read_b64_tr_b16 a[140:141], v7 offset:49152
    v_mfma_f32_16x16x32_bf16 v[104:107], a[84:87], a[132:135], v[104:107]
    buffer_load_dwordx4 v13, s[4:7], s17 offen offset:1024 lds
    v_mfma_f32_16x16x32_bf16 v[108:111], a[88:91], a[128:131], v[108:111]
    ds_read_b64_tr_b16 a[142:143], v7 offset:51200
    v_mfma_f32_16x16x32_bf16 v[108:111], a[92:95], a[132:135], v[108:111]
    v_mfma_f32_16x16x32_bf16 v[112:115], a[96:99], a[128:131], v[112:115]
    v_mfma_f32_16x16x32_bf16 v[112:115], a[100:103], a[132:135], v[112:115]
    buffer_load_dwordx4 v14, s[4:7], s17 offen offset:2048 lds
    v_mfma_f32_16x16x32_bf16 v[116:119], a[104:107], a[128:131], v[116:119]
    v_mfma_f32_16x16x32_bf16 v[116:119], a[108:111], a[132:135], v[116:119]
    ds_read_b128 a[20:23], v3 offset:4096
    v_mfma_f32_16x16x32_bf16 v[120:123], a[112:115], a[128:131], v[120:123]
    v_mfma_f32_16x16x32_bf16 v[120:123], a[116:119], a[132:135], v[120:123]
    buffer_load_dwordx4 v15, s[4:7], s17 offen offset:3072 lds
    v_mfma_f32_16x16x32_bf16 v[124:127], a[120:123], a[128:131], v[124:127]
    s_add_u32 s17, s17, 128
    v_mfma_f32_16x16x32_bf16 v[124:127], a[124:127], a[132:135], v[124:127]
    s_waitcnt lgkmcnt(4)
    v_mfma_f32_16x16x32_bf16 v[128:131], a[64:67], a[136:139], v[128:131]
    s_waitcnt lgkmcnt(1)
    ds_read_b64_tr_b16 a[128:129], v8 offset:32768
    v_mfma_f32_16x16x32_bf16 v[128:131], a[68:71], a[140:143], v[128:131]
    ds_read_b128 a[24:27], v2 offset:6144
    v_mfma_f32_16x16x32_bf16 v[132:135], a[72:75], a[136:139], v[132:135]
    ds_read_b64_tr_b16 a[130:131], v8 offset:34816
    v_mfma_f32_16x16x32_bf16 v[132:135], a[76:79], a[140:143], v[132:135]
    v_mfma_f32_16x16x32_bf16 v[136:139], a[80:83], a[136:139], v[136:139]
    ds_read_b64_tr_b16 a[132:133], v8 offset:49152
    v_mfma_f32_16x16x32_bf16 v[136:139], a[84:87], a[140:143], v[136:139]
    v_mfma_f32_16x16x32_bf16 v[140:143], a[88:91], a[136:139], v[140:143]
    ds_read_b64_tr_b16 a[134:135], v8 offset:51200
    v_mfma_f32_16x16x32_bf16 v[140:143], a[92:95], a[140:143], v[140:143]
    v_mfma_f32_16x16x32_bf16 v[144:147], a[96:99], a[136:139], v[144:147]
    ds_read_b128 a[28:31], v3 offset:6144
    v_mfma_f32_16x16x32_bf16 v[144:147], a[100:103], a[140:143], v[144:147]
    v_mfma_f32_16x16x32_bf16 v[148:151], a[104:107], a[136:139], v[148:151]
    v_mfma_f32_16x16x32_bf16 v[148:151], a[108:111], a[140:143], v[148:151]
    v_mfma_f32_16x16x32_bf16 v[152:155], a[112:115], a[136:139], v[152:155]
    ds_read_b128 a[32:35], v2 offset:8192
    v_mfma_f32_16x16x32_bf16 v[152:155], a[116:119], a[140:143], v[152:155]
    v_mfma_f32_16x16x32_bf16 v[156:159], a[120:123], a[136:139], v[156:159]
    v_mfma_f32_16x16x32_bf16 v[156:159], a[124:127], a[140:143], v[156:159]
    s_waitcnt lgkmcnt(4)
    v_mfma_f32_16x16x32_bf16 v[160:163], a[64:67], a[128:131], v[160:163]
    s_waitcnt lgkmcnt(2)
    ds_read_b64_tr_b16 a[136:137], v9 offset:32768
    v_mfma_f32_16x16x32_bf16 v[160:163], a[68:71], a[132:135], v[160:163]
    ds_read_b128 a[36:39], v3 offset:8192
    v_mfma_f32_16x16x32_bf16 v[164:167], a[72:75], a[128:131], v[164:167]
    ds_read_b64_tr_b16 a[138:139], v9 offset:34816
    v_mfma_f32_16x16x32_bf16 v[164:167], a[76:79], a[132:135], v[164:167]
    v_mfma_f32_16x16x32_bf16 v[168:171], a[80:83], a[128:131], v[168:171]
    ds_read_b64_tr_b16 a[140:141], v9 offset:49152
    v_mfma_f32_16x16x32_bf16 v[168:171], a[84:87], a[132:135], v[168:171]
    v_mfma_f32_16x16x32_bf16 v[172:175], a[88:91], a[128:131], v[172:175]
    ds_read_b64_tr_b16 a[142:143], v9 offset:51200
    v_mfma_f32_16x16x32_bf16 v[172:175], a[92:95], a[132:135], v[172:175]
    v_mfma_f32_16x16x32_bf16 v[176:179], a[96:99], a[128:131], v[176:179]
    ds_read_b128 a[40:43], v2 offset:10240
    v_mfma_f32_16x16x32_bf16 v[176:179], a[100:103], a[132:135], v[176:179]
    v_mfma_f32_16x16x32_bf16 v[180:183], a[104:107], a[128:131], v[180:183]
    v_mfma_f32_16x16x32_bf16 v[180:183], a[108:111], a[132:135], v[180:183]
    v_mfma_f32_16x16x32_bf16 v[184:187], a[112:115], a[128:131], v[184:187]
    ds_read_b128 a[44:47], v3 offset:10240
    v_mfma_f32_16x16x32_bf16 v[184:187], a[116:119], a[132:135], v[184:187]
    v_mfma_f32_16x16x32_bf16 v[188:191], a[120:123], a[128:131], v[188:191]
    v_mfma_f32_16x16x32_bf16 v[188:191], a[124:127], a[132:135], v[188:191]
    s_waitcnt lgkmcnt(4)
    v_mfma_f32_16x16x32_bf16 v[192:195], a[64:67], a[136:139], v[192:195]
    s_waitcnt lgkmcnt(2)
    ds_read_b64_tr_b16 a[128:129], v10 offset:32768
    v_mfma_f32_16x16x32_bf16 v[192:195], a[68:71], a[140:143], v[192:195]
    ds_read_b128 a[48:51], v2 offset:12288
    v_mfma_f32_16x16x32_bf16 v[196:199], a[72:75], a[136:139], v[196:199]
    ds_read_b64_tr_b16 a[130:131], v10 offset:34816
    v_mfma_f32_16x16x32_bf16 v[196:199], a[76:79], a[140:143], v[196:199]
    v_mfma_f32_16x16x32_bf16 v[200:203], a[80:83], a[136:139], v[200:203]
    ds_read_b64_tr_b16 a[132:133], v10 offset:49152
    v_mfma_f32_16x16x32_bf16 v[200:203], a[84:87], a[140:143], v[200:203]
    v_mfma_f32_16x16x32_bf16 v[204:207], a[88:91], a[136:139], v[204:207]
    ds_read_b64_tr_b16 a[134:135], v10 offset:51200
    v_mfma_f32_16x16x32_bf16 v[204:207], a[92:95], a[140:143], v[204:207]
    v_mfma_f32_16x16x32_bf16 v[208:211], a[96:99], a[136:139], v[208:211]
    ds_read_b128 a[52:55], v3 offset:12288
    v_mfma_f32_16x16x32_bf16 v[208:211], a[100:103], a[140:143], v[208:211]
    v_mfma_f32_16x16x32_bf16 v[212:215], a[104:107], a[136:139], v[212:215]
    v_mfma_f32_16x16x32_bf16 v[212:215], a[108:111], a[140:143], v[212:215]
    v_mfma_f32_16x16x32_bf16 v[216:219], a[112:115], a[136:139], v[216:219]
    ds_read_b128 a[56:59], v2 offset:14336
    v_mfma_f32_16x16x32_bf16 v[216:219], a[116:119], a[140:143], v[216:219]
    v_mfma_f32_16x16x32_bf16 v[220:223], a[120:123], a[136:139], v[220:223]
    v_mfma_f32_16x16x32_bf16 v[220:223], a[124:127], a[140:143], v[220:223]
    s_waitcnt lgkmcnt(4)
    v_mfma_f32_16x16x32_bf16 v[224:227], a[64:67], a[128:131], v[224:227]
    s_waitcnt lgkmcnt(2)
    ds_read_b64_tr_b16 a[136:137], v11 offset:32768
    v_mfma_f32_16x16x32_bf16 v[224:227], a[68:71], a[132:135], v[224:227]
    ds_read_b128 a[60:63], v3 offset:14336
    v_mfma_f32_16x16x32_bf16 v[228:231], a[72:75], a[128:131], v[228:231]
    ds_read_b64_tr_b16 a[138:139], v11 offset:34816
    v_mfma_f32_16x16x32_bf16 v[228:231], a[76:79], a[132:135], v[228:231]
    v_mfma_f32_16x16x32_bf16 v[232:235], a[80:83], a[128:131], v[232:235]
    ds_read_b64_tr_b16 a[140:141], v11 offset:49152
    v_mfma_f32_16x16x32_bf16 v[232:235], a[84:87], a[132:135], v[232:235]
    v_mfma_f32_16x16x32_bf16 v[236:239], a[88:91], a[128:131], v[236:239]
    ds_read_b64_tr_b16 a[142:143], v11 offset:51200
    v_mfma_f32_16x16x32_bf16 v[236:239], a[92:95], a[132:135], v[236:239]
    v_mfma_f32_16x16x32_bf16 v[240:243], a[96:99], a[128:131], v[240:243]
    v_mfma_f32_16x16x32_bf16 v[240:243], a[100:103], a[132:135], v[240:243]
    v_mfma_f32_16x16x32_bf16 v[244:247], a[104:107], a[128:131], v[244:247]
    v_mfma_f32_16x16x32_bf16 v[244:247], a[108:111], a[132:135], v[244:247]
    v_mfma_f32_16x16x32_bf16 v[248:251], a[112:115], a[128:131], v[248:251]
    v_mfma_f32_16x16x32_bf16 v[248:251], a[116:119], a[132:135], v[248:251]
    v_mfma_f32_16x16x32_bf16 v[252:255], a[120:123], a[128:131], v[252:255]
    v_mfma_f32_16x16x32_bf16 v[252:255], a[124:127], a[132:135], v[252:255]
    s_waitcnt vmcnt(0) lgkmcnt(0)
    s_barrier
    v_mfma_f32_16x16x32_bf16 a[224:227], a[64:67], a[136:139], a[224:227]
    s_add_u32 m0, s21, 98304
    ds_read_b64_tr_b16 a[128:129], v4 offset:0
    v_mfma_f32_16x16x32_bf16 a[224:227], a[68:71], a[140:143], a[224:227]
    buffer_load_dwordx4 v16, s[8:11], s18 offen offset:0 lds
    v_mfma_f32_16x16x32_bf16 a[228:231], a[72:75], a[136:139], a[228:231]
    ds_read_b64_tr_b16 a[130:131], v4 offset:2048
    v_mfma_f32_16x16x32_bf16 a[228:231], a[76:79], a[140:143], a[228:231]
    v_mfma_f32_16x16x32_bf16 a[232:235], a[80:83], a[136:139], a[232:235]
    ds_read_b64_tr_b16 a[132:133], v4 offset:16384
    v_mfma_f32_16x16x32_bf16 a[232:235], a[84:87], a[140:143], a[232:235]
    buffer_load_dwordx4 v17, s[8:11], s18 offen offset:1024 lds
    v_mfma_f32_16x16x32_bf16 a[236:239], a[88:91], a[136:139], a[236:239]
    ds_read_b64_tr_b16 a[134:135], v4 offset:18432
    v_mfma_f32_16x16x32_bf16 a[236:239], a[92:95], a[140:143], a[236:239]
    v_mfma_f32_16x16x32_bf16 a[240:243], a[96:99], a[136:139], a[240:243]
    v_mfma_f32_16x16x32_bf16 a[240:243], a[100:103], a[140:143], a[240:243]
    buffer_load_dwordx4 v18, s[8:11], s18 offen offset:2048 lds
    v_mfma_f32_16x16x32_bf16 a[244:247], a[104:107], a[136:139], a[244:247]
    v_mfma_f32_16x16x32_bf16 a[244:247], a[108:111], a[140:143], a[244:247]
    v_mfma_f32_16x16x32_bf16 a[248:251], a[112:115], a[136:139], a[248:251]
    v_mfma_f32_16x16x32_bf16 a[248:251], a[116:119], a[140:143], a[248:251]
    buffer_load_dwordx4 v19, s[8:11], s18 offen offset:3072 lds
    v_mfma_f32_16x16x32_bf16 a[252:255], a[120:123], a[136:139], a[252:255]
    s_add_u32 s18, s18, 524288
    v_mfma_f32_16x16x32_bf16 a[252:255], a[124:127], a[140:143], a[252:255]
    s_waitcnt lgkmcnt(2)
    v_mfma_f32_16x16x32_bf16 v[32:35], a[0:3], a[128:131], v[32:35]
    s_waitcnt lgkmcnt(0)
    s_add_u32 m0, s21, 114688
    ds_read_b64_tr_b16 a[136:137], v5 offset:0
    v_mfma_f32_16x16x32_bf16 v[32:35], a[4:7], a[132:135], v[32:35]
    buffer_load_dwordx4 v16, s[8:11], s19 offen offset:0 lds
    v_mfma_f32_16x16x32_bf16 v[36:39], a[8:11], a[128:131], v[36:39]
    ds_read_b64_tr_b16 a[138:139], v5 offset:2048
    v_mfma_f32_16x16x32_bf16 v[36:39], a[12:15], a[132:135], v[36:39]
    ds_read_b128 a[64:67], v2 offset:32768
    v_mfma_f32_16x16x32_bf16 v[40:43], a[16:19], a[128:131], v[40:43]
    ds_read_b64_tr_b16 a[140:141], v5 offset:16384
    v_mfma_f32_16x16x32_bf16 v[40:43], a[20:23], a[132:135], v[40:43]
    buffer_load_dwordx4 v17, s[8:11], s19 offen offset:1024 lds
    v_mfma_f32_16x16x32_bf16 v[44:47], a[24:27], a[128:131], v[44:47]
    ds_read_b64_tr_b16 a[142:143], v5 offset:18432
    v_mfma_f32_16x16x32_bf16 v[44:47], a[28:31], a[132:135], v[44:47]
    v_mfma_f32_16x16x32_bf16 v[48:51], a[32:35], a[128:131], v[48:51]
    v_mfma_f32_16x16x32_bf16 v[48:51], a[36:39], a[132:135], v[48:51]
    buffer_load_dwordx4 v18, s[8:11], s19 offen offset:2048 lds
    v_mfma_f32_16x16x32_bf16 v[52:55], a[40:43], a[128:131], v[52:55]
    v_mfma_f32_16x16x32_bf16 v[52:55], a[44:47], a[132:135], v[52:55]
    ds_read_b128 a[68:71], v3 offset:32768
    v_mfma_f32_16x16x32_bf16 v[56:59], a[48:51], a[128:131], v[56:59]
    v_mfma_f32_16x16x32_bf16 v[56:59], a[52:55], a[132:135], v[56:59]
    buffer_load_dwordx4 v19, s[8:11], s19 offen offset:3072 lds
    v_mfma_f32_16x16x32_bf16 v[60:63], a[56:59], a[128:131], v[60:63]
    s_add_u32 s19, s19, 524288
    v_mfma_f32_16x16x32_bf16 v[60:63], a[60:63], a[132:135], v[60:63]
    s_waitcnt lgkmcnt(4)
    v_mfma_f32_16x16x32_bf16 v[64:67], a[0:3], a[136:139], v[64:67]
    s_waitcnt lgkmcnt(1)
    s_add_u32 m0, s20, 0
    ds_read_b64_tr_b16 a[128:129], v6 offset:0
    v_mfma_f32_16x16x32_bf16 v[64:67], a[4:7], a[140:143], v[64:67]
    buffer_load_dwordx4 v12, s[4:7], s16 offen offset:0 lds
    v_mfma_f32_16x16x32_bf16 v[68:71], a[8:11], a[136:139], v[68:71]
    ds_read_b64_tr_b16 a[130:131], v6 offset:2048
    v_mfma_f32_16x16x32_bf16 v[68:71], a[12:15], a[140:143], v[68:71]
    ds_read_b128 a[72:75], v2 offset:34816
    v_mfma_f32_16x16x32_bf16 v[72:75], a[16:19], a[136:139], v[72:75]
    ds_read_b64_tr_b16 a[132:133], v6 offset:16384
    v_mfma_f32_16x16x32_bf16 v[72:75], a[20:23], a[140:143], v[72:75]
    buffer_load_dwordx4 v13, s[4:7], s16 offen offset:1024 lds
    v_mfma_f32_16x16x32_bf16 v[76:79], a[24:27], a[136:139], v[76:79]
    ds_read_b64_tr_b16 a[134:135], v6 offset:18432
    v_mfma_f32_16x16x32_bf16 v[76:79], a[28:31], a[140:143], v[76:79]
    v_mfma_f32_16x16x32_bf16 v[80:83], a[32:35], a[136:139], v[80:83]
    v_mfma_f32_16x16x32_bf16 v[80:83], a[36:39], a[140:143], v[80:83]
    buffer_load_dwordx4 v14, s[4:7], s16 offen offset:2048 lds
    v_mfma_f32_16x16x32_bf16 v[84:87], a[40:43], a[136:139], v[84:87]
    v_mfma_f32_16x16x32_bf16 v[84:87], a[44:47], a[140:143], v[84:87]
    ds_read_b128 a[76:79], v3 offset:34816
    v_mfma_f32_16x16x32_bf16 v[88:91], a[48:51], a[136:139], v[88:91]
    v_mfma_f32_16x16x32_bf16 v[88:91], a[52:55], a[140:143], v[88:91]
    buffer_load_dwordx4 v15, s[4:7], s16 offen offset:3072 lds
    v_mfma_f32_16x16x32_bf16 v[92:95], a[56:59], a[136:139], v[92:95]
    s_add_u32 s16, s16, 128
    v_mfma_f32_16x16x32_bf16 v[92:95], a[60:63], a[140:143], v[92:95]
    s_waitcnt lgkmcnt(4)
    v_mfma_f32_16x16x32_bf16 v[96:99], a[0:3], a[128:131], v[96:99]
    s_waitcnt lgkmcnt(1)
    s_add_u32 m0, s20, 4096
    ds_read_b64_tr_b16 a[136:137], v7 offset:0
    v_mfma_f32_16x16x32_bf16 v[96:99], a[4:7], a[132:135], v[96:99]
    buffer_load_dwordx4 v12, s[4:7], s17 offen offset:0 lds
    v_mfma_f32_16x16x32_bf16 v[100:103], a[8:11], a[128:131], v[100:103]
    ds_read_b64_tr_b16 a[138:139], v7 offset:2048
    v_mfma_f32_16x16x32_bf16 v[100:103], a[12:15], a[132:135], v[100:103]
    ds_read_b128 a[80:83], v2 offset:36864
    v_mfma_f32_16x16x32_bf16 v[104:107], a[16:19], a[128:131], v[104:107]
    ds_read_b64_tr_b16 a[140:141], v7 offset:16384
    v_mfma_f32_16x16x32_bf16 v[104:107], a[20:23], a[132:135], v[104:107]
    buffer_load_dwordx4 v13, s[4:7], s17 offen offset:1024 lds
    v_mfma_f32_16x16x32_bf16 v[108:111], a[24:27], a[128:131], v[108:111]
    ds_read_b64_tr_b16 a[142:143], v7 offset:18432
    v_mfma_f32_16x16x32_bf16 v[108:111], a[28:31], a[132:135], v[108:111]
    v_mfma_f32_16x16x32_bf16 v[112:115], a[32:35], a[128:131], v[112:115]
    v_mfma_f32_16x16x32_bf16 v[112:115], a[36:39], a[132:135], v[112:115]
    buffer_load_dwordx4 v14, s[4:7], s17 offen offset:2048 lds
    v_mfma_f32_16x16x32_bf16 v[116:119], a[40:43], a[128:131], v[116:119]
    v_mfma_f32_16x16x32_bf16 v[116:119], a[44:47], a[132:135], v[116:119]
    ds_read_b128 a[84:87], v3 offset:36864
    v_mfma_f32_16x16x32_bf16 v[120:123], a[48:51], a[128:131], v[120:123]
    v_mfma_f32_16x16x32_bf16 v[120:123], a[52:55], a[132:135], v[120:123]
    buffer_load_dwordx4 v15, s[4:7], s17 offen offset:3072 lds
    v_mfma_f32_16x16x32_bf16 v[124:127], a[56:59], a[128:131], v[124:127]
    s_add_u32 s17, s17, 128
    v_mfma_f32_16x16x32_bf16 v[124:127], a[60:63], a[132:135], v[124:127]
    s_waitcnt lgkmcnt(4)
    v_mfma_f32_16x16x32_bf16 v[128:131], a[0:3], a[136:139], v[128:131]
    s_waitcnt lgkmcnt(1)
    ds_read_b64_tr_b16 a[128:129], v8 offset:0
    v_mfma_f32_16x16x32_bf16 v[128:131], a[4:7], a[140:143], v[128:131]
    ds_read_b128 a[88:91], v2 offset:38912
    v_mfma_f32_16x16x32_bf16 v[132:135], a[8:11], a[136:139], v[132:135]
    ds_read_b64_tr_b16 a[130:131], v8 offset:2048
    v_mfma_f32_16x16x32_bf16 v[132:135], a[12:15], a[140:143], v[132:135]
    v_mfma_f32_16x16x32_bf16 v[136:139], a[16:19], a[136:139], v[136:139]
    ds_read_b64_tr_b16 a[132:133], v8 offset:16384
    v_mfma_f32_16x16x32_bf16 v[136:139], a[20:23], a[140:143], v[136:139]
    v_mfma_f32_16x16x32_bf16 v[140:143], a[24:27], a[136:139], v[140:143]
    ds_read_b64_tr_b16 a[134:135], v8 offset:18432
    v_mfma_f32_16x16x32_bf16 v[140:143], a[28:31], a[140:143], v[140:143]
    v_mfma_f32_16x16x32_bf16 v[144:147], a[32:35], a[136:139], v[144:147]
    ds_read_b128 a[92:95], v3 offset:38912
    v_mfma_f32_16x16x32_bf16 v[144:147], a[36:39], a[140:143], v[144:147]
    v_mfma_f32_16x16x32_bf16 v[148:151], a[40:43], a[136:139], v[148:151]
    v_mfma_f32_16x16x32_bf16 v[148:151], a[44:47], a[140:143], v[148:151]
    v_mfma_f32_16x16x32_bf16 v[152:155], a[48:51], a[136:139], v[152:155]
    ds_read_b128 a[96:99], v2 offset:40960
    v_mfma_f32_16x16x32_bf16 v[152:155], a[52:55], a[140:143], v[152:155]
    v_mfma_f32_16x16x32_bf16 v[156:159], a[56:59], a[136:139], v[156:159]
    v_mfma_f32_16x16x32_bf16 v[156:159], a[60:63], a[140:143], v[156:159]
    s_waitcnt lgkmcnt(4)
    v_mfma_f32_16x16x32_bf16 v[160:163], a[0:3], a[128:131], v[160:163]
    s_waitcnt lgkmcnt(2)
    ds_read_b64_tr_b16 a[136:137], v9 offset:0
    v_mfma_f32_16x16x32_bf16 v[160:163], a[4:7], a[132:135], v[160:163]
    ds_read_b128 a[100:103], v3 offset:40960
    v_mfma_f32_16x16x32_bf16 v[164:167], a[8:11], a[128:131], v[164:167]
    ds_read_b64_tr_b16 a[138:139], v9 offset:2048
    v_mfma_f32_16x16x32_bf16 v[164:167], a[12:15], a[132:135], v[164:167]
    v_mfma_f32_16x16x32_bf16 v[168:171], a[16:19], a[128:131], v[168:171]
    ds_read_b64_tr_b16 a[140:141], v9 offset:16384
    v_mfma_f32_16x16x32_bf16 v[168:171], a[20:23], a[132:135], v[168:171]
    v_mfma_f32_16x16x32_bf16 v[172:175], a[24:27], a[128:131], v[172:175]
    ds_read_b64_tr_b16 a[142:143], v9 offset:18432
    v_mfma_f32_16x16x32_bf16 v[172:175], a[28:31], a[132:135], v[172:175]
    v_mfma_f32_16x16x32_bf16 v[176:179], a[32:35], a[128:131], v[176:179]
    ds_read_b128 a[104:107], v2 offset:43008
    v_mfma_f32_16x16x32_bf16 v[176:179], a[36:39], a[132:135], v[176:179]
    v_mfma_f32_16x16x32_bf16 v[180:183], a[40:43], a[128:131], v[180:183]
    v_mfma_f32_16x16x32_bf16 v[180:183], a[44:47], a[132:135], v[180:183]
    v_mfma_f32_16x16x32_bf16 v[184:187], a[48:51], a[128:131], v[184:187]
    ds_read_b128 a[108:111], v3 offset:43008
    v_mfma_f32_16x16x32_bf16 v[184:187], a[52:55], a[132:135], v[184:187]
    v_mfma_f32_16x16x32_bf16 v[188:191], a[56:59], a[128:131], v[188:191]
    v_mfma_f32_16x16x32_bf16 v[188:191], a[60:63], a[132:135], v[188:191]
    s_waitcnt lgkmcnt(4)
    v_mfma_f32_16x16x32_bf16 v[192:195], a[0:3], a[136:139], v[192:195]
    s_waitcnt lgkmcnt(2)
    ds_read_b64_tr_b16 a[128:129], v10 offset:0
    v_mfma_f32_16x16x32_bf16 v[192:195], a[4:7], a[140:143], v[192:195]
    ds_read_b128 a[112:115], v2 offset:45056
    v_mfma_f32_16x16x32_bf16 v[196:199], a[8:11], a[136:139], v[196:199]
    ds_read_b64_tr_b16 a[130:131], v10 offset:2048
    v_mfma_f32_16x16x32_bf16 v[196:199], a[12:15], a[140:143], v[196:199]
    v_mfma_f32_16x16x32_bf16 v[200:203], a[16:19], a[136:139], v[200:203]
    ds_read_b64_tr_b16 a[132:133], v10 offset:16384
    v_mfma_f32_16x16x32_bf16 v[200:203], a[20:23], a[140:143], v[200:203]
    v_mfma_f32_16x16x32_bf16 v[204:207], a[24:27], a[136:139], v[204:207]
    ds_read_b64_tr_b16 a[134:135], v10 offset:18432
    v_mfma_f32_16x16x32_bf16 v[204:207], a[28:31], a[140:143], v[204:207]
    v_mfma_f32_16x16x32_bf16 v[208:211], a[32:35], a[136:139], v[208:211]
    ds_read_b128 a[116:119], v3 offset:45056
    v_mfma_f32_16x16x32_bf16 v[208:211], a[36:39], a[140:143], v[208:211]
    v_mfma_f32_16x16x32_bf16 v[212:215], a[40:43], a[136:139], v[212:215]
    v_mfma_f32_16x16x32_bf16 v[212:215], a[44:47], a[140:143], v[212:215]
    v_mfma_f32_16x16x32_bf16 v[216:219], a[48:51], a[136:139], v[216:219]
    ds_read_b128 a[120:123], v2 offset:47104
    v_mfma_f32_16x16x32_bf16 v[216:219], a[52:55], a[140:143], v[216:219]
    v_mfma_f32_16x16x32_bf16 v[220:223], a[56:59], a[136:139], v[220:223]
    v_mfma_f32_16x16x32_bf16 v[220:223], a[60:63], a[140:143], v[220:223]
    s_waitcnt lgkmcnt(4)
    v_mfma_f32_16x16x32_bf16 v[224:227], a[0:3], a[128:131], v[224:227]
    s_waitcnt lgkmcnt(2)
    ds_read_b64_tr_b16 a[136:137], v11 offset:0
    v_mfma_f32_16x16x32_bf16 v[224:227], a[4:7], a[132:135], v[224:227]
    ds_read_b128 a[124:127], v3 offset:47104
    v_mfma_f32_16x16x32_bf16 v[228:231], a[8:11], a[128:131], v[228:231]
    ds_read_b64_tr_b16 a[138:139], v11 offset:2048
    v_mfma_f32_16x16x32_bf16 v[228:231], a[12:15], a[132:135], v[228:231]
    v_mfma_f32_16x16x32_bf16 v[232:235], a[16:19], a[128:131], v[232:235]
    ds_read_b64_tr_b16 a[140:141], v11 offset:16384
    v_mfma_f32_16x16x32_bf16 v[232:235], a[20:23], a[132:135], v[232:235]
    v_mfma_f32_16x16x32_bf16 v[236:239], a[24:27], a[128:131], v[236:239]
    ds_read_b64_tr_b16 a[142:143], v11 offset:18432
    v_mfma_f32_16x16x32_bf16 v[236:239], a[28:31], a[132:135], v[236:239]
    v_mfma_f32_16x16x32_bf16 v[240:243], a[32:35], a[128:131], v[240:243]
    v_mfma_f32_16x16x32_bf16 v[240:243], a[36:39], a[132:135], v[240:243]
    v_mfma_f32_16x16x32_bf16 v[244:247], a[40:43], a[128:131], v[244:247]
    v_mfma_f32_16x16x32_bf16 v[244:247], a[44:47], a[132:135], v[244:247]
    v_mfma_f32_16x16x32_bf16 v[248:251], a[48:51], a[128:131], v[248:251]
    v_mfma_f32_16x16x32_bf16 v[248:251], a[52:55], a[132:135], v[248:251]
    v_mfma_f32_16x16x32_bf16 v[252:255], a[56:59], a[128:131], v[252:255]
    v_mfma_f32_16x16x32_bf16 v[252:255], a[60:63], a[132:135], v[252:255]
    s_waitcnt vmcnt(0) lgkmcnt(0)
    s_barrier
    v_mfma_f32_16x16x32_bf16 a[224:227], a[0:3], a[136:139], a[224:227]
    s_add_u32 m0, s21, 65536
    ds_read_b64_tr_b16 a[128:129], v4 offset:32768
    v_mfma_f32_16x16x32_bf16 a[224:227], a[4:7], a[140:143], a[224:227]
    buffer_load_dwordx4 v16, s[8:11], s18 offen offset:0 lds
    v_mfma_f32_16x16x32_bf16 a[228:231], a[8:11], a[136:139], a[228:231]
    ds_read_b64_tr_b16 a[130:131], v4 offset:34816
    v_mfma_f32_16x16x32_bf16 a[228:231], a[12:15], a[140:143], a[228:231]
    v_mfma_f32_16x16x32_bf16 a[232:235], a[16:19], a[136:139], a[232:235]
    ds_read_b64_tr_b16 a[132:133], v4 offset:49152
    v_mfma_f32_16x16x32_bf16 a[232:235], a[20:23], a[140:143], a[232:235]
    buffer_load_dwordx4 v17, s[8:11], s18 offen offset:1024 lds
    v_mfma_f32_16x16x32_bf16 a[236:239], a[24:27], a[136:139], a[236:239]
    ds_read_b64_tr_b16 a[134:135], v4 offset:51200
    v_mfma_f32_16x16x32_bf16 a[236:239], a[28:31], a[140:143], a[236:239]
    v_mfma_f32_16x16x32_bf16 a[240:243], a[32:35], a[136:139], a[240:243]
    v_mfma_f32_16x16x32_bf16 a[240:243], a[36:39], a[140:143], a[240:243]
    buffer_load_dwordx4 v18, s[8:11], s18 offen offset:2048 lds
    v_mfma_f32_16x16x32_bf16 a[244:247], a[40:43], a[136:139], a[244:247]
    v_mfma_f32_16x16x32_bf16 a[244:247], a[44:47], a[140:143], a[244:247]
    v_mfma_f32_16x16x32_bf16 a[248:251], a[48:51], a[136:139], a[248:251]
    s_sub_u32 s22, s22, 1
    v_mfma_f32_16x16x32_bf16 a[248:251], a[52:55], a[140:143], a[248:251]
    buffer_load_dwordx4 v19, s[8:11], s18 offen offset:3072 lds
    v_mfma_f32_16x16x32_bf16 a[252:255], a[56:59], a[136:139], a[252:255]
    s_add_u32 s18, s18, 524288
    v_mfma_f32_16x16x32_bf16 a[252:255], a[60:63], a[140:143], a[252:255]
    s_waitcnt lgkmcnt(2)
    s_cmp_lg_u32 s22, 0
    s_cbranch_scc1 ALg_2
    v_mfma_f32_16x16x32_bf16 v[32:35], a[64:67], a[128:131], v[32:35]
    s_waitcnt lgkmcnt(0)
    s_add_u32 m0, s21, 81920
    ds_read_b64_tr_b16 a[136:137], v5 offset:32768
    v_mfma_f32_16x16x32_bf16 v[32:35], a[68:71], a[132:135], v[32:35]
    buffer_load_dwordx4 v16, s[8:11], s19 offen offset:0 lds
    v_mfma_f32_16x16x32_bf16 v[36:39], a[72:75], a[128:131], v[36:39]
    ds_read_b64_tr_b16 a[138:139], v5 offset:34816
    v_mfma_f32_16x16x32_bf16 v[36:39], a[76:79], a[132:135], v[36:39]
    ds_read_b128 a[0:3], v2 offset:0
    v_mfma_f32_16x16x32_bf16 v[40:43], a[80:83], a[128:131], v[40:43]
    ds_read_b64_tr_b16 a[140:141], v5 offset:49152
    v_mfma_f32_16x16x32_bf16 v[40:43], a[84:87], a[132:135], v[40:43]
    buffer_load_dwordx4 v17, s[8:11], s19 offen offset:1024 lds
    v_mfma_f32_16x16x32_bf16 v[44:47], a[88:91], a[128:131], v[44:47]
    ds_read_b64_tr_b16 a[142:143], v5 offset:51200
    v_mfma_f32_16x16x32_bf16 v[44:47], a[92:95], a[132:135], v[44:47]
    v_mfma_f32_16x16x32_bf16 v[48:51], a[96:99], a[128:131], v[48:51]
    v_mfma_f32_16x16x32_bf16 v[48:51], a[100:103], a[132:135], v[48:51]
    buffer_load_dwordx4 v18, s[8:11], s19 offen offset:2048 lds
    v_mfma_f32_16x16x32_bf16 v[52:55], a[104:107], a[128:131], v[52:55]
    v_mfma_f32_16x16x32_bf16 v[52:55], a[108:111], a[132:135], v[52:55]
    ds_read_b128 a[4:7], v3 offset:0
    v_mfma_f32_16x16x32_bf16 v[56:59], a[112:115], a[128:131], v[56:59]
    v_mfma_f32_16x16x32_bf16 v[56:59], a[116:119], a[132:135], v[56:59]
    buffer_load_dwordx4 v19, s[8:11], s19 offen offset:3072 lds
    v_mfma_f32_16x16x32_bf16 v[60:63], a[120:123], a[128:131], v[60:63]
    s_add_u32 s19, s19, 524288
    v_mfma_f32_16x16x32_bf16 v[60:63], a[124:127], a[132:135], v[60:63]
    s_waitcnt lgkmcnt(4)
    v_mfma_f32_16x16x32_bf16 v[64:67], a[64:67], a[136:139], v[64:67]
    s_waitcnt lgkmcnt(1)
    s_add_u32 m0, s20, 32768
    ds_read_b64_tr_b16 a[128:129], v6 offset:32768
    v_mfma_f32_16x16x32_bf16 v[64:67], a[68:71], a[140:143], v[64:67]
    buffer_load_dwordx4 v12, s[4:7], s16 offen offset:0 lds
    v_mfma_f32_16x16x32_bf16 v[68:71], a[72:75], a[136:139], v[68:71]
    ds_read_b64_tr_b16 a[130:131], v6 offset:34816
    v_mfma_f32_16x16x32_bf16 v[68:71], a[76:79], a[140:143], v[68:71]
    ds_read_b128 a[8:11], v2 offset:2048
    v_mfma_f32_16x16x32_bf16 v[72:75], a[80:83], a[136:139], v[72:75]
    ds_read_b64_tr_b16 a[132:133], v6 offset:49152
    v_mfma_f32_16x16x32_bf16 v[72:75], a[84:87], a[140:143], v[72:75]
    buffer_load_dwordx4 v13, s[4:7], s16 offen offset:1024 lds
    v_mfma_f32_16x16x32_bf16 v[76:79], a[88:91], a[136:139], v[76:79]
    ds_read_b64_tr_b16 a[134:135], v6 offset:51200
    v_mfma_f32_16x16x32_bf16 v[76:79], a[92:95], a[140:143], v[76:79]
    v_mfma_f32_16x16x32_bf16 v[80:83], a[96:99], a[136:139], v[80:83]
    v_mfma_f32_16x16x32_bf16 v[80:83], a[100:103], a[140:143], v[80:83]
    buffer_load_dwordx4 v14, s[4:7], s16 offen offset:2048 lds
    v_mfma_f32_16x16x32_bf16 v[84:87], a[104:107], a[136:139], v[84:87]
    v_mfma_f32_16x16x32_bf16 v[84:87], a[108:111], a[140:143], v[84:87]
    ds_read_b128 a[12:15], v3 offset:2048
    v_mfma_f32_16x16x32_bf16 v[88:91], a[112:115], a[136:139], v[88:91]
    v_mfma_f32_16x16x32_bf16 v[88:91], a[116:119], a[140:143], v[88:91]
    buffer_load_dwordx4 v15, s[4:7], s16 offen offset:3072 lds
    v_mfma_f32_16x16x32_bf16 v[92:95], a[120:123], a[136:139], v[92:95]
    s_add_u32 s16, s16, 128
    v_mfma_f32_16x16x32_bf16 v[92:95], a[124:127], a[140:143], v[92:95]
    s_waitcnt lgkmcnt(4)
    v_mfma_f32_16x16x32_bf16 v[96:99], a[64:67], a[128:131], v[96:99]
    s_waitcnt lgkmcnt(1)
    s_add_u32 m0, s20, 36864
    ds_read_b64_tr_b16 a[136:137], v7 offset:32768
    v_mfma_f32_16x16x32_bf16 v[96:99], a[68:71], a[132:135], v[96:99]
    buffer_load_dwordx4 v12, s[4:7], s17 offen offset:0 lds
    v_mfma_f32_16x16x32_bf16 v[100:103], a[72:75], a[128:131], v[100:103]
    ds_read_b64_tr_b16 a[138:139], v7 offset:34816
    v_mfma_f32_16x16x32_bf16 v[100:103], a[76:79], a[132:135], v[100:103]
    ds_read_b128 a[16:19], v2 offset:4096
    v_mfma_f32_16x16x32_bf16 v[104:107], a[80:83], a[128:131], v[104:107]
    ds_read_b64_tr_b16 a[140:141], v7 offset:49152
    v_mfma_f32_16x16x32_bf16 v[104:107], a[84:87], a[132:135], v[104:107]
    buffer_load_dwordx4 v13, s[4:7], s17 offen offset:1024 lds
    v_mfma_f32_16x16x32_bf16 v[108:111], a[88:91], a[128:131], v[108:111]
    ds_read_b64_tr_b16 a[142:143], v7 offset:51200
    v_mfma_f32_16x16x32_bf16 v[108:111], a[92:95], a[132:135], v[108:111]
    v_mfma_f32_16x16x32_bf16 v[112:115], a[96:99], a[128:131], v[112:115]
    v_mfma_f32_16x16x32_bf16 v[112:115], a[100:103], a[132:135], v[112:115]
    buffer_load_dwordx4 v14, s[4:7], s17 offen offset:2048 lds
    v_mfma_f32_16x16x32_bf16 v[116:119], a[104:107], a[128:131], v[116:119]
    v_mfma_f32_16x16x32_bf16 v[116:119], a[108:111], a[132:135], v[116:119]
    ds_read_b128 a[20:23], v3 offset:4096
    v_mfma_f32_16x16x32_bf16 v[120:123], a[112:115], a[128:131], v[120:123]
    v_mfma_f32_16x16x32_bf16 v[120:123], a[116:119], a[132:135], v[120:123]
    buffer_load_dwordx4 v15, s[4:7], s17 offen offset:3072 lds
    v_mfma_f32_16x16x32_bf16 v[124:127], a[120:123], a[128:131], v[124:127]
    s_add_u32 s17, s17, 128
    v_mfma_f32_16x16x32_bf16 v[124:127], a[124:127], a[132:135], v[124:127]
    s_waitcnt lgkmcnt(4)
    v_mfma_f32_16x16x32_bf16 v[128:131], a[64:67], a[136:139], v[128:131]
    s_waitcnt lgkmcnt(1)
    ds_read_b64_tr_b16 a[128:129], v8 offset:32768
    v_mfma_f32_16x16x32_bf16 v[128:131], a[68:71], a[140:143], v[128:131]
    ds_read_b128 a[24:27], v2 offset:6144
    v_mfma_f32_16x16x32_bf16 v[132:135], a[72:75], a[136:139], v[132:135]
    ds_read_b64_tr_b16 a[130:131], v8 offset:34816
    v_mfma_f32_16x16x32_bf16 v[132:135], a[76:79], a[140:143], v[132:135]
    v_mfma_f32_16x16x32_bf16 v[136:139], a[80:83], a[136:139], v[136:139]
    ds_read_b64_tr_b16 a[132:133], v8 offset:49152
    v_mfma_f32_16x16x32_bf16 v[136:139], a[84:87], a[140:143], v[136:139]
    v_mfma_f32_16x16x32_bf16 v[140:143], a[88:91], a[136:139], v[140:143]
    ds_read_b64_tr_b16 a[134:135], v8 offset:51200
    v_mfma_f32_16x16x32_bf16 v[140:143], a[92:95], a[140:143], v[140:143]
    v_mfma_f32_16x16x32_bf16 v[144:147], a[96:99], a[136:139], v[144:147]
    ds_read_b128 a[28:31], v3 offset:6144
    v_mfma_f32_16x16x32_bf16 v[144:147], a[100:103], a[140:143], v[144:147]
    v_mfma_f32_16x16x32_bf16 v[148:151], a[104:107], a[136:139], v[148:151]
    v_mfma_f32_16x16x32_bf16 v[148:151], a[108:111], a[140:143], v[148:151]
    v_mfma_f32_16x16x32_bf16 v[152:155], a[112:115], a[136:139], v[152:155]
    ds_read_b128 a[32:35], v2 offset:8192
    v_mfma_f32_16x16x32_bf16 v[152:155], a[116:119], a[140:143], v[152:155]
    v_mfma_f32_16x16x32_bf16 v[156:159], a[120:123], a[136:139], v[156:159]
    v_mfma_f32_16x16x32_bf16 v[156:159], a[124:127], a[140:143], v[156:159]
    s_waitcnt lgkmcnt(4)
    v_mfma_f32_16x16x32_bf16 v[160:163], a[64:67], a[128:131], v[160:163]
    s_waitcnt lgkmcnt(2)
    ds_read_b64_tr_b16 a[136:137], v9 offset:32768
    v_mfma_f32_16x16x32_bf16 v[160:163], a[68:71], a[132:135], v[160:163]
    ds_read_b128 a[36:39], v3 offset:8192
    v_mfma_f32_16x16x32_bf16 v[164:167], a[72:75], a[128:131], v[164:167]
    ds_read_b64_tr_b16 a[138:139], v9 offset:34816
    v_mfma_f32_16x16x32_bf16 v[164:167], a[76:79], a[132:135], v[164:167]
    v_mfma_f32_16x16x32_bf16 v[168:171], a[80:83], a[128:131], v[168:171]
    ds_read_b64_tr_b16 a[140:141], v9 offset:49152
    v_mfma_f32_16x16x32_bf16 v[168:171], a[84:87], a[132:135], v[168:171]
    v_mfma_f32_16x16x32_bf16 v[172:175], a[88:91], a[128:131], v[172:175]
    ds_read_b64_tr_b16 a[142:143], v9 offset:51200
    v_mfma_f32_16x16x32_bf16 v[172:175], a[92:95], a[132:135], v[172:175]
    v_mfma_f32_16x16x32_bf16 v[176:179], a[96:99], a[128:131], v[176:179]
    ds_read_b128 a[40:43], v2 offset:10240
    v_mfma_f32_16x16x32_bf16 v[176:179], a[100:103], a[132:135], v[176:179]
    v_mfma_f32_16x16x32_bf16 v[180:183], a[104:107], a[128:131], v[180:183]
    v_mfma_f32_16x16x32_bf16 v[180:183], a[108:111], a[132:135], v[180:183]
    v_mfma_f32_16x16x32_bf16 v[184:187], a[112:115], a[128:131], v[184:187]
    ds_read_b128 a[44:47], v3 offset:10240
    v_mfma_f32_16x16x32_bf16 v[184:187], a[116:119], a[132:135], v[184:187]
    v_mfma_f32_16x16x32_bf16 v[188:191], a[120:123], a[128:131], v[188:191]
    v_mfma_f32_16x16x32_bf16 v[188:191], a[124:127], a[132:135], v[188:191]
    s_waitcnt lgkmcnt(4)
    v_mfma_f32_16x16x32_bf16 v[192:195], a[64:67], a[136:139], v[192:195]
    s_waitcnt lgkmcnt(2)
    ds_read_b64_tr_b16 a[128:129], v10 offset:32768
    v_mfma_f32_16x16x32_bf16 v[192:195], a[68:71], a[140:143], v[192:195]
    ds_read_b128 a[48:51], v2 offset:12288
    v_mfma_f32_16x16x32_bf16 v[196:199], a[72:75], a[136:139], v[196:199]
    ds_read_b64_tr_b16 a[130:131], v10 offset:34816
    v_mfma_f32_16x16x32_bf16 v[196:199], a[76:79], a[140:143], v[196:199]
    v_mfma_f32_16x16x32_bf16 v[200:203], a[80:83], a[136:139], v[200:203]
    ds_read_b64_tr_b16 a[132:133], v10 offset:49152
    v_mfma_f32_16x16x32_bf16 v[200:203], a[84:87], a[140:143], v[200:203]
    v_mfma_f32_16x16x32_bf16 v[204:207], a[88:91], a[136:139], v[204:207]
    ds_read_b64_tr_b16 a[134:135], v10 offset:51200
    v_mfma_f32_16x16x32_bf16 v[204:207], a[92:95], a[140:143], v[204:207]
    v_mfma_f32_16x16x32_bf16 v[208:211], a[96:99], a[136:139], v[208:211]
    ds_read_b128 a[52:55], v3 offset:12288
    v_mfma_f32_16x16x32_bf16 v[208:211], a[100:103], a[140:143], v[208:211]
    v_mfma_f32_16x16x32_bf16 v[212:215], a[104:107], a[136:139], v[212:215]
    v_mfma_f32_16x16x32_bf16 v[212:215], a[108:111], a[140:143], v[212:215]
    v_mfma_f32_16x16x32_bf16 v[216:219], a[112:115], a[136:139], v[216:219]
    ds_read_b128 a[56:59], v2 offset:14336
    v_mfma_f32_16x16x32_bf16 v[216:219], a[116:119], a[140:143], v[216:219]
    v_mfma_f32_16x16x32_bf16 v[220:223], a[120:123], a[136:139], v[220:223]
    v_mfma_f32_16x16x32_bf16 v[220:223], a[124:127], a[140:143], v[220:223]
    s_waitcnt lgkmcnt(4)
    v_mfma_f32_16x16x32_bf16 v[224:227], a[64:67], a[128:131], v[224:227]
    s_waitcnt lgkmcnt(2)
    ds_read_b64_tr_b16 a[136:137], v11 offset:32768
    v_mfma_f32_16x16x32_bf16 v[224:227], a[68:71], a[132:135], v[224:227]
    ds_read_b128 a[60:63], v3 offset:14336
    v_mfma_f32_16x16x32_bf16 v[228:231], a[72:75], a[128:131], v[228:231]
    ds_read_b64_tr_b16 a[138:139], v11 offset:34816
    v_mfma_f32_16x16x32_bf16 v[228:231], a[76:79], a[132:135], v[228:231]
    v_mfma_f32_16x16x32_bf16 v[232:235], a[80:83], a[128:131], v[232:235]
    ds_read_b64_tr_b16 a[140:141], v11 offset:49152
    v_mfma_f32_16x16x32_bf16 v[232:235], a[84:87], a[132:135], v[232:235]
    v_mfma_f32_16x16x32_bf16 v[236:239], a[88:91], a[128:131], v[236:239]
    ds_read_b64_tr_b16 a[142:143], v11 offset:51200
    v_mfma_f32_16x16x32_bf16 v[236:239], a[92:95], a[132:135], v[236:239]
    v_mfma_f32_16x16x32_bf16 v[240:243], a[96:99], a[128:131], v[240:243]
    v_mfma_f32_16x16x32_bf16 v[240:243], a[100:103], a[132:135], v[240:243]
    v_mfma_f32_16x16x32_bf16 v[244:247], a[104:107], a[128:131], v[244:247]
    v_mfma_f32_16x16x32_bf16 v[244:247], a[108:111], a[132:135], v[244:247]
    v_mfma_f32_16x16x32_bf16 v[248:251], a[112:115], a[128:131], v[248:251]
    v_mfma_f32_16x16x32_bf16 v[248:251], a[116:119], a[132:135], v[248:251]
    v_mfma_f32_16x16x32_bf16 v[252:255], a[120:123], a[128:131], v[252:255]
    v_mfma_f32_16x16x32_bf16 v[252:255], a[124:127], a[132:135], v[252:255]
    s_waitcnt vmcnt(0) lgkmcnt(0)
    s_barrier
    v_mfma_f32_16x16x32_bf16 a[224:227], a[64:67], a[136:139], a[224:227]
    s_add_u32 m0, s21, 98304
    ds_read_b64_tr_b16 a[128:129], v4 offset:0
    v_mfma_f32_16x16x32_bf16 a[224:227], a[68:71], a[140:143], a[224:227]
    buffer_load_dwordx4 v16, s[8:11], s18 offen offset:0 lds
    v_mfma_f32_16x16x32_bf16 a[228:231], a[72:75], a[136:139], a[228:231]
    ds_read_b64_tr_b16 a[130:131], v4 offset:2048
    v_mfma_f32_16x16x32_bf16 a[228:231], a[76:79], a[140:143], a[228:231]
    v_mfma_f32_16x16x32_bf16 a[232:235], a[80:83], a[136:139], a[232:235]
    ds_read_b64_tr_b16 a[132:133], v4 offset:16384
    v_mfma_f32_16x16x32_bf16 a[232:235], a[84:87], a[140:143], a[232:235]
    buffer_load_dwordx4 v17, s[8:11], s18 offen offset:1024 lds
    v_mfma_f32_16x16x32_bf16 a[236:239], a[88:91], a[136:139], a[236:239]
    ds_read_b64_tr_b16 a[134:135], v4 offset:18432
    v_mfma_f32_16x16x32_bf16 a[236:239], a[92:95], a[140:143], a[236:239]
    v_mfma_f32_16x16x32_bf16 a[240:243], a[96:99], a[136:139], a[240:243]
    v_mfma_f32_16x16x32_bf16 a[240:243], a[100:103], a[140:143], a[240:243]
    buffer_load_dwordx4 v18, s[8:11], s18 offen offset:2048 lds
    v_mfma_f32_16x16x32_bf16 a[244:247], a[104:107], a[136:139], a[244:247]
    v_mfma_f32_16x16x32_bf16 a[244:247], a[108:111], a[140:143], a[244:247]
    v_mfma_f32_16x16x32_bf16 a[248:251], a[112:115], a[136:139], a[248:251]
    v_mfma_f32_16x16x32_bf16 a[248:251], a[116:119], a[140:143], a[248:251]
    buffer_load_dwordx4 v19, s[8:11], s18 offen offset:3072 lds
    v_mfma_f32_16x16x32_bf16 a[252:255], a[120:123], a[136:139], a[252:255]
    s_add_u32 s18, s18, 524288
    v_mfma_f32_16x16x32_bf16 a[252:255], a[124:127], a[140:143], a[252:255]
    s_waitcnt lgkmcnt(2)
    v_mfma_f32_16x16x32_bf16 v[32:35], a[0:3], a[128:131], v[32:35]
    s_waitcnt lgkmcnt(0)
    s_add_u32 m0, s21, 114688
    ds_read_b64_tr_b16 a[136:137], v5 offset:0
    v_mfma_f32_16x16x32_bf16 v[32:35], a[4:7], a[132:135], v[32:35]
    buffer_load_dwordx4 v16, s[8:11], s19 offen offset:0 lds
    v_mfma_f32_16x16x32_bf16 v[36:39], a[8:11], a[128:131], v[36:39]
    ds_read_b64_tr_b16 a[138:139], v5 offset:2048
    v_mfma_f32_16x16x32_bf16 v[36:39], a[12:15], a[132:135], v[36:39]
    ds_read_b128 a[64:67], v2 offset:32768
    v_mfma_f32_16x16x32_bf16 v[40:43], a[16:19], a[128:131], v[40:43]
    ds_read_b64_tr_b16 a[140:141], v5 offset:16384
    v_mfma_f32_16x16x32_bf16 v[40:43], a[20:23], a[132:135], v[40:43]
    buffer_load_dwordx4 v17, s[8:11], s19 offen offset:1024 lds
    v_mfma_f32_16x16x32_bf16 v[44:47], a[24:27], a[128:131], v[44:47]
    ds_read_b64_tr_b16 a[142:143], v5 offset:18432
    v_mfma_f32_16x16x32_bf16 v[44:47], a[28:31], a[132:135], v[44:47]
    v_mfma_f32_16x16x32_bf16 v[48:51], a[32:35], a[128:131], v[48:51]
    v_mfma_f32_16x16x32_bf16 v[48:51], a[36:39], a[132:135], v[48:51]
    buffer_load_dwordx4 v18, s[8:11], s19 offen offset:2048 lds
    v_mfma_f32_16x16x32_bf16 v[52:55], a[40:43], a[128:131], v[52:55]
    v_mfma_f32_16x16x32_bf16 v[52:55], a[44:47], a[132:135], v[52:55]
    ds_read_b128 a[68:71], v3 offset:32768
    v_mfma_f32_16x16x32_bf16 v[56:59], a[48:51], a[128:131], v[56:59]
    v_mfma_f32_16x16x32_bf16 v[56:59], a[52:55], a[132:135], v[56:59]
    buffer_load_dwordx4 v19, s[8:11], s19 offen offset:3072 lds
    v_mfma_f32_16x16x32_bf16 v[60:63], a[56:59], a[128:131], v[60:63]
    s_add_u32 s19, s19, 524288
    v_mfma_f32_16x16x32_bf16 v[60:63], a[60:63], a[132:135], v[60:63]
    s_waitcnt lgkmcnt(4)
    v_mfma_f32_16x16x32_bf16 v[64:67], a[0:3], a[136:139], v[64:67]
    s_waitcnt lgkmcnt(1)
    ds_read_b64_tr_b16 a[128:129], v6 offset:0
    v_mfma_f32_16x16x32_bf16 v[64:67], a[4:7], a[140:143], v[64:67]
    v_mfma_f32_16x16x32_bf16 v[68:71], a[8:11], a[136:139], v[68:71]
    ds_read_b64_tr_b16 a[130:131], v6 offset:2048
    v_mfma_f32_16x16x32_bf16 v[68:71], a[12:15], a[140:143], v[68:71]
    ds_read_b128 a[72:75], v2 offset:34816
    v_mfma_f32_16x16x32_bf16 v[72:75], a[16:19], a[136:139], v[72:75]
    ds_read_b64_tr_b16 a[132:133], v6 offset:16384
    v_mfma_f32_16x16x32_bf16 v[72:75], a[20:23], a[140:143], v[72:75]
    v_mfma_f32_16x16x32_bf16 v[76:79], a[24:27], a[136:139], v[76:79]
    ds_read_b64_tr_b16 a[134:135], v6 offset:18432
    v_mfma_f32_16x16x32_bf16 v[76:79], a[28:31], a[140:143], v[76:79]
    v_mfma_f32_16x16x32_bf16 v[80:83], a[32:35], a[136:139], v[80:83]
    v_mfma_f32_16x16x32_bf16 v[80:83], a[36:39], a[140:143], v[80:83]
    ds_read_b128 a[76:79], v3 offset:34816
    v_mfma_f32_16x16x32_bf16 v[84:87], a[40:43], a[136:139], v[84:87]
    v_mfma_f32_16x16x32_bf16 v[84:87], a[44:47], a[140:143], v[84:87]
    v_mfma_f32_16x16x32_bf16 v[88:91], a[48:51], a[136:139], v[88:91]
    v_mfma_f32_16x16x32_bf16 v[88:91], a[52:55], a[140:143], v[88:91]
    v_mfma_f32_16x16x32_bf16 v[92:95], a[56:59], a[136:139], v[92:95]
    ds_read_b128 a[80:83], v2 offset:36864
    v_mfma_f32_16x16x32_bf16 v[92:95], a[60:63], a[140:143], v[92:95]
    s_waitcnt lgkmcnt(5)
    v_mfma_f32_16x16x32_bf16 v[96:99], a[0:3], a[128:131], v[96:99]
    s_waitcnt lgkmcnt(2)
    ds_read_b64_tr_b16 a[136:137], v7 offset:0
    v_mfma_f32_16x16x32_bf16 v[96:99], a[4:7], a[132:135], v[96:99]
    v_mfma_f32_16x16x32_bf16 v[100:103], a[8:11], a[128:131], v[100:103]
    ds_read_b64_tr_b16 a[138:139], v7 offset:2048
    v_mfma_f32_16x16x32_bf16 v[100:103], a[12:15], a[132:135], v[100:103]
    v_mfma_f32_16x16x32_bf16 v[104:107], a[16:19], a[128:131], v[104:107]
    ds_read_b64_tr_b16 a[140:141], v7 offset:16384
    v_mfma_f32_16x16x32_bf16 v[104:107], a[20:23], a[132:135], v[104:107]
    ds_read_b128 a[84:87], v3 offset:36864
    v_mfma_f32_16x16x32_bf16 v[108:111], a[24:27], a[128:131], v[108:111]
    ds_read_b64_tr_b16 a[142:143], v7 offset:18432
    v_mfma_f32_16x16x32_bf16 v[108:111], a[28:31], a[132:135], v[108:111]
    v_mfma_f32_16x16x32_bf16 v[112:115], a[32:35], a[128:131], v[112:115]
    v_mfma_f32_16x16x32_bf16 v[112:115], a[36:39], a[132:135], v[112:115]
    v_mfma_f32_16x16x32_bf16 v[116:119], a[40:43], a[128:131], v[116:119]
    v_mfma_f32_16x16x32_bf16 v[116:119], a[44:47], a[132:135], v[116:119]
    ds_read_b128 a[88:91], v2 offset:38912
    v_mfma_f32_16x16x32_bf16 v[120:123], a[48:51], a[128:131], v[120:123]
    v_mfma_f32_16x16x32_bf16 v[120:123], a[52:55], a[132:135], v[120:123]
    v_mfma_f32_16x16x32_bf16 v[124:127], a[56:59], a[128:131], v[124:127]
    v_mfma_f32_16x16x32_bf16 v[124:127], a[60:63], a[132:135], v[124:127]
    s_waitcnt lgkmcnt(4)
    ds_read_b128 a[92:95], v3 offset:38912
    v_mfma_f32_16x16x32_bf16 v[128:131], a[0:3], a[136:139], v[128:131]
    s_waitcnt lgkmcnt(2)
    ds_read_b64_tr_b16 a[128:129], v8 offset:0
    v_mfma_f32_16x16x32_bf16 v[128:131], a[4:7], a[140:143], v[128:131]
    v_mfma_f32_16x16x32_bf16 v[132:135], a[8:11], a[136:139], v[132:135]
    ds_read_b64_tr_b16 a[130:131], v8 offset:2048
    v_mfma_f32_16x16x32_bf16 v[132:135], a[12:15], a[140:143], v[132:135]
    v_mfma_f32_16x16x32_bf16 v[136:139], a[16:19], a[136:139], v[136:139]
    ds_read_b64_tr_b16 a[132:133], v8 offset:16384
    v_mfma_f32_16x16x32_bf16 v[136:139], a[20:23], a[140:143], v[136:139]
    v_mfma_f32_16x16x32_bf16 v[140:143], a[24:27], a[136:139], v[140:143]
    ds_read_b64_tr_b16 a[134:135], v8 offset:18432
    v_mfma_f32_16x16x32_bf16 v[140:143], a[28:31], a[140:143], v[140:143]
    v_mfma_f32_16x16x32_bf16 v[144:147], a[32:35], a[136:139], v[144:147]
    ds_read_b128 a[96:99], v2 offset:40960
    v_mfma_f32_16x16x32_bf16 v[144:147], a[36:39], a[140:143], v[144:147]
    v_mfma_f32_16x16x32_bf16 v[148:151], a[40:43], a[136:139], v[148:151]
    v_mfma_f32_16x16x32_bf16 v[148:151], a[44:47], a[140:143], v[148:151]
    v_mfma_f32_16x16x32_bf16 v[152:155], a[48:51], a[136:139], v[152:155]
    v_mfma_f32_16x16x32_bf16 v[152:155], a[52:55], a[140:143], v[152:155]
    ds_read_b128 a[100:103], v3 offset:40960
    v_mfma_f32_16x16x32_bf16 v[156:159], a[56:59], a[136:139], v[156:159]
    v_mfma_f32_16x16x32_bf16 v[156:159], a[60:63], a[140:143], v[156:159]
    s_waitcnt lgkmcnt(4)
    v_mfma_f32_16x16x32_bf16 v[160:163], a[0:3], a[128:131], v[160:163]
    s_waitcnt lgkmcnt(2)
    ds_read_b64_tr_b16 a[136:137], v9 offset:0
    v_mfma_f32_16x16x32_bf16 v[160:163], a[4:7], a[132:135], v[160:163]
    v_mfma_f32_16x16x32_bf16 v[164:167], a[8:11], a[128:131], v[164:167]
    ds_read_b64_tr_b16 a[138:139], v9 offset:2048
    v_mfma_f32_16x16x32_bf16 v[164:167], a[12:15], a[132:135], v[164:167]
    ds_read_b128 a[104:107], v2 offset:43008
    v_mfma_f32_16x16x32_bf16 v[168:171], a[16:19], a[128:131], v[168:171]
    ds_read_b64_tr_b16 a[140:141], v9 offset:16384
    v_mfma_f32_16x16x32_bf16 v[168:171], a[20:23], a[132:135], v[168:171]
    v_mfma_f32_16x16x32_bf16 v[172:175], a[24:27], a[128:131], v[172:175]
    ds_read_b64_tr_b16 a[142:143], v9 offset:18432
    v_mfma_f32_16x16x32_bf16 v[172:175], a[28:31], a[132:135], v[172:175]
    v_mfma_f32_16x16x32_bf16 v[176:179], a[32:35], a[128:131], v[176:179]
    v_mfma_f32_16x16x32_bf16 v[176:179], a[36:39], a[132:135], v[176:179]
    v_mfma_f32_16x16x32_bf16 v[180:183], a[40:43], a[128:131], v[180:183]
    ds_read_b128 a[108:111], v3 offset:43008
    v_mfma_f32_16x16x32_bf16 v[180:183], a[44:47], a[132:135], v[180:183]
    v_mfma_f32_16x16x32_bf16 v[184:187], a[48:51], a[128:131], v[184:187]
    v_mfma_f32_16x16x32_bf16 v[184:187], a[52:55], a[132:135], v[184:187]
    v_mfma_f32_16x16x32_bf16 v[188:191], a[56:59], a[128:131], v[188:191]
    ds_read_b128 a[112:115], v2 offset:45056
    v_mfma_f32_16x16x32_bf16 v[188:191], a[60:63], a[132:135], v[188:191]
    s_waitcnt lgkmcnt(5)
    v_mfma_f32_16x16x32_bf16 v[192:195], a[0:3], a[136:139], v[192:195]
    s_waitcnt lgkmcnt(2)
    ds_read_b64_tr_b16 a[128:129], v10 offset:0
    v_mfma_f32_16x16x32_bf16 v[192:195], a[4:7], a[140:143], v[192:195]
    v_mfma_f32_16x16x32_bf16 v[196:199], a[8:11], a[136:139], v[196:199]
    ds_read_b64_tr_b16 a[130:131], v10 offset:2048
    v_mfma_f32_16x16x32_bf16 v[196:199], a[12:15], a[140:143], v[196:199]
    v_mfma_f32_16x16x32_bf16 v[200:203], a[16:19], a[136:139], v[200:203]
    ds_read_b64_tr_b16 a[132:133], v10 offset:16384
    v_mfma_f32_16x16x32_bf16 v[200:203], a[20:23], a[140:143], v[200:203]
    v_mfma_f32_16x16x32_bf16 v[204:207], a[24:27], a[136:139], v[204:207]
    ds_read_b64_tr_b16 a[134:135], v10 offset:18432
    v_mfma_f32_16x16x32_bf16 v[204:207], a[28:31], a[140:143], v[204:207]
    ds_read_b128 a[116:119], v3 offset:45056
    v_mfma_f32_16x16x32_bf16 v[208:211], a[32:35], a[136:139], v[208:211]
    v_mfma_f32_16x16x32_bf16 v[208:211], a[36:39], a[140:143], v[208:211]
    v_mfma_f32_16x16x32_bf16 v[212:215], a[40:43], a[136:139], v[212:215]
    v_mfma_f32_16x16x32_bf16 v[212:215], a[44:47], a[140:143], v[212:215]
    ds_read_b128 a[120:123], v2 offset:47104
    v_mfma_f32_16x16x32_bf16 v[216:219], a[48:51], a[136:139], v[216:219]
    v_mfma_f32_16x16x32_bf16 v[216:219], a[52:55], a[140:143], v[216:219]
    v_mfma_f32_16x16x32_bf16 v[220:223], a[56:59], a[136:139], v[220:223]
    v_mfma_f32_16x16x32_bf16 v[220:223], a[60:63], a[140:143], v[220:223]
    s_waitcnt lgkmcnt(4)
    v_mfma_f32_16x16x32_bf16 v[224:227], a[0:3], a[128:131], v[224:227]
    s_waitcnt lgkmcnt(2)
    ds_read_b64_tr_b16 a[136:137], v11 offset:0
    v_mfma_f32_16x16x32_bf16 v[224:227], a[4:7], a[132:135], v[224:227]
    ds_read_b128 a[124:127], v3 offset:47104
    v_mfma_f32_16x16x32_bf16 v[228:231], a[8:11], a[128:131], v[228:231]
    ds_read_b64_tr_b16 a[138:139], v11 offset:2048
    v_mfma_f32_16x16x32_bf16 v[228:231], a[12:15], a[132:135], v[228:231]
    v_mfma_f32_16x16x32_bf16 v[232:235], a[16:19], a[128:131], v[232:235]
    ds_read_b64_tr_b16 a[140:141], v11 offset:16384
    v_mfma_f32_16x16x32_bf16 v[232:235], a[20:23], a[132:135], v[232:235]
    v_mfma_f32_16x16x32_bf16 v[236:239], a[24:27], a[128:131], v[236:239]
    ds_read_b64_tr_b16 a[142:143], v11 offset:18432
    v_mfma_f32_16x16x32_bf16 v[236:239], a[28:31], a[132:135], v[236:239]
    v_mfma_f32_16x16x32_bf16 v[240:243], a[32:35], a[128:131], v[240:243]
    v_mfma_f32_16x16x32_bf16 v[240:243], a[36:39], a[132:135], v[240:243]
    v_mfma_f32_16x16x32_bf16 v[244:247], a[40:43], a[128:131], v[244:247]
    v_mfma_f32_16x16x32_bf16 v[244:247], a[44:47], a[132:135], v[244:247]
    v_mfma_f32_16x16x32_bf16 v[248:251], a[48:51], a[128:131], v[248:251]
    v_mfma_f32_16x16x32_bf16 v[248:251], a[52:55], a[132:135], v[248:251]
    v_mfma_f32_16x16x32_bf16 v[252:255], a[56:59], a[128:131], v[252:255]
    v_mfma_f32_16x16x32_bf16 v[252:255], a[60:63], a[132:135], v[252:255]
    s_waitcnt vmcnt(0) lgkmcnt(0)
    s_barrier
    v_mfma_f32_16x16x32_bf16 a[224:227], a[0:3], a[136:139], a[224:227]
    ds_read_b64_tr_b16 a[128:129], v4 offset:32768
    v_mfma_f32_16x16x32_bf16 a[224:227], a[4:7], a[140:143], a[224:227]
    v_mfma_f32_16x16x32_bf16 a[228:231], a[8:11], a[136:139], a[228:231]
    ds_read_b64_tr_b16 a[130:131], v4 offset:34816
    v_mfma_f32_16x16x32_bf16 a[228:231], a[12:15], a[140:143], a[228:231]
    v_mfma_f32_16x16x32_bf16 a[232:235], a[16:19], a[136:139], a[232:235]
    ds_read_b64_tr_b16 a[132:133], v4 offset:49152
    v_mfma_f32_16x16x32_bf16 a[232:235], a[20:23], a[140:143], a[232:235]
    v_mfma_f32_16x16x32_bf16 a[236:239], a[24:27], a[136:139], a[236:239]
    ds_read_b64_tr_b16 a[134:135], v4 offset:51200
    v_mfma_f32_16x16x32_bf16 a[236:239], a[28:31], a[140:143], a[236:239]
    v_mfma_f32_16x16x32_bf16 a[240:243], a[32:35], a[136:139], a[240:243]
    v_mfma_f32_16x16x32_bf16 a[240:243], a[36:39], a[140:143], a[240:243]
    v_mfma_f32_16x16x32_bf16 a[244:247], a[40:43], a[136:139], a[244:247]
    v_mfma_f32_16x16x32_bf16 a[244:247], a[44:47], a[140:143], a[244:247]
    v_mfma_f32_16x16x32_bf16 a[248:251], a[48:51], a[136:139], a[248:251]
    v_mfma_f32_16x16x32_bf16 a[248:251], a[52:55], a[140:143], a[248:251]
    v_mfma_f32_16x16x32_bf16 a[252:255], a[56:59], a[136:139], a[252:255]
    v_mfma_f32_16x16x32_bf16 a[252:255], a[60:63], a[140:143], a[252:255]
    s_waitcnt lgkmcnt(2)
    v_mfma_f32_16x16x32_bf16 v[32:35], a[64:67], a[128:131], v[32:35]
    s_waitcnt lgkmcnt(0)
    ds_read_b64_tr_b16 a[136:137], v5 offset:32768
    v_mfma_f32_16x16x32_bf16 v[32:35], a[68:71], a[132:135], v[32:35]
    v_mfma_f32_16x16x32_bf16 v[36:39], a[72:75], a[128:131], v[36:39]
    ds_read_b64_tr_b16 a[138:139], v5 offset:34816
    v_mfma_f32_16x16x32_bf16 v[36:39], a[76:79], a[132:135], v[36:39]
    v_mfma_f32_16x16x32_bf16 v[40:43], a[80:83], a[128:131], v[40:43]
    ds_read_b64_tr_b16 a[140:141], v5 offset:49152
    v_mfma_f32_16x16x32_bf16 v[40:43], a[84:87], a[132:135], v[40:43]
    v_mfma_f32_16x16x32_bf16 v[44:47], a[88:91], a[128:131], v[44:47]
    ds_read_b64_tr_b16 a[142:143], v5 offset:51200
    v_mfma_f32_16x16x32_bf16 v[44:47], a[92:95], a[132:135], v[44:47]
    v_mfma_f32_16x16x32_bf16 v[48:51], a[96:99], a[128:131], v[48:51]
    v_mfma_f32_16x16x32_bf16 v[48:51], a[100:103], a[132:135], v[48:51]
    v_mfma_f32_16x16x32_bf16 v[52:55], a[104:107], a[128:131], v[52:55]
    v_mfma_f32_16x16x32_bf16 v[52:55], a[108:111], a[132:135], v[52:55]
    v_mfma_f32_16x16x32_bf16 v[56:59], a[112:115], a[128:131], v[56:59]
    v_mfma_f32_16x16x32_bf16 v[56:59], a[116:119], a[132:135], v[56:59]
    v_mfma_f32_16x16x32_bf16 v[60:63], a[120:123], a[128:131], v[60:63]
    v_mfma_f32_16x16x32_bf16 v[60:63], a[124:127], a[132:135], v[60:63]
    s_waitcnt lgkmcnt(2)
    v_mfma_f32_16x16x32_bf16 v[64:67], a[64:67], a[136:139], v[64:67]
    s_waitcnt lgkmcnt(0)
    ds_read_b64_tr_b16 a[128:129], v6 offset:32768
    v_mfma_f32_16x16x32_bf16 v[64:67], a[68:71], a[140:143], v[64:67]
    v_mfma_f32_16x16x32_bf16 v[68:71], a[72:75], a[136:139], v[68:71]
    ds_read_b64_tr_b16 a[130:131], v6 offset:34816
    v_mfma_f32_16x16x32_bf16 v[68:71], a[76:79], a[140:143], v[68:71]
    v_mfma_f32_16x16x32_bf16 v[72:75], a[80:83], a[136:139], v[72:75]
    ds_read_b64_tr_b16 a[132:133], v6 offset:49152
    v_mfma_f32_16x16x32_bf16 v[72:75], a[84:87], a[140:143], v[72:75]
    v_mfma_f32_16x16x32_bf16 v[76:79], a[88:91], a[136:139], v[76:79]
    ds_read_b64_tr_b16 a[134:135], v6 offset:51200
    v_mfma_f32_16x16x32_bf16 v[76:79], a[92:95], a[140:143], v[76:79]
    v_mfma_f32_16x16x32_bf16 v[80:83], a[96:99], a[136:139], v[80:83]
    v_mfma_f32_16x16x32_bf16 v[80:83], a[100:103], a[140:143], v[80:83]
    v_mfma_f32_16x16x32_bf16 v[84:87], a[104:107], a[136:139], v[84:87]
    v_mfma_f32_16x16x32_bf16 v[84:87], a[108:111], a[140:143], v[84:87]
    v_mfma_f32_16x16x32_bf16 v[88:91], a[112:115], a[136:139], v[88:91]
    v_mfma_f32_16x16x32_bf16 v[88:91], a[116:119], a[140:143], v[88:91]
    v_mfma_f32_16x16x32_bf16 v[92:95], a[120:123], a[136:139], v[92:95]
    v_mfma_f32_16x16x32_bf16 v[92:95], a[124:127], a[140:143], v[92:95]
    s_waitcnt lgkmcnt(2)
    v_mfma_f32_16x16x32_bf16 v[96:99], a[64:67], a[128:131], v[96:99]
    s_waitcnt lgkmcnt(0)
    ds_read_b64_tr_b16 a[136:137], v7 offset:32768
    v_mfma_f32_16x16x32_bf16 v[96:99], a[68:71], a[132:135], v[96:99]
    v_mfma_f32_16x16x32_bf16 v[100:103], a[72:75], a[128:131], v[100:103]
    ds_read_b64_tr_b16 a[138:139], v7 offset:34816
    v_mfma_f32_16x16x32_bf16 v[100:103], a[76:79], a[132:135], v[100:103]
    v_mfma_f32_16x16x32_bf16 v[104:107], a[80:83], a[128:131], v[104:107]
    ds_read_b64_tr_b16 a[140:141], v7 offset:49152
    v_mfma_f32_16x16x32_bf16 v[104:107], a[84:87], a[132:135], v[104:107]
    v_mfma_f32_16x16x32_bf16 v[108:111], a[88:91], a[128:131], v[108:111]
    ds_read_b64_tr_b16 a[142:143], v7 offset:51200
    v_mfma_f32_16x16x32_bf16 v[108:111], a[92:95], a[132:135], v[108:111]
    v_mfma_f32_16x16x32_bf16 v[112:115], a[96:99], a[128:131], v[112:115]
    v_mfma_f32_16x16x32_bf16 v[112:115], a[100:103], a[132:135], v[112:115]
    v_mfma_f32_16x16x32_bf16 v[116:119], a[104:107], a[128:131], v[116:119]
    v_mfma_f32_16x16x32_bf16 v[116:119], a[108:111], a[132:135], v[116:119]
    v_mfma_f32_16x16x32_bf16 v[120:123], a[112:115], a[128:131], v[120:123]
    v_mfma_f32_16x16x32_bf16 v[120:123], a[116:119], a[132:135], v[120:123]
    v_mfma_f32_16x16x32_bf16 v[124:127], a[120:123], a[128:131], v[124:127]
    v_mfma_f32_16x16x32_bf16 v[124:127], a[124:127], a[132:135], v[124:127]
    s_waitcnt lgkmcnt(2)
    v_mfma_f32_16x16x32_bf16 v[128:131], a[64:67], a[136:139], v[128:131]
    s_waitcnt lgkmcnt(0)
    ds_read_b64_tr_b16 a[128:129], v8 offset:32768
    v_mfma_f32_16x16x32_bf16 v[128:131], a[68:71], a[140:143], v[128:131]
    v_mfma_f32_16x16x32_bf16 v[132:135], a[72:75], a[136:139], v[132:135]
    ds_read_b64_tr_b16 a[130:131], v8 offset:34816
    v_mfma_f32_16x16x32_bf16 v[132:135], a[76:79], a[140:143], v[132:135]
    v_mfma_f32_16x16x32_bf16 v[136:139], a[80:83], a[136:139], v[136:139]
    ds_read_b64_tr_b16 a[132:133], v8 offset:49152
    v_mfma_f32_16x16x32_bf16 v[136:139], a[84:87], a[140:143], v[136:139]
    v_mfma_f32_16x16x32_bf16 v[140:143], a[88:91], a[136:139], v[140:143]
    ds_read_b64_tr_b16 a[134:135], v8 offset:51200
    v_mfma_f32_16x16x32_bf16 v[140:143], a[92:95], a[140:143], v[140:143]
    v_mfma_f32_16x16x32_bf16 v[144:147], a[96:99], a[136:139], v[144:147]
    v_mfma_f32_16x16x32_bf16 v[144:147], a[100:103], a[140:143], v[144:147]
    v_mfma_f32_16x16x32_bf16 v[148:151], a[104:107], a[136:139], v[148:151]
    v_mfma_f32_16x16x32_bf16 v[148:151], a[108:111], a[140:143], v[148:151]
    v_mfma_f32_16x16x32_bf16 v[152:155], a[112:115], a[136:139], v[152:155]
    v_mfma_f32_16x16x32_bf16 v[152:155], a[116:119], a[140:143], v[152:155]
    v_mfma_f32_16x16x32_bf16 v[156:159], a[120:123], a[136:139], v[156:159]
    v_mfma_f32_16x16x32_bf16 v[156:159], a[124:127], a[140:143], v[156:159]
    s_waitcnt lgkmcnt(2)
    v_mfma_f32_16x16x32_bf16 v[160:163], a[64:67], a[128:131], v[160:163]
    s_waitcnt lgkmcnt(0)
    ds_read_b64_tr_b16 a[136:137], v9 offset:32768
    v_mfma_f32_16x16x32_bf16 v[160:163], a[68:71], a[132:135], v[160:163]
    v_mfma_f32_16x16x32_bf16 v[164:167], a[72:75], a[128:131], v[164:167]
    ds_read_b64_tr_b16 a[138:139], v9 offset:34816
    v_mfma_f32_16x16x32_bf16 v[164:167], a[76:79], a[132:135], v[164:167]
    v_mfma_f32_16x16x32_bf16 v[168:171], a[80:83], a[128:131], v[168:171]
    ds_read_b64_tr_b16 a[140:141], v9 offset:49152
    v_mfma_f32_16x16x32_bf16 v[168:171], a[84:87], a[132:135], v[168:171]
    v_mfma_f32_16x16x32_bf16 v[172:175], a[88:91], a[128:131], v[172:175]
    ds_read_b64_tr_b16 a[142:143], v9 offset:51200
    v_mfma_f32_16x16x32_bf16 v[172:175], a[92:95], a[132:135], v[172:175]
    v_mfma_f32_16x16x32_bf16 v[176:179], a[96:99], a[128:131], v[176:179]
    v_mfma_f32_16x16x32_bf16 v[176:179], a[100:103], a[132:135], v[176:179]
    v_mfma_f32_16x16x32_bf16 v[180:183], a[104:107], a[128:131], v[180:183]
    v_mfma_f32_16x16x32_bf16 v[180:183], a[108:111], a[132:135], v[180:183]
    v_mfma_f32_16x16x32_bf16 v[184:187], a[112:115], a[128:131], v[184:187]
    v_mfma_f32_16x16x32_bf16 v[184:187], a[116:119], a[132:135], v[184:187]
    v_mfma_f32_16x16x32_bf16 v[188:191], a[120:123], a[128:131], v[188:191]
    v_mfma_f32_16x16x32_bf16 v[188:191], a[124:127], a[132:135], v[188:191]
    s_waitcnt lgkmcnt(2)
    v_mfma_f32_16x16x32_bf16 v[192:195], a[64:67], a[136:139], v[192:195]
    s_waitcnt lgkmcnt(0)
    ds_read_b64_tr_b16 a[128:129], v10 offset:32768
    v_mfma_f32_16x16x32_bf16 v[192:195], a[68:71], a[140:143], v[192:195]
    v_mfma_f32_16x16x32_bf16 v[196:199], a[72:75], a[136:139], v[196:199]
    ds_read_b64_tr_b16 a[130:131], v10 offset:34816
    v_mfma_f32_16x16x32_bf16 v[196:199], a[76:79], a[140:143], v[196:199]
    v_mfma_f32_16x16x32_bf16 v[200:203], a[80:83], a[136:139], v[200:203]
    ds_read_b64_tr_b16 a[132:133], v10 offset:49152
    v_mfma_f32_16x16x32_bf16 v[200:203], a[84:87], a[140:143], v[200:203]
    v_mfma_f32_16x16x32_bf16 v[204:207], a[88:91], a[136:139], v[204:207]
    ds_read_b64_tr_b16 a[134:135], v10 offset:51200
    v_mfma_f32_16x16x32_bf16 v[204:207], a[92:95], a[140:143], v[204:207]
    v_mfma_f32_16x16x32_bf16 v[208:211], a[96:99], a[136:139], v[208:211]
    v_mfma_f32_16x16x32_bf16 v[208:211], a[100:103], a[140:143], v[208:211]
    v_mfma_f32_16x16x32_bf16 v[212:215], a[104:107], a[136:139], v[212:215]
    v_mfma_f32_16x16x32_bf16 v[212:215], a[108:111], a[140:143], v[212:215]
    v_mfma_f32_16x16x32_bf16 v[216:219], a[112:115], a[136:139], v[216:219]
    v_mfma_f32_16x16x32_bf16 v[216:219], a[116:119], a[140:143], v[216:219]
    v_mfma_f32_16x16x32_bf16 v[220:223], a[120:123], a[136:139], v[220:223]
    v_mfma_f32_16x16x32_bf16 v[220:223], a[124:127], a[140:143], v[220:223]
    s_waitcnt lgkmcnt(2)
    v_mfma_f32_16x16x32_bf16 v[224:227], a[64:67], a[128:131], v[224:227]
    s_waitcnt lgkmcnt(0)
    ds_read_b64_tr_b16 a[136:137], v11 offset:32768
    v_mfma_f32_16x16x32_bf16 v[224:227], a[68:71], a[132:135], v[224:227]
    v_mfma_f32_16x16x32_bf16 v[228:231], a[72:75], a[128:131], v[228:231]
    ds_read_b64_tr_b16 a[138:139], v11 offset:34816
    v_mfma_f32_16x16x32_bf16 v[228:231], a[76:79], a[132:135], v[228:231]
    v_mfma_f32_16x16x32_bf16 v[232:235], a[80:83], a[128:131], v[232:235]
    ds_read_b64_tr_b16 a[140:141], v11 offset:49152
    v_mfma_f32_16x16x32_bf16 v[232:235], a[84:87], a[132:135], v[232:235]
    v_mfma_f32_16x16x32_bf16 v[236:239], a[88:91], a[128:131], v[236:239]
    ds_read_b64_tr_b16 a[142:143], v11 offset:51200
    v_mfma_f32_16x16x32_bf16 v[236:239], a[92:95], a[132:135], v[236:239]
    v_mfma_f32_16x16x32_bf16 v[240:243], a[96:99], a[128:131], v[240:243]
    v_mfma_f32_16x16x32_bf16 v[240:243], a[100:103], a[132:135], v[240:243]
    v_mfma_f32_16x16x32_bf16 v[244:247], a[104:107], a[128:131], v[244:247]
    v_mfma_f32_16x16x32_bf16 v[244:247], a[108:111], a[132:135], v[244:247]
    v_mfma_f32_16x16x32_bf16 v[248:251], a[112:115], a[128:131], v[248:251]
    v_mfma_f32_16x16x32_bf16 v[248:251], a[116:119], a[132:135], v[248:251]
    v_mfma_f32_16x16x32_bf16 v[252:255], a[120:123], a[128:131], v[252:255]
    v_mfma_f32_16x16x32_bf16 v[252:255], a[124:127], a[132:135], v[252:255]
    s_waitcnt lgkmcnt(2)
    v_mfma_f32_16x16x32_bf16 a[224:227], a[64:67], a[136:139], a[224:227]
    s_waitcnt lgkmcnt(0)
    v_mfma_f32_16x16x32_bf16 a[224:227], a[68:71], a[140:143], a[224:227]
    v_mfma_f32_16x16x32_bf16 a[228:231], a[72:75], a[136:139], a[228:231]
    v_mfma_f32_16x16x32_bf16 a[228:231], a[76:79], a[140:143], a[228:231]
    v_mfma_f32_16x16x32_bf16 a[232:235], a[80:83], a[136:139], a[232:235]
    v_mfma_f32_16x16x32_bf16 a[232:235], a[84:87], a[140:143], a[232:235]
    v_mfma_f32_16x16x32_bf16 a[236:239], a[88:91], a[136:139], a[236:239]
    v_mfma_f32_16x16x32_bf16 a[236:239], a[92:95], a[140:143], a[236:239]
    v_mfma_f32_16x16x32_bf16 a[240:243], a[96:99], a[136:139], a[240:243]
    v_mfma_f32_16x16x32_bf16 a[240:243], a[100:103], a[140:143], a[240:243]
    v_mfma_f32_16x16x32_bf16 a[244:247], a[104:107], a[136:139], a[244:247]
    v_mfma_f32_16x16x32_bf16 a[244:247], a[108:111], a[140:143], a[244:247]
    v_mfma_f32_16x16x32_bf16 a[248:251], a[112:115], a[136:139], a[248:251]
    v_mfma_f32_16x16x32_bf16 a[248:251], a[116:119], a[140:143], a[248:251]
    v_mfma_f32_16x16x32_bf16 a[252:255], a[120:123], a[136:139], a[252:255]
    v_mfma_f32_16x16x32_bf16 a[252:255], a[124:127], a[140:143], a[252:255]
    s_lshl_b32 s26, s24, 20
    s_lshl_b32 s27, s25, 17
    s_add_u32 s26, s26, s27
    s_lshr_b32 s27, s23, 1
    s_lshl_b32 s27, s27, 16
    s_add_u32 s26, s26, s27
    s_and_b32 s27, s23, 1
    s_lshl_b32 s27, s27, 14
    s_add_u32 s26, s26, s27
    s_add_u32 s26, s26, 16777216
    v_cvt_pk_bf16_f32 v32, v32, v33
    v_cvt_pk_bf16_f32 v33, v34, v35
    v_cvt_pk_bf16_f32 v34, v36, v37
    v_cvt_pk_bf16_f32 v35, v38, v39
    s_add_u32 s27, s26, 0
    buffer_store_dwordx4 v[32:35], v20, s[12:15], s27 offen offset:0
    v_cvt_pk_bf16_f32 v64, v64, v65
    v_cvt_pk_bf16_f32 v65, v66, v67
    v_cvt_pk_bf16_f32 v66, v68, v69
    v_cvt_pk_bf16_f32 v67, v70, v71
    buffer_store_dwordx4 v[64:67], v20, s[12:15], s27 offen offset:2048
    v_cvt_pk_bf16_f32 v96, v96, v97
    v_cvt_pk_bf16_f32 v97, v98, v99
    v_cvt_pk_bf16_f32 v98, v100, v101
    v_cvt_pk_bf16_f32 v99, v102, v103
    s_add_u32 s27, s26, 4096
    buffer_store_dwordx4 v[96:99], v20, s[12:15], s27 offen offset:0
    v_cvt_pk_bf16_f32 v128, v128, v129
    v_cvt_pk_bf16_f32 v129, v130, v131
    v_cvt_pk_bf16_f32 v130, v132, v133
    v_cvt_pk_bf16_f32 v131, v134, v135
    buffer_store_dwordx4 v[128:131], v20, s[12:15], s27 offen offset:2048
    v_cvt_pk_bf16_f32 v160, v160, v161
    v_cvt_pk_bf16_f32 v161, v162, v163
    v_cvt_pk_bf16_f32 v162, v164, v165
    v_cvt_pk_bf16_f32 v163, v166, v167
    s_add_u32 s27, s26, 8192
    buffer_store_dwordx4 v[160:163], v20, s[12:15], s27 offen offset:0
    v_cvt_pk_bf16_f32 v192, v192, v193
    v_cvt_pk_bf16_f32 v193, v194, v195
    v_cvt_pk_bf16_f32 v194, v196, v197
    v_cvt_pk_bf16_f32 v195, v198, v199
    buffer_store_dwordx4 v[192:195], v20, s[12:15], s27 offen offset:2048
    v_cvt_pk_bf16_f32 v224, v224, v225
    v_cvt_pk_bf16_f32 v225, v226, v227
    v_cvt_pk_bf16_f32 v226, v228, v229
    v_cvt_pk_bf16_f32 v227, v230, v231
    s_add_u32 s27, s26, 12288
    buffer_store_dwordx4 v[224:227], v20, s[12:15], s27 offen offset:0
    v_accvgpr_read_b32 v36, a224
    v_accvgpr_read_b32 v37, a225
    v_accvgpr_read_b32 v38, a226
    v_accvgpr_read_b32 v39, a227
    v_accvgpr_read_b32 v68, a228
    v_accvgpr_read_b32 v69, a229
    v_accvgpr_read_b32 v70, a230
    v_accvgpr_read_b32 v71, a231
    v_cvt_pk_bf16_f32 v36, v36, v37
    v_cvt_pk_bf16_f32 v37, v38, v39
    v_cvt_pk_bf16_f32 v38, v68, v69
    v_cvt_pk_bf16_f32 v39, v70, v71
    buffer_store_dwordx4 v[36:39], v20, s[12:15], s27 offen offset:2048
    v_cvt_pk_bf16_f32 v40, v40, v41
    v_cvt_pk_bf16_f32 v41, v42, v43
    v_cvt_pk_bf16_f32 v42, v44, v45
    v_cvt_pk_bf16_f32 v43, v46, v47
    s_add_u32 s27, s26, 0
    buffer_store_dwordx4 v[40:43], v20, s[12:15], s27 offen offset:1024
    v_cvt_pk_bf16_f32 v72, v72, v73
    v_cvt_pk_bf16_f32 v73, v74, v75
    v_cvt_pk_bf16_f32 v74, v76, v77
    v_cvt_pk_bf16_f32 v75, v78, v79
    buffer_store_dwordx4 v[72:75], v20, s[12:15], s27 offen offset:3072
    v_cvt_pk_bf16_f32 v104, v104, v105
    v_cvt_pk_bf16_f32 v105, v106, v107
    v_cvt_pk_bf16_f32 v106, v108, v109
    v_cvt_pk_bf16_f32 v107, v110, v111
    s_add_u32 s27, s26, 4096
    buffer_store_dwordx4 v[104:107], v20, s[12:15], s27 offen offset:1024
    v_cvt_pk_bf16_f32 v136, v136, v137
    v_cvt_pk_bf16_f32 v137, v138, v139
    v_cvt_pk_bf16_f32 v138, v140, v141
    v_cvt_pk_bf16_f32 v139, v142, v143
    buffer_store_dwordx4 v[136:139], v20, s[12:15], s27 offen offset:3072
    v_cvt_pk_bf16_f32 v168, v168, v169
    v_cvt_pk_bf16_f32 v169, v170, v171
    v_cvt_pk_bf16_f32 v170, v172, v173
    v_cvt_pk_bf16_f32 v171, v174, v175
    s_add_u32 s27, s26, 8192
    buffer_store_dwordx4 v[168:171], v20, s[12:15], s27 offen offset:1024
    v_cvt_pk_bf16_f32 v200, v200, v201
    v_cvt_pk_bf16_f32 v201, v202, v203
    v_cvt_pk_bf16_f32 v202, v204, v205
    v_cvt_pk_bf16_f32 v203, v206, v207
    buffer_store_dwordx4 v[200:203], v20, s[12:15], s27 offen offset:3072
    v_cvt_pk_bf16_f32 v232, v232, v233
    v_cvt_pk_bf16_f32 v233, v234, v235
    v_cvt_pk_bf16_f32 v234, v236, v237
    v_cvt_pk_bf16_f32 v235, v238, v239
    s_add_u32 s27, s26, 12288
    buffer_store_dwordx4 v[232:235], v20, s[12:15], s27 offen offset:1024
    v_accvgpr_read_b32 v44, a232
    v_accvgpr_read_b32 v45, a233
    v_accvgpr_read_b32 v46, a234
    v_accvgpr_read_b32 v47, a235
    v_accvgpr_read_b32 v76, a236
    v_accvgpr_read_b32 v77, a237
    v_accvgpr_read_b32 v78, a238
    v_accvgpr_read_b32 v79, a239
    v_cvt_pk_bf16_f32 v44, v44, v45
    v_cvt_pk_bf16_f32 v45, v46, v47
    v_cvt_pk_bf16_f32 v46, v76, v77
    v_cvt_pk_bf16_f32 v47, v78, v79
    buffer_store_dwordx4 v[44:47], v20, s[12:15], s27 offen offset:3072
    v_cvt_pk_bf16_f32 v48, v48, v49
    v_cvt_pk_bf16_f32 v49, v50, v51
    v_cvt_pk_bf16_f32 v50, v52, v53
    v_cvt_pk_bf16_f32 v51, v54, v55
    s_add_u32 s27, s26, 32768
    buffer_store_dwordx4 v[48:51], v20, s[12:15], s27 offen offset:0
    v_cvt_pk_bf16_f32 v80, v80, v81
    v_cvt_pk_bf16_f32 v81, v82, v83
    v_cvt_pk_bf16_f32 v82, v84, v85
    v_cvt_pk_bf16_f32 v83, v86, v87
    buffer_store_dwordx4 v[80:83], v20, s[12:15], s27 offen offset:2048
    v_cvt_pk_bf16_f32 v112, v112, v113
    v_cvt_pk_bf16_f32 v113, v114, v115
    v_cvt_pk_bf16_f32 v114, v116, v117
    v_cvt_pk_bf16_f32 v115, v118, v119
    s_add_u32 s27, s26, 36864
    buffer_store_dwordx4 v[112:115], v20, s[12:15], s27 offen offset:0
    v_cvt_pk_bf16_f32 v144, v144, v145
    v_cvt_pk_bf16_f32 v145, v146, v147
    v_cvt_pk_bf16_f32 v146, v148, v149
    v_cvt_pk_bf16_f32 v147, v150, v151
    buffer_store_dwordx4 v[144:147], v20, s[12:15], s27 offen offset:2048
    v_cvt_pk_bf16_f32 v176, v176, v177
    v_cvt_pk_bf16_f32 v177, v178, v179
    v_cvt_pk_bf16_f32 v178, v180, v181
    v_cvt_pk_bf16_f32 v179, v182, v183
    s_add_u32 s27, s26, 40960
    buffer_store_dwordx4 v[176:179], v20, s[12:15], s27 offen offset:0
    v_cvt_pk_bf16_f32 v208, v208, v209
    v_cvt_pk_bf16_f32 v209, v210, v211
    v_cvt_pk_bf16_f32 v210, v212, v213
    v_cvt_pk_bf16_f32 v211, v214, v215
    buffer_store_dwordx4 v[208:211], v20, s[12:15], s27 offen offset:2048
    v_cvt_pk_bf16_f32 v240, v240, v241
    v_cvt_pk_bf16_f32 v241, v242, v243
    v_cvt_pk_bf16_f32 v242, v244, v245
    v_cvt_pk_bf16_f32 v243, v246, v247
    s_add_u32 s27, s26, 45056
    buffer_store_dwordx4 v[240:243], v20, s[12:15], s27 offen offset:0
    v_accvgpr_read_b32 v52, a240
    v_accvgpr_read_b32 v53, a241
    v_accvgpr_read_b32 v54, a242
    v_accvgpr_read_b32 v55, a243
    v_accvgpr_read_b32 v84, a244
    v_accvgpr_read_b32 v85, a245
    v_accvgpr_read_b32 v86, a246
    v_accvgpr_read_b32 v87, a247
    v_cvt_pk_bf16_f32 v52, v52, v53
    v_cvt_pk_bf16_f32 v53, v54, v55
    v_cvt_pk_bf16_f32 v54, v84, v85
    v_cvt_pk_bf16_f32 v55, v86, v87
    buffer_store_dwordx4 v[52:55], v20, s[12:15], s27 offen offset:2048
    v_cvt_pk_bf16_f32 v56, v56, v57
    v_cvt_pk_bf16_f32 v57, v58, v59
    v_cvt_pk_bf16_f32 v58, v60, v61
    v_cvt_pk_bf16_f32 v59, v62, v63
    s_add_u32 s27, s26, 32768
    buffer_store_dwordx4 v[56:59], v20, s[12:15], s27 offen offset:1024
    v_cvt_pk_bf16_f32 v88, v88, v89
    v_cvt_pk_bf16_f32 v89, v90, v91
    v_cvt_pk_bf16_f32 v90, v92, v93
    v_cvt_pk_bf16_f32 v91, v94, v95
    buffer_store_dwordx4 v[88:91], v20, s[12:15], s27 offen offset:3072
    v_cvt_pk_bf16_f32 v120, v120, v121
    v_cvt_pk_bf16_f32 v121, v122, v123
    v_cvt_pk_bf16_f32 v122, v124, v125
    v_cvt_pk_bf16_f32 v123, v126, v127
    s_add_u32 s27, s26, 36864
    buffer_store_dwordx4 v[120:123], v20, s[12:15], s27 offen offset:1024
    v_cvt_pk_bf16_f32 v152, v152, v153
    v_cvt_pk_bf16_f32 v153, v154, v155
    v_cvt_pk_bf16_f32 v154, v156, v157
    v_cvt_pk_bf16_f32 v155, v158, v159
    buffer_store_dwordx4 v[152:155], v20, s[12:15], s27 offen offset:3072
    v_cvt_pk_bf16_f32 v184, v184, v185
    v_cvt_pk_bf16_f32 v185, v186, v187
    v_cvt_pk_bf16_f32 v186, v188, v189
    v_cvt_pk_bf16_f32 v187, v190, v191
    s_add_u32 s27, s26, 40960
    buffer_store_dwordx4 v[184:187], v20, s[12:15], s27 offen offset:1024
    v_cvt_pk_bf16_f32 v216, v216, v217
    v_cvt_pk_bf16_f32 v217, v218, v219
    v_cvt_pk_bf16_f32 v218, v220, v221
    v_cvt_pk_bf16_f32 v219, v222, v223
    buffer_store_dwordx4 v[216:219], v20, s[12:15], s27 offen offset:3072
    v_cvt_pk_bf16_f32 v248, v248, v249
    v_cvt_pk_bf16_f32 v249, v250, v251
    v_cvt_pk_bf16_f32 v250, v252, v253
    v_cvt_pk_bf16_f32 v251, v254, v255
    s_add_u32 s27, s26, 45056
    buffer_store_dwordx4 v[248:251], v20, s[12:15], s27 offen offset:1024
    v_accvgpr_read_b32 v60, a248
    v_accvgpr_read_b32 v61, a249
    v_accvgpr_read_b32 v62, a250
    v_accvgpr_read_b32 v63, a251
    v_accvgpr_read_b32 v92, a252
    v_accvgpr_read_b32 v93, a253
    v_accvgpr_read_b32 v94, a254
    v_accvgpr_read_b32 v95, a255
    v_cvt_pk_bf16_f32 v60, v60, v61
    v_cvt_pk_bf16_f32 v61, v62, v63
    v_cvt_pk_bf16_f32 v62, v92, v93
    v_cvt_pk_bf16_f32 v63, v94, v95
    buffer_store_dwordx4 v[60:63], v20, s[12:15], s27 offen offset:3072
K1_Q:
    s_barrier
    v_and_b32 v22, 63, v0
    v_and_b32 v23, 15, v22
    v_lshrrev_b32 v24, 4, v22
    v_lshrrev_b32 v25, 1, v23
    v_xor_b32 v25, v24, v25
    v_lshlrev_b32 v25, 4, v25
    v_lshl_add_u32 v2, v23, 7, v25
    v_xor_b32 v3, 64, v2
    v_lshrrev_b32 v25, 2, v23
    v_and_b32 v26, 1, v24
    v_lshl_or_b32 v26, v26, 2, v25
    v_lshl_add_u32 v25, v24, 3, v25
    v_lshlrev_b32 v25, 9, v25
    v_lshl_add_u32 v25, v26, 5, v25
    v_and_b32 v26, 3, v22
    v_lshl_add_u32 v25, v26, 3, v25
    v_add_u32 v25, 0x10000, v25
    s_lshl_b32 s27, s23, 7
    v_xor_b32 v4, s27, v25
    v_xor_b32 v5, 32, v4
    v_xor_b32 v6, 64, v4
    v_xor_b32 v7, 96, v4
    v_lshrrev_b32 v25, 3, v22
    v_and_b32 v26, 7, v22
    v_lshrrev_b32 v27, 1, v25
    v_xor_b32 v26, v26, v27
    v_lshlrev_b32 v26, 4, v26
    v_mul_u32_u24 v25, 896, v25
    v_add_u32 v12, v25, v26
    v_xor_b32 v26, 64, v26
    v_add_u32 v25, v25, v26
    v_add_u32 v13, 6144, v25
    v_add_u32 v14, 12288, v12
    v_add_u32 v15, 18432, v25
    s_mov_b32 s4, s32
    s_mov_b32 s5, s33
    s_mov_b32 s6, 1835008
    s_mov_b32 s7, 0x20000
    s_mov_b32 s8, s36
    s_mov_b32 s9, s37
    s_mov_b32 s10, 3670016
    s_mov_b32 s11, 0x20000
    s_lshr_b32 s25, s2, 4
    s_lshl_b32 s20, s23, 12
    s_lshl_b32 s16, s25, 2
    s_add_u32 s16, s16, s23
    s_mul_i32 s16, s16, 28672
    s_lshl_b32 s18, s23, 16
    s_lshl_b32 s27, s24, 9
    s_add_u32 s18, s18, s27
    s_add_u32 s19, s18, 262144
    s_add_u32 m0, s20, 0
    s_nop 0
    buffer_load_dwordx4 v12, s[4:7], s16 offen offset:0 lds
    buffer_load_dwordx4 v13, s[4:7], s16 offen offset:1024 lds
    buffer_load_dwordx4 v14, s[4:7], s16 offen offset:2048 lds
    buffer_load_dwordx4 v15, s[4:7], s16 offen offset:3072 lds
    s_add_u32 s16, s16, 128
    s_add_u32 m0, s21, 65536
    s_nop 0
    buffer_load_dwordx4 v16, s[8:11], s18 offen offset:0 lds
    buffer_load_dwordx4 v17, s[8:11], s18 offen offset:1024 lds
    buffer_load_dwordx4 v18, s[8:11], s18 offen offset:2048 lds
    buffer_load_dwordx4 v19, s[8:11], s18 offen offset:3072 lds
    s_add_u32 s18, s18, 524288
    s_add_u32 m0, s21, 81920
    s_nop 0
    buffer_load_dwordx4 v16, s[8:11], s19 offen offset:0 lds
    buffer_load_dwordx4 v17, s[8:11], s19 offen offset:1024 lds
    buffer_load_dwordx4 v18, s[8:11], s19 offen offset:2048 lds
    buffer_load_dwordx4 v19, s[8:11], s19 offen offset:3072 lds
    s_add_u32 s19, s19, 524288
    s_add_u32 m0, s20, 32768
    s_nop 0
    buffer_load_dwordx4 v12, s[4:7], s16 offen offset:0 lds
    buffer_load_dwordx4 v13, s[4:7], s16 offen offset:1024 lds
    buffer_load_dwordx4 v14, s[4:7], s16 offen offset:2048 lds
    buffer_load_dwordx4 v15, s[4:7], s16 offen offset:3072 lds
    s_add_u32 s16, s16, 128
    s_add_u32 m0, s21, 98304
    s_nop 0
    buffer_load_dwordx4 v16, s[8:11], s18 offen offset:0 lds
    buffer_load_dwordx4 v17, s[8:11], s18 offen offset:1024 lds
    buffer_load_dwordx4 v18, s[8:11], s18 offen offset:2048 lds
    buffer_load_dwordx4 v19, s[8:11], s18 offen offset:3072 lds
    s_add_u32 s18, s18, 524288
    s_waitcnt vmcnt(8)
    s_barrier
    ds_read_b128 a[0:3], v2 offset:0
    ds_read_b128 a[4:7], v3 offset:0
    ds_read_b128 a[8:11], v2 offset:2048
    ds_read_b128 a[12:15], v3 offset:2048
    ds_read_b128 a[16:19], v2 offset:4096
    ds_read_b128 a[20:23], v3 offset:4096
    ds_read_b128 a[24:27], v2 offset:6144
    ds_read_b128 a[28:31], v3 offset:6144
    ds_read_b128 a[32:35], v2 offset:8192
    ds_read_b128 a[36:39], v3 offset:8192
    ds_read_b128 a[40:43], v2 offset:10240
    ds_read_b128 a[44:47], v3 offset:10240
    ds_read_b128 a[48:51], v2 offset:12288
    ds_read_b128 a[52:55], v3 offset:12288
    ds_read_b128 a[56:59], v2 offset:14336
    ds_read_b128 a[60:63], v3 offset:14336
    ds_read_b64_tr_b16 a[128:129], v4 offset:0
    ds_read_b64_tr_b16 a[130:131], v4 offset:2048
    ds_read_b64_tr_b16 a[132:133], v4 offset:16384
    ds_read_b64_tr_b16 a[134:135], v4 offset:18432
    s_waitcnt vmcnt(4) lgkmcnt(0)
    s_barrier
    s_mov_b32 s22, 2
    v_mfma_f32_16x16x32_bf16 v[32:35], a[128:131], a[0:3], 0
    s_add_u32 m0, s21, 114688
    ds_read_b64_tr_b16 a[136:137], v5 offset:0
    v_mfma_f32_16x16x32_bf16 v[32:35], a[132:135], a[4:7], v[32:35]
    buffer_load_dwordx4 v16, s[8:11], s19 offen offset:0 lds
    v_mfma_f32_16x16x32_bf16 v[36:39], a[128:131], a[8:11], 0
    ds_read_b64_tr_b16 a[138:139], v5 offset:2048
    v_mfma_f32_16x16x32_bf16 v[36:39], a[132:135], a[12:15], v[36:39]
    ds_read_b128 a[64:67], v2 offset:32768
    v_mfma_f32_16x16x32_bf16 v[40:43], a[128:131], a[16:19], 0
    ds_read_b64_tr_b16 a[140:141], v5 offset:16384
    v_mfma_f32_16x16x32_bf16 v[40:43], a[132:135], a[20:23], v[40:43]
    buffer_load_dwordx4 v17, s[8:11], s19 offen offset:1024 lds
    v_mfma_f32_16x16x32_bf16 v[44:47], a[128:131], a[24:27], 0
    ds_read_b64_tr_b16 a[142:143], v5 offset:18432
    v_mfma_f32_16x16x32_bf16 v[44:47], a[132:135], a[28:31], v[44:47]
    ds_read_b128 a[68:71], v3 offset:32768
    v_mfma_f32_16x16x32_bf16 v[48:51], a[128:131], a[32:35], 0
    ds_read_b128 a[72:75], v2 offset:34816
    v_mfma_f32_16x16x32_bf16 v[48:51], a[132:135], a[36:39], v[48:51]
    buffer_load_dwordx4 v18, s[8:11], s19 offen offset:2048 lds
    v_mfma_f32_16x16x32_bf16 v[52:55], a[128:131], a[40:43], 0
    ds_read_b128 a[76:79], v3 offset:34816
    v_mfma_f32_16x16x32_bf16 v[52:55], a[132:135], a[44:47], v[52:55]
    v_mfma_f32_16x16x32_bf16 v[56:59], a[128:131], a[48:51], 0
    ds_read_b128 a[80:83], v2 offset:36864
    v_mfma_f32_16x16x32_bf16 v[56:59], a[132:135], a[52:55], v[56:59]
    buffer_load_dwordx4 v19, s[8:11], s19 offen offset:3072 lds
    v_mfma_f32_16x16x32_bf16 v[60:63], a[128:131], a[56:59], 0
    s_add_u32 s19, s19, 524288
    ds_read_b128 a[84:87], v3 offset:36864
    v_mfma_f32_16x16x32_bf16 v[60:63], a[132:135], a[60:63], v[60:63]
    s_waitcnt lgkmcnt(8)
    ds_read_b128 a[88:91], v2 offset:38912
    v_mfma_f32_16x16x32_bf16 v[64:67], a[136:139], a[0:3], 0
    s_waitcnt lgkmcnt(6)
    s_add_u32 m0, s20, 0
    ds_read_b64_tr_b16 a[128:129], v6 offset:0
    v_mfma_f32_16x16x32_bf16 v[64:67], a[140:143], a[4:7], v[64:67]
    buffer_load_dwordx4 v12, s[4:7], s16 offen offset:0 lds
    v_mfma_f32_16x16x32_bf16 v[68:71], a[136:139], a[8:11], 0
    ds_read_b64_tr_b16 a[130:131], v6 offset:2048
    v_mfma_f32_16x16x32_bf16 v[68:71], a[140:143], a[12:15], v[68:71]
    v_mfma_f32_16x16x32_bf16 v[72:75], a[136:139], a[16:19], 0
    ds_read_b64_tr_b16 a[132:133], v6 offset:16384
    v_mfma_f32_16x16x32_bf16 v[72:75], a[140:143], a[20:23], v[72:75]
    buffer_load_dwordx4 v13, s[4:7], s16 offen offset:1024 lds
    v_mfma_f32_16x16x32_bf16 v[76:79], a[136:139], a[24:27], 0
    ds_read_b64_tr_b16 a[134:135], v6 offset:18432
    v_mfma_f32_16x16x32_bf16 v[76:79], a[140:143], a[28:31], v[76:79]
    ds_read_b128 a[92:95], v3 offset:38912
    v_mfma_f32_16x16x32_bf16 v[80:83], a[136:139], a[32:35], 0
    ds_read_b128 a[96:99], v2 offset:40960
    v_mfma_f32_16x16x32_bf16 v[80:83], a[140:143], a[36:39], v[80:83]
    buffer_load_dwordx4 v14, s[4:7], s16 offen offset:2048 lds
    v_mfma_f32_16x16x32_bf16 v[84:87], a[136:139], a[40:43], 0
    ds_read_b128 a[100:103], v3 offset:40960
    v_mfma_f32_16x16x32_bf16 v[84:87], a[140:143], a[44:47], v[84:87]
    v_mfma_f32_16x16x32_bf16 v[88:91], a[136:139], a[48:51], 0
    ds_read_b128 a[104:107], v2 offset:43008
    v_mfma_f32_16x16x32_bf16 v[88:91], a[140:143], a[52:55], v[88:91]
    buffer_load_dwordx4 v15, s[4:7], s16 offen offset:3072 lds
    v_mfma_f32_16x16x32_bf16 v[92:95], a[136:139], a[56:59], 0
    s_add_u32 s16, s16, 128
    ds_read_b128 a[108:111], v3 offset:43008
    v_mfma_f32_16x16x32_bf16 v[92:95], a[140:143], a[60:63], v[92:95]
    s_waitcnt lgkmcnt(7)
    ds_read_b128 a[112:115], v2 offset:45056
    v_mfma_f32_16x16x32_bf16 v[96:99], a[128:131], a[0:3], 0
    s_waitcnt lgkmcnt(6)
    ds_read_b64_tr_b16 a[136:137], v7 offset:0
    v_mfma_f32_16x16x32_bf16 v[96:99], a[132:135], a[4:7], v[96:99]
    v_mfma_f32_16x16x32_bf16 v[100:103], a[128:131], a[8:11], 0
    ds_read_b64_tr_b16 a[138:139], v7 offset:2048
    v_mfma_f32_16x16x32_bf16 v[100:103], a[132:135], a[12:15], v[100:103]
    ds_read_b128 a[116:119], v3 offset:45056
    v_mfma_f32_16x16x32_bf16 v[104:107], a[128:131], a[16:19], 0
    ds_read_b64_tr_b16 a[140:141], v7 offset:16384
    v_mfma_f32_16x16x32_bf16 v[104:107], a[132:135], a[20:23], v[104:107]
    ds_read_b128 a[120:123], v2 offset:47104
    v_mfma_f32_16x16x32_bf16 v[108:111], a[128:131], a[24:27], 0
    ds_read_b64_tr_b16 a[142:143], v7 offset:18432
    v_mfma_f32_16x16x32_bf16 v[108:111], a[132:135], a[28:31], v[108:111]
    ds_read_b128 a[124:127], v3 offset:47104
    v_mfma_f32_16x16x32_bf16 v[112:115], a[128:131], a[32:35], 0
    v_mfma_f32_16x16x32_bf16 v[112:115], a[132:135], a[36:39], v[112:115]
    v_mfma_f32_16x16x32_bf16 v[116:119], a[128:131], a[40:43], 0
    v_mfma_f32_16x16x32_bf16 v[116:119], a[132:135], a[44:47], v[116:119]
    v_mfma_f32_16x16x32_bf16 v[120:123], a[128:131], a[48:51], 0
    v_mfma_f32_16x16x32_bf16 v[120:123], a[132:135], a[52:55], v[120:123]
    v_mfma_f32_16x16x32_bf16 v[124:127], a[128:131], a[56:59], 0
    v_mfma_f32_16x16x32_bf16 v[124:127], a[132:135], a[60:63], v[124:127]
    s_waitcnt vmcnt(0) lgkmcnt(0)
    s_barrier
    v_mfma_f32_16x16x32_bf16 v[128:131], a[136:139], a[0:3], 0
    s_add_u32 m0, s21, 65536
    ds_read_b64_tr_b16 a[128:129], v4 offset:32768
    v_mfma_f32_16x16x32_bf16 v[128:131], a[140:143], a[4:7], v[128:131]
    buffer_load_dwordx4 v16, s[8:11], s18 offen offset:0 lds
    v_mfma_f32_16x16x32_bf16 v[132:135], a[136:139], a[8:11], 0
    ds_read_b64_tr_b16 a[130:131], v4 offset:34816
    v_mfma_f32_16x16x32_bf16 v[132:135], a[140:143], a[12:15], v[132:135]
    v_mfma_f32_16x16x32_bf16 v[136:139], a[136:139], a[16:19], 0
    ds_read_b64_tr_b16 a[132:133], v4 offset:49152
    v_mfma_f32_16x16x32_bf16 v[136:139], a[140:143], a[20:23], v[136:139]
    buffer_load_dwordx4 v17, s[8:11], s18 offen offset:1024 lds
    v_mfma_f32_16x16x32_bf16 v[140:143], a[136:139], a[24:27], 0
    ds_read_b64_tr_b16 a[134:135], v4 offset:51200
    v_mfma_f32_16x16x32_bf16 v[140:143], a[140:143], a[28:31], v[140:143]
    v_mfma_f32_16x16x32_bf16 v[144:147], a[136:139], a[32:35], 0
    v_mfma_f32_16x16x32_bf16 v[144:147], a[140:143], a[36:39], v[144:147]
    buffer_load_dwordx4 v18, s[8:11], s18 offen offset:2048 lds
    v_mfma_f32_16x16x32_bf16 v[148:151], a[136:139], a[40:43], 0
    v_mfma_f32_16x16x32_bf16 v[148:151], a[140:143], a[44:47], v[148:151]
    v_mfma_f32_16x16x32_bf16 v[152:155], a[136:139], a[48:51], 0
    v_mfma_f32_16x16x32_bf16 v[152:155], a[140:143], a[52:55], v[152:155]
    buffer_load_dwordx4 v19, s[8:11], s18 offen offset:3072 lds
    v_mfma_f32_16x16x32_bf16 v[156:159], a[136:139], a[56:59], 0
    s_add_u32 s18, s18, 524288
    v_mfma_f32_16x16x32_bf16 v[156:159], a[140:143], a[60:63], v[156:159]
    s_waitcnt lgkmcnt(2)
ALg_3:
    v_mfma_f32_16x16x32_bf16 v[32:35], a[128:131], a[64:67], v[32:35]
    s_waitcnt lgkmcnt(0)
    s_add_u32 m0, s21, 81920
    ds_read_b64_tr_b16 a[136:137], v5 offset:32768
    v_mfma_f32_16x16x32_bf16 v[32:35], a[132:135], a[68:71], v[32:35]
    buffer_load_dwordx4 v16, s[8:11], s19 offen offset:0 lds
    v_mfma_f32_16x16x32_bf16 v[36:39], a[128:131], a[72:75], v[36:39]
    ds_read_b64_tr_b16 a[138:139], v5 offset:34816
    v_mfma_f32_16x16x32_bf16 v[36:39], a[132:135], a[76:79], v[36:39]
    ds_read_b128 a[0:3], v2 offset:0
    v_mfma_f32_16x16x32_bf16 v[40:43], a[128:131], a[80:83], v[40:43]
    ds_read_b64_tr_b16 a[140:141], v5 offset:49152
    v_mfma_f32_16x16x32_bf16 v[40:43], a[132:135], a[84:87], v[40:43]
    buffer_load_dwordx4 v17, s[8:11], s19 offen offset:1024 lds
    v_mfma_f32_16x16x32_bf16 v[44:47], a[128:131], a[88:91], v[44:47]
    ds_read_b64_tr_b16 a[142:143], v5 offset:51200
    v_mfma_f32_16x16x32_bf16 v[44:47], a[132:135], a[92:95], v[44:47]
    ds_read_b128 a[4:7], v3 offset:0
    v_mfma_f32_16x16x32_bf16 v[48:51], a[128:131], a[96:99], v[48:51]
    ds_read_b128 a[8:11], v2 offset:2048
    v_mfma_f32_16x16x32_bf16 v[48:51], a[132:135], a[100:103], v[48:51]
    buffer_load_dwordx4 v18, s[8:11], s19 offen offset:2048 lds
    v_mfma_f32_16x16x32_bf16 v[52:55], a[128:131], a[104:107], v[52:55]
    ds_read_b128 a[12:15], v3 offset:2048
    v_mfma_f32_16x16x32_bf16 v[52:55], a[132:135], a[108:111], v[52:55]
    v_mfma_f32_16x16x32_bf16 v[56:59], a[128:131], a[112:115], v[56:59]
    ds_read_b128 a[16:19], v2 offset:4096
    v_mfma_f32_16x16x32_bf16 v[56:59], a[132:135], a[116:119], v[56:59]
    buffer_load_dwordx4 v19, s[8:11], s19 offen offset:3072 lds
    v_mfma_f32_16x16x32_bf16 v[60:63], a[128:131], a[120:123], v[60:63]
    s_add_u32 s19, s19, 524288
    ds_read_b128 a[20:23], v3 offset:4096
    v_mfma_f32_16x16x32_bf16 v[60:63], a[132:135], a[124:127], v[60:63]
    s_waitcnt lgkmcnt(8)
    ds_read_b128 a[24:27], v2 offset:6144
    v_mfma_f32_16x16x32_bf16 v[64:67], a[136:139], a[64:67], v[64:67]
    s_waitcnt lgkmcnt(6)
    s_add_u32 m0, s20, 32768
    ds_read_b64_tr_b16 a[128:129], v6 offset:32768
    v_mfma_f32_16x16x32_bf16 v[64:67], a[140:143], a[68:71], v[64:67]
    buffer_load_dwordx4 v12, s[4:7], s16 offen offset:0 lds
    v_mfma_f32_16x16x32_bf16 v[68:71], a[136:139], a[72:75], v[68:71]
    ds_read_b64_tr_b16 a[130:131], v6 offset:34816
    v_mfma_f32_16x16x32_bf16 v[68:71], a[140:143], a[76:79], v[68:71]
    v_mfma_f32_16x16x32_bf16 v[72:75], a[136:139], a[80:83], v[72:75]
    ds_read_b64_tr_b16 a[132:133], v6 offset:49152
    v_mfma_f32_16x16x32_bf16 v[72:75], a[140:143], a[84:87], v[72:75]
    buffer_load_dwordx4 v13, s[4:7], s16 offen offset:1024 lds
    v_mfma_f32_16x16x32_bf16 v[76:79], a[136:139], a[88:91], v[76:79]
    ds_read_b64_tr_b16 a[134:135], v6 offset:51200
    v_mfma_f32_16x16x32_bf16 v[76:79], a[140:143], a[92:95], v[76:79]
    ds_read_b128 a[28:31], v3 offset:6144
    v_mfma_f32_16x16x32_bf16 v[80:83], a[136:139], a[96:99], v[80:83]
    ds_read_b128 a[32:35], v2 offset:8192
    v_mfma_f32_16x16x32_bf16 v[80:83], a[140:143], a[100:103], v[80:83]
    buffer_load_dwordx4 v14, s[4:7], s16 offen offset:2048 lds
    v_mfma_f32_16x16x32_bf16 v[84:87], a[136:139], a[104:107], v[84:87]
    ds_read_b128 a[36:39], v3 offset:8192
    v_mfma_f32_16x16x32_bf16 v[84:87], a[140:143], a[108:111], v[84:87]
    v_mfma_f32_16x16x32_bf16 v[88:91], a[136:139], a[112:115], v[88:91]
    ds_read_b128 a[40:43], v2 offset:10240
    v_mfma_f32_16x16x32_bf16 v[88:91], a[140:143], a[116:119], v[88:91]
    buffer_load_dwordx4 v15, s[4:7], s16 offen offset:3072 lds
    v_mfma_f32_16x16x32_bf16 v[92:95], a[136:139], a[120:123], v[92:95]
    s_add_u32 s16, s16, 128
    ds_read_b128 a[44:47], v3 offset:10240
    v_mfma_f32_16x16x32_bf16 v[92:95], a[140:143], a[124:127], v[92:95]
    s_waitcnt lgkmcnt(7)
    ds_read_b128 a[48:51], v2 offset:12288
    v_mfma_f32_16x16x32_bf16 v[96:99], a[128:131], a[64:67], v[96:99]
    s_waitcnt lgkmcnt(6)
    ds_read_b64_tr_b16 a[136:137], v7 offset:32768
    v_mfma_f32_16x16x32_bf16 v[96:99], a[132:135], a[68:71], v[96:99]
    v_mfma_f32_16x16x32_bf16 v[100:103], a[128:131], a[72:75], v[100:103]
    ds_read_b64_tr_b16 a[138:139], v7 offset:34816
    v_mfma_f32_16x16x32_bf16 v[100:103], a[132:135], a[76:79], v[100:103]
    ds_read_b128 a[52:55], v3 offset:12288
    v_mfma_f32_16x16x32_bf16 v[104:107], a[128:131], a[80:83], v[104:107]
    ds_read_b64_tr_b16 a[140:141], v7 offset:49152
    v_mfma_f32_16x16x32_bf16 v[104:107], a[132:135], a[84:87], v[104:107]
    ds_read_b128 a[56:59], v2 offset:14336
    v_mfma_f32_16x16x32_bf16 v[108:111], a[128:131], a[88:91], v[108:111]
    ds_read_b64_tr_b16 a[142:143], v7 offset:51200
    v_mfma_f32_16x16x32_bf16 v[108:111], a[132:135], a[92:95], v[108:111]
    ds_read_b128 a[60:63], v3 offset:14336
    v_mfma_f32_16x16x32_bf16 v[112:115], a[128:131], a[96:99], v[112:115]
    v_mfma_f32_16x16x32_bf16 v[112:115], a[132:135], a[100:103], v[112:115]
    v_mfma_f32_16x16x32_bf16 v[116:119], a[128:131], a[104:107], v[116:119]
    v_mfma_f32_16x16x32_bf16 v[116:119], a[132:135], a[108:111], v[116:119]
    v_mfma_f32_16x16x32_bf16 v[120:123], a[128:131], a[112:115], v[120:123]
    v_mfma_f32_16x16x32_bf16 v[120:123], a[132:135], a[116:119], v[120:123]
    v_mfma_f32_16x16x32_bf16 v[124:127], a[128:131], a[120:123], v[124:127]
    v_mfma_f32_16x16x32_bf16 v[124:127], a[132:135], a[124:127], v[124:127]
    s_waitcnt vmcnt(0) lgkmcnt(0)
    s_barrier
    v_mfma_f32_16x16x32_bf16 v[128:131], a[136:139], a[64:67], v[128:131]
    s_add_u32 m0, s21, 98304
    ds_read_b64_tr_b16 a[128:129], v4 offset:0
    v_mfma_f32_16x16x32_bf16 v[128:131], a[140:143], a[68:71], v[128:131]
    buffer_load_dwordx4 v16, s[8:11], s18 offen offset:0 lds
    v_mfma_f32_16x16x32_bf16 v[132:135], a[136:139], a[72:75], v[132:135]
    ds_read_b64_tr_b16 a[130:131], v4 offset:2048
    v_mfma_f32_16x16x32_bf16 v[132:135], a[140:143], a[76:79], v[132:135]
    v_mfma_f32_16x16x32_bf16 v[136:139], a[136:139], a[80:83], v[136:139]
    ds_read_b64_tr_b16 a[132:133], v4 offset:16384
    v_mfma_f32_16x16x32_bf16 v[136:139], a[140:143], a[84:87], v[136:139]
    buffer_load_dwordx4 v17, s[8:11], s18 offen offset:1024 lds
    v_mfma_f32_16x16x32_bf16 v[140:143], a[136:139], a[88:91], v[140:143]
    ds_read_b64_tr_b16 a[134:135], v4 offset:18432
    v_mfma_f32_16x16x32_bf16 v[140:143], a[140:143], a[92:95], v[140:143]
    v_mfma_f32_16x16x32_bf16 v[144:147], a[136:139], a[96:99], v[144:147]
    v_mfma_f32_16x16x32_bf16 v[144:147], a[140:143], a[100:103], v[144:147]
    buffer_load_dwordx4 v18, s[8:11], s18 offen offset:2048 lds
    v_mfma_f32_16x16x32_bf16 v[148:151], a[136:139], a[104:107], v[148:151]
    v_mfma_f32_16x16x32_bf16 v[148:151], a[140:143], a[108:111], v[148:151]
    v_mfma_f32_16x16x32_bf16 v[152:155], a[136:139], a[112:115], v[152:155]
    v_mfma_f32_16x16x32_bf16 v[152:155], a[140:143], a[116:119], v[152:155]
    buffer_load_dwordx4 v19, s[8:11], s18 offen offset:3072 lds
    v_mfma_f32_16x16x32_bf16 v[156:159], a[136:139], a[120:123], v[156:159]
    s_add_u32 s18, s18, 524288
    v_mfma_f32_16x16x32_bf16 v[156:159], a[140:143], a[124:127], v[156:159]
    s_waitcnt lgkmcnt(2)
    v_mfma_f32_16x16x32_bf16 v[32:35], a[128:131], a[0:3], v[32:35]
    s_waitcnt lgkmcnt(0)
    s_add_u32 m0, s21, 114688
    ds_read_b64_tr_b16 a[136:137], v5 offset:0
    v_mfma_f32_16x16x32_bf16 v[32:35], a[132:135], a[4:7], v[32:35]
    buffer_load_dwordx4 v16, s[8:11], s19 offen offset:0 lds
    v_mfma_f32_16x16x32_bf16 v[36:39], a[128:131], a[8:11], v[36:39]
    ds_read_b64_tr_b16 a[138:139], v5 offset:2048
    v_mfma_f32_16x16x32_bf16 v[36:39], a[132:135], a[12:15], v[36:39]
    ds_read_b128 a[64:67], v2 offset:32768
    v_mfma_f32_16x16x32_bf16 v[40:43], a[128:131], a[16:19], v[40:43]
    ds_read_b64_tr_b16 a[140:141], v5 offset:16384
    v_mfma_f32_16x16x32_bf16 v[40:43], a[132:135], a[20:23], v[40:43]
    buffer_load_dwordx4 v17, s[8:11], s19 offen offset:1024 lds
    v_mfma_f32_16x16x32_bf16 v[44:47], a[128:131], a[24:27], v[44:47]
    ds_read_b64_tr_b16 a[142:143], v5 offset:18432
    v_mfma_f32_16x16x32_bf16 v[44:47], a[132:135], a[28:31], v[44:47]
    ds_read_b128 a[68:71], v3 offset:32768
    v_mfma_f32_16x16x32_bf16 v[48:51], a[128:131], a[32:35], v[48:51]
    ds_read_b128 a[72:75], v2 offset:34816
    v_mfma_f32_16x16x32_bf16 v[48:51], a[132:135], a[36:39], v[48:51]
    buffer_load_dwordx4 v18, s[8:11], s19 offen offset:2048 lds
    v_mfma_f32_16x16x32_bf16 v[52:55], a[128:131], a[40:43], v[52:55]
    ds_read_b128 a[76:79], v3 offset:34816
    v_mfma_f32_16x16x32_bf16 v[52:55], a[132:135], a[44:47], v[52:55]
    v_mfma_f32_16x16x32_bf16 v[56:59], a[128:131], a[48:51], v[56:59]
    ds_read_b128 a[80:83], v2 offset:36864
    v_mfma_f32_16x16x32_bf16 v[56:59], a[132:135], a[52:55], v[56:59]
    buffer_load_dwordx4 v19, s[8:11], s19 offen offset:3072 lds
    v_mfma_f32_16x16x32_bf16 v[60:63], a[128:131], a[56:59], v[60:63]
    s_add_u32 s19, s19, 524288
    ds_read_b128 a[84:87], v3 offset:36864
    v_mfma_f32_16x16x32_bf16 v[60:63], a[132:135], a[60:63], v[60:63]
    s_waitcnt lgkmcnt(8)
    ds_read_b128 a[88:91], v2 offset:38912
    v_mfma_f32_16x16x32_bf16 v[64:67], a[136:139], a[0:3], v[64:67]
    s_waitcnt lgkmcnt(6)
    s_add_u32 m0, s20, 0
    ds_read_b64_tr_b16 a[128:129], v6 offset:0
    v_mfma_f32_16x16x32_bf16 v[64:67], a[140:143], a[4:7], v[64:67]
    buffer_load_dwordx4 v12, s[4:7], s16 offen offset:0 lds
    v_mfma_f32_16x16x32_bf16 v[68:71], a[136:139], a[8:11], v[68:71]
    ds_read_b64_tr_b16 a[130:131], v6 offset:2048
    v_mfma_f32_16x16x32_bf16 v[68:71], a[140:143], a[12:15], v[68:71]
    v_mfma_f32_16x16x32_bf16 v[72:75], a[136:139], a[16:19], v[72:75]
    ds_read_b64_tr_b16 a[132:133], v6 offset:16384
    v_mfma_f32_16x16x32_bf16 v[72:75], a[140:143], a[20:23], v[72:75]
    buffer_load_dwordx4 v13, s[4:7], s16 offen offset:1024 lds
    v_mfma_f32_16x16x32_bf16 v[76:79], a[136:139], a[24:27], v[76:79]
    ds_read_b64_tr_b16 a[134:135], v6 offset:18432
    v_mfma_f32_16x16x32_bf16 v[76:79], a[140:143], a[28:31], v[76:79]
    ds_read_b128 a[92:95], v3 offset:38912
    v_mfma_f32_16x16x32_bf16 v[80:83], a[136:139], a[32:35], v[80:83]
    ds_read_b128 a[96:99], v2 offset:40960
    v_mfma_f32_16x16x32_bf16 v[80:83], a[140:143], a[36:39], v[80:83]
    buffer_load_dwordx4 v14, s[4:7], s16 offen offset:2048 lds
    v_mfma_f32_16x16x32_bf16 v[84:87], a[136:139], a[40:43], v[84:87]
    ds_read_b128 a[100:103], v3 offset:40960
    v_mfma_f32_16x16x32_bf16 v[84:87], a[140:143], a[44:47], v[84:87]
    v_mfma_f32_16x16x32_bf16 v[88:91], a[136:139], a[48:51], v[88:91]
    ds_read_b128 a[104:107], v2 offset:43008
    v_mfma_f32_16x16x32_bf16 v[88:91], a[140:143], a[52:55], v[88:91]
    buffer_load_dwordx4 v15, s[4:7], s16 offen offset:3072 lds
    v_mfma_f32_16x16x32_bf16 v[92:95], a[136:139], a[56:59], v[92:95]
    s_add_u32 s16, s16, 128
    ds_read_b128 a[108:111], v3 offset:43008
    v_mfma_f32_16x16x32_bf16 v[92:95], a[140:143], a[60:63], v[92:95]
    s_waitcnt lgkmcnt(7)
    ds_read_b128 a[112:115], v2 offset:45056
    v_mfma_f32_16x16x32_bf16 v[96:99], a[128:131], a[0:3], v[96:99]
    s_waitcnt lgkmcnt(6)
    ds_read_b64_tr_b16 a[136:137], v7 offset:0
    v_mfma_f32_16x16x32_bf16 v[96:99], a[132:135], a[4:7], v[96:99]
    v_mfma_f32_16x16x32_bf16 v[100:103], a[128:131], a[8:11], v[100:103]
    ds_read_b64_tr_b16 a[138:139], v7 offset:2048
    v_mfma_f32_16x16x32_bf16 v[100:103], a[132:135], a[12:15], v[100:103]
    ds_read_b128 a[116:119], v3 offset:45056
    v_mfma_f32_16x16x32_bf16 v[104:107], a[128:131], a[16:19], v[104:107]
    ds_read_b64_tr_b16 a[140:141], v7 offset:16384
    v_mfma_f32_16x16x32_bf16 v[104:107], a[132:135], a[20:23], v[104:107]
    ds_read_b128 a[120:123], v2 offset:47104
    v_mfma_f32_16x16x32_bf16 v[108:111], a[128:131], a[24:27], v[108:111]
    ds_read_b64_tr_b16 a[142:143], v7 offset:18432
    v_mfma_f32_16x16x32_bf16 v[108:111], a[132:135], a[28:31], v[108:111]
    ds_read_b128 a[124:127], v3 offset:47104
    v_mfma_f32_16x16x32_bf16 v[112:115], a[128:131], a[32:35], v[112:115]
    v_mfma_f32_16x16x32_bf16 v[112:115], a[132:135], a[36:39], v[112:115]
    v_mfma_f32_16x16x32_bf16 v[116:119], a[128:131], a[40:43], v[116:119]
    v_mfma_f32_16x16x32_bf16 v[116:119], a[132:135], a[44:47], v[116:119]
    v_mfma_f32_16x16x32_bf16 v[120:123], a[128:131], a[48:51], v[120:123]
    v_mfma_f32_16x16x32_bf16 v[120:123], a[132:135], a[52:55], v[120:123]
    v_mfma_f32_16x16x32_bf16 v[124:127], a[128:131], a[56:59], v[124:127]
    v_mfma_f32_16x16x32_bf16 v[124:127], a[132:135], a[60:63], v[124:127]
    s_waitcnt vmcnt(0) lgkmcnt(0)
    s_barrier
    v_mfma_f32_16x16x32_bf16 v[128:131], a[136:139], a[0:3], v[128:131]
    s_add_u32 m0, s21, 65536
    ds_read_b64_tr_b16 a[128:129], v4 offset:32768
    v_mfma_f32_16x16x32_bf16 v[128:131], a[140:143], a[4:7], v[128:131]
    buffer_load_dwordx4 v16, s[8:11], s18 offen offset:0 lds
    v_mfma_f32_16x16x32_bf16 v[132:135], a[136:139], a[8:11], v[132:135]
    ds_read_b64_tr_b16 a[130:131], v4 offset:34816
    v_mfma_f32_16x16x32_bf16 v[132:135], a[140:143], a[12:15], v[132:135]
    v_mfma_f32_16x16x32_bf16 v[136:139], a[136:139], a[16:19], v[136:139]
    ds_read_b64_tr_b16 a[132:133], v4 offset:49152
    v_mfma_f32_16x16x32_bf16 v[136:139], a[140:143], a[20:23], v[136:139]
    buffer_load_dwordx4 v17, s[8:11], s18 offen offset:1024 lds
    v_mfma_f32_16x16x32_bf16 v[140:143], a[136:139], a[24:27], v[140:143]
    ds_read_b64_tr_b16 a[134:135], v4 offset:51200
    v_mfma_f32_16x16x32_bf16 v[140:143], a[140:143], a[28:31], v[140:143]
    v_mfma_f32_16x16x32_bf16 v[144:147], a[136:139], a[32:35], v[144:147]
    v_mfma_f32_16x16x32_bf16 v[144:147], a[140:143], a[36:39], v[144:147]
    buffer_load_dwordx4 v18, s[8:11], s18 offen offset:2048 lds
    v_mfma_f32_16x16x32_bf16 v[148:151], a[136:139], a[40:43], v[148:151]
    v_mfma_f32_16x16x32_bf16 v[148:151], a[140:143], a[44:47], v[148:151]
    v_mfma_f32_16x16x32_bf16 v[152:155], a[136:139], a[48:51], v[152:155]
    s_sub_u32 s22, s22, 1
    v_mfma_f32_16x16x32_bf16 v[152:155], a[140:143], a[52:55], v[152:155]
    buffer_load_dwordx4 v19, s[8:11], s18 offen offset:3072 lds
    v_mfma_f32_16x16x32_bf16 v[156:159], a[136:139], a[56:59], v[156:159]
    s_add_u32 s18, s18, 524288
    v_mfma_f32_16x16x32_bf16 v[156:159], a[140:143], a[60:63], v[156:159]
    s_waitcnt lgkmcnt(2)
    s_cmp_lg_u32 s22, 0
    s_cbranch_scc1 ALg_3
    v_mfma_f32_16x16x32_bf16 v[32:35], a[128:131], a[64:67], v[32:35]
    s_waitcnt lgkmcnt(0)
    s_add_u32 m0, s21, 81920
    ds_read_b64_tr_b16 a[136:137], v5 offset:32768
    v_mfma_f32_16x16x32_bf16 v[32:35], a[132:135], a[68:71], v[32:35]
    buffer_load_dwordx4 v16, s[8:11], s19 offen offset:0 lds
    v_mfma_f32_16x16x32_bf16 v[36:39], a[128:131], a[72:75], v[36:39]
    ds_read_b64_tr_b16 a[138:139], v5 offset:34816
    v_mfma_f32_16x16x32_bf16 v[36:39], a[132:135], a[76:79], v[36:39]
    ds_read_b128 a[0:3], v2 offset:0
    v_mfma_f32_16x16x32_bf16 v[40:43], a[128:131], a[80:83], v[40:43]
    ds_read_b64_tr_b16 a[140:141], v5 offset:49152
    v_mfma_f32_16x16x32_bf16 v[40:43], a[132:135], a[84:87], v[40:43]
    buffer_load_dwordx4 v17, s[8:11], s19 offen offset:1024 lds
    v_mfma_f32_16x16x32_bf16 v[44:47], a[128:131], a[88:91], v[44:47]
    ds_read_b64_tr_b16 a[142:143], v5 offset:51200
    v_mfma_f32_16x16x32_bf16 v[44:47], a[132:135], a[92:95], v[44:47]
    ds_read_b128 a[4:7], v3 offset:0
    v_mfma_f32_16x16x32_bf16 v[48:51], a[128:131], a[96:99], v[48:51]
    v_mfma_f32_16x16x32_bf16 v[48:51], a[132:135], a[100:103], v[48:51]
    buffer_load_dwordx4 v18, s[8:11], s19 offen offset:2048 lds
    v_mfma_f32_16x16x32_bf16 v[52:55], a[128:131], a[104:107], v[52:55]
    ds_read_b128 a[8:11], v2 offset:2048
    v_mfma_f32_16x16x32_bf16 v[52:55], a[132:135], a[108:111], v[52:55]
    ds_read_b128 a[12:15], v3 offset:2048
    v_mfma_f32_16x16x32_bf16 v[56:59], a[128:131], a[112:115], v[56:59]
    v_mfma_f32_16x16x32_bf16 v[56:59], a[132:135], a[116:119], v[56:59]
    buffer_load_dwordx4 v19, s[8:11], s19 offen offset:3072 lds
    v_mfma_f32_16x16x32_bf16 v[60:63], a[128:131], a[120:123], v[60:63]
    s_add_u32 s19, s19, 524288
    ds_read_b128 a[16:19], v2 offset:4096
    v_mfma_f32_16x16x32_bf16 v[60:63], a[132:135], a[124:127], v[60:63]
    s_waitcnt lgkmcnt(7)
    ds_read_b128 a[20:23], v3 offset:4096
    v_mfma_f32_16x16x32_bf16 v[64:67], a[136:139], a[64:67], v[64:67]
    s_waitcnt lgkmcnt(5)
    ds_read_b64_tr_b16 a[128:129], v6 offset:32768
    v_mfma_f32_16x16x32_bf16 v[64:67], a[140:143], a[68:71], v[64:67]
    v_mfma_f32_16x16x32_bf16 v[68:71], a[136:139], a[72:75], v[68:71]
    ds_read_b64_tr_b16 a[130:131], v6 offset:34816
    v_mfma_f32_16x16x32_bf16 v[68:71], a[140:143], a[76:79], v[68:71]
    ds_read_b128 a[24:27], v2 offset:6144
    v_mfma_f32_16x16x32_bf16 v[72:75], a[136:139], a[80:83], v[72:75]
    ds_read_b64_tr_b16 a[132:133], v6 offset:49152
    v_mfma_f32_16x16x32_bf16 v[72:75], a[140:143], a[84:87], v[72:75]
    ds_read_b128 a[28:31], v3 offset:6144
    v_mfma_f32_16x16x32_bf16 v[76:79], a[136:139], a[88:91], v[76:79]
    ds_read_b64_tr_b16 a[134:135], v6 offset:51200
    v_mfma_f32_16x16x32_bf16 v[76:79], a[140:143], a[92:95], v[76:79]
    v_mfma_f32_16x16x32_bf16 v[80:83], a[136:139], a[96:99], v[80:83]
    ds_read_b128 a[32:35], v2 offset:8192
    v_mfma_f32_16x16x32_bf16 v[80:83], a[140:143], a[100:103], v[80:83]
    v_mfma_f32_16x16x32_bf16 v[84:87], a[136:139], a[104:107], v[84:87]
    ds_read_b128 a[36:39], v3 offset:8192
    v_mfma_f32_16x16x32_bf16 v[84:87], a[140:143], a[108:111], v[84:87]
    ds_read_b128 a[40:43], v2 offset:10240
    v_mfma_f32_16x16x32_bf16 v[88:91], a[136:139], a[112:115], v[88:91]
    v_mfma_f32_16x16x32_bf16 v[88:91], a[140:143], a[116:119], v[88:91]
    ds_read_b128 a[44:47], v3 offset:10240
    v_mfma_f32_16x16x32_bf16 v[92:95], a[136:139], a[120:123], v[92:95]
    ds_read_b128 a[48:51], v2 offset:12288
    v_mfma_f32_16x16x32_bf16 v[92:95], a[140:143], a[124:127], v[92:95]
    s_waitcnt lgkmcnt(9)
    v_mfma_f32_16x16x32_bf16 v[96:99], a[128:131], a[64:67], v[96:99]
    s_waitcnt lgkmcnt(5)
    ds_read_b64_tr_b16 a[136:137], v7 offset:32768
    v_mfma_f32_16x16x32_bf16 v[96:99], a[132:135], a[68:71], v[96:99]
    ds_read_b128 a[52:55], v3 offset:12288
    v_mfma_f32_16x16x32_bf16 v[100:103], a[128:131], a[72:75], v[100:103]
    ds_read_b64_tr_b16 a[138:139], v7 offset:34816
    v_mfma_f32_16x16x32_bf16 v[100:103], a[132:135], a[76:79], v[100:103]
    ds_read_b128 a[56:59], v2 offset:14336
    v_mfma_f32_16x16x32_bf16 v[104:107], a[128:131], a[80:83], v[104:107]
    ds_read_b64_tr_b16 a[140:141], v7 offset:49152
    v_mfma_f32_16x16x32_bf16 v[104:107], a[132:135], a[84:87], v[104:107]
    v_mfma_f32_16x16x32_bf16 v[108:111], a[128:131], a[88:91], v[108:111]
    ds_read_b64_tr_b16 a[142:143], v7 offset:51200
    v_mfma_f32_16x16x32_bf16 v[108:111], a[132:135], a[92:95], v[108:111]
    ds_read_b128 a[60:63], v3 offset:14336
    v_mfma_f32_16x16x32_bf16 v[112:115], a[128:131], a[96:99], v[112:115]
    v_mfma_f32_16x16x32_bf16 v[112:115], a[132:135], a[100:103], v[112:115]
    v_mfma_f32_16x16x32_bf16 v[116:119], a[128:131], a[104:107], v[116:119]
    v_mfma_f32_16x16x32_bf16 v[116:119], a[132:135], a[108:111], v[116:119]
    v_mfma_f32_16x16x32_bf16 v[120:123], a[128:131], a[112:115], v[120:123]
    v_mfma_f32_16x16x32_bf16 v[120:123], a[132:135], a[116:119], v[120:123]
    v_mfma_f32_16x16x32_bf16 v[124:127], a[128:131], a[120:123], v[124:127]
    v_mfma_f32_16x16x32_bf16 v[124:127], a[132:135], a[124:127], v[124:127]
    s_waitcnt vmcnt(0) lgkmcnt(0)
    s_barrier
    v_mfma_f32_16x16x32_bf16 v[128:131], a[136:139], a[64:67], v[128:131]
    ds_read_b64_tr_b16 a[128:129], v4 offset:0
    v_mfma_f32_16x16x32_bf16 v[128:131], a[140:143], a[68:71], v[128:131]
    v_mfma_f32_16x16x32_bf16 v[132:135], a[136:139], a[72:75], v[132:135]
    ds_read_b64_tr_b16 a[130:131], v4 offset:2048
    v_mfma_f32_16x16x32_bf16 v[132:135], a[140:143], a[76:79], v[132:135]
    v_mfma_f32_16x16x32_bf16 v[136:139], a[136:139], a[80:83], v[136:139]
    ds_read_b64_tr_b16 a[132:133], v4 offset:16384
    v_mfma_f32_16x16x32_bf16 v[136:139], a[140:143], a[84:87], v[136:139]
    v_mfma_f32_16x16x32_bf16 v[140:143], a[136:139], a[88:91], v[140:143]
    ds_read_b64_tr_b16 a[134:135], v4 offset:18432
    v_mfma_f32_16x16x32_bf16 v[140:143], a[140:143], a[92:95], v[140:143]
    v_mfma_f32_16x16x32_bf16 v[144:147], a[136:139], a[96:99], v[144:147]
    v_mfma_f32_16x16x32_bf16 v[144:147], a[140:143], a[100:103], v[144:147]
    v_mfma_f32_16x16x32_bf16 v[148:151], a[136:139], a[104:107], v[148:151]
    v_mfma_f32_16x16x32_bf16 v[148:151], a[140:143], a[108:111], v[148:151]
    v_mfma_f32_16x16x32_bf16 v[152:155], a[136:139], a[112:115], v[152:155]
    v_mfma_f32_16x16x32_bf16 v[152:155], a[140:143], a[116:119], v[152:155]
    v_mfma_f32_16x16x32_bf16 v[156:159], a[136:139], a[120:123], v[156:159]
    v_mfma_f32_16x16x32_bf16 v[156:159], a[140:143], a[124:127], v[156:159]
    s_waitcnt lgkmcnt(2)
    v_mfma_f32_16x16x32_bf16 v[32:35], a[128:131], a[0:3], v[32:35]
    s_waitcnt lgkmcnt(0)
    ds_read_b64_tr_b16 a[136:137], v5 offset:0
    v_mfma_f32_16x16x32_bf16 v[32:35], a[132:135], a[4:7], v[32:35]
    v_mfma_f32_16x16x32_bf16 v[36:39], a[128:131], a[8:11], v[36:39]
    ds_read_b64_tr_b16 a[138:139], v5 offset:2048
    v_mfma_f32_16x16x32_bf16 v[36:39], a[132:135], a[12:15], v[36:39]
    v_mfma_f32_16x16x32_bf16 v[40:43], a[128:131], a[16:19], v[40:43]
    ds_read_b64_tr_b16 a[140:141], v5 offset:16384
    v_mfma_f32_16x16x32_bf16 v[40:43], a[132:135], a[20:23], v[40:43]
    v_mfma_f32_16x16x32_bf16 v[44:47], a[128:131], a[24:27], v[44:47]
    ds_read_b64_tr_b16 a[142:143], v5 offset:18432
    v_mfma_f32_16x16x32_bf16 v[44:47], a[132:135], a[28:31], v[44:47]
    v_mfma_f32_16x16x32_bf16 v[48:51], a[128:131], a[32:35], v[48:51]
    v_mfma_f32_16x16x32_bf16 v[48:51], a[132:135], a[36:39], v[48:51]
    v_mfma_f32_16x16x32_bf16 v[52:55], a[128:131], a[40:43], v[52:55]
    v_mfma_f32_16x16x32_bf16 v[52:55], a[132:135], a[44:47], v[52:55]
    v_mfma_f32_16x16x32_bf16 v[56:59], a[128:131], a[48:51], v[56:59]
    v_mfma_f32_16x16x32_bf16 v[56:59], a[132:135], a[52:55], v[56:59]
    v_mfma_f32_16x16x32_bf16 v[60:63], a[128:131], a[56:59], v[60:63]
    v_mfma_f32_16x16x32_bf16 v[60:63], a[132:135], a[60:63], v[60:63]
    s_waitcnt lgkmcnt(2)
    v_mfma_f32_16x16x32_bf16 v[64:67], a[136:139], a[0:3], v[64:67]
    s_waitcnt lgkmcnt(0)
    ds_read_b64_tr_b16 a[128:129], v6 offset:0
    v_mfma_f32_16x16x32_bf16 v[64:67], a[140:143], a[4:7], v[64:67]
    v_mfma_f32_16x16x32_bf16 v[68:71], a[136:139], a[8:11], v[68:71]
    ds_read_b64_tr_b16 a[130:131], v6 offset:2048
    v_mfma_f32_16x16x32_bf16 v[68:71], a[140:143], a[12:15], v[68:71]
    v_mfma_f32_16x16x32_bf16 v[72:75], a[136:139], a[16:19], v[72:75]
    ds_read_b64_tr_b16 a[132:133], v6 offset:16384
    v_mfma_f32_16x16x32_bf16 v[72:75], a[140:143], a[20:23], v[72:75]
    v_mfma_f32_16x16x32_bf16 v[76:79], a[136:139], a[24:27], v[76:79]
    ds_read_b64_tr_b16 a[134:135], v6 offset:18432
    v_mfma_f32_16x16x32_bf16 v[76:79], a[140:143], a[28:31], v[76:79]
    v_mfma_f32_16x16x32_bf16 v[80:83], a[136:139], a[32:35], v[80:83]
    v_mfma_f32_16x16x32_bf16 v[80:83], a[140:143], a[36:39], v[80:83]
    v_mfma_f32_16x16x32_bf16 v[84:87], a[136:139], a[40:43], v[84:87]
    v_mfma_f32_16x16x32_bf16 v[84:87], a[140:143], a[44:47], v[84:87]
    v_mfma_f32_16x16x32_bf16 v[88:91], a[136:139], a[48:51], v[88:91]
    v_mfma_f32_16x16x32_bf16 v[88:91], a[140:143], a[52:55], v[88:91]
    v_mfma_f32_16x16x32_bf16 v[92:95], a[136:139], a[56:59], v[92:95]
    v_mfma_f32_16x16x32_bf16 v[92:95], a[140:143], a[60:63], v[92:95]
    s_waitcnt lgkmcnt(2)
    v_mfma_f32_16x16x32_bf16 v[96:99], a[128:131], a[0:3], v[96:99]
    s_waitcnt lgkmcnt(0)
    ds_read_b64_tr_b16 a[136:137], v7 offset:0
    v_mfma_f32_16x16x32_bf16 v[96:99], a[132:135], a[4:7], v[96:99]
    v_mfma_f32_16x16x32_bf16 v[100:103], a[128:131], a[8:11], v[100:103]
    ds_read_b64_tr_b16 a[138:139], v7 offset:2048
    v_mfma_f32_16x16x32_bf16 v[100:103], a[132:135], a[12:15], v[100:103]
    v_mfma_f32_16x16x32_bf16 v[104:107], a[128:131], a[16:19], v[104:107]
    ds_read_b64_tr_b16 a[140:141], v7 offset:16384
    v_mfma_f32_16x16x32_bf16 v[104:107], a[132:135], a[20:23], v[104:107]
    v_mfma_f32_16x16x32_bf16 v[108:111], a[128:131], a[24:27], v[108:111]
    ds_read_b64_tr_b16 a[142:143], v7 offset:18432
    v_mfma_f32_16x16x32_bf16 v[108:111], a[132:135], a[28:31], v[108:111]
    v_mfma_f32_16x16x32_bf16 v[112:115], a[128:131], a[32:35], v[112:115]
    v_mfma_f32_16x16x32_bf16 v[112:115], a[132:135], a[36:39], v[112:115]
    v_mfma_f32_16x16x32_bf16 v[116:119], a[128:131], a[40:43], v[116:119]
    v_mfma_f32_16x16x32_bf16 v[116:119], a[132:135], a[44:47], v[116:119]
    v_mfma_f32_16x16x32_bf16 v[120:123], a[128:131], a[48:51], v[120:123]
    v_mfma_f32_16x16x32_bf16 v[120:123], a[132:135], a[52:55], v[120:123]
    v_mfma_f32_16x16x32_bf16 v[124:127], a[128:131], a[56:59], v[124:127]
    v_mfma_f32_16x16x32_bf16 v[124:127], a[132:135], a[60:63], v[124:127]
    s_waitcnt lgkmcnt(2)
    v_mfma_f32_16x16x32_bf16 v[128:131], a[136:139], a[0:3], v[128:131]
    s_waitcnt lgkmcnt(0)
    v_mfma_f32_16x16x32_bf16 v[128:131], a[140:143], a[4:7], v[128:131]
    v_mfma_f32_16x16x32_bf16 v[132:135], a[136:139], a[8:11], v[132:135]
    v_mfma_f32_16x16x32_bf16 v[132:135], a[140:143], a[12:15], v[132:135]
    v_mfma_f32_16x16x32_bf16 v[136:139], a[136:139], a[16:19], v[136:139]
    v_mfma_f32_16x16x32_bf16 v[136:139], a[140:143], a[20:23], v[136:139]
    v_mfma_f32_16x16x32_bf16 v[140:143], a[136:139], a[24:27], v[140:143]
    v_mfma_f32_16x16x32_bf16 v[140:143], a[140:143], a[28:31], v[140:143]
    v_mfma_f32_16x16x32_bf16 v[144:147], a[136:139], a[32:35], v[144:147]
    v_mfma_f32_16x16x32_bf16 v[144:147], a[140:143], a[36:39], v[144:147]
    v_mfma_f32_16x16x32_bf16 v[148:151], a[136:139], a[40:43], v[148:151]
    v_mfma_f32_16x16x32_bf16 v[148:151], a[140:143], a[44:47], v[148:151]
    v_mfma_f32_16x16x32_bf16 v[152:155], a[136:139], a[48:51], v[152:155]
    v_mfma_f32_16x16x32_bf16 v[152:155], a[140:143], a[52:55], v[152:155]
    v_mfma_f32_16x16x32_bf16 v[156:159], a[136:139], a[56:59], v[156:159]
    v_mfma_f32_16x16x32_bf16 v[156:159], a[140:143], a[60:63], v[156:159]
    s_lshl_b32 s26, s24, 20
    s_lshl_b32 s27, s25, 16
    s_add_u32 s26, s26, s27
    s_lshl_b32 s27, s23, 11
    s_add_u32 s26, s26, s27
    s_add_u32 s26, s26, 33554432
    s_mov_b32 s22, 1035512379
    s_nop 1
    s_load_dwordx4 s[44:47], s[0:1], 8
    s_load_dwordx2 s[48:49], s[0:1], 24
    s_waitcnt lgkmcnt(0)
    s_mov_b32 s4, s44
    s_mov_b32 s5, s45
    s_mov_b32 s6, 1835008
    s_mov_b32 s7, 0x20000
    s_mov_b32 s8, s46
    s_mov_b32 s9, s47
    s_mov_b32 s10, 1835008
    s_mov_b32 s11, 0x20000
    s_mov_b32 s52, s48
    s_mov_b32 s53, s49
    s_mov_b32 s54, 3584
    s_mov_b32 s55, 0x20000
    s_mul_hi_u32 s60, s2, 613566757
    s_mul_i32 s61, s60, 7
    s_sub_u32 s61, s2, s61
    v_and_b32 v184, 31, v0
    v_lshrrev_b32 v185, 5, v0
    s_lshl_b32 s62, s60, 3
    v_add_u32 v185, s62, v185
    s_lshl_b32 s62, s61, 5
    v_add_u32 v184, s62, v184
    v_mul_u32_u24 v186, 7168, v185
    v_lshl_add_u32 v186, v184, 2, v186
    v_lshlrev_b32 v187, 4, v184
    buffer_load_dwordx4 v[180:183], v187, s[52:55], 0 offen
    v_subrev_u32 v187, 2688, v186
    buffer_load_dword v160, v187, s[4:7], 0 offen
    v_subrev_u32 v187, 1792, v186
    buffer_load_dword v161, v187, s[4:7], 0 offen
    v_subrev_u32 v187, 896, v186
    buffer_load_dword v162, v187, s[4:7], 0 offen
    v_add_u32 v187, 3584, v186
    buffer_load_dword v163, v186, s[4:7], 0 offen offset:0
    buffer_load_dword v171, v186, s[8:11], 0 offen offset:0
    buffer_load_dword v164, v186, s[4:7], 0 offen offset:896
    buffer_load_dword v172, v186, s[8:11], 0 offen offset:896
    buffer_load_dword v165, v186, s[4:7], 0 offen offset:1792
    buffer_load_dword v173, v186, s[8:11], 0 offen offset:1792
    buffer_load_dword v166, v186, s[4:7], 0 offen offset:2688
    buffer_load_dword v174, v186, s[8:11], 0 offen offset:2688
    buffer_load_dword v167, v187, s[4:7], 0 offen offset:0
    buffer_load_dword v175, v187, s[8:11], 0 offen offset:0
    buffer_load_dword v168, v187, s[4:7], 0 offen offset:896
    buffer_load_dword v176, v187, s[8:11], 0 offen offset:896
    buffer_load_dword v169, v187, s[4:7], 0 offen offset:1792
    buffer_load_dword v177, v187, s[8:11], 0 offen offset:1792
    buffer_load_dword v170, v187, s[4:7], 0 offen offset:2688
    buffer_load_dword v178, v187, s[8:11], 0 offen offset:2688
    v_mul_f32 v32, s22, v32
    v_mul_f32 v33, s22, v33
    v_mul_f32 v34, s22, v34
    v_mul_f32 v35, s22, v35
    v_mul_f32 v64, s22, v64
    v_mul_f32 v65, s22, v65
    v_mul_f32 v66, s22, v66
    v_mul_f32 v67, s22, v67
    v_cvt_pk_bf16_f32 v32, v32, v33
    v_cvt_pk_bf16_f32 v33, v34, v35
    v_cvt_pk_bf16_f32 v34, v64, v65
    v_cvt_pk_bf16_f32 v35, v66, v67
    s_add_u32 s27, s26, 0
    buffer_store_dwordx4 v[32:35], v20, s[12:15], s27 offen offset:0
    v_mul_f32 v96, s22, v96
    v_mul_f32 v97, s22, v97
    v_mul_f32 v98, s22, v98
    v_mul_f32 v99, s22, v99
    v_mul_f32 v128, s22, v128
    v_mul_f32 v129, s22, v129
    v_mul_f32 v130, s22, v130
    v_mul_f32 v131, s22, v131
    v_cvt_pk_bf16_f32 v96, v96, v97
    v_cvt_pk_bf16_f32 v97, v98, v99
    v_cvt_pk_bf16_f32 v98, v128, v129
    v_cvt_pk_bf16_f32 v99, v130, v131
    buffer_store_dwordx4 v[96:99], v20, s[12:15], s27 offen offset:1024
    v_mul_f32 v36, s22, v36
    v_mul_f32 v37, s22, v37
    v_mul_f32 v38, s22, v38
    v_mul_f32 v39, s22, v39
    v_mul_f32 v68, s22, v68
    v_mul_f32 v69, s22, v69
    v_mul_f32 v70, s22, v70
    v_mul_f32 v71, s22, v71
    v_cvt_pk_bf16_f32 v36, v36, v37
    v_cvt_pk_bf16_f32 v37, v38, v39
    v_cvt_pk_bf16_f32 v38, v68, v69
    v_cvt_pk_bf16_f32 v39, v70, v71
    s_add_u32 s27, s26, 8192
    buffer_store_dwordx4 v[36:39], v20, s[12:15], s27 offen offset:0
    v_mul_f32 v100, s22, v100
    v_mul_f32 v101, s22, v101
    v_mul_f32 v102, s22, v102
    v_mul_f32 v103, s22, v103
    v_mul_f32 v132, s22, v132
    v_mul_f32 v133, s22, v133
    v_mul_f32 v134, s22, v134
    v_mul_f32 v135, s22, v135
    v_cvt_pk_bf16_f32 v100, v100, v101
    v_cvt_pk_bf16_f32 v101, v102, v103
    v_cvt_pk_bf16_f32 v102, v132, v133
    v_cvt_pk_bf16_f32 v103, v134, v135
    buffer_store_dwordx4 v[100:103], v20, s[12:15], s27 offen offset:1024
    v_mul_f32 v40, s22, v40
    v_mul_f32 v41, s22, v41
    v_mul_f32 v42, s22, v42
    v_mul_f32 v43, s22, v43
    v_mul_f32 v72, s22, v72
    v_mul_f32 v73, s22, v73
    v_mul_f32 v74, s22, v74
    v_mul_f32 v75, s22, v75
    v_cvt_pk_bf16_f32 v40, v40, v41
    v_cvt_pk_bf16_f32 v41, v42, v43
    v_cvt_pk_bf16_f32 v42, v72, v73
    v_cvt_pk_bf16_f32 v43, v74, v75
    s_add_u32 s27, s26, 16384
    buffer_store_dwordx4 v[40:43], v20, s[12:15], s27 offen offset:0
    v_mul_f32 v104, s22, v104
    v_mul_f32 v105, s22, v105
    v_mul_f32 v106, s22, v106
    v_mul_f32 v107, s22, v107
    v_mul_f32 v136, s22, v136
    v_mul_f32 v137, s22, v137
    v_mul_f32 v138, s22, v138
    v_mul_f32 v139, s22, v139
    v_cvt_pk_bf16_f32 v104, v104, v105
    v_cvt_pk_bf16_f32 v105, v106, v107
    v_cvt_pk_bf16_f32 v106, v136, v137
    v_cvt_pk_bf16_f32 v107, v138, v139
    buffer_store_dwordx4 v[104:107], v20, s[12:15], s27 offen offset:1024
    v_mul_f32 v44, s22, v44
    v_mul_f32 v45, s22, v45
    v_mul_f32 v46, s22, v46
    v_mul_f32 v47, s22, v47
    v_mul_f32 v76, s22, v76
    v_mul_f32 v77, s22, v77
    v_mul_f32 v78, s22, v78
    v_mul_f32 v79, s22, v79
    v_cvt_pk_bf16_f32 v44, v44, v45
    v_cvt_pk_bf16_f32 v45, v46, v47
    v_cvt_pk_bf16_f32 v46, v76, v77
    v_cvt_pk_bf16_f32 v47, v78, v79
    s_add_u32 s27, s26, 24576
    buffer_store_dwordx4 v[44:47], v20, s[12:15], s27 offen offset:0
    v_mul_f32 v108, s22, v108
    v_mul_f32 v109, s22, v109
    v_mul_f32 v110, s22, v110
    v_mul_f32 v111, s22, v111
    v_mul_f32 v140, s22, v140
    v_mul_f32 v141, s22, v141
    v_mul_f32 v142, s22, v142
    v_mul_f32 v143, s22, v143
    v_cvt_pk_bf16_f32 v108, v108, v109
    v_cvt_pk_bf16_f32 v109, v110, v111
    v_cvt_pk_bf16_f32 v110, v140, v141
    v_cvt_pk_bf16_f32 v111, v142, v143
    buffer_store_dwordx4 v[108:111], v20, s[12:15], s27 offen offset:1024
    v_mul_f32 v48, s22, v48
    v_mul_f32 v49, s22, v49
    v_mul_f32 v50, s22, v50
    v_mul_f32 v51, s22, v51
    v_mul_f32 v80, s22, v80
    v_mul_f32 v81, s22, v81
    v_mul_f32 v82, s22, v82
    v_mul_f32 v83, s22, v83
    v_cvt_pk_bf16_f32 v48, v48, v49
    v_cvt_pk_bf16_f32 v49, v50, v51
    v_cvt_pk_bf16_f32 v50, v80, v81
    v_cvt_pk_bf16_f32 v51, v82, v83
    s_add_u32 s27, s26, 32768
    buffer_store_dwordx4 v[48:51], v20, s[12:15], s27 offen offset:0
    v_mul_f32 v112, s22, v112
    v_mul_f32 v113, s22, v113
    v_mul_f32 v114, s22, v114
    v_mul_f32 v115, s22, v115
    v_mul_f32 v144, s22, v144
    v_mul_f32 v145, s22, v145
    v_mul_f32 v146, s22, v146
    v_mul_f32 v147, s22, v147
    v_cvt_pk_bf16_f32 v112, v112, v113
    v_cvt_pk_bf16_f32 v113, v114, v115
    v_cvt_pk_bf16_f32 v114, v144, v145
    v_cvt_pk_bf16_f32 v115, v146, v147
    buffer_store_dwordx4 v[112:115], v20, s[12:15], s27 offen offset:1024
    v_mul_f32 v52, s22, v52
    v_mul_f32 v53, s22, v53
    v_mul_f32 v54, s22, v54
    v_mul_f32 v55, s22, v55
    v_mul_f32 v84, s22, v84
    v_mul_f32 v85, s22, v85
    v_mul_f32 v86, s22, v86
    v_mul_f32 v87, s22, v87
    v_cvt_pk_bf16_f32 v52, v52, v53
    v_cvt_pk_bf16_f32 v53, v54, v55
    v_cvt_pk_bf16_f32 v54, v84, v85
    v_cvt_pk_bf16_f32 v55, v86, v87
    s_add_u32 s27, s26, 40960
    buffer_store_dwordx4 v[52:55], v20, s[12:15], s27 offen offset:0
    v_mul_f32 v116, s22, v116
    v_mul_f32 v117, s22, v117
    v_mul_f32 v118, s22, v118
    v_mul_f32 v119, s22, v119
    v_mul_f32 v148, s22, v148
    v_mul_f32 v149, s22, v149
    v_mul_f32 v150, s22, v150
    v_mul_f32 v151, s22, v151
    v_cvt_pk_bf16_f32 v116, v116, v117
    v_cvt_pk_bf16_f32 v117, v118, v119
    v_cvt_pk_bf16_f32 v118, v148, v149
    v_cvt_pk_bf16_f32 v119, v150, v151
    buffer_store_dwordx4 v[116:119], v20, s[12:15], s27 offen offset:1024
    v_mul_f32 v56, s22, v56
    v_mul_f32 v57, s22, v57
    v_mul_f32 v58, s22, v58
    v_mul_f32 v59, s22, v59
    v_mul_f32 v88, s22, v88
    v_mul_f32 v89, s22, v89
    v_mul_f32 v90, s22, v90
    v_mul_f32 v91, s22, v91
    v_cvt_pk_bf16_f32 v56, v56, v57
    v_cvt_pk_bf16_f32 v57, v58, v59
    v_cvt_pk_bf16_f32 v58, v88, v89
    v_cvt_pk_bf16_f32 v59, v90, v91
    s_add_u32 s27, s26, 49152
    buffer_store_dwordx4 v[56:59], v20, s[12:15], s27 offen offset:0
    v_mul_f32 v120, s22, v120
    v_mul_f32 v121, s22, v121
    v_mul_f32 v122, s22, v122
    v_mul_f32 v123, s22, v123
    v_mul_f32 v152, s22, v152
    v_mul_f32 v153, s22, v153
    v_mul_f32 v154, s22, v154
    v_mul_f32 v155, s22, v155
    v_cvt_pk_bf16_f32 v120, v120, v121
    v_cvt_pk_bf16_f32 v121, v122, v123
    v_cvt_pk_bf16_f32 v122, v152, v153
    v_cvt_pk_bf16_f32 v123, v154, v155
    buffer_store_dwordx4 v[120:123], v20, s[12:15], s27 offen offset:1024
    v_mul_f32 v60, s22, v60
    v_mul_f32 v61, s22, v61
    v_mul_f32 v62, s22, v62
    v_mul_f32 v63, s22, v63
    v_mul_f32 v92, s22, v92
    v_mul_f32 v93, s22, v93
    v_mul_f32 v94, s22, v94
    v_mul_f32 v95, s22, v95
    v_cvt_pk_bf16_f32 v60, v60, v61
    v_cvt_pk_bf16_f32 v61, v62, v63
    v_cvt_pk_bf16_f32 v62, v92, v93
    v_cvt_pk_bf16_f32 v63, v94, v95
    s_add_u32 s27, s26, 57344
    buffer_store_dwordx4 v[60:63], v20, s[12:15], s27 offen offset:0
    v_mul_f32 v124, s22, v124
    v_mul_f32 v125, s22, v125
    v_mul_f32 v126, s22, v126
    v_mul_f32 v127, s22, v127
    v_mul_f32 v156, s22, v156
    v_mul_f32 v157, s22, v157
    v_mul_f32 v158, s22, v158
    v_mul_f32 v159, s22, v159
    v_cvt_pk_bf16_f32 v124, v124, v125
    v_cvt_pk_bf16_f32 v125, v126, v127
    v_cvt_pk_bf16_f32 v126, v156, v157
    v_cvt_pk_bf16_f32 v127, v158, v159
    buffer_store_dwordx4 v[124:127], v20, s[12:15], s27 offen offset:1024
    s_cmp_ge_u32 s2, 224
    s_cbranch_scc1 K1_noprep
    s_waitcnt vmcnt(16)
    v_mul_u32_u24 v186, 8448, v184
    v_lshl_add_u32 v186, v185, 4, v186
    s_mov_b32 s62, 83886208
    s_mov_b32 s63, 83890432
    v_lshlrev_b32 v192, 16, v160
    v_lshlrev_b32 v193, 16, v161
    v_lshlrev_b32 v194, 16, v162
    v_lshlrev_b32 v195, 16, v163
    v_lshlrev_b32 v196, 16, v164
    v_lshlrev_b32 v197, 16, v165
    v_lshlrev_b32 v198, 16, v166
    v_lshlrev_b32 v199, 16, v167
    v_lshlrev_b32 v200, 16, v168
    v_lshlrev_b32 v201, 16, v169
    v_lshlrev_b32 v202, 16, v170
    v_lshlrev_b32 v204, 16, v180
    v_and_b32 v205, 0xffff0000, v180
    v_lshlrev_b32 v206, 16, v181
    v_and_b32 v207, 0xffff0000, v181
    v_mul_f32 v208, v192, v207
    v_fmac_f32 v208, v193, v206
    v_fmac_f32 v208, v194, v205
    v_fmac_f32 v208, v195, v204
    v_lshlrev_b32 v203, 16, v171
    v_mul_f32 v208, v208, v203
    v_mul_f32 v209, v193, v207
    v_fmac_f32 v209, v194, v206
    v_fmac_f32 v209, v195, v205
    v_fmac_f32 v209, v196, v204
    v_lshlrev_b32 v203, 16, v172
    v_mul_f32 v209, v209, v203
    v_mul_f32 v210, v194, v207
    v_fmac_f32 v210, v195, v206
    v_fmac_f32 v210, v196, v205
    v_fmac_f32 v210, v197, v204
    v_lshlrev_b32 v203, 16, v173
    v_mul_f32 v210, v210, v203
    v_mul_f32 v211, v195, v207
    v_fmac_f32 v211, v196, v206
    v_fmac_f32 v211, v197, v205
    v_fmac_f32 v211, v198, v204
    v_lshlrev_b32 v203, 16, v174
    v_mul_f32 v211, v211, v203
    v_mul_f32 v212, v196, v207
    v_fmac_f32 v212, v197, v206
    v_fmac_f32 v212, v198, v205
    v_fmac_f32 v212, v199, v204
    v_lshlrev_b32 v203, 16, v175
    v_mul_f32 v212, v212, v203
    v_mul_f32 v213, v197, v207
    v_fmac_f32 v213, v198, v206
    v_fmac_f32 v213, v199, v205
    v_fmac_f32 v213, v200, v204
    v_lshlrev_b32 v203, 16, v176
    v_mul_f32 v213, v213, v203
    v_mul_f32 v214, v198, v207
    v_fmac_f32 v214, v199, v206
    v_fmac_f32 v214, v200, v205
    v_fmac_f32 v214, v201, v204
    v_lshlrev_b32 v203, 16, v177
    v_mul_f32 v214, v214, v203
    v_mul_f32 v215, v199, v207
    v_fmac_f32 v215, v200, v206
    v_fmac_f32 v215, v201, v205
    v_fmac_f32 v215, v202, v204
    v_lshlrev_b32 v203, 16, v178
    v_mul_f32 v215, v215, v203
    v_cvt_pk_bf16_f32 v216, v208, v209
    v_cvt_pk_bf16_f32 v217, v210, v211
    v_cvt_pk_bf16_f32 v218, v212, v213
    v_cvt_pk_bf16_f32 v219, v214, v215
    buffer_store_dwordx4 v[216:219], v186, s[12:15], s62 offen
    v_and_b32 v192, 0xffff0000, v160
    v_and_b32 v193, 0xffff0000, v161
    v_and_b32 v194, 0xffff0000, v162
    v_and_b32 v195, 0xffff0000, v163
    v_and_b32 v196, 0xffff0000, v164
    v_and_b32 v197, 0xffff0000, v165
    v_and_b32 v198, 0xffff0000, v166
    v_and_b32 v199, 0xffff0000, v167
    v_and_b32 v200, 0xffff0000, v168
    v_and_b32 v201, 0xffff0000, v169
    v_and_b32 v202, 0xffff0000, v170
    v_lshlrev_b32 v204, 16, v182
    v_and_b32 v205, 0xffff0000, v182
    v_lshlrev_b32 v206, 16, v183
    v_and_b32 v207, 0xffff0000, v183
    v_mul_f32 v220, v192, v207
    v_fmac_f32 v220, v193, v206
    v_fmac_f32 v220, v194, v205
    v_fmac_f32 v220, v195, v204
    v_and_b32 v203, 0xffff0000, v171
    v_mul_f32 v220, v220, v203
    v_mul_f32 v221, v193, v207
    v_fmac_f32 v221, v194, v206
    v_fmac_f32 v221, v195, v205
    v_fmac_f32 v221, v196, v204
    v_and_b32 v203, 0xffff0000, v172
    v_mul_f32 v221, v221, v203
    v_mul_f32 v222, v194, v207
    v_fmac_f32 v222, v195, v206
    v_fmac_f32 v222, v196, v205
    v_fmac_f32 v222, v197, v204
    v_and_b32 v203, 0xffff0000, v173
    v_mul_f32 v222, v222, v203
    v_mul_f32 v223, v195, v207
    v_fmac_f32 v223, v196, v206
    v_fmac_f32 v223, v197, v205
    v_fmac_f32 v223, v198, v204
    v_and_b32 v203, 0xffff0000, v174
    v_mul_f32 v223, v223, v203
    v_mul_f32 v224, v196, v207
    v_fmac_f32 v224, v197, v206
    v_fmac_f32 v224, v198, v205
    v_fmac_f32 v224, v199, v204
    v_and_b32 v203, 0xffff0000, v175
    v_mul_f32 v224, v224, v203
    v_mul_f32 v225, v197, v207
    v_fmac_f32 v225, v198, v206
    v_fmac_f32 v225, v199, v205
    v_fmac_f32 v225, v200, v204
    v_and_b32 v203, 0xffff0000, v176
    v_mul_f32 v225, v225, v203
    v_mul_f32 v226, v198, v207
    v_fmac_f32 v226, v199, v206
    v_fmac_f32 v226, v200, v205
    v_fmac_f32 v226, v201, v204
    v_and_b32 v203, 0xffff0000, v177
    v_mul_f32 v226, v226, v203
    v_mul_f32 v227, v199, v207
    v_fmac_f32 v227, v200, v206
    v_fmac_f32 v227, v201, v205
    v_fmac_f32 v227, v202, v204
    v_and_b32 v203, 0xffff0000, v178
    v_mul_f32 v227, v227, v203
    v_cvt_pk_bf16_f32 v228, v220, v221
    v_cvt_pk_bf16_f32 v229, v222, v223
    v_cvt_pk_bf16_f32 v230, v224, v225
    v_cvt_pk_bf16_f32 v231, v226, v227
    buffer_store_dwordx4 v[228:231], v186, s[12:15], s63 offen
    v_cmp_eq_u32 vcc, 0, v185
    s_and_saveexec_b64 s[60:61], vcc
    s_cbranch_execz ALpz_4
    v_mov_b32 v192, 0
    v_mov_b32 v193, 0
    s_sub_u32 s62, s62, 8
    s_sub_u32 s63, s63, 8
    buffer_store_dwordx2 v[192:193], v186, s[12:15], s62 offen
    buffer_store_dwordx2 v[192:193], v186, s[12:15], s63 offen
ALpz_4:
    s_mov_b64 exec, s[60:61]
K1_noprep:
K1_end:
    s_endpgm
.globl p2_kernel
.p2align 8
.type p2_kernel,@function
p2_kernel:
    s_cmp_ge_u32 s2, 256
    s_cbranch_scc1 K2_end
    s_load_dwordx2 s[66:67], s[0:1], 112
    v_lshrrev_b32 v3, 6, v0
    v_and_b32 v4, 63, v0
    v_lshlrev_b32 v1, 4, v4
    v_readfirstlane_b32 s19, v3
    v_add_u32 v2, 0x10000, v1
    s_and_b32 s20, s2, 7
    s_lshl_b32 s20, s20, 1
    s_bfe_u32 s21, s2, 0x10003
    s_add_u32 s20, s20, s21
    s_lshr_b32 s26, s2, 5
    s_lshl_b32 s16, s19, 13
    s_mov_b32 s24, 1266679808
    v_mov_b32 v7, 0xff800000
    v_and_b32 v5, 15, v4
    v_lshrrev_b32 v6, 4, v4
    v_lshlrev_b32 v6, 2, v6
    v_sub_u32 v5, v5, v6
    v_lshl_add_u32 v5, v3, 4, v5
    v_cmp_gt_i32 s[32:33], 0, v5
    v_cmp_gt_i32 s[34:35], 1, v5
    v_cmp_gt_i32 s[36:37], 2, v5
    v_cmp_gt_i32 s[38:39], 3, v5
    v_cmp_gt_i32 s[40:41], 16, v5
    v_cmp_gt_i32 s[42:43], 17, v5
    v_cmp_gt_i32 s[44:45], 18, v5
    v_cmp_gt_i32 s[46:47], 19, v5
    v_cmp_gt_i32 s[48:49], 32, v5
    v_cmp_gt_i32 s[50:51], 33, v5
    v_cmp_gt_i32 s[52:53], 34, v5
    v_cmp_gt_i32 s[54:55], 35, v5
    v_cmp_gt_i32 s[56:57], 48, v5
    v_cmp_gt_i32 s[58:59], 49, v5
    v_cmp_gt_i32 s[60:61], 50, v5
    v_cmp_gt_i32 s[62:63], 51, v5
    s_lshl_b32 s22, s20, 20
    s_add_u32 s22, s22, s16
    s_lshl_b32 s28, s20, 3
    s_add_u32 s28, s28, s26
    s_lshl_b32 s29, s28, 7
    s_add_u32 s29, s29, 94371840
    s_sub_u32 s23, 15, s26
    s_lshl_b32 s21, s26, 1
    s_bitcmp1_b32 s2, 4
    s_cbranch_scc1 K2_roleB
    s_sub_u32 s21, 14, s21
    s_lshl_b32 s21, s21, 15
    s_add_u32 s8, s22, s21
    s_mov_b32 s9, 18
    s_mov_b32 s10, 3221225472
    s_mov_b32 s11, 0
    s_mov_b32 s14, 3221225472
    s_mov_b32 s17, 8
    s_cmp_eq_u32 s26, 7
    s_cselect_b32 s18, 0, 1
    s_branch K2_go
K2_roleB:
    s_mov_b32 s8, s22
    s_cmp_eq_u32 s26, 7
    s_cbranch_scc1 K2_roleB7
    s_sub_u32 s9, 14, s21
    s_mov_b32 s10, s22
    s_add_u32 s11, s21, 2
    s_add_u32 s14, s22, 16777216
    s_sub_u32 s17, 7, s26
    s_mov_b32 s18, 2
    s_branch K2_go
K2_roleB7:
    s_mov_b32 s9, 16
    s_mov_b32 s10, 3221225472
    s_mov_b32 s11, 0
    s_mov_b32 s14, 3221225472
    s_mov_b32 s17, 7
    s_mov_b32 s18, 0
    s_mov_b32 s23, 7
K2_go:
    s_add_u32 s12, s8, 16777216
    s_mov_b32 s13, s9
    s_mov_b32 s15, s11
    s_lshl_b32 s27, s26, 16
    s_add_u32 s27, s27, s22
    s_add_u32 s27, s27, 33554432
    s_lshl_b32 s21, s23, 16
    s_add_u32 s22, s22, s21
    s_add_u32 s22, s22, 33554432
    s_waitcnt lgkmcnt(0)
    s_mov_b32 s4, s66
    s_mov_b32 s5, s67
    s_mov_b32 s6, 268435456
    s_mov_b32 s7, 0x20000
    s_add_u32 m0, s16, 0
    s_nop 0
    buffer_load_dwordx4 v1, s[4:7], s8 offen offset:0 lds
    buffer_load_dwordx4 v1, s[4:7], s8 offen offset:1024 lds
    buffer_load_dwordx4 v1, s[4:7], s8 offen offset:2048 lds
    buffer_load_dwordx4 v1, s[4:7], s8 offen offset:3072 lds
    s_add_u32 s8, s8, 4096
    s_add_u32 m0, s16, 4096
    s_nop 0
    buffer_load_dwordx4 v1, s[4:7], s8 offen offset:0 lds
    buffer_load_dwordx4 v1, s[4:7], s8 offen offset:1024 lds
    buffer_load_dwordx4 v1, s[4:7], s8 offen offset:2048 lds
    buffer_load_dwordx4 v1, s[4:7], s8 offen offset:3072 lds
    s_add_u32 s8, s8, 28672
    s_sub_u32 s9, s9, 1
    s_cmp_eq_u32 s9, 0
    s_cselect_b32 s8, s10, s8
    s_cselect_b32 s9, s11, s9
    s_cselect_b32 s10, 3221225472, s10
    s_add_u32 s21, s22, 0
    buffer_load_dwordx4 a[0:3], v1, s[4:7], s21 offen offset:0
    buffer_load_dwordx4 a[4:7], v1, s[4:7], s21 offen offset:1024
    buffer_load_dwordx4 a[8:11], v1, s[4:7], s21 offen offset:2048
    buffer_load_dwordx4 a[12:15], v1, s[4:7], s21 offen offset:3072
    s_add_u32 s21, s22, 4096
    buffer_load_dwordx4 a[16:19], v1, s[4:7], s21 offen offset:0
    buffer_load_dwordx4 a[20:23], v1, s[4:7], s21 offen offset:1024
    buffer_load_dwordx4 a[24:27], v1, s[4:7], s21 offen offset:2048
    buffer_load_dwordx4 a[28:31], v1, s[4:7], s21 offen offset:3072
    s_add_u32 s21, s22, 32768
    buffer_load_dwordx4 a[32:35], v1, s[4:7], s21 offen offset:0
    buffer_load_dwordx4 a[36:39], v1, s[4:7], s21 offen offset:1024
    buffer_load_dwordx4 a[40:43], v1, s[4:7], s21 offen offset:2048
    buffer_load_dwordx4 a[44:47], v1, s[4:7], s21 offen offset:3072
    s_add_u32 s21, s22, 36864
    buffer_load_dwordx4 a[48:51], v1, s[4:7], s21 offen offset:0
    buffer_load_dwordx4 a[52:55], v1, s[4:7], s21 offen offset:1024
    buffer_load_dwordx4 a[56:59], v1, s[4:7], s21 offen offset:2048
    buffer_load_dwordx4 a[60:63], v1, s[4:7], s21 offen offset:3072
    s_add_u32 m0, s16, 32768
    s_nop 0
    buffer_load_dwordx4 v1, s[4:7], s8 offen offset:0 lds
    buffer_load_dwordx4 v1, s[4:7], s8 offen offset:1024 lds
    buffer_load_dwordx4 v1, s[4:7], s8 offen offset:2048 lds
    buffer_load_dwordx4 v1, s[4:7], s8 offen offset:3072 lds
    s_add_u32 s8, s8, 4096
    s_add_u32 m0, s16, 36864
    s_nop 0
    buffer_load_dwordx4 v1, s[4:7], s8 offen offset:0 lds
    buffer_load_dwordx4 v1, s[4:7], s8 offen offset:1024 lds
    buffer_load_dwordx4 v1, s[4:7], s8 offen offset:2048 lds
    buffer_load_dwordx4 v1, s[4:7], s8 offen offset:3072 lds
    s_add_u32 s8, s8, 28672
    s_sub_u32 s9, s9, 1
    s_cmp_eq_u32 s9, 0
    s_cselect_b32 s8, s10, s8
    s_cselect_b32 s9, s11, s9
    s_cselect_b32 s10, 3221225472, s10
    s_add_u32 m0, s16, 65536
    s_nop 0
    buffer_load_dwordx4 v1, s[4:7], s12 offen offset:0 lds
    buffer_load_dwordx4 v1, s[4:7], s12 offen offset:1024 lds
    buffer_load_dwordx4 v1, s[4:7], s12 offen offset:2048 lds
    buffer_load_dwordx4 v1, s[4:7], s12 offen offset:3072 lds
    s_add_u32 s12, s12, 4096
    s_add_u32 m0, s16, 69632
    s_nop 0
    buffer_load_dwordx4 v1, s[4:7], s12 offen offset:0 lds
    buffer_load_dwordx4 v1, s[4:7], s12 offen offset:1024 lds
    buffer_load_dwordx4 v1, s[4:7], s12 offen offset:2048 lds
    buffer_load_dwordx4 v1, s[4:7], s12 offen offset:3072 lds
    s_add_u32 s12, s12, 28672
    s_sub_u32 s13, s13, 1
    s_cmp_eq_u32 s13, 0
    s_cselect_b32 s12, s14, s12
    s_cselect_b32 s13, s15, s13
    s_cselect_b32 s14, 3221225472, s14
K2_item:
    v_mov_b32 v128, 0
    v_mov_b32 v129, 0
    v_mov_b32 v130, 0
    v_mov_b32 v131, 0
    v_mov_b32 v132, 0
    v_mov_b32 v133, 0
    v_mov_b32 v134, 0
    v_mov_b32 v135, 0
    v_mov_b32 v136, 0
    v_mov_b32 v137, 0
    v_mov_b32 v138, 0
    v_mov_b32 v139, 0
    v_mov_b32 v140, 0
    v_mov_b32 v141, 0
    v_mov_b32 v142, 0
    v_mov_b32 v143, 0
    v_mov_b32 v144, 0
    v_mov_b32 v145, 0
    v_mov_b32 v146, 0
    v_mov_b32 v147, 0
    v_mov_b32 v148, 0
    v_mov_b32 v149, 0
    v_mov_b32 v150, 0
    v_mov_b32 v151, 0
    v_mov_b32 v152, 0
    v_mov_b32 v153, 0
    v_mov_b32 v154, 0
    v_mov_b32 v155, 0
    v_mov_b32 v156, 0
    v_mov_b32 v157, 0
    v_mov_b32 v158, 0
    v_mov_b32 v159, 0
    v_mov_b32 v160, 0
    v_mov_b32 v161, 0
    v_mov_b32 v162, 0
    v_mov_b32 v163, 0
    v_mov_b32 v164, 0
    v_mov_b32 v165, 0
    v_mov_b32 v166, 0
    v_mov_b32 v167, 0
    v_mov_b32 v168, 0
    v_mov_b32 v169, 0
    v_mov_b32 v170, 0
    v_mov_b32 v171, 0
    v_mov_b32 v172, 0
    v_mov_b32 v173, 0
    v_mov_b32 v174, 0
    v_mov_b32 v175, 0
    v_mov_b32 v176, 0
    v_mov_b32 v177, 0
    v_mov_b32 v178, 0
    v_mov_b32 v179, 0
    v_mov_b32 v180, 0
    v_mov_b32 v181, 0
    v_mov_b32 v182, 0
    v_mov_b32 v183, 0
    v_mov_b32 v184, 0
    v_mov_b32 v185, 0
    v_mov_b32 v186, 0
    v_mov_b32 v187, 0
    v_mov_b32 v188, 0
    v_mov_b32 v189, 0
    v_mov_b32 v190, 0
    v_mov_b32 v191, 0
    v_mov_b32 v192, 0
    v_mov_b32 v193, 0
    v_mov_b32 v194, 0
    v_mov_b32 v195, 0
    v_mov_b32 v196, 0
    v_mov_b32 v197, 0
    v_mov_b32 v198, 0
    v_mov_b32 v199, 0
    v_mov_b32 v200, 0
    v_mov_b32 v201, 0
    v_mov_b32 v202, 0
    v_mov_b32 v203, 0
    v_mov_b32 v204, 0
    v_mov_b32 v205, 0
    v_mov_b32 v206, 0
    v_mov_b32 v207, 0
    v_mov_b32 v208, 0
    v_mov_b32 v209, 0
    v_mov_b32 v210, 0
    v_mov_b32 v211, 0
    v_mov_b32 v212, 0
    v_mov_b32 v213, 0
    v_mov_b32 v214, 0
    v_mov_b32 v215, 0
    v_mov_b32 v216, 0
    v_mov_b32 v217, 0
    v_mov_b32 v218, 0
    v_mov_b32 v219, 0
    v_mov_b32 v220, 0
    v_mov_b32 v221, 0
    v_mov_b32 v222, 0
    v_mov_b32 v223, 0
    v_mov_b32 v224, 0
    v_mov_b32 v225, 0
    v_mov_b32 v226, 0
    v_mov_b32 v227, 0
    v_mov_b32 v228, 0
    v_mov_b32 v229, 0
    v_mov_b32 v230, 0
    v_mov_b32 v231, 0
    v_mov_b32 v232, 0
    v_mov_b32 v233, 0
    v_mov_b32 v234, 0
    v_mov_b32 v235, 0
    v_mov_b32 v236, 0
    v_mov_b32 v237, 0
    v_mov_b32 v238, 0
    v_mov_b32 v239, 0
    v_mov_b32 v240, 0
    v_mov_b32 v241, 0
    v_mov_b32 v242, 0
    v_mov_b32 v243, 0
    v_mov_b32 v244, 0
    v_mov_b32 v245, 0
    v_mov_b32 v246, 0
    v_mov_b32 v247, 0
    v_mov_b32 v248, 0
    v_mov_b32 v249, 0
    v_mov_b32 v250, 0
    v_mov_b32 v251, 0
    v_mov_b32 v252, 0
    v_mov_b32 v253, 0
    v_mov_b32 v254, 0
    v_mov_b32 v255, 0
    v_mov_b32 v24, 0
    v_mov_b32 v25, 0
    s_waitcnt vmcnt(0)
    s_barrier
    s_cmp_lg_u32 s18, 3
    s_cbranch_scc1 K2_noflag
    s_mov_b32 s18, 0
    s_cmp_lg_u32 s19, 0
    s_cbranch_scc1 K2_noflag
    v_mov_b32 v3, 1
    v_mov_b32 v4, 0
    s_mov_b64 exec, 1
    buffer_store_dword v3, v4, s[4:7], s29 offen sc1
    s_mov_b64 exec, -1
    s_waitcnt vmcnt(0)
K2_noflag:
    s_cmp_eq_u32 s17, 0
    s_cbranch_scc1 K2_p0d
    ds_read_b128 a[64:67], v1 offset:0
    ds_read_b128 a[68:71], v1 offset:1024
    ds_read_b128 a[72:75], v1 offset:2048
    ds_read_b128 a[76:79], v1 offset:3072
    ds_read_b128 a[80:83], v1 offset:4096
    ds_read_b128 a[84:87], v1 offset:5120
    ds_read_b128 a[88:91], v1 offset:6144
    ds_read_b128 a[92:95], v1 offset:7168
    s_waitcnt lgkmcnt(7)
    v_mfma_f32_16x16x32_bf16 v[32:35], a[64:67], a[0:3], 0
    s_waitcnt lgkmcnt(6)
    ds_read_b128 a[96:99], v1 offset:8192
    v_mfma_f32_16x16x32_bf16 v[32:35], a[68:71], a[4:7], v[32:35]
    s_waitcnt lgkmcnt(6)
    v_mfma_f32_16x16x32_bf16 v[32:35], a[72:75], a[8:11], v[32:35]
    s_waitcnt lgkmcnt(5)
    ds_read_b128 a[100:103], v1 offset:9216
    v_mfma_f32_16x16x32_bf16 v[32:35], a[76:79], a[12:15], v[32:35]
    s_waitcnt lgkmcnt(5)
    v_mfma_f32_16x16x32_bf16 v[32:35], a[80:83], a[16:19], v[32:35]
    s_waitcnt lgkmcnt(4)
    ds_read_b128 a[104:107], v1 offset:10240
    v_mfma_f32_16x16x32_bf16 v[32:35], a[84:87], a[20:23], v[32:35]
    s_waitcnt lgkmcnt(4)
    v_mfma_f32_16x16x32_bf16 v[32:35], a[88:91], a[24:27], v[32:35]
    s_waitcnt lgkmcnt(3)
    ds_read_b128 a[108:111], v1 offset:11264
    v_mfma_f32_16x16x32_bf16 v[32:35], a[92:95], a[28:31], v[32:35]
    v_mfma_f32_16x16x32_bf16 v[36:39], a[64:67], a[32:35], 0
    ds_read_b128 a[112:115], v1 offset:12288
    v_mfma_f32_16x16x32_bf16 v[36:39], a[68:71], a[36:39], v[36:39]
    v_mfma_f32_16x16x32_bf16 v[36:39], a[72:75], a[40:43], v[36:39]
    ds_read_b128 a[116:119], v1 offset:13312
    v_mfma_f32_16x16x32_bf16 v[36:39], a[76:79], a[44:47], v[36:39]
    v_mfma_f32_16x16x32_bf16 v[36:39], a[80:83], a[48:51], v[36:39]
    ds_read_b128 a[120:123], v1 offset:14336
    v_max3_f32 v28, v32, v33, v34
    v_mfma_f32_16x16x32_bf16 v[36:39], a[84:87], a[52:55], v[36:39]
    v_max_f32 v28, v28, v35
    v_mov_b32 v30, v28
    v_mfma_f32_16x16x32_bf16 v[36:39], a[88:91], a[56:59], v[36:39]
    ds_read_b128 a[124:127], v1 offset:15360
    v_mfma_f32_16x16x32_bf16 v[36:39], a[92:95], a[60:63], v[36:39]
    s_waitcnt lgkmcnt(7)
    v_permlane16_swap_b32 v28, v30
    v_max_f32 v28, v28, v30
    v_mfma_f32_16x16x32_bf16 v[40:43], a[96:99], a[0:3], 0
    s_waitcnt lgkmcnt(6)
    ds_read_b128 a[64:67], v1 offset:16384
    v_mov_b32 v30, v28
    v_mfma_f32_16x16x32_bf16 v[40:43], a[100:103], a[4:7], v[40:43]
    s_waitcnt lgkmcnt(6)
    v_mfma_f32_16x16x32_bf16 v[40:43], a[104:107], a[8:11], v[40:43]
    s_waitcnt lgkmcnt(5)
    ds_read_b128 a[68:71], v1 offset:17408
    v_permlane32_swap_b32 v28, v30
    v_mfma_f32_16x16x32_bf16 v[40:43], a[108:111], a[12:15], v[40:43]
    s_waitcnt lgkmcnt(5)
    v_max_f32 v28, v28, v30
    v_sub_f32 v16, 0, v28
    v_mfma_f32_16x16x32_bf16 v[40:43], a[112:115], a[16:19], v[40:43]
    s_waitcnt lgkmcnt(4)
    ds_read_b128 a[72:75], v1 offset:18432
    v_sub_f32 v17, 0, v28
    v_mfma_f32_16x16x32_bf16 v[40:43], a[116:119], a[20:23], v[40:43]
    s_waitcnt lgkmcnt(4)
    v_sub_f32 v18, 0, v28
    v_sub_f32 v19, 0, v28
    v_mfma_f32_16x16x32_bf16 v[40:43], a[120:123], a[24:27], v[40:43]
    s_waitcnt lgkmcnt(3)
    ds_read_b128 a[76:79], v1 offset:19456
    v_max3_f32 v29, v36, v37, v38
    v_mfma_f32_16x16x32_bf16 v[40:43], a[124:127], a[28:31], v[40:43]
    v_max_f32 v29, v29, v39
    v_mov_b32 v31, v29
    v_mfma_f32_16x16x32_bf16 v[44:47], a[96:99], a[32:35], 0
    ds_read_b128 a[80:83], v1 offset:20480
    v_mfma_f32_16x16x32_bf16 v[44:47], a[100:103], a[36:39], v[44:47]
    v_permlane16_swap_b32 v29, v31
    v_max_f32 v29, v29, v31
    v_mfma_f32_16x16x32_bf16 v[44:47], a[104:107], a[40:43], v[44:47]
    ds_read_b128 a[84:87], v1 offset:21504
    v_mov_b32 v31, v29
    v_mfma_f32_16x16x32_bf16 v[44:47], a[108:111], a[44:47], v[44:47]
    v_mfma_f32_16x16x32_bf16 v[44:47], a[112:115], a[48:51], v[44:47]
    ds_read_b128 a[88:91], v1 offset:22528
    v_permlane32_swap_b32 v29, v31
    v_mfma_f32_16x16x32_bf16 v[44:47], a[116:119], a[52:55], v[44:47]
    v_max_f32 v29, v29, v31
    v_sub_f32 v20, 0, v29
    v_mfma_f32_16x16x32_bf16 v[44:47], a[120:123], a[56:59], v[44:47]
    ds_read_b128 a[92:95], v1 offset:23552
    v_sub_f32 v21, 0, v29
    v_mfma_f32_16x16x32_bf16 v[44:47], a[124:127], a[60:63], v[44:47]
    s_waitcnt lgkmcnt(7)
    v_sub_f32 v22, 0, v29
    v_sub_f32 v23, 0, v29
    v_mfma_f32_16x16x32_bf16 v[48:51], a[64:67], a[0:3], v[16:19]
    s_waitcnt lgkmcnt(6)
    ds_read_b128 a[96:99], v1 offset:24576
    v_mfma_f32_16x16x32_bf16 v[48:51], a[68:71], a[4:7], v[48:51]
    s_waitcnt lgkmcnt(6)
    v_mfma_f32_16x16x32_bf16 v[48:51], a[72:75], a[8:11], v[48:51]
    s_waitcnt lgkmcnt(5)
    ds_read_b128 a[100:103], v1 offset:25600
    v_mfma_f32_16x16x32_bf16 v[48:51], a[76:79], a[12:15], v[48:51]
    s_waitcnt lgkmcnt(5)
    v_mfma_f32_16x16x32_bf16 v[48:51], a[80:83], a[16:19], v[48:51]
    s_waitcnt lgkmcnt(4)
    ds_read_b128 a[104:107], v1 offset:26624
    v_mfma_f32_16x16x32_bf16 v[48:51], a[84:87], a[20:23], v[48:51]
    s_waitcnt lgkmcnt(4)
    v_add_f32 v32, v32, v16
    v_add_f32 v33, v33, v16
    v_add_f32 v34, v34, v16
    v_add_f32 v35, v35, v16
    v_mfma_f32_16x16x32_bf16 v[48:51], a[88:91], a[24:27], v[48:51]
    s_waitcnt lgkmcnt(3)
    ds_read_b128 a[108:111], v1 offset:27648
    v_add_f32 v36, v36, v20
    v_add_f32 v37, v37, v20
    v_add_f32 v38, v38, v20
    v_add_f32 v39, v39, v20
    v_mfma_f32_16x16x32_bf16 v[48:51], a[92:95], a[28:31], v[48:51]
    v_add_f32 v40, v40, v16
    v_add_f32 v41, v41, v16
    v_add_f32 v42, v42, v16
    v_add_f32 v43, v43, v16
    v_mfma_f32_16x16x32_bf16 v[52:55], a[64:67], a[32:35], v[20:23]
    ds_read_b128 a[112:115], v1 offset:28672
    v_add_f32 v44, v44, v20
    v_add_f32 v45, v45, v20
    v_add_f32 v46, v46, v20
    v_add_f32 v47, v47, v20
    v_mfma_f32_16x16x32_bf16 v[52:55], a[68:71], a[36:39], v[52:55]
    v_exp_f32 v8, v32
    v_mfma_f32_16x16x32_bf16 v[52:55], a[72:75], a[40:43], v[52:55]
    ds_read_b128 a[116:119], v1 offset:29696
    v_exp_f32 v9, v33
    v_mfma_f32_16x16x32_bf16 v[52:55], a[76:79], a[44:47], v[52:55]
    v_exp_f32 v10, v34
    v_mfma_f32_16x16x32_bf16 v[52:55], a[80:83], a[48:51], v[52:55]
    ds_read_b128 a[120:123], v1 offset:30720
    v_exp_f32 v11, v35
    v_mfma_f32_16x16x32_bf16 v[52:55], a[84:87], a[52:55], v[52:55]
    v_add_f32 v26, v8, v9
    v_cvt_pk_bf16_f32 v96, v8, v9
    v_add_f32 v26, v26, v10
    v_add_f32 v26, v26, v11
    v_cvt_pk_bf16_f32 v97, v10, v11
    v_mfma_f32_16x16x32_bf16 v[52:55], a[88:91], a[56:59], v[52:55]
    ds_read_b128 a[124:127], v1 offset:31744
    v_exp_f32 v12, v36
    v_mfma_f32_16x16x32_bf16 v[52:55], a[92:95], a[60:63], v[52:55]
    s_waitcnt lgkmcnt(7)
    v_exp_f32 v13, v37
    v_mfma_f32_16x16x32_bf16 v[56:59], a[96:99], a[0:3], v[16:19]
    s_waitcnt lgkmcnt(6)
    ds_read_b128 a[64:67], v1 offset:32768
    v_exp_f32 v14, v38
    v_mfma_f32_16x16x32_bf16 v[56:59], a[100:103], a[4:7], v[56:59]
    s_waitcnt lgkmcnt(6)
    v_exp_f32 v15, v39
    v_mfma_f32_16x16x32_bf16 v[56:59], a[104:107], a[8:11], v[56:59]
    s_waitcnt lgkmcnt(5)
    ds_read_b128 a[68:71], v1 offset:33792
    v_add_f32 v27, v12, v13
    v_cvt_pk_bf16_f32 v104, v12, v13
    v_add_f32 v27, v27, v14
    v_add_f32 v27, v27, v15
    v_cvt_pk_bf16_f32 v105, v14, v15
    v_mfma_f32_16x16x32_bf16 v[56:59], a[108:111], a[12:15], v[56:59]
    s_waitcnt lgkmcnt(5)
    v_exp_f32 v8, v40
    v_mfma_f32_16x16x32_bf16 v[56:59], a[112:115], a[16:19], v[56:59]
    s_waitcnt lgkmcnt(4)
    ds_read_b128 a[72:75], v1 offset:34816
    v_exp_f32 v9, v41
    v_mfma_f32_16x16x32_bf16 v[56:59], a[116:119], a[20:23], v[56:59]
    s_waitcnt lgkmcnt(4)
    v_exp_f32 v10, v42
    v_mfma_f32_16x16x32_bf16 v[56:59], a[120:123], a[24:27], v[56:59]
    s_waitcnt lgkmcnt(3)
    ds_read_b128 a[76:79], v1 offset:35840
    v_exp_f32 v11, v43
    v_mfma_f32_16x16x32_bf16 v[56:59], a[124:127], a[28:31], v[56:59]
    v_add_f32 v26, v26, v8
    v_add_f32 v26, v26, v9
    v_cvt_pk_bf16_f32 v98, v8, v9
    v_add_f32 v26, v26, v10
    v_add_f32 v26, v26, v11
    v_cvt_pk_bf16_f32 v99, v10, v11
    v_mfma_f32_16x16x32_bf16 v[60:63], a[96:99], a[32:35], v[20:23]
    ds_read_b128 a[80:83], v1 offset:36864
    v_exp_f32 v12, v44
    v_mfma_f32_16x16x32_bf16 v[60:63], a[100:103], a[36:39], v[60:63]
    v_exp_f32 v13, v45
    v_mfma_f32_16x16x32_bf16 v[60:63], a[104:107], a[40:43], v[60:63]
    ds_read_b128 a[84:87], v1 offset:37888
    v_exp_f32 v14, v46
    v_mfma_f32_16x16x32_bf16 v[60:63], a[108:111], a[44:47], v[60:63]
    v_exp_f32 v15, v47
    v_mfma_f32_16x16x32_bf16 v[60:63], a[112:115], a[48:51], v[60:63]
    ds_read_b128 a[88:91], v1 offset:38912
    v_add_f32 v27, v27, v12
    v_mfma_f32_16x16x32_bf16 v[60:63], a[116:119], a[52:55], v[60:63]
    v_add_f32 v27, v27, v13
    v_cvt_pk_bf16_f32 v106, v12, v13
    v_mfma_f32_16x16x32_bf16 v[60:63], a[120:123], a[56:59], v[60:63]
    s_waitcnt lgkmcnt(7)
    s_barrier
    ds_read_b128 a[92:95], v1 offset:39936
    v_mfma_f32_16x16x32_bf16 v[60:63], a[124:127], a[60:63], v[60:63]
    s_waitcnt lgkmcnt(7)
    v_add_f32 v27, v27, v14
    v_add_f32 v27, v27, v15
    v_cvt_pk_bf16_f32 v107, v14, v15
    s_branch K2_x1
K2_p0d:
    ds_read_b128 a[64:67], v1 offset:0
    ds_read_b128 a[68:71], v1 offset:1024
    ds_read_b128 a[72:75], v1 offset:2048
    ds_read_b128 a[76:79], v1 offset:3072
    ds_read_b128 a[80:83], v1 offset:4096
    ds_read_b128 a[84:87], v1 offset:5120
    ds_read_b128 a[88:91], v1 offset:6144
    ds_read_b128 a[92:95], v1 offset:7168
    v_cndmask_b32 v32, 0, v7, s[32:33]
    v_cndmask_b32 v33, 0, v7, s[34:35]
    v_cndmask_b32 v34, 0, v7, s[36:37]
    v_cndmask_b32 v35, 0, v7, s[38:39]
    v_cndmask_b32 v40, 0, v7, s[40:41]
    v_cndmask_b32 v41, 0, v7, s[42:43]
    v_cndmask_b32 v42, 0, v7, s[44:45]
    v_cndmask_b32 v43, 0, v7, s[46:47]
    s_waitcnt lgkmcnt(7)
    v_mfma_f32_16x16x32_bf16 v[32:35], a[64:67], a[0:3], v[32:35]
    s_waitcnt lgkmcnt(6)
    ds_read_b128 a[96:99], v1 offset:8192
    v_mfma_f32_16x16x32_bf16 v[32:35], a[68:71], a[4:7], v[32:35]
    s_waitcnt lgkmcnt(6)
    v_mfma_f32_16x16x32_bf16 v[32:35], a[72:75], a[8:11], v[32:35]
    s_waitcnt lgkmcnt(5)
    ds_read_b128 a[100:103], v1 offset:9216
    v_mfma_f32_16x16x32_bf16 v[32:35], a[76:79], a[12:15], v[32:35]
    s_waitcnt lgkmcnt(5)
    v_mfma_f32_16x16x32_bf16 v[32:35], a[80:83], a[16:19], v[32:35]
    s_waitcnt lgkmcnt(4)
    ds_read_b128 a[104:107], v1 offset:10240
    v_mfma_f32_16x16x32_bf16 v[32:35], a[84:87], a[20:23], v[32:35]
    s_waitcnt lgkmcnt(4)
    v_mfma_f32_16x16x32_bf16 v[32:35], a[88:91], a[24:27], v[32:35]
    s_waitcnt lgkmcnt(3)
    ds_read_b128 a[108:111], v1 offset:11264
    v_mfma_f32_16x16x32_bf16 v[32:35], a[92:95], a[28:31], v[32:35]
    v_mfma_f32_16x16x32_bf16 v[36:39], a[64:67], a[32:35], 0
    ds_read_b128 a[112:115], v1 offset:12288
    v_mfma_f32_16x16x32_bf16 v[36:39], a[68:71], a[36:39], v[36:39]
    v_mfma_f32_16x16x32_bf16 v[36:39], a[72:75], a[40:43], v[36:39]
    ds_read_b128 a[116:119], v1 offset:13312
    v_mfma_f32_16x16x32_bf16 v[36:39], a[76:79], a[44:47], v[36:39]
    v_mfma_f32_16x16x32_bf16 v[36:39], a[80:83], a[48:51], v[36:39]
    ds_read_b128 a[120:123], v1 offset:14336
    v_max3_f32 v28, v32, v33, v34
    v_mfma_f32_16x16x32_bf16 v[36:39], a[84:87], a[52:55], v[36:39]
    v_max_f32 v28, v28, v35
    v_mov_b32 v30, v28
    v_mfma_f32_16x16x32_bf16 v[36:39], a[88:91], a[56:59], v[36:39]
    ds_read_b128 a[124:127], v1 offset:15360
    v_mfma_f32_16x16x32_bf16 v[36:39], a[92:95], a[60:63], v[36:39]
    s_waitcnt lgkmcnt(7)
    v_permlane16_swap_b32 v28, v30
    v_max_f32 v28, v28, v30
    v_mfma_f32_16x16x32_bf16 v[40:43], a[96:99], a[0:3], v[40:43]
    s_waitcnt lgkmcnt(6)
    ds_read_b128 a[64:67], v1 offset:16384
    v_mov_b32 v30, v28
    v_mfma_f32_16x16x32_bf16 v[40:43], a[100:103], a[4:7], v[40:43]
    s_waitcnt lgkmcnt(6)
    v_mfma_f32_16x16x32_bf16 v[40:43], a[104:107], a[8:11], v[40:43]
    s_waitcnt lgkmcnt(5)
    ds_read_b128 a[68:71], v1 offset:17408
    v_permlane32_swap_b32 v28, v30
    v_mfma_f32_16x16x32_bf16 v[40:43], a[108:111], a[12:15], v[40:43]
    s_waitcnt lgkmcnt(5)
    v_max_f32 v28, v28, v30
    v_sub_f32 v16, 0, v28
    v_mfma_f32_16x16x32_bf16 v[40:43], a[112:115], a[16:19], v[40:43]
    s_waitcnt lgkmcnt(4)
    ds_read_b128 a[72:75], v1 offset:18432
    v_sub_f32 v17, 0, v28
    v_mfma_f32_16x16x32_bf16 v[40:43], a[116:119], a[20:23], v[40:43]
    s_waitcnt lgkmcnt(4)
    v_sub_f32 v18, 0, v28
    v_sub_f32 v19, 0, v28
    v_mfma_f32_16x16x32_bf16 v[40:43], a[120:123], a[24:27], v[40:43]
    s_waitcnt lgkmcnt(3)
    ds_read_b128 a[76:79], v1 offset:19456
    v_max3_f32 v29, v36, v37, v38
    v_cndmask_b32 v48, v16, v7, s[48:49]
    v_mfma_f32_16x16x32_bf16 v[40:43], a[124:127], a[28:31], v[40:43]
    v_max_f32 v29, v29, v39
    v_mov_b32 v31, v29
    v_cndmask_b32 v49, v16, v7, s[50:51]
    v_mfma_f32_16x16x32_bf16 v[44:47], a[96:99], a[32:35], 0
    ds_read_b128 a[80:83], v1 offset:20480
    v_cndmask_b32 v50, v16, v7, s[52:53]
    v_mfma_f32_16x16x32_bf16 v[44:47], a[100:103], a[36:39], v[44:47]
    v_permlane16_swap_b32 v29, v31
    v_max_f32 v29, v29, v31
    v_cndmask_b32 v51, v16, v7, s[54:55]
    v_mfma_f32_16x16x32_bf16 v[44:47], a[104:107], a[40:43], v[44:47]
    ds_read_b128 a[84:87], v1 offset:21504
    v_mov_b32 v31, v29
    v_mfma_f32_16x16x32_bf16 v[44:47], a[108:111], a[44:47], v[44:47]
    v_cndmask_b32 v56, v16, v7, s[56:57]
    v_cndmask_b32 v57, v16, v7, s[58:59]
    v_mfma_f32_16x16x32_bf16 v[44:47], a[112:115], a[48:51], v[44:47]
    ds_read_b128 a[88:91], v1 offset:22528
    v_permlane32_swap_b32 v29, v31
    v_mfma_f32_16x16x32_bf16 v[44:47], a[116:119], a[52:55], v[44:47]
    v_max_f32 v29, v29, v31
    v_sub_f32 v20, 0, v29
    v_mfma_f32_16x16x32_bf16 v[44:47], a[120:123], a[56:59], v[44:47]
    ds_read_b128 a[92:95], v1 offset:23552
    v_sub_f32 v21, 0, v29
    v_mfma_f32_16x16x32_bf16 v[44:47], a[124:127], a[60:63], v[44:47]
    s_waitcnt lgkmcnt(7)
    v_sub_f32 v22, 0, v29
    v_sub_f32 v23, 0, v29
    v_mfma_f32_16x16x32_bf16 v[48:51], a[64:67], a[0:3], v[48:51]
    s_waitcnt lgkmcnt(6)
    ds_read_b128 a[96:99], v1 offset:24576
    v_cndmask_b32 v58, v16, v7, s[60:61]
    v_mfma_f32_16x16x32_bf16 v[48:51], a[68:71], a[4:7], v[48:51]
    s_waitcnt lgkmcnt(6)
    v_cndmask_b32 v59, v16, v7, s[62:63]
    v_mfma_f32_16x16x32_bf16 v[48:51], a[72:75], a[8:11], v[48:51]
    s_waitcnt lgkmcnt(5)
    ds_read_b128 a[100:103], v1 offset:25600
    v_mfma_f32_16x16x32_bf16 v[48:51], a[76:79], a[12:15], v[48:51]
    s_waitcnt lgkmcnt(5)
    v_mfma_f32_16x16x32_bf16 v[48:51], a[80:83], a[16:19], v[48:51]
    s_waitcnt lgkmcnt(4)
    ds_read_b128 a[104:107], v1 offset:26624
    v_mfma_f32_16x16x32_bf16 v[48:51], a[84:87], a[20:23], v[48:51]
    s_waitcnt lgkmcnt(4)
    v_add_f32 v32, v32, v16
    v_add_f32 v33, v33, v16
    v_add_f32 v34, v34, v16
    v_add_f32 v35, v35, v16
    v_mfma_f32_16x16x32_bf16 v[48:51], a[88:91], a[24:27], v[48:51]
    s_waitcnt lgkmcnt(3)
    ds_read_b128 a[108:111], v1 offset:27648
    v_add_f32 v36, v36, v20
    v_add_f32 v37, v37, v20
    v_add_f32 v38, v38, v20
    v_add_f32 v39, v39, v20
    v_mfma_f32_16x16x32_bf16 v[48:51], a[92:95], a[28:31], v[48:51]
    v_add_f32 v40, v40, v16
    v_add_f32 v41, v41, v16
    v_add_f32 v42, v42, v16
    v_add_f32 v43, v43, v16
    v_mfma_f32_16x16x32_bf16 v[52:55], a[64:67], a[32:35], v[20:23]
    ds_read_b128 a[112:115], v1 offset:28672
    v_add_f32 v44, v44, v20
    v_add_f32 v45, v45, v20
    v_add_f32 v46, v46, v20
    v_add_f32 v47, v47, v20
    v_mfma_f32_16x16x32_bf16 v[52:55], a[68:71], a[36:39], v[52:55]
    v_exp_f32 v8, v32
    v_mfma_f32_16x16x32_bf16 v[52:55], a[72:75], a[40:43], v[52:55]
    ds_read_b128 a[116:119], v1 offset:29696
    v_exp_f32 v9, v33
    v_mfma_f32_16x16x32_bf16 v[52:55], a[76:79], a[44:47], v[52:55]
    v_exp_f32 v10, v34
    v_mfma_f32_16x16x32_bf16 v[52:55], a[80:83], a[48:51], v[52:55]
    ds_read_b128 a[120:123], v1 offset:30720
    v_exp_f32 v11, v35
    v_mfma_f32_16x16x32_bf16 v[52:55], a[84:87], a[52:55], v[52:55]
    v_add_f32 v26, v8, v9
    v_cvt_pk_bf16_f32 v96, v8, v9
    v_add_f32 v26, v26, v10
    v_add_f32 v26, v26, v11
    v_cvt_pk_bf16_f32 v97, v10, v11
    v_mfma_f32_16x16x32_bf16 v[52:55], a[88:91], a[56:59], v[52:55]
    ds_read_b128 a[124:127], v1 offset:31744
    v_exp_f32 v12, v36
    v_mfma_f32_16x16x32_bf16 v[52:55], a[92:95], a[60:63], v[52:55]
    s_waitcnt lgkmcnt(7)
    v_exp_f32 v13, v37
    v_mfma_f32_16x16x32_bf16 v[56:59], a[96:99], a[0:3], v[56:59]
    s_waitcnt lgkmcnt(6)
    ds_read_b128 a[64:67], v1 offset:32768
    v_exp_f32 v14, v38
    v_mfma_f32_16x16x32_bf16 v[56:59], a[100:103], a[4:7], v[56:59]
    s_waitcnt lgkmcnt(6)
    v_exp_f32 v15, v39
    v_mfma_f32_16x16x32_bf16 v[56:59], a[104:107], a[8:11], v[56:59]
    s_waitcnt lgkmcnt(5)
    ds_read_b128 a[68:71], v1 offset:33792
    v_add_f32 v27, v12, v13
    v_cvt_pk_bf16_f32 v104, v12, v13
    v_add_f32 v27, v27, v14
    v_add_f32 v27, v27, v15
    v_cvt_pk_bf16_f32 v105, v14, v15
    v_mfma_f32_16x16x32_bf16 v[56:59], a[108:111], a[12:15], v[56:59]
    s_waitcnt lgkmcnt(5)
    v_exp_f32 v8, v40
    v_mfma_f32_16x16x32_bf16 v[56:59], a[112:115], a[16:19], v[56:59]
    s_waitcnt lgkmcnt(4)
    ds_read_b128 a[72:75], v1 offset:34816
    v_exp_f32 v9, v41
    v_mfma_f32_16x16x32_bf16 v[56:59], a[116:119], a[20:23], v[56:59]
    s_waitcnt lgkmcnt(4)
    v_exp_f32 v10, v42
    v_mfma_f32_16x16x32_bf16 v[56:59], a[120:123], a[24:27], v[56:59]
    s_waitcnt lgkmcnt(3)
    ds_read_b128 a[76:79], v1 offset:35840
    v_exp_f32 v11, v43
    v_mfma_f32_16x16x32_bf16 v[56:59], a[124:127], a[28:31], v[56:59]
    v_add_f32 v26, v26, v8
    v_add_f32 v26, v26, v9
    v_cvt_pk_bf16_f32 v98, v8, v9
    v_add_f32 v26, v26, v10
    v_add_f32 v26, v26, v11
    v_cvt_pk_bf16_f32 v99, v10, v11
    v_mfma_f32_16x16x32_bf16 v[60:63], a[96:99], a[32:35], v[20:23]
    ds_read_b128 a[80:83], v1 offset:36864
    v_exp_f32 v12, v44
    v_mfma_f32_16x16x32_bf16 v[60:63], a[100:103], a[36:39], v[60:63]
    v_exp_f32 v13, v45
    v_mfma_f32_16x16x32_bf16 v[60:63], a[104:107], a[40:43], v[60:63]
    ds_read_b128 a[84:87], v1 offset:37888
    v_exp_f32 v14, v46
    v_mfma_f32_16x16x32_bf16 v[60:63], a[108:111], a[44:47], v[60:63]
    v_exp_f32 v15, v47
    v_mfma_f32_16x16x32_bf16 v[60:63], a[112:115], a[48:51], v[60:63]
    ds_read_b128 a[88:91], v1 offset:38912
    v_add_f32 v27, v27, v12
    v_mfma_f32_16x16x32_bf16 v[60:63], a[116:119], a[52:55], v[60:63]
    v_add_f32 v27, v27, v13
    v_cvt_pk_bf16_f32 v106, v12, v13
    v_mfma_f32_16x16x32_bf16 v[60:63], a[120:123], a[56:59], v[60:63]
    s_waitcnt lgkmcnt(7)
    s_barrier
    ds_read_b128 a[92:95], v1 offset:39936
    v_mfma_f32_16x16x32_bf16 v[60:63], a[124:127], a[60:63], v[60:63]
    s_waitcnt lgkmcnt(6)
    v_add_f32 v27, v27, v14
    v_add_f32 v27, v27, v15
    v_cvt_pk_bf16_f32 v107, v14, v15
    s_branch K2_dx1
    .p2align 6
K2_loop:
    v_mfma_f32_16x16x32_bf16 v[128:131], a[64:67], v[96:99], v[128:131]
    s_add_u32 m0, s16, 98304
    ds_read_b128 a[96:99], v2 offset:8192
    v_add_f32 v24, v24, v26
    v_mfma_f32_16x16x32_bf16 v[128:131], a[68:71], v[100:103], v[128:131]
    buffer_load_dwordx4 v1, s[4:7], s12 offen offset:0 lds
    v_mfma_f32_16x16x32_bf16 v[132:135], a[68:71], v[108:111], v[132:135]
    ds_read_b128 a[100:103], v2 offset:9216
    v_add_f32 v25, v25, v27
    v_mfma_f32_16x16x32_bf16 v[132:135], a[64:67], v[104:107], v[132:135]
    s_waitcnt lgkmcnt(7)
    v_exp_f32 v8, v64
    v_mfma_f32_16x16x32_bf16 v[136:139], a[72:75], v[96:99], v[136:139]
    s_waitcnt lgkmcnt(6)
    ds_read_b128 a[104:107], v2 offset:10240
    v_mfma_f32_16x16x32_bf16 v[136:139], a[76:79], v[100:103], v[136:139]
    buffer_load_dwordx4 v1, s[4:7], s12 offen offset:1024 lds
    v_mfma_f32_16x16x32_bf16 v[140:143], a[76:79], v[108:111], v[140:143]
    ds_read_b128 a[108:111], v2 offset:11264
    v_mfma_f32_16x16x32_bf16 v[140:143], a[72:75], v[104:107], v[140:143]
    s_waitcnt lgkmcnt(7)
    v_exp_f32 v9, v65
    v_mfma_f32_16x16x32_bf16 v[144:147], a[80:83], v[96:99], v[144:147]
    s_waitcnt lgkmcnt(6)
    ds_read_b128 a[112:115], v2 offset:12288
    v_add_f32 v26, v8, v9
    v_mfma_f32_16x16x32_bf16 v[144:147], a[84:87], v[100:103], v[144:147]
    buffer_load_dwordx4 v1, s[4:7], s12 offen offset:2048 lds
    v_mfma_f32_16x16x32_bf16 v[148:151], a[84:87], v[108:111], v[148:151]
    ds_read_b128 a[116:119], v2 offset:13312
    v_cvt_pk_bf16_f32 v112, v8, v9
    v_mfma_f32_16x16x32_bf16 v[148:151], a[80:83], v[104:107], v[148:151]
    s_waitcnt lgkmcnt(7)
    v_exp_f32 v10, v66
    v_mfma_f32_16x16x32_bf16 v[152:155], a[88:91], v[96:99], v[152:155]
    s_waitcnt lgkmcnt(6)
    ds_read_b128 a[120:123], v2 offset:14336
    v_add_f32 v26, v26, v10
    v_mfma_f32_16x16x32_bf16 v[152:155], a[92:95], v[100:103], v[152:155]
    buffer_load_dwordx4 v1, s[4:7], s12 offen offset:3072 lds
    v_mfma_f32_16x16x32_bf16 v[156:159], a[92:95], v[108:111], v[156:159]
    s_add_u32 s12, s12, 4096
    ds_read_b128 a[124:127], v2 offset:15360
    v_mfma_f32_16x16x32_bf16 v[156:159], a[88:91], v[104:107], v[156:159]
    s_waitcnt lgkmcnt(6)
    v_exp_f32 v11, v67
    v_mfma_f32_16x16x32_bf16 v[160:163], a[96:99], v[96:99], v[160:163]
    s_add_u32 m0, s16, 102400
    ds_read_b128 a[64:67], v2 offset:16384
    v_add_f32 v26, v26, v11
    v_mfma_f32_16x16x32_bf16 v[160:163], a[100:103], v[100:103], v[160:163]
    buffer_load_dwordx4 v1, s[4:7], s12 offen offset:0 lds
    v_mfma_f32_16x16x32_bf16 v[164:167], a[100:103], v[108:111], v[164:167]
    ds_read_b128 a[68:71], v2 offset:17408
    v_cvt_pk_bf16_f32 v113, v10, v11
    v_mfma_f32_16x16x32_bf16 v[164:167], a[96:99], v[104:107], v[164:167]
    s_waitcnt lgkmcnt(7)
    v_mfma_f32_16x16x32_bf16 v[168:171], a[104:107], v[96:99], v[168:171]
    s_waitcnt lgkmcnt(6)
    ds_read_b128 a[72:75], v2 offset:18432
    v_mfma_f32_16x16x32_bf16 v[168:171], a[108:111], v[100:103], v[168:171]
    buffer_load_dwordx4 v1, s[4:7], s12 offen offset:1024 lds
    v_mfma_f32_16x16x32_bf16 v[172:175], a[108:111], v[108:111], v[172:175]
    ds_read_b128 a[76:79], v2 offset:19456
    v_mfma_f32_16x16x32_bf16 v[172:175], a[104:107], v[104:107], v[172:175]
    s_waitcnt lgkmcnt(7)
    v_exp_f32 v12, v68
    v_mfma_f32_16x16x32_bf16 v[176:179], a[112:115], v[96:99], v[176:179]
    s_waitcnt lgkmcnt(6)
    ds_read_b128 a[80:83], v2 offset:20480
    v_mfma_f32_16x16x32_bf16 v[176:179], a[116:119], v[100:103], v[176:179]
    buffer_load_dwordx4 v1, s[4:7], s12 offen offset:2048 lds
    v_mfma_f32_16x16x32_bf16 v[180:183], a[116:119], v[108:111], v[180:183]
    ds_read_b128 a[84:87], v2 offset:21504
    v_mfma_f32_16x16x32_bf16 v[180:183], a[112:115], v[104:107], v[180:183]
    s_waitcnt lgkmcnt(7)
    v_exp_f32 v13, v69
    v_mfma_f32_16x16x32_bf16 v[184:187], a[120:123], v[96:99], v[184:187]
    s_waitcnt lgkmcnt(6)
    ds_read_b128 a[88:91], v2 offset:22528
    v_add_f32 v27, v12, v13
    v_mfma_f32_16x16x32_bf16 v[184:187], a[124:127], v[100:103], v[184:187]
    s_waitcnt lgkmcnt(5)
    buffer_load_dwordx4 v1, s[4:7], s12 offen offset:3072 lds
    v_mfma_f32_16x16x32_bf16 v[188:191], a[124:127], v[108:111], v[188:191]
    s_add_u32 s12, s12, 28672
    ds_read_b128 a[92:95], v2 offset:23552
    v_cvt_pk_bf16_f32 v120, v12, v13
    v_mfma_f32_16x16x32_bf16 v[188:191], a[120:123], v[104:107], v[188:191]
    s_sub_u32 s13, s13, 1
    v_exp_f32 v14, v70
    v_mfma_f32_16x16x32_bf16 v[192:195], a[64:67], v[96:99], v[192:195]
    s_cmp_eq_u32 s13, 0
    ds_read_b128 a[96:99], v2 offset:24576
    v_add_f32 v27, v27, v14
    v_mfma_f32_16x16x32_bf16 v[192:195], a[68:71], v[100:103], v[192:195]
    s_cselect_b32 s12, s14, s12
    v_mfma_f32_16x16x32_bf16 v[196:199], a[68:71], v[108:111], v[196:199]
    s_waitcnt lgkmcnt(6)
    s_cselect_b32 s13, s15, s13
    ds_read_b128 a[100:103], v2 offset:25600
    v_mfma_f32_16x16x32_bf16 v[196:199], a[64:67], v[104:107], v[196:199]
    s_cselect_b32 s14, 3221225472, s14
    v_exp_f32 v15, v71
    v_mfma_f32_16x16x32_bf16 v[200:203], a[72:75], v[96:99], v[200:203]
    s_waitcnt lgkmcnt(6)
    ds_read_b128 a[104:107], v2 offset:26624
    v_add_f32 v27, v27, v15
    v_mfma_f32_16x16x32_bf16 v[200:203], a[76:79], v[100:103], v[200:203]
    v_exp_f32 v8, v72
    v_mfma_f32_16x16x32_bf16 v[204:207], a[76:79], v[108:111], v[204:207]
    ds_read_b128 a[108:111], v2 offset:27648
    v_cvt_pk_bf16_f32 v121, v14, v15
    v_mfma_f32_16x16x32_bf16 v[204:207], a[72:75], v[104:107], v[204:207]
    s_waitcnt lgkmcnt(7)
    v_exp_f32 v9, v73
    v_mfma_f32_16x16x32_bf16 v[208:211], a[80:83], v[96:99], v[208:211]
    s_waitcnt lgkmcnt(6)
    ds_read_b128 a[112:115], v2 offset:28672
    v_add_f32 v26, v26, v8
    v_mfma_f32_16x16x32_bf16 v[208:211], a[84:87], v[100:103], v[208:211]
    v_add_f32 v26, v26, v9
    v_cvt_pk_bf16_f32 v114, v8, v9
    v_mfma_f32_16x16x32_bf16 v[212:215], a[84:87], v[108:111], v[212:215]
    ds_read_b128 a[116:119], v2 offset:29696
    v_mfma_f32_16x16x32_bf16 v[212:215], a[80:83], v[104:107], v[212:215]
    s_waitcnt lgkmcnt(7)
    v_exp_f32 v10, v74
    v_mfma_f32_16x16x32_bf16 v[216:219], a[88:91], v[96:99], v[216:219]
    s_waitcnt lgkmcnt(6)
    ds_read_b128 a[120:123], v2 offset:30720
    v_add_f32 v26, v26, v10
    v_mfma_f32_16x16x32_bf16 v[216:219], a[92:95], v[100:103], v[216:219]
    v_exp_f32 v11, v75
    v_mfma_f32_16x16x32_bf16 v[220:223], a[92:95], v[108:111], v[220:223]
    ds_read_b128 a[124:127], v2 offset:31744
    v_add_f32 v26, v26, v11
    v_mfma_f32_16x16x32_bf16 v[220:223], a[88:91], v[104:107], v[220:223]
    s_waitcnt vmcnt(8) lgkmcnt(7)
    s_barrier
    v_cvt_pk_bf16_f32 v115, v10, v11
    v_mfma_f32_16x16x32_bf16 v[224:227], a[96:99], v[96:99], v[224:227]
    s_waitcnt lgkmcnt(6)
    ds_read_b128 a[64:67], v1 offset:0
    v_mfma_f32_16x16x32_bf16 v[224:227], a[100:103], v[100:103], v[224:227]
    v_exp_f32 v12, v76
    v_mfma_f32_16x16x32_bf16 v[228:231], a[100:103], v[108:111], v[228:231]
    ds_read_b128 a[68:71], v1 offset:1024
    v_add_f32 v27, v27, v12
    v_mfma_f32_16x16x32_bf16 v[228:231], a[96:99], v[104:107], v[228:231]
    s_waitcnt lgkmcnt(7)
    v_mfma_f32_16x16x32_bf16 v[232:235], a[104:107], v[96:99], v[232:235]
    s_waitcnt lgkmcnt(6)
    ds_read_b128 a[72:75], v1 offset:2048
    v_mfma_f32_16x16x32_bf16 v[232:235], a[108:111], v[100:103], v[232:235]
    v_exp_f32 v13, v77
    v_mfma_f32_16x16x32_bf16 v[236:239], a[108:111], v[108:111], v[236:239]
    ds_read_b128 a[76:79], v1 offset:3072
    v_add_f32 v27, v27, v13
    v_mfma_f32_16x16x32_bf16 v[236:239], a[104:107], v[104:107], v[236:239]
    s_waitcnt lgkmcnt(7)
    v_exp_f32 v14, v78
    v_mfma_f32_16x16x32_bf16 v[240:243], a[112:115], v[96:99], v[240:243]
    s_waitcnt lgkmcnt(6)
    ds_read_b128 a[80:83], v1 offset:4096
    v_cvt_pk_bf16_f32 v122, v12, v13
    v_mfma_f32_16x16x32_bf16 v[240:243], a[116:119], v[100:103], v[240:243]
    v_exp_f32 v15, v79
    v_mfma_f32_16x16x32_bf16 v[244:247], a[116:119], v[108:111], v[244:247]
    ds_read_b128 a[84:87], v1 offset:5120
    v_add_f32 v27, v27, v14
    v_mfma_f32_16x16x32_bf16 v[244:247], a[112:115], v[104:107], v[244:247]
    s_waitcnt lgkmcnt(7)
    v_add_f32 v27, v27, v15
    v_cvt_pk_bf16_f32 v123, v14, v15
    v_mfma_f32_16x16x32_bf16 v[248:251], a[120:123], v[96:99], v[248:251]
    s_waitcnt lgkmcnt(6)
    ds_read_b128 a[88:91], v1 offset:6144
    v_mfma_f32_16x16x32_bf16 v[248:251], a[124:127], v[100:103], v[248:251]
    v_mfma_f32_16x16x32_bf16 v[252:255], a[124:127], v[108:111], v[252:255]
    ds_read_b128 a[92:95], v1 offset:7168
    v_mfma_f32_16x16x32_bf16 v[252:255], a[120:123], v[104:107], v[252:255]
    s_waitcnt lgkmcnt(7)
    v_mfma_f32_16x16x32_bf16 v[32:35], a[64:67], a[0:3], v[16:19]
    s_waitcnt lgkmcnt(6)
    s_add_u32 m0, s16, 32768
    ds_read_b128 a[96:99], v1 offset:8192
    v_mfma_f32_16x16x32_bf16 v[32:35], a[68:71], a[4:7], v[32:35]
    s_waitcnt lgkmcnt(6)
    buffer_load_dwordx4 v1, s[4:7], s8 offen offset:0 lds
    v_mfma_f32_16x16x32_bf16 v[32:35], a[72:75], a[8:11], v[32:35]
    s_waitcnt lgkmcnt(5)
    ds_read_b128 a[100:103], v1 offset:9216
    v_mfma_f32_16x16x32_bf16 v[32:35], a[76:79], a[12:15], v[32:35]
    s_waitcnt lgkmcnt(5)
    v_exp_f32 v8, v80
    v_mfma_f32_16x16x32_bf16 v[32:35], a[80:83], a[16:19], v[32:35]
    s_waitcnt lgkmcnt(4)
    ds_read_b128 a[104:107], v1 offset:10240
    v_add_f32 v26, v26, v8
    v_mfma_f32_16x16x32_bf16 v[32:35], a[84:87], a[20:23], v[32:35]
    s_waitcnt lgkmcnt(4)
    buffer_load_dwordx4 v1, s[4:7], s8 offen offset:1024 lds
    v_mfma_f32_16x16x32_bf16 v[32:35], a[88:91], a[24:27], v[32:35]
    s_waitcnt lgkmcnt(3)
    ds_read_b128 a[108:111], v1 offset:11264
    v_mfma_f32_16x16x32_bf16 v[32:35], a[92:95], a[28:31], v[32:35]
    v_exp_f32 v9, v81
    v_mfma_f32_16x16x32_bf16 v[36:39], a[64:67], a[32:35], v[20:23]
    ds_read_b128 a[112:115], v1 offset:12288
    v_add_f32 v26, v26, v9
    v_mfma_f32_16x16x32_bf16 v[36:39], a[68:71], a[36:39], v[36:39]
    buffer_load_dwordx4 v1, s[4:7], s8 offen offset:2048 lds
    v_mfma_f32_16x16x32_bf16 v[36:39], a[72:75], a[40:43], v[36:39]
    ds_read_b128 a[116:119], v1 offset:13312
    v_cvt_pk_bf16_f32 v116, v8, v9
    v_mfma_f32_16x16x32_bf16 v[36:39], a[76:79], a[44:47], v[36:39]
    v_exp_f32 v10, v82
    v_mfma_f32_16x16x32_bf16 v[36:39], a[80:83], a[48:51], v[36:39]
    ds_read_b128 a[120:123], v1 offset:14336
    v_add_f32 v26, v26, v10
    v_mfma_f32_16x16x32_bf16 v[36:39], a[84:87], a[52:55], v[36:39]
    buffer_load_dwordx4 v1, s[4:7], s8 offen offset:3072 lds
    v_mfma_f32_16x16x32_bf16 v[36:39], a[88:91], a[56:59], v[36:39]
    s_add_u32 s8, s8, 4096
    ds_read_b128 a[124:127], v1 offset:15360
    v_mfma_f32_16x16x32_bf16 v[36:39], a[92:95], a[60:63], v[36:39]
    s_waitcnt lgkmcnt(6)
    v_exp_f32 v11, v83
    v_mfma_f32_16x16x32_bf16 v[40:43], a[96:99], a[0:3], v[16:19]
    s_add_u32 m0, s16, 36864
    ds_read_b128 a[64:67], v1 offset:16384
    v_add_f32 v26, v26, v11
    v_mfma_f32_16x16x32_bf16 v[40:43], a[100:103], a[4:7], v[40:43]
    s_waitcnt lgkmcnt(6)
    buffer_load_dwordx4 v1, s[4:7], s8 offen offset:0 lds
    v_mfma_f32_16x16x32_bf16 v[40:43], a[104:107], a[8:11], v[40:43]
    s_waitcnt lgkmcnt(5)
    ds_read_b128 a[68:71], v1 offset:17408
    v_cvt_pk_bf16_f32 v117, v10, v11
    v_mfma_f32_16x16x32_bf16 v[40:43], a[108:111], a[12:15], v[40:43]
    s_waitcnt lgkmcnt(5)
    v_mfma_f32_16x16x32_bf16 v[40:43], a[112:115], a[16:19], v[40:43]
    s_waitcnt lgkmcnt(4)
    ds_read_b128 a[72:75], v1 offset:18432
    v_mfma_f32_16x16x32_bf16 v[40:43], a[116:119], a[20:23], v[40:43]
    s_waitcnt lgkmcnt(4)
    buffer_load_dwordx4 v1, s[4:7], s8 offen offset:1024 lds
    v_mfma_f32_16x16x32_bf16 v[40:43], a[120:123], a[24:27], v[40:43]
    s_waitcnt lgkmcnt(3)
    ds_read_b128 a[76:79], v1 offset:19456
    v_mfma_f32_16x16x32_bf16 v[40:43], a[124:127], a[28:31], v[40:43]
    v_exp_f32 v12, v84
    v_mfma_f32_16x16x32_bf16 v[44:47], a[96:99], a[32:35], v[20:23]
    ds_read_b128 a[80:83], v1 offset:20480
    v_add_f32 v27, v27, v12
    v_mfma_f32_16x16x32_bf16 v[44:47], a[100:103], a[36:39], v[44:47]
    buffer_load_dwordx4 v1, s[4:7], s8 offen offset:2048 lds
    v_mfma_f32_16x16x32_bf16 v[44:47], a[104:107], a[40:43], v[44:47]
    ds_read_b128 a[84:87], v1 offset:21504
    v_mfma_f32_16x16x32_bf16 v[44:47], a[108:111], a[44:47], v[44:47]
    v_exp_f32 v13, v85
    v_mfma_f32_16x16x32_bf16 v[44:47], a[112:115], a[48:51], v[44:47]
    ds_read_b128 a[88:91], v1 offset:22528
    v_add_f32 v27, v27, v13
    v_mfma_f32_16x16x32_bf16 v[44:47], a[116:119], a[52:55], v[44:47]
    s_waitcnt lgkmcnt(3)
    buffer_load_dwordx4 v1, s[4:7], s8 offen offset:3072 lds
    v_mfma_f32_16x16x32_bf16 v[44:47], a[120:123], a[56:59], v[44:47]
    s_add_u32 s8, s8, 28672
    ds_read_b128 a[92:95], v1 offset:23552
    v_cvt_pk_bf16_f32 v124, v12, v13
    v_mfma_f32_16x16x32_bf16 v[44:47], a[124:127], a[60:63], v[44:47]
    s_sub_u32 s9, s9, 1
    v_exp_f32 v14, v86
    v_mfma_f32_16x16x32_bf16 v[48:51], a[64:67], a[0:3], v[16:19]
    s_cmp_eq_u32 s9, 0
    ds_read_b128 a[96:99], v1 offset:24576
    v_add_f32 v27, v27, v14
    v_mfma_f32_16x16x32_bf16 v[48:51], a[68:71], a[4:7], v[48:51]
    s_cselect_b32 s8, s10, s8
    v_exp_f32 v15, v87
    v_mfma_f32_16x16x32_bf16 v[48:51], a[72:75], a[8:11], v[48:51]
    s_cselect_b32 s9, s11, s9
    ds_read_b128 a[100:103], v1 offset:25600
    v_add_f32 v27, v27, v15
    v_mfma_f32_16x16x32_bf16 v[48:51], a[76:79], a[12:15], v[48:51]
    s_waitcnt lgkmcnt(5)
    s_cselect_b32 s10, 3221225472, s10
    v_cvt_pk_bf16_f32 v125, v14, v15
    v_mfma_f32_16x16x32_bf16 v[48:51], a[80:83], a[16:19], v[48:51]
    s_waitcnt lgkmcnt(4)
    ds_read_b128 a[104:107], v1 offset:26624
    v_mfma_f32_16x16x32_bf16 v[48:51], a[84:87], a[20:23], v[48:51]
    s_waitcnt lgkmcnt(4)
    v_exp_f32 v8, v88
    v_mfma_f32_16x16x32_bf16 v[48:51], a[88:91], a[24:27], v[48:51]
    s_waitcnt lgkmcnt(3)
    ds_read_b128 a[108:111], v1 offset:27648
    v_add_f32 v26, v26, v8
    v_mfma_f32_16x16x32_bf16 v[48:51], a[92:95], a[28:31], v[48:51]
    v_exp_f32 v9, v89
    v_mfma_f32_16x16x32_bf16 v[52:55], a[64:67], a[32:35], v[20:23]
    ds_read_b128 a[112:115], v1 offset:28672
    v_add_f32 v26, v26, v9
    v_mfma_f32_16x16x32_bf16 v[52:55], a[68:71], a[36:39], v[52:55]
    v_exp_f32 v10, v90
    v_mfma_f32_16x16x32_bf16 v[52:55], a[72:75], a[40:43], v[52:55]
    ds_read_b128 a[116:119], v1 offset:29696
    v_cvt_pk_bf16_f32 v118, v8, v9
    v_mfma_f32_16x16x32_bf16 v[52:55], a[76:79], a[44:47], v[52:55]
    v_exp_f32 v11, v91
    v_mfma_f32_16x16x32_bf16 v[52:55], a[80:83], a[48:51], v[52:55]
    ds_read_b128 a[120:123], v1 offset:30720
    v_add_f32 v26, v26, v10
    v_mfma_f32_16x16x32_bf16 v[52:55], a[84:87], a[52:55], v[52:55]
    v_add_f32 v26, v26, v11
    v_cvt_pk_bf16_f32 v119, v10, v11
    v_mfma_f32_16x16x32_bf16 v[52:55], a[88:91], a[56:59], v[52:55]
    ds_read_b128 a[124:127], v1 offset:31744
    v_mfma_f32_16x16x32_bf16 v[52:55], a[92:95], a[60:63], v[52:55]
    s_waitcnt vmcnt(8) lgkmcnt(7)
    s_barrier
    v_mfma_f32_16x16x32_bf16 v[56:59], a[96:99], a[0:3], v[16:19]
    s_waitcnt lgkmcnt(6)
    ds_read_b128 a[64:67], v2 offset:32768
    v_mfma_f32_16x16x32_bf16 v[56:59], a[100:103], a[4:7], v[56:59]
    s_waitcnt lgkmcnt(6)
    v_exp_f32 v12, v92
    v_mfma_f32_16x16x32_bf16 v[56:59], a[104:107], a[8:11], v[56:59]
    s_waitcnt lgkmcnt(5)
    ds_read_b128 a[68:71], v2 offset:33792
    v_add_f32 v27, v27, v12
    v_mfma_f32_16x16x32_bf16 v[56:59], a[108:111], a[12:15], v[56:59]
    s_waitcnt lgkmcnt(5)
    v_exp_f32 v13, v93
    v_mfma_f32_16x16x32_bf16 v[56:59], a[112:115], a[16:19], v[56:59]
    s_waitcnt lgkmcnt(4)
    ds_read_b128 a[72:75], v2 offset:34816
    v_add_f32 v27, v27, v13
    v_mfma_f32_16x16x32_bf16 v[56:59], a[116:119], a[20:23], v[56:59]
    s_waitcnt lgkmcnt(4)
    v_exp_f32 v14, v94
    v_mfma_f32_16x16x32_bf16 v[56:59], a[120:123], a[24:27], v[56:59]
    s_waitcnt lgkmcnt(3)
    ds_read_b128 a[76:79], v2 offset:35840
    v_cvt_pk_bf16_f32 v126, v12, v13
    v_mfma_f32_16x16x32_bf16 v[56:59], a[124:127], a[28:31], v[56:59]
    v_exp_f32 v15, v95
    v_mfma_f32_16x16x32_bf16 v[60:63], a[96:99], a[32:35], v[20:23]
    ds_read_b128 a[80:83], v2 offset:36864
    v_add_f32 v27, v27, v14
    v_mfma_f32_16x16x32_bf16 v[60:63], a[100:103], a[36:39], v[60:63]
    v_add_f32 v27, v27, v15
    v_cvt_pk_bf16_f32 v127, v14, v15
    v_mfma_f32_16x16x32_bf16 v[60:63], a[104:107], a[40:43], v[60:63]
    ds_read_b128 a[84:87], v2 offset:37888
    v_add_f32 v28, v26, v27
    v_mfma_f32_16x16x32_bf16 v[60:63], a[108:111], a[44:47], v[60:63]
    v_cmp_nge_f32 vcc, s24, v28
    v_mfma_f32_16x16x32_bf16 v[60:63], a[112:115], a[48:51], v[60:63]
    ds_read_b128 a[88:91], v2 offset:38912
    v_mfma_f32_16x16x32_bf16 v[60:63], a[116:119], a[52:55], v[60:63]
    v_mfma_f32_16x16x32_bf16 v[60:63], a[120:123], a[56:59], v[60:63]
    ds_read_b128 a[92:95], v2 offset:39936
    v_mfma_f32_16x16x32_bf16 v[60:63], a[124:127], a[60:63], v[60:63]
    s_waitcnt lgkmcnt(6)
    s_cbranch_vccnz BLstub_1
BLback_2:
    v_mfma_f32_16x16x32_bf16 v[128:131], a[64:67], v[112:115], v[128:131]
    s_add_u32 m0, s16, 65536
    ds_read_b128 a[96:99], v2 offset:40960
    v_add_f32 v24, v24, v26
    v_mfma_f32_16x16x32_bf16 v[128:131], a[68:71], v[116:119], v[128:131]
    buffer_load_dwordx4 v1, s[4:7], s12 offen offset:0 lds
    v_mfma_f32_16x16x32_bf16 v[132:135], a[68:71], v[124:127], v[132:135]
    ds_read_b128 a[100:103], v2 offset:41984
    v_add_f32 v25, v25, v27
    v_mfma_f32_16x16x32_bf16 v[132:135], a[64:67], v[120:123], v[132:135]
    s_waitcnt lgkmcnt(7)
    v_exp_f32 v8, v32
    v_mfma_f32_16x16x32_bf16 v[136:139], a[72:75], v[112:115], v[136:139]
    s_waitcnt lgkmcnt(6)
    ds_read_b128 a[104:107], v2 offset:43008
    v_mfma_f32_16x16x32_bf16 v[136:139], a[76:79], v[116:119], v[136:139]
    buffer_load_dwordx4 v1, s[4:7], s12 offen offset:1024 lds
    v_mfma_f32_16x16x32_bf16 v[140:143], a[76:79], v[124:127], v[140:143]
    ds_read_b128 a[108:111], v2 offset:44032
    v_mfma_f32_16x16x32_bf16 v[140:143], a[72:75], v[120:123], v[140:143]
    s_waitcnt lgkmcnt(7)
    v_exp_f32 v9, v33
    v_mfma_f32_16x16x32_bf16 v[144:147], a[80:83], v[112:115], v[144:147]
    s_waitcnt lgkmcnt(6)
    ds_read_b128 a[112:115], v2 offset:45056
    v_add_f32 v26, v8, v9
    v_mfma_f32_16x16x32_bf16 v[144:147], a[84:87], v[116:119], v[144:147]
    buffer_load_dwordx4 v1, s[4:7], s12 offen offset:2048 lds
    v_mfma_f32_16x16x32_bf16 v[148:151], a[84:87], v[124:127], v[148:151]
    ds_read_b128 a[116:119], v2 offset:46080
    v_cvt_pk_bf16_f32 v96, v8, v9
    v_mfma_f32_16x16x32_bf16 v[148:151], a[80:83], v[120:123], v[148:151]
    s_waitcnt lgkmcnt(7)
    v_exp_f32 v10, v34
    v_mfma_f32_16x16x32_bf16 v[152:155], a[88:91], v[112:115], v[152:155]
    s_waitcnt lgkmcnt(6)
    ds_read_b128 a[120:123], v2 offset:47104
    v_add_f32 v26, v26, v10
    v_mfma_f32_16x16x32_bf16 v[152:155], a[92:95], v[116:119], v[152:155]
    buffer_load_dwordx4 v1, s[4:7], s12 offen offset:3072 lds
    v_mfma_f32_16x16x32_bf16 v[156:159], a[92:95], v[124:127], v[156:159]
    s_add_u32 s12, s12, 4096
    ds_read_b128 a[124:127], v2 offset:48128
    v_mfma_f32_16x16x32_bf16 v[156:159], a[88:91], v[120:123], v[156:159]
    s_waitcnt lgkmcnt(6)
    v_exp_f32 v11, v35
    v_mfma_f32_16x16x32_bf16 v[160:163], a[96:99], v[112:115], v[160:163]
    s_add_u32 m0, s16, 69632
    ds_read_b128 a[64:67], v2 offset:49152
    v_add_f32 v26, v26, v11
    v_mfma_f32_16x16x32_bf16 v[160:163], a[100:103], v[116:119], v[160:163]
    buffer_load_dwordx4 v1, s[4:7], s12 offen offset:0 lds
    v_mfma_f32_16x16x32_bf16 v[164:167], a[100:103], v[124:127], v[164:167]
    ds_read_b128 a[68:71], v2 offset:50176
    v_cvt_pk_bf16_f32 v97, v10, v11
    v_mfma_f32_16x16x32_bf16 v[164:167], a[96:99], v[120:123], v[164:167]
    s_waitcnt lgkmcnt(7)
    v_mfma_f32_16x16x32_bf16 v[168:171], a[104:107], v[112:115], v[168:171]
    s_waitcnt lgkmcnt(6)
    ds_read_b128 a[72:75], v2 offset:51200
    v_mfma_f32_16x16x32_bf16 v[168:171], a[108:111], v[116:119], v[168:171]
    buffer_load_dwordx4 v1, s[4:7], s12 offen offset:1024 lds
    v_mfma_f32_16x16x32_bf16 v[172:175], a[108:111], v[124:127], v[172:175]
    ds_read_b128 a[76:79], v2 offset:52224
    v_mfma_f32_16x16x32_bf16 v[172:175], a[104:107], v[120:123], v[172:175]
    s_waitcnt lgkmcnt(7)
    v_exp_f32 v12, v36
    v_mfma_f32_16x16x32_bf16 v[176:179], a[112:115], v[112:115], v[176:179]
    s_waitcnt lgkmcnt(6)
    ds_read_b128 a[80:83], v2 offset:53248
    v_mfma_f32_16x16x32_bf16 v[176:179], a[116:119], v[116:119], v[176:179]
    buffer_load_dwordx4 v1, s[4:7], s12 offen offset:2048 lds
    v_mfma_f32_16x16x32_bf16 v[180:183], a[116:119], v[124:127], v[180:183]
    ds_read_b128 a[84:87], v2 offset:54272
    v_mfma_f32_16x16x32_bf16 v[180:183], a[112:115], v[120:123], v[180:183]
    s_waitcnt lgkmcnt(7)
    v_exp_f32 v13, v37
    v_mfma_f32_16x16x32_bf16 v[184:187], a[120:123], v[112:115], v[184:187]
    s_waitcnt lgkmcnt(6)
    ds_read_b128 a[88:91], v2 offset:55296
    v_add_f32 v27, v12, v13
    v_mfma_f32_16x16x32_bf16 v[184:187], a[124:127], v[116:119], v[184:187]
    s_waitcnt lgkmcnt(5)
    buffer_load_dwordx4 v1, s[4:7], s12 offen offset:3072 lds
    v_mfma_f32_16x16x32_bf16 v[188:191], a[124:127], v[124:127], v[188:191]
    s_add_u32 s12, s12, 28672
    ds_read_b128 a[92:95], v2 offset:56320
    v_cvt_pk_bf16_f32 v104, v12, v13
    v_mfma_f32_16x16x32_bf16 v[188:191], a[120:123], v[120:123], v[188:191]
    s_sub_u32 s13, s13, 1
    v_exp_f32 v14, v38
    v_mfma_f32_16x16x32_bf16 v[192:195], a[64:67], v[112:115], v[192:195]
    s_cmp_eq_u32 s13, 0
    ds_read_b128 a[96:99], v2 offset:57344
    v_add_f32 v27, v27, v14
    v_mfma_f32_16x16x32_bf16 v[192:195], a[68:71], v[116:119], v[192:195]
    s_cselect_b32 s12, s14, s12
    v_mfma_f32_16x16x32_bf16 v[196:199], a[68:71], v[124:127], v[196:199]
    s_waitcnt lgkmcnt(6)
    s_cselect_b32 s13, s15, s13
    ds_read_b128 a[100:103], v2 offset:58368
    v_mfma_f32_16x16x32_bf16 v[196:199], a[64:67], v[120:123], v[196:199]
    s_cselect_b32 s14, 3221225472, s14
    v_exp_f32 v15, v39
    v_mfma_f32_16x16x32_bf16 v[200:203], a[72:75], v[112:115], v[200:203]
    s_waitcnt lgkmcnt(6)
    ds_read_b128 a[104:107], v2 offset:59392
    v_add_f32 v27, v27, v15
    v_mfma_f32_16x16x32_bf16 v[200:203], a[76:79], v[116:119], v[200:203]
    v_exp_f32 v8, v40
    v_mfma_f32_16x16x32_bf16 v[204:207], a[76:79], v[124:127], v[204:207]
    ds_read_b128 a[108:111], v2 offset:60416
    v_cvt_pk_bf16_f32 v105, v14, v15
    v_mfma_f32_16x16x32_bf16 v[204:207], a[72:75], v[120:123], v[204:207]
    s_waitcnt lgkmcnt(7)
    v_exp_f32 v9, v41
    v_mfma_f32_16x16x32_bf16 v[208:211], a[80:83], v[112:115], v[208:211]
    s_waitcnt lgkmcnt(6)
    ds_read_b128 a[112:115], v2 offset:61440
    v_add_f32 v26, v26, v8
    v_mfma_f32_16x16x32_bf16 v[208:211], a[84:87], v[116:119], v[208:211]
    v_add_f32 v26, v26, v9
    v_cvt_pk_bf16_f32 v98, v8, v9
    v_mfma_f32_16x16x32_bf16 v[212:215], a[84:87], v[124:127], v[212:215]
    ds_read_b128 a[116:119], v2 offset:62464
    v_mfma_f32_16x16x32_bf16 v[212:215], a[80:83], v[120:123], v[212:215]
    s_waitcnt lgkmcnt(7)
    v_exp_f32 v10, v42
    v_mfma_f32_16x16x32_bf16 v[216:219], a[88:91], v[112:115], v[216:219]
    s_waitcnt lgkmcnt(6)
    ds_read_b128 a[120:123], v2 offset:63488
    v_add_f32 v26, v26, v10
    v_mfma_f32_16x16x32_bf16 v[216:219], a[92:95], v[116:119], v[216:219]
    v_exp_f32 v11, v43
    v_mfma_f32_16x16x32_bf16 v[220:223], a[92:95], v[124:127], v[220:223]
    ds_read_b128 a[124:127], v2 offset:64512
    v_add_f32 v26, v26, v11
    v_mfma_f32_16x16x32_bf16 v[220:223], a[88:91], v[120:123], v[220:223]
    s_waitcnt vmcnt(8) lgkmcnt(7)
    s_barrier
    v_cvt_pk_bf16_f32 v99, v10, v11
    v_mfma_f32_16x16x32_bf16 v[224:227], a[96:99], v[112:115], v[224:227]
    s_waitcnt lgkmcnt(6)
    ds_read_b128 a[64:67], v1 offset:32768
    v_mfma_f32_16x16x32_bf16 v[224:227], a[100:103], v[116:119], v[224:227]
    v_exp_f32 v12, v44
    v_mfma_f32_16x16x32_bf16 v[228:231], a[100:103], v[124:127], v[228:231]
    ds_read_b128 a[68:71], v1 offset:33792
    v_add_f32 v27, v27, v12
    v_mfma_f32_16x16x32_bf16 v[228:231], a[96:99], v[120:123], v[228:231]
    s_waitcnt lgkmcnt(7)
    v_mfma_f32_16x16x32_bf16 v[232:235], a[104:107], v[112:115], v[232:235]
    s_waitcnt lgkmcnt(6)
    ds_read_b128 a[72:75], v1 offset:34816
    v_mfma_f32_16x16x32_bf16 v[232:235], a[108:111], v[116:119], v[232:235]
    v_exp_f32 v13, v45
    v_mfma_f32_16x16x32_bf16 v[236:239], a[108:111], v[124:127], v[236:239]
    ds_read_b128 a[76:79], v1 offset:35840
    v_add_f32 v27, v27, v13
    v_mfma_f32_16x16x32_bf16 v[236:239], a[104:107], v[120:123], v[236:239]
    s_waitcnt lgkmcnt(7)
    v_exp_f32 v14, v46
    v_mfma_f32_16x16x32_bf16 v[240:243], a[112:115], v[112:115], v[240:243]
    s_waitcnt lgkmcnt(6)
    ds_read_b128 a[80:83], v1 offset:36864
    v_cvt_pk_bf16_f32 v106, v12, v13
    v_mfma_f32_16x16x32_bf16 v[240:243], a[116:119], v[116:119], v[240:243]
    v_exp_f32 v15, v47
    v_mfma_f32_16x16x32_bf16 v[244:247], a[116:119], v[124:127], v[244:247]
    ds_read_b128 a[84:87], v1 offset:37888
    v_add_f32 v27, v27, v14
    v_mfma_f32_16x16x32_bf16 v[244:247], a[112:115], v[120:123], v[244:247]
    s_waitcnt lgkmcnt(7)
    v_add_f32 v27, v27, v15
    v_cvt_pk_bf16_f32 v107, v14, v15
    v_mfma_f32_16x16x32_bf16 v[248:251], a[120:123], v[112:115], v[248:251]
    s_waitcnt lgkmcnt(6)
    ds_read_b128 a[88:91], v1 offset:38912
    v_mfma_f32_16x16x32_bf16 v[248:251], a[124:127], v[116:119], v[248:251]
    v_mfma_f32_16x16x32_bf16 v[252:255], a[124:127], v[124:127], v[252:255]
    ds_read_b128 a[92:95], v1 offset:39936
    v_mfma_f32_16x16x32_bf16 v[252:255], a[120:123], v[120:123], v[252:255]
    s_waitcnt lgkmcnt(7)
K2_x1:
    v_mfma_f32_16x16x32_bf16 v[64:67], a[64:67], a[0:3], v[16:19]
    s_waitcnt lgkmcnt(6)
    s_add_u32 m0, s16, 0
    ds_read_b128 a[96:99], v1 offset:40960
    v_mfma_f32_16x16x32_bf16 v[64:67], a[68:71], a[4:7], v[64:67]
    s_waitcnt lgkmcnt(6)
    buffer_load_dwordx4 v1, s[4:7], s8 offen offset:0 lds
    v_mfma_f32_16x16x32_bf16 v[64:67], a[72:75], a[8:11], v[64:67]
    s_waitcnt lgkmcnt(5)
    ds_read_b128 a[100:103], v1 offset:41984
    v_mfma_f32_16x16x32_bf16 v[64:67], a[76:79], a[12:15], v[64:67]
    s_waitcnt lgkmcnt(5)
    v_exp_f32 v8, v48
    v_mfma_f32_16x16x32_bf16 v[64:67], a[80:83], a[16:19], v[64:67]
    s_waitcnt lgkmcnt(4)
    ds_read_b128 a[104:107], v1 offset:43008
    v_add_f32 v26, v26, v8
    v_mfma_f32_16x16x32_bf16 v[64:67], a[84:87], a[20:23], v[64:67]
    s_waitcnt lgkmcnt(4)
    buffer_load_dwordx4 v1, s[4:7], s8 offen offset:1024 lds
    v_mfma_f32_16x16x32_bf16 v[64:67], a[88:91], a[24:27], v[64:67]
    s_waitcnt lgkmcnt(3)
    ds_read_b128 a[108:111], v1 offset:44032
    v_mfma_f32_16x16x32_bf16 v[64:67], a[92:95], a[28:31], v[64:67]
    v_exp_f32 v9, v49
    v_mfma_f32_16x16x32_bf16 v[68:71], a[64:67], a[32:35], v[20:23]
    ds_read_b128 a[112:115], v1 offset:45056
    v_add_f32 v26, v26, v9
    v_mfma_f32_16x16x32_bf16 v[68:71], a[68:71], a[36:39], v[68:71]
    buffer_load_dwordx4 v1, s[4:7], s8 offen offset:2048 lds
    v_mfma_f32_16x16x32_bf16 v[68:71], a[72:75], a[40:43], v[68:71]
    ds_read_b128 a[116:119], v1 offset:46080
    v_cvt_pk_bf16_f32 v100, v8, v9
    v_mfma_f32_16x16x32_bf16 v[68:71], a[76:79], a[44:47], v[68:71]
    v_exp_f32 v10, v50
    v_mfma_f32_16x16x32_bf16 v[68:71], a[80:83], a[48:51], v[68:71]
    ds_read_b128 a[120:123], v1 offset:47104
    v_add_f32 v26, v26, v10
    v_mfma_f32_16x16x32_bf16 v[68:71], a[84:87], a[52:55], v[68:71]
    buffer_load_dwordx4 v1, s[4:7], s8 offen offset:3072 lds
    v_mfma_f32_16x16x32_bf16 v[68:71], a[88:91], a[56:59], v[68:71]
    s_add_u32 s8, s8, 4096
    ds_read_b128 a[124:127], v1 offset:48128
    v_mfma_f32_16x16x32_bf16 v[68:71], a[92:95], a[60:63], v[68:71]
    s_waitcnt lgkmcnt(6)
    v_exp_f32 v11, v51
    v_mfma_f32_16x16x32_bf16 v[72:75], a[96:99], a[0:3], v[16:19]
    s_add_u32 m0, s16, 4096
    ds_read_b128 a[64:67], v1 offset:49152
    v_add_f32 v26, v26, v11
    v_mfma_f32_16x16x32_bf16 v[72:75], a[100:103], a[4:7], v[72:75]
    s_waitcnt lgkmcnt(6)
    buffer_load_dwordx4 v1, s[4:7], s8 offen offset:0 lds
    v_mfma_f32_16x16x32_bf16 v[72:75], a[104:107], a[8:11], v[72:75]
    s_waitcnt lgkmcnt(5)
    ds_read_b128 a[68:71], v1 offset:50176
    v_cvt_pk_bf16_f32 v101, v10, v11
    v_mfma_f32_16x16x32_bf16 v[72:75], a[108:111], a[12:15], v[72:75]
    s_waitcnt lgkmcnt(5)
    v_mfma_f32_16x16x32_bf16 v[72:75], a[112:115], a[16:19], v[72:75]
    s_waitcnt lgkmcnt(4)
    ds_read_b128 a[72:75], v1 offset:51200
    v_mfma_f32_16x16x32_bf16 v[72:75], a[116:119], a[20:23], v[72:75]
    s_waitcnt lgkmcnt(4)
    buffer_load_dwordx4 v1, s[4:7], s8 offen offset:1024 lds
    v_mfma_f32_16x16x32_bf16 v[72:75], a[120:123], a[24:27], v[72:75]
    s_waitcnt lgkmcnt(3)
    ds_read_b128 a[76:79], v1 offset:52224
    v_mfma_f32_16x16x32_bf16 v[72:75], a[124:127], a[28:31], v[72:75]
    v_exp_f32 v12, v52
    v_mfma_f32_16x16x32_bf16 v[76:79], a[96:99], a[32:35], v[20:23]
    ds_read_b128 a[80:83], v1 offset:53248
    v_add_f32 v27, v27, v12
    v_mfma_f32_16x16x32_bf16 v[76:79], a[100:103], a[36:39], v[76:79]
    buffer_load_dwordx4 v1, s[4:7], s8 offen offset:2048 lds
    v_mfma_f32_16x16x32_bf16 v[76:79], a[104:107], a[40:43], v[76:79]
    ds_read_b128 a[84:87], v1 offset:54272
    v_mfma_f32_16x16x32_bf16 v[76:79], a[108:111], a[44:47], v[76:79]
    v_exp_f32 v13, v53
    v_mfma_f32_16x16x32_bf16 v[76:79], a[112:115], a[48:51], v[76:79]
    ds_read_b128 a[88:91], v1 offset:55296
    v_add_f32 v27, v27, v13
    v_mfma_f32_16x16x32_bf16 v[76:79], a[116:119], a[52:55], v[76:79]
    s_waitcnt lgkmcnt(3)
    buffer_load_dwordx4 v1, s[4:7], s8 offen offset:3072 lds
    v_mfma_f32_16x16x32_bf16 v[76:79], a[120:123], a[56:59], v[76:79]
    s_add_u32 s8, s8, 28672
    ds_read_b128 a[92:95], v1 offset:56320
    v_cvt_pk_bf16_f32 v108, v12, v13
    v_mfma_f32_16x16x32_bf16 v[76:79], a[124:127], a[60:63], v[76:79]
    s_sub_u32 s9, s9, 1
    v_exp_f32 v14, v54
    v_mfma_f32_16x16x32_bf16 v[80:83], a[64:67], a[0:3], v[16:19]
    s_cmp_eq_u32 s9, 0
    ds_read_b128 a[96:99], v1 offset:57344
    v_add_f32 v27, v27, v14
    v_mfma_f32_16x16x32_bf16 v[80:83], a[68:71], a[4:7], v[80:83]
    s_cselect_b32 s8, s10, s8
    v_exp_f32 v15, v55
    v_mfma_f32_16x16x32_bf16 v[80:83], a[72:75], a[8:11], v[80:83]
    s_cselect_b32 s9, s11, s9
    ds_read_b128 a[100:103], v1 offset:58368
    v_add_f32 v27, v27, v15
    v_mfma_f32_16x16x32_bf16 v[80:83], a[76:79], a[12:15], v[80:83]
    s_waitcnt lgkmcnt(5)
    s_cselect_b32 s10, 3221225472, s10
    v_cvt_pk_bf16_f32 v109, v14, v15
    v_mfma_f32_16x16x32_bf16 v[80:83], a[80:83], a[16:19], v[80:83]
    s_waitcnt lgkmcnt(4)
    ds_read_b128 a[104:107], v1 offset:59392
    v_mfma_f32_16x16x32_bf16 v[80:83], a[84:87], a[20:23], v[80:83]
    s_waitcnt lgkmcnt(4)
    v_exp_f32 v8, v56
    v_mfma_f32_16x16x32_bf16 v[80:83], a[88:91], a[24:27], v[80:83]
    s_waitcnt lgkmcnt(3)
    ds_read_b128 a[108:111], v1 offset:60416
    v_add_f32 v26, v26, v8
    v_mfma_f32_16x16x32_bf16 v[80:83], a[92:95], a[28:31], v[80:83]
    v_exp_f32 v9, v57
    v_mfma_f32_16x16x32_bf16 v[84:87], a[64:67], a[32:35], v[20:23]
    ds_read_b128 a[112:115], v1 offset:61440
    v_add_f32 v26, v26, v9
    v_mfma_f32_16x16x32_bf16 v[84:87], a[68:71], a[36:39], v[84:87]
    v_exp_f32 v10, v58
    v_mfma_f32_16x16x32_bf16 v[84:87], a[72:75], a[40:43], v[84:87]
    ds_read_b128 a[116:119], v1 offset:62464
    v_cvt_pk_bf16_f32 v102, v8, v9
    v_mfma_f32_16x16x32_bf16 v[84:87], a[76:79], a[44:47], v[84:87]
    v_exp_f32 v11, v59
    v_mfma_f32_16x16x32_bf16 v[84:87], a[80:83], a[48:51], v[84:87]
    ds_read_b128 a[120:123], v1 offset:63488
    v_add_f32 v26, v26, v10
    v_mfma_f32_16x16x32_bf16 v[84:87], a[84:87], a[52:55], v[84:87]
    v_add_f32 v26, v26, v11
    v_cvt_pk_bf16_f32 v103, v10, v11
    v_mfma_f32_16x16x32_bf16 v[84:87], a[88:91], a[56:59], v[84:87]
    ds_read_b128 a[124:127], v1 offset:64512
    v_mfma_f32_16x16x32_bf16 v[84:87], a[92:95], a[60:63], v[84:87]
    s_waitcnt vmcnt(8) lgkmcnt(7)
    s_barrier
    v_mfma_f32_16x16x32_bf16 v[88:91], a[96:99], a[0:3], v[16:19]
    s_waitcnt lgkmcnt(6)
    ds_read_b128 a[64:67], v2 offset:0
    v_mfma_f32_16x16x32_bf16 v[88:91], a[100:103], a[4:7], v[88:91]
    s_waitcnt lgkmcnt(6)
    v_exp_f32 v12, v60
    v_mfma_f32_16x16x32_bf16 v[88:91], a[104:107], a[8:11], v[88:91]
    s_waitcnt lgkmcnt(5)
    ds_read_b128 a[68:71], v2 offset:1024
    v_add_f32 v27, v27, v12
    v_mfma_f32_16x16x32_bf16 v[88:91], a[108:111], a[12:15], v[88:91]
    s_waitcnt lgkmcnt(5)
    v_exp_f32 v13, v61
    v_mfma_f32_16x16x32_bf16 v[88:91], a[112:115], a[16:19], v[88:91]
    s_waitcnt lgkmcnt(4)
    ds_read_b128 a[72:75], v2 offset:2048
    v_add_f32 v27, v27, v13
    v_mfma_f32_16x16x32_bf16 v[88:91], a[116:119], a[20:23], v[88:91]
    s_waitcnt lgkmcnt(4)
    v_exp_f32 v14, v62
    v_mfma_f32_16x16x32_bf16 v[88:91], a[120:123], a[24:27], v[88:91]
    s_waitcnt lgkmcnt(3)
    ds_read_b128 a[76:79], v2 offset:3072
    v_cvt_pk_bf16_f32 v110, v12, v13
    v_mfma_f32_16x16x32_bf16 v[88:91], a[124:127], a[28:31], v[88:91]
    v_exp_f32 v15, v63
    v_mfma_f32_16x16x32_bf16 v[92:95], a[96:99], a[32:35], v[20:23]
    s_sub_u32 s17, s17, 1
    ds_read_b128 a[80:83], v2 offset:4096
    v_add_f32 v27, v27, v14
    v_mfma_f32_16x16x32_bf16 v[92:95], a[100:103], a[36:39], v[92:95]
    v_add_f32 v27, v27, v15
    v_cvt_pk_bf16_f32 v111, v14, v15
    v_mfma_f32_16x16x32_bf16 v[92:95], a[104:107], a[40:43], v[92:95]
    ds_read_b128 a[84:87], v2 offset:5120
    v_add_f32 v28, v26, v27
    v_mfma_f32_16x16x32_bf16 v[92:95], a[108:111], a[44:47], v[92:95]
    v_cmp_nge_f32 vcc, s24, v28
    v_mfma_f32_16x16x32_bf16 v[92:95], a[112:115], a[48:51], v[92:95]
    ds_read_b128 a[88:91], v2 offset:6144
    v_mfma_f32_16x16x32_bf16 v[92:95], a[116:119], a[52:55], v[92:95]
    v_mfma_f32_16x16x32_bf16 v[92:95], a[120:123], a[56:59], v[92:95]
    ds_read_b128 a[92:95], v2 offset:7168
    v_mfma_f32_16x16x32_bf16 v[92:95], a[124:127], a[60:63], v[92:95]
    s_waitcnt lgkmcnt(6)
    s_cbranch_vccnz BLstub_3
BLback_4:
    s_cmp_lg_u32 s17, 0
    s_cbranch_scc1 K2_loop
    s_cmp_eq_u32 s18, 2
    s_cbranch_scc1 K2_ntail
    v_mfma_f32_16x16x32_bf16 v[128:131], a[64:67], v[96:99], v[128:131]
    s_add_u32 m0, s16, 98304
    ds_read_b128 a[96:99], v2 offset:8192
    v_add_f32 v24, v24, v26
    v_mfma_f32_16x16x32_bf16 v[128:131], a[68:71], v[100:103], v[128:131]
    buffer_load_dwordx4 v1, s[4:7], s12 offen offset:0 lds
    v_mfma_f32_16x16x32_bf16 v[132:135], a[68:71], v[108:111], v[132:135]
    ds_read_b128 a[100:103], v2 offset:9216
    v_add_f32 v25, v25, v27
    v_mfma_f32_16x16x32_bf16 v[132:135], a[64:67], v[104:107], v[132:135]
    s_waitcnt lgkmcnt(7)
    v_exp_f32 v8, v64
    v_mfma_f32_16x16x32_bf16 v[136:139], a[72:75], v[96:99], v[136:139]
    s_waitcnt lgkmcnt(6)
    ds_read_b128 a[104:107], v2 offset:10240
    v_mfma_f32_16x16x32_bf16 v[136:139], a[76:79], v[100:103], v[136:139]
    buffer_load_dwordx4 v1, s[4:7], s12 offen offset:1024 lds
    v_mfma_f32_16x16x32_bf16 v[140:143], a[76:79], v[108:111], v[140:143]
    ds_read_b128 a[108:111], v2 offset:11264
    v_mfma_f32_16x16x32_bf16 v[140:143], a[72:75], v[104:107], v[140:143]
    s_waitcnt lgkmcnt(7)
    v_exp_f32 v9, v65
    v_mfma_f32_16x16x32_bf16 v[144:147], a[80:83], v[96:99], v[144:147]
    s_waitcnt lgkmcnt(6)
    ds_read_b128 a[112:115], v2 offset:12288
    v_add_f32 v26, v8, v9
    v_mfma_f32_16x16x32_bf16 v[144:147], a[84:87], v[100:103], v[144:147]
    buffer_load_dwordx4 v1, s[4:7], s12 offen offset:2048 lds
    v_mfma_f32_16x16x32_bf16 v[148:151], a[84:87], v[108:111], v[148:151]
    ds_read_b128 a[116:119], v2 offset:13312
    v_cvt_pk_bf16_f32 v112, v8, v9
    v_mfma_f32_16x16x32_bf16 v[148:151], a[80:83], v[104:107], v[148:151]
    s_waitcnt lgkmcnt(7)
    v_exp_f32 v10, v66
    v_mfma_f32_16x16x32_bf16 v[152:155], a[88:91], v[96:99], v[152:155]
    s_waitcnt lgkmcnt(6)
    ds_read_b128 a[120:123], v2 offset:14336
    v_add_f32 v26, v26, v10
    v_mfma_f32_16x16x32_bf16 v[152:155], a[92:95], v[100:103], v[152:155]
    buffer_load_dwordx4 v1, s[4:7], s12 offen offset:3072 lds
    v_mfma_f32_16x16x32_bf16 v[156:159], a[92:95], v[108:111], v[156:159]
    s_add_u32 s12, s12, 4096
    ds_read_b128 a[124:127], v2 offset:15360
    v_mfma_f32_16x16x32_bf16 v[156:159], a[88:91], v[104:107], v[156:159]
    s_waitcnt lgkmcnt(6)
    v_exp_f32 v11, v67
    v_mfma_f32_16x16x32_bf16 v[160:163], a[96:99], v[96:99], v[160:163]
    s_add_u32 m0, s16, 102400
    ds_read_b128 a[64:67], v2 offset:16384
    v_add_f32 v26, v26, v11
    v_mfma_f32_16x16x32_bf16 v[160:163], a[100:103], v[100:103], v[160:163]
    buffer_load_dwordx4 v1, s[4:7], s12 offen offset:0 lds
    v_mfma_f32_16x16x32_bf16 v[164:167], a[100:103], v[108:111], v[164:167]
    ds_read_b128 a[68:71], v2 offset:17408
    v_cvt_pk_bf16_f32 v113, v10, v11
    v_mfma_f32_16x16x32_bf16 v[164:167], a[96:99], v[104:107], v[164:167]
    s_waitcnt lgkmcnt(7)
    v_mfma_f32_16x16x32_bf16 v[168:171], a[104:107], v[96:99], v[168:171]
    s_waitcnt lgkmcnt(6)
    ds_read_b128 a[72:75], v2 offset:18432
    v_mfma_f32_16x16x32_bf16 v[168:171], a[108:111], v[100:103], v[168:171]
    buffer_load_dwordx4 v1, s[4:7], s12 offen offset:1024 lds
    v_mfma_f32_16x16x32_bf16 v[172:175], a[108:111], v[108:111], v[172:175]
    ds_read_b128 a[76:79], v2 offset:19456
    v_mfma_f32_16x16x32_bf16 v[172:175], a[104:107], v[104:107], v[172:175]
    s_waitcnt lgkmcnt(7)
    v_exp_f32 v12, v68
    v_mfma_f32_16x16x32_bf16 v[176:179], a[112:115], v[96:99], v[176:179]
    s_waitcnt lgkmcnt(6)
    ds_read_b128 a[80:83], v2 offset:20480
    v_mfma_f32_16x16x32_bf16 v[176:179], a[116:119], v[100:103], v[176:179]
    buffer_load_dwordx4 v1, s[4:7], s12 offen offset:2048 lds
    v_mfma_f32_16x16x32_bf16 v[180:183], a[116:119], v[108:111], v[180:183]
    ds_read_b128 a[84:87], v2 offset:21504
    v_mfma_f32_16x16x32_bf16 v[180:183], a[112:115], v[104:107], v[180:183]
    s_waitcnt lgkmcnt(7)
    v_exp_f32 v13, v69
    v_mfma_f32_16x16x32_bf16 v[184:187], a[120:123], v[96:99], v[184:187]
    s_waitcnt lgkmcnt(6)
    ds_read_b128 a[88:91], v2 offset:22528
    v_add_f32 v27, v12, v13
    v_mfma_f32_16x16x32_bf16 v[184:187], a[124:127], v[100:103], v[184:187]
    s_waitcnt lgkmcnt(5)
    buffer_load_dwordx4 v1, s[4:7], s12 offen offset:3072 lds
    v_mfma_f32_16x16x32_bf16 v[188:191], a[124:127], v[108:111], v[188:191]
    s_add_u32 s12, s12, 28672
    ds_read_b128 a[92:95], v2 offset:23552
    v_cvt_pk_bf16_f32 v120, v12, v13
    v_mfma_f32_16x16x32_bf16 v[188:191], a[120:123], v[104:107], v[188:191]
    s_sub_u32 s13, s13, 1
    v_exp_f32 v14, v70
    v_mfma_f32_16x16x32_bf16 v[192:195], a[64:67], v[96:99], v[192:195]
    s_cmp_eq_u32 s13, 0
    ds_read_b128 a[96:99], v2 offset:24576
    v_add_f32 v27, v27, v14
    v_mfma_f32_16x16x32_bf16 v[192:195], a[68:71], v[100:103], v[192:195]
    s_cselect_b32 s12, s14, s12
    v_mfma_f32_16x16x32_bf16 v[196:199], a[68:71], v[108:111], v[196:199]
    s_waitcnt lgkmcnt(6)
    s_cselect_b32 s13, s15, s13
    ds_read_b128 a[100:103], v2 offset:25600
    v_mfma_f32_16x16x32_bf16 v[196:199], a[64:67], v[104:107], v[196:199]
    s_cselect_b32 s14, 3221225472, s14
    v_exp_f32 v15, v71
    v_mfma_f32_16x16x32_bf16 v[200:203], a[72:75], v[96:99], v[200:203]
    s_waitcnt lgkmcnt(6)
    ds_read_b128 a[104:107], v2 offset:26624
    v_add_f32 v27, v27, v15
    v_mfma_f32_16x16x32_bf16 v[200:203], a[76:79], v[100:103], v[200:203]
    v_exp_f32 v8, v72
    v_mfma_f32_16x16x32_bf16 v[204:207], a[76:79], v[108:111], v[204:207]
    ds_read_b128 a[108:111], v2 offset:27648
    v_cvt_pk_bf16_f32 v121, v14, v15
    v_mfma_f32_16x16x32_bf16 v[204:207], a[72:75], v[104:107], v[204:207]
    s_waitcnt lgkmcnt(7)
    v_exp_f32 v9, v73
    v_mfma_f32_16x16x32_bf16 v[208:211], a[80:83], v[96:99], v[208:211]
    s_waitcnt lgkmcnt(6)
    ds_read_b128 a[112:115], v2 offset:28672
    v_add_f32 v26, v26, v8
    v_mfma_f32_16x16x32_bf16 v[208:211], a[84:87], v[100:103], v[208:211]
    v_add_f32 v26, v26, v9
    v_cvt_pk_bf16_f32 v114, v8, v9
    v_mfma_f32_16x16x32_bf16 v[212:215], a[84:87], v[108:111], v[212:215]
    ds_read_b128 a[116:119], v2 offset:29696
    v_mfma_f32_16x16x32_bf16 v[212:215], a[80:83], v[104:107], v[212:215]
    s_waitcnt lgkmcnt(7)
    v_exp_f32 v10, v74
    v_mfma_f32_16x16x32_bf16 v[216:219], a[88:91], v[96:99], v[216:219]
    s_waitcnt lgkmcnt(6)
    ds_read_b128 a[120:123], v2 offset:30720
    v_add_f32 v26, v26, v10
    v_mfma_f32_16x16x32_bf16 v[216:219], a[92:95], v[100:103], v[216:219]
    v_exp_f32 v11, v75
    v_mfma_f32_16x16x32_bf16 v[220:223], a[92:95], v[108:111], v[220:223]
    ds_read_b128 a[124:127], v2 offset:31744
    v_add_f32 v26, v26, v11
    v_mfma_f32_16x16x32_bf16 v[220:223], a[88:91], v[104:107], v[220:223]
    s_waitcnt vmcnt(8) lgkmcnt(7)
    s_barrier
    v_cvt_pk_bf16_f32 v115, v10, v11
    v_mfma_f32_16x16x32_bf16 v[224:227], a[96:99], v[96:99], v[224:227]
    s_waitcnt lgkmcnt(6)
    ds_read_b128 a[64:67], v1 offset:0
    v_mfma_f32_16x16x32_bf16 v[224:227], a[100:103], v[100:103], v[224:227]
    v_exp_f32 v12, v76
    v_mfma_f32_16x16x32_bf16 v[228:231], a[100:103], v[108:111], v[228:231]
    ds_read_b128 a[68:71], v1 offset:1024
    v_add_f32 v27, v27, v12
    v_mfma_f32_16x16x32_bf16 v[228:231], a[96:99], v[104:107], v[228:231]
    s_waitcnt lgkmcnt(7)
    v_mfma_f32_16x16x32_bf16 v[232:235], a[104:107], v[96:99], v[232:235]
    s_waitcnt lgkmcnt(6)
    ds_read_b128 a[72:75], v1 offset:2048
    v_mfma_f32_16x16x32_bf16 v[232:235], a[108:111], v[100:103], v[232:235]
    v_exp_f32 v13, v77
    v_mfma_f32_16x16x32_bf16 v[236:239], a[108:111], v[108:111], v[236:239]
    ds_read_b128 a[76:79], v1 offset:3072
    v_add_f32 v27, v27, v13
    v_mfma_f32_16x16x32_bf16 v[236:239], a[104:107], v[104:107], v[236:239]
    s_waitcnt lgkmcnt(7)
    v_exp_f32 v14, v78
    v_mfma_f32_16x16x32_bf16 v[240:243], a[112:115], v[96:99], v[240:243]
    s_waitcnt lgkmcnt(6)
    ds_read_b128 a[80:83], v1 offset:4096
    v_cvt_pk_bf16_f32 v122, v12, v13
    v_mfma_f32_16x16x32_bf16 v[240:243], a[116:119], v[100:103], v[240:243]
    v_exp_f32 v15, v79
    v_mfma_f32_16x16x32_bf16 v[244:247], a[116:119], v[108:111], v[244:247]
    ds_read_b128 a[84:87], v1 offset:5120
    v_add_f32 v27, v27, v14
    v_mfma_f32_16x16x32_bf16 v[244:247], a[112:115], v[104:107], v[244:247]
    s_waitcnt lgkmcnt(7)
    v_add_f32 v27, v27, v15
    v_cvt_pk_bf16_f32 v123, v14, v15
    v_mfma_f32_16x16x32_bf16 v[248:251], a[120:123], v[96:99], v[248:251]
    s_waitcnt lgkmcnt(6)
    ds_read_b128 a[88:91], v1 offset:6144
    v_mfma_f32_16x16x32_bf16 v[248:251], a[124:127], v[100:103], v[248:251]
    v_mfma_f32_16x16x32_bf16 v[252:255], a[124:127], v[108:111], v[252:255]
    ds_read_b128 a[92:95], v1 offset:7168
    v_mfma_f32_16x16x32_bf16 v[252:255], a[120:123], v[104:107], v[252:255]
    s_waitcnt lgkmcnt(6)
    v_cndmask_b32 v32, v16, v7, s[32:33]
    v_cndmask_b32 v33, v16, v7, s[34:35]
    v_cndmask_b32 v34, v16, v7, s[36:37]
    v_cndmask_b32 v35, v16, v7, s[38:39]
    s_nop 1
    v_mfma_f32_16x16x32_bf16 v[32:35], a[64:67], a[0:3], v[32:35]
    s_add_u32 m0, s16, 32768
    ds_read_b128 a[96:99], v1 offset:8192
    v_cndmask_b32 v40, v16, v7, s[40:41]
    v_mfma_f32_16x16x32_bf16 v[32:35], a[68:71], a[4:7], v[32:35]
    s_waitcnt lgkmcnt(6)
    buffer_load_dwordx4 v1, s[4:7], s8 offen offset:0 lds
    v_mfma_f32_16x16x32_bf16 v[32:35], a[72:75], a[8:11], v[32:35]
    s_waitcnt lgkmcnt(5)
    ds_read_b128 a[100:103], v1 offset:9216
    v_cndmask_b32 v41, v16, v7, s[42:43]
    v_mfma_f32_16x16x32_bf16 v[32:35], a[76:79], a[12:15], v[32:35]
    s_waitcnt lgkmcnt(5)
    v_cndmask_b32 v42, v16, v7, s[44:45]
    v_cndmask_b32 v43, v16, v7, s[46:47]
    v_mfma_f32_16x16x32_bf16 v[32:35], a[80:83], a[16:19], v[32:35]
    s_waitcnt lgkmcnt(4)
    ds_read_b128 a[104:107], v1 offset:10240
    v_mfma_f32_16x16x32_bf16 v[32:35], a[84:87], a[20:23], v[32:35]
    s_waitcnt lgkmcnt(4)
    buffer_load_dwordx4 v1, s[4:7], s8 offen offset:1024 lds
    v_mfma_f32_16x16x32_bf16 v[32:35], a[88:91], a[24:27], v[32:35]
    s_waitcnt lgkmcnt(3)
    ds_read_b128 a[108:111], v1 offset:11264
    v_mfma_f32_16x16x32_bf16 v[32:35], a[92:95], a[28:31], v[32:35]
    v_exp_f32 v8, v80
    v_mfma_f32_16x16x32_bf16 v[36:39], a[64:67], a[32:35], v[20:23]
    ds_read_b128 a[112:115], v1 offset:12288
    v_add_f32 v26, v26, v8
    v_mfma_f32_16x16x32_bf16 v[36:39], a[68:71], a[36:39], v[36:39]
    buffer_load_dwordx4 v1, s[4:7], s8 offen offset:2048 lds
    v_mfma_f32_16x16x32_bf16 v[36:39], a[72:75], a[40:43], v[36:39]
    ds_read_b128 a[116:119], v1 offset:13312
    v_mfma_f32_16x16x32_bf16 v[36:39], a[76:79], a[44:47], v[36:39]
    v_exp_f32 v9, v81
    v_mfma_f32_16x16x32_bf16 v[36:39], a[80:83], a[48:51], v[36:39]
    ds_read_b128 a[120:123], v1 offset:14336
    v_add_f32 v26, v26, v9
    v_mfma_f32_16x16x32_bf16 v[36:39], a[84:87], a[52:55], v[36:39]
    buffer_load_dwordx4 v1, s[4:7], s8 offen offset:3072 lds
    v_mfma_f32_16x16x32_bf16 v[36:39], a[88:91], a[56:59], v[36:39]
    s_add_u32 s8, s8, 4096
    ds_read_b128 a[124:127], v1 offset:15360
    v_cvt_pk_bf16_f32 v116, v8, v9
    v_mfma_f32_16x16x32_bf16 v[36:39], a[92:95], a[60:63], v[36:39]
    s_waitcnt lgkmcnt(6)
    v_exp_f32 v10, v82
    v_mfma_f32_16x16x32_bf16 v[40:43], a[96:99], a[0:3], v[40:43]
    s_add_u32 m0, s16, 36864
    ds_read_b128 a[64:67], v1 offset:16384
    v_cndmask_b32 v48, v16, v7, s[48:49]
    v_mfma_f32_16x16x32_bf16 v[40:43], a[100:103], a[4:7], v[40:43]
    s_waitcnt lgkmcnt(6)
    buffer_load_dwordx4 v1, s[4:7], s8 offen offset:0 lds
    v_mfma_f32_16x16x32_bf16 v[40:43], a[104:107], a[8:11], v[40:43]
    s_waitcnt lgkmcnt(5)
    ds_read_b128 a[68:71], v1 offset:17408
    v_cndmask_b32 v49, v16, v7, s[50:51]
    v_mfma_f32_16x16x32_bf16 v[40:43], a[108:111], a[12:15], v[40:43]
    s_waitcnt lgkmcnt(5)
    v_cndmask_b32 v50, v16, v7, s[52:53]
    v_cndmask_b32 v51, v16, v7, s[54:55]
    v_mfma_f32_16x16x32_bf16 v[40:43], a[112:115], a[16:19], v[40:43]
    s_waitcnt lgkmcnt(4)
    ds_read_b128 a[72:75], v1 offset:18432
    v_add_f32 v26, v26, v10
    v_mfma_f32_16x16x32_bf16 v[40:43], a[116:119], a[20:23], v[40:43]
    s_waitcnt lgkmcnt(4)
    buffer_load_dwordx4 v1, s[4:7], s8 offen offset:1024 lds
    v_mfma_f32_16x16x32_bf16 v[40:43], a[120:123], a[24:27], v[40:43]
    s_waitcnt lgkmcnt(3)
    ds_read_b128 a[76:79], v1 offset:19456
    v_mfma_f32_16x16x32_bf16 v[40:43], a[124:127], a[28:31], v[40:43]
    v_exp_f32 v11, v83
    v_mfma_f32_16x16x32_bf16 v[44:47], a[96:99], a[32:35], v[20:23]
    ds_read_b128 a[80:83], v1 offset:20480
    v_add_f32 v26, v26, v11
    v_mfma_f32_16x16x32_bf16 v[44:47], a[100:103], a[36:39], v[44:47]
    buffer_load_dwordx4 v1, s[4:7], s8 offen offset:2048 lds
    v_mfma_f32_16x16x32_bf16 v[44:47], a[104:107], a[40:43], v[44:47]
    ds_read_b128 a[84:87], v1 offset:21504
    v_cvt_pk_bf16_f32 v117, v10, v11
    v_mfma_f32_16x16x32_bf16 v[44:47], a[108:111], a[44:47], v[44:47]
    v_exp_f32 v12, v84
    v_mfma_f32_16x16x32_bf16 v[44:47], a[112:115], a[48:51], v[44:47]
    ds_read_b128 a[88:91], v1 offset:22528
    v_add_f32 v27, v27, v12
    v_mfma_f32_16x16x32_bf16 v[44:47], a[116:119], a[52:55], v[44:47]
    buffer_load_dwordx4 v1, s[4:7], s8 offen offset:3072 lds
    v_mfma_f32_16x16x32_bf16 v[44:47], a[120:123], a[56:59], v[44:47]
    s_waitcnt lgkmcnt(2)
    s_add_u32 s8, s8, 28672
    ds_read_b128 a[92:95], v1 offset:23552
    v_mfma_f32_16x16x32_bf16 v[44:47], a[124:127], a[60:63], v[44:47]
    s_sub_u32 s9, s9, 1
    v_exp_f32 v13, v85
    v_mfma_f32_16x16x32_bf16 v[48:51], a[64:67], a[0:3], v[48:51]
    s_cmp_eq_u32 s9, 0
    ds_read_b128 a[96:99], v1 offset:24576
    v_cndmask_b32 v56, v16, v7, s[56:57]
    v_mfma_f32_16x16x32_bf16 v[48:51], a[68:71], a[4:7], v[48:51]
    s_cselect_b32 s8, s10, s8
    v_cndmask_b32 v57, v16, v7, s[58:59]
    v_cndmask_b32 v58, v16, v7, s[60:61]
    v_mfma_f32_16x16x32_bf16 v[48:51], a[72:75], a[8:11], v[48:51]
    s_cselect_b32 s9, s11, s9
    ds_read_b128 a[100:103], v1 offset:25600
    v_cndmask_b32 v59, v16, v7, s[62:63]
    v_mfma_f32_16x16x32_bf16 v[48:51], a[76:79], a[12:15], v[48:51]
    s_cselect_b32 s10, 3221225472, s10
    v_exp_f32 v14, v86
    v_mfma_f32_16x16x32_bf16 v[48:51], a[80:83], a[16:19], v[48:51]
    s_waitcnt lgkmcnt(4)
    ds_read_b128 a[104:107], v1 offset:26624
    v_add_f32 v27, v27, v13
    v_cvt_pk_bf16_f32 v124, v12, v13
    v_mfma_f32_16x16x32_bf16 v[48:51], a[84:87], a[20:23], v[48:51]
    s_waitcnt lgkmcnt(4)
    v_exp_f32 v15, v87
    v_mfma_f32_16x16x32_bf16 v[48:51], a[88:91], a[24:27], v[48:51]
    s_waitcnt lgkmcnt(3)
    ds_read_b128 a[108:111], v1 offset:27648
    v_add_f32 v27, v27, v14
    v_mfma_f32_16x16x32_bf16 v[48:51], a[92:95], a[28:31], v[48:51]
    v_exp_f32 v8, v88
    v_mfma_f32_16x16x32_bf16 v[52:55], a[64:67], a[32:35], v[20:23]
    ds_read_b128 a[112:115], v1 offset:28672
    v_add_f32 v27, v27, v15
    v_mfma_f32_16x16x32_bf16 v[52:55], a[68:71], a[36:39], v[52:55]
    v_exp_f32 v9, v89
    v_mfma_f32_16x16x32_bf16 v[52:55], a[72:75], a[40:43], v[52:55]
    ds_read_b128 a[116:119], v1 offset:29696
    v_cvt_pk_bf16_f32 v125, v14, v15
    v_mfma_f32_16x16x32_bf16 v[52:55], a[76:79], a[44:47], v[52:55]
    v_exp_f32 v10, v90
    v_mfma_f32_16x16x32_bf16 v[52:55], a[80:83], a[48:51], v[52:55]
    ds_read_b128 a[120:123], v1 offset:30720
    v_add_f32 v26, v26, v8
    v_mfma_f32_16x16x32_bf16 v[52:55], a[84:87], a[52:55], v[52:55]
    v_exp_f32 v11, v91
    v_mfma_f32_16x16x32_bf16 v[52:55], a[88:91], a[56:59], v[52:55]
    ds_read_b128 a[124:127], v1 offset:31744
    v_add_f32 v26, v26, v9
    v_cvt_pk_bf16_f32 v118, v8, v9
    v_mfma_f32_16x16x32_bf16 v[52:55], a[92:95], a[60:63], v[52:55]
    s_waitcnt vmcnt(8) lgkmcnt(7)
    s_barrier
    v_add_f32 v26, v26, v10
    v_mfma_f32_16x16x32_bf16 v[56:59], a[96:99], a[0:3], v[56:59]
    s_waitcnt lgkmcnt(6)
    ds_read_b128 a[64:67], v2 offset:32768
    v_add_f32 v26, v26, v11
    v_mfma_f32_16x16x32_bf16 v[56:59], a[100:103], a[4:7], v[56:59]
    s_waitcnt lgkmcnt(6)
    v_exp_f32 v12, v92
    v_mfma_f32_16x16x32_bf16 v[56:59], a[104:107], a[8:11], v[56:59]
    s_waitcnt lgkmcnt(5)
    ds_read_b128 a[68:71], v2 offset:33792
    v_cvt_pk_bf16_f32 v119, v10, v11
    v_mfma_f32_16x16x32_bf16 v[56:59], a[108:111], a[12:15], v[56:59]
    s_waitcnt lgkmcnt(5)
    v_exp_f32 v13, v93
    v_mfma_f32_16x16x32_bf16 v[56:59], a[112:115], a[16:19], v[56:59]
    s_waitcnt lgkmcnt(4)
    ds_read_b128 a[72:75], v2 offset:34816
    v_add_f32 v27, v27, v12
    v_mfma_f32_16x16x32_bf16 v[56:59], a[116:119], a[20:23], v[56:59]
    s_waitcnt lgkmcnt(4)
    v_exp_f32 v14, v94
    v_mfma_f32_16x16x32_bf16 v[56:59], a[120:123], a[24:27], v[56:59]
    s_waitcnt lgkmcnt(3)
    ds_read_b128 a[76:79], v2 offset:35840
    v_add_f32 v27, v27, v13
    v_mfma_f32_16x16x32_bf16 v[56:59], a[124:127], a[28:31], v[56:59]
    v_exp_f32 v15, v95
    v_mfma_f32_16x16x32_bf16 v[60:63], a[96:99], a[32:35], v[20:23]
    ds_read_b128 a[80:83], v2 offset:36864
    v_cvt_pk_bf16_f32 v126, v12, v13
    v_mfma_f32_16x16x32_bf16 v[60:63], a[100:103], a[36:39], v[60:63]
    v_add_f32 v27, v27, v14
    v_add_f32 v27, v27, v15
    v_mfma_f32_16x16x32_bf16 v[60:63], a[104:107], a[40:43], v[60:63]
    ds_read_b128 a[84:87], v2 offset:37888
    v_cvt_pk_bf16_f32 v127, v14, v15
    v_mfma_f32_16x16x32_bf16 v[60:63], a[108:111], a[44:47], v[60:63]
    v_add_f32 v28, v26, v27
    v_cmp_nge_f32 vcc, s24, v28
    v_mfma_f32_16x16x32_bf16 v[60:63], a[112:115], a[48:51], v[60:63]
    ds_read_b128 a[88:91], v2 offset:38912
    v_mfma_f32_16x16x32_bf16 v[60:63], a[116:119], a[52:55], v[60:63]
    v_mfma_f32_16x16x32_bf16 v[60:63], a[120:123], a[56:59], v[60:63]
    ds_read_b128 a[92:95], v2 offset:39936
    v_mfma_f32_16x16x32_bf16 v[60:63], a[124:127], a[60:63], v[60:63]
    s_waitcnt lgkmcnt(6)
    s_cbranch_vccnz BLstub_5
BLback_6:
    v_mfma_f32_16x16x32_bf16 v[128:131], a[64:67], v[112:115], v[128:131]
    s_add_u32 m0, s16, 65536
    ds_read_b128 a[96:99], v2 offset:40960
    v_add_f32 v24, v24, v26
    v_mfma_f32_16x16x32_bf16 v[128:131], a[68:71], v[116:119], v[128:131]
    buffer_load_dwordx4 v1, s[4:7], s12 offen offset:0 lds
    v_mfma_f32_16x16x32_bf16 v[132:135], a[68:71], v[124:127], v[132:135]
    ds_read_b128 a[100:103], v2 offset:41984
    v_add_f32 v25, v25, v27
    v_mfma_f32_16x16x32_bf16 v[132:135], a[64:67], v[120:123], v[132:135]
    s_waitcnt lgkmcnt(7)
    v_exp_f32 v8, v32
    v_mfma_f32_16x16x32_bf16 v[136:139], a[72:75], v[112:115], v[136:139]
    s_waitcnt lgkmcnt(6)
    ds_read_b128 a[104:107], v2 offset:43008
    v_mfma_f32_16x16x32_bf16 v[136:139], a[76:79], v[116:119], v[136:139]
    buffer_load_dwordx4 v1, s[4:7], s12 offen offset:1024 lds
    v_mfma_f32_16x16x32_bf16 v[140:143], a[76:79], v[124:127], v[140:143]
    ds_read_b128 a[108:111], v2 offset:44032
    v_mfma_f32_16x16x32_bf16 v[140:143], a[72:75], v[120:123], v[140:143]
    s_waitcnt lgkmcnt(7)
    v_exp_f32 v9, v33
    v_mfma_f32_16x16x32_bf16 v[144:147], a[80:83], v[112:115], v[144:147]
    s_waitcnt lgkmcnt(6)
    ds_read_b128 a[112:115], v2 offset:45056
    v_add_f32 v26, v8, v9
    v_mfma_f32_16x16x32_bf16 v[144:147], a[84:87], v[116:119], v[144:147]
    buffer_load_dwordx4 v1, s[4:7], s12 offen offset:2048 lds
    v_mfma_f32_16x16x32_bf16 v[148:151], a[84:87], v[124:127], v[148:151]
    ds_read_b128 a[116:119], v2 offset:46080
    v_cvt_pk_bf16_f32 v96, v8, v9
    v_mfma_f32_16x16x32_bf16 v[148:151], a[80:83], v[120:123], v[148:151]
    s_waitcnt lgkmcnt(7)
    v_exp_f32 v10, v34
    v_mfma_f32_16x16x32_bf16 v[152:155], a[88:91], v[112:115], v[152:155]
    s_waitcnt lgkmcnt(6)
    ds_read_b128 a[120:123], v2 offset:47104
    v_add_f32 v26, v26, v10
    v_mfma_f32_16x16x32_bf16 v[152:155], a[92:95], v[116:119], v[152:155]
    buffer_load_dwordx4 v1, s[4:7], s12 offen offset:3072 lds
    v_mfma_f32_16x16x32_bf16 v[156:159], a[92:95], v[124:127], v[156:159]
    s_add_u32 s12, s12, 4096
    ds_read_b128 a[124:127], v2 offset:48128
    v_mfma_f32_16x16x32_bf16 v[156:159], a[88:91], v[120:123], v[156:159]
    s_waitcnt lgkmcnt(6)
    v_exp_f32 v11, v35
    v_mfma_f32_16x16x32_bf16 v[160:163], a[96:99], v[112:115], v[160:163]
    s_add_u32 m0, s16, 69632
    ds_read_b128 a[64:67], v2 offset:49152
    v_add_f32 v26, v26, v11
    v_mfma_f32_16x16x32_bf16 v[160:163], a[100:103], v[116:119], v[160:163]
    buffer_load_dwordx4 v1, s[4:7], s12 offen offset:0 lds
    v_mfma_f32_16x16x32_bf16 v[164:167], a[100:103], v[124:127], v[164:167]
    ds_read_b128 a[68:71], v2 offset:50176
    v_cvt_pk_bf16_f32 v97, v10, v11
    v_mfma_f32_16x16x32_bf16 v[164:167], a[96:99], v[120:123], v[164:167]
    s_waitcnt lgkmcnt(7)
    v_mfma_f32_16x16x32_bf16 v[168:171], a[104:107], v[112:115], v[168:171]
    s_waitcnt lgkmcnt(6)
    ds_read_b128 a[72:75], v2 offset:51200
    v_mfma_f32_16x16x32_bf16 v[168:171], a[108:111], v[116:119], v[168:171]
    buffer_load_dwordx4 v1, s[4:7], s12 offen offset:1024 lds
    v_mfma_f32_16x16x32_bf16 v[172:175], a[108:111], v[124:127], v[172:175]
    ds_read_b128 a[76:79], v2 offset:52224
    v_mfma_f32_16x16x32_bf16 v[172:175], a[104:107], v[120:123], v[172:175]
    s_waitcnt lgkmcnt(7)
    v_exp_f32 v12, v36
    v_mfma_f32_16x16x32_bf16 v[176:179], a[112:115], v[112:115], v[176:179]
    s_waitcnt lgkmcnt(6)
    ds_read_b128 a[80:83], v2 offset:53248
    v_mfma_f32_16x16x32_bf16 v[176:179], a[116:119], v[116:119], v[176:179]
    buffer_load_dwordx4 v1, s[4:7], s12 offen offset:2048 lds
    v_mfma_f32_16x16x32_bf16 v[180:183], a[116:119], v[124:127], v[180:183]
    ds_read_b128 a[84:87], v2 offset:54272
    v_mfma_f32_16x16x32_bf16 v[180:183], a[112:115], v[120:123], v[180:183]
    s_waitcnt lgkmcnt(7)
    v_exp_f32 v13, v37
    v_mfma_f32_16x16x32_bf16 v[184:187], a[120:123], v[112:115], v[184:187]
    s_waitcnt lgkmcnt(6)
    ds_read_b128 a[88:91], v2 offset:55296
    v_add_f32 v27, v12, v13
    v_mfma_f32_16x16x32_bf16 v[184:187], a[124:127], v[116:119], v[184:187]
    s_waitcnt lgkmcnt(5)
    buffer_load_dwordx4 v1, s[4:7], s12 offen offset:3072 lds
    v_mfma_f32_16x16x32_bf16 v[188:191], a[124:127], v[124:127], v[188:191]
    s_add_u32 s12, s12, 28672
    ds_read_b128 a[92:95], v2 offset:56320
    v_cvt_pk_bf16_f32 v104, v12, v13
    v_mfma_f32_16x16x32_bf16 v[188:191], a[120:123], v[120:123], v[188:191]
    s_sub_u32 s13, s13, 1
    v_exp_f32 v14, v38
    v_mfma_f32_16x16x32_bf16 v[192:195], a[64:67], v[112:115], v[192:195]
    s_cmp_eq_u32 s13, 0
    ds_read_b128 a[96:99], v2 offset:57344
    v_add_f32 v27, v27, v14
    v_mfma_f32_16x16x32_bf16 v[192:195], a[68:71], v[116:119], v[192:195]
    s_cselect_b32 s12, s14, s12
    v_mfma_f32_16x16x32_bf16 v[196:199], a[68:71], v[124:127], v[196:199]
    s_waitcnt lgkmcnt(6)
    s_cselect_b32 s13, s15, s13
    ds_read_b128 a[100:103], v2 offset:58368
    v_mfma_f32_16x16x32_bf16 v[196:199], a[64:67], v[120:123], v[196:199]
    s_cselect_b32 s14, 3221225472, s14
    v_exp_f32 v15, v39
    v_mfma_f32_16x16x32_bf16 v[200:203], a[72:75], v[112:115], v[200:203]
    s_waitcnt lgkmcnt(6)
    ds_read_b128 a[104:107], v2 offset:59392
    v_add_f32 v27, v27, v15
    v_mfma_f32_16x16x32_bf16 v[200:203], a[76:79], v[116:119], v[200:203]
    v_exp_f32 v8, v40
    v_mfma_f32_16x16x32_bf16 v[204:207], a[76:79], v[124:127], v[204:207]
    ds_read_b128 a[108:111], v2 offset:60416
    v_cvt_pk_bf16_f32 v105, v14, v15
    v_mfma_f32_16x16x32_bf16 v[204:207], a[72:75], v[120:123], v[204:207]
    s_waitcnt lgkmcnt(7)
    v_exp_f32 v9, v41
    v_mfma_f32_16x16x32_bf16 v[208:211], a[80:83], v[112:115], v[208:211]
    s_waitcnt lgkmcnt(6)
    ds_read_b128 a[112:115], v2 offset:61440
    v_add_f32 v26, v26, v8
    v_mfma_f32_16x16x32_bf16 v[208:211], a[84:87], v[116:119], v[208:211]
    v_add_f32 v26, v26, v9
    v_cvt_pk_bf16_f32 v98, v8, v9
    v_mfma_f32_16x16x32_bf16 v[212:215], a[84:87], v[124:127], v[212:215]
    ds_read_b128 a[116:119], v2 offset:62464
    v_mfma_f32_16x16x32_bf16 v[212:215], a[80:83], v[120:123], v[212:215]
    s_waitcnt lgkmcnt(7)
    v_exp_f32 v10, v42
    v_mfma_f32_16x16x32_bf16 v[216:219], a[88:91], v[112:115], v[216:219]
    s_waitcnt lgkmcnt(6)
    ds_read_b128 a[120:123], v2 offset:63488
    v_add_f32 v26, v26, v10
    v_mfma_f32_16x16x32_bf16 v[216:219], a[92:95], v[116:119], v[216:219]
    v_exp_f32 v11, v43
    v_mfma_f32_16x16x32_bf16 v[220:223], a[92:95], v[124:127], v[220:223]
    ds_read_b128 a[124:127], v2 offset:64512
    v_add_f32 v26, v26, v11
    v_mfma_f32_16x16x32_bf16 v[220:223], a[88:91], v[120:123], v[220:223]
    s_waitcnt vmcnt(8) lgkmcnt(7)
    s_barrier
    v_cvt_pk_bf16_f32 v99, v10, v11
    v_mfma_f32_16x16x32_bf16 v[224:227], a[96:99], v[112:115], v[224:227]
    s_waitcnt lgkmcnt(6)
    ds_read_b128 a[64:67], v1 offset:32768
    v_mfma_f32_16x16x32_bf16 v[224:227], a[100:103], v[116:119], v[224:227]
    v_exp_f32 v12, v44
    v_mfma_f32_16x16x32_bf16 v[228:231], a[100:103], v[124:127], v[228:231]
    ds_read_b128 a[68:71], v1 offset:33792
    v_add_f32 v27, v27, v12
    v_mfma_f32_16x16x32_bf16 v[228:231], a[96:99], v[120:123], v[228:231]
    s_waitcnt lgkmcnt(7)
    v_mfma_f32_16x16x32_bf16 v[232:235], a[104:107], v[112:115], v[232:235]
    s_waitcnt lgkmcnt(6)
    ds_read_b128 a[72:75], v1 offset:34816
    v_mfma_f32_16x16x32_bf16 v[232:235], a[108:111], v[116:119], v[232:235]
    v_exp_f32 v13, v45
    v_mfma_f32_16x16x32_bf16 v[236:239], a[108:111], v[124:127], v[236:239]
    ds_read_b128 a[76:79], v1 offset:35840
    v_add_f32 v27, v27, v13
    v_mfma_f32_16x16x32_bf16 v[236:239], a[104:107], v[120:123], v[236:239]
    s_waitcnt lgkmcnt(7)
    v_exp_f32 v14, v46
    v_mfma_f32_16x16x32_bf16 v[240:243], a[112:115], v[112:115], v[240:243]
    s_waitcnt lgkmcnt(6)
    ds_read_b128 a[80:83], v1 offset:36864
    v_cvt_pk_bf16_f32 v106, v12, v13
    v_mfma_f32_16x16x32_bf16 v[240:243], a[116:119], v[116:119], v[240:243]
    v_exp_f32 v15, v47
    v_mfma_f32_16x16x32_bf16 v[244:247], a[116:119], v[124:127], v[244:247]
    ds_read_b128 a[84:87], v1 offset:37888
    v_add_f32 v27, v27, v14
    v_mfma_f32_16x16x32_bf16 v[244:247], a[112:115], v[120:123], v[244:247]
    s_waitcnt lgkmcnt(7)
    v_add_f32 v27, v27, v15
    v_cvt_pk_bf16_f32 v107, v14, v15
    v_mfma_f32_16x16x32_bf16 v[248:251], a[120:123], v[112:115], v[248:251]
    s_waitcnt lgkmcnt(6)
    ds_read_b128 a[88:91], v1 offset:38912
    v_mfma_f32_16x16x32_bf16 v[248:251], a[124:127], v[116:119], v[248:251]
    v_mfma_f32_16x16x32_bf16 v[252:255], a[124:127], v[124:127], v[252:255]
    ds_read_b128 a[92:95], v1 offset:39936
    v_mfma_f32_16x16x32_bf16 v[252:255], a[120:123], v[120:123], v[252:255]
    s_waitcnt lgkmcnt(6)
K2_dx1:
    v_cndmask_b32 v68, v20, v7, s[32:33]
    v_cndmask_b32 v69, v20, v7, s[34:35]
    v_cndmask_b32 v70, v20, v7, s[36:37]
    v_cndmask_b32 v71, v20, v7, s[38:39]
    s_nop 1
    v_mfma_f32_16x16x32_bf16 v[68:71], a[64:67], a[32:35], v[68:71]
    s_add_u32 m0, s16, 0
    ds_read_b128 a[96:99], v1 offset:40960
    v_cndmask_b32 v76, v20, v7, s[40:41]
    v_cndmask_b32 v79, v20, v7, s[46:47]
    v_exp_f32 v8, v48
    v_mfma_f32_16x16x32_bf16 v[68:71], a[68:71], a[36:39], v[68:71]
    s_waitcnt lgkmcnt(6)
    ds_read_b128 a[100:103], v1 offset:41984
    buffer_load_dwordx4 v1, s[4:7], s12 offen offset:0 lds
    v_exp_f32 v9, v49
    v_add_f32 v26, v26, v8
    v_mfma_f32_16x16x32_bf16 v[68:71], a[72:75], a[40:43], v[68:71]
    s_waitcnt lgkmcnt(6)
    ds_read_b128 a[104:107], v1 offset:43008
    v_cndmask_b32 v77, v20, v7, s[42:43]
    v_add_f32 v26, v26, v9
    v_cvt_pk_bf16_f32 v100, v8, v9
    v_mfma_f32_16x16x32_bf16 v[68:71], a[76:79], a[44:47], v[68:71]
    s_waitcnt lgkmcnt(6)
    ds_read_b128 a[108:111], v1 offset:44032
    buffer_load_dwordx4 v1, s[4:7], s12 offen offset:1024 lds
    v_exp_f32 v10, v50
    v_mfma_f32_16x16x32_bf16 v[68:71], a[80:83], a[48:51], v[68:71]
    s_waitcnt lgkmcnt(6)
    ds_read_b128 a[112:115], v1 offset:45056
    v_cndmask_b32 v78, v20, v7, s[44:45]
    v_exp_f32 v11, v51
    v_add_f32 v26, v26, v10
    v_mfma_f32_16x16x32_bf16 v[68:71], a[84:87], a[52:55], v[68:71]
    s_waitcnt lgkmcnt(6)
    ds_read_b128 a[116:119], v1 offset:46080
    buffer_load_dwordx4 v1, s[4:7], s12 offen offset:2048 lds
    v_add_f32 v26, v26, v11
    v_cvt_pk_bf16_f32 v101, v10, v11
    v_mfma_f32_16x16x32_bf16 v[68:71], a[88:91], a[56:59], v[68:71]
    s_waitcnt lgkmcnt(6)
    ds_read_b128 a[120:123], v1 offset:47104
    v_exp_f32 v12, v52
    v_mfma_f32_16x16x32_bf16 v[68:71], a[92:95], a[60:63], v[68:71]
    s_waitcnt lgkmcnt(5)
    ds_read_b128 a[124:127], v1 offset:48128
    buffer_load_dwordx4 v1, s[4:7], s12 offen offset:3072 lds
    v_add_f32 v27, v27, v12
    v_mfma_f32_16x16x32_bf16 v[76:79], a[96:99], a[32:35], v[76:79]
    s_add_u32 s12, s12, 4096
    s_add_u32 m0, s16, 4096
    ds_read_b128 a[64:67], v1 offset:49152
    v_cndmask_b32 v86, v20, v7, s[52:53]
    v_cndmask_b32 v87, v20, v7, s[54:55]
    v_exp_f32 v13, v53
    v_mfma_f32_16x16x32_bf16 v[76:79], a[100:103], a[36:39], v[76:79]
    s_waitcnt lgkmcnt(6)
    ds_read_b128 a[68:71], v1 offset:50176
    buffer_load_dwordx4 v1, s[4:7], s12 offen offset:0 lds
    v_exp_f32 v14, v54
    v_add_f32 v27, v27, v13
    v_cvt_pk_bf16_f32 v108, v12, v13
    v_mfma_f32_16x16x32_bf16 v[76:79], a[104:107], a[40:43], v[76:79]
    s_waitcnt lgkmcnt(6)
    ds_read_b128 a[72:75], v1 offset:51200
    v_cndmask_b32 v84, v20, v7, s[48:49]
    v_add_f32 v27, v27, v14
    v_mfma_f32_16x16x32_bf16 v[76:79], a[108:111], a[44:47], v[76:79]
    s_waitcnt lgkmcnt(6)
    ds_read_b128 a[76:79], v1 offset:52224
    buffer_load_dwordx4 v1, s[4:7], s12 offen offset:1024 lds
    v_exp_f32 v15, v55
    v_mfma_f32_16x16x32_bf16 v[76:79], a[112:115], a[48:51], v[76:79]
    s_waitcnt lgkmcnt(6)
    ds_read_b128 a[80:83], v1 offset:53248
    v_cndmask_b32 v85, v20, v7, s[50:51]
    v_add_f32 v27, v27, v15
    v_cvt_pk_bf16_f32 v109, v14, v15
    v_mfma_f32_16x16x32_bf16 v[76:79], a[116:119], a[52:55], v[76:79]
    s_waitcnt lgkmcnt(6)
    ds_read_b128 a[84:87], v1 offset:54272
    buffer_load_dwordx4 v1, s[4:7], s12 offen offset:2048 lds
    v_exp_f32 v8, v56
    v_mfma_f32_16x16x32_bf16 v[76:79], a[120:123], a[56:59], v[76:79]
    s_waitcnt lgkmcnt(6)
    ds_read_b128 a[88:91], v1 offset:55296
    v_exp_f32 v9, v57
    v_add_f32 v26, v26, v8
    v_mfma_f32_16x16x32_bf16 v[76:79], a[124:127], a[60:63], v[76:79]
    s_waitcnt lgkmcnt(1)
    ds_read_b128 a[92:95], v1 offset:56320
    buffer_load_dwordx4 v1, s[4:7], s12 offen offset:3072 lds
    v_add_f32 v26, v26, v9
    v_cvt_pk_bf16_f32 v102, v8, v9
    v_mfma_f32_16x16x32_bf16 v[84:87], a[64:67], a[32:35], v[84:87]
    s_add_u32 s12, s12, 28672
    ds_read_b128 a[96:99], v1 offset:57344
    v_cndmask_b32 v92, v20, v7, s[56:57]
    v_exp_f32 v10, v58
    v_mfma_f32_16x16x32_bf16 v[84:87], a[68:71], a[36:39], v[84:87]
    s_sub_u32 s13, s13, 1
    ds_read_b128 a[100:103], v1 offset:58368
    v_cndmask_b32 v93, v20, v7, s[58:59]
    v_exp_f32 v11, v59
    v_mfma_f32_16x16x32_bf16 v[84:87], a[72:75], a[40:43], v[84:87]
    s_cmp_eq_u32 s13, 0
    ds_read_b128 a[104:107], v1 offset:59392
    v_cndmask_b32 v94, v20, v7, s[60:61]
    v_mfma_f32_16x16x32_bf16 v[84:87], a[76:79], a[44:47], v[84:87]
    s_cselect_b32 s12, s14, s12
    ds_read_b128 a[108:111], v1 offset:60416
    v_cndmask_b32 v95, v20, v7, s[62:63]
    v_exp_f32 v12, v60
    v_mfma_f32_16x16x32_bf16 v[84:87], a[80:83], a[48:51], v[84:87]
    s_cselect_b32 s13, s15, s13
    ds_read_b128 a[112:115], v1 offset:61440
    v_add_f32 v26, v26, v10
    v_add_f32 v26, v26, v11
    v_cvt_pk_bf16_f32 v103, v10, v11
    v_add_f32 v27, v27, v12
    v_mfma_f32_16x16x32_bf16 v[84:87], a[84:87], a[52:55], v[84:87]
    s_waitcnt lgkmcnt(6)
    s_cselect_b32 s14, 3221225472, s14
    ds_read_b128 a[116:119], v1 offset:62464
    v_exp_f32 v13, v61
    v_mfma_f32_16x16x32_bf16 v[84:87], a[88:91], a[56:59], v[84:87]
    s_waitcnt lgkmcnt(6)
    ds_read_b128 a[120:123], v1 offset:63488
    v_exp_f32 v14, v62
    v_mfma_f32_16x16x32_bf16 v[84:87], a[92:95], a[60:63], v[84:87]
    s_waitcnt vmcnt(8) lgkmcnt(6)
    s_barrier
    ds_read_b128 a[124:127], v1 offset:64512
    v_mfma_f32_16x16x32_bf16 v[92:95], a[96:99], a[32:35], v[92:95]
    s_waitcnt lgkmcnt(6)
    ds_read_b128 a[64:67], v2 offset:0
    v_exp_f32 v15, v63
    v_mfma_f32_16x16x32_bf16 v[92:95], a[100:103], a[36:39], v[92:95]
    s_waitcnt lgkmcnt(6)
    ds_read_b128 a[68:71], v2 offset:1024
    v_add_f32 v27, v27, v13
    v_mfma_f32_16x16x32_bf16 v[92:95], a[104:107], a[40:43], v[92:95]
    s_waitcnt lgkmcnt(6)
    ds_read_b128 a[72:75], v2 offset:2048
    v_cvt_pk_bf16_f32 v110, v12, v13
    v_mfma_f32_16x16x32_bf16 v[92:95], a[108:111], a[44:47], v[92:95]
    s_waitcnt lgkmcnt(6)
    ds_read_b128 a[76:79], v2 offset:3072
    v_add_f32 v27, v27, v14
    v_mfma_f32_16x16x32_bf16 v[92:95], a[112:115], a[48:51], v[92:95]
    s_waitcnt lgkmcnt(6)
    ds_read_b128 a[80:83], v2 offset:4096
    v_add_f32 v27, v27, v15
    v_mfma_f32_16x16x32_bf16 v[92:95], a[116:119], a[52:55], v[92:95]
    s_waitcnt lgkmcnt(6)
    ds_read_b128 a[84:87], v2 offset:5120
    v_cvt_pk_bf16_f32 v111, v14, v15
    v_mfma_f32_16x16x32_bf16 v[92:95], a[120:123], a[56:59], v[92:95]
    s_waitcnt lgkmcnt(6)
    ds_read_b128 a[88:91], v2 offset:6144
    v_add_f32 v28, v26, v27
    v_mfma_f32_16x16x32_bf16 v[92:95], a[124:127], a[60:63], v[92:95]
    s_waitcnt lgkmcnt(6)
    ds_read_b128 a[92:95], v2 offset:7168
    v_cmp_nge_f32 vcc, s24, v28
    s_cbranch_vccnz BLstub_7
BLback_8:
    v_mfma_f32_16x16x32_bf16 v[128:131], a[64:67], v[96:99], v[128:131]
    s_waitcnt lgkmcnt(6)
    ds_read_b128 a[96:99], v2 offset:8192
    v_add_f32 v24, v24, v26
    v_mfma_f32_16x16x32_bf16 v[128:131], a[68:71], v[100:103], v[128:131]
    v_add_f32 v25, v25, v27
    v_mfma_f32_16x16x32_bf16 v[132:135], a[68:71], v[108:111], v[132:135]
    ds_read_b128 a[100:103], v2 offset:9216
    v_mfma_f32_16x16x32_bf16 v[132:135], a[64:67], v[104:107], v[132:135]
    s_waitcnt lgkmcnt(7)
    v_exp_f32 v8, v68
    v_mfma_f32_16x16x32_bf16 v[136:139], a[72:75], v[96:99], v[136:139]
    s_waitcnt lgkmcnt(6)
    ds_read_b128 a[104:107], v2 offset:10240
    v_mfma_f32_16x16x32_bf16 v[136:139], a[76:79], v[100:103], v[136:139]
    v_exp_f32 v9, v69
    v_mfma_f32_16x16x32_bf16 v[140:143], a[76:79], v[108:111], v[140:143]
    ds_read_b128 a[108:111], v2 offset:11264
    v_add_f32 v27, v8, v9
    v_mfma_f32_16x16x32_bf16 v[140:143], a[72:75], v[104:107], v[140:143]
    s_waitcnt lgkmcnt(7)
    v_cvt_pk_bf16_f32 v120, v8, v9
    v_mfma_f32_16x16x32_bf16 v[144:147], a[80:83], v[96:99], v[144:147]
    s_waitcnt lgkmcnt(6)
    ds_read_b128 a[112:115], v2 offset:12288
    v_mfma_f32_16x16x32_bf16 v[144:147], a[84:87], v[100:103], v[144:147]
    v_exp_f32 v10, v70
    v_mfma_f32_16x16x32_bf16 v[148:151], a[84:87], v[108:111], v[148:151]
    ds_read_b128 a[116:119], v2 offset:13312
    v_add_f32 v27, v27, v10
    v_mfma_f32_16x16x32_bf16 v[148:151], a[80:83], v[104:107], v[148:151]
    s_waitcnt lgkmcnt(7)
    v_mfma_f32_16x16x32_bf16 v[152:155], a[88:91], v[96:99], v[152:155]
    s_waitcnt lgkmcnt(6)
    ds_read_b128 a[120:123], v2 offset:14336
    v_mfma_f32_16x16x32_bf16 v[152:155], a[92:95], v[100:103], v[152:155]
    v_exp_f32 v11, v71
    v_mfma_f32_16x16x32_bf16 v[156:159], a[92:95], v[108:111], v[156:159]
    ds_read_b128 a[124:127], v2 offset:15360
    v_add_f32 v27, v27, v11
    v_mfma_f32_16x16x32_bf16 v[156:159], a[88:91], v[104:107], v[156:159]
    s_waitcnt lgkmcnt(7)
    v_exp_f32 v12, v76
    v_mfma_f32_16x16x32_bf16 v[160:163], a[96:99], v[96:99], v[160:163]
    s_waitcnt lgkmcnt(6)
    ds_read_b128 a[64:67], v2 offset:16384
    v_cvt_pk_bf16_f32 v121, v10, v11
    v_mfma_f32_16x16x32_bf16 v[160:163], a[100:103], v[100:103], v[160:163]
    v_add_f32 v27, v27, v12
    v_mfma_f32_16x16x32_bf16 v[164:167], a[100:103], v[108:111], v[164:167]
    ds_read_b128 a[68:71], v2 offset:17408
    v_mfma_f32_16x16x32_bf16 v[164:167], a[96:99], v[104:107], v[164:167]
    s_waitcnt lgkmcnt(7)
    v_exp_f32 v13, v77
    v_mfma_f32_16x16x32_bf16 v[168:171], a[104:107], v[96:99], v[168:171]
    s_waitcnt lgkmcnt(6)
    ds_read_b128 a[72:75], v2 offset:18432
    v_add_f32 v27, v27, v13
    v_mfma_f32_16x16x32_bf16 v[168:171], a[108:111], v[100:103], v[168:171]
    v_cvt_pk_bf16_f32 v122, v12, v13
    v_mfma_f32_16x16x32_bf16 v[172:175], a[108:111], v[108:111], v[172:175]
    ds_read_b128 a[76:79], v2 offset:19456
    v_mfma_f32_16x16x32_bf16 v[172:175], a[104:107], v[104:107], v[172:175]
    s_waitcnt lgkmcnt(7)
    v_exp_f32 v14, v78
    v_mfma_f32_16x16x32_bf16 v[176:179], a[112:115], v[96:99], v[176:179]
    s_waitcnt lgkmcnt(6)
    ds_read_b128 a[80:83], v2 offset:20480
    v_add_f32 v27, v27, v14
    v_mfma_f32_16x16x32_bf16 v[176:179], a[116:119], v[100:103], v[176:179]
    v_exp_f32 v15, v79
    v_mfma_f32_16x16x32_bf16 v[180:183], a[116:119], v[108:111], v[180:183]
    ds_read_b128 a[84:87], v2 offset:21504
    v_add_f32 v27, v27, v15
    v_mfma_f32_16x16x32_bf16 v[180:183], a[112:115], v[104:107], v[180:183]
    s_waitcnt lgkmcnt(7)
    v_cvt_pk_bf16_f32 v123, v14, v15
    v_mfma_f32_16x16x32_bf16 v[184:187], a[120:123], v[96:99], v[184:187]
    s_waitcnt lgkmcnt(6)
    ds_read_b128 a[88:91], v2 offset:22528
    v_mfma_f32_16x16x32_bf16 v[184:187], a[124:127], v[100:103], v[184:187]
    v_exp_f32 v8, v84
    v_mfma_f32_16x16x32_bf16 v[188:191], a[124:127], v[108:111], v[188:191]
    ds_read_b128 a[92:95], v2 offset:23552
    v_add_f32 v27, v27, v8
    v_mfma_f32_16x16x32_bf16 v[188:191], a[120:123], v[104:107], v[188:191]
    s_waitcnt lgkmcnt(7)
    v_mfma_f32_16x16x32_bf16 v[192:195], a[64:67], v[96:99], v[192:195]
    s_waitcnt lgkmcnt(6)
    ds_read_b128 a[96:99], v2 offset:24576
    v_mfma_f32_16x16x32_bf16 v[192:195], a[68:71], v[100:103], v[192:195]
    v_exp_f32 v9, v85
    v_mfma_f32_16x16x32_bf16 v[196:199], a[68:71], v[108:111], v[196:199]
    ds_read_b128 a[100:103], v2 offset:25600
    v_add_f32 v27, v27, v9
    v_mfma_f32_16x16x32_bf16 v[196:199], a[64:67], v[104:107], v[196:199]
    s_waitcnt lgkmcnt(7)
    v_exp_f32 v10, v86
    v_mfma_f32_16x16x32_bf16 v[200:203], a[72:75], v[96:99], v[200:203]
    s_waitcnt lgkmcnt(6)
    ds_read_b128 a[104:107], v2 offset:26624
    v_cvt_pk_bf16_f32 v124, v8, v9
    v_mfma_f32_16x16x32_bf16 v[200:203], a[76:79], v[100:103], v[200:203]
    v_add_f32 v27, v27, v10
    v_mfma_f32_16x16x32_bf16 v[204:207], a[76:79], v[108:111], v[204:207]
    ds_read_b128 a[108:111], v2 offset:27648
    v_mfma_f32_16x16x32_bf16 v[204:207], a[72:75], v[104:107], v[204:207]
    s_waitcnt lgkmcnt(7)
    v_exp_f32 v11, v87
    v_mfma_f32_16x16x32_bf16 v[208:211], a[80:83], v[96:99], v[208:211]
    s_waitcnt lgkmcnt(6)
    ds_read_b128 a[112:115], v2 offset:28672
    v_add_f32 v27, v27, v11
    v_mfma_f32_16x16x32_bf16 v[208:211], a[84:87], v[100:103], v[208:211]
    v_cvt_pk_bf16_f32 v125, v10, v11
    v_mfma_f32_16x16x32_bf16 v[212:215], a[84:87], v[108:111], v[212:215]
    ds_read_b128 a[116:119], v2 offset:29696
    v_mfma_f32_16x16x32_bf16 v[212:215], a[80:83], v[104:107], v[212:215]
    s_waitcnt lgkmcnt(7)
    v_exp_f32 v12, v92
    v_mfma_f32_16x16x32_bf16 v[216:219], a[88:91], v[96:99], v[216:219]
    s_waitcnt lgkmcnt(6)
    ds_read_b128 a[120:123], v2 offset:30720
    v_add_f32 v27, v27, v12
    v_mfma_f32_16x16x32_bf16 v[216:219], a[92:95], v[100:103], v[216:219]
    v_exp_f32 v13, v93
    v_mfma_f32_16x16x32_bf16 v[220:223], a[92:95], v[108:111], v[220:223]
    ds_read_b128 a[124:127], v2 offset:31744
    v_add_f32 v27, v27, v13
    v_mfma_f32_16x16x32_bf16 v[220:223], a[88:91], v[104:107], v[220:223]
    s_waitcnt vmcnt(0) lgkmcnt(7)
    s_barrier
    v_cvt_pk_bf16_f32 v126, v12, v13
    v_mfma_f32_16x16x32_bf16 v[224:227], a[96:99], v[96:99], v[224:227]
    s_waitcnt lgkmcnt(6)
    ds_read_b128 a[64:67], v1 offset:0
    v_mfma_f32_16x16x32_bf16 v[224:227], a[100:103], v[100:103], v[224:227]
    v_mfma_f32_16x16x32_bf16 v[228:231], a[100:103], v[108:111], v[228:231]
    ds_read_b128 a[68:71], v1 offset:1024
    v_mfma_f32_16x16x32_bf16 v[228:231], a[96:99], v[104:107], v[228:231]
    s_waitcnt lgkmcnt(7)
    v_exp_f32 v14, v94
    v_mfma_f32_16x16x32_bf16 v[232:235], a[104:107], v[96:99], v[232:235]
    s_waitcnt lgkmcnt(6)
    ds_read_b128 a[72:75], v1 offset:2048
    v_add_f32 v27, v27, v14
    v_mfma_f32_16x16x32_bf16 v[232:235], a[108:111], v[100:103], v[232:235]
    v_mfma_f32_16x16x32_bf16 v[236:239], a[108:111], v[108:111], v[236:239]
    ds_read_b128 a[76:79], v1 offset:3072
    v_mfma_f32_16x16x32_bf16 v[236:239], a[104:107], v[104:107], v[236:239]
    s_waitcnt lgkmcnt(7)
    v_exp_f32 v15, v95
    v_mfma_f32_16x16x32_bf16 v[240:243], a[112:115], v[96:99], v[240:243]
    s_waitcnt lgkmcnt(6)
    ds_read_b128 a[80:83], v1 offset:4096
    v_add_f32 v27, v27, v15
    v_mfma_f32_16x16x32_bf16 v[240:243], a[116:119], v[100:103], v[240:243]
    v_cvt_pk_bf16_f32 v127, v14, v15
    v_cmp_nge_f32 vcc, s24, v27
    v_mfma_f32_16x16x32_bf16 v[244:247], a[116:119], v[108:111], v[244:247]
    ds_read_b128 a[84:87], v1 offset:5120
    v_mfma_f32_16x16x32_bf16 v[244:247], a[112:115], v[104:107], v[244:247]
    s_waitcnt lgkmcnt(7)
    v_mfma_f32_16x16x32_bf16 v[248:251], a[120:123], v[96:99], v[248:251]
    s_waitcnt lgkmcnt(6)
    ds_read_b128 a[88:91], v1 offset:6144
    v_mfma_f32_16x16x32_bf16 v[248:251], a[124:127], v[100:103], v[248:251]
    v_mfma_f32_16x16x32_bf16 v[252:255], a[124:127], v[108:111], v[252:255]
    ds_read_b128 a[92:95], v1 offset:7168
    v_mfma_f32_16x16x32_bf16 v[252:255], a[120:123], v[104:107], v[252:255]
    s_waitcnt lgkmcnt(7)
    s_cbranch_vccnz BLstub_9
BLback_10:
    v_mfma_f32_16x16x32_bf16 v[132:135], a[64:67], v[120:123], v[132:135]
    s_waitcnt lgkmcnt(6)
    ds_read_b128 a[96:99], v1 offset:8192
    v_add_f32 v25, v25, v27
    v_mfma_f32_16x16x32_bf16 v[132:135], a[68:71], v[124:127], v[132:135]
    s_waitcnt lgkmcnt(6)
    ds_read_b128 a[100:103], v1 offset:9216
    v_mfma_f32_16x16x32_bf16 v[140:143], a[72:75], v[120:123], v[140:143]
    s_waitcnt lgkmcnt(6)
    ds_read_b128 a[104:107], v1 offset:10240
    v_mfma_f32_16x16x32_bf16 v[140:143], a[76:79], v[124:127], v[140:143]
    s_waitcnt lgkmcnt(6)
    ds_read_b128 a[108:111], v1 offset:11264
    v_mfma_f32_16x16x32_bf16 v[148:151], a[80:83], v[120:123], v[148:151]
    s_waitcnt lgkmcnt(6)
    ds_read_b128 a[112:115], v1 offset:12288
    v_mfma_f32_16x16x32_bf16 v[148:151], a[84:87], v[124:127], v[148:151]
    s_waitcnt lgkmcnt(6)
    ds_read_b128 a[116:119], v1 offset:13312
    v_mfma_f32_16x16x32_bf16 v[156:159], a[88:91], v[120:123], v[156:159]
    s_waitcnt lgkmcnt(6)
    ds_read_b128 a[120:123], v1 offset:14336
    v_mfma_f32_16x16x32_bf16 v[156:159], a[92:95], v[124:127], v[156:159]
    s_waitcnt lgkmcnt(6)
    ds_read_b128 a[124:127], v1 offset:15360
    v_mfma_f32_16x16x32_bf16 v[164:167], a[96:99], v[120:123], v[164:167]
    s_waitcnt lgkmcnt(6)
    ds_read_b128 a[64:67], v1 offset:16384
    v_mfma_f32_16x16x32_bf16 v[164:167], a[100:103], v[124:127], v[164:167]
    s_waitcnt lgkmcnt(6)
    ds_read_b128 a[68:71], v1 offset:17408
    v_mfma_f32_16x16x32_bf16 v[172:175], a[104:107], v[120:123], v[172:175]
    s_waitcnt lgkmcnt(6)
    ds_read_b128 a[72:75], v1 offset:18432
    v_mfma_f32_16x16x32_bf16 v[172:175], a[108:111], v[124:127], v[172:175]
    s_waitcnt lgkmcnt(6)
    ds_read_b128 a[76:79], v1 offset:19456
    v_mfma_f32_16x16x32_bf16 v[180:183], a[112:115], v[120:123], v[180:183]
    s_waitcnt lgkmcnt(6)
    ds_read_b128 a[80:83], v1 offset:20480
    v_mfma_f32_16x16x32_bf16 v[180:183], a[116:119], v[124:127], v[180:183]
    s_waitcnt lgkmcnt(6)
    ds_read_b128 a[84:87], v1 offset:21504
    v_mfma_f32_16x16x32_bf16 v[188:191], a[120:123], v[120:123], v[188:191]
    s_waitcnt lgkmcnt(6)
    ds_read_b128 a[88:91], v1 offset:22528
    v_mfma_f32_16x16x32_bf16 v[188:191], a[124:127], v[124:127], v[188:191]
    s_waitcnt lgkmcnt(6)
    ds_read_b128 a[92:95], v1 offset:23552
    v_mfma_f32_16x16x32_bf16 v[196:199], a[64:67], v[120:123], v[196:199]
    s_waitcnt lgkmcnt(6)
    ds_read_b128 a[96:99], v1 offset:24576
    v_mfma_f32_16x16x32_bf16 v[196:199], a[68:71], v[124:127], v[196:199]
    s_waitcnt lgkmcnt(6)
    ds_read_b128 a[100:103], v1 offset:25600
    v_mfma_f32_16x16x32_bf16 v[204:207], a[72:75], v[120:123], v[204:207]
    s_waitcnt lgkmcnt(6)
    ds_read_b128 a[104:107], v1 offset:26624
    v_mfma_f32_16x16x32_bf16 v[204:207], a[76:79], v[124:127], v[204:207]
    s_waitcnt lgkmcnt(6)
    ds_read_b128 a[108:111], v1 offset:27648
    v_mfma_f32_16x16x32_bf16 v[212:215], a[80:83], v[120:123], v[212:215]
    s_waitcnt lgkmcnt(6)
    ds_read_b128 a[112:115], v1 offset:28672
    v_mfma_f32_16x16x32_bf16 v[212:215], a[84:87], v[124:127], v[212:215]
    s_waitcnt lgkmcnt(6)
    ds_read_b128 a[116:119], v1 offset:29696
    v_mfma_f32_16x16x32_bf16 v[220:223], a[88:91], v[120:123], v[220:223]
    s_waitcnt lgkmcnt(6)
    ds_read_b128 a[120:123], v1 offset:30720
    v_mfma_f32_16x16x32_bf16 v[220:223], a[92:95], v[124:127], v[220:223]
    s_waitcnt lgkmcnt(6)
    ds_read_b128 a[124:127], v1 offset:31744
    v_mfma_f32_16x16x32_bf16 v[228:231], a[96:99], v[120:123], v[228:231]
    s_waitcnt lgkmcnt(6)
    v_mfma_f32_16x16x32_bf16 v[228:231], a[100:103], v[124:127], v[228:231]
    s_waitcnt lgkmcnt(5)
    v_mfma_f32_16x16x32_bf16 v[236:239], a[104:107], v[120:123], v[236:239]
    s_waitcnt lgkmcnt(4)
    v_mfma_f32_16x16x32_bf16 v[236:239], a[108:111], v[124:127], v[236:239]
    s_waitcnt lgkmcnt(3)
    v_mfma_f32_16x16x32_bf16 v[244:247], a[112:115], v[120:123], v[244:247]
    s_waitcnt lgkmcnt(2)
    v_mfma_f32_16x16x32_bf16 v[244:247], a[116:119], v[124:127], v[244:247]
    s_waitcnt lgkmcnt(1)
    v_mfma_f32_16x16x32_bf16 v[252:255], a[120:123], v[120:123], v[252:255]
    s_waitcnt lgkmcnt(0)
    v_mfma_f32_16x16x32_bf16 v[252:255], a[124:127], v[124:127], v[252:255]
    v_mov_b32 v28, v24
    s_nop 1
    v_permlane16_swap_b32 v24, v28
    v_add_f32 v24, v24, v28
    v_mov_b32 v28, v24
    s_nop 1
    v_permlane32_swap_b32 v24, v28
    v_add_f32 v24, v24, v28
    v_mov_b32 v29, v25
    s_nop 1
    v_permlane16_swap_b32 v25, v29
    v_add_f32 v25, v25, v29
    v_mov_b32 v29, v25
    s_nop 1
    v_permlane32_swap_b32 v25, v29
    v_add_f32 v25, v25, v29
    s_lshl_b32 s22, s23, 3
    s_add_u32 s22, s22, s19
    s_lshl_b32 s22, s22, 17
    s_lshl_b32 s21, s20, 13
    s_add_u32 s22, s22, s21
    s_add_u32 s22, s22, 50331648
    s_cmp_eq_u32 s18, 1
    s_cbranch_scc1 K2_comb
    v_rcp_f32 v28, v24
    v_rcp_f32 v29, v25
    s_nop 0
    s_add_u32 s21, s22, 0
    v_mul_f32 v128, v128, v28
    v_mul_f32 v129, v129, v28
    v_mul_f32 v130, v130, v28
    v_mul_f32 v131, v131, v28
    v_mul_f32 v136, v136, v28
    v_mul_f32 v137, v137, v28
    v_mul_f32 v138, v138, v28
    v_mul_f32 v139, v139, v28
    v_cvt_pk_bf16_f32 v128, v128, v129
    v_cvt_pk_bf16_f32 v129, v130, v131
    v_cvt_pk_bf16_f32 v130, v136, v137
    v_cvt_pk_bf16_f32 v131, v138, v139
    buffer_store_dwordx4 v[128:131], v1, s[4:7], s21 offen offset:0
    v_mul_f32 v144, v144, v28
    v_mul_f32 v145, v145, v28
    v_mul_f32 v146, v146, v28
    v_mul_f32 v147, v147, v28
    v_mul_f32 v152, v152, v28
    v_mul_f32 v153, v153, v28
    v_mul_f32 v154, v154, v28
    v_mul_f32 v155, v155, v28
    v_cvt_pk_bf16_f32 v144, v144, v145
    v_cvt_pk_bf16_f32 v145, v146, v147
    v_cvt_pk_bf16_f32 v146, v152, v153
    v_cvt_pk_bf16_f32 v147, v154, v155
    buffer_store_dwordx4 v[144:147], v1, s[4:7], s21 offen offset:1024
    v_mul_f32 v160, v160, v28
    v_mul_f32 v161, v161, v28
    v_mul_f32 v162, v162, v28
    v_mul_f32 v163, v163, v28
    v_mul_f32 v168, v168, v28
    v_mul_f32 v169, v169, v28
    v_mul_f32 v170, v170, v28
    v_mul_f32 v171, v171, v28
    v_cvt_pk_bf16_f32 v160, v160, v161
    v_cvt_pk_bf16_f32 v161, v162, v163
    v_cvt_pk_bf16_f32 v162, v168, v169
    v_cvt_pk_bf16_f32 v163, v170, v171
    buffer_store_dwordx4 v[160:163], v1, s[4:7], s21 offen offset:2048
    v_mul_f32 v176, v176, v28
    v_mul_f32 v177, v177, v28
    v_mul_f32 v178, v178, v28
    v_mul_f32 v179, v179, v28
    v_mul_f32 v184, v184, v28
    v_mul_f32 v185, v185, v28
    v_mul_f32 v186, v186, v28
    v_mul_f32 v187, v187, v28
    v_cvt_pk_bf16_f32 v176, v176, v177
    v_cvt_pk_bf16_f32 v177, v178, v179
    v_cvt_pk_bf16_f32 v178, v184, v185
    v_cvt_pk_bf16_f32 v179, v186, v187
    buffer_store_dwordx4 v[176:179], v1, s[4:7], s21 offen offset:3072
    s_add_u32 s21, s22, 4096
    v_mul_f32 v192, v192, v28
    v_mul_f32 v193, v193, v28
    v_mul_f32 v194, v194, v28
    v_mul_f32 v195, v195, v28
    v_mul_f32 v200, v200, v28
    v_mul_f32 v201, v201, v28
    v_mul_f32 v202, v202, v28
    v_mul_f32 v203, v203, v28
    v_cvt_pk_bf16_f32 v192, v192, v193
    v_cvt_pk_bf16_f32 v193, v194, v195
    v_cvt_pk_bf16_f32 v194, v200, v201
    v_cvt_pk_bf16_f32 v195, v202, v203
    buffer_store_dwordx4 v[192:195], v1, s[4:7], s21 offen offset:0
    v_mul_f32 v208, v208, v28
    v_mul_f32 v209, v209, v28
    v_mul_f32 v210, v210, v28
    v_mul_f32 v211, v211, v28
    v_mul_f32 v216, v216, v28
    v_mul_f32 v217, v217, v28
    v_mul_f32 v218, v218, v28
    v_mul_f32 v219, v219, v28
    v_cvt_pk_bf16_f32 v208, v208, v209
    v_cvt_pk_bf16_f32 v209, v210, v211
    v_cvt_pk_bf16_f32 v210, v216, v217
    v_cvt_pk_bf16_f32 v211, v218, v219
    buffer_store_dwordx4 v[208:211], v1, s[4:7], s21 offen offset:1024
    v_mul_f32 v224, v224, v28
    v_mul_f32 v225, v225, v28
    v_mul_f32 v226, v226, v28
    v_mul_f32 v227, v227, v28
    v_mul_f32 v232, v232, v28
    v_mul_f32 v233, v233, v28
    v_mul_f32 v234, v234, v28
    v_mul_f32 v235, v235, v28
    v_cvt_pk_bf16_f32 v224, v224, v225
    v_cvt_pk_bf16_f32 v225, v226, v227
    v_cvt_pk_bf16_f32 v226, v232, v233
    v_cvt_pk_bf16_f32 v227, v234, v235
    buffer_store_dwordx4 v[224:227], v1, s[4:7], s21 offen offset:2048
    v_mul_f32 v240, v240, v28
    v_mul_f32 v241, v241, v28
    v_mul_f32 v242, v242, v28
    v_mul_f32 v243, v243, v28
    v_mul_f32 v248, v248, v28
    v_mul_f32 v249, v249, v28
    v_mul_f32 v250, v250, v28
    v_mul_f32 v251, v251, v28
    v_cvt_pk_bf16_f32 v240, v240, v241
    v_cvt_pk_bf16_f32 v241, v242, v243
    v_cvt_pk_bf16_f32 v242, v248, v249
    v_cvt_pk_bf16_f32 v243, v250, v251
    buffer_store_dwordx4 v[240:243], v1, s[4:7], s21 offen offset:3072
    s_add_u32 s21, s22, 524288
    v_mul_f32 v132, v132, v29
    v_mul_f32 v133, v133, v29
    v_mul_f32 v134, v134, v29
    v_mul_f32 v135, v135, v29
    v_mul_f32 v140, v140, v29
    v_mul_f32 v141, v141, v29
    v_mul_f32 v142, v142, v29
    v_mul_f32 v143, v143, v29
    v_cvt_pk_bf16_f32 v132, v132, v133
    v_cvt_pk_bf16_f32 v133, v134, v135
    v_cvt_pk_bf16_f32 v134, v140, v141
    v_cvt_pk_bf16_f32 v135, v142, v143
    buffer_store_dwordx4 v[132:135], v1, s[4:7], s21 offen offset:0
    v_mul_f32 v148, v148, v29
    v_mul_f32 v149, v149, v29
    v_mul_f32 v150, v150, v29
    v_mul_f32 v151, v151, v29
    v_mul_f32 v156, v156, v29
    v_mul_f32 v157, v157, v29
    v_mul_f32 v158, v158, v29
    v_mul_f32 v159, v159, v29
    v_cvt_pk_bf16_f32 v148, v148, v149
    v_cvt_pk_bf16_f32 v149, v150, v151
    v_cvt_pk_bf16_f32 v150, v156, v157
    v_cvt_pk_bf16_f32 v151, v158, v159
    buffer_store_dwordx4 v[148:151], v1, s[4:7], s21 offen offset:1024
    v_mul_f32 v164, v164, v29
    v_mul_f32 v165, v165, v29
    v_mul_f32 v166, v166, v29
    v_mul_f32 v167, v167, v29
    v_mul_f32 v172, v172, v29
    v_mul_f32 v173, v173, v29
    v_mul_f32 v174, v174, v29
    v_mul_f32 v175, v175, v29
    v_cvt_pk_bf16_f32 v164, v164, v165
    v_cvt_pk_bf16_f32 v165, v166, v167
    v_cvt_pk_bf16_f32 v166, v172, v173
    v_cvt_pk_bf16_f32 v167, v174, v175
    buffer_store_dwordx4 v[164:167], v1, s[4:7], s21 offen offset:2048
    v_mul_f32 v180, v180, v29
    v_mul_f32 v181, v181, v29
    v_mul_f32 v182, v182, v29
    v_mul_f32 v183, v183, v29
    v_mul_f32 v188, v188, v29
    v_mul_f32 v189, v189, v29
    v_mul_f32 v190, v190, v29
    v_mul_f32 v191, v191, v29
    v_cvt_pk_bf16_f32 v180, v180, v181
    v_cvt_pk_bf16_f32 v181, v182, v183
    v_cvt_pk_bf16_f32 v182, v188, v189
    v_cvt_pk_bf16_f32 v183, v190, v191
    buffer_store_dwordx4 v[180:183], v1, s[4:7], s21 offen offset:3072
    s_add_u32 s21, s22, 528384
    v_mul_f32 v196, v196, v29
    v_mul_f32 v197, v197, v29
    v_mul_f32 v198, v198, v29
    v_mul_f32 v199, v199, v29
    v_mul_f32 v204, v204, v29
    v_mul_f32 v205, v205, v29
    v_mul_f32 v206, v206, v29
    v_mul_f32 v207, v207, v29
    v_cvt_pk_bf16_f32 v196, v196, v197
    v_cvt_pk_bf16_f32 v197, v198, v199
    v_cvt_pk_bf16_f32 v198, v204, v205
    v_cvt_pk_bf16_f32 v199, v206, v207
    buffer_store_dwordx4 v[196:199], v1, s[4:7], s21 offen offset:0
    v_mul_f32 v212, v212, v29
    v_mul_f32 v213, v213, v29
    v_mul_f32 v214, v214, v29
    v_mul_f32 v215, v215, v29
    v_mul_f32 v220, v220, v29
    v_mul_f32 v221, v221, v29
    v_mul_f32 v222, v222, v29
    v_mul_f32 v223, v223, v29
    v_cvt_pk_bf16_f32 v212, v212, v213
    v_cvt_pk_bf16_f32 v213, v214, v215
    v_cvt_pk_bf16_f32 v214, v220, v221
    v_cvt_pk_bf16_f32 v215, v222, v223
    buffer_store_dwordx4 v[212:215], v1, s[4:7], s21 offen offset:1024
    v_mul_f32 v228, v228, v29
    v_mul_f32 v229, v229, v29
    v_mul_f32 v230, v230, v29
    v_mul_f32 v231, v231, v29
    v_mul_f32 v236, v236, v29
    v_mul_f32 v237, v237, v29
    v_mul_f32 v238, v238, v29
    v_mul_f32 v239, v239, v29
    v_cvt_pk_bf16_f32 v228, v228, v229
    v_cvt_pk_bf16_f32 v229, v230, v231
    v_cvt_pk_bf16_f32 v230, v236, v237
    v_cvt_pk_bf16_f32 v231, v238, v239
    buffer_store_dwordx4 v[228:231], v1, s[4:7], s21 offen offset:2048
    v_mul_f32 v244, v244, v29
    v_mul_f32 v245, v245, v29
    v_mul_f32 v246, v246, v29
    v_mul_f32 v247, v247, v29
    v_mul_f32 v252, v252, v29
    v_mul_f32 v253, v253, v29
    v_mul_f32 v254, v254, v29
    v_mul_f32 v255, v255, v29
    v_cvt_pk_bf16_f32 v244, v244, v245
    v_cvt_pk_bf16_f32 v245, v246, v247
    v_cvt_pk_bf16_f32 v246, v252, v253
    v_cvt_pk_bf16_f32 v247, v254, v255
    buffer_store_dwordx4 v[244:247], v1, s[4:7], s21 offen offset:3072
    s_branch K2_fin
K2_comb:
    s_lshl_b32 s27, s28, 2
    s_add_u32 s27, s27, s19
    s_lshl_b32 s28, s27, 10
    s_add_u32 s28, s28, 75497472
    s_lshl_b32 s27, s27, 14
    s_add_u32 s27, s27, 67108864
    v_mov_b32 v4, 0
K2_poll:
    buffer_load_dword v3, v4, s[4:7], s29 offen sc1
    s_waitcnt vmcnt(0)
    v_cmp_eq_u32 vcc, 1, v3
    s_cbranch_vccnz K2_polled
    s_sleep 8
    s_branch K2_poll
K2_polled:
    buffer_load_dwordx4 v[8:11], v1, s[4:7], s28 offen sc1
    s_add_u32 s21, s27, 0
    buffer_load_dwordx4 a[0:3], v1, s[4:7], s21 offen offset:0 sc1
    buffer_load_dwordx4 a[4:7], v1, s[4:7], s21 offen offset:1024 sc1
    buffer_load_dwordx4 a[8:11], v1, s[4:7], s21 offen offset:2048 sc1
    buffer_load_dwordx4 a[12:15], v1, s[4:7], s21 offen offset:3072 sc1
    s_add_u32 s21, s27, 4096
    buffer_load_dwordx4 a[16:19], v1, s[4:7], s21 offen offset:0 sc1
    buffer_load_dwordx4 a[20:23], v1, s[4:7], s21 offen offset:1024 sc1
    buffer_load_dwordx4 a[24:27], v1, s[4:7], s21 offen offset:2048 sc1
    buffer_load_dwordx4 a[28:31], v1, s[4:7], s21 offen offset:3072 sc1
    s_add_u32 s21, s27, 8192
    buffer_load_dwordx4 a[32:35], v1, s[4:7], s21 offen offset:0 sc1
    buffer_load_dwordx4 a[36:39], v1, s[4:7], s21 offen offset:1024 sc1
    buffer_load_dwordx4 a[40:43], v1, s[4:7], s21 offen offset:2048 sc1
    buffer_load_dwordx4 a[44:47], v1, s[4:7], s21 offen offset:3072 sc1
    s_add_u32 s21, s27, 12288
    buffer_load_dwordx4 a[48:51], v1, s[4:7], s21 offen offset:0 sc1
    buffer_load_dwordx4 a[52:55], v1, s[4:7], s21 offen offset:1024 sc1
    buffer_load_dwordx4 a[56:59], v1, s[4:7], s21 offen offset:2048 sc1
    buffer_load_dwordx4 a[60:63], v1, s[4:7], s21 offen offset:3072 sc1
    s_waitcnt vmcnt(16)
    v_min_f32 v12, v16, v8
    v_sub_f32 v13, v12, v16
    v_sub_f32 v14, v12, v8
    v_exp_f32 v13, v13
    v_exp_f32 v14, v14
    s_nop 0
    v_mul_f32 v14, v14, v9
    v_fma_f32 v12, v24, v13, v14
    v_rcp_f32 v12, v12
    s_nop 0
    v_mul_f32 v28, v13, v12
    v_mul_f32 v30, v14, v12
    v_min_f32 v12, v20, v10
    v_sub_f32 v13, v12, v20
    v_sub_f32 v14, v12, v10
    v_exp_f32 v13, v13
    v_exp_f32 v14, v14
    s_nop 0
    v_mul_f32 v14, v14, v11
    v_fma_f32 v12, v25, v13, v14
    v_rcp_f32 v12, v12
    s_nop 0
    v_mul_f32 v29, v13, v12
    v_mul_f32 v31, v14, v12
    s_waitcnt vmcnt(0)
    s_add_u32 s21, s22, 0
    v_mul_f32 v128, v128, v28
    v_mul_f32 v129, v129, v28
    v_mul_f32 v130, v130, v28
    v_mul_f32 v131, v131, v28
    v_mul_f32 v136, v136, v28
    v_mul_f32 v137, v137, v28
    v_mul_f32 v138, v138, v28
    v_mul_f32 v139, v139, v28
    v_accvgpr_read_b32 v8, a0
    v_accvgpr_read_b32 v9, a1
    v_accvgpr_read_b32 v10, a2
    v_accvgpr_read_b32 v11, a3
    v_lshlrev_b32 v12, 16, v8
    v_and_b32 v8, 0xffff0000, v8
    v_lshlrev_b32 v13, 16, v9
    v_and_b32 v9, 0xffff0000, v9
    v_lshlrev_b32 v14, 16, v10
    v_and_b32 v10, 0xffff0000, v10
    v_lshlrev_b32 v15, 16, v11
    v_and_b32 v11, 0xffff0000, v11
    v_fmac_f32 v128, v12, v30
    v_fmac_f32 v129, v8, v30
    v_fmac_f32 v130, v13, v30
    v_fmac_f32 v131, v9, v30
    v_fmac_f32 v136, v14, v30
    v_fmac_f32 v137, v10, v30
    v_fmac_f32 v138, v15, v30
    v_fmac_f32 v139, v11, v30
    v_cvt_pk_bf16_f32 v128, v128, v129
    v_cvt_pk_bf16_f32 v129, v130, v131
    v_cvt_pk_bf16_f32 v130, v136, v137
    v_cvt_pk_bf16_f32 v131, v138, v139
    buffer_store_dwordx4 v[128:131], v1, s[4:7], s21 offen offset:0
    v_mul_f32 v144, v144, v28
    v_mul_f32 v145, v145, v28
    v_mul_f32 v146, v146, v28
    v_mul_f32 v147, v147, v28
    v_mul_f32 v152, v152, v28
    v_mul_f32 v153, v153, v28
    v_mul_f32 v154, v154, v28
    v_mul_f32 v155, v155, v28
    v_accvgpr_read_b32 v8, a4
    v_accvgpr_read_b32 v9, a5
    v_accvgpr_read_b32 v10, a6
    v_accvgpr_read_b32 v11, a7
    v_lshlrev_b32 v12, 16, v8
    v_and_b32 v8, 0xffff0000, v8
    v_lshlrev_b32 v13, 16, v9
    v_and_b32 v9, 0xffff0000, v9
    v_lshlrev_b32 v14, 16, v10
    v_and_b32 v10, 0xffff0000, v10
    v_lshlrev_b32 v15, 16, v11
    v_and_b32 v11, 0xffff0000, v11
    v_fmac_f32 v144, v12, v30
    v_fmac_f32 v145, v8, v30
    v_fmac_f32 v146, v13, v30
    v_fmac_f32 v147, v9, v30
    v_fmac_f32 v152, v14, v30
    v_fmac_f32 v153, v10, v30
    v_fmac_f32 v154, v15, v30
    v_fmac_f32 v155, v11, v30
    v_cvt_pk_bf16_f32 v144, v144, v145
    v_cvt_pk_bf16_f32 v145, v146, v147
    v_cvt_pk_bf16_f32 v146, v152, v153
    v_cvt_pk_bf16_f32 v147, v154, v155
    buffer_store_dwordx4 v[144:147], v1, s[4:7], s21 offen offset:1024
    v_mul_f32 v160, v160, v28
    v_mul_f32 v161, v161, v28
    v_mul_f32 v162, v162, v28
    v_mul_f32 v163, v163, v28
    v_mul_f32 v168, v168, v28
    v_mul_f32 v169, v169, v28
    v_mul_f32 v170, v170, v28
    v_mul_f32 v171, v171, v28
    v_accvgpr_read_b32 v8, a8
    v_accvgpr_read_b32 v9, a9
    v_accvgpr_read_b32 v10, a10
    v_accvgpr_read_b32 v11, a11
    v_lshlrev_b32 v12, 16, v8
    v_and_b32 v8, 0xffff0000, v8
    v_lshlrev_b32 v13, 16, v9
    v_and_b32 v9, 0xffff0000, v9
    v_lshlrev_b32 v14, 16, v10
    v_and_b32 v10, 0xffff0000, v10
    v_lshlrev_b32 v15, 16, v11
    v_and_b32 v11, 0xffff0000, v11
    v_fmac_f32 v160, v12, v30
    v_fmac_f32 v161, v8, v30
    v_fmac_f32 v162, v13, v30
    v_fmac_f32 v163, v9, v30
    v_fmac_f32 v168, v14, v30
    v_fmac_f32 v169, v10, v30
    v_fmac_f32 v170, v15, v30
    v_fmac_f32 v171, v11, v30
    v_cvt_pk_bf16_f32 v160, v160, v161
    v_cvt_pk_bf16_f32 v161, v162, v163
    v_cvt_pk_bf16_f32 v162, v168, v169
    v_cvt_pk_bf16_f32 v163, v170, v171
    buffer_store_dwordx4 v[160:163], v1, s[4:7], s21 offen offset:2048
    v_mul_f32 v176, v176, v28
    v_mul_f32 v177, v177, v28
    v_mul_f32 v178, v178, v28
    v_mul_f32 v179, v179, v28
    v_mul_f32 v184, v184, v28
    v_mul_f32 v185, v185, v28
    v_mul_f32 v186, v186, v28
    v_mul_f32 v187, v187, v28
    v_accvgpr_read_b32 v8, a12
    v_accvgpr_read_b32 v9, a13
    v_accvgpr_read_b32 v10, a14
    v_accvgpr_read_b32 v11, a15
    v_lshlrev_b32 v12, 16, v8
    v_and_b32 v8, 0xffff0000, v8
    v_lshlrev_b32 v13, 16, v9
    v_and_b32 v9, 0xffff0000, v9
    v_lshlrev_b32 v14, 16, v10
    v_and_b32 v10, 0xffff0000, v10
    v_lshlrev_b32 v15, 16, v11
    v_and_b32 v11, 0xffff0000, v11
    v_fmac_f32 v176, v12, v30
    v_fmac_f32 v177, v8, v30
    v_fmac_f32 v178, v13, v30
    v_fmac_f32 v179, v9, v30
    v_fmac_f32 v184, v14, v30
    v_fmac_f32 v185, v10, v30
    v_fmac_f32 v186, v15, v30
    v_fmac_f32 v187, v11, v30
    v_cvt_pk_bf16_f32 v176, v176, v177
    v_cvt_pk_bf16_f32 v177, v178, v179
    v_cvt_pk_bf16_f32 v178, v184, v185
    v_cvt_pk_bf16_f32 v179, v186, v187
    buffer_store_dwordx4 v[176:179], v1, s[4:7], s21 offen offset:3072
    s_add_u32 s21, s22, 4096
    v_mul_f32 v192, v192, v28
    v_mul_f32 v193, v193, v28
    v_mul_f32 v194, v194, v28
    v_mul_f32 v195, v195, v28
    v_mul_f32 v200, v200, v28
    v_mul_f32 v201, v201, v28
    v_mul_f32 v202, v202, v28
    v_mul_f32 v203, v203, v28
    v_accvgpr_read_b32 v8, a16
    v_accvgpr_read_b32 v9, a17
    v_accvgpr_read_b32 v10, a18
    v_accvgpr_read_b32 v11, a19
    v_lshlrev_b32 v12, 16, v8
    v_and_b32 v8, 0xffff0000, v8
    v_lshlrev_b32 v13, 16, v9
    v_and_b32 v9, 0xffff0000, v9
    v_lshlrev_b32 v14, 16, v10
    v_and_b32 v10, 0xffff0000, v10
    v_lshlrev_b32 v15, 16, v11
    v_and_b32 v11, 0xffff0000, v11
    v_fmac_f32 v192, v12, v30
    v_fmac_f32 v193, v8, v30
    v_fmac_f32 v194, v13, v30
    v_fmac_f32 v195, v9, v30
    v_fmac_f32 v200, v14, v30
    v_fmac_f32 v201, v10, v30
    v_fmac_f32 v202, v15, v30
    v_fmac_f32 v203, v11, v30
    v_cvt_pk_bf16_f32 v192, v192, v193
    v_cvt_pk_bf16_f32 v193, v194, v195
    v_cvt_pk_bf16_f32 v194, v200, v201
    v_cvt_pk_bf16_f32 v195, v202, v203
    buffer_store_dwordx4 v[192:195], v1, s[4:7], s21 offen offset:0
    v_mul_f32 v208, v208, v28
    v_mul_f32 v209, v209, v28
    v_mul_f32 v210, v210, v28
    v_mul_f32 v211, v211, v28
    v_mul_f32 v216, v216, v28
    v_mul_f32 v217, v217, v28
    v_mul_f32 v218, v218, v28
    v_mul_f32 v219, v219, v28
    v_accvgpr_read_b32 v8, a20
    v_accvgpr_read_b32 v9, a21
    v_accvgpr_read_b32 v10, a22
    v_accvgpr_read_b32 v11, a23
    v_lshlrev_b32 v12, 16, v8
    v_and_b32 v8, 0xffff0000, v8
    v_lshlrev_b32 v13, 16, v9
    v_and_b32 v9, 0xffff0000, v9
    v_lshlrev_b32 v14, 16, v10
    v_and_b32 v10, 0xffff0000, v10
    v_lshlrev_b32 v15, 16, v11
    v_and_b32 v11, 0xffff0000, v11
    v_fmac_f32 v208, v12, v30
    v_fmac_f32 v209, v8, v30
    v_fmac_f32 v210, v13, v30
    v_fmac_f32 v211, v9, v30
    v_fmac_f32 v216, v14, v30
    v_fmac_f32 v217, v10, v30
    v_fmac_f32 v218, v15, v30
    v_fmac_f32 v219, v11, v30
    v_cvt_pk_bf16_f32 v208, v208, v209
    v_cvt_pk_bf16_f32 v209, v210, v211
    v_cvt_pk_bf16_f32 v210, v216, v217
    v_cvt_pk_bf16_f32 v211, v218, v219
    buffer_store_dwordx4 v[208:211], v1, s[4:7], s21 offen offset:1024
    v_mul_f32 v224, v224, v28
    v_mul_f32 v225, v225, v28
    v_mul_f32 v226, v226, v28
    v_mul_f32 v227, v227, v28
    v_mul_f32 v232, v232, v28
    v_mul_f32 v233, v233, v28
    v_mul_f32 v234, v234, v28
    v_mul_f32 v235, v235, v28
    v_accvgpr_read_b32 v8, a24
    v_accvgpr_read_b32 v9, a25
    v_accvgpr_read_b32 v10, a26
    v_accvgpr_read_b32 v11, a27
    v_lshlrev_b32 v12, 16, v8
    v_and_b32 v8, 0xffff0000, v8
    v_lshlrev_b32 v13, 16, v9
    v_and_b32 v9, 0xffff0000, v9
    v_lshlrev_b32 v14, 16, v10
    v_and_b32 v10, 0xffff0000, v10
    v_lshlrev_b32 v15, 16, v11
    v_and_b32 v11, 0xffff0000, v11
    v_fmac_f32 v224, v12, v30
    v_fmac_f32 v225, v8, v30
    v_fmac_f32 v226, v13, v30
    v_fmac_f32 v227, v9, v30
    v_fmac_f32 v232, v14, v30
    v_fmac_f32 v233, v10, v30
    v_fmac_f32 v234, v15, v30
    v_fmac_f32 v235, v11, v30
    v_cvt_pk_bf16_f32 v224, v224, v225
    v_cvt_pk_bf16_f32 v225, v226, v227
    v_cvt_pk_bf16_f32 v226, v232, v233
    v_cvt_pk_bf16_f32 v227, v234, v235
    buffer_store_dwordx4 v[224:227], v1, s[4:7], s21 offen offset:2048
    v_mul_f32 v240, v240, v28
    v_mul_f32 v241, v241, v28
    v_mul_f32 v242, v242, v28
    v_mul_f32 v243, v243, v28
    v_mul_f32 v248, v248, v28
    v_mul_f32 v249, v249, v28
    v_mul_f32 v250, v250, v28
    v_mul_f32 v251, v251, v28
    v_accvgpr_read_b32 v8, a28
    v_accvgpr_read_b32 v9, a29
    v_accvgpr_read_b32 v10, a30
    v_accvgpr_read_b32 v11, a31
    v_lshlrev_b32 v12, 16, v8
    v_and_b32 v8, 0xffff0000, v8
    v_lshlrev_b32 v13, 16, v9
    v_and_b32 v9, 0xffff0000, v9
    v_lshlrev_b32 v14, 16, v10
    v_and_b32 v10, 0xffff0000, v10
    v_lshlrev_b32 v15, 16, v11
    v_and_b32 v11, 0xffff0000, v11
    v_fmac_f32 v240, v12, v30
    v_fmac_f32 v241, v8, v30
    v_fmac_f32 v242, v13, v30
    v_fmac_f32 v243, v9, v30
    v_fmac_f32 v248, v14, v30
    v_fmac_f32 v249, v10, v30
    v_fmac_f32 v250, v15, v30
    v_fmac_f32 v251, v11, v30
    v_cvt_pk_bf16_f32 v240, v240, v241
    v_cvt_pk_bf16_f32 v241, v242, v243
    v_cvt_pk_bf16_f32 v242, v248, v249
    v_cvt_pk_bf16_f32 v243, v250, v251
    buffer_store_dwordx4 v[240:243], v1, s[4:7], s21 offen offset:3072
    s_add_u32 s21, s22, 524288
    v_mul_f32 v132, v132, v29
    v_mul_f32 v133, v133, v29
    v_mul_f32 v134, v134, v29
    v_mul_f32 v135, v135, v29
    v_mul_f32 v140, v140, v29
    v_mul_f32 v141, v141, v29
    v_mul_f32 v142, v142, v29
    v_mul_f32 v143, v143, v29
    v_accvgpr_read_b32 v8, a32
    v_accvgpr_read_b32 v9, a33
    v_accvgpr_read_b32 v10, a34
    v_accvgpr_read_b32 v11, a35
    v_lshlrev_b32 v12, 16, v8
    v_and_b32 v8, 0xffff0000, v8
    v_lshlrev_b32 v13, 16, v9
    v_and_b32 v9, 0xffff0000, v9
    v_lshlrev_b32 v14, 16, v10
    v_and_b32 v10, 0xffff0000, v10
    v_lshlrev_b32 v15, 16, v11
    v_and_b32 v11, 0xffff0000, v11
    v_fmac_f32 v132, v12, v31
    v_fmac_f32 v133, v8, v31
    v_fmac_f32 v134, v13, v31
    v_fmac_f32 v135, v9, v31
    v_fmac_f32 v140, v14, v31
    v_fmac_f32 v141, v10, v31
    v_fmac_f32 v142, v15, v31
    v_fmac_f32 v143, v11, v31
    v_cvt_pk_bf16_f32 v132, v132, v133
    v_cvt_pk_bf16_f32 v133, v134, v135
    v_cvt_pk_bf16_f32 v134, v140, v141
    v_cvt_pk_bf16_f32 v135, v142, v143
    buffer_store_dwordx4 v[132:135], v1, s[4:7], s21 offen offset:0
    v_mul_f32 v148, v148, v29
    v_mul_f32 v149, v149, v29
    v_mul_f32 v150, v150, v29
    v_mul_f32 v151, v151, v29
    v_mul_f32 v156, v156, v29
    v_mul_f32 v157, v157, v29
    v_mul_f32 v158, v158, v29
    v_mul_f32 v159, v159, v29
    v_accvgpr_read_b32 v8, a36
    v_accvgpr_read_b32 v9, a37
    v_accvgpr_read_b32 v10, a38
    v_accvgpr_read_b32 v11, a39
    v_lshlrev_b32 v12, 16, v8
    v_and_b32 v8, 0xffff0000, v8
    v_lshlrev_b32 v13, 16, v9
    v_and_b32 v9, 0xffff0000, v9
    v_lshlrev_b32 v14, 16, v10
    v_and_b32 v10, 0xffff0000, v10
    v_lshlrev_b32 v15, 16, v11
    v_and_b32 v11, 0xffff0000, v11
    v_fmac_f32 v148, v12, v31
    v_fmac_f32 v149, v8, v31
    v_fmac_f32 v150, v13, v31
    v_fmac_f32 v151, v9, v31
    v_fmac_f32 v156, v14, v31
    v_fmac_f32 v157, v10, v31
    v_fmac_f32 v158, v15, v31
    v_fmac_f32 v159, v11, v31
    v_cvt_pk_bf16_f32 v148, v148, v149
    v_cvt_pk_bf16_f32 v149, v150, v151
    v_cvt_pk_bf16_f32 v150, v156, v157
    v_cvt_pk_bf16_f32 v151, v158, v159
    buffer_store_dwordx4 v[148:151], v1, s[4:7], s21 offen offset:1024
    v_mul_f32 v164, v164, v29
    v_mul_f32 v165, v165, v29
    v_mul_f32 v166, v166, v29
    v_mul_f32 v167, v167, v29
    v_mul_f32 v172, v172, v29
    v_mul_f32 v173, v173, v29
    v_mul_f32 v174, v174, v29
    v_mul_f32 v175, v175, v29
    v_accvgpr_read_b32 v8, a40
    v_accvgpr_read_b32 v9, a41
    v_accvgpr_read_b32 v10, a42
    v_accvgpr_read_b32 v11, a43
    v_lshlrev_b32 v12, 16, v8
    v_and_b32 v8, 0xffff0000, v8
    v_lshlrev_b32 v13, 16, v9
    v_and_b32 v9, 0xffff0000, v9
    v_lshlrev_b32 v14, 16, v10
    v_and_b32 v10, 0xffff0000, v10
    v_lshlrev_b32 v15, 16, v11
    v_and_b32 v11, 0xffff0000, v11
    v_fmac_f32 v164, v12, v31
    v_fmac_f32 v165, v8, v31
    v_fmac_f32 v166, v13, v31
    v_fmac_f32 v167, v9, v31
    v_fmac_f32 v172, v14, v31
    v_fmac_f32 v173, v10, v31
    v_fmac_f32 v174, v15, v31
    v_fmac_f32 v175, v11, v31
    v_cvt_pk_bf16_f32 v164, v164, v165
    v_cvt_pk_bf16_f32 v165, v166, v167
    v_cvt_pk_bf16_f32 v166, v172, v173
    v_cvt_pk_bf16_f32 v167, v174, v175
    buffer_store_dwordx4 v[164:167], v1, s[4:7], s21 offen offset:2048
    v_mul_f32 v180, v180, v29
    v_mul_f32 v181, v181, v29
    v_mul_f32 v182, v182, v29
    v_mul_f32 v183, v183, v29
    v_mul_f32 v188, v188, v29
    v_mul_f32 v189, v189, v29
    v_mul_f32 v190, v190, v29
    v_mul_f32 v191, v191, v29
    v_accvgpr_read_b32 v8, a44
    v_accvgpr_read_b32 v9, a45
    v_accvgpr_read_b32 v10, a46
    v_accvgpr_read_b32 v11, a47
    v_lshlrev_b32 v12, 16, v8
    v_and_b32 v8, 0xffff0000, v8
    v_lshlrev_b32 v13, 16, v9
    v_and_b32 v9, 0xffff0000, v9
    v_lshlrev_b32 v14, 16, v10
    v_and_b32 v10, 0xffff0000, v10
    v_lshlrev_b32 v15, 16, v11
    v_and_b32 v11, 0xffff0000, v11
    v_fmac_f32 v180, v12, v31
    v_fmac_f32 v181, v8, v31
    v_fmac_f32 v182, v13, v31
    v_fmac_f32 v183, v9, v31
    v_fmac_f32 v188, v14, v31
    v_fmac_f32 v189, v10, v31
    v_fmac_f32 v190, v15, v31
    v_fmac_f32 v191, v11, v31
    v_cvt_pk_bf16_f32 v180, v180, v181
    v_cvt_pk_bf16_f32 v181, v182, v183
    v_cvt_pk_bf16_f32 v182, v188, v189
    v_cvt_pk_bf16_f32 v183, v190, v191
    buffer_store_dwordx4 v[180:183], v1, s[4:7], s21 offen offset:3072
    s_add_u32 s21, s22, 528384
    v_mul_f32 v196, v196, v29
    v_mul_f32 v197, v197, v29
    v_mul_f32 v198, v198, v29
    v_mul_f32 v199, v199, v29
    v_mul_f32 v204, v204, v29
    v_mul_f32 v205, v205, v29
    v_mul_f32 v206, v206, v29
    v_mul_f32 v207, v207, v29
    v_accvgpr_read_b32 v8, a48
    v_accvgpr_read_b32 v9, a49
    v_accvgpr_read_b32 v10, a50
    v_accvgpr_read_b32 v11, a51
    v_lshlrev_b32 v12, 16, v8
    v_and_b32 v8, 0xffff0000, v8
    v_lshlrev_b32 v13, 16, v9
    v_and_b32 v9, 0xffff0000, v9
    v_lshlrev_b32 v14, 16, v10
    v_and_b32 v10, 0xffff0000, v10
    v_lshlrev_b32 v15, 16, v11
    v_and_b32 v11, 0xffff0000, v11
    v_fmac_f32 v196, v12, v31
    v_fmac_f32 v197, v8, v31
    v_fmac_f32 v198, v13, v31
    v_fmac_f32 v199, v9, v31
    v_fmac_f32 v204, v14, v31
    v_fmac_f32 v205, v10, v31
    v_fmac_f32 v206, v15, v31
    v_fmac_f32 v207, v11, v31
    v_cvt_pk_bf16_f32 v196, v196, v197
    v_cvt_pk_bf16_f32 v197, v198, v199
    v_cvt_pk_bf16_f32 v198, v204, v205
    v_cvt_pk_bf16_f32 v199, v206, v207
    buffer_store_dwordx4 v[196:199], v1, s[4:7], s21 offen offset:0
    v_mul_f32 v212, v212, v29
    v_mul_f32 v213, v213, v29
    v_mul_f32 v214, v214, v29
    v_mul_f32 v215, v215, v29
    v_mul_f32 v220, v220, v29
    v_mul_f32 v221, v221, v29
    v_mul_f32 v222, v222, v29
    v_mul_f32 v223, v223, v29
    v_accvgpr_read_b32 v8, a52
    v_accvgpr_read_b32 v9, a53
    v_accvgpr_read_b32 v10, a54
    v_accvgpr_read_b32 v11, a55
    v_lshlrev_b32 v12, 16, v8
    v_and_b32 v8, 0xffff0000, v8
    v_lshlrev_b32 v13, 16, v9
    v_and_b32 v9, 0xffff0000, v9
    v_lshlrev_b32 v14, 16, v10
    v_and_b32 v10, 0xffff0000, v10
    v_lshlrev_b32 v15, 16, v11
    v_and_b32 v11, 0xffff0000, v11
    v_fmac_f32 v212, v12, v31
    v_fmac_f32 v213, v8, v31
    v_fmac_f32 v214, v13, v31
    v_fmac_f32 v215, v9, v31
    v_fmac_f32 v220, v14, v31
    v_fmac_f32 v221, v10, v31
    v_fmac_f32 v222, v15, v31
    v_fmac_f32 v223, v11, v31
    v_cvt_pk_bf16_f32 v212, v212, v213
    v_cvt_pk_bf16_f32 v213, v214, v215
    v_cvt_pk_bf16_f32 v214, v220, v221
    v_cvt_pk_bf16_f32 v215, v222, v223
    buffer_store_dwordx4 v[212:215], v1, s[4:7], s21 offen offset:1024
    v_mul_f32 v228, v228, v29
    v_mul_f32 v229, v229, v29
    v_mul_f32 v230, v230, v29
    v_mul_f32 v231, v231, v29
    v_mul_f32 v236, v236, v29
    v_mul_f32 v237, v237, v29
    v_mul_f32 v238, v238, v29
    v_mul_f32 v239, v239, v29
    v_accvgpr_read_b32 v8, a56
    v_accvgpr_read_b32 v9, a57
    v_accvgpr_read_b32 v10, a58
    v_accvgpr_read_b32 v11, a59
    v_lshlrev_b32 v12, 16, v8
    v_and_b32 v8, 0xffff0000, v8
    v_lshlrev_b32 v13, 16, v9
    v_and_b32 v9, 0xffff0000, v9
    v_lshlrev_b32 v14, 16, v10
    v_and_b32 v10, 0xffff0000, v10
    v_lshlrev_b32 v15, 16, v11
    v_and_b32 v11, 0xffff0000, v11
    v_fmac_f32 v228, v12, v31
    v_fmac_f32 v229, v8, v31
    v_fmac_f32 v230, v13, v31
    v_fmac_f32 v231, v9, v31
    v_fmac_f32 v236, v14, v31
    v_fmac_f32 v237, v10, v31
    v_fmac_f32 v238, v15, v31
    v_fmac_f32 v239, v11, v31
    v_cvt_pk_bf16_f32 v228, v228, v229
    v_cvt_pk_bf16_f32 v229, v230, v231
    v_cvt_pk_bf16_f32 v230, v236, v237
    v_cvt_pk_bf16_f32 v231, v238, v239
    buffer_store_dwordx4 v[228:231], v1, s[4:7], s21 offen offset:2048
    v_mul_f32 v244, v244, v29
    v_mul_f32 v245, v245, v29
    v_mul_f32 v246, v246, v29
    v_mul_f32 v247, v247, v29
    v_mul_f32 v252, v252, v29
    v_mul_f32 v253, v253, v29
    v_mul_f32 v254, v254, v29
    v_mul_f32 v255, v255, v29
    v_accvgpr_read_b32 v8, a60
    v_accvgpr_read_b32 v9, a61
    v_accvgpr_read_b32 v10, a62
    v_accvgpr_read_b32 v11, a63
    v_lshlrev_b32 v12, 16, v8
    v_and_b32 v8, 0xffff0000, v8
    v_lshlrev_b32 v13, 16, v9
    v_and_b32 v9, 0xffff0000, v9
    v_lshlrev_b32 v14, 16, v10
    v_and_b32 v10, 0xffff0000, v10
    v_lshlrev_b32 v15, 16, v11
    v_and_b32 v11, 0xffff0000, v11
    v_fmac_f32 v244, v12, v31
    v_fmac_f32 v245, v8, v31
    v_fmac_f32 v246, v13, v31
    v_fmac_f32 v247, v9, v31
    v_fmac_f32 v252, v14, v31
    v_fmac_f32 v253, v10, v31
    v_fmac_f32 v254, v15, v31
    v_fmac_f32 v255, v11, v31
    v_cvt_pk_bf16_f32 v244, v244, v245
    v_cvt_pk_bf16_f32 v245, v246, v247
    v_cvt_pk_bf16_f32 v246, v252, v253
    v_cvt_pk_bf16_f32 v247, v254, v255
    buffer_store_dwordx4 v[244:247], v1, s[4:7], s21 offen offset:3072
K2_fin:
K2_end:
    s_endpgm
K2_ntail:
    v_mfma_f32_16x16x32_bf16 v[128:131], a[64:67], v[96:99], v[128:131]
    s_add_u32 m0, s16, 98304
    ds_read_b128 a[96:99], v2 offset:8192
    v_add_f32 v24, v24, v26
    v_mfma_f32_16x16x32_bf16 v[128:131], a[68:71], v[100:103], v[128:131]
    buffer_load_dwordx4 v1, s[4:7], s12 offen offset:0 lds
    v_mfma_f32_16x16x32_bf16 v[132:135], a[68:71], v[108:111], v[132:135]
    ds_read_b128 a[100:103], v2 offset:9216
    v_add_f32 v25, v25, v27
    v_mfma_f32_16x16x32_bf16 v[132:135], a[64:67], v[104:107], v[132:135]
    s_waitcnt lgkmcnt(7)
    buffer_load_dwordx4 v1, s[4:7], s12 offen offset:1024 lds
    v_exp_f32 v8, v64
    v_mfma_f32_16x16x32_bf16 v[136:139], a[72:75], v[96:99], v[136:139]
    s_waitcnt lgkmcnt(6)
    ds_read_b128 a[104:107], v2 offset:10240
    v_exp_f32 v9, v65
    v_mfma_f32_16x16x32_bf16 v[136:139], a[76:79], v[100:103], v[136:139]
    buffer_load_dwordx4 v1, s[4:7], s12 offen offset:2048 lds
    v_add_f32 v26, v8, v9
    v_cvt_pk_bf16_f32 v112, v8, v9
    v_mfma_f32_16x16x32_bf16 v[140:143], a[76:79], v[108:111], v[140:143]
    ds_read_b128 a[108:111], v2 offset:11264
    v_exp_f32 v10, v66
    v_mfma_f32_16x16x32_bf16 v[140:143], a[72:75], v[104:107], v[140:143]
    s_waitcnt lgkmcnt(6)
    buffer_load_dwordx4 v1, s[4:7], s12 offen offset:3072 lds
    v_mfma_f32_16x16x32_bf16 v[144:147], a[80:83], v[96:99], v[144:147]
    s_add_u32 s12, s12, 4096
    s_add_u32 m0, s16, 102400
    ds_read_b128 a[112:115], v2 offset:12288
    v_exp_f32 v11, v67
    v_mfma_f32_16x16x32_bf16 v[144:147], a[84:87], v[100:103], v[144:147]
    buffer_load_dwordx4 v1, s[4:7], s12 offen offset:0 lds
    v_exp_f32 v12, v68
    v_mfma_f32_16x16x32_bf16 v[148:151], a[84:87], v[108:111], v[148:151]
    ds_read_b128 a[116:119], v2 offset:13312
    v_add_f32 v26, v26, v10
    v_mfma_f32_16x16x32_bf16 v[148:151], a[80:83], v[104:107], v[148:151]
    s_waitcnt lgkmcnt(7)
    buffer_load_dwordx4 v1, s[4:7], s12 offen offset:1024 lds
    v_exp_f32 v13, v69
    v_mfma_f32_16x16x32_bf16 v[152:155], a[88:91], v[96:99], v[152:155]
    s_waitcnt lgkmcnt(6)
    ds_read_b128 a[120:123], v2 offset:14336
    v_add_f32 v26, v26, v11
    v_cvt_pk_bf16_f32 v113, v10, v11
    v_mfma_f32_16x16x32_bf16 v[152:155], a[92:95], v[100:103], v[152:155]
    buffer_load_dwordx4 v1, s[4:7], s12 offen offset:2048 lds
    v_exp_f32 v14, v70
    v_mfma_f32_16x16x32_bf16 v[156:159], a[92:95], v[108:111], v[156:159]
    ds_read_b128 a[124:127], v2 offset:15360
    v_add_f32 v27, v12, v13
    v_cvt_pk_bf16_f32 v120, v12, v13
    v_mfma_f32_16x16x32_bf16 v[156:159], a[88:91], v[104:107], v[156:159]
    s_waitcnt lgkmcnt(4)
    buffer_load_dwordx4 v1, s[4:7], s12 offen offset:3072 lds
    v_exp_f32 v15, v71
    v_mfma_f32_16x16x32_bf16 v[160:163], a[96:99], v[96:99], v[160:163]
    s_add_u32 s12, s12, 28672
    ds_read_b128 a[64:67], v2 offset:16384
    v_exp_f32 v8, v72
    v_mfma_f32_16x16x32_bf16 v[160:163], a[100:103], v[100:103], v[160:163]
    s_sub_u32 s13, s13, 1
    v_add_f32 v27, v27, v14
    v_add_f32 v27, v27, v15
    v_mfma_f32_16x16x32_bf16 v[164:167], a[100:103], v[108:111], v[164:167]
    s_cmp_eq_u32 s13, 0
    ds_read_b128 a[68:71], v2 offset:17408
    v_exp_f32 v9, v73
    v_mfma_f32_16x16x32_bf16 v[164:167], a[96:99], v[104:107], v[164:167]
    s_cselect_b32 s12, s14, s12
    v_cvt_pk_bf16_f32 v121, v14, v15
    v_add_f32 v26, v26, v8
    v_mfma_f32_16x16x32_bf16 v[168:171], a[104:107], v[96:99], v[168:171]
    s_cselect_b32 s13, s15, s13
    ds_read_b128 a[72:75], v2 offset:18432
    v_exp_f32 v10, v74
    v_mfma_f32_16x16x32_bf16 v[168:171], a[108:111], v[100:103], v[168:171]
    s_cselect_b32 s14, 3221225472, s14
    v_exp_f32 v11, v75
    v_mfma_f32_16x16x32_bf16 v[172:175], a[108:111], v[108:111], v[172:175]
    ds_read_b128 a[76:79], v2 offset:19456
    v_add_f32 v26, v26, v9
    v_cvt_pk_bf16_f32 v114, v8, v9
    v_mfma_f32_16x16x32_bf16 v[172:175], a[104:107], v[104:107], v[172:175]
    s_waitcnt lgkmcnt(7)
    v_exp_f32 v12, v76
    v_mfma_f32_16x16x32_bf16 v[176:179], a[112:115], v[96:99], v[176:179]
    s_waitcnt lgkmcnt(6)
    ds_read_b128 a[80:83], v2 offset:20480
    v_add_f32 v26, v26, v10
    v_mfma_f32_16x16x32_bf16 v[176:179], a[116:119], v[100:103], v[176:179]
    v_exp_f32 v13, v77
    v_mfma_f32_16x16x32_bf16 v[180:183], a[116:119], v[108:111], v[180:183]
    ds_read_b128 a[84:87], v2 offset:21504
    v_add_f32 v26, v26, v11
    v_cvt_pk_bf16_f32 v115, v10, v11
    v_add_f32 v27, v27, v12
    v_mfma_f32_16x16x32_bf16 v[180:183], a[112:115], v[104:107], v[180:183]
    s_waitcnt lgkmcnt(7)
    v_exp_f32 v14, v78
    v_mfma_f32_16x16x32_bf16 v[184:187], a[120:123], v[96:99], v[184:187]
    s_waitcnt lgkmcnt(6)
    ds_read_b128 a[88:91], v2 offset:22528
    v_exp_f32 v15, v79
    v_mfma_f32_16x16x32_bf16 v[184:187], a[124:127], v[100:103], v[184:187]
    v_add_f32 v27, v27, v13
    v_cvt_pk_bf16_f32 v122, v12, v13
    v_mfma_f32_16x16x32_bf16 v[188:191], a[124:127], v[108:111], v[188:191]
    ds_read_b128 a[92:95], v2 offset:23552
    v_exp_f32 v8, v80
    v_mfma_f32_16x16x32_bf16 v[188:191], a[120:123], v[104:107], v[188:191]
    s_waitcnt lgkmcnt(7)
    v_add_f32 v27, v27, v14
    v_add_f32 v27, v27, v15
    v_cvt_pk_bf16_f32 v123, v14, v15
    v_mfma_f32_16x16x32_bf16 v[192:195], a[64:67], v[96:99], v[192:195]
    s_waitcnt lgkmcnt(6)
    ds_read_b128 a[96:99], v2 offset:24576
    v_exp_f32 v9, v81
    v_mfma_f32_16x16x32_bf16 v[192:195], a[68:71], v[100:103], v[192:195]
    v_exp_f32 v10, v82
    v_mfma_f32_16x16x32_bf16 v[196:199], a[68:71], v[108:111], v[196:199]
    ds_read_b128 a[100:103], v2 offset:25600
    v_add_f32 v26, v26, v8
    v_mfma_f32_16x16x32_bf16 v[196:199], a[64:67], v[104:107], v[196:199]
    s_waitcnt lgkmcnt(7)
    v_exp_f32 v11, v83
    v_mfma_f32_16x16x32_bf16 v[200:203], a[72:75], v[96:99], v[200:203]
    s_waitcnt lgkmcnt(6)
    ds_read_b128 a[104:107], v2 offset:26624
    v_add_f32 v26, v26, v9
    v_cvt_pk_bf16_f32 v116, v8, v9
    v_mfma_f32_16x16x32_bf16 v[200:203], a[76:79], v[100:103], v[200:203]
    v_exp_f32 v12, v84
    v_mfma_f32_16x16x32_bf16 v[204:207], a[76:79], v[108:111], v[204:207]
    ds_read_b128 a[108:111], v2 offset:27648
    v_add_f32 v26, v26, v10
    v_add_f32 v26, v26, v11
    v_cvt_pk_bf16_f32 v117, v10, v11
    v_mfma_f32_16x16x32_bf16 v[204:207], a[72:75], v[104:107], v[204:207]
    s_waitcnt lgkmcnt(7)
    v_exp_f32 v13, v85
    v_mfma_f32_16x16x32_bf16 v[208:211], a[80:83], v[96:99], v[208:211]
    s_waitcnt lgkmcnt(6)
    ds_read_b128 a[112:115], v2 offset:28672
    v_exp_f32 v14, v86
    v_mfma_f32_16x16x32_bf16 v[208:211], a[84:87], v[100:103], v[208:211]
    v_add_f32 v27, v27, v12
    v_add_f32 v27, v27, v13
    v_mfma_f32_16x16x32_bf16 v[212:215], a[84:87], v[108:111], v[212:215]
    ds_read_b128 a[116:119], v2 offset:29696
    v_exp_f32 v15, v87
    v_mfma_f32_16x16x32_bf16 v[212:215], a[80:83], v[104:107], v[212:215]
    s_waitcnt lgkmcnt(7)
    v_cvt_pk_bf16_f32 v124, v12, v13
    v_add_f32 v27, v27, v14
    v_mfma_f32_16x16x32_bf16 v[216:219], a[88:91], v[96:99], v[216:219]
    s_waitcnt lgkmcnt(6)
    ds_read_b128 a[120:123], v2 offset:30720
    v_exp_f32 v8, v88
    v_mfma_f32_16x16x32_bf16 v[216:219], a[92:95], v[100:103], v[216:219]
    v_exp_f32 v9, v89
    v_mfma_f32_16x16x32_bf16 v[220:223], a[92:95], v[108:111], v[220:223]
    ds_read_b128 a[124:127], v2 offset:31744
    v_add_f32 v27, v27, v15
    v_cvt_pk_bf16_f32 v125, v14, v15
    v_mfma_f32_16x16x32_bf16 v[220:223], a[88:91], v[104:107], v[220:223]
    s_waitcnt vmcnt(0) lgkmcnt(7)
    s_barrier
    v_exp_f32 v10, v90
    v_mfma_f32_16x16x32_bf16 v[224:227], a[96:99], v[96:99], v[224:227]
    s_waitcnt lgkmcnt(6)
    ds_read_b128 a[64:67], v2 offset:32768
    v_add_f32 v26, v26, v8
    v_mfma_f32_16x16x32_bf16 v[224:227], a[100:103], v[100:103], v[224:227]
    v_exp_f32 v11, v91
    v_mfma_f32_16x16x32_bf16 v[228:231], a[100:103], v[108:111], v[228:231]
    ds_read_b128 a[68:71], v2 offset:33792
    v_add_f32 v26, v26, v9
    v_cvt_pk_bf16_f32 v118, v8, v9
    v_add_f32 v26, v26, v10
    v_mfma_f32_16x16x32_bf16 v[228:231], a[96:99], v[104:107], v[228:231]
    s_waitcnt lgkmcnt(7)
    v_exp_f32 v12, v92
    v_mfma_f32_16x16x32_bf16 v[232:235], a[104:107], v[96:99], v[232:235]
    s_waitcnt lgkmcnt(6)
    ds_read_b128 a[72:75], v2 offset:34816
    v_exp_f32 v13, v93
    v_mfma_f32_16x16x32_bf16 v[232:235], a[108:111], v[100:103], v[232:235]
    v_add_f32 v26, v26, v11
    v_cvt_pk_bf16_f32 v119, v10, v11
    v_mfma_f32_16x16x32_bf16 v[236:239], a[108:111], v[108:111], v[236:239]
    ds_read_b128 a[76:79], v2 offset:35840
    v_exp_f32 v14, v94
    v_mfma_f32_16x16x32_bf16 v[236:239], a[104:107], v[104:107], v[236:239]
    s_waitcnt lgkmcnt(7)
    v_add_f32 v27, v27, v12
    v_add_f32 v27, v27, v13
    v_mfma_f32_16x16x32_bf16 v[240:243], a[112:115], v[96:99], v[240:243]
    s_waitcnt lgkmcnt(6)
    ds_read_b128 a[80:83], v2 offset:36864
    v_exp_f32 v15, v95
    v_mfma_f32_16x16x32_bf16 v[240:243], a[116:119], v[100:103], v[240:243]
    v_cvt_pk_bf16_f32 v126, v12, v13
    v_add_f32 v27, v27, v14
    v_mfma_f32_16x16x32_bf16 v[244:247], a[116:119], v[108:111], v[244:247]
    ds_read_b128 a[84:87], v2 offset:37888
    v_add_f32 v27, v27, v15
    v_mfma_f32_16x16x32_bf16 v[244:247], a[112:115], v[104:107], v[244:247]
    s_waitcnt lgkmcnt(7)
    v_cvt_pk_bf16_f32 v127, v14, v15
    v_add_f32 v28, v26, v27
    v_mfma_f32_16x16x32_bf16 v[248:251], a[120:123], v[96:99], v[248:251]
    s_waitcnt lgkmcnt(6)
    ds_read_b128 a[88:91], v2 offset:38912
    v_cmp_nge_f32 vcc, s24, v28
    v_mfma_f32_16x16x32_bf16 v[248:251], a[124:127], v[100:103], v[248:251]
    v_mfma_f32_16x16x32_bf16 v[252:255], a[124:127], v[108:111], v[252:255]
    ds_read_b128 a[92:95], v2 offset:39936
    v_mfma_f32_16x16x32_bf16 v[252:255], a[120:123], v[104:107], v[252:255]
    s_waitcnt lgkmcnt(6)
    s_cbranch_vccnz BLstub_11
BLback_12:
    v_mfma_f32_16x16x32_bf16 v[128:131], a[64:67], v[112:115], v[128:131]
    s_add_u32 m0, s16, 32768
    ds_read_b128 a[96:99], v2 offset:40960
    v_add_f32 v24, v24, v26
    v_mfma_f32_16x16x32_bf16 v[128:131], a[68:71], v[116:119], v[128:131]
    buffer_load_dwordx4 v1, s[4:7], s8 offen offset:0 lds
    v_mfma_f32_16x16x32_bf16 v[132:135], a[68:71], v[124:127], v[132:135]
    ds_read_b128 a[100:103], v2 offset:41984
    v_add_f32 v25, v25, v27
    v_mfma_f32_16x16x32_bf16 v[132:135], a[64:67], v[120:123], v[132:135]
    s_waitcnt lgkmcnt(7)
    buffer_load_dwordx4 v1, s[4:7], s8 offen offset:1024 lds
    v_mfma_f32_16x16x32_bf16 v[136:139], a[72:75], v[112:115], v[136:139]
    s_waitcnt lgkmcnt(6)
    ds_read_b128 a[104:107], v2 offset:43008
    v_mfma_f32_16x16x32_bf16 v[136:139], a[76:79], v[116:119], v[136:139]
    buffer_load_dwordx4 v1, s[4:7], s8 offen offset:2048 lds
    v_mfma_f32_16x16x32_bf16 v[140:143], a[76:79], v[124:127], v[140:143]
    ds_read_b128 a[108:111], v2 offset:44032
    v_mfma_f32_16x16x32_bf16 v[140:143], a[72:75], v[120:123], v[140:143]
    s_waitcnt lgkmcnt(6)
    buffer_load_dwordx4 v1, s[4:7], s8 offen offset:3072 lds
    v_mfma_f32_16x16x32_bf16 v[144:147], a[80:83], v[112:115], v[144:147]
    s_add_u32 s8, s8, 4096
    s_add_u32 m0, s16, 36864
    ds_read_b128 a[112:115], v2 offset:45056
    v_mfma_f32_16x16x32_bf16 v[144:147], a[84:87], v[116:119], v[144:147]
    buffer_load_dwordx4 v1, s[4:7], s8 offen offset:0 lds
    v_mfma_f32_16x16x32_bf16 v[148:151], a[84:87], v[124:127], v[148:151]
    ds_read_b128 a[116:119], v2 offset:46080
    v_mfma_f32_16x16x32_bf16 v[148:151], a[80:83], v[120:123], v[148:151]
    s_waitcnt lgkmcnt(7)
    buffer_load_dwordx4 v1, s[4:7], s8 offen offset:1024 lds
    v_mfma_f32_16x16x32_bf16 v[152:155], a[88:91], v[112:115], v[152:155]
    s_waitcnt lgkmcnt(6)
    ds_read_b128 a[120:123], v2 offset:47104
    v_mfma_f32_16x16x32_bf16 v[152:155], a[92:95], v[116:119], v[152:155]
    buffer_load_dwordx4 v1, s[4:7], s8 offen offset:2048 lds
    v_mfma_f32_16x16x32_bf16 v[156:159], a[92:95], v[124:127], v[156:159]
    ds_read_b128 a[124:127], v2 offset:48128
    v_mfma_f32_16x16x32_bf16 v[156:159], a[88:91], v[120:123], v[156:159]
    s_waitcnt lgkmcnt(7)
    buffer_load_dwordx4 v1, s[4:7], s8 offen offset:3072 lds
    v_mfma_f32_16x16x32_bf16 v[160:163], a[96:99], v[112:115], v[160:163]
    s_waitcnt lgkmcnt(6)
    s_add_u32 s8, s8, 28672
    ds_read_b128 a[64:67], v2 offset:49152
    v_mfma_f32_16x16x32_bf16 v[160:163], a[100:103], v[116:119], v[160:163]
    s_sub_u32 s9, s9, 1
    v_mfma_f32_16x16x32_bf16 v[164:167], a[100:103], v[124:127], v[164:167]
    s_cmp_eq_u32 s9, 0
    ds_read_b128 a[68:71], v2 offset:50176
    v_mfma_f32_16x16x32_bf16 v[164:167], a[96:99], v[120:123], v[164:167]
    s_waitcnt lgkmcnt(7)
    s_cselect_b32 s8, s10, s8
    v_mfma_f32_16x16x32_bf16 v[168:171], a[104:107], v[112:115], v[168:171]
    s_waitcnt lgkmcnt(6)
    s_cselect_b32 s9, s11, s9
    ds_read_b128 a[72:75], v2 offset:51200
    v_mfma_f32_16x16x32_bf16 v[168:171], a[108:111], v[116:119], v[168:171]
    s_cselect_b32 s10, 3221225472, s10
    v_mfma_f32_16x16x32_bf16 v[172:175], a[108:111], v[124:127], v[172:175]
    ds_read_b128 a[76:79], v2 offset:52224
    v_mfma_f32_16x16x32_bf16 v[172:175], a[104:107], v[120:123], v[172:175]
    s_waitcnt lgkmcnt(7)
    v_mfma_f32_16x16x32_bf16 v[176:179], a[112:115], v[112:115], v[176:179]
    s_waitcnt lgkmcnt(6)
    s_add_u32 s21, s27, 0
    ds_read_b128 a[80:83], v2 offset:53248
    v_mfma_f32_16x16x32_bf16 v[176:179], a[116:119], v[116:119], v[176:179]
    buffer_load_dwordx4 a[0:3], v1, s[4:7], s21 offen offset:0
    v_mfma_f32_16x16x32_bf16 v[180:183], a[116:119], v[124:127], v[180:183]
    ds_read_b128 a[84:87], v2 offset:54272
    v_mfma_f32_16x16x32_bf16 v[180:183], a[112:115], v[120:123], v[180:183]
    s_waitcnt lgkmcnt(7)
    buffer_load_dwordx4 a[4:7], v1, s[4:7], s21 offen offset:1024
    v_mfma_f32_16x16x32_bf16 v[184:187], a[120:123], v[112:115], v[184:187]
    s_waitcnt lgkmcnt(6)
    ds_read_b128 a[88:91], v2 offset:55296
    v_mfma_f32_16x16x32_bf16 v[184:187], a[124:127], v[116:119], v[184:187]
    buffer_load_dwordx4 a[8:11], v1, s[4:7], s21 offen offset:2048
    v_mfma_f32_16x16x32_bf16 v[188:191], a[124:127], v[124:127], v[188:191]
    ds_read_b128 a[92:95], v2 offset:56320
    v_mfma_f32_16x16x32_bf16 v[188:191], a[120:123], v[120:123], v[188:191]
    s_waitcnt lgkmcnt(7)
    buffer_load_dwordx4 a[12:15], v1, s[4:7], s21 offen offset:3072
    v_mfma_f32_16x16x32_bf16 v[192:195], a[64:67], v[112:115], v[192:195]
    s_waitcnt lgkmcnt(6)
    s_add_u32 s21, s27, 4096
    ds_read_b128 a[96:99], v2 offset:57344
    v_mfma_f32_16x16x32_bf16 v[192:195], a[68:71], v[116:119], v[192:195]
    buffer_load_dwordx4 a[16:19], v1, s[4:7], s21 offen offset:0
    v_mfma_f32_16x16x32_bf16 v[196:199], a[68:71], v[124:127], v[196:199]
    ds_read_b128 a[100:103], v2 offset:58368
    v_mfma_f32_16x16x32_bf16 v[196:199], a[64:67], v[120:123], v[196:199]
    s_waitcnt lgkmcnt(7)
    buffer_load_dwordx4 a[20:23], v1, s[4:7], s21 offen offset:1024
    v_mfma_f32_16x16x32_bf16 v[200:203], a[72:75], v[112:115], v[200:203]
    s_waitcnt lgkmcnt(6)
    ds_read_b128 a[104:107], v2 offset:59392
    v_mfma_f32_16x16x32_bf16 v[200:203], a[76:79], v[116:119], v[200:203]
    buffer_load_dwordx4 a[24:27], v1, s[4:7], s21 offen offset:2048
    v_mfma_f32_16x16x32_bf16 v[204:207], a[76:79], v[124:127], v[204:207]
    ds_read_b128 a[108:111], v2 offset:60416
    v_mfma_f32_16x16x32_bf16 v[204:207], a[72:75], v[120:123], v[204:207]
    s_waitcnt lgkmcnt(7)
    buffer_load_dwordx4 a[28:31], v1, s[4:7], s21 offen offset:3072
    v_mfma_f32_16x16x32_bf16 v[208:211], a[80:83], v[112:115], v[208:211]
    s_waitcnt lgkmcnt(6)
    s_add_u32 s21, s27, 32768
    ds_read_b128 a[112:115], v2 offset:61440
    v_mfma_f32_16x16x32_bf16 v[208:211], a[84:87], v[116:119], v[208:211]
    buffer_load_dwordx4 a[32:35], v1, s[4:7], s21 offen offset:0
    v_mfma_f32_16x16x32_bf16 v[212:215], a[84:87], v[124:127], v[212:215]
    ds_read_b128 a[116:119], v2 offset:62464
    v_mfma_f32_16x16x32_bf16 v[212:215], a[80:83], v[120:123], v[212:215]
    s_waitcnt lgkmcnt(7)
    buffer_load_dwordx4 a[36:39], v1, s[4:7], s21 offen offset:1024
    v_mfma_f32_16x16x32_bf16 v[216:219], a[88:91], v[112:115], v[216:219]
    s_waitcnt lgkmcnt(6)
    ds_read_b128 a[120:123], v2 offset:63488
    v_mfma_f32_16x16x32_bf16 v[216:219], a[92:95], v[116:119], v[216:219]
    buffer_load_dwordx4 a[40:43], v1, s[4:7], s21 offen offset:2048
    v_mfma_f32_16x16x32_bf16 v[220:223], a[92:95], v[124:127], v[220:223]
    ds_read_b128 a[124:127], v2 offset:64512
    v_mfma_f32_16x16x32_bf16 v[220:223], a[88:91], v[120:123], v[220:223]
    s_waitcnt lgkmcnt(6)
    buffer_load_dwordx4 a[44:47], v1, s[4:7], s21 offen offset:3072
    v_mfma_f32_16x16x32_bf16 v[224:227], a[96:99], v[112:115], v[224:227]
    s_add_u32 s21, s27, 36864
    buffer_load_dwordx4 a[48:51], v1, s[4:7], s21 offen offset:0
    v_mfma_f32_16x16x32_bf16 v[224:227], a[100:103], v[116:119], v[224:227]
    buffer_load_dwordx4 a[52:55], v1, s[4:7], s21 offen offset:1024
    v_mfma_f32_16x16x32_bf16 v[228:231], a[100:103], v[124:127], v[228:231]
    buffer_load_dwordx4 a[56:59], v1, s[4:7], s21 offen offset:2048
    v_mfma_f32_16x16x32_bf16 v[228:231], a[96:99], v[120:123], v[228:231]
    s_waitcnt lgkmcnt(5)
    buffer_load_dwordx4 a[60:63], v1, s[4:7], s21 offen offset:3072
    v_mfma_f32_16x16x32_bf16 v[232:235], a[104:107], v[112:115], v[232:235]
    s_waitcnt lgkmcnt(4)
    v_mfma_f32_16x16x32_bf16 v[232:235], a[108:111], v[116:119], v[232:235]
    v_mfma_f32_16x16x32_bf16 v[236:239], a[108:111], v[124:127], v[236:239]
    v_mfma_f32_16x16x32_bf16 v[236:239], a[104:107], v[120:123], v[236:239]
    s_waitcnt lgkmcnt(3)
    v_mfma_f32_16x16x32_bf16 v[240:243], a[112:115], v[112:115], v[240:243]
    s_waitcnt lgkmcnt(2)
    v_mfma_f32_16x16x32_bf16 v[240:243], a[116:119], v[116:119], v[240:243]
    v_mfma_f32_16x16x32_bf16 v[244:247], a[116:119], v[124:127], v[244:247]
    v_mfma_f32_16x16x32_bf16 v[244:247], a[112:115], v[120:123], v[244:247]
    s_waitcnt lgkmcnt(1)
    v_mfma_f32_16x16x32_bf16 v[248:251], a[120:123], v[112:115], v[248:251]
    s_waitcnt lgkmcnt(0)
    v_mfma_f32_16x16x32_bf16 v[248:251], a[124:127], v[116:119], v[248:251]
    v_mfma_f32_16x16x32_bf16 v[252:255], a[124:127], v[124:127], v[252:255]
    v_mfma_f32_16x16x32_bf16 v[252:255], a[120:123], v[120:123], v[252:255]
    s_barrier
    s_add_u32 m0, s16, 65536
    s_nop 0
    buffer_load_dwordx4 v1, s[4:7], s12 offen offset:0 lds
    buffer_load_dwordx4 v1, s[4:7], s12 offen offset:1024 lds
    buffer_load_dwordx4 v1, s[4:7], s12 offen offset:2048 lds
    buffer_load_dwordx4 v1, s[4:7], s12 offen offset:3072 lds
    s_add_u32 s12, s12, 4096
    s_add_u32 m0, s16, 69632
    s_nop 0
    buffer_load_dwordx4 v1, s[4:7], s12 offen offset:0 lds
    buffer_load_dwordx4 v1, s[4:7], s12 offen offset:1024 lds
    buffer_load_dwordx4 v1, s[4:7], s12 offen offset:2048 lds
    buffer_load_dwordx4 v1, s[4:7], s12 offen offset:3072 lds
    s_add_u32 s12, s12, 28672
    s_sub_u32 s13, s13, 1
    s_cmp_eq_u32 s13, 0
    s_cselect_b32 s12, s14, s12
    s_cselect_b32 s13, s15, s13
    s_cselect_b32 s14, 3221225472, s14
    v_mov_b32 v28, v24
    s_nop 1
    v_permlane16_swap_b32 v24, v28
    v_add_f32 v24, v24, v28
    v_mov_b32 v28, v24
    s_nop 1
    v_permlane32_swap_b32 v24, v28
    v_add_f32 v24, v24, v28
    v_mov_b32 v29, v25
    s_nop 1
    v_permlane16_swap_b32 v25, v29
    v_add_f32 v25, v25, v29
    v_mov_b32 v29, v25
    s_nop 1
    v_permlane32_swap_b32 v25, v29
    v_add_f32 v25, v25, v29
    s_lshl_b32 s27, s28, 2
    s_add_u32 s27, s27, s19
    s_lshl_b32 s28, s27, 10
    s_add_u32 s28, s28, 75497472
    s_lshl_b32 s27, s27, 14
    s_add_u32 s27, s27, 67108864
    v_rcp_f32 v28, v24
    v_rcp_f32 v29, v25
    v_mov_b32 v8, v16
    v_mov_b32 v9, v24
    v_mov_b32 v10, v20
    v_mov_b32 v11, v25
    buffer_store_dwordx4 v[8:11], v1, s[4:7], s28 offen sc1
    s_add_u32 s21, s27, 0
    v_mul_f32 v128, v128, v28
    v_mul_f32 v129, v129, v28
    v_mul_f32 v130, v130, v28
    v_mul_f32 v131, v131, v28
    v_mul_f32 v136, v136, v28
    v_mul_f32 v137, v137, v28
    v_mul_f32 v138, v138, v28
    v_mul_f32 v139, v139, v28
    v_cvt_pk_bf16_f32 v128, v128, v129
    v_cvt_pk_bf16_f32 v129, v130, v131
    v_cvt_pk_bf16_f32 v130, v136, v137
    v_cvt_pk_bf16_f32 v131, v138, v139
    buffer_store_dwordx4 v[128:131], v1, s[4:7], s21 offen offset:0 sc1
    v_mul_f32 v144, v144, v28
    v_mul_f32 v145, v145, v28
    v_mul_f32 v146, v146, v28
    v_mul_f32 v147, v147, v28
    v_mul_f32 v152, v152, v28
    v_mul_f32 v153, v153, v28
    v_mul_f32 v154, v154, v28
    v_mul_f32 v155, v155, v28
    v_cvt_pk_bf16_f32 v144, v144, v145
    v_cvt_pk_bf16_f32 v145, v146, v147
    v_cvt_pk_bf16_f32 v146, v152, v153
    v_cvt_pk_bf16_f32 v147, v154, v155
    buffer_store_dwordx4 v[144:147], v1, s[4:7], s21 offen offset:1024 sc1
    v_mul_f32 v160, v160, v28
    v_mul_f32 v161, v161, v28
    v_mul_f32 v162, v162, v28
    v_mul_f32 v163, v163, v28
    v_mul_f32 v168, v168, v28
    v_mul_f32 v169, v169, v28
    v_mul_f32 v170, v170, v28
    v_mul_f32 v171, v171, v28
    v_cvt_pk_bf16_f32 v160, v160, v161
    v_cvt_pk_bf16_f32 v161, v162, v163
    v_cvt_pk_bf16_f32 v162, v168, v169
    v_cvt_pk_bf16_f32 v163, v170, v171
    buffer_store_dwordx4 v[160:163], v1, s[4:7], s21 offen offset:2048 sc1
    v_mul_f32 v176, v176, v28
    v_mul_f32 v177, v177, v28
    v_mul_f32 v178, v178, v28
    v_mul_f32 v179, v179, v28
    v_mul_f32 v184, v184, v28
    v_mul_f32 v185, v185, v28
    v_mul_f32 v186, v186, v28
    v_mul_f32 v187, v187, v28
    v_cvt_pk_bf16_f32 v176, v176, v177
    v_cvt_pk_bf16_f32 v177, v178, v179
    v_cvt_pk_bf16_f32 v178, v184, v185
    v_cvt_pk_bf16_f32 v179, v186, v187
    buffer_store_dwordx4 v[176:179], v1, s[4:7], s21 offen offset:3072 sc1
    s_add_u32 s21, s27, 4096
    v_mul_f32 v192, v192, v28
    v_mul_f32 v193, v193, v28
    v_mul_f32 v194, v194, v28
    v_mul_f32 v195, v195, v28
    v_mul_f32 v200, v200, v28
    v_mul_f32 v201, v201, v28
    v_mul_f32 v202, v202, v28
    v_mul_f32 v203, v203, v28
    v_cvt_pk_bf16_f32 v192, v192, v193
    v_cvt_pk_bf16_f32 v193, v194, v195
    v_cvt_pk_bf16_f32 v194, v200, v201
    v_cvt_pk_bf16_f32 v195, v202, v203
    buffer_store_dwordx4 v[192:195], v1, s[4:7], s21 offen offset:0 sc1
    v_mul_f32 v208, v208, v28
    v_mul_f32 v209, v209, v28
    v_mul_f32 v210, v210, v28
    v_mul_f32 v211, v211, v28
    v_mul_f32 v216, v216, v28
    v_mul_f32 v217, v217, v28
    v_mul_f32 v218, v218, v28
    v_mul_f32 v219, v219, v28
    v_cvt_pk_bf16_f32 v208, v208, v209
    v_cvt_pk_bf16_f32 v209, v210, v211
    v_cvt_pk_bf16_f32 v210, v216, v217
    v_cvt_pk_bf16_f32 v211, v218, v219
    buffer_store_dwordx4 v[208:211], v1, s[4:7], s21 offen offset:1024 sc1
    v_mul_f32 v224, v224, v28
    v_mul_f32 v225, v225, v28
    v_mul_f32 v226, v226, v28
    v_mul_f32 v227, v227, v28
    v_mul_f32 v232, v232, v28
    v_mul_f32 v233, v233, v28
    v_mul_f32 v234, v234, v28
    v_mul_f32 v235, v235, v28
    v_cvt_pk_bf16_f32 v224, v224, v225
    v_cvt_pk_bf16_f32 v225, v226, v227
    v_cvt_pk_bf16_f32 v226, v232, v233
    v_cvt_pk_bf16_f32 v227, v234, v235
    buffer_store_dwordx4 v[224:227], v1, s[4:7], s21 offen offset:2048 sc1
    v_mul_f32 v240, v240, v28
    v_mul_f32 v241, v241, v28
    v_mul_f32 v242, v242, v28
    v_mul_f32 v243, v243, v28
    v_mul_f32 v248, v248, v28
    v_mul_f32 v249, v249, v28
    v_mul_f32 v250, v250, v28
    v_mul_f32 v251, v251, v28
    v_cvt_pk_bf16_f32 v240, v240, v241
    v_cvt_pk_bf16_f32 v241, v242, v243
    v_cvt_pk_bf16_f32 v242, v248, v249
    v_cvt_pk_bf16_f32 v243, v250, v251
    buffer_store_dwordx4 v[240:243], v1, s[4:7], s21 offen offset:3072 sc1
    s_add_u32 s21, s27, 8192
    v_mul_f32 v132, v132, v29
    v_mul_f32 v133, v133, v29
    v_mul_f32 v134, v134, v29
    v_mul_f32 v135, v135, v29
    v_mul_f32 v140, v140, v29
    v_mul_f32 v141, v141, v29
    v_mul_f32 v142, v142, v29
    v_mul_f32 v143, v143, v29
    v_cvt_pk_bf16_f32 v132, v132, v133
    v_cvt_pk_bf16_f32 v133, v134, v135
    v_cvt_pk_bf16_f32 v134, v140, v141
    v_cvt_pk_bf16_f32 v135, v142, v143
    buffer_store_dwordx4 v[132:135], v1, s[4:7], s21 offen offset:0 sc1
    v_mul_f32 v148, v148, v29
    v_mul_f32 v149, v149, v29
    v_mul_f32 v150, v150, v29
    v_mul_f32 v151, v151, v29
    v_mul_f32 v156, v156, v29
    v_mul_f32 v157, v157, v29
    v_mul_f32 v158, v158, v29
    v_mul_f32 v159, v159, v29
    v_cvt_pk_bf16_f32 v148, v148, v149
    v_cvt_pk_bf16_f32 v149, v150, v151
    v_cvt_pk_bf16_f32 v150, v156, v157
    v_cvt_pk_bf16_f32 v151, v158, v159
    buffer_store_dwordx4 v[148:151], v1, s[4:7], s21 offen offset:1024 sc1
    v_mul_f32 v164, v164, v29
    v_mul_f32 v165, v165, v29
    v_mul_f32 v166, v166, v29
    v_mul_f32 v167, v167, v29
    v_mul_f32 v172, v172, v29
    v_mul_f32 v173, v173, v29
    v_mul_f32 v174, v174, v29
    v_mul_f32 v175, v175, v29
    v_cvt_pk_bf16_f32 v164, v164, v165
    v_cvt_pk_bf16_f32 v165, v166, v167
    v_cvt_pk_bf16_f32 v166, v172, v173
    v_cvt_pk_bf16_f32 v167, v174, v175
    buffer_store_dwordx4 v[164:167], v1, s[4:7], s21 offen offset:2048 sc1
    v_mul_f32 v180, v180, v29
    v_mul_f32 v181, v181, v29
    v_mul_f32 v182, v182, v29
    v_mul_f32 v183, v183, v29
    v_mul_f32 v188, v188, v29
    v_mul_f32 v189, v189, v29
    v_mul_f32 v190, v190, v29
    v_mul_f32 v191, v191, v29
    v_cvt_pk_bf16_f32 v180, v180, v181
    v_cvt_pk_bf16_f32 v181, v182, v183
    v_cvt_pk_bf16_f32 v182, v188, v189
    v_cvt_pk_bf16_f32 v183, v190, v191
    buffer_store_dwordx4 v[180:183], v1, s[4:7], s21 offen offset:3072 sc1
    s_add_u32 s21, s27, 12288
    v_mul_f32 v196, v196, v29
    v_mul_f32 v197, v197, v29
    v_mul_f32 v198, v198, v29
    v_mul_f32 v199, v199, v29
    v_mul_f32 v204, v204, v29
    v_mul_f32 v205, v205, v29
    v_mul_f32 v206, v206, v29
    v_mul_f32 v207, v207, v29
    v_cvt_pk_bf16_f32 v196, v196, v197
    v_cvt_pk_bf16_f32 v197, v198, v199
    v_cvt_pk_bf16_f32 v198, v204, v205
    v_cvt_pk_bf16_f32 v199, v206, v207
    buffer_store_dwordx4 v[196:199], v1, s[4:7], s21 offen offset:0 sc1
    v_mul_f32 v212, v212, v29
    v_mul_f32 v213, v213, v29
    v_mul_f32 v214, v214, v29
    v_mul_f32 v215, v215, v29
    v_mul_f32 v220, v220, v29
    v_mul_f32 v221, v221, v29
    v_mul_f32 v222, v222, v29
    v_mul_f32 v223, v223, v29
    v_cvt_pk_bf16_f32 v212, v212, v213
    v_cvt_pk_bf16_f32 v213, v214, v215
    v_cvt_pk_bf16_f32 v214, v220, v221
    v_cvt_pk_bf16_f32 v215, v222, v223
    buffer_store_dwordx4 v[212:215], v1, s[4:7], s21 offen offset:1024 sc1
    v_mul_f32 v228, v228, v29
    v_mul_f32 v229, v229, v29
    v_mul_f32 v230, v230, v29
    v_mul_f32 v231, v231, v29
    v_mul_f32 v236, v236, v29
    v_mul_f32 v237, v237, v29
    v_mul_f32 v238, v238, v29
    v_mul_f32 v239, v239, v29
    v_cvt_pk_bf16_f32 v228, v228, v229
    v_cvt_pk_bf16_f32 v229, v230, v231
    v_cvt_pk_bf16_f32 v230, v236, v237
    v_cvt_pk_bf16_f32 v231, v238, v239
    buffer_store_dwordx4 v[228:231], v1, s[4:7], s21 offen offset:2048 sc1
    v_mul_f32 v244, v244, v29
    v_mul_f32 v245, v245, v29
    v_mul_f32 v246, v246, v29
    v_mul_f32 v247, v247, v29
    v_mul_f32 v252, v252, v29
    v_mul_f32 v253, v253, v29
    v_mul_f32 v254, v254, v29
    v_mul_f32 v255, v255, v29
    v_cvt_pk_bf16_f32 v244, v244, v245
    v_cvt_pk_bf16_f32 v245, v246, v247
    v_cvt_pk_bf16_f32 v246, v252, v253
    v_cvt_pk_bf16_f32 v247, v254, v255
    buffer_store_dwordx4 v[244:247], v1, s[4:7], s21 offen offset:3072 sc1
    s_mov_b32 s18, 3
    s_mov_b32 s23, s26
    s_mov_b32 s17, s26
    s_nop 0
    s_branch K2_item
BLstub_1:
    s_call_b64 s[30:31], K2_slow1
    s_branch BLback_2
BLstub_3:
    s_call_b64 s[30:31], K2_slow0
    s_branch BLback_4
BLstub_5:
    s_call_b64 s[30:31], K2_slow1
    s_branch BLback_6
BLstub_7:
    s_call_b64 s[30:31], K2_slow0
    s_branch BLback_8
BLstub_9:
    s_call_b64 s[30:31], K2_slow1
    s_branch BLback_10
BLstub_11:
    s_call_b64 s[30:31], K2_slow1
    s_branch BLback_12
K2_slow0:
    s_nop 7
    s_nop 7
    v_max3_f32 v28, v32, v33, 0
    v_max3_f32 v28, v34, v35, v28
    v_max3_f32 v28, v40, v41, v28
    v_max3_f32 v28, v42, v43, v28
    v_max3_f32 v28, v48, v49, v28
    v_max3_f32 v28, v50, v51, v28
    v_max3_f32 v28, v56, v57, v28
    v_max3_f32 v28, v58, v59, v28
    v_mov_b32 v29, v28
    s_nop 1
    v_permlane16_swap_b32 v28, v29
    v_max_f32 v28, v28, v29
    v_mov_b32 v29, v28
    s_nop 1
    v_permlane32_swap_b32 v28, v29
    v_max_f32 v28, v28, v29
    v_exp_f32 v29, -v28
    v_sub_f32 v16, v16, v28
    v_sub_f32 v17, v17, v28
    v_sub_f32 v18, v18, v28
    v_sub_f32 v19, v19, v28
    v_mul_f32 v24, v24, v29
    v_mul_f32 v128, v128, v29
    v_mul_f32 v129, v129, v29
    v_mul_f32 v130, v130, v29
    v_mul_f32 v131, v131, v29
    v_mul_f32 v136, v136, v29
    v_mul_f32 v137, v137, v29
    v_mul_f32 v138, v138, v29
    v_mul_f32 v139, v139, v29
    v_mul_f32 v144, v144, v29
    v_mul_f32 v145, v145, v29
    v_mul_f32 v146, v146, v29
    v_mul_f32 v147, v147, v29
    v_mul_f32 v152, v152, v29
    v_mul_f32 v153, v153, v29
    v_mul_f32 v154, v154, v29
    v_mul_f32 v155, v155, v29
    v_mul_f32 v160, v160, v29
    v_mul_f32 v161, v161, v29
    v_mul_f32 v162, v162, v29
    v_mul_f32 v163, v163, v29
    v_mul_f32 v168, v168, v29
    v_mul_f32 v169, v169, v29
    v_mul_f32 v170, v170, v29
    v_mul_f32 v171, v171, v29
    v_mul_f32 v176, v176, v29
    v_mul_f32 v177, v177, v29
    v_mul_f32 v178, v178, v29
    v_mul_f32 v179, v179, v29
    v_mul_f32 v184, v184, v29
    v_mul_f32 v185, v185, v29
    v_mul_f32 v186, v186, v29
    v_mul_f32 v187, v187, v29
    v_mul_f32 v192, v192, v29
    v_mul_f32 v193, v193, v29
    v_mul_f32 v194, v194, v29
    v_mul_f32 v195, v195, v29
    v_mul_f32 v200, v200, v29
    v_mul_f32 v201, v201, v29
    v_mul_f32 v202, v202, v29
    v_mul_f32 v203, v203, v29
    v_mul_f32 v208, v208, v29
    v_mul_f32 v209, v209, v29
    v_mul_f32 v210, v210, v29
    v_mul_f32 v211, v211, v29
    v_mul_f32 v216, v216, v29
    v_mul_f32 v217, v217, v29
    v_mul_f32 v218, v218, v29
    v_mul_f32 v219, v219, v29
    v_mul_f32 v224, v224, v29
    v_mul_f32 v225, v225, v29
    v_mul_f32 v226, v226, v29
    v_mul_f32 v227, v227, v29
    v_mul_f32 v232, v232, v29
    v_mul_f32 v233, v233, v29
    v_mul_f32 v234, v234, v29
    v_mul_f32 v235, v235, v29
    v_mul_f32 v240, v240, v29
    v_mul_f32 v241, v241, v29
    v_mul_f32 v242, v242, v29
    v_mul_f32 v243, v243, v29
    v_mul_f32 v248, v248, v29
    v_mul_f32 v249, v249, v29
    v_mul_f32 v250, v250, v29
    v_mul_f32 v251, v251, v29
    v_sub_f32 v32, v32, v28
    v_sub_f32 v33, v33, v28
    v_sub_f32 v34, v34, v28
    v_sub_f32 v35, v35, v28
    v_sub_f32 v40, v40, v28
    v_sub_f32 v41, v41, v28
    v_sub_f32 v42, v42, v28
    v_sub_f32 v43, v43, v28
    v_sub_f32 v48, v48, v28
    v_sub_f32 v49, v49, v28
    v_sub_f32 v50, v50, v28
    v_sub_f32 v51, v51, v28
    v_sub_f32 v56, v56, v28
    v_sub_f32 v57, v57, v28
    v_sub_f32 v58, v58, v28
    v_sub_f32 v59, v59, v28
    v_sub_f32 v64, v64, v28
    v_sub_f32 v65, v65, v28
    v_sub_f32 v66, v66, v28
    v_sub_f32 v67, v67, v28
    v_sub_f32 v72, v72, v28
    v_sub_f32 v73, v73, v28
    v_sub_f32 v74, v74, v28
    v_sub_f32 v75, v75, v28
    v_sub_f32 v80, v80, v28
    v_sub_f32 v81, v81, v28
    v_sub_f32 v82, v82, v28
    v_sub_f32 v83, v83, v28
    v_sub_f32 v88, v88, v28
    v_sub_f32 v89, v89, v28
    v_sub_f32 v90, v90, v28
    v_sub_f32 v91, v91, v28
    v_max3_f32 v28, v36, v37, 0
    v_max3_f32 v28, v38, v39, v28
    v_max3_f32 v28, v44, v45, v28
    v_max3_f32 v28, v46, v47, v28
    v_max3_f32 v28, v52, v53, v28
    v_max3_f32 v28, v54, v55, v28
    v_max3_f32 v28, v60, v61, v28
    v_max3_f32 v28, v62, v63, v28
    v_mov_b32 v29, v28
    s_nop 1
    v_permlane16_swap_b32 v28, v29
    v_max_f32 v28, v28, v29
    v_mov_b32 v29, v28
    s_nop 1
    v_permlane32_swap_b32 v28, v29
    v_max_f32 v28, v28, v29
    v_exp_f32 v29, -v28
    v_sub_f32 v20, v20, v28
    v_sub_f32 v21, v21, v28
    v_sub_f32 v22, v22, v28
    v_sub_f32 v23, v23, v28
    v_mul_f32 v25, v25, v29
    v_mul_f32 v132, v132, v29
    v_mul_f32 v133, v133, v29
    v_mul_f32 v134, v134, v29
    v_mul_f32 v135, v135, v29
    v_mul_f32 v140, v140, v29
    v_mul_f32 v141, v141, v29
    v_mul_f32 v142, v142, v29
    v_mul_f32 v143, v143, v29
    v_mul_f32 v148, v148, v29
    v_mul_f32 v149, v149, v29
    v_mul_f32 v150, v150, v29
    v_mul_f32 v151, v151, v29
    v_mul_f32 v156, v156, v29
    v_mul_f32 v157, v157, v29
    v_mul_f32 v158, v158, v29
    v_mul_f32 v159, v159, v29
    v_mul_f32 v164, v164, v29
    v_mul_f32 v165, v165, v29
    v_mul_f32 v166, v166, v29
    v_mul_f32 v167, v167, v29
    v_mul_f32 v172, v172, v29
    v_mul_f32 v173, v173, v29
    v_mul_f32 v174, v174, v29
    v_mul_f32 v175, v175, v29
    v_mul_f32 v180, v180, v29
    v_mul_f32 v181, v181, v29
    v_mul_f32 v182, v182, v29
    v_mul_f32 v183, v183, v29
    v_mul_f32 v188, v188, v29
    v_mul_f32 v189, v189, v29
    v_mul_f32 v190, v190, v29
    v_mul_f32 v191, v191, v29
    v_mul_f32 v196, v196, v29
    v_mul_f32 v197, v197, v29
    v_mul_f32 v198, v198, v29
    v_mul_f32 v199, v199, v29
    v_mul_f32 v204, v204, v29
    v_mul_f32 v205, v205, v29
    v_mul_f32 v206, v206, v29
    v_mul_f32 v207, v207, v29
    v_mul_f32 v212, v212, v29
    v_mul_f32 v213, v213, v29
    v_mul_f32 v214, v214, v29
    v_mul_f32 v215, v215, v29
    v_mul_f32 v220, v220, v29
    v_mul_f32 v221, v221, v29
    v_mul_f32 v222, v222, v29
    v_mul_f32 v223, v223, v29
    v_mul_f32 v228, v228, v29
    v_mul_f32 v229, v229, v29
    v_mul_f32 v230, v230, v29
    v_mul_f32 v231, v231, v29
    v_mul_f32 v236, v236, v29
    v_mul_f32 v237, v237, v29
    v_mul_f32 v238, v238, v29
    v_mul_f32 v239, v239, v29
    v_mul_f32 v244, v244, v29
    v_mul_f32 v245, v245, v29
    v_mul_f32 v246, v246, v29
    v_mul_f32 v247, v247, v29
    v_mul_f32 v252, v252, v29
    v_mul_f32 v253, v253, v29
    v_mul_f32 v254, v254, v29
    v_mul_f32 v255, v255, v29
    v_sub_f32 v36, v36, v28
    v_sub_f32 v37, v37, v28
    v_sub_f32 v38, v38, v28
    v_sub_f32 v39, v39, v28
    v_sub_f32 v44, v44, v28
    v_sub_f32 v45, v45, v28
    v_sub_f32 v46, v46, v28
    v_sub_f32 v47, v47, v28
    v_sub_f32 v52, v52, v28
    v_sub_f32 v53, v53, v28
    v_sub_f32 v54, v54, v28
    v_sub_f32 v55, v55, v28
    v_sub_f32 v60, v60, v28
    v_sub_f32 v61, v61, v28
    v_sub_f32 v62, v62, v28
    v_sub_f32 v63, v63, v28
    v_sub_f32 v68, v68, v28
    v_sub_f32 v69, v69, v28
    v_sub_f32 v70, v70, v28
    v_sub_f32 v71, v71, v28
    v_sub_f32 v76, v76, v28
    v_sub_f32 v77, v77, v28
    v_sub_f32 v78, v78, v28
    v_sub_f32 v79, v79, v28
    v_sub_f32 v84, v84, v28
    v_sub_f32 v85, v85, v28
    v_sub_f32 v86, v86, v28
    v_sub_f32 v87, v87, v28
    v_sub_f32 v92, v92, v28
    v_sub_f32 v93, v93, v28
    v_sub_f32 v94, v94, v28
    v_sub_f32 v95, v95, v28
    v_exp_f32 v8, v32
    v_exp_f32 v9, v33
    v_exp_f32 v10, v34
    v_exp_f32 v11, v35
    s_nop 0
    v_add_f32 v26, v8, v9
    v_cvt_pk_bf16_f32 v96, v8, v9
    v_add_f32 v26, v26, v10
    v_add_f32 v26, v26, v11
    v_cvt_pk_bf16_f32 v97, v10, v11
    v_exp_f32 v12, v36
    v_exp_f32 v13, v37
    v_exp_f32 v14, v38
    v_exp_f32 v15, v39
    s_nop 0
    v_add_f32 v27, v12, v13
    v_cvt_pk_bf16_f32 v104, v12, v13
    v_add_f32 v27, v27, v14
    v_add_f32 v27, v27, v15
    v_cvt_pk_bf16_f32 v105, v14, v15
    v_exp_f32 v8, v40
    v_exp_f32 v9, v41
    v_exp_f32 v10, v42
    v_exp_f32 v11, v43
    s_nop 0
    v_add_f32 v26, v26, v8
    v_add_f32 v26, v26, v9
    v_cvt_pk_bf16_f32 v98, v8, v9
    v_add_f32 v26, v26, v10
    v_add_f32 v26, v26, v11
    v_cvt_pk_bf16_f32 v99, v10, v11
    v_exp_f32 v12, v44
    v_exp_f32 v13, v45
    v_exp_f32 v14, v46
    v_exp_f32 v15, v47
    s_nop 0
    v_add_f32 v27, v27, v12
    v_add_f32 v27, v27, v13
    v_cvt_pk_bf16_f32 v106, v12, v13
    v_add_f32 v27, v27, v14
    v_add_f32 v27, v27, v15
    v_cvt_pk_bf16_f32 v107, v14, v15
    v_exp_f32 v8, v48
    v_exp_f32 v9, v49
    v_exp_f32 v10, v50
    v_exp_f32 v11, v51
    s_nop 0
    v_add_f32 v26, v26, v8
    v_add_f32 v26, v26, v9
    v_cvt_pk_bf16_f32 v100, v8, v9
    v_add_f32 v26, v26, v10
    v_add_f32 v26, v26, v11
    v_cvt_pk_bf16_f32 v101, v10, v11
    v_exp_f32 v12, v52
    v_exp_f32 v13, v53
    v_exp_f32 v14, v54
    v_exp_f32 v15, v55
    s_nop 0
    v_add_f32 v27, v27, v12
    v_add_f32 v27, v27, v13
    v_cvt_pk_bf16_f32 v108, v12, v13
    v_add_f32 v27, v27, v14
    v_add_f32 v27, v27, v15
    v_cvt_pk_bf16_f32 v109, v14, v15
    v_exp_f32 v8, v56
    v_exp_f32 v9, v57
    v_exp_f32 v10, v58
    v_exp_f32 v11, v59
    s_nop 0
    v_add_f32 v26, v26, v8
    v_add_f32 v26, v26, v9
    v_cvt_pk_bf16_f32 v102, v8, v9
    v_add_f32 v26, v26, v10
    v_add_f32 v26, v26, v11
    v_cvt_pk_bf16_f32 v103, v10, v11
    v_exp_f32 v12, v60
    v_exp_f32 v13, v61
    v_exp_f32 v14, v62
    v_exp_f32 v15, v63
    s_nop 0
    v_add_f32 v27, v27, v12
    v_add_f32 v27, v27, v13
    v_cvt_pk_bf16_f32 v110, v12, v13
    v_add_f32 v27, v27, v14
    v_add_f32 v27, v27, v15
    v_cvt_pk_bf16_f32 v111, v14, v15
    s_nop 1
    s_setpc_b64 s[30:31]
K2_slow1:
    s_nop 7
    s_nop 7
    v_max3_f32 v28, v64, v65, 0
    v_max3_f32 v28, v66, v67, v28
    v_max3_f32 v28, v72, v73, v28
    v_max3_f32 v28, v74, v75, v28
    v_max3_f32 v28, v80, v81, v28
    v_max3_f32 v28, v82, v83, v28
    v_max3_f32 v28, v88, v89, v28
    v_max3_f32 v28, v90, v91, v28
    v_mov_b32 v29, v28
    s_nop 1
    v_permlane16_swap_b32 v28, v29
    v_max_f32 v28, v28, v29
    v_mov_b32 v29, v28
    s_nop 1
    v_permlane32_swap_b32 v28, v29
    v_max_f32 v28, v28, v29
    v_exp_f32 v29, -v28
    v_sub_f32 v16, v16, v28
    v_sub_f32 v17, v17, v28
    v_sub_f32 v18, v18, v28
    v_sub_f32 v19, v19, v28
    v_mul_f32 v24, v24, v29
    v_mul_f32 v128, v128, v29
    v_mul_f32 v129, v129, v29
    v_mul_f32 v130, v130, v29
    v_mul_f32 v131, v131, v29
    v_mul_f32 v136, v136, v29
    v_mul_f32 v137, v137, v29
    v_mul_f32 v138, v138, v29
    v_mul_f32 v139, v139, v29
    v_mul_f32 v144, v144, v29
    v_mul_f32 v145, v145, v29
    v_mul_f32 v146, v146, v29
    v_mul_f32 v147, v147, v29
    v_mul_f32 v152, v152, v29
    v_mul_f32 v153, v153, v29
    v_mul_f32 v154, v154, v29
    v_mul_f32 v155, v155, v29
    v_mul_f32 v160, v160, v29
    v_mul_f32 v161, v161, v29
    v_mul_f32 v162, v162, v29
    v_mul_f32 v163, v163, v29
    v_mul_f32 v168, v168, v29
    v_mul_f32 v169, v169, v29
    v_mul_f32 v170, v170, v29
    v_mul_f32 v171, v171, v29
    v_mul_f32 v176, v176, v29
    v_mul_f32 v177, v177, v29
    v_mul_f32 v178, v178, v29
    v_mul_f32 v179, v179, v29
    v_mul_f32 v184, v184, v29
    v_mul_f32 v185, v185, v29
    v_mul_f32 v186, v186, v29
    v_mul_f32 v187, v187, v29
    v_mul_f32 v192, v192, v29
    v_mul_f32 v193, v193, v29
    v_mul_f32 v194, v194, v29
    v_mul_f32 v195, v195, v29
    v_mul_f32 v200, v200, v29
    v_mul_f32 v201, v201, v29
    v_mul_f32 v202, v202, v29
    v_mul_f32 v203, v203, v29
    v_mul_f32 v208, v208, v29
    v_mul_f32 v209, v209, v29
    v_mul_f32 v210, v210, v29
    v_mul_f32 v211, v211, v29
    v_mul_f32 v216, v216, v29
    v_mul_f32 v217, v217, v29
    v_mul_f32 v218, v218, v29
    v_mul_f32 v219, v219, v29
    v_mul_f32 v224, v224, v29
    v_mul_f32 v225, v225, v29
    v_mul_f32 v226, v226, v29
    v_mul_f32 v227, v227, v29
    v_mul_f32 v232, v232, v29
    v_mul_f32 v233, v233, v29
    v_mul_f32 v234, v234, v29
    v_mul_f32 v235, v235, v29
    v_mul_f32 v240, v240, v29
    v_mul_f32 v241, v241, v29
    v_mul_f32 v242, v242, v29
    v_mul_f32 v243, v243, v29
    v_mul_f32 v248, v248, v29
    v_mul_f32 v249, v249, v29
    v_mul_f32 v250, v250, v29
    v_mul_f32 v251, v251, v29
    v_sub_f32 v32, v32, v28
    v_sub_f32 v33, v33, v28
    v_sub_f32 v34, v34, v28
    v_sub_f32 v35, v35, v28
    v_sub_f32 v40, v40, v28
    v_sub_f32 v41, v41, v28
    v_sub_f32 v42, v42, v28
    v_sub_f32 v43, v43, v28
    v_sub_f32 v48, v48, v28
    v_sub_f32 v49, v49, v28
    v_sub_f32 v50, v50, v28
    v_sub_f32 v51, v51, v28
    v_sub_f32 v56, v56, v28
    v_sub_f32 v57, v57, v28
    v_sub_f32 v58, v58, v28
    v_sub_f32 v59, v59, v28
    v_sub_f32 v64, v64, v28
    v_sub_f32 v65, v65, v28
    v_sub_f32 v66, v66, v28
    v_sub_f32 v67, v67, v28
    v_sub_f32 v72, v72, v28
    v_sub_f32 v73, v73, v28
    v_sub_f32 v74, v74, v28
    v_sub_f32 v75, v75, v28
    v_sub_f32 v80, v80, v28
    v_sub_f32 v81, v81, v28
    v_sub_f32 v82, v82, v28
    v_sub_f32 v83, v83, v28
    v_sub_f32 v88, v88, v28
    v_sub_f32 v89, v89, v28
    v_sub_f32 v90, v90, v28
    v_sub_f32 v91, v91, v28
    v_max3_f32 v28, v68, v69, 0
    v_max3_f32 v28, v70, v71, v28
    v_max3_f32 v28, v76, v77, v28
    v_max3_f32 v28, v78, v79, v28
    v_max3_f32 v28, v84, v85, v28
    v_max3_f32 v28, v86, v87, v28
    v_max3_f32 v28, v92, v93, v28
    v_max3_f32 v28, v94, v95, v28
    v_mov_b32 v29, v28
    s_nop 1
    v_permlane16_swap_b32 v28, v29
    v_max_f32 v28, v28, v29
    v_mov_b32 v29, v28
    s_nop 1
    v_permlane32_swap_b32 v28, v29
    v_max_f32 v28, v28, v29
    v_exp_f32 v29, -v28
    v_sub_f32 v20, v20, v28
    v_sub_f32 v21, v21, v28
    v_sub_f32 v22, v22, v28
    v_sub_f32 v23, v23, v28
    v_mul_f32 v25, v25, v29
    v_mul_f32 v132, v132, v29
    v_mul_f32 v133, v133, v29
    v_mul_f32 v134, v134, v29
    v_mul_f32 v135, v135, v29
    v_mul_f32 v140, v140, v29
    v_mul_f32 v141, v141, v29
    v_mul_f32 v142, v142, v29
    v_mul_f32 v143, v143, v29
    v_mul_f32 v148, v148, v29
    v_mul_f32 v149, v149, v29
    v_mul_f32 v150, v150, v29
    v_mul_f32 v151, v151, v29
    v_mul_f32 v156, v156, v29
    v_mul_f32 v157, v157, v29
    v_mul_f32 v158, v158, v29
    v_mul_f32 v159, v159, v29
    v_mul_f32 v164, v164, v29
    v_mul_f32 v165, v165, v29
    v_mul_f32 v166, v166, v29
    v_mul_f32 v167, v167, v29
    v_mul_f32 v172, v172, v29
    v_mul_f32 v173, v173, v29
    v_mul_f32 v174, v174, v29
    v_mul_f32 v175, v175, v29
    v_mul_f32 v180, v180, v29
    v_mul_f32 v181, v181, v29
    v_mul_f32 v182, v182, v29
    v_mul_f32 v183, v183, v29
    v_mul_f32 v188, v188, v29
    v_mul_f32 v189, v189, v29
    v_mul_f32 v190, v190, v29
    v_mul_f32 v191, v191, v29
    v_mul_f32 v196, v196, v29
    v_mul_f32 v197, v197, v29
    v_mul_f32 v198, v198, v29
    v_mul_f32 v199, v199, v29
    v_mul_f32 v204, v204, v29
    v_mul_f32 v205, v205, v29
    v_mul_f32 v206, v206, v29
    v_mul_f32 v207, v207, v29
    v_mul_f32 v212, v212, v29
    v_mul_f32 v213, v213, v29
    v_mul_f32 v214, v214, v29
    v_mul_f32 v215, v215, v29
    v_mul_f32 v220, v220, v29
    v_mul_f32 v221, v221, v29
    v_mul_f32 v222, v222, v29
    v_mul_f32 v223, v223, v29
    v_mul_f32 v228, v228, v29
    v_mul_f32 v229, v229, v29
    v_mul_f32 v230, v230, v29
    v_mul_f32 v231, v231, v29
    v_mul_f32 v236, v236, v29
    v_mul_f32 v237, v237, v29
    v_mul_f32 v238, v238, v29
    v_mul_f32 v239, v239, v29
    v_mul_f32 v244, v244, v29
    v_mul_f32 v245, v245, v29
    v_mul_f32 v246, v246, v29
    v_mul_f32 v247, v247, v29
    v_mul_f32 v252, v252, v29
    v_mul_f32 v253, v253, v29
    v_mul_f32 v254, v254, v29
    v_mul_f32 v255, v255, v29
    v_sub_f32 v36, v36, v28
    v_sub_f32 v37, v37, v28
    v_sub_f32 v38, v38, v28
    v_sub_f32 v39, v39, v28
    v_sub_f32 v44, v44, v28
    v_sub_f32 v45, v45, v28
    v_sub_f32 v46, v46, v28
    v_sub_f32 v47, v47, v28
    v_sub_f32 v52, v52, v28
    v_sub_f32 v53, v53, v28
    v_sub_f32 v54, v54, v28
    v_sub_f32 v55, v55, v28
    v_sub_f32 v60, v60, v28
    v_sub_f32 v61, v61, v28
    v_sub_f32 v62, v62, v28
    v_sub_f32 v63, v63, v28
    v_sub_f32 v68, v68, v28
    v_sub_f32 v69, v69, v28
    v_sub_f32 v70, v70, v28
    v_sub_f32 v71, v71, v28
    v_sub_f32 v76, v76, v28
    v_sub_f32 v77, v77, v28
    v_sub_f32 v78, v78, v28
    v_sub_f32 v79, v79, v28
    v_sub_f32 v84, v84, v28
    v_sub_f32 v85, v85, v28
    v_sub_f32 v86, v86, v28
    v_sub_f32 v87, v87, v28
    v_sub_f32 v92, v92, v28
    v_sub_f32 v93, v93, v28
    v_sub_f32 v94, v94, v28
    v_sub_f32 v95, v95, v28
    v_exp_f32 v8, v64
    v_exp_f32 v9, v65
    v_exp_f32 v10, v66
    v_exp_f32 v11, v67
    s_nop 0
    v_add_f32 v26, v8, v9
    v_cvt_pk_bf16_f32 v112, v8, v9
    v_add_f32 v26, v26, v10
    v_add_f32 v26, v26, v11
    v_cvt_pk_bf16_f32 v113, v10, v11
    v_exp_f32 v12, v68
    v_exp_f32 v13, v69
    v_exp_f32 v14, v70
    v_exp_f32 v15, v71
    s_nop 0
    v_add_f32 v27, v12, v13
    v_cvt_pk_bf16_f32 v120, v12, v13
    v_add_f32 v27, v27, v14
    v_add_f32 v27, v27, v15
    v_cvt_pk_bf16_f32 v121, v14, v15
    v_exp_f32 v8, v72
    v_exp_f32 v9, v73
    v_exp_f32 v10, v74
    v_exp_f32 v11, v75
    s_nop 0
    v_add_f32 v26, v26, v8
    v_add_f32 v26, v26, v9
    v_cvt_pk_bf16_f32 v114, v8, v9
    v_add_f32 v26, v26, v10
    v_add_f32 v26, v26, v11
    v_cvt_pk_bf16_f32 v115, v10, v11
    v_exp_f32 v12, v76
    v_exp_f32 v13, v77
    v_exp_f32 v14, v78
    v_exp_f32 v15, v79
    s_nop 0
    v_add_f32 v27, v27, v12
    v_add_f32 v27, v27, v13
    v_cvt_pk_bf16_f32 v122, v12, v13
    v_add_f32 v27, v27, v14
    v_add_f32 v27, v27, v15
    v_cvt_pk_bf16_f32 v123, v14, v15
    v_exp_f32 v8, v80
    v_exp_f32 v9, v81
    v_exp_f32 v10, v82
    v_exp_f32 v11, v83
    s_nop 0
    v_add_f32 v26, v26, v8
    v_add_f32 v26, v26, v9
    v_cvt_pk_bf16_f32 v116, v8, v9
    v_add_f32 v26, v26, v10
    v_add_f32 v26, v26, v11
    v_cvt_pk_bf16_f32 v117, v10, v11
    v_exp_f32 v12, v84
    v_exp_f32 v13, v85
    v_exp_f32 v14, v86
    v_exp_f32 v15, v87
    s_nop 0
    v_add_f32 v27, v27, v12
    v_add_f32 v27, v27, v13
    v_cvt_pk_bf16_f32 v124, v12, v13
    v_add_f32 v27, v27, v14
    v_add_f32 v27, v27, v15
    v_cvt_pk_bf16_f32 v125, v14, v15
    v_exp_f32 v8, v88
    v_exp_f32 v9, v89
    v_exp_f32 v10, v90
    v_exp_f32 v11, v91
    s_nop 0
    v_add_f32 v26, v26, v8
    v_add_f32 v26, v26, v9
    v_cvt_pk_bf16_f32 v118, v8, v9
    v_add_f32 v26, v26, v10
    v_add_f32 v26, v26, v11
    v_cvt_pk_bf16_f32 v119, v10, v11
    v_exp_f32 v12, v92
    v_exp_f32 v13, v93
    v_exp_f32 v14, v94
    v_exp_f32 v15, v95
    s_nop 0
    v_add_f32 v27, v27, v12
    v_add_f32 v27, v27, v13
    v_cvt_pk_bf16_f32 v126, v12, v13
    v_add_f32 v27, v27, v14
    v_add_f32 v27, v27, v15
    v_cvt_pk_bf16_f32 v127, v14, v15
    s_nop 1
    s_setpc_b64 s[30:31]
.globl p3_kernel
.p2align 8
.type p3_kernel,@function
p3_kernel:
    s_cmp_ge_u32 s2, 256
    s_cbranch_scc1 K3_end
    s_load_dwordx4 s[64:67], s[0:1], 88
    s_load_dwordx2 s[68:69], s[0:1], 112
    s_load_dwordx2 s[70:71], s[0:1], 0
    s_load_dwordx4 s[72:75], s[0:1], 32
    v_lshrrev_b32 v1, 6, v0
    s_nop 0
    v_readfirstlane_b32 s16, v1
    s_waitcnt lgkmcnt(0)
    s_mov_b32 s4, s68
    s_mov_b32 s5, s69
    s_mov_b32 s6, 268435456
    s_mov_b32 s7, 0x20000
    s_mov_b32 s12, s66
    s_mov_b32 s13, s67
    s_mov_b32 s14, 3670016
    s_mov_b32 s15, 0x20000
    s_cmp_ge_u32 s2, 224
    s_cbranch_scc1 K3_conv
    s_mov_b32 s8, s64
    s_mov_b32 s9, s65
    s_mov_b32 s10, 3670016
    s_mov_b32 s11, 0x20000
    s_and_b32 s17, s2, 7
    s_lshl_b32 s17, s17, 2
    s_bfe_u32 s19, s2, 0x20003
    s_add_u32 s17, s17, s19
    s_lshr_b32 s18, s2, 5
    v_and_b32 v1, 63, v0
    v_lshlrev_b32 v4, 4, v1
    v_add_u32 v5, 131072, v4
    v_add_u32 v6, 262144, v4
    v_add_u32 v7, 393216, v4
    v_lshrrev_b32 v2, 3, v1
    v_and_b32 v3, 6, v2
    v_and_b32 v16, 7, v1
    v_xor_b32 v3, v3, v16
    v_lshlrev_b32 v3, 4, v3
    v_mul_u32_u24 v2, 896, v2
    v_add_u32 v8, v2, v3
    v_add_u32 v9, 6144, v8
    v_add_u32 v10, 12288, v8
    v_add_u32 v11, 18432, v8
    v_lshrrev_b32 v2, 2, v1
    v_bfe_u32 v3, v1, 3, 2
    v_lshlrev_b32 v3, 5, v3
    v_lshl_add_u32 v2, v2, 7, v3
    v_and_b32 v3, 3, v1
    v_lshl_add_u32 v2, v3, 3, v2
    s_lshl_b32 s23, s16, 15
    v_add_u32 v12, s23, v2
    v_xor_b32 v13, 32, v12
    v_xor_b32 v14, 64, v12
    v_xor_b32 v15, 96, v12
    s_lshl_b32 s20, s17, 19
    s_add_u32 s20, s20, s23
    s_add_u32 s20, s20, 50331648
    s_mul_i32 s21, s16, 917504
    s_lshl_b32 s19, s18, 7
    s_add_u32 s21, s21, s19
    s_add_u32 s22, s21, 28672
    s_add_u32 m0, s23, 0
    buffer_load_dwordx4 a[0:3], v4, s[4:7], s20 offen
    buffer_load_dwordx4 v8, s[8:11], s21 offen offset:0 lds
    buffer_load_dwordx4 v9, s[8:11], s21 offen offset:1024 lds
    buffer_load_dwordx4 v10, s[8:11], s21 offen offset:2048 lds
    buffer_load_dwordx4 v11, s[8:11], s21 offen offset:3072 lds
    s_add_u32 s21, s21, 57344
    buffer_load_dwordx4 a[4:7], v4, s[4:7], s20 offen offset:1024
    buffer_load_dwordx4 a[8:11], v5, s[4:7], s20 offen offset:0
    buffer_load_dwordx4 a[12:15], v5, s[4:7], s20 offen offset:1024
    s_add_u32 m0, s23, 4096
    buffer_load_dwordx4 a[16:19], v6, s[4:7], s20 offen
    buffer_load_dwordx4 v8, s[8:11], s22 offen offset:0 lds
    buffer_load_dwordx4 v9, s[8:11], s22 offen offset:1024 lds
    buffer_load_dwordx4 v10, s[8:11], s22 offen offset:2048 lds
    buffer_load_dwordx4 v11, s[8:11], s22 offen offset:3072 lds
    s_add_u32 s22, s22, 57344
    buffer_load_dwordx4 a[20:23], v6, s[4:7], s20 offen offset:1024
    buffer_load_dwordx4 a[24:27], v7, s[4:7], s20 offen offset:0
    buffer_load_dwordx4 a[28:31], v7, s[4:7], s20 offen offset:1024
    s_add_u32 s20, s20, 2048
    s_add_u32 m0, s23, 8192
    buffer_load_dwordx4 a[32:35], v4, s[4:7], s20 offen
    buffer_load_dwordx4 v8, s[8:11], s21 offen offset:0 lds
    buffer_load_dwordx4 v9, s[8:11], s21 offen offset:1024 lds
    buffer_load_dwordx4 v10, s[8:11], s21 offen offset:2048 lds
    buffer_load_dwordx4 v11, s[8:11], s21 offen offset:3072 lds
    s_add_u32 s21, s21, 57344
    buffer_load_dwordx4 a[36:39], v4, s[4:7], s20 offen offset:1024
    buffer_load_dwordx4 a[40:43], v5, s[4:7], s20 offen offset:0
    buffer_load_dwordx4 a[44:47], v5, s[4:7], s20 offen offset:1024
    s_add_u32 m0, s23, 12288
    buffer_load_dwordx4 a[48:51], v6, s[4:7], s20 offen
    buffer_load_dwordx4 v8, s[8:11], s22 offen offset:0 lds
    buffer_load_dwordx4 v9, s[8:11], s22 offen offset:1024 lds
    buffer_load_dwordx4 v10, s[8:11], s22 offen offset:2048 lds
    buffer_load_dwordx4 v11, s[8:11], s22 offen offset:3072 lds
    s_add_u32 s22, s22, 57344
    buffer_load_dwordx4 a[52:55], v6, s[4:7], s20 offen offset:1024
    buffer_load_dwordx4 a[56:59], v7, s[4:7], s20 offen offset:0
    buffer_load_dwordx4 a[60:63], v7, s[4:7], s20 offen offset:1024
    s_add_u32 s20, s20, 2048
    s_add_u32 m0, s23, 16384
    buffer_load_dwordx4 a[64:67], v4, s[4:7], s20 offen
    buffer_load_dwordx4 v8, s[8:11], s21 offen offset:0 lds
    buffer_load_dwordx4 v9, s[8:11], s21 offen offset:1024 lds
    buffer_load_dwordx4 v10, s[8:11], s21 offen offset:2048 lds
    buffer_load_dwordx4 v11, s[8:11], s21 offen offset:3072 lds
    s_add_u32 s21, s21, 57344
    buffer_load_dwordx4 a[68:71], v4, s[4:7], s20 offen offset:1024
    buffer_load_dwordx4 a[72:75], v5, s[4:7], s20 offen offset:0
    buffer_load_dwordx4 a[76:79], v5, s[4:7], s20 offen offset:1024
    s_add_u32 m0, s23, 20480
    buffer_load_dwordx4 a[80:83], v6, s[4:7], s20 offen
    buffer_load_dwordx4 v8, s[8:11], s22 offen offset:0 lds
    buffer_load_dwordx4 v9, s[8:11], s22 offen offset:1024 lds
    buffer_load_dwordx4 v10, s[8:11], s22 offen offset:2048 lds
    buffer_load_dwordx4 v11, s[8:11], s22 offen offset:3072 lds
    s_add_u32 s22, s22, 57344
    buffer_load_dwordx4 a[84:87], v6, s[4:7], s20 offen offset:1024
    buffer_load_dwordx4 a[88:91], v7, s[4:7], s20 offen offset:0
    buffer_load_dwordx4 a[92:95], v7, s[4:7], s20 offen offset:1024
    s_add_u32 s20, s20, 2048
    s_waitcnt vmcnt(32)
    ds_read_b64_tr_b16 a[128:129], v12 offset:0
    ds_read_b64_tr_b16 a[130:131], v12 offset:2048
    ds_read_b64_tr_b16 a[132:133], v12 offset:4096
    ds_read_b64_tr_b16 a[134:135], v12 offset:6144
    ds_read_b64_tr_b16 a[136:137], v13 offset:0
    ds_read_b64_tr_b16 a[138:139], v13 offset:2048
    ds_read_b64_tr_b16 a[140:141], v13 offset:4096
    ds_read_b64_tr_b16 a[142:143], v13 offset:6144
    ds_read_b64_tr_b16 a[144:145], v14 offset:0
    ds_read_b64_tr_b16 a[146:147], v14 offset:2048
    ds_read_b64_tr_b16 a[148:149], v14 offset:4096
    ds_read_b64_tr_b16 a[150:151], v14 offset:6144
    ds_read_b64_tr_b16 a[152:153], v15 offset:0
    ds_read_b64_tr_b16 a[154:155], v15 offset:2048
    ds_read_b64_tr_b16 a[156:157], v15 offset:4096
    ds_read_b64_tr_b16 a[158:159], v15 offset:6144
    s_waitcnt lgkmcnt(0)
    v_mfma_f32_16x16x32_bf16 v[32:35], a[128:131], a[0:3], 0
    s_add_u32 m0, s23, 24576
    buffer_load_dwordx4 a[96:99], v4, s[4:7], s20 offen
    v_mfma_f32_16x16x32_bf16 v[32:35], a[132:135], a[4:7], v[32:35]
    buffer_load_dwordx4 v8, s[8:11], s21 offen offset:0 lds
    v_mfma_f32_16x16x32_bf16 v[36:39], a[128:131], a[8:11], 0
    buffer_load_dwordx4 v9, s[8:11], s21 offen offset:1024 lds
    v_mfma_f32_16x16x32_bf16 v[36:39], a[132:135], a[12:15], v[36:39]
    buffer_load_dwordx4 v10, s[8:11], s21 offen offset:2048 lds
    v_mfma_f32_16x16x32_bf16 v[40:43], a[128:131], a[16:19], 0
    buffer_load_dwordx4 v11, s[8:11], s21 offen offset:3072 lds
    v_mfma_f32_16x16x32_bf16 v[40:43], a[132:135], a[20:23], v[40:43]
    s_add_u32 s21, s21, 57344
    buffer_load_dwordx4 a[100:103], v4, s[4:7], s20 offen offset:1024
    v_mfma_f32_16x16x32_bf16 v[44:47], a[128:131], a[24:27], 0
    buffer_load_dwordx4 a[104:107], v5, s[4:7], s20 offen offset:0
    v_mfma_f32_16x16x32_bf16 v[44:47], a[132:135], a[28:31], v[44:47]
    buffer_load_dwordx4 a[108:111], v5, s[4:7], s20 offen offset:1024
    v_mfma_f32_16x16x32_bf16 v[48:51], a[136:139], a[0:3], 0
    s_add_u32 m0, s23, 28672
    buffer_load_dwordx4 a[112:115], v6, s[4:7], s20 offen
    v_mfma_f32_16x16x32_bf16 v[48:51], a[140:143], a[4:7], v[48:51]
    buffer_load_dwordx4 v8, s[8:11], s22 offen offset:0 lds
    v_mfma_f32_16x16x32_bf16 v[52:55], a[136:139], a[8:11], 0
    buffer_load_dwordx4 v9, s[8:11], s22 offen offset:1024 lds
    v_mfma_f32_16x16x32_bf16 v[52:55], a[140:143], a[12:15], v[52:55]
    buffer_load_dwordx4 v10, s[8:11], s22 offen offset:2048 lds
    v_mfma_f32_16x16x32_bf16 v[56:59], a[136:139], a[16:19], 0
    buffer_load_dwordx4 v11, s[8:11], s22 offen offset:3072 lds
    v_mfma_f32_16x16x32_bf16 v[56:59], a[140:143], a[20:23], v[56:59]
    s_add_u32 s22, s22, 57344
    buffer_load_dwordx4 a[116:119], v6, s[4:7], s20 offen offset:1024
    v_mfma_f32_16x16x32_bf16 v[60:63], a[136:139], a[24:27], 0
    buffer_load_dwordx4 a[120:123], v7, s[4:7], s20 offen offset:0
    v_mfma_f32_16x16x32_bf16 v[60:63], a[140:143], a[28:31], v[60:63]
    s_waitcnt vmcnt(31)
    buffer_load_dwordx4 a[124:127], v7, s[4:7], s20 offen offset:1024
    v_mfma_f32_16x16x32_bf16 v[64:67], a[144:147], a[0:3], 0
    s_add_u32 s20, s20, 2048
    ds_read_b64_tr_b16 a[160:161], v12 offset:8192
    v_mfma_f32_16x16x32_bf16 v[64:67], a[148:151], a[4:7], v[64:67]
    ds_read_b64_tr_b16 a[162:163], v12 offset:10240
    v_mfma_f32_16x16x32_bf16 v[68:71], a[144:147], a[8:11], 0
    ds_read_b64_tr_b16 a[164:165], v12 offset:12288
    v_mfma_f32_16x16x32_bf16 v[68:71], a[148:151], a[12:15], v[68:71]
    ds_read_b64_tr_b16 a[166:167], v12 offset:14336
    v_mfma_f32_16x16x32_bf16 v[72:75], a[144:147], a[16:19], 0
    ds_read_b64_tr_b16 a[168:169], v13 offset:8192
    v_mfma_f32_16x16x32_bf16 v[72:75], a[148:151], a[20:23], v[72:75]
    ds_read_b64_tr_b16 a[170:171], v13 offset:10240
    v_mfma_f32_16x16x32_bf16 v[76:79], a[144:147], a[24:27], 0
    ds_read_b64_tr_b16 a[172:173], v13 offset:12288
    v_mfma_f32_16x16x32_bf16 v[76:79], a[148:151], a[28:31], v[76:79]
    ds_read_b64_tr_b16 a[174:175], v13 offset:14336
    v_mfma_f32_16x16x32_bf16 v[80:83], a[152:155], a[0:3], 0
    ds_read_b64_tr_b16 a[176:177], v14 offset:8192
    v_mfma_f32_16x16x32_bf16 v[80:83], a[156:159], a[4:7], v[80:83]
    ds_read_b64_tr_b16 a[178:179], v14 offset:10240
    v_mfma_f32_16x16x32_bf16 v[84:87], a[152:155], a[8:11], 0
    ds_read_b64_tr_b16 a[180:181], v14 offset:12288
    v_mfma_f32_16x16x32_bf16 v[84:87], a[156:159], a[12:15], v[84:87]
    ds_read_b64_tr_b16 a[182:183], v14 offset:14336
    v_mfma_f32_16x16x32_bf16 v[88:91], a[152:155], a[16:19], 0
    ds_read_b64_tr_b16 a[184:185], v15 offset:8192
    v_mfma_f32_16x16x32_bf16 v[88:91], a[156:159], a[20:23], v[88:91]
    ds_read_b64_tr_b16 a[186:187], v15 offset:10240
    v_mfma_f32_16x16x32_bf16 v[92:95], a[152:155], a[24:27], 0
    ds_read_b64_tr_b16 a[188:189], v15 offset:12288
    v_mfma_f32_16x16x32_bf16 v[92:95], a[156:159], a[28:31], v[92:95]
    s_waitcnt lgkmcnt(11)
    ds_read_b64_tr_b16 a[190:191], v15 offset:14336
    v_mfma_f32_16x16x32_bf16 v[32:35], a[160:163], a[32:35], v[32:35]
    s_add_u32 m0, s23, 0
    buffer_load_dwordx4 a[0:3], v4, s[4:7], s20 offen
    v_mfma_f32_16x16x32_bf16 v[32:35], a[164:167], a[36:39], v[32:35]
    buffer_load_dwordx4 v8, s[8:11], s21 offen offset:0 lds
    v_mfma_f32_16x16x32_bf16 v[36:39], a[160:163], a[40:43], v[36:39]
    buffer_load_dwordx4 v9, s[8:11], s21 offen offset:1024 lds
    v_mfma_f32_16x16x32_bf16 v[36:39], a[164:167], a[44:47], v[36:39]
    buffer_load_dwordx4 v10, s[8:11], s21 offen offset:2048 lds
    v_mfma_f32_16x16x32_bf16 v[40:43], a[160:163], a[48:51], v[40:43]
    buffer_load_dwordx4 v11, s[8:11], s21 offen offset:3072 lds
    v_mfma_f32_16x16x32_bf16 v[40:43], a[164:167], a[52:55], v[40:43]
    s_add_u32 s21, s21, 57344
    buffer_load_dwordx4 a[4:7], v4, s[4:7], s20 offen offset:1024
    v_mfma_f32_16x16x32_bf16 v[44:47], a[160:163], a[56:59], v[44:47]
    buffer_load_dwordx4 a[8:11], v5, s[4:7], s20 offen offset:0
    v_mfma_f32_16x16x32_bf16 v[44:47], a[164:167], a[60:63], v[44:47]
    s_waitcnt lgkmcnt(8)
    buffer_load_dwordx4 a[12:15], v5, s[4:7], s20 offen offset:1024
    v_mfma_f32_16x16x32_bf16 v[48:51], a[168:171], a[32:35], v[48:51]
    s_add_u32 m0, s23, 4096
    buffer_load_dwordx4 a[16:19], v6, s[4:7], s20 offen
    v_mfma_f32_16x16x32_bf16 v[48:51], a[172:175], a[36:39], v[48:51]
    buffer_load_dwordx4 v8, s[8:11], s22 offen offset:0 lds
    v_mfma_f32_16x16x32_bf16 v[52:55], a[168:171], a[40:43], v[52:55]
    buffer_load_dwordx4 v9, s[8:11], s22 offen offset:1024 lds
    v_mfma_f32_16x16x32_bf16 v[52:55], a[172:175], a[44:47], v[52:55]
    buffer_load_dwordx4 v10, s[8:11], s22 offen offset:2048 lds
    v_mfma_f32_16x16x32_bf16 v[56:59], a[168:171], a[48:51], v[56:59]
    buffer_load_dwordx4 v11, s[8:11], s22 offen offset:3072 lds
    v_mfma_f32_16x16x32_bf16 v[56:59], a[172:175], a[52:55], v[56:59]
    s_add_u32 s22, s22, 57344
    buffer_load_dwordx4 a[20:23], v6, s[4:7], s20 offen offset:1024
    v_mfma_f32_16x16x32_bf16 v[60:63], a[168:171], a[56:59], v[60:63]
    buffer_load_dwordx4 a[24:27], v7, s[4:7], s20 offen offset:0
    v_mfma_f32_16x16x32_bf16 v[60:63], a[172:175], a[60:63], v[60:63]
    s_waitcnt vmcnt(31) lgkmcnt(6)
    buffer_load_dwordx4 a[28:31], v7, s[4:7], s20 offen offset:1024
    v_mfma_f32_16x16x32_bf16 v[64:67], a[176:179], a[32:35], v[64:67]
    s_waitcnt lgkmcnt(4)
    s_add_u32 s20, s20, 2048
    ds_read_b64_tr_b16 a[128:129], v12 offset:16384
    v_mfma_f32_16x16x32_bf16 v[64:67], a[180:183], a[36:39], v[64:67]
    ds_read_b64_tr_b16 a[130:131], v12 offset:18432
    v_mfma_f32_16x16x32_bf16 v[68:71], a[176:179], a[40:43], v[68:71]
    ds_read_b64_tr_b16 a[132:133], v12 offset:20480
    v_mfma_f32_16x16x32_bf16 v[68:71], a[180:183], a[44:47], v[68:71]
    ds_read_b64_tr_b16 a[134:135], v12 offset:22528
    v_mfma_f32_16x16x32_bf16 v[72:75], a[176:179], a[48:51], v[72:75]
    ds_read_b64_tr_b16 a[136:137], v13 offset:16384
    v_mfma_f32_16x16x32_bf16 v[72:75], a[180:183], a[52:55], v[72:75]
    ds_read_b64_tr_b16 a[138:139], v13 offset:18432
    v_mfma_f32_16x16x32_bf16 v[76:79], a[176:179], a[56:59], v[76:79]
    ds_read_b64_tr_b16 a[140:141], v13 offset:20480
    v_mfma_f32_16x16x32_bf16 v[76:79], a[180:183], a[60:63], v[76:79]
    s_waitcnt lgkmcnt(9)
    ds_read_b64_tr_b16 a[142:143], v13 offset:22528
    v_mfma_f32_16x16x32_bf16 v[80:83], a[184:187], a[32:35], v[80:83]
    s_waitcnt lgkmcnt(8)
    ds_read_b64_tr_b16 a[144:145], v14 offset:16384
    v_mfma_f32_16x16x32_bf16 v[80:83], a[188:191], a[36:39], v[80:83]
    ds_read_b64_tr_b16 a[146:147], v14 offset:18432
    v_mfma_f32_16x16x32_bf16 v[84:87], a[184:187], a[40:43], v[84:87]
    ds_read_b64_tr_b16 a[148:149], v14 offset:20480
    v_mfma_f32_16x16x32_bf16 v[84:87], a[188:191], a[44:47], v[84:87]
    ds_read_b64_tr_b16 a[150:151], v14 offset:22528
    v_mfma_f32_16x16x32_bf16 v[88:91], a[184:187], a[48:51], v[88:91]
    ds_read_b64_tr_b16 a[152:153], v15 offset:16384
    v_mfma_f32_16x16x32_bf16 v[88:91], a[188:191], a[52:55], v[88:91]
    ds_read_b64_tr_b16 a[154:155], v15 offset:18432
    v_mfma_f32_16x16x32_bf16 v[92:95], a[184:187], a[56:59], v[92:95]
    ds_read_b64_tr_b16 a[156:157], v15 offset:20480
    v_mfma_f32_16x16x32_bf16 v[92:95], a[188:191], a[60:63], v[92:95]
    s_waitcnt lgkmcnt(11)
    ds_read_b64_tr_b16 a[158:159], v15 offset:22528
    v_mfma_f32_16x16x32_bf16 v[32:35], a[128:131], a[64:67], v[32:35]
    s_add_u32 m0, s23, 8192
    buffer_load_dwordx4 a[32:35], v4, s[4:7], s20 offen
    v_mfma_f32_16x16x32_bf16 v[32:35], a[132:135], a[68:71], v[32:35]
    buffer_load_dwordx4 v8, s[8:11], s21 offen offset:0 lds
    v_mfma_f32_16x16x32_bf16 v[36:39], a[128:131], a[72:75], v[36:39]
    buffer_load_dwordx4 v9, s[8:11], s21 offen offset:1024 lds
    v_mfma_f32_16x16x32_bf16 v[36:39], a[132:135], a[76:79], v[36:39]
    buffer_load_dwordx4 v10, s[8:11], s21 offen offset:2048 lds
    v_mfma_f32_16x16x32_bf16 v[40:43], a[128:131], a[80:83], v[40:43]
    buffer_load_dwordx4 v11, s[8:11], s21 offen offset:3072 lds
    v_mfma_f32_16x16x32_bf16 v[40:43], a[132:135], a[84:87], v[40:43]
    s_add_u32 s21, s21, 57344
    buffer_load_dwordx4 a[36:39], v4, s[4:7], s20 offen offset:1024
    v_mfma_f32_16x16x32_bf16 v[44:47], a[128:131], a[88:91], v[44:47]
    buffer_load_dwordx4 a[40:43], v5, s[4:7], s20 offen offset:0
    v_mfma_f32_16x16x32_bf16 v[44:47], a[132:135], a[92:95], v[44:47]
    s_waitcnt lgkmcnt(8)
    buffer_load_dwordx4 a[44:47], v5, s[4:7], s20 offen offset:1024
    v_mfma_f32_16x16x32_bf16 v[48:51], a[136:139], a[64:67], v[48:51]
    s_add_u32 m0, s23, 12288
    buffer_load_dwordx4 a[48:51], v6, s[4:7], s20 offen
    v_mfma_f32_16x16x32_bf16 v[48:51], a[140:143], a[68:71], v[48:51]
    buffer_load_dwordx4 v8, s[8:11], s22 offen offset:0 lds
    v_mfma_f32_16x16x32_bf16 v[52:55], a[136:139], a[72:75], v[52:55]
    buffer_load_dwordx4 v9, s[8:11], s22 offen offset:1024 lds
    v_mfma_f32_16x16x32_bf16 v[52:55], a[140:143], a[76:79], v[52:55]
    buffer_load_dwordx4 v10, s[8:11], s22 offen offset:2048 lds
    v_mfma_f32_16x16x32_bf16 v[56:59], a[136:139], a[80:83], v[56:59]
    buffer_load_dwordx4 v11, s[8:11], s22 offen offset:3072 lds
    v_mfma_f32_16x16x32_bf16 v[56:59], a[140:143], a[84:87], v[56:59]
    s_add_u32 s22, s22, 57344
    buffer_load_dwordx4 a[52:55], v6, s[4:7], s20 offen offset:1024
    v_mfma_f32_16x16x32_bf16 v[60:63], a[136:139], a[88:91], v[60:63]
    buffer_load_dwordx4 a[56:59], v7, s[4:7], s20 offen offset:0
    v_mfma_f32_16x16x32_bf16 v[60:63], a[140:143], a[92:95], v[60:63]
    s_waitcnt vmcnt(31) lgkmcnt(6)
    buffer_load_dwordx4 a[60:63], v7, s[4:7], s20 offen offset:1024
    v_mfma_f32_16x16x32_bf16 v[64:67], a[144:147], a[64:67], v[64:67]
    s_waitcnt lgkmcnt(4)
    s_add_u32 s20, s20, 2048
    ds_read_b64_tr_b16 a[160:161], v12 offset:24576
    v_mfma_f32_16x16x32_bf16 v[64:67], a[148:151], a[68:71], v[64:67]
    ds_read_b64_tr_b16 a[162:163], v12 offset:26624
    v_mfma_f32_16x16x32_bf16 v[68:71], a[144:147], a[72:75], v[68:71]
    ds_read_b64_tr_b16 a[164:165], v12 offset:28672
    v_mfma_f32_16x16x32_bf16 v[68:71], a[148:151], a[76:79], v[68:71]
    ds_read_b64_tr_b16 a[166:167], v12 offset:30720
    v_mfma_f32_16x16x32_bf16 v[72:75], a[144:147], a[80:83], v[72:75]
    ds_read_b64_tr_b16 a[168:169], v13 offset:24576
    v_mfma_f32_16x16x32_bf16 v[72:75], a[148:151], a[84:87], v[72:75]
    ds_read_b64_tr_b16 a[170:171], v13 offset:26624
    v_mfma_f32_16x16x32_bf16 v[76:79], a[144:147], a[88:91], v[76:79]
    ds_read_b64_tr_b16 a[172:173], v13 offset:28672
    v_mfma_f32_16x16x32_bf16 v[76:79], a[148:151], a[92:95], v[76:79]
    s_waitcnt lgkmcnt(9)
    ds_read_b64_tr_b16 a[174:175], v13 offset:30720
    v_mfma_f32_16x16x32_bf16 v[80:83], a[152:155], a[64:67], v[80:83]
    s_waitcnt lgkmcnt(8)
    ds_read_b64_tr_b16 a[176:177], v14 offset:24576
    v_mfma_f32_16x16x32_bf16 v[80:83], a[156:159], a[68:71], v[80:83]
    ds_read_b64_tr_b16 a[178:179], v14 offset:26624
    v_mfma_f32_16x16x32_bf16 v[84:87], a[152:155], a[72:75], v[84:87]
    ds_read_b64_tr_b16 a[180:181], v14 offset:28672
    v_mfma_f32_16x16x32_bf16 v[84:87], a[156:159], a[76:79], v[84:87]
    ds_read_b64_tr_b16 a[182:183], v14 offset:30720
    v_mfma_f32_16x16x32_bf16 v[88:91], a[152:155], a[80:83], v[88:91]
    ds_read_b64_tr_b16 a[184:185], v15 offset:24576
    v_mfma_f32_16x16x32_bf16 v[88:91], a[156:159], a[84:87], v[88:91]
    ds_read_b64_tr_b16 a[186:187], v15 offset:26624
    v_mfma_f32_16x16x32_bf16 v[92:95], a[152:155], a[88:91], v[92:95]
    ds_read_b64_tr_b16 a[188:189], v15 offset:28672
    v_mfma_f32_16x16x32_bf16 v[92:95], a[156:159], a[92:95], v[92:95]
    s_waitcnt lgkmcnt(11)
    ds_read_b64_tr_b16 a[190:191], v15 offset:30720
    v_mfma_f32_16x16x32_bf16 v[32:35], a[160:163], a[96:99], v[32:35]
    s_add_u32 m0, s23, 16384
    buffer_load_dwordx4 a[64:67], v4, s[4:7], s20 offen
    v_mfma_f32_16x16x32_bf16 v[32:35], a[164:167], a[100:103], v[32:35]
    buffer_load_dwordx4 v8, s[8:11], s21 offen offset:0 lds
    v_mfma_f32_16x16x32_bf16 v[36:39], a[160:163], a[104:107], v[36:39]
    buffer_load_dwordx4 v9, s[8:11], s21 offen offset:1024 lds
    v_mfma_f32_16x16x32_bf16 v[36:39], a[164:167], a[108:111], v[36:39]
    buffer_load_dwordx4 v10, s[8:11], s21 offen offset:2048 lds
    v_mfma_f32_16x16x32_bf16 v[40:43], a[160:163], a[112:115], v[40:43]
    buffer_load_dwordx4 v11, s[8:11], s21 offen offset:3072 lds
    v_mfma_f32_16x16x32_bf16 v[40:43], a[164:167], a[116:119], v[40:43]
    s_add_u32 s21, s21, 57344
    buffer_load_dwordx4 a[68:71], v4, s[4:7], s20 offen offset:1024
    v_mfma_f32_16x16x32_bf16 v[44:47], a[160:163], a[120:123], v[44:47]
    buffer_load_dwordx4 a[72:75], v5, s[4:7], s20 offen offset:0
    v_mfma_f32_16x16x32_bf16 v[44:47], a[164:167], a[124:127], v[44:47]
    s_waitcnt lgkmcnt(8)
    buffer_load_dwordx4 a[76:79], v5, s[4:7], s20 offen offset:1024
    v_mfma_f32_16x16x32_bf16 v[48:51], a[168:171], a[96:99], v[48:51]
    s_add_u32 m0, s23, 20480
    buffer_load_dwordx4 a[80:83], v6, s[4:7], s20 offen
    v_mfma_f32_16x16x32_bf16 v[48:51], a[172:175], a[100:103], v[48:51]
    buffer_load_dwordx4 v8, s[8:11], s22 offen offset:0 lds
    v_mfma_f32_16x16x32_bf16 v[52:55], a[168:171], a[104:107], v[52:55]
    buffer_load_dwordx4 v9, s[8:11], s22 offen offset:1024 lds
    v_mfma_f32_16x16x32_bf16 v[52:55], a[172:175], a[108:111], v[52:55]
    buffer_load_dwordx4 v10, s[8:11], s22 offen offset:2048 lds
    v_mfma_f32_16x16x32_bf16 v[56:59], a[168:171], a[112:115], v[56:59]
    buffer_load_dwordx4 v11, s[8:11], s22 offen offset:3072 lds
    v_mfma_f32_16x16x32_bf16 v[56:59], a[172:175], a[116:119], v[56:59]
    s_add_u32 s22, s22, 57344
    buffer_load_dwordx4 a[84:87], v6, s[4:7], s20 offen offset:1024
    v_mfma_f32_16x16x32_bf16 v[60:63], a[168:171], a[120:123], v[60:63]
    buffer_load_dwordx4 a[88:91], v7, s[4:7], s20 offen offset:0
    v_mfma_f32_16x16x32_bf16 v[60:63], a[172:175], a[124:127], v[60:63]
    s_waitcnt vmcnt(31) lgkmcnt(6)
    buffer_load_dwordx4 a[92:95], v7, s[4:7], s20 offen offset:1024
    v_mfma_f32_16x16x32_bf16 v[64:67], a[176:179], a[96:99], v[64:67]
    s_waitcnt lgkmcnt(4)
    s_add_u32 s20, s20, 2048
    ds_read_b64_tr_b16 a[128:129], v12 offset:0
    v_mfma_f32_16x16x32_bf16 v[64:67], a[180:183], a[100:103], v[64:67]
    ds_read_b64_tr_b16 a[130:131], v12 offset:2048
    v_mfma_f32_16x16x32_bf16 v[68:71], a[176:179], a[104:107], v[68:71]
    ds_read_b64_tr_b16 a[132:133], v12 offset:4096
    v_mfma_f32_16x16x32_bf16 v[68:71], a[180:183], a[108:111], v[68:71]
    ds_read_b64_tr_b16 a[134:135], v12 offset:6144
    v_mfma_f32_16x16x32_bf16 v[72:75], a[176:179], a[112:115], v[72:75]
    ds_read_b64_tr_b16 a[136:137], v13 offset:0
    v_mfma_f32_16x16x32_bf16 v[72:75], a[180:183], a[116:119], v[72:75]
    ds_read_b64_tr_b16 a[138:139], v13 offset:2048
    v_mfma_f32_16x16x32_bf16 v[76:79], a[176:179], a[120:123], v[76:79]
    ds_read_b64_tr_b16 a[140:141], v13 offset:4096
    v_mfma_f32_16x16x32_bf16 v[76:79], a[180:183], a[124:127], v[76:79]
    s_waitcnt lgkmcnt(9)
    ds_read_b64_tr_b16 a[142:143], v13 offset:6144
    v_mfma_f32_16x16x32_bf16 v[80:83], a[184:187], a[96:99], v[80:83]
    s_waitcnt lgkmcnt(8)
    ds_read_b64_tr_b16 a[144:145], v14 offset:0
    v_mfma_f32_16x16x32_bf16 v[80:83], a[188:191], a[100:103], v[80:83]
    ds_read_b64_tr_b16 a[146:147], v14 offset:2048
    v_mfma_f32_16x16x32_bf16 v[84:87], a[184:187], a[104:107], v[84:87]
    ds_read_b64_tr_b16 a[148:149], v14 offset:4096
    v_mfma_f32_16x16x32_bf16 v[84:87], a[188:191], a[108:111], v[84:87]
    ds_read_b64_tr_b16 a[150:151], v14 offset:6144
    v_mfma_f32_16x16x32_bf16 v[88:91], a[184:187], a[112:115], v[88:91]
    ds_read_b64_tr_b16 a[152:153], v15 offset:0
    v_mfma_f32_16x16x32_bf16 v[88:91], a[188:191], a[116:119], v[88:91]
    ds_read_b64_tr_b16 a[154:155], v15 offset:2048
    v_mfma_f32_16x16x32_bf16 v[92:95], a[184:187], a[120:123], v[92:95]
    ds_read_b64_tr_b16 a[156:157], v15 offset:4096
    v_mfma_f32_16x16x32_bf16 v[92:95], a[188:191], a[124:127], v[92:95]
    s_waitcnt lgkmcnt(11)
    ds_read_b64_tr_b16 a[158:159], v15 offset:6144
    v_mfma_f32_16x16x32_bf16 v[32:35], a[128:131], a[0:3], v[32:35]
    s_add_u32 m0, s23, 24576
    buffer_load_dwordx4 a[96:99], v4, s[4:7], s20 offen
    v_mfma_f32_16x16x32_bf16 v[32:35], a[132:135], a[4:7], v[32:35]
    buffer_load_dwordx4 v8, s[8:11], s21 offen offset:0 lds
    v_mfma_f32_16x16x32_bf16 v[36:39], a[128:131], a[8:11], v[36:39]
    buffer_load_dwordx4 v9, s[8:11], s21 offen offset:1024 lds
    v_mfma_f32_16x16x32_bf16 v[36:39], a[132:135], a[12:15], v[36:39]
    buffer_load_dwordx4 v10, s[8:11], s21 offen offset:2048 lds
    v_mfma_f32_16x16x32_bf16 v[40:43], a[128:131], a[16:19], v[40:43]
    buffer_load_dwordx4 v11, s[8:11], s21 offen offset:3072 lds
    v_mfma_f32_16x16x32_bf16 v[40:43], a[132:135], a[20:23], v[40:43]
    s_add_u32 s21, s21, 57344
    buffer_load_dwordx4 a[100:103], v4, s[4:7], s20 offen offset:1024
    v_mfma_f32_16x16x32_bf16 v[44:47], a[128:131], a[24:27], v[44:47]
    buffer_load_dwordx4 a[104:107], v5, s[4:7], s20 offen offset:0
    v_mfma_f32_16x16x32_bf16 v[44:47], a[132:135], a[28:31], v[44:47]
    s_waitcnt lgkmcnt(8)
    buffer_load_dwordx4 a[108:111], v5, s[4:7], s20 offen offset:1024
    v_mfma_f32_16x16x32_bf16 v[48:51], a[136:139], a[0:3], v[48:51]
    s_add_u32 m0, s23, 28672
    buffer_load_dwordx4 a[112:115], v6, s[4:7], s20 offen
    v_mfma_f32_16x16x32_bf16 v[48:51], a[140:143], a[4:7], v[48:51]
    buffer_load_dwordx4 v8, s[8:11], s22 offen offset:0 lds
    v_mfma_f32_16x16x32_bf16 v[52:55], a[136:139], a[8:11], v[52:55]
    buffer_load_dwordx4 v9, s[8:11], s22 offen offset:1024 lds
    v_mfma_f32_16x16x32_bf16 v[52:55], a[140:143], a[12:15], v[52:55]
    buffer_load_dwordx4 v10, s[8:11], s22 offen offset:2048 lds
    v_mfma_f32_16x16x32_bf16 v[56:59], a[136:139], a[16:19], v[56:59]
    buffer_load_dwordx4 v11, s[8:11], s22 offen offset:3072 lds
    v_mfma_f32_16x16x32_bf16 v[56:59], a[140:143], a[20:23], v[56:59]
    s_add_u32 s22, s22, 57344
    buffer_load_dwordx4 a[116:119], v6, s[4:7], s20 offen offset:1024
    v_mfma_f32_16x16x32_bf16 v[60:63], a[136:139], a[24:27], v[60:63]
    buffer_load_dwordx4 a[120:123], v7, s[4:7], s20 offen offset:0
    v_mfma_f32_16x16x32_bf16 v[60:63], a[140:143], a[28:31], v[60:63]
    s_waitcnt vmcnt(31) lgkmcnt(6)
    buffer_load_dwordx4 a[124:127], v7, s[4:7], s20 offen offset:1024
    v_mfma_f32_16x16x32_bf16 v[64:67], a[144:147], a[0:3], v[64:67]
    s_waitcnt lgkmcnt(4)
    s_add_u32 s20, s20, 2048
    ds_read_b64_tr_b16 a[160:161], v12 offset:8192
    v_mfma_f32_16x16x32_bf16 v[64:67], a[148:151], a[4:7], v[64:67]
    ds_read_b64_tr_b16 a[162:163], v12 offset:10240
    v_mfma_f32_16x16x32_bf16 v[68:71], a[144:147], a[8:11], v[68:71]
    ds_read_b64_tr_b16 a[164:165], v12 offset:12288
    v_mfma_f32_16x16x32_bf16 v[68:71], a[148:151], a[12:15], v[68:71]
    ds_read_b64_tr_b16 a[166:167], v12 offset:14336
    v_mfma_f32_16x16x32_bf16 v[72:75], a[144:147], a[16:19], v[72:75]
    ds_read_b64_tr_b16 a[168:169], v13 offset:8192
    v_mfma_f32_16x16x32_bf16 v[72:75], a[148:151], a[20:23], v[72:75]
    ds_read_b64_tr_b16 a[170:171], v13 offset:10240
    v_mfma_f32_16x16x32_bf16 v[76:79], a[144:147], a[24:27], v[76:79]
    ds_read_b64_tr_b16 a[172:173], v13 offset:12288
    v_mfma_f32_16x16x32_bf16 v[76:79], a[148:151], a[28:31], v[76:79]
    s_waitcnt lgkmcnt(9)
    ds_read_b64_tr_b16 a[174:175], v13 offset:14336
    v_mfma_f32_16x16x32_bf16 v[80:83], a[152:155], a[0:3], v[80:83]
    s_waitcnt lgkmcnt(8)
    ds_read_b64_tr_b16 a[176:177], v14 offset:8192
    v_mfma_f32_16x16x32_bf16 v[80:83], a[156:159], a[4:7], v[80:83]
    ds_read_b64_tr_b16 a[178:179], v14 offset:10240
    v_mfma_f32_16x16x32_bf16 v[84:87], a[152:155], a[8:11], v[84:87]
    ds_read_b64_tr_b16 a[180:181], v14 offset:12288
    v_mfma_f32_16x16x32_bf16 v[84:87], a[156:159], a[12:15], v[84:87]
    ds_read_b64_tr_b16 a[182:183], v14 offset:14336
    v_mfma_f32_16x16x32_bf16 v[88:91], a[152:155], a[16:19], v[88:91]
    ds_read_b64_tr_b16 a[184:185], v15 offset:8192
    v_mfma_f32_16x16x32_bf16 v[88:91], a[156:159], a[20:23], v[88:91]
    ds_read_b64_tr_b16 a[186:187], v15 offset:10240
    v_mfma_f32_16x16x32_bf16 v[92:95], a[152:155], a[24:27], v[92:95]
    ds_read_b64_tr_b16 a[188:189], v15 offset:12288
    v_mfma_f32_16x16x32_bf16 v[92:95], a[156:159], a[28:31], v[92:95]
    s_waitcnt lgkmcnt(11)
    ds_read_b64_tr_b16 a[190:191], v15 offset:14336
    v_mfma_f32_16x16x32_bf16 v[32:35], a[160:163], a[32:35], v[32:35]
    s_add_u32 m0, s23, 0
    buffer_load_dwordx4 a[0:3], v4, s[4:7], s20 offen
    v_mfma_f32_16x16x32_bf16 v[32:35], a[164:167], a[36:39], v[32:35]
    buffer_load_dwordx4 v8, s[8:11], s21 offen offset:0 lds
    v_mfma_f32_16x16x32_bf16 v[36:39], a[160:163], a[40:43], v[36:39]
    buffer_load_dwordx4 v9, s[8:11], s21 offen offset:1024 lds
    v_mfma_f32_16x16x32_bf16 v[36:39], a[164:167], a[44:47], v[36:39]
    buffer_load_dwordx4 v10, s[8:11], s21 offen offset:2048 lds
    v_mfma_f32_16x16x32_bf16 v[40:43], a[160:163], a[48:51], v[40:43]
    buffer_load_dwordx4 v11, s[8:11], s21 offen offset:3072 lds
    v_mfma_f32_16x16x32_bf16 v[40:43], a[164:167], a[52:55], v[40:43]
    s_add_u32 s21, s21, 57344
    buffer_load_dwordx4 a[4:7], v4, s[4:7], s20 offen offset:1024
    v_mfma_f32_16x16x32_bf16 v[44:47], a[160:163], a[56:59], v[44:47]
    buffer_load_dwordx4 a[8:11], v5, s[4:7], s20 offen offset:0
    v_mfma_f32_16x16x32_bf16 v[44:47], a[164:167], a[60:63], v[44:47]
    s_waitcnt lgkmcnt(8)
    buffer_load_dwordx4 a[12:15], v5, s[4:7], s20 offen offset:1024
    v_mfma_f32_16x16x32_bf16 v[48:51], a[168:171], a[32:35], v[48:51]
    s_add_u32 m0, s23, 4096
    buffer_load_dwordx4 a[16:19], v6, s[4:7], s20 offen
    v_mfma_f32_16x16x32_bf16 v[48:51], a[172:175], a[36:39], v[48:51]
    buffer_load_dwordx4 v8, s[8:11], s22 offen offset:0 lds
    v_mfma_f32_16x16x32_bf16 v[52:55], a[168:171], a[40:43], v[52:55]
    buffer_load_dwordx4 v9, s[8:11], s22 offen offset:1024 lds
    v_mfma_f32_16x16x32_bf16 v[52:55], a[172:175], a[44:47], v[52:55]
    buffer_load_dwordx4 v10, s[8:11], s22 offen offset:2048 lds
    v_mfma_f32_16x16x32_bf16 v[56:59], a[168:171], a[48:51], v[56:59]
    buffer_load_dwordx4 v11, s[8:11], s22 offen offset:3072 lds
    v_mfma_f32_16x16x32_bf16 v[56:59], a[172:175], a[52:55], v[56:59]
    s_add_u32 s22, s22, 57344
    buffer_load_dwordx4 a[20:23], v6, s[4:7], s20 offen offset:1024
    v_mfma_f32_16x16x32_bf16 v[60:63], a[168:171], a[56:59], v[60:63]
    buffer_load_dwordx4 a[24:27], v7, s[4:7], s20 offen offset:0
    v_mfma_f32_16x16x32_bf16 v[60:63], a[172:175], a[60:63], v[60:63]
    s_waitcnt vmcnt(31) lgkmcnt(6)
    buffer_load_dwordx4 a[28:31], v7, s[4:7], s20 offen offset:1024
    v_mfma_f32_16x16x32_bf16 v[64:67], a[176:179], a[32:35], v[64:67]
    s_waitcnt lgkmcnt(4)
    s_add_u32 s20, s20, 2048
    ds_read_b64_tr_b16 a[128:129], v12 offset:16384
    v_mfma_f32_16x16x32_bf16 v[64:67], a[180:183], a[36:39], v[64:67]
    ds_read_b64_tr_b16 a[130:131], v12 offset:18432
    v_mfma_f32_16x16x32_bf16 v[68:71], a[176:179], a[40:43], v[68:71]
    ds_read_b64_tr_b16 a[132:133], v12 offset:20480
    v_mfma_f32_16x16x32_bf16 v[68:71], a[180:183], a[44:47], v[68:71]
    ds_read_b64_tr_b16 a[134:135], v12 offset:22528
    v_mfma_f32_16x16x32_bf16 v[72:75], a[176:179], a[48:51], v[72:75]
    ds_read_b64_tr_b16 a[136:137], v13 offset:16384
    v_mfma_f32_16x16x32_bf16 v[72:75], a[180:183], a[52:55], v[72:75]
    ds_read_b64_tr_b16 a[138:139], v13 offset:18432
    v_mfma_f32_16x16x32_bf16 v[76:79], a[176:179], a[56:59], v[76:79]
    ds_read_b64_tr_b16 a[140:141], v13 offset:20480
    v_mfma_f32_16x16x32_bf16 v[76:79], a[180:183], a[60:63], v[76:79]
    s_waitcnt lgkmcnt(9)
    ds_read_b64_tr_b16 a[142:143], v13 offset:22528
    v_mfma_f32_16x16x32_bf16 v[80:83], a[184:187], a[32:35], v[80:83]
    s_waitcnt lgkmcnt(8)
    ds_read_b64_tr_b16 a[144:145], v14 offset:16384
    v_mfma_f32_16x16x32_bf16 v[80:83], a[188:191], a[36:39], v[80:83]
    ds_read_b64_tr_b16 a[146:147], v14 offset:18432
    v_mfma_f32_16x16x32_bf16 v[84:87], a[184:187], a[40:43], v[84:87]
    ds_read_b64_tr_b16 a[148:149], v14 offset:20480
    v_mfma_f32_16x16x32_bf16 v[84:87], a[188:191], a[44:47], v[84:87]
    ds_read_b64_tr_b16 a[150:151], v14 offset:22528
    v_mfma_f32_16x16x32_bf16 v[88:91], a[184:187], a[48:51], v[88:91]
    ds_read_b64_tr_b16 a[152:153], v15 offset:16384
    v_mfma_f32_16x16x32_bf16 v[88:91], a[188:191], a[52:55], v[88:91]
    ds_read_b64_tr_b16 a[154:155], v15 offset:18432
    v_mfma_f32_16x16x32_bf16 v[92:95], a[184:187], a[56:59], v[92:95]
    ds_read_b64_tr_b16 a[156:157], v15 offset:20480
    v_mfma_f32_16x16x32_bf16 v[92:95], a[188:191], a[60:63], v[92:95]
    s_waitcnt lgkmcnt(11)
    ds_read_b64_tr_b16 a[158:159], v15 offset:22528
    v_mfma_f32_16x16x32_bf16 v[32:35], a[128:131], a[64:67], v[32:35]
    s_add_u32 m0, s23, 8192
    buffer_load_dwordx4 a[32:35], v4, s[4:7], s20 offen
    v_mfma_f32_16x16x32_bf16 v[32:35], a[132:135], a[68:71], v[32:35]
    buffer_load_dwordx4 v8, s[8:11], s21 offen offset:0 lds
    v_mfma_f32_16x16x32_bf16 v[36:39], a[128:131], a[72:75], v[36:39]
    buffer_load_dwordx4 v9, s[8:11], s21 offen offset:1024 lds
    v_mfma_f32_16x16x32_bf16 v[36:39], a[132:135], a[76:79], v[36:39]
    buffer_load_dwordx4 v10, s[8:11], s21 offen offset:2048 lds
    v_mfma_f32_16x16x32_bf16 v[40:43], a[128:131], a[80:83], v[40:43]
    buffer_load_dwordx4 v11, s[8:11], s21 offen offset:3072 lds
    v_mfma_f32_16x16x32_bf16 v[40:43], a[132:135], a[84:87], v[40:43]
    s_add_u32 s21, s21, 57344
    buffer_load_dwordx4 a[36:39], v4, s[4:7], s20 offen offset:1024
    v_mfma_f32_16x16x32_bf16 v[44:47], a[128:131], a[88:91], v[44:47]
    buffer_load_dwordx4 a[40:43], v5, s[4:7], s20 offen offset:0
    v_mfma_f32_16x16x32_bf16 v[44:47], a[132:135], a[92:95], v[44:47]
    s_waitcnt lgkmcnt(8)
    buffer_load_dwordx4 a[44:47], v5, s[4:7], s20 offen offset:1024
    v_mfma_f32_16x16x32_bf16 v[48:51], a[136:139], a[64:67], v[48:51]
    s_add_u32 m0, s23, 12288
    buffer_load_dwordx4 a[48:51], v6, s[4:7], s20 offen
    v_mfma_f32_16x16x32_bf16 v[48:51], a[140:143], a[68:71], v[48:51]
    buffer_load_dwordx4 v8, s[8:11], s22 offen offset:0 lds
    v_mfma_f32_16x16x32_bf16 v[52:55], a[136:139], a[72:75], v[52:55]
    buffer_load_dwordx4 v9, s[8:11], s22 offen offset:1024 lds
    v_mfma_f32_16x16x32_bf16 v[52:55], a[140:143], a[76:79], v[52:55]
    buffer_load_dwordx4 v10, s[8:11], s22 offen offset:2048 lds
    v_mfma_f32_16x16x32_bf16 v[56:59], a[136:139], a[80:83], v[56:59]
    buffer_load_dwordx4 v11, s[8:11], s22 offen offset:3072 lds
    v_mfma_f32_16x16x32_bf16 v[56:59], a[140:143], a[84:87], v[56:59]
    s_add_u32 s22, s22, 57344
    buffer_load_dwordx4 a[52:55], v6, s[4:7], s20 offen offset:1024
    v_mfma_f32_16x16x32_bf16 v[60:63], a[136:139], a[88:91], v[60:63]
    buffer_load_dwordx4 a[56:59], v7, s[4:7], s20 offen offset:0
    v_mfma_f32_16x16x32_bf16 v[60:63], a[140:143], a[92:95], v[60:63]
    s_waitcnt vmcnt(31) lgkmcnt(6)
    buffer_load_dwordx4 a[60:63], v7, s[4:7], s20 offen offset:1024
    v_mfma_f32_16x16x32_bf16 v[64:67], a[144:147], a[64:67], v[64:67]
    s_waitcnt lgkmcnt(4)
    s_add_u32 s20, s20, 2048
    ds_read_b64_tr_b16 a[160:161], v12 offset:24576
    v_mfma_f32_16x16x32_bf16 v[64:67], a[148:151], a[68:71], v[64:67]
    ds_read_b64_tr_b16 a[162:163], v12 offset:26624
    v_mfma_f32_16x16x32_bf16 v[68:71], a[144:147], a[72:75], v[68:71]
    ds_read_b64_tr_b16 a[164:165], v12 offset:28672
    v_mfma_f32_16x16x32_bf16 v[68:71], a[148:151], a[76:79], v[68:71]
    ds_read_b64_tr_b16 a[166:167], v12 offset:30720
    v_mfma_f32_16x16x32_bf16 v[72:75], a[144:147], a[80:83], v[72:75]
    ds_read_b64_tr_b16 a[168:169], v13 offset:24576
    v_mfma_f32_16x16x32_bf16 v[72:75], a[148:151], a[84:87], v[72:75]
    ds_read_b64_tr_b16 a[170:171], v13 offset:26624
    v_mfma_f32_16x16x32_bf16 v[76:79], a[144:147], a[88:91], v[76:79]
    ds_read_b64_tr_b16 a[172:173], v13 offset:28672
    v_mfma_f32_16x16x32_bf16 v[76:79], a[148:151], a[92:95], v[76:79]
    s_waitcnt lgkmcnt(9)
    ds_read_b64_tr_b16 a[174:175], v13 offset:30720
    v_mfma_f32_16x16x32_bf16 v[80:83], a[152:155], a[64:67], v[80:83]
    s_waitcnt lgkmcnt(8)
    ds_read_b64_tr_b16 a[176:177], v14 offset:24576
    v_mfma_f32_16x16x32_bf16 v[80:83], a[156:159], a[68:71], v[80:83]
    ds_read_b64_tr_b16 a[178:179], v14 offset:26624
    v_mfma_f32_16x16x32_bf16 v[84:87], a[152:155], a[72:75], v[84:87]
    ds_read_b64_tr_b16 a[180:181], v14 offset:28672
    v_mfma_f32_16x16x32_bf16 v[84:87], a[156:159], a[76:79], v[84:87]
    ds_read_b64_tr_b16 a[182:183], v14 offset:30720
    v_mfma_f32_16x16x32_bf16 v[88:91], a[152:155], a[80:83], v[88:91]
    ds_read_b64_tr_b16 a[184:185], v15 offset:24576
    v_mfma_f32_16x16x32_bf16 v[88:91], a[156:159], a[84:87], v[88:91]
    ds_read_b64_tr_b16 a[186:187], v15 offset:26624
    v_mfma_f32_16x16x32_bf16 v[92:95], a[152:155], a[88:91], v[92:95]
    ds_read_b64_tr_b16 a[188:189], v15 offset:28672
    v_mfma_f32_16x16x32_bf16 v[92:95], a[156:159], a[92:95], v[92:95]
    s_waitcnt lgkmcnt(11)
    ds_read_b64_tr_b16 a[190:191], v15 offset:30720
    v_mfma_f32_16x16x32_bf16 v[32:35], a[160:163], a[96:99], v[32:35]
    s_add_u32 m0, s23, 16384
    buffer_load_dwordx4 a[64:67], v4, s[4:7], s20 offen
    v_mfma_f32_16x16x32_bf16 v[32:35], a[164:167], a[100:103], v[32:35]
    buffer_load_dwordx4 v8, s[8:11], s21 offen offset:0 lds
    v_mfma_f32_16x16x32_bf16 v[36:39], a[160:163], a[104:107], v[36:39]
    buffer_load_dwordx4 v9, s[8:11], s21 offen offset:1024 lds
    v_mfma_f32_16x16x32_bf16 v[36:39], a[164:167], a[108:111], v[36:39]
    buffer_load_dwordx4 v10, s[8:11], s21 offen offset:2048 lds
    v_mfma_f32_16x16x32_bf16 v[40:43], a[160:163], a[112:115], v[40:43]
    buffer_load_dwordx4 v11, s[8:11], s21 offen offset:3072 lds
    v_mfma_f32_16x16x32_bf16 v[40:43], a[164:167], a[116:119], v[40:43]
    s_add_u32 s21, s21, 57344
    buffer_load_dwordx4 a[68:71], v4, s[4:7], s20 offen offset:1024
    v_mfma_f32_16x16x32_bf16 v[44:47], a[160:163], a[120:123], v[44:47]
    buffer_load_dwordx4 a[72:75], v5, s[4:7], s20 offen offset:0
    v_mfma_f32_16x16x32_bf16 v[44:47], a[164:167], a[124:127], v[44:47]
    s_waitcnt lgkmcnt(8)
    buffer_load_dwordx4 a[76:79], v5, s[4:7], s20 offen offset:1024
    v_mfma_f32_16x16x32_bf16 v[48:51], a[168:171], a[96:99], v[48:51]
    s_add_u32 m0, s23, 20480
    buffer_load_dwordx4 a[80:83], v6, s[4:7], s20 offen
    v_mfma_f32_16x16x32_bf16 v[48:51], a[172:175], a[100:103], v[48:51]
    buffer_load_dwordx4 v8, s[8:11], s22 offen offset:0 lds
    v_mfma_f32_16x16x32_bf16 v[52:55], a[168:171], a[104:107], v[52:55]
    buffer_load_dwordx4 v9, s[8:11], s22 offen offset:1024 lds
    v_mfma_f32_16x16x32_bf16 v[52:55], a[172:175], a[108:111], v[52:55]
    buffer_load_dwordx4 v10, s[8:11], s22 offen offset:2048 lds
    v_mfma_f32_16x16x32_bf16 v[56:59], a[168:171], a[112:115], v[56:59]
    buffer_load_dwordx4 v11, s[8:11], s22 offen offset:3072 lds
    v_mfma_f32_16x16x32_bf16 v[56:59], a[172:175], a[116:119], v[56:59]
    s_add_u32 s22, s22, 57344
    buffer_load_dwordx4 a[84:87], v6, s[4:7], s20 offen offset:1024
    v_mfma_f32_16x16x32_bf16 v[60:63], a[168:171], a[120:123], v[60:63]
    buffer_load_dwordx4 a[88:91], v7, s[4:7], s20 offen offset:0
    v_mfma_f32_16x16x32_bf16 v[60:63], a[172:175], a[124:127], v[60:63]
    s_waitcnt vmcnt(31) lgkmcnt(6)
    buffer_load_dwordx4 a[92:95], v7, s[4:7], s20 offen offset:1024
    v_mfma_f32_16x16x32_bf16 v[64:67], a[176:179], a[96:99], v[64:67]
    s_waitcnt lgkmcnt(4)
    s_add_u32 s20, s20, 2048
    ds_read_b64_tr_b16 a[128:129], v12 offset:0
    v_mfma_f32_16x16x32_bf16 v[64:67], a[180:183], a[100:103], v[64:67]
    ds_read_b64_tr_b16 a[130:131], v12 offset:2048
    v_mfma_f32_16x16x32_bf16 v[68:71], a[176:179], a[104:107], v[68:71]
    ds_read_b64_tr_b16 a[132:133], v12 offset:4096
    v_mfma_f32_16x16x32_bf16 v[68:71], a[180:183], a[108:111], v[68:71]
    ds_read_b64_tr_b16 a[134:135], v12 offset:6144
    v_mfma_f32_16x16x32_bf16 v[72:75], a[176:179], a[112:115], v[72:75]
    ds_read_b64_tr_b16 a[136:137], v13 offset:0
    v_mfma_f32_16x16x32_bf16 v[72:75], a[180:183], a[116:119], v[72:75]
    ds_read_b64_tr_b16 a[138:139], v13 offset:2048
    v_mfma_f32_16x16x32_bf16 v[76:79], a[176:179], a[120:123], v[76:79]
    ds_read_b64_tr_b16 a[140:141], v13 offset:4096
    v_mfma_f32_16x16x32_bf16 v[76:79], a[180:183], a[124:127], v[76:79]
    s_waitcnt lgkmcnt(9)
    ds_read_b64_tr_b16 a[142:143], v13 offset:6144
    v_mfma_f32_16x16x32_bf16 v[80:83], a[184:187], a[96:99], v[80:83]
    s_waitcnt lgkmcnt(8)
    ds_read_b64_tr_b16 a[144:145], v14 offset:0
    v_mfma_f32_16x16x32_bf16 v[80:83], a[188:191], a[100:103], v[80:83]
    ds_read_b64_tr_b16 a[146:147], v14 offset:2048
    v_mfma_f32_16x16x32_bf16 v[84:87], a[184:187], a[104:107], v[84:87]
    ds_read_b64_tr_b16 a[148:149], v14 offset:4096
    v_mfma_f32_16x16x32_bf16 v[84:87], a[188:191], a[108:111], v[84:87]
    ds_read_b64_tr_b16 a[150:151], v14 offset:6144
    v_mfma_f32_16x16x32_bf16 v[88:91], a[184:187], a[112:115], v[88:91]
    ds_read_b64_tr_b16 a[152:153], v15 offset:0
    v_mfma_f32_16x16x32_bf16 v[88:91], a[188:191], a[116:119], v[88:91]
    ds_read_b64_tr_b16 a[154:155], v15 offset:2048
    v_mfma_f32_16x16x32_bf16 v[92:95], a[184:187], a[120:123], v[92:95]
    ds_read_b64_tr_b16 a[156:157], v15 offset:4096
    v_mfma_f32_16x16x32_bf16 v[92:95], a[188:191], a[124:127], v[92:95]
    s_waitcnt lgkmcnt(11)
    ds_read_b64_tr_b16 a[158:159], v15 offset:6144
    v_mfma_f32_16x16x32_bf16 v[32:35], a[128:131], a[0:3], v[32:35]
    s_add_u32 m0, s23, 24576
    buffer_load_dwordx4 a[96:99], v4, s[4:7], s20 offen
    v_mfma_f32_16x16x32_bf16 v[32:35], a[132:135], a[4:7], v[32:35]
    buffer_load_dwordx4 v8, s[8:11], s21 offen offset:0 lds
    v_mfma_f32_16x16x32_bf16 v[36:39], a[128:131], a[8:11], v[36:39]
    buffer_load_dwordx4 v9, s[8:11], s21 offen offset:1024 lds
    v_mfma_f32_16x16x32_bf16 v[36:39], a[132:135], a[12:15], v[36:39]
    buffer_load_dwordx4 v10, s[8:11], s21 offen offset:2048 lds
    v_mfma_f32_16x16x32_bf16 v[40:43], a[128:131], a[16:19], v[40:43]
    buffer_load_dwordx4 v11, s[8:11], s21 offen offset:3072 lds
    v_mfma_f32_16x16x32_bf16 v[40:43], a[132:135], a[20:23], v[40:43]
    s_add_u32 s21, s21, 57344
    buffer_load_dwordx4 a[100:103], v4, s[4:7], s20 offen offset:1024
    v_mfma_f32_16x16x32_bf16 v[44:47], a[128:131], a[24:27], v[44:47]
    buffer_load_dwordx4 a[104:107], v5, s[4:7], s20 offen offset:0
    v_mfma_f32_16x16x32_bf16 v[44:47], a[132:135], a[28:31], v[44:47]
    s_waitcnt lgkmcnt(8)
    buffer_load_dwordx4 a[108:111], v5, s[4:7], s20 offen offset:1024
    v_mfma_f32_16x16x32_bf16 v[48:51], a[136:139], a[0:3], v[48:51]
    s_add_u32 m0, s23, 28672
    buffer_load_dwordx4 a[112:115], v6, s[4:7], s20 offen
    v_mfma_f32_16x16x32_bf16 v[48:51], a[140:143], a[4:7], v[48:51]
    buffer_load_dwordx4 v8, s[8:11], s22 offen offset:0 lds
    v_mfma_f32_16x16x32_bf16 v[52:55], a[136:139], a[8:11], v[52:55]
    buffer_load_dwordx4 v9, s[8:11], s22 offen offset:1024 lds
    v_mfma_f32_16x16x32_bf16 v[52:55], a[140:143], a[12:15], v[52:55]
    buffer_load_dwordx4 v10, s[8:11], s22 offen offset:2048 lds
    v_mfma_f32_16x16x32_bf16 v[56:59], a[136:139], a[16:19], v[56:59]
    buffer_load_dwordx4 v11, s[8:11], s22 offen offset:3072 lds
    v_mfma_f32_16x16x32_bf16 v[56:59], a[140:143], a[20:23], v[56:59]
    s_add_u32 s22, s22, 57344
    buffer_load_dwordx4 a[116:119], v6, s[4:7], s20 offen offset:1024
    v_mfma_f32_16x16x32_bf16 v[60:63], a[136:139], a[24:27], v[60:63]
    buffer_load_dwordx4 a[120:123], v7, s[4:7], s20 offen offset:0
    v_mfma_f32_16x16x32_bf16 v[60:63], a[140:143], a[28:31], v[60:63]
    s_waitcnt vmcnt(31) lgkmcnt(6)
    buffer_load_dwordx4 a[124:127], v7, s[4:7], s20 offen offset:1024
    v_mfma_f32_16x16x32_bf16 v[64:67], a[144:147], a[0:3], v[64:67]
    s_waitcnt lgkmcnt(4)
    s_add_u32 s20, s20, 2048
    ds_read_b64_tr_b16 a[160:161], v12 offset:8192
    v_mfma_f32_16x16x32_bf16 v[64:67], a[148:151], a[4:7], v[64:67]
    ds_read_b64_tr_b16 a[162:163], v12 offset:10240
    v_mfma_f32_16x16x32_bf16 v[68:71], a[144:147], a[8:11], v[68:71]
    ds_read_b64_tr_b16 a[164:165], v12 offset:12288
    v_mfma_f32_16x16x32_bf16 v[68:71], a[148:151], a[12:15], v[68:71]
    ds_read_b64_tr_b16 a[166:167], v12 offset:14336
    v_mfma_f32_16x16x32_bf16 v[72:75], a[144:147], a[16:19], v[72:75]
    ds_read_b64_tr_b16 a[168:169], v13 offset:8192
    v_mfma_f32_16x16x32_bf16 v[72:75], a[148:151], a[20:23], v[72:75]
    ds_read_b64_tr_b16 a[170:171], v13 offset:10240
    v_mfma_f32_16x16x32_bf16 v[76:79], a[144:147], a[24:27], v[76:79]
    ds_read_b64_tr_b16 a[172:173], v13 offset:12288
    v_mfma_f32_16x16x32_bf16 v[76:79], a[148:151], a[28:31], v[76:79]
    s_waitcnt lgkmcnt(9)
    ds_read_b64_tr_b16 a[174:175], v13 offset:14336
    v_mfma_f32_16x16x32_bf16 v[80:83], a[152:155], a[0:3], v[80:83]
    s_waitcnt lgkmcnt(8)
    ds_read_b64_tr_b16 a[176:177], v14 offset:8192
    v_mfma_f32_16x16x32_bf16 v[80:83], a[156:159], a[4:7], v[80:83]
    ds_read_b64_tr_b16 a[178:179], v14 offset:10240
    v_mfma_f32_16x16x32_bf16 v[84:87], a[152:155], a[8:11], v[84:87]
    ds_read_b64_tr_b16 a[180:181], v14 offset:12288
    v_mfma_f32_16x16x32_bf16 v[84:87], a[156:159], a[12:15], v[84:87]
    ds_read_b64_tr_b16 a[182:183], v14 offset:14336
    v_mfma_f32_16x16x32_bf16 v[88:91], a[152:155], a[16:19], v[88:91]
    ds_read_b64_tr_b16 a[184:185], v15 offset:8192
    v_mfma_f32_16x16x32_bf16 v[88:91], a[156:159], a[20:23], v[88:91]
    ds_read_b64_tr_b16 a[186:187], v15 offset:10240
    v_mfma_f32_16x16x32_bf16 v[92:95], a[152:155], a[24:27], v[92:95]
    ds_read_b64_tr_b16 a[188:189], v15 offset:12288
    v_mfma_f32_16x16x32_bf16 v[92:95], a[156:159], a[28:31], v[92:95]
    s_waitcnt lgkmcnt(11)
    ds_read_b64_tr_b16 a[190:191], v15 offset:14336
    v_mfma_f32_16x16x32_bf16 v[32:35], a[160:163], a[32:35], v[32:35]
    s_add_u32 m0, s23, 0
    buffer_load_dwordx4 a[0:3], v4, s[4:7], s20 offen
    v_mfma_f32_16x16x32_bf16 v[32:35], a[164:167], a[36:39], v[32:35]
    buffer_load_dwordx4 v8, s[8:11], s21 offen offset:0 lds
    v_mfma_f32_16x16x32_bf16 v[36:39], a[160:163], a[40:43], v[36:39]
    buffer_load_dwordx4 v9, s[8:11], s21 offen offset:1024 lds
    v_mfma_f32_16x16x32_bf16 v[36:39], a[164:167], a[44:47], v[36:39]
    buffer_load_dwordx4 v10, s[8:11], s21 offen offset:2048 lds
    v_mfma_f32_16x16x32_bf16 v[40:43], a[160:163], a[48:51], v[40:43]
    buffer_load_dwordx4 v11, s[8:11], s21 offen offset:3072 lds
    v_mfma_f32_16x16x32_bf16 v[40:43], a[164:167], a[52:55], v[40:43]
    s_add_u32 s21, s21, 57344
    buffer_load_dwordx4 a[4:7], v4, s[4:7], s20 offen offset:1024
    v_mfma_f32_16x16x32_bf16 v[44:47], a[160:163], a[56:59], v[44:47]
    buffer_load_dwordx4 a[8:11], v5, s[4:7], s20 offen offset:0
    v_mfma_f32_16x16x32_bf16 v[44:47], a[164:167], a[60:63], v[44:47]
    s_waitcnt lgkmcnt(8)
    buffer_load_dwordx4 a[12:15], v5, s[4:7], s20 offen offset:1024
    v_mfma_f32_16x16x32_bf16 v[48:51], a[168:171], a[32:35], v[48:51]
    s_add_u32 m0, s23, 4096
    buffer_load_dwordx4 a[16:19], v6, s[4:7], s20 offen
    v_mfma_f32_16x16x32_bf16 v[48:51], a[172:175], a[36:39], v[48:51]
    buffer_load_dwordx4 v8, s[8:11], s22 offen offset:0 lds
    v_mfma_f32_16x16x32_bf16 v[52:55], a[168:171], a[40:43], v[52:55]
    buffer_load_dwordx4 v9, s[8:11], s22 offen offset:1024 lds
    v_mfma_f32_16x16x32_bf16 v[52:55], a[172:175], a[44:47], v[52:55]
    buffer_load_dwordx4 v10, s[8:11], s22 offen offset:2048 lds
    v_mfma_f32_16x16x32_bf16 v[56:59], a[168:171], a[48:51], v[56:59]
    buffer_load_dwordx4 v11, s[8:11], s22 offen offset:3072 lds
    v_mfma_f32_16x16x32_bf16 v[56:59], a[172:175], a[52:55], v[56:59]
    s_add_u32 s22, s22, 57344
    buffer_load_dwordx4 a[20:23], v6, s[4:7], s20 offen offset:1024
    v_mfma_f32_16x16x32_bf16 v[60:63], a[168:171], a[56:59], v[60:63]
    buffer_load_dwordx4 a[24:27], v7, s[4:7], s20 offen offset:0
    v_mfma_f32_16x16x32_bf16 v[60:63], a[172:175], a[60:63], v[60:63]
    s_waitcnt vmcnt(31) lgkmcnt(6)
    buffer_load_dwordx4 a[28:31], v7, s[4:7], s20 offen offset:1024
    v_mfma_f32_16x16x32_bf16 v[64:67], a[176:179], a[32:35], v[64:67]
    s_waitcnt lgkmcnt(4)
    s_add_u32 s20, s20, 2048
    ds_read_b64_tr_b16 a[128:129], v12 offset:16384
    v_mfma_f32_16x16x32_bf16 v[64:67], a[180:183], a[36:39], v[64:67]
    ds_read_b64_tr_b16 a[130:131], v12 offset:18432
    v_mfma_f32_16x16x32_bf16 v[68:71], a[176:179], a[40:43], v[68:71]
    ds_read_b64_tr_b16 a[132:133], v12 offset:20480
    v_mfma_f32_16x16x32_bf16 v[68:71], a[180:183], a[44:47], v[68:71]
    ds_read_b64_tr_b16 a[134:135], v12 offset:22528
    v_mfma_f32_16x16x32_bf16 v[72:75], a[176:179], a[48:51], v[72:75]
    ds_read_b64_tr_b16 a[136:137], v13 offset:16384
    v_mfma_f32_16x16x32_bf16 v[72:75], a[180:183], a[52:55], v[72:75]
    ds_read_b64_tr_b16 a[138:139], v13 offset:18432
    v_mfma_f32_16x16x32_bf16 v[76:79], a[176:179], a[56:59], v[76:79]
    ds_read_b64_tr_b16 a[140:141], v13 offset:20480
    v_mfma_f32_16x16x32_bf16 v[76:79], a[180:183], a[60:63], v[76:79]
    s_waitcnt lgkmcnt(9)
    ds_read_b64_tr_b16 a[142:143], v13 offset:22528
    v_mfma_f32_16x16x32_bf16 v[80:83], a[184:187], a[32:35], v[80:83]
    s_waitcnt lgkmcnt(8)
    ds_read_b64_tr_b16 a[144:145], v14 offset:16384
    v_mfma_f32_16x16x32_bf16 v[80:83], a[188:191], a[36:39], v[80:83]
    ds_read_b64_tr_b16 a[146:147], v14 offset:18432
    v_mfma_f32_16x16x32_bf16 v[84:87], a[184:187], a[40:43], v[84:87]
    ds_read_b64_tr_b16 a[148:149], v14 offset:20480
    v_mfma_f32_16x16x32_bf16 v[84:87], a[188:191], a[44:47], v[84:87]
    ds_read_b64_tr_b16 a[150:151], v14 offset:22528
    v_mfma_f32_16x16x32_bf16 v[88:91], a[184:187], a[48:51], v[88:91]
    ds_read_b64_tr_b16 a[152:153], v15 offset:16384
    v_mfma_f32_16x16x32_bf16 v[88:91], a[188:191], a[52:55], v[88:91]
    ds_read_b64_tr_b16 a[154:155], v15 offset:18432
    v_mfma_f32_16x16x32_bf16 v[92:95], a[184:187], a[56:59], v[92:95]
    ds_read_b64_tr_b16 a[156:157], v15 offset:20480
    v_mfma_f32_16x16x32_bf16 v[92:95], a[188:191], a[60:63], v[92:95]
    s_waitcnt lgkmcnt(11)
    ds_read_b64_tr_b16 a[158:159], v15 offset:22528
    v_mfma_f32_16x16x32_bf16 v[32:35], a[128:131], a[64:67], v[32:35]
    s_add_u32 m0, s23, 8192
    buffer_load_dwordx4 a[32:35], v4, s[4:7], s20 offen
    v_mfma_f32_16x16x32_bf16 v[32:35], a[132:135], a[68:71], v[32:35]
    buffer_load_dwordx4 v8, s[8:11], s21 offen offset:0 lds
    v_mfma_f32_16x16x32_bf16 v[36:39], a[128:131], a[72:75], v[36:39]
    buffer_load_dwordx4 v9, s[8:11], s21 offen offset:1024 lds
    v_mfma_f32_16x16x32_bf16 v[36:39], a[132:135], a[76:79], v[36:39]
    buffer_load_dwordx4 v10, s[8:11], s21 offen offset:2048 lds
    v_mfma_f32_16x16x32_bf16 v[40:43], a[128:131], a[80:83], v[40:43]
    buffer_load_dwordx4 v11, s[8:11], s21 offen offset:3072 lds
    v_mfma_f32_16x16x32_bf16 v[40:43], a[132:135], a[84:87], v[40:43]
    s_add_u32 s21, s21, 57344
    buffer_load_dwordx4 a[36:39], v4, s[4:7], s20 offen offset:1024
    v_mfma_f32_16x16x32_bf16 v[44:47], a[128:131], a[88:91], v[44:47]
    buffer_load_dwordx4 a[40:43], v5, s[4:7], s20 offen offset:0
    v_mfma_f32_16x16x32_bf16 v[44:47], a[132:135], a[92:95], v[44:47]
    s_waitcnt lgkmcnt(8)
    buffer_load_dwordx4 a[44:47], v5, s[4:7], s20 offen offset:1024
    v_mfma_f32_16x16x32_bf16 v[48:51], a[136:139], a[64:67], v[48:51]
    s_add_u32 m0, s23, 12288
    buffer_load_dwordx4 a[48:51], v6, s[4:7], s20 offen
    v_mfma_f32_16x16x32_bf16 v[48:51], a[140:143], a[68:71], v[48:51]
    buffer_load_dwordx4 v8, s[8:11], s22 offen offset:0 lds
    v_mfma_f32_16x16x32_bf16 v[52:55], a[136:139], a[72:75], v[52:55]
    buffer_load_dwordx4 v9, s[8:11], s22 offen offset:1024 lds
    v_mfma_f32_16x16x32_bf16 v[52:55], a[140:143], a[76:79], v[52:55]
    buffer_load_dwordx4 v10, s[8:11], s22 offen offset:2048 lds
    v_mfma_f32_16x16x32_bf16 v[56:59], a[136:139], a[80:83], v[56:59]
    buffer_load_dwordx4 v11, s[8:11], s22 offen offset:3072 lds
    v_mfma_f32_16x16x32_bf16 v[56:59], a[140:143], a[84:87], v[56:59]
    s_add_u32 s22, s22, 57344
    buffer_load_dwordx4 a[52:55], v6, s[4:7], s20 offen offset:1024
    v_mfma_f32_16x16x32_bf16 v[60:63], a[136:139], a[88:91], v[60:63]
    buffer_load_dwordx4 a[56:59], v7, s[4:7], s20 offen offset:0
    v_mfma_f32_16x16x32_bf16 v[60:63], a[140:143], a[92:95], v[60:63]
    s_waitcnt vmcnt(31) lgkmcnt(6)
    buffer_load_dwordx4 a[60:63], v7, s[4:7], s20 offen offset:1024
    v_mfma_f32_16x16x32_bf16 v[64:67], a[144:147], a[64:67], v[64:67]
    s_waitcnt lgkmcnt(4)
    s_add_u32 s20, s20, 2048
    ds_read_b64_tr_b16 a[160:161], v12 offset:24576
    v_mfma_f32_16x16x32_bf16 v[64:67], a[148:151], a[68:71], v[64:67]
    ds_read_b64_tr_b16 a[162:163], v12 offset:26624
    v_mfma_f32_16x16x32_bf16 v[68:71], a[144:147], a[72:75], v[68:71]
    ds_read_b64_tr_b16 a[164:165], v12 offset:28672
    v_mfma_f32_16x16x32_bf16 v[68:71], a[148:151], a[76:79], v[68:71]
    ds_read_b64_tr_b16 a[166:167], v12 offset:30720
    v_mfma_f32_16x16x32_bf16 v[72:75], a[144:147], a[80:83], v[72:75]
    ds_read_b64_tr_b16 a[168:169], v13 offset:24576
    v_mfma_f32_16x16x32_bf16 v[72:75], a[148:151], a[84:87], v[72:75]
    ds_read_b64_tr_b16 a[170:171], v13 offset:26624
    v_mfma_f32_16x16x32_bf16 v[76:79], a[144:147], a[88:91], v[76:79]
    ds_read_b64_tr_b16 a[172:173], v13 offset:28672
    v_mfma_f32_16x16x32_bf16 v[76:79], a[148:151], a[92:95], v[76:79]
    s_waitcnt lgkmcnt(9)
    ds_read_b64_tr_b16 a[174:175], v13 offset:30720
    v_mfma_f32_16x16x32_bf16 v[80:83], a[152:155], a[64:67], v[80:83]
    s_waitcnt lgkmcnt(8)
    ds_read_b64_tr_b16 a[176:177], v14 offset:24576
    v_mfma_f32_16x16x32_bf16 v[80:83], a[156:159], a[68:71], v[80:83]
    ds_read_b64_tr_b16 a[178:179], v14 offset:26624
    v_mfma_f32_16x16x32_bf16 v[84:87], a[152:155], a[72:75], v[84:87]
    ds_read_b64_tr_b16 a[180:181], v14 offset:28672
    v_mfma_f32_16x16x32_bf16 v[84:87], a[156:159], a[76:79], v[84:87]
    ds_read_b64_tr_b16 a[182:183], v14 offset:30720
    v_mfma_f32_16x16x32_bf16 v[88:91], a[152:155], a[80:83], v[88:91]
    ds_read_b64_tr_b16 a[184:185], v15 offset:24576
    v_mfma_f32_16x16x32_bf16 v[88:91], a[156:159], a[84:87], v[88:91]
    ds_read_b64_tr_b16 a[186:187], v15 offset:26624
    v_mfma_f32_16x16x32_bf16 v[92:95], a[152:155], a[88:91], v[92:95]
    ds_read_b64_tr_b16 a[188:189], v15 offset:28672
    v_mfma_f32_16x16x32_bf16 v[92:95], a[156:159], a[92:95], v[92:95]
    s_waitcnt lgkmcnt(11)
    ds_read_b64_tr_b16 a[190:191], v15 offset:30720
    v_mfma_f32_16x16x32_bf16 v[32:35], a[160:163], a[96:99], v[32:35]
    s_add_u32 m0, s23, 16384
    buffer_load_dwordx4 a[64:67], v4, s[4:7], s20 offen
    v_mfma_f32_16x16x32_bf16 v[32:35], a[164:167], a[100:103], v[32:35]
    buffer_load_dwordx4 v8, s[8:11], s21 offen offset:0 lds
    v_mfma_f32_16x16x32_bf16 v[36:39], a[160:163], a[104:107], v[36:39]
    buffer_load_dwordx4 v9, s[8:11], s21 offen offset:1024 lds
    v_mfma_f32_16x16x32_bf16 v[36:39], a[164:167], a[108:111], v[36:39]
    buffer_load_dwordx4 v10, s[8:11], s21 offen offset:2048 lds
    v_mfma_f32_16x16x32_bf16 v[40:43], a[160:163], a[112:115], v[40:43]
    buffer_load_dwordx4 v11, s[8:11], s21 offen offset:3072 lds
    v_mfma_f32_16x16x32_bf16 v[40:43], a[164:167], a[116:119], v[40:43]
    s_add_u32 s21, s21, 57344
    buffer_load_dwordx4 a[68:71], v4, s[4:7], s20 offen offset:1024
    v_mfma_f32_16x16x32_bf16 v[44:47], a[160:163], a[120:123], v[44:47]
    buffer_load_dwordx4 a[72:75], v5, s[4:7], s20 offen offset:0
    v_mfma_f32_16x16x32_bf16 v[44:47], a[164:167], a[124:127], v[44:47]
    s_waitcnt lgkmcnt(8)
    buffer_load_dwordx4 a[76:79], v5, s[4:7], s20 offen offset:1024
    v_mfma_f32_16x16x32_bf16 v[48:51], a[168:171], a[96:99], v[48:51]
    s_add_u32 m0, s23, 20480
    buffer_load_dwordx4 a[80:83], v6, s[4:7], s20 offen
    v_mfma_f32_16x16x32_bf16 v[48:51], a[172:175], a[100:103], v[48:51]
    buffer_load_dwordx4 v8, s[8:11], s22 offen offset:0 lds
    v_mfma_f32_16x16x32_bf16 v[52:55], a[168:171], a[104:107], v[52:55]
    buffer_load_dwordx4 v9, s[8:11], s22 offen offset:1024 lds
    v_mfma_f32_16x16x32_bf16 v[52:55], a[172:175], a[108:111], v[52:55]
    buffer_load_dwordx4 v10, s[8:11], s22 offen offset:2048 lds
    v_mfma_f32_16x16x32_bf16 v[56:59], a[168:171], a[112:115], v[56:59]
    buffer_load_dwordx4 v11, s[8:11], s22 offen offset:3072 lds
    v_mfma_f32_16x16x32_bf16 v[56:59], a[172:175], a[116:119], v[56:59]
    s_add_u32 s22, s22, 57344
    buffer_load_dwordx4 a[84:87], v6, s[4:7], s20 offen offset:1024
    v_mfma_f32_16x16x32_bf16 v[60:63], a[168:171], a[120:123], v[60:63]
    buffer_load_dwordx4 a[88:91], v7, s[4:7], s20 offen offset:0
    v_mfma_f32_16x16x32_bf16 v[60:63], a[172:175], a[124:127], v[60:63]
    s_waitcnt vmcnt(31) lgkmcnt(6)
    buffer_load_dwordx4 a[92:95], v7, s[4:7], s20 offen offset:1024
    v_mfma_f32_16x16x32_bf16 v[64:67], a[176:179], a[96:99], v[64:67]
    s_waitcnt lgkmcnt(4)
    s_add_u32 s20, s20, 2048
    ds_read_b64_tr_b16 a[128:129], v12 offset:0
    v_mfma_f32_16x16x32_bf16 v[64:67], a[180:183], a[100:103], v[64:67]
    ds_read_b64_tr_b16 a[130:131], v12 offset:2048
    v_mfma_f32_16x16x32_bf16 v[68:71], a[176:179], a[104:107], v[68:71]
    ds_read_b64_tr_b16 a[132:133], v12 offset:4096
    v_mfma_f32_16x16x32_bf16 v[68:71], a[180:183], a[108:111], v[68:71]
    ds_read_b64_tr_b16 a[134:135], v12 offset:6144
    v_mfma_f32_16x16x32_bf16 v[72:75], a[176:179], a[112:115], v[72:75]
    ds_read_b64_tr_b16 a[136:137], v13 offset:0
    v_mfma_f32_16x16x32_bf16 v[72:75], a[180:183], a[116:119], v[72:75]
    ds_read_b64_tr_b16 a[138:139], v13 offset:2048
    v_mfma_f32_16x16x32_bf16 v[76:79], a[176:179], a[120:123], v[76:79]
    ds_read_b64_tr_b16 a[140:141], v13 offset:4096
    v_mfma_f32_16x16x32_bf16 v[76:79], a[180:183], a[124:127], v[76:79]
    s_waitcnt lgkmcnt(9)
    ds_read_b64_tr_b16 a[142:143], v13 offset:6144
    v_mfma_f32_16x16x32_bf16 v[80:83], a[184:187], a[96:99], v[80:83]
    s_waitcnt lgkmcnt(8)
    ds_read_b64_tr_b16 a[144:145], v14 offset:0
    v_mfma_f32_16x16x32_bf16 v[80:83], a[188:191], a[100:103], v[80:83]
    ds_read_b64_tr_b16 a[146:147], v14 offset:2048
    v_mfma_f32_16x16x32_bf16 v[84:87], a[184:187], a[104:107], v[84:87]
    ds_read_b64_tr_b16 a[148:149], v14 offset:4096
    v_mfma_f32_16x16x32_bf16 v[84:87], a[188:191], a[108:111], v[84:87]
    ds_read_b64_tr_b16 a[150:151], v14 offset:6144
    v_mfma_f32_16x16x32_bf16 v[88:91], a[184:187], a[112:115], v[88:91]
    ds_read_b64_tr_b16 a[152:153], v15 offset:0
    v_mfma_f32_16x16x32_bf16 v[88:91], a[188:191], a[116:119], v[88:91]
    ds_read_b64_tr_b16 a[154:155], v15 offset:2048
    v_mfma_f32_16x16x32_bf16 v[92:95], a[184:187], a[120:123], v[92:95]
    ds_read_b64_tr_b16 a[156:157], v15 offset:4096
    v_mfma_f32_16x16x32_bf16 v[92:95], a[188:191], a[124:127], v[92:95]
    s_waitcnt lgkmcnt(11)
    ds_read_b64_tr_b16 a[158:159], v15 offset:6144
    v_mfma_f32_16x16x32_bf16 v[32:35], a[128:131], a[0:3], v[32:35]
    s_add_u32 m0, s23, 24576
    buffer_load_dwordx4 a[96:99], v4, s[4:7], s20 offen
    v_mfma_f32_16x16x32_bf16 v[32:35], a[132:135], a[4:7], v[32:35]
    buffer_load_dwordx4 v8, s[8:11], s21 offen offset:0 lds
    v_mfma_f32_16x16x32_bf16 v[36:39], a[128:131], a[8:11], v[36:39]
    buffer_load_dwordx4 v9, s[8:11], s21 offen offset:1024 lds
    v_mfma_f32_16x16x32_bf16 v[36:39], a[132:135], a[12:15], v[36:39]
    buffer_load_dwordx4 v10, s[8:11], s21 offen offset:2048 lds
    v_mfma_f32_16x16x32_bf16 v[40:43], a[128:131], a[16:19], v[40:43]
    buffer_load_dwordx4 v11, s[8:11], s21 offen offset:3072 lds
    v_mfma_f32_16x16x32_bf16 v[40:43], a[132:135], a[20:23], v[40:43]
    s_add_u32 s21, s21, 57344
    buffer_load_dwordx4 a[100:103], v4, s[4:7], s20 offen offset:1024
    v_mfma_f32_16x16x32_bf16 v[44:47], a[128:131], a[24:27], v[44:47]
    buffer_load_dwordx4 a[104:107], v5, s[4:7], s20 offen offset:0
    v_mfma_f32_16x16x32_bf16 v[44:47], a[132:135], a[28:31], v[44:47]
    s_waitcnt lgkmcnt(8)
    buffer_load_dwordx4 a[108:111], v5, s[4:7], s20 offen offset:1024
    v_mfma_f32_16x16x32_bf16 v[48:51], a[136:139], a[0:3], v[48:51]
    s_add_u32 m0, s23, 28672
    buffer_load_dwordx4 a[112:115], v6, s[4:7], s20 offen
    v_mfma_f32_16x16x32_bf16 v[48:51], a[140:143], a[4:7], v[48:51]
    buffer_load_dwordx4 v8, s[8:11], s22 offen offset:0 lds
    v_mfma_f32_16x16x32_bf16 v[52:55], a[136:139], a[8:11], v[52:55]
    buffer_load_dwordx4 v9, s[8:11], s22 offen offset:1024 lds
    v_mfma_f32_16x16x32_bf16 v[52:55], a[140:143], a[12:15], v[52:55]
    buffer_load_dwordx4 v10, s[8:11], s22 offen offset:2048 lds
    v_mfma_f32_16x16x32_bf16 v[56:59], a[136:139], a[16:19], v[56:59]
    buffer_load_dwordx4 v11, s[8:11], s22 offen offset:3072 lds
    v_mfma_f32_16x16x32_bf16 v[56:59], a[140:143], a[20:23], v[56:59]
    s_add_u32 s22, s22, 57344
    buffer_load_dwordx4 a[116:119], v6, s[4:7], s20 offen offset:1024
    v_mfma_f32_16x16x32_bf16 v[60:63], a[136:139], a[24:27], v[60:63]
    buffer_load_dwordx4 a[120:123], v7, s[4:7], s20 offen offset:0
    v_mfma_f32_16x16x32_bf16 v[60:63], a[140:143], a[28:31], v[60:63]
    s_waitcnt vmcnt(31) lgkmcnt(6)
    buffer_load_dwordx4 a[124:127], v7, s[4:7], s20 offen offset:1024
    v_mfma_f32_16x16x32_bf16 v[64:67], a[144:147], a[0:3], v[64:67]
    s_waitcnt lgkmcnt(4)
    s_add_u32 s20, s20, 2048
    ds_read_b64_tr_b16 a[160:161], v12 offset:8192
    v_mfma_f32_16x16x32_bf16 v[64:67], a[148:151], a[4:7], v[64:67]
    ds_read_b64_tr_b16 a[162:163], v12 offset:10240
    v_mfma_f32_16x16x32_bf16 v[68:71], a[144:147], a[8:11], v[68:71]
    ds_read_b64_tr_b16 a[164:165], v12 offset:12288
    v_mfma_f32_16x16x32_bf16 v[68:71], a[148:151], a[12:15], v[68:71]
    ds_read_b64_tr_b16 a[166:167], v12 offset:14336
    v_mfma_f32_16x16x32_bf16 v[72:75], a[144:147], a[16:19], v[72:75]
    ds_read_b64_tr_b16 a[168:169], v13 offset:8192
    v_mfma_f32_16x16x32_bf16 v[72:75], a[148:151], a[20:23], v[72:75]
    ds_read_b64_tr_b16 a[170:171], v13 offset:10240
    v_mfma_f32_16x16x32_bf16 v[76:79], a[144:147], a[24:27], v[76:79]
    ds_read_b64_tr_b16 a[172:173], v13 offset:12288
    v_mfma_f32_16x16x32_bf16 v[76:79], a[148:151], a[28:31], v[76:79]
    s_waitcnt lgkmcnt(9)
    ds_read_b64_tr_b16 a[174:175], v13 offset:14336
    v_mfma_f32_16x16x32_bf16 v[80:83], a[152:155], a[0:3], v[80:83]
    s_waitcnt lgkmcnt(8)
    ds_read_b64_tr_b16 a[176:177], v14 offset:8192
    v_mfma_f32_16x16x32_bf16 v[80:83], a[156:159], a[4:7], v[80:83]
    ds_read_b64_tr_b16 a[178:179], v14 offset:10240
    v_mfma_f32_16x16x32_bf16 v[84:87], a[152:155], a[8:11], v[84:87]
    ds_read_b64_tr_b16 a[180:181], v14 offset:12288
    v_mfma_f32_16x16x32_bf16 v[84:87], a[156:159], a[12:15], v[84:87]
    ds_read_b64_tr_b16 a[182:183], v14 offset:14336
    v_mfma_f32_16x16x32_bf16 v[88:91], a[152:155], a[16:19], v[88:91]
    ds_read_b64_tr_b16 a[184:185], v15 offset:8192
    v_mfma_f32_16x16x32_bf16 v[88:91], a[156:159], a[20:23], v[88:91]
    ds_read_b64_tr_b16 a[186:187], v15 offset:10240
    v_mfma_f32_16x16x32_bf16 v[92:95], a[152:155], a[24:27], v[92:95]
    ds_read_b64_tr_b16 a[188:189], v15 offset:12288
    v_mfma_f32_16x16x32_bf16 v[92:95], a[156:159], a[28:31], v[92:95]
    s_waitcnt lgkmcnt(13)
    ds_read_b64_tr_b16 a[190:191], v15 offset:14336
    v_mfma_f32_16x16x32_bf16 v[32:35], a[160:163], a[32:35], v[32:35]
    s_waitcnt lgkmcnt(12)
    v_mfma_f32_16x16x32_bf16 v[32:35], a[164:167], a[36:39], v[32:35]
    v_mfma_f32_16x16x32_bf16 v[36:39], a[160:163], a[40:43], v[36:39]
    v_mfma_f32_16x16x32_bf16 v[36:39], a[164:167], a[44:47], v[36:39]
    v_mfma_f32_16x16x32_bf16 v[40:43], a[160:163], a[48:51], v[40:43]
    v_mfma_f32_16x16x32_bf16 v[40:43], a[164:167], a[52:55], v[40:43]
    v_mfma_f32_16x16x32_bf16 v[44:47], a[160:163], a[56:59], v[44:47]
    v_mfma_f32_16x16x32_bf16 v[44:47], a[164:167], a[60:63], v[44:47]
    s_waitcnt lgkmcnt(10)
    v_mfma_f32_16x16x32_bf16 v[48:51], a[168:171], a[32:35], v[48:51]
    s_waitcnt lgkmcnt(8)
    v_mfma_f32_16x16x32_bf16 v[48:51], a[172:175], a[36:39], v[48:51]
    v_mfma_f32_16x16x32_bf16 v[52:55], a[168:171], a[40:43], v[52:55]
    v_mfma_f32_16x16x32_bf16 v[52:55], a[172:175], a[44:47], v[52:55]
    v_mfma_f32_16x16x32_bf16 v[56:59], a[168:171], a[48:51], v[56:59]
    v_mfma_f32_16x16x32_bf16 v[56:59], a[172:175], a[52:55], v[56:59]
    v_mfma_f32_16x16x32_bf16 v[60:63], a[168:171], a[56:59], v[60:63]
    v_mfma_f32_16x16x32_bf16 v[60:63], a[172:175], a[60:63], v[60:63]
    s_waitcnt vmcnt(16) lgkmcnt(6)
    v_mfma_f32_16x16x32_bf16 v[64:67], a[176:179], a[32:35], v[64:67]
    s_waitcnt lgkmcnt(4)
    ds_read_b64_tr_b16 a[128:129], v12 offset:16384
    v_mfma_f32_16x16x32_bf16 v[64:67], a[180:183], a[36:39], v[64:67]
    ds_read_b64_tr_b16 a[130:131], v12 offset:18432
    v_mfma_f32_16x16x32_bf16 v[68:71], a[176:179], a[40:43], v[68:71]
    ds_read_b64_tr_b16 a[132:133], v12 offset:20480
    v_mfma_f32_16x16x32_bf16 v[68:71], a[180:183], a[44:47], v[68:71]
    ds_read_b64_tr_b16 a[134:135], v12 offset:22528
    v_mfma_f32_16x16x32_bf16 v[72:75], a[176:179], a[48:51], v[72:75]
    ds_read_b64_tr_b16 a[136:137], v13 offset:16384
    v_mfma_f32_16x16x32_bf16 v[72:75], a[180:183], a[52:55], v[72:75]
    ds_read_b64_tr_b16 a[138:139], v13 offset:18432
    v_mfma_f32_16x16x32_bf16 v[76:79], a[176:179], a[56:59], v[76:79]
    ds_read_b64_tr_b16 a[140:141], v13 offset:20480
    v_mfma_f32_16x16x32_bf16 v[76:79], a[180:183], a[60:63], v[76:79]
    s_waitcnt lgkmcnt(9)
    ds_read_b64_tr_b16 a[142:143], v13 offset:22528
    v_mfma_f32_16x16x32_bf16 v[80:83], a[184:187], a[32:35], v[80:83]
    s_waitcnt lgkmcnt(8)
    ds_read_b64_tr_b16 a[144:145], v14 offset:16384
    v_mfma_f32_16x16x32_bf16 v[80:83], a[188:191], a[36:39], v[80:83]
    ds_read_b64_tr_b16 a[146:147], v14 offset:18432
    v_mfma_f32_16x16x32_bf16 v[84:87], a[184:187], a[40:43], v[84:87]
    ds_read_b64_tr_b16 a[148:149], v14 offset:20480
    v_mfma_f32_16x16x32_bf16 v[84:87], a[188:191], a[44:47], v[84:87]
    ds_read_b64_tr_b16 a[150:151], v14 offset:22528
    v_mfma_f32_16x16x32_bf16 v[88:91], a[184:187], a[48:51], v[88:91]
    ds_read_b64_tr_b16 a[152:153], v15 offset:16384
    v_mfma_f32_16x16x32_bf16 v[88:91], a[188:191], a[52:55], v[88:91]
    ds_read_b64_tr_b16 a[154:155], v15 offset:18432
    v_mfma_f32_16x16x32_bf16 v[92:95], a[184:187], a[56:59], v[92:95]
    ds_read_b64_tr_b16 a[156:157], v15 offset:20480
    v_mfma_f32_16x16x32_bf16 v[92:95], a[188:191], a[60:63], v[92:95]
    s_waitcnt lgkmcnt(13)
    ds_read_b64_tr_b16 a[158:159], v15 offset:22528
    v_mfma_f32_16x16x32_bf16 v[32:35], a[128:131], a[64:67], v[32:35]
    s_waitcnt lgkmcnt(12)
    v_mfma_f32_16x16x32_bf16 v[32:35], a[132:135], a[68:71], v[32:35]
    v_mfma_f32_16x16x32_bf16 v[36:39], a[128:131], a[72:75], v[36:39]
    v_mfma_f32_16x16x32_bf16 v[36:39], a[132:135], a[76:79], v[36:39]
    v_mfma_f32_16x16x32_bf16 v[40:43], a[128:131], a[80:83], v[40:43]
    v_mfma_f32_16x16x32_bf16 v[40:43], a[132:135], a[84:87], v[40:43]
    v_mfma_f32_16x16x32_bf16 v[44:47], a[128:131], a[88:91], v[44:47]
    v_mfma_f32_16x16x32_bf16 v[44:47], a[132:135], a[92:95], v[44:47]
    s_waitcnt lgkmcnt(10)
    v_mfma_f32_16x16x32_bf16 v[48:51], a[136:139], a[64:67], v[48:51]
    s_waitcnt lgkmcnt(8)
    v_mfma_f32_16x16x32_bf16 v[48:51], a[140:143], a[68:71], v[48:51]
    v_mfma_f32_16x16x32_bf16 v[52:55], a[136:139], a[72:75], v[52:55]
    v_mfma_f32_16x16x32_bf16 v[52:55], a[140:143], a[76:79], v[52:55]
    v_mfma_f32_16x16x32_bf16 v[56:59], a[136:139], a[80:83], v[56:59]
    v_mfma_f32_16x16x32_bf16 v[56:59], a[140:143], a[84:87], v[56:59]
    v_mfma_f32_16x16x32_bf16 v[60:63], a[136:139], a[88:91], v[60:63]
    v_mfma_f32_16x16x32_bf16 v[60:63], a[140:143], a[92:95], v[60:63]
    s_waitcnt vmcnt(0) lgkmcnt(6)
    v_mfma_f32_16x16x32_bf16 v[64:67], a[144:147], a[64:67], v[64:67]
    s_waitcnt lgkmcnt(4)
    ds_read_b64_tr_b16 a[160:161], v12 offset:24576
    v_mfma_f32_16x16x32_bf16 v[64:67], a[148:151], a[68:71], v[64:67]
    ds_read_b64_tr_b16 a[162:163], v12 offset:26624
    v_mfma_f32_16x16x32_bf16 v[68:71], a[144:147], a[72:75], v[68:71]
    ds_read_b64_tr_b16 a[164:165], v12 offset:28672
    v_mfma_f32_16x16x32_bf16 v[68:71], a[148:151], a[76:79], v[68:71]
    ds_read_b64_tr_b16 a[166:167], v12 offset:30720
    v_mfma_f32_16x16x32_bf16 v[72:75], a[144:147], a[80:83], v[72:75]
    ds_read_b64_tr_b16 a[168:169], v13 offset:24576
    v_mfma_f32_16x16x32_bf16 v[72:75], a[148:151], a[84:87], v[72:75]
    ds_read_b64_tr_b16 a[170:171], v13 offset:26624
    v_mfma_f32_16x16x32_bf16 v[76:79], a[144:147], a[88:91], v[76:79]
    ds_read_b64_tr_b16 a[172:173], v13 offset:28672
    v_mfma_f32_16x16x32_bf16 v[76:79], a[148:151], a[92:95], v[76:79]
    s_waitcnt lgkmcnt(9)
    ds_read_b64_tr_b16 a[174:175], v13 offset:30720
    v_mfma_f32_16x16x32_bf16 v[80:83], a[152:155], a[64:67], v[80:83]
    s_waitcnt lgkmcnt(8)
    ds_read_b64_tr_b16 a[176:177], v14 offset:24576
    v_mfma_f32_16x16x32_bf16 v[80:83], a[156:159], a[68:71], v[80:83]
    ds_read_b64_tr_b16 a[178:179], v14 offset:26624
    v_mfma_f32_16x16x32_bf16 v[84:87], a[152:155], a[72:75], v[84:87]
    ds_read_b64_tr_b16 a[180:181], v14 offset:28672
    v_mfma_f32_16x16x32_bf16 v[84:87], a[156:159], a[76:79], v[84:87]
    ds_read_b64_tr_b16 a[182:183], v14 offset:30720
    v_mfma_f32_16x16x32_bf16 v[88:91], a[152:155], a[80:83], v[88:91]
    ds_read_b64_tr_b16 a[184:185], v15 offset:24576
    v_mfma_f32_16x16x32_bf16 v[88:91], a[156:159], a[84:87], v[88:91]
    ds_read_b64_tr_b16 a[186:187], v15 offset:26624
    v_mfma_f32_16x16x32_bf16 v[92:95], a[152:155], a[88:91], v[92:95]
    ds_read_b64_tr_b16 a[188:189], v15 offset:28672
    v_mfma_f32_16x16x32_bf16 v[92:95], a[156:159], a[92:95], v[92:95]
    s_waitcnt lgkmcnt(13)
    ds_read_b64_tr_b16 a[190:191], v15 offset:30720
    v_mfma_f32_16x16x32_bf16 v[32:35], a[160:163], a[96:99], v[32:35]
    s_waitcnt lgkmcnt(12)
    v_mfma_f32_16x16x32_bf16 v[32:35], a[164:167], a[100:103], v[32:35]
    v_mfma_f32_16x16x32_bf16 v[36:39], a[160:163], a[104:107], v[36:39]
    v_mfma_f32_16x16x32_bf16 v[36:39], a[164:167], a[108:111], v[36:39]
    v_mfma_f32_16x16x32_bf16 v[40:43], a[160:163], a[112:115], v[40:43]
    v_mfma_f32_16x16x32_bf16 v[40:43], a[164:167], a[116:119], v[40:43]
    v_mfma_f32_16x16x32_bf16 v[44:47], a[160:163], a[120:123], v[44:47]
    v_mfma_f32_16x16x32_bf16 v[44:47], a[164:167], a[124:127], v[44:47]
    s_waitcnt lgkmcnt(10)
    v_mfma_f32_16x16x32_bf16 v[48:51], a[168:171], a[96:99], v[48:51]
    s_waitcnt lgkmcnt(8)
    v_mfma_f32_16x16x32_bf16 v[48:51], a[172:175], a[100:103], v[48:51]
    v_mfma_f32_16x16x32_bf16 v[52:55], a[168:171], a[104:107], v[52:55]
    v_mfma_f32_16x16x32_bf16 v[52:55], a[172:175], a[108:111], v[52:55]
    v_mfma_f32_16x16x32_bf16 v[56:59], a[168:171], a[112:115], v[56:59]
    v_mfma_f32_16x16x32_bf16 v[56:59], a[172:175], a[116:119], v[56:59]
    v_mfma_f32_16x16x32_bf16 v[60:63], a[168:171], a[120:123], v[60:63]
    v_mfma_f32_16x16x32_bf16 v[60:63], a[172:175], a[124:127], v[60:63]
    s_waitcnt lgkmcnt(6)
    v_mfma_f32_16x16x32_bf16 v[64:67], a[176:179], a[96:99], v[64:67]
    s_waitcnt lgkmcnt(4)
    v_mfma_f32_16x16x32_bf16 v[64:67], a[180:183], a[100:103], v[64:67]
    v_mfma_f32_16x16x32_bf16 v[68:71], a[176:179], a[104:107], v[68:71]
    v_mfma_f32_16x16x32_bf16 v[68:71], a[180:183], a[108:111], v[68:71]
    v_mfma_f32_16x16x32_bf16 v[72:75], a[176:179], a[112:115], v[72:75]
    v_mfma_f32_16x16x32_bf16 v[72:75], a[180:183], a[116:119], v[72:75]
    v_mfma_f32_16x16x32_bf16 v[76:79], a[176:179], a[120:123], v[76:79]
    v_mfma_f32_16x16x32_bf16 v[76:79], a[180:183], a[124:127], v[76:79]
    s_waitcnt lgkmcnt(2)
    v_mfma_f32_16x16x32_bf16 v[80:83], a[184:187], a[96:99], v[80:83]
    s_waitcnt lgkmcnt(0)
    v_mfma_f32_16x16x32_bf16 v[80:83], a[188:191], a[100:103], v[80:83]
    v_mfma_f32_16x16x32_bf16 v[84:87], a[184:187], a[104:107], v[84:87]
    v_mfma_f32_16x16x32_bf16 v[84:87], a[188:191], a[108:111], v[84:87]
    v_mfma_f32_16x16x32_bf16 v[88:91], a[184:187], a[112:115], v[88:91]
    v_mfma_f32_16x16x32_bf16 v[88:91], a[188:191], a[116:119], v[88:91]
    v_mfma_f32_16x16x32_bf16 v[92:95], a[184:187], a[120:123], v[92:95]
    v_mfma_f32_16x16x32_bf16 v[92:95], a[188:191], a[124:127], v[92:95]
    s_barrier
    s_lshl_b32 s19, s16, 14
    v_add_u32 v2, s19, v4
    s_lshl_b32 s19, s16, 12
    v_add_u32 v3, s19, v4
    s_nop 3
    ds_write_b128 v2, v[32:35] offset:0
    ds_write_b128 v2, v[48:51] offset:1024
    ds_write_b128 v2, v[64:67] offset:2048
    ds_write_b128 v2, v[80:83] offset:3072
    ds_write_b128 v2, v[36:39] offset:4096
    ds_write_b128 v2, v[52:55] offset:5120
    ds_write_b128 v2, v[68:71] offset:6144
    ds_write_b128 v2, v[84:87] offset:7168
    ds_write_b128 v2, v[40:43] offset:8192
    ds_write_b128 v2, v[56:59] offset:9216
    ds_write_b128 v2, v[72:75] offset:10240
    ds_write_b128 v2, v[88:91] offset:11264
    ds_write_b128 v2, v[44:47] offset:12288
    ds_write_b128 v2, v[60:63] offset:13312
    ds_write_b128 v2, v[76:79] offset:14336
    ds_write_b128 v2, v[92:95] offset:15360
    s_waitcnt lgkmcnt(0)
    s_barrier
    ds_read_b128 v[32:35], v3 offset:0
    ds_read_b128 v[36:39], v3 offset:16384
    ds_read_b128 v[40:43], v3 offset:32768
    ds_read_b128 v[44:47], v3 offset:49152
    ds_read_b128 v[48:51], v3 offset:1024
    ds_read_b128 v[52:55], v3 offset:17408
    ds_read_b128 v[56:59], v3 offset:33792
    ds_read_b128 v[60:63], v3 offset:50176
    ds_read_b128 v[64:67], v3 offset:2048
    ds_read_b128 v[68:71], v3 offset:18432
    ds_read_b128 v[72:75], v3 offset:34816
    ds_read_b128 v[76:79], v3 offset:51200
    ds_read_b128 v[80:83], v3 offset:3072
    ds_read_b128 v[84:87], v3 offset:19456
    ds_read_b128 v[88:91], v3 offset:35840
    ds_read_b128 v[92:95], v3 offset:52224
    v_and_b32 v2, 15, v1
    v_mul_u32_u24 v2, 1792, v2
    v_lshrrev_b32 v3, 4, v1
    v_lshl_add_u32 v2, v3, 3, v2
    s_lshl_b32 s19, s17, 2
    s_add_u32 s19, s19, s16
    s_mul_i32 s19, s19, 28672
    s_lshl_b32 s20, s18, 7
    s_add_u32 s19, s19, s20
    s_waitcnt lgkmcnt(12)
    v_add_f32 v32, v32, v36
    v_add_f32 v40, v40, v44
    v_add_f32 v33, v33, v37
    v_add_f32 v41, v41, v45
    v_add_f32 v34, v34, v38
    v_add_f32 v42, v42, v46
    v_add_f32 v35, v35, v39
    v_add_f32 v43, v43, v47
    v_add_f32 v32, v32, v40
    v_add_f32 v33, v33, v41
    v_add_f32 v34, v34, v42
    v_add_f32 v35, v35, v43
    v_cvt_pk_bf16_f32 v32, v32, v33
    v_cvt_pk_bf16_f32 v33, v34, v35
    buffer_store_dwordx2 v[32:33], v2, s[12:15], s19 offen offset:896
    s_waitcnt lgkmcnt(8)
    v_add_f32 v48, v48, v52
    v_add_f32 v56, v56, v60
    v_add_f32 v49, v49, v53
    v_add_f32 v57, v57, v61
    v_add_f32 v50, v50, v54
    v_add_f32 v58, v58, v62
    v_add_f32 v51, v51, v55
    v_add_f32 v59, v59, v63
    v_add_f32 v48, v48, v56
    v_add_f32 v49, v49, v57
    v_add_f32 v50, v50, v58
    v_add_f32 v51, v51, v59
    v_cvt_pk_bf16_f32 v48, v48, v49
    v_cvt_pk_bf16_f32 v49, v50, v51
    buffer_store_dwordx2 v[48:49], v2, s[12:15], s19 offen offset:928
    s_waitcnt lgkmcnt(4)
    v_add_f32 v64, v64, v68
    v_add_f32 v72, v72, v76
    v_add_f32 v65, v65, v69
    v_add_f32 v73, v73, v77
    v_add_f32 v66, v66, v70
    v_add_f32 v74, v74, v78
    v_add_f32 v67, v67, v71
    v_add_f32 v75, v75, v79
    v_add_f32 v64, v64, v72
    v_add_f32 v65, v65, v73
    v_add_f32 v66, v66, v74
    v_add_f32 v67, v67, v75
    v_cvt_pk_bf16_f32 v64, v64, v65
    v_cvt_pk_bf16_f32 v65, v66, v67
    buffer_store_dwordx2 v[64:65], v2, s[12:15], s19 offen offset:960
    s_waitcnt lgkmcnt(0)
    v_add_f32 v80, v80, v84
    v_add_f32 v88, v88, v92
    v_add_f32 v81, v81, v85
    v_add_f32 v89, v89, v93
    v_add_f32 v82, v82, v86
    v_add_f32 v90, v90, v94
    v_add_f32 v83, v83, v87
    v_add_f32 v91, v91, v95
    v_add_f32 v80, v80, v88
    v_add_f32 v81, v81, v89
    v_add_f32 v82, v82, v90
    v_add_f32 v83, v83, v91
    v_cvt_pk_bf16_f32 v80, v80, v81
    v_cvt_pk_bf16_f32 v81, v82, v83
    buffer_store_dwordx2 v[80:81], v2, s[12:15], s19 offen offset:992
    s_branch K3_fin
K3_conv:
    s_mov_b32 s8, s72
    s_mov_b32 s9, s73
    s_mov_b32 s10, 1835008
    s_mov_b32 s11, 0x20000
    s_mov_b32 s24, s70
    s_mov_b32 s25, s71
    s_mov_b32 s26, 1835008
    s_mov_b32 s27, 0x20000
    s_and_b32 s17, s2, 7
    s_cmp_eq_u32 s17, 7
    s_cbranch_scc1 K3_end
    s_lshl_b32 s17, s17, 2
    s_bfe_u32 s23, s2, 0x20003
    s_add_u32 s23, s23, s17
    s_lshl_b32 s23, s23, 1
    s_lshr_b32 s17, s16, 1
    s_add_u32 s23, s23, s17
    s_lshl_b32 s23, s23, 3
    s_lshl_b32 s48, s23, 1
    s_add_u32 s50, s74, s48
    s_addc_u32 s51, s75, 0
    s_load_dwordx4 s[36:39], s[50:51], 0
    s_mul_i32 s21, s17, 42496
    s_and_b32 s49, s16, 1
    s_mul_i32 s18, s23, 4224
    s_lshl_b32 s17, s49, 2
    s_sub_u32 s18, s18, s17
    s_add_u32 s18, s18, 83886208
    s_sub_u32 s19, s18, 2
    s_lshl_b32 s20, s23, 12
    s_lshl_b32 s17, s49, 11
    s_add_u32 s20, s20, s17
    s_add_u32 s22, s21, s17
    s_add_u32 s22, s22, 17152
    v_and_b32 v1, 63, v0
    v_lshlrev_b32 v2, 4, v1
    v_and_b32 v10, 15, v1
    v_lshrrev_b32 v11, 4, v1
    v_lshrrev_b32 v12, 2, v10
    v_mul_u32_u24 v12, 4160, v12
    v_and_b32 v13, 3, v1
    v_lshl_add_u32 v12, v13, 3, v12
    v_lshlrev_b32 v13, 4, v11
    v_sub_u32 v12, v12, v13
    s_lshl_b32 s17, s49, 8
    s_add_u32 s52, s21, s17
    s_add_u32 s52, s52, 88
    v_add_u32 v3, s52, v12
    v_lshl_add_u32 v12, v10, 5, v13
    s_sub_u32 s52, s21, s17
    s_add_u32 s52, s52, 16928
    v_add_u32 v4, s52, v12
    v_lshlrev_b32 v12, 5, v10
    v_lshl_add_u32 v12, v11, 3, v12
    s_lshl_b32 s52, s49, 11
    s_add_u32 s52, s52, s21
    s_add_u32 s52, s52, 64
    v_add_u32 v7, s52, v12
    s_lshl_b32 s52, s16, 13
    s_add_u32 s52, s52, 84992
    v_add_u32 v5, s52, v2
    s_lshl_b32 s53, s49, 12
    s_sub_u32 s52, s52, s53
    v_add_u32 v6, s52, v2
    v_lshlrev_b32 v12, 4, v10
    v_lshl_add_u32 v12, v11, 2, v12
    s_lshl_b32 s52, s49, 10
    v_add_u32 v12, s52, v12
    v_mul_u32_u24 v8, 896, v12
    s_mul_i32 s17, s49, 8320
    s_add_u32 s21, s21, s17
    s_add_u32 s21, s21, 64
    s_add_u32 m0, s22, 0
    s_nop 0
    buffer_load_dwordx4 v2, s[8:11], s20 offen offset:0 lds
    buffer_load_dwordx4 v2, s[8:11], s20 offen offset:1024 lds
    s_add_u32 m0, s21, 0
    s_nop 0
    buffer_load_dwordx4 v2, s[4:7], s18 offen offset:0 lds
    buffer_load_dwordx4 v2, s[4:7], s18 offen offset:1024 lds
    buffer_load_dwordx4 v2, s[4:7], s18 offen offset:2048 lds
    buffer_load_dwordx4 v2, s[4:7], s18 offen offset:3072 lds
    s_add_u32 m0, s21, 4160
    s_nop 0
    buffer_load_dwordx4 v2, s[4:7], s19 offen offset:0 lds
    buffer_load_dwordx4 v2, s[4:7], s19 offen offset:1024 lds
    buffer_load_dwordx4 v2, s[4:7], s19 offen offset:2048 lds
    buffer_load_dwordx4 v2, s[4:7], s19 offen offset:3072 lds
    s_add_u32 s20, s20, 4096
    s_add_u32 s18, s18, 4224
    s_add_u32 s19, s19, 4224
    s_add_u32 m0, s22, 21248
    s_nop 0
    buffer_load_dwordx4 v2, s[8:11], s20 offen offset:0 lds
    buffer_load_dwordx4 v2, s[8:11], s20 offen offset:1024 lds
    s_add_u32 m0, s21, 21248
    s_nop 0
    buffer_load_dwordx4 v2, s[4:7], s18 offen offset:0 lds
    buffer_load_dwordx4 v2, s[4:7], s18 offen offset:1024 lds
    buffer_load_dwordx4 v2, s[4:7], s18 offen offset:2048 lds
    buffer_load_dwordx4 v2, s[4:7], s18 offen offset:3072 lds
    s_add_u32 m0, s21, 25408
    s_nop 0
    buffer_load_dwordx4 v2, s[4:7], s19 offen offset:0 lds
    buffer_load_dwordx4 v2, s[4:7], s19 offen offset:1024 lds
    buffer_load_dwordx4 v2, s[4:7], s19 offen offset:2048 lds
    buffer_load_dwordx4 v2, s[4:7], s19 offen offset:3072 lds
    s_add_u32 s20, s20, 4096
    s_add_u32 s18, s18, 4224
    s_add_u32 s19, s19, 4224
    v_mov_b32 v12, 0
    v_mov_b32 v13, 0
    s_mul_i32 s52, s16, 21248
    v_lshl_add_u32 v14, v1, 3, s52
    ds_write_b64 v14, v[12:13] offset:16640
    v_mul_u32_u24 v14, 4160, v11
    v_lshl_add_u32 v14, v10, 2, v14
    v_add_u32 v14, s52, v14
    ds_write_b32 v14, v12
    s_add_u32 s52, s48, 0
    buffer_load_dwordx4 v[64:67], v8, s[24:27], s52 offen offset:0
    buffer_load_dwordx4 v[68:71], v8, s[24:27], s52 offen offset:896
    buffer_load_dwordx4 v[72:75], v8, s[24:27], s52 offen offset:1792
    buffer_load_dwordx4 v[76:79], v8, s[24:27], s52 offen offset:2688
    s_add_u32 s52, s48, 229376
    buffer_load_dwordx4 v[80:83], v8, s[24:27], s52 offen offset:0
    buffer_load_dwordx4 v[84:87], v8, s[24:27], s52 offen offset:896
    buffer_load_dwordx4 v[88:91], v8, s[24:27], s52 offen offset:1792
    buffer_load_dwordx4 v[92:95], v8, s[24:27], s52 offen offset:2688
    s_add_u32 s52, s48, 458752
    buffer_load_dwordx4 v[96:99], v8, s[24:27], s52 offen offset:0
    buffer_load_dwordx4 v[100:103], v8, s[24:27], s52 offen offset:896
    buffer_load_dwordx4 v[104:107], v8, s[24:27], s52 offen offset:1792
    buffer_load_dwordx4 v[108:111], v8, s[24:27], s52 offen offset:2688
    s_add_u32 s52, s48, 688128
    buffer_load_dwordx4 v[112:115], v8, s[24:27], s52 offen offset:0
    buffer_load_dwordx4 v[116:119], v8, s[24:27], s52 offen offset:896
    buffer_load_dwordx4 v[120:123], v8, s[24:27], s52 offen offset:1792
    buffer_load_dwordx4 v[124:127], v8, s[24:27], s52 offen offset:2688
    v_lshlrev_b32 v8, 1, v8
    s_waitcnt lgkmcnt(0)
    s_lshl_b32 s40, s36, 16
    s_and_b32 s41, s36, 0xffff0000
    s_lshl_b32 s42, s37, 16
    s_and_b32 s43, s37, 0xffff0000
    s_lshl_b32 s44, s38, 16
    s_and_b32 s45, s38, 0xffff0000
    s_lshl_b32 s46, s39, 16
    s_and_b32 s47, s39, 0xffff0000
    s_waitcnt vmcnt(26)
    s_barrier
    ds_read_b64_tr_b16 a[0:1], v3 offset:8
    ds_read_b64_tr_b16 a[2:3], v3 offset:0
    ds_read_b128 a[32:35], v4 offset:192
    ds_read_b64_tr_b16 a[4:5], v3 offset:520
    ds_read_b64_tr_b16 a[6:7], v3 offset:512
    ds_read_b128 a[36:39], v4 offset:704
    ds_read_b64_tr_b16 a[8:9], v3 offset:1032
    ds_read_b64_tr_b16 a[10:11], v3 offset:1024
    ds_read_b128 a[40:43], v4 offset:1216
    ds_read_b64_tr_b16 a[12:13], v3 offset:1544
    ds_read_b64_tr_b16 a[14:15], v3 offset:1536
    ds_read_b128 a[44:47], v4 offset:1728
    ds_read_b64_tr_b16 a[16:17], v3 offset:2056
    ds_read_b64_tr_b16 a[18:19], v3 offset:2048
    ds_read_b128 a[48:51], v4 offset:2240
    ds_read_b64_tr_b16 a[20:21], v3 offset:2568
    ds_read_b64_tr_b16 a[22:23], v3 offset:2560
    ds_read_b128 a[52:55], v4 offset:2752
    ds_read_b64_tr_b16 a[24:25], v3 offset:3080
    ds_read_b64_tr_b16 a[26:27], v3 offset:3072
    ds_read_b128 a[56:59], v4 offset:3264
    ds_read_b64_tr_b16 a[28:29], v3 offset:3592
    ds_read_b64_tr_b16 a[30:31], v3 offset:3584
    ds_read_b128 a[60:63], v4 offset:3776
    s_waitcnt lgkmcnt(0)
    v_mfma_f32_16x16x32_bf16 v[32:35], a[0:3], a[32:35], 0
    ds_read_b64_tr_b16 a[64:65], v3 offset:72
    v_mfma_f32_16x16x32_bf16 v[36:39], a[0:3], a[36:39], 0
    ds_read_b64_tr_b16 a[66:67], v3 offset:64
    v_mfma_f32_16x16x32_bf16 v[36:39], a[4:7], a[32:35], v[36:39]
    ds_read_b128 a[96:99], v4 offset:128
    v_mfma_f32_16x16x32_bf16 v[40:43], a[0:3], a[40:43], 0
    ds_read_b64_tr_b16 a[68:69], v3 offset:584
    v_mfma_f32_16x16x32_bf16 v[40:43], a[4:7], a[36:39], v[40:43]
    v_mfma_f32_16x16x32_bf16 v[40:43], a[8:11], a[32:35], v[40:43]
    ds_read_b64_tr_b16 a[70:71], v3 offset:576
    v_mfma_f32_16x16x32_bf16 v[44:47], a[0:3], a[44:47], 0
    ds_read_b128 a[100:103], v4 offset:640
    v_mfma_f32_16x16x32_bf16 v[44:47], a[4:7], a[40:43], v[44:47]
    ds_read_b64_tr_b16 a[72:73], v3 offset:1096
    v_mfma_f32_16x16x32_bf16 v[44:47], a[8:11], a[36:39], v[44:47]
    ds_read_b64_tr_b16 a[74:75], v3 offset:1088
    v_mfma_f32_16x16x32_bf16 v[44:47], a[12:15], a[32:35], v[44:47]
    v_mfma_f32_16x16x32_bf16 v[48:51], a[0:3], a[48:51], 0
    ds_read_b128 a[104:107], v4 offset:1152
    v_mfma_f32_16x16x32_bf16 v[48:51], a[4:7], a[44:47], v[48:51]
    ds_read_b64_tr_b16 a[76:77], v3 offset:1608
    v_mfma_f32_16x16x32_bf16 v[48:51], a[8:11], a[40:43], v[48:51]
    ds_read_b64_tr_b16 a[78:79], v3 offset:1600
    v_mfma_f32_16x16x32_bf16 v[48:51], a[12:15], a[36:39], v[48:51]
    ds_read_b128 a[108:111], v4 offset:1664
    v_mfma_f32_16x16x32_bf16 v[48:51], a[16:19], a[32:35], v[48:51]
    v_mfma_f32_16x16x32_bf16 v[52:55], a[0:3], a[52:55], 0
    ds_read_b64_tr_b16 a[80:81], v3 offset:2120
    v_mfma_f32_16x16x32_bf16 v[52:55], a[4:7], a[48:51], v[52:55]
    ds_read_b64_tr_b16 a[82:83], v3 offset:2112
    v_mfma_f32_16x16x32_bf16 v[52:55], a[8:11], a[44:47], v[52:55]
    ds_read_b128 a[112:115], v4 offset:2176
    v_mfma_f32_16x16x32_bf16 v[52:55], a[12:15], a[40:43], v[52:55]
    ds_read_b64_tr_b16 a[84:85], v3 offset:2632
    v_mfma_f32_16x16x32_bf16 v[52:55], a[16:19], a[36:39], v[52:55]
    v_mfma_f32_16x16x32_bf16 v[52:55], a[20:23], a[32:35], v[52:55]
    ds_read_b64_tr_b16 a[86:87], v3 offset:2624
    v_mfma_f32_16x16x32_bf16 v[56:59], a[0:3], a[56:59], 0
    ds_read_b128 a[116:119], v4 offset:2688
    v_mfma_f32_16x16x32_bf16 v[56:59], a[4:7], a[52:55], v[56:59]
    ds_read_b64_tr_b16 a[88:89], v3 offset:3144
    v_mfma_f32_16x16x32_bf16 v[56:59], a[8:11], a[48:51], v[56:59]
    ds_read_b64_tr_b16 a[90:91], v3 offset:3136
    v_mfma_f32_16x16x32_bf16 v[56:59], a[12:15], a[44:47], v[56:59]
    v_mfma_f32_16x16x32_bf16 v[56:59], a[16:19], a[40:43], v[56:59]
    ds_read_b128 a[120:123], v4 offset:3200
    v_mfma_f32_16x16x32_bf16 v[56:59], a[20:23], a[36:39], v[56:59]
    ds_read_b64_tr_b16 a[92:93], v3 offset:3656
    v_mfma_f32_16x16x32_bf16 v[56:59], a[24:27], a[32:35], v[56:59]
    ds_read_b64_tr_b16 a[94:95], v3 offset:3648
    v_mfma_f32_16x16x32_bf16 v[60:63], a[0:3], a[60:63], 0
    ds_read_b128 a[124:127], v4 offset:3712
    v_mfma_f32_16x16x32_bf16 v[60:63], a[4:7], a[56:59], v[60:63]
    v_mfma_f32_16x16x32_bf16 v[60:63], a[8:11], a[52:55], v[60:63]
    v_mfma_f32_16x16x32_bf16 v[60:63], a[12:15], a[48:51], v[60:63]
    v_mfma_f32_16x16x32_bf16 v[60:63], a[16:19], a[44:47], v[60:63]
    v_mfma_f32_16x16x32_bf16 v[60:63], a[20:23], a[40:43], v[60:63]
    v_mfma_f32_16x16x32_bf16 v[60:63], a[24:27], a[36:39], v[60:63]
    v_mfma_f32_16x16x32_bf16 v[60:63], a[28:31], a[32:35], v[60:63]
    s_waitcnt lgkmcnt(15)
    v_mfma_f32_16x16x32_bf16 v[32:35], a[64:67], a[96:99], v[32:35]
    ds_read_b64_tr_b16 a[0:1], v3 offset:136
    v_mfma_f32_16x16x32_bf16 v[36:39], a[64:67], a[100:103], v[36:39]
    ds_read_b64_tr_b16 a[2:3], v3 offset:128
    v_mfma_f32_16x16x32_bf16 v[36:39], a[68:71], a[96:99], v[36:39]
    ds_read_b128 a[32:35], v4 offset:64
    v_mfma_f32_16x16x32_bf16 v[40:43], a[64:67], a[104:107], v[40:43]
    ds_read_b64_tr_b16 a[4:5], v3 offset:648
    v_mfma_f32_16x16x32_bf16 v[40:43], a[68:71], a[100:103], v[40:43]
    v_mfma_f32_16x16x32_bf16 v[40:43], a[72:75], a[96:99], v[40:43]
    s_waitcnt lgkmcnt(15)
    ds_read_b64_tr_b16 a[6:7], v3 offset:640
    v_mfma_f32_16x16x32_bf16 v[44:47], a[64:67], a[108:111], v[44:47]
    ds_read_b128 a[36:39], v4 offset:576
    v_mfma_f32_16x16x32_bf16 v[44:47], a[68:71], a[104:107], v[44:47]
    ds_read_b64_tr_b16 a[8:9], v3 offset:1160
    v_mfma_f32_16x16x32_bf16 v[44:47], a[72:75], a[100:103], v[44:47]
    ds_read_b64_tr_b16 a[10:11], v3 offset:1152
    v_mfma_f32_16x16x32_bf16 v[44:47], a[76:79], a[96:99], v[44:47]
    s_waitcnt lgkmcnt(15)
    v_mfma_f32_16x16x32_bf16 v[48:51], a[64:67], a[112:115], v[48:51]
    ds_read_b128 a[40:43], v4 offset:1088
    v_mfma_f32_16x16x32_bf16 v[48:51], a[68:71], a[108:111], v[48:51]
    ds_read_b64_tr_b16 a[12:13], v3 offset:1672
    v_mfma_f32_16x16x32_bf16 v[48:51], a[72:75], a[104:107], v[48:51]
    ds_read_b64_tr_b16 a[14:15], v3 offset:1664
    v_mfma_f32_16x16x32_bf16 v[48:51], a[76:79], a[100:103], v[48:51]
    ds_read_b128 a[44:47], v4 offset:1600
    v_mfma_f32_16x16x32_bf16 v[48:51], a[80:83], a[96:99], v[48:51]
    s_waitcnt lgkmcnt(15)
    v_mfma_f32_16x16x32_bf16 v[52:55], a[64:67], a[116:119], v[52:55]
    ds_read_b64_tr_b16 a[16:17], v3 offset:2184
    v_mfma_f32_16x16x32_bf16 v[52:55], a[68:71], a[112:115], v[52:55]
    ds_read_b64_tr_b16 a[18:19], v3 offset:2176
    v_mfma_f32_16x16x32_bf16 v[52:55], a[72:75], a[108:111], v[52:55]
    ds_read_b128 a[48:51], v4 offset:2112
    v_mfma_f32_16x16x32_bf16 v[52:55], a[76:79], a[104:107], v[52:55]
    ds_read_b64_tr_b16 a[20:21], v3 offset:2696
    v_mfma_f32_16x16x32_bf16 v[52:55], a[80:83], a[100:103], v[52:55]
    v_mfma_f32_16x16x32_bf16 v[52:55], a[84:87], a[96:99], v[52:55]
    ds_read_b64_tr_b16 a[22:23], v3 offset:2688
    v_mfma_f32_16x16x32_bf16 v[56:59], a[64:67], a[120:123], v[56:59]
    ds_read_b128 a[52:55], v4 offset:2624
    v_mfma_f32_16x16x32_bf16 v[56:59], a[68:71], a[116:119], v[56:59]
    ds_read_b64_tr_b16 a[24:25], v3 offset:3208
    v_mfma_f32_16x16x32_bf16 v[56:59], a[72:75], a[112:115], v[56:59]
    ds_read_b64_tr_b16 a[26:27], v3 offset:3200
    v_mfma_f32_16x16x32_bf16 v[56:59], a[76:79], a[108:111], v[56:59]
    v_mfma_f32_16x16x32_bf16 v[56:59], a[80:83], a[104:107], v[56:59]
    ds_read_b128 a[56:59], v4 offset:3136
    v_mfma_f32_16x16x32_bf16 v[56:59], a[84:87], a[100:103], v[56:59]
    ds_read_b64_tr_b16 a[28:29], v3 offset:3720
    v_mfma_f32_16x16x32_bf16 v[56:59], a[88:91], a[96:99], v[56:59]
    s_waitcnt lgkmcnt(15)
    ds_read_b64_tr_b16 a[30:31], v3 offset:3712
    v_mfma_f32_16x16x32_bf16 v[60:63], a[64:67], a[124:127], v[60:63]
    ds_read_b128 a[60:63], v4 offset:3648
    v_mfma_f32_16x16x32_bf16 v[60:63], a[68:71], a[120:123], v[60:63]
    v_mfma_f32_16x16x32_bf16 v[60:63], a[72:75], a[116:119], v[60:63]
    v_mfma_f32_16x16x32_bf16 v[60:63], a[76:79], a[112:115], v[60:63]
    v_mfma_f32_16x16x32_bf16 v[60:63], a[80:83], a[108:111], v[60:63]
    v_mfma_f32_16x16x32_bf16 v[60:63], a[84:87], a[104:107], v[60:63]
    v_mfma_f32_16x16x32_bf16 v[60:63], a[88:91], a[100:103], v[60:63]
    v_mfma_f32_16x16x32_bf16 v[60:63], a[92:95], a[96:99], v[60:63]
    v_mfma_f32_16x16x32_bf16 v[32:35], a[0:3], a[32:35], v[32:35]
    ds_read_b64_tr_b16 a[64:65], v3 offset:200
    v_mfma_f32_16x16x32_bf16 v[36:39], a[0:3], a[36:39], v[36:39]
    ds_read_b64_tr_b16 a[66:67], v3 offset:192
    v_mfma_f32_16x16x32_bf16 v[36:39], a[4:7], a[32:35], v[36:39]
    s_waitcnt lgkmcnt(15)
    ds_read_b128 a[96:99], v4 offset:0
    v_mfma_f32_16x16x32_bf16 v[40:43], a[0:3], a[40:43], v[40:43]
    ds_read_b64_tr_b16 a[68:69], v3 offset:712
    v_mfma_f32_16x16x32_bf16 v[40:43], a[4:7], a[36:39], v[40:43]
    v_mfma_f32_16x16x32_bf16 v[40:43], a[8:11], a[32:35], v[40:43]
    s_waitcnt lgkmcnt(15)
    ds_read_b64_tr_b16 a[70:71], v3 offset:704
    v_mfma_f32_16x16x32_bf16 v[44:47], a[0:3], a[44:47], v[44:47]
    ds_read_b128 a[100:103], v4 offset:512
    v_mfma_f32_16x16x32_bf16 v[44:47], a[4:7], a[40:43], v[44:47]
    ds_read_b64_tr_b16 a[72:73], v3 offset:1224
    v_mfma_f32_16x16x32_bf16 v[44:47], a[8:11], a[36:39], v[44:47]
    ds_read_b64_tr_b16 a[74:75], v3 offset:1216
    v_mfma_f32_16x16x32_bf16 v[44:47], a[12:15], a[32:35], v[44:47]
    s_waitcnt lgkmcnt(15)
    v_mfma_f32_16x16x32_bf16 v[48:51], a[0:3], a[48:51], v[48:51]
    ds_read_b128 a[104:107], v4 offset:1024
    v_mfma_f32_16x16x32_bf16 v[48:51], a[4:7], a[44:47], v[48:51]
    ds_read_b64_tr_b16 a[76:77], v3 offset:1736
    v_mfma_f32_16x16x32_bf16 v[48:51], a[8:11], a[40:43], v[48:51]
    ds_read_b64_tr_b16 a[78:79], v3 offset:1728
    v_mfma_f32_16x16x32_bf16 v[48:51], a[12:15], a[36:39], v[48:51]
    ds_read_b128 a[108:111], v4 offset:1536
    v_mfma_f32_16x16x32_bf16 v[48:51], a[16:19], a[32:35], v[48:51]
    s_waitcnt lgkmcnt(15)
    v_mfma_f32_16x16x32_bf16 v[52:55], a[0:3], a[52:55], v[52:55]
    ds_read_b64_tr_b16 a[80:81], v3 offset:2248
    v_mfma_f32_16x16x32_bf16 v[52:55], a[4:7], a[48:51], v[52:55]
    ds_read_b64_tr_b16 a[82:83], v3 offset:2240
    v_mfma_f32_16x16x32_bf16 v[52:55], a[8:11], a[44:47], v[52:55]
    ds_read_b128 a[112:115], v4 offset:2048
    v_mfma_f32_16x16x32_bf16 v[52:55], a[12:15], a[40:43], v[52:55]
    ds_read_b64_tr_b16 a[84:85], v3 offset:2760
    v_mfma_f32_16x16x32_bf16 v[52:55], a[16:19], a[36:39], v[52:55]
    v_mfma_f32_16x16x32_bf16 v[52:55], a[20:23], a[32:35], v[52:55]
    ds_read_b64_tr_b16 a[86:87], v3 offset:2752
    v_mfma_f32_16x16x32_bf16 v[56:59], a[0:3], a[56:59], v[56:59]
    ds_read_b128 a[116:119], v4 offset:2560
    v_mfma_f32_16x16x32_bf16 v[56:59], a[4:7], a[52:55], v[56:59]
    ds_read_b64_tr_b16 a[88:89], v3 offset:3272
    v_mfma_f32_16x16x32_bf16 v[56:59], a[8:11], a[48:51], v[56:59]
    ds_read_b64_tr_b16 a[90:91], v3 offset:3264
    v_mfma_f32_16x16x32_bf16 v[56:59], a[12:15], a[44:47], v[56:59]
    v_mfma_f32_16x16x32_bf16 v[56:59], a[16:19], a[40:43], v[56:59]
    ds_read_b128 a[120:123], v4 offset:3072
    v_mfma_f32_16x16x32_bf16 v[56:59], a[20:23], a[36:39], v[56:59]
    ds_read_b64_tr_b16 a[92:93], v3 offset:3784
    v_mfma_f32_16x16x32_bf16 v[56:59], a[24:27], a[32:35], v[56:59]
    s_waitcnt lgkmcnt(15)
    ds_read_b64_tr_b16 a[94:95], v3 offset:3776
    v_mfma_f32_16x16x32_bf16 v[60:63], a[0:3], a[60:63], v[60:63]
    ds_read_b128 a[124:127], v4 offset:3584
    v_mfma_f32_16x16x32_bf16 v[60:63], a[4:7], a[56:59], v[60:63]
    v_mfma_f32_16x16x32_bf16 v[60:63], a[8:11], a[52:55], v[60:63]
    ds_read_b64 v[176:177], v7 offset:0
    v_mfma_f32_16x16x32_bf16 v[60:63], a[12:15], a[48:51], v[60:63]
    ds_read_b64 v[178:179], v7 offset:512
    v_mfma_f32_16x16x32_bf16 v[60:63], a[16:19], a[44:47], v[60:63]
    ds_read_b64 v[180:181], v7 offset:1024
    v_mfma_f32_16x16x32_bf16 v[60:63], a[20:23], a[40:43], v[60:63]
    ds_read_b64 v[182:183], v7 offset:1536
    v_mfma_f32_16x16x32_bf16 v[60:63], a[24:27], a[36:39], v[60:63]
    v_mfma_f32_16x16x32_bf16 v[60:63], a[28:31], a[32:35], v[60:63]
    s_waitcnt vmcnt(0) lgkmcnt(0)
    s_barrier
    v_mfma_f32_16x16x32_bf16 v[32:35], a[64:67], a[96:99], v[32:35]
    ds_read_b64_tr_b16 a[0:1], v3 offset:21256
    v_mfma_f32_16x16x32_bf16 v[36:39], a[64:67], a[100:103], v[36:39]
    ds_read_b64_tr_b16 a[2:3], v3 offset:21248
    v_mfma_f32_16x16x32_bf16 v[36:39], a[68:71], a[96:99], v[36:39]
    ds_read_b128 a[32:35], v4 offset:21440
    v_mfma_f32_16x16x32_bf16 v[40:43], a[64:67], a[104:107], v[40:43]
    ds_read_b64_tr_b16 a[4:5], v3 offset:21768
    v_mfma_f32_16x16x32_bf16 v[40:43], a[68:71], a[100:103], v[40:43]
    ds_read_b64_tr_b16 a[6:7], v3 offset:21760
    v_mfma_f32_16x16x32_bf16 v[40:43], a[72:75], a[96:99], v[40:43]
    ds_read_b128 a[36:39], v4 offset:21952
    v_mfma_f32_16x16x32_bf16 v[44:47], a[64:67], a[108:111], v[44:47]
    ds_read_b64_tr_b16 a[8:9], v3 offset:22280
    v_mfma_f32_16x16x32_bf16 v[44:47], a[68:71], a[104:107], v[44:47]
    ds_read_b64_tr_b16 a[10:11], v3 offset:22272
    v_mfma_f32_16x16x32_bf16 v[44:47], a[72:75], a[100:103], v[44:47]
    ds_read_b128 a[40:43], v4 offset:22464
    ds_write_b128 v5, v[32:35] offset:0
    v_mfma_f32_16x16x32_bf16 v[44:47], a[76:79], a[96:99], v[44:47]
    ds_read_b64_tr_b16 a[12:13], v3 offset:22792
    v_mfma_f32_16x16x32_bf16 v[48:51], a[64:67], a[112:115], v[48:51]
    ds_read_b64_tr_b16 a[14:15], v3 offset:22784
    ds_write_b128 v5, v[36:39] offset:1024
    v_mfma_f32_16x16x32_bf16 v[48:51], a[68:71], a[108:111], v[48:51]
    ds_read_b128 a[44:47], v4 offset:22976
    v_mfma_f32_16x16x32_bf16 v[48:51], a[72:75], a[104:107], v[48:51]
    ds_read_b64_tr_b16 a[16:17], v3 offset:23304
    v_mfma_f32_16x16x32_bf16 v[48:51], a[76:79], a[100:103], v[48:51]
    ds_read_b64_tr_b16 a[18:19], v3 offset:23296
    ds_write_b128 v5, v[40:43] offset:2048
    v_mfma_f32_16x16x32_bf16 v[48:51], a[80:83], a[96:99], v[48:51]
    ds_read_b128 a[48:51], v4 offset:23488
    v_mfma_f32_16x16x32_bf16 v[52:55], a[64:67], a[116:119], v[52:55]
    ds_read_b64_tr_b16 a[20:21], v3 offset:23816
    v_mfma_f32_16x16x32_bf16 v[52:55], a[68:71], a[112:115], v[52:55]
    ds_read_b64_tr_b16 a[22:23], v3 offset:23808
    v_mfma_f32_16x16x32_bf16 v[52:55], a[72:75], a[108:111], v[52:55]
    ds_read_b128 a[52:55], v4 offset:24000
    ds_write_b128 v5, v[44:47] offset:3072
    v_mfma_f32_16x16x32_bf16 v[52:55], a[76:79], a[104:107], v[52:55]
    ds_read_b64_tr_b16 a[24:25], v3 offset:24328
    v_mfma_f32_16x16x32_bf16 v[52:55], a[80:83], a[100:103], v[52:55]
    ds_read_b64_tr_b16 a[26:27], v3 offset:24320
    v_mfma_f32_16x16x32_bf16 v[52:55], a[84:87], a[96:99], v[52:55]
    ds_read_b128 a[56:59], v4 offset:24512
    v_mfma_f32_16x16x32_bf16 v[56:59], a[64:67], a[120:123], v[56:59]
    ds_read_b64_tr_b16 a[28:29], v3 offset:24840
    v_mfma_f32_16x16x32_bf16 v[56:59], a[68:71], a[116:119], v[56:59]
    ds_read_b64_tr_b16 a[30:31], v3 offset:24832
    ds_write_b128 v5, v[48:51] offset:4096
    v_mfma_f32_16x16x32_bf16 v[56:59], a[72:75], a[112:115], v[56:59]
    ds_read_b128 a[60:63], v4 offset:25024
    v_mfma_f32_16x16x32_bf16 v[56:59], a[76:79], a[108:111], v[56:59]
    v_mfma_f32_16x16x32_bf16 v[56:59], a[80:83], a[104:107], v[56:59]
    v_mfma_f32_16x16x32_bf16 v[56:59], a[84:87], a[100:103], v[56:59]
    v_mfma_f32_16x16x32_bf16 v[56:59], a[88:91], a[96:99], v[56:59]
    v_mfma_f32_16x16x32_bf16 v[60:63], a[64:67], a[124:127], v[60:63]
    ds_write_b128 v5, v[52:55] offset:5120
    v_mfma_f32_16x16x32_bf16 v[60:63], a[68:71], a[120:123], v[60:63]
    v_mfma_f32_16x16x32_bf16 v[60:63], a[72:75], a[116:119], v[60:63]
    v_mfma_f32_16x16x32_bf16 v[60:63], a[76:79], a[112:115], v[60:63]
    v_mfma_f32_16x16x32_bf16 v[60:63], a[80:83], a[108:111], v[60:63]
    v_mfma_f32_16x16x32_bf16 v[60:63], a[84:87], a[104:107], v[60:63]
    v_mfma_f32_16x16x32_bf16 v[60:63], a[88:91], a[100:103], v[60:63]
    v_mfma_f32_16x16x32_bf16 v[60:63], a[92:95], a[96:99], v[60:63]
    s_waitcnt lgkmcnt(15)
    ds_write_b128 v5, v[56:59] offset:6144
    v_mfma_f32_16x16x32_bf16 v[32:35], a[0:3], a[32:35], 0
    s_add_u32 m0, s22, 0
    ds_read_b64_tr_b16 a[64:65], v3 offset:21320
    v_mfma_f32_16x16x32_bf16 v[36:39], a[0:3], a[36:39], 0
    ds_read_b64_tr_b16 a[66:67], v3 offset:21312
    v_mfma_f32_16x16x32_bf16 v[36:39], a[4:7], a[32:35], v[36:39]
    ds_read_b128 a[96:99], v4 offset:21376
    v_mfma_f32_16x16x32_bf16 v[40:43], a[0:3], a[40:43], 0
    ds_read_b64_tr_b16 a[68:69], v3 offset:21832
    v_mfma_f32_16x16x32_bf16 v[40:43], a[4:7], a[36:39], v[40:43]
    buffer_load_dwordx4 v2, s[8:11], s20 offen offset:0 lds
    v_mfma_f32_16x16x32_bf16 v[40:43], a[8:11], a[32:35], v[40:43]
    ds_read_b64_tr_b16 a[70:71], v3 offset:21824
    v_mfma_f32_16x16x32_bf16 v[44:47], a[0:3], a[44:47], 0
    ds_read_b128 a[100:103], v4 offset:21888
    v_mfma_f32_16x16x32_bf16 v[44:47], a[4:7], a[40:43], v[44:47]
    ds_write_b128 v5, v[60:63] offset:7168
    v_mfma_f32_16x16x32_bf16 v[44:47], a[8:11], a[36:39], v[44:47]
    ds_read_b64_tr_b16 a[72:73], v3 offset:22344
    v_mfma_f32_16x16x32_bf16 v[44:47], a[12:15], a[32:35], v[44:47]
    s_waitcnt lgkmcnt(15)
    ds_read_b64_tr_b16 a[74:75], v3 offset:22336
    v_mfma_f32_16x16x32_bf16 v[48:51], a[0:3], a[48:51], 0
    buffer_load_dwordx4 v2, s[8:11], s20 offen offset:1024 lds
    v_mfma_f32_16x16x32_bf16 v[48:51], a[4:7], a[44:47], v[48:51]
    s_add_u32 m0, s21, 0
    ds_read_b128 a[104:107], v4 offset:22400
    v_mfma_f32_16x16x32_bf16 v[48:51], a[8:11], a[40:43], v[48:51]
    ds_read_b64_tr_b16 a[76:77], v3 offset:22856
    v_mfma_f32_16x16x32_bf16 v[48:51], a[12:15], a[36:39], v[48:51]
    ds_read_b64_tr_b16 a[78:79], v3 offset:22848
    v_mfma_f32_16x16x32_bf16 v[48:51], a[16:19], a[32:35], v[48:51]
    ds_read_b128 a[108:111], v4 offset:22912
    v_mfma_f32_16x16x32_bf16 v[52:55], a[0:3], a[52:55], 0
    buffer_load_dwordx4 v2, s[4:7], s18 offen offset:0 lds
    v_mfma_f32_16x16x32_bf16 v[52:55], a[4:7], a[48:51], v[52:55]
    ds_read_b64_tr_b16 a[80:81], v3 offset:23368
    v_mfma_f32_16x16x32_bf16 v[52:55], a[8:11], a[44:47], v[52:55]
    ds_read_b64_tr_b16 a[82:83], v3 offset:23360
    v_mfma_f32_16x16x32_bf16 v[52:55], a[12:15], a[40:43], v[52:55]
    ds_read_b128 a[112:115], v4 offset:23424
    v_mfma_f32_16x16x32_bf16 v[52:55], a[16:19], a[36:39], v[52:55]
    ds_read_b64_tr_b16 a[84:85], v3 offset:23880
    v_mfma_f32_16x16x32_bf16 v[52:55], a[20:23], a[32:35], v[52:55]
    s_waitcnt lgkmcnt(15)
    buffer_load_dwordx4 v2, s[4:7], s18 offen offset:1024 lds
    v_mfma_f32_16x16x32_bf16 v[56:59], a[0:3], a[56:59], 0
    ds_read_b64_tr_b16 a[86:87], v3 offset:23872
    v_mfma_f32_16x16x32_bf16 v[56:59], a[4:7], a[52:55], v[56:59]
    ds_read_b128 a[116:119], v4 offset:23936
    v_mfma_f32_16x16x32_bf16 v[56:59], a[8:11], a[48:51], v[56:59]
    ds_read_b64_tr_b16 a[88:89], v3 offset:24392
    v_mfma_f32_16x16x32_bf16 v[56:59], a[12:15], a[44:47], v[56:59]
    ds_read_b64_tr_b16 a[90:91], v3 offset:24384
    v_mfma_f32_16x16x32_bf16 v[56:59], a[16:19], a[40:43], v[56:59]
    buffer_load_dwordx4 v2, s[4:7], s18 offen offset:2048 lds
    v_mfma_f32_16x16x32_bf16 v[56:59], a[20:23], a[36:39], v[56:59]
    ds_read_b128 a[120:123], v4 offset:24448
    v_mfma_f32_16x16x32_bf16 v[56:59], a[24:27], a[32:35], v[56:59]
    ds_read_b64_tr_b16 a[92:93], v3 offset:24904
    v_mfma_f32_16x16x32_bf16 v[60:63], a[0:3], a[60:63], 0
    ds_read_b64_tr_b16 a[94:95], v3 offset:24896
    v_mfma_f32_16x16x32_bf16 v[60:63], a[4:7], a[56:59], v[60:63]
    ds_read_b128 a[124:127], v4 offset:24960
    v_mfma_f32_16x16x32_bf16 v[60:63], a[8:11], a[52:55], v[60:63]
    buffer_load_dwordx4 v2, s[4:7], s18 offen offset:3072 lds
    v_mfma_f32_16x16x32_bf16 v[60:63], a[12:15], a[48:51], v[60:63]
    s_add_u32 m0, s21, 4160
    v_mfma_f32_16x16x32_bf16 v[60:63], a[16:19], a[44:47], v[60:63]
    buffer_load_dwordx4 v2, s[4:7], s19 offen offset:0 lds
    v_mfma_f32_16x16x32_bf16 v[60:63], a[20:23], a[40:43], v[60:63]
    buffer_load_dwordx4 v2, s[4:7], s19 offen offset:1024 lds
    v_mfma_f32_16x16x32_bf16 v[60:63], a[24:27], a[36:39], v[60:63]
    buffer_load_dwordx4 v2, s[4:7], s19 offen offset:2048 lds
    v_mfma_f32_16x16x32_bf16 v[60:63], a[28:31], a[32:35], v[60:63]
    s_waitcnt lgkmcnt(15)
    buffer_load_dwordx4 v2, s[4:7], s19 offen offset:3072 lds
    v_mfma_f32_16x16x32_bf16 v[32:35], a[64:67], a[96:99], v[32:35]
    s_add_u32 s20, s20, 4096
    ds_read_b64_tr_b16 a[0:1], v3 offset:21384
    v_mfma_f32_16x16x32_bf16 v[36:39], a[64:67], a[100:103], v[36:39]
    s_add_u32 s18, s18, 4224
    ds_read_b64_tr_b16 a[2:3], v3 offset:21376
    v_mfma_f32_16x16x32_bf16 v[36:39], a[68:71], a[96:99], v[36:39]
    s_add_u32 s19, s19, 4224
    ds_read_b128 a[32:35], v4 offset:21312
    v_mfma_f32_16x16x32_bf16 v[40:43], a[64:67], a[104:107], v[40:43]
    ds_read_b64_tr_b16 a[4:5], v3 offset:21896
    v_mfma_f32_16x16x32_bf16 v[40:43], a[68:71], a[100:103], v[40:43]
    v_mfma_f32_16x16x32_bf16 v[40:43], a[72:75], a[96:99], v[40:43]
    s_waitcnt lgkmcnt(15)
    ds_read_b64_tr_b16 a[6:7], v3 offset:21888
    v_mfma_f32_16x16x32_bf16 v[44:47], a[64:67], a[108:111], v[44:47]
    ds_read_b128 a[36:39], v4 offset:21824
    v_mfma_f32_16x16x32_bf16 v[44:47], a[68:71], a[104:107], v[44:47]
    ds_read_b64_tr_b16 a[8:9], v3 offset:22408
    v_mfma_f32_16x16x32_bf16 v[44:47], a[72:75], a[100:103], v[44:47]
    ds_read_b64_tr_b16 a[10:11], v3 offset:22400
    v_mfma_f32_16x16x32_bf16 v[44:47], a[76:79], a[96:99], v[44:47]
    s_waitcnt lgkmcnt(15)
    v_mfma_f32_16x16x32_bf16 v[48:51], a[64:67], a[112:115], v[48:51]
    ds_read_b128 a[40:43], v4 offset:22336
    v_mfma_f32_16x16x32_bf16 v[48:51], a[68:71], a[108:111], v[48:51]
    ds_read_b64_tr_b16 a[12:13], v3 offset:22920
    v_mfma_f32_16x16x32_bf16 v[48:51], a[72:75], a[104:107], v[48:51]
    ds_read_b64_tr_b16 a[14:15], v3 offset:22912
    v_mfma_f32_16x16x32_bf16 v[48:51], a[76:79], a[100:103], v[48:51]
    ds_read_b128 a[44:47], v4 offset:22848
    v_mfma_f32_16x16x32_bf16 v[48:51], a[80:83], a[96:99], v[48:51]
    s_waitcnt lgkmcnt(15)
    v_mfma_f32_16x16x32_bf16 v[52:55], a[64:67], a[116:119], v[52:55]
    ds_read_b64_tr_b16 a[16:17], v3 offset:23432
    v_mfma_f32_16x16x32_bf16 v[52:55], a[68:71], a[112:115], v[52:55]
    ds_read_b64_tr_b16 a[18:19], v3 offset:23424
    v_mfma_f32_16x16x32_bf16 v[52:55], a[72:75], a[108:111], v[52:55]
    ds_read_b128 a[48:51], v4 offset:23360
    v_mfma_f32_16x16x32_bf16 v[52:55], a[76:79], a[104:107], v[52:55]
    ds_read_b64_tr_b16 a[20:21], v3 offset:23944
    v_mfma_f32_16x16x32_bf16 v[52:55], a[80:83], a[100:103], v[52:55]
    v_mfma_f32_16x16x32_bf16 v[52:55], a[84:87], a[96:99], v[52:55]
    ds_read_b64_tr_b16 a[22:23], v3 offset:23936
    v_mfma_f32_16x16x32_bf16 v[56:59], a[64:67], a[120:123], v[56:59]
    ds_read_b128 a[52:55], v4 offset:23872
    v_mfma_f32_16x16x32_bf16 v[56:59], a[68:71], a[116:119], v[56:59]
    ds_read_b64_tr_b16 a[24:25], v3 offset:24456
    v_mfma_f32_16x16x32_bf16 v[56:59], a[72:75], a[112:115], v[56:59]
    ds_read_b64_tr_b16 a[26:27], v3 offset:24448
    v_mfma_f32_16x16x32_bf16 v[56:59], a[76:79], a[108:111], v[56:59]
    v_mfma_f32_16x16x32_bf16 v[56:59], a[80:83], a[104:107], v[56:59]
    ds_read_b128 a[56:59], v4 offset:24384
    v_mfma_f32_16x16x32_bf16 v[56:59], a[84:87], a[100:103], v[56:59]
    ds_read_b64_tr_b16 a[28:29], v3 offset:24968
    v_mfma_f32_16x16x32_bf16 v[56:59], a[88:91], a[96:99], v[56:59]
    s_waitcnt lgkmcnt(15)
    ds_read_b64_tr_b16 a[30:31], v3 offset:24960
    v_mfma_f32_16x16x32_bf16 v[60:63], a[64:67], a[124:127], v[60:63]
    ds_read_b128 a[60:63], v4 offset:24896
    v_mfma_f32_16x16x32_bf16 v[60:63], a[68:71], a[120:123], v[60:63]
    v_mfma_f32_16x16x32_bf16 v[60:63], a[72:75], a[116:119], v[60:63]
    v_mfma_f32_16x16x32_bf16 v[60:63], a[76:79], a[112:115], v[60:63]
    v_mfma_f32_16x16x32_bf16 v[60:63], a[80:83], a[108:111], v[60:63]
    v_mfma_f32_16x16x32_bf16 v[60:63], a[84:87], a[104:107], v[60:63]
    v_mfma_f32_16x16x32_bf16 v[60:63], a[88:91], a[100:103], v[60:63]
    v_mfma_f32_16x16x32_bf16 v[60:63], a[92:95], a[96:99], v[60:63]
    v_mfma_f32_16x16x32_bf16 v[32:35], a[0:3], a[32:35], v[32:35]
    ds_read_b64_tr_b16 a[64:65], v3 offset:21448
    v_mfma_f32_16x16x32_bf16 v[36:39], a[0:3], a[36:39], v[36:39]
    ds_read_b64_tr_b16 a[66:67], v3 offset:21440
    v_mfma_f32_16x16x32_bf16 v[36:39], a[4:7], a[32:35], v[36:39]
    s_waitcnt lgkmcnt(15)
    ds_read_b128 a[96:99], v4 offset:21248
    v_mfma_f32_16x16x32_bf16 v[40:43], a[0:3], a[40:43], v[40:43]
    ds_read_b64_tr_b16 a[68:69], v3 offset:21960
    v_mfma_f32_16x16x32_bf16 v[40:43], a[4:7], a[36:39], v[40:43]
    v_mfma_f32_16x16x32_bf16 v[40:43], a[8:11], a[32:35], v[40:43]
    s_waitcnt lgkmcnt(15)
    ds_read_b64_tr_b16 a[70:71], v3 offset:21952
    v_mfma_f32_16x16x32_bf16 v[44:47], a[0:3], a[44:47], v[44:47]
    ds_read_b128 a[100:103], v4 offset:21760
    v_mfma_f32_16x16x32_bf16 v[44:47], a[4:7], a[40:43], v[44:47]
    ds_read_b64_tr_b16 a[72:73], v3 offset:22472
    v_mfma_f32_16x16x32_bf16 v[44:47], a[8:11], a[36:39], v[44:47]
    ds_read_b64_tr_b16 a[74:75], v3 offset:22464
    v_mfma_f32_16x16x32_bf16 v[44:47], a[12:15], a[32:35], v[44:47]
    s_waitcnt lgkmcnt(15)
    v_mfma_f32_16x16x32_bf16 v[48:51], a[0:3], a[48:51], v[48:51]
    ds_read_b128 a[104:107], v4 offset:22272
    v_mfma_f32_16x16x32_bf16 v[48:51], a[4:7], a[44:47], v[48:51]
    ds_read_b64_tr_b16 a[76:77], v3 offset:22984
    v_mfma_f32_16x16x32_bf16 v[48:51], a[8:11], a[40:43], v[48:51]
    ds_read_b64_tr_b16 a[78:79], v3 offset:22976
    v_mfma_f32_16x16x32_bf16 v[48:51], a[12:15], a[36:39], v[48:51]
    ds_read_b128 a[108:111], v4 offset:22784
    v_mfma_f32_16x16x32_bf16 v[48:51], a[16:19], a[32:35], v[48:51]
    s_waitcnt lgkmcnt(15)
    v_mfma_f32_16x16x32_bf16 v[52:55], a[0:3], a[52:55], v[52:55]
    ds_read_b64_tr_b16 a[80:81], v3 offset:23496
    v_mfma_f32_16x16x32_bf16 v[52:55], a[4:7], a[48:51], v[52:55]
    ds_read_b64_tr_b16 a[82:83], v3 offset:23488
    v_mfma_f32_16x16x32_bf16 v[52:55], a[8:11], a[44:47], v[52:55]
    ds_read_b128 a[112:115], v4 offset:23296
    v_mfma_f32_16x16x32_bf16 v[52:55], a[12:15], a[40:43], v[52:55]
    ds_read_b64_tr_b16 a[84:85], v3 offset:24008
    v_mfma_f32_16x16x32_bf16 v[52:55], a[16:19], a[36:39], v[52:55]
    v_mfma_f32_16x16x32_bf16 v[52:55], a[20:23], a[32:35], v[52:55]
    ds_read_b64_tr_b16 a[86:87], v3 offset:24000
    v_mfma_f32_16x16x32_bf16 v[56:59], a[0:3], a[56:59], v[56:59]
    ds_read_b128 a[116:119], v4 offset:23808
    v_mfma_f32_16x16x32_bf16 v[56:59], a[4:7], a[52:55], v[56:59]
    ds_read_b64_tr_b16 a[88:89], v3 offset:24520
    v_mfma_f32_16x16x32_bf16 v[56:59], a[8:11], a[48:51], v[56:59]
    ds_read_b64_tr_b16 a[90:91], v3 offset:24512
    v_mfma_f32_16x16x32_bf16 v[56:59], a[12:15], a[44:47], v[56:59]
    v_mfma_f32_16x16x32_bf16 v[56:59], a[16:19], a[40:43], v[56:59]
    ds_read_b128 a[120:123], v4 offset:24320
    v_mfma_f32_16x16x32_bf16 v[56:59], a[20:23], a[36:39], v[56:59]
    ds_read_b64_tr_b16 a[92:93], v3 offset:25032
    v_mfma_f32_16x16x32_bf16 v[56:59], a[24:27], a[32:35], v[56:59]
    s_waitcnt lgkmcnt(15)
    ds_read_b64_tr_b16 a[94:95], v3 offset:25024
    v_mfma_f32_16x16x32_bf16 v[60:63], a[0:3], a[60:63], v[60:63]
    ds_read_b128 a[124:127], v4 offset:24832
    v_mfma_f32_16x16x32_bf16 v[60:63], a[4:7], a[56:59], v[60:63]
    v_mfma_f32_16x16x32_bf16 v[60:63], a[8:11], a[52:55], v[60:63]
    ds_read_b64 v[184:185], v7 offset:21248
    v_mfma_f32_16x16x32_bf16 v[60:63], a[12:15], a[48:51], v[60:63]
    ds_read_b64 v[186:187], v7 offset:21760
    v_mfma_f32_16x16x32_bf16 v[60:63], a[16:19], a[44:47], v[60:63]
    ds_read_b64 v[188:189], v7 offset:22272
    v_mfma_f32_16x16x32_bf16 v[60:63], a[20:23], a[40:43], v[60:63]
    ds_read_b64 v[190:191], v7 offset:22784
    v_mfma_f32_16x16x32_bf16 v[60:63], a[24:27], a[36:39], v[60:63]
    v_mfma_f32_16x16x32_bf16 v[60:63], a[28:31], a[32:35], v[60:63]
    s_waitcnt vmcnt(0) lgkmcnt(0)
    s_barrier
    v_mfma_f32_16x16x32_bf16 v[32:35], a[64:67], a[96:99], v[32:35]
    ds_read_b64_tr_b16 a[0:1], v3 offset:8
    v_mfma_f32_16x16x32_bf16 v[36:39], a[64:67], a[100:103], v[36:39]
    ds_read_b64_tr_b16 a[2:3], v3 offset:0
    v_mfma_f32_16x16x32_bf16 v[36:39], a[68:71], a[96:99], v[36:39]
    ds_read_b128 a[32:35], v4 offset:192
    v_mfma_f32_16x16x32_bf16 v[40:43], a[64:67], a[104:107], v[40:43]
    ds_read_b64_tr_b16 a[4:5], v3 offset:520
    v_mfma_f32_16x16x32_bf16 v[40:43], a[68:71], a[100:103], v[40:43]
    ds_read_b64_tr_b16 a[6:7], v3 offset:512
    v_mfma_f32_16x16x32_bf16 v[40:43], a[72:75], a[96:99], v[40:43]
    ds_read_b128 a[36:39], v4 offset:704
    v_mfma_f32_16x16x32_bf16 v[44:47], a[64:67], a[108:111], v[44:47]
    ds_read_b64_tr_b16 a[8:9], v3 offset:1032
    v_mfma_f32_16x16x32_bf16 v[44:47], a[68:71], a[104:107], v[44:47]
    ds_read_b64_tr_b16 a[10:11], v3 offset:1024
    v_mfma_f32_16x16x32_bf16 v[44:47], a[72:75], a[100:103], v[44:47]
    ds_read_b128 a[40:43], v4 offset:1216
    ds_write_b128 v5, v[32:35] offset:32768
    v_mfma_f32_16x16x32_bf16 v[44:47], a[76:79], a[96:99], v[44:47]
    ds_read_b64_tr_b16 a[12:13], v3 offset:1544
    v_mfma_f32_16x16x32_bf16 v[48:51], a[64:67], a[112:115], v[48:51]
    ds_read_b64_tr_b16 a[14:15], v3 offset:1536
    ds_write_b128 v5, v[36:39] offset:33792
    v_mfma_f32_16x16x32_bf16 v[48:51], a[68:71], a[108:111], v[48:51]
    ds_read_b128 a[44:47], v4 offset:1728
    v_mfma_f32_16x16x32_bf16 v[48:51], a[72:75], a[104:107], v[48:51]
    ds_read_b64_tr_b16 a[16:17], v3 offset:2056
    v_mfma_f32_16x16x32_bf16 v[48:51], a[76:79], a[100:103], v[48:51]
    ds_read_b64_tr_b16 a[18:19], v3 offset:2048
    ds_write_b128 v5, v[40:43] offset:34816
    v_mfma_f32_16x16x32_bf16 v[48:51], a[80:83], a[96:99], v[48:51]
    ds_read_b128 a[48:51], v4 offset:2240
    v_mfma_f32_16x16x32_bf16 v[52:55], a[64:67], a[116:119], v[52:55]
    ds_read_b64_tr_b16 a[20:21], v3 offset:2568
    v_mfma_f32_16x16x32_bf16 v[52:55], a[68:71], a[112:115], v[52:55]
    ds_read_b64_tr_b16 a[22:23], v3 offset:2560
    v_mfma_f32_16x16x32_bf16 v[52:55], a[72:75], a[108:111], v[52:55]
    ds_read_b128 a[52:55], v4 offset:2752
    ds_write_b128 v5, v[44:47] offset:35840
    v_mfma_f32_16x16x32_bf16 v[52:55], a[76:79], a[104:107], v[52:55]
    ds_read_b64_tr_b16 a[24:25], v3 offset:3080
    v_mfma_f32_16x16x32_bf16 v[52:55], a[80:83], a[100:103], v[52:55]
    ds_read_b64_tr_b16 a[26:27], v3 offset:3072
    v_mfma_f32_16x16x32_bf16 v[52:55], a[84:87], a[96:99], v[52:55]
    ds_read_b128 a[56:59], v4 offset:3264
    v_mfma_f32_16x16x32_bf16 v[56:59], a[64:67], a[120:123], v[56:59]
    ds_read_b64_tr_b16 a[28:29], v3 offset:3592
    v_mfma_f32_16x16x32_bf16 v[56:59], a[68:71], a[116:119], v[56:59]
    ds_read_b64_tr_b16 a[30:31], v3 offset:3584
    ds_write_b128 v5, v[48:51] offset:36864
    v_mfma_f32_16x16x32_bf16 v[56:59], a[72:75], a[112:115], v[56:59]
    ds_read_b128 a[60:63], v4 offset:3776
    v_mfma_f32_16x16x32_bf16 v[56:59], a[76:79], a[108:111], v[56:59]
    v_mfma_f32_16x16x32_bf16 v[56:59], a[80:83], a[104:107], v[56:59]
    v_mfma_f32_16x16x32_bf16 v[56:59], a[84:87], a[100:103], v[56:59]
    v_mfma_f32_16x16x32_bf16 v[56:59], a[88:91], a[96:99], v[56:59]
    v_mfma_f32_16x16x32_bf16 v[60:63], a[64:67], a[124:127], v[60:63]
    ds_write_b128 v5, v[52:55] offset:37888
    v_mfma_f32_16x16x32_bf16 v[60:63], a[68:71], a[120:123], v[60:63]
    v_mfma_f32_16x16x32_bf16 v[60:63], a[72:75], a[116:119], v[60:63]
    v_mfma_f32_16x16x32_bf16 v[60:63], a[76:79], a[112:115], v[60:63]
    v_mfma_f32_16x16x32_bf16 v[60:63], a[80:83], a[108:111], v[60:63]
    v_mfma_f32_16x16x32_bf16 v[60:63], a[84:87], a[104:107], v[60:63]
    v_mfma_f32_16x16x32_bf16 v[60:63], a[88:91], a[100:103], v[60:63]
    v_mfma_f32_16x16x32_bf16 v[60:63], a[92:95], a[96:99], v[60:63]
    s_waitcnt lgkmcnt(15)
    ds_write_b128 v5, v[56:59] offset:38912
    v_mfma_f32_16x16x32_bf16 v[32:35], a[0:3], a[32:35], 0
    s_add_u32 m0, s22, 21248
    ds_read_b64_tr_b16 a[64:65], v3 offset:72
    v_mfma_f32_16x16x32_bf16 v[36:39], a[0:3], a[36:39], 0
    ds_read_b64_tr_b16 a[66:67], v3 offset:64
    v_mfma_f32_16x16x32_bf16 v[36:39], a[4:7], a[32:35], v[36:39]
    ds_read_b128 a[96:99], v4 offset:128
    v_mfma_f32_16x16x32_bf16 v[40:43], a[0:3], a[40:43], 0
    ds_read_b64_tr_b16 a[68:69], v3 offset:584
    v_mfma_f32_16x16x32_bf16 v[40:43], a[4:7], a[36:39], v[40:43]
    ds_read_b128 v[128:131], v6 offset:0
    v_mfma_f32_16x16x32_bf16 v[40:43], a[8:11], a[32:35], v[40:43]
    ds_read_b64_tr_b16 a[70:71], v3 offset:576
    v_mfma_f32_16x16x32_bf16 v[44:47], a[0:3], a[44:47], 0
    ds_read_b128 a[100:103], v4 offset:640
    v_mfma_f32_16x16x32_bf16 v[44:47], a[4:7], a[40:43], v[44:47]
    ds_write_b128 v5, v[60:63] offset:39936
    v_mfma_f32_16x16x32_bf16 v[44:47], a[8:11], a[36:39], v[44:47]
    ds_read_b64_tr_b16 a[72:73], v3 offset:1096
    v_mfma_f32_16x16x32_bf16 v[44:47], a[12:15], a[32:35], v[44:47]
    s_waitcnt lgkmcnt(15)
    ds_read_b64_tr_b16 a[74:75], v3 offset:1088
    v_mfma_f32_16x16x32_bf16 v[48:51], a[0:3], a[48:51], 0
    ds_read_b128 v[144:147], v6 offset:8192
    v_mfma_f32_16x16x32_bf16 v[48:51], a[4:7], a[44:47], v[48:51]
    ds_read_b128 a[104:107], v4 offset:1152
    v_mfma_f32_16x16x32_bf16 v[48:51], a[8:11], a[40:43], v[48:51]
    ds_read_b64_tr_b16 a[76:77], v3 offset:1608
    v_mfma_f32_16x16x32_bf16 v[48:51], a[12:15], a[36:39], v[48:51]
    ds_read_b64_tr_b16 a[78:79], v3 offset:1600
    v_mfma_f32_16x16x32_bf16 v[48:51], a[16:19], a[32:35], v[48:51]
    ds_read_b128 a[108:111], v4 offset:1664
    v_mfma_f32_16x16x32_bf16 v[52:55], a[0:3], a[52:55], 0
    ds_read_b128 v[132:135], v6 offset:1024
    v_mfma_f32_16x16x32_bf16 v[52:55], a[4:7], a[48:51], v[52:55]
    ds_read_b64_tr_b16 a[80:81], v3 offset:2120
    v_mfma_f32_16x16x32_bf16 v[52:55], a[8:11], a[44:47], v[52:55]
    ds_read_b64_tr_b16 a[82:83], v3 offset:2112
    v_mfma_f32_16x16x32_bf16 v[52:55], a[12:15], a[40:43], v[52:55]
    ds_read_b128 a[112:115], v4 offset:2176
    v_mfma_f32_16x16x32_bf16 v[52:55], a[16:19], a[36:39], v[52:55]
    ds_read_b64_tr_b16 a[84:85], v3 offset:2632
    v_mfma_f32_16x16x32_bf16 v[52:55], a[20:23], a[32:35], v[52:55]
    ds_read_b128 v[148:151], v6 offset:9216
    v_mfma_f32_16x16x32_bf16 v[56:59], a[0:3], a[56:59], 0
    ds_read_b64_tr_b16 a[86:87], v3 offset:2624
    v_mfma_f32_16x16x32_bf16 v[56:59], a[4:7], a[52:55], v[56:59]
    ds_read_b128 a[116:119], v4 offset:2688
    v_mfma_f32_16x16x32_bf16 v[56:59], a[8:11], a[48:51], v[56:59]
    ds_read_b64_tr_b16 a[88:89], v3 offset:3144
    v_mfma_f32_16x16x32_bf16 v[56:59], a[12:15], a[44:47], v[56:59]
    ds_read_b64_tr_b16 a[90:91], v3 offset:3136
    v_mfma_f32_16x16x32_bf16 v[56:59], a[16:19], a[40:43], v[56:59]
    ds_read_b128 v[136:139], v6 offset:2048
    v_mfma_f32_16x16x32_bf16 v[56:59], a[20:23], a[36:39], v[56:59]
    ds_read_b128 a[120:123], v4 offset:3200
    v_mfma_f32_16x16x32_bf16 v[56:59], a[24:27], a[32:35], v[56:59]
    s_waitcnt lgkmcnt(15)
    ds_read_b64_tr_b16 a[92:93], v3 offset:3656
    v_mfma_f32_16x16x32_bf16 v[60:63], a[0:3], a[60:63], 0
    ds_read_b64_tr_b16 a[94:95], v3 offset:3648
    v_mfma_f32_16x16x32_bf16 v[60:63], a[4:7], a[56:59], v[60:63]
    ds_read_b128 a[124:127], v4 offset:3712
    v_mfma_f32_16x16x32_bf16 v[60:63], a[8:11], a[52:55], v[60:63]
    ds_read_b128 v[152:155], v6 offset:10240
    v_mfma_f32_16x16x32_bf16 v[60:63], a[12:15], a[48:51], v[60:63]
    ds_read_b128 v[140:143], v6 offset:3072
    v_mfma_f32_16x16x32_bf16 v[60:63], a[16:19], a[44:47], v[60:63]
    ds_read_b128 v[156:159], v6 offset:11264
    v_mfma_f32_16x16x32_bf16 v[60:63], a[20:23], a[40:43], v[60:63]
    buffer_load_dwordx4 v2, s[8:11], s20 offen offset:0 lds
    v_mfma_f32_16x16x32_bf16 v[60:63], a[24:27], a[36:39], v[60:63]
    buffer_load_dwordx4 v2, s[8:11], s20 offen offset:1024 lds
    v_mfma_f32_16x16x32_bf16 v[60:63], a[28:31], a[32:35], v[60:63]
    s_add_u32 m0, s21, 21248
    v_add_f32 v128, v128, v144
    v_lshlrev_b32 v208, 16, v176
    v_mfma_f32_16x16x32_bf16 v[32:35], a[64:67], a[96:99], v[32:35]
    ds_read_b64_tr_b16 a[0:1], v3 offset:136
    v_lshlrev_b32 v209, 16, v64
    v_mfma_f32_16x16x32_bf16 v[36:39], a[64:67], a[100:103], v[36:39]
    ds_read_b64_tr_b16 a[2:3], v3 offset:128
    v_fmac_f32 v128, s40, v208
    v_mfma_f32_16x16x32_bf16 v[36:39], a[68:71], a[96:99], v[36:39]
    ds_read_b128 a[32:35], v4 offset:64
    v_mul_f32 v160, v128, v209
    v_mfma_f32_16x16x32_bf16 v[40:43], a[64:67], a[104:107], v[40:43]
    ds_read_b64_tr_b16 a[4:5], v3 offset:648
    v_add_f32 v129, v129, v145
    v_mfma_f32_16x16x32_bf16 v[40:43], a[68:71], a[100:103], v[40:43]
    buffer_load_dwordx4 v2, s[4:7], s18 offen offset:0 lds
    v_mfma_f32_16x16x32_bf16 v[40:43], a[72:75], a[96:99], v[40:43]
    s_waitcnt lgkmcnt(15)
    ds_read_b64_tr_b16 a[6:7], v3 offset:640
    v_and_b32 v210, 0xffff0000, v176
    v_mfma_f32_16x16x32_bf16 v[44:47], a[64:67], a[108:111], v[44:47]
    ds_read_b128 a[36:39], v4 offset:576
    v_lshlrev_b32 v211, 16, v68
    v_mfma_f32_16x16x32_bf16 v[44:47], a[68:71], a[104:107], v[44:47]
    ds_read_b64_tr_b16 a[8:9], v3 offset:1160
    v_fmac_f32 v129, s40, v210
    v_mfma_f32_16x16x32_bf16 v[44:47], a[72:75], a[100:103], v[44:47]
    ds_read_b64_tr_b16 a[10:11], v3 offset:1152
    v_mul_f32 v161, v129, v211
    v_mfma_f32_16x16x32_bf16 v[44:47], a[76:79], a[96:99], v[44:47]
    buffer_load_dwordx4 v2, s[4:7], s18 offen offset:1024 lds
    v_mfma_f32_16x16x32_bf16 v[48:51], a[64:67], a[112:115], v[48:51]
    ds_read_b128 a[40:43], v4 offset:1088
    v_add_f32 v130, v130, v146
    v_mfma_f32_16x16x32_bf16 v[48:51], a[68:71], a[108:111], v[48:51]
    ds_read_b64_tr_b16 a[12:13], v3 offset:1672
    v_lshlrev_b32 v208, 16, v177
    v_mfma_f32_16x16x32_bf16 v[48:51], a[72:75], a[104:107], v[48:51]
    ds_read_b64_tr_b16 a[14:15], v3 offset:1664
    v_lshlrev_b32 v209, 16, v72
    v_mfma_f32_16x16x32_bf16 v[48:51], a[76:79], a[100:103], v[48:51]
    ds_read_b128 a[44:47], v4 offset:1600
    v_fmac_f32 v130, s40, v208
    v_mfma_f32_16x16x32_bf16 v[48:51], a[80:83], a[96:99], v[48:51]
    s_waitcnt lgkmcnt(15)
    buffer_load_dwordx4 v2, s[4:7], s18 offen offset:2048 lds
    v_mfma_f32_16x16x32_bf16 v[52:55], a[64:67], a[116:119], v[52:55]
    ds_read_b64_tr_b16 a[16:17], v3 offset:2184
    v_mul_f32 v162, v130, v209
    v_mfma_f32_16x16x32_bf16 v[52:55], a[68:71], a[112:115], v[52:55]
    ds_read_b64_tr_b16 a[18:19], v3 offset:2176
    v_add_f32 v131, v131, v147
    v_mfma_f32_16x16x32_bf16 v[52:55], a[72:75], a[108:111], v[52:55]
    ds_read_b128 a[48:51], v4 offset:2112
    v_and_b32 v210, 0xffff0000, v177
    v_mfma_f32_16x16x32_bf16 v[52:55], a[76:79], a[104:107], v[52:55]
    ds_read_b64_tr_b16 a[20:21], v3 offset:2696
    v_lshlrev_b32 v211, 16, v76
    v_mfma_f32_16x16x32_bf16 v[52:55], a[80:83], a[100:103], v[52:55]
    buffer_load_dwordx4 v2, s[4:7], s18 offen offset:3072 lds
    v_mfma_f32_16x16x32_bf16 v[52:55], a[84:87], a[96:99], v[52:55]
    s_add_u32 m0, s21, 25408
    ds_read_b64_tr_b16 a[22:23], v3 offset:2688
    v_fmac_f32 v131, s40, v210
    v_mfma_f32_16x16x32_bf16 v[56:59], a[64:67], a[120:123], v[56:59]
    ds_read_b128 a[52:55], v4 offset:2624
    v_mul_f32 v163, v131, v211
    v_mfma_f32_16x16x32_bf16 v[56:59], a[68:71], a[116:119], v[56:59]
    ds_read_b64_tr_b16 a[24:25], v3 offset:3208
    v_add_f32 v132, v132, v148
    v_mfma_f32_16x16x32_bf16 v[56:59], a[72:75], a[112:115], v[56:59]
    ds_read_b64_tr_b16 a[26:27], v3 offset:3200
    v_lshlrev_b32 v208, 16, v178
    v_mfma_f32_16x16x32_bf16 v[56:59], a[76:79], a[108:111], v[56:59]
    buffer_load_dwordx4 v2, s[4:7], s19 offen offset:0 lds
    v_mfma_f32_16x16x32_bf16 v[56:59], a[80:83], a[104:107], v[56:59]
    ds_read_b128 a[56:59], v4 offset:3136
    v_lshlrev_b32 v209, 16, v80
    v_mfma_f32_16x16x32_bf16 v[56:59], a[84:87], a[100:103], v[56:59]
    ds_read_b64_tr_b16 a[28:29], v3 offset:3720
    v_fmac_f32 v132, s40, v208
    v_mfma_f32_16x16x32_bf16 v[56:59], a[88:91], a[96:99], v[56:59]
    ds_read_b64_tr_b16 a[30:31], v3 offset:3712
    v_mul_f32 v164, v132, v209
    v_mfma_f32_16x16x32_bf16 v[60:63], a[64:67], a[124:127], v[60:63]
    ds_read_b128 a[60:63], v4 offset:3648
    v_add_f32 v133, v133, v149
    v_mfma_f32_16x16x32_bf16 v[60:63], a[68:71], a[120:123], v[60:63]
    buffer_load_dwordx4 v2, s[4:7], s19 offen offset:1024 lds
    v_mfma_f32_16x16x32_bf16 v[60:63], a[72:75], a[116:119], v[60:63]
    buffer_load_dwordx4 v2, s[4:7], s19 offen offset:2048 lds
    v_mfma_f32_16x16x32_bf16 v[60:63], a[76:79], a[112:115], v[60:63]
    buffer_load_dwordx4 v2, s[4:7], s19 offen offset:3072 lds
    v_mfma_f32_16x16x32_bf16 v[60:63], a[80:83], a[108:111], v[60:63]
    s_add_u32 s20, s20, 4096
    v_and_b32 v210, 0xffff0000, v178
    v_lshlrev_b32 v211, 16, v84
    v_mfma_f32_16x16x32_bf16 v[60:63], a[84:87], a[104:107], v[60:63]
    s_add_u32 s18, s18, 4224
    v_fmac_f32 v133, s40, v210
    v_mul_f32 v165, v133, v211
    v_mfma_f32_16x16x32_bf16 v[60:63], a[88:91], a[100:103], v[60:63]
    s_add_u32 s19, s19, 4224
    v_add_f32 v134, v134, v150
    v_lshlrev_b32 v208, 16, v179
    v_mfma_f32_16x16x32_bf16 v[60:63], a[92:95], a[96:99], v[60:63]
    s_waitcnt lgkmcnt(15)
    v_lshlrev_b32 v209, 16, v88
    v_fmac_f32 v134, s40, v208
    v_mfma_f32_16x16x32_bf16 v[32:35], a[0:3], a[32:35], v[32:35]
    ds_read_b64_tr_b16 a[64:65], v3 offset:200
    v_mul_f32 v166, v134, v209
    v_mfma_f32_16x16x32_bf16 v[36:39], a[0:3], a[36:39], v[36:39]
    ds_read_b64_tr_b16 a[66:67], v3 offset:192
    v_add_f32 v135, v135, v151
    v_mfma_f32_16x16x32_bf16 v[36:39], a[4:7], a[32:35], v[36:39]
    ds_read_b128 a[96:99], v4 offset:0
    v_and_b32 v210, 0xffff0000, v179
    v_mfma_f32_16x16x32_bf16 v[40:43], a[0:3], a[40:43], v[40:43]
    ds_read_b64_tr_b16 a[68:69], v3 offset:712
    v_lshlrev_b32 v211, 16, v92
    v_mfma_f32_16x16x32_bf16 v[40:43], a[4:7], a[36:39], v[40:43]
    v_fmac_f32 v135, s40, v210
    v_mul_f32 v167, v135, v211
    v_mfma_f32_16x16x32_bf16 v[40:43], a[8:11], a[32:35], v[40:43]
    s_waitcnt lgkmcnt(15)
    ds_read_b64_tr_b16 a[70:71], v3 offset:704
    v_add_f32 v136, v136, v152
    v_mfma_f32_16x16x32_bf16 v[44:47], a[0:3], a[44:47], v[44:47]
    ds_read_b128 a[100:103], v4 offset:512
    v_lshlrev_b32 v208, 16, v180
    v_mfma_f32_16x16x32_bf16 v[44:47], a[4:7], a[40:43], v[44:47]
    ds_read_b64_tr_b16 a[72:73], v3 offset:1224
    v_lshlrev_b32 v209, 16, v96
    v_mfma_f32_16x16x32_bf16 v[44:47], a[8:11], a[36:39], v[44:47]
    ds_read_b64_tr_b16 a[74:75], v3 offset:1216
    v_fmac_f32 v136, s40, v208
    v_mfma_f32_16x16x32_bf16 v[44:47], a[12:15], a[32:35], v[44:47]
    s_waitcnt lgkmcnt(15)
    v_mul_f32 v168, v136, v209
    v_add_f32 v137, v137, v153
    v_mfma_f32_16x16x32_bf16 v[48:51], a[0:3], a[48:51], v[48:51]
    ds_read_b128 a[104:107], v4 offset:1024
    v_and_b32 v210, 0xffff0000, v180
    v_mfma_f32_16x16x32_bf16 v[48:51], a[4:7], a[44:47], v[48:51]
    ds_read_b64_tr_b16 a[76:77], v3 offset:1736
    v_lshlrev_b32 v211, 16, v100
    v_mfma_f32_16x16x32_bf16 v[48:51], a[8:11], a[40:43], v[48:51]
    ds_read_b64_tr_b16 a[78:79], v3 offset:1728
    v_fmac_f32 v137, s40, v210
    v_mfma_f32_16x16x32_bf16 v[48:51], a[12:15], a[36:39], v[48:51]
    ds_read_b128 a[108:111], v4 offset:1536
    v_mul_f32 v169, v137, v211
    v_mfma_f32_16x16x32_bf16 v[48:51], a[16:19], a[32:35], v[48:51]
    s_waitcnt lgkmcnt(15)
    v_add_f32 v138, v138, v154
    v_lshlrev_b32 v208, 16, v181
    v_mfma_f32_16x16x32_bf16 v[52:55], a[0:3], a[52:55], v[52:55]
    ds_read_b64_tr_b16 a[80:81], v3 offset:2248
    v_lshlrev_b32 v209, 16, v104
    v_mfma_f32_16x16x32_bf16 v[52:55], a[4:7], a[48:51], v[52:55]
    ds_read_b64_tr_b16 a[82:83], v3 offset:2240
    v_fmac_f32 v138, s40, v208
    v_mfma_f32_16x16x32_bf16 v[52:55], a[8:11], a[44:47], v[52:55]
    ds_read_b128 a[112:115], v4 offset:2048
    v_mul_f32 v170, v138, v209
    v_mfma_f32_16x16x32_bf16 v[52:55], a[12:15], a[40:43], v[52:55]
    ds_read_b64_tr_b16 a[84:85], v3 offset:2760
    v_add_f32 v139, v139, v155
    v_mfma_f32_16x16x32_bf16 v[52:55], a[16:19], a[36:39], v[52:55]
    v_and_b32 v210, 0xffff0000, v181
    v_lshlrev_b32 v211, 16, v108
    v_mfma_f32_16x16x32_bf16 v[52:55], a[20:23], a[32:35], v[52:55]
    ds_read_b64_tr_b16 a[86:87], v3 offset:2752
    v_fmac_f32 v139, s40, v210
    v_mfma_f32_16x16x32_bf16 v[56:59], a[0:3], a[56:59], v[56:59]
    ds_read_b128 a[116:119], v4 offset:2560
    v_mul_f32 v171, v139, v211
    v_mfma_f32_16x16x32_bf16 v[56:59], a[4:7], a[52:55], v[56:59]
    ds_read_b64_tr_b16 a[88:89], v3 offset:3272
    v_add_f32 v140, v140, v156
    v_mfma_f32_16x16x32_bf16 v[56:59], a[8:11], a[48:51], v[56:59]
    ds_read_b64_tr_b16 a[90:91], v3 offset:3264
    v_lshlrev_b32 v208, 16, v182
    v_mfma_f32_16x16x32_bf16 v[56:59], a[12:15], a[44:47], v[56:59]
    v_lshlrev_b32 v209, 16, v112
    v_fmac_f32 v140, s40, v208
    v_mfma_f32_16x16x32_bf16 v[56:59], a[16:19], a[40:43], v[56:59]
    ds_read_b128 a[120:123], v4 offset:3072
    v_mul_f32 v172, v140, v209
    v_mfma_f32_16x16x32_bf16 v[56:59], a[20:23], a[36:39], v[56:59]
    ds_read_b64_tr_b16 a[92:93], v3 offset:3784
    v_add_f32 v141, v141, v157
    v_mfma_f32_16x16x32_bf16 v[56:59], a[24:27], a[32:35], v[56:59]
    s_waitcnt lgkmcnt(15)
    ds_read_b64_tr_b16 a[94:95], v3 offset:3776
    v_and_b32 v210, 0xffff0000, v182
    v_mfma_f32_16x16x32_bf16 v[60:63], a[0:3], a[60:63], v[60:63]
    ds_read_b128 a[124:127], v4 offset:3584
    v_lshlrev_b32 v211, 16, v116
    v_mfma_f32_16x16x32_bf16 v[60:63], a[4:7], a[56:59], v[60:63]
    v_fmac_f32 v141, s40, v210
    v_mul_f32 v173, v141, v211
    v_mfma_f32_16x16x32_bf16 v[60:63], a[8:11], a[52:55], v[60:63]
    ds_read_b64 v[192:193], v7 offset:0
    v_add_f32 v142, v142, v158
    v_mfma_f32_16x16x32_bf16 v[60:63], a[12:15], a[48:51], v[60:63]
    ds_read_b64 v[194:195], v7 offset:512
    v_lshlrev_b32 v208, 16, v183
    v_mfma_f32_16x16x32_bf16 v[60:63], a[16:19], a[44:47], v[60:63]
    ds_read_b64 v[196:197], v7 offset:1024
    v_lshlrev_b32 v209, 16, v120
    v_mfma_f32_16x16x32_bf16 v[60:63], a[20:23], a[40:43], v[60:63]
    ds_read_b64 v[198:199], v7 offset:1536
    v_fmac_f32 v142, s40, v208
    v_mfma_f32_16x16x32_bf16 v[60:63], a[24:27], a[36:39], v[60:63]
    v_mul_f32 v174, v142, v209
    v_add_f32 v143, v143, v159
    v_mfma_f32_16x16x32_bf16 v[60:63], a[28:31], a[32:35], v[60:63]
    s_waitcnt vmcnt(0) lgkmcnt(0)
    s_barrier
    v_and_b32 v210, 0xffff0000, v183
    v_mfma_f32_16x16x32_bf16 v[32:35], a[64:67], a[96:99], v[32:35]
    ds_read_b64_tr_b16 a[0:1], v3 offset:21256
    v_lshlrev_b32 v211, 16, v124
    v_mfma_f32_16x16x32_bf16 v[36:39], a[64:67], a[100:103], v[36:39]
    ds_read_b64_tr_b16 a[2:3], v3 offset:21248
    v_fmac_f32 v143, s40, v210
    v_mfma_f32_16x16x32_bf16 v[36:39], a[68:71], a[96:99], v[36:39]
    ds_read_b128 a[32:35], v4 offset:21440
    v_mul_f32 v175, v143, v211
    v_mfma_f32_16x16x32_bf16 v[40:43], a[64:67], a[104:107], v[40:43]
    ds_read_b64_tr_b16 a[4:5], v3 offset:21768
    v_mfma_f32_16x16x32_bf16 v[40:43], a[68:71], a[100:103], v[40:43]
    ds_read_b64_tr_b16 a[6:7], v3 offset:21760
    v_mfma_f32_16x16x32_bf16 v[40:43], a[72:75], a[96:99], v[40:43]
    ds_read_b128 a[36:39], v4 offset:21952
    v_mfma_f32_16x16x32_bf16 v[44:47], a[64:67], a[108:111], v[44:47]
    ds_read_b64_tr_b16 a[8:9], v3 offset:22280
    v_mfma_f32_16x16x32_bf16 v[44:47], a[68:71], a[104:107], v[44:47]
    ds_read_b64_tr_b16 a[10:11], v3 offset:22272
    v_mfma_f32_16x16x32_bf16 v[44:47], a[72:75], a[100:103], v[44:47]
    ds_read_b128 a[40:43], v4 offset:22464
    ds_write_b128 v5, v[32:35] offset:0
    v_mfma_f32_16x16x32_bf16 v[44:47], a[76:79], a[96:99], v[44:47]
    ds_read_b64_tr_b16 a[12:13], v3 offset:22792
    v_mfma_f32_16x16x32_bf16 v[48:51], a[64:67], a[112:115], v[48:51]
    ds_read_b64_tr_b16 a[14:15], v3 offset:22784
    ds_write_b128 v5, v[36:39] offset:1024
    v_mfma_f32_16x16x32_bf16 v[48:51], a[68:71], a[108:111], v[48:51]
    ds_read_b128 a[44:47], v4 offset:22976
    v_mfma_f32_16x16x32_bf16 v[48:51], a[72:75], a[104:107], v[48:51]
    ds_read_b64_tr_b16 a[16:17], v3 offset:23304
    v_mfma_f32_16x16x32_bf16 v[48:51], a[76:79], a[100:103], v[48:51]
    ds_read_b64_tr_b16 a[18:19], v3 offset:23296
    ds_write_b128 v5, v[40:43] offset:2048
    v_mfma_f32_16x16x32_bf16 v[48:51], a[80:83], a[96:99], v[48:51]
    ds_read_b128 a[48:51], v4 offset:23488
    v_mfma_f32_16x16x32_bf16 v[52:55], a[64:67], a[116:119], v[52:55]
    ds_read_b64_tr_b16 a[20:21], v3 offset:23816
    v_mfma_f32_16x16x32_bf16 v[52:55], a[68:71], a[112:115], v[52:55]
    ds_read_b64_tr_b16 a[22:23], v3 offset:23808
    v_mfma_f32_16x16x32_bf16 v[52:55], a[72:75], a[108:111], v[52:55]
    ds_read_b128 a[52:55], v4 offset:24000
    ds_write_b128 v5, v[44:47] offset:3072
    v_mfma_f32_16x16x32_bf16 v[52:55], a[76:79], a[104:107], v[52:55]
    ds_read_b64_tr_b16 a[24:25], v3 offset:24328
    v_mfma_f32_16x16x32_bf16 v[52:55], a[80:83], a[100:103], v[52:55]
    ds_read_b64_tr_b16 a[26:27], v3 offset:24320
    v_mfma_f32_16x16x32_bf16 v[52:55], a[84:87], a[96:99], v[52:55]
    ds_read_b128 a[56:59], v4 offset:24512
    v_mfma_f32_16x16x32_bf16 v[56:59], a[64:67], a[120:123], v[56:59]
    ds_read_b64_tr_b16 a[28:29], v3 offset:24840
    v_mfma_f32_16x16x32_bf16 v[56:59], a[68:71], a[116:119], v[56:59]
    ds_read_b64_tr_b16 a[30:31], v3 offset:24832
    ds_write_b128 v5, v[48:51] offset:4096
    v_mfma_f32_16x16x32_bf16 v[56:59], a[72:75], a[112:115], v[56:59]
    ds_read_b128 a[60:63], v4 offset:25024
    v_mfma_f32_16x16x32_bf16 v[56:59], a[76:79], a[108:111], v[56:59]
    v_mfma_f32_16x16x32_bf16 v[56:59], a[80:83], a[104:107], v[56:59]
    v_mfma_f32_16x16x32_bf16 v[56:59], a[84:87], a[100:103], v[56:59]
    v_mfma_f32_16x16x32_bf16 v[56:59], a[88:91], a[96:99], v[56:59]
    v_mfma_f32_16x16x32_bf16 v[60:63], a[64:67], a[124:127], v[60:63]
    ds_write_b128 v5, v[52:55] offset:5120
    v_mfma_f32_16x16x32_bf16 v[60:63], a[68:71], a[120:123], v[60:63]
    v_mfma_f32_16x16x32_bf16 v[60:63], a[72:75], a[116:119], v[60:63]
    v_mfma_f32_16x16x32_bf16 v[60:63], a[76:79], a[112:115], v[60:63]
    v_mfma_f32_16x16x32_bf16 v[60:63], a[80:83], a[108:111], v[60:63]
    v_mfma_f32_16x16x32_bf16 v[60:63], a[84:87], a[104:107], v[60:63]
    v_mfma_f32_16x16x32_bf16 v[60:63], a[88:91], a[100:103], v[60:63]
    v_mfma_f32_16x16x32_bf16 v[60:63], a[92:95], a[96:99], v[60:63]
    s_waitcnt lgkmcnt(15)
    ds_write_b128 v5, v[56:59] offset:6144
    v_mfma_f32_16x16x32_bf16 v[32:35], a[0:3], a[32:35], 0
    s_add_u32 m0, s22, 0
    ds_read_b64_tr_b16 a[64:65], v3 offset:21320
    v_mfma_f32_16x16x32_bf16 v[36:39], a[0:3], a[36:39], 0
    ds_read_b64_tr_b16 a[66:67], v3 offset:21312
    v_mfma_f32_16x16x32_bf16 v[36:39], a[4:7], a[32:35], v[36:39]
    ds_read_b128 a[96:99], v4 offset:21376
    v_mfma_f32_16x16x32_bf16 v[40:43], a[0:3], a[40:43], 0
    ds_read_b64_tr_b16 a[68:69], v3 offset:21832
    v_mfma_f32_16x16x32_bf16 v[40:43], a[4:7], a[36:39], v[40:43]
    ds_read_b128 v[128:131], v6 offset:32768
    v_mfma_f32_16x16x32_bf16 v[40:43], a[8:11], a[32:35], v[40:43]
    ds_read_b64_tr_b16 a[70:71], v3 offset:21824
    v_mfma_f32_16x16x32_bf16 v[44:47], a[0:3], a[44:47], 0
    ds_read_b128 a[100:103], v4 offset:21888
    v_mfma_f32_16x16x32_bf16 v[44:47], a[4:7], a[40:43], v[44:47]
    ds_write_b128 v5, v[60:63] offset:7168
    v_mfma_f32_16x16x32_bf16 v[44:47], a[8:11], a[36:39], v[44:47]
    ds_read_b64_tr_b16 a[72:73], v3 offset:22344
    v_mfma_f32_16x16x32_bf16 v[44:47], a[12:15], a[32:35], v[44:47]
    s_waitcnt lgkmcnt(15)
    ds_read_b64_tr_b16 a[74:75], v3 offset:22336
    v_mfma_f32_16x16x32_bf16 v[48:51], a[0:3], a[48:51], 0
    ds_read_b128 v[144:147], v6 offset:40960
    v_mfma_f32_16x16x32_bf16 v[48:51], a[4:7], a[44:47], v[48:51]
    ds_read_b128 a[104:107], v4 offset:22400
    v_mfma_f32_16x16x32_bf16 v[48:51], a[8:11], a[40:43], v[48:51]
    ds_read_b64_tr_b16 a[76:77], v3 offset:22856
    v_mfma_f32_16x16x32_bf16 v[48:51], a[12:15], a[36:39], v[48:51]
    ds_read_b64_tr_b16 a[78:79], v3 offset:22848
    v_mfma_f32_16x16x32_bf16 v[48:51], a[16:19], a[32:35], v[48:51]
    ds_read_b128 a[108:111], v4 offset:22912
    v_mfma_f32_16x16x32_bf16 v[52:55], a[0:3], a[52:55], 0
    ds_read_b128 v[132:135], v6 offset:33792
    v_mfma_f32_16x16x32_bf16 v[52:55], a[4:7], a[48:51], v[52:55]
    ds_read_b64_tr_b16 a[80:81], v3 offset:23368
    v_mfma_f32_16x16x32_bf16 v[52:55], a[8:11], a[44:47], v[52:55]
    ds_read_b64_tr_b16 a[82:83], v3 offset:23360
    v_mfma_f32_16x16x32_bf16 v[52:55], a[12:15], a[40:43], v[52:55]
    ds_read_b128 a[112:115], v4 offset:23424
    v_mfma_f32_16x16x32_bf16 v[52:55], a[16:19], a[36:39], v[52:55]
    ds_read_b64_tr_b16 a[84:85], v3 offset:23880
    v_mfma_f32_16x16x32_bf16 v[52:55], a[20:23], a[32:35], v[52:55]
    ds_read_b128 v[148:151], v6 offset:41984
    v_mfma_f32_16x16x32_bf16 v[56:59], a[0:3], a[56:59], 0
    ds_read_b64_tr_b16 a[86:87], v3 offset:23872
    v_mfma_f32_16x16x32_bf16 v[56:59], a[4:7], a[52:55], v[56:59]
    ds_read_b128 a[116:119], v4 offset:23936
    v_mfma_f32_16x16x32_bf16 v[56:59], a[8:11], a[48:51], v[56:59]
    ds_read_b64_tr_b16 a[88:89], v3 offset:24392
    v_mfma_f32_16x16x32_bf16 v[56:59], a[12:15], a[44:47], v[56:59]
    ds_read_b64_tr_b16 a[90:91], v3 offset:24384
    v_mfma_f32_16x16x32_bf16 v[56:59], a[16:19], a[40:43], v[56:59]
    ds_read_b128 v[136:139], v6 offset:34816
    v_mfma_f32_16x16x32_bf16 v[56:59], a[20:23], a[36:39], v[56:59]
    ds_read_b128 a[120:123], v4 offset:24448
    v_mfma_f32_16x16x32_bf16 v[56:59], a[24:27], a[32:35], v[56:59]
    s_waitcnt lgkmcnt(15)
    ds_read_b64_tr_b16 a[92:93], v3 offset:24904
    v_mfma_f32_16x16x32_bf16 v[60:63], a[0:3], a[60:63], 0
    ds_read_b64_tr_b16 a[94:95], v3 offset:24896
    v_mfma_f32_16x16x32_bf16 v[60:63], a[4:7], a[56:59], v[60:63]
    ds_read_b128 a[124:127], v4 offset:24960
    v_mfma_f32_16x16x32_bf16 v[60:63], a[8:11], a[52:55], v[60:63]
    ds_read_b128 v[152:155], v6 offset:43008
    v_mfma_f32_16x16x32_bf16 v[60:63], a[12:15], a[48:51], v[60:63]
    ds_read_b128 v[140:143], v6 offset:35840
    v_mfma_f32_16x16x32_bf16 v[60:63], a[16:19], a[44:47], v[60:63]
    ds_read_b128 v[156:159], v6 offset:44032
    v_mfma_f32_16x16x32_bf16 v[60:63], a[20:23], a[40:43], v[60:63]
    buffer_load_dwordx4 v2, s[8:11], s20 offen offset:0 lds
    v_mfma_f32_16x16x32_bf16 v[60:63], a[24:27], a[36:39], v[60:63]
    buffer_load_dwordx4 v2, s[8:11], s20 offen offset:1024 lds
    v_mfma_f32_16x16x32_bf16 v[60:63], a[28:31], a[32:35], v[60:63]
    s_add_u32 m0, s21, 0
    v_add_f32 v128, v128, v144
    v_lshlrev_b32 v208, 16, v184
    v_mfma_f32_16x16x32_bf16 v[32:35], a[64:67], a[96:99], v[32:35]
    ds_read_b64_tr_b16 a[0:1], v3 offset:21384
    v_and_b32 v209, 0xffff0000, v64
    v_mfma_f32_16x16x32_bf16 v[36:39], a[64:67], a[100:103], v[36:39]
    ds_read_b64_tr_b16 a[2:3], v3 offset:21376
    v_fmac_f32 v128, s41, v208
    v_mfma_f32_16x16x32_bf16 v[36:39], a[68:71], a[96:99], v[36:39]
    ds_read_b128 a[32:35], v4 offset:21312
    v_mul_f32 v128, v128, v209
    v_mfma_f32_16x16x32_bf16 v[40:43], a[64:67], a[104:107], v[40:43]
    ds_read_b64_tr_b16 a[4:5], v3 offset:21896
    v_cvt_pk_bf16_f32 v64, v160, v128
    v_mfma_f32_16x16x32_bf16 v[40:43], a[68:71], a[100:103], v[40:43]
    buffer_load_dwordx4 v2, s[4:7], s18 offen offset:0 lds
    v_mfma_f32_16x16x32_bf16 v[40:43], a[72:75], a[96:99], v[40:43]
    s_waitcnt lgkmcnt(15)
    ds_read_b64_tr_b16 a[6:7], v3 offset:21888
    v_add_f32 v129, v129, v145
    v_mfma_f32_16x16x32_bf16 v[44:47], a[64:67], a[108:111], v[44:47]
    ds_read_b128 a[36:39], v4 offset:21824
    v_and_b32 v210, 0xffff0000, v184
    v_mfma_f32_16x16x32_bf16 v[44:47], a[68:71], a[104:107], v[44:47]
    ds_read_b64_tr_b16 a[8:9], v3 offset:22408
    v_and_b32 v211, 0xffff0000, v68
    v_mfma_f32_16x16x32_bf16 v[44:47], a[72:75], a[100:103], v[44:47]
    ds_read_b64_tr_b16 a[10:11], v3 offset:22400
    v_fmac_f32 v129, s41, v210
    v_mfma_f32_16x16x32_bf16 v[44:47], a[76:79], a[96:99], v[44:47]
    buffer_load_dwordx4 v2, s[4:7], s18 offen offset:1024 lds
    v_mfma_f32_16x16x32_bf16 v[48:51], a[64:67], a[112:115], v[48:51]
    ds_read_b128 a[40:43], v4 offset:22336
    v_mul_f32 v129, v129, v211
    v_mfma_f32_16x16x32_bf16 v[48:51], a[68:71], a[108:111], v[48:51]
    ds_read_b64_tr_b16 a[12:13], v3 offset:22920
    v_cvt_pk_bf16_f32 v68, v161, v129
    v_mfma_f32_16x16x32_bf16 v[48:51], a[72:75], a[104:107], v[48:51]
    ds_read_b64_tr_b16 a[14:15], v3 offset:22912
    v_add_f32 v130, v130, v146
    v_mfma_f32_16x16x32_bf16 v[48:51], a[76:79], a[100:103], v[48:51]
    ds_read_b128 a[44:47], v4 offset:22848
    v_lshlrev_b32 v208, 16, v185
    v_mfma_f32_16x16x32_bf16 v[48:51], a[80:83], a[96:99], v[48:51]
    s_waitcnt lgkmcnt(15)
    buffer_load_dwordx4 v2, s[4:7], s18 offen offset:2048 lds
    v_mfma_f32_16x16x32_bf16 v[52:55], a[64:67], a[116:119], v[52:55]
    ds_read_b64_tr_b16 a[16:17], v3 offset:23432
    v_and_b32 v209, 0xffff0000, v72
    v_mfma_f32_16x16x32_bf16 v[52:55], a[68:71], a[112:115], v[52:55]
    ds_read_b64_tr_b16 a[18:19], v3 offset:23424
    v_fmac_f32 v130, s41, v208
    v_mfma_f32_16x16x32_bf16 v[52:55], a[72:75], a[108:111], v[52:55]
    ds_read_b128 a[48:51], v4 offset:23360
    v_mul_f32 v130, v130, v209
    v_mfma_f32_16x16x32_bf16 v[52:55], a[76:79], a[104:107], v[52:55]
    ds_read_b64_tr_b16 a[20:21], v3 offset:23944
    v_cvt_pk_bf16_f32 v72, v162, v130
    v_mfma_f32_16x16x32_bf16 v[52:55], a[80:83], a[100:103], v[52:55]
    buffer_load_dwordx4 v2, s[4:7], s18 offen offset:3072 lds
    v_mfma_f32_16x16x32_bf16 v[52:55], a[84:87], a[96:99], v[52:55]
    s_add_u32 m0, s21, 4160
    ds_read_b64_tr_b16 a[22:23], v3 offset:23936
    v_add_f32 v131, v131, v147
    v_mfma_f32_16x16x32_bf16 v[56:59], a[64:67], a[120:123], v[56:59]
    ds_read_b128 a[52:55], v4 offset:23872
    v_and_b32 v210, 0xffff0000, v185
    v_mfma_f32_16x16x32_bf16 v[56:59], a[68:71], a[116:119], v[56:59]
    ds_read_b64_tr_b16 a[24:25], v3 offset:24456
    v_and_b32 v211, 0xffff0000, v76
    v_mfma_f32_16x16x32_bf16 v[56:59], a[72:75], a[112:115], v[56:59]
    ds_read_b64_tr_b16 a[26:27], v3 offset:24448
    v_fmac_f32 v131, s41, v210
    v_mfma_f32_16x16x32_bf16 v[56:59], a[76:79], a[108:111], v[56:59]
    buffer_load_dwordx4 v2, s[4:7], s19 offen offset:0 lds
    v_mfma_f32_16x16x32_bf16 v[56:59], a[80:83], a[104:107], v[56:59]
    ds_read_b128 a[56:59], v4 offset:24384
    v_mul_f32 v131, v131, v211
    v_mfma_f32_16x16x32_bf16 v[56:59], a[84:87], a[100:103], v[56:59]
    ds_read_b64_tr_b16 a[28:29], v3 offset:24968
    v_cvt_pk_bf16_f32 v76, v163, v131
    v_mfma_f32_16x16x32_bf16 v[56:59], a[88:91], a[96:99], v[56:59]
    ds_read_b64_tr_b16 a[30:31], v3 offset:24960
    v_add_f32 v132, v132, v148
    v_mfma_f32_16x16x32_bf16 v[60:63], a[64:67], a[124:127], v[60:63]
    ds_read_b128 a[60:63], v4 offset:24896
    v_lshlrev_b32 v208, 16, v186
    v_mfma_f32_16x16x32_bf16 v[60:63], a[68:71], a[120:123], v[60:63]
    buffer_load_dwordx4 v2, s[4:7], s19 offen offset:1024 lds
    v_mfma_f32_16x16x32_bf16 v[60:63], a[72:75], a[116:119], v[60:63]
    buffer_load_dwordx4 v2, s[4:7], s19 offen offset:2048 lds
    v_mfma_f32_16x16x32_bf16 v[60:63], a[76:79], a[112:115], v[60:63]
    buffer_load_dwordx4 v2, s[4:7], s19 offen offset:3072 lds
    v_mfma_f32_16x16x32_bf16 v[60:63], a[80:83], a[108:111], v[60:63]
    s_add_u32 s20, s20, 4096
    v_and_b32 v209, 0xffff0000, v80
    v_fmac_f32 v132, s41, v208
    v_mfma_f32_16x16x32_bf16 v[60:63], a[84:87], a[104:107], v[60:63]
    s_add_u32 s18, s18, 4224
    v_mul_f32 v132, v132, v209
    v_cvt_pk_bf16_f32 v80, v164, v132
    v_mfma_f32_16x16x32_bf16 v[60:63], a[88:91], a[100:103], v[60:63]
    s_add_u32 s19, s19, 4224
    v_add_f32 v133, v133, v149
    v_and_b32 v210, 0xffff0000, v186
    v_mfma_f32_16x16x32_bf16 v[60:63], a[92:95], a[96:99], v[60:63]
    s_waitcnt lgkmcnt(15)
    v_and_b32 v211, 0xffff0000, v84
    v_fmac_f32 v133, s41, v210
    v_mfma_f32_16x16x32_bf16 v[32:35], a[0:3], a[32:35], v[32:35]
    ds_read_b64_tr_b16 a[64:65], v3 offset:21448
    v_mul_f32 v133, v133, v211
    v_mfma_f32_16x16x32_bf16 v[36:39], a[0:3], a[36:39], v[36:39]
    ds_read_b64_tr_b16 a[66:67], v3 offset:21440
    v_cvt_pk_bf16_f32 v84, v165, v133
    v_mfma_f32_16x16x32_bf16 v[36:39], a[4:7], a[32:35], v[36:39]
    ds_read_b128 a[96:99], v4 offset:21248
    v_add_f32 v134, v134, v150
    v_mfma_f32_16x16x32_bf16 v[40:43], a[0:3], a[40:43], v[40:43]
    ds_read_b64_tr_b16 a[68:69], v3 offset:21960
    v_lshlrev_b32 v208, 16, v187
    v_mfma_f32_16x16x32_bf16 v[40:43], a[4:7], a[36:39], v[40:43]
    v_and_b32 v209, 0xffff0000, v88
    v_fmac_f32 v134, s41, v208
    v_mfma_f32_16x16x32_bf16 v[40:43], a[8:11], a[32:35], v[40:43]
    s_waitcnt lgkmcnt(15)
    ds_read_b64_tr_b16 a[70:71], v3 offset:21952
    v_mul_f32 v134, v134, v209
    v_mfma_f32_16x16x32_bf16 v[44:47], a[0:3], a[44:47], v[44:47]
    ds_read_b128 a[100:103], v4 offset:21760
    v_cvt_pk_bf16_f32 v88, v166, v134
    v_mfma_f32_16x16x32_bf16 v[44:47], a[4:7], a[40:43], v[44:47]
    ds_read_b64_tr_b16 a[72:73], v3 offset:22472
    v_add_f32 v135, v135, v151
    v_mfma_f32_16x16x32_bf16 v[44:47], a[8:11], a[36:39], v[44:47]
    ds_read_b64_tr_b16 a[74:75], v3 offset:22464
    v_and_b32 v210, 0xffff0000, v187
    v_mfma_f32_16x16x32_bf16 v[44:47], a[12:15], a[32:35], v[44:47]
    s_waitcnt lgkmcnt(15)
    v_and_b32 v211, 0xffff0000, v92
    v_fmac_f32 v135, s41, v210
    v_mfma_f32_16x16x32_bf16 v[48:51], a[0:3], a[48:51], v[48:51]
    ds_read_b128 a[104:107], v4 offset:22272
    v_mul_f32 v135, v135, v211
    v_mfma_f32_16x16x32_bf16 v[48:51], a[4:7], a[44:47], v[48:51]
    ds_read_b64_tr_b16 a[76:77], v3 offset:22984
    v_cvt_pk_bf16_f32 v92, v167, v135
    v_mfma_f32_16x16x32_bf16 v[48:51], a[8:11], a[40:43], v[48:51]
    ds_read_b64_tr_b16 a[78:79], v3 offset:22976
    v_add_f32 v136, v136, v152
    v_mfma_f32_16x16x32_bf16 v[48:51], a[12:15], a[36:39], v[48:51]
    ds_read_b128 a[108:111], v4 offset:22784
    v_lshlrev_b32 v208, 16, v188
    v_mfma_f32_16x16x32_bf16 v[48:51], a[16:19], a[32:35], v[48:51]
    s_waitcnt lgkmcnt(15)
    v_and_b32 v209, 0xffff0000, v96
    v_fmac_f32 v136, s41, v208
    v_mfma_f32_16x16x32_bf16 v[52:55], a[0:3], a[52:55], v[52:55]
    ds_read_b64_tr_b16 a[80:81], v3 offset:23496
    v_mul_f32 v136, v136, v209
    v_mfma_f32_16x16x32_bf16 v[52:55], a[4:7], a[48:51], v[52:55]
    ds_read_b64_tr_b16 a[82:83], v3 offset:23488
    v_cvt_pk_bf16_f32 v96, v168, v136
    v_mfma_f32_16x16x32_bf16 v[52:55], a[8:11], a[44:47], v[52:55]
    ds_read_b128 a[112:115], v4 offset:23296
    v_add_f32 v137, v137, v153
    v_mfma_f32_16x16x32_bf16 v[52:55], a[12:15], a[40:43], v[52:55]
    ds_read_b64_tr_b16 a[84:85], v3 offset:24008
    v_and_b32 v210, 0xffff0000, v188
    v_mfma_f32_16x16x32_bf16 v[52:55], a[16:19], a[36:39], v[52:55]
    v_and_b32 v211, 0xffff0000, v100
    v_fmac_f32 v137, s41, v210
    v_mfma_f32_16x16x32_bf16 v[52:55], a[20:23], a[32:35], v[52:55]
    ds_read_b64_tr_b16 a[86:87], v3 offset:24000
    v_mul_f32 v137, v137, v211
    v_mfma_f32_16x16x32_bf16 v[56:59], a[0:3], a[56:59], v[56:59]
    ds_read_b128 a[116:119], v4 offset:23808
    v_cvt_pk_bf16_f32 v100, v169, v137
    v_mfma_f32_16x16x32_bf16 v[56:59], a[4:7], a[52:55], v[56:59]
    ds_read_b64_tr_b16 a[88:89], v3 offset:24520
    v_add_f32 v138, v138, v154
    v_mfma_f32_16x16x32_bf16 v[56:59], a[8:11], a[48:51], v[56:59]
    ds_read_b64_tr_b16 a[90:91], v3 offset:24512
    v_lshlrev_b32 v208, 16, v189
    v_mfma_f32_16x16x32_bf16 v[56:59], a[12:15], a[44:47], v[56:59]
    v_and_b32 v209, 0xffff0000, v104
    v_fmac_f32 v138, s41, v208
    v_mfma_f32_16x16x32_bf16 v[56:59], a[16:19], a[40:43], v[56:59]
    ds_read_b128 a[120:123], v4 offset:24320
    v_mul_f32 v138, v138, v209
    v_mfma_f32_16x16x32_bf16 v[56:59], a[20:23], a[36:39], v[56:59]
    ds_read_b64_tr_b16 a[92:93], v3 offset:25032
    v_cvt_pk_bf16_f32 v104, v170, v138
    v_mfma_f32_16x16x32_bf16 v[56:59], a[24:27], a[32:35], v[56:59]
    s_waitcnt lgkmcnt(15)
    ds_read_b64_tr_b16 a[94:95], v3 offset:25024
    v_add_f32 v139, v139, v155
    v_mfma_f32_16x16x32_bf16 v[60:63], a[0:3], a[60:63], v[60:63]
    ds_read_b128 a[124:127], v4 offset:24832
    v_and_b32 v210, 0xffff0000, v189
    v_mfma_f32_16x16x32_bf16 v[60:63], a[4:7], a[56:59], v[60:63]
    v_and_b32 v211, 0xffff0000, v108
    v_fmac_f32 v139, s41, v210
    v_mfma_f32_16x16x32_bf16 v[60:63], a[8:11], a[52:55], v[60:63]
    ds_read_b64 v[200:201], v7 offset:21248
    v_mul_f32 v139, v139, v211
    v_mfma_f32_16x16x32_bf16 v[60:63], a[12:15], a[48:51], v[60:63]
    ds_read_b64 v[202:203], v7 offset:21760
    v_cvt_pk_bf16_f32 v108, v171, v139
    v_mfma_f32_16x16x32_bf16 v[60:63], a[16:19], a[44:47], v[60:63]
    ds_read_b64 v[204:205], v7 offset:22272
    v_add_f32 v140, v140, v156
    v_mfma_f32_16x16x32_bf16 v[60:63], a[20:23], a[40:43], v[60:63]
    ds_read_b64 v[206:207], v7 offset:22784
    v_lshlrev_b32 v208, 16, v190
    v_mfma_f32_16x16x32_bf16 v[60:63], a[24:27], a[36:39], v[60:63]
    v_and_b32 v209, 0xffff0000, v112
    v_fmac_f32 v140, s41, v208
    v_mfma_f32_16x16x32_bf16 v[60:63], a[28:31], a[32:35], v[60:63]
    s_waitcnt vmcnt(0) lgkmcnt(0)
    s_barrier
    v_mul_f32 v140, v140, v209
    v_mfma_f32_16x16x32_bf16 v[32:35], a[64:67], a[96:99], v[32:35]
    ds_read_b64_tr_b16 a[0:1], v3 offset:8
    v_cvt_pk_bf16_f32 v112, v172, v140
    v_mfma_f32_16x16x32_bf16 v[36:39], a[64:67], a[100:103], v[36:39]
    ds_read_b64_tr_b16 a[2:3], v3 offset:0
    v_add_f32 v141, v141, v157
    v_mfma_f32_16x16x32_bf16 v[36:39], a[68:71], a[96:99], v[36:39]
    ds_read_b128 a[32:35], v4 offset:192
    v_and_b32 v210, 0xffff0000, v190
    v_mfma_f32_16x16x32_bf16 v[40:43], a[64:67], a[104:107], v[40:43]
    ds_read_b64_tr_b16 a[4:5], v3 offset:520
    v_and_b32 v211, 0xffff0000, v116
    v_mfma_f32_16x16x32_bf16 v[40:43], a[68:71], a[100:103], v[40:43]
    ds_read_b64_tr_b16 a[6:7], v3 offset:512
    v_fmac_f32 v141, s41, v210
    v_mfma_f32_16x16x32_bf16 v[40:43], a[72:75], a[96:99], v[40:43]
    ds_read_b128 a[36:39], v4 offset:704
    v_mul_f32 v141, v141, v211
    v_mfma_f32_16x16x32_bf16 v[44:47], a[64:67], a[108:111], v[44:47]
    ds_read_b64_tr_b16 a[8:9], v3 offset:1032
    v_cvt_pk_bf16_f32 v116, v173, v141
    v_mfma_f32_16x16x32_bf16 v[44:47], a[68:71], a[104:107], v[44:47]
    ds_read_b64_tr_b16 a[10:11], v3 offset:1024
    v_add_f32 v142, v142, v158
    v_mfma_f32_16x16x32_bf16 v[44:47], a[72:75], a[100:103], v[44:47]
    ds_read_b128 a[40:43], v4 offset:1216
    ds_write_b128 v5, v[32:35] offset:32768
    v_mfma_f32_16x16x32_bf16 v[44:47], a[76:79], a[96:99], v[44:47]
    ds_read_b64_tr_b16 a[12:13], v3 offset:1544
    v_lshlrev_b32 v208, 16, v191
    v_mfma_f32_16x16x32_bf16 v[48:51], a[64:67], a[112:115], v[48:51]
    ds_read_b64_tr_b16 a[14:15], v3 offset:1536
    ds_write_b128 v5, v[36:39] offset:33792
    v_mfma_f32_16x16x32_bf16 v[48:51], a[68:71], a[108:111], v[48:51]
    ds_read_b128 a[44:47], v4 offset:1728
    v_and_b32 v209, 0xffff0000, v120
    v_mfma_f32_16x16x32_bf16 v[48:51], a[72:75], a[104:107], v[48:51]
    ds_read_b64_tr_b16 a[16:17], v3 offset:2056
    v_fmac_f32 v142, s41, v208
    v_mfma_f32_16x16x32_bf16 v[48:51], a[76:79], a[100:103], v[48:51]
    ds_read_b64_tr_b16 a[18:19], v3 offset:2048
    ds_write_b128 v5, v[40:43] offset:34816
    v_mfma_f32_16x16x32_bf16 v[48:51], a[80:83], a[96:99], v[48:51]
    ds_read_b128 a[48:51], v4 offset:2240
    v_mul_f32 v142, v142, v209
    v_mfma_f32_16x16x32_bf16 v[52:55], a[64:67], a[116:119], v[52:55]
    ds_read_b64_tr_b16 a[20:21], v3 offset:2568
    v_cvt_pk_bf16_f32 v120, v174, v142
    v_mfma_f32_16x16x32_bf16 v[52:55], a[68:71], a[112:115], v[52:55]
    ds_read_b64_tr_b16 a[22:23], v3 offset:2560
    v_add_f32 v143, v143, v159
    v_mfma_f32_16x16x32_bf16 v[52:55], a[72:75], a[108:111], v[52:55]
    ds_read_b128 a[52:55], v4 offset:2752
    ds_write_b128 v5, v[44:47] offset:35840
    v_mfma_f32_16x16x32_bf16 v[52:55], a[76:79], a[104:107], v[52:55]
    ds_read_b64_tr_b16 a[24:25], v3 offset:3080
    v_and_b32 v210, 0xffff0000, v191
    v_mfma_f32_16x16x32_bf16 v[52:55], a[80:83], a[100:103], v[52:55]
    ds_read_b64_tr_b16 a[26:27], v3 offset:3072
    v_and_b32 v211, 0xffff0000, v124
    v_mfma_f32_16x16x32_bf16 v[52:55], a[84:87], a[96:99], v[52:55]
    ds_read_b128 a[56:59], v4 offset:3264
    v_fmac_f32 v143, s41, v210
    v_mfma_f32_16x16x32_bf16 v[56:59], a[64:67], a[120:123], v[56:59]
    ds_read_b64_tr_b16 a[28:29], v3 offset:3592
    v_mul_f32 v143, v143, v211
    v_mfma_f32_16x16x32_bf16 v[56:59], a[68:71], a[116:119], v[56:59]
    ds_read_b64_tr_b16 a[30:31], v3 offset:3584
    ds_write_b128 v5, v[48:51] offset:36864
    v_mfma_f32_16x16x32_bf16 v[56:59], a[72:75], a[112:115], v[56:59]
    ds_read_b128 a[60:63], v4 offset:3776
    v_cvt_pk_bf16_f32 v124, v175, v143
    v_mfma_f32_16x16x32_bf16 v[56:59], a[76:79], a[108:111], v[56:59]
    v_mfma_f32_16x16x32_bf16 v[56:59], a[80:83], a[104:107], v[56:59]
    v_mfma_f32_16x16x32_bf16 v[56:59], a[84:87], a[100:103], v[56:59]
    v_mfma_f32_16x16x32_bf16 v[56:59], a[88:91], a[96:99], v[56:59]
    v_mfma_f32_16x16x32_bf16 v[60:63], a[64:67], a[124:127], v[60:63]
    ds_write_b128 v5, v[52:55] offset:37888
    v_mfma_f32_16x16x32_bf16 v[60:63], a[68:71], a[120:123], v[60:63]
    v_mfma_f32_16x16x32_bf16 v[60:63], a[72:75], a[116:119], v[60:63]
    v_mfma_f32_16x16x32_bf16 v[60:63], a[76:79], a[112:115], v[60:63]
    v_mfma_f32_16x16x32_bf16 v[60:63], a[80:83], a[108:111], v[60:63]
    v_mfma_f32_16x16x32_bf16 v[60:63], a[84:87], a[104:107], v[60:63]
    v_mfma_f32_16x16x32_bf16 v[60:63], a[88:91], a[100:103], v[60:63]
    v_mfma_f32_16x16x32_bf16 v[60:63], a[92:95], a[96:99], v[60:63]
    s_waitcnt lgkmcnt(15)
    ds_write_b128 v5, v[56:59] offset:38912
    v_mfma_f32_16x16x32_bf16 v[32:35], a[0:3], a[32:35], 0
    s_add_u32 m0, s22, 21248
    ds_read_b64_tr_b16 a[64:65], v3 offset:72
    v_mfma_f32_16x16x32_bf16 v[36:39], a[0:3], a[36:39], 0
    ds_read_b64_tr_b16 a[66:67], v3 offset:64
    v_mfma_f32_16x16x32_bf16 v[36:39], a[4:7], a[32:35], v[36:39]
    ds_read_b128 a[96:99], v4 offset:128
    v_mfma_f32_16x16x32_bf16 v[40:43], a[0:3], a[40:43], 0
    ds_read_b64_tr_b16 a[68:69], v3 offset:584
    v_mfma_f32_16x16x32_bf16 v[40:43], a[4:7], a[36:39], v[40:43]
    ds_read_b128 v[128:131], v6 offset:0
    v_mfma_f32_16x16x32_bf16 v[40:43], a[8:11], a[32:35], v[40:43]
    ds_read_b64_tr_b16 a[70:71], v3 offset:576
    v_mfma_f32_16x16x32_bf16 v[44:47], a[0:3], a[44:47], 0
    ds_read_b128 a[100:103], v4 offset:640
    v_mfma_f32_16x16x32_bf16 v[44:47], a[4:7], a[40:43], v[44:47]
    ds_write_b128 v5, v[60:63] offset:39936
    v_mfma_f32_16x16x32_bf16 v[44:47], a[8:11], a[36:39], v[44:47]
    ds_read_b64_tr_b16 a[72:73], v3 offset:1096
    v_mfma_f32_16x16x32_bf16 v[44:47], a[12:15], a[32:35], v[44:47]
    s_waitcnt lgkmcnt(15)
    ds_read_b64_tr_b16 a[74:75], v3 offset:1088
    v_mfma_f32_16x16x32_bf16 v[48:51], a[0:3], a[48:51], 0
    ds_read_b128 v[144:147], v6 offset:8192
    v_mfma_f32_16x16x32_bf16 v[48:51], a[4:7], a[44:47], v[48:51]
    ds_read_b128 a[104:107], v4 offset:1152
    v_mfma_f32_16x16x32_bf16 v[48:51], a[8:11], a[40:43], v[48:51]
    ds_read_b64_tr_b16 a[76:77], v3 offset:1608
    v_mfma_f32_16x16x32_bf16 v[48:51], a[12:15], a[36:39], v[48:51]
    ds_read_b64_tr_b16 a[78:79], v3 offset:1600
    v_mfma_f32_16x16x32_bf16 v[48:51], a[16:19], a[32:35], v[48:51]
    ds_read_b128 a[108:111], v4 offset:1664
    v_mfma_f32_16x16x32_bf16 v[52:55], a[0:3], a[52:55], 0
    ds_read_b128 v[132:135], v6 offset:1024
    v_mfma_f32_16x16x32_bf16 v[52:55], a[4:7], a[48:51], v[52:55]
    ds_read_b64_tr_b16 a[80:81], v3 offset:2120
    v_mfma_f32_16x16x32_bf16 v[52:55], a[8:11], a[44:47], v[52:55]
    ds_read_b64_tr_b16 a[82:83], v3 offset:2112
    v_mfma_f32_16x16x32_bf16 v[52:55], a[12:15], a[40:43], v[52:55]
    ds_read_b128 a[112:115], v4 offset:2176
    v_mfma_f32_16x16x32_bf16 v[52:55], a[16:19], a[36:39], v[52:55]
    ds_read_b64_tr_b16 a[84:85], v3 offset:2632
    v_mfma_f32_16x16x32_bf16 v[52:55], a[20:23], a[32:35], v[52:55]
    ds_read_b128 v[148:151], v6 offset:9216
    v_mfma_f32_16x16x32_bf16 v[56:59], a[0:3], a[56:59], 0
    ds_read_b64_tr_b16 a[86:87], v3 offset:2624
    v_mfma_f32_16x16x32_bf16 v[56:59], a[4:7], a[52:55], v[56:59]
    ds_read_b128 a[116:119], v4 offset:2688
    v_mfma_f32_16x16x32_bf16 v[56:59], a[8:11], a[48:51], v[56:59]
    ds_read_b64_tr_b16 a[88:89], v3 offset:3144
    v_mfma_f32_16x16x32_bf16 v[56:59], a[12:15], a[44:47], v[56:59]
    ds_read_b64_tr_b16 a[90:91], v3 offset:3136
    v_mfma_f32_16x16x32_bf16 v[56:59], a[16:19], a[40:43], v[56:59]
    ds_read_b128 v[136:139], v6 offset:2048
    v_mfma_f32_16x16x32_bf16 v[56:59], a[20:23], a[36:39], v[56:59]
    ds_read_b128 a[120:123], v4 offset:3200
    v_mfma_f32_16x16x32_bf16 v[56:59], a[24:27], a[32:35], v[56:59]
    s_waitcnt lgkmcnt(15)
    ds_read_b64_tr_b16 a[92:93], v3 offset:3656
    v_mfma_f32_16x16x32_bf16 v[60:63], a[0:3], a[60:63], 0
    ds_read_b64_tr_b16 a[94:95], v3 offset:3648
    v_mfma_f32_16x16x32_bf16 v[60:63], a[4:7], a[56:59], v[60:63]
    ds_read_b128 a[124:127], v4 offset:3712
    v_mfma_f32_16x16x32_bf16 v[60:63], a[8:11], a[52:55], v[60:63]
    ds_read_b128 v[152:155], v6 offset:10240
    v_mfma_f32_16x16x32_bf16 v[60:63], a[12:15], a[48:51], v[60:63]
    ds_read_b128 v[140:143], v6 offset:3072
    v_mfma_f32_16x16x32_bf16 v[60:63], a[16:19], a[44:47], v[60:63]
    ds_read_b128 v[156:159], v6 offset:11264
    v_mfma_f32_16x16x32_bf16 v[60:63], a[20:23], a[40:43], v[60:63]
    buffer_load_dwordx4 v2, s[8:11], s20 offen offset:0 lds
    v_mfma_f32_16x16x32_bf16 v[60:63], a[24:27], a[36:39], v[60:63]
    buffer_load_dwordx4 v2, s[8:11], s20 offen offset:1024 lds
    v_mfma_f32_16x16x32_bf16 v[60:63], a[28:31], a[32:35], v[60:63]
    s_add_u32 m0, s21, 21248
    v_add_f32 v128, v128, v144
    v_lshlrev_b32 v208, 16, v192
    v_mfma_f32_16x16x32_bf16 v[32:35], a[64:67], a[96:99], v[32:35]
    ds_read_b64_tr_b16 a[0:1], v3 offset:136
    v_lshlrev_b32 v209, 16, v65
    v_mfma_f32_16x16x32_bf16 v[36:39], a[64:67], a[100:103], v[36:39]
    ds_read_b64_tr_b16 a[2:3], v3 offset:128
    v_fmac_f32 v128, s42, v208
    v_mfma_f32_16x16x32_bf16 v[36:39], a[68:71], a[96:99], v[36:39]
    ds_read_b128 a[32:35], v4 offset:64
    v_mul_f32 v160, v128, v209
    v_mfma_f32_16x16x32_bf16 v[40:43], a[64:67], a[104:107], v[40:43]
    ds_read_b64_tr_b16 a[4:5], v3 offset:648
    v_add_f32 v129, v129, v145
    v_mfma_f32_16x16x32_bf16 v[40:43], a[68:71], a[100:103], v[40:43]
    buffer_load_dwordx4 v2, s[4:7], s18 offen offset:0 lds
    v_mfma_f32_16x16x32_bf16 v[40:43], a[72:75], a[96:99], v[40:43]
    s_waitcnt lgkmcnt(15)
    ds_read_b64_tr_b16 a[6:7], v3 offset:640
    v_and_b32 v210, 0xffff0000, v192
    v_mfma_f32_16x16x32_bf16 v[44:47], a[64:67], a[108:111], v[44:47]
    ds_read_b128 a[36:39], v4 offset:576
    v_lshlrev_b32 v211, 16, v69
    v_mfma_f32_16x16x32_bf16 v[44:47], a[68:71], a[104:107], v[44:47]
    ds_read_b64_tr_b16 a[8:9], v3 offset:1160
    v_fmac_f32 v129, s42, v210
    v_mfma_f32_16x16x32_bf16 v[44:47], a[72:75], a[100:103], v[44:47]
    ds_read_b64_tr_b16 a[10:11], v3 offset:1152
    v_mul_f32 v161, v129, v211
    v_mfma_f32_16x16x32_bf16 v[44:47], a[76:79], a[96:99], v[44:47]
    buffer_load_dwordx4 v2, s[4:7], s18 offen offset:1024 lds
    v_mfma_f32_16x16x32_bf16 v[48:51], a[64:67], a[112:115], v[48:51]
    ds_read_b128 a[40:43], v4 offset:1088
    v_add_f32 v130, v130, v146
    v_mfma_f32_16x16x32_bf16 v[48:51], a[68:71], a[108:111], v[48:51]
    ds_read_b64_tr_b16 a[12:13], v3 offset:1672
    v_lshlrev_b32 v208, 16, v193
    v_mfma_f32_16x16x32_bf16 v[48:51], a[72:75], a[104:107], v[48:51]
    ds_read_b64_tr_b16 a[14:15], v3 offset:1664
    v_lshlrev_b32 v209, 16, v73
    v_mfma_f32_16x16x32_bf16 v[48:51], a[76:79], a[100:103], v[48:51]
    ds_read_b128 a[44:47], v4 offset:1600
    v_fmac_f32 v130, s42, v208
    v_mfma_f32_16x16x32_bf16 v[48:51], a[80:83], a[96:99], v[48:51]
    s_waitcnt lgkmcnt(15)
    buffer_load_dwordx4 v2, s[4:7], s18 offen offset:2048 lds
    v_mfma_f32_16x16x32_bf16 v[52:55], a[64:67], a[116:119], v[52:55]
    ds_read_b64_tr_b16 a[16:17], v3 offset:2184
    v_mul_f32 v162, v130, v209
    v_mfma_f32_16x16x32_bf16 v[52:55], a[68:71], a[112:115], v[52:55]
    ds_read_b64_tr_b16 a[18:19], v3 offset:2176
    v_add_f32 v131, v131, v147
    v_mfma_f32_16x16x32_bf16 v[52:55], a[72:75], a[108:111], v[52:55]
    ds_read_b128 a[48:51], v4 offset:2112
    v_and_b32 v210, 0xffff0000, v193
    v_mfma_f32_16x16x32_bf16 v[52:55], a[76:79], a[104:107], v[52:55]
    ds_read_b64_tr_b16 a[20:21], v3 offset:2696
    v_lshlrev_b32 v211, 16, v77
    v_mfma_f32_16x16x32_bf16 v[52:55], a[80:83], a[100:103], v[52:55]
    buffer_load_dwordx4 v2, s[4:7], s18 offen offset:3072 lds
    v_mfma_f32_16x16x32_bf16 v[52:55], a[84:87], a[96:99], v[52:55]
    s_add_u32 m0, s21, 25408
    ds_read_b64_tr_b16 a[22:23], v3 offset:2688
    v_fmac_f32 v131, s42, v210
    v_mfma_f32_16x16x32_bf16 v[56:59], a[64:67], a[120:123], v[56:59]
    ds_read_b128 a[52:55], v4 offset:2624
    v_mul_f32 v163, v131, v211
    v_mfma_f32_16x16x32_bf16 v[56:59], a[68:71], a[116:119], v[56:59]
    ds_read_b64_tr_b16 a[24:25], v3 offset:3208
    v_add_f32 v132, v132, v148
    v_mfma_f32_16x16x32_bf16 v[56:59], a[72:75], a[112:115], v[56:59]
    ds_read_b64_tr_b16 a[26:27], v3 offset:3200
    v_lshlrev_b32 v208, 16, v194
    v_mfma_f32_16x16x32_bf16 v[56:59], a[76:79], a[108:111], v[56:59]
    buffer_load_dwordx4 v2, s[4:7], s19 offen offset:0 lds
    v_mfma_f32_16x16x32_bf16 v[56:59], a[80:83], a[104:107], v[56:59]
    ds_read_b128 a[56:59], v4 offset:3136
    v_lshlrev_b32 v209, 16, v81
    v_mfma_f32_16x16x32_bf16 v[56:59], a[84:87], a[100:103], v[56:59]
    ds_read_b64_tr_b16 a[28:29], v3 offset:3720
    v_fmac_f32 v132, s42, v208
    v_mfma_f32_16x16x32_bf16 v[56:59], a[88:91], a[96:99], v[56:59]
    ds_read_b64_tr_b16 a[30:31], v3 offset:3712
    v_mul_f32 v164, v132, v209
    v_mfma_f32_16x16x32_bf16 v[60:63], a[64:67], a[124:127], v[60:63]
    ds_read_b128 a[60:63], v4 offset:3648
    v_add_f32 v133, v133, v149
    v_mfma_f32_16x16x32_bf16 v[60:63], a[68:71], a[120:123], v[60:63]
    buffer_load_dwordx4 v2, s[4:7], s19 offen offset:1024 lds
    v_mfma_f32_16x16x32_bf16 v[60:63], a[72:75], a[116:119], v[60:63]
    buffer_load_dwordx4 v2, s[4:7], s19 offen offset:2048 lds
    v_mfma_f32_16x16x32_bf16 v[60:63], a[76:79], a[112:115], v[60:63]
    buffer_load_dwordx4 v2, s[4:7], s19 offen offset:3072 lds
    v_mfma_f32_16x16x32_bf16 v[60:63], a[80:83], a[108:111], v[60:63]
    s_add_u32 s20, s20, 4096
    v_and_b32 v210, 0xffff0000, v194
    v_lshlrev_b32 v211, 16, v85
    v_mfma_f32_16x16x32_bf16 v[60:63], a[84:87], a[104:107], v[60:63]
    s_add_u32 s18, s18, 4224
    v_fmac_f32 v133, s42, v210
    v_mul_f32 v165, v133, v211
    v_mfma_f32_16x16x32_bf16 v[60:63], a[88:91], a[100:103], v[60:63]
    s_add_u32 s19, s19, 4224
    v_add_f32 v134, v134, v150
    v_lshlrev_b32 v208, 16, v195
    v_mfma_f32_16x16x32_bf16 v[60:63], a[92:95], a[96:99], v[60:63]
    s_waitcnt lgkmcnt(15)
    v_lshlrev_b32 v209, 16, v89
    v_fmac_f32 v134, s42, v208
    v_mfma_f32_16x16x32_bf16 v[32:35], a[0:3], a[32:35], v[32:35]
    ds_read_b64_tr_b16 a[64:65], v3 offset:200
    v_mul_f32 v166, v134, v209
    v_mfma_f32_16x16x32_bf16 v[36:39], a[0:3], a[36:39], v[36:39]
    ds_read_b64_tr_b16 a[66:67], v3 offset:192
    v_add_f32 v135, v135, v151
    v_mfma_f32_16x16x32_bf16 v[36:39], a[4:7], a[32:35], v[36:39]
    ds_read_b128 a[96:99], v4 offset:0
    v_and_b32 v210, 0xffff0000, v195
    v_mfma_f32_16x16x32_bf16 v[40:43], a[0:3], a[40:43], v[40:43]
    ds_read_b64_tr_b16 a[68:69], v3 offset:712
    v_lshlrev_b32 v211, 16, v93
    v_mfma_f32_16x16x32_bf16 v[40:43], a[4:7], a[36:39], v[40:43]
    v_fmac_f32 v135, s42, v210
    v_mul_f32 v167, v135, v211
    v_mfma_f32_16x16x32_bf16 v[40:43], a[8:11], a[32:35], v[40:43]
    s_waitcnt lgkmcnt(15)
    ds_read_b64_tr_b16 a[70:71], v3 offset:704
    v_add_f32 v136, v136, v152
    v_mfma_f32_16x16x32_bf16 v[44:47], a[0:3], a[44:47], v[44:47]
    ds_read_b128 a[100:103], v4 offset:512
    v_lshlrev_b32 v208, 16, v196
    v_mfma_f32_16x16x32_bf16 v[44:47], a[4:7], a[40:43], v[44:47]
    ds_read_b64_tr_b16 a[72:73], v3 offset:1224
    v_lshlrev_b32 v209, 16, v97
    v_mfma_f32_16x16x32_bf16 v[44:47], a[8:11], a[36:39], v[44:47]
    ds_read_b64_tr_b16 a[74:75], v3 offset:1216
    v_fmac_f32 v136, s42, v208
    v_mfma_f32_16x16x32_bf16 v[44:47], a[12:15], a[32:35], v[44:47]
    s_waitcnt lgkmcnt(15)
    v_mul_f32 v168, v136, v209
    v_add_f32 v137, v137, v153
    v_mfma_f32_16x16x32_bf16 v[48:51], a[0:3], a[48:51], v[48:51]
    ds_read_b128 a[104:107], v4 offset:1024
    v_and_b32 v210, 0xffff0000, v196
    v_mfma_f32_16x16x32_bf16 v[48:51], a[4:7], a[44:47], v[48:51]
    ds_read_b64_tr_b16 a[76:77], v3 offset:1736
    v_lshlrev_b32 v211, 16, v101
    v_mfma_f32_16x16x32_bf16 v[48:51], a[8:11], a[40:43], v[48:51]
    ds_read_b64_tr_b16 a[78:79], v3 offset:1728
    v_fmac_f32 v137, s42, v210
    v_mfma_f32_16x16x32_bf16 v[48:51], a[12:15], a[36:39], v[48:51]
    ds_read_b128 a[108:111], v4 offset:1536
    v_mul_f32 v169, v137, v211
    v_mfma_f32_16x16x32_bf16 v[48:51], a[16:19], a[32:35], v[48:51]
    s_waitcnt lgkmcnt(15)
    v_add_f32 v138, v138, v154
    v_lshlrev_b32 v208, 16, v197
    v_mfma_f32_16x16x32_bf16 v[52:55], a[0:3], a[52:55], v[52:55]
    ds_read_b64_tr_b16 a[80:81], v3 offset:2248
    v_lshlrev_b32 v209, 16, v105
    v_mfma_f32_16x16x32_bf16 v[52:55], a[4:7], a[48:51], v[52:55]
    ds_read_b64_tr_b16 a[82:83], v3 offset:2240
    v_fmac_f32 v138, s42, v208
    v_mfma_f32_16x16x32_bf16 v[52:55], a[8:11], a[44:47], v[52:55]
    ds_read_b128 a[112:115], v4 offset:2048
    v_mul_f32 v170, v138, v209
    v_mfma_f32_16x16x32_bf16 v[52:55], a[12:15], a[40:43], v[52:55]
    ds_read_b64_tr_b16 a[84:85], v3 offset:2760
    v_add_f32 v139, v139, v155
    v_mfma_f32_16x16x32_bf16 v[52:55], a[16:19], a[36:39], v[52:55]
    v_and_b32 v210, 0xffff0000, v197
    v_lshlrev_b32 v211, 16, v109
    v_mfma_f32_16x16x32_bf16 v[52:55], a[20:23], a[32:35], v[52:55]
    ds_read_b64_tr_b16 a[86:87], v3 offset:2752
    v_fmac_f32 v139, s42, v210
    v_mfma_f32_16x16x32_bf16 v[56:59], a[0:3], a[56:59], v[56:59]
    ds_read_b128 a[116:119], v4 offset:2560
    v_mul_f32 v171, v139, v211
    v_mfma_f32_16x16x32_bf16 v[56:59], a[4:7], a[52:55], v[56:59]
    ds_read_b64_tr_b16 a[88:89], v3 offset:3272
    v_add_f32 v140, v140, v156
    v_mfma_f32_16x16x32_bf16 v[56:59], a[8:11], a[48:51], v[56:59]
    ds_read_b64_tr_b16 a[90:91], v3 offset:3264
    v_lshlrev_b32 v208, 16, v198
    v_mfma_f32_16x16x32_bf16 v[56:59], a[12:15], a[44:47], v[56:59]
    v_lshlrev_b32 v209, 16, v113
    v_fmac_f32 v140, s42, v208
    v_mfma_f32_16x16x32_bf16 v[56:59], a[16:19], a[40:43], v[56:59]
    ds_read_b128 a[120:123], v4 offset:3072
    v_mul_f32 v172, v140, v209
    v_mfma_f32_16x16x32_bf16 v[56:59], a[20:23], a[36:39], v[56:59]
    ds_read_b64_tr_b16 a[92:93], v3 offset:3784
    v_add_f32 v141, v141, v157
    v_mfma_f32_16x16x32_bf16 v[56:59], a[24:27], a[32:35], v[56:59]
    s_waitcnt lgkmcnt(15)
    ds_read_b64_tr_b16 a[94:95], v3 offset:3776
    v_and_b32 v210, 0xffff0000, v198
    v_mfma_f32_16x16x32_bf16 v[60:63], a[0:3], a[60:63], v[60:63]
    ds_read_b128 a[124:127], v4 offset:3584
    v_lshlrev_b32 v211, 16, v117
    v_mfma_f32_16x16x32_bf16 v[60:63], a[4:7], a[56:59], v[60:63]
    v_fmac_f32 v141, s42, v210
    v_mul_f32 v173, v141, v211
    v_mfma_f32_16x16x32_bf16 v[60:63], a[8:11], a[52:55], v[60:63]
    ds_read_b64 v[176:177], v7 offset:0
    v_add_f32 v142, v142, v158
    v_mfma_f32_16x16x32_bf16 v[60:63], a[12:15], a[48:51], v[60:63]
    ds_read_b64 v[178:179], v7 offset:512
    v_lshlrev_b32 v208, 16, v199
    v_mfma_f32_16x16x32_bf16 v[60:63], a[16:19], a[44:47], v[60:63]
    ds_read_b64 v[180:181], v7 offset:1024
    v_lshlrev_b32 v209, 16, v121
    v_mfma_f32_16x16x32_bf16 v[60:63], a[20:23], a[40:43], v[60:63]
    ds_read_b64 v[182:183], v7 offset:1536
    v_fmac_f32 v142, s42, v208
    v_mfma_f32_16x16x32_bf16 v[60:63], a[24:27], a[36:39], v[60:63]
    v_mul_f32 v174, v142, v209
    v_add_f32 v143, v143, v159
    v_mfma_f32_16x16x32_bf16 v[60:63], a[28:31], a[32:35], v[60:63]
    s_waitcnt vmcnt(0) lgkmcnt(0)
    s_barrier
    v_and_b32 v210, 0xffff0000, v199
    v_mfma_f32_16x16x32_bf16 v[32:35], a[64:67], a[96:99], v[32:35]
    ds_read_b64_tr_b16 a[0:1], v3 offset:21256
    v_lshlrev_b32 v211, 16, v125
    v_mfma_f32_16x16x32_bf16 v[36:39], a[64:67], a[100:103], v[36:39]
    ds_read_b64_tr_b16 a[2:3], v3 offset:21248
    v_fmac_f32 v143, s42, v210
    v_mfma_f32_16x16x32_bf16 v[36:39], a[68:71], a[96:99], v[36:39]
    ds_read_b128 a[32:35], v4 offset:21440
    v_mul_f32 v175, v143, v211
    v_mfma_f32_16x16x32_bf16 v[40:43], a[64:67], a[104:107], v[40:43]
    ds_read_b64_tr_b16 a[4:5], v3 offset:21768
    v_mfma_f32_16x16x32_bf16 v[40:43], a[68:71], a[100:103], v[40:43]
    ds_read_b64_tr_b16 a[6:7], v3 offset:21760
    v_mfma_f32_16x16x32_bf16 v[40:43], a[72:75], a[96:99], v[40:43]
    ds_read_b128 a[36:39], v4 offset:21952
    v_mfma_f32_16x16x32_bf16 v[44:47], a[64:67], a[108:111], v[44:47]
    ds_read_b64_tr_b16 a[8:9], v3 offset:22280
    v_mfma_f32_16x16x32_bf16 v[44:47], a[68:71], a[104:107], v[44:47]
    ds_read_b64_tr_b16 a[10:11], v3 offset:22272
    v_mfma_f32_16x16x32_bf16 v[44:47], a[72:75], a[100:103], v[44:47]
    ds_read_b128 a[40:43], v4 offset:22464
    ds_write_b128 v5, v[32:35] offset:0
    v_mfma_f32_16x16x32_bf16 v[44:47], a[76:79], a[96:99], v[44:47]
    ds_read_b64_tr_b16 a[12:13], v3 offset:22792
    v_mfma_f32_16x16x32_bf16 v[48:51], a[64:67], a[112:115], v[48:51]
    ds_read_b64_tr_b16 a[14:15], v3 offset:22784
    ds_write_b128 v5, v[36:39] offset:1024
    v_mfma_f32_16x16x32_bf16 v[48:51], a[68:71], a[108:111], v[48:51]
    ds_read_b128 a[44:47], v4 offset:22976
    v_mfma_f32_16x16x32_bf16 v[48:51], a[72:75], a[104:107], v[48:51]
    ds_read_b64_tr_b16 a[16:17], v3 offset:23304
    v_mfma_f32_16x16x32_bf16 v[48:51], a[76:79], a[100:103], v[48:51]
    ds_read_b64_tr_b16 a[18:19], v3 offset:23296
    ds_write_b128 v5, v[40:43] offset:2048
    v_mfma_f32_16x16x32_bf16 v[48:51], a[80:83], a[96:99], v[48:51]
    ds_read_b128 a[48:51], v4 offset:23488
    v_mfma_f32_16x16x32_bf16 v[52:55], a[64:67], a[116:119], v[52:55]
    ds_read_b64_tr_b16 a[20:21], v3 offset:23816
    v_mfma_f32_16x16x32_bf16 v[52:55], a[68:71], a[112:115], v[52:55]
    ds_read_b64_tr_b16 a[22:23], v3 offset:23808
    v_mfma_f32_16x16x32_bf16 v[52:55], a[72:75], a[108:111], v[52:55]
    ds_read_b128 a[52:55], v4 offset:24000
    ds_write_b128 v5, v[44:47] offset:3072
    v_mfma_f32_16x16x32_bf16 v[52:55], a[76:79], a[104:107], v[52:55]
    ds_read_b64_tr_b16 a[24:25], v3 offset:24328
    v_mfma_f32_16x16x32_bf16 v[52:55], a[80:83], a[100:103], v[52:55]
    ds_read_b64_tr_b16 a[26:27], v3 offset:24320
    v_mfma_f32_16x16x32_bf16 v[52:55], a[84:87], a[96:99], v[52:55]
    ds_read_b128 a[56:59], v4 offset:24512
    v_mfma_f32_16x16x32_bf16 v[56:59], a[64:67], a[120:123], v[56:59]
    ds_read_b64_tr_b16 a[28:29], v3 offset:24840
    v_mfma_f32_16x16x32_bf16 v[56:59], a[68:71], a[116:119], v[56:59]
    ds_read_b64_tr_b16 a[30:31], v3 offset:24832
    ds_write_b128 v5, v[48:51] offset:4096
    v_mfma_f32_16x16x32_bf16 v[56:59], a[72:75], a[112:115], v[56:59]
    ds_read_b128 a[60:63], v4 offset:25024
    v_mfma_f32_16x16x32_bf16 v[56:59], a[76:79], a[108:111], v[56:59]
    v_mfma_f32_16x16x32_bf16 v[56:59], a[80:83], a[104:107], v[56:59]
    v_mfma_f32_16x16x32_bf16 v[56:59], a[84:87], a[100:103], v[56:59]
    v_mfma_f32_16x16x32_bf16 v[56:59], a[88:91], a[96:99], v[56:59]
    v_mfma_f32_16x16x32_bf16 v[60:63], a[64:67], a[124:127], v[60:63]
    ds_write_b128 v5, v[52:55] offset:5120
    v_mfma_f32_16x16x32_bf16 v[60:63], a[68:71], a[120:123], v[60:63]
    v_mfma_f32_16x16x32_bf16 v[60:63], a[72:75], a[116:119], v[60:63]
    v_mfma_f32_16x16x32_bf16 v[60:63], a[76:79], a[112:115], v[60:63]
    v_mfma_f32_16x16x32_bf16 v[60:63], a[80:83], a[108:111], v[60:63]
    v_mfma_f32_16x16x32_bf16 v[60:63], a[84:87], a[104:107], v[60:63]
    v_mfma_f32_16x16x32_bf16 v[60:63], a[88:91], a[100:103], v[60:63]
    v_mfma_f32_16x16x32_bf16 v[60:63], a[92:95], a[96:99], v[60:63]
    s_waitcnt lgkmcnt(15)
    ds_write_b128 v5, v[56:59] offset:6144
    v_mfma_f32_16x16x32_bf16 v[32:35], a[0:3], a[32:35], 0
    s_add_u32 m0, s22, 0
    ds_read_b64_tr_b16 a[64:65], v3 offset:21320
    v_mfma_f32_16x16x32_bf16 v[36:39], a[0:3], a[36:39], 0
    ds_read_b64_tr_b16 a[66:67], v3 offset:21312
    v_mfma_f32_16x16x32_bf16 v[36:39], a[4:7], a[32:35], v[36:39]
    ds_read_b128 a[96:99], v4 offset:21376
    v_mfma_f32_16x16x32_bf16 v[40:43], a[0:3], a[40:43], 0
    ds_read_b64_tr_b16 a[68:69], v3 offset:21832
    v_mfma_f32_16x16x32_bf16 v[40:43], a[4:7], a[36:39], v[40:43]
    ds_read_b128 v[128:131], v6 offset:32768
    v_mfma_f32_16x16x32_bf16 v[40:43], a[8:11], a[32:35], v[40:43]
    ds_read_b64_tr_b16 a[70:71], v3 offset:21824
    v_mfma_f32_16x16x32_bf16 v[44:47], a[0:3], a[44:47], 0
    ds_read_b128 a[100:103], v4 offset:21888
    v_mfma_f32_16x16x32_bf16 v[44:47], a[4:7], a[40:43], v[44:47]
    ds_write_b128 v5, v[60:63] offset:7168
    v_mfma_f32_16x16x32_bf16 v[44:47], a[8:11], a[36:39], v[44:47]
    ds_read_b64_tr_b16 a[72:73], v3 offset:22344
    v_mfma_f32_16x16x32_bf16 v[44:47], a[12:15], a[32:35], v[44:47]
    s_waitcnt lgkmcnt(15)
    ds_read_b64_tr_b16 a[74:75], v3 offset:22336
    v_mfma_f32_16x16x32_bf16 v[48:51], a[0:3], a[48:51], 0
    ds_read_b128 v[144:147], v6 offset:40960
    v_mfma_f32_16x16x32_bf16 v[48:51], a[4:7], a[44:47], v[48:51]
    ds_read_b128 a[104:107], v4 offset:22400
    v_mfma_f32_16x16x32_bf16 v[48:51], a[8:11], a[40:43], v[48:51]
    ds_read_b64_tr_b16 a[76:77], v3 offset:22856
    v_mfma_f32_16x16x32_bf16 v[48:51], a[12:15], a[36:39], v[48:51]
    ds_read_b64_tr_b16 a[78:79], v3 offset:22848
    v_mfma_f32_16x16x32_bf16 v[48:51], a[16:19], a[32:35], v[48:51]
    ds_read_b128 a[108:111], v4 offset:22912
    v_mfma_f32_16x16x32_bf16 v[52:55], a[0:3], a[52:55], 0
    ds_read_b128 v[132:135], v6 offset:33792
    v_mfma_f32_16x16x32_bf16 v[52:55], a[4:7], a[48:51], v[52:55]
    ds_read_b64_tr_b16 a[80:81], v3 offset:23368
    v_mfma_f32_16x16x32_bf16 v[52:55], a[8:11], a[44:47], v[52:55]
    ds_read_b64_tr_b16 a[82:83], v3 offset:23360
    v_mfma_f32_16x16x32_bf16 v[52:55], a[12:15], a[40:43], v[52:55]
    ds_read_b128 a[112:115], v4 offset:23424
    v_mfma_f32_16x16x32_bf16 v[52:55], a[16:19], a[36:39], v[52:55]
    ds_read_b64_tr_b16 a[84:85], v3 offset:23880
    v_mfma_f32_16x16x32_bf16 v[52:55], a[20:23], a[32:35], v[52:55]
    ds_read_b128 v[148:151], v6 offset:41984
    v_mfma_f32_16x16x32_bf16 v[56:59], a[0:3], a[56:59], 0
    ds_read_b64_tr_b16 a[86:87], v3 offset:23872
    v_mfma_f32_16x16x32_bf16 v[56:59], a[4:7], a[52:55], v[56:59]
    ds_read_b128 a[116:119], v4 offset:23936
    v_mfma_f32_16x16x32_bf16 v[56:59], a[8:11], a[48:51], v[56:59]
    ds_read_b64_tr_b16 a[88:89], v3 offset:24392
    v_mfma_f32_16x16x32_bf16 v[56:59], a[12:15], a[44:47], v[56:59]
    ds_read_b64_tr_b16 a[90:91], v3 offset:24384
    v_mfma_f32_16x16x32_bf16 v[56:59], a[16:19], a[40:43], v[56:59]
    ds_read_b128 v[136:139], v6 offset:34816
    v_mfma_f32_16x16x32_bf16 v[56:59], a[20:23], a[36:39], v[56:59]
    ds_read_b128 a[120:123], v4 offset:24448
    v_mfma_f32_16x16x32_bf16 v[56:59], a[24:27], a[32:35], v[56:59]
    s_waitcnt lgkmcnt(15)
    ds_read_b64_tr_b16 a[92:93], v3 offset:24904
    v_mfma_f32_16x16x32_bf16 v[60:63], a[0:3], a[60:63], 0
    ds_read_b64_tr_b16 a[94:95], v3 offset:24896
    v_mfma_f32_16x16x32_bf16 v[60:63], a[4:7], a[56:59], v[60:63]
    ds_read_b128 a[124:127], v4 offset:24960
    v_mfma_f32_16x16x32_bf16 v[60:63], a[8:11], a[52:55], v[60:63]
    ds_read_b128 v[152:155], v6 offset:43008
    v_mfma_f32_16x16x32_bf16 v[60:63], a[12:15], a[48:51], v[60:63]
    ds_read_b128 v[140:143], v6 offset:35840
    v_mfma_f32_16x16x32_bf16 v[60:63], a[16:19], a[44:47], v[60:63]
    ds_read_b128 v[156:159], v6 offset:44032
    v_mfma_f32_16x16x32_bf16 v[60:63], a[20:23], a[40:43], v[60:63]
    buffer_load_dwordx4 v2, s[8:11], s20 offen offset:0 lds
    v_mfma_f32_16x16x32_bf16 v[60:63], a[24:27], a[36:39], v[60:63]
    buffer_load_dwordx4 v2, s[8:11], s20 offen offset:1024 lds
    v_mfma_f32_16x16x32_bf16 v[60:63], a[28:31], a[32:35], v[60:63]
    s_add_u32 m0, s21, 0
    v_add_f32 v128, v128, v144
    v_lshlrev_b32 v208, 16, v200
    v_mfma_f32_16x16x32_bf16 v[32:35], a[64:67], a[96:99], v[32:35]
    ds_read_b64_tr_b16 a[0:1], v3 offset:21384
    v_and_b32 v209, 0xffff0000, v65
    v_mfma_f32_16x16x32_bf16 v[36:39], a[64:67], a[100:103], v[36:39]
    ds_read_b64_tr_b16 a[2:3], v3 offset:21376
    v_fmac_f32 v128, s43, v208
    v_mfma_f32_16x16x32_bf16 v[36:39], a[68:71], a[96:99], v[36:39]
    ds_read_b128 a[32:35], v4 offset:21312
    v_mul_f32 v128, v128, v209
    v_mfma_f32_16x16x32_bf16 v[40:43], a[64:67], a[104:107], v[40:43]
    ds_read_b64_tr_b16 a[4:5], v3 offset:21896
    v_cvt_pk_bf16_f32 v65, v160, v128
    v_mfma_f32_16x16x32_bf16 v[40:43], a[68:71], a[100:103], v[40:43]
    buffer_load_dwordx4 v2, s[4:7], s18 offen offset:0 lds
    v_mfma_f32_16x16x32_bf16 v[40:43], a[72:75], a[96:99], v[40:43]
    s_waitcnt lgkmcnt(15)
    ds_read_b64_tr_b16 a[6:7], v3 offset:21888
    v_add_f32 v129, v129, v145
    v_mfma_f32_16x16x32_bf16 v[44:47], a[64:67], a[108:111], v[44:47]
    ds_read_b128 a[36:39], v4 offset:21824
    v_and_b32 v210, 0xffff0000, v200
    v_mfma_f32_16x16x32_bf16 v[44:47], a[68:71], a[104:107], v[44:47]
    ds_read_b64_tr_b16 a[8:9], v3 offset:22408
    v_and_b32 v211, 0xffff0000, v69
    v_mfma_f32_16x16x32_bf16 v[44:47], a[72:75], a[100:103], v[44:47]
    ds_read_b64_tr_b16 a[10:11], v3 offset:22400
    v_fmac_f32 v129, s43, v210
    v_mfma_f32_16x16x32_bf16 v[44:47], a[76:79], a[96:99], v[44:47]
    buffer_load_dwordx4 v2, s[4:7], s18 offen offset:1024 lds
    v_mfma_f32_16x16x32_bf16 v[48:51], a[64:67], a[112:115], v[48:51]
    ds_read_b128 a[40:43], v4 offset:22336
    v_mul_f32 v129, v129, v211
    v_mfma_f32_16x16x32_bf16 v[48:51], a[68:71], a[108:111], v[48:51]
    ds_read_b64_tr_b16 a[12:13], v3 offset:22920
    v_cvt_pk_bf16_f32 v69, v161, v129
    v_mfma_f32_16x16x32_bf16 v[48:51], a[72:75], a[104:107], v[48:51]
    ds_read_b64_tr_b16 a[14:15], v3 offset:22912
    v_add_f32 v130, v130, v146
    v_mfma_f32_16x16x32_bf16 v[48:51], a[76:79], a[100:103], v[48:51]
    ds_read_b128 a[44:47], v4 offset:22848
    v_lshlrev_b32 v208, 16, v201
    v_mfma_f32_16x16x32_bf16 v[48:51], a[80:83], a[96:99], v[48:51]
    s_waitcnt lgkmcnt(15)
    buffer_load_dwordx4 v2, s[4:7], s18 offen offset:2048 lds
    v_mfma_f32_16x16x32_bf16 v[52:55], a[64:67], a[116:119], v[52:55]
    ds_read_b64_tr_b16 a[16:17], v3 offset:23432
    v_and_b32 v209, 0xffff0000, v73
    v_mfma_f32_16x16x32_bf16 v[52:55], a[68:71], a[112:115], v[52:55]
    ds_read_b64_tr_b16 a[18:19], v3 offset:23424
    v_fmac_f32 v130, s43, v208
    v_mfma_f32_16x16x32_bf16 v[52:55], a[72:75], a[108:111], v[52:55]
    ds_read_b128 a[48:51], v4 offset:23360
    v_mul_f32 v130, v130, v209
    v_mfma_f32_16x16x32_bf16 v[52:55], a[76:79], a[104:107], v[52:55]
    ds_read_b64_tr_b16 a[20:21], v3 offset:23944
    v_cvt_pk_bf16_f32 v73, v162, v130
    v_mfma_f32_16x16x32_bf16 v[52:55], a[80:83], a[100:103], v[52:55]
    buffer_load_dwordx4 v2, s[4:7], s18 offen offset:3072 lds
    v_mfma_f32_16x16x32_bf16 v[52:55], a[84:87], a[96:99], v[52:55]
    s_add_u32 m0, s21, 4160
    ds_read_b64_tr_b16 a[22:23], v3 offset:23936
    v_add_f32 v131, v131, v147
    v_mfma_f32_16x16x32_bf16 v[56:59], a[64:67], a[120:123], v[56:59]
    ds_read_b128 a[52:55], v4 offset:23872
    v_and_b32 v210, 0xffff0000, v201
    v_mfma_f32_16x16x32_bf16 v[56:59], a[68:71], a[116:119], v[56:59]
    ds_read_b64_tr_b16 a[24:25], v3 offset:24456
    v_and_b32 v211, 0xffff0000, v77
    v_mfma_f32_16x16x32_bf16 v[56:59], a[72:75], a[112:115], v[56:59]
    ds_read_b64_tr_b16 a[26:27], v3 offset:24448
    v_fmac_f32 v131, s43, v210
    v_mfma_f32_16x16x32_bf16 v[56:59], a[76:79], a[108:111], v[56:59]
    buffer_load_dwordx4 v2, s[4:7], s19 offen offset:0 lds
    v_mfma_f32_16x16x32_bf16 v[56:59], a[80:83], a[104:107], v[56:59]
    ds_read_b128 a[56:59], v4 offset:24384
    v_mul_f32 v131, v131, v211
    v_mfma_f32_16x16x32_bf16 v[56:59], a[84:87], a[100:103], v[56:59]
    ds_read_b64_tr_b16 a[28:29], v3 offset:24968
    v_cvt_pk_bf16_f32 v77, v163, v131
    v_mfma_f32_16x16x32_bf16 v[56:59], a[88:91], a[96:99], v[56:59]
    ds_read_b64_tr_b16 a[30:31], v3 offset:24960
    v_add_f32 v132, v132, v148
    v_mfma_f32_16x16x32_bf16 v[60:63], a[64:67], a[124:127], v[60:63]
    ds_read_b128 a[60:63], v4 offset:24896
    v_lshlrev_b32 v208, 16, v202
    v_mfma_f32_16x16x32_bf16 v[60:63], a[68:71], a[120:123], v[60:63]
    buffer_load_dwordx4 v2, s[4:7], s19 offen offset:1024 lds
    v_mfma_f32_16x16x32_bf16 v[60:63], a[72:75], a[116:119], v[60:63]
    buffer_load_dwordx4 v2, s[4:7], s19 offen offset:2048 lds
    v_mfma_f32_16x16x32_bf16 v[60:63], a[76:79], a[112:115], v[60:63]
    buffer_load_dwordx4 v2, s[4:7], s19 offen offset:3072 lds
    v_mfma_f32_16x16x32_bf16 v[60:63], a[80:83], a[108:111], v[60:63]
    s_add_u32 s20, s20, 4096
    v_and_b32 v209, 0xffff0000, v81
    v_fmac_f32 v132, s43, v208
    v_mfma_f32_16x16x32_bf16 v[60:63], a[84:87], a[104:107], v[60:63]
    s_add_u32 s18, s18, 4224
    v_mul_f32 v132, v132, v209
    v_cvt_pk_bf16_f32 v81, v164, v132
    v_mfma_f32_16x16x32_bf16 v[60:63], a[88:91], a[100:103], v[60:63]
    s_add_u32 s19, s19, 4224
    v_add_f32 v133, v133, v149
    v_and_b32 v210, 0xffff0000, v202
    v_mfma_f32_16x16x32_bf16 v[60:63], a[92:95], a[96:99], v[60:63]
    s_waitcnt lgkmcnt(15)
    v_and_b32 v211, 0xffff0000, v85
    v_fmac_f32 v133, s43, v210
    v_mfma_f32_16x16x32_bf16 v[32:35], a[0:3], a[32:35], v[32:35]
    ds_read_b64_tr_b16 a[64:65], v3 offset:21448
    v_mul_f32 v133, v133, v211
    v_mfma_f32_16x16x32_bf16 v[36:39], a[0:3], a[36:39], v[36:39]
    ds_read_b64_tr_b16 a[66:67], v3 offset:21440
    v_cvt_pk_bf16_f32 v85, v165, v133
    v_mfma_f32_16x16x32_bf16 v[36:39], a[4:7], a[32:35], v[36:39]
    ds_read_b128 a[96:99], v4 offset:21248
    v_add_f32 v134, v134, v150
    v_mfma_f32_16x16x32_bf16 v[40:43], a[0:3], a[40:43], v[40:43]
    ds_read_b64_tr_b16 a[68:69], v3 offset:21960
    v_lshlrev_b32 v208, 16, v203
    v_mfma_f32_16x16x32_bf16 v[40:43], a[4:7], a[36:39], v[40:43]
    v_and_b32 v209, 0xffff0000, v89
    v_fmac_f32 v134, s43, v208
    v_mfma_f32_16x16x32_bf16 v[40:43], a[8:11], a[32:35], v[40:43]
    s_waitcnt lgkmcnt(15)
    ds_read_b64_tr_b16 a[70:71], v3 offset:21952
    v_mul_f32 v134, v134, v209
    v_mfma_f32_16x16x32_bf16 v[44:47], a[0:3], a[44:47], v[44:47]
    ds_read_b128 a[100:103], v4 offset:21760
    v_cvt_pk_bf16_f32 v89, v166, v134
    v_mfma_f32_16x16x32_bf16 v[44:47], a[4:7], a[40:43], v[44:47]
    ds_read_b64_tr_b16 a[72:73], v3 offset:22472
    v_add_f32 v135, v135, v151
    v_mfma_f32_16x16x32_bf16 v[44:47], a[8:11], a[36:39], v[44:47]
    ds_read_b64_tr_b16 a[74:75], v3 offset:22464
    v_and_b32 v210, 0xffff0000, v203
    v_mfma_f32_16x16x32_bf16 v[44:47], a[12:15], a[32:35], v[44:47]
    s_waitcnt lgkmcnt(15)
    v_and_b32 v211, 0xffff0000, v93
    v_fmac_f32 v135, s43, v210
    v_mfma_f32_16x16x32_bf16 v[48:51], a[0:3], a[48:51], v[48:51]
    ds_read_b128 a[104:107], v4 offset:22272
    v_mul_f32 v135, v135, v211
    v_mfma_f32_16x16x32_bf16 v[48:51], a[4:7], a[44:47], v[48:51]
    ds_read_b64_tr_b16 a[76:77], v3 offset:22984
    v_cvt_pk_bf16_f32 v93, v167, v135
    v_mfma_f32_16x16x32_bf16 v[48:51], a[8:11], a[40:43], v[48:51]
    ds_read_b64_tr_b16 a[78:79], v3 offset:22976
    v_add_f32 v136, v136, v152
    v_mfma_f32_16x16x32_bf16 v[48:51], a[12:15], a[36:39], v[48:51]
    ds_read_b128 a[108:111], v4 offset:22784
    v_lshlrev_b32 v208, 16, v204
    v_mfma_f32_16x16x32_bf16 v[48:51], a[16:19], a[32:35], v[48:51]
    s_waitcnt lgkmcnt(15)
    v_and_b32 v209, 0xffff0000, v97
    v_fmac_f32 v136, s43, v208
    v_mfma_f32_16x16x32_bf16 v[52:55], a[0:3], a[52:55], v[52:55]
    ds_read_b64_tr_b16 a[80:81], v3 offset:23496
    v_mul_f32 v136, v136, v209
    v_mfma_f32_16x16x32_bf16 v[52:55], a[4:7], a[48:51], v[52:55]
    ds_read_b64_tr_b16 a[82:83], v3 offset:23488
    v_cvt_pk_bf16_f32 v97, v168, v136
    v_mfma_f32_16x16x32_bf16 v[52:55], a[8:11], a[44:47], v[52:55]
    ds_read_b128 a[112:115], v4 offset:23296
    v_add_f32 v137, v137, v153
    v_mfma_f32_16x16x32_bf16 v[52:55], a[12:15], a[40:43], v[52:55]
    ds_read_b64_tr_b16 a[84:85], v3 offset:24008
    v_and_b32 v210, 0xffff0000, v204
    v_mfma_f32_16x16x32_bf16 v[52:55], a[16:19], a[36:39], v[52:55]
    v_and_b32 v211, 0xffff0000, v101
    v_fmac_f32 v137, s43, v210
    v_mfma_f32_16x16x32_bf16 v[52:55], a[20:23], a[32:35], v[52:55]
    ds_read_b64_tr_b16 a[86:87], v3 offset:24000
    v_mul_f32 v137, v137, v211
    v_mfma_f32_16x16x32_bf16 v[56:59], a[0:3], a[56:59], v[56:59]
    ds_read_b128 a[116:119], v4 offset:23808
    v_cvt_pk_bf16_f32 v101, v169, v137
    v_mfma_f32_16x16x32_bf16 v[56:59], a[4:7], a[52:55], v[56:59]
    ds_read_b64_tr_b16 a[88:89], v3 offset:24520
    v_add_f32 v138, v138, v154
    v_mfma_f32_16x16x32_bf16 v[56:59], a[8:11], a[48:51], v[56:59]
    ds_read_b64_tr_b16 a[90:91], v3 offset:24512
    v_lshlrev_b32 v208, 16, v205
    v_mfma_f32_16x16x32_bf16 v[56:59], a[12:15], a[44:47], v[56:59]
    v_and_b32 v209, 0xffff0000, v105
    v_fmac_f32 v138, s43, v208
    v_mfma_f32_16x16x32_bf16 v[56:59], a[16:19], a[40:43], v[56:59]
    ds_read_b128 a[120:123], v4 offset:24320
    v_mul_f32 v138, v138, v209
    v_mfma_f32_16x16x32_bf16 v[56:59], a[20:23], a[36:39], v[56:59]
    ds_read_b64_tr_b16 a[92:93], v3 offset:25032
    v_cvt_pk_bf16_f32 v105, v170, v138
    v_mfma_f32_16x16x32_bf16 v[56:59], a[24:27], a[32:35], v[56:59]
    s_waitcnt lgkmcnt(15)
    ds_read_b64_tr_b16 a[94:95], v3 offset:25024
    v_add_f32 v139, v139, v155
    v_mfma_f32_16x16x32_bf16 v[60:63], a[0:3], a[60:63], v[60:63]
    ds_read_b128 a[124:127], v4 offset:24832
    v_and_b32 v210, 0xffff0000, v205
    v_mfma_f32_16x16x32_bf16 v[60:63], a[4:7], a[56:59], v[60:63]
    v_and_b32 v211, 0xffff0000, v109
    v_fmac_f32 v139, s43, v210
    v_mfma_f32_16x16x32_bf16 v[60:63], a[8:11], a[52:55], v[60:63]
    ds_read_b64 v[184:185], v7 offset:21248
    v_mul_f32 v139, v139, v211
    v_mfma_f32_16x16x32_bf16 v[60:63], a[12:15], a[48:51], v[60:63]
    ds_read_b64 v[186:187], v7 offset:21760
    v_cvt_pk_bf16_f32 v109, v171, v139
    v_mfma_f32_16x16x32_bf16 v[60:63], a[16:19], a[44:47], v[60:63]
    ds_read_b64 v[188:189], v7 offset:22272
    v_add_f32 v140, v140, v156
    v_mfma_f32_16x16x32_bf16 v[60:63], a[20:23], a[40:43], v[60:63]
    ds_read_b64 v[190:191], v7 offset:22784
    v_lshlrev_b32 v208, 16, v206
    v_mfma_f32_16x16x32_bf16 v[60:63], a[24:27], a[36:39], v[60:63]
    v_and_b32 v209, 0xffff0000, v113
    v_fmac_f32 v140, s43, v208
    v_mfma_f32_16x16x32_bf16 v[60:63], a[28:31], a[32:35], v[60:63]
    s_waitcnt vmcnt(0) lgkmcnt(0)
    s_barrier
    v_mul_f32 v140, v140, v209
    v_mfma_f32_16x16x32_bf16 v[32:35], a[64:67], a[96:99], v[32:35]
    ds_read_b64_tr_b16 a[0:1], v3 offset:8
    v_cvt_pk_bf16_f32 v113, v172, v140
    v_mfma_f32_16x16x32_bf16 v[36:39], a[64:67], a[100:103], v[36:39]
    ds_read_b64_tr_b16 a[2:3], v3 offset:0
    v_add_f32 v141, v141, v157
    v_mfma_f32_16x16x32_bf16 v[36:39], a[68:71], a[96:99], v[36:39]
    ds_read_b128 a[32:35], v4 offset:192
    v_and_b32 v210, 0xffff0000, v206
    v_mfma_f32_16x16x32_bf16 v[40:43], a[64:67], a[104:107], v[40:43]
    ds_read_b64_tr_b16 a[4:5], v3 offset:520
    v_and_b32 v211, 0xffff0000, v117
    v_mfma_f32_16x16x32_bf16 v[40:43], a[68:71], a[100:103], v[40:43]
    ds_read_b64_tr_b16 a[6:7], v3 offset:512
    v_fmac_f32 v141, s43, v210
    v_mfma_f32_16x16x32_bf16 v[40:43], a[72:75], a[96:99], v[40:43]
    ds_read_b128 a[36:39], v4 offset:704
    v_mul_f32 v141, v141, v211
    v_mfma_f32_16x16x32_bf16 v[44:47], a[64:67], a[108:111], v[44:47]
    ds_read_b64_tr_b16 a[8:9], v3 offset:1032
    v_cvt_pk_bf16_f32 v117, v173, v141
    v_mfma_f32_16x16x32_bf16 v[44:47], a[68:71], a[104:107], v[44:47]
    ds_read_b64_tr_b16 a[10:11], v3 offset:1024
    v_add_f32 v142, v142, v158
    v_mfma_f32_16x16x32_bf16 v[44:47], a[72:75], a[100:103], v[44:47]
    ds_read_b128 a[40:43], v4 offset:1216
    ds_write_b128 v5, v[32:35] offset:32768
    v_mfma_f32_16x16x32_bf16 v[44:47], a[76:79], a[96:99], v[44:47]
    ds_read_b64_tr_b16 a[12:13], v3 offset:1544
    v_lshlrev_b32 v208, 16, v207
    v_mfma_f32_16x16x32_bf16 v[48:51], a[64:67], a[112:115], v[48:51]
    ds_read_b64_tr_b16 a[14:15], v3 offset:1536
    ds_write_b128 v5, v[36:39] offset:33792
    v_mfma_f32_16x16x32_bf16 v[48:51], a[68:71], a[108:111], v[48:51]
    ds_read_b128 a[44:47], v4 offset:1728
    v_and_b32 v209, 0xffff0000, v121
    v_mfma_f32_16x16x32_bf16 v[48:51], a[72:75], a[104:107], v[48:51]
    ds_read_b64_tr_b16 a[16:17], v3 offset:2056
    v_fmac_f32 v142, s43, v208
    v_mfma_f32_16x16x32_bf16 v[48:51], a[76:79], a[100:103], v[48:51]
    ds_read_b64_tr_b16 a[18:19], v3 offset:2048
    ds_write_b128 v5, v[40:43] offset:34816
    v_mfma_f32_16x16x32_bf16 v[48:51], a[80:83], a[96:99], v[48:51]
    ds_read_b128 a[48:51], v4 offset:2240
    v_mul_f32 v142, v142, v209
    v_mfma_f32_16x16x32_bf16 v[52:55], a[64:67], a[116:119], v[52:55]
    ds_read_b64_tr_b16 a[20:21], v3 offset:2568
    v_cvt_pk_bf16_f32 v121, v174, v142
    v_mfma_f32_16x16x32_bf16 v[52:55], a[68:71], a[112:115], v[52:55]
    ds_read_b64_tr_b16 a[22:23], v3 offset:2560
    v_add_f32 v143, v143, v159
    v_mfma_f32_16x16x32_bf16 v[52:55], a[72:75], a[108:111], v[52:55]
    ds_read_b128 a[52:55], v4 offset:2752
    ds_write_b128 v5, v[44:47] offset:35840
    v_mfma_f32_16x16x32_bf16 v[52:55], a[76:79], a[104:107], v[52:55]
    ds_read_b64_tr_b16 a[24:25], v3 offset:3080
    v_and_b32 v210, 0xffff0000, v207
    v_mfma_f32_16x16x32_bf16 v[52:55], a[80:83], a[100:103], v[52:55]
    ds_read_b64_tr_b16 a[26:27], v3 offset:3072
    v_and_b32 v211, 0xffff0000, v125
    v_mfma_f32_16x16x32_bf16 v[52:55], a[84:87], a[96:99], v[52:55]
    ds_read_b128 a[56:59], v4 offset:3264
    v_fmac_f32 v143, s43, v210
    v_mfma_f32_16x16x32_bf16 v[56:59], a[64:67], a[120:123], v[56:59]
    ds_read_b64_tr_b16 a[28:29], v3 offset:3592
    v_mul_f32 v143, v143, v211
    v_mfma_f32_16x16x32_bf16 v[56:59], a[68:71], a[116:119], v[56:59]
    ds_read_b64_tr_b16 a[30:31], v3 offset:3584
    ds_write_b128 v5, v[48:51] offset:36864
    v_mfma_f32_16x16x32_bf16 v[56:59], a[72:75], a[112:115], v[56:59]
    ds_read_b128 a[60:63], v4 offset:3776
    v_cvt_pk_bf16_f32 v125, v175, v143
    v_mfma_f32_16x16x32_bf16 v[56:59], a[76:79], a[108:111], v[56:59]
    v_mfma_f32_16x16x32_bf16 v[56:59], a[80:83], a[104:107], v[56:59]
    v_mfma_f32_16x16x32_bf16 v[56:59], a[84:87], a[100:103], v[56:59]
    v_mfma_f32_16x16x32_bf16 v[56:59], a[88:91], a[96:99], v[56:59]
    v_mfma_f32_16x16x32_bf16 v[60:63], a[64:67], a[124:127], v[60:63]
    ds_write_b128 v5, v[52:55] offset:37888
    v_mfma_f32_16x16x32_bf16 v[60:63], a[68:71], a[120:123], v[60:63]
    v_mfma_f32_16x16x32_bf16 v[60:63], a[72:75], a[116:119], v[60:63]
    v_mfma_f32_16x16x32_bf16 v[60:63], a[76:79], a[112:115], v[60:63]
    v_mfma_f32_16x16x32_bf16 v[60:63], a[80:83], a[108:111], v[60:63]
    v_mfma_f32_16x16x32_bf16 v[60:63], a[84:87], a[104:107], v[60:63]
    v_mfma_f32_16x16x32_bf16 v[60:63], a[88:91], a[100:103], v[60:63]
    v_mfma_f32_16x16x32_bf16 v[60:63], a[92:95], a[96:99], v[60:63]
    s_waitcnt lgkmcnt(15)
    ds_write_b128 v5, v[56:59] offset:38912
    v_mfma_f32_16x16x32_bf16 v[32:35], a[0:3], a[32:35], 0
    s_add_u32 m0, s22, 21248
    ds_read_b64_tr_b16 a[64:65], v3 offset:72
    v_mfma_f32_16x16x32_bf16 v[36:39], a[0:3], a[36:39], 0
    ds_read_b64_tr_b16 a[66:67], v3 offset:64
    v_mfma_f32_16x16x32_bf16 v[36:39], a[4:7], a[32:35], v[36:39]
    ds_read_b128 a[96:99], v4 offset:128
    v_mfma_f32_16x16x32_bf16 v[40:43], a[0:3], a[40:43], 0
    ds_read_b64_tr_b16 a[68:69], v3 offset:584
    v_mfma_f32_16x16x32_bf16 v[40:43], a[4:7], a[36:39], v[40:43]
    ds_read_b128 v[128:131], v6 offset:0
    v_mfma_f32_16x16x32_bf16 v[40:43], a[8:11], a[32:35], v[40:43]
    ds_read_b64_tr_b16 a[70:71], v3 offset:576
    v_mfma_f32_16x16x32_bf16 v[44:47], a[0:3], a[44:47], 0
    ds_read_b128 a[100:103], v4 offset:640
    v_mfma_f32_16x16x32_bf16 v[44:47], a[4:7], a[40:43], v[44:47]
    ds_write_b128 v5, v[60:63] offset:39936
    v_mfma_f32_16x16x32_bf16 v[44:47], a[8:11], a[36:39], v[44:47]
    ds_read_b64_tr_b16 a[72:73], v3 offset:1096
    v_mfma_f32_16x16x32_bf16 v[44:47], a[12:15], a[32:35], v[44:47]
    s_waitcnt lgkmcnt(15)
    ds_read_b64_tr_b16 a[74:75], v3 offset:1088
    v_mfma_f32_16x16x32_bf16 v[48:51], a[0:3], a[48:51], 0
    ds_read_b128 v[144:147], v6 offset:8192
    v_mfma_f32_16x16x32_bf16 v[48:51], a[4:7], a[44:47], v[48:51]
    ds_read_b128 a[104:107], v4 offset:1152
    v_mfma_f32_16x16x32_bf16 v[48:51], a[8:11], a[40:43], v[48:51]
    ds_read_b64_tr_b16 a[76:77], v3 offset:1608
    v_mfma_f32_16x16x32_bf16 v[48:51], a[12:15], a[36:39], v[48:51]
    ds_read_b64_tr_b16 a[78:79], v3 offset:1600
    v_mfma_f32_16x16x32_bf16 v[48:51], a[16:19], a[32:35], v[48:51]
    ds_read_b128 a[108:111], v4 offset:1664
    v_mfma_f32_16x16x32_bf16 v[52:55], a[0:3], a[52:55], 0
    ds_read_b128 v[132:135], v6 offset:1024
    v_mfma_f32_16x16x32_bf16 v[52:55], a[4:7], a[48:51], v[52:55]
    ds_read_b64_tr_b16 a[80:81], v3 offset:2120
    v_mfma_f32_16x16x32_bf16 v[52:55], a[8:11], a[44:47], v[52:55]
    ds_read_b64_tr_b16 a[82:83], v3 offset:2112
    v_mfma_f32_16x16x32_bf16 v[52:55], a[12:15], a[40:43], v[52:55]
    ds_read_b128 a[112:115], v4 offset:2176
    v_mfma_f32_16x16x32_bf16 v[52:55], a[16:19], a[36:39], v[52:55]
    ds_read_b64_tr_b16 a[84:85], v3 offset:2632
    v_mfma_f32_16x16x32_bf16 v[52:55], a[20:23], a[32:35], v[52:55]
    ds_read_b128 v[148:151], v6 offset:9216
    v_mfma_f32_16x16x32_bf16 v[56:59], a[0:3], a[56:59], 0
    ds_read_b64_tr_b16 a[86:87], v3 offset:2624
    v_mfma_f32_16x16x32_bf16 v[56:59], a[4:7], a[52:55], v[56:59]
    ds_read_b128 a[116:119], v4 offset:2688
    v_mfma_f32_16x16x32_bf16 v[56:59], a[8:11], a[48:51], v[56:59]
    ds_read_b64_tr_b16 a[88:89], v3 offset:3144
    v_mfma_f32_16x16x32_bf16 v[56:59], a[12:15], a[44:47], v[56:59]
    ds_read_b64_tr_b16 a[90:91], v3 offset:3136
    v_mfma_f32_16x16x32_bf16 v[56:59], a[16:19], a[40:43], v[56:59]
    ds_read_b128 v[136:139], v6 offset:2048
    v_mfma_f32_16x16x32_bf16 v[56:59], a[20:23], a[36:39], v[56:59]
    ds_read_b128 a[120:123], v4 offset:3200
    v_mfma_f32_16x16x32_bf16 v[56:59], a[24:27], a[32:35], v[56:59]
    s_waitcnt lgkmcnt(15)
    ds_read_b64_tr_b16 a[92:93], v3 offset:3656
    v_mfma_f32_16x16x32_bf16 v[60:63], a[0:3], a[60:63], 0
    ds_read_b64_tr_b16 a[94:95], v3 offset:3648
    v_mfma_f32_16x16x32_bf16 v[60:63], a[4:7], a[56:59], v[60:63]
    ds_read_b128 a[124:127], v4 offset:3712
    v_mfma_f32_16x16x32_bf16 v[60:63], a[8:11], a[52:55], v[60:63]
    ds_read_b128 v[152:155], v6 offset:10240
    v_mfma_f32_16x16x32_bf16 v[60:63], a[12:15], a[48:51], v[60:63]
    ds_read_b128 v[140:143], v6 offset:3072
    v_mfma_f32_16x16x32_bf16 v[60:63], a[16:19], a[44:47], v[60:63]
    ds_read_b128 v[156:159], v6 offset:11264
    v_mfma_f32_16x16x32_bf16 v[60:63], a[20:23], a[40:43], v[60:63]
    buffer_load_dwordx4 v2, s[8:11], s20 offen offset:0 lds
    v_mfma_f32_16x16x32_bf16 v[60:63], a[24:27], a[36:39], v[60:63]
    buffer_load_dwordx4 v2, s[8:11], s20 offen offset:1024 lds
    v_mfma_f32_16x16x32_bf16 v[60:63], a[28:31], a[32:35], v[60:63]
    s_add_u32 m0, s21, 21248
    v_add_f32 v128, v128, v144
    v_lshlrev_b32 v208, 16, v176
    v_mfma_f32_16x16x32_bf16 v[32:35], a[64:67], a[96:99], v[32:35]
    ds_read_b64_tr_b16 a[0:1], v3 offset:136
    v_lshlrev_b32 v209, 16, v66
    v_mfma_f32_16x16x32_bf16 v[36:39], a[64:67], a[100:103], v[36:39]
    ds_read_b64_tr_b16 a[2:3], v3 offset:128
    v_fmac_f32 v128, s44, v208
    v_mfma_f32_16x16x32_bf16 v[36:39], a[68:71], a[96:99], v[36:39]
    ds_read_b128 a[32:35], v4 offset:64
    v_mul_f32 v160, v128, v209
    v_mfma_f32_16x16x32_bf16 v[40:43], a[64:67], a[104:107], v[40:43]
    ds_read_b64_tr_b16 a[4:5], v3 offset:648
    v_add_f32 v129, v129, v145
    v_mfma_f32_16x16x32_bf16 v[40:43], a[68:71], a[100:103], v[40:43]
    buffer_load_dwordx4 v2, s[4:7], s18 offen offset:0 lds
    v_mfma_f32_16x16x32_bf16 v[40:43], a[72:75], a[96:99], v[40:43]
    s_waitcnt lgkmcnt(15)
    ds_read_b64_tr_b16 a[6:7], v3 offset:640
    v_and_b32 v210, 0xffff0000, v176
    v_mfma_f32_16x16x32_bf16 v[44:47], a[64:67], a[108:111], v[44:47]
    ds_read_b128 a[36:39], v4 offset:576
    v_lshlrev_b32 v211, 16, v70
    v_mfma_f32_16x16x32_bf16 v[44:47], a[68:71], a[104:107], v[44:47]
    ds_read_b64_tr_b16 a[8:9], v3 offset:1160
    v_fmac_f32 v129, s44, v210
    v_mfma_f32_16x16x32_bf16 v[44:47], a[72:75], a[100:103], v[44:47]
    ds_read_b64_tr_b16 a[10:11], v3 offset:1152
    v_mul_f32 v161, v129, v211
    v_mfma_f32_16x16x32_bf16 v[44:47], a[76:79], a[96:99], v[44:47]
    buffer_load_dwordx4 v2, s[4:7], s18 offen offset:1024 lds
    v_mfma_f32_16x16x32_bf16 v[48:51], a[64:67], a[112:115], v[48:51]
    ds_read_b128 a[40:43], v4 offset:1088
    v_add_f32 v130, v130, v146
    v_mfma_f32_16x16x32_bf16 v[48:51], a[68:71], a[108:111], v[48:51]
    ds_read_b64_tr_b16 a[12:13], v3 offset:1672
    v_lshlrev_b32 v208, 16, v177
    v_mfma_f32_16x16x32_bf16 v[48:51], a[72:75], a[104:107], v[48:51]
    ds_read_b64_tr_b16 a[14:15], v3 offset:1664
    v_lshlrev_b32 v209, 16, v74
    v_mfma_f32_16x16x32_bf16 v[48:51], a[76:79], a[100:103], v[48:51]
    ds_read_b128 a[44:47], v4 offset:1600
    v_fmac_f32 v130, s44, v208
    v_mfma_f32_16x16x32_bf16 v[48:51], a[80:83], a[96:99], v[48:51]
    s_waitcnt lgkmcnt(15)
    buffer_load_dwordx4 v2, s[4:7], s18 offen offset:2048 lds
    v_mfma_f32_16x16x32_bf16 v[52:55], a[64:67], a[116:119], v[52:55]
    ds_read_b64_tr_b16 a[16:17], v3 offset:2184
    v_mul_f32 v162, v130, v209
    v_mfma_f32_16x16x32_bf16 v[52:55], a[68:71], a[112:115], v[52:55]
    ds_read_b64_tr_b16 a[18:19], v3 offset:2176
    v_add_f32 v131, v131, v147
    v_mfma_f32_16x16x32_bf16 v[52:55], a[72:75], a[108:111], v[52:55]
    ds_read_b128 a[48:51], v4 offset:2112
    v_and_b32 v210, 0xffff0000, v177
    v_mfma_f32_16x16x32_bf16 v[52:55], a[76:79], a[104:107], v[52:55]
    ds_read_b64_tr_b16 a[20:21], v3 offset:2696
    v_lshlrev_b32 v211, 16, v78
    v_mfma_f32_16x16x32_bf16 v[52:55], a[80:83], a[100:103], v[52:55]
    buffer_load_dwordx4 v2, s[4:7], s18 offen offset:3072 lds
    v_mfma_f32_16x16x32_bf16 v[52:55], a[84:87], a[96:99], v[52:55]
    s_add_u32 m0, s21, 25408
    ds_read_b64_tr_b16 a[22:23], v3 offset:2688
    v_fmac_f32 v131, s44, v210
    v_mfma_f32_16x16x32_bf16 v[56:59], a[64:67], a[120:123], v[56:59]
    ds_read_b128 a[52:55], v4 offset:2624
    v_mul_f32 v163, v131, v211
    v_mfma_f32_16x16x32_bf16 v[56:59], a[68:71], a[116:119], v[56:59]
    ds_read_b64_tr_b16 a[24:25], v3 offset:3208
    v_add_f32 v132, v132, v148
    v_mfma_f32_16x16x32_bf16 v[56:59], a[72:75], a[112:115], v[56:59]
    ds_read_b64_tr_b16 a[26:27], v3 offset:3200
    v_lshlrev_b32 v208, 16, v178
    v_mfma_f32_16x16x32_bf16 v[56:59], a[76:79], a[108:111], v[56:59]
    buffer_load_dwordx4 v2, s[4:7], s19 offen offset:0 lds
    v_mfma_f32_16x16x32_bf16 v[56:59], a[80:83], a[104:107], v[56:59]
    ds_read_b128 a[56:59], v4 offset:3136
    v_lshlrev_b32 v209, 16, v82
    v_mfma_f32_16x16x32_bf16 v[56:59], a[84:87], a[100:103], v[56:59]
    ds_read_b64_tr_b16 a[28:29], v3 offset:3720
    v_fmac_f32 v132, s44, v208
    v_mfma_f32_16x16x32_bf16 v[56:59], a[88:91], a[96:99], v[56:59]
    ds_read_b64_tr_b16 a[30:31], v3 offset:3712
    v_mul_f32 v164, v132, v209
    v_mfma_f32_16x16x32_bf16 v[60:63], a[64:67], a[124:127], v[60:63]
    ds_read_b128 a[60:63], v4 offset:3648
    v_add_f32 v133, v133, v149
    v_mfma_f32_16x16x32_bf16 v[60:63], a[68:71], a[120:123], v[60:63]
    buffer_load_dwordx4 v2, s[4:7], s19 offen offset:1024 lds
    v_mfma_f32_16x16x32_bf16 v[60:63], a[72:75], a[116:119], v[60:63]
    buffer_load_dwordx4 v2, s[4:7], s19 offen offset:2048 lds
    v_mfma_f32_16x16x32_bf16 v[60:63], a[76:79], a[112:115], v[60:63]
    buffer_load_dwordx4 v2, s[4:7], s19 offen offset:3072 lds
    v_mfma_f32_16x16x32_bf16 v[60:63], a[80:83], a[108:111], v[60:63]
    s_add_u32 s20, s20, 4096
    v_and_b32 v210, 0xffff0000, v178
    v_lshlrev_b32 v211, 16, v86
    v_mfma_f32_16x16x32_bf16 v[60:63], a[84:87], a[104:107], v[60:63]
    s_add_u32 s18, s18, 4224
    v_fmac_f32 v133, s44, v210
    v_mul_f32 v165, v133, v211
    v_mfma_f32_16x16x32_bf16 v[60:63], a[88:91], a[100:103], v[60:63]
    s_add_u32 s19, s19, 4224
    v_add_f32 v134, v134, v150
    v_lshlrev_b32 v208, 16, v179
    v_mfma_f32_16x16x32_bf16 v[60:63], a[92:95], a[96:99], v[60:63]
    s_waitcnt lgkmcnt(15)
    v_lshlrev_b32 v209, 16, v90
    v_fmac_f32 v134, s44, v208
    v_mfma_f32_16x16x32_bf16 v[32:35], a[0:3], a[32:35], v[32:35]
    ds_read_b64_tr_b16 a[64:65], v3 offset:200
    v_mul_f32 v166, v134, v209
    v_mfma_f32_16x16x32_bf16 v[36:39], a[0:3], a[36:39], v[36:39]
    ds_read_b64_tr_b16 a[66:67], v3 offset:192
    v_add_f32 v135, v135, v151
    v_mfma_f32_16x16x32_bf16 v[36:39], a[4:7], a[32:35], v[36:39]
    ds_read_b128 a[96:99], v4 offset:0
    v_and_b32 v210, 0xffff0000, v179
    v_mfma_f32_16x16x32_bf16 v[40:43], a[0:3], a[40:43], v[40:43]
    ds_read_b64_tr_b16 a[68:69], v3 offset:712
    v_lshlrev_b32 v211, 16, v94
    v_mfma_f32_16x16x32_bf16 v[40:43], a[4:7], a[36:39], v[40:43]
    v_fmac_f32 v135, s44, v210
    v_mul_f32 v167, v135, v211
    v_mfma_f32_16x16x32_bf16 v[40:43], a[8:11], a[32:35], v[40:43]
    s_waitcnt lgkmcnt(15)
    ds_read_b64_tr_b16 a[70:71], v3 offset:704
    v_add_f32 v136, v136, v152
    v_mfma_f32_16x16x32_bf16 v[44:47], a[0:3], a[44:47], v[44:47]
    ds_read_b128 a[100:103], v4 offset:512
    v_lshlrev_b32 v208, 16, v180
    v_mfma_f32_16x16x32_bf16 v[44:47], a[4:7], a[40:43], v[44:47]
    ds_read_b64_tr_b16 a[72:73], v3 offset:1224
    v_lshlrev_b32 v209, 16, v98
    v_mfma_f32_16x16x32_bf16 v[44:47], a[8:11], a[36:39], v[44:47]
    ds_read_b64_tr_b16 a[74:75], v3 offset:1216
    v_fmac_f32 v136, s44, v208
    v_mfma_f32_16x16x32_bf16 v[44:47], a[12:15], a[32:35], v[44:47]
    s_waitcnt lgkmcnt(15)
    v_mul_f32 v168, v136, v209
    v_add_f32 v137, v137, v153
    v_mfma_f32_16x16x32_bf16 v[48:51], a[0:3], a[48:51], v[48:51]
    ds_read_b128 a[104:107], v4 offset:1024
    v_and_b32 v210, 0xffff0000, v180
    v_mfma_f32_16x16x32_bf16 v[48:51], a[4:7], a[44:47], v[48:51]
    ds_read_b64_tr_b16 a[76:77], v3 offset:1736
    v_lshlrev_b32 v211, 16, v102
    v_mfma_f32_16x16x32_bf16 v[48:51], a[8:11], a[40:43], v[48:51]
    ds_read_b64_tr_b16 a[78:79], v3 offset:1728
    v_fmac_f32 v137, s44, v210
    v_mfma_f32_16x16x32_bf16 v[48:51], a[12:15], a[36:39], v[48:51]
    ds_read_b128 a[108:111], v4 offset:1536
    v_mul_f32 v169, v137, v211
    v_mfma_f32_16x16x32_bf16 v[48:51], a[16:19], a[32:35], v[48:51]
    s_waitcnt lgkmcnt(15)
    v_add_f32 v138, v138, v154
    v_lshlrev_b32 v208, 16, v181
    v_mfma_f32_16x16x32_bf16 v[52:55], a[0:3], a[52:55], v[52:55]
    ds_read_b64_tr_b16 a[80:81], v3 offset:2248
    v_lshlrev_b32 v209, 16, v106
    v_mfma_f32_16x16x32_bf16 v[52:55], a[4:7], a[48:51], v[52:55]
    ds_read_b64_tr_b16 a[82:83], v3 offset:2240
    v_fmac_f32 v138, s44, v208
    v_mfma_f32_16x16x32_bf16 v[52:55], a[8:11], a[44:47], v[52:55]
    ds_read_b128 a[112:115], v4 offset:2048
    v_mul_f32 v170, v138, v209
    v_mfma_f32_16x16x32_bf16 v[52:55], a[12:15], a[40:43], v[52:55]
    ds_read_b64_tr_b16 a[84:85], v3 offset:2760
    v_add_f32 v139, v139, v155
    v_mfma_f32_16x16x32_bf16 v[52:55], a[16:19], a[36:39], v[52:55]
    v_and_b32 v210, 0xffff0000, v181
    v_lshlrev_b32 v211, 16, v110
    v_mfma_f32_16x16x32_bf16 v[52:55], a[20:23], a[32:35], v[52:55]
    ds_read_b64_tr_b16 a[86:87], v3 offset:2752
    v_fmac_f32 v139, s44, v210
    v_mfma_f32_16x16x32_bf16 v[56:59], a[0:3], a[56:59], v[56:59]
    ds_read_b128 a[116:119], v4 offset:2560
    v_mul_f32 v171, v139, v211
    v_mfma_f32_16x16x32_bf16 v[56:59], a[4:7], a[52:55], v[56:59]
    ds_read_b64_tr_b16 a[88:89], v3 offset:3272
    v_add_f32 v140, v140, v156
    v_mfma_f32_16x16x32_bf16 v[56:59], a[8:11], a[48:51], v[56:59]
    ds_read_b64_tr_b16 a[90:91], v3 offset:3264
    v_lshlrev_b32 v208, 16, v182
    v_mfma_f32_16x16x32_bf16 v[56:59], a[12:15], a[44:47], v[56:59]
    v_lshlrev_b32 v209, 16, v114
    v_fmac_f32 v140, s44, v208
    v_mfma_f32_16x16x32_bf16 v[56:59], a[16:19], a[40:43], v[56:59]
    ds_read_b128 a[120:123], v4 offset:3072
    v_mul_f32 v172, v140, v209
    v_mfma_f32_16x16x32_bf16 v[56:59], a[20:23], a[36:39], v[56:59]
    ds_read_b64_tr_b16 a[92:93], v3 offset:3784
    v_add_f32 v141, v141, v157
    v_mfma_f32_16x16x32_bf16 v[56:59], a[24:27], a[32:35], v[56:59]
    s_waitcnt lgkmcnt(15)
    ds_read_b64_tr_b16 a[94:95], v3 offset:3776
    v_and_b32 v210, 0xffff0000, v182
    v_mfma_f32_16x16x32_bf16 v[60:63], a[0:3], a[60:63], v[60:63]
    ds_read_b128 a[124:127], v4 offset:3584
    v_lshlrev_b32 v211, 16, v118
    v_mfma_f32_16x16x32_bf16 v[60:63], a[4:7], a[56:59], v[60:63]
    v_fmac_f32 v141, s44, v210
    v_mul_f32 v173, v141, v211
    v_mfma_f32_16x16x32_bf16 v[60:63], a[8:11], a[52:55], v[60:63]
    ds_read_b64 v[192:193], v7 offset:0
    v_add_f32 v142, v142, v158
    v_mfma_f32_16x16x32_bf16 v[60:63], a[12:15], a[48:51], v[60:63]
    ds_read_b64 v[194:195], v7 offset:512
    v_lshlrev_b32 v208, 16, v183
    v_mfma_f32_16x16x32_bf16 v[60:63], a[16:19], a[44:47], v[60:63]
    ds_read_b64 v[196:197], v7 offset:1024
    v_lshlrev_b32 v209, 16, v122
    v_mfma_f32_16x16x32_bf16 v[60:63], a[20:23], a[40:43], v[60:63]
    ds_read_b64 v[198:199], v7 offset:1536
    v_fmac_f32 v142, s44, v208
    v_mfma_f32_16x16x32_bf16 v[60:63], a[24:27], a[36:39], v[60:63]
    v_mul_f32 v174, v142, v209
    v_add_f32 v143, v143, v159
    v_mfma_f32_16x16x32_bf16 v[60:63], a[28:31], a[32:35], v[60:63]
    s_waitcnt vmcnt(0) lgkmcnt(0)
    s_barrier
    v_and_b32 v210, 0xffff0000, v183
    v_mfma_f32_16x16x32_bf16 v[32:35], a[64:67], a[96:99], v[32:35]
    ds_read_b64_tr_b16 a[0:1], v3 offset:21256
    v_lshlrev_b32 v211, 16, v126
    v_mfma_f32_16x16x32_bf16 v[36:39], a[64:67], a[100:103], v[36:39]
    ds_read_b64_tr_b16 a[2:3], v3 offset:21248
    v_fmac_f32 v143, s44, v210
    v_mfma_f32_16x16x32_bf16 v[36:39], a[68:71], a[96:99], v[36:39]
    ds_read_b128 a[32:35], v4 offset:21440
    v_mul_f32 v175, v143, v211
    v_mfma_f32_16x16x32_bf16 v[40:43], a[64:67], a[104:107], v[40:43]
    ds_read_b64_tr_b16 a[4:5], v3 offset:21768
    v_mfma_f32_16x16x32_bf16 v[40:43], a[68:71], a[100:103], v[40:43]
    ds_read_b64_tr_b16 a[6:7], v3 offset:21760
    v_mfma_f32_16x16x32_bf16 v[40:43], a[72:75], a[96:99], v[40:43]
    ds_read_b128 a[36:39], v4 offset:21952
    v_mfma_f32_16x16x32_bf16 v[44:47], a[64:67], a[108:111], v[44:47]
    ds_read_b64_tr_b16 a[8:9], v3 offset:22280
    v_mfma_f32_16x16x32_bf16 v[44:47], a[68:71], a[104:107], v[44:47]
    ds_read_b64_tr_b16 a[10:11], v3 offset:22272
    v_mfma_f32_16x16x32_bf16 v[44:47], a[72:75], a[100:103], v[44:47]
    ds_read_b128 a[40:43], v4 offset:22464
    ds_write_b128 v5, v[32:35] offset:0
    v_mfma_f32_16x16x32_bf16 v[44:47], a[76:79], a[96:99], v[44:47]
    ds_read_b64_tr_b16 a[12:13], v3 offset:22792
    v_mfma_f32_16x16x32_bf16 v[48:51], a[64:67], a[112:115], v[48:51]
    ds_read_b64_tr_b16 a[14:15], v3 offset:22784
    ds_write_b128 v5, v[36:39] offset:1024
    v_mfma_f32_16x16x32_bf16 v[48:51], a[68:71], a[108:111], v[48:51]
    ds_read_b128 a[44:47], v4 offset:22976
    v_mfma_f32_16x16x32_bf16 v[48:51], a[72:75], a[104:107], v[48:51]
    ds_read_b64_tr_b16 a[16:17], v3 offset:23304
    v_mfma_f32_16x16x32_bf16 v[48:51], a[76:79], a[100:103], v[48:51]
    ds_read_b64_tr_b16 a[18:19], v3 offset:23296
    ds_write_b128 v5, v[40:43] offset:2048
    v_mfma_f32_16x16x32_bf16 v[48:51], a[80:83], a[96:99], v[48:51]
    ds_read_b128 a[48:51], v4 offset:23488
    v_mfma_f32_16x16x32_bf16 v[52:55], a[64:67], a[116:119], v[52:55]
    ds_read_b64_tr_b16 a[20:21], v3 offset:23816
    v_mfma_f32_16x16x32_bf16 v[52:55], a[68:71], a[112:115], v[52:55]
    ds_read_b64_tr_b16 a[22:23], v3 offset:23808
    v_mfma_f32_16x16x32_bf16 v[52:55], a[72:75], a[108:111], v[52:55]
    ds_read_b128 a[52:55], v4 offset:24000
    ds_write_b128 v5, v[44:47] offset:3072
    v_mfma_f32_16x16x32_bf16 v[52:55], a[76:79], a[104:107], v[52:55]
    ds_read_b64_tr_b16 a[24:25], v3 offset:24328
    v_mfma_f32_16x16x32_bf16 v[52:55], a[80:83], a[100:103], v[52:55]
    ds_read_b64_tr_b16 a[26:27], v3 offset:24320
    v_mfma_f32_16x16x32_bf16 v[52:55], a[84:87], a[96:99], v[52:55]
    ds_read_b128 a[56:59], v4 offset:24512
    v_mfma_f32_16x16x32_bf16 v[56:59], a[64:67], a[120:123], v[56:59]
    ds_read_b64_tr_b16 a[28:29], v3 offset:24840
    v_mfma_f32_16x16x32_bf16 v[56:59], a[68:71], a[116:119], v[56:59]
    ds_read_b64_tr_b16 a[30:31], v3 offset:24832
    ds_write_b128 v5, v[48:51] offset:4096
    v_mfma_f32_16x16x32_bf16 v[56:59], a[72:75], a[112:115], v[56:59]
    ds_read_b128 a[60:63], v4 offset:25024
    v_mfma_f32_16x16x32_bf16 v[56:59], a[76:79], a[108:111], v[56:59]
    v_mfma_f32_16x16x32_bf16 v[56:59], a[80:83], a[104:107], v[56:59]
    v_mfma_f32_16x16x32_bf16 v[56:59], a[84:87], a[100:103], v[56:59]
    v_mfma_f32_16x16x32_bf16 v[56:59], a[88:91], a[96:99], v[56:59]
    v_mfma_f32_16x16x32_bf16 v[60:63], a[64:67], a[124:127], v[60:63]
    ds_write_b128 v5, v[52:55] offset:5120
    v_mfma_f32_16x16x32_bf16 v[60:63], a[68:71], a[120:123], v[60:63]
    v_mfma_f32_16x16x32_bf16 v[60:63], a[72:75], a[116:119], v[60:63]
    v_mfma_f32_16x16x32_bf16 v[60:63], a[76:79], a[112:115], v[60:63]
    v_mfma_f32_16x16x32_bf16 v[60:63], a[80:83], a[108:111], v[60:63]
    v_mfma_f32_16x16x32_bf16 v[60:63], a[84:87], a[104:107], v[60:63]
    v_mfma_f32_16x16x32_bf16 v[60:63], a[88:91], a[100:103], v[60:63]
    v_mfma_f32_16x16x32_bf16 v[60:63], a[92:95], a[96:99], v[60:63]
    s_waitcnt lgkmcnt(15)
    ds_write_b128 v5, v[56:59] offset:6144
    v_mfma_f32_16x16x32_bf16 v[32:35], a[0:3], a[32:35], 0
    ds_read_b64_tr_b16 a[64:65], v3 offset:21320
    v_mfma_f32_16x16x32_bf16 v[36:39], a[0:3], a[36:39], 0
    ds_read_b64_tr_b16 a[66:67], v3 offset:21312
    v_mfma_f32_16x16x32_bf16 v[36:39], a[4:7], a[32:35], v[36:39]
    ds_read_b128 a[96:99], v4 offset:21376
    v_mfma_f32_16x16x32_bf16 v[40:43], a[0:3], a[40:43], 0
    ds_read_b64_tr_b16 a[68:69], v3 offset:21832
    v_mfma_f32_16x16x32_bf16 v[40:43], a[4:7], a[36:39], v[40:43]
    ds_read_b128 v[128:131], v6 offset:32768
    v_mfma_f32_16x16x32_bf16 v[40:43], a[8:11], a[32:35], v[40:43]
    ds_read_b64_tr_b16 a[70:71], v3 offset:21824
    v_mfma_f32_16x16x32_bf16 v[44:47], a[0:3], a[44:47], 0
    ds_read_b128 a[100:103], v4 offset:21888
    v_mfma_f32_16x16x32_bf16 v[44:47], a[4:7], a[40:43], v[44:47]
    ds_write_b128 v5, v[60:63] offset:7168
    v_mfma_f32_16x16x32_bf16 v[44:47], a[8:11], a[36:39], v[44:47]
    ds_read_b64_tr_b16 a[72:73], v3 offset:22344
    v_mfma_f32_16x16x32_bf16 v[44:47], a[12:15], a[32:35], v[44:47]
    s_waitcnt lgkmcnt(15)
    ds_read_b64_tr_b16 a[74:75], v3 offset:22336
    v_mfma_f32_16x16x32_bf16 v[48:51], a[0:3], a[48:51], 0
    ds_read_b128 v[144:147], v6 offset:40960
    v_mfma_f32_16x16x32_bf16 v[48:51], a[4:7], a[44:47], v[48:51]
    ds_read_b128 a[104:107], v4 offset:22400
    v_mfma_f32_16x16x32_bf16 v[48:51], a[8:11], a[40:43], v[48:51]
    ds_read_b64_tr_b16 a[76:77], v3 offset:22856
    v_mfma_f32_16x16x32_bf16 v[48:51], a[12:15], a[36:39], v[48:51]
    ds_read_b64_tr_b16 a[78:79], v3 offset:22848
    v_mfma_f32_16x16x32_bf16 v[48:51], a[16:19], a[32:35], v[48:51]
    ds_read_b128 a[108:111], v4 offset:22912
    v_mfma_f32_16x16x32_bf16 v[52:55], a[0:3], a[52:55], 0
    ds_read_b128 v[132:135], v6 offset:33792
    v_mfma_f32_16x16x32_bf16 v[52:55], a[4:7], a[48:51], v[52:55]
    ds_read_b64_tr_b16 a[80:81], v3 offset:23368
    v_mfma_f32_16x16x32_bf16 v[52:55], a[8:11], a[44:47], v[52:55]
    ds_read_b64_tr_b16 a[82:83], v3 offset:23360
    v_mfma_f32_16x16x32_bf16 v[52:55], a[12:15], a[40:43], v[52:55]
    ds_read_b128 a[112:115], v4 offset:23424
    v_mfma_f32_16x16x32_bf16 v[52:55], a[16:19], a[36:39], v[52:55]
    ds_read_b64_tr_b16 a[84:85], v3 offset:23880
    v_mfma_f32_16x16x32_bf16 v[52:55], a[20:23], a[32:35], v[52:55]
    ds_read_b128 v[148:151], v6 offset:41984
    v_mfma_f32_16x16x32_bf16 v[56:59], a[0:3], a[56:59], 0
    ds_read_b64_tr_b16 a[86:87], v3 offset:23872
    v_mfma_f32_16x16x32_bf16 v[56:59], a[4:7], a[52:55], v[56:59]
    ds_read_b128 a[116:119], v4 offset:23936
    v_mfma_f32_16x16x32_bf16 v[56:59], a[8:11], a[48:51], v[56:59]
    ds_read_b64_tr_b16 a[88:89], v3 offset:24392
    v_mfma_f32_16x16x32_bf16 v[56:59], a[12:15], a[44:47], v[56:59]
    ds_read_b64_tr_b16 a[90:91], v3 offset:24384
    v_mfma_f32_16x16x32_bf16 v[56:59], a[16:19], a[40:43], v[56:59]
    ds_read_b128 v[136:139], v6 offset:34816
    v_mfma_f32_16x16x32_bf16 v[56:59], a[20:23], a[36:39], v[56:59]
    ds_read_b128 a[120:123], v4 offset:24448
    v_mfma_f32_16x16x32_bf16 v[56:59], a[24:27], a[32:35], v[56:59]
    s_waitcnt lgkmcnt(15)
    ds_read_b64_tr_b16 a[92:93], v3 offset:24904
    v_mfma_f32_16x16x32_bf16 v[60:63], a[0:3], a[60:63], 0
    ds_read_b64_tr_b16 a[94:95], v3 offset:24896
    v_mfma_f32_16x16x32_bf16 v[60:63], a[4:7], a[56:59], v[60:63]
    ds_read_b128 a[124:127], v4 offset:24960
    v_mfma_f32_16x16x32_bf16 v[60:63], a[8:11], a[52:55], v[60:63]
    ds_read_b128 v[152:155], v6 offset:43008
    v_mfma_f32_16x16x32_bf16 v[60:63], a[12:15], a[48:51], v[60:63]
    ds_read_b128 v[140:143], v6 offset:35840
    v_mfma_f32_16x16x32_bf16 v[60:63], a[16:19], a[44:47], v[60:63]
    ds_read_b128 v[156:159], v6 offset:44032
    v_mfma_f32_16x16x32_bf16 v[60:63], a[20:23], a[40:43], v[60:63]
    v_add_f32 v128, v128, v144
    v_lshlrev_b32 v208, 16, v184
    v_mfma_f32_16x16x32_bf16 v[60:63], a[24:27], a[36:39], v[60:63]
    v_and_b32 v209, 0xffff0000, v66
    v_fmac_f32 v128, s45, v208
    v_mfma_f32_16x16x32_bf16 v[60:63], a[28:31], a[32:35], v[60:63]
    v_mul_f32 v128, v128, v209
    v_cvt_pk_bf16_f32 v66, v160, v128
    v_mfma_f32_16x16x32_bf16 v[32:35], a[64:67], a[96:99], v[32:35]
    ds_read_b64_tr_b16 a[0:1], v3 offset:21384
    v_add_f32 v129, v129, v145
    v_mfma_f32_16x16x32_bf16 v[36:39], a[64:67], a[100:103], v[36:39]
    ds_read_b64_tr_b16 a[2:3], v3 offset:21376
    v_and_b32 v210, 0xffff0000, v184
    v_mfma_f32_16x16x32_bf16 v[36:39], a[68:71], a[96:99], v[36:39]
    ds_read_b128 a[32:35], v4 offset:21312
    v_and_b32 v211, 0xffff0000, v70
    v_mfma_f32_16x16x32_bf16 v[40:43], a[64:67], a[104:107], v[40:43]
    ds_read_b64_tr_b16 a[4:5], v3 offset:21896
    v_fmac_f32 v129, s45, v210
    v_mfma_f32_16x16x32_bf16 v[40:43], a[68:71], a[100:103], v[40:43]
    v_mul_f32 v129, v129, v211
    v_cvt_pk_bf16_f32 v70, v161, v129
    v_mfma_f32_16x16x32_bf16 v[40:43], a[72:75], a[96:99], v[40:43]
    s_waitcnt lgkmcnt(15)
    ds_read_b64_tr_b16 a[6:7], v3 offset:21888
    v_add_f32 v130, v130, v146
    v_mfma_f32_16x16x32_bf16 v[44:47], a[64:67], a[108:111], v[44:47]
    ds_read_b128 a[36:39], v4 offset:21824
    v_lshlrev_b32 v208, 16, v185
    v_mfma_f32_16x16x32_bf16 v[44:47], a[68:71], a[104:107], v[44:47]
    ds_read_b64_tr_b16 a[8:9], v3 offset:22408
    v_and_b32 v209, 0xffff0000, v74
    v_mfma_f32_16x16x32_bf16 v[44:47], a[72:75], a[100:103], v[44:47]
    ds_read_b64_tr_b16 a[10:11], v3 offset:22400
    v_fmac_f32 v130, s45, v208
    v_mfma_f32_16x16x32_bf16 v[44:47], a[76:79], a[96:99], v[44:47]
    v_mul_f32 v130, v130, v209
    v_cvt_pk_bf16_f32 v74, v162, v130
    v_mfma_f32_16x16x32_bf16 v[48:51], a[64:67], a[112:115], v[48:51]
    ds_read_b128 a[40:43], v4 offset:22336
    v_add_f32 v131, v131, v147
    v_mfma_f32_16x16x32_bf16 v[48:51], a[68:71], a[108:111], v[48:51]
    ds_read_b64_tr_b16 a[12:13], v3 offset:22920
    v_and_b32 v210, 0xffff0000, v185
    v_mfma_f32_16x16x32_bf16 v[48:51], a[72:75], a[104:107], v[48:51]
    ds_read_b64_tr_b16 a[14:15], v3 offset:22912
    v_and_b32 v211, 0xffff0000, v78
    v_mfma_f32_16x16x32_bf16 v[48:51], a[76:79], a[100:103], v[48:51]
    ds_read_b128 a[44:47], v4 offset:22848
    v_fmac_f32 v131, s45, v210
    v_mfma_f32_16x16x32_bf16 v[48:51], a[80:83], a[96:99], v[48:51]
    s_waitcnt lgkmcnt(15)
    v_mul_f32 v131, v131, v211
    v_cvt_pk_bf16_f32 v78, v163, v131
    v_mfma_f32_16x16x32_bf16 v[52:55], a[64:67], a[116:119], v[52:55]
    ds_read_b64_tr_b16 a[16:17], v3 offset:23432
    v_add_f32 v132, v132, v148
    v_mfma_f32_16x16x32_bf16 v[52:55], a[68:71], a[112:115], v[52:55]
    ds_read_b64_tr_b16 a[18:19], v3 offset:23424
    v_lshlrev_b32 v208, 16, v186
    v_mfma_f32_16x16x32_bf16 v[52:55], a[72:75], a[108:111], v[52:55]
    ds_read_b128 a[48:51], v4 offset:23360
    v_and_b32 v209, 0xffff0000, v82
    v_mfma_f32_16x16x32_bf16 v[52:55], a[76:79], a[104:107], v[52:55]
    ds_read_b64_tr_b16 a[20:21], v3 offset:23944
    v_fmac_f32 v132, s45, v208
    v_mfma_f32_16x16x32_bf16 v[52:55], a[80:83], a[100:103], v[52:55]
    v_mul_f32 v132, v132, v209
    v_cvt_pk_bf16_f32 v82, v164, v132
    v_mfma_f32_16x16x32_bf16 v[52:55], a[84:87], a[96:99], v[52:55]
    ds_read_b64_tr_b16 a[22:23], v3 offset:23936
    v_add_f32 v133, v133, v149
    v_mfma_f32_16x16x32_bf16 v[56:59], a[64:67], a[120:123], v[56:59]
    ds_read_b128 a[52:55], v4 offset:23872
    v_and_b32 v210, 0xffff0000, v186
    v_mfma_f32_16x16x32_bf16 v[56:59], a[68:71], a[116:119], v[56:59]
    ds_read_b64_tr_b16 a[24:25], v3 offset:24456
    v_and_b32 v211, 0xffff0000, v86
    v_mfma_f32_16x16x32_bf16 v[56:59], a[72:75], a[112:115], v[56:59]
    ds_read_b64_tr_b16 a[26:27], v3 offset:24448
    v_fmac_f32 v133, s45, v210
    v_mfma_f32_16x16x32_bf16 v[56:59], a[76:79], a[108:111], v[56:59]
    v_mul_f32 v133, v133, v211
    v_cvt_pk_bf16_f32 v86, v165, v133
    v_mfma_f32_16x16x32_bf16 v[56:59], a[80:83], a[104:107], v[56:59]
    ds_read_b128 a[56:59], v4 offset:24384
    v_add_f32 v134, v134, v150
    v_mfma_f32_16x16x32_bf16 v[56:59], a[84:87], a[100:103], v[56:59]
    ds_read_b64_tr_b16 a[28:29], v3 offset:24968
    v_lshlrev_b32 v208, 16, v187
    v_mfma_f32_16x16x32_bf16 v[56:59], a[88:91], a[96:99], v[56:59]
    ds_read_b64_tr_b16 a[30:31], v3 offset:24960
    v_and_b32 v209, 0xffff0000, v90
    v_mfma_f32_16x16x32_bf16 v[60:63], a[64:67], a[124:127], v[60:63]
    ds_read_b128 a[60:63], v4 offset:24896
    v_fmac_f32 v134, s45, v208
    v_mfma_f32_16x16x32_bf16 v[60:63], a[68:71], a[120:123], v[60:63]
    v_mul_f32 v134, v134, v209
    v_cvt_pk_bf16_f32 v90, v166, v134
    v_mfma_f32_16x16x32_bf16 v[60:63], a[72:75], a[116:119], v[60:63]
    v_add_f32 v135, v135, v151
    v_and_b32 v210, 0xffff0000, v187
    v_mfma_f32_16x16x32_bf16 v[60:63], a[76:79], a[112:115], v[60:63]
    v_and_b32 v211, 0xffff0000, v94
    v_fmac_f32 v135, s45, v210
    v_mfma_f32_16x16x32_bf16 v[60:63], a[80:83], a[108:111], v[60:63]
    v_mul_f32 v135, v135, v211
    v_cvt_pk_bf16_f32 v94, v167, v135
    v_mfma_f32_16x16x32_bf16 v[60:63], a[84:87], a[104:107], v[60:63]
    s_waitcnt lgkmcnt(15)
    v_add_f32 v136, v136, v152
    v_lshlrev_b32 v208, 16, v188
    v_mfma_f32_16x16x32_bf16 v[60:63], a[88:91], a[100:103], v[60:63]
    v_and_b32 v209, 0xffff0000, v98
    v_fmac_f32 v136, s45, v208
    v_mfma_f32_16x16x32_bf16 v[60:63], a[92:95], a[96:99], v[60:63]
    v_mul_f32 v136, v136, v209
    v_cvt_pk_bf16_f32 v98, v168, v136
    v_mfma_f32_16x16x32_bf16 v[32:35], a[0:3], a[32:35], v[32:35]
    ds_read_b64_tr_b16 a[64:65], v3 offset:21448
    v_add_f32 v137, v137, v153
    v_mfma_f32_16x16x32_bf16 v[36:39], a[0:3], a[36:39], v[36:39]
    ds_read_b64_tr_b16 a[66:67], v3 offset:21440
    v_and_b32 v210, 0xffff0000, v188
    v_mfma_f32_16x16x32_bf16 v[36:39], a[4:7], a[32:35], v[36:39]
    ds_read_b128 a[96:99], v4 offset:21248
    v_and_b32 v211, 0xffff0000, v102
    v_mfma_f32_16x16x32_bf16 v[40:43], a[0:3], a[40:43], v[40:43]
    ds_read_b64_tr_b16 a[68:69], v3 offset:21960
    v_fmac_f32 v137, s45, v210
    v_mfma_f32_16x16x32_bf16 v[40:43], a[4:7], a[36:39], v[40:43]
    v_mul_f32 v137, v137, v211
    v_cvt_pk_bf16_f32 v102, v169, v137
    v_mfma_f32_16x16x32_bf16 v[40:43], a[8:11], a[32:35], v[40:43]
    s_waitcnt lgkmcnt(15)
    ds_read_b64_tr_b16 a[70:71], v3 offset:21952
    v_add_f32 v138, v138, v154
    v_mfma_f32_16x16x32_bf16 v[44:47], a[0:3], a[44:47], v[44:47]
    ds_read_b128 a[100:103], v4 offset:21760
    v_lshlrev_b32 v208, 16, v189
    v_mfma_f32_16x16x32_bf16 v[44:47], a[4:7], a[40:43], v[44:47]
    ds_read_b64_tr_b16 a[72:73], v3 offset:22472
    v_and_b32 v209, 0xffff0000, v106
    v_mfma_f32_16x16x32_bf16 v[44:47], a[8:11], a[36:39], v[44:47]
    ds_read_b64_tr_b16 a[74:75], v3 offset:22464
    v_fmac_f32 v138, s45, v208
    v_mfma_f32_16x16x32_bf16 v[44:47], a[12:15], a[32:35], v[44:47]
    s_waitcnt lgkmcnt(15)
    v_mul_f32 v138, v138, v209
    v_cvt_pk_bf16_f32 v106, v170, v138
    v_mfma_f32_16x16x32_bf16 v[48:51], a[0:3], a[48:51], v[48:51]
    ds_read_b128 a[104:107], v4 offset:22272
    v_add_f32 v139, v139, v155
    v_mfma_f32_16x16x32_bf16 v[48:51], a[4:7], a[44:47], v[48:51]
    ds_read_b64_tr_b16 a[76:77], v3 offset:22984
    v_and_b32 v210, 0xffff0000, v189
    v_mfma_f32_16x16x32_bf16 v[48:51], a[8:11], a[40:43], v[48:51]
    ds_read_b64_tr_b16 a[78:79], v3 offset:22976
    v_and_b32 v211, 0xffff0000, v110
    v_mfma_f32_16x16x32_bf16 v[48:51], a[12:15], a[36:39], v[48:51]
    ds_read_b128 a[108:111], v4 offset:22784
    v_fmac_f32 v139, s45, v210
    v_mfma_f32_16x16x32_bf16 v[48:51], a[16:19], a[32:35], v[48:51]
    s_waitcnt lgkmcnt(15)
    v_mul_f32 v139, v139, v211
    v_cvt_pk_bf16_f32 v110, v171, v139
    v_mfma_f32_16x16x32_bf16 v[52:55], a[0:3], a[52:55], v[52:55]
    ds_read_b64_tr_b16 a[80:81], v3 offset:23496
    v_add_f32 v140, v140, v156
    v_mfma_f32_16x16x32_bf16 v[52:55], a[4:7], a[48:51], v[52:55]
    ds_read_b64_tr_b16 a[82:83], v3 offset:23488
    v_lshlrev_b32 v208, 16, v190
    v_mfma_f32_16x16x32_bf16 v[52:55], a[8:11], a[44:47], v[52:55]
    ds_read_b128 a[112:115], v4 offset:23296
    v_and_b32 v209, 0xffff0000, v114
    v_mfma_f32_16x16x32_bf16 v[52:55], a[12:15], a[40:43], v[52:55]
    ds_read_b64_tr_b16 a[84:85], v3 offset:24008
    v_fmac_f32 v140, s45, v208
    v_mfma_f32_16x16x32_bf16 v[52:55], a[16:19], a[36:39], v[52:55]
    v_mul_f32 v140, v140, v209
    v_cvt_pk_bf16_f32 v114, v172, v140
    v_mfma_f32_16x16x32_bf16 v[52:55], a[20:23], a[32:35], v[52:55]
    ds_read_b64_tr_b16 a[86:87], v3 offset:24000
    v_add_f32 v141, v141, v157
    v_mfma_f32_16x16x32_bf16 v[56:59], a[0:3], a[56:59], v[56:59]
    ds_read_b128 a[116:119], v4 offset:23808
    v_and_b32 v210, 0xffff0000, v190
    v_mfma_f32_16x16x32_bf16 v[56:59], a[4:7], a[52:55], v[56:59]
    ds_read_b64_tr_b16 a[88:89], v3 offset:24520
    v_and_b32 v211, 0xffff0000, v118
    v_mfma_f32_16x16x32_bf16 v[56:59], a[8:11], a[48:51], v[56:59]
    ds_read_b64_tr_b16 a[90:91], v3 offset:24512
    v_fmac_f32 v141, s45, v210
    v_mfma_f32_16x16x32_bf16 v[56:59], a[12:15], a[44:47], v[56:59]
    v_mul_f32 v141, v141, v211
    v_cvt_pk_bf16_f32 v118, v173, v141
    v_mfma_f32_16x16x32_bf16 v[56:59], a[16:19], a[40:43], v[56:59]
    ds_read_b128 a[120:123], v4 offset:24320
    v_add_f32 v142, v142, v158
    v_mfma_f32_16x16x32_bf16 v[56:59], a[20:23], a[36:39], v[56:59]
    ds_read_b64_tr_b16 a[92:93], v3 offset:25032
    v_lshlrev_b32 v208, 16, v191
    v_mfma_f32_16x16x32_bf16 v[56:59], a[24:27], a[32:35], v[56:59]
    s_waitcnt lgkmcnt(15)
    ds_read_b64_tr_b16 a[94:95], v3 offset:25024
    v_and_b32 v209, 0xffff0000, v122
    v_mfma_f32_16x16x32_bf16 v[60:63], a[0:3], a[60:63], v[60:63]
    ds_read_b128 a[124:127], v4 offset:24832
    v_fmac_f32 v142, s45, v208
    v_mfma_f32_16x16x32_bf16 v[60:63], a[4:7], a[56:59], v[60:63]
    v_mul_f32 v142, v142, v209
    v_cvt_pk_bf16_f32 v122, v174, v142
    v_mfma_f32_16x16x32_bf16 v[60:63], a[8:11], a[52:55], v[60:63]
    ds_read_b64 v[200:201], v7 offset:21248
    v_add_f32 v143, v143, v159
    v_mfma_f32_16x16x32_bf16 v[60:63], a[12:15], a[48:51], v[60:63]
    ds_read_b64 v[202:203], v7 offset:21760
    v_and_b32 v210, 0xffff0000, v191
    v_mfma_f32_16x16x32_bf16 v[60:63], a[16:19], a[44:47], v[60:63]
    ds_read_b64 v[204:205], v7 offset:22272
    v_and_b32 v211, 0xffff0000, v126
    v_mfma_f32_16x16x32_bf16 v[60:63], a[20:23], a[40:43], v[60:63]
    ds_read_b64 v[206:207], v7 offset:22784
    v_fmac_f32 v143, s45, v210
    v_mfma_f32_16x16x32_bf16 v[60:63], a[24:27], a[36:39], v[60:63]
    v_mul_f32 v143, v143, v211
    v_cvt_pk_bf16_f32 v126, v175, v143
    v_mfma_f32_16x16x32_bf16 v[60:63], a[28:31], a[32:35], v[60:63]
    s_waitcnt vmcnt(0) lgkmcnt(0)
    s_barrier
    v_mfma_f32_16x16x32_bf16 v[32:35], a[64:67], a[96:99], v[32:35]
    v_mfma_f32_16x16x32_bf16 v[36:39], a[64:67], a[100:103], v[36:39]
    v_mfma_f32_16x16x32_bf16 v[36:39], a[68:71], a[96:99], v[36:39]
    v_mfma_f32_16x16x32_bf16 v[40:43], a[64:67], a[104:107], v[40:43]
    v_mfma_f32_16x16x32_bf16 v[40:43], a[68:71], a[100:103], v[40:43]
    v_mfma_f32_16x16x32_bf16 v[40:43], a[72:75], a[96:99], v[40:43]
    v_mfma_f32_16x16x32_bf16 v[44:47], a[64:67], a[108:111], v[44:47]
    v_mfma_f32_16x16x32_bf16 v[44:47], a[68:71], a[104:107], v[44:47]
    v_mfma_f32_16x16x32_bf16 v[44:47], a[72:75], a[100:103], v[44:47]
    ds_write_b128 v5, v[32:35] offset:32768
    v_mfma_f32_16x16x32_bf16 v[44:47], a[76:79], a[96:99], v[44:47]
    v_mfma_f32_16x16x32_bf16 v[48:51], a[64:67], a[112:115], v[48:51]
    ds_write_b128 v5, v[36:39] offset:33792
    v_mfma_f32_16x16x32_bf16 v[48:51], a[68:71], a[108:111], v[48:51]
    v_mfma_f32_16x16x32_bf16 v[48:51], a[72:75], a[104:107], v[48:51]
    v_mfma_f32_16x16x32_bf16 v[48:51], a[76:79], a[100:103], v[48:51]
    ds_write_b128 v5, v[40:43] offset:34816
    v_mfma_f32_16x16x32_bf16 v[48:51], a[80:83], a[96:99], v[48:51]
    v_mfma_f32_16x16x32_bf16 v[52:55], a[64:67], a[116:119], v[52:55]
    v_mfma_f32_16x16x32_bf16 v[52:55], a[68:71], a[112:115], v[52:55]
    v_mfma_f32_16x16x32_bf16 v[52:55], a[72:75], a[108:111], v[52:55]
    ds_write_b128 v5, v[44:47] offset:35840
    v_mfma_f32_16x16x32_bf16 v[52:55], a[76:79], a[104:107], v[52:55]
    v_mfma_f32_16x16x32_bf16 v[52:55], a[80:83], a[100:103], v[52:55]
    v_mfma_f32_16x16x32_bf16 v[52:55], a[84:87], a[96:99], v[52:55]
    v_mfma_f32_16x16x32_bf16 v[56:59], a[64:67], a[120:123], v[56:59]
    v_mfma_f32_16x16x32_bf16 v[56:59], a[68:71], a[116:119], v[56:59]
    ds_write_b128 v5, v[48:51] offset:36864
    v_mfma_f32_16x16x32_bf16 v[56:59], a[72:75], a[112:115], v[56:59]
    v_mfma_f32_16x16x32_bf16 v[56:59], a[76:79], a[108:111], v[56:59]
    v_mfma_f32_16x16x32_bf16 v[56:59], a[80:83], a[104:107], v[56:59]
    v_mfma_f32_16x16x32_bf16 v[56:59], a[84:87], a[100:103], v[56:59]
    v_mfma_f32_16x16x32_bf16 v[56:59], a[88:91], a[96:99], v[56:59]
    v_mfma_f32_16x16x32_bf16 v[60:63], a[64:67], a[124:127], v[60:63]
    ds_write_b128 v5, v[52:55] offset:37888
    v_mfma_f32_16x16x32_bf16 v[60:63], a[68:71], a[120:123], v[60:63]
    v_mfma_f32_16x16x32_bf16 v[60:63], a[72:75], a[116:119], v[60:63]
    v_mfma_f32_16x16x32_bf16 v[60:63], a[76:79], a[112:115], v[60:63]
    v_mfma_f32_16x16x32_bf16 v[60:63], a[80:83], a[108:111], v[60:63]
    v_mfma_f32_16x16x32_bf16 v[60:63], a[84:87], a[104:107], v[60:63]
    v_mfma_f32_16x16x32_bf16 v[60:63], a[88:91], a[100:103], v[60:63]
    v_mfma_f32_16x16x32_bf16 v[60:63], a[92:95], a[96:99], v[60:63]
    ds_write_b128 v5, v[56:59] offset:38912
    ds_read_b128 v[128:131], v6 offset:0
    ds_read_b128 v[144:147], v6 offset:8192
    ds_read_b128 v[132:135], v6 offset:1024
    ds_read_b128 v[148:151], v6 offset:9216
    ds_read_b128 v[136:139], v6 offset:2048
    ds_read_b128 v[152:155], v6 offset:10240
    ds_read_b128 v[140:143], v6 offset:3072
    ds_read_b128 v[156:159], v6 offset:11264
    ds_write_b128 v5, v[60:63] offset:39936
    s_waitcnt lgkmcnt(1)
    v_add_f32 v128, v128, v144
    v_lshlrev_b32 v208, 16, v192
    v_lshlrev_b32 v209, 16, v67
    v_fmac_f32 v128, s46, v208
    v_mul_f32 v160, v128, v209
    v_add_f32 v129, v129, v145
    v_and_b32 v210, 0xffff0000, v192
    v_lshlrev_b32 v211, 16, v71
    v_fmac_f32 v129, s46, v210
    v_mul_f32 v161, v129, v211
    v_add_f32 v130, v130, v146
    v_lshlrev_b32 v208, 16, v193
    v_lshlrev_b32 v209, 16, v75
    v_fmac_f32 v130, s46, v208
    v_mul_f32 v162, v130, v209
    v_add_f32 v131, v131, v147
    v_and_b32 v210, 0xffff0000, v193
    v_lshlrev_b32 v211, 16, v79
    v_fmac_f32 v131, s46, v210
    v_mul_f32 v163, v131, v211
    v_add_f32 v132, v132, v148
    v_lshlrev_b32 v208, 16, v194
    v_lshlrev_b32 v209, 16, v83
    v_fmac_f32 v132, s46, v208
    v_mul_f32 v164, v132, v209
    v_add_f32 v133, v133, v149
    v_and_b32 v210, 0xffff0000, v194
    v_lshlrev_b32 v211, 16, v87
    v_fmac_f32 v133, s46, v210
    v_mul_f32 v165, v133, v211
    v_add_f32 v134, v134, v150
    v_lshlrev_b32 v208, 16, v195
    v_lshlrev_b32 v209, 16, v91
    v_fmac_f32 v134, s46, v208
    v_mul_f32 v166, v134, v209
    v_add_f32 v135, v135, v151
    v_and_b32 v210, 0xffff0000, v195
    v_lshlrev_b32 v211, 16, v95
    v_fmac_f32 v135, s46, v210
    v_mul_f32 v167, v135, v211
    v_add_f32 v136, v136, v152
    v_lshlrev_b32 v208, 16, v196
    v_lshlrev_b32 v209, 16, v99
    v_fmac_f32 v136, s46, v208
    v_mul_f32 v168, v136, v209
    v_add_f32 v137, v137, v153
    v_and_b32 v210, 0xffff0000, v196
    v_lshlrev_b32 v211, 16, v103
    v_fmac_f32 v137, s46, v210
    v_mul_f32 v169, v137, v211
    v_add_f32 v138, v138, v154
    v_lshlrev_b32 v208, 16, v197
    v_lshlrev_b32 v209, 16, v107
    v_fmac_f32 v138, s46, v208
    v_mul_f32 v170, v138, v209
    v_add_f32 v139, v139, v155
    v_and_b32 v210, 0xffff0000, v197
    v_lshlrev_b32 v211, 16, v111
    v_fmac_f32 v139, s46, v210
    v_mul_f32 v171, v139, v211
    v_add_f32 v140, v140, v156
    v_lshlrev_b32 v208, 16, v198
    v_lshlrev_b32 v209, 16, v115
    v_fmac_f32 v140, s46, v208
    v_mul_f32 v172, v140, v209
    v_add_f32 v141, v141, v157
    v_and_b32 v210, 0xffff0000, v198
    v_lshlrev_b32 v211, 16, v119
    v_fmac_f32 v141, s46, v210
    v_mul_f32 v173, v141, v211
    v_add_f32 v142, v142, v158
    v_lshlrev_b32 v208, 16, v199
    v_lshlrev_b32 v209, 16, v123
    v_fmac_f32 v142, s46, v208
    v_mul_f32 v174, v142, v209
    v_add_f32 v143, v143, v159
    v_and_b32 v210, 0xffff0000, v199
    v_lshlrev_b32 v211, 16, v127
    v_fmac_f32 v143, s46, v210
    v_mul_f32 v175, v143, v211
    s_waitcnt lgkmcnt(0)
    s_barrier
    ds_read_b128 v[128:131], v6 offset:32768
    ds_read_b128 v[144:147], v6 offset:40960
    ds_read_b128 v[132:135], v6 offset:33792
    ds_read_b128 v[148:151], v6 offset:41984
    ds_read_b128 v[136:139], v6 offset:34816
    ds_read_b128 v[152:155], v6 offset:43008
    ds_read_b128 v[140:143], v6 offset:35840
    ds_read_b128 v[156:159], v6 offset:44032
    s_waitcnt lgkmcnt(0)
    v_add_f32 v128, v128, v144
    v_lshlrev_b32 v208, 16, v200
    v_and_b32 v209, 0xffff0000, v67
    v_fmac_f32 v128, s47, v208
    v_mul_f32 v128, v128, v209
    v_cvt_pk_bf16_f32 v67, v160, v128
    v_add_f32 v129, v129, v145
    v_and_b32 v210, 0xffff0000, v200
    v_and_b32 v211, 0xffff0000, v71
    v_fmac_f32 v129, s47, v210
    v_mul_f32 v129, v129, v211
    v_cvt_pk_bf16_f32 v71, v161, v129
    v_add_f32 v130, v130, v146
    v_lshlrev_b32 v208, 16, v201
    v_and_b32 v209, 0xffff0000, v75
    v_fmac_f32 v130, s47, v208
    v_mul_f32 v130, v130, v209
    v_cvt_pk_bf16_f32 v75, v162, v130
    v_add_f32 v131, v131, v147
    v_and_b32 v210, 0xffff0000, v201
    v_and_b32 v211, 0xffff0000, v79
    v_fmac_f32 v131, s47, v210
    v_mul_f32 v131, v131, v211
    v_cvt_pk_bf16_f32 v79, v163, v131
    s_add_u32 s52, s48, 0
    buffer_store_dwordx4 v[64:67], v8, s[12:15], s52 offen offset:0
    buffer_store_dwordx4 v[68:71], v8, s[12:15], s52 offen offset:1792
    s_add_u32 s52, s48, 3584
    buffer_store_dwordx4 v[72:75], v8, s[12:15], s52 offen offset:0
    buffer_store_dwordx4 v[76:79], v8, s[12:15], s52 offen offset:1792
    v_add_f32 v132, v132, v148
    v_lshlrev_b32 v208, 16, v202
    v_and_b32 v209, 0xffff0000, v83
    v_fmac_f32 v132, s47, v208
    v_mul_f32 v132, v132, v209
    v_cvt_pk_bf16_f32 v83, v164, v132
    v_add_f32 v133, v133, v149
    v_and_b32 v210, 0xffff0000, v202
    v_and_b32 v211, 0xffff0000, v87
    v_fmac_f32 v133, s47, v210
    v_mul_f32 v133, v133, v211
    v_cvt_pk_bf16_f32 v87, v165, v133
    v_add_f32 v134, v134, v150
    v_lshlrev_b32 v208, 16, v203
    v_and_b32 v209, 0xffff0000, v91
    v_fmac_f32 v134, s47, v208
    v_mul_f32 v134, v134, v209
    v_cvt_pk_bf16_f32 v91, v166, v134
    v_add_f32 v135, v135, v151
    v_and_b32 v210, 0xffff0000, v203
    v_and_b32 v211, 0xffff0000, v95
    v_fmac_f32 v135, s47, v210
    v_mul_f32 v135, v135, v211
    v_cvt_pk_bf16_f32 v95, v167, v135
    s_add_u32 s52, s48, 458752
    buffer_store_dwordx4 v[80:83], v8, s[12:15], s52 offen offset:0
    buffer_store_dwordx4 v[84:87], v8, s[12:15], s52 offen offset:1792
    s_add_u32 s52, s48, 462336
    buffer_store_dwordx4 v[88:91], v8, s[12:15], s52 offen offset:0
    buffer_store_dwordx4 v[92:95], v8, s[12:15], s52 offen offset:1792
    v_add_f32 v136, v136, v152
    v_lshlrev_b32 v208, 16, v204
    v_and_b32 v209, 0xffff0000, v99
    v_fmac_f32 v136, s47, v208
    v_mul_f32 v136, v136, v209
    v_cvt_pk_bf16_f32 v99, v168, v136
    v_add_f32 v137, v137, v153
    v_and_b32 v210, 0xffff0000, v204
    v_and_b32 v211, 0xffff0000, v103
    v_fmac_f32 v137, s47, v210
    v_mul_f32 v137, v137, v211
    v_cvt_pk_bf16_f32 v103, v169, v137
    v_add_f32 v138, v138, v154
    v_lshlrev_b32 v208, 16, v205
    v_and_b32 v209, 0xffff0000, v107
    v_fmac_f32 v138, s47, v208
    v_mul_f32 v138, v138, v209
    v_cvt_pk_bf16_f32 v107, v170, v138
    v_add_f32 v139, v139, v155
    v_and_b32 v210, 0xffff0000, v205
    v_and_b32 v211, 0xffff0000, v111
    v_fmac_f32 v139, s47, v210
    v_mul_f32 v139, v139, v211
    v_cvt_pk_bf16_f32 v111, v171, v139
    s_add_u32 s52, s48, 917504
    buffer_store_dwordx4 v[96:99], v8, s[12:15], s52 offen offset:0
    buffer_store_dwordx4 v[100:103], v8, s[12:15], s52 offen offset:1792
    s_add_u32 s52, s48, 921088
    buffer_store_dwordx4 v[104:107], v8, s[12:15], s52 offen offset:0
    buffer_store_dwordx4 v[108:111], v8, s[12:15], s52 offen offset:1792
    v_add_f32 v140, v140, v156
    v_lshlrev_b32 v208, 16, v206
    v_and_b32 v209, 0xffff0000, v115
    v_fmac_f32 v140, s47, v208
    v_mul_f32 v140, v140, v209
    v_cvt_pk_bf16_f32 v115, v172, v140
    v_add_f32 v141, v141, v157
    v_and_b32 v210, 0xffff0000, v206
    v_and_b32 v211, 0xffff0000, v119
    v_fmac_f32 v141, s47, v210
    v_mul_f32 v141, v141, v211
    v_cvt_pk_bf16_f32 v119, v173, v141
    v_add_f32 v142, v142, v158
    v_lshlrev_b32 v208, 16, v207
    v_and_b32 v209, 0xffff0000, v123
    v_fmac_f32 v142, s47, v208
    v_mul_f32 v142, v142, v209
    v_cvt_pk_bf16_f32 v123, v174, v142
    v_add_f32 v143, v143, v159
    v_and_b32 v210, 0xffff0000, v207
    v_and_b32 v211, 0xffff0000, v127
    v_fmac_f32 v143, s47, v210
    v_mul_f32 v143, v143, v211
    v_cvt_pk_bf16_f32 v127, v175, v143
    s_add_u32 s52, s48, 1376256
    buffer_store_dwordx4 v[112:115], v8, s[12:15], s52 offen offset:0
    buffer_store_dwordx4 v[116:119], v8, s[12:15], s52 offen offset:1792
    s_add_u32 s52, s48, 1379840
    buffer_store_dwordx4 v[120:123], v8, s[12:15], s52 offen offset:0
    buffer_store_dwordx4 v[124:127], v8, s[12:15], s52 offen offset:1792
K3_fin:
K3_end:
    s_endpgm
.section .rodata,"a"
.p2align 6
.amdhsa_kernel p1_kernel
  .amdhsa_next_free_vgpr 512
  .amdhsa_next_free_sgpr 102
  .amdhsa_accum_offset 256
  .amdhsa_group_segment_fixed_size 0
  .amdhsa_kernarg_size 120
  .amdhsa_user_sgpr_count 2
  .amdhsa_user_sgpr_kernarg_segment_ptr 1
  .amdhsa_system_sgpr_workgroup_id_x 1
  .amdhsa_float_denorm_mode_32 3
  .amdhsa_float_denorm_mode_16_64 3
  .amdhsa_ieee_mode 0
  .amdhsa_dx10_clamp 0
.end_amdhsa_kernel
.p2align 6
.amdhsa_kernel p2_kernel
  .amdhsa_next_free_vgpr 512
  .amdhsa_next_free_sgpr 102
  .amdhsa_accum_offset 256
  .amdhsa_group_segment_fixed_size 0
  .amdhsa_kernarg_size 120
  .amdhsa_user_sgpr_count 2
  .amdhsa_user_sgpr_kernarg_segment_ptr 1
  .amdhsa_system_sgpr_workgroup_id_x 1
  .amdhsa_float_denorm_mode_32 3
  .amdhsa_float_denorm_mode_16_64 3
  .amdhsa_ieee_mode 0
  .amdhsa_dx10_clamp 0
.end_amdhsa_kernel
.p2align 6
.amdhsa_kernel p3_kernel
  .amdhsa_next_free_vgpr 512
  .amdhsa_next_free_sgpr 102
  .amdhsa_accum_offset 256
  .amdhsa_group_segment_fixed_size 0
  .amdhsa_kernarg_size 120
  .amdhsa_user_sgpr_count 2
  .amdhsa_user_sgpr_kernarg_segment_ptr 1
  .amdhsa_system_sgpr_workgroup_id_x 1
  .amdhsa_float_denorm_mode_32 3
  .amdhsa_float_denorm_mode_16_64 3
  .amdhsa_ieee_mode 0
  .amdhsa_dx10_clamp 0
.end_amdhsa_kernel
```

```asm
; @launch grid=(256,1,1) block=(256,1,1) lds=163840
.amdgcn_target "amdgcn-amd-amdhsa--gfx950"
.text
.globl concat_heads__ssm_conv_h3__compressed_kv_cla__prompt_kernel
.p2align 8
.type concat_heads__ssm_conv_h3__compressed_kv_cla__prompt_kernel,@function
concat_heads__ssm_conv_h3__compressed_kv_cla__prompt_kernel:
s_cmp_ge_u32 s2, 256
s_cbranch_scc1 M_end
s_load_dwordx16 s[64:79], s[0:1], 0
s_load_dwordx8 s[80:87], s[0:1], 64
s_load_dwordx4 s[88:91], s[0:1], 96
s_load_dwordx2 s[92:93], s[0:1], 112
v_lshrrev_b32 v28, 6, v0
v_and_b32 v29, 63, v0
v_lshlrev_b32 v1, 4, v29
v_readfirstlane_b32 s3, v28
s_and_b32 s20, s2, 7
s_lshl_b32 s20, s20, 1
s_bfe_u32 s22, s2, 0x10003
s_add_u32 s20, s20, s22
s_lshr_b32 s21, s2, 5
s_mov_b32 s101, 0x40000
v_lshrrev_b32 v26, 7, v1
v_lshrrev_b32 v27, 1, v26
v_lshlrev_b32 v27, 4, v27
v_and_b32 v28, 0x70, v1
v_xor_b32 v27, v27, v28
v_mul_u32_u24 v26, 2048, v26
v_add_u32 v12, v26, v27
v_xor_b32 v27, 64, v27
v_add_u32 v26, v26, v27
v_add_u32 v13, 15360, v26
v_add_u32 v14, 30720, v12
v_add_u32 v15, 46080, v26
v_lshrrev_b32 v26, 5, v29
v_and_b32 v27, 31, v29
s_and_b32 s22, s3, 1
s_lshl_b32 s22, s22, 2
v_or_b32 v28, s22, v26
v_lshlrev_b32 v28, 1, v28
v_xor_b32 v27, v27, v28
v_lshlrev_b32 v27, 4, v27
v_lshl_add_u32 v16, v26, 13, v27
v_xor_b32 v26, 64, v16
v_add_u32 v17, 15360, v26
v_add_u32 v18, 30720, v16
v_add_u32 v19, 46080, v26
s_lshl_b32 s28, s3, 13
s_lshl_b32 s29, s3, 12
s_lshl_b32 s24, s21, 19
s_lshl_b32 s22, s3, 17
s_add_u32 s24, s24, s22
s_add_u32 s25, s24, 65536
s_lshl_b32 s26, s3, 16
s_lshl_b32 s22, s20, 9
s_add_u32 s26, s26, s22
s_add_u32 s27, s26, 262144
s_mov_b32 s10, 4194304
s_mov_b32 s11, 0x20000
s_mov_b32 s14, 8388608
s_mov_b32 s15, 0x20000
s_bitcmp1_b32 s2, 4
s_waitcnt lgkmcnt(0)
s_mov_b64 s[8:9], s[78:79]
s_cselect_b64 s[12:13], s[84:85], s[82:83]
s_add_u32 m0, s28, 0
s_nop 0
buffer_load_dwordx4 v12, s[8:11], s24 offen offset:0 lds
buffer_load_dwordx4 v13, s[8:11], s24 offen offset:1024 lds
buffer_load_dwordx4 v14, s[8:11], s24 offen offset:2048 lds
buffer_load_dwordx4 v15, s[8:11], s24 offen offset:3072 lds
s_add_u32 s24, s24, 128
s_add_u32 m0, s28, 4096
s_nop 0
buffer_load_dwordx4 v12, s[8:11], s25 offen offset:0 lds
buffer_load_dwordx4 v13, s[8:11], s25 offen offset:1024 lds
buffer_load_dwordx4 v14, s[8:11], s25 offen offset:2048 lds
buffer_load_dwordx4 v15, s[8:11], s25 offen offset:3072 lds
s_add_u32 s25, s25, 128
s_add_u32 m0, s29, 65536
s_nop 0
buffer_load_dwordx4 v16, s[12:15], s26 offen offset:0 nt lds
buffer_load_dwordx4 v17, s[12:15], s26 offen offset:1024 nt lds
buffer_load_dwordx4 v18, s[12:15], s26 offen offset:2048 nt lds
buffer_load_dwordx4 v19, s[12:15], s26 offen offset:3072 nt lds
s_add_u32 s26, s26, 524288
s_add_u32 m0, s29, 81920
s_nop 0
buffer_load_dwordx4 v16, s[12:15], s27 offen offset:0 nt lds
buffer_load_dwordx4 v17, s[12:15], s27 offen offset:1024 nt lds
buffer_load_dwordx4 v18, s[12:15], s27 offen offset:2048 nt lds
buffer_load_dwordx4 v19, s[12:15], s27 offen offset:3072 nt lds
s_add_u32 s27, s27, 524288
s_mov_b32 s4, s92
s_mov_b32 s5, s93
s_mov_b32 s6, 268435456
s_mov_b32 s7, 0x20000
s_mov_b32 s52, s66
s_mov_b32 s53, s67
s_mov_b32 s54, 1835008
s_mov_b32 s55, 0x20000
s_mov_b32 s56, s68
s_mov_b32 s57, s69
s_mov_b32 s58, 1835008
s_mov_b32 s59, 0x20000
s_mov_b32 s60, s70
s_mov_b32 s61, s71
s_mov_b32 s62, 3584
s_mov_b32 s63, 0x20000
s_add_u32 m0, s28, 32768
s_nop 0
buffer_load_dwordx4 v12, s[8:11], s24 offen offset:0 lds
buffer_load_dwordx4 v13, s[8:11], s24 offen offset:1024 lds
buffer_load_dwordx4 v14, s[8:11], s24 offen offset:2048 lds
buffer_load_dwordx4 v15, s[8:11], s24 offen offset:3072 lds
s_add_u32 s24, s24, 128
s_add_u32 m0, s28, 36864
s_nop 0
buffer_load_dwordx4 v12, s[8:11], s25 offen offset:0 lds
buffer_load_dwordx4 v13, s[8:11], s25 offen offset:1024 lds
buffer_load_dwordx4 v14, s[8:11], s25 offen offset:2048 lds
buffer_load_dwordx4 v15, s[8:11], s25 offen offset:3072 lds
s_add_u32 s25, s25, 128
s_add_u32 m0, s29, 98304
s_nop 0
buffer_load_dwordx4 v16, s[12:15], s26 offen offset:0 nt lds
buffer_load_dwordx4 v17, s[12:15], s26 offen offset:1024 nt lds
buffer_load_dwordx4 v18, s[12:15], s26 offen offset:2048 nt lds
buffer_load_dwordx4 v19, s[12:15], s26 offen offset:3072 nt lds
s_add_u32 s26, s26, 524288
s_mul_hi_u32 s22, s2, 613566757
s_mul_i32 s23, s22, 7
s_sub_u32 s23, s2, s23
v_and_b32 v248, 31, v0
v_lshrrev_b32 v249, 5, v0
s_lshl_b32 s22, s22, 3
v_add_u32 v249, s22, v249
s_lshl_b32 s23, s23, 5
v_add_u32 v248, s23, v248
v_mul_u32_u24 v250, 7168, v249
v_lshl_add_u32 v250, v248, 2, v250
v_lshlrev_b32 v251, 4, v248
buffer_load_dwordx4 v[244:247], v251, s[60:63], 0 offen
v_subrev_u32 v251, 2688, v250
buffer_load_dword v224, v251, s[52:55], 0 offen nt
v_subrev_u32 v251, 1792, v250
buffer_load_dword v225, v251, s[52:55], 0 offen nt
v_subrev_u32 v251, 896, v250
buffer_load_dword v226, v251, s[52:55], 0 offen nt
v_add_u32 v251, 3584, v250
buffer_load_dword v227, v250, s[52:55], 0 offen offset:0 nt
buffer_load_dword v235, v250, s[56:59], 0 offen offset:0 nt
buffer_load_dword v228, v250, s[52:55], 0 offen offset:896 nt
buffer_load_dword v236, v250, s[56:59], 0 offen offset:896 nt
buffer_load_dword v229, v250, s[52:55], 0 offen offset:1792 nt
buffer_load_dword v237, v250, s[56:59], 0 offen offset:1792 nt
buffer_load_dword v230, v250, s[52:55], 0 offen offset:2688 nt
buffer_load_dword v238, v250, s[56:59], 0 offen offset:2688 nt
buffer_load_dword v231, v251, s[52:55], 0 offen offset:0 nt
buffer_load_dword v239, v251, s[56:59], 0 offen offset:0 nt
buffer_load_dword v232, v251, s[52:55], 0 offen offset:896 nt
buffer_load_dword v240, v251, s[56:59], 0 offen offset:896 nt
buffer_load_dword v233, v251, s[52:55], 0 offen offset:1792 nt
buffer_load_dword v241, v251, s[56:59], 0 offen offset:1792 nt
buffer_load_dword v234, v251, s[52:55], 0 offen offset:2688 nt
buffer_load_dword v242, v251, s[56:59], 0 offen offset:2688 nt
v_mul_u32_u24 v250, 8448, v248
v_lshl_add_u32 v250, v249, 4, v250
v_cmp_eq_u32 vcc, 0, v249
v_mov_b32 v251, 3221225472
v_mov_b32 v252, 0
v_mov_b32 v253, 0
v_cndmask_b32 v251, v251, v250, vcc
s_cmp_lt_u32 s2, 224
s_cselect_b32 s38, 83886192, 3221225472
s_add_u32 s39, s38, 4224
s_cmp_eq_u32 s3, 3
s_cselect_b64 s[40:41], s[72:73], s[76:77]
s_cselect_b32 s42, 1835008, 0
s_cmp_eq_u32 s3, 1
s_cselect_b32 s42, 1835008, s42
s_cmp_eq_u32 s3, 3
s_cselect_b64 s[44:45], s[86:87], s[80:81]
s_cselect_b32 s46, 3670016, 0
s_cmp_eq_u32 s3, 1
s_cselect_b32 s46, 3670016, s46
s_cmp_eq_u32 s3, 3
s_cselect_b64 s[48:49], s[64:65], s[64:65]
s_cselect_b32 s50, 1835008, 0
s_cmp_eq_u32 s3, 1
s_cselect_b32 s50, 0, s50
s_cmp_eq_u32 s3, 3
s_cselect_b64 s[52:53], s[64:65], s[64:65]
s_cselect_b32 s54, 0, 0
s_cmp_eq_u32 s3, 1
s_cselect_b32 s54, 0, s54
s_mov_b32 s19, 0x20000
s_cmp_eq_u32 s3, 2
s_cbranch_scc1 M_pf2
s_cmp_lg_u32 s3, 0
s_cbranch_scc1 M_pf3
s_mov_b64 s[16:17], s[12:13]
s_mov_b32 s18, 8388608
s_mov_b32 s51, 8388608
s_mov_b32 s47, 524288
s_mov_b32 s43, 1048576
s_lshl_b32 s22, s21, 16
s_lshl_b32 s23, s20, 9
s_add_u32 s22, s22, s23
v_lshrrev_b32 v26, 2, v29
v_lshl_add_u32 v26, v26, 13, s22
v_and_b32 v27, 3, v29
v_lshl_add_u32 v20, v27, 7, v26
v_cmp_gt_u32 vcc, 32, v29
v_mov_b32 v26, 3221225472
s_nop 0
v_cndmask_b32 v20, v26, v20, vcc
buffer_load_dword v21, v20, s[16:19], s43 offen nt
s_add_u32 s43, s43, s47
s_branch M_pfd
M_pf2:
s_mov_b64 s[16:17], s[78:79]
s_mov_b32 s18, 4194304
s_mov_b32 s51, 2048
s_mov_b32 s47, 256
s_mov_b32 s43, 256
s_lshl_b32 s22, s2, 14
v_lshrrev_b32 v26, 1, v29
v_lshl_add_u32 v26, v26, 11, s22
v_and_b32 v27, 1, v29
v_lshl_add_u32 v20, v27, 7, v26
v_cmp_gt_u32 vcc, 16, v29
s_branch M_pfd
M_pf3:
s_mov_b64 s[16:17], s[76:77]
s_mov_b32 s18, 0
s_mov_b32 s51, 3670016
s_mov_b32 s47, 917504
s_mov_b32 s43, 0
s_mul_i32 s22, s2, 3584
v_lshl_add_u32 v20, v29, 7, s22
v_cmp_gt_u32 vcc, 28, v29
M_pfd:
v_mov_b32 v26, 3221225472
s_nop 0
v_cndmask_b32 v20, v26, v20, vcc
s_cmp_eq_u32 s3, 0
s_cselect_b32 s23, s43, 3221225472
buffer_load_dword v21, v20, s[16:19], s23 offen nt
s_cselect_b32 s23, 3221225472, s43
buffer_load_dword v21, v20, s[16:19], s23 offen
s_add_u32 s43, s43, s47
s_mov_b32 s60, s90
s_mov_b32 s61, s91
s_mov_b32 s62, 256
s_mov_b32 s63, 0x20000
s_mul_hi_u32 s22, s2, 715827883
s_mul_i32 s22, s22, 6
s_sub_u32 s55, s2, s22
s_getpc_b64 s[56:57]
M_pc:
s_lshr_b32 s22, s2, 3
s_lshl_b32 s22, s22, 5
v_and_b32 v26, 31, v0
v_add_u32 v26, s22, v26
v_lshlrev_b32 v26, 7, v26
v_min_u32 v26, M_end-M_pc, v26
v_mov_b32 v27, s57
v_add_co_u32 v26, vcc, s56, v26
s_nop 1
v_addc_co_u32 v27, vcc, 0, v27, vcc
global_load_dword v21, v[26:27], off
v_and_b32 v30, 15, v29
v_lshrrev_b32 v31, 4, v29
v_lshrrev_b32 v26, 1, v30
v_xor_b32 v26, v31, v26
v_lshlrev_b32 v26, 4, v26
v_lshl_add_u32 v2, v30, 7, v26
s_lshr_b32 s22, s3, 1
s_lshl_b32 s22, s22, 14
v_add_u32 v2, s22, v2
v_xor_b32 v3, 64, v2
v_lshrrev_b32 v26, 2, v30
v_and_b32 v27, 1, v31
v_lshl_or_b32 v27, v27, 2, v26
v_lshl_add_u32 v26, v31, 3, v26
v_lshlrev_b32 v26, 9, v26
v_lshl_add_u32 v26, v27, 5, v26
v_and_b32 v27, 3, v29
v_lshl_add_u32 v26, v27, 3, v26
s_lshl_b32 s22, s3, 7
s_add_u32 s22, s22, 131072
v_xor_b32 v22, s22, v26
s_and_b32 s22, s3, 1
s_lshl_b32 s22, s22, 8
s_add_u32 s22, s22, 0x10000
v_xor_b32 v4, s22, v26
v_xor_b32 v5, 32, v4
v_xor_b32 v6, 64, v4
v_xor_b32 v7, 96, v4
v_xor_b32 v8, 128, v4
v_xor_b32 v9, 160, v4
v_xor_b32 v10, 192, v4
v_xor_b32 v11, 224, v4
v_xor_b32 v23, 32, v22
v_xor_b32 v24, 64, v22
v_xor_b32 v25, 96, v22
s_lshr_b32 s22, s2, 4
s_lshl_b32 s23, s20, 5
s_add_u32 s23, s23, s22
s_lshl_b32 s23, s23, 2
v_mov_b32 v28, 3221225472
v_writelane_b32 v28, s23, 0
s_add_u32 s30, s23, 64
v_writelane_b32 v28, s30, 1
s_add_u32 s30, s23, 4096
v_writelane_b32 v28, s30, 2
s_sub_u32 s37, 15, s21
s_bitcmp1_b32 s2, 4
s_cselect_b32 s37, s21, s37
s_lshl_b32 s30, s37, 5
s_add_u32 s30, s30, s20
s_lshl_b32 s30, s30, 2
s_add_u32 s30, s30, 8192
v_writelane_b32 v28, s30, 3
s_lshl_b32 s30, s2, 2
s_add_u32 s30, s30, 12288
v_writelane_b32 v28, s30, 4
s_cmp_eq_u32 s3, 0
s_cselect_b32 s30, 94371840, 3221225472
buffer_store_dword v252, v28, s[4:7], s30 offen sc1
v_mov_b32 v27, 1
v_cmp_eq_u32 vcc, 0, v0
v_mov_b32 v26, 3221225472
s_lshl_b32 s31, s20, 20
s_lshl_b32 s22, s21, 17
v_cndmask_b32 v26, v26, v252, vcc
s_add_u32 s31, s31, s22
s_lshr_b32 s22, s3, 1
s_lshl_b32 s22, s22, 16
s_add_u32 s31, s31, s22
s_and_b32 s22, s3, 1
s_waitcnt vmcnt(36)
s_barrier
ds_read_b128 a[0:3], v2 offset:0
ds_read_b128 a[4:7], v3 offset:0
ds_read_b128 a[8:11], v2 offset:2048
ds_read_b128 a[12:15], v3 offset:2048
ds_read_b128 a[16:19], v2 offset:4096
ds_read_b128 a[20:23], v3 offset:4096
ds_read_b128 a[24:27], v2 offset:6144
ds_read_b128 a[28:31], v3 offset:6144
ds_read_b128 a[32:35], v2 offset:8192
ds_read_b128 a[36:39], v3 offset:8192
ds_read_b128 a[40:43], v2 offset:10240
ds_read_b128 a[44:47], v3 offset:10240
ds_read_b128 a[48:51], v2 offset:12288
ds_read_b128 a[52:55], v3 offset:12288
ds_read_b128 a[56:59], v2 offset:14336
ds_read_b128 a[60:63], v3 offset:14336
ds_read_b64_tr_b16 a[128:129], v4 offset:0
ds_read_b64_tr_b16 a[130:131], v4 offset:2048
ds_read_b64_tr_b16 a[132:133], v4 offset:16384
ds_read_b64_tr_b16 a[134:135], v4 offset:18432
s_waitcnt vmcnt(28) lgkmcnt(0)
s_barrier
s_bitcmp1_b32 s2, 4
s_cbranch_scc1 M_V
s_lshl_b32 s22, s22, 12
s_add_u32 s31, s31, s22
s_mov_b32 s32, 8192
s_mov_b32 s33, 8192
s_mov_b32 s34, 8192
s_mov_b32 s35, 4294910976
s_mov_b32 s36, 4294910976
s_mov_b32 s30, 6
v_mfma_f32_16x16x32_bf16 v[32:35], a[128:131], a[0:3], 0
s_add_u32 m0, s29, 114688
ds_read_b64_tr_b16 a[136:137], v5 offset:0
v_mfma_f32_16x16x32_bf16 v[32:35], a[132:135], a[4:7], v[32:35]
buffer_load_dwordx4 v16, s[12:15], s27 offen offset:0 nt lds
v_mfma_f32_16x16x32_bf16 v[40:43], a[128:131], a[8:11], 0
ds_read_b64_tr_b16 a[138:139], v5 offset:2048
v_mfma_f32_16x16x32_bf16 v[40:43], a[132:135], a[12:15], v[40:43]
v_mfma_f32_16x16x32_bf16 v[48:51], a[128:131], a[16:19], 0
ds_read_b64_tr_b16 a[140:141], v5 offset:16384
v_mfma_f32_16x16x32_bf16 v[48:51], a[132:135], a[20:23], v[48:51]
buffer_load_dwordx4 v17, s[12:15], s27 offen offset:1024 nt lds
v_mfma_f32_16x16x32_bf16 v[56:59], a[128:131], a[24:27], 0
ds_read_b64_tr_b16 a[142:143], v5 offset:18432
v_mfma_f32_16x16x32_bf16 v[56:59], a[132:135], a[28:31], v[56:59]
v_mfma_f32_16x16x32_bf16 v[64:67], a[128:131], a[32:35], 0
ds_read_b128 a[64:67], v2 offset:32768
v_mfma_f32_16x16x32_bf16 v[64:67], a[132:135], a[36:39], v[64:67]
buffer_load_dwordx4 v18, s[12:15], s27 offen offset:2048 nt lds
v_mfma_f32_16x16x32_bf16 v[72:75], a[128:131], a[40:43], 0
ds_read_b128 a[68:71], v3 offset:32768
v_mfma_f32_16x16x32_bf16 v[72:75], a[132:135], a[44:47], v[72:75]
v_mfma_f32_16x16x32_bf16 v[80:83], a[128:131], a[48:51], 0
v_mfma_f32_16x16x32_bf16 v[80:83], a[132:135], a[52:55], v[80:83]
buffer_load_dwordx4 v19, s[12:15], s27 offen offset:3072 nt lds
v_mfma_f32_16x16x32_bf16 v[88:91], a[128:131], a[56:59], 0
s_add_u32 s27, s27, 524288
ds_read_b128 a[72:75], v2 offset:34816
v_mfma_f32_16x16x32_bf16 v[88:91], a[132:135], a[60:63], v[88:91]
s_waitcnt vmcnt(8) lgkmcnt(3)
v_mfma_f32_16x16x32_bf16 v[36:39], a[136:139], a[0:3], 0
s_add_u32 m0, s28, 0
ds_read_b64_tr_b16 a[128:129], v6 offset:0
v_lshlrev_b32 v204, 16, v244
v_and_b32 v205, 0xffff0000, v244
v_mfma_f32_16x16x32_bf16 v[36:39], a[140:143], a[4:7], v[36:39]
buffer_load_dwordx4 v12, s[8:11], s24 offen offset:0 lds
v_lshlrev_b32 v206, 16, v245
v_mfma_f32_16x16x32_bf16 v[44:47], a[136:139], a[8:11], 0
ds_read_b64_tr_b16 a[130:131], v6 offset:2048
v_and_b32 v207, 0xffff0000, v245
v_lshlrev_b32 v192, 16, v224
v_lshlrev_b32 v193, 16, v225
v_mfma_f32_16x16x32_bf16 v[44:47], a[140:143], a[12:15], v[44:47]
v_lshlrev_b32 v194, 16, v226
v_lshlrev_b32 v195, 16, v227
v_mul_f32 v208, v192, v207
v_mfma_f32_16x16x32_bf16 v[52:55], a[136:139], a[16:19], 0
ds_read_b64_tr_b16 a[132:133], v6 offset:16384
v_lshlrev_b32 v203, 16, v235
v_fmac_f32 v208, v193, v206
v_fmac_f32 v208, v194, v205
v_mfma_f32_16x16x32_bf16 v[52:55], a[140:143], a[20:23], v[52:55]
buffer_load_dwordx4 v13, s[8:11], s24 offen offset:1024 lds
v_fmac_f32 v208, v195, v204
v_mfma_f32_16x16x32_bf16 v[60:63], a[136:139], a[24:27], 0
ds_read_b64_tr_b16 a[134:135], v6 offset:18432
v_mul_f32 v208, v208, v203
v_lshlrev_b32 v196, 16, v228
v_mul_f32 v209, v193, v207
v_mfma_f32_16x16x32_bf16 v[60:63], a[140:143], a[28:31], v[60:63]
v_lshlrev_b32 v203, 16, v236
v_fmac_f32 v209, v194, v206
v_fmac_f32 v209, v195, v205
v_mfma_f32_16x16x32_bf16 v[68:71], a[136:139], a[32:35], 0
ds_read_b128 a[76:79], v3 offset:34816
v_fmac_f32 v209, v196, v204
v_mul_f32 v209, v209, v203
v_cvt_pk_bf16_f32 v216, v208, v209
v_mfma_f32_16x16x32_bf16 v[68:71], a[140:143], a[36:39], v[68:71]
buffer_load_dwordx4 v14, s[8:11], s24 offen offset:2048 lds
v_lshlrev_b32 v197, 16, v229
v_mfma_f32_16x16x32_bf16 v[76:79], a[136:139], a[40:43], 0
v_mul_f32 v210, v194, v207
v_lshlrev_b32 v203, 16, v237
v_fmac_f32 v210, v195, v206
v_mfma_f32_16x16x32_bf16 v[76:79], a[140:143], a[44:47], v[76:79]
v_fmac_f32 v210, v196, v205
v_fmac_f32 v210, v197, v204
v_mul_f32 v210, v210, v203
v_lshlrev_b32 v198, 16, v230
v_mfma_f32_16x16x32_bf16 v[84:87], a[136:139], a[48:51], 0
ds_read_b128 a[80:83], v2 offset:36864
v_mul_f32 v211, v195, v207
v_lshlrev_b32 v203, 16, v238
v_mfma_f32_16x16x32_bf16 v[84:87], a[140:143], a[52:55], v[84:87]
buffer_load_dwordx4 v15, s[8:11], s24 offen offset:3072 lds
v_fmac_f32 v211, v196, v206
v_fmac_f32 v211, v197, v205
v_mfma_f32_16x16x32_bf16 v[92:95], a[136:139], a[56:59], 0
s_add_u32 s24, s24, 128
ds_read_b128 a[84:87], v3 offset:36864
v_fmac_f32 v211, v198, v204
v_mul_f32 v211, v211, v203
v_mfma_f32_16x16x32_bf16 v[92:95], a[140:143], a[60:63], v[92:95]
s_waitcnt lgkmcnt(3)
v_cvt_pk_bf16_f32 v217, v210, v211
v_lshlrev_b32 v199, 16, v231
v_mul_f32 v212, v196, v207
v_lshlrev_b32 v203, 16, v239
v_mfma_f32_16x16x32_bf16 v[96:99], a[128:131], a[0:3], 0
s_add_u32 m0, s28, 4096
ds_read_b64_tr_b16 a[136:137], v7 offset:0
v_fmac_f32 v212, v197, v206
v_fmac_f32 v212, v198, v205
v_mfma_f32_16x16x32_bf16 v[96:99], a[132:135], a[4:7], v[96:99]
buffer_load_dwordx4 v12, s[8:11], s25 offen offset:0 lds
v_fmac_f32 v212, v199, v204
v_mul_f32 v212, v212, v203
v_mfma_f32_16x16x32_bf16 v[104:107], a[128:131], a[8:11], 0
ds_read_b64_tr_b16 a[138:139], v7 offset:2048
v_lshlrev_b32 v200, 16, v232
v_mul_f32 v213, v197, v207
v_mfma_f32_16x16x32_bf16 v[104:107], a[132:135], a[12:15], v[104:107]
v_lshlrev_b32 v203, 16, v240
v_fmac_f32 v213, v198, v206
v_fmac_f32 v213, v199, v205
v_fmac_f32 v213, v200, v204
v_mfma_f32_16x16x32_bf16 v[112:115], a[128:131], a[16:19], 0
ds_read_b64_tr_b16 a[140:141], v7 offset:16384
v_mul_f32 v213, v213, v203
v_cvt_pk_bf16_f32 v218, v212, v213
v_mfma_f32_16x16x32_bf16 v[112:115], a[132:135], a[20:23], v[112:115]
buffer_load_dwordx4 v13, s[8:11], s25 offen offset:1024 lds
v_lshlrev_b32 v201, 16, v233
v_mfma_f32_16x16x32_bf16 v[120:123], a[128:131], a[24:27], 0
ds_read_b64_tr_b16 a[142:143], v7 offset:18432
v_mul_f32 v214, v198, v207
v_lshlrev_b32 v203, 16, v241
v_fmac_f32 v214, v199, v206
v_mfma_f32_16x16x32_bf16 v[120:123], a[132:135], a[28:31], v[120:123]
v_fmac_f32 v214, v200, v205
v_fmac_f32 v214, v201, v204
v_mul_f32 v214, v214, v203
v_mfma_f32_16x16x32_bf16 v[128:131], a[128:131], a[32:35], 0
v_lshlrev_b32 v202, 16, v234
v_mul_f32 v215, v199, v207
v_lshlrev_b32 v203, 16, v242
v_fmac_f32 v215, v200, v206
v_mfma_f32_16x16x32_bf16 v[128:131], a[132:135], a[36:39], v[128:131]
buffer_load_dwordx4 v14, s[8:11], s25 offen offset:2048 lds
v_fmac_f32 v215, v201, v205
v_mfma_f32_16x16x32_bf16 v[136:139], a[128:131], a[40:43], 0
ds_read_b128 a[88:91], v2 offset:38912
v_fmac_f32 v215, v202, v204
v_mul_f32 v215, v215, v203
v_cvt_pk_bf16_f32 v219, v214, v215
v_mfma_f32_16x16x32_bf16 v[136:139], a[132:135], a[44:47], v[136:139]
v_lshlrev_b32 v204, 16, v246
v_and_b32 v205, 0xffff0000, v246
v_lshlrev_b32 v206, 16, v247
v_mfma_f32_16x16x32_bf16 v[144:147], a[128:131], a[48:51], 0
ds_read_b128 a[92:95], v3 offset:38912
v_and_b32 v207, 0xffff0000, v247
v_and_b32 v192, 0xffff0000, v224
v_and_b32 v193, 0xffff0000, v225
v_mfma_f32_16x16x32_bf16 v[144:147], a[132:135], a[52:55], v[144:147]
s_waitcnt lgkmcnt(2)
buffer_load_dwordx4 v15, s[8:11], s25 offen offset:3072 lds
v_and_b32 v194, 0xffff0000, v226
v_mfma_f32_16x16x32_bf16 v[152:155], a[128:131], a[56:59], 0
s_add_u32 s25, s25, 128
v_and_b32 v195, 0xffff0000, v227
v_mul_f32 v208, v192, v207
v_and_b32 v203, 0xffff0000, v235
v_mfma_f32_16x16x32_bf16 v[152:155], a[132:135], a[60:63], v[152:155]
s_cmp_eq_u32 s3, 0
v_fmac_f32 v208, v193, v206
v_fmac_f32 v208, v194, v205
v_fmac_f32 v208, v195, v204
v_mul_f32 v208, v208, v203
v_mfma_f32_16x16x32_bf16 v[100:103], a[136:139], a[0:3], 0
s_cselect_b32 s23, s43, 3221225472
ds_read_b64_tr_b16 a[128:129], v8 offset:0
v_and_b32 v196, 0xffff0000, v228
v_mul_f32 v209, v193, v207
v_mfma_f32_16x16x32_bf16 v[100:103], a[140:143], a[4:7], v[100:103]
buffer_load_dword v21, v20, s[16:19], s23 offen nt
v_and_b32 v203, 0xffff0000, v236
v_fmac_f32 v209, v194, v206
v_mfma_f32_16x16x32_bf16 v[108:111], a[136:139], a[8:11], 0
s_cselect_b32 s23, 3221225472, s43
ds_read_b64_tr_b16 a[130:131], v8 offset:2048
v_fmac_f32 v209, v195, v205
v_fmac_f32 v209, v196, v204
v_mfma_f32_16x16x32_bf16 v[108:111], a[140:143], a[12:15], v[108:111]
buffer_load_dword v21, v20, s[16:19], s23 offen
v_mul_f32 v209, v209, v203
v_cvt_pk_bf16_f32 v220, v208, v209
v_mfma_f32_16x16x32_bf16 v[116:119], a[136:139], a[16:19], 0
s_add_u32 s43, s43, s47
ds_read_b64_tr_b16 a[132:133], v8 offset:16384
v_and_b32 v197, 0xffff0000, v229
v_mul_f32 v210, v194, v207
v_mfma_f32_16x16x32_bf16 v[116:119], a[140:143], a[20:23], v[116:119]
s_cmp_ge_u32 s43, s51
v_and_b32 v203, 0xffff0000, v237
v_fmac_f32 v210, v195, v206
v_fmac_f32 v210, v196, v205
v_fmac_f32 v210, v197, v204
v_mfma_f32_16x16x32_bf16 v[124:127], a[136:139], a[24:27], 0
s_cselect_b32 s43, 0, s43
ds_read_b64_tr_b16 a[134:135], v8 offset:18432
v_mul_f32 v210, v210, v203
v_and_b32 v198, 0xffff0000, v230
v_mfma_f32_16x16x32_bf16 v[124:127], a[140:143], a[28:31], v[124:127]
s_cselect_b32 s51, s42, s51
v_mul_f32 v211, v195, v207
v_and_b32 v203, 0xffff0000, v238
v_fmac_f32 v211, v196, v206
v_fmac_f32 v211, v197, v205
v_mfma_f32_16x16x32_bf16 v[132:135], a[136:139], a[32:35], 0
s_cselect_b64 s[16:17], s[40:41], s[16:17]
ds_read_b128 a[96:99], v2 offset:40960
v_fmac_f32 v211, v198, v204
v_mul_f32 v211, v211, v203
v_mfma_f32_16x16x32_bf16 v[132:135], a[140:143], a[36:39], v[132:135]
s_cselect_b32 s18, s42, s18
v_cvt_pk_bf16_f32 v221, v210, v211
v_and_b32 v199, 0xffff0000, v231
v_mul_f32 v212, v196, v207
v_mfma_f32_16x16x32_bf16 v[140:143], a[136:139], a[40:43], 0
s_cselect_b64 s[40:41], s[44:45], s[40:41]
v_and_b32 v203, 0xffff0000, v239
v_fmac_f32 v212, v197, v206
v_fmac_f32 v212, v198, v205
v_fmac_f32 v212, v199, v204
v_mfma_f32_16x16x32_bf16 v[140:143], a[140:143], a[44:47], v[140:143]
s_cselect_b32 s42, s46, s42
v_mul_f32 v212, v212, v203
v_and_b32 v200, 0xffff0000, v232
v_mul_f32 v213, v197, v207
v_mfma_f32_16x16x32_bf16 v[148:151], a[136:139], a[48:51], 0
s_cselect_b64 s[44:45], s[48:49], s[44:45]
ds_read_b128 a[100:103], v3 offset:40960
v_and_b32 v203, 0xffff0000, v240
v_fmac_f32 v213, v198, v206
v_fmac_f32 v213, v199, v205
v_mfma_f32_16x16x32_bf16 v[148:151], a[140:143], a[52:55], v[148:151]
s_cselect_b32 s46, s50, s46
v_fmac_f32 v213, v200, v204
v_mul_f32 v213, v213, v203
v_cvt_pk_bf16_f32 v222, v212, v213
v_mfma_f32_16x16x32_bf16 v[156:159], a[136:139], a[56:59], 0
s_cselect_b64 s[48:49], s[52:53], s[48:49]
ds_read_b128 a[104:107], v2 offset:43008
v_and_b32 v201, 0xffff0000, v233
v_mul_f32 v214, v198, v207
v_and_b32 v203, 0xffff0000, v241
v_mfma_f32_16x16x32_bf16 v[156:159], a[140:143], a[60:63], v[156:159]
s_waitcnt lgkmcnt(3)
s_cselect_b32 s50, s54, s50
v_fmac_f32 v214, v199, v206
v_fmac_f32 v214, v200, v205
v_fmac_f32 v214, v201, v204
v_mfma_f32_16x16x32_bf16 v[160:163], a[128:131], a[0:3], 0
s_cselect_b32 s54, 0, s54
ds_read_b64_tr_b16 a[136:137], v9 offset:0
v_mul_f32 v214, v214, v203
v_and_b32 v202, 0xffff0000, v234
v_mul_f32 v215, v199, v207
v_mfma_f32_16x16x32_bf16 v[160:163], a[132:135], a[4:7], v[160:163]
v_and_b32 v203, 0xffff0000, v242
v_fmac_f32 v215, v200, v206
v_fmac_f32 v215, v201, v205
v_mfma_f32_16x16x32_bf16 v[168:171], a[128:131], a[8:11], 0
ds_read_b64_tr_b16 a[138:139], v9 offset:2048
v_fmac_f32 v215, v202, v204
v_mul_f32 v215, v215, v203
v_cvt_pk_bf16_f32 v223, v214, v215
v_mfma_f32_16x16x32_bf16 v[168:171], a[132:135], a[12:15], v[168:171]
buffer_store_dwordx4 v[216:219], v250, s[4:7], s38 offen offset:16 sc1
v_mfma_f32_16x16x32_bf16 v[176:179], a[128:131], a[16:19], 0
ds_read_b64_tr_b16 a[140:141], v9 offset:16384
v_mfma_f32_16x16x32_bf16 v[176:179], a[132:135], a[20:23], v[176:179]
buffer_store_dwordx4 v[220:223], v250, s[4:7], s39 offen offset:16 sc1
v_mfma_f32_16x16x32_bf16 v[184:187], a[128:131], a[24:27], 0
ds_read_b64_tr_b16 a[142:143], v9 offset:18432
v_mfma_f32_16x16x32_bf16 v[184:187], a[132:135], a[28:31], v[184:187]
v_mfma_f32_16x16x32_bf16 v[192:195], a[128:131], a[32:35], 0
v_mfma_f32_16x16x32_bf16 v[192:195], a[132:135], a[36:39], v[192:195]
v_mfma_f32_16x16x32_bf16 v[200:203], a[128:131], a[40:43], 0
ds_read_b128 a[108:111], v3 offset:43008
v_mfma_f32_16x16x32_bf16 v[200:203], a[132:135], a[44:47], v[200:203]
buffer_store_dwordx2 v[252:253], v251, s[4:7], s38 offen offset:8 sc1
v_mfma_f32_16x16x32_bf16 v[208:211], a[128:131], a[48:51], 0
ds_read_b128 a[112:115], v2 offset:45056
v_mfma_f32_16x16x32_bf16 v[208:211], a[132:135], a[52:55], v[208:211]
buffer_store_dwordx2 v[252:253], v251, s[4:7], s39 offen offset:8 sc1
v_mfma_f32_16x16x32_bf16 v[216:219], a[128:131], a[56:59], 0
v_mfma_f32_16x16x32_bf16 v[216:219], a[132:135], a[60:63], v[216:219]
s_waitcnt lgkmcnt(4)
v_mfma_f32_16x16x32_bf16 v[164:167], a[136:139], a[0:3], 0
s_waitcnt lgkmcnt(2)
ds_read_b64_tr_b16 a[128:129], v10 offset:0
v_mfma_f32_16x16x32_bf16 v[164:167], a[140:143], a[4:7], v[164:167]
v_mfma_f32_16x16x32_bf16 v[172:175], a[136:139], a[8:11], 0
ds_read_b64_tr_b16 a[130:131], v10 offset:2048
v_mfma_f32_16x16x32_bf16 v[172:175], a[140:143], a[12:15], v[172:175]
v_mfma_f32_16x16x32_bf16 v[180:183], a[136:139], a[16:19], 0
ds_read_b64_tr_b16 a[132:133], v10 offset:16384
v_mfma_f32_16x16x32_bf16 v[180:183], a[140:143], a[20:23], v[180:183]
v_mfma_f32_16x16x32_bf16 v[188:191], a[136:139], a[24:27], 0
ds_read_b64_tr_b16 a[134:135], v10 offset:18432
v_mfma_f32_16x16x32_bf16 v[188:191], a[140:143], a[28:31], v[188:191]
v_mfma_f32_16x16x32_bf16 v[196:199], a[136:139], a[32:35], 0
ds_read_b128 a[116:119], v3 offset:45056
v_mfma_f32_16x16x32_bf16 v[196:199], a[140:143], a[36:39], v[196:199]
v_mfma_f32_16x16x32_bf16 v[204:207], a[136:139], a[40:43], 0
ds_read_b128 a[120:123], v2 offset:47104
v_mfma_f32_16x16x32_bf16 v[204:207], a[140:143], a[44:47], v[204:207]
v_mfma_f32_16x16x32_bf16 v[212:215], a[136:139], a[48:51], 0
v_mfma_f32_16x16x32_bf16 v[212:215], a[140:143], a[52:55], v[212:215]
v_mfma_f32_16x16x32_bf16 v[220:223], a[136:139], a[56:59], 0
ds_read_b128 a[124:127], v3 offset:47104
v_mfma_f32_16x16x32_bf16 v[220:223], a[140:143], a[60:63], v[220:223]
s_waitcnt lgkmcnt(5)
v_mfma_f32_16x16x32_bf16 v[224:227], a[128:131], a[0:3], 0
s_waitcnt lgkmcnt(3)
ds_read_b64_tr_b16 a[136:137], v11 offset:0
v_mfma_f32_16x16x32_bf16 v[224:227], a[132:135], a[4:7], v[224:227]
v_mfma_f32_16x16x32_bf16 v[232:235], a[128:131], a[8:11], 0
ds_read_b64_tr_b16 a[138:139], v11 offset:2048
v_mfma_f32_16x16x32_bf16 v[232:235], a[132:135], a[12:15], v[232:235]
v_mfma_f32_16x16x32_bf16 v[240:243], a[128:131], a[16:19], 0
ds_read_b64_tr_b16 a[140:141], v11 offset:16384
v_mfma_f32_16x16x32_bf16 v[240:243], a[132:135], a[20:23], v[240:243]
v_mfma_f32_16x16x32_bf16 v[248:251], a[128:131], a[24:27], 0
ds_read_b64_tr_b16 a[142:143], v11 offset:18432
v_mfma_f32_16x16x32_bf16 v[248:251], a[132:135], a[28:31], v[248:251]
v_mfma_f32_16x16x32_bf16 a[224:227], a[128:131], a[32:35], 0
v_mfma_f32_16x16x32_bf16 a[224:227], a[132:135], a[36:39], a[224:227]
v_mfma_f32_16x16x32_bf16 a[232:235], a[128:131], a[40:43], 0
v_mfma_f32_16x16x32_bf16 a[232:235], a[132:135], a[44:47], a[232:235]
v_mfma_f32_16x16x32_bf16 a[240:243], a[128:131], a[48:51], 0
v_mfma_f32_16x16x32_bf16 a[240:243], a[132:135], a[52:55], a[240:243]
v_mfma_f32_16x16x32_bf16 a[248:251], a[128:131], a[56:59], 0
v_mfma_f32_16x16x32_bf16 a[248:251], a[132:135], a[60:63], a[248:251]
s_waitcnt vmcnt(6) lgkmcnt(0)
s_barrier
v_mfma_f32_16x16x32_bf16 v[228:231], a[136:139], a[0:3], 0
s_add_u32 m0, s29, 65536
ds_read_b64_tr_b16 a[128:129], v4 offset:32768
v_mfma_f32_16x16x32_bf16 v[228:231], a[140:143], a[4:7], v[228:231]
buffer_load_dwordx4 v16, s[12:15], s26 offen offset:0 lds
v_mfma_f32_16x16x32_bf16 v[236:239], a[136:139], a[8:11], 0
ds_read_b64_tr_b16 a[130:131], v4 offset:34816
v_mfma_f32_16x16x32_bf16 v[236:239], a[140:143], a[12:15], v[236:239]
v_mfma_f32_16x16x32_bf16 v[244:247], a[136:139], a[16:19], 0
ds_read_b64_tr_b16 a[132:133], v4 offset:49152
v_mfma_f32_16x16x32_bf16 v[244:247], a[140:143], a[20:23], v[244:247]
buffer_load_dwordx4 v17, s[12:15], s26 offen offset:1024 lds
v_mfma_f32_16x16x32_bf16 v[252:255], a[136:139], a[24:27], 0
ds_read_b64_tr_b16 a[134:135], v4 offset:51200
v_mfma_f32_16x16x32_bf16 v[252:255], a[140:143], a[28:31], v[252:255]
v_mfma_f32_16x16x32_bf16 a[228:231], a[136:139], a[32:35], 0
v_mfma_f32_16x16x32_bf16 a[228:231], a[140:143], a[36:39], a[228:231]
buffer_load_dwordx4 v18, s[12:15], s26 offen offset:2048 lds
v_mfma_f32_16x16x32_bf16 a[236:239], a[136:139], a[40:43], 0
v_mfma_f32_16x16x32_bf16 a[236:239], a[140:143], a[44:47], a[236:239]
v_mfma_f32_16x16x32_bf16 a[244:247], a[136:139], a[48:51], 0
v_mfma_f32_16x16x32_bf16 a[244:247], a[140:143], a[52:55], a[244:247]
buffer_load_dwordx4 v19, s[12:15], s26 offen offset:3072 lds
v_mfma_f32_16x16x32_bf16 a[252:255], a[136:139], a[56:59], 0
s_add_u32 s26, s26, 524288
v_mfma_f32_16x16x32_bf16 a[252:255], a[140:143], a[60:63], a[252:255]
s_waitcnt lgkmcnt(2)
Lg_1:
v_mfma_f32_16x16x32_bf16 v[32:35], a[128:131], a[64:67], v[32:35]
s_waitcnt lgkmcnt(0)
s_add_u32 m0, s29, 81920
ds_read_b64_tr_b16 a[136:137], v5 offset:32768
v_mfma_f32_16x16x32_bf16 v[32:35], a[132:135], a[68:71], v[32:35]
buffer_load_dwordx4 v16, s[12:15], s27 offen offset:0 lds
v_mfma_f32_16x16x32_bf16 v[40:43], a[128:131], a[72:75], v[40:43]
ds_read_b64_tr_b16 a[138:139], v5 offset:34816
v_mfma_f32_16x16x32_bf16 v[40:43], a[132:135], a[76:79], v[40:43]
v_mfma_f32_16x16x32_bf16 v[48:51], a[128:131], a[80:83], v[48:51]
ds_read_b64_tr_b16 a[140:141], v5 offset:49152
v_mfma_f32_16x16x32_bf16 v[48:51], a[132:135], a[84:87], v[48:51]
buffer_load_dwordx4 v17, s[12:15], s27 offen offset:1024 lds
v_mfma_f32_16x16x32_bf16 v[56:59], a[128:131], a[88:91], v[56:59]
ds_read_b64_tr_b16 a[142:143], v5 offset:51200
v_mfma_f32_16x16x32_bf16 v[56:59], a[132:135], a[92:95], v[56:59]
v_mfma_f32_16x16x32_bf16 v[64:67], a[128:131], a[96:99], v[64:67]
ds_read_b128 a[0:3], v2 offset:0
v_mfma_f32_16x16x32_bf16 v[64:67], a[132:135], a[100:103], v[64:67]
buffer_load_dwordx4 v18, s[12:15], s27 offen offset:2048 lds
v_mfma_f32_16x16x32_bf16 v[72:75], a[128:131], a[104:107], v[72:75]
ds_read_b128 a[4:7], v3 offset:0
v_mfma_f32_16x16x32_bf16 v[72:75], a[132:135], a[108:111], v[72:75]
v_mfma_f32_16x16x32_bf16 v[80:83], a[128:131], a[112:115], v[80:83]
v_mfma_f32_16x16x32_bf16 v[80:83], a[132:135], a[116:119], v[80:83]
buffer_load_dwordx4 v19, s[12:15], s27 offen offset:3072 lds
v_mfma_f32_16x16x32_bf16 v[88:91], a[128:131], a[120:123], v[88:91]
s_add_u32 s27, s27, 524288
ds_read_b128 a[8:11], v2 offset:2048
v_mfma_f32_16x16x32_bf16 v[88:91], a[132:135], a[124:127], v[88:91]
s_waitcnt lgkmcnt(5)
v_mfma_f32_16x16x32_bf16 v[36:39], a[136:139], a[64:67], v[36:39]
s_waitcnt lgkmcnt(3)
s_add_u32 m0, s28, 32768
ds_read_b64_tr_b16 a[128:129], v6 offset:32768
v_mfma_f32_16x16x32_bf16 v[36:39], a[140:143], a[68:71], v[36:39]
buffer_load_dwordx4 v12, s[8:11], s24 offen offset:0 lds
v_mfma_f32_16x16x32_bf16 v[44:47], a[136:139], a[72:75], v[44:47]
ds_read_b64_tr_b16 a[130:131], v6 offset:34816
v_mfma_f32_16x16x32_bf16 v[44:47], a[140:143], a[76:79], v[44:47]
v_mfma_f32_16x16x32_bf16 v[52:55], a[136:139], a[80:83], v[52:55]
ds_read_b64_tr_b16 a[132:133], v6 offset:49152
v_mfma_f32_16x16x32_bf16 v[52:55], a[140:143], a[84:87], v[52:55]
buffer_load_dwordx4 v13, s[8:11], s24 offen offset:1024 lds
v_mfma_f32_16x16x32_bf16 v[60:63], a[136:139], a[88:91], v[60:63]
ds_read_b64_tr_b16 a[134:135], v6 offset:51200
v_mfma_f32_16x16x32_bf16 v[60:63], a[140:143], a[92:95], v[60:63]
v_mfma_f32_16x16x32_bf16 v[68:71], a[136:139], a[96:99], v[68:71]
ds_read_b128 a[12:15], v3 offset:2048
v_mfma_f32_16x16x32_bf16 v[68:71], a[140:143], a[100:103], v[68:71]
buffer_load_dwordx4 v14, s[8:11], s24 offen offset:2048 lds
v_mfma_f32_16x16x32_bf16 v[76:79], a[136:139], a[104:107], v[76:79]
v_mfma_f32_16x16x32_bf16 v[76:79], a[140:143], a[108:111], v[76:79]
v_mfma_f32_16x16x32_bf16 v[84:87], a[136:139], a[112:115], v[84:87]
ds_read_b128 a[16:19], v2 offset:4096
v_mfma_f32_16x16x32_bf16 v[84:87], a[140:143], a[116:119], v[84:87]
buffer_load_dwordx4 v15, s[8:11], s24 offen offset:3072 lds
v_mfma_f32_16x16x32_bf16 v[92:95], a[136:139], a[120:123], v[92:95]
s_add_u32 s24, s24, 128
ds_read_b128 a[20:23], v3 offset:4096
v_mfma_f32_16x16x32_bf16 v[92:95], a[140:143], a[124:127], v[92:95]
s_waitcnt lgkmcnt(5)
v_mfma_f32_16x16x32_bf16 v[96:99], a[128:131], a[64:67], v[96:99]
s_waitcnt lgkmcnt(3)
s_add_u32 m0, s28, 36864
ds_read_b64_tr_b16 a[136:137], v7 offset:32768
v_mfma_f32_16x16x32_bf16 v[96:99], a[132:135], a[68:71], v[96:99]
buffer_load_dwordx4 v12, s[8:11], s25 offen offset:0 lds
v_mfma_f32_16x16x32_bf16 v[104:107], a[128:131], a[72:75], v[104:107]
ds_read_b64_tr_b16 a[138:139], v7 offset:34816
v_mfma_f32_16x16x32_bf16 v[104:107], a[132:135], a[76:79], v[104:107]
v_mfma_f32_16x16x32_bf16 v[112:115], a[128:131], a[80:83], v[112:115]
ds_read_b64_tr_b16 a[140:141], v7 offset:49152
v_mfma_f32_16x16x32_bf16 v[112:115], a[132:135], a[84:87], v[112:115]
buffer_load_dwordx4 v13, s[8:11], s25 offen offset:1024 lds
v_mfma_f32_16x16x32_bf16 v[120:123], a[128:131], a[88:91], v[120:123]
ds_read_b64_tr_b16 a[142:143], v7 offset:51200
v_mfma_f32_16x16x32_bf16 v[120:123], a[132:135], a[92:95], v[120:123]
v_mfma_f32_16x16x32_bf16 v[128:131], a[128:131], a[96:99], v[128:131]
v_mfma_f32_16x16x32_bf16 v[128:131], a[132:135], a[100:103], v[128:131]
buffer_load_dwordx4 v14, s[8:11], s25 offen offset:2048 lds
v_mfma_f32_16x16x32_bf16 v[136:139], a[128:131], a[104:107], v[136:139]
ds_read_b128 a[24:27], v2 offset:6144
v_mfma_f32_16x16x32_bf16 v[136:139], a[132:135], a[108:111], v[136:139]
v_mfma_f32_16x16x32_bf16 v[144:147], a[128:131], a[112:115], v[144:147]
ds_read_b128 a[28:31], v3 offset:6144
v_mfma_f32_16x16x32_bf16 v[144:147], a[132:135], a[116:119], v[144:147]
buffer_load_dwordx4 v15, s[8:11], s25 offen offset:3072 lds
v_mfma_f32_16x16x32_bf16 v[152:155], a[128:131], a[120:123], v[152:155]
s_add_u32 s25, s25, 128
v_mfma_f32_16x16x32_bf16 v[152:155], a[132:135], a[124:127], v[152:155]
s_waitcnt lgkmcnt(4)
buffer_load_dword v21, v20, s[16:19], s43 offen
v_mfma_f32_16x16x32_bf16 v[100:103], a[136:139], a[64:67], v[100:103]
s_waitcnt lgkmcnt(2)
s_add_u32 s43, s43, s47
ds_read_b64_tr_b16 a[128:129], v8 offset:32768
v_mfma_f32_16x16x32_bf16 v[100:103], a[140:143], a[68:71], v[100:103]
s_cmp_ge_u32 s43, s51
v_mfma_f32_16x16x32_bf16 v[108:111], a[136:139], a[72:75], v[108:111]
s_cselect_b32 s43, 0, s43
ds_read_b64_tr_b16 a[130:131], v8 offset:34816
v_mfma_f32_16x16x32_bf16 v[108:111], a[140:143], a[76:79], v[108:111]
s_cselect_b32 s51, s42, s51
v_mfma_f32_16x16x32_bf16 v[116:119], a[136:139], a[80:83], v[116:119]
s_cselect_b64 s[16:17], s[40:41], s[16:17]
ds_read_b64_tr_b16 a[132:133], v8 offset:49152
v_mfma_f32_16x16x32_bf16 v[116:119], a[140:143], a[84:87], v[116:119]
s_cselect_b32 s18, s42, s18
v_mfma_f32_16x16x32_bf16 v[124:127], a[136:139], a[88:91], v[124:127]
s_cselect_b64 s[40:41], s[44:45], s[40:41]
ds_read_b64_tr_b16 a[134:135], v8 offset:51200
v_mfma_f32_16x16x32_bf16 v[124:127], a[140:143], a[92:95], v[124:127]
s_cselect_b32 s42, s46, s42
v_mfma_f32_16x16x32_bf16 v[132:135], a[136:139], a[96:99], v[132:135]
s_cselect_b64 s[44:45], s[48:49], s[44:45]
ds_read_b128 a[32:35], v2 offset:8192
v_mfma_f32_16x16x32_bf16 v[132:135], a[140:143], a[100:103], v[132:135]
s_cselect_b32 s46, s50, s46
v_mfma_f32_16x16x32_bf16 v[140:143], a[136:139], a[104:107], v[140:143]
s_cselect_b64 s[48:49], s[52:53], s[48:49]
v_mfma_f32_16x16x32_bf16 v[140:143], a[140:143], a[108:111], v[140:143]
s_cselect_b32 s50, s54, s50
v_mfma_f32_16x16x32_bf16 v[148:151], a[136:139], a[112:115], v[148:151]
s_cselect_b32 s54, 0, s54
ds_read_b128 a[36:39], v3 offset:8192
v_mfma_f32_16x16x32_bf16 v[148:151], a[140:143], a[116:119], v[148:151]
v_mfma_f32_16x16x32_bf16 v[156:159], a[136:139], a[120:123], v[156:159]
ds_read_b128 a[40:43], v2 offset:10240
v_mfma_f32_16x16x32_bf16 v[156:159], a[140:143], a[124:127], v[156:159]
s_waitcnt lgkmcnt(5)
v_mfma_f32_16x16x32_bf16 v[160:163], a[128:131], a[64:67], v[160:163]
s_waitcnt lgkmcnt(3)
ds_read_b64_tr_b16 a[136:137], v9 offset:32768
v_mfma_f32_16x16x32_bf16 v[160:163], a[132:135], a[68:71], v[160:163]
v_mfma_f32_16x16x32_bf16 v[168:171], a[128:131], a[72:75], v[168:171]
ds_read_b64_tr_b16 a[138:139], v9 offset:34816
v_mfma_f32_16x16x32_bf16 v[168:171], a[132:135], a[76:79], v[168:171]
v_mfma_f32_16x16x32_bf16 v[176:179], a[128:131], a[80:83], v[176:179]
ds_read_b64_tr_b16 a[140:141], v9 offset:49152
v_mfma_f32_16x16x32_bf16 v[176:179], a[132:135], a[84:87], v[176:179]
v_mfma_f32_16x16x32_bf16 v[184:187], a[128:131], a[88:91], v[184:187]
ds_read_b64_tr_b16 a[142:143], v9 offset:51200
v_mfma_f32_16x16x32_bf16 v[184:187], a[132:135], a[92:95], v[184:187]
v_mfma_f32_16x16x32_bf16 v[192:195], a[128:131], a[96:99], v[192:195]
v_mfma_f32_16x16x32_bf16 v[192:195], a[132:135], a[100:103], v[192:195]
v_mfma_f32_16x16x32_bf16 v[200:203], a[128:131], a[104:107], v[200:203]
ds_read_b128 a[44:47], v3 offset:10240
v_mfma_f32_16x16x32_bf16 v[200:203], a[132:135], a[108:111], v[200:203]
v_mfma_f32_16x16x32_bf16 v[208:211], a[128:131], a[112:115], v[208:211]
ds_read_b128 a[48:51], v2 offset:12288
v_mfma_f32_16x16x32_bf16 v[208:211], a[132:135], a[116:119], v[208:211]
v_mfma_f32_16x16x32_bf16 v[216:219], a[128:131], a[120:123], v[216:219]
v_mfma_f32_16x16x32_bf16 v[216:219], a[132:135], a[124:127], v[216:219]
s_waitcnt lgkmcnt(4)
v_mfma_f32_16x16x32_bf16 v[164:167], a[136:139], a[64:67], v[164:167]
s_waitcnt lgkmcnt(2)
ds_read_b64_tr_b16 a[128:129], v10 offset:32768
v_mfma_f32_16x16x32_bf16 v[164:167], a[140:143], a[68:71], v[164:167]
v_mfma_f32_16x16x32_bf16 v[172:175], a[136:139], a[72:75], v[172:175]
ds_read_b64_tr_b16 a[130:131], v10 offset:34816
v_mfma_f32_16x16x32_bf16 v[172:175], a[140:143], a[76:79], v[172:175]
v_mfma_f32_16x16x32_bf16 v[180:183], a[136:139], a[80:83], v[180:183]
ds_read_b64_tr_b16 a[132:133], v10 offset:49152
v_mfma_f32_16x16x32_bf16 v[180:183], a[140:143], a[84:87], v[180:183]
v_mfma_f32_16x16x32_bf16 v[188:191], a[136:139], a[88:91], v[188:191]
ds_read_b64_tr_b16 a[134:135], v10 offset:51200
v_mfma_f32_16x16x32_bf16 v[188:191], a[140:143], a[92:95], v[188:191]
v_mfma_f32_16x16x32_bf16 v[196:199], a[136:139], a[96:99], v[196:199]
ds_read_b128 a[52:55], v3 offset:12288
v_mfma_f32_16x16x32_bf16 v[196:199], a[140:143], a[100:103], v[196:199]
v_mfma_f32_16x16x32_bf16 v[204:207], a[136:139], a[104:107], v[204:207]
ds_read_b128 a[56:59], v2 offset:14336
v_mfma_f32_16x16x32_bf16 v[204:207], a[140:143], a[108:111], v[204:207]
v_mfma_f32_16x16x32_bf16 v[212:215], a[136:139], a[112:115], v[212:215]
v_mfma_f32_16x16x32_bf16 v[212:215], a[140:143], a[116:119], v[212:215]
v_mfma_f32_16x16x32_bf16 v[220:223], a[136:139], a[120:123], v[220:223]
ds_read_b128 a[60:63], v3 offset:14336
v_mfma_f32_16x16x32_bf16 v[220:223], a[140:143], a[124:127], v[220:223]
s_waitcnt lgkmcnt(5)
v_mfma_f32_16x16x32_bf16 v[224:227], a[128:131], a[64:67], v[224:227]
s_waitcnt lgkmcnt(3)
ds_read_b64_tr_b16 a[136:137], v11 offset:32768
v_mfma_f32_16x16x32_bf16 v[224:227], a[132:135], a[68:71], v[224:227]
v_mfma_f32_16x16x32_bf16 v[232:235], a[128:131], a[72:75], v[232:235]
ds_read_b64_tr_b16 a[138:139], v11 offset:34816
v_mfma_f32_16x16x32_bf16 v[232:235], a[132:135], a[76:79], v[232:235]
v_mfma_f32_16x16x32_bf16 v[240:243], a[128:131], a[80:83], v[240:243]
ds_read_b64_tr_b16 a[140:141], v11 offset:49152
v_mfma_f32_16x16x32_bf16 v[240:243], a[132:135], a[84:87], v[240:243]
v_mfma_f32_16x16x32_bf16 v[248:251], a[128:131], a[88:91], v[248:251]
ds_read_b64_tr_b16 a[142:143], v11 offset:51200
v_mfma_f32_16x16x32_bf16 v[248:251], a[132:135], a[92:95], v[248:251]
v_mfma_f32_16x16x32_bf16 a[224:227], a[128:131], a[96:99], a[224:227]
v_mfma_f32_16x16x32_bf16 a[224:227], a[132:135], a[100:103], a[224:227]
v_mfma_f32_16x16x32_bf16 a[232:235], a[128:131], a[104:107], a[232:235]
v_mfma_f32_16x16x32_bf16 a[232:235], a[132:135], a[108:111], a[232:235]
v_mfma_f32_16x16x32_bf16 a[240:243], a[128:131], a[112:115], a[240:243]
v_mfma_f32_16x16x32_bf16 a[240:243], a[132:135], a[116:119], a[240:243]
v_mfma_f32_16x16x32_bf16 a[248:251], a[128:131], a[120:123], a[248:251]
v_mfma_f32_16x16x32_bf16 a[248:251], a[132:135], a[124:127], a[248:251]
s_waitcnt vmcnt(1) lgkmcnt(0)
s_barrier
v_mfma_f32_16x16x32_bf16 v[228:231], a[136:139], a[64:67], v[228:231]
s_add_u32 m0, s29, 98304
ds_read_b64_tr_b16 a[128:129], v4 offset:0
v_mfma_f32_16x16x32_bf16 v[228:231], a[140:143], a[68:71], v[228:231]
buffer_load_dwordx4 v16, s[12:15], s26 offen offset:0 lds
v_mfma_f32_16x16x32_bf16 v[236:239], a[136:139], a[72:75], v[236:239]
ds_read_b64_tr_b16 a[130:131], v4 offset:2048
v_mfma_f32_16x16x32_bf16 v[236:239], a[140:143], a[76:79], v[236:239]
v_mfma_f32_16x16x32_bf16 v[244:247], a[136:139], a[80:83], v[244:247]
ds_read_b64_tr_b16 a[132:133], v4 offset:16384
v_mfma_f32_16x16x32_bf16 v[244:247], a[140:143], a[84:87], v[244:247]
buffer_load_dwordx4 v17, s[12:15], s26 offen offset:1024 lds
v_mfma_f32_16x16x32_bf16 v[252:255], a[136:139], a[88:91], v[252:255]
ds_read_b64_tr_b16 a[134:135], v4 offset:18432
v_mfma_f32_16x16x32_bf16 v[252:255], a[140:143], a[92:95], v[252:255]
v_mfma_f32_16x16x32_bf16 a[228:231], a[136:139], a[96:99], a[228:231]
v_mfma_f32_16x16x32_bf16 a[228:231], a[140:143], a[100:103], a[228:231]
buffer_load_dwordx4 v18, s[12:15], s26 offen offset:2048 lds
v_mfma_f32_16x16x32_bf16 a[236:239], a[136:139], a[104:107], a[236:239]
v_mfma_f32_16x16x32_bf16 a[236:239], a[140:143], a[108:111], a[236:239]
v_mfma_f32_16x16x32_bf16 a[244:247], a[136:139], a[112:115], a[244:247]
v_mfma_f32_16x16x32_bf16 a[244:247], a[140:143], a[116:119], a[244:247]
buffer_load_dwordx4 v19, s[12:15], s26 offen offset:3072 lds
v_mfma_f32_16x16x32_bf16 a[252:255], a[136:139], a[120:123], a[252:255]
s_add_u32 s26, s26, 524288
v_mfma_f32_16x16x32_bf16 a[252:255], a[140:143], a[124:127], a[252:255]
s_waitcnt lgkmcnt(2)
v_mfma_f32_16x16x32_bf16 v[32:35], a[128:131], a[0:3], v[32:35]
s_waitcnt lgkmcnt(0)
s_add_u32 m0, s29, 114688
ds_read_b64_tr_b16 a[136:137], v5 offset:0
v_mfma_f32_16x16x32_bf16 v[32:35], a[132:135], a[4:7], v[32:35]
buffer_load_dwordx4 v16, s[12:15], s27 offen offset:0 lds
v_mfma_f32_16x16x32_bf16 v[40:43], a[128:131], a[8:11], v[40:43]
ds_read_b64_tr_b16 a[138:139], v5 offset:2048
v_mfma_f32_16x16x32_bf16 v[40:43], a[132:135], a[12:15], v[40:43]
v_mfma_f32_16x16x32_bf16 v[48:51], a[128:131], a[16:19], v[48:51]
ds_read_b64_tr_b16 a[140:141], v5 offset:16384
v_mfma_f32_16x16x32_bf16 v[48:51], a[132:135], a[20:23], v[48:51]
buffer_load_dwordx4 v17, s[12:15], s27 offen offset:1024 lds
v_mfma_f32_16x16x32_bf16 v[56:59], a[128:131], a[24:27], v[56:59]
ds_read_b64_tr_b16 a[142:143], v5 offset:18432
v_mfma_f32_16x16x32_bf16 v[56:59], a[132:135], a[28:31], v[56:59]
v_mfma_f32_16x16x32_bf16 v[64:67], a[128:131], a[32:35], v[64:67]
ds_read_b128 a[64:67], v2 offset:32768
v_mfma_f32_16x16x32_bf16 v[64:67], a[132:135], a[36:39], v[64:67]
buffer_load_dwordx4 v18, s[12:15], s27 offen offset:2048 lds
v_mfma_f32_16x16x32_bf16 v[72:75], a[128:131], a[40:43], v[72:75]
ds_read_b128 a[68:71], v3 offset:32768
v_mfma_f32_16x16x32_bf16 v[72:75], a[132:135], a[44:47], v[72:75]
v_mfma_f32_16x16x32_bf16 v[80:83], a[128:131], a[48:51], v[80:83]
v_mfma_f32_16x16x32_bf16 v[80:83], a[132:135], a[52:55], v[80:83]
buffer_load_dwordx4 v19, s[12:15], s27 offen offset:3072 lds
v_mfma_f32_16x16x32_bf16 v[88:91], a[128:131], a[56:59], v[88:91]
s_add_u32 s27, s27, 524288
ds_read_b128 a[72:75], v2 offset:34816
v_mfma_f32_16x16x32_bf16 v[88:91], a[132:135], a[60:63], v[88:91]
s_waitcnt lgkmcnt(5)
v_mfma_f32_16x16x32_bf16 v[36:39], a[136:139], a[0:3], v[36:39]
s_waitcnt lgkmcnt(3)
s_add_u32 m0, s28, 0
ds_read_b64_tr_b16 a[128:129], v6 offset:0
v_mfma_f32_16x16x32_bf16 v[36:39], a[140:143], a[4:7], v[36:39]
buffer_load_dwordx4 v12, s[8:11], s24 offen offset:0 lds
v_mfma_f32_16x16x32_bf16 v[44:47], a[136:139], a[8:11], v[44:47]
ds_read_b64_tr_b16 a[130:131], v6 offset:2048
v_mfma_f32_16x16x32_bf16 v[44:47], a[140:143], a[12:15], v[44:47]
v_mfma_f32_16x16x32_bf16 v[52:55], a[136:139], a[16:19], v[52:55]
ds_read_b64_tr_b16 a[132:133], v6 offset:16384
v_mfma_f32_16x16x32_bf16 v[52:55], a[140:143], a[20:23], v[52:55]
buffer_load_dwordx4 v13, s[8:11], s24 offen offset:1024 lds
v_mfma_f32_16x16x32_bf16 v[60:63], a[136:139], a[24:27], v[60:63]
ds_read_b64_tr_b16 a[134:135], v6 offset:18432
v_mfma_f32_16x16x32_bf16 v[60:63], a[140:143], a[28:31], v[60:63]
v_mfma_f32_16x16x32_bf16 v[68:71], a[136:139], a[32:35], v[68:71]
ds_read_b128 a[76:79], v3 offset:34816
v_mfma_f32_16x16x32_bf16 v[68:71], a[140:143], a[36:39], v[68:71]
buffer_load_dwordx4 v14, s[8:11], s24 offen offset:2048 lds
v_mfma_f32_16x16x32_bf16 v[76:79], a[136:139], a[40:43], v[76:79]
v_mfma_f32_16x16x32_bf16 v[76:79], a[140:143], a[44:47], v[76:79]
v_mfma_f32_16x16x32_bf16 v[84:87], a[136:139], a[48:51], v[84:87]
ds_read_b128 a[80:83], v2 offset:36864
v_mfma_f32_16x16x32_bf16 v[84:87], a[140:143], a[52:55], v[84:87]
buffer_load_dwordx4 v15, s[8:11], s24 offen offset:3072 lds
v_mfma_f32_16x16x32_bf16 v[92:95], a[136:139], a[56:59], v[92:95]
s_add_u32 s24, s24, 128
ds_read_b128 a[84:87], v3 offset:36864
v_mfma_f32_16x16x32_bf16 v[92:95], a[140:143], a[60:63], v[92:95]
s_waitcnt lgkmcnt(5)
v_mfma_f32_16x16x32_bf16 v[96:99], a[128:131], a[0:3], v[96:99]
s_waitcnt lgkmcnt(3)
s_add_u32 m0, s28, 4096
ds_read_b64_tr_b16 a[136:137], v7 offset:0
v_mfma_f32_16x16x32_bf16 v[96:99], a[132:135], a[4:7], v[96:99]
buffer_load_dwordx4 v12, s[8:11], s25 offen offset:0 lds
v_mfma_f32_16x16x32_bf16 v[104:107], a[128:131], a[8:11], v[104:107]
ds_read_b64_tr_b16 a[138:139], v7 offset:2048
v_mfma_f32_16x16x32_bf16 v[104:107], a[132:135], a[12:15], v[104:107]
v_mfma_f32_16x16x32_bf16 v[112:115], a[128:131], a[16:19], v[112:115]
ds_read_b64_tr_b16 a[140:141], v7 offset:16384
v_mfma_f32_16x16x32_bf16 v[112:115], a[132:135], a[20:23], v[112:115]
buffer_load_dwordx4 v13, s[8:11], s25 offen offset:1024 lds
v_mfma_f32_16x16x32_bf16 v[120:123], a[128:131], a[24:27], v[120:123]
ds_read_b64_tr_b16 a[142:143], v7 offset:18432
v_mfma_f32_16x16x32_bf16 v[120:123], a[132:135], a[28:31], v[120:123]
v_mfma_f32_16x16x32_bf16 v[128:131], a[128:131], a[32:35], v[128:131]
v_mfma_f32_16x16x32_bf16 v[128:131], a[132:135], a[36:39], v[128:131]
buffer_load_dwordx4 v14, s[8:11], s25 offen offset:2048 lds
v_mfma_f32_16x16x32_bf16 v[136:139], a[128:131], a[40:43], v[136:139]
ds_read_b128 a[88:91], v2 offset:38912
v_mfma_f32_16x16x32_bf16 v[136:139], a[132:135], a[44:47], v[136:139]
v_mfma_f32_16x16x32_bf16 v[144:147], a[128:131], a[48:51], v[144:147]
ds_read_b128 a[92:95], v3 offset:38912
v_mfma_f32_16x16x32_bf16 v[144:147], a[132:135], a[52:55], v[144:147]
buffer_load_dwordx4 v15, s[8:11], s25 offen offset:3072 lds
v_mfma_f32_16x16x32_bf16 v[152:155], a[128:131], a[56:59], v[152:155]
s_add_u32 s25, s25, 128
v_mfma_f32_16x16x32_bf16 v[152:155], a[132:135], a[60:63], v[152:155]
s_waitcnt lgkmcnt(4)
buffer_load_dword v21, v20, s[16:19], s43 offen
v_mfma_f32_16x16x32_bf16 v[100:103], a[136:139], a[0:3], v[100:103]
s_waitcnt lgkmcnt(2)
s_add_u32 s43, s43, s47
ds_read_b64_tr_b16 a[128:129], v8 offset:0
v_mfma_f32_16x16x32_bf16 v[100:103], a[140:143], a[4:7], v[100:103]
s_cmp_ge_u32 s43, s51
v_mfma_f32_16x16x32_bf16 v[108:111], a[136:139], a[8:11], v[108:111]
s_cselect_b32 s43, 0, s43
ds_read_b64_tr_b16 a[130:131], v8 offset:2048
v_mfma_f32_16x16x32_bf16 v[108:111], a[140:143], a[12:15], v[108:111]
s_cselect_b32 s51, s42, s51
v_mfma_f32_16x16x32_bf16 v[116:119], a[136:139], a[16:19], v[116:119]
s_cselect_b64 s[16:17], s[40:41], s[16:17]
ds_read_b64_tr_b16 a[132:133], v8 offset:16384
v_mfma_f32_16x16x32_bf16 v[116:119], a[140:143], a[20:23], v[116:119]
s_cselect_b32 s18, s42, s18
v_mfma_f32_16x16x32_bf16 v[124:127], a[136:139], a[24:27], v[124:127]
s_cselect_b64 s[40:41], s[44:45], s[40:41]
ds_read_b64_tr_b16 a[134:135], v8 offset:18432
v_mfma_f32_16x16x32_bf16 v[124:127], a[140:143], a[28:31], v[124:127]
s_cselect_b32 s42, s46, s42
v_mfma_f32_16x16x32_bf16 v[132:135], a[136:139], a[32:35], v[132:135]
s_cselect_b64 s[44:45], s[48:49], s[44:45]
ds_read_b128 a[96:99], v2 offset:40960
v_mfma_f32_16x16x32_bf16 v[132:135], a[140:143], a[36:39], v[132:135]
s_cselect_b32 s46, s50, s46
v_mfma_f32_16x16x32_bf16 v[140:143], a[136:139], a[40:43], v[140:143]
s_cselect_b64 s[48:49], s[52:53], s[48:49]
v_mfma_f32_16x16x32_bf16 v[140:143], a[140:143], a[44:47], v[140:143]
s_cselect_b32 s50, s54, s50
v_mfma_f32_16x16x32_bf16 v[148:151], a[136:139], a[48:51], v[148:151]
s_cselect_b32 s54, 0, s54
ds_read_b128 a[100:103], v3 offset:40960
v_mfma_f32_16x16x32_bf16 v[148:151], a[140:143], a[52:55], v[148:151]
v_mfma_f32_16x16x32_bf16 v[156:159], a[136:139], a[56:59], v[156:159]
ds_read_b128 a[104:107], v2 offset:43008
v_mfma_f32_16x16x32_bf16 v[156:159], a[140:143], a[60:63], v[156:159]
s_waitcnt lgkmcnt(5)
v_mfma_f32_16x16x32_bf16 v[160:163], a[128:131], a[0:3], v[160:163]
s_waitcnt lgkmcnt(3)
ds_read_b64_tr_b16 a[136:137], v9 offset:0
v_mfma_f32_16x16x32_bf16 v[160:163], a[132:135], a[4:7], v[160:163]
v_mfma_f32_16x16x32_bf16 v[168:171], a[128:131], a[8:11], v[168:171]
ds_read_b64_tr_b16 a[138:139], v9 offset:2048
v_mfma_f32_16x16x32_bf16 v[168:171], a[132:135], a[12:15], v[168:171]
v_mfma_f32_16x16x32_bf16 v[176:179], a[128:131], a[16:19], v[176:179]
ds_read_b64_tr_b16 a[140:141], v9 offset:16384
v_mfma_f32_16x16x32_bf16 v[176:179], a[132:135], a[20:23], v[176:179]
v_mfma_f32_16x16x32_bf16 v[184:187], a[128:131], a[24:27], v[184:187]
ds_read_b64_tr_b16 a[142:143], v9 offset:18432
v_mfma_f32_16x16x32_bf16 v[184:187], a[132:135], a[28:31], v[184:187]
v_mfma_f32_16x16x32_bf16 v[192:195], a[128:131], a[32:35], v[192:195]
v_mfma_f32_16x16x32_bf16 v[192:195], a[132:135], a[36:39], v[192:195]
v_mfma_f32_16x16x32_bf16 v[200:203], a[128:131], a[40:43], v[200:203]
ds_read_b128 a[108:111], v3 offset:43008
v_mfma_f32_16x16x32_bf16 v[200:203], a[132:135], a[44:47], v[200:203]
v_mfma_f32_16x16x32_bf16 v[208:211], a[128:131], a[48:51], v[208:211]
ds_read_b128 a[112:115], v2 offset:45056
v_mfma_f32_16x16x32_bf16 v[208:211], a[132:135], a[52:55], v[208:211]
v_mfma_f32_16x16x32_bf16 v[216:219], a[128:131], a[56:59], v[216:219]
v_mfma_f32_16x16x32_bf16 v[216:219], a[132:135], a[60:63], v[216:219]
s_waitcnt lgkmcnt(4)
v_mfma_f32_16x16x32_bf16 v[164:167], a[136:139], a[0:3], v[164:167]
s_waitcnt lgkmcnt(2)
ds_read_b64_tr_b16 a[128:129], v10 offset:0
v_mfma_f32_16x16x32_bf16 v[164:167], a[140:143], a[4:7], v[164:167]
v_mfma_f32_16x16x32_bf16 v[172:175], a[136:139], a[8:11], v[172:175]
ds_read_b64_tr_b16 a[130:131], v10 offset:2048
v_mfma_f32_16x16x32_bf16 v[172:175], a[140:143], a[12:15], v[172:175]
v_mfma_f32_16x16x32_bf16 v[180:183], a[136:139], a[16:19], v[180:183]
ds_read_b64_tr_b16 a[132:133], v10 offset:16384
v_mfma_f32_16x16x32_bf16 v[180:183], a[140:143], a[20:23], v[180:183]
v_mfma_f32_16x16x32_bf16 v[188:191], a[136:139], a[24:27], v[188:191]
ds_read_b64_tr_b16 a[134:135], v10 offset:18432
v_mfma_f32_16x16x32_bf16 v[188:191], a[140:143], a[28:31], v[188:191]
v_mfma_f32_16x16x32_bf16 v[196:199], a[136:139], a[32:35], v[196:199]
ds_read_b128 a[116:119], v3 offset:45056
v_mfma_f32_16x16x32_bf16 v[196:199], a[140:143], a[36:39], v[196:199]
v_mfma_f32_16x16x32_bf16 v[204:207], a[136:139], a[40:43], v[204:207]
ds_read_b128 a[120:123], v2 offset:47104
v_mfma_f32_16x16x32_bf16 v[204:207], a[140:143], a[44:47], v[204:207]
v_mfma_f32_16x16x32_bf16 v[212:215], a[136:139], a[48:51], v[212:215]
v_mfma_f32_16x16x32_bf16 v[212:215], a[140:143], a[52:55], v[212:215]
v_mfma_f32_16x16x32_bf16 v[220:223], a[136:139], a[56:59], v[220:223]
ds_read_b128 a[124:127], v3 offset:47104
v_mfma_f32_16x16x32_bf16 v[220:223], a[140:143], a[60:63], v[220:223]
s_waitcnt lgkmcnt(5)
v_mfma_f32_16x16x32_bf16 v[224:227], a[128:131], a[0:3], v[224:227]
s_waitcnt lgkmcnt(3)
ds_read_b64_tr_b16 a[136:137], v11 offset:0
v_mfma_f32_16x16x32_bf16 v[224:227], a[132:135], a[4:7], v[224:227]
v_mfma_f32_16x16x32_bf16 v[232:235], a[128:131], a[8:11], v[232:235]
ds_read_b64_tr_b16 a[138:139], v11 offset:2048
v_mfma_f32_16x16x32_bf16 v[232:235], a[132:135], a[12:15], v[232:235]
v_mfma_f32_16x16x32_bf16 v[240:243], a[128:131], a[16:19], v[240:243]
s_sub_u32 s30, s30, 1
ds_read_b64_tr_b16 a[140:141], v11 offset:16384
v_mfma_f32_16x16x32_bf16 v[240:243], a[132:135], a[20:23], v[240:243]
s_cmp_eq_u32 s30, s55
v_mfma_f32_16x16x32_bf16 v[248:251], a[128:131], a[24:27], v[248:251]
s_cselect_b32 s22, 0, 3221225472
ds_read_b64_tr_b16 a[142:143], v11 offset:18432
v_mfma_f32_16x16x32_bf16 v[248:251], a[132:135], a[28:31], v[248:251]
v_mfma_f32_16x16x32_bf16 a[224:227], a[128:131], a[32:35], a[224:227]
v_mfma_f32_16x16x32_bf16 a[224:227], a[132:135], a[36:39], a[224:227]
v_mfma_f32_16x16x32_bf16 a[232:235], a[128:131], a[40:43], a[232:235]
v_mfma_f32_16x16x32_bf16 a[232:235], a[132:135], a[44:47], a[232:235]
v_mfma_f32_16x16x32_bf16 a[240:243], a[128:131], a[48:51], a[240:243]
v_mfma_f32_16x16x32_bf16 a[240:243], a[132:135], a[52:55], a[240:243]
v_mfma_f32_16x16x32_bf16 a[248:251], a[128:131], a[56:59], a[248:251]
v_mfma_f32_16x16x32_bf16 a[248:251], a[132:135], a[60:63], a[248:251]
s_waitcnt vmcnt(1) lgkmcnt(0)
s_barrier
v_mfma_f32_16x16x32_bf16 v[228:231], a[136:139], a[0:3], v[228:231]
s_add_u32 m0, s29, 65536
ds_read_b64_tr_b16 a[128:129], v4 offset:32768
v_mfma_f32_16x16x32_bf16 v[228:231], a[140:143], a[4:7], v[228:231]
buffer_load_dwordx4 v16, s[12:15], s26 offen offset:0 lds
v_mfma_f32_16x16x32_bf16 v[236:239], a[136:139], a[8:11], v[236:239]
ds_read_b64_tr_b16 a[130:131], v4 offset:34816
v_mfma_f32_16x16x32_bf16 v[236:239], a[140:143], a[12:15], v[236:239]
v_mfma_f32_16x16x32_bf16 v[244:247], a[136:139], a[16:19], v[244:247]
ds_read_b64_tr_b16 a[132:133], v4 offset:49152
v_mfma_f32_16x16x32_bf16 v[244:247], a[140:143], a[20:23], v[244:247]
buffer_load_dwordx4 v17, s[12:15], s26 offen offset:1024 lds
v_mfma_f32_16x16x32_bf16 v[252:255], a[136:139], a[24:27], v[252:255]
ds_read_b64_tr_b16 a[134:135], v4 offset:51200
v_mfma_f32_16x16x32_bf16 v[252:255], a[140:143], a[28:31], v[252:255]
v_mfma_f32_16x16x32_bf16 a[228:231], a[136:139], a[32:35], a[228:231]
v_mfma_f32_16x16x32_bf16 a[228:231], a[140:143], a[36:39], a[228:231]
buffer_load_dwordx4 v18, s[12:15], s26 offen offset:2048 lds
v_mfma_f32_16x16x32_bf16 a[236:239], a[136:139], a[40:43], a[236:239]
v_mfma_f32_16x16x32_bf16 a[236:239], a[140:143], a[44:47], a[236:239]
v_mfma_f32_16x16x32_bf16 a[244:247], a[136:139], a[48:51], a[244:247]
v_mfma_f32_16x16x32_bf16 a[244:247], a[140:143], a[52:55], a[244:247]
buffer_load_dwordx4 v19, s[12:15], s26 offen offset:3072 lds
v_mfma_f32_16x16x32_bf16 a[252:255], a[136:139], a[56:59], a[252:255]
s_add_u32 s26, s26, 524288
v_mfma_f32_16x16x32_bf16 a[252:255], a[140:143], a[60:63], a[252:255]
s_waitcnt lgkmcnt(2)
buffer_atomic_add v27, v26, s[60:63], s22 offen sc1
s_cmp_lg_u32 s30, 0
s_cbranch_scc1 Lg_1
v_mfma_f32_16x16x32_bf16 v[32:35], a[128:131], a[64:67], v[32:35]
s_waitcnt lgkmcnt(0)
s_add_u32 m0, s29, 81920
ds_read_b64_tr_b16 a[136:137], v5 offset:32768
v_mfma_f32_16x16x32_bf16 v[32:35], a[132:135], a[68:71], v[32:35]
buffer_load_dwordx4 v16, s[12:15], s27 offen offset:0 lds
v_mfma_f32_16x16x32_bf16 v[40:43], a[128:131], a[72:75], v[40:43]
ds_read_b64_tr_b16 a[138:139], v5 offset:34816
v_mfma_f32_16x16x32_bf16 v[40:43], a[132:135], a[76:79], v[40:43]
v_mfma_f32_16x16x32_bf16 v[48:51], a[128:131], a[80:83], v[48:51]
ds_read_b64_tr_b16 a[140:141], v5 offset:49152
v_mfma_f32_16x16x32_bf16 v[48:51], a[132:135], a[84:87], v[48:51]
buffer_load_dwordx4 v17, s[12:15], s27 offen offset:1024 lds
v_mfma_f32_16x16x32_bf16 v[56:59], a[128:131], a[88:91], v[56:59]
ds_read_b64_tr_b16 a[142:143], v5 offset:51200
v_mfma_f32_16x16x32_bf16 v[56:59], a[132:135], a[92:95], v[56:59]
v_mfma_f32_16x16x32_bf16 v[64:67], a[128:131], a[96:99], v[64:67]
ds_read_b128 a[0:3], v2 offset:0
v_mfma_f32_16x16x32_bf16 v[64:67], a[132:135], a[100:103], v[64:67]
buffer_load_dwordx4 v18, s[12:15], s27 offen offset:2048 lds
v_mfma_f32_16x16x32_bf16 v[72:75], a[128:131], a[104:107], v[72:75]
ds_read_b128 a[4:7], v3 offset:0
v_mfma_f32_16x16x32_bf16 v[72:75], a[132:135], a[108:111], v[72:75]
v_mfma_f32_16x16x32_bf16 v[80:83], a[128:131], a[112:115], v[80:83]
v_mfma_f32_16x16x32_bf16 v[80:83], a[132:135], a[116:119], v[80:83]
buffer_load_dwordx4 v19, s[12:15], s27 offen offset:3072 lds
v_mfma_f32_16x16x32_bf16 v[88:91], a[128:131], a[120:123], v[88:91]
s_add_u32 s27, s27, 524288
ds_read_b128 a[8:11], v2 offset:2048
v_mfma_f32_16x16x32_bf16 v[88:91], a[132:135], a[124:127], v[88:91]
s_waitcnt lgkmcnt(5)
v_mfma_f32_16x16x32_bf16 v[36:39], a[136:139], a[64:67], v[36:39]
s_waitcnt lgkmcnt(3)
s_add_u32 m0, s28, 32768
ds_read_b64_tr_b16 a[128:129], v6 offset:32768
v_mfma_f32_16x16x32_bf16 v[36:39], a[140:143], a[68:71], v[36:39]
buffer_load_dwordx4 v12, s[8:11], s24 offen offset:0 lds
v_mfma_f32_16x16x32_bf16 v[44:47], a[136:139], a[72:75], v[44:47]
ds_read_b64_tr_b16 a[130:131], v6 offset:34816
v_mfma_f32_16x16x32_bf16 v[44:47], a[140:143], a[76:79], v[44:47]
v_mfma_f32_16x16x32_bf16 v[52:55], a[136:139], a[80:83], v[52:55]
ds_read_b64_tr_b16 a[132:133], v6 offset:49152
v_mfma_f32_16x16x32_bf16 v[52:55], a[140:143], a[84:87], v[52:55]
buffer_load_dwordx4 v13, s[8:11], s24 offen offset:1024 lds
v_mfma_f32_16x16x32_bf16 v[60:63], a[136:139], a[88:91], v[60:63]
ds_read_b64_tr_b16 a[134:135], v6 offset:51200
v_mfma_f32_16x16x32_bf16 v[60:63], a[140:143], a[92:95], v[60:63]
v_mfma_f32_16x16x32_bf16 v[68:71], a[136:139], a[96:99], v[68:71]
ds_read_b128 a[12:15], v3 offset:2048
v_mfma_f32_16x16x32_bf16 v[68:71], a[140:143], a[100:103], v[68:71]
buffer_load_dwordx4 v14, s[8:11], s24 offen offset:2048 lds
v_mfma_f32_16x16x32_bf16 v[76:79], a[136:139], a[104:107], v[76:79]
v_mfma_f32_16x16x32_bf16 v[76:79], a[140:143], a[108:111], v[76:79]
v_mfma_f32_16x16x32_bf16 v[84:87], a[136:139], a[112:115], v[84:87]
ds_read_b128 a[16:19], v2 offset:4096
v_mfma_f32_16x16x32_bf16 v[84:87], a[140:143], a[116:119], v[84:87]
buffer_load_dwordx4 v15, s[8:11], s24 offen offset:3072 lds
v_mfma_f32_16x16x32_bf16 v[92:95], a[136:139], a[120:123], v[92:95]
s_add_u32 s24, s24, 128
ds_read_b128 a[20:23], v3 offset:4096
v_mfma_f32_16x16x32_bf16 v[92:95], a[140:143], a[124:127], v[92:95]
s_waitcnt lgkmcnt(5)
v_mfma_f32_16x16x32_bf16 v[96:99], a[128:131], a[64:67], v[96:99]
s_waitcnt lgkmcnt(3)
s_add_u32 m0, s28, 36864
ds_read_b64_tr_b16 a[136:137], v7 offset:32768
v_mfma_f32_16x16x32_bf16 v[96:99], a[132:135], a[68:71], v[96:99]
buffer_load_dwordx4 v12, s[8:11], s25 offen offset:0 lds
v_mfma_f32_16x16x32_bf16 v[104:107], a[128:131], a[72:75], v[104:107]
ds_read_b64_tr_b16 a[138:139], v7 offset:34816
v_mfma_f32_16x16x32_bf16 v[104:107], a[132:135], a[76:79], v[104:107]
v_mfma_f32_16x16x32_bf16 v[112:115], a[128:131], a[80:83], v[112:115]
ds_read_b64_tr_b16 a[140:141], v7 offset:49152
v_mfma_f32_16x16x32_bf16 v[112:115], a[132:135], a[84:87], v[112:115]
buffer_load_dwordx4 v13, s[8:11], s25 offen offset:1024 lds
v_mfma_f32_16x16x32_bf16 v[120:123], a[128:131], a[88:91], v[120:123]
ds_read_b64_tr_b16 a[142:143], v7 offset:51200
v_mfma_f32_16x16x32_bf16 v[120:123], a[132:135], a[92:95], v[120:123]
v_mfma_f32_16x16x32_bf16 v[128:131], a[128:131], a[96:99], v[128:131]
v_mfma_f32_16x16x32_bf16 v[128:131], a[132:135], a[100:103], v[128:131]
buffer_load_dwordx4 v14, s[8:11], s25 offen offset:2048 lds
v_mfma_f32_16x16x32_bf16 v[136:139], a[128:131], a[104:107], v[136:139]
ds_read_b128 a[24:27], v2 offset:6144
v_mfma_f32_16x16x32_bf16 v[136:139], a[132:135], a[108:111], v[136:139]
v_mfma_f32_16x16x32_bf16 v[144:147], a[128:131], a[112:115], v[144:147]
ds_read_b128 a[28:31], v3 offset:6144
v_mfma_f32_16x16x32_bf16 v[144:147], a[132:135], a[116:119], v[144:147]
buffer_load_dwordx4 v15, s[8:11], s25 offen offset:3072 lds
v_mfma_f32_16x16x32_bf16 v[152:155], a[128:131], a[120:123], v[152:155]
s_add_u32 s25, s25, 128
v_mfma_f32_16x16x32_bf16 v[152:155], a[132:135], a[124:127], v[152:155]
s_waitcnt lgkmcnt(4)
v_mfma_f32_16x16x32_bf16 v[100:103], a[136:139], a[64:67], v[100:103]
s_waitcnt lgkmcnt(2)
ds_read_b64_tr_b16 a[128:129], v8 offset:32768
v_lshrrev_b32 v28, 7, v1
v_mfma_f32_16x16x32_bf16 v[100:103], a[140:143], a[68:71], v[100:103]
v_lshrrev_b32 v29, 1, v28
v_lshlrev_b32 v29, 4, v29
v_mfma_f32_16x16x32_bf16 v[108:111], a[136:139], a[72:75], v[108:111]
s_mov_b64 s[8:9], s[76:77]
ds_read_b64_tr_b16 a[130:131], v8 offset:34816
v_and_b32 v30, 0x70, v1
v_mfma_f32_16x16x32_bf16 v[108:111], a[140:143], a[76:79], v[108:111]
s_mov_b32 s10, 1835008
v_xor_b32 v29, v29, v30
v_mul_u32_u24 v28, 896, v28
v_mfma_f32_16x16x32_bf16 v[116:119], a[136:139], a[80:83], v[116:119]
s_lshl_b32 s24, s37, 2
ds_read_b64_tr_b16 a[132:133], v8 offset:49152
v_add_u32 v12, v28, v29
v_mfma_f32_16x16x32_bf16 v[116:119], a[140:143], a[84:87], v[116:119]
s_add_u32 s24, s24, s3
v_xor_b32 v29, 64, v29
v_add_u32 v28, v28, v29
v_mfma_f32_16x16x32_bf16 v[124:127], a[136:139], a[88:91], v[124:127]
s_mul_i32 s24, s24, 28672
ds_read_b64_tr_b16 a[134:135], v8 offset:51200
v_add_u32 v13, 6144, v28
v_mfma_f32_16x16x32_bf16 v[124:127], a[140:143], a[92:95], v[124:127]
s_mov_b32 s28, s29
v_add_u32 v14, 12288, v12
v_add_u32 v15, 18432, v28
v_mfma_f32_16x16x32_bf16 v[132:135], a[136:139], a[96:99], v[132:135]
ds_read_b128 a[32:35], v2 offset:8192
v_mfma_f32_16x16x32_bf16 v[132:135], a[140:143], a[100:103], v[132:135]
v_mfma_f32_16x16x32_bf16 v[140:143], a[136:139], a[104:107], v[140:143]
v_mfma_f32_16x16x32_bf16 v[140:143], a[140:143], a[108:111], v[140:143]
v_mfma_f32_16x16x32_bf16 v[148:151], a[136:139], a[112:115], v[148:151]
ds_read_b128 a[36:39], v3 offset:8192
v_mov_b32 v20, 0
v_mfma_f32_16x16x32_bf16 v[148:151], a[140:143], a[116:119], v[148:151]
v_mfma_f32_16x16x32_bf16 v[156:159], a[136:139], a[120:123], v[156:159]
ds_read_b128 a[40:43], v2 offset:10240
v_mfma_f32_16x16x32_bf16 v[156:159], a[140:143], a[124:127], v[156:159]
s_waitcnt lgkmcnt(5)
v_mfma_f32_16x16x32_bf16 v[160:163], a[128:131], a[64:67], v[160:163]
s_waitcnt lgkmcnt(3)
ds_read_b64_tr_b16 a[136:137], v9 offset:32768
v_mfma_f32_16x16x32_bf16 v[160:163], a[132:135], a[68:71], v[160:163]
v_mfma_f32_16x16x32_bf16 v[168:171], a[128:131], a[72:75], v[168:171]
ds_read_b64_tr_b16 a[138:139], v9 offset:34816
v_mfma_f32_16x16x32_bf16 v[168:171], a[132:135], a[76:79], v[168:171]
v_mfma_f32_16x16x32_bf16 v[176:179], a[128:131], a[80:83], v[176:179]
ds_read_b64_tr_b16 a[140:141], v9 offset:49152
v_mfma_f32_16x16x32_bf16 v[176:179], a[132:135], a[84:87], v[176:179]
v_mfma_f32_16x16x32_bf16 v[184:187], a[128:131], a[88:91], v[184:187]
ds_read_b64_tr_b16 a[142:143], v9 offset:51200
v_mfma_f32_16x16x32_bf16 v[184:187], a[132:135], a[92:95], v[184:187]
v_mfma_f32_16x16x32_bf16 v[192:195], a[128:131], a[96:99], v[192:195]
v_mfma_f32_16x16x32_bf16 v[192:195], a[132:135], a[100:103], v[192:195]
v_mfma_f32_16x16x32_bf16 v[200:203], a[128:131], a[104:107], v[200:203]
ds_read_b128 a[44:47], v3 offset:10240
v_mfma_f32_16x16x32_bf16 v[200:203], a[132:135], a[108:111], v[200:203]
v_mfma_f32_16x16x32_bf16 v[208:211], a[128:131], a[112:115], v[208:211]
ds_read_b128 a[48:51], v2 offset:12288
v_mfma_f32_16x16x32_bf16 v[208:211], a[132:135], a[116:119], v[208:211]
v_mfma_f32_16x16x32_bf16 v[216:219], a[128:131], a[120:123], v[216:219]
v_mfma_f32_16x16x32_bf16 v[216:219], a[132:135], a[124:127], v[216:219]
s_waitcnt lgkmcnt(4)
v_mfma_f32_16x16x32_bf16 v[164:167], a[136:139], a[64:67], v[164:167]
s_waitcnt lgkmcnt(2)
ds_read_b64_tr_b16 a[128:129], v10 offset:32768
v_mfma_f32_16x16x32_bf16 v[164:167], a[140:143], a[68:71], v[164:167]
v_mfma_f32_16x16x32_bf16 v[172:175], a[136:139], a[72:75], v[172:175]
ds_read_b64_tr_b16 a[130:131], v10 offset:34816
v_mfma_f32_16x16x32_bf16 v[172:175], a[140:143], a[76:79], v[172:175]
v_mfma_f32_16x16x32_bf16 v[180:183], a[136:139], a[80:83], v[180:183]
ds_read_b64_tr_b16 a[132:133], v10 offset:49152
v_mfma_f32_16x16x32_bf16 v[180:183], a[140:143], a[84:87], v[180:183]
v_mfma_f32_16x16x32_bf16 v[188:191], a[136:139], a[88:91], v[188:191]
ds_read_b64_tr_b16 a[134:135], v10 offset:51200
v_mfma_f32_16x16x32_bf16 v[188:191], a[140:143], a[92:95], v[188:191]
v_mfma_f32_16x16x32_bf16 v[196:199], a[136:139], a[96:99], v[196:199]
ds_read_b128 a[52:55], v3 offset:12288
v_mfma_f32_16x16x32_bf16 v[196:199], a[140:143], a[100:103], v[196:199]
v_mfma_f32_16x16x32_bf16 v[204:207], a[136:139], a[104:107], v[204:207]
ds_read_b128 a[56:59], v2 offset:14336
v_mfma_f32_16x16x32_bf16 v[204:207], a[140:143], a[108:111], v[204:207]
v_mfma_f32_16x16x32_bf16 v[212:215], a[136:139], a[112:115], v[212:215]
v_mfma_f32_16x16x32_bf16 v[212:215], a[140:143], a[116:119], v[212:215]
v_mfma_f32_16x16x32_bf16 v[220:223], a[136:139], a[120:123], v[220:223]
ds_read_b128 a[60:63], v3 offset:14336
v_mfma_f32_16x16x32_bf16 v[220:223], a[140:143], a[124:127], v[220:223]
s_waitcnt lgkmcnt(5)
v_mfma_f32_16x16x32_bf16 v[224:227], a[128:131], a[64:67], v[224:227]
s_waitcnt lgkmcnt(3)
ds_read_b64_tr_b16 a[136:137], v11 offset:32768
v_mfma_f32_16x16x32_bf16 v[224:227], a[132:135], a[68:71], v[224:227]
v_mfma_f32_16x16x32_bf16 v[232:235], a[128:131], a[72:75], v[232:235]
ds_read_b64_tr_b16 a[138:139], v11 offset:34816
v_mfma_f32_16x16x32_bf16 v[232:235], a[132:135], a[76:79], v[232:235]
v_mfma_f32_16x16x32_bf16 v[240:243], a[128:131], a[80:83], v[240:243]
ds_read_b64_tr_b16 a[140:141], v11 offset:49152
v_mfma_f32_16x16x32_bf16 v[240:243], a[132:135], a[84:87], v[240:243]
v_mfma_f32_16x16x32_bf16 v[248:251], a[128:131], a[88:91], v[248:251]
ds_read_b64_tr_b16 a[142:143], v11 offset:51200
v_mfma_f32_16x16x32_bf16 v[248:251], a[132:135], a[92:95], v[248:251]
v_mfma_f32_16x16x32_bf16 a[224:227], a[128:131], a[96:99], a[224:227]
v_mfma_f32_16x16x32_bf16 a[224:227], a[132:135], a[100:103], a[224:227]
v_mfma_f32_16x16x32_bf16 a[232:235], a[128:131], a[104:107], a[232:235]
v_mfma_f32_16x16x32_bf16 a[232:235], a[132:135], a[108:111], a[232:235]
v_mfma_f32_16x16x32_bf16 a[240:243], a[128:131], a[112:115], a[240:243]
v_mfma_f32_16x16x32_bf16 a[240:243], a[132:135], a[116:119], a[240:243]
v_mfma_f32_16x16x32_bf16 a[248:251], a[128:131], a[120:123], a[248:251]
v_mfma_f32_16x16x32_bf16 a[248:251], a[132:135], a[124:127], a[248:251]
s_waitcnt vmcnt(0) lgkmcnt(0)
s_barrier
v_mfma_f32_16x16x32_bf16 v[228:231], a[136:139], a[64:67], v[228:231]
s_add_u32 m0, s29, 98304
ds_read_b64_tr_b16 a[128:129], v4 offset:0
v_mfma_f32_16x16x32_bf16 v[228:231], a[140:143], a[68:71], v[228:231]
buffer_load_dwordx4 v16, s[12:15], s26 offen offset:0 lds
v_mfma_f32_16x16x32_bf16 v[236:239], a[136:139], a[72:75], v[236:239]
ds_read_b64_tr_b16 a[130:131], v4 offset:2048
v_mfma_f32_16x16x32_bf16 v[236:239], a[140:143], a[76:79], v[236:239]
v_mfma_f32_16x16x32_bf16 v[244:247], a[136:139], a[80:83], v[244:247]
ds_read_b64_tr_b16 a[132:133], v4 offset:16384
v_mfma_f32_16x16x32_bf16 v[244:247], a[140:143], a[84:87], v[244:247]
buffer_load_dwordx4 v17, s[12:15], s26 offen offset:1024 lds
v_mfma_f32_16x16x32_bf16 v[252:255], a[136:139], a[88:91], v[252:255]
ds_read_b64_tr_b16 a[134:135], v4 offset:18432
v_mfma_f32_16x16x32_bf16 v[252:255], a[140:143], a[92:95], v[252:255]
v_mfma_f32_16x16x32_bf16 a[228:231], a[136:139], a[96:99], a[228:231]
v_mfma_f32_16x16x32_bf16 a[228:231], a[140:143], a[100:103], a[228:231]
buffer_load_dwordx4 v18, s[12:15], s26 offen offset:2048 lds
v_mfma_f32_16x16x32_bf16 a[236:239], a[136:139], a[104:107], a[236:239]
v_mfma_f32_16x16x32_bf16 a[236:239], a[140:143], a[108:111], a[236:239]
v_mfma_f32_16x16x32_bf16 a[244:247], a[136:139], a[112:115], a[244:247]
v_mfma_f32_16x16x32_bf16 a[244:247], a[140:143], a[116:119], a[244:247]
buffer_load_dwordx4 v19, s[12:15], s26 offen offset:3072 lds
v_mfma_f32_16x16x32_bf16 a[252:255], a[136:139], a[120:123], a[252:255]
s_add_u32 s26, s26, 524288
v_mfma_f32_16x16x32_bf16 a[252:255], a[140:143], a[124:127], a[252:255]
s_waitcnt lgkmcnt(2)
v_mfma_f32_16x16x32_bf16 v[32:35], a[128:131], a[0:3], v[32:35]
s_waitcnt lgkmcnt(0)
s_add_u32 m0, s29, 114688
ds_read_b64_tr_b16 a[136:137], v5 offset:0
v_mfma_f32_16x16x32_bf16 v[32:35], a[132:135], a[4:7], v[32:35]
buffer_load_dwordx4 v16, s[12:15], s27 offen offset:0 lds
v_mfma_f32_16x16x32_bf16 v[40:43], a[128:131], a[8:11], v[40:43]
ds_read_b64_tr_b16 a[138:139], v5 offset:2048
v_mfma_f32_16x16x32_bf16 v[40:43], a[132:135], a[12:15], v[40:43]
v_mfma_f32_16x16x32_bf16 v[48:51], a[128:131], a[16:19], v[48:51]
ds_read_b64_tr_b16 a[140:141], v5 offset:16384
v_mfma_f32_16x16x32_bf16 v[48:51], a[132:135], a[20:23], v[48:51]
buffer_load_dwordx4 v17, s[12:15], s27 offen offset:1024 lds
v_mfma_f32_16x16x32_bf16 v[56:59], a[128:131], a[24:27], v[56:59]
ds_read_b64_tr_b16 a[142:143], v5 offset:18432
v_mfma_f32_16x16x32_bf16 v[56:59], a[132:135], a[28:31], v[56:59]
v_mfma_f32_16x16x32_bf16 v[64:67], a[128:131], a[32:35], v[64:67]
ds_read_b128 a[64:67], v2 offset:32768
v_mfma_f32_16x16x32_bf16 v[64:67], a[132:135], a[36:39], v[64:67]
buffer_load_dwordx4 v18, s[12:15], s27 offen offset:2048 lds
v_mfma_f32_16x16x32_bf16 v[72:75], a[128:131], a[40:43], v[72:75]
ds_read_b128 a[68:71], v3 offset:32768
v_mfma_f32_16x16x32_bf16 v[72:75], a[132:135], a[44:47], v[72:75]
v_mfma_f32_16x16x32_bf16 v[80:83], a[128:131], a[48:51], v[80:83]
v_mfma_f32_16x16x32_bf16 v[80:83], a[132:135], a[52:55], v[80:83]
buffer_load_dwordx4 v19, s[12:15], s27 offen offset:3072 lds
v_mfma_f32_16x16x32_bf16 v[88:91], a[128:131], a[56:59], v[88:91]
s_add_u32 s27, s27, 524288
ds_read_b128 a[72:75], v2 offset:34816
v_mfma_f32_16x16x32_bf16 v[88:91], a[132:135], a[60:63], v[88:91]
s_waitcnt lgkmcnt(5)
v_mfma_f32_16x16x32_bf16 v[36:39], a[136:139], a[0:3], v[36:39]
s_waitcnt lgkmcnt(3)
s_add_u32 m0, s28, 0
ds_read_b64_tr_b16 a[128:129], v6 offset:0
v_mfma_f32_16x16x32_bf16 v[36:39], a[140:143], a[4:7], v[36:39]
buffer_load_dwordx4 v12, s[8:11], s24 offen offset:0 lds
v_mfma_f32_16x16x32_bf16 v[44:47], a[136:139], a[8:11], v[44:47]
ds_read_b64_tr_b16 a[130:131], v6 offset:2048
v_mfma_f32_16x16x32_bf16 v[44:47], a[140:143], a[12:15], v[44:47]
v_mfma_f32_16x16x32_bf16 v[52:55], a[136:139], a[16:19], v[52:55]
ds_read_b64_tr_b16 a[132:133], v6 offset:16384
v_mfma_f32_16x16x32_bf16 v[52:55], a[140:143], a[20:23], v[52:55]
buffer_load_dwordx4 v13, s[8:11], s24 offen offset:1024 lds
v_mfma_f32_16x16x32_bf16 v[60:63], a[136:139], a[24:27], v[60:63]
ds_read_b64_tr_b16 a[134:135], v6 offset:18432
v_mfma_f32_16x16x32_bf16 v[60:63], a[140:143], a[28:31], v[60:63]
v_mfma_f32_16x16x32_bf16 v[68:71], a[136:139], a[32:35], v[68:71]
ds_read_b128 a[76:79], v3 offset:34816
v_mfma_f32_16x16x32_bf16 v[68:71], a[140:143], a[36:39], v[68:71]
buffer_load_dwordx4 v14, s[8:11], s24 offen offset:2048 lds
v_mfma_f32_16x16x32_bf16 v[76:79], a[136:139], a[40:43], v[76:79]
v_mfma_f32_16x16x32_bf16 v[76:79], a[140:143], a[44:47], v[76:79]
v_mfma_f32_16x16x32_bf16 v[84:87], a[136:139], a[48:51], v[84:87]
ds_read_b128 a[80:83], v2 offset:36864
v_mfma_f32_16x16x32_bf16 v[84:87], a[140:143], a[52:55], v[84:87]
buffer_load_dwordx4 v15, s[8:11], s24 offen offset:3072 lds
v_mfma_f32_16x16x32_bf16 v[92:95], a[136:139], a[56:59], v[92:95]
s_add_u32 s24, s24, 128
ds_read_b128 a[84:87], v3 offset:36864
v_mfma_f32_16x16x32_bf16 v[92:95], a[140:143], a[60:63], v[92:95]
s_waitcnt lgkmcnt(3)
s_mov_b64 s[12:13], s[80:81]
v_mfma_f32_16x16x32_bf16 v[96:99], a[128:131], a[0:3], v[96:99]
s_mov_b32 s14, 3670016
s_add_u32 m0, s28, 16384
ds_read_b64_tr_b16 a[136:137], v7 offset:0
v_mfma_f32_16x16x32_bf16 v[96:99], a[132:135], a[4:7], v[96:99]
buffer_load_dwordx4 v12, s[8:11], s24 offen offset:0 lds
v_mfma_f32_16x16x32_bf16 v[104:107], a[128:131], a[8:11], v[104:107]
ds_read_b64_tr_b16 a[138:139], v7 offset:2048
v_mfma_f32_16x16x32_bf16 v[104:107], a[132:135], a[12:15], v[104:107]
v_mfma_f32_16x16x32_bf16 v[112:115], a[128:131], a[16:19], v[112:115]
ds_read_b64_tr_b16 a[140:141], v7 offset:16384
v_mfma_f32_16x16x32_bf16 v[112:115], a[132:135], a[20:23], v[112:115]
buffer_load_dwordx4 v13, s[8:11], s24 offen offset:1024 lds
v_mfma_f32_16x16x32_bf16 v[120:123], a[128:131], a[24:27], v[120:123]
ds_read_b64_tr_b16 a[142:143], v7 offset:18432
v_mfma_f32_16x16x32_bf16 v[120:123], a[132:135], a[28:31], v[120:123]
v_mfma_f32_16x16x32_bf16 v[128:131], a[128:131], a[32:35], v[128:131]
v_mfma_f32_16x16x32_bf16 v[128:131], a[132:135], a[36:39], v[128:131]
buffer_load_dwordx4 v14, s[8:11], s24 offen offset:2048 lds
v_mfma_f32_16x16x32_bf16 v[136:139], a[128:131], a[40:43], v[136:139]
ds_read_b128 a[88:91], v2 offset:38912
v_mfma_f32_16x16x32_bf16 v[136:139], a[132:135], a[44:47], v[136:139]
v_mfma_f32_16x16x32_bf16 v[144:147], a[128:131], a[48:51], v[144:147]
ds_read_b128 a[92:95], v3 offset:38912
v_mfma_f32_16x16x32_bf16 v[144:147], a[132:135], a[52:55], v[144:147]
buffer_load_dwordx4 v15, s[8:11], s24 offen offset:3072 lds
v_mfma_f32_16x16x32_bf16 v[152:155], a[128:131], a[56:59], v[152:155]
s_add_u32 s24, s24, 128
v_mfma_f32_16x16x32_bf16 v[152:155], a[132:135], a[60:63], v[152:155]
s_waitcnt lgkmcnt(2)
s_sub_u32 s26, s26, 8388608
v_mfma_f32_16x16x32_bf16 v[100:103], a[136:139], a[0:3], v[100:103]
s_sub_u32 s27, s27, 8388608
s_add_u32 m0, s29, 131072
ds_read_b64_tr_b16 a[128:129], v8 offset:0
v_mfma_f32_16x16x32_bf16 v[100:103], a[140:143], a[4:7], v[100:103]
buffer_load_dwordx4 v16, s[12:15], s26 offen offset:0 lds
v_mfma_f32_16x16x32_bf16 v[108:111], a[136:139], a[8:11], v[108:111]
ds_read_b64_tr_b16 a[130:131], v8 offset:2048
v_mfma_f32_16x16x32_bf16 v[108:111], a[140:143], a[12:15], v[108:111]
v_mfma_f32_16x16x32_bf16 v[116:119], a[136:139], a[16:19], v[116:119]
ds_read_b64_tr_b16 a[132:133], v8 offset:16384
v_mfma_f32_16x16x32_bf16 v[116:119], a[140:143], a[20:23], v[116:119]
buffer_load_dwordx4 v17, s[12:15], s26 offen offset:1024 lds
v_mfma_f32_16x16x32_bf16 v[124:127], a[136:139], a[24:27], v[124:127]
ds_read_b64_tr_b16 a[134:135], v8 offset:18432
v_mfma_f32_16x16x32_bf16 v[124:127], a[140:143], a[28:31], v[124:127]
v_mfma_f32_16x16x32_bf16 v[132:135], a[136:139], a[32:35], v[132:135]
ds_read_b128 a[96:99], v2 offset:40960
v_mfma_f32_16x16x32_bf16 v[132:135], a[140:143], a[36:39], v[132:135]
buffer_load_dwordx4 v18, s[12:15], s26 offen offset:2048 lds
v_mfma_f32_16x16x32_bf16 v[140:143], a[136:139], a[40:43], v[140:143]
v_mfma_f32_16x16x32_bf16 v[140:143], a[140:143], a[44:47], v[140:143]
v_mfma_f32_16x16x32_bf16 v[148:151], a[136:139], a[48:51], v[148:151]
ds_read_b128 a[100:103], v3 offset:40960
v_mfma_f32_16x16x32_bf16 v[148:151], a[140:143], a[52:55], v[148:151]
buffer_load_dwordx4 v19, s[12:15], s26 offen offset:3072 lds
v_mfma_f32_16x16x32_bf16 v[156:159], a[136:139], a[56:59], v[156:159]
s_add_u32 s26, s26, 524288
ds_read_b128 a[104:107], v2 offset:43008
v_mfma_f32_16x16x32_bf16 v[156:159], a[140:143], a[60:63], v[156:159]
s_waitcnt lgkmcnt(5)
v_mfma_f32_16x16x32_bf16 v[160:163], a[128:131], a[0:3], v[160:163]
s_waitcnt lgkmcnt(3)
s_add_u32 m0, s29, 147456
ds_read_b64_tr_b16 a[136:137], v9 offset:0
v_mfma_f32_16x16x32_bf16 v[160:163], a[132:135], a[4:7], v[160:163]
buffer_load_dwordx4 v16, s[12:15], s27 offen offset:0 lds
v_mfma_f32_16x16x32_bf16 v[168:171], a[128:131], a[8:11], v[168:171]
ds_read_b64_tr_b16 a[138:139], v9 offset:2048
v_mfma_f32_16x16x32_bf16 v[168:171], a[132:135], a[12:15], v[168:171]
v_mfma_f32_16x16x32_bf16 v[176:179], a[128:131], a[16:19], v[176:179]
ds_read_b64_tr_b16 a[140:141], v9 offset:16384
v_mfma_f32_16x16x32_bf16 v[176:179], a[132:135], a[20:23], v[176:179]
buffer_load_dwordx4 v17, s[12:15], s27 offen offset:1024 lds
v_mfma_f32_16x16x32_bf16 v[184:187], a[128:131], a[24:27], v[184:187]
ds_read_b64_tr_b16 a[142:143], v9 offset:18432
v_mfma_f32_16x16x32_bf16 v[184:187], a[132:135], a[28:31], v[184:187]
v_mfma_f32_16x16x32_bf16 v[192:195], a[128:131], a[32:35], v[192:195]
v_mfma_f32_16x16x32_bf16 v[192:195], a[132:135], a[36:39], v[192:195]
buffer_load_dwordx4 v18, s[12:15], s27 offen offset:2048 lds
v_mfma_f32_16x16x32_bf16 v[200:203], a[128:131], a[40:43], v[200:203]
ds_read_b128 a[108:111], v3 offset:43008
v_mfma_f32_16x16x32_bf16 v[200:203], a[132:135], a[44:47], v[200:203]
v_mfma_f32_16x16x32_bf16 v[208:211], a[128:131], a[48:51], v[208:211]
ds_read_b128 a[112:115], v2 offset:45056
v_mfma_f32_16x16x32_bf16 v[208:211], a[132:135], a[52:55], v[208:211]
buffer_load_dwordx4 v19, s[12:15], s27 offen offset:3072 lds
v_mfma_f32_16x16x32_bf16 v[216:219], a[128:131], a[56:59], v[216:219]
s_add_u32 s27, s27, 524288
v_mfma_f32_16x16x32_bf16 v[216:219], a[132:135], a[60:63], v[216:219]
s_waitcnt lgkmcnt(4)
v_mfma_f32_16x16x32_bf16 v[164:167], a[136:139], a[0:3], v[164:167]
s_waitcnt lgkmcnt(2)
ds_read_b64_tr_b16 a[128:129], v10 offset:0
v_mfma_f32_16x16x32_bf16 v[164:167], a[140:143], a[4:7], v[164:167]
v_mfma_f32_16x16x32_bf16 v[172:175], a[136:139], a[8:11], v[172:175]
ds_read_b64_tr_b16 a[130:131], v10 offset:2048
v_mfma_f32_16x16x32_bf16 v[172:175], a[140:143], a[12:15], v[172:175]
v_mfma_f32_16x16x32_bf16 v[180:183], a[136:139], a[16:19], v[180:183]
ds_read_b64_tr_b16 a[132:133], v10 offset:16384
v_mfma_f32_16x16x32_bf16 v[180:183], a[140:143], a[20:23], v[180:183]
v_mfma_f32_16x16x32_bf16 v[188:191], a[136:139], a[24:27], v[188:191]
ds_read_b64_tr_b16 a[134:135], v10 offset:18432
v_mfma_f32_16x16x32_bf16 v[188:191], a[140:143], a[28:31], v[188:191]
v_mfma_f32_16x16x32_bf16 v[196:199], a[136:139], a[32:35], v[196:199]
ds_read_b128 a[116:119], v3 offset:45056
v_mfma_f32_16x16x32_bf16 v[196:199], a[140:143], a[36:39], v[196:199]
v_mfma_f32_16x16x32_bf16 v[204:207], a[136:139], a[40:43], v[204:207]
ds_read_b128 a[120:123], v2 offset:47104
v_mfma_f32_16x16x32_bf16 v[204:207], a[140:143], a[44:47], v[204:207]
v_mfma_f32_16x16x32_bf16 v[212:215], a[136:139], a[48:51], v[212:215]
v_mfma_f32_16x16x32_bf16 v[212:215], a[140:143], a[52:55], v[212:215]
v_mfma_f32_16x16x32_bf16 v[220:223], a[136:139], a[56:59], v[220:223]
ds_read_b128 a[124:127], v3 offset:47104
v_mfma_f32_16x16x32_bf16 v[220:223], a[140:143], a[60:63], v[220:223]
s_waitcnt lgkmcnt(5)
v_mfma_f32_16x16x32_bf16 v[224:227], a[128:131], a[0:3], v[224:227]
s_waitcnt lgkmcnt(3)
ds_read_b64_tr_b16 a[136:137], v11 offset:0
v_mfma_f32_16x16x32_bf16 v[224:227], a[132:135], a[4:7], v[224:227]
v_mfma_f32_16x16x32_bf16 v[232:235], a[128:131], a[8:11], v[232:235]
ds_read_b64_tr_b16 a[138:139], v11 offset:2048
v_mfma_f32_16x16x32_bf16 v[232:235], a[132:135], a[12:15], v[232:235]
v_mfma_f32_16x16x32_bf16 v[240:243], a[128:131], a[16:19], v[240:243]
ds_read_b64_tr_b16 a[140:141], v11 offset:16384
v_mfma_f32_16x16x32_bf16 v[240:243], a[132:135], a[20:23], v[240:243]
v_mfma_f32_16x16x32_bf16 v[248:251], a[128:131], a[24:27], v[248:251]
ds_read_b64_tr_b16 a[142:143], v11 offset:18432
v_mfma_f32_16x16x32_bf16 v[248:251], a[132:135], a[28:31], v[248:251]
v_mfma_f32_16x16x32_bf16 a[224:227], a[128:131], a[32:35], a[224:227]
v_mfma_f32_16x16x32_bf16 a[224:227], a[132:135], a[36:39], a[224:227]
v_mfma_f32_16x16x32_bf16 a[232:235], a[128:131], a[40:43], a[232:235]
v_mfma_f32_16x16x32_bf16 a[232:235], a[132:135], a[44:47], a[232:235]
v_mfma_f32_16x16x32_bf16 a[240:243], a[128:131], a[48:51], a[240:243]
v_mfma_f32_16x16x32_bf16 a[240:243], a[132:135], a[52:55], a[240:243]
v_mfma_f32_16x16x32_bf16 a[248:251], a[128:131], a[56:59], a[248:251]
v_mfma_f32_16x16x32_bf16 a[248:251], a[132:135], a[60:63], a[248:251]
s_waitcnt vmcnt(12) lgkmcnt(0)
s_barrier
v_mfma_f32_16x16x32_bf16 v[228:231], a[136:139], a[0:3], v[228:231]
s_add_u32 m0, s28, 32768
ds_read_b64_tr_b16 a[128:129], v4 offset:32768
v_mfma_f32_16x16x32_bf16 v[228:231], a[140:143], a[4:7], v[228:231]
s_lshr_b32 s22, s3, 1
buffer_load_dwordx4 v12, s[8:11], s24 offen offset:0 lds
v_mfma_f32_16x16x32_bf16 v[236:239], a[136:139], a[8:11], v[236:239]
s_lshl_b32 s22, s22, 14
ds_read_b64_tr_b16 a[130:131], v4 offset:34816
v_subrev_u32 v2, s22, v2
v_mfma_f32_16x16x32_bf16 v[236:239], a[140:143], a[12:15], v[236:239]
v_subrev_u32 v3, s22, v3
v_mfma_f32_16x16x32_bf16 v[244:247], a[136:139], a[16:19], v[244:247]
ds_read_b64_tr_b16 a[132:133], v4 offset:49152
v_mfma_f32_16x16x32_bf16 v[244:247], a[140:143], a[20:23], v[244:247]
buffer_load_dwordx4 v13, s[8:11], s24 offen offset:1024 lds
v_mfma_f32_16x16x32_bf16 v[252:255], a[136:139], a[24:27], v[252:255]
ds_read_b64_tr_b16 a[134:135], v4 offset:51200
v_mfma_f32_16x16x32_bf16 v[252:255], a[140:143], a[28:31], v[252:255]
v_mfma_f32_16x16x32_bf16 a[228:231], a[136:139], a[32:35], a[228:231]
v_mfma_f32_16x16x32_bf16 a[228:231], a[140:143], a[36:39], a[228:231]
buffer_load_dwordx4 v14, s[8:11], s24 offen offset:2048 lds
v_mfma_f32_16x16x32_bf16 a[236:239], a[136:139], a[40:43], a[236:239]
v_mfma_f32_16x16x32_bf16 a[236:239], a[140:143], a[44:47], a[236:239]
v_mfma_f32_16x16x32_bf16 a[244:247], a[136:139], a[48:51], a[244:247]
v_mfma_f32_16x16x32_bf16 a[244:247], a[140:143], a[52:55], a[244:247]
buffer_load_dwordx4 v15, s[8:11], s24 offen offset:3072 lds
v_mfma_f32_16x16x32_bf16 a[252:255], a[136:139], a[56:59], a[252:255]
s_add_u32 s24, s24, 128
v_mfma_f32_16x16x32_bf16 a[252:255], a[140:143], a[60:63], a[252:255]
s_waitcnt lgkmcnt(2)
v_mfma_f32_16x16x32_bf16 v[32:35], a[128:131], a[64:67], v[32:35]
s_waitcnt lgkmcnt(0)
s_add_u32 m0, s29, 65536
ds_read_b64_tr_b16 a[136:137], v5 offset:32768
v_mfma_f32_16x16x32_bf16 v[32:35], a[132:135], a[68:71], v[32:35]
buffer_load_dwordx4 v16, s[12:15], s26 offen offset:0 lds
v_mfma_f32_16x16x32_bf16 v[40:43], a[128:131], a[72:75], v[40:43]
ds_read_b64_tr_b16 a[138:139], v5 offset:34816
v_mfma_f32_16x16x32_bf16 v[40:43], a[132:135], a[76:79], v[40:43]
v_mfma_f32_16x16x32_bf16 v[48:51], a[128:131], a[80:83], v[48:51]
ds_read_b64_tr_b16 a[140:141], v5 offset:49152
v_mfma_f32_16x16x32_bf16 v[48:51], a[132:135], a[84:87], v[48:51]
buffer_load_dwordx4 v17, s[12:15], s26 offen offset:1024 lds
v_mfma_f32_16x16x32_bf16 v[56:59], a[128:131], a[88:91], v[56:59]
ds_read_b64_tr_b16 a[142:143], v5 offset:51200
v_mfma_f32_16x16x32_bf16 v[56:59], a[132:135], a[92:95], v[56:59]
v_mfma_f32_16x16x32_bf16 v[64:67], a[128:131], a[96:99], v[64:67]
ds_read_b128 a[0:3], v2 offset:0
v_mfma_f32_16x16x32_bf16 v[64:67], a[132:135], a[100:103], v[64:67]
buffer_load_dwordx4 v18, s[12:15], s26 offen offset:2048 lds
v_mfma_f32_16x16x32_bf16 v[72:75], a[128:131], a[104:107], v[72:75]
ds_read_b128 a[4:7], v3 offset:0
v_mfma_f32_16x16x32_bf16 v[72:75], a[132:135], a[108:111], v[72:75]
v_mfma_f32_16x16x32_bf16 v[80:83], a[128:131], a[112:115], v[80:83]
v_mfma_f32_16x16x32_bf16 v[80:83], a[132:135], a[116:119], v[80:83]
buffer_load_dwordx4 v19, s[12:15], s26 offen offset:3072 lds
v_mfma_f32_16x16x32_bf16 v[88:91], a[128:131], a[120:123], v[88:91]
s_add_u32 s26, s26, 524288
ds_read_b128 a[8:11], v2 offset:2048
v_mfma_f32_16x16x32_bf16 v[88:91], a[132:135], a[124:127], v[88:91]
s_waitcnt lgkmcnt(5)
v_mfma_f32_16x16x32_bf16 v[36:39], a[136:139], a[64:67], v[36:39]
s_waitcnt lgkmcnt(3)
s_add_u32 m0, s29, 81920
ds_read_b64_tr_b16 a[128:129], v6 offset:32768
v_mfma_f32_16x16x32_bf16 v[36:39], a[140:143], a[68:71], v[36:39]
buffer_load_dwordx4 v16, s[12:15], s27 offen offset:0 lds
v_mfma_f32_16x16x32_bf16 v[44:47], a[136:139], a[72:75], v[44:47]
ds_read_b64_tr_b16 a[130:131], v6 offset:34816
v_mfma_f32_16x16x32_bf16 v[44:47], a[140:143], a[76:79], v[44:47]
v_mfma_f32_16x16x32_bf16 v[52:55], a[136:139], a[80:83], v[52:55]
ds_read_b64_tr_b16 a[132:133], v6 offset:49152
v_mfma_f32_16x16x32_bf16 v[52:55], a[140:143], a[84:87], v[52:55]
buffer_load_dwordx4 v17, s[12:15], s27 offen offset:1024 lds
v_mfma_f32_16x16x32_bf16 v[60:63], a[136:139], a[88:91], v[60:63]
ds_read_b64_tr_b16 a[134:135], v6 offset:51200
v_cvt_pk_bf16_f32 v32, v32, v33
v_mfma_f32_16x16x32_bf16 v[60:63], a[140:143], a[92:95], v[60:63]
v_cvt_pk_bf16_f32 v33, v34, v35
v_cvt_pk_bf16_f32 v34, v36, v37
v_mfma_f32_16x16x32_bf16 v[68:71], a[136:139], a[96:99], v[68:71]
ds_read_b128 a[12:15], v3 offset:2048
v_cvt_pk_bf16_f32 v35, v38, v39
v_mfma_f32_16x16x32_bf16 v[68:71], a[140:143], a[100:103], v[68:71]
buffer_load_dwordx4 v18, s[12:15], s27 offen offset:2048 lds
v_mfma_f32_16x16x32_bf16 v[76:79], a[136:139], a[104:107], v[76:79]
v_cvt_pk_bf16_f32 v40, v40, v41
v_cvt_pk_bf16_f32 v41, v42, v43
v_mfma_f32_16x16x32_bf16 v[76:79], a[140:143], a[108:111], v[76:79]
v_cvt_pk_bf16_f32 v42, v44, v45
v_cvt_pk_bf16_f32 v43, v46, v47
v_mfma_f32_16x16x32_bf16 v[84:87], a[136:139], a[112:115], v[84:87]
ds_read_b128 a[16:19], v2 offset:4096
v_cvt_pk_bf16_f32 v48, v48, v49
v_mfma_f32_16x16x32_bf16 v[84:87], a[140:143], a[116:119], v[84:87]
buffer_load_dwordx4 v19, s[12:15], s27 offen offset:3072 lds
v_mfma_f32_16x16x32_bf16 v[92:95], a[136:139], a[120:123], v[92:95]
s_add_u32 s27, s27, 524288
ds_read_b128 a[20:23], v3 offset:4096
v_cvt_pk_bf16_f32 v49, v50, v51
v_mfma_f32_16x16x32_bf16 v[92:95], a[140:143], a[124:127], v[92:95]
s_waitcnt lgkmcnt(3)
v_cvt_pk_bf16_f32 v50, v52, v53
v_cvt_pk_bf16_f32 v51, v54, v55
v_mfma_f32_16x16x32_bf16 v[96:99], a[128:131], a[64:67], v[96:99]
s_add_u32 m0, s28, 49152
ds_read_b64_tr_b16 a[136:137], v7 offset:32768
v_cvt_pk_bf16_f32 v56, v56, v57
v_mfma_f32_16x16x32_bf16 v[96:99], a[132:135], a[68:71], v[96:99]
buffer_load_dwordx4 v12, s[8:11], s24 offen offset:0 lds
v_mfma_f32_16x16x32_bf16 v[104:107], a[128:131], a[72:75], v[104:107]
ds_read_b64_tr_b16 a[138:139], v7 offset:34816
v_cvt_pk_bf16_f32 v57, v58, v59
v_mfma_f32_16x16x32_bf16 v[104:107], a[132:135], a[76:79], v[104:107]
v_cvt_pk_bf16_f32 v58, v60, v61
v_cvt_pk_bf16_f32 v59, v62, v63
v_mfma_f32_16x16x32_bf16 v[112:115], a[128:131], a[80:83], v[112:115]
ds_read_b64_tr_b16 a[140:141], v7 offset:49152
v_cvt_pk_bf16_f32 v64, v64, v65
v_mfma_f32_16x16x32_bf16 v[112:115], a[132:135], a[84:87], v[112:115]
buffer_load_dwordx4 v13, s[8:11], s24 offen offset:1024 lds
v_mfma_f32_16x16x32_bf16 v[120:123], a[128:131], a[88:91], v[120:123]
ds_read_b64_tr_b16 a[142:143], v7 offset:51200
v_cvt_pk_bf16_f32 v65, v66, v67
v_mfma_f32_16x16x32_bf16 v[120:123], a[132:135], a[92:95], v[120:123]
v_cvt_pk_bf16_f32 v66, v68, v69
v_cvt_pk_bf16_f32 v67, v70, v71
v_mfma_f32_16x16x32_bf16 v[128:131], a[128:131], a[96:99], v[128:131]
v_cvt_pk_bf16_f32 v72, v72, v73
v_cvt_pk_bf16_f32 v73, v74, v75
v_mfma_f32_16x16x32_bf16 v[128:131], a[132:135], a[100:103], v[128:131]
buffer_load_dwordx4 v14, s[8:11], s24 offen offset:2048 lds
v_mfma_f32_16x16x32_bf16 v[136:139], a[128:131], a[104:107], v[136:139]
ds_read_b128 a[24:27], v2 offset:6144
v_cvt_pk_bf16_f32 v74, v76, v77
v_mfma_f32_16x16x32_bf16 v[136:139], a[132:135], a[108:111], v[136:139]
v_cvt_pk_bf16_f32 v75, v78, v79
v_cvt_pk_bf16_f32 v80, v80, v81
v_mfma_f32_16x16x32_bf16 v[144:147], a[128:131], a[112:115], v[144:147]
ds_read_b128 a[28:31], v3 offset:6144
v_cvt_pk_bf16_f32 v81, v82, v83
v_mfma_f32_16x16x32_bf16 v[144:147], a[132:135], a[116:119], v[144:147]
buffer_load_dwordx4 v15, s[8:11], s24 offen offset:3072 lds
v_mfma_f32_16x16x32_bf16 v[152:155], a[128:131], a[120:123], v[152:155]
s_add_u32 s24, s24, 128
v_cvt_pk_bf16_f32 v82, v84, v85
v_cvt_pk_bf16_f32 v83, v86, v87
v_mfma_f32_16x16x32_bf16 v[152:155], a[132:135], a[124:127], v[152:155]
s_waitcnt lgkmcnt(4)
v_cvt_pk_bf16_f32 v88, v88, v89
v_cvt_pk_bf16_f32 v89, v90, v91
v_mfma_f32_16x16x32_bf16 v[100:103], a[136:139], a[64:67], v[100:103]
s_waitcnt lgkmcnt(2)
ds_read_b64_tr_b16 a[128:129], v8 offset:32768
v_cvt_pk_bf16_f32 v90, v92, v93
v_mfma_f32_16x16x32_bf16 v[100:103], a[140:143], a[68:71], v[100:103]
v_cvt_pk_bf16_f32 v91, v94, v95
v_mfma_f32_16x16x32_bf16 v[108:111], a[136:139], a[72:75], v[108:111]
ds_read_b64_tr_b16 a[130:131], v8 offset:34816
v_mfma_f32_16x16x32_bf16 v[108:111], a[140:143], a[76:79], v[108:111]
buffer_store_dwordx4 v[32:35], v1, s[4:7], s31 offen sc1
v_mfma_f32_16x16x32_bf16 v[116:119], a[136:139], a[80:83], v[116:119]
s_add_u32 s31, s31, s32
ds_read_b64_tr_b16 a[132:133], v8 offset:49152
v_mfma_f32_16x16x32_bf16 v[116:119], a[140:143], a[84:87], v[116:119]
v_mfma_f32_16x16x32_bf16 v[124:127], a[136:139], a[88:91], v[124:127]
ds_read_b64_tr_b16 a[134:135], v8 offset:51200
v_cvt_pk_bf16_f32 v96, v96, v97
v_mfma_f32_16x16x32_bf16 v[124:127], a[140:143], a[92:95], v[124:127]
v_cvt_pk_bf16_f32 v97, v98, v99
v_cvt_pk_bf16_f32 v98, v100, v101
v_mfma_f32_16x16x32_bf16 v[132:135], a[136:139], a[96:99], v[132:135]
ds_read_b128 a[32:35], v2 offset:8192
v_cvt_pk_bf16_f32 v99, v102, v103
v_mfma_f32_16x16x32_bf16 v[132:135], a[140:143], a[100:103], v[132:135]
v_cvt_pk_bf16_f32 v104, v104, v105
v_cvt_pk_bf16_f32 v105, v106, v107
v_mfma_f32_16x16x32_bf16 v[140:143], a[136:139], a[104:107], v[140:143]
v_cvt_pk_bf16_f32 v106, v108, v109
v_cvt_pk_bf16_f32 v107, v110, v111
v_mfma_f32_16x16x32_bf16 v[140:143], a[140:143], a[108:111], v[140:143]
v_cvt_pk_bf16_f32 v112, v112, v113
v_cvt_pk_bf16_f32 v113, v114, v115
v_mfma_f32_16x16x32_bf16 v[148:151], a[136:139], a[112:115], v[148:151]
ds_read_b128 a[36:39], v3 offset:8192
v_cvt_pk_bf16_f32 v114, v116, v117
v_mfma_f32_16x16x32_bf16 v[148:151], a[140:143], a[116:119], v[148:151]
v_cvt_pk_bf16_f32 v115, v118, v119
v_cvt_pk_bf16_f32 v120, v120, v121
v_mfma_f32_16x16x32_bf16 v[156:159], a[136:139], a[120:123], v[156:159]
ds_read_b128 a[40:43], v2 offset:10240
v_cvt_pk_bf16_f32 v121, v122, v123
v_mfma_f32_16x16x32_bf16 v[156:159], a[140:143], a[124:127], v[156:159]
s_waitcnt lgkmcnt(5)
v_cvt_pk_bf16_f32 v122, v124, v125
v_cvt_pk_bf16_f32 v123, v126, v127
v_mfma_f32_16x16x32_bf16 v[160:163], a[128:131], a[64:67], v[160:163]
s_waitcnt lgkmcnt(3)
ds_read_b64_tr_b16 a[136:137], v9 offset:32768
v_cvt_pk_bf16_f32 v128, v128, v129
v_mfma_f32_16x16x32_bf16 v[160:163], a[132:135], a[68:71], v[160:163]
buffer_store_dwordx4 v[40:43], v1, s[4:7], s31 offen sc1
v_mfma_f32_16x16x32_bf16 v[168:171], a[128:131], a[72:75], v[168:171]
s_add_u32 s31, s31, s33
ds_read_b64_tr_b16 a[138:139], v9 offset:34816
v_cvt_pk_bf16_f32 v129, v130, v131
v_mfma_f32_16x16x32_bf16 v[168:171], a[132:135], a[76:79], v[168:171]
v_cvt_pk_bf16_f32 v130, v132, v133
v_cvt_pk_bf16_f32 v131, v134, v135
v_mfma_f32_16x16x32_bf16 v[176:179], a[128:131], a[80:83], v[176:179]
ds_read_b64_tr_b16 a[140:141], v9 offset:49152
v_cvt_pk_bf16_f32 v136, v136, v137
v_mfma_f32_16x16x32_bf16 v[176:179], a[132:135], a[84:87], v[176:179]
v_cvt_pk_bf16_f32 v137, v138, v139
v_cvt_pk_bf16_f32 v138, v140, v141
v_mfma_f32_16x16x32_bf16 v[184:187], a[128:131], a[88:91], v[184:187]
ds_read_b64_tr_b16 a[142:143], v9 offset:51200
v_cvt_pk_bf16_f32 v139, v142, v143
v_mfma_f32_16x16x32_bf16 v[184:187], a[132:135], a[92:95], v[184:187]
v_cvt_pk_bf16_f32 v144, v144, v145
v_cvt_pk_bf16_f32 v145, v146, v147
v_mfma_f32_16x16x32_bf16 v[192:195], a[128:131], a[96:99], v[192:195]
v_cvt_pk_bf16_f32 v146, v148, v149
v_cvt_pk_bf16_f32 v147, v150, v151
v_mfma_f32_16x16x32_bf16 v[192:195], a[132:135], a[100:103], v[192:195]
v_cvt_pk_bf16_f32 v152, v152, v153
v_cvt_pk_bf16_f32 v153, v154, v155
v_mfma_f32_16x16x32_bf16 v[200:203], a[128:131], a[104:107], v[200:203]
ds_read_b128 a[44:47], v3 offset:10240
v_cvt_pk_bf16_f32 v154, v156, v157
v_mfma_f32_16x16x32_bf16 v[200:203], a[132:135], a[108:111], v[200:203]
v_cvt_pk_bf16_f32 v155, v158, v159
v_mfma_f32_16x16x32_bf16 v[208:211], a[128:131], a[112:115], v[208:211]
ds_read_b128 a[48:51], v2 offset:12288
v_mfma_f32_16x16x32_bf16 v[208:211], a[132:135], a[116:119], v[208:211]
v_mfma_f32_16x16x32_bf16 v[216:219], a[128:131], a[120:123], v[216:219]
v_mfma_f32_16x16x32_bf16 v[216:219], a[132:135], a[124:127], v[216:219]
s_waitcnt lgkmcnt(4)
buffer_store_dwordx4 v[48:51], v1, s[4:7], s31 offen sc1
v_mfma_f32_16x16x32_bf16 v[164:167], a[136:139], a[64:67], v[164:167]
s_waitcnt lgkmcnt(2)
s_add_u32 s31, s31, s32
ds_read_b64_tr_b16 a[128:129], v10 offset:32768
v_mfma_f32_16x16x32_bf16 v[164:167], a[140:143], a[68:71], v[164:167]
v_mfma_f32_16x16x32_bf16 v[172:175], a[136:139], a[72:75], v[172:175]
ds_read_b64_tr_b16 a[130:131], v10 offset:34816
v_mfma_f32_16x16x32_bf16 v[172:175], a[140:143], a[76:79], v[172:175]
v_mfma_f32_16x16x32_bf16 v[180:183], a[136:139], a[80:83], v[180:183]
ds_read_b64_tr_b16 a[132:133], v10 offset:49152
v_mfma_f32_16x16x32_bf16 v[180:183], a[140:143], a[84:87], v[180:183]
v_mfma_f32_16x16x32_bf16 v[188:191], a[136:139], a[88:91], v[188:191]
ds_read_b64_tr_b16 a[134:135], v10 offset:51200
v_cvt_pk_bf16_f32 v160, v160, v161
v_mfma_f32_16x16x32_bf16 v[188:191], a[140:143], a[92:95], v[188:191]
v_cvt_pk_bf16_f32 v161, v162, v163
v_cvt_pk_bf16_f32 v162, v164, v165
v_mfma_f32_16x16x32_bf16 v[196:199], a[136:139], a[96:99], v[196:199]
ds_read_b128 a[52:55], v3 offset:12288
v_cvt_pk_bf16_f32 v163, v166, v167
v_mfma_f32_16x16x32_bf16 v[196:199], a[140:143], a[100:103], v[196:199]
v_cvt_pk_bf16_f32 v168, v168, v169
v_cvt_pk_bf16_f32 v169, v170, v171
v_mfma_f32_16x16x32_bf16 v[204:207], a[136:139], a[104:107], v[204:207]
ds_read_b128 a[56:59], v2 offset:14336
v_cvt_pk_bf16_f32 v170, v172, v173
v_mfma_f32_16x16x32_bf16 v[204:207], a[140:143], a[108:111], v[204:207]
v_cvt_pk_bf16_f32 v171, v174, v175
v_cvt_pk_bf16_f32 v176, v176, v177
v_mfma_f32_16x16x32_bf16 v[212:215], a[136:139], a[112:115], v[212:215]
v_cvt_pk_bf16_f32 v177, v178, v179
v_cvt_pk_bf16_f32 v178, v180, v181
v_mfma_f32_16x16x32_bf16 v[212:215], a[140:143], a[116:119], v[212:215]
buffer_store_dwordx4 v[56:59], v1, s[4:7], s31 offen sc1
v_mfma_f32_16x16x32_bf16 v[220:223], a[136:139], a[120:123], v[220:223]
s_add_u32 s31, s31, s34
ds_read_b128 a[60:63], v3 offset:14336
v_cvt_pk_bf16_f32 v179, v182, v183
v_mfma_f32_16x16x32_bf16 v[220:223], a[140:143], a[124:127], v[220:223]
s_waitcnt lgkmcnt(5)
v_cvt_pk_bf16_f32 v184, v184, v185
v_cvt_pk_bf16_f32 v185, v186, v187
v_mfma_f32_16x16x32_bf16 v[224:227], a[128:131], a[64:67], v[224:227]
s_waitcnt lgkmcnt(3)
ds_read_b64_tr_b16 a[136:137], v11 offset:32768
v_cvt_pk_bf16_f32 v186, v188, v189
v_mfma_f32_16x16x32_bf16 v[224:227], a[132:135], a[68:71], v[224:227]
v_cvt_pk_bf16_f32 v187, v190, v191
v_cvt_pk_bf16_f32 v192, v192, v193
v_mfma_f32_16x16x32_bf16 v[232:235], a[128:131], a[72:75], v[232:235]
ds_read_b64_tr_b16 a[138:139], v11 offset:34816
v_cvt_pk_bf16_f32 v193, v194, v195
v_mfma_f32_16x16x32_bf16 v[232:235], a[132:135], a[76:79], v[232:235]
v_cvt_pk_bf16_f32 v194, v196, v197
v_cvt_pk_bf16_f32 v195, v198, v199
v_mfma_f32_16x16x32_bf16 v[240:243], a[128:131], a[80:83], v[240:243]
ds_read_b64_tr_b16 a[140:141], v11 offset:49152
v_cvt_pk_bf16_f32 v200, v200, v201
v_mfma_f32_16x16x32_bf16 v[240:243], a[132:135], a[84:87], v[240:243]
v_cvt_pk_bf16_f32 v201, v202, v203
v_cvt_pk_bf16_f32 v202, v204, v205
v_mfma_f32_16x16x32_bf16 v[248:251], a[128:131], a[88:91], v[248:251]
ds_read_b64_tr_b16 a[142:143], v11 offset:51200
v_cvt_pk_bf16_f32 v203, v206, v207
v_mfma_f32_16x16x32_bf16 v[248:251], a[132:135], a[92:95], v[248:251]
v_cvt_pk_bf16_f32 v208, v208, v209
v_cvt_pk_bf16_f32 v209, v210, v211
v_mfma_f32_16x16x32_bf16 a[224:227], a[128:131], a[96:99], a[224:227]
v_cvt_pk_bf16_f32 v210, v212, v213
v_cvt_pk_bf16_f32 v211, v214, v215
v_mfma_f32_16x16x32_bf16 a[224:227], a[132:135], a[100:103], a[224:227]
v_cvt_pk_bf16_f32 v216, v216, v217
v_cvt_pk_bf16_f32 v217, v218, v219
v_mfma_f32_16x16x32_bf16 a[232:235], a[128:131], a[104:107], a[232:235]
v_cvt_pk_bf16_f32 v218, v220, v221
v_cvt_pk_bf16_f32 v219, v222, v223
v_mfma_f32_16x16x32_bf16 a[232:235], a[132:135], a[108:111], a[232:235]
buffer_store_dwordx4 v[64:67], v1, s[4:7], s31 offen sc1
v_mfma_f32_16x16x32_bf16 a[240:243], a[128:131], a[112:115], a[240:243]
s_add_u32 s31, s31, s32
v_mfma_f32_16x16x32_bf16 a[240:243], a[132:135], a[116:119], a[240:243]
v_mfma_f32_16x16x32_bf16 a[248:251], a[128:131], a[120:123], a[248:251]
v_mfma_f32_16x16x32_bf16 a[248:251], a[132:135], a[124:127], a[248:251]
s_waitcnt vmcnt(21) lgkmcnt(0)
s_barrier
v_mfma_f32_16x16x32_bf16 v[228:231], a[136:139], a[64:67], v[228:231]
s_add_u32 m0, s29, 98304
ds_read_b64_tr_b16 a[128:129], v22 offset:0
v_mfma_f32_16x16x32_bf16 v[228:231], a[140:143], a[68:71], v[228:231]
buffer_load_dwordx4 v16, s[12:15], s26 offen offset:0 lds
v_mfma_f32_16x16x32_bf16 v[236:239], a[136:139], a[72:75], v[236:239]
ds_read_b64_tr_b16 a[130:131], v22 offset:2048
v_mfma_f32_16x16x32_bf16 v[236:239], a[140:143], a[76:79], v[236:239]
v_mfma_f32_16x16x32_bf16 v[244:247], a[136:139], a[80:83], v[244:247]
ds_read_b64_tr_b16 a[132:133], v22 offset:16384
v_mfma_f32_16x16x32_bf16 v[244:247], a[140:143], a[84:87], v[244:247]
buffer_load_dwordx4 v17, s[12:15], s26 offen offset:1024 lds
v_mfma_f32_16x16x32_bf16 v[252:255], a[136:139], a[88:91], v[252:255]
ds_read_b64_tr_b16 a[134:135], v22 offset:18432
v_add_u32 v22, 4294901760, v22
v_mfma_f32_16x16x32_bf16 v[252:255], a[140:143], a[92:95], v[252:255]
v_mfma_f32_16x16x32_bf16 a[228:231], a[136:139], a[96:99], a[228:231]
v_mfma_f32_16x16x32_bf16 a[228:231], a[140:143], a[100:103], a[228:231]
buffer_load_dwordx4 v18, s[12:15], s26 offen offset:2048 lds
v_mfma_f32_16x16x32_bf16 a[236:239], a[136:139], a[104:107], a[236:239]
buffer_store_dwordx4 v[72:75], v1, s[4:7], s31 offen sc1
v_mfma_f32_16x16x32_bf16 a[236:239], a[140:143], a[108:111], a[236:239]
s_add_u32 s31, s31, s33
v_mfma_f32_16x16x32_bf16 a[244:247], a[136:139], a[112:115], a[244:247]
v_mfma_f32_16x16x32_bf16 a[244:247], a[140:143], a[116:119], a[244:247]
buffer_load_dwordx4 v19, s[12:15], s26 offen offset:3072 lds
v_mfma_f32_16x16x32_bf16 a[252:255], a[136:139], a[120:123], a[252:255]
s_add_u32 s26, s26, 524288
v_mfma_f32_16x16x32_bf16 a[252:255], a[140:143], a[124:127], a[252:255]
s_waitcnt lgkmcnt(2)
s_branch M_Q
M_V:
s_lshl_b32 s22, s22, 14
s_add_u32 s31, s31, s22
s_add_u32 s31, s31, 16777216
s_mov_b32 s32, 1024
s_mov_b32 s33, 31744
s_mov_b32 s34, 4294935552
s_mov_b32 s35, 4294935552
s_mov_b32 s36, 4294935552
s_mov_b32 s30, 6
v_mfma_f32_16x16x32_bf16 v[32:35], a[0:3], a[128:131], 0
s_add_u32 m0, s29, 114688
ds_read_b64_tr_b16 a[136:137], v5 offset:0
v_mfma_f32_16x16x32_bf16 v[32:35], a[4:7], a[132:135], v[32:35]
buffer_load_dwordx4 v16, s[12:15], s27 offen offset:0 nt lds
v_mfma_f32_16x16x32_bf16 v[36:39], a[8:11], a[128:131], 0
ds_read_b64_tr_b16 a[138:139], v5 offset:2048
v_mfma_f32_16x16x32_bf16 v[36:39], a[12:15], a[132:135], v[36:39]
v_mfma_f32_16x16x32_bf16 v[40:43], a[16:19], a[128:131], 0
ds_read_b64_tr_b16 a[140:141], v5 offset:16384
v_mfma_f32_16x16x32_bf16 v[40:43], a[20:23], a[132:135], v[40:43]
buffer_load_dwordx4 v17, s[12:15], s27 offen offset:1024 nt lds
v_mfma_f32_16x16x32_bf16 v[44:47], a[24:27], a[128:131], 0
ds_read_b64_tr_b16 a[142:143], v5 offset:18432
v_mfma_f32_16x16x32_bf16 v[44:47], a[28:31], a[132:135], v[44:47]
v_mfma_f32_16x16x32_bf16 v[48:51], a[32:35], a[128:131], 0
ds_read_b128 a[64:67], v2 offset:32768
v_mfma_f32_16x16x32_bf16 v[48:51], a[36:39], a[132:135], v[48:51]
buffer_load_dwordx4 v18, s[12:15], s27 offen offset:2048 nt lds
v_mfma_f32_16x16x32_bf16 v[52:55], a[40:43], a[128:131], 0
ds_read_b128 a[68:71], v3 offset:32768
v_mfma_f32_16x16x32_bf16 v[52:55], a[44:47], a[132:135], v[52:55]
v_mfma_f32_16x16x32_bf16 v[56:59], a[48:51], a[128:131], 0
v_mfma_f32_16x16x32_bf16 v[56:59], a[52:55], a[132:135], v[56:59]
buffer_load_dwordx4 v19, s[12:15], s27 offen offset:3072 nt lds
v_mfma_f32_16x16x32_bf16 v[60:63], a[56:59], a[128:131], 0
s_add_u32 s27, s27, 524288
ds_read_b128 a[72:75], v2 offset:34816
v_mfma_f32_16x16x32_bf16 v[60:63], a[60:63], a[132:135], v[60:63]
s_waitcnt vmcnt(8) lgkmcnt(3)
v_mfma_f32_16x16x32_bf16 v[64:67], a[0:3], a[136:139], 0
s_add_u32 m0, s28, 0
ds_read_b64_tr_b16 a[128:129], v6 offset:0
v_lshlrev_b32 v204, 16, v244
v_and_b32 v205, 0xffff0000, v244
v_mfma_f32_16x16x32_bf16 v[64:67], a[4:7], a[140:143], v[64:67]
buffer_load_dwordx4 v12, s[8:11], s24 offen offset:0 lds
v_lshlrev_b32 v206, 16, v245
v_mfma_f32_16x16x32_bf16 v[68:71], a[8:11], a[136:139], 0
ds_read_b64_tr_b16 a[130:131], v6 offset:2048
v_and_b32 v207, 0xffff0000, v245
v_lshlrev_b32 v192, 16, v224
v_lshlrev_b32 v193, 16, v225
v_mfma_f32_16x16x32_bf16 v[68:71], a[12:15], a[140:143], v[68:71]
v_lshlrev_b32 v194, 16, v226
v_lshlrev_b32 v195, 16, v227
v_mul_f32 v208, v192, v207
v_mfma_f32_16x16x32_bf16 v[72:75], a[16:19], a[136:139], 0
ds_read_b64_tr_b16 a[132:133], v6 offset:16384
v_lshlrev_b32 v203, 16, v235
v_fmac_f32 v208, v193, v206
v_fmac_f32 v208, v194, v205
v_mfma_f32_16x16x32_bf16 v[72:75], a[20:23], a[140:143], v[72:75]
buffer_load_dwordx4 v13, s[8:11], s24 offen offset:1024 lds
v_fmac_f32 v208, v195, v204
v_mfma_f32_16x16x32_bf16 v[76:79], a[24:27], a[136:139], 0
ds_read_b64_tr_b16 a[134:135], v6 offset:18432
v_mul_f32 v208, v208, v203
v_lshlrev_b32 v196, 16, v228
v_mul_f32 v209, v193, v207
v_mfma_f32_16x16x32_bf16 v[76:79], a[28:31], a[140:143], v[76:79]
v_lshlrev_b32 v203, 16, v236
v_fmac_f32 v209, v194, v206
v_fmac_f32 v209, v195, v205
v_mfma_f32_16x16x32_bf16 v[80:83], a[32:35], a[136:139], 0
ds_read_b128 a[76:79], v3 offset:34816
v_fmac_f32 v209, v196, v204
v_mul_f32 v209, v209, v203
v_cvt_pk_bf16_f32 v216, v208, v209
v_mfma_f32_16x16x32_bf16 v[80:83], a[36:39], a[140:143], v[80:83]
buffer_load_dwordx4 v14, s[8:11], s24 offen offset:2048 lds
v_lshlrev_b32 v197, 16, v229
v_mfma_f32_16x16x32_bf16 v[84:87], a[40:43], a[136:139], 0
v_mul_f32 v210, v194, v207
v_lshlrev_b32 v203, 16, v237
v_fmac_f32 v210, v195, v206
v_mfma_f32_16x16x32_bf16 v[84:87], a[44:47], a[140:143], v[84:87]
v_fmac_f32 v210, v196, v205
v_fmac_f32 v210, v197, v204
v_mul_f32 v210, v210, v203
v_lshlrev_b32 v198, 16, v230
v_mfma_f32_16x16x32_bf16 v[88:91], a[48:51], a[136:139], 0
ds_read_b128 a[80:83], v2 offset:36864
v_mul_f32 v211, v195, v207
v_lshlrev_b32 v203, 16, v238
v_mfma_f32_16x16x32_bf16 v[88:91], a[52:55], a[140:143], v[88:91]
buffer_load_dwordx4 v15, s[8:11], s24 offen offset:3072 lds
v_fmac_f32 v211, v196, v206
v_fmac_f32 v211, v197, v205
v_mfma_f32_16x16x32_bf16 v[92:95], a[56:59], a[136:139], 0
s_add_u32 s24, s24, 128
ds_read_b128 a[84:87], v3 offset:36864
v_fmac_f32 v211, v198, v204
v_mul_f32 v211, v211, v203
v_mfma_f32_16x16x32_bf16 v[92:95], a[60:63], a[140:143], v[92:95]
s_waitcnt lgkmcnt(3)
v_cvt_pk_bf16_f32 v217, v210, v211
v_lshlrev_b32 v199, 16, v231
v_mul_f32 v212, v196, v207
v_lshlrev_b32 v203, 16, v239
v_mfma_f32_16x16x32_bf16 v[96:99], a[0:3], a[128:131], 0
s_add_u32 m0, s28, 4096
ds_read_b64_tr_b16 a[136:137], v7 offset:0
v_fmac_f32 v212, v197, v206
v_fmac_f32 v212, v198, v205
v_mfma_f32_16x16x32_bf16 v[96:99], a[4:7], a[132:135], v[96:99]
buffer_load_dwordx4 v12, s[8:11], s25 offen offset:0 lds
v_fmac_f32 v212, v199, v204
v_mul_f32 v212, v212, v203
v_mfma_f32_16x16x32_bf16 v[100:103], a[8:11], a[128:131], 0
ds_read_b64_tr_b16 a[138:139], v7 offset:2048
v_lshlrev_b32 v200, 16, v232
v_mul_f32 v213, v197, v207
v_mfma_f32_16x16x32_bf16 v[100:103], a[12:15], a[132:135], v[100:103]
v_lshlrev_b32 v203, 16, v240
v_fmac_f32 v213, v198, v206
v_fmac_f32 v213, v199, v205
v_fmac_f32 v213, v200, v204
v_mfma_f32_16x16x32_bf16 v[104:107], a[16:19], a[128:131], 0
ds_read_b64_tr_b16 a[140:141], v7 offset:16384
v_mul_f32 v213, v213, v203
v_cvt_pk_bf16_f32 v218, v212, v213
v_mfma_f32_16x16x32_bf16 v[104:107], a[20:23], a[132:135], v[104:107]
buffer_load_dwordx4 v13, s[8:11], s25 offen offset:1024 lds
v_lshlrev_b32 v201, 16, v233
v_mfma_f32_16x16x32_bf16 v[108:111], a[24:27], a[128:131], 0
ds_read_b64_tr_b16 a[142:143], v7 offset:18432
v_mul_f32 v214, v198, v207
v_lshlrev_b32 v203, 16, v241
v_fmac_f32 v214, v199, v206
v_mfma_f32_16x16x32_bf16 v[108:111], a[28:31], a[132:135], v[108:111]
v_fmac_f32 v214, v200, v205
v_fmac_f32 v214, v201, v204
v_mul_f32 v214, v214, v203
v_mfma_f32_16x16x32_bf16 v[112:115], a[32:35], a[128:131], 0
v_lshlrev_b32 v202, 16, v234
v_mul_f32 v215, v199, v207
v_lshlrev_b32 v203, 16, v242
v_fmac_f32 v215, v200, v206
v_mfma_f32_16x16x32_bf16 v[112:115], a[36:39], a[132:135], v[112:115]
buffer_load_dwordx4 v14, s[8:11], s25 offen offset:2048 lds
v_fmac_f32 v215, v201, v205
v_mfma_f32_16x16x32_bf16 v[116:119], a[40:43], a[128:131], 0
ds_read_b128 a[88:91], v2 offset:38912
v_fmac_f32 v215, v202, v204
v_mul_f32 v215, v215, v203
v_cvt_pk_bf16_f32 v219, v214, v215
v_mfma_f32_16x16x32_bf16 v[116:119], a[44:47], a[132:135], v[116:119]
v_lshlrev_b32 v204, 16, v246
v_and_b32 v205, 0xffff0000, v246
v_lshlrev_b32 v206, 16, v247
v_mfma_f32_16x16x32_bf16 v[120:123], a[48:51], a[128:131], 0
ds_read_b128 a[92:95], v3 offset:38912
v_and_b32 v207, 0xffff0000, v247
v_and_b32 v192, 0xffff0000, v224
v_and_b32 v193, 0xffff0000, v225
v_mfma_f32_16x16x32_bf16 v[120:123], a[52:55], a[132:135], v[120:123]
s_waitcnt lgkmcnt(2)
buffer_load_dwordx4 v15, s[8:11], s25 offen offset:3072 lds
v_and_b32 v194, 0xffff0000, v226
v_mfma_f32_16x16x32_bf16 v[124:127], a[56:59], a[128:131], 0
s_add_u32 s25, s25, 128
v_and_b32 v195, 0xffff0000, v227
v_mul_f32 v208, v192, v207
v_and_b32 v203, 0xffff0000, v235
v_mfma_f32_16x16x32_bf16 v[124:127], a[60:63], a[132:135], v[124:127]
s_cmp_eq_u32 s3, 0
v_fmac_f32 v208, v193, v206
v_fmac_f32 v208, v194, v205
v_fmac_f32 v208, v195, v204
v_mul_f32 v208, v208, v203
v_mfma_f32_16x16x32_bf16 v[128:131], a[0:3], a[136:139], 0
s_cselect_b32 s23, s43, 3221225472
ds_read_b64_tr_b16 a[128:129], v8 offset:0
v_and_b32 v196, 0xffff0000, v228
v_mul_f32 v209, v193, v207
v_mfma_f32_16x16x32_bf16 v[128:131], a[4:7], a[140:143], v[128:131]
buffer_load_dword v21, v20, s[16:19], s23 offen nt
v_and_b32 v203, 0xffff0000, v236
v_fmac_f32 v209, v194, v206
v_mfma_f32_16x16x32_bf16 v[132:135], a[8:11], a[136:139], 0
s_cselect_b32 s23, 3221225472, s43
ds_read_b64_tr_b16 a[130:131], v8 offset:2048
v_fmac_f32 v209, v195, v205
v_fmac_f32 v209, v196, v204
v_mfma_f32_16x16x32_bf16 v[132:135], a[12:15], a[140:143], v[132:135]
buffer_load_dword v21, v20, s[16:19], s23 offen
v_mul_f32 v209, v209, v203
v_cvt_pk_bf16_f32 v220, v208, v209
v_mfma_f32_16x16x32_bf16 v[136:139], a[16:19], a[136:139], 0
s_add_u32 s43, s43, s47
ds_read_b64_tr_b16 a[132:133], v8 offset:16384
v_and_b32 v197, 0xffff0000, v229
v_mul_f32 v210, v194, v207
v_mfma_f32_16x16x32_bf16 v[136:139], a[20:23], a[140:143], v[136:139]
s_cmp_ge_u32 s43, s51
v_and_b32 v203, 0xffff0000, v237
v_fmac_f32 v210, v195, v206
v_fmac_f32 v210, v196, v205
v_fmac_f32 v210, v197, v204
v_mfma_f32_16x16x32_bf16 v[140:143], a[24:27], a[136:139], 0
s_cselect_b32 s43, 0, s43
ds_read_b64_tr_b16 a[134:135], v8 offset:18432
v_mul_f32 v210, v210, v203
v_and_b32 v198, 0xffff0000, v230
v_mfma_f32_16x16x32_bf16 v[140:143], a[28:31], a[140:143], v[140:143]
s_cselect_b32 s51, s42, s51
v_mul_f32 v211, v195, v207
v_and_b32 v203, 0xffff0000, v238
v_fmac_f32 v211, v196, v206
v_fmac_f32 v211, v197, v205
v_mfma_f32_16x16x32_bf16 v[144:147], a[32:35], a[136:139], 0
s_cselect_b64 s[16:17], s[40:41], s[16:17]
ds_read_b128 a[96:99], v2 offset:40960
v_fmac_f32 v211, v198, v204
v_mul_f32 v211, v211, v203
v_mfma_f32_16x16x32_bf16 v[144:147], a[36:39], a[140:143], v[144:147]
s_cselect_b32 s18, s42, s18
v_cvt_pk_bf16_f32 v221, v210, v211
v_and_b32 v199, 0xffff0000, v231
v_mul_f32 v212, v196, v207
v_mfma_f32_16x16x32_bf16 v[148:151], a[40:43], a[136:139], 0
s_cselect_b64 s[40:41], s[44:45], s[40:41]
v_and_b32 v203, 0xffff0000, v239
v_fmac_f32 v212, v197, v206
v_fmac_f32 v212, v198, v205
v_fmac_f32 v212, v199, v204
v_mfma_f32_16x16x32_bf16 v[148:151], a[44:47], a[140:143], v[148:151]
s_cselect_b32 s42, s46, s42
v_mul_f32 v212, v212, v203
v_and_b32 v200, 0xffff0000, v232
v_mul_f32 v213, v197, v207
v_mfma_f32_16x16x32_bf16 v[152:155], a[48:51], a[136:139], 0
s_cselect_b64 s[44:45], s[48:49], s[44:45]
ds_read_b128 a[100:103], v3 offset:40960
v_and_b32 v203, 0xffff0000, v240
v_fmac_f32 v213, v198, v206
v_fmac_f32 v213, v199, v205
v_mfma_f32_16x16x32_bf16 v[152:155], a[52:55], a[140:143], v[152:155]
s_cselect_b32 s46, s50, s46
v_fmac_f32 v213, v200, v204
v_mul_f32 v213, v213, v203
v_cvt_pk_bf16_f32 v222, v212, v213
v_mfma_f32_16x16x32_bf16 v[156:159], a[56:59], a[136:139], 0
s_cselect_b64 s[48:49], s[52:53], s[48:49]
ds_read_b128 a[104:107], v2 offset:43008
v_and_b32 v201, 0xffff0000, v233
v_mul_f32 v214, v198, v207
v_and_b32 v203, 0xffff0000, v241
v_mfma_f32_16x16x32_bf16 v[156:159], a[60:63], a[140:143], v[156:159]
s_waitcnt lgkmcnt(3)
s_cselect_b32 s50, s54, s50
v_fmac_f32 v214, v199, v206
v_fmac_f32 v214, v200, v205
v_fmac_f32 v214, v201, v204
v_mfma_f32_16x16x32_bf16 v[160:163], a[0:3], a[128:131], 0
s_cselect_b32 s54, 0, s54
ds_read_b64_tr_b16 a[136:137], v9 offset:0
v_mul_f32 v214, v214, v203
v_and_b32 v202, 0xffff0000, v234
v_mul_f32 v215, v199, v207
v_mfma_f32_16x16x32_bf16 v[160:163], a[4:7], a[132:135], v[160:163]
v_and_b32 v203, 0xffff0000, v242
v_fmac_f32 v215, v200, v206
v_fmac_f32 v215, v201, v205
v_mfma_f32_16x16x32_bf16 v[164:167], a[8:11], a[128:131], 0
ds_read_b64_tr_b16 a[138:139], v9 offset:2048
v_fmac_f32 v215, v202, v204
v_mul_f32 v215, v215, v203
v_cvt_pk_bf16_f32 v223, v214, v215
v_mfma_f32_16x16x32_bf16 v[164:167], a[12:15], a[132:135], v[164:167]
buffer_store_dwordx4 v[216:219], v250, s[4:7], s38 offen offset:16 sc1
v_mfma_f32_16x16x32_bf16 v[168:171], a[16:19], a[128:131], 0
ds_read_b64_tr_b16 a[140:141], v9 offset:16384
v_mfma_f32_16x16x32_bf16 v[168:171], a[20:23], a[132:135], v[168:171]
buffer_store_dwordx4 v[220:223], v250, s[4:7], s39 offen offset:16 sc1
v_mfma_f32_16x16x32_bf16 v[172:175], a[24:27], a[128:131], 0
ds_read_b64_tr_b16 a[142:143], v9 offset:18432
v_mfma_f32_16x16x32_bf16 v[172:175], a[28:31], a[132:135], v[172:175]
v_mfma_f32_16x16x32_bf16 v[176:179], a[32:35], a[128:131], 0
v_mfma_f32_16x16x32_bf16 v[176:179], a[36:39], a[132:135], v[176:179]
v_mfma_f32_16x16x32_bf16 v[180:183], a[40:43], a[128:131], 0
ds_read_b128 a[108:111], v3 offset:43008
v_mfma_f32_16x16x32_bf16 v[180:183], a[44:47], a[132:135], v[180:183]
buffer_store_dwordx2 v[252:253], v251, s[4:7], s38 offen offset:8 sc1
v_mfma_f32_16x16x32_bf16 v[184:187], a[48:51], a[128:131], 0
ds_read_b128 a[112:115], v2 offset:45056
v_mfma_f32_16x16x32_bf16 v[184:187], a[52:55], a[132:135], v[184:187]
buffer_store_dwordx2 v[252:253], v251, s[4:7], s39 offen offset:8 sc1
v_mfma_f32_16x16x32_bf16 v[188:191], a[56:59], a[128:131], 0
v_mfma_f32_16x16x32_bf16 v[188:191], a[60:63], a[132:135], v[188:191]
s_waitcnt lgkmcnt(4)
v_mfma_f32_16x16x32_bf16 v[192:195], a[0:3], a[136:139], 0
s_waitcnt lgkmcnt(2)
ds_read_b64_tr_b16 a[128:129], v10 offset:0
v_mfma_f32_16x16x32_bf16 v[192:195], a[4:7], a[140:143], v[192:195]
v_mfma_f32_16x16x32_bf16 v[196:199], a[8:11], a[136:139], 0
ds_read_b64_tr_b16 a[130:131], v10 offset:2048
v_mfma_f32_16x16x32_bf16 v[196:199], a[12:15], a[140:143], v[196:199]
v_mfma_f32_16x16x32_bf16 v[200:203], a[16:19], a[136:139], 0
ds_read_b64_tr_b16 a[132:133], v10 offset:16384
v_mfma_f32_16x16x32_bf16 v[200:203], a[20:23], a[140:143], v[200:203]
v_mfma_f32_16x16x32_bf16 v[204:207], a[24:27], a[136:139], 0
ds_read_b64_tr_b16 a[134:135], v10 offset:18432
v_mfma_f32_16x16x32_bf16 v[204:207], a[28:31], a[140:143], v[204:207]
v_mfma_f32_16x16x32_bf16 v[208:211], a[32:35], a[136:139], 0
ds_read_b128 a[116:119], v3 offset:45056
v_mfma_f32_16x16x32_bf16 v[208:211], a[36:39], a[140:143], v[208:211]
v_mfma_f32_16x16x32_bf16 v[212:215], a[40:43], a[136:139], 0
ds_read_b128 a[120:123], v2 offset:47104
v_mfma_f32_16x16x32_bf16 v[212:215], a[44:47], a[140:143], v[212:215]
v_mfma_f32_16x16x32_bf16 v[216:219], a[48:51], a[136:139], 0
v_mfma_f32_16x16x32_bf16 v[216:219], a[52:55], a[140:143], v[216:219]
v_mfma_f32_16x16x32_bf16 v[220:223], a[56:59], a[136:139], 0
ds_read_b128 a[124:127], v3 offset:47104
v_mfma_f32_16x16x32_bf16 v[220:223], a[60:63], a[140:143], v[220:223]
s_waitcnt lgkmcnt(5)
v_mfma_f32_16x16x32_bf16 v[224:227], a[0:3], a[128:131], 0
s_waitcnt lgkmcnt(3)
ds_read_b64_tr_b16 a[136:137], v11 offset:0
v_mfma_f32_16x16x32_bf16 v[224:227], a[4:7], a[132:135], v[224:227]
v_mfma_f32_16x16x32_bf16 v[228:231], a[8:11], a[128:131], 0
ds_read_b64_tr_b16 a[138:139], v11 offset:2048
v_mfma_f32_16x16x32_bf16 v[228:231], a[12:15], a[132:135], v[228:231]
v_mfma_f32_16x16x32_bf16 v[232:235], a[16:19], a[128:131], 0
ds_read_b64_tr_b16 a[140:141], v11 offset:16384
v_mfma_f32_16x16x32_bf16 v[232:235], a[20:23], a[132:135], v[232:235]
v_mfma_f32_16x16x32_bf16 v[236:239], a[24:27], a[128:131], 0
ds_read_b64_tr_b16 a[142:143], v11 offset:18432
v_mfma_f32_16x16x32_bf16 v[236:239], a[28:31], a[132:135], v[236:239]
v_mfma_f32_16x16x32_bf16 v[240:243], a[32:35], a[128:131], 0
v_mfma_f32_16x16x32_bf16 v[240:243], a[36:39], a[132:135], v[240:243]
v_mfma_f32_16x16x32_bf16 v[244:247], a[40:43], a[128:131], 0
v_mfma_f32_16x16x32_bf16 v[244:247], a[44:47], a[132:135], v[244:247]
v_mfma_f32_16x16x32_bf16 v[248:251], a[48:51], a[128:131], 0
v_mfma_f32_16x16x32_bf16 v[248:251], a[52:55], a[132:135], v[248:251]
v_mfma_f32_16x16x32_bf16 v[252:255], a[56:59], a[128:131], 0
v_mfma_f32_16x16x32_bf16 v[252:255], a[60:63], a[132:135], v[252:255]
s_waitcnt vmcnt(6) lgkmcnt(0)
s_barrier
v_mfma_f32_16x16x32_bf16 a[224:227], a[0:3], a[136:139], 0
s_add_u32 m0, s29, 65536
ds_read_b64_tr_b16 a[128:129], v4 offset:32768
v_mfma_f32_16x16x32_bf16 a[224:227], a[4:7], a[140:143], a[224:227]
buffer_load_dwordx4 v16, s[12:15], s26 offen offset:0 lds
v_mfma_f32_16x16x32_bf16 a[228:231], a[8:11], a[136:139], 0
ds_read_b64_tr_b16 a[130:131], v4 offset:34816
v_mfma_f32_16x16x32_bf16 a[228:231], a[12:15], a[140:143], a[228:231]
v_mfma_f32_16x16x32_bf16 a[232:235], a[16:19], a[136:139], 0
ds_read_b64_tr_b16 a[132:133], v4 offset:49152
v_mfma_f32_16x16x32_bf16 a[232:235], a[20:23], a[140:143], a[232:235]
buffer_load_dwordx4 v17, s[12:15], s26 offen offset:1024 lds
v_mfma_f32_16x16x32_bf16 a[236:239], a[24:27], a[136:139], 0
ds_read_b64_tr_b16 a[134:135], v4 offset:51200
v_mfma_f32_16x16x32_bf16 a[236:239], a[28:31], a[140:143], a[236:239]
v_mfma_f32_16x16x32_bf16 a[240:243], a[32:35], a[136:139], 0
v_mfma_f32_16x16x32_bf16 a[240:243], a[36:39], a[140:143], a[240:243]
buffer_load_dwordx4 v18, s[12:15], s26 offen offset:2048 lds
v_mfma_f32_16x16x32_bf16 a[244:247], a[40:43], a[136:139], 0
v_mfma_f32_16x16x32_bf16 a[244:247], a[44:47], a[140:143], a[244:247]
v_mfma_f32_16x16x32_bf16 a[248:251], a[48:51], a[136:139], 0
v_mfma_f32_16x16x32_bf16 a[248:251], a[52:55], a[140:143], a[248:251]
buffer_load_dwordx4 v19, s[12:15], s26 offen offset:3072 lds
v_mfma_f32_16x16x32_bf16 a[252:255], a[56:59], a[136:139], 0
s_add_u32 s26, s26, 524288
v_mfma_f32_16x16x32_bf16 a[252:255], a[60:63], a[140:143], a[252:255]
s_waitcnt lgkmcnt(2)
Lg_2:
v_mfma_f32_16x16x32_bf16 v[32:35], a[64:67], a[128:131], v[32:35]
s_waitcnt lgkmcnt(0)
s_add_u32 m0, s29, 81920
ds_read_b64_tr_b16 a[136:137], v5 offset:32768
v_mfma_f32_16x16x32_bf16 v[32:35], a[68:71], a[132:135], v[32:35]
buffer_load_dwordx4 v16, s[12:15], s27 offen offset:0 lds
v_mfma_f32_16x16x32_bf16 v[36:39], a[72:75], a[128:131], v[36:39]
ds_read_b64_tr_b16 a[138:139], v5 offset:34816
v_mfma_f32_16x16x32_bf16 v[36:39], a[76:79], a[132:135], v[36:39]
v_mfma_f32_16x16x32_bf16 v[40:43], a[80:83], a[128:131], v[40:43]
ds_read_b64_tr_b16 a[140:141], v5 offset:49152
v_mfma_f32_16x16x32_bf16 v[40:43], a[84:87], a[132:135], v[40:43]
buffer_load_dwordx4 v17, s[12:15], s27 offen offset:1024 lds
v_mfma_f32_16x16x32_bf16 v[44:47], a[88:91], a[128:131], v[44:47]
ds_read_b64_tr_b16 a[142:143], v5 offset:51200
v_mfma_f32_16x16x32_bf16 v[44:47], a[92:95], a[132:135], v[44:47]
v_mfma_f32_16x16x32_bf16 v[48:51], a[96:99], a[128:131], v[48:51]
ds_read_b128 a[0:3], v2 offset:0
v_mfma_f32_16x16x32_bf16 v[48:51], a[100:103], a[132:135], v[48:51]
buffer_load_dwordx4 v18, s[12:15], s27 offen offset:2048 lds
v_mfma_f32_16x16x32_bf16 v[52:55], a[104:107], a[128:131], v[52:55]
ds_read_b128 a[4:7], v3 offset:0
v_mfma_f32_16x16x32_bf16 v[52:55], a[108:111], a[132:135], v[52:55]
v_mfma_f32_16x16x32_bf16 v[56:59], a[112:115], a[128:131], v[56:59]
v_mfma_f32_16x16x32_bf16 v[56:59], a[116:119], a[132:135], v[56:59]
buffer_load_dwordx4 v19, s[12:15], s27 offen offset:3072 lds
v_mfma_f32_16x16x32_bf16 v[60:63], a[120:123], a[128:131], v[60:63]
s_add_u32 s27, s27, 524288
ds_read_b128 a[8:11], v2 offset:2048
v_mfma_f32_16x16x32_bf16 v[60:63], a[124:127], a[132:135], v[60:63]
s_waitcnt lgkmcnt(5)
v_mfma_f32_16x16x32_bf16 v[64:67], a[64:67], a[136:139], v[64:67]
s_waitcnt lgkmcnt(3)
s_add_u32 m0, s28, 32768
ds_read_b64_tr_b16 a[128:129], v6 offset:32768
v_mfma_f32_16x16x32_bf16 v[64:67], a[68:71], a[140:143], v[64:67]
buffer_load_dwordx4 v12, s[8:11], s24 offen offset:0 lds
v_mfma_f32_16x16x32_bf16 v[68:71], a[72:75], a[136:139], v[68:71]
ds_read_b64_tr_b16 a[130:131], v6 offset:34816
v_mfma_f32_16x16x32_bf16 v[68:71], a[76:79], a[140:143], v[68:71]
v_mfma_f32_16x16x32_bf16 v[72:75], a[80:83], a[136:139], v[72:75]
ds_read_b64_tr_b16 a[132:133], v6 offset:49152
v_mfma_f32_16x16x32_bf16 v[72:75], a[84:87], a[140:143], v[72:75]
buffer_load_dwordx4 v13, s[8:11], s24 offen offset:1024 lds
v_mfma_f32_16x16x32_bf16 v[76:79], a[88:91], a[136:139], v[76:79]
ds_read_b64_tr_b16 a[134:135], v6 offset:51200
v_mfma_f32_16x16x32_bf16 v[76:79], a[92:95], a[140:143], v[76:79]
v_mfma_f32_16x16x32_bf16 v[80:83], a[96:99], a[136:139], v[80:83]
ds_read_b128 a[12:15], v3 offset:2048
v_mfma_f32_16x16x32_bf16 v[80:83], a[100:103], a[140:143], v[80:83]
buffer_load_dwordx4 v14, s[8:11], s24 offen offset:2048 lds
v_mfma_f32_16x16x32_bf16 v[84:87], a[104:107], a[136:139], v[84:87]
v_mfma_f32_16x16x32_bf16 v[84:87], a[108:111], a[140:143], v[84:87]
v_mfma_f32_16x16x32_bf16 v[88:91], a[112:115], a[136:139], v[88:91]
ds_read_b128 a[16:19], v2 offset:4096
v_mfma_f32_16x16x32_bf16 v[88:91], a[116:119], a[140:143], v[88:91]
buffer_load_dwordx4 v15, s[8:11], s24 offen offset:3072 lds
v_mfma_f32_16x16x32_bf16 v[92:95], a[120:123], a[136:139], v[92:95]
s_add_u32 s24, s24, 128
ds_read_b128 a[20:23], v3 offset:4096
v_mfma_f32_16x16x32_bf16 v[92:95], a[124:127], a[140:143], v[92:95]
s_waitcnt lgkmcnt(5)
v_mfma_f32_16x16x32_bf16 v[96:99], a[64:67], a[128:131], v[96:99]
s_waitcnt lgkmcnt(3)
s_add_u32 m0, s28, 36864
ds_read_b64_tr_b16 a[136:137], v7 offset:32768
v_mfma_f32_16x16x32_bf16 v[96:99], a[68:71], a[132:135], v[96:99]
buffer_load_dwordx4 v12, s[8:11], s25 offen offset:0 lds
v_mfma_f32_16x16x32_bf16 v[100:103], a[72:75], a[128:131], v[100:103]
ds_read_b64_tr_b16 a[138:139], v7 offset:34816
v_mfma_f32_16x16x32_bf16 v[100:103], a[76:79], a[132:135], v[100:103]
v_mfma_f32_16x16x32_bf16 v[104:107], a[80:83], a[128:131], v[104:107]
ds_read_b64_tr_b16 a[140:141], v7 offset:49152
v_mfma_f32_16x16x32_bf16 v[104:107], a[84:87], a[132:135], v[104:107]
buffer_load_dwordx4 v13, s[8:11], s25 offen offset:1024 lds
v_mfma_f32_16x16x32_bf16 v[108:111], a[88:91], a[128:131], v[108:111]
ds_read_b64_tr_b16 a[142:143], v7 offset:51200
v_mfma_f32_16x16x32_bf16 v[108:111], a[92:95], a[132:135], v[108:111]
v_mfma_f32_16x16x32_bf16 v[112:115], a[96:99], a[128:131], v[112:115]
v_mfma_f32_16x16x32_bf16 v[112:115], a[100:103], a[132:135], v[112:115]
buffer_load_dwordx4 v14, s[8:11], s25 offen offset:2048 lds
v_mfma_f32_16x16x32_bf16 v[116:119], a[104:107], a[128:131], v[116:119]
ds_read_b128 a[24:27], v2 offset:6144
v_mfma_f32_16x16x32_bf16 v[116:119], a[108:111], a[132:135], v[116:119]
v_mfma_f32_16x16x32_bf16 v[120:123], a[112:115], a[128:131], v[120:123]
ds_read_b128 a[28:31], v3 offset:6144
v_mfma_f32_16x16x32_bf16 v[120:123], a[116:119], a[132:135], v[120:123]
buffer_load_dwordx4 v15, s[8:11], s25 offen offset:3072 lds
v_mfma_f32_16x16x32_bf16 v[124:127], a[120:123], a[128:131], v[124:127]
s_add_u32 s25, s25, 128
v_mfma_f32_16x16x32_bf16 v[124:127], a[124:127], a[132:135], v[124:127]
s_waitcnt lgkmcnt(4)
buffer_load_dword v21, v20, s[16:19], s43 offen
v_mfma_f32_16x16x32_bf16 v[128:131], a[64:67], a[136:139], v[128:131]
s_waitcnt lgkmcnt(2)
s_add_u32 s43, s43, s47
ds_read_b64_tr_b16 a[128:129], v8 offset:32768
v_mfma_f32_16x16x32_bf16 v[128:131], a[68:71], a[140:143], v[128:131]
s_cmp_ge_u32 s43, s51
v_mfma_f32_16x16x32_bf16 v[132:135], a[72:75], a[136:139], v[132:135]
s_cselect_b32 s43, 0, s43
ds_read_b64_tr_b16 a[130:131], v8 offset:34816
v_mfma_f32_16x16x32_bf16 v[132:135], a[76:79], a[140:143], v[132:135]
s_cselect_b32 s51, s42, s51
v_mfma_f32_16x16x32_bf16 v[136:139], a[80:83], a[136:139], v[136:139]
s_cselect_b64 s[16:17], s[40:41], s[16:17]
ds_read_b64_tr_b16 a[132:133], v8 offset:49152
v_mfma_f32_16x16x32_bf16 v[136:139], a[84:87], a[140:143], v[136:139]
s_cselect_b32 s18, s42, s18
v_mfma_f32_16x16x32_bf16 v[140:143], a[88:91], a[136:139], v[140:143]
s_cselect_b64 s[40:41], s[44:45], s[40:41]
ds_read_b64_tr_b16 a[134:135], v8 offset:51200
v_mfma_f32_16x16x32_bf16 v[140:143], a[92:95], a[140:143], v[140:143]
s_cselect_b32 s42, s46, s42
v_mfma_f32_16x16x32_bf16 v[144:147], a[96:99], a[136:139], v[144:147]
s_cselect_b64 s[44:45], s[48:49], s[44:45]
ds_read_b128 a[32:35], v2 offset:8192
v_mfma_f32_16x16x32_bf16 v[144:147], a[100:103], a[140:143], v[144:147]
s_cselect_b32 s46, s50, s46
v_mfma_f32_16x16x32_bf16 v[148:151], a[104:107], a[136:139], v[148:151]
s_cselect_b64 s[48:49], s[52:53], s[48:49]
v_mfma_f32_16x16x32_bf16 v[148:151], a[108:111], a[140:143], v[148:151]
s_cselect_b32 s50, s54, s50
v_mfma_f32_16x16x32_bf16 v[152:155], a[112:115], a[136:139], v[152:155]
s_cselect_b32 s54, 0, s54
ds_read_b128 a[36:39], v3 offset:8192
v_mfma_f32_16x16x32_bf16 v[152:155], a[116:119], a[140:143], v[152:155]
v_mfma_f32_16x16x32_bf16 v[156:159], a[120:123], a[136:139], v[156:159]
ds_read_b128 a[40:43], v2 offset:10240
v_mfma_f32_16x16x32_bf16 v[156:159], a[124:127], a[140:143], v[156:159]
s_waitcnt lgkmcnt(5)
v_mfma_f32_16x16x32_bf16 v[160:163], a[64:67], a[128:131], v[160:163]
s_waitcnt lgkmcnt(3)
ds_read_b64_tr_b16 a[136:137], v9 offset:32768
v_mfma_f32_16x16x32_bf16 v[160:163], a[68:71], a[132:135], v[160:163]
v_mfma_f32_16x16x32_bf16 v[164:167], a[72:75], a[128:131], v[164:167]
ds_read_b64_tr_b16 a[138:139], v9 offset:34816
v_mfma_f32_16x16x32_bf16 v[164:167], a[76:79], a[132:135], v[164:167]
v_mfma_f32_16x16x32_bf16 v[168:171], a[80:83], a[128:131], v[168:171]
ds_read_b64_tr_b16 a[140:141], v9 offset:49152
v_mfma_f32_16x16x32_bf16 v[168:171], a[84:87], a[132:135], v[168:171]
v_mfma_f32_16x16x32_bf16 v[172:175], a[88:91], a[128:131], v[172:175]
ds_read_b64_tr_b16 a[142:143], v9 offset:51200
v_mfma_f32_16x16x32_bf16 v[172:175], a[92:95], a[132:135], v[172:175]
v_mfma_f32_16x16x32_bf16 v[176:179], a[96:99], a[128:131], v[176:179]
v_mfma_f32_16x16x32_bf16 v[176:179], a[100:103], a[132:135], v[176:179]
v_mfma_f32_16x16x32_bf16 v[180:183], a[104:107], a[128:131], v[180:183]
ds_read_b128 a[44:47], v3 offset:10240
v_mfma_f32_16x16x32_bf16 v[180:183], a[108:111], a[132:135], v[180:183]
v_mfma_f32_16x16x32_bf16 v[184:187], a[112:115], a[128:131], v[184:187]
ds_read_b128 a[48:51], v2 offset:12288
v_mfma_f32_16x16x32_bf16 v[184:187], a[116:119], a[132:135], v[184:187]
v_mfma_f32_16x16x32_bf16 v[188:191], a[120:123], a[128:131], v[188:191]
v_mfma_f32_16x16x32_bf16 v[188:191], a[124:127], a[132:135], v[188:191]
s_waitcnt lgkmcnt(4)
v_mfma_f32_16x16x32_bf16 v[192:195], a[64:67], a[136:139], v[192:195]
s_waitcnt lgkmcnt(2)
ds_read_b64_tr_b16 a[128:129], v10 offset:32768
v_mfma_f32_16x16x32_bf16 v[192:195], a[68:71], a[140:143], v[192:195]
v_mfma_f32_16x16x32_bf16 v[196:199], a[72:75], a[136:139], v[196:199]
ds_read_b64_tr_b16 a[130:131], v10 offset:34816
v_mfma_f32_16x16x32_bf16 v[196:199], a[76:79], a[140:143], v[196:199]
v_mfma_f32_16x16x32_bf16 v[200:203], a[80:83], a[136:139], v[200:203]
ds_read_b64_tr_b16 a[132:133], v10 offset:49152
v_mfma_f32_16x16x32_bf16 v[200:203], a[84:87], a[140:143], v[200:203]
v_mfma_f32_16x16x32_bf16 v[204:207], a[88:91], a[136:139], v[204:207]
ds_read_b64_tr_b16 a[134:135], v10 offset:51200
v_mfma_f32_16x16x32_bf16 v[204:207], a[92:95], a[140:143], v[204:207]
v_mfma_f32_16x16x32_bf16 v[208:211], a[96:99], a[136:139], v[208:211]
ds_read_b128 a[52:55], v3 offset:12288
v_mfma_f32_16x16x32_bf16 v[208:211], a[100:103], a[140:143], v[208:211]
v_mfma_f32_16x16x32_bf16 v[212:215], a[104:107], a[136:139], v[212:215]
ds_read_b128 a[56:59], v2 offset:14336
v_mfma_f32_16x16x32_bf16 v[212:215], a[108:111], a[140:143], v[212:215]
v_mfma_f32_16x16x32_bf16 v[216:219], a[112:115], a[136:139], v[216:219]
v_mfma_f32_16x16x32_bf16 v[216:219], a[116:119], a[140:143], v[216:219]
v_mfma_f32_16x16x32_bf16 v[220:223], a[120:123], a[136:139], v[220:223]
ds_read_b128 a[60:63], v3 offset:14336
v_mfma_f32_16x16x32_bf16 v[220:223], a[124:127], a[140:143], v[220:223]
s_waitcnt lgkmcnt(5)
v_mfma_f32_16x16x32_bf16 v[224:227], a[64:67], a[128:131], v[224:227]
s_waitcnt lgkmcnt(3)
ds_read_b64_tr_b16 a[136:137], v11 offset:32768
v_mfma_f32_16x16x32_bf16 v[224:227], a[68:71], a[132:135], v[224:227]
v_mfma_f32_16x16x32_bf16 v[228:231], a[72:75], a[128:131], v[228:231]
ds_read_b64_tr_b16 a[138:139], v11 offset:34816
v_mfma_f32_16x16x32_bf16 v[228:231], a[76:79], a[132:135], v[228:231]
v_mfma_f32_16x16x32_bf16 v[232:235], a[80:83], a[128:131], v[232:235]
ds_read_b64_tr_b16 a[140:141], v11 offset:49152
v_mfma_f32_16x16x32_bf16 v[232:235], a[84:87], a[132:135], v[232:235]
v_mfma_f32_16x16x32_bf16 v[236:239], a[88:91], a[128:131], v[236:239]
ds_read_b64_tr_b16 a[142:143], v11 offset:51200
v_mfma_f32_16x16x32_bf16 v[236:239], a[92:95], a[132:135], v[236:239]
v_mfma_f32_16x16x32_bf16 v[240:243], a[96:99], a[128:131], v[240:243]
v_mfma_f32_16x16x32_bf16 v[240:243], a[100:103], a[132:135], v[240:243]
v_mfma_f32_16x16x32_bf16 v[244:247], a[104:107], a[128:131], v[244:247]
v_mfma_f32_16x16x32_bf16 v[244:247], a[108:111], a[132:135], v[244:247]
v_mfma_f32_16x16x32_bf16 v[248:251], a[112:115], a[128:131], v[248:251]
v_mfma_f32_16x16x32_bf16 v[248:251], a[116:119], a[132:135], v[248:251]
v_mfma_f32_16x16x32_bf16 v[252:255], a[120:123], a[128:131], v[252:255]
v_mfma_f32_16x16x32_bf16 v[252:255], a[124:127], a[132:135], v[252:255]
s_waitcnt vmcnt(1) lgkmcnt(0)
s_barrier
v_mfma_f32_16x16x32_bf16 a[224:227], a[64:67], a[136:139], a[224:227]
s_add_u32 m0, s29, 98304
ds_read_b64_tr_b16 a[128:129], v4 offset:0
v_mfma_f32_16x16x32_bf16 a[224:227], a[68:71], a[140:143], a[224:227]
buffer_load_dwordx4 v16, s[12:15], s26 offen offset:0 lds
v_mfma_f32_16x16x32_bf16 a[228:231], a[72:75], a[136:139], a[228:231]
ds_read_b64_tr_b16 a[130:131], v4 offset:2048
v_mfma_f32_16x16x32_bf16 a[228:231], a[76:79], a[140:143], a[228:231]
v_mfma_f32_16x16x32_bf16 a[232:235], a[80:83], a[136:139], a[232:235]
ds_read_b64_tr_b16 a[132:133], v4 offset:16384
v_mfma_f32_16x16x32_bf16 a[232:235], a[84:87], a[140:143], a[232:235]
buffer_load_dwordx4 v17, s[12:15], s26 offen offset:1024 lds
v_mfma_f32_16x16x32_bf16 a[236:239], a[88:91], a[136:139], a[236:239]
ds_read_b64_tr_b16 a[134:135], v4 offset:18432
v_mfma_f32_16x16x32_bf16 a[236:239], a[92:95], a[140:143], a[236:239]
v_mfma_f32_16x16x32_bf16 a[240:243], a[96:99], a[136:139], a[240:243]
v_mfma_f32_16x16x32_bf16 a[240:243], a[100:103], a[140:143], a[240:243]
buffer_load_dwordx4 v18, s[12:15], s26 offen offset:2048 lds
v_mfma_f32_16x16x32_bf16 a[244:247], a[104:107], a[136:139], a[244:247]
v_mfma_f32_16x16x32_bf16 a[244:247], a[108:111], a[140:143], a[244:247]
v_mfma_f32_16x16x32_bf16 a[248:251], a[112:115], a[136:139], a[248:251]
v_mfma_f32_16x16x32_bf16 a[248:251], a[116:119], a[140:143], a[248:251]
buffer_load_dwordx4 v19, s[12:15], s26 offen offset:3072 lds
v_mfma_f32_16x16x32_bf16 a[252:255], a[120:123], a[136:139], a[252:255]
s_add_u32 s26, s26, 524288
v_mfma_f32_16x16x32_bf16 a[252:255], a[124:127], a[140:143], a[252:255]
s_waitcnt lgkmcnt(2)
v_mfma_f32_16x16x32_bf16 v[32:35], a[0:3], a[128:131], v[32:35]
s_waitcnt lgkmcnt(0)
s_add_u32 m0, s29, 114688
ds_read_b64_tr_b16 a[136:137], v5 offset:0
v_mfma_f32_16x16x32_bf16 v[32:35], a[4:7], a[132:135], v[32:35]
buffer_load_dwordx4 v16, s[12:15], s27 offen offset:0 lds
v_mfma_f32_16x16x32_bf16 v[36:39], a[8:11], a[128:131], v[36:39]
ds_read_b64_tr_b16 a[138:139], v5 offset:2048
v_mfma_f32_16x16x32_bf16 v[36:39], a[12:15], a[132:135], v[36:39]
v_mfma_f32_16x16x32_bf16 v[40:43], a[16:19], a[128:131], v[40:43]
ds_read_b64_tr_b16 a[140:141], v5 offset:16384
v_mfma_f32_16x16x32_bf16 v[40:43], a[20:23], a[132:135], v[40:43]
buffer_load_dwordx4 v17, s[12:15], s27 offen offset:1024 lds
v_mfma_f32_16x16x32_bf16 v[44:47], a[24:27], a[128:131], v[44:47]
ds_read_b64_tr_b16 a[142:143], v5 offset:18432
v_mfma_f32_16x16x32_bf16 v[44:47], a[28:31], a[132:135], v[44:47]
v_mfma_f32_16x16x32_bf16 v[48:51], a[32:35], a[128:131], v[48:51]
ds_read_b128 a[64:67], v2 offset:32768
v_mfma_f32_16x16x32_bf16 v[48:51], a[36:39], a[132:135], v[48:51]
buffer_load_dwordx4 v18, s[12:15], s27 offen offset:2048 lds
v_mfma_f32_16x16x32_bf16 v[52:55], a[40:43], a[128:131], v[52:55]
ds_read_b128 a[68:71], v3 offset:32768
v_mfma_f32_16x16x32_bf16 v[52:55], a[44:47], a[132:135], v[52:55]
v_mfma_f32_16x16x32_bf16 v[56:59], a[48:51], a[128:131], v[56:59]
v_mfma_f32_16x16x32_bf16 v[56:59], a[52:55], a[132:135], v[56:59]
buffer_load_dwordx4 v19, s[12:15], s27 offen offset:3072 lds
v_mfma_f32_16x16x32_bf16 v[60:63], a[56:59], a[128:131], v[60:63]
s_add_u32 s27, s27, 524288
ds_read_b128 a[72:75], v2 offset:34816
v_mfma_f32_16x16x32_bf16 v[60:63], a[60:63], a[132:135], v[60:63]
s_waitcnt lgkmcnt(5)
v_mfma_f32_16x16x32_bf16 v[64:67], a[0:3], a[136:139], v[64:67]
s_waitcnt lgkmcnt(3)
s_add_u32 m0, s28, 0
ds_read_b64_tr_b16 a[128:129], v6 offset:0
v_mfma_f32_16x16x32_bf16 v[64:67], a[4:7], a[140:143], v[64:67]
buffer_load_dwordx4 v12, s[8:11], s24 offen offset:0 lds
v_mfma_f32_16x16x32_bf16 v[68:71], a[8:11], a[136:139], v[68:71]
ds_read_b64_tr_b16 a[130:131], v6 offset:2048
v_mfma_f32_16x16x32_bf16 v[68:71], a[12:15], a[140:143], v[68:71]
v_mfma_f32_16x16x32_bf16 v[72:75], a[16:19], a[136:139], v[72:75]
ds_read_b64_tr_b16 a[132:133], v6 offset:16384
v_mfma_f32_16x16x32_bf16 v[72:75], a[20:23], a[140:143], v[72:75]
buffer_load_dwordx4 v13, s[8:11], s24 offen offset:1024 lds
v_mfma_f32_16x16x32_bf16 v[76:79], a[24:27], a[136:139], v[76:79]
ds_read_b64_tr_b16 a[134:135], v6 offset:18432
v_mfma_f32_16x16x32_bf16 v[76:79], a[28:31], a[140:143], v[76:79]
v_mfma_f32_16x16x32_bf16 v[80:83], a[32:35], a[136:139], v[80:83]
ds_read_b128 a[76:79], v3 offset:34816
v_mfma_f32_16x16x32_bf16 v[80:83], a[36:39], a[140:143], v[80:83]
buffer_load_dwordx4 v14, s[8:11], s24 offen offset:2048 lds
v_mfma_f32_16x16x32_bf16 v[84:87], a[40:43], a[136:139], v[84:87]
v_mfma_f32_16x16x32_bf16 v[84:87], a[44:47], a[140:143], v[84:87]
v_mfma_f32_16x16x32_bf16 v[88:91], a[48:51], a[136:139], v[88:91]
ds_read_b128 a[80:83], v2 offset:36864
v_mfma_f32_16x16x32_bf16 v[88:91], a[52:55], a[140:143], v[88:91]
buffer_load_dwordx4 v15, s[8:11], s24 offen offset:3072 lds
v_mfma_f32_16x16x32_bf16 v[92:95], a[56:59], a[136:139], v[92:95]
s_add_u32 s24, s24, 128
ds_read_b128 a[84:87], v3 offset:36864
v_mfma_f32_16x16x32_bf16 v[92:95], a[60:63], a[140:143], v[92:95]
s_waitcnt lgkmcnt(5)
v_mfma_f32_16x16x32_bf16 v[96:99], a[0:3], a[128:131], v[96:99]
s_waitcnt lgkmcnt(3)
s_add_u32 m0, s28, 4096
ds_read_b64_tr_b16 a[136:137], v7 offset:0
v_mfma_f32_16x16x32_bf16 v[96:99], a[4:7], a[132:135], v[96:99]
buffer_load_dwordx4 v12, s[8:11], s25 offen offset:0 lds
v_mfma_f32_16x16x32_bf16 v[100:103], a[8:11], a[128:131], v[100:103]
ds_read_b64_tr_b16 a[138:139], v7 offset:2048
v_mfma_f32_16x16x32_bf16 v[100:103], a[12:15], a[132:135], v[100:103]
v_mfma_f32_16x16x32_bf16 v[104:107], a[16:19], a[128:131], v[104:107]
ds_read_b64_tr_b16 a[140:141], v7 offset:16384
v_mfma_f32_16x16x32_bf16 v[104:107], a[20:23], a[132:135], v[104:107]
buffer_load_dwordx4 v13, s[8:11], s25 offen offset:1024 lds
v_mfma_f32_16x16x32_bf16 v[108:111], a[24:27], a[128:131], v[108:111]
ds_read_b64_tr_b16 a[142:143], v7 offset:18432
v_mfma_f32_16x16x32_bf16 v[108:111], a[28:31], a[132:135], v[108:111]
v_mfma_f32_16x16x32_bf16 v[112:115], a[32:35], a[128:131], v[112:115]
v_mfma_f32_16x16x32_bf16 v[112:115], a[36:39], a[132:135], v[112:115]
buffer_load_dwordx4 v14, s[8:11], s25 offen offset:2048 lds
v_mfma_f32_16x16x32_bf16 v[116:119], a[40:43], a[128:131], v[116:119]
ds_read_b128 a[88:91], v2 offset:38912
v_mfma_f32_16x16x32_bf16 v[116:119], a[44:47], a[132:135], v[116:119]
v_mfma_f32_16x16x32_bf16 v[120:123], a[48:51], a[128:131], v[120:123]
ds_read_b128 a[92:95], v3 offset:38912
v_mfma_f32_16x16x32_bf16 v[120:123], a[52:55], a[132:135], v[120:123]
buffer_load_dwordx4 v15, s[8:11], s25 offen offset:3072 lds
v_mfma_f32_16x16x32_bf16 v[124:127], a[56:59], a[128:131], v[124:127]
s_add_u32 s25, s25, 128
v_mfma_f32_16x16x32_bf16 v[124:127], a[60:63], a[132:135], v[124:127]
s_waitcnt lgkmcnt(4)
buffer_load_dword v21, v20, s[16:19], s43 offen
v_mfma_f32_16x16x32_bf16 v[128:131], a[0:3], a[136:139], v[128:131]
s_waitcnt lgkmcnt(2)
s_add_u32 s43, s43, s47
ds_read_b64_tr_b16 a[128:129], v8 offset:0
v_mfma_f32_16x16x32_bf16 v[128:131], a[4:7], a[140:143], v[128:131]
s_cmp_ge_u32 s43, s51
v_mfma_f32_16x16x32_bf16 v[132:135], a[8:11], a[136:139], v[132:135]
s_cselect_b32 s43, 0, s43
ds_read_b64_tr_b16 a[130:131], v8 offset:2048
v_mfma_f32_16x16x32_bf16 v[132:135], a[12:15], a[140:143], v[132:135]
s_cselect_b32 s51, s42, s51
v_mfma_f32_16x16x32_bf16 v[136:139], a[16:19], a[136:139], v[136:139]
s_cselect_b64 s[16:17], s[40:41], s[16:17]
ds_read_b64_tr_b16 a[132:133], v8 offset:16384
v_mfma_f32_16x16x32_bf16 v[136:139], a[20:23], a[140:143], v[136:139]
s_cselect_b32 s18, s42, s18
v_mfma_f32_16x16x32_bf16 v[140:143], a[24:27], a[136:139], v[140:143]
s_cselect_b64 s[40:41], s[44:45], s[40:41]
ds_read_b64_tr_b16 a[134:135], v8 offset:18432
v_mfma_f32_16x16x32_bf16 v[140:143], a[28:31], a[140:143], v[140:143]
s_cselect_b32 s42, s46, s42
v_mfma_f32_16x16x32_bf16 v[144:147], a[32:35], a[136:139], v[144:147]
s_cselect_b64 s[44:45], s[48:49], s[44:45]
ds_read_b128 a[96:99], v2 offset:40960
v_mfma_f32_16x16x32_bf16 v[144:147], a[36:39], a[140:143], v[144:147]
s_cselect_b32 s46, s50, s46
v_mfma_f32_16x16x32_bf16 v[148:151], a[40:43], a[136:139], v[148:151]
s_cselect_b64 s[48:49], s[52:53], s[48:49]
v_mfma_f32_16x16x32_bf16 v[148:151], a[44:47], a[140:143], v[148:151]
s_cselect_b32 s50, s54, s50
v_mfma_f32_16x16x32_bf16 v[152:155], a[48:51], a[136:139], v[152:155]
s_cselect_b32 s54, 0, s54
ds_read_b128 a[100:103], v3 offset:40960
v_mfma_f32_16x16x32_bf16 v[152:155], a[52:55], a[140:143], v[152:155]
v_mfma_f32_16x16x32_bf16 v[156:159], a[56:59], a[136:139], v[156:159]
ds_read_b128 a[104:107], v2 offset:43008
v_mfma_f32_16x16x32_bf16 v[156:159], a[60:63], a[140:143], v[156:159]
s_waitcnt lgkmcnt(5)
v_mfma_f32_16x16x32_bf16 v[160:163], a[0:3], a[128:131], v[160:163]
s_waitcnt lgkmcnt(3)
ds_read_b64_tr_b16 a[136:137], v9 offset:0
v_mfma_f32_16x16x32_bf16 v[160:163], a[4:7], a[132:135], v[160:163]
v_mfma_f32_16x16x32_bf16 v[164:167], a[8:11], a[128:131], v[164:167]
ds_read_b64_tr_b16 a[138:139], v9 offset:2048
v_mfma_f32_16x16x32_bf16 v[164:167], a[12:15], a[132:135], v[164:167]
v_mfma_f32_16x16x32_bf16 v[168:171], a[16:19], a[128:131], v[168:171]
ds_read_b64_tr_b16 a[140:141], v9 offset:16384
v_mfma_f32_16x16x32_bf16 v[168:171], a[20:23], a[132:135], v[168:171]
v_mfma_f32_16x16x32_bf16 v[172:175], a[24:27], a[128:131], v[172:175]
ds_read_b64_tr_b16 a[142:143], v9 offset:18432
v_mfma_f32_16x16x32_bf16 v[172:175], a[28:31], a[132:135], v[172:175]
v_mfma_f32_16x16x32_bf16 v[176:179], a[32:35], a[128:131], v[176:179]
v_mfma_f32_16x16x32_bf16 v[176:179], a[36:39], a[132:135], v[176:179]
v_mfma_f32_16x16x32_bf16 v[180:183], a[40:43], a[128:131], v[180:183]
ds_read_b128 a[108:111], v3 offset:43008
v_mfma_f32_16x16x32_bf16 v[180:183], a[44:47], a[132:135], v[180:183]
v_mfma_f32_16x16x32_bf16 v[184:187], a[48:51], a[128:131], v[184:187]
ds_read_b128 a[112:115], v2 offset:45056
v_mfma_f32_16x16x32_bf16 v[184:187], a[52:55], a[132:135], v[184:187]
v_mfma_f32_16x16x32_bf16 v[188:191], a[56:59], a[128:131], v[188:191]
v_mfma_f32_16x16x32_bf16 v[188:191], a[60:63], a[132:135], v[188:191]
s_waitcnt lgkmcnt(4)
v_mfma_f32_16x16x32_bf16 v[192:195], a[0:3], a[136:139], v[192:195]
s_waitcnt lgkmcnt(2)
ds_read_b64_tr_b16 a[128:129], v10 offset:0
v_mfma_f32_16x16x32_bf16 v[192:195], a[4:7], a[140:143], v[192:195]
v_mfma_f32_16x16x32_bf16 v[196:199], a[8:11], a[136:139], v[196:199]
ds_read_b64_tr_b16 a[130:131], v10 offset:2048
v_mfma_f32_16x16x32_bf16 v[196:199], a[12:15], a[140:143], v[196:199]
v_mfma_f32_16x16x32_bf16 v[200:203], a[16:19], a[136:139], v[200:203]
ds_read_b64_tr_b16 a[132:133], v10 offset:16384
v_mfma_f32_16x16x32_bf16 v[200:203], a[20:23], a[140:143], v[200:203]
v_mfma_f32_16x16x32_bf16 v[204:207], a[24:27], a[136:139], v[204:207]
ds_read_b64_tr_b16 a[134:135], v10 offset:18432
v_mfma_f32_16x16x32_bf16 v[204:207], a[28:31], a[140:143], v[204:207]
v_mfma_f32_16x16x32_bf16 v[208:211], a[32:35], a[136:139], v[208:211]
ds_read_b128 a[116:119], v3 offset:45056
v_mfma_f32_16x16x32_bf16 v[208:211], a[36:39], a[140:143], v[208:211]
v_mfma_f32_16x16x32_bf16 v[212:215], a[40:43], a[136:139], v[212:215]
ds_read_b128 a[120:123], v2 offset:47104
v_mfma_f32_16x16x32_bf16 v[212:215], a[44:47], a[140:143], v[212:215]
v_mfma_f32_16x16x32_bf16 v[216:219], a[48:51], a[136:139], v[216:219]
v_mfma_f32_16x16x32_bf16 v[216:219], a[52:55], a[140:143], v[216:219]
v_mfma_f32_16x16x32_bf16 v[220:223], a[56:59], a[136:139], v[220:223]
ds_read_b128 a[124:127], v3 offset:47104
v_mfma_f32_16x16x32_bf16 v[220:223], a[60:63], a[140:143], v[220:223]
s_waitcnt lgkmcnt(5)
v_mfma_f32_16x16x32_bf16 v[224:227], a[0:3], a[128:131], v[224:227]
s_waitcnt lgkmcnt(3)
ds_read_b64_tr_b16 a[136:137], v11 offset:0
v_mfma_f32_16x16x32_bf16 v[224:227], a[4:7], a[132:135], v[224:227]
v_mfma_f32_16x16x32_bf16 v[228:231], a[8:11], a[128:131], v[228:231]
ds_read_b64_tr_b16 a[138:139], v11 offset:2048
v_mfma_f32_16x16x32_bf16 v[228:231], a[12:15], a[132:135], v[228:231]
v_mfma_f32_16x16x32_bf16 v[232:235], a[16:19], a[128:131], v[232:235]
s_sub_u32 s30, s30, 1
ds_read_b64_tr_b16 a[140:141], v11 offset:16384
v_mfma_f32_16x16x32_bf16 v[232:235], a[20:23], a[132:135], v[232:235]
s_cmp_eq_u32 s30, s55
v_mfma_f32_16x16x32_bf16 v[236:239], a[24:27], a[128:131], v[236:239]
s_cselect_b32 s22, 0, 3221225472
ds_read_b64_tr_b16 a[142:143], v11 offset:18432
v_mfma_f32_16x16x32_bf16 v[236:239], a[28:31], a[132:135], v[236:239]
v_mfma_f32_16x16x32_bf16 v[240:243], a[32:35], a[128:131], v[240:243]
v_mfma_f32_16x16x32_bf16 v[240:243], a[36:39], a[132:135], v[240:243]
v_mfma_f32_16x16x32_bf16 v[244:247], a[40:43], a[128:131], v[244:247]
v_mfma_f32_16x16x32_bf16 v[244:247], a[44:47], a[132:135], v[244:247]
v_mfma_f32_16x16x32_bf16 v[248:251], a[48:51], a[128:131], v[248:251]
v_mfma_f32_16x16x32_bf16 v[248:251], a[52:55], a[132:135], v[248:251]
v_mfma_f32_16x16x32_bf16 v[252:255], a[56:59], a[128:131], v[252:255]
v_mfma_f32_16x16x32_bf16 v[252:255], a[60:63], a[132:135], v[252:255]
s_waitcnt vmcnt(1) lgkmcnt(0)
s_barrier
v_mfma_f32_16x16x32_bf16 a[224:227], a[0:3], a[136:139], a[224:227]
s_add_u32 m0, s29, 65536
ds_read_b64_tr_b16 a[128:129], v4 offset:32768
v_mfma_f32_16x16x32_bf16 a[224:227], a[4:7], a[140:143], a[224:227]
buffer_load_dwordx4 v16, s[12:15], s26 offen offset:0 lds
v_mfma_f32_16x16x32_bf16 a[228:231], a[8:11], a[136:139], a[228:231]
ds_read_b64_tr_b16 a[130:131], v4 offset:34816
v_mfma_f32_16x16x32_bf16 a[228:231], a[12:15], a[140:143], a[228:231]
v_mfma_f32_16x16x32_bf16 a[232:235], a[16:19], a[136:139], a[232:235]
ds_read_b64_tr_b16 a[132:133], v4 offset:49152
v_mfma_f32_16x16x32_bf16 a[232:235], a[20:23], a[140:143], a[232:235]
buffer_load_dwordx4 v17, s[12:15], s26 offen offset:1024 lds
v_mfma_f32_16x16x32_bf16 a[236:239], a[24:27], a[136:139], a[236:239]
ds_read_b64_tr_b16 a[134:135], v4 offset:51200
v_mfma_f32_16x16x32_bf16 a[236:239], a[28:31], a[140:143], a[236:239]
v_mfma_f32_16x16x32_bf16 a[240:243], a[32:35], a[136:139], a[240:243]
v_mfma_f32_16x16x32_bf16 a[240:243], a[36:39], a[140:143], a[240:243]
buffer_load_dwordx4 v18, s[12:15], s26 offen offset:2048 lds
v_mfma_f32_16x16x32_bf16 a[244:247], a[40:43], a[136:139], a[244:247]
v_mfma_f32_16x16x32_bf16 a[244:247], a[44:47], a[140:143], a[244:247]
v_mfma_f32_16x16x32_bf16 a[248:251], a[48:51], a[136:139], a[248:251]
v_mfma_f32_16x16x32_bf16 a[248:251], a[52:55], a[140:143], a[248:251]
buffer_load_dwordx4 v19, s[12:15], s26 offen offset:3072 lds
v_mfma_f32_16x16x32_bf16 a[252:255], a[56:59], a[136:139], a[252:255]
s_add_u32 s26, s26, 524288
v_mfma_f32_16x16x32_bf16 a[252:255], a[60:63], a[140:143], a[252:255]
s_waitcnt lgkmcnt(2)
buffer_atomic_add v27, v26, s[60:63], s22 offen sc1
s_cmp_lg_u32 s30, 0
s_cbranch_scc1 Lg_2
v_mfma_f32_16x16x32_bf16 v[32:35], a[64:67], a[128:131], v[32:35]
s_waitcnt lgkmcnt(0)
s_add_u32 m0, s29, 81920
ds_read_b64_tr_b16 a[136:137], v5 offset:32768
v_mfma_f32_16x16x32_bf16 v[32:35], a[68:71], a[132:135], v[32:35]
buffer_load_dwordx4 v16, s[12:15], s27 offen offset:0 lds
v_mfma_f32_16x16x32_bf16 v[36:39], a[72:75], a[128:131], v[36:39]
ds_read_b64_tr_b16 a[138:139], v5 offset:34816
v_mfma_f32_16x16x32_bf16 v[36:39], a[76:79], a[132:135], v[36:39]
v_mfma_f32_16x16x32_bf16 v[40:43], a[80:83], a[128:131], v[40:43]
ds_read_b64_tr_b16 a[140:141], v5 offset:49152
v_mfma_f32_16x16x32_bf16 v[40:43], a[84:87], a[132:135], v[40:43]
buffer_load_dwordx4 v17, s[12:15], s27 offen offset:1024 lds
v_mfma_f32_16x16x32_bf16 v[44:47], a[88:91], a[128:131], v[44:47]
ds_read_b64_tr_b16 a[142:143], v5 offset:51200
v_mfma_f32_16x16x32_bf16 v[44:47], a[92:95], a[132:135], v[44:47]
v_mfma_f32_16x16x32_bf16 v[48:51], a[96:99], a[128:131], v[48:51]
ds_read_b128 a[0:3], v2 offset:0
v_mfma_f32_16x16x32_bf16 v[48:51], a[100:103], a[132:135], v[48:51]
buffer_load_dwordx4 v18, s[12:15], s27 offen offset:2048 lds
v_mfma_f32_16x16x32_bf16 v[52:55], a[104:107], a[128:131], v[52:55]
ds_read_b128 a[4:7], v3 offset:0
v_mfma_f32_16x16x32_bf16 v[52:55], a[108:111], a[132:135], v[52:55]
v_mfma_f32_16x16x32_bf16 v[56:59], a[112:115], a[128:131], v[56:59]
v_mfma_f32_16x16x32_bf16 v[56:59], a[116:119], a[132:135], v[56:59]
buffer_load_dwordx4 v19, s[12:15], s27 offen offset:3072 lds
v_mfma_f32_16x16x32_bf16 v[60:63], a[120:123], a[128:131], v[60:63]
s_add_u32 s27, s27, 524288
ds_read_b128 a[8:11], v2 offset:2048
v_mfma_f32_16x16x32_bf16 v[60:63], a[124:127], a[132:135], v[60:63]
s_waitcnt lgkmcnt(5)
v_mfma_f32_16x16x32_bf16 v[64:67], a[64:67], a[136:139], v[64:67]
s_waitcnt lgkmcnt(3)
s_add_u32 m0, s28, 32768
ds_read_b64_tr_b16 a[128:129], v6 offset:32768
v_mfma_f32_16x16x32_bf16 v[64:67], a[68:71], a[140:143], v[64:67]
buffer_load_dwordx4 v12, s[8:11], s24 offen offset:0 lds
v_mfma_f32_16x16x32_bf16 v[68:71], a[72:75], a[136:139], v[68:71]
ds_read_b64_tr_b16 a[130:131], v6 offset:34816
v_mfma_f32_16x16x32_bf16 v[68:71], a[76:79], a[140:143], v[68:71]
v_mfma_f32_16x16x32_bf16 v[72:75], a[80:83], a[136:139], v[72:75]
ds_read_b64_tr_b16 a[132:133], v6 offset:49152
v_mfma_f32_16x16x32_bf16 v[72:75], a[84:87], a[140:143], v[72:75]
buffer_load_dwordx4 v13, s[8:11], s24 offen offset:1024 lds
v_mfma_f32_16x16x32_bf16 v[76:79], a[88:91], a[136:139], v[76:79]
ds_read_b64_tr_b16 a[134:135], v6 offset:51200
v_mfma_f32_16x16x32_bf16 v[76:79], a[92:95], a[140:143], v[76:79]
v_mfma_f32_16x16x32_bf16 v[80:83], a[96:99], a[136:139], v[80:83]
ds_read_b128 a[12:15], v3 offset:2048
v_mfma_f32_16x16x32_bf16 v[80:83], a[100:103], a[140:143], v[80:83]
buffer_load_dwordx4 v14, s[8:11], s24 offen offset:2048 lds
v_mfma_f32_16x16x32_bf16 v[84:87], a[104:107], a[136:139], v[84:87]
v_mfma_f32_16x16x32_bf16 v[84:87], a[108:111], a[140:143], v[84:87]
v_mfma_f32_16x16x32_bf16 v[88:91], a[112:115], a[136:139], v[88:91]
ds_read_b128 a[16:19], v2 offset:4096
v_mfma_f32_16x16x32_bf16 v[88:91], a[116:119], a[140:143], v[88:91]
buffer_load_dwordx4 v15, s[8:11], s24 offen offset:3072 lds
v_mfma_f32_16x16x32_bf16 v[92:95], a[120:123], a[136:139], v[92:95]
s_add_u32 s24, s24, 128
ds_read_b128 a[20:23], v3 offset:4096
v_mfma_f32_16x16x32_bf16 v[92:95], a[124:127], a[140:143], v[92:95]
s_waitcnt lgkmcnt(5)
v_mfma_f32_16x16x32_bf16 v[96:99], a[64:67], a[128:131], v[96:99]
s_waitcnt lgkmcnt(3)
s_add_u32 m0, s28, 36864
ds_read_b64_tr_b16 a[136:137], v7 offset:32768
v_mfma_f32_16x16x32_bf16 v[96:99], a[68:71], a[132:135], v[96:99]
buffer_load_dwordx4 v12, s[8:11], s25 offen offset:0 lds
v_mfma_f32_16x16x32_bf16 v[100:103], a[72:75], a[128:131], v[100:103]
ds_read_b64_tr_b16 a[138:139], v7 offset:34816
v_mfma_f32_16x16x32_bf16 v[100:103], a[76:79], a[132:135], v[100:103]
v_mfma_f32_16x16x32_bf16 v[104:107], a[80:83], a[128:131], v[104:107]
ds_read_b64_tr_b16 a[140:141], v7 offset:49152
v_mfma_f32_16x16x32_bf16 v[104:107], a[84:87], a[132:135], v[104:107]
buffer_load_dwordx4 v13, s[8:11], s25 offen offset:1024 lds
v_mfma_f32_16x16x32_bf16 v[108:111], a[88:91], a[128:131], v[108:111]
ds_read_b64_tr_b16 a[142:143], v7 offset:51200
v_mfma_f32_16x16x32_bf16 v[108:111], a[92:95], a[132:135], v[108:111]
v_mfma_f32_16x16x32_bf16 v[112:115], a[96:99], a[128:131], v[112:115]
v_mfma_f32_16x16x32_bf16 v[112:115], a[100:103], a[132:135], v[112:115]
buffer_load_dwordx4 v14, s[8:11], s25 offen offset:2048 lds
v_mfma_f32_16x16x32_bf16 v[116:119], a[104:107], a[128:131], v[116:119]
ds_read_b128 a[24:27], v2 offset:6144
v_mfma_f32_16x16x32_bf16 v[116:119], a[108:111], a[132:135], v[116:119]
v_mfma_f32_16x16x32_bf16 v[120:123], a[112:115], a[128:131], v[120:123]
ds_read_b128 a[28:31], v3 offset:6144
v_mfma_f32_16x16x32_bf16 v[120:123], a[116:119], a[132:135], v[120:123]
buffer_load_dwordx4 v15, s[8:11], s25 offen offset:3072 lds
v_mfma_f32_16x16x32_bf16 v[124:127], a[120:123], a[128:131], v[124:127]
s_add_u32 s25, s25, 128
v_mfma_f32_16x16x32_bf16 v[124:127], a[124:127], a[132:135], v[124:127]
s_waitcnt lgkmcnt(4)
v_mfma_f32_16x16x32_bf16 v[128:131], a[64:67], a[136:139], v[128:131]
s_waitcnt lgkmcnt(2)
ds_read_b64_tr_b16 a[128:129], v8 offset:32768
v_lshrrev_b32 v28, 7, v1
v_mfma_f32_16x16x32_bf16 v[128:131], a[68:71], a[140:143], v[128:131]
v_lshrrev_b32 v29, 1, v28
v_lshlrev_b32 v29, 4, v29
v_mfma_f32_16x16x32_bf16 v[132:135], a[72:75], a[136:139], v[132:135]
s_mov_b64 s[8:9], s[76:77]
ds_read_b64_tr_b16 a[130:131], v8 offset:34816
v_and_b32 v30, 0x70, v1
v_mfma_f32_16x16x32_bf16 v[132:135], a[76:79], a[140:143], v[132:135]
s_mov_b32 s10, 1835008
v_xor_b32 v29, v29, v30
v_mul_u32_u24 v28, 896, v28
v_mfma_f32_16x16x32_bf16 v[136:139], a[80:83], a[136:139], v[136:139]
s_lshl_b32 s24, s37, 2
ds_read_b64_tr_b16 a[132:133], v8 offset:49152
v_add_u32 v12, v28, v29
v_mfma_f32_16x16x32_bf16 v[136:139], a[84:87], a[140:143], v[136:139]
s_add_u32 s24, s24, s3
v_xor_b32 v29, 64, v29
v_add_u32 v28, v28, v29
v_mfma_f32_16x16x32_bf16 v[140:143], a[88:91], a[136:139], v[140:143]
s_mul_i32 s24, s24, 28672
ds_read_b64_tr_b16 a[134:135], v8 offset:51200
v_add_u32 v13, 6144, v28
v_mfma_f32_16x16x32_bf16 v[140:143], a[92:95], a[140:143], v[140:143]
s_mov_b32 s28, s29
v_add_u32 v14, 12288, v12
v_add_u32 v15, 18432, v28
v_mfma_f32_16x16x32_bf16 v[144:147], a[96:99], a[136:139], v[144:147]
ds_read_b128 a[32:35], v2 offset:8192
v_mfma_f32_16x16x32_bf16 v[144:147], a[100:103], a[140:143], v[144:147]
v_mfma_f32_16x16x32_bf16 v[148:151], a[104:107], a[136:139], v[148:151]
v_mfma_f32_16x16x32_bf16 v[148:151], a[108:111], a[140:143], v[148:151]
v_mfma_f32_16x16x32_bf16 v[152:155], a[112:115], a[136:139], v[152:155]
ds_read_b128 a[36:39], v3 offset:8192
v_mov_b32 v20, 0
v_mfma_f32_16x16x32_bf16 v[152:155], a[116:119], a[140:143], v[152:155]
v_mfma_f32_16x16x32_bf16 v[156:159], a[120:123], a[136:139], v[156:159]
ds_read_b128 a[40:43], v2 offset:10240
v_mfma_f32_16x16x32_bf16 v[156:159], a[124:127], a[140:143], v[156:159]
s_waitcnt lgkmcnt(5)
v_mfma_f32_16x16x32_bf16 v[160:163], a[64:67], a[128:131], v[160:163]
s_waitcnt lgkmcnt(3)
ds_read_b64_tr_b16 a[136:137], v9 offset:32768
v_mfma_f32_16x16x32_bf16 v[160:163], a[68:71], a[132:135], v[160:163]
v_mfma_f32_16x16x32_bf16 v[164:167], a[72:75], a[128:131], v[164:167]
ds_read_b64_tr_b16 a[138:139], v9 offset:34816
v_mfma_f32_16x16x32_bf16 v[164:167], a[76:79], a[132:135], v[164:167]
v_mfma_f32_16x16x32_bf16 v[168:171], a[80:83], a[128:131], v[168:171]
ds_read_b64_tr_b16 a[140:141], v9 offset:49152
v_mfma_f32_16x16x32_bf16 v[168:171], a[84:87], a[132:135], v[168:171]
v_mfma_f32_16x16x32_bf16 v[172:175], a[88:91], a[128:131], v[172:175]
ds_read_b64_tr_b16 a[142:143], v9 offset:51200
v_mfma_f32_16x16x32_bf16 v[172:175], a[92:95], a[132:135], v[172:175]
v_mfma_f32_16x16x32_bf16 v[176:179], a[96:99], a[128:131], v[176:179]
v_mfma_f32_16x16x32_bf16 v[176:179], a[100:103], a[132:135], v[176:179]
v_mfma_f32_16x16x32_bf16 v[180:183], a[104:107], a[128:131], v[180:183]
ds_read_b128 a[44:47], v3 offset:10240
v_mfma_f32_16x16x32_bf16 v[180:183], a[108:111], a[132:135], v[180:183]
v_mfma_f32_16x16x32_bf16 v[184:187], a[112:115], a[128:131], v[184:187]
ds_read_b128 a[48:51], v2 offset:12288
v_mfma_f32_16x16x32_bf16 v[184:187], a[116:119], a[132:135], v[184:187]
v_mfma_f32_16x16x32_bf16 v[188:191], a[120:123], a[128:131], v[188:191]
v_mfma_f32_16x16x32_bf16 v[188:191], a[124:127], a[132:135], v[188:191]
s_waitcnt lgkmcnt(4)
v_mfma_f32_16x16x32_bf16 v[192:195], a[64:67], a[136:139], v[192:195]
s_waitcnt lgkmcnt(2)
ds_read_b64_tr_b16 a[128:129], v10 offset:32768
v_mfma_f32_16x16x32_bf16 v[192:195], a[68:71], a[140:143], v[192:195]
v_mfma_f32_16x16x32_bf16 v[196:199], a[72:75], a[136:139], v[196:199]
ds_read_b64_tr_b16 a[130:131], v10 offset:34816
v_mfma_f32_16x16x32_bf16 v[196:199], a[76:79], a[140:143], v[196:199]
v_mfma_f32_16x16x32_bf16 v[200:203], a[80:83], a[136:139], v[200:203]
ds_read_b64_tr_b16 a[132:133], v10 offset:49152
v_mfma_f32_16x16x32_bf16 v[200:203], a[84:87], a[140:143], v[200:203]
v_mfma_f32_16x16x32_bf16 v[204:207], a[88:91], a[136:139], v[204:207]
ds_read_b64_tr_b16 a[134:135], v10 offset:51200
v_mfma_f32_16x16x32_bf16 v[204:207], a[92:95], a[140:143], v[204:207]
v_mfma_f32_16x16x32_bf16 v[208:211], a[96:99], a[136:139], v[208:211]
ds_read_b128 a[52:55], v3 offset:12288
v_mfma_f32_16x16x32_bf16 v[208:211], a[100:103], a[140:143], v[208:211]
v_mfma_f32_16x16x32_bf16 v[212:215], a[104:107], a[136:139], v[212:215]
ds_read_b128 a[56:59], v2 offset:14336
v_mfma_f32_16x16x32_bf16 v[212:215], a[108:111], a[140:143], v[212:215]
v_mfma_f32_16x16x32_bf16 v[216:219], a[112:115], a[136:139], v[216:219]
v_mfma_f32_16x16x32_bf16 v[216:219], a[116:119], a[140:143], v[216:219]
v_mfma_f32_16x16x32_bf16 v[220:223], a[120:123], a[136:139], v[220:223]
ds_read_b128 a[60:63], v3 offset:14336
v_mfma_f32_16x16x32_bf16 v[220:223], a[124:127], a[140:143], v[220:223]
s_waitcnt lgkmcnt(5)
v_mfma_f32_16x16x32_bf16 v[224:227], a[64:67], a[128:131], v[224:227]
s_waitcnt lgkmcnt(3)
ds_read_b64_tr_b16 a[136:137], v11 offset:32768
v_mfma_f32_16x16x32_bf16 v[224:227], a[68:71], a[132:135], v[224:227]
v_mfma_f32_16x16x32_bf16 v[228:231], a[72:75], a[128:131], v[228:231]
ds_read_b64_tr_b16 a[138:139], v11 offset:34816
v_mfma_f32_16x16x32_bf16 v[228:231], a[76:79], a[132:135], v[228:231]
v_mfma_f32_16x16x32_bf16 v[232:235], a[80:83], a[128:131], v[232:235]
ds_read_b64_tr_b16 a[140:141], v11 offset:49152
v_mfma_f32_16x16x32_bf16 v[232:235], a[84:87], a[132:135], v[232:235]
v_mfma_f32_16x16x32_bf16 v[236:239], a[88:91], a[128:131], v[236:239]
ds_read_b64_tr_b16 a[142:143], v11 offset:51200
v_mfma_f32_16x16x32_bf16 v[236:239], a[92:95], a[132:135], v[236:239]
v_mfma_f32_16x16x32_bf16 v[240:243], a[96:99], a[128:131], v[240:243]
v_mfma_f32_16x16x32_bf16 v[240:243], a[100:103], a[132:135], v[240:243]
v_mfma_f32_16x16x32_bf16 v[244:247], a[104:107], a[128:131], v[244:247]
v_mfma_f32_16x16x32_bf16 v[244:247], a[108:111], a[132:135], v[244:247]
v_mfma_f32_16x16x32_bf16 v[248:251], a[112:115], a[128:131], v[248:251]
v_mfma_f32_16x16x32_bf16 v[248:251], a[116:119], a[132:135], v[248:251]
v_mfma_f32_16x16x32_bf16 v[252:255], a[120:123], a[128:131], v[252:255]
v_mfma_f32_16x16x32_bf16 v[252:255], a[124:127], a[132:135], v[252:255]
s_waitcnt vmcnt(0) lgkmcnt(0)
s_barrier
v_mfma_f32_16x16x32_bf16 a[224:227], a[64:67], a[136:139], a[224:227]
s_add_u32 m0, s29, 98304
ds_read_b64_tr_b16 a[128:129], v4 offset:0
v_mfma_f32_16x16x32_bf16 a[224:227], a[68:71], a[140:143], a[224:227]
buffer_load_dwordx4 v16, s[12:15], s26 offen offset:0 lds
v_mfma_f32_16x16x32_bf16 a[228:231], a[72:75], a[136:139], a[228:231]
ds_read_b64_tr_b16 a[130:131], v4 offset:2048
v_mfma_f32_16x16x32_bf16 a[228:231], a[76:79], a[140:143], a[228:231]
v_mfma_f32_16x16x32_bf16 a[232:235], a[80:83], a[136:139], a[232:235]
ds_read_b64_tr_b16 a[132:133], v4 offset:16384
v_mfma_f32_16x16x32_bf16 a[232:235], a[84:87], a[140:143], a[232:235]
buffer_load_dwordx4 v17, s[12:15], s26 offen offset:1024 lds
v_mfma_f32_16x16x32_bf16 a[236:239], a[88:91], a[136:139], a[236:239]
ds_read_b64_tr_b16 a[134:135], v4 offset:18432
v_mfma_f32_16x16x32_bf16 a[236:239], a[92:95], a[140:143], a[236:239]
v_mfma_f32_16x16x32_bf16 a[240:243], a[96:99], a[136:139], a[240:243]
v_mfma_f32_16x16x32_bf16 a[240:243], a[100:103], a[140:143], a[240:243]
buffer_load_dwordx4 v18, s[12:15], s26 offen offset:2048 lds
v_mfma_f32_16x16x32_bf16 a[244:247], a[104:107], a[136:139], a[244:247]
v_mfma_f32_16x16x32_bf16 a[244:247], a[108:111], a[140:143], a[244:247]
v_mfma_f32_16x16x32_bf16 a[248:251], a[112:115], a[136:139], a[248:251]
v_mfma_f32_16x16x32_bf16 a[248:251], a[116:119], a[140:143], a[248:251]
buffer_load_dwordx4 v19, s[12:15], s26 offen offset:3072 lds
v_mfma_f32_16x16x32_bf16 a[252:255], a[120:123], a[136:139], a[252:255]
s_add_u32 s26, s26, 524288
v_mfma_f32_16x16x32_bf16 a[252:255], a[124:127], a[140:143], a[252:255]
s_waitcnt lgkmcnt(2)
v_mfma_f32_16x16x32_bf16 v[32:35], a[0:3], a[128:131], v[32:35]
s_waitcnt lgkmcnt(0)
s_add_u32 m0, s29, 114688
ds_read_b64_tr_b16 a[136:137], v5 offset:0
v_mfma_f32_16x16x32_bf16 v[32:35], a[4:7], a[132:135], v[32:35]
buffer_load_dwordx4 v16, s[12:15], s27 offen offset:0 lds
v_mfma_f32_16x16x32_bf16 v[36:39], a[8:11], a[128:131], v[36:39]
ds_read_b64_tr_b16 a[138:139], v5 offset:2048
v_mfma_f32_16x16x32_bf16 v[36:39], a[12:15], a[132:135], v[36:39]
v_mfma_f32_16x16x32_bf16 v[40:43], a[16:19], a[128:131], v[40:43]
ds_read_b64_tr_b16 a[140:141], v5 offset:16384
v_mfma_f32_16x16x32_bf16 v[40:43], a[20:23], a[132:135], v[40:43]
buffer_load_dwordx4 v17, s[12:15], s27 offen offset:1024 lds
v_mfma_f32_16x16x32_bf16 v[44:47], a[24:27], a[128:131], v[44:47]
ds_read_b64_tr_b16 a[142:143], v5 offset:18432
v_mfma_f32_16x16x32_bf16 v[44:47], a[28:31], a[132:135], v[44:47]
v_mfma_f32_16x16x32_bf16 v[48:51], a[32:35], a[128:131], v[48:51]
ds_read_b128 a[64:67], v2 offset:32768
v_mfma_f32_16x16x32_bf16 v[48:51], a[36:39], a[132:135], v[48:51]
buffer_load_dwordx4 v18, s[12:15], s27 offen offset:2048 lds
v_mfma_f32_16x16x32_bf16 v[52:55], a[40:43], a[128:131], v[52:55]
ds_read_b128 a[68:71], v3 offset:32768
v_mfma_f32_16x16x32_bf16 v[52:55], a[44:47], a[132:135], v[52:55]
v_mfma_f32_16x16x32_bf16 v[56:59], a[48:51], a[128:131], v[56:59]
v_mfma_f32_16x16x32_bf16 v[56:59], a[52:55], a[132:135], v[56:59]
buffer_load_dwordx4 v19, s[12:15], s27 offen offset:3072 lds
v_mfma_f32_16x16x32_bf16 v[60:63], a[56:59], a[128:131], v[60:63]
s_add_u32 s27, s27, 524288
ds_read_b128 a[72:75], v2 offset:34816
v_mfma_f32_16x16x32_bf16 v[60:63], a[60:63], a[132:135], v[60:63]
s_waitcnt lgkmcnt(5)
v_mfma_f32_16x16x32_bf16 v[64:67], a[0:3], a[136:139], v[64:67]
s_waitcnt lgkmcnt(3)
s_add_u32 m0, s28, 0
ds_read_b64_tr_b16 a[128:129], v6 offset:0
v_mfma_f32_16x16x32_bf16 v[64:67], a[4:7], a[140:143], v[64:67]
buffer_load_dwordx4 v12, s[8:11], s24 offen offset:0 lds
v_mfma_f32_16x16x32_bf16 v[68:71], a[8:11], a[136:139], v[68:71]
ds_read_b64_tr_b16 a[130:131], v6 offset:2048
v_mfma_f32_16x16x32_bf16 v[68:71], a[12:15], a[140:143], v[68:71]
v_mfma_f32_16x16x32_bf16 v[72:75], a[16:19], a[136:139], v[72:75]
ds_read_b64_tr_b16 a[132:133], v6 offset:16384
v_mfma_f32_16x16x32_bf16 v[72:75], a[20:23], a[140:143], v[72:75]
buffer_load_dwordx4 v13, s[8:11], s24 offen offset:1024 lds
v_mfma_f32_16x16x32_bf16 v[76:79], a[24:27], a[136:139], v[76:79]
ds_read_b64_tr_b16 a[134:135], v6 offset:18432
v_mfma_f32_16x16x32_bf16 v[76:79], a[28:31], a[140:143], v[76:79]
v_mfma_f32_16x16x32_bf16 v[80:83], a[32:35], a[136:139], v[80:83]
ds_read_b128 a[76:79], v3 offset:34816
v_mfma_f32_16x16x32_bf16 v[80:83], a[36:39], a[140:143], v[80:83]
buffer_load_dwordx4 v14, s[8:11], s24 offen offset:2048 lds
v_mfma_f32_16x16x32_bf16 v[84:87], a[40:43], a[136:139], v[84:87]
v_mfma_f32_16x16x32_bf16 v[84:87], a[44:47], a[140:143], v[84:87]
v_mfma_f32_16x16x32_bf16 v[88:91], a[48:51], a[136:139], v[88:91]
ds_read_b128 a[80:83], v2 offset:36864
v_mfma_f32_16x16x32_bf16 v[88:91], a[52:55], a[140:143], v[88:91]
buffer_load_dwordx4 v15, s[8:11], s24 offen offset:3072 lds
v_mfma_f32_16x16x32_bf16 v[92:95], a[56:59], a[136:139], v[92:95]
s_add_u32 s24, s24, 128
ds_read_b128 a[84:87], v3 offset:36864
v_mfma_f32_16x16x32_bf16 v[92:95], a[60:63], a[140:143], v[92:95]
s_waitcnt lgkmcnt(3)
s_mov_b64 s[12:13], s[80:81]
v_mfma_f32_16x16x32_bf16 v[96:99], a[0:3], a[128:131], v[96:99]
s_mov_b32 s14, 3670016
s_add_u32 m0, s28, 16384
ds_read_b64_tr_b16 a[136:137], v7 offset:0
v_mfma_f32_16x16x32_bf16 v[96:99], a[4:7], a[132:135], v[96:99]
buffer_load_dwordx4 v12, s[8:11], s24 offen offset:0 lds
v_mfma_f32_16x16x32_bf16 v[100:103], a[8:11], a[128:131], v[100:103]
ds_read_b64_tr_b16 a[138:139], v7 offset:2048
v_mfma_f32_16x16x32_bf16 v[100:103], a[12:15], a[132:135], v[100:103]
v_mfma_f32_16x16x32_bf16 v[104:107], a[16:19], a[128:131], v[104:107]
ds_read_b64_tr_b16 a[140:141], v7 offset:16384
v_mfma_f32_16x16x32_bf16 v[104:107], a[20:23], a[132:135], v[104:107]
buffer_load_dwordx4 v13, s[8:11], s24 offen offset:1024 lds
v_mfma_f32_16x16x32_bf16 v[108:111], a[24:27], a[128:131], v[108:111]
ds_read_b64_tr_b16 a[142:143], v7 offset:18432
v_mfma_f32_16x16x32_bf16 v[108:111], a[28:31], a[132:135], v[108:111]
v_mfma_f32_16x16x32_bf16 v[112:115], a[32:35], a[128:131], v[112:115]
v_mfma_f32_16x16x32_bf16 v[112:115], a[36:39], a[132:135], v[112:115]
buffer_load_dwordx4 v14, s[8:11], s24 offen offset:2048 lds
v_mfma_f32_16x16x32_bf16 v[116:119], a[40:43], a[128:131], v[116:119]
ds_read_b128 a[88:91], v2 offset:38912
v_mfma_f32_16x16x32_bf16 v[116:119], a[44:47], a[132:135], v[116:119]
v_mfma_f32_16x16x32_bf16 v[120:123], a[48:51], a[128:131], v[120:123]
ds_read_b128 a[92:95], v3 offset:38912
v_mfma_f32_16x16x32_bf16 v[120:123], a[52:55], a[132:135], v[120:123]
buffer_load_dwordx4 v15, s[8:11], s24 offen offset:3072 lds
v_mfma_f32_16x16x32_bf16 v[124:127], a[56:59], a[128:131], v[124:127]
s_add_u32 s24, s24, 128
v_mfma_f32_16x16x32_bf16 v[124:127], a[60:63], a[132:135], v[124:127]
s_waitcnt lgkmcnt(2)
s_sub_u32 s26, s26, 8388608
v_mfma_f32_16x16x32_bf16 v[128:131], a[0:3], a[136:139], v[128:131]
s_sub_u32 s27, s27, 8388608
s_add_u32 m0, s29, 131072
ds_read_b64_tr_b16 a[128:129], v8 offset:0
v_mfma_f32_16x16x32_bf16 v[128:131], a[4:7], a[140:143], v[128:131]
buffer_load_dwordx4 v16, s[12:15], s26 offen offset:0 lds
v_mfma_f32_16x16x32_bf16 v[132:135], a[8:11], a[136:139], v[132:135]
ds_read_b64_tr_b16 a[130:131], v8 offset:2048
v_mfma_f32_16x16x32_bf16 v[132:135], a[12:15], a[140:143], v[132:135]
v_mfma_f32_16x16x32_bf16 v[136:139], a[16:19], a[136:139], v[136:139]
ds_read_b64_tr_b16 a[132:133], v8 offset:16384
v_mfma_f32_16x16x32_bf16 v[136:139], a[20:23], a[140:143], v[136:139]
buffer_load_dwordx4 v17, s[12:15], s26 offen offset:1024 lds
v_mfma_f32_16x16x32_bf16 v[140:143], a[24:27], a[136:139], v[140:143]
ds_read_b64_tr_b16 a[134:135], v8 offset:18432
v_mfma_f32_16x16x32_bf16 v[140:143], a[28:31], a[140:143], v[140:143]
v_mfma_f32_16x16x32_bf16 v[144:147], a[32:35], a[136:139], v[144:147]
ds_read_b128 a[96:99], v2 offset:40960
v_mfma_f32_16x16x32_bf16 v[144:147], a[36:39], a[140:143], v[144:147]
buffer_load_dwordx4 v18, s[12:15], s26 offen offset:2048 lds
v_mfma_f32_16x16x32_bf16 v[148:151], a[40:43], a[136:139], v[148:151]
v_mfma_f32_16x16x32_bf16 v[148:151], a[44:47], a[140:143], v[148:151]
v_mfma_f32_16x16x32_bf16 v[152:155], a[48:51], a[136:139], v[152:155]
ds_read_b128 a[100:103], v3 offset:40960
v_mfma_f32_16x16x32_bf16 v[152:155], a[52:55], a[140:143], v[152:155]
buffer_load_dwordx4 v19, s[12:15], s26 offen offset:3072 lds
v_mfma_f32_16x16x32_bf16 v[156:159], a[56:59], a[136:139], v[156:159]
s_add_u32 s26, s26, 524288
ds_read_b128 a[104:107], v2 offset:43008
v_mfma_f32_16x16x32_bf16 v[156:159], a[60:63], a[140:143], v[156:159]
s_waitcnt lgkmcnt(5)
v_mfma_f32_16x16x32_bf16 v[160:163], a[0:3], a[128:131], v[160:163]
s_waitcnt lgkmcnt(3)
s_add_u32 m0, s29, 147456
ds_read_b64_tr_b16 a[136:137], v9 offset:0
v_mfma_f32_16x16x32_bf16 v[160:163], a[4:7], a[132:135], v[160:163]
buffer_load_dwordx4 v16, s[12:15], s27 offen offset:0 lds
v_mfma_f32_16x16x32_bf16 v[164:167], a[8:11], a[128:131], v[164:167]
ds_read_b64_tr_b16 a[138:139], v9 offset:2048
v_mfma_f32_16x16x32_bf16 v[164:167], a[12:15], a[132:135], v[164:167]
v_mfma_f32_16x16x32_bf16 v[168:171], a[16:19], a[128:131], v[168:171]
ds_read_b64_tr_b16 a[140:141], v9 offset:16384
v_mfma_f32_16x16x32_bf16 v[168:171], a[20:23], a[132:135], v[168:171]
buffer_load_dwordx4 v17, s[12:15], s27 offen offset:1024 lds
v_mfma_f32_16x16x32_bf16 v[172:175], a[24:27], a[128:131], v[172:175]
ds_read_b64_tr_b16 a[142:143], v9 offset:18432
v_mfma_f32_16x16x32_bf16 v[172:175], a[28:31], a[132:135], v[172:175]
v_mfma_f32_16x16x32_bf16 v[176:179], a[32:35], a[128:131], v[176:179]
v_mfma_f32_16x16x32_bf16 v[176:179], a[36:39], a[132:135], v[176:179]
buffer_load_dwordx4 v18, s[12:15], s27 offen offset:2048 lds
v_mfma_f32_16x16x32_bf16 v[180:183], a[40:43], a[128:131], v[180:183]
ds_read_b128 a[108:111], v3 offset:43008
v_mfma_f32_16x16x32_bf16 v[180:183], a[44:47], a[132:135], v[180:183]
v_mfma_f32_16x16x32_bf16 v[184:187], a[48:51], a[128:131], v[184:187]
ds_read_b128 a[112:115], v2 offset:45056
v_mfma_f32_16x16x32_bf16 v[184:187], a[52:55], a[132:135], v[184:187]
buffer_load_dwordx4 v19, s[12:15], s27 offen offset:3072 lds
v_mfma_f32_16x16x32_bf16 v[188:191], a[56:59], a[128:131], v[188:191]
s_add_u32 s27, s27, 524288
v_mfma_f32_16x16x32_bf16 v[188:191], a[60:63], a[132:135], v[188:191]
s_waitcnt lgkmcnt(4)
v_mfma_f32_16x16x32_bf16 v[192:195], a[0:3], a[136:139], v[192:195]
s_waitcnt lgkmcnt(2)
ds_read_b64_tr_b16 a[128:129], v10 offset:0
v_mfma_f32_16x16x32_bf16 v[192:195], a[4:7], a[140:143], v[192:195]
v_mfma_f32_16x16x32_bf16 v[196:199], a[8:11], a[136:139], v[196:199]
ds_read_b64_tr_b16 a[130:131], v10 offset:2048
v_mfma_f32_16x16x32_bf16 v[196:199], a[12:15], a[140:143], v[196:199]
v_mfma_f32_16x16x32_bf16 v[200:203], a[16:19], a[136:139], v[200:203]
ds_read_b64_tr_b16 a[132:133], v10 offset:16384
v_mfma_f32_16x16x32_bf16 v[200:203], a[20:23], a[140:143], v[200:203]
v_mfma_f32_16x16x32_bf16 v[204:207], a[24:27], a[136:139], v[204:207]
ds_read_b64_tr_b16 a[134:135], v10 offset:18432
v_mfma_f32_16x16x32_bf16 v[204:207], a[28:31], a[140:143], v[204:207]
v_mfma_f32_16x16x32_bf16 v[208:211], a[32:35], a[136:139], v[208:211]
ds_read_b128 a[116:119], v3 offset:45056
v_mfma_f32_16x16x32_bf16 v[208:211], a[36:39], a[140:143], v[208:211]
v_mfma_f32_16x16x32_bf16 v[212:215], a[40:43], a[136:139], v[212:215]
ds_read_b128 a[120:123], v2 offset:47104
v_mfma_f32_16x16x32_bf16 v[212:215], a[44:47], a[140:143], v[212:215]
v_mfma_f32_16x16x32_bf16 v[216:219], a[48:51], a[136:139], v[216:219]
v_mfma_f32_16x16x32_bf16 v[216:219], a[52:55], a[140:143], v[216:219]
v_mfma_f32_16x16x32_bf16 v[220:223], a[56:59], a[136:139], v[220:223]
ds_read_b128 a[124:127], v3 offset:47104
v_mfma_f32_16x16x32_bf16 v[220:223], a[60:63], a[140:143], v[220:223]
s_waitcnt lgkmcnt(5)
v_mfma_f32_16x16x32_bf16 v[224:227], a[0:3], a[128:131], v[224:227]
s_waitcnt lgkmcnt(3)
ds_read_b64_tr_b16 a[136:137], v11 offset:0
v_mfma_f32_16x16x32_bf16 v[224:227], a[4:7], a[132:135], v[224:227]
v_mfma_f32_16x16x32_bf16 v[228:231], a[8:11], a[128:131], v[228:231]
ds_read_b64_tr_b16 a[138:139], v11 offset:2048
v_mfma_f32_16x16x32_bf16 v[228:231], a[12:15], a[132:135], v[228:231]
v_mfma_f32_16x16x32_bf16 v[232:235], a[16:19], a[128:131], v[232:235]
ds_read_b64_tr_b16 a[140:141], v11 offset:16384
v_mfma_f32_16x16x32_bf16 v[232:235], a[20:23], a[132:135], v[232:235]
v_mfma_f32_16x16x32_bf16 v[236:239], a[24:27], a[128:131], v[236:239]
ds_read_b64_tr_b16 a[142:143], v11 offset:18432
v_mfma_f32_16x16x32_bf16 v[236:239], a[28:31], a[132:135], v[236:239]
v_mfma_f32_16x16x32_bf16 v[240:243], a[32:35], a[128:131], v[240:243]
v_mfma_f32_16x16x32_bf16 v[240:243], a[36:39], a[132:135], v[240:243]
v_mfma_f32_16x16x32_bf16 v[244:247], a[40:43], a[128:131], v[244:247]
v_mfma_f32_16x16x32_bf16 v[244:247], a[44:47], a[132:135], v[244:247]
v_mfma_f32_16x16x32_bf16 v[248:251], a[48:51], a[128:131], v[248:251]
v_mfma_f32_16x16x32_bf16 v[248:251], a[52:55], a[132:135], v[248:251]
v_mfma_f32_16x16x32_bf16 v[252:255], a[56:59], a[128:131], v[252:255]
v_mfma_f32_16x16x32_bf16 v[252:255], a[60:63], a[132:135], v[252:255]
s_waitcnt vmcnt(12) lgkmcnt(0)
s_barrier
v_mfma_f32_16x16x32_bf16 a[224:227], a[0:3], a[136:139], a[224:227]
s_add_u32 m0, s28, 32768
ds_read_b64_tr_b16 a[128:129], v4 offset:32768
v_mfma_f32_16x16x32_bf16 a[224:227], a[4:7], a[140:143], a[224:227]
s_lshr_b32 s22, s3, 1
buffer_load_dwordx4 v12, s[8:11], s24 offen offset:0 lds
v_mfma_f32_16x16x32_bf16 a[228:231], a[8:11], a[136:139], a[228:231]
s_lshl_b32 s22, s22, 14
ds_read_b64_tr_b16 a[130:131], v4 offset:34816
v_subrev_u32 v2, s22, v2
v_mfma_f32_16x16x32_bf16 a[228:231], a[12:15], a[140:143], a[228:231]
v_subrev_u32 v3, s22, v3
v_mfma_f32_16x16x32_bf16 a[232:235], a[16:19], a[136:139], a[232:235]
ds_read_b64_tr_b16 a[132:133], v4 offset:49152
v_mfma_f32_16x16x32_bf16 a[232:235], a[20:23], a[140:143], a[232:235]
buffer_load_dwordx4 v13, s[8:11], s24 offen offset:1024 lds
v_mfma_f32_16x16x32_bf16 a[236:239], a[24:27], a[136:139], a[236:239]
ds_read_b64_tr_b16 a[134:135], v4 offset:51200
v_mfma_f32_16x16x32_bf16 a[236:239], a[28:31], a[140:143], a[236:239]
v_mfma_f32_16x16x32_bf16 a[240:243], a[32:35], a[136:139], a[240:243]
v_mfma_f32_16x16x32_bf16 a[240:243], a[36:39], a[140:143], a[240:243]
buffer_load_dwordx4 v14, s[8:11], s24 offen offset:2048 lds
v_mfma_f32_16x16x32_bf16 a[244:247], a[40:43], a[136:139], a[244:247]
v_mfma_f32_16x16x32_bf16 a[244:247], a[44:47], a[140:143], a[244:247]
v_mfma_f32_16x16x32_bf16 a[248:251], a[48:51], a[136:139], a[248:251]
v_mfma_f32_16x16x32_bf16 a[248:251], a[52:55], a[140:143], a[248:251]
buffer_load_dwordx4 v15, s[8:11], s24 offen offset:3072 lds
v_mfma_f32_16x16x32_bf16 a[252:255], a[56:59], a[136:139], a[252:255]
s_add_u32 s24, s24, 128
v_mfma_f32_16x16x32_bf16 a[252:255], a[60:63], a[140:143], a[252:255]
s_waitcnt lgkmcnt(2)
v_mfma_f32_16x16x32_bf16 v[32:35], a[64:67], a[128:131], v[32:35]
s_waitcnt lgkmcnt(0)
s_add_u32 m0, s29, 65536
ds_read_b64_tr_b16 a[136:137], v5 offset:32768
v_mfma_f32_16x16x32_bf16 v[32:35], a[68:71], a[132:135], v[32:35]
buffer_load_dwordx4 v16, s[12:15], s26 offen offset:0 lds
v_mfma_f32_16x16x32_bf16 v[36:39], a[72:75], a[128:131], v[36:39]
ds_read_b64_tr_b16 a[138:139], v5 offset:34816
v_mfma_f32_16x16x32_bf16 v[36:39], a[76:79], a[132:135], v[36:39]
v_mfma_f32_16x16x32_bf16 v[40:43], a[80:83], a[128:131], v[40:43]
ds_read_b64_tr_b16 a[140:141], v5 offset:49152
v_mfma_f32_16x16x32_bf16 v[40:43], a[84:87], a[132:135], v[40:43]
buffer_load_dwordx4 v17, s[12:15], s26 offen offset:1024 lds
v_mfma_f32_16x16x32_bf16 v[44:47], a[88:91], a[128:131], v[44:47]
ds_read_b64_tr_b16 a[142:143], v5 offset:51200
v_mfma_f32_16x16x32_bf16 v[44:47], a[92:95], a[132:135], v[44:47]
v_mfma_f32_16x16x32_bf16 v[48:51], a[96:99], a[128:131], v[48:51]
ds_read_b128 a[0:3], v2 offset:0
v_cvt_pk_bf16_f32 v32, v32, v33
v_mfma_f32_16x16x32_bf16 v[48:51], a[100:103], a[132:135], v[48:51]
buffer_load_dwordx4 v18, s[12:15], s26 offen offset:2048 lds
v_mfma_f32_16x16x32_bf16 v[52:55], a[104:107], a[128:131], v[52:55]
ds_read_b128 a[4:7], v3 offset:0
v_cvt_pk_bf16_f32 v33, v34, v35
v_mfma_f32_16x16x32_bf16 v[52:55], a[108:111], a[132:135], v[52:55]
v_cvt_pk_bf16_f32 v34, v36, v37
v_cvt_pk_bf16_f32 v35, v38, v39
v_mfma_f32_16x16x32_bf16 v[56:59], a[112:115], a[128:131], v[56:59]
v_cvt_pk_bf16_f32 v40, v40, v41
v_cvt_pk_bf16_f32 v41, v42, v43
v_mfma_f32_16x16x32_bf16 v[56:59], a[116:119], a[132:135], v[56:59]
buffer_load_dwordx4 v19, s[12:15], s26 offen offset:3072 lds
v_mfma_f32_16x16x32_bf16 v[60:63], a[120:123], a[128:131], v[60:63]
s_add_u32 s26, s26, 524288
ds_read_b128 a[8:11], v2 offset:2048
v_cvt_pk_bf16_f32 v42, v44, v45
v_mfma_f32_16x16x32_bf16 v[60:63], a[124:127], a[132:135], v[60:63]
s_waitcnt lgkmcnt(3)
v_cvt_pk_bf16_f32 v43, v46, v47
v_mfma_f32_16x16x32_bf16 v[64:67], a[64:67], a[136:139], v[64:67]
s_add_u32 m0, s29, 81920
ds_read_b64_tr_b16 a[128:129], v6 offset:32768
v_cvt_pk_bf16_f32 v48, v48, v49
v_mfma_f32_16x16x32_bf16 v[64:67], a[68:71], a[140:143], v[64:67]
buffer_load_dwordx4 v16, s[12:15], s27 offen offset:0 lds
v_mfma_f32_16x16x32_bf16 v[68:71], a[72:75], a[136:139], v[68:71]
ds_read_b64_tr_b16 a[130:131], v6 offset:34816
v_cvt_pk_bf16_f32 v49, v50, v51
v_mfma_f32_16x16x32_bf16 v[68:71], a[76:79], a[140:143], v[68:71]
v_cvt_pk_bf16_f32 v50, v52, v53
v_cvt_pk_bf16_f32 v51, v54, v55
v_mfma_f32_16x16x32_bf16 v[72:75], a[80:83], a[136:139], v[72:75]
ds_read_b64_tr_b16 a[132:133], v6 offset:49152
v_cvt_pk_bf16_f32 v56, v56, v57
v_mfma_f32_16x16x32_bf16 v[72:75], a[84:87], a[140:143], v[72:75]
buffer_load_dwordx4 v17, s[12:15], s27 offen offset:1024 lds
v_mfma_f32_16x16x32_bf16 v[76:79], a[88:91], a[136:139], v[76:79]
ds_read_b64_tr_b16 a[134:135], v6 offset:51200
v_cvt_pk_bf16_f32 v57, v58, v59
v_mfma_f32_16x16x32_bf16 v[76:79], a[92:95], a[140:143], v[76:79]
v_cvt_pk_bf16_f32 v58, v60, v61
v_cvt_pk_bf16_f32 v59, v62, v63
v_mfma_f32_16x16x32_bf16 v[80:83], a[96:99], a[136:139], v[80:83]
ds_read_b128 a[12:15], v3 offset:2048
v_cvt_pk_bf16_f32 v64, v64, v65
v_mfma_f32_16x16x32_bf16 v[80:83], a[100:103], a[140:143], v[80:83]
buffer_load_dwordx4 v18, s[12:15], s27 offen offset:2048 lds
v_mfma_f32_16x16x32_bf16 v[84:87], a[104:107], a[136:139], v[84:87]
v_cvt_pk_bf16_f32 v65, v66, v67
v_cvt_pk_bf16_f32 v66, v68, v69
v_mfma_f32_16x16x32_bf16 v[84:87], a[108:111], a[140:143], v[84:87]
v_cvt_pk_bf16_f32 v67, v70, v71
v_mfma_f32_16x16x32_bf16 v[88:91], a[112:115], a[136:139], v[88:91]
ds_read_b128 a[16:19], v2 offset:4096
v_cvt_pk_bf16_f32 v72, v72, v73
v_mfma_f32_16x16x32_bf16 v[88:91], a[116:119], a[140:143], v[88:91]
buffer_load_dwordx4 v19, s[12:15], s27 offen offset:3072 lds
v_mfma_f32_16x16x32_bf16 v[92:95], a[120:123], a[136:139], v[92:95]
s_add_u32 s27, s27, 524288
ds_read_b128 a[20:23], v3 offset:4096
v_cvt_pk_bf16_f32 v73, v74, v75
v_mfma_f32_16x16x32_bf16 v[92:95], a[124:127], a[140:143], v[92:95]
s_waitcnt lgkmcnt(3)
v_cvt_pk_bf16_f32 v74, v76, v77
v_cvt_pk_bf16_f32 v75, v78, v79
v_mfma_f32_16x16x32_bf16 v[96:99], a[64:67], a[128:131], v[96:99]
s_add_u32 m0, s28, 49152
ds_read_b64_tr_b16 a[136:137], v7 offset:32768
v_cvt_pk_bf16_f32 v80, v80, v81
v_mfma_f32_16x16x32_bf16 v[96:99], a[68:71], a[132:135], v[96:99]
buffer_load_dwordx4 v12, s[8:11], s24 offen offset:0 lds
v_mfma_f32_16x16x32_bf16 v[100:103], a[72:75], a[128:131], v[100:103]
ds_read_b64_tr_b16 a[138:139], v7 offset:34816
v_cvt_pk_bf16_f32 v81, v82, v83
v_mfma_f32_16x16x32_bf16 v[100:103], a[76:79], a[132:135], v[100:103]
v_cvt_pk_bf16_f32 v82, v84, v85
v_cvt_pk_bf16_f32 v83, v86, v87
v_mfma_f32_16x16x32_bf16 v[104:107], a[80:83], a[128:131], v[104:107]
ds_read_b64_tr_b16 a[140:141], v7 offset:49152
v_cvt_pk_bf16_f32 v88, v88, v89
v_mfma_f32_16x16x32_bf16 v[104:107], a[84:87], a[132:135], v[104:107]
buffer_load_dwordx4 v13, s[8:11], s24 offen offset:1024 lds
v_mfma_f32_16x16x32_bf16 v[108:111], a[88:91], a[128:131], v[108:111]
ds_read_b64_tr_b16 a[142:143], v7 offset:51200
v_cvt_pk_bf16_f32 v89, v90, v91
v_mfma_f32_16x16x32_bf16 v[108:111], a[92:95], a[132:135], v[108:111]
v_cvt_pk_bf16_f32 v90, v92, v93
v_cvt_pk_bf16_f32 v91, v94, v95
v_mfma_f32_16x16x32_bf16 v[112:115], a[96:99], a[128:131], v[112:115]
v_cvt_pk_bf16_f32 v96, v96, v97
v_cvt_pk_bf16_f32 v97, v98, v99
v_mfma_f32_16x16x32_bf16 v[112:115], a[100:103], a[132:135], v[112:115]
buffer_load_dwordx4 v14, s[8:11], s24 offen offset:2048 lds
v_mfma_f32_16x16x32_bf16 v[116:119], a[104:107], a[128:131], v[116:119]
ds_read_b128 a[24:27], v2 offset:6144
v_cvt_pk_bf16_f32 v98, v100, v101
v_mfma_f32_16x16x32_bf16 v[116:119], a[108:111], a[132:135], v[116:119]
v_cvt_pk_bf16_f32 v99, v102, v103
v_mfma_f32_16x16x32_bf16 v[120:123], a[112:115], a[128:131], v[120:123]
ds_read_b128 a[28:31], v3 offset:6144
v_cvt_pk_bf16_f32 v104, v104, v105
v_mfma_f32_16x16x32_bf16 v[120:123], a[116:119], a[132:135], v[120:123]
buffer_load_dwordx4 v15, s[8:11], s24 offen offset:3072 lds
v_mfma_f32_16x16x32_bf16 v[124:127], a[120:123], a[128:131], v[124:127]
s_add_u32 s24, s24, 128
v_cvt_pk_bf16_f32 v105, v106, v107
v_cvt_pk_bf16_f32 v106, v108, v109
v_mfma_f32_16x16x32_bf16 v[124:127], a[124:127], a[132:135], v[124:127]
s_waitcnt lgkmcnt(4)
v_cvt_pk_bf16_f32 v107, v110, v111
v_mfma_f32_16x16x32_bf16 v[128:131], a[64:67], a[136:139], v[128:131]
s_waitcnt lgkmcnt(2)
ds_read_b64_tr_b16 a[128:129], v8 offset:32768
v_cvt_pk_bf16_f32 v112, v112, v113
v_mfma_f32_16x16x32_bf16 v[128:131], a[68:71], a[140:143], v[128:131]
v_cvt_pk_bf16_f32 v113, v114, v115
v_cvt_pk_bf16_f32 v114, v116, v117
v_mfma_f32_16x16x32_bf16 v[132:135], a[72:75], a[136:139], v[132:135]
ds_read_b64_tr_b16 a[130:131], v8 offset:34816
v_cvt_pk_bf16_f32 v115, v118, v119
v_mfma_f32_16x16x32_bf16 v[132:135], a[76:79], a[140:143], v[132:135]
buffer_store_dwordx4 v[32:35], v1, s[4:7], s31 offen sc1
v_mfma_f32_16x16x32_bf16 v[136:139], a[80:83], a[136:139], v[136:139]
s_add_u32 s31, s31, s32
ds_read_b64_tr_b16 a[132:133], v8 offset:49152
v_cvt_pk_bf16_f32 v120, v120, v121
v_mfma_f32_16x16x32_bf16 v[136:139], a[84:87], a[140:143], v[136:139]
v_cvt_pk_bf16_f32 v121, v122, v123
v_cvt_pk_bf16_f32 v122, v124, v125
v_mfma_f32_16x16x32_bf16 v[140:143], a[88:91], a[136:139], v[140:143]
ds_read_b64_tr_b16 a[134:135], v8 offset:51200
v_cvt_pk_bf16_f32 v123, v126, v127
v_mfma_f32_16x16x32_bf16 v[140:143], a[92:95], a[140:143], v[140:143]
v_mfma_f32_16x16x32_bf16 v[144:147], a[96:99], a[136:139], v[144:147]
ds_read_b128 a[32:35], v2 offset:8192
v_cvt_pk_bf16_f32 v128, v128, v129
v_mfma_f32_16x16x32_bf16 v[144:147], a[100:103], a[140:143], v[144:147]
v_cvt_pk_bf16_f32 v129, v130, v131
v_cvt_pk_bf16_f32 v130, v132, v133
v_mfma_f32_16x16x32_bf16 v[148:151], a[104:107], a[136:139], v[148:151]
v_cvt_pk_bf16_f32 v131, v134, v135
v_mfma_f32_16x16x32_bf16 v[148:151], a[108:111], a[140:143], v[148:151]
v_mfma_f32_16x16x32_bf16 v[152:155], a[112:115], a[136:139], v[152:155]
ds_read_b128 a[36:39], v3 offset:8192
v_cvt_pk_bf16_f32 v136, v136, v137
v_mfma_f32_16x16x32_bf16 v[152:155], a[116:119], a[140:143], v[152:155]
v_cvt_pk_bf16_f32 v137, v138, v139
v_cvt_pk_bf16_f32 v138, v140, v141
v_mfma_f32_16x16x32_bf16 v[156:159], a[120:123], a[136:139], v[156:159]
ds_read_b128 a[40:43], v2 offset:10240
v_cvt_pk_bf16_f32 v139, v142, v143
v_mfma_f32_16x16x32_bf16 v[156:159], a[124:127], a[140:143], v[156:159]
s_waitcnt lgkmcnt(5)
v_mfma_f32_16x16x32_bf16 v[160:163], a[64:67], a[128:131], v[160:163]
s_waitcnt lgkmcnt(3)
ds_read_b64_tr_b16 a[136:137], v9 offset:32768
v_cvt_pk_bf16_f32 v144, v144, v145
v_mfma_f32_16x16x32_bf16 v[160:163], a[68:71], a[132:135], v[160:163]
buffer_store_dwordx4 v[40:43], v1, s[4:7], s31 offen sc1
v_mfma_f32_16x16x32_bf16 v[164:167], a[72:75], a[128:131], v[164:167]
s_add_u32 s31, s31, s33
ds_read_b64_tr_b16 a[138:139], v9 offset:34816
v_cvt_pk_bf16_f32 v145, v146, v147
v_mfma_f32_16x16x32_bf16 v[164:167], a[76:79], a[132:135], v[164:167]
v_cvt_pk_bf16_f32 v146, v148, v149
v_cvt_pk_bf16_f32 v147, v150, v151
v_mfma_f32_16x16x32_bf16 v[168:171], a[80:83], a[128:131], v[168:171]
ds_read_b64_tr_b16 a[140:141], v9 offset:49152
v_cvt_pk_bf16_f32 v152, v152, v153
v_mfma_f32_16x16x32_bf16 v[168:171], a[84:87], a[132:135], v[168:171]
v_cvt_pk_bf16_f32 v153, v154, v155
v_cvt_pk_bf16_f32 v154, v156, v157
v_mfma_f32_16x16x32_bf16 v[172:175], a[88:91], a[128:131], v[172:175]
ds_read_b64_tr_b16 a[142:143], v9 offset:51200
v_cvt_pk_bf16_f32 v155, v158, v159
v_mfma_f32_16x16x32_bf16 v[172:175], a[92:95], a[132:135], v[172:175]
v_mfma_f32_16x16x32_bf16 v[176:179], a[96:99], a[128:131], v[176:179]
v_cvt_pk_bf16_f32 v160, v160, v161
v_cvt_pk_bf16_f32 v161, v162, v163
v_mfma_f32_16x16x32_bf16 v[176:179], a[100:103], a[132:135], v[176:179]
v_cvt_pk_bf16_f32 v162, v164, v165
v_cvt_pk_bf16_f32 v163, v166, v167
v_mfma_f32_16x16x32_bf16 v[180:183], a[104:107], a[128:131], v[180:183]
ds_read_b128 a[44:47], v3 offset:10240
v_mfma_f32_16x16x32_bf16 v[180:183], a[108:111], a[132:135], v[180:183]
v_mfma_f32_16x16x32_bf16 v[184:187], a[112:115], a[128:131], v[184:187]
ds_read_b128 a[48:51], v2 offset:12288
v_cvt_pk_bf16_f32 v168, v168, v169
v_mfma_f32_16x16x32_bf16 v[184:187], a[116:119], a[132:135], v[184:187]
v_cvt_pk_bf16_f32 v169, v170, v171
v_cvt_pk_bf16_f32 v170, v172, v173
v_mfma_f32_16x16x32_bf16 v[188:191], a[120:123], a[128:131], v[188:191]
v_cvt_pk_bf16_f32 v171, v174, v175
v_mfma_f32_16x16x32_bf16 v[188:191], a[124:127], a[132:135], v[188:191]
s_waitcnt lgkmcnt(2)
buffer_store_dwordx4 v[48:51], v1, s[4:7], s31 offen sc1
v_mfma_f32_16x16x32_bf16 v[192:195], a[64:67], a[136:139], v[192:195]
s_add_u32 s31, s31, s32
ds_read_b64_tr_b16 a[128:129], v10 offset:32768
v_cvt_pk_bf16_f32 v176, v176, v177
v_mfma_f32_16x16x32_bf16 v[192:195], a[68:71], a[140:143], v[192:195]
v_cvt_pk_bf16_f32 v177, v178, v179
v_cvt_pk_bf16_f32 v178, v180, v181
v_mfma_f32_16x16x32_bf16 v[196:199], a[72:75], a[136:139], v[196:199]
ds_read_b64_tr_b16 a[130:131], v10 offset:34816
v_cvt_pk_bf16_f32 v179, v182, v183
v_mfma_f32_16x16x32_bf16 v[196:199], a[76:79], a[140:143], v[196:199]
v_mfma_f32_16x16x32_bf16 v[200:203], a[80:83], a[136:139], v[200:203]
ds_read_b64_tr_b16 a[132:133], v10 offset:49152
v_cvt_pk_bf16_f32 v184, v184, v185
v_mfma_f32_16x16x32_bf16 v[200:203], a[84:87], a[140:143], v[200:203]
v_cvt_pk_bf16_f32 v185, v186, v187
v_cvt_pk_bf16_f32 v186, v188, v189
v_mfma_f32_16x16x32_bf16 v[204:207], a[88:91], a[136:139], v[204:207]
ds_read_b64_tr_b16 a[134:135], v10 offset:51200
v_cvt_pk_bf16_f32 v187, v190, v191
v_mfma_f32_16x16x32_bf16 v[204:207], a[92:95], a[140:143], v[204:207]
v_mfma_f32_16x16x32_bf16 v[208:211], a[96:99], a[136:139], v[208:211]
ds_read_b128 a[52:55], v3 offset:12288
v_cvt_pk_bf16_f32 v192, v192, v193
v_mfma_f32_16x16x32_bf16 v[208:211], a[100:103], a[140:143], v[208:211]
v_cvt_pk_bf16_f32 v193, v194, v195
v_cvt_pk_bf16_f32 v194, v196, v197
v_mfma_f32_16x16x32_bf16 v[212:215], a[104:107], a[136:139], v[212:215]
ds_read_b128 a[56:59], v2 offset:14336
v_cvt_pk_bf16_f32 v195, v198, v199
v_mfma_f32_16x16x32_bf16 v[212:215], a[108:111], a[140:143], v[212:215]
v_mfma_f32_16x16x32_bf16 v[216:219], a[112:115], a[136:139], v[216:219]
v_cvt_pk_bf16_f32 v200, v200, v201
v_cvt_pk_bf16_f32 v201, v202, v203
v_mfma_f32_16x16x32_bf16 v[216:219], a[116:119], a[140:143], v[216:219]
buffer_store_dwordx4 v[56:59], v1, s[4:7], s31 offen sc1
v_mfma_f32_16x16x32_bf16 v[220:223], a[120:123], a[136:139], v[220:223]
s_add_u32 s31, s31, s34
ds_read_b128 a[60:63], v3 offset:14336
v_cvt_pk_bf16_f32 v202, v204, v205
v_mfma_f32_16x16x32_bf16 v[220:223], a[124:127], a[140:143], v[220:223]
s_waitcnt lgkmcnt(5)
v_cvt_pk_bf16_f32 v203, v206, v207
v_mfma_f32_16x16x32_bf16 v[224:227], a[64:67], a[128:131], v[224:227]
s_waitcnt lgkmcnt(3)
ds_read_b64_tr_b16 a[136:137], v11 offset:32768
v_cvt_pk_bf16_f32 v208, v208, v209
v_mfma_f32_16x16x32_bf16 v[224:227], a[68:71], a[132:135], v[224:227]
v_cvt_pk_bf16_f32 v209, v210, v211
v_cvt_pk_bf16_f32 v210, v212, v213
v_mfma_f32_16x16x32_bf16 v[228:231], a[72:75], a[128:131], v[228:231]
ds_read_b64_tr_b16 a[138:139], v11 offset:34816
v_cvt_pk_bf16_f32 v211, v214, v215
v_mfma_f32_16x16x32_bf16 v[228:231], a[76:79], a[132:135], v[228:231]
v_mfma_f32_16x16x32_bf16 v[232:235], a[80:83], a[128:131], v[232:235]
ds_read_b64_tr_b16 a[140:141], v11 offset:49152
v_cvt_pk_bf16_f32 v216, v216, v217
v_mfma_f32_16x16x32_bf16 v[232:235], a[84:87], a[132:135], v[232:235]
v_cvt_pk_bf16_f32 v217, v218, v219
v_cvt_pk_bf16_f32 v218, v220, v221
v_mfma_f32_16x16x32_bf16 v[236:239], a[88:91], a[128:131], v[236:239]
ds_read_b64_tr_b16 a[142:143], v11 offset:51200
v_cvt_pk_bf16_f32 v219, v222, v223
v_mfma_f32_16x16x32_bf16 v[236:239], a[92:95], a[132:135], v[236:239]
v_mfma_f32_16x16x32_bf16 v[240:243], a[96:99], a[128:131], v[240:243]
v_mfma_f32_16x16x32_bf16 v[240:243], a[100:103], a[132:135], v[240:243]
v_mfma_f32_16x16x32_bf16 v[244:247], a[104:107], a[128:131], v[244:247]
v_mfma_f32_16x16x32_bf16 v[244:247], a[108:111], a[132:135], v[244:247]
buffer_store_dwordx4 v[64:67], v1, s[4:7], s31 offen sc1
v_mfma_f32_16x16x32_bf16 v[248:251], a[112:115], a[128:131], v[248:251]
s_add_u32 s31, s31, s32
v_mfma_f32_16x16x32_bf16 v[248:251], a[116:119], a[132:135], v[248:251]
v_mfma_f32_16x16x32_bf16 v[252:255], a[120:123], a[128:131], v[252:255]
v_mfma_f32_16x16x32_bf16 v[252:255], a[124:127], a[132:135], v[252:255]
s_waitcnt vmcnt(21) lgkmcnt(0)
s_barrier
v_mfma_f32_16x16x32_bf16 a[224:227], a[64:67], a[136:139], a[224:227]
s_add_u32 m0, s29, 98304
ds_read_b64_tr_b16 a[128:129], v22 offset:0
v_mfma_f32_16x16x32_bf16 a[224:227], a[68:71], a[140:143], a[224:227]
buffer_load_dwordx4 v16, s[12:15], s26 offen offset:0 lds
v_mfma_f32_16x16x32_bf16 a[228:231], a[72:75], a[136:139], a[228:231]
ds_read_b64_tr_b16 a[130:131], v22 offset:2048
v_mfma_f32_16x16x32_bf16 a[228:231], a[76:79], a[140:143], a[228:231]
v_mfma_f32_16x16x32_bf16 a[232:235], a[80:83], a[136:139], a[232:235]
ds_read_b64_tr_b16 a[132:133], v22 offset:16384
v_mfma_f32_16x16x32_bf16 a[232:235], a[84:87], a[140:143], a[232:235]
buffer_load_dwordx4 v17, s[12:15], s26 offen offset:1024 lds
v_mfma_f32_16x16x32_bf16 a[236:239], a[88:91], a[136:139], a[236:239]
ds_read_b64_tr_b16 a[134:135], v22 offset:18432
v_add_u32 v22, 4294901760, v22
v_mfma_f32_16x16x32_bf16 a[236:239], a[92:95], a[140:143], a[236:239]
v_mfma_f32_16x16x32_bf16 a[240:243], a[96:99], a[136:139], a[240:243]
v_mfma_f32_16x16x32_bf16 a[240:243], a[100:103], a[140:143], a[240:243]
buffer_load_dwordx4 v18, s[12:15], s26 offen offset:2048 lds
v_mfma_f32_16x16x32_bf16 a[244:247], a[104:107], a[136:139], a[244:247]
buffer_store_dwordx4 v[72:75], v1, s[4:7], s31 offen sc1
v_mfma_f32_16x16x32_bf16 a[244:247], a[108:111], a[140:143], a[244:247]
s_add_u32 s31, s31, s33
v_mfma_f32_16x16x32_bf16 a[248:251], a[112:115], a[136:139], a[248:251]
v_mfma_f32_16x16x32_bf16 a[248:251], a[116:119], a[140:143], a[248:251]
buffer_load_dwordx4 v19, s[12:15], s26 offen offset:3072 lds
v_mfma_f32_16x16x32_bf16 a[252:255], a[120:123], a[136:139], a[252:255]
s_add_u32 s26, s26, 524288
v_mfma_f32_16x16x32_bf16 a[252:255], a[124:127], a[140:143], a[252:255]
s_waitcnt lgkmcnt(2)
M_Q:
v_mfma_f32_16x16x32_bf16 v[36:39], a[128:131], a[0:3], 0
s_waitcnt lgkmcnt(0)
s_add_u32 m0, s29, 114688
ds_read_b64_tr_b16 a[136:137], v23 offset:0
v_mfma_f32_16x16x32_bf16 v[36:39], a[132:135], a[4:7], v[36:39]
buffer_load_dwordx4 v16, s[12:15], s27 offen offset:0 lds
v_mfma_f32_16x16x32_bf16 v[44:47], a[128:131], a[8:11], 0
ds_read_b64_tr_b16 a[138:139], v23 offset:2048
v_cvt_pk_bf16_f32 v224, v224, v225
v_mfma_f32_16x16x32_bf16 v[44:47], a[132:135], a[12:15], v[44:47]
ds_read_b128 a[64:67], v2 offset:16384
ds_read_b128 a[68:71], v3 offset:16384
v_mfma_f32_16x16x32_bf16 v[52:55], a[128:131], a[16:19], 0
ds_read_b64_tr_b16 a[140:141], v23 offset:16384
v_cvt_pk_bf16_f32 v225, v226, v227
v_mfma_f32_16x16x32_bf16 v[52:55], a[132:135], a[20:23], v[52:55]
buffer_load_dwordx4 v17, s[12:15], s27 offen offset:1024 lds
v_mfma_f32_16x16x32_bf16 v[60:63], a[128:131], a[24:27], 0
ds_read_b64_tr_b16 a[142:143], v23 offset:18432
v_add_u32 v23, 4294901760, v23
v_mfma_f32_16x16x32_bf16 v[60:63], a[132:135], a[28:31], v[60:63]
v_cvt_pk_bf16_f32 v226, v228, v229
v_cvt_pk_bf16_f32 v227, v230, v231
v_mfma_f32_16x16x32_bf16 v[68:71], a[128:131], a[32:35], 0
ds_read_b128 a[72:75], v2 offset:18432
v_cvt_pk_bf16_f32 v232, v232, v233
v_mfma_f32_16x16x32_bf16 v[68:71], a[132:135], a[36:39], v[68:71]
buffer_load_dwordx4 v18, s[12:15], s27 offen offset:2048 lds
v_mfma_f32_16x16x32_bf16 v[76:79], a[128:131], a[40:43], 0
ds_read_b128 a[76:79], v3 offset:18432
v_cvt_pk_bf16_f32 v233, v234, v235
v_mfma_f32_16x16x32_bf16 v[76:79], a[132:135], a[44:47], v[76:79]
ds_read_b128 a[80:83], v2 offset:20480
v_cvt_pk_bf16_f32 v234, v236, v237
v_mfma_f32_16x16x32_bf16 v[84:87], a[128:131], a[48:51], 0
ds_read_b128 a[84:87], v3 offset:20480
v_cvt_pk_bf16_f32 v235, v238, v239
v_mfma_f32_16x16x32_bf16 v[84:87], a[132:135], a[52:55], v[84:87]
buffer_load_dwordx4 v19, s[12:15], s27 offen offset:3072 lds
v_mfma_f32_16x16x32_bf16 v[92:95], a[128:131], a[56:59], 0
s_add_u32 s27, s27, 524288
ds_read_b128 a[88:91], v2 offset:22528
v_cvt_pk_bf16_f32 v240, v240, v241
v_mfma_f32_16x16x32_bf16 v[92:95], a[132:135], a[60:63], v[92:95]
s_waitcnt lgkmcnt(5)
v_cvt_pk_bf16_f32 v241, v242, v243
v_cvt_pk_bf16_f32 v242, v244, v245
v_mfma_f32_16x16x32_bf16 v[100:103], a[136:139], a[0:3], 0
s_add_u32 m0, s28, 0
ds_read_b64_tr_b16 a[128:129], v24 offset:0
v_cvt_pk_bf16_f32 v243, v246, v247
v_mfma_f32_16x16x32_bf16 v[100:103], a[140:143], a[4:7], v[100:103]
buffer_load_dwordx4 v12, s[8:11], s24 offen offset:0 lds
v_mfma_f32_16x16x32_bf16 v[108:111], a[136:139], a[8:11], 0
ds_read_b64_tr_b16 a[130:131], v24 offset:2048
v_cvt_pk_bf16_f32 v248, v248, v249
v_mfma_f32_16x16x32_bf16 v[108:111], a[140:143], a[12:15], v[108:111]
ds_read_b128 a[92:95], v3 offset:22528
v_cvt_pk_bf16_f32 v249, v250, v251
v_mfma_f32_16x16x32_bf16 v[116:119], a[136:139], a[16:19], 0
ds_read_b64_tr_b16 a[132:133], v24 offset:16384
v_cvt_pk_bf16_f32 v250, v252, v253
v_mfma_f32_16x16x32_bf16 v[116:119], a[140:143], a[20:23], v[116:119]
buffer_load_dwordx4 v13, s[8:11], s24 offen offset:1024 lds
v_mfma_f32_16x16x32_bf16 v[124:127], a[136:139], a[24:27], 0
ds_read_b64_tr_b16 a[134:135], v24 offset:18432
v_add_u32 v24, 4294901760, v24
v_mfma_f32_16x16x32_bf16 v[124:127], a[140:143], a[28:31], v[124:127]
v_cvt_pk_bf16_f32 v251, v254, v255
v_mfma_f32_16x16x32_bf16 v[132:135], a[136:139], a[32:35], 0
ds_read_b128 a[96:99], v2 offset:24576
v_mfma_f32_16x16x32_bf16 v[132:135], a[140:143], a[36:39], v[132:135]
buffer_load_dwordx4 v14, s[8:11], s24 offen offset:2048 lds
v_mfma_f32_16x16x32_bf16 v[140:143], a[136:139], a[40:43], 0
ds_read_b128 a[100:103], v3 offset:24576
v_mfma_f32_16x16x32_bf16 v[140:143], a[140:143], a[44:47], v[140:143]
ds_read_b128 a[104:107], v2 offset:26624
v_mfma_f32_16x16x32_bf16 v[148:151], a[136:139], a[48:51], 0
ds_read_b128 a[108:111], v3 offset:26624
v_mfma_f32_16x16x32_bf16 v[148:151], a[140:143], a[52:55], v[148:151]
buffer_load_dwordx4 v15, s[8:11], s24 offen offset:3072 lds
v_mfma_f32_16x16x32_bf16 v[156:159], a[136:139], a[56:59], 0
s_add_u32 s24, s24, 128
ds_read_b128 a[112:115], v2 offset:28672
v_mfma_f32_16x16x32_bf16 v[156:159], a[140:143], a[60:63], v[156:159]
s_waitcnt lgkmcnt(8)
buffer_store_dwordx4 v[80:83], v1, s[4:7], s31 offen sc1
v_mfma_f32_16x16x32_bf16 v[164:167], a[128:131], a[0:3], 0
s_waitcnt lgkmcnt(5)
s_add_u32 s31, s31, s32
ds_read_b64_tr_b16 a[136:137], v25 offset:0
v_mfma_f32_16x16x32_bf16 v[164:167], a[132:135], a[4:7], v[164:167]
buffer_store_dwordx4 v[88:91], v1, s[4:7], s31 offen sc1
v_mfma_f32_16x16x32_bf16 v[172:175], a[128:131], a[8:11], 0
s_add_u32 s31, s31, s35
ds_read_b64_tr_b16 a[138:139], v25 offset:2048
v_mfma_f32_16x16x32_bf16 v[172:175], a[132:135], a[12:15], v[172:175]
ds_read_b128 a[116:119], v3 offset:28672
v_mfma_f32_16x16x32_bf16 v[180:183], a[128:131], a[16:19], 0
ds_read_b64_tr_b16 a[140:141], v25 offset:16384
v_mfma_f32_16x16x32_bf16 v[180:183], a[132:135], a[20:23], v[180:183]
buffer_store_dwordx4 v[96:99], v1, s[4:7], s31 offen sc1
v_mfma_f32_16x16x32_bf16 v[188:191], a[128:131], a[24:27], 0
s_add_u32 s31, s31, s32
ds_read_b64_tr_b16 a[142:143], v25 offset:18432
v_add_u32 v25, 4294901760, v25
v_mfma_f32_16x16x32_bf16 v[188:191], a[132:135], a[28:31], v[188:191]
v_mfma_f32_16x16x32_bf16 v[196:199], a[128:131], a[32:35], 0
ds_read_b128 a[120:123], v2 offset:30720
v_mfma_f32_16x16x32_bf16 v[196:199], a[132:135], a[36:39], v[196:199]
v_mfma_f32_16x16x32_bf16 v[204:207], a[128:131], a[40:43], 0
ds_read_b128 a[124:127], v3 offset:30720
v_mfma_f32_16x16x32_bf16 v[204:207], a[132:135], a[44:47], v[204:207]
v_mfma_f32_16x16x32_bf16 v[212:215], a[128:131], a[48:51], 0
v_mfma_f32_16x16x32_bf16 v[212:215], a[132:135], a[52:55], v[212:215]
buffer_store_dwordx4 v[104:107], v1, s[4:7], s31 offen sc1
v_mfma_f32_16x16x32_bf16 v[220:223], a[128:131], a[56:59], 0
s_add_u32 s31, s31, s33
v_mfma_f32_16x16x32_bf16 v[220:223], a[132:135], a[60:63], v[220:223]
s_waitcnt vmcnt(26) lgkmcnt(0)
s_barrier
v_mfma_f32_16x16x32_bf16 v[228:231], a[136:139], a[0:3], 0
s_add_u32 m0, s29, 131072
ds_read_b64_tr_b16 a[128:129], v22 offset:0
v_mfma_f32_16x16x32_bf16 v[228:231], a[140:143], a[4:7], v[228:231]
buffer_load_dwordx4 v16, s[12:15], s26 offen offset:0 lds
v_mfma_f32_16x16x32_bf16 v[236:239], a[136:139], a[8:11], 0
ds_read_b64_tr_b16 a[130:131], v22 offset:2048
v_mfma_f32_16x16x32_bf16 v[236:239], a[140:143], a[12:15], v[236:239]
v_mfma_f32_16x16x32_bf16 v[244:247], a[136:139], a[16:19], 0
ds_read_b64_tr_b16 a[132:133], v22 offset:16384
v_mfma_f32_16x16x32_bf16 v[244:247], a[140:143], a[20:23], v[244:247]
buffer_load_dwordx4 v17, s[12:15], s26 offen offset:1024 lds
v_mfma_f32_16x16x32_bf16 v[252:255], a[136:139], a[24:27], 0
ds_read_b64_tr_b16 a[134:135], v22 offset:18432
v_add_u32 v22, 32768, v22
v_mfma_f32_16x16x32_bf16 v[252:255], a[140:143], a[28:31], v[252:255]
v_mfma_f32_16x16x32_bf16 a[160:163], a[136:139], a[32:35], 0
v_mfma_f32_16x16x32_bf16 a[160:163], a[140:143], a[36:39], a[160:163]
buffer_load_dwordx4 v18, s[12:15], s26 offen offset:2048 lds
v_mfma_f32_16x16x32_bf16 a[164:167], a[136:139], a[40:43], 0
v_mfma_f32_16x16x32_bf16 a[164:167], a[140:143], a[44:47], a[164:167]
v_mfma_f32_16x16x32_bf16 a[168:171], a[136:139], a[48:51], 0
v_mfma_f32_16x16x32_bf16 a[168:171], a[140:143], a[52:55], a[168:171]
buffer_load_dwordx4 v19, s[12:15], s26 offen offset:3072 lds
v_mfma_f32_16x16x32_bf16 a[172:175], a[136:139], a[56:59], 0
s_add_u32 s26, s26, 524288
v_mfma_f32_16x16x32_bf16 a[172:175], a[140:143], a[60:63], a[172:175]
s_waitcnt lgkmcnt(2)
v_mfma_f32_16x16x32_bf16 v[36:39], a[128:131], a[64:67], v[36:39]
s_waitcnt lgkmcnt(0)
s_add_u32 m0, s29, 147456
ds_read_b64_tr_b16 a[136:137], v23 offset:0
v_mfma_f32_16x16x32_bf16 v[36:39], a[132:135], a[68:71], v[36:39]
buffer_load_dwordx4 v16, s[12:15], s27 offen offset:0 lds
v_mfma_f32_16x16x32_bf16 v[44:47], a[128:131], a[72:75], v[44:47]
ds_read_b64_tr_b16 a[138:139], v23 offset:2048
v_mfma_f32_16x16x32_bf16 v[44:47], a[132:135], a[76:79], v[44:47]
ds_read_b128 a[0:3], v2 offset:32768
ds_read_b128 a[4:7], v3 offset:32768
v_mfma_f32_16x16x32_bf16 v[52:55], a[128:131], a[80:83], v[52:55]
ds_read_b64_tr_b16 a[140:141], v23 offset:16384
v_mfma_f32_16x16x32_bf16 v[52:55], a[132:135], a[84:87], v[52:55]
buffer_load_dwordx4 v17, s[12:15], s27 offen offset:1024 lds
v_mfma_f32_16x16x32_bf16 v[60:63], a[128:131], a[88:91], v[60:63]
ds_read_b64_tr_b16 a[142:143], v23 offset:18432
v_add_u32 v23, 32768, v23
v_mfma_f32_16x16x32_bf16 v[60:63], a[132:135], a[92:95], v[60:63]
buffer_store_dwordx4 v[112:115], v1, s[4:7], s31 offen sc1
v_mfma_f32_16x16x32_bf16 v[68:71], a[128:131], a[96:99], v[68:71]
s_add_u32 s31, s31, s32
ds_read_b128 a[8:11], v2 offset:34816
v_mfma_f32_16x16x32_bf16 v[68:71], a[132:135], a[100:103], v[68:71]
buffer_load_dwordx4 v18, s[12:15], s27 offen offset:2048 lds
v_mfma_f32_16x16x32_bf16 v[76:79], a[128:131], a[104:107], v[76:79]
ds_read_b128 a[12:15], v3 offset:34816
v_mfma_f32_16x16x32_bf16 v[76:79], a[132:135], a[108:111], v[76:79]
ds_read_b128 a[16:19], v2 offset:36864
v_mfma_f32_16x16x32_bf16 v[84:87], a[128:131], a[112:115], v[84:87]
ds_read_b128 a[20:23], v3 offset:36864
v_mfma_f32_16x16x32_bf16 v[84:87], a[132:135], a[116:119], v[84:87]
buffer_load_dwordx4 v19, s[12:15], s27 offen offset:3072 lds
v_mfma_f32_16x16x32_bf16 v[92:95], a[128:131], a[120:123], v[92:95]
s_add_u32 s27, s27, 524288
ds_read_b128 a[24:27], v2 offset:38912
v_mfma_f32_16x16x32_bf16 v[92:95], a[132:135], a[124:127], v[92:95]
s_waitcnt lgkmcnt(9)
buffer_store_dwordx4 v[120:123], v1, s[4:7], s31 offen sc1
v_mfma_f32_16x16x32_bf16 v[100:103], a[136:139], a[64:67], v[100:103]
s_waitcnt lgkmcnt(5)
s_add_u32 m0, s28, 16384
ds_read_b64_tr_b16 a[128:129], v24 offset:0
v_mfma_f32_16x16x32_bf16 v[100:103], a[140:143], a[68:71], v[100:103]
s_add_u32 s31, s31, s34
buffer_load_dwordx4 v12, s[8:11], s24 offen offset:0 lds
v_mfma_f32_16x16x32_bf16 v[108:111], a[136:139], a[72:75], v[108:111]
ds_read_b64_tr_b16 a[130:131], v24 offset:2048
v_mfma_f32_16x16x32_bf16 v[108:111], a[140:143], a[76:79], v[108:111]
ds_read_b128 a[28:31], v3 offset:38912
v_mfma_f32_16x16x32_bf16 v[116:119], a[136:139], a[80:83], v[116:119]
ds_read_b64_tr_b16 a[132:133], v24 offset:16384
v_mfma_f32_16x16x32_bf16 v[116:119], a[140:143], a[84:87], v[116:119]
buffer_load_dwordx4 v13, s[8:11], s24 offen offset:1024 lds
v_mfma_f32_16x16x32_bf16 v[124:127], a[136:139], a[88:91], v[124:127]
ds_read_b64_tr_b16 a[134:135], v24 offset:18432
v_add_u32 v24, 32768, v24
v_mfma_f32_16x16x32_bf16 v[124:127], a[140:143], a[92:95], v[124:127]
v_mfma_f32_16x16x32_bf16 v[132:135], a[136:139], a[96:99], v[132:135]
ds_read_b128 a[32:35], v2 offset:40960
v_mfma_f32_16x16x32_bf16 v[132:135], a[140:143], a[100:103], v[132:135]
buffer_load_dwordx4 v14, s[8:11], s24 offen offset:2048 lds
v_mfma_f32_16x16x32_bf16 v[140:143], a[136:139], a[104:107], v[140:143]
ds_read_b128 a[36:39], v3 offset:40960
v_mfma_f32_16x16x32_bf16 v[140:143], a[140:143], a[108:111], v[140:143]
ds_read_b128 a[40:43], v2 offset:43008
v_mfma_f32_16x16x32_bf16 v[148:151], a[136:139], a[112:115], v[148:151]
ds_read_b128 a[44:47], v3 offset:43008
v_mfma_f32_16x16x32_bf16 v[148:151], a[140:143], a[116:119], v[148:151]
buffer_load_dwordx4 v15, s[8:11], s24 offen offset:3072 lds
v_mfma_f32_16x16x32_bf16 v[156:159], a[136:139], a[120:123], v[156:159]
s_add_u32 s24, s24, 128
ds_read_b128 a[48:51], v2 offset:45056
v_mfma_f32_16x16x32_bf16 v[156:159], a[140:143], a[124:127], v[156:159]
s_waitcnt lgkmcnt(8)
buffer_store_dwordx4 v[128:131], v1, s[4:7], s31 offen sc1
v_mfma_f32_16x16x32_bf16 v[164:167], a[128:131], a[64:67], v[164:167]
s_waitcnt lgkmcnt(5)
s_add_u32 s31, s31, s32
ds_read_b64_tr_b16 a[136:137], v25 offset:0
v_mfma_f32_16x16x32_bf16 v[164:167], a[132:135], a[68:71], v[164:167]
v_mfma_f32_16x16x32_bf16 v[172:175], a[128:131], a[72:75], v[172:175]
ds_read_b64_tr_b16 a[138:139], v25 offset:2048
v_mfma_f32_16x16x32_bf16 v[172:175], a[132:135], a[76:79], v[172:175]
ds_read_b128 a[52:55], v3 offset:45056
v_mfma_f32_16x16x32_bf16 v[180:183], a[128:131], a[80:83], v[180:183]
ds_read_b64_tr_b16 a[140:141], v25 offset:16384
v_mfma_f32_16x16x32_bf16 v[180:183], a[132:135], a[84:87], v[180:183]
v_mfma_f32_16x16x32_bf16 v[188:191], a[128:131], a[88:91], v[188:191]
ds_read_b64_tr_b16 a[142:143], v25 offset:18432
v_add_u32 v25, 32768, v25
v_mfma_f32_16x16x32_bf16 v[188:191], a[132:135], a[92:95], v[188:191]
v_mfma_f32_16x16x32_bf16 v[196:199], a[128:131], a[96:99], v[196:199]
ds_read_b128 a[56:59], v2 offset:47104
v_mfma_f32_16x16x32_bf16 v[196:199], a[132:135], a[100:103], v[196:199]
v_mfma_f32_16x16x32_bf16 v[204:207], a[128:131], a[104:107], v[204:207]
ds_read_b128 a[60:63], v3 offset:47104
v_mfma_f32_16x16x32_bf16 v[204:207], a[132:135], a[108:111], v[204:207]
v_mfma_f32_16x16x32_bf16 v[212:215], a[128:131], a[112:115], v[212:215]
v_mfma_f32_16x16x32_bf16 v[212:215], a[132:135], a[116:119], v[212:215]
buffer_store_dwordx4 v[136:139], v1, s[4:7], s31 offen sc1
v_mfma_f32_16x16x32_bf16 v[220:223], a[128:131], a[120:123], v[220:223]
s_add_u32 s31, s31, s33
v_mfma_f32_16x16x32_bf16 v[220:223], a[132:135], a[124:127], v[220:223]
s_waitcnt vmcnt(24) lgkmcnt(0)
s_barrier
v_mfma_f32_16x16x32_bf16 v[228:231], a[136:139], a[64:67], v[228:231]
s_add_u32 m0, s29, 65536
ds_read_b64_tr_b16 a[128:129], v22 offset:0
v_mfma_f32_16x16x32_bf16 v[228:231], a[140:143], a[68:71], v[228:231]
buffer_load_dwordx4 v16, s[12:15], s26 offen offset:0 lds
v_mfma_f32_16x16x32_bf16 v[236:239], a[136:139], a[72:75], v[236:239]
ds_read_b64_tr_b16 a[130:131], v22 offset:2048
v_mfma_f32_16x16x32_bf16 v[236:239], a[140:143], a[76:79], v[236:239]
v_mfma_f32_16x16x32_bf16 v[244:247], a[136:139], a[80:83], v[244:247]
ds_read_b64_tr_b16 a[132:133], v22 offset:16384
v_mfma_f32_16x16x32_bf16 v[244:247], a[140:143], a[84:87], v[244:247]
buffer_load_dwordx4 v17, s[12:15], s26 offen offset:1024 lds
v_mfma_f32_16x16x32_bf16 v[252:255], a[136:139], a[88:91], v[252:255]
ds_read_b64_tr_b16 a[134:135], v22 offset:18432
v_add_u32 v22, 32768, v22
v_mfma_f32_16x16x32_bf16 v[252:255], a[140:143], a[92:95], v[252:255]
v_mfma_f32_16x16x32_bf16 a[160:163], a[136:139], a[96:99], a[160:163]
v_mfma_f32_16x16x32_bf16 a[160:163], a[140:143], a[100:103], a[160:163]
buffer_load_dwordx4 v18, s[12:15], s26 offen offset:2048 lds
v_mfma_f32_16x16x32_bf16 a[164:167], a[136:139], a[104:107], a[164:167]
v_mfma_f32_16x16x32_bf16 a[164:167], a[140:143], a[108:111], a[164:167]
v_mfma_f32_16x16x32_bf16 a[168:171], a[136:139], a[112:115], a[168:171]
v_mfma_f32_16x16x32_bf16 a[168:171], a[140:143], a[116:119], a[168:171]
buffer_load_dwordx4 v19, s[12:15], s26 offen offset:3072 lds
v_mfma_f32_16x16x32_bf16 a[172:175], a[136:139], a[120:123], a[172:175]
s_add_u32 s26, s26, 524288
v_mfma_f32_16x16x32_bf16 a[172:175], a[140:143], a[124:127], a[172:175]
s_waitcnt lgkmcnt(2)
v_mfma_f32_16x16x32_bf16 v[36:39], a[128:131], a[0:3], v[36:39]
s_waitcnt lgkmcnt(0)
s_add_u32 m0, s29, 81920
ds_read_b64_tr_b16 a[136:137], v23 offset:0
v_mfma_f32_16x16x32_bf16 v[36:39], a[132:135], a[4:7], v[36:39]
buffer_load_dwordx4 v16, s[12:15], s27 offen offset:0 lds
v_mfma_f32_16x16x32_bf16 v[44:47], a[128:131], a[8:11], v[44:47]
ds_read_b64_tr_b16 a[138:139], v23 offset:2048
v_mfma_f32_16x16x32_bf16 v[44:47], a[132:135], a[12:15], v[44:47]
ds_read_b128 a[64:67], v2 offset:49152
ds_read_b128 a[68:71], v3 offset:49152
v_mfma_f32_16x16x32_bf16 v[52:55], a[128:131], a[16:19], v[52:55]
ds_read_b64_tr_b16 a[140:141], v23 offset:16384
v_mfma_f32_16x16x32_bf16 v[52:55], a[132:135], a[20:23], v[52:55]
buffer_load_dwordx4 v17, s[12:15], s27 offen offset:1024 lds
v_mfma_f32_16x16x32_bf16 v[60:63], a[128:131], a[24:27], v[60:63]
ds_read_b64_tr_b16 a[142:143], v23 offset:18432
v_add_u32 v23, 32768, v23
v_mfma_f32_16x16x32_bf16 v[60:63], a[132:135], a[28:31], v[60:63]
buffer_store_dwordx4 v[144:147], v1, s[4:7], s31 offen sc1
v_mfma_f32_16x16x32_bf16 v[68:71], a[128:131], a[32:35], v[68:71]
s_add_u32 s31, s31, s32
ds_read_b128 a[72:75], v2 offset:51200
v_mfma_f32_16x16x32_bf16 v[68:71], a[132:135], a[36:39], v[68:71]
buffer_load_dwordx4 v18, s[12:15], s27 offen offset:2048 lds
v_mfma_f32_16x16x32_bf16 v[76:79], a[128:131], a[40:43], v[76:79]
ds_read_b128 a[76:79], v3 offset:51200
v_mfma_f32_16x16x32_bf16 v[76:79], a[132:135], a[44:47], v[76:79]
ds_read_b128 a[80:83], v2 offset:53248
v_mfma_f32_16x16x32_bf16 v[84:87], a[128:131], a[48:51], v[84:87]
ds_read_b128 a[84:87], v3 offset:53248
v_mfma_f32_16x16x32_bf16 v[84:87], a[132:135], a[52:55], v[84:87]
buffer_load_dwordx4 v19, s[12:15], s27 offen offset:3072 lds
v_mfma_f32_16x16x32_bf16 v[92:95], a[128:131], a[56:59], v[92:95]
s_add_u32 s27, s27, 524288
ds_read_b128 a[88:91], v2 offset:55296
v_mfma_f32_16x16x32_bf16 v[92:95], a[132:135], a[60:63], v[92:95]
s_waitcnt lgkmcnt(9)
buffer_store_dwordx4 v[152:155], v1, s[4:7], s31 offen sc1
v_mfma_f32_16x16x32_bf16 v[100:103], a[136:139], a[0:3], v[100:103]
s_waitcnt lgkmcnt(5)
s_add_u32 m0, s28, 32768
ds_read_b64_tr_b16 a[128:129], v24 offset:0
v_mfma_f32_16x16x32_bf16 v[100:103], a[140:143], a[4:7], v[100:103]
s_add_u32 s31, s31, s36
buffer_load_dwordx4 v12, s[8:11], s24 offen offset:0 lds
v_mfma_f32_16x16x32_bf16 v[108:111], a[136:139], a[8:11], v[108:111]
ds_read_b64_tr_b16 a[130:131], v24 offset:2048
v_mfma_f32_16x16x32_bf16 v[108:111], a[140:143], a[12:15], v[108:111]
ds_read_b128 a[92:95], v3 offset:55296
v_mfma_f32_16x16x32_bf16 v[116:119], a[136:139], a[16:19], v[116:119]
ds_read_b64_tr_b16 a[132:133], v24 offset:16384
v_mfma_f32_16x16x32_bf16 v[116:119], a[140:143], a[20:23], v[116:119]
buffer_load_dwordx4 v13, s[8:11], s24 offen offset:1024 lds
v_mfma_f32_16x16x32_bf16 v[124:127], a[136:139], a[24:27], v[124:127]
ds_read_b64_tr_b16 a[134:135], v24 offset:18432
v_add_u32 v24, 32768, v24
v_mfma_f32_16x16x32_bf16 v[124:127], a[140:143], a[28:31], v[124:127]
v_mfma_f32_16x16x32_bf16 v[132:135], a[136:139], a[32:35], v[132:135]
ds_read_b128 a[96:99], v2 offset:57344
v_mfma_f32_16x16x32_bf16 v[132:135], a[140:143], a[36:39], v[132:135]
buffer_load_dwordx4 v14, s[8:11], s24 offen offset:2048 lds
v_mfma_f32_16x16x32_bf16 v[140:143], a[136:139], a[40:43], v[140:143]
ds_read_b128 a[100:103], v3 offset:57344
v_mfma_f32_16x16x32_bf16 v[140:143], a[140:143], a[44:47], v[140:143]
ds_read_b128 a[104:107], v2 offset:59392
v_mfma_f32_16x16x32_bf16 v[148:151], a[136:139], a[48:51], v[148:151]
ds_read_b128 a[108:111], v3 offset:59392
v_mfma_f32_16x16x32_bf16 v[148:151], a[140:143], a[52:55], v[148:151]
buffer_load_dwordx4 v15, s[8:11], s24 offen offset:3072 lds
v_mfma_f32_16x16x32_bf16 v[156:159], a[136:139], a[56:59], v[156:159]
s_add_u32 s24, s24, 128
ds_read_b128 a[112:115], v2 offset:61440
v_mfma_f32_16x16x32_bf16 v[156:159], a[140:143], a[60:63], v[156:159]
s_waitcnt lgkmcnt(8)
buffer_store_dwordx4 v[160:163], v1, s[4:7], s31 offen sc1
v_mfma_f32_16x16x32_bf16 v[164:167], a[128:131], a[0:3], v[164:167]
s_waitcnt lgkmcnt(5)
s_add_u32 s31, s31, s32
ds_read_b64_tr_b16 a[136:137], v25 offset:0
v_mfma_f32_16x16x32_bf16 v[164:167], a[132:135], a[4:7], v[164:167]
v_mfma_f32_16x16x32_bf16 v[172:175], a[128:131], a[8:11], v[172:175]
ds_read_b64_tr_b16 a[138:139], v25 offset:2048
v_mfma_f32_16x16x32_bf16 v[172:175], a[132:135], a[12:15], v[172:175]
ds_read_b128 a[116:119], v3 offset:61440
v_mfma_f32_16x16x32_bf16 v[180:183], a[128:131], a[16:19], v[180:183]
ds_read_b64_tr_b16 a[140:141], v25 offset:16384
v_mfma_f32_16x16x32_bf16 v[180:183], a[132:135], a[20:23], v[180:183]
v_mfma_f32_16x16x32_bf16 v[188:191], a[128:131], a[24:27], v[188:191]
ds_read_b64_tr_b16 a[142:143], v25 offset:18432
v_add_u32 v25, 32768, v25
v_mfma_f32_16x16x32_bf16 v[188:191], a[132:135], a[28:31], v[188:191]
v_mfma_f32_16x16x32_bf16 v[196:199], a[128:131], a[32:35], v[196:199]
ds_read_b128 a[120:123], v2 offset:63488
v_mfma_f32_16x16x32_bf16 v[196:199], a[132:135], a[36:39], v[196:199]
v_mfma_f32_16x16x32_bf16 v[204:207], a[128:131], a[40:43], v[204:207]
ds_read_b128 a[124:127], v3 offset:63488
v_mfma_f32_16x16x32_bf16 v[204:207], a[132:135], a[44:47], v[204:207]
v_mfma_f32_16x16x32_bf16 v[212:215], a[128:131], a[48:51], v[212:215]
v_mfma_f32_16x16x32_bf16 v[212:215], a[132:135], a[52:55], v[212:215]
buffer_store_dwordx4 v[168:171], v1, s[4:7], s31 offen sc1
v_mfma_f32_16x16x32_bf16 v[220:223], a[128:131], a[56:59], v[220:223]
s_add_u32 s31, s31, s33
v_mfma_f32_16x16x32_bf16 v[220:223], a[132:135], a[60:63], v[220:223]
s_waitcnt vmcnt(23) lgkmcnt(0)
s_barrier
v_mfma_f32_16x16x32_bf16 v[228:231], a[136:139], a[0:3], v[228:231]
s_add_u32 m0, s29, 98304
ds_read_b64_tr_b16 a[128:129], v22 offset:0
v_mfma_f32_16x16x32_bf16 v[228:231], a[140:143], a[4:7], v[228:231]
buffer_load_dwordx4 v16, s[12:15], s26 offen offset:0 lds
v_mfma_f32_16x16x32_bf16 v[236:239], a[136:139], a[8:11], v[236:239]
ds_read_b64_tr_b16 a[130:131], v22 offset:2048
v_mfma_f32_16x16x32_bf16 v[236:239], a[140:143], a[12:15], v[236:239]
v_mfma_f32_16x16x32_bf16 v[244:247], a[136:139], a[16:19], v[244:247]
ds_read_b64_tr_b16 a[132:133], v22 offset:16384
v_mfma_f32_16x16x32_bf16 v[244:247], a[140:143], a[20:23], v[244:247]
buffer_load_dwordx4 v17, s[12:15], s26 offen offset:1024 lds
v_mfma_f32_16x16x32_bf16 v[252:255], a[136:139], a[24:27], v[252:255]
ds_read_b64_tr_b16 a[134:135], v22 offset:18432
v_add_u32 v22, 4294901760, v22
v_mfma_f32_16x16x32_bf16 v[252:255], a[140:143], a[28:31], v[252:255]
v_mfma_f32_16x16x32_bf16 a[160:163], a[136:139], a[32:35], a[160:163]
v_mfma_f32_16x16x32_bf16 a[160:163], a[140:143], a[36:39], a[160:163]
buffer_load_dwordx4 v18, s[12:15], s26 offen offset:2048 lds
v_mfma_f32_16x16x32_bf16 a[164:167], a[136:139], a[40:43], a[164:167]
v_mfma_f32_16x16x32_bf16 a[164:167], a[140:143], a[44:47], a[164:167]
v_mfma_f32_16x16x32_bf16 a[168:171], a[136:139], a[48:51], a[168:171]
v_mfma_f32_16x16x32_bf16 a[168:171], a[140:143], a[52:55], a[168:171]
buffer_load_dwordx4 v19, s[12:15], s26 offen offset:3072 lds
v_mfma_f32_16x16x32_bf16 a[172:175], a[136:139], a[56:59], a[172:175]
s_add_u32 s26, s26, 524288
v_mfma_f32_16x16x32_bf16 a[172:175], a[140:143], a[60:63], a[172:175]
s_waitcnt lgkmcnt(2)
v_mfma_f32_16x16x32_bf16 v[36:39], a[128:131], a[64:67], v[36:39]
s_waitcnt lgkmcnt(0)
s_add_u32 m0, s29, 114688
ds_read_b64_tr_b16 a[136:137], v23 offset:0
v_mfma_f32_16x16x32_bf16 v[36:39], a[132:135], a[68:71], v[36:39]
buffer_load_dwordx4 v16, s[12:15], s27 offen offset:0 lds
v_mfma_f32_16x16x32_bf16 v[44:47], a[128:131], a[72:75], v[44:47]
ds_read_b64_tr_b16 a[138:139], v23 offset:2048
v_mfma_f32_16x16x32_bf16 v[44:47], a[132:135], a[76:79], v[44:47]
ds_read_b128 a[0:3], v2 offset:0
ds_read_b128 a[4:7], v3 offset:0
v_mfma_f32_16x16x32_bf16 v[52:55], a[128:131], a[80:83], v[52:55]
ds_read_b64_tr_b16 a[140:141], v23 offset:16384
v_mfma_f32_16x16x32_bf16 v[52:55], a[132:135], a[84:87], v[52:55]
buffer_load_dwordx4 v17, s[12:15], s27 offen offset:1024 lds
v_mfma_f32_16x16x32_bf16 v[60:63], a[128:131], a[88:91], v[60:63]
ds_read_b64_tr_b16 a[142:143], v23 offset:18432
v_add_u32 v23, 4294901760, v23
v_mfma_f32_16x16x32_bf16 v[60:63], a[132:135], a[92:95], v[60:63]
buffer_store_dwordx4 v[176:179], v1, s[4:7], s31 offen sc1
v_mfma_f32_16x16x32_bf16 v[68:71], a[128:131], a[96:99], v[68:71]
s_add_u32 s31, s31, s32
ds_read_b128 a[8:11], v2 offset:2048
v_mfma_f32_16x16x32_bf16 v[68:71], a[132:135], a[100:103], v[68:71]
buffer_load_dwordx4 v18, s[12:15], s27 offen offset:2048 lds
v_mfma_f32_16x16x32_bf16 v[76:79], a[128:131], a[104:107], v[76:79]
ds_read_b128 a[12:15], v3 offset:2048
v_mfma_f32_16x16x32_bf16 v[76:79], a[132:135], a[108:111], v[76:79]
ds_read_b128 a[16:19], v2 offset:4096
v_mfma_f32_16x16x32_bf16 v[84:87], a[128:131], a[112:115], v[84:87]
ds_read_b128 a[20:23], v3 offset:4096
v_mfma_f32_16x16x32_bf16 v[84:87], a[132:135], a[116:119], v[84:87]
buffer_load_dwordx4 v19, s[12:15], s27 offen offset:3072 lds
v_mfma_f32_16x16x32_bf16 v[92:95], a[128:131], a[120:123], v[92:95]
s_add_u32 s27, s27, 524288
ds_read_b128 a[24:27], v2 offset:6144
v_mfma_f32_16x16x32_bf16 v[92:95], a[132:135], a[124:127], v[92:95]
s_waitcnt lgkmcnt(9)
buffer_store_dwordx4 v[184:187], v1, s[4:7], s31 offen sc1
v_mfma_f32_16x16x32_bf16 v[100:103], a[136:139], a[64:67], v[100:103]
s_waitcnt lgkmcnt(5)
s_add_u32 s31, s31, s34
ds_read_b64_tr_b16 a[128:129], v24 offset:0
v_mfma_f32_16x16x32_bf16 v[100:103], a[140:143], a[68:71], v[100:103]
v_mfma_f32_16x16x32_bf16 v[108:111], a[136:139], a[72:75], v[108:111]
ds_read_b64_tr_b16 a[130:131], v24 offset:2048
v_mfma_f32_16x16x32_bf16 v[108:111], a[140:143], a[76:79], v[108:111]
ds_read_b128 a[28:31], v3 offset:6144
v_mfma_f32_16x16x32_bf16 v[116:119], a[136:139], a[80:83], v[116:119]
ds_read_b64_tr_b16 a[132:133], v24 offset:16384
v_mfma_f32_16x16x32_bf16 v[116:119], a[140:143], a[84:87], v[116:119]
v_mfma_f32_16x16x32_bf16 v[124:127], a[136:139], a[88:91], v[124:127]
ds_read_b64_tr_b16 a[134:135], v24 offset:18432
v_add_u32 v24, 4294901760, v24
v_mfma_f32_16x16x32_bf16 v[124:127], a[140:143], a[92:95], v[124:127]
v_mfma_f32_16x16x32_bf16 v[132:135], a[136:139], a[96:99], v[132:135]
ds_read_b128 a[32:35], v2 offset:8192
v_mfma_f32_16x16x32_bf16 v[132:135], a[140:143], a[100:103], v[132:135]
v_mfma_f32_16x16x32_bf16 v[140:143], a[136:139], a[104:107], v[140:143]
ds_read_b128 a[36:39], v3 offset:8192
v_mfma_f32_16x16x32_bf16 v[140:143], a[140:143], a[108:111], v[140:143]
ds_read_b128 a[40:43], v2 offset:10240
v_mfma_f32_16x16x32_bf16 v[148:151], a[136:139], a[112:115], v[148:151]
ds_read_b128 a[44:47], v3 offset:10240
v_mfma_f32_16x16x32_bf16 v[148:151], a[140:143], a[116:119], v[148:151]
v_mfma_f32_16x16x32_bf16 v[156:159], a[136:139], a[120:123], v[156:159]
ds_read_b128 a[48:51], v2 offset:12288
v_mfma_f32_16x16x32_bf16 v[156:159], a[140:143], a[124:127], v[156:159]
s_waitcnt lgkmcnt(8)
buffer_store_dwordx4 v[192:195], v1, s[4:7], s31 offen sc1
v_mfma_f32_16x16x32_bf16 v[164:167], a[128:131], a[64:67], v[164:167]
s_waitcnt lgkmcnt(5)
s_add_u32 s31, s31, s32
ds_read_b64_tr_b16 a[136:137], v25 offset:0
v_mfma_f32_16x16x32_bf16 v[164:167], a[132:135], a[68:71], v[164:167]
v_mfma_f32_16x16x32_bf16 v[172:175], a[128:131], a[72:75], v[172:175]
ds_read_b64_tr_b16 a[138:139], v25 offset:2048
v_mfma_f32_16x16x32_bf16 v[172:175], a[132:135], a[76:79], v[172:175]
ds_read_b128 a[52:55], v3 offset:12288
v_mfma_f32_16x16x32_bf16 v[180:183], a[128:131], a[80:83], v[180:183]
ds_read_b64_tr_b16 a[140:141], v25 offset:16384
v_mfma_f32_16x16x32_bf16 v[180:183], a[132:135], a[84:87], v[180:183]
v_mfma_f32_16x16x32_bf16 v[188:191], a[128:131], a[88:91], v[188:191]
ds_read_b64_tr_b16 a[142:143], v25 offset:18432
v_add_u32 v25, 4294901760, v25
v_mfma_f32_16x16x32_bf16 v[188:191], a[132:135], a[92:95], v[188:191]
v_mfma_f32_16x16x32_bf16 v[196:199], a[128:131], a[96:99], v[196:199]
ds_read_b128 a[56:59], v2 offset:14336
v_mfma_f32_16x16x32_bf16 v[196:199], a[132:135], a[100:103], v[196:199]
v_mfma_f32_16x16x32_bf16 v[204:207], a[128:131], a[104:107], v[204:207]
ds_read_b128 a[60:63], v3 offset:14336
v_mfma_f32_16x16x32_bf16 v[204:207], a[132:135], a[108:111], v[204:207]
v_mfma_f32_16x16x32_bf16 v[212:215], a[128:131], a[112:115], v[212:215]
v_mfma_f32_16x16x32_bf16 v[212:215], a[132:135], a[116:119], v[212:215]
buffer_store_dwordx4 v[200:203], v1, s[4:7], s31 offen sc1
v_mfma_f32_16x16x32_bf16 v[220:223], a[128:131], a[120:123], v[220:223]
s_add_u32 s31, s31, s33
v_mfma_f32_16x16x32_bf16 v[220:223], a[132:135], a[124:127], v[220:223]
s_waitcnt vmcnt(19) lgkmcnt(0)
s_barrier
v_mfma_f32_16x16x32_bf16 v[228:231], a[136:139], a[64:67], v[228:231]
s_add_u32 m0, s29, 131072
ds_read_b64_tr_b16 a[128:129], v22 offset:0
v_mfma_f32_16x16x32_bf16 v[228:231], a[140:143], a[68:71], v[228:231]
buffer_load_dwordx4 v16, s[12:15], s26 offen offset:0 lds
v_mfma_f32_16x16x32_bf16 v[236:239], a[136:139], a[72:75], v[236:239]
ds_read_b64_tr_b16 a[130:131], v22 offset:2048
v_mfma_f32_16x16x32_bf16 v[236:239], a[140:143], a[76:79], v[236:239]
v_mfma_f32_16x16x32_bf16 v[244:247], a[136:139], a[80:83], v[244:247]
ds_read_b64_tr_b16 a[132:133], v22 offset:16384
v_mfma_f32_16x16x32_bf16 v[244:247], a[140:143], a[84:87], v[244:247]
buffer_load_dwordx4 v17, s[12:15], s26 offen offset:1024 lds
v_mfma_f32_16x16x32_bf16 v[252:255], a[136:139], a[88:91], v[252:255]
ds_read_b64_tr_b16 a[134:135], v22 offset:18432
v_add_u32 v22, 32768, v22
v_mfma_f32_16x16x32_bf16 v[252:255], a[140:143], a[92:95], v[252:255]
v_mfma_f32_16x16x32_bf16 a[160:163], a[136:139], a[96:99], a[160:163]
v_mfma_f32_16x16x32_bf16 a[160:163], a[140:143], a[100:103], a[160:163]
buffer_load_dwordx4 v18, s[12:15], s26 offen offset:2048 lds
v_mfma_f32_16x16x32_bf16 a[164:167], a[136:139], a[104:107], a[164:167]
v_mfma_f32_16x16x32_bf16 a[164:167], a[140:143], a[108:111], a[164:167]
v_mfma_f32_16x16x32_bf16 a[168:171], a[136:139], a[112:115], a[168:171]
v_mfma_f32_16x16x32_bf16 a[168:171], a[140:143], a[116:119], a[168:171]
buffer_load_dwordx4 v19, s[12:15], s26 offen offset:3072 lds
v_mfma_f32_16x16x32_bf16 a[172:175], a[136:139], a[120:123], a[172:175]
s_add_u32 s26, s26, 524288
v_mfma_f32_16x16x32_bf16 a[172:175], a[140:143], a[124:127], a[172:175]
s_waitcnt lgkmcnt(2)
buffer_load_dword v21, v20, s[60:63], 0 offen sc1
v_mfma_f32_16x16x32_bf16 v[36:39], a[128:131], a[0:3], v[36:39]
s_waitcnt lgkmcnt(0)
s_add_u32 m0, s29, 147456
ds_read_b64_tr_b16 a[136:137], v23 offset:0
v_mfma_f32_16x16x32_bf16 v[36:39], a[132:135], a[4:7], v[36:39]
buffer_load_dwordx4 v16, s[12:15], s27 offen offset:0 lds
v_mfma_f32_16x16x32_bf16 v[44:47], a[128:131], a[8:11], v[44:47]
ds_read_b64_tr_b16 a[138:139], v23 offset:2048
v_mfma_f32_16x16x32_bf16 v[44:47], a[132:135], a[12:15], v[44:47]
ds_read_b128 a[64:67], v2 offset:16384
ds_read_b128 a[68:71], v3 offset:16384
v_mfma_f32_16x16x32_bf16 v[52:55], a[128:131], a[16:19], v[52:55]
ds_read_b64_tr_b16 a[140:141], v23 offset:16384
v_mfma_f32_16x16x32_bf16 v[52:55], a[132:135], a[20:23], v[52:55]
buffer_load_dwordx4 v17, s[12:15], s27 offen offset:1024 lds
v_mfma_f32_16x16x32_bf16 v[60:63], a[128:131], a[24:27], v[60:63]
ds_read_b64_tr_b16 a[142:143], v23 offset:18432
v_add_u32 v23, 32768, v23
v_mfma_f32_16x16x32_bf16 v[60:63], a[132:135], a[28:31], v[60:63]
buffer_store_dwordx4 v[208:211], v1, s[4:7], s31 offen sc1
v_mfma_f32_16x16x32_bf16 v[68:71], a[128:131], a[32:35], v[68:71]
s_add_u32 s31, s31, s32
ds_read_b128 a[72:75], v2 offset:18432
v_mfma_f32_16x16x32_bf16 v[68:71], a[132:135], a[36:39], v[68:71]
buffer_load_dwordx4 v18, s[12:15], s27 offen offset:2048 lds
v_mfma_f32_16x16x32_bf16 v[76:79], a[128:131], a[40:43], v[76:79]
ds_read_b128 a[76:79], v3 offset:18432
v_mfma_f32_16x16x32_bf16 v[76:79], a[132:135], a[44:47], v[76:79]
ds_read_b128 a[80:83], v2 offset:20480
v_mfma_f32_16x16x32_bf16 v[84:87], a[128:131], a[48:51], v[84:87]
ds_read_b128 a[84:87], v3 offset:20480
v_mfma_f32_16x16x32_bf16 v[84:87], a[132:135], a[52:55], v[84:87]
buffer_load_dwordx4 v19, s[12:15], s27 offen offset:3072 lds
v_mfma_f32_16x16x32_bf16 v[92:95], a[128:131], a[56:59], v[92:95]
s_add_u32 s27, s27, 524288
ds_read_b128 a[88:91], v2 offset:22528
v_mfma_f32_16x16x32_bf16 v[92:95], a[132:135], a[60:63], v[92:95]
s_waitcnt lgkmcnt(9)
buffer_store_dwordx4 v[216:219], v1, s[4:7], s31 offen sc1
v_mfma_f32_16x16x32_bf16 v[100:103], a[136:139], a[0:3], v[100:103]
s_waitcnt lgkmcnt(5)
s_add_u32 s31, s31, s35
ds_read_b64_tr_b16 a[128:129], v24 offset:0
v_mfma_f32_16x16x32_bf16 v[100:103], a[140:143], a[4:7], v[100:103]
v_mfma_f32_16x16x32_bf16 v[108:111], a[136:139], a[8:11], v[108:111]
ds_read_b64_tr_b16 a[130:131], v24 offset:2048
v_mfma_f32_16x16x32_bf16 v[108:111], a[140:143], a[12:15], v[108:111]
ds_read_b128 a[92:95], v3 offset:22528
v_mfma_f32_16x16x32_bf16 v[116:119], a[136:139], a[16:19], v[116:119]
ds_read_b64_tr_b16 a[132:133], v24 offset:16384
v_mfma_f32_16x16x32_bf16 v[116:119], a[140:143], a[20:23], v[116:119]
v_mfma_f32_16x16x32_bf16 v[124:127], a[136:139], a[24:27], v[124:127]
ds_read_b64_tr_b16 a[134:135], v24 offset:18432
v_add_u32 v24, 32768, v24
v_mfma_f32_16x16x32_bf16 v[124:127], a[140:143], a[28:31], v[124:127]
v_mfma_f32_16x16x32_bf16 v[132:135], a[136:139], a[32:35], v[132:135]
ds_read_b128 a[96:99], v2 offset:24576
v_mfma_f32_16x16x32_bf16 v[132:135], a[140:143], a[36:39], v[132:135]
buffer_store_dwordx4 v[224:227], v1, s[4:7], s31 offen sc1
v_mfma_f32_16x16x32_bf16 v[140:143], a[136:139], a[40:43], v[140:143]
s_add_u32 s31, s31, s32
ds_read_b128 a[100:103], v3 offset:24576
v_mfma_f32_16x16x32_bf16 v[140:143], a[140:143], a[44:47], v[140:143]
ds_read_b128 a[104:107], v2 offset:26624
v_mfma_f32_16x16x32_bf16 v[148:151], a[136:139], a[48:51], v[148:151]
ds_read_b128 a[108:111], v3 offset:26624
v_mfma_f32_16x16x32_bf16 v[148:151], a[140:143], a[52:55], v[148:151]
v_mfma_f32_16x16x32_bf16 v[156:159], a[136:139], a[56:59], v[156:159]
ds_read_b128 a[112:115], v2 offset:28672
v_mfma_f32_16x16x32_bf16 v[156:159], a[140:143], a[60:63], v[156:159]
s_waitcnt lgkmcnt(8)
v_mfma_f32_16x16x32_bf16 v[164:167], a[128:131], a[0:3], v[164:167]
s_waitcnt lgkmcnt(5)
ds_read_b64_tr_b16 a[136:137], v25 offset:0
v_mfma_f32_16x16x32_bf16 v[164:167], a[132:135], a[4:7], v[164:167]
v_mfma_f32_16x16x32_bf16 v[172:175], a[128:131], a[8:11], v[172:175]
ds_read_b64_tr_b16 a[138:139], v25 offset:2048
v_mfma_f32_16x16x32_bf16 v[172:175], a[132:135], a[12:15], v[172:175]
ds_read_b128 a[116:119], v3 offset:28672
v_mfma_f32_16x16x32_bf16 v[180:183], a[128:131], a[16:19], v[180:183]
ds_read_b64_tr_b16 a[140:141], v25 offset:16384
v_mfma_f32_16x16x32_bf16 v[180:183], a[132:135], a[20:23], v[180:183]
buffer_store_dwordx4 v[232:235], v1, s[4:7], s31 offen sc1
v_mfma_f32_16x16x32_bf16 v[188:191], a[128:131], a[24:27], v[188:191]
s_add_u32 s31, s31, s33
ds_read_b64_tr_b16 a[142:143], v25 offset:18432
v_add_u32 v25, 32768, v25
v_mfma_f32_16x16x32_bf16 v[188:191], a[132:135], a[28:31], v[188:191]
v_mfma_f32_16x16x32_bf16 v[196:199], a[128:131], a[32:35], v[196:199]
ds_read_b128 a[120:123], v2 offset:30720
v_mfma_f32_16x16x32_bf16 v[196:199], a[132:135], a[36:39], v[196:199]
v_mfma_f32_16x16x32_bf16 v[204:207], a[128:131], a[40:43], v[204:207]
ds_read_b128 a[124:127], v3 offset:30720
v_mfma_f32_16x16x32_bf16 v[204:207], a[132:135], a[44:47], v[204:207]
v_mfma_f32_16x16x32_bf16 v[212:215], a[128:131], a[48:51], v[212:215]
v_mfma_f32_16x16x32_bf16 v[212:215], a[132:135], a[52:55], v[212:215]
v_mfma_f32_16x16x32_bf16 v[220:223], a[128:131], a[56:59], v[220:223]
v_mfma_f32_16x16x32_bf16 v[220:223], a[132:135], a[60:63], v[220:223]
s_waitcnt vmcnt(16) lgkmcnt(0)
s_barrier
v_mfma_f32_16x16x32_bf16 v[228:231], a[136:139], a[0:3], v[228:231]
ds_read_b64_tr_b16 a[128:129], v22 offset:0
v_mfma_f32_16x16x32_bf16 v[228:231], a[140:143], a[4:7], v[228:231]
buffer_store_dwordx4 v[240:243], v1, s[4:7], s31 offen sc1
v_mfma_f32_16x16x32_bf16 v[236:239], a[136:139], a[8:11], v[236:239]
s_add_u32 s31, s31, s32
ds_read_b64_tr_b16 a[130:131], v22 offset:2048
v_mfma_f32_16x16x32_bf16 v[236:239], a[140:143], a[12:15], v[236:239]
v_mfma_f32_16x16x32_bf16 v[244:247], a[136:139], a[16:19], v[244:247]
ds_read_b64_tr_b16 a[132:133], v22 offset:16384
v_mfma_f32_16x16x32_bf16 v[244:247], a[140:143], a[20:23], v[244:247]
v_mfma_f32_16x16x32_bf16 v[252:255], a[136:139], a[24:27], v[252:255]
ds_read_b64_tr_b16 a[134:135], v22 offset:18432
v_add_u32 v22, 32768, v22
v_mfma_f32_16x16x32_bf16 v[252:255], a[140:143], a[28:31], v[252:255]
v_mfma_f32_16x16x32_bf16 a[160:163], a[136:139], a[32:35], a[160:163]
v_mfma_f32_16x16x32_bf16 a[160:163], a[140:143], a[36:39], a[160:163]
v_mfma_f32_16x16x32_bf16 a[164:167], a[136:139], a[40:43], a[164:167]
v_mfma_f32_16x16x32_bf16 a[164:167], a[140:143], a[44:47], a[164:167]
v_mfma_f32_16x16x32_bf16 a[168:171], a[136:139], a[48:51], a[168:171]
v_mfma_f32_16x16x32_bf16 a[168:171], a[140:143], a[52:55], a[168:171]
v_mfma_f32_16x16x32_bf16 a[172:175], a[136:139], a[56:59], a[172:175]
v_mfma_f32_16x16x32_bf16 a[172:175], a[140:143], a[60:63], a[172:175]
s_waitcnt lgkmcnt(2)
v_mfma_f32_16x16x32_bf16 v[36:39], a[128:131], a[64:67], v[36:39]
s_waitcnt lgkmcnt(0)
ds_read_b64_tr_b16 a[136:137], v23 offset:0
v_mfma_f32_16x16x32_bf16 v[36:39], a[132:135], a[68:71], v[36:39]
buffer_store_dwordx4 v[248:251], v1, s[4:7], s31 offen sc1
v_mfma_f32_16x16x32_bf16 v[44:47], a[128:131], a[72:75], v[44:47]
s_add_u32 s31, s31, s34
ds_read_b64_tr_b16 a[138:139], v23 offset:2048
v_mfma_f32_16x16x32_bf16 v[44:47], a[132:135], a[76:79], v[44:47]
ds_read_b128 a[0:3], v2 offset:32768
ds_read_b128 a[4:7], v3 offset:32768
v_mfma_f32_16x16x32_bf16 v[52:55], a[128:131], a[80:83], v[52:55]
ds_read_b64_tr_b16 a[140:141], v23 offset:16384
v_mfma_f32_16x16x32_bf16 v[52:55], a[132:135], a[84:87], v[52:55]
v_mfma_f32_16x16x32_bf16 v[60:63], a[128:131], a[88:91], v[60:63]
ds_read_b64_tr_b16 a[142:143], v23 offset:18432
v_add_u32 v23, 32768, v23
v_mfma_f32_16x16x32_bf16 v[60:63], a[132:135], a[92:95], v[60:63]
v_mfma_f32_16x16x32_bf16 v[68:71], a[128:131], a[96:99], v[68:71]
ds_read_b128 a[8:11], v2 offset:34816
v_mfma_f32_16x16x32_bf16 v[68:71], a[132:135], a[100:103], v[68:71]
v_mfma_f32_16x16x32_bf16 v[76:79], a[128:131], a[104:107], v[76:79]
ds_read_b128 a[12:15], v3 offset:34816
v_mfma_f32_16x16x32_bf16 v[76:79], a[132:135], a[108:111], v[76:79]
ds_read_b128 a[16:19], v2 offset:36864
v_mfma_f32_16x16x32_bf16 v[84:87], a[128:131], a[112:115], v[84:87]
ds_read_b128 a[20:23], v3 offset:36864
v_accvgpr_read_b32 v32, a224
v_mfma_f32_16x16x32_bf16 v[84:87], a[132:135], a[116:119], v[84:87]
v_accvgpr_read_b32 v33, a225
v_accvgpr_read_b32 v34, a226
v_mfma_f32_16x16x32_bf16 v[92:95], a[128:131], a[120:123], v[92:95]
ds_read_b128 a[24:27], v2 offset:38912
v_accvgpr_read_b32 v35, a227
v_mfma_f32_16x16x32_bf16 v[92:95], a[132:135], a[124:127], v[92:95]
s_waitcnt lgkmcnt(9)
v_accvgpr_read_b32 v40, a228
v_accvgpr_read_b32 v41, a229
v_mfma_f32_16x16x32_bf16 v[100:103], a[136:139], a[64:67], v[100:103]
s_waitcnt lgkmcnt(5)
ds_read_b64_tr_b16 a[128:129], v24 offset:0
v_accvgpr_read_b32 v42, a230
v_mfma_f32_16x16x32_bf16 v[100:103], a[140:143], a[68:71], v[100:103]
v_accvgpr_read_b32 v43, a231
v_cvt_pk_bf16_f32 v32, v32, v33
v_mfma_f32_16x16x32_bf16 v[108:111], a[136:139], a[72:75], v[108:111]
ds_read_b64_tr_b16 a[130:131], v24 offset:2048
v_cvt_pk_bf16_f32 v33, v34, v35
v_mfma_f32_16x16x32_bf16 v[108:111], a[140:143], a[76:79], v[108:111]
ds_read_b128 a[28:31], v3 offset:38912
v_cvt_pk_bf16_f32 v34, v40, v41
v_mfma_f32_16x16x32_bf16 v[116:119], a[136:139], a[80:83], v[116:119]
ds_read_b64_tr_b16 a[132:133], v24 offset:16384
v_cvt_pk_bf16_f32 v35, v42, v43
v_mfma_f32_16x16x32_bf16 v[116:119], a[140:143], a[84:87], v[116:119]
buffer_store_dwordx4 v[32:35], v1, s[4:7], s31 offen sc1
v_mfma_f32_16x16x32_bf16 v[124:127], a[136:139], a[88:91], v[124:127]
s_add_u32 s31, s31, s32
ds_read_b64_tr_b16 a[134:135], v24 offset:18432
v_add_u32 v24, 32768, v24
v_mfma_f32_16x16x32_bf16 v[124:127], a[140:143], a[92:95], v[124:127]
v_mfma_f32_16x16x32_bf16 v[132:135], a[136:139], a[96:99], v[132:135]
ds_read_b128 a[32:35], v2 offset:40960
v_accvgpr_read_b32 v48, a232
v_mfma_f32_16x16x32_bf16 v[132:135], a[140:143], a[100:103], v[132:135]
v_accvgpr_read_b32 v49, a233
v_accvgpr_read_b32 v50, a234
v_mfma_f32_16x16x32_bf16 v[140:143], a[136:139], a[104:107], v[140:143]
ds_read_b128 a[36:39], v3 offset:40960
v_accvgpr_read_b32 v51, a235
v_mfma_f32_16x16x32_bf16 v[140:143], a[140:143], a[108:111], v[140:143]
ds_read_b128 a[40:43], v2 offset:43008
v_accvgpr_read_b32 v56, a236
v_mfma_f32_16x16x32_bf16 v[148:151], a[136:139], a[112:115], v[148:151]
ds_read_b128 a[44:47], v3 offset:43008
v_accvgpr_read_b32 v57, a237
v_mfma_f32_16x16x32_bf16 v[148:151], a[140:143], a[116:119], v[148:151]
v_accvgpr_read_b32 v58, a238
v_accvgpr_read_b32 v59, a239
v_mfma_f32_16x16x32_bf16 v[156:159], a[136:139], a[120:123], v[156:159]
ds_read_b128 a[48:51], v2 offset:45056
v_cvt_pk_bf16_f32 v48, v48, v49
v_mfma_f32_16x16x32_bf16 v[156:159], a[140:143], a[124:127], v[156:159]
s_waitcnt lgkmcnt(8)
v_cvt_pk_bf16_f32 v49, v50, v51
v_cvt_pk_bf16_f32 v50, v56, v57
v_mfma_f32_16x16x32_bf16 v[164:167], a[128:131], a[64:67], v[164:167]
s_waitcnt lgkmcnt(5)
ds_read_b64_tr_b16 a[136:137], v25 offset:0
v_cvt_pk_bf16_f32 v51, v58, v59
v_mfma_f32_16x16x32_bf16 v[164:167], a[132:135], a[68:71], v[164:167]
buffer_store_dwordx4 v[48:51], v1, s[4:7], s31 offen sc1
v_mfma_f32_16x16x32_bf16 v[172:175], a[128:131], a[72:75], v[172:175]
s_add_u32 s31, s31, s33
ds_read_b64_tr_b16 a[138:139], v25 offset:2048
v_mfma_f32_16x16x32_bf16 v[172:175], a[132:135], a[76:79], v[172:175]
ds_read_b128 a[52:55], v3 offset:45056
v_mfma_f32_16x16x32_bf16 v[180:183], a[128:131], a[80:83], v[180:183]
ds_read_b64_tr_b16 a[140:141], v25 offset:16384
v_accvgpr_read_b32 v64, a240
v_mfma_f32_16x16x32_bf16 v[180:183], a[132:135], a[84:87], v[180:183]
v_accvgpr_read_b32 v65, a241
v_accvgpr_read_b32 v66, a242
v_mfma_f32_16x16x32_bf16 v[188:191], a[128:131], a[88:91], v[188:191]
ds_read_b64_tr_b16 a[142:143], v25 offset:18432
v_add_u32 v25, 32768, v25
v_mfma_f32_16x16x32_bf16 v[188:191], a[132:135], a[92:95], v[188:191]
v_accvgpr_read_b32 v67, a243
v_accvgpr_read_b32 v72, a244
v_mfma_f32_16x16x32_bf16 v[196:199], a[128:131], a[96:99], v[196:199]
ds_read_b128 a[56:59], v2 offset:47104
v_accvgpr_read_b32 v73, a245
v_mfma_f32_16x16x32_bf16 v[196:199], a[132:135], a[100:103], v[196:199]
v_accvgpr_read_b32 v74, a246
v_accvgpr_read_b32 v75, a247
v_mfma_f32_16x16x32_bf16 v[204:207], a[128:131], a[104:107], v[204:207]
ds_read_b128 a[60:63], v3 offset:47104
v_cvt_pk_bf16_f32 v64, v64, v65
v_mfma_f32_16x16x32_bf16 v[204:207], a[132:135], a[108:111], v[204:207]
v_cvt_pk_bf16_f32 v65, v66, v67
v_cvt_pk_bf16_f32 v66, v72, v73
v_mfma_f32_16x16x32_bf16 v[212:215], a[128:131], a[112:115], v[212:215]
v_cvt_pk_bf16_f32 v67, v74, v75
v_mfma_f32_16x16x32_bf16 v[212:215], a[132:135], a[116:119], v[212:215]
buffer_store_dwordx4 v[64:67], v1, s[4:7], s31 offen sc1
v_mfma_f32_16x16x32_bf16 v[220:223], a[128:131], a[120:123], v[220:223]
s_add_u32 s31, s31, s32
v_mfma_f32_16x16x32_bf16 v[220:223], a[132:135], a[124:127], v[220:223]
s_waitcnt vmcnt(8) lgkmcnt(0)
s_barrier
v_mfma_f32_16x16x32_bf16 v[228:231], a[136:139], a[64:67], v[228:231]
ds_read_b64_tr_b16 a[128:129], v22 offset:0
v_accvgpr_read_b32 v80, a248
v_mfma_f32_16x16x32_bf16 v[228:231], a[140:143], a[68:71], v[228:231]
v_accvgpr_read_b32 v81, a249
v_accvgpr_read_b32 v82, a250
v_mfma_f32_16x16x32_bf16 v[236:239], a[136:139], a[72:75], v[236:239]
ds_read_b64_tr_b16 a[130:131], v22 offset:2048
v_accvgpr_read_b32 v83, a251
v_mfma_f32_16x16x32_bf16 v[236:239], a[140:143], a[76:79], v[236:239]
v_accvgpr_read_b32 v88, a252
v_accvgpr_read_b32 v89, a253
v_mfma_f32_16x16x32_bf16 v[244:247], a[136:139], a[80:83], v[244:247]
ds_read_b64_tr_b16 a[132:133], v22 offset:16384
v_accvgpr_read_b32 v90, a254
v_mfma_f32_16x16x32_bf16 v[244:247], a[140:143], a[84:87], v[244:247]
v_accvgpr_read_b32 v91, a255
v_cvt_pk_bf16_f32 v80, v80, v81
v_mfma_f32_16x16x32_bf16 v[252:255], a[136:139], a[88:91], v[252:255]
ds_read_b64_tr_b16 a[134:135], v22 offset:18432
v_cvt_pk_bf16_f32 v81, v82, v83
v_mfma_f32_16x16x32_bf16 v[252:255], a[140:143], a[92:95], v[252:255]
v_cvt_pk_bf16_f32 v82, v88, v89
v_cvt_pk_bf16_f32 v83, v90, v91
v_mfma_f32_16x16x32_bf16 a[160:163], a[136:139], a[96:99], a[160:163]
buffer_store_dwordx4 v[80:83], v1, s[4:7], s31 offen sc1
v_mfma_f32_16x16x32_bf16 a[160:163], a[140:143], a[100:103], a[160:163]
v_cmp_ne_u32 vcc, 0x100, v21
v_mfma_f32_16x16x32_bf16 a[164:167], a[136:139], a[104:107], a[164:167]
v_mfma_f32_16x16x32_bf16 a[164:167], a[140:143], a[108:111], a[164:167]
v_mfma_f32_16x16x32_bf16 a[168:171], a[136:139], a[112:115], a[168:171]
v_mfma_f32_16x16x32_bf16 a[168:171], a[140:143], a[116:119], a[168:171]
v_mfma_f32_16x16x32_bf16 a[172:175], a[136:139], a[120:123], a[172:175]
v_mfma_f32_16x16x32_bf16 a[172:175], a[140:143], a[124:127], a[172:175]
s_waitcnt lgkmcnt(2)
s_cbranch_vccnz M_cntspin
M_cntok:
s_and_b32 s22, s2, 0xf0
s_cmp_eq_u32 s22, 0xf0
s_cbranch_scc1 M_own
s_bitcmp1_b32 s2, 4
s_cbranch_scc1 M_conv
M_own:
v_mfma_f32_16x16x32_bf16 v[36:39], a[128:131], a[0:3], v[36:39]
s_waitcnt lgkmcnt(0)
ds_read_b64_tr_b16 a[136:137], v23 offset:0
v_mfma_f32_16x16x32_bf16 v[36:39], a[132:135], a[4:7], v[36:39]
v_mfma_f32_16x16x32_bf16 v[44:47], a[128:131], a[8:11], v[44:47]
s_lshr_b32 s22, s2, 4
ds_read_b64_tr_b16 a[138:139], v23 offset:2048
v_mfma_f32_16x16x32_bf16 v[44:47], a[132:135], a[12:15], v[44:47]
s_lshl_b32 s23, s20, 5
v_mfma_f32_16x16x32_bf16 v[52:55], a[128:131], a[16:19], v[52:55]
s_add_u32 s23, s23, s22
ds_read_b64_tr_b16 a[140:141], v23 offset:16384
v_mfma_f32_16x16x32_bf16 v[52:55], a[132:135], a[20:23], v[52:55]
s_lshl_b32 s23, s23, 2
v_mfma_f32_16x16x32_bf16 v[60:63], a[128:131], a[24:27], v[60:63]
s_add_u32 s45, s23, 94371840
ds_read_b64_tr_b16 a[142:143], v23 offset:18432
v_mfma_f32_16x16x32_bf16 v[60:63], a[132:135], a[28:31], v[60:63]
s_lshl_b32 s31, s20, 20
v_mfma_f32_16x16x32_bf16 v[68:71], a[128:131], a[32:35], v[68:71]
s_lshl_b32 s22, s37, 16
v_mfma_f32_16x16x32_bf16 v[68:71], a[132:135], a[36:39], v[68:71]
s_add_u32 s31, s31, s22
v_mfma_f32_16x16x32_bf16 v[76:79], a[128:131], a[40:43], v[76:79]
s_lshl_b32 s22, s3, 11
v_mfma_f32_16x16x32_bf16 v[76:79], a[132:135], a[44:47], v[76:79]
s_add_u32 s31, s31, s22
v_mfma_f32_16x16x32_bf16 v[84:87], a[128:131], a[48:51], v[84:87]
s_add_u32 s31, s31, 33554432
v_mfma_f32_16x16x32_bf16 v[84:87], a[132:135], a[52:55], v[84:87]
s_cmp_eq_u32 s21, 7
v_mfma_f32_16x16x32_bf16 v[92:95], a[128:131], a[56:59], v[92:95]
s_cselect_b32 s31, 3221225472, s31
v_mfma_f32_16x16x32_bf16 v[92:95], a[132:135], a[60:63], v[92:95]
s_waitcnt lgkmcnt(2)
v_mfma_f32_16x16x32_bf16 v[100:103], a[136:139], a[0:3], v[100:103]
s_waitcnt lgkmcnt(0)
ds_read_b64_tr_b16 a[128:129], v24 offset:0
v_mfma_f32_16x16x32_bf16 v[100:103], a[140:143], a[4:7], v[100:103]
v_mfma_f32_16x16x32_bf16 v[108:111], a[136:139], a[8:11], v[108:111]
ds_read_b64_tr_b16 a[130:131], v24 offset:2048
v_mfma_f32_16x16x32_bf16 v[108:111], a[140:143], a[12:15], v[108:111]
v_mfma_f32_16x16x32_bf16 v[116:119], a[136:139], a[16:19], v[116:119]
ds_read_b64_tr_b16 a[132:133], v24 offset:16384
v_mfma_f32_16x16x32_bf16 v[116:119], a[140:143], a[20:23], v[116:119]
v_mfma_f32_16x16x32_bf16 v[124:127], a[136:139], a[24:27], v[124:127]
ds_read_b64_tr_b16 a[134:135], v24 offset:18432
v_mfma_f32_16x16x32_bf16 v[124:127], a[140:143], a[28:31], v[124:127]
v_mfma_f32_16x16x32_bf16 v[132:135], a[136:139], a[32:35], v[132:135]
v_mfma_f32_16x16x32_bf16 v[132:135], a[140:143], a[36:39], v[132:135]
v_mfma_f32_16x16x32_bf16 v[140:143], a[136:139], a[40:43], v[140:143]
v_mfma_f32_16x16x32_bf16 v[140:143], a[140:143], a[44:47], v[140:143]
v_mfma_f32_16x16x32_bf16 v[148:151], a[136:139], a[48:51], v[148:151]
v_mfma_f32_16x16x32_bf16 v[148:151], a[140:143], a[52:55], v[148:151]
v_mfma_f32_16x16x32_bf16 v[156:159], a[136:139], a[56:59], v[156:159]
v_mfma_f32_16x16x32_bf16 v[156:159], a[140:143], a[60:63], v[156:159]
s_waitcnt lgkmcnt(2)
v_mfma_f32_16x16x32_bf16 v[164:167], a[128:131], a[0:3], v[164:167]
s_waitcnt lgkmcnt(0)
ds_read_b64_tr_b16 a[136:137], v25 offset:0
v_mfma_f32_16x16x32_bf16 v[164:167], a[132:135], a[4:7], v[164:167]
v_mfma_f32_16x16x32_bf16 v[172:175], a[128:131], a[8:11], v[172:175]
ds_read_b64_tr_b16 a[138:139], v25 offset:2048
v_mfma_f32_16x16x32_bf16 v[172:175], a[132:135], a[12:15], v[172:175]
v_mfma_f32_16x16x32_bf16 v[180:183], a[128:131], a[16:19], v[180:183]
ds_read_b64_tr_b16 a[140:141], v25 offset:16384
v_mfma_f32_16x16x32_bf16 v[180:183], a[132:135], a[20:23], v[180:183]
v_mfma_f32_16x16x32_bf16 v[188:191], a[128:131], a[24:27], v[188:191]
ds_read_b64_tr_b16 a[142:143], v25 offset:18432
v_mfma_f32_16x16x32_bf16 v[188:191], a[132:135], a[28:31], v[188:191]
v_mfma_f32_16x16x32_bf16 v[196:199], a[128:131], a[32:35], v[196:199]
v_mfma_f32_16x16x32_bf16 v[196:199], a[132:135], a[36:39], v[196:199]
v_mfma_f32_16x16x32_bf16 v[204:207], a[128:131], a[40:43], v[204:207]
v_mfma_f32_16x16x32_bf16 v[204:207], a[132:135], a[44:47], v[204:207]
v_mfma_f32_16x16x32_bf16 v[212:215], a[128:131], a[48:51], v[212:215]
v_mfma_f32_16x16x32_bf16 v[212:215], a[132:135], a[52:55], v[212:215]
v_mfma_f32_16x16x32_bf16 v[220:223], a[128:131], a[56:59], v[220:223]
v_mfma_f32_16x16x32_bf16 v[220:223], a[132:135], a[60:63], v[220:223]
s_waitcnt lgkmcnt(2)
v_mfma_f32_16x16x32_bf16 v[228:231], a[136:139], a[0:3], v[228:231]
s_waitcnt lgkmcnt(0)
v_mfma_f32_16x16x32_bf16 v[228:231], a[140:143], a[4:7], v[228:231]
v_mfma_f32_16x16x32_bf16 v[236:239], a[136:139], a[8:11], v[236:239]
v_mfma_f32_16x16x32_bf16 v[236:239], a[140:143], a[12:15], v[236:239]
v_mfma_f32_16x16x32_bf16 v[244:247], a[136:139], a[16:19], v[244:247]
v_mfma_f32_16x16x32_bf16 v[244:247], a[140:143], a[20:23], v[244:247]
v_mfma_f32_16x16x32_bf16 v[252:255], a[136:139], a[24:27], v[252:255]
v_mfma_f32_16x16x32_bf16 v[252:255], a[140:143], a[28:31], v[252:255]
v_mfma_f32_16x16x32_bf16 a[160:163], a[136:139], a[32:35], a[160:163]
v_mfma_f32_16x16x32_bf16 a[160:163], a[140:143], a[36:39], a[160:163]
v_mfma_f32_16x16x32_bf16 a[164:167], a[136:139], a[40:43], a[164:167]
v_mfma_f32_16x16x32_bf16 a[164:167], a[140:143], a[44:47], a[164:167]
v_mfma_f32_16x16x32_bf16 a[168:171], a[136:139], a[48:51], a[168:171]
v_mfma_f32_16x16x32_bf16 a[168:171], a[140:143], a[52:55], a[168:171]
v_mfma_f32_16x16x32_bf16 a[172:175], a[136:139], a[56:59], a[172:175]
v_mfma_f32_16x16x32_bf16 a[172:175], a[140:143], a[60:63], a[172:175]
s_waitcnt vmcnt(0)
s_barrier
buffer_store_dword v27, v26, s[4:7], s45 offen sc1
s_mov_b32 s22, 1035512379
s_mov_b32 s23, 1035512379
s_lshl_b32 s30, s3, 11
s_add_u32 s30, s30, 65536
v_add_u32 v28, s30, v1
v_pk_mul_f32 v[36:37], v[36:37], s[22:23]
v_pk_mul_f32 v[38:39], v[38:39], s[22:23]
v_pk_mul_f32 v[100:101], v[100:101], s[22:23]
v_pk_mul_f32 v[102:103], v[102:103], s[22:23]
v_cvt_pk_bf16_f32 v36, v36, v37
v_cvt_pk_bf16_f32 v37, v38, v39
v_cvt_pk_bf16_f32 v38, v100, v101
v_cvt_pk_bf16_f32 v39, v102, v103
ds_write_b128 v28, v[36:39] offset:0
s_add_u32 s30, s31, 0
buffer_store_dwordx4 v[36:39], v1, s[4:7], s30 offen offset:0 sc1
v_pk_mul_f32 v[44:45], v[44:45], s[22:23]
v_pk_mul_f32 v[46:47], v[46:47], s[22:23]
v_pk_mul_f32 v[108:109], v[108:109], s[22:23]
v_pk_mul_f32 v[110:111], v[110:111], s[22:23]
v_cvt_pk_bf16_f32 v44, v44, v45
v_cvt_pk_bf16_f32 v45, v46, v47
v_cvt_pk_bf16_f32 v46, v108, v109
v_cvt_pk_bf16_f32 v47, v110, v111
ds_write_b128 v28, v[44:47] offset:8192
s_add_u32 s30, s31, 8192
buffer_store_dwordx4 v[44:47], v1, s[4:7], s30 offen offset:0 sc1
v_pk_mul_f32 v[52:53], v[52:53], s[22:23]
v_pk_mul_f32 v[54:55], v[54:55], s[22:23]
v_pk_mul_f32 v[116:117], v[116:117], s[22:23]
v_pk_mul_f32 v[118:119], v[118:119], s[22:23]
v_cvt_pk_bf16_f32 v52, v52, v53
v_cvt_pk_bf16_f32 v53, v54, v55
v_cvt_pk_bf16_f32 v54, v116, v117
v_cvt_pk_bf16_f32 v55, v118, v119
ds_write_b128 v28, v[52:55] offset:16384
s_add_u32 s30, s31, 16384
buffer_store_dwordx4 v[52:55], v1, s[4:7], s30 offen offset:0 sc1
v_pk_mul_f32 v[60:61], v[60:61], s[22:23]
v_pk_mul_f32 v[62:63], v[62:63], s[22:23]
v_pk_mul_f32 v[124:125], v[124:125], s[22:23]
v_pk_mul_f32 v[126:127], v[126:127], s[22:23]
v_cvt_pk_bf16_f32 v60, v60, v61
v_cvt_pk_bf16_f32 v61, v62, v63
v_cvt_pk_bf16_f32 v62, v124, v125
v_cvt_pk_bf16_f32 v63, v126, v127
ds_write_b128 v28, v[60:63] offset:24576
s_add_u32 s30, s31, 24576
buffer_store_dwordx4 v[60:63], v1, s[4:7], s30 offen offset:0 sc1
v_pk_mul_f32 v[68:69], v[68:69], s[22:23]
v_pk_mul_f32 v[70:71], v[70:71], s[22:23]
v_pk_mul_f32 v[132:133], v[132:133], s[22:23]
v_pk_mul_f32 v[134:135], v[134:135], s[22:23]
v_cvt_pk_bf16_f32 v68, v68, v69
v_cvt_pk_bf16_f32 v69, v70, v71
v_cvt_pk_bf16_f32 v70, v132, v133
v_cvt_pk_bf16_f32 v71, v134, v135
ds_write_b128 v28, v[68:71] offset:32768
s_add_u32 s30, s31, 32768
buffer_store_dwordx4 v[68:71], v1, s[4:7], s30 offen offset:0 sc1
v_pk_mul_f32 v[76:77], v[76:77], s[22:23]
v_pk_mul_f32 v[78:79], v[78:79], s[22:23]
v_pk_mul_f32 v[140:141], v[140:141], s[22:23]
v_pk_mul_f32 v[142:143], v[142:143], s[22:23]
v_cvt_pk_bf16_f32 v76, v76, v77
v_cvt_pk_bf16_f32 v77, v78, v79
v_cvt_pk_bf16_f32 v78, v140, v141
v_cvt_pk_bf16_f32 v79, v142, v143
ds_write_b128 v28, v[76:79] offset:40960
s_add_u32 s30, s31, 40960
buffer_store_dwordx4 v[76:79], v1, s[4:7], s30 offen offset:0 sc1
v_pk_mul_f32 v[84:85], v[84:85], s[22:23]
v_pk_mul_f32 v[86:87], v[86:87], s[22:23]
v_pk_mul_f32 v[148:149], v[148:149], s[22:23]
v_pk_mul_f32 v[150:151], v[150:151], s[22:23]
v_cvt_pk_bf16_f32 v84, v84, v85
v_cvt_pk_bf16_f32 v85, v86, v87
v_cvt_pk_bf16_f32 v86, v148, v149
v_cvt_pk_bf16_f32 v87, v150, v151
ds_write_b128 v28, v[84:87] offset:49152
s_add_u32 s30, s31, 49152
buffer_store_dwordx4 v[84:87], v1, s[4:7], s30 offen offset:0 sc1
v_pk_mul_f32 v[92:93], v[92:93], s[22:23]
v_pk_mul_f32 v[94:95], v[94:95], s[22:23]
v_pk_mul_f32 v[156:157], v[156:157], s[22:23]
v_pk_mul_f32 v[158:159], v[158:159], s[22:23]
v_cvt_pk_bf16_f32 v92, v92, v93
v_cvt_pk_bf16_f32 v93, v94, v95
v_cvt_pk_bf16_f32 v94, v156, v157
v_cvt_pk_bf16_f32 v95, v158, v159
ds_write_b128 v28, v[92:95] offset:57344
s_add_u32 s30, s31, 57344
buffer_store_dwordx4 v[92:95], v1, s[4:7], s30 offen offset:0 sc1
v_pk_mul_f32 v[164:165], v[164:165], s[22:23]
v_pk_mul_f32 v[166:167], v[166:167], s[22:23]
v_pk_mul_f32 v[228:229], v[228:229], s[22:23]
v_pk_mul_f32 v[230:231], v[230:231], s[22:23]
v_cvt_pk_bf16_f32 v164, v164, v165
v_cvt_pk_bf16_f32 v165, v166, v167
v_cvt_pk_bf16_f32 v166, v228, v229
v_cvt_pk_bf16_f32 v167, v230, v231
ds_write_b128 v28, v[164:167] offset:1024
s_add_u32 s30, s31, 0
buffer_store_dwordx4 v[164:167], v1, s[4:7], s30 offen offset:1024 sc1
v_pk_mul_f32 v[172:173], v[172:173], s[22:23]
v_pk_mul_f32 v[174:175], v[174:175], s[22:23]
v_pk_mul_f32 v[236:237], v[236:237], s[22:23]
v_pk_mul_f32 v[238:239], v[238:239], s[22:23]
v_cvt_pk_bf16_f32 v172, v172, v173
v_cvt_pk_bf16_f32 v173, v174, v175
v_cvt_pk_bf16_f32 v174, v236, v237
v_cvt_pk_bf16_f32 v175, v238, v239
ds_write_b128 v28, v[172:175] offset:9216
s_add_u32 s30, s31, 8192
buffer_store_dwordx4 v[172:175], v1, s[4:7], s30 offen offset:1024 sc1
v_pk_mul_f32 v[180:181], v[180:181], s[22:23]
v_pk_mul_f32 v[182:183], v[182:183], s[22:23]
v_pk_mul_f32 v[244:245], v[244:245], s[22:23]
v_pk_mul_f32 v[246:247], v[246:247], s[22:23]
v_cvt_pk_bf16_f32 v180, v180, v181
v_cvt_pk_bf16_f32 v181, v182, v183
v_cvt_pk_bf16_f32 v182, v244, v245
v_cvt_pk_bf16_f32 v183, v246, v247
ds_write_b128 v28, v[180:183] offset:17408
s_add_u32 s30, s31, 16384
buffer_store_dwordx4 v[180:183], v1, s[4:7], s30 offen offset:1024 sc1
v_pk_mul_f32 v[188:189], v[188:189], s[22:23]
v_pk_mul_f32 v[190:191], v[190:191], s[22:23]
v_pk_mul_f32 v[252:253], v[252:253], s[22:23]
v_pk_mul_f32 v[254:255], v[254:255], s[22:23]
v_cvt_pk_bf16_f32 v188, v188, v189
v_cvt_pk_bf16_f32 v189, v190, v191
v_cvt_pk_bf16_f32 v190, v252, v253
v_cvt_pk_bf16_f32 v191, v254, v255
ds_write_b128 v28, v[188:191] offset:25600
s_add_u32 s30, s31, 24576
buffer_store_dwordx4 v[188:191], v1, s[4:7], s30 offen offset:1024 sc1
v_accvgpr_read_b32 v128, a160
v_accvgpr_read_b32 v129, a161
v_accvgpr_read_b32 v130, a162
v_accvgpr_read_b32 v131, a163
v_pk_mul_f32 v[196:197], v[196:197], s[22:23]
v_pk_mul_f32 v[198:199], v[198:199], s[22:23]
v_pk_mul_f32 v[128:129], v[128:129], s[22:23]
v_pk_mul_f32 v[130:131], v[130:131], s[22:23]
v_cvt_pk_bf16_f32 v196, v196, v197
v_cvt_pk_bf16_f32 v197, v198, v199
v_cvt_pk_bf16_f32 v198, v128, v129
v_cvt_pk_bf16_f32 v199, v130, v131
ds_write_b128 v28, v[196:199] offset:33792
s_add_u32 s30, s31, 32768
buffer_store_dwordx4 v[196:199], v1, s[4:7], s30 offen offset:1024 sc1
v_accvgpr_read_b32 v136, a164
v_accvgpr_read_b32 v137, a165
v_accvgpr_read_b32 v138, a166
v_accvgpr_read_b32 v139, a167
v_pk_mul_f32 v[204:205], v[204:205], s[22:23]
v_pk_mul_f32 v[206:207], v[206:207], s[22:23]
v_pk_mul_f32 v[136:137], v[136:137], s[22:23]
v_pk_mul_f32 v[138:139], v[138:139], s[22:23]
v_cvt_pk_bf16_f32 v204, v204, v205
v_cvt_pk_bf16_f32 v205, v206, v207
v_cvt_pk_bf16_f32 v206, v136, v137
v_cvt_pk_bf16_f32 v207, v138, v139
ds_write_b128 v28, v[204:207] offset:41984
s_add_u32 s30, s31, 40960
buffer_store_dwordx4 v[204:207], v1, s[4:7], s30 offen offset:1024 sc1
v_accvgpr_read_b32 v144, a168
v_accvgpr_read_b32 v145, a169
v_accvgpr_read_b32 v146, a170
v_accvgpr_read_b32 v147, a171
v_pk_mul_f32 v[212:213], v[212:213], s[22:23]
v_pk_mul_f32 v[214:215], v[214:215], s[22:23]
v_pk_mul_f32 v[144:145], v[144:145], s[22:23]
v_pk_mul_f32 v[146:147], v[146:147], s[22:23]
v_cvt_pk_bf16_f32 v212, v212, v213
v_cvt_pk_bf16_f32 v213, v214, v215
v_cvt_pk_bf16_f32 v214, v144, v145
v_cvt_pk_bf16_f32 v215, v146, v147
ds_write_b128 v28, v[212:215] offset:50176
s_add_u32 s30, s31, 49152
buffer_store_dwordx4 v[212:215], v1, s[4:7], s30 offen offset:1024 sc1
v_accvgpr_read_b32 v152, a172
v_accvgpr_read_b32 v153, a173
v_accvgpr_read_b32 v154, a174
v_accvgpr_read_b32 v155, a175
v_pk_mul_f32 v[220:221], v[220:221], s[22:23]
v_pk_mul_f32 v[222:223], v[222:223], s[22:23]
v_pk_mul_f32 v[152:153], v[152:153], s[22:23]
v_pk_mul_f32 v[154:155], v[154:155], s[22:23]
v_cvt_pk_bf16_f32 v220, v220, v221
v_cvt_pk_bf16_f32 v221, v222, v223
v_cvt_pk_bf16_f32 v222, v152, v153
v_cvt_pk_bf16_f32 v223, v154, v155
ds_write_b128 v28, v[220:223] offset:58368
s_add_u32 s30, s31, 57344
buffer_store_dwordx4 v[220:223], v1, s[4:7], s30 offen offset:1024 sc1
s_add_u32 s31, s45, 64
s_lshl_b32 s22, s3, 13
s_add_u32 s22, s22, 65536
v_add_u32 v28, s22, v1
s_waitcnt lgkmcnt(0)
s_barrier
ds_read_b128 a[0:3], v28 offset:0
ds_read_b128 a[4:7], v28 offset:1024
ds_read_b128 a[8:11], v28 offset:2048
ds_read_b128 a[12:15], v28 offset:3072
ds_read_b128 a[16:19], v28 offset:4096
ds_read_b128 a[20:23], v28 offset:5120
ds_read_b128 a[24:27], v28 offset:6144
ds_read_b128 a[28:31], v28 offset:7168
ds_read_b128 a[32:35], v28 offset:32768
ds_read_b128 a[36:39], v28 offset:33792
ds_read_b128 a[40:43], v28 offset:34816
ds_read_b128 a[44:47], v28 offset:35840
ds_read_b128 a[48:51], v28 offset:36864
ds_read_b128 a[52:55], v28 offset:37888
ds_read_b128 a[56:59], v28 offset:38912
ds_read_b128 a[60:63], v28 offset:39936
v_lshrrev_b32 v3, 6, v0
v_and_b32 v4, 63, v0
v_add_u32 v2, 0x10000, v1
s_lshl_b32 s18, s3, 13
s_mov_b32 s25, 1266679808
v_and_b32 v5, 15, v4
v_lshrrev_b32 v6, 4, v4
v_lshlrev_b32 v6, 2, v6
v_sub_u32 v5, v5, v6
v_lshl_add_u32 v5, v3, 4, v5
v_cmp_gt_i32 s[32:33], 0, v5
v_cmp_gt_i32 s[34:35], 1, v5
v_cmp_gt_i32 s[36:37], 2, v5
v_cmp_gt_i32 s[38:39], 3, v5
v_cmp_gt_i32 s[40:41], 16, v5
v_cmp_gt_i32 s[42:43], 17, v5
v_cmp_gt_i32 s[44:45], 18, v5
v_cmp_gt_i32 s[46:47], 19, v5
v_cmp_gt_i32 s[48:49], 32, v5
v_cmp_gt_i32 s[50:51], 33, v5
v_cmp_gt_i32 s[52:53], 34, v5
v_cmp_gt_i32 s[54:55], 35, v5
v_cmp_gt_i32 s[56:57], 48, v5
v_cmp_gt_i32 s[58:59], 49, v5
v_cmp_gt_i32 s[60:61], 50, v5
v_cmp_gt_i32 s[62:63], 51, v5
v_cmp_eq_u32 vcc, 0, v0
v_mov_b32 v7, 0xff800000
v_mov_b32 v6, 1
v_mov_b32 v3, 0
v_mov_b32 v5, 3221225472
v_cndmask_b32 v5, v5, v3, vcc
s_lshl_b32 s30, s20, 20
s_add_u32 s30, s30, s18
s_lshl_b32 s27, s20, 3
s_add_u32 s27, s27, s21
s_lshl_b32 s28, s20, 7
s_lshl_b32 s22, s21, 3
s_add_u32 s28, s28, s22
s_add_u32 s28, s28, 94375940
s_sub_u32 s29, 15, s21
s_lshl_b32 s22, s21, 1
s_mov_b32 s10, 3221225472
s_mov_b32 s11, 0
s_mov_b32 s14, 3221225472
s_bitcmp1_b32 s2, 4
s_cbranch_scc1 Lr_9401B
s_sub_u32 s22, 14, s22
s_lshl_b32 s22, s22, 15
s_add_u32 s8, s30, s22
s_mov_b32 s9, 18
s_mov_b32 s19, 8
s_cmp_eq_u32 s21, 7
s_cselect_b32 s24, 0, 1
s_branch Lr_9401go
Lr_9401B:
s_mov_b32 s8, s30
s_cmp_eq_u32 s21, 7
s_cbranch_scc1 Lr_9401B7
s_sub_u32 s9, 14, s22
s_mov_b32 s10, s30
s_add_u32 s11, s22, 2
s_add_u32 s14, s30, 16777216
s_sub_u32 s19, 7, s21
s_mov_b32 s24, 2
s_branch Lr_9401go
Lr_9401B7:
s_mov_b32 s9, 16
s_mov_b32 s19, 7
s_mov_b32 s24, 0
s_mov_b32 s29, 7
Lr_9401go:
s_add_u32 s12, s8, 16777216
s_mov_b32 s13, s9
s_mov_b32 s15, s11
s_lshl_b32 s26, s21, 16
s_add_u32 s26, s26, s30
s_add_u32 s26, s26, 33554432
v_mov_b32 v128, 0
v_mov_b32 v129, 0
v_mov_b32 v130, 0
v_mov_b32 v131, 0
v_mov_b32 v132, 0
v_mov_b32 v133, 0
v_mov_b32 v134, 0
v_mov_b32 v135, 0
v_mov_b32 v136, 0
v_mov_b32 v137, 0
v_mov_b32 v138, 0
v_mov_b32 v139, 0
v_mov_b32 v140, 0
v_mov_b32 v141, 0
v_mov_b32 v142, 0
v_mov_b32 v143, 0
v_mov_b32 v144, 0
v_mov_b32 v145, 0
v_mov_b32 v146, 0
v_mov_b32 v147, 0
v_mov_b32 v148, 0
v_mov_b32 v149, 0
v_mov_b32 v150, 0
v_mov_b32 v151, 0
v_mov_b32 v152, 0
v_mov_b32 v153, 0
v_mov_b32 v154, 0
v_mov_b32 v155, 0
v_mov_b32 v156, 0
v_mov_b32 v157, 0
v_mov_b32 v158, 0
v_mov_b32 v159, 0
v_mov_b32 v160, 0
v_mov_b32 v161, 0
v_mov_b32 v162, 0
v_mov_b32 v163, 0
v_mov_b32 v164, 0
v_mov_b32 v165, 0
v_mov_b32 v166, 0
v_mov_b32 v167, 0
v_mov_b32 v168, 0
v_mov_b32 v169, 0
v_mov_b32 v170, 0
v_mov_b32 v171, 0
v_mov_b32 v172, 0
v_mov_b32 v173, 0
v_mov_b32 v174, 0
v_mov_b32 v175, 0
v_mov_b32 v176, 0
v_mov_b32 v177, 0
v_mov_b32 v178, 0
v_mov_b32 v179, 0
v_mov_b32 v180, 0
v_mov_b32 v181, 0
v_mov_b32 v182, 0
v_mov_b32 v183, 0
v_mov_b32 v184, 0
v_mov_b32 v185, 0
v_mov_b32 v186, 0
v_mov_b32 v187, 0
v_mov_b32 v188, 0
v_mov_b32 v189, 0
v_mov_b32 v190, 0
v_mov_b32 v191, 0
v_mov_b32 v192, 0
v_mov_b32 v193, 0
v_mov_b32 v194, 0
v_mov_b32 v195, 0
v_mov_b32 v196, 0
v_mov_b32 v197, 0
v_mov_b32 v198, 0
v_mov_b32 v199, 0
v_mov_b32 v200, 0
v_mov_b32 v201, 0
v_mov_b32 v202, 0
v_mov_b32 v203, 0
v_mov_b32 v204, 0
v_mov_b32 v205, 0
v_mov_b32 v206, 0
v_mov_b32 v207, 0
v_mov_b32 v208, 0
v_mov_b32 v209, 0
v_mov_b32 v210, 0
v_mov_b32 v211, 0
v_mov_b32 v212, 0
v_mov_b32 v213, 0
v_mov_b32 v214, 0
v_mov_b32 v215, 0
v_mov_b32 v216, 0
v_mov_b32 v217, 0
v_mov_b32 v218, 0
v_mov_b32 v219, 0
v_mov_b32 v220, 0
v_mov_b32 v221, 0
v_mov_b32 v222, 0
v_mov_b32 v223, 0
v_mov_b32 v224, 0
v_mov_b32 v225, 0
v_mov_b32 v226, 0
v_mov_b32 v227, 0
v_mov_b32 v228, 0
v_mov_b32 v229, 0
v_mov_b32 v230, 0
v_mov_b32 v231, 0
v_mov_b32 v232, 0
v_mov_b32 v233, 0
v_mov_b32 v234, 0
v_mov_b32 v235, 0
v_mov_b32 v236, 0
v_mov_b32 v237, 0
v_mov_b32 v238, 0
v_mov_b32 v239, 0
v_mov_b32 v240, 0
v_mov_b32 v241, 0
v_mov_b32 v242, 0
v_mov_b32 v243, 0
v_mov_b32 v244, 0
v_mov_b32 v245, 0
v_mov_b32 v246, 0
v_mov_b32 v247, 0
v_mov_b32 v248, 0
v_mov_b32 v249, 0
v_mov_b32 v250, 0
v_mov_b32 v251, 0
v_mov_b32 v252, 0
v_mov_b32 v253, 0
v_mov_b32 v254, 0
v_mov_b32 v255, 0
v_mov_b32 v24, 0
v_mov_b32 v25, 0
s_lshl_b32 s22, s20, 7
s_add_u32 s22, s22, 94371840
v_lshrrev_b32 v4, 4, v1
v_min_u32 v4, 15, v4
v_lshlrev_b32 v4, 2, v4
Lp_9402:
buffer_load_dword v3, v4, s[4:7], s22 offen sc1
s_waitcnt vmcnt(0)
v_cmp_ne_u32 vcc, 1, v3
s_cbranch_vccz Lpd_9403
s_sleep 4
s_sub_u32 s101, s101, 1
s_cbranch_scc0 Lp_9402
s_mov_b32 s101, 0
Lpd_9403:
s_add_u32 m0, s18, 0
s_nop 0
buffer_load_dwordx4 v1, s[4:7], s8 offen offset:0 sc1 lds
buffer_load_dwordx4 v1, s[4:7], s8 offen offset:1024 sc1 lds
buffer_load_dwordx4 v1, s[4:7], s8 offen offset:2048 sc1 lds
buffer_load_dwordx4 v1, s[4:7], s8 offen offset:3072 sc1 lds
s_add_u32 s8, s8, 4096
s_add_u32 m0, s18, 4096
s_nop 0
buffer_load_dwordx4 v1, s[4:7], s8 offen offset:0 sc1 lds
buffer_load_dwordx4 v1, s[4:7], s8 offen offset:1024 sc1 lds
buffer_load_dwordx4 v1, s[4:7], s8 offen offset:2048 sc1 lds
buffer_load_dwordx4 v1, s[4:7], s8 offen offset:3072 sc1 lds
s_add_u32 s8, s8, 28672
s_sub_u32 s9, s9, 1
s_cmp_eq_u32 s9, 0
s_cselect_b32 s8, s10, s8
s_cselect_b32 s9, s11, s9
s_cselect_b32 s10, 3221225472, s10
s_add_u32 m0, s18, 32768
s_nop 0
buffer_load_dwordx4 v1, s[4:7], s8 offen offset:0 sc1 lds
buffer_load_dwordx4 v1, s[4:7], s8 offen offset:1024 sc1 lds
buffer_load_dwordx4 v1, s[4:7], s8 offen offset:2048 sc1 lds
buffer_load_dwordx4 v1, s[4:7], s8 offen offset:3072 sc1 lds
s_add_u32 s8, s8, 4096
s_add_u32 m0, s18, 36864
s_nop 0
buffer_load_dwordx4 v1, s[4:7], s8 offen offset:0 sc1 lds
buffer_load_dwordx4 v1, s[4:7], s8 offen offset:1024 sc1 lds
buffer_load_dwordx4 v1, s[4:7], s8 offen offset:2048 sc1 lds
buffer_load_dwordx4 v1, s[4:7], s8 offen offset:3072 sc1 lds
s_add_u32 s8, s8, 28672
s_sub_u32 s9, s9, 1
s_cmp_eq_u32 s9, 0
s_cselect_b32 s8, s10, s8
s_cselect_b32 s9, s11, s9
s_cselect_b32 s10, 3221225472, s10
s_waitcnt lgkmcnt(0)
s_barrier
buffer_store_dword v6, v5, s[4:7], s31 offen sc1
s_add_u32 m0, s18, 65536
s_nop 0
buffer_load_dwordx4 v1, s[4:7], s12 offen offset:0 sc1 lds
buffer_load_dwordx4 v1, s[4:7], s12 offen offset:1024 sc1 lds
buffer_load_dwordx4 v1, s[4:7], s12 offen offset:2048 sc1 lds
buffer_load_dwordx4 v1, s[4:7], s12 offen offset:3072 sc1 lds
s_add_u32 s12, s12, 4096
s_add_u32 m0, s18, 69632
s_nop 0
buffer_load_dwordx4 v1, s[4:7], s12 offen offset:0 sc1 lds
buffer_load_dwordx4 v1, s[4:7], s12 offen offset:1024 sc1 lds
buffer_load_dwordx4 v1, s[4:7], s12 offen offset:2048 sc1 lds
buffer_load_dwordx4 v1, s[4:7], s12 offen offset:3072 sc1 lds
s_add_u32 s12, s12, 28672
s_sub_u32 s13, s13, 1
s_cmp_eq_u32 s13, 0
s_cselect_b32 s12, s14, s12
s_cselect_b32 s13, s15, s13
s_cselect_b32 s14, 3221225472, s14
s_waitcnt vmcnt(17)
s_barrier
K2_item:
s_cmp_eq_u32 s19, 0
s_cbranch_scc1 K2_p0d
ds_read_b128 a[64:67], v1 offset:0
ds_read_b128 a[68:71], v1 offset:1024
ds_read_b128 a[72:75], v1 offset:2048
ds_read_b128 a[76:79], v1 offset:3072
ds_read_b128 a[80:83], v1 offset:4096
ds_read_b128 a[84:87], v1 offset:5120
ds_read_b128 a[88:91], v1 offset:6144
ds_read_b128 a[92:95], v1 offset:7168
s_waitcnt lgkmcnt(7)
v_mfma_f32_16x16x32_bf16 v[32:35], a[64:67], a[0:3], 0
s_waitcnt lgkmcnt(6)
ds_read_b128 a[96:99], v1 offset:8192
v_mfma_f32_16x16x32_bf16 v[32:35], a[68:71], a[4:7], v[32:35]
s_waitcnt lgkmcnt(6)
v_mfma_f32_16x16x32_bf16 v[32:35], a[72:75], a[8:11], v[32:35]
s_waitcnt lgkmcnt(5)
ds_read_b128 a[100:103], v1 offset:9216
v_mfma_f32_16x16x32_bf16 v[32:35], a[76:79], a[12:15], v[32:35]
s_waitcnt lgkmcnt(5)
v_mfma_f32_16x16x32_bf16 v[32:35], a[80:83], a[16:19], v[32:35]
s_waitcnt lgkmcnt(4)
ds_read_b128 a[104:107], v1 offset:10240
v_mfma_f32_16x16x32_bf16 v[32:35], a[84:87], a[20:23], v[32:35]
s_waitcnt lgkmcnt(4)
v_mfma_f32_16x16x32_bf16 v[32:35], a[88:91], a[24:27], v[32:35]
s_waitcnt lgkmcnt(3)
ds_read_b128 a[108:111], v1 offset:11264
v_mfma_f32_16x16x32_bf16 v[32:35], a[92:95], a[28:31], v[32:35]
v_mfma_f32_16x16x32_bf16 v[36:39], a[64:67], a[32:35], 0
ds_read_b128 a[112:115], v1 offset:12288
v_mfma_f32_16x16x32_bf16 v[36:39], a[68:71], a[36:39], v[36:39]
v_mfma_f32_16x16x32_bf16 v[36:39], a[72:75], a[40:43], v[36:39]
ds_read_b128 a[116:119], v1 offset:13312
v_mfma_f32_16x16x32_bf16 v[36:39], a[76:79], a[44:47], v[36:39]
v_mfma_f32_16x16x32_bf16 v[36:39], a[80:83], a[48:51], v[36:39]
ds_read_b128 a[120:123], v1 offset:14336
v_max3_f32 v28, v32, v33, v34
v_mfma_f32_16x16x32_bf16 v[36:39], a[84:87], a[52:55], v[36:39]
v_max_f32 v28, v28, v35
v_mov_b32 v30, v28
v_mfma_f32_16x16x32_bf16 v[36:39], a[88:91], a[56:59], v[36:39]
ds_read_b128 a[124:127], v1 offset:15360
v_mfma_f32_16x16x32_bf16 v[36:39], a[92:95], a[60:63], v[36:39]
s_waitcnt lgkmcnt(7)
v_permlane16_swap_b32 v28, v30
v_max_f32 v28, v28, v30
v_mfma_f32_16x16x32_bf16 v[40:43], a[96:99], a[0:3], 0
s_waitcnt lgkmcnt(6)
ds_read_b128 a[64:67], v1 offset:16384
v_mov_b32 v30, v28
v_mfma_f32_16x16x32_bf16 v[40:43], a[100:103], a[4:7], v[40:43]
s_waitcnt lgkmcnt(6)
v_mfma_f32_16x16x32_bf16 v[40:43], a[104:107], a[8:11], v[40:43]
s_waitcnt lgkmcnt(5)
ds_read_b128 a[68:71], v1 offset:17408
v_permlane32_swap_b32 v28, v30
v_mfma_f32_16x16x32_bf16 v[40:43], a[108:111], a[12:15], v[40:43]
s_waitcnt lgkmcnt(5)
v_max_f32 v28, v28, v30
v_sub_f32 v16, 0, v28
v_mfma_f32_16x16x32_bf16 v[40:43], a[112:115], a[16:19], v[40:43]
s_waitcnt lgkmcnt(4)
ds_read_b128 a[72:75], v1 offset:18432
v_sub_f32 v17, 0, v28
v_mfma_f32_16x16x32_bf16 v[40:43], a[116:119], a[20:23], v[40:43]
s_waitcnt lgkmcnt(4)
v_sub_f32 v18, 0, v28
v_sub_f32 v19, 0, v28
v_mfma_f32_16x16x32_bf16 v[40:43], a[120:123], a[24:27], v[40:43]
s_waitcnt lgkmcnt(3)
ds_read_b128 a[76:79], v1 offset:19456
v_max3_f32 v29, v36, v37, v38
v_mfma_f32_16x16x32_bf16 v[40:43], a[124:127], a[28:31], v[40:43]
v_max_f32 v29, v29, v39
v_mov_b32 v31, v29
v_mfma_f32_16x16x32_bf16 v[44:47], a[96:99], a[32:35], 0
ds_read_b128 a[80:83], v1 offset:20480
v_mfma_f32_16x16x32_bf16 v[44:47], a[100:103], a[36:39], v[44:47]
v_permlane16_swap_b32 v29, v31
v_max_f32 v29, v29, v31
v_mfma_f32_16x16x32_bf16 v[44:47], a[104:107], a[40:43], v[44:47]
ds_read_b128 a[84:87], v1 offset:21504
v_mov_b32 v31, v29
v_mfma_f32_16x16x32_bf16 v[44:47], a[108:111], a[44:47], v[44:47]
v_mfma_f32_16x16x32_bf16 v[44:47], a[112:115], a[48:51], v[44:47]
ds_read_b128 a[88:91], v1 offset:22528
v_permlane32_swap_b32 v29, v31
v_mfma_f32_16x16x32_bf16 v[44:47], a[116:119], a[52:55], v[44:47]
v_max_f32 v29, v29, v31
v_sub_f32 v20, 0, v29
v_mfma_f32_16x16x32_bf16 v[44:47], a[120:123], a[56:59], v[44:47]
ds_read_b128 a[92:95], v1 offset:23552
v_sub_f32 v21, 0, v29
v_mfma_f32_16x16x32_bf16 v[44:47], a[124:127], a[60:63], v[44:47]
s_waitcnt lgkmcnt(7)
v_sub_f32 v22, 0, v29
v_sub_f32 v23, 0, v29
v_mfma_f32_16x16x32_bf16 v[48:51], a[64:67], a[0:3], v[16:19]
s_waitcnt lgkmcnt(6)
ds_read_b128 a[96:99], v1 offset:24576
v_mfma_f32_16x16x32_bf16 v[48:51], a[68:71], a[4:7], v[48:51]
s_waitcnt lgkmcnt(6)
v_mfma_f32_16x16x32_bf16 v[48:51], a[72:75], a[8:11], v[48:51]
s_waitcnt lgkmcnt(5)
ds_read_b128 a[100:103], v1 offset:25600
v_mfma_f32_16x16x32_bf16 v[48:51], a[76:79], a[12:15], v[48:51]
s_waitcnt lgkmcnt(5)
v_mfma_f32_16x16x32_bf16 v[48:51], a[80:83], a[16:19], v[48:51]
s_waitcnt lgkmcnt(4)
ds_read_b128 a[104:107], v1 offset:26624
v_mfma_f32_16x16x32_bf16 v[48:51], a[84:87], a[20:23], v[48:51]
s_waitcnt lgkmcnt(4)
v_add_f32 v32, v32, v16
v_add_f32 v33, v33, v16
v_add_f32 v34, v34, v16
v_add_f32 v35, v35, v16
v_mfma_f32_16x16x32_bf16 v[48:51], a[88:91], a[24:27], v[48:51]
s_waitcnt lgkmcnt(3)
ds_read_b128 a[108:111], v1 offset:27648
v_add_f32 v36, v36, v20
v_add_f32 v37, v37, v20
v_add_f32 v38, v38, v20
v_add_f32 v39, v39, v20
v_mfma_f32_16x16x32_bf16 v[48:51], a[92:95], a[28:31], v[48:51]
v_add_f32 v40, v40, v16
v_add_f32 v41, v41, v16
v_add_f32 v42, v42, v16
v_add_f32 v43, v43, v16
v_mfma_f32_16x16x32_bf16 v[52:55], a[64:67], a[32:35], v[20:23]
ds_read_b128 a[112:115], v1 offset:28672
v_add_f32 v44, v44, v20
v_add_f32 v45, v45, v20
v_add_f32 v46, v46, v20
v_add_f32 v47, v47, v20
v_mfma_f32_16x16x32_bf16 v[52:55], a[68:71], a[36:39], v[52:55]
v_exp_f32 v8, v32
v_mfma_f32_16x16x32_bf16 v[52:55], a[72:75], a[40:43], v[52:55]
ds_read_b128 a[116:119], v1 offset:29696
v_exp_f32 v9, v33
v_mfma_f32_16x16x32_bf16 v[52:55], a[76:79], a[44:47], v[52:55]
v_exp_f32 v10, v34
v_mfma_f32_16x16x32_bf16 v[52:55], a[80:83], a[48:51], v[52:55]
ds_read_b128 a[120:123], v1 offset:30720
v_exp_f32 v11, v35
v_mfma_f32_16x16x32_bf16 v[52:55], a[84:87], a[52:55], v[52:55]
v_add_f32 v26, v8, v9
v_cvt_pk_bf16_f32 v96, v8, v9
v_add_f32 v26, v26, v10
v_add_f32 v26, v26, v11
v_cvt_pk_bf16_f32 v97, v10, v11
v_mfma_f32_16x16x32_bf16 v[52:55], a[88:91], a[56:59], v[52:55]
ds_read_b128 a[124:127], v1 offset:31744
v_exp_f32 v12, v36
v_mfma_f32_16x16x32_bf16 v[52:55], a[92:95], a[60:63], v[52:55]
s_waitcnt vmcnt(8) lgkmcnt(7)
s_barrier
v_exp_f32 v13, v37
v_mfma_f32_16x16x32_bf16 v[56:59], a[96:99], a[0:3], v[16:19]
s_waitcnt lgkmcnt(6)
ds_read_b128 a[64:67], v1 offset:32768
v_exp_f32 v14, v38
v_mfma_f32_16x16x32_bf16 v[56:59], a[100:103], a[4:7], v[56:59]
s_waitcnt lgkmcnt(6)
v_exp_f32 v15, v39
v_mfma_f32_16x16x32_bf16 v[56:59], a[104:107], a[8:11], v[56:59]
s_waitcnt lgkmcnt(5)
ds_read_b128 a[68:71], v1 offset:33792
v_add_f32 v27, v12, v13
v_cvt_pk_bf16_f32 v104, v12, v13
v_add_f32 v27, v27, v14
v_add_f32 v27, v27, v15
v_cvt_pk_bf16_f32 v105, v14, v15
v_mfma_f32_16x16x32_bf16 v[56:59], a[108:111], a[12:15], v[56:59]
s_waitcnt lgkmcnt(5)
v_exp_f32 v8, v40
v_mfma_f32_16x16x32_bf16 v[56:59], a[112:115], a[16:19], v[56:59]
s_waitcnt lgkmcnt(4)
ds_read_b128 a[72:75], v1 offset:34816
v_exp_f32 v9, v41
v_mfma_f32_16x16x32_bf16 v[56:59], a[116:119], a[20:23], v[56:59]
s_waitcnt lgkmcnt(4)
v_exp_f32 v10, v42
v_mfma_f32_16x16x32_bf16 v[56:59], a[120:123], a[24:27], v[56:59]
s_waitcnt lgkmcnt(3)
ds_read_b128 a[76:79], v1 offset:35840
v_exp_f32 v11, v43
v_mfma_f32_16x16x32_bf16 v[56:59], a[124:127], a[28:31], v[56:59]
v_add_f32 v26, v26, v8
v_add_f32 v26, v26, v9
v_cvt_pk_bf16_f32 v98, v8, v9
v_add_f32 v26, v26, v10
v_add_f32 v26, v26, v11
v_cvt_pk_bf16_f32 v99, v10, v11
v_mfma_f32_16x16x32_bf16 v[60:63], a[96:99], a[32:35], v[20:23]
ds_read_b128 a[80:83], v1 offset:36864
v_exp_f32 v12, v44
v_mfma_f32_16x16x32_bf16 v[60:63], a[100:103], a[36:39], v[60:63]
v_exp_f32 v13, v45
v_mfma_f32_16x16x32_bf16 v[60:63], a[104:107], a[40:43], v[60:63]
ds_read_b128 a[84:87], v1 offset:37888
v_exp_f32 v14, v46
v_mfma_f32_16x16x32_bf16 v[60:63], a[108:111], a[44:47], v[60:63]
v_exp_f32 v15, v47
v_mfma_f32_16x16x32_bf16 v[60:63], a[112:115], a[48:51], v[60:63]
ds_read_b128 a[88:91], v1 offset:38912
v_add_f32 v27, v27, v12
v_mfma_f32_16x16x32_bf16 v[60:63], a[116:119], a[52:55], v[60:63]
v_add_f32 v27, v27, v13
v_cvt_pk_bf16_f32 v106, v12, v13
v_mfma_f32_16x16x32_bf16 v[60:63], a[120:123], a[56:59], v[60:63]
s_waitcnt lgkmcnt(7)
s_barrier
ds_read_b128 a[92:95], v1 offset:39936
v_mfma_f32_16x16x32_bf16 v[60:63], a[124:127], a[60:63], v[60:63]
s_waitcnt lgkmcnt(7)
v_add_f32 v27, v27, v14
v_add_f32 v27, v27, v15
v_cvt_pk_bf16_f32 v107, v14, v15
s_branch K2_x1
.p2align 6
K2_loop:
v_mfma_f32_16x16x32_bf16 v[128:131], a[64:67], v[96:99], v[128:131]
s_add_u32 m0, s18, 98304
ds_read_b128 a[96:99], v2 offset:8192
v_add_f32 v24, v24, v26
v_mfma_f32_16x16x32_bf16 v[128:131], a[68:71], v[100:103], v[128:131]
buffer_load_dwordx4 v1, s[4:7], s12 offen offset:0 sc1 lds
v_mfma_f32_16x16x32_bf16 v[132:135], a[68:71], v[108:111], v[132:135]
ds_read_b128 a[100:103], v2 offset:9216
v_add_f32 v25, v25, v27
v_mfma_f32_16x16x32_bf16 v[132:135], a[64:67], v[104:107], v[132:135]
s_waitcnt lgkmcnt(7)
v_exp_f32 v8, v64
v_mfma_f32_16x16x32_bf16 v[136:139], a[72:75], v[96:99], v[136:139]
s_waitcnt lgkmcnt(6)
ds_read_b128 a[104:107], v2 offset:10240
v_mfma_f32_16x16x32_bf16 v[136:139], a[76:79], v[100:103], v[136:139]
buffer_load_dwordx4 v1, s[4:7], s12 offen offset:1024 sc1 lds
v_mfma_f32_16x16x32_bf16 v[140:143], a[76:79], v[108:111], v[140:143]
ds_read_b128 a[108:111], v2 offset:11264
v_mfma_f32_16x16x32_bf16 v[140:143], a[72:75], v[104:107], v[140:143]
s_waitcnt lgkmcnt(7)
v_exp_f32 v9, v65
v_mfma_f32_16x16x32_bf16 v[144:147], a[80:83], v[96:99], v[144:147]
s_waitcnt lgkmcnt(6)
ds_read_b128 a[112:115], v2 offset:12288
v_add_f32 v26, v8, v9
v_mfma_f32_16x16x32_bf16 v[144:147], a[84:87], v[100:103], v[144:147]
buffer_load_dwordx4 v1, s[4:7], s12 offen offset:2048 sc1 lds
v_mfma_f32_16x16x32_bf16 v[148:151], a[84:87], v[108:111], v[148:151]
ds_read_b128 a[116:119], v2 offset:13312
v_cvt_pk_bf16_f32 v112, v8, v9
v_mfma_f32_16x16x32_bf16 v[148:151], a[80:83], v[104:107], v[148:151]
s_waitcnt lgkmcnt(7)
v_exp_f32 v10, v66
v_mfma_f32_16x16x32_bf16 v[152:155], a[88:91], v[96:99], v[152:155]
s_waitcnt lgkmcnt(6)
ds_read_b128 a[120:123], v2 offset:14336
v_add_f32 v26, v26, v10
v_mfma_f32_16x16x32_bf16 v[152:155], a[92:95], v[100:103], v[152:155]
buffer_load_dwordx4 v1, s[4:7], s12 offen offset:3072 sc1 lds
v_mfma_f32_16x16x32_bf16 v[156:159], a[92:95], v[108:111], v[156:159]
s_add_u32 s12, s12, 4096
ds_read_b128 a[124:127], v2 offset:15360
v_mfma_f32_16x16x32_bf16 v[156:159], a[88:91], v[104:107], v[156:159]
s_waitcnt lgkmcnt(6)
v_exp_f32 v11, v67
v_mfma_f32_16x16x32_bf16 v[160:163], a[96:99], v[96:99], v[160:163]
s_add_u32 m0, s18, 102400
ds_read_b128 a[64:67], v2 offset:16384
v_add_f32 v26, v26, v11
v_mfma_f32_16x16x32_bf16 v[160:163], a[100:103], v[100:103], v[160:163]
buffer_load_dwordx4 v1, s[4:7], s12 offen offset:0 sc1 lds
v_mfma_f32_16x16x32_bf16 v[164:167], a[100:103], v[108:111], v[164:167]
ds_read_b128 a[68:71], v2 offset:17408
v_cvt_pk_bf16_f32 v113, v10, v11
v_mfma_f32_16x16x32_bf16 v[164:167], a[96:99], v[104:107], v[164:167]
s_waitcnt lgkmcnt(7)
v_mfma_f32_16x16x32_bf16 v[168:171], a[104:107], v[96:99], v[168:171]
s_waitcnt lgkmcnt(6)
ds_read_b128 a[72:75], v2 offset:18432
v_mfma_f32_16x16x32_bf16 v[168:171], a[108:111], v[100:103], v[168:171]
buffer_load_dwordx4 v1, s[4:7], s12 offen offset:1024 sc1 lds
v_mfma_f32_16x16x32_bf16 v[172:175], a[108:111], v[108:111], v[172:175]
ds_read_b128 a[76:79], v2 offset:19456
v_mfma_f32_16x16x32_bf16 v[172:175], a[104:107], v[104:107], v[172:175]
s_waitcnt lgkmcnt(7)
v_exp_f32 v12, v68
v_mfma_f32_16x16x32_bf16 v[176:179], a[112:115], v[96:99], v[176:179]
s_waitcnt lgkmcnt(6)
ds_read_b128 a[80:83], v2 offset:20480
v_mfma_f32_16x16x32_bf16 v[176:179], a[116:119], v[100:103], v[176:179]
buffer_load_dwordx4 v1, s[4:7], s12 offen offset:2048 sc1 lds
v_mfma_f32_16x16x32_bf16 v[180:183], a[116:119], v[108:111], v[180:183]
ds_read_b128 a[84:87], v2 offset:21504
v_mfma_f32_16x16x32_bf16 v[180:183], a[112:115], v[104:107], v[180:183]
s_waitcnt lgkmcnt(7)
v_exp_f32 v13, v69
v_mfma_f32_16x16x32_bf16 v[184:187], a[120:123], v[96:99], v[184:187]
s_waitcnt lgkmcnt(6)
ds_read_b128 a[88:91], v2 offset:22528
v_add_f32 v27, v12, v13
v_mfma_f32_16x16x32_bf16 v[184:187], a[124:127], v[100:103], v[184:187]
s_waitcnt lgkmcnt(5)
buffer_load_dwordx4 v1, s[4:7], s12 offen offset:3072 sc1 lds
v_mfma_f32_16x16x32_bf16 v[188:191], a[124:127], v[108:111], v[188:191]
s_add_u32 s12, s12, 28672
ds_read_b128 a[92:95], v2 offset:23552
v_cvt_pk_bf16_f32 v120, v12, v13
v_mfma_f32_16x16x32_bf16 v[188:191], a[120:123], v[104:107], v[188:191]
s_sub_u32 s13, s13, 1
v_exp_f32 v14, v70
v_mfma_f32_16x16x32_bf16 v[192:195], a[64:67], v[96:99], v[192:195]
s_cmp_eq_u32 s13, 0
ds_read_b128 a[96:99], v2 offset:24576
v_add_f32 v27, v27, v14
v_mfma_f32_16x16x32_bf16 v[192:195], a[68:71], v[100:103], v[192:195]
s_cselect_b32 s12, s14, s12
v_mfma_f32_16x16x32_bf16 v[196:199], a[68:71], v[108:111], v[196:199]
s_waitcnt lgkmcnt(6)
s_cselect_b32 s13, s15, s13
ds_read_b128 a[100:103], v2 offset:25600
v_mfma_f32_16x16x32_bf16 v[196:199], a[64:67], v[104:107], v[196:199]
s_cselect_b32 s14, 3221225472, s14
v_exp_f32 v15, v71
v_mfma_f32_16x16x32_bf16 v[200:203], a[72:75], v[96:99], v[200:203]
s_waitcnt lgkmcnt(6)
ds_read_b128 a[104:107], v2 offset:26624
v_add_f32 v27, v27, v15
v_mfma_f32_16x16x32_bf16 v[200:203], a[76:79], v[100:103], v[200:203]
v_exp_f32 v8, v72
v_mfma_f32_16x16x32_bf16 v[204:207], a[76:79], v[108:111], v[204:207]
ds_read_b128 a[108:111], v2 offset:27648
v_cvt_pk_bf16_f32 v121, v14, v15
v_mfma_f32_16x16x32_bf16 v[204:207], a[72:75], v[104:107], v[204:207]
s_waitcnt lgkmcnt(7)
v_exp_f32 v9, v73
v_mfma_f32_16x16x32_bf16 v[208:211], a[80:83], v[96:99], v[208:211]
s_waitcnt lgkmcnt(6)
ds_read_b128 a[112:115], v2 offset:28672
v_add_f32 v26, v26, v8
v_mfma_f32_16x16x32_bf16 v[208:211], a[84:87], v[100:103], v[208:211]
v_add_f32 v26, v26, v9
v_cvt_pk_bf16_f32 v114, v8, v9
v_mfma_f32_16x16x32_bf16 v[212:215], a[84:87], v[108:111], v[212:215]
ds_read_b128 a[116:119], v2 offset:29696
v_mfma_f32_16x16x32_bf16 v[212:215], a[80:83], v[104:107], v[212:215]
s_waitcnt lgkmcnt(7)
v_exp_f32 v10, v74
v_mfma_f32_16x16x32_bf16 v[216:219], a[88:91], v[96:99], v[216:219]
s_waitcnt lgkmcnt(6)
ds_read_b128 a[120:123], v2 offset:30720
v_add_f32 v26, v26, v10
v_mfma_f32_16x16x32_bf16 v[216:219], a[92:95], v[100:103], v[216:219]
v_exp_f32 v11, v75
v_mfma_f32_16x16x32_bf16 v[220:223], a[92:95], v[108:111], v[220:223]
ds_read_b128 a[124:127], v2 offset:31744
v_add_f32 v26, v26, v11
v_mfma_f32_16x16x32_bf16 v[220:223], a[88:91], v[104:107], v[220:223]
s_waitcnt vmcnt(8) lgkmcnt(7)
s_barrier
v_cvt_pk_bf16_f32 v115, v10, v11
v_mfma_f32_16x16x32_bf16 v[224:227], a[96:99], v[96:99], v[224:227]
s_waitcnt lgkmcnt(6)
ds_read_b128 a[64:67], v1 offset:0
v_mfma_f32_16x16x32_bf16 v[224:227], a[100:103], v[100:103], v[224:227]
v_exp_f32 v12, v76
v_mfma_f32_16x16x32_bf16 v[228:231], a[100:103], v[108:111], v[228:231]
ds_read_b128 a[68:71], v1 offset:1024
v_add_f32 v27, v27, v12
v_mfma_f32_16x16x32_bf16 v[228:231], a[96:99], v[104:107], v[228:231]
s_waitcnt lgkmcnt(7)
v_mfma_f32_16x16x32_bf16 v[232:235], a[104:107], v[96:99], v[232:235]
s_waitcnt lgkmcnt(6)
ds_read_b128 a[72:75], v1 offset:2048
v_mfma_f32_16x16x32_bf16 v[232:235], a[108:111], v[100:103], v[232:235]
v_exp_f32 v13, v77
v_mfma_f32_16x16x32_bf16 v[236:239], a[108:111], v[108:111], v[236:239]
ds_read_b128 a[76:79], v1 offset:3072
v_add_f32 v27, v27, v13
v_mfma_f32_16x16x32_bf16 v[236:239], a[104:107], v[104:107], v[236:239]
s_waitcnt lgkmcnt(7)
v_exp_f32 v14, v78
v_mfma_f32_16x16x32_bf16 v[240:243], a[112:115], v[96:99], v[240:243]
s_waitcnt lgkmcnt(6)
ds_read_b128 a[80:83], v1 offset:4096
v_cvt_pk_bf16_f32 v122, v12, v13
v_mfma_f32_16x16x32_bf16 v[240:243], a[116:119], v[100:103], v[240:243]
v_exp_f32 v15, v79
v_mfma_f32_16x16x32_bf16 v[244:247], a[116:119], v[108:111], v[244:247]
ds_read_b128 a[84:87], v1 offset:5120
v_add_f32 v27, v27, v14
v_mfma_f32_16x16x32_bf16 v[244:247], a[112:115], v[104:107], v[244:247]
s_waitcnt lgkmcnt(7)
v_add_f32 v27, v27, v15
v_cvt_pk_bf16_f32 v123, v14, v15
v_mfma_f32_16x16x32_bf16 v[248:251], a[120:123], v[96:99], v[248:251]
s_waitcnt lgkmcnt(6)
ds_read_b128 a[88:91], v1 offset:6144
v_mfma_f32_16x16x32_bf16 v[248:251], a[124:127], v[100:103], v[248:251]
v_mfma_f32_16x16x32_bf16 v[252:255], a[124:127], v[108:111], v[252:255]
ds_read_b128 a[92:95], v1 offset:7168
v_mfma_f32_16x16x32_bf16 v[252:255], a[120:123], v[104:107], v[252:255]
s_waitcnt lgkmcnt(7)
v_mfma_f32_16x16x32_bf16 v[32:35], a[64:67], a[0:3], v[16:19]
s_waitcnt lgkmcnt(6)
s_add_u32 m0, s18, 32768
ds_read_b128 a[96:99], v1 offset:8192
v_mfma_f32_16x16x32_bf16 v[32:35], a[68:71], a[4:7], v[32:35]
s_waitcnt lgkmcnt(6)
buffer_load_dwordx4 v1, s[4:7], s8 offen offset:0 sc1 lds
v_mfma_f32_16x16x32_bf16 v[32:35], a[72:75], a[8:11], v[32:35]
s_waitcnt lgkmcnt(5)
ds_read_b128 a[100:103], v1 offset:9216
v_mfma_f32_16x16x32_bf16 v[32:35], a[76:79], a[12:15], v[32:35]
s_waitcnt lgkmcnt(5)
v_exp_f32 v8, v80
v_mfma_f32_16x16x32_bf16 v[32:35], a[80:83], a[16:19], v[32:35]
s_waitcnt lgkmcnt(4)
ds_read_b128 a[104:107], v1 offset:10240
v_add_f32 v26, v26, v8
v_mfma_f32_16x16x32_bf16 v[32:35], a[84:87], a[20:23], v[32:35]
s_waitcnt lgkmcnt(4)
buffer_load_dwordx4 v1, s[4:7], s8 offen offset:1024 sc1 lds
v_mfma_f32_16x16x32_bf16 v[32:35], a[88:91], a[24:27], v[32:35]
s_waitcnt lgkmcnt(3)
ds_read_b128 a[108:111], v1 offset:11264
v_mfma_f32_16x16x32_bf16 v[32:35], a[92:95], a[28:31], v[32:35]
v_exp_f32 v9, v81
v_mfma_f32_16x16x32_bf16 v[36:39], a[64:67], a[32:35], v[20:23]
ds_read_b128 a[112:115], v1 offset:12288
v_add_f32 v26, v26, v9
v_mfma_f32_16x16x32_bf16 v[36:39], a[68:71], a[36:39], v[36:39]
buffer_load_dwordx4 v1, s[4:7], s8 offen offset:2048 sc1 lds
v_mfma_f32_16x16x32_bf16 v[36:39], a[72:75], a[40:43], v[36:39]
ds_read_b128 a[116:119], v1 offset:13312
v_cvt_pk_bf16_f32 v116, v8, v9
v_mfma_f32_16x16x32_bf16 v[36:39], a[76:79], a[44:47], v[36:39]
v_exp_f32 v10, v82
v_mfma_f32_16x16x32_bf16 v[36:39], a[80:83], a[48:51], v[36:39]
ds_read_b128 a[120:123], v1 offset:14336
v_add_f32 v26, v26, v10
v_mfma_f32_16x16x32_bf16 v[36:39], a[84:87], a[52:55], v[36:39]
buffer_load_dwordx4 v1, s[4:7], s8 offen offset:3072 sc1 lds
v_mfma_f32_16x16x32_bf16 v[36:39], a[88:91], a[56:59], v[36:39]
s_add_u32 s8, s8, 4096
ds_read_b128 a[124:127], v1 offset:15360
v_mfma_f32_16x16x32_bf16 v[36:39], a[92:95], a[60:63], v[36:39]
s_waitcnt lgkmcnt(6)
v_exp_f32 v11, v83
v_mfma_f32_16x16x32_bf16 v[40:43], a[96:99], a[0:3], v[16:19]
s_add_u32 m0, s18, 36864
ds_read_b128 a[64:67], v1 offset:16384
v_add_f32 v26, v26, v11
v_mfma_f32_16x16x32_bf16 v[40:43], a[100:103], a[4:7], v[40:43]
s_waitcnt lgkmcnt(6)
buffer_load_dwordx4 v1, s[4:7], s8 offen offset:0 sc1 lds
v_mfma_f32_16x16x32_bf16 v[40:43], a[104:107], a[8:11], v[40:43]
s_waitcnt lgkmcnt(5)
ds_read_b128 a[68:71], v1 offset:17408
v_cvt_pk_bf16_f32 v117, v10, v11
v_mfma_f32_16x16x32_bf16 v[40:43], a[108:111], a[12:15], v[40:43]
s_waitcnt lgkmcnt(5)
v_mfma_f32_16x16x32_bf16 v[40:43], a[112:115], a[16:19], v[40:43]
s_waitcnt lgkmcnt(4)
ds_read_b128 a[72:75], v1 offset:18432
v_mfma_f32_16x16x32_bf16 v[40:43], a[116:119], a[20:23], v[40:43]
s_waitcnt lgkmcnt(4)
buffer_load_dwordx4 v1, s[4:7], s8 offen offset:1024 sc1 lds
v_mfma_f32_16x16x32_bf16 v[40:43], a[120:123], a[24:27], v[40:43]
s_waitcnt lgkmcnt(3)
ds_read_b128 a[76:79], v1 offset:19456
v_mfma_f32_16x16x32_bf16 v[40:43], a[124:127], a[28:31], v[40:43]
v_exp_f32 v12, v84
v_mfma_f32_16x16x32_bf16 v[44:47], a[96:99], a[32:35], v[20:23]
ds_read_b128 a[80:83], v1 offset:20480
v_add_f32 v27, v27, v12
v_mfma_f32_16x16x32_bf16 v[44:47], a[100:103], a[36:39], v[44:47]
buffer_load_dwordx4 v1, s[4:7], s8 offen offset:2048 sc1 lds
v_mfma_f32_16x16x32_bf16 v[44:47], a[104:107], a[40:43], v[44:47]
ds_read_b128 a[84:87], v1 offset:21504
v_mfma_f32_16x16x32_bf16 v[44:47], a[108:111], a[44:47], v[44:47]
v_exp_f32 v13, v85
v_mfma_f32_16x16x32_bf16 v[44:47], a[112:115], a[48:51], v[44:47]
ds_read_b128 a[88:91], v1 offset:22528
v_add_f32 v27, v27, v13
v_mfma_f32_16x16x32_bf16 v[44:47], a[116:119], a[52:55], v[44:47]
s_waitcnt lgkmcnt(3)
buffer_load_dwordx4 v1, s[4:7], s8 offen offset:3072 sc1 lds
v_mfma_f32_16x16x32_bf16 v[44:47], a[120:123], a[56:59], v[44:47]
s_add_u32 s8, s8, 28672
ds_read_b128 a[92:95], v1 offset:23552
v_cvt_pk_bf16_f32 v124, v12, v13
v_mfma_f32_16x16x32_bf16 v[44:47], a[124:127], a[60:63], v[44:47]
s_sub_u32 s9, s9, 1
v_exp_f32 v14, v86
v_mfma_f32_16x16x32_bf16 v[48:51], a[64:67], a[0:3], v[16:19]
s_cmp_eq_u32 s9, 0
ds_read_b128 a[96:99], v1 offset:24576
v_add_f32 v27, v27, v14
v_mfma_f32_16x16x32_bf16 v[48:51], a[68:71], a[4:7], v[48:51]
s_cselect_b32 s8, s10, s8
v_exp_f32 v15, v87
v_mfma_f32_16x16x32_bf16 v[48:51], a[72:75], a[8:11], v[48:51]
s_cselect_b32 s9, s11, s9
ds_read_b128 a[100:103], v1 offset:25600
v_add_f32 v27, v27, v15
v_mfma_f32_16x16x32_bf16 v[48:51], a[76:79], a[12:15], v[48:51]
s_waitcnt lgkmcnt(5)
s_cselect_b32 s10, 3221225472, s10
v_cvt_pk_bf16_f32 v125, v14, v15
v_mfma_f32_16x16x32_bf16 v[48:51], a[80:83], a[16:19], v[48:51]
s_waitcnt lgkmcnt(4)
ds_read_b128 a[104:107], v1 offset:26624
v_mfma_f32_16x16x32_bf16 v[48:51], a[84:87], a[20:23], v[48:51]
s_waitcnt lgkmcnt(4)
v_exp_f32 v8, v88
v_mfma_f32_16x16x32_bf16 v[48:51], a[88:91], a[24:27], v[48:51]
s_waitcnt lgkmcnt(3)
ds_read_b128 a[108:111], v1 offset:27648
v_add_f32 v26, v26, v8
v_mfma_f32_16x16x32_bf16 v[48:51], a[92:95], a[28:31], v[48:51]
v_exp_f32 v9, v89
v_mfma_f32_16x16x32_bf16 v[52:55], a[64:67], a[32:35], v[20:23]
ds_read_b128 a[112:115], v1 offset:28672
v_add_f32 v26, v26, v9
v_mfma_f32_16x16x32_bf16 v[52:55], a[68:71], a[36:39], v[52:55]
v_exp_f32 v10, v90
v_mfma_f32_16x16x32_bf16 v[52:55], a[72:75], a[40:43], v[52:55]
ds_read_b128 a[116:119], v1 offset:29696
v_cvt_pk_bf16_f32 v118, v8, v9
v_mfma_f32_16x16x32_bf16 v[52:55], a[76:79], a[44:47], v[52:55]
v_exp_f32 v11, v91
v_mfma_f32_16x16x32_bf16 v[52:55], a[80:83], a[48:51], v[52:55]
ds_read_b128 a[120:123], v1 offset:30720
v_add_f32 v26, v26, v10
v_mfma_f32_16x16x32_bf16 v[52:55], a[84:87], a[52:55], v[52:55]
v_add_f32 v26, v26, v11
v_cvt_pk_bf16_f32 v119, v10, v11
v_mfma_f32_16x16x32_bf16 v[52:55], a[88:91], a[56:59], v[52:55]
ds_read_b128 a[124:127], v1 offset:31744
v_mfma_f32_16x16x32_bf16 v[52:55], a[92:95], a[60:63], v[52:55]
s_waitcnt vmcnt(8) lgkmcnt(7)
s_barrier
v_mfma_f32_16x16x32_bf16 v[56:59], a[96:99], a[0:3], v[16:19]
s_waitcnt lgkmcnt(6)
ds_read_b128 a[64:67], v2 offset:32768
v_mfma_f32_16x16x32_bf16 v[56:59], a[100:103], a[4:7], v[56:59]
s_waitcnt lgkmcnt(6)
v_exp_f32 v12, v92
v_mfma_f32_16x16x32_bf16 v[56:59], a[104:107], a[8:11], v[56:59]
s_waitcnt lgkmcnt(5)
ds_read_b128 a[68:71], v2 offset:33792
v_add_f32 v27, v27, v12
v_mfma_f32_16x16x32_bf16 v[56:59], a[108:111], a[12:15], v[56:59]
s_waitcnt lgkmcnt(5)
v_exp_f32 v13, v93
v_mfma_f32_16x16x32_bf16 v[56:59], a[112:115], a[16:19], v[56:59]
s_waitcnt lgkmcnt(4)
ds_read_b128 a[72:75], v2 offset:34816
v_add_f32 v27, v27, v13
v_mfma_f32_16x16x32_bf16 v[56:59], a[116:119], a[20:23], v[56:59]
s_waitcnt lgkmcnt(4)
v_exp_f32 v14, v94
v_mfma_f32_16x16x32_bf16 v[56:59], a[120:123], a[24:27], v[56:59]
s_waitcnt lgkmcnt(3)
ds_read_b128 a[76:79], v2 offset:35840
v_cvt_pk_bf16_f32 v126, v12, v13
v_mfma_f32_16x16x32_bf16 v[56:59], a[124:127], a[28:31], v[56:59]
v_exp_f32 v15, v95
v_mfma_f32_16x16x32_bf16 v[60:63], a[96:99], a[32:35], v[20:23]
ds_read_b128 a[80:83], v2 offset:36864
v_add_f32 v27, v27, v14
v_mfma_f32_16x16x32_bf16 v[60:63], a[100:103], a[36:39], v[60:63]
v_add_f32 v27, v27, v15
v_cvt_pk_bf16_f32 v127, v14, v15
v_mfma_f32_16x16x32_bf16 v[60:63], a[104:107], a[40:43], v[60:63]
ds_read_b128 a[84:87], v2 offset:37888
v_add_f32 v28, v26, v27
v_mfma_f32_16x16x32_bf16 v[60:63], a[108:111], a[44:47], v[60:63]
v_cmp_nge_f32 vcc, s25, v28
v_mfma_f32_16x16x32_bf16 v[60:63], a[112:115], a[48:51], v[60:63]
ds_read_b128 a[88:91], v2 offset:38912
v_mfma_f32_16x16x32_bf16 v[60:63], a[116:119], a[52:55], v[60:63]
v_mfma_f32_16x16x32_bf16 v[60:63], a[120:123], a[56:59], v[60:63]
ds_read_b128 a[92:95], v2 offset:39936
v_mfma_f32_16x16x32_bf16 v[60:63], a[124:127], a[60:63], v[60:63]
s_waitcnt lgkmcnt(6)
s_cbranch_vccnz Lstub_3
Lback_4:
v_mfma_f32_16x16x32_bf16 v[128:131], a[64:67], v[112:115], v[128:131]
s_add_u32 m0, s18, 65536
ds_read_b128 a[96:99], v2 offset:40960
v_add_f32 v24, v24, v26
v_mfma_f32_16x16x32_bf16 v[128:131], a[68:71], v[116:119], v[128:131]
buffer_load_dwordx4 v1, s[4:7], s12 offen offset:0 sc1 lds
v_mfma_f32_16x16x32_bf16 v[132:135], a[68:71], v[124:127], v[132:135]
ds_read_b128 a[100:103], v2 offset:41984
v_add_f32 v25, v25, v27
v_mfma_f32_16x16x32_bf16 v[132:135], a[64:67], v[120:123], v[132:135]
s_waitcnt lgkmcnt(7)
v_exp_f32 v8, v32
v_mfma_f32_16x16x32_bf16 v[136:139], a[72:75], v[112:115], v[136:139]
s_waitcnt lgkmcnt(6)
ds_read_b128 a[104:107], v2 offset:43008
v_mfma_f32_16x16x32_bf16 v[136:139], a[76:79], v[116:119], v[136:139]
buffer_load_dwordx4 v1, s[4:7], s12 offen offset:1024 sc1 lds
v_mfma_f32_16x16x32_bf16 v[140:143], a[76:79], v[124:127], v[140:143]
ds_read_b128 a[108:111], v2 offset:44032
v_mfma_f32_16x16x32_bf16 v[140:143], a[72:75], v[120:123], v[140:143]
s_waitcnt lgkmcnt(7)
v_exp_f32 v9, v33
v_mfma_f32_16x16x32_bf16 v[144:147], a[80:83], v[112:115], v[144:147]
s_waitcnt lgkmcnt(6)
ds_read_b128 a[112:115], v2 offset:45056
v_add_f32 v26, v8, v9
v_mfma_f32_16x16x32_bf16 v[144:147], a[84:87], v[116:119], v[144:147]
buffer_load_dwordx4 v1, s[4:7], s12 offen offset:2048 sc1 lds
v_mfma_f32_16x16x32_bf16 v[148:151], a[84:87], v[124:127], v[148:151]
ds_read_b128 a[116:119], v2 offset:46080
v_cvt_pk_bf16_f32 v96, v8, v9
v_mfma_f32_16x16x32_bf16 v[148:151], a[80:83], v[120:123], v[148:151]
s_waitcnt lgkmcnt(7)
v_exp_f32 v10, v34
v_mfma_f32_16x16x32_bf16 v[152:155], a[88:91], v[112:115], v[152:155]
s_waitcnt lgkmcnt(6)
ds_read_b128 a[120:123], v2 offset:47104
v_add_f32 v26, v26, v10
v_mfma_f32_16x16x32_bf16 v[152:155], a[92:95], v[116:119], v[152:155]
buffer_load_dwordx4 v1, s[4:7], s12 offen offset:3072 sc1 lds
v_mfma_f32_16x16x32_bf16 v[156:159], a[92:95], v[124:127], v[156:159]
s_add_u32 s12, s12, 4096
ds_read_b128 a[124:127], v2 offset:48128
v_mfma_f32_16x16x32_bf16 v[156:159], a[88:91], v[120:123], v[156:159]
s_waitcnt lgkmcnt(6)
v_exp_f32 v11, v35
v_mfma_f32_16x16x32_bf16 v[160:163], a[96:99], v[112:115], v[160:163]
s_add_u32 m0, s18, 69632
ds_read_b128 a[64:67], v2 offset:49152
v_add_f32 v26, v26, v11
v_mfma_f32_16x16x32_bf16 v[160:163], a[100:103], v[116:119], v[160:163]
buffer_load_dwordx4 v1, s[4:7], s12 offen offset:0 sc1 lds
v_mfma_f32_16x16x32_bf16 v[164:167], a[100:103], v[124:127], v[164:167]
ds_read_b128 a[68:71], v2 offset:50176
v_cvt_pk_bf16_f32 v97, v10, v11
v_mfma_f32_16x16x32_bf16 v[164:167], a[96:99], v[120:123], v[164:167]
s_waitcnt lgkmcnt(7)
v_mfma_f32_16x16x32_bf16 v[168:171], a[104:107], v[112:115], v[168:171]
s_waitcnt lgkmcnt(6)
ds_read_b128 a[72:75], v2 offset:51200
v_mfma_f32_16x16x32_bf16 v[168:171], a[108:111], v[116:119], v[168:171]
buffer_load_dwordx4 v1, s[4:7], s12 offen offset:1024 sc1 lds
v_mfma_f32_16x16x32_bf16 v[172:175], a[108:111], v[124:127], v[172:175]
ds_read_b128 a[76:79], v2 offset:52224
v_mfma_f32_16x16x32_bf16 v[172:175], a[104:107], v[120:123], v[172:175]
s_waitcnt lgkmcnt(7)
v_exp_f32 v12, v36
v_mfma_f32_16x16x32_bf16 v[176:179], a[112:115], v[112:115], v[176:179]
s_waitcnt lgkmcnt(6)
ds_read_b128 a[80:83], v2 offset:53248
v_mfma_f32_16x16x32_bf16 v[176:179], a[116:119], v[116:119], v[176:179]
buffer_load_dwordx4 v1, s[4:7], s12 offen offset:2048 sc1 lds
v_mfma_f32_16x16x32_bf16 v[180:183], a[116:119], v[124:127], v[180:183]
ds_read_b128 a[84:87], v2 offset:54272
v_mfma_f32_16x16x32_bf16 v[180:183], a[112:115], v[120:123], v[180:183]
s_waitcnt lgkmcnt(7)
v_exp_f32 v13, v37
v_mfma_f32_16x16x32_bf16 v[184:187], a[120:123], v[112:115], v[184:187]
s_waitcnt lgkmcnt(6)
ds_read_b128 a[88:91], v2 offset:55296
v_add_f32 v27, v12, v13
v_mfma_f32_16x16x32_bf16 v[184:187], a[124:127], v[116:119], v[184:187]
s_waitcnt lgkmcnt(5)
buffer_load_dwordx4 v1, s[4:7], s12 offen offset:3072 sc1 lds
v_mfma_f32_16x16x32_bf16 v[188:191], a[124:127], v[124:127], v[188:191]
s_add_u32 s12, s12, 28672
ds_read_b128 a[92:95], v2 offset:56320
v_cvt_pk_bf16_f32 v104, v12, v13
v_mfma_f32_16x16x32_bf16 v[188:191], a[120:123], v[120:123], v[188:191]
s_sub_u32 s13, s13, 1
v_exp_f32 v14, v38
v_mfma_f32_16x16x32_bf16 v[192:195], a[64:67], v[112:115], v[192:195]
s_cmp_eq_u32 s13, 0
ds_read_b128 a[96:99], v2 offset:57344
v_add_f32 v27, v27, v14
v_mfma_f32_16x16x32_bf16 v[192:195], a[68:71], v[116:119], v[192:195]
s_cselect_b32 s12, s14, s12
v_mfma_f32_16x16x32_bf16 v[196:199], a[68:71], v[124:127], v[196:199]
s_waitcnt lgkmcnt(6)
s_cselect_b32 s13, s15, s13
ds_read_b128 a[100:103], v2 offset:58368
v_mfma_f32_16x16x32_bf16 v[196:199], a[64:67], v[120:123], v[196:199]
s_cselect_b32 s14, 3221225472, s14
v_exp_f32 v15, v39
v_mfma_f32_16x16x32_bf16 v[200:203], a[72:75], v[112:115], v[200:203]
s_waitcnt lgkmcnt(6)
ds_read_b128 a[104:107], v2 offset:59392
v_add_f32 v27, v27, v15
v_mfma_f32_16x16x32_bf16 v[200:203], a[76:79], v[116:119], v[200:203]
v_exp_f32 v8, v40
v_mfma_f32_16x16x32_bf16 v[204:207], a[76:79], v[124:127], v[204:207]
ds_read_b128 a[108:111], v2 offset:60416
v_cvt_pk_bf16_f32 v105, v14, v15
v_mfma_f32_16x16x32_bf16 v[204:207], a[72:75], v[120:123], v[204:207]
s_waitcnt lgkmcnt(7)
v_exp_f32 v9, v41
v_mfma_f32_16x16x32_bf16 v[208:211], a[80:83], v[112:115], v[208:211]
s_waitcnt lgkmcnt(6)
ds_read_b128 a[112:115], v2 offset:61440
v_add_f32 v26, v26, v8
v_mfma_f32_16x16x32_bf16 v[208:211], a[84:87], v[116:119], v[208:211]
v_add_f32 v26, v26, v9
v_cvt_pk_bf16_f32 v98, v8, v9
v_mfma_f32_16x16x32_bf16 v[212:215], a[84:87], v[124:127], v[212:215]
ds_read_b128 a[116:119], v2 offset:62464
v_mfma_f32_16x16x32_bf16 v[212:215], a[80:83], v[120:123], v[212:215]
s_waitcnt lgkmcnt(7)
v_exp_f32 v10, v42
v_mfma_f32_16x16x32_bf16 v[216:219], a[88:91], v[112:115], v[216:219]
s_waitcnt lgkmcnt(6)
ds_read_b128 a[120:123], v2 offset:63488
v_add_f32 v26, v26, v10
v_mfma_f32_16x16x32_bf16 v[216:219], a[92:95], v[116:119], v[216:219]
v_exp_f32 v11, v43
v_mfma_f32_16x16x32_bf16 v[220:223], a[92:95], v[124:127], v[220:223]
ds_read_b128 a[124:127], v2 offset:64512
v_add_f32 v26, v26, v11
v_mfma_f32_16x16x32_bf16 v[220:223], a[88:91], v[120:123], v[220:223]
s_waitcnt vmcnt(8) lgkmcnt(7)
s_barrier
v_cvt_pk_bf16_f32 v99, v10, v11
v_mfma_f32_16x16x32_bf16 v[224:227], a[96:99], v[112:115], v[224:227]
s_waitcnt lgkmcnt(6)
ds_read_b128 a[64:67], v1 offset:32768
v_mfma_f32_16x16x32_bf16 v[224:227], a[100:103], v[116:119], v[224:227]
v_exp_f32 v12, v44
v_mfma_f32_16x16x32_bf16 v[228:231], a[100:103], v[124:127], v[228:231]
ds_read_b128 a[68:71], v1 offset:33792
v_add_f32 v27, v27, v12
v_mfma_f32_16x16x32_bf16 v[228:231], a[96:99], v[120:123], v[228:231]
s_waitcnt lgkmcnt(7)
v_mfma_f32_16x16x32_bf16 v[232:235], a[104:107], v[112:115], v[232:235]
s_waitcnt lgkmcnt(6)
ds_read_b128 a[72:75], v1 offset:34816
v_mfma_f32_16x16x32_bf16 v[232:235], a[108:111], v[116:119], v[232:235]
v_exp_f32 v13, v45
v_mfma_f32_16x16x32_bf16 v[236:239], a[108:111], v[124:127], v[236:239]
ds_read_b128 a[76:79], v1 offset:35840
v_add_f32 v27, v27, v13
v_mfma_f32_16x16x32_bf16 v[236:239], a[104:107], v[120:123], v[236:239]
s_waitcnt lgkmcnt(7)
v_exp_f32 v14, v46
v_mfma_f32_16x16x32_bf16 v[240:243], a[112:115], v[112:115], v[240:243]
s_waitcnt lgkmcnt(6)
ds_read_b128 a[80:83], v1 offset:36864
v_cvt_pk_bf16_f32 v106, v12, v13
v_mfma_f32_16x16x32_bf16 v[240:243], a[116:119], v[116:119], v[240:243]
v_exp_f32 v15, v47
v_mfma_f32_16x16x32_bf16 v[244:247], a[116:119], v[124:127], v[244:247]
ds_read_b128 a[84:87], v1 offset:37888
v_add_f32 v27, v27, v14
v_mfma_f32_16x16x32_bf16 v[244:247], a[112:115], v[120:123], v[244:247]
s_waitcnt lgkmcnt(7)
v_add_f32 v27, v27, v15
v_cvt_pk_bf16_f32 v107, v14, v15
v_mfma_f32_16x16x32_bf16 v[248:251], a[120:123], v[112:115], v[248:251]
s_waitcnt lgkmcnt(6)
ds_read_b128 a[88:91], v1 offset:38912
v_mfma_f32_16x16x32_bf16 v[248:251], a[124:127], v[116:119], v[248:251]
v_mfma_f32_16x16x32_bf16 v[252:255], a[124:127], v[124:127], v[252:255]
ds_read_b128 a[92:95], v1 offset:39936
v_mfma_f32_16x16x32_bf16 v[252:255], a[120:123], v[120:123], v[252:255]
s_waitcnt lgkmcnt(7)
K2_x1:
v_mfma_f32_16x16x32_bf16 v[64:67], a[64:67], a[0:3], v[16:19]
s_waitcnt lgkmcnt(6)
s_add_u32 m0, s18, 0
ds_read_b128 a[96:99], v1 offset:40960
v_mfma_f32_16x16x32_bf16 v[64:67], a[68:71], a[4:7], v[64:67]
s_waitcnt lgkmcnt(6)
buffer_load_dwordx4 v1, s[4:7], s8 offen offset:0 sc1 lds
v_mfma_f32_16x16x32_bf16 v[64:67], a[72:75], a[8:11], v[64:67]
s_waitcnt lgkmcnt(5)
ds_read_b128 a[100:103], v1 offset:41984
v_mfma_f32_16x16x32_bf16 v[64:67], a[76:79], a[12:15], v[64:67]
s_waitcnt lgkmcnt(5)
v_exp_f32 v8, v48
v_mfma_f32_16x16x32_bf16 v[64:67], a[80:83], a[16:19], v[64:67]
s_waitcnt lgkmcnt(4)
ds_read_b128 a[104:107], v1 offset:43008
v_add_f32 v26, v26, v8
v_mfma_f32_16x16x32_bf16 v[64:67], a[84:87], a[20:23], v[64:67]
s_waitcnt lgkmcnt(4)
buffer_load_dwordx4 v1, s[4:7], s8 offen offset:1024 sc1 lds
v_mfma_f32_16x16x32_bf16 v[64:67], a[88:91], a[24:27], v[64:67]
s_waitcnt lgkmcnt(3)
ds_read_b128 a[108:111], v1 offset:44032
v_mfma_f32_16x16x32_bf16 v[64:67], a[92:95], a[28:31], v[64:67]
v_exp_f32 v9, v49
v_mfma_f32_16x16x32_bf16 v[68:71], a[64:67], a[32:35], v[20:23]
ds_read_b128 a[112:115], v1 offset:45056
v_add_f32 v26, v26, v9
v_mfma_f32_16x16x32_bf16 v[68:71], a[68:71], a[36:39], v[68:71]
buffer_load_dwordx4 v1, s[4:7], s8 offen offset:2048 sc1 lds
v_mfma_f32_16x16x32_bf16 v[68:71], a[72:75], a[40:43], v[68:71]
ds_read_b128 a[116:119], v1 offset:46080
v_cvt_pk_bf16_f32 v100, v8, v9
v_mfma_f32_16x16x32_bf16 v[68:71], a[76:79], a[44:47], v[68:71]
v_exp_f32 v10, v50
v_mfma_f32_16x16x32_bf16 v[68:71], a[80:83], a[48:51], v[68:71]
ds_read_b128 a[120:123], v1 offset:47104
v_add_f32 v26, v26, v10
v_mfma_f32_16x16x32_bf16 v[68:71], a[84:87], a[52:55], v[68:71]
buffer_load_dwordx4 v1, s[4:7], s8 offen offset:3072 sc1 lds
v_mfma_f32_16x16x32_bf16 v[68:71], a[88:91], a[56:59], v[68:71]
s_add_u32 s8, s8, 4096
ds_read_b128 a[124:127], v1 offset:48128
v_mfma_f32_16x16x32_bf16 v[68:71], a[92:95], a[60:63], v[68:71]
s_waitcnt lgkmcnt(6)
v_exp_f32 v11, v51
v_mfma_f32_16x16x32_bf16 v[72:75], a[96:99], a[0:3], v[16:19]
s_add_u32 m0, s18, 4096
ds_read_b128 a[64:67], v1 offset:49152
v_add_f32 v26, v26, v11
v_mfma_f32_16x16x32_bf16 v[72:75], a[100:103], a[4:7], v[72:75]
s_waitcnt lgkmcnt(6)
buffer_load_dwordx4 v1, s[4:7], s8 offen offset:0 sc1 lds
v_mfma_f32_16x16x32_bf16 v[72:75], a[104:107], a[8:11], v[72:75]
s_waitcnt lgkmcnt(5)
ds_read_b128 a[68:71], v1 offset:50176
v_cvt_pk_bf16_f32 v101, v10, v11
v_mfma_f32_16x16x32_bf16 v[72:75], a[108:111], a[12:15], v[72:75]
s_waitcnt lgkmcnt(5)
v_mfma_f32_16x16x32_bf16 v[72:75], a[112:115], a[16:19], v[72:75]
s_waitcnt lgkmcnt(4)
ds_read_b128 a[72:75], v1 offset:51200
v_mfma_f32_16x16x32_bf16 v[72:75], a[116:119], a[20:23], v[72:75]
s_waitcnt lgkmcnt(4)
buffer_load_dwordx4 v1, s[4:7], s8 offen offset:1024 sc1 lds
v_mfma_f32_16x16x32_bf16 v[72:75], a[120:123], a[24:27], v[72:75]
s_waitcnt lgkmcnt(3)
ds_read_b128 a[76:79], v1 offset:52224
v_mfma_f32_16x16x32_bf16 v[72:75], a[124:127], a[28:31], v[72:75]
v_exp_f32 v12, v52
v_mfma_f32_16x16x32_bf16 v[76:79], a[96:99], a[32:35], v[20:23]
ds_read_b128 a[80:83], v1 offset:53248
v_add_f32 v27, v27, v12
v_mfma_f32_16x16x32_bf16 v[76:79], a[100:103], a[36:39], v[76:79]
buffer_load_dwordx4 v1, s[4:7], s8 offen offset:2048 sc1 lds
v_mfma_f32_16x16x32_bf16 v[76:79], a[104:107], a[40:43], v[76:79]
ds_read_b128 a[84:87], v1 offset:54272
v_mfma_f32_16x16x32_bf16 v[76:79], a[108:111], a[44:47], v[76:79]
v_exp_f32 v13, v53
v_mfma_f32_16x16x32_bf16 v[76:79], a[112:115], a[48:51], v[76:79]
ds_read_b128 a[88:91], v1 offset:55296
v_add_f32 v27, v27, v13
v_mfma_f32_16x16x32_bf16 v[76:79], a[116:119], a[52:55], v[76:79]
s_waitcnt lgkmcnt(3)
buffer_load_dwordx4 v1, s[4:7], s8 offen offset:3072 sc1 lds
v_mfma_f32_16x16x32_bf16 v[76:79], a[120:123], a[56:59], v[76:79]
s_add_u32 s8, s8, 28672
ds_read_b128 a[92:95], v1 offset:56320
v_cvt_pk_bf16_f32 v108, v12, v13
v_mfma_f32_16x16x32_bf16 v[76:79], a[124:127], a[60:63], v[76:79]
s_sub_u32 s9, s9, 1
v_exp_f32 v14, v54
v_mfma_f32_16x16x32_bf16 v[80:83], a[64:67], a[0:3], v[16:19]
s_cmp_eq_u32 s9, 0
ds_read_b128 a[96:99], v1 offset:57344
v_add_f32 v27, v27, v14
v_mfma_f32_16x16x32_bf16 v[80:83], a[68:71], a[4:7], v[80:83]
s_cselect_b32 s8, s10, s8
v_exp_f32 v15, v55
v_mfma_f32_16x16x32_bf16 v[80:83], a[72:75], a[8:11], v[80:83]
s_cselect_b32 s9, s11, s9
ds_read_b128 a[100:103], v1 offset:58368
v_add_f32 v27, v27, v15
v_mfma_f32_16x16x32_bf16 v[80:83], a[76:79], a[12:15], v[80:83]
s_waitcnt lgkmcnt(5)
s_cselect_b32 s10, 3221225472, s10
v_cvt_pk_bf16_f32 v109, v14, v15
v_mfma_f32_16x16x32_bf16 v[80:83], a[80:83], a[16:19], v[80:83]
s_waitcnt lgkmcnt(4)
ds_read_b128 a[104:107], v1 offset:59392
v_mfma_f32_16x16x32_bf16 v[80:83], a[84:87], a[20:23], v[80:83]
s_waitcnt lgkmcnt(4)
v_exp_f32 v8, v56
v_mfma_f32_16x16x32_bf16 v[80:83], a[88:91], a[24:27], v[80:83]
s_waitcnt lgkmcnt(3)
ds_read_b128 a[108:111], v1 offset:60416
v_add_f32 v26, v26, v8
v_mfma_f32_16x16x32_bf16 v[80:83], a[92:95], a[28:31], v[80:83]
v_exp_f32 v9, v57
v_mfma_f32_16x16x32_bf16 v[84:87], a[64:67], a[32:35], v[20:23]
ds_read_b128 a[112:115], v1 offset:61440
v_add_f32 v26, v26, v9
v_mfma_f32_16x16x32_bf16 v[84:87], a[68:71], a[36:39], v[84:87]
v_exp_f32 v10, v58
v_mfma_f32_16x16x32_bf16 v[84:87], a[72:75], a[40:43], v[84:87]
ds_read_b128 a[116:119], v1 offset:62464
v_cvt_pk_bf16_f32 v102, v8, v9
v_mfma_f32_16x16x32_bf16 v[84:87], a[76:79], a[44:47], v[84:87]
v_exp_f32 v11, v59
v_mfma_f32_16x16x32_bf16 v[84:87], a[80:83], a[48:51], v[84:87]
ds_read_b128 a[120:123], v1 offset:63488
v_add_f32 v26, v26, v10
v_mfma_f32_16x16x32_bf16 v[84:87], a[84:87], a[52:55], v[84:87]
v_add_f32 v26, v26, v11
v_cvt_pk_bf16_f32 v103, v10, v11
v_mfma_f32_16x16x32_bf16 v[84:87], a[88:91], a[56:59], v[84:87]
ds_read_b128 a[124:127], v1 offset:64512
v_mfma_f32_16x16x32_bf16 v[84:87], a[92:95], a[60:63], v[84:87]
s_waitcnt vmcnt(8) lgkmcnt(7)
s_barrier
v_mfma_f32_16x16x32_bf16 v[88:91], a[96:99], a[0:3], v[16:19]
s_waitcnt lgkmcnt(6)
ds_read_b128 a[64:67], v2 offset:0
v_mfma_f32_16x16x32_bf16 v[88:91], a[100:103], a[4:7], v[88:91]
s_waitcnt lgkmcnt(6)
v_exp_f32 v12, v60
v_mfma_f32_16x16x32_bf16 v[88:91], a[104:107], a[8:11], v[88:91]
s_waitcnt lgkmcnt(5)
ds_read_b128 a[68:71], v2 offset:1024
v_add_f32 v27, v27, v12
v_mfma_f32_16x16x32_bf16 v[88:91], a[108:111], a[12:15], v[88:91]
s_waitcnt lgkmcnt(5)
v_exp_f32 v13, v61
v_mfma_f32_16x16x32_bf16 v[88:91], a[112:115], a[16:19], v[88:91]
s_waitcnt lgkmcnt(4)
ds_read_b128 a[72:75], v2 offset:2048
v_add_f32 v27, v27, v13
v_mfma_f32_16x16x32_bf16 v[88:91], a[116:119], a[20:23], v[88:91]
s_waitcnt lgkmcnt(4)
v_exp_f32 v14, v62
v_mfma_f32_16x16x32_bf16 v[88:91], a[120:123], a[24:27], v[88:91]
s_waitcnt lgkmcnt(3)
ds_read_b128 a[76:79], v2 offset:3072
v_cvt_pk_bf16_f32 v110, v12, v13
v_mfma_f32_16x16x32_bf16 v[88:91], a[124:127], a[28:31], v[88:91]
v_exp_f32 v15, v63
v_mfma_f32_16x16x32_bf16 v[92:95], a[96:99], a[32:35], v[20:23]
s_sub_u32 s19, s19, 1
ds_read_b128 a[80:83], v2 offset:4096
v_add_f32 v27, v27, v14
v_mfma_f32_16x16x32_bf16 v[92:95], a[100:103], a[36:39], v[92:95]
v_add_f32 v27, v27, v15
v_cvt_pk_bf16_f32 v111, v14, v15
v_mfma_f32_16x16x32_bf16 v[92:95], a[104:107], a[40:43], v[92:95]
ds_read_b128 a[84:87], v2 offset:5120
v_add_f32 v28, v26, v27
v_mfma_f32_16x16x32_bf16 v[92:95], a[108:111], a[44:47], v[92:95]
v_cmp_nge_f32 vcc, s25, v28
v_mfma_f32_16x16x32_bf16 v[92:95], a[112:115], a[48:51], v[92:95]
ds_read_b128 a[88:91], v2 offset:6144
v_mfma_f32_16x16x32_bf16 v[92:95], a[116:119], a[52:55], v[92:95]
v_mfma_f32_16x16x32_bf16 v[92:95], a[120:123], a[56:59], v[92:95]
ds_read_b128 a[92:95], v2 offset:7168
v_mfma_f32_16x16x32_bf16 v[92:95], a[124:127], a[60:63], v[92:95]
s_waitcnt lgkmcnt(6)
s_cbranch_vccnz Lstub_5
Lback_6:
s_cmp_lg_u32 s19, 0
s_cbranch_scc1 K2_loop
s_cmp_eq_u32 s24, 2
s_cbranch_scc1 K2_ntail
v_mfma_f32_16x16x32_bf16 v[128:131], a[64:67], v[96:99], v[128:131]
s_add_u32 m0, s18, 98304
ds_read_b128 a[96:99], v2 offset:8192
v_add_f32 v24, v24, v26
v_mfma_f32_16x16x32_bf16 v[128:131], a[68:71], v[100:103], v[128:131]
buffer_load_dwordx4 v1, s[4:7], s12 offen offset:0 sc1 lds
v_mfma_f32_16x16x32_bf16 v[132:135], a[68:71], v[108:111], v[132:135]
ds_read_b128 a[100:103], v2 offset:9216
v_add_f32 v25, v25, v27
v_mfma_f32_16x16x32_bf16 v[132:135], a[64:67], v[104:107], v[132:135]
s_waitcnt lgkmcnt(7)
v_exp_f32 v8, v64
v_mfma_f32_16x16x32_bf16 v[136:139], a[72:75], v[96:99], v[136:139]
s_waitcnt lgkmcnt(6)
ds_read_b128 a[104:107], v2 offset:10240
v_mfma_f32_16x16x32_bf16 v[136:139], a[76:79], v[100:103], v[136:139]
buffer_load_dwordx4 v1, s[4:7], s12 offen offset:1024 sc1 lds
v_mfma_f32_16x16x32_bf16 v[140:143], a[76:79], v[108:111], v[140:143]
ds_read_b128 a[108:111], v2 offset:11264
v_mfma_f32_16x16x32_bf16 v[140:143], a[72:75], v[104:107], v[140:143]
s_waitcnt lgkmcnt(7)
v_exp_f32 v9, v65
v_mfma_f32_16x16x32_bf16 v[144:147], a[80:83], v[96:99], v[144:147]
s_waitcnt lgkmcnt(6)
ds_read_b128 a[112:115], v2 offset:12288
v_add_f32 v26, v8, v9
v_mfma_f32_16x16x32_bf16 v[144:147], a[84:87], v[100:103], v[144:147]
buffer_load_dwordx4 v1, s[4:7], s12 offen offset:2048 sc1 lds
v_mfma_f32_16x16x32_bf16 v[148:151], a[84:87], v[108:111], v[148:151]
ds_read_b128 a[116:119], v2 offset:13312
v_cvt_pk_bf16_f32 v112, v8, v9
v_mfma_f32_16x16x32_bf16 v[148:151], a[80:83], v[104:107], v[148:151]
s_waitcnt lgkmcnt(7)
v_exp_f32 v10, v66
v_mfma_f32_16x16x32_bf16 v[152:155], a[88:91], v[96:99], v[152:155]
s_waitcnt lgkmcnt(6)
ds_read_b128 a[120:123], v2 offset:14336
v_add_f32 v26, v26, v10
v_mfma_f32_16x16x32_bf16 v[152:155], a[92:95], v[100:103], v[152:155]
buffer_load_dwordx4 v1, s[4:7], s12 offen offset:3072 sc1 lds
v_mfma_f32_16x16x32_bf16 v[156:159], a[92:95], v[108:111], v[156:159]
s_add_u32 s12, s12, 4096
ds_read_b128 a[124:127], v2 offset:15360
v_mfma_f32_16x16x32_bf16 v[156:159], a[88:91], v[104:107], v[156:159]
s_waitcnt lgkmcnt(6)
v_exp_f32 v11, v67
v_mfma_f32_16x16x32_bf16 v[160:163], a[96:99], v[96:99], v[160:163]
s_add_u32 m0, s18, 102400
ds_read_b128 a[64:67], v2 offset:16384
v_add_f32 v26, v26, v11
v_mfma_f32_16x16x32_bf16 v[160:163], a[100:103], v[100:103], v[160:163]
buffer_load_dwordx4 v1, s[4:7], s12 offen offset:0 sc1 lds
v_mfma_f32_16x16x32_bf16 v[164:167], a[100:103], v[108:111], v[164:167]
ds_read_b128 a[68:71], v2 offset:17408
v_cvt_pk_bf16_f32 v113, v10, v11
v_mfma_f32_16x16x32_bf16 v[164:167], a[96:99], v[104:107], v[164:167]
s_waitcnt lgkmcnt(7)
v_mfma_f32_16x16x32_bf16 v[168:171], a[104:107], v[96:99], v[168:171]
s_waitcnt lgkmcnt(6)
ds_read_b128 a[72:75], v2 offset:18432
v_mfma_f32_16x16x32_bf16 v[168:171], a[108:111], v[100:103], v[168:171]
buffer_load_dwordx4 v1, s[4:7], s12 offen offset:1024 sc1 lds
v_mfma_f32_16x16x32_bf16 v[172:175], a[108:111], v[108:111], v[172:175]
ds_read_b128 a[76:79], v2 offset:19456
v_mfma_f32_16x16x32_bf16 v[172:175], a[104:107], v[104:107], v[172:175]
s_waitcnt lgkmcnt(7)
v_exp_f32 v12, v68
v_mfma_f32_16x16x32_bf16 v[176:179], a[112:115], v[96:99], v[176:179]
s_waitcnt lgkmcnt(6)
ds_read_b128 a[80:83], v2 offset:20480
v_mfma_f32_16x16x32_bf16 v[176:179], a[116:119], v[100:103], v[176:179]
buffer_load_dwordx4 v1, s[4:7], s12 offen offset:2048 sc1 lds
v_mfma_f32_16x16x32_bf16 v[180:183], a[116:119], v[108:111], v[180:183]
ds_read_b128 a[84:87], v2 offset:21504
v_mfma_f32_16x16x32_bf16 v[180:183], a[112:115], v[104:107], v[180:183]
s_waitcnt lgkmcnt(7)
v_exp_f32 v13, v69
v_mfma_f32_16x16x32_bf16 v[184:187], a[120:123], v[96:99], v[184:187]
s_waitcnt lgkmcnt(6)
ds_read_b128 a[88:91], v2 offset:22528
v_add_f32 v27, v12, v13
v_mfma_f32_16x16x32_bf16 v[184:187], a[124:127], v[100:103], v[184:187]
s_waitcnt lgkmcnt(5)
buffer_load_dwordx4 v1, s[4:7], s12 offen offset:3072 sc1 lds
v_mfma_f32_16x16x32_bf16 v[188:191], a[124:127], v[108:111], v[188:191]
s_add_u32 s12, s12, 28672
ds_read_b128 a[92:95], v2 offset:23552
v_cvt_pk_bf16_f32 v120, v12, v13
v_mfma_f32_16x16x32_bf16 v[188:191], a[120:123], v[104:107], v[188:191]
s_sub_u32 s13, s13, 1
v_exp_f32 v14, v70
v_mfma_f32_16x16x32_bf16 v[192:195], a[64:67], v[96:99], v[192:195]
s_cmp_eq_u32 s13, 0
ds_read_b128 a[96:99], v2 offset:24576
v_add_f32 v27, v27, v14
v_mfma_f32_16x16x32_bf16 v[192:195], a[68:71], v[100:103], v[192:195]
s_cselect_b32 s12, s14, s12
v_mfma_f32_16x16x32_bf16 v[196:199], a[68:71], v[108:111], v[196:199]
s_waitcnt lgkmcnt(6)
s_cselect_b32 s13, s15, s13
ds_read_b128 a[100:103], v2 offset:25600
v_mfma_f32_16x16x32_bf16 v[196:199], a[64:67], v[104:107], v[196:199]
s_cselect_b32 s14, 3221225472, s14
v_exp_f32 v15, v71
v_mfma_f32_16x16x32_bf16 v[200:203], a[72:75], v[96:99], v[200:203]
s_waitcnt lgkmcnt(6)
ds_read_b128 a[104:107], v2 offset:26624
v_add_f32 v27, v27, v15
v_mfma_f32_16x16x32_bf16 v[200:203], a[76:79], v[100:103], v[200:203]
v_exp_f32 v8, v72
v_mfma_f32_16x16x32_bf16 v[204:207], a[76:79], v[108:111], v[204:207]
ds_read_b128 a[108:111], v2 offset:27648
v_cvt_pk_bf16_f32 v121, v14, v15
v_mfma_f32_16x16x32_bf16 v[204:207], a[72:75], v[104:107], v[204:207]
s_waitcnt lgkmcnt(7)
v_exp_f32 v9, v73
v_mfma_f32_16x16x32_bf16 v[208:211], a[80:83], v[96:99], v[208:211]
s_waitcnt lgkmcnt(6)
ds_read_b128 a[112:115], v2 offset:28672
v_add_f32 v26, v26, v8
v_mfma_f32_16x16x32_bf16 v[208:211], a[84:87], v[100:103], v[208:211]
v_add_f32 v26, v26, v9
v_cvt_pk_bf16_f32 v114, v8, v9
v_mfma_f32_16x16x32_bf16 v[212:215], a[84:87], v[108:111], v[212:215]
ds_read_b128 a[116:119], v2 offset:29696
v_mfma_f32_16x16x32_bf16 v[212:215], a[80:83], v[104:107], v[212:215]
s_waitcnt lgkmcnt(7)
v_exp_f32 v10, v74
v_mfma_f32_16x16x32_bf16 v[216:219], a[88:91], v[96:99], v[216:219]
s_waitcnt lgkmcnt(6)
ds_read_b128 a[120:123], v2 offset:30720
v_add_f32 v26, v26, v10
v_mfma_f32_16x16x32_bf16 v[216:219], a[92:95], v[100:103], v[216:219]
v_exp_f32 v11, v75
v_mfma_f32_16x16x32_bf16 v[220:223], a[92:95], v[108:111], v[220:223]
ds_read_b128 a[124:127], v2 offset:31744
v_add_f32 v26, v26, v11
v_mfma_f32_16x16x32_bf16 v[220:223], a[88:91], v[104:107], v[220:223]
s_waitcnt vmcnt(8) lgkmcnt(7)
s_barrier
v_cvt_pk_bf16_f32 v115, v10, v11
v_mfma_f32_16x16x32_bf16 v[224:227], a[96:99], v[96:99], v[224:227]
s_waitcnt lgkmcnt(6)
ds_read_b128 a[64:67], v1 offset:0
v_mfma_f32_16x16x32_bf16 v[224:227], a[100:103], v[100:103], v[224:227]
v_exp_f32 v12, v76
v_mfma_f32_16x16x32_bf16 v[228:231], a[100:103], v[108:111], v[228:231]
ds_read_b128 a[68:71], v1 offset:1024
v_add_f32 v27, v27, v12
v_mfma_f32_16x16x32_bf16 v[228:231], a[96:99], v[104:107], v[228:231]
s_waitcnt lgkmcnt(7)
v_mfma_f32_16x16x32_bf16 v[232:235], a[104:107], v[96:99], v[232:235]
s_waitcnt lgkmcnt(6)
ds_read_b128 a[72:75], v1 offset:2048
v_mfma_f32_16x16x32_bf16 v[232:235], a[108:111], v[100:103], v[232:235]
v_exp_f32 v13, v77
v_mfma_f32_16x16x32_bf16 v[236:239], a[108:111], v[108:111], v[236:239]
ds_read_b128 a[76:79], v1 offset:3072
v_add_f32 v27, v27, v13
v_mfma_f32_16x16x32_bf16 v[236:239], a[104:107], v[104:107], v[236:239]
s_waitcnt lgkmcnt(7)
v_exp_f32 v14, v78
v_mfma_f32_16x16x32_bf16 v[240:243], a[112:115], v[96:99], v[240:243]
s_waitcnt lgkmcnt(6)
ds_read_b128 a[80:83], v1 offset:4096
v_cvt_pk_bf16_f32 v122, v12, v13
v_mfma_f32_16x16x32_bf16 v[240:243], a[116:119], v[100:103], v[240:243]
v_exp_f32 v15, v79
v_mfma_f32_16x16x32_bf16 v[244:247], a[116:119], v[108:111], v[244:247]
ds_read_b128 a[84:87], v1 offset:5120
v_add_f32 v27, v27, v14
v_mfma_f32_16x16x32_bf16 v[244:247], a[112:115], v[104:107], v[244:247]
s_waitcnt lgkmcnt(7)
v_add_f32 v27, v27, v15
v_cvt_pk_bf16_f32 v123, v14, v15
v_mfma_f32_16x16x32_bf16 v[248:251], a[120:123], v[96:99], v[248:251]
s_waitcnt lgkmcnt(6)
ds_read_b128 a[88:91], v1 offset:6144
v_mfma_f32_16x16x32_bf16 v[248:251], a[124:127], v[100:103], v[248:251]
v_mfma_f32_16x16x32_bf16 v[252:255], a[124:127], v[108:111], v[252:255]
ds_read_b128 a[92:95], v1 offset:7168
v_mfma_f32_16x16x32_bf16 v[252:255], a[120:123], v[104:107], v[252:255]
s_waitcnt lgkmcnt(6)
v_cndmask_b32 v32, v16, v7, s[32:33]
v_cndmask_b32 v33, v16, v7, s[34:35]
v_cndmask_b32 v34, v16, v7, s[36:37]
v_cndmask_b32 v35, v16, v7, s[38:39]
s_nop 1
v_mfma_f32_16x16x32_bf16 v[32:35], a[64:67], a[0:3], v[32:35]
s_add_u32 m0, s18, 32768
ds_read_b128 a[96:99], v1 offset:8192
v_cndmask_b32 v40, v16, v7, s[40:41]
v_mfma_f32_16x16x32_bf16 v[32:35], a[68:71], a[4:7], v[32:35]
s_waitcnt lgkmcnt(6)
buffer_load_dwordx4 v1, s[4:7], s8 offen offset:0 sc1 lds
v_mfma_f32_16x16x32_bf16 v[32:35], a[72:75], a[8:11], v[32:35]
s_waitcnt lgkmcnt(5)
ds_read_b128 a[100:103], v1 offset:9216
v_cndmask_b32 v41, v16, v7, s[42:43]
v_mfma_f32_16x16x32_bf16 v[32:35], a[76:79], a[12:15], v[32:35]
s_waitcnt lgkmcnt(5)
v_cndmask_b32 v42, v16, v7, s[44:45]
v_cndmask_b32 v43, v16, v7, s[46:47]
v_mfma_f32_16x16x32_bf16 v[32:35], a[80:83], a[16:19], v[32:35]
s_waitcnt lgkmcnt(4)
ds_read_b128 a[104:107], v1 offset:10240
v_mfma_f32_16x16x32_bf16 v[32:35], a[84:87], a[20:23], v[32:35]
s_waitcnt lgkmcnt(4)
buffer_load_dwordx4 v1, s[4:7], s8 offen offset:1024 sc1 lds
v_mfma_f32_16x16x32_bf16 v[32:35], a[88:91], a[24:27], v[32:35]
s_waitcnt lgkmcnt(3)
ds_read_b128 a[108:111], v1 offset:11264
v_mfma_f32_16x16x32_bf16 v[32:35], a[92:95], a[28:31], v[32:35]
v_exp_f32 v8, v80
v_mfma_f32_16x16x32_bf16 v[36:39], a[64:67], a[32:35], v[20:23]
ds_read_b128 a[112:115], v1 offset:12288
v_add_f32 v26, v26, v8
v_mfma_f32_16x16x32_bf16 v[36:39], a[68:71], a[36:39], v[36:39]
buffer_load_dwordx4 v1, s[4:7], s8 offen offset:2048 sc1 lds
v_mfma_f32_16x16x32_bf16 v[36:39], a[72:75], a[40:43], v[36:39]
ds_read_b128 a[116:119], v1 offset:13312
v_mfma_f32_16x16x32_bf16 v[36:39], a[76:79], a[44:47], v[36:39]
v_exp_f32 v9, v81
v_mfma_f32_16x16x32_bf16 v[36:39], a[80:83], a[48:51], v[36:39]
ds_read_b128 a[120:123], v1 offset:14336
v_add_f32 v26, v26, v9
v_mfma_f32_16x16x32_bf16 v[36:39], a[84:87], a[52:55], v[36:39]
buffer_load_dwordx4 v1, s[4:7], s8 offen offset:3072 sc1 lds
v_mfma_f32_16x16x32_bf16 v[36:39], a[88:91], a[56:59], v[36:39]
s_add_u32 s8, s8, 4096
ds_read_b128 a[124:127], v1 offset:15360
v_cvt_pk_bf16_f32 v116, v8, v9
v_mfma_f32_16x16x32_bf16 v[36:39], a[92:95], a[60:63], v[36:39]
s_waitcnt lgkmcnt(6)
v_exp_f32 v10, v82
v_mfma_f32_16x16x32_bf16 v[40:43], a[96:99], a[0:3], v[40:43]
s_add_u32 m0, s18, 36864
ds_read_b128 a[64:67], v1 offset:16384
v_cndmask_b32 v48, v16, v7, s[48:49]
v_mfma_f32_16x16x32_bf16 v[40:43], a[100:103], a[4:7], v[40:43]
s_waitcnt lgkmcnt(6)
buffer_load_dwordx4 v1, s[4:7], s8 offen offset:0 sc1 lds
v_mfma_f32_16x16x32_bf16 v[40:43], a[104:107], a[8:11], v[40:43]
s_waitcnt lgkmcnt(5)
ds_read_b128 a[68:71], v1 offset:17408
v_cndmask_b32 v49, v16, v7, s[50:51]
v_mfma_f32_16x16x32_bf16 v[40:43], a[108:111], a[12:15], v[40:43]
s_waitcnt lgkmcnt(5)
v_cndmask_b32 v50, v16, v7, s[52:53]
v_cndmask_b32 v51, v16, v7, s[54:55]
v_mfma_f32_16x16x32_bf16 v[40:43], a[112:115], a[16:19], v[40:43]
s_waitcnt lgkmcnt(4)
ds_read_b128 a[72:75], v1 offset:18432
v_add_f32 v26, v26, v10
v_mfma_f32_16x16x32_bf16 v[40:43], a[116:119], a[20:23], v[40:43]
s_waitcnt lgkmcnt(4)
buffer_load_dwordx4 v1, s[4:7], s8 offen offset:1024 sc1 lds
v_mfma_f32_16x16x32_bf16 v[40:43], a[120:123], a[24:27], v[40:43]
s_waitcnt lgkmcnt(3)
ds_read_b128 a[76:79], v1 offset:19456
v_mfma_f32_16x16x32_bf16 v[40:43], a[124:127], a[28:31], v[40:43]
v_exp_f32 v11, v83
v_mfma_f32_16x16x32_bf16 v[44:47], a[96:99], a[32:35], v[20:23]
ds_read_b128 a[80:83], v1 offset:20480
v_add_f32 v26, v26, v11
v_mfma_f32_16x16x32_bf16 v[44:47], a[100:103], a[36:39], v[44:47]
buffer_load_dwordx4 v1, s[4:7], s8 offen offset:2048 sc1 lds
v_mfma_f32_16x16x32_bf16 v[44:47], a[104:107], a[40:43], v[44:47]
ds_read_b128 a[84:87], v1 offset:21504
v_cvt_pk_bf16_f32 v117, v10, v11
v_mfma_f32_16x16x32_bf16 v[44:47], a[108:111], a[44:47], v[44:47]
v_exp_f32 v12, v84
v_mfma_f32_16x16x32_bf16 v[44:47], a[112:115], a[48:51], v[44:47]
ds_read_b128 a[88:91], v1 offset:22528
v_add_f32 v27, v27, v12
v_mfma_f32_16x16x32_bf16 v[44:47], a[116:119], a[52:55], v[44:47]
buffer_load_dwordx4 v1, s[4:7], s8 offen offset:3072 sc1 lds
v_mfma_f32_16x16x32_bf16 v[44:47], a[120:123], a[56:59], v[44:47]
s_waitcnt lgkmcnt(2)
s_add_u32 s8, s8, 28672
ds_read_b128 a[92:95], v1 offset:23552
v_mfma_f32_16x16x32_bf16 v[44:47], a[124:127], a[60:63], v[44:47]
s_sub_u32 s9, s9, 1
v_exp_f32 v13, v85
v_mfma_f32_16x16x32_bf16 v[48:51], a[64:67], a[0:3], v[48:51]
s_cmp_eq_u32 s9, 0
ds_read_b128 a[96:99], v1 offset:24576
v_cndmask_b32 v56, v16, v7, s[56:57]
v_mfma_f32_16x16x32_bf16 v[48:51], a[68:71], a[4:7], v[48:51]
s_cselect_b32 s8, s10, s8
v_cndmask_b32 v57, v16, v7, s[58:59]
v_cndmask_b32 v58, v16, v7, s[60:61]
v_mfma_f32_16x16x32_bf16 v[48:51], a[72:75], a[8:11], v[48:51]
s_cselect_b32 s9, s11, s9
ds_read_b128 a[100:103], v1 offset:25600
v_cndmask_b32 v59, v16, v7, s[62:63]
v_mfma_f32_16x16x32_bf16 v[48:51], a[76:79], a[12:15], v[48:51]
s_cselect_b32 s10, 3221225472, s10
v_exp_f32 v14, v86
v_mfma_f32_16x16x32_bf16 v[48:51], a[80:83], a[16:19], v[48:51]
s_waitcnt lgkmcnt(4)
ds_read_b128 a[104:107], v1 offset:26624
v_add_f32 v27, v27, v13
v_cvt_pk_bf16_f32 v124, v12, v13
v_mfma_f32_16x16x32_bf16 v[48:51], a[84:87], a[20:23], v[48:51]
s_waitcnt lgkmcnt(4)
v_exp_f32 v15, v87
v_mfma_f32_16x16x32_bf16 v[48:51], a[88:91], a[24:27], v[48:51]
s_waitcnt lgkmcnt(3)
ds_read_b128 a[108:111], v1 offset:27648
v_add_f32 v27, v27, v14
v_mfma_f32_16x16x32_bf16 v[48:51], a[92:95], a[28:31], v[48:51]
v_exp_f32 v8, v88
v_mfma_f32_16x16x32_bf16 v[52:55], a[64:67], a[32:35], v[20:23]
ds_read_b128 a[112:115], v1 offset:28672
v_add_f32 v27, v27, v15
v_mfma_f32_16x16x32_bf16 v[52:55], a[68:71], a[36:39], v[52:55]
v_exp_f32 v9, v89
v_mfma_f32_16x16x32_bf16 v[52:55], a[72:75], a[40:43], v[52:55]
ds_read_b128 a[116:119], v1 offset:29696
v_cvt_pk_bf16_f32 v125, v14, v15
v_mfma_f32_16x16x32_bf16 v[52:55], a[76:79], a[44:47], v[52:55]
v_exp_f32 v10, v90
v_mfma_f32_16x16x32_bf16 v[52:55], a[80:83], a[48:51], v[52:55]
ds_read_b128 a[120:123], v1 offset:30720
v_add_f32 v26, v26, v8
v_mfma_f32_16x16x32_bf16 v[52:55], a[84:87], a[52:55], v[52:55]
v_exp_f32 v11, v91
v_mfma_f32_16x16x32_bf16 v[52:55], a[88:91], a[56:59], v[52:55]
ds_read_b128 a[124:127], v1 offset:31744
v_add_f32 v26, v26, v9
v_cvt_pk_bf16_f32 v118, v8, v9
v_mfma_f32_16x16x32_bf16 v[52:55], a[92:95], a[60:63], v[52:55]
s_waitcnt vmcnt(8) lgkmcnt(7)
s_barrier
v_add_f32 v26, v26, v10
v_mfma_f32_16x16x32_bf16 v[56:59], a[96:99], a[0:3], v[56:59]
s_waitcnt lgkmcnt(6)
ds_read_b128 a[64:67], v2 offset:32768
v_add_f32 v26, v26, v11
v_mfma_f32_16x16x32_bf16 v[56:59], a[100:103], a[4:7], v[56:59]
s_waitcnt lgkmcnt(6)
v_exp_f32 v12, v92
v_mfma_f32_16x16x32_bf16 v[56:59], a[104:107], a[8:11], v[56:59]
s_waitcnt lgkmcnt(5)
ds_read_b128 a[68:71], v2 offset:33792
v_cvt_pk_bf16_f32 v119, v10, v11
v_mfma_f32_16x16x32_bf16 v[56:59], a[108:111], a[12:15], v[56:59]
s_waitcnt lgkmcnt(5)
v_exp_f32 v13, v93
v_mfma_f32_16x16x32_bf16 v[56:59], a[112:115], a[16:19], v[56:59]
s_waitcnt lgkmcnt(4)
ds_read_b128 a[72:75], v2 offset:34816
v_add_f32 v27, v27, v12
v_mfma_f32_16x16x32_bf16 v[56:59], a[116:119], a[20:23], v[56:59]
s_waitcnt lgkmcnt(4)
v_exp_f32 v14, v94
v_mfma_f32_16x16x32_bf16 v[56:59], a[120:123], a[24:27], v[56:59]
s_waitcnt lgkmcnt(3)
ds_read_b128 a[76:79], v2 offset:35840
v_add_f32 v27, v27, v13
v_mfma_f32_16x16x32_bf16 v[56:59], a[124:127], a[28:31], v[56:59]
v_exp_f32 v15, v95
v_mfma_f32_16x16x32_bf16 v[60:63], a[96:99], a[32:35], v[20:23]
ds_read_b128 a[80:83], v2 offset:36864
v_cvt_pk_bf16_f32 v126, v12, v13
v_mfma_f32_16x16x32_bf16 v[60:63], a[100:103], a[36:39], v[60:63]
v_add_f32 v27, v27, v14
v_add_f32 v27, v27, v15
v_mfma_f32_16x16x32_bf16 v[60:63], a[104:107], a[40:43], v[60:63]
ds_read_b128 a[84:87], v2 offset:37888
v_cvt_pk_bf16_f32 v127, v14, v15
v_mfma_f32_16x16x32_bf16 v[60:63], a[108:111], a[44:47], v[60:63]
v_add_f32 v28, v26, v27
v_cmp_nge_f32 vcc, s25, v28
v_mfma_f32_16x16x32_bf16 v[60:63], a[112:115], a[48:51], v[60:63]
ds_read_b128 a[88:91], v2 offset:38912
v_mfma_f32_16x16x32_bf16 v[60:63], a[116:119], a[52:55], v[60:63]
v_mfma_f32_16x16x32_bf16 v[60:63], a[120:123], a[56:59], v[60:63]
ds_read_b128 a[92:95], v2 offset:39936
v_mfma_f32_16x16x32_bf16 v[60:63], a[124:127], a[60:63], v[60:63]
s_waitcnt lgkmcnt(6)
s_cbranch_vccnz Lstub_7
Lback_8:
v_mfma_f32_16x16x32_bf16 v[128:131], a[64:67], v[112:115], v[128:131]
s_add_u32 m0, s18, 65536
ds_read_b128 a[96:99], v2 offset:40960
v_add_f32 v24, v24, v26
v_mfma_f32_16x16x32_bf16 v[128:131], a[68:71], v[116:119], v[128:131]
buffer_load_dwordx4 v1, s[4:7], s12 offen offset:0 sc1 lds
v_mfma_f32_16x16x32_bf16 v[132:135], a[68:71], v[124:127], v[132:135]
ds_read_b128 a[100:103], v2 offset:41984
v_add_f32 v25, v25, v27
v_mfma_f32_16x16x32_bf16 v[132:135], a[64:67], v[120:123], v[132:135]
s_waitcnt lgkmcnt(7)
v_exp_f32 v8, v32
v_mfma_f32_16x16x32_bf16 v[136:139], a[72:75], v[112:115], v[136:139]
s_waitcnt lgkmcnt(6)
ds_read_b128 a[104:107], v2 offset:43008
v_mfma_f32_16x16x32_bf16 v[136:139], a[76:79], v[116:119], v[136:139]
buffer_load_dwordx4 v1, s[4:7], s12 offen offset:1024 sc1 lds
v_mfma_f32_16x16x32_bf16 v[140:143], a[76:79], v[124:127], v[140:143]
ds_read_b128 a[108:111], v2 offset:44032
v_mfma_f32_16x16x32_bf16 v[140:143], a[72:75], v[120:123], v[140:143]
s_waitcnt lgkmcnt(7)
v_exp_f32 v9, v33
v_mfma_f32_16x16x32_bf16 v[144:147], a[80:83], v[112:115], v[144:147]
s_waitcnt lgkmcnt(6)
ds_read_b128 a[112:115], v2 offset:45056
v_add_f32 v26, v8, v9
v_mfma_f32_16x16x32_bf16 v[144:147], a[84:87], v[116:119], v[144:147]
buffer_load_dwordx4 v1, s[4:7], s12 offen offset:2048 sc1 lds
v_mfma_f32_16x16x32_bf16 v[148:151], a[84:87], v[124:127], v[148:151]
ds_read_b128 a[116:119], v2 offset:46080
v_cvt_pk_bf16_f32 v96, v8, v9
v_mfma_f32_16x16x32_bf16 v[148:151], a[80:83], v[120:123], v[148:151]
s_waitcnt lgkmcnt(7)
v_exp_f32 v10, v34
v_mfma_f32_16x16x32_bf16 v[152:155], a[88:91], v[112:115], v[152:155]
s_waitcnt lgkmcnt(6)
ds_read_b128 a[120:123], v2 offset:47104
v_add_f32 v26, v26, v10
v_mfma_f32_16x16x32_bf16 v[152:155], a[92:95], v[116:119], v[152:155]
buffer_load_dwordx4 v1, s[4:7], s12 offen offset:3072 sc1 lds
v_mfma_f32_16x16x32_bf16 v[156:159], a[92:95], v[124:127], v[156:159]
s_add_u32 s12, s12, 4096
ds_read_b128 a[124:127], v2 offset:48128
v_mfma_f32_16x16x32_bf16 v[156:159], a[88:91], v[120:123], v[156:159]
s_waitcnt lgkmcnt(6)
v_exp_f32 v11, v35
v_mfma_f32_16x16x32_bf16 v[160:163], a[96:99], v[112:115], v[160:163]
s_add_u32 m0, s18, 69632
ds_read_b128 a[64:67], v2 offset:49152
v_add_f32 v26, v26, v11
v_mfma_f32_16x16x32_bf16 v[160:163], a[100:103], v[116:119], v[160:163]
buffer_load_dwordx4 v1, s[4:7], s12 offen offset:0 sc1 lds
v_mfma_f32_16x16x32_bf16 v[164:167], a[100:103], v[124:127], v[164:167]
ds_read_b128 a[68:71], v2 offset:50176
v_cvt_pk_bf16_f32 v97, v10, v11
v_mfma_f32_16x16x32_bf16 v[164:167], a[96:99], v[120:123], v[164:167]
s_waitcnt lgkmcnt(7)
v_mfma_f32_16x16x32_bf16 v[168:171], a[104:107], v[112:115], v[168:171]
s_waitcnt lgkmcnt(6)
ds_read_b128 a[72:75], v2 offset:51200
v_mfma_f32_16x16x32_bf16 v[168:171], a[108:111], v[116:119], v[168:171]
buffer_load_dwordx4 v1, s[4:7], s12 offen offset:1024 sc1 lds
v_mfma_f32_16x16x32_bf16 v[172:175], a[108:111], v[124:127], v[172:175]
ds_read_b128 a[76:79], v2 offset:52224
v_mfma_f32_16x16x32_bf16 v[172:175], a[104:107], v[120:123], v[172:175]
s_waitcnt lgkmcnt(7)
v_exp_f32 v12, v36
v_mfma_f32_16x16x32_bf16 v[176:179], a[112:115], v[112:115], v[176:179]
s_waitcnt lgkmcnt(6)
ds_read_b128 a[80:83], v2 offset:53248
v_mfma_f32_16x16x32_bf16 v[176:179], a[116:119], v[116:119], v[176:179]
buffer_load_dwordx4 v1, s[4:7], s12 offen offset:2048 sc1 lds
v_mfma_f32_16x16x32_bf16 v[180:183], a[116:119], v[124:127], v[180:183]
ds_read_b128 a[84:87], v2 offset:54272
v_mfma_f32_16x16x32_bf16 v[180:183], a[112:115], v[120:123], v[180:183]
s_waitcnt lgkmcnt(7)
v_exp_f32 v13, v37
v_mfma_f32_16x16x32_bf16 v[184:187], a[120:123], v[112:115], v[184:187]
s_waitcnt lgkmcnt(6)
ds_read_b128 a[88:91], v2 offset:55296
v_add_f32 v27, v12, v13
v_mfma_f32_16x16x32_bf16 v[184:187], a[124:127], v[116:119], v[184:187]
s_waitcnt lgkmcnt(5)
buffer_load_dwordx4 v1, s[4:7], s12 offen offset:3072 sc1 lds
v_mfma_f32_16x16x32_bf16 v[188:191], a[124:127], v[124:127], v[188:191]
s_add_u32 s12, s12, 28672
ds_read_b128 a[92:95], v2 offset:56320
v_cvt_pk_bf16_f32 v104, v12, v13
v_mfma_f32_16x16x32_bf16 v[188:191], a[120:123], v[120:123], v[188:191]
s_sub_u32 s13, s13, 1
v_exp_f32 v14, v38
v_mfma_f32_16x16x32_bf16 v[192:195], a[64:67], v[112:115], v[192:195]
s_cmp_eq_u32 s13, 0
ds_read_b128 a[96:99], v2 offset:57344
v_add_f32 v27, v27, v14
v_mfma_f32_16x16x32_bf16 v[192:195], a[68:71], v[116:119], v[192:195]
s_cselect_b32 s12, s14, s12
v_mfma_f32_16x16x32_bf16 v[196:199], a[68:71], v[124:127], v[196:199]
s_waitcnt lgkmcnt(6)
s_cselect_b32 s13, s15, s13
ds_read_b128 a[100:103], v2 offset:58368
v_mfma_f32_16x16x32_bf16 v[196:199], a[64:67], v[120:123], v[196:199]
s_cselect_b32 s14, 3221225472, s14
v_exp_f32 v15, v39
v_mfma_f32_16x16x32_bf16 v[200:203], a[72:75], v[112:115], v[200:203]
s_waitcnt lgkmcnt(6)
ds_read_b128 a[104:107], v2 offset:59392
v_add_f32 v27, v27, v15
v_mfma_f32_16x16x32_bf16 v[200:203], a[76:79], v[116:119], v[200:203]
v_exp_f32 v8, v40
v_mfma_f32_16x16x32_bf16 v[204:207], a[76:79], v[124:127], v[204:207]
ds_read_b128 a[108:111], v2 offset:60416
v_cvt_pk_bf16_f32 v105, v14, v15
v_mfma_f32_16x16x32_bf16 v[204:207], a[72:75], v[120:123], v[204:207]
s_waitcnt lgkmcnt(7)
v_exp_f32 v9, v41
v_mfma_f32_16x16x32_bf16 v[208:211], a[80:83], v[112:115], v[208:211]
s_waitcnt lgkmcnt(6)
ds_read_b128 a[112:115], v2 offset:61440
v_add_f32 v26, v26, v8
v_mfma_f32_16x16x32_bf16 v[208:211], a[84:87], v[116:119], v[208:211]
v_add_f32 v26, v26, v9
v_cvt_pk_bf16_f32 v98, v8, v9
v_mfma_f32_16x16x32_bf16 v[212:215], a[84:87], v[124:127], v[212:215]
ds_read_b128 a[116:119], v2 offset:62464
v_mfma_f32_16x16x32_bf16 v[212:215], a[80:83], v[120:123], v[212:215]
s_waitcnt lgkmcnt(7)
v_exp_f32 v10, v42
v_mfma_f32_16x16x32_bf16 v[216:219], a[88:91], v[112:115], v[216:219]
s_waitcnt lgkmcnt(6)
ds_read_b128 a[120:123], v2 offset:63488
v_add_f32 v26, v26, v10
v_mfma_f32_16x16x32_bf16 v[216:219], a[92:95], v[116:119], v[216:219]
v_exp_f32 v11, v43
v_mfma_f32_16x16x32_bf16 v[220:223], a[92:95], v[124:127], v[220:223]
ds_read_b128 a[124:127], v2 offset:64512
v_add_f32 v26, v26, v11
v_mfma_f32_16x16x32_bf16 v[220:223], a[88:91], v[120:123], v[220:223]
s_waitcnt vmcnt(8) lgkmcnt(7)
s_barrier
v_cvt_pk_bf16_f32 v99, v10, v11
v_mfma_f32_16x16x32_bf16 v[224:227], a[96:99], v[112:115], v[224:227]
s_waitcnt lgkmcnt(6)
ds_read_b128 a[64:67], v1 offset:32768
v_mfma_f32_16x16x32_bf16 v[224:227], a[100:103], v[116:119], v[224:227]
v_exp_f32 v12, v44
v_mfma_f32_16x16x32_bf16 v[228:231], a[100:103], v[124:127], v[228:231]
ds_read_b128 a[68:71], v1 offset:33792
v_add_f32 v27, v27, v12
v_mfma_f32_16x16x32_bf16 v[228:231], a[96:99], v[120:123], v[228:231]
s_waitcnt lgkmcnt(7)
v_mfma_f32_16x16x32_bf16 v[232:235], a[104:107], v[112:115], v[232:235]
s_waitcnt lgkmcnt(6)
ds_read_b128 a[72:75], v1 offset:34816
v_mfma_f32_16x16x32_bf16 v[232:235], a[108:111], v[116:119], v[232:235]
v_exp_f32 v13, v45
v_mfma_f32_16x16x32_bf16 v[236:239], a[108:111], v[124:127], v[236:239]
ds_read_b128 a[76:79], v1 offset:35840
v_add_f32 v27, v27, v13
v_mfma_f32_16x16x32_bf16 v[236:239], a[104:107], v[120:123], v[236:239]
s_waitcnt lgkmcnt(7)
v_exp_f32 v14, v46
v_mfma_f32_16x16x32_bf16 v[240:243], a[112:115], v[112:115], v[240:243]
s_waitcnt lgkmcnt(6)
ds_read_b128 a[80:83], v1 offset:36864
v_cvt_pk_bf16_f32 v106, v12, v13
v_mfma_f32_16x16x32_bf16 v[240:243], a[116:119], v[116:119], v[240:243]
v_exp_f32 v15, v47
v_mfma_f32_16x16x32_bf16 v[244:247], a[116:119], v[124:127], v[244:247]
ds_read_b128 a[84:87], v1 offset:37888
v_add_f32 v27, v27, v14
v_mfma_f32_16x16x32_bf16 v[244:247], a[112:115], v[120:123], v[244:247]
s_waitcnt lgkmcnt(7)
v_add_f32 v27, v27, v15
v_cvt_pk_bf16_f32 v107, v14, v15
v_mfma_f32_16x16x32_bf16 v[248:251], a[120:123], v[112:115], v[248:251]
s_waitcnt lgkmcnt(6)
ds_read_b128 a[88:91], v1 offset:38912
v_mfma_f32_16x16x32_bf16 v[248:251], a[124:127], v[116:119], v[248:251]
v_mfma_f32_16x16x32_bf16 v[252:255], a[124:127], v[124:127], v[252:255]
ds_read_b128 a[92:95], v1 offset:39936
v_mfma_f32_16x16x32_bf16 v[252:255], a[120:123], v[120:123], v[252:255]
s_waitcnt lgkmcnt(6)
K2_dx1:
v_cndmask_b32 v68, v20, v7, s[32:33]
v_cndmask_b32 v69, v20, v7, s[34:35]
v_cndmask_b32 v70, v20, v7, s[36:37]
v_cndmask_b32 v71, v20, v7, s[38:39]
s_nop 1
v_mfma_f32_16x16x32_bf16 v[68:71], a[64:67], a[32:35], v[68:71]
s_add_u32 m0, s18, 0
ds_read_b128 a[96:99], v1 offset:40960
v_cndmask_b32 v76, v20, v7, s[40:41]
v_cndmask_b32 v79, v20, v7, s[46:47]
v_exp_f32 v8, v48
v_mfma_f32_16x16x32_bf16 v[68:71], a[68:71], a[36:39], v[68:71]
s_waitcnt lgkmcnt(6)
ds_read_b128 a[100:103], v1 offset:41984
buffer_load_dwordx4 v1, s[4:7], s12 offen offset:0 sc1 lds
v_exp_f32 v9, v49
v_add_f32 v26, v26, v8
v_mfma_f32_16x16x32_bf16 v[68:71], a[72:75], a[40:43], v[68:71]
s_waitcnt lgkmcnt(6)
ds_read_b128 a[104:107], v1 offset:43008
v_cndmask_b32 v77, v20, v7, s[42:43]
v_add_f32 v26, v26, v9
v_cvt_pk_bf16_f32 v100, v8, v9
v_mfma_f32_16x16x32_bf16 v[68:71], a[76:79], a[44:47], v[68:71]
s_waitcnt lgkmcnt(6)
ds_read_b128 a[108:111], v1 offset:44032
buffer_load_dwordx4 v1, s[4:7], s12 offen offset:1024 sc1 lds
v_exp_f32 v10, v50
v_mfma_f32_16x16x32_bf16 v[68:71], a[80:83], a[48:51], v[68:71]
s_waitcnt lgkmcnt(6)
ds_read_b128 a[112:115], v1 offset:45056
v_cndmask_b32 v78, v20, v7, s[44:45]
v_exp_f32 v11, v51
v_add_f32 v26, v26, v10
v_mfma_f32_16x16x32_bf16 v[68:71], a[84:87], a[52:55], v[68:71]
s_waitcnt lgkmcnt(6)
ds_read_b128 a[116:119], v1 offset:46080
buffer_load_dwordx4 v1, s[4:7], s12 offen offset:2048 sc1 lds
v_add_f32 v26, v26, v11
v_cvt_pk_bf16_f32 v101, v10, v11
v_mfma_f32_16x16x32_bf16 v[68:71], a[88:91], a[56:59], v[68:71]
s_waitcnt lgkmcnt(6)
ds_read_b128 a[120:123], v1 offset:47104
v_exp_f32 v12, v52
v_mfma_f32_16x16x32_bf16 v[68:71], a[92:95], a[60:63], v[68:71]
s_waitcnt lgkmcnt(5)
ds_read_b128 a[124:127], v1 offset:48128
buffer_load_dwordx4 v1, s[4:7], s12 offen offset:3072 sc1 lds
v_add_f32 v27, v27, v12
v_mfma_f32_16x16x32_bf16 v[76:79], a[96:99], a[32:35], v[76:79]
s_add_u32 s12, s12, 4096
s_add_u32 m0, s18, 4096
ds_read_b128 a[64:67], v1 offset:49152
v_cndmask_b32 v86, v20, v7, s[52:53]
v_cndmask_b32 v87, v20, v7, s[54:55]
v_exp_f32 v13, v53
v_mfma_f32_16x16x32_bf16 v[76:79], a[100:103], a[36:39], v[76:79]
s_waitcnt lgkmcnt(6)
ds_read_b128 a[68:71], v1 offset:50176
buffer_load_dwordx4 v1, s[4:7], s12 offen offset:0 sc1 lds
v_exp_f32 v14, v54
v_add_f32 v27, v27, v13
v_cvt_pk_bf16_f32 v108, v12, v13
v_mfma_f32_16x16x32_bf16 v[76:79], a[104:107], a[40:43], v[76:79]
s_waitcnt lgkmcnt(6)
ds_read_b128 a[72:75], v1 offset:51200
v_cndmask_b32 v84, v20, v7, s[48:49]
v_add_f32 v27, v27, v14
v_mfma_f32_16x16x32_bf16 v[76:79], a[108:111], a[44:47], v[76:79]
s_waitcnt lgkmcnt(6)
ds_read_b128 a[76:79], v1 offset:52224
buffer_load_dwordx4 v1, s[4:7], s12 offen offset:1024 sc1 lds
v_exp_f32 v15, v55
v_mfma_f32_16x16x32_bf16 v[76:79], a[112:115], a[48:51], v[76:79]
s_waitcnt lgkmcnt(6)
ds_read_b128 a[80:83], v1 offset:53248
v_cndmask_b32 v85, v20, v7, s[50:51]
v_add_f32 v27, v27, v15
v_cvt_pk_bf16_f32 v109, v14, v15
v_mfma_f32_16x16x32_bf16 v[76:79], a[116:119], a[52:55], v[76:79]
s_waitcnt lgkmcnt(6)
ds_read_b128 a[84:87], v1 offset:54272
buffer_load_dwordx4 v1, s[4:7], s12 offen offset:2048 sc1 lds
v_exp_f32 v8, v56
v_mfma_f32_16x16x32_bf16 v[76:79], a[120:123], a[56:59], v[76:79]
s_waitcnt lgkmcnt(6)
ds_read_b128 a[88:91], v1 offset:55296
v_exp_f32 v9, v57
v_add_f32 v26, v26, v8
v_mfma_f32_16x16x32_bf16 v[76:79], a[124:127], a[60:63], v[76:79]
s_waitcnt lgkmcnt(1)
ds_read_b128 a[92:95], v1 offset:56320
buffer_load_dwordx4 v1, s[4:7], s12 offen offset:3072 sc1 lds
v_add_f32 v26, v26, v9
v_cvt_pk_bf16_f32 v102, v8, v9
v_mfma_f32_16x16x32_bf16 v[84:87], a[64:67], a[32:35], v[84:87]
s_add_u32 s12, s12, 28672
ds_read_b128 a[96:99], v1 offset:57344
v_cndmask_b32 v92, v20, v7, s[56:57]
v_exp_f32 v10, v58
v_mfma_f32_16x16x32_bf16 v[84:87], a[68:71], a[36:39], v[84:87]
s_sub_u32 s13, s13, 1
ds_read_b128 a[100:103], v1 offset:58368
v_cndmask_b32 v93, v20, v7, s[58:59]
v_exp_f32 v11, v59
v_mfma_f32_16x16x32_bf16 v[84:87], a[72:75], a[40:43], v[84:87]
s_cmp_eq_u32 s13, 0
ds_read_b128 a[104:107], v1 offset:59392
v_cndmask_b32 v94, v20, v7, s[60:61]
v_mfma_f32_16x16x32_bf16 v[84:87], a[76:79], a[44:47], v[84:87]
s_cselect_b32 s12, s14, s12
ds_read_b128 a[108:111], v1 offset:60416
v_cndmask_b32 v95, v20, v7, s[62:63]
v_exp_f32 v12, v60
v_mfma_f32_16x16x32_bf16 v[84:87], a[80:83], a[48:51], v[84:87]
s_cselect_b32 s13, s15, s13
ds_read_b128 a[112:115], v1 offset:61440
v_add_f32 v26, v26, v10
v_add_f32 v26, v26, v11
v_cvt_pk_bf16_f32 v103, v10, v11
v_add_f32 v27, v27, v12
v_mfma_f32_16x16x32_bf16 v[84:87], a[84:87], a[52:55], v[84:87]
s_waitcnt lgkmcnt(6)
s_cselect_b32 s14, 3221225472, s14
ds_read_b128 a[116:119], v1 offset:62464
v_exp_f32 v13, v61
v_mfma_f32_16x16x32_bf16 v[84:87], a[88:91], a[56:59], v[84:87]
s_waitcnt lgkmcnt(6)
ds_read_b128 a[120:123], v1 offset:63488
v_exp_f32 v14, v62
v_mfma_f32_16x16x32_bf16 v[84:87], a[92:95], a[60:63], v[84:87]
s_waitcnt vmcnt(8) lgkmcnt(6)
s_barrier
ds_read_b128 a[124:127], v1 offset:64512
v_mfma_f32_16x16x32_bf16 v[92:95], a[96:99], a[32:35], v[92:95]
s_waitcnt lgkmcnt(6)
ds_read_b128 a[64:67], v2 offset:0
v_exp_f32 v15, v63
v_mfma_f32_16x16x32_bf16 v[92:95], a[100:103], a[36:39], v[92:95]
s_waitcnt lgkmcnt(6)
ds_read_b128 a[68:71], v2 offset:1024
v_add_f32 v27, v27, v13
v_mfma_f32_16x16x32_bf16 v[92:95], a[104:107], a[40:43], v[92:95]
s_waitcnt lgkmcnt(6)
ds_read_b128 a[72:75], v2 offset:2048
v_cvt_pk_bf16_f32 v110, v12, v13
v_mfma_f32_16x16x32_bf16 v[92:95], a[108:111], a[44:47], v[92:95]
s_waitcnt lgkmcnt(6)
ds_read_b128 a[76:79], v2 offset:3072
v_add_f32 v27, v27, v14
v_mfma_f32_16x16x32_bf16 v[92:95], a[112:115], a[48:51], v[92:95]
s_waitcnt lgkmcnt(6)
ds_read_b128 a[80:83], v2 offset:4096
v_add_f32 v27, v27, v15
v_mfma_f32_16x16x32_bf16 v[92:95], a[116:119], a[52:55], v[92:95]
s_waitcnt lgkmcnt(6)
ds_read_b128 a[84:87], v2 offset:5120
v_cvt_pk_bf16_f32 v111, v14, v15
v_mfma_f32_16x16x32_bf16 v[92:95], a[120:123], a[56:59], v[92:95]
s_waitcnt lgkmcnt(6)
ds_read_b128 a[88:91], v2 offset:6144
v_add_f32 v28, v26, v27
v_mfma_f32_16x16x32_bf16 v[92:95], a[124:127], a[60:63], v[92:95]
s_waitcnt lgkmcnt(6)
ds_read_b128 a[92:95], v2 offset:7168
v_cmp_nge_f32 vcc, s25, v28
s_cbranch_vccnz Lstub_9
Lback_10:
v_mfma_f32_16x16x32_bf16 v[128:131], a[64:67], v[96:99], v[128:131]
s_waitcnt lgkmcnt(6)
ds_read_b128 a[96:99], v2 offset:8192
v_add_f32 v24, v24, v26
v_mfma_f32_16x16x32_bf16 v[128:131], a[68:71], v[100:103], v[128:131]
v_add_f32 v25, v25, v27
v_mfma_f32_16x16x32_bf16 v[132:135], a[68:71], v[108:111], v[132:135]
ds_read_b128 a[100:103], v2 offset:9216
v_mfma_f32_16x16x32_bf16 v[132:135], a[64:67], v[104:107], v[132:135]
s_waitcnt lgkmcnt(7)
v_exp_f32 v8, v68
v_mfma_f32_16x16x32_bf16 v[136:139], a[72:75], v[96:99], v[136:139]
s_waitcnt lgkmcnt(6)
ds_read_b128 a[104:107], v2 offset:10240
v_mfma_f32_16x16x32_bf16 v[136:139], a[76:79], v[100:103], v[136:139]
v_exp_f32 v9, v69
v_mfma_f32_16x16x32_bf16 v[140:143], a[76:79], v[108:111], v[140:143]
ds_read_b128 a[108:111], v2 offset:11264
v_add_f32 v27, v8, v9
v_mfma_f32_16x16x32_bf16 v[140:143], a[72:75], v[104:107], v[140:143]
s_waitcnt lgkmcnt(7)
v_cvt_pk_bf16_f32 v120, v8, v9
v_mfma_f32_16x16x32_bf16 v[144:147], a[80:83], v[96:99], v[144:147]
s_waitcnt lgkmcnt(6)
ds_read_b128 a[112:115], v2 offset:12288
v_mfma_f32_16x16x32_bf16 v[144:147], a[84:87], v[100:103], v[144:147]
v_exp_f32 v10, v70
v_mfma_f32_16x16x32_bf16 v[148:151], a[84:87], v[108:111], v[148:151]
ds_read_b128 a[116:119], v2 offset:13312
v_add_f32 v27, v27, v10
v_mfma_f32_16x16x32_bf16 v[148:151], a[80:83], v[104:107], v[148:151]
s_waitcnt lgkmcnt(7)
v_mfma_f32_16x16x32_bf16 v[152:155], a[88:91], v[96:99], v[152:155]
s_waitcnt lgkmcnt(6)
ds_read_b128 a[120:123], v2 offset:14336
v_mfma_f32_16x16x32_bf16 v[152:155], a[92:95], v[100:103], v[152:155]
v_exp_f32 v11, v71
v_mfma_f32_16x16x32_bf16 v[156:159], a[92:95], v[108:111], v[156:159]
ds_read_b128 a[124:127], v2 offset:15360
v_add_f32 v27, v27, v11
v_mfma_f32_16x16x32_bf16 v[156:159], a[88:91], v[104:107], v[156:159]
s_waitcnt lgkmcnt(7)
v_exp_f32 v12, v76
v_mfma_f32_16x16x32_bf16 v[160:163], a[96:99], v[96:99], v[160:163]
s_waitcnt lgkmcnt(6)
ds_read_b128 a[64:67], v2 offset:16384
v_cvt_pk_bf16_f32 v121, v10, v11
v_mfma_f32_16x16x32_bf16 v[160:163], a[100:103], v[100:103], v[160:163]
v_add_f32 v27, v27, v12
v_mfma_f32_16x16x32_bf16 v[164:167], a[100:103], v[108:111], v[164:167]
ds_read_b128 a[68:71], v2 offset:17408
v_mfma_f32_16x16x32_bf16 v[164:167], a[96:99], v[104:107], v[164:167]
s_waitcnt lgkmcnt(7)
v_exp_f32 v13, v77
v_mfma_f32_16x16x32_bf16 v[168:171], a[104:107], v[96:99], v[168:171]
s_waitcnt lgkmcnt(6)
ds_read_b128 a[72:75], v2 offset:18432
v_add_f32 v27, v27, v13
v_mfma_f32_16x16x32_bf16 v[168:171], a[108:111], v[100:103], v[168:171]
v_cvt_pk_bf16_f32 v122, v12, v13
v_mfma_f32_16x16x32_bf16 v[172:175], a[108:111], v[108:111], v[172:175]
ds_read_b128 a[76:79], v2 offset:19456
v_mfma_f32_16x16x32_bf16 v[172:175], a[104:107], v[104:107], v[172:175]
s_waitcnt lgkmcnt(7)
v_exp_f32 v14, v78
v_mfma_f32_16x16x32_bf16 v[176:179], a[112:115], v[96:99], v[176:179]
s_waitcnt lgkmcnt(6)
ds_read_b128 a[80:83], v2 offset:20480
v_add_f32 v27, v27, v14
v_mfma_f32_16x16x32_bf16 v[176:179], a[116:119], v[100:103], v[176:179]
v_exp_f32 v15, v79
v_mfma_f32_16x16x32_bf16 v[180:183], a[116:119], v[108:111], v[180:183]
ds_read_b128 a[84:87], v2 offset:21504
v_add_f32 v27, v27, v15
v_mfma_f32_16x16x32_bf16 v[180:183], a[112:115], v[104:107], v[180:183]
s_waitcnt lgkmcnt(7)
v_cvt_pk_bf16_f32 v123, v14, v15
v_mfma_f32_16x16x32_bf16 v[184:187], a[120:123], v[96:99], v[184:187]
s_waitcnt lgkmcnt(6)
ds_read_b128 a[88:91], v2 offset:22528
v_mfma_f32_16x16x32_bf16 v[184:187], a[124:127], v[100:103], v[184:187]
v_exp_f32 v8, v84
v_mfma_f32_16x16x32_bf16 v[188:191], a[124:127], v[108:111], v[188:191]
ds_read_b128 a[92:95], v2 offset:23552
v_add_f32 v27, v27, v8
v_mfma_f32_16x16x32_bf16 v[188:191], a[120:123], v[104:107], v[188:191]
s_waitcnt lgkmcnt(7)
v_mfma_f32_16x16x32_bf16 v[192:195], a[64:67], v[96:99], v[192:195]
s_waitcnt lgkmcnt(6)
ds_read_b128 a[96:99], v2 offset:24576
v_mfma_f32_16x16x32_bf16 v[192:195], a[68:71], v[100:103], v[192:195]
v_exp_f32 v9, v85
v_mfma_f32_16x16x32_bf16 v[196:199], a[68:71], v[108:111], v[196:199]
ds_read_b128 a[100:103], v2 offset:25600
v_add_f32 v27, v27, v9
v_mfma_f32_16x16x32_bf16 v[196:199], a[64:67], v[104:107], v[196:199]
s_waitcnt lgkmcnt(7)
v_exp_f32 v10, v86
v_mfma_f32_16x16x32_bf16 v[200:203], a[72:75], v[96:99], v[200:203]
s_waitcnt lgkmcnt(6)
ds_read_b128 a[104:107], v2 offset:26624
v_cvt_pk_bf16_f32 v124, v8, v9
v_mfma_f32_16x16x32_bf16 v[200:203], a[76:79], v[100:103], v[200:203]
v_add_f32 v27, v27, v10
v_mfma_f32_16x16x32_bf16 v[204:207], a[76:79], v[108:111], v[204:207]
ds_read_b128 a[108:111], v2 offset:27648
v_mfma_f32_16x16x32_bf16 v[204:207], a[72:75], v[104:107], v[204:207]
s_waitcnt lgkmcnt(7)
v_exp_f32 v11, v87
v_mfma_f32_16x16x32_bf16 v[208:211], a[80:83], v[96:99], v[208:211]
s_waitcnt lgkmcnt(6)
ds_read_b128 a[112:115], v2 offset:28672
v_add_f32 v27, v27, v11
v_mfma_f32_16x16x32_bf16 v[208:211], a[84:87], v[100:103], v[208:211]
v_cvt_pk_bf16_f32 v125, v10, v11
v_mfma_f32_16x16x32_bf16 v[212:215], a[84:87], v[108:111], v[212:215]
ds_read_b128 a[116:119], v2 offset:29696
v_mfma_f32_16x16x32_bf16 v[212:215], a[80:83], v[104:107], v[212:215]
s_waitcnt lgkmcnt(7)
v_exp_f32 v12, v92
v_mfma_f32_16x16x32_bf16 v[216:219], a[88:91], v[96:99], v[216:219]
s_waitcnt lgkmcnt(6)
ds_read_b128 a[120:123], v2 offset:30720
v_add_f32 v27, v27, v12
v_mfma_f32_16x16x32_bf16 v[216:219], a[92:95], v[100:103], v[216:219]
v_exp_f32 v13, v93
v_mfma_f32_16x16x32_bf16 v[220:223], a[92:95], v[108:111], v[220:223]
ds_read_b128 a[124:127], v2 offset:31744
v_add_f32 v27, v27, v13
v_mfma_f32_16x16x32_bf16 v[220:223], a[88:91], v[104:107], v[220:223]
s_waitcnt vmcnt(0) lgkmcnt(7)
s_barrier
v_cvt_pk_bf16_f32 v126, v12, v13
v_mfma_f32_16x16x32_bf16 v[224:227], a[96:99], v[96:99], v[224:227]
s_waitcnt lgkmcnt(6)
ds_read_b128 a[64:67], v1 offset:0
v_mfma_f32_16x16x32_bf16 v[224:227], a[100:103], v[100:103], v[224:227]
v_mfma_f32_16x16x32_bf16 v[228:231], a[100:103], v[108:111], v[228:231]
ds_read_b128 a[68:71], v1 offset:1024
v_mfma_f32_16x16x32_bf16 v[228:231], a[96:99], v[104:107], v[228:231]
s_waitcnt lgkmcnt(7)
v_exp_f32 v14, v94
v_mfma_f32_16x16x32_bf16 v[232:235], a[104:107], v[96:99], v[232:235]
s_waitcnt lgkmcnt(6)
ds_read_b128 a[72:75], v1 offset:2048
v_add_f32 v27, v27, v14
v_mfma_f32_16x16x32_bf16 v[232:235], a[108:111], v[100:103], v[232:235]
v_mfma_f32_16x16x32_bf16 v[236:239], a[108:111], v[108:111], v[236:239]
ds_read_b128 a[76:79], v1 offset:3072
v_mfma_f32_16x16x32_bf16 v[236:239], a[104:107], v[104:107], v[236:239]
s_waitcnt lgkmcnt(7)
v_exp_f32 v15, v95
v_mfma_f32_16x16x32_bf16 v[240:243], a[112:115], v[96:99], v[240:243]
s_waitcnt lgkmcnt(6)
ds_read_b128 a[80:83], v1 offset:4096
v_add_f32 v27, v27, v15
v_mfma_f32_16x16x32_bf16 v[240:243], a[116:119], v[100:103], v[240:243]
v_cvt_pk_bf16_f32 v127, v14, v15
v_cmp_nge_f32 vcc, s25, v27
v_mfma_f32_16x16x32_bf16 v[244:247], a[116:119], v[108:111], v[244:247]
ds_read_b128 a[84:87], v1 offset:5120
v_mfma_f32_16x16x32_bf16 v[244:247], a[112:115], v[104:107], v[244:247]
s_waitcnt lgkmcnt(7)
v_mfma_f32_16x16x32_bf16 v[248:251], a[120:123], v[96:99], v[248:251]
s_waitcnt lgkmcnt(6)
ds_read_b128 a[88:91], v1 offset:6144
v_mfma_f32_16x16x32_bf16 v[248:251], a[124:127], v[100:103], v[248:251]
v_mfma_f32_16x16x32_bf16 v[252:255], a[124:127], v[108:111], v[252:255]
ds_read_b128 a[92:95], v1 offset:7168
v_mfma_f32_16x16x32_bf16 v[252:255], a[120:123], v[104:107], v[252:255]
s_waitcnt lgkmcnt(7)
s_cbranch_vccnz Lstub_11
Lback_12:
v_mfma_f32_16x16x32_bf16 v[132:135], a[64:67], v[120:123], v[132:135]
s_waitcnt lgkmcnt(6)
ds_read_b128 a[96:99], v1 offset:8192
v_add_f32 v25, v25, v27
v_mfma_f32_16x16x32_bf16 v[132:135], a[68:71], v[124:127], v[132:135]
s_waitcnt lgkmcnt(6)
ds_read_b128 a[100:103], v1 offset:9216
v_mfma_f32_16x16x32_bf16 v[140:143], a[72:75], v[120:123], v[140:143]
s_waitcnt lgkmcnt(6)
ds_read_b128 a[104:107], v1 offset:10240
v_mfma_f32_16x16x32_bf16 v[140:143], a[76:79], v[124:127], v[140:143]
s_waitcnt lgkmcnt(6)
ds_read_b128 a[108:111], v1 offset:11264
v_mfma_f32_16x16x32_bf16 v[148:151], a[80:83], v[120:123], v[148:151]
s_waitcnt lgkmcnt(6)
ds_read_b128 a[112:115], v1 offset:12288
v_mfma_f32_16x16x32_bf16 v[148:151], a[84:87], v[124:127], v[148:151]
s_waitcnt lgkmcnt(6)
ds_read_b128 a[116:119], v1 offset:13312
v_mfma_f32_16x16x32_bf16 v[156:159], a[88:91], v[120:123], v[156:159]
s_waitcnt lgkmcnt(6)
ds_read_b128 a[120:123], v1 offset:14336
v_mfma_f32_16x16x32_bf16 v[156:159], a[92:95], v[124:127], v[156:159]
s_waitcnt lgkmcnt(6)
ds_read_b128 a[124:127], v1 offset:15360
v_mfma_f32_16x16x32_bf16 v[164:167], a[96:99], v[120:123], v[164:167]
s_waitcnt lgkmcnt(6)
ds_read_b128 a[64:67], v1 offset:16384
v_mfma_f32_16x16x32_bf16 v[164:167], a[100:103], v[124:127], v[164:167]
s_waitcnt lgkmcnt(6)
ds_read_b128 a[68:71], v1 offset:17408
v_mfma_f32_16x16x32_bf16 v[172:175], a[104:107], v[120:123], v[172:175]
s_waitcnt lgkmcnt(6)
ds_read_b128 a[72:75], v1 offset:18432
v_mfma_f32_16x16x32_bf16 v[172:175], a[108:111], v[124:127], v[172:175]
s_waitcnt lgkmcnt(6)
ds_read_b128 a[76:79], v1 offset:19456
v_mfma_f32_16x16x32_bf16 v[180:183], a[112:115], v[120:123], v[180:183]
s_waitcnt lgkmcnt(6)
ds_read_b128 a[80:83], v1 offset:20480
v_mfma_f32_16x16x32_bf16 v[180:183], a[116:119], v[124:127], v[180:183]
s_waitcnt lgkmcnt(6)
ds_read_b128 a[84:87], v1 offset:21504
v_mfma_f32_16x16x32_bf16 v[188:191], a[120:123], v[120:123], v[188:191]
s_waitcnt lgkmcnt(6)
ds_read_b128 a[88:91], v1 offset:22528
v_mfma_f32_16x16x32_bf16 v[188:191], a[124:127], v[124:127], v[188:191]
s_waitcnt lgkmcnt(6)
ds_read_b128 a[92:95], v1 offset:23552
v_mfma_f32_16x16x32_bf16 v[196:199], a[64:67], v[120:123], v[196:199]
s_waitcnt lgkmcnt(6)
ds_read_b128 a[96:99], v1 offset:24576
v_mfma_f32_16x16x32_bf16 v[196:199], a[68:71], v[124:127], v[196:199]
s_waitcnt lgkmcnt(6)
ds_read_b128 a[100:103], v1 offset:25600
v_mfma_f32_16x16x32_bf16 v[204:207], a[72:75], v[120:123], v[204:207]
s_waitcnt lgkmcnt(6)
ds_read_b128 a[104:107], v1 offset:26624
v_mfma_f32_16x16x32_bf16 v[204:207], a[76:79], v[124:127], v[204:207]
s_waitcnt lgkmcnt(6)
ds_read_b128 a[108:111], v1 offset:27648
v_mfma_f32_16x16x32_bf16 v[212:215], a[80:83], v[120:123], v[212:215]
s_waitcnt lgkmcnt(6)
ds_read_b128 a[112:115], v1 offset:28672
v_mfma_f32_16x16x32_bf16 v[212:215], a[84:87], v[124:127], v[212:215]
s_waitcnt lgkmcnt(6)
ds_read_b128 a[116:119], v1 offset:29696
v_mfma_f32_16x16x32_bf16 v[220:223], a[88:91], v[120:123], v[220:223]
s_waitcnt lgkmcnt(6)
ds_read_b128 a[120:123], v1 offset:30720
v_mfma_f32_16x16x32_bf16 v[220:223], a[92:95], v[124:127], v[220:223]
s_waitcnt lgkmcnt(6)
ds_read_b128 a[124:127], v1 offset:31744
v_mfma_f32_16x16x32_bf16 v[228:231], a[96:99], v[120:123], v[228:231]
s_waitcnt lgkmcnt(6)
v_mfma_f32_16x16x32_bf16 v[228:231], a[100:103], v[124:127], v[228:231]
s_waitcnt lgkmcnt(5)
v_mfma_f32_16x16x32_bf16 v[236:239], a[104:107], v[120:123], v[236:239]
s_waitcnt lgkmcnt(4)
v_mfma_f32_16x16x32_bf16 v[236:239], a[108:111], v[124:127], v[236:239]
s_waitcnt lgkmcnt(3)
v_mfma_f32_16x16x32_bf16 v[244:247], a[112:115], v[120:123], v[244:247]
s_waitcnt lgkmcnt(2)
v_mfma_f32_16x16x32_bf16 v[244:247], a[116:119], v[124:127], v[244:247]
s_waitcnt lgkmcnt(1)
v_mfma_f32_16x16x32_bf16 v[252:255], a[120:123], v[120:123], v[252:255]
s_waitcnt lgkmcnt(0)
v_mfma_f32_16x16x32_bf16 v[252:255], a[124:127], v[124:127], v[252:255]
v_mov_b32 v28, v24
s_nop 1
v_permlane16_swap_b32 v24, v28
v_add_f32 v24, v24, v28
v_mov_b32 v28, v24
s_nop 1
v_permlane32_swap_b32 v24, v28
v_add_f32 v24, v24, v28
v_mov_b32 v29, v25
s_nop 1
v_permlane16_swap_b32 v25, v29
v_add_f32 v25, v25, v29
v_mov_b32 v29, v25
s_nop 1
v_permlane32_swap_b32 v25, v29
v_add_f32 v25, v25, v29
s_lshl_b32 s23, s29, 3
s_add_u32 s23, s23, s3
s_lshl_b32 s23, s23, 17
s_lshl_b32 s22, s20, 13
s_add_u32 s23, s23, s22
s_add_u32 s23, s23, 50331648
s_cmp_lg_u32 s24, 1
s_cbranch_scc1 K2_plain
s_lshl_b32 s26, s27, 2
s_add_u32 s26, s26, s3
s_lshl_b32 s27, s26, 10
s_add_u32 s27, s27, 75497472
s_lshl_b32 s26, s26, 14
s_add_u32 s26, s26, 67108864
v_lshrrev_b32 v4, 4, v1
v_min_u32 v4, 0, v4
v_lshlrev_b32 v4, 2, v4
Lp_9001:
buffer_load_dword v3, v4, s[4:7], s28 offen sc1
s_waitcnt vmcnt(0)
v_cmp_ne_u32 vcc, 1, v3
s_cbranch_vccz Lpd_9002
s_sleep 4
s_sub_u32 s101, s101, 1
s_cbranch_scc0 Lp_9001
s_mov_b32 s101, 0
Lpd_9002:
buffer_load_dwordx4 v[8:11], v1, s[4:7], s27 offen sc1
s_add_u32 s22, s26, 0
buffer_load_dwordx4 a[0:3], v1, s[4:7], s22 offen offset:0 sc1
buffer_load_dwordx4 a[4:7], v1, s[4:7], s22 offen offset:1024 sc1
buffer_load_dwordx4 a[8:11], v1, s[4:7], s22 offen offset:2048 sc1
buffer_load_dwordx4 a[12:15], v1, s[4:7], s22 offen offset:3072 sc1
s_add_u32 s22, s26, 4096
buffer_load_dwordx4 a[16:19], v1, s[4:7], s22 offen offset:0 sc1
buffer_load_dwordx4 a[20:23], v1, s[4:7], s22 offen offset:1024 sc1
buffer_load_dwordx4 a[24:27], v1, s[4:7], s22 offen offset:2048 sc1
buffer_load_dwordx4 a[28:31], v1, s[4:7], s22 offen offset:3072 sc1
s_add_u32 s22, s26, 8192
buffer_load_dwordx4 a[32:35], v1, s[4:7], s22 offen offset:0 sc1
buffer_load_dwordx4 a[36:39], v1, s[4:7], s22 offen offset:1024 sc1
buffer_load_dwordx4 a[40:43], v1, s[4:7], s22 offen offset:2048 sc1
buffer_load_dwordx4 a[44:47], v1, s[4:7], s22 offen offset:3072 sc1
s_add_u32 s22, s26, 12288
buffer_load_dwordx4 a[48:51], v1, s[4:7], s22 offen offset:0 sc1
buffer_load_dwordx4 a[52:55], v1, s[4:7], s22 offen offset:1024 sc1
buffer_load_dwordx4 a[56:59], v1, s[4:7], s22 offen offset:2048 sc1
buffer_load_dwordx4 a[60:63], v1, s[4:7], s22 offen offset:3072 sc1
s_waitcnt vmcnt(16)
v_min_f32 v12, v16, v8
v_sub_f32 v13, v12, v16
v_sub_f32 v14, v12, v8
v_exp_f32 v13, v13
v_exp_f32 v14, v14
s_nop 0
v_mul_f32 v14, v14, v9
v_fma_f32 v12, v24, v13, v14
v_rcp_f32 v12, v12
s_nop 0
v_mul_f32 v3, v13, v12
v_mul_f32 v26, v14, v12
v_min_f32 v12, v20, v10
v_sub_f32 v13, v12, v20
v_sub_f32 v14, v12, v10
v_exp_f32 v13, v13
v_exp_f32 v14, v14
s_nop 0
v_mul_f32 v14, v14, v11
v_fma_f32 v12, v25, v13, v14
v_rcp_f32 v12, v12
s_nop 0
v_mul_f32 v4, v13, v12
v_mul_f32 v27, v14, v12
s_waitcnt vmcnt(0)
v_mov_b32 v28, v3
v_mov_b32 v29, v3
v_mov_b32 v30, v26
v_mov_b32 v31, v26
s_add_u32 s22, s23, 0
v_accvgpr_read_b32 v9, a0
v_accvgpr_read_b32 v11, a1
v_accvgpr_read_b32 v13, a2
v_accvgpr_read_b32 v15, a3
v_pk_mul_f32 v[128:129], v[128:129], v[28:29]
v_pk_mul_f32 v[130:131], v[130:131], v[28:29]
v_pk_mul_f32 v[136:137], v[136:137], v[28:29]
v_pk_mul_f32 v[138:139], v[138:139], v[28:29]
v_lshlrev_b32 v8, 16, v9
v_and_b32 v9, 0xffff0000, v9
v_lshlrev_b32 v10, 16, v11
v_and_b32 v11, 0xffff0000, v11
v_lshlrev_b32 v12, 16, v13
v_and_b32 v13, 0xffff0000, v13
v_lshlrev_b32 v14, 16, v15
v_and_b32 v15, 0xffff0000, v15
v_pk_fma_f32 v[128:129], v[8:9], v[30:31], v[128:129]
v_pk_fma_f32 v[130:131], v[10:11], v[30:31], v[130:131]
v_pk_fma_f32 v[136:137], v[12:13], v[30:31], v[136:137]
v_pk_fma_f32 v[138:139], v[14:15], v[30:31], v[138:139]
v_cvt_pk_bf16_f32 v128, v128, v129
v_cvt_pk_bf16_f32 v129, v130, v131
v_cvt_pk_bf16_f32 v130, v136, v137
v_cvt_pk_bf16_f32 v131, v138, v139
buffer_store_dwordx4 v[128:131], v1, s[4:7], s22 offen offset:0 sc1
v_accvgpr_read_b32 v9, a4
v_accvgpr_read_b32 v11, a5
v_accvgpr_read_b32 v13, a6
v_accvgpr_read_b32 v15, a7
v_pk_mul_f32 v[144:145], v[144:145], v[28:29]
v_pk_mul_f32 v[146:147], v[146:147], v[28:29]
v_pk_mul_f32 v[152:153], v[152:153], v[28:29]
v_pk_mul_f32 v[154:155], v[154:155], v[28:29]
v_lshlrev_b32 v8, 16, v9
v_and_b32 v9, 0xffff0000, v9
v_lshlrev_b32 v10, 16, v11
v_and_b32 v11, 0xffff0000, v11
v_lshlrev_b32 v12, 16, v13
v_and_b32 v13, 0xffff0000, v13
v_lshlrev_b32 v14, 16, v15
v_and_b32 v15, 0xffff0000, v15
v_pk_fma_f32 v[144:145], v[8:9], v[30:31], v[144:145]
v_pk_fma_f32 v[146:147], v[10:11], v[30:31], v[146:147]
v_pk_fma_f32 v[152:153], v[12:13], v[30:31], v[152:153]
v_pk_fma_f32 v[154:155], v[14:15], v[30:31], v[154:155]
v_cvt_pk_bf16_f32 v144, v144, v145
v_cvt_pk_bf16_f32 v145, v146, v147
v_cvt_pk_bf16_f32 v146, v152, v153
v_cvt_pk_bf16_f32 v147, v154, v155
buffer_store_dwordx4 v[144:147], v1, s[4:7], s22 offen offset:1024 sc1
v_accvgpr_read_b32 v9, a8
v_accvgpr_read_b32 v11, a9
v_accvgpr_read_b32 v13, a10
v_accvgpr_read_b32 v15, a11
v_pk_mul_f32 v[160:161], v[160:161], v[28:29]
v_pk_mul_f32 v[162:163], v[162:163], v[28:29]
v_pk_mul_f32 v[168:169], v[168:169], v[28:29]
v_pk_mul_f32 v[170:171], v[170:171], v[28:29]
v_lshlrev_b32 v8, 16, v9
v_and_b32 v9, 0xffff0000, v9
v_lshlrev_b32 v10, 16, v11
v_and_b32 v11, 0xffff0000, v11
v_lshlrev_b32 v12, 16, v13
v_and_b32 v13, 0xffff0000, v13
v_lshlrev_b32 v14, 16, v15
v_and_b32 v15, 0xffff0000, v15
v_pk_fma_f32 v[160:161], v[8:9], v[30:31], v[160:161]
v_pk_fma_f32 v[162:163], v[10:11], v[30:31], v[162:163]
v_pk_fma_f32 v[168:169], v[12:13], v[30:31], v[168:169]
v_pk_fma_f32 v[170:171], v[14:15], v[30:31], v[170:171]
v_cvt_pk_bf16_f32 v160, v160, v161
v_cvt_pk_bf16_f32 v161, v162, v163
v_cvt_pk_bf16_f32 v162, v168, v169
v_cvt_pk_bf16_f32 v163, v170, v171
buffer_store_dwordx4 v[160:163], v1, s[4:7], s22 offen offset:2048 sc1
v_accvgpr_read_b32 v9, a12
v_accvgpr_read_b32 v11, a13
v_accvgpr_read_b32 v13, a14
v_accvgpr_read_b32 v15, a15
v_pk_mul_f32 v[176:177], v[176:177], v[28:29]
v_pk_mul_f32 v[178:179], v[178:179], v[28:29]
v_pk_mul_f32 v[184:185], v[184:185], v[28:29]
v_pk_mul_f32 v[186:187], v[186:187], v[28:29]
v_lshlrev_b32 v8, 16, v9
v_and_b32 v9, 0xffff0000, v9
v_lshlrev_b32 v10, 16, v11
v_and_b32 v11, 0xffff0000, v11
v_lshlrev_b32 v12, 16, v13
v_and_b32 v13, 0xffff0000, v13
v_lshlrev_b32 v14, 16, v15
v_and_b32 v15, 0xffff0000, v15
v_pk_fma_f32 v[176:177], v[8:9], v[30:31], v[176:177]
v_pk_fma_f32 v[178:179], v[10:11], v[30:31], v[178:179]
v_pk_fma_f32 v[184:185], v[12:13], v[30:31], v[184:185]
v_pk_fma_f32 v[186:187], v[14:15], v[30:31], v[186:187]
v_cvt_pk_bf16_f32 v176, v176, v177
v_cvt_pk_bf16_f32 v177, v178, v179
v_cvt_pk_bf16_f32 v178, v184, v185
v_cvt_pk_bf16_f32 v179, v186, v187
buffer_store_dwordx4 v[176:179], v1, s[4:7], s22 offen offset:3072 sc1
s_add_u32 s22, s23, 4096
v_accvgpr_read_b32 v9, a16
v_accvgpr_read_b32 v11, a17
v_accvgpr_read_b32 v13, a18
v_accvgpr_read_b32 v15, a19
v_pk_mul_f32 v[192:193], v[192:193], v[28:29]
v_pk_mul_f32 v[194:195], v[194:195], v[28:29]
v_pk_mul_f32 v[200:201], v[200:201], v[28:29]
v_pk_mul_f32 v[202:203], v[202:203], v[28:29]
v_lshlrev_b32 v8, 16, v9
v_and_b32 v9, 0xffff0000, v9
v_lshlrev_b32 v10, 16, v11
v_and_b32 v11, 0xffff0000, v11
v_lshlrev_b32 v12, 16, v13
v_and_b32 v13, 0xffff0000, v13
v_lshlrev_b32 v14, 16, v15
v_and_b32 v15, 0xffff0000, v15
v_pk_fma_f32 v[192:193], v[8:9], v[30:31], v[192:193]
v_pk_fma_f32 v[194:195], v[10:11], v[30:31], v[194:195]
v_pk_fma_f32 v[200:201], v[12:13], v[30:31], v[200:201]
v_pk_fma_f32 v[202:203], v[14:15], v[30:31], v[202:203]
v_cvt_pk_bf16_f32 v192, v192, v193
v_cvt_pk_bf16_f32 v193, v194, v195
v_cvt_pk_bf16_f32 v194, v200, v201
v_cvt_pk_bf16_f32 v195, v202, v203
buffer_store_dwordx4 v[192:195], v1, s[4:7], s22 offen offset:0 sc1
v_accvgpr_read_b32 v9, a20
v_accvgpr_read_b32 v11, a21
v_accvgpr_read_b32 v13, a22
v_accvgpr_read_b32 v15, a23
v_pk_mul_f32 v[208:209], v[208:209], v[28:29]
v_pk_mul_f32 v[210:211], v[210:211], v[28:29]
v_pk_mul_f32 v[216:217], v[216:217], v[28:29]
v_pk_mul_f32 v[218:219], v[218:219], v[28:29]
v_lshlrev_b32 v8, 16, v9
v_and_b32 v9, 0xffff0000, v9
v_lshlrev_b32 v10, 16, v11
v_and_b32 v11, 0xffff0000, v11
v_lshlrev_b32 v12, 16, v13
v_and_b32 v13, 0xffff0000, v13
v_lshlrev_b32 v14, 16, v15
v_and_b32 v15, 0xffff0000, v15
v_pk_fma_f32 v[208:209], v[8:9], v[30:31], v[208:209]
v_pk_fma_f32 v[210:211], v[10:11], v[30:31], v[210:211]
v_pk_fma_f32 v[216:217], v[12:13], v[30:31], v[216:217]
v_pk_fma_f32 v[218:219], v[14:15], v[30:31], v[218:219]
v_cvt_pk_bf16_f32 v208, v208, v209
v_cvt_pk_bf16_f32 v209, v210, v211
v_cvt_pk_bf16_f32 v210, v216, v217
v_cvt_pk_bf16_f32 v211, v218, v219
buffer_store_dwordx4 v[208:211], v1, s[4:7], s22 offen offset:1024 sc1
v_accvgpr_read_b32 v9, a24
v_accvgpr_read_b32 v11, a25
v_accvgpr_read_b32 v13, a26
v_accvgpr_read_b32 v15, a27
v_pk_mul_f32 v[224:225], v[224:225], v[28:29]
v_pk_mul_f32 v[226:227], v[226:227], v[28:29]
v_pk_mul_f32 v[232:233], v[232:233], v[28:29]
v_pk_mul_f32 v[234:235], v[234:235], v[28:29]
v_lshlrev_b32 v8, 16, v9
v_and_b32 v9, 0xffff0000, v9
v_lshlrev_b32 v10, 16, v11
v_and_b32 v11, 0xffff0000, v11
v_lshlrev_b32 v12, 16, v13
v_and_b32 v13, 0xffff0000, v13
v_lshlrev_b32 v14, 16, v15
v_and_b32 v15, 0xffff0000, v15
v_pk_fma_f32 v[224:225], v[8:9], v[30:31], v[224:225]
v_pk_fma_f32 v[226:227], v[10:11], v[30:31], v[226:227]
v_pk_fma_f32 v[232:233], v[12:13], v[30:31], v[232:233]
v_pk_fma_f32 v[234:235], v[14:15], v[30:31], v[234:235]
v_cvt_pk_bf16_f32 v224, v224, v225
v_cvt_pk_bf16_f32 v225, v226, v227
v_cvt_pk_bf16_f32 v226, v232, v233
v_cvt_pk_bf16_f32 v227, v234, v235
buffer_store_dwordx4 v[224:227], v1, s[4:7], s22 offen offset:2048 sc1
v_accvgpr_read_b32 v9, a28
v_accvgpr_read_b32 v11, a29
v_accvgpr_read_b32 v13, a30
v_accvgpr_read_b32 v15, a31
v_pk_mul_f32 v[240:241], v[240:241], v[28:29]
v_pk_mul_f32 v[242:243], v[242:243], v[28:29]
v_pk_mul_f32 v[248:249], v[248:249], v[28:29]
v_pk_mul_f32 v[250:251], v[250:251], v[28:29]
v_lshlrev_b32 v8, 16, v9
v_and_b32 v9, 0xffff0000, v9
v_lshlrev_b32 v10, 16, v11
v_and_b32 v11, 0xffff0000, v11
v_lshlrev_b32 v12, 16, v13
v_and_b32 v13, 0xffff0000, v13
v_lshlrev_b32 v14, 16, v15
v_and_b32 v15, 0xffff0000, v15
v_pk_fma_f32 v[240:241], v[8:9], v[30:31], v[240:241]
v_pk_fma_f32 v[242:243], v[10:11], v[30:31], v[242:243]
v_pk_fma_f32 v[248:249], v[12:13], v[30:31], v[248:249]
v_pk_fma_f32 v[250:251], v[14:15], v[30:31], v[250:251]
v_cvt_pk_bf16_f32 v240, v240, v241
v_cvt_pk_bf16_f32 v241, v242, v243
v_cvt_pk_bf16_f32 v242, v248, v249
v_cvt_pk_bf16_f32 v243, v250, v251
buffer_store_dwordx4 v[240:243], v1, s[4:7], s22 offen offset:3072 sc1
v_mov_b32 v28, v4
v_mov_b32 v29, v4
v_mov_b32 v30, v27
v_mov_b32 v31, v27
s_add_u32 s22, s23, 524288
v_accvgpr_read_b32 v9, a32
v_accvgpr_read_b32 v11, a33
v_accvgpr_read_b32 v13, a34
v_accvgpr_read_b32 v15, a35
v_pk_mul_f32 v[132:133], v[132:133], v[28:29]
v_pk_mul_f32 v[134:135], v[134:135], v[28:29]
v_pk_mul_f32 v[140:141], v[140:141], v[28:29]
v_pk_mul_f32 v[142:143], v[142:143], v[28:29]
v_lshlrev_b32 v8, 16, v9
v_and_b32 v9, 0xffff0000, v9
v_lshlrev_b32 v10, 16, v11
v_and_b32 v11, 0xffff0000, v11
v_lshlrev_b32 v12, 16, v13
v_and_b32 v13, 0xffff0000, v13
v_lshlrev_b32 v14, 16, v15
v_and_b32 v15, 0xffff0000, v15
v_pk_fma_f32 v[132:133], v[8:9], v[30:31], v[132:133]
v_pk_fma_f32 v[134:135], v[10:11], v[30:31], v[134:135]
v_pk_fma_f32 v[140:141], v[12:13], v[30:31], v[140:141]
v_pk_fma_f32 v[142:143], v[14:15], v[30:31], v[142:143]
v_cvt_pk_bf16_f32 v132, v132, v133
v_cvt_pk_bf16_f32 v133, v134, v135
v_cvt_pk_bf16_f32 v134, v140, v141
v_cvt_pk_bf16_f32 v135, v142, v143
buffer_store_dwordx4 v[132:135], v1, s[4:7], s22 offen offset:0 sc1
v_accvgpr_read_b32 v9, a36
v_accvgpr_read_b32 v11, a37
v_accvgpr_read_b32 v13, a38
v_accvgpr_read_b32 v15, a39
v_pk_mul_f32 v[148:149], v[148:149], v[28:29]
v_pk_mul_f32 v[150:151], v[150:151], v[28:29]
v_pk_mul_f32 v[156:157], v[156:157], v[28:29]
v_pk_mul_f32 v[158:159], v[158:159], v[28:29]
v_lshlrev_b32 v8, 16, v9
v_and_b32 v9, 0xffff0000, v9
v_lshlrev_b32 v10, 16, v11
v_and_b32 v11, 0xffff0000, v11
v_lshlrev_b32 v12, 16, v13
v_and_b32 v13, 0xffff0000, v13
v_lshlrev_b32 v14, 16, v15
v_and_b32 v15, 0xffff0000, v15
v_pk_fma_f32 v[148:149], v[8:9], v[30:31], v[148:149]
v_pk_fma_f32 v[150:151], v[10:11], v[30:31], v[150:151]
v_pk_fma_f32 v[156:157], v[12:13], v[30:31], v[156:157]
v_pk_fma_f32 v[158:159], v[14:15], v[30:31], v[158:159]
v_cvt_pk_bf16_f32 v148, v148, v149
v_cvt_pk_bf16_f32 v149, v150, v151
v_cvt_pk_bf16_f32 v150, v156, v157
v_cvt_pk_bf16_f32 v151, v158, v159
buffer_store_dwordx4 v[148:151], v1, s[4:7], s22 offen offset:1024 sc1
v_accvgpr_read_b32 v9, a40
v_accvgpr_read_b32 v11, a41
v_accvgpr_read_b32 v13, a42
v_accvgpr_read_b32 v15, a43
v_pk_mul_f32 v[164:165], v[164:165], v[28:29]
v_pk_mul_f32 v[166:167], v[166:167], v[28:29]
v_pk_mul_f32 v[172:173], v[172:173], v[28:29]
v_pk_mul_f32 v[174:175], v[174:175], v[28:29]
v_lshlrev_b32 v8, 16, v9
v_and_b32 v9, 0xffff0000, v9
v_lshlrev_b32 v10, 16, v11
v_and_b32 v11, 0xffff0000, v11
v_lshlrev_b32 v12, 16, v13
v_and_b32 v13, 0xffff0000, v13
v_lshlrev_b32 v14, 16, v15
v_and_b32 v15, 0xffff0000, v15
v_pk_fma_f32 v[164:165], v[8:9], v[30:31], v[164:165]
v_pk_fma_f32 v[166:167], v[10:11], v[30:31], v[166:167]
v_pk_fma_f32 v[172:173], v[12:13], v[30:31], v[172:173]
v_pk_fma_f32 v[174:175], v[14:15], v[30:31], v[174:175]
v_cvt_pk_bf16_f32 v164, v164, v165
v_cvt_pk_bf16_f32 v165, v166, v167
v_cvt_pk_bf16_f32 v166, v172, v173
v_cvt_pk_bf16_f32 v167, v174, v175
buffer_store_dwordx4 v[164:167], v1, s[4:7], s22 offen offset:2048 sc1
v_accvgpr_read_b32 v9, a44
v_accvgpr_read_b32 v11, a45
v_accvgpr_read_b32 v13, a46
v_accvgpr_read_b32 v15, a47
v_pk_mul_f32 v[180:181], v[180:181], v[28:29]
v_pk_mul_f32 v[182:183], v[182:183], v[28:29]
v_pk_mul_f32 v[188:189], v[188:189], v[28:29]
v_pk_mul_f32 v[190:191], v[190:191], v[28:29]
v_lshlrev_b32 v8, 16, v9
v_and_b32 v9, 0xffff0000, v9
v_lshlrev_b32 v10, 16, v11
v_and_b32 v11, 0xffff0000, v11
v_lshlrev_b32 v12, 16, v13
v_and_b32 v13, 0xffff0000, v13
v_lshlrev_b32 v14, 16, v15
v_and_b32 v15, 0xffff0000, v15
v_pk_fma_f32 v[180:181], v[8:9], v[30:31], v[180:181]
v_pk_fma_f32 v[182:183], v[10:11], v[30:31], v[182:183]
v_pk_fma_f32 v[188:189], v[12:13], v[30:31], v[188:189]
v_pk_fma_f32 v[190:191], v[14:15], v[30:31], v[190:191]
v_cvt_pk_bf16_f32 v180, v180, v181
v_cvt_pk_bf16_f32 v181, v182, v183
v_cvt_pk_bf16_f32 v182, v188, v189
v_cvt_pk_bf16_f32 v183, v190, v191
buffer_store_dwordx4 v[180:183], v1, s[4:7], s22 offen offset:3072 sc1
s_add_u32 s22, s23, 528384
v_accvgpr_read_b32 v9, a48
v_accvgpr_read_b32 v11, a49
v_accvgpr_read_b32 v13, a50
v_accvgpr_read_b32 v15, a51
v_pk_mul_f32 v[196:197], v[196:197], v[28:29]
v_pk_mul_f32 v[198:199], v[198:199], v[28:29]
v_pk_mul_f32 v[204:205], v[204:205], v[28:29]
v_pk_mul_f32 v[206:207], v[206:207], v[28:29]
v_lshlrev_b32 v8, 16, v9
v_and_b32 v9, 0xffff0000, v9
v_lshlrev_b32 v10, 16, v11
v_and_b32 v11, 0xffff0000, v11
v_lshlrev_b32 v12, 16, v13
v_and_b32 v13, 0xffff0000, v13
v_lshlrev_b32 v14, 16, v15
v_and_b32 v15, 0xffff0000, v15
v_pk_fma_f32 v[196:197], v[8:9], v[30:31], v[196:197]
v_pk_fma_f32 v[198:199], v[10:11], v[30:31], v[198:199]
v_pk_fma_f32 v[204:205], v[12:13], v[30:31], v[204:205]
v_pk_fma_f32 v[206:207], v[14:15], v[30:31], v[206:207]
v_cvt_pk_bf16_f32 v196, v196, v197
v_cvt_pk_bf16_f32 v197, v198, v199
v_cvt_pk_bf16_f32 v198, v204, v205
v_cvt_pk_bf16_f32 v199, v206, v207
buffer_store_dwordx4 v[196:199], v1, s[4:7], s22 offen offset:0 sc1
v_accvgpr_read_b32 v9, a52
v_accvgpr_read_b32 v11, a53
v_accvgpr_read_b32 v13, a54
v_accvgpr_read_b32 v15, a55
v_pk_mul_f32 v[212:213], v[212:213], v[28:29]
v_pk_mul_f32 v[214:215], v[214:215], v[28:29]
v_pk_mul_f32 v[220:221], v[220:221], v[28:29]
v_pk_mul_f32 v[222:223], v[222:223], v[28:29]
v_lshlrev_b32 v8, 16, v9
v_and_b32 v9, 0xffff0000, v9
v_lshlrev_b32 v10, 16, v11
v_and_b32 v11, 0xffff0000, v11
v_lshlrev_b32 v12, 16, v13
v_and_b32 v13, 0xffff0000, v13
v_lshlrev_b32 v14, 16, v15
v_and_b32 v15, 0xffff0000, v15
v_pk_fma_f32 v[212:213], v[8:9], v[30:31], v[212:213]
v_pk_fma_f32 v[214:215], v[10:11], v[30:31], v[214:215]
v_pk_fma_f32 v[220:221], v[12:13], v[30:31], v[220:221]
v_pk_fma_f32 v[222:223], v[14:15], v[30:31], v[222:223]
v_cvt_pk_bf16_f32 v212, v212, v213
v_cvt_pk_bf16_f32 v213, v214, v215
v_cvt_pk_bf16_f32 v214, v220, v221
v_cvt_pk_bf16_f32 v215, v222, v223
buffer_store_dwordx4 v[212:215], v1, s[4:7], s22 offen offset:1024 sc1
v_accvgpr_read_b32 v9, a56
v_accvgpr_read_b32 v11, a57
v_accvgpr_read_b32 v13, a58
v_accvgpr_read_b32 v15, a59
v_pk_mul_f32 v[228:229], v[228:229], v[28:29]
v_pk_mul_f32 v[230:231], v[230:231], v[28:29]
v_pk_mul_f32 v[236:237], v[236:237], v[28:29]
v_pk_mul_f32 v[238:239], v[238:239], v[28:29]
v_lshlrev_b32 v8, 16, v9
v_and_b32 v9, 0xffff0000, v9
v_lshlrev_b32 v10, 16, v11
v_and_b32 v11, 0xffff0000, v11
v_lshlrev_b32 v12, 16, v13
v_and_b32 v13, 0xffff0000, v13
v_lshlrev_b32 v14, 16, v15
v_and_b32 v15, 0xffff0000, v15
v_pk_fma_f32 v[228:229], v[8:9], v[30:31], v[228:229]
v_pk_fma_f32 v[230:231], v[10:11], v[30:31], v[230:231]
v_pk_fma_f32 v[236:237], v[12:13], v[30:31], v[236:237]
v_pk_fma_f32 v[238:239], v[14:15], v[30:31], v[238:239]
v_cvt_pk_bf16_f32 v228, v228, v229
v_cvt_pk_bf16_f32 v229, v230, v231
v_cvt_pk_bf16_f32 v230, v236, v237
v_cvt_pk_bf16_f32 v231, v238, v239
buffer_store_dwordx4 v[228:231], v1, s[4:7], s22 offen offset:2048 sc1
v_accvgpr_read_b32 v9, a60
v_accvgpr_read_b32 v11, a61
v_accvgpr_read_b32 v13, a62
v_accvgpr_read_b32 v15, a63
v_pk_mul_f32 v[244:245], v[244:245], v[28:29]
v_pk_mul_f32 v[246:247], v[246:247], v[28:29]
v_pk_mul_f32 v[252:253], v[252:253], v[28:29]
v_pk_mul_f32 v[254:255], v[254:255], v[28:29]
v_lshlrev_b32 v8, 16, v9
v_and_b32 v9, 0xffff0000, v9
v_lshlrev_b32 v10, 16, v11
v_and_b32 v11, 0xffff0000, v11
v_lshlrev_b32 v12, 16, v13
v_and_b32 v13, 0xffff0000, v13
v_lshlrev_b32 v14, 16, v15
v_and_b32 v15, 0xffff0000, v15
v_pk_fma_f32 v[244:245], v[8:9], v[30:31], v[244:245]
v_pk_fma_f32 v[246:247], v[10:11], v[30:31], v[246:247]
v_pk_fma_f32 v[252:253], v[12:13], v[30:31], v[252:253]
v_pk_fma_f32 v[254:255], v[14:15], v[30:31], v[254:255]
v_cvt_pk_bf16_f32 v244, v244, v245
v_cvt_pk_bf16_f32 v245, v246, v247
v_cvt_pk_bf16_f32 v246, v252, v253
v_cvt_pk_bf16_f32 v247, v254, v255
buffer_store_dwordx4 v[244:247], v1, s[4:7], s22 offen offset:3072 sc1
K2_done:
s_lshl_b32 s34, s29, 5
s_add_u32 s34, s34, s20
s_lshl_b32 s34, s34, 2
s_add_u32 s34, s34, 94380032
s_and_b32 s22, s2, 0xd0
s_cmp_eq_u32 s22, 0xd0
s_cbranch_scc1 M_final
s_mov_b32 s8, s86
s_mov_b32 s9, s87
s_mov_b32 s10, 3670016
s_mov_b32 s11, 0x20000
s_mov_b32 s12, s88
s_mov_b32 s13, s89
s_mov_b32 s14, 3670016
s_mov_b32 s15, 0x20000
s_lshr_b32 s22, s2, 3
s_cmp_ge_u32 s22, 28
s_cselect_b32 s23, 2, 0
s_sub_u32 s22, s22, s23
s_lshr_b32 s25, s22, 2
s_and_b32 s22, s22, 3
s_and_b32 s24, s2, 7
s_lshl_b32 s24, s24, 2
s_add_u32 s24, s24, s22
s_lshl_b32 s22, s22, 1
s_add_u32 s30, s22, s25
s_lshl_b32 s30, s30, 1
v_lshrrev_b32 v20, 4, v1
v_mov_b32 v8, v1
v_add_u32 v9, 131072, v1
v_add_u32 v10, 262144, v1
v_add_u32 v11, 393216, v1
v_lshrrev_b32 v2, 3, v20
v_and_b32 v3, 6, v2
v_and_b32 v4, 7, v20
v_xor_b32 v3, v3, v4
v_lshlrev_b32 v3, 4, v3
v_mul_u32_u24 v2, 896, v2
v_add_u32 v12, v2, v3
v_add_u32 v13, 6144, v12
v_add_u32 v14, 12288, v12
v_add_u32 v15, 18432, v12
v_lshrrev_b32 v2, 2, v20
v_bfe_u32 v3, v20, 3, 2
v_lshlrev_b32 v3, 5, v3
v_lshl_add_u32 v2, v2, 7, v3
v_and_b32 v3, 3, v20
v_lshl_add_u32 v2, v3, 3, v2
s_mul_i32 s29, s3, 40960
v_add_u32 v16, s29, v2
v_xor_b32 v17, 32, v16
v_xor_b32 v18, 64, v16
v_xor_b32 v19, 96, v16
s_lshl_b32 s31, s24, 19
s_lshl_b32 s22, s3, 15
s_add_u32 s31, s31, s22
s_add_u32 s31, s31, 50331648
s_mul_i32 s32, s3, 917504
s_lshl_b32 s22, s25, 7
s_add_u32 s32, s32, s22
s_barrier
s_add_u32 s22, s30, 0
s_and_b32 s22, s22, 15
s_mul_i32 s22, s22, 57344
s_add_u32 s27, s32, s22
s_add_u32 s28, s27, 28672
s_add_u32 m0, s29, 0
s_nop 0
buffer_load_dwordx4 v12, s[8:11], s27 offen offset:0 lds
buffer_load_dwordx4 v13, s[8:11], s27 offen offset:1024 lds
buffer_load_dwordx4 v14, s[8:11], s27 offen offset:2048 lds
buffer_load_dwordx4 v15, s[8:11], s27 offen offset:3072 lds
s_add_u32 m0, s29, 4096
s_nop 0
buffer_load_dwordx4 v12, s[8:11], s28 offen offset:0 lds
buffer_load_dwordx4 v13, s[8:11], s28 offen offset:1024 lds
buffer_load_dwordx4 v14, s[8:11], s28 offen offset:2048 lds
buffer_load_dwordx4 v15, s[8:11], s28 offen offset:3072 lds
s_add_u32 s22, s30, 1
s_and_b32 s22, s22, 15
s_mul_i32 s22, s22, 57344
s_add_u32 s27, s32, s22
s_add_u32 s28, s27, 28672
s_add_u32 m0, s29, 8192
s_nop 0
buffer_load_dwordx4 v12, s[8:11], s27 offen offset:0 lds
buffer_load_dwordx4 v13, s[8:11], s27 offen offset:1024 lds
buffer_load_dwordx4 v14, s[8:11], s27 offen offset:2048 lds
buffer_load_dwordx4 v15, s[8:11], s27 offen offset:3072 lds
s_add_u32 m0, s29, 12288
s_nop 0
buffer_load_dwordx4 v12, s[8:11], s28 offen offset:0 lds
buffer_load_dwordx4 v13, s[8:11], s28 offen offset:1024 lds
buffer_load_dwordx4 v14, s[8:11], s28 offen offset:2048 lds
buffer_load_dwordx4 v15, s[8:11], s28 offen offset:3072 lds
s_add_u32 s22, s30, 2
s_and_b32 s22, s22, 15
s_mul_i32 s22, s22, 57344
s_add_u32 s27, s32, s22
s_add_u32 s28, s27, 28672
s_add_u32 m0, s29, 16384
s_nop 0
buffer_load_dwordx4 v12, s[8:11], s27 offen offset:0 lds
buffer_load_dwordx4 v13, s[8:11], s27 offen offset:1024 lds
buffer_load_dwordx4 v14, s[8:11], s27 offen offset:2048 lds
buffer_load_dwordx4 v15, s[8:11], s27 offen offset:3072 lds
s_add_u32 m0, s29, 20480
s_nop 0
buffer_load_dwordx4 v12, s[8:11], s28 offen offset:0 lds
buffer_load_dwordx4 v13, s[8:11], s28 offen offset:1024 lds
buffer_load_dwordx4 v14, s[8:11], s28 offen offset:2048 lds
buffer_load_dwordx4 v15, s[8:11], s28 offen offset:3072 lds
s_add_u32 s22, s30, 3
s_and_b32 s22, s22, 15
s_mul_i32 s22, s22, 57344
s_add_u32 s27, s32, s22
s_add_u32 s28, s27, 28672
s_add_u32 m0, s29, 24576
s_nop 0
buffer_load_dwordx4 v12, s[8:11], s27 offen offset:0 lds
buffer_load_dwordx4 v13, s[8:11], s27 offen offset:1024 lds
buffer_load_dwordx4 v14, s[8:11], s27 offen offset:2048 lds
buffer_load_dwordx4 v15, s[8:11], s27 offen offset:3072 lds
s_add_u32 m0, s29, 28672
s_nop 0
buffer_load_dwordx4 v12, s[8:11], s28 offen offset:0 lds
buffer_load_dwordx4 v13, s[8:11], s28 offen offset:1024 lds
buffer_load_dwordx4 v14, s[8:11], s28 offen offset:2048 lds
buffer_load_dwordx4 v15, s[8:11], s28 offen offset:3072 lds
s_add_u32 s22, s30, 4
s_and_b32 s22, s22, 15
s_mul_i32 s22, s22, 57344
s_add_u32 s27, s32, s22
s_add_u32 s28, s27, 28672
s_add_u32 m0, s29, 32768
s_nop 0
buffer_load_dwordx4 v12, s[8:11], s27 offen offset:0 lds
buffer_load_dwordx4 v13, s[8:11], s27 offen offset:1024 lds
buffer_load_dwordx4 v14, s[8:11], s27 offen offset:2048 lds
buffer_load_dwordx4 v15, s[8:11], s27 offen offset:3072 lds
s_add_u32 m0, s29, 36864
s_nop 0
buffer_load_dwordx4 v12, s[8:11], s28 offen offset:0 lds
buffer_load_dwordx4 v13, s[8:11], s28 offen offset:1024 lds
buffer_load_dwordx4 v14, s[8:11], s28 offen offset:2048 lds
buffer_load_dwordx4 v15, s[8:11], s28 offen offset:3072 lds
s_waitcnt vmcnt(40)
s_barrier
buffer_store_dword v6, v5, s[4:7], s34 offen sc1
s_lshr_b32 s22, s24, 1
s_lshl_b32 s22, s22, 7
s_add_u32 s33, s22, 94380032
v_lshrrev_b32 v4, 4, v1
v_min_u32 v4, 15, v4
v_lshlrev_b32 v4, 2, v4
Lp_9201:
buffer_load_dword v3, v4, s[4:7], s33 offen sc1
s_waitcnt vmcnt(0)
v_cmp_ne_u32 vcc, 1, v3
s_cbranch_vccz Lpd_9202
s_sleep 4
s_sub_u32 s101, s101, 1
s_cbranch_scc0 Lp_9201
s_mov_b32 s101, 0
Lpd_9202:
s_add_u32 s23, s30, 0
s_and_b32 s23, s23, 15
s_lshl_b32 s23, s23, 11
s_add_u32 s26, s31, s23
buffer_load_dwordx4 a[0:3], v8, s[4:7], s26 offen offset:0 sc1
buffer_load_dwordx4 a[4:7], v8, s[4:7], s26 offen offset:1024 sc1
buffer_load_dwordx4 a[8:11], v9, s[4:7], s26 offen offset:0 sc1
buffer_load_dwordx4 a[12:15], v9, s[4:7], s26 offen offset:1024 sc1
buffer_load_dwordx4 a[16:19], v10, s[4:7], s26 offen offset:0 sc1
buffer_load_dwordx4 a[20:23], v10, s[4:7], s26 offen offset:1024 sc1
buffer_load_dwordx4 a[24:27], v11, s[4:7], s26 offen offset:0 sc1
buffer_load_dwordx4 a[28:31], v11, s[4:7], s26 offen offset:1024 sc1
s_add_u32 s23, s30, 1
s_and_b32 s23, s23, 15
s_lshl_b32 s23, s23, 11
s_add_u32 s26, s31, s23
buffer_load_dwordx4 a[32:35], v8, s[4:7], s26 offen offset:0 sc1
buffer_load_dwordx4 a[36:39], v8, s[4:7], s26 offen offset:1024 sc1
buffer_load_dwordx4 a[40:43], v9, s[4:7], s26 offen offset:0 sc1
buffer_load_dwordx4 a[44:47], v9, s[4:7], s26 offen offset:1024 sc1
buffer_load_dwordx4 a[48:51], v10, s[4:7], s26 offen offset:0 sc1
buffer_load_dwordx4 a[52:55], v10, s[4:7], s26 offen offset:1024 sc1
buffer_load_dwordx4 a[56:59], v11, s[4:7], s26 offen offset:0 sc1
buffer_load_dwordx4 a[60:63], v11, s[4:7], s26 offen offset:1024 sc1
s_add_u32 s23, s30, 2
s_and_b32 s23, s23, 15
s_lshl_b32 s23, s23, 11
s_add_u32 s26, s31, s23
buffer_load_dwordx4 a[64:67], v8, s[4:7], s26 offen offset:0 sc1
buffer_load_dwordx4 a[68:71], v8, s[4:7], s26 offen offset:1024 sc1
buffer_load_dwordx4 a[72:75], v9, s[4:7], s26 offen offset:0 sc1
buffer_load_dwordx4 a[76:79], v9, s[4:7], s26 offen offset:1024 sc1
buffer_load_dwordx4 a[80:83], v10, s[4:7], s26 offen offset:0 sc1
buffer_load_dwordx4 a[84:87], v10, s[4:7], s26 offen offset:1024 sc1
buffer_load_dwordx4 a[88:91], v11, s[4:7], s26 offen offset:0 sc1
buffer_load_dwordx4 a[92:95], v11, s[4:7], s26 offen offset:1024 sc1
ds_read_b64_tr_b16 a[128:129], v16 offset:0
ds_read_b64_tr_b16 a[130:131], v16 offset:2048
ds_read_b64_tr_b16 a[132:133], v16 offset:4096
ds_read_b64_tr_b16 a[134:135], v16 offset:6144
ds_read_b64_tr_b16 a[136:137], v17 offset:0
ds_read_b64_tr_b16 a[138:139], v17 offset:2048
ds_read_b64_tr_b16 a[140:141], v17 offset:4096
ds_read_b64_tr_b16 a[142:143], v17 offset:6144
ds_read_b64_tr_b16 a[144:145], v18 offset:0
ds_read_b64_tr_b16 a[146:147], v18 offset:2048
ds_read_b64_tr_b16 a[148:149], v18 offset:4096
ds_read_b64_tr_b16 a[150:151], v18 offset:6144
ds_read_b64_tr_b16 a[152:153], v19 offset:0
ds_read_b64_tr_b16 a[154:155], v19 offset:2048
ds_read_b64_tr_b16 a[156:157], v19 offset:4096
ds_read_b64_tr_b16 a[158:159], v19 offset:6144
s_waitcnt vmcnt(16) lgkmcnt(0)
v_mfma_f32_16x16x32_bf16 v[32:35], a[128:131], a[0:3], 0
s_add_u32 s23, s30, 3
s_and_b32 s23, s23, 15
s_lshl_b32 s23, s23, 11
s_add_u32 s26, s31, s23
ds_read_b64_tr_b16 a[160:161], v16 offset:8192
v_mfma_f32_16x16x32_bf16 v[32:35], a[132:135], a[4:7], v[32:35]
buffer_load_dwordx4 a[96:99], v8, s[4:7], s26 offen offset:0 sc1
v_mfma_f32_16x16x32_bf16 v[36:39], a[128:131], a[8:11], 0
ds_read_b64_tr_b16 a[162:163], v16 offset:10240
v_mfma_f32_16x16x32_bf16 v[36:39], a[132:135], a[12:15], v[36:39]
buffer_load_dwordx4 a[100:103], v8, s[4:7], s26 offen offset:1024 sc1
v_mfma_f32_16x16x32_bf16 v[40:43], a[128:131], a[16:19], 0
ds_read_b64_tr_b16 a[164:165], v16 offset:12288
v_mfma_f32_16x16x32_bf16 v[40:43], a[132:135], a[20:23], v[40:43]
buffer_load_dwordx4 a[104:107], v9, s[4:7], s26 offen offset:0 sc1
v_mfma_f32_16x16x32_bf16 v[44:47], a[128:131], a[24:27], 0
ds_read_b64_tr_b16 a[166:167], v16 offset:14336
v_mfma_f32_16x16x32_bf16 v[44:47], a[132:135], a[28:31], v[44:47]
buffer_load_dwordx4 a[108:111], v9, s[4:7], s26 offen offset:1024 sc1
v_mfma_f32_16x16x32_bf16 v[48:51], a[136:139], a[0:3], 0
ds_read_b64_tr_b16 a[168:169], v17 offset:8192
v_mfma_f32_16x16x32_bf16 v[48:51], a[140:143], a[4:7], v[48:51]
buffer_load_dwordx4 a[112:115], v10, s[4:7], s26 offen offset:0 sc1
v_mfma_f32_16x16x32_bf16 v[52:55], a[136:139], a[8:11], 0
ds_read_b64_tr_b16 a[170:171], v17 offset:10240
v_mfma_f32_16x16x32_bf16 v[52:55], a[140:143], a[12:15], v[52:55]
buffer_load_dwordx4 a[116:119], v10, s[4:7], s26 offen offset:1024 sc1
v_mfma_f32_16x16x32_bf16 v[56:59], a[136:139], a[16:19], 0
ds_read_b64_tr_b16 a[172:173], v17 offset:12288
v_mfma_f32_16x16x32_bf16 v[56:59], a[140:143], a[20:23], v[56:59]
buffer_load_dwordx4 a[120:123], v11, s[4:7], s26 offen offset:0 sc1
v_mfma_f32_16x16x32_bf16 v[60:63], a[136:139], a[24:27], 0
ds_read_b64_tr_b16 a[174:175], v17 offset:14336
v_mfma_f32_16x16x32_bf16 v[60:63], a[140:143], a[28:31], v[60:63]
buffer_load_dwordx4 a[124:127], v11, s[4:7], s26 offen offset:1024 sc1
v_mfma_f32_16x16x32_bf16 v[64:67], a[144:147], a[0:3], 0
s_add_u32 s22, s30, 5
s_and_b32 s22, s22, 15
s_mul_i32 s22, s22, 57344
s_add_u32 s27, s32, s22
s_add_u32 s28, s27, 28672
s_add_u32 m0, s29, 0
ds_read_b64_tr_b16 a[176:177], v18 offset:8192
v_mfma_f32_16x16x32_bf16 v[64:67], a[148:151], a[4:7], v[64:67]
buffer_load_dwordx4 v12, s[8:11], s27 offen offset:0 lds
v_mfma_f32_16x16x32_bf16 v[68:71], a[144:147], a[8:11], 0
ds_read_b64_tr_b16 a[178:179], v18 offset:10240
v_mfma_f32_16x16x32_bf16 v[68:71], a[148:151], a[12:15], v[68:71]
buffer_load_dwordx4 v13, s[8:11], s27 offen offset:1024 lds
v_mfma_f32_16x16x32_bf16 v[72:75], a[144:147], a[16:19], 0
ds_read_b64_tr_b16 a[180:181], v18 offset:12288
v_mfma_f32_16x16x32_bf16 v[72:75], a[148:151], a[20:23], v[72:75]
buffer_load_dwordx4 v14, s[8:11], s27 offen offset:2048 lds
v_mfma_f32_16x16x32_bf16 v[76:79], a[144:147], a[24:27], 0
ds_read_b64_tr_b16 a[182:183], v18 offset:14336
v_mfma_f32_16x16x32_bf16 v[76:79], a[148:151], a[28:31], v[76:79]
buffer_load_dwordx4 v15, s[8:11], s27 offen offset:3072 lds
v_mfma_f32_16x16x32_bf16 v[80:83], a[152:155], a[0:3], 0
s_add_u32 m0, s29, 4096
ds_read_b64_tr_b16 a[184:185], v19 offset:8192
v_mfma_f32_16x16x32_bf16 v[80:83], a[156:159], a[4:7], v[80:83]
buffer_load_dwordx4 v12, s[8:11], s28 offen offset:0 lds
v_mfma_f32_16x16x32_bf16 v[84:87], a[152:155], a[8:11], 0
ds_read_b64_tr_b16 a[186:187], v19 offset:10240
v_mfma_f32_16x16x32_bf16 v[84:87], a[156:159], a[12:15], v[84:87]
buffer_load_dwordx4 v13, s[8:11], s28 offen offset:1024 lds
v_mfma_f32_16x16x32_bf16 v[88:91], a[152:155], a[16:19], 0
ds_read_b64_tr_b16 a[188:189], v19 offset:12288
v_mfma_f32_16x16x32_bf16 v[88:91], a[156:159], a[20:23], v[88:91]
buffer_load_dwordx4 v14, s[8:11], s28 offen offset:2048 lds
v_mfma_f32_16x16x32_bf16 v[92:95], a[152:155], a[24:27], 0
ds_read_b64_tr_b16 a[190:191], v19 offset:14336
v_mfma_f32_16x16x32_bf16 v[92:95], a[156:159], a[28:31], v[92:95]
buffer_load_dwordx4 v15, s[8:11], s28 offen offset:3072 lds
s_waitcnt vmcnt(24) lgkmcnt(0)
v_mfma_f32_16x16x32_bf16 v[32:35], a[160:163], a[32:35], v[32:35]
s_add_u32 s23, s30, 4
s_and_b32 s23, s23, 15
s_lshl_b32 s23, s23, 11
s_add_u32 s26, s31, s23
ds_read_b64_tr_b16 a[128:129], v16 offset:16384
v_mfma_f32_16x16x32_bf16 v[32:35], a[164:167], a[36:39], v[32:35]
buffer_load_dwordx4 a[0:3], v8, s[4:7], s26 offen offset:0 sc1
v_mfma_f32_16x16x32_bf16 v[36:39], a[160:163], a[40:43], v[36:39]
ds_read_b64_tr_b16 a[130:131], v16 offset:18432
v_mfma_f32_16x16x32_bf16 v[36:39], a[164:167], a[44:47], v[36:39]
buffer_load_dwordx4 a[4:7], v8, s[4:7], s26 offen offset:1024 sc1
v_mfma_f32_16x16x32_bf16 v[40:43], a[160:163], a[48:51], v[40:43]
ds_read_b64_tr_b16 a[132:133], v16 offset:20480
v_mfma_f32_16x16x32_bf16 v[40:43], a[164:167], a[52:55], v[40:43]
buffer_load_dwordx4 a[8:11], v9, s[4:7], s26 offen offset:0 sc1
v_mfma_f32_16x16x32_bf16 v[44:47], a[160:163], a[56:59], v[44:47]
ds_read_b64_tr_b16 a[134:135], v16 offset:22528
v_mfma_f32_16x16x32_bf16 v[44:47], a[164:167], a[60:63], v[44:47]
buffer_load_dwordx4 a[12:15], v9, s[4:7], s26 offen offset:1024 sc1
v_mfma_f32_16x16x32_bf16 v[48:51], a[168:171], a[32:35], v[48:51]
ds_read_b64_tr_b16 a[136:137], v17 offset:16384
v_mfma_f32_16x16x32_bf16 v[48:51], a[172:175], a[36:39], v[48:51]
buffer_load_dwordx4 a[16:19], v10, s[4:7], s26 offen offset:0 sc1
v_mfma_f32_16x16x32_bf16 v[52:55], a[168:171], a[40:43], v[52:55]
ds_read_b64_tr_b16 a[138:139], v17 offset:18432
v_mfma_f32_16x16x32_bf16 v[52:55], a[172:175], a[44:47], v[52:55]
buffer_load_dwordx4 a[20:23], v10, s[4:7], s26 offen offset:1024 sc1
v_mfma_f32_16x16x32_bf16 v[56:59], a[168:171], a[48:51], v[56:59]
ds_read_b64_tr_b16 a[140:141], v17 offset:20480
v_mfma_f32_16x16x32_bf16 v[56:59], a[172:175], a[52:55], v[56:59]
buffer_load_dwordx4 a[24:27], v11, s[4:7], s26 offen offset:0 sc1
v_mfma_f32_16x16x32_bf16 v[60:63], a[168:171], a[56:59], v[60:63]
ds_read_b64_tr_b16 a[142:143], v17 offset:22528
v_mfma_f32_16x16x32_bf16 v[60:63], a[172:175], a[60:63], v[60:63]
buffer_load_dwordx4 a[28:31], v11, s[4:7], s26 offen offset:1024 sc1
v_mfma_f32_16x16x32_bf16 v[64:67], a[176:179], a[32:35], v[64:67]
s_add_u32 s22, s30, 6
s_and_b32 s22, s22, 15
s_mul_i32 s22, s22, 57344
s_add_u32 s27, s32, s22
s_add_u32 s28, s27, 28672
s_add_u32 m0, s29, 8192
ds_read_b64_tr_b16 a[144:145], v18 offset:16384
v_mfma_f32_16x16x32_bf16 v[64:67], a[180:183], a[36:39], v[64:67]
buffer_load_dwordx4 v12, s[8:11], s27 offen offset:0 lds
v_mfma_f32_16x16x32_bf16 v[68:71], a[176:179], a[40:43], v[68:71]
ds_read_b64_tr_b16 a[146:147], v18 offset:18432
v_mfma_f32_16x16x32_bf16 v[68:71], a[180:183], a[44:47], v[68:71]
buffer_load_dwordx4 v13, s[8:11], s27 offen offset:1024 lds
v_mfma_f32_16x16x32_bf16 v[72:75], a[176:179], a[48:51], v[72:75]
ds_read_b64_tr_b16 a[148:149], v18 offset:20480
v_mfma_f32_16x16x32_bf16 v[72:75], a[180:183], a[52:55], v[72:75]
buffer_load_dwordx4 v14, s[8:11], s27 offen offset:2048 lds
v_mfma_f32_16x16x32_bf16 v[76:79], a[176:179], a[56:59], v[76:79]
ds_read_b64_tr_b16 a[150:151], v18 offset:22528
v_mfma_f32_16x16x32_bf16 v[76:79], a[180:183], a[60:63], v[76:79]
buffer_load_dwordx4 v15, s[8:11], s27 offen offset:3072 lds
v_mfma_f32_16x16x32_bf16 v[80:83], a[184:187], a[32:35], v[80:83]
s_add_u32 m0, s29, 12288
ds_read_b64_tr_b16 a[152:153], v19 offset:16384
v_mfma_f32_16x16x32_bf16 v[80:83], a[188:191], a[36:39], v[80:83]
buffer_load_dwordx4 v12, s[8:11], s28 offen offset:0 lds
v_mfma_f32_16x16x32_bf16 v[84:87], a[184:187], a[40:43], v[84:87]
ds_read_b64_tr_b16 a[154:155], v19 offset:18432
v_mfma_f32_16x16x32_bf16 v[84:87], a[188:191], a[44:47], v[84:87]
buffer_load_dwordx4 v13, s[8:11], s28 offen offset:1024 lds
v_mfma_f32_16x16x32_bf16 v[88:91], a[184:187], a[48:51], v[88:91]
ds_read_b64_tr_b16 a[156:157], v19 offset:20480
v_mfma_f32_16x16x32_bf16 v[88:91], a[188:191], a[52:55], v[88:91]
buffer_load_dwordx4 v14, s[8:11], s28 offen offset:2048 lds
v_mfma_f32_16x16x32_bf16 v[92:95], a[184:187], a[56:59], v[92:95]
ds_read_b64_tr_b16 a[158:159], v19 offset:22528
v_mfma_f32_16x16x32_bf16 v[92:95], a[188:191], a[60:63], v[92:95]
buffer_load_dwordx4 v15, s[8:11], s28 offen offset:3072 lds
s_waitcnt vmcnt(32) lgkmcnt(0)
v_mfma_f32_16x16x32_bf16 v[32:35], a[128:131], a[64:67], v[32:35]
s_add_u32 s23, s30, 5
s_and_b32 s23, s23, 15
s_lshl_b32 s23, s23, 11
s_add_u32 s26, s31, s23
ds_read_b64_tr_b16 a[160:161], v16 offset:24576
v_mfma_f32_16x16x32_bf16 v[32:35], a[132:135], a[68:71], v[32:35]
buffer_load_dwordx4 a[32:35], v8, s[4:7], s26 offen offset:0 sc1
v_mfma_f32_16x16x32_bf16 v[36:39], a[128:131], a[72:75], v[36:39]
ds_read_b64_tr_b16 a[162:163], v16 offset:26624
v_mfma_f32_16x16x32_bf16 v[36:39], a[132:135], a[76:79], v[36:39]
buffer_load_dwordx4 a[36:39], v8, s[4:7], s26 offen offset:1024 sc1
v_mfma_f32_16x16x32_bf16 v[40:43], a[128:131], a[80:83], v[40:43]
ds_read_b64_tr_b16 a[164:165], v16 offset:28672
v_mfma_f32_16x16x32_bf16 v[40:43], a[132:135], a[84:87], v[40:43]
buffer_load_dwordx4 a[40:43], v9, s[4:7], s26 offen offset:0 sc1
v_mfma_f32_16x16x32_bf16 v[44:47], a[128:131], a[88:91], v[44:47]
ds_read_b64_tr_b16 a[166:167], v16 offset:30720
v_mfma_f32_16x16x32_bf16 v[44:47], a[132:135], a[92:95], v[44:47]
buffer_load_dwordx4 a[44:47], v9, s[4:7], s26 offen offset:1024 sc1
v_mfma_f32_16x16x32_bf16 v[48:51], a[136:139], a[64:67], v[48:51]
ds_read_b64_tr_b16 a[168:169], v17 offset:24576
v_mfma_f32_16x16x32_bf16 v[48:51], a[140:143], a[68:71], v[48:51]
buffer_load_dwordx4 a[48:51], v10, s[4:7], s26 offen offset:0 sc1
v_mfma_f32_16x16x32_bf16 v[52:55], a[136:139], a[72:75], v[52:55]
ds_read_b64_tr_b16 a[170:171], v17 offset:26624
v_mfma_f32_16x16x32_bf16 v[52:55], a[140:143], a[76:79], v[52:55]
buffer_load_dwordx4 a[52:55], v10, s[4:7], s26 offen offset:1024 sc1
v_mfma_f32_16x16x32_bf16 v[56:59], a[136:139], a[80:83], v[56:59]
ds_read_b64_tr_b16 a[172:173], v17 offset:28672
v_mfma_f32_16x16x32_bf16 v[56:59], a[140:143], a[84:87], v[56:59]
buffer_load_dwordx4 a[56:59], v11, s[4:7], s26 offen offset:0 sc1
v_mfma_f32_16x16x32_bf16 v[60:63], a[136:139], a[88:91], v[60:63]
ds_read_b64_tr_b16 a[174:175], v17 offset:30720
v_mfma_f32_16x16x32_bf16 v[60:63], a[140:143], a[92:95], v[60:63]
buffer_load_dwordx4 a[60:63], v11, s[4:7], s26 offen offset:1024 sc1
v_mfma_f32_16x16x32_bf16 v[64:67], a[144:147], a[64:67], v[64:67]
s_add_u32 s22, s30, 7
s_and_b32 s22, s22, 15
s_mul_i32 s22, s22, 57344
s_add_u32 s27, s32, s22
s_add_u32 s28, s27, 28672
s_add_u32 m0, s29, 16384
ds_read_b64_tr_b16 a[176:177], v18 offset:24576
v_mfma_f32_16x16x32_bf16 v[64:67], a[148:151], a[68:71], v[64:67]
buffer_load_dwordx4 v12, s[8:11], s27 offen offset:0 lds
v_mfma_f32_16x16x32_bf16 v[68:71], a[144:147], a[72:75], v[68:71]
ds_read_b64_tr_b16 a[178:179], v18 offset:26624
v_mfma_f32_16x16x32_bf16 v[68:71], a[148:151], a[76:79], v[68:71]
buffer_load_dwordx4 v13, s[8:11], s27 offen offset:1024 lds
v_mfma_f32_16x16x32_bf16 v[72:75], a[144:147], a[80:83], v[72:75]
ds_read_b64_tr_b16 a[180:181], v18 offset:28672
v_mfma_f32_16x16x32_bf16 v[72:75], a[148:151], a[84:87], v[72:75]
buffer_load_dwordx4 v14, s[8:11], s27 offen offset:2048 lds
v_mfma_f32_16x16x32_bf16 v[76:79], a[144:147], a[88:91], v[76:79]
ds_read_b64_tr_b16 a[182:183], v18 offset:30720
v_mfma_f32_16x16x32_bf16 v[76:79], a[148:151], a[92:95], v[76:79]
buffer_load_dwordx4 v15, s[8:11], s27 offen offset:3072 lds
v_mfma_f32_16x16x32_bf16 v[80:83], a[152:155], a[64:67], v[80:83]
s_add_u32 m0, s29, 20480
ds_read_b64_tr_b16 a[184:185], v19 offset:24576
v_mfma_f32_16x16x32_bf16 v[80:83], a[156:159], a[68:71], v[80:83]
buffer_load_dwordx4 v12, s[8:11], s28 offen offset:0 lds
v_mfma_f32_16x16x32_bf16 v[84:87], a[152:155], a[72:75], v[84:87]
ds_read_b64_tr_b16 a[186:187], v19 offset:26624
v_mfma_f32_16x16x32_bf16 v[84:87], a[156:159], a[76:79], v[84:87]
buffer_load_dwordx4 v13, s[8:11], s28 offen offset:1024 lds
v_mfma_f32_16x16x32_bf16 v[88:91], a[152:155], a[80:83], v[88:91]
ds_read_b64_tr_b16 a[188:189], v19 offset:28672
v_mfma_f32_16x16x32_bf16 v[88:91], a[156:159], a[84:87], v[88:91]
buffer_load_dwordx4 v14, s[8:11], s28 offen offset:2048 lds
v_mfma_f32_16x16x32_bf16 v[92:95], a[152:155], a[88:91], v[92:95]
ds_read_b64_tr_b16 a[190:191], v19 offset:30720
v_mfma_f32_16x16x32_bf16 v[92:95], a[156:159], a[92:95], v[92:95]
buffer_load_dwordx4 v15, s[8:11], s28 offen offset:3072 lds
s_waitcnt vmcnt(40) lgkmcnt(0)
v_mfma_f32_16x16x32_bf16 v[32:35], a[160:163], a[96:99], v[32:35]
s_add_u32 s23, s30, 6
s_and_b32 s23, s23, 15
s_lshl_b32 s23, s23, 11
s_add_u32 s26, s31, s23
ds_read_b64_tr_b16 a[128:129], v16 offset:32768
v_mfma_f32_16x16x32_bf16 v[32:35], a[164:167], a[100:103], v[32:35]
buffer_load_dwordx4 a[64:67], v8, s[4:7], s26 offen offset:0 sc1
v_mfma_f32_16x16x32_bf16 v[36:39], a[160:163], a[104:107], v[36:39]
ds_read_b64_tr_b16 a[130:131], v16 offset:34816
v_mfma_f32_16x16x32_bf16 v[36:39], a[164:167], a[108:111], v[36:39]
buffer_load_dwordx4 a[68:71], v8, s[4:7], s26 offen offset:1024 sc1
v_mfma_f32_16x16x32_bf16 v[40:43], a[160:163], a[112:115], v[40:43]
ds_read_b64_tr_b16 a[132:133], v16 offset:36864
v_mfma_f32_16x16x32_bf16 v[40:43], a[164:167], a[116:119], v[40:43]
buffer_load_dwordx4 a[72:75], v9, s[4:7], s26 offen offset:0 sc1
v_mfma_f32_16x16x32_bf16 v[44:47], a[160:163], a[120:123], v[44:47]
ds_read_b64_tr_b16 a[134:135], v16 offset:38912
v_mfma_f32_16x16x32_bf16 v[44:47], a[164:167], a[124:127], v[44:47]
buffer_load_dwordx4 a[76:79], v9, s[4:7], s26 offen offset:1024 sc1
v_mfma_f32_16x16x32_bf16 v[48:51], a[168:171], a[96:99], v[48:51]
ds_read_b64_tr_b16 a[136:137], v17 offset:32768
v_mfma_f32_16x16x32_bf16 v[48:51], a[172:175], a[100:103], v[48:51]
buffer_load_dwordx4 a[80:83], v10, s[4:7], s26 offen offset:0 sc1
v_mfma_f32_16x16x32_bf16 v[52:55], a[168:171], a[104:107], v[52:55]
ds_read_b64_tr_b16 a[138:139], v17 offset:34816
v_mfma_f32_16x16x32_bf16 v[52:55], a[172:175], a[108:111], v[52:55]
buffer_load_dwordx4 a[84:87], v10, s[4:7], s26 offen offset:1024 sc1
v_mfma_f32_16x16x32_bf16 v[56:59], a[168:171], a[112:115], v[56:59]
ds_read_b64_tr_b16 a[140:141], v17 offset:36864
v_mfma_f32_16x16x32_bf16 v[56:59], a[172:175], a[116:119], v[56:59]
buffer_load_dwordx4 a[88:91], v11, s[4:7], s26 offen offset:0 sc1
v_mfma_f32_16x16x32_bf16 v[60:63], a[168:171], a[120:123], v[60:63]
ds_read_b64_tr_b16 a[142:143], v17 offset:38912
v_mfma_f32_16x16x32_bf16 v[60:63], a[172:175], a[124:127], v[60:63]
buffer_load_dwordx4 a[92:95], v11, s[4:7], s26 offen offset:1024 sc1
v_mfma_f32_16x16x32_bf16 v[64:67], a[176:179], a[96:99], v[64:67]
s_add_u32 s22, s30, 8
s_and_b32 s22, s22, 15
s_mul_i32 s22, s22, 57344
s_add_u32 s27, s32, s22
s_add_u32 s28, s27, 28672
s_add_u32 m0, s29, 24576
ds_read_b64_tr_b16 a[144:145], v18 offset:32768
v_mfma_f32_16x16x32_bf16 v[64:67], a[180:183], a[100:103], v[64:67]
buffer_load_dwordx4 v12, s[8:11], s27 offen offset:0 lds
v_mfma_f32_16x16x32_bf16 v[68:71], a[176:179], a[104:107], v[68:71]
ds_read_b64_tr_b16 a[146:147], v18 offset:34816
v_mfma_f32_16x16x32_bf16 v[68:71], a[180:183], a[108:111], v[68:71]
buffer_load_dwordx4 v13, s[8:11], s27 offen offset:1024 lds
v_mfma_f32_16x16x32_bf16 v[72:75], a[176:179], a[112:115], v[72:75]
ds_read_b64_tr_b16 a[148:149], v18 offset:36864
v_mfma_f32_16x16x32_bf16 v[72:75], a[180:183], a[116:119], v[72:75]
buffer_load_dwordx4 v14, s[8:11], s27 offen offset:2048 lds
v_mfma_f32_16x16x32_bf16 v[76:79], a[176:179], a[120:123], v[76:79]
ds_read_b64_tr_b16 a[150:151], v18 offset:38912
v_mfma_f32_16x16x32_bf16 v[76:79], a[180:183], a[124:127], v[76:79]
buffer_load_dwordx4 v15, s[8:11], s27 offen offset:3072 lds
v_mfma_f32_16x16x32_bf16 v[80:83], a[184:187], a[96:99], v[80:83]
s_add_u32 m0, s29, 28672
ds_read_b64_tr_b16 a[152:153], v19 offset:32768
v_mfma_f32_16x16x32_bf16 v[80:83], a[188:191], a[100:103], v[80:83]
buffer_load_dwordx4 v12, s[8:11], s28 offen offset:0 lds
v_mfma_f32_16x16x32_bf16 v[84:87], a[184:187], a[104:107], v[84:87]
ds_read_b64_tr_b16 a[154:155], v19 offset:34816
v_mfma_f32_16x16x32_bf16 v[84:87], a[188:191], a[108:111], v[84:87]
buffer_load_dwordx4 v13, s[8:11], s28 offen offset:1024 lds
v_mfma_f32_16x16x32_bf16 v[88:91], a[184:187], a[112:115], v[88:91]
ds_read_b64_tr_b16 a[156:157], v19 offset:36864
v_mfma_f32_16x16x32_bf16 v[88:91], a[188:191], a[116:119], v[88:91]
buffer_load_dwordx4 v14, s[8:11], s28 offen offset:2048 lds
v_mfma_f32_16x16x32_bf16 v[92:95], a[184:187], a[120:123], v[92:95]
ds_read_b64_tr_b16 a[158:159], v19 offset:38912
v_mfma_f32_16x16x32_bf16 v[92:95], a[188:191], a[124:127], v[92:95]
buffer_load_dwordx4 v15, s[8:11], s28 offen offset:3072 lds
s_waitcnt vmcnt(40) lgkmcnt(0)
v_mfma_f32_16x16x32_bf16 v[32:35], a[128:131], a[0:3], v[32:35]
s_add_u32 s23, s30, 7
s_and_b32 s23, s23, 15
s_lshl_b32 s23, s23, 11
s_add_u32 s26, s31, s23
ds_read_b64_tr_b16 a[160:161], v16 offset:0
v_mfma_f32_16x16x32_bf16 v[32:35], a[132:135], a[4:7], v[32:35]
buffer_load_dwordx4 a[96:99], v8, s[4:7], s26 offen offset:0 sc1
v_mfma_f32_16x16x32_bf16 v[36:39], a[128:131], a[8:11], v[36:39]
ds_read_b64_tr_b16 a[162:163], v16 offset:2048
v_mfma_f32_16x16x32_bf16 v[36:39], a[132:135], a[12:15], v[36:39]
buffer_load_dwordx4 a[100:103], v8, s[4:7], s26 offen offset:1024 sc1
v_mfma_f32_16x16x32_bf16 v[40:43], a[128:131], a[16:19], v[40:43]
ds_read_b64_tr_b16 a[164:165], v16 offset:4096
v_mfma_f32_16x16x32_bf16 v[40:43], a[132:135], a[20:23], v[40:43]
buffer_load_dwordx4 a[104:107], v9, s[4:7], s26 offen offset:0 sc1
v_mfma_f32_16x16x32_bf16 v[44:47], a[128:131], a[24:27], v[44:47]
ds_read_b64_tr_b16 a[166:167], v16 offset:6144
v_mfma_f32_16x16x32_bf16 v[44:47], a[132:135], a[28:31], v[44:47]
buffer_load_dwordx4 a[108:111], v9, s[4:7], s26 offen offset:1024 sc1
v_mfma_f32_16x16x32_bf16 v[48:51], a[136:139], a[0:3], v[48:51]
ds_read_b64_tr_b16 a[168:169], v17 offset:0
v_mfma_f32_16x16x32_bf16 v[48:51], a[140:143], a[4:7], v[48:51]
buffer_load_dwordx4 a[112:115], v10, s[4:7], s26 offen offset:0 sc1
v_mfma_f32_16x16x32_bf16 v[52:55], a[136:139], a[8:11], v[52:55]
ds_read_b64_tr_b16 a[170:171], v17 offset:2048
v_mfma_f32_16x16x32_bf16 v[52:55], a[140:143], a[12:15], v[52:55]
buffer_load_dwordx4 a[116:119], v10, s[4:7], s26 offen offset:1024 sc1
v_mfma_f32_16x16x32_bf16 v[56:59], a[136:139], a[16:19], v[56:59]
ds_read_b64_tr_b16 a[172:173], v17 offset:4096
v_mfma_f32_16x16x32_bf16 v[56:59], a[140:143], a[20:23], v[56:59]
buffer_load_dwordx4 a[120:123], v11, s[4:7], s26 offen offset:0 sc1
v_mfma_f32_16x16x32_bf16 v[60:63], a[136:139], a[24:27], v[60:63]
ds_read_b64_tr_b16 a[174:175], v17 offset:6144
v_mfma_f32_16x16x32_bf16 v[60:63], a[140:143], a[28:31], v[60:63]
buffer_load_dwordx4 a[124:127], v11, s[4:7], s26 offen offset:1024 sc1
v_mfma_f32_16x16x32_bf16 v[64:67], a[144:147], a[0:3], v[64:67]
s_add_u32 s22, s30, 9
s_and_b32 s22, s22, 15
s_mul_i32 s22, s22, 57344
s_add_u32 s27, s32, s22
s_add_u32 s28, s27, 28672
s_add_u32 m0, s29, 32768
ds_read_b64_tr_b16 a[176:177], v18 offset:0
v_mfma_f32_16x16x32_bf16 v[64:67], a[148:151], a[4:7], v[64:67]
buffer_load_dwordx4 v12, s[8:11], s27 offen offset:0 lds
v_mfma_f32_16x16x32_bf16 v[68:71], a[144:147], a[8:11], v[68:71]
ds_read_b64_tr_b16 a[178:179], v18 offset:2048
v_mfma_f32_16x16x32_bf16 v[68:71], a[148:151], a[12:15], v[68:71]
buffer_load_dwordx4 v13, s[8:11], s27 offen offset:1024 lds
v_mfma_f32_16x16x32_bf16 v[72:75], a[144:147], a[16:19], v[72:75]
ds_read_b64_tr_b16 a[180:181], v18 offset:4096
v_mfma_f32_16x16x32_bf16 v[72:75], a[148:151], a[20:23], v[72:75]
buffer_load_dwordx4 v14, s[8:11], s27 offen offset:2048 lds
v_mfma_f32_16x16x32_bf16 v[76:79], a[144:147], a[24:27], v[76:79]
ds_read_b64_tr_b16 a[182:183], v18 offset:6144
v_mfma_f32_16x16x32_bf16 v[76:79], a[148:151], a[28:31], v[76:79]
buffer_load_dwordx4 v15, s[8:11], s27 offen offset:3072 lds
v_mfma_f32_16x16x32_bf16 v[80:83], a[152:155], a[0:3], v[80:83]
s_add_u32 m0, s29, 36864
ds_read_b64_tr_b16 a[184:185], v19 offset:0
v_mfma_f32_16x16x32_bf16 v[80:83], a[156:159], a[4:7], v[80:83]
buffer_load_dwordx4 v12, s[8:11], s28 offen offset:0 lds
v_mfma_f32_16x16x32_bf16 v[84:87], a[152:155], a[8:11], v[84:87]
ds_read_b64_tr_b16 a[186:187], v19 offset:2048
v_mfma_f32_16x16x32_bf16 v[84:87], a[156:159], a[12:15], v[84:87]
buffer_load_dwordx4 v13, s[8:11], s28 offen offset:1024 lds
v_mfma_f32_16x16x32_bf16 v[88:91], a[152:155], a[16:19], v[88:91]
ds_read_b64_tr_b16 a[188:189], v19 offset:4096
v_mfma_f32_16x16x32_bf16 v[88:91], a[156:159], a[20:23], v[88:91]
buffer_load_dwordx4 v14, s[8:11], s28 offen offset:2048 lds
v_mfma_f32_16x16x32_bf16 v[92:95], a[152:155], a[24:27], v[92:95]
ds_read_b64_tr_b16 a[190:191], v19 offset:6144
v_mfma_f32_16x16x32_bf16 v[92:95], a[156:159], a[28:31], v[92:95]
buffer_load_dwordx4 v15, s[8:11], s28 offen offset:3072 lds
s_waitcnt vmcnt(40) lgkmcnt(0)
v_mfma_f32_16x16x32_bf16 v[32:35], a[160:163], a[32:35], v[32:35]
s_add_u32 s23, s30, 8
s_and_b32 s23, s23, 15
s_lshl_b32 s23, s23, 11
s_add_u32 s26, s31, s23
ds_read_b64_tr_b16 a[128:129], v16 offset:8192
v_mfma_f32_16x16x32_bf16 v[32:35], a[164:167], a[36:39], v[32:35]
buffer_load_dwordx4 a[0:3], v8, s[4:7], s26 offen offset:0 sc1
v_mfma_f32_16x16x32_bf16 v[36:39], a[160:163], a[40:43], v[36:39]
ds_read_b64_tr_b16 a[130:131], v16 offset:10240
v_mfma_f32_16x16x32_bf16 v[36:39], a[164:167], a[44:47], v[36:39]
buffer_load_dwordx4 a[4:7], v8, s[4:7], s26 offen offset:1024 sc1
v_mfma_f32_16x16x32_bf16 v[40:43], a[160:163], a[48:51], v[40:43]
ds_read_b64_tr_b16 a[132:133], v16 offset:12288
v_mfma_f32_16x16x32_bf16 v[40:43], a[164:167], a[52:55], v[40:43]
buffer_load_dwordx4 a[8:11], v9, s[4:7], s26 offen offset:0 sc1
v_mfma_f32_16x16x32_bf16 v[44:47], a[160:163], a[56:59], v[44:47]
ds_read_b64_tr_b16 a[134:135], v16 offset:14336
v_mfma_f32_16x16x32_bf16 v[44:47], a[164:167], a[60:63], v[44:47]
buffer_load_dwordx4 a[12:15], v9, s[4:7], s26 offen offset:1024 sc1
v_mfma_f32_16x16x32_bf16 v[48:51], a[168:171], a[32:35], v[48:51]
ds_read_b64_tr_b16 a[136:137], v17 offset:8192
v_mfma_f32_16x16x32_bf16 v[48:51], a[172:175], a[36:39], v[48:51]
buffer_load_dwordx4 a[16:19], v10, s[4:7], s26 offen offset:0 sc1
v_mfma_f32_16x16x32_bf16 v[52:55], a[168:171], a[40:43], v[52:55]
ds_read_b64_tr_b16 a[138:139], v17 offset:10240
v_mfma_f32_16x16x32_bf16 v[52:55], a[172:175], a[44:47], v[52:55]
buffer_load_dwordx4 a[20:23], v10, s[4:7], s26 offen offset:1024 sc1
v_mfma_f32_16x16x32_bf16 v[56:59], a[168:171], a[48:51], v[56:59]
ds_read_b64_tr_b16 a[140:141], v17 offset:12288
v_mfma_f32_16x16x32_bf16 v[56:59], a[172:175], a[52:55], v[56:59]
buffer_load_dwordx4 a[24:27], v11, s[4:7], s26 offen offset:0 sc1
v_mfma_f32_16x16x32_bf16 v[60:63], a[168:171], a[56:59], v[60:63]
ds_read_b64_tr_b16 a[142:143], v17 offset:14336
v_mfma_f32_16x16x32_bf16 v[60:63], a[172:175], a[60:63], v[60:63]
buffer_load_dwordx4 a[28:31], v11, s[4:7], s26 offen offset:1024 sc1
v_mfma_f32_16x16x32_bf16 v[64:67], a[176:179], a[32:35], v[64:67]
s_add_u32 s22, s30, 10
s_and_b32 s22, s22, 15
s_mul_i32 s22, s22, 57344
s_add_u32 s27, s32, s22
s_add_u32 s28, s27, 28672
s_add_u32 m0, s29, 0
ds_read_b64_tr_b16 a[144:145], v18 offset:8192
v_mfma_f32_16x16x32_bf16 v[64:67], a[180:183], a[36:39], v[64:67]
buffer_load_dwordx4 v12, s[8:11], s27 offen offset:0 lds
v_mfma_f32_16x16x32_bf16 v[68:71], a[176:179], a[40:43], v[68:71]
ds_read_b64_tr_b16 a[146:147], v18 offset:10240
v_mfma_f32_16x16x32_bf16 v[68:71], a[180:183], a[44:47], v[68:71]
buffer_load_dwordx4 v13, s[8:11], s27 offen offset:1024 lds
v_mfma_f32_16x16x32_bf16 v[72:75], a[176:179], a[48:51], v[72:75]
ds_read_b64_tr_b16 a[148:149], v18 offset:12288
v_mfma_f32_16x16x32_bf16 v[72:75], a[180:183], a[52:55], v[72:75]
buffer_load_dwordx4 v14, s[8:11], s27 offen offset:2048 lds
v_mfma_f32_16x16x32_bf16 v[76:79], a[176:179], a[56:59], v[76:79]
ds_read_b64_tr_b16 a[150:151], v18 offset:14336
v_mfma_f32_16x16x32_bf16 v[76:79], a[180:183], a[60:63], v[76:79]
buffer_load_dwordx4 v15, s[8:11], s27 offen offset:3072 lds
v_mfma_f32_16x16x32_bf16 v[80:83], a[184:187], a[32:35], v[80:83]
s_add_u32 m0, s29, 4096
ds_read_b64_tr_b16 a[152:153], v19 offset:8192
v_mfma_f32_16x16x32_bf16 v[80:83], a[188:191], a[36:39], v[80:83]
buffer_load_dwordx4 v12, s[8:11], s28 offen offset:0 lds
v_mfma_f32_16x16x32_bf16 v[84:87], a[184:187], a[40:43], v[84:87]
ds_read_b64_tr_b16 a[154:155], v19 offset:10240
v_mfma_f32_16x16x32_bf16 v[84:87], a[188:191], a[44:47], v[84:87]
buffer_load_dwordx4 v13, s[8:11], s28 offen offset:1024 lds
v_mfma_f32_16x16x32_bf16 v[88:91], a[184:187], a[48:51], v[88:91]
ds_read_b64_tr_b16 a[156:157], v19 offset:12288
v_mfma_f32_16x16x32_bf16 v[88:91], a[188:191], a[52:55], v[88:91]
buffer_load_dwordx4 v14, s[8:11], s28 offen offset:2048 lds
v_mfma_f32_16x16x32_bf16 v[92:95], a[184:187], a[56:59], v[92:95]
ds_read_b64_tr_b16 a[158:159], v19 offset:14336
v_mfma_f32_16x16x32_bf16 v[92:95], a[188:191], a[60:63], v[92:95]
buffer_load_dwordx4 v15, s[8:11], s28 offen offset:3072 lds
s_waitcnt vmcnt(40) lgkmcnt(0)
v_mfma_f32_16x16x32_bf16 v[32:35], a[128:131], a[64:67], v[32:35]
s_add_u32 s23, s30, 9
s_and_b32 s23, s23, 15
s_lshl_b32 s23, s23, 11
s_add_u32 s26, s31, s23
ds_read_b64_tr_b16 a[160:161], v16 offset:16384
v_mfma_f32_16x16x32_bf16 v[32:35], a[132:135], a[68:71], v[32:35]
buffer_load_dwordx4 a[32:35], v8, s[4:7], s26 offen offset:0 sc1
v_mfma_f32_16x16x32_bf16 v[36:39], a[128:131], a[72:75], v[36:39]
ds_read_b64_tr_b16 a[162:163], v16 offset:18432
v_mfma_f32_16x16x32_bf16 v[36:39], a[132:135], a[76:79], v[36:39]
buffer_load_dwordx4 a[36:39], v8, s[4:7], s26 offen offset:1024 sc1
v_mfma_f32_16x16x32_bf16 v[40:43], a[128:131], a[80:83], v[40:43]
ds_read_b64_tr_b16 a[164:165], v16 offset:20480
v_mfma_f32_16x16x32_bf16 v[40:43], a[132:135], a[84:87], v[40:43]
buffer_load_dwordx4 a[40:43], v9, s[4:7], s26 offen offset:0 sc1
v_mfma_f32_16x16x32_bf16 v[44:47], a[128:131], a[88:91], v[44:47]
ds_read_b64_tr_b16 a[166:167], v16 offset:22528
v_mfma_f32_16x16x32_bf16 v[44:47], a[132:135], a[92:95], v[44:47]
buffer_load_dwordx4 a[44:47], v9, s[4:7], s26 offen offset:1024 sc1
v_mfma_f32_16x16x32_bf16 v[48:51], a[136:139], a[64:67], v[48:51]
ds_read_b64_tr_b16 a[168:169], v17 offset:16384
v_mfma_f32_16x16x32_bf16 v[48:51], a[140:143], a[68:71], v[48:51]
buffer_load_dwordx4 a[48:51], v10, s[4:7], s26 offen offset:0 sc1
v_mfma_f32_16x16x32_bf16 v[52:55], a[136:139], a[72:75], v[52:55]
ds_read_b64_tr_b16 a[170:171], v17 offset:18432
v_mfma_f32_16x16x32_bf16 v[52:55], a[140:143], a[76:79], v[52:55]
buffer_load_dwordx4 a[52:55], v10, s[4:7], s26 offen offset:1024 sc1
v_mfma_f32_16x16x32_bf16 v[56:59], a[136:139], a[80:83], v[56:59]
ds_read_b64_tr_b16 a[172:173], v17 offset:20480
v_mfma_f32_16x16x32_bf16 v[56:59], a[140:143], a[84:87], v[56:59]
buffer_load_dwordx4 a[56:59], v11, s[4:7], s26 offen offset:0 sc1
v_mfma_f32_16x16x32_bf16 v[60:63], a[136:139], a[88:91], v[60:63]
ds_read_b64_tr_b16 a[174:175], v17 offset:22528
v_mfma_f32_16x16x32_bf16 v[60:63], a[140:143], a[92:95], v[60:63]
buffer_load_dwordx4 a[60:63], v11, s[4:7], s26 offen offset:1024 sc1
v_mfma_f32_16x16x32_bf16 v[64:67], a[144:147], a[64:67], v[64:67]
s_add_u32 s22, s30, 11
s_and_b32 s22, s22, 15
s_mul_i32 s22, s22, 57344
s_add_u32 s27, s32, s22
s_add_u32 s28, s27, 28672
s_add_u32 m0, s29, 8192
ds_read_b64_tr_b16 a[176:177], v18 offset:16384
v_mfma_f32_16x16x32_bf16 v[64:67], a[148:151], a[68:71], v[64:67]
buffer_load_dwordx4 v12, s[8:11], s27 offen offset:0 lds
v_mfma_f32_16x16x32_bf16 v[68:71], a[144:147], a[72:75], v[68:71]
ds_read_b64_tr_b16 a[178:179], v18 offset:18432
v_mfma_f32_16x16x32_bf16 v[68:71], a[148:151], a[76:79], v[68:71]
buffer_load_dwordx4 v13, s[8:11], s27 offen offset:1024 lds
v_mfma_f32_16x16x32_bf16 v[72:75], a[144:147], a[80:83], v[72:75]
ds_read_b64_tr_b16 a[180:181], v18 offset:20480
v_mfma_f32_16x16x32_bf16 v[72:75], a[148:151], a[84:87], v[72:75]
buffer_load_dwordx4 v14, s[8:11], s27 offen offset:2048 lds
v_mfma_f32_16x16x32_bf16 v[76:79], a[144:147], a[88:91], v[76:79]
ds_read_b64_tr_b16 a[182:183], v18 offset:22528
v_mfma_f32_16x16x32_bf16 v[76:79], a[148:151], a[92:95], v[76:79]
buffer_load_dwordx4 v15, s[8:11], s27 offen offset:3072 lds
v_mfma_f32_16x16x32_bf16 v[80:83], a[152:155], a[64:67], v[80:83]
s_add_u32 m0, s29, 12288
ds_read_b64_tr_b16 a[184:185], v19 offset:16384
v_mfma_f32_16x16x32_bf16 v[80:83], a[156:159], a[68:71], v[80:83]
buffer_load_dwordx4 v12, s[8:11], s28 offen offset:0 lds
v_mfma_f32_16x16x32_bf16 v[84:87], a[152:155], a[72:75], v[84:87]
ds_read_b64_tr_b16 a[186:187], v19 offset:18432
v_mfma_f32_16x16x32_bf16 v[84:87], a[156:159], a[76:79], v[84:87]
buffer_load_dwordx4 v13, s[8:11], s28 offen offset:1024 lds
v_mfma_f32_16x16x32_bf16 v[88:91], a[152:155], a[80:83], v[88:91]
ds_read_b64_tr_b16 a[188:189], v19 offset:20480
v_mfma_f32_16x16x32_bf16 v[88:91], a[156:159], a[84:87], v[88:91]
buffer_load_dwordx4 v14, s[8:11], s28 offen offset:2048 lds
v_mfma_f32_16x16x32_bf16 v[92:95], a[152:155], a[88:91], v[92:95]
ds_read_b64_tr_b16 a[190:191], v19 offset:22528
v_mfma_f32_16x16x32_bf16 v[92:95], a[156:159], a[92:95], v[92:95]
buffer_load_dwordx4 v15, s[8:11], s28 offen offset:3072 lds
s_waitcnt vmcnt(40) lgkmcnt(0)
v_mfma_f32_16x16x32_bf16 v[32:35], a[160:163], a[96:99], v[32:35]
s_add_u32 s23, s30, 10
s_and_b32 s23, s23, 15
s_lshl_b32 s23, s23, 11
s_add_u32 s26, s31, s23
ds_read_b64_tr_b16 a[128:129], v16 offset:24576
v_mfma_f32_16x16x32_bf16 v[32:35], a[164:167], a[100:103], v[32:35]
buffer_load_dwordx4 a[64:67], v8, s[4:7], s26 offen offset:0 sc1
v_mfma_f32_16x16x32_bf16 v[36:39], a[160:163], a[104:107], v[36:39]
ds_read_b64_tr_b16 a[130:131], v16 offset:26624
v_mfma_f32_16x16x32_bf16 v[36:39], a[164:167], a[108:111], v[36:39]
buffer_load_dwordx4 a[68:71], v8, s[4:7], s26 offen offset:1024 sc1
v_mfma_f32_16x16x32_bf16 v[40:43], a[160:163], a[112:115], v[40:43]
ds_read_b64_tr_b16 a[132:133], v16 offset:28672
v_mfma_f32_16x16x32_bf16 v[40:43], a[164:167], a[116:119], v[40:43]
buffer_load_dwordx4 a[72:75], v9, s[4:7], s26 offen offset:0 sc1
v_mfma_f32_16x16x32_bf16 v[44:47], a[160:163], a[120:123], v[44:47]
ds_read_b64_tr_b16 a[134:135], v16 offset:30720
v_mfma_f32_16x16x32_bf16 v[44:47], a[164:167], a[124:127], v[44:47]
buffer_load_dwordx4 a[76:79], v9, s[4:7], s26 offen offset:1024 sc1
v_mfma_f32_16x16x32_bf16 v[48:51], a[168:171], a[96:99], v[48:51]
ds_read_b64_tr_b16 a[136:137], v17 offset:24576
v_mfma_f32_16x16x32_bf16 v[48:51], a[172:175], a[100:103], v[48:51]
buffer_load_dwordx4 a[80:83], v10, s[4:7], s26 offen offset:0 sc1
v_mfma_f32_16x16x32_bf16 v[52:55], a[168:171], a[104:107], v[52:55]
ds_read_b64_tr_b16 a[138:139], v17 offset:26624
v_mfma_f32_16x16x32_bf16 v[52:55], a[172:175], a[108:111], v[52:55]
buffer_load_dwordx4 a[84:87], v10, s[4:7], s26 offen offset:1024 sc1
v_mfma_f32_16x16x32_bf16 v[56:59], a[168:171], a[112:115], v[56:59]
ds_read_b64_tr_b16 a[140:141], v17 offset:28672
v_mfma_f32_16x16x32_bf16 v[56:59], a[172:175], a[116:119], v[56:59]
buffer_load_dwordx4 a[88:91], v11, s[4:7], s26 offen offset:0 sc1
v_mfma_f32_16x16x32_bf16 v[60:63], a[168:171], a[120:123], v[60:63]
ds_read_b64_tr_b16 a[142:143], v17 offset:30720
v_mfma_f32_16x16x32_bf16 v[60:63], a[172:175], a[124:127], v[60:63]
buffer_load_dwordx4 a[92:95], v11, s[4:7], s26 offen offset:1024 sc1
v_mfma_f32_16x16x32_bf16 v[64:67], a[176:179], a[96:99], v[64:67]
s_add_u32 s22, s30, 12
s_and_b32 s22, s22, 15
s_mul_i32 s22, s22, 57344
s_add_u32 s27, s32, s22
s_add_u32 s28, s27, 28672
s_add_u32 m0, s29, 16384
ds_read_b64_tr_b16 a[144:145], v18 offset:24576
v_mfma_f32_16x16x32_bf16 v[64:67], a[180:183], a[100:103], v[64:67]
buffer_load_dwordx4 v12, s[8:11], s27 offen offset:0 lds
v_mfma_f32_16x16x32_bf16 v[68:71], a[176:179], a[104:107], v[68:71]
ds_read_b64_tr_b16 a[146:147], v18 offset:26624
v_mfma_f32_16x16x32_bf16 v[68:71], a[180:183], a[108:111], v[68:71]
buffer_load_dwordx4 v13, s[8:11], s27 offen offset:1024 lds
v_mfma_f32_16x16x32_bf16 v[72:75], a[176:179], a[112:115], v[72:75]
ds_read_b64_tr_b16 a[148:149], v18 offset:28672
v_mfma_f32_16x16x32_bf16 v[72:75], a[180:183], a[116:119], v[72:75]
buffer_load_dwordx4 v14, s[8:11], s27 offen offset:2048 lds
v_mfma_f32_16x16x32_bf16 v[76:79], a[176:179], a[120:123], v[76:79]
ds_read_b64_tr_b16 a[150:151], v18 offset:30720
v_mfma_f32_16x16x32_bf16 v[76:79], a[180:183], a[124:127], v[76:79]
buffer_load_dwordx4 v15, s[8:11], s27 offen offset:3072 lds
v_mfma_f32_16x16x32_bf16 v[80:83], a[184:187], a[96:99], v[80:83]
s_add_u32 m0, s29, 20480
ds_read_b64_tr_b16 a[152:153], v19 offset:24576
v_mfma_f32_16x16x32_bf16 v[80:83], a[188:191], a[100:103], v[80:83]
buffer_load_dwordx4 v12, s[8:11], s28 offen offset:0 lds
v_mfma_f32_16x16x32_bf16 v[84:87], a[184:187], a[104:107], v[84:87]
ds_read_b64_tr_b16 a[154:155], v19 offset:26624
v_mfma_f32_16x16x32_bf16 v[84:87], a[188:191], a[108:111], v[84:87]
buffer_load_dwordx4 v13, s[8:11], s28 offen offset:1024 lds
v_mfma_f32_16x16x32_bf16 v[88:91], a[184:187], a[112:115], v[88:91]
ds_read_b64_tr_b16 a[156:157], v19 offset:28672
v_mfma_f32_16x16x32_bf16 v[88:91], a[188:191], a[116:119], v[88:91]
buffer_load_dwordx4 v14, s[8:11], s28 offen offset:2048 lds
v_mfma_f32_16x16x32_bf16 v[92:95], a[184:187], a[120:123], v[92:95]
ds_read_b64_tr_b16 a[158:159], v19 offset:30720
v_mfma_f32_16x16x32_bf16 v[92:95], a[188:191], a[124:127], v[92:95]
buffer_load_dwordx4 v15, s[8:11], s28 offen offset:3072 lds
s_waitcnt vmcnt(40) lgkmcnt(0)
v_mfma_f32_16x16x32_bf16 v[32:35], a[128:131], a[0:3], v[32:35]
s_add_u32 s23, s30, 11
s_and_b32 s23, s23, 15
s_lshl_b32 s23, s23, 11
s_add_u32 s26, s31, s23
ds_read_b64_tr_b16 a[160:161], v16 offset:32768
v_mfma_f32_16x16x32_bf16 v[32:35], a[132:135], a[4:7], v[32:35]
buffer_load_dwordx4 a[96:99], v8, s[4:7], s26 offen offset:0 sc1
v_mfma_f32_16x16x32_bf16 v[36:39], a[128:131], a[8:11], v[36:39]
ds_read_b64_tr_b16 a[162:163], v16 offset:34816
v_mfma_f32_16x16x32_bf16 v[36:39], a[132:135], a[12:15], v[36:39]
buffer_load_dwordx4 a[100:103], v8, s[4:7], s26 offen offset:1024 sc1
v_mfma_f32_16x16x32_bf16 v[40:43], a[128:131], a[16:19], v[40:43]
ds_read_b64_tr_b16 a[164:165], v16 offset:36864
v_mfma_f32_16x16x32_bf16 v[40:43], a[132:135], a[20:23], v[40:43]
buffer_load_dwordx4 a[104:107], v9, s[4:7], s26 offen offset:0 sc1
v_mfma_f32_16x16x32_bf16 v[44:47], a[128:131], a[24:27], v[44:47]
ds_read_b64_tr_b16 a[166:167], v16 offset:38912
v_mfma_f32_16x16x32_bf16 v[44:47], a[132:135], a[28:31], v[44:47]
buffer_load_dwordx4 a[108:111], v9, s[4:7], s26 offen offset:1024 sc1
v_mfma_f32_16x16x32_bf16 v[48:51], a[136:139], a[0:3], v[48:51]
ds_read_b64_tr_b16 a[168:169], v17 offset:32768
v_mfma_f32_16x16x32_bf16 v[48:51], a[140:143], a[4:7], v[48:51]
buffer_load_dwordx4 a[112:115], v10, s[4:7], s26 offen offset:0 sc1
v_mfma_f32_16x16x32_bf16 v[52:55], a[136:139], a[8:11], v[52:55]
ds_read_b64_tr_b16 a[170:171], v17 offset:34816
v_mfma_f32_16x16x32_bf16 v[52:55], a[140:143], a[12:15], v[52:55]
buffer_load_dwordx4 a[116:119], v10, s[4:7], s26 offen offset:1024 sc1
v_mfma_f32_16x16x32_bf16 v[56:59], a[136:139], a[16:19], v[56:59]
ds_read_b64_tr_b16 a[172:173], v17 offset:36864
v_mfma_f32_16x16x32_bf16 v[56:59], a[140:143], a[20:23], v[56:59]
buffer_load_dwordx4 a[120:123], v11, s[4:7], s26 offen offset:0 sc1
v_mfma_f32_16x16x32_bf16 v[60:63], a[136:139], a[24:27], v[60:63]
ds_read_b64_tr_b16 a[174:175], v17 offset:38912
v_mfma_f32_16x16x32_bf16 v[60:63], a[140:143], a[28:31], v[60:63]
buffer_load_dwordx4 a[124:127], v11, s[4:7], s26 offen offset:1024 sc1
v_mfma_f32_16x16x32_bf16 v[64:67], a[144:147], a[0:3], v[64:67]
s_add_u32 s22, s30, 13
s_and_b32 s22, s22, 15
s_mul_i32 s22, s22, 57344
s_add_u32 s27, s32, s22
s_add_u32 s28, s27, 28672
s_add_u32 m0, s29, 24576
ds_read_b64_tr_b16 a[176:177], v18 offset:32768
v_mfma_f32_16x16x32_bf16 v[64:67], a[148:151], a[4:7], v[64:67]
buffer_load_dwordx4 v12, s[8:11], s27 offen offset:0 lds
v_mfma_f32_16x16x32_bf16 v[68:71], a[144:147], a[8:11], v[68:71]
ds_read_b64_tr_b16 a[178:179], v18 offset:34816
v_mfma_f32_16x16x32_bf16 v[68:71], a[148:151], a[12:15], v[68:71]
buffer_load_dwordx4 v13, s[8:11], s27 offen offset:1024 lds
v_mfma_f32_16x16x32_bf16 v[72:75], a[144:147], a[16:19], v[72:75]
ds_read_b64_tr_b16 a[180:181], v18 offset:36864
v_mfma_f32_16x16x32_bf16 v[72:75], a[148:151], a[20:23], v[72:75]
buffer_load_dwordx4 v14, s[8:11], s27 offen offset:2048 lds
v_mfma_f32_16x16x32_bf16 v[76:79], a[144:147], a[24:27], v[76:79]
ds_read_b64_tr_b16 a[182:183], v18 offset:38912
v_mfma_f32_16x16x32_bf16 v[76:79], a[148:151], a[28:31], v[76:79]
buffer_load_dwordx4 v15, s[8:11], s27 offen offset:3072 lds
v_mfma_f32_16x16x32_bf16 v[80:83], a[152:155], a[0:3], v[80:83]
s_add_u32 m0, s29, 28672
ds_read_b64_tr_b16 a[184:185], v19 offset:32768
v_mfma_f32_16x16x32_bf16 v[80:83], a[156:159], a[4:7], v[80:83]
buffer_load_dwordx4 v12, s[8:11], s28 offen offset:0 lds
v_mfma_f32_16x16x32_bf16 v[84:87], a[152:155], a[8:11], v[84:87]
ds_read_b64_tr_b16 a[186:187], v19 offset:34816
v_mfma_f32_16x16x32_bf16 v[84:87], a[156:159], a[12:15], v[84:87]
buffer_load_dwordx4 v13, s[8:11], s28 offen offset:1024 lds
v_mfma_f32_16x16x32_bf16 v[88:91], a[152:155], a[16:19], v[88:91]
ds_read_b64_tr_b16 a[188:189], v19 offset:36864
v_mfma_f32_16x16x32_bf16 v[88:91], a[156:159], a[20:23], v[88:91]
buffer_load_dwordx4 v14, s[8:11], s28 offen offset:2048 lds
v_mfma_f32_16x16x32_bf16 v[92:95], a[152:155], a[24:27], v[92:95]
ds_read_b64_tr_b16 a[190:191], v19 offset:38912
v_mfma_f32_16x16x32_bf16 v[92:95], a[156:159], a[28:31], v[92:95]
buffer_load_dwordx4 v15, s[8:11], s28 offen offset:3072 lds
s_waitcnt vmcnt(40) lgkmcnt(0)
v_mfma_f32_16x16x32_bf16 v[32:35], a[160:163], a[32:35], v[32:35]
s_add_u32 s23, s30, 12
s_and_b32 s23, s23, 15
s_lshl_b32 s23, s23, 11
s_add_u32 s26, s31, s23
ds_read_b64_tr_b16 a[128:129], v16 offset:0
v_mfma_f32_16x16x32_bf16 v[32:35], a[164:167], a[36:39], v[32:35]
buffer_load_dwordx4 a[0:3], v8, s[4:7], s26 offen offset:0 sc1
v_mfma_f32_16x16x32_bf16 v[36:39], a[160:163], a[40:43], v[36:39]
ds_read_b64_tr_b16 a[130:131], v16 offset:2048
v_mfma_f32_16x16x32_bf16 v[36:39], a[164:167], a[44:47], v[36:39]
buffer_load_dwordx4 a[4:7], v8, s[4:7], s26 offen offset:1024 sc1
v_mfma_f32_16x16x32_bf16 v[40:43], a[160:163], a[48:51], v[40:43]
ds_read_b64_tr_b16 a[132:133], v16 offset:4096
v_mfma_f32_16x16x32_bf16 v[40:43], a[164:167], a[52:55], v[40:43]
buffer_load_dwordx4 a[8:11], v9, s[4:7], s26 offen offset:0 sc1
v_mfma_f32_16x16x32_bf16 v[44:47], a[160:163], a[56:59], v[44:47]
ds_read_b64_tr_b16 a[134:135], v16 offset:6144
v_mfma_f32_16x16x32_bf16 v[44:47], a[164:167], a[60:63], v[44:47]
buffer_load_dwordx4 a[12:15], v9, s[4:7], s26 offen offset:1024 sc1
v_mfma_f32_16x16x32_bf16 v[48:51], a[168:171], a[32:35], v[48:51]
ds_read_b64_tr_b16 a[136:137], v17 offset:0
v_mfma_f32_16x16x32_bf16 v[48:51], a[172:175], a[36:39], v[48:51]
buffer_load_dwordx4 a[16:19], v10, s[4:7], s26 offen offset:0 sc1
v_mfma_f32_16x16x32_bf16 v[52:55], a[168:171], a[40:43], v[52:55]
ds_read_b64_tr_b16 a[138:139], v17 offset:2048
v_mfma_f32_16x16x32_bf16 v[52:55], a[172:175], a[44:47], v[52:55]
buffer_load_dwordx4 a[20:23], v10, s[4:7], s26 offen offset:1024 sc1
v_mfma_f32_16x16x32_bf16 v[56:59], a[168:171], a[48:51], v[56:59]
ds_read_b64_tr_b16 a[140:141], v17 offset:4096
v_mfma_f32_16x16x32_bf16 v[56:59], a[172:175], a[52:55], v[56:59]
buffer_load_dwordx4 a[24:27], v11, s[4:7], s26 offen offset:0 sc1
v_mfma_f32_16x16x32_bf16 v[60:63], a[168:171], a[56:59], v[60:63]
ds_read_b64_tr_b16 a[142:143], v17 offset:6144
v_mfma_f32_16x16x32_bf16 v[60:63], a[172:175], a[60:63], v[60:63]
buffer_load_dwordx4 a[28:31], v11, s[4:7], s26 offen offset:1024 sc1
v_mfma_f32_16x16x32_bf16 v[64:67], a[176:179], a[32:35], v[64:67]
s_add_u32 s22, s30, 14
s_and_b32 s22, s22, 15
s_mul_i32 s22, s22, 57344
s_add_u32 s27, s32, s22
s_add_u32 s28, s27, 28672
s_add_u32 m0, s29, 32768
ds_read_b64_tr_b16 a[144:145], v18 offset:0
v_mfma_f32_16x16x32_bf16 v[64:67], a[180:183], a[36:39], v[64:67]
buffer_load_dwordx4 v12, s[8:11], s27 offen offset:0 lds
v_mfma_f32_16x16x32_bf16 v[68:71], a[176:179], a[40:43], v[68:71]
ds_read_b64_tr_b16 a[146:147], v18 offset:2048
v_mfma_f32_16x16x32_bf16 v[68:71], a[180:183], a[44:47], v[68:71]
buffer_load_dwordx4 v13, s[8:11], s27 offen offset:1024 lds
v_mfma_f32_16x16x32_bf16 v[72:75], a[176:179], a[48:51], v[72:75]
ds_read_b64_tr_b16 a[148:149], v18 offset:4096
v_mfma_f32_16x16x32_bf16 v[72:75], a[180:183], a[52:55], v[72:75]
buffer_load_dwordx4 v14, s[8:11], s27 offen offset:2048 lds
v_mfma_f32_16x16x32_bf16 v[76:79], a[176:179], a[56:59], v[76:79]
ds_read_b64_tr_b16 a[150:151], v18 offset:6144
v_mfma_f32_16x16x32_bf16 v[76:79], a[180:183], a[60:63], v[76:79]
buffer_load_dwordx4 v15, s[8:11], s27 offen offset:3072 lds
v_mfma_f32_16x16x32_bf16 v[80:83], a[184:187], a[32:35], v[80:83]
s_add_u32 m0, s29, 36864
ds_read_b64_tr_b16 a[152:153], v19 offset:0
v_mfma_f32_16x16x32_bf16 v[80:83], a[188:191], a[36:39], v[80:83]
buffer_load_dwordx4 v12, s[8:11], s28 offen offset:0 lds
v_mfma_f32_16x16x32_bf16 v[84:87], a[184:187], a[40:43], v[84:87]
ds_read_b64_tr_b16 a[154:155], v19 offset:2048
v_mfma_f32_16x16x32_bf16 v[84:87], a[188:191], a[44:47], v[84:87]
buffer_load_dwordx4 v13, s[8:11], s28 offen offset:1024 lds
v_mfma_f32_16x16x32_bf16 v[88:91], a[184:187], a[48:51], v[88:91]
ds_read_b64_tr_b16 a[156:157], v19 offset:4096
v_mfma_f32_16x16x32_bf16 v[88:91], a[188:191], a[52:55], v[88:91]
buffer_load_dwordx4 v14, s[8:11], s28 offen offset:2048 lds
v_mfma_f32_16x16x32_bf16 v[92:95], a[184:187], a[56:59], v[92:95]
ds_read_b64_tr_b16 a[158:159], v19 offset:6144
v_mfma_f32_16x16x32_bf16 v[92:95], a[188:191], a[60:63], v[92:95]
buffer_load_dwordx4 v15, s[8:11], s28 offen offset:3072 lds
s_waitcnt vmcnt(40) lgkmcnt(0)
v_mfma_f32_16x16x32_bf16 v[32:35], a[128:131], a[64:67], v[32:35]
s_add_u32 s23, s30, 13
s_and_b32 s23, s23, 15
s_lshl_b32 s23, s23, 11
s_add_u32 s26, s31, s23
ds_read_b64_tr_b16 a[160:161], v16 offset:8192
v_mfma_f32_16x16x32_bf16 v[32:35], a[132:135], a[68:71], v[32:35]
buffer_load_dwordx4 a[32:35], v8, s[4:7], s26 offen offset:0 sc1
v_mfma_f32_16x16x32_bf16 v[36:39], a[128:131], a[72:75], v[36:39]
ds_read_b64_tr_b16 a[162:163], v16 offset:10240
v_mfma_f32_16x16x32_bf16 v[36:39], a[132:135], a[76:79], v[36:39]
buffer_load_dwordx4 a[36:39], v8, s[4:7], s26 offen offset:1024 sc1
v_mfma_f32_16x16x32_bf16 v[40:43], a[128:131], a[80:83], v[40:43]
ds_read_b64_tr_b16 a[164:165], v16 offset:12288
v_mfma_f32_16x16x32_bf16 v[40:43], a[132:135], a[84:87], v[40:43]
buffer_load_dwordx4 a[40:43], v9, s[4:7], s26 offen offset:0 sc1
v_mfma_f32_16x16x32_bf16 v[44:47], a[128:131], a[88:91], v[44:47]
ds_read_b64_tr_b16 a[166:167], v16 offset:14336
v_mfma_f32_16x16x32_bf16 v[44:47], a[132:135], a[92:95], v[44:47]
buffer_load_dwordx4 a[44:47], v9, s[4:7], s26 offen offset:1024 sc1
v_mfma_f32_16x16x32_bf16 v[48:51], a[136:139], a[64:67], v[48:51]
ds_read_b64_tr_b16 a[168:169], v17 offset:8192
v_mfma_f32_16x16x32_bf16 v[48:51], a[140:143], a[68:71], v[48:51]
buffer_load_dwordx4 a[48:51], v10, s[4:7], s26 offen offset:0 sc1
v_mfma_f32_16x16x32_bf16 v[52:55], a[136:139], a[72:75], v[52:55]
ds_read_b64_tr_b16 a[170:171], v17 offset:10240
v_mfma_f32_16x16x32_bf16 v[52:55], a[140:143], a[76:79], v[52:55]
buffer_load_dwordx4 a[52:55], v10, s[4:7], s26 offen offset:1024 sc1
v_mfma_f32_16x16x32_bf16 v[56:59], a[136:139], a[80:83], v[56:59]
ds_read_b64_tr_b16 a[172:173], v17 offset:12288
v_mfma_f32_16x16x32_bf16 v[56:59], a[140:143], a[84:87], v[56:59]
buffer_load_dwordx4 a[56:59], v11, s[4:7], s26 offen offset:0 sc1
v_mfma_f32_16x16x32_bf16 v[60:63], a[136:139], a[88:91], v[60:63]
ds_read_b64_tr_b16 a[174:175], v17 offset:14336
v_mfma_f32_16x16x32_bf16 v[60:63], a[140:143], a[92:95], v[60:63]
buffer_load_dwordx4 a[60:63], v11, s[4:7], s26 offen offset:1024 sc1
v_mfma_f32_16x16x32_bf16 v[64:67], a[144:147], a[64:67], v[64:67]
s_add_u32 s22, s30, 15
s_and_b32 s22, s22, 15
s_mul_i32 s22, s22, 57344
s_add_u32 s27, s32, s22
s_add_u32 s28, s27, 28672
s_add_u32 m0, s29, 0
ds_read_b64_tr_b16 a[176:177], v18 offset:8192
v_mfma_f32_16x16x32_bf16 v[64:67], a[148:151], a[68:71], v[64:67]
buffer_load_dwordx4 v12, s[8:11], s27 offen offset:0 lds
v_mfma_f32_16x16x32_bf16 v[68:71], a[144:147], a[72:75], v[68:71]
ds_read_b64_tr_b16 a[178:179], v18 offset:10240
v_mfma_f32_16x16x32_bf16 v[68:71], a[148:151], a[76:79], v[68:71]
buffer_load_dwordx4 v13, s[8:11], s27 offen offset:1024 lds
v_mfma_f32_16x16x32_bf16 v[72:75], a[144:147], a[80:83], v[72:75]
ds_read_b64_tr_b16 a[180:181], v18 offset:12288
v_mfma_f32_16x16x32_bf16 v[72:75], a[148:151], a[84:87], v[72:75]
buffer_load_dwordx4 v14, s[8:11], s27 offen offset:2048 lds
v_mfma_f32_16x16x32_bf16 v[76:79], a[144:147], a[88:91], v[76:79]
ds_read_b64_tr_b16 a[182:183], v18 offset:14336
v_mfma_f32_16x16x32_bf16 v[76:79], a[148:151], a[92:95], v[76:79]
buffer_load_dwordx4 v15, s[8:11], s27 offen offset:3072 lds
v_mfma_f32_16x16x32_bf16 v[80:83], a[152:155], a[64:67], v[80:83]
s_add_u32 m0, s29, 4096
ds_read_b64_tr_b16 a[184:185], v19 offset:8192
v_mfma_f32_16x16x32_bf16 v[80:83], a[156:159], a[68:71], v[80:83]
buffer_load_dwordx4 v12, s[8:11], s28 offen offset:0 lds
v_mfma_f32_16x16x32_bf16 v[84:87], a[152:155], a[72:75], v[84:87]
ds_read_b64_tr_b16 a[186:187], v19 offset:10240
v_mfma_f32_16x16x32_bf16 v[84:87], a[156:159], a[76:79], v[84:87]
buffer_load_dwordx4 v13, s[8:11], s28 offen offset:1024 lds
v_mfma_f32_16x16x32_bf16 v[88:91], a[152:155], a[80:83], v[88:91]
ds_read_b64_tr_b16 a[188:189], v19 offset:12288
v_mfma_f32_16x16x32_bf16 v[88:91], a[156:159], a[84:87], v[88:91]
buffer_load_dwordx4 v14, s[8:11], s28 offen offset:2048 lds
v_mfma_f32_16x16x32_bf16 v[92:95], a[152:155], a[88:91], v[92:95]
ds_read_b64_tr_b16 a[190:191], v19 offset:14336
v_mfma_f32_16x16x32_bf16 v[92:95], a[156:159], a[92:95], v[92:95]
buffer_load_dwordx4 v15, s[8:11], s28 offen offset:3072 lds
s_waitcnt vmcnt(40) lgkmcnt(0)
v_mfma_f32_16x16x32_bf16 v[32:35], a[160:163], a[96:99], v[32:35]
s_add_u32 s23, s30, 14
s_and_b32 s23, s23, 15
s_lshl_b32 s23, s23, 11
s_add_u32 s26, s31, s23
ds_read_b64_tr_b16 a[128:129], v16 offset:16384
v_mfma_f32_16x16x32_bf16 v[32:35], a[164:167], a[100:103], v[32:35]
buffer_load_dwordx4 a[64:67], v8, s[4:7], s26 offen offset:0 sc1
v_mfma_f32_16x16x32_bf16 v[36:39], a[160:163], a[104:107], v[36:39]
ds_read_b64_tr_b16 a[130:131], v16 offset:18432
v_mfma_f32_16x16x32_bf16 v[36:39], a[164:167], a[108:111], v[36:39]
buffer_load_dwordx4 a[68:71], v8, s[4:7], s26 offen offset:1024 sc1
v_mfma_f32_16x16x32_bf16 v[40:43], a[160:163], a[112:115], v[40:43]
ds_read_b64_tr_b16 a[132:133], v16 offset:20480
v_mfma_f32_16x16x32_bf16 v[40:43], a[164:167], a[116:119], v[40:43]
buffer_load_dwordx4 a[72:75], v9, s[4:7], s26 offen offset:0 sc1
v_mfma_f32_16x16x32_bf16 v[44:47], a[160:163], a[120:123], v[44:47]
ds_read_b64_tr_b16 a[134:135], v16 offset:22528
v_mfma_f32_16x16x32_bf16 v[44:47], a[164:167], a[124:127], v[44:47]
buffer_load_dwordx4 a[76:79], v9, s[4:7], s26 offen offset:1024 sc1
v_mfma_f32_16x16x32_bf16 v[48:51], a[168:171], a[96:99], v[48:51]
ds_read_b64_tr_b16 a[136:137], v17 offset:16384
v_mfma_f32_16x16x32_bf16 v[48:51], a[172:175], a[100:103], v[48:51]
buffer_load_dwordx4 a[80:83], v10, s[4:7], s26 offen offset:0 sc1
v_mfma_f32_16x16x32_bf16 v[52:55], a[168:171], a[104:107], v[52:55]
ds_read_b64_tr_b16 a[138:139], v17 offset:18432
v_mfma_f32_16x16x32_bf16 v[52:55], a[172:175], a[108:111], v[52:55]
buffer_load_dwordx4 a[84:87], v10, s[4:7], s26 offen offset:1024 sc1
v_mfma_f32_16x16x32_bf16 v[56:59], a[168:171], a[112:115], v[56:59]
ds_read_b64_tr_b16 a[140:141], v17 offset:20480
v_mfma_f32_16x16x32_bf16 v[56:59], a[172:175], a[116:119], v[56:59]
buffer_load_dwordx4 a[88:91], v11, s[4:7], s26 offen offset:0 sc1
v_mfma_f32_16x16x32_bf16 v[60:63], a[168:171], a[120:123], v[60:63]
ds_read_b64_tr_b16 a[142:143], v17 offset:22528
v_mfma_f32_16x16x32_bf16 v[60:63], a[172:175], a[124:127], v[60:63]
buffer_load_dwordx4 a[92:95], v11, s[4:7], s26 offen offset:1024 sc1
v_mfma_f32_16x16x32_bf16 v[64:67], a[176:179], a[96:99], v[64:67]
ds_read_b64_tr_b16 a[144:145], v18 offset:16384
v_mfma_f32_16x16x32_bf16 v[64:67], a[180:183], a[100:103], v[64:67]
v_mfma_f32_16x16x32_bf16 v[68:71], a[176:179], a[104:107], v[68:71]
ds_read_b64_tr_b16 a[146:147], v18 offset:18432
v_mfma_f32_16x16x32_bf16 v[68:71], a[180:183], a[108:111], v[68:71]
v_mfma_f32_16x16x32_bf16 v[72:75], a[176:179], a[112:115], v[72:75]
ds_read_b64_tr_b16 a[148:149], v18 offset:20480
v_mfma_f32_16x16x32_bf16 v[72:75], a[180:183], a[116:119], v[72:75]
v_mfma_f32_16x16x32_bf16 v[76:79], a[176:179], a[120:123], v[76:79]
ds_read_b64_tr_b16 a[150:151], v18 offset:22528
v_mfma_f32_16x16x32_bf16 v[76:79], a[180:183], a[124:127], v[76:79]
v_mfma_f32_16x16x32_bf16 v[80:83], a[184:187], a[96:99], v[80:83]
ds_read_b64_tr_b16 a[152:153], v19 offset:16384
v_mfma_f32_16x16x32_bf16 v[80:83], a[188:191], a[100:103], v[80:83]
v_mfma_f32_16x16x32_bf16 v[84:87], a[184:187], a[104:107], v[84:87]
ds_read_b64_tr_b16 a[154:155], v19 offset:18432
v_mfma_f32_16x16x32_bf16 v[84:87], a[188:191], a[108:111], v[84:87]
v_mfma_f32_16x16x32_bf16 v[88:91], a[184:187], a[112:115], v[88:91]
ds_read_b64_tr_b16 a[156:157], v19 offset:20480
v_mfma_f32_16x16x32_bf16 v[88:91], a[188:191], a[116:119], v[88:91]
v_mfma_f32_16x16x32_bf16 v[92:95], a[184:187], a[120:123], v[92:95]
ds_read_b64_tr_b16 a[158:159], v19 offset:22528
v_mfma_f32_16x16x32_bf16 v[92:95], a[188:191], a[124:127], v[92:95]
s_waitcnt vmcnt(32) lgkmcnt(0)
v_mfma_f32_16x16x32_bf16 v[32:35], a[128:131], a[0:3], v[32:35]
s_add_u32 s23, s30, 15
s_and_b32 s23, s23, 15
s_lshl_b32 s23, s23, 11
s_add_u32 s26, s31, s23
ds_read_b64_tr_b16 a[160:161], v16 offset:24576
v_mfma_f32_16x16x32_bf16 v[32:35], a[132:135], a[4:7], v[32:35]
buffer_load_dwordx4 a[96:99], v8, s[4:7], s26 offen offset:0 sc1
v_mfma_f32_16x16x32_bf16 v[36:39], a[128:131], a[8:11], v[36:39]
ds_read_b64_tr_b16 a[162:163], v16 offset:26624
v_mfma_f32_16x16x32_bf16 v[36:39], a[132:135], a[12:15], v[36:39]
buffer_load_dwordx4 a[100:103], v8, s[4:7], s26 offen offset:1024 sc1
v_mfma_f32_16x16x32_bf16 v[40:43], a[128:131], a[16:19], v[40:43]
ds_read_b64_tr_b16 a[164:165], v16 offset:28672
v_mfma_f32_16x16x32_bf16 v[40:43], a[132:135], a[20:23], v[40:43]
buffer_load_dwordx4 a[104:107], v9, s[4:7], s26 offen offset:0 sc1
v_mfma_f32_16x16x32_bf16 v[44:47], a[128:131], a[24:27], v[44:47]
ds_read_b64_tr_b16 a[166:167], v16 offset:30720
v_mfma_f32_16x16x32_bf16 v[44:47], a[132:135], a[28:31], v[44:47]
buffer_load_dwordx4 a[108:111], v9, s[4:7], s26 offen offset:1024 sc1
v_mfma_f32_16x16x32_bf16 v[48:51], a[136:139], a[0:3], v[48:51]
ds_read_b64_tr_b16 a[168:169], v17 offset:24576
v_mfma_f32_16x16x32_bf16 v[48:51], a[140:143], a[4:7], v[48:51]
buffer_load_dwordx4 a[112:115], v10, s[4:7], s26 offen offset:0 sc1
v_mfma_f32_16x16x32_bf16 v[52:55], a[136:139], a[8:11], v[52:55]
ds_read_b64_tr_b16 a[170:171], v17 offset:26624
v_mfma_f32_16x16x32_bf16 v[52:55], a[140:143], a[12:15], v[52:55]
buffer_load_dwordx4 a[116:119], v10, s[4:7], s26 offen offset:1024 sc1
v_mfma_f32_16x16x32_bf16 v[56:59], a[136:139], a[16:19], v[56:59]
ds_read_b64_tr_b16 a[172:173], v17 offset:28672
v_mfma_f32_16x16x32_bf16 v[56:59], a[140:143], a[20:23], v[56:59]
buffer_load_dwordx4 a[120:123], v11, s[4:7], s26 offen offset:0 sc1
v_mfma_f32_16x16x32_bf16 v[60:63], a[136:139], a[24:27], v[60:63]
ds_read_b64_tr_b16 a[174:175], v17 offset:30720
v_mfma_f32_16x16x32_bf16 v[60:63], a[140:143], a[28:31], v[60:63]
buffer_load_dwordx4 a[124:127], v11, s[4:7], s26 offen offset:1024 sc1
v_mfma_f32_16x16x32_bf16 v[64:67], a[144:147], a[0:3], v[64:67]
ds_read_b64_tr_b16 a[176:177], v18 offset:24576
v_mfma_f32_16x16x32_bf16 v[64:67], a[148:151], a[4:7], v[64:67]
v_mfma_f32_16x16x32_bf16 v[68:71], a[144:147], a[8:11], v[68:71]
ds_read_b64_tr_b16 a[178:179], v18 offset:26624
v_mfma_f32_16x16x32_bf16 v[68:71], a[148:151], a[12:15], v[68:71]
v_mfma_f32_16x16x32_bf16 v[72:75], a[144:147], a[16:19], v[72:75]
ds_read_b64_tr_b16 a[180:181], v18 offset:28672
v_mfma_f32_16x16x32_bf16 v[72:75], a[148:151], a[20:23], v[72:75]
v_mfma_f32_16x16x32_bf16 v[76:79], a[144:147], a[24:27], v[76:79]
ds_read_b64_tr_b16 a[182:183], v18 offset:30720
v_mfma_f32_16x16x32_bf16 v[76:79], a[148:151], a[28:31], v[76:79]
v_mfma_f32_16x16x32_bf16 v[80:83], a[152:155], a[0:3], v[80:83]
ds_read_b64_tr_b16 a[184:185], v19 offset:24576
v_mfma_f32_16x16x32_bf16 v[80:83], a[156:159], a[4:7], v[80:83]
v_mfma_f32_16x16x32_bf16 v[84:87], a[152:155], a[8:11], v[84:87]
ds_read_b64_tr_b16 a[186:187], v19 offset:26624
v_mfma_f32_16x16x32_bf16 v[84:87], a[156:159], a[12:15], v[84:87]
v_mfma_f32_16x16x32_bf16 v[88:91], a[152:155], a[16:19], v[88:91]
ds_read_b64_tr_b16 a[188:189], v19 offset:28672
v_mfma_f32_16x16x32_bf16 v[88:91], a[156:159], a[20:23], v[88:91]
v_mfma_f32_16x16x32_bf16 v[92:95], a[152:155], a[24:27], v[92:95]
ds_read_b64_tr_b16 a[190:191], v19 offset:30720
v_mfma_f32_16x16x32_bf16 v[92:95], a[156:159], a[28:31], v[92:95]
s_waitcnt vmcnt(24) lgkmcnt(0)
v_mfma_f32_16x16x32_bf16 v[32:35], a[160:163], a[32:35], v[32:35]
ds_read_b64_tr_b16 a[128:129], v16 offset:32768
v_mfma_f32_16x16x32_bf16 v[32:35], a[164:167], a[36:39], v[32:35]
v_mfma_f32_16x16x32_bf16 v[36:39], a[160:163], a[40:43], v[36:39]
ds_read_b64_tr_b16 a[130:131], v16 offset:34816
v_mfma_f32_16x16x32_bf16 v[36:39], a[164:167], a[44:47], v[36:39]
v_mfma_f32_16x16x32_bf16 v[40:43], a[160:163], a[48:51], v[40:43]
ds_read_b64_tr_b16 a[132:133], v16 offset:36864
v_mfma_f32_16x16x32_bf16 v[40:43], a[164:167], a[52:55], v[40:43]
v_mfma_f32_16x16x32_bf16 v[44:47], a[160:163], a[56:59], v[44:47]
ds_read_b64_tr_b16 a[134:135], v16 offset:38912
v_mfma_f32_16x16x32_bf16 v[44:47], a[164:167], a[60:63], v[44:47]
v_mfma_f32_16x16x32_bf16 v[48:51], a[168:171], a[32:35], v[48:51]
ds_read_b64_tr_b16 a[136:137], v17 offset:32768
v_mfma_f32_16x16x32_bf16 v[48:51], a[172:175], a[36:39], v[48:51]
v_mfma_f32_16x16x32_bf16 v[52:55], a[168:171], a[40:43], v[52:55]
ds_read_b64_tr_b16 a[138:139], v17 offset:34816
v_mfma_f32_16x16x32_bf16 v[52:55], a[172:175], a[44:47], v[52:55]
v_mfma_f32_16x16x32_bf16 v[56:59], a[168:171], a[48:51], v[56:59]
ds_read_b64_tr_b16 a[140:141], v17 offset:36864
v_mfma_f32_16x16x32_bf16 v[56:59], a[172:175], a[52:55], v[56:59]
v_mfma_f32_16x16x32_bf16 v[60:63], a[168:171], a[56:59], v[60:63]
ds_read_b64_tr_b16 a[142:143], v17 offset:38912
v_mfma_f32_16x16x32_bf16 v[60:63], a[172:175], a[60:63], v[60:63]
v_mfma_f32_16x16x32_bf16 v[64:67], a[176:179], a[32:35], v[64:67]
ds_read_b64_tr_b16 a[144:145], v18 offset:32768
v_mfma_f32_16x16x32_bf16 v[64:67], a[180:183], a[36:39], v[64:67]
v_mfma_f32_16x16x32_bf16 v[68:71], a[176:179], a[40:43], v[68:71]
ds_read_b64_tr_b16 a[146:147], v18 offset:34816
v_mfma_f32_16x16x32_bf16 v[68:71], a[180:183], a[44:47], v[68:71]
v_mfma_f32_16x16x32_bf16 v[72:75], a[176:179], a[48:51], v[72:75]
ds_read_b64_tr_b16 a[148:149], v18 offset:36864
v_mfma_f32_16x16x32_bf16 v[72:75], a[180:183], a[52:55], v[72:75]
v_mfma_f32_16x16x32_bf16 v[76:79], a[176:179], a[56:59], v[76:79]
ds_read_b64_tr_b16 a[150:151], v18 offset:38912
v_mfma_f32_16x16x32_bf16 v[76:79], a[180:183], a[60:63], v[76:79]
v_mfma_f32_16x16x32_bf16 v[80:83], a[184:187], a[32:35], v[80:83]
ds_read_b64_tr_b16 a[152:153], v19 offset:32768
v_mfma_f32_16x16x32_bf16 v[80:83], a[188:191], a[36:39], v[80:83]
v_mfma_f32_16x16x32_bf16 v[84:87], a[184:187], a[40:43], v[84:87]
ds_read_b64_tr_b16 a[154:155], v19 offset:34816
v_mfma_f32_16x16x32_bf16 v[84:87], a[188:191], a[44:47], v[84:87]
v_mfma_f32_16x16x32_bf16 v[88:91], a[184:187], a[48:51], v[88:91]
ds_read_b64_tr_b16 a[156:157], v19 offset:36864
v_mfma_f32_16x16x32_bf16 v[88:91], a[188:191], a[52:55], v[88:91]
v_mfma_f32_16x16x32_bf16 v[92:95], a[184:187], a[56:59], v[92:95]
ds_read_b64_tr_b16 a[158:159], v19 offset:38912
v_mfma_f32_16x16x32_bf16 v[92:95], a[188:191], a[60:63], v[92:95]
s_waitcnt vmcnt(8) lgkmcnt(0)
v_mfma_f32_16x16x32_bf16 v[32:35], a[128:131], a[64:67], v[32:35]
ds_read_b64_tr_b16 a[160:161], v16 offset:0
v_mfma_f32_16x16x32_bf16 v[32:35], a[132:135], a[68:71], v[32:35]
v_mfma_f32_16x16x32_bf16 v[36:39], a[128:131], a[72:75], v[36:39]
ds_read_b64_tr_b16 a[162:163], v16 offset:2048
v_mfma_f32_16x16x32_bf16 v[36:39], a[132:135], a[76:79], v[36:39]
v_mfma_f32_16x16x32_bf16 v[40:43], a[128:131], a[80:83], v[40:43]
ds_read_b64_tr_b16 a[164:165], v16 offset:4096
v_mfma_f32_16x16x32_bf16 v[40:43], a[132:135], a[84:87], v[40:43]
v_mfma_f32_16x16x32_bf16 v[44:47], a[128:131], a[88:91], v[44:47]
ds_read_b64_tr_b16 a[166:167], v16 offset:6144
v_mfma_f32_16x16x32_bf16 v[44:47], a[132:135], a[92:95], v[44:47]
v_mfma_f32_16x16x32_bf16 v[48:51], a[136:139], a[64:67], v[48:51]
ds_read_b64_tr_b16 a[168:169], v17 offset:0
v_mfma_f32_16x16x32_bf16 v[48:51], a[140:143], a[68:71], v[48:51]
v_mfma_f32_16x16x32_bf16 v[52:55], a[136:139], a[72:75], v[52:55]
ds_read_b64_tr_b16 a[170:171], v17 offset:2048
v_mfma_f32_16x16x32_bf16 v[52:55], a[140:143], a[76:79], v[52:55]
v_mfma_f32_16x16x32_bf16 v[56:59], a[136:139], a[80:83], v[56:59]
ds_read_b64_tr_b16 a[172:173], v17 offset:4096
v_mfma_f32_16x16x32_bf16 v[56:59], a[140:143], a[84:87], v[56:59]
v_mfma_f32_16x16x32_bf16 v[60:63], a[136:139], a[88:91], v[60:63]
ds_read_b64_tr_b16 a[174:175], v17 offset:6144
v_mfma_f32_16x16x32_bf16 v[60:63], a[140:143], a[92:95], v[60:63]
v_mfma_f32_16x16x32_bf16 v[64:67], a[144:147], a[64:67], v[64:67]
ds_read_b64_tr_b16 a[176:177], v18 offset:0
v_mfma_f32_16x16x32_bf16 v[64:67], a[148:151], a[68:71], v[64:67]
v_mfma_f32_16x16x32_bf16 v[68:71], a[144:147], a[72:75], v[68:71]
ds_read_b64_tr_b16 a[178:179], v18 offset:2048
v_mfma_f32_16x16x32_bf16 v[68:71], a[148:151], a[76:79], v[68:71]
v_mfma_f32_16x16x32_bf16 v[72:75], a[144:147], a[80:83], v[72:75]
ds_read_b64_tr_b16 a[180:181], v18 offset:4096
v_mfma_f32_16x16x32_bf16 v[72:75], a[148:151], a[84:87], v[72:75]
v_mfma_f32_16x16x32_bf16 v[76:79], a[144:147], a[88:91], v[76:79]
ds_read_b64_tr_b16 a[182:183], v18 offset:6144
v_mfma_f32_16x16x32_bf16 v[76:79], a[148:151], a[92:95], v[76:79]
v_mfma_f32_16x16x32_bf16 v[80:83], a[152:155], a[64:67], v[80:83]
ds_read_b64_tr_b16 a[184:185], v19 offset:0
v_mfma_f32_16x16x32_bf16 v[80:83], a[156:159], a[68:71], v[80:83]
v_mfma_f32_16x16x32_bf16 v[84:87], a[152:155], a[72:75], v[84:87]
ds_read_b64_tr_b16 a[186:187], v19 offset:2048
v_mfma_f32_16x16x32_bf16 v[84:87], a[156:159], a[76:79], v[84:87]
v_mfma_f32_16x16x32_bf16 v[88:91], a[152:155], a[80:83], v[88:91]
ds_read_b64_tr_b16 a[188:189], v19 offset:4096
v_mfma_f32_16x16x32_bf16 v[88:91], a[156:159], a[84:87], v[88:91]
v_mfma_f32_16x16x32_bf16 v[92:95], a[152:155], a[88:91], v[92:95]
ds_read_b64_tr_b16 a[190:191], v19 offset:6144
v_mfma_f32_16x16x32_bf16 v[92:95], a[156:159], a[92:95], v[92:95]
s_waitcnt vmcnt(0) lgkmcnt(0)
v_mfma_f32_16x16x32_bf16 v[32:35], a[160:163], a[96:99], v[32:35]
v_mfma_f32_16x16x32_bf16 v[32:35], a[164:167], a[100:103], v[32:35]
v_mfma_f32_16x16x32_bf16 v[36:39], a[160:163], a[104:107], v[36:39]
v_mfma_f32_16x16x32_bf16 v[36:39], a[164:167], a[108:111], v[36:39]
v_mfma_f32_16x16x32_bf16 v[40:43], a[160:163], a[112:115], v[40:43]
v_mfma_f32_16x16x32_bf16 v[40:43], a[164:167], a[116:119], v[40:43]
v_mfma_f32_16x16x32_bf16 v[44:47], a[160:163], a[120:123], v[44:47]
v_mfma_f32_16x16x32_bf16 v[44:47], a[164:167], a[124:127], v[44:47]
v_mfma_f32_16x16x32_bf16 v[48:51], a[168:171], a[96:99], v[48:51]
v_mfma_f32_16x16x32_bf16 v[48:51], a[172:175], a[100:103], v[48:51]
v_mfma_f32_16x16x32_bf16 v[52:55], a[168:171], a[104:107], v[52:55]
v_mfma_f32_16x16x32_bf16 v[52:55], a[172:175], a[108:111], v[52:55]
v_mfma_f32_16x16x32_bf16 v[56:59], a[168:171], a[112:115], v[56:59]
v_mfma_f32_16x16x32_bf16 v[56:59], a[172:175], a[116:119], v[56:59]
v_mfma_f32_16x16x32_bf16 v[60:63], a[168:171], a[120:123], v[60:63]
v_mfma_f32_16x16x32_bf16 v[60:63], a[172:175], a[124:127], v[60:63]
v_mfma_f32_16x16x32_bf16 v[64:67], a[176:179], a[96:99], v[64:67]
v_mfma_f32_16x16x32_bf16 v[64:67], a[180:183], a[100:103], v[64:67]
v_mfma_f32_16x16x32_bf16 v[68:71], a[176:179], a[104:107], v[68:71]
v_mfma_f32_16x16x32_bf16 v[68:71], a[180:183], a[108:111], v[68:71]
v_mfma_f32_16x16x32_bf16 v[72:75], a[176:179], a[112:115], v[72:75]
v_mfma_f32_16x16x32_bf16 v[72:75], a[180:183], a[116:119], v[72:75]
v_mfma_f32_16x16x32_bf16 v[76:79], a[176:179], a[120:123], v[76:79]
v_mfma_f32_16x16x32_bf16 v[76:79], a[180:183], a[124:127], v[76:79]
v_mfma_f32_16x16x32_bf16 v[80:83], a[184:187], a[96:99], v[80:83]
v_mfma_f32_16x16x32_bf16 v[80:83], a[188:191], a[100:103], v[80:83]
v_mfma_f32_16x16x32_bf16 v[84:87], a[184:187], a[104:107], v[84:87]
v_mfma_f32_16x16x32_bf16 v[84:87], a[188:191], a[108:111], v[84:87]
v_mfma_f32_16x16x32_bf16 v[88:91], a[184:187], a[112:115], v[88:91]
v_mfma_f32_16x16x32_bf16 v[88:91], a[188:191], a[116:119], v[88:91]
v_mfma_f32_16x16x32_bf16 v[92:95], a[184:187], a[120:123], v[92:95]
v_mfma_f32_16x16x32_bf16 v[92:95], a[188:191], a[124:127], v[92:95]
s_barrier
s_lshl_b32 s22, s3, 14
v_add_u32 v2, s22, v1
s_lshl_b32 s22, s3, 12
v_add_u32 v3, s22, v1
s_nop 3
ds_write_b128 v2, v[32:35] offset:0
ds_write_b128 v2, v[48:51] offset:1024
ds_write_b128 v2, v[64:67] offset:2048
ds_write_b128 v2, v[80:83] offset:3072
ds_write_b128 v2, v[36:39] offset:4096
ds_write_b128 v2, v[52:55] offset:5120
ds_write_b128 v2, v[68:71] offset:6144
ds_write_b128 v2, v[84:87] offset:7168
ds_write_b128 v2, v[40:43] offset:8192
ds_write_b128 v2, v[56:59] offset:9216
ds_write_b128 v2, v[72:75] offset:10240
ds_write_b128 v2, v[88:91] offset:11264
ds_write_b128 v2, v[44:47] offset:12288
ds_write_b128 v2, v[60:63] offset:13312
ds_write_b128 v2, v[76:79] offset:14336
ds_write_b128 v2, v[92:95] offset:15360
s_waitcnt lgkmcnt(0)
s_barrier
ds_read_b128 v[32:35], v3 offset:0
ds_read_b128 v[36:39], v3 offset:16384
ds_read_b128 v[40:43], v3 offset:32768
ds_read_b128 v[44:47], v3 offset:49152
ds_read_b128 v[48:51], v3 offset:1024
ds_read_b128 v[52:55], v3 offset:17408
ds_read_b128 v[56:59], v3 offset:33792
ds_read_b128 v[60:63], v3 offset:50176
ds_read_b128 v[64:67], v3 offset:2048
ds_read_b128 v[68:71], v3 offset:18432
ds_read_b128 v[72:75], v3 offset:34816
ds_read_b128 v[76:79], v3 offset:51200
ds_read_b128 v[80:83], v3 offset:3072
ds_read_b128 v[84:87], v3 offset:19456
ds_read_b128 v[88:91], v3 offset:35840
ds_read_b128 v[92:95], v3 offset:52224
v_and_b32 v2, 15, v20
v_mul_u32_u24 v2, 1792, v2
v_lshrrev_b32 v3, 4, v20
v_lshl_add_u32 v2, v3, 3, v2
s_lshl_b32 s22, s24, 2
s_add_u32 s22, s22, s3
s_mul_i32 s22, s22, 28672
s_lshl_b32 s23, s25, 7
s_add_u32 s22, s22, s23
s_waitcnt lgkmcnt(12)
v_pk_add_f32 v[32:33], v[32:33], v[36:37]
v_pk_add_f32 v[40:41], v[40:41], v[44:45]
v_pk_add_f32 v[34:35], v[34:35], v[38:39]
v_pk_add_f32 v[42:43], v[42:43], v[46:47]
v_pk_add_f32 v[32:33], v[32:33], v[40:41]
v_pk_add_f32 v[34:35], v[34:35], v[42:43]
v_cvt_pk_bf16_f32 v32, v32, v33
v_cvt_pk_bf16_f32 v33, v34, v35
buffer_store_dwordx2 v[32:33], v2, s[12:15], s22 offen offset:896
s_waitcnt lgkmcnt(8)
v_pk_add_f32 v[48:49], v[48:49], v[52:53]
v_pk_add_f32 v[56:57], v[56:57], v[60:61]
v_pk_add_f32 v[50:51], v[50:51], v[54:55]
v_pk_add_f32 v[58:59], v[58:59], v[62:63]
v_pk_add_f32 v[48:49], v[48:49], v[56:57]
v_pk_add_f32 v[50:51], v[50:51], v[58:59]
v_cvt_pk_bf16_f32 v48, v48, v49
v_cvt_pk_bf16_f32 v49, v50, v51
buffer_store_dwordx2 v[48:49], v2, s[12:15], s22 offen offset:928
s_waitcnt lgkmcnt(4)
v_pk_add_f32 v[64:65], v[64:65], v[68:69]
v_pk_add_f32 v[72:73], v[72:73], v[76:77]
v_pk_add_f32 v[66:67], v[66:67], v[70:71]
v_pk_add_f32 v[74:75], v[74:75], v[78:79]
v_pk_add_f32 v[64:65], v[64:65], v[72:73]
v_pk_add_f32 v[66:67], v[66:67], v[74:75]
v_cvt_pk_bf16_f32 v64, v64, v65
v_cvt_pk_bf16_f32 v65, v66, v67
buffer_store_dwordx2 v[64:65], v2, s[12:15], s22 offen offset:960
s_waitcnt lgkmcnt(0)
v_pk_add_f32 v[80:81], v[80:81], v[84:85]
v_pk_add_f32 v[88:89], v[88:89], v[92:93]
v_pk_add_f32 v[82:83], v[82:83], v[86:87]
v_pk_add_f32 v[90:91], v[90:91], v[94:95]
v_pk_add_f32 v[80:81], v[80:81], v[88:89]
v_pk_add_f32 v[82:83], v[82:83], v[90:91]
v_cvt_pk_bf16_f32 v80, v80, v81
v_cvt_pk_bf16_f32 v81, v82, v83
buffer_store_dwordx2 v[80:81], v2, s[12:15], s22 offen offset:992
M_fin:
s_endpgm
M_final:
s_mov_b32 s8, s64
s_mov_b32 s9, s65
s_mov_b32 s10, 1835008
s_mov_b32 s11, 0x20000
s_mov_b32 s12, s88
s_mov_b32 s13, s89
s_mov_b32 s14, 3670016
s_mov_b32 s15, 0x20000
s_and_b32 s24, s2, 7
s_lshl_b32 s24, s24, 2
s_bfe_u32 s22, s2, 0x10003
s_add_u32 s24, s24, s22
s_bfe_u32 s22, s2, 0x10005
s_lshl_b32 s22, s22, 1
s_add_u32 s24, s24, s22
v_lshrrev_b32 v20, 4, v1
v_and_b32 v21, 15, v20
v_lshrrev_b32 v22, 4, v20
v_mul_u32_u24 v2, 896, v21
v_lshlrev_b32 v9, 1, v2
v_lshl_add_u32 v2, v22, 4, v2
v_lshl_add_u32 v9, v22, 4, v9
s_lshl_b32 s22, s24, 2
s_add_u32 s22, s22, s3
s_mul_i32 s25, s22, 14336
s_lshl_b32 s26, s25, 1
buffer_load_dwordx4 v[32:35], v2, s[8:11], s25 offen offset:0
buffer_load_dwordx4 v[36:39], v2, s[8:11], s25 offen offset:64
buffer_load_dwordx4 v[40:43], v2, s[8:11], s25 offen offset:128
buffer_load_dwordx4 v[44:47], v2, s[8:11], s25 offen offset:192
buffer_load_dwordx4 v[48:51], v2, s[8:11], s25 offen offset:256
buffer_load_dwordx4 v[52:55], v2, s[8:11], s25 offen offset:320
buffer_load_dwordx4 v[56:59], v2, s[8:11], s25 offen offset:384
buffer_load_dwordx4 v[60:63], v2, s[8:11], s25 offen offset:448
buffer_load_dwordx4 v[64:67], v2, s[8:11], s25 offen offset:512
buffer_load_dwordx4 v[68:71], v2, s[8:11], s25 offen offset:576
buffer_load_dwordx4 v[72:75], v2, s[8:11], s25 offen offset:640
buffer_load_dwordx4 v[76:79], v2, s[8:11], s25 offen offset:704
buffer_load_dwordx4 v[80:83], v2, s[8:11], s25 offen offset:768
buffer_load_dwordx4 v[84:87], v2, s[8:11], s25 offen offset:832
s_waitcnt vmcnt(14)
s_barrier
buffer_store_dword v6, v5, s[4:7], s34 offen sc1
v_lshlrev_b32 v10, 5, v22
v_add3_u32 v10, v10, v21, 16
v_lshlrev_b32 v10, 2, v10
v_min_u32 v11, 380, v10
v_add_u32 v11, 512, v11
s_mov_b32 s27, 94384128
Lfp:
buffer_load_dword v3, v10, s[4:7], s27 offen sc1
buffer_load_dword v4, v11, s[4:7], s27 offen sc1
s_waitcnt vmcnt(0)
v_and_b32 v3, v3, v4
v_cmp_ne_u32 vcc, 1, v3
s_cbranch_vccz Lfpd
s_sleep 4
s_sub_u32 s101, s101, 1
s_cbranch_scc0 Lfp
s_mov_b32 s101, 0
Lfpd:
v_lshrrev_b32 v3, 3, v20
v_and_b32 v4, 7, v20
v_lshlrev_b32 v4, 4, v4
v_lshl_add_u32 v3, v3, 12, v4
s_mul_i32 s27, s3, 458752
s_lshl_b32 s22, s24, 7
s_add_u32 s27, s27, s22
s_add_u32 s27, s27, 88080384
s_mul_i32 s28, s3, 14336
s_add_u32 m0, s28, 0
s_nop 0
buffer_load_dwordx4 v3, s[4:7], s27 offen sc1 lds
s_add_u32 s27, s27, 32768
s_add_u32 m0, s28, 1024
s_nop 0
buffer_load_dwordx4 v3, s[4:7], s27 offen sc1 lds
s_add_u32 s27, s27, 32768
s_add_u32 m0, s28, 2048
s_nop 0
buffer_load_dwordx4 v3, s[4:7], s27 offen sc1 lds
s_add_u32 s27, s27, 32768
s_add_u32 m0, s28, 3072
s_nop 0
buffer_load_dwordx4 v3, s[4:7], s27 offen sc1 lds
s_add_u32 s27, s27, 32768
s_add_u32 m0, s28, 4096
s_nop 0
buffer_load_dwordx4 v3, s[4:7], s27 offen sc1 lds
s_add_u32 s27, s27, 32768
s_add_u32 m0, s28, 5120
s_nop 0
buffer_load_dwordx4 v3, s[4:7], s27 offen sc1 lds
s_add_u32 s27, s27, 32768
s_add_u32 m0, s28, 6144
s_nop 0
buffer_load_dwordx4 v3, s[4:7], s27 offen sc1 lds
s_add_u32 s27, s27, 32768
s_add_u32 m0, s28, 7168
s_nop 0
buffer_load_dwordx4 v3, s[4:7], s27 offen sc1 lds
s_add_u32 s27, s27, 32768
s_add_u32 m0, s28, 8192
s_nop 0
buffer_load_dwordx4 v3, s[4:7], s27 offen sc1 lds
s_add_u32 s27, s27, 32768
s_add_u32 m0, s28, 9216
s_nop 0
buffer_load_dwordx4 v3, s[4:7], s27 offen sc1 lds
s_add_u32 s27, s27, 32768
s_add_u32 m0, s28, 10240
s_nop 0
buffer_load_dwordx4 v3, s[4:7], s27 offen sc1 lds
s_add_u32 s27, s27, 32768
s_add_u32 m0, s28, 11264
s_nop 0
buffer_load_dwordx4 v3, s[4:7], s27 offen sc1 lds
s_add_u32 s27, s27, 32768
s_add_u32 m0, s28, 12288
s_nop 0
buffer_load_dwordx4 v3, s[4:7], s27 offen sc1 lds
s_add_u32 s27, s27, 32768
s_add_u32 m0, s28, 13312
s_nop 0
buffer_load_dwordx4 v3, s[4:7], s27 offen sc1 lds
s_add_u32 s27, s27, 32768
v_lshrrev_b32 v3, 2, v21
v_lshl_add_u32 v3, v22, 3, v3
v_lshlrev_b32 v3, 7, v3
v_and_b32 v4, 3, v20
v_lshl_add_u32 v3, v4, 3, v3
s_lshl_b32 s22, s3, 5
v_add_u32 v3, s22, v3
s_waitcnt vmcnt(0)
s_barrier
ds_read_b64_tr_b16 v[96:97], v3 offset:0
ds_read_b64_tr_b16 v[98:99], v3 offset:512
ds_read_b64_tr_b16 v[100:101], v3 offset:4096
ds_read_b64_tr_b16 v[102:103], v3 offset:4608
ds_read_b64_tr_b16 v[104:105], v3 offset:8192
ds_read_b64_tr_b16 v[106:107], v3 offset:8704
ds_read_b64_tr_b16 v[108:109], v3 offset:12288
ds_read_b64_tr_b16 v[110:111], v3 offset:12800
ds_read_b64_tr_b16 v[112:113], v3 offset:16384
ds_read_b64_tr_b16 v[114:115], v3 offset:16896
ds_read_b64_tr_b16 v[116:117], v3 offset:20480
ds_read_b64_tr_b16 v[118:119], v3 offset:20992
ds_read_b64_tr_b16 v[120:121], v3 offset:24576
ds_read_b64_tr_b16 v[122:123], v3 offset:25088
s_waitcnt lgkmcnt(0)
ds_read_b64_tr_b16 v[124:125], v3 offset:28672
ds_read_b64_tr_b16 v[126:127], v3 offset:29184
ds_read_b64_tr_b16 v[128:129], v3 offset:32768
ds_read_b64_tr_b16 v[130:131], v3 offset:33280
ds_read_b64_tr_b16 v[132:133], v3 offset:36864
ds_read_b64_tr_b16 v[134:135], v3 offset:37376
ds_read_b64_tr_b16 v[136:137], v3 offset:40960
ds_read_b64_tr_b16 v[138:139], v3 offset:41472
ds_read_b64_tr_b16 v[140:141], v3 offset:45056
ds_read_b64_tr_b16 v[142:143], v3 offset:45568
ds_read_b64_tr_b16 v[144:145], v3 offset:49152
ds_read_b64_tr_b16 v[146:147], v3 offset:49664
ds_read_b64_tr_b16 v[148:149], v3 offset:53248
ds_read_b64_tr_b16 v[150:151], v3 offset:53760
v_lshlrev_b32 v10, 16, v32
v_and_b32 v11, 0xffff0000, v32
v_lshlrev_b32 v12, 16, v96
v_and_b32 v13, 0xffff0000, v96
v_pk_mul_f32 v[10:11], v[10:11], v[12:13]
v_cvt_pk_bf16_f32 v32, v10, v11
v_lshlrev_b32 v10, 16, v33
v_and_b32 v11, 0xffff0000, v33
v_lshlrev_b32 v12, 16, v97
v_and_b32 v13, 0xffff0000, v97
v_pk_mul_f32 v[10:11], v[10:11], v[12:13]
v_cvt_pk_bf16_f32 v33, v10, v11
v_lshlrev_b32 v10, 16, v34
v_and_b32 v11, 0xffff0000, v34
v_lshlrev_b32 v12, 16, v98
v_and_b32 v13, 0xffff0000, v98
v_pk_mul_f32 v[10:11], v[10:11], v[12:13]
v_cvt_pk_bf16_f32 v34, v10, v11
v_lshlrev_b32 v10, 16, v35
v_and_b32 v11, 0xffff0000, v35
v_lshlrev_b32 v12, 16, v99
v_and_b32 v13, 0xffff0000, v99
v_pk_mul_f32 v[10:11], v[10:11], v[12:13]
v_cvt_pk_bf16_f32 v35, v10, v11
buffer_store_dwordx4 v[32:35], v9, s[12:15], s26 offen offset:0
v_lshlrev_b32 v10, 16, v36
v_and_b32 v11, 0xffff0000, v36
v_lshlrev_b32 v12, 16, v100
v_and_b32 v13, 0xffff0000, v100
v_pk_mul_f32 v[10:11], v[10:11], v[12:13]
v_cvt_pk_bf16_f32 v36, v10, v11
v_lshlrev_b32 v10, 16, v37
v_and_b32 v11, 0xffff0000, v37
v_lshlrev_b32 v12, 16, v101
v_and_b32 v13, 0xffff0000, v101
v_pk_mul_f32 v[10:11], v[10:11], v[12:13]
v_cvt_pk_bf16_f32 v37, v10, v11
v_lshlrev_b32 v10, 16, v38
v_and_b32 v11, 0xffff0000, v38
v_lshlrev_b32 v12, 16, v102
v_and_b32 v13, 0xffff0000, v102
v_pk_mul_f32 v[10:11], v[10:11], v[12:13]
v_cvt_pk_bf16_f32 v38, v10, v11
v_lshlrev_b32 v10, 16, v39
v_and_b32 v11, 0xffff0000, v39
v_lshlrev_b32 v12, 16, v103
v_and_b32 v13, 0xffff0000, v103
v_pk_mul_f32 v[10:11], v[10:11], v[12:13]
v_cvt_pk_bf16_f32 v39, v10, v11
buffer_store_dwordx4 v[36:39], v9, s[12:15], s26 offen offset:64
v_lshlrev_b32 v10, 16, v40
v_and_b32 v11, 0xffff0000, v40
v_lshlrev_b32 v12, 16, v104
v_and_b32 v13, 0xffff0000, v104
v_pk_mul_f32 v[10:11], v[10:11], v[12:13]
v_cvt_pk_bf16_f32 v40, v10, v11
v_lshlrev_b32 v10, 16, v41
v_and_b32 v11, 0xffff0000, v41
v_lshlrev_b32 v12, 16, v105
v_and_b32 v13, 0xffff0000, v105
v_pk_mul_f32 v[10:11], v[10:11], v[12:13]
v_cvt_pk_bf16_f32 v41, v10, v11
v_lshlrev_b32 v10, 16, v42
v_and_b32 v11, 0xffff0000, v42
v_lshlrev_b32 v12, 16, v106
v_and_b32 v13, 0xffff0000, v106
v_pk_mul_f32 v[10:11], v[10:11], v[12:13]
v_cvt_pk_bf16_f32 v42, v10, v11
v_lshlrev_b32 v10, 16, v43
v_and_b32 v11, 0xffff0000, v43
v_lshlrev_b32 v12, 16, v107
v_and_b32 v13, 0xffff0000, v107
v_pk_mul_f32 v[10:11], v[10:11], v[12:13]
v_cvt_pk_bf16_f32 v43, v10, v11
buffer_store_dwordx4 v[40:43], v9, s[12:15], s26 offen offset:128
v_lshlrev_b32 v10, 16, v44
v_and_b32 v11, 0xffff0000, v44
v_lshlrev_b32 v12, 16, v108
v_and_b32 v13, 0xffff0000, v108
v_pk_mul_f32 v[10:11], v[10:11], v[12:13]
v_cvt_pk_bf16_f32 v44, v10, v11
v_lshlrev_b32 v10, 16, v45
v_and_b32 v11, 0xffff0000, v45
v_lshlrev_b32 v12, 16, v109
v_and_b32 v13, 0xffff0000, v109
v_pk_mul_f32 v[10:11], v[10:11], v[12:13]
v_cvt_pk_bf16_f32 v45, v10, v11
v_lshlrev_b32 v10, 16, v46
v_and_b32 v11, 0xffff0000, v46
v_lshlrev_b32 v12, 16, v110
v_and_b32 v13, 0xffff0000, v110
v_pk_mul_f32 v[10:11], v[10:11], v[12:13]
v_cvt_pk_bf16_f32 v46, v10, v11
v_lshlrev_b32 v10, 16, v47
v_and_b32 v11, 0xffff0000, v47
v_lshlrev_b32 v12, 16, v111
v_and_b32 v13, 0xffff0000, v111
v_pk_mul_f32 v[10:11], v[10:11], v[12:13]
v_cvt_pk_bf16_f32 v47, v10, v11
buffer_store_dwordx4 v[44:47], v9, s[12:15], s26 offen offset:192
v_lshlrev_b32 v10, 16, v48
v_and_b32 v11, 0xffff0000, v48
v_lshlrev_b32 v12, 16, v112
v_and_b32 v13, 0xffff0000, v112
v_pk_mul_f32 v[10:11], v[10:11], v[12:13]
v_cvt_pk_bf16_f32 v48, v10, v11
v_lshlrev_b32 v10, 16, v49
v_and_b32 v11, 0xffff0000, v49
v_lshlrev_b32 v12, 16, v113
v_and_b32 v13, 0xffff0000, v113
v_pk_mul_f32 v[10:11], v[10:11], v[12:13]
v_cvt_pk_bf16_f32 v49, v10, v11
v_lshlrev_b32 v10, 16, v50
v_and_b32 v11, 0xffff0000, v50
v_lshlrev_b32 v12, 16, v114
v_and_b32 v13, 0xffff0000, v114
v_pk_mul_f32 v[10:11], v[10:11], v[12:13]
v_cvt_pk_bf16_f32 v50, v10, v11
v_lshlrev_b32 v10, 16, v51
v_and_b32 v11, 0xffff0000, v51
v_lshlrev_b32 v12, 16, v115
v_and_b32 v13, 0xffff0000, v115
v_pk_mul_f32 v[10:11], v[10:11], v[12:13]
v_cvt_pk_bf16_f32 v51, v10, v11
buffer_store_dwordx4 v[48:51], v9, s[12:15], s26 offen offset:256
v_lshlrev_b32 v10, 16, v52
v_and_b32 v11, 0xffff0000, v52
v_lshlrev_b32 v12, 16, v116
v_and_b32 v13, 0xffff0000, v116
v_pk_mul_f32 v[10:11], v[10:11], v[12:13]
v_cvt_pk_bf16_f32 v52, v10, v11
v_lshlrev_b32 v10, 16, v53
v_and_b32 v11, 0xffff0000, v53
v_lshlrev_b32 v12, 16, v117
v_and_b32 v13, 0xffff0000, v117
v_pk_mul_f32 v[10:11], v[10:11], v[12:13]
v_cvt_pk_bf16_f32 v53, v10, v11
v_lshlrev_b32 v10, 16, v54
v_and_b32 v11, 0xffff0000, v54
v_lshlrev_b32 v12, 16, v118
v_and_b32 v13, 0xffff0000, v118
v_pk_mul_f32 v[10:11], v[10:11], v[12:13]
v_cvt_pk_bf16_f32 v54, v10, v11
v_lshlrev_b32 v10, 16, v55
v_and_b32 v11, 0xffff0000, v55
v_lshlrev_b32 v12, 16, v119
v_and_b32 v13, 0xffff0000, v119
v_pk_mul_f32 v[10:11], v[10:11], v[12:13]
v_cvt_pk_bf16_f32 v55, v10, v11
buffer_store_dwordx4 v[52:55], v9, s[12:15], s26 offen offset:320
v_lshlrev_b32 v10, 16, v56
v_and_b32 v11, 0xffff0000, v56
v_lshlrev_b32 v12, 16, v120
v_and_b32 v13, 0xffff0000, v120
v_pk_mul_f32 v[10:11], v[10:11], v[12:13]
v_cvt_pk_bf16_f32 v56, v10, v11
v_lshlrev_b32 v10, 16, v57
v_and_b32 v11, 0xffff0000, v57
v_lshlrev_b32 v12, 16, v121
v_and_b32 v13, 0xffff0000, v121
v_pk_mul_f32 v[10:11], v[10:11], v[12:13]
v_cvt_pk_bf16_f32 v57, v10, v11
v_lshlrev_b32 v10, 16, v58
v_and_b32 v11, 0xffff0000, v58
v_lshlrev_b32 v12, 16, v122
v_and_b32 v13, 0xffff0000, v122
v_pk_mul_f32 v[10:11], v[10:11], v[12:13]
v_cvt_pk_bf16_f32 v58, v10, v11
v_lshlrev_b32 v10, 16, v59
v_and_b32 v11, 0xffff0000, v59
v_lshlrev_b32 v12, 16, v123
v_and_b32 v13, 0xffff0000, v123
v_pk_mul_f32 v[10:11], v[10:11], v[12:13]
v_cvt_pk_bf16_f32 v59, v10, v11
buffer_store_dwordx4 v[56:59], v9, s[12:15], s26 offen offset:384
s_waitcnt lgkmcnt(0)
v_lshlrev_b32 v10, 16, v60
v_and_b32 v11, 0xffff0000, v60
v_lshlrev_b32 v12, 16, v124
v_and_b32 v13, 0xffff0000, v124
v_pk_mul_f32 v[10:11], v[10:11], v[12:13]
v_cvt_pk_bf16_f32 v60, v10, v11
v_lshlrev_b32 v10, 16, v61
v_and_b32 v11, 0xffff0000, v61
v_lshlrev_b32 v12, 16, v125
v_and_b32 v13, 0xffff0000, v125
v_pk_mul_f32 v[10:11], v[10:11], v[12:13]
v_cvt_pk_bf16_f32 v61, v10, v11
v_lshlrev_b32 v10, 16, v62
v_and_b32 v11, 0xffff0000, v62
v_lshlrev_b32 v12, 16, v126
v_and_b32 v13, 0xffff0000, v126
v_pk_mul_f32 v[10:11], v[10:11], v[12:13]
v_cvt_pk_bf16_f32 v62, v10, v11
v_lshlrev_b32 v10, 16, v63
v_and_b32 v11, 0xffff0000, v63
v_lshlrev_b32 v12, 16, v127
v_and_b32 v13, 0xffff0000, v127
v_pk_mul_f32 v[10:11], v[10:11], v[12:13]
v_cvt_pk_bf16_f32 v63, v10, v11
buffer_store_dwordx4 v[60:63], v9, s[12:15], s26 offen offset:448
v_lshlrev_b32 v10, 16, v64
v_and_b32 v11, 0xffff0000, v64
v_lshlrev_b32 v12, 16, v128
v_and_b32 v13, 0xffff0000, v128
v_pk_mul_f32 v[10:11], v[10:11], v[12:13]
v_cvt_pk_bf16_f32 v64, v10, v11
v_lshlrev_b32 v10, 16, v65
v_and_b32 v11, 0xffff0000, v65
v_lshlrev_b32 v12, 16, v129
v_and_b32 v13, 0xffff0000, v129
v_pk_mul_f32 v[10:11], v[10:11], v[12:13]
v_cvt_pk_bf16_f32 v65, v10, v11
v_lshlrev_b32 v10, 16, v66
v_and_b32 v11, 0xffff0000, v66
v_lshlrev_b32 v12, 16, v130
v_and_b32 v13, 0xffff0000, v130
v_pk_mul_f32 v[10:11], v[10:11], v[12:13]
v_cvt_pk_bf16_f32 v66, v10, v11
v_lshlrev_b32 v10, 16, v67
v_and_b32 v11, 0xffff0000, v67
v_lshlrev_b32 v12, 16, v131
v_and_b32 v13, 0xffff0000, v131
v_pk_mul_f32 v[10:11], v[10:11], v[12:13]
v_cvt_pk_bf16_f32 v67, v10, v11
buffer_store_dwordx4 v[64:67], v9, s[12:15], s26 offen offset:512
v_lshlrev_b32 v10, 16, v68
v_and_b32 v11, 0xffff0000, v68
v_lshlrev_b32 v12, 16, v132
v_and_b32 v13, 0xffff0000, v132
v_pk_mul_f32 v[10:11], v[10:11], v[12:13]
v_cvt_pk_bf16_f32 v68, v10, v11
v_lshlrev_b32 v10, 16, v69
v_and_b32 v11, 0xffff0000, v69
v_lshlrev_b32 v12, 16, v133
v_and_b32 v13, 0xffff0000, v133
v_pk_mul_f32 v[10:11], v[10:11], v[12:13]
v_cvt_pk_bf16_f32 v69, v10, v11
v_lshlrev_b32 v10, 16, v70
v_and_b32 v11, 0xffff0000, v70
v_lshlrev_b32 v12, 16, v134
v_and_b32 v13, 0xffff0000, v134
v_pk_mul_f32 v[10:11], v[10:11], v[12:13]
v_cvt_pk_bf16_f32 v70, v10, v11
v_lshlrev_b32 v10, 16, v71
v_and_b32 v11, 0xffff0000, v71
v_lshlrev_b32 v12, 16, v135
v_and_b32 v13, 0xffff0000, v135
v_pk_mul_f32 v[10:11], v[10:11], v[12:13]
v_cvt_pk_bf16_f32 v71, v10, v11
buffer_store_dwordx4 v[68:71], v9, s[12:15], s26 offen offset:576
v_lshlrev_b32 v10, 16, v72
v_and_b32 v11, 0xffff0000, v72
v_lshlrev_b32 v12, 16, v136
v_and_b32 v13, 0xffff0000, v136
v_pk_mul_f32 v[10:11], v[10:11], v[12:13]
v_cvt_pk_bf16_f32 v72, v10, v11
v_lshlrev_b32 v10, 16, v73
v_and_b32 v11, 0xffff0000, v73
v_lshlrev_b32 v12, 16, v137
v_and_b32 v13, 0xffff0000, v137
v_pk_mul_f32 v[10:11], v[10:11], v[12:13]
v_cvt_pk_bf16_f32 v73, v10, v11
v_lshlrev_b32 v10, 16, v74
v_and_b32 v11, 0xffff0000, v74
v_lshlrev_b32 v12, 16, v138
v_and_b32 v13, 0xffff0000, v138
v_pk_mul_f32 v[10:11], v[10:11], v[12:13]
v_cvt_pk_bf16_f32 v74, v10, v11
v_lshlrev_b32 v10, 16, v75
v_and_b32 v11, 0xffff0000, v75
v_lshlrev_b32 v12, 16, v139
v_and_b32 v13, 0xffff0000, v139
v_pk_mul_f32 v[10:11], v[10:11], v[12:13]
v_cvt_pk_bf16_f32 v75, v10, v11
buffer_store_dwordx4 v[72:75], v9, s[12:15], s26 offen offset:640
v_lshlrev_b32 v10, 16, v76
v_and_b32 v11, 0xffff0000, v76
v_lshlrev_b32 v12, 16, v140
v_and_b32 v13, 0xffff0000, v140
v_pk_mul_f32 v[10:11], v[10:11], v[12:13]
v_cvt_pk_bf16_f32 v76, v10, v11
v_lshlrev_b32 v10, 16, v77
v_and_b32 v11, 0xffff0000, v77
v_lshlrev_b32 v12, 16, v141
v_and_b32 v13, 0xffff0000, v141
v_pk_mul_f32 v[10:11], v[10:11], v[12:13]
v_cvt_pk_bf16_f32 v77, v10, v11
v_lshlrev_b32 v10, 16, v78
v_and_b32 v11, 0xffff0000, v78
v_lshlrev_b32 v12, 16, v142
v_and_b32 v13, 0xffff0000, v142
v_pk_mul_f32 v[10:11], v[10:11], v[12:13]
v_cvt_pk_bf16_f32 v78, v10, v11
v_lshlrev_b32 v10, 16, v79
v_and_b32 v11, 0xffff0000, v79
v_lshlrev_b32 v12, 16, v143
v_and_b32 v13, 0xffff0000, v143
v_pk_mul_f32 v[10:11], v[10:11], v[12:13]
v_cvt_pk_bf16_f32 v79, v10, v11
buffer_store_dwordx4 v[76:79], v9, s[12:15], s26 offen offset:704
v_lshlrev_b32 v10, 16, v80
v_and_b32 v11, 0xffff0000, v80
v_lshlrev_b32 v12, 16, v144
v_and_b32 v13, 0xffff0000, v144
v_pk_mul_f32 v[10:11], v[10:11], v[12:13]
v_cvt_pk_bf16_f32 v80, v10, v11
v_lshlrev_b32 v10, 16, v81
v_and_b32 v11, 0xffff0000, v81
v_lshlrev_b32 v12, 16, v145
v_and_b32 v13, 0xffff0000, v145
v_pk_mul_f32 v[10:11], v[10:11], v[12:13]
v_cvt_pk_bf16_f32 v81, v10, v11
v_lshlrev_b32 v10, 16, v82
v_and_b32 v11, 0xffff0000, v82
v_lshlrev_b32 v12, 16, v146
v_and_b32 v13, 0xffff0000, v146
v_pk_mul_f32 v[10:11], v[10:11], v[12:13]
v_cvt_pk_bf16_f32 v82, v10, v11
v_lshlrev_b32 v10, 16, v83
v_and_b32 v11, 0xffff0000, v83
v_lshlrev_b32 v12, 16, v147
v_and_b32 v13, 0xffff0000, v147
v_pk_mul_f32 v[10:11], v[10:11], v[12:13]
v_cvt_pk_bf16_f32 v83, v10, v11
buffer_store_dwordx4 v[80:83], v9, s[12:15], s26 offen offset:768
v_lshlrev_b32 v10, 16, v84
v_and_b32 v11, 0xffff0000, v84
v_lshlrev_b32 v12, 16, v148
v_and_b32 v13, 0xffff0000, v148
v_pk_mul_f32 v[10:11], v[10:11], v[12:13]
v_cvt_pk_bf16_f32 v84, v10, v11
v_lshlrev_b32 v10, 16, v85
v_and_b32 v11, 0xffff0000, v85
v_lshlrev_b32 v12, 16, v149
v_and_b32 v13, 0xffff0000, v149
v_pk_mul_f32 v[10:11], v[10:11], v[12:13]
v_cvt_pk_bf16_f32 v85, v10, v11
v_lshlrev_b32 v10, 16, v86
v_and_b32 v11, 0xffff0000, v86
v_lshlrev_b32 v12, 16, v150
v_and_b32 v13, 0xffff0000, v150
v_pk_mul_f32 v[10:11], v[10:11], v[12:13]
v_cvt_pk_bf16_f32 v86, v10, v11
v_lshlrev_b32 v10, 16, v87
v_and_b32 v11, 0xffff0000, v87
v_lshlrev_b32 v12, 16, v151
v_and_b32 v13, 0xffff0000, v151
v_pk_mul_f32 v[10:11], v[10:11], v[12:13]
v_cvt_pk_bf16_f32 v87, v10, v11
buffer_store_dwordx4 v[84:87], v9, s[12:15], s26 offen offset:832
s_branch M_fin
M_conv:
v_mfma_f32_16x16x32_bf16 v[36:39], a[128:131], a[0:3], v[36:39]
s_waitcnt lgkmcnt(0)
ds_read_b64_tr_b16 a[136:137], v23 offset:0
v_mfma_f32_16x16x32_bf16 v[36:39], a[132:135], a[4:7], v[36:39]
s_mul_i32 s43, s20, 7
v_mfma_f32_16x16x32_bf16 v[44:47], a[128:131], a[8:11], v[44:47]
s_add_u32 s43, s43, s21
ds_read_b64_tr_b16 a[138:139], v23 offset:2048
v_mfma_f32_16x16x32_bf16 v[44:47], a[132:135], a[12:15], v[44:47]
s_lshl_b32 s43, s43, 2
v_mfma_f32_16x16x32_bf16 v[52:55], a[128:131], a[16:19], v[52:55]
s_add_u32 s43, s43, s3
ds_read_b64_tr_b16 a[140:141], v23 offset:16384
v_mfma_f32_16x16x32_bf16 v[52:55], a[132:135], a[20:23], v[52:55]
s_mul_i32 s40, s43, 4224
v_mfma_f32_16x16x32_bf16 v[60:63], a[128:131], a[24:27], v[60:63]
s_add_u32 s40, s40, 83886208
ds_read_b64_tr_b16 a[142:143], v23 offset:18432
v_mfma_f32_16x16x32_bf16 v[60:63], a[132:135], a[28:31], v[60:63]
s_lshl_b32 s41, s43, 12
v_mfma_f32_16x16x32_bf16 v[68:71], a[128:131], a[32:35], v[68:71]
s_mul_i32 s42, s3, 21248
v_mfma_f32_16x16x32_bf16 v[68:71], a[132:135], a[36:39], v[68:71]
s_add_u32 s42, s42, 46080
v_mfma_f32_16x16x32_bf16 v[76:79], a[128:131], a[40:43], v[76:79]
s_mov_b64 s[8:9], s[72:73]
v_mfma_f32_16x16x32_bf16 v[76:79], a[132:135], a[44:47], v[76:79]
s_add_u32 m0, s42, 17152
v_mfma_f32_16x16x32_bf16 v[84:87], a[128:131], a[48:51], v[84:87]
buffer_load_dwordx4 v1, s[8:11], s41 offen offset:0 lds
v_mfma_f32_16x16x32_bf16 v[84:87], a[132:135], a[52:55], v[84:87]
buffer_load_dwordx4 v1, s[8:11], s41 offen offset:1024 lds
v_mfma_f32_16x16x32_bf16 v[92:95], a[128:131], a[56:59], v[92:95]
buffer_load_dwordx4 v1, s[8:11], s41 offen offset:2048 lds
v_mfma_f32_16x16x32_bf16 v[92:95], a[132:135], a[60:63], v[92:95]
s_waitcnt lgkmcnt(2)
buffer_load_dwordx4 v1, s[8:11], s41 offen offset:3072 lds
v_mfma_f32_16x16x32_bf16 v[100:103], a[136:139], a[0:3], v[100:103]
s_waitcnt lgkmcnt(0)
ds_read_b64_tr_b16 a[128:129], v24 offset:0
v_mfma_f32_16x16x32_bf16 v[100:103], a[140:143], a[4:7], v[100:103]
s_add_u32 m0, s42, 64
v_mfma_f32_16x16x32_bf16 v[108:111], a[136:139], a[8:11], v[108:111]
ds_read_b64_tr_b16 a[130:131], v24 offset:2048
v_mfma_f32_16x16x32_bf16 v[108:111], a[140:143], a[12:15], v[108:111]
buffer_load_dwordx4 v1, s[4:7], s40 offen offset:0 sc1 lds
v_mfma_f32_16x16x32_bf16 v[116:119], a[136:139], a[16:19], v[116:119]
ds_read_b64_tr_b16 a[132:133], v24 offset:16384
v_mfma_f32_16x16x32_bf16 v[116:119], a[140:143], a[20:23], v[116:119]
buffer_load_dwordx4 v1, s[4:7], s40 offen offset:1024 sc1 lds
v_mfma_f32_16x16x32_bf16 v[124:127], a[136:139], a[24:27], v[124:127]
ds_read_b64_tr_b16 a[134:135], v24 offset:18432
v_mfma_f32_16x16x32_bf16 v[124:127], a[140:143], a[28:31], v[124:127]
buffer_load_dwordx4 v1, s[4:7], s40 offen offset:2048 sc1 lds
v_mfma_f32_16x16x32_bf16 v[132:135], a[136:139], a[32:35], v[132:135]
buffer_load_dwordx4 v1, s[4:7], s40 offen offset:3072 sc1 lds
v_mfma_f32_16x16x32_bf16 v[132:135], a[140:143], a[36:39], v[132:135]
s_sub_u32 s40, s40, 2
v_mfma_f32_16x16x32_bf16 v[140:143], a[136:139], a[40:43], v[140:143]
s_add_u32 m0, s42, 4224
v_mfma_f32_16x16x32_bf16 v[140:143], a[140:143], a[44:47], v[140:143]
buffer_load_dwordx4 v1, s[4:7], s40 offen offset:0 sc1 lds
v_mfma_f32_16x16x32_bf16 v[148:151], a[136:139], a[48:51], v[148:151]
buffer_load_dwordx4 v1, s[4:7], s40 offen offset:1024 sc1 lds
v_mfma_f32_16x16x32_bf16 v[148:151], a[140:143], a[52:55], v[148:151]
buffer_load_dwordx4 v1, s[4:7], s40 offen offset:2048 sc1 lds
v_mfma_f32_16x16x32_bf16 v[156:159], a[136:139], a[56:59], v[156:159]
buffer_load_dwordx4 v1, s[4:7], s40 offen offset:3072 sc1 lds
v_mfma_f32_16x16x32_bf16 v[156:159], a[140:143], a[60:63], v[156:159]
s_waitcnt lgkmcnt(2)
v_mfma_f32_16x16x32_bf16 v[164:167], a[128:131], a[0:3], v[164:167]
s_waitcnt lgkmcnt(0)
ds_read_b64_tr_b16 a[136:137], v25 offset:0
v_mfma_f32_16x16x32_bf16 v[164:167], a[132:135], a[4:7], v[164:167]
s_sub_u32 s40, s40, 2
v_mfma_f32_16x16x32_bf16 v[172:175], a[128:131], a[8:11], v[172:175]
s_add_u32 m0, s42, 8384
ds_read_b64_tr_b16 a[138:139], v25 offset:2048
v_mfma_f32_16x16x32_bf16 v[172:175], a[132:135], a[12:15], v[172:175]
buffer_load_dwordx4 v1, s[4:7], s40 offen offset:0 sc1 lds
v_mfma_f32_16x16x32_bf16 v[180:183], a[128:131], a[16:19], v[180:183]
ds_read_b64_tr_b16 a[140:141], v25 offset:16384
v_mfma_f32_16x16x32_bf16 v[180:183], a[132:135], a[20:23], v[180:183]
buffer_load_dwordx4 v1, s[4:7], s40 offen offset:1024 sc1 lds
v_mfma_f32_16x16x32_bf16 v[188:191], a[128:131], a[24:27], v[188:191]
ds_read_b64_tr_b16 a[142:143], v25 offset:18432
v_mfma_f32_16x16x32_bf16 v[188:191], a[132:135], a[28:31], v[188:191]
buffer_load_dwordx4 v1, s[4:7], s40 offen offset:2048 sc1 lds
v_mfma_f32_16x16x32_bf16 v[196:199], a[128:131], a[32:35], v[196:199]
buffer_load_dwordx4 v1, s[4:7], s40 offen offset:3072 sc1 lds
v_mfma_f32_16x16x32_bf16 v[196:199], a[132:135], a[36:39], v[196:199]
s_sub_u32 s40, s40, 2
v_mfma_f32_16x16x32_bf16 v[204:207], a[128:131], a[40:43], v[204:207]
s_add_u32 m0, s42, 12544
v_mfma_f32_16x16x32_bf16 v[204:207], a[132:135], a[44:47], v[204:207]
buffer_load_dwordx4 v1, s[4:7], s40 offen offset:0 sc1 lds
v_mfma_f32_16x16x32_bf16 v[212:215], a[128:131], a[48:51], v[212:215]
buffer_load_dwordx4 v1, s[4:7], s40 offen offset:1024 sc1 lds
v_mfma_f32_16x16x32_bf16 v[212:215], a[132:135], a[52:55], v[212:215]
buffer_load_dwordx4 v1, s[4:7], s40 offen offset:2048 sc1 lds
v_mfma_f32_16x16x32_bf16 v[220:223], a[128:131], a[56:59], v[220:223]
buffer_load_dwordx4 v1, s[4:7], s40 offen offset:3072 sc1 lds
v_mfma_f32_16x16x32_bf16 v[220:223], a[132:135], a[60:63], v[220:223]
s_waitcnt lgkmcnt(2)
v_mfma_f32_16x16x32_bf16 v[228:231], a[136:139], a[0:3], v[228:231]
s_waitcnt lgkmcnt(0)
v_mfma_f32_16x16x32_bf16 v[228:231], a[140:143], a[4:7], v[228:231]
v_mfma_f32_16x16x32_bf16 v[236:239], a[136:139], a[8:11], v[236:239]
v_mfma_f32_16x16x32_bf16 v[236:239], a[140:143], a[12:15], v[236:239]
v_mfma_f32_16x16x32_bf16 v[244:247], a[136:139], a[16:19], v[244:247]
v_mfma_f32_16x16x32_bf16 v[244:247], a[140:143], a[20:23], v[244:247]
v_mfma_f32_16x16x32_bf16 v[252:255], a[136:139], a[24:27], v[252:255]
v_mfma_f32_16x16x32_bf16 v[252:255], a[140:143], a[28:31], v[252:255]
v_mfma_f32_16x16x32_bf16 a[160:163], a[136:139], a[32:35], a[160:163]
v_mfma_f32_16x16x32_bf16 a[160:163], a[140:143], a[36:39], a[160:163]
v_mfma_f32_16x16x32_bf16 a[164:167], a[136:139], a[40:43], a[164:167]
v_mfma_f32_16x16x32_bf16 a[164:167], a[140:143], a[44:47], a[164:167]
v_mfma_f32_16x16x32_bf16 a[168:171], a[136:139], a[48:51], a[168:171]
v_mfma_f32_16x16x32_bf16 a[168:171], a[140:143], a[52:55], a[168:171]
v_mfma_f32_16x16x32_bf16 a[172:175], a[136:139], a[56:59], a[172:175]
v_mfma_f32_16x16x32_bf16 a[172:175], a[140:143], a[60:63], a[172:175]
s_lshr_b32 s22, s2, 4
s_lshl_b32 s23, s20, 5
s_add_u32 s23, s23, s22
s_lshl_b32 s23, s23, 2
s_add_u32 s45, s23, 94371840
s_lshl_b32 s31, s20, 20
s_lshl_b32 s22, s37, 16
s_add_u32 s31, s31, s22
s_lshl_b32 s22, s3, 11
s_add_u32 s31, s31, s22
s_add_u32 s31, s31, 33554432
s_waitcnt vmcnt(20)
s_barrier
buffer_store_dword v27, v26, s[4:7], s45 offen sc1
s_mov_b32 s22, 1035512379
s_mov_b32 s23, 1035512379
v_pk_mul_f32 v[36:37], v[36:37], s[22:23]
v_pk_mul_f32 v[38:39], v[38:39], s[22:23]
v_pk_mul_f32 v[100:101], v[100:101], s[22:23]
v_pk_mul_f32 v[102:103], v[102:103], s[22:23]
v_cvt_pk_bf16_f32 v36, v36, v37
v_cvt_pk_bf16_f32 v37, v38, v39
v_cvt_pk_bf16_f32 v38, v100, v101
v_cvt_pk_bf16_f32 v39, v102, v103
s_add_u32 s30, s31, 0
buffer_store_dwordx4 v[36:39], v1, s[4:7], s30 offen offset:0
v_pk_mul_f32 v[44:45], v[44:45], s[22:23]
v_pk_mul_f32 v[46:47], v[46:47], s[22:23]
v_pk_mul_f32 v[108:109], v[108:109], s[22:23]
v_pk_mul_f32 v[110:111], v[110:111], s[22:23]
v_cvt_pk_bf16_f32 v44, v44, v45
v_cvt_pk_bf16_f32 v45, v46, v47
v_cvt_pk_bf16_f32 v46, v108, v109
v_cvt_pk_bf16_f32 v47, v110, v111
s_add_u32 s30, s31, 8192
buffer_store_dwordx4 v[44:47], v1, s[4:7], s30 offen offset:0
v_pk_mul_f32 v[52:53], v[52:53], s[22:23]
v_pk_mul_f32 v[54:55], v[54:55], s[22:23]
v_pk_mul_f32 v[116:117], v[116:117], s[22:23]
v_pk_mul_f32 v[118:119], v[118:119], s[22:23]
v_cvt_pk_bf16_f32 v52, v52, v53
v_cvt_pk_bf16_f32 v53, v54, v55
v_cvt_pk_bf16_f32 v54, v116, v117
v_cvt_pk_bf16_f32 v55, v118, v119
s_add_u32 s30, s31, 16384
buffer_store_dwordx4 v[52:55], v1, s[4:7], s30 offen offset:0
v_pk_mul_f32 v[60:61], v[60:61], s[22:23]
v_pk_mul_f32 v[62:63], v[62:63], s[22:23]
v_pk_mul_f32 v[124:125], v[124:125], s[22:23]
v_pk_mul_f32 v[126:127], v[126:127], s[22:23]
v_cvt_pk_bf16_f32 v60, v60, v61
v_cvt_pk_bf16_f32 v61, v62, v63
v_cvt_pk_bf16_f32 v62, v124, v125
v_cvt_pk_bf16_f32 v63, v126, v127
s_add_u32 s30, s31, 24576
buffer_store_dwordx4 v[60:63], v1, s[4:7], s30 offen offset:0
v_pk_mul_f32 v[68:69], v[68:69], s[22:23]
v_pk_mul_f32 v[70:71], v[70:71], s[22:23]
v_pk_mul_f32 v[132:133], v[132:133], s[22:23]
v_pk_mul_f32 v[134:135], v[134:135], s[22:23]
v_cvt_pk_bf16_f32 v68, v68, v69
v_cvt_pk_bf16_f32 v69, v70, v71
v_cvt_pk_bf16_f32 v70, v132, v133
v_cvt_pk_bf16_f32 v71, v134, v135
s_add_u32 s30, s31, 32768
buffer_store_dwordx4 v[68:71], v1, s[4:7], s30 offen offset:0
v_pk_mul_f32 v[76:77], v[76:77], s[22:23]
v_pk_mul_f32 v[78:79], v[78:79], s[22:23]
v_pk_mul_f32 v[140:141], v[140:141], s[22:23]
v_pk_mul_f32 v[142:143], v[142:143], s[22:23]
v_cvt_pk_bf16_f32 v76, v76, v77
v_cvt_pk_bf16_f32 v77, v78, v79
v_cvt_pk_bf16_f32 v78, v140, v141
v_cvt_pk_bf16_f32 v79, v142, v143
s_add_u32 s30, s31, 40960
buffer_store_dwordx4 v[76:79], v1, s[4:7], s30 offen offset:0
v_pk_mul_f32 v[84:85], v[84:85], s[22:23]
v_pk_mul_f32 v[86:87], v[86:87], s[22:23]
v_pk_mul_f32 v[148:149], v[148:149], s[22:23]
v_pk_mul_f32 v[150:151], v[150:151], s[22:23]
v_cvt_pk_bf16_f32 v84, v84, v85
v_cvt_pk_bf16_f32 v85, v86, v87
v_cvt_pk_bf16_f32 v86, v148, v149
v_cvt_pk_bf16_f32 v87, v150, v151
s_add_u32 s30, s31, 49152
buffer_store_dwordx4 v[84:87], v1, s[4:7], s30 offen offset:0
v_pk_mul_f32 v[92:93], v[92:93], s[22:23]
v_pk_mul_f32 v[94:95], v[94:95], s[22:23]
v_pk_mul_f32 v[156:157], v[156:157], s[22:23]
v_pk_mul_f32 v[158:159], v[158:159], s[22:23]
v_cvt_pk_bf16_f32 v92, v92, v93
v_cvt_pk_bf16_f32 v93, v94, v95
v_cvt_pk_bf16_f32 v94, v156, v157
v_cvt_pk_bf16_f32 v95, v158, v159
s_add_u32 s30, s31, 57344
buffer_store_dwordx4 v[92:95], v1, s[4:7], s30 offen offset:0
v_pk_mul_f32 v[164:165], v[164:165], s[22:23]
v_pk_mul_f32 v[166:167], v[166:167], s[22:23]
v_pk_mul_f32 v[228:229], v[228:229], s[22:23]
v_pk_mul_f32 v[230:231], v[230:231], s[22:23]
v_cvt_pk_bf16_f32 v164, v164, v165
v_cvt_pk_bf16_f32 v165, v166, v167
v_cvt_pk_bf16_f32 v166, v228, v229
v_cvt_pk_bf16_f32 v167, v230, v231
s_add_u32 s30, s31, 0
buffer_store_dwordx4 v[164:167], v1, s[4:7], s30 offen offset:1024
v_pk_mul_f32 v[172:173], v[172:173], s[22:23]
v_pk_mul_f32 v[174:175], v[174:175], s[22:23]
v_pk_mul_f32 v[236:237], v[236:237], s[22:23]
v_pk_mul_f32 v[238:239], v[238:239], s[22:23]
v_cvt_pk_bf16_f32 v172, v172, v173
v_cvt_pk_bf16_f32 v173, v174, v175
v_cvt_pk_bf16_f32 v174, v236, v237
v_cvt_pk_bf16_f32 v175, v238, v239
s_add_u32 s30, s31, 8192
buffer_store_dwordx4 v[172:175], v1, s[4:7], s30 offen offset:1024
v_pk_mul_f32 v[180:181], v[180:181], s[22:23]
v_pk_mul_f32 v[182:183], v[182:183], s[22:23]
v_pk_mul_f32 v[244:245], v[244:245], s[22:23]
v_pk_mul_f32 v[246:247], v[246:247], s[22:23]
v_cvt_pk_bf16_f32 v180, v180, v181
v_cvt_pk_bf16_f32 v181, v182, v183
v_cvt_pk_bf16_f32 v182, v244, v245
v_cvt_pk_bf16_f32 v183, v246, v247
s_add_u32 s30, s31, 16384
buffer_store_dwordx4 v[180:183], v1, s[4:7], s30 offen offset:1024
v_pk_mul_f32 v[188:189], v[188:189], s[22:23]
v_pk_mul_f32 v[190:191], v[190:191], s[22:23]
v_pk_mul_f32 v[252:253], v[252:253], s[22:23]
v_pk_mul_f32 v[254:255], v[254:255], s[22:23]
v_cvt_pk_bf16_f32 v188, v188, v189
v_cvt_pk_bf16_f32 v189, v190, v191
v_cvt_pk_bf16_f32 v190, v252, v253
v_cvt_pk_bf16_f32 v191, v254, v255
s_add_u32 s30, s31, 24576
buffer_store_dwordx4 v[188:191], v1, s[4:7], s30 offen offset:1024
v_accvgpr_read_b32 v128, a160
v_accvgpr_read_b32 v129, a161
v_accvgpr_read_b32 v130, a162
v_accvgpr_read_b32 v131, a163
v_pk_mul_f32 v[196:197], v[196:197], s[22:23]
v_pk_mul_f32 v[198:199], v[198:199], s[22:23]
v_pk_mul_f32 v[128:129], v[128:129], s[22:23]
v_pk_mul_f32 v[130:131], v[130:131], s[22:23]
v_cvt_pk_bf16_f32 v196, v196, v197
v_cvt_pk_bf16_f32 v197, v198, v199
v_cvt_pk_bf16_f32 v198, v128, v129
v_cvt_pk_bf16_f32 v199, v130, v131
s_add_u32 s30, s31, 32768
buffer_store_dwordx4 v[196:199], v1, s[4:7], s30 offen offset:1024
v_accvgpr_read_b32 v136, a164
v_accvgpr_read_b32 v137, a165
v_accvgpr_read_b32 v138, a166
v_accvgpr_read_b32 v139, a167
v_pk_mul_f32 v[204:205], v[204:205], s[22:23]
v_pk_mul_f32 v[206:207], v[206:207], s[22:23]
v_pk_mul_f32 v[136:137], v[136:137], s[22:23]
v_pk_mul_f32 v[138:139], v[138:139], s[22:23]
v_cvt_pk_bf16_f32 v204, v204, v205
v_cvt_pk_bf16_f32 v205, v206, v207
v_cvt_pk_bf16_f32 v206, v136, v137
v_cvt_pk_bf16_f32 v207, v138, v139
s_add_u32 s30, s31, 40960
buffer_store_dwordx4 v[204:207], v1, s[4:7], s30 offen offset:1024
v_accvgpr_read_b32 v144, a168
v_accvgpr_read_b32 v145, a169
v_accvgpr_read_b32 v146, a170
v_accvgpr_read_b32 v147, a171
v_pk_mul_f32 v[212:213], v[212:213], s[22:23]
v_pk_mul_f32 v[214:215], v[214:215], s[22:23]
v_pk_mul_f32 v[144:145], v[144:145], s[22:23]
v_pk_mul_f32 v[146:147], v[146:147], s[22:23]
v_cvt_pk_bf16_f32 v212, v212, v213
v_cvt_pk_bf16_f32 v213, v214, v215
v_cvt_pk_bf16_f32 v214, v144, v145
v_cvt_pk_bf16_f32 v215, v146, v147
s_add_u32 s30, s31, 49152
buffer_store_dwordx4 v[212:215], v1, s[4:7], s30 offen offset:1024
v_accvgpr_read_b32 v152, a172
v_accvgpr_read_b32 v153, a173
v_accvgpr_read_b32 v154, a174
v_accvgpr_read_b32 v155, a175
v_pk_mul_f32 v[220:221], v[220:221], s[22:23]
v_pk_mul_f32 v[222:223], v[222:223], s[22:23]
v_pk_mul_f32 v[152:153], v[152:153], s[22:23]
v_pk_mul_f32 v[154:155], v[154:155], s[22:23]
v_cvt_pk_bf16_f32 v220, v220, v221
v_cvt_pk_bf16_f32 v221, v222, v223
v_cvt_pk_bf16_f32 v222, v152, v153
v_cvt_pk_bf16_f32 v223, v154, v155
s_add_u32 s30, s31, 57344
buffer_store_dwordx4 v[220:223], v1, s[4:7], s30 offen offset:1024
s_lshr_b32 s46, s43, 1
s_lshl_b32 s46, s46, 2
s_add_u32 s46, s74, s46
s_addc_u32 s47, s75, 0
s_load_dword s44, s[46:47], 0
v_lshrrev_b32 v9, 4, v1
v_and_b32 v10, 15, v9
v_lshrrev_b32 v11, 4, v9
v_lshrrev_b32 v12, 2, v10
v_mul_u32_u24 v12, 4160, v12
v_and_b32 v13, 3, v9
v_lshl_add_u32 v12, v13, 3, v12
v_lshlrev_b32 v13, 4, v11
v_sub_u32 v12, v12, v13
s_add_u32 s22, s42, 88
v_add_u32 v2, s22, v12
v_lshl_add_u32 v12, v10, 5, v13
s_add_u32 s22, s42, 16672
v_add_u32 v3, s22, v12
v_lshlrev_b32 v12, 5, v10
v_lshl_add_u32 v8, v11, 3, v12
s_add_u32 s22, s42, 64
v_add_u32 v4, s22, v8
v_mov_b32 v12, 0
v_mov_b32 v13, 0
v_lshl_add_u32 v14, v9, 3, s42
ds_write_b64 v14, v[12:13] offset:16640
v_mul_u32_u24 v14, 4160, v11
v_lshl_add_u32 v14, v10, 2, v14
v_add_u32 v14, s42, v14
ds_write_b32 v14, v12
s_waitcnt vmcnt(17) lgkmcnt(0)
s_lshl_b32 s22, s44, 16
s_and_b32 s44, s44, 0xffff0000
s_bitcmp1_b32 s43, 0
s_cselect_b32 s44, s44, s22
s_lshl_b32 s41, s43, 12
s_add_u32 s41, s41, 88080384
ds_read_b64_tr_b16 a[0:1], v2 offset:8
ds_read_b64_tr_b16 a[2:3], v2 offset:0
ds_read_b128 a[32:35], v3 offset:448
ds_read_b64_tr_b16 a[4:5], v2 offset:520
ds_read_b64_tr_b16 a[6:7], v2 offset:512
ds_read_b128 a[36:39], v3 offset:960
ds_read_b64_tr_b16 a[8:9], v2 offset:1032
ds_read_b64_tr_b16 a[10:11], v2 offset:1024
ds_read_b128 a[40:43], v3 offset:1472
ds_read_b64_tr_b16 a[12:13], v2 offset:1544
ds_read_b64_tr_b16 a[14:15], v2 offset:1536
ds_read_b128 a[44:47], v3 offset:1984
ds_read_b64_tr_b16 a[16:17], v2 offset:2056
ds_read_b64_tr_b16 a[18:19], v2 offset:2048
ds_read_b128 a[48:51], v3 offset:2496
ds_read_b64_tr_b16 a[20:21], v2 offset:2568
ds_read_b64_tr_b16 a[22:23], v2 offset:2560
ds_read_b128 a[52:55], v3 offset:3008
ds_read_b64_tr_b16 a[24:25], v2 offset:3080
ds_read_b64_tr_b16 a[26:27], v2 offset:3072
ds_read_b128 a[56:59], v3 offset:3520
ds_read_b64_tr_b16 a[28:29], v2 offset:3592
ds_read_b64_tr_b16 a[30:31], v2 offset:3584
ds_read_b128 a[60:63], v3 offset:4032
s_waitcnt lgkmcnt(15)
v_mfma_f32_16x16x32_bf16 v[32:35], a[0:3], a[32:35], 0
s_waitcnt lgkmcnt(15)
ds_read_b64_tr_b16 a[64:65], v2 offset:72
v_mfma_f32_16x16x32_bf16 v[36:39], a[0:3], a[36:39], 0
ds_read_b64_tr_b16 a[66:67], v2 offset:64
v_mfma_f32_16x16x32_bf16 v[36:39], a[4:7], a[32:35], v[36:39]
ds_read_b128 a[96:99], v3 offset:384
v_mfma_f32_16x16x32_bf16 v[40:43], a[0:3], a[40:43], 0
ds_read_b64_tr_b16 a[68:69], v2 offset:584
v_mfma_f32_16x16x32_bf16 v[40:43], a[4:7], a[36:39], v[40:43]
ds_read_b64_tr_b16 a[70:71], v2 offset:576
v_mfma_f32_16x16x32_bf16 v[40:43], a[8:11], a[32:35], v[40:43]
s_waitcnt lgkmcnt(15)
ds_read_b128 a[100:103], v3 offset:896
v_mfma_f32_16x16x32_bf16 v[44:47], a[0:3], a[44:47], 0
ds_read_b64_tr_b16 a[72:73], v2 offset:1096
v_mfma_f32_16x16x32_bf16 v[44:47], a[4:7], a[40:43], v[44:47]
ds_read_b64_tr_b16 a[74:75], v2 offset:1088
v_mfma_f32_16x16x32_bf16 v[44:47], a[8:11], a[36:39], v[44:47]
ds_read_b128 a[104:107], v3 offset:1408
v_mfma_f32_16x16x32_bf16 v[44:47], a[12:15], a[32:35], v[44:47]
s_waitcnt lgkmcnt(15)
ds_read_b64_tr_b16 a[76:77], v2 offset:1608
v_mfma_f32_16x16x32_bf16 v[48:51], a[0:3], a[48:51], 0
ds_read_b64_tr_b16 a[78:79], v2 offset:1600
v_mfma_f32_16x16x32_bf16 v[48:51], a[4:7], a[44:47], v[48:51]
ds_read_b128 a[108:111], v3 offset:1920
v_mfma_f32_16x16x32_bf16 v[48:51], a[8:11], a[40:43], v[48:51]
ds_read_b64_tr_b16 a[80:81], v2 offset:2120
v_mfma_f32_16x16x32_bf16 v[48:51], a[12:15], a[36:39], v[48:51]
ds_read_b64_tr_b16 a[82:83], v2 offset:2112
v_mfma_f32_16x16x32_bf16 v[48:51], a[16:19], a[32:35], v[48:51]
ds_read_b128 a[112:115], v3 offset:2432
v_mfma_f32_16x16x32_bf16 v[52:55], a[0:3], a[52:55], 0
ds_read_b64_tr_b16 a[84:85], v2 offset:2632
v_mfma_f32_16x16x32_bf16 v[52:55], a[4:7], a[48:51], v[52:55]
ds_read_b64_tr_b16 a[86:87], v2 offset:2624
v_mfma_f32_16x16x32_bf16 v[52:55], a[8:11], a[44:47], v[52:55]
ds_read_b128 a[116:119], v3 offset:2944
v_mfma_f32_16x16x32_bf16 v[52:55], a[12:15], a[40:43], v[52:55]
ds_read_b64_tr_b16 a[88:89], v2 offset:3144
v_mfma_f32_16x16x32_bf16 v[52:55], a[16:19], a[36:39], v[52:55]
ds_read_b64_tr_b16 a[90:91], v2 offset:3136
v_mfma_f32_16x16x32_bf16 v[52:55], a[20:23], a[32:35], v[52:55]
s_waitcnt lgkmcnt(15)
ds_read_b128 a[120:123], v3 offset:3456
v_mfma_f32_16x16x32_bf16 v[56:59], a[0:3], a[56:59], 0
ds_read_b64_tr_b16 a[92:93], v2 offset:3656
v_mfma_f32_16x16x32_bf16 v[56:59], a[4:7], a[52:55], v[56:59]
ds_read_b64_tr_b16 a[94:95], v2 offset:3648
v_mfma_f32_16x16x32_bf16 v[56:59], a[8:11], a[48:51], v[56:59]
ds_read_b128 a[124:127], v3 offset:3968
v_mfma_f32_16x16x32_bf16 v[56:59], a[12:15], a[44:47], v[56:59]
v_mfma_f32_16x16x32_bf16 v[56:59], a[16:19], a[40:43], v[56:59]
v_mfma_f32_16x16x32_bf16 v[56:59], a[20:23], a[36:39], v[56:59]
v_mfma_f32_16x16x32_bf16 v[56:59], a[24:27], a[32:35], v[56:59]
v_mfma_f32_16x16x32_bf16 v[60:63], a[0:3], a[60:63], 0
v_mfma_f32_16x16x32_bf16 v[60:63], a[4:7], a[56:59], v[60:63]
v_mfma_f32_16x16x32_bf16 v[60:63], a[8:11], a[52:55], v[60:63]
v_mfma_f32_16x16x32_bf16 v[60:63], a[12:15], a[48:51], v[60:63]
v_mfma_f32_16x16x32_bf16 v[60:63], a[16:19], a[44:47], v[60:63]
v_mfma_f32_16x16x32_bf16 v[60:63], a[20:23], a[40:43], v[60:63]
v_mfma_f32_16x16x32_bf16 v[60:63], a[24:27], a[36:39], v[60:63]
v_mfma_f32_16x16x32_bf16 v[60:63], a[28:31], a[32:35], v[60:63]
v_mfma_f32_16x16x32_bf16 v[32:35], a[64:67], a[96:99], v[32:35]
s_waitcnt lgkmcnt(15)
ds_read_b64_tr_b16 a[0:1], v2 offset:136
v_mfma_f32_16x16x32_bf16 v[36:39], a[64:67], a[100:103], v[36:39]
ds_read_b64_tr_b16 a[2:3], v2 offset:128
v_mfma_f32_16x16x32_bf16 v[36:39], a[68:71], a[96:99], v[36:39]
ds_read_b128 a[32:35], v3 offset:320
v_mfma_f32_16x16x32_bf16 v[40:43], a[64:67], a[104:107], v[40:43]
ds_read_b64_tr_b16 a[4:5], v2 offset:648
v_mfma_f32_16x16x32_bf16 v[40:43], a[68:71], a[100:103], v[40:43]
ds_read_b64_tr_b16 a[6:7], v2 offset:640
v_mfma_f32_16x16x32_bf16 v[40:43], a[72:75], a[96:99], v[40:43]
s_waitcnt lgkmcnt(15)
ds_read_b128 a[36:39], v3 offset:832
v_mfma_f32_16x16x32_bf16 v[44:47], a[64:67], a[108:111], v[44:47]
ds_read_b64_tr_b16 a[8:9], v2 offset:1160
v_mfma_f32_16x16x32_bf16 v[44:47], a[68:71], a[104:107], v[44:47]
ds_read_b64_tr_b16 a[10:11], v2 offset:1152
v_mfma_f32_16x16x32_bf16 v[44:47], a[72:75], a[100:103], v[44:47]
ds_read_b128 a[40:43], v3 offset:1344
v_mfma_f32_16x16x32_bf16 v[44:47], a[76:79], a[96:99], v[44:47]
s_waitcnt lgkmcnt(15)
ds_read_b64_tr_b16 a[12:13], v2 offset:1672
v_mfma_f32_16x16x32_bf16 v[48:51], a[64:67], a[112:115], v[48:51]
ds_read_b64_tr_b16 a[14:15], v2 offset:1664
v_mfma_f32_16x16x32_bf16 v[48:51], a[68:71], a[108:111], v[48:51]
ds_read_b128 a[44:47], v3 offset:1856
v_mfma_f32_16x16x32_bf16 v[48:51], a[72:75], a[104:107], v[48:51]
ds_read_b64_tr_b16 a[16:17], v2 offset:2184
v_mfma_f32_16x16x32_bf16 v[48:51], a[76:79], a[100:103], v[48:51]
ds_read_b64_tr_b16 a[18:19], v2 offset:2176
v_mfma_f32_16x16x32_bf16 v[48:51], a[80:83], a[96:99], v[48:51]
ds_read_b128 a[48:51], v3 offset:2368
v_mfma_f32_16x16x32_bf16 v[52:55], a[64:67], a[116:119], v[52:55]
ds_read_b64_tr_b16 a[20:21], v2 offset:2696
v_mfma_f32_16x16x32_bf16 v[52:55], a[68:71], a[112:115], v[52:55]
ds_read_b64_tr_b16 a[22:23], v2 offset:2688
v_mfma_f32_16x16x32_bf16 v[52:55], a[72:75], a[108:111], v[52:55]
ds_read_b128 a[52:55], v3 offset:2880
v_mfma_f32_16x16x32_bf16 v[52:55], a[76:79], a[104:107], v[52:55]
ds_read_b64_tr_b16 a[24:25], v2 offset:3208
v_mfma_f32_16x16x32_bf16 v[52:55], a[80:83], a[100:103], v[52:55]
ds_read_b64_tr_b16 a[26:27], v2 offset:3200
v_mfma_f32_16x16x32_bf16 v[52:55], a[84:87], a[96:99], v[52:55]
s_waitcnt lgkmcnt(15)
ds_read_b128 a[56:59], v3 offset:3392
v_mfma_f32_16x16x32_bf16 v[56:59], a[64:67], a[120:123], v[56:59]
ds_read_b64_tr_b16 a[28:29], v2 offset:3720
v_mfma_f32_16x16x32_bf16 v[56:59], a[68:71], a[116:119], v[56:59]
ds_read_b64_tr_b16 a[30:31], v2 offset:3712
v_mfma_f32_16x16x32_bf16 v[56:59], a[72:75], a[112:115], v[56:59]
ds_read_b128 a[60:63], v3 offset:3904
v_mfma_f32_16x16x32_bf16 v[56:59], a[76:79], a[108:111], v[56:59]
v_mfma_f32_16x16x32_bf16 v[56:59], a[80:83], a[104:107], v[56:59]
v_mfma_f32_16x16x32_bf16 v[56:59], a[84:87], a[100:103], v[56:59]
v_mfma_f32_16x16x32_bf16 v[56:59], a[88:91], a[96:99], v[56:59]
v_mfma_f32_16x16x32_bf16 v[60:63], a[64:67], a[124:127], v[60:63]
v_mfma_f32_16x16x32_bf16 v[60:63], a[68:71], a[120:123], v[60:63]
v_mfma_f32_16x16x32_bf16 v[60:63], a[72:75], a[116:119], v[60:63]
v_mfma_f32_16x16x32_bf16 v[60:63], a[76:79], a[112:115], v[60:63]
v_mfma_f32_16x16x32_bf16 v[60:63], a[80:83], a[108:111], v[60:63]
v_mfma_f32_16x16x32_bf16 v[60:63], a[84:87], a[104:107], v[60:63]
v_mfma_f32_16x16x32_bf16 v[60:63], a[88:91], a[100:103], v[60:63]
v_mfma_f32_16x16x32_bf16 v[60:63], a[92:95], a[96:99], v[60:63]
v_mfma_f32_16x16x32_bf16 v[32:35], a[0:3], a[32:35], v[32:35]
s_waitcnt lgkmcnt(15)
ds_read_b64_tr_b16 a[64:65], v2 offset:200
v_mfma_f32_16x16x32_bf16 v[36:39], a[0:3], a[36:39], v[36:39]
ds_read_b64_tr_b16 a[66:67], v2 offset:192
v_mfma_f32_16x16x32_bf16 v[36:39], a[4:7], a[32:35], v[36:39]
ds_read_b128 a[96:99], v3 offset:256
v_mfma_f32_16x16x32_bf16 v[40:43], a[0:3], a[40:43], v[40:43]
ds_read_b64_tr_b16 a[68:69], v2 offset:712
v_mfma_f32_16x16x32_bf16 v[40:43], a[4:7], a[36:39], v[40:43]
ds_read_b64_tr_b16 a[70:71], v2 offset:704
v_mfma_f32_16x16x32_bf16 v[40:43], a[8:11], a[32:35], v[40:43]
s_waitcnt lgkmcnt(15)
ds_read_b128 a[100:103], v3 offset:768
v_mfma_f32_16x16x32_bf16 v[44:47], a[0:3], a[44:47], v[44:47]
ds_read_b64_tr_b16 a[72:73], v2 offset:1224
v_mfma_f32_16x16x32_bf16 v[44:47], a[4:7], a[40:43], v[44:47]
ds_read_b64_tr_b16 a[74:75], v2 offset:1216
v_mfma_f32_16x16x32_bf16 v[44:47], a[8:11], a[36:39], v[44:47]
ds_read_b128 a[104:107], v3 offset:1280
v_mfma_f32_16x16x32_bf16 v[44:47], a[12:15], a[32:35], v[44:47]
s_waitcnt lgkmcnt(15)
ds_read_b64_tr_b16 a[76:77], v2 offset:1736
v_mfma_f32_16x16x32_bf16 v[48:51], a[0:3], a[48:51], v[48:51]
ds_read_b64_tr_b16 a[78:79], v2 offset:1728
v_mfma_f32_16x16x32_bf16 v[48:51], a[4:7], a[44:47], v[48:51]
ds_read_b128 a[108:111], v3 offset:1792
v_mfma_f32_16x16x32_bf16 v[48:51], a[8:11], a[40:43], v[48:51]
ds_read_b64_tr_b16 a[80:81], v2 offset:2248
v_mfma_f32_16x16x32_bf16 v[48:51], a[12:15], a[36:39], v[48:51]
ds_read_b64_tr_b16 a[82:83], v2 offset:2240
v_mfma_f32_16x16x32_bf16 v[48:51], a[16:19], a[32:35], v[48:51]
ds_read_b128 a[112:115], v3 offset:2304
v_mfma_f32_16x16x32_bf16 v[52:55], a[0:3], a[52:55], v[52:55]
ds_read_b64_tr_b16 a[84:85], v2 offset:2760
v_mfma_f32_16x16x32_bf16 v[52:55], a[4:7], a[48:51], v[52:55]
ds_read_b64_tr_b16 a[86:87], v2 offset:2752
v_mfma_f32_16x16x32_bf16 v[52:55], a[8:11], a[44:47], v[52:55]
ds_read_b128 a[116:119], v3 offset:2816
v_mfma_f32_16x16x32_bf16 v[52:55], a[12:15], a[40:43], v[52:55]
ds_read_b64_tr_b16 a[88:89], v2 offset:3272
v_mfma_f32_16x16x32_bf16 v[52:55], a[16:19], a[36:39], v[52:55]
ds_read_b64_tr_b16 a[90:91], v2 offset:3264
v_mfma_f32_16x16x32_bf16 v[52:55], a[20:23], a[32:35], v[52:55]
s_waitcnt lgkmcnt(15)
ds_read_b128 a[120:123], v3 offset:3328
v_mfma_f32_16x16x32_bf16 v[56:59], a[0:3], a[56:59], v[56:59]
ds_read_b64_tr_b16 a[92:93], v2 offset:3784
v_mfma_f32_16x16x32_bf16 v[56:59], a[4:7], a[52:55], v[56:59]
ds_read_b64_tr_b16 a[94:95], v2 offset:3776
v_mfma_f32_16x16x32_bf16 v[56:59], a[8:11], a[48:51], v[56:59]
ds_read_b128 a[124:127], v3 offset:3840
v_mfma_f32_16x16x32_bf16 v[56:59], a[12:15], a[44:47], v[56:59]
v_mfma_f32_16x16x32_bf16 v[56:59], a[16:19], a[40:43], v[56:59]
v_mfma_f32_16x16x32_bf16 v[56:59], a[20:23], a[36:39], v[56:59]
v_mfma_f32_16x16x32_bf16 v[56:59], a[24:27], a[32:35], v[56:59]
v_mfma_f32_16x16x32_bf16 v[60:63], a[0:3], a[60:63], v[60:63]
v_mfma_f32_16x16x32_bf16 v[60:63], a[4:7], a[56:59], v[60:63]
v_mfma_f32_16x16x32_bf16 v[60:63], a[8:11], a[52:55], v[60:63]
v_mfma_f32_16x16x32_bf16 v[60:63], a[12:15], a[48:51], v[60:63]
v_mfma_f32_16x16x32_bf16 v[60:63], a[16:19], a[44:47], v[60:63]
v_mfma_f32_16x16x32_bf16 v[60:63], a[20:23], a[40:43], v[60:63]
v_mfma_f32_16x16x32_bf16 v[60:63], a[24:27], a[36:39], v[60:63]
v_mfma_f32_16x16x32_bf16 v[60:63], a[28:31], a[32:35], v[60:63]
v_mfma_f32_16x16x32_bf16 v[32:35], a[64:67], a[96:99], v[32:35]
s_waitcnt lgkmcnt(15)
ds_read_b64_tr_b16 a[0:1], v2 offset:264
v_mfma_f32_16x16x32_bf16 v[36:39], a[64:67], a[100:103], v[36:39]
ds_read_b64_tr_b16 a[2:3], v2 offset:256
v_mfma_f32_16x16x32_bf16 v[36:39], a[68:71], a[96:99], v[36:39]
ds_read_b128 a[32:35], v3 offset:192
v_mfma_f32_16x16x32_bf16 v[40:43], a[64:67], a[104:107], v[40:43]
ds_read_b64_tr_b16 a[4:5], v2 offset:776
v_mfma_f32_16x16x32_bf16 v[40:43], a[68:71], a[100:103], v[40:43]
ds_read_b64_tr_b16 a[6:7], v2 offset:768
v_mfma_f32_16x16x32_bf16 v[40:43], a[72:75], a[96:99], v[40:43]
s_waitcnt lgkmcnt(15)
ds_read_b128 a[36:39], v3 offset:704
v_mfma_f32_16x16x32_bf16 v[44:47], a[64:67], a[108:111], v[44:47]
ds_read_b64_tr_b16 a[8:9], v2 offset:1288
v_mfma_f32_16x16x32_bf16 v[44:47], a[68:71], a[104:107], v[44:47]
ds_read_b64_tr_b16 a[10:11], v2 offset:1280
v_mfma_f32_16x16x32_bf16 v[44:47], a[72:75], a[100:103], v[44:47]
ds_read_b128 a[40:43], v3 offset:1216
v_mfma_f32_16x16x32_bf16 v[44:47], a[76:79], a[96:99], v[44:47]
s_waitcnt lgkmcnt(15)
ds_read_b64_tr_b16 a[12:13], v2 offset:1800
v_mfma_f32_16x16x32_bf16 v[48:51], a[64:67], a[112:115], v[48:51]
ds_read_b64_tr_b16 a[14:15], v2 offset:1792
v_mfma_f32_16x16x32_bf16 v[48:51], a[68:71], a[108:111], v[48:51]
ds_read_b128 a[44:47], v3 offset:1728
v_mfma_f32_16x16x32_bf16 v[48:51], a[72:75], a[104:107], v[48:51]
ds_read_b64_tr_b16 a[16:17], v2 offset:2312
v_mfma_f32_16x16x32_bf16 v[48:51], a[76:79], a[100:103], v[48:51]
ds_read_b64_tr_b16 a[18:19], v2 offset:2304
v_mfma_f32_16x16x32_bf16 v[48:51], a[80:83], a[96:99], v[48:51]
ds_read_b128 a[48:51], v3 offset:2240
v_mfma_f32_16x16x32_bf16 v[52:55], a[64:67], a[116:119], v[52:55]
ds_read_b64_tr_b16 a[20:21], v2 offset:2824
v_mfma_f32_16x16x32_bf16 v[52:55], a[68:71], a[112:115], v[52:55]
ds_read_b64_tr_b16 a[22:23], v2 offset:2816
v_mfma_f32_16x16x32_bf16 v[52:55], a[72:75], a[108:111], v[52:55]
ds_read_b128 a[52:55], v3 offset:2752
v_mfma_f32_16x16x32_bf16 v[52:55], a[76:79], a[104:107], v[52:55]
ds_read_b64_tr_b16 a[24:25], v2 offset:3336
v_mfma_f32_16x16x32_bf16 v[52:55], a[80:83], a[100:103], v[52:55]
ds_read_b64_tr_b16 a[26:27], v2 offset:3328
v_mfma_f32_16x16x32_bf16 v[52:55], a[84:87], a[96:99], v[52:55]
s_waitcnt lgkmcnt(15)
ds_read_b128 a[56:59], v3 offset:3264
v_mfma_f32_16x16x32_bf16 v[56:59], a[64:67], a[120:123], v[56:59]
ds_read_b64_tr_b16 a[28:29], v2 offset:3848
v_mfma_f32_16x16x32_bf16 v[56:59], a[68:71], a[116:119], v[56:59]
ds_read_b64_tr_b16 a[30:31], v2 offset:3840
v_mfma_f32_16x16x32_bf16 v[56:59], a[72:75], a[112:115], v[56:59]
ds_read_b128 a[60:63], v3 offset:3776
v_mfma_f32_16x16x32_bf16 v[56:59], a[76:79], a[108:111], v[56:59]
v_mfma_f32_16x16x32_bf16 v[56:59], a[80:83], a[104:107], v[56:59]
v_mfma_f32_16x16x32_bf16 v[56:59], a[84:87], a[100:103], v[56:59]
v_mfma_f32_16x16x32_bf16 v[56:59], a[88:91], a[96:99], v[56:59]
v_mfma_f32_16x16x32_bf16 v[60:63], a[64:67], a[124:127], v[60:63]
v_mfma_f32_16x16x32_bf16 v[60:63], a[68:71], a[120:123], v[60:63]
v_mfma_f32_16x16x32_bf16 v[60:63], a[72:75], a[116:119], v[60:63]
v_mfma_f32_16x16x32_bf16 v[60:63], a[76:79], a[112:115], v[60:63]
v_mfma_f32_16x16x32_bf16 v[60:63], a[80:83], a[108:111], v[60:63]
v_mfma_f32_16x16x32_bf16 v[60:63], a[84:87], a[104:107], v[60:63]
v_mfma_f32_16x16x32_bf16 v[60:63], a[88:91], a[100:103], v[60:63]
v_mfma_f32_16x16x32_bf16 v[60:63], a[92:95], a[96:99], v[60:63]
v_mfma_f32_16x16x32_bf16 v[32:35], a[0:3], a[32:35], v[32:35]
s_waitcnt lgkmcnt(15)
ds_read_b64_tr_b16 a[64:65], v2 offset:328
v_mfma_f32_16x16x32_bf16 v[36:39], a[0:3], a[36:39], v[36:39]
ds_read_b64_tr_b16 a[66:67], v2 offset:320
v_mfma_f32_16x16x32_bf16 v[36:39], a[4:7], a[32:35], v[36:39]
ds_read_b128 a[96:99], v3 offset:128
v_mfma_f32_16x16x32_bf16 v[40:43], a[0:3], a[40:43], v[40:43]
ds_read_b64_tr_b16 a[68:69], v2 offset:840
v_mfma_f32_16x16x32_bf16 v[40:43], a[4:7], a[36:39], v[40:43]
ds_read_b64_tr_b16 a[70:71], v2 offset:832
v_mfma_f32_16x16x32_bf16 v[40:43], a[8:11], a[32:35], v[40:43]
s_waitcnt lgkmcnt(15)
ds_read_b128 a[100:103], v3 offset:640
v_mfma_f32_16x16x32_bf16 v[44:47], a[0:3], a[44:47], v[44:47]
ds_read_b64_tr_b16 a[72:73], v2 offset:1352
v_mfma_f32_16x16x32_bf16 v[44:47], a[4:7], a[40:43], v[44:47]
ds_read_b64_tr_b16 a[74:75], v2 offset:1344
v_mfma_f32_16x16x32_bf16 v[44:47], a[8:11], a[36:39], v[44:47]
ds_read_b128 a[104:107], v3 offset:1152
v_mfma_f32_16x16x32_bf16 v[44:47], a[12:15], a[32:35], v[44:47]
s_waitcnt lgkmcnt(15)
ds_read_b64_tr_b16 a[76:77], v2 offset:1864
v_mfma_f32_16x16x32_bf16 v[48:51], a[0:3], a[48:51], v[48:51]
ds_read_b64_tr_b16 a[78:79], v2 offset:1856
v_mfma_f32_16x16x32_bf16 v[48:51], a[4:7], a[44:47], v[48:51]
ds_read_b128 a[108:111], v3 offset:1664
v_mfma_f32_16x16x32_bf16 v[48:51], a[8:11], a[40:43], v[48:51]
ds_read_b64_tr_b16 a[80:81], v2 offset:2376
v_mfma_f32_16x16x32_bf16 v[48:51], a[12:15], a[36:39], v[48:51]
ds_read_b64_tr_b16 a[82:83], v2 offset:2368
v_mfma_f32_16x16x32_bf16 v[48:51], a[16:19], a[32:35], v[48:51]
ds_read_b128 a[112:115], v3 offset:2176
v_mfma_f32_16x16x32_bf16 v[52:55], a[0:3], a[52:55], v[52:55]
ds_read_b64_tr_b16 a[84:85], v2 offset:2888
v_mfma_f32_16x16x32_bf16 v[52:55], a[4:7], a[48:51], v[52:55]
ds_read_b64_tr_b16 a[86:87], v2 offset:2880
v_mfma_f32_16x16x32_bf16 v[52:55], a[8:11], a[44:47], v[52:55]
ds_read_b128 a[116:119], v3 offset:2688
v_mfma_f32_16x16x32_bf16 v[52:55], a[12:15], a[40:43], v[52:55]
ds_read_b64_tr_b16 a[88:89], v2 offset:3400
v_mfma_f32_16x16x32_bf16 v[52:55], a[16:19], a[36:39], v[52:55]
ds_read_b64_tr_b16 a[90:91], v2 offset:3392
v_mfma_f32_16x16x32_bf16 v[52:55], a[20:23], a[32:35], v[52:55]
s_waitcnt lgkmcnt(15)
ds_read_b128 a[120:123], v3 offset:3200
v_mfma_f32_16x16x32_bf16 v[56:59], a[0:3], a[56:59], v[56:59]
ds_read_b64_tr_b16 a[92:93], v2 offset:3912
v_mfma_f32_16x16x32_bf16 v[56:59], a[4:7], a[52:55], v[56:59]
ds_read_b64_tr_b16 a[94:95], v2 offset:3904
v_mfma_f32_16x16x32_bf16 v[56:59], a[8:11], a[48:51], v[56:59]
ds_read_b128 a[124:127], v3 offset:3712
v_mfma_f32_16x16x32_bf16 v[56:59], a[12:15], a[44:47], v[56:59]
v_mfma_f32_16x16x32_bf16 v[56:59], a[16:19], a[40:43], v[56:59]
v_mfma_f32_16x16x32_bf16 v[56:59], a[20:23], a[36:39], v[56:59]
v_mfma_f32_16x16x32_bf16 v[56:59], a[24:27], a[32:35], v[56:59]
v_mfma_f32_16x16x32_bf16 v[60:63], a[0:3], a[60:63], v[60:63]
v_mfma_f32_16x16x32_bf16 v[60:63], a[4:7], a[56:59], v[60:63]
v_mfma_f32_16x16x32_bf16 v[60:63], a[8:11], a[52:55], v[60:63]
v_mfma_f32_16x16x32_bf16 v[60:63], a[12:15], a[48:51], v[60:63]
v_mfma_f32_16x16x32_bf16 v[60:63], a[16:19], a[44:47], v[60:63]
v_mfma_f32_16x16x32_bf16 v[60:63], a[20:23], a[40:43], v[60:63]
v_mfma_f32_16x16x32_bf16 v[60:63], a[24:27], a[36:39], v[60:63]
v_mfma_f32_16x16x32_bf16 v[60:63], a[28:31], a[32:35], v[60:63]
v_mfma_f32_16x16x32_bf16 v[32:35], a[64:67], a[96:99], v[32:35]
s_waitcnt lgkmcnt(15)
ds_read_b64_tr_b16 a[0:1], v2 offset:392
v_mfma_f32_16x16x32_bf16 v[36:39], a[64:67], a[100:103], v[36:39]
ds_read_b64_tr_b16 a[2:3], v2 offset:384
v_mfma_f32_16x16x32_bf16 v[36:39], a[68:71], a[96:99], v[36:39]
ds_read_b128 a[32:35], v3 offset:64
v_mfma_f32_16x16x32_bf16 v[40:43], a[64:67], a[104:107], v[40:43]
ds_read_b64_tr_b16 a[4:5], v2 offset:904
v_mfma_f32_16x16x32_bf16 v[40:43], a[68:71], a[100:103], v[40:43]
ds_read_b64_tr_b16 a[6:7], v2 offset:896
v_mfma_f32_16x16x32_bf16 v[40:43], a[72:75], a[96:99], v[40:43]
s_waitcnt lgkmcnt(15)
ds_read_b128 a[36:39], v3 offset:576
v_mfma_f32_16x16x32_bf16 v[44:47], a[64:67], a[108:111], v[44:47]
ds_read_b64_tr_b16 a[8:9], v2 offset:1416
v_mfma_f32_16x16x32_bf16 v[44:47], a[68:71], a[104:107], v[44:47]
ds_read_b64_tr_b16 a[10:11], v2 offset:1408
v_mfma_f32_16x16x32_bf16 v[44:47], a[72:75], a[100:103], v[44:47]
ds_read_b128 a[40:43], v3 offset:1088
v_mfma_f32_16x16x32_bf16 v[44:47], a[76:79], a[96:99], v[44:47]
s_waitcnt lgkmcnt(15)
ds_read_b64_tr_b16 a[12:13], v2 offset:1928
v_mfma_f32_16x16x32_bf16 v[48:51], a[64:67], a[112:115], v[48:51]
ds_read_b64_tr_b16 a[14:15], v2 offset:1920
v_mfma_f32_16x16x32_bf16 v[48:51], a[68:71], a[108:111], v[48:51]
ds_read_b128 a[44:47], v3 offset:1600
v_mfma_f32_16x16x32_bf16 v[48:51], a[72:75], a[104:107], v[48:51]
ds_read_b64_tr_b16 a[16:17], v2 offset:2440
v_mfma_f32_16x16x32_bf16 v[48:51], a[76:79], a[100:103], v[48:51]
ds_read_b64_tr_b16 a[18:19], v2 offset:2432
v_mfma_f32_16x16x32_bf16 v[48:51], a[80:83], a[96:99], v[48:51]
ds_read_b128 a[48:51], v3 offset:2112
v_mfma_f32_16x16x32_bf16 v[52:55], a[64:67], a[116:119], v[52:55]
ds_read_b64_tr_b16 a[20:21], v2 offset:2952
v_mfma_f32_16x16x32_bf16 v[52:55], a[68:71], a[112:115], v[52:55]
ds_read_b64_tr_b16 a[22:23], v2 offset:2944
v_mfma_f32_16x16x32_bf16 v[52:55], a[72:75], a[108:111], v[52:55]
ds_read_b128 a[52:55], v3 offset:2624
v_mfma_f32_16x16x32_bf16 v[52:55], a[76:79], a[104:107], v[52:55]
ds_read_b64_tr_b16 a[24:25], v2 offset:3464
v_mfma_f32_16x16x32_bf16 v[52:55], a[80:83], a[100:103], v[52:55]
ds_read_b64_tr_b16 a[26:27], v2 offset:3456
v_mfma_f32_16x16x32_bf16 v[52:55], a[84:87], a[96:99], v[52:55]
s_waitcnt lgkmcnt(15)
ds_read_b128 a[56:59], v3 offset:3136
v_mfma_f32_16x16x32_bf16 v[56:59], a[64:67], a[120:123], v[56:59]
ds_read_b64_tr_b16 a[28:29], v2 offset:3976
v_mfma_f32_16x16x32_bf16 v[56:59], a[68:71], a[116:119], v[56:59]
ds_read_b64_tr_b16 a[30:31], v2 offset:3968
v_mfma_f32_16x16x32_bf16 v[56:59], a[72:75], a[112:115], v[56:59]
ds_read_b128 a[60:63], v3 offset:3648
v_mfma_f32_16x16x32_bf16 v[56:59], a[76:79], a[108:111], v[56:59]
ds_read_b64 v[64:65], v4 offset:0
v_mfma_f32_16x16x32_bf16 v[56:59], a[80:83], a[104:107], v[56:59]
ds_read_b64 v[66:67], v4 offset:512
v_mfma_f32_16x16x32_bf16 v[56:59], a[84:87], a[100:103], v[56:59]
ds_read_b64 v[68:69], v4 offset:1024
v_mfma_f32_16x16x32_bf16 v[56:59], a[88:91], a[96:99], v[56:59]
ds_read_b64 v[70:71], v4 offset:1536
v_mfma_f32_16x16x32_bf16 v[60:63], a[64:67], a[124:127], v[60:63]
ds_read_b64 v[72:73], v4 offset:2048
v_mfma_f32_16x16x32_bf16 v[60:63], a[68:71], a[120:123], v[60:63]
ds_read_b64 v[74:75], v4 offset:2560
v_mfma_f32_16x16x32_bf16 v[60:63], a[72:75], a[116:119], v[60:63]
ds_read_b64 v[76:77], v4 offset:3072
v_mfma_f32_16x16x32_bf16 v[60:63], a[76:79], a[112:115], v[60:63]
ds_read_b64 v[78:79], v4 offset:3584
v_mfma_f32_16x16x32_bf16 v[60:63], a[80:83], a[108:111], v[60:63]
v_mfma_f32_16x16x32_bf16 v[60:63], a[84:87], a[104:107], v[60:63]
v_mfma_f32_16x16x32_bf16 v[60:63], a[88:91], a[100:103], v[60:63]
v_mfma_f32_16x16x32_bf16 v[60:63], a[92:95], a[96:99], v[60:63]
v_mfma_f32_16x16x32_bf16 v[32:35], a[0:3], a[32:35], v[32:35]
s_waitcnt lgkmcnt(15)
ds_read_b64_tr_b16 a[64:65], v2 offset:456
v_mfma_f32_16x16x32_bf16 v[36:39], a[0:3], a[36:39], v[36:39]
ds_read_b64_tr_b16 a[66:67], v2 offset:448
v_mfma_f32_16x16x32_bf16 v[36:39], a[4:7], a[32:35], v[36:39]
ds_read_b128 a[96:99], v3 offset:0
v_mfma_f32_16x16x32_bf16 v[40:43], a[0:3], a[40:43], v[40:43]
ds_read_b64_tr_b16 a[68:69], v2 offset:968
v_mfma_f32_16x16x32_bf16 v[40:43], a[4:7], a[36:39], v[40:43]
ds_read_b64_tr_b16 a[70:71], v2 offset:960
v_mfma_f32_16x16x32_bf16 v[40:43], a[8:11], a[32:35], v[40:43]
ds_read_b128 a[100:103], v3 offset:512
v_mfma_f32_16x16x32_bf16 v[44:47], a[0:3], a[44:47], v[44:47]
ds_read_b64_tr_b16 a[72:73], v2 offset:1480
v_mfma_f32_16x16x32_bf16 v[44:47], a[4:7], a[40:43], v[44:47]
ds_read_b64_tr_b16 a[74:75], v2 offset:1472
v_mfma_f32_16x16x32_bf16 v[44:47], a[8:11], a[36:39], v[44:47]
ds_read_b128 a[104:107], v3 offset:1024
v_mfma_f32_16x16x32_bf16 v[44:47], a[12:15], a[32:35], v[44:47]
ds_read_b64_tr_b16 a[76:77], v2 offset:1992
v_mfma_f32_16x16x32_bf16 v[48:51], a[0:3], a[48:51], v[48:51]
ds_read_b64_tr_b16 a[78:79], v2 offset:1984
v_mfma_f32_16x16x32_bf16 v[48:51], a[4:7], a[44:47], v[48:51]
ds_read_b128 a[108:111], v3 offset:1536
v_mfma_f32_16x16x32_bf16 v[48:51], a[8:11], a[40:43], v[48:51]
ds_read_b64_tr_b16 a[80:81], v2 offset:2504
v_mfma_f32_16x16x32_bf16 v[48:51], a[12:15], a[36:39], v[48:51]
ds_read_b64_tr_b16 a[82:83], v2 offset:2496
v_mfma_f32_16x16x32_bf16 v[48:51], a[16:19], a[32:35], v[48:51]
s_waitcnt lgkmcnt(15)
ds_read_b128 a[112:115], v3 offset:2048
v_mfma_f32_16x16x32_bf16 v[52:55], a[0:3], a[52:55], v[52:55]
ds_read_b64_tr_b16 a[84:85], v2 offset:3016
v_mfma_f32_16x16x32_bf16 v[52:55], a[4:7], a[48:51], v[52:55]
ds_read_b64_tr_b16 a[86:87], v2 offset:3008
v_mfma_f32_16x16x32_bf16 v[52:55], a[8:11], a[44:47], v[52:55]
ds_read_b128 a[116:119], v3 offset:2560
v_mfma_f32_16x16x32_bf16 v[52:55], a[12:15], a[40:43], v[52:55]
ds_read_b64_tr_b16 a[88:89], v2 offset:3528
v_mfma_f32_16x16x32_bf16 v[52:55], a[16:19], a[36:39], v[52:55]
ds_read_b64_tr_b16 a[90:91], v2 offset:3520
v_mfma_f32_16x16x32_bf16 v[52:55], a[20:23], a[32:35], v[52:55]
ds_read_b128 a[120:123], v3 offset:3072
v_mfma_f32_16x16x32_bf16 v[56:59], a[0:3], a[56:59], v[56:59]
ds_read_b64_tr_b16 a[92:93], v2 offset:4040
v_mfma_f32_16x16x32_bf16 v[56:59], a[4:7], a[52:55], v[56:59]
ds_read_b64_tr_b16 a[94:95], v2 offset:4032
v_mfma_f32_16x16x32_bf16 v[56:59], a[8:11], a[48:51], v[56:59]
ds_read_b128 a[124:127], v3 offset:3584
v_mfma_f32_16x16x32_bf16 v[56:59], a[12:15], a[44:47], v[56:59]
v_mfma_f32_16x16x32_bf16 v[56:59], a[16:19], a[40:43], v[56:59]
v_mfma_f32_16x16x32_bf16 v[56:59], a[20:23], a[36:39], v[56:59]
v_mfma_f32_16x16x32_bf16 v[56:59], a[24:27], a[32:35], v[56:59]
v_mfma_f32_16x16x32_bf16 v[60:63], a[0:3], a[60:63], v[60:63]
v_mfma_f32_16x16x32_bf16 v[60:63], a[4:7], a[56:59], v[60:63]
v_mfma_f32_16x16x32_bf16 v[60:63], a[8:11], a[52:55], v[60:63]
v_mfma_f32_16x16x32_bf16 v[60:63], a[12:15], a[48:51], v[60:63]
v_mfma_f32_16x16x32_bf16 v[60:63], a[16:19], a[44:47], v[60:63]
v_mfma_f32_16x16x32_bf16 v[60:63], a[20:23], a[40:43], v[60:63]
v_mfma_f32_16x16x32_bf16 v[60:63], a[24:27], a[36:39], v[60:63]
v_mfma_f32_16x16x32_bf16 v[60:63], a[28:31], a[32:35], v[60:63]
s_waitcnt lgkmcnt(15)
v_mfma_f32_16x16x32_bf16 v[32:35], a[64:67], a[96:99], v[32:35]
v_mfma_f32_16x16x32_bf16 v[36:39], a[64:67], a[100:103], v[36:39]
v_mfma_f32_16x16x32_bf16 v[36:39], a[68:71], a[96:99], v[36:39]
v_mfma_f32_16x16x32_bf16 v[40:43], a[64:67], a[104:107], v[40:43]
v_mfma_f32_16x16x32_bf16 v[40:43], a[68:71], a[100:103], v[40:43]
v_mfma_f32_16x16x32_bf16 v[40:43], a[72:75], a[96:99], v[40:43]
s_waitcnt lgkmcnt(12)
v_mfma_f32_16x16x32_bf16 v[44:47], a[64:67], a[108:111], v[44:47]
v_mfma_f32_16x16x32_bf16 v[44:47], a[68:71], a[104:107], v[44:47]
v_mfma_f32_16x16x32_bf16 v[44:47], a[72:75], a[100:103], v[44:47]
v_lshlrev_b32 v10, 16, v64
v_fmac_f32 v32, s44, v10
v_mfma_f32_16x16x32_bf16 v[44:47], a[76:79], a[96:99], v[44:47]
s_waitcnt lgkmcnt(9)
v_and_b32 v11, 0xffff0000, v64
v_fmac_f32 v33, s44, v11
v_mfma_f32_16x16x32_bf16 v[48:51], a[64:67], a[112:115], v[48:51]
v_lshlrev_b32 v12, 16, v65
v_fmac_f32 v34, s44, v12
v_mfma_f32_16x16x32_bf16 v[48:51], a[68:71], a[108:111], v[48:51]
v_and_b32 v13, 0xffff0000, v65
v_fmac_f32 v35, s44, v13
v_mfma_f32_16x16x32_bf16 v[48:51], a[72:75], a[104:107], v[48:51]
v_cvt_pk_bf16_f32 v32, v32, v33
v_cvt_pk_bf16_f32 v33, v34, v35
v_mfma_f32_16x16x32_bf16 v[48:51], a[76:79], a[100:103], v[48:51]
buffer_store_dwordx2 v[32:33], v8, s[4:7], s41 offen offset:0 sc1
v_mfma_f32_16x16x32_bf16 v[48:51], a[80:83], a[96:99], v[48:51]
s_waitcnt lgkmcnt(6)
v_lshlrev_b32 v10, 16, v66
v_fmac_f32 v36, s44, v10
v_mfma_f32_16x16x32_bf16 v[52:55], a[64:67], a[116:119], v[52:55]
v_and_b32 v11, 0xffff0000, v66
v_fmac_f32 v37, s44, v11
v_mfma_f32_16x16x32_bf16 v[52:55], a[68:71], a[112:115], v[52:55]
v_lshlrev_b32 v12, 16, v67
v_fmac_f32 v38, s44, v12
v_mfma_f32_16x16x32_bf16 v[52:55], a[72:75], a[108:111], v[52:55]
v_and_b32 v13, 0xffff0000, v67
v_fmac_f32 v39, s44, v13
v_mfma_f32_16x16x32_bf16 v[52:55], a[76:79], a[104:107], v[52:55]
v_cvt_pk_bf16_f32 v36, v36, v37
v_cvt_pk_bf16_f32 v37, v38, v39
v_mfma_f32_16x16x32_bf16 v[52:55], a[80:83], a[100:103], v[52:55]
buffer_store_dwordx2 v[36:37], v8, s[4:7], s41 offen offset:512 sc1
v_mfma_f32_16x16x32_bf16 v[52:55], a[84:87], a[96:99], v[52:55]
s_waitcnt lgkmcnt(3)
v_lshlrev_b32 v10, 16, v68
v_fmac_f32 v40, s44, v10
v_mfma_f32_16x16x32_bf16 v[56:59], a[64:67], a[120:123], v[56:59]
v_and_b32 v11, 0xffff0000, v68
v_fmac_f32 v41, s44, v11
v_mfma_f32_16x16x32_bf16 v[56:59], a[68:71], a[116:119], v[56:59]
v_lshlrev_b32 v12, 16, v69
v_fmac_f32 v42, s44, v12
v_mfma_f32_16x16x32_bf16 v[56:59], a[72:75], a[112:115], v[56:59]
v_and_b32 v13, 0xffff0000, v69
v_fmac_f32 v43, s44, v13
v_mfma_f32_16x16x32_bf16 v[56:59], a[76:79], a[108:111], v[56:59]
v_cvt_pk_bf16_f32 v40, v40, v41
v_cvt_pk_bf16_f32 v41, v42, v43
v_mfma_f32_16x16x32_bf16 v[56:59], a[80:83], a[104:107], v[56:59]
buffer_store_dwordx2 v[40:41], v8, s[4:7], s41 offen offset:1024 sc1
v_mfma_f32_16x16x32_bf16 v[56:59], a[84:87], a[100:103], v[56:59]
v_lshlrev_b32 v10, 16, v70
v_fmac_f32 v44, s44, v10
v_mfma_f32_16x16x32_bf16 v[56:59], a[88:91], a[96:99], v[56:59]
s_waitcnt lgkmcnt(0)
v_and_b32 v11, 0xffff0000, v70
v_fmac_f32 v45, s44, v11
v_mfma_f32_16x16x32_bf16 v[60:63], a[64:67], a[124:127], v[60:63]
v_lshlrev_b32 v12, 16, v71
v_fmac_f32 v46, s44, v12
v_mfma_f32_16x16x32_bf16 v[60:63], a[68:71], a[120:123], v[60:63]
v_and_b32 v13, 0xffff0000, v71
v_fmac_f32 v47, s44, v13
v_mfma_f32_16x16x32_bf16 v[60:63], a[72:75], a[116:119], v[60:63]
v_cvt_pk_bf16_f32 v44, v44, v45
v_cvt_pk_bf16_f32 v45, v46, v47
v_mfma_f32_16x16x32_bf16 v[60:63], a[76:79], a[112:115], v[60:63]
buffer_store_dwordx2 v[44:45], v8, s[4:7], s41 offen offset:1536 sc1
v_mfma_f32_16x16x32_bf16 v[60:63], a[80:83], a[108:111], v[60:63]
v_lshlrev_b32 v10, 16, v72
v_fmac_f32 v48, s44, v10
v_mfma_f32_16x16x32_bf16 v[60:63], a[84:87], a[104:107], v[60:63]
v_and_b32 v11, 0xffff0000, v72
v_fmac_f32 v49, s44, v11
v_mfma_f32_16x16x32_bf16 v[60:63], a[88:91], a[100:103], v[60:63]
v_lshlrev_b32 v12, 16, v73
v_fmac_f32 v50, s44, v12
v_mfma_f32_16x16x32_bf16 v[60:63], a[92:95], a[96:99], v[60:63]
v_and_b32 v13, 0xffff0000, v73
v_fmac_f32 v51, s44, v13
v_cvt_pk_bf16_f32 v48, v48, v49
v_cvt_pk_bf16_f32 v49, v50, v51
buffer_store_dwordx2 v[48:49], v8, s[4:7], s41 offen offset:2048 sc1
v_lshlrev_b32 v10, 16, v74
v_fmac_f32 v52, s44, v10
v_and_b32 v11, 0xffff0000, v74
v_fmac_f32 v53, s44, v11
v_lshlrev_b32 v12, 16, v75
v_fmac_f32 v54, s44, v12
v_and_b32 v13, 0xffff0000, v75
v_fmac_f32 v55, s44, v13
v_cvt_pk_bf16_f32 v52, v52, v53
v_cvt_pk_bf16_f32 v53, v54, v55
buffer_store_dwordx2 v[52:53], v8, s[4:7], s41 offen offset:2560 sc1
v_lshlrev_b32 v10, 16, v76
v_fmac_f32 v56, s44, v10
v_and_b32 v11, 0xffff0000, v76
v_fmac_f32 v57, s44, v11
v_lshlrev_b32 v12, 16, v77
v_fmac_f32 v58, s44, v12
v_and_b32 v13, 0xffff0000, v77
v_fmac_f32 v59, s44, v13
v_cvt_pk_bf16_f32 v56, v56, v57
v_cvt_pk_bf16_f32 v57, v58, v59
buffer_store_dwordx2 v[56:57], v8, s[4:7], s41 offen offset:3072 sc1
v_lshlrev_b32 v10, 16, v78
v_fmac_f32 v60, s44, v10
v_and_b32 v11, 0xffff0000, v78
v_fmac_f32 v61, s44, v11
v_lshlrev_b32 v12, 16, v79
v_fmac_f32 v62, s44, v12
v_and_b32 v13, 0xffff0000, v79
v_fmac_f32 v63, s44, v13
v_cvt_pk_bf16_f32 v60, v60, v61
v_cvt_pk_bf16_f32 v61, v62, v63
buffer_store_dwordx2 v[60:61], v8, s[4:7], s41 offen offset:3584 sc1
v_lshrrev_b32 v3, 6, v0
v_and_b32 v4, 63, v0
v_add_u32 v2, 0x10000, v1
s_lshl_b32 s18, s3, 13
s_mov_b32 s25, 1266679808
v_and_b32 v5, 15, v4
v_lshrrev_b32 v6, 4, v4
v_lshlrev_b32 v6, 2, v6
v_sub_u32 v5, v5, v6
v_lshl_add_u32 v5, v3, 4, v5
v_cmp_gt_i32 s[32:33], 0, v5
v_cmp_gt_i32 s[34:35], 1, v5
v_cmp_gt_i32 s[36:37], 2, v5
v_cmp_gt_i32 s[38:39], 3, v5
v_cmp_gt_i32 s[40:41], 16, v5
v_cmp_gt_i32 s[42:43], 17, v5
v_cmp_gt_i32 s[44:45], 18, v5
v_cmp_gt_i32 s[46:47], 19, v5
v_cmp_gt_i32 s[48:49], 32, v5
v_cmp_gt_i32 s[50:51], 33, v5
v_cmp_gt_i32 s[52:53], 34, v5
v_cmp_gt_i32 s[54:55], 35, v5
v_cmp_gt_i32 s[56:57], 48, v5
v_cmp_gt_i32 s[58:59], 49, v5
v_cmp_gt_i32 s[60:61], 50, v5
v_cmp_gt_i32 s[62:63], 51, v5
v_cmp_eq_u32 vcc, 0, v0
v_mov_b32 v7, 0xff800000
v_mov_b32 v6, 1
v_mov_b32 v3, 0
v_mov_b32 v5, 3221225472
v_cndmask_b32 v5, v5, v3, vcc
s_lshl_b32 s30, s20, 20
s_add_u32 s30, s30, s18
s_lshl_b32 s27, s20, 3
s_add_u32 s27, s27, s21
s_lshl_b32 s28, s20, 7
s_lshl_b32 s22, s21, 3
s_add_u32 s28, s28, s22
s_add_u32 s28, s28, 94375940
s_sub_u32 s29, 15, s21
s_lshl_b32 s22, s21, 1
s_mov_b32 s10, 3221225472
s_mov_b32 s11, 0
s_mov_b32 s14, 3221225472
s_bitcmp1_b32 s2, 4
s_cbranch_scc1 Lr_9601B
s_sub_u32 s22, 14, s22
s_lshl_b32 s22, s22, 15
s_add_u32 s8, s30, s22
s_mov_b32 s9, 18
s_mov_b32 s19, 8
s_cmp_eq_u32 s21, 7
s_cselect_b32 s24, 0, 1
s_branch Lr_9601go
Lr_9601B:
s_mov_b32 s8, s30
s_cmp_eq_u32 s21, 7
s_cbranch_scc1 Lr_9601B7
s_sub_u32 s9, 14, s22
s_mov_b32 s10, s30
s_add_u32 s11, s22, 2
s_add_u32 s14, s30, 16777216
s_sub_u32 s19, 7, s21
s_mov_b32 s24, 2
s_branch Lr_9601go
Lr_9601B7:
s_mov_b32 s9, 16
s_mov_b32 s19, 7
s_mov_b32 s24, 0
s_mov_b32 s29, 7
Lr_9601go:
s_add_u32 s12, s8, 16777216
s_mov_b32 s13, s9
s_mov_b32 s15, s11
s_lshl_b32 s26, s21, 16
s_add_u32 s26, s26, s30
s_add_u32 s26, s26, 33554432
v_mov_b32 v128, 0
v_mov_b32 v129, 0
v_mov_b32 v130, 0
v_mov_b32 v131, 0
v_mov_b32 v132, 0
v_mov_b32 v133, 0
v_mov_b32 v134, 0
v_mov_b32 v135, 0
v_mov_b32 v136, 0
v_mov_b32 v137, 0
v_mov_b32 v138, 0
v_mov_b32 v139, 0
v_mov_b32 v140, 0
v_mov_b32 v141, 0
v_mov_b32 v142, 0
v_mov_b32 v143, 0
v_mov_b32 v144, 0
v_mov_b32 v145, 0
v_mov_b32 v146, 0
v_mov_b32 v147, 0
v_mov_b32 v148, 0
v_mov_b32 v149, 0
v_mov_b32 v150, 0
v_mov_b32 v151, 0
v_mov_b32 v152, 0
v_mov_b32 v153, 0
v_mov_b32 v154, 0
v_mov_b32 v155, 0
v_mov_b32 v156, 0
v_mov_b32 v157, 0
v_mov_b32 v158, 0
v_mov_b32 v159, 0
v_mov_b32 v160, 0
v_mov_b32 v161, 0
v_mov_b32 v162, 0
v_mov_b32 v163, 0
v_mov_b32 v164, 0
v_mov_b32 v165, 0
v_mov_b32 v166, 0
v_mov_b32 v167, 0
v_mov_b32 v168, 0
v_mov_b32 v169, 0
v_mov_b32 v170, 0
v_mov_b32 v171, 0
v_mov_b32 v172, 0
v_mov_b32 v173, 0
v_mov_b32 v174, 0
v_mov_b32 v175, 0
v_mov_b32 v176, 0
v_mov_b32 v177, 0
v_mov_b32 v178, 0
v_mov_b32 v179, 0
v_mov_b32 v180, 0
v_mov_b32 v181, 0
v_mov_b32 v182, 0
v_mov_b32 v183, 0
v_mov_b32 v184, 0
v_mov_b32 v185, 0
v_mov_b32 v186, 0
v_mov_b32 v187, 0
v_mov_b32 v188, 0
v_mov_b32 v189, 0
v_mov_b32 v190, 0
v_mov_b32 v191, 0
v_mov_b32 v192, 0
v_mov_b32 v193, 0
v_mov_b32 v194, 0
v_mov_b32 v195, 0
v_mov_b32 v196, 0
v_mov_b32 v197, 0
v_mov_b32 v198, 0
v_mov_b32 v199, 0
v_mov_b32 v200, 0
v_mov_b32 v201, 0
v_mov_b32 v202, 0
v_mov_b32 v203, 0
v_mov_b32 v204, 0
v_mov_b32 v205, 0
v_mov_b32 v206, 0
v_mov_b32 v207, 0
v_mov_b32 v208, 0
v_mov_b32 v209, 0
v_mov_b32 v210, 0
v_mov_b32 v211, 0
v_mov_b32 v212, 0
v_mov_b32 v213, 0
v_mov_b32 v214, 0
v_mov_b32 v215, 0
v_mov_b32 v216, 0
v_mov_b32 v217, 0
v_mov_b32 v218, 0
v_mov_b32 v219, 0
v_mov_b32 v220, 0
v_mov_b32 v221, 0
v_mov_b32 v222, 0
v_mov_b32 v223, 0
v_mov_b32 v224, 0
v_mov_b32 v225, 0
v_mov_b32 v226, 0
v_mov_b32 v227, 0
v_mov_b32 v228, 0
v_mov_b32 v229, 0
v_mov_b32 v230, 0
v_mov_b32 v231, 0
v_mov_b32 v232, 0
v_mov_b32 v233, 0
v_mov_b32 v234, 0
v_mov_b32 v235, 0
v_mov_b32 v236, 0
v_mov_b32 v237, 0
v_mov_b32 v238, 0
v_mov_b32 v239, 0
v_mov_b32 v240, 0
v_mov_b32 v241, 0
v_mov_b32 v242, 0
v_mov_b32 v243, 0
v_mov_b32 v244, 0
v_mov_b32 v245, 0
v_mov_b32 v246, 0
v_mov_b32 v247, 0
v_mov_b32 v248, 0
v_mov_b32 v249, 0
v_mov_b32 v250, 0
v_mov_b32 v251, 0
v_mov_b32 v252, 0
v_mov_b32 v253, 0
v_mov_b32 v254, 0
v_mov_b32 v255, 0
v_mov_b32 v24, 0
v_mov_b32 v25, 0
s_lshl_b32 s22, s20, 7
s_add_u32 s22, s22, 94371840
s_lshl_b32 s23, s21, 3
s_add_u32 s23, s23, 64
v_lshrrev_b32 v4, 2, v1
v_mov_b32 v3, s23
v_cmp_gt_u32 vcc, 64, v4
s_lshl_b32 s31, s2, 2
s_add_u32 s31, s31, 94384128
v_cndmask_b32 v4, v3, v4, vcc
Lcp:
buffer_load_dword v3, v4, s[4:7], s22 offen sc1
s_waitcnt vmcnt(0)
v_cmp_ne_u32 vcc, 1, v3
s_cbranch_vccz Lcpd
s_sleep 4
s_sub_u32 s101, s101, 1
s_cbranch_scc0 Lcp
s_mov_b32 s101, 0
Lcpd:
s_lshl_b32 s23, s29, 16
s_add_u32 s23, s23, s30
s_add_u32 s23, s23, 33554432
s_add_u32 m0, s18, 0
s_nop 0
buffer_load_dwordx4 v1, s[4:7], s8 offen offset:0 sc1 lds
buffer_load_dwordx4 v1, s[4:7], s8 offen offset:1024 sc1 lds
buffer_load_dwordx4 v1, s[4:7], s8 offen offset:2048 sc1 lds
buffer_load_dwordx4 v1, s[4:7], s8 offen offset:3072 sc1 lds
s_add_u32 s8, s8, 4096
s_add_u32 m0, s18, 4096
s_nop 0
buffer_load_dwordx4 v1, s[4:7], s8 offen offset:0 sc1 lds
buffer_load_dwordx4 v1, s[4:7], s8 offen offset:1024 sc1 lds
buffer_load_dwordx4 v1, s[4:7], s8 offen offset:2048 sc1 lds
buffer_load_dwordx4 v1, s[4:7], s8 offen offset:3072 sc1 lds
s_add_u32 s8, s8, 28672
s_sub_u32 s9, s9, 1
s_cmp_eq_u32 s9, 0
s_cselect_b32 s8, s10, s8
s_cselect_b32 s9, s11, s9
s_cselect_b32 s10, 3221225472, s10
s_add_u32 s22, s23, 0
buffer_load_dwordx4 a[0:3], v1, s[4:7], s22 offen offset:0 sc1
buffer_load_dwordx4 a[4:7], v1, s[4:7], s22 offen offset:1024 sc1
buffer_load_dwordx4 a[8:11], v1, s[4:7], s22 offen offset:2048 sc1
buffer_load_dwordx4 a[12:15], v1, s[4:7], s22 offen offset:3072 sc1
s_add_u32 s22, s23, 4096
buffer_load_dwordx4 a[16:19], v1, s[4:7], s22 offen offset:0 sc1
buffer_load_dwordx4 a[20:23], v1, s[4:7], s22 offen offset:1024 sc1
buffer_load_dwordx4 a[24:27], v1, s[4:7], s22 offen offset:2048 sc1
buffer_load_dwordx4 a[28:31], v1, s[4:7], s22 offen offset:3072 sc1
s_add_u32 s22, s23, 32768
buffer_load_dwordx4 a[32:35], v1, s[4:7], s22 offen offset:0 sc1
buffer_load_dwordx4 a[36:39], v1, s[4:7], s22 offen offset:1024 sc1
buffer_load_dwordx4 a[40:43], v1, s[4:7], s22 offen offset:2048 sc1
buffer_load_dwordx4 a[44:47], v1, s[4:7], s22 offen offset:3072 sc1
s_add_u32 s22, s23, 36864
buffer_load_dwordx4 a[48:51], v1, s[4:7], s22 offen offset:0 sc1
buffer_load_dwordx4 a[52:55], v1, s[4:7], s22 offen offset:1024 sc1
buffer_load_dwordx4 a[56:59], v1, s[4:7], s22 offen offset:2048 sc1
buffer_load_dwordx4 a[60:63], v1, s[4:7], s22 offen offset:3072 sc1
s_barrier
buffer_store_dword v6, v5, s[4:7], s31 offen sc1
s_add_u32 m0, s18, 32768
s_nop 0
buffer_load_dwordx4 v1, s[4:7], s8 offen offset:0 sc1 lds
buffer_load_dwordx4 v1, s[4:7], s8 offen offset:1024 sc1 lds
buffer_load_dwordx4 v1, s[4:7], s8 offen offset:2048 sc1 lds
buffer_load_dwordx4 v1, s[4:7], s8 offen offset:3072 sc1 lds
s_add_u32 s8, s8, 4096
s_add_u32 m0, s18, 36864
s_nop 0
buffer_load_dwordx4 v1, s[4:7], s8 offen offset:0 sc1 lds
buffer_load_dwordx4 v1, s[4:7], s8 offen offset:1024 sc1 lds
buffer_load_dwordx4 v1, s[4:7], s8 offen offset:2048 sc1 lds
buffer_load_dwordx4 v1, s[4:7], s8 offen offset:3072 sc1 lds
s_add_u32 s8, s8, 28672
s_sub_u32 s9, s9, 1
s_cmp_eq_u32 s9, 0
s_cselect_b32 s8, s10, s8
s_cselect_b32 s9, s11, s9
s_cselect_b32 s10, 3221225472, s10
s_add_u32 m0, s18, 65536
s_nop 0
buffer_load_dwordx4 v1, s[4:7], s12 offen offset:0 sc1 lds
buffer_load_dwordx4 v1, s[4:7], s12 offen offset:1024 sc1 lds
buffer_load_dwordx4 v1, s[4:7], s12 offen offset:2048 sc1 lds
buffer_load_dwordx4 v1, s[4:7], s12 offen offset:3072 sc1 lds
s_add_u32 s12, s12, 4096
s_add_u32 m0, s18, 69632
s_nop 0
buffer_load_dwordx4 v1, s[4:7], s12 offen offset:0 sc1 lds
buffer_load_dwordx4 v1, s[4:7], s12 offen offset:1024 sc1 lds
buffer_load_dwordx4 v1, s[4:7], s12 offen offset:2048 sc1 lds
buffer_load_dwordx4 v1, s[4:7], s12 offen offset:3072 sc1 lds
s_add_u32 s12, s12, 28672
s_sub_u32 s13, s13, 1
s_cmp_eq_u32 s13, 0
s_cselect_b32 s12, s14, s12
s_cselect_b32 s13, s15, s13
s_cselect_b32 s14, 3221225472, s14
s_waitcnt vmcnt(17)
s_barrier
s_branch K2_item
K2_plain:
v_rcp_f32 v3, v24
v_rcp_f32 v4, v25
s_nop 0
v_mov_b32 v28, v3
v_mov_b32 v29, v3
s_add_u32 s22, s23, 0
v_pk_mul_f32 v[128:129], v[128:129], v[28:29]
v_pk_mul_f32 v[130:131], v[130:131], v[28:29]
v_pk_mul_f32 v[136:137], v[136:137], v[28:29]
v_pk_mul_f32 v[138:139], v[138:139], v[28:29]
v_cvt_pk_bf16_f32 v128, v128, v129
v_cvt_pk_bf16_f32 v129, v130, v131
v_cvt_pk_bf16_f32 v130, v136, v137
v_cvt_pk_bf16_f32 v131, v138, v139
buffer_store_dwordx4 v[128:131], v1, s[4:7], s22 offen offset:0 sc1
v_pk_mul_f32 v[144:145], v[144:145], v[28:29]
v_pk_mul_f32 v[146:147], v[146:147], v[28:29]
v_pk_mul_f32 v[152:153], v[152:153], v[28:29]
v_pk_mul_f32 v[154:155], v[154:155], v[28:29]
v_cvt_pk_bf16_f32 v144, v144, v145
v_cvt_pk_bf16_f32 v145, v146, v147
v_cvt_pk_bf16_f32 v146, v152, v153
v_cvt_pk_bf16_f32 v147, v154, v155
buffer_store_dwordx4 v[144:147], v1, s[4:7], s22 offen offset:1024 sc1
v_pk_mul_f32 v[160:161], v[160:161], v[28:29]
v_pk_mul_f32 v[162:163], v[162:163], v[28:29]
v_pk_mul_f32 v[168:169], v[168:169], v[28:29]
v_pk_mul_f32 v[170:171], v[170:171], v[28:29]
v_cvt_pk_bf16_f32 v160, v160, v161
v_cvt_pk_bf16_f32 v161, v162, v163
v_cvt_pk_bf16_f32 v162, v168, v169
v_cvt_pk_bf16_f32 v163, v170, v171
buffer_store_dwordx4 v[160:163], v1, s[4:7], s22 offen offset:2048 sc1
v_pk_mul_f32 v[176:177], v[176:177], v[28:29]
v_pk_mul_f32 v[178:179], v[178:179], v[28:29]
v_pk_mul_f32 v[184:185], v[184:185], v[28:29]
v_pk_mul_f32 v[186:187], v[186:187], v[28:29]
v_cvt_pk_bf16_f32 v176, v176, v177
v_cvt_pk_bf16_f32 v177, v178, v179
v_cvt_pk_bf16_f32 v178, v184, v185
v_cvt_pk_bf16_f32 v179, v186, v187
buffer_store_dwordx4 v[176:179], v1, s[4:7], s22 offen offset:3072 sc1
s_add_u32 s22, s23, 4096
v_pk_mul_f32 v[192:193], v[192:193], v[28:29]
v_pk_mul_f32 v[194:195], v[194:195], v[28:29]
v_pk_mul_f32 v[200:201], v[200:201], v[28:29]
v_pk_mul_f32 v[202:203], v[202:203], v[28:29]
v_cvt_pk_bf16_f32 v192, v192, v193
v_cvt_pk_bf16_f32 v193, v194, v195
v_cvt_pk_bf16_f32 v194, v200, v201
v_cvt_pk_bf16_f32 v195, v202, v203
buffer_store_dwordx4 v[192:195], v1, s[4:7], s22 offen offset:0 sc1
v_pk_mul_f32 v[208:209], v[208:209], v[28:29]
v_pk_mul_f32 v[210:211], v[210:211], v[28:29]
v_pk_mul_f32 v[216:217], v[216:217], v[28:29]
v_pk_mul_f32 v[218:219], v[218:219], v[28:29]
v_cvt_pk_bf16_f32 v208, v208, v209
v_cvt_pk_bf16_f32 v209, v210, v211
v_cvt_pk_bf16_f32 v210, v216, v217
v_cvt_pk_bf16_f32 v211, v218, v219
buffer_store_dwordx4 v[208:211], v1, s[4:7], s22 offen offset:1024 sc1
v_pk_mul_f32 v[224:225], v[224:225], v[28:29]
v_pk_mul_f32 v[226:227], v[226:227], v[28:29]
v_pk_mul_f32 v[232:233], v[232:233], v[28:29]
v_pk_mul_f32 v[234:235], v[234:235], v[28:29]
v_cvt_pk_bf16_f32 v224, v224, v225
v_cvt_pk_bf16_f32 v225, v226, v227
v_cvt_pk_bf16_f32 v226, v232, v233
v_cvt_pk_bf16_f32 v227, v234, v235
buffer_store_dwordx4 v[224:227], v1, s[4:7], s22 offen offset:2048 sc1
v_pk_mul_f32 v[240:241], v[240:241], v[28:29]
v_pk_mul_f32 v[242:243], v[242:243], v[28:29]
v_pk_mul_f32 v[248:249], v[248:249], v[28:29]
v_pk_mul_f32 v[250:251], v[250:251], v[28:29]
v_cvt_pk_bf16_f32 v240, v240, v241
v_cvt_pk_bf16_f32 v241, v242, v243
v_cvt_pk_bf16_f32 v242, v248, v249
v_cvt_pk_bf16_f32 v243, v250, v251
buffer_store_dwordx4 v[240:243], v1, s[4:7], s22 offen offset:3072 sc1
v_mov_b32 v28, v4
v_mov_b32 v29, v4
s_add_u32 s22, s23, 524288
v_pk_mul_f32 v[132:133], v[132:133], v[28:29]
v_pk_mul_f32 v[134:135], v[134:135], v[28:29]
v_pk_mul_f32 v[140:141], v[140:141], v[28:29]
v_pk_mul_f32 v[142:143], v[142:143], v[28:29]
v_cvt_pk_bf16_f32 v132, v132, v133
v_cvt_pk_bf16_f32 v133, v134, v135
v_cvt_pk_bf16_f32 v134, v140, v141
v_cvt_pk_bf16_f32 v135, v142, v143
buffer_store_dwordx4 v[132:135], v1, s[4:7], s22 offen offset:0 sc1
v_pk_mul_f32 v[148:149], v[148:149], v[28:29]
v_pk_mul_f32 v[150:151], v[150:151], v[28:29]
v_pk_mul_f32 v[156:157], v[156:157], v[28:29]
v_pk_mul_f32 v[158:159], v[158:159], v[28:29]
v_cvt_pk_bf16_f32 v148, v148, v149
v_cvt_pk_bf16_f32 v149, v150, v151
v_cvt_pk_bf16_f32 v150, v156, v157
v_cvt_pk_bf16_f32 v151, v158, v159
buffer_store_dwordx4 v[148:151], v1, s[4:7], s22 offen offset:1024 sc1
v_pk_mul_f32 v[164:165], v[164:165], v[28:29]
v_pk_mul_f32 v[166:167], v[166:167], v[28:29]
v_pk_mul_f32 v[172:173], v[172:173], v[28:29]
v_pk_mul_f32 v[174:175], v[174:175], v[28:29]
v_cvt_pk_bf16_f32 v164, v164, v165
v_cvt_pk_bf16_f32 v165, v166, v167
v_cvt_pk_bf16_f32 v166, v172, v173
v_cvt_pk_bf16_f32 v167, v174, v175
buffer_store_dwordx4 v[164:167], v1, s[4:7], s22 offen offset:2048 sc1
v_pk_mul_f32 v[180:181], v[180:181], v[28:29]
v_pk_mul_f32 v[182:183], v[182:183], v[28:29]
v_pk_mul_f32 v[188:189], v[188:189], v[28:29]
v_pk_mul_f32 v[190:191], v[190:191], v[28:29]
v_cvt_pk_bf16_f32 v180, v180, v181
v_cvt_pk_bf16_f32 v181, v182, v183
v_cvt_pk_bf16_f32 v182, v188, v189
v_cvt_pk_bf16_f32 v183, v190, v191
buffer_store_dwordx4 v[180:183], v1, s[4:7], s22 offen offset:3072 sc1
s_add_u32 s22, s23, 528384
v_pk_mul_f32 v[196:197], v[196:197], v[28:29]
v_pk_mul_f32 v[198:199], v[198:199], v[28:29]
v_pk_mul_f32 v[204:205], v[204:205], v[28:29]
v_pk_mul_f32 v[206:207], v[206:207], v[28:29]
v_cvt_pk_bf16_f32 v196, v196, v197
v_cvt_pk_bf16_f32 v197, v198, v199
v_cvt_pk_bf16_f32 v198, v204, v205
v_cvt_pk_bf16_f32 v199, v206, v207
buffer_store_dwordx4 v[196:199], v1, s[4:7], s22 offen offset:0 sc1
v_pk_mul_f32 v[212:213], v[212:213], v[28:29]
v_pk_mul_f32 v[214:215], v[214:215], v[28:29]
v_pk_mul_f32 v[220:221], v[220:221], v[28:29]
v_pk_mul_f32 v[222:223], v[222:223], v[28:29]
v_cvt_pk_bf16_f32 v212, v212, v213
v_cvt_pk_bf16_f32 v213, v214, v215
v_cvt_pk_bf16_f32 v214, v220, v221
v_cvt_pk_bf16_f32 v215, v222, v223
buffer_store_dwordx4 v[212:215], v1, s[4:7], s22 offen offset:1024 sc1
v_pk_mul_f32 v[228:229], v[228:229], v[28:29]
v_pk_mul_f32 v[230:231], v[230:231], v[28:29]
v_pk_mul_f32 v[236:237], v[236:237], v[28:29]
v_pk_mul_f32 v[238:239], v[238:239], v[28:29]
v_cvt_pk_bf16_f32 v228, v228, v229
v_cvt_pk_bf16_f32 v229, v230, v231
v_cvt_pk_bf16_f32 v230, v236, v237
v_cvt_pk_bf16_f32 v231, v238, v239
buffer_store_dwordx4 v[228:231], v1, s[4:7], s22 offen offset:2048 sc1
v_pk_mul_f32 v[244:245], v[244:245], v[28:29]
v_pk_mul_f32 v[246:247], v[246:247], v[28:29]
v_pk_mul_f32 v[252:253], v[252:253], v[28:29]
v_pk_mul_f32 v[254:255], v[254:255], v[28:29]
v_cvt_pk_bf16_f32 v244, v244, v245
v_cvt_pk_bf16_f32 v245, v246, v247
v_cvt_pk_bf16_f32 v246, v252, v253
v_cvt_pk_bf16_f32 v247, v254, v255
buffer_store_dwordx4 v[244:247], v1, s[4:7], s22 offen offset:3072 sc1
s_branch K2_done
K2_p0d:
ds_read_b128 a[64:67], v1 offset:0
ds_read_b128 a[68:71], v1 offset:1024
ds_read_b128 a[72:75], v1 offset:2048
ds_read_b128 a[76:79], v1 offset:3072
ds_read_b128 a[80:83], v1 offset:4096
ds_read_b128 a[84:87], v1 offset:5120
ds_read_b128 a[88:91], v1 offset:6144
ds_read_b128 a[92:95], v1 offset:7168
v_cndmask_b32 v32, 0, v7, s[32:33]
v_cndmask_b32 v33, 0, v7, s[34:35]
v_cndmask_b32 v34, 0, v7, s[36:37]
v_cndmask_b32 v35, 0, v7, s[38:39]
v_cndmask_b32 v40, 0, v7, s[40:41]
v_cndmask_b32 v41, 0, v7, s[42:43]
v_cndmask_b32 v42, 0, v7, s[44:45]
v_cndmask_b32 v43, 0, v7, s[46:47]
s_waitcnt lgkmcnt(7)
v_mfma_f32_16x16x32_bf16 v[32:35], a[64:67], a[0:3], v[32:35]
s_waitcnt lgkmcnt(6)
ds_read_b128 a[96:99], v1 offset:8192
v_mfma_f32_16x16x32_bf16 v[32:35], a[68:71], a[4:7], v[32:35]
s_waitcnt lgkmcnt(6)
v_mfma_f32_16x16x32_bf16 v[32:35], a[72:75], a[8:11], v[32:35]
s_waitcnt lgkmcnt(5)
ds_read_b128 a[100:103], v1 offset:9216
v_mfma_f32_16x16x32_bf16 v[32:35], a[76:79], a[12:15], v[32:35]
s_waitcnt lgkmcnt(5)
v_mfma_f32_16x16x32_bf16 v[32:35], a[80:83], a[16:19], v[32:35]
s_waitcnt lgkmcnt(4)
ds_read_b128 a[104:107], v1 offset:10240
v_mfma_f32_16x16x32_bf16 v[32:35], a[84:87], a[20:23], v[32:35]
s_waitcnt lgkmcnt(4)
v_mfma_f32_16x16x32_bf16 v[32:35], a[88:91], a[24:27], v[32:35]
s_waitcnt lgkmcnt(3)
ds_read_b128 a[108:111], v1 offset:11264
v_mfma_f32_16x16x32_bf16 v[32:35], a[92:95], a[28:31], v[32:35]
v_mfma_f32_16x16x32_bf16 v[36:39], a[64:67], a[32:35], 0
ds_read_b128 a[112:115], v1 offset:12288
v_mfma_f32_16x16x32_bf16 v[36:39], a[68:71], a[36:39], v[36:39]
v_mfma_f32_16x16x32_bf16 v[36:39], a[72:75], a[40:43], v[36:39]
ds_read_b128 a[116:119], v1 offset:13312
v_mfma_f32_16x16x32_bf16 v[36:39], a[76:79], a[44:47], v[36:39]
v_mfma_f32_16x16x32_bf16 v[36:39], a[80:83], a[48:51], v[36:39]
ds_read_b128 a[120:123], v1 offset:14336
v_max3_f32 v28, v32, v33, v34
v_mfma_f32_16x16x32_bf16 v[36:39], a[84:87], a[52:55], v[36:39]
v_max_f32 v28, v28, v35
v_mov_b32 v30, v28
v_mfma_f32_16x16x32_bf16 v[36:39], a[88:91], a[56:59], v[36:39]
ds_read_b128 a[124:127], v1 offset:15360
v_mfma_f32_16x16x32_bf16 v[36:39], a[92:95], a[60:63], v[36:39]
s_waitcnt lgkmcnt(7)
v_permlane16_swap_b32 v28, v30
v_max_f32 v28, v28, v30
v_mfma_f32_16x16x32_bf16 v[40:43], a[96:99], a[0:3], v[40:43]
s_waitcnt lgkmcnt(6)
ds_read_b128 a[64:67], v1 offset:16384
v_mov_b32 v30, v28
v_mfma_f32_16x16x32_bf16 v[40:43], a[100:103], a[4:7], v[40:43]
s_waitcnt lgkmcnt(6)
v_mfma_f32_16x16x32_bf16 v[40:43], a[104:107], a[8:11], v[40:43]
s_waitcnt lgkmcnt(5)
ds_read_b128 a[68:71], v1 offset:17408
v_permlane32_swap_b32 v28, v30
v_mfma_f32_16x16x32_bf16 v[40:43], a[108:111], a[12:15], v[40:43]
s_waitcnt lgkmcnt(5)
v_max_f32 v28, v28, v30
v_sub_f32 v16, 0, v28
v_mfma_f32_16x16x32_bf16 v[40:43], a[112:115], a[16:19], v[40:43]
s_waitcnt lgkmcnt(4)
ds_read_b128 a[72:75], v1 offset:18432
v_sub_f32 v17, 0, v28
v_mfma_f32_16x16x32_bf16 v[40:43], a[116:119], a[20:23], v[40:43]
s_waitcnt lgkmcnt(4)
v_sub_f32 v18, 0, v28
v_sub_f32 v19, 0, v28
v_mfma_f32_16x16x32_bf16 v[40:43], a[120:123], a[24:27], v[40:43]
s_waitcnt lgkmcnt(3)
ds_read_b128 a[76:79], v1 offset:19456
v_max3_f32 v29, v36, v37, v38
v_cndmask_b32 v48, v16, v7, s[48:49]
v_mfma_f32_16x16x32_bf16 v[40:43], a[124:127], a[28:31], v[40:43]
v_max_f32 v29, v29, v39
v_mov_b32 v31, v29
v_cndmask_b32 v49, v16, v7, s[50:51]
v_mfma_f32_16x16x32_bf16 v[44:47], a[96:99], a[32:35], 0
ds_read_b128 a[80:83], v1 offset:20480
v_cndmask_b32 v50, v16, v7, s[52:53]
v_mfma_f32_16x16x32_bf16 v[44:47], a[100:103], a[36:39], v[44:47]
v_permlane16_swap_b32 v29, v31
v_max_f32 v29, v29, v31
v_cndmask_b32 v51, v16, v7, s[54:55]
v_mfma_f32_16x16x32_bf16 v[44:47], a[104:107], a[40:43], v[44:47]
ds_read_b128 a[84:87], v1 offset:21504
v_mov_b32 v31, v29
v_mfma_f32_16x16x32_bf16 v[44:47], a[108:111], a[44:47], v[44:47]
v_cndmask_b32 v56, v16, v7, s[56:57]
v_cndmask_b32 v57, v16, v7, s[58:59]
v_mfma_f32_16x16x32_bf16 v[44:47], a[112:115], a[48:51], v[44:47]
ds_read_b128 a[88:91], v1 offset:22528
v_permlane32_swap_b32 v29, v31
v_mfma_f32_16x16x32_bf16 v[44:47], a[116:119], a[52:55], v[44:47]
v_max_f32 v29, v29, v31
v_sub_f32 v20, 0, v29
v_mfma_f32_16x16x32_bf16 v[44:47], a[120:123], a[56:59], v[44:47]
ds_read_b128 a[92:95], v1 offset:23552
v_sub_f32 v21, 0, v29
v_mfma_f32_16x16x32_bf16 v[44:47], a[124:127], a[60:63], v[44:47]
s_waitcnt lgkmcnt(7)
v_sub_f32 v22, 0, v29
v_sub_f32 v23, 0, v29
v_mfma_f32_16x16x32_bf16 v[48:51], a[64:67], a[0:3], v[48:51]
s_waitcnt lgkmcnt(6)
ds_read_b128 a[96:99], v1 offset:24576
v_cndmask_b32 v58, v16, v7, s[60:61]
v_mfma_f32_16x16x32_bf16 v[48:51], a[68:71], a[4:7], v[48:51]
s_waitcnt lgkmcnt(6)
v_cndmask_b32 v59, v16, v7, s[62:63]
v_mfma_f32_16x16x32_bf16 v[48:51], a[72:75], a[8:11], v[48:51]
s_waitcnt lgkmcnt(5)
ds_read_b128 a[100:103], v1 offset:25600
v_mfma_f32_16x16x32_bf16 v[48:51], a[76:79], a[12:15], v[48:51]
s_waitcnt lgkmcnt(5)
v_mfma_f32_16x16x32_bf16 v[48:51], a[80:83], a[16:19], v[48:51]
s_waitcnt lgkmcnt(4)
ds_read_b128 a[104:107], v1 offset:26624
v_mfma_f32_16x16x32_bf16 v[48:51], a[84:87], a[20:23], v[48:51]
s_waitcnt lgkmcnt(4)
v_add_f32 v32, v32, v16
v_add_f32 v33, v33, v16
v_add_f32 v34, v34, v16
v_add_f32 v35, v35, v16
v_mfma_f32_16x16x32_bf16 v[48:51], a[88:91], a[24:27], v[48:51]
s_waitcnt lgkmcnt(3)
ds_read_b128 a[108:111], v1 offset:27648
v_add_f32 v36, v36, v20
v_add_f32 v37, v37, v20
v_add_f32 v38, v38, v20
v_add_f32 v39, v39, v20
v_mfma_f32_16x16x32_bf16 v[48:51], a[92:95], a[28:31], v[48:51]
v_add_f32 v40, v40, v16
v_add_f32 v41, v41, v16
v_add_f32 v42, v42, v16
v_add_f32 v43, v43, v16
v_mfma_f32_16x16x32_bf16 v[52:55], a[64:67], a[32:35], v[20:23]
ds_read_b128 a[112:115], v1 offset:28672
v_add_f32 v44, v44, v20
v_add_f32 v45, v45, v20
v_add_f32 v46, v46, v20
v_add_f32 v47, v47, v20
v_mfma_f32_16x16x32_bf16 v[52:55], a[68:71], a[36:39], v[52:55]
v_exp_f32 v8, v32
v_mfma_f32_16x16x32_bf16 v[52:55], a[72:75], a[40:43], v[52:55]
ds_read_b128 a[116:119], v1 offset:29696
v_exp_f32 v9, v33
v_mfma_f32_16x16x32_bf16 v[52:55], a[76:79], a[44:47], v[52:55]
v_exp_f32 v10, v34
v_mfma_f32_16x16x32_bf16 v[52:55], a[80:83], a[48:51], v[52:55]
ds_read_b128 a[120:123], v1 offset:30720
v_exp_f32 v11, v35
v_mfma_f32_16x16x32_bf16 v[52:55], a[84:87], a[52:55], v[52:55]
v_add_f32 v26, v8, v9
v_cvt_pk_bf16_f32 v96, v8, v9
v_add_f32 v26, v26, v10
v_add_f32 v26, v26, v11
v_cvt_pk_bf16_f32 v97, v10, v11
v_mfma_f32_16x16x32_bf16 v[52:55], a[88:91], a[56:59], v[52:55]
ds_read_b128 a[124:127], v1 offset:31744
v_exp_f32 v12, v36
v_mfma_f32_16x16x32_bf16 v[52:55], a[92:95], a[60:63], v[52:55]
s_waitcnt vmcnt(8) lgkmcnt(7)
s_barrier
v_exp_f32 v13, v37
v_mfma_f32_16x16x32_bf16 v[56:59], a[96:99], a[0:3], v[56:59]
s_waitcnt lgkmcnt(6)
ds_read_b128 a[64:67], v1 offset:32768
v_exp_f32 v14, v38
v_mfma_f32_16x16x32_bf16 v[56:59], a[100:103], a[4:7], v[56:59]
s_waitcnt lgkmcnt(6)
v_exp_f32 v15, v39
v_mfma_f32_16x16x32_bf16 v[56:59], a[104:107], a[8:11], v[56:59]
s_waitcnt lgkmcnt(5)
ds_read_b128 a[68:71], v1 offset:33792
v_add_f32 v27, v12, v13
v_cvt_pk_bf16_f32 v104, v12, v13
v_add_f32 v27, v27, v14
v_add_f32 v27, v27, v15
v_cvt_pk_bf16_f32 v105, v14, v15
v_mfma_f32_16x16x32_bf16 v[56:59], a[108:111], a[12:15], v[56:59]
s_waitcnt lgkmcnt(5)
v_exp_f32 v8, v40
v_mfma_f32_16x16x32_bf16 v[56:59], a[112:115], a[16:19], v[56:59]
s_waitcnt lgkmcnt(4)
ds_read_b128 a[72:75], v1 offset:34816
v_exp_f32 v9, v41
v_mfma_f32_16x16x32_bf16 v[56:59], a[116:119], a[20:23], v[56:59]
s_waitcnt lgkmcnt(4)
v_exp_f32 v10, v42
v_mfma_f32_16x16x32_bf16 v[56:59], a[120:123], a[24:27], v[56:59]
s_waitcnt lgkmcnt(3)
ds_read_b128 a[76:79], v1 offset:35840
v_exp_f32 v11, v43
v_mfma_f32_16x16x32_bf16 v[56:59], a[124:127], a[28:31], v[56:59]
v_add_f32 v26, v26, v8
v_add_f32 v26, v26, v9
v_cvt_pk_bf16_f32 v98, v8, v9
v_add_f32 v26, v26, v10
v_add_f32 v26, v26, v11
v_cvt_pk_bf16_f32 v99, v10, v11
v_mfma_f32_16x16x32_bf16 v[60:63], a[96:99], a[32:35], v[20:23]
ds_read_b128 a[80:83], v1 offset:36864
v_exp_f32 v12, v44
v_mfma_f32_16x16x32_bf16 v[60:63], a[100:103], a[36:39], v[60:63]
v_exp_f32 v13, v45
v_mfma_f32_16x16x32_bf16 v[60:63], a[104:107], a[40:43], v[60:63]
ds_read_b128 a[84:87], v1 offset:37888
v_exp_f32 v14, v46
v_mfma_f32_16x16x32_bf16 v[60:63], a[108:111], a[44:47], v[60:63]
v_exp_f32 v15, v47
v_mfma_f32_16x16x32_bf16 v[60:63], a[112:115], a[48:51], v[60:63]
ds_read_b128 a[88:91], v1 offset:38912
v_add_f32 v27, v27, v12
v_mfma_f32_16x16x32_bf16 v[60:63], a[116:119], a[52:55], v[60:63]
v_add_f32 v27, v27, v13
v_cvt_pk_bf16_f32 v106, v12, v13
v_mfma_f32_16x16x32_bf16 v[60:63], a[120:123], a[56:59], v[60:63]
s_waitcnt lgkmcnt(7)
s_barrier
ds_read_b128 a[92:95], v1 offset:39936
v_mfma_f32_16x16x32_bf16 v[60:63], a[124:127], a[60:63], v[60:63]
s_waitcnt lgkmcnt(6)
v_add_f32 v27, v27, v14
v_add_f32 v27, v27, v15
v_cvt_pk_bf16_f32 v107, v14, v15
s_branch K2_dx1
K2_ntail:
v_mfma_f32_16x16x32_bf16 v[128:131], a[64:67], v[96:99], v[128:131]
s_add_u32 m0, s18, 98304
ds_read_b128 a[96:99], v2 offset:8192
v_add_f32 v24, v24, v26
v_mfma_f32_16x16x32_bf16 v[128:131], a[68:71], v[100:103], v[128:131]
buffer_load_dwordx4 v1, s[4:7], s12 offen offset:0 sc1 lds
v_mfma_f32_16x16x32_bf16 v[132:135], a[68:71], v[108:111], v[132:135]
ds_read_b128 a[100:103], v2 offset:9216
v_add_f32 v25, v25, v27
v_mfma_f32_16x16x32_bf16 v[132:135], a[64:67], v[104:107], v[132:135]
s_waitcnt lgkmcnt(7)
buffer_load_dwordx4 v1, s[4:7], s12 offen offset:1024 sc1 lds
v_exp_f32 v8, v64
v_mfma_f32_16x16x32_bf16 v[136:139], a[72:75], v[96:99], v[136:139]
s_waitcnt lgkmcnt(6)
ds_read_b128 a[104:107], v2 offset:10240
v_exp_f32 v9, v65
v_mfma_f32_16x16x32_bf16 v[136:139], a[76:79], v[100:103], v[136:139]
buffer_load_dwordx4 v1, s[4:7], s12 offen offset:2048 sc1 lds
v_add_f32 v26, v8, v9
v_cvt_pk_bf16_f32 v112, v8, v9
v_mfma_f32_16x16x32_bf16 v[140:143], a[76:79], v[108:111], v[140:143]
ds_read_b128 a[108:111], v2 offset:11264
v_exp_f32 v10, v66
v_mfma_f32_16x16x32_bf16 v[140:143], a[72:75], v[104:107], v[140:143]
s_waitcnt lgkmcnt(6)
buffer_load_dwordx4 v1, s[4:7], s12 offen offset:3072 sc1 lds
v_mfma_f32_16x16x32_bf16 v[144:147], a[80:83], v[96:99], v[144:147]
s_add_u32 s12, s12, 4096
s_add_u32 m0, s18, 102400
ds_read_b128 a[112:115], v2 offset:12288
v_exp_f32 v11, v67
v_mfma_f32_16x16x32_bf16 v[144:147], a[84:87], v[100:103], v[144:147]
buffer_load_dwordx4 v1, s[4:7], s12 offen offset:0 sc1 lds
v_exp_f32 v12, v68
v_mfma_f32_16x16x32_bf16 v[148:151], a[84:87], v[108:111], v[148:151]
ds_read_b128 a[116:119], v2 offset:13312
v_add_f32 v26, v26, v10
v_mfma_f32_16x16x32_bf16 v[148:151], a[80:83], v[104:107], v[148:151]
s_waitcnt lgkmcnt(7)
buffer_load_dwordx4 v1, s[4:7], s12 offen offset:1024 sc1 lds
v_exp_f32 v13, v69
v_mfma_f32_16x16x32_bf16 v[152:155], a[88:91], v[96:99], v[152:155]
s_waitcnt lgkmcnt(6)
ds_read_b128 a[120:123], v2 offset:14336
v_add_f32 v26, v26, v11
v_cvt_pk_bf16_f32 v113, v10, v11
v_mfma_f32_16x16x32_bf16 v[152:155], a[92:95], v[100:103], v[152:155]
buffer_load_dwordx4 v1, s[4:7], s12 offen offset:2048 sc1 lds
v_exp_f32 v14, v70
v_mfma_f32_16x16x32_bf16 v[156:159], a[92:95], v[108:111], v[156:159]
ds_read_b128 a[124:127], v2 offset:15360
v_add_f32 v27, v12, v13
v_cvt_pk_bf16_f32 v120, v12, v13
v_mfma_f32_16x16x32_bf16 v[156:159], a[88:91], v[104:107], v[156:159]
s_waitcnt lgkmcnt(4)
buffer_load_dwordx4 v1, s[4:7], s12 offen offset:3072 sc1 lds
v_exp_f32 v15, v71
v_mfma_f32_16x16x32_bf16 v[160:163], a[96:99], v[96:99], v[160:163]
s_add_u32 s12, s12, 28672
ds_read_b128 a[64:67], v2 offset:16384
v_exp_f32 v8, v72
v_mfma_f32_16x16x32_bf16 v[160:163], a[100:103], v[100:103], v[160:163]
s_sub_u32 s13, s13, 1
v_add_f32 v27, v27, v14
v_add_f32 v27, v27, v15
v_mfma_f32_16x16x32_bf16 v[164:167], a[100:103], v[108:111], v[164:167]
s_cmp_eq_u32 s13, 0
ds_read_b128 a[68:71], v2 offset:17408
v_exp_f32 v9, v73
v_mfma_f32_16x16x32_bf16 v[164:167], a[96:99], v[104:107], v[164:167]
s_cselect_b32 s12, s14, s12
v_cvt_pk_bf16_f32 v121, v14, v15
v_add_f32 v26, v26, v8
v_mfma_f32_16x16x32_bf16 v[168:171], a[104:107], v[96:99], v[168:171]
s_cselect_b32 s13, s15, s13
ds_read_b128 a[72:75], v2 offset:18432
v_exp_f32 v10, v74
v_mfma_f32_16x16x32_bf16 v[168:171], a[108:111], v[100:103], v[168:171]
s_cselect_b32 s14, 3221225472, s14
v_exp_f32 v11, v75
v_mfma_f32_16x16x32_bf16 v[172:175], a[108:111], v[108:111], v[172:175]
ds_read_b128 a[76:79], v2 offset:19456
v_add_f32 v26, v26, v9
v_cvt_pk_bf16_f32 v114, v8, v9
v_mfma_f32_16x16x32_bf16 v[172:175], a[104:107], v[104:107], v[172:175]
s_waitcnt lgkmcnt(7)
v_exp_f32 v12, v76
v_mfma_f32_16x16x32_bf16 v[176:179], a[112:115], v[96:99], v[176:179]
s_waitcnt lgkmcnt(6)
ds_read_b128 a[80:83], v2 offset:20480
v_add_f32 v26, v26, v10
v_mfma_f32_16x16x32_bf16 v[176:179], a[116:119], v[100:103], v[176:179]
v_exp_f32 v13, v77
v_mfma_f32_16x16x32_bf16 v[180:183], a[116:119], v[108:111], v[180:183]
ds_read_b128 a[84:87], v2 offset:21504
v_add_f32 v26, v26, v11
v_cvt_pk_bf16_f32 v115, v10, v11
v_add_f32 v27, v27, v12
v_mfma_f32_16x16x32_bf16 v[180:183], a[112:115], v[104:107], v[180:183]
s_waitcnt lgkmcnt(7)
v_exp_f32 v14, v78
v_mfma_f32_16x16x32_bf16 v[184:187], a[120:123], v[96:99], v[184:187]
s_waitcnt lgkmcnt(6)
ds_read_b128 a[88:91], v2 offset:22528
v_exp_f32 v15, v79
v_mfma_f32_16x16x32_bf16 v[184:187], a[124:127], v[100:103], v[184:187]
v_add_f32 v27, v27, v13
v_cvt_pk_bf16_f32 v122, v12, v13
v_mfma_f32_16x16x32_bf16 v[188:191], a[124:127], v[108:111], v[188:191]
ds_read_b128 a[92:95], v2 offset:23552
v_exp_f32 v8, v80
v_mfma_f32_16x16x32_bf16 v[188:191], a[120:123], v[104:107], v[188:191]
s_waitcnt lgkmcnt(7)
v_add_f32 v27, v27, v14
v_add_f32 v27, v27, v15
v_cvt_pk_bf16_f32 v123, v14, v15
v_mfma_f32_16x16x32_bf16 v[192:195], a[64:67], v[96:99], v[192:195]
s_waitcnt lgkmcnt(6)
ds_read_b128 a[96:99], v2 offset:24576
v_exp_f32 v9, v81
v_mfma_f32_16x16x32_bf16 v[192:195], a[68:71], v[100:103], v[192:195]
v_exp_f32 v10, v82
v_mfma_f32_16x16x32_bf16 v[196:199], a[68:71], v[108:111], v[196:199]
ds_read_b128 a[100:103], v2 offset:25600
v_add_f32 v26, v26, v8
v_mfma_f32_16x16x32_bf16 v[196:199], a[64:67], v[104:107], v[196:199]
s_waitcnt lgkmcnt(7)
v_exp_f32 v11, v83
v_mfma_f32_16x16x32_bf16 v[200:203], a[72:75], v[96:99], v[200:203]
s_waitcnt lgkmcnt(6)
ds_read_b128 a[104:107], v2 offset:26624
v_add_f32 v26, v26, v9
v_cvt_pk_bf16_f32 v116, v8, v9
v_mfma_f32_16x16x32_bf16 v[200:203], a[76:79], v[100:103], v[200:203]
v_exp_f32 v12, v84
v_mfma_f32_16x16x32_bf16 v[204:207], a[76:79], v[108:111], v[204:207]
ds_read_b128 a[108:111], v2 offset:27648
v_add_f32 v26, v26, v10
v_add_f32 v26, v26, v11
v_cvt_pk_bf16_f32 v117, v10, v11
v_mfma_f32_16x16x32_bf16 v[204:207], a[72:75], v[104:107], v[204:207]
s_waitcnt lgkmcnt(7)
v_exp_f32 v13, v85
v_mfma_f32_16x16x32_bf16 v[208:211], a[80:83], v[96:99], v[208:211]
s_waitcnt lgkmcnt(6)
ds_read_b128 a[112:115], v2 offset:28672
v_exp_f32 v14, v86
v_mfma_f32_16x16x32_bf16 v[208:211], a[84:87], v[100:103], v[208:211]
v_add_f32 v27, v27, v12
v_add_f32 v27, v27, v13
v_mfma_f32_16x16x32_bf16 v[212:215], a[84:87], v[108:111], v[212:215]
ds_read_b128 a[116:119], v2 offset:29696
v_exp_f32 v15, v87
v_mfma_f32_16x16x32_bf16 v[212:215], a[80:83], v[104:107], v[212:215]
s_waitcnt lgkmcnt(7)
v_cvt_pk_bf16_f32 v124, v12, v13
v_add_f32 v27, v27, v14
v_mfma_f32_16x16x32_bf16 v[216:219], a[88:91], v[96:99], v[216:219]
s_waitcnt lgkmcnt(6)
ds_read_b128 a[120:123], v2 offset:30720
v_exp_f32 v8, v88
v_mfma_f32_16x16x32_bf16 v[216:219], a[92:95], v[100:103], v[216:219]
v_exp_f32 v9, v89
v_mfma_f32_16x16x32_bf16 v[220:223], a[92:95], v[108:111], v[220:223]
ds_read_b128 a[124:127], v2 offset:31744
v_add_f32 v27, v27, v15
v_cvt_pk_bf16_f32 v125, v14, v15
v_mfma_f32_16x16x32_bf16 v[220:223], a[88:91], v[104:107], v[220:223]
s_waitcnt vmcnt(0) lgkmcnt(7)
s_barrier
v_exp_f32 v10, v90
v_mfma_f32_16x16x32_bf16 v[224:227], a[96:99], v[96:99], v[224:227]
s_waitcnt lgkmcnt(6)
ds_read_b128 a[64:67], v2 offset:32768
v_add_f32 v26, v26, v8
v_mfma_f32_16x16x32_bf16 v[224:227], a[100:103], v[100:103], v[224:227]
v_exp_f32 v11, v91
v_mfma_f32_16x16x32_bf16 v[228:231], a[100:103], v[108:111], v[228:231]
ds_read_b128 a[68:71], v2 offset:33792
v_add_f32 v26, v26, v9
v_cvt_pk_bf16_f32 v118, v8, v9
v_add_f32 v26, v26, v10
v_mfma_f32_16x16x32_bf16 v[228:231], a[96:99], v[104:107], v[228:231]
s_waitcnt lgkmcnt(7)
v_exp_f32 v12, v92
v_mfma_f32_16x16x32_bf16 v[232:235], a[104:107], v[96:99], v[232:235]
s_waitcnt lgkmcnt(6)
ds_read_b128 a[72:75], v2 offset:34816
v_exp_f32 v13, v93
v_mfma_f32_16x16x32_bf16 v[232:235], a[108:111], v[100:103], v[232:235]
v_add_f32 v26, v26, v11
v_cvt_pk_bf16_f32 v119, v10, v11
v_mfma_f32_16x16x32_bf16 v[236:239], a[108:111], v[108:111], v[236:239]
ds_read_b128 a[76:79], v2 offset:35840
v_exp_f32 v14, v94
v_mfma_f32_16x16x32_bf16 v[236:239], a[104:107], v[104:107], v[236:239]
s_waitcnt lgkmcnt(7)
v_add_f32 v27, v27, v12
v_add_f32 v27, v27, v13
v_mfma_f32_16x16x32_bf16 v[240:243], a[112:115], v[96:99], v[240:243]
s_waitcnt lgkmcnt(6)
ds_read_b128 a[80:83], v2 offset:36864
v_exp_f32 v15, v95
v_mfma_f32_16x16x32_bf16 v[240:243], a[116:119], v[100:103], v[240:243]
v_cvt_pk_bf16_f32 v126, v12, v13
v_add_f32 v27, v27, v14
v_mfma_f32_16x16x32_bf16 v[244:247], a[116:119], v[108:111], v[244:247]
ds_read_b128 a[84:87], v2 offset:37888
v_add_f32 v27, v27, v15
v_mfma_f32_16x16x32_bf16 v[244:247], a[112:115], v[104:107], v[244:247]
s_waitcnt lgkmcnt(7)
v_cvt_pk_bf16_f32 v127, v14, v15
v_add_f32 v28, v26, v27
v_mfma_f32_16x16x32_bf16 v[248:251], a[120:123], v[96:99], v[248:251]
s_waitcnt lgkmcnt(6)
ds_read_b128 a[88:91], v2 offset:38912
v_cmp_nge_f32 vcc, s25, v28
v_mfma_f32_16x16x32_bf16 v[248:251], a[124:127], v[100:103], v[248:251]
v_mfma_f32_16x16x32_bf16 v[252:255], a[124:127], v[108:111], v[252:255]
ds_read_b128 a[92:95], v2 offset:39936
v_mfma_f32_16x16x32_bf16 v[252:255], a[120:123], v[104:107], v[252:255]
s_waitcnt lgkmcnt(6)
s_cbranch_vccnz Lstub_13
Lback_14:
v_mfma_f32_16x16x32_bf16 v[128:131], a[64:67], v[112:115], v[128:131]
s_add_u32 m0, s18, 32768
ds_read_b128 a[96:99], v2 offset:40960
v_add_f32 v24, v24, v26
v_mfma_f32_16x16x32_bf16 v[128:131], a[68:71], v[116:119], v[128:131]
buffer_load_dwordx4 v1, s[4:7], s8 offen offset:0 sc1 lds
v_mfma_f32_16x16x32_bf16 v[132:135], a[68:71], v[124:127], v[132:135]
ds_read_b128 a[100:103], v2 offset:41984
v_add_f32 v25, v25, v27
v_mfma_f32_16x16x32_bf16 v[132:135], a[64:67], v[120:123], v[132:135]
s_waitcnt lgkmcnt(7)
buffer_load_dwordx4 v1, s[4:7], s8 offen offset:1024 sc1 lds
v_mfma_f32_16x16x32_bf16 v[136:139], a[72:75], v[112:115], v[136:139]
s_waitcnt lgkmcnt(6)
ds_read_b128 a[104:107], v2 offset:43008
v_mfma_f32_16x16x32_bf16 v[136:139], a[76:79], v[116:119], v[136:139]
buffer_load_dwordx4 v1, s[4:7], s8 offen offset:2048 sc1 lds
v_mfma_f32_16x16x32_bf16 v[140:143], a[76:79], v[124:127], v[140:143]
ds_read_b128 a[108:111], v2 offset:44032
v_mfma_f32_16x16x32_bf16 v[140:143], a[72:75], v[120:123], v[140:143]
s_waitcnt lgkmcnt(6)
buffer_load_dwordx4 v1, s[4:7], s8 offen offset:3072 sc1 lds
v_mfma_f32_16x16x32_bf16 v[144:147], a[80:83], v[112:115], v[144:147]
s_add_u32 s8, s8, 4096
s_add_u32 m0, s18, 36864
ds_read_b128 a[112:115], v2 offset:45056
v_mfma_f32_16x16x32_bf16 v[144:147], a[84:87], v[116:119], v[144:147]
buffer_load_dwordx4 v1, s[4:7], s8 offen offset:0 sc1 lds
v_mfma_f32_16x16x32_bf16 v[148:151], a[84:87], v[124:127], v[148:151]
ds_read_b128 a[116:119], v2 offset:46080
v_mfma_f32_16x16x32_bf16 v[148:151], a[80:83], v[120:123], v[148:151]
s_waitcnt lgkmcnt(7)
buffer_load_dwordx4 v1, s[4:7], s8 offen offset:1024 sc1 lds
v_mfma_f32_16x16x32_bf16 v[152:155], a[88:91], v[112:115], v[152:155]
s_waitcnt lgkmcnt(6)
ds_read_b128 a[120:123], v2 offset:47104
v_mfma_f32_16x16x32_bf16 v[152:155], a[92:95], v[116:119], v[152:155]
buffer_load_dwordx4 v1, s[4:7], s8 offen offset:2048 sc1 lds
v_mfma_f32_16x16x32_bf16 v[156:159], a[92:95], v[124:127], v[156:159]
ds_read_b128 a[124:127], v2 offset:48128
v_mfma_f32_16x16x32_bf16 v[156:159], a[88:91], v[120:123], v[156:159]
s_waitcnt lgkmcnt(7)
buffer_load_dwordx4 v1, s[4:7], s8 offen offset:3072 sc1 lds
v_mfma_f32_16x16x32_bf16 v[160:163], a[96:99], v[112:115], v[160:163]
s_waitcnt lgkmcnt(6)
s_add_u32 s8, s8, 28672
ds_read_b128 a[64:67], v2 offset:49152
v_mfma_f32_16x16x32_bf16 v[160:163], a[100:103], v[116:119], v[160:163]
s_sub_u32 s9, s9, 1
v_mfma_f32_16x16x32_bf16 v[164:167], a[100:103], v[124:127], v[164:167]
s_cmp_eq_u32 s9, 0
ds_read_b128 a[68:71], v2 offset:50176
v_mfma_f32_16x16x32_bf16 v[164:167], a[96:99], v[120:123], v[164:167]
s_waitcnt lgkmcnt(7)
s_cselect_b32 s8, s10, s8
v_mfma_f32_16x16x32_bf16 v[168:171], a[104:107], v[112:115], v[168:171]
s_waitcnt lgkmcnt(6)
s_cselect_b32 s9, s11, s9
ds_read_b128 a[72:75], v2 offset:51200
v_mfma_f32_16x16x32_bf16 v[168:171], a[108:111], v[116:119], v[168:171]
s_cselect_b32 s10, 3221225472, s10
v_mfma_f32_16x16x32_bf16 v[172:175], a[108:111], v[124:127], v[172:175]
ds_read_b128 a[76:79], v2 offset:52224
v_mfma_f32_16x16x32_bf16 v[172:175], a[104:107], v[120:123], v[172:175]
s_waitcnt lgkmcnt(7)
v_mfma_f32_16x16x32_bf16 v[176:179], a[112:115], v[112:115], v[176:179]
s_waitcnt lgkmcnt(6)
s_add_u32 s22, s26, 0
ds_read_b128 a[80:83], v2 offset:53248
v_mfma_f32_16x16x32_bf16 v[176:179], a[116:119], v[116:119], v[176:179]
buffer_load_dwordx4 a[0:3], v1, s[4:7], s22 offen offset:0 sc1
v_mfma_f32_16x16x32_bf16 v[180:183], a[116:119], v[124:127], v[180:183]
ds_read_b128 a[84:87], v2 offset:54272
v_mfma_f32_16x16x32_bf16 v[180:183], a[112:115], v[120:123], v[180:183]
s_waitcnt lgkmcnt(7)
buffer_load_dwordx4 a[4:7], v1, s[4:7], s22 offen offset:1024 sc1
v_mfma_f32_16x16x32_bf16 v[184:187], a[120:123], v[112:115], v[184:187]
s_waitcnt lgkmcnt(6)
ds_read_b128 a[88:91], v2 offset:55296
v_mfma_f32_16x16x32_bf16 v[184:187], a[124:127], v[116:119], v[184:187]
buffer_load_dwordx4 a[8:11], v1, s[4:7], s22 offen offset:2048 sc1
v_mfma_f32_16x16x32_bf16 v[188:191], a[124:127], v[124:127], v[188:191]
ds_read_b128 a[92:95], v2 offset:56320
v_mfma_f32_16x16x32_bf16 v[188:191], a[120:123], v[120:123], v[188:191]
s_waitcnt lgkmcnt(7)
buffer_load_dwordx4 a[12:15], v1, s[4:7], s22 offen offset:3072 sc1
v_mfma_f32_16x16x32_bf16 v[192:195], a[64:67], v[112:115], v[192:195]
s_waitcnt lgkmcnt(6)
s_add_u32 s22, s26, 4096
ds_read_b128 a[96:99], v2 offset:57344
v_mfma_f32_16x16x32_bf16 v[192:195], a[68:71], v[116:119], v[192:195]
buffer_load_dwordx4 a[16:19], v1, s[4:7], s22 offen offset:0 sc1
v_mfma_f32_16x16x32_bf16 v[196:199], a[68:71], v[124:127], v[196:199]
ds_read_b128 a[100:103], v2 offset:58368
v_mfma_f32_16x16x32_bf16 v[196:199], a[64:67], v[120:123], v[196:199]
s_waitcnt lgkmcnt(7)
buffer_load_dwordx4 a[20:23], v1, s[4:7], s22 offen offset:1024 sc1
v_mfma_f32_16x16x32_bf16 v[200:203], a[72:75], v[112:115], v[200:203]
s_waitcnt lgkmcnt(6)
ds_read_b128 a[104:107], v2 offset:59392
v_mfma_f32_16x16x32_bf16 v[200:203], a[76:79], v[116:119], v[200:203]
buffer_load_dwordx4 a[24:27], v1, s[4:7], s22 offen offset:2048 sc1
v_mfma_f32_16x16x32_bf16 v[204:207], a[76:79], v[124:127], v[204:207]
ds_read_b128 a[108:111], v2 offset:60416
v_mfma_f32_16x16x32_bf16 v[204:207], a[72:75], v[120:123], v[204:207]
s_waitcnt lgkmcnt(7)
buffer_load_dwordx4 a[28:31], v1, s[4:7], s22 offen offset:3072 sc1
v_mfma_f32_16x16x32_bf16 v[208:211], a[80:83], v[112:115], v[208:211]
s_waitcnt lgkmcnt(6)
s_add_u32 s22, s26, 32768
ds_read_b128 a[112:115], v2 offset:61440
v_mfma_f32_16x16x32_bf16 v[208:211], a[84:87], v[116:119], v[208:211]
buffer_load_dwordx4 a[32:35], v1, s[4:7], s22 offen offset:0 sc1
v_mfma_f32_16x16x32_bf16 v[212:215], a[84:87], v[124:127], v[212:215]
ds_read_b128 a[116:119], v2 offset:62464
v_mfma_f32_16x16x32_bf16 v[212:215], a[80:83], v[120:123], v[212:215]
s_waitcnt lgkmcnt(7)
buffer_load_dwordx4 a[36:39], v1, s[4:7], s22 offen offset:1024 sc1
v_mfma_f32_16x16x32_bf16 v[216:219], a[88:91], v[112:115], v[216:219]
s_waitcnt lgkmcnt(6)
ds_read_b128 a[120:123], v2 offset:63488
v_mfma_f32_16x16x32_bf16 v[216:219], a[92:95], v[116:119], v[216:219]
buffer_load_dwordx4 a[40:43], v1, s[4:7], s22 offen offset:2048 sc1
v_mfma_f32_16x16x32_bf16 v[220:223], a[92:95], v[124:127], v[220:223]
ds_read_b128 a[124:127], v2 offset:64512
v_mfma_f32_16x16x32_bf16 v[220:223], a[88:91], v[120:123], v[220:223]
s_waitcnt lgkmcnt(6)
buffer_load_dwordx4 a[44:47], v1, s[4:7], s22 offen offset:3072 sc1
v_mfma_f32_16x16x32_bf16 v[224:227], a[96:99], v[112:115], v[224:227]
s_add_u32 s22, s26, 36864
buffer_load_dwordx4 a[48:51], v1, s[4:7], s22 offen offset:0 sc1
v_mfma_f32_16x16x32_bf16 v[224:227], a[100:103], v[116:119], v[224:227]
buffer_load_dwordx4 a[52:55], v1, s[4:7], s22 offen offset:1024 sc1
v_mfma_f32_16x16x32_bf16 v[228:231], a[100:103], v[124:127], v[228:231]
buffer_load_dwordx4 a[56:59], v1, s[4:7], s22 offen offset:2048 sc1
v_mfma_f32_16x16x32_bf16 v[228:231], a[96:99], v[120:123], v[228:231]
s_waitcnt lgkmcnt(5)
buffer_load_dwordx4 a[60:63], v1, s[4:7], s22 offen offset:3072 sc1
v_mfma_f32_16x16x32_bf16 v[232:235], a[104:107], v[112:115], v[232:235]
s_waitcnt lgkmcnt(4)
v_mfma_f32_16x16x32_bf16 v[232:235], a[108:111], v[116:119], v[232:235]
v_mfma_f32_16x16x32_bf16 v[236:239], a[108:111], v[124:127], v[236:239]
v_mfma_f32_16x16x32_bf16 v[236:239], a[104:107], v[120:123], v[236:239]
s_waitcnt lgkmcnt(3)
v_mfma_f32_16x16x32_bf16 v[240:243], a[112:115], v[112:115], v[240:243]
s_waitcnt lgkmcnt(2)
v_mfma_f32_16x16x32_bf16 v[240:243], a[116:119], v[116:119], v[240:243]
v_mfma_f32_16x16x32_bf16 v[244:247], a[116:119], v[124:127], v[244:247]
v_mfma_f32_16x16x32_bf16 v[244:247], a[112:115], v[120:123], v[244:247]
s_waitcnt lgkmcnt(1)
v_mfma_f32_16x16x32_bf16 v[248:251], a[120:123], v[112:115], v[248:251]
s_waitcnt lgkmcnt(0)
v_mfma_f32_16x16x32_bf16 v[248:251], a[124:127], v[116:119], v[248:251]
v_mfma_f32_16x16x32_bf16 v[252:255], a[124:127], v[124:127], v[252:255]
v_mfma_f32_16x16x32_bf16 v[252:255], a[120:123], v[120:123], v[252:255]
v_mov_b32 v28, v24
s_nop 1
v_permlane16_swap_b32 v24, v28
v_add_f32 v24, v24, v28
v_mov_b32 v28, v24
s_nop 1
v_permlane32_swap_b32 v24, v28
v_add_f32 v24, v24, v28
v_mov_b32 v29, v25
s_nop 1
v_permlane16_swap_b32 v25, v29
v_add_f32 v25, v25, v29
v_mov_b32 v29, v25
s_nop 1
v_permlane32_swap_b32 v25, v29
v_add_f32 v25, v25, v29
s_lshl_b32 s26, s27, 2
s_add_u32 s26, s26, s3
s_lshl_b32 s27, s26, 10
s_add_u32 s27, s27, 75497472
s_lshl_b32 s26, s26, 14
s_add_u32 s26, s26, 67108864
v_rcp_f32 v3, v24
v_rcp_f32 v4, v25
v_mov_b32 v8, v16
v_mov_b32 v9, v24
v_mov_b32 v10, v20
v_mov_b32 v11, v25
buffer_store_dwordx4 v[8:11], v1, s[4:7], s27 offen sc1
v_mov_b32 v28, v3
v_mov_b32 v29, v3
s_add_u32 s22, s26, 0
v_pk_mul_f32 v[128:129], v[128:129], v[28:29]
v_pk_mul_f32 v[130:131], v[130:131], v[28:29]
v_pk_mul_f32 v[136:137], v[136:137], v[28:29]
v_pk_mul_f32 v[138:139], v[138:139], v[28:29]
v_cvt_pk_bf16_f32 v128, v128, v129
v_cvt_pk_bf16_f32 v129, v130, v131
v_cvt_pk_bf16_f32 v130, v136, v137
v_cvt_pk_bf16_f32 v131, v138, v139
buffer_store_dwordx4 v[128:131], v1, s[4:7], s22 offen offset:0 sc1
v_pk_mul_f32 v[144:145], v[144:145], v[28:29]
v_pk_mul_f32 v[146:147], v[146:147], v[28:29]
v_pk_mul_f32 v[152:153], v[152:153], v[28:29]
v_pk_mul_f32 v[154:155], v[154:155], v[28:29]
v_cvt_pk_bf16_f32 v144, v144, v145
v_cvt_pk_bf16_f32 v145, v146, v147
v_cvt_pk_bf16_f32 v146, v152, v153
v_cvt_pk_bf16_f32 v147, v154, v155
buffer_store_dwordx4 v[144:147], v1, s[4:7], s22 offen offset:1024 sc1
v_pk_mul_f32 v[160:161], v[160:161], v[28:29]
v_pk_mul_f32 v[162:163], v[162:163], v[28:29]
v_pk_mul_f32 v[168:169], v[168:169], v[28:29]
v_pk_mul_f32 v[170:171], v[170:171], v[28:29]
v_cvt_pk_bf16_f32 v160, v160, v161
v_cvt_pk_bf16_f32 v161, v162, v163
v_cvt_pk_bf16_f32 v162, v168, v169
v_cvt_pk_bf16_f32 v163, v170, v171
buffer_store_dwordx4 v[160:163], v1, s[4:7], s22 offen offset:2048 sc1
v_pk_mul_f32 v[176:177], v[176:177], v[28:29]
v_pk_mul_f32 v[178:179], v[178:179], v[28:29]
v_pk_mul_f32 v[184:185], v[184:185], v[28:29]
v_pk_mul_f32 v[186:187], v[186:187], v[28:29]
v_cvt_pk_bf16_f32 v176, v176, v177
v_cvt_pk_bf16_f32 v177, v178, v179
v_cvt_pk_bf16_f32 v178, v184, v185
v_cvt_pk_bf16_f32 v179, v186, v187
buffer_store_dwordx4 v[176:179], v1, s[4:7], s22 offen offset:3072 sc1
s_add_u32 s22, s26, 4096
v_pk_mul_f32 v[192:193], v[192:193], v[28:29]
v_pk_mul_f32 v[194:195], v[194:195], v[28:29]
v_pk_mul_f32 v[200:201], v[200:201], v[28:29]
v_pk_mul_f32 v[202:203], v[202:203], v[28:29]
v_cvt_pk_bf16_f32 v192, v192, v193
v_cvt_pk_bf16_f32 v193, v194, v195
v_cvt_pk_bf16_f32 v194, v200, v201
v_cvt_pk_bf16_f32 v195, v202, v203
buffer_store_dwordx4 v[192:195], v1, s[4:7], s22 offen offset:0 sc1
v_pk_mul_f32 v[208:209], v[208:209], v[28:29]
v_pk_mul_f32 v[210:211], v[210:211], v[28:29]
v_pk_mul_f32 v[216:217], v[216:217], v[28:29]
v_pk_mul_f32 v[218:219], v[218:219], v[28:29]
v_cvt_pk_bf16_f32 v208, v208, v209
v_cvt_pk_bf16_f32 v209, v210, v211
v_cvt_pk_bf16_f32 v210, v216, v217
v_cvt_pk_bf16_f32 v211, v218, v219
buffer_store_dwordx4 v[208:211], v1, s[4:7], s22 offen offset:1024 sc1
v_pk_mul_f32 v[224:225], v[224:225], v[28:29]
v_pk_mul_f32 v[226:227], v[226:227], v[28:29]
v_pk_mul_f32 v[232:233], v[232:233], v[28:29]
v_pk_mul_f32 v[234:235], v[234:235], v[28:29]
v_cvt_pk_bf16_f32 v224, v224, v225
v_cvt_pk_bf16_f32 v225, v226, v227
v_cvt_pk_bf16_f32 v226, v232, v233
v_cvt_pk_bf16_f32 v227, v234, v235
buffer_store_dwordx4 v[224:227], v1, s[4:7], s22 offen offset:2048 sc1
v_pk_mul_f32 v[240:241], v[240:241], v[28:29]
v_pk_mul_f32 v[242:243], v[242:243], v[28:29]
v_pk_mul_f32 v[248:249], v[248:249], v[28:29]
v_pk_mul_f32 v[250:251], v[250:251], v[28:29]
v_cvt_pk_bf16_f32 v240, v240, v241
v_cvt_pk_bf16_f32 v241, v242, v243
v_cvt_pk_bf16_f32 v242, v248, v249
v_cvt_pk_bf16_f32 v243, v250, v251
buffer_store_dwordx4 v[240:243], v1, s[4:7], s22 offen offset:3072 sc1
v_mov_b32 v28, v4
v_mov_b32 v29, v4
s_add_u32 s22, s26, 8192
v_pk_mul_f32 v[132:133], v[132:133], v[28:29]
v_pk_mul_f32 v[134:135], v[134:135], v[28:29]
v_pk_mul_f32 v[140:141], v[140:141], v[28:29]
v_pk_mul_f32 v[142:143], v[142:143], v[28:29]
v_cvt_pk_bf16_f32 v132, v132, v133
v_cvt_pk_bf16_f32 v133, v134, v135
v_cvt_pk_bf16_f32 v134, v140, v141
v_cvt_pk_bf16_f32 v135, v142, v143
buffer_store_dwordx4 v[132:135], v1, s[4:7], s22 offen offset:0 sc1
v_pk_mul_f32 v[148:149], v[148:149], v[28:29]
v_pk_mul_f32 v[150:151], v[150:151], v[28:29]
v_pk_mul_f32 v[156:157], v[156:157], v[28:29]
v_pk_mul_f32 v[158:159], v[158:159], v[28:29]
v_cvt_pk_bf16_f32 v148, v148, v149
v_cvt_pk_bf16_f32 v149, v150, v151
v_cvt_pk_bf16_f32 v150, v156, v157
v_cvt_pk_bf16_f32 v151, v158, v159
buffer_store_dwordx4 v[148:151], v1, s[4:7], s22 offen offset:1024 sc1
v_pk_mul_f32 v[164:165], v[164:165], v[28:29]
v_pk_mul_f32 v[166:167], v[166:167], v[28:29]
v_pk_mul_f32 v[172:173], v[172:173], v[28:29]
v_pk_mul_f32 v[174:175], v[174:175], v[28:29]
v_cvt_pk_bf16_f32 v164, v164, v165
v_cvt_pk_bf16_f32 v165, v166, v167
v_cvt_pk_bf16_f32 v166, v172, v173
v_cvt_pk_bf16_f32 v167, v174, v175
buffer_store_dwordx4 v[164:167], v1, s[4:7], s22 offen offset:2048 sc1
v_pk_mul_f32 v[180:181], v[180:181], v[28:29]
v_pk_mul_f32 v[182:183], v[182:183], v[28:29]
v_pk_mul_f32 v[188:189], v[188:189], v[28:29]
v_pk_mul_f32 v[190:191], v[190:191], v[28:29]
v_cvt_pk_bf16_f32 v180, v180, v181
v_cvt_pk_bf16_f32 v181, v182, v183
v_cvt_pk_bf16_f32 v182, v188, v189
v_cvt_pk_bf16_f32 v183, v190, v191
buffer_store_dwordx4 v[180:183], v1, s[4:7], s22 offen offset:3072 sc1
s_add_u32 s22, s26, 12288
v_pk_mul_f32 v[196:197], v[196:197], v[28:29]
v_pk_mul_f32 v[198:199], v[198:199], v[28:29]
v_pk_mul_f32 v[204:205], v[204:205], v[28:29]
v_pk_mul_f32 v[206:207], v[206:207], v[28:29]
v_cvt_pk_bf16_f32 v196, v196, v197
v_cvt_pk_bf16_f32 v197, v198, v199
v_cvt_pk_bf16_f32 v198, v204, v205
v_cvt_pk_bf16_f32 v199, v206, v207
buffer_store_dwordx4 v[196:199], v1, s[4:7], s22 offen offset:0 sc1
v_pk_mul_f32 v[212:213], v[212:213], v[28:29]
v_pk_mul_f32 v[214:215], v[214:215], v[28:29]
v_pk_mul_f32 v[220:221], v[220:221], v[28:29]
v_pk_mul_f32 v[222:223], v[222:223], v[28:29]
v_cvt_pk_bf16_f32 v212, v212, v213
v_cvt_pk_bf16_f32 v213, v214, v215
v_cvt_pk_bf16_f32 v214, v220, v221
v_cvt_pk_bf16_f32 v215, v222, v223
buffer_store_dwordx4 v[212:215], v1, s[4:7], s22 offen offset:1024 sc1
v_pk_mul_f32 v[228:229], v[228:229], v[28:29]
v_pk_mul_f32 v[230:231], v[230:231], v[28:29]
v_pk_mul_f32 v[236:237], v[236:237], v[28:29]
v_pk_mul_f32 v[238:239], v[238:239], v[28:29]
v_cvt_pk_bf16_f32 v228, v228, v229
v_cvt_pk_bf16_f32 v229, v230, v231
v_cvt_pk_bf16_f32 v230, v236, v237
v_cvt_pk_bf16_f32 v231, v238, v239
buffer_store_dwordx4 v[228:231], v1, s[4:7], s22 offen offset:2048 sc1
v_pk_mul_f32 v[244:245], v[244:245], v[28:29]
v_pk_mul_f32 v[246:247], v[246:247], v[28:29]
v_pk_mul_f32 v[252:253], v[252:253], v[28:29]
v_pk_mul_f32 v[254:255], v[254:255], v[28:29]
v_cvt_pk_bf16_f32 v244, v244, v245
v_cvt_pk_bf16_f32 v245, v246, v247
v_cvt_pk_bf16_f32 v246, v252, v253
v_cvt_pk_bf16_f32 v247, v254, v255
buffer_store_dwordx4 v[244:247], v1, s[4:7], s22 offen offset:3072 sc1
s_mov_b32 s24, 0
s_mov_b32 s29, s21
s_mov_b32 s19, s21
v_mov_b32 v128, 0
v_mov_b32 v129, 0
v_mov_b32 v130, 0
v_mov_b32 v131, 0
v_mov_b32 v132, 0
v_mov_b32 v133, 0
v_mov_b32 v134, 0
v_mov_b32 v135, 0
v_mov_b32 v136, 0
v_mov_b32 v137, 0
v_mov_b32 v138, 0
v_mov_b32 v139, 0
v_mov_b32 v140, 0
v_mov_b32 v141, 0
v_mov_b32 v142, 0
v_mov_b32 v143, 0
v_mov_b32 v144, 0
v_mov_b32 v145, 0
v_mov_b32 v146, 0
v_mov_b32 v147, 0
v_mov_b32 v148, 0
v_mov_b32 v149, 0
v_mov_b32 v150, 0
v_mov_b32 v151, 0
v_mov_b32 v152, 0
v_mov_b32 v153, 0
v_mov_b32 v154, 0
v_mov_b32 v155, 0
v_mov_b32 v156, 0
v_mov_b32 v157, 0
v_mov_b32 v158, 0
v_mov_b32 v159, 0
v_mov_b32 v160, 0
v_mov_b32 v161, 0
v_mov_b32 v162, 0
v_mov_b32 v163, 0
v_mov_b32 v164, 0
v_mov_b32 v165, 0
v_mov_b32 v166, 0
v_mov_b32 v167, 0
v_mov_b32 v168, 0
v_mov_b32 v169, 0
v_mov_b32 v170, 0
v_mov_b32 v171, 0
v_mov_b32 v172, 0
v_mov_b32 v173, 0
v_mov_b32 v174, 0
v_mov_b32 v175, 0
v_mov_b32 v176, 0
v_mov_b32 v177, 0
v_mov_b32 v178, 0
v_mov_b32 v179, 0
v_mov_b32 v180, 0
v_mov_b32 v181, 0
v_mov_b32 v182, 0
v_mov_b32 v183, 0
v_mov_b32 v184, 0
v_mov_b32 v185, 0
v_mov_b32 v186, 0
v_mov_b32 v187, 0
v_mov_b32 v188, 0
v_mov_b32 v189, 0
v_mov_b32 v190, 0
v_mov_b32 v191, 0
v_mov_b32 v192, 0
v_mov_b32 v193, 0
v_mov_b32 v194, 0
v_mov_b32 v195, 0
v_mov_b32 v196, 0
v_mov_b32 v197, 0
v_mov_b32 v198, 0
v_mov_b32 v199, 0
v_mov_b32 v200, 0
v_mov_b32 v201, 0
v_mov_b32 v202, 0
v_mov_b32 v203, 0
v_mov_b32 v204, 0
v_mov_b32 v205, 0
v_mov_b32 v206, 0
v_mov_b32 v207, 0
v_mov_b32 v208, 0
v_mov_b32 v209, 0
v_mov_b32 v210, 0
v_mov_b32 v211, 0
v_mov_b32 v212, 0
v_mov_b32 v213, 0
v_mov_b32 v214, 0
v_mov_b32 v215, 0
v_mov_b32 v216, 0
v_mov_b32 v217, 0
v_mov_b32 v218, 0
v_mov_b32 v219, 0
v_mov_b32 v220, 0
v_mov_b32 v221, 0
v_mov_b32 v222, 0
v_mov_b32 v223, 0
v_mov_b32 v224, 0
v_mov_b32 v225, 0
v_mov_b32 v226, 0
v_mov_b32 v227, 0
v_mov_b32 v228, 0
v_mov_b32 v229, 0
v_mov_b32 v230, 0
v_mov_b32 v231, 0
v_mov_b32 v232, 0
v_mov_b32 v233, 0
v_mov_b32 v234, 0
v_mov_b32 v235, 0
v_mov_b32 v236, 0
v_mov_b32 v237, 0
v_mov_b32 v238, 0
v_mov_b32 v239, 0
v_mov_b32 v240, 0
v_mov_b32 v241, 0
v_mov_b32 v242, 0
v_mov_b32 v243, 0
v_mov_b32 v244, 0
v_mov_b32 v245, 0
v_mov_b32 v246, 0
v_mov_b32 v247, 0
v_mov_b32 v248, 0
v_mov_b32 v249, 0
v_mov_b32 v250, 0
v_mov_b32 v251, 0
v_mov_b32 v252, 0
v_mov_b32 v253, 0
v_mov_b32 v254, 0
v_mov_b32 v255, 0
v_mov_b32 v24, 0
v_mov_b32 v25, 0
s_waitcnt vmcnt(0)
s_barrier
buffer_store_dword v6, v5, s[4:7], s28 offen sc1
s_add_u32 m0, s18, 65536
s_nop 0
buffer_load_dwordx4 v1, s[4:7], s12 offen offset:0 sc1 lds
buffer_load_dwordx4 v1, s[4:7], s12 offen offset:1024 sc1 lds
buffer_load_dwordx4 v1, s[4:7], s12 offen offset:2048 sc1 lds
buffer_load_dwordx4 v1, s[4:7], s12 offen offset:3072 sc1 lds
s_add_u32 s12, s12, 4096
s_add_u32 m0, s18, 69632
s_nop 0
buffer_load_dwordx4 v1, s[4:7], s12 offen offset:0 sc1 lds
buffer_load_dwordx4 v1, s[4:7], s12 offen offset:1024 sc1 lds
buffer_load_dwordx4 v1, s[4:7], s12 offen offset:2048 sc1 lds
buffer_load_dwordx4 v1, s[4:7], s12 offen offset:3072 sc1 lds
s_add_u32 s12, s12, 28672
s_sub_u32 s13, s13, 1
s_cmp_eq_u32 s13, 0
s_cselect_b32 s12, s14, s12
s_cselect_b32 s13, s15, s13
s_cselect_b32 s14, 3221225472, s14
s_branch K2_item
Lstub_3:
s_call_b64 s[16:17], K2_slow1
s_branch Lback_4
Lstub_5:
s_call_b64 s[16:17], K2_slow0
s_branch Lback_6
Lstub_7:
s_call_b64 s[16:17], K2_slow1
s_branch Lback_8
Lstub_9:
s_call_b64 s[16:17], K2_slow0
s_branch Lback_10
Lstub_11:
s_call_b64 s[16:17], K2_slow1
s_branch Lback_12
Lstub_13:
s_call_b64 s[16:17], K2_slow1
s_branch Lback_14
K2_slow0:
s_nop 7
s_nop 7
v_max3_f32 v28, v32, v33, 0
v_max3_f32 v28, v34, v35, v28
v_max3_f32 v28, v40, v41, v28
v_max3_f32 v28, v42, v43, v28
v_max3_f32 v28, v48, v49, v28
v_max3_f32 v28, v50, v51, v28
v_max3_f32 v28, v56, v57, v28
v_max3_f32 v28, v58, v59, v28
v_mov_b32 v29, v28
s_nop 1
v_permlane16_swap_b32 v28, v29
v_max_f32 v28, v28, v29
v_mov_b32 v29, v28
s_nop 1
v_permlane32_swap_b32 v28, v29
v_max_f32 v28, v28, v29
v_exp_f32 v29, -v28
v_sub_f32 v16, v16, v28
v_sub_f32 v17, v17, v28
v_sub_f32 v18, v18, v28
v_sub_f32 v19, v19, v28
v_mul_f32 v24, v24, v29
v_mul_f32 v128, v128, v29
v_mul_f32 v129, v129, v29
v_mul_f32 v130, v130, v29
v_mul_f32 v131, v131, v29
v_mul_f32 v136, v136, v29
v_mul_f32 v137, v137, v29
v_mul_f32 v138, v138, v29
v_mul_f32 v139, v139, v29
v_mul_f32 v144, v144, v29
v_mul_f32 v145, v145, v29
v_mul_f32 v146, v146, v29
v_mul_f32 v147, v147, v29
v_mul_f32 v152, v152, v29
v_mul_f32 v153, v153, v29
v_mul_f32 v154, v154, v29
v_mul_f32 v155, v155, v29
v_mul_f32 v160, v160, v29
v_mul_f32 v161, v161, v29
v_mul_f32 v162, v162, v29
v_mul_f32 v163, v163, v29
v_mul_f32 v168, v168, v29
v_mul_f32 v169, v169, v29
v_mul_f32 v170, v170, v29
v_mul_f32 v171, v171, v29
v_mul_f32 v176, v176, v29
v_mul_f32 v177, v177, v29
v_mul_f32 v178, v178, v29
v_mul_f32 v179, v179, v29
v_mul_f32 v184, v184, v29
v_mul_f32 v185, v185, v29
v_mul_f32 v186, v186, v29
v_mul_f32 v187, v187, v29
v_mul_f32 v192, v192, v29
v_mul_f32 v193, v193, v29
v_mul_f32 v194, v194, v29
v_mul_f32 v195, v195, v29
v_mul_f32 v200, v200, v29
v_mul_f32 v201, v201, v29
v_mul_f32 v202, v202, v29
v_mul_f32 v203, v203, v29
v_mul_f32 v208, v208, v29
v_mul_f32 v209, v209, v29
v_mul_f32 v210, v210, v29
v_mul_f32 v211, v211, v29
v_mul_f32 v216, v216, v29
v_mul_f32 v217, v217, v29
v_mul_f32 v218, v218, v29
v_mul_f32 v219, v219, v29
v_mul_f32 v224, v224, v29
v_mul_f32 v225, v225, v29
v_mul_f32 v226, v226, v29
v_mul_f32 v227, v227, v29
v_mul_f32 v232, v232, v29
v_mul_f32 v233, v233, v29
v_mul_f32 v234, v234, v29
v_mul_f32 v235, v235, v29
v_mul_f32 v240, v240, v29
v_mul_f32 v241, v241, v29
v_mul_f32 v242, v242, v29
v_mul_f32 v243, v243, v29
v_mul_f32 v248, v248, v29
v_mul_f32 v249, v249, v29
v_mul_f32 v250, v250, v29
v_mul_f32 v251, v251, v29
v_sub_f32 v32, v32, v28
v_sub_f32 v33, v33, v28
v_sub_f32 v34, v34, v28
v_sub_f32 v35, v35, v28
v_sub_f32 v40, v40, v28
v_sub_f32 v41, v41, v28
v_sub_f32 v42, v42, v28
v_sub_f32 v43, v43, v28
v_sub_f32 v48, v48, v28
v_sub_f32 v49, v49, v28
v_sub_f32 v50, v50, v28
v_sub_f32 v51, v51, v28
v_sub_f32 v56, v56, v28
v_sub_f32 v57, v57, v28
v_sub_f32 v58, v58, v28
v_sub_f32 v59, v59, v28
v_sub_f32 v64, v64, v28
v_sub_f32 v65, v65, v28
v_sub_f32 v66, v66, v28
v_sub_f32 v67, v67, v28
v_sub_f32 v72, v72, v28
v_sub_f32 v73, v73, v28
v_sub_f32 v74, v74, v28
v_sub_f32 v75, v75, v28
v_sub_f32 v80, v80, v28
v_sub_f32 v81, v81, v28
v_sub_f32 v82, v82, v28
v_sub_f32 v83, v83, v28
v_sub_f32 v88, v88, v28
v_sub_f32 v89, v89, v28
v_sub_f32 v90, v90, v28
v_sub_f32 v91, v91, v28
v_max3_f32 v28, v36, v37, 0
v_max3_f32 v28, v38, v39, v28
v_max3_f32 v28, v44, v45, v28
v_max3_f32 v28, v46, v47, v28
v_max3_f32 v28, v52, v53, v28
v_max3_f32 v28, v54, v55, v28
v_max3_f32 v28, v60, v61, v28
v_max3_f32 v28, v62, v63, v28
v_mov_b32 v29, v28
s_nop 1
v_permlane16_swap_b32 v28, v29
v_max_f32 v28, v28, v29
v_mov_b32 v29, v28
s_nop 1
v_permlane32_swap_b32 v28, v29
v_max_f32 v28, v28, v29
v_exp_f32 v29, -v28
v_sub_f32 v20, v20, v28
v_sub_f32 v21, v21, v28
v_sub_f32 v22, v22, v28
v_sub_f32 v23, v23, v28
v_mul_f32 v25, v25, v29
v_mul_f32 v132, v132, v29
v_mul_f32 v133, v133, v29
v_mul_f32 v134, v134, v29
v_mul_f32 v135, v135, v29
v_mul_f32 v140, v140, v29
v_mul_f32 v141, v141, v29
v_mul_f32 v142, v142, v29
v_mul_f32 v143, v143, v29
v_mul_f32 v148, v148, v29
v_mul_f32 v149, v149, v29
v_mul_f32 v150, v150, v29
v_mul_f32 v151, v151, v29
v_mul_f32 v156, v156, v29
v_mul_f32 v157, v157, v29
v_mul_f32 v158, v158, v29
v_mul_f32 v159, v159, v29
v_mul_f32 v164, v164, v29
v_mul_f32 v165, v165, v29
v_mul_f32 v166, v166, v29
v_mul_f32 v167, v167, v29
v_mul_f32 v172, v172, v29
v_mul_f32 v173, v173, v29
v_mul_f32 v174, v174, v29
v_mul_f32 v175, v175, v29
v_mul_f32 v180, v180, v29
v_mul_f32 v181, v181, v29
v_mul_f32 v182, v182, v29
v_mul_f32 v183, v183, v29
v_mul_f32 v188, v188, v29
v_mul_f32 v189, v189, v29
v_mul_f32 v190, v190, v29
v_mul_f32 v191, v191, v29
v_mul_f32 v196, v196, v29
v_mul_f32 v197, v197, v29
v_mul_f32 v198, v198, v29
v_mul_f32 v199, v199, v29
v_mul_f32 v204, v204, v29
v_mul_f32 v205, v205, v29
v_mul_f32 v206, v206, v29
v_mul_f32 v207, v207, v29
v_mul_f32 v212, v212, v29
v_mul_f32 v213, v213, v29
v_mul_f32 v214, v214, v29
v_mul_f32 v215, v215, v29
v_mul_f32 v220, v220, v29
v_mul_f32 v221, v221, v29
v_mul_f32 v222, v222, v29
v_mul_f32 v223, v223, v29
v_mul_f32 v228, v228, v29
v_mul_f32 v229, v229, v29
v_mul_f32 v230, v230, v29
v_mul_f32 v231, v231, v29
v_mul_f32 v236, v236, v29
v_mul_f32 v237, v237, v29
v_mul_f32 v238, v238, v29
v_mul_f32 v239, v239, v29
v_mul_f32 v244, v244, v29
v_mul_f32 v245, v245, v29
v_mul_f32 v246, v246, v29
v_mul_f32 v247, v247, v29
v_mul_f32 v252, v252, v29
v_mul_f32 v253, v253, v29
v_mul_f32 v254, v254, v29
v_mul_f32 v255, v255, v29
v_sub_f32 v36, v36, v28
v_sub_f32 v37, v37, v28
v_sub_f32 v38, v38, v28
v_sub_f32 v39, v39, v28
v_sub_f32 v44, v44, v28
v_sub_f32 v45, v45, v28
v_sub_f32 v46, v46, v28
v_sub_f32 v47, v47, v28
v_sub_f32 v52, v52, v28
v_sub_f32 v53, v53, v28
v_sub_f32 v54, v54, v28
v_sub_f32 v55, v55, v28
v_sub_f32 v60, v60, v28
v_sub_f32 v61, v61, v28
v_sub_f32 v62, v62, v28
v_sub_f32 v63, v63, v28
v_sub_f32 v68, v68, v28
v_sub_f32 v69, v69, v28
v_sub_f32 v70, v70, v28
v_sub_f32 v71, v71, v28
v_sub_f32 v76, v76, v28
v_sub_f32 v77, v77, v28
v_sub_f32 v78, v78, v28
v_sub_f32 v79, v79, v28
v_sub_f32 v84, v84, v28
v_sub_f32 v85, v85, v28
v_sub_f32 v86, v86, v28
v_sub_f32 v87, v87, v28
v_sub_f32 v92, v92, v28
v_sub_f32 v93, v93, v28
v_sub_f32 v94, v94, v28
v_sub_f32 v95, v95, v28
v_exp_f32 v8, v32
v_exp_f32 v9, v33
v_exp_f32 v10, v34
v_exp_f32 v11, v35
s_nop 0
v_add_f32 v26, v8, v9
v_cvt_pk_bf16_f32 v96, v8, v9
v_add_f32 v26, v26, v10
v_add_f32 v26, v26, v11
v_cvt_pk_bf16_f32 v97, v10, v11
v_exp_f32 v12, v36
v_exp_f32 v13, v37
v_exp_f32 v14, v38
v_exp_f32 v15, v39
s_nop 0
v_add_f32 v27, v12, v13
v_cvt_pk_bf16_f32 v104, v12, v13
v_add_f32 v27, v27, v14
v_add_f32 v27, v27, v15
v_cvt_pk_bf16_f32 v105, v14, v15
v_exp_f32 v8, v40
v_exp_f32 v9, v41
v_exp_f32 v10, v42
v_exp_f32 v11, v43
s_nop 0
v_add_f32 v26, v26, v8
v_add_f32 v26, v26, v9
v_cvt_pk_bf16_f32 v98, v8, v9
v_add_f32 v26, v26, v10
v_add_f32 v26, v26, v11
v_cvt_pk_bf16_f32 v99, v10, v11
v_exp_f32 v12, v44
v_exp_f32 v13, v45
v_exp_f32 v14, v46
v_exp_f32 v15, v47
s_nop 0
v_add_f32 v27, v27, v12
v_add_f32 v27, v27, v13
v_cvt_pk_bf16_f32 v106, v12, v13
v_add_f32 v27, v27, v14
v_add_f32 v27, v27, v15
v_cvt_pk_bf16_f32 v107, v14, v15
v_exp_f32 v8, v48
v_exp_f32 v9, v49
v_exp_f32 v10, v50
v_exp_f32 v11, v51
s_nop 0
v_add_f32 v26, v26, v8
v_add_f32 v26, v26, v9
v_cvt_pk_bf16_f32 v100, v8, v9
v_add_f32 v26, v26, v10
v_add_f32 v26, v26, v11
v_cvt_pk_bf16_f32 v101, v10, v11
v_exp_f32 v12, v52
v_exp_f32 v13, v53
v_exp_f32 v14, v54
v_exp_f32 v15, v55
s_nop 0
v_add_f32 v27, v27, v12
v_add_f32 v27, v27, v13
v_cvt_pk_bf16_f32 v108, v12, v13
v_add_f32 v27, v27, v14
v_add_f32 v27, v27, v15
v_cvt_pk_bf16_f32 v109, v14, v15
v_exp_f32 v8, v56
v_exp_f32 v9, v57
v_exp_f32 v10, v58
v_exp_f32 v11, v59
s_nop 0
v_add_f32 v26, v26, v8
v_add_f32 v26, v26, v9
v_cvt_pk_bf16_f32 v102, v8, v9
v_add_f32 v26, v26, v10
v_add_f32 v26, v26, v11
v_cvt_pk_bf16_f32 v103, v10, v11
v_exp_f32 v12, v60
v_exp_f32 v13, v61
v_exp_f32 v14, v62
v_exp_f32 v15, v63
s_nop 0
v_add_f32 v27, v27, v12
v_add_f32 v27, v27, v13
v_cvt_pk_bf16_f32 v110, v12, v13
v_add_f32 v27, v27, v14
v_add_f32 v27, v27, v15
v_cvt_pk_bf16_f32 v111, v14, v15
s_nop 1
s_setpc_b64 s[16:17]
K2_slow1:
s_nop 7
s_nop 7
v_max3_f32 v28, v64, v65, 0
v_max3_f32 v28, v66, v67, v28
v_max3_f32 v28, v72, v73, v28
v_max3_f32 v28, v74, v75, v28
v_max3_f32 v28, v80, v81, v28
v_max3_f32 v28, v82, v83, v28
v_max3_f32 v28, v88, v89, v28
v_max3_f32 v28, v90, v91, v28
v_mov_b32 v29, v28
s_nop 1
v_permlane16_swap_b32 v28, v29
v_max_f32 v28, v28, v29
v_mov_b32 v29, v28
s_nop 1
v_permlane32_swap_b32 v28, v29
v_max_f32 v28, v28, v29
v_exp_f32 v29, -v28
v_sub_f32 v16, v16, v28
v_sub_f32 v17, v17, v28
v_sub_f32 v18, v18, v28
v_sub_f32 v19, v19, v28
v_mul_f32 v24, v24, v29
v_mul_f32 v128, v128, v29
v_mul_f32 v129, v129, v29
v_mul_f32 v130, v130, v29
v_mul_f32 v131, v131, v29
v_mul_f32 v136, v136, v29
v_mul_f32 v137, v137, v29
v_mul_f32 v138, v138, v29
v_mul_f32 v139, v139, v29
v_mul_f32 v144, v144, v29
v_mul_f32 v145, v145, v29
v_mul_f32 v146, v146, v29
v_mul_f32 v147, v147, v29
v_mul_f32 v152, v152, v29
v_mul_f32 v153, v153, v29
v_mul_f32 v154, v154, v29
v_mul_f32 v155, v155, v29
v_mul_f32 v160, v160, v29
v_mul_f32 v161, v161, v29
v_mul_f32 v162, v162, v29
v_mul_f32 v163, v163, v29
v_mul_f32 v168, v168, v29
v_mul_f32 v169, v169, v29
v_mul_f32 v170, v170, v29
v_mul_f32 v171, v171, v29
v_mul_f32 v176, v176, v29
v_mul_f32 v177, v177, v29
v_mul_f32 v178, v178, v29
v_mul_f32 v179, v179, v29
v_mul_f32 v184, v184, v29
v_mul_f32 v185, v185, v29
v_mul_f32 v186, v186, v29
v_mul_f32 v187, v187, v29
v_mul_f32 v192, v192, v29
v_mul_f32 v193, v193, v29
v_mul_f32 v194, v194, v29
v_mul_f32 v195, v195, v29
v_mul_f32 v200, v200, v29
v_mul_f32 v201, v201, v29
v_mul_f32 v202, v202, v29
v_mul_f32 v203, v203, v29
v_mul_f32 v208, v208, v29
v_mul_f32 v209, v209, v29
v_mul_f32 v210, v210, v29
v_mul_f32 v211, v211, v29
v_mul_f32 v216, v216, v29
v_mul_f32 v217, v217, v29
v_mul_f32 v218, v218, v29
v_mul_f32 v219, v219, v29
v_mul_f32 v224, v224, v29
v_mul_f32 v225, v225, v29
v_mul_f32 v226, v226, v29
v_mul_f32 v227, v227, v29
v_mul_f32 v232, v232, v29
v_mul_f32 v233, v233, v29
v_mul_f32 v234, v234, v29
v_mul_f32 v235, v235, v29
v_mul_f32 v240, v240, v29
v_mul_f32 v241, v241, v29
v_mul_f32 v242, v242, v29
v_mul_f32 v243, v243, v29
v_mul_f32 v248, v248, v29
v_mul_f32 v249, v249, v29
v_mul_f32 v250, v250, v29
v_mul_f32 v251, v251, v29
v_sub_f32 v32, v32, v28
v_sub_f32 v33, v33, v28
v_sub_f32 v34, v34, v28
v_sub_f32 v35, v35, v28
v_sub_f32 v40, v40, v28
v_sub_f32 v41, v41, v28
v_sub_f32 v42, v42, v28
v_sub_f32 v43, v43, v28
v_sub_f32 v48, v48, v28
v_sub_f32 v49, v49, v28
v_sub_f32 v50, v50, v28
v_sub_f32 v51, v51, v28
v_sub_f32 v56, v56, v28
v_sub_f32 v57, v57, v28
v_sub_f32 v58, v58, v28
v_sub_f32 v59, v59, v28
v_sub_f32 v64, v64, v28
v_sub_f32 v65, v65, v28
v_sub_f32 v66, v66, v28
v_sub_f32 v67, v67, v28
v_sub_f32 v72, v72, v28
v_sub_f32 v73, v73, v28
v_sub_f32 v74, v74, v28
v_sub_f32 v75, v75, v28
v_sub_f32 v80, v80, v28
v_sub_f32 v81, v81, v28
v_sub_f32 v82, v82, v28
v_sub_f32 v83, v83, v28
v_sub_f32 v88, v88, v28
v_sub_f32 v89, v89, v28
v_sub_f32 v90, v90, v28
v_sub_f32 v91, v91, v28
v_max3_f32 v28, v68, v69, 0
v_max3_f32 v28, v70, v71, v28
v_max3_f32 v28, v76, v77, v28
v_max3_f32 v28, v78, v79, v28
v_max3_f32 v28, v84, v85, v28
v_max3_f32 v28, v86, v87, v28
v_max3_f32 v28, v92, v93, v28
v_max3_f32 v28, v94, v95, v28
v_mov_b32 v29, v28
s_nop 1
v_permlane16_swap_b32 v28, v29
v_max_f32 v28, v28, v29
v_mov_b32 v29, v28
s_nop 1
v_permlane32_swap_b32 v28, v29
v_max_f32 v28, v28, v29
v_exp_f32 v29, -v28
v_sub_f32 v20, v20, v28
v_sub_f32 v21, v21, v28
v_sub_f32 v22, v22, v28
v_sub_f32 v23, v23, v28
v_mul_f32 v25, v25, v29
v_mul_f32 v132, v132, v29
v_mul_f32 v133, v133, v29
v_mul_f32 v134, v134, v29
v_mul_f32 v135, v135, v29
v_mul_f32 v140, v140, v29
v_mul_f32 v141, v141, v29
v_mul_f32 v142, v142, v29
v_mul_f32 v143, v143, v29
v_mul_f32 v148, v148, v29
v_mul_f32 v149, v149, v29
v_mul_f32 v150, v150, v29
v_mul_f32 v151, v151, v29
v_mul_f32 v156, v156, v29
v_mul_f32 v157, v157, v29
v_mul_f32 v158, v158, v29
v_mul_f32 v159, v159, v29
v_mul_f32 v164, v164, v29
v_mul_f32 v165, v165, v29
v_mul_f32 v166, v166, v29
v_mul_f32 v167, v167, v29
v_mul_f32 v172, v172, v29
v_mul_f32 v173, v173, v29
v_mul_f32 v174, v174, v29
v_mul_f32 v175, v175, v29
v_mul_f32 v180, v180, v29
v_mul_f32 v181, v181, v29
v_mul_f32 v182, v182, v29
v_mul_f32 v183, v183, v29
v_mul_f32 v188, v188, v29
v_mul_f32 v189, v189, v29
v_mul_f32 v190, v190, v29
v_mul_f32 v191, v191, v29
v_mul_f32 v196, v196, v29
v_mul_f32 v197, v197, v29
v_mul_f32 v198, v198, v29
v_mul_f32 v199, v199, v29
v_mul_f32 v204, v204, v29
v_mul_f32 v205, v205, v29
v_mul_f32 v206, v206, v29
v_mul_f32 v207, v207, v29
v_mul_f32 v212, v212, v29
v_mul_f32 v213, v213, v29
v_mul_f32 v214, v214, v29
v_mul_f32 v215, v215, v29
v_mul_f32 v220, v220, v29
v_mul_f32 v221, v221, v29
v_mul_f32 v222, v222, v29
v_mul_f32 v223, v223, v29
v_mul_f32 v228, v228, v29
v_mul_f32 v229, v229, v29
v_mul_f32 v230, v230, v29
v_mul_f32 v231, v231, v29
v_mul_f32 v236, v236, v29
v_mul_f32 v237, v237, v29
v_mul_f32 v238, v238, v29
v_mul_f32 v239, v239, v29
v_mul_f32 v244, v244, v29
v_mul_f32 v245, v245, v29
v_mul_f32 v246, v246, v29
v_mul_f32 v247, v247, v29
v_mul_f32 v252, v252, v29
v_mul_f32 v253, v253, v29
v_mul_f32 v254, v254, v29
v_mul_f32 v255, v255, v29
v_sub_f32 v36, v36, v28
v_sub_f32 v37, v37, v28
v_sub_f32 v38, v38, v28
v_sub_f32 v39, v39, v28
v_sub_f32 v44, v44, v28
v_sub_f32 v45, v45, v28
v_sub_f32 v46, v46, v28
v_sub_f32 v47, v47, v28
v_sub_f32 v52, v52, v28
v_sub_f32 v53, v53, v28
v_sub_f32 v54, v54, v28
v_sub_f32 v55, v55, v28
v_sub_f32 v60, v60, v28
v_sub_f32 v61, v61, v28
v_sub_f32 v62, v62, v28
v_sub_f32 v63, v63, v28
v_sub_f32 v68, v68, v28
v_sub_f32 v69, v69, v28
v_sub_f32 v70, v70, v28
v_sub_f32 v71, v71, v28
v_sub_f32 v76, v76, v28
v_sub_f32 v77, v77, v28
v_sub_f32 v78, v78, v28
v_sub_f32 v79, v79, v28
v_sub_f32 v84, v84, v28
v_sub_f32 v85, v85, v28
v_sub_f32 v86, v86, v28
v_sub_f32 v87, v87, v28
v_sub_f32 v92, v92, v28
v_sub_f32 v93, v93, v28
v_sub_f32 v94, v94, v28
v_sub_f32 v95, v95, v28
v_exp_f32 v8, v64
v_exp_f32 v9, v65
v_exp_f32 v10, v66
v_exp_f32 v11, v67
s_nop 0
v_add_f32 v26, v8, v9
v_cvt_pk_bf16_f32 v112, v8, v9
v_add_f32 v26, v26, v10
v_add_f32 v26, v26, v11
v_cvt_pk_bf16_f32 v113, v10, v11
v_exp_f32 v12, v68
v_exp_f32 v13, v69
v_exp_f32 v14, v70
v_exp_f32 v15, v71
s_nop 0
v_add_f32 v27, v12, v13
v_cvt_pk_bf16_f32 v120, v12, v13
v_add_f32 v27, v27, v14
v_add_f32 v27, v27, v15
v_cvt_pk_bf16_f32 v121, v14, v15
v_exp_f32 v8, v72
v_exp_f32 v9, v73
v_exp_f32 v10, v74
v_exp_f32 v11, v75
s_nop 0
v_add_f32 v26, v26, v8
v_add_f32 v26, v26, v9
v_cvt_pk_bf16_f32 v114, v8, v9
v_add_f32 v26, v26, v10
v_add_f32 v26, v26, v11
v_cvt_pk_bf16_f32 v115, v10, v11
v_exp_f32 v12, v76
v_exp_f32 v13, v77
v_exp_f32 v14, v78
v_exp_f32 v15, v79
s_nop 0
v_add_f32 v27, v27, v12
v_add_f32 v27, v27, v13
v_cvt_pk_bf16_f32 v122, v12, v13
v_add_f32 v27, v27, v14
v_add_f32 v27, v27, v15
v_cvt_pk_bf16_f32 v123, v14, v15
v_exp_f32 v8, v80
v_exp_f32 v9, v81
v_exp_f32 v10, v82
v_exp_f32 v11, v83
s_nop 0
v_add_f32 v26, v26, v8
v_add_f32 v26, v26, v9
v_cvt_pk_bf16_f32 v116, v8, v9
v_add_f32 v26, v26, v10
v_add_f32 v26, v26, v11
v_cvt_pk_bf16_f32 v117, v10, v11
v_exp_f32 v12, v84
v_exp_f32 v13, v85
v_exp_f32 v14, v86
v_exp_f32 v15, v87
s_nop 0
v_add_f32 v27, v27, v12
v_add_f32 v27, v27, v13
v_cvt_pk_bf16_f32 v124, v12, v13
v_add_f32 v27, v27, v14
v_add_f32 v27, v27, v15
v_cvt_pk_bf16_f32 v125, v14, v15
v_exp_f32 v8, v88
v_exp_f32 v9, v89
v_exp_f32 v10, v90
v_exp_f32 v11, v91
s_nop 0
v_add_f32 v26, v26, v8
v_add_f32 v26, v26, v9
v_cvt_pk_bf16_f32 v118, v8, v9
v_add_f32 v26, v26, v10
v_add_f32 v26, v26, v11
v_cvt_pk_bf16_f32 v119, v10, v11
v_exp_f32 v12, v92
v_exp_f32 v13, v93
v_exp_f32 v14, v94
v_exp_f32 v15, v95
s_nop 0
v_add_f32 v27, v27, v12
v_add_f32 v27, v27, v13
v_cvt_pk_bf16_f32 v126, v12, v13
v_add_f32 v27, v27, v14
v_add_f32 v27, v27, v15
v_cvt_pk_bf16_f32 v127, v14, v15
s_nop 1
s_setpc_b64 s[16:17]
M_cntspin:
v_lshrrev_b32 v29, 4, v1
v_min_u32 v29, 0, v29
v_lshlrev_b32 v29, 2, v29
LpC_1:
buffer_load_dword v28, v29, s[60:63], 0 offen sc1
s_waitcnt vmcnt(0)
v_cmp_ne_u32 vcc, 256, v28
s_cbranch_vccz LpdC_2
s_sleep 4
s_sub_u32 s101, s101, 1
s_cbranch_scc0 LpC_1
s_mov_b32 s101, 0
LpdC_2:
s_branch M_cntok
M_end:
s_endpgm
.section .rodata,"a"
.p2align 6
.amdhsa_kernel concat_heads__ssm_conv_h3__compressed_kv_cla__prompt_kernel
  .amdhsa_next_free_vgpr 512
  .amdhsa_next_free_sgpr 102
  .amdhsa_accum_offset 256
  .amdhsa_group_segment_fixed_size 0
  .amdhsa_kernarg_size 120
  .amdhsa_user_sgpr_count 2
  .amdhsa_user_sgpr_kernarg_segment_ptr 1
  .amdhsa_system_sgpr_workgroup_id_x 1
  .amdhsa_float_denorm_mode_32 3
  .amdhsa_float_denorm_mode_16_64 3
  .amdhsa_ieee_mode 0
  .amdhsa_dx10_clamp 0
.end_amdhsa_kernel
```

```asm
; @launch grid=(256,1,1) block=(256,1,1) lds=163840
.amdgcn_target "amdgcn-amd-amdhsa--gfx950"
.text
.globl concat_heads__ssm_conv_h3__compressed_kv_cla__prompt_kernel
.p2align 8
.type concat_heads__ssm_conv_h3__compressed_kv_cla__prompt_kernel,@function
concat_heads__ssm_conv_h3__compressed_kv_cla__prompt_kernel:
s_cmp_ge_u32 s2, 256
s_cbranch_scc1 M_end
s_load_dwordx16 s[64:79], s[0:1], 0
s_load_dwordx8 s[80:87], s[0:1], 64
s_load_dwordx4 s[88:91], s[0:1], 96
s_load_dwordx2 s[92:93], s[0:1], 112
v_lshrrev_b32 v28, 6, v0
v_and_b32 v29, 63, v0
v_lshlrev_b32 v1, 4, v29
v_readfirstlane_b32 s3, v28
s_and_b32 s20, s2, 7
s_lshl_b32 s20, s20, 1
s_bfe_u32 s22, s2, 0x10003
s_add_u32 s20, s20, s22
s_lshr_b32 s21, s2, 5
s_mov_b32 s101, 0x40000
v_lshrrev_b32 v26, 7, v1
v_lshrrev_b32 v27, 1, v26
v_lshlrev_b32 v27, 4, v27
v_and_b32 v28, 0x70, v1
v_xor_b32 v27, v27, v28
v_mul_u32_u24 v26, 2048, v26
v_add_u32 v12, v26, v27
v_xor_b32 v27, 64, v27
v_add_u32 v26, v26, v27
v_add_u32 v13, 15360, v26
v_add_u32 v14, 30720, v12
v_add_u32 v15, 46080, v26
v_lshrrev_b32 v26, 5, v29
v_and_b32 v27, 31, v29
s_and_b32 s22, s3, 1
s_lshl_b32 s22, s22, 2
v_or_b32 v28, s22, v26
v_lshlrev_b32 v28, 1, v28
v_xor_b32 v27, v27, v28
v_lshlrev_b32 v27, 4, v27
v_lshl_add_u32 v16, v26, 13, v27
v_xor_b32 v26, 64, v16
v_add_u32 v17, 15360, v26
v_add_u32 v18, 30720, v16
v_add_u32 v19, 46080, v26
s_lshl_b32 s28, s3, 13
s_lshl_b32 s29, s3, 12
s_lshl_b32 s24, s21, 19
s_lshl_b32 s22, s3, 17
s_add_u32 s24, s24, s22
s_add_u32 s25, s24, 65536
s_lshl_b32 s26, s3, 16
s_lshl_b32 s22, s20, 9
s_add_u32 s26, s26, s22
s_add_u32 s27, s26, 262144
s_mov_b32 s10, 4194304
s_mov_b32 s11, 0x20000
s_mov_b32 s14, 8388608
s_mov_b32 s15, 0x20000
s_bitcmp1_b32 s2, 4
s_waitcnt lgkmcnt(0)
s_mov_b64 s[8:9], s[78:79]
s_cselect_b64 s[12:13], s[84:85], s[82:83]
s_add_u32 m0, s28, 0
s_nop 0
buffer_load_dwordx4 v12, s[8:11], s24 offen offset:0 lds
buffer_load_dwordx4 v13, s[8:11], s24 offen offset:1024 lds
buffer_load_dwordx4 v14, s[8:11], s24 offen offset:2048 lds
buffer_load_dwordx4 v15, s[8:11], s24 offen offset:3072 lds
s_add_u32 s24, s24, 128
s_add_u32 m0, s28, 4096
s_nop 0
buffer_load_dwordx4 v12, s[8:11], s25 offen offset:0 lds
buffer_load_dwordx4 v13, s[8:11], s25 offen offset:1024 lds
buffer_load_dwordx4 v14, s[8:11], s25 offen offset:2048 lds
buffer_load_dwordx4 v15, s[8:11], s25 offen offset:3072 lds
s_add_u32 s25, s25, 128
s_add_u32 m0, s29, 65536
s_nop 0
buffer_load_dwordx4 v16, s[12:15], s26 offen offset:0 nt lds
buffer_load_dwordx4 v17, s[12:15], s26 offen offset:1024 nt lds
buffer_load_dwordx4 v18, s[12:15], s26 offen offset:2048 nt lds
buffer_load_dwordx4 v19, s[12:15], s26 offen offset:3072 nt lds
s_add_u32 s26, s26, 524288
s_add_u32 m0, s29, 81920
s_nop 0
buffer_load_dwordx4 v16, s[12:15], s27 offen offset:0 nt lds
buffer_load_dwordx4 v17, s[12:15], s27 offen offset:1024 nt lds
buffer_load_dwordx4 v18, s[12:15], s27 offen offset:2048 nt lds
buffer_load_dwordx4 v19, s[12:15], s27 offen offset:3072 nt lds
s_add_u32 s27, s27, 524288
s_mov_b32 s4, s92
s_mov_b32 s5, s93
s_mov_b32 s6, 268435456
s_mov_b32 s7, 0x20000
s_add_u32 m0, s28, 32768
s_nop 0
buffer_load_dwordx4 v12, s[8:11], s24 offen offset:0 lds
buffer_load_dwordx4 v13, s[8:11], s24 offen offset:1024 lds
buffer_load_dwordx4 v14, s[8:11], s24 offen offset:2048 lds
buffer_load_dwordx4 v15, s[8:11], s24 offen offset:3072 lds
s_add_u32 s24, s24, 128
s_add_u32 m0, s28, 36864
s_nop 0
buffer_load_dwordx4 v12, s[8:11], s25 offen offset:0 lds
buffer_load_dwordx4 v13, s[8:11], s25 offen offset:1024 lds
buffer_load_dwordx4 v14, s[8:11], s25 offen offset:2048 lds
buffer_load_dwordx4 v15, s[8:11], s25 offen offset:3072 lds
s_add_u32 s25, s25, 128
s_add_u32 m0, s29, 98304
s_nop 0
buffer_load_dwordx4 v16, s[12:15], s26 offen offset:0 nt lds
buffer_load_dwordx4 v17, s[12:15], s26 offen offset:1024 nt lds
buffer_load_dwordx4 v18, s[12:15], s26 offen offset:2048 nt lds
buffer_load_dwordx4 v19, s[12:15], s26 offen offset:3072 nt lds
s_add_u32 s26, s26, 524288
s_mul_hi_u32 s38, s2, 613566757
s_mul_i32 s39, s38, 7
s_sub_u32 s39, s2, s39
v_mov_b32 v246, 0
v_mov_b32 v229, 0
v_mov_b32 v231, 0
s_cmp_eq_u32 s3, 3
s_cselect_b64 s[40:41], s[76:77], s[80:81]
s_cselect_b32 s42, 1835008, 0
s_cmp_eq_u32 s3, 1
s_cselect_b32 s42, 3670016, s42
s_cmp_eq_u32 s3, 3
s_cselect_b64 s[44:45], s[86:87], s[72:73]
s_cselect_b32 s46, 3670016, 0
s_cmp_eq_u32 s3, 1
s_cselect_b32 s46, 1835008, s46
s_mov_b32 s19, 0x20000
s_cmp_eq_u32 s3, 2
s_cbranch_scc1 M_pf2
s_cmp_lg_u32 s3, 0
s_cbranch_scc1 M_pf3
s_mov_b64 s[16:17], s[12:13]
s_mov_b32 s18, 8388608
s_mov_b32 s51, 8388608
s_mov_b32 s47, 524288
s_mov_b32 s43, 1048576
s_lshl_b32 s22, s21, 16
s_lshl_b32 s23, s20, 9
s_add_u32 s22, s22, s23
v_lshrrev_b32 v26, 2, v29
v_lshl_add_u32 v26, v26, 13, s22
v_and_b32 v27, 3, v29
v_lshl_add_u32 v20, v27, 7, v26
v_cmp_gt_u32 vcc, 32, v29
v_mov_b32 v26, 3221225472
s_nop 0
v_cndmask_b32 v20, v26, v20, vcc
buffer_load_dword v21, v20, s[16:19], s43 offen nt
s_add_u32 s43, s43, s47
s_branch M_pfd
M_pf2:
s_mov_b64 s[16:17], s[78:79]
s_mov_b32 s18, 4194304
s_mov_b32 s51, 2048
s_mov_b64 s[40:41], s[64:65]
s_mov_b32 s42, 1835008
s_mov_b32 s47, 256
s_mov_b32 s43, 256
s_lshl_b32 s22, s2, 14
v_lshrrev_b32 v26, 1, v29
v_lshl_add_u32 v26, v26, 11, s22
v_and_b32 v27, 1, v29
v_lshl_add_u32 v20, v27, 7, v26
v_cmp_gt_u32 vcc, 16, v29
s_branch M_pfd
M_pf3:
s_mov_b64 s[16:17], s[76:77]
s_mov_b32 s18, 0
s_mov_b32 s51, 2490368
s_mov_b32 s47, 622592
s_mov_b32 s43, 0
s_mul_i32 s22, s2, 2432
v_lshl_add_u32 v20, v29, 7, s22
v_cmp_gt_u32 vcc, 19, v29
M_pfd:
v_mov_b32 v26, 3221225472
s_nop 0
v_cndmask_b32 v20, v26, v20, vcc
s_cmp_eq_u32 s3, 0
s_cselect_b32 s23, s43, 3221225472
buffer_load_dword v21, v20, s[16:19], s23 offen nt
s_cselect_b32 s23, 3221225472, s43
buffer_load_dword v21, v20, s[16:19], s23 offen
s_add_u32 s43, s43, s47
s_mov_b32 s60, s90
s_mov_b32 s61, s91
s_mov_b32 s62, 256
s_mov_b32 s63, 0x20000
s_bfe_u32 s55, s2, 0x20003
s_add_u32 s55, s55, 5
s_getpc_b64 s[56:57]
M_pc:
s_lshr_b32 s22, s2, 3
s_lshl_b32 s22, s22, 5
v_and_b32 v26, 31, v0
v_add_u32 v26, s22, v26
v_lshlrev_b32 v26, 7, v26
v_min_u32 v26, M_end-M_pc, v26
v_mov_b32 v27, s57
v_add_co_u32 v26, vcc, s56, v26
s_nop 1
v_addc_co_u32 v27, vcc, 0, v27, vcc
global_load_dword v21, v[26:27], off
v_and_b32 v30, 15, v29
v_lshrrev_b32 v31, 4, v29
v_lshrrev_b32 v26, 1, v30
v_xor_b32 v26, v31, v26
v_lshlrev_b32 v26, 4, v26
v_lshl_add_u32 v2, v30, 7, v26
s_lshr_b32 s22, s3, 1
s_lshl_b32 s22, s22, 14
v_add_u32 v2, s22, v2
v_xor_b32 v3, 64, v2
v_lshrrev_b32 v26, 2, v30
v_and_b32 v27, 1, v31
v_lshl_or_b32 v27, v27, 2, v26
v_lshl_add_u32 v26, v31, 3, v26
v_lshlrev_b32 v26, 9, v26
v_lshl_add_u32 v26, v27, 5, v26
v_and_b32 v27, 3, v29
v_lshl_add_u32 v26, v27, 3, v26
s_and_b32 s22, s3, 1
s_lshl_b32 s22, s22, 8
s_add_u32 s22, s22, 0x10000
v_xor_b32 v4, s22, v26
v_xor_b32 v5, 32, v4
v_xor_b32 v6, 64, v4
v_xor_b32 v7, 96, v4
v_xor_b32 v8, 128, v4
v_xor_b32 v9, 160, v4
v_xor_b32 v10, 192, v4
v_xor_b32 v11, 224, v4
s_lshr_b32 s22, s2, 4
s_lshl_b32 s23, s20, 5
s_add_u32 s23, s23, s22
s_lshl_b32 s23, s23, 2
v_mov_b32 v28, 3221225472
v_writelane_b32 v28, s23, 0
s_add_u32 s30, s23, 64
v_writelane_b32 v28, s30, 1
s_add_u32 s30, s23, 4096
v_writelane_b32 v28, s30, 2
s_sub_u32 s37, 15, s21
s_bitcmp1_b32 s2, 4
s_cselect_b32 s37, s21, s37
s_lshl_b32 s30, s37, 5
s_add_u32 s30, s30, s20
s_lshl_b32 s30, s30, 2
s_add_u32 s30, s30, 8192
v_writelane_b32 v28, s30, 3
s_add_u32 s30, s30, 64
v_writelane_b32 v28, s30, 6
s_lshl_b32 s30, s2, 2
s_add_u32 s30, s30, 12288
v_writelane_b32 v28, s30, 4
s_lshl_b32 s30, s39, 5
s_add_u32 s30, s30, s38
s_lshl_b32 s30, s30, 2
s_add_u32 s30, s30, 20480
s_cmp_lt_u32 s2, 224
s_cselect_b32 s30, s30, 3221225472
v_writelane_b32 v28, s30, 7
s_cmp_eq_u32 s3, 0
s_cselect_b32 s30, 94371840, 3221225472
buffer_store_dword v246, v28, s[4:7], s30 offen sc1
v_mov_b32 v27, 1
v_cmp_eq_u32 vcc, 0, v0
v_mov_b32 v26, 3221225472
s_lshl_b32 s31, s20, 20
s_lshl_b32 s22, s21, 17
v_cndmask_b32 v26, v26, v246, vcc
s_add_u32 s31, s31, s22
s_lshr_b32 s22, s3, 1
s_lshl_b32 s22, s22, 16
s_add_u32 s31, s31, s22
s_and_b32 s22, s3, 1
s_waitcnt vmcnt(16)
s_barrier
ds_read_b128 a[0:3], v2 offset:0
ds_read_b128 a[4:7], v3 offset:0
ds_read_b128 a[8:11], v2 offset:2048
ds_read_b128 a[12:15], v3 offset:2048
ds_read_b128 a[16:19], v2 offset:4096
ds_read_b128 a[20:23], v3 offset:4096
ds_read_b128 a[24:27], v2 offset:6144
ds_read_b128 a[28:31], v3 offset:6144
ds_read_b128 a[32:35], v2 offset:8192
ds_read_b128 a[36:39], v3 offset:8192
ds_read_b128 a[40:43], v2 offset:10240
ds_read_b128 a[44:47], v3 offset:10240
ds_read_b128 a[48:51], v2 offset:12288
ds_read_b128 a[52:55], v3 offset:12288
ds_read_b128 a[56:59], v2 offset:14336
ds_read_b128 a[60:63], v3 offset:14336
ds_read_b64_tr_b16 a[128:129], v4 offset:0
ds_read_b64_tr_b16 a[130:131], v4 offset:2048
ds_read_b64_tr_b16 a[132:133], v4 offset:16384
ds_read_b64_tr_b16 a[134:135], v4 offset:18432
s_waitcnt vmcnt(8) lgkmcnt(0)
s_barrier
s_bitcmp1_b32 s2, 4
s_cbranch_scc1 M_V
s_lshl_b32 s22, s22, 12
s_add_u32 s31, s31, s22
s_mov_b32 s32, 8192
s_mov_b32 s33, 8192
s_mov_b32 s34, 8192
s_mov_b32 s35, 4294910976
s_mov_b32 s36, 4294910976
s_mov_b32 s30, 8
s_mov_b32 s82, 3221225472
v_mfma_f32_16x16x32_bf16 v[32:35], a[128:131], a[0:3], 0
s_add_u32 m0, s29, 114688
ds_read_b64_tr_b16 a[136:137], v5 offset:0
v_mfma_f32_16x16x32_bf16 v[32:35], a[132:135], a[4:7], v[32:35]
buffer_load_dwordx4 v16, s[12:15], s27 offen offset:0 nt lds
v_mfma_f32_16x16x32_bf16 v[40:43], a[128:131], a[8:11], 0
ds_read_b64_tr_b16 a[138:139], v5 offset:2048
v_mfma_f32_16x16x32_bf16 v[40:43], a[132:135], a[12:15], v[40:43]
v_mfma_f32_16x16x32_bf16 v[48:51], a[128:131], a[16:19], 0
ds_read_b64_tr_b16 a[140:141], v5 offset:16384
v_mfma_f32_16x16x32_bf16 v[48:51], a[132:135], a[20:23], v[48:51]
buffer_load_dwordx4 v17, s[12:15], s27 offen offset:1024 nt lds
v_mfma_f32_16x16x32_bf16 v[56:59], a[128:131], a[24:27], 0
ds_read_b64_tr_b16 a[142:143], v5 offset:18432
v_mfma_f32_16x16x32_bf16 v[56:59], a[132:135], a[28:31], v[56:59]
v_mfma_f32_16x16x32_bf16 v[64:67], a[128:131], a[32:35], 0
ds_read_b128 a[64:67], v2 offset:32768
v_mfma_f32_16x16x32_bf16 v[64:67], a[132:135], a[36:39], v[64:67]
buffer_load_dwordx4 v18, s[12:15], s27 offen offset:2048 nt lds
v_mfma_f32_16x16x32_bf16 v[72:75], a[128:131], a[40:43], 0
ds_read_b128 a[68:71], v3 offset:32768
v_mfma_f32_16x16x32_bf16 v[72:75], a[132:135], a[44:47], v[72:75]
v_mfma_f32_16x16x32_bf16 v[80:83], a[128:131], a[48:51], 0
v_mfma_f32_16x16x32_bf16 v[80:83], a[132:135], a[52:55], v[80:83]
buffer_load_dwordx4 v19, s[12:15], s27 offen offset:3072 nt lds
v_mfma_f32_16x16x32_bf16 v[88:91], a[128:131], a[56:59], 0
s_add_u32 s27, s27, 524288
ds_read_b128 a[72:75], v2 offset:34816
v_mfma_f32_16x16x32_bf16 v[88:91], a[132:135], a[60:63], v[88:91]
s_waitcnt lgkmcnt(5)
v_mfma_f32_16x16x32_bf16 v[36:39], a[136:139], a[0:3], 0
s_waitcnt lgkmcnt(3)
s_add_u32 m0, s28, 0
ds_read_b64_tr_b16 a[128:129], v6 offset:0
v_mfma_f32_16x16x32_bf16 v[36:39], a[140:143], a[4:7], v[36:39]
buffer_load_dwordx4 v12, s[8:11], s24 offen offset:0 lds
v_mfma_f32_16x16x32_bf16 v[44:47], a[136:139], a[8:11], 0
ds_read_b64_tr_b16 a[130:131], v6 offset:2048
v_mfma_f32_16x16x32_bf16 v[44:47], a[140:143], a[12:15], v[44:47]
v_mfma_f32_16x16x32_bf16 v[52:55], a[136:139], a[16:19], 0
ds_read_b64_tr_b16 a[132:133], v6 offset:16384
v_mfma_f32_16x16x32_bf16 v[52:55], a[140:143], a[20:23], v[52:55]
buffer_load_dwordx4 v13, s[8:11], s24 offen offset:1024 lds
v_mfma_f32_16x16x32_bf16 v[60:63], a[136:139], a[24:27], 0
ds_read_b64_tr_b16 a[134:135], v6 offset:18432
v_mfma_f32_16x16x32_bf16 v[60:63], a[140:143], a[28:31], v[60:63]
v_mfma_f32_16x16x32_bf16 v[68:71], a[136:139], a[32:35], 0
ds_read_b128 a[76:79], v3 offset:34816
v_mfma_f32_16x16x32_bf16 v[68:71], a[140:143], a[36:39], v[68:71]
buffer_load_dwordx4 v14, s[8:11], s24 offen offset:2048 lds
v_mfma_f32_16x16x32_bf16 v[76:79], a[136:139], a[40:43], 0
v_mfma_f32_16x16x32_bf16 v[76:79], a[140:143], a[44:47], v[76:79]
v_mfma_f32_16x16x32_bf16 v[84:87], a[136:139], a[48:51], 0
ds_read_b128 a[80:83], v2 offset:36864
v_mfma_f32_16x16x32_bf16 v[84:87], a[140:143], a[52:55], v[84:87]
buffer_load_dwordx4 v15, s[8:11], s24 offen offset:3072 lds
v_mfma_f32_16x16x32_bf16 v[92:95], a[136:139], a[56:59], 0
s_add_u32 s24, s24, 128
ds_read_b128 a[84:87], v3 offset:36864
v_mfma_f32_16x16x32_bf16 v[92:95], a[140:143], a[60:63], v[92:95]
s_waitcnt lgkmcnt(5)
v_mfma_f32_16x16x32_bf16 v[96:99], a[128:131], a[0:3], 0
s_waitcnt lgkmcnt(3)
s_add_u32 m0, s28, 4096
ds_read_b64_tr_b16 a[136:137], v7 offset:0
v_mfma_f32_16x16x32_bf16 v[96:99], a[132:135], a[4:7], v[96:99]
buffer_load_dwordx4 v12, s[8:11], s25 offen offset:0 lds
v_mfma_f32_16x16x32_bf16 v[104:107], a[128:131], a[8:11], 0
ds_read_b64_tr_b16 a[138:139], v7 offset:2048
v_mfma_f32_16x16x32_bf16 v[104:107], a[132:135], a[12:15], v[104:107]
v_mfma_f32_16x16x32_bf16 v[112:115], a[128:131], a[16:19], 0
ds_read_b64_tr_b16 a[140:141], v7 offset:16384
v_mfma_f32_16x16x32_bf16 v[112:115], a[132:135], a[20:23], v[112:115]
buffer_load_dwordx4 v13, s[8:11], s25 offen offset:1024 lds
v_mfma_f32_16x16x32_bf16 v[120:123], a[128:131], a[24:27], 0
ds_read_b64_tr_b16 a[142:143], v7 offset:18432
v_mfma_f32_16x16x32_bf16 v[120:123], a[132:135], a[28:31], v[120:123]
v_mfma_f32_16x16x32_bf16 v[128:131], a[128:131], a[32:35], 0
v_mfma_f32_16x16x32_bf16 v[128:131], a[132:135], a[36:39], v[128:131]
buffer_load_dwordx4 v14, s[8:11], s25 offen offset:2048 lds
v_mfma_f32_16x16x32_bf16 v[136:139], a[128:131], a[40:43], 0
ds_read_b128 a[88:91], v2 offset:38912
v_mfma_f32_16x16x32_bf16 v[136:139], a[132:135], a[44:47], v[136:139]
v_mfma_f32_16x16x32_bf16 v[144:147], a[128:131], a[48:51], 0
ds_read_b128 a[92:95], v3 offset:38912
v_mfma_f32_16x16x32_bf16 v[144:147], a[132:135], a[52:55], v[144:147]
buffer_load_dwordx4 v15, s[8:11], s25 offen offset:3072 lds
v_mfma_f32_16x16x32_bf16 v[152:155], a[128:131], a[56:59], 0
s_add_u32 s25, s25, 128
v_mfma_f32_16x16x32_bf16 v[152:155], a[132:135], a[60:63], v[152:155]
s_waitcnt lgkmcnt(4)
v_mfma_f32_16x16x32_bf16 v[100:103], a[136:139], a[0:3], 0
s_waitcnt lgkmcnt(2)
s_cmp_eq_u32 s3, 0
ds_read_b64_tr_b16 a[128:129], v8 offset:0
v_mfma_f32_16x16x32_bf16 v[100:103], a[140:143], a[4:7], v[100:103]
s_cselect_b32 s23, s43, 3221225472
buffer_load_dword v21, v20, s[16:19], s23 offen nt
v_mfma_f32_16x16x32_bf16 v[108:111], a[136:139], a[8:11], 0
s_cselect_b32 s23, 3221225472, s43
ds_read_b64_tr_b16 a[130:131], v8 offset:2048
v_mfma_f32_16x16x32_bf16 v[108:111], a[140:143], a[12:15], v[108:111]
buffer_load_dword v21, v20, s[16:19], s23 offen
v_mfma_f32_16x16x32_bf16 v[116:119], a[136:139], a[16:19], 0
s_add_u32 s43, s43, s47
ds_read_b64_tr_b16 a[132:133], v8 offset:16384
v_mfma_f32_16x16x32_bf16 v[116:119], a[140:143], a[20:23], v[116:119]
s_cmp_ge_u32 s43, s51
v_mfma_f32_16x16x32_bf16 v[124:127], a[136:139], a[24:27], 0
s_cselect_b32 s43, 0, s43
ds_read_b64_tr_b16 a[134:135], v8 offset:18432
v_mfma_f32_16x16x32_bf16 v[124:127], a[140:143], a[28:31], v[124:127]
s_cselect_b32 s51, s42, s51
v_mfma_f32_16x16x32_bf16 v[132:135], a[136:139], a[32:35], 0
s_cselect_b64 s[16:17], s[40:41], s[16:17]
ds_read_b128 a[96:99], v2 offset:40960
v_mfma_f32_16x16x32_bf16 v[132:135], a[140:143], a[36:39], v[132:135]
s_cselect_b32 s18, s42, s18
v_mfma_f32_16x16x32_bf16 v[140:143], a[136:139], a[40:43], 0
s_cselect_b64 s[40:41], s[44:45], s[40:41]
v_mfma_f32_16x16x32_bf16 v[140:143], a[140:143], a[44:47], v[140:143]
s_cselect_b32 s42, s46, s42
v_mfma_f32_16x16x32_bf16 v[148:151], a[136:139], a[48:51], 0
s_cselect_b32 s46, 0, s46
ds_read_b128 a[100:103], v3 offset:40960
v_mfma_f32_16x16x32_bf16 v[148:151], a[140:143], a[52:55], v[148:151]
s_cmp_eq_u32 s3, 0
v_mfma_f32_16x16x32_bf16 v[156:159], a[136:139], a[56:59], 0
s_cselect_b32 s23, s43, 3221225472
ds_read_b128 a[104:107], v2 offset:43008
v_mfma_f32_16x16x32_bf16 v[156:159], a[140:143], a[60:63], v[156:159]
s_waitcnt lgkmcnt(5)
buffer_load_dword v21, v20, s[16:19], s23 offen nt
v_mfma_f32_16x16x32_bf16 v[160:163], a[128:131], a[0:3], 0
s_waitcnt lgkmcnt(3)
s_cselect_b32 s23, 3221225472, s43
ds_read_b64_tr_b16 a[136:137], v9 offset:0
v_mfma_f32_16x16x32_bf16 v[160:163], a[132:135], a[4:7], v[160:163]
buffer_load_dword v21, v20, s[16:19], s23 offen
v_mfma_f32_16x16x32_bf16 v[168:171], a[128:131], a[8:11], 0
s_add_u32 s43, s43, s47
ds_read_b64_tr_b16 a[138:139], v9 offset:2048
v_mfma_f32_16x16x32_bf16 v[168:171], a[132:135], a[12:15], v[168:171]
s_cmp_ge_u32 s43, s51
v_mfma_f32_16x16x32_bf16 v[176:179], a[128:131], a[16:19], 0
s_cselect_b32 s43, 0, s43
ds_read_b64_tr_b16 a[140:141], v9 offset:16384
v_mfma_f32_16x16x32_bf16 v[176:179], a[132:135], a[20:23], v[176:179]
s_cselect_b32 s51, s42, s51
v_mfma_f32_16x16x32_bf16 v[184:187], a[128:131], a[24:27], 0
s_cselect_b64 s[16:17], s[40:41], s[16:17]
ds_read_b64_tr_b16 a[142:143], v9 offset:18432
v_mfma_f32_16x16x32_bf16 v[184:187], a[132:135], a[28:31], v[184:187]
s_cselect_b32 s18, s42, s18
v_mfma_f32_16x16x32_bf16 v[192:195], a[128:131], a[32:35], 0
s_cselect_b64 s[40:41], s[44:45], s[40:41]
v_mfma_f32_16x16x32_bf16 v[192:195], a[132:135], a[36:39], v[192:195]
s_cselect_b32 s42, s46, s42
v_mfma_f32_16x16x32_bf16 v[200:203], a[128:131], a[40:43], 0
s_cselect_b32 s46, 0, s46
ds_read_b128 a[108:111], v3 offset:43008
v_mfma_f32_16x16x32_bf16 v[200:203], a[132:135], a[44:47], v[200:203]
v_mfma_f32_16x16x32_bf16 v[208:211], a[128:131], a[48:51], 0
ds_read_b128 a[112:115], v2 offset:45056
v_mfma_f32_16x16x32_bf16 v[208:211], a[132:135], a[52:55], v[208:211]
v_mfma_f32_16x16x32_bf16 v[216:219], a[128:131], a[56:59], 0
v_mfma_f32_16x16x32_bf16 v[216:219], a[132:135], a[60:63], v[216:219]
s_waitcnt lgkmcnt(4)
v_mfma_f32_16x16x32_bf16 v[164:167], a[136:139], a[0:3], 0
s_waitcnt lgkmcnt(2)
ds_read_b64_tr_b16 a[128:129], v10 offset:0
v_mfma_f32_16x16x32_bf16 v[164:167], a[140:143], a[4:7], v[164:167]
v_mfma_f32_16x16x32_bf16 v[172:175], a[136:139], a[8:11], 0
ds_read_b64_tr_b16 a[130:131], v10 offset:2048
v_mfma_f32_16x16x32_bf16 v[172:175], a[140:143], a[12:15], v[172:175]
v_mfma_f32_16x16x32_bf16 v[180:183], a[136:139], a[16:19], 0
ds_read_b64_tr_b16 a[132:133], v10 offset:16384
v_mfma_f32_16x16x32_bf16 v[180:183], a[140:143], a[20:23], v[180:183]
v_mfma_f32_16x16x32_bf16 v[188:191], a[136:139], a[24:27], 0
ds_read_b64_tr_b16 a[134:135], v10 offset:18432
v_mfma_f32_16x16x32_bf16 v[188:191], a[140:143], a[28:31], v[188:191]
v_mfma_f32_16x16x32_bf16 v[196:199], a[136:139], a[32:35], 0
ds_read_b128 a[116:119], v3 offset:45056
v_mfma_f32_16x16x32_bf16 v[196:199], a[140:143], a[36:39], v[196:199]
v_mfma_f32_16x16x32_bf16 v[204:207], a[136:139], a[40:43], 0
ds_read_b128 a[120:123], v2 offset:47104
v_mfma_f32_16x16x32_bf16 v[204:207], a[140:143], a[44:47], v[204:207]
v_mfma_f32_16x16x32_bf16 v[212:215], a[136:139], a[48:51], 0
v_mfma_f32_16x16x32_bf16 v[212:215], a[140:143], a[52:55], v[212:215]
v_mfma_f32_16x16x32_bf16 v[220:223], a[136:139], a[56:59], 0
ds_read_b128 a[124:127], v3 offset:47104
v_mfma_f32_16x16x32_bf16 v[220:223], a[140:143], a[60:63], v[220:223]
s_waitcnt lgkmcnt(5)
v_mfma_f32_16x16x32_bf16 a[192:195], a[128:131], a[0:3], 0
s_waitcnt lgkmcnt(3)
ds_read_b64_tr_b16 a[136:137], v11 offset:0
v_mfma_f32_16x16x32_bf16 a[192:195], a[132:135], a[4:7], a[192:195]
v_mfma_f32_16x16x32_bf16 a[200:203], a[128:131], a[8:11], 0
ds_read_b64_tr_b16 a[138:139], v11 offset:2048
v_mfma_f32_16x16x32_bf16 a[200:203], a[132:135], a[12:15], a[200:203]
v_mfma_f32_16x16x32_bf16 a[208:211], a[128:131], a[16:19], 0
ds_read_b64_tr_b16 a[140:141], v11 offset:16384
v_mfma_f32_16x16x32_bf16 a[208:211], a[132:135], a[20:23], a[208:211]
v_mfma_f32_16x16x32_bf16 a[216:219], a[128:131], a[24:27], 0
ds_read_b64_tr_b16 a[142:143], v11 offset:18432
v_mfma_f32_16x16x32_bf16 a[216:219], a[132:135], a[28:31], a[216:219]
v_mfma_f32_16x16x32_bf16 a[224:227], a[128:131], a[32:35], 0
v_mfma_f32_16x16x32_bf16 a[224:227], a[132:135], a[36:39], a[224:227]
v_mfma_f32_16x16x32_bf16 a[232:235], a[128:131], a[40:43], 0
v_mfma_f32_16x16x32_bf16 a[232:235], a[132:135], a[44:47], a[232:235]
v_mfma_f32_16x16x32_bf16 a[240:243], a[128:131], a[48:51], 0
v_mfma_f32_16x16x32_bf16 a[240:243], a[132:135], a[52:55], a[240:243]
v_mfma_f32_16x16x32_bf16 a[248:251], a[128:131], a[56:59], 0
v_mfma_f32_16x16x32_bf16 a[248:251], a[132:135], a[60:63], a[248:251]
s_waitcnt vmcnt(4) lgkmcnt(0)
s_barrier
v_mfma_f32_16x16x32_bf16 a[196:199], a[136:139], a[0:3], 0
s_add_u32 m0, s29, 65536
ds_read_b64_tr_b16 a[128:129], v4 offset:32768
v_mfma_f32_16x16x32_bf16 a[196:199], a[140:143], a[4:7], a[196:199]
buffer_load_dwordx4 v16, s[12:15], s26 offen offset:0 lds
v_mfma_f32_16x16x32_bf16 a[204:207], a[136:139], a[8:11], 0
ds_read_b64_tr_b16 a[130:131], v4 offset:34816
v_mfma_f32_16x16x32_bf16 a[204:207], a[140:143], a[12:15], a[204:207]
v_mfma_f32_16x16x32_bf16 a[212:215], a[136:139], a[16:19], 0
ds_read_b64_tr_b16 a[132:133], v4 offset:49152
v_mfma_f32_16x16x32_bf16 a[212:215], a[140:143], a[20:23], a[212:215]
buffer_load_dwordx4 v17, s[12:15], s26 offen offset:1024 lds
v_mfma_f32_16x16x32_bf16 a[220:223], a[136:139], a[24:27], 0
ds_read_b64_tr_b16 a[134:135], v4 offset:51200
v_mfma_f32_16x16x32_bf16 a[220:223], a[140:143], a[28:31], a[220:223]
v_mfma_f32_16x16x32_bf16 a[228:231], a[136:139], a[32:35], 0
v_mfma_f32_16x16x32_bf16 a[228:231], a[140:143], a[36:39], a[228:231]
buffer_load_dwordx4 v18, s[12:15], s26 offen offset:2048 lds
v_mfma_f32_16x16x32_bf16 a[236:239], a[136:139], a[40:43], 0
v_mfma_f32_16x16x32_bf16 a[236:239], a[140:143], a[44:47], a[236:239]
v_mfma_f32_16x16x32_bf16 a[244:247], a[136:139], a[48:51], 0
v_mfma_f32_16x16x32_bf16 a[244:247], a[140:143], a[52:55], a[244:247]
buffer_load_dwordx4 v19, s[12:15], s26 offen offset:3072 lds
v_mfma_f32_16x16x32_bf16 a[252:255], a[136:139], a[56:59], 0
s_add_u32 s26, s26, 524288
v_mfma_f32_16x16x32_bf16 a[252:255], a[140:143], a[60:63], a[252:255]
s_waitcnt lgkmcnt(2)
Lg_1:
v_mfma_f32_16x16x32_bf16 v[32:35], a[128:131], a[64:67], v[32:35]
s_waitcnt lgkmcnt(0)
s_add_u32 m0, s29, 81920
ds_read_b64_tr_b16 a[136:137], v5 offset:32768
v_mfma_f32_16x16x32_bf16 v[32:35], a[132:135], a[68:71], v[32:35]
buffer_load_dwordx4 v16, s[12:15], s27 offen offset:0 lds
v_mfma_f32_16x16x32_bf16 v[40:43], a[128:131], a[72:75], v[40:43]
ds_read_b64_tr_b16 a[138:139], v5 offset:34816
v_mfma_f32_16x16x32_bf16 v[40:43], a[132:135], a[76:79], v[40:43]
v_mfma_f32_16x16x32_bf16 v[48:51], a[128:131], a[80:83], v[48:51]
ds_read_b64_tr_b16 a[140:141], v5 offset:49152
v_mfma_f32_16x16x32_bf16 v[48:51], a[132:135], a[84:87], v[48:51]
buffer_load_dwordx4 v17, s[12:15], s27 offen offset:1024 lds
v_mfma_f32_16x16x32_bf16 v[56:59], a[128:131], a[88:91], v[56:59]
ds_read_b64_tr_b16 a[142:143], v5 offset:51200
v_mfma_f32_16x16x32_bf16 v[56:59], a[132:135], a[92:95], v[56:59]
v_mfma_f32_16x16x32_bf16 v[64:67], a[128:131], a[96:99], v[64:67]
ds_read_b128 a[0:3], v2 offset:0
v_mfma_f32_16x16x32_bf16 v[64:67], a[132:135], a[100:103], v[64:67]
buffer_load_dwordx4 v18, s[12:15], s27 offen offset:2048 lds
v_mfma_f32_16x16x32_bf16 v[72:75], a[128:131], a[104:107], v[72:75]
ds_read_b128 a[4:7], v3 offset:0
v_mfma_f32_16x16x32_bf16 v[72:75], a[132:135], a[108:111], v[72:75]
v_mfma_f32_16x16x32_bf16 v[80:83], a[128:131], a[112:115], v[80:83]
v_mfma_f32_16x16x32_bf16 v[80:83], a[132:135], a[116:119], v[80:83]
buffer_load_dwordx4 v19, s[12:15], s27 offen offset:3072 lds
v_mfma_f32_16x16x32_bf16 v[88:91], a[128:131], a[120:123], v[88:91]
s_add_u32 s27, s27, 524288
ds_read_b128 a[8:11], v2 offset:2048
v_mfma_f32_16x16x32_bf16 v[88:91], a[132:135], a[124:127], v[88:91]
s_waitcnt lgkmcnt(5)
v_mfma_f32_16x16x32_bf16 v[36:39], a[136:139], a[64:67], v[36:39]
s_waitcnt lgkmcnt(3)
s_add_u32 m0, s28, 32768
ds_read_b64_tr_b16 a[128:129], v6 offset:32768
v_mfma_f32_16x16x32_bf16 v[36:39], a[140:143], a[68:71], v[36:39]
buffer_load_dwordx4 v12, s[8:11], s24 offen offset:0 lds
v_mfma_f32_16x16x32_bf16 v[44:47], a[136:139], a[72:75], v[44:47]
ds_read_b64_tr_b16 a[130:131], v6 offset:34816
v_mfma_f32_16x16x32_bf16 v[44:47], a[140:143], a[76:79], v[44:47]
v_mfma_f32_16x16x32_bf16 v[52:55], a[136:139], a[80:83], v[52:55]
ds_read_b64_tr_b16 a[132:133], v6 offset:49152
v_mfma_f32_16x16x32_bf16 v[52:55], a[140:143], a[84:87], v[52:55]
buffer_load_dwordx4 v13, s[8:11], s24 offen offset:1024 lds
v_mfma_f32_16x16x32_bf16 v[60:63], a[136:139], a[88:91], v[60:63]
ds_read_b64_tr_b16 a[134:135], v6 offset:51200
v_mfma_f32_16x16x32_bf16 v[60:63], a[140:143], a[92:95], v[60:63]
v_mfma_f32_16x16x32_bf16 v[68:71], a[136:139], a[96:99], v[68:71]
ds_read_b128 a[12:15], v3 offset:2048
v_mfma_f32_16x16x32_bf16 v[68:71], a[140:143], a[100:103], v[68:71]
buffer_load_dwordx4 v14, s[8:11], s24 offen offset:2048 lds
v_mfma_f32_16x16x32_bf16 v[76:79], a[136:139], a[104:107], v[76:79]
v_mfma_f32_16x16x32_bf16 v[76:79], a[140:143], a[108:111], v[76:79]
v_mfma_f32_16x16x32_bf16 v[84:87], a[136:139], a[112:115], v[84:87]
ds_read_b128 a[16:19], v2 offset:4096
v_mfma_f32_16x16x32_bf16 v[84:87], a[140:143], a[116:119], v[84:87]
buffer_load_dwordx4 v15, s[8:11], s24 offen offset:3072 lds
v_mfma_f32_16x16x32_bf16 v[92:95], a[136:139], a[120:123], v[92:95]
s_add_u32 s24, s24, 128
ds_read_b128 a[20:23], v3 offset:4096
v_mfma_f32_16x16x32_bf16 v[92:95], a[140:143], a[124:127], v[92:95]
s_waitcnt lgkmcnt(5)
v_mfma_f32_16x16x32_bf16 v[96:99], a[128:131], a[64:67], v[96:99]
s_waitcnt lgkmcnt(3)
s_add_u32 m0, s28, 36864
ds_read_b64_tr_b16 a[136:137], v7 offset:32768
v_mfma_f32_16x16x32_bf16 v[96:99], a[132:135], a[68:71], v[96:99]
buffer_load_dwordx4 v12, s[8:11], s25 offen offset:0 lds
v_mfma_f32_16x16x32_bf16 v[104:107], a[128:131], a[72:75], v[104:107]
ds_read_b64_tr_b16 a[138:139], v7 offset:34816
v_mfma_f32_16x16x32_bf16 v[104:107], a[132:135], a[76:79], v[104:107]
v_mfma_f32_16x16x32_bf16 v[112:115], a[128:131], a[80:83], v[112:115]
ds_read_b64_tr_b16 a[140:141], v7 offset:49152
v_mfma_f32_16x16x32_bf16 v[112:115], a[132:135], a[84:87], v[112:115]
buffer_load_dwordx4 v13, s[8:11], s25 offen offset:1024 lds
v_mfma_f32_16x16x32_bf16 v[120:123], a[128:131], a[88:91], v[120:123]
ds_read_b64_tr_b16 a[142:143], v7 offset:51200
v_mfma_f32_16x16x32_bf16 v[120:123], a[132:135], a[92:95], v[120:123]
v_mfma_f32_16x16x32_bf16 v[128:131], a[128:131], a[96:99], v[128:131]
v_mfma_f32_16x16x32_bf16 v[128:131], a[132:135], a[100:103], v[128:131]
buffer_load_dwordx4 v14, s[8:11], s25 offen offset:2048 lds
v_mfma_f32_16x16x32_bf16 v[136:139], a[128:131], a[104:107], v[136:139]
ds_read_b128 a[24:27], v2 offset:6144
v_mfma_f32_16x16x32_bf16 v[136:139], a[132:135], a[108:111], v[136:139]
v_mfma_f32_16x16x32_bf16 v[144:147], a[128:131], a[112:115], v[144:147]
ds_read_b128 a[28:31], v3 offset:6144
v_mfma_f32_16x16x32_bf16 v[144:147], a[132:135], a[116:119], v[144:147]
buffer_load_dwordx4 v15, s[8:11], s25 offen offset:3072 lds
v_mfma_f32_16x16x32_bf16 v[152:155], a[128:131], a[120:123], v[152:155]
s_add_u32 s25, s25, 128
v_mfma_f32_16x16x32_bf16 v[152:155], a[132:135], a[124:127], v[152:155]
s_waitcnt lgkmcnt(4)
v_mfma_f32_16x16x32_bf16 v[100:103], a[136:139], a[64:67], v[100:103]
s_waitcnt lgkmcnt(2)
ds_read_b64_tr_b16 a[128:129], v8 offset:32768
v_mfma_f32_16x16x32_bf16 v[100:103], a[140:143], a[68:71], v[100:103]
buffer_load_dword v21, v20, s[16:19], s43 offen
v_mfma_f32_16x16x32_bf16 v[108:111], a[136:139], a[72:75], v[108:111]
s_add_u32 s43, s43, s47
ds_read_b64_tr_b16 a[130:131], v8 offset:34816
v_mfma_f32_16x16x32_bf16 v[108:111], a[140:143], a[76:79], v[108:111]
s_cmp_ge_u32 s43, s51
v_mfma_f32_16x16x32_bf16 v[116:119], a[136:139], a[80:83], v[116:119]
s_cselect_b32 s43, 0, s43
ds_read_b64_tr_b16 a[132:133], v8 offset:49152
v_mfma_f32_16x16x32_bf16 v[116:119], a[140:143], a[84:87], v[116:119]
s_cselect_b32 s51, s42, s51
v_mfma_f32_16x16x32_bf16 v[124:127], a[136:139], a[88:91], v[124:127]
s_cselect_b64 s[16:17], s[40:41], s[16:17]
ds_read_b64_tr_b16 a[134:135], v8 offset:51200
v_mfma_f32_16x16x32_bf16 v[124:127], a[140:143], a[92:95], v[124:127]
s_cselect_b32 s18, s42, s18
v_mfma_f32_16x16x32_bf16 v[132:135], a[136:139], a[96:99], v[132:135]
s_cselect_b64 s[40:41], s[44:45], s[40:41]
ds_read_b128 a[32:35], v2 offset:8192
v_mfma_f32_16x16x32_bf16 v[132:135], a[140:143], a[100:103], v[132:135]
s_cselect_b32 s42, s46, s42
v_mfma_f32_16x16x32_bf16 v[140:143], a[136:139], a[104:107], v[140:143]
s_cselect_b32 s46, 0, s46
v_mfma_f32_16x16x32_bf16 v[140:143], a[140:143], a[108:111], v[140:143]
s_cmp_eq_u32 s30, s55
v_mfma_f32_16x16x32_bf16 v[148:151], a[136:139], a[112:115], v[148:151]
s_cselect_b32 s22, 0, 3221225472
ds_read_b128 a[36:39], v3 offset:8192
v_mfma_f32_16x16x32_bf16 v[148:151], a[140:143], a[116:119], v[148:151]
s_sub_u32 s30, s30, 1
buffer_atomic_add v27, v26, s[60:63], s22 offen sc1
v_mfma_f32_16x16x32_bf16 v[156:159], a[136:139], a[120:123], v[156:159]
ds_read_b128 a[40:43], v2 offset:10240
v_mfma_f32_16x16x32_bf16 v[156:159], a[140:143], a[124:127], v[156:159]
s_waitcnt lgkmcnt(5)
v_mfma_f32_16x16x32_bf16 v[160:163], a[128:131], a[64:67], v[160:163]
s_waitcnt lgkmcnt(3)
ds_read_b64_tr_b16 a[136:137], v9 offset:32768
v_mfma_f32_16x16x32_bf16 v[160:163], a[132:135], a[68:71], v[160:163]
v_mfma_f32_16x16x32_bf16 v[168:171], a[128:131], a[72:75], v[168:171]
ds_read_b64_tr_b16 a[138:139], v9 offset:34816
v_mfma_f32_16x16x32_bf16 v[168:171], a[132:135], a[76:79], v[168:171]
v_mfma_f32_16x16x32_bf16 v[176:179], a[128:131], a[80:83], v[176:179]
ds_read_b64_tr_b16 a[140:141], v9 offset:49152
v_mfma_f32_16x16x32_bf16 v[176:179], a[132:135], a[84:87], v[176:179]
v_mfma_f32_16x16x32_bf16 v[184:187], a[128:131], a[88:91], v[184:187]
ds_read_b64_tr_b16 a[142:143], v9 offset:51200
v_mfma_f32_16x16x32_bf16 v[184:187], a[132:135], a[92:95], v[184:187]
v_mfma_f32_16x16x32_bf16 v[192:195], a[128:131], a[96:99], v[192:195]
v_mfma_f32_16x16x32_bf16 v[192:195], a[132:135], a[100:103], v[192:195]
v_mfma_f32_16x16x32_bf16 v[200:203], a[128:131], a[104:107], v[200:203]
ds_read_b128 a[44:47], v3 offset:10240
v_mfma_f32_16x16x32_bf16 v[200:203], a[132:135], a[108:111], v[200:203]
v_mfma_f32_16x16x32_bf16 v[208:211], a[128:131], a[112:115], v[208:211]
ds_read_b128 a[48:51], v2 offset:12288
v_mfma_f32_16x16x32_bf16 v[208:211], a[132:135], a[116:119], v[208:211]
v_mfma_f32_16x16x32_bf16 v[216:219], a[128:131], a[120:123], v[216:219]
v_mfma_f32_16x16x32_bf16 v[216:219], a[132:135], a[124:127], v[216:219]
s_waitcnt lgkmcnt(4)
v_mfma_f32_16x16x32_bf16 v[164:167], a[136:139], a[64:67], v[164:167]
s_waitcnt lgkmcnt(2)
ds_read_b64_tr_b16 a[128:129], v10 offset:32768
v_mfma_f32_16x16x32_bf16 v[164:167], a[140:143], a[68:71], v[164:167]
v_mfma_f32_16x16x32_bf16 v[172:175], a[136:139], a[72:75], v[172:175]
ds_read_b64_tr_b16 a[130:131], v10 offset:34816
v_mfma_f32_16x16x32_bf16 v[172:175], a[140:143], a[76:79], v[172:175]
v_mfma_f32_16x16x32_bf16 v[180:183], a[136:139], a[80:83], v[180:183]
ds_read_b64_tr_b16 a[132:133], v10 offset:49152
v_mfma_f32_16x16x32_bf16 v[180:183], a[140:143], a[84:87], v[180:183]
v_mfma_f32_16x16x32_bf16 v[188:191], a[136:139], a[88:91], v[188:191]
ds_read_b64_tr_b16 a[134:135], v10 offset:51200
v_mfma_f32_16x16x32_bf16 v[188:191], a[140:143], a[92:95], v[188:191]
v_mfma_f32_16x16x32_bf16 v[196:199], a[136:139], a[96:99], v[196:199]
ds_read_b128 a[52:55], v3 offset:12288
v_mfma_f32_16x16x32_bf16 v[196:199], a[140:143], a[100:103], v[196:199]
v_mfma_f32_16x16x32_bf16 v[204:207], a[136:139], a[104:107], v[204:207]
ds_read_b128 a[56:59], v2 offset:14336
v_mfma_f32_16x16x32_bf16 v[204:207], a[140:143], a[108:111], v[204:207]
v_mfma_f32_16x16x32_bf16 v[212:215], a[136:139], a[112:115], v[212:215]
v_mfma_f32_16x16x32_bf16 v[212:215], a[140:143], a[116:119], v[212:215]
v_mfma_f32_16x16x32_bf16 v[220:223], a[136:139], a[120:123], v[220:223]
ds_read_b128 a[60:63], v3 offset:14336
v_mfma_f32_16x16x32_bf16 v[220:223], a[140:143], a[124:127], v[220:223]
s_waitcnt lgkmcnt(5)
v_mfma_f32_16x16x32_bf16 a[192:195], a[128:131], a[64:67], a[192:195]
s_waitcnt lgkmcnt(3)
ds_read_b64_tr_b16 a[136:137], v11 offset:32768
v_mfma_f32_16x16x32_bf16 a[192:195], a[132:135], a[68:71], a[192:195]
v_mfma_f32_16x16x32_bf16 a[200:203], a[128:131], a[72:75], a[200:203]
ds_read_b64_tr_b16 a[138:139], v11 offset:34816
v_mfma_f32_16x16x32_bf16 a[200:203], a[132:135], a[76:79], a[200:203]
v_mfma_f32_16x16x32_bf16 a[208:211], a[128:131], a[80:83], a[208:211]
ds_read_b64_tr_b16 a[140:141], v11 offset:49152
v_mfma_f32_16x16x32_bf16 a[208:211], a[132:135], a[84:87], a[208:211]
v_mfma_f32_16x16x32_bf16 a[216:219], a[128:131], a[88:91], a[216:219]
ds_read_b64_tr_b16 a[142:143], v11 offset:51200
v_mfma_f32_16x16x32_bf16 a[216:219], a[132:135], a[92:95], a[216:219]
v_mfma_f32_16x16x32_bf16 a[224:227], a[128:131], a[96:99], a[224:227]
v_mfma_f32_16x16x32_bf16 a[224:227], a[132:135], a[100:103], a[224:227]
v_mfma_f32_16x16x32_bf16 a[232:235], a[128:131], a[104:107], a[232:235]
v_mfma_f32_16x16x32_bf16 a[232:235], a[132:135], a[108:111], a[232:235]
v_mfma_f32_16x16x32_bf16 a[240:243], a[128:131], a[112:115], a[240:243]
v_mfma_f32_16x16x32_bf16 a[240:243], a[132:135], a[116:119], a[240:243]
v_mfma_f32_16x16x32_bf16 a[248:251], a[128:131], a[120:123], a[248:251]
v_mfma_f32_16x16x32_bf16 a[248:251], a[132:135], a[124:127], a[248:251]
s_waitcnt vmcnt(2) lgkmcnt(0)
s_barrier
v_mfma_f32_16x16x32_bf16 a[196:199], a[136:139], a[64:67], a[196:199]
s_add_u32 m0, s29, 98304
ds_read_b64_tr_b16 a[128:129], v4 offset:0
v_mfma_f32_16x16x32_bf16 a[196:199], a[140:143], a[68:71], a[196:199]
buffer_load_dwordx4 v16, s[12:15], s26 offen offset:0 lds
v_mfma_f32_16x16x32_bf16 a[204:207], a[136:139], a[72:75], a[204:207]
ds_read_b64_tr_b16 a[130:131], v4 offset:2048
v_mfma_f32_16x16x32_bf16 a[204:207], a[140:143], a[76:79], a[204:207]
v_mfma_f32_16x16x32_bf16 a[212:215], a[136:139], a[80:83], a[212:215]
ds_read_b64_tr_b16 a[132:133], v4 offset:16384
v_mfma_f32_16x16x32_bf16 a[212:215], a[140:143], a[84:87], a[212:215]
buffer_load_dwordx4 v17, s[12:15], s26 offen offset:1024 lds
v_mfma_f32_16x16x32_bf16 a[220:223], a[136:139], a[88:91], a[220:223]
ds_read_b64_tr_b16 a[134:135], v4 offset:18432
v_mfma_f32_16x16x32_bf16 a[220:223], a[140:143], a[92:95], a[220:223]
v_mfma_f32_16x16x32_bf16 a[228:231], a[136:139], a[96:99], a[228:231]
v_mfma_f32_16x16x32_bf16 a[228:231], a[140:143], a[100:103], a[228:231]
buffer_load_dwordx4 v18, s[12:15], s26 offen offset:2048 lds
v_mfma_f32_16x16x32_bf16 a[236:239], a[136:139], a[104:107], a[236:239]
v_mfma_f32_16x16x32_bf16 a[236:239], a[140:143], a[108:111], a[236:239]
v_mfma_f32_16x16x32_bf16 a[244:247], a[136:139], a[112:115], a[244:247]
v_mfma_f32_16x16x32_bf16 a[244:247], a[140:143], a[116:119], a[244:247]
buffer_load_dwordx4 v19, s[12:15], s26 offen offset:3072 lds
v_mfma_f32_16x16x32_bf16 a[252:255], a[136:139], a[120:123], a[252:255]
s_add_u32 s26, s26, 524288
v_mfma_f32_16x16x32_bf16 a[252:255], a[140:143], a[124:127], a[252:255]
s_waitcnt lgkmcnt(2)
buffer_store_dword v27, v26, s[4:7], s82 offen sc1
v_mfma_f32_16x16x32_bf16 v[32:35], a[128:131], a[0:3], v[32:35]
s_waitcnt lgkmcnt(0)
s_add_u32 m0, s29, 114688
ds_read_b64_tr_b16 a[136:137], v5 offset:0
v_mfma_f32_16x16x32_bf16 v[32:35], a[132:135], a[4:7], v[32:35]
buffer_load_dwordx4 v16, s[12:15], s27 offen offset:0 lds
v_mfma_f32_16x16x32_bf16 v[40:43], a[128:131], a[8:11], v[40:43]
ds_read_b64_tr_b16 a[138:139], v5 offset:2048
v_mfma_f32_16x16x32_bf16 v[40:43], a[132:135], a[12:15], v[40:43]
v_mfma_f32_16x16x32_bf16 v[48:51], a[128:131], a[16:19], v[48:51]
ds_read_b64_tr_b16 a[140:141], v5 offset:16384
v_mfma_f32_16x16x32_bf16 v[48:51], a[132:135], a[20:23], v[48:51]
buffer_load_dwordx4 v17, s[12:15], s27 offen offset:1024 lds
v_mfma_f32_16x16x32_bf16 v[56:59], a[128:131], a[24:27], v[56:59]
ds_read_b64_tr_b16 a[142:143], v5 offset:18432
v_mfma_f32_16x16x32_bf16 v[56:59], a[132:135], a[28:31], v[56:59]
v_mfma_f32_16x16x32_bf16 v[64:67], a[128:131], a[32:35], v[64:67]
ds_read_b128 a[64:67], v2 offset:32768
v_mfma_f32_16x16x32_bf16 v[64:67], a[132:135], a[36:39], v[64:67]
buffer_load_dwordx4 v18, s[12:15], s27 offen offset:2048 lds
v_mfma_f32_16x16x32_bf16 v[72:75], a[128:131], a[40:43], v[72:75]
ds_read_b128 a[68:71], v3 offset:32768
v_mfma_f32_16x16x32_bf16 v[72:75], a[132:135], a[44:47], v[72:75]
v_mfma_f32_16x16x32_bf16 v[80:83], a[128:131], a[48:51], v[80:83]
v_mfma_f32_16x16x32_bf16 v[80:83], a[132:135], a[52:55], v[80:83]
buffer_load_dwordx4 v19, s[12:15], s27 offen offset:3072 lds
v_mfma_f32_16x16x32_bf16 v[88:91], a[128:131], a[56:59], v[88:91]
s_add_u32 s27, s27, 524288
ds_read_b128 a[72:75], v2 offset:34816
v_mfma_f32_16x16x32_bf16 v[88:91], a[132:135], a[60:63], v[88:91]
s_waitcnt lgkmcnt(5)
v_mfma_f32_16x16x32_bf16 v[36:39], a[136:139], a[0:3], v[36:39]
s_waitcnt lgkmcnt(3)
s_add_u32 m0, s28, 0
ds_read_b64_tr_b16 a[128:129], v6 offset:0
v_mfma_f32_16x16x32_bf16 v[36:39], a[140:143], a[4:7], v[36:39]
buffer_load_dwordx4 v12, s[8:11], s24 offen offset:0 lds
v_mfma_f32_16x16x32_bf16 v[44:47], a[136:139], a[8:11], v[44:47]
ds_read_b64_tr_b16 a[130:131], v6 offset:2048
v_mfma_f32_16x16x32_bf16 v[44:47], a[140:143], a[12:15], v[44:47]
v_mfma_f32_16x16x32_bf16 v[52:55], a[136:139], a[16:19], v[52:55]
ds_read_b64_tr_b16 a[132:133], v6 offset:16384
v_mfma_f32_16x16x32_bf16 v[52:55], a[140:143], a[20:23], v[52:55]
buffer_load_dwordx4 v13, s[8:11], s24 offen offset:1024 lds
v_mfma_f32_16x16x32_bf16 v[60:63], a[136:139], a[24:27], v[60:63]
ds_read_b64_tr_b16 a[134:135], v6 offset:18432
v_mfma_f32_16x16x32_bf16 v[60:63], a[140:143], a[28:31], v[60:63]
v_mfma_f32_16x16x32_bf16 v[68:71], a[136:139], a[32:35], v[68:71]
ds_read_b128 a[76:79], v3 offset:34816
v_mfma_f32_16x16x32_bf16 v[68:71], a[140:143], a[36:39], v[68:71]
buffer_load_dwordx4 v14, s[8:11], s24 offen offset:2048 lds
v_mfma_f32_16x16x32_bf16 v[76:79], a[136:139], a[40:43], v[76:79]
v_mfma_f32_16x16x32_bf16 v[76:79], a[140:143], a[44:47], v[76:79]
v_mfma_f32_16x16x32_bf16 v[84:87], a[136:139], a[48:51], v[84:87]
ds_read_b128 a[80:83], v2 offset:36864
v_mfma_f32_16x16x32_bf16 v[84:87], a[140:143], a[52:55], v[84:87]
buffer_load_dwordx4 v15, s[8:11], s24 offen offset:3072 lds
v_mfma_f32_16x16x32_bf16 v[92:95], a[136:139], a[56:59], v[92:95]
s_add_u32 s24, s24, 128
ds_read_b128 a[84:87], v3 offset:36864
v_mfma_f32_16x16x32_bf16 v[92:95], a[140:143], a[60:63], v[92:95]
s_waitcnt lgkmcnt(5)
v_mfma_f32_16x16x32_bf16 v[96:99], a[128:131], a[0:3], v[96:99]
s_waitcnt lgkmcnt(3)
s_add_u32 m0, s28, 4096
ds_read_b64_tr_b16 a[136:137], v7 offset:0
v_mfma_f32_16x16x32_bf16 v[96:99], a[132:135], a[4:7], v[96:99]
buffer_load_dwordx4 v12, s[8:11], s25 offen offset:0 lds
v_mfma_f32_16x16x32_bf16 v[104:107], a[128:131], a[8:11], v[104:107]
ds_read_b64_tr_b16 a[138:139], v7 offset:2048
v_mfma_f32_16x16x32_bf16 v[104:107], a[132:135], a[12:15], v[104:107]
v_mfma_f32_16x16x32_bf16 v[112:115], a[128:131], a[16:19], v[112:115]
ds_read_b64_tr_b16 a[140:141], v7 offset:16384
v_mfma_f32_16x16x32_bf16 v[112:115], a[132:135], a[20:23], v[112:115]
buffer_load_dwordx4 v13, s[8:11], s25 offen offset:1024 lds
v_mfma_f32_16x16x32_bf16 v[120:123], a[128:131], a[24:27], v[120:123]
ds_read_b64_tr_b16 a[142:143], v7 offset:18432
v_mfma_f32_16x16x32_bf16 v[120:123], a[132:135], a[28:31], v[120:123]
v_mfma_f32_16x16x32_bf16 v[128:131], a[128:131], a[32:35], v[128:131]
v_mfma_f32_16x16x32_bf16 v[128:131], a[132:135], a[36:39], v[128:131]
buffer_load_dwordx4 v14, s[8:11], s25 offen offset:2048 lds
v_mfma_f32_16x16x32_bf16 v[136:139], a[128:131], a[40:43], v[136:139]
ds_read_b128 a[88:91], v2 offset:38912
v_mfma_f32_16x16x32_bf16 v[136:139], a[132:135], a[44:47], v[136:139]
v_mfma_f32_16x16x32_bf16 v[144:147], a[128:131], a[48:51], v[144:147]
ds_read_b128 a[92:95], v3 offset:38912
v_mfma_f32_16x16x32_bf16 v[144:147], a[132:135], a[52:55], v[144:147]
buffer_load_dwordx4 v15, s[8:11], s25 offen offset:3072 lds
v_mfma_f32_16x16x32_bf16 v[152:155], a[128:131], a[56:59], v[152:155]
s_add_u32 s25, s25, 128
v_mfma_f32_16x16x32_bf16 v[152:155], a[132:135], a[60:63], v[152:155]
s_waitcnt lgkmcnt(4)
v_mfma_f32_16x16x32_bf16 v[100:103], a[136:139], a[0:3], v[100:103]
s_waitcnt lgkmcnt(2)
ds_read_b64_tr_b16 a[128:129], v8 offset:0
v_mfma_f32_16x16x32_bf16 v[100:103], a[140:143], a[4:7], v[100:103]
buffer_load_dword v21, v20, s[16:19], s43 offen
v_mfma_f32_16x16x32_bf16 v[108:111], a[136:139], a[8:11], v[108:111]
s_add_u32 s43, s43, s47
ds_read_b64_tr_b16 a[130:131], v8 offset:2048
v_mfma_f32_16x16x32_bf16 v[108:111], a[140:143], a[12:15], v[108:111]
s_cmp_ge_u32 s43, s51
v_mfma_f32_16x16x32_bf16 v[116:119], a[136:139], a[16:19], v[116:119]
s_cselect_b32 s43, 0, s43
ds_read_b64_tr_b16 a[132:133], v8 offset:16384
v_mfma_f32_16x16x32_bf16 v[116:119], a[140:143], a[20:23], v[116:119]
s_cselect_b32 s51, s42, s51
v_mfma_f32_16x16x32_bf16 v[124:127], a[136:139], a[24:27], v[124:127]
s_cselect_b64 s[16:17], s[40:41], s[16:17]
ds_read_b64_tr_b16 a[134:135], v8 offset:18432
v_mfma_f32_16x16x32_bf16 v[124:127], a[140:143], a[28:31], v[124:127]
s_cselect_b32 s18, s42, s18
v_mfma_f32_16x16x32_bf16 v[132:135], a[136:139], a[32:35], v[132:135]
s_cselect_b64 s[40:41], s[44:45], s[40:41]
ds_read_b128 a[96:99], v2 offset:40960
v_mfma_f32_16x16x32_bf16 v[132:135], a[140:143], a[36:39], v[132:135]
s_cselect_b32 s42, s46, s42
v_mfma_f32_16x16x32_bf16 v[140:143], a[136:139], a[40:43], v[140:143]
s_cselect_b32 s46, 0, s46
v_mfma_f32_16x16x32_bf16 v[140:143], a[140:143], a[44:47], v[140:143]
s_cmp_eq_u32 s30, s55
v_mfma_f32_16x16x32_bf16 v[148:151], a[136:139], a[48:51], v[148:151]
s_cselect_b32 s22, 0, 3221225472
ds_read_b128 a[100:103], v3 offset:40960
v_mfma_f32_16x16x32_bf16 v[148:151], a[140:143], a[52:55], v[148:151]
s_sub_u32 s30, s30, 1
buffer_atomic_add v27, v26, s[60:63], s22 offen sc1
v_mfma_f32_16x16x32_bf16 v[156:159], a[136:139], a[56:59], v[156:159]
ds_read_b128 a[104:107], v2 offset:43008
v_mfma_f32_16x16x32_bf16 v[156:159], a[140:143], a[60:63], v[156:159]
s_waitcnt lgkmcnt(5)
v_mfma_f32_16x16x32_bf16 v[160:163], a[128:131], a[0:3], v[160:163]
s_waitcnt lgkmcnt(3)
ds_read_b64_tr_b16 a[136:137], v9 offset:0
v_mfma_f32_16x16x32_bf16 v[160:163], a[132:135], a[4:7], v[160:163]
v_mfma_f32_16x16x32_bf16 v[168:171], a[128:131], a[8:11], v[168:171]
ds_read_b64_tr_b16 a[138:139], v9 offset:2048
v_mfma_f32_16x16x32_bf16 v[168:171], a[132:135], a[12:15], v[168:171]
v_mfma_f32_16x16x32_bf16 v[176:179], a[128:131], a[16:19], v[176:179]
ds_read_b64_tr_b16 a[140:141], v9 offset:16384
v_mfma_f32_16x16x32_bf16 v[176:179], a[132:135], a[20:23], v[176:179]
v_mfma_f32_16x16x32_bf16 v[184:187], a[128:131], a[24:27], v[184:187]
ds_read_b64_tr_b16 a[142:143], v9 offset:18432
v_mfma_f32_16x16x32_bf16 v[184:187], a[132:135], a[28:31], v[184:187]
v_mfma_f32_16x16x32_bf16 v[192:195], a[128:131], a[32:35], v[192:195]
v_mfma_f32_16x16x32_bf16 v[192:195], a[132:135], a[36:39], v[192:195]
v_mfma_f32_16x16x32_bf16 v[200:203], a[128:131], a[40:43], v[200:203]
ds_read_b128 a[108:111], v3 offset:43008
v_mfma_f32_16x16x32_bf16 v[200:203], a[132:135], a[44:47], v[200:203]
v_mfma_f32_16x16x32_bf16 v[208:211], a[128:131], a[48:51], v[208:211]
ds_read_b128 a[112:115], v2 offset:45056
v_mfma_f32_16x16x32_bf16 v[208:211], a[132:135], a[52:55], v[208:211]
v_mfma_f32_16x16x32_bf16 v[216:219], a[128:131], a[56:59], v[216:219]
v_mfma_f32_16x16x32_bf16 v[216:219], a[132:135], a[60:63], v[216:219]
s_waitcnt lgkmcnt(4)
v_mfma_f32_16x16x32_bf16 v[164:167], a[136:139], a[0:3], v[164:167]
s_waitcnt lgkmcnt(2)
ds_read_b64_tr_b16 a[128:129], v10 offset:0
v_mfma_f32_16x16x32_bf16 v[164:167], a[140:143], a[4:7], v[164:167]
v_mfma_f32_16x16x32_bf16 v[172:175], a[136:139], a[8:11], v[172:175]
ds_read_b64_tr_b16 a[130:131], v10 offset:2048
v_mfma_f32_16x16x32_bf16 v[172:175], a[140:143], a[12:15], v[172:175]
v_mfma_f32_16x16x32_bf16 v[180:183], a[136:139], a[16:19], v[180:183]
ds_read_b64_tr_b16 a[132:133], v10 offset:16384
v_mfma_f32_16x16x32_bf16 v[180:183], a[140:143], a[20:23], v[180:183]
v_mfma_f32_16x16x32_bf16 v[188:191], a[136:139], a[24:27], v[188:191]
ds_read_b64_tr_b16 a[134:135], v10 offset:18432
v_mfma_f32_16x16x32_bf16 v[188:191], a[140:143], a[28:31], v[188:191]
v_mfma_f32_16x16x32_bf16 v[196:199], a[136:139], a[32:35], v[196:199]
ds_read_b128 a[116:119], v3 offset:45056
v_mfma_f32_16x16x32_bf16 v[196:199], a[140:143], a[36:39], v[196:199]
v_mfma_f32_16x16x32_bf16 v[204:207], a[136:139], a[40:43], v[204:207]
ds_read_b128 a[120:123], v2 offset:47104
v_mfma_f32_16x16x32_bf16 v[204:207], a[140:143], a[44:47], v[204:207]
v_mfma_f32_16x16x32_bf16 v[212:215], a[136:139], a[48:51], v[212:215]
v_mfma_f32_16x16x32_bf16 v[212:215], a[140:143], a[52:55], v[212:215]
v_mfma_f32_16x16x32_bf16 v[220:223], a[136:139], a[56:59], v[220:223]
ds_read_b128 a[124:127], v3 offset:47104
v_mfma_f32_16x16x32_bf16 v[220:223], a[140:143], a[60:63], v[220:223]
s_waitcnt lgkmcnt(5)
v_mfma_f32_16x16x32_bf16 a[192:195], a[128:131], a[0:3], a[192:195]
s_waitcnt lgkmcnt(3)
ds_read_b64_tr_b16 a[136:137], v11 offset:0
v_mfma_f32_16x16x32_bf16 a[192:195], a[132:135], a[4:7], a[192:195]
v_mfma_f32_16x16x32_bf16 a[200:203], a[128:131], a[8:11], a[200:203]
ds_read_b64_tr_b16 a[138:139], v11 offset:2048
v_mfma_f32_16x16x32_bf16 a[200:203], a[132:135], a[12:15], a[200:203]
v_mfma_f32_16x16x32_bf16 a[208:211], a[128:131], a[16:19], a[208:211]
ds_read_b64_tr_b16 a[140:141], v11 offset:16384
v_mfma_f32_16x16x32_bf16 a[208:211], a[132:135], a[20:23], a[208:211]
v_mfma_f32_16x16x32_bf16 a[216:219], a[128:131], a[24:27], a[216:219]
ds_read_b64_tr_b16 a[142:143], v11 offset:18432
v_mfma_f32_16x16x32_bf16 a[216:219], a[132:135], a[28:31], a[216:219]
v_mfma_f32_16x16x32_bf16 a[224:227], a[128:131], a[32:35], a[224:227]
v_mfma_f32_16x16x32_bf16 a[224:227], a[132:135], a[36:39], a[224:227]
v_mfma_f32_16x16x32_bf16 a[232:235], a[128:131], a[40:43], a[232:235]
v_mfma_f32_16x16x32_bf16 a[232:235], a[132:135], a[44:47], a[232:235]
v_mfma_f32_16x16x32_bf16 a[240:243], a[128:131], a[48:51], a[240:243]
v_mfma_f32_16x16x32_bf16 a[240:243], a[132:135], a[52:55], a[240:243]
v_mfma_f32_16x16x32_bf16 a[248:251], a[128:131], a[56:59], a[248:251]
v_mfma_f32_16x16x32_bf16 a[248:251], a[132:135], a[60:63], a[248:251]
s_waitcnt vmcnt(2) lgkmcnt(0)
s_barrier
v_mfma_f32_16x16x32_bf16 a[196:199], a[136:139], a[0:3], a[196:199]
s_add_u32 m0, s29, 65536
ds_read_b64_tr_b16 a[128:129], v4 offset:32768
v_mfma_f32_16x16x32_bf16 a[196:199], a[140:143], a[4:7], a[196:199]
buffer_load_dwordx4 v16, s[12:15], s26 offen offset:0 lds
v_mfma_f32_16x16x32_bf16 a[204:207], a[136:139], a[8:11], a[204:207]
ds_read_b64_tr_b16 a[130:131], v4 offset:34816
v_mfma_f32_16x16x32_bf16 a[204:207], a[140:143], a[12:15], a[204:207]
v_mfma_f32_16x16x32_bf16 a[212:215], a[136:139], a[16:19], a[212:215]
ds_read_b64_tr_b16 a[132:133], v4 offset:49152
v_mfma_f32_16x16x32_bf16 a[212:215], a[140:143], a[20:23], a[212:215]
buffer_load_dwordx4 v17, s[12:15], s26 offen offset:1024 lds
v_mfma_f32_16x16x32_bf16 a[220:223], a[136:139], a[24:27], a[220:223]
ds_read_b64_tr_b16 a[134:135], v4 offset:51200
v_mfma_f32_16x16x32_bf16 a[220:223], a[140:143], a[28:31], a[220:223]
v_mfma_f32_16x16x32_bf16 a[228:231], a[136:139], a[32:35], a[228:231]
v_mfma_f32_16x16x32_bf16 a[228:231], a[140:143], a[36:39], a[228:231]
buffer_load_dwordx4 v18, s[12:15], s26 offen offset:2048 lds
v_mfma_f32_16x16x32_bf16 a[236:239], a[136:139], a[40:43], a[236:239]
v_mfma_f32_16x16x32_bf16 a[236:239], a[140:143], a[44:47], a[236:239]
v_mfma_f32_16x16x32_bf16 a[244:247], a[136:139], a[48:51], a[244:247]
v_mfma_f32_16x16x32_bf16 a[244:247], a[140:143], a[52:55], a[244:247]
buffer_load_dwordx4 v19, s[12:15], s26 offen offset:3072 lds
v_mfma_f32_16x16x32_bf16 a[252:255], a[136:139], a[56:59], a[252:255]
s_add_u32 s26, s26, 524288
v_mfma_f32_16x16x32_bf16 a[252:255], a[140:143], a[60:63], a[252:255]
s_waitcnt lgkmcnt(2)
s_bitcmp1_b32 s30, 1
s_cbranch_scc1 Lg_1
s_cmp_eq_u32 s30, 0
s_cbranch_scc1 Lg_1t
v_mfma_f32_16x16x32_bf16 v[32:35], a[128:131], a[64:67], v[32:35]
s_waitcnt lgkmcnt(0)
s_add_u32 m0, s29, 81920
ds_read_b64_tr_b16 a[136:137], v5 offset:32768
v_mfma_f32_16x16x32_bf16 v[32:35], a[132:135], a[68:71], v[32:35]
buffer_load_dwordx4 v16, s[12:15], s27 offen offset:0 lds
v_mfma_f32_16x16x32_bf16 v[40:43], a[128:131], a[72:75], v[40:43]
s_lshl_b32 s22, s38, 3
ds_read_b64_tr_b16 a[138:139], v5 offset:34816
v_mfma_f32_16x16x32_bf16 v[40:43], a[132:135], a[76:79], v[40:43]
s_lshl_b32 s23, s39, 5
v_and_b32 v252, 31, v0
v_lshrrev_b32 v253, 5, v0
v_mfma_f32_16x16x32_bf16 v[48:51], a[128:131], a[80:83], v[48:51]
ds_read_b64_tr_b16 a[140:141], v5 offset:49152
v_add_u32 v253, s22, v253
v_mfma_f32_16x16x32_bf16 v[48:51], a[132:135], a[84:87], v[48:51]
buffer_load_dwordx4 v17, s[12:15], s27 offen offset:1024 lds
v_mfma_f32_16x16x32_bf16 v[56:59], a[128:131], a[88:91], v[56:59]
ds_read_b64_tr_b16 a[142:143], v5 offset:51200
v_add_u32 v252, s23, v252
v_mfma_f32_16x16x32_bf16 v[56:59], a[132:135], a[92:95], v[56:59]
v_mul_u32_u24 v254, 7168, v253
v_lshl_add_u32 v254, v252, 2, v254
v_mfma_f32_16x16x32_bf16 v[64:67], a[128:131], a[96:99], v[64:67]
ds_read_b128 a[0:3], v2 offset:0
v_lshlrev_b32 v252, 4, v252
v_mfma_f32_16x16x32_bf16 v[64:67], a[132:135], a[100:103], v[64:67]
buffer_load_dwordx4 v18, s[12:15], s27 offen offset:2048 lds
v_mfma_f32_16x16x32_bf16 v[72:75], a[128:131], a[104:107], v[72:75]
ds_read_b128 a[4:7], v3 offset:0
v_add_u32 v255, 3584, v254
v_mfma_f32_16x16x32_bf16 v[72:75], a[132:135], a[108:111], v[72:75]
v_subrev_u32 v22, 3584, v254
v_subrev_u32 v23, 2688, v254
v_mfma_f32_16x16x32_bf16 v[80:83], a[128:131], a[112:115], v[80:83]
v_subrev_u32 v24, 1792, v254
v_subrev_u32 v25, 896, v254
v_mfma_f32_16x16x32_bf16 v[80:83], a[132:135], a[116:119], v[80:83]
buffer_load_dwordx4 v19, s[12:15], s27 offen offset:3072 lds
v_mfma_f32_16x16x32_bf16 v[88:91], a[128:131], a[120:123], v[88:91]
s_add_u32 s27, s27, 524288
ds_read_b128 a[8:11], v2 offset:2048
v_mfma_f32_16x16x32_bf16 v[88:91], a[132:135], a[124:127], v[88:91]
s_waitcnt lgkmcnt(5)
v_mfma_f32_16x16x32_bf16 v[36:39], a[136:139], a[64:67], v[36:39]
s_waitcnt lgkmcnt(3)
s_add_u32 m0, s28, 32768
ds_read_b64_tr_b16 a[128:129], v6 offset:32768
v_mfma_f32_16x16x32_bf16 v[36:39], a[140:143], a[68:71], v[36:39]
buffer_load_dwordx4 v12, s[8:11], s24 offen offset:0 lds
v_mfma_f32_16x16x32_bf16 v[44:47], a[136:139], a[72:75], v[44:47]
ds_read_b64_tr_b16 a[130:131], v6 offset:34816
v_mfma_f32_16x16x32_bf16 v[44:47], a[140:143], a[76:79], v[44:47]
v_mfma_f32_16x16x32_bf16 v[52:55], a[136:139], a[80:83], v[52:55]
ds_read_b64_tr_b16 a[132:133], v6 offset:49152
v_mfma_f32_16x16x32_bf16 v[52:55], a[140:143], a[84:87], v[52:55]
buffer_load_dwordx4 v13, s[8:11], s24 offen offset:1024 lds
v_mfma_f32_16x16x32_bf16 v[60:63], a[136:139], a[88:91], v[60:63]
ds_read_b64_tr_b16 a[134:135], v6 offset:51200
v_mfma_f32_16x16x32_bf16 v[60:63], a[140:143], a[92:95], v[60:63]
v_mfma_f32_16x16x32_bf16 v[68:71], a[136:139], a[96:99], v[68:71]
ds_read_b128 a[12:15], v3 offset:2048
v_mfma_f32_16x16x32_bf16 v[68:71], a[140:143], a[100:103], v[68:71]
buffer_load_dwordx4 v14, s[8:11], s24 offen offset:2048 lds
v_mfma_f32_16x16x32_bf16 v[76:79], a[136:139], a[104:107], v[76:79]
v_mfma_f32_16x16x32_bf16 v[76:79], a[140:143], a[108:111], v[76:79]
v_mfma_f32_16x16x32_bf16 v[84:87], a[136:139], a[112:115], v[84:87]
ds_read_b128 a[16:19], v2 offset:4096
v_mfma_f32_16x16x32_bf16 v[84:87], a[140:143], a[116:119], v[84:87]
buffer_load_dwordx4 v15, s[8:11], s24 offen offset:3072 lds
v_mfma_f32_16x16x32_bf16 v[92:95], a[136:139], a[120:123], v[92:95]
s_add_u32 s24, s24, 128
ds_read_b128 a[20:23], v3 offset:4096
v_mfma_f32_16x16x32_bf16 v[92:95], a[140:143], a[124:127], v[92:95]
s_waitcnt lgkmcnt(5)
v_mfma_f32_16x16x32_bf16 v[96:99], a[128:131], a[64:67], v[96:99]
s_waitcnt lgkmcnt(3)
s_add_u32 m0, s28, 36864
ds_read_b64_tr_b16 a[136:137], v7 offset:32768
v_mfma_f32_16x16x32_bf16 v[96:99], a[132:135], a[68:71], v[96:99]
buffer_load_dwordx4 v12, s[8:11], s25 offen offset:0 lds
v_mfma_f32_16x16x32_bf16 v[104:107], a[128:131], a[72:75], v[104:107]
ds_read_b64_tr_b16 a[138:139], v7 offset:34816
v_mfma_f32_16x16x32_bf16 v[104:107], a[132:135], a[76:79], v[104:107]
v_mfma_f32_16x16x32_bf16 v[112:115], a[128:131], a[80:83], v[112:115]
ds_read_b64_tr_b16 a[140:141], v7 offset:49152
v_mfma_f32_16x16x32_bf16 v[112:115], a[132:135], a[84:87], v[112:115]
buffer_load_dwordx4 v13, s[8:11], s25 offen offset:1024 lds
v_mfma_f32_16x16x32_bf16 v[120:123], a[128:131], a[88:91], v[120:123]
ds_read_b64_tr_b16 a[142:143], v7 offset:51200
v_mfma_f32_16x16x32_bf16 v[120:123], a[132:135], a[92:95], v[120:123]
v_mfma_f32_16x16x32_bf16 v[128:131], a[128:131], a[96:99], v[128:131]
v_mfma_f32_16x16x32_bf16 v[128:131], a[132:135], a[100:103], v[128:131]
buffer_load_dwordx4 v14, s[8:11], s25 offen offset:2048 lds
v_mfma_f32_16x16x32_bf16 v[136:139], a[128:131], a[104:107], v[136:139]
ds_read_b128 a[24:27], v2 offset:6144
v_mfma_f32_16x16x32_bf16 v[136:139], a[132:135], a[108:111], v[136:139]
v_mfma_f32_16x16x32_bf16 v[144:147], a[128:131], a[112:115], v[144:147]
ds_read_b128 a[28:31], v3 offset:6144
v_mfma_f32_16x16x32_bf16 v[144:147], a[132:135], a[116:119], v[144:147]
buffer_load_dwordx4 v15, s[8:11], s25 offen offset:3072 lds
v_mfma_f32_16x16x32_bf16 v[152:155], a[128:131], a[120:123], v[152:155]
s_add_u32 s25, s25, 128
v_mfma_f32_16x16x32_bf16 v[152:155], a[132:135], a[124:127], v[152:155]
s_waitcnt lgkmcnt(2)
v_mfma_f32_16x16x32_bf16 v[100:103], a[136:139], a[64:67], v[100:103]
s_mov_b64 s[56:57], s[70:71]
s_mov_b32 s58, 3584
s_mov_b32 s59, 0x20000
ds_read_b64_tr_b16 a[128:129], v8 offset:32768
buffer_load_dwordx4 v[248:251], v252, s[56:59], 0 offen
v_mfma_f32_16x16x32_bf16 v[100:103], a[140:143], a[68:71], v[100:103]
s_mov_b64 s[56:57], s[66:67]
s_mov_b32 s58, 1835008
buffer_load_dword v224, v22, s[56:59], 0 offen nt
v_mfma_f32_16x16x32_bf16 v[108:111], a[136:139], a[72:75], v[108:111]
ds_read_b64_tr_b16 a[130:131], v8 offset:34816
buffer_load_dword v225, v23, s[56:59], 0 offen nt
v_mfma_f32_16x16x32_bf16 v[108:111], a[140:143], a[76:79], v[108:111]
buffer_load_dword v226, v24, s[56:59], 0 offen nt
v_mfma_f32_16x16x32_bf16 v[116:119], a[136:139], a[80:83], v[116:119]
ds_read_b64_tr_b16 a[132:133], v8 offset:49152
buffer_load_dword v227, v25, s[56:59], 0 offen nt
v_mfma_f32_16x16x32_bf16 v[116:119], a[140:143], a[84:87], v[116:119]
buffer_load_dword v228, v254, s[56:59], 0 offen offset:0 nt
v_mfma_f32_16x16x32_bf16 v[124:127], a[136:139], a[88:91], v[124:127]
ds_read_b64_tr_b16 a[134:135], v8 offset:51200
buffer_load_dword v229, v254, s[56:59], 0 offen offset:896 nt
v_mfma_f32_16x16x32_bf16 v[124:127], a[140:143], a[92:95], v[124:127]
buffer_load_dword v230, v254, s[56:59], 0 offen offset:1792 nt
v_mfma_f32_16x16x32_bf16 v[132:135], a[136:139], a[96:99], v[132:135]
ds_read_b128 a[32:35], v2 offset:8192
buffer_load_dword v231, v254, s[56:59], 0 offen offset:2688 nt
v_mfma_f32_16x16x32_bf16 v[132:135], a[140:143], a[100:103], v[132:135]
buffer_load_dword v232, v255, s[56:59], 0 offen offset:0 nt
v_mfma_f32_16x16x32_bf16 v[140:143], a[136:139], a[104:107], v[140:143]
buffer_load_dword v233, v255, s[56:59], 0 offen offset:896 nt
v_mfma_f32_16x16x32_bf16 v[140:143], a[140:143], a[108:111], v[140:143]
buffer_load_dword v234, v255, s[56:59], 0 offen offset:1792 nt
v_mfma_f32_16x16x32_bf16 v[148:151], a[136:139], a[112:115], v[148:151]
ds_read_b128 a[36:39], v3 offset:8192
buffer_load_dword v235, v255, s[56:59], 0 offen offset:2688 nt
v_mfma_f32_16x16x32_bf16 v[148:151], a[140:143], a[116:119], v[148:151]
s_mov_b64 s[56:57], s[68:69]
buffer_load_dword v236, v25, s[56:59], 0 offen nt
v_mfma_f32_16x16x32_bf16 v[156:159], a[136:139], a[120:123], v[156:159]
ds_read_b128 a[40:43], v2 offset:10240
buffer_load_dword v237, v254, s[56:59], 0 offen offset:0 nt
v_mfma_f32_16x16x32_bf16 v[156:159], a[140:143], a[124:127], v[156:159]
s_waitcnt lgkmcnt(5)
buffer_load_dword v238, v254, s[56:59], 0 offen offset:896 nt
v_mfma_f32_16x16x32_bf16 v[160:163], a[128:131], a[64:67], v[160:163]
s_waitcnt lgkmcnt(3)
ds_read_b64_tr_b16 a[136:137], v9 offset:32768
buffer_load_dword v239, v254, s[56:59], 0 offen offset:1792 nt
v_mfma_f32_16x16x32_bf16 v[160:163], a[132:135], a[68:71], v[160:163]
buffer_load_dword v240, v254, s[56:59], 0 offen offset:2688 nt
v_mfma_f32_16x16x32_bf16 v[168:171], a[128:131], a[72:75], v[168:171]
ds_read_b64_tr_b16 a[138:139], v9 offset:34816
buffer_load_dword v241, v255, s[56:59], 0 offen offset:0 nt
v_mfma_f32_16x16x32_bf16 v[168:171], a[132:135], a[76:79], v[168:171]
buffer_load_dword v242, v255, s[56:59], 0 offen offset:896 nt
v_mfma_f32_16x16x32_bf16 v[176:179], a[128:131], a[80:83], v[176:179]
ds_read_b64_tr_b16 a[140:141], v9 offset:49152
buffer_load_dword v243, v255, s[56:59], 0 offen offset:1792 nt
v_mfma_f32_16x16x32_bf16 v[176:179], a[132:135], a[84:87], v[176:179]
buffer_load_dword v244, v255, s[56:59], 0 offen offset:2688 nt
v_mfma_f32_16x16x32_bf16 v[184:187], a[128:131], a[88:91], v[184:187]
ds_read_b64_tr_b16 a[142:143], v9 offset:51200
v_mfma_f32_16x16x32_bf16 v[184:187], a[132:135], a[92:95], v[184:187]
v_mfma_f32_16x16x32_bf16 v[192:195], a[128:131], a[96:99], v[192:195]
v_mfma_f32_16x16x32_bf16 v[192:195], a[132:135], a[100:103], v[192:195]
v_mfma_f32_16x16x32_bf16 v[200:203], a[128:131], a[104:107], v[200:203]
ds_read_b128 a[44:47], v3 offset:10240
v_mfma_f32_16x16x32_bf16 v[200:203], a[132:135], a[108:111], v[200:203]
v_mfma_f32_16x16x32_bf16 v[208:211], a[128:131], a[112:115], v[208:211]
ds_read_b128 a[48:51], v2 offset:12288
v_mfma_f32_16x16x32_bf16 v[208:211], a[132:135], a[116:119], v[208:211]
v_mfma_f32_16x16x32_bf16 v[216:219], a[128:131], a[120:123], v[216:219]
v_mfma_f32_16x16x32_bf16 v[216:219], a[132:135], a[124:127], v[216:219]
s_waitcnt lgkmcnt(4)
v_mfma_f32_16x16x32_bf16 v[164:167], a[136:139], a[64:67], v[164:167]
s_waitcnt lgkmcnt(2)
ds_read_b64_tr_b16 a[128:129], v10 offset:32768
v_mfma_f32_16x16x32_bf16 v[164:167], a[140:143], a[68:71], v[164:167]
v_mfma_f32_16x16x32_bf16 v[172:175], a[136:139], a[72:75], v[172:175]
ds_read_b64_tr_b16 a[130:131], v10 offset:34816
v_mfma_f32_16x16x32_bf16 v[172:175], a[140:143], a[76:79], v[172:175]
v_mfma_f32_16x16x32_bf16 v[180:183], a[136:139], a[80:83], v[180:183]
ds_read_b64_tr_b16 a[132:133], v10 offset:49152
v_mfma_f32_16x16x32_bf16 v[180:183], a[140:143], a[84:87], v[180:183]
v_mfma_f32_16x16x32_bf16 v[188:191], a[136:139], a[88:91], v[188:191]
ds_read_b64_tr_b16 a[134:135], v10 offset:51200
v_mfma_f32_16x16x32_bf16 v[188:191], a[140:143], a[92:95], v[188:191]
v_mfma_f32_16x16x32_bf16 v[196:199], a[136:139], a[96:99], v[196:199]
ds_read_b128 a[52:55], v3 offset:12288
v_mfma_f32_16x16x32_bf16 v[196:199], a[140:143], a[100:103], v[196:199]
v_mfma_f32_16x16x32_bf16 v[204:207], a[136:139], a[104:107], v[204:207]
ds_read_b128 a[56:59], v2 offset:14336
v_mfma_f32_16x16x32_bf16 v[204:207], a[140:143], a[108:111], v[204:207]
v_mfma_f32_16x16x32_bf16 v[212:215], a[136:139], a[112:115], v[212:215]
v_mfma_f32_16x16x32_bf16 v[212:215], a[140:143], a[116:119], v[212:215]
v_mfma_f32_16x16x32_bf16 v[220:223], a[136:139], a[120:123], v[220:223]
ds_read_b128 a[60:63], v3 offset:14336
v_mfma_f32_16x16x32_bf16 v[220:223], a[140:143], a[124:127], v[220:223]
s_waitcnt lgkmcnt(5)
v_mfma_f32_16x16x32_bf16 a[192:195], a[128:131], a[64:67], a[192:195]
s_waitcnt lgkmcnt(3)
ds_read_b64_tr_b16 a[136:137], v11 offset:32768
v_mfma_f32_16x16x32_bf16 a[192:195], a[132:135], a[68:71], a[192:195]
v_mfma_f32_16x16x32_bf16 a[200:203], a[128:131], a[72:75], a[200:203]
ds_read_b64_tr_b16 a[138:139], v11 offset:34816
v_mfma_f32_16x16x32_bf16 a[200:203], a[132:135], a[76:79], a[200:203]
v_mfma_f32_16x16x32_bf16 a[208:211], a[128:131], a[80:83], a[208:211]
ds_read_b64_tr_b16 a[140:141], v11 offset:49152
v_mfma_f32_16x16x32_bf16 a[208:211], a[132:135], a[84:87], a[208:211]
v_mfma_f32_16x16x32_bf16 a[216:219], a[128:131], a[88:91], a[216:219]
ds_read_b64_tr_b16 a[142:143], v11 offset:51200
v_mfma_f32_16x16x32_bf16 a[216:219], a[132:135], a[92:95], a[216:219]
v_mfma_f32_16x16x32_bf16 a[224:227], a[128:131], a[96:99], a[224:227]
v_mfma_f32_16x16x32_bf16 a[224:227], a[132:135], a[100:103], a[224:227]
v_mfma_f32_16x16x32_bf16 a[232:235], a[128:131], a[104:107], a[232:235]
v_mfma_f32_16x16x32_bf16 a[232:235], a[132:135], a[108:111], a[232:235]
v_mfma_f32_16x16x32_bf16 a[240:243], a[128:131], a[112:115], a[240:243]
v_mfma_f32_16x16x32_bf16 a[240:243], a[132:135], a[116:119], a[240:243]
v_mfma_f32_16x16x32_bf16 a[248:251], a[128:131], a[120:123], a[248:251]
v_mfma_f32_16x16x32_bf16 a[248:251], a[132:135], a[124:127], a[248:251]
s_waitcnt vmcnt(22) lgkmcnt(0)
s_barrier
v_mfma_f32_16x16x32_bf16 a[196:199], a[136:139], a[64:67], a[196:199]
s_add_u32 m0, s29, 98304
ds_read_b64_tr_b16 a[128:129], v4 offset:0
v_mfma_f32_16x16x32_bf16 a[196:199], a[140:143], a[68:71], a[196:199]
buffer_load_dwordx4 v16, s[12:15], s26 offen offset:0 lds
v_mfma_f32_16x16x32_bf16 a[204:207], a[136:139], a[72:75], a[204:207]
ds_read_b64_tr_b16 a[130:131], v4 offset:2048
v_mfma_f32_16x16x32_bf16 a[204:207], a[140:143], a[76:79], a[204:207]
v_mfma_f32_16x16x32_bf16 a[212:215], a[136:139], a[80:83], a[212:215]
ds_read_b64_tr_b16 a[132:133], v4 offset:16384
v_mfma_f32_16x16x32_bf16 a[212:215], a[140:143], a[84:87], a[212:215]
buffer_load_dwordx4 v17, s[12:15], s26 offen offset:1024 lds
v_mfma_f32_16x16x32_bf16 a[220:223], a[136:139], a[88:91], a[220:223]
ds_read_b64_tr_b16 a[134:135], v4 offset:18432
v_mfma_f32_16x16x32_bf16 a[220:223], a[140:143], a[92:95], a[220:223]
v_mfma_f32_16x16x32_bf16 a[228:231], a[136:139], a[96:99], a[228:231]
v_mfma_f32_16x16x32_bf16 a[228:231], a[140:143], a[100:103], a[228:231]
buffer_load_dwordx4 v18, s[12:15], s26 offen offset:2048 lds
v_mfma_f32_16x16x32_bf16 a[236:239], a[136:139], a[104:107], a[236:239]
v_mfma_f32_16x16x32_bf16 a[236:239], a[140:143], a[108:111], a[236:239]
v_mfma_f32_16x16x32_bf16 a[244:247], a[136:139], a[112:115], a[244:247]
v_mfma_f32_16x16x32_bf16 a[244:247], a[140:143], a[116:119], a[244:247]
buffer_load_dwordx4 v19, s[12:15], s26 offen offset:3072 lds
v_mfma_f32_16x16x32_bf16 a[252:255], a[136:139], a[120:123], a[252:255]
s_add_u32 s26, s26, 524288
v_mfma_f32_16x16x32_bf16 a[252:255], a[140:143], a[124:127], a[252:255]
s_waitcnt lgkmcnt(2)
v_mfma_f32_16x16x32_bf16 v[32:35], a[128:131], a[0:3], v[32:35]
s_waitcnt lgkmcnt(0)
s_add_u32 m0, s29, 114688
ds_read_b64_tr_b16 a[136:137], v5 offset:0
v_mfma_f32_16x16x32_bf16 v[32:35], a[132:135], a[4:7], v[32:35]
buffer_load_dwordx4 v16, s[12:15], s27 offen offset:0 lds
v_mfma_f32_16x16x32_bf16 v[40:43], a[128:131], a[8:11], v[40:43]
ds_read_b64_tr_b16 a[138:139], v5 offset:2048
v_mfma_f32_16x16x32_bf16 v[40:43], a[132:135], a[12:15], v[40:43]
v_mfma_f32_16x16x32_bf16 v[48:51], a[128:131], a[16:19], v[48:51]
ds_read_b64_tr_b16 a[140:141], v5 offset:16384
v_mfma_f32_16x16x32_bf16 v[48:51], a[132:135], a[20:23], v[48:51]
buffer_load_dwordx4 v17, s[12:15], s27 offen offset:1024 lds
v_mfma_f32_16x16x32_bf16 v[56:59], a[128:131], a[24:27], v[56:59]
ds_read_b64_tr_b16 a[142:143], v5 offset:18432
v_mfma_f32_16x16x32_bf16 v[56:59], a[132:135], a[28:31], v[56:59]
v_mfma_f32_16x16x32_bf16 v[64:67], a[128:131], a[32:35], v[64:67]
ds_read_b128 a[64:67], v2 offset:32768
v_mfma_f32_16x16x32_bf16 v[64:67], a[132:135], a[36:39], v[64:67]
buffer_load_dwordx4 v18, s[12:15], s27 offen offset:2048 lds
v_mfma_f32_16x16x32_bf16 v[72:75], a[128:131], a[40:43], v[72:75]
ds_read_b128 a[68:71], v3 offset:32768
v_mfma_f32_16x16x32_bf16 v[72:75], a[132:135], a[44:47], v[72:75]
v_mfma_f32_16x16x32_bf16 v[80:83], a[128:131], a[48:51], v[80:83]
v_mfma_f32_16x16x32_bf16 v[80:83], a[132:135], a[52:55], v[80:83]
buffer_load_dwordx4 v19, s[12:15], s27 offen offset:3072 lds
v_mfma_f32_16x16x32_bf16 v[88:91], a[128:131], a[56:59], v[88:91]
s_add_u32 s27, s27, 524288
ds_read_b128 a[72:75], v2 offset:34816
v_mfma_f32_16x16x32_bf16 v[88:91], a[132:135], a[60:63], v[88:91]
s_waitcnt lgkmcnt(5)
v_mfma_f32_16x16x32_bf16 v[36:39], a[136:139], a[0:3], v[36:39]
s_waitcnt lgkmcnt(3)
s_add_u32 m0, s28, 0
ds_read_b64_tr_b16 a[128:129], v6 offset:0
v_mfma_f32_16x16x32_bf16 v[36:39], a[140:143], a[4:7], v[36:39]
buffer_load_dwordx4 v12, s[8:11], s24 offen offset:0 lds
v_mfma_f32_16x16x32_bf16 v[44:47], a[136:139], a[8:11], v[44:47]
ds_read_b64_tr_b16 a[130:131], v6 offset:2048
v_mfma_f32_16x16x32_bf16 v[44:47], a[140:143], a[12:15], v[44:47]
v_mfma_f32_16x16x32_bf16 v[52:55], a[136:139], a[16:19], v[52:55]
ds_read_b64_tr_b16 a[132:133], v6 offset:16384
v_mfma_f32_16x16x32_bf16 v[52:55], a[140:143], a[20:23], v[52:55]
buffer_load_dwordx4 v13, s[8:11], s24 offen offset:1024 lds
v_mfma_f32_16x16x32_bf16 v[60:63], a[136:139], a[24:27], v[60:63]
ds_read_b64_tr_b16 a[134:135], v6 offset:18432
v_mfma_f32_16x16x32_bf16 v[60:63], a[140:143], a[28:31], v[60:63]
v_mfma_f32_16x16x32_bf16 v[68:71], a[136:139], a[32:35], v[68:71]
ds_read_b128 a[76:79], v3 offset:34816
v_mfma_f32_16x16x32_bf16 v[68:71], a[140:143], a[36:39], v[68:71]
buffer_load_dwordx4 v14, s[8:11], s24 offen offset:2048 lds
v_mfma_f32_16x16x32_bf16 v[76:79], a[136:139], a[40:43], v[76:79]
v_mfma_f32_16x16x32_bf16 v[76:79], a[140:143], a[44:47], v[76:79]
v_mfma_f32_16x16x32_bf16 v[84:87], a[136:139], a[48:51], v[84:87]
ds_read_b128 a[80:83], v2 offset:36864
v_mfma_f32_16x16x32_bf16 v[84:87], a[140:143], a[52:55], v[84:87]
buffer_load_dwordx4 v15, s[8:11], s24 offen offset:3072 lds
v_mfma_f32_16x16x32_bf16 v[92:95], a[136:139], a[56:59], v[92:95]
s_add_u32 s24, s24, 128
ds_read_b128 a[84:87], v3 offset:36864
v_mfma_f32_16x16x32_bf16 v[92:95], a[140:143], a[60:63], v[92:95]
s_waitcnt lgkmcnt(5)
v_mfma_f32_16x16x32_bf16 v[96:99], a[128:131], a[0:3], v[96:99]
s_waitcnt lgkmcnt(3)
s_add_u32 m0, s28, 4096
ds_read_b64_tr_b16 a[136:137], v7 offset:0
v_mfma_f32_16x16x32_bf16 v[96:99], a[132:135], a[4:7], v[96:99]
buffer_load_dwordx4 v12, s[8:11], s25 offen offset:0 lds
v_mfma_f32_16x16x32_bf16 v[104:107], a[128:131], a[8:11], v[104:107]
ds_read_b64_tr_b16 a[138:139], v7 offset:2048
v_mfma_f32_16x16x32_bf16 v[104:107], a[132:135], a[12:15], v[104:107]
v_mfma_f32_16x16x32_bf16 v[112:115], a[128:131], a[16:19], v[112:115]
ds_read_b64_tr_b16 a[140:141], v7 offset:16384
v_mfma_f32_16x16x32_bf16 v[112:115], a[132:135], a[20:23], v[112:115]
buffer_load_dwordx4 v13, s[8:11], s25 offen offset:1024 lds
v_mfma_f32_16x16x32_bf16 v[120:123], a[128:131], a[24:27], v[120:123]
ds_read_b64_tr_b16 a[142:143], v7 offset:18432
v_mfma_f32_16x16x32_bf16 v[120:123], a[132:135], a[28:31], v[120:123]
v_mfma_f32_16x16x32_bf16 v[128:131], a[128:131], a[32:35], v[128:131]
v_mfma_f32_16x16x32_bf16 v[128:131], a[132:135], a[36:39], v[128:131]
buffer_load_dwordx4 v14, s[8:11], s25 offen offset:2048 lds
v_mfma_f32_16x16x32_bf16 v[136:139], a[128:131], a[40:43], v[136:139]
ds_read_b128 a[88:91], v2 offset:38912
v_mfma_f32_16x16x32_bf16 v[136:139], a[132:135], a[44:47], v[136:139]
v_mfma_f32_16x16x32_bf16 v[144:147], a[128:131], a[48:51], v[144:147]
ds_read_b128 a[92:95], v3 offset:38912
v_mfma_f32_16x16x32_bf16 v[144:147], a[132:135], a[52:55], v[144:147]
buffer_load_dwordx4 v15, s[8:11], s25 offen offset:3072 lds
v_mfma_f32_16x16x32_bf16 v[152:155], a[128:131], a[56:59], v[152:155]
s_add_u32 s25, s25, 128
v_mfma_f32_16x16x32_bf16 v[152:155], a[132:135], a[60:63], v[152:155]
s_waitcnt lgkmcnt(4)
v_mfma_f32_16x16x32_bf16 v[100:103], a[136:139], a[0:3], v[100:103]
s_waitcnt lgkmcnt(2)
ds_read_b64_tr_b16 a[128:129], v8 offset:0
v_mfma_f32_16x16x32_bf16 v[100:103], a[140:143], a[4:7], v[100:103]
buffer_load_dword v21, v20, s[16:19], s43 offen
v_mfma_f32_16x16x32_bf16 v[108:111], a[136:139], a[8:11], v[108:111]
s_add_u32 s43, s43, s47
ds_read_b64_tr_b16 a[130:131], v8 offset:2048
v_mfma_f32_16x16x32_bf16 v[108:111], a[140:143], a[12:15], v[108:111]
s_cmp_ge_u32 s43, s51
v_mfma_f32_16x16x32_bf16 v[116:119], a[136:139], a[16:19], v[116:119]
s_cselect_b32 s43, 0, s43
ds_read_b64_tr_b16 a[132:133], v8 offset:16384
v_mfma_f32_16x16x32_bf16 v[116:119], a[140:143], a[20:23], v[116:119]
s_cselect_b32 s51, s42, s51
v_mfma_f32_16x16x32_bf16 v[124:127], a[136:139], a[24:27], v[124:127]
s_cselect_b64 s[16:17], s[40:41], s[16:17]
ds_read_b64_tr_b16 a[134:135], v8 offset:18432
v_mfma_f32_16x16x32_bf16 v[124:127], a[140:143], a[28:31], v[124:127]
s_cselect_b32 s18, s42, s18
v_mfma_f32_16x16x32_bf16 v[132:135], a[136:139], a[32:35], v[132:135]
s_cselect_b64 s[40:41], s[44:45], s[40:41]
ds_read_b128 a[96:99], v2 offset:40960
v_mfma_f32_16x16x32_bf16 v[132:135], a[140:143], a[36:39], v[132:135]
s_cselect_b32 s42, s46, s42
v_mfma_f32_16x16x32_bf16 v[140:143], a[136:139], a[40:43], v[140:143]
s_cselect_b32 s46, 0, s46
v_mfma_f32_16x16x32_bf16 v[140:143], a[140:143], a[44:47], v[140:143]
s_lshl_b32 s59, s39, 5
v_mfma_f32_16x16x32_bf16 v[148:151], a[136:139], a[48:51], v[148:151]
s_add_u32 s59, s59, s38
ds_read_b128 a[100:103], v3 offset:40960
v_mfma_f32_16x16x32_bf16 v[148:151], a[140:143], a[52:55], v[148:151]
s_lshl_b32 s59, s59, 2
v_mfma_f32_16x16x32_bf16 v[156:159], a[136:139], a[56:59], v[156:159]
s_add_u32 s59, s59, 94392320
ds_read_b128 a[104:107], v2 offset:43008
v_mfma_f32_16x16x32_bf16 v[156:159], a[140:143], a[60:63], v[156:159]
s_waitcnt lgkmcnt(5)
s_cmp_lt_u32 s2, 224
v_mfma_f32_16x16x32_bf16 v[160:163], a[128:131], a[0:3], v[160:163]
s_waitcnt lgkmcnt(3)
s_cselect_b32 s59, s59, 3221225472
ds_read_b64_tr_b16 a[136:137], v9 offset:0
v_mfma_f32_16x16x32_bf16 v[160:163], a[132:135], a[4:7], v[160:163]
buffer_load_dword v21, v20, s[16:19], s43 offen
v_mfma_f32_16x16x32_bf16 v[168:171], a[128:131], a[8:11], v[168:171]
s_add_u32 s43, s43, s47
ds_read_b64_tr_b16 a[138:139], v9 offset:2048
v_mfma_f32_16x16x32_bf16 v[168:171], a[132:135], a[12:15], v[168:171]
s_cmp_ge_u32 s43, s51
v_mfma_f32_16x16x32_bf16 v[176:179], a[128:131], a[16:19], v[176:179]
s_cselect_b32 s43, 0, s43
ds_read_b64_tr_b16 a[140:141], v9 offset:16384
v_mfma_f32_16x16x32_bf16 v[176:179], a[132:135], a[20:23], v[176:179]
s_cselect_b32 s51, s42, s51
v_mfma_f32_16x16x32_bf16 v[184:187], a[128:131], a[24:27], v[184:187]
s_cselect_b64 s[16:17], s[40:41], s[16:17]
ds_read_b64_tr_b16 a[142:143], v9 offset:18432
v_mfma_f32_16x16x32_bf16 v[184:187], a[132:135], a[28:31], v[184:187]
s_cselect_b32 s18, s42, s18
v_mfma_f32_16x16x32_bf16 v[192:195], a[128:131], a[32:35], v[192:195]
s_cselect_b64 s[40:41], s[44:45], s[40:41]
v_mfma_f32_16x16x32_bf16 v[192:195], a[132:135], a[36:39], v[192:195]
s_cselect_b32 s42, s46, s42
v_mfma_f32_16x16x32_bf16 v[200:203], a[128:131], a[40:43], v[200:203]
s_cselect_b32 s46, 0, s46
ds_read_b128 a[108:111], v3 offset:43008
v_mfma_f32_16x16x32_bf16 v[200:203], a[132:135], a[44:47], v[200:203]
v_mfma_f32_16x16x32_bf16 v[208:211], a[128:131], a[48:51], v[208:211]
ds_read_b128 a[112:115], v2 offset:45056
v_mfma_f32_16x16x32_bf16 v[208:211], a[132:135], a[52:55], v[208:211]
v_mfma_f32_16x16x32_bf16 v[216:219], a[128:131], a[56:59], v[216:219]
v_mfma_f32_16x16x32_bf16 v[216:219], a[132:135], a[60:63], v[216:219]
s_waitcnt lgkmcnt(4)
v_mfma_f32_16x16x32_bf16 v[164:167], a[136:139], a[0:3], v[164:167]
s_waitcnt lgkmcnt(2)
ds_read_b64_tr_b16 a[128:129], v10 offset:0
v_mfma_f32_16x16x32_bf16 v[164:167], a[140:143], a[4:7], v[164:167]
v_mfma_f32_16x16x32_bf16 v[172:175], a[136:139], a[8:11], v[172:175]
ds_read_b64_tr_b16 a[130:131], v10 offset:2048
v_mfma_f32_16x16x32_bf16 v[172:175], a[140:143], a[12:15], v[172:175]
v_mfma_f32_16x16x32_bf16 v[180:183], a[136:139], a[16:19], v[180:183]
ds_read_b64_tr_b16 a[132:133], v10 offset:16384
v_mfma_f32_16x16x32_bf16 v[180:183], a[140:143], a[20:23], v[180:183]
v_mfma_f32_16x16x32_bf16 v[188:191], a[136:139], a[24:27], v[188:191]
ds_read_b64_tr_b16 a[134:135], v10 offset:18432
v_mfma_f32_16x16x32_bf16 v[188:191], a[140:143], a[28:31], v[188:191]
v_mfma_f32_16x16x32_bf16 v[196:199], a[136:139], a[32:35], v[196:199]
ds_read_b128 a[116:119], v3 offset:45056
v_mfma_f32_16x16x32_bf16 v[196:199], a[140:143], a[36:39], v[196:199]
v_mfma_f32_16x16x32_bf16 v[204:207], a[136:139], a[40:43], v[204:207]
ds_read_b128 a[120:123], v2 offset:47104
v_mfma_f32_16x16x32_bf16 v[204:207], a[140:143], a[44:47], v[204:207]
v_mfma_f32_16x16x32_bf16 v[212:215], a[136:139], a[48:51], v[212:215]
v_mfma_f32_16x16x32_bf16 v[212:215], a[140:143], a[52:55], v[212:215]
v_mfma_f32_16x16x32_bf16 v[220:223], a[136:139], a[56:59], v[220:223]
ds_read_b128 a[124:127], v3 offset:47104
v_mfma_f32_16x16x32_bf16 v[220:223], a[140:143], a[60:63], v[220:223]
s_waitcnt lgkmcnt(5)
v_mfma_f32_16x16x32_bf16 a[192:195], a[128:131], a[0:3], a[192:195]
s_waitcnt lgkmcnt(3)
ds_read_b64_tr_b16 a[136:137], v11 offset:0
v_mfma_f32_16x16x32_bf16 a[192:195], a[132:135], a[4:7], a[192:195]
v_mfma_f32_16x16x32_bf16 a[200:203], a[128:131], a[8:11], a[200:203]
ds_read_b64_tr_b16 a[138:139], v11 offset:2048
v_mfma_f32_16x16x32_bf16 a[200:203], a[132:135], a[12:15], a[200:203]
v_mfma_f32_16x16x32_bf16 a[208:211], a[128:131], a[16:19], a[208:211]
ds_read_b64_tr_b16 a[140:141], v11 offset:16384
v_and_b32 v252, 31, v0
v_mfma_f32_16x16x32_bf16 a[208:211], a[132:135], a[20:23], a[208:211]
v_lshrrev_b32 v253, 5, v0
v_lshlrev_b32 v252, 8, v252
v_mfma_f32_16x16x32_bf16 a[216:219], a[128:131], a[24:27], a[216:219]
ds_read_b64_tr_b16 a[142:143], v11 offset:18432
v_lshl_add_u32 v252, v253, 4, v252
v_mfma_f32_16x16x32_bf16 a[216:219], a[132:135], a[28:31], a[216:219]
v_add_u32 v252, 147456, v252
v_mfma_f32_16x16x32_bf16 a[224:227], a[128:131], a[32:35], a[224:227]
v_mfma_f32_16x16x32_bf16 a[224:227], a[132:135], a[36:39], a[224:227]
v_mfma_f32_16x16x32_bf16 a[232:235], a[128:131], a[40:43], a[232:235]
v_mfma_f32_16x16x32_bf16 a[232:235], a[132:135], a[44:47], a[232:235]
v_mfma_f32_16x16x32_bf16 a[240:243], a[128:131], a[48:51], a[240:243]
v_mfma_f32_16x16x32_bf16 a[240:243], a[132:135], a[52:55], a[240:243]
v_mfma_f32_16x16x32_bf16 a[248:251], a[128:131], a[56:59], a[248:251]
v_mfma_f32_16x16x32_bf16 a[248:251], a[132:135], a[60:63], a[248:251]
s_waitcnt vmcnt(2) lgkmcnt(0)
s_barrier
v_mfma_f32_16x16x32_bf16 a[196:199], a[136:139], a[0:3], a[196:199]
s_add_u32 m0, s29, 65536
ds_read_b64_tr_b16 a[128:129], v4 offset:32768
v_lshlrev_b32 v28, 16, v248
v_mfma_f32_16x16x32_bf16 a[196:199], a[140:143], a[4:7], a[196:199]
buffer_load_dwordx4 v16, s[12:15], s26 offen offset:0 lds
v_mfma_f32_16x16x32_bf16 a[204:207], a[136:139], a[8:11], a[204:207]
ds_read_b64_tr_b16 a[130:131], v4 offset:34816
v_and_b32 v29, 0xffff0000, v248
v_mfma_f32_16x16x32_bf16 a[204:207], a[140:143], a[12:15], a[204:207]
v_lshlrev_b32 v30, 16, v249
v_and_b32 v253, 0xffff0000, v249
v_mfma_f32_16x16x32_bf16 a[212:215], a[136:139], a[16:19], a[212:215]
ds_read_b64_tr_b16 a[132:133], v4 offset:49152
v_lshlrev_b32 v22, 16, v224
v_mfma_f32_16x16x32_bf16 a[212:215], a[140:143], a[20:23], a[212:215]
buffer_load_dwordx4 v17, s[12:15], s26 offen offset:1024 lds
v_mfma_f32_16x16x32_bf16 a[220:223], a[136:139], a[24:27], a[220:223]
ds_read_b64_tr_b16 a[134:135], v4 offset:51200
v_lshlrev_b32 v23, 16, v225
v_mfma_f32_16x16x32_bf16 a[220:223], a[140:143], a[28:31], a[220:223]
v_lshlrev_b32 v24, 16, v226
v_mul_f32 v254, v22, v253
v_mfma_f32_16x16x32_bf16 a[228:231], a[136:139], a[32:35], a[228:231]
v_lshlrev_b32 v25, 16, v227
v_lshlrev_b32 v247, 16, v236
v_mfma_f32_16x16x32_bf16 a[228:231], a[140:143], a[36:39], a[228:231]
buffer_load_dwordx4 v18, s[12:15], s26 offen offset:2048 lds
v_mfma_f32_16x16x32_bf16 a[236:239], a[136:139], a[40:43], a[236:239]
v_fmac_f32 v254, v23, v30
v_fmac_f32 v254, v24, v29
v_mfma_f32_16x16x32_bf16 a[236:239], a[140:143], a[44:47], a[236:239]
v_fmac_f32 v254, v25, v28
v_mul_f32 v254, v254, v247
v_mfma_f32_16x16x32_bf16 a[244:247], a[136:139], a[48:51], a[244:247]
v_mul_f32 v255, v23, v253
v_lshlrev_b32 v22, 16, v228
v_mfma_f32_16x16x32_bf16 a[244:247], a[140:143], a[52:55], a[244:247]
buffer_load_dwordx4 v19, s[12:15], s26 offen offset:3072 lds
v_mfma_f32_16x16x32_bf16 a[252:255], a[136:139], a[56:59], a[252:255]
s_add_u32 s26, s26, 524288
v_lshlrev_b32 v247, 16, v237
v_fmac_f32 v255, v24, v30
v_mfma_f32_16x16x32_bf16 a[252:255], a[140:143], a[60:63], a[252:255]
s_waitcnt lgkmcnt(0)
v_fmac_f32 v255, v25, v29
v_fmac_f32 v255, v22, v28
v_mfma_f32_16x16x32_bf16 v[32:35], a[128:131], a[64:67], v[32:35]
s_add_u32 m0, s29, 81920
ds_read_b64_tr_b16 a[136:137], v5 offset:32768
v_mul_f32 v255, v255, v247
v_mfma_f32_16x16x32_bf16 v[32:35], a[132:135], a[68:71], v[32:35]
buffer_load_dwordx4 v16, s[12:15], s27 offen offset:0 lds
v_mfma_f32_16x16x32_bf16 v[40:43], a[128:131], a[72:75], v[40:43]
ds_read_b64_tr_b16 a[138:139], v5 offset:34816
v_cvt_pk_bf16_f32 v246, v254, v255
v_mfma_f32_16x16x32_bf16 v[40:43], a[132:135], a[76:79], v[40:43]
v_accvgpr_write_b32 a180, v246
v_mul_f32 v254, v24, v253
v_mfma_f32_16x16x32_bf16 v[48:51], a[128:131], a[80:83], v[48:51]
ds_read_b64_tr_b16 a[140:141], v5 offset:49152
v_lshlrev_b32 v23, 16, v229
v_mfma_f32_16x16x32_bf16 v[48:51], a[132:135], a[84:87], v[48:51]
buffer_load_dwordx4 v17, s[12:15], s27 offen offset:1024 lds
v_lshlrev_b32 v247, 16, v238
v_mfma_f32_16x16x32_bf16 v[56:59], a[128:131], a[88:91], v[56:59]
ds_read_b64_tr_b16 a[142:143], v5 offset:51200
v_fmac_f32 v254, v25, v30
v_mfma_f32_16x16x32_bf16 v[56:59], a[132:135], a[92:95], v[56:59]
v_fmac_f32 v254, v22, v29
v_fmac_f32 v254, v23, v28
v_mfma_f32_16x16x32_bf16 v[64:67], a[128:131], a[96:99], v[64:67]
ds_read_b128 a[0:3], v2 offset:0
v_mul_f32 v254, v254, v247
v_mfma_f32_16x16x32_bf16 v[64:67], a[132:135], a[100:103], v[64:67]
buffer_load_dwordx4 v18, s[12:15], s27 offen offset:2048 lds
v_mfma_f32_16x16x32_bf16 v[72:75], a[128:131], a[104:107], v[72:75]
ds_read_b128 a[4:7], v3 offset:0
v_cvt_pk_bf16_f32 v246, v255, v254
v_accvgpr_write_b32 a176, v246
v_mfma_f32_16x16x32_bf16 v[72:75], a[132:135], a[108:111], v[72:75]
v_mul_f32 v255, v25, v253
v_lshlrev_b32 v24, 16, v230
v_mfma_f32_16x16x32_bf16 v[80:83], a[128:131], a[112:115], v[80:83]
v_lshlrev_b32 v247, 16, v239
v_fmac_f32 v255, v22, v30
v_mfma_f32_16x16x32_bf16 v[80:83], a[132:135], a[116:119], v[80:83]
buffer_load_dwordx4 v19, s[12:15], s27 offen offset:3072 lds
v_mfma_f32_16x16x32_bf16 v[88:91], a[128:131], a[120:123], v[88:91]
s_add_u32 s27, s27, 524288
ds_read_b128 a[8:11], v2 offset:2048
v_fmac_f32 v255, v23, v29
v_mfma_f32_16x16x32_bf16 v[88:91], a[132:135], a[124:127], v[88:91]
s_waitcnt lgkmcnt(3)
v_fmac_f32 v255, v24, v28
v_mul_f32 v255, v255, v247
v_mfma_f32_16x16x32_bf16 v[36:39], a[136:139], a[64:67], v[36:39]
s_add_u32 m0, s28, 32768
ds_read_b64_tr_b16 a[128:129], v6 offset:32768
v_cvt_pk_bf16_f32 v246, v254, v255
v_accvgpr_write_b32 a181, v246
v_mfma_f32_16x16x32_bf16 v[36:39], a[140:143], a[68:71], v[36:39]
buffer_load_dwordx4 v12, s[8:11], s24 offen offset:0 lds
v_mfma_f32_16x16x32_bf16 v[44:47], a[136:139], a[72:75], v[44:47]
ds_read_b64_tr_b16 a[130:131], v6 offset:34816
v_mul_f32 v254, v22, v253
v_mfma_f32_16x16x32_bf16 v[44:47], a[140:143], a[76:79], v[44:47]
v_lshlrev_b32 v25, 16, v231
v_lshlrev_b32 v247, 16, v240
v_mfma_f32_16x16x32_bf16 v[52:55], a[136:139], a[80:83], v[52:55]
ds_read_b64_tr_b16 a[132:133], v6 offset:49152
v_fmac_f32 v254, v23, v30
v_mfma_f32_16x16x32_bf16 v[52:55], a[140:143], a[84:87], v[52:55]
buffer_load_dwordx4 v13, s[8:11], s24 offen offset:1024 lds
v_fmac_f32 v254, v24, v29
v_mfma_f32_16x16x32_bf16 v[60:63], a[136:139], a[88:91], v[60:63]
ds_read_b64_tr_b16 a[134:135], v6 offset:51200
v_fmac_f32 v254, v25, v28
v_mfma_f32_16x16x32_bf16 v[60:63], a[140:143], a[92:95], v[60:63]
v_mul_f32 v254, v254, v247
v_cvt_pk_bf16_f32 v246, v255, v254
v_mfma_f32_16x16x32_bf16 v[68:71], a[136:139], a[96:99], v[68:71]
ds_read_b128 a[12:15], v3 offset:2048
v_accvgpr_write_b32 a177, v246
v_mfma_f32_16x16x32_bf16 v[68:71], a[140:143], a[100:103], v[68:71]
buffer_load_dwordx4 v14, s[8:11], s24 offen offset:2048 lds
v_mfma_f32_16x16x32_bf16 v[76:79], a[136:139], a[104:107], v[76:79]
v_mul_f32 v255, v23, v253
v_lshlrev_b32 v22, 16, v232
v_lshlrev_b32 v247, 16, v241
v_mfma_f32_16x16x32_bf16 v[76:79], a[140:143], a[108:111], v[76:79]
v_fmac_f32 v255, v24, v30
v_fmac_f32 v255, v25, v29
v_mfma_f32_16x16x32_bf16 v[84:87], a[136:139], a[112:115], v[84:87]
ds_read_b128 a[16:19], v2 offset:4096
v_fmac_f32 v255, v22, v28
v_mfma_f32_16x16x32_bf16 v[84:87], a[140:143], a[116:119], v[84:87]
buffer_load_dwordx4 v15, s[8:11], s24 offen offset:3072 lds
v_mfma_f32_16x16x32_bf16 v[92:95], a[136:139], a[120:123], v[92:95]
s_add_u32 s24, s24, 128
ds_read_b128 a[20:23], v3 offset:4096
v_mul_f32 v255, v255, v247
v_mfma_f32_16x16x32_bf16 v[92:95], a[140:143], a[124:127], v[92:95]
s_waitcnt lgkmcnt(3)
v_cvt_pk_bf16_f32 v246, v254, v255
v_accvgpr_write_b32 a182, v246
v_mfma_f32_16x16x32_bf16 v[96:99], a[128:131], a[64:67], v[96:99]
s_add_u32 m0, s28, 36864
ds_read_b64_tr_b16 a[136:137], v7 offset:32768
v_mul_f32 v254, v24, v253
v_lshlrev_b32 v23, 16, v233
v_mfma_f32_16x16x32_bf16 v[96:99], a[132:135], a[68:71], v[96:99]
buffer_load_dwordx4 v12, s[8:11], s25 offen offset:0 lds
v_mfma_f32_16x16x32_bf16 v[104:107], a[128:131], a[72:75], v[104:107]
ds_read_b64_tr_b16 a[138:139], v7 offset:34816
v_lshlrev_b32 v247, 16, v242
v_mfma_f32_16x16x32_bf16 v[104:107], a[132:135], a[76:79], v[104:107]
v_fmac_f32 v254, v25, v30
v_fmac_f32 v254, v22, v29
v_mfma_f32_16x16x32_bf16 v[112:115], a[128:131], a[80:83], v[112:115]
ds_read_b64_tr_b16 a[140:141], v7 offset:49152
v_fmac_f32 v254, v23, v28
v_mfma_f32_16x16x32_bf16 v[112:115], a[132:135], a[84:87], v[112:115]
buffer_load_dwordx4 v13, s[8:11], s25 offen offset:1024 lds
v_mul_f32 v254, v254, v247
v_mfma_f32_16x16x32_bf16 v[120:123], a[128:131], a[88:91], v[120:123]
ds_read_b64_tr_b16 a[142:143], v7 offset:51200
v_cvt_pk_bf16_f32 v246, v255, v254
v_mfma_f32_16x16x32_bf16 v[120:123], a[132:135], a[92:95], v[120:123]
v_accvgpr_write_b32 a178, v246
v_mul_f32 v255, v25, v253
v_mfma_f32_16x16x32_bf16 v[128:131], a[128:131], a[96:99], v[128:131]
v_lshlrev_b32 v24, 16, v234
v_lshlrev_b32 v247, 16, v243
v_mfma_f32_16x16x32_bf16 v[128:131], a[132:135], a[100:103], v[128:131]
buffer_load_dwordx4 v14, s[8:11], s25 offen offset:2048 lds
v_mfma_f32_16x16x32_bf16 v[136:139], a[128:131], a[104:107], v[136:139]
ds_read_b128 a[24:27], v2 offset:6144
v_fmac_f32 v255, v22, v30
v_fmac_f32 v255, v23, v29
v_mfma_f32_16x16x32_bf16 v[136:139], a[132:135], a[108:111], v[136:139]
v_fmac_f32 v255, v24, v28
v_mul_f32 v255, v255, v247
v_mfma_f32_16x16x32_bf16 v[144:147], a[128:131], a[112:115], v[144:147]
ds_read_b128 a[28:31], v3 offset:6144
v_cvt_pk_bf16_f32 v246, v254, v255
v_mfma_f32_16x16x32_bf16 v[144:147], a[132:135], a[116:119], v[144:147]
buffer_load_dwordx4 v15, s[8:11], s25 offen offset:3072 lds
v_mfma_f32_16x16x32_bf16 v[152:155], a[128:131], a[120:123], v[152:155]
s_add_u32 s25, s25, 128
v_accvgpr_write_b32 a183, v246
v_mul_f32 v254, v22, v253
v_mfma_f32_16x16x32_bf16 v[152:155], a[132:135], a[124:127], v[152:155]
s_waitcnt lgkmcnt(4)
v_lshlrev_b32 v25, 16, v235
v_lshlrev_b32 v247, 16, v244
v_mfma_f32_16x16x32_bf16 v[100:103], a[136:139], a[64:67], v[100:103]
s_waitcnt lgkmcnt(2)
ds_read_b64_tr_b16 a[128:129], v8 offset:32768
v_fmac_f32 v254, v23, v30
v_fmac_f32 v254, v24, v29
v_mfma_f32_16x16x32_bf16 v[100:103], a[140:143], a[68:71], v[100:103]
buffer_load_dword v21, v20, s[16:19], s43 offen
v_mfma_f32_16x16x32_bf16 v[108:111], a[136:139], a[72:75], v[108:111]
s_add_u32 s43, s43, s47
ds_read_b64_tr_b16 a[130:131], v8 offset:34816
v_fmac_f32 v254, v25, v28
v_mfma_f32_16x16x32_bf16 v[108:111], a[140:143], a[76:79], v[108:111]
s_cmp_ge_u32 s43, s51
v_mul_f32 v254, v254, v247
v_cvt_pk_bf16_f32 v246, v255, v254
v_mfma_f32_16x16x32_bf16 v[116:119], a[136:139], a[80:83], v[116:119]
s_cselect_b32 s43, 0, s43
ds_read_b64_tr_b16 a[132:133], v8 offset:49152
v_accvgpr_write_b32 a179, v246
v_mfma_f32_16x16x32_bf16 v[116:119], a[140:143], a[84:87], v[116:119]
s_cselect_b32 s51, s42, s51
v_lshlrev_b32 v28, 16, v250
v_and_b32 v29, 0xffff0000, v250
v_lshlrev_b32 v30, 16, v251
v_mfma_f32_16x16x32_bf16 v[124:127], a[136:139], a[88:91], v[124:127]
s_cselect_b64 s[16:17], s[40:41], s[16:17]
ds_read_b64_tr_b16 a[134:135], v8 offset:51200
v_and_b32 v253, 0xffff0000, v251
v_mfma_f32_16x16x32_bf16 v[124:127], a[140:143], a[92:95], v[124:127]
s_cselect_b32 s18, s42, s18
v_and_b32 v22, 0xffff0000, v224
v_and_b32 v23, 0xffff0000, v225
v_mfma_f32_16x16x32_bf16 v[132:135], a[136:139], a[96:99], v[132:135]
s_cselect_b64 s[40:41], s[44:45], s[40:41]
ds_read_b128 a[32:35], v2 offset:8192
v_and_b32 v24, 0xffff0000, v226
v_mfma_f32_16x16x32_bf16 v[132:135], a[140:143], a[100:103], v[132:135]
s_cselect_b32 s42, s46, s42
v_mul_f32 v254, v22, v253
v_and_b32 v25, 0xffff0000, v227
v_mfma_f32_16x16x32_bf16 v[140:143], a[136:139], a[104:107], v[140:143]
s_cselect_b32 s46, 0, s46
v_and_b32 v247, 0xffff0000, v236
v_fmac_f32 v254, v23, v30
v_mfma_f32_16x16x32_bf16 v[140:143], a[140:143], a[108:111], v[140:143]
buffer_load_dword v245, off, s[60:63], 0 sc1
v_fmac_f32 v254, v24, v29
v_mfma_f32_16x16x32_bf16 v[148:151], a[136:139], a[112:115], v[148:151]
ds_read_b128 a[36:39], v3 offset:8192
v_fmac_f32 v254, v25, v28
v_mfma_f32_16x16x32_bf16 v[148:151], a[140:143], a[116:119], v[148:151]
v_mul_f32 v254, v254, v247
v_mul_f32 v255, v23, v253
v_mfma_f32_16x16x32_bf16 v[156:159], a[136:139], a[120:123], v[156:159]
ds_read_b128 a[40:43], v2 offset:10240
v_and_b32 v22, 0xffff0000, v228
v_mfma_f32_16x16x32_bf16 v[156:159], a[140:143], a[124:127], v[156:159]
s_waitcnt lgkmcnt(5)
v_and_b32 v247, 0xffff0000, v237
v_fmac_f32 v255, v24, v30
v_mfma_f32_16x16x32_bf16 v[160:163], a[128:131], a[64:67], v[160:163]
s_waitcnt lgkmcnt(3)
ds_read_b64_tr_b16 a[136:137], v9 offset:32768
v_fmac_f32 v255, v25, v29
v_fmac_f32 v255, v22, v28
v_mfma_f32_16x16x32_bf16 v[160:163], a[132:135], a[68:71], v[160:163]
v_mul_f32 v255, v255, v247
v_cvt_pk_bf16_f32 v246, v254, v255
v_mfma_f32_16x16x32_bf16 v[168:171], a[128:131], a[72:75], v[168:171]
ds_read_b64_tr_b16 a[138:139], v9 offset:34816
v_accvgpr_write_b32 a188, v246
v_mfma_f32_16x16x32_bf16 v[168:171], a[132:135], a[76:79], v[168:171]
v_mul_f32 v254, v24, v253
v_and_b32 v23, 0xffff0000, v229
v_mfma_f32_16x16x32_bf16 v[176:179], a[128:131], a[80:83], v[176:179]
ds_read_b64_tr_b16 a[140:141], v9 offset:49152
v_and_b32 v247, 0xffff0000, v238
v_mfma_f32_16x16x32_bf16 v[176:179], a[132:135], a[84:87], v[176:179]
v_fmac_f32 v254, v25, v30
v_fmac_f32 v254, v22, v29
v_fmac_f32 v254, v23, v28
v_mfma_f32_16x16x32_bf16 v[184:187], a[128:131], a[88:91], v[184:187]
ds_read_b64_tr_b16 a[142:143], v9 offset:51200
v_mul_f32 v254, v254, v247
v_mfma_f32_16x16x32_bf16 v[184:187], a[132:135], a[92:95], v[184:187]
v_cvt_pk_bf16_f32 v246, v255, v254
v_accvgpr_write_b32 a184, v246
v_mfma_f32_16x16x32_bf16 v[192:195], a[128:131], a[96:99], v[192:195]
v_mul_f32 v255, v25, v253
v_and_b32 v24, 0xffff0000, v230
v_mfma_f32_16x16x32_bf16 v[192:195], a[132:135], a[100:103], v[192:195]
v_and_b32 v247, 0xffff0000, v239
v_fmac_f32 v255, v22, v30
v_mfma_f32_16x16x32_bf16 v[200:203], a[128:131], a[104:107], v[200:203]
ds_read_b128 a[44:47], v3 offset:10240
v_fmac_f32 v255, v23, v29
v_mfma_f32_16x16x32_bf16 v[200:203], a[132:135], a[108:111], v[200:203]
v_fmac_f32 v255, v24, v28
v_mul_f32 v255, v255, v247
v_cvt_pk_bf16_f32 v246, v254, v255
v_mfma_f32_16x16x32_bf16 v[208:211], a[128:131], a[112:115], v[208:211]
ds_read_b128 a[48:51], v2 offset:12288
v_accvgpr_write_b32 a189, v246
v_mfma_f32_16x16x32_bf16 v[208:211], a[132:135], a[116:119], v[208:211]
v_mul_f32 v254, v22, v253
v_and_b32 v25, 0xffff0000, v231
v_mfma_f32_16x16x32_bf16 v[216:219], a[128:131], a[120:123], v[216:219]
v_and_b32 v247, 0xffff0000, v240
v_fmac_f32 v254, v23, v30
v_mfma_f32_16x16x32_bf16 v[216:219], a[132:135], a[124:127], v[216:219]
s_waitcnt lgkmcnt(4)
v_fmac_f32 v254, v24, v29
v_fmac_f32 v254, v25, v28
v_mfma_f32_16x16x32_bf16 v[164:167], a[136:139], a[64:67], v[164:167]
s_waitcnt lgkmcnt(2)
ds_read_b64_tr_b16 a[128:129], v10 offset:32768
v_mul_f32 v254, v254, v247
v_cvt_pk_bf16_f32 v246, v255, v254
v_mfma_f32_16x16x32_bf16 v[164:167], a[140:143], a[68:71], v[164:167]
v_accvgpr_write_b32 a185, v246
v_mul_f32 v255, v23, v253
v_mfma_f32_16x16x32_bf16 v[172:175], a[136:139], a[72:75], v[172:175]
ds_read_b64_tr_b16 a[130:131], v10 offset:34816
v_and_b32 v22, 0xffff0000, v232
v_mfma_f32_16x16x32_bf16 v[172:175], a[140:143], a[76:79], v[172:175]
v_and_b32 v247, 0xffff0000, v241
v_fmac_f32 v255, v24, v30
v_mfma_f32_16x16x32_bf16 v[180:183], a[136:139], a[80:83], v[180:183]
s_lshr_b32 s22, s3, 1
ds_read_b64_tr_b16 a[132:133], v10 offset:49152
v_fmac_f32 v255, v25, v29
v_mfma_f32_16x16x32_bf16 v[180:183], a[140:143], a[84:87], v[180:183]
s_mul_i32 s22, s22, 2097152
v_fmac_f32 v255, v22, v28
v_mul_f32 v255, v255, v247
v_cvt_pk_bf16_f32 v246, v254, v255
v_mfma_f32_16x16x32_bf16 v[188:191], a[136:139], a[88:91], v[188:191]
s_and_b32 s23, s3, 1
ds_read_b64_tr_b16 a[134:135], v10 offset:51200
v_accvgpr_write_b32 a190, v246
v_mfma_f32_16x16x32_bf16 v[188:191], a[140:143], a[92:95], v[188:191]
s_lshl_b32 s23, s23, 5
v_mul_f32 v254, v24, v253
v_and_b32 v23, 0xffff0000, v233
v_mfma_f32_16x16x32_bf16 v[196:199], a[136:139], a[96:99], v[196:199]
s_lshl_b32 s56, s39, 6
ds_read_b128 a[52:55], v3 offset:12288
v_and_b32 v247, 0xffff0000, v242
v_mfma_f32_16x16x32_bf16 v[196:199], a[140:143], a[100:103], v[196:199]
s_add_u32 s23, s23, s56
v_fmac_f32 v254, v25, v30
v_fmac_f32 v254, v22, v29
v_mfma_f32_16x16x32_bf16 v[204:207], a[136:139], a[104:107], v[204:207]
s_mul_i32 s23, s23, 4224
ds_read_b128 a[56:59], v2 offset:14336
v_fmac_f32 v254, v23, v28
v_mfma_f32_16x16x32_bf16 v[204:207], a[140:143], a[108:111], v[204:207]
s_add_u32 s22, s22, s23
v_mul_f32 v254, v254, v247
v_cvt_pk_bf16_f32 v246, v255, v254
v_accvgpr_write_b32 a186, v246
v_mfma_f32_16x16x32_bf16 v[212:215], a[136:139], a[112:115], v[212:215]
s_add_u32 s57, s22, 83886200
v_mul_f32 v255, v25, v253
v_and_b32 v24, 0xffff0000, v234
v_mfma_f32_16x16x32_bf16 v[212:215], a[140:143], a[116:119], v[212:215]
s_lshl_b32 s23, s38, 7
v_and_b32 v247, 0xffff0000, v243
v_fmac_f32 v255, v22, v30
v_mfma_f32_16x16x32_bf16 v[220:223], a[136:139], a[120:123], v[220:223]
s_add_u32 s22, s22, s23
ds_read_b128 a[60:63], v3 offset:14336
v_fmac_f32 v255, v23, v29
v_mfma_f32_16x16x32_bf16 v[220:223], a[140:143], a[124:127], v[220:223]
s_waitcnt lgkmcnt(3)
s_add_u32 s56, s22, 83886208
v_fmac_f32 v255, v24, v28
v_mul_f32 v255, v255, v247
v_mfma_f32_16x16x32_bf16 a[192:195], a[128:131], a[64:67], a[192:195]
s_cmp_lt_u32 s2, 224
ds_read_b64_tr_b16 a[136:137], v11 offset:32768
v_cvt_pk_bf16_f32 v246, v254, v255
v_accvgpr_write_b32 a191, v246
v_mfma_f32_16x16x32_bf16 a[192:195], a[132:135], a[68:71], a[192:195]
s_cselect_b32 s56, s56, 3221225472
v_mul_f32 v254, v22, v253
v_and_b32 v25, 0xffff0000, v235
v_mfma_f32_16x16x32_bf16 a[200:203], a[128:131], a[72:75], a[200:203]
s_cmp_eq_u32 s38, 0
ds_read_b64_tr_b16 a[138:139], v11 offset:34816
v_and_b32 v247, 0xffff0000, v244
v_mfma_f32_16x16x32_bf16 a[200:203], a[132:135], a[76:79], a[200:203]
s_cselect_b32 s57, s57, 3221225472
v_fmac_f32 v254, v23, v30
v_fmac_f32 v254, v24, v29
v_mfma_f32_16x16x32_bf16 a[208:211], a[128:131], a[80:83], a[208:211]
ds_read_b64_tr_b16 a[140:141], v11 offset:49152
v_fmac_f32 v254, v25, v28
v_mfma_f32_16x16x32_bf16 a[208:211], a[132:135], a[84:87], a[208:211]
v_mul_f32 v254, v254, v247
v_cvt_pk_bf16_f32 v246, v255, v254
v_accvgpr_write_b32 a187, v246
v_mfma_f32_16x16x32_bf16 a[216:219], a[128:131], a[88:91], a[216:219]
ds_read_b64_tr_b16 a[142:143], v11 offset:51200
v_mfma_f32_16x16x32_bf16 a[216:219], a[132:135], a[92:95], a[216:219]
ds_write_b128 v252, a[176:179] offset:0
v_mfma_f32_16x16x32_bf16 a[224:227], a[128:131], a[96:99], a[224:227]
v_mfma_f32_16x16x32_bf16 a[224:227], a[132:135], a[100:103], a[224:227]
ds_write_b128 v252, a[180:183] offset:8192
v_mfma_f32_16x16x32_bf16 a[232:235], a[128:131], a[104:107], a[232:235]
v_mfma_f32_16x16x32_bf16 a[232:235], a[132:135], a[108:111], a[232:235]
ds_write_b128 v252, a[184:187] offset:128
v_mfma_f32_16x16x32_bf16 a[240:243], a[128:131], a[112:115], a[240:243]
v_mfma_f32_16x16x32_bf16 a[240:243], a[132:135], a[116:119], a[240:243]
ds_write_b128 v252, a[188:191] offset:8320
v_mfma_f32_16x16x32_bf16 a[248:251], a[128:131], a[120:123], a[248:251]
v_mfma_f32_16x16x32_bf16 a[248:251], a[132:135], a[124:127], a[248:251]
s_waitcnt vmcnt(2) lgkmcnt(0)
s_barrier
v_mfma_f32_16x16x32_bf16 a[196:199], a[136:139], a[64:67], a[196:199]
s_add_u32 m0, s29, 98304
ds_read_b64_tr_b16 a[128:129], v4 offset:0
v_add_u32 v22, s29, v1
v_mfma_f32_16x16x32_bf16 a[196:199], a[140:143], a[68:71], a[196:199]
buffer_load_dwordx4 v16, s[12:15], s26 offen offset:0 lds
v_mfma_f32_16x16x32_bf16 a[204:207], a[136:139], a[72:75], a[204:207]
ds_read_b64_tr_b16 a[130:131], v4 offset:2048
v_add_u32 v22, 147456, v22
v_mfma_f32_16x16x32_bf16 a[204:207], a[140:143], a[76:79], a[204:207]
v_lshrrev_b32 v224, 7, v1
v_mul_u32_u24 v224, 4224, v224
v_mfma_f32_16x16x32_bf16 a[212:215], a[136:139], a[80:83], a[212:215]
ds_read_b64_tr_b16 a[132:133], v4 offset:16384
v_and_b32 v225, 0x70, v1
v_mfma_f32_16x16x32_bf16 a[212:215], a[140:143], a[84:87], a[212:215]
buffer_load_dwordx4 v17, s[12:15], s26 offen offset:1024 lds
v_mfma_f32_16x16x32_bf16 a[220:223], a[136:139], a[88:91], a[220:223]
ds_read_b64_tr_b16 a[134:135], v4 offset:18432
v_add_u32 v224, v224, v225
v_mfma_f32_16x16x32_bf16 a[220:223], a[140:143], a[92:95], a[220:223]
v_bfe_u32 v225, v1, 4, 5
v_mul_u32_u24 v225, 4224, v225
v_mfma_f32_16x16x32_bf16 a[228:231], a[136:139], a[96:99], a[228:231]
v_mov_b32 v226, 0
v_mov_b32 v227, 0
v_mfma_f32_16x16x32_bf16 a[228:231], a[140:143], a[100:103], a[228:231]
buffer_load_dwordx4 v18, s[12:15], s26 offen offset:2048 lds
v_mfma_f32_16x16x32_bf16 a[236:239], a[136:139], a[104:107], a[236:239]
v_mfma_f32_16x16x32_bf16 a[236:239], a[140:143], a[108:111], a[236:239]
v_mfma_f32_16x16x32_bf16 a[244:247], a[136:139], a[112:115], a[244:247]
v_mfma_f32_16x16x32_bf16 a[244:247], a[140:143], a[116:119], a[244:247]
buffer_load_dwordx4 v19, s[12:15], s26 offen offset:3072 lds
v_mfma_f32_16x16x32_bf16 a[252:255], a[136:139], a[120:123], a[252:255]
s_add_u32 s26, s26, 524288
v_mfma_f32_16x16x32_bf16 a[252:255], a[140:143], a[124:127], a[252:255]
s_waitcnt lgkmcnt(2)
v_mfma_f32_16x16x32_bf16 v[32:35], a[128:131], a[0:3], v[32:35]
s_waitcnt lgkmcnt(0)
s_add_u32 m0, s29, 114688
ds_read_b64_tr_b16 a[136:137], v5 offset:0
v_mfma_f32_16x16x32_bf16 v[32:35], a[132:135], a[4:7], v[32:35]
buffer_load_dwordx4 v16, s[12:15], s27 offen offset:0 lds
v_mfma_f32_16x16x32_bf16 v[40:43], a[128:131], a[8:11], v[40:43]
s_mul_i32 s52, s20, 7
ds_read_b64_tr_b16 a[138:139], v5 offset:2048
v_mfma_f32_16x16x32_bf16 v[40:43], a[132:135], a[12:15], v[40:43]
s_add_u32 s52, s52, s21
buffer_store_dwordx2 v[226:227], v225, s[4:7], s57 offen sc1
v_mfma_f32_16x16x32_bf16 v[48:51], a[128:131], a[16:19], v[48:51]
s_lshl_b32 s53, s52, 2
ds_read_b64_tr_b16 a[140:141], v5 offset:16384
v_mfma_f32_16x16x32_bf16 v[48:51], a[132:135], a[20:23], v[48:51]
s_add_u32 s53, s53, s3
buffer_load_dwordx4 v17, s[12:15], s27 offen offset:1024 lds
v_mfma_f32_16x16x32_bf16 v[56:59], a[128:131], a[24:27], v[56:59]
s_lshl_b32 s49, s53, 12
ds_read_b64_tr_b16 a[142:143], v5 offset:18432
v_mfma_f32_16x16x32_bf16 v[56:59], a[132:135], a[28:31], v[56:59]
s_mul_i32 s53, s53, 4224
v_mfma_f32_16x16x32_bf16 v[64:67], a[128:131], a[32:35], v[64:67]
s_add_u32 s53, s53, 83886080
ds_read_b128 a[64:67], v2 offset:32768
v_mfma_f32_16x16x32_bf16 v[64:67], a[132:135], a[36:39], v[64:67]
s_lshr_b32 s52, s52, 4
buffer_load_dwordx4 v18, s[12:15], s27 offen offset:2048 lds
v_mfma_f32_16x16x32_bf16 v[72:75], a[128:131], a[40:43], v[72:75]
s_min_u32 s52, s52, 6
ds_read_b128 a[68:71], v3 offset:32768
v_mfma_f32_16x16x32_bf16 v[72:75], a[132:135], a[44:47], v[72:75]
s_lshl_b32 s52, s52, 7
ds_read_b128 a[176:179], v22 offset:0
v_mfma_f32_16x16x32_bf16 v[80:83], a[128:131], a[48:51], v[80:83]
s_add_u32 s52, s52, 94392320
ds_read_b128 a[180:183], v22 offset:1024
v_mfma_f32_16x16x32_bf16 v[80:83], a[132:135], a[52:55], v[80:83]
buffer_load_dwordx4 v19, s[12:15], s27 offen offset:3072 lds
v_mfma_f32_16x16x32_bf16 v[88:91], a[128:131], a[56:59], v[88:91]
s_add_u32 s27, s27, 524288
ds_read_b128 a[72:75], v2 offset:34816
v_mfma_f32_16x16x32_bf16 v[88:91], a[132:135], a[60:63], v[88:91]
s_waitcnt lgkmcnt(7)
ds_read_b128 a[184:187], v22 offset:2048
v_mfma_f32_16x16x32_bf16 v[36:39], a[136:139], a[0:3], v[36:39]
s_waitcnt lgkmcnt(6)
s_add_u32 m0, s28, 0
ds_read_b64_tr_b16 a[128:129], v6 offset:0
v_mfma_f32_16x16x32_bf16 v[36:39], a[140:143], a[4:7], v[36:39]
buffer_load_dwordx4 v12, s[8:11], s24 offen offset:0 lds
v_mfma_f32_16x16x32_bf16 v[44:47], a[136:139], a[8:11], v[44:47]
ds_read_b64_tr_b16 a[130:131], v6 offset:2048
v_mfma_f32_16x16x32_bf16 v[44:47], a[140:143], a[12:15], v[44:47]
ds_read_b128 a[188:191], v22 offset:3072
v_mfma_f32_16x16x32_bf16 v[52:55], a[136:139], a[16:19], v[52:55]
ds_read_b64_tr_b16 a[132:133], v6 offset:16384
v_bfe_u32 v231, v1, 4, 5
v_mfma_f32_16x16x32_bf16 v[52:55], a[140:143], a[20:23], v[52:55]
buffer_load_dwordx4 v13, s[8:11], s24 offen offset:1024 lds
v_mfma_f32_16x16x32_bf16 v[60:63], a[136:139], a[24:27], v[60:63]
ds_read_b64_tr_b16 a[134:135], v6 offset:18432
v_lshlrev_b32 v231, 2, v231
v_mfma_f32_16x16x32_bf16 v[60:63], a[140:143], a[28:31], v[60:63]
v_lshlrev_b32 v229, 3, v1
v_min_u32 v229, 4096, v229
v_mfma_f32_16x16x32_bf16 v[68:71], a[136:139], a[32:35], v[68:71]
ds_read_b128 a[76:79], v3 offset:34816
v_mfma_f32_16x16x32_bf16 v[68:71], a[140:143], a[36:39], v[68:71]
buffer_load_dwordx4 v14, s[8:11], s24 offen offset:2048 lds
v_mfma_f32_16x16x32_bf16 v[76:79], a[136:139], a[40:43], v[76:79]
v_mfma_f32_16x16x32_bf16 v[76:79], a[140:143], a[44:47], v[76:79]
v_mfma_f32_16x16x32_bf16 v[84:87], a[136:139], a[48:51], v[84:87]
ds_read_b128 a[80:83], v2 offset:36864
v_mfma_f32_16x16x32_bf16 v[84:87], a[140:143], a[52:55], v[84:87]
buffer_load_dwordx4 v15, s[8:11], s24 offen offset:3072 lds
v_mfma_f32_16x16x32_bf16 v[92:95], a[136:139], a[56:59], v[92:95]
s_add_u32 s24, s24, 128
ds_read_b128 a[84:87], v3 offset:36864
v_mfma_f32_16x16x32_bf16 v[92:95], a[140:143], a[60:63], v[92:95]
s_waitcnt lgkmcnt(6)
v_mfma_f32_16x16x32_bf16 v[96:99], a[128:131], a[0:3], v[96:99]
s_waitcnt lgkmcnt(3)
s_add_u32 m0, s28, 4096
ds_read_b64_tr_b16 a[136:137], v7 offset:0
v_mfma_f32_16x16x32_bf16 v[96:99], a[132:135], a[4:7], v[96:99]
buffer_load_dwordx4 v12, s[8:11], s25 offen offset:0 lds
v_mfma_f32_16x16x32_bf16 v[104:107], a[128:131], a[8:11], v[104:107]
ds_read_b64_tr_b16 a[138:139], v7 offset:2048
v_mfma_f32_16x16x32_bf16 v[104:107], a[132:135], a[12:15], v[104:107]
v_mfma_f32_16x16x32_bf16 v[112:115], a[128:131], a[16:19], v[112:115]
ds_read_b64_tr_b16 a[140:141], v7 offset:16384
v_mfma_f32_16x16x32_bf16 v[112:115], a[132:135], a[20:23], v[112:115]
buffer_load_dwordx4 v13, s[8:11], s25 offen offset:1024 lds
v_mfma_f32_16x16x32_bf16 v[120:123], a[128:131], a[24:27], v[120:123]
ds_read_b64_tr_b16 a[142:143], v7 offset:18432
v_mfma_f32_16x16x32_bf16 v[120:123], a[132:135], a[28:31], v[120:123]
v_mfma_f32_16x16x32_bf16 v[128:131], a[128:131], a[32:35], v[128:131]
v_mfma_f32_16x16x32_bf16 v[128:131], a[132:135], a[36:39], v[128:131]
buffer_load_dwordx4 v14, s[8:11], s25 offen offset:2048 lds
v_mfma_f32_16x16x32_bf16 v[136:139], a[128:131], a[40:43], v[136:139]
ds_read_b128 a[88:91], v2 offset:38912
v_mfma_f32_16x16x32_bf16 v[136:139], a[132:135], a[44:47], v[136:139]
v_mfma_f32_16x16x32_bf16 v[144:147], a[128:131], a[48:51], v[144:147]
ds_read_b128 a[92:95], v3 offset:38912
v_mfma_f32_16x16x32_bf16 v[144:147], a[132:135], a[52:55], v[144:147]
buffer_load_dwordx4 v15, s[8:11], s25 offen offset:3072 lds
v_mfma_f32_16x16x32_bf16 v[152:155], a[128:131], a[56:59], v[152:155]
s_add_u32 s25, s25, 128
v_mfma_f32_16x16x32_bf16 v[152:155], a[132:135], a[60:63], v[152:155]
s_waitcnt lgkmcnt(4)
v_mfma_f32_16x16x32_bf16 v[100:103], a[136:139], a[0:3], v[100:103]
s_waitcnt lgkmcnt(2)
ds_read_b64_tr_b16 a[128:129], v8 offset:0
v_mfma_f32_16x16x32_bf16 v[100:103], a[140:143], a[4:7], v[100:103]
buffer_store_dwordx4 a[176:179], v224, s[4:7], s56 offen sc1
v_mfma_f32_16x16x32_bf16 v[108:111], a[136:139], a[8:11], v[108:111]
s_add_u32 s56, s56, 33792
ds_read_b64_tr_b16 a[130:131], v8 offset:2048
v_mfma_f32_16x16x32_bf16 v[108:111], a[140:143], a[12:15], v[108:111]
v_mfma_f32_16x16x32_bf16 v[116:119], a[136:139], a[16:19], v[116:119]
ds_read_b64_tr_b16 a[132:133], v8 offset:16384
v_mfma_f32_16x16x32_bf16 v[116:119], a[140:143], a[20:23], v[116:119]
v_mfma_f32_16x16x32_bf16 v[124:127], a[136:139], a[24:27], v[124:127]
s_cmp_lt_u32 s21, 0
ds_read_b64_tr_b16 a[134:135], v8 offset:18432
v_mfma_f32_16x16x32_bf16 v[124:127], a[140:143], a[28:31], v[124:127]
s_cselect_b32 s53, s53, 3221225472
v_mfma_f32_16x16x32_bf16 v[132:135], a[136:139], a[32:35], v[132:135]
s_cselect_b32 s49, s49, 3221225472
ds_read_b128 a[96:99], v2 offset:40960
v_mfma_f32_16x16x32_bf16 v[132:135], a[140:143], a[36:39], v[132:135]
s_add_u32 s48, s53, 2097152
v_mfma_f32_16x16x32_bf16 v[140:143], a[136:139], a[40:43], v[140:143]
v_mfma_f32_16x16x32_bf16 v[140:143], a[140:143], a[44:47], v[140:143]
v_mfma_f32_16x16x32_bf16 v[148:151], a[136:139], a[48:51], v[148:151]
ds_read_b128 a[100:103], v3 offset:40960
v_mfma_f32_16x16x32_bf16 v[148:151], a[140:143], a[52:55], v[148:151]
v_mfma_f32_16x16x32_bf16 v[156:159], a[136:139], a[56:59], v[156:159]
ds_read_b128 a[104:107], v2 offset:43008
v_mfma_f32_16x16x32_bf16 v[156:159], a[140:143], a[60:63], v[156:159]
s_waitcnt lgkmcnt(5)
v_mfma_f32_16x16x32_bf16 v[160:163], a[128:131], a[0:3], v[160:163]
s_waitcnt lgkmcnt(3)
ds_read_b64_tr_b16 a[136:137], v9 offset:0
v_mfma_f32_16x16x32_bf16 v[160:163], a[132:135], a[4:7], v[160:163]
v_mfma_f32_16x16x32_bf16 v[168:171], a[128:131], a[8:11], v[168:171]
ds_read_b64_tr_b16 a[138:139], v9 offset:2048
v_mfma_f32_16x16x32_bf16 v[168:171], a[132:135], a[12:15], v[168:171]
buffer_store_dwordx4 a[180:183], v224, s[4:7], s56 offen sc1
v_mfma_f32_16x16x32_bf16 v[176:179], a[128:131], a[16:19], v[176:179]
s_add_u32 s56, s56, 33792
ds_read_b64_tr_b16 a[140:141], v9 offset:16384
v_mfma_f32_16x16x32_bf16 v[176:179], a[132:135], a[20:23], v[176:179]
v_mfma_f32_16x16x32_bf16 v[184:187], a[128:131], a[24:27], v[184:187]
ds_read_b64_tr_b16 a[142:143], v9 offset:18432
v_mfma_f32_16x16x32_bf16 v[184:187], a[132:135], a[28:31], v[184:187]
v_mfma_f32_16x16x32_bf16 v[192:195], a[128:131], a[32:35], v[192:195]
v_mfma_f32_16x16x32_bf16 v[192:195], a[132:135], a[36:39], v[192:195]
v_mfma_f32_16x16x32_bf16 v[200:203], a[128:131], a[40:43], v[200:203]
ds_read_b128 a[108:111], v3 offset:43008
v_mfma_f32_16x16x32_bf16 v[200:203], a[132:135], a[44:47], v[200:203]
v_mfma_f32_16x16x32_bf16 v[208:211], a[128:131], a[48:51], v[208:211]
ds_read_b128 a[112:115], v2 offset:45056
v_mfma_f32_16x16x32_bf16 v[208:211], a[132:135], a[52:55], v[208:211]
v_mfma_f32_16x16x32_bf16 v[216:219], a[128:131], a[56:59], v[216:219]
v_mfma_f32_16x16x32_bf16 v[216:219], a[132:135], a[60:63], v[216:219]
s_waitcnt lgkmcnt(4)
v_mfma_f32_16x16x32_bf16 v[164:167], a[136:139], a[0:3], v[164:167]
s_waitcnt lgkmcnt(2)
ds_read_b64_tr_b16 a[128:129], v10 offset:0
v_mfma_f32_16x16x32_bf16 v[164:167], a[140:143], a[4:7], v[164:167]
v_mfma_f32_16x16x32_bf16 v[172:175], a[136:139], a[8:11], v[172:175]
ds_read_b64_tr_b16 a[130:131], v10 offset:2048
v_mfma_f32_16x16x32_bf16 v[172:175], a[140:143], a[12:15], v[172:175]
v_mfma_f32_16x16x32_bf16 v[180:183], a[136:139], a[16:19], v[180:183]
ds_read_b64_tr_b16 a[132:133], v10 offset:16384
v_mfma_f32_16x16x32_bf16 v[180:183], a[140:143], a[20:23], v[180:183]
buffer_store_dwordx4 a[184:187], v224, s[4:7], s56 offen sc1
v_mfma_f32_16x16x32_bf16 v[188:191], a[136:139], a[24:27], v[188:191]
s_add_u32 s56, s56, 33792
ds_read_b64_tr_b16 a[134:135], v10 offset:18432
v_mfma_f32_16x16x32_bf16 v[188:191], a[140:143], a[28:31], v[188:191]
v_mfma_f32_16x16x32_bf16 v[196:199], a[136:139], a[32:35], v[196:199]
ds_read_b128 a[116:119], v3 offset:45056
v_mfma_f32_16x16x32_bf16 v[196:199], a[140:143], a[36:39], v[196:199]
v_mfma_f32_16x16x32_bf16 v[204:207], a[136:139], a[40:43], v[204:207]
ds_read_b128 a[120:123], v2 offset:47104
v_mfma_f32_16x16x32_bf16 v[204:207], a[140:143], a[44:47], v[204:207]
v_mfma_f32_16x16x32_bf16 v[212:215], a[136:139], a[48:51], v[212:215]
v_mfma_f32_16x16x32_bf16 v[212:215], a[140:143], a[52:55], v[212:215]
v_mfma_f32_16x16x32_bf16 v[220:223], a[136:139], a[56:59], v[220:223]
ds_read_b128 a[124:127], v3 offset:47104
v_mfma_f32_16x16x32_bf16 v[220:223], a[140:143], a[60:63], v[220:223]
s_waitcnt lgkmcnt(5)
v_mfma_f32_16x16x32_bf16 a[192:195], a[128:131], a[0:3], a[192:195]
s_waitcnt lgkmcnt(3)
ds_read_b64_tr_b16 a[136:137], v11 offset:0
v_mfma_f32_16x16x32_bf16 a[192:195], a[132:135], a[4:7], a[192:195]
v_mfma_f32_16x16x32_bf16 a[200:203], a[128:131], a[8:11], a[200:203]
ds_read_b64_tr_b16 a[138:139], v11 offset:2048
v_mfma_f32_16x16x32_bf16 a[200:203], a[132:135], a[12:15], a[200:203]
v_mfma_f32_16x16x32_bf16 a[208:211], a[128:131], a[16:19], a[208:211]
ds_read_b64_tr_b16 a[140:141], v11 offset:16384
v_mfma_f32_16x16x32_bf16 a[208:211], a[132:135], a[20:23], a[208:211]
v_mfma_f32_16x16x32_bf16 a[216:219], a[128:131], a[24:27], a[216:219]
ds_read_b64_tr_b16 a[142:143], v11 offset:18432
v_mfma_f32_16x16x32_bf16 a[216:219], a[132:135], a[28:31], a[216:219]
buffer_store_dwordx4 a[188:191], v224, s[4:7], s56 offen sc1
v_mfma_f32_16x16x32_bf16 a[224:227], a[128:131], a[32:35], a[224:227]
s_add_u32 s56, s56, 33792
v_mfma_f32_16x16x32_bf16 a[224:227], a[132:135], a[36:39], a[224:227]
v_mfma_f32_16x16x32_bf16 a[232:235], a[128:131], a[40:43], a[232:235]
v_mfma_f32_16x16x32_bf16 a[232:235], a[132:135], a[44:47], a[232:235]
v_mfma_f32_16x16x32_bf16 a[240:243], a[128:131], a[48:51], a[240:243]
v_mfma_f32_16x16x32_bf16 a[240:243], a[132:135], a[52:55], a[240:243]
v_mfma_f32_16x16x32_bf16 a[248:251], a[128:131], a[56:59], a[248:251]
v_mfma_f32_16x16x32_bf16 a[248:251], a[132:135], a[60:63], a[248:251]
s_waitcnt vmcnt(4) lgkmcnt(0)
s_barrier
v_mfma_f32_16x16x32_bf16 a[196:199], a[136:139], a[0:3], a[196:199]
s_add_u32 m0, s29, 65536
ds_read_b64_tr_b16 a[128:129], v4 offset:32768
v_mfma_f32_16x16x32_bf16 a[196:199], a[140:143], a[4:7], a[196:199]
buffer_load_dwordx4 v16, s[12:15], s26 offen offset:0 lds
v_mfma_f32_16x16x32_bf16 a[204:207], a[136:139], a[8:11], a[204:207]
ds_read_b64_tr_b16 a[130:131], v4 offset:34816
v_cmp_gt_u32 vcc, 0x100, v245
v_mfma_f32_16x16x32_bf16 a[204:207], a[140:143], a[12:15], a[204:207]
v_mfma_f32_16x16x32_bf16 a[212:215], a[136:139], a[16:19], a[212:215]
ds_read_b64_tr_b16 a[132:133], v4 offset:49152
v_mfma_f32_16x16x32_bf16 a[212:215], a[140:143], a[20:23], a[212:215]
buffer_load_dwordx4 v17, s[12:15], s26 offen offset:1024 lds
v_mfma_f32_16x16x32_bf16 a[220:223], a[136:139], a[24:27], a[220:223]
ds_read_b64_tr_b16 a[134:135], v4 offset:51200
v_mfma_f32_16x16x32_bf16 a[220:223], a[140:143], a[28:31], a[220:223]
v_mfma_f32_16x16x32_bf16 a[228:231], a[136:139], a[32:35], a[228:231]
v_mfma_f32_16x16x32_bf16 a[228:231], a[140:143], a[36:39], a[228:231]
buffer_load_dwordx4 v18, s[12:15], s26 offen offset:2048 lds
v_mfma_f32_16x16x32_bf16 a[236:239], a[136:139], a[40:43], a[236:239]
v_mfma_f32_16x16x32_bf16 a[236:239], a[140:143], a[44:47], a[236:239]
v_mfma_f32_16x16x32_bf16 a[244:247], a[136:139], a[48:51], a[244:247]
v_mfma_f32_16x16x32_bf16 a[244:247], a[140:143], a[52:55], a[244:247]
buffer_load_dwordx4 v19, s[12:15], s26 offen offset:3072 lds
v_mfma_f32_16x16x32_bf16 a[252:255], a[136:139], a[56:59], a[252:255]
s_add_u32 s26, s26, 524288
v_mfma_f32_16x16x32_bf16 a[252:255], a[140:143], a[60:63], a[252:255]
s_waitcnt lgkmcnt(2)
s_mov_b32 s82, s59
s_cbranch_vccnz M_cntspinK
s_branch Lg_1
Lg_1t:
buffer_load_dword v230, v231, s[4:7], s52 offen sc1
v_mfma_f32_16x16x32_bf16 v[32:35], a[128:131], a[64:67], v[32:35]
s_waitcnt lgkmcnt(0)
s_add_u32 m0, s29, 81920
ds_read_b64_tr_b16 a[136:137], v5 offset:32768
v_mfma_f32_16x16x32_bf16 v[32:35], a[132:135], a[68:71], v[32:35]
buffer_load_dwordx4 v16, s[12:15], s27 offen offset:0 lds
v_mfma_f32_16x16x32_bf16 v[40:43], a[128:131], a[72:75], v[40:43]
s_and_b32 s44, s3, 1
ds_read_b64_tr_b16 a[138:139], v5 offset:34816
v_mfma_f32_16x16x32_bf16 v[40:43], a[132:135], a[76:79], v[40:43]
s_lshl_b32 s44, s44, 8
v_mfma_f32_16x16x32_bf16 v[48:51], a[128:131], a[80:83], v[48:51]
s_lshl_b32 s45, s3, 7
ds_read_b64_tr_b16 a[140:141], v5 offset:49152
v_mfma_f32_16x16x32_bf16 v[48:51], a[132:135], a[84:87], v[48:51]
s_xor_b32 s44, s44, s45
buffer_load_dwordx4 v17, s[12:15], s27 offen offset:1024 lds
v_mfma_f32_16x16x32_bf16 v[56:59], a[128:131], a[88:91], v[56:59]
s_xor_b32 s44, s44, 196608
ds_read_b64_tr_b16 a[142:143], v5 offset:51200
v_mfma_f32_16x16x32_bf16 v[56:59], a[132:135], a[92:95], v[56:59]
v_mfma_f32_16x16x32_bf16 v[64:67], a[128:131], a[96:99], v[64:67]
ds_read_b128 a[0:3], v2 offset:0
v_mfma_f32_16x16x32_bf16 v[64:67], a[132:135], a[100:103], v[64:67]
buffer_load_dwordx4 v18, s[12:15], s27 offen offset:2048 lds
v_mfma_f32_16x16x32_bf16 v[72:75], a[128:131], a[104:107], v[72:75]
ds_read_b128 a[4:7], v3 offset:0
v_mfma_f32_16x16x32_bf16 v[72:75], a[132:135], a[108:111], v[72:75]
v_mfma_f32_16x16x32_bf16 v[80:83], a[128:131], a[112:115], v[80:83]
v_mfma_f32_16x16x32_bf16 v[80:83], a[132:135], a[116:119], v[80:83]
buffer_load_dwordx4 v19, s[12:15], s27 offen offset:3072 lds
v_mfma_f32_16x16x32_bf16 v[88:91], a[128:131], a[120:123], v[88:91]
s_add_u32 s27, s27, 524288
ds_read_b128 a[8:11], v2 offset:2048
v_mfma_f32_16x16x32_bf16 v[88:91], a[132:135], a[124:127], v[88:91]
s_waitcnt lgkmcnt(5)
v_mfma_f32_16x16x32_bf16 v[36:39], a[136:139], a[64:67], v[36:39]
s_waitcnt lgkmcnt(3)
s_add_u32 m0, s28, 32768
ds_read_b64_tr_b16 a[128:129], v6 offset:32768
v_mfma_f32_16x16x32_bf16 v[36:39], a[140:143], a[68:71], v[36:39]
buffer_load_dwordx4 v12, s[8:11], s24 offen offset:0 lds
v_mfma_f32_16x16x32_bf16 v[44:47], a[136:139], a[72:75], v[44:47]
ds_read_b64_tr_b16 a[130:131], v6 offset:34816
v_mfma_f32_16x16x32_bf16 v[44:47], a[140:143], a[76:79], v[44:47]
v_mfma_f32_16x16x32_bf16 v[52:55], a[136:139], a[80:83], v[52:55]
s_mov_b64 s[56:57], s[72:73]
ds_read_b64_tr_b16 a[132:133], v6 offset:49152
v_mfma_f32_16x16x32_bf16 v[52:55], a[140:143], a[84:87], v[52:55]
s_mov_b32 s58, 1835008
buffer_load_dwordx4 v13, s[8:11], s24 offen offset:1024 lds
v_mfma_f32_16x16x32_bf16 v[60:63], a[136:139], a[88:91], v[60:63]
s_mov_b32 s59, 0x20000
ds_read_b64_tr_b16 a[134:135], v6 offset:51200
v_mfma_f32_16x16x32_bf16 v[60:63], a[140:143], a[92:95], v[60:63]
v_mfma_f32_16x16x32_bf16 v[68:71], a[136:139], a[96:99], v[68:71]
ds_read_b128 a[12:15], v3 offset:2048
v_mfma_f32_16x16x32_bf16 v[68:71], a[140:143], a[100:103], v[68:71]
buffer_load_dwordx4 v14, s[8:11], s24 offen offset:2048 lds
v_mfma_f32_16x16x32_bf16 v[76:79], a[136:139], a[104:107], v[76:79]
v_mfma_f32_16x16x32_bf16 v[76:79], a[140:143], a[108:111], v[76:79]
v_mfma_f32_16x16x32_bf16 v[84:87], a[136:139], a[112:115], v[84:87]
ds_read_b128 a[16:19], v2 offset:4096
v_mfma_f32_16x16x32_bf16 v[84:87], a[140:143], a[116:119], v[84:87]
buffer_load_dwordx4 v15, s[8:11], s24 offen offset:3072 lds
v_mfma_f32_16x16x32_bf16 v[92:95], a[136:139], a[120:123], v[92:95]
s_add_u32 s24, s24, 128
ds_read_b128 a[20:23], v3 offset:4096
v_mfma_f32_16x16x32_bf16 v[92:95], a[140:143], a[124:127], v[92:95]
s_waitcnt lgkmcnt(5)
v_mfma_f32_16x16x32_bf16 v[96:99], a[128:131], a[64:67], v[96:99]
s_waitcnt lgkmcnt(3)
s_add_u32 m0, s28, 36864
ds_read_b64_tr_b16 a[136:137], v7 offset:32768
v_mfma_f32_16x16x32_bf16 v[96:99], a[132:135], a[68:71], v[96:99]
buffer_load_dwordx4 v12, s[8:11], s25 offen offset:0 lds
v_mfma_f32_16x16x32_bf16 v[104:107], a[128:131], a[72:75], v[104:107]
ds_read_b64_tr_b16 a[138:139], v7 offset:34816
v_mfma_f32_16x16x32_bf16 v[104:107], a[132:135], a[76:79], v[104:107]
v_mfma_f32_16x16x32_bf16 v[112:115], a[128:131], a[80:83], v[112:115]
ds_read_b64_tr_b16 a[140:141], v7 offset:49152
v_mfma_f32_16x16x32_bf16 v[112:115], a[132:135], a[84:87], v[112:115]
buffer_load_dwordx4 v13, s[8:11], s25 offen offset:1024 lds
v_mfma_f32_16x16x32_bf16 v[120:123], a[128:131], a[88:91], v[120:123]
ds_read_b64_tr_b16 a[142:143], v7 offset:51200
v_mfma_f32_16x16x32_bf16 v[120:123], a[132:135], a[92:95], v[120:123]
v_mfma_f32_16x16x32_bf16 v[128:131], a[128:131], a[96:99], v[128:131]
v_mfma_f32_16x16x32_bf16 v[128:131], a[132:135], a[100:103], v[128:131]
buffer_load_dwordx4 v14, s[8:11], s25 offen offset:2048 lds
v_mfma_f32_16x16x32_bf16 v[136:139], a[128:131], a[104:107], v[136:139]
ds_read_b128 a[24:27], v2 offset:6144
v_mfma_f32_16x16x32_bf16 v[136:139], a[132:135], a[108:111], v[136:139]
v_mfma_f32_16x16x32_bf16 v[144:147], a[128:131], a[112:115], v[144:147]
ds_read_b128 a[28:31], v3 offset:6144
v_mfma_f32_16x16x32_bf16 v[144:147], a[132:135], a[116:119], v[144:147]
buffer_load_dwordx4 v15, s[8:11], s25 offen offset:3072 lds
v_mfma_f32_16x16x32_bf16 v[152:155], a[128:131], a[120:123], v[152:155]
s_add_u32 s25, s25, 128
s_waitcnt vmcnt(12)
v_mfma_f32_16x16x32_bf16 v[152:155], a[132:135], a[124:127], v[152:155]
s_waitcnt lgkmcnt(4)
v_cmp_gt_u32 vcc, 1, v230
v_mfma_f32_16x16x32_bf16 v[100:103], a[136:139], a[64:67], v[100:103]
s_waitcnt lgkmcnt(2)
s_cbranch_vccnz M_ppspinK
M_ppokK:
ds_read_b64_tr_b16 a[128:129], v8 offset:32768
v_mfma_f32_16x16x32_bf16 v[100:103], a[140:143], a[68:71], v[100:103]
buffer_load_dword v230, v229, s[4:7], s53 offen sc1
v_mfma_f32_16x16x32_bf16 v[108:111], a[136:139], a[72:75], v[108:111]
s_mov_b64 s[8:9], s[76:77]
ds_read_b64_tr_b16 a[130:131], v8 offset:34816
v_mfma_f32_16x16x32_bf16 v[108:111], a[140:143], a[76:79], v[108:111]
s_mov_b32 s10, 1835008
buffer_load_dword v230, v229, s[4:7], s48 offen sc1
v_mfma_f32_16x16x32_bf16 v[116:119], a[136:139], a[80:83], v[116:119]
s_lshl_b32 s24, s37, 2
ds_read_b64_tr_b16 a[132:133], v8 offset:49152
v_mfma_f32_16x16x32_bf16 v[116:119], a[140:143], a[84:87], v[116:119]
s_add_u32 s24, s24, s3
buffer_load_dword v230, v229, s[56:59], s49 offen
v_mfma_f32_16x16x32_bf16 v[124:127], a[136:139], a[88:91], v[124:127]
s_mul_i32 s24, s24, 28672
ds_read_b64_tr_b16 a[134:135], v8 offset:51200
v_mfma_f32_16x16x32_bf16 v[124:127], a[140:143], a[92:95], v[124:127]
s_mov_b32 s28, s29
buffer_load_dword v21, v20, s[16:19], s43 offen
v_mfma_f32_16x16x32_bf16 v[132:135], a[136:139], a[96:99], v[132:135]
ds_read_b128 a[32:35], v2 offset:8192
v_mfma_f32_16x16x32_bf16 v[132:135], a[140:143], a[100:103], v[132:135]
v_mfma_f32_16x16x32_bf16 v[140:143], a[136:139], a[104:107], v[140:143]
v_mfma_f32_16x16x32_bf16 v[140:143], a[140:143], a[108:111], v[140:143]
v_mfma_f32_16x16x32_bf16 v[148:151], a[136:139], a[112:115], v[148:151]
ds_read_b128 a[36:39], v3 offset:8192
v_lshrrev_b32 v28, 7, v1
v_mfma_f32_16x16x32_bf16 v[148:151], a[140:143], a[116:119], v[148:151]
v_lshrrev_b32 v29, 1, v28
v_lshlrev_b32 v29, 4, v29
v_mfma_f32_16x16x32_bf16 v[156:159], a[136:139], a[120:123], v[156:159]
ds_read_b128 a[40:43], v2 offset:10240
v_and_b32 v30, 0x70, v1
v_mfma_f32_16x16x32_bf16 v[156:159], a[140:143], a[124:127], v[156:159]
s_waitcnt lgkmcnt(5)
v_xor_b32 v29, v29, v30
v_mul_u32_u24 v28, 896, v28
v_mfma_f32_16x16x32_bf16 v[160:163], a[128:131], a[64:67], v[160:163]
s_waitcnt lgkmcnt(3)
ds_read_b64_tr_b16 a[136:137], v9 offset:32768
v_add_u32 v12, v28, v29
v_mfma_f32_16x16x32_bf16 v[160:163], a[132:135], a[68:71], v[160:163]
v_xor_b32 v29, 64, v29
v_add_u32 v28, v28, v29
v_mfma_f32_16x16x32_bf16 v[168:171], a[128:131], a[72:75], v[168:171]
ds_read_b64_tr_b16 a[138:139], v9 offset:34816
v_add_u32 v13, 6144, v28
v_mfma_f32_16x16x32_bf16 v[168:171], a[132:135], a[76:79], v[168:171]
v_add_u32 v14, 12288, v12
v_add_u32 v15, 18432, v28
v_mfma_f32_16x16x32_bf16 v[176:179], a[128:131], a[80:83], v[176:179]
ds_read_b64_tr_b16 a[140:141], v9 offset:49152
v_xor_b32 v22, s44, v4
v_mfma_f32_16x16x32_bf16 v[176:179], a[132:135], a[84:87], v[176:179]
v_xor_b32 v23, 32, v22
v_xor_b32 v24, 64, v22
v_mfma_f32_16x16x32_bf16 v[184:187], a[128:131], a[88:91], v[184:187]
ds_read_b64_tr_b16 a[142:143], v9 offset:51200
v_xor_b32 v25, 96, v22
v_mfma_f32_16x16x32_bf16 v[184:187], a[132:135], a[92:95], v[184:187]
v_mfma_f32_16x16x32_bf16 v[192:195], a[128:131], a[96:99], v[192:195]
v_mfma_f32_16x16x32_bf16 v[192:195], a[132:135], a[100:103], v[192:195]
v_mfma_f32_16x16x32_bf16 v[200:203], a[128:131], a[104:107], v[200:203]
ds_read_b128 a[44:47], v3 offset:10240
v_mfma_f32_16x16x32_bf16 v[200:203], a[132:135], a[108:111], v[200:203]
v_mfma_f32_16x16x32_bf16 v[208:211], a[128:131], a[112:115], v[208:211]
ds_read_b128 a[48:51], v2 offset:12288
v_mfma_f32_16x16x32_bf16 v[208:211], a[132:135], a[116:119], v[208:211]
v_mfma_f32_16x16x32_bf16 v[216:219], a[128:131], a[120:123], v[216:219]
v_mfma_f32_16x16x32_bf16 v[216:219], a[132:135], a[124:127], v[216:219]
s_waitcnt lgkmcnt(4)
v_mfma_f32_16x16x32_bf16 v[164:167], a[136:139], a[64:67], v[164:167]
s_waitcnt lgkmcnt(2)
ds_read_b64_tr_b16 a[128:129], v10 offset:32768
v_mfma_f32_16x16x32_bf16 v[164:167], a[140:143], a[68:71], v[164:167]
v_mfma_f32_16x16x32_bf16 v[172:175], a[136:139], a[72:75], v[172:175]
ds_read_b64_tr_b16 a[130:131], v10 offset:34816
v_mfma_f32_16x16x32_bf16 v[172:175], a[140:143], a[76:79], v[172:175]
v_mfma_f32_16x16x32_bf16 v[180:183], a[136:139], a[80:83], v[180:183]
ds_read_b64_tr_b16 a[132:133], v10 offset:49152
v_mfma_f32_16x16x32_bf16 v[180:183], a[140:143], a[84:87], v[180:183]
v_mfma_f32_16x16x32_bf16 v[188:191], a[136:139], a[88:91], v[188:191]
ds_read_b64_tr_b16 a[134:135], v10 offset:51200
v_mfma_f32_16x16x32_bf16 v[188:191], a[140:143], a[92:95], v[188:191]
v_mfma_f32_16x16x32_bf16 v[196:199], a[136:139], a[96:99], v[196:199]
ds_read_b128 a[52:55], v3 offset:12288
v_mfma_f32_16x16x32_bf16 v[196:199], a[140:143], a[100:103], v[196:199]
v_mfma_f32_16x16x32_bf16 v[204:207], a[136:139], a[104:107], v[204:207]
ds_read_b128 a[56:59], v2 offset:14336
v_mfma_f32_16x16x32_bf16 v[204:207], a[140:143], a[108:111], v[204:207]
v_mfma_f32_16x16x32_bf16 v[212:215], a[136:139], a[112:115], v[212:215]
v_mfma_f32_16x16x32_bf16 v[212:215], a[140:143], a[116:119], v[212:215]
v_mfma_f32_16x16x32_bf16 v[220:223], a[136:139], a[120:123], v[220:223]
ds_read_b128 a[60:63], v3 offset:14336
v_mfma_f32_16x16x32_bf16 v[220:223], a[140:143], a[124:127], v[220:223]
s_waitcnt lgkmcnt(5)
v_mfma_f32_16x16x32_bf16 a[192:195], a[128:131], a[64:67], a[192:195]
s_waitcnt lgkmcnt(3)
ds_read_b64_tr_b16 a[136:137], v11 offset:32768
v_mfma_f32_16x16x32_bf16 a[192:195], a[132:135], a[68:71], a[192:195]
v_mfma_f32_16x16x32_bf16 a[200:203], a[128:131], a[72:75], a[200:203]
ds_read_b64_tr_b16 a[138:139], v11 offset:34816
v_mfma_f32_16x16x32_bf16 a[200:203], a[132:135], a[76:79], a[200:203]
v_mfma_f32_16x16x32_bf16 a[208:211], a[128:131], a[80:83], a[208:211]
ds_read_b64_tr_b16 a[140:141], v11 offset:49152
v_mfma_f32_16x16x32_bf16 a[208:211], a[132:135], a[84:87], a[208:211]
v_mfma_f32_16x16x32_bf16 a[216:219], a[128:131], a[88:91], a[216:219]
ds_read_b64_tr_b16 a[142:143], v11 offset:51200
v_mfma_f32_16x16x32_bf16 a[216:219], a[132:135], a[92:95], a[216:219]
v_mfma_f32_16x16x32_bf16 a[224:227], a[128:131], a[96:99], a[224:227]
v_mfma_f32_16x16x32_bf16 a[224:227], a[132:135], a[100:103], a[224:227]
v_mfma_f32_16x16x32_bf16 a[232:235], a[128:131], a[104:107], a[232:235]
v_mfma_f32_16x16x32_bf16 a[232:235], a[132:135], a[108:111], a[232:235]
v_mfma_f32_16x16x32_bf16 a[240:243], a[128:131], a[112:115], a[240:243]
v_mfma_f32_16x16x32_bf16 a[240:243], a[132:135], a[116:119], a[240:243]
v_mfma_f32_16x16x32_bf16 a[248:251], a[128:131], a[120:123], a[248:251]
v_mfma_f32_16x16x32_bf16 a[248:251], a[132:135], a[124:127], a[248:251]
s_waitcnt vmcnt(4) lgkmcnt(0)
s_barrier
v_mfma_f32_16x16x32_bf16 a[196:199], a[136:139], a[64:67], a[196:199]
s_add_u32 m0, s29, 98304
ds_read_b64_tr_b16 a[128:129], v4 offset:0
v_mfma_f32_16x16x32_bf16 a[196:199], a[140:143], a[68:71], a[196:199]
buffer_load_dwordx4 v16, s[12:15], s26 offen offset:0 lds
v_mfma_f32_16x16x32_bf16 a[204:207], a[136:139], a[72:75], a[204:207]
ds_read_b64_tr_b16 a[130:131], v4 offset:2048
v_mfma_f32_16x16x32_bf16 a[204:207], a[140:143], a[76:79], a[204:207]
v_mfma_f32_16x16x32_bf16 a[212:215], a[136:139], a[80:83], a[212:215]
ds_read_b64_tr_b16 a[132:133], v4 offset:16384
v_mfma_f32_16x16x32_bf16 a[212:215], a[140:143], a[84:87], a[212:215]
buffer_load_dwordx4 v17, s[12:15], s26 offen offset:1024 lds
v_mfma_f32_16x16x32_bf16 a[220:223], a[136:139], a[88:91], a[220:223]
ds_read_b64_tr_b16 a[134:135], v4 offset:18432
v_mfma_f32_16x16x32_bf16 a[220:223], a[140:143], a[92:95], a[220:223]
v_mfma_f32_16x16x32_bf16 a[228:231], a[136:139], a[96:99], a[228:231]
v_mfma_f32_16x16x32_bf16 a[228:231], a[140:143], a[100:103], a[228:231]
buffer_load_dwordx4 v18, s[12:15], s26 offen offset:2048 lds
v_mfma_f32_16x16x32_bf16 a[236:239], a[136:139], a[104:107], a[236:239]
v_mfma_f32_16x16x32_bf16 a[236:239], a[140:143], a[108:111], a[236:239]
v_mfma_f32_16x16x32_bf16 a[244:247], a[136:139], a[112:115], a[244:247]
v_mfma_f32_16x16x32_bf16 a[244:247], a[140:143], a[116:119], a[244:247]
buffer_load_dwordx4 v19, s[12:15], s26 offen offset:3072 lds
v_mfma_f32_16x16x32_bf16 a[252:255], a[136:139], a[120:123], a[252:255]
s_add_u32 s26, s26, 524288
v_mfma_f32_16x16x32_bf16 a[252:255], a[140:143], a[124:127], a[252:255]
s_waitcnt lgkmcnt(2)
v_mfma_f32_16x16x32_bf16 v[32:35], a[128:131], a[0:3], v[32:35]
s_waitcnt lgkmcnt(0)
s_add_u32 m0, s29, 114688
ds_read_b64_tr_b16 a[136:137], v5 offset:0
v_mfma_f32_16x16x32_bf16 v[32:35], a[132:135], a[4:7], v[32:35]
buffer_load_dwordx4 v16, s[12:15], s27 offen offset:0 lds
v_mfma_f32_16x16x32_bf16 v[40:43], a[128:131], a[8:11], v[40:43]
ds_read_b64_tr_b16 a[138:139], v5 offset:2048
v_mfma_f32_16x16x32_bf16 v[40:43], a[132:135], a[12:15], v[40:43]
v_mfma_f32_16x16x32_bf16 v[48:51], a[128:131], a[16:19], v[48:51]
ds_read_b64_tr_b16 a[140:141], v5 offset:16384
v_mfma_f32_16x16x32_bf16 v[48:51], a[132:135], a[20:23], v[48:51]
buffer_load_dwordx4 v17, s[12:15], s27 offen offset:1024 lds
v_mfma_f32_16x16x32_bf16 v[56:59], a[128:131], a[24:27], v[56:59]
ds_read_b64_tr_b16 a[142:143], v5 offset:18432
v_mfma_f32_16x16x32_bf16 v[56:59], a[132:135], a[28:31], v[56:59]
v_mfma_f32_16x16x32_bf16 v[64:67], a[128:131], a[32:35], v[64:67]
ds_read_b128 a[64:67], v2 offset:32768
v_mfma_f32_16x16x32_bf16 v[64:67], a[132:135], a[36:39], v[64:67]
buffer_load_dwordx4 v18, s[12:15], s27 offen offset:2048 lds
v_mfma_f32_16x16x32_bf16 v[72:75], a[128:131], a[40:43], v[72:75]
ds_read_b128 a[68:71], v3 offset:32768
v_mfma_f32_16x16x32_bf16 v[72:75], a[132:135], a[44:47], v[72:75]
v_mfma_f32_16x16x32_bf16 v[80:83], a[128:131], a[48:51], v[80:83]
v_mfma_f32_16x16x32_bf16 v[80:83], a[132:135], a[52:55], v[80:83]
buffer_load_dwordx4 v19, s[12:15], s27 offen offset:3072 lds
v_mfma_f32_16x16x32_bf16 v[88:91], a[128:131], a[56:59], v[88:91]
s_add_u32 s27, s27, 524288
ds_read_b128 a[72:75], v2 offset:34816
v_mfma_f32_16x16x32_bf16 v[88:91], a[132:135], a[60:63], v[88:91]
s_waitcnt lgkmcnt(5)
v_mfma_f32_16x16x32_bf16 v[36:39], a[136:139], a[0:3], v[36:39]
s_waitcnt lgkmcnt(3)
s_add_u32 m0, s28, 0
ds_read_b64_tr_b16 a[128:129], v6 offset:0
v_mfma_f32_16x16x32_bf16 v[36:39], a[140:143], a[4:7], v[36:39]
buffer_load_dwordx4 v12, s[8:11], s24 offen offset:0 lds
v_mfma_f32_16x16x32_bf16 v[44:47], a[136:139], a[8:11], v[44:47]
ds_read_b64_tr_b16 a[130:131], v6 offset:2048
v_mfma_f32_16x16x32_bf16 v[44:47], a[140:143], a[12:15], v[44:47]
v_mfma_f32_16x16x32_bf16 v[52:55], a[136:139], a[16:19], v[52:55]
ds_read_b64_tr_b16 a[132:133], v6 offset:16384
v_mfma_f32_16x16x32_bf16 v[52:55], a[140:143], a[20:23], v[52:55]
buffer_load_dwordx4 v13, s[8:11], s24 offen offset:1024 lds
v_mfma_f32_16x16x32_bf16 v[60:63], a[136:139], a[24:27], v[60:63]
ds_read_b64_tr_b16 a[134:135], v6 offset:18432
v_mfma_f32_16x16x32_bf16 v[60:63], a[140:143], a[28:31], v[60:63]
v_mfma_f32_16x16x32_bf16 v[68:71], a[136:139], a[32:35], v[68:71]
ds_read_b128 a[76:79], v3 offset:34816
v_mfma_f32_16x16x32_bf16 v[68:71], a[140:143], a[36:39], v[68:71]
buffer_load_dwordx4 v14, s[8:11], s24 offen offset:2048 lds
v_mfma_f32_16x16x32_bf16 v[76:79], a[136:139], a[40:43], v[76:79]
v_mfma_f32_16x16x32_bf16 v[76:79], a[140:143], a[44:47], v[76:79]
v_mfma_f32_16x16x32_bf16 v[84:87], a[136:139], a[48:51], v[84:87]
ds_read_b128 a[80:83], v2 offset:36864
v_mfma_f32_16x16x32_bf16 v[84:87], a[140:143], a[52:55], v[84:87]
buffer_load_dwordx4 v15, s[8:11], s24 offen offset:3072 lds
v_mfma_f32_16x16x32_bf16 v[92:95], a[136:139], a[56:59], v[92:95]
s_add_u32 s24, s24, 128
ds_read_b128 a[84:87], v3 offset:36864
v_mfma_f32_16x16x32_bf16 v[92:95], a[140:143], a[60:63], v[92:95]
s_waitcnt lgkmcnt(3)
s_mov_b64 s[12:13], s[80:81]
v_mfma_f32_16x16x32_bf16 v[96:99], a[128:131], a[0:3], v[96:99]
s_mov_b32 s14, 3670016
s_add_u32 m0, s28, 16384
ds_read_b64_tr_b16 a[136:137], v7 offset:0
v_mfma_f32_16x16x32_bf16 v[96:99], a[132:135], a[4:7], v[96:99]
buffer_load_dwordx4 v12, s[8:11], s24 offen offset:0 lds
v_mfma_f32_16x16x32_bf16 v[104:107], a[128:131], a[8:11], v[104:107]
ds_read_b64_tr_b16 a[138:139], v7 offset:2048
v_mfma_f32_16x16x32_bf16 v[104:107], a[132:135], a[12:15], v[104:107]
v_mfma_f32_16x16x32_bf16 v[112:115], a[128:131], a[16:19], v[112:115]
ds_read_b64_tr_b16 a[140:141], v7 offset:16384
v_mfma_f32_16x16x32_bf16 v[112:115], a[132:135], a[20:23], v[112:115]
buffer_load_dwordx4 v13, s[8:11], s24 offen offset:1024 lds
v_mfma_f32_16x16x32_bf16 v[120:123], a[128:131], a[24:27], v[120:123]
ds_read_b64_tr_b16 a[142:143], v7 offset:18432
v_mfma_f32_16x16x32_bf16 v[120:123], a[132:135], a[28:31], v[120:123]
v_mfma_f32_16x16x32_bf16 v[128:131], a[128:131], a[32:35], v[128:131]
v_mfma_f32_16x16x32_bf16 v[128:131], a[132:135], a[36:39], v[128:131]
buffer_load_dwordx4 v14, s[8:11], s24 offen offset:2048 lds
v_mfma_f32_16x16x32_bf16 v[136:139], a[128:131], a[40:43], v[136:139]
ds_read_b128 a[88:91], v2 offset:38912
v_mfma_f32_16x16x32_bf16 v[136:139], a[132:135], a[44:47], v[136:139]
v_mfma_f32_16x16x32_bf16 v[144:147], a[128:131], a[48:51], v[144:147]
ds_read_b128 a[92:95], v3 offset:38912
v_mfma_f32_16x16x32_bf16 v[144:147], a[132:135], a[52:55], v[144:147]
buffer_load_dwordx4 v15, s[8:11], s24 offen offset:3072 lds
v_mfma_f32_16x16x32_bf16 v[152:155], a[128:131], a[56:59], v[152:155]
s_add_u32 s24, s24, 128
v_mfma_f32_16x16x32_bf16 v[152:155], a[132:135], a[60:63], v[152:155]
s_waitcnt lgkmcnt(2)
s_sub_u32 s26, s26, 8388608
v_mfma_f32_16x16x32_bf16 v[100:103], a[136:139], a[0:3], v[100:103]
s_sub_u32 s27, s27, 8388608
s_add_u32 m0, s29, 131072
ds_read_b64_tr_b16 a[128:129], v8 offset:0
v_mfma_f32_16x16x32_bf16 v[100:103], a[140:143], a[4:7], v[100:103]
buffer_load_dwordx4 v16, s[12:15], s26 offen offset:0 lds
v_mfma_f32_16x16x32_bf16 v[108:111], a[136:139], a[8:11], v[108:111]
ds_read_b64_tr_b16 a[130:131], v8 offset:2048
v_mfma_f32_16x16x32_bf16 v[108:111], a[140:143], a[12:15], v[108:111]
v_mfma_f32_16x16x32_bf16 v[116:119], a[136:139], a[16:19], v[116:119]
ds_read_b64_tr_b16 a[132:133], v8 offset:16384
v_mfma_f32_16x16x32_bf16 v[116:119], a[140:143], a[20:23], v[116:119]
buffer_load_dwordx4 v17, s[12:15], s26 offen offset:1024 lds
v_mfma_f32_16x16x32_bf16 v[124:127], a[136:139], a[24:27], v[124:127]
ds_read_b64_tr_b16 a[134:135], v8 offset:18432
v_mfma_f32_16x16x32_bf16 v[124:127], a[140:143], a[28:31], v[124:127]
v_mfma_f32_16x16x32_bf16 v[132:135], a[136:139], a[32:35], v[132:135]
ds_read_b128 a[96:99], v2 offset:40960
v_mfma_f32_16x16x32_bf16 v[132:135], a[140:143], a[36:39], v[132:135]
buffer_load_dwordx4 v18, s[12:15], s26 offen offset:2048 lds
v_mfma_f32_16x16x32_bf16 v[140:143], a[136:139], a[40:43], v[140:143]
v_mfma_f32_16x16x32_bf16 v[140:143], a[140:143], a[44:47], v[140:143]
v_mfma_f32_16x16x32_bf16 v[148:151], a[136:139], a[48:51], v[148:151]
ds_read_b128 a[100:103], v3 offset:40960
v_mfma_f32_16x16x32_bf16 v[148:151], a[140:143], a[52:55], v[148:151]
buffer_load_dwordx4 v19, s[12:15], s26 offen offset:3072 lds
v_mfma_f32_16x16x32_bf16 v[156:159], a[136:139], a[56:59], v[156:159]
s_add_u32 s26, s26, 524288
ds_read_b128 a[104:107], v2 offset:43008
v_mfma_f32_16x16x32_bf16 v[156:159], a[140:143], a[60:63], v[156:159]
s_waitcnt lgkmcnt(5)
v_mfma_f32_16x16x32_bf16 v[160:163], a[128:131], a[0:3], v[160:163]
s_waitcnt lgkmcnt(3)
s_add_u32 m0, s29, 147456
ds_read_b64_tr_b16 a[136:137], v9 offset:0
v_mfma_f32_16x16x32_bf16 v[160:163], a[132:135], a[4:7], v[160:163]
buffer_load_dwordx4 v16, s[12:15], s27 offen offset:0 lds
v_mfma_f32_16x16x32_bf16 v[168:171], a[128:131], a[8:11], v[168:171]
ds_read_b64_tr_b16 a[138:139], v9 offset:2048
v_mfma_f32_16x16x32_bf16 v[168:171], a[132:135], a[12:15], v[168:171]
v_mfma_f32_16x16x32_bf16 v[176:179], a[128:131], a[16:19], v[176:179]
ds_read_b64_tr_b16 a[140:141], v9 offset:16384
v_mfma_f32_16x16x32_bf16 v[176:179], a[132:135], a[20:23], v[176:179]
buffer_load_dwordx4 v17, s[12:15], s27 offen offset:1024 lds
v_mfma_f32_16x16x32_bf16 v[184:187], a[128:131], a[24:27], v[184:187]
ds_read_b64_tr_b16 a[142:143], v9 offset:18432
v_mfma_f32_16x16x32_bf16 v[184:187], a[132:135], a[28:31], v[184:187]
v_mfma_f32_16x16x32_bf16 v[192:195], a[128:131], a[32:35], v[192:195]
v_mfma_f32_16x16x32_bf16 v[192:195], a[132:135], a[36:39], v[192:195]
buffer_load_dwordx4 v18, s[12:15], s27 offen offset:2048 lds
v_mfma_f32_16x16x32_bf16 v[200:203], a[128:131], a[40:43], v[200:203]
ds_read_b128 a[108:111], v3 offset:43008
v_mfma_f32_16x16x32_bf16 v[200:203], a[132:135], a[44:47], v[200:203]
v_mfma_f32_16x16x32_bf16 v[208:211], a[128:131], a[48:51], v[208:211]
ds_read_b128 a[112:115], v2 offset:45056
v_mfma_f32_16x16x32_bf16 v[208:211], a[132:135], a[52:55], v[208:211]
buffer_load_dwordx4 v19, s[12:15], s27 offen offset:3072 lds
v_mfma_f32_16x16x32_bf16 v[216:219], a[128:131], a[56:59], v[216:219]
s_add_u32 s27, s27, 524288
v_mfma_f32_16x16x32_bf16 v[216:219], a[132:135], a[60:63], v[216:219]
s_waitcnt lgkmcnt(4)
v_mfma_f32_16x16x32_bf16 v[164:167], a[136:139], a[0:3], v[164:167]
s_waitcnt lgkmcnt(2)
ds_read_b64_tr_b16 a[128:129], v10 offset:0
v_mfma_f32_16x16x32_bf16 v[164:167], a[140:143], a[4:7], v[164:167]
v_mfma_f32_16x16x32_bf16 v[172:175], a[136:139], a[8:11], v[172:175]
ds_read_b64_tr_b16 a[130:131], v10 offset:2048
v_mfma_f32_16x16x32_bf16 v[172:175], a[140:143], a[12:15], v[172:175]
v_mfma_f32_16x16x32_bf16 v[180:183], a[136:139], a[16:19], v[180:183]
ds_read_b64_tr_b16 a[132:133], v10 offset:16384
v_mfma_f32_16x16x32_bf16 v[180:183], a[140:143], a[20:23], v[180:183]
v_mfma_f32_16x16x32_bf16 v[188:191], a[136:139], a[24:27], v[188:191]
ds_read_b64_tr_b16 a[134:135], v10 offset:18432
v_mfma_f32_16x16x32_bf16 v[188:191], a[140:143], a[28:31], v[188:191]
v_mfma_f32_16x16x32_bf16 v[196:199], a[136:139], a[32:35], v[196:199]
ds_read_b128 a[116:119], v3 offset:45056
v_mfma_f32_16x16x32_bf16 v[196:199], a[140:143], a[36:39], v[196:199]
v_mfma_f32_16x16x32_bf16 v[204:207], a[136:139], a[40:43], v[204:207]
ds_read_b128 a[120:123], v2 offset:47104
v_mfma_f32_16x16x32_bf16 v[204:207], a[140:143], a[44:47], v[204:207]
v_mfma_f32_16x16x32_bf16 v[212:215], a[136:139], a[48:51], v[212:215]
v_mfma_f32_16x16x32_bf16 v[212:215], a[140:143], a[52:55], v[212:215]
v_mfma_f32_16x16x32_bf16 v[220:223], a[136:139], a[56:59], v[220:223]
ds_read_b128 a[124:127], v3 offset:47104
v_mfma_f32_16x16x32_bf16 v[220:223], a[140:143], a[60:63], v[220:223]
s_waitcnt lgkmcnt(5)
v_mfma_f32_16x16x32_bf16 a[192:195], a[128:131], a[0:3], a[192:195]
s_waitcnt lgkmcnt(3)
ds_read_b64_tr_b16 a[136:137], v11 offset:0
v_mfma_f32_16x16x32_bf16 a[192:195], a[132:135], a[4:7], a[192:195]
v_mfma_f32_16x16x32_bf16 a[200:203], a[128:131], a[8:11], a[200:203]
ds_read_b64_tr_b16 a[138:139], v11 offset:2048
v_mfma_f32_16x16x32_bf16 a[200:203], a[132:135], a[12:15], a[200:203]
v_mfma_f32_16x16x32_bf16 a[208:211], a[128:131], a[16:19], a[208:211]
ds_read_b64_tr_b16 a[140:141], v11 offset:16384
v_mfma_f32_16x16x32_bf16 a[208:211], a[132:135], a[20:23], a[208:211]
v_mfma_f32_16x16x32_bf16 a[216:219], a[128:131], a[24:27], a[216:219]
ds_read_b64_tr_b16 a[142:143], v11 offset:18432
v_mfma_f32_16x16x32_bf16 a[216:219], a[132:135], a[28:31], a[216:219]
v_mfma_f32_16x16x32_bf16 a[224:227], a[128:131], a[32:35], a[224:227]
v_mfma_f32_16x16x32_bf16 a[224:227], a[132:135], a[36:39], a[224:227]
v_mfma_f32_16x16x32_bf16 a[232:235], a[128:131], a[40:43], a[232:235]
v_mfma_f32_16x16x32_bf16 a[232:235], a[132:135], a[44:47], a[232:235]
v_mfma_f32_16x16x32_bf16 a[240:243], a[128:131], a[48:51], a[240:243]
v_mfma_f32_16x16x32_bf16 a[240:243], a[132:135], a[52:55], a[240:243]
v_mfma_f32_16x16x32_bf16 a[248:251], a[128:131], a[56:59], a[248:251]
v_mfma_f32_16x16x32_bf16 a[248:251], a[132:135], a[60:63], a[248:251]
s_waitcnt vmcnt(12) lgkmcnt(0)
s_barrier
v_mfma_f32_16x16x32_bf16 a[196:199], a[136:139], a[0:3], a[196:199]
s_add_u32 m0, s28, 32768
ds_read_b64_tr_b16 a[128:129], v4 offset:32768
v_mfma_f32_16x16x32_bf16 a[196:199], a[140:143], a[4:7], a[196:199]
s_lshr_b32 s22, s3, 1
buffer_load_dwordx4 v12, s[8:11], s24 offen offset:0 lds
v_mfma_f32_16x16x32_bf16 a[204:207], a[136:139], a[8:11], a[204:207]
s_lshl_b32 s22, s22, 14
ds_read_b64_tr_b16 a[130:131], v4 offset:34816
v_subrev_u32 v2, s22, v2
v_mfma_f32_16x16x32_bf16 a[204:207], a[140:143], a[12:15], a[204:207]
v_subrev_u32 v3, s22, v3
v_mfma_f32_16x16x32_bf16 a[212:215], a[136:139], a[16:19], a[212:215]
ds_read_b64_tr_b16 a[132:133], v4 offset:49152
v_mfma_f32_16x16x32_bf16 a[212:215], a[140:143], a[20:23], a[212:215]
buffer_load_dwordx4 v13, s[8:11], s24 offen offset:1024 lds
v_mfma_f32_16x16x32_bf16 a[220:223], a[136:139], a[24:27], a[220:223]
ds_read_b64_tr_b16 a[134:135], v4 offset:51200
v_mfma_f32_16x16x32_bf16 a[220:223], a[140:143], a[28:31], a[220:223]
v_mfma_f32_16x16x32_bf16 a[228:231], a[136:139], a[32:35], a[228:231]
v_mfma_f32_16x16x32_bf16 a[228:231], a[140:143], a[36:39], a[228:231]
buffer_load_dwordx4 v14, s[8:11], s24 offen offset:2048 lds
v_mfma_f32_16x16x32_bf16 a[236:239], a[136:139], a[40:43], a[236:239]
v_mfma_f32_16x16x32_bf16 a[236:239], a[140:143], a[44:47], a[236:239]
v_mfma_f32_16x16x32_bf16 a[244:247], a[136:139], a[48:51], a[244:247]
v_mfma_f32_16x16x32_bf16 a[244:247], a[140:143], a[52:55], a[244:247]
buffer_load_dwordx4 v15, s[8:11], s24 offen offset:3072 lds
v_mfma_f32_16x16x32_bf16 a[252:255], a[136:139], a[56:59], a[252:255]
s_add_u32 s24, s24, 128
v_mfma_f32_16x16x32_bf16 a[252:255], a[140:143], a[60:63], a[252:255]
s_waitcnt lgkmcnt(2)
v_mfma_f32_16x16x32_bf16 v[32:35], a[128:131], a[64:67], v[32:35]
s_waitcnt lgkmcnt(0)
s_add_u32 m0, s29, 65536
ds_read_b64_tr_b16 a[136:137], v5 offset:32768
v_mfma_f32_16x16x32_bf16 v[32:35], a[132:135], a[68:71], v[32:35]
buffer_load_dwordx4 v16, s[12:15], s26 offen offset:0 lds
v_mfma_f32_16x16x32_bf16 v[40:43], a[128:131], a[72:75], v[40:43]
ds_read_b64_tr_b16 a[138:139], v5 offset:34816
v_mfma_f32_16x16x32_bf16 v[40:43], a[132:135], a[76:79], v[40:43]
v_mfma_f32_16x16x32_bf16 v[48:51], a[128:131], a[80:83], v[48:51]
ds_read_b64_tr_b16 a[140:141], v5 offset:49152
v_mfma_f32_16x16x32_bf16 v[48:51], a[132:135], a[84:87], v[48:51]
buffer_load_dwordx4 v17, s[12:15], s26 offen offset:1024 lds
v_mfma_f32_16x16x32_bf16 v[56:59], a[128:131], a[88:91], v[56:59]
ds_read_b64_tr_b16 a[142:143], v5 offset:51200
v_mfma_f32_16x16x32_bf16 v[56:59], a[132:135], a[92:95], v[56:59]
v_mfma_f32_16x16x32_bf16 v[64:67], a[128:131], a[96:99], v[64:67]
ds_read_b128 a[0:3], v2 offset:0
v_mfma_f32_16x16x32_bf16 v[64:67], a[132:135], a[100:103], v[64:67]
buffer_load_dwordx4 v18, s[12:15], s26 offen offset:2048 lds
v_mfma_f32_16x16x32_bf16 v[72:75], a[128:131], a[104:107], v[72:75]
ds_read_b128 a[4:7], v3 offset:0
v_mfma_f32_16x16x32_bf16 v[72:75], a[132:135], a[108:111], v[72:75]
v_mfma_f32_16x16x32_bf16 v[80:83], a[128:131], a[112:115], v[80:83]
v_mfma_f32_16x16x32_bf16 v[80:83], a[132:135], a[116:119], v[80:83]
buffer_load_dwordx4 v19, s[12:15], s26 offen offset:3072 lds
v_mfma_f32_16x16x32_bf16 v[88:91], a[128:131], a[120:123], v[88:91]
s_add_u32 s26, s26, 524288
ds_read_b128 a[8:11], v2 offset:2048
v_mfma_f32_16x16x32_bf16 v[88:91], a[132:135], a[124:127], v[88:91]
s_waitcnt lgkmcnt(5)
v_mfma_f32_16x16x32_bf16 v[36:39], a[136:139], a[64:67], v[36:39]
s_waitcnt lgkmcnt(3)
s_add_u32 m0, s29, 81920
ds_read_b64_tr_b16 a[128:129], v6 offset:32768
v_mfma_f32_16x16x32_bf16 v[36:39], a[140:143], a[68:71], v[36:39]
buffer_load_dwordx4 v16, s[12:15], s27 offen offset:0 lds
v_mfma_f32_16x16x32_bf16 v[44:47], a[136:139], a[72:75], v[44:47]
ds_read_b64_tr_b16 a[130:131], v6 offset:34816
v_mfma_f32_16x16x32_bf16 v[44:47], a[140:143], a[76:79], v[44:47]
v_mfma_f32_16x16x32_bf16 v[52:55], a[136:139], a[80:83], v[52:55]
ds_read_b64_tr_b16 a[132:133], v6 offset:49152
v_mfma_f32_16x16x32_bf16 v[52:55], a[140:143], a[84:87], v[52:55]
buffer_load_dwordx4 v17, s[12:15], s27 offen offset:1024 lds
v_mfma_f32_16x16x32_bf16 v[60:63], a[136:139], a[88:91], v[60:63]
ds_read_b64_tr_b16 a[134:135], v6 offset:51200
v_cvt_pk_bf16_f32 v32, v32, v33
v_mfma_f32_16x16x32_bf16 v[60:63], a[140:143], a[92:95], v[60:63]
v_cvt_pk_bf16_f32 v33, v34, v35
v_cvt_pk_bf16_f32 v34, v36, v37
v_mfma_f32_16x16x32_bf16 v[68:71], a[136:139], a[96:99], v[68:71]
ds_read_b128 a[12:15], v3 offset:2048
v_cvt_pk_bf16_f32 v35, v38, v39
v_mfma_f32_16x16x32_bf16 v[68:71], a[140:143], a[100:103], v[68:71]
buffer_load_dwordx4 v18, s[12:15], s27 offen offset:2048 lds
v_mfma_f32_16x16x32_bf16 v[76:79], a[136:139], a[104:107], v[76:79]
v_cvt_pk_bf16_f32 v40, v40, v41
v_cvt_pk_bf16_f32 v41, v42, v43
v_mfma_f32_16x16x32_bf16 v[76:79], a[140:143], a[108:111], v[76:79]
v_cvt_pk_bf16_f32 v42, v44, v45
v_cvt_pk_bf16_f32 v43, v46, v47
v_mfma_f32_16x16x32_bf16 v[84:87], a[136:139], a[112:115], v[84:87]
ds_read_b128 a[16:19], v2 offset:4096
v_cvt_pk_bf16_f32 v48, v48, v49
v_mfma_f32_16x16x32_bf16 v[84:87], a[140:143], a[116:119], v[84:87]
buffer_load_dwordx4 v19, s[12:15], s27 offen offset:3072 lds
v_mfma_f32_16x16x32_bf16 v[92:95], a[136:139], a[120:123], v[92:95]
s_add_u32 s27, s27, 524288
ds_read_b128 a[20:23], v3 offset:4096
v_cvt_pk_bf16_f32 v49, v50, v51
v_mfma_f32_16x16x32_bf16 v[92:95], a[140:143], a[124:127], v[92:95]
s_waitcnt lgkmcnt(3)
v_cvt_pk_bf16_f32 v50, v52, v53
v_cvt_pk_bf16_f32 v51, v54, v55
v_mfma_f32_16x16x32_bf16 v[96:99], a[128:131], a[64:67], v[96:99]
s_add_u32 m0, s28, 49152
ds_read_b64_tr_b16 a[136:137], v7 offset:32768
v_cvt_pk_bf16_f32 v56, v56, v57
v_mfma_f32_16x16x32_bf16 v[96:99], a[132:135], a[68:71], v[96:99]
buffer_load_dwordx4 v12, s[8:11], s24 offen offset:0 lds
v_mfma_f32_16x16x32_bf16 v[104:107], a[128:131], a[72:75], v[104:107]
ds_read_b64_tr_b16 a[138:139], v7 offset:34816
v_cvt_pk_bf16_f32 v57, v58, v59
v_mfma_f32_16x16x32_bf16 v[104:107], a[132:135], a[76:79], v[104:107]
v_cvt_pk_bf16_f32 v58, v60, v61
v_cvt_pk_bf16_f32 v59, v62, v63
v_mfma_f32_16x16x32_bf16 v[112:115], a[128:131], a[80:83], v[112:115]
ds_read_b64_tr_b16 a[140:141], v7 offset:49152
v_cvt_pk_bf16_f32 v64, v64, v65
v_mfma_f32_16x16x32_bf16 v[112:115], a[132:135], a[84:87], v[112:115]
buffer_load_dwordx4 v13, s[8:11], s24 offen offset:1024 lds
v_mfma_f32_16x16x32_bf16 v[120:123], a[128:131], a[88:91], v[120:123]
ds_read_b64_tr_b16 a[142:143], v7 offset:51200
v_cvt_pk_bf16_f32 v65, v66, v67
v_mfma_f32_16x16x32_bf16 v[120:123], a[132:135], a[92:95], v[120:123]
v_cvt_pk_bf16_f32 v66, v68, v69
v_cvt_pk_bf16_f32 v67, v70, v71
v_mfma_f32_16x16x32_bf16 v[128:131], a[128:131], a[96:99], v[128:131]
v_cvt_pk_bf16_f32 v72, v72, v73
v_cvt_pk_bf16_f32 v73, v74, v75
v_mfma_f32_16x16x32_bf16 v[128:131], a[132:135], a[100:103], v[128:131]
buffer_load_dwordx4 v14, s[8:11], s24 offen offset:2048 lds
v_mfma_f32_16x16x32_bf16 v[136:139], a[128:131], a[104:107], v[136:139]
ds_read_b128 a[24:27], v2 offset:6144
v_cvt_pk_bf16_f32 v74, v76, v77
v_mfma_f32_16x16x32_bf16 v[136:139], a[132:135], a[108:111], v[136:139]
buffer_store_dwordx4 v[32:35], v1, s[4:7], s31 offen sc1
v_mfma_f32_16x16x32_bf16 v[144:147], a[128:131], a[112:115], v[144:147]
s_add_u32 s31, s31, s32
ds_read_b128 a[28:31], v3 offset:6144
v_cvt_pk_bf16_f32 v75, v78, v79
v_mfma_f32_16x16x32_bf16 v[144:147], a[132:135], a[116:119], v[144:147]
buffer_load_dwordx4 v15, s[8:11], s24 offen offset:3072 lds
v_mfma_f32_16x16x32_bf16 v[152:155], a[128:131], a[120:123], v[152:155]
s_add_u32 s24, s24, 128
v_cvt_pk_bf16_f32 v80, v80, v81
v_cvt_pk_bf16_f32 v81, v82, v83
v_mfma_f32_16x16x32_bf16 v[152:155], a[132:135], a[124:127], v[152:155]
s_waitcnt lgkmcnt(4)
v_cvt_pk_bf16_f32 v82, v84, v85
v_cvt_pk_bf16_f32 v83, v86, v87
v_mfma_f32_16x16x32_bf16 v[100:103], a[136:139], a[64:67], v[100:103]
s_waitcnt lgkmcnt(2)
ds_read_b64_tr_b16 a[128:129], v8 offset:32768
v_cvt_pk_bf16_f32 v88, v88, v89
v_mfma_f32_16x16x32_bf16 v[100:103], a[140:143], a[68:71], v[100:103]
v_cvt_pk_bf16_f32 v89, v90, v91
v_cvt_pk_bf16_f32 v90, v92, v93
v_mfma_f32_16x16x32_bf16 v[108:111], a[136:139], a[72:75], v[108:111]
ds_read_b64_tr_b16 a[130:131], v8 offset:34816
v_cvt_pk_bf16_f32 v91, v94, v95
v_mfma_f32_16x16x32_bf16 v[108:111], a[140:143], a[76:79], v[108:111]
v_mfma_f32_16x16x32_bf16 v[116:119], a[136:139], a[80:83], v[116:119]
ds_read_b64_tr_b16 a[132:133], v8 offset:49152
v_mfma_f32_16x16x32_bf16 v[116:119], a[140:143], a[84:87], v[116:119]
v_mfma_f32_16x16x32_bf16 v[124:127], a[136:139], a[88:91], v[124:127]
ds_read_b64_tr_b16 a[134:135], v8 offset:51200
v_cvt_pk_bf16_f32 v96, v96, v97
v_mfma_f32_16x16x32_bf16 v[124:127], a[140:143], a[92:95], v[124:127]
buffer_store_dwordx4 v[40:43], v1, s[4:7], s31 offen sc1
v_mfma_f32_16x16x32_bf16 v[132:135], a[136:139], a[96:99], v[132:135]
s_add_u32 s31, s31, s33
ds_read_b128 a[32:35], v2 offset:8192
v_cvt_pk_bf16_f32 v97, v98, v99
v_mfma_f32_16x16x32_bf16 v[132:135], a[140:143], a[100:103], v[132:135]
v_cvt_pk_bf16_f32 v98, v100, v101
v_cvt_pk_bf16_f32 v99, v102, v103
v_mfma_f32_16x16x32_bf16 v[140:143], a[136:139], a[104:107], v[140:143]
v_cvt_pk_bf16_f32 v104, v104, v105
v_cvt_pk_bf16_f32 v105, v106, v107
v_mfma_f32_16x16x32_bf16 v[140:143], a[140:143], a[108:111], v[140:143]
v_cvt_pk_bf16_f32 v106, v108, v109
v_cvt_pk_bf16_f32 v107, v110, v111
v_mfma_f32_16x16x32_bf16 v[148:151], a[136:139], a[112:115], v[148:151]
ds_read_b128 a[36:39], v3 offset:8192
v_cvt_pk_bf16_f32 v112, v112, v113
v_mfma_f32_16x16x32_bf16 v[148:151], a[140:143], a[116:119], v[148:151]
v_cvt_pk_bf16_f32 v113, v114, v115
v_cvt_pk_bf16_f32 v114, v116, v117
v_mfma_f32_16x16x32_bf16 v[156:159], a[136:139], a[120:123], v[156:159]
ds_read_b128 a[40:43], v2 offset:10240
v_cvt_pk_bf16_f32 v115, v118, v119
v_mfma_f32_16x16x32_bf16 v[156:159], a[140:143], a[124:127], v[156:159]
s_waitcnt lgkmcnt(5)
v_cvt_pk_bf16_f32 v120, v120, v121
v_cvt_pk_bf16_f32 v121, v122, v123
v_mfma_f32_16x16x32_bf16 v[160:163], a[128:131], a[64:67], v[160:163]
s_waitcnt lgkmcnt(3)
ds_read_b64_tr_b16 a[136:137], v9 offset:32768
v_cvt_pk_bf16_f32 v122, v124, v125
v_mfma_f32_16x16x32_bf16 v[160:163], a[132:135], a[68:71], v[160:163]
v_cvt_pk_bf16_f32 v123, v126, v127
v_cvt_pk_bf16_f32 v128, v128, v129
v_mfma_f32_16x16x32_bf16 v[168:171], a[128:131], a[72:75], v[168:171]
ds_read_b64_tr_b16 a[138:139], v9 offset:34816
v_cvt_pk_bf16_f32 v129, v130, v131
v_mfma_f32_16x16x32_bf16 v[168:171], a[132:135], a[76:79], v[168:171]
v_cvt_pk_bf16_f32 v130, v132, v133
v_cvt_pk_bf16_f32 v131, v134, v135
v_mfma_f32_16x16x32_bf16 v[176:179], a[128:131], a[80:83], v[176:179]
ds_read_b64_tr_b16 a[140:141], v9 offset:49152
v_cvt_pk_bf16_f32 v136, v136, v137
v_mfma_f32_16x16x32_bf16 v[176:179], a[132:135], a[84:87], v[176:179]
buffer_store_dwordx4 v[48:51], v1, s[4:7], s31 offen sc1
v_mfma_f32_16x16x32_bf16 v[184:187], a[128:131], a[88:91], v[184:187]
s_add_u32 s31, s31, s32
ds_read_b64_tr_b16 a[142:143], v9 offset:51200
v_cvt_pk_bf16_f32 v137, v138, v139
v_mfma_f32_16x16x32_bf16 v[184:187], a[132:135], a[92:95], v[184:187]
v_cvt_pk_bf16_f32 v138, v140, v141
v_cvt_pk_bf16_f32 v139, v142, v143
v_mfma_f32_16x16x32_bf16 v[192:195], a[128:131], a[96:99], v[192:195]
v_cvt_pk_bf16_f32 v144, v144, v145
v_cvt_pk_bf16_f32 v145, v146, v147
v_mfma_f32_16x16x32_bf16 v[192:195], a[132:135], a[100:103], v[192:195]
v_cvt_pk_bf16_f32 v146, v148, v149
v_cvt_pk_bf16_f32 v147, v150, v151
v_mfma_f32_16x16x32_bf16 v[200:203], a[128:131], a[104:107], v[200:203]
ds_read_b128 a[44:47], v3 offset:10240
v_cvt_pk_bf16_f32 v152, v152, v153
v_mfma_f32_16x16x32_bf16 v[200:203], a[132:135], a[108:111], v[200:203]
v_cvt_pk_bf16_f32 v153, v154, v155
v_cvt_pk_bf16_f32 v154, v156, v157
v_mfma_f32_16x16x32_bf16 v[208:211], a[128:131], a[112:115], v[208:211]
ds_read_b128 a[48:51], v2 offset:12288
v_cvt_pk_bf16_f32 v155, v158, v159
v_mfma_f32_16x16x32_bf16 v[208:211], a[132:135], a[116:119], v[208:211]
v_mfma_f32_16x16x32_bf16 v[216:219], a[128:131], a[120:123], v[216:219]
v_mfma_f32_16x16x32_bf16 v[216:219], a[132:135], a[124:127], v[216:219]
s_waitcnt lgkmcnt(4)
v_mfma_f32_16x16x32_bf16 v[164:167], a[136:139], a[64:67], v[164:167]
s_waitcnt lgkmcnt(2)
ds_read_b64_tr_b16 a[128:129], v10 offset:32768
v_mfma_f32_16x16x32_bf16 v[164:167], a[140:143], a[68:71], v[164:167]
v_mfma_f32_16x16x32_bf16 v[172:175], a[136:139], a[72:75], v[172:175]
ds_read_b64_tr_b16 a[130:131], v10 offset:34816
v_mfma_f32_16x16x32_bf16 v[172:175], a[140:143], a[76:79], v[172:175]
buffer_store_dwordx4 v[56:59], v1, s[4:7], s31 offen sc1
v_mfma_f32_16x16x32_bf16 v[180:183], a[136:139], a[80:83], v[180:183]
s_add_u32 s31, s31, s34
ds_read_b64_tr_b16 a[132:133], v10 offset:49152
v_mfma_f32_16x16x32_bf16 v[180:183], a[140:143], a[84:87], v[180:183]
v_mfma_f32_16x16x32_bf16 v[188:191], a[136:139], a[88:91], v[188:191]
ds_read_b64_tr_b16 a[134:135], v10 offset:51200
v_cvt_pk_bf16_f32 v160, v160, v161
v_mfma_f32_16x16x32_bf16 v[188:191], a[140:143], a[92:95], v[188:191]
v_cvt_pk_bf16_f32 v161, v162, v163
v_cvt_pk_bf16_f32 v162, v164, v165
v_mfma_f32_16x16x32_bf16 v[196:199], a[136:139], a[96:99], v[196:199]
ds_read_b128 a[52:55], v3 offset:12288
v_cvt_pk_bf16_f32 v163, v166, v167
v_mfma_f32_16x16x32_bf16 v[196:199], a[140:143], a[100:103], v[196:199]
v_cvt_pk_bf16_f32 v168, v168, v169
v_cvt_pk_bf16_f32 v169, v170, v171
v_mfma_f32_16x16x32_bf16 v[204:207], a[136:139], a[104:107], v[204:207]
ds_read_b128 a[56:59], v2 offset:14336
v_cvt_pk_bf16_f32 v170, v172, v173
v_mfma_f32_16x16x32_bf16 v[204:207], a[140:143], a[108:111], v[204:207]
v_cvt_pk_bf16_f32 v171, v174, v175
v_cvt_pk_bf16_f32 v176, v176, v177
v_mfma_f32_16x16x32_bf16 v[212:215], a[136:139], a[112:115], v[212:215]
v_cvt_pk_bf16_f32 v177, v178, v179
v_cvt_pk_bf16_f32 v178, v180, v181
v_mfma_f32_16x16x32_bf16 v[212:215], a[140:143], a[116:119], v[212:215]
v_cvt_pk_bf16_f32 v179, v182, v183
v_cvt_pk_bf16_f32 v184, v184, v185
v_mfma_f32_16x16x32_bf16 v[220:223], a[136:139], a[120:123], v[220:223]
ds_read_b128 a[60:63], v3 offset:14336
v_cvt_pk_bf16_f32 v185, v186, v187
v_mfma_f32_16x16x32_bf16 v[220:223], a[140:143], a[124:127], v[220:223]
s_waitcnt lgkmcnt(5)
v_cvt_pk_bf16_f32 v186, v188, v189
v_cvt_pk_bf16_f32 v187, v190, v191
v_mfma_f32_16x16x32_bf16 a[192:195], a[128:131], a[64:67], a[192:195]
s_waitcnt lgkmcnt(3)
ds_read_b64_tr_b16 a[136:137], v11 offset:32768
v_cvt_pk_bf16_f32 v192, v192, v193
v_mfma_f32_16x16x32_bf16 a[192:195], a[132:135], a[68:71], a[192:195]
buffer_store_dwordx4 v[64:67], v1, s[4:7], s31 offen sc1
v_mfma_f32_16x16x32_bf16 a[200:203], a[128:131], a[72:75], a[200:203]
s_add_u32 s31, s31, s32
ds_read_b64_tr_b16 a[138:139], v11 offset:34816
v_cvt_pk_bf16_f32 v193, v194, v195
v_mfma_f32_16x16x32_bf16 a[200:203], a[132:135], a[76:79], a[200:203]
v_cvt_pk_bf16_f32 v194, v196, v197
v_cvt_pk_bf16_f32 v195, v198, v199
v_mfma_f32_16x16x32_bf16 a[208:211], a[128:131], a[80:83], a[208:211]
ds_read_b64_tr_b16 a[140:141], v11 offset:49152
v_cvt_pk_bf16_f32 v200, v200, v201
v_mfma_f32_16x16x32_bf16 a[208:211], a[132:135], a[84:87], a[208:211]
v_cvt_pk_bf16_f32 v201, v202, v203
v_cvt_pk_bf16_f32 v202, v204, v205
v_mfma_f32_16x16x32_bf16 a[216:219], a[128:131], a[88:91], a[216:219]
ds_read_b64_tr_b16 a[142:143], v11 offset:51200
v_cvt_pk_bf16_f32 v203, v206, v207
v_mfma_f32_16x16x32_bf16 a[216:219], a[132:135], a[92:95], a[216:219]
v_cvt_pk_bf16_f32 v208, v208, v209
v_cvt_pk_bf16_f32 v209, v210, v211
v_mfma_f32_16x16x32_bf16 a[224:227], a[128:131], a[96:99], a[224:227]
v_cvt_pk_bf16_f32 v210, v212, v213
v_cvt_pk_bf16_f32 v211, v214, v215
v_mfma_f32_16x16x32_bf16 a[224:227], a[132:135], a[100:103], a[224:227]
v_cvt_pk_bf16_f32 v216, v216, v217
v_cvt_pk_bf16_f32 v217, v218, v219
v_mfma_f32_16x16x32_bf16 a[232:235], a[128:131], a[104:107], a[232:235]
v_cvt_pk_bf16_f32 v218, v220, v221
v_cvt_pk_bf16_f32 v219, v222, v223
v_mfma_f32_16x16x32_bf16 a[232:235], a[132:135], a[108:111], a[232:235]
v_mfma_f32_16x16x32_bf16 a[240:243], a[128:131], a[112:115], a[240:243]
v_mfma_f32_16x16x32_bf16 a[240:243], a[132:135], a[116:119], a[240:243]
v_mfma_f32_16x16x32_bf16 a[248:251], a[128:131], a[120:123], a[248:251]
v_mfma_f32_16x16x32_bf16 a[248:251], a[132:135], a[124:127], a[248:251]
s_waitcnt vmcnt(21) lgkmcnt(0)
s_barrier
v_mfma_f32_16x16x32_bf16 a[196:199], a[136:139], a[64:67], a[196:199]
s_add_u32 m0, s29, 98304
ds_read_b64_tr_b16 a[128:129], v22 offset:0
v_mfma_f32_16x16x32_bf16 a[196:199], a[140:143], a[68:71], a[196:199]
buffer_load_dwordx4 v16, s[12:15], s26 offen offset:0 lds
v_mfma_f32_16x16x32_bf16 a[204:207], a[136:139], a[72:75], a[204:207]
ds_read_b64_tr_b16 a[130:131], v22 offset:2048
v_mfma_f32_16x16x32_bf16 a[204:207], a[140:143], a[76:79], a[204:207]
buffer_store_dwordx4 v[72:75], v1, s[4:7], s31 offen sc1
v_mfma_f32_16x16x32_bf16 a[212:215], a[136:139], a[80:83], a[212:215]
s_add_u32 s31, s31, s33
ds_read_b64_tr_b16 a[132:133], v22 offset:16384
v_mfma_f32_16x16x32_bf16 a[212:215], a[140:143], a[84:87], a[212:215]
buffer_load_dwordx4 v17, s[12:15], s26 offen offset:1024 lds
v_mfma_f32_16x16x32_bf16 a[220:223], a[136:139], a[88:91], a[220:223]
ds_read_b64_tr_b16 a[134:135], v22 offset:18432
v_add_u32 v22, 4294901760, v22
v_mfma_f32_16x16x32_bf16 a[220:223], a[140:143], a[92:95], a[220:223]
v_mfma_f32_16x16x32_bf16 a[228:231], a[136:139], a[96:99], a[228:231]
v_mfma_f32_16x16x32_bf16 a[228:231], a[140:143], a[100:103], a[228:231]
buffer_load_dwordx4 v18, s[12:15], s26 offen offset:2048 lds
v_mfma_f32_16x16x32_bf16 a[236:239], a[136:139], a[104:107], a[236:239]
v_mfma_f32_16x16x32_bf16 a[236:239], a[140:143], a[108:111], a[236:239]
v_mfma_f32_16x16x32_bf16 a[244:247], a[136:139], a[112:115], a[244:247]
v_mfma_f32_16x16x32_bf16 a[244:247], a[140:143], a[116:119], a[244:247]
buffer_load_dwordx4 v19, s[12:15], s26 offen offset:3072 lds
v_mfma_f32_16x16x32_bf16 a[252:255], a[136:139], a[120:123], a[252:255]
s_add_u32 s26, s26, 524288
v_mfma_f32_16x16x32_bf16 a[252:255], a[140:143], a[124:127], a[252:255]
s_waitcnt lgkmcnt(2)
s_branch M_Q
M_V:
s_lshl_b32 s22, s22, 14
s_add_u32 s31, s31, s22
s_add_u32 s31, s31, 16777216
s_mov_b32 s32, 1024
s_mov_b32 s33, 31744
s_mov_b32 s34, 4294935552
s_mov_b32 s35, 4294935552
s_mov_b32 s36, 4294935552
s_mov_b32 s30, 8
s_mov_b32 s82, 3221225472
v_mfma_f32_16x16x32_bf16 v[32:35], a[0:3], a[128:131], 0
s_add_u32 m0, s29, 114688
ds_read_b64_tr_b16 a[136:137], v5 offset:0
v_mfma_f32_16x16x32_bf16 v[32:35], a[4:7], a[132:135], v[32:35]
buffer_load_dwordx4 v16, s[12:15], s27 offen offset:0 nt lds
v_mfma_f32_16x16x32_bf16 v[36:39], a[8:11], a[128:131], 0
ds_read_b64_tr_b16 a[138:139], v5 offset:2048
v_mfma_f32_16x16x32_bf16 v[36:39], a[12:15], a[132:135], v[36:39]
v_mfma_f32_16x16x32_bf16 v[40:43], a[16:19], a[128:131], 0
ds_read_b64_tr_b16 a[140:141], v5 offset:16384
v_mfma_f32_16x16x32_bf16 v[40:43], a[20:23], a[132:135], v[40:43]
buffer_load_dwordx4 v17, s[12:15], s27 offen offset:1024 nt lds
v_mfma_f32_16x16x32_bf16 v[44:47], a[24:27], a[128:131], 0
ds_read_b64_tr_b16 a[142:143], v5 offset:18432
v_mfma_f32_16x16x32_bf16 v[44:47], a[28:31], a[132:135], v[44:47]
v_mfma_f32_16x16x32_bf16 v[48:51], a[32:35], a[128:131], 0
ds_read_b128 a[64:67], v2 offset:32768
v_mfma_f32_16x16x32_bf16 v[48:51], a[36:39], a[132:135], v[48:51]
buffer_load_dwordx4 v18, s[12:15], s27 offen offset:2048 nt lds
v_mfma_f32_16x16x32_bf16 v[52:55], a[40:43], a[128:131], 0
ds_read_b128 a[68:71], v3 offset:32768
v_mfma_f32_16x16x32_bf16 v[52:55], a[44:47], a[132:135], v[52:55]
v_mfma_f32_16x16x32_bf16 v[56:59], a[48:51], a[128:131], 0
v_mfma_f32_16x16x32_bf16 v[56:59], a[52:55], a[132:135], v[56:59]
buffer_load_dwordx4 v19, s[12:15], s27 offen offset:3072 nt lds
v_mfma_f32_16x16x32_bf16 v[60:63], a[56:59], a[128:131], 0
s_add_u32 s27, s27, 524288
ds_read_b128 a[72:75], v2 offset:34816
v_mfma_f32_16x16x32_bf16 v[60:63], a[60:63], a[132:135], v[60:63]
s_waitcnt lgkmcnt(5)
v_mfma_f32_16x16x32_bf16 v[64:67], a[0:3], a[136:139], 0
s_waitcnt lgkmcnt(3)
s_add_u32 m0, s28, 0
ds_read_b64_tr_b16 a[128:129], v6 offset:0
v_mfma_f32_16x16x32_bf16 v[64:67], a[4:7], a[140:143], v[64:67]
buffer_load_dwordx4 v12, s[8:11], s24 offen offset:0 lds
v_mfma_f32_16x16x32_bf16 v[68:71], a[8:11], a[136:139], 0
ds_read_b64_tr_b16 a[130:131], v6 offset:2048
v_mfma_f32_16x16x32_bf16 v[68:71], a[12:15], a[140:143], v[68:71]
v_mfma_f32_16x16x32_bf16 v[72:75], a[16:19], a[136:139], 0
ds_read_b64_tr_b16 a[132:133], v6 offset:16384
v_mfma_f32_16x16x32_bf16 v[72:75], a[20:23], a[140:143], v[72:75]
buffer_load_dwordx4 v13, s[8:11], s24 offen offset:1024 lds
v_mfma_f32_16x16x32_bf16 v[76:79], a[24:27], a[136:139], 0
ds_read_b64_tr_b16 a[134:135], v6 offset:18432
v_mfma_f32_16x16x32_bf16 v[76:79], a[28:31], a[140:143], v[76:79]
v_mfma_f32_16x16x32_bf16 v[80:83], a[32:35], a[136:139], 0
ds_read_b128 a[76:79], v3 offset:34816
v_mfma_f32_16x16x32_bf16 v[80:83], a[36:39], a[140:143], v[80:83]
buffer_load_dwordx4 v14, s[8:11], s24 offen offset:2048 lds
v_mfma_f32_16x16x32_bf16 v[84:87], a[40:43], a[136:139], 0
v_mfma_f32_16x16x32_bf16 v[84:87], a[44:47], a[140:143], v[84:87]
v_mfma_f32_16x16x32_bf16 v[88:91], a[48:51], a[136:139], 0
ds_read_b128 a[80:83], v2 offset:36864
v_mfma_f32_16x16x32_bf16 v[88:91], a[52:55], a[140:143], v[88:91]
buffer_load_dwordx4 v15, s[8:11], s24 offen offset:3072 lds
v_mfma_f32_16x16x32_bf16 v[92:95], a[56:59], a[136:139], 0
s_add_u32 s24, s24, 128
ds_read_b128 a[84:87], v3 offset:36864
v_mfma_f32_16x16x32_bf16 v[92:95], a[60:63], a[140:143], v[92:95]
s_waitcnt lgkmcnt(5)
v_mfma_f32_16x16x32_bf16 v[96:99], a[0:3], a[128:131], 0
s_waitcnt lgkmcnt(3)
s_add_u32 m0, s28, 4096
ds_read_b64_tr_b16 a[136:137], v7 offset:0
v_mfma_f32_16x16x32_bf16 v[96:99], a[4:7], a[132:135], v[96:99]
buffer_load_dwordx4 v12, s[8:11], s25 offen offset:0 lds
v_mfma_f32_16x16x32_bf16 v[100:103], a[8:11], a[128:131], 0
ds_read_b64_tr_b16 a[138:139], v7 offset:2048
v_mfma_f32_16x16x32_bf16 v[100:103], a[12:15], a[132:135], v[100:103]
v_mfma_f32_16x16x32_bf16 v[104:107], a[16:19], a[128:131], 0
ds_read_b64_tr_b16 a[140:141], v7 offset:16384
v_mfma_f32_16x16x32_bf16 v[104:107], a[20:23], a[132:135], v[104:107]
buffer_load_dwordx4 v13, s[8:11], s25 offen offset:1024 lds
v_mfma_f32_16x16x32_bf16 v[108:111], a[24:27], a[128:131], 0
ds_read_b64_tr_b16 a[142:143], v7 offset:18432
v_mfma_f32_16x16x32_bf16 v[108:111], a[28:31], a[132:135], v[108:111]
v_mfma_f32_16x16x32_bf16 v[112:115], a[32:35], a[128:131], 0
v_mfma_f32_16x16x32_bf16 v[112:115], a[36:39], a[132:135], v[112:115]
buffer_load_dwordx4 v14, s[8:11], s25 offen offset:2048 lds
v_mfma_f32_16x16x32_bf16 v[116:119], a[40:43], a[128:131], 0
ds_read_b128 a[88:91], v2 offset:38912
v_mfma_f32_16x16x32_bf16 v[116:119], a[44:47], a[132:135], v[116:119]
v_mfma_f32_16x16x32_bf16 v[120:123], a[48:51], a[128:131], 0
ds_read_b128 a[92:95], v3 offset:38912
v_mfma_f32_16x16x32_bf16 v[120:123], a[52:55], a[132:135], v[120:123]
buffer_load_dwordx4 v15, s[8:11], s25 offen offset:3072 lds
v_mfma_f32_16x16x32_bf16 v[124:127], a[56:59], a[128:131], 0
s_add_u32 s25, s25, 128
v_mfma_f32_16x16x32_bf16 v[124:127], a[60:63], a[132:135], v[124:127]
s_waitcnt lgkmcnt(4)
v_mfma_f32_16x16x32_bf16 v[128:131], a[0:3], a[136:139], 0
s_waitcnt lgkmcnt(2)
s_cmp_eq_u32 s3, 0
ds_read_b64_tr_b16 a[128:129], v8 offset:0
v_mfma_f32_16x16x32_bf16 v[128:131], a[4:7], a[140:143], v[128:131]
s_cselect_b32 s23, s43, 3221225472
buffer_load_dword v21, v20, s[16:19], s23 offen nt
v_mfma_f32_16x16x32_bf16 v[132:135], a[8:11], a[136:139], 0
s_cselect_b32 s23, 3221225472, s43
ds_read_b64_tr_b16 a[130:131], v8 offset:2048
v_mfma_f32_16x16x32_bf16 v[132:135], a[12:15], a[140:143], v[132:135]
buffer_load_dword v21, v20, s[16:19], s23 offen
v_mfma_f32_16x16x32_bf16 v[136:139], a[16:19], a[136:139], 0
s_add_u32 s43, s43, s47
ds_read_b64_tr_b16 a[132:133], v8 offset:16384
v_mfma_f32_16x16x32_bf16 v[136:139], a[20:23], a[140:143], v[136:139]
s_cmp_ge_u32 s43, s51
v_mfma_f32_16x16x32_bf16 v[140:143], a[24:27], a[136:139], 0
s_cselect_b32 s43, 0, s43
ds_read_b64_tr_b16 a[134:135], v8 offset:18432
v_mfma_f32_16x16x32_bf16 v[140:143], a[28:31], a[140:143], v[140:143]
s_cselect_b32 s51, s42, s51
v_mfma_f32_16x16x32_bf16 v[144:147], a[32:35], a[136:139], 0
s_cselect_b64 s[16:17], s[40:41], s[16:17]
ds_read_b128 a[96:99], v2 offset:40960
v_mfma_f32_16x16x32_bf16 v[144:147], a[36:39], a[140:143], v[144:147]
s_cselect_b32 s18, s42, s18
v_mfma_f32_16x16x32_bf16 v[148:151], a[40:43], a[136:139], 0
s_cselect_b64 s[40:41], s[44:45], s[40:41]
v_mfma_f32_16x16x32_bf16 v[148:151], a[44:47], a[140:143], v[148:151]
s_cselect_b32 s42, s46, s42
v_mfma_f32_16x16x32_bf16 v[152:155], a[48:51], a[136:139], 0
s_cselect_b32 s46, 0, s46
ds_read_b128 a[100:103], v3 offset:40960
v_mfma_f32_16x16x32_bf16 v[152:155], a[52:55], a[140:143], v[152:155]
s_cmp_eq_u32 s3, 0
v_mfma_f32_16x16x32_bf16 v[156:159], a[56:59], a[136:139], 0
s_cselect_b32 s23, s43, 3221225472
ds_read_b128 a[104:107], v2 offset:43008
v_mfma_f32_16x16x32_bf16 v[156:159], a[60:63], a[140:143], v[156:159]
s_waitcnt lgkmcnt(5)
buffer_load_dword v21, v20, s[16:19], s23 offen nt
v_mfma_f32_16x16x32_bf16 v[160:163], a[0:3], a[128:131], 0
s_waitcnt lgkmcnt(3)
s_cselect_b32 s23, 3221225472, s43
ds_read_b64_tr_b16 a[136:137], v9 offset:0
v_mfma_f32_16x16x32_bf16 v[160:163], a[4:7], a[132:135], v[160:163]
buffer_load_dword v21, v20, s[16:19], s23 offen
v_mfma_f32_16x16x32_bf16 v[164:167], a[8:11], a[128:131], 0
s_add_u32 s43, s43, s47
ds_read_b64_tr_b16 a[138:139], v9 offset:2048
v_mfma_f32_16x16x32_bf16 v[164:167], a[12:15], a[132:135], v[164:167]
s_cmp_ge_u32 s43, s51
v_mfma_f32_16x16x32_bf16 v[168:171], a[16:19], a[128:131], 0
s_cselect_b32 s43, 0, s43
ds_read_b64_tr_b16 a[140:141], v9 offset:16384
v_mfma_f32_16x16x32_bf16 v[168:171], a[20:23], a[132:135], v[168:171]
s_cselect_b32 s51, s42, s51
v_mfma_f32_16x16x32_bf16 v[172:175], a[24:27], a[128:131], 0
s_cselect_b64 s[16:17], s[40:41], s[16:17]
ds_read_b64_tr_b16 a[142:143], v9 offset:18432
v_mfma_f32_16x16x32_bf16 v[172:175], a[28:31], a[132:135], v[172:175]
s_cselect_b32 s18, s42, s18
v_mfma_f32_16x16x32_bf16 v[176:179], a[32:35], a[128:131], 0
s_cselect_b64 s[40:41], s[44:45], s[40:41]
v_mfma_f32_16x16x32_bf16 v[176:179], a[36:39], a[132:135], v[176:179]
s_cselect_b32 s42, s46, s42
v_mfma_f32_16x16x32_bf16 v[180:183], a[40:43], a[128:131], 0
s_cselect_b32 s46, 0, s46
ds_read_b128 a[108:111], v3 offset:43008
v_mfma_f32_16x16x32_bf16 v[180:183], a[44:47], a[132:135], v[180:183]
v_mfma_f32_16x16x32_bf16 v[184:187], a[48:51], a[128:131], 0
ds_read_b128 a[112:115], v2 offset:45056
v_mfma_f32_16x16x32_bf16 v[184:187], a[52:55], a[132:135], v[184:187]
v_mfma_f32_16x16x32_bf16 v[188:191], a[56:59], a[128:131], 0
v_mfma_f32_16x16x32_bf16 v[188:191], a[60:63], a[132:135], v[188:191]
s_waitcnt lgkmcnt(4)
v_mfma_f32_16x16x32_bf16 v[192:195], a[0:3], a[136:139], 0
s_waitcnt lgkmcnt(2)
ds_read_b64_tr_b16 a[128:129], v10 offset:0
v_mfma_f32_16x16x32_bf16 v[192:195], a[4:7], a[140:143], v[192:195]
v_mfma_f32_16x16x32_bf16 v[196:199], a[8:11], a[136:139], 0
ds_read_b64_tr_b16 a[130:131], v10 offset:2048
v_mfma_f32_16x16x32_bf16 v[196:199], a[12:15], a[140:143], v[196:199]
v_mfma_f32_16x16x32_bf16 v[200:203], a[16:19], a[136:139], 0
ds_read_b64_tr_b16 a[132:133], v10 offset:16384
v_mfma_f32_16x16x32_bf16 v[200:203], a[20:23], a[140:143], v[200:203]
v_mfma_f32_16x16x32_bf16 v[204:207], a[24:27], a[136:139], 0
ds_read_b64_tr_b16 a[134:135], v10 offset:18432
v_mfma_f32_16x16x32_bf16 v[204:207], a[28:31], a[140:143], v[204:207]
v_mfma_f32_16x16x32_bf16 v[208:211], a[32:35], a[136:139], 0
ds_read_b128 a[116:119], v3 offset:45056
v_mfma_f32_16x16x32_bf16 v[208:211], a[36:39], a[140:143], v[208:211]
v_mfma_f32_16x16x32_bf16 v[212:215], a[40:43], a[136:139], 0
ds_read_b128 a[120:123], v2 offset:47104
v_mfma_f32_16x16x32_bf16 v[212:215], a[44:47], a[140:143], v[212:215]
v_mfma_f32_16x16x32_bf16 v[216:219], a[48:51], a[136:139], 0
v_mfma_f32_16x16x32_bf16 v[216:219], a[52:55], a[140:143], v[216:219]
v_mfma_f32_16x16x32_bf16 v[220:223], a[56:59], a[136:139], 0
ds_read_b128 a[124:127], v3 offset:47104
v_mfma_f32_16x16x32_bf16 v[220:223], a[60:63], a[140:143], v[220:223]
s_waitcnt lgkmcnt(5)
v_mfma_f32_16x16x32_bf16 a[192:195], a[0:3], a[128:131], 0
s_waitcnt lgkmcnt(3)
ds_read_b64_tr_b16 a[136:137], v11 offset:0
v_mfma_f32_16x16x32_bf16 a[192:195], a[4:7], a[132:135], a[192:195]
v_mfma_f32_16x16x32_bf16 a[196:199], a[8:11], a[128:131], 0
ds_read_b64_tr_b16 a[138:139], v11 offset:2048
v_mfma_f32_16x16x32_bf16 a[196:199], a[12:15], a[132:135], a[196:199]
v_mfma_f32_16x16x32_bf16 a[200:203], a[16:19], a[128:131], 0
ds_read_b64_tr_b16 a[140:141], v11 offset:16384
v_mfma_f32_16x16x32_bf16 a[200:203], a[20:23], a[132:135], a[200:203]
v_mfma_f32_16x16x32_bf16 a[204:207], a[24:27], a[128:131], 0
ds_read_b64_tr_b16 a[142:143], v11 offset:18432
v_mfma_f32_16x16x32_bf16 a[204:207], a[28:31], a[132:135], a[204:207]
v_mfma_f32_16x16x32_bf16 a[208:211], a[32:35], a[128:131], 0
v_mfma_f32_16x16x32_bf16 a[208:211], a[36:39], a[132:135], a[208:211]
v_mfma_f32_16x16x32_bf16 a[212:215], a[40:43], a[128:131], 0
v_mfma_f32_16x16x32_bf16 a[212:215], a[44:47], a[132:135], a[212:215]
v_mfma_f32_16x16x32_bf16 a[216:219], a[48:51], a[128:131], 0
v_mfma_f32_16x16x32_bf16 a[216:219], a[52:55], a[132:135], a[216:219]
v_mfma_f32_16x16x32_bf16 a[220:223], a[56:59], a[128:131], 0
v_mfma_f32_16x16x32_bf16 a[220:223], a[60:63], a[132:135], a[220:223]
s_waitcnt vmcnt(4) lgkmcnt(0)
s_barrier
v_mfma_f32_16x16x32_bf16 a[224:227], a[0:3], a[136:139], 0
s_add_u32 m0, s29, 65536
ds_read_b64_tr_b16 a[128:129], v4 offset:32768
v_mfma_f32_16x16x32_bf16 a[224:227], a[4:7], a[140:143], a[224:227]
buffer_load_dwordx4 v16, s[12:15], s26 offen offset:0 lds
v_mfma_f32_16x16x32_bf16 a[228:231], a[8:11], a[136:139], 0
ds_read_b64_tr_b16 a[130:131], v4 offset:34816
v_mfma_f32_16x16x32_bf16 a[228:231], a[12:15], a[140:143], a[228:231]
v_mfma_f32_16x16x32_bf16 a[232:235], a[16:19], a[136:139], 0
ds_read_b64_tr_b16 a[132:133], v4 offset:49152
v_mfma_f32_16x16x32_bf16 a[232:235], a[20:23], a[140:143], a[232:235]
buffer_load_dwordx4 v17, s[12:15], s26 offen offset:1024 lds
v_mfma_f32_16x16x32_bf16 a[236:239], a[24:27], a[136:139], 0
ds_read_b64_tr_b16 a[134:135], v4 offset:51200
v_mfma_f32_16x16x32_bf16 a[236:239], a[28:31], a[140:143], a[236:239]
v_mfma_f32_16x16x32_bf16 a[240:243], a[32:35], a[136:139], 0
v_mfma_f32_16x16x32_bf16 a[240:243], a[36:39], a[140:143], a[240:243]
buffer_load_dwordx4 v18, s[12:15], s26 offen offset:2048 lds
v_mfma_f32_16x16x32_bf16 a[244:247], a[40:43], a[136:139], 0
v_mfma_f32_16x16x32_bf16 a[244:247], a[44:47], a[140:143], a[244:247]
v_mfma_f32_16x16x32_bf16 a[248:251], a[48:51], a[136:139], 0
v_mfma_f32_16x16x32_bf16 a[248:251], a[52:55], a[140:143], a[248:251]
buffer_load_dwordx4 v19, s[12:15], s26 offen offset:3072 lds
v_mfma_f32_16x16x32_bf16 a[252:255], a[56:59], a[136:139], 0
s_add_u32 s26, s26, 524288
v_mfma_f32_16x16x32_bf16 a[252:255], a[60:63], a[140:143], a[252:255]
s_waitcnt lgkmcnt(2)
Lg_2:
v_mfma_f32_16x16x32_bf16 v[32:35], a[64:67], a[128:131], v[32:35]
s_waitcnt lgkmcnt(0)
s_add_u32 m0, s29, 81920
ds_read_b64_tr_b16 a[136:137], v5 offset:32768
v_mfma_f32_16x16x32_bf16 v[32:35], a[68:71], a[132:135], v[32:35]
buffer_load_dwordx4 v16, s[12:15], s27 offen offset:0 lds
v_mfma_f32_16x16x32_bf16 v[36:39], a[72:75], a[128:131], v[36:39]
ds_read_b64_tr_b16 a[138:139], v5 offset:34816
v_mfma_f32_16x16x32_bf16 v[36:39], a[76:79], a[132:135], v[36:39]
v_mfma_f32_16x16x32_bf16 v[40:43], a[80:83], a[128:131], v[40:43]
ds_read_b64_tr_b16 a[140:141], v5 offset:49152
v_mfma_f32_16x16x32_bf16 v[40:43], a[84:87], a[132:135], v[40:43]
buffer_load_dwordx4 v17, s[12:15], s27 offen offset:1024 lds
v_mfma_f32_16x16x32_bf16 v[44:47], a[88:91], a[128:131], v[44:47]
ds_read_b64_tr_b16 a[142:143], v5 offset:51200
v_mfma_f32_16x16x32_bf16 v[44:47], a[92:95], a[132:135], v[44:47]
v_mfma_f32_16x16x32_bf16 v[48:51], a[96:99], a[128:131], v[48:51]
ds_read_b128 a[0:3], v2 offset:0
v_mfma_f32_16x16x32_bf16 v[48:51], a[100:103], a[132:135], v[48:51]
buffer_load_dwordx4 v18, s[12:15], s27 offen offset:2048 lds
v_mfma_f32_16x16x32_bf16 v[52:55], a[104:107], a[128:131], v[52:55]
ds_read_b128 a[4:7], v3 offset:0
v_mfma_f32_16x16x32_bf16 v[52:55], a[108:111], a[132:135], v[52:55]
v_mfma_f32_16x16x32_bf16 v[56:59], a[112:115], a[128:131], v[56:59]
v_mfma_f32_16x16x32_bf16 v[56:59], a[116:119], a[132:135], v[56:59]
buffer_load_dwordx4 v19, s[12:15], s27 offen offset:3072 lds
v_mfma_f32_16x16x32_bf16 v[60:63], a[120:123], a[128:131], v[60:63]
s_add_u32 s27, s27, 524288
ds_read_b128 a[8:11], v2 offset:2048
v_mfma_f32_16x16x32_bf16 v[60:63], a[124:127], a[132:135], v[60:63]
s_waitcnt lgkmcnt(5)
v_mfma_f32_16x16x32_bf16 v[64:67], a[64:67], a[136:139], v[64:67]
s_waitcnt lgkmcnt(3)
s_add_u32 m0, s28, 32768
ds_read_b64_tr_b16 a[128:129], v6 offset:32768
v_mfma_f32_16x16x32_bf16 v[64:67], a[68:71], a[140:143], v[64:67]
buffer_load_dwordx4 v12, s[8:11], s24 offen offset:0 lds
v_mfma_f32_16x16x32_bf16 v[68:71], a[72:75], a[136:139], v[68:71]
ds_read_b64_tr_b16 a[130:131], v6 offset:34816
v_mfma_f32_16x16x32_bf16 v[68:71], a[76:79], a[140:143], v[68:71]
v_mfma_f32_16x16x32_bf16 v[72:75], a[80:83], a[136:139], v[72:75]
ds_read_b64_tr_b16 a[132:133], v6 offset:49152
v_mfma_f32_16x16x32_bf16 v[72:75], a[84:87], a[140:143], v[72:75]
buffer_load_dwordx4 v13, s[8:11], s24 offen offset:1024 lds
v_mfma_f32_16x16x32_bf16 v[76:79], a[88:91], a[136:139], v[76:79]
ds_read_b64_tr_b16 a[134:135], v6 offset:51200
v_mfma_f32_16x16x32_bf16 v[76:79], a[92:95], a[140:143], v[76:79]
v_mfma_f32_16x16x32_bf16 v[80:83], a[96:99], a[136:139], v[80:83]
ds_read_b128 a[12:15], v3 offset:2048
v_mfma_f32_16x16x32_bf16 v[80:83], a[100:103], a[140:143], v[80:83]
buffer_load_dwordx4 v14, s[8:11], s24 offen offset:2048 lds
v_mfma_f32_16x16x32_bf16 v[84:87], a[104:107], a[136:139], v[84:87]
v_mfma_f32_16x16x32_bf16 v[84:87], a[108:111], a[140:143], v[84:87]
v_mfma_f32_16x16x32_bf16 v[88:91], a[112:115], a[136:139], v[88:91]
ds_read_b128 a[16:19], v2 offset:4096
v_mfma_f32_16x16x32_bf16 v[88:91], a[116:119], a[140:143], v[88:91]
buffer_load_dwordx4 v15, s[8:11], s24 offen offset:3072 lds
v_mfma_f32_16x16x32_bf16 v[92:95], a[120:123], a[136:139], v[92:95]
s_add_u32 s24, s24, 128
ds_read_b128 a[20:23], v3 offset:4096
v_mfma_f32_16x16x32_bf16 v[92:95], a[124:127], a[140:143], v[92:95]
s_waitcnt lgkmcnt(5)
v_mfma_f32_16x16x32_bf16 v[96:99], a[64:67], a[128:131], v[96:99]
s_waitcnt lgkmcnt(3)
s_add_u32 m0, s28, 36864
ds_read_b64_tr_b16 a[136:137], v7 offset:32768
v_mfma_f32_16x16x32_bf16 v[96:99], a[68:71], a[132:135], v[96:99]
buffer_load_dwordx4 v12, s[8:11], s25 offen offset:0 lds
v_mfma_f32_16x16x32_bf16 v[100:103], a[72:75], a[128:131], v[100:103]
ds_read_b64_tr_b16 a[138:139], v7 offset:34816
v_mfma_f32_16x16x32_bf16 v[100:103], a[76:79], a[132:135], v[100:103]
v_mfma_f32_16x16x32_bf16 v[104:107], a[80:83], a[128:131], v[104:107]
ds_read_b64_tr_b16 a[140:141], v7 offset:49152
v_mfma_f32_16x16x32_bf16 v[104:107], a[84:87], a[132:135], v[104:107]
buffer_load_dwordx4 v13, s[8:11], s25 offen offset:1024 lds
v_mfma_f32_16x16x32_bf16 v[108:111], a[88:91], a[128:131], v[108:111]
ds_read_b64_tr_b16 a[142:143], v7 offset:51200
v_mfma_f32_16x16x32_bf16 v[108:111], a[92:95], a[132:135], v[108:111]
v_mfma_f32_16x16x32_bf16 v[112:115], a[96:99], a[128:131], v[112:115]
v_mfma_f32_16x16x32_bf16 v[112:115], a[100:103], a[132:135], v[112:115]
buffer_load_dwordx4 v14, s[8:11], s25 offen offset:2048 lds
v_mfma_f32_16x16x32_bf16 v[116:119], a[104:107], a[128:131], v[116:119]
ds_read_b128 a[24:27], v2 offset:6144
v_mfma_f32_16x16x32_bf16 v[116:119], a[108:111], a[132:135], v[116:119]
v_mfma_f32_16x16x32_bf16 v[120:123], a[112:115], a[128:131], v[120:123]
ds_read_b128 a[28:31], v3 offset:6144
v_mfma_f32_16x16x32_bf16 v[120:123], a[116:119], a[132:135], v[120:123]
buffer_load_dwordx4 v15, s[8:11], s25 offen offset:3072 lds
v_mfma_f32_16x16x32_bf16 v[124:127], a[120:123], a[128:131], v[124:127]
s_add_u32 s25, s25, 128
v_mfma_f32_16x16x32_bf16 v[124:127], a[124:127], a[132:135], v[124:127]
s_waitcnt lgkmcnt(4)
v_mfma_f32_16x16x32_bf16 v[128:131], a[64:67], a[136:139], v[128:131]
s_waitcnt lgkmcnt(2)
ds_read_b64_tr_b16 a[128:129], v8 offset:32768
v_mfma_f32_16x16x32_bf16 v[128:131], a[68:71], a[140:143], v[128:131]
buffer_load_dword v21, v20, s[16:19], s43 offen
v_mfma_f32_16x16x32_bf16 v[132:135], a[72:75], a[136:139], v[132:135]
s_add_u32 s43, s43, s47
ds_read_b64_tr_b16 a[130:131], v8 offset:34816
v_mfma_f32_16x16x32_bf16 v[132:135], a[76:79], a[140:143], v[132:135]
s_cmp_ge_u32 s43, s51
v_mfma_f32_16x16x32_bf16 v[136:139], a[80:83], a[136:139], v[136:139]
s_cselect_b32 s43, 0, s43
ds_read_b64_tr_b16 a[132:133], v8 offset:49152
v_mfma_f32_16x16x32_bf16 v[136:139], a[84:87], a[140:143], v[136:139]
s_cselect_b32 s51, s42, s51
v_mfma_f32_16x16x32_bf16 v[140:143], a[88:91], a[136:139], v[140:143]
s_cselect_b64 s[16:17], s[40:41], s[16:17]
ds_read_b64_tr_b16 a[134:135], v8 offset:51200
v_mfma_f32_16x16x32_bf16 v[140:143], a[92:95], a[140:143], v[140:143]
s_cselect_b32 s18, s42, s18
v_mfma_f32_16x16x32_bf16 v[144:147], a[96:99], a[136:139], v[144:147]
s_cselect_b64 s[40:41], s[44:45], s[40:41]
ds_read_b128 a[32:35], v2 offset:8192
v_mfma_f32_16x16x32_bf16 v[144:147], a[100:103], a[140:143], v[144:147]
s_cselect_b32 s42, s46, s42
v_mfma_f32_16x16x32_bf16 v[148:151], a[104:107], a[136:139], v[148:151]
s_cselect_b32 s46, 0, s46
v_mfma_f32_16x16x32_bf16 v[148:151], a[108:111], a[140:143], v[148:151]
s_cmp_eq_u32 s30, s55
v_mfma_f32_16x16x32_bf16 v[152:155], a[112:115], a[136:139], v[152:155]
s_cselect_b32 s22, 0, 3221225472
ds_read_b128 a[36:39], v3 offset:8192
v_mfma_f32_16x16x32_bf16 v[152:155], a[116:119], a[140:143], v[152:155]
s_sub_u32 s30, s30, 1
buffer_atomic_add v27, v26, s[60:63], s22 offen sc1
v_mfma_f32_16x16x32_bf16 v[156:159], a[120:123], a[136:139], v[156:159]
ds_read_b128 a[40:43], v2 offset:10240
v_mfma_f32_16x16x32_bf16 v[156:159], a[124:127], a[140:143], v[156:159]
s_waitcnt lgkmcnt(5)
v_mfma_f32_16x16x32_bf16 v[160:163], a[64:67], a[128:131], v[160:163]
s_waitcnt lgkmcnt(3)
ds_read_b64_tr_b16 a[136:137], v9 offset:32768
v_mfma_f32_16x16x32_bf16 v[160:163], a[68:71], a[132:135], v[160:163]
v_mfma_f32_16x16x32_bf16 v[164:167], a[72:75], a[128:131], v[164:167]
ds_read_b64_tr_b16 a[138:139], v9 offset:34816
v_mfma_f32_16x16x32_bf16 v[164:167], a[76:79], a[132:135], v[164:167]
v_mfma_f32_16x16x32_bf16 v[168:171], a[80:83], a[128:131], v[168:171]
ds_read_b64_tr_b16 a[140:141], v9 offset:49152
v_mfma_f32_16x16x32_bf16 v[168:171], a[84:87], a[132:135], v[168:171]
v_mfma_f32_16x16x32_bf16 v[172:175], a[88:91], a[128:131], v[172:175]
ds_read_b64_tr_b16 a[142:143], v9 offset:51200
v_mfma_f32_16x16x32_bf16 v[172:175], a[92:95], a[132:135], v[172:175]
v_mfma_f32_16x16x32_bf16 v[176:179], a[96:99], a[128:131], v[176:179]
v_mfma_f32_16x16x32_bf16 v[176:179], a[100:103], a[132:135], v[176:179]
v_mfma_f32_16x16x32_bf16 v[180:183], a[104:107], a[128:131], v[180:183]
ds_read_b128 a[44:47], v3 offset:10240
v_mfma_f32_16x16x32_bf16 v[180:183], a[108:111], a[132:135], v[180:183]
v_mfma_f32_16x16x32_bf16 v[184:187], a[112:115], a[128:131], v[184:187]
ds_read_b128 a[48:51], v2 offset:12288
v_mfma_f32_16x16x32_bf16 v[184:187], a[116:119], a[132:135], v[184:187]
v_mfma_f32_16x16x32_bf16 v[188:191], a[120:123], a[128:131], v[188:191]
v_mfma_f32_16x16x32_bf16 v[188:191], a[124:127], a[132:135], v[188:191]
s_waitcnt lgkmcnt(4)
v_mfma_f32_16x16x32_bf16 v[192:195], a[64:67], a[136:139], v[192:195]
s_waitcnt lgkmcnt(2)
ds_read_b64_tr_b16 a[128:129], v10 offset:32768
v_mfma_f32_16x16x32_bf16 v[192:195], a[68:71], a[140:143], v[192:195]
v_mfma_f32_16x16x32_bf16 v[196:199], a[72:75], a[136:139], v[196:199]
ds_read_b64_tr_b16 a[130:131], v10 offset:34816
v_mfma_f32_16x16x32_bf16 v[196:199], a[76:79], a[140:143], v[196:199]
v_mfma_f32_16x16x32_bf16 v[200:203], a[80:83], a[136:139], v[200:203]
ds_read_b64_tr_b16 a[132:133], v10 offset:49152
v_mfma_f32_16x16x32_bf16 v[200:203], a[84:87], a[140:143], v[200:203]
v_mfma_f32_16x16x32_bf16 v[204:207], a[88:91], a[136:139], v[204:207]
ds_read_b64_tr_b16 a[134:135], v10 offset:51200
v_mfma_f32_16x16x32_bf16 v[204:207], a[92:95], a[140:143], v[204:207]
v_mfma_f32_16x16x32_bf16 v[208:211], a[96:99], a[136:139], v[208:211]
ds_read_b128 a[52:55], v3 offset:12288
v_mfma_f32_16x16x32_bf16 v[208:211], a[100:103], a[140:143], v[208:211]
v_mfma_f32_16x16x32_bf16 v[212:215], a[104:107], a[136:139], v[212:215]
ds_read_b128 a[56:59], v2 offset:14336
v_mfma_f32_16x16x32_bf16 v[212:215], a[108:111], a[140:143], v[212:215]
v_mfma_f32_16x16x32_bf16 v[216:219], a[112:115], a[136:139], v[216:219]
v_mfma_f32_16x16x32_bf16 v[216:219], a[116:119], a[140:143], v[216:219]
v_mfma_f32_16x16x32_bf16 v[220:223], a[120:123], a[136:139], v[220:223]
ds_read_b128 a[60:63], v3 offset:14336
v_mfma_f32_16x16x32_bf16 v[220:223], a[124:127], a[140:143], v[220:223]
s_waitcnt lgkmcnt(5)
v_mfma_f32_16x16x32_bf16 a[192:195], a[64:67], a[128:131], a[192:195]
s_waitcnt lgkmcnt(3)
ds_read_b64_tr_b16 a[136:137], v11 offset:32768
v_mfma_f32_16x16x32_bf16 a[192:195], a[68:71], a[132:135], a[192:195]
v_mfma_f32_16x16x32_bf16 a[196:199], a[72:75], a[128:131], a[196:199]
ds_read_b64_tr_b16 a[138:139], v11 offset:34816
v_mfma_f32_16x16x32_bf16 a[196:199], a[76:79], a[132:135], a[196:199]
v_mfma_f32_16x16x32_bf16 a[200:203], a[80:83], a[128:131], a[200:203]
ds_read_b64_tr_b16 a[140:141], v11 offset:49152
v_mfma_f32_16x16x32_bf16 a[200:203], a[84:87], a[132:135], a[200:203]
v_mfma_f32_16x16x32_bf16 a[204:207], a[88:91], a[128:131], a[204:207]
ds_read_b64_tr_b16 a[142:143], v11 offset:51200
v_mfma_f32_16x16x32_bf16 a[204:207], a[92:95], a[132:135], a[204:207]
v_mfma_f32_16x16x32_bf16 a[208:211], a[96:99], a[128:131], a[208:211]
v_mfma_f32_16x16x32_bf16 a[208:211], a[100:103], a[132:135], a[208:211]
v_mfma_f32_16x16x32_bf16 a[212:215], a[104:107], a[128:131], a[212:215]
v_mfma_f32_16x16x32_bf16 a[212:215], a[108:111], a[132:135], a[212:215]
v_mfma_f32_16x16x32_bf16 a[216:219], a[112:115], a[128:131], a[216:219]
v_mfma_f32_16x16x32_bf16 a[216:219], a[116:119], a[132:135], a[216:219]
v_mfma_f32_16x16x32_bf16 a[220:223], a[120:123], a[128:131], a[220:223]
v_mfma_f32_16x16x32_bf16 a[220:223], a[124:127], a[132:135], a[220:223]
s_waitcnt vmcnt(2) lgkmcnt(0)
s_barrier
v_mfma_f32_16x16x32_bf16 a[224:227], a[64:67], a[136:139], a[224:227]
s_add_u32 m0, s29, 98304
ds_read_b64_tr_b16 a[128:129], v4 offset:0
v_mfma_f32_16x16x32_bf16 a[224:227], a[68:71], a[140:143], a[224:227]
buffer_load_dwordx4 v16, s[12:15], s26 offen offset:0 lds
v_mfma_f32_16x16x32_bf16 a[228:231], a[72:75], a[136:139], a[228:231]
ds_read_b64_tr_b16 a[130:131], v4 offset:2048
v_mfma_f32_16x16x32_bf16 a[228:231], a[76:79], a[140:143], a[228:231]
v_mfma_f32_16x16x32_bf16 a[232:235], a[80:83], a[136:139], a[232:235]
ds_read_b64_tr_b16 a[132:133], v4 offset:16384
v_mfma_f32_16x16x32_bf16 a[232:235], a[84:87], a[140:143], a[232:235]
buffer_load_dwordx4 v17, s[12:15], s26 offen offset:1024 lds
v_mfma_f32_16x16x32_bf16 a[236:239], a[88:91], a[136:139], a[236:239]
ds_read_b64_tr_b16 a[134:135], v4 offset:18432
v_mfma_f32_16x16x32_bf16 a[236:239], a[92:95], a[140:143], a[236:239]
v_mfma_f32_16x16x32_bf16 a[240:243], a[96:99], a[136:139], a[240:243]
v_mfma_f32_16x16x32_bf16 a[240:243], a[100:103], a[140:143], a[240:243]
buffer_load_dwordx4 v18, s[12:15], s26 offen offset:2048 lds
v_mfma_f32_16x16x32_bf16 a[244:247], a[104:107], a[136:139], a[244:247]
v_mfma_f32_16x16x32_bf16 a[244:247], a[108:111], a[140:143], a[244:247]
v_mfma_f32_16x16x32_bf16 a[248:251], a[112:115], a[136:139], a[248:251]
v_mfma_f32_16x16x32_bf16 a[248:251], a[116:119], a[140:143], a[248:251]
buffer_load_dwordx4 v19, s[12:15], s26 offen offset:3072 lds
v_mfma_f32_16x16x32_bf16 a[252:255], a[120:123], a[136:139], a[252:255]
s_add_u32 s26, s26, 524288
v_mfma_f32_16x16x32_bf16 a[252:255], a[124:127], a[140:143], a[252:255]
s_waitcnt lgkmcnt(2)
buffer_store_dword v27, v26, s[4:7], s82 offen sc1
v_mfma_f32_16x16x32_bf16 v[32:35], a[0:3], a[128:131], v[32:35]
s_waitcnt lgkmcnt(0)
s_add_u32 m0, s29, 114688
ds_read_b64_tr_b16 a[136:137], v5 offset:0
v_mfma_f32_16x16x32_bf16 v[32:35], a[4:7], a[132:135], v[32:35]
buffer_load_dwordx4 v16, s[12:15], s27 offen offset:0 lds
v_mfma_f32_16x16x32_bf16 v[36:39], a[8:11], a[128:131], v[36:39]
ds_read_b64_tr_b16 a[138:139], v5 offset:2048
v_mfma_f32_16x16x32_bf16 v[36:39], a[12:15], a[132:135], v[36:39]
v_mfma_f32_16x16x32_bf16 v[40:43], a[16:19], a[128:131], v[40:43]
ds_read_b64_tr_b16 a[140:141], v5 offset:16384
v_mfma_f32_16x16x32_bf16 v[40:43], a[20:23], a[132:135], v[40:43]
buffer_load_dwordx4 v17, s[12:15], s27 offen offset:1024 lds
v_mfma_f32_16x16x32_bf16 v[44:47], a[24:27], a[128:131], v[44:47]
ds_read_b64_tr_b16 a[142:143], v5 offset:18432
v_mfma_f32_16x16x32_bf16 v[44:47], a[28:31], a[132:135], v[44:47]
v_mfma_f32_16x16x32_bf16 v[48:51], a[32:35], a[128:131], v[48:51]
ds_read_b128 a[64:67], v2 offset:32768
v_mfma_f32_16x16x32_bf16 v[48:51], a[36:39], a[132:135], v[48:51]
buffer_load_dwordx4 v18, s[12:15], s27 offen offset:2048 lds
v_mfma_f32_16x16x32_bf16 v[52:55], a[40:43], a[128:131], v[52:55]
ds_read_b128 a[68:71], v3 offset:32768
v_mfma_f32_16x16x32_bf16 v[52:55], a[44:47], a[132:135], v[52:55]
v_mfma_f32_16x16x32_bf16 v[56:59], a[48:51], a[128:131], v[56:59]
v_mfma_f32_16x16x32_bf16 v[56:59], a[52:55], a[132:135], v[56:59]
buffer_load_dwordx4 v19, s[12:15], s27 offen offset:3072 lds
v_mfma_f32_16x16x32_bf16 v[60:63], a[56:59], a[128:131], v[60:63]
s_add_u32 s27, s27, 524288
ds_read_b128 a[72:75], v2 offset:34816
v_mfma_f32_16x16x32_bf16 v[60:63], a[60:63], a[132:135], v[60:63]
s_waitcnt lgkmcnt(5)
v_mfma_f32_16x16x32_bf16 v[64:67], a[0:3], a[136:139], v[64:67]
s_waitcnt lgkmcnt(3)
s_add_u32 m0, s28, 0
ds_read_b64_tr_b16 a[128:129], v6 offset:0
v_mfma_f32_16x16x32_bf16 v[64:67], a[4:7], a[140:143], v[64:67]
buffer_load_dwordx4 v12, s[8:11], s24 offen offset:0 lds
v_mfma_f32_16x16x32_bf16 v[68:71], a[8:11], a[136:139], v[68:71]
ds_read_b64_tr_b16 a[130:131], v6 offset:2048
v_mfma_f32_16x16x32_bf16 v[68:71], a[12:15], a[140:143], v[68:71]
v_mfma_f32_16x16x32_bf16 v[72:75], a[16:19], a[136:139], v[72:75]
ds_read_b64_tr_b16 a[132:133], v6 offset:16384
v_mfma_f32_16x16x32_bf16 v[72:75], a[20:23], a[140:143], v[72:75]
buffer_load_dwordx4 v13, s[8:11], s24 offen offset:1024 lds
v_mfma_f32_16x16x32_bf16 v[76:79], a[24:27], a[136:139], v[76:79]
ds_read_b64_tr_b16 a[134:135], v6 offset:18432
v_mfma_f32_16x16x32_bf16 v[76:79], a[28:31], a[140:143], v[76:79]
v_mfma_f32_16x16x32_bf16 v[80:83], a[32:35], a[136:139], v[80:83]
ds_read_b128 a[76:79], v3 offset:34816
v_mfma_f32_16x16x32_bf16 v[80:83], a[36:39], a[140:143], v[80:83]
buffer_load_dwordx4 v14, s[8:11], s24 offen offset:2048 lds
v_mfma_f32_16x16x32_bf16 v[84:87], a[40:43], a[136:139], v[84:87]
v_mfma_f32_16x16x32_bf16 v[84:87], a[44:47], a[140:143], v[84:87]
v_mfma_f32_16x16x32_bf16 v[88:91], a[48:51], a[136:139], v[88:91]
ds_read_b128 a[80:83], v2 offset:36864
v_mfma_f32_16x16x32_bf16 v[88:91], a[52:55], a[140:143], v[88:91]
buffer_load_dwordx4 v15, s[8:11], s24 offen offset:3072 lds
v_mfma_f32_16x16x32_bf16 v[92:95], a[56:59], a[136:139], v[92:95]
s_add_u32 s24, s24, 128
ds_read_b128 a[84:87], v3 offset:36864
v_mfma_f32_16x16x32_bf16 v[92:95], a[60:63], a[140:143], v[92:95]
s_waitcnt lgkmcnt(5)
v_mfma_f32_16x16x32_bf16 v[96:99], a[0:3], a[128:131], v[96:99]
s_waitcnt lgkmcnt(3)
s_add_u32 m0, s28, 4096
ds_read_b64_tr_b16 a[136:137], v7 offset:0
v_mfma_f32_16x16x32_bf16 v[96:99], a[4:7], a[132:135], v[96:99]
buffer_load_dwordx4 v12, s[8:11], s25 offen offset:0 lds
v_mfma_f32_16x16x32_bf16 v[100:103], a[8:11], a[128:131], v[100:103]
ds_read_b64_tr_b16 a[138:139], v7 offset:2048
v_mfma_f32_16x16x32_bf16 v[100:103], a[12:15], a[132:135], v[100:103]
v_mfma_f32_16x16x32_bf16 v[104:107], a[16:19], a[128:131], v[104:107]
ds_read_b64_tr_b16 a[140:141], v7 offset:16384
v_mfma_f32_16x16x32_bf16 v[104:107], a[20:23], a[132:135], v[104:107]
buffer_load_dwordx4 v13, s[8:11], s25 offen offset:1024 lds
v_mfma_f32_16x16x32_bf16 v[108:111], a[24:27], a[128:131], v[108:111]
ds_read_b64_tr_b16 a[142:143], v7 offset:18432
v_mfma_f32_16x16x32_bf16 v[108:111], a[28:31], a[132:135], v[108:111]
v_mfma_f32_16x16x32_bf16 v[112:115], a[32:35], a[128:131], v[112:115]
v_mfma_f32_16x16x32_bf16 v[112:115], a[36:39], a[132:135], v[112:115]
buffer_load_dwordx4 v14, s[8:11], s25 offen offset:2048 lds
v_mfma_f32_16x16x32_bf16 v[116:119], a[40:43], a[128:131], v[116:119]
ds_read_b128 a[88:91], v2 offset:38912
v_mfma_f32_16x16x32_bf16 v[116:119], a[44:47], a[132:135], v[116:119]
v_mfma_f32_16x16x32_bf16 v[120:123], a[48:51], a[128:131], v[120:123]
ds_read_b128 a[92:95], v3 offset:38912
v_mfma_f32_16x16x32_bf16 v[120:123], a[52:55], a[132:135], v[120:123]
buffer_load_dwordx4 v15, s[8:11], s25 offen offset:3072 lds
v_mfma_f32_16x16x32_bf16 v[124:127], a[56:59], a[128:131], v[124:127]
s_add_u32 s25, s25, 128
v_mfma_f32_16x16x32_bf16 v[124:127], a[60:63], a[132:135], v[124:127]
s_waitcnt lgkmcnt(4)
v_mfma_f32_16x16x32_bf16 v[128:131], a[0:3], a[136:139], v[128:131]
s_waitcnt lgkmcnt(2)
ds_read_b64_tr_b16 a[128:129], v8 offset:0
v_mfma_f32_16x16x32_bf16 v[128:131], a[4:7], a[140:143], v[128:131]
buffer_load_dword v21, v20, s[16:19], s43 offen
v_mfma_f32_16x16x32_bf16 v[132:135], a[8:11], a[136:139], v[132:135]
s_add_u32 s43, s43, s47
ds_read_b64_tr_b16 a[130:131], v8 offset:2048
v_mfma_f32_16x16x32_bf16 v[132:135], a[12:15], a[140:143], v[132:135]
s_cmp_ge_u32 s43, s51
v_mfma_f32_16x16x32_bf16 v[136:139], a[16:19], a[136:139], v[136:139]
s_cselect_b32 s43, 0, s43
ds_read_b64_tr_b16 a[132:133], v8 offset:16384
v_mfma_f32_16x16x32_bf16 v[136:139], a[20:23], a[140:143], v[136:139]
s_cselect_b32 s51, s42, s51
v_mfma_f32_16x16x32_bf16 v[140:143], a[24:27], a[136:139], v[140:143]
s_cselect_b64 s[16:17], s[40:41], s[16:17]
ds_read_b64_tr_b16 a[134:135], v8 offset:18432
v_mfma_f32_16x16x32_bf16 v[140:143], a[28:31], a[140:143], v[140:143]
s_cselect_b32 s18, s42, s18
v_mfma_f32_16x16x32_bf16 v[144:147], a[32:35], a[136:139], v[144:147]
s_cselect_b64 s[40:41], s[44:45], s[40:41]
ds_read_b128 a[96:99], v2 offset:40960
v_mfma_f32_16x16x32_bf16 v[144:147], a[36:39], a[140:143], v[144:147]
s_cselect_b32 s42, s46, s42
v_mfma_f32_16x16x32_bf16 v[148:151], a[40:43], a[136:139], v[148:151]
s_cselect_b32 s46, 0, s46
v_mfma_f32_16x16x32_bf16 v[148:151], a[44:47], a[140:143], v[148:151]
s_cmp_eq_u32 s30, s55
v_mfma_f32_16x16x32_bf16 v[152:155], a[48:51], a[136:139], v[152:155]
s_cselect_b32 s22, 0, 3221225472
ds_read_b128 a[100:103], v3 offset:40960
v_mfma_f32_16x16x32_bf16 v[152:155], a[52:55], a[140:143], v[152:155]
s_sub_u32 s30, s30, 1
buffer_atomic_add v27, v26, s[60:63], s22 offen sc1
v_mfma_f32_16x16x32_bf16 v[156:159], a[56:59], a[136:139], v[156:159]
ds_read_b128 a[104:107], v2 offset:43008
v_mfma_f32_16x16x32_bf16 v[156:159], a[60:63], a[140:143], v[156:159]
s_waitcnt lgkmcnt(5)
v_mfma_f32_16x16x32_bf16 v[160:163], a[0:3], a[128:131], v[160:163]
s_waitcnt lgkmcnt(3)
ds_read_b64_tr_b16 a[136:137], v9 offset:0
v_mfma_f32_16x16x32_bf16 v[160:163], a[4:7], a[132:135], v[160:163]
v_mfma_f32_16x16x32_bf16 v[164:167], a[8:11], a[128:131], v[164:167]
ds_read_b64_tr_b16 a[138:139], v9 offset:2048
v_mfma_f32_16x16x32_bf16 v[164:167], a[12:15], a[132:135], v[164:167]
v_mfma_f32_16x16x32_bf16 v[168:171], a[16:19], a[128:131], v[168:171]
ds_read_b64_tr_b16 a[140:141], v9 offset:16384
v_mfma_f32_16x16x32_bf16 v[168:171], a[20:23], a[132:135], v[168:171]
v_mfma_f32_16x16x32_bf16 v[172:175], a[24:27], a[128:131], v[172:175]
ds_read_b64_tr_b16 a[142:143], v9 offset:18432
v_mfma_f32_16x16x32_bf16 v[172:175], a[28:31], a[132:135], v[172:175]
v_mfma_f32_16x16x32_bf16 v[176:179], a[32:35], a[128:131], v[176:179]
v_mfma_f32_16x16x32_bf16 v[176:179], a[36:39], a[132:135], v[176:179]
v_mfma_f32_16x16x32_bf16 v[180:183], a[40:43], a[128:131], v[180:183]
ds_read_b128 a[108:111], v3 offset:43008
v_mfma_f32_16x16x32_bf16 v[180:183], a[44:47], a[132:135], v[180:183]
v_mfma_f32_16x16x32_bf16 v[184:187], a[48:51], a[128:131], v[184:187]
ds_read_b128 a[112:115], v2 offset:45056
v_mfma_f32_16x16x32_bf16 v[184:187], a[52:55], a[132:135], v[184:187]
v_mfma_f32_16x16x32_bf16 v[188:191], a[56:59], a[128:131], v[188:191]
v_mfma_f32_16x16x32_bf16 v[188:191], a[60:63], a[132:135], v[188:191]
s_waitcnt lgkmcnt(4)
v_mfma_f32_16x16x32_bf16 v[192:195], a[0:3], a[136:139], v[192:195]
s_waitcnt lgkmcnt(2)
ds_read_b64_tr_b16 a[128:129], v10 offset:0
v_mfma_f32_16x16x32_bf16 v[192:195], a[4:7], a[140:143], v[192:195]
v_mfma_f32_16x16x32_bf16 v[196:199], a[8:11], a[136:139], v[196:199]
ds_read_b64_tr_b16 a[130:131], v10 offset:2048
v_mfma_f32_16x16x32_bf16 v[196:199], a[12:15], a[140:143], v[196:199]
v_mfma_f32_16x16x32_bf16 v[200:203], a[16:19], a[136:139], v[200:203]
ds_read_b64_tr_b16 a[132:133], v10 offset:16384
v_mfma_f32_16x16x32_bf16 v[200:203], a[20:23], a[140:143], v[200:203]
v_mfma_f32_16x16x32_bf16 v[204:207], a[24:27], a[136:139], v[204:207]
ds_read_b64_tr_b16 a[134:135], v10 offset:18432
v_mfma_f32_16x16x32_bf16 v[204:207], a[28:31], a[140:143], v[204:207]
v_mfma_f32_16x16x32_bf16 v[208:211], a[32:35], a[136:139], v[208:211]
ds_read_b128 a[116:119], v3 offset:45056
v_mfma_f32_16x16x32_bf16 v[208:211], a[36:39], a[140:143], v[208:211]
v_mfma_f32_16x16x32_bf16 v[212:215], a[40:43], a[136:139], v[212:215]
ds_read_b128 a[120:123], v2 offset:47104
v_mfma_f32_16x16x32_bf16 v[212:215], a[44:47], a[140:143], v[212:215]
v_mfma_f32_16x16x32_bf16 v[216:219], a[48:51], a[136:139], v[216:219]
v_mfma_f32_16x16x32_bf16 v[216:219], a[52:55], a[140:143], v[216:219]
v_mfma_f32_16x16x32_bf16 v[220:223], a[56:59], a[136:139], v[220:223]
ds_read_b128 a[124:127], v3 offset:47104
v_mfma_f32_16x16x32_bf16 v[220:223], a[60:63], a[140:143], v[220:223]
s_waitcnt lgkmcnt(5)
v_mfma_f32_16x16x32_bf16 a[192:195], a[0:3], a[128:131], a[192:195]
s_waitcnt lgkmcnt(3)
ds_read_b64_tr_b16 a[136:137], v11 offset:0
v_mfma_f32_16x16x32_bf16 a[192:195], a[4:7], a[132:135], a[192:195]
v_mfma_f32_16x16x32_bf16 a[196:199], a[8:11], a[128:131], a[196:199]
ds_read_b64_tr_b16 a[138:139], v11 offset:2048
v_mfma_f32_16x16x32_bf16 a[196:199], a[12:15], a[132:135], a[196:199]
v_mfma_f32_16x16x32_bf16 a[200:203], a[16:19], a[128:131], a[200:203]
ds_read_b64_tr_b16 a[140:141], v11 offset:16384
v_mfma_f32_16x16x32_bf16 a[200:203], a[20:23], a[132:135], a[200:203]
v_mfma_f32_16x16x32_bf16 a[204:207], a[24:27], a[128:131], a[204:207]
ds_read_b64_tr_b16 a[142:143], v11 offset:18432
v_mfma_f32_16x16x32_bf16 a[204:207], a[28:31], a[132:135], a[204:207]
v_mfma_f32_16x16x32_bf16 a[208:211], a[32:35], a[128:131], a[208:211]
v_mfma_f32_16x16x32_bf16 a[208:211], a[36:39], a[132:135], a[208:211]
v_mfma_f32_16x16x32_bf16 a[212:215], a[40:43], a[128:131], a[212:215]
v_mfma_f32_16x16x32_bf16 a[212:215], a[44:47], a[132:135], a[212:215]
v_mfma_f32_16x16x32_bf16 a[216:219], a[48:51], a[128:131], a[216:219]
v_mfma_f32_16x16x32_bf16 a[216:219], a[52:55], a[132:135], a[216:219]
v_mfma_f32_16x16x32_bf16 a[220:223], a[56:59], a[128:131], a[220:223]
v_mfma_f32_16x16x32_bf16 a[220:223], a[60:63], a[132:135], a[220:223]
s_waitcnt vmcnt(2) lgkmcnt(0)
s_barrier
v_mfma_f32_16x16x32_bf16 a[224:227], a[0:3], a[136:139], a[224:227]
s_add_u32 m0, s29, 65536
ds_read_b64_tr_b16 a[128:129], v4 offset:32768
v_mfma_f32_16x16x32_bf16 a[224:227], a[4:7], a[140:143], a[224:227]
buffer_load_dwordx4 v16, s[12:15], s26 offen offset:0 lds
v_mfma_f32_16x16x32_bf16 a[228:231], a[8:11], a[136:139], a[228:231]
ds_read_b64_tr_b16 a[130:131], v4 offset:34816
v_mfma_f32_16x16x32_bf16 a[228:231], a[12:15], a[140:143], a[228:231]
v_mfma_f32_16x16x32_bf16 a[232:235], a[16:19], a[136:139], a[232:235]
ds_read_b64_tr_b16 a[132:133], v4 offset:49152
v_mfma_f32_16x16x32_bf16 a[232:235], a[20:23], a[140:143], a[232:235]
buffer_load_dwordx4 v17, s[12:15], s26 offen offset:1024 lds
v_mfma_f32_16x16x32_bf16 a[236:239], a[24:27], a[136:139], a[236:239]
ds_read_b64_tr_b16 a[134:135], v4 offset:51200
v_mfma_f32_16x16x32_bf16 a[236:239], a[28:31], a[140:143], a[236:239]
v_mfma_f32_16x16x32_bf16 a[240:243], a[32:35], a[136:139], a[240:243]
v_mfma_f32_16x16x32_bf16 a[240:243], a[36:39], a[140:143], a[240:243]
buffer_load_dwordx4 v18, s[12:15], s26 offen offset:2048 lds
v_mfma_f32_16x16x32_bf16 a[244:247], a[40:43], a[136:139], a[244:247]
v_mfma_f32_16x16x32_bf16 a[244:247], a[44:47], a[140:143], a[244:247]
v_mfma_f32_16x16x32_bf16 a[248:251], a[48:51], a[136:139], a[248:251]
v_mfma_f32_16x16x32_bf16 a[248:251], a[52:55], a[140:143], a[248:251]
buffer_load_dwordx4 v19, s[12:15], s26 offen offset:3072 lds
v_mfma_f32_16x16x32_bf16 a[252:255], a[56:59], a[136:139], a[252:255]
s_add_u32 s26, s26, 524288
v_mfma_f32_16x16x32_bf16 a[252:255], a[60:63], a[140:143], a[252:255]
s_waitcnt lgkmcnt(2)
s_bitcmp1_b32 s30, 1
s_cbranch_scc1 Lg_2
s_cmp_eq_u32 s30, 0
s_cbranch_scc1 Lg_2t
v_mfma_f32_16x16x32_bf16 v[32:35], a[64:67], a[128:131], v[32:35]
s_waitcnt lgkmcnt(0)
s_add_u32 m0, s29, 81920
ds_read_b64_tr_b16 a[136:137], v5 offset:32768
v_mfma_f32_16x16x32_bf16 v[32:35], a[68:71], a[132:135], v[32:35]
buffer_load_dwordx4 v16, s[12:15], s27 offen offset:0 lds
v_mfma_f32_16x16x32_bf16 v[36:39], a[72:75], a[128:131], v[36:39]
s_lshl_b32 s22, s38, 3
ds_read_b64_tr_b16 a[138:139], v5 offset:34816
v_mfma_f32_16x16x32_bf16 v[36:39], a[76:79], a[132:135], v[36:39]
s_lshl_b32 s23, s39, 5
v_and_b32 v252, 31, v0
v_lshrrev_b32 v253, 5, v0
v_mfma_f32_16x16x32_bf16 v[40:43], a[80:83], a[128:131], v[40:43]
ds_read_b64_tr_b16 a[140:141], v5 offset:49152
v_add_u32 v253, s22, v253
v_mfma_f32_16x16x32_bf16 v[40:43], a[84:87], a[132:135], v[40:43]
buffer_load_dwordx4 v17, s[12:15], s27 offen offset:1024 lds
v_mfma_f32_16x16x32_bf16 v[44:47], a[88:91], a[128:131], v[44:47]
ds_read_b64_tr_b16 a[142:143], v5 offset:51200
v_add_u32 v252, s23, v252
v_mfma_f32_16x16x32_bf16 v[44:47], a[92:95], a[132:135], v[44:47]
v_mul_u32_u24 v254, 7168, v253
v_lshl_add_u32 v254, v252, 2, v254
v_mfma_f32_16x16x32_bf16 v[48:51], a[96:99], a[128:131], v[48:51]
ds_read_b128 a[0:3], v2 offset:0
v_lshlrev_b32 v252, 4, v252
v_mfma_f32_16x16x32_bf16 v[48:51], a[100:103], a[132:135], v[48:51]
buffer_load_dwordx4 v18, s[12:15], s27 offen offset:2048 lds
v_mfma_f32_16x16x32_bf16 v[52:55], a[104:107], a[128:131], v[52:55]
ds_read_b128 a[4:7], v3 offset:0
v_add_u32 v255, 3584, v254
v_mfma_f32_16x16x32_bf16 v[52:55], a[108:111], a[132:135], v[52:55]
v_subrev_u32 v22, 3584, v254
v_subrev_u32 v23, 2688, v254
v_mfma_f32_16x16x32_bf16 v[56:59], a[112:115], a[128:131], v[56:59]
v_subrev_u32 v24, 1792, v254
v_subrev_u32 v25, 896, v254
v_mfma_f32_16x16x32_bf16 v[56:59], a[116:119], a[132:135], v[56:59]
buffer_load_dwordx4 v19, s[12:15], s27 offen offset:3072 lds
v_mfma_f32_16x16x32_bf16 v[60:63], a[120:123], a[128:131], v[60:63]
s_add_u32 s27, s27, 524288
ds_read_b128 a[8:11], v2 offset:2048
v_mfma_f32_16x16x32_bf16 v[60:63], a[124:127], a[132:135], v[60:63]
s_waitcnt lgkmcnt(5)
v_mfma_f32_16x16x32_bf16 v[64:67], a[64:67], a[136:139], v[64:67]
s_waitcnt lgkmcnt(3)
s_add_u32 m0, s28, 32768
ds_read_b64_tr_b16 a[128:129], v6 offset:32768
v_mfma_f32_16x16x32_bf16 v[64:67], a[68:71], a[140:143], v[64:67]
buffer_load_dwordx4 v12, s[8:11], s24 offen offset:0 lds
v_mfma_f32_16x16x32_bf16 v[68:71], a[72:75], a[136:139], v[68:71]
ds_read_b64_tr_b16 a[130:131], v6 offset:34816
v_mfma_f32_16x16x32_bf16 v[68:71], a[76:79], a[140:143], v[68:71]
v_mfma_f32_16x16x32_bf16 v[72:75], a[80:83], a[136:139], v[72:75]
ds_read_b64_tr_b16 a[132:133], v6 offset:49152
v_mfma_f32_16x16x32_bf16 v[72:75], a[84:87], a[140:143], v[72:75]
buffer_load_dwordx4 v13, s[8:11], s24 offen offset:1024 lds
v_mfma_f32_16x16x32_bf16 v[76:79], a[88:91], a[136:139], v[76:79]
ds_read_b64_tr_b16 a[134:135], v6 offset:51200
v_mfma_f32_16x16x32_bf16 v[76:79], a[92:95], a[140:143], v[76:79]
v_mfma_f32_16x16x32_bf16 v[80:83], a[96:99], a[136:139], v[80:83]
ds_read_b128 a[12:15], v3 offset:2048
v_mfma_f32_16x16x32_bf16 v[80:83], a[100:103], a[140:143], v[80:83]
buffer_load_dwordx4 v14, s[8:11], s24 offen offset:2048 lds
v_mfma_f32_16x16x32_bf16 v[84:87], a[104:107], a[136:139], v[84:87]
v_mfma_f32_16x16x32_bf16 v[84:87], a[108:111], a[140:143], v[84:87]
v_mfma_f32_16x16x32_bf16 v[88:91], a[112:115], a[136:139], v[88:91]
ds_read_b128 a[16:19], v2 offset:4096
v_mfma_f32_16x16x32_bf16 v[88:91], a[116:119], a[140:143], v[88:91]
buffer_load_dwordx4 v15, s[8:11], s24 offen offset:3072 lds
v_mfma_f32_16x16x32_bf16 v[92:95], a[120:123], a[136:139], v[92:95]
s_add_u32 s24, s24, 128
ds_read_b128 a[20:23], v3 offset:4096
v_mfma_f32_16x16x32_bf16 v[92:95], a[124:127], a[140:143], v[92:95]
s_waitcnt lgkmcnt(5)
v_mfma_f32_16x16x32_bf16 v[96:99], a[64:67], a[128:131], v[96:99]
s_waitcnt lgkmcnt(3)
s_add_u32 m0, s28, 36864
ds_read_b64_tr_b16 a[136:137], v7 offset:32768
v_mfma_f32_16x16x32_bf16 v[96:99], a[68:71], a[132:135], v[96:99]
buffer_load_dwordx4 v12, s[8:11], s25 offen offset:0 lds
v_mfma_f32_16x16x32_bf16 v[100:103], a[72:75], a[128:131], v[100:103]
ds_read_b64_tr_b16 a[138:139], v7 offset:34816
v_mfma_f32_16x16x32_bf16 v[100:103], a[76:79], a[132:135], v[100:103]
v_mfma_f32_16x16x32_bf16 v[104:107], a[80:83], a[128:131], v[104:107]
ds_read_b64_tr_b16 a[140:141], v7 offset:49152
v_mfma_f32_16x16x32_bf16 v[104:107], a[84:87], a[132:135], v[104:107]
buffer_load_dwordx4 v13, s[8:11], s25 offen offset:1024 lds
v_mfma_f32_16x16x32_bf16 v[108:111], a[88:91], a[128:131], v[108:111]
ds_read_b64_tr_b16 a[142:143], v7 offset:51200
v_mfma_f32_16x16x32_bf16 v[108:111], a[92:95], a[132:135], v[108:111]
v_mfma_f32_16x16x32_bf16 v[112:115], a[96:99], a[128:131], v[112:115]
v_mfma_f32_16x16x32_bf16 v[112:115], a[100:103], a[132:135], v[112:115]
buffer_load_dwordx4 v14, s[8:11], s25 offen offset:2048 lds
v_mfma_f32_16x16x32_bf16 v[116:119], a[104:107], a[128:131], v[116:119]
ds_read_b128 a[24:27], v2 offset:6144
v_mfma_f32_16x16x32_bf16 v[116:119], a[108:111], a[132:135], v[116:119]
v_mfma_f32_16x16x32_bf16 v[120:123], a[112:115], a[128:131], v[120:123]
ds_read_b128 a[28:31], v3 offset:6144
v_mfma_f32_16x16x32_bf16 v[120:123], a[116:119], a[132:135], v[120:123]
buffer_load_dwordx4 v15, s[8:11], s25 offen offset:3072 lds
v_mfma_f32_16x16x32_bf16 v[124:127], a[120:123], a[128:131], v[124:127]
s_add_u32 s25, s25, 128
v_mfma_f32_16x16x32_bf16 v[124:127], a[124:127], a[132:135], v[124:127]
s_waitcnt lgkmcnt(2)
v_mfma_f32_16x16x32_bf16 v[128:131], a[64:67], a[136:139], v[128:131]
s_mov_b64 s[56:57], s[70:71]
s_mov_b32 s58, 3584
s_mov_b32 s59, 0x20000
ds_read_b64_tr_b16 a[128:129], v8 offset:32768
buffer_load_dwordx4 v[248:251], v252, s[56:59], 0 offen
v_mfma_f32_16x16x32_bf16 v[128:131], a[68:71], a[140:143], v[128:131]
s_mov_b64 s[56:57], s[66:67]
s_mov_b32 s58, 1835008
buffer_load_dword v224, v22, s[56:59], 0 offen nt
v_mfma_f32_16x16x32_bf16 v[132:135], a[72:75], a[136:139], v[132:135]
ds_read_b64_tr_b16 a[130:131], v8 offset:34816
buffer_load_dword v225, v23, s[56:59], 0 offen nt
v_mfma_f32_16x16x32_bf16 v[132:135], a[76:79], a[140:143], v[132:135]
buffer_load_dword v226, v24, s[56:59], 0 offen nt
v_mfma_f32_16x16x32_bf16 v[136:139], a[80:83], a[136:139], v[136:139]
ds_read_b64_tr_b16 a[132:133], v8 offset:49152
buffer_load_dword v227, v25, s[56:59], 0 offen nt
v_mfma_f32_16x16x32_bf16 v[136:139], a[84:87], a[140:143], v[136:139]
buffer_load_dword v228, v254, s[56:59], 0 offen offset:0 nt
v_mfma_f32_16x16x32_bf16 v[140:143], a[88:91], a[136:139], v[140:143]
ds_read_b64_tr_b16 a[134:135], v8 offset:51200
buffer_load_dword v229, v254, s[56:59], 0 offen offset:896 nt
v_mfma_f32_16x16x32_bf16 v[140:143], a[92:95], a[140:143], v[140:143]
buffer_load_dword v230, v254, s[56:59], 0 offen offset:1792 nt
v_mfma_f32_16x16x32_bf16 v[144:147], a[96:99], a[136:139], v[144:147]
ds_read_b128 a[32:35], v2 offset:8192
buffer_load_dword v231, v254, s[56:59], 0 offen offset:2688 nt
v_mfma_f32_16x16x32_bf16 v[144:147], a[100:103], a[140:143], v[144:147]
buffer_load_dword v232, v255, s[56:59], 0 offen offset:0 nt
v_mfma_f32_16x16x32_bf16 v[148:151], a[104:107], a[136:139], v[148:151]
buffer_load_dword v233, v255, s[56:59], 0 offen offset:896 nt
v_mfma_f32_16x16x32_bf16 v[148:151], a[108:111], a[140:143], v[148:151]
buffer_load_dword v234, v255, s[56:59], 0 offen offset:1792 nt
v_mfma_f32_16x16x32_bf16 v[152:155], a[112:115], a[136:139], v[152:155]
ds_read_b128 a[36:39], v3 offset:8192
buffer_load_dword v235, v255, s[56:59], 0 offen offset:2688 nt
v_mfma_f32_16x16x32_bf16 v[152:155], a[116:119], a[140:143], v[152:155]
s_mov_b64 s[56:57], s[68:69]
buffer_load_dword v236, v25, s[56:59], 0 offen nt
v_mfma_f32_16x16x32_bf16 v[156:159], a[120:123], a[136:139], v[156:159]
ds_read_b128 a[40:43], v2 offset:10240
buffer_load_dword v237, v254, s[56:59], 0 offen offset:0 nt
v_mfma_f32_16x16x32_bf16 v[156:159], a[124:127], a[140:143], v[156:159]
s_waitcnt lgkmcnt(5)
buffer_load_dword v238, v254, s[56:59], 0 offen offset:896 nt
v_mfma_f32_16x16x32_bf16 v[160:163], a[64:67], a[128:131], v[160:163]
s_waitcnt lgkmcnt(3)
ds_read_b64_tr_b16 a[136:137], v9 offset:32768
buffer_load_dword v239, v254, s[56:59], 0 offen offset:1792 nt
v_mfma_f32_16x16x32_bf16 v[160:163], a[68:71], a[132:135], v[160:163]
buffer_load_dword v240, v254, s[56:59], 0 offen offset:2688 nt
v_mfma_f32_16x16x32_bf16 v[164:167], a[72:75], a[128:131], v[164:167]
ds_read_b64_tr_b16 a[138:139], v9 offset:34816
buffer_load_dword v241, v255, s[56:59], 0 offen offset:0 nt
v_mfma_f32_16x16x32_bf16 v[164:167], a[76:79], a[132:135], v[164:167]
buffer_load_dword v242, v255, s[56:59], 0 offen offset:896 nt
v_mfma_f32_16x16x32_bf16 v[168:171], a[80:83], a[128:131], v[168:171]
ds_read_b64_tr_b16 a[140:141], v9 offset:49152
buffer_load_dword v243, v255, s[56:59], 0 offen offset:1792 nt
v_mfma_f32_16x16x32_bf16 v[168:171], a[84:87], a[132:135], v[168:171]
buffer_load_dword v244, v255, s[56:59], 0 offen offset:2688 nt
v_mfma_f32_16x16x32_bf16 v[172:175], a[88:91], a[128:131], v[172:175]
ds_read_b64_tr_b16 a[142:143], v9 offset:51200
v_mfma_f32_16x16x32_bf16 v[172:175], a[92:95], a[132:135], v[172:175]
v_mfma_f32_16x16x32_bf16 v[176:179], a[96:99], a[128:131], v[176:179]
v_mfma_f32_16x16x32_bf16 v[176:179], a[100:103], a[132:135], v[176:179]
v_mfma_f32_16x16x32_bf16 v[180:183], a[104:107], a[128:131], v[180:183]
ds_read_b128 a[44:47], v3 offset:10240
v_mfma_f32_16x16x32_bf16 v[180:183], a[108:111], a[132:135], v[180:183]
v_mfma_f32_16x16x32_bf16 v[184:187], a[112:115], a[128:131], v[184:187]
ds_read_b128 a[48:51], v2 offset:12288
v_mfma_f32_16x16x32_bf16 v[184:187], a[116:119], a[132:135], v[184:187]
v_mfma_f32_16x16x32_bf16 v[188:191], a[120:123], a[128:131], v[188:191]
v_mfma_f32_16x16x32_bf16 v[188:191], a[124:127], a[132:135], v[188:191]
s_waitcnt lgkmcnt(4)
v_mfma_f32_16x16x32_bf16 v[192:195], a[64:67], a[136:139], v[192:195]
s_waitcnt lgkmcnt(2)
ds_read_b64_tr_b16 a[128:129], v10 offset:32768
v_mfma_f32_16x16x32_bf16 v[192:195], a[68:71], a[140:143], v[192:195]
v_mfma_f32_16x16x32_bf16 v[196:199], a[72:75], a[136:139], v[196:199]
ds_read_b64_tr_b16 a[130:131], v10 offset:34816
v_mfma_f32_16x16x32_bf16 v[196:199], a[76:79], a[140:143], v[196:199]
v_mfma_f32_16x16x32_bf16 v[200:203], a[80:83], a[136:139], v[200:203]
ds_read_b64_tr_b16 a[132:133], v10 offset:49152
v_mfma_f32_16x16x32_bf16 v[200:203], a[84:87], a[140:143], v[200:203]
v_mfma_f32_16x16x32_bf16 v[204:207], a[88:91], a[136:139], v[204:207]
ds_read_b64_tr_b16 a[134:135], v10 offset:51200
v_mfma_f32_16x16x32_bf16 v[204:207], a[92:95], a[140:143], v[204:207]
v_mfma_f32_16x16x32_bf16 v[208:211], a[96:99], a[136:139], v[208:211]
ds_read_b128 a[52:55], v3 offset:12288
v_mfma_f32_16x16x32_bf16 v[208:211], a[100:103], a[140:143], v[208:211]
v_mfma_f32_16x16x32_bf16 v[212:215], a[104:107], a[136:139], v[212:215]
ds_read_b128 a[56:59], v2 offset:14336
v_mfma_f32_16x16x32_bf16 v[212:215], a[108:111], a[140:143], v[212:215]
v_mfma_f32_16x16x32_bf16 v[216:219], a[112:115], a[136:139], v[216:219]
v_mfma_f32_16x16x32_bf16 v[216:219], a[116:119], a[140:143], v[216:219]
v_mfma_f32_16x16x32_bf16 v[220:223], a[120:123], a[136:139], v[220:223]
ds_read_b128 a[60:63], v3 offset:14336
v_mfma_f32_16x16x32_bf16 v[220:223], a[124:127], a[140:143], v[220:223]
s_waitcnt lgkmcnt(5)
v_mfma_f32_16x16x32_bf16 a[192:195], a[64:67], a[128:131], a[192:195]
s_waitcnt lgkmcnt(3)
ds_read_b64_tr_b16 a[136:137], v11 offset:32768
v_mfma_f32_16x16x32_bf16 a[192:195], a[68:71], a[132:135], a[192:195]
v_mfma_f32_16x16x32_bf16 a[196:199], a[72:75], a[128:131], a[196:199]
ds_read_b64_tr_b16 a[138:139], v11 offset:34816
v_mfma_f32_16x16x32_bf16 a[196:199], a[76:79], a[132:135], a[196:199]
v_mfma_f32_16x16x32_bf16 a[200:203], a[80:83], a[128:131], a[200:203]
ds_read_b64_tr_b16 a[140:141], v11 offset:49152
v_mfma_f32_16x16x32_bf16 a[200:203], a[84:87], a[132:135], a[200:203]
v_mfma_f32_16x16x32_bf16 a[204:207], a[88:91], a[128:131], a[204:207]
ds_read_b64_tr_b16 a[142:143], v11 offset:51200
v_mfma_f32_16x16x32_bf16 a[204:207], a[92:95], a[132:135], a[204:207]
v_mfma_f32_16x16x32_bf16 a[208:211], a[96:99], a[128:131], a[208:211]
v_mfma_f32_16x16x32_bf16 a[208:211], a[100:103], a[132:135], a[208:211]
v_mfma_f32_16x16x32_bf16 a[212:215], a[104:107], a[128:131], a[212:215]
v_mfma_f32_16x16x32_bf16 a[212:215], a[108:111], a[132:135], a[212:215]
v_mfma_f32_16x16x32_bf16 a[216:219], a[112:115], a[128:131], a[216:219]
v_mfma_f32_16x16x32_bf16 a[216:219], a[116:119], a[132:135], a[216:219]
v_mfma_f32_16x16x32_bf16 a[220:223], a[120:123], a[128:131], a[220:223]
v_mfma_f32_16x16x32_bf16 a[220:223], a[124:127], a[132:135], a[220:223]
s_waitcnt vmcnt(22) lgkmcnt(0)
s_barrier
v_mfma_f32_16x16x32_bf16 a[224:227], a[64:67], a[136:139], a[224:227]
s_add_u32 m0, s29, 98304
ds_read_b64_tr_b16 a[128:129], v4 offset:0
v_mfma_f32_16x16x32_bf16 a[224:227], a[68:71], a[140:143], a[224:227]
buffer_load_dwordx4 v16, s[12:15], s26 offen offset:0 lds
v_mfma_f32_16x16x32_bf16 a[228:231], a[72:75], a[136:139], a[228:231]
ds_read_b64_tr_b16 a[130:131], v4 offset:2048
v_mfma_f32_16x16x32_bf16 a[228:231], a[76:79], a[140:143], a[228:231]
v_mfma_f32_16x16x32_bf16 a[232:235], a[80:83], a[136:139], a[232:235]
ds_read_b64_tr_b16 a[132:133], v4 offset:16384
v_mfma_f32_16x16x32_bf16 a[232:235], a[84:87], a[140:143], a[232:235]
buffer_load_dwordx4 v17, s[12:15], s26 offen offset:1024 lds
v_mfma_f32_16x16x32_bf16 a[236:239], a[88:91], a[136:139], a[236:239]
ds_read_b64_tr_b16 a[134:135], v4 offset:18432
v_mfma_f32_16x16x32_bf16 a[236:239], a[92:95], a[140:143], a[236:239]
v_mfma_f32_16x16x32_bf16 a[240:243], a[96:99], a[136:139], a[240:243]
v_mfma_f32_16x16x32_bf16 a[240:243], a[100:103], a[140:143], a[240:243]
buffer_load_dwordx4 v18, s[12:15], s26 offen offset:2048 lds
v_mfma_f32_16x16x32_bf16 a[244:247], a[104:107], a[136:139], a[244:247]
v_mfma_f32_16x16x32_bf16 a[244:247], a[108:111], a[140:143], a[244:247]
v_mfma_f32_16x16x32_bf16 a[248:251], a[112:115], a[136:139], a[248:251]
v_mfma_f32_16x16x32_bf16 a[248:251], a[116:119], a[140:143], a[248:251]
buffer_load_dwordx4 v19, s[12:15], s26 offen offset:3072 lds
v_mfma_f32_16x16x32_bf16 a[252:255], a[120:123], a[136:139], a[252:255]
s_add_u32 s26, s26, 524288
v_mfma_f32_16x16x32_bf16 a[252:255], a[124:127], a[140:143], a[252:255]
s_waitcnt lgkmcnt(2)
v_mfma_f32_16x16x32_bf16 v[32:35], a[0:3], a[128:131], v[32:35]
s_waitcnt lgkmcnt(0)
s_add_u32 m0, s29, 114688
ds_read_b64_tr_b16 a[136:137], v5 offset:0
v_mfma_f32_16x16x32_bf16 v[32:35], a[4:7], a[132:135], v[32:35]
buffer_load_dwordx4 v16, s[12:15], s27 offen offset:0 lds
v_mfma_f32_16x16x32_bf16 v[36:39], a[8:11], a[128:131], v[36:39]
ds_read_b64_tr_b16 a[138:139], v5 offset:2048
v_mfma_f32_16x16x32_bf16 v[36:39], a[12:15], a[132:135], v[36:39]
v_mfma_f32_16x16x32_bf16 v[40:43], a[16:19], a[128:131], v[40:43]
ds_read_b64_tr_b16 a[140:141], v5 offset:16384
v_mfma_f32_16x16x32_bf16 v[40:43], a[20:23], a[132:135], v[40:43]
buffer_load_dwordx4 v17, s[12:15], s27 offen offset:1024 lds
v_mfma_f32_16x16x32_bf16 v[44:47], a[24:27], a[128:131], v[44:47]
ds_read_b64_tr_b16 a[142:143], v5 offset:18432
v_mfma_f32_16x16x32_bf16 v[44:47], a[28:31], a[132:135], v[44:47]
v_mfma_f32_16x16x32_bf16 v[48:51], a[32:35], a[128:131], v[48:51]
ds_read_b128 a[64:67], v2 offset:32768
v_mfma_f32_16x16x32_bf16 v[48:51], a[36:39], a[132:135], v[48:51]
buffer_load_dwordx4 v18, s[12:15], s27 offen offset:2048 lds
v_mfma_f32_16x16x32_bf16 v[52:55], a[40:43], a[128:131], v[52:55]
ds_read_b128 a[68:71], v3 offset:32768
v_mfma_f32_16x16x32_bf16 v[52:55], a[44:47], a[132:135], v[52:55]
v_mfma_f32_16x16x32_bf16 v[56:59], a[48:51], a[128:131], v[56:59]
v_mfma_f32_16x16x32_bf16 v[56:59], a[52:55], a[132:135], v[56:59]
buffer_load_dwordx4 v19, s[12:15], s27 offen offset:3072 lds
v_mfma_f32_16x16x32_bf16 v[60:63], a[56:59], a[128:131], v[60:63]
s_add_u32 s27, s27, 524288
ds_read_b128 a[72:75], v2 offset:34816
v_mfma_f32_16x16x32_bf16 v[60:63], a[60:63], a[132:135], v[60:63]
s_waitcnt lgkmcnt(5)
v_mfma_f32_16x16x32_bf16 v[64:67], a[0:3], a[136:139], v[64:67]
s_waitcnt lgkmcnt(3)
s_add_u32 m0, s28, 0
ds_read_b64_tr_b16 a[128:129], v6 offset:0
v_mfma_f32_16x16x32_bf16 v[64:67], a[4:7], a[140:143], v[64:67]
buffer_load_dwordx4 v12, s[8:11], s24 offen offset:0 lds
v_mfma_f32_16x16x32_bf16 v[68:71], a[8:11], a[136:139], v[68:71]
ds_read_b64_tr_b16 a[130:131], v6 offset:2048
v_mfma_f32_16x16x32_bf16 v[68:71], a[12:15], a[140:143], v[68:71]
v_mfma_f32_16x16x32_bf16 v[72:75], a[16:19], a[136:139], v[72:75]
ds_read_b64_tr_b16 a[132:133], v6 offset:16384
v_mfma_f32_16x16x32_bf16 v[72:75], a[20:23], a[140:143], v[72:75]
buffer_load_dwordx4 v13, s[8:11], s24 offen offset:1024 lds
v_mfma_f32_16x16x32_bf16 v[76:79], a[24:27], a[136:139], v[76:79]
ds_read_b64_tr_b16 a[134:135], v6 offset:18432
v_mfma_f32_16x16x32_bf16 v[76:79], a[28:31], a[140:143], v[76:79]
v_mfma_f32_16x16x32_bf16 v[80:83], a[32:35], a[136:139], v[80:83]
ds_read_b128 a[76:79], v3 offset:34816
v_mfma_f32_16x16x32_bf16 v[80:83], a[36:39], a[140:143], v[80:83]
buffer_load_dwordx4 v14, s[8:11], s24 offen offset:2048 lds
v_mfma_f32_16x16x32_bf16 v[84:87], a[40:43], a[136:139], v[84:87]
v_mfma_f32_16x16x32_bf16 v[84:87], a[44:47], a[140:143], v[84:87]
v_mfma_f32_16x16x32_bf16 v[88:91], a[48:51], a[136:139], v[88:91]
ds_read_b128 a[80:83], v2 offset:36864
v_mfma_f32_16x16x32_bf16 v[88:91], a[52:55], a[140:143], v[88:91]
buffer_load_dwordx4 v15, s[8:11], s24 offen offset:3072 lds
v_mfma_f32_16x16x32_bf16 v[92:95], a[56:59], a[136:139], v[92:95]
s_add_u32 s24, s24, 128
ds_read_b128 a[84:87], v3 offset:36864
v_mfma_f32_16x16x32_bf16 v[92:95], a[60:63], a[140:143], v[92:95]
s_waitcnt lgkmcnt(5)
v_mfma_f32_16x16x32_bf16 v[96:99], a[0:3], a[128:131], v[96:99]
s_waitcnt lgkmcnt(3)
s_add_u32 m0, s28, 4096
ds_read_b64_tr_b16 a[136:137], v7 offset:0
v_mfma_f32_16x16x32_bf16 v[96:99], a[4:7], a[132:135], v[96:99]
buffer_load_dwordx4 v12, s[8:11], s25 offen offset:0 lds
v_mfma_f32_16x16x32_bf16 v[100:103], a[8:11], a[128:131], v[100:103]
ds_read_b64_tr_b16 a[138:139], v7 offset:2048
v_mfma_f32_16x16x32_bf16 v[100:103], a[12:15], a[132:135], v[100:103]
v_mfma_f32_16x16x32_bf16 v[104:107], a[16:19], a[128:131], v[104:107]
ds_read_b64_tr_b16 a[140:141], v7 offset:16384
v_mfma_f32_16x16x32_bf16 v[104:107], a[20:23], a[132:135], v[104:107]
buffer_load_dwordx4 v13, s[8:11], s25 offen offset:1024 lds
v_mfma_f32_16x16x32_bf16 v[108:111], a[24:27], a[128:131], v[108:111]
ds_read_b64_tr_b16 a[142:143], v7 offset:18432
v_mfma_f32_16x16x32_bf16 v[108:111], a[28:31], a[132:135], v[108:111]
v_mfma_f32_16x16x32_bf16 v[112:115], a[32:35], a[128:131], v[112:115]
v_mfma_f32_16x16x32_bf16 v[112:115], a[36:39], a[132:135], v[112:115]
buffer_load_dwordx4 v14, s[8:11], s25 offen offset:2048 lds
v_mfma_f32_16x16x32_bf16 v[116:119], a[40:43], a[128:131], v[116:119]
ds_read_b128 a[88:91], v2 offset:38912
v_mfma_f32_16x16x32_bf16 v[116:119], a[44:47], a[132:135], v[116:119]
v_mfma_f32_16x16x32_bf16 v[120:123], a[48:51], a[128:131], v[120:123]
ds_read_b128 a[92:95], v3 offset:38912
v_mfma_f32_16x16x32_bf16 v[120:123], a[52:55], a[132:135], v[120:123]
buffer_load_dwordx4 v15, s[8:11], s25 offen offset:3072 lds
v_mfma_f32_16x16x32_bf16 v[124:127], a[56:59], a[128:131], v[124:127]
s_add_u32 s25, s25, 128
v_mfma_f32_16x16x32_bf16 v[124:127], a[60:63], a[132:135], v[124:127]
s_waitcnt lgkmcnt(4)
v_mfma_f32_16x16x32_bf16 v[128:131], a[0:3], a[136:139], v[128:131]
s_waitcnt lgkmcnt(2)
ds_read_b64_tr_b16 a[128:129], v8 offset:0
v_mfma_f32_16x16x32_bf16 v[128:131], a[4:7], a[140:143], v[128:131]
buffer_load_dword v21, v20, s[16:19], s43 offen
v_mfma_f32_16x16x32_bf16 v[132:135], a[8:11], a[136:139], v[132:135]
s_add_u32 s43, s43, s47
ds_read_b64_tr_b16 a[130:131], v8 offset:2048
v_mfma_f32_16x16x32_bf16 v[132:135], a[12:15], a[140:143], v[132:135]
s_cmp_ge_u32 s43, s51
v_mfma_f32_16x16x32_bf16 v[136:139], a[16:19], a[136:139], v[136:139]
s_cselect_b32 s43, 0, s43
ds_read_b64_tr_b16 a[132:133], v8 offset:16384
v_mfma_f32_16x16x32_bf16 v[136:139], a[20:23], a[140:143], v[136:139]
s_cselect_b32 s51, s42, s51
v_mfma_f32_16x16x32_bf16 v[140:143], a[24:27], a[136:139], v[140:143]
s_cselect_b64 s[16:17], s[40:41], s[16:17]
ds_read_b64_tr_b16 a[134:135], v8 offset:18432
v_mfma_f32_16x16x32_bf16 v[140:143], a[28:31], a[140:143], v[140:143]
s_cselect_b32 s18, s42, s18
v_mfma_f32_16x16x32_bf16 v[144:147], a[32:35], a[136:139], v[144:147]
s_cselect_b64 s[40:41], s[44:45], s[40:41]
ds_read_b128 a[96:99], v2 offset:40960
v_mfma_f32_16x16x32_bf16 v[144:147], a[36:39], a[140:143], v[144:147]
s_cselect_b32 s42, s46, s42
v_mfma_f32_16x16x32_bf16 v[148:151], a[40:43], a[136:139], v[148:151]
s_cselect_b32 s46, 0, s46
v_mfma_f32_16x16x32_bf16 v[148:151], a[44:47], a[140:143], v[148:151]
s_lshl_b32 s59, s39, 5
v_mfma_f32_16x16x32_bf16 v[152:155], a[48:51], a[136:139], v[152:155]
s_add_u32 s59, s59, s38
ds_read_b128 a[100:103], v3 offset:40960
v_mfma_f32_16x16x32_bf16 v[152:155], a[52:55], a[140:143], v[152:155]
s_lshl_b32 s59, s59, 2
v_mfma_f32_16x16x32_bf16 v[156:159], a[56:59], a[136:139], v[156:159]
s_add_u32 s59, s59, 94392320
ds_read_b128 a[104:107], v2 offset:43008
v_mfma_f32_16x16x32_bf16 v[156:159], a[60:63], a[140:143], v[156:159]
s_waitcnt lgkmcnt(5)
s_cmp_lt_u32 s2, 224
v_mfma_f32_16x16x32_bf16 v[160:163], a[0:3], a[128:131], v[160:163]
s_waitcnt lgkmcnt(3)
s_cselect_b32 s59, s59, 3221225472
ds_read_b64_tr_b16 a[136:137], v9 offset:0
v_mfma_f32_16x16x32_bf16 v[160:163], a[4:7], a[132:135], v[160:163]
buffer_load_dword v21, v20, s[16:19], s43 offen
v_mfma_f32_16x16x32_bf16 v[164:167], a[8:11], a[128:131], v[164:167]
s_add_u32 s43, s43, s47
ds_read_b64_tr_b16 a[138:139], v9 offset:2048
v_mfma_f32_16x16x32_bf16 v[164:167], a[12:15], a[132:135], v[164:167]
s_cmp_ge_u32 s43, s51
v_mfma_f32_16x16x32_bf16 v[168:171], a[16:19], a[128:131], v[168:171]
s_cselect_b32 s43, 0, s43
ds_read_b64_tr_b16 a[140:141], v9 offset:16384
v_mfma_f32_16x16x32_bf16 v[168:171], a[20:23], a[132:135], v[168:171]
s_cselect_b32 s51, s42, s51
v_mfma_f32_16x16x32_bf16 v[172:175], a[24:27], a[128:131], v[172:175]
s_cselect_b64 s[16:17], s[40:41], s[16:17]
ds_read_b64_tr_b16 a[142:143], v9 offset:18432
v_mfma_f32_16x16x32_bf16 v[172:175], a[28:31], a[132:135], v[172:175]
s_cselect_b32 s18, s42, s18
v_mfma_f32_16x16x32_bf16 v[176:179], a[32:35], a[128:131], v[176:179]
s_cselect_b64 s[40:41], s[44:45], s[40:41]
v_mfma_f32_16x16x32_bf16 v[176:179], a[36:39], a[132:135], v[176:179]
s_cselect_b32 s42, s46, s42
v_mfma_f32_16x16x32_bf16 v[180:183], a[40:43], a[128:131], v[180:183]
s_cselect_b32 s46, 0, s46
ds_read_b128 a[108:111], v3 offset:43008
v_mfma_f32_16x16x32_bf16 v[180:183], a[44:47], a[132:135], v[180:183]
v_mfma_f32_16x16x32_bf16 v[184:187], a[48:51], a[128:131], v[184:187]
ds_read_b128 a[112:115], v2 offset:45056
v_mfma_f32_16x16x32_bf16 v[184:187], a[52:55], a[132:135], v[184:187]
v_mfma_f32_16x16x32_bf16 v[188:191], a[56:59], a[128:131], v[188:191]
v_mfma_f32_16x16x32_bf16 v[188:191], a[60:63], a[132:135], v[188:191]
s_waitcnt lgkmcnt(4)
v_mfma_f32_16x16x32_bf16 v[192:195], a[0:3], a[136:139], v[192:195]
s_waitcnt lgkmcnt(2)
ds_read_b64_tr_b16 a[128:129], v10 offset:0
v_mfma_f32_16x16x32_bf16 v[192:195], a[4:7], a[140:143], v[192:195]
v_mfma_f32_16x16x32_bf16 v[196:199], a[8:11], a[136:139], v[196:199]
ds_read_b64_tr_b16 a[130:131], v10 offset:2048
v_mfma_f32_16x16x32_bf16 v[196:199], a[12:15], a[140:143], v[196:199]
v_mfma_f32_16x16x32_bf16 v[200:203], a[16:19], a[136:139], v[200:203]
ds_read_b64_tr_b16 a[132:133], v10 offset:16384
v_mfma_f32_16x16x32_bf16 v[200:203], a[20:23], a[140:143], v[200:203]
v_mfma_f32_16x16x32_bf16 v[204:207], a[24:27], a[136:139], v[204:207]
ds_read_b64_tr_b16 a[134:135], v10 offset:18432
v_mfma_f32_16x16x32_bf16 v[204:207], a[28:31], a[140:143], v[204:207]
v_mfma_f32_16x16x32_bf16 v[208:211], a[32:35], a[136:139], v[208:211]
ds_read_b128 a[116:119], v3 offset:45056
v_mfma_f32_16x16x32_bf16 v[208:211], a[36:39], a[140:143], v[208:211]
v_mfma_f32_16x16x32_bf16 v[212:215], a[40:43], a[136:139], v[212:215]
ds_read_b128 a[120:123], v2 offset:47104
v_mfma_f32_16x16x32_bf16 v[212:215], a[44:47], a[140:143], v[212:215]
v_mfma_f32_16x16x32_bf16 v[216:219], a[48:51], a[136:139], v[216:219]
v_mfma_f32_16x16x32_bf16 v[216:219], a[52:55], a[140:143], v[216:219]
v_mfma_f32_16x16x32_bf16 v[220:223], a[56:59], a[136:139], v[220:223]
ds_read_b128 a[124:127], v3 offset:47104
v_mfma_f32_16x16x32_bf16 v[220:223], a[60:63], a[140:143], v[220:223]
s_waitcnt lgkmcnt(5)
v_mfma_f32_16x16x32_bf16 a[192:195], a[0:3], a[128:131], a[192:195]
s_waitcnt lgkmcnt(3)
ds_read_b64_tr_b16 a[136:137], v11 offset:0
v_mfma_f32_16x16x32_bf16 a[192:195], a[4:7], a[132:135], a[192:195]
v_mfma_f32_16x16x32_bf16 a[196:199], a[8:11], a[128:131], a[196:199]
ds_read_b64_tr_b16 a[138:139], v11 offset:2048
v_mfma_f32_16x16x32_bf16 a[196:199], a[12:15], a[132:135], a[196:199]
v_mfma_f32_16x16x32_bf16 a[200:203], a[16:19], a[128:131], a[200:203]
ds_read_b64_tr_b16 a[140:141], v11 offset:16384
v_and_b32 v252, 31, v0
v_mfma_f32_16x16x32_bf16 a[200:203], a[20:23], a[132:135], a[200:203]
v_lshrrev_b32 v253, 5, v0
v_lshlrev_b32 v252, 8, v252
v_mfma_f32_16x16x32_bf16 a[204:207], a[24:27], a[128:131], a[204:207]
ds_read_b64_tr_b16 a[142:143], v11 offset:18432
v_lshl_add_u32 v252, v253, 4, v252
v_mfma_f32_16x16x32_bf16 a[204:207], a[28:31], a[132:135], a[204:207]
v_add_u32 v252, 147456, v252
v_mfma_f32_16x16x32_bf16 a[208:211], a[32:35], a[128:131], a[208:211]
v_mfma_f32_16x16x32_bf16 a[208:211], a[36:39], a[132:135], a[208:211]
v_mfma_f32_16x16x32_bf16 a[212:215], a[40:43], a[128:131], a[212:215]
v_mfma_f32_16x16x32_bf16 a[212:215], a[44:47], a[132:135], a[212:215]
v_mfma_f32_16x16x32_bf16 a[216:219], a[48:51], a[128:131], a[216:219]
v_mfma_f32_16x16x32_bf16 a[216:219], a[52:55], a[132:135], a[216:219]
v_mfma_f32_16x16x32_bf16 a[220:223], a[56:59], a[128:131], a[220:223]
v_mfma_f32_16x16x32_bf16 a[220:223], a[60:63], a[132:135], a[220:223]
s_waitcnt vmcnt(2) lgkmcnt(0)
s_barrier
v_mfma_f32_16x16x32_bf16 a[224:227], a[0:3], a[136:139], a[224:227]
s_add_u32 m0, s29, 65536
ds_read_b64_tr_b16 a[128:129], v4 offset:32768
v_lshlrev_b32 v28, 16, v248
v_mfma_f32_16x16x32_bf16 a[224:227], a[4:7], a[140:143], a[224:227]
buffer_load_dwordx4 v16, s[12:15], s26 offen offset:0 lds
v_mfma_f32_16x16x32_bf16 a[228:231], a[8:11], a[136:139], a[228:231]
ds_read_b64_tr_b16 a[130:131], v4 offset:34816
v_and_b32 v29, 0xffff0000, v248
v_mfma_f32_16x16x32_bf16 a[228:231], a[12:15], a[140:143], a[228:231]
v_lshlrev_b32 v30, 16, v249
v_and_b32 v253, 0xffff0000, v249
v_mfma_f32_16x16x32_bf16 a[232:235], a[16:19], a[136:139], a[232:235]
ds_read_b64_tr_b16 a[132:133], v4 offset:49152
v_lshlrev_b32 v22, 16, v224
v_mfma_f32_16x16x32_bf16 a[232:235], a[20:23], a[140:143], a[232:235]
buffer_load_dwordx4 v17, s[12:15], s26 offen offset:1024 lds
v_mfma_f32_16x16x32_bf16 a[236:239], a[24:27], a[136:139], a[236:239]
ds_read_b64_tr_b16 a[134:135], v4 offset:51200
v_lshlrev_b32 v23, 16, v225
v_mfma_f32_16x16x32_bf16 a[236:239], a[28:31], a[140:143], a[236:239]
v_lshlrev_b32 v24, 16, v226
v_mul_f32 v254, v22, v253
v_mfma_f32_16x16x32_bf16 a[240:243], a[32:35], a[136:139], a[240:243]
v_lshlrev_b32 v25, 16, v227
v_lshlrev_b32 v247, 16, v236
v_mfma_f32_16x16x32_bf16 a[240:243], a[36:39], a[140:143], a[240:243]
buffer_load_dwordx4 v18, s[12:15], s26 offen offset:2048 lds
v_mfma_f32_16x16x32_bf16 a[244:247], a[40:43], a[136:139], a[244:247]
v_fmac_f32 v254, v23, v30
v_fmac_f32 v254, v24, v29
v_mfma_f32_16x16x32_bf16 a[244:247], a[44:47], a[140:143], a[244:247]
v_fmac_f32 v254, v25, v28
v_mul_f32 v254, v254, v247
v_mfma_f32_16x16x32_bf16 a[248:251], a[48:51], a[136:139], a[248:251]
v_mul_f32 v255, v23, v253
v_lshlrev_b32 v22, 16, v228
v_mfma_f32_16x16x32_bf16 a[248:251], a[52:55], a[140:143], a[248:251]
buffer_load_dwordx4 v19, s[12:15], s26 offen offset:3072 lds
v_mfma_f32_16x16x32_bf16 a[252:255], a[56:59], a[136:139], a[252:255]
s_add_u32 s26, s26, 524288
v_lshlrev_b32 v247, 16, v237
v_fmac_f32 v255, v24, v30
v_mfma_f32_16x16x32_bf16 a[252:255], a[60:63], a[140:143], a[252:255]
s_waitcnt lgkmcnt(0)
v_fmac_f32 v255, v25, v29
v_fmac_f32 v255, v22, v28
v_mfma_f32_16x16x32_bf16 v[32:35], a[64:67], a[128:131], v[32:35]
s_add_u32 m0, s29, 81920
ds_read_b64_tr_b16 a[136:137], v5 offset:32768
v_mul_f32 v255, v255, v247
v_mfma_f32_16x16x32_bf16 v[32:35], a[68:71], a[132:135], v[32:35]
buffer_load_dwordx4 v16, s[12:15], s27 offen offset:0 lds
v_mfma_f32_16x16x32_bf16 v[36:39], a[72:75], a[128:131], v[36:39]
ds_read_b64_tr_b16 a[138:139], v5 offset:34816
v_cvt_pk_bf16_f32 v246, v254, v255
v_mfma_f32_16x16x32_bf16 v[36:39], a[76:79], a[132:135], v[36:39]
v_accvgpr_write_b32 a180, v246
v_mul_f32 v254, v24, v253
v_mfma_f32_16x16x32_bf16 v[40:43], a[80:83], a[128:131], v[40:43]
ds_read_b64_tr_b16 a[140:141], v5 offset:49152
v_lshlrev_b32 v23, 16, v229
v_mfma_f32_16x16x32_bf16 v[40:43], a[84:87], a[132:135], v[40:43]
buffer_load_dwordx4 v17, s[12:15], s27 offen offset:1024 lds
v_lshlrev_b32 v247, 16, v238
v_mfma_f32_16x16x32_bf16 v[44:47], a[88:91], a[128:131], v[44:47]
ds_read_b64_tr_b16 a[142:143], v5 offset:51200
v_fmac_f32 v254, v25, v30
v_mfma_f32_16x16x32_bf16 v[44:47], a[92:95], a[132:135], v[44:47]
v_fmac_f32 v254, v22, v29
v_fmac_f32 v254, v23, v28
v_mfma_f32_16x16x32_bf16 v[48:51], a[96:99], a[128:131], v[48:51]
ds_read_b128 a[0:3], v2 offset:0
v_mul_f32 v254, v254, v247
v_mfma_f32_16x16x32_bf16 v[48:51], a[100:103], a[132:135], v[48:51]
buffer_load_dwordx4 v18, s[12:15], s27 offen offset:2048 lds
v_mfma_f32_16x16x32_bf16 v[52:55], a[104:107], a[128:131], v[52:55]
ds_read_b128 a[4:7], v3 offset:0
v_cvt_pk_bf16_f32 v246, v255, v254
v_accvgpr_write_b32 a176, v246
v_mfma_f32_16x16x32_bf16 v[52:55], a[108:111], a[132:135], v[52:55]
v_mul_f32 v255, v25, v253
v_lshlrev_b32 v24, 16, v230
v_mfma_f32_16x16x32_bf16 v[56:59], a[112:115], a[128:131], v[56:59]
v_lshlrev_b32 v247, 16, v239
v_fmac_f32 v255, v22, v30
v_mfma_f32_16x16x32_bf16 v[56:59], a[116:119], a[132:135], v[56:59]
buffer_load_dwordx4 v19, s[12:15], s27 offen offset:3072 lds
v_mfma_f32_16x16x32_bf16 v[60:63], a[120:123], a[128:131], v[60:63]
s_add_u32 s27, s27, 524288
ds_read_b128 a[8:11], v2 offset:2048
v_fmac_f32 v255, v23, v29
v_mfma_f32_16x16x32_bf16 v[60:63], a[124:127], a[132:135], v[60:63]
s_waitcnt lgkmcnt(3)
v_fmac_f32 v255, v24, v28
v_mul_f32 v255, v255, v247
v_mfma_f32_16x16x32_bf16 v[64:67], a[64:67], a[136:139], v[64:67]
s_add_u32 m0, s28, 32768
ds_read_b64_tr_b16 a[128:129], v6 offset:32768
v_cvt_pk_bf16_f32 v246, v254, v255
v_accvgpr_write_b32 a181, v246
v_mfma_f32_16x16x32_bf16 v[64:67], a[68:71], a[140:143], v[64:67]
buffer_load_dwordx4 v12, s[8:11], s24 offen offset:0 lds
v_mfma_f32_16x16x32_bf16 v[68:71], a[72:75], a[136:139], v[68:71]
ds_read_b64_tr_b16 a[130:131], v6 offset:34816
v_mul_f32 v254, v22, v253
v_mfma_f32_16x16x32_bf16 v[68:71], a[76:79], a[140:143], v[68:71]
v_lshlrev_b32 v25, 16, v231
v_lshlrev_b32 v247, 16, v240
v_mfma_f32_16x16x32_bf16 v[72:75], a[80:83], a[136:139], v[72:75]
ds_read_b64_tr_b16 a[132:133], v6 offset:49152
v_fmac_f32 v254, v23, v30
v_mfma_f32_16x16x32_bf16 v[72:75], a[84:87], a[140:143], v[72:75]
buffer_load_dwordx4 v13, s[8:11], s24 offen offset:1024 lds
v_fmac_f32 v254, v24, v29
v_mfma_f32_16x16x32_bf16 v[76:79], a[88:91], a[136:139], v[76:79]
ds_read_b64_tr_b16 a[134:135], v6 offset:51200
v_fmac_f32 v254, v25, v28
v_mfma_f32_16x16x32_bf16 v[76:79], a[92:95], a[140:143], v[76:79]
v_mul_f32 v254, v254, v247
v_cvt_pk_bf16_f32 v246, v255, v254
v_mfma_f32_16x16x32_bf16 v[80:83], a[96:99], a[136:139], v[80:83]
ds_read_b128 a[12:15], v3 offset:2048
v_accvgpr_write_b32 a177, v246
v_mfma_f32_16x16x32_bf16 v[80:83], a[100:103], a[140:143], v[80:83]
buffer_load_dwordx4 v14, s[8:11], s24 offen offset:2048 lds
v_mfma_f32_16x16x32_bf16 v[84:87], a[104:107], a[136:139], v[84:87]
v_mul_f32 v255, v23, v253
v_lshlrev_b32 v22, 16, v232
v_lshlrev_b32 v247, 16, v241
v_mfma_f32_16x16x32_bf16 v[84:87], a[108:111], a[140:143], v[84:87]
v_fmac_f32 v255, v24, v30
v_fmac_f32 v255, v25, v29
v_mfma_f32_16x16x32_bf16 v[88:91], a[112:115], a[136:139], v[88:91]
ds_read_b128 a[16:19], v2 offset:4096
v_fmac_f32 v255, v22, v28
v_mfma_f32_16x16x32_bf16 v[88:91], a[116:119], a[140:143], v[88:91]
buffer_load_dwordx4 v15, s[8:11], s24 offen offset:3072 lds
v_mfma_f32_16x16x32_bf16 v[92:95], a[120:123], a[136:139], v[92:95]
s_add_u32 s24, s24, 128
ds_read_b128 a[20:23], v3 offset:4096
v_mul_f32 v255, v255, v247
v_mfma_f32_16x16x32_bf16 v[92:95], a[124:127], a[140:143], v[92:95]
s_waitcnt lgkmcnt(3)
v_cvt_pk_bf16_f32 v246, v254, v255
v_accvgpr_write_b32 a182, v246
v_mfma_f32_16x16x32_bf16 v[96:99], a[64:67], a[128:131], v[96:99]
s_add_u32 m0, s28, 36864
ds_read_b64_tr_b16 a[136:137], v7 offset:32768
v_mul_f32 v254, v24, v253
v_lshlrev_b32 v23, 16, v233
v_mfma_f32_16x16x32_bf16 v[96:99], a[68:71], a[132:135], v[96:99]
buffer_load_dwordx4 v12, s[8:11], s25 offen offset:0 lds
v_mfma_f32_16x16x32_bf16 v[100:103], a[72:75], a[128:131], v[100:103]
ds_read_b64_tr_b16 a[138:139], v7 offset:34816
v_lshlrev_b32 v247, 16, v242
v_mfma_f32_16x16x32_bf16 v[100:103], a[76:79], a[132:135], v[100:103]
v_fmac_f32 v254, v25, v30
v_fmac_f32 v254, v22, v29
v_mfma_f32_16x16x32_bf16 v[104:107], a[80:83], a[128:131], v[104:107]
ds_read_b64_tr_b16 a[140:141], v7 offset:49152
v_fmac_f32 v254, v23, v28
v_mfma_f32_16x16x32_bf16 v[104:107], a[84:87], a[132:135], v[104:107]
buffer_load_dwordx4 v13, s[8:11], s25 offen offset:1024 lds
v_mul_f32 v254, v254, v247
v_mfma_f32_16x16x32_bf16 v[108:111], a[88:91], a[128:131], v[108:111]
ds_read_b64_tr_b16 a[142:143], v7 offset:51200
v_cvt_pk_bf16_f32 v246, v255, v254
v_mfma_f32_16x16x32_bf16 v[108:111], a[92:95], a[132:135], v[108:111]
v_accvgpr_write_b32 a178, v246
v_mul_f32 v255, v25, v253
v_mfma_f32_16x16x32_bf16 v[112:115], a[96:99], a[128:131], v[112:115]
v_lshlrev_b32 v24, 16, v234
v_lshlrev_b32 v247, 16, v243
v_mfma_f32_16x16x32_bf16 v[112:115], a[100:103], a[132:135], v[112:115]
buffer_load_dwordx4 v14, s[8:11], s25 offen offset:2048 lds
v_mfma_f32_16x16x32_bf16 v[116:119], a[104:107], a[128:131], v[116:119]
ds_read_b128 a[24:27], v2 offset:6144
v_fmac_f32 v255, v22, v30
v_fmac_f32 v255, v23, v29
v_mfma_f32_16x16x32_bf16 v[116:119], a[108:111], a[132:135], v[116:119]
v_fmac_f32 v255, v24, v28
v_mul_f32 v255, v255, v247
v_mfma_f32_16x16x32_bf16 v[120:123], a[112:115], a[128:131], v[120:123]
ds_read_b128 a[28:31], v3 offset:6144
v_cvt_pk_bf16_f32 v246, v254, v255
v_mfma_f32_16x16x32_bf16 v[120:123], a[116:119], a[132:135], v[120:123]
buffer_load_dwordx4 v15, s[8:11], s25 offen offset:3072 lds
v_mfma_f32_16x16x32_bf16 v[124:127], a[120:123], a[128:131], v[124:127]
s_add_u32 s25, s25, 128
v_accvgpr_write_b32 a183, v246
v_mul_f32 v254, v22, v253
v_mfma_f32_16x16x32_bf16 v[124:127], a[124:127], a[132:135], v[124:127]
s_waitcnt lgkmcnt(4)
v_lshlrev_b32 v25, 16, v235
v_lshlrev_b32 v247, 16, v244
v_mfma_f32_16x16x32_bf16 v[128:131], a[64:67], a[136:139], v[128:131]
s_waitcnt lgkmcnt(2)
ds_read_b64_tr_b16 a[128:129], v8 offset:32768
v_fmac_f32 v254, v23, v30
v_fmac_f32 v254, v24, v29
v_mfma_f32_16x16x32_bf16 v[128:131], a[68:71], a[140:143], v[128:131]
buffer_load_dword v21, v20, s[16:19], s43 offen
v_mfma_f32_16x16x32_bf16 v[132:135], a[72:75], a[136:139], v[132:135]
s_add_u32 s43, s43, s47
ds_read_b64_tr_b16 a[130:131], v8 offset:34816
v_fmac_f32 v254, v25, v28
v_mfma_f32_16x16x32_bf16 v[132:135], a[76:79], a[140:143], v[132:135]
s_cmp_ge_u32 s43, s51
v_mul_f32 v254, v254, v247
v_cvt_pk_bf16_f32 v246, v255, v254
v_mfma_f32_16x16x32_bf16 v[136:139], a[80:83], a[136:139], v[136:139]
s_cselect_b32 s43, 0, s43
ds_read_b64_tr_b16 a[132:133], v8 offset:49152
v_accvgpr_write_b32 a179, v246
v_mfma_f32_16x16x32_bf16 v[136:139], a[84:87], a[140:143], v[136:139]
s_cselect_b32 s51, s42, s51
v_lshlrev_b32 v28, 16, v250
v_and_b32 v29, 0xffff0000, v250
v_lshlrev_b32 v30, 16, v251
v_mfma_f32_16x16x32_bf16 v[140:143], a[88:91], a[136:139], v[140:143]
s_cselect_b64 s[16:17], s[40:41], s[16:17]
ds_read_b64_tr_b16 a[134:135], v8 offset:51200
v_and_b32 v253, 0xffff0000, v251
v_mfma_f32_16x16x32_bf16 v[140:143], a[92:95], a[140:143], v[140:143]
s_cselect_b32 s18, s42, s18
v_and_b32 v22, 0xffff0000, v224
v_and_b32 v23, 0xffff0000, v225
v_mfma_f32_16x16x32_bf16 v[144:147], a[96:99], a[136:139], v[144:147]
s_cselect_b64 s[40:41], s[44:45], s[40:41]
ds_read_b128 a[32:35], v2 offset:8192
v_and_b32 v24, 0xffff0000, v226
v_mfma_f32_16x16x32_bf16 v[144:147], a[100:103], a[140:143], v[144:147]
s_cselect_b32 s42, s46, s42
v_mul_f32 v254, v22, v253
v_and_b32 v25, 0xffff0000, v227
v_mfma_f32_16x16x32_bf16 v[148:151], a[104:107], a[136:139], v[148:151]
s_cselect_b32 s46, 0, s46
v_and_b32 v247, 0xffff0000, v236
v_fmac_f32 v254, v23, v30
v_mfma_f32_16x16x32_bf16 v[148:151], a[108:111], a[140:143], v[148:151]
buffer_load_dword v245, off, s[60:63], 0 sc1
v_fmac_f32 v254, v24, v29
v_mfma_f32_16x16x32_bf16 v[152:155], a[112:115], a[136:139], v[152:155]
ds_read_b128 a[36:39], v3 offset:8192
v_fmac_f32 v254, v25, v28
v_mfma_f32_16x16x32_bf16 v[152:155], a[116:119], a[140:143], v[152:155]
v_mul_f32 v254, v254, v247
v_mul_f32 v255, v23, v253
v_mfma_f32_16x16x32_bf16 v[156:159], a[120:123], a[136:139], v[156:159]
ds_read_b128 a[40:43], v2 offset:10240
v_and_b32 v22, 0xffff0000, v228
v_mfma_f32_16x16x32_bf16 v[156:159], a[124:127], a[140:143], v[156:159]
s_waitcnt lgkmcnt(5)
v_and_b32 v247, 0xffff0000, v237
v_fmac_f32 v255, v24, v30
v_mfma_f32_16x16x32_bf16 v[160:163], a[64:67], a[128:131], v[160:163]
s_waitcnt lgkmcnt(3)
ds_read_b64_tr_b16 a[136:137], v9 offset:32768
v_fmac_f32 v255, v25, v29
v_fmac_f32 v255, v22, v28
v_mfma_f32_16x16x32_bf16 v[160:163], a[68:71], a[132:135], v[160:163]
v_mul_f32 v255, v255, v247
v_cvt_pk_bf16_f32 v246, v254, v255
v_mfma_f32_16x16x32_bf16 v[164:167], a[72:75], a[128:131], v[164:167]
ds_read_b64_tr_b16 a[138:139], v9 offset:34816
v_accvgpr_write_b32 a188, v246
v_mfma_f32_16x16x32_bf16 v[164:167], a[76:79], a[132:135], v[164:167]
v_mul_f32 v254, v24, v253
v_and_b32 v23, 0xffff0000, v229
v_mfma_f32_16x16x32_bf16 v[168:171], a[80:83], a[128:131], v[168:171]
ds_read_b64_tr_b16 a[140:141], v9 offset:49152
v_and_b32 v247, 0xffff0000, v238
v_mfma_f32_16x16x32_bf16 v[168:171], a[84:87], a[132:135], v[168:171]
v_fmac_f32 v254, v25, v30
v_fmac_f32 v254, v22, v29
v_fmac_f32 v254, v23, v28
v_mfma_f32_16x16x32_bf16 v[172:175], a[88:91], a[128:131], v[172:175]
ds_read_b64_tr_b16 a[142:143], v9 offset:51200
v_mul_f32 v254, v254, v247
v_mfma_f32_16x16x32_bf16 v[172:175], a[92:95], a[132:135], v[172:175]
v_cvt_pk_bf16_f32 v246, v255, v254
v_accvgpr_write_b32 a184, v246
v_mfma_f32_16x16x32_bf16 v[176:179], a[96:99], a[128:131], v[176:179]
v_mul_f32 v255, v25, v253
v_and_b32 v24, 0xffff0000, v230
v_mfma_f32_16x16x32_bf16 v[176:179], a[100:103], a[132:135], v[176:179]
v_and_b32 v247, 0xffff0000, v239
v_fmac_f32 v255, v22, v30
v_mfma_f32_16x16x32_bf16 v[180:183], a[104:107], a[128:131], v[180:183]
ds_read_b128 a[44:47], v3 offset:10240
v_fmac_f32 v255, v23, v29
v_mfma_f32_16x16x32_bf16 v[180:183], a[108:111], a[132:135], v[180:183]
v_fmac_f32 v255, v24, v28
v_mul_f32 v255, v255, v247
v_cvt_pk_bf16_f32 v246, v254, v255
v_mfma_f32_16x16x32_bf16 v[184:187], a[112:115], a[128:131], v[184:187]
ds_read_b128 a[48:51], v2 offset:12288
v_accvgpr_write_b32 a189, v246
v_mfma_f32_16x16x32_bf16 v[184:187], a[116:119], a[132:135], v[184:187]
v_mul_f32 v254, v22, v253
v_and_b32 v25, 0xffff0000, v231
v_mfma_f32_16x16x32_bf16 v[188:191], a[120:123], a[128:131], v[188:191]
v_and_b32 v247, 0xffff0000, v240
v_fmac_f32 v254, v23, v30
v_mfma_f32_16x16x32_bf16 v[188:191], a[124:127], a[132:135], v[188:191]
s_waitcnt lgkmcnt(4)
v_fmac_f32 v254, v24, v29
v_fmac_f32 v254, v25, v28
v_mfma_f32_16x16x32_bf16 v[192:195], a[64:67], a[136:139], v[192:195]
s_waitcnt lgkmcnt(2)
ds_read_b64_tr_b16 a[128:129], v10 offset:32768
v_mul_f32 v254, v254, v247
v_cvt_pk_bf16_f32 v246, v255, v254
v_mfma_f32_16x16x32_bf16 v[192:195], a[68:71], a[140:143], v[192:195]
v_accvgpr_write_b32 a185, v246
v_mul_f32 v255, v23, v253
v_mfma_f32_16x16x32_bf16 v[196:199], a[72:75], a[136:139], v[196:199]
ds_read_b64_tr_b16 a[130:131], v10 offset:34816
v_and_b32 v22, 0xffff0000, v232
v_mfma_f32_16x16x32_bf16 v[196:199], a[76:79], a[140:143], v[196:199]
v_and_b32 v247, 0xffff0000, v241
v_fmac_f32 v255, v24, v30
v_mfma_f32_16x16x32_bf16 v[200:203], a[80:83], a[136:139], v[200:203]
s_lshr_b32 s22, s3, 1
ds_read_b64_tr_b16 a[132:133], v10 offset:49152
v_fmac_f32 v255, v25, v29
v_mfma_f32_16x16x32_bf16 v[200:203], a[84:87], a[140:143], v[200:203]
s_mul_i32 s22, s22, 2097152
v_fmac_f32 v255, v22, v28
v_mul_f32 v255, v255, v247
v_cvt_pk_bf16_f32 v246, v254, v255
v_mfma_f32_16x16x32_bf16 v[204:207], a[88:91], a[136:139], v[204:207]
s_and_b32 s23, s3, 1
ds_read_b64_tr_b16 a[134:135], v10 offset:51200
v_accvgpr_write_b32 a190, v246
v_mfma_f32_16x16x32_bf16 v[204:207], a[92:95], a[140:143], v[204:207]
s_lshl_b32 s23, s23, 5
v_mul_f32 v254, v24, v253
v_and_b32 v23, 0xffff0000, v233
v_mfma_f32_16x16x32_bf16 v[208:211], a[96:99], a[136:139], v[208:211]
s_lshl_b32 s56, s39, 6
ds_read_b128 a[52:55], v3 offset:12288
v_and_b32 v247, 0xffff0000, v242
v_mfma_f32_16x16x32_bf16 v[208:211], a[100:103], a[140:143], v[208:211]
s_add_u32 s23, s23, s56
v_fmac_f32 v254, v25, v30
v_fmac_f32 v254, v22, v29
v_mfma_f32_16x16x32_bf16 v[212:215], a[104:107], a[136:139], v[212:215]
s_mul_i32 s23, s23, 4224
ds_read_b128 a[56:59], v2 offset:14336
v_fmac_f32 v254, v23, v28
v_mfma_f32_16x16x32_bf16 v[212:215], a[108:111], a[140:143], v[212:215]
s_add_u32 s22, s22, s23
v_mul_f32 v254, v254, v247
v_cvt_pk_bf16_f32 v246, v255, v254
v_accvgpr_write_b32 a186, v246
v_mfma_f32_16x16x32_bf16 v[216:219], a[112:115], a[136:139], v[216:219]
s_add_u32 s57, s22, 83886200
v_mul_f32 v255, v25, v253
v_and_b32 v24, 0xffff0000, v234
v_mfma_f32_16x16x32_bf16 v[216:219], a[116:119], a[140:143], v[216:219]
s_lshl_b32 s23, s38, 7
v_and_b32 v247, 0xffff0000, v243
v_fmac_f32 v255, v22, v30
v_mfma_f32_16x16x32_bf16 v[220:223], a[120:123], a[136:139], v[220:223]
s_add_u32 s22, s22, s23
ds_read_b128 a[60:63], v3 offset:14336
v_fmac_f32 v255, v23, v29
v_mfma_f32_16x16x32_bf16 v[220:223], a[124:127], a[140:143], v[220:223]
s_waitcnt lgkmcnt(3)
s_add_u32 s56, s22, 83886208
v_fmac_f32 v255, v24, v28
v_mul_f32 v255, v255, v247
v_mfma_f32_16x16x32_bf16 a[192:195], a[64:67], a[128:131], a[192:195]
s_cmp_lt_u32 s2, 224
ds_read_b64_tr_b16 a[136:137], v11 offset:32768
v_cvt_pk_bf16_f32 v246, v254, v255
v_accvgpr_write_b32 a191, v246
v_mfma_f32_16x16x32_bf16 a[192:195], a[68:71], a[132:135], a[192:195]
s_cselect_b32 s56, s56, 3221225472
v_mul_f32 v254, v22, v253
v_and_b32 v25, 0xffff0000, v235
v_mfma_f32_16x16x32_bf16 a[196:199], a[72:75], a[128:131], a[196:199]
s_cmp_eq_u32 s38, 0
ds_read_b64_tr_b16 a[138:139], v11 offset:34816
v_and_b32 v247, 0xffff0000, v244
v_mfma_f32_16x16x32_bf16 a[196:199], a[76:79], a[132:135], a[196:199]
s_cselect_b32 s57, s57, 3221225472
v_fmac_f32 v254, v23, v30
v_fmac_f32 v254, v24, v29
v_mfma_f32_16x16x32_bf16 a[200:203], a[80:83], a[128:131], a[200:203]
ds_read_b64_tr_b16 a[140:141], v11 offset:49152
v_fmac_f32 v254, v25, v28
v_mfma_f32_16x16x32_bf16 a[200:203], a[84:87], a[132:135], a[200:203]
v_mul_f32 v254, v254, v247
v_cvt_pk_bf16_f32 v246, v255, v254
v_accvgpr_write_b32 a187, v246
v_mfma_f32_16x16x32_bf16 a[204:207], a[88:91], a[128:131], a[204:207]
ds_read_b64_tr_b16 a[142:143], v11 offset:51200
v_mfma_f32_16x16x32_bf16 a[204:207], a[92:95], a[132:135], a[204:207]
ds_write_b128 v252, a[176:179] offset:0
v_mfma_f32_16x16x32_bf16 a[208:211], a[96:99], a[128:131], a[208:211]
v_mfma_f32_16x16x32_bf16 a[208:211], a[100:103], a[132:135], a[208:211]
ds_write_b128 v252, a[180:183] offset:8192
v_mfma_f32_16x16x32_bf16 a[212:215], a[104:107], a[128:131], a[212:215]
v_mfma_f32_16x16x32_bf16 a[212:215], a[108:111], a[132:135], a[212:215]
ds_write_b128 v252, a[184:187] offset:128
v_mfma_f32_16x16x32_bf16 a[216:219], a[112:115], a[128:131], a[216:219]
v_mfma_f32_16x16x32_bf16 a[216:219], a[116:119], a[132:135], a[216:219]
ds_write_b128 v252, a[188:191] offset:8320
v_mfma_f32_16x16x32_bf16 a[220:223], a[120:123], a[128:131], a[220:223]
v_mfma_f32_16x16x32_bf16 a[220:223], a[124:127], a[132:135], a[220:223]
s_waitcnt vmcnt(2) lgkmcnt(0)
s_barrier
v_mfma_f32_16x16x32_bf16 a[224:227], a[64:67], a[136:139], a[224:227]
s_add_u32 m0, s29, 98304
ds_read_b64_tr_b16 a[128:129], v4 offset:0
v_add_u32 v22, s29, v1
v_mfma_f32_16x16x32_bf16 a[224:227], a[68:71], a[140:143], a[224:227]
buffer_load_dwordx4 v16, s[12:15], s26 offen offset:0 lds
v_mfma_f32_16x16x32_bf16 a[228:231], a[72:75], a[136:139], a[228:231]
ds_read_b64_tr_b16 a[130:131], v4 offset:2048
v_add_u32 v22, 147456, v22
v_mfma_f32_16x16x32_bf16 a[228:231], a[76:79], a[140:143], a[228:231]
v_lshrrev_b32 v224, 7, v1
v_mul_u32_u24 v224, 4224, v224
v_mfma_f32_16x16x32_bf16 a[232:235], a[80:83], a[136:139], a[232:235]
ds_read_b64_tr_b16 a[132:133], v4 offset:16384
v_and_b32 v225, 0x70, v1
v_mfma_f32_16x16x32_bf16 a[232:235], a[84:87], a[140:143], a[232:235]
buffer_load_dwordx4 v17, s[12:15], s26 offen offset:1024 lds
v_mfma_f32_16x16x32_bf16 a[236:239], a[88:91], a[136:139], a[236:239]
ds_read_b64_tr_b16 a[134:135], v4 offset:18432
v_add_u32 v224, v224, v225
v_mfma_f32_16x16x32_bf16 a[236:239], a[92:95], a[140:143], a[236:239]
v_bfe_u32 v225, v1, 4, 5
v_mul_u32_u24 v225, 4224, v225
v_mfma_f32_16x16x32_bf16 a[240:243], a[96:99], a[136:139], a[240:243]
v_mov_b32 v226, 0
v_mov_b32 v227, 0
v_mfma_f32_16x16x32_bf16 a[240:243], a[100:103], a[140:143], a[240:243]
buffer_load_dwordx4 v18, s[12:15], s26 offen offset:2048 lds
v_mfma_f32_16x16x32_bf16 a[244:247], a[104:107], a[136:139], a[244:247]
v_mfma_f32_16x16x32_bf16 a[244:247], a[108:111], a[140:143], a[244:247]
v_mfma_f32_16x16x32_bf16 a[248:251], a[112:115], a[136:139], a[248:251]
v_mfma_f32_16x16x32_bf16 a[248:251], a[116:119], a[140:143], a[248:251]
buffer_load_dwordx4 v19, s[12:15], s26 offen offset:3072 lds
v_mfma_f32_16x16x32_bf16 a[252:255], a[120:123], a[136:139], a[252:255]
s_add_u32 s26, s26, 524288
v_mfma_f32_16x16x32_bf16 a[252:255], a[124:127], a[140:143], a[252:255]
s_waitcnt lgkmcnt(2)
v_mfma_f32_16x16x32_bf16 v[32:35], a[0:3], a[128:131], v[32:35]
s_waitcnt lgkmcnt(0)
s_add_u32 m0, s29, 114688
ds_read_b64_tr_b16 a[136:137], v5 offset:0
v_mfma_f32_16x16x32_bf16 v[32:35], a[4:7], a[132:135], v[32:35]
buffer_load_dwordx4 v16, s[12:15], s27 offen offset:0 lds
v_mfma_f32_16x16x32_bf16 v[36:39], a[8:11], a[128:131], v[36:39]
s_mul_i32 s52, s20, 7
ds_read_b64_tr_b16 a[138:139], v5 offset:2048
v_mfma_f32_16x16x32_bf16 v[36:39], a[12:15], a[132:135], v[36:39]
s_add_u32 s52, s52, s21
buffer_store_dwordx2 v[226:227], v225, s[4:7], s57 offen sc1
v_mfma_f32_16x16x32_bf16 v[40:43], a[16:19], a[128:131], v[40:43]
s_lshl_b32 s53, s52, 2
ds_read_b64_tr_b16 a[140:141], v5 offset:16384
v_mfma_f32_16x16x32_bf16 v[40:43], a[20:23], a[132:135], v[40:43]
s_add_u32 s53, s53, s3
buffer_load_dwordx4 v17, s[12:15], s27 offen offset:1024 lds
v_mfma_f32_16x16x32_bf16 v[44:47], a[24:27], a[128:131], v[44:47]
s_lshl_b32 s49, s53, 12
ds_read_b64_tr_b16 a[142:143], v5 offset:18432
v_mfma_f32_16x16x32_bf16 v[44:47], a[28:31], a[132:135], v[44:47]
s_mul_i32 s53, s53, 4224
v_mfma_f32_16x16x32_bf16 v[48:51], a[32:35], a[128:131], v[48:51]
s_add_u32 s53, s53, 83886080
ds_read_b128 a[64:67], v2 offset:32768
v_mfma_f32_16x16x32_bf16 v[48:51], a[36:39], a[132:135], v[48:51]
s_lshr_b32 s52, s52, 4
buffer_load_dwordx4 v18, s[12:15], s27 offen offset:2048 lds
v_mfma_f32_16x16x32_bf16 v[52:55], a[40:43], a[128:131], v[52:55]
s_min_u32 s52, s52, 6
ds_read_b128 a[68:71], v3 offset:32768
v_mfma_f32_16x16x32_bf16 v[52:55], a[44:47], a[132:135], v[52:55]
s_lshl_b32 s52, s52, 7
ds_read_b128 a[176:179], v22 offset:0
v_mfma_f32_16x16x32_bf16 v[56:59], a[48:51], a[128:131], v[56:59]
s_add_u32 s52, s52, 94392320
ds_read_b128 a[180:183], v22 offset:1024
v_mfma_f32_16x16x32_bf16 v[56:59], a[52:55], a[132:135], v[56:59]
buffer_load_dwordx4 v19, s[12:15], s27 offen offset:3072 lds
v_mfma_f32_16x16x32_bf16 v[60:63], a[56:59], a[128:131], v[60:63]
s_add_u32 s27, s27, 524288
ds_read_b128 a[72:75], v2 offset:34816
v_mfma_f32_16x16x32_bf16 v[60:63], a[60:63], a[132:135], v[60:63]
s_waitcnt lgkmcnt(7)
ds_read_b128 a[184:187], v22 offset:2048
v_mfma_f32_16x16x32_bf16 v[64:67], a[0:3], a[136:139], v[64:67]
s_waitcnt lgkmcnt(6)
s_add_u32 m0, s28, 0
ds_read_b64_tr_b16 a[128:129], v6 offset:0
v_mfma_f32_16x16x32_bf16 v[64:67], a[4:7], a[140:143], v[64:67]
buffer_load_dwordx4 v12, s[8:11], s24 offen offset:0 lds
v_mfma_f32_16x16x32_bf16 v[68:71], a[8:11], a[136:139], v[68:71]
ds_read_b64_tr_b16 a[130:131], v6 offset:2048
v_mfma_f32_16x16x32_bf16 v[68:71], a[12:15], a[140:143], v[68:71]
ds_read_b128 a[188:191], v22 offset:3072
v_mfma_f32_16x16x32_bf16 v[72:75], a[16:19], a[136:139], v[72:75]
ds_read_b64_tr_b16 a[132:133], v6 offset:16384
v_bfe_u32 v231, v1, 4, 5
v_mfma_f32_16x16x32_bf16 v[72:75], a[20:23], a[140:143], v[72:75]
buffer_load_dwordx4 v13, s[8:11], s24 offen offset:1024 lds
v_mfma_f32_16x16x32_bf16 v[76:79], a[24:27], a[136:139], v[76:79]
ds_read_b64_tr_b16 a[134:135], v6 offset:18432
v_lshlrev_b32 v231, 2, v231
v_mfma_f32_16x16x32_bf16 v[76:79], a[28:31], a[140:143], v[76:79]
v_lshlrev_b32 v229, 3, v1
v_min_u32 v229, 4096, v229
v_mfma_f32_16x16x32_bf16 v[80:83], a[32:35], a[136:139], v[80:83]
ds_read_b128 a[76:79], v3 offset:34816
v_mfma_f32_16x16x32_bf16 v[80:83], a[36:39], a[140:143], v[80:83]
buffer_load_dwordx4 v14, s[8:11], s24 offen offset:2048 lds
v_mfma_f32_16x16x32_bf16 v[84:87], a[40:43], a[136:139], v[84:87]
v_mfma_f32_16x16x32_bf16 v[84:87], a[44:47], a[140:143], v[84:87]
v_mfma_f32_16x16x32_bf16 v[88:91], a[48:51], a[136:139], v[88:91]
ds_read_b128 a[80:83], v2 offset:36864
v_mfma_f32_16x16x32_bf16 v[88:91], a[52:55], a[140:143], v[88:91]
buffer_load_dwordx4 v15, s[8:11], s24 offen offset:3072 lds
v_mfma_f32_16x16x32_bf16 v[92:95], a[56:59], a[136:139], v[92:95]
s_add_u32 s24, s24, 128
ds_read_b128 a[84:87], v3 offset:36864
v_mfma_f32_16x16x32_bf16 v[92:95], a[60:63], a[140:143], v[92:95]
s_waitcnt lgkmcnt(6)
v_mfma_f32_16x16x32_bf16 v[96:99], a[0:3], a[128:131], v[96:99]
s_waitcnt lgkmcnt(3)
s_add_u32 m0, s28, 4096
ds_read_b64_tr_b16 a[136:137], v7 offset:0
v_mfma_f32_16x16x32_bf16 v[96:99], a[4:7], a[132:135], v[96:99]
buffer_load_dwordx4 v12, s[8:11], s25 offen offset:0 lds
v_mfma_f32_16x16x32_bf16 v[100:103], a[8:11], a[128:131], v[100:103]
ds_read_b64_tr_b16 a[138:139], v7 offset:2048
v_mfma_f32_16x16x32_bf16 v[100:103], a[12:15], a[132:135], v[100:103]
v_mfma_f32_16x16x32_bf16 v[104:107], a[16:19], a[128:131], v[104:107]
ds_read_b64_tr_b16 a[140:141], v7 offset:16384
v_mfma_f32_16x16x32_bf16 v[104:107], a[20:23], a[132:135], v[104:107]
buffer_load_dwordx4 v13, s[8:11], s25 offen offset:1024 lds
v_mfma_f32_16x16x32_bf16 v[108:111], a[24:27], a[128:131], v[108:111]
ds_read_b64_tr_b16 a[142:143], v7 offset:18432
v_mfma_f32_16x16x32_bf16 v[108:111], a[28:31], a[132:135], v[108:111]
v_mfma_f32_16x16x32_bf16 v[112:115], a[32:35], a[128:131], v[112:115]
v_mfma_f32_16x16x32_bf16 v[112:115], a[36:39], a[132:135], v[112:115]
buffer_load_dwordx4 v14, s[8:11], s25 offen offset:2048 lds
v_mfma_f32_16x16x32_bf16 v[116:119], a[40:43], a[128:131], v[116:119]
ds_read_b128 a[88:91], v2 offset:38912
v_mfma_f32_16x16x32_bf16 v[116:119], a[44:47], a[132:135], v[116:119]
v_mfma_f32_16x16x32_bf16 v[120:123], a[48:51], a[128:131], v[120:123]
ds_read_b128 a[92:95], v3 offset:38912
v_mfma_f32_16x16x32_bf16 v[120:123], a[52:55], a[132:135], v[120:123]
buffer_load_dwordx4 v15, s[8:11], s25 offen offset:3072 lds
v_mfma_f32_16x16x32_bf16 v[124:127], a[56:59], a[128:131], v[124:127]
s_add_u32 s25, s25, 128
v_mfma_f32_16x16x32_bf16 v[124:127], a[60:63], a[132:135], v[124:127]
s_waitcnt lgkmcnt(4)
v_mfma_f32_16x16x32_bf16 v[128:131], a[0:3], a[136:139], v[128:131]
s_waitcnt lgkmcnt(2)
ds_read_b64_tr_b16 a[128:129], v8 offset:0
v_mfma_f32_16x16x32_bf16 v[128:131], a[4:7], a[140:143], v[128:131]
buffer_store_dwordx4 a[176:179], v224, s[4:7], s56 offen sc1
v_mfma_f32_16x16x32_bf16 v[132:135], a[8:11], a[136:139], v[132:135]
s_add_u32 s56, s56, 33792
ds_read_b64_tr_b16 a[130:131], v8 offset:2048
v_mfma_f32_16x16x32_bf16 v[132:135], a[12:15], a[140:143], v[132:135]
v_mfma_f32_16x16x32_bf16 v[136:139], a[16:19], a[136:139], v[136:139]
ds_read_b64_tr_b16 a[132:133], v8 offset:16384
v_mfma_f32_16x16x32_bf16 v[136:139], a[20:23], a[140:143], v[136:139]
v_mfma_f32_16x16x32_bf16 v[140:143], a[24:27], a[136:139], v[140:143]
s_cmp_lt_u32 s21, 7
ds_read_b64_tr_b16 a[134:135], v8 offset:18432
v_mfma_f32_16x16x32_bf16 v[140:143], a[28:31], a[140:143], v[140:143]
s_cselect_b32 s53, s53, 3221225472
v_mfma_f32_16x16x32_bf16 v[144:147], a[32:35], a[136:139], v[144:147]
s_cselect_b32 s49, s49, 3221225472
ds_read_b128 a[96:99], v2 offset:40960
v_mfma_f32_16x16x32_bf16 v[144:147], a[36:39], a[140:143], v[144:147]
s_add_u32 s48, s53, 2097152
v_mfma_f32_16x16x32_bf16 v[148:151], a[40:43], a[136:139], v[148:151]
v_mfma_f32_16x16x32_bf16 v[148:151], a[44:47], a[140:143], v[148:151]
v_mfma_f32_16x16x32_bf16 v[152:155], a[48:51], a[136:139], v[152:155]
ds_read_b128 a[100:103], v3 offset:40960
v_mfma_f32_16x16x32_bf16 v[152:155], a[52:55], a[140:143], v[152:155]
v_mfma_f32_16x16x32_bf16 v[156:159], a[56:59], a[136:139], v[156:159]
ds_read_b128 a[104:107], v2 offset:43008
v_mfma_f32_16x16x32_bf16 v[156:159], a[60:63], a[140:143], v[156:159]
s_waitcnt lgkmcnt(5)
v_mfma_f32_16x16x32_bf16 v[160:163], a[0:3], a[128:131], v[160:163]
s_waitcnt lgkmcnt(3)
ds_read_b64_tr_b16 a[136:137], v9 offset:0
v_mfma_f32_16x16x32_bf16 v[160:163], a[4:7], a[132:135], v[160:163]
v_mfma_f32_16x16x32_bf16 v[164:167], a[8:11], a[128:131], v[164:167]
ds_read_b64_tr_b16 a[138:139], v9 offset:2048
v_mfma_f32_16x16x32_bf16 v[164:167], a[12:15], a[132:135], v[164:167]
buffer_store_dwordx4 a[180:183], v224, s[4:7], s56 offen sc1
v_mfma_f32_16x16x32_bf16 v[168:171], a[16:19], a[128:131], v[168:171]
s_add_u32 s56, s56, 33792
ds_read_b64_tr_b16 a[140:141], v9 offset:16384
v_mfma_f32_16x16x32_bf16 v[168:171], a[20:23], a[132:135], v[168:171]
v_mfma_f32_16x16x32_bf16 v[172:175], a[24:27], a[128:131], v[172:175]
ds_read_b64_tr_b16 a[142:143], v9 offset:18432
v_mfma_f32_16x16x32_bf16 v[172:175], a[28:31], a[132:135], v[172:175]
v_mfma_f32_16x16x32_bf16 v[176:179], a[32:35], a[128:131], v[176:179]
v_mfma_f32_16x16x32_bf16 v[176:179], a[36:39], a[132:135], v[176:179]
v_mfma_f32_16x16x32_bf16 v[180:183], a[40:43], a[128:131], v[180:183]
ds_read_b128 a[108:111], v3 offset:43008
v_mfma_f32_16x16x32_bf16 v[180:183], a[44:47], a[132:135], v[180:183]
v_mfma_f32_16x16x32_bf16 v[184:187], a[48:51], a[128:131], v[184:187]
ds_read_b128 a[112:115], v2 offset:45056
v_mfma_f32_16x16x32_bf16 v[184:187], a[52:55], a[132:135], v[184:187]
v_mfma_f32_16x16x32_bf16 v[188:191], a[56:59], a[128:131], v[188:191]
v_mfma_f32_16x16x32_bf16 v[188:191], a[60:63], a[132:135], v[188:191]
s_waitcnt lgkmcnt(4)
v_mfma_f32_16x16x32_bf16 v[192:195], a[0:3], a[136:139], v[192:195]
s_waitcnt lgkmcnt(2)
ds_read_b64_tr_b16 a[128:129], v10 offset:0
v_mfma_f32_16x16x32_bf16 v[192:195], a[4:7], a[140:143], v[192:195]
v_mfma_f32_16x16x32_bf16 v[196:199], a[8:11], a[136:139], v[196:199]
ds_read_b64_tr_b16 a[130:131], v10 offset:2048
v_mfma_f32_16x16x32_bf16 v[196:199], a[12:15], a[140:143], v[196:199]
v_mfma_f32_16x16x32_bf16 v[200:203], a[16:19], a[136:139], v[200:203]
ds_read_b64_tr_b16 a[132:133], v10 offset:16384
v_mfma_f32_16x16x32_bf16 v[200:203], a[20:23], a[140:143], v[200:203]
buffer_store_dwordx4 a[184:187], v224, s[4:7], s56 offen sc1
v_mfma_f32_16x16x32_bf16 v[204:207], a[24:27], a[136:139], v[204:207]
s_add_u32 s56, s56, 33792
ds_read_b64_tr_b16 a[134:135], v10 offset:18432
v_mfma_f32_16x16x32_bf16 v[204:207], a[28:31], a[140:143], v[204:207]
v_mfma_f32_16x16x32_bf16 v[208:211], a[32:35], a[136:139], v[208:211]
ds_read_b128 a[116:119], v3 offset:45056
v_mfma_f32_16x16x32_bf16 v[208:211], a[36:39], a[140:143], v[208:211]
v_mfma_f32_16x16x32_bf16 v[212:215], a[40:43], a[136:139], v[212:215]
ds_read_b128 a[120:123], v2 offset:47104
v_mfma_f32_16x16x32_bf16 v[212:215], a[44:47], a[140:143], v[212:215]
v_mfma_f32_16x16x32_bf16 v[216:219], a[48:51], a[136:139], v[216:219]
v_mfma_f32_16x16x32_bf16 v[216:219], a[52:55], a[140:143], v[216:219]
v_mfma_f32_16x16x32_bf16 v[220:223], a[56:59], a[136:139], v[220:223]
ds_read_b128 a[124:127], v3 offset:47104
v_mfma_f32_16x16x32_bf16 v[220:223], a[60:63], a[140:143], v[220:223]
s_waitcnt lgkmcnt(5)
v_mfma_f32_16x16x32_bf16 a[192:195], a[0:3], a[128:131], a[192:195]
s_waitcnt lgkmcnt(3)
ds_read_b64_tr_b16 a[136:137], v11 offset:0
v_mfma_f32_16x16x32_bf16 a[192:195], a[4:7], a[132:135], a[192:195]
v_mfma_f32_16x16x32_bf16 a[196:199], a[8:11], a[128:131], a[196:199]
ds_read_b64_tr_b16 a[138:139], v11 offset:2048
v_mfma_f32_16x16x32_bf16 a[196:199], a[12:15], a[132:135], a[196:199]
v_mfma_f32_16x16x32_bf16 a[200:203], a[16:19], a[128:131], a[200:203]
ds_read_b64_tr_b16 a[140:141], v11 offset:16384
v_mfma_f32_16x16x32_bf16 a[200:203], a[20:23], a[132:135], a[200:203]
v_mfma_f32_16x16x32_bf16 a[204:207], a[24:27], a[128:131], a[204:207]
ds_read_b64_tr_b16 a[142:143], v11 offset:18432
v_mfma_f32_16x16x32_bf16 a[204:207], a[28:31], a[132:135], a[204:207]
buffer_store_dwordx4 a[188:191], v224, s[4:7], s56 offen sc1
v_mfma_f32_16x16x32_bf16 a[208:211], a[32:35], a[128:131], a[208:211]
s_add_u32 s56, s56, 33792
v_mfma_f32_16x16x32_bf16 a[208:211], a[36:39], a[132:135], a[208:211]
v_mfma_f32_16x16x32_bf16 a[212:215], a[40:43], a[128:131], a[212:215]
v_mfma_f32_16x16x32_bf16 a[212:215], a[44:47], a[132:135], a[212:215]
v_mfma_f32_16x16x32_bf16 a[216:219], a[48:51], a[128:131], a[216:219]
v_mfma_f32_16x16x32_bf16 a[216:219], a[52:55], a[132:135], a[216:219]
v_mfma_f32_16x16x32_bf16 a[220:223], a[56:59], a[128:131], a[220:223]
v_mfma_f32_16x16x32_bf16 a[220:223], a[60:63], a[132:135], a[220:223]
s_waitcnt vmcnt(4) lgkmcnt(0)
s_barrier
v_mfma_f32_16x16x32_bf16 a[224:227], a[0:3], a[136:139], a[224:227]
s_add_u32 m0, s29, 65536
ds_read_b64_tr_b16 a[128:129], v4 offset:32768
v_mfma_f32_16x16x32_bf16 a[224:227], a[4:7], a[140:143], a[224:227]
buffer_load_dwordx4 v16, s[12:15], s26 offen offset:0 lds
v_mfma_f32_16x16x32_bf16 a[228:231], a[8:11], a[136:139], a[228:231]
ds_read_b64_tr_b16 a[130:131], v4 offset:34816
v_cmp_gt_u32 vcc, 0x100, v245
v_mfma_f32_16x16x32_bf16 a[228:231], a[12:15], a[140:143], a[228:231]
v_mfma_f32_16x16x32_bf16 a[232:235], a[16:19], a[136:139], a[232:235]
ds_read_b64_tr_b16 a[132:133], v4 offset:49152
v_mfma_f32_16x16x32_bf16 a[232:235], a[20:23], a[140:143], a[232:235]
buffer_load_dwordx4 v17, s[12:15], s26 offen offset:1024 lds
v_mfma_f32_16x16x32_bf16 a[236:239], a[24:27], a[136:139], a[236:239]
ds_read_b64_tr_b16 a[134:135], v4 offset:51200
v_mfma_f32_16x16x32_bf16 a[236:239], a[28:31], a[140:143], a[236:239]
v_mfma_f32_16x16x32_bf16 a[240:243], a[32:35], a[136:139], a[240:243]
v_mfma_f32_16x16x32_bf16 a[240:243], a[36:39], a[140:143], a[240:243]
buffer_load_dwordx4 v18, s[12:15], s26 offen offset:2048 lds
v_mfma_f32_16x16x32_bf16 a[244:247], a[40:43], a[136:139], a[244:247]
v_mfma_f32_16x16x32_bf16 a[244:247], a[44:47], a[140:143], a[244:247]
v_mfma_f32_16x16x32_bf16 a[248:251], a[48:51], a[136:139], a[248:251]
v_mfma_f32_16x16x32_bf16 a[248:251], a[52:55], a[140:143], a[248:251]
buffer_load_dwordx4 v19, s[12:15], s26 offen offset:3072 lds
v_mfma_f32_16x16x32_bf16 a[252:255], a[56:59], a[136:139], a[252:255]
s_add_u32 s26, s26, 524288
v_mfma_f32_16x16x32_bf16 a[252:255], a[60:63], a[140:143], a[252:255]
s_waitcnt lgkmcnt(2)
s_mov_b32 s82, s59
s_cbranch_vccnz M_cntspinV
s_branch Lg_2
Lg_2t:
buffer_load_dword v230, v231, s[4:7], s52 offen sc1
v_mfma_f32_16x16x32_bf16 v[32:35], a[64:67], a[128:131], v[32:35]
s_waitcnt lgkmcnt(0)
s_add_u32 m0, s29, 81920
ds_read_b64_tr_b16 a[136:137], v5 offset:32768
v_mfma_f32_16x16x32_bf16 v[32:35], a[68:71], a[132:135], v[32:35]
buffer_load_dwordx4 v16, s[12:15], s27 offen offset:0 lds
v_mfma_f32_16x16x32_bf16 v[36:39], a[72:75], a[128:131], v[36:39]
s_and_b32 s44, s3, 1
ds_read_b64_tr_b16 a[138:139], v5 offset:34816
v_mfma_f32_16x16x32_bf16 v[36:39], a[76:79], a[132:135], v[36:39]
s_lshl_b32 s44, s44, 8
v_mfma_f32_16x16x32_bf16 v[40:43], a[80:83], a[128:131], v[40:43]
s_lshl_b32 s45, s3, 7
ds_read_b64_tr_b16 a[140:141], v5 offset:49152
v_mfma_f32_16x16x32_bf16 v[40:43], a[84:87], a[132:135], v[40:43]
s_xor_b32 s44, s44, s45
buffer_load_dwordx4 v17, s[12:15], s27 offen offset:1024 lds
v_mfma_f32_16x16x32_bf16 v[44:47], a[88:91], a[128:131], v[44:47]
s_xor_b32 s44, s44, 196608
ds_read_b64_tr_b16 a[142:143], v5 offset:51200
v_mfma_f32_16x16x32_bf16 v[44:47], a[92:95], a[132:135], v[44:47]
v_mfma_f32_16x16x32_bf16 v[48:51], a[96:99], a[128:131], v[48:51]
ds_read_b128 a[0:3], v2 offset:0
v_mfma_f32_16x16x32_bf16 v[48:51], a[100:103], a[132:135], v[48:51]
buffer_load_dwordx4 v18, s[12:15], s27 offen offset:2048 lds
v_mfma_f32_16x16x32_bf16 v[52:55], a[104:107], a[128:131], v[52:55]
ds_read_b128 a[4:7], v3 offset:0
v_mfma_f32_16x16x32_bf16 v[52:55], a[108:111], a[132:135], v[52:55]
v_mfma_f32_16x16x32_bf16 v[56:59], a[112:115], a[128:131], v[56:59]
v_mfma_f32_16x16x32_bf16 v[56:59], a[116:119], a[132:135], v[56:59]
buffer_load_dwordx4 v19, s[12:15], s27 offen offset:3072 lds
v_mfma_f32_16x16x32_bf16 v[60:63], a[120:123], a[128:131], v[60:63]
s_add_u32 s27, s27, 524288
ds_read_b128 a[8:11], v2 offset:2048
v_mfma_f32_16x16x32_bf16 v[60:63], a[124:127], a[132:135], v[60:63]
s_waitcnt lgkmcnt(5)
v_mfma_f32_16x16x32_bf16 v[64:67], a[64:67], a[136:139], v[64:67]
s_waitcnt lgkmcnt(3)
s_add_u32 m0, s28, 32768
ds_read_b64_tr_b16 a[128:129], v6 offset:32768
v_mfma_f32_16x16x32_bf16 v[64:67], a[68:71], a[140:143], v[64:67]
buffer_load_dwordx4 v12, s[8:11], s24 offen offset:0 lds
v_mfma_f32_16x16x32_bf16 v[68:71], a[72:75], a[136:139], v[68:71]
ds_read_b64_tr_b16 a[130:131], v6 offset:34816
v_mfma_f32_16x16x32_bf16 v[68:71], a[76:79], a[140:143], v[68:71]
v_mfma_f32_16x16x32_bf16 v[72:75], a[80:83], a[136:139], v[72:75]
s_mov_b64 s[56:57], s[72:73]
ds_read_b64_tr_b16 a[132:133], v6 offset:49152
v_mfma_f32_16x16x32_bf16 v[72:75], a[84:87], a[140:143], v[72:75]
s_mov_b32 s58, 1835008
buffer_load_dwordx4 v13, s[8:11], s24 offen offset:1024 lds
v_mfma_f32_16x16x32_bf16 v[76:79], a[88:91], a[136:139], v[76:79]
s_mov_b32 s59, 0x20000
ds_read_b64_tr_b16 a[134:135], v6 offset:51200
v_mfma_f32_16x16x32_bf16 v[76:79], a[92:95], a[140:143], v[76:79]
v_mfma_f32_16x16x32_bf16 v[80:83], a[96:99], a[136:139], v[80:83]
ds_read_b128 a[12:15], v3 offset:2048
v_mfma_f32_16x16x32_bf16 v[80:83], a[100:103], a[140:143], v[80:83]
buffer_load_dwordx4 v14, s[8:11], s24 offen offset:2048 lds
v_mfma_f32_16x16x32_bf16 v[84:87], a[104:107], a[136:139], v[84:87]
v_mfma_f32_16x16x32_bf16 v[84:87], a[108:111], a[140:143], v[84:87]
v_mfma_f32_16x16x32_bf16 v[88:91], a[112:115], a[136:139], v[88:91]
ds_read_b128 a[16:19], v2 offset:4096
v_mfma_f32_16x16x32_bf16 v[88:91], a[116:119], a[140:143], v[88:91]
buffer_load_dwordx4 v15, s[8:11], s24 offen offset:3072 lds
v_mfma_f32_16x16x32_bf16 v[92:95], a[120:123], a[136:139], v[92:95]
s_add_u32 s24, s24, 128
ds_read_b128 a[20:23], v3 offset:4096
v_mfma_f32_16x16x32_bf16 v[92:95], a[124:127], a[140:143], v[92:95]
s_waitcnt lgkmcnt(5)
v_mfma_f32_16x16x32_bf16 v[96:99], a[64:67], a[128:131], v[96:99]
s_waitcnt lgkmcnt(3)
s_add_u32 m0, s28, 36864
ds_read_b64_tr_b16 a[136:137], v7 offset:32768
v_mfma_f32_16x16x32_bf16 v[96:99], a[68:71], a[132:135], v[96:99]
buffer_load_dwordx4 v12, s[8:11], s25 offen offset:0 lds
v_mfma_f32_16x16x32_bf16 v[100:103], a[72:75], a[128:131], v[100:103]
ds_read_b64_tr_b16 a[138:139], v7 offset:34816
v_mfma_f32_16x16x32_bf16 v[100:103], a[76:79], a[132:135], v[100:103]
v_mfma_f32_16x16x32_bf16 v[104:107], a[80:83], a[128:131], v[104:107]
ds_read_b64_tr_b16 a[140:141], v7 offset:49152
v_mfma_f32_16x16x32_bf16 v[104:107], a[84:87], a[132:135], v[104:107]
buffer_load_dwordx4 v13, s[8:11], s25 offen offset:1024 lds
v_mfma_f32_16x16x32_bf16 v[108:111], a[88:91], a[128:131], v[108:111]
ds_read_b64_tr_b16 a[142:143], v7 offset:51200
v_mfma_f32_16x16x32_bf16 v[108:111], a[92:95], a[132:135], v[108:111]
v_mfma_f32_16x16x32_bf16 v[112:115], a[96:99], a[128:131], v[112:115]
v_mfma_f32_16x16x32_bf16 v[112:115], a[100:103], a[132:135], v[112:115]
buffer_load_dwordx4 v14, s[8:11], s25 offen offset:2048 lds
v_mfma_f32_16x16x32_bf16 v[116:119], a[104:107], a[128:131], v[116:119]
ds_read_b128 a[24:27], v2 offset:6144
v_mfma_f32_16x16x32_bf16 v[116:119], a[108:111], a[132:135], v[116:119]
v_mfma_f32_16x16x32_bf16 v[120:123], a[112:115], a[128:131], v[120:123]
ds_read_b128 a[28:31], v3 offset:6144
v_mfma_f32_16x16x32_bf16 v[120:123], a[116:119], a[132:135], v[120:123]
buffer_load_dwordx4 v15, s[8:11], s25 offen offset:3072 lds
v_mfma_f32_16x16x32_bf16 v[124:127], a[120:123], a[128:131], v[124:127]
s_add_u32 s25, s25, 128
s_waitcnt vmcnt(12)
v_mfma_f32_16x16x32_bf16 v[124:127], a[124:127], a[132:135], v[124:127]
s_waitcnt lgkmcnt(4)
v_cmp_gt_u32 vcc, 1, v230
v_mfma_f32_16x16x32_bf16 v[128:131], a[64:67], a[136:139], v[128:131]
s_waitcnt lgkmcnt(2)
s_cbranch_vccnz M_ppspinV
M_ppokV:
ds_read_b64_tr_b16 a[128:129], v8 offset:32768
v_mfma_f32_16x16x32_bf16 v[128:131], a[68:71], a[140:143], v[128:131]
buffer_load_dword v230, v229, s[4:7], s53 offen sc1
v_mfma_f32_16x16x32_bf16 v[132:135], a[72:75], a[136:139], v[132:135]
s_mov_b64 s[8:9], s[76:77]
ds_read_b64_tr_b16 a[130:131], v8 offset:34816
v_mfma_f32_16x16x32_bf16 v[132:135], a[76:79], a[140:143], v[132:135]
s_mov_b32 s10, 1835008
buffer_load_dword v230, v229, s[4:7], s48 offen sc1
v_mfma_f32_16x16x32_bf16 v[136:139], a[80:83], a[136:139], v[136:139]
s_lshl_b32 s24, s37, 2
ds_read_b64_tr_b16 a[132:133], v8 offset:49152
v_mfma_f32_16x16x32_bf16 v[136:139], a[84:87], a[140:143], v[136:139]
s_add_u32 s24, s24, s3
buffer_load_dword v230, v229, s[56:59], s49 offen
v_mfma_f32_16x16x32_bf16 v[140:143], a[88:91], a[136:139], v[140:143]
s_mul_i32 s24, s24, 28672
ds_read_b64_tr_b16 a[134:135], v8 offset:51200
v_mfma_f32_16x16x32_bf16 v[140:143], a[92:95], a[140:143], v[140:143]
s_mov_b32 s28, s29
buffer_load_dword v21, v20, s[16:19], s43 offen
v_mfma_f32_16x16x32_bf16 v[144:147], a[96:99], a[136:139], v[144:147]
ds_read_b128 a[32:35], v2 offset:8192
v_mfma_f32_16x16x32_bf16 v[144:147], a[100:103], a[140:143], v[144:147]
v_mfma_f32_16x16x32_bf16 v[148:151], a[104:107], a[136:139], v[148:151]
v_mfma_f32_16x16x32_bf16 v[148:151], a[108:111], a[140:143], v[148:151]
v_mfma_f32_16x16x32_bf16 v[152:155], a[112:115], a[136:139], v[152:155]
ds_read_b128 a[36:39], v3 offset:8192
v_lshrrev_b32 v28, 7, v1
v_mfma_f32_16x16x32_bf16 v[152:155], a[116:119], a[140:143], v[152:155]
v_lshrrev_b32 v29, 1, v28
v_lshlrev_b32 v29, 4, v29
v_mfma_f32_16x16x32_bf16 v[156:159], a[120:123], a[136:139], v[156:159]
ds_read_b128 a[40:43], v2 offset:10240
v_and_b32 v30, 0x70, v1
v_mfma_f32_16x16x32_bf16 v[156:159], a[124:127], a[140:143], v[156:159]
s_waitcnt lgkmcnt(5)
v_xor_b32 v29, v29, v30
v_mul_u32_u24 v28, 896, v28
v_mfma_f32_16x16x32_bf16 v[160:163], a[64:67], a[128:131], v[160:163]
s_waitcnt lgkmcnt(3)
ds_read_b64_tr_b16 a[136:137], v9 offset:32768
v_add_u32 v12, v28, v29
v_mfma_f32_16x16x32_bf16 v[160:163], a[68:71], a[132:135], v[160:163]
v_xor_b32 v29, 64, v29
v_add_u32 v28, v28, v29
v_mfma_f32_16x16x32_bf16 v[164:167], a[72:75], a[128:131], v[164:167]
ds_read_b64_tr_b16 a[138:139], v9 offset:34816
v_add_u32 v13, 6144, v28
v_mfma_f32_16x16x32_bf16 v[164:167], a[76:79], a[132:135], v[164:167]
v_add_u32 v14, 12288, v12
v_add_u32 v15, 18432, v28
v_mfma_f32_16x16x32_bf16 v[168:171], a[80:83], a[128:131], v[168:171]
ds_read_b64_tr_b16 a[140:141], v9 offset:49152
v_xor_b32 v22, s44, v4
v_mfma_f32_16x16x32_bf16 v[168:171], a[84:87], a[132:135], v[168:171]
v_xor_b32 v23, 32, v22
v_xor_b32 v24, 64, v22
v_mfma_f32_16x16x32_bf16 v[172:175], a[88:91], a[128:131], v[172:175]
ds_read_b64_tr_b16 a[142:143], v9 offset:51200
v_xor_b32 v25, 96, v22
v_mfma_f32_16x16x32_bf16 v[172:175], a[92:95], a[132:135], v[172:175]
v_mfma_f32_16x16x32_bf16 v[176:179], a[96:99], a[128:131], v[176:179]
v_mfma_f32_16x16x32_bf16 v[176:179], a[100:103], a[132:135], v[176:179]
v_mfma_f32_16x16x32_bf16 v[180:183], a[104:107], a[128:131], v[180:183]
ds_read_b128 a[44:47], v3 offset:10240
v_mfma_f32_16x16x32_bf16 v[180:183], a[108:111], a[132:135], v[180:183]
v_mfma_f32_16x16x32_bf16 v[184:187], a[112:115], a[128:131], v[184:187]
ds_read_b128 a[48:51], v2 offset:12288
v_mfma_f32_16x16x32_bf16 v[184:187], a[116:119], a[132:135], v[184:187]
v_mfma_f32_16x16x32_bf16 v[188:191], a[120:123], a[128:131], v[188:191]
v_mfma_f32_16x16x32_bf16 v[188:191], a[124:127], a[132:135], v[188:191]
s_waitcnt lgkmcnt(4)
v_mfma_f32_16x16x32_bf16 v[192:195], a[64:67], a[136:139], v[192:195]
s_waitcnt lgkmcnt(2)
ds_read_b64_tr_b16 a[128:129], v10 offset:32768
v_mfma_f32_16x16x32_bf16 v[192:195], a[68:71], a[140:143], v[192:195]
v_mfma_f32_16x16x32_bf16 v[196:199], a[72:75], a[136:139], v[196:199]
ds_read_b64_tr_b16 a[130:131], v10 offset:34816
v_mfma_f32_16x16x32_bf16 v[196:199], a[76:79], a[140:143], v[196:199]
v_mfma_f32_16x16x32_bf16 v[200:203], a[80:83], a[136:139], v[200:203]
ds_read_b64_tr_b16 a[132:133], v10 offset:49152
v_mfma_f32_16x16x32_bf16 v[200:203], a[84:87], a[140:143], v[200:203]
v_mfma_f32_16x16x32_bf16 v[204:207], a[88:91], a[136:139], v[204:207]
ds_read_b64_tr_b16 a[134:135], v10 offset:51200
v_mfma_f32_16x16x32_bf16 v[204:207], a[92:95], a[140:143], v[204:207]
v_mfma_f32_16x16x32_bf16 v[208:211], a[96:99], a[136:139], v[208:211]
ds_read_b128 a[52:55], v3 offset:12288
v_mfma_f32_16x16x32_bf16 v[208:211], a[100:103], a[140:143], v[208:211]
v_mfma_f32_16x16x32_bf16 v[212:215], a[104:107], a[136:139], v[212:215]
ds_read_b128 a[56:59], v2 offset:14336
v_mfma_f32_16x16x32_bf16 v[212:215], a[108:111], a[140:143], v[212:215]
v_mfma_f32_16x16x32_bf16 v[216:219], a[112:115], a[136:139], v[216:219]
v_mfma_f32_16x16x32_bf16 v[216:219], a[116:119], a[140:143], v[216:219]
v_mfma_f32_16x16x32_bf16 v[220:223], a[120:123], a[136:139], v[220:223]
ds_read_b128 a[60:63], v3 offset:14336
v_mfma_f32_16x16x32_bf16 v[220:223], a[124:127], a[140:143], v[220:223]
s_waitcnt lgkmcnt(5)
v_mfma_f32_16x16x32_bf16 a[192:195], a[64:67], a[128:131], a[192:195]
s_waitcnt lgkmcnt(3)
ds_read_b64_tr_b16 a[136:137], v11 offset:32768
v_mfma_f32_16x16x32_bf16 a[192:195], a[68:71], a[132:135], a[192:195]
v_mfma_f32_16x16x32_bf16 a[196:199], a[72:75], a[128:131], a[196:199]
ds_read_b64_tr_b16 a[138:139], v11 offset:34816
v_mfma_f32_16x16x32_bf16 a[196:199], a[76:79], a[132:135], a[196:199]
v_mfma_f32_16x16x32_bf16 a[200:203], a[80:83], a[128:131], a[200:203]
ds_read_b64_tr_b16 a[140:141], v11 offset:49152
v_mfma_f32_16x16x32_bf16 a[200:203], a[84:87], a[132:135], a[200:203]
v_mfma_f32_16x16x32_bf16 a[204:207], a[88:91], a[128:131], a[204:207]
ds_read_b64_tr_b16 a[142:143], v11 offset:51200
v_mfma_f32_16x16x32_bf16 a[204:207], a[92:95], a[132:135], a[204:207]
v_mfma_f32_16x16x32_bf16 a[208:211], a[96:99], a[128:131], a[208:211]
v_mfma_f32_16x16x32_bf16 a[208:211], a[100:103], a[132:135], a[208:211]
v_mfma_f32_16x16x32_bf16 a[212:215], a[104:107], a[128:131], a[212:215]
v_mfma_f32_16x16x32_bf16 a[212:215], a[108:111], a[132:135], a[212:215]
v_mfma_f32_16x16x32_bf16 a[216:219], a[112:115], a[128:131], a[216:219]
v_mfma_f32_16x16x32_bf16 a[216:219], a[116:119], a[132:135], a[216:219]
v_mfma_f32_16x16x32_bf16 a[220:223], a[120:123], a[128:131], a[220:223]
v_mfma_f32_16x16x32_bf16 a[220:223], a[124:127], a[132:135], a[220:223]
s_waitcnt vmcnt(4) lgkmcnt(0)
s_barrier
v_mfma_f32_16x16x32_bf16 a[224:227], a[64:67], a[136:139], a[224:227]
s_add_u32 m0, s29, 98304
ds_read_b64_tr_b16 a[128:129], v4 offset:0
v_mfma_f32_16x16x32_bf16 a[224:227], a[68:71], a[140:143], a[224:227]
buffer_load_dwordx4 v16, s[12:15], s26 offen offset:0 lds
v_mfma_f32_16x16x32_bf16 a[228:231], a[72:75], a[136:139], a[228:231]
ds_read_b64_tr_b16 a[130:131], v4 offset:2048
v_mfma_f32_16x16x32_bf16 a[228:231], a[76:79], a[140:143], a[228:231]
v_mfma_f32_16x16x32_bf16 a[232:235], a[80:83], a[136:139], a[232:235]
ds_read_b64_tr_b16 a[132:133], v4 offset:16384
v_mfma_f32_16x16x32_bf16 a[232:235], a[84:87], a[140:143], a[232:235]
buffer_load_dwordx4 v17, s[12:15], s26 offen offset:1024 lds
v_mfma_f32_16x16x32_bf16 a[236:239], a[88:91], a[136:139], a[236:239]
ds_read_b64_tr_b16 a[134:135], v4 offset:18432
v_mfma_f32_16x16x32_bf16 a[236:239], a[92:95], a[140:143], a[236:239]
v_mfma_f32_16x16x32_bf16 a[240:243], a[96:99], a[136:139], a[240:243]
v_mfma_f32_16x16x32_bf16 a[240:243], a[100:103], a[140:143], a[240:243]
buffer_load_dwordx4 v18, s[12:15], s26 offen offset:2048 lds
v_mfma_f32_16x16x32_bf16 a[244:247], a[104:107], a[136:139], a[244:247]
v_mfma_f32_16x16x32_bf16 a[244:247], a[108:111], a[140:143], a[244:247]
v_mfma_f32_16x16x32_bf16 a[248:251], a[112:115], a[136:139], a[248:251]
v_mfma_f32_16x16x32_bf16 a[248:251], a[116:119], a[140:143], a[248:251]
buffer_load_dwordx4 v19, s[12:15], s26 offen offset:3072 lds
v_mfma_f32_16x16x32_bf16 a[252:255], a[120:123], a[136:139], a[252:255]
s_add_u32 s26, s26, 524288
v_mfma_f32_16x16x32_bf16 a[252:255], a[124:127], a[140:143], a[252:255]
s_waitcnt lgkmcnt(2)
v_mfma_f32_16x16x32_bf16 v[32:35], a[0:3], a[128:131], v[32:35]
s_waitcnt lgkmcnt(0)
s_add_u32 m0, s29, 114688
ds_read_b64_tr_b16 a[136:137], v5 offset:0
v_mfma_f32_16x16x32_bf16 v[32:35], a[4:7], a[132:135], v[32:35]
buffer_load_dwordx4 v16, s[12:15], s27 offen offset:0 lds
v_mfma_f32_16x16x32_bf16 v[36:39], a[8:11], a[128:131], v[36:39]
ds_read_b64_tr_b16 a[138:139], v5 offset:2048
v_mfma_f32_16x16x32_bf16 v[36:39], a[12:15], a[132:135], v[36:39]
v_mfma_f32_16x16x32_bf16 v[40:43], a[16:19], a[128:131], v[40:43]
ds_read_b64_tr_b16 a[140:141], v5 offset:16384
v_mfma_f32_16x16x32_bf16 v[40:43], a[20:23], a[132:135], v[40:43]
buffer_load_dwordx4 v17, s[12:15], s27 offen offset:1024 lds
v_mfma_f32_16x16x32_bf16 v[44:47], a[24:27], a[128:131], v[44:47]
ds_read_b64_tr_b16 a[142:143], v5 offset:18432
v_mfma_f32_16x16x32_bf16 v[44:47], a[28:31], a[132:135], v[44:47]
v_mfma_f32_16x16x32_bf16 v[48:51], a[32:35], a[128:131], v[48:51]
ds_read_b128 a[64:67], v2 offset:32768
v_mfma_f32_16x16x32_bf16 v[48:51], a[36:39], a[132:135], v[48:51]
buffer_load_dwordx4 v18, s[12:15], s27 offen offset:2048 lds
v_mfma_f32_16x16x32_bf16 v[52:55], a[40:43], a[128:131], v[52:55]
ds_read_b128 a[68:71], v3 offset:32768
v_mfma_f32_16x16x32_bf16 v[52:55], a[44:47], a[132:135], v[52:55]
v_mfma_f32_16x16x32_bf16 v[56:59], a[48:51], a[128:131], v[56:59]
v_mfma_f32_16x16x32_bf16 v[56:59], a[52:55], a[132:135], v[56:59]
buffer_load_dwordx4 v19, s[12:15], s27 offen offset:3072 lds
v_mfma_f32_16x16x32_bf16 v[60:63], a[56:59], a[128:131], v[60:63]
s_add_u32 s27, s27, 524288
ds_read_b128 a[72:75], v2 offset:34816
v_mfma_f32_16x16x32_bf16 v[60:63], a[60:63], a[132:135], v[60:63]
s_waitcnt lgkmcnt(5)
v_mfma_f32_16x16x32_bf16 v[64:67], a[0:3], a[136:139], v[64:67]
s_waitcnt lgkmcnt(3)
s_add_u32 m0, s28, 0
ds_read_b64_tr_b16 a[128:129], v6 offset:0
v_mfma_f32_16x16x32_bf16 v[64:67], a[4:7], a[140:143], v[64:67]
buffer_load_dwordx4 v12, s[8:11], s24 offen offset:0 lds
v_mfma_f32_16x16x32_bf16 v[68:71], a[8:11], a[136:139], v[68:71]
ds_read_b64_tr_b16 a[130:131], v6 offset:2048
v_mfma_f32_16x16x32_bf16 v[68:71], a[12:15], a[140:143], v[68:71]
v_mfma_f32_16x16x32_bf16 v[72:75], a[16:19], a[136:139], v[72:75]
ds_read_b64_tr_b16 a[132:133], v6 offset:16384
v_mfma_f32_16x16x32_bf16 v[72:75], a[20:23], a[140:143], v[72:75]
buffer_load_dwordx4 v13, s[8:11], s24 offen offset:1024 lds
v_mfma_f32_16x16x32_bf16 v[76:79], a[24:27], a[136:139], v[76:79]
ds_read_b64_tr_b16 a[134:135], v6 offset:18432
v_mfma_f32_16x16x32_bf16 v[76:79], a[28:31], a[140:143], v[76:79]
v_mfma_f32_16x16x32_bf16 v[80:83], a[32:35], a[136:139], v[80:83]
ds_read_b128 a[76:79], v3 offset:34816
v_mfma_f32_16x16x32_bf16 v[80:83], a[36:39], a[140:143], v[80:83]
buffer_load_dwordx4 v14, s[8:11], s24 offen offset:2048 lds
v_mfma_f32_16x16x32_bf16 v[84:87], a[40:43], a[136:139], v[84:87]
v_mfma_f32_16x16x32_bf16 v[84:87], a[44:47], a[140:143], v[84:87]
v_mfma_f32_16x16x32_bf16 v[88:91], a[48:51], a[136:139], v[88:91]
ds_read_b128 a[80:83], v2 offset:36864
v_mfma_f32_16x16x32_bf16 v[88:91], a[52:55], a[140:143], v[88:91]
buffer_load_dwordx4 v15, s[8:11], s24 offen offset:3072 lds
v_mfma_f32_16x16x32_bf16 v[92:95], a[56:59], a[136:139], v[92:95]
s_add_u32 s24, s24, 128
ds_read_b128 a[84:87], v3 offset:36864
v_mfma_f32_16x16x32_bf16 v[92:95], a[60:63], a[140:143], v[92:95]
s_waitcnt lgkmcnt(3)
s_mov_b64 s[12:13], s[80:81]
v_mfma_f32_16x16x32_bf16 v[96:99], a[0:3], a[128:131], v[96:99]
s_mov_b32 s14, 3670016
s_add_u32 m0, s28, 16384
ds_read_b64_tr_b16 a[136:137], v7 offset:0
v_mfma_f32_16x16x32_bf16 v[96:99], a[4:7], a[132:135], v[96:99]
buffer_load_dwordx4 v12, s[8:11], s24 offen offset:0 lds
v_mfma_f32_16x16x32_bf16 v[100:103], a[8:11], a[128:131], v[100:103]
ds_read_b64_tr_b16 a[138:139], v7 offset:2048
v_mfma_f32_16x16x32_bf16 v[100:103], a[12:15], a[132:135], v[100:103]
v_mfma_f32_16x16x32_bf16 v[104:107], a[16:19], a[128:131], v[104:107]
ds_read_b64_tr_b16 a[140:141], v7 offset:16384
v_mfma_f32_16x16x32_bf16 v[104:107], a[20:23], a[132:135], v[104:107]
buffer_load_dwordx4 v13, s[8:11], s24 offen offset:1024 lds
v_mfma_f32_16x16x32_bf16 v[108:111], a[24:27], a[128:131], v[108:111]
ds_read_b64_tr_b16 a[142:143], v7 offset:18432
v_mfma_f32_16x16x32_bf16 v[108:111], a[28:31], a[132:135], v[108:111]
v_mfma_f32_16x16x32_bf16 v[112:115], a[32:35], a[128:131], v[112:115]
v_mfma_f32_16x16x32_bf16 v[112:115], a[36:39], a[132:135], v[112:115]
buffer_load_dwordx4 v14, s[8:11], s24 offen offset:2048 lds
v_mfma_f32_16x16x32_bf16 v[116:119], a[40:43], a[128:131], v[116:119]
ds_read_b128 a[88:91], v2 offset:38912
v_mfma_f32_16x16x32_bf16 v[116:119], a[44:47], a[132:135], v[116:119]
v_mfma_f32_16x16x32_bf16 v[120:123], a[48:51], a[128:131], v[120:123]
ds_read_b128 a[92:95], v3 offset:38912
v_mfma_f32_16x16x32_bf16 v[120:123], a[52:55], a[132:135], v[120:123]
buffer_load_dwordx4 v15, s[8:11], s24 offen offset:3072 lds
v_mfma_f32_16x16x32_bf16 v[124:127], a[56:59], a[128:131], v[124:127]
s_add_u32 s24, s24, 128
v_mfma_f32_16x16x32_bf16 v[124:127], a[60:63], a[132:135], v[124:127]
s_waitcnt lgkmcnt(2)
s_sub_u32 s26, s26, 8388608
v_mfma_f32_16x16x32_bf16 v[128:131], a[0:3], a[136:139], v[128:131]
s_sub_u32 s27, s27, 8388608
s_add_u32 m0, s29, 131072
ds_read_b64_tr_b16 a[128:129], v8 offset:0
v_mfma_f32_16x16x32_bf16 v[128:131], a[4:7], a[140:143], v[128:131]
buffer_load_dwordx4 v16, s[12:15], s26 offen offset:0 lds
v_mfma_f32_16x16x32_bf16 v[132:135], a[8:11], a[136:139], v[132:135]
ds_read_b64_tr_b16 a[130:131], v8 offset:2048
v_mfma_f32_16x16x32_bf16 v[132:135], a[12:15], a[140:143], v[132:135]
v_mfma_f32_16x16x32_bf16 v[136:139], a[16:19], a[136:139], v[136:139]
ds_read_b64_tr_b16 a[132:133], v8 offset:16384
v_mfma_f32_16x16x32_bf16 v[136:139], a[20:23], a[140:143], v[136:139]
buffer_load_dwordx4 v17, s[12:15], s26 offen offset:1024 lds
v_mfma_f32_16x16x32_bf16 v[140:143], a[24:27], a[136:139], v[140:143]
ds_read_b64_tr_b16 a[134:135], v8 offset:18432
v_mfma_f32_16x16x32_bf16 v[140:143], a[28:31], a[140:143], v[140:143]
v_mfma_f32_16x16x32_bf16 v[144:147], a[32:35], a[136:139], v[144:147]
ds_read_b128 a[96:99], v2 offset:40960
v_mfma_f32_16x16x32_bf16 v[144:147], a[36:39], a[140:143], v[144:147]
buffer_load_dwordx4 v18, s[12:15], s26 offen offset:2048 lds
v_mfma_f32_16x16x32_bf16 v[148:151], a[40:43], a[136:139], v[148:151]
v_mfma_f32_16x16x32_bf16 v[148:151], a[44:47], a[140:143], v[148:151]
v_mfma_f32_16x16x32_bf16 v[152:155], a[48:51], a[136:139], v[152:155]
ds_read_b128 a[100:103], v3 offset:40960
v_mfma_f32_16x16x32_bf16 v[152:155], a[52:55], a[140:143], v[152:155]
buffer_load_dwordx4 v19, s[12:15], s26 offen offset:3072 lds
v_mfma_f32_16x16x32_bf16 v[156:159], a[56:59], a[136:139], v[156:159]
s_add_u32 s26, s26, 524288
ds_read_b128 a[104:107], v2 offset:43008
v_mfma_f32_16x16x32_bf16 v[156:159], a[60:63], a[140:143], v[156:159]
s_waitcnt lgkmcnt(5)
v_mfma_f32_16x16x32_bf16 v[160:163], a[0:3], a[128:131], v[160:163]
s_waitcnt lgkmcnt(3)
s_add_u32 m0, s29, 147456
ds_read_b64_tr_b16 a[136:137], v9 offset:0
v_mfma_f32_16x16x32_bf16 v[160:163], a[4:7], a[132:135], v[160:163]
buffer_load_dwordx4 v16, s[12:15], s27 offen offset:0 lds
v_mfma_f32_16x16x32_bf16 v[164:167], a[8:11], a[128:131], v[164:167]
ds_read_b64_tr_b16 a[138:139], v9 offset:2048
v_mfma_f32_16x16x32_bf16 v[164:167], a[12:15], a[132:135], v[164:167]
v_mfma_f32_16x16x32_bf16 v[168:171], a[16:19], a[128:131], v[168:171]
ds_read_b64_tr_b16 a[140:141], v9 offset:16384
v_mfma_f32_16x16x32_bf16 v[168:171], a[20:23], a[132:135], v[168:171]
buffer_load_dwordx4 v17, s[12:15], s27 offen offset:1024 lds
v_mfma_f32_16x16x32_bf16 v[172:175], a[24:27], a[128:131], v[172:175]
ds_read_b64_tr_b16 a[142:143], v9 offset:18432
v_mfma_f32_16x16x32_bf16 v[172:175], a[28:31], a[132:135], v[172:175]
v_mfma_f32_16x16x32_bf16 v[176:179], a[32:35], a[128:131], v[176:179]
v_mfma_f32_16x16x32_bf16 v[176:179], a[36:39], a[132:135], v[176:179]
buffer_load_dwordx4 v18, s[12:15], s27 offen offset:2048 lds
v_mfma_f32_16x16x32_bf16 v[180:183], a[40:43], a[128:131], v[180:183]
ds_read_b128 a[108:111], v3 offset:43008
v_mfma_f32_16x16x32_bf16 v[180:183], a[44:47], a[132:135], v[180:183]
v_mfma_f32_16x16x32_bf16 v[184:187], a[48:51], a[128:131], v[184:187]
ds_read_b128 a[112:115], v2 offset:45056
v_mfma_f32_16x16x32_bf16 v[184:187], a[52:55], a[132:135], v[184:187]
buffer_load_dwordx4 v19, s[12:15], s27 offen offset:3072 lds
v_mfma_f32_16x16x32_bf16 v[188:191], a[56:59], a[128:131], v[188:191]
s_add_u32 s27, s27, 524288
v_mfma_f32_16x16x32_bf16 v[188:191], a[60:63], a[132:135], v[188:191]
s_waitcnt lgkmcnt(4)
v_mfma_f32_16x16x32_bf16 v[192:195], a[0:3], a[136:139], v[192:195]
s_waitcnt lgkmcnt(2)
ds_read_b64_tr_b16 a[128:129], v10 offset:0
v_mfma_f32_16x16x32_bf16 v[192:195], a[4:7], a[140:143], v[192:195]
v_mfma_f32_16x16x32_bf16 v[196:199], a[8:11], a[136:139], v[196:199]
ds_read_b64_tr_b16 a[130:131], v10 offset:2048
v_mfma_f32_16x16x32_bf16 v[196:199], a[12:15], a[140:143], v[196:199]
v_mfma_f32_16x16x32_bf16 v[200:203], a[16:19], a[136:139], v[200:203]
ds_read_b64_tr_b16 a[132:133], v10 offset:16384
v_mfma_f32_16x16x32_bf16 v[200:203], a[20:23], a[140:143], v[200:203]
v_mfma_f32_16x16x32_bf16 v[204:207], a[24:27], a[136:139], v[204:207]
ds_read_b64_tr_b16 a[134:135], v10 offset:18432
v_mfma_f32_16x16x32_bf16 v[204:207], a[28:31], a[140:143], v[204:207]
v_mfma_f32_16x16x32_bf16 v[208:211], a[32:35], a[136:139], v[208:211]
ds_read_b128 a[116:119], v3 offset:45056
v_mfma_f32_16x16x32_bf16 v[208:211], a[36:39], a[140:143], v[208:211]
v_mfma_f32_16x16x32_bf16 v[212:215], a[40:43], a[136:139], v[212:215]
ds_read_b128 a[120:123], v2 offset:47104
v_mfma_f32_16x16x32_bf16 v[212:215], a[44:47], a[140:143], v[212:215]
v_mfma_f32_16x16x32_bf16 v[216:219], a[48:51], a[136:139], v[216:219]
v_mfma_f32_16x16x32_bf16 v[216:219], a[52:55], a[140:143], v[216:219]
v_mfma_f32_16x16x32_bf16 v[220:223], a[56:59], a[136:139], v[220:223]
ds_read_b128 a[124:127], v3 offset:47104
v_mfma_f32_16x16x32_bf16 v[220:223], a[60:63], a[140:143], v[220:223]
s_waitcnt lgkmcnt(5)
v_mfma_f32_16x16x32_bf16 a[192:195], a[0:3], a[128:131], a[192:195]
s_waitcnt lgkmcnt(3)
ds_read_b64_tr_b16 a[136:137], v11 offset:0
v_mfma_f32_16x16x32_bf16 a[192:195], a[4:7], a[132:135], a[192:195]
v_mfma_f32_16x16x32_bf16 a[196:199], a[8:11], a[128:131], a[196:199]
ds_read_b64_tr_b16 a[138:139], v11 offset:2048
v_mfma_f32_16x16x32_bf16 a[196:199], a[12:15], a[132:135], a[196:199]
v_mfma_f32_16x16x32_bf16 a[200:203], a[16:19], a[128:131], a[200:203]
ds_read_b64_tr_b16 a[140:141], v11 offset:16384
v_mfma_f32_16x16x32_bf16 a[200:203], a[20:23], a[132:135], a[200:203]
v_mfma_f32_16x16x32_bf16 a[204:207], a[24:27], a[128:131], a[204:207]
ds_read_b64_tr_b16 a[142:143], v11 offset:18432
v_mfma_f32_16x16x32_bf16 a[204:207], a[28:31], a[132:135], a[204:207]
v_mfma_f32_16x16x32_bf16 a[208:211], a[32:35], a[128:131], a[208:211]
v_mfma_f32_16x16x32_bf16 a[208:211], a[36:39], a[132:135], a[208:211]
v_mfma_f32_16x16x32_bf16 a[212:215], a[40:43], a[128:131], a[212:215]
v_mfma_f32_16x16x32_bf16 a[212:215], a[44:47], a[132:135], a[212:215]
v_mfma_f32_16x16x32_bf16 a[216:219], a[48:51], a[128:131], a[216:219]
v_mfma_f32_16x16x32_bf16 a[216:219], a[52:55], a[132:135], a[216:219]
v_mfma_f32_16x16x32_bf16 a[220:223], a[56:59], a[128:131], a[220:223]
v_mfma_f32_16x16x32_bf16 a[220:223], a[60:63], a[132:135], a[220:223]
s_waitcnt vmcnt(12) lgkmcnt(0)
s_barrier
v_mfma_f32_16x16x32_bf16 a[224:227], a[0:3], a[136:139], a[224:227]
s_add_u32 m0, s28, 32768
ds_read_b64_tr_b16 a[128:129], v4 offset:32768
v_mfma_f32_16x16x32_bf16 a[224:227], a[4:7], a[140:143], a[224:227]
s_lshr_b32 s22, s3, 1
buffer_load_dwordx4 v12, s[8:11], s24 offen offset:0 lds
v_mfma_f32_16x16x32_bf16 a[228:231], a[8:11], a[136:139], a[228:231]
s_lshl_b32 s22, s22, 14
ds_read_b64_tr_b16 a[130:131], v4 offset:34816
v_subrev_u32 v2, s22, v2
v_mfma_f32_16x16x32_bf16 a[228:231], a[12:15], a[140:143], a[228:231]
v_subrev_u32 v3, s22, v3
v_mfma_f32_16x16x32_bf16 a[232:235], a[16:19], a[136:139], a[232:235]
ds_read_b64_tr_b16 a[132:133], v4 offset:49152
v_mfma_f32_16x16x32_bf16 a[232:235], a[20:23], a[140:143], a[232:235]
buffer_load_dwordx4 v13, s[8:11], s24 offen offset:1024 lds
v_mfma_f32_16x16x32_bf16 a[236:239], a[24:27], a[136:139], a[236:239]
ds_read_b64_tr_b16 a[134:135], v4 offset:51200
v_mfma_f32_16x16x32_bf16 a[236:239], a[28:31], a[140:143], a[236:239]
v_mfma_f32_16x16x32_bf16 a[240:243], a[32:35], a[136:139], a[240:243]
v_mfma_f32_16x16x32_bf16 a[240:243], a[36:39], a[140:143], a[240:243]
buffer_load_dwordx4 v14, s[8:11], s24 offen offset:2048 lds
v_mfma_f32_16x16x32_bf16 a[244:247], a[40:43], a[136:139], a[244:247]
v_mfma_f32_16x16x32_bf16 a[244:247], a[44:47], a[140:143], a[244:247]
v_mfma_f32_16x16x32_bf16 a[248:251], a[48:51], a[136:139], a[248:251]
v_mfma_f32_16x16x32_bf16 a[248:251], a[52:55], a[140:143], a[248:251]
buffer_load_dwordx4 v15, s[8:11], s24 offen offset:3072 lds
v_mfma_f32_16x16x32_bf16 a[252:255], a[56:59], a[136:139], a[252:255]
s_add_u32 s24, s24, 128
v_mfma_f32_16x16x32_bf16 a[252:255], a[60:63], a[140:143], a[252:255]
s_waitcnt lgkmcnt(2)
v_mfma_f32_16x16x32_bf16 v[32:35], a[64:67], a[128:131], v[32:35]
s_waitcnt lgkmcnt(0)
s_add_u32 m0, s29, 65536
ds_read_b64_tr_b16 a[136:137], v5 offset:32768
v_mfma_f32_16x16x32_bf16 v[32:35], a[68:71], a[132:135], v[32:35]
buffer_load_dwordx4 v16, s[12:15], s26 offen offset:0 lds
v_mfma_f32_16x16x32_bf16 v[36:39], a[72:75], a[128:131], v[36:39]
ds_read_b64_tr_b16 a[138:139], v5 offset:34816
v_mfma_f32_16x16x32_bf16 v[36:39], a[76:79], a[132:135], v[36:39]
v_mfma_f32_16x16x32_bf16 v[40:43], a[80:83], a[128:131], v[40:43]
ds_read_b64_tr_b16 a[140:141], v5 offset:49152
v_mfma_f32_16x16x32_bf16 v[40:43], a[84:87], a[132:135], v[40:43]
buffer_load_dwordx4 v17, s[12:15], s26 offen offset:1024 lds
v_mfma_f32_16x16x32_bf16 v[44:47], a[88:91], a[128:131], v[44:47]
ds_read_b64_tr_b16 a[142:143], v5 offset:51200
v_mfma_f32_16x16x32_bf16 v[44:47], a[92:95], a[132:135], v[44:47]
v_mfma_f32_16x16x32_bf16 v[48:51], a[96:99], a[128:131], v[48:51]
ds_read_b128 a[0:3], v2 offset:0
v_cvt_pk_bf16_f32 v32, v32, v33
v_mfma_f32_16x16x32_bf16 v[48:51], a[100:103], a[132:135], v[48:51]
buffer_load_dwordx4 v18, s[12:15], s26 offen offset:2048 lds
v_mfma_f32_16x16x32_bf16 v[52:55], a[104:107], a[128:131], v[52:55]
ds_read_b128 a[4:7], v3 offset:0
v_cvt_pk_bf16_f32 v33, v34, v35
v_mfma_f32_16x16x32_bf16 v[52:55], a[108:111], a[132:135], v[52:55]
v_cvt_pk_bf16_f32 v34, v36, v37
v_cvt_pk_bf16_f32 v35, v38, v39
v_mfma_f32_16x16x32_bf16 v[56:59], a[112:115], a[128:131], v[56:59]
v_cvt_pk_bf16_f32 v40, v40, v41
v_cvt_pk_bf16_f32 v41, v42, v43
v_mfma_f32_16x16x32_bf16 v[56:59], a[116:119], a[132:135], v[56:59]
buffer_load_dwordx4 v19, s[12:15], s26 offen offset:3072 lds
v_mfma_f32_16x16x32_bf16 v[60:63], a[120:123], a[128:131], v[60:63]
s_add_u32 s26, s26, 524288
ds_read_b128 a[8:11], v2 offset:2048
v_cvt_pk_bf16_f32 v42, v44, v45
v_mfma_f32_16x16x32_bf16 v[60:63], a[124:127], a[132:135], v[60:63]
s_waitcnt lgkmcnt(3)
v_cvt_pk_bf16_f32 v43, v46, v47
v_mfma_f32_16x16x32_bf16 v[64:67], a[64:67], a[136:139], v[64:67]
s_add_u32 m0, s29, 81920
ds_read_b64_tr_b16 a[128:129], v6 offset:32768
v_cvt_pk_bf16_f32 v48, v48, v49
v_mfma_f32_16x16x32_bf16 v[64:67], a[68:71], a[140:143], v[64:67]
buffer_load_dwordx4 v16, s[12:15], s27 offen offset:0 lds
v_mfma_f32_16x16x32_bf16 v[68:71], a[72:75], a[136:139], v[68:71]
ds_read_b64_tr_b16 a[130:131], v6 offset:34816
v_cvt_pk_bf16_f32 v49, v50, v51
v_mfma_f32_16x16x32_bf16 v[68:71], a[76:79], a[140:143], v[68:71]
v_cvt_pk_bf16_f32 v50, v52, v53
v_cvt_pk_bf16_f32 v51, v54, v55
v_mfma_f32_16x16x32_bf16 v[72:75], a[80:83], a[136:139], v[72:75]
ds_read_b64_tr_b16 a[132:133], v6 offset:49152
v_cvt_pk_bf16_f32 v56, v56, v57
v_mfma_f32_16x16x32_bf16 v[72:75], a[84:87], a[140:143], v[72:75]
buffer_load_dwordx4 v17, s[12:15], s27 offen offset:1024 lds
v_mfma_f32_16x16x32_bf16 v[76:79], a[88:91], a[136:139], v[76:79]
ds_read_b64_tr_b16 a[134:135], v6 offset:51200
v_cvt_pk_bf16_f32 v57, v58, v59
v_mfma_f32_16x16x32_bf16 v[76:79], a[92:95], a[140:143], v[76:79]
v_cvt_pk_bf16_f32 v58, v60, v61
v_cvt_pk_bf16_f32 v59, v62, v63
v_mfma_f32_16x16x32_bf16 v[80:83], a[96:99], a[136:139], v[80:83]
ds_read_b128 a[12:15], v3 offset:2048
v_cvt_pk_bf16_f32 v64, v64, v65
v_mfma_f32_16x16x32_bf16 v[80:83], a[100:103], a[140:143], v[80:83]
buffer_load_dwordx4 v18, s[12:15], s27 offen offset:2048 lds
v_mfma_f32_16x16x32_bf16 v[84:87], a[104:107], a[136:139], v[84:87]
v_cvt_pk_bf16_f32 v65, v66, v67
v_cvt_pk_bf16_f32 v66, v68, v69
v_mfma_f32_16x16x32_bf16 v[84:87], a[108:111], a[140:143], v[84:87]
v_cvt_pk_bf16_f32 v67, v70, v71
v_mfma_f32_16x16x32_bf16 v[88:91], a[112:115], a[136:139], v[88:91]
ds_read_b128 a[16:19], v2 offset:4096
v_cvt_pk_bf16_f32 v72, v72, v73
v_mfma_f32_16x16x32_bf16 v[88:91], a[116:119], a[140:143], v[88:91]
buffer_load_dwordx4 v19, s[12:15], s27 offen offset:3072 lds
v_mfma_f32_16x16x32_bf16 v[92:95], a[120:123], a[136:139], v[92:95]
s_add_u32 s27, s27, 524288
ds_read_b128 a[20:23], v3 offset:4096
v_cvt_pk_bf16_f32 v73, v74, v75
v_mfma_f32_16x16x32_bf16 v[92:95], a[124:127], a[140:143], v[92:95]
s_waitcnt lgkmcnt(3)
v_cvt_pk_bf16_f32 v74, v76, v77
v_cvt_pk_bf16_f32 v75, v78, v79
v_mfma_f32_16x16x32_bf16 v[96:99], a[64:67], a[128:131], v[96:99]
s_add_u32 m0, s28, 49152
ds_read_b64_tr_b16 a[136:137], v7 offset:32768
v_cvt_pk_bf16_f32 v80, v80, v81
v_mfma_f32_16x16x32_bf16 v[96:99], a[68:71], a[132:135], v[96:99]
buffer_load_dwordx4 v12, s[8:11], s24 offen offset:0 lds
v_mfma_f32_16x16x32_bf16 v[100:103], a[72:75], a[128:131], v[100:103]
ds_read_b64_tr_b16 a[138:139], v7 offset:34816
v_cvt_pk_bf16_f32 v81, v82, v83
v_mfma_f32_16x16x32_bf16 v[100:103], a[76:79], a[132:135], v[100:103]
v_cvt_pk_bf16_f32 v82, v84, v85
v_cvt_pk_bf16_f32 v83, v86, v87
v_mfma_f32_16x16x32_bf16 v[104:107], a[80:83], a[128:131], v[104:107]
ds_read_b64_tr_b16 a[140:141], v7 offset:49152
v_cvt_pk_bf16_f32 v88, v88, v89
v_mfma_f32_16x16x32_bf16 v[104:107], a[84:87], a[132:135], v[104:107]
buffer_load_dwordx4 v13, s[8:11], s24 offen offset:1024 lds
v_mfma_f32_16x16x32_bf16 v[108:111], a[88:91], a[128:131], v[108:111]
ds_read_b64_tr_b16 a[142:143], v7 offset:51200
v_cvt_pk_bf16_f32 v89, v90, v91
v_mfma_f32_16x16x32_bf16 v[108:111], a[92:95], a[132:135], v[108:111]
v_cvt_pk_bf16_f32 v90, v92, v93
v_cvt_pk_bf16_f32 v91, v94, v95
v_mfma_f32_16x16x32_bf16 v[112:115], a[96:99], a[128:131], v[112:115]
v_cvt_pk_bf16_f32 v96, v96, v97
v_cvt_pk_bf16_f32 v97, v98, v99
v_mfma_f32_16x16x32_bf16 v[112:115], a[100:103], a[132:135], v[112:115]
buffer_load_dwordx4 v14, s[8:11], s24 offen offset:2048 lds
v_mfma_f32_16x16x32_bf16 v[116:119], a[104:107], a[128:131], v[116:119]
ds_read_b128 a[24:27], v2 offset:6144
v_cvt_pk_bf16_f32 v98, v100, v101
v_mfma_f32_16x16x32_bf16 v[116:119], a[108:111], a[132:135], v[116:119]
buffer_store_dwordx4 v[32:35], v1, s[4:7], s31 offen sc1
v_mfma_f32_16x16x32_bf16 v[120:123], a[112:115], a[128:131], v[120:123]
s_add_u32 s31, s31, s32
ds_read_b128 a[28:31], v3 offset:6144
v_cvt_pk_bf16_f32 v99, v102, v103
v_mfma_f32_16x16x32_bf16 v[120:123], a[116:119], a[132:135], v[120:123]
buffer_load_dwordx4 v15, s[8:11], s24 offen offset:3072 lds
v_mfma_f32_16x16x32_bf16 v[124:127], a[120:123], a[128:131], v[124:127]
s_add_u32 s24, s24, 128
v_cvt_pk_bf16_f32 v104, v104, v105
v_cvt_pk_bf16_f32 v105, v106, v107
v_mfma_f32_16x16x32_bf16 v[124:127], a[124:127], a[132:135], v[124:127]
s_waitcnt lgkmcnt(4)
v_cvt_pk_bf16_f32 v106, v108, v109
v_cvt_pk_bf16_f32 v107, v110, v111
v_mfma_f32_16x16x32_bf16 v[128:131], a[64:67], a[136:139], v[128:131]
s_waitcnt lgkmcnt(2)
ds_read_b64_tr_b16 a[128:129], v8 offset:32768
v_cvt_pk_bf16_f32 v112, v112, v113
v_mfma_f32_16x16x32_bf16 v[128:131], a[68:71], a[140:143], v[128:131]
v_cvt_pk_bf16_f32 v113, v114, v115
v_cvt_pk_bf16_f32 v114, v116, v117
v_mfma_f32_16x16x32_bf16 v[132:135], a[72:75], a[136:139], v[132:135]
ds_read_b64_tr_b16 a[130:131], v8 offset:34816
v_cvt_pk_bf16_f32 v115, v118, v119
v_mfma_f32_16x16x32_bf16 v[132:135], a[76:79], a[140:143], v[132:135]
v_mfma_f32_16x16x32_bf16 v[136:139], a[80:83], a[136:139], v[136:139]
ds_read_b64_tr_b16 a[132:133], v8 offset:49152
v_cvt_pk_bf16_f32 v120, v120, v121
v_mfma_f32_16x16x32_bf16 v[136:139], a[84:87], a[140:143], v[136:139]
v_cvt_pk_bf16_f32 v121, v122, v123
v_cvt_pk_bf16_f32 v122, v124, v125
v_mfma_f32_16x16x32_bf16 v[140:143], a[88:91], a[136:139], v[140:143]
ds_read_b64_tr_b16 a[134:135], v8 offset:51200
v_cvt_pk_bf16_f32 v123, v126, v127
v_mfma_f32_16x16x32_bf16 v[140:143], a[92:95], a[140:143], v[140:143]
buffer_store_dwordx4 v[40:43], v1, s[4:7], s31 offen sc1
v_mfma_f32_16x16x32_bf16 v[144:147], a[96:99], a[136:139], v[144:147]
s_add_u32 s31, s31, s33
ds_read_b128 a[32:35], v2 offset:8192
v_cvt_pk_bf16_f32 v128, v128, v129
v_mfma_f32_16x16x32_bf16 v[144:147], a[100:103], a[140:143], v[144:147]
v_cvt_pk_bf16_f32 v129, v130, v131
v_cvt_pk_bf16_f32 v130, v132, v133
v_mfma_f32_16x16x32_bf16 v[148:151], a[104:107], a[136:139], v[148:151]
v_cvt_pk_bf16_f32 v131, v134, v135
v_mfma_f32_16x16x32_bf16 v[148:151], a[108:111], a[140:143], v[148:151]
v_mfma_f32_16x16x32_bf16 v[152:155], a[112:115], a[136:139], v[152:155]
ds_read_b128 a[36:39], v3 offset:8192
v_cvt_pk_bf16_f32 v136, v136, v137
v_mfma_f32_16x16x32_bf16 v[152:155], a[116:119], a[140:143], v[152:155]
v_cvt_pk_bf16_f32 v137, v138, v139
v_cvt_pk_bf16_f32 v138, v140, v141
v_mfma_f32_16x16x32_bf16 v[156:159], a[120:123], a[136:139], v[156:159]
ds_read_b128 a[40:43], v2 offset:10240
v_cvt_pk_bf16_f32 v139, v142, v143
v_mfma_f32_16x16x32_bf16 v[156:159], a[124:127], a[140:143], v[156:159]
s_waitcnt lgkmcnt(5)
v_mfma_f32_16x16x32_bf16 v[160:163], a[64:67], a[128:131], v[160:163]
s_waitcnt lgkmcnt(3)
ds_read_b64_tr_b16 a[136:137], v9 offset:32768
v_cvt_pk_bf16_f32 v144, v144, v145
v_mfma_f32_16x16x32_bf16 v[160:163], a[68:71], a[132:135], v[160:163]
v_cvt_pk_bf16_f32 v145, v146, v147
v_cvt_pk_bf16_f32 v146, v148, v149
v_mfma_f32_16x16x32_bf16 v[164:167], a[72:75], a[128:131], v[164:167]
ds_read_b64_tr_b16 a[138:139], v9 offset:34816
v_cvt_pk_bf16_f32 v147, v150, v151
v_mfma_f32_16x16x32_bf16 v[164:167], a[76:79], a[132:135], v[164:167]
v_mfma_f32_16x16x32_bf16 v[168:171], a[80:83], a[128:131], v[168:171]
ds_read_b64_tr_b16 a[140:141], v9 offset:49152
v_cvt_pk_bf16_f32 v152, v152, v153
v_mfma_f32_16x16x32_bf16 v[168:171], a[84:87], a[132:135], v[168:171]
buffer_store_dwordx4 v[48:51], v1, s[4:7], s31 offen sc1
v_mfma_f32_16x16x32_bf16 v[172:175], a[88:91], a[128:131], v[172:175]
s_add_u32 s31, s31, s32
ds_read_b64_tr_b16 a[142:143], v9 offset:51200
v_cvt_pk_bf16_f32 v153, v154, v155
v_mfma_f32_16x16x32_bf16 v[172:175], a[92:95], a[132:135], v[172:175]
v_cvt_pk_bf16_f32 v154, v156, v157
v_cvt_pk_bf16_f32 v155, v158, v159
v_mfma_f32_16x16x32_bf16 v[176:179], a[96:99], a[128:131], v[176:179]
v_cvt_pk_bf16_f32 v160, v160, v161
v_cvt_pk_bf16_f32 v161, v162, v163
v_mfma_f32_16x16x32_bf16 v[176:179], a[100:103], a[132:135], v[176:179]
v_cvt_pk_bf16_f32 v162, v164, v165
v_cvt_pk_bf16_f32 v163, v166, v167
v_mfma_f32_16x16x32_bf16 v[180:183], a[104:107], a[128:131], v[180:183]
ds_read_b128 a[44:47], v3 offset:10240
v_mfma_f32_16x16x32_bf16 v[180:183], a[108:111], a[132:135], v[180:183]
v_mfma_f32_16x16x32_bf16 v[184:187], a[112:115], a[128:131], v[184:187]
ds_read_b128 a[48:51], v2 offset:12288
v_cvt_pk_bf16_f32 v168, v168, v169
v_mfma_f32_16x16x32_bf16 v[184:187], a[116:119], a[132:135], v[184:187]
v_cvt_pk_bf16_f32 v169, v170, v171
v_cvt_pk_bf16_f32 v170, v172, v173
v_mfma_f32_16x16x32_bf16 v[188:191], a[120:123], a[128:131], v[188:191]
v_cvt_pk_bf16_f32 v171, v174, v175
v_mfma_f32_16x16x32_bf16 v[188:191], a[124:127], a[132:135], v[188:191]
s_waitcnt lgkmcnt(4)
v_mfma_f32_16x16x32_bf16 v[192:195], a[64:67], a[136:139], v[192:195]
s_waitcnt lgkmcnt(2)
ds_read_b64_tr_b16 a[128:129], v10 offset:32768
v_cvt_pk_bf16_f32 v176, v176, v177
v_mfma_f32_16x16x32_bf16 v[192:195], a[68:71], a[140:143], v[192:195]
v_cvt_pk_bf16_f32 v177, v178, v179
v_cvt_pk_bf16_f32 v178, v180, v181
v_mfma_f32_16x16x32_bf16 v[196:199], a[72:75], a[136:139], v[196:199]
ds_read_b64_tr_b16 a[130:131], v10 offset:34816
v_cvt_pk_bf16_f32 v179, v182, v183
v_mfma_f32_16x16x32_bf16 v[196:199], a[76:79], a[140:143], v[196:199]
buffer_store_dwordx4 v[56:59], v1, s[4:7], s31 offen sc1
v_mfma_f32_16x16x32_bf16 v[200:203], a[80:83], a[136:139], v[200:203]
s_add_u32 s31, s31, s34
ds_read_b64_tr_b16 a[132:133], v10 offset:49152
v_cvt_pk_bf16_f32 v184, v184, v185
v_mfma_f32_16x16x32_bf16 v[200:203], a[84:87], a[140:143], v[200:203]
v_cvt_pk_bf16_f32 v185, v186, v187
v_cvt_pk_bf16_f32 v186, v188, v189
v_mfma_f32_16x16x32_bf16 v[204:207], a[88:91], a[136:139], v[204:207]
ds_read_b64_tr_b16 a[134:135], v10 offset:51200
v_cvt_pk_bf16_f32 v187, v190, v191
v_mfma_f32_16x16x32_bf16 v[204:207], a[92:95], a[140:143], v[204:207]
v_mfma_f32_16x16x32_bf16 v[208:211], a[96:99], a[136:139], v[208:211]
ds_read_b128 a[52:55], v3 offset:12288
v_cvt_pk_bf16_f32 v192, v192, v193
v_mfma_f32_16x16x32_bf16 v[208:211], a[100:103], a[140:143], v[208:211]
v_cvt_pk_bf16_f32 v193, v194, v195
v_cvt_pk_bf16_f32 v194, v196, v197
v_mfma_f32_16x16x32_bf16 v[212:215], a[104:107], a[136:139], v[212:215]
ds_read_b128 a[56:59], v2 offset:14336
v_cvt_pk_bf16_f32 v195, v198, v199
v_mfma_f32_16x16x32_bf16 v[212:215], a[108:111], a[140:143], v[212:215]
v_mfma_f32_16x16x32_bf16 v[216:219], a[112:115], a[136:139], v[216:219]
v_cvt_pk_bf16_f32 v200, v200, v201
v_cvt_pk_bf16_f32 v201, v202, v203
v_mfma_f32_16x16x32_bf16 v[216:219], a[116:119], a[140:143], v[216:219]
v_cvt_pk_bf16_f32 v202, v204, v205
v_cvt_pk_bf16_f32 v203, v206, v207
v_mfma_f32_16x16x32_bf16 v[220:223], a[120:123], a[136:139], v[220:223]
ds_read_b128 a[60:63], v3 offset:14336
v_mfma_f32_16x16x32_bf16 v[220:223], a[124:127], a[140:143], v[220:223]
s_waitcnt lgkmcnt(5)
v_mfma_f32_16x16x32_bf16 a[192:195], a[64:67], a[128:131], a[192:195]
s_waitcnt lgkmcnt(3)
ds_read_b64_tr_b16 a[136:137], v11 offset:32768
v_cvt_pk_bf16_f32 v208, v208, v209
v_mfma_f32_16x16x32_bf16 a[192:195], a[68:71], a[132:135], a[192:195]
buffer_store_dwordx4 v[64:67], v1, s[4:7], s31 offen sc1
v_mfma_f32_16x16x32_bf16 a[196:199], a[72:75], a[128:131], a[196:199]
s_add_u32 s31, s31, s32
ds_read_b64_tr_b16 a[138:139], v11 offset:34816
v_cvt_pk_bf16_f32 v209, v210, v211
v_mfma_f32_16x16x32_bf16 a[196:199], a[76:79], a[132:135], a[196:199]
v_cvt_pk_bf16_f32 v210, v212, v213
v_cvt_pk_bf16_f32 v211, v214, v215
v_mfma_f32_16x16x32_bf16 a[200:203], a[80:83], a[128:131], a[200:203]
ds_read_b64_tr_b16 a[140:141], v11 offset:49152
v_cvt_pk_bf16_f32 v216, v216, v217
v_mfma_f32_16x16x32_bf16 a[200:203], a[84:87], a[132:135], a[200:203]
v_cvt_pk_bf16_f32 v217, v218, v219
v_cvt_pk_bf16_f32 v218, v220, v221
v_mfma_f32_16x16x32_bf16 a[204:207], a[88:91], a[128:131], a[204:207]
ds_read_b64_tr_b16 a[142:143], v11 offset:51200
v_cvt_pk_bf16_f32 v219, v222, v223
v_mfma_f32_16x16x32_bf16 a[204:207], a[92:95], a[132:135], a[204:207]
v_mfma_f32_16x16x32_bf16 a[208:211], a[96:99], a[128:131], a[208:211]
v_mfma_f32_16x16x32_bf16 a[208:211], a[100:103], a[132:135], a[208:211]
v_mfma_f32_16x16x32_bf16 a[212:215], a[104:107], a[128:131], a[212:215]
v_mfma_f32_16x16x32_bf16 a[212:215], a[108:111], a[132:135], a[212:215]
v_mfma_f32_16x16x32_bf16 a[216:219], a[112:115], a[128:131], a[216:219]
v_mfma_f32_16x16x32_bf16 a[216:219], a[116:119], a[132:135], a[216:219]
v_mfma_f32_16x16x32_bf16 a[220:223], a[120:123], a[128:131], a[220:223]
v_mfma_f32_16x16x32_bf16 a[220:223], a[124:127], a[132:135], a[220:223]
s_waitcnt vmcnt(21) lgkmcnt(0)
s_barrier
v_mfma_f32_16x16x32_bf16 a[224:227], a[64:67], a[136:139], a[224:227]
s_add_u32 m0, s29, 98304
ds_read_b64_tr_b16 a[128:129], v22 offset:0
v_mfma_f32_16x16x32_bf16 a[224:227], a[68:71], a[140:143], a[224:227]
buffer_load_dwordx4 v16, s[12:15], s26 offen offset:0 lds
v_mfma_f32_16x16x32_bf16 a[228:231], a[72:75], a[136:139], a[228:231]
ds_read_b64_tr_b16 a[130:131], v22 offset:2048
v_mfma_f32_16x16x32_bf16 a[228:231], a[76:79], a[140:143], a[228:231]
buffer_store_dwordx4 v[72:75], v1, s[4:7], s31 offen sc1
v_mfma_f32_16x16x32_bf16 a[232:235], a[80:83], a[136:139], a[232:235]
s_add_u32 s31, s31, s33
ds_read_b64_tr_b16 a[132:133], v22 offset:16384
v_mfma_f32_16x16x32_bf16 a[232:235], a[84:87], a[140:143], a[232:235]
buffer_load_dwordx4 v17, s[12:15], s26 offen offset:1024 lds
v_mfma_f32_16x16x32_bf16 a[236:239], a[88:91], a[136:139], a[236:239]
ds_read_b64_tr_b16 a[134:135], v22 offset:18432
v_add_u32 v22, 4294901760, v22
v_mfma_f32_16x16x32_bf16 a[236:239], a[92:95], a[140:143], a[236:239]
v_mfma_f32_16x16x32_bf16 a[240:243], a[96:99], a[136:139], a[240:243]
v_mfma_f32_16x16x32_bf16 a[240:243], a[100:103], a[140:143], a[240:243]
buffer_load_dwordx4 v18, s[12:15], s26 offen offset:2048 lds
v_mfma_f32_16x16x32_bf16 a[244:247], a[104:107], a[136:139], a[244:247]
v_mfma_f32_16x16x32_bf16 a[244:247], a[108:111], a[140:143], a[244:247]
v_mfma_f32_16x16x32_bf16 a[248:251], a[112:115], a[136:139], a[248:251]
v_mfma_f32_16x16x32_bf16 a[248:251], a[116:119], a[140:143], a[248:251]
buffer_load_dwordx4 v19, s[12:15], s26 offen offset:3072 lds
v_mfma_f32_16x16x32_bf16 a[252:255], a[120:123], a[136:139], a[252:255]
s_add_u32 s26, s26, 524288
v_mfma_f32_16x16x32_bf16 a[252:255], a[124:127], a[140:143], a[252:255]
s_waitcnt lgkmcnt(2)
M_Q:
v_mfma_f32_16x16x32_bf16 v[36:39], a[128:131], a[0:3], 0
s_waitcnt lgkmcnt(0)
s_add_u32 m0, s29, 114688
ds_read_b64_tr_b16 a[136:137], v23 offset:0
v_mfma_f32_16x16x32_bf16 v[36:39], a[132:135], a[4:7], v[36:39]
buffer_load_dwordx4 v16, s[12:15], s27 offen offset:0 lds
v_mfma_f32_16x16x32_bf16 v[44:47], a[128:131], a[8:11], 0
ds_read_b64_tr_b16 a[138:139], v23 offset:2048
v_mfma_f32_16x16x32_bf16 v[44:47], a[132:135], a[12:15], v[44:47]
ds_read_b128 a[64:67], v2 offset:16384
ds_read_b128 a[68:71], v3 offset:16384
v_mfma_f32_16x16x32_bf16 v[52:55], a[128:131], a[16:19], 0
ds_read_b64_tr_b16 a[140:141], v23 offset:16384
v_mfma_f32_16x16x32_bf16 v[52:55], a[132:135], a[20:23], v[52:55]
buffer_load_dwordx4 v17, s[12:15], s27 offen offset:1024 lds
v_mfma_f32_16x16x32_bf16 v[60:63], a[128:131], a[24:27], 0
ds_read_b64_tr_b16 a[142:143], v23 offset:18432
v_add_u32 v23, 4294901760, v23
v_mfma_f32_16x16x32_bf16 v[60:63], a[132:135], a[28:31], v[60:63]
buffer_store_dwordx4 v[80:83], v1, s[4:7], s31 offen sc1
v_mfma_f32_16x16x32_bf16 v[68:71], a[128:131], a[32:35], 0
s_add_u32 s31, s31, s32
ds_read_b128 a[72:75], v2 offset:18432
v_mfma_f32_16x16x32_bf16 v[68:71], a[132:135], a[36:39], v[68:71]
buffer_load_dwordx4 v18, s[12:15], s27 offen offset:2048 lds
v_mfma_f32_16x16x32_bf16 v[76:79], a[128:131], a[40:43], 0
ds_read_b128 a[76:79], v3 offset:18432
v_mfma_f32_16x16x32_bf16 v[76:79], a[132:135], a[44:47], v[76:79]
ds_read_b128 a[80:83], v2 offset:20480
v_mfma_f32_16x16x32_bf16 v[84:87], a[128:131], a[48:51], 0
ds_read_b128 a[84:87], v3 offset:20480
v_mfma_f32_16x16x32_bf16 v[84:87], a[132:135], a[52:55], v[84:87]
buffer_load_dwordx4 v19, s[12:15], s27 offen offset:3072 lds
v_mfma_f32_16x16x32_bf16 v[92:95], a[128:131], a[56:59], 0
s_add_u32 s27, s27, 524288
ds_read_b128 a[88:91], v2 offset:22528
v_mfma_f32_16x16x32_bf16 v[92:95], a[132:135], a[60:63], v[92:95]
s_waitcnt lgkmcnt(9)
buffer_store_dwordx4 v[88:91], v1, s[4:7], s31 offen sc1
v_mfma_f32_16x16x32_bf16 v[100:103], a[136:139], a[0:3], 0
s_waitcnt lgkmcnt(5)
s_add_u32 m0, s28, 0
ds_read_b64_tr_b16 a[128:129], v24 offset:0
v_mfma_f32_16x16x32_bf16 v[100:103], a[140:143], a[4:7], v[100:103]
s_add_u32 s31, s31, s35
buffer_load_dwordx4 v12, s[8:11], s24 offen offset:0 lds
v_mfma_f32_16x16x32_bf16 v[108:111], a[136:139], a[8:11], 0
ds_read_b64_tr_b16 a[130:131], v24 offset:2048
v_mfma_f32_16x16x32_bf16 v[108:111], a[140:143], a[12:15], v[108:111]
ds_read_b128 a[92:95], v3 offset:22528
v_mfma_f32_16x16x32_bf16 v[116:119], a[136:139], a[16:19], 0
ds_read_b64_tr_b16 a[132:133], v24 offset:16384
v_mfma_f32_16x16x32_bf16 v[116:119], a[140:143], a[20:23], v[116:119]
buffer_load_dwordx4 v13, s[8:11], s24 offen offset:1024 lds
v_mfma_f32_16x16x32_bf16 v[124:127], a[136:139], a[24:27], 0
ds_read_b64_tr_b16 a[134:135], v24 offset:18432
v_add_u32 v24, 4294901760, v24
v_mfma_f32_16x16x32_bf16 v[124:127], a[140:143], a[28:31], v[124:127]
v_mfma_f32_16x16x32_bf16 v[132:135], a[136:139], a[32:35], 0
ds_read_b128 a[96:99], v2 offset:24576
v_mfma_f32_16x16x32_bf16 v[132:135], a[140:143], a[36:39], v[132:135]
buffer_load_dwordx4 v14, s[8:11], s24 offen offset:2048 lds
v_mfma_f32_16x16x32_bf16 v[140:143], a[136:139], a[40:43], 0
ds_read_b128 a[100:103], v3 offset:24576
v_mfma_f32_16x16x32_bf16 v[140:143], a[140:143], a[44:47], v[140:143]
ds_read_b128 a[104:107], v2 offset:26624
v_mfma_f32_16x16x32_bf16 v[148:151], a[136:139], a[48:51], 0
ds_read_b128 a[108:111], v3 offset:26624
v_mfma_f32_16x16x32_bf16 v[148:151], a[140:143], a[52:55], v[148:151]
buffer_load_dwordx4 v15, s[8:11], s24 offen offset:3072 lds
v_mfma_f32_16x16x32_bf16 v[156:159], a[136:139], a[56:59], 0
s_add_u32 s24, s24, 128
ds_read_b128 a[112:115], v2 offset:28672
v_mfma_f32_16x16x32_bf16 v[156:159], a[140:143], a[60:63], v[156:159]
s_waitcnt lgkmcnt(8)
buffer_store_dwordx4 v[96:99], v1, s[4:7], s31 offen sc1
v_mfma_f32_16x16x32_bf16 v[164:167], a[128:131], a[0:3], 0
s_waitcnt lgkmcnt(5)
s_add_u32 s31, s31, s32
ds_read_b64_tr_b16 a[136:137], v25 offset:0
v_mfma_f32_16x16x32_bf16 v[164:167], a[132:135], a[4:7], v[164:167]
v_mfma_f32_16x16x32_bf16 v[172:175], a[128:131], a[8:11], 0
ds_read_b64_tr_b16 a[138:139], v25 offset:2048
v_mfma_f32_16x16x32_bf16 v[172:175], a[132:135], a[12:15], v[172:175]
ds_read_b128 a[116:119], v3 offset:28672
v_mfma_f32_16x16x32_bf16 v[180:183], a[128:131], a[16:19], 0
ds_read_b64_tr_b16 a[140:141], v25 offset:16384
v_mfma_f32_16x16x32_bf16 v[180:183], a[132:135], a[20:23], v[180:183]
buffer_store_dwordx4 v[104:107], v1, s[4:7], s31 offen sc1
v_mfma_f32_16x16x32_bf16 v[188:191], a[128:131], a[24:27], 0
s_add_u32 s31, s31, s33
ds_read_b64_tr_b16 a[142:143], v25 offset:18432
v_add_u32 v25, 4294901760, v25
v_mfma_f32_16x16x32_bf16 v[188:191], a[132:135], a[28:31], v[188:191]
v_mfma_f32_16x16x32_bf16 v[196:199], a[128:131], a[32:35], 0
ds_read_b128 a[120:123], v2 offset:30720
v_mfma_f32_16x16x32_bf16 v[196:199], a[132:135], a[36:39], v[196:199]
v_mfma_f32_16x16x32_bf16 v[204:207], a[128:131], a[40:43], 0
ds_read_b128 a[124:127], v3 offset:30720
v_mfma_f32_16x16x32_bf16 v[204:207], a[132:135], a[44:47], v[204:207]
v_mfma_f32_16x16x32_bf16 v[212:215], a[128:131], a[48:51], 0
v_mfma_f32_16x16x32_bf16 v[212:215], a[132:135], a[52:55], v[212:215]
v_mfma_f32_16x16x32_bf16 v[220:223], a[128:131], a[56:59], 0
v_mfma_f32_16x16x32_bf16 v[220:223], a[132:135], a[60:63], v[220:223]
s_waitcnt vmcnt(26) lgkmcnt(0)
s_barrier
v_mfma_f32_16x16x32_bf16 v[224:227], a[136:139], a[0:3], 0
s_add_u32 m0, s29, 131072
ds_read_b64_tr_b16 a[128:129], v22 offset:0
v_mfma_f32_16x16x32_bf16 v[224:227], a[140:143], a[4:7], v[224:227]
buffer_load_dwordx4 v16, s[12:15], s26 offen offset:0 lds
v_mfma_f32_16x16x32_bf16 v[228:231], a[136:139], a[8:11], 0
ds_read_b64_tr_b16 a[130:131], v22 offset:2048
v_mfma_f32_16x16x32_bf16 v[228:231], a[140:143], a[12:15], v[228:231]
buffer_store_dwordx4 v[112:115], v1, s[4:7], s31 offen sc1
v_mfma_f32_16x16x32_bf16 v[232:235], a[136:139], a[16:19], 0
s_add_u32 s31, s31, s32
ds_read_b64_tr_b16 a[132:133], v22 offset:16384
v_mfma_f32_16x16x32_bf16 v[232:235], a[140:143], a[20:23], v[232:235]
buffer_load_dwordx4 v17, s[12:15], s26 offen offset:1024 lds
v_mfma_f32_16x16x32_bf16 v[236:239], a[136:139], a[24:27], 0
ds_read_b64_tr_b16 a[134:135], v22 offset:18432
v_add_u32 v22, 32768, v22
v_mfma_f32_16x16x32_bf16 v[236:239], a[140:143], a[28:31], v[236:239]
v_mfma_f32_16x16x32_bf16 v[240:243], a[136:139], a[32:35], 0
v_mfma_f32_16x16x32_bf16 v[240:243], a[140:143], a[36:39], v[240:243]
buffer_load_dwordx4 v18, s[12:15], s26 offen offset:2048 lds
v_mfma_f32_16x16x32_bf16 v[244:247], a[136:139], a[40:43], 0
v_mfma_f32_16x16x32_bf16 v[244:247], a[140:143], a[44:47], v[244:247]
v_mfma_f32_16x16x32_bf16 v[248:251], a[136:139], a[48:51], 0
v_mfma_f32_16x16x32_bf16 v[248:251], a[140:143], a[52:55], v[248:251]
buffer_load_dwordx4 v19, s[12:15], s26 offen offset:3072 lds
v_mfma_f32_16x16x32_bf16 v[252:255], a[136:139], a[56:59], 0
s_add_u32 s26, s26, 524288
v_mfma_f32_16x16x32_bf16 v[252:255], a[140:143], a[60:63], v[252:255]
s_waitcnt lgkmcnt(0)
v_mfma_f32_16x16x32_bf16 v[36:39], a[128:131], a[64:67], v[36:39]
s_add_u32 m0, s29, 147456
ds_read_b64_tr_b16 a[136:137], v23 offset:0
v_accvgpr_read_b32 v32, a192
v_mfma_f32_16x16x32_bf16 v[36:39], a[132:135], a[68:71], v[36:39]
buffer_load_dwordx4 v16, s[12:15], s27 offen offset:0 lds
v_mfma_f32_16x16x32_bf16 v[44:47], a[128:131], a[72:75], v[44:47]
ds_read_b64_tr_b16 a[138:139], v23 offset:2048
v_accvgpr_read_b32 v33, a193
v_mfma_f32_16x16x32_bf16 v[44:47], a[132:135], a[76:79], v[44:47]
ds_read_b128 a[0:3], v2 offset:32768
ds_read_b128 a[4:7], v3 offset:32768
v_mfma_f32_16x16x32_bf16 v[52:55], a[128:131], a[80:83], v[52:55]
ds_read_b64_tr_b16 a[140:141], v23 offset:16384
v_accvgpr_read_b32 v34, a194
v_mfma_f32_16x16x32_bf16 v[52:55], a[132:135], a[84:87], v[52:55]
buffer_load_dwordx4 v17, s[12:15], s27 offen offset:1024 lds
v_mfma_f32_16x16x32_bf16 v[60:63], a[128:131], a[88:91], v[60:63]
ds_read_b64_tr_b16 a[142:143], v23 offset:18432
v_add_u32 v23, 32768, v23
v_mfma_f32_16x16x32_bf16 v[60:63], a[132:135], a[92:95], v[60:63]
buffer_store_dwordx4 v[120:123], v1, s[4:7], s31 offen sc1
v_mfma_f32_16x16x32_bf16 v[68:71], a[128:131], a[96:99], v[68:71]
s_add_u32 s31, s31, s34
ds_read_b128 a[8:11], v2 offset:34816
v_accvgpr_read_b32 v35, a195
v_mfma_f32_16x16x32_bf16 v[68:71], a[132:135], a[100:103], v[68:71]
buffer_load_dwordx4 v18, s[12:15], s27 offen offset:2048 lds
v_mfma_f32_16x16x32_bf16 v[76:79], a[128:131], a[104:107], v[76:79]
ds_read_b128 a[12:15], v3 offset:34816
v_accvgpr_read_b32 v96, a196
v_mfma_f32_16x16x32_bf16 v[76:79], a[132:135], a[108:111], v[76:79]
ds_read_b128 a[16:19], v2 offset:36864
v_accvgpr_read_b32 v97, a197
v_mfma_f32_16x16x32_bf16 v[84:87], a[128:131], a[112:115], v[84:87]
ds_read_b128 a[20:23], v3 offset:36864
v_accvgpr_read_b32 v98, a198
v_mfma_f32_16x16x32_bf16 v[84:87], a[132:135], a[116:119], v[84:87]
buffer_load_dwordx4 v19, s[12:15], s27 offen offset:3072 lds
v_mfma_f32_16x16x32_bf16 v[92:95], a[128:131], a[120:123], v[92:95]
s_add_u32 s27, s27, 524288
ds_read_b128 a[24:27], v2 offset:38912
v_accvgpr_read_b32 v99, a199
v_mfma_f32_16x16x32_bf16 v[92:95], a[132:135], a[124:127], v[92:95]
s_waitcnt lgkmcnt(5)
buffer_store_dwordx4 v[128:131], v1, s[4:7], s31 offen sc1
v_mfma_f32_16x16x32_bf16 v[100:103], a[136:139], a[64:67], v[100:103]
s_add_u32 m0, s28, 16384
ds_read_b64_tr_b16 a[128:129], v24 offset:0
v_cvt_pk_bf16_f32 v32, v32, v33
v_mfma_f32_16x16x32_bf16 v[100:103], a[140:143], a[68:71], v[100:103]
s_add_u32 s31, s31, s32
buffer_load_dwordx4 v12, s[8:11], s24 offen offset:0 lds
v_mfma_f32_16x16x32_bf16 v[108:111], a[136:139], a[72:75], v[108:111]
ds_read_b64_tr_b16 a[130:131], v24 offset:2048
v_cvt_pk_bf16_f32 v33, v34, v35
v_mfma_f32_16x16x32_bf16 v[108:111], a[140:143], a[76:79], v[108:111]
ds_read_b128 a[28:31], v3 offset:38912
v_cvt_pk_bf16_f32 v34, v96, v97
v_mfma_f32_16x16x32_bf16 v[116:119], a[136:139], a[80:83], v[116:119]
ds_read_b64_tr_b16 a[132:133], v24 offset:16384
v_cvt_pk_bf16_f32 v35, v98, v99
v_mfma_f32_16x16x32_bf16 v[116:119], a[140:143], a[84:87], v[116:119]
buffer_load_dwordx4 v13, s[8:11], s24 offen offset:1024 lds
v_mfma_f32_16x16x32_bf16 v[124:127], a[136:139], a[88:91], v[124:127]
ds_read_b64_tr_b16 a[134:135], v24 offset:18432
v_add_u32 v24, 32768, v24
v_mfma_f32_16x16x32_bf16 v[124:127], a[140:143], a[92:95], v[124:127]
v_accvgpr_read_b32 v40, a200
v_accvgpr_read_b32 v41, a201
v_mfma_f32_16x16x32_bf16 v[132:135], a[136:139], a[96:99], v[132:135]
ds_read_b128 a[32:35], v2 offset:40960
v_accvgpr_read_b32 v42, a202
v_mfma_f32_16x16x32_bf16 v[132:135], a[140:143], a[100:103], v[132:135]
buffer_load_dwordx4 v14, s[8:11], s24 offen offset:2048 lds
v_mfma_f32_16x16x32_bf16 v[140:143], a[136:139], a[104:107], v[140:143]
ds_read_b128 a[36:39], v3 offset:40960
v_accvgpr_read_b32 v43, a203
v_mfma_f32_16x16x32_bf16 v[140:143], a[140:143], a[108:111], v[140:143]
ds_read_b128 a[40:43], v2 offset:43008
v_accvgpr_read_b32 v96, a204
v_mfma_f32_16x16x32_bf16 v[148:151], a[136:139], a[112:115], v[148:151]
ds_read_b128 a[44:47], v3 offset:43008
v_accvgpr_read_b32 v97, a205
v_mfma_f32_16x16x32_bf16 v[148:151], a[140:143], a[116:119], v[148:151]
buffer_load_dwordx4 v15, s[8:11], s24 offen offset:3072 lds
v_mfma_f32_16x16x32_bf16 v[156:159], a[136:139], a[120:123], v[156:159]
s_add_u32 s24, s24, 128
ds_read_b128 a[48:51], v2 offset:45056
v_accvgpr_read_b32 v98, a206
v_mfma_f32_16x16x32_bf16 v[156:159], a[140:143], a[124:127], v[156:159]
s_waitcnt lgkmcnt(5)
buffer_store_dwordx4 v[136:139], v1, s[4:7], s31 offen sc1
v_mfma_f32_16x16x32_bf16 v[164:167], a[128:131], a[64:67], v[164:167]
s_add_u32 s31, s31, s33
ds_read_b64_tr_b16 a[136:137], v25 offset:0
v_accvgpr_read_b32 v99, a207
v_mfma_f32_16x16x32_bf16 v[164:167], a[132:135], a[68:71], v[164:167]
v_cvt_pk_bf16_f32 v40, v40, v41
v_cvt_pk_bf16_f32 v41, v42, v43
v_mfma_f32_16x16x32_bf16 v[172:175], a[128:131], a[72:75], v[172:175]
ds_read_b64_tr_b16 a[138:139], v25 offset:2048
v_cvt_pk_bf16_f32 v42, v96, v97
v_mfma_f32_16x16x32_bf16 v[172:175], a[132:135], a[76:79], v[172:175]
ds_read_b128 a[52:55], v3 offset:45056
v_cvt_pk_bf16_f32 v43, v98, v99
v_mfma_f32_16x16x32_bf16 v[180:183], a[128:131], a[80:83], v[180:183]
ds_read_b64_tr_b16 a[140:141], v25 offset:16384
v_accvgpr_read_b32 v48, a208
v_mfma_f32_16x16x32_bf16 v[180:183], a[132:135], a[84:87], v[180:183]
buffer_store_dwordx4 v[144:147], v1, s[4:7], s31 offen sc1
v_mfma_f32_16x16x32_bf16 v[188:191], a[128:131], a[88:91], v[188:191]
s_add_u32 s31, s31, s32
ds_read_b64_tr_b16 a[142:143], v25 offset:18432
v_add_u32 v25, 32768, v25
v_mfma_f32_16x16x32_bf16 v[188:191], a[132:135], a[92:95], v[188:191]
v_accvgpr_read_b32 v49, a209
v_accvgpr_read_b32 v50, a210
v_mfma_f32_16x16x32_bf16 v[196:199], a[128:131], a[96:99], v[196:199]
ds_read_b128 a[56:59], v2 offset:47104
v_accvgpr_read_b32 v51, a211
v_mfma_f32_16x16x32_bf16 v[196:199], a[132:135], a[100:103], v[196:199]
v_accvgpr_read_b32 v96, a212
v_accvgpr_read_b32 v97, a213
v_mfma_f32_16x16x32_bf16 v[204:207], a[128:131], a[104:107], v[204:207]
ds_read_b128 a[60:63], v3 offset:47104
v_accvgpr_read_b32 v98, a214
v_mfma_f32_16x16x32_bf16 v[204:207], a[132:135], a[108:111], v[204:207]
v_accvgpr_read_b32 v99, a215
v_cvt_pk_bf16_f32 v48, v48, v49
v_mfma_f32_16x16x32_bf16 v[212:215], a[128:131], a[112:115], v[212:215]
v_cvt_pk_bf16_f32 v49, v50, v51
v_cvt_pk_bf16_f32 v50, v96, v97
v_mfma_f32_16x16x32_bf16 v[212:215], a[132:135], a[116:119], v[212:215]
v_cvt_pk_bf16_f32 v51, v98, v99
v_accvgpr_read_b32 v56, a216
v_mfma_f32_16x16x32_bf16 v[220:223], a[128:131], a[120:123], v[220:223]
v_accvgpr_read_b32 v57, a217
v_accvgpr_read_b32 v58, a218
v_mfma_f32_16x16x32_bf16 v[220:223], a[132:135], a[124:127], v[220:223]
s_waitcnt vmcnt(24) lgkmcnt(0)
s_barrier
v_accvgpr_read_b32 v59, a219
v_mfma_f32_16x16x32_bf16 v[224:227], a[136:139], a[64:67], v[224:227]
s_add_u32 m0, s29, 65536
ds_read_b64_tr_b16 a[128:129], v22 offset:0
v_accvgpr_read_b32 v96, a220
v_mfma_f32_16x16x32_bf16 v[224:227], a[140:143], a[68:71], v[224:227]
buffer_load_dwordx4 v16, s[12:15], s26 offen offset:0 lds
v_mfma_f32_16x16x32_bf16 v[228:231], a[136:139], a[72:75], v[228:231]
ds_read_b64_tr_b16 a[130:131], v22 offset:2048
v_accvgpr_read_b32 v97, a221
v_mfma_f32_16x16x32_bf16 v[228:231], a[140:143], a[76:79], v[228:231]
buffer_store_dwordx4 v[152:155], v1, s[4:7], s31 offen sc1
v_mfma_f32_16x16x32_bf16 v[232:235], a[136:139], a[80:83], v[232:235]
s_add_u32 s31, s31, s36
ds_read_b64_tr_b16 a[132:133], v22 offset:16384
v_accvgpr_read_b32 v98, a222
v_mfma_f32_16x16x32_bf16 v[232:235], a[140:143], a[84:87], v[232:235]
buffer_load_dwordx4 v17, s[12:15], s26 offen offset:1024 lds
v_mfma_f32_16x16x32_bf16 v[236:239], a[136:139], a[88:91], v[236:239]
ds_read_b64_tr_b16 a[134:135], v22 offset:18432
v_add_u32 v22, 32768, v22
v_mfma_f32_16x16x32_bf16 v[236:239], a[140:143], a[92:95], v[236:239]
v_accvgpr_read_b32 v99, a223
v_cvt_pk_bf16_f32 v56, v56, v57
v_mfma_f32_16x16x32_bf16 v[240:243], a[136:139], a[96:99], v[240:243]
v_cvt_pk_bf16_f32 v57, v58, v59
v_cvt_pk_bf16_f32 v58, v96, v97
v_mfma_f32_16x16x32_bf16 v[240:243], a[140:143], a[100:103], v[240:243]
buffer_load_dwordx4 v18, s[12:15], s26 offen offset:2048 lds
v_mfma_f32_16x16x32_bf16 v[244:247], a[136:139], a[104:107], v[244:247]
v_cvt_pk_bf16_f32 v59, v98, v99
v_accvgpr_read_b32 v64, a224
v_mfma_f32_16x16x32_bf16 v[244:247], a[140:143], a[108:111], v[244:247]
v_accvgpr_read_b32 v65, a225
v_accvgpr_read_b32 v66, a226
v_mfma_f32_16x16x32_bf16 v[248:251], a[136:139], a[112:115], v[248:251]
v_accvgpr_read_b32 v67, a227
v_accvgpr_read_b32 v96, a228
v_mfma_f32_16x16x32_bf16 v[248:251], a[140:143], a[116:119], v[248:251]
buffer_load_dwordx4 v19, s[12:15], s26 offen offset:3072 lds
v_mfma_f32_16x16x32_bf16 v[252:255], a[136:139], a[120:123], v[252:255]
s_add_u32 s26, s26, 524288
v_accvgpr_read_b32 v97, a229
v_accvgpr_read_b32 v98, a230
v_mfma_f32_16x16x32_bf16 v[252:255], a[140:143], a[124:127], v[252:255]
s_waitcnt lgkmcnt(0)
v_accvgpr_read_b32 v99, a231
v_cvt_pk_bf16_f32 v64, v64, v65
v_mfma_f32_16x16x32_bf16 v[36:39], a[128:131], a[0:3], v[36:39]
s_add_u32 m0, s29, 81920
ds_read_b64_tr_b16 a[136:137], v23 offset:0
v_cvt_pk_bf16_f32 v65, v66, v67
v_mfma_f32_16x16x32_bf16 v[36:39], a[132:135], a[4:7], v[36:39]
buffer_load_dwordx4 v16, s[12:15], s27 offen offset:0 lds
v_mfma_f32_16x16x32_bf16 v[44:47], a[128:131], a[8:11], v[44:47]
ds_read_b64_tr_b16 a[138:139], v23 offset:2048
v_cvt_pk_bf16_f32 v66, v96, v97
v_mfma_f32_16x16x32_bf16 v[44:47], a[132:135], a[12:15], v[44:47]
ds_read_b128 a[64:67], v2 offset:49152
ds_read_b128 a[68:71], v3 offset:49152
v_mfma_f32_16x16x32_bf16 v[52:55], a[128:131], a[16:19], v[52:55]
ds_read_b64_tr_b16 a[140:141], v23 offset:16384
v_cvt_pk_bf16_f32 v67, v98, v99
v_mfma_f32_16x16x32_bf16 v[52:55], a[132:135], a[20:23], v[52:55]
buffer_load_dwordx4 v17, s[12:15], s27 offen offset:1024 lds
v_mfma_f32_16x16x32_bf16 v[60:63], a[128:131], a[24:27], v[60:63]
ds_read_b64_tr_b16 a[142:143], v23 offset:18432
v_add_u32 v23, 32768, v23
v_mfma_f32_16x16x32_bf16 v[60:63], a[132:135], a[28:31], v[60:63]
buffer_store_dwordx4 v[160:163], v1, s[4:7], s31 offen sc1
v_mfma_f32_16x16x32_bf16 v[68:71], a[128:131], a[32:35], v[68:71]
s_add_u32 s31, s31, s32
ds_read_b128 a[72:75], v2 offset:51200
v_accvgpr_read_b32 v72, a232
v_mfma_f32_16x16x32_bf16 v[68:71], a[132:135], a[36:39], v[68:71]
buffer_load_dwordx4 v18, s[12:15], s27 offen offset:2048 lds
v_mfma_f32_16x16x32_bf16 v[76:79], a[128:131], a[40:43], v[76:79]
ds_read_b128 a[76:79], v3 offset:51200
v_accvgpr_read_b32 v73, a233
v_mfma_f32_16x16x32_bf16 v[76:79], a[132:135], a[44:47], v[76:79]
ds_read_b128 a[80:83], v2 offset:53248
v_accvgpr_read_b32 v74, a234
v_mfma_f32_16x16x32_bf16 v[84:87], a[128:131], a[48:51], v[84:87]
ds_read_b128 a[84:87], v3 offset:53248
v_accvgpr_read_b32 v75, a235
v_mfma_f32_16x16x32_bf16 v[84:87], a[132:135], a[52:55], v[84:87]
buffer_load_dwordx4 v19, s[12:15], s27 offen offset:3072 lds
v_mfma_f32_16x16x32_bf16 v[92:95], a[128:131], a[56:59], v[92:95]
s_add_u32 s27, s27, 524288
ds_read_b128 a[88:91], v2 offset:55296
v_accvgpr_read_b32 v96, a236
v_mfma_f32_16x16x32_bf16 v[92:95], a[132:135], a[60:63], v[92:95]
s_waitcnt lgkmcnt(5)
buffer_store_dwordx4 v[168:171], v1, s[4:7], s31 offen sc1
v_mfma_f32_16x16x32_bf16 v[100:103], a[136:139], a[0:3], v[100:103]
s_add_u32 m0, s28, 32768
ds_read_b64_tr_b16 a[128:129], v24 offset:0
v_accvgpr_read_b32 v97, a237
v_mfma_f32_16x16x32_bf16 v[100:103], a[140:143], a[4:7], v[100:103]
s_add_u32 s31, s31, s33
buffer_load_dwordx4 v12, s[8:11], s24 offen offset:0 lds
v_mfma_f32_16x16x32_bf16 v[108:111], a[136:139], a[8:11], v[108:111]
ds_read_b64_tr_b16 a[130:131], v24 offset:2048
v_accvgpr_read_b32 v98, a238
v_mfma_f32_16x16x32_bf16 v[108:111], a[140:143], a[12:15], v[108:111]
ds_read_b128 a[92:95], v3 offset:55296
v_accvgpr_read_b32 v99, a239
v_mfma_f32_16x16x32_bf16 v[116:119], a[136:139], a[16:19], v[116:119]
ds_read_b64_tr_b16 a[132:133], v24 offset:16384
v_cvt_pk_bf16_f32 v72, v72, v73
v_mfma_f32_16x16x32_bf16 v[116:119], a[140:143], a[20:23], v[116:119]
buffer_load_dwordx4 v13, s[8:11], s24 offen offset:1024 lds
v_mfma_f32_16x16x32_bf16 v[124:127], a[136:139], a[24:27], v[124:127]
ds_read_b64_tr_b16 a[134:135], v24 offset:18432
v_add_u32 v24, 32768, v24
v_mfma_f32_16x16x32_bf16 v[124:127], a[140:143], a[28:31], v[124:127]
v_cvt_pk_bf16_f32 v73, v74, v75
v_cvt_pk_bf16_f32 v74, v96, v97
v_mfma_f32_16x16x32_bf16 v[132:135], a[136:139], a[32:35], v[132:135]
ds_read_b128 a[96:99], v2 offset:57344
v_cvt_pk_bf16_f32 v75, v98, v99
v_mfma_f32_16x16x32_bf16 v[132:135], a[140:143], a[36:39], v[132:135]
buffer_load_dwordx4 v14, s[8:11], s24 offen offset:2048 lds
v_mfma_f32_16x16x32_bf16 v[140:143], a[136:139], a[40:43], v[140:143]
ds_read_b128 a[100:103], v3 offset:57344
v_accvgpr_read_b32 v80, a240
v_mfma_f32_16x16x32_bf16 v[140:143], a[140:143], a[44:47], v[140:143]
ds_read_b128 a[104:107], v2 offset:59392
v_accvgpr_read_b32 v81, a241
v_mfma_f32_16x16x32_bf16 v[148:151], a[136:139], a[48:51], v[148:151]
ds_read_b128 a[108:111], v3 offset:59392
v_accvgpr_read_b32 v82, a242
v_mfma_f32_16x16x32_bf16 v[148:151], a[140:143], a[52:55], v[148:151]
buffer_load_dwordx4 v15, s[8:11], s24 offen offset:3072 lds
v_mfma_f32_16x16x32_bf16 v[156:159], a[136:139], a[56:59], v[156:159]
s_add_u32 s24, s24, 128
ds_read_b128 a[112:115], v2 offset:61440
v_accvgpr_read_b32 v83, a243
v_mfma_f32_16x16x32_bf16 v[156:159], a[140:143], a[60:63], v[156:159]
s_waitcnt lgkmcnt(5)
buffer_store_dwordx4 v[176:179], v1, s[4:7], s31 offen sc1
v_mfma_f32_16x16x32_bf16 v[164:167], a[128:131], a[0:3], v[164:167]
s_add_u32 s31, s31, s32
ds_read_b64_tr_b16 a[136:137], v25 offset:0
v_accvgpr_read_b32 v96, a244
v_mfma_f32_16x16x32_bf16 v[164:167], a[132:135], a[4:7], v[164:167]
v_accvgpr_read_b32 v97, a245
v_accvgpr_read_b32 v98, a246
v_mfma_f32_16x16x32_bf16 v[172:175], a[128:131], a[8:11], v[172:175]
ds_read_b64_tr_b16 a[138:139], v25 offset:2048
v_accvgpr_read_b32 v99, a247
v_mfma_f32_16x16x32_bf16 v[172:175], a[132:135], a[12:15], v[172:175]
ds_read_b128 a[116:119], v3 offset:61440
v_cvt_pk_bf16_f32 v80, v80, v81
v_mfma_f32_16x16x32_bf16 v[180:183], a[128:131], a[16:19], v[180:183]
ds_read_b64_tr_b16 a[140:141], v25 offset:16384
v_cvt_pk_bf16_f32 v81, v82, v83
v_mfma_f32_16x16x32_bf16 v[180:183], a[132:135], a[20:23], v[180:183]
buffer_store_dwordx4 v[184:187], v1, s[4:7], s31 offen sc1
v_mfma_f32_16x16x32_bf16 v[188:191], a[128:131], a[24:27], v[188:191]
s_add_u32 s31, s31, s34
ds_read_b64_tr_b16 a[142:143], v25 offset:18432
v_add_u32 v25, 32768, v25
v_mfma_f32_16x16x32_bf16 v[188:191], a[132:135], a[28:31], v[188:191]
v_cvt_pk_bf16_f32 v82, v96, v97
v_cvt_pk_bf16_f32 v83, v98, v99
v_mfma_f32_16x16x32_bf16 v[196:199], a[128:131], a[32:35], v[196:199]
ds_read_b128 a[120:123], v2 offset:63488
v_accvgpr_read_b32 v88, a248
v_mfma_f32_16x16x32_bf16 v[196:199], a[132:135], a[36:39], v[196:199]
v_accvgpr_read_b32 v89, a249
v_accvgpr_read_b32 v90, a250
v_mfma_f32_16x16x32_bf16 v[204:207], a[128:131], a[40:43], v[204:207]
ds_read_b128 a[124:127], v3 offset:63488
v_accvgpr_read_b32 v91, a251
v_mfma_f32_16x16x32_bf16 v[204:207], a[132:135], a[44:47], v[204:207]
v_accvgpr_read_b32 v96, a252
v_accvgpr_read_b32 v97, a253
v_mfma_f32_16x16x32_bf16 v[212:215], a[128:131], a[48:51], v[212:215]
v_accvgpr_read_b32 v98, a254
v_accvgpr_read_b32 v99, a255
v_mfma_f32_16x16x32_bf16 v[212:215], a[132:135], a[52:55], v[212:215]
v_cvt_pk_bf16_f32 v88, v88, v89
v_cvt_pk_bf16_f32 v89, v90, v91
v_mfma_f32_16x16x32_bf16 v[220:223], a[128:131], a[56:59], v[220:223]
v_cvt_pk_bf16_f32 v90, v96, v97
v_cvt_pk_bf16_f32 v91, v98, v99
v_mfma_f32_16x16x32_bf16 v[220:223], a[132:135], a[60:63], v[220:223]
s_waitcnt vmcnt(24) lgkmcnt(0)
s_barrier
v_mfma_f32_16x16x32_bf16 v[224:227], a[136:139], a[0:3], v[224:227]
s_add_u32 m0, s29, 98304
ds_read_b64_tr_b16 a[128:129], v22 offset:0
v_mfma_f32_16x16x32_bf16 v[224:227], a[140:143], a[4:7], v[224:227]
buffer_load_dwordx4 v16, s[12:15], s26 offen offset:0 lds
v_mfma_f32_16x16x32_bf16 v[228:231], a[136:139], a[8:11], v[228:231]
ds_read_b64_tr_b16 a[130:131], v22 offset:2048
v_mfma_f32_16x16x32_bf16 v[228:231], a[140:143], a[12:15], v[228:231]
buffer_store_dwordx4 v[192:195], v1, s[4:7], s31 offen sc1
v_mfma_f32_16x16x32_bf16 v[232:235], a[136:139], a[16:19], v[232:235]
s_add_u32 s31, s31, s32
ds_read_b64_tr_b16 a[132:133], v22 offset:16384
v_mfma_f32_16x16x32_bf16 v[232:235], a[140:143], a[20:23], v[232:235]
buffer_load_dwordx4 v17, s[12:15], s26 offen offset:1024 lds
v_mfma_f32_16x16x32_bf16 v[236:239], a[136:139], a[24:27], v[236:239]
ds_read_b64_tr_b16 a[134:135], v22 offset:18432
v_add_u32 v22, 4294901760, v22
v_mfma_f32_16x16x32_bf16 v[236:239], a[140:143], a[28:31], v[236:239]
v_mfma_f32_16x16x32_bf16 v[240:243], a[136:139], a[32:35], v[240:243]
v_mfma_f32_16x16x32_bf16 v[240:243], a[140:143], a[36:39], v[240:243]
buffer_load_dwordx4 v18, s[12:15], s26 offen offset:2048 lds
v_mfma_f32_16x16x32_bf16 v[244:247], a[136:139], a[40:43], v[244:247]
v_mfma_f32_16x16x32_bf16 v[244:247], a[140:143], a[44:47], v[244:247]
v_mfma_f32_16x16x32_bf16 v[248:251], a[136:139], a[48:51], v[248:251]
v_mfma_f32_16x16x32_bf16 v[248:251], a[140:143], a[52:55], v[248:251]
buffer_load_dwordx4 v19, s[12:15], s26 offen offset:3072 lds
v_mfma_f32_16x16x32_bf16 v[252:255], a[136:139], a[56:59], v[252:255]
s_add_u32 s26, s26, 524288
v_mfma_f32_16x16x32_bf16 v[252:255], a[140:143], a[60:63], v[252:255]
s_waitcnt lgkmcnt(2)
v_mfma_f32_16x16x32_bf16 v[36:39], a[128:131], a[64:67], v[36:39]
s_waitcnt lgkmcnt(0)
s_add_u32 m0, s29, 114688
ds_read_b64_tr_b16 a[136:137], v23 offset:0
v_mfma_f32_16x16x32_bf16 v[36:39], a[132:135], a[68:71], v[36:39]
buffer_load_dwordx4 v16, s[12:15], s27 offen offset:0 lds
v_mfma_f32_16x16x32_bf16 v[44:47], a[128:131], a[72:75], v[44:47]
ds_read_b64_tr_b16 a[138:139], v23 offset:2048
v_mfma_f32_16x16x32_bf16 v[44:47], a[132:135], a[76:79], v[44:47]
ds_read_b128 a[0:3], v2 offset:0
ds_read_b128 a[4:7], v3 offset:0
v_mfma_f32_16x16x32_bf16 v[52:55], a[128:131], a[80:83], v[52:55]
ds_read_b64_tr_b16 a[140:141], v23 offset:16384
v_mfma_f32_16x16x32_bf16 v[52:55], a[132:135], a[84:87], v[52:55]
buffer_load_dwordx4 v17, s[12:15], s27 offen offset:1024 lds
v_mfma_f32_16x16x32_bf16 v[60:63], a[128:131], a[88:91], v[60:63]
ds_read_b64_tr_b16 a[142:143], v23 offset:18432
v_add_u32 v23, 4294901760, v23
v_mfma_f32_16x16x32_bf16 v[60:63], a[132:135], a[92:95], v[60:63]
buffer_store_dwordx4 v[200:203], v1, s[4:7], s31 offen sc1
v_mfma_f32_16x16x32_bf16 v[68:71], a[128:131], a[96:99], v[68:71]
s_add_u32 s31, s31, s33
ds_read_b128 a[8:11], v2 offset:2048
v_mfma_f32_16x16x32_bf16 v[68:71], a[132:135], a[100:103], v[68:71]
buffer_load_dwordx4 v18, s[12:15], s27 offen offset:2048 lds
v_mfma_f32_16x16x32_bf16 v[76:79], a[128:131], a[104:107], v[76:79]
ds_read_b128 a[12:15], v3 offset:2048
v_mfma_f32_16x16x32_bf16 v[76:79], a[132:135], a[108:111], v[76:79]
ds_read_b128 a[16:19], v2 offset:4096
v_mfma_f32_16x16x32_bf16 v[84:87], a[128:131], a[112:115], v[84:87]
ds_read_b128 a[20:23], v3 offset:4096
v_mfma_f32_16x16x32_bf16 v[84:87], a[132:135], a[116:119], v[84:87]
buffer_load_dwordx4 v19, s[12:15], s27 offen offset:3072 lds
v_mfma_f32_16x16x32_bf16 v[92:95], a[128:131], a[120:123], v[92:95]
s_add_u32 s27, s27, 524288
ds_read_b128 a[24:27], v2 offset:6144
v_mfma_f32_16x16x32_bf16 v[92:95], a[132:135], a[124:127], v[92:95]
s_waitcnt lgkmcnt(9)
buffer_store_dwordx4 v[208:211], v1, s[4:7], s31 offen sc1
v_mfma_f32_16x16x32_bf16 v[100:103], a[136:139], a[64:67], v[100:103]
s_waitcnt lgkmcnt(5)
s_add_u32 s31, s31, s32
ds_read_b64_tr_b16 a[128:129], v24 offset:0
v_mfma_f32_16x16x32_bf16 v[100:103], a[140:143], a[68:71], v[100:103]
v_mfma_f32_16x16x32_bf16 v[108:111], a[136:139], a[72:75], v[108:111]
ds_read_b64_tr_b16 a[130:131], v24 offset:2048
v_mfma_f32_16x16x32_bf16 v[108:111], a[140:143], a[76:79], v[108:111]
ds_read_b128 a[28:31], v3 offset:6144
v_mfma_f32_16x16x32_bf16 v[116:119], a[136:139], a[80:83], v[116:119]
ds_read_b64_tr_b16 a[132:133], v24 offset:16384
v_mfma_f32_16x16x32_bf16 v[116:119], a[140:143], a[84:87], v[116:119]
v_mfma_f32_16x16x32_bf16 v[124:127], a[136:139], a[88:91], v[124:127]
ds_read_b64_tr_b16 a[134:135], v24 offset:18432
v_add_u32 v24, 4294901760, v24
v_mfma_f32_16x16x32_bf16 v[124:127], a[140:143], a[92:95], v[124:127]
v_mfma_f32_16x16x32_bf16 v[132:135], a[136:139], a[96:99], v[132:135]
ds_read_b128 a[32:35], v2 offset:8192
v_mfma_f32_16x16x32_bf16 v[132:135], a[140:143], a[100:103], v[132:135]
buffer_store_dwordx4 v[216:219], v1, s[4:7], s31 offen sc1
v_mfma_f32_16x16x32_bf16 v[140:143], a[136:139], a[104:107], v[140:143]
s_add_u32 s31, s31, s35
ds_read_b128 a[36:39], v3 offset:8192
v_mfma_f32_16x16x32_bf16 v[140:143], a[140:143], a[108:111], v[140:143]
ds_read_b128 a[40:43], v2 offset:10240
v_mfma_f32_16x16x32_bf16 v[148:151], a[136:139], a[112:115], v[148:151]
ds_read_b128 a[44:47], v3 offset:10240
v_mfma_f32_16x16x32_bf16 v[148:151], a[140:143], a[116:119], v[148:151]
v_mfma_f32_16x16x32_bf16 v[156:159], a[136:139], a[120:123], v[156:159]
ds_read_b128 a[48:51], v2 offset:12288
v_mfma_f32_16x16x32_bf16 v[156:159], a[140:143], a[124:127], v[156:159]
s_waitcnt lgkmcnt(8)
v_mfma_f32_16x16x32_bf16 v[164:167], a[128:131], a[64:67], v[164:167]
s_waitcnt lgkmcnt(5)
ds_read_b64_tr_b16 a[136:137], v25 offset:0
v_mfma_f32_16x16x32_bf16 v[164:167], a[132:135], a[68:71], v[164:167]
v_mfma_f32_16x16x32_bf16 v[172:175], a[128:131], a[72:75], v[172:175]
ds_read_b64_tr_b16 a[138:139], v25 offset:2048
v_mfma_f32_16x16x32_bf16 v[172:175], a[132:135], a[76:79], v[172:175]
ds_read_b128 a[52:55], v3 offset:12288
v_mfma_f32_16x16x32_bf16 v[180:183], a[128:131], a[80:83], v[180:183]
ds_read_b64_tr_b16 a[140:141], v25 offset:16384
v_mfma_f32_16x16x32_bf16 v[180:183], a[132:135], a[84:87], v[180:183]
buffer_store_dwordx4 v[32:35], v1, s[4:7], s31 offen sc1
v_mfma_f32_16x16x32_bf16 v[188:191], a[128:131], a[88:91], v[188:191]
s_add_u32 s31, s31, s32
ds_read_b64_tr_b16 a[142:143], v25 offset:18432
v_add_u32 v25, 4294901760, v25
v_mfma_f32_16x16x32_bf16 v[188:191], a[132:135], a[92:95], v[188:191]
v_mfma_f32_16x16x32_bf16 v[196:199], a[128:131], a[96:99], v[196:199]
ds_read_b128 a[56:59], v2 offset:14336
v_mfma_f32_16x16x32_bf16 v[196:199], a[132:135], a[100:103], v[196:199]
v_mfma_f32_16x16x32_bf16 v[204:207], a[128:131], a[104:107], v[204:207]
ds_read_b128 a[60:63], v3 offset:14336
v_mfma_f32_16x16x32_bf16 v[204:207], a[132:135], a[108:111], v[204:207]
v_mfma_f32_16x16x32_bf16 v[212:215], a[128:131], a[112:115], v[212:215]
v_mfma_f32_16x16x32_bf16 v[212:215], a[132:135], a[116:119], v[212:215]
v_mfma_f32_16x16x32_bf16 v[220:223], a[128:131], a[120:123], v[220:223]
v_mfma_f32_16x16x32_bf16 v[220:223], a[132:135], a[124:127], v[220:223]
s_waitcnt vmcnt(20) lgkmcnt(0)
s_barrier
v_mfma_f32_16x16x32_bf16 v[224:227], a[136:139], a[64:67], v[224:227]
s_add_u32 m0, s29, 131072
ds_read_b64_tr_b16 a[128:129], v22 offset:0
v_mfma_f32_16x16x32_bf16 v[224:227], a[140:143], a[68:71], v[224:227]
buffer_load_dwordx4 v16, s[12:15], s26 offen offset:0 lds
v_mfma_f32_16x16x32_bf16 v[228:231], a[136:139], a[72:75], v[228:231]
ds_read_b64_tr_b16 a[130:131], v22 offset:2048
v_mfma_f32_16x16x32_bf16 v[228:231], a[140:143], a[76:79], v[228:231]
buffer_store_dwordx4 v[40:43], v1, s[4:7], s31 offen sc1
v_mfma_f32_16x16x32_bf16 v[232:235], a[136:139], a[80:83], v[232:235]
s_add_u32 s31, s31, s33
ds_read_b64_tr_b16 a[132:133], v22 offset:16384
v_mfma_f32_16x16x32_bf16 v[232:235], a[140:143], a[84:87], v[232:235]
buffer_load_dwordx4 v17, s[12:15], s26 offen offset:1024 lds
v_mfma_f32_16x16x32_bf16 v[236:239], a[136:139], a[88:91], v[236:239]
ds_read_b64_tr_b16 a[134:135], v22 offset:18432
v_add_u32 v22, 32768, v22
v_mfma_f32_16x16x32_bf16 v[236:239], a[140:143], a[92:95], v[236:239]
v_mfma_f32_16x16x32_bf16 v[240:243], a[136:139], a[96:99], v[240:243]
v_mfma_f32_16x16x32_bf16 v[240:243], a[140:143], a[100:103], v[240:243]
buffer_load_dwordx4 v18, s[12:15], s26 offen offset:2048 lds
v_mfma_f32_16x16x32_bf16 v[244:247], a[136:139], a[104:107], v[244:247]
v_mfma_f32_16x16x32_bf16 v[244:247], a[140:143], a[108:111], v[244:247]
v_mfma_f32_16x16x32_bf16 v[248:251], a[136:139], a[112:115], v[248:251]
v_mfma_f32_16x16x32_bf16 v[248:251], a[140:143], a[116:119], v[248:251]
buffer_load_dwordx4 v19, s[12:15], s26 offen offset:3072 lds
v_mfma_f32_16x16x32_bf16 v[252:255], a[136:139], a[120:123], v[252:255]
s_add_u32 s26, s26, 524288
v_mfma_f32_16x16x32_bf16 v[252:255], a[140:143], a[124:127], v[252:255]
s_waitcnt lgkmcnt(2)
v_mfma_f32_16x16x32_bf16 v[36:39], a[128:131], a[0:3], v[36:39]
s_waitcnt lgkmcnt(0)
s_add_u32 m0, s29, 147456
ds_read_b64_tr_b16 a[136:137], v23 offset:0
v_mfma_f32_16x16x32_bf16 v[36:39], a[132:135], a[4:7], v[36:39]
buffer_load_dwordx4 v16, s[12:15], s27 offen offset:0 lds
v_mfma_f32_16x16x32_bf16 v[44:47], a[128:131], a[8:11], v[44:47]
ds_read_b64_tr_b16 a[138:139], v23 offset:2048
v_mfma_f32_16x16x32_bf16 v[44:47], a[132:135], a[12:15], v[44:47]
ds_read_b128 a[64:67], v2 offset:16384
ds_read_b128 a[68:71], v3 offset:16384
v_mfma_f32_16x16x32_bf16 v[52:55], a[128:131], a[16:19], v[52:55]
ds_read_b64_tr_b16 a[140:141], v23 offset:16384
v_mfma_f32_16x16x32_bf16 v[52:55], a[132:135], a[20:23], v[52:55]
buffer_load_dwordx4 v17, s[12:15], s27 offen offset:1024 lds
v_mfma_f32_16x16x32_bf16 v[60:63], a[128:131], a[24:27], v[60:63]
ds_read_b64_tr_b16 a[142:143], v23 offset:18432
v_add_u32 v23, 32768, v23
v_mfma_f32_16x16x32_bf16 v[60:63], a[132:135], a[28:31], v[60:63]
buffer_store_dwordx4 v[48:51], v1, s[4:7], s31 offen sc1
v_mfma_f32_16x16x32_bf16 v[68:71], a[128:131], a[32:35], v[68:71]
s_add_u32 s31, s31, s32
ds_read_b128 a[72:75], v2 offset:18432
v_mfma_f32_16x16x32_bf16 v[68:71], a[132:135], a[36:39], v[68:71]
buffer_load_dwordx4 v18, s[12:15], s27 offen offset:2048 lds
v_mfma_f32_16x16x32_bf16 v[76:79], a[128:131], a[40:43], v[76:79]
ds_read_b128 a[76:79], v3 offset:18432
v_mfma_f32_16x16x32_bf16 v[76:79], a[132:135], a[44:47], v[76:79]
ds_read_b128 a[80:83], v2 offset:20480
v_mfma_f32_16x16x32_bf16 v[84:87], a[128:131], a[48:51], v[84:87]
ds_read_b128 a[84:87], v3 offset:20480
v_mfma_f32_16x16x32_bf16 v[84:87], a[132:135], a[52:55], v[84:87]
buffer_load_dwordx4 v19, s[12:15], s27 offen offset:3072 lds
v_mfma_f32_16x16x32_bf16 v[92:95], a[128:131], a[56:59], v[92:95]
s_add_u32 s27, s27, 524288
ds_read_b128 a[88:91], v2 offset:22528
v_mfma_f32_16x16x32_bf16 v[92:95], a[132:135], a[60:63], v[92:95]
s_waitcnt lgkmcnt(9)
buffer_store_dwordx4 v[56:59], v1, s[4:7], s31 offen sc1
v_mfma_f32_16x16x32_bf16 v[100:103], a[136:139], a[0:3], v[100:103]
s_waitcnt lgkmcnt(5)
s_add_u32 s31, s31, s34
ds_read_b64_tr_b16 a[128:129], v24 offset:0
v_mfma_f32_16x16x32_bf16 v[100:103], a[140:143], a[4:7], v[100:103]
v_mfma_f32_16x16x32_bf16 v[108:111], a[136:139], a[8:11], v[108:111]
ds_read_b64_tr_b16 a[130:131], v24 offset:2048
v_mfma_f32_16x16x32_bf16 v[108:111], a[140:143], a[12:15], v[108:111]
ds_read_b128 a[92:95], v3 offset:22528
v_mfma_f32_16x16x32_bf16 v[116:119], a[136:139], a[16:19], v[116:119]
ds_read_b64_tr_b16 a[132:133], v24 offset:16384
v_mfma_f32_16x16x32_bf16 v[116:119], a[140:143], a[20:23], v[116:119]
buffer_store_dwordx4 v[64:67], v1, s[4:7], s31 offen sc1
v_mfma_f32_16x16x32_bf16 v[124:127], a[136:139], a[24:27], v[124:127]
s_add_u32 s31, s31, s32
ds_read_b64_tr_b16 a[134:135], v24 offset:18432
v_add_u32 v24, 32768, v24
v_mfma_f32_16x16x32_bf16 v[124:127], a[140:143], a[28:31], v[124:127]
v_mfma_f32_16x16x32_bf16 v[132:135], a[136:139], a[32:35], v[132:135]
ds_read_b128 a[96:99], v2 offset:24576
v_mfma_f32_16x16x32_bf16 v[132:135], a[140:143], a[36:39], v[132:135]
v_mfma_f32_16x16x32_bf16 v[140:143], a[136:139], a[40:43], v[140:143]
ds_read_b128 a[100:103], v3 offset:24576
v_mfma_f32_16x16x32_bf16 v[140:143], a[140:143], a[44:47], v[140:143]
ds_read_b128 a[104:107], v2 offset:26624
v_mfma_f32_16x16x32_bf16 v[148:151], a[136:139], a[48:51], v[148:151]
ds_read_b128 a[108:111], v3 offset:26624
v_mfma_f32_16x16x32_bf16 v[148:151], a[140:143], a[52:55], v[148:151]
v_mfma_f32_16x16x32_bf16 v[156:159], a[136:139], a[56:59], v[156:159]
ds_read_b128 a[112:115], v2 offset:28672
v_mfma_f32_16x16x32_bf16 v[156:159], a[140:143], a[60:63], v[156:159]
s_waitcnt lgkmcnt(8)
buffer_store_dwordx4 v[72:75], v1, s[4:7], s31 offen sc1
v_mfma_f32_16x16x32_bf16 v[164:167], a[128:131], a[0:3], v[164:167]
s_waitcnt lgkmcnt(5)
s_add_u32 s31, s31, s33
ds_read_b64_tr_b16 a[136:137], v25 offset:0
v_mfma_f32_16x16x32_bf16 v[164:167], a[132:135], a[4:7], v[164:167]
v_mfma_f32_16x16x32_bf16 v[172:175], a[128:131], a[8:11], v[172:175]
ds_read_b64_tr_b16 a[138:139], v25 offset:2048
v_mfma_f32_16x16x32_bf16 v[172:175], a[132:135], a[12:15], v[172:175]
ds_read_b128 a[116:119], v3 offset:28672
v_mfma_f32_16x16x32_bf16 v[180:183], a[128:131], a[16:19], v[180:183]
ds_read_b64_tr_b16 a[140:141], v25 offset:16384
v_mfma_f32_16x16x32_bf16 v[180:183], a[132:135], a[20:23], v[180:183]
v_mfma_f32_16x16x32_bf16 v[188:191], a[128:131], a[24:27], v[188:191]
ds_read_b64_tr_b16 a[142:143], v25 offset:18432
v_add_u32 v25, 32768, v25
v_mfma_f32_16x16x32_bf16 v[188:191], a[132:135], a[28:31], v[188:191]
v_mfma_f32_16x16x32_bf16 v[196:199], a[128:131], a[32:35], v[196:199]
ds_read_b128 a[120:123], v2 offset:30720
v_mfma_f32_16x16x32_bf16 v[196:199], a[132:135], a[36:39], v[196:199]
buffer_store_dwordx4 v[80:83], v1, s[4:7], s31 offen sc1
v_mfma_f32_16x16x32_bf16 v[204:207], a[128:131], a[40:43], v[204:207]
s_add_u32 s31, s31, s32
ds_read_b128 a[124:127], v3 offset:30720
v_mfma_f32_16x16x32_bf16 v[204:207], a[132:135], a[44:47], v[204:207]
v_mfma_f32_16x16x32_bf16 v[212:215], a[128:131], a[48:51], v[212:215]
v_mfma_f32_16x16x32_bf16 v[212:215], a[132:135], a[52:55], v[212:215]
v_mfma_f32_16x16x32_bf16 v[220:223], a[128:131], a[56:59], v[220:223]
v_mfma_f32_16x16x32_bf16 v[220:223], a[132:135], a[60:63], v[220:223]
s_waitcnt vmcnt(17) lgkmcnt(0)
s_barrier
v_mfma_f32_16x16x32_bf16 v[224:227], a[136:139], a[0:3], v[224:227]
ds_read_b64_tr_b16 a[128:129], v22 offset:0
v_mfma_f32_16x16x32_bf16 v[224:227], a[140:143], a[4:7], v[224:227]
v_mfma_f32_16x16x32_bf16 v[228:231], a[136:139], a[8:11], v[228:231]
ds_read_b64_tr_b16 a[130:131], v22 offset:2048
v_mfma_f32_16x16x32_bf16 v[228:231], a[140:143], a[12:15], v[228:231]
buffer_store_dwordx4 v[88:91], v1, s[4:7], s31 offen sc1
v_mfma_f32_16x16x32_bf16 v[232:235], a[136:139], a[16:19], v[232:235]
ds_read_b64_tr_b16 a[132:133], v22 offset:16384
v_mfma_f32_16x16x32_bf16 v[232:235], a[140:143], a[20:23], v[232:235]
v_mfma_f32_16x16x32_bf16 v[236:239], a[136:139], a[24:27], v[236:239]
ds_read_b64_tr_b16 a[134:135], v22 offset:18432
v_add_u32 v22, 32768, v22
v_mfma_f32_16x16x32_bf16 v[236:239], a[140:143], a[28:31], v[236:239]
v_mfma_f32_16x16x32_bf16 v[240:243], a[136:139], a[32:35], v[240:243]
v_mfma_f32_16x16x32_bf16 v[240:243], a[140:143], a[36:39], v[240:243]
v_mfma_f32_16x16x32_bf16 v[244:247], a[136:139], a[40:43], v[244:247]
v_mfma_f32_16x16x32_bf16 v[244:247], a[140:143], a[44:47], v[244:247]
v_mfma_f32_16x16x32_bf16 v[248:251], a[136:139], a[48:51], v[248:251]
v_mfma_f32_16x16x32_bf16 v[248:251], a[140:143], a[52:55], v[248:251]
v_mfma_f32_16x16x32_bf16 v[252:255], a[136:139], a[56:59], v[252:255]
v_mfma_f32_16x16x32_bf16 v[252:255], a[140:143], a[60:63], v[252:255]
s_waitcnt lgkmcnt(2)
v_mfma_f32_16x16x32_bf16 v[36:39], a[128:131], a[64:67], v[36:39]
s_waitcnt lgkmcnt(0)
ds_read_b64_tr_b16 a[136:137], v23 offset:0
v_mfma_f32_16x16x32_bf16 v[36:39], a[132:135], a[68:71], v[36:39]
v_mfma_f32_16x16x32_bf16 v[44:47], a[128:131], a[72:75], v[44:47]
s_lshl_b32 s22, s20, 7
ds_read_b64_tr_b16 a[138:139], v23 offset:2048
v_bfe_u32 v20, v1, 4, 4
v_mfma_f32_16x16x32_bf16 v[44:47], a[132:135], a[76:79], v[44:47]
s_add_u32 s70, s22, 94371840
ds_read_b128 a[0:3], v2 offset:32768
ds_read_b128 a[4:7], v3 offset:32768
v_mfma_f32_16x16x32_bf16 v[52:55], a[128:131], a[80:83], v[52:55]
s_lshr_b32 s22, s2, 4
ds_read_b64_tr_b16 a[140:141], v23 offset:16384
v_lshlrev_b32 v20, 2, v20
v_mfma_f32_16x16x32_bf16 v[52:55], a[132:135], a[84:87], v[52:55]
s_lshl_b32 s22, s22, 2
v_mfma_f32_16x16x32_bf16 v[60:63], a[128:131], a[88:91], v[60:63]
s_add_u32 s66, s70, s22
ds_read_b64_tr_b16 a[142:143], v23 offset:18432
v_add_u32 v23, 32768, v23
v_mfma_f32_16x16x32_bf16 v[60:63], a[132:135], a[92:95], v[60:63]
s_lshl_b32 s67, s20, 20
v_mfma_f32_16x16x32_bf16 v[68:71], a[128:131], a[96:99], v[68:71]
s_lshl_b32 s22, s37, 16
ds_read_b128 a[8:11], v2 offset:34816
v_mfma_f32_16x16x32_bf16 v[68:71], a[132:135], a[100:103], v[68:71]
s_add_u32 s67, s67, s22
v_mfma_f32_16x16x32_bf16 v[76:79], a[128:131], a[104:107], v[76:79]
s_lshl_b32 s22, s3, 11
ds_read_b128 a[12:15], v3 offset:34816
v_mfma_f32_16x16x32_bf16 v[76:79], a[132:135], a[108:111], v[76:79]
s_add_u32 s67, s67, s22
ds_read_b128 a[16:19], v2 offset:36864
v_mfma_f32_16x16x32_bf16 v[84:87], a[128:131], a[112:115], v[84:87]
s_add_u32 s67, s67, 33554432
ds_read_b128 a[20:23], v3 offset:36864
v_mfma_f32_16x16x32_bf16 v[84:87], a[132:135], a[116:119], v[84:87]
s_mov_b32 s68, 1035512379
v_mfma_f32_16x16x32_bf16 v[92:95], a[128:131], a[120:123], v[92:95]
s_mov_b32 s69, 1035512379
ds_read_b128 a[24:27], v2 offset:38912
v_mfma_f32_16x16x32_bf16 v[92:95], a[132:135], a[124:127], v[92:95]
s_waitcnt lgkmcnt(9)
v_mfma_f32_16x16x32_bf16 v[100:103], a[136:139], a[64:67], v[100:103]
s_waitcnt lgkmcnt(5)
ds_read_b64_tr_b16 a[128:129], v24 offset:0
v_mfma_f32_16x16x32_bf16 v[100:103], a[140:143], a[68:71], v[100:103]
v_mfma_f32_16x16x32_bf16 v[108:111], a[136:139], a[72:75], v[108:111]
ds_read_b64_tr_b16 a[130:131], v24 offset:2048
v_mfma_f32_16x16x32_bf16 v[108:111], a[140:143], a[76:79], v[108:111]
ds_read_b128 a[28:31], v3 offset:38912
v_mfma_f32_16x16x32_bf16 v[116:119], a[136:139], a[80:83], v[116:119]
ds_read_b64_tr_b16 a[132:133], v24 offset:16384
v_mfma_f32_16x16x32_bf16 v[116:119], a[140:143], a[84:87], v[116:119]
v_mfma_f32_16x16x32_bf16 v[124:127], a[136:139], a[88:91], v[124:127]
ds_read_b64_tr_b16 a[134:135], v24 offset:18432
v_add_u32 v24, 32768, v24
v_mfma_f32_16x16x32_bf16 v[124:127], a[140:143], a[92:95], v[124:127]
v_mfma_f32_16x16x32_bf16 v[132:135], a[136:139], a[96:99], v[132:135]
ds_read_b128 a[32:35], v2 offset:40960
v_mfma_f32_16x16x32_bf16 v[132:135], a[140:143], a[100:103], v[132:135]
v_mfma_f32_16x16x32_bf16 v[140:143], a[136:139], a[104:107], v[140:143]
ds_read_b128 a[36:39], v3 offset:40960
v_mfma_f32_16x16x32_bf16 v[140:143], a[140:143], a[108:111], v[140:143]
ds_read_b128 a[40:43], v2 offset:43008
v_mfma_f32_16x16x32_bf16 v[148:151], a[136:139], a[112:115], v[148:151]
ds_read_b128 a[44:47], v3 offset:43008
v_mfma_f32_16x16x32_bf16 v[148:151], a[140:143], a[116:119], v[148:151]
v_mfma_f32_16x16x32_bf16 v[156:159], a[136:139], a[120:123], v[156:159]
ds_read_b128 a[48:51], v2 offset:45056
v_mfma_f32_16x16x32_bf16 v[156:159], a[140:143], a[124:127], v[156:159]
s_waitcnt lgkmcnt(8)
v_mfma_f32_16x16x32_bf16 v[164:167], a[128:131], a[64:67], v[164:167]
s_waitcnt lgkmcnt(5)
ds_read_b64_tr_b16 a[136:137], v25 offset:0
v_mfma_f32_16x16x32_bf16 v[164:167], a[132:135], a[68:71], v[164:167]
v_mfma_f32_16x16x32_bf16 v[172:175], a[128:131], a[72:75], v[172:175]
ds_read_b64_tr_b16 a[138:139], v25 offset:2048
v_mfma_f32_16x16x32_bf16 v[172:175], a[132:135], a[76:79], v[172:175]
ds_read_b128 a[52:55], v3 offset:45056
v_mfma_f32_16x16x32_bf16 v[180:183], a[128:131], a[80:83], v[180:183]
ds_read_b64_tr_b16 a[140:141], v25 offset:16384
v_mfma_f32_16x16x32_bf16 v[180:183], a[132:135], a[84:87], v[180:183]
v_mfma_f32_16x16x32_bf16 v[188:191], a[128:131], a[88:91], v[188:191]
ds_read_b64_tr_b16 a[142:143], v25 offset:18432
v_add_u32 v25, 32768, v25
v_mfma_f32_16x16x32_bf16 v[188:191], a[132:135], a[92:95], v[188:191]
v_mfma_f32_16x16x32_bf16 v[196:199], a[128:131], a[96:99], v[196:199]
ds_read_b128 a[56:59], v2 offset:47104
v_mfma_f32_16x16x32_bf16 v[196:199], a[132:135], a[100:103], v[196:199]
v_mfma_f32_16x16x32_bf16 v[204:207], a[128:131], a[104:107], v[204:207]
ds_read_b128 a[60:63], v3 offset:47104
v_mfma_f32_16x16x32_bf16 v[204:207], a[132:135], a[108:111], v[204:207]
v_mfma_f32_16x16x32_bf16 v[212:215], a[128:131], a[112:115], v[212:215]
v_mfma_f32_16x16x32_bf16 v[212:215], a[132:135], a[116:119], v[212:215]
v_mfma_f32_16x16x32_bf16 v[220:223], a[128:131], a[120:123], v[220:223]
v_mfma_f32_16x16x32_bf16 v[220:223], a[132:135], a[124:127], v[220:223]
s_waitcnt vmcnt(0) lgkmcnt(0)
s_barrier
v_mfma_f32_16x16x32_bf16 v[224:227], a[136:139], a[64:67], v[224:227]
ds_read_b64_tr_b16 a[128:129], v22 offset:0
v_mfma_f32_16x16x32_bf16 v[224:227], a[140:143], a[68:71], v[224:227]
buffer_store_dword v27, v26, s[4:7], s66 offen sc1
v_mfma_f32_16x16x32_bf16 v[228:231], a[136:139], a[72:75], v[228:231]
ds_read_b64_tr_b16 a[130:131], v22 offset:2048
v_mfma_f32_16x16x32_bf16 v[228:231], a[140:143], a[76:79], v[228:231]
v_mfma_f32_16x16x32_bf16 v[232:235], a[136:139], a[80:83], v[232:235]
ds_read_b64_tr_b16 a[132:133], v22 offset:16384
v_mfma_f32_16x16x32_bf16 v[232:235], a[140:143], a[84:87], v[232:235]
v_mfma_f32_16x16x32_bf16 v[236:239], a[136:139], a[88:91], v[236:239]
ds_read_b64_tr_b16 a[134:135], v22 offset:18432
v_mfma_f32_16x16x32_bf16 v[236:239], a[140:143], a[92:95], v[236:239]
v_mfma_f32_16x16x32_bf16 v[240:243], a[136:139], a[96:99], v[240:243]
v_mfma_f32_16x16x32_bf16 v[240:243], a[140:143], a[100:103], v[240:243]
v_mfma_f32_16x16x32_bf16 v[244:247], a[136:139], a[104:107], v[244:247]
v_mfma_f32_16x16x32_bf16 v[244:247], a[140:143], a[108:111], v[244:247]
v_mfma_f32_16x16x32_bf16 v[248:251], a[136:139], a[112:115], v[248:251]
v_mfma_f32_16x16x32_bf16 v[248:251], a[140:143], a[116:119], v[248:251]
v_mfma_f32_16x16x32_bf16 v[252:255], a[136:139], a[120:123], v[252:255]
v_mfma_f32_16x16x32_bf16 v[252:255], a[140:143], a[124:127], v[252:255]
s_waitcnt lgkmcnt(2)
s_and_b32 s22, s2, 0xf0
s_cmp_eq_u32 s22, 0xf0
s_cbranch_scc1 M_own
s_bitcmp1_b32 s2, 4
s_cbranch_scc1 M_conv
M_own:
v_mfma_f32_16x16x32_bf16 v[36:39], a[128:131], a[0:3], v[36:39]
s_waitcnt lgkmcnt(0)
ds_read_b64_tr_b16 a[136:137], v23 offset:0
v_lshrrev_b32 v28, 6, v0
v_mfma_f32_16x16x32_bf16 v[36:39], a[132:135], a[4:7], v[36:39]
s_cmp_eq_u32 s21, 7
v_lshl_add_u32 v28, v28, 11, v1
v_add_u32 v28, 65536, v28
v_mfma_f32_16x16x32_bf16 v[44:47], a[128:131], a[8:11], v[44:47]
s_cselect_b32 s67, 3221225472, s67
ds_read_b64_tr_b16 a[138:139], v23 offset:2048
v_lshrrev_b32 v3, 6, v0
v_mfma_f32_16x16x32_bf16 v[44:47], a[132:135], a[12:15], v[44:47]
s_lshl_b32 s18, s3, 13
v_and_b32 v4, 63, v0
v_add_u32 v2, 0x10000, v1
v_mfma_f32_16x16x32_bf16 v[52:55], a[128:131], a[16:19], v[52:55]
s_lshl_b32 s30, s20, 20
ds_read_b64_tr_b16 a[140:141], v23 offset:16384
v_and_b32 v5, 15, v4
v_mfma_f32_16x16x32_bf16 v[52:55], a[132:135], a[20:23], v[52:55]
s_add_u32 s30, s30, s18
v_lshrrev_b32 v6, 4, v4
v_lshlrev_b32 v6, 2, v6
v_mfma_f32_16x16x32_bf16 v[60:63], a[128:131], a[24:27], v[60:63]
s_lshl_b32 s22, s21, 1
ds_read_b64_tr_b16 a[142:143], v23 offset:18432
v_sub_u32 v5, v5, v6
v_mfma_f32_16x16x32_bf16 v[60:63], a[132:135], a[28:31], v[60:63]
s_sub_u32 s22, 14, s22
v_lshl_add_u32 v5, v3, 4, v5
v_cmp_gt_i32 s[32:33], 0, v5
v_mfma_f32_16x16x32_bf16 v[68:71], a[128:131], a[32:35], v[68:71]
s_lshl_b32 s22, s22, 15
v_cmp_gt_i32 s[34:35], 1, v5
v_cmp_gt_i32 s[36:37], 2, v5
v_mfma_f32_16x16x32_bf16 v[68:71], a[132:135], a[36:39], v[68:71]
s_add_u32 s8, s30, s22
v_cmp_gt_i32 s[38:39], 3, v5
v_cmp_gt_i32 s[40:41], 16, v5
v_mfma_f32_16x16x32_bf16 v[76:79], a[128:131], a[40:43], v[76:79]
s_mov_b32 s10, 3221225472
v_cmp_gt_i32 s[42:43], 17, v5
v_cmp_gt_i32 s[44:45], 18, v5
v_mfma_f32_16x16x32_bf16 v[76:79], a[132:135], a[44:47], v[76:79]
s_mov_b32 s11, 0
v_cmp_gt_i32 s[46:47], 19, v5
v_cmp_gt_i32 s[48:49], 32, v5
v_mfma_f32_16x16x32_bf16 v[84:87], a[128:131], a[48:51], v[84:87]
s_mov_b32 s14, 3221225472
v_cmp_gt_i32 s[50:51], 33, v5
v_cmp_gt_i32 s[52:53], 34, v5
v_mfma_f32_16x16x32_bf16 v[84:87], a[132:135], a[52:55], v[84:87]
s_sub_u32 s29, 15, s21
v_cmp_gt_i32 s[54:55], 35, v5
v_cmp_gt_i32 s[56:57], 48, v5
v_mfma_f32_16x16x32_bf16 v[92:95], a[128:131], a[56:59], v[92:95]
s_cmp_eq_u32 s21, 7
v_cmp_gt_i32 s[58:59], 49, v5
v_cmp_gt_i32 s[60:61], 50, v5
v_mfma_f32_16x16x32_bf16 v[92:95], a[132:135], a[60:63], v[92:95]
s_waitcnt lgkmcnt(2)
v_cmp_gt_i32 s[62:63], 51, v5
v_mov_b32 v7, 0xff800000
v_mfma_f32_16x16x32_bf16 v[100:103], a[136:139], a[0:3], v[100:103]
s_waitcnt lgkmcnt(0)
ds_read_b64_tr_b16 a[128:129], v24 offset:0
v_mov_b32 v6, 1
v_mfma_f32_16x16x32_bf16 v[100:103], a[140:143], a[4:7], v[100:103]
s_cselect_b32 s24, 0, 1
v_mov_b32 v5, v26
v_mfma_f32_16x16x32_bf16 v[108:111], a[136:139], a[8:11], v[108:111]
s_bitcmp1_b32 s2, 4
ds_read_b64_tr_b16 a[130:131], v24 offset:2048
v_mfma_f32_16x16x32_bf16 v[108:111], a[140:143], a[12:15], v[108:111]
s_cselect_b32 s9, 16, 18
v_mfma_f32_16x16x32_bf16 v[116:119], a[136:139], a[16:19], v[116:119]
s_cselect_b32 s19, 7, 8
ds_read_b64_tr_b16 a[132:133], v24 offset:16384
v_mfma_f32_16x16x32_bf16 v[116:119], a[140:143], a[20:23], v[116:119]
s_cselect_b32 s29, 7, s29
v_mfma_f32_16x16x32_bf16 v[124:127], a[136:139], a[24:27], v[124:127]
s_add_u32 s12, s8, 16777216
ds_read_b64_tr_b16 a[134:135], v24 offset:18432
v_mul_f32 v36, s68, v36
v_mfma_f32_16x16x32_bf16 v[124:127], a[140:143], a[28:31], v[124:127]
s_mov_b32 s13, s9
v_mul_f32 v37, s68, v37
v_mul_f32 v38, s68, v38
v_mfma_f32_16x16x32_bf16 v[132:135], a[136:139], a[32:35], v[132:135]
s_mov_b32 s15, s11
v_mul_f32 v39, s68, v39
v_mul_f32 v100, s68, v100
v_mfma_f32_16x16x32_bf16 v[132:135], a[140:143], a[36:39], v[132:135]
v_mul_f32 v101, s68, v101
v_mul_f32 v102, s68, v102
v_mfma_f32_16x16x32_bf16 v[140:143], a[136:139], a[40:43], v[140:143]
v_mul_f32 v103, s68, v103
v_cvt_pk_bf16_f32 v36, v36, v37
v_mfma_f32_16x16x32_bf16 v[140:143], a[140:143], a[44:47], v[140:143]
v_cvt_pk_bf16_f32 v37, v38, v39
v_cvt_pk_bf16_f32 v38, v100, v101
v_mfma_f32_16x16x32_bf16 v[148:151], a[136:139], a[48:51], v[148:151]
v_cvt_pk_bf16_f32 v39, v102, v103
v_mul_f32 v44, s68, v44
v_mfma_f32_16x16x32_bf16 v[148:151], a[140:143], a[52:55], v[148:151]
ds_write_b128 v28, v[36:39] offset:0
v_mul_f32 v45, s68, v45
v_mfma_f32_16x16x32_bf16 v[156:159], a[136:139], a[56:59], v[156:159]
s_add_u32 s23, s67, 0
buffer_store_dwordx4 v[36:39], v1, s[4:7], s23 offen offset:0 sc1
v_mfma_f32_16x16x32_bf16 v[156:159], a[140:143], a[60:63], v[156:159]
s_waitcnt lgkmcnt(2)
v_mul_f32 v46, s68, v46
v_mul_f32 v47, s68, v47
v_mfma_f32_16x16x32_bf16 v[164:167], a[128:131], a[0:3], v[164:167]
s_waitcnt lgkmcnt(0)
ds_read_b64_tr_b16 a[136:137], v25 offset:0
v_mul_f32 v108, s68, v108
v_mfma_f32_16x16x32_bf16 v[164:167], a[132:135], a[4:7], v[164:167]
v_mul_f32 v109, s68, v109
v_mul_f32 v110, s68, v110
v_mfma_f32_16x16x32_bf16 v[172:175], a[128:131], a[8:11], v[172:175]
ds_read_b64_tr_b16 a[138:139], v25 offset:2048
v_mul_f32 v111, s68, v111
v_mfma_f32_16x16x32_bf16 v[172:175], a[132:135], a[12:15], v[172:175]
v_cvt_pk_bf16_f32 v44, v44, v45
v_cvt_pk_bf16_f32 v45, v46, v47
v_mfma_f32_16x16x32_bf16 v[180:183], a[128:131], a[16:19], v[180:183]
ds_read_b64_tr_b16 a[140:141], v25 offset:16384
v_cvt_pk_bf16_f32 v46, v108, v109
v_mfma_f32_16x16x32_bf16 v[180:183], a[132:135], a[20:23], v[180:183]
v_cvt_pk_bf16_f32 v47, v110, v111
v_mul_f32 v52, s68, v52
v_mfma_f32_16x16x32_bf16 v[188:191], a[128:131], a[24:27], v[188:191]
ds_read_b64_tr_b16 a[142:143], v25 offset:18432
v_mul_f32 v53, s68, v53
v_mfma_f32_16x16x32_bf16 v[188:191], a[132:135], a[28:31], v[188:191]
ds_write_b128 v28, v[44:47] offset:8192
v_mul_f32 v54, s68, v54
v_mfma_f32_16x16x32_bf16 v[196:199], a[128:131], a[32:35], v[196:199]
s_add_u32 s23, s67, 8192
buffer_store_dwordx4 v[44:47], v1, s[4:7], s23 offen offset:0 sc1
v_mfma_f32_16x16x32_bf16 v[196:199], a[132:135], a[36:39], v[196:199]
v_mul_f32 v55, s68, v55
v_mul_f32 v116, s68, v116
v_mfma_f32_16x16x32_bf16 v[204:207], a[128:131], a[40:43], v[204:207]
v_mul_f32 v117, s68, v117
v_mul_f32 v118, s68, v118
v_mfma_f32_16x16x32_bf16 v[204:207], a[132:135], a[44:47], v[204:207]
v_mul_f32 v119, s68, v119
v_cvt_pk_bf16_f32 v52, v52, v53
v_mfma_f32_16x16x32_bf16 v[212:215], a[128:131], a[48:51], v[212:215]
v_cvt_pk_bf16_f32 v53, v54, v55
v_cvt_pk_bf16_f32 v54, v116, v117
v_mfma_f32_16x16x32_bf16 v[212:215], a[132:135], a[52:55], v[212:215]
v_cvt_pk_bf16_f32 v55, v118, v119
v_mul_f32 v60, s68, v60
v_mfma_f32_16x16x32_bf16 v[220:223], a[128:131], a[56:59], v[220:223]
ds_write_b128 v28, v[52:55] offset:16384
v_mul_f32 v61, s68, v61
v_mfma_f32_16x16x32_bf16 v[220:223], a[132:135], a[60:63], v[220:223]
s_waitcnt lgkmcnt(2)
s_add_u32 s23, s67, 16384
buffer_store_dwordx4 v[52:55], v1, s[4:7], s23 offen offset:0 sc1
v_mfma_f32_16x16x32_bf16 v[224:227], a[136:139], a[0:3], v[224:227]
s_waitcnt lgkmcnt(0)
v_mul_f32 v62, s68, v62
v_mul_f32 v63, s68, v63
v_mfma_f32_16x16x32_bf16 v[224:227], a[140:143], a[4:7], v[224:227]
v_mul_f32 v124, s68, v124
v_mul_f32 v125, s68, v125
v_mfma_f32_16x16x32_bf16 v[228:231], a[136:139], a[8:11], v[228:231]
v_mul_f32 v126, s68, v126
v_mul_f32 v127, s68, v127
v_mfma_f32_16x16x32_bf16 v[228:231], a[140:143], a[12:15], v[228:231]
v_cvt_pk_bf16_f32 v60, v60, v61
v_cvt_pk_bf16_f32 v61, v62, v63
v_mfma_f32_16x16x32_bf16 v[232:235], a[136:139], a[16:19], v[232:235]
v_cvt_pk_bf16_f32 v62, v124, v125
v_cvt_pk_bf16_f32 v63, v126, v127
v_mfma_f32_16x16x32_bf16 v[232:235], a[140:143], a[20:23], v[232:235]
ds_write_b128 v28, v[60:63] offset:24576
v_mul_f32 v68, s68, v68
v_mfma_f32_16x16x32_bf16 v[236:239], a[136:139], a[24:27], v[236:239]
s_add_u32 s23, s67, 24576
buffer_store_dwordx4 v[60:63], v1, s[4:7], s23 offen offset:0 sc1
v_mfma_f32_16x16x32_bf16 v[236:239], a[140:143], a[28:31], v[236:239]
v_mul_f32 v69, s68, v69
v_mul_f32 v70, s68, v70
v_mfma_f32_16x16x32_bf16 v[240:243], a[136:139], a[32:35], v[240:243]
v_mul_f32 v71, s68, v71
v_mul_f32 v132, s68, v132
v_mfma_f32_16x16x32_bf16 v[240:243], a[140:143], a[36:39], v[240:243]
v_mul_f32 v133, s68, v133
v_mul_f32 v134, s68, v134
v_mfma_f32_16x16x32_bf16 v[244:247], a[136:139], a[40:43], v[244:247]
v_mul_f32 v135, s68, v135
v_cvt_pk_bf16_f32 v68, v68, v69
v_mfma_f32_16x16x32_bf16 v[244:247], a[140:143], a[44:47], v[244:247]
v_cvt_pk_bf16_f32 v69, v70, v71
v_cvt_pk_bf16_f32 v70, v132, v133
v_mfma_f32_16x16x32_bf16 v[248:251], a[136:139], a[48:51], v[248:251]
v_cvt_pk_bf16_f32 v71, v134, v135
v_mfma_f32_16x16x32_bf16 v[248:251], a[140:143], a[52:55], v[248:251]
ds_write_b128 v28, v[68:71] offset:32768
v_mfma_f32_16x16x32_bf16 v[252:255], a[136:139], a[56:59], v[252:255]
s_add_u32 s23, s67, 32768
buffer_store_dwordx4 v[68:71], v1, s[4:7], s23 offen offset:0 sc1
v_mfma_f32_16x16x32_bf16 v[252:255], a[140:143], a[60:63], v[252:255]
buffer_load_dword v21, v20, s[4:7], s70 offen sc1
v_pk_mul_f32 v[76:77], v[76:77], s[68:69]
v_pk_mul_f32 v[78:79], v[78:79], s[68:69]
v_pk_mul_f32 v[140:141], v[140:141], s[68:69]
v_pk_mul_f32 v[142:143], v[142:143], s[68:69]
v_cvt_pk_bf16_f32 v76, v76, v77
v_cvt_pk_bf16_f32 v77, v78, v79
v_cvt_pk_bf16_f32 v78, v140, v141
v_cvt_pk_bf16_f32 v79, v142, v143
ds_write_b128 v28, v[76:79] offset:40960
s_add_u32 s23, s67, 40960
buffer_store_dwordx4 v[76:79], v1, s[4:7], s23 offen offset:0 sc1
v_pk_mul_f32 v[84:85], v[84:85], s[68:69]
v_pk_mul_f32 v[86:87], v[86:87], s[68:69]
v_pk_mul_f32 v[148:149], v[148:149], s[68:69]
v_pk_mul_f32 v[150:151], v[150:151], s[68:69]
v_cvt_pk_bf16_f32 v84, v84, v85
v_cvt_pk_bf16_f32 v85, v86, v87
v_cvt_pk_bf16_f32 v86, v148, v149
v_cvt_pk_bf16_f32 v87, v150, v151
ds_write_b128 v28, v[84:87] offset:49152
s_add_u32 s23, s67, 49152
buffer_store_dwordx4 v[84:87], v1, s[4:7], s23 offen offset:0 sc1
v_pk_mul_f32 v[92:93], v[92:93], s[68:69]
v_pk_mul_f32 v[94:95], v[94:95], s[68:69]
v_pk_mul_f32 v[156:157], v[156:157], s[68:69]
v_pk_mul_f32 v[158:159], v[158:159], s[68:69]
v_cvt_pk_bf16_f32 v92, v92, v93
v_cvt_pk_bf16_f32 v93, v94, v95
v_cvt_pk_bf16_f32 v94, v156, v157
v_cvt_pk_bf16_f32 v95, v158, v159
ds_write_b128 v28, v[92:95] offset:57344
s_add_u32 s23, s67, 57344
buffer_store_dwordx4 v[92:95], v1, s[4:7], s23 offen offset:0 sc1
v_pk_mul_f32 v[164:165], v[164:165], s[68:69]
v_pk_mul_f32 v[166:167], v[166:167], s[68:69]
v_pk_mul_f32 v[224:225], v[224:225], s[68:69]
v_pk_mul_f32 v[226:227], v[226:227], s[68:69]
v_cvt_pk_bf16_f32 v164, v164, v165
v_cvt_pk_bf16_f32 v165, v166, v167
v_cvt_pk_bf16_f32 v166, v224, v225
v_cvt_pk_bf16_f32 v167, v226, v227
ds_write_b128 v28, v[164:167] offset:1024
s_add_u32 s23, s67, 0
buffer_store_dwordx4 v[164:167], v1, s[4:7], s23 offen offset:1024 sc1
v_pk_mul_f32 v[172:173], v[172:173], s[68:69]
v_pk_mul_f32 v[174:175], v[174:175], s[68:69]
v_pk_mul_f32 v[228:229], v[228:229], s[68:69]
v_pk_mul_f32 v[230:231], v[230:231], s[68:69]
v_cvt_pk_bf16_f32 v172, v172, v173
v_cvt_pk_bf16_f32 v173, v174, v175
v_cvt_pk_bf16_f32 v174, v228, v229
v_cvt_pk_bf16_f32 v175, v230, v231
ds_write_b128 v28, v[172:175] offset:9216
s_add_u32 s23, s67, 8192
buffer_store_dwordx4 v[172:175], v1, s[4:7], s23 offen offset:1024 sc1
v_pk_mul_f32 v[180:181], v[180:181], s[68:69]
v_pk_mul_f32 v[182:183], v[182:183], s[68:69]
v_pk_mul_f32 v[232:233], v[232:233], s[68:69]
v_pk_mul_f32 v[234:235], v[234:235], s[68:69]
v_cvt_pk_bf16_f32 v180, v180, v181
v_cvt_pk_bf16_f32 v181, v182, v183
v_cvt_pk_bf16_f32 v182, v232, v233
v_cvt_pk_bf16_f32 v183, v234, v235
ds_write_b128 v28, v[180:183] offset:17408
s_add_u32 s23, s67, 16384
buffer_store_dwordx4 v[180:183], v1, s[4:7], s23 offen offset:1024 sc1
v_pk_mul_f32 v[188:189], v[188:189], s[68:69]
v_pk_mul_f32 v[190:191], v[190:191], s[68:69]
v_pk_mul_f32 v[236:237], v[236:237], s[68:69]
v_pk_mul_f32 v[238:239], v[238:239], s[68:69]
v_cvt_pk_bf16_f32 v188, v188, v189
v_cvt_pk_bf16_f32 v189, v190, v191
v_cvt_pk_bf16_f32 v190, v236, v237
v_cvt_pk_bf16_f32 v191, v238, v239
ds_write_b128 v28, v[188:191] offset:25600
s_add_u32 s23, s67, 24576
buffer_store_dwordx4 v[188:191], v1, s[4:7], s23 offen offset:1024 sc1
v_pk_mul_f32 v[196:197], v[196:197], s[68:69]
v_pk_mul_f32 v[198:199], v[198:199], s[68:69]
v_pk_mul_f32 v[240:241], v[240:241], s[68:69]
v_pk_mul_f32 v[242:243], v[242:243], s[68:69]
v_cvt_pk_bf16_f32 v196, v196, v197
v_cvt_pk_bf16_f32 v197, v198, v199
v_cvt_pk_bf16_f32 v198, v240, v241
v_cvt_pk_bf16_f32 v199, v242, v243
ds_write_b128 v28, v[196:199] offset:33792
s_add_u32 s23, s67, 32768
buffer_store_dwordx4 v[196:199], v1, s[4:7], s23 offen offset:1024 sc1
v_pk_mul_f32 v[204:205], v[204:205], s[68:69]
v_pk_mul_f32 v[206:207], v[206:207], s[68:69]
v_pk_mul_f32 v[244:245], v[244:245], s[68:69]
v_pk_mul_f32 v[246:247], v[246:247], s[68:69]
v_cvt_pk_bf16_f32 v204, v204, v205
v_cvt_pk_bf16_f32 v205, v206, v207
v_cvt_pk_bf16_f32 v206, v244, v245
v_cvt_pk_bf16_f32 v207, v246, v247
ds_write_b128 v28, v[204:207] offset:41984
s_add_u32 s23, s67, 40960
buffer_store_dwordx4 v[204:207], v1, s[4:7], s23 offen offset:1024 sc1
v_pk_mul_f32 v[212:213], v[212:213], s[68:69]
v_pk_mul_f32 v[214:215], v[214:215], s[68:69]
v_pk_mul_f32 v[248:249], v[248:249], s[68:69]
v_pk_mul_f32 v[250:251], v[250:251], s[68:69]
v_cvt_pk_bf16_f32 v212, v212, v213
v_cvt_pk_bf16_f32 v213, v214, v215
v_cvt_pk_bf16_f32 v214, v248, v249
v_cvt_pk_bf16_f32 v215, v250, v251
ds_write_b128 v28, v[212:215] offset:50176
s_add_u32 s23, s67, 49152
buffer_store_dwordx4 v[212:215], v1, s[4:7], s23 offen offset:1024 sc1
v_pk_mul_f32 v[220:221], v[220:221], s[68:69]
v_pk_mul_f32 v[222:223], v[222:223], s[68:69]
v_pk_mul_f32 v[252:253], v[252:253], s[68:69]
v_pk_mul_f32 v[254:255], v[254:255], s[68:69]
v_cvt_pk_bf16_f32 v220, v220, v221
v_cvt_pk_bf16_f32 v221, v222, v223
v_cvt_pk_bf16_f32 v222, v252, v253
v_cvt_pk_bf16_f32 v223, v254, v255
ds_write_b128 v28, v[220:223] offset:58368
s_add_u32 s23, s67, 57344
buffer_store_dwordx4 v[220:223], v1, s[4:7], s23 offen offset:1024 sc1
s_waitcnt vmcnt(11)
v_cmp_gt_u32 vcc, 1, v21
s_cbranch_vccnz M_kvspin
M_kvok:
s_add_u32 m0, s18, 0
s_nop 0
buffer_load_dwordx4 v1, s[4:7], s8 offen offset:0 sc1 lds
buffer_load_dwordx4 v1, s[4:7], s8 offen offset:1024 sc1 lds
buffer_load_dwordx4 v1, s[4:7], s8 offen offset:2048 sc1 lds
buffer_load_dwordx4 v1, s[4:7], s8 offen offset:3072 sc1 lds
s_add_u32 s8, s8, 4096
s_add_u32 m0, s18, 4096
s_nop 0
buffer_load_dwordx4 v1, s[4:7], s8 offen offset:0 sc1 lds
buffer_load_dwordx4 v1, s[4:7], s8 offen offset:1024 sc1 lds
buffer_load_dwordx4 v1, s[4:7], s8 offen offset:2048 sc1 lds
buffer_load_dwordx4 v1, s[4:7], s8 offen offset:3072 sc1 lds
s_add_u32 s8, s8, 28672
s_sub_u32 s9, s9, 1
s_cmp_eq_u32 s9, 0
s_cselect_b32 s8, s10, s8
s_cselect_b32 s9, s11, s9
s_cselect_b32 s10, 3221225472, s10
v_add_u32 v28, s18, v2
s_waitcnt lgkmcnt(0)
s_barrier
ds_read_b128 a[0:3], v28 offset:0
ds_read_b128 a[4:7], v28 offset:1024
ds_read_b128 a[8:11], v28 offset:2048
ds_read_b128 a[12:15], v28 offset:3072
ds_read_b128 a[16:19], v28 offset:4096
ds_read_b128 a[20:23], v28 offset:5120
ds_read_b128 a[24:27], v28 offset:6144
ds_read_b128 a[28:31], v28 offset:7168
ds_read_b128 a[32:35], v28 offset:32768
ds_read_b128 a[36:39], v28 offset:33792
ds_read_b128 a[40:43], v28 offset:34816
ds_read_b128 a[44:47], v28 offset:35840
ds_read_b128 a[48:51], v28 offset:36864
ds_read_b128 a[52:55], v28 offset:37888
ds_read_b128 a[56:59], v28 offset:38912
ds_read_b128 a[60:63], v28 offset:39936
s_mov_b32 s25, 1266679808
s_lshl_b32 s22, s21, 3
s_add_u32 s28, s70, s22
s_add_u32 s28, s28, 4100
s_lshl_b32 s26, s21, 16
s_add_u32 s26, s26, s30
s_add_u32 s26, s26, 33554432
s_lshl_b32 s76, s20, 3
s_add_u32 s76, s76, s21
s_lshl_b32 s76, s76, 2
s_add_u32 s76, s76, s3
s_lshl_b32 s27, s76, 10
s_add_u32 s27, s27, 75497472
s_lshl_b32 s76, s76, 14
s_add_u32 s76, s76, 67108864
s_lshl_b32 s81, s20, 2
s_add_u32 s81, s81, s3
s_mul_i32 s81, s81, 57344
s_cmp_eq_u32 s24, 1
s_cselect_b32 s80, s28, s70
s_cselect_b32 s77, s76, 3221225472
s_cselect_b32 s78, s27, 3221225472
s_add_u32 s22, s66, 64
s_mov_b32 s71, 3221225472
s_waitcnt vmcnt(8)
s_barrier
buffer_store_dword v6, v5, s[4:7], s22 offen sc1
s_add_u32 m0, s18, 32768
s_nop 0
buffer_load_dwordx4 v1, s[4:7], s8 offen offset:0 sc1 lds
buffer_load_dwordx4 v1, s[4:7], s8 offen offset:1024 sc1 lds
buffer_load_dwordx4 v1, s[4:7], s8 offen offset:2048 sc1 lds
buffer_load_dwordx4 v1, s[4:7], s8 offen offset:3072 sc1 lds
s_add_u32 s8, s8, 4096
s_add_u32 m0, s18, 36864
s_nop 0
buffer_load_dwordx4 v1, s[4:7], s8 offen offset:0 sc1 lds
buffer_load_dwordx4 v1, s[4:7], s8 offen offset:1024 sc1 lds
buffer_load_dwordx4 v1, s[4:7], s8 offen offset:2048 sc1 lds
buffer_load_dwordx4 v1, s[4:7], s8 offen offset:3072 sc1 lds
s_add_u32 s8, s8, 28672
s_sub_u32 s9, s9, 1
s_cmp_eq_u32 s9, 0
s_cselect_b32 s8, s10, s8
s_cselect_b32 s9, s11, s9
s_cselect_b32 s10, 3221225472, s10
v_mov_b64 v[128:129], 0
v_mov_b64 v[130:131], 0
v_mov_b64 v[132:133], 0
v_mov_b64 v[134:135], 0
v_mov_b64 v[136:137], 0
v_mov_b64 v[138:139], 0
v_mov_b64 v[140:141], 0
v_mov_b64 v[142:143], 0
v_mov_b64 v[144:145], 0
v_mov_b64 v[146:147], 0
v_mov_b64 v[148:149], 0
v_mov_b64 v[150:151], 0
v_mov_b64 v[152:153], 0
v_mov_b64 v[154:155], 0
v_mov_b64 v[156:157], 0
v_mov_b64 v[158:159], 0
v_mov_b64 v[160:161], 0
v_mov_b64 v[162:163], 0
v_mov_b64 v[164:165], 0
v_mov_b64 v[166:167], 0
v_mov_b64 v[168:169], 0
v_mov_b64 v[170:171], 0
v_mov_b64 v[172:173], 0
v_mov_b64 v[174:175], 0
v_mov_b64 v[176:177], 0
v_mov_b64 v[178:179], 0
v_mov_b64 v[180:181], 0
v_mov_b64 v[182:183], 0
v_mov_b64 v[184:185], 0
v_mov_b64 v[186:187], 0
v_mov_b64 v[188:189], 0
v_mov_b64 v[190:191], 0
v_mov_b64 v[192:193], 0
v_mov_b64 v[194:195], 0
v_mov_b64 v[196:197], 0
v_mov_b64 v[198:199], 0
v_mov_b64 v[200:201], 0
v_mov_b64 v[202:203], 0
v_mov_b64 v[204:205], 0
v_mov_b64 v[206:207], 0
v_mov_b64 v[208:209], 0
v_mov_b64 v[210:211], 0
v_mov_b64 v[212:213], 0
v_mov_b64 v[214:215], 0
v_mov_b64 v[216:217], 0
v_mov_b64 v[218:219], 0
v_mov_b64 v[220:221], 0
v_mov_b64 v[222:223], 0
v_mov_b64 v[224:225], 0
v_mov_b64 v[226:227], 0
v_mov_b64 v[228:229], 0
v_mov_b64 v[230:231], 0
v_mov_b64 v[232:233], 0
v_mov_b64 v[234:235], 0
v_mov_b64 v[236:237], 0
v_mov_b64 v[238:239], 0
v_mov_b64 v[240:241], 0
v_mov_b64 v[242:243], 0
v_mov_b64 v[244:245], 0
v_mov_b64 v[246:247], 0
v_mov_b64 v[248:249], 0
v_mov_b64 v[250:251], 0
v_mov_b64 v[252:253], 0
v_mov_b64 v[254:255], 0
v_mov_b64 v[24:25], 0
s_waitcnt vmcnt(9) lgkmcnt(0)
s_barrier
K2_item:
s_cmp_eq_u32 s19, 0
s_cbranch_scc1 K2_p0d
ds_read_b128 a[64:67], v1 offset:0
ds_read_b128 a[68:71], v1 offset:1024
ds_read_b128 a[72:75], v1 offset:2048
ds_read_b128 a[76:79], v1 offset:3072
ds_read_b128 a[80:83], v1 offset:4096
ds_read_b128 a[84:87], v1 offset:5120
ds_read_b128 a[88:91], v1 offset:6144
ds_read_b128 a[92:95], v1 offset:7168
s_waitcnt lgkmcnt(7)
v_mfma_f32_16x16x32_bf16 v[32:35], a[64:67], a[0:3], 0
s_waitcnt lgkmcnt(6)
s_add_u32 m0, s18, 65536
ds_read_b128 a[96:99], v1 offset:8192
v_mfma_f32_16x16x32_bf16 v[32:35], a[68:71], a[4:7], v[32:35]
s_waitcnt lgkmcnt(6)
buffer_load_dwordx4 v1, s[4:7], s12 offen offset:0 sc1 lds
v_mfma_f32_16x16x32_bf16 v[32:35], a[72:75], a[8:11], v[32:35]
s_waitcnt lgkmcnt(5)
ds_read_b128 a[100:103], v1 offset:9216
v_mfma_f32_16x16x32_bf16 v[32:35], a[76:79], a[12:15], v[32:35]
s_waitcnt lgkmcnt(5)
buffer_load_dwordx4 v1, s[4:7], s12 offen offset:1024 sc1 lds
v_mfma_f32_16x16x32_bf16 v[32:35], a[80:83], a[16:19], v[32:35]
s_waitcnt lgkmcnt(4)
ds_read_b128 a[104:107], v1 offset:10240
v_mfma_f32_16x16x32_bf16 v[32:35], a[84:87], a[20:23], v[32:35]
s_waitcnt lgkmcnt(4)
buffer_load_dwordx4 v1, s[4:7], s12 offen offset:2048 sc1 lds
v_mfma_f32_16x16x32_bf16 v[32:35], a[88:91], a[24:27], v[32:35]
s_waitcnt lgkmcnt(3)
ds_read_b128 a[108:111], v1 offset:11264
v_mfma_f32_16x16x32_bf16 v[32:35], a[92:95], a[28:31], v[32:35]
buffer_load_dwordx4 v1, s[4:7], s12 offen offset:3072 sc1 lds
v_mfma_f32_16x16x32_bf16 v[36:39], a[64:67], a[32:35], 0
s_add_u32 s12, s12, 4096
s_add_u32 m0, s18, 69632
ds_read_b128 a[112:115], v1 offset:12288
v_mfma_f32_16x16x32_bf16 v[36:39], a[68:71], a[36:39], v[36:39]
buffer_load_dwordx4 v1, s[4:7], s12 offen offset:0 sc1 lds
v_mfma_f32_16x16x32_bf16 v[36:39], a[72:75], a[40:43], v[36:39]
ds_read_b128 a[116:119], v1 offset:13312
v_mfma_f32_16x16x32_bf16 v[36:39], a[76:79], a[44:47], v[36:39]
buffer_load_dwordx4 v1, s[4:7], s12 offen offset:1024 sc1 lds
v_mfma_f32_16x16x32_bf16 v[36:39], a[80:83], a[48:51], v[36:39]
ds_read_b128 a[120:123], v1 offset:14336
v_max3_f32 v28, v32, v33, v34
v_mfma_f32_16x16x32_bf16 v[36:39], a[84:87], a[52:55], v[36:39]
buffer_load_dwordx4 v1, s[4:7], s12 offen offset:2048 sc1 lds
v_mfma_f32_16x16x32_bf16 v[36:39], a[88:91], a[56:59], v[36:39]
ds_read_b128 a[124:127], v1 offset:15360
v_max_f32 v28, v28, v35
v_mfma_f32_16x16x32_bf16 v[36:39], a[92:95], a[60:63], v[36:39]
s_waitcnt lgkmcnt(6)
buffer_load_dwordx4 v1, s[4:7], s12 offen offset:3072 sc1 lds
v_mfma_f32_16x16x32_bf16 v[40:43], a[96:99], a[0:3], 0
s_add_u32 s12, s12, 28672
ds_read_b128 a[64:67], v1 offset:16384
v_mov_b32 v30, v28
v_mfma_f32_16x16x32_bf16 v[40:43], a[100:103], a[4:7], v[40:43]
s_waitcnt lgkmcnt(2)
s_sub_u32 s13, s13, 1
v_mfma_f32_16x16x32_bf16 v[40:43], a[104:107], a[8:11], v[40:43]
s_cmp_eq_u32 s13, 0
ds_read_b128 a[68:71], v1 offset:17408
v_permlane16_swap_b32 v28, v30
v_mfma_f32_16x16x32_bf16 v[40:43], a[108:111], a[12:15], v[40:43]
s_cselect_b32 s12, s14, s12
v_max_f32 v28, v28, v30
v_mov_b32 v30, v28
v_mfma_f32_16x16x32_bf16 v[40:43], a[112:115], a[16:19], v[40:43]
s_cselect_b32 s13, s15, s13
ds_read_b128 a[72:75], v1 offset:18432
v_max3_f32 v29, v36, v37, v38
v_mfma_f32_16x16x32_bf16 v[40:43], a[116:119], a[20:23], v[40:43]
s_cselect_b32 s14, 3221225472, s14
v_permlane32_swap_b32 v28, v30
v_max_f32 v28, v28, v30
v_mfma_f32_16x16x32_bf16 v[40:43], a[120:123], a[24:27], v[40:43]
s_waitcnt lgkmcnt(3)
ds_read_b128 a[76:79], v1 offset:19456
v_sub_f32 v16, 0, v28
v_mfma_f32_16x16x32_bf16 v[40:43], a[124:127], a[28:31], v[40:43]
v_sub_f32 v17, 0, v28
v_sub_f32 v18, 0, v28
v_mfma_f32_16x16x32_bf16 v[44:47], a[96:99], a[32:35], 0
ds_read_b128 a[80:83], v1 offset:20480
v_sub_f32 v19, 0, v28
v_mfma_f32_16x16x32_bf16 v[44:47], a[100:103], a[36:39], v[44:47]
v_max_f32 v29, v29, v39
v_mov_b32 v31, v29
v_mfma_f32_16x16x32_bf16 v[44:47], a[104:107], a[40:43], v[44:47]
ds_read_b128 a[84:87], v1 offset:21504
v_mfma_f32_16x16x32_bf16 v[44:47], a[108:111], a[44:47], v[44:47]
v_permlane16_swap_b32 v29, v31
v_max_f32 v29, v29, v31
v_mfma_f32_16x16x32_bf16 v[44:47], a[112:115], a[48:51], v[44:47]
ds_read_b128 a[88:91], v1 offset:22528
v_mov_b32 v31, v29
v_mfma_f32_16x16x32_bf16 v[44:47], a[116:119], a[52:55], v[44:47]
v_mfma_f32_16x16x32_bf16 v[44:47], a[120:123], a[56:59], v[44:47]
ds_read_b128 a[92:95], v1 offset:23552
v_permlane32_swap_b32 v29, v31
v_mfma_f32_16x16x32_bf16 v[44:47], a[124:127], a[60:63], v[44:47]
s_waitcnt lgkmcnt(7)
v_max_f32 v29, v29, v31
v_sub_f32 v20, 0, v29
v_mfma_f32_16x16x32_bf16 v[48:51], a[64:67], a[0:3], v[16:19]
s_waitcnt lgkmcnt(6)
ds_read_b128 a[96:99], v1 offset:24576
v_sub_f32 v21, 0, v29
v_mfma_f32_16x16x32_bf16 v[48:51], a[68:71], a[4:7], v[48:51]
s_waitcnt lgkmcnt(6)
v_sub_f32 v22, 0, v29
v_sub_f32 v23, 0, v29
v_mfma_f32_16x16x32_bf16 v[48:51], a[72:75], a[8:11], v[48:51]
s_waitcnt lgkmcnt(5)
ds_read_b128 a[100:103], v1 offset:25600
v_mfma_f32_16x16x32_bf16 v[48:51], a[76:79], a[12:15], v[48:51]
s_waitcnt lgkmcnt(5)
v_mfma_f32_16x16x32_bf16 v[48:51], a[80:83], a[16:19], v[48:51]
s_waitcnt lgkmcnt(4)
ds_read_b128 a[104:107], v1 offset:26624
v_mfma_f32_16x16x32_bf16 v[48:51], a[84:87], a[20:23], v[48:51]
s_waitcnt lgkmcnt(4)
v_add_f32 v32, v32, v16
v_add_f32 v33, v33, v16
v_add_f32 v34, v34, v16
v_add_f32 v35, v35, v16
v_mfma_f32_16x16x32_bf16 v[48:51], a[88:91], a[24:27], v[48:51]
s_waitcnt lgkmcnt(3)
ds_read_b128 a[108:111], v1 offset:27648
v_add_f32 v36, v36, v20
v_add_f32 v37, v37, v20
v_add_f32 v38, v38, v20
v_add_f32 v39, v39, v20
v_mfma_f32_16x16x32_bf16 v[48:51], a[92:95], a[28:31], v[48:51]
v_add_f32 v40, v40, v16
v_add_f32 v41, v41, v16
v_add_f32 v42, v42, v16
v_add_f32 v43, v43, v16
v_mfma_f32_16x16x32_bf16 v[52:55], a[64:67], a[32:35], v[20:23]
ds_read_b128 a[112:115], v1 offset:28672
v_add_f32 v44, v44, v20
v_add_f32 v45, v45, v20
v_add_f32 v46, v46, v20
v_add_f32 v47, v47, v20
v_mfma_f32_16x16x32_bf16 v[52:55], a[68:71], a[36:39], v[52:55]
v_exp_f32 v8, v32
v_mfma_f32_16x16x32_bf16 v[52:55], a[72:75], a[40:43], v[52:55]
ds_read_b128 a[116:119], v1 offset:29696
v_exp_f32 v9, v33
v_mfma_f32_16x16x32_bf16 v[52:55], a[76:79], a[44:47], v[52:55]
v_exp_f32 v10, v34
v_mfma_f32_16x16x32_bf16 v[52:55], a[80:83], a[48:51], v[52:55]
ds_read_b128 a[120:123], v1 offset:30720
v_exp_f32 v11, v35
v_mfma_f32_16x16x32_bf16 v[52:55], a[84:87], a[52:55], v[52:55]
v_exp_f32 v12, v36
v_mfma_f32_16x16x32_bf16 v[52:55], a[88:91], a[56:59], v[52:55]
ds_read_b128 a[124:127], v1 offset:31744
v_exp_f32 v13, v37
v_mfma_f32_16x16x32_bf16 v[52:55], a[92:95], a[60:63], v[52:55]
s_waitcnt vmcnt(8) lgkmcnt(7)
s_barrier
v_add_f32 v26, v8, v9
v_cvt_pk_bf16_f32 v96, v8, v9
v_add_f32 v26, v26, v10
v_add_f32 v26, v26, v11
v_cvt_pk_bf16_f32 v97, v10, v11
v_add_f32 v27, v12, v13
v_cvt_pk_bf16_f32 v104, v12, v13
v_mfma_f32_16x16x32_bf16 v[56:59], a[96:99], a[0:3], v[16:19]
s_waitcnt lgkmcnt(6)
ds_read_b128 a[64:67], v1 offset:32768
v_exp_f32 v14, v38
v_mfma_f32_16x16x32_bf16 v[56:59], a[100:103], a[4:7], v[56:59]
s_waitcnt lgkmcnt(6)
buffer_store_dword v6, v5, s[4:7], s71 offen sc1
v_add_f32 v27, v27, v14
v_mfma_f32_16x16x32_bf16 v[56:59], a[104:107], a[8:11], v[56:59]
s_waitcnt lgkmcnt(5)
ds_read_b128 a[68:71], v1 offset:33792
v_exp_f32 v15, v39
v_mfma_f32_16x16x32_bf16 v[56:59], a[108:111], a[12:15], v[56:59]
s_waitcnt lgkmcnt(5)
v_exp_f32 v8, v40
v_mfma_f32_16x16x32_bf16 v[56:59], a[112:115], a[16:19], v[56:59]
s_waitcnt lgkmcnt(4)
ds_read_b128 a[72:75], v1 offset:34816
v_exp_f32 v9, v41
v_mfma_f32_16x16x32_bf16 v[56:59], a[116:119], a[20:23], v[56:59]
s_waitcnt lgkmcnt(4)
v_exp_f32 v10, v42
v_mfma_f32_16x16x32_bf16 v[56:59], a[120:123], a[24:27], v[56:59]
s_waitcnt lgkmcnt(3)
ds_read_b128 a[76:79], v1 offset:35840
v_add_f32 v27, v27, v15
v_cvt_pk_bf16_f32 v105, v14, v15
v_add_f32 v26, v26, v8
v_add_f32 v26, v26, v9
v_cvt_pk_bf16_f32 v98, v8, v9
v_add_f32 v26, v26, v10
v_mfma_f32_16x16x32_bf16 v[56:59], a[124:127], a[28:31], v[56:59]
v_exp_f32 v11, v43
v_mfma_f32_16x16x32_bf16 v[60:63], a[96:99], a[32:35], v[20:23]
ds_read_b128 a[80:83], v1 offset:36864
v_exp_f32 v12, v44
v_mfma_f32_16x16x32_bf16 v[60:63], a[100:103], a[36:39], v[60:63]
v_exp_f32 v13, v45
v_mfma_f32_16x16x32_bf16 v[60:63], a[104:107], a[40:43], v[60:63]
ds_read_b128 a[84:87], v1 offset:37888
v_exp_f32 v14, v46
v_mfma_f32_16x16x32_bf16 v[60:63], a[108:111], a[44:47], v[60:63]
v_exp_f32 v15, v47
v_mfma_f32_16x16x32_bf16 v[60:63], a[112:115], a[48:51], v[60:63]
ds_read_b128 a[88:91], v1 offset:38912
v_add_f32 v26, v26, v11
v_cvt_pk_bf16_f32 v99, v10, v11
v_mfma_f32_16x16x32_bf16 v[60:63], a[116:119], a[52:55], v[60:63]
v_add_f32 v27, v27, v12
v_add_f32 v27, v27, v13
v_cvt_pk_bf16_f32 v106, v12, v13
v_mfma_f32_16x16x32_bf16 v[60:63], a[120:123], a[56:59], v[60:63]
s_waitcnt lgkmcnt(7)
s_barrier
ds_read_b128 a[92:95], v1 offset:39936
v_mfma_f32_16x16x32_bf16 v[60:63], a[124:127], a[60:63], v[60:63]
s_waitcnt lgkmcnt(7)
v_add_f32 v27, v27, v14
v_add_f32 v27, v27, v15
v_cvt_pk_bf16_f32 v107, v14, v15
s_branch K2_x1
.p2align 6
K2_loop:
v_mfma_f32_16x16x32_bf16 v[128:131], a[64:67], v[96:99], v[128:131]
s_add_u32 m0, s18, 98304
ds_read_b128 a[96:99], v2 offset:8192
v_add_f32 v24, v24, v26
v_mfma_f32_16x16x32_bf16 v[128:131], a[68:71], v[100:103], v[128:131]
buffer_load_dwordx4 v1, s[4:7], s12 offen offset:0 sc1 lds
v_mfma_f32_16x16x32_bf16 v[132:135], a[68:71], v[108:111], v[132:135]
ds_read_b128 a[100:103], v2 offset:9216
v_add_f32 v25, v25, v27
v_mfma_f32_16x16x32_bf16 v[132:135], a[64:67], v[104:107], v[132:135]
s_waitcnt lgkmcnt(7)
v_exp_f32 v8, v64
v_mfma_f32_16x16x32_bf16 v[136:139], a[72:75], v[96:99], v[136:139]
s_waitcnt lgkmcnt(6)
ds_read_b128 a[104:107], v2 offset:10240
v_mfma_f32_16x16x32_bf16 v[136:139], a[76:79], v[100:103], v[136:139]
buffer_load_dwordx4 v1, s[4:7], s12 offen offset:1024 sc1 lds
v_mfma_f32_16x16x32_bf16 v[140:143], a[76:79], v[108:111], v[140:143]
ds_read_b128 a[108:111], v2 offset:11264
v_mfma_f32_16x16x32_bf16 v[140:143], a[72:75], v[104:107], v[140:143]
s_waitcnt lgkmcnt(7)
v_exp_f32 v9, v65
v_mfma_f32_16x16x32_bf16 v[144:147], a[80:83], v[96:99], v[144:147]
s_waitcnt lgkmcnt(6)
ds_read_b128 a[112:115], v2 offset:12288
v_add_f32 v26, v8, v9
v_mfma_f32_16x16x32_bf16 v[144:147], a[84:87], v[100:103], v[144:147]
buffer_load_dwordx4 v1, s[4:7], s12 offen offset:2048 sc1 lds
v_mfma_f32_16x16x32_bf16 v[148:151], a[84:87], v[108:111], v[148:151]
ds_read_b128 a[116:119], v2 offset:13312
v_cvt_pk_bf16_f32 v112, v8, v9
v_mfma_f32_16x16x32_bf16 v[148:151], a[80:83], v[104:107], v[148:151]
s_waitcnt lgkmcnt(7)
v_exp_f32 v10, v66
v_mfma_f32_16x16x32_bf16 v[152:155], a[88:91], v[96:99], v[152:155]
s_waitcnt lgkmcnt(6)
ds_read_b128 a[120:123], v2 offset:14336
v_add_f32 v26, v26, v10
v_mfma_f32_16x16x32_bf16 v[152:155], a[92:95], v[100:103], v[152:155]
buffer_load_dwordx4 v1, s[4:7], s12 offen offset:3072 sc1 lds
v_mfma_f32_16x16x32_bf16 v[156:159], a[92:95], v[108:111], v[156:159]
s_add_u32 s12, s12, 4096
ds_read_b128 a[124:127], v2 offset:15360
v_mfma_f32_16x16x32_bf16 v[156:159], a[88:91], v[104:107], v[156:159]
s_waitcnt lgkmcnt(6)
v_exp_f32 v11, v67
v_mfma_f32_16x16x32_bf16 v[160:163], a[96:99], v[96:99], v[160:163]
s_add_u32 m0, s18, 102400
ds_read_b128 a[64:67], v2 offset:16384
v_add_f32 v26, v26, v11
v_mfma_f32_16x16x32_bf16 v[160:163], a[100:103], v[100:103], v[160:163]
buffer_load_dwordx4 v1, s[4:7], s12 offen offset:0 sc1 lds
v_mfma_f32_16x16x32_bf16 v[164:167], a[100:103], v[108:111], v[164:167]
ds_read_b128 a[68:71], v2 offset:17408
v_cvt_pk_bf16_f32 v113, v10, v11
v_mfma_f32_16x16x32_bf16 v[164:167], a[96:99], v[104:107], v[164:167]
s_waitcnt lgkmcnt(7)
v_mfma_f32_16x16x32_bf16 v[168:171], a[104:107], v[96:99], v[168:171]
s_waitcnt lgkmcnt(6)
ds_read_b128 a[72:75], v2 offset:18432
v_mfma_f32_16x16x32_bf16 v[168:171], a[108:111], v[100:103], v[168:171]
buffer_load_dwordx4 v1, s[4:7], s12 offen offset:1024 sc1 lds
v_mfma_f32_16x16x32_bf16 v[172:175], a[108:111], v[108:111], v[172:175]
ds_read_b128 a[76:79], v2 offset:19456
v_mfma_f32_16x16x32_bf16 v[172:175], a[104:107], v[104:107], v[172:175]
s_waitcnt lgkmcnt(7)
v_exp_f32 v12, v68
v_mfma_f32_16x16x32_bf16 v[176:179], a[112:115], v[96:99], v[176:179]
s_waitcnt lgkmcnt(6)
ds_read_b128 a[80:83], v2 offset:20480
v_mfma_f32_16x16x32_bf16 v[176:179], a[116:119], v[100:103], v[176:179]
buffer_load_dwordx4 v1, s[4:7], s12 offen offset:2048 sc1 lds
v_mfma_f32_16x16x32_bf16 v[180:183], a[116:119], v[108:111], v[180:183]
ds_read_b128 a[84:87], v2 offset:21504
v_mfma_f32_16x16x32_bf16 v[180:183], a[112:115], v[104:107], v[180:183]
s_waitcnt lgkmcnt(7)
v_exp_f32 v13, v69
v_mfma_f32_16x16x32_bf16 v[184:187], a[120:123], v[96:99], v[184:187]
s_waitcnt lgkmcnt(6)
ds_read_b128 a[88:91], v2 offset:22528
v_add_f32 v27, v12, v13
v_mfma_f32_16x16x32_bf16 v[184:187], a[124:127], v[100:103], v[184:187]
s_waitcnt lgkmcnt(5)
buffer_load_dwordx4 v1, s[4:7], s12 offen offset:3072 sc1 lds
v_mfma_f32_16x16x32_bf16 v[188:191], a[124:127], v[108:111], v[188:191]
s_add_u32 s12, s12, 28672
ds_read_b128 a[92:95], v2 offset:23552
v_cvt_pk_bf16_f32 v120, v12, v13
v_mfma_f32_16x16x32_bf16 v[188:191], a[120:123], v[104:107], v[188:191]
s_sub_u32 s13, s13, 1
v_exp_f32 v14, v70
v_mfma_f32_16x16x32_bf16 v[192:195], a[64:67], v[96:99], v[192:195]
s_cmp_eq_u32 s13, 0
ds_read_b128 a[96:99], v2 offset:24576
v_add_f32 v27, v27, v14
v_mfma_f32_16x16x32_bf16 v[192:195], a[68:71], v[100:103], v[192:195]
s_cselect_b32 s12, s14, s12
v_mfma_f32_16x16x32_bf16 v[196:199], a[68:71], v[108:111], v[196:199]
s_waitcnt lgkmcnt(6)
s_cselect_b32 s13, s15, s13
ds_read_b128 a[100:103], v2 offset:25600
v_mfma_f32_16x16x32_bf16 v[196:199], a[64:67], v[104:107], v[196:199]
s_cselect_b32 s14, 3221225472, s14
v_exp_f32 v15, v71
v_mfma_f32_16x16x32_bf16 v[200:203], a[72:75], v[96:99], v[200:203]
s_waitcnt lgkmcnt(6)
ds_read_b128 a[104:107], v2 offset:26624
v_add_f32 v27, v27, v15
v_mfma_f32_16x16x32_bf16 v[200:203], a[76:79], v[100:103], v[200:203]
v_exp_f32 v8, v72
v_mfma_f32_16x16x32_bf16 v[204:207], a[76:79], v[108:111], v[204:207]
ds_read_b128 a[108:111], v2 offset:27648
v_cvt_pk_bf16_f32 v121, v14, v15
v_mfma_f32_16x16x32_bf16 v[204:207], a[72:75], v[104:107], v[204:207]
s_waitcnt lgkmcnt(7)
v_exp_f32 v9, v73
v_mfma_f32_16x16x32_bf16 v[208:211], a[80:83], v[96:99], v[208:211]
s_waitcnt lgkmcnt(6)
ds_read_b128 a[112:115], v2 offset:28672
v_add_f32 v26, v26, v8
v_mfma_f32_16x16x32_bf16 v[208:211], a[84:87], v[100:103], v[208:211]
v_add_f32 v26, v26, v9
v_cvt_pk_bf16_f32 v114, v8, v9
v_mfma_f32_16x16x32_bf16 v[212:215], a[84:87], v[108:111], v[212:215]
ds_read_b128 a[116:119], v2 offset:29696
v_mfma_f32_16x16x32_bf16 v[212:215], a[80:83], v[104:107], v[212:215]
s_waitcnt lgkmcnt(7)
v_exp_f32 v10, v74
v_mfma_f32_16x16x32_bf16 v[216:219], a[88:91], v[96:99], v[216:219]
s_waitcnt lgkmcnt(6)
ds_read_b128 a[120:123], v2 offset:30720
v_add_f32 v26, v26, v10
v_mfma_f32_16x16x32_bf16 v[216:219], a[92:95], v[100:103], v[216:219]
v_exp_f32 v11, v75
v_mfma_f32_16x16x32_bf16 v[220:223], a[92:95], v[108:111], v[220:223]
ds_read_b128 a[124:127], v2 offset:31744
v_add_f32 v26, v26, v11
v_mfma_f32_16x16x32_bf16 v[220:223], a[88:91], v[104:107], v[220:223]
s_waitcnt vmcnt(8) lgkmcnt(7)
s_barrier
v_cvt_pk_bf16_f32 v115, v10, v11
v_mfma_f32_16x16x32_bf16 v[224:227], a[96:99], v[96:99], v[224:227]
s_waitcnt lgkmcnt(6)
ds_read_b128 a[64:67], v1 offset:0
v_mfma_f32_16x16x32_bf16 v[224:227], a[100:103], v[100:103], v[224:227]
v_exp_f32 v12, v76
v_mfma_f32_16x16x32_bf16 v[228:231], a[100:103], v[108:111], v[228:231]
ds_read_b128 a[68:71], v1 offset:1024
v_add_f32 v27, v27, v12
v_mfma_f32_16x16x32_bf16 v[228:231], a[96:99], v[104:107], v[228:231]
s_waitcnt lgkmcnt(7)
v_mfma_f32_16x16x32_bf16 v[232:235], a[104:107], v[96:99], v[232:235]
s_waitcnt lgkmcnt(6)
ds_read_b128 a[72:75], v1 offset:2048
v_mfma_f32_16x16x32_bf16 v[232:235], a[108:111], v[100:103], v[232:235]
v_exp_f32 v13, v77
v_mfma_f32_16x16x32_bf16 v[236:239], a[108:111], v[108:111], v[236:239]
ds_read_b128 a[76:79], v1 offset:3072
v_add_f32 v27, v27, v13
v_mfma_f32_16x16x32_bf16 v[236:239], a[104:107], v[104:107], v[236:239]
s_waitcnt lgkmcnt(7)
v_exp_f32 v14, v78
v_mfma_f32_16x16x32_bf16 v[240:243], a[112:115], v[96:99], v[240:243]
s_waitcnt lgkmcnt(6)
ds_read_b128 a[80:83], v1 offset:4096
v_cvt_pk_bf16_f32 v122, v12, v13
v_mfma_f32_16x16x32_bf16 v[240:243], a[116:119], v[100:103], v[240:243]
v_exp_f32 v15, v79
v_mfma_f32_16x16x32_bf16 v[244:247], a[116:119], v[108:111], v[244:247]
ds_read_b128 a[84:87], v1 offset:5120
v_add_f32 v27, v27, v14
v_mfma_f32_16x16x32_bf16 v[244:247], a[112:115], v[104:107], v[244:247]
s_waitcnt lgkmcnt(7)
v_add_f32 v27, v27, v15
v_cvt_pk_bf16_f32 v123, v14, v15
v_mfma_f32_16x16x32_bf16 v[248:251], a[120:123], v[96:99], v[248:251]
s_waitcnt lgkmcnt(6)
ds_read_b128 a[88:91], v1 offset:6144
v_mfma_f32_16x16x32_bf16 v[248:251], a[124:127], v[100:103], v[248:251]
v_mfma_f32_16x16x32_bf16 v[252:255], a[124:127], v[108:111], v[252:255]
ds_read_b128 a[92:95], v1 offset:7168
v_mfma_f32_16x16x32_bf16 v[252:255], a[120:123], v[104:107], v[252:255]
s_waitcnt lgkmcnt(7)
v_mfma_f32_16x16x32_bf16 v[32:35], a[64:67], a[0:3], v[16:19]
s_waitcnt lgkmcnt(6)
s_add_u32 m0, s18, 32768
ds_read_b128 a[96:99], v1 offset:8192
v_mfma_f32_16x16x32_bf16 v[32:35], a[68:71], a[4:7], v[32:35]
s_waitcnt lgkmcnt(6)
buffer_load_dwordx4 v1, s[4:7], s8 offen offset:0 sc1 lds
v_mfma_f32_16x16x32_bf16 v[32:35], a[72:75], a[8:11], v[32:35]
s_waitcnt lgkmcnt(5)
ds_read_b128 a[100:103], v1 offset:9216
v_mfma_f32_16x16x32_bf16 v[32:35], a[76:79], a[12:15], v[32:35]
s_waitcnt lgkmcnt(5)
v_exp_f32 v8, v80
v_mfma_f32_16x16x32_bf16 v[32:35], a[80:83], a[16:19], v[32:35]
s_waitcnt lgkmcnt(4)
ds_read_b128 a[104:107], v1 offset:10240
v_add_f32 v26, v26, v8
v_mfma_f32_16x16x32_bf16 v[32:35], a[84:87], a[20:23], v[32:35]
s_waitcnt lgkmcnt(4)
buffer_load_dwordx4 v1, s[4:7], s8 offen offset:1024 sc1 lds
v_mfma_f32_16x16x32_bf16 v[32:35], a[88:91], a[24:27], v[32:35]
s_waitcnt lgkmcnt(3)
ds_read_b128 a[108:111], v1 offset:11264
v_mfma_f32_16x16x32_bf16 v[32:35], a[92:95], a[28:31], v[32:35]
v_exp_f32 v9, v81
v_mfma_f32_16x16x32_bf16 v[36:39], a[64:67], a[32:35], v[20:23]
ds_read_b128 a[112:115], v1 offset:12288
v_add_f32 v26, v26, v9
v_mfma_f32_16x16x32_bf16 v[36:39], a[68:71], a[36:39], v[36:39]
buffer_load_dwordx4 v1, s[4:7], s8 offen offset:2048 sc1 lds
v_mfma_f32_16x16x32_bf16 v[36:39], a[72:75], a[40:43], v[36:39]
ds_read_b128 a[116:119], v1 offset:13312
v_cvt_pk_bf16_f32 v116, v8, v9
v_mfma_f32_16x16x32_bf16 v[36:39], a[76:79], a[44:47], v[36:39]
v_exp_f32 v10, v82
v_mfma_f32_16x16x32_bf16 v[36:39], a[80:83], a[48:51], v[36:39]
ds_read_b128 a[120:123], v1 offset:14336
v_add_f32 v26, v26, v10
v_mfma_f32_16x16x32_bf16 v[36:39], a[84:87], a[52:55], v[36:39]
buffer_load_dwordx4 v1, s[4:7], s8 offen offset:3072 sc1 lds
v_mfma_f32_16x16x32_bf16 v[36:39], a[88:91], a[56:59], v[36:39]
s_add_u32 s8, s8, 4096
ds_read_b128 a[124:127], v1 offset:15360
v_mfma_f32_16x16x32_bf16 v[36:39], a[92:95], a[60:63], v[36:39]
s_waitcnt lgkmcnt(6)
v_exp_f32 v11, v83
v_mfma_f32_16x16x32_bf16 v[40:43], a[96:99], a[0:3], v[16:19]
s_add_u32 m0, s18, 36864
ds_read_b128 a[64:67], v1 offset:16384
v_add_f32 v26, v26, v11
v_mfma_f32_16x16x32_bf16 v[40:43], a[100:103], a[4:7], v[40:43]
s_waitcnt lgkmcnt(6)
buffer_load_dwordx4 v1, s[4:7], s8 offen offset:0 sc1 lds
v_mfma_f32_16x16x32_bf16 v[40:43], a[104:107], a[8:11], v[40:43]
s_waitcnt lgkmcnt(5)
ds_read_b128 a[68:71], v1 offset:17408
v_cvt_pk_bf16_f32 v117, v10, v11
v_mfma_f32_16x16x32_bf16 v[40:43], a[108:111], a[12:15], v[40:43]
s_waitcnt lgkmcnt(5)
v_mfma_f32_16x16x32_bf16 v[40:43], a[112:115], a[16:19], v[40:43]
s_waitcnt lgkmcnt(4)
ds_read_b128 a[72:75], v1 offset:18432
v_mfma_f32_16x16x32_bf16 v[40:43], a[116:119], a[20:23], v[40:43]
s_waitcnt lgkmcnt(4)
buffer_load_dwordx4 v1, s[4:7], s8 offen offset:1024 sc1 lds
v_mfma_f32_16x16x32_bf16 v[40:43], a[120:123], a[24:27], v[40:43]
s_waitcnt lgkmcnt(3)
ds_read_b128 a[76:79], v1 offset:19456
v_mfma_f32_16x16x32_bf16 v[40:43], a[124:127], a[28:31], v[40:43]
v_exp_f32 v12, v84
v_mfma_f32_16x16x32_bf16 v[44:47], a[96:99], a[32:35], v[20:23]
ds_read_b128 a[80:83], v1 offset:20480
v_add_f32 v27, v27, v12
v_mfma_f32_16x16x32_bf16 v[44:47], a[100:103], a[36:39], v[44:47]
buffer_load_dwordx4 v1, s[4:7], s8 offen offset:2048 sc1 lds
v_mfma_f32_16x16x32_bf16 v[44:47], a[104:107], a[40:43], v[44:47]
ds_read_b128 a[84:87], v1 offset:21504
v_mfma_f32_16x16x32_bf16 v[44:47], a[108:111], a[44:47], v[44:47]
v_exp_f32 v13, v85
v_mfma_f32_16x16x32_bf16 v[44:47], a[112:115], a[48:51], v[44:47]
ds_read_b128 a[88:91], v1 offset:22528
v_add_f32 v27, v27, v13
v_mfma_f32_16x16x32_bf16 v[44:47], a[116:119], a[52:55], v[44:47]
s_waitcnt lgkmcnt(3)
buffer_load_dwordx4 v1, s[4:7], s8 offen offset:3072 sc1 lds
v_mfma_f32_16x16x32_bf16 v[44:47], a[120:123], a[56:59], v[44:47]
s_add_u32 s8, s8, 28672
ds_read_b128 a[92:95], v1 offset:23552
v_cvt_pk_bf16_f32 v124, v12, v13
v_mfma_f32_16x16x32_bf16 v[44:47], a[124:127], a[60:63], v[44:47]
s_sub_u32 s9, s9, 1
v_exp_f32 v14, v86
v_mfma_f32_16x16x32_bf16 v[48:51], a[64:67], a[0:3], v[16:19]
s_cmp_eq_u32 s9, 0
ds_read_b128 a[96:99], v1 offset:24576
v_add_f32 v27, v27, v14
v_mfma_f32_16x16x32_bf16 v[48:51], a[68:71], a[4:7], v[48:51]
s_cselect_b32 s8, s10, s8
v_exp_f32 v15, v87
v_mfma_f32_16x16x32_bf16 v[48:51], a[72:75], a[8:11], v[48:51]
s_cselect_b32 s9, s11, s9
ds_read_b128 a[100:103], v1 offset:25600
v_add_f32 v27, v27, v15
v_mfma_f32_16x16x32_bf16 v[48:51], a[76:79], a[12:15], v[48:51]
s_waitcnt lgkmcnt(5)
s_cselect_b32 s10, 3221225472, s10
v_cvt_pk_bf16_f32 v125, v14, v15
v_mfma_f32_16x16x32_bf16 v[48:51], a[80:83], a[16:19], v[48:51]
s_waitcnt lgkmcnt(4)
ds_read_b128 a[104:107], v1 offset:26624
v_mfma_f32_16x16x32_bf16 v[48:51], a[84:87], a[20:23], v[48:51]
s_waitcnt lgkmcnt(4)
v_exp_f32 v8, v88
v_mfma_f32_16x16x32_bf16 v[48:51], a[88:91], a[24:27], v[48:51]
s_waitcnt lgkmcnt(3)
ds_read_b128 a[108:111], v1 offset:27648
v_add_f32 v26, v26, v8
v_mfma_f32_16x16x32_bf16 v[48:51], a[92:95], a[28:31], v[48:51]
v_exp_f32 v9, v89
v_mfma_f32_16x16x32_bf16 v[52:55], a[64:67], a[32:35], v[20:23]
ds_read_b128 a[112:115], v1 offset:28672
v_add_f32 v26, v26, v9
v_mfma_f32_16x16x32_bf16 v[52:55], a[68:71], a[36:39], v[52:55]
v_exp_f32 v10, v90
v_mfma_f32_16x16x32_bf16 v[52:55], a[72:75], a[40:43], v[52:55]
ds_read_b128 a[116:119], v1 offset:29696
v_cvt_pk_bf16_f32 v118, v8, v9
v_mfma_f32_16x16x32_bf16 v[52:55], a[76:79], a[44:47], v[52:55]
v_exp_f32 v11, v91
v_mfma_f32_16x16x32_bf16 v[52:55], a[80:83], a[48:51], v[52:55]
ds_read_b128 a[120:123], v1 offset:30720
v_add_f32 v26, v26, v10
v_mfma_f32_16x16x32_bf16 v[52:55], a[84:87], a[52:55], v[52:55]
v_add_f32 v26, v26, v11
v_cvt_pk_bf16_f32 v119, v10, v11
v_mfma_f32_16x16x32_bf16 v[52:55], a[88:91], a[56:59], v[52:55]
ds_read_b128 a[124:127], v1 offset:31744
v_mfma_f32_16x16x32_bf16 v[52:55], a[92:95], a[60:63], v[52:55]
s_waitcnt vmcnt(8) lgkmcnt(7)
s_barrier
v_mfma_f32_16x16x32_bf16 v[56:59], a[96:99], a[0:3], v[16:19]
s_waitcnt lgkmcnt(6)
ds_read_b128 a[64:67], v2 offset:32768
v_mfma_f32_16x16x32_bf16 v[56:59], a[100:103], a[4:7], v[56:59]
s_waitcnt lgkmcnt(6)
v_exp_f32 v12, v92
v_mfma_f32_16x16x32_bf16 v[56:59], a[104:107], a[8:11], v[56:59]
s_waitcnt lgkmcnt(5)
ds_read_b128 a[68:71], v2 offset:33792
v_add_f32 v27, v27, v12
v_mfma_f32_16x16x32_bf16 v[56:59], a[108:111], a[12:15], v[56:59]
s_waitcnt lgkmcnt(5)
v_exp_f32 v13, v93
v_mfma_f32_16x16x32_bf16 v[56:59], a[112:115], a[16:19], v[56:59]
s_waitcnt lgkmcnt(4)
ds_read_b128 a[72:75], v2 offset:34816
v_add_f32 v27, v27, v13
v_mfma_f32_16x16x32_bf16 v[56:59], a[116:119], a[20:23], v[56:59]
s_waitcnt lgkmcnt(4)
v_exp_f32 v14, v94
v_mfma_f32_16x16x32_bf16 v[56:59], a[120:123], a[24:27], v[56:59]
s_waitcnt lgkmcnt(3)
ds_read_b128 a[76:79], v2 offset:35840
v_cvt_pk_bf16_f32 v126, v12, v13
v_mfma_f32_16x16x32_bf16 v[56:59], a[124:127], a[28:31], v[56:59]
v_exp_f32 v15, v95
v_mfma_f32_16x16x32_bf16 v[60:63], a[96:99], a[32:35], v[20:23]
ds_read_b128 a[80:83], v2 offset:36864
v_add_f32 v27, v27, v14
v_mfma_f32_16x16x32_bf16 v[60:63], a[100:103], a[36:39], v[60:63]
v_add_f32 v27, v27, v15
v_cvt_pk_bf16_f32 v127, v14, v15
v_mfma_f32_16x16x32_bf16 v[60:63], a[104:107], a[40:43], v[60:63]
ds_read_b128 a[84:87], v2 offset:37888
v_add_f32 v28, v26, v27
v_mfma_f32_16x16x32_bf16 v[60:63], a[108:111], a[44:47], v[60:63]
v_cmp_nge_f32 vcc, s25, v28
v_mfma_f32_16x16x32_bf16 v[60:63], a[112:115], a[48:51], v[60:63]
ds_read_b128 a[88:91], v2 offset:38912
v_mfma_f32_16x16x32_bf16 v[60:63], a[116:119], a[52:55], v[60:63]
v_mfma_f32_16x16x32_bf16 v[60:63], a[120:123], a[56:59], v[60:63]
ds_read_b128 a[92:95], v2 offset:39936
v_mfma_f32_16x16x32_bf16 v[60:63], a[124:127], a[60:63], v[60:63]
s_waitcnt lgkmcnt(6)
s_cbranch_vccnz Lstub_3
Lback_4:
v_mfma_f32_16x16x32_bf16 v[128:131], a[64:67], v[112:115], v[128:131]
s_add_u32 m0, s18, 65536
ds_read_b128 a[96:99], v2 offset:40960
v_add_f32 v24, v24, v26
v_mfma_f32_16x16x32_bf16 v[128:131], a[68:71], v[116:119], v[128:131]
buffer_load_dwordx4 v1, s[4:7], s12 offen offset:0 sc1 lds
v_mfma_f32_16x16x32_bf16 v[132:135], a[68:71], v[124:127], v[132:135]
ds_read_b128 a[100:103], v2 offset:41984
v_add_f32 v25, v25, v27
v_mfma_f32_16x16x32_bf16 v[132:135], a[64:67], v[120:123], v[132:135]
s_waitcnt lgkmcnt(7)
v_exp_f32 v8, v32
v_mfma_f32_16x16x32_bf16 v[136:139], a[72:75], v[112:115], v[136:139]
s_waitcnt lgkmcnt(6)
ds_read_b128 a[104:107], v2 offset:43008
v_mfma_f32_16x16x32_bf16 v[136:139], a[76:79], v[116:119], v[136:139]
buffer_load_dwordx4 v1, s[4:7], s12 offen offset:1024 sc1 lds
v_mfma_f32_16x16x32_bf16 v[140:143], a[76:79], v[124:127], v[140:143]
ds_read_b128 a[108:111], v2 offset:44032
v_mfma_f32_16x16x32_bf16 v[140:143], a[72:75], v[120:123], v[140:143]
s_waitcnt lgkmcnt(7)
v_exp_f32 v9, v33
v_mfma_f32_16x16x32_bf16 v[144:147], a[80:83], v[112:115], v[144:147]
s_waitcnt lgkmcnt(6)
ds_read_b128 a[112:115], v2 offset:45056
v_add_f32 v26, v8, v9
v_mfma_f32_16x16x32_bf16 v[144:147], a[84:87], v[116:119], v[144:147]
buffer_load_dwordx4 v1, s[4:7], s12 offen offset:2048 sc1 lds
v_mfma_f32_16x16x32_bf16 v[148:151], a[84:87], v[124:127], v[148:151]
ds_read_b128 a[116:119], v2 offset:46080
v_cvt_pk_bf16_f32 v96, v8, v9
v_mfma_f32_16x16x32_bf16 v[148:151], a[80:83], v[120:123], v[148:151]
s_waitcnt lgkmcnt(7)
v_exp_f32 v10, v34
v_mfma_f32_16x16x32_bf16 v[152:155], a[88:91], v[112:115], v[152:155]
s_waitcnt lgkmcnt(6)
ds_read_b128 a[120:123], v2 offset:47104
v_add_f32 v26, v26, v10
v_mfma_f32_16x16x32_bf16 v[152:155], a[92:95], v[116:119], v[152:155]
buffer_load_dwordx4 v1, s[4:7], s12 offen offset:3072 sc1 lds
v_mfma_f32_16x16x32_bf16 v[156:159], a[92:95], v[124:127], v[156:159]
s_add_u32 s12, s12, 4096
ds_read_b128 a[124:127], v2 offset:48128
v_mfma_f32_16x16x32_bf16 v[156:159], a[88:91], v[120:123], v[156:159]
s_waitcnt lgkmcnt(6)
v_exp_f32 v11, v35
v_mfma_f32_16x16x32_bf16 v[160:163], a[96:99], v[112:115], v[160:163]
s_add_u32 m0, s18, 69632
ds_read_b128 a[64:67], v2 offset:49152
v_add_f32 v26, v26, v11
v_mfma_f32_16x16x32_bf16 v[160:163], a[100:103], v[116:119], v[160:163]
buffer_load_dwordx4 v1, s[4:7], s12 offen offset:0 sc1 lds
v_mfma_f32_16x16x32_bf16 v[164:167], a[100:103], v[124:127], v[164:167]
ds_read_b128 a[68:71], v2 offset:50176
v_cvt_pk_bf16_f32 v97, v10, v11
v_mfma_f32_16x16x32_bf16 v[164:167], a[96:99], v[120:123], v[164:167]
s_waitcnt lgkmcnt(7)
v_mfma_f32_16x16x32_bf16 v[168:171], a[104:107], v[112:115], v[168:171]
s_waitcnt lgkmcnt(6)
ds_read_b128 a[72:75], v2 offset:51200
v_mfma_f32_16x16x32_bf16 v[168:171], a[108:111], v[116:119], v[168:171]
buffer_load_dwordx4 v1, s[4:7], s12 offen offset:1024 sc1 lds
v_mfma_f32_16x16x32_bf16 v[172:175], a[108:111], v[124:127], v[172:175]
ds_read_b128 a[76:79], v2 offset:52224
v_mfma_f32_16x16x32_bf16 v[172:175], a[104:107], v[120:123], v[172:175]
s_waitcnt lgkmcnt(7)
v_exp_f32 v12, v36
v_mfma_f32_16x16x32_bf16 v[176:179], a[112:115], v[112:115], v[176:179]
s_waitcnt lgkmcnt(6)
ds_read_b128 a[80:83], v2 offset:53248
v_mfma_f32_16x16x32_bf16 v[176:179], a[116:119], v[116:119], v[176:179]
buffer_load_dwordx4 v1, s[4:7], s12 offen offset:2048 sc1 lds
v_mfma_f32_16x16x32_bf16 v[180:183], a[116:119], v[124:127], v[180:183]
ds_read_b128 a[84:87], v2 offset:54272
v_mfma_f32_16x16x32_bf16 v[180:183], a[112:115], v[120:123], v[180:183]
s_waitcnt lgkmcnt(7)
v_exp_f32 v13, v37
v_mfma_f32_16x16x32_bf16 v[184:187], a[120:123], v[112:115], v[184:187]
s_waitcnt lgkmcnt(6)
ds_read_b128 a[88:91], v2 offset:55296
v_add_f32 v27, v12, v13
v_mfma_f32_16x16x32_bf16 v[184:187], a[124:127], v[116:119], v[184:187]
s_waitcnt lgkmcnt(5)
buffer_load_dwordx4 v1, s[4:7], s12 offen offset:3072 sc1 lds
v_mfma_f32_16x16x32_bf16 v[188:191], a[124:127], v[124:127], v[188:191]
s_add_u32 s12, s12, 28672
ds_read_b128 a[92:95], v2 offset:56320
v_cvt_pk_bf16_f32 v104, v12, v13
v_mfma_f32_16x16x32_bf16 v[188:191], a[120:123], v[120:123], v[188:191]
s_sub_u32 s13, s13, 1
v_exp_f32 v14, v38
v_mfma_f32_16x16x32_bf16 v[192:195], a[64:67], v[112:115], v[192:195]
s_cmp_eq_u32 s13, 0
ds_read_b128 a[96:99], v2 offset:57344
v_add_f32 v27, v27, v14
v_mfma_f32_16x16x32_bf16 v[192:195], a[68:71], v[116:119], v[192:195]
s_cselect_b32 s12, s14, s12
v_mfma_f32_16x16x32_bf16 v[196:199], a[68:71], v[124:127], v[196:199]
s_waitcnt lgkmcnt(6)
s_cselect_b32 s13, s15, s13
ds_read_b128 a[100:103], v2 offset:58368
v_mfma_f32_16x16x32_bf16 v[196:199], a[64:67], v[120:123], v[196:199]
s_cselect_b32 s14, 3221225472, s14
v_exp_f32 v15, v39
v_mfma_f32_16x16x32_bf16 v[200:203], a[72:75], v[112:115], v[200:203]
s_waitcnt lgkmcnt(6)
ds_read_b128 a[104:107], v2 offset:59392
v_add_f32 v27, v27, v15
v_mfma_f32_16x16x32_bf16 v[200:203], a[76:79], v[116:119], v[200:203]
v_exp_f32 v8, v40
v_mfma_f32_16x16x32_bf16 v[204:207], a[76:79], v[124:127], v[204:207]
ds_read_b128 a[108:111], v2 offset:60416
v_cvt_pk_bf16_f32 v105, v14, v15
v_mfma_f32_16x16x32_bf16 v[204:207], a[72:75], v[120:123], v[204:207]
s_waitcnt lgkmcnt(7)
v_exp_f32 v9, v41
v_mfma_f32_16x16x32_bf16 v[208:211], a[80:83], v[112:115], v[208:211]
s_waitcnt lgkmcnt(6)
ds_read_b128 a[112:115], v2 offset:61440
v_add_f32 v26, v26, v8
v_mfma_f32_16x16x32_bf16 v[208:211], a[84:87], v[116:119], v[208:211]
v_add_f32 v26, v26, v9
v_cvt_pk_bf16_f32 v98, v8, v9
v_mfma_f32_16x16x32_bf16 v[212:215], a[84:87], v[124:127], v[212:215]
ds_read_b128 a[116:119], v2 offset:62464
v_mfma_f32_16x16x32_bf16 v[212:215], a[80:83], v[120:123], v[212:215]
s_waitcnt lgkmcnt(7)
v_exp_f32 v10, v42
v_mfma_f32_16x16x32_bf16 v[216:219], a[88:91], v[112:115], v[216:219]
s_waitcnt lgkmcnt(6)
ds_read_b128 a[120:123], v2 offset:63488
v_add_f32 v26, v26, v10
v_mfma_f32_16x16x32_bf16 v[216:219], a[92:95], v[116:119], v[216:219]
v_exp_f32 v11, v43
v_mfma_f32_16x16x32_bf16 v[220:223], a[92:95], v[124:127], v[220:223]
ds_read_b128 a[124:127], v2 offset:64512
v_add_f32 v26, v26, v11
v_mfma_f32_16x16x32_bf16 v[220:223], a[88:91], v[120:123], v[220:223]
s_waitcnt vmcnt(8) lgkmcnt(7)
s_barrier
v_cvt_pk_bf16_f32 v99, v10, v11
v_mfma_f32_16x16x32_bf16 v[224:227], a[96:99], v[112:115], v[224:227]
s_waitcnt lgkmcnt(6)
ds_read_b128 a[64:67], v1 offset:32768
v_mfma_f32_16x16x32_bf16 v[224:227], a[100:103], v[116:119], v[224:227]
v_exp_f32 v12, v44
v_mfma_f32_16x16x32_bf16 v[228:231], a[100:103], v[124:127], v[228:231]
ds_read_b128 a[68:71], v1 offset:33792
v_add_f32 v27, v27, v12
v_mfma_f32_16x16x32_bf16 v[228:231], a[96:99], v[120:123], v[228:231]
s_waitcnt lgkmcnt(7)
v_mfma_f32_16x16x32_bf16 v[232:235], a[104:107], v[112:115], v[232:235]
s_waitcnt lgkmcnt(6)
ds_read_b128 a[72:75], v1 offset:34816
v_mfma_f32_16x16x32_bf16 v[232:235], a[108:111], v[116:119], v[232:235]
v_exp_f32 v13, v45
v_mfma_f32_16x16x32_bf16 v[236:239], a[108:111], v[124:127], v[236:239]
ds_read_b128 a[76:79], v1 offset:35840
v_add_f32 v27, v27, v13
v_mfma_f32_16x16x32_bf16 v[236:239], a[104:107], v[120:123], v[236:239]
s_waitcnt lgkmcnt(7)
v_exp_f32 v14, v46
v_mfma_f32_16x16x32_bf16 v[240:243], a[112:115], v[112:115], v[240:243]
s_waitcnt lgkmcnt(6)
ds_read_b128 a[80:83], v1 offset:36864
v_cvt_pk_bf16_f32 v106, v12, v13
v_mfma_f32_16x16x32_bf16 v[240:243], a[116:119], v[116:119], v[240:243]
v_exp_f32 v15, v47
v_mfma_f32_16x16x32_bf16 v[244:247], a[116:119], v[124:127], v[244:247]
ds_read_b128 a[84:87], v1 offset:37888
v_add_f32 v27, v27, v14
v_mfma_f32_16x16x32_bf16 v[244:247], a[112:115], v[120:123], v[244:247]
s_waitcnt lgkmcnt(7)
v_add_f32 v27, v27, v15
v_cvt_pk_bf16_f32 v107, v14, v15
v_mfma_f32_16x16x32_bf16 v[248:251], a[120:123], v[112:115], v[248:251]
s_waitcnt lgkmcnt(6)
ds_read_b128 a[88:91], v1 offset:38912
v_mfma_f32_16x16x32_bf16 v[248:251], a[124:127], v[116:119], v[248:251]
v_mfma_f32_16x16x32_bf16 v[252:255], a[124:127], v[124:127], v[252:255]
ds_read_b128 a[92:95], v1 offset:39936
v_mfma_f32_16x16x32_bf16 v[252:255], a[120:123], v[120:123], v[252:255]
s_waitcnt lgkmcnt(7)
K2_x1:
v_mfma_f32_16x16x32_bf16 v[64:67], a[64:67], a[0:3], v[16:19]
s_waitcnt lgkmcnt(6)
s_add_u32 m0, s18, 0
ds_read_b128 a[96:99], v1 offset:40960
v_mfma_f32_16x16x32_bf16 v[64:67], a[68:71], a[4:7], v[64:67]
s_waitcnt lgkmcnt(6)
buffer_load_dwordx4 v1, s[4:7], s8 offen offset:0 sc1 lds
v_mfma_f32_16x16x32_bf16 v[64:67], a[72:75], a[8:11], v[64:67]
s_waitcnt lgkmcnt(5)
ds_read_b128 a[100:103], v1 offset:41984
v_mfma_f32_16x16x32_bf16 v[64:67], a[76:79], a[12:15], v[64:67]
s_waitcnt lgkmcnt(5)
v_exp_f32 v8, v48
v_mfma_f32_16x16x32_bf16 v[64:67], a[80:83], a[16:19], v[64:67]
s_waitcnt lgkmcnt(4)
ds_read_b128 a[104:107], v1 offset:43008
v_add_f32 v26, v26, v8
v_mfma_f32_16x16x32_bf16 v[64:67], a[84:87], a[20:23], v[64:67]
s_waitcnt lgkmcnt(4)
buffer_load_dwordx4 v1, s[4:7], s8 offen offset:1024 sc1 lds
v_mfma_f32_16x16x32_bf16 v[64:67], a[88:91], a[24:27], v[64:67]
s_waitcnt lgkmcnt(3)
ds_read_b128 a[108:111], v1 offset:44032
v_mfma_f32_16x16x32_bf16 v[64:67], a[92:95], a[28:31], v[64:67]
v_exp_f32 v9, v49
v_mfma_f32_16x16x32_bf16 v[68:71], a[64:67], a[32:35], v[20:23]
ds_read_b128 a[112:115], v1 offset:45056
v_add_f32 v26, v26, v9
v_mfma_f32_16x16x32_bf16 v[68:71], a[68:71], a[36:39], v[68:71]
buffer_load_dwordx4 v1, s[4:7], s8 offen offset:2048 sc1 lds
v_mfma_f32_16x16x32_bf16 v[68:71], a[72:75], a[40:43], v[68:71]
ds_read_b128 a[116:119], v1 offset:46080
v_cvt_pk_bf16_f32 v100, v8, v9
v_mfma_f32_16x16x32_bf16 v[68:71], a[76:79], a[44:47], v[68:71]
v_exp_f32 v10, v50
v_mfma_f32_16x16x32_bf16 v[68:71], a[80:83], a[48:51], v[68:71]
ds_read_b128 a[120:123], v1 offset:47104
v_add_f32 v26, v26, v10
v_mfma_f32_16x16x32_bf16 v[68:71], a[84:87], a[52:55], v[68:71]
buffer_load_dwordx4 v1, s[4:7], s8 offen offset:3072 sc1 lds
v_mfma_f32_16x16x32_bf16 v[68:71], a[88:91], a[56:59], v[68:71]
s_add_u32 s8, s8, 4096
ds_read_b128 a[124:127], v1 offset:48128
v_mfma_f32_16x16x32_bf16 v[68:71], a[92:95], a[60:63], v[68:71]
s_waitcnt lgkmcnt(6)
v_exp_f32 v11, v51
v_mfma_f32_16x16x32_bf16 v[72:75], a[96:99], a[0:3], v[16:19]
s_add_u32 m0, s18, 4096
ds_read_b128 a[64:67], v1 offset:49152
v_add_f32 v26, v26, v11
v_mfma_f32_16x16x32_bf16 v[72:75], a[100:103], a[4:7], v[72:75]
s_waitcnt lgkmcnt(6)
buffer_load_dwordx4 v1, s[4:7], s8 offen offset:0 sc1 lds
v_mfma_f32_16x16x32_bf16 v[72:75], a[104:107], a[8:11], v[72:75]
s_waitcnt lgkmcnt(5)
ds_read_b128 a[68:71], v1 offset:50176
v_cvt_pk_bf16_f32 v101, v10, v11
v_mfma_f32_16x16x32_bf16 v[72:75], a[108:111], a[12:15], v[72:75]
s_waitcnt lgkmcnt(5)
v_mfma_f32_16x16x32_bf16 v[72:75], a[112:115], a[16:19], v[72:75]
s_waitcnt lgkmcnt(4)
ds_read_b128 a[72:75], v1 offset:51200
v_mfma_f32_16x16x32_bf16 v[72:75], a[116:119], a[20:23], v[72:75]
s_waitcnt lgkmcnt(4)
buffer_load_dwordx4 v1, s[4:7], s8 offen offset:1024 sc1 lds
v_mfma_f32_16x16x32_bf16 v[72:75], a[120:123], a[24:27], v[72:75]
s_waitcnt lgkmcnt(3)
ds_read_b128 a[76:79], v1 offset:52224
v_mfma_f32_16x16x32_bf16 v[72:75], a[124:127], a[28:31], v[72:75]
v_exp_f32 v12, v52
v_mfma_f32_16x16x32_bf16 v[76:79], a[96:99], a[32:35], v[20:23]
ds_read_b128 a[80:83], v1 offset:53248
v_add_f32 v27, v27, v12
v_mfma_f32_16x16x32_bf16 v[76:79], a[100:103], a[36:39], v[76:79]
buffer_load_dwordx4 v1, s[4:7], s8 offen offset:2048 sc1 lds
v_mfma_f32_16x16x32_bf16 v[76:79], a[104:107], a[40:43], v[76:79]
ds_read_b128 a[84:87], v1 offset:54272
v_mfma_f32_16x16x32_bf16 v[76:79], a[108:111], a[44:47], v[76:79]
v_exp_f32 v13, v53
v_mfma_f32_16x16x32_bf16 v[76:79], a[112:115], a[48:51], v[76:79]
ds_read_b128 a[88:91], v1 offset:55296
v_add_f32 v27, v27, v13
v_mfma_f32_16x16x32_bf16 v[76:79], a[116:119], a[52:55], v[76:79]
s_waitcnt lgkmcnt(3)
buffer_load_dwordx4 v1, s[4:7], s8 offen offset:3072 sc1 lds
v_mfma_f32_16x16x32_bf16 v[76:79], a[120:123], a[56:59], v[76:79]
s_add_u32 s8, s8, 28672
ds_read_b128 a[92:95], v1 offset:56320
v_cvt_pk_bf16_f32 v108, v12, v13
v_mfma_f32_16x16x32_bf16 v[76:79], a[124:127], a[60:63], v[76:79]
s_sub_u32 s9, s9, 1
v_exp_f32 v14, v54
v_mfma_f32_16x16x32_bf16 v[80:83], a[64:67], a[0:3], v[16:19]
s_cmp_eq_u32 s9, 0
ds_read_b128 a[96:99], v1 offset:57344
v_add_f32 v27, v27, v14
v_mfma_f32_16x16x32_bf16 v[80:83], a[68:71], a[4:7], v[80:83]
s_cselect_b32 s8, s10, s8
v_exp_f32 v15, v55
v_mfma_f32_16x16x32_bf16 v[80:83], a[72:75], a[8:11], v[80:83]
s_cselect_b32 s9, s11, s9
ds_read_b128 a[100:103], v1 offset:58368
v_add_f32 v27, v27, v15
v_mfma_f32_16x16x32_bf16 v[80:83], a[76:79], a[12:15], v[80:83]
s_waitcnt lgkmcnt(5)
s_cselect_b32 s10, 3221225472, s10
v_cvt_pk_bf16_f32 v109, v14, v15
v_mfma_f32_16x16x32_bf16 v[80:83], a[80:83], a[16:19], v[80:83]
s_waitcnt lgkmcnt(4)
ds_read_b128 a[104:107], v1 offset:59392
v_mfma_f32_16x16x32_bf16 v[80:83], a[84:87], a[20:23], v[80:83]
s_waitcnt lgkmcnt(4)
v_exp_f32 v8, v56
v_mfma_f32_16x16x32_bf16 v[80:83], a[88:91], a[24:27], v[80:83]
s_waitcnt lgkmcnt(3)
ds_read_b128 a[108:111], v1 offset:60416
v_add_f32 v26, v26, v8
v_mfma_f32_16x16x32_bf16 v[80:83], a[92:95], a[28:31], v[80:83]
v_exp_f32 v9, v57
v_mfma_f32_16x16x32_bf16 v[84:87], a[64:67], a[32:35], v[20:23]
ds_read_b128 a[112:115], v1 offset:61440
v_add_f32 v26, v26, v9
v_mfma_f32_16x16x32_bf16 v[84:87], a[68:71], a[36:39], v[84:87]
v_exp_f32 v10, v58
v_mfma_f32_16x16x32_bf16 v[84:87], a[72:75], a[40:43], v[84:87]
ds_read_b128 a[116:119], v1 offset:62464
v_cvt_pk_bf16_f32 v102, v8, v9
v_mfma_f32_16x16x32_bf16 v[84:87], a[76:79], a[44:47], v[84:87]
v_exp_f32 v11, v59
v_mfma_f32_16x16x32_bf16 v[84:87], a[80:83], a[48:51], v[84:87]
ds_read_b128 a[120:123], v1 offset:63488
v_add_f32 v26, v26, v10
v_mfma_f32_16x16x32_bf16 v[84:87], a[84:87], a[52:55], v[84:87]
v_add_f32 v26, v26, v11
v_cvt_pk_bf16_f32 v103, v10, v11
v_mfma_f32_16x16x32_bf16 v[84:87], a[88:91], a[56:59], v[84:87]
ds_read_b128 a[124:127], v1 offset:64512
v_mfma_f32_16x16x32_bf16 v[84:87], a[92:95], a[60:63], v[84:87]
s_waitcnt vmcnt(8) lgkmcnt(7)
s_barrier
v_mfma_f32_16x16x32_bf16 v[88:91], a[96:99], a[0:3], v[16:19]
s_waitcnt lgkmcnt(6)
ds_read_b128 a[64:67], v2 offset:0
v_mfma_f32_16x16x32_bf16 v[88:91], a[100:103], a[4:7], v[88:91]
s_waitcnt lgkmcnt(6)
v_exp_f32 v12, v60
v_mfma_f32_16x16x32_bf16 v[88:91], a[104:107], a[8:11], v[88:91]
s_waitcnt lgkmcnt(5)
ds_read_b128 a[68:71], v2 offset:1024
v_add_f32 v27, v27, v12
v_mfma_f32_16x16x32_bf16 v[88:91], a[108:111], a[12:15], v[88:91]
s_waitcnt lgkmcnt(5)
v_exp_f32 v13, v61
v_mfma_f32_16x16x32_bf16 v[88:91], a[112:115], a[16:19], v[88:91]
s_waitcnt lgkmcnt(4)
ds_read_b128 a[72:75], v2 offset:2048
v_add_f32 v27, v27, v13
v_mfma_f32_16x16x32_bf16 v[88:91], a[116:119], a[20:23], v[88:91]
s_waitcnt lgkmcnt(4)
v_exp_f32 v14, v62
v_mfma_f32_16x16x32_bf16 v[88:91], a[120:123], a[24:27], v[88:91]
s_waitcnt lgkmcnt(3)
ds_read_b128 a[76:79], v2 offset:3072
v_cvt_pk_bf16_f32 v110, v12, v13
v_mfma_f32_16x16x32_bf16 v[88:91], a[124:127], a[28:31], v[88:91]
v_exp_f32 v15, v63
v_mfma_f32_16x16x32_bf16 v[92:95], a[96:99], a[32:35], v[20:23]
s_sub_u32 s19, s19, 1
ds_read_b128 a[80:83], v2 offset:4096
v_add_f32 v27, v27, v14
v_mfma_f32_16x16x32_bf16 v[92:95], a[100:103], a[36:39], v[92:95]
v_add_f32 v27, v27, v15
v_cvt_pk_bf16_f32 v111, v14, v15
v_mfma_f32_16x16x32_bf16 v[92:95], a[104:107], a[40:43], v[92:95]
ds_read_b128 a[84:87], v2 offset:5120
v_add_f32 v28, v26, v27
v_mfma_f32_16x16x32_bf16 v[92:95], a[108:111], a[44:47], v[92:95]
v_cmp_nge_f32 vcc, s25, v28
v_mfma_f32_16x16x32_bf16 v[92:95], a[112:115], a[48:51], v[92:95]
ds_read_b128 a[88:91], v2 offset:6144
v_mfma_f32_16x16x32_bf16 v[92:95], a[116:119], a[52:55], v[92:95]
v_mfma_f32_16x16x32_bf16 v[92:95], a[120:123], a[56:59], v[92:95]
ds_read_b128 a[92:95], v2 offset:7168
v_mfma_f32_16x16x32_bf16 v[92:95], a[124:127], a[60:63], v[92:95]
s_waitcnt lgkmcnt(6)
s_cbranch_vccnz Lstub_5
Lback_6:
s_cmp_lg_u32 s19, 0
s_cbranch_scc1 K2_loop
s_cmp_eq_u32 s24, 2
s_cbranch_scc1 K2_ntail
v_mfma_f32_16x16x32_bf16 v[128:131], a[64:67], v[96:99], v[128:131]
s_add_u32 m0, s18, 98304
ds_read_b128 a[96:99], v2 offset:8192
v_add_f32 v24, v24, v26
v_mfma_f32_16x16x32_bf16 v[128:131], a[68:71], v[100:103], v[128:131]
buffer_load_dwordx4 v1, s[4:7], s12 offen offset:0 sc1 lds
v_mfma_f32_16x16x32_bf16 v[132:135], a[68:71], v[108:111], v[132:135]
ds_read_b128 a[100:103], v2 offset:9216
v_add_f32 v25, v25, v27
v_mfma_f32_16x16x32_bf16 v[132:135], a[64:67], v[104:107], v[132:135]
s_waitcnt lgkmcnt(7)
v_exp_f32 v8, v64
v_mfma_f32_16x16x32_bf16 v[136:139], a[72:75], v[96:99], v[136:139]
s_waitcnt lgkmcnt(6)
ds_read_b128 a[104:107], v2 offset:10240
v_mfma_f32_16x16x32_bf16 v[136:139], a[76:79], v[100:103], v[136:139]
buffer_load_dwordx4 v1, s[4:7], s12 offen offset:1024 sc1 lds
v_mfma_f32_16x16x32_bf16 v[140:143], a[76:79], v[108:111], v[140:143]
ds_read_b128 a[108:111], v2 offset:11264
v_mfma_f32_16x16x32_bf16 v[140:143], a[72:75], v[104:107], v[140:143]
s_waitcnt lgkmcnt(7)
v_exp_f32 v9, v65
v_mfma_f32_16x16x32_bf16 v[144:147], a[80:83], v[96:99], v[144:147]
s_waitcnt lgkmcnt(6)
ds_read_b128 a[112:115], v2 offset:12288
v_add_f32 v26, v8, v9
v_mfma_f32_16x16x32_bf16 v[144:147], a[84:87], v[100:103], v[144:147]
buffer_load_dwordx4 v1, s[4:7], s12 offen offset:2048 sc1 lds
v_mfma_f32_16x16x32_bf16 v[148:151], a[84:87], v[108:111], v[148:151]
ds_read_b128 a[116:119], v2 offset:13312
v_cvt_pk_bf16_f32 v112, v8, v9
v_mfma_f32_16x16x32_bf16 v[148:151], a[80:83], v[104:107], v[148:151]
s_waitcnt lgkmcnt(7)
v_exp_f32 v10, v66
v_mfma_f32_16x16x32_bf16 v[152:155], a[88:91], v[96:99], v[152:155]
s_waitcnt lgkmcnt(6)
ds_read_b128 a[120:123], v2 offset:14336
v_add_f32 v26, v26, v10
v_mfma_f32_16x16x32_bf16 v[152:155], a[92:95], v[100:103], v[152:155]
buffer_load_dwordx4 v1, s[4:7], s12 offen offset:3072 sc1 lds
v_mfma_f32_16x16x32_bf16 v[156:159], a[92:95], v[108:111], v[156:159]
s_add_u32 s12, s12, 4096
ds_read_b128 a[124:127], v2 offset:15360
v_mfma_f32_16x16x32_bf16 v[156:159], a[88:91], v[104:107], v[156:159]
s_waitcnt lgkmcnt(6)
v_exp_f32 v11, v67
v_mfma_f32_16x16x32_bf16 v[160:163], a[96:99], v[96:99], v[160:163]
s_add_u32 m0, s18, 102400
ds_read_b128 a[64:67], v2 offset:16384
v_add_f32 v26, v26, v11
v_mfma_f32_16x16x32_bf16 v[160:163], a[100:103], v[100:103], v[160:163]
buffer_load_dwordx4 v1, s[4:7], s12 offen offset:0 sc1 lds
v_mfma_f32_16x16x32_bf16 v[164:167], a[100:103], v[108:111], v[164:167]
ds_read_b128 a[68:71], v2 offset:17408
v_cvt_pk_bf16_f32 v113, v10, v11
v_mfma_f32_16x16x32_bf16 v[164:167], a[96:99], v[104:107], v[164:167]
s_waitcnt lgkmcnt(7)
v_mfma_f32_16x16x32_bf16 v[168:171], a[104:107], v[96:99], v[168:171]
s_waitcnt lgkmcnt(6)
ds_read_b128 a[72:75], v2 offset:18432
v_mfma_f32_16x16x32_bf16 v[168:171], a[108:111], v[100:103], v[168:171]
buffer_load_dwordx4 v1, s[4:7], s12 offen offset:1024 sc1 lds
v_mfma_f32_16x16x32_bf16 v[172:175], a[108:111], v[108:111], v[172:175]
ds_read_b128 a[76:79], v2 offset:19456
v_mfma_f32_16x16x32_bf16 v[172:175], a[104:107], v[104:107], v[172:175]
s_waitcnt lgkmcnt(7)
v_exp_f32 v12, v68
v_mfma_f32_16x16x32_bf16 v[176:179], a[112:115], v[96:99], v[176:179]
s_waitcnt lgkmcnt(6)
ds_read_b128 a[80:83], v2 offset:20480
v_mfma_f32_16x16x32_bf16 v[176:179], a[116:119], v[100:103], v[176:179]
buffer_load_dwordx4 v1, s[4:7], s12 offen offset:2048 sc1 lds
v_mfma_f32_16x16x32_bf16 v[180:183], a[116:119], v[108:111], v[180:183]
ds_read_b128 a[84:87], v2 offset:21504
v_mfma_f32_16x16x32_bf16 v[180:183], a[112:115], v[104:107], v[180:183]
s_waitcnt lgkmcnt(7)
v_exp_f32 v13, v69
v_mfma_f32_16x16x32_bf16 v[184:187], a[120:123], v[96:99], v[184:187]
s_waitcnt lgkmcnt(6)
ds_read_b128 a[88:91], v2 offset:22528
v_add_f32 v27, v12, v13
v_mfma_f32_16x16x32_bf16 v[184:187], a[124:127], v[100:103], v[184:187]
s_waitcnt lgkmcnt(5)
buffer_load_dwordx4 v1, s[4:7], s12 offen offset:3072 sc1 lds
v_mfma_f32_16x16x32_bf16 v[188:191], a[124:127], v[108:111], v[188:191]
s_add_u32 s12, s12, 28672
ds_read_b128 a[92:95], v2 offset:23552
v_cvt_pk_bf16_f32 v120, v12, v13
v_mfma_f32_16x16x32_bf16 v[188:191], a[120:123], v[104:107], v[188:191]
s_sub_u32 s13, s13, 1
v_exp_f32 v14, v70
v_mfma_f32_16x16x32_bf16 v[192:195], a[64:67], v[96:99], v[192:195]
s_cmp_eq_u32 s13, 0
ds_read_b128 a[96:99], v2 offset:24576
v_add_f32 v27, v27, v14
v_mfma_f32_16x16x32_bf16 v[192:195], a[68:71], v[100:103], v[192:195]
s_cselect_b32 s12, s14, s12
v_mfma_f32_16x16x32_bf16 v[196:199], a[68:71], v[108:111], v[196:199]
s_waitcnt lgkmcnt(6)
s_cselect_b32 s13, s15, s13
ds_read_b128 a[100:103], v2 offset:25600
v_mfma_f32_16x16x32_bf16 v[196:199], a[64:67], v[104:107], v[196:199]
s_cselect_b32 s14, 3221225472, s14
v_exp_f32 v15, v71
v_mfma_f32_16x16x32_bf16 v[200:203], a[72:75], v[96:99], v[200:203]
s_waitcnt lgkmcnt(6)
ds_read_b128 a[104:107], v2 offset:26624
v_add_f32 v27, v27, v15
v_mfma_f32_16x16x32_bf16 v[200:203], a[76:79], v[100:103], v[200:203]
v_exp_f32 v8, v72
v_mfma_f32_16x16x32_bf16 v[204:207], a[76:79], v[108:111], v[204:207]
ds_read_b128 a[108:111], v2 offset:27648
v_cvt_pk_bf16_f32 v121, v14, v15
v_mfma_f32_16x16x32_bf16 v[204:207], a[72:75], v[104:107], v[204:207]
s_waitcnt lgkmcnt(7)
v_exp_f32 v9, v73
v_mfma_f32_16x16x32_bf16 v[208:211], a[80:83], v[96:99], v[208:211]
s_waitcnt lgkmcnt(6)
ds_read_b128 a[112:115], v2 offset:28672
v_add_f32 v26, v26, v8
v_mfma_f32_16x16x32_bf16 v[208:211], a[84:87], v[100:103], v[208:211]
v_add_f32 v26, v26, v9
v_cvt_pk_bf16_f32 v114, v8, v9
v_mfma_f32_16x16x32_bf16 v[212:215], a[84:87], v[108:111], v[212:215]
ds_read_b128 a[116:119], v2 offset:29696
v_mfma_f32_16x16x32_bf16 v[212:215], a[80:83], v[104:107], v[212:215]
s_waitcnt lgkmcnt(7)
v_exp_f32 v10, v74
v_mfma_f32_16x16x32_bf16 v[216:219], a[88:91], v[96:99], v[216:219]
s_waitcnt lgkmcnt(6)
ds_read_b128 a[120:123], v2 offset:30720
v_add_f32 v26, v26, v10
v_mfma_f32_16x16x32_bf16 v[216:219], a[92:95], v[100:103], v[216:219]
v_exp_f32 v11, v75
v_mfma_f32_16x16x32_bf16 v[220:223], a[92:95], v[108:111], v[220:223]
ds_read_b128 a[124:127], v2 offset:31744
v_add_f32 v26, v26, v11
v_mfma_f32_16x16x32_bf16 v[220:223], a[88:91], v[104:107], v[220:223]
s_waitcnt vmcnt(8) lgkmcnt(7)
s_barrier
v_cvt_pk_bf16_f32 v115, v10, v11
v_mfma_f32_16x16x32_bf16 v[224:227], a[96:99], v[96:99], v[224:227]
s_waitcnt lgkmcnt(6)
ds_read_b128 a[64:67], v1 offset:0
v_mfma_f32_16x16x32_bf16 v[224:227], a[100:103], v[100:103], v[224:227]
v_exp_f32 v12, v76
v_mfma_f32_16x16x32_bf16 v[228:231], a[100:103], v[108:111], v[228:231]
ds_read_b128 a[68:71], v1 offset:1024
v_add_f32 v27, v27, v12
v_mfma_f32_16x16x32_bf16 v[228:231], a[96:99], v[104:107], v[228:231]
s_waitcnt lgkmcnt(7)
v_mfma_f32_16x16x32_bf16 v[232:235], a[104:107], v[96:99], v[232:235]
s_waitcnt lgkmcnt(6)
ds_read_b128 a[72:75], v1 offset:2048
v_mfma_f32_16x16x32_bf16 v[232:235], a[108:111], v[100:103], v[232:235]
v_exp_f32 v13, v77
v_mfma_f32_16x16x32_bf16 v[236:239], a[108:111], v[108:111], v[236:239]
ds_read_b128 a[76:79], v1 offset:3072
v_add_f32 v27, v27, v13
v_mfma_f32_16x16x32_bf16 v[236:239], a[104:107], v[104:107], v[236:239]
s_waitcnt lgkmcnt(7)
v_exp_f32 v14, v78
v_mfma_f32_16x16x32_bf16 v[240:243], a[112:115], v[96:99], v[240:243]
s_waitcnt lgkmcnt(6)
ds_read_b128 a[80:83], v1 offset:4096
v_cvt_pk_bf16_f32 v122, v12, v13
v_mfma_f32_16x16x32_bf16 v[240:243], a[116:119], v[100:103], v[240:243]
v_exp_f32 v15, v79
v_mfma_f32_16x16x32_bf16 v[244:247], a[116:119], v[108:111], v[244:247]
ds_read_b128 a[84:87], v1 offset:5120
v_add_f32 v27, v27, v14
v_mfma_f32_16x16x32_bf16 v[244:247], a[112:115], v[104:107], v[244:247]
s_waitcnt lgkmcnt(7)
v_add_f32 v27, v27, v15
v_cvt_pk_bf16_f32 v123, v14, v15
v_mfma_f32_16x16x32_bf16 v[248:251], a[120:123], v[96:99], v[248:251]
s_waitcnt lgkmcnt(6)
ds_read_b128 a[88:91], v1 offset:6144
v_mfma_f32_16x16x32_bf16 v[248:251], a[124:127], v[100:103], v[248:251]
v_mfma_f32_16x16x32_bf16 v[252:255], a[124:127], v[108:111], v[252:255]
ds_read_b128 a[92:95], v1 offset:7168
v_mfma_f32_16x16x32_bf16 v[252:255], a[120:123], v[104:107], v[252:255]
s_waitcnt lgkmcnt(6)
v_cndmask_b32 v32, v16, v7, s[32:33]
v_cndmask_b32 v33, v16, v7, s[34:35]
v_cndmask_b32 v34, v16, v7, s[36:37]
v_cndmask_b32 v35, v16, v7, s[38:39]
s_nop 1
v_mfma_f32_16x16x32_bf16 v[32:35], a[64:67], a[0:3], v[32:35]
s_add_u32 m0, s18, 32768
ds_read_b128 a[96:99], v1 offset:8192
v_cndmask_b32 v40, v16, v7, s[40:41]
v_mfma_f32_16x16x32_bf16 v[32:35], a[68:71], a[4:7], v[32:35]
s_waitcnt lgkmcnt(6)
buffer_load_dwordx4 v1, s[4:7], s8 offen offset:0 sc1 lds
v_mfma_f32_16x16x32_bf16 v[32:35], a[72:75], a[8:11], v[32:35]
s_waitcnt lgkmcnt(5)
ds_read_b128 a[100:103], v1 offset:9216
v_cndmask_b32 v41, v16, v7, s[42:43]
v_mfma_f32_16x16x32_bf16 v[32:35], a[76:79], a[12:15], v[32:35]
s_waitcnt lgkmcnt(5)
v_cndmask_b32 v42, v16, v7, s[44:45]
v_cndmask_b32 v43, v16, v7, s[46:47]
v_mfma_f32_16x16x32_bf16 v[32:35], a[80:83], a[16:19], v[32:35]
s_waitcnt lgkmcnt(4)
ds_read_b128 a[104:107], v1 offset:10240
v_mfma_f32_16x16x32_bf16 v[32:35], a[84:87], a[20:23], v[32:35]
s_waitcnt lgkmcnt(4)
buffer_load_dwordx4 v1, s[4:7], s8 offen offset:1024 sc1 lds
v_mfma_f32_16x16x32_bf16 v[32:35], a[88:91], a[24:27], v[32:35]
s_waitcnt lgkmcnt(3)
ds_read_b128 a[108:111], v1 offset:11264
v_mfma_f32_16x16x32_bf16 v[32:35], a[92:95], a[28:31], v[32:35]
v_exp_f32 v8, v80
v_mfma_f32_16x16x32_bf16 v[36:39], a[64:67], a[32:35], v[20:23]
ds_read_b128 a[112:115], v1 offset:12288
v_add_f32 v26, v26, v8
v_mfma_f32_16x16x32_bf16 v[36:39], a[68:71], a[36:39], v[36:39]
buffer_load_dwordx4 v1, s[4:7], s8 offen offset:2048 sc1 lds
v_mfma_f32_16x16x32_bf16 v[36:39], a[72:75], a[40:43], v[36:39]
ds_read_b128 a[116:119], v1 offset:13312
v_mfma_f32_16x16x32_bf16 v[36:39], a[76:79], a[44:47], v[36:39]
v_exp_f32 v9, v81
v_mfma_f32_16x16x32_bf16 v[36:39], a[80:83], a[48:51], v[36:39]
ds_read_b128 a[120:123], v1 offset:14336
v_add_f32 v26, v26, v9
v_mfma_f32_16x16x32_bf16 v[36:39], a[84:87], a[52:55], v[36:39]
buffer_load_dwordx4 v1, s[4:7], s8 offen offset:3072 sc1 lds
v_mfma_f32_16x16x32_bf16 v[36:39], a[88:91], a[56:59], v[36:39]
s_add_u32 s8, s8, 4096
ds_read_b128 a[124:127], v1 offset:15360
v_cvt_pk_bf16_f32 v116, v8, v9
v_mfma_f32_16x16x32_bf16 v[36:39], a[92:95], a[60:63], v[36:39]
s_waitcnt lgkmcnt(6)
v_exp_f32 v10, v82
v_mfma_f32_16x16x32_bf16 v[40:43], a[96:99], a[0:3], v[40:43]
s_add_u32 m0, s18, 36864
ds_read_b128 a[64:67], v1 offset:16384
v_cndmask_b32 v48, v16, v7, s[48:49]
v_mfma_f32_16x16x32_bf16 v[40:43], a[100:103], a[4:7], v[40:43]
s_waitcnt lgkmcnt(6)
buffer_load_dwordx4 v1, s[4:7], s8 offen offset:0 sc1 lds
v_mfma_f32_16x16x32_bf16 v[40:43], a[104:107], a[8:11], v[40:43]
s_waitcnt lgkmcnt(5)
ds_read_b128 a[68:71], v1 offset:17408
v_cndmask_b32 v49, v16, v7, s[50:51]
v_mfma_f32_16x16x32_bf16 v[40:43], a[108:111], a[12:15], v[40:43]
s_waitcnt lgkmcnt(5)
v_cndmask_b32 v50, v16, v7, s[52:53]
v_cndmask_b32 v51, v16, v7, s[54:55]
v_mfma_f32_16x16x32_bf16 v[40:43], a[112:115], a[16:19], v[40:43]
s_waitcnt lgkmcnt(4)
ds_read_b128 a[72:75], v1 offset:18432
v_add_f32 v26, v26, v10
v_mfma_f32_16x16x32_bf16 v[40:43], a[116:119], a[20:23], v[40:43]
s_waitcnt lgkmcnt(4)
buffer_load_dwordx4 v1, s[4:7], s8 offen offset:1024 sc1 lds
v_mfma_f32_16x16x32_bf16 v[40:43], a[120:123], a[24:27], v[40:43]
s_waitcnt lgkmcnt(3)
ds_read_b128 a[76:79], v1 offset:19456
v_mfma_f32_16x16x32_bf16 v[40:43], a[124:127], a[28:31], v[40:43]
v_exp_f32 v11, v83
v_mfma_f32_16x16x32_bf16 v[44:47], a[96:99], a[32:35], v[20:23]
ds_read_b128 a[80:83], v1 offset:20480
v_add_f32 v26, v26, v11
v_mfma_f32_16x16x32_bf16 v[44:47], a[100:103], a[36:39], v[44:47]
buffer_load_dwordx4 v1, s[4:7], s8 offen offset:2048 sc1 lds
v_mfma_f32_16x16x32_bf16 v[44:47], a[104:107], a[40:43], v[44:47]
ds_read_b128 a[84:87], v1 offset:21504
v_cvt_pk_bf16_f32 v117, v10, v11
v_mfma_f32_16x16x32_bf16 v[44:47], a[108:111], a[44:47], v[44:47]
v_exp_f32 v12, v84
v_mfma_f32_16x16x32_bf16 v[44:47], a[112:115], a[48:51], v[44:47]
ds_read_b128 a[88:91], v1 offset:22528
v_add_f32 v27, v27, v12
v_mfma_f32_16x16x32_bf16 v[44:47], a[116:119], a[52:55], v[44:47]
buffer_load_dwordx4 v1, s[4:7], s8 offen offset:3072 sc1 lds
v_mfma_f32_16x16x32_bf16 v[44:47], a[120:123], a[56:59], v[44:47]
s_waitcnt lgkmcnt(2)
s_add_u32 s8, s8, 28672
ds_read_b128 a[92:95], v1 offset:23552
v_mfma_f32_16x16x32_bf16 v[44:47], a[124:127], a[60:63], v[44:47]
s_sub_u32 s9, s9, 1
v_exp_f32 v13, v85
v_mfma_f32_16x16x32_bf16 v[48:51], a[64:67], a[0:3], v[48:51]
s_cmp_eq_u32 s9, 0
ds_read_b128 a[96:99], v1 offset:24576
v_cndmask_b32 v56, v16, v7, s[56:57]
v_mfma_f32_16x16x32_bf16 v[48:51], a[68:71], a[4:7], v[48:51]
s_cselect_b32 s8, s10, s8
v_cndmask_b32 v57, v16, v7, s[58:59]
v_cndmask_b32 v58, v16, v7, s[60:61]
v_mfma_f32_16x16x32_bf16 v[48:51], a[72:75], a[8:11], v[48:51]
s_cselect_b32 s9, s11, s9
ds_read_b128 a[100:103], v1 offset:25600
v_cndmask_b32 v59, v16, v7, s[62:63]
v_mfma_f32_16x16x32_bf16 v[48:51], a[76:79], a[12:15], v[48:51]
s_cselect_b32 s10, 3221225472, s10
v_exp_f32 v14, v86
v_mfma_f32_16x16x32_bf16 v[48:51], a[80:83], a[16:19], v[48:51]
s_waitcnt lgkmcnt(4)
ds_read_b128 a[104:107], v1 offset:26624
v_add_f32 v27, v27, v13
v_cvt_pk_bf16_f32 v124, v12, v13
v_mfma_f32_16x16x32_bf16 v[48:51], a[84:87], a[20:23], v[48:51]
s_waitcnt lgkmcnt(4)
v_exp_f32 v15, v87
v_mfma_f32_16x16x32_bf16 v[48:51], a[88:91], a[24:27], v[48:51]
s_waitcnt lgkmcnt(3)
ds_read_b128 a[108:111], v1 offset:27648
v_add_f32 v27, v27, v14
v_mfma_f32_16x16x32_bf16 v[48:51], a[92:95], a[28:31], v[48:51]
v_exp_f32 v8, v88
v_mfma_f32_16x16x32_bf16 v[52:55], a[64:67], a[32:35], v[20:23]
ds_read_b128 a[112:115], v1 offset:28672
v_add_f32 v27, v27, v15
v_mfma_f32_16x16x32_bf16 v[52:55], a[68:71], a[36:39], v[52:55]
v_exp_f32 v9, v89
v_mfma_f32_16x16x32_bf16 v[52:55], a[72:75], a[40:43], v[52:55]
ds_read_b128 a[116:119], v1 offset:29696
v_cvt_pk_bf16_f32 v125, v14, v15
v_mfma_f32_16x16x32_bf16 v[52:55], a[76:79], a[44:47], v[52:55]
v_exp_f32 v10, v90
v_mfma_f32_16x16x32_bf16 v[52:55], a[80:83], a[48:51], v[52:55]
ds_read_b128 a[120:123], v1 offset:30720
v_add_f32 v26, v26, v8
v_mfma_f32_16x16x32_bf16 v[52:55], a[84:87], a[52:55], v[52:55]
v_exp_f32 v11, v91
v_mfma_f32_16x16x32_bf16 v[52:55], a[88:91], a[56:59], v[52:55]
ds_read_b128 a[124:127], v1 offset:31744
v_add_f32 v26, v26, v9
v_cvt_pk_bf16_f32 v118, v8, v9
v_mfma_f32_16x16x32_bf16 v[52:55], a[92:95], a[60:63], v[52:55]
s_waitcnt vmcnt(8) lgkmcnt(7)
s_barrier
v_add_f32 v26, v26, v10
v_mfma_f32_16x16x32_bf16 v[56:59], a[96:99], a[0:3], v[56:59]
s_waitcnt lgkmcnt(6)
ds_read_b128 a[64:67], v2 offset:32768
v_add_f32 v26, v26, v11
v_mfma_f32_16x16x32_bf16 v[56:59], a[100:103], a[4:7], v[56:59]
s_waitcnt lgkmcnt(6)
v_exp_f32 v12, v92
v_mfma_f32_16x16x32_bf16 v[56:59], a[104:107], a[8:11], v[56:59]
s_waitcnt lgkmcnt(5)
ds_read_b128 a[68:71], v2 offset:33792
v_cvt_pk_bf16_f32 v119, v10, v11
v_mfma_f32_16x16x32_bf16 v[56:59], a[108:111], a[12:15], v[56:59]
s_waitcnt lgkmcnt(5)
v_exp_f32 v13, v93
v_mfma_f32_16x16x32_bf16 v[56:59], a[112:115], a[16:19], v[56:59]
s_waitcnt lgkmcnt(4)
ds_read_b128 a[72:75], v2 offset:34816
v_add_f32 v27, v27, v12
v_mfma_f32_16x16x32_bf16 v[56:59], a[116:119], a[20:23], v[56:59]
s_waitcnt lgkmcnt(4)
v_exp_f32 v14, v94
v_mfma_f32_16x16x32_bf16 v[56:59], a[120:123], a[24:27], v[56:59]
s_waitcnt lgkmcnt(3)
ds_read_b128 a[76:79], v2 offset:35840
v_add_f32 v27, v27, v13
v_mfma_f32_16x16x32_bf16 v[56:59], a[124:127], a[28:31], v[56:59]
v_exp_f32 v15, v95
v_mfma_f32_16x16x32_bf16 v[60:63], a[96:99], a[32:35], v[20:23]
ds_read_b128 a[80:83], v2 offset:36864
v_cvt_pk_bf16_f32 v126, v12, v13
v_mfma_f32_16x16x32_bf16 v[60:63], a[100:103], a[36:39], v[60:63]
v_add_f32 v27, v27, v14
v_add_f32 v27, v27, v15
v_mfma_f32_16x16x32_bf16 v[60:63], a[104:107], a[40:43], v[60:63]
ds_read_b128 a[84:87], v2 offset:37888
v_cvt_pk_bf16_f32 v127, v14, v15
v_mfma_f32_16x16x32_bf16 v[60:63], a[108:111], a[44:47], v[60:63]
v_add_f32 v28, v26, v27
v_cmp_nge_f32 vcc, s25, v28
v_mfma_f32_16x16x32_bf16 v[60:63], a[112:115], a[48:51], v[60:63]
ds_read_b128 a[88:91], v2 offset:38912
v_mfma_f32_16x16x32_bf16 v[60:63], a[116:119], a[52:55], v[60:63]
v_mfma_f32_16x16x32_bf16 v[60:63], a[120:123], a[56:59], v[60:63]
ds_read_b128 a[92:95], v2 offset:39936
v_mfma_f32_16x16x32_bf16 v[60:63], a[124:127], a[60:63], v[60:63]
s_waitcnt lgkmcnt(6)
s_cbranch_vccnz Lstub_7
Lback_8:
v_mfma_f32_16x16x32_bf16 v[128:131], a[64:67], v[112:115], v[128:131]
s_add_u32 m0, s18, 65536
ds_read_b128 a[96:99], v2 offset:40960
v_add_f32 v24, v24, v26
v_mfma_f32_16x16x32_bf16 v[128:131], a[68:71], v[116:119], v[128:131]
buffer_load_dwordx4 v1, s[4:7], s12 offen offset:0 sc1 lds
v_mfma_f32_16x16x32_bf16 v[132:135], a[68:71], v[124:127], v[132:135]
ds_read_b128 a[100:103], v2 offset:41984
v_add_f32 v25, v25, v27
v_mfma_f32_16x16x32_bf16 v[132:135], a[64:67], v[120:123], v[132:135]
s_waitcnt lgkmcnt(7)
v_exp_f32 v8, v32
v_mfma_f32_16x16x32_bf16 v[136:139], a[72:75], v[112:115], v[136:139]
s_waitcnt lgkmcnt(6)
ds_read_b128 a[104:107], v2 offset:43008
v_mfma_f32_16x16x32_bf16 v[136:139], a[76:79], v[116:119], v[136:139]
buffer_load_dwordx4 v1, s[4:7], s12 offen offset:1024 sc1 lds
v_mfma_f32_16x16x32_bf16 v[140:143], a[76:79], v[124:127], v[140:143]
ds_read_b128 a[108:111], v2 offset:44032
v_mfma_f32_16x16x32_bf16 v[140:143], a[72:75], v[120:123], v[140:143]
s_waitcnt lgkmcnt(7)
v_exp_f32 v9, v33
v_mfma_f32_16x16x32_bf16 v[144:147], a[80:83], v[112:115], v[144:147]
s_waitcnt lgkmcnt(6)
ds_read_b128 a[112:115], v2 offset:45056
v_add_f32 v26, v8, v9
v_mfma_f32_16x16x32_bf16 v[144:147], a[84:87], v[116:119], v[144:147]
buffer_load_dwordx4 v1, s[4:7], s12 offen offset:2048 sc1 lds
v_mfma_f32_16x16x32_bf16 v[148:151], a[84:87], v[124:127], v[148:151]
ds_read_b128 a[116:119], v2 offset:46080
v_cvt_pk_bf16_f32 v96, v8, v9
v_mfma_f32_16x16x32_bf16 v[148:151], a[80:83], v[120:123], v[148:151]
s_waitcnt lgkmcnt(7)
v_exp_f32 v10, v34
v_mfma_f32_16x16x32_bf16 v[152:155], a[88:91], v[112:115], v[152:155]
s_waitcnt lgkmcnt(6)
ds_read_b128 a[120:123], v2 offset:47104
v_add_f32 v26, v26, v10
v_mfma_f32_16x16x32_bf16 v[152:155], a[92:95], v[116:119], v[152:155]
buffer_load_dwordx4 v1, s[4:7], s12 offen offset:3072 sc1 lds
v_mfma_f32_16x16x32_bf16 v[156:159], a[92:95], v[124:127], v[156:159]
s_add_u32 s12, s12, 4096
ds_read_b128 a[124:127], v2 offset:48128
v_mfma_f32_16x16x32_bf16 v[156:159], a[88:91], v[120:123], v[156:159]
s_waitcnt lgkmcnt(6)
v_exp_f32 v11, v35
v_mfma_f32_16x16x32_bf16 v[160:163], a[96:99], v[112:115], v[160:163]
s_add_u32 m0, s18, 69632
ds_read_b128 a[64:67], v2 offset:49152
v_add_f32 v26, v26, v11
v_mfma_f32_16x16x32_bf16 v[160:163], a[100:103], v[116:119], v[160:163]
buffer_load_dwordx4 v1, s[4:7], s12 offen offset:0 sc1 lds
v_mfma_f32_16x16x32_bf16 v[164:167], a[100:103], v[124:127], v[164:167]
ds_read_b128 a[68:71], v2 offset:50176
v_cvt_pk_bf16_f32 v97, v10, v11
v_mfma_f32_16x16x32_bf16 v[164:167], a[96:99], v[120:123], v[164:167]
s_waitcnt lgkmcnt(7)
v_mfma_f32_16x16x32_bf16 v[168:171], a[104:107], v[112:115], v[168:171]
s_waitcnt lgkmcnt(6)
ds_read_b128 a[72:75], v2 offset:51200
v_mfma_f32_16x16x32_bf16 v[168:171], a[108:111], v[116:119], v[168:171]
buffer_load_dwordx4 v1, s[4:7], s12 offen offset:1024 sc1 lds
v_mfma_f32_16x16x32_bf16 v[172:175], a[108:111], v[124:127], v[172:175]
ds_read_b128 a[76:79], v2 offset:52224
v_mfma_f32_16x16x32_bf16 v[172:175], a[104:107], v[120:123], v[172:175]
s_waitcnt lgkmcnt(7)
v_exp_f32 v12, v36
v_mfma_f32_16x16x32_bf16 v[176:179], a[112:115], v[112:115], v[176:179]
s_waitcnt lgkmcnt(6)
ds_read_b128 a[80:83], v2 offset:53248
v_mfma_f32_16x16x32_bf16 v[176:179], a[116:119], v[116:119], v[176:179]
buffer_load_dwordx4 v1, s[4:7], s12 offen offset:2048 sc1 lds
v_mfma_f32_16x16x32_bf16 v[180:183], a[116:119], v[124:127], v[180:183]
ds_read_b128 a[84:87], v2 offset:54272
v_mfma_f32_16x16x32_bf16 v[180:183], a[112:115], v[120:123], v[180:183]
s_waitcnt lgkmcnt(7)
v_exp_f32 v13, v37
v_mfma_f32_16x16x32_bf16 v[184:187], a[120:123], v[112:115], v[184:187]
s_waitcnt lgkmcnt(6)
ds_read_b128 a[88:91], v2 offset:55296
v_add_f32 v27, v12, v13
v_mfma_f32_16x16x32_bf16 v[184:187], a[124:127], v[116:119], v[184:187]
s_waitcnt lgkmcnt(5)
buffer_load_dwordx4 v1, s[4:7], s12 offen offset:3072 sc1 lds
v_mfma_f32_16x16x32_bf16 v[188:191], a[124:127], v[124:127], v[188:191]
s_add_u32 s12, s12, 28672
ds_read_b128 a[92:95], v2 offset:56320
v_cvt_pk_bf16_f32 v104, v12, v13
v_mfma_f32_16x16x32_bf16 v[188:191], a[120:123], v[120:123], v[188:191]
s_sub_u32 s13, s13, 1
v_exp_f32 v14, v38
v_mfma_f32_16x16x32_bf16 v[192:195], a[64:67], v[112:115], v[192:195]
s_cmp_eq_u32 s13, 0
ds_read_b128 a[96:99], v2 offset:57344
v_add_f32 v27, v27, v14
v_mfma_f32_16x16x32_bf16 v[192:195], a[68:71], v[116:119], v[192:195]
s_cselect_b32 s12, s14, s12
v_exp_f32 v15, v39
v_mfma_f32_16x16x32_bf16 v[196:199], a[68:71], v[124:127], v[196:199]
s_cselect_b32 s13, s15, s13
ds_read_b128 a[100:103], v2 offset:58368
v_add_f32 v27, v27, v15
v_mfma_f32_16x16x32_bf16 v[196:199], a[64:67], v[120:123], v[196:199]
s_waitcnt lgkmcnt(7)
s_cselect_b32 s14, 3221225472, s14
v_cvt_pk_bf16_f32 v105, v14, v15
v_mfma_f32_16x16x32_bf16 v[200:203], a[72:75], v[112:115], v[200:203]
s_waitcnt lgkmcnt(6)
ds_read_b128 a[104:107], v2 offset:59392
v_mfma_f32_16x16x32_bf16 v[200:203], a[76:79], v[116:119], v[200:203]
buffer_load_dword v3, off, s[4:7], s80 sc1
v_mfma_f32_16x16x32_bf16 v[204:207], a[76:79], v[124:127], v[204:207]
ds_read_b128 a[108:111], v2 offset:60416
v_mfma_f32_16x16x32_bf16 v[204:207], a[72:75], v[120:123], v[204:207]
s_waitcnt lgkmcnt(7)
v_exp_f32 v8, v40
v_mfma_f32_16x16x32_bf16 v[208:211], a[80:83], v[112:115], v[208:211]
s_waitcnt lgkmcnt(6)
ds_read_b128 a[112:115], v2 offset:61440
v_add_f32 v26, v26, v8
v_mfma_f32_16x16x32_bf16 v[208:211], a[84:87], v[116:119], v[208:211]
v_exp_f32 v9, v41
v_mfma_f32_16x16x32_bf16 v[212:215], a[84:87], v[124:127], v[212:215]
ds_read_b128 a[116:119], v2 offset:62464
v_add_f32 v26, v26, v9
v_mfma_f32_16x16x32_bf16 v[212:215], a[80:83], v[120:123], v[212:215]
s_waitcnt lgkmcnt(7)
v_exp_f32 v10, v42
v_mfma_f32_16x16x32_bf16 v[216:219], a[88:91], v[112:115], v[216:219]
s_waitcnt lgkmcnt(6)
ds_read_b128 a[120:123], v2 offset:63488
v_cvt_pk_bf16_f32 v98, v8, v9
v_mfma_f32_16x16x32_bf16 v[216:219], a[92:95], v[116:119], v[216:219]
v_exp_f32 v11, v43
v_mfma_f32_16x16x32_bf16 v[220:223], a[92:95], v[124:127], v[220:223]
ds_read_b128 a[124:127], v2 offset:64512
v_add_f32 v26, v26, v10
v_mfma_f32_16x16x32_bf16 v[220:223], a[88:91], v[120:123], v[220:223]
s_waitcnt vmcnt(9) lgkmcnt(7)
s_barrier
v_add_f32 v26, v26, v11
v_mfma_f32_16x16x32_bf16 v[224:227], a[96:99], v[112:115], v[224:227]
s_waitcnt lgkmcnt(6)
ds_read_b128 a[64:67], v1 offset:32768
v_cvt_pk_bf16_f32 v99, v10, v11
v_mfma_f32_16x16x32_bf16 v[224:227], a[100:103], v[116:119], v[224:227]
v_mfma_f32_16x16x32_bf16 v[228:231], a[100:103], v[124:127], v[228:231]
ds_read_b128 a[68:71], v1 offset:33792
v_mfma_f32_16x16x32_bf16 v[228:231], a[96:99], v[120:123], v[228:231]
s_waitcnt lgkmcnt(7)
v_exp_f32 v12, v44
v_mfma_f32_16x16x32_bf16 v[232:235], a[104:107], v[112:115], v[232:235]
s_waitcnt lgkmcnt(6)
ds_read_b128 a[72:75], v1 offset:34816
v_add_f32 v27, v27, v12
v_mfma_f32_16x16x32_bf16 v[232:235], a[108:111], v[116:119], v[232:235]
v_exp_f32 v13, v45
v_mfma_f32_16x16x32_bf16 v[236:239], a[108:111], v[124:127], v[236:239]
ds_read_b128 a[76:79], v1 offset:35840
v_add_f32 v27, v27, v13
v_mfma_f32_16x16x32_bf16 v[236:239], a[104:107], v[120:123], v[236:239]
s_waitcnt lgkmcnt(7)
v_exp_f32 v14, v46
v_mfma_f32_16x16x32_bf16 v[240:243], a[112:115], v[112:115], v[240:243]
s_waitcnt lgkmcnt(6)
ds_read_b128 a[80:83], v1 offset:36864
v_cvt_pk_bf16_f32 v106, v12, v13
v_mfma_f32_16x16x32_bf16 v[240:243], a[116:119], v[116:119], v[240:243]
v_exp_f32 v15, v47
v_mfma_f32_16x16x32_bf16 v[244:247], a[116:119], v[124:127], v[244:247]
ds_read_b128 a[84:87], v1 offset:37888
v_add_f32 v27, v27, v14
v_mfma_f32_16x16x32_bf16 v[244:247], a[112:115], v[120:123], v[244:247]
s_waitcnt lgkmcnt(7)
v_add_f32 v27, v27, v15
v_cvt_pk_bf16_f32 v107, v14, v15
v_mfma_f32_16x16x32_bf16 v[248:251], a[120:123], v[112:115], v[248:251]
s_waitcnt lgkmcnt(6)
ds_read_b128 a[88:91], v1 offset:38912
v_mfma_f32_16x16x32_bf16 v[248:251], a[124:127], v[116:119], v[248:251]
v_mfma_f32_16x16x32_bf16 v[252:255], a[124:127], v[124:127], v[252:255]
ds_read_b128 a[92:95], v1 offset:39936
v_mfma_f32_16x16x32_bf16 v[252:255], a[120:123], v[120:123], v[252:255]
s_waitcnt lgkmcnt(6)
K2_dx1:
v_cndmask_b32 v68, v20, v7, s[32:33]
v_cndmask_b32 v69, v20, v7, s[34:35]
v_cndmask_b32 v70, v20, v7, s[36:37]
v_cndmask_b32 v71, v20, v7, s[38:39]
s_nop 1
v_mfma_f32_16x16x32_bf16 v[68:71], a[64:67], a[32:35], v[68:71]
s_add_u32 m0, s18, 0
ds_read_b128 a[96:99], v1 offset:40960
v_cndmask_b32 v76, v20, v7, s[40:41]
v_cndmask_b32 v79, v20, v7, s[46:47]
v_mfma_f32_16x16x32_bf16 v[68:71], a[68:71], a[36:39], v[68:71]
s_waitcnt lgkmcnt(6)
ds_read_b128 a[100:103], v1 offset:41984
buffer_load_dwordx4 v1, s[4:7], s12 offen offset:0 sc1 lds
v_mfma_f32_16x16x32_bf16 v[68:71], a[72:75], a[40:43], v[68:71]
s_waitcnt lgkmcnt(6)
ds_read_b128 a[104:107], v1 offset:43008
v_cndmask_b32 v77, v20, v7, s[42:43]
v_mfma_f32_16x16x32_bf16 v[68:71], a[76:79], a[44:47], v[68:71]
s_waitcnt lgkmcnt(6)
ds_read_b128 a[108:111], v1 offset:44032
buffer_load_dwordx4 v1, s[4:7], s12 offen offset:1024 sc1 lds
v_mfma_f32_16x16x32_bf16 v[68:71], a[80:83], a[48:51], v[68:71]
s_waitcnt lgkmcnt(6)
ds_read_b128 a[112:115], v1 offset:45056
v_cndmask_b32 v78, v20, v7, s[44:45]
v_mfma_f32_16x16x32_bf16 v[68:71], a[84:87], a[52:55], v[68:71]
s_waitcnt lgkmcnt(6)
ds_read_b128 a[116:119], v1 offset:46080
buffer_load_dwordx4 v1, s[4:7], s12 offen offset:2048 sc1 lds
v_mfma_f32_16x16x32_bf16 v[68:71], a[88:91], a[56:59], v[68:71]
s_waitcnt lgkmcnt(6)
ds_read_b128 a[120:123], v1 offset:47104
v_exp_f32 v8, v48
v_exp_f32 v9, v49
v_exp_f32 v10, v50
v_mfma_f32_16x16x32_bf16 v[68:71], a[92:95], a[60:63], v[68:71]
s_waitcnt lgkmcnt(5)
ds_read_b128 a[124:127], v1 offset:48128
buffer_load_dwordx4 v1, s[4:7], s12 offen offset:3072 sc1 lds
v_add_f32 v26, v26, v8
v_add_f32 v26, v26, v9
v_cvt_pk_bf16_f32 v100, v8, v9
v_add_f32 v26, v26, v10
v_mfma_f32_16x16x32_bf16 v[76:79], a[96:99], a[32:35], v[76:79]
s_add_u32 s12, s12, 4096
s_add_u32 m0, s18, 4096
ds_read_b128 a[64:67], v1 offset:49152
v_cndmask_b32 v86, v20, v7, s[52:53]
v_cndmask_b32 v87, v20, v7, s[54:55]
v_mfma_f32_16x16x32_bf16 v[76:79], a[100:103], a[36:39], v[76:79]
s_waitcnt lgkmcnt(6)
ds_read_b128 a[68:71], v1 offset:50176
buffer_load_dwordx4 v1, s[4:7], s12 offen offset:0 sc1 lds
v_mfma_f32_16x16x32_bf16 v[76:79], a[104:107], a[40:43], v[76:79]
s_waitcnt lgkmcnt(6)
ds_read_b128 a[72:75], v1 offset:51200
v_cndmask_b32 v84, v20, v7, s[48:49]
v_mfma_f32_16x16x32_bf16 v[76:79], a[108:111], a[44:47], v[76:79]
s_waitcnt lgkmcnt(6)
ds_read_b128 a[76:79], v1 offset:52224
buffer_load_dwordx4 v1, s[4:7], s12 offen offset:1024 sc1 lds
v_mfma_f32_16x16x32_bf16 v[76:79], a[112:115], a[48:51], v[76:79]
s_waitcnt lgkmcnt(6)
ds_read_b128 a[80:83], v1 offset:53248
v_cndmask_b32 v85, v20, v7, s[50:51]
v_mfma_f32_16x16x32_bf16 v[76:79], a[116:119], a[52:55], v[76:79]
s_waitcnt lgkmcnt(6)
ds_read_b128 a[84:87], v1 offset:54272
buffer_load_dwordx4 v1, s[4:7], s12 offen offset:2048 sc1 lds
v_mfma_f32_16x16x32_bf16 v[76:79], a[120:123], a[56:59], v[76:79]
s_waitcnt lgkmcnt(6)
ds_read_b128 a[88:91], v1 offset:55296
v_exp_f32 v11, v51
v_exp_f32 v12, v52
v_mfma_f32_16x16x32_bf16 v[76:79], a[124:127], a[60:63], v[76:79]
s_waitcnt lgkmcnt(1)
ds_read_b128 a[92:95], v1 offset:56320
buffer_load_dwordx4 v1, s[4:7], s12 offen offset:3072 sc1 lds
v_add_f32 v26, v26, v11
v_cvt_pk_bf16_f32 v101, v10, v11
v_add_f32 v27, v27, v12
v_mfma_f32_16x16x32_bf16 v[84:87], a[64:67], a[32:35], v[84:87]
s_add_u32 s12, s12, 28672
ds_read_b128 a[96:99], v1 offset:57344
v_cndmask_b32 v92, v20, v7, s[56:57]
v_mfma_f32_16x16x32_bf16 v[84:87], a[68:71], a[36:39], v[84:87]
s_sub_u32 s13, s13, 1
ds_read_b128 a[100:103], v1 offset:58368
v_cndmask_b32 v93, v20, v7, s[58:59]
v_mfma_f32_16x16x32_bf16 v[84:87], a[72:75], a[40:43], v[84:87]
s_cmp_eq_u32 s13, 0
ds_read_b128 a[104:107], v1 offset:59392
v_cndmask_b32 v94, v20, v7, s[60:61]
v_mfma_f32_16x16x32_bf16 v[84:87], a[76:79], a[44:47], v[84:87]
s_cselect_b32 s12, s14, s12
ds_read_b128 a[108:111], v1 offset:60416
v_cndmask_b32 v95, v20, v7, s[62:63]
v_mfma_f32_16x16x32_bf16 v[84:87], a[80:83], a[48:51], v[84:87]
s_cselect_b32 s13, s15, s13
ds_read_b128 a[112:115], v1 offset:61440
v_exp_f32 v13, v53
v_exp_f32 v14, v54
v_mfma_f32_16x16x32_bf16 v[84:87], a[84:87], a[52:55], v[84:87]
s_waitcnt lgkmcnt(6)
s_cselect_b32 s14, 3221225472, s14
ds_read_b128 a[116:119], v1 offset:62464
v_exp_f32 v15, v55
v_exp_f32 v8, v56
v_exp_f32 v9, v57
v_add_f32 v27, v27, v13
v_cvt_pk_bf16_f32 v108, v12, v13
v_add_f32 v27, v27, v14
v_mfma_f32_16x16x32_bf16 v[84:87], a[88:91], a[56:59], v[84:87]
s_waitcnt lgkmcnt(6)
ds_read_b128 a[120:123], v1 offset:63488
v_exp_f32 v10, v58
v_exp_f32 v11, v59
v_add_f32 v27, v27, v15
v_cvt_pk_bf16_f32 v109, v14, v15
v_mfma_f32_16x16x32_bf16 v[84:87], a[92:95], a[60:63], v[84:87]
s_waitcnt vmcnt(8) lgkmcnt(6)
s_barrier
ds_read_b128 a[124:127], v1 offset:64512
v_mfma_f32_16x16x32_bf16 v[92:95], a[96:99], a[32:35], v[92:95]
s_waitcnt lgkmcnt(6)
ds_read_b128 a[64:67], v2 offset:0
v_exp_f32 v12, v60
v_exp_f32 v13, v61
v_mfma_f32_16x16x32_bf16 v[92:95], a[100:103], a[36:39], v[92:95]
s_waitcnt lgkmcnt(6)
ds_read_b128 a[68:71], v2 offset:1024
v_exp_f32 v14, v62
v_exp_f32 v15, v63
v_mfma_f32_16x16x32_bf16 v[92:95], a[104:107], a[40:43], v[92:95]
s_waitcnt lgkmcnt(6)
ds_read_b128 a[72:75], v2 offset:2048
v_add_f32 v26, v26, v8
v_add_f32 v26, v26, v9
v_cvt_pk_bf16_f32 v102, v8, v9
v_mfma_f32_16x16x32_bf16 v[92:95], a[108:111], a[44:47], v[92:95]
s_waitcnt lgkmcnt(6)
ds_read_b128 a[76:79], v2 offset:3072
v_add_f32 v26, v26, v10
v_add_f32 v26, v26, v11
v_cvt_pk_bf16_f32 v103, v10, v11
v_mfma_f32_16x16x32_bf16 v[92:95], a[112:115], a[48:51], v[92:95]
s_waitcnt lgkmcnt(6)
ds_read_b128 a[80:83], v2 offset:4096
v_add_f32 v27, v27, v12
v_mfma_f32_16x16x32_bf16 v[92:95], a[116:119], a[52:55], v[92:95]
s_waitcnt lgkmcnt(6)
ds_read_b128 a[84:87], v2 offset:5120
v_add_f32 v27, v27, v13
v_cvt_pk_bf16_f32 v110, v12, v13
v_mfma_f32_16x16x32_bf16 v[92:95], a[120:123], a[56:59], v[92:95]
s_waitcnt lgkmcnt(6)
ds_read_b128 a[88:91], v2 offset:6144
v_add_f32 v27, v27, v14
v_add_f32 v27, v27, v15
v_cvt_pk_bf16_f32 v111, v14, v15
v_mfma_f32_16x16x32_bf16 v[92:95], a[124:127], a[60:63], v[92:95]
s_waitcnt lgkmcnt(6)
ds_read_b128 a[92:95], v2 offset:7168
v_add_f32 v28, v26, v27
v_cmp_nge_f32 vcc, s25, v28
s_cbranch_vccnz Lstub_9
Lback_10:
v_cmp_gt_u32 vcc, 1, v3
s_cbranch_vccnz K2_tspin
K2_tok:
v_mfma_f32_16x16x32_bf16 v[128:131], a[64:67], v[96:99], v[128:131]
s_waitcnt lgkmcnt(6)
ds_read_b128 a[96:99], v2 offset:8192
v_add_f32 v24, v24, v26
v_mfma_f32_16x16x32_bf16 v[128:131], a[68:71], v[100:103], v[128:131]
buffer_load_dwordx4 a[252:255], v1, s[4:7], s78 offen sc1
v_mfma_f32_16x16x32_bf16 v[132:135], a[68:71], v[108:111], v[132:135]
ds_read_b128 a[100:103], v2 offset:9216
v_add_f32 v25, v25, v27
v_mfma_f32_16x16x32_bf16 v[132:135], a[64:67], v[104:107], v[132:135]
s_waitcnt lgkmcnt(6)
v_exp_f32 v8, v68
v_mfma_f32_16x16x32_bf16 v[136:139], a[72:75], v[96:99], v[136:139]
s_add_u32 s22, s77, 0
ds_read_b128 a[104:107], v2 offset:10240
v_exp_f32 v9, v69
v_mfma_f32_16x16x32_bf16 v[136:139], a[76:79], v[100:103], v[136:139]
buffer_load_dwordx4 a[0:3], v1, s[4:7], s22 offen offset:0 sc1
v_mfma_f32_16x16x32_bf16 v[140:143], a[76:79], v[108:111], v[140:143]
ds_read_b128 a[108:111], v2 offset:11264
v_add_f32 v27, v8, v9
v_mfma_f32_16x16x32_bf16 v[140:143], a[72:75], v[104:107], v[140:143]
s_waitcnt lgkmcnt(7)
v_exp_f32 v10, v70
v_mfma_f32_16x16x32_bf16 v[144:147], a[80:83], v[96:99], v[144:147]
s_waitcnt lgkmcnt(6)
ds_read_b128 a[112:115], v2 offset:12288
v_cvt_pk_bf16_f32 v120, v8, v9
v_mfma_f32_16x16x32_bf16 v[144:147], a[84:87], v[100:103], v[144:147]
buffer_load_dwordx4 a[4:7], v1, s[4:7], s22 offen offset:1024 sc1
v_mfma_f32_16x16x32_bf16 v[148:151], a[84:87], v[108:111], v[148:151]
ds_read_b128 a[116:119], v2 offset:13312
v_add_f32 v27, v27, v10
v_mfma_f32_16x16x32_bf16 v[148:151], a[80:83], v[104:107], v[148:151]
s_waitcnt lgkmcnt(7)
v_exp_f32 v11, v71
v_mfma_f32_16x16x32_bf16 v[152:155], a[88:91], v[96:99], v[152:155]
s_waitcnt lgkmcnt(6)
ds_read_b128 a[120:123], v2 offset:14336
v_add_f32 v27, v27, v11
v_mfma_f32_16x16x32_bf16 v[152:155], a[92:95], v[100:103], v[152:155]
buffer_load_dwordx4 a[8:11], v1, s[4:7], s22 offen offset:2048 sc1
v_mfma_f32_16x16x32_bf16 v[156:159], a[92:95], v[108:111], v[156:159]
ds_read_b128 a[124:127], v2 offset:15360
v_cvt_pk_bf16_f32 v121, v10, v11
v_mfma_f32_16x16x32_bf16 v[156:159], a[88:91], v[104:107], v[156:159]
s_waitcnt lgkmcnt(7)
v_exp_f32 v12, v76
v_mfma_f32_16x16x32_bf16 v[160:163], a[96:99], v[96:99], v[160:163]
s_waitcnt lgkmcnt(6)
ds_read_b128 a[64:67], v2 offset:16384
v_add_f32 v27, v27, v12
v_mfma_f32_16x16x32_bf16 v[160:163], a[100:103], v[100:103], v[160:163]
buffer_load_dwordx4 a[12:15], v1, s[4:7], s22 offen offset:3072 sc1
v_mfma_f32_16x16x32_bf16 v[164:167], a[100:103], v[108:111], v[164:167]
ds_read_b128 a[68:71], v2 offset:17408
v_mfma_f32_16x16x32_bf16 v[164:167], a[96:99], v[104:107], v[164:167]
s_waitcnt lgkmcnt(6)
v_exp_f32 v13, v77
v_mfma_f32_16x16x32_bf16 v[168:171], a[104:107], v[96:99], v[168:171]
s_add_u32 s22, s77, 4096
ds_read_b128 a[72:75], v2 offset:18432
v_add_f32 v27, v27, v13
v_mfma_f32_16x16x32_bf16 v[168:171], a[108:111], v[100:103], v[168:171]
buffer_load_dwordx4 a[16:19], v1, s[4:7], s22 offen offset:0 sc1
v_mfma_f32_16x16x32_bf16 v[172:175], a[108:111], v[108:111], v[172:175]
ds_read_b128 a[76:79], v2 offset:19456
v_exp_f32 v14, v78
v_mfma_f32_16x16x32_bf16 v[172:175], a[104:107], v[104:107], v[172:175]
s_waitcnt lgkmcnt(7)
v_exp_f32 v15, v79
v_mfma_f32_16x16x32_bf16 v[176:179], a[112:115], v[96:99], v[176:179]
s_waitcnt lgkmcnt(6)
ds_read_b128 a[80:83], v2 offset:20480
v_cvt_pk_bf16_f32 v122, v12, v13
v_mfma_f32_16x16x32_bf16 v[176:179], a[116:119], v[100:103], v[176:179]
buffer_load_dwordx4 a[20:23], v1, s[4:7], s22 offen offset:1024 sc1
v_mfma_f32_16x16x32_bf16 v[180:183], a[116:119], v[108:111], v[180:183]
ds_read_b128 a[84:87], v2 offset:21504
v_add_f32 v27, v27, v14
v_mfma_f32_16x16x32_bf16 v[180:183], a[112:115], v[104:107], v[180:183]
s_waitcnt lgkmcnt(7)
v_exp_f32 v8, v84
v_mfma_f32_16x16x32_bf16 v[184:187], a[120:123], v[96:99], v[184:187]
s_waitcnt lgkmcnt(6)
ds_read_b128 a[88:91], v2 offset:22528
v_add_f32 v27, v27, v15
v_cvt_pk_bf16_f32 v123, v14, v15
v_mfma_f32_16x16x32_bf16 v[184:187], a[124:127], v[100:103], v[184:187]
buffer_load_dwordx4 a[24:27], v1, s[4:7], s22 offen offset:2048 sc1
v_mfma_f32_16x16x32_bf16 v[188:191], a[124:127], v[108:111], v[188:191]
ds_read_b128 a[92:95], v2 offset:23552
v_add_f32 v27, v27, v8
v_mfma_f32_16x16x32_bf16 v[188:191], a[120:123], v[104:107], v[188:191]
s_waitcnt lgkmcnt(7)
v_exp_f32 v9, v85
v_mfma_f32_16x16x32_bf16 v[192:195], a[64:67], v[96:99], v[192:195]
s_waitcnt lgkmcnt(6)
ds_read_b128 a[96:99], v2 offset:24576
v_add_f32 v27, v27, v9
v_mfma_f32_16x16x32_bf16 v[192:195], a[68:71], v[100:103], v[192:195]
buffer_load_dwordx4 a[28:31], v1, s[4:7], s22 offen offset:3072 sc1
v_mfma_f32_16x16x32_bf16 v[196:199], a[68:71], v[108:111], v[196:199]
ds_read_b128 a[100:103], v2 offset:25600
v_cvt_pk_bf16_f32 v124, v8, v9
v_mfma_f32_16x16x32_bf16 v[196:199], a[64:67], v[104:107], v[196:199]
s_waitcnt lgkmcnt(6)
v_exp_f32 v10, v86
v_mfma_f32_16x16x32_bf16 v[200:203], a[72:75], v[96:99], v[200:203]
s_add_u32 s22, s77, 8192
ds_read_b128 a[104:107], v2 offset:26624
v_add_f32 v27, v27, v10
v_mfma_f32_16x16x32_bf16 v[200:203], a[76:79], v[100:103], v[200:203]
buffer_load_dwordx4 a[32:35], v1, s[4:7], s22 offen offset:0 sc1
v_mfma_f32_16x16x32_bf16 v[204:207], a[76:79], v[108:111], v[204:207]
ds_read_b128 a[108:111], v2 offset:27648
v_mfma_f32_16x16x32_bf16 v[204:207], a[72:75], v[104:107], v[204:207]
s_waitcnt lgkmcnt(7)
v_exp_f32 v11, v87
v_mfma_f32_16x16x32_bf16 v[208:211], a[80:83], v[96:99], v[208:211]
s_waitcnt lgkmcnt(6)
ds_read_b128 a[112:115], v2 offset:28672
v_exp_f32 v12, v92
v_mfma_f32_16x16x32_bf16 v[208:211], a[84:87], v[100:103], v[208:211]
buffer_load_dwordx4 a[36:39], v1, s[4:7], s22 offen offset:1024 sc1
v_mfma_f32_16x16x32_bf16 v[212:215], a[84:87], v[108:111], v[212:215]
ds_read_b128 a[116:119], v2 offset:29696
v_add_f32 v27, v27, v11
v_mfma_f32_16x16x32_bf16 v[212:215], a[80:83], v[104:107], v[212:215]
s_waitcnt lgkmcnt(7)
v_exp_f32 v13, v93
v_mfma_f32_16x16x32_bf16 v[216:219], a[88:91], v[96:99], v[216:219]
s_waitcnt lgkmcnt(6)
ds_read_b128 a[120:123], v2 offset:30720
v_cvt_pk_bf16_f32 v125, v10, v11
v_add_f32 v27, v27, v12
v_mfma_f32_16x16x32_bf16 v[216:219], a[92:95], v[100:103], v[216:219]
buffer_load_dwordx4 a[40:43], v1, s[4:7], s22 offen offset:2048 sc1
v_mfma_f32_16x16x32_bf16 v[220:223], a[92:95], v[108:111], v[220:223]
ds_read_b128 a[124:127], v2 offset:31744
v_add_f32 v27, v27, v13
v_mfma_f32_16x16x32_bf16 v[220:223], a[88:91], v[104:107], v[220:223]
s_waitcnt vmcnt(12) lgkmcnt(7)
s_barrier
v_cvt_pk_bf16_f32 v126, v12, v13
v_mfma_f32_16x16x32_bf16 v[224:227], a[96:99], v[96:99], v[224:227]
s_waitcnt lgkmcnt(6)
ds_read_b128 a[64:67], v1 offset:0
v_mfma_f32_16x16x32_bf16 v[224:227], a[100:103], v[100:103], v[224:227]
buffer_load_dwordx4 a[44:47], v1, s[4:7], s22 offen offset:3072 sc1
v_mfma_f32_16x16x32_bf16 v[228:231], a[100:103], v[108:111], v[228:231]
ds_read_b128 a[68:71], v1 offset:1024
v_mfma_f32_16x16x32_bf16 v[228:231], a[96:99], v[104:107], v[228:231]
s_waitcnt lgkmcnt(6)
v_exp_f32 v14, v94
v_mfma_f32_16x16x32_bf16 v[232:235], a[104:107], v[96:99], v[232:235]
s_add_u32 s22, s77, 12288
ds_read_b128 a[72:75], v1 offset:2048
v_add_f32 v27, v27, v14
v_mfma_f32_16x16x32_bf16 v[232:235], a[108:111], v[100:103], v[232:235]
buffer_load_dwordx4 a[48:51], v1, s[4:7], s22 offen offset:0 sc1
v_mfma_f32_16x16x32_bf16 v[236:239], a[108:111], v[108:111], v[236:239]
ds_read_b128 a[76:79], v1 offset:3072
v_mfma_f32_16x16x32_bf16 v[236:239], a[104:107], v[104:107], v[236:239]
s_waitcnt lgkmcnt(7)
v_exp_f32 v15, v95
v_mfma_f32_16x16x32_bf16 v[240:243], a[112:115], v[96:99], v[240:243]
s_waitcnt lgkmcnt(6)
ds_read_b128 a[80:83], v1 offset:4096
v_add_f32 v27, v27, v15
v_mfma_f32_16x16x32_bf16 v[240:243], a[116:119], v[100:103], v[240:243]
buffer_load_dwordx4 a[52:55], v1, s[4:7], s22 offen offset:1024 sc1
v_mfma_f32_16x16x32_bf16 v[244:247], a[116:119], v[108:111], v[244:247]
ds_read_b128 a[84:87], v1 offset:5120
v_cvt_pk_bf16_f32 v127, v14, v15
v_mfma_f32_16x16x32_bf16 v[244:247], a[112:115], v[104:107], v[244:247]
s_waitcnt lgkmcnt(7)
v_cmp_nge_f32 vcc, s25, v27
v_mfma_f32_16x16x32_bf16 v[248:251], a[120:123], v[96:99], v[248:251]
s_waitcnt lgkmcnt(6)
ds_read_b128 a[88:91], v1 offset:6144
v_mfma_f32_16x16x32_bf16 v[248:251], a[124:127], v[100:103], v[248:251]
buffer_load_dwordx4 a[56:59], v1, s[4:7], s22 offen offset:2048 sc1
v_mfma_f32_16x16x32_bf16 v[252:255], a[124:127], v[108:111], v[252:255]
ds_read_b128 a[92:95], v1 offset:7168
v_mfma_f32_16x16x32_bf16 v[252:255], a[120:123], v[104:107], v[252:255]
s_waitcnt lgkmcnt(4)
buffer_load_dwordx4 a[60:63], v1, s[4:7], s22 offen offset:3072 sc1
s_cbranch_vccnz Lstub_11
Lback_12:
v_mfma_f32_16x16x32_bf16 v[132:135], a[64:67], v[120:123], v[132:135]
s_mov_b64 s[36:37], s[86:87]
ds_read_b128 a[96:99], v1 offset:8192
v_add_f32 v25, v25, v27
v_mfma_f32_16x16x32_bf16 v[132:135], a[68:71], v[124:127], v[132:135]
s_mov_b32 s38, 3670016
ds_read_b128 a[100:103], v1 offset:9216
v_lshrrev_b32 v28, 7, v1
v_mfma_f32_16x16x32_bf16 v[140:143], a[72:75], v[120:123], v[140:143]
s_mov_b32 s39, 0x20000
ds_read_b128 a[104:107], v1 offset:10240
v_and_b32 v29, 6, v28
v_mfma_f32_16x16x32_bf16 v[140:143], a[76:79], v[124:127], v[140:143]
s_waitcnt lgkmcnt(6)
ds_read_b128 a[108:111], v1 offset:11264
v_lshlrev_b32 v29, 4, v29
v_mfma_f32_16x16x32_bf16 v[148:151], a[80:83], v[120:123], v[148:151]
s_waitcnt lgkmcnt(6)
ds_read_b128 a[112:115], v1 offset:12288
v_and_b32 v30, 0x70, v1
v_mfma_f32_16x16x32_bf16 v[148:151], a[84:87], v[124:127], v[148:151]
s_waitcnt lgkmcnt(6)
ds_read_b128 a[116:119], v1 offset:13312
v_xor_b32 v29, v29, v30
v_mfma_f32_16x16x32_bf16 v[156:159], a[88:91], v[120:123], v[156:159]
s_waitcnt lgkmcnt(6)
ds_read_b128 a[120:123], v1 offset:14336
v_mul_u32_u24 v28, 896, v28
v_mfma_f32_16x16x32_bf16 v[156:159], a[92:95], v[124:127], v[156:159]
s_waitcnt lgkmcnt(6)
ds_read_b128 a[124:127], v1 offset:15360
v_add_u32 v8, v28, v29
v_mfma_f32_16x16x32_bf16 v[164:167], a[96:99], v[120:123], v[164:167]
s_waitcnt lgkmcnt(6)
ds_read_b128 a[64:67], v1 offset:16384
v_add_u32 v9, 6144, v8
v_mfma_f32_16x16x32_bf16 v[164:167], a[100:103], v[124:127], v[164:167]
s_waitcnt lgkmcnt(6)
ds_read_b128 a[68:71], v1 offset:17408
v_add_u32 v10, 12288, v8
v_mfma_f32_16x16x32_bf16 v[172:175], a[104:107], v[120:123], v[172:175]
s_waitcnt lgkmcnt(6)
ds_read_b128 a[72:75], v1 offset:18432
v_add_u32 v11, 18432, v8
v_mfma_f32_16x16x32_bf16 v[172:175], a[108:111], v[124:127], v[172:175]
s_waitcnt lgkmcnt(6)
ds_read_b128 a[76:79], v1 offset:19456
v_lshrrev_b32 v28, 6, v1
v_mfma_f32_16x16x32_bf16 v[180:183], a[112:115], v[120:123], v[180:183]
s_waitcnt lgkmcnt(6)
ds_read_b128 a[80:83], v1 offset:20480
v_bfe_u32 v29, v1, 7, 2
v_mfma_f32_16x16x32_bf16 v[180:183], a[116:119], v[124:127], v[180:183]
s_waitcnt lgkmcnt(6)
ds_read_b128 a[84:87], v1 offset:21504
v_lshlrev_b32 v29, 5, v29
v_mfma_f32_16x16x32_bf16 v[188:191], a[120:123], v[120:123], v[188:191]
s_waitcnt lgkmcnt(6)
ds_read_b128 a[88:91], v1 offset:22528
v_lshl_add_u32 v28, v28, 7, v29
v_mfma_f32_16x16x32_bf16 v[188:191], a[124:127], v[124:127], v[188:191]
s_waitcnt lgkmcnt(6)
ds_read_b128 a[92:95], v1 offset:23552
v_bfe_u32 v29, v1, 4, 2
v_mfma_f32_16x16x32_bf16 v[196:199], a[64:67], v[120:123], v[196:199]
s_waitcnt lgkmcnt(6)
ds_read_b128 a[96:99], v1 offset:24576
v_lshl_add_u32 v28, v29, 3, v28
v_mfma_f32_16x16x32_bf16 v[196:199], a[68:71], v[124:127], v[196:199]
s_waitcnt lgkmcnt(6)
ds_read_b128 a[100:103], v1 offset:25600
v_add_u32 v12, 131072, v28
v_mfma_f32_16x16x32_bf16 v[204:207], a[72:75], v[120:123], v[204:207]
s_waitcnt lgkmcnt(6)
ds_read_b128 a[104:107], v1 offset:26624
v_xor_b32 v13, 32, v12
v_mfma_f32_16x16x32_bf16 v[204:207], a[76:79], v[124:127], v[204:207]
s_waitcnt lgkmcnt(6)
ds_read_b128 a[108:111], v1 offset:27648
v_xor_b32 v14, 64, v12
v_mfma_f32_16x16x32_bf16 v[212:215], a[80:83], v[120:123], v[212:215]
s_waitcnt lgkmcnt(6)
ds_read_b128 a[112:115], v1 offset:28672
v_xor_b32 v15, 96, v12
v_mfma_f32_16x16x32_bf16 v[212:215], a[84:87], v[124:127], v[212:215]
s_waitcnt lgkmcnt(6)
ds_read_b128 a[116:119], v1 offset:29696
v_mfma_f32_16x16x32_bf16 v[220:223], a[88:91], v[120:123], v[220:223]
s_waitcnt lgkmcnt(6)
s_add_u32 m0, s18, 131072
ds_read_b128 a[120:123], v1 offset:30720
v_mfma_f32_16x16x32_bf16 v[220:223], a[92:95], v[124:127], v[220:223]
s_waitcnt lgkmcnt(6)
ds_read_b128 a[124:127], v1 offset:31744
v_mfma_f32_16x16x32_bf16 v[228:231], a[96:99], v[120:123], v[228:231]
s_waitcnt lgkmcnt(6)
buffer_load_dwordx4 v8, s[36:39], s81 offen offset:0 lds
v_mfma_f32_16x16x32_bf16 v[228:231], a[100:103], v[124:127], v[228:231]
s_waitcnt lgkmcnt(5)
buffer_load_dwordx4 v9, s[36:39], s81 offen offset:1024 lds
v_mfma_f32_16x16x32_bf16 v[236:239], a[104:107], v[120:123], v[236:239]
s_waitcnt lgkmcnt(4)
buffer_load_dwordx4 v10, s[36:39], s81 offen offset:2048 lds
v_mfma_f32_16x16x32_bf16 v[236:239], a[108:111], v[124:127], v[236:239]
s_waitcnt lgkmcnt(3)
buffer_load_dwordx4 v11, s[36:39], s81 offen offset:3072 lds
v_mfma_f32_16x16x32_bf16 v[244:247], a[112:115], v[120:123], v[244:247]
s_waitcnt lgkmcnt(2)
s_add_u32 s81, s81, 28672
v_mfma_f32_16x16x32_bf16 v[244:247], a[116:119], v[124:127], v[244:247]
s_waitcnt lgkmcnt(1)
s_add_u32 m0, s18, 135168
v_mfma_f32_16x16x32_bf16 v[252:255], a[120:123], v[120:123], v[252:255]
s_waitcnt lgkmcnt(0)
buffer_load_dwordx4 v8, s[36:39], s81 offen offset:0 lds
v_mfma_f32_16x16x32_bf16 v[252:255], a[124:127], v[124:127], v[252:255]
buffer_load_dwordx4 v9, s[36:39], s81 offen offset:1024 lds
buffer_load_dwordx4 v10, s[36:39], s81 offen offset:2048 lds
buffer_load_dwordx4 v11, s[36:39], s81 offen offset:3072 lds
s_sub_u32 s81, s81, 28544
v_mov_b32 v28, v24
s_nop 1
v_permlane16_swap_b32 v24, v28
v_add_f32 v24, v24, v28
v_mov_b32 v28, v24
s_nop 1
v_permlane32_swap_b32 v24, v28
v_add_f32 v24, v24, v28
v_mov_b32 v29, v25
s_nop 1
v_permlane16_swap_b32 v25, v29
v_add_f32 v25, v25, v29
v_mov_b32 v29, v25
s_nop 1
v_permlane32_swap_b32 v25, v29
v_add_f32 v25, v25, v29
s_lshl_b32 s8, s29, 3
s_add_u32 s8, s8, s3
s_lshl_b32 s8, s8, 4
s_add_u32 s8, s8, s20
s_mul_i32 s8, s8, 14336
s_add_u32 s8, s8, 104857600
s_add_u32 s12, s8, 917504
s_cmp_lg_u32 s24, 1
s_cbranch_scc1 K2_plain
s_waitcnt vmcnt(8)
v_accvgpr_read_b32 v32, a252
v_accvgpr_read_b32 v33, a253
v_accvgpr_read_b32 v34, a254
v_accvgpr_read_b32 v35, a255
v_min_f32 v36, v16, v32
v_sub_f32 v37, v36, v16
v_sub_f32 v38, v36, v32
v_exp_f32 v37, v37
v_exp_f32 v38, v38
s_nop 0
v_mul_f32 v38, v38, v33
v_fma_f32 v36, v24, v37, v38
v_rcp_f32 v36, v36
s_nop 0
v_mul_f32 v24, v37, v36
v_mul_f32 v26, v38, v36
v_min_f32 v36, v20, v34
v_sub_f32 v37, v36, v20
v_sub_f32 v38, v36, v34
v_exp_f32 v37, v37
v_exp_f32 v38, v38
s_nop 0
v_mul_f32 v38, v38, v35
v_fma_f32 v36, v25, v37, v38
v_rcp_f32 v36, v36
s_nop 0
v_mul_f32 v25, v37, v36
v_mul_f32 v27, v38, v36
v_mov_b32 v28, v24
v_mov_b32 v29, v24
v_mov_b32 v30, v26
v_mov_b32 v31, v26
v_accvgpr_read_b32 v41, a0
v_accvgpr_read_b32 v43, a1
v_accvgpr_read_b32 v45, a2
v_accvgpr_read_b32 v47, a3
v_pk_mul_f32 v[128:129], v[128:129], v[28:29]
v_pk_mul_f32 v[130:131], v[130:131], v[28:29]
v_pk_mul_f32 v[136:137], v[136:137], v[28:29]
v_pk_mul_f32 v[138:139], v[138:139], v[28:29]
v_lshlrev_b32 v40, 16, v41
v_and_b32 v41, 0xffff0000, v41
v_lshlrev_b32 v42, 16, v43
v_and_b32 v43, 0xffff0000, v43
v_lshlrev_b32 v44, 16, v45
v_and_b32 v45, 0xffff0000, v45
v_lshlrev_b32 v46, 16, v47
v_and_b32 v47, 0xffff0000, v47
v_pk_fma_f32 v[128:129], v[40:41], v[30:31], v[128:129]
v_pk_fma_f32 v[130:131], v[42:43], v[30:31], v[130:131]
v_pk_fma_f32 v[136:137], v[44:45], v[30:31], v[136:137]
v_pk_fma_f32 v[138:139], v[46:47], v[30:31], v[138:139]
v_cvt_pk_bf16_f32 v128, v128, v129
v_cvt_pk_bf16_f32 v129, v130, v131
v_cvt_pk_bf16_f32 v130, v136, v137
v_cvt_pk_bf16_f32 v131, v138, v139
s_add_u32 m0, s18, 98304
s_nop 0
buffer_load_dwordx4 v8, s[36:39], s81 offen offset:0 lds
v_accvgpr_read_b32 v41, a4
v_accvgpr_read_b32 v43, a5
v_accvgpr_read_b32 v45, a6
v_accvgpr_read_b32 v47, a7
v_pk_mul_f32 v[144:145], v[144:145], v[28:29]
v_pk_mul_f32 v[146:147], v[146:147], v[28:29]
v_pk_mul_f32 v[152:153], v[152:153], v[28:29]
v_pk_mul_f32 v[154:155], v[154:155], v[28:29]
v_lshlrev_b32 v40, 16, v41
v_and_b32 v41, 0xffff0000, v41
v_lshlrev_b32 v42, 16, v43
v_and_b32 v43, 0xffff0000, v43
v_lshlrev_b32 v44, 16, v45
v_and_b32 v45, 0xffff0000, v45
v_lshlrev_b32 v46, 16, v47
v_and_b32 v47, 0xffff0000, v47
v_pk_fma_f32 v[144:145], v[40:41], v[30:31], v[144:145]
v_pk_fma_f32 v[146:147], v[42:43], v[30:31], v[146:147]
v_pk_fma_f32 v[152:153], v[44:45], v[30:31], v[152:153]
v_pk_fma_f32 v[154:155], v[46:47], v[30:31], v[154:155]
v_cvt_pk_bf16_f32 v144, v144, v145
v_cvt_pk_bf16_f32 v145, v146, v147
v_cvt_pk_bf16_f32 v146, v152, v153
v_cvt_pk_bf16_f32 v147, v154, v155
buffer_load_dwordx4 v9, s[36:39], s81 offen offset:1024 lds
v_accvgpr_read_b32 v41, a8
v_accvgpr_read_b32 v43, a9
v_accvgpr_read_b32 v45, a10
v_accvgpr_read_b32 v47, a11
v_pk_mul_f32 v[160:161], v[160:161], v[28:29]
v_pk_mul_f32 v[162:163], v[162:163], v[28:29]
v_pk_mul_f32 v[168:169], v[168:169], v[28:29]
v_pk_mul_f32 v[170:171], v[170:171], v[28:29]
v_lshlrev_b32 v40, 16, v41
v_and_b32 v41, 0xffff0000, v41
v_lshlrev_b32 v42, 16, v43
v_and_b32 v43, 0xffff0000, v43
v_lshlrev_b32 v44, 16, v45
v_and_b32 v45, 0xffff0000, v45
v_lshlrev_b32 v46, 16, v47
v_and_b32 v47, 0xffff0000, v47
v_pk_fma_f32 v[160:161], v[40:41], v[30:31], v[160:161]
v_pk_fma_f32 v[162:163], v[42:43], v[30:31], v[162:163]
v_pk_fma_f32 v[168:169], v[44:45], v[30:31], v[168:169]
v_pk_fma_f32 v[170:171], v[46:47], v[30:31], v[170:171]
v_cvt_pk_bf16_f32 v160, v160, v161
v_cvt_pk_bf16_f32 v161, v162, v163
v_cvt_pk_bf16_f32 v162, v168, v169
v_cvt_pk_bf16_f32 v163, v170, v171
buffer_load_dwordx4 v10, s[36:39], s81 offen offset:2048 lds
v_accvgpr_read_b32 v41, a12
v_accvgpr_read_b32 v43, a13
v_accvgpr_read_b32 v45, a14
v_accvgpr_read_b32 v47, a15
v_pk_mul_f32 v[176:177], v[176:177], v[28:29]
v_pk_mul_f32 v[178:179], v[178:179], v[28:29]
v_pk_mul_f32 v[184:185], v[184:185], v[28:29]
v_pk_mul_f32 v[186:187], v[186:187], v[28:29]
v_lshlrev_b32 v40, 16, v41
v_and_b32 v41, 0xffff0000, v41
v_lshlrev_b32 v42, 16, v43
v_and_b32 v43, 0xffff0000, v43
v_lshlrev_b32 v44, 16, v45
v_and_b32 v45, 0xffff0000, v45
v_lshlrev_b32 v46, 16, v47
v_and_b32 v47, 0xffff0000, v47
v_pk_fma_f32 v[176:177], v[40:41], v[30:31], v[176:177]
v_pk_fma_f32 v[178:179], v[42:43], v[30:31], v[178:179]
v_pk_fma_f32 v[184:185], v[44:45], v[30:31], v[184:185]
v_pk_fma_f32 v[186:187], v[46:47], v[30:31], v[186:187]
v_cvt_pk_bf16_f32 v176, v176, v177
v_cvt_pk_bf16_f32 v177, v178, v179
v_cvt_pk_bf16_f32 v178, v184, v185
v_cvt_pk_bf16_f32 v179, v186, v187
buffer_load_dwordx4 v11, s[36:39], s81 offen offset:3072 lds
v_accvgpr_read_b32 v41, a16
v_accvgpr_read_b32 v43, a17
v_accvgpr_read_b32 v45, a18
v_accvgpr_read_b32 v47, a19
v_pk_mul_f32 v[192:193], v[192:193], v[28:29]
v_pk_mul_f32 v[194:195], v[194:195], v[28:29]
v_pk_mul_f32 v[200:201], v[200:201], v[28:29]
v_pk_mul_f32 v[202:203], v[202:203], v[28:29]
v_lshlrev_b32 v40, 16, v41
v_and_b32 v41, 0xffff0000, v41
v_lshlrev_b32 v42, 16, v43
v_and_b32 v43, 0xffff0000, v43
v_lshlrev_b32 v44, 16, v45
v_and_b32 v45, 0xffff0000, v45
v_lshlrev_b32 v46, 16, v47
v_and_b32 v47, 0xffff0000, v47
v_pk_fma_f32 v[192:193], v[40:41], v[30:31], v[192:193]
v_pk_fma_f32 v[194:195], v[42:43], v[30:31], v[194:195]
v_pk_fma_f32 v[200:201], v[44:45], v[30:31], v[200:201]
v_pk_fma_f32 v[202:203], v[46:47], v[30:31], v[202:203]
v_cvt_pk_bf16_f32 v192, v192, v193
v_cvt_pk_bf16_f32 v193, v194, v195
v_cvt_pk_bf16_f32 v194, v200, v201
v_cvt_pk_bf16_f32 v195, v202, v203
s_add_u32 s81, s81, 28672
s_add_u32 m0, s18, 102400
s_nop 0
buffer_load_dwordx4 v8, s[36:39], s81 offen offset:0 lds
v_accvgpr_read_b32 v41, a20
v_accvgpr_read_b32 v43, a21
v_accvgpr_read_b32 v45, a22
v_accvgpr_read_b32 v47, a23
v_pk_mul_f32 v[208:209], v[208:209], v[28:29]
v_pk_mul_f32 v[210:211], v[210:211], v[28:29]
v_pk_mul_f32 v[216:217], v[216:217], v[28:29]
v_pk_mul_f32 v[218:219], v[218:219], v[28:29]
v_lshlrev_b32 v40, 16, v41
v_and_b32 v41, 0xffff0000, v41
v_lshlrev_b32 v42, 16, v43
v_and_b32 v43, 0xffff0000, v43
v_lshlrev_b32 v44, 16, v45
v_and_b32 v45, 0xffff0000, v45
v_lshlrev_b32 v46, 16, v47
v_and_b32 v47, 0xffff0000, v47
v_pk_fma_f32 v[208:209], v[40:41], v[30:31], v[208:209]
v_pk_fma_f32 v[210:211], v[42:43], v[30:31], v[210:211]
v_pk_fma_f32 v[216:217], v[44:45], v[30:31], v[216:217]
v_pk_fma_f32 v[218:219], v[46:47], v[30:31], v[218:219]
v_cvt_pk_bf16_f32 v208, v208, v209
v_cvt_pk_bf16_f32 v209, v210, v211
v_cvt_pk_bf16_f32 v210, v216, v217
v_cvt_pk_bf16_f32 v211, v218, v219
buffer_load_dwordx4 v9, s[36:39], s81 offen offset:1024 lds
v_accvgpr_read_b32 v41, a24
v_accvgpr_read_b32 v43, a25
v_accvgpr_read_b32 v45, a26
v_accvgpr_read_b32 v47, a27
v_pk_mul_f32 v[224:225], v[224:225], v[28:29]
v_pk_mul_f32 v[226:227], v[226:227], v[28:29]
v_pk_mul_f32 v[232:233], v[232:233], v[28:29]
v_pk_mul_f32 v[234:235], v[234:235], v[28:29]
v_lshlrev_b32 v40, 16, v41
v_and_b32 v41, 0xffff0000, v41
v_lshlrev_b32 v42, 16, v43
v_and_b32 v43, 0xffff0000, v43
v_lshlrev_b32 v44, 16, v45
v_and_b32 v45, 0xffff0000, v45
v_lshlrev_b32 v46, 16, v47
v_and_b32 v47, 0xffff0000, v47
v_pk_fma_f32 v[224:225], v[40:41], v[30:31], v[224:225]
v_pk_fma_f32 v[226:227], v[42:43], v[30:31], v[226:227]
v_pk_fma_f32 v[232:233], v[44:45], v[30:31], v[232:233]
v_pk_fma_f32 v[234:235], v[46:47], v[30:31], v[234:235]
v_cvt_pk_bf16_f32 v224, v224, v225
v_cvt_pk_bf16_f32 v225, v226, v227
v_cvt_pk_bf16_f32 v226, v232, v233
v_cvt_pk_bf16_f32 v227, v234, v235
buffer_load_dwordx4 v10, s[36:39], s81 offen offset:2048 lds
v_accvgpr_read_b32 v41, a28
v_accvgpr_read_b32 v43, a29
v_accvgpr_read_b32 v45, a30
v_accvgpr_read_b32 v47, a31
v_pk_mul_f32 v[240:241], v[240:241], v[28:29]
v_pk_mul_f32 v[242:243], v[242:243], v[28:29]
v_pk_mul_f32 v[248:249], v[248:249], v[28:29]
v_pk_mul_f32 v[250:251], v[250:251], v[28:29]
v_lshlrev_b32 v40, 16, v41
v_and_b32 v41, 0xffff0000, v41
v_lshlrev_b32 v42, 16, v43
v_and_b32 v43, 0xffff0000, v43
v_lshlrev_b32 v44, 16, v45
v_and_b32 v45, 0xffff0000, v45
v_lshlrev_b32 v46, 16, v47
v_and_b32 v47, 0xffff0000, v47
v_pk_fma_f32 v[240:241], v[40:41], v[30:31], v[240:241]
v_pk_fma_f32 v[242:243], v[42:43], v[30:31], v[242:243]
v_pk_fma_f32 v[248:249], v[44:45], v[30:31], v[248:249]
v_pk_fma_f32 v[250:251], v[46:47], v[30:31], v[250:251]
v_cvt_pk_bf16_f32 v240, v240, v241
v_cvt_pk_bf16_f32 v241, v242, v243
v_cvt_pk_bf16_f32 v242, v248, v249
v_cvt_pk_bf16_f32 v243, v250, v251
buffer_load_dwordx4 v11, s[36:39], s81 offen offset:3072 lds
v_mov_b32 v28, v25
v_mov_b32 v29, v25
v_mov_b32 v30, v27
v_mov_b32 v31, v27
v_accvgpr_read_b32 v41, a32
v_accvgpr_read_b32 v43, a33
v_accvgpr_read_b32 v45, a34
v_accvgpr_read_b32 v47, a35
v_pk_mul_f32 v[132:133], v[132:133], v[28:29]
v_pk_mul_f32 v[134:135], v[134:135], v[28:29]
v_pk_mul_f32 v[140:141], v[140:141], v[28:29]
v_pk_mul_f32 v[142:143], v[142:143], v[28:29]
v_lshlrev_b32 v40, 16, v41
v_and_b32 v41, 0xffff0000, v41
v_lshlrev_b32 v42, 16, v43
v_and_b32 v43, 0xffff0000, v43
v_lshlrev_b32 v44, 16, v45
v_and_b32 v45, 0xffff0000, v45
v_lshlrev_b32 v46, 16, v47
v_and_b32 v47, 0xffff0000, v47
v_pk_fma_f32 v[132:133], v[40:41], v[30:31], v[132:133]
v_pk_fma_f32 v[134:135], v[42:43], v[30:31], v[134:135]
v_pk_fma_f32 v[140:141], v[44:45], v[30:31], v[140:141]
v_pk_fma_f32 v[142:143], v[46:47], v[30:31], v[142:143]
v_cvt_pk_bf16_f32 v132, v132, v133
v_cvt_pk_bf16_f32 v133, v134, v135
v_cvt_pk_bf16_f32 v134, v140, v141
v_cvt_pk_bf16_f32 v135, v142, v143
s_sub_u32 s81, s81, 28544
s_add_u32 m0, s18, 32768
s_nop 0
buffer_load_dwordx4 v8, s[36:39], s81 offen offset:0 lds
v_accvgpr_read_b32 v41, a36
v_accvgpr_read_b32 v43, a37
v_accvgpr_read_b32 v45, a38
v_accvgpr_read_b32 v47, a39
v_pk_mul_f32 v[148:149], v[148:149], v[28:29]
v_pk_mul_f32 v[150:151], v[150:151], v[28:29]
v_pk_mul_f32 v[156:157], v[156:157], v[28:29]
v_pk_mul_f32 v[158:159], v[158:159], v[28:29]
v_lshlrev_b32 v40, 16, v41
v_and_b32 v41, 0xffff0000, v41
v_lshlrev_b32 v42, 16, v43
v_and_b32 v43, 0xffff0000, v43
v_lshlrev_b32 v44, 16, v45
v_and_b32 v45, 0xffff0000, v45
v_lshlrev_b32 v46, 16, v47
v_and_b32 v47, 0xffff0000, v47
v_pk_fma_f32 v[148:149], v[40:41], v[30:31], v[148:149]
v_pk_fma_f32 v[150:151], v[42:43], v[30:31], v[150:151]
v_pk_fma_f32 v[156:157], v[44:45], v[30:31], v[156:157]
v_pk_fma_f32 v[158:159], v[46:47], v[30:31], v[158:159]
v_cvt_pk_bf16_f32 v148, v148, v149
v_cvt_pk_bf16_f32 v149, v150, v151
v_cvt_pk_bf16_f32 v150, v156, v157
v_cvt_pk_bf16_f32 v151, v158, v159
buffer_load_dwordx4 v9, s[36:39], s81 offen offset:1024 lds
v_accvgpr_read_b32 v41, a40
v_accvgpr_read_b32 v43, a41
v_accvgpr_read_b32 v45, a42
v_accvgpr_read_b32 v47, a43
v_pk_mul_f32 v[164:165], v[164:165], v[28:29]
v_pk_mul_f32 v[166:167], v[166:167], v[28:29]
v_pk_mul_f32 v[172:173], v[172:173], v[28:29]
v_pk_mul_f32 v[174:175], v[174:175], v[28:29]
v_lshlrev_b32 v40, 16, v41
v_and_b32 v41, 0xffff0000, v41
v_lshlrev_b32 v42, 16, v43
v_and_b32 v43, 0xffff0000, v43
v_lshlrev_b32 v44, 16, v45
v_and_b32 v45, 0xffff0000, v45
v_lshlrev_b32 v46, 16, v47
v_and_b32 v47, 0xffff0000, v47
v_pk_fma_f32 v[164:165], v[40:41], v[30:31], v[164:165]
v_pk_fma_f32 v[166:167], v[42:43], v[30:31], v[166:167]
v_pk_fma_f32 v[172:173], v[44:45], v[30:31], v[172:173]
v_pk_fma_f32 v[174:175], v[46:47], v[30:31], v[174:175]
v_cvt_pk_bf16_f32 v164, v164, v165
v_cvt_pk_bf16_f32 v165, v166, v167
v_cvt_pk_bf16_f32 v166, v172, v173
v_cvt_pk_bf16_f32 v167, v174, v175
buffer_load_dwordx4 v10, s[36:39], s81 offen offset:2048 lds
v_accvgpr_read_b32 v41, a44
v_accvgpr_read_b32 v43, a45
v_accvgpr_read_b32 v45, a46
v_accvgpr_read_b32 v47, a47
v_pk_mul_f32 v[180:181], v[180:181], v[28:29]
v_pk_mul_f32 v[182:183], v[182:183], v[28:29]
v_pk_mul_f32 v[188:189], v[188:189], v[28:29]
v_pk_mul_f32 v[190:191], v[190:191], v[28:29]
v_lshlrev_b32 v40, 16, v41
v_and_b32 v41, 0xffff0000, v41
v_lshlrev_b32 v42, 16, v43
v_and_b32 v43, 0xffff0000, v43
v_lshlrev_b32 v44, 16, v45
v_and_b32 v45, 0xffff0000, v45
v_lshlrev_b32 v46, 16, v47
v_and_b32 v47, 0xffff0000, v47
v_pk_fma_f32 v[180:181], v[40:41], v[30:31], v[180:181]
v_pk_fma_f32 v[182:183], v[42:43], v[30:31], v[182:183]
v_pk_fma_f32 v[188:189], v[44:45], v[30:31], v[188:189]
v_pk_fma_f32 v[190:191], v[46:47], v[30:31], v[190:191]
v_cvt_pk_bf16_f32 v180, v180, v181
v_cvt_pk_bf16_f32 v181, v182, v183
v_cvt_pk_bf16_f32 v182, v188, v189
v_cvt_pk_bf16_f32 v183, v190, v191
buffer_load_dwordx4 v11, s[36:39], s81 offen offset:3072 lds
v_accvgpr_read_b32 v41, a48
v_accvgpr_read_b32 v43, a49
v_accvgpr_read_b32 v45, a50
v_accvgpr_read_b32 v47, a51
v_pk_mul_f32 v[196:197], v[196:197], v[28:29]
v_pk_mul_f32 v[198:199], v[198:199], v[28:29]
v_pk_mul_f32 v[204:205], v[204:205], v[28:29]
v_pk_mul_f32 v[206:207], v[206:207], v[28:29]
v_lshlrev_b32 v40, 16, v41
v_and_b32 v41, 0xffff0000, v41
v_lshlrev_b32 v42, 16, v43
v_and_b32 v43, 0xffff0000, v43
v_lshlrev_b32 v44, 16, v45
v_and_b32 v45, 0xffff0000, v45
v_lshlrev_b32 v46, 16, v47
v_and_b32 v47, 0xffff0000, v47
v_pk_fma_f32 v[196:197], v[40:41], v[30:31], v[196:197]
v_pk_fma_f32 v[198:199], v[42:43], v[30:31], v[198:199]
v_pk_fma_f32 v[204:205], v[44:45], v[30:31], v[204:205]
v_pk_fma_f32 v[206:207], v[46:47], v[30:31], v[206:207]
v_cvt_pk_bf16_f32 v196, v196, v197
v_cvt_pk_bf16_f32 v197, v198, v199
v_cvt_pk_bf16_f32 v198, v204, v205
v_cvt_pk_bf16_f32 v199, v206, v207
s_add_u32 s81, s81, 28672
s_add_u32 m0, s18, 36864
s_nop 0
buffer_load_dwordx4 v8, s[36:39], s81 offen offset:0 lds
v_accvgpr_read_b32 v41, a52
v_accvgpr_read_b32 v43, a53
v_accvgpr_read_b32 v45, a54
v_accvgpr_read_b32 v47, a55
v_pk_mul_f32 v[212:213], v[212:213], v[28:29]
v_pk_mul_f32 v[214:215], v[214:215], v[28:29]
v_pk_mul_f32 v[220:221], v[220:221], v[28:29]
v_pk_mul_f32 v[222:223], v[222:223], v[28:29]
v_lshlrev_b32 v40, 16, v41
v_and_b32 v41, 0xffff0000, v41
v_lshlrev_b32 v42, 16, v43
v_and_b32 v43, 0xffff0000, v43
v_lshlrev_b32 v44, 16, v45
v_and_b32 v45, 0xffff0000, v45
v_lshlrev_b32 v46, 16, v47
v_and_b32 v47, 0xffff0000, v47
v_pk_fma_f32 v[212:213], v[40:41], v[30:31], v[212:213]
v_pk_fma_f32 v[214:215], v[42:43], v[30:31], v[214:215]
v_pk_fma_f32 v[220:221], v[44:45], v[30:31], v[220:221]
v_pk_fma_f32 v[222:223], v[46:47], v[30:31], v[222:223]
v_cvt_pk_bf16_f32 v212, v212, v213
v_cvt_pk_bf16_f32 v213, v214, v215
v_cvt_pk_bf16_f32 v214, v220, v221
v_cvt_pk_bf16_f32 v215, v222, v223
buffer_load_dwordx4 v9, s[36:39], s81 offen offset:1024 lds
v_accvgpr_read_b32 v41, a56
v_accvgpr_read_b32 v43, a57
v_accvgpr_read_b32 v45, a58
v_accvgpr_read_b32 v47, a59
v_pk_mul_f32 v[228:229], v[228:229], v[28:29]
v_pk_mul_f32 v[230:231], v[230:231], v[28:29]
v_pk_mul_f32 v[236:237], v[236:237], v[28:29]
v_pk_mul_f32 v[238:239], v[238:239], v[28:29]
v_lshlrev_b32 v40, 16, v41
v_and_b32 v41, 0xffff0000, v41
v_lshlrev_b32 v42, 16, v43
v_and_b32 v43, 0xffff0000, v43
v_lshlrev_b32 v44, 16, v45
v_and_b32 v45, 0xffff0000, v45
v_lshlrev_b32 v46, 16, v47
v_and_b32 v47, 0xffff0000, v47
v_pk_fma_f32 v[228:229], v[40:41], v[30:31], v[228:229]
v_pk_fma_f32 v[230:231], v[42:43], v[30:31], v[230:231]
v_pk_fma_f32 v[236:237], v[44:45], v[30:31], v[236:237]
v_pk_fma_f32 v[238:239], v[46:47], v[30:31], v[238:239]
v_cvt_pk_bf16_f32 v228, v228, v229
v_cvt_pk_bf16_f32 v229, v230, v231
v_cvt_pk_bf16_f32 v230, v236, v237
v_cvt_pk_bf16_f32 v231, v238, v239
buffer_load_dwordx4 v10, s[36:39], s81 offen offset:2048 lds
v_accvgpr_read_b32 v41, a60
v_accvgpr_read_b32 v43, a61
v_accvgpr_read_b32 v45, a62
v_accvgpr_read_b32 v47, a63
v_pk_mul_f32 v[244:245], v[244:245], v[28:29]
v_pk_mul_f32 v[246:247], v[246:247], v[28:29]
v_pk_mul_f32 v[252:253], v[252:253], v[28:29]
v_pk_mul_f32 v[254:255], v[254:255], v[28:29]
v_lshlrev_b32 v40, 16, v41
v_and_b32 v41, 0xffff0000, v41
v_lshlrev_b32 v42, 16, v43
v_and_b32 v43, 0xffff0000, v43
v_lshlrev_b32 v44, 16, v45
v_and_b32 v45, 0xffff0000, v45
v_lshlrev_b32 v46, 16, v47
v_and_b32 v47, 0xffff0000, v47
v_pk_fma_f32 v[244:245], v[40:41], v[30:31], v[244:245]
v_pk_fma_f32 v[246:247], v[42:43], v[30:31], v[246:247]
v_pk_fma_f32 v[252:253], v[44:45], v[30:31], v[252:253]
v_pk_fma_f32 v[254:255], v[46:47], v[30:31], v[254:255]
v_cvt_pk_bf16_f32 v244, v244, v245
v_cvt_pk_bf16_f32 v245, v246, v247
v_cvt_pk_bf16_f32 v246, v252, v253
v_cvt_pk_bf16_f32 v247, v254, v255
buffer_load_dwordx4 v11, s[36:39], s81 offen offset:3072 lds
s_sub_u32 s81, s81, 28544
K2_done:
s_waitcnt vmcnt(16)
s_barrier
ds_read_b64_tr_b16 a[64:65], v12 offset:0
ds_read_b64_tr_b16 a[66:67], v12 offset:2048
ds_read_b64_tr_b16 a[68:69], v12 offset:4096
ds_read_b64_tr_b16 a[70:71], v12 offset:6144
ds_read_b64_tr_b16 a[72:73], v12 offset:8192
ds_read_b64_tr_b16 a[74:75], v12 offset:10240
ds_read_b64_tr_b16 a[76:77], v12 offset:12288
ds_read_b64_tr_b16 a[78:79], v12 offset:14336
ds_read_b64_tr_b16 a[80:81], v12 offset:16384
ds_read_b64_tr_b16 a[82:83], v12 offset:18432
ds_read_b64_tr_b16 a[84:85], v12 offset:20480
ds_read_b64_tr_b16 a[86:87], v12 offset:22528
ds_read_b64_tr_b16 a[88:89], v12 offset:24576
ds_read_b64_tr_b16 a[90:91], v12 offset:26624
ds_read_b64_tr_b16 a[92:93], v12 offset:28672
ds_read_b64_tr_b16 a[94:95], v12 offset:30720
v_add_u32 v12, 4294934528, v12
s_waitcnt lgkmcnt(14)
v_mfma_f32_16x16x32_bf16 v[32:35], a[64:67], v[128:131], 0
s_waitcnt lgkmcnt(12)
s_add_u32 m0, s18, 65536
ds_read_b64_tr_b16 a[96:97], v13 offset:0
v_mfma_f32_16x16x32_bf16 v[32:35], a[68:71], v[144:147], v[32:35]
s_waitcnt lgkmcnt(11)
ds_read_b64_tr_b16 a[98:99], v13 offset:2048
buffer_load_dwordx4 v8, s[36:39], s81 offen offset:0 lds
v_mfma_f32_16x16x32_bf16 v[32:35], a[72:75], v[160:163], v[32:35]
s_waitcnt lgkmcnt(10)
ds_read_b64_tr_b16 a[100:101], v13 offset:4096
v_mfma_f32_16x16x32_bf16 v[32:35], a[76:79], v[176:179], v[32:35]
s_waitcnt lgkmcnt(9)
ds_read_b64_tr_b16 a[102:103], v13 offset:6144
v_mfma_f32_16x16x32_bf16 v[32:35], a[80:83], v[192:195], v[32:35]
s_waitcnt lgkmcnt(8)
ds_read_b64_tr_b16 a[104:105], v13 offset:8192
v_mfma_f32_16x16x32_bf16 v[32:35], a[84:87], v[208:211], v[32:35]
s_waitcnt lgkmcnt(7)
ds_read_b64_tr_b16 a[106:107], v13 offset:10240
buffer_load_dwordx4 v9, s[36:39], s81 offen offset:1024 lds
v_mfma_f32_16x16x32_bf16 v[32:35], a[88:91], v[224:227], v[32:35]
s_waitcnt lgkmcnt(6)
ds_read_b64_tr_b16 a[108:109], v13 offset:12288
v_mfma_f32_16x16x32_bf16 v[32:35], a[92:95], v[240:243], v[32:35]
ds_read_b64_tr_b16 a[110:111], v13 offset:14336
v_mfma_f32_16x16x32_bf16 v[36:39], a[64:67], v[132:135], 0
ds_read_b64_tr_b16 a[112:113], v13 offset:16384
v_mfma_f32_16x16x32_bf16 v[36:39], a[68:71], v[148:151], v[36:39]
ds_read_b64_tr_b16 a[114:115], v13 offset:18432
buffer_load_dwordx4 v10, s[36:39], s81 offen offset:2048 lds
v_mfma_f32_16x16x32_bf16 v[36:39], a[72:75], v[164:167], v[36:39]
ds_read_b64_tr_b16 a[116:117], v13 offset:20480
v_mfma_f32_16x16x32_bf16 v[36:39], a[76:79], v[180:183], v[36:39]
ds_read_b64_tr_b16 a[118:119], v13 offset:22528
v_mfma_f32_16x16x32_bf16 v[36:39], a[80:83], v[196:199], v[36:39]
ds_read_b64_tr_b16 a[120:121], v13 offset:24576
v_mfma_f32_16x16x32_bf16 v[36:39], a[84:87], v[212:215], v[36:39]
ds_read_b64_tr_b16 a[122:123], v13 offset:26624
buffer_load_dwordx4 v11, s[36:39], s81 offen offset:3072 lds
v_mfma_f32_16x16x32_bf16 v[36:39], a[88:91], v[228:231], v[36:39]
ds_read_b64_tr_b16 a[124:125], v13 offset:28672
v_mfma_f32_16x16x32_bf16 v[36:39], a[92:95], v[244:247], v[36:39]
s_waitcnt lgkmcnt(11)
ds_read_b64_tr_b16 a[126:127], v13 offset:30720
v_add_u32 v13, 4294934528, v13
v_mfma_f32_16x16x32_bf16 v[40:43], a[96:99], v[128:131], 0
s_add_u32 s81, s81, 28672
s_add_u32 m0, s18, 69632
ds_read_b64_tr_b16 a[64:65], v14 offset:0
v_mfma_f32_16x16x32_bf16 v[40:43], a[100:103], v[144:147], v[40:43]
s_waitcnt lgkmcnt(11)
ds_read_b64_tr_b16 a[66:67], v14 offset:2048
buffer_load_dwordx4 v8, s[36:39], s81 offen offset:0 lds
v_mfma_f32_16x16x32_bf16 v[40:43], a[104:107], v[160:163], v[40:43]
s_waitcnt lgkmcnt(10)
ds_read_b64_tr_b16 a[68:69], v14 offset:4096
v_mfma_f32_16x16x32_bf16 v[40:43], a[108:111], v[176:179], v[40:43]
s_waitcnt lgkmcnt(9)
ds_read_b64_tr_b16 a[70:71], v14 offset:6144
v_mfma_f32_16x16x32_bf16 v[40:43], a[112:115], v[192:195], v[40:43]
s_waitcnt lgkmcnt(8)
ds_read_b64_tr_b16 a[72:73], v14 offset:8192
v_mfma_f32_16x16x32_bf16 v[40:43], a[116:119], v[208:211], v[40:43]
s_waitcnt lgkmcnt(7)
ds_read_b64_tr_b16 a[74:75], v14 offset:10240
buffer_load_dwordx4 v9, s[36:39], s81 offen offset:1024 lds
v_mfma_f32_16x16x32_bf16 v[40:43], a[120:123], v[224:227], v[40:43]
s_waitcnt lgkmcnt(6)
ds_read_b64_tr_b16 a[76:77], v14 offset:12288
v_mfma_f32_16x16x32_bf16 v[40:43], a[124:127], v[240:243], v[40:43]
ds_read_b64_tr_b16 a[78:79], v14 offset:14336
v_mfma_f32_16x16x32_bf16 v[44:47], a[96:99], v[132:135], 0
ds_read_b64_tr_b16 a[80:81], v14 offset:16384
v_mfma_f32_16x16x32_bf16 v[44:47], a[100:103], v[148:151], v[44:47]
ds_read_b64_tr_b16 a[82:83], v14 offset:18432
buffer_load_dwordx4 v10, s[36:39], s81 offen offset:2048 lds
v_mfma_f32_16x16x32_bf16 v[44:47], a[104:107], v[164:167], v[44:47]
ds_read_b64_tr_b16 a[84:85], v14 offset:20480
v_mfma_f32_16x16x32_bf16 v[44:47], a[108:111], v[180:183], v[44:47]
ds_read_b64_tr_b16 a[86:87], v14 offset:22528
v_mfma_f32_16x16x32_bf16 v[44:47], a[112:115], v[196:199], v[44:47]
ds_read_b64_tr_b16 a[88:89], v14 offset:24576
v_mfma_f32_16x16x32_bf16 v[44:47], a[116:119], v[212:215], v[44:47]
ds_read_b64_tr_b16 a[90:91], v14 offset:26624
buffer_load_dwordx4 v11, s[36:39], s81 offen offset:3072 lds
v_mfma_f32_16x16x32_bf16 v[44:47], a[120:123], v[228:231], v[44:47]
ds_read_b64_tr_b16 a[92:93], v14 offset:28672
v_mfma_f32_16x16x32_bf16 v[44:47], a[124:127], v[244:247], v[44:47]
s_waitcnt lgkmcnt(13)
ds_read_b64_tr_b16 a[94:95], v14 offset:30720
v_add_u32 v14, 4294934528, v14
v_mfma_f32_16x16x32_bf16 v[48:51], a[64:67], v[128:131], 0
s_waitcnt lgkmcnt(12)
s_sub_u32 s81, s81, 28544
ds_read_b64_tr_b16 a[96:97], v15 offset:0
v_mfma_f32_16x16x32_bf16 v[48:51], a[68:71], v[144:147], v[48:51]
s_waitcnt lgkmcnt(11)
ds_read_b64_tr_b16 a[98:99], v15 offset:2048
v_mfma_f32_16x16x32_bf16 v[48:51], a[72:75], v[160:163], v[48:51]
s_waitcnt lgkmcnt(10)
ds_read_b64_tr_b16 a[100:101], v15 offset:4096
v_mfma_f32_16x16x32_bf16 v[48:51], a[76:79], v[176:179], v[48:51]
s_waitcnt lgkmcnt(9)
ds_read_b64_tr_b16 a[102:103], v15 offset:6144
v_mfma_f32_16x16x32_bf16 v[48:51], a[80:83], v[192:195], v[48:51]
s_waitcnt lgkmcnt(8)
ds_read_b64_tr_b16 a[104:105], v15 offset:8192
v_cvt_pk_bf16_f32 v32, v32, v33
v_mfma_f32_16x16x32_bf16 v[48:51], a[84:87], v[208:211], v[48:51]
s_waitcnt lgkmcnt(7)
ds_read_b64_tr_b16 a[106:107], v15 offset:10240
v_cvt_pk_bf16_f32 v33, v34, v35
v_mfma_f32_16x16x32_bf16 v[48:51], a[88:91], v[224:227], v[48:51]
s_waitcnt lgkmcnt(6)
ds_read_b64_tr_b16 a[108:109], v15 offset:12288
v_cvt_pk_bf16_f32 v34, v40, v41
v_mfma_f32_16x16x32_bf16 v[48:51], a[92:95], v[240:243], v[48:51]
ds_read_b64_tr_b16 a[110:111], v15 offset:14336
v_cvt_pk_bf16_f32 v35, v42, v43
v_mfma_f32_16x16x32_bf16 v[52:55], a[64:67], v[132:135], 0
ds_read_b64_tr_b16 a[112:113], v15 offset:16384
buffer_store_dwordx4 v[32:35], v1, s[4:7], s8 offen offset:0 sc1
v_mfma_f32_16x16x32_bf16 v[52:55], a[68:71], v[148:151], v[52:55]
ds_read_b64_tr_b16 a[114:115], v15 offset:18432
v_mfma_f32_16x16x32_bf16 v[52:55], a[72:75], v[164:167], v[52:55]
ds_read_b64_tr_b16 a[116:117], v15 offset:20480
v_mfma_f32_16x16x32_bf16 v[52:55], a[76:79], v[180:183], v[52:55]
ds_read_b64_tr_b16 a[118:119], v15 offset:22528
v_mfma_f32_16x16x32_bf16 v[52:55], a[80:83], v[196:199], v[52:55]
ds_read_b64_tr_b16 a[120:121], v15 offset:24576
v_mfma_f32_16x16x32_bf16 v[52:55], a[84:87], v[212:215], v[52:55]
ds_read_b64_tr_b16 a[122:123], v15 offset:26624
v_mfma_f32_16x16x32_bf16 v[52:55], a[88:91], v[228:231], v[52:55]
ds_read_b64_tr_b16 a[124:125], v15 offset:28672
ds_read_b64_tr_b16 a[126:127], v15 offset:30720
v_mfma_f32_16x16x32_bf16 v[52:55], a[92:95], v[244:247], v[52:55]
s_waitcnt vmcnt(17) lgkmcnt(14)
s_barrier
v_add_u32 v15, 4294934528, v15
v_mfma_f32_16x16x32_bf16 v[56:59], a[96:99], v[128:131], 0
s_waitcnt lgkmcnt(12)
ds_read_b64_tr_b16 a[64:65], v12 offset:0
v_cvt_pk_bf16_f32 v36, v36, v37
v_mfma_f32_16x16x32_bf16 v[56:59], a[100:103], v[144:147], v[56:59]
s_waitcnt lgkmcnt(11)
ds_read_b64_tr_b16 a[66:67], v12 offset:2048
v_cvt_pk_bf16_f32 v37, v38, v39
v_mfma_f32_16x16x32_bf16 v[56:59], a[104:107], v[160:163], v[56:59]
s_waitcnt lgkmcnt(10)
ds_read_b64_tr_b16 a[68:69], v12 offset:4096
v_cvt_pk_bf16_f32 v38, v44, v45
v_mfma_f32_16x16x32_bf16 v[56:59], a[108:111], v[176:179], v[56:59]
s_waitcnt lgkmcnt(9)
ds_read_b64_tr_b16 a[70:71], v12 offset:6144
v_cvt_pk_bf16_f32 v39, v46, v47
v_mfma_f32_16x16x32_bf16 v[56:59], a[112:115], v[192:195], v[56:59]
s_waitcnt lgkmcnt(8)
ds_read_b64_tr_b16 a[72:73], v12 offset:8192
buffer_store_dwordx4 v[36:39], v1, s[4:7], s12 offen offset:0 sc1
v_mfma_f32_16x16x32_bf16 v[56:59], a[116:119], v[208:211], v[56:59]
s_waitcnt lgkmcnt(7)
ds_read_b64_tr_b16 a[74:75], v12 offset:10240
v_mfma_f32_16x16x32_bf16 v[56:59], a[120:123], v[224:227], v[56:59]
s_waitcnt lgkmcnt(6)
ds_read_b64_tr_b16 a[76:77], v12 offset:12288
v_mfma_f32_16x16x32_bf16 v[56:59], a[124:127], v[240:243], v[56:59]
ds_read_b64_tr_b16 a[78:79], v12 offset:14336
v_mfma_f32_16x16x32_bf16 v[60:63], a[96:99], v[132:135], 0
ds_read_b64_tr_b16 a[80:81], v12 offset:16384
v_mfma_f32_16x16x32_bf16 v[60:63], a[100:103], v[148:151], v[60:63]
ds_read_b64_tr_b16 a[82:83], v12 offset:18432
v_mfma_f32_16x16x32_bf16 v[60:63], a[104:107], v[164:167], v[60:63]
ds_read_b64_tr_b16 a[84:85], v12 offset:20480
v_mfma_f32_16x16x32_bf16 v[60:63], a[108:111], v[180:183], v[60:63]
ds_read_b64_tr_b16 a[86:87], v12 offset:22528
v_mfma_f32_16x16x32_bf16 v[60:63], a[112:115], v[196:199], v[60:63]
ds_read_b64_tr_b16 a[88:89], v12 offset:24576
v_mfma_f32_16x16x32_bf16 v[60:63], a[116:119], v[212:215], v[60:63]
ds_read_b64_tr_b16 a[90:91], v12 offset:26624
v_mfma_f32_16x16x32_bf16 v[60:63], a[120:123], v[228:231], v[60:63]
ds_read_b64_tr_b16 a[92:93], v12 offset:28672
v_mfma_f32_16x16x32_bf16 v[60:63], a[124:127], v[244:247], v[60:63]
s_waitcnt lgkmcnt(13)
ds_read_b64_tr_b16 a[94:95], v12 offset:30720
v_add_u32 v12, 4294901760, v12
v_mfma_f32_16x16x32_bf16 v[64:67], a[64:67], v[128:131], 0
s_waitcnt lgkmcnt(10)
s_add_u32 m0, s18, 0
ds_read_b64_tr_b16 a[96:97], v13 offset:0
v_mfma_f32_16x16x32_bf16 v[64:67], a[68:71], v[144:147], v[64:67]
s_lshl_b32 s34, s29, 5
ds_read_b64_tr_b16 a[98:99], v13 offset:2048
buffer_load_dwordx4 v8, s[36:39], s81 offen offset:0 lds
v_mfma_f32_16x16x32_bf16 v[64:67], a[72:75], v[160:163], v[64:67]
s_waitcnt lgkmcnt(10)
s_add_u32 s34, s34, s20
ds_read_b64_tr_b16 a[100:101], v13 offset:4096
v_mfma_f32_16x16x32_bf16 v[64:67], a[76:79], v[176:179], v[64:67]
s_waitcnt lgkmcnt(3)
s_lshl_b32 s34, s34, 2
ds_read_b64_tr_b16 a[102:103], v13 offset:6144
v_mfma_f32_16x16x32_bf16 v[64:67], a[80:83], v[192:195], v[64:67]
s_add_u32 s34, s34, 94380032
ds_read_b64_tr_b16 a[104:105], v13 offset:8192
v_cvt_pk_bf16_f32 v48, v48, v49
v_mfma_f32_16x16x32_bf16 v[64:67], a[84:87], v[208:211], v[64:67]
s_add_u32 s35, s34, 64
ds_read_b64_tr_b16 a[106:107], v13 offset:10240
v_cvt_pk_bf16_f32 v49, v50, v51
v_mfma_f32_16x16x32_bf16 v[64:67], a[88:91], v[224:227], v[64:67]
s_lshr_b32 s22, s2, 3
ds_read_b64_tr_b16 a[108:109], v13 offset:12288
v_cvt_pk_bf16_f32 v50, v56, v57
v_mfma_f32_16x16x32_bf16 v[64:67], a[92:95], v[240:243], v[64:67]
s_add_u32 s23, s22, 4
ds_read_b64_tr_b16 a[110:111], v13 offset:14336
v_cvt_pk_bf16_f32 v51, v58, v59
v_mfma_f32_16x16x32_bf16 v[68:71], a[64:67], v[132:135], 0
s_lshr_b32 s23, s23, 5
ds_read_b64_tr_b16 a[112:113], v13 offset:16384
buffer_store_dwordx4 v[48:51], v1, s[4:7], s8 offen offset:1024 sc1
v_mfma_f32_16x16x32_bf16 v[68:71], a[68:71], v[148:151], v[68:71]
s_lshl_b32 s23, s23, 1
ds_read_b64_tr_b16 a[114:115], v13 offset:18432
buffer_load_dwordx4 v9, s[36:39], s81 offen offset:1024 lds
v_mfma_f32_16x16x32_bf16 v[68:71], a[72:75], v[164:167], v[68:71]
s_sub_u32 s22, s22, s23
ds_read_b64_tr_b16 a[116:117], v13 offset:20480
v_mfma_f32_16x16x32_bf16 v[68:71], a[76:79], v[180:183], v[68:71]
s_lshr_b32 s80, s22, 2
ds_read_b64_tr_b16 a[118:119], v13 offset:22528
v_mfma_f32_16x16x32_bf16 v[68:71], a[80:83], v[196:199], v[68:71]
s_and_b32 s22, s22, 3
ds_read_b64_tr_b16 a[120:121], v13 offset:24576
v_mfma_f32_16x16x32_bf16 v[68:71], a[84:87], v[212:215], v[68:71]
s_and_b32 s79, s2, 7
ds_read_b64_tr_b16 a[122:123], v13 offset:26624
buffer_load_dwordx4 v10, s[36:39], s81 offen offset:2048 lds
v_mfma_f32_16x16x32_bf16 v[68:71], a[88:91], v[228:231], v[68:71]
s_waitcnt lgkmcnt(4)
s_lshl_b32 s79, s79, 2
ds_read_b64_tr_b16 a[124:125], v13 offset:28672
v_mfma_f32_16x16x32_bf16 v[68:71], a[92:95], v[244:247], v[68:71]
s_add_u32 s79, s79, s22
ds_read_b64_tr_b16 a[126:127], v13 offset:30720
v_add_u32 v13, 4294901760, v13
v_mfma_f32_16x16x32_bf16 v[72:75], a[96:99], v[128:131], 0
s_lshl_b32 s22, s79, 2
ds_read_b64_tr_b16 a[64:65], v14 offset:0
v_cvt_pk_bf16_f32 v52, v52, v53
v_mfma_f32_16x16x32_bf16 v[72:75], a[100:103], v[144:147], v[72:75]
s_add_u32 s22, s22, s3
ds_read_b64_tr_b16 a[66:67], v14 offset:2048
v_cvt_pk_bf16_f32 v53, v54, v55
v_mfma_f32_16x16x32_bf16 v[72:75], a[104:107], v[160:163], v[72:75]
s_mul_i32 s25, s22, 28672
ds_read_b64_tr_b16 a[68:69], v14 offset:4096
v_cvt_pk_bf16_f32 v54, v60, v61
v_mfma_f32_16x16x32_bf16 v[72:75], a[108:111], v[176:179], v[72:75]
s_lshl_b32 s23, s80, 6
ds_read_b64_tr_b16 a[70:71], v14 offset:6144
v_cvt_pk_bf16_f32 v55, v62, v63
v_mfma_f32_16x16x32_bf16 v[72:75], a[112:115], v[192:195], v[72:75]
s_waitcnt lgkmcnt(4)
s_add_u32 s25, s25, s23
ds_read_b64_tr_b16 a[72:73], v14 offset:8192
buffer_store_dwordx4 v[52:55], v1, s[4:7], s12 offen offset:1024 sc1
v_mfma_f32_16x16x32_bf16 v[72:75], a[116:119], v[208:211], v[72:75]
s_mul_i32 s26, s22, 229376
ds_read_b64_tr_b16 a[74:75], v14 offset:10240
buffer_load_dwordx4 v11, s[36:39], s81 offen offset:3072 lds
v_mfma_f32_16x16x32_bf16 v[72:75], a[120:123], v[224:227], v[72:75]
s_lshl_b32 s23, s80, 10
ds_read_b64_tr_b16 a[76:77], v14 offset:12288
v_lshrrev_b32 v20, 4, v1
v_mfma_f32_16x16x32_bf16 v[72:75], a[124:127], v[240:243], v[72:75]
s_add_u32 s26, s26, s23
ds_read_b64_tr_b16 a[78:79], v14 offset:14336
v_and_b32 v19, 15, v20
v_mfma_f32_16x16x32_bf16 v[76:79], a[96:99], v[132:135], 0
s_add_u32 s81, s81, 28672
s_add_u32 m0, s18, 4096
ds_read_b64_tr_b16 a[80:81], v14 offset:16384
v_mfma_f32_16x16x32_bf16 v[76:79], a[100:103], v[148:151], v[76:79]
s_add_u32 s26, s26, 104857600
ds_read_b64_tr_b16 a[82:83], v14 offset:18432
buffer_load_dwordx4 v8, s[36:39], s81 offen offset:0 lds
v_mfma_f32_16x16x32_bf16 v[76:79], a[104:107], v[164:167], v[76:79]
s_lshr_b32 s22, s79, 1
ds_read_b64_tr_b16 a[84:85], v14 offset:20480
v_mul_u32_u24 v21, 1792, v19
v_mfma_f32_16x16x32_bf16 v[76:79], a[108:111], v[180:183], v[76:79]
s_lshl_b32 s22, s22, 7
ds_read_b64_tr_b16 a[86:87], v14 offset:22528
v_lshlrev_b32 v19, 2, v19
v_mfma_f32_16x16x32_bf16 v[76:79], a[112:115], v[196:199], v[76:79]
s_add_u32 s33, s22, 94380032
ds_read_b64_tr_b16 a[88:89], v14 offset:24576
v_lshrrev_b32 v22, 4, v20
v_mfma_f32_16x16x32_bf16 v[76:79], a[116:119], v[212:215], v[76:79]
s_mov_b64 s[40:41], s[88:89]
ds_read_b64_tr_b16 a[90:91], v14 offset:26624
buffer_load_dwordx4 v9, s[36:39], s81 offen offset:1024 lds
v_mfma_f32_16x16x32_bf16 v[76:79], a[120:123], v[228:231], v[76:79]
s_mov_b32 s42, 3670016
ds_read_b64_tr_b16 a[92:93], v14 offset:28672
v_lshl_add_u32 v21, v22, 3, v21
v_mfma_f32_16x16x32_bf16 v[76:79], a[124:127], v[244:247], v[76:79]
s_waitcnt lgkmcnt(13)
s_mov_b32 s43, 0x20000
ds_read_b64_tr_b16 a[94:95], v14 offset:30720
v_add_u32 v14, 4294901760, v14
v_mfma_f32_16x16x32_bf16 v[80:83], a[64:67], v[128:131], 0
s_waitcnt lgkmcnt(12)
ds_read_b64_tr_b16 a[96:97], v15 offset:0
v_mfma_f32_16x16x32_bf16 v[80:83], a[68:71], v[144:147], v[80:83]
s_waitcnt lgkmcnt(11)
ds_read_b64_tr_b16 a[98:99], v15 offset:2048
buffer_load_dwordx4 v10, s[36:39], s81 offen offset:2048 lds
v_mfma_f32_16x16x32_bf16 v[80:83], a[72:75], v[160:163], v[80:83]
s_waitcnt lgkmcnt(10)
ds_read_b64_tr_b16 a[100:101], v15 offset:4096
v_mfma_f32_16x16x32_bf16 v[80:83], a[76:79], v[176:179], v[80:83]
s_waitcnt lgkmcnt(9)
ds_read_b64_tr_b16 a[102:103], v15 offset:6144
v_mfma_f32_16x16x32_bf16 v[80:83], a[80:83], v[192:195], v[80:83]
s_waitcnt lgkmcnt(8)
ds_read_b64_tr_b16 a[104:105], v15 offset:8192
v_cvt_pk_bf16_f32 v64, v64, v65
v_mfma_f32_16x16x32_bf16 v[80:83], a[84:87], v[208:211], v[80:83]
s_waitcnt lgkmcnt(7)
ds_read_b64_tr_b16 a[106:107], v15 offset:10240
v_cvt_pk_bf16_f32 v65, v66, v67
v_mfma_f32_16x16x32_bf16 v[80:83], a[88:91], v[224:227], v[80:83]
s_waitcnt lgkmcnt(6)
ds_read_b64_tr_b16 a[108:109], v15 offset:12288
v_cvt_pk_bf16_f32 v66, v72, v73
v_mfma_f32_16x16x32_bf16 v[80:83], a[92:95], v[240:243], v[80:83]
ds_read_b64_tr_b16 a[110:111], v15 offset:14336
v_cvt_pk_bf16_f32 v67, v74, v75
v_mfma_f32_16x16x32_bf16 v[84:87], a[64:67], v[132:135], 0
ds_read_b64_tr_b16 a[112:113], v15 offset:16384
buffer_store_dwordx4 v[64:67], v1, s[4:7], s8 offen offset:2048 sc1
v_mfma_f32_16x16x32_bf16 v[84:87], a[68:71], v[148:151], v[84:87]
ds_read_b64_tr_b16 a[114:115], v15 offset:18432
buffer_load_dwordx4 v11, s[36:39], s81 offen offset:3072 lds
v_mfma_f32_16x16x32_bf16 v[84:87], a[72:75], v[164:167], v[84:87]
ds_read_b64_tr_b16 a[116:117], v15 offset:20480
v_mfma_f32_16x16x32_bf16 v[84:87], a[76:79], v[180:183], v[84:87]
ds_read_b64_tr_b16 a[118:119], v15 offset:22528
v_mfma_f32_16x16x32_bf16 v[84:87], a[80:83], v[196:199], v[84:87]
s_sub_u32 s81, s81, 28544
ds_read_b64_tr_b16 a[120:121], v15 offset:24576
v_mfma_f32_16x16x32_bf16 v[84:87], a[84:87], v[212:215], v[84:87]
ds_read_b64_tr_b16 a[122:123], v15 offset:26624
v_mfma_f32_16x16x32_bf16 v[84:87], a[88:91], v[228:231], v[84:87]
ds_read_b64_tr_b16 a[124:125], v15 offset:28672
ds_read_b64_tr_b16 a[126:127], v15 offset:30720
v_mfma_f32_16x16x32_bf16 v[84:87], a[92:95], v[244:247], v[84:87]
s_waitcnt vmcnt(21) lgkmcnt(14)
s_barrier
v_add_u32 v15, 4294901760, v15
v_mfma_f32_16x16x32_bf16 v[88:91], a[96:99], v[128:131], 0
s_waitcnt lgkmcnt(12)
ds_read_b64_tr_b16 a[64:65], v12 offset:0
v_cvt_pk_bf16_f32 v68, v68, v69
v_mfma_f32_16x16x32_bf16 v[88:91], a[100:103], v[144:147], v[88:91]
s_waitcnt lgkmcnt(11)
ds_read_b64_tr_b16 a[66:67], v12 offset:2048
v_cvt_pk_bf16_f32 v69, v70, v71
v_mfma_f32_16x16x32_bf16 v[88:91], a[104:107], v[160:163], v[88:91]
s_waitcnt lgkmcnt(10)
ds_read_b64_tr_b16 a[68:69], v12 offset:4096
v_cvt_pk_bf16_f32 v70, v76, v77
v_mfma_f32_16x16x32_bf16 v[88:91], a[108:111], v[176:179], v[88:91]
s_waitcnt lgkmcnt(9)
ds_read_b64_tr_b16 a[70:71], v12 offset:6144
v_cvt_pk_bf16_f32 v71, v78, v79
v_mfma_f32_16x16x32_bf16 v[88:91], a[112:115], v[192:195], v[88:91]
s_waitcnt lgkmcnt(8)
ds_read_b64_tr_b16 a[72:73], v12 offset:8192
buffer_store_dwordx4 v[68:71], v1, s[4:7], s12 offen offset:2048 sc1
v_mfma_f32_16x16x32_bf16 v[88:91], a[116:119], v[208:211], v[88:91]
s_waitcnt lgkmcnt(7)
ds_read_b64_tr_b16 a[74:75], v12 offset:10240
v_mfma_f32_16x16x32_bf16 v[88:91], a[120:123], v[224:227], v[88:91]
s_waitcnt lgkmcnt(6)
ds_read_b64_tr_b16 a[76:77], v12 offset:12288
v_mfma_f32_16x16x32_bf16 v[88:91], a[124:127], v[240:243], v[88:91]
ds_read_b64_tr_b16 a[78:79], v12 offset:14336
v_mfma_f32_16x16x32_bf16 v[92:95], a[96:99], v[132:135], 0
ds_read_b64_tr_b16 a[80:81], v12 offset:16384
v_mfma_f32_16x16x32_bf16 v[92:95], a[100:103], v[148:151], v[92:95]
ds_read_b64_tr_b16 a[82:83], v12 offset:18432
v_mfma_f32_16x16x32_bf16 v[92:95], a[104:107], v[164:167], v[92:95]
ds_read_b64_tr_b16 a[84:85], v12 offset:20480
v_mfma_f32_16x16x32_bf16 v[92:95], a[108:111], v[180:183], v[92:95]
ds_read_b64_tr_b16 a[86:87], v12 offset:22528
v_mfma_f32_16x16x32_bf16 v[92:95], a[112:115], v[196:199], v[92:95]
ds_read_b64_tr_b16 a[88:89], v12 offset:24576
v_mfma_f32_16x16x32_bf16 v[92:95], a[116:119], v[212:215], v[92:95]
ds_read_b64_tr_b16 a[90:91], v12 offset:26624
v_mfma_f32_16x16x32_bf16 v[92:95], a[120:123], v[228:231], v[92:95]
ds_read_b64_tr_b16 a[92:93], v12 offset:28672
v_mfma_f32_16x16x32_bf16 v[92:95], a[124:127], v[244:247], v[92:95]
s_waitcnt lgkmcnt(13)
ds_read_b64_tr_b16 a[94:95], v12 offset:30720
v_add_u32 v12, 32768, v12
v_mfma_f32_16x16x32_bf16 v[32:35], a[64:67], v[128:131], 0
s_waitcnt lgkmcnt(12)
s_add_u32 m0, s18, 131072
ds_read_b64_tr_b16 a[96:97], v13 offset:0
v_mfma_f32_16x16x32_bf16 v[32:35], a[68:71], v[144:147], v[32:35]
s_waitcnt lgkmcnt(11)
ds_read_b64_tr_b16 a[98:99], v13 offset:2048
buffer_load_dwordx4 v8, s[36:39], s81 offen offset:0 lds
v_mfma_f32_16x16x32_bf16 v[32:35], a[72:75], v[160:163], v[32:35]
s_waitcnt lgkmcnt(10)
ds_read_b64_tr_b16 a[100:101], v13 offset:4096
v_mfma_f32_16x16x32_bf16 v[32:35], a[76:79], v[176:179], v[32:35]
s_waitcnt lgkmcnt(9)
ds_read_b64_tr_b16 a[102:103], v13 offset:6144
v_mfma_f32_16x16x32_bf16 v[32:35], a[80:83], v[192:195], v[32:35]
s_waitcnt lgkmcnt(8)
ds_read_b64_tr_b16 a[104:105], v13 offset:8192
v_cvt_pk_bf16_f32 v80, v80, v81
v_mfma_f32_16x16x32_bf16 v[32:35], a[84:87], v[208:211], v[32:35]
s_waitcnt lgkmcnt(7)
ds_read_b64_tr_b16 a[106:107], v13 offset:10240
v_cvt_pk_bf16_f32 v81, v82, v83
v_mfma_f32_16x16x32_bf16 v[32:35], a[88:91], v[224:227], v[32:35]
s_waitcnt lgkmcnt(6)
ds_read_b64_tr_b16 a[108:109], v13 offset:12288
v_cvt_pk_bf16_f32 v82, v88, v89
v_mfma_f32_16x16x32_bf16 v[32:35], a[92:95], v[240:243], v[32:35]
ds_read_b64_tr_b16 a[110:111], v13 offset:14336
v_cvt_pk_bf16_f32 v83, v90, v91
v_mfma_f32_16x16x32_bf16 v[36:39], a[64:67], v[132:135], 0
ds_read_b64_tr_b16 a[112:113], v13 offset:16384
buffer_store_dwordx4 v[80:83], v1, s[4:7], s8 offen offset:3072 sc1
v_mfma_f32_16x16x32_bf16 v[36:39], a[68:71], v[148:151], v[36:39]
ds_read_b64_tr_b16 a[114:115], v13 offset:18432
buffer_load_dwordx4 v9, s[36:39], s81 offen offset:1024 lds
v_mfma_f32_16x16x32_bf16 v[36:39], a[72:75], v[164:167], v[36:39]
ds_read_b64_tr_b16 a[116:117], v13 offset:20480
v_mfma_f32_16x16x32_bf16 v[36:39], a[76:79], v[180:183], v[36:39]
ds_read_b64_tr_b16 a[118:119], v13 offset:22528
v_mfma_f32_16x16x32_bf16 v[36:39], a[80:83], v[196:199], v[36:39]
ds_read_b64_tr_b16 a[120:121], v13 offset:24576
v_mfma_f32_16x16x32_bf16 v[36:39], a[84:87], v[212:215], v[36:39]
ds_read_b64_tr_b16 a[122:123], v13 offset:26624
buffer_load_dwordx4 v10, s[36:39], s81 offen offset:2048 lds
v_mfma_f32_16x16x32_bf16 v[36:39], a[88:91], v[228:231], v[36:39]
ds_read_b64_tr_b16 a[124:125], v13 offset:28672
v_mfma_f32_16x16x32_bf16 v[36:39], a[92:95], v[244:247], v[36:39]
s_waitcnt lgkmcnt(13)
ds_read_b64_tr_b16 a[126:127], v13 offset:30720
v_add_u32 v13, 32768, v13
v_mfma_f32_16x16x32_bf16 v[40:43], a[96:99], v[128:131], 0
s_waitcnt lgkmcnt(12)
ds_read_b64_tr_b16 a[64:65], v14 offset:0
v_cvt_pk_bf16_f32 v84, v84, v85
v_mfma_f32_16x16x32_bf16 v[40:43], a[100:103], v[144:147], v[40:43]
s_waitcnt lgkmcnt(11)
ds_read_b64_tr_b16 a[66:67], v14 offset:2048
v_cvt_pk_bf16_f32 v85, v86, v87
v_mfma_f32_16x16x32_bf16 v[40:43], a[104:107], v[160:163], v[40:43]
s_waitcnt lgkmcnt(10)
ds_read_b64_tr_b16 a[68:69], v14 offset:4096
v_cvt_pk_bf16_f32 v86, v92, v93
v_mfma_f32_16x16x32_bf16 v[40:43], a[108:111], v[176:179], v[40:43]
s_waitcnt lgkmcnt(9)
ds_read_b64_tr_b16 a[70:71], v14 offset:6144
v_cvt_pk_bf16_f32 v87, v94, v95
v_mfma_f32_16x16x32_bf16 v[40:43], a[112:115], v[192:195], v[40:43]
s_waitcnt lgkmcnt(8)
ds_read_b64_tr_b16 a[72:73], v14 offset:8192
buffer_store_dwordx4 v[84:87], v1, s[4:7], s12 offen offset:3072 sc1
v_mfma_f32_16x16x32_bf16 v[40:43], a[116:119], v[208:211], v[40:43]
s_waitcnt lgkmcnt(7)
ds_read_b64_tr_b16 a[74:75], v14 offset:10240
buffer_load_dwordx4 v11, s[36:39], s81 offen offset:3072 lds
v_mfma_f32_16x16x32_bf16 v[40:43], a[120:123], v[224:227], v[40:43]
s_waitcnt lgkmcnt(6)
ds_read_b64_tr_b16 a[76:77], v14 offset:12288
v_mfma_f32_16x16x32_bf16 v[40:43], a[124:127], v[240:243], v[40:43]
ds_read_b64_tr_b16 a[78:79], v14 offset:14336
v_mfma_f32_16x16x32_bf16 v[44:47], a[96:99], v[132:135], 0
s_add_u32 s81, s81, 28672
s_add_u32 m0, s18, 135168
ds_read_b64_tr_b16 a[80:81], v14 offset:16384
v_mfma_f32_16x16x32_bf16 v[44:47], a[100:103], v[148:151], v[44:47]
ds_read_b64_tr_b16 a[82:83], v14 offset:18432
buffer_load_dwordx4 v8, s[36:39], s81 offen offset:0 lds
v_mfma_f32_16x16x32_bf16 v[44:47], a[104:107], v[164:167], v[44:47]
ds_read_b64_tr_b16 a[84:85], v14 offset:20480
v_mfma_f32_16x16x32_bf16 v[44:47], a[108:111], v[180:183], v[44:47]
ds_read_b64_tr_b16 a[86:87], v14 offset:22528
v_mfma_f32_16x16x32_bf16 v[44:47], a[112:115], v[196:199], v[44:47]
s_add_u32 s8, s8, 4096
s_add_u32 s12, s12, 4096
ds_read_b64_tr_b16 a[88:89], v14 offset:24576
v_mfma_f32_16x16x32_bf16 v[44:47], a[116:119], v[212:215], v[44:47]
ds_read_b64_tr_b16 a[90:91], v14 offset:26624
buffer_load_dwordx4 v9, s[36:39], s81 offen offset:1024 lds
v_mfma_f32_16x16x32_bf16 v[44:47], a[120:123], v[228:231], v[44:47]
ds_read_b64_tr_b16 a[92:93], v14 offset:28672
v_mfma_f32_16x16x32_bf16 v[44:47], a[124:127], v[244:247], v[44:47]
s_waitcnt lgkmcnt(13)
ds_read_b64_tr_b16 a[94:95], v14 offset:30720
v_add_u32 v14, 32768, v14
v_mfma_f32_16x16x32_bf16 v[48:51], a[64:67], v[128:131], 0
s_waitcnt lgkmcnt(12)
ds_read_b64_tr_b16 a[96:97], v15 offset:0
v_mfma_f32_16x16x32_bf16 v[48:51], a[68:71], v[144:147], v[48:51]
s_waitcnt lgkmcnt(11)
ds_read_b64_tr_b16 a[98:99], v15 offset:2048
buffer_load_dwordx4 v10, s[36:39], s81 offen offset:2048 lds
v_mfma_f32_16x16x32_bf16 v[48:51], a[72:75], v[160:163], v[48:51]
s_waitcnt lgkmcnt(10)
ds_read_b64_tr_b16 a[100:101], v15 offset:4096
v_mfma_f32_16x16x32_bf16 v[48:51], a[76:79], v[176:179], v[48:51]
s_waitcnt lgkmcnt(9)
ds_read_b64_tr_b16 a[102:103], v15 offset:6144
v_mfma_f32_16x16x32_bf16 v[48:51], a[80:83], v[192:195], v[48:51]
s_waitcnt lgkmcnt(8)
ds_read_b64_tr_b16 a[104:105], v15 offset:8192
v_cvt_pk_bf16_f32 v32, v32, v33
v_mfma_f32_16x16x32_bf16 v[48:51], a[84:87], v[208:211], v[48:51]
s_waitcnt lgkmcnt(7)
ds_read_b64_tr_b16 a[106:107], v15 offset:10240
v_cvt_pk_bf16_f32 v33, v34, v35
v_mfma_f32_16x16x32_bf16 v[48:51], a[88:91], v[224:227], v[48:51]
s_waitcnt lgkmcnt(6)
ds_read_b64_tr_b16 a[108:109], v15 offset:12288
v_cvt_pk_bf16_f32 v34, v40, v41
v_mfma_f32_16x16x32_bf16 v[48:51], a[92:95], v[240:243], v[48:51]
ds_read_b64_tr_b16 a[110:111], v15 offset:14336
v_cvt_pk_bf16_f32 v35, v42, v43
v_mfma_f32_16x16x32_bf16 v[52:55], a[64:67], v[132:135], 0
ds_read_b64_tr_b16 a[112:113], v15 offset:16384
buffer_store_dwordx4 v[32:35], v1, s[4:7], s8 offen offset:0 sc1
v_mfma_f32_16x16x32_bf16 v[52:55], a[68:71], v[148:151], v[52:55]
ds_read_b64_tr_b16 a[114:115], v15 offset:18432
buffer_load_dwordx4 v11, s[36:39], s81 offen offset:3072 lds
v_mfma_f32_16x16x32_bf16 v[52:55], a[72:75], v[164:167], v[52:55]
ds_read_b64_tr_b16 a[116:117], v15 offset:20480
v_mfma_f32_16x16x32_bf16 v[52:55], a[76:79], v[180:183], v[52:55]
ds_read_b64_tr_b16 a[118:119], v15 offset:22528
v_mfma_f32_16x16x32_bf16 v[52:55], a[80:83], v[196:199], v[52:55]
s_sub_u32 s81, s81, 28544
ds_read_b64_tr_b16 a[120:121], v15 offset:24576
v_mfma_f32_16x16x32_bf16 v[52:55], a[84:87], v[212:215], v[52:55]
ds_read_b64_tr_b16 a[122:123], v15 offset:26624
v_mfma_f32_16x16x32_bf16 v[52:55], a[88:91], v[228:231], v[52:55]
ds_read_b64_tr_b16 a[124:125], v15 offset:28672
ds_read_b64_tr_b16 a[126:127], v15 offset:30720
v_mfma_f32_16x16x32_bf16 v[52:55], a[92:95], v[244:247], v[52:55]
s_waitcnt vmcnt(25) lgkmcnt(14)
s_barrier
v_add_u32 v15, 32768, v15
v_mfma_f32_16x16x32_bf16 v[56:59], a[96:99], v[128:131], 0
s_waitcnt lgkmcnt(12)
ds_read_b64_tr_b16 a[64:65], v12 offset:0
v_cvt_pk_bf16_f32 v36, v36, v37
v_mfma_f32_16x16x32_bf16 v[56:59], a[100:103], v[144:147], v[56:59]
s_waitcnt lgkmcnt(11)
ds_read_b64_tr_b16 a[66:67], v12 offset:2048
v_cvt_pk_bf16_f32 v37, v38, v39
v_mfma_f32_16x16x32_bf16 v[56:59], a[104:107], v[160:163], v[56:59]
s_waitcnt lgkmcnt(10)
ds_read_b64_tr_b16 a[68:69], v12 offset:4096
v_cvt_pk_bf16_f32 v38, v44, v45
v_mfma_f32_16x16x32_bf16 v[56:59], a[108:111], v[176:179], v[56:59]
s_waitcnt lgkmcnt(9)
ds_read_b64_tr_b16 a[70:71], v12 offset:6144
v_cvt_pk_bf16_f32 v39, v46, v47
v_mfma_f32_16x16x32_bf16 v[56:59], a[112:115], v[192:195], v[56:59]
s_waitcnt lgkmcnt(8)
ds_read_b64_tr_b16 a[72:73], v12 offset:8192
buffer_store_dwordx4 v[36:39], v1, s[4:7], s12 offen offset:0 sc1
v_mfma_f32_16x16x32_bf16 v[56:59], a[116:119], v[208:211], v[56:59]
s_waitcnt lgkmcnt(7)
ds_read_b64_tr_b16 a[74:75], v12 offset:10240
v_mfma_f32_16x16x32_bf16 v[56:59], a[120:123], v[224:227], v[56:59]
s_waitcnt lgkmcnt(6)
ds_read_b64_tr_b16 a[76:77], v12 offset:12288
v_mfma_f32_16x16x32_bf16 v[56:59], a[124:127], v[240:243], v[56:59]
ds_read_b64_tr_b16 a[78:79], v12 offset:14336
v_mfma_f32_16x16x32_bf16 v[60:63], a[96:99], v[132:135], 0
ds_read_b64_tr_b16 a[80:81], v12 offset:16384
v_mfma_f32_16x16x32_bf16 v[60:63], a[100:103], v[148:151], v[60:63]
ds_read_b64_tr_b16 a[82:83], v12 offset:18432
v_mfma_f32_16x16x32_bf16 v[60:63], a[104:107], v[164:167], v[60:63]
ds_read_b64_tr_b16 a[84:85], v12 offset:20480
v_mfma_f32_16x16x32_bf16 v[60:63], a[108:111], v[180:183], v[60:63]
ds_read_b64_tr_b16 a[86:87], v12 offset:22528
v_mfma_f32_16x16x32_bf16 v[60:63], a[112:115], v[196:199], v[60:63]
ds_read_b64_tr_b16 a[88:89], v12 offset:24576
v_mfma_f32_16x16x32_bf16 v[60:63], a[116:119], v[212:215], v[60:63]
ds_read_b64_tr_b16 a[90:91], v12 offset:26624
v_mfma_f32_16x16x32_bf16 v[60:63], a[120:123], v[228:231], v[60:63]
ds_read_b64_tr_b16 a[92:93], v12 offset:28672
v_mfma_f32_16x16x32_bf16 v[60:63], a[124:127], v[244:247], v[60:63]
s_waitcnt lgkmcnt(13)
ds_read_b64_tr_b16 a[94:95], v12 offset:30720
v_add_u32 v12, 4294901760, v12
v_mfma_f32_16x16x32_bf16 v[64:67], a[64:67], v[128:131], 0
s_waitcnt lgkmcnt(12)
s_add_u32 m0, s18, 98304
ds_read_b64_tr_b16 a[96:97], v13 offset:0
v_mfma_f32_16x16x32_bf16 v[64:67], a[68:71], v[144:147], v[64:67]
s_waitcnt lgkmcnt(11)
ds_read_b64_tr_b16 a[98:99], v13 offset:2048
buffer_load_dwordx4 v8, s[36:39], s81 offen offset:0 lds
v_mfma_f32_16x16x32_bf16 v[64:67], a[72:75], v[160:163], v[64:67]
s_waitcnt lgkmcnt(10)
ds_read_b64_tr_b16 a[100:101], v13 offset:4096
v_mfma_f32_16x16x32_bf16 v[64:67], a[76:79], v[176:179], v[64:67]
s_waitcnt lgkmcnt(9)
ds_read_b64_tr_b16 a[102:103], v13 offset:6144
v_mfma_f32_16x16x32_bf16 v[64:67], a[80:83], v[192:195], v[64:67]
s_waitcnt lgkmcnt(8)
ds_read_b64_tr_b16 a[104:105], v13 offset:8192
v_cvt_pk_bf16_f32 v48, v48, v49
v_mfma_f32_16x16x32_bf16 v[64:67], a[84:87], v[208:211], v[64:67]
s_waitcnt lgkmcnt(7)
ds_read_b64_tr_b16 a[106:107], v13 offset:10240
v_cvt_pk_bf16_f32 v49, v50, v51
v_mfma_f32_16x16x32_bf16 v[64:67], a[88:91], v[224:227], v[64:67]
s_waitcnt lgkmcnt(6)
ds_read_b64_tr_b16 a[108:109], v13 offset:12288
v_cvt_pk_bf16_f32 v50, v56, v57
v_mfma_f32_16x16x32_bf16 v[64:67], a[92:95], v[240:243], v[64:67]
ds_read_b64_tr_b16 a[110:111], v13 offset:14336
v_cvt_pk_bf16_f32 v51, v58, v59
v_mfma_f32_16x16x32_bf16 v[68:71], a[64:67], v[132:135], 0
ds_read_b64_tr_b16 a[112:113], v13 offset:16384
buffer_store_dwordx4 v[48:51], v1, s[4:7], s8 offen offset:1024 sc1
v_mfma_f32_16x16x32_bf16 v[68:71], a[68:71], v[148:151], v[68:71]
ds_read_b64_tr_b16 a[114:115], v13 offset:18432
buffer_load_dwordx4 v9, s[36:39], s81 offen offset:1024 lds
v_mfma_f32_16x16x32_bf16 v[68:71], a[72:75], v[164:167], v[68:71]
ds_read_b64_tr_b16 a[116:117], v13 offset:20480
v_mfma_f32_16x16x32_bf16 v[68:71], a[76:79], v[180:183], v[68:71]
ds_read_b64_tr_b16 a[118:119], v13 offset:22528
v_mfma_f32_16x16x32_bf16 v[68:71], a[80:83], v[196:199], v[68:71]
ds_read_b64_tr_b16 a[120:121], v13 offset:24576
v_mfma_f32_16x16x32_bf16 v[68:71], a[84:87], v[212:215], v[68:71]
ds_read_b64_tr_b16 a[122:123], v13 offset:26624
buffer_load_dwordx4 v10, s[36:39], s81 offen offset:2048 lds
v_mfma_f32_16x16x32_bf16 v[68:71], a[88:91], v[228:231], v[68:71]
ds_read_b64_tr_b16 a[124:125], v13 offset:28672
v_mfma_f32_16x16x32_bf16 v[68:71], a[92:95], v[244:247], v[68:71]
s_waitcnt lgkmcnt(13)
ds_read_b64_tr_b16 a[126:127], v13 offset:30720
v_add_u32 v13, 4294901760, v13
v_mfma_f32_16x16x32_bf16 v[72:75], a[96:99], v[128:131], 0
s_waitcnt lgkmcnt(12)
ds_read_b64_tr_b16 a[64:65], v14 offset:0
v_cvt_pk_bf16_f32 v52, v52, v53
v_mfma_f32_16x16x32_bf16 v[72:75], a[100:103], v[144:147], v[72:75]
s_waitcnt lgkmcnt(11)
ds_read_b64_tr_b16 a[66:67], v14 offset:2048
v_cvt_pk_bf16_f32 v53, v54, v55
v_mfma_f32_16x16x32_bf16 v[72:75], a[104:107], v[160:163], v[72:75]
s_waitcnt lgkmcnt(10)
ds_read_b64_tr_b16 a[68:69], v14 offset:4096
v_cvt_pk_bf16_f32 v54, v60, v61
v_mfma_f32_16x16x32_bf16 v[72:75], a[108:111], v[176:179], v[72:75]
s_waitcnt lgkmcnt(9)
ds_read_b64_tr_b16 a[70:71], v14 offset:6144
v_cvt_pk_bf16_f32 v55, v62, v63
v_mfma_f32_16x16x32_bf16 v[72:75], a[112:115], v[192:195], v[72:75]
s_waitcnt lgkmcnt(8)
ds_read_b64_tr_b16 a[72:73], v14 offset:8192
buffer_store_dwordx4 v[52:55], v1, s[4:7], s12 offen offset:1024 sc1
v_mfma_f32_16x16x32_bf16 v[72:75], a[116:119], v[208:211], v[72:75]
s_waitcnt lgkmcnt(7)
ds_read_b64_tr_b16 a[74:75], v14 offset:10240
buffer_load_dwordx4 v11, s[36:39], s81 offen offset:3072 lds
v_mfma_f32_16x16x32_bf16 v[72:75], a[120:123], v[224:227], v[72:75]
s_waitcnt lgkmcnt(6)
ds_read_b64_tr_b16 a[76:77], v14 offset:12288
v_mfma_f32_16x16x32_bf16 v[72:75], a[124:127], v[240:243], v[72:75]
ds_read_b64_tr_b16 a[78:79], v14 offset:14336
v_mfma_f32_16x16x32_bf16 v[76:79], a[96:99], v[132:135], 0
s_add_u32 s81, s81, 28672
s_add_u32 m0, s18, 102400
ds_read_b64_tr_b16 a[80:81], v14 offset:16384
v_mfma_f32_16x16x32_bf16 v[76:79], a[100:103], v[148:151], v[76:79]
ds_read_b64_tr_b16 a[82:83], v14 offset:18432
buffer_load_dwordx4 v8, s[36:39], s81 offen offset:0 lds
v_mfma_f32_16x16x32_bf16 v[76:79], a[104:107], v[164:167], v[76:79]
ds_read_b64_tr_b16 a[84:85], v14 offset:20480
v_mfma_f32_16x16x32_bf16 v[76:79], a[108:111], v[180:183], v[76:79]
ds_read_b64_tr_b16 a[86:87], v14 offset:22528
v_mfma_f32_16x16x32_bf16 v[76:79], a[112:115], v[196:199], v[76:79]
ds_read_b64_tr_b16 a[88:89], v14 offset:24576
v_mfma_f32_16x16x32_bf16 v[76:79], a[116:119], v[212:215], v[76:79]
ds_read_b64_tr_b16 a[90:91], v14 offset:26624
buffer_load_dwordx4 v9, s[36:39], s81 offen offset:1024 lds
v_mfma_f32_16x16x32_bf16 v[76:79], a[120:123], v[228:231], v[76:79]
ds_read_b64_tr_b16 a[92:93], v14 offset:28672
v_mfma_f32_16x16x32_bf16 v[76:79], a[124:127], v[244:247], v[76:79]
s_waitcnt lgkmcnt(13)
ds_read_b64_tr_b16 a[94:95], v14 offset:30720
v_add_u32 v14, 4294901760, v14
v_mfma_f32_16x16x32_bf16 v[80:83], a[64:67], v[128:131], 0
s_waitcnt lgkmcnt(12)
ds_read_b64_tr_b16 a[96:97], v15 offset:0
v_mfma_f32_16x16x32_bf16 v[80:83], a[68:71], v[144:147], v[80:83]
s_waitcnt lgkmcnt(11)
ds_read_b64_tr_b16 a[98:99], v15 offset:2048
buffer_load_dwordx4 v10, s[36:39], s81 offen offset:2048 lds
v_mfma_f32_16x16x32_bf16 v[80:83], a[72:75], v[160:163], v[80:83]
s_waitcnt lgkmcnt(10)
ds_read_b64_tr_b16 a[100:101], v15 offset:4096
v_mfma_f32_16x16x32_bf16 v[80:83], a[76:79], v[176:179], v[80:83]
s_waitcnt lgkmcnt(9)
ds_read_b64_tr_b16 a[102:103], v15 offset:6144
v_mfma_f32_16x16x32_bf16 v[80:83], a[80:83], v[192:195], v[80:83]
s_waitcnt lgkmcnt(8)
ds_read_b64_tr_b16 a[104:105], v15 offset:8192
v_cvt_pk_bf16_f32 v64, v64, v65
v_mfma_f32_16x16x32_bf16 v[80:83], a[84:87], v[208:211], v[80:83]
s_waitcnt lgkmcnt(7)
ds_read_b64_tr_b16 a[106:107], v15 offset:10240
v_cvt_pk_bf16_f32 v65, v66, v67
v_mfma_f32_16x16x32_bf16 v[80:83], a[88:91], v[224:227], v[80:83]
s_waitcnt lgkmcnt(6)
ds_read_b64_tr_b16 a[108:109], v15 offset:12288
v_cvt_pk_bf16_f32 v66, v72, v73
v_mfma_f32_16x16x32_bf16 v[80:83], a[92:95], v[240:243], v[80:83]
ds_read_b64_tr_b16 a[110:111], v15 offset:14336
v_cvt_pk_bf16_f32 v67, v74, v75
v_mfma_f32_16x16x32_bf16 v[84:87], a[64:67], v[132:135], 0
ds_read_b64_tr_b16 a[112:113], v15 offset:16384
buffer_store_dwordx4 v[64:67], v1, s[4:7], s8 offen offset:2048 sc1
v_mfma_f32_16x16x32_bf16 v[84:87], a[68:71], v[148:151], v[84:87]
ds_read_b64_tr_b16 a[114:115], v15 offset:18432
buffer_load_dwordx4 v11, s[36:39], s81 offen offset:3072 lds
v_mfma_f32_16x16x32_bf16 v[84:87], a[72:75], v[164:167], v[84:87]
ds_read_b64_tr_b16 a[116:117], v15 offset:20480
v_mfma_f32_16x16x32_bf16 v[84:87], a[76:79], v[180:183], v[84:87]
ds_read_b64_tr_b16 a[118:119], v15 offset:22528
v_mfma_f32_16x16x32_bf16 v[84:87], a[80:83], v[196:199], v[84:87]
s_sub_u32 s81, s81, 28544
ds_read_b64_tr_b16 a[120:121], v15 offset:24576
v_mfma_f32_16x16x32_bf16 v[84:87], a[84:87], v[212:215], v[84:87]
ds_read_b64_tr_b16 a[122:123], v15 offset:26624
v_mfma_f32_16x16x32_bf16 v[84:87], a[88:91], v[228:231], v[84:87]
ds_read_b64_tr_b16 a[124:125], v15 offset:28672
ds_read_b64_tr_b16 a[126:127], v15 offset:30720
v_mfma_f32_16x16x32_bf16 v[84:87], a[92:95], v[244:247], v[84:87]
s_waitcnt vmcnt(24) lgkmcnt(14)
s_barrier
v_add_u32 v15, 4294901760, v15
v_mfma_f32_16x16x32_bf16 v[88:91], a[96:99], v[128:131], 0
s_waitcnt lgkmcnt(12)
ds_read_b64_tr_b16 a[64:65], v12 offset:0
v_cvt_pk_bf16_f32 v68, v68, v69
v_mfma_f32_16x16x32_bf16 v[88:91], a[100:103], v[144:147], v[88:91]
s_waitcnt lgkmcnt(11)
ds_read_b64_tr_b16 a[66:67], v12 offset:2048
v_cvt_pk_bf16_f32 v69, v70, v71
v_mfma_f32_16x16x32_bf16 v[88:91], a[104:107], v[160:163], v[88:91]
s_waitcnt lgkmcnt(10)
ds_read_b64_tr_b16 a[68:69], v12 offset:4096
v_cvt_pk_bf16_f32 v70, v76, v77
v_mfma_f32_16x16x32_bf16 v[88:91], a[108:111], v[176:179], v[88:91]
s_waitcnt lgkmcnt(9)
ds_read_b64_tr_b16 a[70:71], v12 offset:6144
v_cvt_pk_bf16_f32 v71, v78, v79
v_mfma_f32_16x16x32_bf16 v[88:91], a[112:115], v[192:195], v[88:91]
s_waitcnt lgkmcnt(8)
ds_read_b64_tr_b16 a[72:73], v12 offset:8192
buffer_store_dwordx4 v[68:71], v1, s[4:7], s12 offen offset:2048 sc1
v_mfma_f32_16x16x32_bf16 v[88:91], a[116:119], v[208:211], v[88:91]
s_waitcnt lgkmcnt(7)
ds_read_b64_tr_b16 a[74:75], v12 offset:10240
v_mfma_f32_16x16x32_bf16 v[88:91], a[120:123], v[224:227], v[88:91]
s_waitcnt lgkmcnt(6)
ds_read_b64_tr_b16 a[76:77], v12 offset:12288
v_mfma_f32_16x16x32_bf16 v[88:91], a[124:127], v[240:243], v[88:91]
ds_read_b64_tr_b16 a[78:79], v12 offset:14336
v_mfma_f32_16x16x32_bf16 v[92:95], a[96:99], v[132:135], 0
ds_read_b64_tr_b16 a[80:81], v12 offset:16384
v_mfma_f32_16x16x32_bf16 v[92:95], a[100:103], v[148:151], v[92:95]
ds_read_b64_tr_b16 a[82:83], v12 offset:18432
v_mfma_f32_16x16x32_bf16 v[92:95], a[104:107], v[164:167], v[92:95]
ds_read_b64_tr_b16 a[84:85], v12 offset:20480
v_mfma_f32_16x16x32_bf16 v[92:95], a[108:111], v[180:183], v[92:95]
ds_read_b64_tr_b16 a[86:87], v12 offset:22528
v_mfma_f32_16x16x32_bf16 v[92:95], a[112:115], v[196:199], v[92:95]
ds_read_b64_tr_b16 a[88:89], v12 offset:24576
v_mfma_f32_16x16x32_bf16 v[92:95], a[116:119], v[212:215], v[92:95]
ds_read_b64_tr_b16 a[90:91], v12 offset:26624
v_mfma_f32_16x16x32_bf16 v[92:95], a[120:123], v[228:231], v[92:95]
ds_read_b64_tr_b16 a[92:93], v12 offset:28672
v_mfma_f32_16x16x32_bf16 v[92:95], a[124:127], v[244:247], v[92:95]
s_waitcnt lgkmcnt(13)
ds_read_b64_tr_b16 a[94:95], v12 offset:30720
v_add_u32 v12, 131072, v12
v_mfma_f32_16x16x32_bf16 v[32:35], a[64:67], v[128:131], 0
s_waitcnt lgkmcnt(12)
ds_read_b64_tr_b16 a[96:97], v13 offset:0
v_mfma_f32_16x16x32_bf16 v[32:35], a[68:71], v[144:147], v[32:35]
s_waitcnt lgkmcnt(11)
ds_read_b64_tr_b16 a[98:99], v13 offset:2048
v_mfma_f32_16x16x32_bf16 v[32:35], a[72:75], v[160:163], v[32:35]
s_waitcnt lgkmcnt(10)
ds_read_b64_tr_b16 a[100:101], v13 offset:4096
v_mfma_f32_16x16x32_bf16 v[32:35], a[76:79], v[176:179], v[32:35]
s_waitcnt lgkmcnt(9)
ds_read_b64_tr_b16 a[102:103], v13 offset:6144
v_mfma_f32_16x16x32_bf16 v[32:35], a[80:83], v[192:195], v[32:35]
s_waitcnt lgkmcnt(8)
ds_read_b64_tr_b16 a[104:105], v13 offset:8192
v_cvt_pk_bf16_f32 v80, v80, v81
v_mfma_f32_16x16x32_bf16 v[32:35], a[84:87], v[208:211], v[32:35]
s_waitcnt lgkmcnt(7)
ds_read_b64_tr_b16 a[106:107], v13 offset:10240
v_cvt_pk_bf16_f32 v81, v82, v83
v_mfma_f32_16x16x32_bf16 v[32:35], a[88:91], v[224:227], v[32:35]
s_waitcnt lgkmcnt(6)
ds_read_b64_tr_b16 a[108:109], v13 offset:12288
v_cvt_pk_bf16_f32 v82, v88, v89
v_mfma_f32_16x16x32_bf16 v[32:35], a[92:95], v[240:243], v[32:35]
ds_read_b64_tr_b16 a[110:111], v13 offset:14336
v_cvt_pk_bf16_f32 v83, v90, v91
v_mfma_f32_16x16x32_bf16 v[36:39], a[64:67], v[132:135], 0
ds_read_b64_tr_b16 a[112:113], v13 offset:16384
buffer_store_dwordx4 v[80:83], v1, s[4:7], s8 offen offset:3072 sc1
v_mfma_f32_16x16x32_bf16 v[36:39], a[68:71], v[148:151], v[36:39]
ds_read_b64_tr_b16 a[114:115], v13 offset:18432
v_mfma_f32_16x16x32_bf16 v[36:39], a[72:75], v[164:167], v[36:39]
ds_read_b64_tr_b16 a[116:117], v13 offset:20480
v_mfma_f32_16x16x32_bf16 v[36:39], a[76:79], v[180:183], v[36:39]
ds_read_b64_tr_b16 a[118:119], v13 offset:22528
v_mfma_f32_16x16x32_bf16 v[36:39], a[80:83], v[196:199], v[36:39]
ds_read_b64_tr_b16 a[120:121], v13 offset:24576
v_mfma_f32_16x16x32_bf16 v[36:39], a[84:87], v[212:215], v[36:39]
ds_read_b64_tr_b16 a[122:123], v13 offset:26624
v_mfma_f32_16x16x32_bf16 v[36:39], a[88:91], v[228:231], v[36:39]
ds_read_b64_tr_b16 a[124:125], v13 offset:28672
v_mfma_f32_16x16x32_bf16 v[36:39], a[92:95], v[244:247], v[36:39]
s_waitcnt lgkmcnt(13)
ds_read_b64_tr_b16 a[126:127], v13 offset:30720
v_add_u32 v13, 131072, v13
v_mfma_f32_16x16x32_bf16 v[40:43], a[96:99], v[128:131], 0
s_waitcnt lgkmcnt(12)
ds_read_b64_tr_b16 a[64:65], v14 offset:0
v_cvt_pk_bf16_f32 v84, v84, v85
v_mfma_f32_16x16x32_bf16 v[40:43], a[100:103], v[144:147], v[40:43]
s_waitcnt lgkmcnt(11)
ds_read_b64_tr_b16 a[66:67], v14 offset:2048
v_cvt_pk_bf16_f32 v85, v86, v87
v_mfma_f32_16x16x32_bf16 v[40:43], a[104:107], v[160:163], v[40:43]
s_waitcnt lgkmcnt(10)
ds_read_b64_tr_b16 a[68:69], v14 offset:4096
v_cvt_pk_bf16_f32 v86, v92, v93
v_mfma_f32_16x16x32_bf16 v[40:43], a[108:111], v[176:179], v[40:43]
s_waitcnt lgkmcnt(9)
ds_read_b64_tr_b16 a[70:71], v14 offset:6144
v_cvt_pk_bf16_f32 v87, v94, v95
v_mfma_f32_16x16x32_bf16 v[40:43], a[112:115], v[192:195], v[40:43]
s_waitcnt lgkmcnt(8)
ds_read_b64_tr_b16 a[72:73], v14 offset:8192
buffer_store_dwordx4 v[84:87], v1, s[4:7], s12 offen offset:3072 sc1
v_mfma_f32_16x16x32_bf16 v[40:43], a[116:119], v[208:211], v[40:43]
s_waitcnt lgkmcnt(7)
ds_read_b64_tr_b16 a[74:75], v14 offset:10240
v_mfma_f32_16x16x32_bf16 v[40:43], a[120:123], v[224:227], v[40:43]
s_waitcnt lgkmcnt(6)
ds_read_b64_tr_b16 a[76:77], v14 offset:12288
v_mfma_f32_16x16x32_bf16 v[40:43], a[124:127], v[240:243], v[40:43]
ds_read_b64_tr_b16 a[78:79], v14 offset:14336
v_mfma_f32_16x16x32_bf16 v[44:47], a[96:99], v[132:135], 0
ds_read_b64_tr_b16 a[80:81], v14 offset:16384
v_mfma_f32_16x16x32_bf16 v[44:47], a[100:103], v[148:151], v[44:47]
ds_read_b64_tr_b16 a[82:83], v14 offset:18432
v_mfma_f32_16x16x32_bf16 v[44:47], a[104:107], v[164:167], v[44:47]
ds_read_b64_tr_b16 a[84:85], v14 offset:20480
v_mfma_f32_16x16x32_bf16 v[44:47], a[108:111], v[180:183], v[44:47]
ds_read_b64_tr_b16 a[86:87], v14 offset:22528
v_mfma_f32_16x16x32_bf16 v[44:47], a[112:115], v[196:199], v[44:47]
s_add_u32 s8, s8, 4096
s_add_u32 s12, s12, 4096
ds_read_b64_tr_b16 a[88:89], v14 offset:24576
v_mfma_f32_16x16x32_bf16 v[44:47], a[116:119], v[212:215], v[44:47]
ds_read_b64_tr_b16 a[90:91], v14 offset:26624
v_mfma_f32_16x16x32_bf16 v[44:47], a[120:123], v[228:231], v[44:47]
ds_read_b64_tr_b16 a[92:93], v14 offset:28672
v_mfma_f32_16x16x32_bf16 v[44:47], a[124:127], v[244:247], v[44:47]
s_waitcnt lgkmcnt(13)
ds_read_b64_tr_b16 a[94:95], v14 offset:30720
v_add_u32 v14, 131072, v14
v_mfma_f32_16x16x32_bf16 v[48:51], a[64:67], v[128:131], 0
s_waitcnt lgkmcnt(12)
ds_read_b64_tr_b16 a[96:97], v15 offset:0
v_mfma_f32_16x16x32_bf16 v[48:51], a[68:71], v[144:147], v[48:51]
s_waitcnt lgkmcnt(11)
ds_read_b64_tr_b16 a[98:99], v15 offset:2048
v_mfma_f32_16x16x32_bf16 v[48:51], a[72:75], v[160:163], v[48:51]
s_waitcnt lgkmcnt(10)
ds_read_b64_tr_b16 a[100:101], v15 offset:4096
v_mfma_f32_16x16x32_bf16 v[48:51], a[76:79], v[176:179], v[48:51]
s_waitcnt lgkmcnt(9)
ds_read_b64_tr_b16 a[102:103], v15 offset:6144
v_mfma_f32_16x16x32_bf16 v[48:51], a[80:83], v[192:195], v[48:51]
s_waitcnt lgkmcnt(8)
ds_read_b64_tr_b16 a[104:105], v15 offset:8192
v_cvt_pk_bf16_f32 v32, v32, v33
v_mfma_f32_16x16x32_bf16 v[48:51], a[84:87], v[208:211], v[48:51]
s_waitcnt lgkmcnt(7)
ds_read_b64_tr_b16 a[106:107], v15 offset:10240
v_cvt_pk_bf16_f32 v33, v34, v35
v_mfma_f32_16x16x32_bf16 v[48:51], a[88:91], v[224:227], v[48:51]
s_waitcnt lgkmcnt(6)
ds_read_b64_tr_b16 a[108:109], v15 offset:12288
v_cvt_pk_bf16_f32 v34, v40, v41
v_mfma_f32_16x16x32_bf16 v[48:51], a[92:95], v[240:243], v[48:51]
ds_read_b64_tr_b16 a[110:111], v15 offset:14336
v_cvt_pk_bf16_f32 v35, v42, v43
v_mfma_f32_16x16x32_bf16 v[52:55], a[64:67], v[132:135], 0
ds_read_b64_tr_b16 a[112:113], v15 offset:16384
buffer_store_dwordx4 v[32:35], v1, s[4:7], s8 offen offset:0 sc1
v_mfma_f32_16x16x32_bf16 v[52:55], a[68:71], v[148:151], v[52:55]
ds_read_b64_tr_b16 a[114:115], v15 offset:18432
v_mfma_f32_16x16x32_bf16 v[52:55], a[72:75], v[164:167], v[52:55]
ds_read_b64_tr_b16 a[116:117], v15 offset:20480
v_mfma_f32_16x16x32_bf16 v[52:55], a[76:79], v[180:183], v[52:55]
ds_read_b64_tr_b16 a[118:119], v15 offset:22528
v_mfma_f32_16x16x32_bf16 v[52:55], a[80:83], v[196:199], v[52:55]
ds_read_b64_tr_b16 a[120:121], v15 offset:24576
v_mfma_f32_16x16x32_bf16 v[52:55], a[84:87], v[212:215], v[52:55]
ds_read_b64_tr_b16 a[122:123], v15 offset:26624
v_mfma_f32_16x16x32_bf16 v[52:55], a[88:91], v[228:231], v[52:55]
ds_read_b64_tr_b16 a[124:125], v15 offset:28672
ds_read_b64_tr_b16 a[126:127], v15 offset:30720
v_mfma_f32_16x16x32_bf16 v[52:55], a[92:95], v[244:247], v[52:55]
s_waitcnt vmcnt(3) lgkmcnt(14)
s_barrier
v_add_u32 v15, 131072, v15
v_mfma_f32_16x16x32_bf16 v[56:59], a[96:99], v[128:131], 0
s_waitcnt lgkmcnt(12)
ds_read_b64_tr_b16 a[64:65], v12 offset:0
v_cvt_pk_bf16_f32 v36, v36, v37
v_mfma_f32_16x16x32_bf16 v[56:59], a[100:103], v[144:147], v[56:59]
s_waitcnt lgkmcnt(11)
ds_read_b64_tr_b16 a[66:67], v12 offset:2048
buffer_store_dword v6, v5, s[4:7], s34 offen sc1
v_mfma_f32_16x16x32_bf16 v[56:59], a[104:107], v[160:163], v[56:59]
s_waitcnt lgkmcnt(10)
ds_read_b64_tr_b16 a[68:69], v12 offset:4096
v_cvt_pk_bf16_f32 v37, v38, v39
v_mfma_f32_16x16x32_bf16 v[56:59], a[108:111], v[176:179], v[56:59]
s_waitcnt lgkmcnt(9)
ds_read_b64_tr_b16 a[70:71], v12 offset:6144
v_cvt_pk_bf16_f32 v38, v44, v45
v_mfma_f32_16x16x32_bf16 v[56:59], a[112:115], v[192:195], v[56:59]
s_waitcnt lgkmcnt(8)
ds_read_b64_tr_b16 a[72:73], v12 offset:8192
v_cvt_pk_bf16_f32 v39, v46, v47
v_mfma_f32_16x16x32_bf16 v[56:59], a[116:119], v[208:211], v[56:59]
s_waitcnt lgkmcnt(7)
ds_read_b64_tr_b16 a[74:75], v12 offset:10240
buffer_store_dwordx4 v[36:39], v1, s[4:7], s12 offen offset:0 sc1
v_mfma_f32_16x16x32_bf16 v[56:59], a[120:123], v[224:227], v[56:59]
s_waitcnt lgkmcnt(6)
ds_read_b64_tr_b16 a[76:77], v12 offset:12288
v_mfma_f32_16x16x32_bf16 v[56:59], a[124:127], v[240:243], v[56:59]
ds_read_b64_tr_b16 a[78:79], v12 offset:14336
v_mfma_f32_16x16x32_bf16 v[60:63], a[96:99], v[132:135], 0
ds_read_b64_tr_b16 a[80:81], v12 offset:16384
v_mfma_f32_16x16x32_bf16 v[60:63], a[100:103], v[148:151], v[60:63]
ds_read_b64_tr_b16 a[82:83], v12 offset:18432
v_mfma_f32_16x16x32_bf16 v[60:63], a[104:107], v[164:167], v[60:63]
ds_read_b64_tr_b16 a[84:85], v12 offset:20480
v_mfma_f32_16x16x32_bf16 v[60:63], a[108:111], v[180:183], v[60:63]
ds_read_b64_tr_b16 a[86:87], v12 offset:22528
v_mfma_f32_16x16x32_bf16 v[60:63], a[112:115], v[196:199], v[60:63]
ds_read_b64_tr_b16 a[88:89], v12 offset:24576
v_mfma_f32_16x16x32_bf16 v[60:63], a[116:119], v[212:215], v[60:63]
ds_read_b64_tr_b16 a[90:91], v12 offset:26624
v_mfma_f32_16x16x32_bf16 v[60:63], a[120:123], v[228:231], v[60:63]
ds_read_b64_tr_b16 a[92:93], v12 offset:28672
v_mfma_f32_16x16x32_bf16 v[60:63], a[124:127], v[244:247], v[60:63]
s_waitcnt lgkmcnt(13)
ds_read_b64_tr_b16 a[94:95], v12 offset:30720
v_add_u32 v12, 4294934528, v12
v_mfma_f32_16x16x32_bf16 v[64:67], a[64:67], v[128:131], 0
s_waitcnt lgkmcnt(12)
ds_read_b64_tr_b16 a[96:97], v13 offset:0
v_mfma_f32_16x16x32_bf16 v[64:67], a[68:71], v[144:147], v[64:67]
s_waitcnt lgkmcnt(11)
ds_read_b64_tr_b16 a[98:99], v13 offset:2048
v_mfma_f32_16x16x32_bf16 v[64:67], a[72:75], v[160:163], v[64:67]
s_waitcnt lgkmcnt(10)
ds_read_b64_tr_b16 a[100:101], v13 offset:4096
v_mfma_f32_16x16x32_bf16 v[64:67], a[76:79], v[176:179], v[64:67]
s_waitcnt lgkmcnt(9)
ds_read_b64_tr_b16 a[102:103], v13 offset:6144
v_mfma_f32_16x16x32_bf16 v[64:67], a[80:83], v[192:195], v[64:67]
s_waitcnt lgkmcnt(8)
ds_read_b64_tr_b16 a[104:105], v13 offset:8192
v_cvt_pk_bf16_f32 v48, v48, v49
v_mfma_f32_16x16x32_bf16 v[64:67], a[84:87], v[208:211], v[64:67]
s_waitcnt lgkmcnt(7)
ds_read_b64_tr_b16 a[106:107], v13 offset:10240
v_cvt_pk_bf16_f32 v49, v50, v51
v_mfma_f32_16x16x32_bf16 v[64:67], a[88:91], v[224:227], v[64:67]
s_waitcnt lgkmcnt(6)
ds_read_b64_tr_b16 a[108:109], v13 offset:12288
v_cvt_pk_bf16_f32 v50, v56, v57
v_mfma_f32_16x16x32_bf16 v[64:67], a[92:95], v[240:243], v[64:67]
ds_read_b64_tr_b16 a[110:111], v13 offset:14336
v_cvt_pk_bf16_f32 v51, v58, v59
v_mfma_f32_16x16x32_bf16 v[68:71], a[64:67], v[132:135], 0
ds_read_b64_tr_b16 a[112:113], v13 offset:16384
buffer_store_dwordx4 v[48:51], v1, s[4:7], s8 offen offset:1024 sc1
v_mfma_f32_16x16x32_bf16 v[68:71], a[68:71], v[148:151], v[68:71]
ds_read_b64_tr_b16 a[114:115], v13 offset:18432
v_mfma_f32_16x16x32_bf16 v[68:71], a[72:75], v[164:167], v[68:71]
ds_read_b64_tr_b16 a[116:117], v13 offset:20480
v_mfma_f32_16x16x32_bf16 v[68:71], a[76:79], v[180:183], v[68:71]
ds_read_b64_tr_b16 a[118:119], v13 offset:22528
v_mfma_f32_16x16x32_bf16 v[68:71], a[80:83], v[196:199], v[68:71]
ds_read_b64_tr_b16 a[120:121], v13 offset:24576
v_mfma_f32_16x16x32_bf16 v[68:71], a[84:87], v[212:215], v[68:71]
ds_read_b64_tr_b16 a[122:123], v13 offset:26624
v_mfma_f32_16x16x32_bf16 v[68:71], a[88:91], v[228:231], v[68:71]
ds_read_b64_tr_b16 a[124:125], v13 offset:28672
v_mfma_f32_16x16x32_bf16 v[68:71], a[92:95], v[244:247], v[68:71]
s_waitcnt lgkmcnt(13)
ds_read_b64_tr_b16 a[126:127], v13 offset:30720
v_add_u32 v13, 4294934528, v13
v_mfma_f32_16x16x32_bf16 v[72:75], a[96:99], v[128:131], 0
s_waitcnt lgkmcnt(12)
ds_read_b64_tr_b16 a[64:65], v14 offset:0
v_cvt_pk_bf16_f32 v52, v52, v53
v_mfma_f32_16x16x32_bf16 v[72:75], a[100:103], v[144:147], v[72:75]
s_waitcnt lgkmcnt(11)
ds_read_b64_tr_b16 a[66:67], v14 offset:2048
v_cvt_pk_bf16_f32 v53, v54, v55
v_mfma_f32_16x16x32_bf16 v[72:75], a[104:107], v[160:163], v[72:75]
s_waitcnt lgkmcnt(10)
ds_read_b64_tr_b16 a[68:69], v14 offset:4096
v_cvt_pk_bf16_f32 v54, v60, v61
v_mfma_f32_16x16x32_bf16 v[72:75], a[108:111], v[176:179], v[72:75]
s_waitcnt lgkmcnt(9)
ds_read_b64_tr_b16 a[70:71], v14 offset:6144
v_cvt_pk_bf16_f32 v55, v62, v63
v_mfma_f32_16x16x32_bf16 v[72:75], a[112:115], v[192:195], v[72:75]
s_waitcnt lgkmcnt(8)
ds_read_b64_tr_b16 a[72:73], v14 offset:8192
buffer_store_dwordx4 v[52:55], v1, s[4:7], s12 offen offset:1024 sc1
v_mfma_f32_16x16x32_bf16 v[72:75], a[116:119], v[208:211], v[72:75]
s_waitcnt lgkmcnt(7)
ds_read_b64_tr_b16 a[74:75], v14 offset:10240
v_mfma_f32_16x16x32_bf16 v[72:75], a[120:123], v[224:227], v[72:75]
s_waitcnt lgkmcnt(6)
ds_read_b64_tr_b16 a[76:77], v14 offset:12288
v_mfma_f32_16x16x32_bf16 v[72:75], a[124:127], v[240:243], v[72:75]
ds_read_b64_tr_b16 a[78:79], v14 offset:14336
v_mfma_f32_16x16x32_bf16 v[76:79], a[96:99], v[132:135], 0
ds_read_b64_tr_b16 a[80:81], v14 offset:16384
v_mfma_f32_16x16x32_bf16 v[76:79], a[100:103], v[148:151], v[76:79]
ds_read_b64_tr_b16 a[82:83], v14 offset:18432
v_mfma_f32_16x16x32_bf16 v[76:79], a[104:107], v[164:167], v[76:79]
ds_read_b64_tr_b16 a[84:85], v14 offset:20480
v_mfma_f32_16x16x32_bf16 v[76:79], a[108:111], v[180:183], v[76:79]
ds_read_b64_tr_b16 a[86:87], v14 offset:22528
v_mfma_f32_16x16x32_bf16 v[76:79], a[112:115], v[196:199], v[76:79]
ds_read_b64_tr_b16 a[88:89], v14 offset:24576
v_mfma_f32_16x16x32_bf16 v[76:79], a[116:119], v[212:215], v[76:79]
ds_read_b64_tr_b16 a[90:91], v14 offset:26624
v_mfma_f32_16x16x32_bf16 v[76:79], a[120:123], v[228:231], v[76:79]
ds_read_b64_tr_b16 a[92:93], v14 offset:28672
v_mfma_f32_16x16x32_bf16 v[76:79], a[124:127], v[244:247], v[76:79]
s_waitcnt lgkmcnt(13)
ds_read_b64_tr_b16 a[94:95], v14 offset:30720
v_add_u32 v14, 4294934528, v14
v_mfma_f32_16x16x32_bf16 v[80:83], a[64:67], v[128:131], 0
s_waitcnt lgkmcnt(12)
ds_read_b64_tr_b16 a[96:97], v15 offset:0
v_mfma_f32_16x16x32_bf16 v[80:83], a[68:71], v[144:147], v[80:83]
s_waitcnt lgkmcnt(11)
ds_read_b64_tr_b16 a[98:99], v15 offset:2048
v_mfma_f32_16x16x32_bf16 v[80:83], a[72:75], v[160:163], v[80:83]
s_waitcnt lgkmcnt(10)
ds_read_b64_tr_b16 a[100:101], v15 offset:4096
v_mfma_f32_16x16x32_bf16 v[80:83], a[76:79], v[176:179], v[80:83]
s_waitcnt lgkmcnt(9)
ds_read_b64_tr_b16 a[102:103], v15 offset:6144
v_mfma_f32_16x16x32_bf16 v[80:83], a[80:83], v[192:195], v[80:83]
s_waitcnt lgkmcnt(8)
ds_read_b64_tr_b16 a[104:105], v15 offset:8192
v_cvt_pk_bf16_f32 v64, v64, v65
v_mfma_f32_16x16x32_bf16 v[80:83], a[84:87], v[208:211], v[80:83]
s_waitcnt lgkmcnt(7)
ds_read_b64_tr_b16 a[106:107], v15 offset:10240
v_cvt_pk_bf16_f32 v65, v66, v67
v_mfma_f32_16x16x32_bf16 v[80:83], a[88:91], v[224:227], v[80:83]
s_waitcnt lgkmcnt(6)
ds_read_b64_tr_b16 a[108:109], v15 offset:12288
v_cvt_pk_bf16_f32 v66, v72, v73
v_mfma_f32_16x16x32_bf16 v[80:83], a[92:95], v[240:243], v[80:83]
ds_read_b64_tr_b16 a[110:111], v15 offset:14336
v_cvt_pk_bf16_f32 v67, v74, v75
v_mfma_f32_16x16x32_bf16 v[84:87], a[64:67], v[132:135], 0
ds_read_b64_tr_b16 a[112:113], v15 offset:16384
buffer_store_dwordx4 v[64:67], v1, s[4:7], s8 offen offset:2048 sc1
v_mfma_f32_16x16x32_bf16 v[84:87], a[68:71], v[148:151], v[84:87]
ds_read_b64_tr_b16 a[114:115], v15 offset:18432
v_mfma_f32_16x16x32_bf16 v[84:87], a[72:75], v[164:167], v[84:87]
ds_read_b64_tr_b16 a[116:117], v15 offset:20480
v_mfma_f32_16x16x32_bf16 v[84:87], a[76:79], v[180:183], v[84:87]
ds_read_b64_tr_b16 a[118:119], v15 offset:22528
v_mfma_f32_16x16x32_bf16 v[84:87], a[80:83], v[196:199], v[84:87]
ds_read_b64_tr_b16 a[120:121], v15 offset:24576
v_mfma_f32_16x16x32_bf16 v[84:87], a[84:87], v[212:215], v[84:87]
ds_read_b64_tr_b16 a[122:123], v15 offset:26624
v_mfma_f32_16x16x32_bf16 v[84:87], a[88:91], v[228:231], v[84:87]
ds_read_b64_tr_b16 a[124:125], v15 offset:28672
ds_read_b64_tr_b16 a[126:127], v15 offset:30720
v_mfma_f32_16x16x32_bf16 v[84:87], a[92:95], v[244:247], v[84:87]
s_waitcnt vmcnt(9) lgkmcnt(14)
s_barrier
v_add_u32 v15, 4294934528, v15
v_mfma_f32_16x16x32_bf16 v[88:91], a[96:99], v[128:131], 0
s_waitcnt lgkmcnt(12)
ds_read_b64_tr_b16 a[64:65], v12 offset:0
v_cvt_pk_bf16_f32 v68, v68, v69
v_mfma_f32_16x16x32_bf16 v[88:91], a[100:103], v[144:147], v[88:91]
s_waitcnt lgkmcnt(11)
ds_read_b64_tr_b16 a[66:67], v12 offset:2048
v_cvt_pk_bf16_f32 v69, v70, v71
v_mfma_f32_16x16x32_bf16 v[88:91], a[104:107], v[160:163], v[88:91]
s_waitcnt lgkmcnt(10)
ds_read_b64_tr_b16 a[68:69], v12 offset:4096
v_cvt_pk_bf16_f32 v70, v76, v77
v_mfma_f32_16x16x32_bf16 v[88:91], a[108:111], v[176:179], v[88:91]
s_waitcnt lgkmcnt(9)
ds_read_b64_tr_b16 a[70:71], v12 offset:6144
v_cvt_pk_bf16_f32 v71, v78, v79
v_mfma_f32_16x16x32_bf16 v[88:91], a[112:115], v[192:195], v[88:91]
s_waitcnt lgkmcnt(8)
ds_read_b64_tr_b16 a[72:73], v12 offset:8192
buffer_store_dwordx4 v[68:71], v1, s[4:7], s12 offen offset:2048 sc1
v_mfma_f32_16x16x32_bf16 v[88:91], a[116:119], v[208:211], v[88:91]
s_waitcnt lgkmcnt(7)
ds_read_b64_tr_b16 a[74:75], v12 offset:10240
v_mfma_f32_16x16x32_bf16 v[88:91], a[120:123], v[224:227], v[88:91]
s_waitcnt lgkmcnt(6)
ds_read_b64_tr_b16 a[76:77], v12 offset:12288
v_mfma_f32_16x16x32_bf16 v[88:91], a[124:127], v[240:243], v[88:91]
ds_read_b64_tr_b16 a[78:79], v12 offset:14336
v_mfma_f32_16x16x32_bf16 v[92:95], a[96:99], v[132:135], 0
ds_read_b64_tr_b16 a[80:81], v12 offset:16384
v_mfma_f32_16x16x32_bf16 v[92:95], a[100:103], v[148:151], v[92:95]
ds_read_b64_tr_b16 a[82:83], v12 offset:18432
v_mfma_f32_16x16x32_bf16 v[92:95], a[104:107], v[164:167], v[92:95]
ds_read_b64_tr_b16 a[84:85], v12 offset:20480
v_mfma_f32_16x16x32_bf16 v[92:95], a[108:111], v[180:183], v[92:95]
ds_read_b64_tr_b16 a[86:87], v12 offset:22528
v_mfma_f32_16x16x32_bf16 v[92:95], a[112:115], v[196:199], v[92:95]
ds_read_b64_tr_b16 a[88:89], v12 offset:24576
v_mfma_f32_16x16x32_bf16 v[92:95], a[116:119], v[212:215], v[92:95]
ds_read_b64_tr_b16 a[90:91], v12 offset:26624
v_mfma_f32_16x16x32_bf16 v[92:95], a[120:123], v[228:231], v[92:95]
ds_read_b64_tr_b16 a[92:93], v12 offset:28672
v_mfma_f32_16x16x32_bf16 v[92:95], a[124:127], v[244:247], v[92:95]
s_waitcnt lgkmcnt(13)
ds_read_b64_tr_b16 a[94:95], v12 offset:30720
v_mfma_f32_16x16x32_bf16 v[32:35], a[64:67], v[128:131], 0
s_waitcnt lgkmcnt(12)
ds_read_b64_tr_b16 a[96:97], v13 offset:0
v_mfma_f32_16x16x32_bf16 v[32:35], a[68:71], v[144:147], v[32:35]
s_waitcnt lgkmcnt(11)
ds_read_b64_tr_b16 a[98:99], v13 offset:2048
v_mfma_f32_16x16x32_bf16 v[32:35], a[72:75], v[160:163], v[32:35]
s_waitcnt lgkmcnt(10)
ds_read_b64_tr_b16 a[100:101], v13 offset:4096
v_mfma_f32_16x16x32_bf16 v[32:35], a[76:79], v[176:179], v[32:35]
s_waitcnt lgkmcnt(9)
ds_read_b64_tr_b16 a[102:103], v13 offset:6144
v_mfma_f32_16x16x32_bf16 v[32:35], a[80:83], v[192:195], v[32:35]
s_waitcnt lgkmcnt(8)
ds_read_b64_tr_b16 a[104:105], v13 offset:8192
v_cvt_pk_bf16_f32 v80, v80, v81
v_mfma_f32_16x16x32_bf16 v[32:35], a[84:87], v[208:211], v[32:35]
s_waitcnt lgkmcnt(7)
ds_read_b64_tr_b16 a[106:107], v13 offset:10240
v_cvt_pk_bf16_f32 v81, v82, v83
v_mfma_f32_16x16x32_bf16 v[32:35], a[88:91], v[224:227], v[32:35]
s_waitcnt lgkmcnt(6)
ds_read_b64_tr_b16 a[108:109], v13 offset:12288
v_cvt_pk_bf16_f32 v82, v88, v89
v_mfma_f32_16x16x32_bf16 v[32:35], a[92:95], v[240:243], v[32:35]
ds_read_b64_tr_b16 a[110:111], v13 offset:14336
v_cvt_pk_bf16_f32 v83, v90, v91
v_mfma_f32_16x16x32_bf16 v[36:39], a[64:67], v[132:135], 0
ds_read_b64_tr_b16 a[112:113], v13 offset:16384
buffer_store_dwordx4 v[80:83], v1, s[4:7], s8 offen offset:3072 sc1
v_mfma_f32_16x16x32_bf16 v[36:39], a[68:71], v[148:151], v[36:39]
ds_read_b64_tr_b16 a[114:115], v13 offset:18432
v_mfma_f32_16x16x32_bf16 v[36:39], a[72:75], v[164:167], v[36:39]
ds_read_b64_tr_b16 a[116:117], v13 offset:20480
v_mfma_f32_16x16x32_bf16 v[36:39], a[76:79], v[180:183], v[36:39]
ds_read_b64_tr_b16 a[118:119], v13 offset:22528
v_mfma_f32_16x16x32_bf16 v[36:39], a[80:83], v[196:199], v[36:39]
ds_read_b64_tr_b16 a[120:121], v13 offset:24576
v_mfma_f32_16x16x32_bf16 v[36:39], a[84:87], v[212:215], v[36:39]
ds_read_b64_tr_b16 a[122:123], v13 offset:26624
v_mfma_f32_16x16x32_bf16 v[36:39], a[88:91], v[228:231], v[36:39]
ds_read_b64_tr_b16 a[124:125], v13 offset:28672
v_mfma_f32_16x16x32_bf16 v[36:39], a[92:95], v[244:247], v[36:39]
s_waitcnt lgkmcnt(13)
ds_read_b64_tr_b16 a[126:127], v13 offset:30720
v_mfma_f32_16x16x32_bf16 v[40:43], a[96:99], v[128:131], 0
s_waitcnt lgkmcnt(12)
ds_read_b64_tr_b16 a[64:65], v14 offset:0
v_cvt_pk_bf16_f32 v84, v84, v85
v_mfma_f32_16x16x32_bf16 v[40:43], a[100:103], v[144:147], v[40:43]
s_waitcnt lgkmcnt(11)
ds_read_b64_tr_b16 a[66:67], v14 offset:2048
v_cvt_pk_bf16_f32 v85, v86, v87
v_mfma_f32_16x16x32_bf16 v[40:43], a[104:107], v[160:163], v[40:43]
s_waitcnt lgkmcnt(10)
ds_read_b64_tr_b16 a[68:69], v14 offset:4096
v_cvt_pk_bf16_f32 v86, v92, v93
v_mfma_f32_16x16x32_bf16 v[40:43], a[108:111], v[176:179], v[40:43]
s_waitcnt lgkmcnt(9)
ds_read_b64_tr_b16 a[70:71], v14 offset:6144
v_cvt_pk_bf16_f32 v87, v94, v95
v_mfma_f32_16x16x32_bf16 v[40:43], a[112:115], v[192:195], v[40:43]
s_waitcnt lgkmcnt(8)
ds_read_b64_tr_b16 a[72:73], v14 offset:8192
buffer_store_dwordx4 v[84:87], v1, s[4:7], s12 offen offset:3072 sc1
v_mfma_f32_16x16x32_bf16 v[40:43], a[116:119], v[208:211], v[40:43]
s_waitcnt lgkmcnt(7)
ds_read_b64_tr_b16 a[74:75], v14 offset:10240
v_mfma_f32_16x16x32_bf16 v[40:43], a[120:123], v[224:227], v[40:43]
s_waitcnt lgkmcnt(6)
ds_read_b64_tr_b16 a[76:77], v14 offset:12288
v_mfma_f32_16x16x32_bf16 v[40:43], a[124:127], v[240:243], v[40:43]
ds_read_b64_tr_b16 a[78:79], v14 offset:14336
v_mfma_f32_16x16x32_bf16 v[44:47], a[96:99], v[132:135], 0
ds_read_b64_tr_b16 a[80:81], v14 offset:16384
v_mfma_f32_16x16x32_bf16 v[44:47], a[100:103], v[148:151], v[44:47]
ds_read_b64_tr_b16 a[82:83], v14 offset:18432
v_mfma_f32_16x16x32_bf16 v[44:47], a[104:107], v[164:167], v[44:47]
ds_read_b64_tr_b16 a[84:85], v14 offset:20480
v_mfma_f32_16x16x32_bf16 v[44:47], a[108:111], v[180:183], v[44:47]
ds_read_b64_tr_b16 a[86:87], v14 offset:22528
v_mfma_f32_16x16x32_bf16 v[44:47], a[112:115], v[196:199], v[44:47]
s_add_u32 s8, s8, 4096
s_add_u32 s12, s12, 4096
ds_read_b64_tr_b16 a[88:89], v14 offset:24576
buffer_load_dword v18, v19, s[4:7], s33 offen offset:0 sc1
v_mfma_f32_16x16x32_bf16 v[44:47], a[116:119], v[212:215], v[44:47]
ds_read_b64_tr_b16 a[90:91], v14 offset:26624
v_mfma_f32_16x16x32_bf16 v[44:47], a[120:123], v[228:231], v[44:47]
ds_read_b64_tr_b16 a[92:93], v14 offset:28672
v_mfma_f32_16x16x32_bf16 v[44:47], a[124:127], v[244:247], v[44:47]
s_waitcnt lgkmcnt(13)
ds_read_b64_tr_b16 a[94:95], v14 offset:30720
v_mfma_f32_16x16x32_bf16 v[48:51], a[64:67], v[128:131], 0
s_waitcnt lgkmcnt(12)
ds_read_b64_tr_b16 a[96:97], v15 offset:0
v_mfma_f32_16x16x32_bf16 v[48:51], a[68:71], v[144:147], v[48:51]
s_waitcnt lgkmcnt(11)
ds_read_b64_tr_b16 a[98:99], v15 offset:2048
v_mfma_f32_16x16x32_bf16 v[48:51], a[72:75], v[160:163], v[48:51]
s_waitcnt lgkmcnt(10)
ds_read_b64_tr_b16 a[100:101], v15 offset:4096
v_mfma_f32_16x16x32_bf16 v[48:51], a[76:79], v[176:179], v[48:51]
s_waitcnt lgkmcnt(9)
ds_read_b64_tr_b16 a[102:103], v15 offset:6144
v_mfma_f32_16x16x32_bf16 v[48:51], a[80:83], v[192:195], v[48:51]
s_waitcnt lgkmcnt(8)
ds_read_b64_tr_b16 a[104:105], v15 offset:8192
v_cvt_pk_bf16_f32 v32, v32, v33
v_mfma_f32_16x16x32_bf16 v[48:51], a[84:87], v[208:211], v[48:51]
s_waitcnt lgkmcnt(7)
ds_read_b64_tr_b16 a[106:107], v15 offset:10240
v_cvt_pk_bf16_f32 v33, v34, v35
v_mfma_f32_16x16x32_bf16 v[48:51], a[88:91], v[224:227], v[48:51]
s_waitcnt lgkmcnt(6)
ds_read_b64_tr_b16 a[108:109], v15 offset:12288
v_cvt_pk_bf16_f32 v34, v40, v41
v_mfma_f32_16x16x32_bf16 v[48:51], a[92:95], v[240:243], v[48:51]
ds_read_b64_tr_b16 a[110:111], v15 offset:14336
v_cvt_pk_bf16_f32 v35, v42, v43
v_mfma_f32_16x16x32_bf16 v[52:55], a[64:67], v[132:135], 0
ds_read_b64_tr_b16 a[112:113], v15 offset:16384
buffer_store_dwordx4 v[32:35], v1, s[4:7], s8 offen offset:0 sc1
v_mfma_f32_16x16x32_bf16 v[52:55], a[68:71], v[148:151], v[52:55]
ds_read_b64_tr_b16 a[114:115], v15 offset:18432
v_mfma_f32_16x16x32_bf16 v[52:55], a[72:75], v[164:167], v[52:55]
ds_read_b64_tr_b16 a[116:117], v15 offset:20480
v_mfma_f32_16x16x32_bf16 v[52:55], a[76:79], v[180:183], v[52:55]
ds_read_b64_tr_b16 a[118:119], v15 offset:22528
v_mfma_f32_16x16x32_bf16 v[52:55], a[80:83], v[196:199], v[52:55]
ds_read_b64_tr_b16 a[120:121], v15 offset:24576
v_mfma_f32_16x16x32_bf16 v[52:55], a[84:87], v[212:215], v[52:55]
ds_read_b64_tr_b16 a[122:123], v15 offset:26624
v_mfma_f32_16x16x32_bf16 v[52:55], a[88:91], v[228:231], v[52:55]
ds_read_b64_tr_b16 a[124:125], v15 offset:28672
ds_read_b64_tr_b16 a[126:127], v15 offset:30720
v_mfma_f32_16x16x32_bf16 v[52:55], a[92:95], v[244:247], v[52:55]
s_waitcnt lgkmcnt(14)
v_mfma_f32_16x16x32_bf16 v[56:59], a[96:99], v[128:131], 0
s_waitcnt lgkmcnt(12)
v_cvt_pk_bf16_f32 v36, v36, v37
v_mfma_f32_16x16x32_bf16 v[56:59], a[100:103], v[144:147], v[56:59]
s_waitcnt lgkmcnt(10)
v_cvt_pk_bf16_f32 v37, v38, v39
v_mfma_f32_16x16x32_bf16 v[56:59], a[104:107], v[160:163], v[56:59]
s_waitcnt lgkmcnt(8)
v_cvt_pk_bf16_f32 v38, v44, v45
v_mfma_f32_16x16x32_bf16 v[56:59], a[108:111], v[176:179], v[56:59]
s_waitcnt lgkmcnt(6)
v_cvt_pk_bf16_f32 v39, v46, v47
v_mfma_f32_16x16x32_bf16 v[56:59], a[112:115], v[192:195], v[56:59]
s_waitcnt lgkmcnt(4)
buffer_store_dwordx4 v[36:39], v1, s[4:7], s12 offen offset:0 sc1
v_mfma_f32_16x16x32_bf16 v[56:59], a[116:119], v[208:211], v[56:59]
s_waitcnt lgkmcnt(2)
v_mfma_f32_16x16x32_bf16 v[56:59], a[120:123], v[224:227], v[56:59]
s_waitcnt lgkmcnt(0)
v_mfma_f32_16x16x32_bf16 v[56:59], a[124:127], v[240:243], v[56:59]
v_mfma_f32_16x16x32_bf16 v[60:63], a[96:99], v[132:135], 0
v_mfma_f32_16x16x32_bf16 v[60:63], a[100:103], v[148:151], v[60:63]
v_mfma_f32_16x16x32_bf16 v[60:63], a[104:107], v[164:167], v[60:63]
v_mfma_f32_16x16x32_bf16 v[60:63], a[108:111], v[180:183], v[60:63]
v_mfma_f32_16x16x32_bf16 v[60:63], a[112:115], v[196:199], v[60:63]
v_mfma_f32_16x16x32_bf16 v[60:63], a[116:119], v[212:215], v[60:63]
v_mfma_f32_16x16x32_bf16 v[60:63], a[120:123], v[228:231], v[60:63]
v_mfma_f32_16x16x32_bf16 v[60:63], a[124:127], v[244:247], v[60:63]
s_nop 7
v_cvt_pk_bf16_f32 v48, v48, v49
v_cvt_pk_bf16_f32 v49, v50, v51
v_cvt_pk_bf16_f32 v50, v56, v57
v_cvt_pk_bf16_f32 v51, v58, v59
buffer_store_dwordx4 v[48:51], v1, s[4:7], s8 offen offset:1024 sc1
v_cvt_pk_bf16_f32 v52, v52, v53
v_cvt_pk_bf16_f32 v53, v54, v55
v_cvt_pk_bf16_f32 v54, v60, v61
v_cvt_pk_bf16_f32 v55, v62, v63
buffer_store_dwordx4 v[52:55], v1, s[4:7], s12 offen offset:1024 sc1
s_and_b32 s22, s2, 0xd0
s_cmp_eq_u32 s22, 0xd0
s_cbranch_scc1 M_final
s_waitcnt vmcnt(4)
v_cmp_gt_u32 vcc, 1, v18
s_cbranch_vccnz M_rslow
buffer_load_dwordx4 v[128:131], v1, s[4:7], s26 offen sc1
s_add_u32 s26, s26, 14336
buffer_load_dwordx4 v[132:135], v1, s[4:7], s26 offen sc1
s_add_u32 s26, s26, 14336
buffer_load_dwordx4 v[136:139], v1, s[4:7], s26 offen sc1
s_add_u32 s26, s26, 14336
buffer_load_dwordx4 v[140:143], v1, s[4:7], s26 offen sc1
s_add_u32 s26, s26, 14336
buffer_load_dwordx4 v[144:147], v1, s[4:7], s26 offen sc1
s_add_u32 s26, s26, 14336
buffer_load_dwordx4 v[148:151], v1, s[4:7], s26 offen sc1
s_add_u32 s26, s26, 14336
buffer_load_dwordx4 v[152:155], v1, s[4:7], s26 offen sc1
s_add_u32 s26, s26, 14336
buffer_load_dwordx4 v[156:159], v1, s[4:7], s26 offen sc1
s_add_u32 s26, s26, 14336
buffer_load_dwordx4 v[160:163], v1, s[4:7], s26 offen sc1
s_add_u32 s26, s26, 14336
buffer_load_dwordx4 v[164:167], v1, s[4:7], s26 offen sc1
s_add_u32 s26, s26, 14336
buffer_load_dwordx4 v[168:171], v1, s[4:7], s26 offen sc1
s_add_u32 s26, s26, 14336
buffer_load_dwordx4 v[172:175], v1, s[4:7], s26 offen sc1
s_add_u32 s26, s26, 14336
buffer_load_dwordx4 v[176:179], v1, s[4:7], s26 offen sc1
s_add_u32 s26, s26, 14336
buffer_load_dwordx4 v[180:183], v1, s[4:7], s26 offen sc1
s_add_u32 s26, s26, 14336
buffer_load_dwordx4 v[184:187], v1, s[4:7], s26 offen sc1
s_add_u32 s26, s26, 14336
buffer_load_dwordx4 v[188:191], v1, s[4:7], s26 offen sc1
s_waitcnt vmcnt(16)
s_barrier
buffer_store_dword v6, v5, s[4:7], s35 offen sc1
M_rjoin:
Lp_9201:
buffer_load_dword v18, v19, s[4:7], s33 offen offset:64 sc1
s_waitcnt vmcnt(0)
v_cmp_gt_u32 vcc, 1, v18
s_cbranch_vccz Lpd_9202
s_sleep 8
s_sub_u32 s101, s101, 1
s_cbranch_scc0 Lp_9201
s_mov_b32 s101, 0
Lpd_9202:
s_sub_u32 s26, s26, 207872
buffer_load_dwordx4 v[192:195], v1, s[4:7], s26 offen sc1
s_add_u32 s26, s26, 14336
buffer_load_dwordx4 v[196:199], v1, s[4:7], s26 offen sc1
s_add_u32 s26, s26, 14336
buffer_load_dwordx4 v[200:203], v1, s[4:7], s26 offen sc1
s_add_u32 s26, s26, 14336
buffer_load_dwordx4 v[204:207], v1, s[4:7], s26 offen sc1
s_add_u32 s26, s26, 14336
buffer_load_dwordx4 v[208:211], v1, s[4:7], s26 offen sc1
s_add_u32 s26, s26, 14336
buffer_load_dwordx4 v[212:215], v1, s[4:7], s26 offen sc1
s_add_u32 s26, s26, 14336
buffer_load_dwordx4 v[216:219], v1, s[4:7], s26 offen sc1
s_add_u32 s26, s26, 14336
buffer_load_dwordx4 v[220:223], v1, s[4:7], s26 offen sc1
s_add_u32 s26, s26, 14336
buffer_load_dwordx4 v[224:227], v1, s[4:7], s26 offen sc1
s_add_u32 s26, s26, 14336
buffer_load_dwordx4 v[228:231], v1, s[4:7], s26 offen sc1
s_add_u32 s26, s26, 14336
buffer_load_dwordx4 v[232:235], v1, s[4:7], s26 offen sc1
s_add_u32 s26, s26, 14336
buffer_load_dwordx4 v[236:239], v1, s[4:7], s26 offen sc1
s_add_u32 s26, s26, 14336
buffer_load_dwordx4 v[240:243], v1, s[4:7], s26 offen sc1
s_add_u32 s26, s26, 14336
buffer_load_dwordx4 v[244:247], v1, s[4:7], s26 offen sc1
s_add_u32 s26, s26, 14336
buffer_load_dwordx4 v[248:251], v1, s[4:7], s26 offen sc1
s_add_u32 s26, s26, 14336
buffer_load_dwordx4 v[252:255], v1, s[4:7], s26 offen sc1
v_lshlrev_b32 v96, 16, v128
v_and_b32 v97, 0xffff0000, v128
v_lshlrev_b32 v98, 16, v129
v_and_b32 v99, 0xffff0000, v129
v_lshlrev_b32 v100, 16, v130
v_and_b32 v101, 0xffff0000, v130
v_lshlrev_b32 v102, 16, v131
v_and_b32 v103, 0xffff0000, v131
v_lshlrev_b32 v10, 16, v132
v_and_b32 v11, 0xffff0000, v132
v_lshlrev_b32 v12, 16, v133
v_and_b32 v13, 0xffff0000, v133
v_lshlrev_b32 v14, 16, v134
v_and_b32 v15, 0xffff0000, v134
v_lshlrev_b32 v16, 16, v135
v_and_b32 v17, 0xffff0000, v135
v_pk_add_f32 v[96:97], v[96:97], v[10:11]
v_pk_add_f32 v[98:99], v[98:99], v[12:13]
v_pk_add_f32 v[100:101], v[100:101], v[14:15]
v_pk_add_f32 v[102:103], v[102:103], v[16:17]
v_lshlrev_b32 v10, 16, v136
v_and_b32 v11, 0xffff0000, v136
v_lshlrev_b32 v12, 16, v137
v_and_b32 v13, 0xffff0000, v137
v_lshlrev_b32 v14, 16, v138
v_and_b32 v15, 0xffff0000, v138
v_lshlrev_b32 v16, 16, v139
v_and_b32 v17, 0xffff0000, v139
v_pk_add_f32 v[96:97], v[96:97], v[10:11]
v_pk_add_f32 v[98:99], v[98:99], v[12:13]
v_pk_add_f32 v[100:101], v[100:101], v[14:15]
v_pk_add_f32 v[102:103], v[102:103], v[16:17]
v_lshlrev_b32 v10, 16, v140
v_and_b32 v11, 0xffff0000, v140
v_lshlrev_b32 v12, 16, v141
v_and_b32 v13, 0xffff0000, v141
v_lshlrev_b32 v14, 16, v142
v_and_b32 v15, 0xffff0000, v142
v_lshlrev_b32 v16, 16, v143
v_and_b32 v17, 0xffff0000, v143
v_pk_add_f32 v[96:97], v[96:97], v[10:11]
v_pk_add_f32 v[98:99], v[98:99], v[12:13]
v_pk_add_f32 v[100:101], v[100:101], v[14:15]
v_pk_add_f32 v[102:103], v[102:103], v[16:17]
v_lshlrev_b32 v10, 16, v144
v_and_b32 v11, 0xffff0000, v144
v_lshlrev_b32 v12, 16, v145
v_and_b32 v13, 0xffff0000, v145
v_lshlrev_b32 v14, 16, v146
v_and_b32 v15, 0xffff0000, v146
v_lshlrev_b32 v16, 16, v147
v_and_b32 v17, 0xffff0000, v147
v_pk_add_f32 v[96:97], v[96:97], v[10:11]
v_pk_add_f32 v[98:99], v[98:99], v[12:13]
v_pk_add_f32 v[100:101], v[100:101], v[14:15]
v_pk_add_f32 v[102:103], v[102:103], v[16:17]
v_lshlrev_b32 v10, 16, v148
v_and_b32 v11, 0xffff0000, v148
v_lshlrev_b32 v12, 16, v149
v_and_b32 v13, 0xffff0000, v149
v_lshlrev_b32 v14, 16, v150
v_and_b32 v15, 0xffff0000, v150
v_lshlrev_b32 v16, 16, v151
v_and_b32 v17, 0xffff0000, v151
v_pk_add_f32 v[96:97], v[96:97], v[10:11]
v_pk_add_f32 v[98:99], v[98:99], v[12:13]
v_pk_add_f32 v[100:101], v[100:101], v[14:15]
v_pk_add_f32 v[102:103], v[102:103], v[16:17]
v_lshlrev_b32 v10, 16, v152
v_and_b32 v11, 0xffff0000, v152
v_lshlrev_b32 v12, 16, v153
v_and_b32 v13, 0xffff0000, v153
v_lshlrev_b32 v14, 16, v154
v_and_b32 v15, 0xffff0000, v154
v_lshlrev_b32 v16, 16, v155
v_and_b32 v17, 0xffff0000, v155
v_pk_add_f32 v[96:97], v[96:97], v[10:11]
v_pk_add_f32 v[98:99], v[98:99], v[12:13]
v_pk_add_f32 v[100:101], v[100:101], v[14:15]
v_pk_add_f32 v[102:103], v[102:103], v[16:17]
v_lshlrev_b32 v10, 16, v156
v_and_b32 v11, 0xffff0000, v156
v_lshlrev_b32 v12, 16, v157
v_and_b32 v13, 0xffff0000, v157
v_lshlrev_b32 v14, 16, v158
v_and_b32 v15, 0xffff0000, v158
v_lshlrev_b32 v16, 16, v159
v_and_b32 v17, 0xffff0000, v159
v_pk_add_f32 v[96:97], v[96:97], v[10:11]
v_pk_add_f32 v[98:99], v[98:99], v[12:13]
v_pk_add_f32 v[100:101], v[100:101], v[14:15]
v_pk_add_f32 v[102:103], v[102:103], v[16:17]
v_lshlrev_b32 v10, 16, v160
v_and_b32 v11, 0xffff0000, v160
v_lshlrev_b32 v12, 16, v161
v_and_b32 v13, 0xffff0000, v161
v_lshlrev_b32 v14, 16, v162
v_and_b32 v15, 0xffff0000, v162
v_lshlrev_b32 v16, 16, v163
v_and_b32 v17, 0xffff0000, v163
v_pk_add_f32 v[96:97], v[96:97], v[10:11]
v_pk_add_f32 v[98:99], v[98:99], v[12:13]
v_pk_add_f32 v[100:101], v[100:101], v[14:15]
v_pk_add_f32 v[102:103], v[102:103], v[16:17]
v_lshlrev_b32 v10, 16, v164
v_and_b32 v11, 0xffff0000, v164
v_lshlrev_b32 v12, 16, v165
v_and_b32 v13, 0xffff0000, v165
v_lshlrev_b32 v14, 16, v166
v_and_b32 v15, 0xffff0000, v166
v_lshlrev_b32 v16, 16, v167
v_and_b32 v17, 0xffff0000, v167
v_pk_add_f32 v[96:97], v[96:97], v[10:11]
v_pk_add_f32 v[98:99], v[98:99], v[12:13]
v_pk_add_f32 v[100:101], v[100:101], v[14:15]
v_pk_add_f32 v[102:103], v[102:103], v[16:17]
v_lshlrev_b32 v10, 16, v168
v_and_b32 v11, 0xffff0000, v168
v_lshlrev_b32 v12, 16, v169
v_and_b32 v13, 0xffff0000, v169
v_lshlrev_b32 v14, 16, v170
v_and_b32 v15, 0xffff0000, v170
v_lshlrev_b32 v16, 16, v171
v_and_b32 v17, 0xffff0000, v171
v_pk_add_f32 v[96:97], v[96:97], v[10:11]
v_pk_add_f32 v[98:99], v[98:99], v[12:13]
v_pk_add_f32 v[100:101], v[100:101], v[14:15]
v_pk_add_f32 v[102:103], v[102:103], v[16:17]
v_lshlrev_b32 v10, 16, v172
v_and_b32 v11, 0xffff0000, v172
v_lshlrev_b32 v12, 16, v173
v_and_b32 v13, 0xffff0000, v173
v_lshlrev_b32 v14, 16, v174
v_and_b32 v15, 0xffff0000, v174
v_lshlrev_b32 v16, 16, v175
v_and_b32 v17, 0xffff0000, v175
v_pk_add_f32 v[96:97], v[96:97], v[10:11]
v_pk_add_f32 v[98:99], v[98:99], v[12:13]
v_pk_add_f32 v[100:101], v[100:101], v[14:15]
v_pk_add_f32 v[102:103], v[102:103], v[16:17]
v_lshlrev_b32 v10, 16, v176
v_and_b32 v11, 0xffff0000, v176
v_lshlrev_b32 v12, 16, v177
v_and_b32 v13, 0xffff0000, v177
v_lshlrev_b32 v14, 16, v178
v_and_b32 v15, 0xffff0000, v178
v_lshlrev_b32 v16, 16, v179
v_and_b32 v17, 0xffff0000, v179
v_pk_add_f32 v[96:97], v[96:97], v[10:11]
v_pk_add_f32 v[98:99], v[98:99], v[12:13]
v_pk_add_f32 v[100:101], v[100:101], v[14:15]
v_pk_add_f32 v[102:103], v[102:103], v[16:17]
v_lshlrev_b32 v10, 16, v180
v_and_b32 v11, 0xffff0000, v180
v_lshlrev_b32 v12, 16, v181
v_and_b32 v13, 0xffff0000, v181
v_lshlrev_b32 v14, 16, v182
v_and_b32 v15, 0xffff0000, v182
v_lshlrev_b32 v16, 16, v183
v_and_b32 v17, 0xffff0000, v183
v_pk_add_f32 v[96:97], v[96:97], v[10:11]
v_pk_add_f32 v[98:99], v[98:99], v[12:13]
v_pk_add_f32 v[100:101], v[100:101], v[14:15]
v_pk_add_f32 v[102:103], v[102:103], v[16:17]
v_lshlrev_b32 v10, 16, v184
v_and_b32 v11, 0xffff0000, v184
v_lshlrev_b32 v12, 16, v185
v_and_b32 v13, 0xffff0000, v185
v_lshlrev_b32 v14, 16, v186
v_and_b32 v15, 0xffff0000, v186
v_lshlrev_b32 v16, 16, v187
v_and_b32 v17, 0xffff0000, v187
v_pk_add_f32 v[96:97], v[96:97], v[10:11]
v_pk_add_f32 v[98:99], v[98:99], v[12:13]
v_pk_add_f32 v[100:101], v[100:101], v[14:15]
v_pk_add_f32 v[102:103], v[102:103], v[16:17]
v_lshlrev_b32 v10, 16, v188
v_and_b32 v11, 0xffff0000, v188
v_lshlrev_b32 v12, 16, v189
v_and_b32 v13, 0xffff0000, v189
v_lshlrev_b32 v14, 16, v190
v_and_b32 v15, 0xffff0000, v190
v_lshlrev_b32 v16, 16, v191
v_and_b32 v17, 0xffff0000, v191
v_pk_add_f32 v[96:97], v[96:97], v[10:11]
v_pk_add_f32 v[98:99], v[98:99], v[12:13]
v_pk_add_f32 v[100:101], v[100:101], v[14:15]
v_pk_add_f32 v[102:103], v[102:103], v[16:17]
v_cvt_pk_bf16_f32 v96, v96, v97
v_cvt_pk_bf16_f32 v97, v98, v99
v_cvt_pk_bf16_f32 v98, v100, v101
v_cvt_pk_bf16_f32 v99, v102, v103
buffer_store_dwordx2 v[96:97], v21, s[40:43], s25 offen offset:896
buffer_store_dwordx2 v[98:99], v21, s[40:43], s25 offen offset:928
s_waitcnt vmcnt(17)
v_lshlrev_b32 v104, 16, v192
v_and_b32 v105, 0xffff0000, v192
v_lshlrev_b32 v106, 16, v193
v_and_b32 v107, 0xffff0000, v193
v_lshlrev_b32 v108, 16, v194
v_and_b32 v109, 0xffff0000, v194
v_lshlrev_b32 v110, 16, v195
v_and_b32 v111, 0xffff0000, v195
s_waitcnt vmcnt(16)
v_lshlrev_b32 v10, 16, v196
v_and_b32 v11, 0xffff0000, v196
v_lshlrev_b32 v12, 16, v197
v_and_b32 v13, 0xffff0000, v197
v_lshlrev_b32 v14, 16, v198
v_and_b32 v15, 0xffff0000, v198
v_lshlrev_b32 v16, 16, v199
v_and_b32 v17, 0xffff0000, v199
v_pk_add_f32 v[104:105], v[104:105], v[10:11]
v_pk_add_f32 v[106:107], v[106:107], v[12:13]
v_pk_add_f32 v[108:109], v[108:109], v[14:15]
v_pk_add_f32 v[110:111], v[110:111], v[16:17]
s_waitcnt vmcnt(15)
v_lshlrev_b32 v10, 16, v200
v_and_b32 v11, 0xffff0000, v200
v_lshlrev_b32 v12, 16, v201
v_and_b32 v13, 0xffff0000, v201
v_lshlrev_b32 v14, 16, v202
v_and_b32 v15, 0xffff0000, v202
v_lshlrev_b32 v16, 16, v203
v_and_b32 v17, 0xffff0000, v203
v_pk_add_f32 v[104:105], v[104:105], v[10:11]
v_pk_add_f32 v[106:107], v[106:107], v[12:13]
v_pk_add_f32 v[108:109], v[108:109], v[14:15]
v_pk_add_f32 v[110:111], v[110:111], v[16:17]
s_waitcnt vmcnt(14)
v_lshlrev_b32 v10, 16, v204
v_and_b32 v11, 0xffff0000, v204
v_lshlrev_b32 v12, 16, v205
v_and_b32 v13, 0xffff0000, v205
v_lshlrev_b32 v14, 16, v206
v_and_b32 v15, 0xffff0000, v206
v_lshlrev_b32 v16, 16, v207
v_and_b32 v17, 0xffff0000, v207
v_pk_add_f32 v[104:105], v[104:105], v[10:11]
v_pk_add_f32 v[106:107], v[106:107], v[12:13]
v_pk_add_f32 v[108:109], v[108:109], v[14:15]
v_pk_add_f32 v[110:111], v[110:111], v[16:17]
s_waitcnt vmcnt(13)
v_lshlrev_b32 v10, 16, v208
v_and_b32 v11, 0xffff0000, v208
v_lshlrev_b32 v12, 16, v209
v_and_b32 v13, 0xffff0000, v209
v_lshlrev_b32 v14, 16, v210
v_and_b32 v15, 0xffff0000, v210
v_lshlrev_b32 v16, 16, v211
v_and_b32 v17, 0xffff0000, v211
v_pk_add_f32 v[104:105], v[104:105], v[10:11]
v_pk_add_f32 v[106:107], v[106:107], v[12:13]
v_pk_add_f32 v[108:109], v[108:109], v[14:15]
v_pk_add_f32 v[110:111], v[110:111], v[16:17]
s_waitcnt vmcnt(12)
v_lshlrev_b32 v10, 16, v212
v_and_b32 v11, 0xffff0000, v212
v_lshlrev_b32 v12, 16, v213
v_and_b32 v13, 0xffff0000, v213
v_lshlrev_b32 v14, 16, v214
v_and_b32 v15, 0xffff0000, v214
v_lshlrev_b32 v16, 16, v215
v_and_b32 v17, 0xffff0000, v215
v_pk_add_f32 v[104:105], v[104:105], v[10:11]
v_pk_add_f32 v[106:107], v[106:107], v[12:13]
v_pk_add_f32 v[108:109], v[108:109], v[14:15]
v_pk_add_f32 v[110:111], v[110:111], v[16:17]
s_waitcnt vmcnt(11)
v_lshlrev_b32 v10, 16, v216
v_and_b32 v11, 0xffff0000, v216
v_lshlrev_b32 v12, 16, v217
v_and_b32 v13, 0xffff0000, v217
v_lshlrev_b32 v14, 16, v218
v_and_b32 v15, 0xffff0000, v218
v_lshlrev_b32 v16, 16, v219
v_and_b32 v17, 0xffff0000, v219
v_pk_add_f32 v[104:105], v[104:105], v[10:11]
v_pk_add_f32 v[106:107], v[106:107], v[12:13]
v_pk_add_f32 v[108:109], v[108:109], v[14:15]
v_pk_add_f32 v[110:111], v[110:111], v[16:17]
s_waitcnt vmcnt(10)
v_lshlrev_b32 v10, 16, v220
v_and_b32 v11, 0xffff0000, v220
v_lshlrev_b32 v12, 16, v221
v_and_b32 v13, 0xffff0000, v221
v_lshlrev_b32 v14, 16, v222
v_and_b32 v15, 0xffff0000, v222
v_lshlrev_b32 v16, 16, v223
v_and_b32 v17, 0xffff0000, v223
v_pk_add_f32 v[104:105], v[104:105], v[10:11]
v_pk_add_f32 v[106:107], v[106:107], v[12:13]
v_pk_add_f32 v[108:109], v[108:109], v[14:15]
v_pk_add_f32 v[110:111], v[110:111], v[16:17]
s_waitcnt vmcnt(9)
v_lshlrev_b32 v10, 16, v224
v_and_b32 v11, 0xffff0000, v224
v_lshlrev_b32 v12, 16, v225
v_and_b32 v13, 0xffff0000, v225
v_lshlrev_b32 v14, 16, v226
v_and_b32 v15, 0xffff0000, v226
v_lshlrev_b32 v16, 16, v227
v_and_b32 v17, 0xffff0000, v227
v_pk_add_f32 v[104:105], v[104:105], v[10:11]
v_pk_add_f32 v[106:107], v[106:107], v[12:13]
v_pk_add_f32 v[108:109], v[108:109], v[14:15]
v_pk_add_f32 v[110:111], v[110:111], v[16:17]
s_waitcnt vmcnt(8)
v_lshlrev_b32 v10, 16, v228
v_and_b32 v11, 0xffff0000, v228
v_lshlrev_b32 v12, 16, v229
v_and_b32 v13, 0xffff0000, v229
v_lshlrev_b32 v14, 16, v230
v_and_b32 v15, 0xffff0000, v230
v_lshlrev_b32 v16, 16, v231
v_and_b32 v17, 0xffff0000, v231
v_pk_add_f32 v[104:105], v[104:105], v[10:11]
v_pk_add_f32 v[106:107], v[106:107], v[12:13]
v_pk_add_f32 v[108:109], v[108:109], v[14:15]
v_pk_add_f32 v[110:111], v[110:111], v[16:17]
s_waitcnt vmcnt(7)
v_lshlrev_b32 v10, 16, v232
v_and_b32 v11, 0xffff0000, v232
v_lshlrev_b32 v12, 16, v233
v_and_b32 v13, 0xffff0000, v233
v_lshlrev_b32 v14, 16, v234
v_and_b32 v15, 0xffff0000, v234
v_lshlrev_b32 v16, 16, v235
v_and_b32 v17, 0xffff0000, v235
v_pk_add_f32 v[104:105], v[104:105], v[10:11]
v_pk_add_f32 v[106:107], v[106:107], v[12:13]
v_pk_add_f32 v[108:109], v[108:109], v[14:15]
v_pk_add_f32 v[110:111], v[110:111], v[16:17]
s_waitcnt vmcnt(6)
v_lshlrev_b32 v10, 16, v236
v_and_b32 v11, 0xffff0000, v236
v_lshlrev_b32 v12, 16, v237
v_and_b32 v13, 0xffff0000, v237
v_lshlrev_b32 v14, 16, v238
v_and_b32 v15, 0xffff0000, v238
v_lshlrev_b32 v16, 16, v239
v_and_b32 v17, 0xffff0000, v239
v_pk_add_f32 v[104:105], v[104:105], v[10:11]
v_pk_add_f32 v[106:107], v[106:107], v[12:13]
v_pk_add_f32 v[108:109], v[108:109], v[14:15]
v_pk_add_f32 v[110:111], v[110:111], v[16:17]
s_waitcnt vmcnt(5)
v_lshlrev_b32 v10, 16, v240
v_and_b32 v11, 0xffff0000, v240
v_lshlrev_b32 v12, 16, v241
v_and_b32 v13, 0xffff0000, v241
v_lshlrev_b32 v14, 16, v242
v_and_b32 v15, 0xffff0000, v242
v_lshlrev_b32 v16, 16, v243
v_and_b32 v17, 0xffff0000, v243
v_pk_add_f32 v[104:105], v[104:105], v[10:11]
v_pk_add_f32 v[106:107], v[106:107], v[12:13]
v_pk_add_f32 v[108:109], v[108:109], v[14:15]
v_pk_add_f32 v[110:111], v[110:111], v[16:17]
s_waitcnt vmcnt(4)
v_lshlrev_b32 v10, 16, v244
v_and_b32 v11, 0xffff0000, v244
v_lshlrev_b32 v12, 16, v245
v_and_b32 v13, 0xffff0000, v245
v_lshlrev_b32 v14, 16, v246
v_and_b32 v15, 0xffff0000, v246
v_lshlrev_b32 v16, 16, v247
v_and_b32 v17, 0xffff0000, v247
v_pk_add_f32 v[104:105], v[104:105], v[10:11]
v_pk_add_f32 v[106:107], v[106:107], v[12:13]
v_pk_add_f32 v[108:109], v[108:109], v[14:15]
v_pk_add_f32 v[110:111], v[110:111], v[16:17]
s_waitcnt vmcnt(3)
v_lshlrev_b32 v10, 16, v248
v_and_b32 v11, 0xffff0000, v248
v_lshlrev_b32 v12, 16, v249
v_and_b32 v13, 0xffff0000, v249
v_lshlrev_b32 v14, 16, v250
v_and_b32 v15, 0xffff0000, v250
v_lshlrev_b32 v16, 16, v251
v_and_b32 v17, 0xffff0000, v251
v_pk_add_f32 v[104:105], v[104:105], v[10:11]
v_pk_add_f32 v[106:107], v[106:107], v[12:13]
v_pk_add_f32 v[108:109], v[108:109], v[14:15]
v_pk_add_f32 v[110:111], v[110:111], v[16:17]
s_waitcnt vmcnt(2)
v_lshlrev_b32 v10, 16, v252
v_and_b32 v11, 0xffff0000, v252
v_lshlrev_b32 v12, 16, v253
v_and_b32 v13, 0xffff0000, v253
v_lshlrev_b32 v14, 16, v254
v_and_b32 v15, 0xffff0000, v254
v_lshlrev_b32 v16, 16, v255
v_and_b32 v17, 0xffff0000, v255
v_pk_add_f32 v[104:105], v[104:105], v[10:11]
v_pk_add_f32 v[106:107], v[106:107], v[12:13]
v_pk_add_f32 v[108:109], v[108:109], v[14:15]
v_pk_add_f32 v[110:111], v[110:111], v[16:17]
v_cvt_pk_bf16_f32 v104, v104, v105
v_cvt_pk_bf16_f32 v105, v106, v107
v_cvt_pk_bf16_f32 v106, v108, v109
v_cvt_pk_bf16_f32 v107, v110, v111
buffer_store_dwordx2 v[104:105], v21, s[40:43], s25 offen offset:1344
buffer_store_dwordx2 v[106:107], v21, s[40:43], s25 offen offset:1376
M_fin:
s_endpgm
M_final:
s_mov_b32 s8, s64
s_mov_b32 s9, s65
s_mov_b32 s10, 1835008
s_mov_b32 s11, 0x20000
s_mov_b32 s12, s88
s_mov_b32 s13, s89
s_mov_b32 s14, 3670016
s_mov_b32 s15, 0x20000
s_and_b32 s24, s2, 7
s_lshl_b32 s24, s24, 2
s_bfe_u32 s22, s2, 0x10003
s_add_u32 s24, s24, s22
s_bfe_u32 s22, s2, 0x10005
s_lshl_b32 s22, s22, 1
s_add_u32 s24, s24, s22
v_lshrrev_b32 v20, 4, v1
v_and_b32 v21, 15, v20
v_lshrrev_b32 v22, 4, v20
v_mul_u32_u24 v2, 896, v21
v_lshlrev_b32 v9, 1, v2
v_lshl_add_u32 v2, v22, 4, v2
v_lshl_add_u32 v9, v22, 4, v9
s_lshl_b32 s22, s24, 2
s_add_u32 s22, s22, s3
s_mul_i32 s25, s22, 14336
s_lshl_b32 s26, s25, 1
v_lshlrev_b32 v10, 5, v22
v_add3_u32 v10, v10, v21, 16
v_lshlrev_b32 v10, 2, v10
v_min_u32 v11, 380, v10
v_add_u32 v11, 512, v11
s_mov_b32 s27, 94384128
Lfp:
buffer_load_dword v3, v10, s[4:7], s27 offen sc1
buffer_load_dword v4, v11, s[4:7], s27 offen sc1
s_waitcnt vmcnt(0)
v_and_b32 v3, v3, v4
v_cmp_gt_u32 vcc, 1, v3
s_cbranch_vccz Lfpd
s_sleep 2
s_sub_u32 s101, s101, 1
s_cbranch_scc0 Lfp
s_mov_b32 s101, 0
Lfpd:
s_barrier
buffer_store_dword v6, v5, s[4:7], s35 offen sc1
v_lshrrev_b32 v3, 3, v20
v_and_b32 v4, 7, v20
v_lshlrev_b32 v4, 4, v4
v_lshl_add_u32 v3, v3, 12, v4
s_mul_i32 s27, s3, 458752
s_lshl_b32 s22, s24, 7
s_add_u32 s27, s27, s22
s_add_u32 s27, s27, 88080384
s_mul_i32 s28, s3, 14336
s_add_u32 m0, s28, 0
s_nop 0
buffer_load_dwordx4 v3, s[4:7], s27 offen sc1 lds
s_add_u32 s27, s27, 32768
s_add_u32 m0, s28, 1024
s_nop 0
buffer_load_dwordx4 v3, s[4:7], s27 offen sc1 lds
s_add_u32 s27, s27, 32768
s_add_u32 m0, s28, 2048
s_nop 0
buffer_load_dwordx4 v3, s[4:7], s27 offen sc1 lds
s_add_u32 s27, s27, 32768
s_add_u32 m0, s28, 3072
s_nop 0
buffer_load_dwordx4 v3, s[4:7], s27 offen sc1 lds
s_add_u32 s27, s27, 32768
s_add_u32 m0, s28, 4096
s_nop 0
buffer_load_dwordx4 v3, s[4:7], s27 offen sc1 lds
s_add_u32 s27, s27, 32768
s_add_u32 m0, s28, 5120
s_nop 0
buffer_load_dwordx4 v3, s[4:7], s27 offen sc1 lds
s_add_u32 s27, s27, 32768
s_add_u32 m0, s28, 6144
s_nop 0
buffer_load_dwordx4 v3, s[4:7], s27 offen sc1 lds
s_add_u32 s27, s27, 32768
s_add_u32 m0, s28, 7168
s_nop 0
buffer_load_dwordx4 v3, s[4:7], s27 offen sc1 lds
s_add_u32 s27, s27, 32768
s_add_u32 m0, s28, 8192
s_nop 0
buffer_load_dwordx4 v3, s[4:7], s27 offen sc1 lds
s_add_u32 s27, s27, 32768
s_add_u32 m0, s28, 9216
s_nop 0
buffer_load_dwordx4 v3, s[4:7], s27 offen sc1 lds
s_add_u32 s27, s27, 32768
s_add_u32 m0, s28, 10240
s_nop 0
buffer_load_dwordx4 v3, s[4:7], s27 offen sc1 lds
s_add_u32 s27, s27, 32768
s_add_u32 m0, s28, 11264
s_nop 0
buffer_load_dwordx4 v3, s[4:7], s27 offen sc1 lds
s_add_u32 s27, s27, 32768
s_add_u32 m0, s28, 12288
s_nop 0
buffer_load_dwordx4 v3, s[4:7], s27 offen sc1 lds
s_add_u32 s27, s27, 32768
s_add_u32 m0, s28, 13312
s_nop 0
buffer_load_dwordx4 v3, s[4:7], s27 offen sc1 lds
s_add_u32 s27, s27, 32768
buffer_load_dwordx4 v[160:163], v2, s[8:11], s25 offen offset:0
buffer_load_dwordx4 v[164:167], v2, s[8:11], s25 offen offset:64
buffer_load_dwordx4 v[168:171], v2, s[8:11], s25 offen offset:128
buffer_load_dwordx4 v[172:175], v2, s[8:11], s25 offen offset:192
buffer_load_dwordx4 v[176:179], v2, s[8:11], s25 offen offset:256
buffer_load_dwordx4 v[180:183], v2, s[8:11], s25 offen offset:320
buffer_load_dwordx4 v[184:187], v2, s[8:11], s25 offen offset:384
buffer_load_dwordx4 v[188:191], v2, s[8:11], s25 offen offset:448
buffer_load_dwordx4 v[192:195], v2, s[8:11], s25 offen offset:512
buffer_load_dwordx4 v[196:199], v2, s[8:11], s25 offen offset:576
buffer_load_dwordx4 v[200:203], v2, s[8:11], s25 offen offset:640
buffer_load_dwordx4 v[204:207], v2, s[8:11], s25 offen offset:704
buffer_load_dwordx4 v[208:211], v2, s[8:11], s25 offen offset:768
buffer_load_dwordx4 v[212:215], v2, s[8:11], s25 offen offset:832
v_lshrrev_b32 v3, 2, v21
v_lshl_add_u32 v3, v22, 3, v3
v_lshlrev_b32 v3, 7, v3
v_and_b32 v4, 3, v20
v_lshl_add_u32 v3, v4, 3, v3
s_lshl_b32 s22, s3, 5
v_add_u32 v3, s22, v3
s_waitcnt vmcnt(14)
s_barrier
ds_read_b64_tr_b16 v[96:97], v3 offset:0
ds_read_b64_tr_b16 v[98:99], v3 offset:512
ds_read_b64_tr_b16 v[100:101], v3 offset:4096
ds_read_b64_tr_b16 v[102:103], v3 offset:4608
ds_read_b64_tr_b16 v[104:105], v3 offset:8192
ds_read_b64_tr_b16 v[106:107], v3 offset:8704
ds_read_b64_tr_b16 v[108:109], v3 offset:12288
ds_read_b64_tr_b16 v[110:111], v3 offset:12800
ds_read_b64_tr_b16 v[112:113], v3 offset:16384
ds_read_b64_tr_b16 v[114:115], v3 offset:16896
ds_read_b64_tr_b16 v[116:117], v3 offset:20480
ds_read_b64_tr_b16 v[118:119], v3 offset:20992
ds_read_b64_tr_b16 v[120:121], v3 offset:24576
ds_read_b64_tr_b16 v[122:123], v3 offset:25088
s_waitcnt lgkmcnt(0)
ds_read_b64_tr_b16 v[124:125], v3 offset:28672
ds_read_b64_tr_b16 v[126:127], v3 offset:29184
ds_read_b64_tr_b16 v[128:129], v3 offset:32768
ds_read_b64_tr_b16 v[130:131], v3 offset:33280
ds_read_b64_tr_b16 v[132:133], v3 offset:36864
ds_read_b64_tr_b16 v[134:135], v3 offset:37376
ds_read_b64_tr_b16 v[136:137], v3 offset:40960
ds_read_b64_tr_b16 v[138:139], v3 offset:41472
ds_read_b64_tr_b16 v[140:141], v3 offset:45056
ds_read_b64_tr_b16 v[142:143], v3 offset:45568
ds_read_b64_tr_b16 v[144:145], v3 offset:49152
ds_read_b64_tr_b16 v[146:147], v3 offset:49664
ds_read_b64_tr_b16 v[148:149], v3 offset:53248
ds_read_b64_tr_b16 v[150:151], v3 offset:53760
s_waitcnt vmcnt(13)
v_lshlrev_b32 v10, 16, v160
v_and_b32 v11, 0xffff0000, v160
v_lshlrev_b32 v12, 16, v96
v_and_b32 v13, 0xffff0000, v96
v_pk_mul_f32 v[10:11], v[10:11], v[12:13]
v_cvt_pk_bf16_f32 v160, v10, v11
v_lshlrev_b32 v10, 16, v161
v_and_b32 v11, 0xffff0000, v161
v_lshlrev_b32 v12, 16, v97
v_and_b32 v13, 0xffff0000, v97
v_pk_mul_f32 v[10:11], v[10:11], v[12:13]
v_cvt_pk_bf16_f32 v161, v10, v11
v_lshlrev_b32 v10, 16, v162
v_and_b32 v11, 0xffff0000, v162
v_lshlrev_b32 v12, 16, v98
v_and_b32 v13, 0xffff0000, v98
v_pk_mul_f32 v[10:11], v[10:11], v[12:13]
v_cvt_pk_bf16_f32 v162, v10, v11
v_lshlrev_b32 v10, 16, v163
v_and_b32 v11, 0xffff0000, v163
v_lshlrev_b32 v12, 16, v99
v_and_b32 v13, 0xffff0000, v99
v_pk_mul_f32 v[10:11], v[10:11], v[12:13]
v_cvt_pk_bf16_f32 v163, v10, v11
buffer_store_dwordx4 v[160:163], v9, s[12:15], s26 offen offset:0
s_waitcnt vmcnt(13)
v_lshlrev_b32 v10, 16, v164
v_and_b32 v11, 0xffff0000, v164
v_lshlrev_b32 v12, 16, v100
v_and_b32 v13, 0xffff0000, v100
v_pk_mul_f32 v[10:11], v[10:11], v[12:13]
v_cvt_pk_bf16_f32 v164, v10, v11
v_lshlrev_b32 v10, 16, v165
v_and_b32 v11, 0xffff0000, v165
v_lshlrev_b32 v12, 16, v101
v_and_b32 v13, 0xffff0000, v101
v_pk_mul_f32 v[10:11], v[10:11], v[12:13]
v_cvt_pk_bf16_f32 v165, v10, v11
v_lshlrev_b32 v10, 16, v166
v_and_b32 v11, 0xffff0000, v166
v_lshlrev_b32 v12, 16, v102
v_and_b32 v13, 0xffff0000, v102
v_pk_mul_f32 v[10:11], v[10:11], v[12:13]
v_cvt_pk_bf16_f32 v166, v10, v11
v_lshlrev_b32 v10, 16, v167
v_and_b32 v11, 0xffff0000, v167
v_lshlrev_b32 v12, 16, v103
v_and_b32 v13, 0xffff0000, v103
v_pk_mul_f32 v[10:11], v[10:11], v[12:13]
v_cvt_pk_bf16_f32 v167, v10, v11
buffer_store_dwordx4 v[164:167], v9, s[12:15], s26 offen offset:64
s_waitcnt vmcnt(13)
v_lshlrev_b32 v10, 16, v168
v_and_b32 v11, 0xffff0000, v168
v_lshlrev_b32 v12, 16, v104
v_and_b32 v13, 0xffff0000, v104
v_pk_mul_f32 v[10:11], v[10:11], v[12:13]
v_cvt_pk_bf16_f32 v168, v10, v11
v_lshlrev_b32 v10, 16, v169
v_and_b32 v11, 0xffff0000, v169
v_lshlrev_b32 v12, 16, v105
v_and_b32 v13, 0xffff0000, v105
v_pk_mul_f32 v[10:11], v[10:11], v[12:13]
v_cvt_pk_bf16_f32 v169, v10, v11
v_lshlrev_b32 v10, 16, v170
v_and_b32 v11, 0xffff0000, v170
v_lshlrev_b32 v12, 16, v106
v_and_b32 v13, 0xffff0000, v106
v_pk_mul_f32 v[10:11], v[10:11], v[12:13]
v_cvt_pk_bf16_f32 v170, v10, v11
v_lshlrev_b32 v10, 16, v171
v_and_b32 v11, 0xffff0000, v171
v_lshlrev_b32 v12, 16, v107
v_and_b32 v13, 0xffff0000, v107
v_pk_mul_f32 v[10:11], v[10:11], v[12:13]
v_cvt_pk_bf16_f32 v171, v10, v11
buffer_store_dwordx4 v[168:171], v9, s[12:15], s26 offen offset:128
s_waitcnt vmcnt(13)
v_lshlrev_b32 v10, 16, v172
v_and_b32 v11, 0xffff0000, v172
v_lshlrev_b32 v12, 16, v108
v_and_b32 v13, 0xffff0000, v108
v_pk_mul_f32 v[10:11], v[10:11], v[12:13]
v_cvt_pk_bf16_f32 v172, v10, v11
v_lshlrev_b32 v10, 16, v173
v_and_b32 v11, 0xffff0000, v173
v_lshlrev_b32 v12, 16, v109
v_and_b32 v13, 0xffff0000, v109
v_pk_mul_f32 v[10:11], v[10:11], v[12:13]
v_cvt_pk_bf16_f32 v173, v10, v11
v_lshlrev_b32 v10, 16, v174
v_and_b32 v11, 0xffff0000, v174
v_lshlrev_b32 v12, 16, v110
v_and_b32 v13, 0xffff0000, v110
v_pk_mul_f32 v[10:11], v[10:11], v[12:13]
v_cvt_pk_bf16_f32 v174, v10, v11
v_lshlrev_b32 v10, 16, v175
v_and_b32 v11, 0xffff0000, v175
v_lshlrev_b32 v12, 16, v111
v_and_b32 v13, 0xffff0000, v111
v_pk_mul_f32 v[10:11], v[10:11], v[12:13]
v_cvt_pk_bf16_f32 v175, v10, v11
buffer_store_dwordx4 v[172:175], v9, s[12:15], s26 offen offset:192
s_waitcnt vmcnt(13)
v_lshlrev_b32 v10, 16, v176
v_and_b32 v11, 0xffff0000, v176
v_lshlrev_b32 v12, 16, v112
v_and_b32 v13, 0xffff0000, v112
v_pk_mul_f32 v[10:11], v[10:11], v[12:13]
v_cvt_pk_bf16_f32 v176, v10, v11
v_lshlrev_b32 v10, 16, v177
v_and_b32 v11, 0xffff0000, v177
v_lshlrev_b32 v12, 16, v113
v_and_b32 v13, 0xffff0000, v113
v_pk_mul_f32 v[10:11], v[10:11], v[12:13]
v_cvt_pk_bf16_f32 v177, v10, v11
v_lshlrev_b32 v10, 16, v178
v_and_b32 v11, 0xffff0000, v178
v_lshlrev_b32 v12, 16, v114
v_and_b32 v13, 0xffff0000, v114
v_pk_mul_f32 v[10:11], v[10:11], v[12:13]
v_cvt_pk_bf16_f32 v178, v10, v11
v_lshlrev_b32 v10, 16, v179
v_and_b32 v11, 0xffff0000, v179
v_lshlrev_b32 v12, 16, v115
v_and_b32 v13, 0xffff0000, v115
v_pk_mul_f32 v[10:11], v[10:11], v[12:13]
v_cvt_pk_bf16_f32 v179, v10, v11
buffer_store_dwordx4 v[176:179], v9, s[12:15], s26 offen offset:256
s_waitcnt vmcnt(13)
v_lshlrev_b32 v10, 16, v180
v_and_b32 v11, 0xffff0000, v180
v_lshlrev_b32 v12, 16, v116
v_and_b32 v13, 0xffff0000, v116
v_pk_mul_f32 v[10:11], v[10:11], v[12:13]
v_cvt_pk_bf16_f32 v180, v10, v11
v_lshlrev_b32 v10, 16, v181
v_and_b32 v11, 0xffff0000, v181
v_lshlrev_b32 v12, 16, v117
v_and_b32 v13, 0xffff0000, v117
v_pk_mul_f32 v[10:11], v[10:11], v[12:13]
v_cvt_pk_bf16_f32 v181, v10, v11
v_lshlrev_b32 v10, 16, v182
v_and_b32 v11, 0xffff0000, v182
v_lshlrev_b32 v12, 16, v118
v_and_b32 v13, 0xffff0000, v118
v_pk_mul_f32 v[10:11], v[10:11], v[12:13]
v_cvt_pk_bf16_f32 v182, v10, v11
v_lshlrev_b32 v10, 16, v183
v_and_b32 v11, 0xffff0000, v183
v_lshlrev_b32 v12, 16, v119
v_and_b32 v13, 0xffff0000, v119
v_pk_mul_f32 v[10:11], v[10:11], v[12:13]
v_cvt_pk_bf16_f32 v183, v10, v11
buffer_store_dwordx4 v[180:183], v9, s[12:15], s26 offen offset:320
s_waitcnt vmcnt(13)
v_lshlrev_b32 v10, 16, v184
v_and_b32 v11, 0xffff0000, v184
v_lshlrev_b32 v12, 16, v120
v_and_b32 v13, 0xffff0000, v120
v_pk_mul_f32 v[10:11], v[10:11], v[12:13]
v_cvt_pk_bf16_f32 v184, v10, v11
v_lshlrev_b32 v10, 16, v185
v_and_b32 v11, 0xffff0000, v185
v_lshlrev_b32 v12, 16, v121
v_and_b32 v13, 0xffff0000, v121
v_pk_mul_f32 v[10:11], v[10:11], v[12:13]
v_cvt_pk_bf16_f32 v185, v10, v11
v_lshlrev_b32 v10, 16, v186
v_and_b32 v11, 0xffff0000, v186
v_lshlrev_b32 v12, 16, v122
v_and_b32 v13, 0xffff0000, v122
v_pk_mul_f32 v[10:11], v[10:11], v[12:13]
v_cvt_pk_bf16_f32 v186, v10, v11
v_lshlrev_b32 v10, 16, v187
v_and_b32 v11, 0xffff0000, v187
v_lshlrev_b32 v12, 16, v123
v_and_b32 v13, 0xffff0000, v123
v_pk_mul_f32 v[10:11], v[10:11], v[12:13]
v_cvt_pk_bf16_f32 v187, v10, v11
buffer_store_dwordx4 v[184:187], v9, s[12:15], s26 offen offset:384
s_waitcnt lgkmcnt(0)
s_waitcnt vmcnt(13)
v_lshlrev_b32 v10, 16, v188
v_and_b32 v11, 0xffff0000, v188
v_lshlrev_b32 v12, 16, v124
v_and_b32 v13, 0xffff0000, v124
v_pk_mul_f32 v[10:11], v[10:11], v[12:13]
v_cvt_pk_bf16_f32 v188, v10, v11
v_lshlrev_b32 v10, 16, v189
v_and_b32 v11, 0xffff0000, v189
v_lshlrev_b32 v12, 16, v125
v_and_b32 v13, 0xffff0000, v125
v_pk_mul_f32 v[10:11], v[10:11], v[12:13]
v_cvt_pk_bf16_f32 v189, v10, v11
v_lshlrev_b32 v10, 16, v190
v_and_b32 v11, 0xffff0000, v190
v_lshlrev_b32 v12, 16, v126
v_and_b32 v13, 0xffff0000, v126
v_pk_mul_f32 v[10:11], v[10:11], v[12:13]
v_cvt_pk_bf16_f32 v190, v10, v11
v_lshlrev_b32 v10, 16, v191
v_and_b32 v11, 0xffff0000, v191
v_lshlrev_b32 v12, 16, v127
v_and_b32 v13, 0xffff0000, v127
v_pk_mul_f32 v[10:11], v[10:11], v[12:13]
v_cvt_pk_bf16_f32 v191, v10, v11
buffer_store_dwordx4 v[188:191], v9, s[12:15], s26 offen offset:448
s_waitcnt vmcnt(13)
v_lshlrev_b32 v10, 16, v192
v_and_b32 v11, 0xffff0000, v192
v_lshlrev_b32 v12, 16, v128
v_and_b32 v13, 0xffff0000, v128
v_pk_mul_f32 v[10:11], v[10:11], v[12:13]
v_cvt_pk_bf16_f32 v192, v10, v11
v_lshlrev_b32 v10, 16, v193
v_and_b32 v11, 0xffff0000, v193
v_lshlrev_b32 v12, 16, v129
v_and_b32 v13, 0xffff0000, v129
v_pk_mul_f32 v[10:11], v[10:11], v[12:13]
v_cvt_pk_bf16_f32 v193, v10, v11
v_lshlrev_b32 v10, 16, v194
v_and_b32 v11, 0xffff0000, v194
v_lshlrev_b32 v12, 16, v130
v_and_b32 v13, 0xffff0000, v130
v_pk_mul_f32 v[10:11], v[10:11], v[12:13]
v_cvt_pk_bf16_f32 v194, v10, v11
v_lshlrev_b32 v10, 16, v195
v_and_b32 v11, 0xffff0000, v195
v_lshlrev_b32 v12, 16, v131
v_and_b32 v13, 0xffff0000, v131
v_pk_mul_f32 v[10:11], v[10:11], v[12:13]
v_cvt_pk_bf16_f32 v195, v10, v11
buffer_store_dwordx4 v[192:195], v9, s[12:15], s26 offen offset:512
s_waitcnt vmcnt(13)
v_lshlrev_b32 v10, 16, v196
v_and_b32 v11, 0xffff0000, v196
v_lshlrev_b32 v12, 16, v132
v_and_b32 v13, 0xffff0000, v132
v_pk_mul_f32 v[10:11], v[10:11], v[12:13]
v_cvt_pk_bf16_f32 v196, v10, v11
v_lshlrev_b32 v10, 16, v197
v_and_b32 v11, 0xffff0000, v197
v_lshlrev_b32 v12, 16, v133
v_and_b32 v13, 0xffff0000, v133
v_pk_mul_f32 v[10:11], v[10:11], v[12:13]
v_cvt_pk_bf16_f32 v197, v10, v11
v_lshlrev_b32 v10, 16, v198
v_and_b32 v11, 0xffff0000, v198
v_lshlrev_b32 v12, 16, v134
v_and_b32 v13, 0xffff0000, v134
v_pk_mul_f32 v[10:11], v[10:11], v[12:13]
v_cvt_pk_bf16_f32 v198, v10, v11
v_lshlrev_b32 v10, 16, v199
v_and_b32 v11, 0xffff0000, v199
v_lshlrev_b32 v12, 16, v135
v_and_b32 v13, 0xffff0000, v135
v_pk_mul_f32 v[10:11], v[10:11], v[12:13]
v_cvt_pk_bf16_f32 v199, v10, v11
buffer_store_dwordx4 v[196:199], v9, s[12:15], s26 offen offset:576
s_waitcnt vmcnt(13)
v_lshlrev_b32 v10, 16, v200
v_and_b32 v11, 0xffff0000, v200
v_lshlrev_b32 v12, 16, v136
v_and_b32 v13, 0xffff0000, v136
v_pk_mul_f32 v[10:11], v[10:11], v[12:13]
v_cvt_pk_bf16_f32 v200, v10, v11
v_lshlrev_b32 v10, 16, v201
v_and_b32 v11, 0xffff0000, v201
v_lshlrev_b32 v12, 16, v137
v_and_b32 v13, 0xffff0000, v137
v_pk_mul_f32 v[10:11], v[10:11], v[12:13]
v_cvt_pk_bf16_f32 v201, v10, v11
v_lshlrev_b32 v10, 16, v202
v_and_b32 v11, 0xffff0000, v202
v_lshlrev_b32 v12, 16, v138
v_and_b32 v13, 0xffff0000, v138
v_pk_mul_f32 v[10:11], v[10:11], v[12:13]
v_cvt_pk_bf16_f32 v202, v10, v11
v_lshlrev_b32 v10, 16, v203
v_and_b32 v11, 0xffff0000, v203
v_lshlrev_b32 v12, 16, v139
v_and_b32 v13, 0xffff0000, v139
v_pk_mul_f32 v[10:11], v[10:11], v[12:13]
v_cvt_pk_bf16_f32 v203, v10, v11
buffer_store_dwordx4 v[200:203], v9, s[12:15], s26 offen offset:640
s_waitcnt vmcnt(13)
v_lshlrev_b32 v10, 16, v204
v_and_b32 v11, 0xffff0000, v204
v_lshlrev_b32 v12, 16, v140
v_and_b32 v13, 0xffff0000, v140
v_pk_mul_f32 v[10:11], v[10:11], v[12:13]
v_cvt_pk_bf16_f32 v204, v10, v11
v_lshlrev_b32 v10, 16, v205
v_and_b32 v11, 0xffff0000, v205
v_lshlrev_b32 v12, 16, v141
v_and_b32 v13, 0xffff0000, v141
v_pk_mul_f32 v[10:11], v[10:11], v[12:13]
v_cvt_pk_bf16_f32 v205, v10, v11
v_lshlrev_b32 v10, 16, v206
v_and_b32 v11, 0xffff0000, v206
v_lshlrev_b32 v12, 16, v142
v_and_b32 v13, 0xffff0000, v142
v_pk_mul_f32 v[10:11], v[10:11], v[12:13]
v_cvt_pk_bf16_f32 v206, v10, v11
v_lshlrev_b32 v10, 16, v207
v_and_b32 v11, 0xffff0000, v207
v_lshlrev_b32 v12, 16, v143
v_and_b32 v13, 0xffff0000, v143
v_pk_mul_f32 v[10:11], v[10:11], v[12:13]
v_cvt_pk_bf16_f32 v207, v10, v11
buffer_store_dwordx4 v[204:207], v9, s[12:15], s26 offen offset:704
s_waitcnt vmcnt(13)
v_lshlrev_b32 v10, 16, v208
v_and_b32 v11, 0xffff0000, v208
v_lshlrev_b32 v12, 16, v144
v_and_b32 v13, 0xffff0000, v144
v_pk_mul_f32 v[10:11], v[10:11], v[12:13]
v_cvt_pk_bf16_f32 v208, v10, v11
v_lshlrev_b32 v10, 16, v209
v_and_b32 v11, 0xffff0000, v209
v_lshlrev_b32 v12, 16, v145
v_and_b32 v13, 0xffff0000, v145
v_pk_mul_f32 v[10:11], v[10:11], v[12:13]
v_cvt_pk_bf16_f32 v209, v10, v11
v_lshlrev_b32 v10, 16, v210
v_and_b32 v11, 0xffff0000, v210
v_lshlrev_b32 v12, 16, v146
v_and_b32 v13, 0xffff0000, v146
v_pk_mul_f32 v[10:11], v[10:11], v[12:13]
v_cvt_pk_bf16_f32 v210, v10, v11
v_lshlrev_b32 v10, 16, v211
v_and_b32 v11, 0xffff0000, v211
v_lshlrev_b32 v12, 16, v147
v_and_b32 v13, 0xffff0000, v147
v_pk_mul_f32 v[10:11], v[10:11], v[12:13]
v_cvt_pk_bf16_f32 v211, v10, v11
buffer_store_dwordx4 v[208:211], v9, s[12:15], s26 offen offset:768
s_waitcnt vmcnt(13)
v_lshlrev_b32 v10, 16, v212
v_and_b32 v11, 0xffff0000, v212
v_lshlrev_b32 v12, 16, v148
v_and_b32 v13, 0xffff0000, v148
v_pk_mul_f32 v[10:11], v[10:11], v[12:13]
v_cvt_pk_bf16_f32 v212, v10, v11
v_lshlrev_b32 v10, 16, v213
v_and_b32 v11, 0xffff0000, v213
v_lshlrev_b32 v12, 16, v149
v_and_b32 v13, 0xffff0000, v149
v_pk_mul_f32 v[10:11], v[10:11], v[12:13]
v_cvt_pk_bf16_f32 v213, v10, v11
v_lshlrev_b32 v10, 16, v214
v_and_b32 v11, 0xffff0000, v214
v_lshlrev_b32 v12, 16, v150
v_and_b32 v13, 0xffff0000, v150
v_pk_mul_f32 v[10:11], v[10:11], v[12:13]
v_cvt_pk_bf16_f32 v214, v10, v11
v_lshlrev_b32 v10, 16, v215
v_and_b32 v11, 0xffff0000, v215
v_lshlrev_b32 v12, 16, v151
v_and_b32 v13, 0xffff0000, v151
v_pk_mul_f32 v[10:11], v[10:11], v[12:13]
v_cvt_pk_bf16_f32 v215, v10, v11
buffer_store_dwordx4 v[212:215], v9, s[12:15], s26 offen offset:832
s_branch M_fin
M_rslow:
s_waitcnt vmcnt(0)
s_barrier
buffer_store_dword v6, v5, s[4:7], s35 offen sc1
Lp_9251:
buffer_load_dword v18, v19, s[4:7], s33 offen offset:0 sc1
s_waitcnt vmcnt(0)
v_cmp_gt_u32 vcc, 1, v18
s_cbranch_vccz Lpd_9252
s_sleep 8
s_sub_u32 s101, s101, 1
s_cbranch_scc0 Lp_9251
s_mov_b32 s101, 0
Lpd_9252:
buffer_load_dwordx4 v[128:131], v1, s[4:7], s26 offen sc1
s_add_u32 s26, s26, 14336
buffer_load_dwordx4 v[132:135], v1, s[4:7], s26 offen sc1
s_add_u32 s26, s26, 14336
buffer_load_dwordx4 v[136:139], v1, s[4:7], s26 offen sc1
s_add_u32 s26, s26, 14336
buffer_load_dwordx4 v[140:143], v1, s[4:7], s26 offen sc1
s_add_u32 s26, s26, 14336
buffer_load_dwordx4 v[144:147], v1, s[4:7], s26 offen sc1
s_add_u32 s26, s26, 14336
buffer_load_dwordx4 v[148:151], v1, s[4:7], s26 offen sc1
s_add_u32 s26, s26, 14336
buffer_load_dwordx4 v[152:155], v1, s[4:7], s26 offen sc1
s_add_u32 s26, s26, 14336
buffer_load_dwordx4 v[156:159], v1, s[4:7], s26 offen sc1
s_add_u32 s26, s26, 14336
buffer_load_dwordx4 v[160:163], v1, s[4:7], s26 offen sc1
s_add_u32 s26, s26, 14336
buffer_load_dwordx4 v[164:167], v1, s[4:7], s26 offen sc1
s_add_u32 s26, s26, 14336
buffer_load_dwordx4 v[168:171], v1, s[4:7], s26 offen sc1
s_add_u32 s26, s26, 14336
buffer_load_dwordx4 v[172:175], v1, s[4:7], s26 offen sc1
s_add_u32 s26, s26, 14336
buffer_load_dwordx4 v[176:179], v1, s[4:7], s26 offen sc1
s_add_u32 s26, s26, 14336
buffer_load_dwordx4 v[180:183], v1, s[4:7], s26 offen sc1
s_add_u32 s26, s26, 14336
buffer_load_dwordx4 v[184:187], v1, s[4:7], s26 offen sc1
s_add_u32 s26, s26, 14336
buffer_load_dwordx4 v[188:191], v1, s[4:7], s26 offen sc1
s_branch M_rjoin
M_conv:
v_mfma_f32_16x16x32_bf16 v[36:39], a[128:131], a[0:3], v[36:39]
s_waitcnt lgkmcnt(0)
ds_read_b64_tr_b16 a[136:137], v23 offset:0
v_mfma_f32_16x16x32_bf16 v[36:39], a[132:135], a[4:7], v[36:39]
s_mul_i32 s85, s20, 7
v_mfma_f32_16x16x32_bf16 v[44:47], a[128:131], a[8:11], v[44:47]
s_add_u32 s85, s85, s21
ds_read_b64_tr_b16 a[138:139], v23 offset:2048
v_mfma_f32_16x16x32_bf16 v[44:47], a[132:135], a[12:15], v[44:47]
s_lshl_b32 s85, s85, 2
v_mfma_f32_16x16x32_bf16 v[52:55], a[128:131], a[16:19], v[52:55]
s_add_u32 s85, s85, s3
ds_read_b64_tr_b16 a[140:141], v23 offset:16384
v_mfma_f32_16x16x32_bf16 v[52:55], a[132:135], a[20:23], v[52:55]
s_mul_i32 s82, s85, 4224
v_mfma_f32_16x16x32_bf16 v[60:63], a[128:131], a[24:27], v[60:63]
s_add_u32 s82, s82, 83886208
ds_read_b64_tr_b16 a[142:143], v23 offset:18432
v_mfma_f32_16x16x32_bf16 v[60:63], a[132:135], a[28:31], v[60:63]
s_lshl_b32 s83, s85, 12
v_mfma_f32_16x16x32_bf16 v[68:71], a[128:131], a[32:35], v[68:71]
s_mul_i32 s84, s3, 21248
v_mfma_f32_16x16x32_bf16 v[68:71], a[132:135], a[36:39], v[68:71]
s_add_u32 s84, s84, 46080
v_mfma_f32_16x16x32_bf16 v[76:79], a[128:131], a[40:43], v[76:79]
s_mov_b64 s[60:61], s[72:73]
v_mfma_f32_16x16x32_bf16 v[76:79], a[132:135], a[44:47], v[76:79]
s_mov_b32 s62, 1835008
v_mfma_f32_16x16x32_bf16 v[84:87], a[128:131], a[48:51], v[84:87]
s_add_u32 m0, s84, 17152
v_lshrrev_b32 v9, 4, v1
v_and_b32 v10, 15, v9
v_mfma_f32_16x16x32_bf16 v[84:87], a[132:135], a[52:55], v[84:87]
buffer_load_dwordx4 v1, s[60:63], s83 offen offset:0 lds
v_mfma_f32_16x16x32_bf16 v[92:95], a[128:131], a[56:59], v[92:95]
buffer_load_dwordx4 v1, s[60:63], s83 offen offset:1024 lds
v_mfma_f32_16x16x32_bf16 v[92:95], a[132:135], a[60:63], v[92:95]
s_waitcnt lgkmcnt(2)
buffer_load_dwordx4 v1, s[60:63], s83 offen offset:2048 lds
v_mfma_f32_16x16x32_bf16 v[100:103], a[136:139], a[0:3], v[100:103]
s_waitcnt lgkmcnt(0)
ds_read_b64_tr_b16 a[128:129], v24 offset:0
v_lshrrev_b32 v11, 4, v9
v_mfma_f32_16x16x32_bf16 v[100:103], a[140:143], a[4:7], v[100:103]
buffer_load_dwordx4 v1, s[60:63], s83 offen offset:3072 lds
v_mfma_f32_16x16x32_bf16 v[108:111], a[136:139], a[8:11], v[108:111]
s_add_u32 m0, s84, 64
ds_read_b64_tr_b16 a[130:131], v24 offset:2048
v_lshrrev_b32 v12, 2, v10
v_mfma_f32_16x16x32_bf16 v[108:111], a[140:143], a[12:15], v[108:111]
buffer_load_dwordx4 v1, s[4:7], s82 offen offset:0 sc1 lds
v_mfma_f32_16x16x32_bf16 v[116:119], a[136:139], a[16:19], v[116:119]
ds_read_b64_tr_b16 a[132:133], v24 offset:16384
v_mul_u32_u24 v12, 4160, v12
v_mfma_f32_16x16x32_bf16 v[116:119], a[140:143], a[20:23], v[116:119]
buffer_load_dwordx4 v1, s[4:7], s82 offen offset:1024 sc1 lds
v_mfma_f32_16x16x32_bf16 v[124:127], a[136:139], a[24:27], v[124:127]
ds_read_b64_tr_b16 a[134:135], v24 offset:18432
v_and_b32 v13, 3, v9
v_mfma_f32_16x16x32_bf16 v[124:127], a[140:143], a[28:31], v[124:127]
buffer_load_dwordx4 v1, s[4:7], s82 offen offset:2048 sc1 lds
v_mfma_f32_16x16x32_bf16 v[132:135], a[136:139], a[32:35], v[132:135]
buffer_load_dwordx4 v1, s[4:7], s82 offen offset:3072 sc1 lds
v_mfma_f32_16x16x32_bf16 v[132:135], a[140:143], a[36:39], v[132:135]
s_add_u32 s82, s82, 2097152
v_lshl_add_u32 v12, v13, 3, v12
v_lshlrev_b32 v13, 4, v11
v_mfma_f32_16x16x32_bf16 v[140:143], a[136:139], a[40:43], v[140:143]
s_add_u32 m0, s84, 4224
v_sub_u32 v12, v12, v13
v_add_u32 v12, 88, v12
v_mfma_f32_16x16x32_bf16 v[140:143], a[140:143], a[44:47], v[140:143]
buffer_load_dwordx4 v1, s[4:7], s82 offen offset:0 sc1 lds
v_mfma_f32_16x16x32_bf16 v[148:151], a[136:139], a[48:51], v[148:151]
buffer_load_dwordx4 v1, s[4:7], s82 offen offset:1024 sc1 lds
v_mfma_f32_16x16x32_bf16 v[148:151], a[140:143], a[52:55], v[148:151]
buffer_load_dwordx4 v1, s[4:7], s82 offen offset:2048 sc1 lds
v_mfma_f32_16x16x32_bf16 v[156:159], a[136:139], a[56:59], v[156:159]
buffer_load_dwordx4 v1, s[4:7], s82 offen offset:3072 sc1 lds
v_mfma_f32_16x16x32_bf16 v[156:159], a[140:143], a[60:63], v[156:159]
s_waitcnt lgkmcnt(2)
v_add_u32 v16, s84, v12
v_lshl_add_u32 v12, v10, 5, v13
v_mfma_f32_16x16x32_bf16 v[164:167], a[128:131], a[0:3], v[164:167]
s_waitcnt lgkmcnt(0)
ds_read_b64_tr_b16 a[136:137], v25 offset:0
v_add_u32 v12, 16672, v12
v_mfma_f32_16x16x32_bf16 v[164:167], a[132:135], a[4:7], v[164:167]
s_add_u32 s82, s82, 4292870140
v_add_u32 v17, s84, v12
v_lshlrev_b32 v12, 5, v10
v_mfma_f32_16x16x32_bf16 v[172:175], a[128:131], a[8:11], v[172:175]
s_add_u32 m0, s84, 8384
ds_read_b64_tr_b16 a[138:139], v25 offset:2048
v_lshl_add_u32 v8, v11, 3, v12
v_mfma_f32_16x16x32_bf16 v[172:175], a[132:135], a[12:15], v[172:175]
buffer_load_dwordx4 v1, s[4:7], s82 offen offset:0 sc1 lds
v_mfma_f32_16x16x32_bf16 v[180:183], a[128:131], a[16:19], v[180:183]
ds_read_b64_tr_b16 a[140:141], v25 offset:16384
v_add3_u32 v18, s84, 64, v8
v_mfma_f32_16x16x32_bf16 v[180:183], a[132:135], a[20:23], v[180:183]
buffer_load_dwordx4 v1, s[4:7], s82 offen offset:1024 sc1 lds
v_mfma_f32_16x16x32_bf16 v[188:191], a[128:131], a[24:27], v[188:191]
ds_read_b64_tr_b16 a[142:143], v25 offset:18432
v_mov_b32 v19, 0
v_mfma_f32_16x16x32_bf16 v[188:191], a[132:135], a[28:31], v[188:191]
buffer_load_dwordx4 v1, s[4:7], s82 offen offset:2048 sc1 lds
v_mfma_f32_16x16x32_bf16 v[196:199], a[128:131], a[32:35], v[196:199]
buffer_load_dwordx4 v1, s[4:7], s82 offen offset:3072 sc1 lds
v_mfma_f32_16x16x32_bf16 v[196:199], a[132:135], a[36:39], v[196:199]
s_add_u32 s82, s82, 2097152
v_mov_b32 v12, 0
v_mov_b32 v13, 0
v_mfma_f32_16x16x32_bf16 v[204:207], a[128:131], a[40:43], v[204:207]
s_add_u32 m0, s84, 12544
v_lshl_add_u32 v14, v9, 3, s84
v_mfma_f32_16x16x32_bf16 v[204:207], a[132:135], a[44:47], v[204:207]
buffer_load_dwordx4 v1, s[4:7], s82 offen offset:0 sc1 lds
v_mfma_f32_16x16x32_bf16 v[212:215], a[128:131], a[48:51], v[212:215]
buffer_load_dwordx4 v1, s[4:7], s82 offen offset:1024 sc1 lds
v_mfma_f32_16x16x32_bf16 v[212:215], a[132:135], a[52:55], v[212:215]
buffer_load_dwordx4 v1, s[4:7], s82 offen offset:2048 sc1 lds
v_mfma_f32_16x16x32_bf16 v[220:223], a[128:131], a[56:59], v[220:223]
buffer_load_dwordx4 v1, s[4:7], s82 offen offset:3072 sc1 lds
v_mfma_f32_16x16x32_bf16 v[220:223], a[132:135], a[60:63], v[220:223]
s_waitcnt lgkmcnt(2)
ds_write_b64 v14, v[12:13] offset:16640
v_mul_u32_u24 v14, 4160, v11
v_mfma_f32_16x16x32_bf16 v[224:227], a[136:139], a[0:3], v[224:227]
s_waitcnt lgkmcnt(0)
v_lshl_add_u32 v14, v10, 2, v14
v_add_u32 v14, s84, v14
v_mfma_f32_16x16x32_bf16 v[224:227], a[140:143], a[4:7], v[224:227]
ds_write_b32 v14, v12
v_mul_f32 v36, s68, v36
v_mfma_f32_16x16x32_bf16 v[228:231], a[136:139], a[8:11], v[228:231]
v_mul_f32 v37, s68, v37
v_mul_f32 v38, s68, v38
v_mfma_f32_16x16x32_bf16 v[228:231], a[140:143], a[12:15], v[228:231]
v_mul_f32 v39, s68, v39
v_mul_f32 v100, s68, v100
v_mfma_f32_16x16x32_bf16 v[232:235], a[136:139], a[16:19], v[232:235]
v_mul_f32 v101, s68, v101
v_mul_f32 v102, s68, v102
v_mfma_f32_16x16x32_bf16 v[232:235], a[140:143], a[20:23], v[232:235]
v_mul_f32 v103, s68, v103
v_cvt_pk_bf16_f32 v36, v36, v37
v_mfma_f32_16x16x32_bf16 v[236:239], a[136:139], a[24:27], v[236:239]
v_cvt_pk_bf16_f32 v37, v38, v39
v_cvt_pk_bf16_f32 v38, v100, v101
v_mfma_f32_16x16x32_bf16 v[236:239], a[140:143], a[28:31], v[236:239]
v_cvt_pk_bf16_f32 v39, v102, v103
v_mul_f32 v44, s68, v44
v_mfma_f32_16x16x32_bf16 v[240:243], a[136:139], a[32:35], v[240:243]
v_mul_f32 v45, s68, v45
v_mul_f32 v46, s68, v46
v_mfma_f32_16x16x32_bf16 v[240:243], a[140:143], a[36:39], v[240:243]
v_mul_f32 v47, s68, v47
v_mul_f32 v108, s68, v108
v_mfma_f32_16x16x32_bf16 v[244:247], a[136:139], a[40:43], v[244:247]
v_mul_f32 v109, s68, v109
v_mul_f32 v110, s68, v110
v_mfma_f32_16x16x32_bf16 v[244:247], a[140:143], a[44:47], v[244:247]
v_mul_f32 v111, s68, v111
v_cvt_pk_bf16_f32 v44, v44, v45
v_mfma_f32_16x16x32_bf16 v[248:251], a[136:139], a[48:51], v[248:251]
v_cvt_pk_bf16_f32 v45, v46, v47
v_cvt_pk_bf16_f32 v46, v108, v109
v_mfma_f32_16x16x32_bf16 v[248:251], a[140:143], a[52:55], v[248:251]
v_cvt_pk_bf16_f32 v47, v110, v111
v_mfma_f32_16x16x32_bf16 v[252:255], a[136:139], a[56:59], v[252:255]
v_mfma_f32_16x16x32_bf16 v[252:255], a[140:143], a[60:63], v[252:255]
s_mov_b64 s[60:61], s[74:75]
s_mov_b32 s62, 896
s_lshl_b32 s79, s85, 1
buffer_load_short_d16_hi v19, off, s[60:63], s79
s_lshl_b32 s83, s85, 12
s_add_u32 s83, s83, 88080384
v_pk_mul_f32 v[52:53], v[52:53], s[68:69]
v_pk_mul_f32 v[54:55], v[54:55], s[68:69]
v_pk_mul_f32 v[116:117], v[116:117], s[68:69]
v_pk_mul_f32 v[118:119], v[118:119], s[68:69]
v_cvt_pk_bf16_f32 v52, v52, v53
v_cvt_pk_bf16_f32 v53, v54, v55
v_cvt_pk_bf16_f32 v54, v116, v117
v_cvt_pk_bf16_f32 v55, v118, v119
v_pk_mul_f32 v[60:61], v[60:61], s[68:69]
v_pk_mul_f32 v[62:63], v[62:63], s[68:69]
v_pk_mul_f32 v[124:125], v[124:125], s[68:69]
v_pk_mul_f32 v[126:127], v[126:127], s[68:69]
v_cvt_pk_bf16_f32 v60, v60, v61
v_cvt_pk_bf16_f32 v61, v62, v63
v_cvt_pk_bf16_f32 v62, v124, v125
v_cvt_pk_bf16_f32 v63, v126, v127
v_pk_mul_f32 v[68:69], v[68:69], s[68:69]
v_pk_mul_f32 v[70:71], v[70:71], s[68:69]
v_pk_mul_f32 v[132:133], v[132:133], s[68:69]
v_pk_mul_f32 v[134:135], v[134:135], s[68:69]
v_cvt_pk_bf16_f32 v68, v68, v69
v_cvt_pk_bf16_f32 v69, v70, v71
v_cvt_pk_bf16_f32 v70, v132, v133
v_cvt_pk_bf16_f32 v71, v134, v135
v_pk_mul_f32 v[76:77], v[76:77], s[68:69]
v_pk_mul_f32 v[78:79], v[78:79], s[68:69]
v_pk_mul_f32 v[140:141], v[140:141], s[68:69]
v_pk_mul_f32 v[142:143], v[142:143], s[68:69]
v_cvt_pk_bf16_f32 v76, v76, v77
v_cvt_pk_bf16_f32 v77, v78, v79
v_cvt_pk_bf16_f32 v78, v140, v141
v_cvt_pk_bf16_f32 v79, v142, v143
v_pk_mul_f32 v[84:85], v[84:85], s[68:69]
v_pk_mul_f32 v[86:87], v[86:87], s[68:69]
v_pk_mul_f32 v[148:149], v[148:149], s[68:69]
v_pk_mul_f32 v[150:151], v[150:151], s[68:69]
v_cvt_pk_bf16_f32 v84, v84, v85
v_cvt_pk_bf16_f32 v85, v86, v87
v_cvt_pk_bf16_f32 v86, v148, v149
v_cvt_pk_bf16_f32 v87, v150, v151
v_pk_mul_f32 v[92:93], v[92:93], s[68:69]
v_pk_mul_f32 v[94:95], v[94:95], s[68:69]
v_pk_mul_f32 v[156:157], v[156:157], s[68:69]
v_pk_mul_f32 v[158:159], v[158:159], s[68:69]
v_cvt_pk_bf16_f32 v92, v92, v93
v_cvt_pk_bf16_f32 v93, v94, v95
v_cvt_pk_bf16_f32 v94, v156, v157
v_cvt_pk_bf16_f32 v95, v158, v159
v_pk_mul_f32 v[164:165], v[164:165], s[68:69]
v_pk_mul_f32 v[166:167], v[166:167], s[68:69]
v_pk_mul_f32 v[224:225], v[224:225], s[68:69]
v_pk_mul_f32 v[226:227], v[226:227], s[68:69]
v_cvt_pk_bf16_f32 v164, v164, v165
v_cvt_pk_bf16_f32 v165, v166, v167
v_cvt_pk_bf16_f32 v166, v224, v225
v_cvt_pk_bf16_f32 v167, v226, v227
v_pk_mul_f32 v[172:173], v[172:173], s[68:69]
v_pk_mul_f32 v[174:175], v[174:175], s[68:69]
v_pk_mul_f32 v[228:229], v[228:229], s[68:69]
v_pk_mul_f32 v[230:231], v[230:231], s[68:69]
v_cvt_pk_bf16_f32 v172, v172, v173
v_cvt_pk_bf16_f32 v173, v174, v175
v_cvt_pk_bf16_f32 v174, v228, v229
v_cvt_pk_bf16_f32 v175, v230, v231
v_pk_mul_f32 v[180:181], v[180:181], s[68:69]
v_pk_mul_f32 v[182:183], v[182:183], s[68:69]
v_pk_mul_f32 v[232:233], v[232:233], s[68:69]
v_pk_mul_f32 v[234:235], v[234:235], s[68:69]
v_cvt_pk_bf16_f32 v180, v180, v181
v_cvt_pk_bf16_f32 v181, v182, v183
v_cvt_pk_bf16_f32 v182, v232, v233
v_cvt_pk_bf16_f32 v183, v234, v235
v_pk_mul_f32 v[188:189], v[188:189], s[68:69]
v_pk_mul_f32 v[190:191], v[190:191], s[68:69]
v_pk_mul_f32 v[236:237], v[236:237], s[68:69]
v_pk_mul_f32 v[238:239], v[238:239], s[68:69]
v_cvt_pk_bf16_f32 v188, v188, v189
v_cvt_pk_bf16_f32 v189, v190, v191
v_cvt_pk_bf16_f32 v190, v236, v237
v_cvt_pk_bf16_f32 v191, v238, v239
v_pk_mul_f32 v[196:197], v[196:197], s[68:69]
v_pk_mul_f32 v[198:199], v[198:199], s[68:69]
v_pk_mul_f32 v[240:241], v[240:241], s[68:69]
v_pk_mul_f32 v[242:243], v[242:243], s[68:69]
v_cvt_pk_bf16_f32 v196, v196, v197
v_cvt_pk_bf16_f32 v197, v198, v199
v_cvt_pk_bf16_f32 v198, v240, v241
v_cvt_pk_bf16_f32 v199, v242, v243
v_pk_mul_f32 v[204:205], v[204:205], s[68:69]
v_pk_mul_f32 v[206:207], v[206:207], s[68:69]
v_pk_mul_f32 v[244:245], v[244:245], s[68:69]
v_pk_mul_f32 v[246:247], v[246:247], s[68:69]
v_cvt_pk_bf16_f32 v204, v204, v205
v_cvt_pk_bf16_f32 v205, v206, v207
v_cvt_pk_bf16_f32 v206, v244, v245
v_cvt_pk_bf16_f32 v207, v246, v247
v_pk_mul_f32 v[212:213], v[212:213], s[68:69]
v_pk_mul_f32 v[214:215], v[214:215], s[68:69]
v_pk_mul_f32 v[248:249], v[248:249], s[68:69]
v_pk_mul_f32 v[250:251], v[250:251], s[68:69]
v_cvt_pk_bf16_f32 v212, v212, v213
v_cvt_pk_bf16_f32 v213, v214, v215
v_cvt_pk_bf16_f32 v214, v248, v249
v_cvt_pk_bf16_f32 v215, v250, v251
v_pk_mul_f32 v[220:221], v[220:221], s[68:69]
v_pk_mul_f32 v[222:223], v[222:223], s[68:69]
v_pk_mul_f32 v[252:253], v[252:253], s[68:69]
v_pk_mul_f32 v[254:255], v[254:255], s[68:69]
v_cvt_pk_bf16_f32 v220, v220, v221
v_cvt_pk_bf16_f32 v221, v222, v223
v_cvt_pk_bf16_f32 v222, v252, v253
v_cvt_pk_bf16_f32 v223, v254, v255
s_waitcnt vmcnt(1) lgkmcnt(0)
ds_read_b64_tr_b16 a[128:129], v16 offset:8
ds_read_b64_tr_b16 a[130:131], v16 offset:0
ds_read_b128 a[160:163], v17 offset:448
ds_read_b64_tr_b16 a[132:133], v16 offset:520
ds_read_b64_tr_b16 a[134:135], v16 offset:512
ds_read_b128 a[164:167], v17 offset:960
ds_read_b64_tr_b16 a[136:137], v16 offset:1032
ds_read_b64_tr_b16 a[138:139], v16 offset:1024
ds_read_b128 a[168:171], v17 offset:1472
ds_read_b64_tr_b16 a[140:141], v16 offset:1544
ds_read_b64_tr_b16 a[142:143], v16 offset:1536
ds_read_b128 a[172:175], v17 offset:1984
ds_read_b64_tr_b16 a[144:145], v16 offset:2056
ds_read_b64_tr_b16 a[146:147], v16 offset:2048
ds_read_b128 a[176:179], v17 offset:2496
ds_read_b64_tr_b16 a[148:149], v16 offset:2568
ds_read_b64_tr_b16 a[150:151], v16 offset:2560
ds_read_b128 a[180:183], v17 offset:3008
ds_read_b64_tr_b16 a[152:153], v16 offset:3080
ds_read_b64_tr_b16 a[154:155], v16 offset:3072
ds_read_b128 a[184:187], v17 offset:3520
ds_read_b64_tr_b16 a[156:157], v16 offset:3592
ds_read_b64_tr_b16 a[158:159], v16 offset:3584
ds_read_b128 a[188:191], v17 offset:4032
s_waitcnt lgkmcnt(15)
v_mfma_f32_16x16x32_bf16 v[32:35], a[128:131], a[160:163], 0
s_waitcnt lgkmcnt(15)
s_add_u32 s23, s67, 0
ds_read_b64_tr_b16 a[192:193], v16 offset:72
v_lshrrev_b32 v3, 6, v0
v_mfma_f32_16x16x32_bf16 v[40:43], a[128:131], a[164:167], 0
ds_read_b64_tr_b16 a[194:195], v16 offset:64
v_and_b32 v4, 63, v0
v_mfma_f32_16x16x32_bf16 v[40:43], a[132:135], a[160:163], v[40:43]
ds_read_b128 a[224:227], v17 offset:384
v_add_u32 v2, 0x10000, v1
v_mfma_f32_16x16x32_bf16 v[48:51], a[128:131], a[168:171], 0
buffer_store_dwordx4 v[164:167], v1, s[4:7], s23 offen offset:1024
v_mfma_f32_16x16x32_bf16 v[48:51], a[132:135], a[164:167], v[48:51]
s_add_u32 s23, s67, 8192
ds_read_b64_tr_b16 a[196:197], v16 offset:584
v_and_b32 v5, 15, v4
v_mfma_f32_16x16x32_bf16 v[48:51], a[136:139], a[160:163], v[48:51]
s_waitcnt lgkmcnt(15)
ds_read_b64_tr_b16 a[198:199], v16 offset:576
v_lshrrev_b32 v6, 4, v4
v_mfma_f32_16x16x32_bf16 v[56:59], a[128:131], a[172:175], 0
ds_read_b128 a[228:231], v17 offset:896
v_lshlrev_b32 v6, 2, v6
v_mfma_f32_16x16x32_bf16 v[56:59], a[132:135], a[168:171], v[56:59]
buffer_store_dwordx4 v[172:175], v1, s[4:7], s23 offen offset:1024
v_mfma_f32_16x16x32_bf16 v[56:59], a[136:139], a[164:167], v[56:59]
s_add_u32 s23, s67, 16384
ds_read_b64_tr_b16 a[200:201], v16 offset:1096
v_sub_u32 v5, v5, v6
v_mfma_f32_16x16x32_bf16 v[56:59], a[140:143], a[160:163], v[56:59]
s_waitcnt lgkmcnt(15)
ds_read_b64_tr_b16 a[202:203], v16 offset:1088
v_lshl_add_u32 v5, v3, 4, v5
v_mfma_f32_16x16x32_bf16 v[64:67], a[128:131], a[176:179], 0
ds_read_b128 a[232:235], v17 offset:1408
v_cmp_gt_i32 s[32:33], 0, v5
v_mfma_f32_16x16x32_bf16 v[64:67], a[132:135], a[172:175], v[64:67]
buffer_store_dwordx4 v[180:183], v1, s[4:7], s23 offen offset:1024
v_mfma_f32_16x16x32_bf16 v[64:67], a[136:139], a[168:171], v[64:67]
s_add_u32 s23, s67, 24576
ds_read_b64_tr_b16 a[204:205], v16 offset:1608
v_cmp_gt_i32 s[34:35], 1, v5
v_mfma_f32_16x16x32_bf16 v[64:67], a[140:143], a[164:167], v[64:67]
ds_read_b64_tr_b16 a[206:207], v16 offset:1600
v_cmp_gt_i32 s[36:37], 2, v5
v_mfma_f32_16x16x32_bf16 v[64:67], a[144:147], a[160:163], v[64:67]
s_waitcnt lgkmcnt(15)
ds_read_b128 a[236:239], v17 offset:1920
v_cmp_gt_i32 s[38:39], 3, v5
v_mfma_f32_16x16x32_bf16 v[72:75], a[128:131], a[180:183], 0
buffer_store_dwordx4 v[188:191], v1, s[4:7], s23 offen offset:1024
v_mfma_f32_16x16x32_bf16 v[72:75], a[132:135], a[176:179], v[72:75]
s_add_u32 s23, s67, 32768
ds_read_b64_tr_b16 a[208:209], v16 offset:2120
v_cmp_gt_i32 s[40:41], 16, v5
v_mfma_f32_16x16x32_bf16 v[72:75], a[136:139], a[172:175], v[72:75]
ds_read_b64_tr_b16 a[210:211], v16 offset:2112
v_cmp_gt_i32 s[42:43], 17, v5
v_mfma_f32_16x16x32_bf16 v[72:75], a[140:143], a[168:171], v[72:75]
ds_read_b128 a[240:243], v17 offset:2432
v_cmp_gt_i32 s[44:45], 18, v5
v_mfma_f32_16x16x32_bf16 v[72:75], a[144:147], a[164:167], v[72:75]
s_waitcnt lgkmcnt(15)
buffer_store_dwordx4 v[196:199], v1, s[4:7], s23 offen offset:1024
v_mfma_f32_16x16x32_bf16 v[72:75], a[148:151], a[160:163], v[72:75]
s_add_u32 s23, s67, 40960
ds_read_b64_tr_b16 a[212:213], v16 offset:2632
v_cmp_gt_i32 s[46:47], 19, v5
v_mfma_f32_16x16x32_bf16 v[80:83], a[128:131], a[184:187], 0
ds_read_b64_tr_b16 a[214:215], v16 offset:2624
v_cmp_gt_i32 s[48:49], 32, v5
v_mfma_f32_16x16x32_bf16 v[80:83], a[132:135], a[180:183], v[80:83]
ds_read_b128 a[244:247], v17 offset:2944
v_cmp_gt_i32 s[50:51], 33, v5
v_mfma_f32_16x16x32_bf16 v[80:83], a[136:139], a[176:179], v[80:83]
buffer_store_dwordx4 v[204:207], v1, s[4:7], s23 offen offset:1024
v_mfma_f32_16x16x32_bf16 v[80:83], a[140:143], a[172:175], v[80:83]
s_add_u32 s23, s67, 49152
ds_read_b64_tr_b16 a[216:217], v16 offset:3144
v_cmp_gt_i32 s[52:53], 34, v5
v_mfma_f32_16x16x32_bf16 v[80:83], a[144:147], a[168:171], v[80:83]
ds_read_b64_tr_b16 a[218:219], v16 offset:3136
v_cmp_gt_i32 s[54:55], 35, v5
v_mfma_f32_16x16x32_bf16 v[80:83], a[148:151], a[164:167], v[80:83]
ds_read_b128 a[248:251], v17 offset:3456
v_cmp_gt_i32 s[56:57], 48, v5
v_mfma_f32_16x16x32_bf16 v[80:83], a[152:155], a[160:163], v[80:83]
buffer_store_dwordx4 v[212:215], v1, s[4:7], s23 offen offset:1024
v_mfma_f32_16x16x32_bf16 v[88:91], a[128:131], a[188:191], 0
s_add_u32 s23, s67, 57344
ds_read_b64_tr_b16 a[220:221], v16 offset:3656
v_cmp_gt_i32 s[58:59], 49, v5
v_mfma_f32_16x16x32_bf16 v[88:91], a[132:135], a[184:187], v[88:91]
ds_read_b64_tr_b16 a[222:223], v16 offset:3648
v_cmp_gt_i32 s[60:61], 50, v5
v_mfma_f32_16x16x32_bf16 v[88:91], a[136:139], a[180:183], v[88:91]
ds_read_b128 a[252:255], v17 offset:3968
v_cmp_gt_i32 s[62:63], 51, v5
v_mfma_f32_16x16x32_bf16 v[88:91], a[140:143], a[176:179], v[88:91]
s_waitcnt lgkmcnt(15)
buffer_store_dwordx4 v[220:223], v1, s[4:7], s23 offen offset:1024
v_mfma_f32_16x16x32_bf16 v[88:91], a[144:147], a[172:175], v[88:91]
s_add_u32 s23, s67, 0
buffer_store_dwordx4 v[36:39], v1, s[4:7], s23 offen offset:0
v_mfma_f32_16x16x32_bf16 v[88:91], a[148:151], a[168:171], v[88:91]
s_add_u32 s23, s67, 8192
buffer_store_dwordx4 v[44:47], v1, s[4:7], s23 offen offset:0
v_mfma_f32_16x16x32_bf16 v[88:91], a[152:155], a[164:167], v[88:91]
s_add_u32 s23, s67, 16384
buffer_store_dwordx4 v[52:55], v1, s[4:7], s23 offen offset:0
v_mfma_f32_16x16x32_bf16 v[88:91], a[156:159], a[160:163], v[88:91]
s_add_u32 s23, s67, 24576
buffer_store_dwordx4 v[60:63], v1, s[4:7], s23 offen offset:0
v_mfma_f32_16x16x32_bf16 v[32:35], a[192:195], a[224:227], v[32:35]
s_add_u32 s23, s67, 32768
ds_read_b64_tr_b16 a[128:129], v16 offset:136
v_mov_b32 v7, 0xff800000
v_mfma_f32_16x16x32_bf16 v[40:43], a[192:195], a[228:231], v[40:43]
ds_read_b64_tr_b16 a[130:131], v16 offset:128
v_mov_b32 v6, 1
v_mfma_f32_16x16x32_bf16 v[40:43], a[196:199], a[224:227], v[40:43]
ds_read_b128 a[160:163], v17 offset:320
v_mov_b32 v5, v26
v_mfma_f32_16x16x32_bf16 v[48:51], a[192:195], a[232:235], v[48:51]
buffer_store_dwordx4 v[68:71], v1, s[4:7], s23 offen offset:0
v_mfma_f32_16x16x32_bf16 v[48:51], a[196:199], a[228:231], v[48:51]
s_add_u32 s23, s67, 40960
ds_read_b64_tr_b16 a[132:133], v16 offset:648
v_mov_b32 v24, 0
v_mfma_f32_16x16x32_bf16 v[48:51], a[200:203], a[224:227], v[48:51]
s_waitcnt lgkmcnt(15)
ds_read_b64_tr_b16 a[134:135], v16 offset:640
v_mov_b32 v25, 0
v_mfma_f32_16x16x32_bf16 v[56:59], a[192:195], a[236:239], v[56:59]
ds_read_b128 a[164:167], v17 offset:832
v_mov_b32 v128, 0
v_mfma_f32_16x16x32_bf16 v[56:59], a[196:199], a[232:235], v[56:59]
buffer_store_dwordx4 v[76:79], v1, s[4:7], s23 offen offset:0
v_mfma_f32_16x16x32_bf16 v[56:59], a[200:203], a[228:231], v[56:59]
s_add_u32 s23, s67, 49152
ds_read_b64_tr_b16 a[136:137], v16 offset:1160
v_mov_b32 v129, 0
v_mfma_f32_16x16x32_bf16 v[56:59], a[204:207], a[224:227], v[56:59]
s_waitcnt lgkmcnt(15)
ds_read_b64_tr_b16 a[138:139], v16 offset:1152
v_mov_b32 v130, 0
v_mfma_f32_16x16x32_bf16 v[64:67], a[192:195], a[240:243], v[64:67]
ds_read_b128 a[168:171], v17 offset:1344
v_mov_b32 v131, 0
v_mfma_f32_16x16x32_bf16 v[64:67], a[196:199], a[236:239], v[64:67]
buffer_store_dwordx4 v[84:87], v1, s[4:7], s23 offen offset:0
v_mfma_f32_16x16x32_bf16 v[64:67], a[200:203], a[232:235], v[64:67]
s_add_u32 s23, s67, 57344
ds_read_b64_tr_b16 a[140:141], v16 offset:1672
v_mov_b32 v132, 0
v_mfma_f32_16x16x32_bf16 v[64:67], a[204:207], a[228:231], v[64:67]
ds_read_b64_tr_b16 a[142:143], v16 offset:1664
v_mov_b32 v133, 0
v_mfma_f32_16x16x32_bf16 v[64:67], a[208:211], a[224:227], v[64:67]
s_waitcnt lgkmcnt(15)
ds_read_b128 a[172:175], v17 offset:1856
v_mov_b32 v134, 0
v_mfma_f32_16x16x32_bf16 v[72:75], a[192:195], a[244:247], v[72:75]
s_waitcnt lgkmcnt(15)
buffer_store_dwordx4 v[92:95], v1, s[4:7], s23 offen offset:0
v_mfma_f32_16x16x32_bf16 v[72:75], a[196:199], a[240:243], v[72:75]
s_lshl_b32 s18, s3, 13
ds_read_b64_tr_b16 a[144:145], v16 offset:2184
v_mov_b32 v135, 0
v_mfma_f32_16x16x32_bf16 v[72:75], a[200:203], a[236:239], v[72:75]
s_lshl_b32 s30, s20, 20
ds_read_b64_tr_b16 a[146:147], v16 offset:2176
v_mov_b32 v136, 0
v_mfma_f32_16x16x32_bf16 v[72:75], a[204:207], a[232:235], v[72:75]
s_add_u32 s30, s30, s18
ds_read_b128 a[176:179], v17 offset:2368
v_mov_b32 v137, 0
v_mfma_f32_16x16x32_bf16 v[72:75], a[208:211], a[228:231], v[72:75]
s_lshl_b32 s22, s21, 1
v_mov_b32 v138, 0
v_mov_b32 v139, 0
v_mfma_f32_16x16x32_bf16 v[72:75], a[212:215], a[224:227], v[72:75]
s_mov_b32 s8, s30
ds_read_b64_tr_b16 a[148:149], v16 offset:2696
v_mov_b32 v140, 0
v_mfma_f32_16x16x32_bf16 v[80:83], a[192:195], a[248:251], v[80:83]
s_sub_u32 s9, 14, s22
ds_read_b64_tr_b16 a[150:151], v16 offset:2688
v_mov_b32 v141, 0
v_mfma_f32_16x16x32_bf16 v[80:83], a[196:199], a[244:247], v[80:83]
s_mov_b32 s10, s30
ds_read_b128 a[180:183], v17 offset:2880
v_mov_b32 v142, 0
v_mfma_f32_16x16x32_bf16 v[80:83], a[200:203], a[240:243], v[80:83]
s_add_u32 s11, s22, 2
v_mov_b32 v143, 0
v_mov_b32 v144, 0
v_mfma_f32_16x16x32_bf16 v[80:83], a[204:207], a[236:239], v[80:83]
s_add_u32 s14, s30, 16777216
ds_read_b64_tr_b16 a[152:153], v16 offset:3208
v_mov_b32 v145, 0
v_mfma_f32_16x16x32_bf16 v[80:83], a[208:211], a[232:235], v[80:83]
s_sub_u32 s19, 7, s21
ds_read_b64_tr_b16 a[154:155], v16 offset:3200
v_mov_b32 v146, 0
v_mfma_f32_16x16x32_bf16 v[80:83], a[212:215], a[228:231], v[80:83]
s_mov_b32 s24, 2
ds_read_b128 a[184:187], v17 offset:3392
v_mov_b32 v147, 0
v_mfma_f32_16x16x32_bf16 v[80:83], a[216:219], a[224:227], v[80:83]
s_waitcnt lgkmcnt(15)
s_sub_u32 s29, 15, s21
v_mov_b32 v148, 0
v_mov_b32 v149, 0
v_mfma_f32_16x16x32_bf16 v[88:91], a[192:195], a[252:255], v[88:91]
s_add_u32 s12, s8, 16777216
ds_read_b64_tr_b16 a[156:157], v16 offset:3720
v_mov_b32 v150, 0
v_mfma_f32_16x16x32_bf16 v[88:91], a[196:199], a[248:251], v[88:91]
s_mov_b32 s13, s9
ds_read_b64_tr_b16 a[158:159], v16 offset:3712
v_mov_b32 v151, 0
v_mfma_f32_16x16x32_bf16 v[88:91], a[200:203], a[244:247], v[88:91]
s_mov_b32 s15, s11
ds_read_b128 a[188:191], v17 offset:3904
v_mov_b32 v152, 0
v_mfma_f32_16x16x32_bf16 v[88:91], a[204:207], a[240:243], v[88:91]
s_mov_b32 s25, 1266679808
v_mov_b32 v153, 0
v_mov_b32 v154, 0
v_mfma_f32_16x16x32_bf16 v[88:91], a[208:211], a[236:239], v[88:91]
s_lshl_b32 s22, s21, 3
v_mov_b32 v155, 0
v_mov_b32 v156, 0
v_mfma_f32_16x16x32_bf16 v[88:91], a[212:215], a[232:235], v[88:91]
s_add_u32 s28, s70, s22
v_mov_b32 v157, 0
v_mov_b32 v158, 0
v_mfma_f32_16x16x32_bf16 v[88:91], a[216:219], a[228:231], v[88:91]
s_add_u32 s28, s28, 4100
v_mov_b32 v159, 0
v_mov_b32 v160, 0
v_mfma_f32_16x16x32_bf16 v[88:91], a[220:223], a[224:227], v[88:91]
s_lshl_b32 s26, s21, 16
v_mov_b32 v161, 0
v_mov_b32 v162, 0
v_mfma_f32_16x16x32_bf16 v[32:35], a[128:131], a[160:163], v[32:35]
s_add_u32 s26, s26, s30
ds_read_b64_tr_b16 a[192:193], v16 offset:200
v_mov_b32 v163, 0
v_mfma_f32_16x16x32_bf16 v[40:43], a[128:131], a[164:167], v[40:43]
s_add_u32 s26, s26, 33554432
ds_read_b64_tr_b16 a[194:195], v16 offset:192
v_mov_b32 v164, 0
v_mfma_f32_16x16x32_bf16 v[40:43], a[132:135], a[160:163], v[40:43]
s_waitcnt lgkmcnt(14)
s_lshl_b32 s76, s20, 3
ds_read_b128 a[224:227], v17 offset:256
v_mov_b32 v165, 0
v_mfma_f32_16x16x32_bf16 v[48:51], a[128:131], a[168:171], v[48:51]
s_add_u32 s76, s76, s21
v_mov_b32 v166, 0
v_mov_b32 v167, 0
v_mfma_f32_16x16x32_bf16 v[48:51], a[132:135], a[164:167], v[48:51]
s_lshl_b32 s76, s76, 2
ds_read_b64_tr_b16 a[196:197], v16 offset:712
v_mov_b32 v168, 0
v_mfma_f32_16x16x32_bf16 v[48:51], a[136:139], a[160:163], v[48:51]
s_add_u32 s76, s76, s3
ds_read_b64_tr_b16 a[198:199], v16 offset:704
v_mov_b32 v169, 0
v_mfma_f32_16x16x32_bf16 v[56:59], a[128:131], a[172:175], v[56:59]
s_lshl_b32 s27, s76, 10
ds_read_b128 a[228:231], v17 offset:768
v_mov_b32 v170, 0
v_mfma_f32_16x16x32_bf16 v[56:59], a[132:135], a[168:171], v[56:59]
s_add_u32 s27, s27, 75497472
v_mov_b32 v171, 0
v_mov_b32 v172, 0
v_mfma_f32_16x16x32_bf16 v[56:59], a[136:139], a[164:167], v[56:59]
s_lshl_b32 s76, s76, 14
ds_read_b64_tr_b16 a[200:201], v16 offset:1224
v_mov_b32 v173, 0
v_mfma_f32_16x16x32_bf16 v[56:59], a[140:143], a[160:163], v[56:59]
s_waitcnt lgkmcnt(13)
s_add_u32 s76, s76, 67108864
ds_read_b64_tr_b16 a[202:203], v16 offset:1216
v_mov_b32 v174, 0
v_mfma_f32_16x16x32_bf16 v[64:67], a[128:131], a[176:179], v[64:67]
s_lshl_b32 s81, s20, 2
ds_read_b128 a[232:235], v17 offset:1280
v_mov_b32 v175, 0
v_mfma_f32_16x16x32_bf16 v[64:67], a[132:135], a[172:175], v[64:67]
s_add_u32 s81, s81, s3
v_mov_b32 v176, 0
v_mov_b32 v177, 0
v_mfma_f32_16x16x32_bf16 v[64:67], a[136:139], a[168:171], v[64:67]
s_mul_i32 s81, s81, 57344
ds_read_b64_tr_b16 a[204:205], v16 offset:1736
v_mov_b32 v178, 0
v_mfma_f32_16x16x32_bf16 v[64:67], a[140:143], a[164:167], v[64:67]
s_cmp_eq_u32 s24, 1
ds_read_b64_tr_b16 a[206:207], v16 offset:1728
v_mov_b32 v179, 0
v_mfma_f32_16x16x32_bf16 v[64:67], a[144:147], a[160:163], v[64:67]
s_cselect_b32 s80, s28, s70
ds_read_b128 a[236:239], v17 offset:1792
v_mov_b32 v180, 0
v_mfma_f32_16x16x32_bf16 v[72:75], a[128:131], a[180:183], v[72:75]
s_cselect_b32 s77, s76, 3221225472
v_mov_b32 v181, 0
v_mov_b32 v182, 0
v_mfma_f32_16x16x32_bf16 v[72:75], a[132:135], a[176:179], v[72:75]
s_cselect_b32 s78, s27, 3221225472
ds_read_b64_tr_b16 a[208:209], v16 offset:2248
v_mov_b32 v183, 0
v_mfma_f32_16x16x32_bf16 v[72:75], a[136:139], a[172:175], v[72:75]
s_lshl_b32 s71, s2, 2
ds_read_b64_tr_b16 a[210:211], v16 offset:2240
v_mov_b32 v184, 0
v_mfma_f32_16x16x32_bf16 v[72:75], a[140:143], a[168:171], v[72:75]
s_add_u32 s71, s71, 94384128
ds_read_b128 a[240:243], v17 offset:2304
v_mov_b32 v185, 0
v_mfma_f32_16x16x32_bf16 v[72:75], a[144:147], a[164:167], v[72:75]
s_lshl_b32 s31, s29, 16
v_mov_b32 v186, 0
v_mov_b32 v187, 0
v_mfma_f32_16x16x32_bf16 v[72:75], a[148:151], a[160:163], v[72:75]
s_waitcnt lgkmcnt(15)
s_add_u32 s31, s31, s30
ds_read_b64_tr_b16 a[212:213], v16 offset:2760
v_mov_b32 v188, 0
v_mfma_f32_16x16x32_bf16 v[80:83], a[128:131], a[184:187], v[80:83]
s_add_u32 s31, s31, 33554432
ds_read_b64_tr_b16 a[214:215], v16 offset:2752
v_mov_b32 v189, 0
v_mfma_f32_16x16x32_bf16 v[80:83], a[132:135], a[180:183], v[80:83]
s_lshl_b32 s22, s21, 3
ds_read_b128 a[244:247], v17 offset:2816
v_mov_b32 v190, 0
v_mfma_f32_16x16x32_bf16 v[80:83], a[136:139], a[176:179], v[80:83]
s_add_u32 s22, s22, 64
v_mov_b32 v191, 0
v_mov_b32 v192, 0
v_mfma_f32_16x16x32_bf16 v[80:83], a[140:143], a[172:175], v[80:83]
ds_read_b64_tr_b16 a[216:217], v16 offset:3272
v_lshrrev_b32 v15, 2, v1
v_mfma_f32_16x16x32_bf16 v[80:83], a[144:147], a[168:171], v[80:83]
ds_read_b64_tr_b16 a[218:219], v16 offset:3264
v_mov_b32 v14, s22
v_mfma_f32_16x16x32_bf16 v[80:83], a[148:151], a[164:167], v[80:83]
ds_read_b128 a[248:251], v17 offset:3328
v_cmp_gt_u32 vcc, 64, v15
v_mfma_f32_16x16x32_bf16 v[80:83], a[152:155], a[160:163], v[80:83]
s_nop 0
v_cndmask_b32 v15, v14, v15, vcc
v_mov_b32 v193, 0
v_mfma_f32_16x16x32_bf16 v[88:91], a[128:131], a[188:191], v[88:91]
ds_read_b64_tr_b16 a[220:221], v16 offset:3784
v_mov_b32 v194, 0
v_mfma_f32_16x16x32_bf16 v[88:91], a[132:135], a[184:187], v[88:91]
ds_read_b64_tr_b16 a[222:223], v16 offset:3776
v_mov_b32 v195, 0
v_mfma_f32_16x16x32_bf16 v[88:91], a[136:139], a[180:183], v[88:91]
ds_read_b128 a[252:255], v17 offset:3840
v_mov_b32 v196, 0
v_mfma_f32_16x16x32_bf16 v[88:91], a[140:143], a[176:179], v[88:91]
v_mov_b32 v197, 0
v_mov_b32 v198, 0
v_mfma_f32_16x16x32_bf16 v[88:91], a[144:147], a[172:175], v[88:91]
v_mov_b32 v199, 0
v_mov_b32 v200, 0
v_mfma_f32_16x16x32_bf16 v[88:91], a[148:151], a[168:171], v[88:91]
v_mov_b32 v201, 0
v_mov_b32 v202, 0
v_mfma_f32_16x16x32_bf16 v[88:91], a[152:155], a[164:167], v[88:91]
v_mov_b32 v203, 0
v_mov_b32 v204, 0
v_mfma_f32_16x16x32_bf16 v[88:91], a[156:159], a[160:163], v[88:91]
s_waitcnt lgkmcnt(15)
v_mov_b32 v205, 0
v_mov_b32 v206, 0
v_mfma_f32_16x16x32_bf16 v[32:35], a[192:195], a[224:227], v[32:35]
ds_read_b64_tr_b16 a[128:129], v16 offset:264
v_mov_b32 v207, 0
v_mfma_f32_16x16x32_bf16 v[40:43], a[192:195], a[228:231], v[40:43]
ds_read_b64_tr_b16 a[130:131], v16 offset:256
v_mov_b32 v208, 0
v_mfma_f32_16x16x32_bf16 v[40:43], a[196:199], a[224:227], v[40:43]
ds_read_b128 a[160:163], v17 offset:192
v_mov_b32 v209, 0
v_mfma_f32_16x16x32_bf16 v[48:51], a[192:195], a[232:235], v[48:51]
v_mov_b32 v210, 0
v_mov_b32 v211, 0
v_mfma_f32_16x16x32_bf16 v[48:51], a[196:199], a[228:231], v[48:51]
ds_read_b64_tr_b16 a[132:133], v16 offset:776
v_mov_b32 v212, 0
v_mfma_f32_16x16x32_bf16 v[48:51], a[200:203], a[224:227], v[48:51]
s_waitcnt lgkmcnt(15)
ds_read_b64_tr_b16 a[134:135], v16 offset:768
v_mov_b32 v213, 0
v_mfma_f32_16x16x32_bf16 v[56:59], a[192:195], a[236:239], v[56:59]
ds_read_b128 a[164:167], v17 offset:704
v_mov_b32 v214, 0
v_mfma_f32_16x16x32_bf16 v[56:59], a[196:199], a[232:235], v[56:59]
buffer_load_dword v14, v15, s[4:7], s70 offen sc1
v_mfma_f32_16x16x32_bf16 v[56:59], a[200:203], a[228:231], v[56:59]
ds_read_b64_tr_b16 a[136:137], v16 offset:1288
v_mov_b32 v215, 0
v_mfma_f32_16x16x32_bf16 v[56:59], a[204:207], a[224:227], v[56:59]
s_waitcnt lgkmcnt(15)
ds_read_b64_tr_b16 a[138:139], v16 offset:1280
v_mov_b32 v216, 0
v_mfma_f32_16x16x32_bf16 v[64:67], a[192:195], a[240:243], v[64:67]
ds_read_b128 a[168:171], v17 offset:1216
v_mov_b32 v217, 0
v_mfma_f32_16x16x32_bf16 v[64:67], a[196:199], a[236:239], v[64:67]
v_mov_b32 v218, 0
v_mov_b32 v219, 0
v_mfma_f32_16x16x32_bf16 v[64:67], a[200:203], a[232:235], v[64:67]
ds_read_b64_tr_b16 a[140:141], v16 offset:1800
v_mov_b32 v220, 0
v_mfma_f32_16x16x32_bf16 v[64:67], a[204:207], a[228:231], v[64:67]
ds_read_b64_tr_b16 a[142:143], v16 offset:1792
v_mov_b32 v221, 0
v_mfma_f32_16x16x32_bf16 v[64:67], a[208:211], a[224:227], v[64:67]
s_waitcnt lgkmcnt(15)
ds_read_b128 a[172:175], v17 offset:1728
v_mov_b32 v222, 0
v_mfma_f32_16x16x32_bf16 v[72:75], a[192:195], a[244:247], v[72:75]
v_mov_b32 v223, 0
v_mov_b32 v224, 0
v_mfma_f32_16x16x32_bf16 v[72:75], a[196:199], a[240:243], v[72:75]
ds_read_b64_tr_b16 a[144:145], v16 offset:2312
v_mov_b32 v225, 0
v_mfma_f32_16x16x32_bf16 v[72:75], a[200:203], a[236:239], v[72:75]
ds_read_b64_tr_b16 a[146:147], v16 offset:2304
v_mov_b32 v226, 0
v_mfma_f32_16x16x32_bf16 v[72:75], a[204:207], a[232:235], v[72:75]
ds_read_b128 a[176:179], v17 offset:2240
v_mov_b32 v227, 0
v_mfma_f32_16x16x32_bf16 v[72:75], a[208:211], a[228:231], v[72:75]
v_mov_b32 v228, 0
v_mov_b32 v229, 0
v_mfma_f32_16x16x32_bf16 v[72:75], a[212:215], a[224:227], v[72:75]
s_waitcnt lgkmcnt(15)
ds_read_b64_tr_b16 a[148:149], v16 offset:2824
v_mov_b32 v230, 0
v_mfma_f32_16x16x32_bf16 v[80:83], a[192:195], a[248:251], v[80:83]
ds_read_b64_tr_b16 a[150:151], v16 offset:2816
v_mov_b32 v231, 0
v_mfma_f32_16x16x32_bf16 v[80:83], a[196:199], a[244:247], v[80:83]
ds_read_b128 a[180:183], v17 offset:2752
v_mov_b32 v232, 0
v_mfma_f32_16x16x32_bf16 v[80:83], a[200:203], a[240:243], v[80:83]
v_mov_b32 v233, 0
v_mov_b32 v234, 0
v_mfma_f32_16x16x32_bf16 v[80:83], a[204:207], a[236:239], v[80:83]
ds_read_b64_tr_b16 a[152:153], v16 offset:3336
v_mov_b32 v235, 0
v_mfma_f32_16x16x32_bf16 v[80:83], a[208:211], a[232:235], v[80:83]
ds_read_b64_tr_b16 a[154:155], v16 offset:3328
v_mov_b32 v236, 0
v_mfma_f32_16x16x32_bf16 v[80:83], a[212:215], a[228:231], v[80:83]
ds_read_b128 a[184:187], v17 offset:3264
v_mov_b32 v237, 0
v_mfma_f32_16x16x32_bf16 v[80:83], a[216:219], a[224:227], v[80:83]
v_mov_b32 v238, 0
v_mov_b32 v239, 0
v_mfma_f32_16x16x32_bf16 v[88:91], a[192:195], a[252:255], v[88:91]
ds_read_b64_tr_b16 a[156:157], v16 offset:3848
v_mov_b32 v240, 0
v_mfma_f32_16x16x32_bf16 v[88:91], a[196:199], a[248:251], v[88:91]
ds_read_b64_tr_b16 a[158:159], v16 offset:3840
v_mov_b32 v241, 0
v_mfma_f32_16x16x32_bf16 v[88:91], a[200:203], a[244:247], v[88:91]
ds_read_b128 a[188:191], v17 offset:3776
v_mov_b32 v242, 0
v_mfma_f32_16x16x32_bf16 v[88:91], a[204:207], a[240:243], v[88:91]
v_mov_b32 v243, 0
v_mov_b32 v244, 0
v_mfma_f32_16x16x32_bf16 v[88:91], a[208:211], a[236:239], v[88:91]
v_mov_b32 v245, 0
v_mov_b32 v246, 0
v_mfma_f32_16x16x32_bf16 v[88:91], a[212:215], a[232:235], v[88:91]
v_mov_b32 v247, 0
v_mov_b32 v248, 0
v_mfma_f32_16x16x32_bf16 v[88:91], a[216:219], a[228:231], v[88:91]
v_mov_b32 v249, 0
v_mov_b32 v250, 0
v_mfma_f32_16x16x32_bf16 v[88:91], a[220:223], a[224:227], v[88:91]
s_waitcnt lgkmcnt(15)
v_mov_b32 v251, 0
v_mov_b32 v252, 0
s_waitcnt vmcnt(0)
v_cmp_gt_u32 vcc, 1, v14
s_cbranch_vccnz M_cspin
M_cok:
v_mfma_f32_16x16x32_bf16 v[32:35], a[128:131], a[160:163], v[32:35]
s_add_u32 s22, s31, 0
ds_read_b64_tr_b16 a[192:193], v16 offset:328
v_mov_b32 v253, 0
v_mfma_f32_16x16x32_bf16 v[40:43], a[128:131], a[164:167], v[40:43]
ds_read_b64_tr_b16 a[194:195], v16 offset:320
v_mov_b32 v254, 0
v_mfma_f32_16x16x32_bf16 v[40:43], a[132:135], a[160:163], v[40:43]
ds_read_b128 a[224:227], v17 offset:128
v_mov_b32 v255, 0
v_mfma_f32_16x16x32_bf16 v[48:51], a[128:131], a[168:171], v[48:51]
buffer_load_dwordx4 a[0:3], v1, s[4:7], s22 offen offset:0 sc1
v_mfma_f32_16x16x32_bf16 v[48:51], a[132:135], a[164:167], v[48:51]
ds_read_b64_tr_b16 a[196:197], v16 offset:840
v_mfma_f32_16x16x32_bf16 v[48:51], a[136:139], a[160:163], v[48:51]
s_waitcnt lgkmcnt(15)
ds_read_b64_tr_b16 a[198:199], v16 offset:832
v_mfma_f32_16x16x32_bf16 v[56:59], a[128:131], a[172:175], v[56:59]
ds_read_b128 a[228:231], v17 offset:640
v_mfma_f32_16x16x32_bf16 v[56:59], a[132:135], a[168:171], v[56:59]
buffer_load_dwordx4 a[4:7], v1, s[4:7], s22 offen offset:1024 sc1
v_mfma_f32_16x16x32_bf16 v[56:59], a[136:139], a[164:167], v[56:59]
ds_read_b64_tr_b16 a[200:201], v16 offset:1352
v_mfma_f32_16x16x32_bf16 v[56:59], a[140:143], a[160:163], v[56:59]
s_waitcnt lgkmcnt(15)
ds_read_b64_tr_b16 a[202:203], v16 offset:1344
v_mfma_f32_16x16x32_bf16 v[64:67], a[128:131], a[176:179], v[64:67]
ds_read_b128 a[232:235], v17 offset:1152
v_mfma_f32_16x16x32_bf16 v[64:67], a[132:135], a[172:175], v[64:67]
buffer_load_dwordx4 a[8:11], v1, s[4:7], s22 offen offset:2048 sc1
v_mfma_f32_16x16x32_bf16 v[64:67], a[136:139], a[168:171], v[64:67]
ds_read_b64_tr_b16 a[204:205], v16 offset:1864
v_mfma_f32_16x16x32_bf16 v[64:67], a[140:143], a[164:167], v[64:67]
ds_read_b64_tr_b16 a[206:207], v16 offset:1856
v_mfma_f32_16x16x32_bf16 v[64:67], a[144:147], a[160:163], v[64:67]
s_waitcnt lgkmcnt(15)
ds_read_b128 a[236:239], v17 offset:1664
v_mfma_f32_16x16x32_bf16 v[72:75], a[128:131], a[180:183], v[72:75]
buffer_load_dwordx4 a[12:15], v1, s[4:7], s22 offen offset:3072 sc1
v_mfma_f32_16x16x32_bf16 v[72:75], a[132:135], a[176:179], v[72:75]
s_add_u32 s22, s31, 4096
ds_read_b64_tr_b16 a[208:209], v16 offset:2376
v_mfma_f32_16x16x32_bf16 v[72:75], a[136:139], a[172:175], v[72:75]
ds_read_b64_tr_b16 a[210:211], v16 offset:2368
v_mfma_f32_16x16x32_bf16 v[72:75], a[140:143], a[168:171], v[72:75]
ds_read_b128 a[240:243], v17 offset:2176
v_mfma_f32_16x16x32_bf16 v[72:75], a[144:147], a[164:167], v[72:75]
buffer_load_dwordx4 a[16:19], v1, s[4:7], s22 offen offset:0 sc1
v_mfma_f32_16x16x32_bf16 v[72:75], a[148:151], a[160:163], v[72:75]
s_waitcnt lgkmcnt(15)
ds_read_b64_tr_b16 a[212:213], v16 offset:2888
v_mfma_f32_16x16x32_bf16 v[80:83], a[128:131], a[184:187], v[80:83]
ds_read_b64_tr_b16 a[214:215], v16 offset:2880
v_mfma_f32_16x16x32_bf16 v[80:83], a[132:135], a[180:183], v[80:83]
ds_read_b128 a[244:247], v17 offset:2688
v_mfma_f32_16x16x32_bf16 v[80:83], a[136:139], a[176:179], v[80:83]
buffer_load_dwordx4 a[20:23], v1, s[4:7], s22 offen offset:1024 sc1
v_mfma_f32_16x16x32_bf16 v[80:83], a[140:143], a[172:175], v[80:83]
ds_read_b64_tr_b16 a[216:217], v16 offset:3400
v_mfma_f32_16x16x32_bf16 v[80:83], a[144:147], a[168:171], v[80:83]
ds_read_b64_tr_b16 a[218:219], v16 offset:3392
v_mfma_f32_16x16x32_bf16 v[80:83], a[148:151], a[164:167], v[80:83]
ds_read_b128 a[248:251], v17 offset:3200
v_mfma_f32_16x16x32_bf16 v[80:83], a[152:155], a[160:163], v[80:83]
buffer_load_dwordx4 a[24:27], v1, s[4:7], s22 offen offset:2048 sc1
v_mfma_f32_16x16x32_bf16 v[88:91], a[128:131], a[188:191], v[88:91]
ds_read_b64_tr_b16 a[220:221], v16 offset:3912
v_mfma_f32_16x16x32_bf16 v[88:91], a[132:135], a[184:187], v[88:91]
ds_read_b64_tr_b16 a[222:223], v16 offset:3904
v_mfma_f32_16x16x32_bf16 v[88:91], a[136:139], a[180:183], v[88:91]
ds_read_b128 a[252:255], v17 offset:3712
v_mfma_f32_16x16x32_bf16 v[88:91], a[140:143], a[176:179], v[88:91]
buffer_load_dwordx4 a[28:31], v1, s[4:7], s22 offen offset:3072 sc1
v_mfma_f32_16x16x32_bf16 v[88:91], a[144:147], a[172:175], v[88:91]
s_add_u32 s22, s31, 32768
buffer_load_dwordx4 a[32:35], v1, s[4:7], s22 offen offset:0 sc1
v_mfma_f32_16x16x32_bf16 v[88:91], a[148:151], a[168:171], v[88:91]
buffer_load_dwordx4 a[36:39], v1, s[4:7], s22 offen offset:1024 sc1
v_mfma_f32_16x16x32_bf16 v[88:91], a[152:155], a[164:167], v[88:91]
buffer_load_dwordx4 a[40:43], v1, s[4:7], s22 offen offset:2048 sc1
v_mfma_f32_16x16x32_bf16 v[88:91], a[156:159], a[160:163], v[88:91]
s_waitcnt lgkmcnt(15)
buffer_load_dwordx4 a[44:47], v1, s[4:7], s22 offen offset:3072 sc1
v_mfma_f32_16x16x32_bf16 v[32:35], a[192:195], a[224:227], v[32:35]
s_add_u32 s22, s31, 36864
ds_read_b64_tr_b16 a[128:129], v16 offset:392
v_mfma_f32_16x16x32_bf16 v[40:43], a[192:195], a[228:231], v[40:43]
ds_read_b64_tr_b16 a[130:131], v16 offset:384
v_mfma_f32_16x16x32_bf16 v[40:43], a[196:199], a[224:227], v[40:43]
ds_read_b128 a[160:163], v17 offset:64
v_mfma_f32_16x16x32_bf16 v[48:51], a[192:195], a[232:235], v[48:51]
ds_read_b64 v[96:97], v18 offset:0
v_mfma_f32_16x16x32_bf16 v[48:51], a[196:199], a[228:231], v[48:51]
ds_read_b64_tr_b16 a[132:133], v16 offset:904
v_mfma_f32_16x16x32_bf16 v[48:51], a[200:203], a[224:227], v[48:51]
s_waitcnt lgkmcnt(15)
ds_read_b64_tr_b16 a[134:135], v16 offset:896
v_mfma_f32_16x16x32_bf16 v[56:59], a[192:195], a[236:239], v[56:59]
ds_read_b128 a[164:167], v17 offset:576
v_mfma_f32_16x16x32_bf16 v[56:59], a[196:199], a[232:235], v[56:59]
ds_read_b64 v[98:99], v18 offset:512
v_mfma_f32_16x16x32_bf16 v[56:59], a[200:203], a[228:231], v[56:59]
ds_read_b64_tr_b16 a[136:137], v16 offset:1416
v_mfma_f32_16x16x32_bf16 v[56:59], a[204:207], a[224:227], v[56:59]
s_waitcnt lgkmcnt(15)
ds_read_b64_tr_b16 a[138:139], v16 offset:1408
v_mfma_f32_16x16x32_bf16 v[64:67], a[192:195], a[240:243], v[64:67]
ds_read_b128 a[168:171], v17 offset:1088
v_mfma_f32_16x16x32_bf16 v[64:67], a[196:199], a[236:239], v[64:67]
ds_read_b64 v[100:101], v18 offset:1024
v_mfma_f32_16x16x32_bf16 v[64:67], a[200:203], a[232:235], v[64:67]
ds_read_b64_tr_b16 a[140:141], v16 offset:1928
v_mfma_f32_16x16x32_bf16 v[64:67], a[204:207], a[228:231], v[64:67]
ds_read_b64_tr_b16 a[142:143], v16 offset:1920
v_mfma_f32_16x16x32_bf16 v[64:67], a[208:211], a[224:227], v[64:67]
ds_read_b128 a[172:175], v17 offset:1600
v_mfma_f32_16x16x32_bf16 v[72:75], a[192:195], a[244:247], v[72:75]
ds_read_b64 v[102:103], v18 offset:1536
v_mfma_f32_16x16x32_bf16 v[72:75], a[196:199], a[240:243], v[72:75]
ds_read_b64_tr_b16 a[144:145], v16 offset:2440
v_mfma_f32_16x16x32_bf16 v[72:75], a[200:203], a[236:239], v[72:75]
ds_read_b64_tr_b16 a[146:147], v16 offset:2432
v_mfma_f32_16x16x32_bf16 v[72:75], a[204:207], a[232:235], v[72:75]
ds_read_b128 a[176:179], v17 offset:2112
v_mfma_f32_16x16x32_bf16 v[72:75], a[208:211], a[228:231], v[72:75]
ds_read_b64 v[104:105], v18 offset:2048
v_mfma_f32_16x16x32_bf16 v[72:75], a[212:215], a[224:227], v[72:75]
s_waitcnt lgkmcnt(15)
ds_read_b64_tr_b16 a[148:149], v16 offset:2952
v_mfma_f32_16x16x32_bf16 v[80:83], a[192:195], a[248:251], v[80:83]
ds_read_b64_tr_b16 a[150:151], v16 offset:2944
v_mfma_f32_16x16x32_bf16 v[80:83], a[196:199], a[244:247], v[80:83]
ds_read_b128 a[180:183], v17 offset:2624
v_mfma_f32_16x16x32_bf16 v[80:83], a[200:203], a[240:243], v[80:83]
ds_read_b64 v[106:107], v18 offset:2560
v_mfma_f32_16x16x32_bf16 v[80:83], a[204:207], a[236:239], v[80:83]
ds_read_b64_tr_b16 a[152:153], v16 offset:3464
v_mfma_f32_16x16x32_bf16 v[80:83], a[208:211], a[232:235], v[80:83]
ds_read_b64_tr_b16 a[154:155], v16 offset:3456
v_mfma_f32_16x16x32_bf16 v[80:83], a[212:215], a[228:231], v[80:83]
ds_read_b128 a[184:187], v17 offset:3136
v_mfma_f32_16x16x32_bf16 v[80:83], a[216:219], a[224:227], v[80:83]
ds_read_b64 v[108:109], v18 offset:3072
v_mfma_f32_16x16x32_bf16 v[88:91], a[192:195], a[252:255], v[88:91]
ds_read_b64_tr_b16 a[156:157], v16 offset:3976
v_mfma_f32_16x16x32_bf16 v[88:91], a[196:199], a[248:251], v[88:91]
ds_read_b64_tr_b16 a[158:159], v16 offset:3968
v_mfma_f32_16x16x32_bf16 v[88:91], a[200:203], a[244:247], v[88:91]
ds_read_b128 a[188:191], v17 offset:3648
v_mfma_f32_16x16x32_bf16 v[88:91], a[204:207], a[240:243], v[88:91]
ds_read_b64 v[110:111], v18 offset:3584
v_mfma_f32_16x16x32_bf16 v[88:91], a[208:211], a[236:239], v[88:91]
buffer_load_dwordx4 a[48:51], v1, s[4:7], s22 offen offset:0 sc1
v_mfma_f32_16x16x32_bf16 v[88:91], a[212:215], a[232:235], v[88:91]
buffer_load_dwordx4 a[52:55], v1, s[4:7], s22 offen offset:1024 sc1
v_mfma_f32_16x16x32_bf16 v[88:91], a[216:219], a[228:231], v[88:91]
buffer_load_dwordx4 a[56:59], v1, s[4:7], s22 offen offset:2048 sc1
v_mfma_f32_16x16x32_bf16 v[88:91], a[220:223], a[224:227], v[88:91]
buffer_load_dwordx4 a[60:63], v1, s[4:7], s22 offen offset:3072 sc1
v_mfma_f32_16x16x32_bf16 v[32:35], a[128:131], a[160:163], v[32:35]
s_waitcnt lgkmcnt(15)
s_add_u32 m0, s18, 0
ds_read_b64_tr_b16 a[192:193], v16 offset:456
v_mfma_f32_16x16x32_bf16 v[40:43], a[128:131], a[164:167], v[40:43]
ds_read_b64_tr_b16 a[194:195], v16 offset:448
v_mfma_f32_16x16x32_bf16 v[40:43], a[132:135], a[160:163], v[40:43]
ds_read_b128 a[224:227], v17 offset:0
v_mfma_f32_16x16x32_bf16 v[48:51], a[128:131], a[168:171], v[48:51]
buffer_load_dwordx4 v1, s[4:7], s8 offen offset:0 sc1 lds
v_mfma_f32_16x16x32_bf16 v[48:51], a[132:135], a[164:167], v[48:51]
ds_read_b64_tr_b16 a[196:197], v16 offset:968
v_mfma_f32_16x16x32_bf16 v[48:51], a[136:139], a[160:163], v[48:51]
ds_read_b64_tr_b16 a[198:199], v16 offset:960
v_mfma_f32_16x16x32_bf16 v[56:59], a[128:131], a[172:175], v[56:59]
ds_read_b128 a[228:231], v17 offset:512
v_mfma_f32_16x16x32_bf16 v[56:59], a[132:135], a[168:171], v[56:59]
buffer_load_dwordx4 v1, s[4:7], s8 offen offset:1024 sc1 lds
v_mfma_f32_16x16x32_bf16 v[56:59], a[136:139], a[164:167], v[56:59]
ds_read_b64_tr_b16 a[200:201], v16 offset:1480
v_mfma_f32_16x16x32_bf16 v[56:59], a[140:143], a[160:163], v[56:59]
s_waitcnt lgkmcnt(15)
ds_read_b64_tr_b16 a[202:203], v16 offset:1472
v_mfma_f32_16x16x32_bf16 v[64:67], a[128:131], a[176:179], v[64:67]
ds_read_b128 a[232:235], v17 offset:1024
v_mfma_f32_16x16x32_bf16 v[64:67], a[132:135], a[172:175], v[64:67]
buffer_load_dwordx4 v1, s[4:7], s8 offen offset:2048 sc1 lds
v_mfma_f32_16x16x32_bf16 v[64:67], a[136:139], a[168:171], v[64:67]
ds_read_b64_tr_b16 a[204:205], v16 offset:1992
v_mfma_f32_16x16x32_bf16 v[64:67], a[140:143], a[164:167], v[64:67]
ds_read_b64_tr_b16 a[206:207], v16 offset:1984
v_mfma_f32_16x16x32_bf16 v[64:67], a[144:147], a[160:163], v[64:67]
ds_read_b128 a[236:239], v17 offset:1536
v_mfma_f32_16x16x32_bf16 v[72:75], a[128:131], a[180:183], v[72:75]
buffer_load_dwordx4 v1, s[4:7], s8 offen offset:3072 sc1 lds
v_mfma_f32_16x16x32_bf16 v[72:75], a[132:135], a[176:179], v[72:75]
s_add_u32 s8, s8, 4096
ds_read_b64_tr_b16 a[208:209], v16 offset:2504
v_mfma_f32_16x16x32_bf16 v[72:75], a[136:139], a[172:175], v[72:75]
s_add_u32 m0, s18, 4096
ds_read_b64_tr_b16 a[210:211], v16 offset:2496
v_mfma_f32_16x16x32_bf16 v[72:75], a[140:143], a[168:171], v[72:75]
ds_read_b128 a[240:243], v17 offset:2048
v_mfma_f32_16x16x32_bf16 v[72:75], a[144:147], a[164:167], v[72:75]
buffer_load_dwordx4 v1, s[4:7], s8 offen offset:0 sc1 lds
v_mfma_f32_16x16x32_bf16 v[72:75], a[148:151], a[160:163], v[72:75]
s_waitcnt lgkmcnt(15)
ds_read_b64_tr_b16 a[212:213], v16 offset:3016
v_mfma_f32_16x16x32_bf16 v[80:83], a[128:131], a[184:187], v[80:83]
ds_read_b64_tr_b16 a[214:215], v16 offset:3008
v_mfma_f32_16x16x32_bf16 v[80:83], a[132:135], a[180:183], v[80:83]
ds_read_b128 a[244:247], v17 offset:2560
v_mfma_f32_16x16x32_bf16 v[80:83], a[136:139], a[176:179], v[80:83]
buffer_load_dwordx4 v1, s[4:7], s8 offen offset:1024 sc1 lds
v_mfma_f32_16x16x32_bf16 v[80:83], a[140:143], a[172:175], v[80:83]
ds_read_b64_tr_b16 a[216:217], v16 offset:3528
v_mfma_f32_16x16x32_bf16 v[80:83], a[144:147], a[168:171], v[80:83]
ds_read_b64_tr_b16 a[218:219], v16 offset:3520
v_mfma_f32_16x16x32_bf16 v[80:83], a[148:151], a[164:167], v[80:83]
ds_read_b128 a[248:251], v17 offset:3072
v_mfma_f32_16x16x32_bf16 v[80:83], a[152:155], a[160:163], v[80:83]
buffer_load_dwordx4 v1, s[4:7], s8 offen offset:2048 sc1 lds
v_mfma_f32_16x16x32_bf16 v[88:91], a[128:131], a[188:191], v[88:91]
ds_read_b64_tr_b16 a[220:221], v16 offset:4040
v_mfma_f32_16x16x32_bf16 v[88:91], a[132:135], a[184:187], v[88:91]
ds_read_b64_tr_b16 a[222:223], v16 offset:4032
v_mfma_f32_16x16x32_bf16 v[88:91], a[136:139], a[180:183], v[88:91]
ds_read_b128 a[252:255], v17 offset:3584
v_mfma_f32_16x16x32_bf16 v[88:91], a[140:143], a[176:179], v[88:91]
buffer_load_dwordx4 v1, s[4:7], s8 offen offset:3072 sc1 lds
v_mfma_f32_16x16x32_bf16 v[88:91], a[144:147], a[172:175], v[88:91]
s_add_u32 s8, s8, 28672
v_mfma_f32_16x16x32_bf16 v[88:91], a[148:151], a[168:171], v[88:91]
s_sub_u32 s9, s9, 1
v_mfma_f32_16x16x32_bf16 v[88:91], a[152:155], a[164:167], v[88:91]
s_cmp_eq_u32 s9, 0
v_mfma_f32_16x16x32_bf16 v[88:91], a[156:159], a[160:163], v[88:91]
s_waitcnt lgkmcnt(15)
s_cselect_b32 s8, s10, s8
v_mfma_f32_16x16x32_bf16 v[32:35], a[192:195], a[224:227], v[32:35]
v_mfma_f32_16x16x32_bf16 v[40:43], a[192:195], a[228:231], v[40:43]
s_waitcnt lgkmcnt(0)
s_barrier
v_mfma_f32_16x16x32_bf16 v[40:43], a[196:199], a[224:227], v[40:43]
s_cselect_b32 s9, s11, s9
v_mfma_f32_16x16x32_bf16 v[48:51], a[192:195], a[232:235], v[48:51]
s_cselect_b32 s10, 3221225472, s10
v_mfma_f32_16x16x32_bf16 v[48:51], a[196:199], a[228:231], v[48:51]
s_add_u32 m0, s18, 32768
v_mfma_f32_16x16x32_bf16 v[48:51], a[200:203], a[224:227], v[48:51]
buffer_load_dwordx4 v1, s[4:7], s8 offen offset:0 sc1 lds
v_mfma_f32_16x16x32_bf16 v[56:59], a[192:195], a[236:239], v[56:59]
buffer_load_dwordx4 v1, s[4:7], s8 offen offset:1024 sc1 lds
v_mfma_f32_16x16x32_bf16 v[56:59], a[196:199], a[232:235], v[56:59]
buffer_load_dwordx4 v1, s[4:7], s8 offen offset:2048 sc1 lds
v_mfma_f32_16x16x32_bf16 v[56:59], a[200:203], a[228:231], v[56:59]
buffer_load_dwordx4 v1, s[4:7], s8 offen offset:3072 sc1 lds
v_mfma_f32_16x16x32_bf16 v[56:59], a[204:207], a[224:227], v[56:59]
s_add_u32 s8, s8, 4096
v_lshlrev_b32 v10, 16, v96
v_fmac_f32 v32, v19, v10
v_mfma_f32_16x16x32_bf16 v[64:67], a[192:195], a[240:243], v[64:67]
s_add_u32 m0, s18, 36864
v_and_b32 v11, 0xffff0000, v96
v_fmac_f32 v33, v19, v11
v_mfma_f32_16x16x32_bf16 v[64:67], a[196:199], a[236:239], v[64:67]
buffer_load_dwordx4 v1, s[4:7], s8 offen offset:0 sc1 lds
v_mfma_f32_16x16x32_bf16 v[64:67], a[200:203], a[232:235], v[64:67]
buffer_load_dwordx4 v1, s[4:7], s8 offen offset:1024 sc1 lds
v_mfma_f32_16x16x32_bf16 v[64:67], a[204:207], a[228:231], v[64:67]
buffer_load_dwordx4 v1, s[4:7], s8 offen offset:2048 sc1 lds
v_mfma_f32_16x16x32_bf16 v[64:67], a[208:211], a[224:227], v[64:67]
buffer_load_dwordx4 v1, s[4:7], s8 offen offset:3072 sc1 lds
v_mfma_f32_16x16x32_bf16 v[72:75], a[192:195], a[244:247], v[72:75]
s_add_u32 s8, s8, 28672
v_lshlrev_b32 v12, 16, v97
v_fmac_f32 v34, v19, v12
v_mfma_f32_16x16x32_bf16 v[72:75], a[196:199], a[240:243], v[72:75]
s_sub_u32 s9, s9, 1
v_and_b32 v13, 0xffff0000, v97
v_fmac_f32 v35, v19, v13
v_mfma_f32_16x16x32_bf16 v[72:75], a[200:203], a[236:239], v[72:75]
s_cmp_eq_u32 s9, 0
v_cvt_pk_bf16_f32 v32, v32, v33
v_cvt_pk_bf16_f32 v33, v34, v35
v_mfma_f32_16x16x32_bf16 v[72:75], a[204:207], a[232:235], v[72:75]
s_cselect_b32 s8, s10, s8
buffer_store_dwordx2 v[32:33], v8, s[4:7], s83 offen offset:0 sc1
v_mfma_f32_16x16x32_bf16 v[72:75], a[208:211], a[228:231], v[72:75]
s_cselect_b32 s9, s11, s9
v_lshlrev_b32 v10, 16, v98
v_fmac_f32 v40, v19, v10
v_mfma_f32_16x16x32_bf16 v[72:75], a[212:215], a[224:227], v[72:75]
s_cselect_b32 s10, 3221225472, s10
v_and_b32 v11, 0xffff0000, v98
v_fmac_f32 v41, v19, v11
v_mfma_f32_16x16x32_bf16 v[80:83], a[192:195], a[248:251], v[80:83]
v_lshlrev_b32 v12, 16, v99
v_fmac_f32 v42, v19, v12
v_mfma_f32_16x16x32_bf16 v[80:83], a[196:199], a[244:247], v[80:83]
v_and_b32 v13, 0xffff0000, v99
v_fmac_f32 v43, v19, v13
v_mfma_f32_16x16x32_bf16 v[80:83], a[200:203], a[240:243], v[80:83]
v_cvt_pk_bf16_f32 v40, v40, v41
v_cvt_pk_bf16_f32 v41, v42, v43
v_mfma_f32_16x16x32_bf16 v[80:83], a[204:207], a[236:239], v[80:83]
buffer_store_dwordx2 v[40:41], v8, s[4:7], s83 offen offset:512 sc1
v_mfma_f32_16x16x32_bf16 v[80:83], a[208:211], a[232:235], v[80:83]
v_lshlrev_b32 v10, 16, v100
v_fmac_f32 v48, v19, v10
v_mfma_f32_16x16x32_bf16 v[80:83], a[212:215], a[228:231], v[80:83]
v_and_b32 v11, 0xffff0000, v100
v_fmac_f32 v49, v19, v11
v_mfma_f32_16x16x32_bf16 v[80:83], a[216:219], a[224:227], v[80:83]
v_lshlrev_b32 v12, 16, v101
v_fmac_f32 v50, v19, v12
v_mfma_f32_16x16x32_bf16 v[88:91], a[192:195], a[252:255], v[88:91]
v_and_b32 v13, 0xffff0000, v101
v_fmac_f32 v51, v19, v13
v_mfma_f32_16x16x32_bf16 v[88:91], a[196:199], a[248:251], v[88:91]
v_cvt_pk_bf16_f32 v48, v48, v49
v_cvt_pk_bf16_f32 v49, v50, v51
v_mfma_f32_16x16x32_bf16 v[88:91], a[200:203], a[244:247], v[88:91]
buffer_store_dwordx2 v[48:49], v8, s[4:7], s83 offen offset:1024 sc1
v_mfma_f32_16x16x32_bf16 v[88:91], a[204:207], a[240:243], v[88:91]
v_lshlrev_b32 v10, 16, v102
v_fmac_f32 v56, v19, v10
v_mfma_f32_16x16x32_bf16 v[88:91], a[208:211], a[236:239], v[88:91]
v_and_b32 v11, 0xffff0000, v102
v_fmac_f32 v57, v19, v11
v_mfma_f32_16x16x32_bf16 v[88:91], a[212:215], a[232:235], v[88:91]
v_lshlrev_b32 v12, 16, v103
v_fmac_f32 v58, v19, v12
v_mfma_f32_16x16x32_bf16 v[88:91], a[216:219], a[228:231], v[88:91]
v_and_b32 v13, 0xffff0000, v103
v_fmac_f32 v59, v19, v13
v_mfma_f32_16x16x32_bf16 v[88:91], a[220:223], a[224:227], v[88:91]
v_cvt_pk_bf16_f32 v56, v56, v57
v_cvt_pk_bf16_f32 v57, v58, v59
buffer_store_dwordx2 v[56:57], v8, s[4:7], s83 offen offset:1536 sc1
v_lshlrev_b32 v10, 16, v104
v_fmac_f32 v64, v19, v10
v_and_b32 v11, 0xffff0000, v104
v_fmac_f32 v65, v19, v11
v_lshlrev_b32 v12, 16, v105
v_fmac_f32 v66, v19, v12
v_and_b32 v13, 0xffff0000, v105
v_fmac_f32 v67, v19, v13
v_cvt_pk_bf16_f32 v64, v64, v65
v_cvt_pk_bf16_f32 v65, v66, v67
buffer_store_dwordx2 v[64:65], v8, s[4:7], s83 offen offset:2048 sc1
v_lshlrev_b32 v10, 16, v106
v_fmac_f32 v72, v19, v10
v_and_b32 v11, 0xffff0000, v106
v_fmac_f32 v73, v19, v11
v_lshlrev_b32 v12, 16, v107
v_fmac_f32 v74, v19, v12
v_and_b32 v13, 0xffff0000, v107
v_fmac_f32 v75, v19, v13
v_cvt_pk_bf16_f32 v72, v72, v73
v_cvt_pk_bf16_f32 v73, v74, v75
buffer_store_dwordx2 v[72:73], v8, s[4:7], s83 offen offset:2560 sc1
v_lshlrev_b32 v10, 16, v108
v_fmac_f32 v80, v19, v10
v_and_b32 v11, 0xffff0000, v108
v_fmac_f32 v81, v19, v11
v_lshlrev_b32 v12, 16, v109
v_fmac_f32 v82, v19, v12
v_and_b32 v13, 0xffff0000, v109
v_fmac_f32 v83, v19, v13
v_cvt_pk_bf16_f32 v80, v80, v81
v_cvt_pk_bf16_f32 v81, v82, v83
buffer_store_dwordx2 v[80:81], v8, s[4:7], s83 offen offset:3072 sc1
v_lshlrev_b32 v10, 16, v110
v_fmac_f32 v88, v19, v10
v_and_b32 v11, 0xffff0000, v110
v_fmac_f32 v89, v19, v11
v_lshlrev_b32 v12, 16, v111
v_fmac_f32 v90, v19, v12
v_and_b32 v13, 0xffff0000, v111
v_fmac_f32 v91, v19, v13
v_cvt_pk_bf16_f32 v88, v88, v89
v_cvt_pk_bf16_f32 v89, v90, v91
buffer_store_dwordx2 v[88:89], v8, s[4:7], s83 offen offset:3584 sc1
s_waitcnt vmcnt(16)
s_barrier
s_branch K2_item
M_cspin:
Lp_15:
buffer_load_dword v14, v15, s[4:7], s70 offen sc1
s_waitcnt vmcnt(0)
v_cmp_gt_u32 vcc, 1, v14
s_cbranch_vccz Lpd_16
s_sleep 8
s_sub_u32 s101, s101, 1
s_cbranch_scc0 Lp_15
s_mov_b32 s101, 0
Lpd_16:
s_branch M_cok
M_kvspin:
Lp_17:
buffer_load_dword v21, v20, s[4:7], s70 offen sc1
s_waitcnt vmcnt(0)
v_cmp_gt_u32 vcc, 1, v21
s_cbranch_vccz Lpd_18
s_sleep 8
s_sub_u32 s101, s101, 1
s_cbranch_scc0 Lp_17
s_mov_b32 s101, 0
Lpd_18:
s_branch M_kvok
K2_plain:
v_rcp_f32 v24, v24
v_rcp_f32 v25, v25
s_nop 0
v_mov_b32 v28, v24
v_mov_b32 v29, v24
v_pk_mul_f32 v[128:129], v[128:129], v[28:29]
v_pk_mul_f32 v[130:131], v[130:131], v[28:29]
v_pk_mul_f32 v[136:137], v[136:137], v[28:29]
v_pk_mul_f32 v[138:139], v[138:139], v[28:29]
v_cvt_pk_bf16_f32 v128, v128, v129
v_cvt_pk_bf16_f32 v129, v130, v131
v_cvt_pk_bf16_f32 v130, v136, v137
v_cvt_pk_bf16_f32 v131, v138, v139
s_add_u32 m0, s18, 98304
s_nop 0
buffer_load_dwordx4 v8, s[36:39], s81 offen offset:0 lds
v_pk_mul_f32 v[144:145], v[144:145], v[28:29]
v_pk_mul_f32 v[146:147], v[146:147], v[28:29]
v_pk_mul_f32 v[152:153], v[152:153], v[28:29]
v_pk_mul_f32 v[154:155], v[154:155], v[28:29]
v_cvt_pk_bf16_f32 v144, v144, v145
v_cvt_pk_bf16_f32 v145, v146, v147
v_cvt_pk_bf16_f32 v146, v152, v153
v_cvt_pk_bf16_f32 v147, v154, v155
buffer_load_dwordx4 v9, s[36:39], s81 offen offset:1024 lds
v_pk_mul_f32 v[160:161], v[160:161], v[28:29]
v_pk_mul_f32 v[162:163], v[162:163], v[28:29]
v_pk_mul_f32 v[168:169], v[168:169], v[28:29]
v_pk_mul_f32 v[170:171], v[170:171], v[28:29]
v_cvt_pk_bf16_f32 v160, v160, v161
v_cvt_pk_bf16_f32 v161, v162, v163
v_cvt_pk_bf16_f32 v162, v168, v169
v_cvt_pk_bf16_f32 v163, v170, v171
buffer_load_dwordx4 v10, s[36:39], s81 offen offset:2048 lds
v_pk_mul_f32 v[176:177], v[176:177], v[28:29]
v_pk_mul_f32 v[178:179], v[178:179], v[28:29]
v_pk_mul_f32 v[184:185], v[184:185], v[28:29]
v_pk_mul_f32 v[186:187], v[186:187], v[28:29]
v_cvt_pk_bf16_f32 v176, v176, v177
v_cvt_pk_bf16_f32 v177, v178, v179
v_cvt_pk_bf16_f32 v178, v184, v185
v_cvt_pk_bf16_f32 v179, v186, v187
buffer_load_dwordx4 v11, s[36:39], s81 offen offset:3072 lds
v_pk_mul_f32 v[192:193], v[192:193], v[28:29]
v_pk_mul_f32 v[194:195], v[194:195], v[28:29]
v_pk_mul_f32 v[200:201], v[200:201], v[28:29]
v_pk_mul_f32 v[202:203], v[202:203], v[28:29]
v_cvt_pk_bf16_f32 v192, v192, v193
v_cvt_pk_bf16_f32 v193, v194, v195
v_cvt_pk_bf16_f32 v194, v200, v201
v_cvt_pk_bf16_f32 v195, v202, v203
s_add_u32 s81, s81, 28672
s_add_u32 m0, s18, 102400
s_nop 0
buffer_load_dwordx4 v8, s[36:39], s81 offen offset:0 lds
v_pk_mul_f32 v[208:209], v[208:209], v[28:29]
v_pk_mul_f32 v[210:211], v[210:211], v[28:29]
v_pk_mul_f32 v[216:217], v[216:217], v[28:29]
v_pk_mul_f32 v[218:219], v[218:219], v[28:29]
v_cvt_pk_bf16_f32 v208, v208, v209
v_cvt_pk_bf16_f32 v209, v210, v211
v_cvt_pk_bf16_f32 v210, v216, v217
v_cvt_pk_bf16_f32 v211, v218, v219
buffer_load_dwordx4 v9, s[36:39], s81 offen offset:1024 lds
v_pk_mul_f32 v[224:225], v[224:225], v[28:29]
v_pk_mul_f32 v[226:227], v[226:227], v[28:29]
v_pk_mul_f32 v[232:233], v[232:233], v[28:29]
v_pk_mul_f32 v[234:235], v[234:235], v[28:29]
v_cvt_pk_bf16_f32 v224, v224, v225
v_cvt_pk_bf16_f32 v225, v226, v227
v_cvt_pk_bf16_f32 v226, v232, v233
v_cvt_pk_bf16_f32 v227, v234, v235
buffer_load_dwordx4 v10, s[36:39], s81 offen offset:2048 lds
v_pk_mul_f32 v[240:241], v[240:241], v[28:29]
v_pk_mul_f32 v[242:243], v[242:243], v[28:29]
v_pk_mul_f32 v[248:249], v[248:249], v[28:29]
v_pk_mul_f32 v[250:251], v[250:251], v[28:29]
v_cvt_pk_bf16_f32 v240, v240, v241
v_cvt_pk_bf16_f32 v241, v242, v243
v_cvt_pk_bf16_f32 v242, v248, v249
v_cvt_pk_bf16_f32 v243, v250, v251
buffer_load_dwordx4 v11, s[36:39], s81 offen offset:3072 lds
v_mov_b32 v28, v25
v_mov_b32 v29, v25
v_pk_mul_f32 v[132:133], v[132:133], v[28:29]
v_pk_mul_f32 v[134:135], v[134:135], v[28:29]
v_pk_mul_f32 v[140:141], v[140:141], v[28:29]
v_pk_mul_f32 v[142:143], v[142:143], v[28:29]
v_cvt_pk_bf16_f32 v132, v132, v133
v_cvt_pk_bf16_f32 v133, v134, v135
v_cvt_pk_bf16_f32 v134, v140, v141
v_cvt_pk_bf16_f32 v135, v142, v143
s_sub_u32 s81, s81, 28544
s_add_u32 m0, s18, 32768
s_nop 0
buffer_load_dwordx4 v8, s[36:39], s81 offen offset:0 lds
v_pk_mul_f32 v[148:149], v[148:149], v[28:29]
v_pk_mul_f32 v[150:151], v[150:151], v[28:29]
v_pk_mul_f32 v[156:157], v[156:157], v[28:29]
v_pk_mul_f32 v[158:159], v[158:159], v[28:29]
v_cvt_pk_bf16_f32 v148, v148, v149
v_cvt_pk_bf16_f32 v149, v150, v151
v_cvt_pk_bf16_f32 v150, v156, v157
v_cvt_pk_bf16_f32 v151, v158, v159
buffer_load_dwordx4 v9, s[36:39], s81 offen offset:1024 lds
v_pk_mul_f32 v[164:165], v[164:165], v[28:29]
v_pk_mul_f32 v[166:167], v[166:167], v[28:29]
v_pk_mul_f32 v[172:173], v[172:173], v[28:29]
v_pk_mul_f32 v[174:175], v[174:175], v[28:29]
v_cvt_pk_bf16_f32 v164, v164, v165
v_cvt_pk_bf16_f32 v165, v166, v167
v_cvt_pk_bf16_f32 v166, v172, v173
v_cvt_pk_bf16_f32 v167, v174, v175
buffer_load_dwordx4 v10, s[36:39], s81 offen offset:2048 lds
v_pk_mul_f32 v[180:181], v[180:181], v[28:29]
v_pk_mul_f32 v[182:183], v[182:183], v[28:29]
v_pk_mul_f32 v[188:189], v[188:189], v[28:29]
v_pk_mul_f32 v[190:191], v[190:191], v[28:29]
v_cvt_pk_bf16_f32 v180, v180, v181
v_cvt_pk_bf16_f32 v181, v182, v183
v_cvt_pk_bf16_f32 v182, v188, v189
v_cvt_pk_bf16_f32 v183, v190, v191
buffer_load_dwordx4 v11, s[36:39], s81 offen offset:3072 lds
v_pk_mul_f32 v[196:197], v[196:197], v[28:29]
v_pk_mul_f32 v[198:199], v[198:199], v[28:29]
v_pk_mul_f32 v[204:205], v[204:205], v[28:29]
v_pk_mul_f32 v[206:207], v[206:207], v[28:29]
v_cvt_pk_bf16_f32 v196, v196, v197
v_cvt_pk_bf16_f32 v197, v198, v199
v_cvt_pk_bf16_f32 v198, v204, v205
v_cvt_pk_bf16_f32 v199, v206, v207
s_add_u32 s81, s81, 28672
s_add_u32 m0, s18, 36864
s_nop 0
buffer_load_dwordx4 v8, s[36:39], s81 offen offset:0 lds
v_pk_mul_f32 v[212:213], v[212:213], v[28:29]
v_pk_mul_f32 v[214:215], v[214:215], v[28:29]
v_pk_mul_f32 v[220:221], v[220:221], v[28:29]
v_pk_mul_f32 v[222:223], v[222:223], v[28:29]
v_cvt_pk_bf16_f32 v212, v212, v213
v_cvt_pk_bf16_f32 v213, v214, v215
v_cvt_pk_bf16_f32 v214, v220, v221
v_cvt_pk_bf16_f32 v215, v222, v223
buffer_load_dwordx4 v9, s[36:39], s81 offen offset:1024 lds
v_pk_mul_f32 v[228:229], v[228:229], v[28:29]
v_pk_mul_f32 v[230:231], v[230:231], v[28:29]
v_pk_mul_f32 v[236:237], v[236:237], v[28:29]
v_pk_mul_f32 v[238:239], v[238:239], v[28:29]
v_cvt_pk_bf16_f32 v228, v228, v229
v_cvt_pk_bf16_f32 v229, v230, v231
v_cvt_pk_bf16_f32 v230, v236, v237
v_cvt_pk_bf16_f32 v231, v238, v239
buffer_load_dwordx4 v10, s[36:39], s81 offen offset:2048 lds
v_pk_mul_f32 v[244:245], v[244:245], v[28:29]
v_pk_mul_f32 v[246:247], v[246:247], v[28:29]
v_pk_mul_f32 v[252:253], v[252:253], v[28:29]
v_pk_mul_f32 v[254:255], v[254:255], v[28:29]
v_cvt_pk_bf16_f32 v244, v244, v245
v_cvt_pk_bf16_f32 v245, v246, v247
v_cvt_pk_bf16_f32 v246, v252, v253
v_cvt_pk_bf16_f32 v247, v254, v255
buffer_load_dwordx4 v11, s[36:39], s81 offen offset:3072 lds
s_sub_u32 s81, s81, 28544
s_branch K2_done
K2_tspin:
Lp_9101:
buffer_load_dword v3, off, s[4:7], s80 sc1
s_waitcnt vmcnt(0)
v_cmp_gt_u32 vcc, 1, v3
s_cbranch_vccz Lpd_9102
s_sleep 8
s_sub_u32 s101, s101, 1
s_cbranch_scc0 Lp_9101
s_mov_b32 s101, 0
Lpd_9102:
s_branch K2_tok
K2_p0d:
buffer_load_dword v3, off, s[4:7], s80 sc1
ds_read_b128 a[64:67], v1 offset:0
ds_read_b128 a[68:71], v1 offset:1024
ds_read_b128 a[72:75], v1 offset:2048
ds_read_b128 a[76:79], v1 offset:3072
ds_read_b128 a[80:83], v1 offset:4096
ds_read_b128 a[84:87], v1 offset:5120
ds_read_b128 a[88:91], v1 offset:6144
ds_read_b128 a[92:95], v1 offset:7168
v_cndmask_b32 v32, 0, v7, s[32:33]
v_cndmask_b32 v33, 0, v7, s[34:35]
v_cndmask_b32 v34, 0, v7, s[36:37]
v_cndmask_b32 v35, 0, v7, s[38:39]
v_cndmask_b32 v40, 0, v7, s[40:41]
v_cndmask_b32 v41, 0, v7, s[42:43]
v_cndmask_b32 v42, 0, v7, s[44:45]
v_cndmask_b32 v43, 0, v7, s[46:47]
s_waitcnt lgkmcnt(7)
v_mfma_f32_16x16x32_bf16 v[32:35], a[64:67], a[0:3], v[32:35]
s_waitcnt lgkmcnt(6)
s_add_u32 m0, s18, 65536
ds_read_b128 a[96:99], v1 offset:8192
v_mfma_f32_16x16x32_bf16 v[32:35], a[68:71], a[4:7], v[32:35]
s_waitcnt lgkmcnt(6)
buffer_load_dwordx4 v1, s[4:7], s12 offen offset:0 sc1 lds
v_mfma_f32_16x16x32_bf16 v[32:35], a[72:75], a[8:11], v[32:35]
s_waitcnt lgkmcnt(5)
ds_read_b128 a[100:103], v1 offset:9216
v_mfma_f32_16x16x32_bf16 v[32:35], a[76:79], a[12:15], v[32:35]
s_waitcnt lgkmcnt(5)
buffer_load_dwordx4 v1, s[4:7], s12 offen offset:1024 sc1 lds
v_mfma_f32_16x16x32_bf16 v[32:35], a[80:83], a[16:19], v[32:35]
s_waitcnt lgkmcnt(4)
ds_read_b128 a[104:107], v1 offset:10240
v_mfma_f32_16x16x32_bf16 v[32:35], a[84:87], a[20:23], v[32:35]
s_waitcnt lgkmcnt(4)
buffer_load_dwordx4 v1, s[4:7], s12 offen offset:2048 sc1 lds
v_mfma_f32_16x16x32_bf16 v[32:35], a[88:91], a[24:27], v[32:35]
s_waitcnt lgkmcnt(3)
ds_read_b128 a[108:111], v1 offset:11264
v_mfma_f32_16x16x32_bf16 v[32:35], a[92:95], a[28:31], v[32:35]
buffer_load_dwordx4 v1, s[4:7], s12 offen offset:3072 sc1 lds
v_mfma_f32_16x16x32_bf16 v[36:39], a[64:67], a[32:35], 0
s_add_u32 s12, s12, 4096
s_add_u32 m0, s18, 69632
ds_read_b128 a[112:115], v1 offset:12288
v_mfma_f32_16x16x32_bf16 v[36:39], a[68:71], a[36:39], v[36:39]
buffer_load_dwordx4 v1, s[4:7], s12 offen offset:0 sc1 lds
v_mfma_f32_16x16x32_bf16 v[36:39], a[72:75], a[40:43], v[36:39]
ds_read_b128 a[116:119], v1 offset:13312
v_mfma_f32_16x16x32_bf16 v[36:39], a[76:79], a[44:47], v[36:39]
buffer_load_dwordx4 v1, s[4:7], s12 offen offset:1024 sc1 lds
v_mfma_f32_16x16x32_bf16 v[36:39], a[80:83], a[48:51], v[36:39]
ds_read_b128 a[120:123], v1 offset:14336
v_max3_f32 v28, v32, v33, v34
v_mfma_f32_16x16x32_bf16 v[36:39], a[84:87], a[52:55], v[36:39]
buffer_load_dwordx4 v1, s[4:7], s12 offen offset:2048 sc1 lds
v_mfma_f32_16x16x32_bf16 v[36:39], a[88:91], a[56:59], v[36:39]
ds_read_b128 a[124:127], v1 offset:15360
v_max_f32 v28, v28, v35
v_mfma_f32_16x16x32_bf16 v[36:39], a[92:95], a[60:63], v[36:39]
s_waitcnt lgkmcnt(6)
buffer_load_dwordx4 v1, s[4:7], s12 offen offset:3072 sc1 lds
v_mfma_f32_16x16x32_bf16 v[40:43], a[96:99], a[0:3], v[40:43]
s_add_u32 s12, s12, 28672
ds_read_b128 a[64:67], v1 offset:16384
v_mov_b32 v30, v28
v_mfma_f32_16x16x32_bf16 v[40:43], a[100:103], a[4:7], v[40:43]
s_waitcnt lgkmcnt(2)
s_sub_u32 s13, s13, 1
v_mfma_f32_16x16x32_bf16 v[40:43], a[104:107], a[8:11], v[40:43]
s_cmp_eq_u32 s13, 0
ds_read_b128 a[68:71], v1 offset:17408
v_permlane16_swap_b32 v28, v30
v_mfma_f32_16x16x32_bf16 v[40:43], a[108:111], a[12:15], v[40:43]
s_cselect_b32 s12, s14, s12
v_max_f32 v28, v28, v30
v_mov_b32 v30, v28
v_mfma_f32_16x16x32_bf16 v[40:43], a[112:115], a[16:19], v[40:43]
s_cselect_b32 s13, s15, s13
ds_read_b128 a[72:75], v1 offset:18432
v_max3_f32 v29, v36, v37, v38
v_mfma_f32_16x16x32_bf16 v[40:43], a[116:119], a[20:23], v[40:43]
s_cselect_b32 s14, 3221225472, s14
v_permlane32_swap_b32 v28, v30
v_max_f32 v28, v28, v30
v_mfma_f32_16x16x32_bf16 v[40:43], a[120:123], a[24:27], v[40:43]
s_waitcnt lgkmcnt(3)
ds_read_b128 a[76:79], v1 offset:19456
v_sub_f32 v16, 0, v28
v_mfma_f32_16x16x32_bf16 v[40:43], a[124:127], a[28:31], v[40:43]
v_sub_f32 v17, 0, v28
v_sub_f32 v18, 0, v28
v_mfma_f32_16x16x32_bf16 v[44:47], a[96:99], a[32:35], 0
ds_read_b128 a[80:83], v1 offset:20480
v_sub_f32 v19, 0, v28
v_mfma_f32_16x16x32_bf16 v[44:47], a[100:103], a[36:39], v[44:47]
v_max_f32 v29, v29, v39
v_mov_b32 v31, v29
v_cndmask_b32 v48, v16, v7, s[48:49]
v_mfma_f32_16x16x32_bf16 v[44:47], a[104:107], a[40:43], v[44:47]
ds_read_b128 a[84:87], v1 offset:21504
v_cndmask_b32 v49, v16, v7, s[50:51]
v_mfma_f32_16x16x32_bf16 v[44:47], a[108:111], a[44:47], v[44:47]
v_permlane16_swap_b32 v29, v31
v_max_f32 v29, v29, v31
v_cndmask_b32 v50, v16, v7, s[52:53]
v_mfma_f32_16x16x32_bf16 v[44:47], a[112:115], a[48:51], v[44:47]
ds_read_b128 a[88:91], v1 offset:22528
v_mov_b32 v31, v29
v_cndmask_b32 v51, v16, v7, s[54:55]
v_mfma_f32_16x16x32_bf16 v[44:47], a[116:119], a[52:55], v[44:47]
v_cndmask_b32 v56, v16, v7, s[56:57]
v_cndmask_b32 v57, v16, v7, s[58:59]
v_mfma_f32_16x16x32_bf16 v[44:47], a[120:123], a[56:59], v[44:47]
ds_read_b128 a[92:95], v1 offset:23552
v_permlane32_swap_b32 v29, v31
v_mfma_f32_16x16x32_bf16 v[44:47], a[124:127], a[60:63], v[44:47]
s_waitcnt lgkmcnt(7)
v_max_f32 v29, v29, v31
v_sub_f32 v20, 0, v29
v_mfma_f32_16x16x32_bf16 v[48:51], a[64:67], a[0:3], v[48:51]
s_waitcnt lgkmcnt(6)
ds_read_b128 a[96:99], v1 offset:24576
v_sub_f32 v21, 0, v29
v_mfma_f32_16x16x32_bf16 v[48:51], a[68:71], a[4:7], v[48:51]
s_waitcnt lgkmcnt(6)
v_sub_f32 v22, 0, v29
v_sub_f32 v23, 0, v29
v_mfma_f32_16x16x32_bf16 v[48:51], a[72:75], a[8:11], v[48:51]
s_waitcnt lgkmcnt(5)
ds_read_b128 a[100:103], v1 offset:25600
v_cndmask_b32 v58, v16, v7, s[60:61]
v_mfma_f32_16x16x32_bf16 v[48:51], a[76:79], a[12:15], v[48:51]
s_waitcnt lgkmcnt(5)
v_cndmask_b32 v59, v16, v7, s[62:63]
v_mfma_f32_16x16x32_bf16 v[48:51], a[80:83], a[16:19], v[48:51]
s_waitcnt lgkmcnt(4)
ds_read_b128 a[104:107], v1 offset:26624
v_mfma_f32_16x16x32_bf16 v[48:51], a[84:87], a[20:23], v[48:51]
s_waitcnt lgkmcnt(4)
v_add_f32 v32, v32, v16
v_add_f32 v33, v33, v16
v_add_f32 v34, v34, v16
v_add_f32 v35, v35, v16
v_mfma_f32_16x16x32_bf16 v[48:51], a[88:91], a[24:27], v[48:51]
s_waitcnt lgkmcnt(3)
ds_read_b128 a[108:111], v1 offset:27648
v_add_f32 v36, v36, v20
v_add_f32 v37, v37, v20
v_add_f32 v38, v38, v20
v_add_f32 v39, v39, v20
v_mfma_f32_16x16x32_bf16 v[48:51], a[92:95], a[28:31], v[48:51]
v_add_f32 v40, v40, v16
v_add_f32 v41, v41, v16
v_add_f32 v42, v42, v16
v_add_f32 v43, v43, v16
v_mfma_f32_16x16x32_bf16 v[52:55], a[64:67], a[32:35], v[20:23]
ds_read_b128 a[112:115], v1 offset:28672
v_add_f32 v44, v44, v20
v_add_f32 v45, v45, v20
v_add_f32 v46, v46, v20
v_add_f32 v47, v47, v20
v_mfma_f32_16x16x32_bf16 v[52:55], a[68:71], a[36:39], v[52:55]
v_exp_f32 v8, v32
v_mfma_f32_16x16x32_bf16 v[52:55], a[72:75], a[40:43], v[52:55]
ds_read_b128 a[116:119], v1 offset:29696
v_exp_f32 v9, v33
v_mfma_f32_16x16x32_bf16 v[52:55], a[76:79], a[44:47], v[52:55]
v_exp_f32 v10, v34
v_mfma_f32_16x16x32_bf16 v[52:55], a[80:83], a[48:51], v[52:55]
ds_read_b128 a[120:123], v1 offset:30720
v_exp_f32 v11, v35
v_mfma_f32_16x16x32_bf16 v[52:55], a[84:87], a[52:55], v[52:55]
v_exp_f32 v12, v36
v_mfma_f32_16x16x32_bf16 v[52:55], a[88:91], a[56:59], v[52:55]
ds_read_b128 a[124:127], v1 offset:31744
v_exp_f32 v13, v37
v_mfma_f32_16x16x32_bf16 v[52:55], a[92:95], a[60:63], v[52:55]
s_waitcnt vmcnt(8) lgkmcnt(7)
s_barrier
v_add_f32 v26, v8, v9
v_cvt_pk_bf16_f32 v96, v8, v9
v_add_f32 v26, v26, v10
v_add_f32 v26, v26, v11
v_cvt_pk_bf16_f32 v97, v10, v11
v_add_f32 v27, v12, v13
v_cvt_pk_bf16_f32 v104, v12, v13
v_mfma_f32_16x16x32_bf16 v[56:59], a[96:99], a[0:3], v[56:59]
s_waitcnt lgkmcnt(6)
ds_read_b128 a[64:67], v1 offset:32768
v_exp_f32 v14, v38
v_mfma_f32_16x16x32_bf16 v[56:59], a[100:103], a[4:7], v[56:59]
s_waitcnt lgkmcnt(6)
buffer_store_dword v6, v5, s[4:7], s71 offen sc1
v_add_f32 v27, v27, v14
v_mfma_f32_16x16x32_bf16 v[56:59], a[104:107], a[8:11], v[56:59]
s_waitcnt lgkmcnt(5)
ds_read_b128 a[68:71], v1 offset:33792
v_exp_f32 v15, v39
v_mfma_f32_16x16x32_bf16 v[56:59], a[108:111], a[12:15], v[56:59]
s_waitcnt lgkmcnt(5)
v_exp_f32 v8, v40
v_mfma_f32_16x16x32_bf16 v[56:59], a[112:115], a[16:19], v[56:59]
s_waitcnt lgkmcnt(4)
ds_read_b128 a[72:75], v1 offset:34816
v_exp_f32 v9, v41
v_mfma_f32_16x16x32_bf16 v[56:59], a[116:119], a[20:23], v[56:59]
s_waitcnt lgkmcnt(4)
v_exp_f32 v10, v42
v_mfma_f32_16x16x32_bf16 v[56:59], a[120:123], a[24:27], v[56:59]
s_waitcnt lgkmcnt(3)
ds_read_b128 a[76:79], v1 offset:35840
v_add_f32 v27, v27, v15
v_cvt_pk_bf16_f32 v105, v14, v15
v_add_f32 v26, v26, v8
v_add_f32 v26, v26, v9
v_cvt_pk_bf16_f32 v98, v8, v9
v_add_f32 v26, v26, v10
v_mfma_f32_16x16x32_bf16 v[56:59], a[124:127], a[28:31], v[56:59]
v_exp_f32 v11, v43
v_mfma_f32_16x16x32_bf16 v[60:63], a[96:99], a[32:35], v[20:23]
ds_read_b128 a[80:83], v1 offset:36864
v_exp_f32 v12, v44
v_mfma_f32_16x16x32_bf16 v[60:63], a[100:103], a[36:39], v[60:63]
v_exp_f32 v13, v45
v_mfma_f32_16x16x32_bf16 v[60:63], a[104:107], a[40:43], v[60:63]
ds_read_b128 a[84:87], v1 offset:37888
v_exp_f32 v14, v46
v_mfma_f32_16x16x32_bf16 v[60:63], a[108:111], a[44:47], v[60:63]
v_exp_f32 v15, v47
v_mfma_f32_16x16x32_bf16 v[60:63], a[112:115], a[48:51], v[60:63]
ds_read_b128 a[88:91], v1 offset:38912
v_add_f32 v26, v26, v11
v_cvt_pk_bf16_f32 v99, v10, v11
v_mfma_f32_16x16x32_bf16 v[60:63], a[116:119], a[52:55], v[60:63]
v_add_f32 v27, v27, v12
v_add_f32 v27, v27, v13
v_cvt_pk_bf16_f32 v106, v12, v13
v_mfma_f32_16x16x32_bf16 v[60:63], a[120:123], a[56:59], v[60:63]
s_waitcnt lgkmcnt(7)
s_barrier
ds_read_b128 a[92:95], v1 offset:39936
v_mfma_f32_16x16x32_bf16 v[60:63], a[124:127], a[60:63], v[60:63]
s_waitcnt lgkmcnt(6)
v_add_f32 v27, v27, v14
v_add_f32 v27, v27, v15
v_cvt_pk_bf16_f32 v107, v14, v15
s_branch K2_dx1
K2_ntail:
v_mfma_f32_16x16x32_bf16 v[128:131], a[64:67], v[96:99], v[128:131]
s_add_u32 m0, s18, 98304
ds_read_b128 a[96:99], v2 offset:8192
v_add_f32 v24, v24, v26
v_mfma_f32_16x16x32_bf16 v[128:131], a[68:71], v[100:103], v[128:131]
buffer_load_dwordx4 v1, s[4:7], s12 offen offset:0 sc1 lds
v_mfma_f32_16x16x32_bf16 v[132:135], a[68:71], v[108:111], v[132:135]
ds_read_b128 a[100:103], v2 offset:9216
v_add_f32 v25, v25, v27
v_mfma_f32_16x16x32_bf16 v[132:135], a[64:67], v[104:107], v[132:135]
s_waitcnt lgkmcnt(7)
buffer_load_dwordx4 v1, s[4:7], s12 offen offset:1024 sc1 lds
v_mfma_f32_16x16x32_bf16 v[136:139], a[72:75], v[96:99], v[136:139]
s_waitcnt lgkmcnt(6)
ds_read_b128 a[104:107], v2 offset:10240
v_exp_f32 v8, v64
v_mfma_f32_16x16x32_bf16 v[136:139], a[76:79], v[100:103], v[136:139]
buffer_load_dwordx4 v1, s[4:7], s12 offen offset:2048 sc1 lds
v_mfma_f32_16x16x32_bf16 v[140:143], a[76:79], v[108:111], v[140:143]
ds_read_b128 a[108:111], v2 offset:11264
v_mfma_f32_16x16x32_bf16 v[140:143], a[72:75], v[104:107], v[140:143]
s_waitcnt lgkmcnt(6)
buffer_load_dwordx4 v1, s[4:7], s12 offen offset:3072 sc1 lds
v_mfma_f32_16x16x32_bf16 v[144:147], a[80:83], v[96:99], v[144:147]
s_add_u32 s12, s12, 4096
s_add_u32 m0, s18, 102400
ds_read_b128 a[112:115], v2 offset:12288
v_mfma_f32_16x16x32_bf16 v[144:147], a[84:87], v[100:103], v[144:147]
buffer_load_dwordx4 v1, s[4:7], s12 offen offset:0 sc1 lds
v_mfma_f32_16x16x32_bf16 v[148:151], a[84:87], v[108:111], v[148:151]
ds_read_b128 a[116:119], v2 offset:13312
v_exp_f32 v9, v65
v_mfma_f32_16x16x32_bf16 v[148:151], a[80:83], v[104:107], v[148:151]
s_waitcnt lgkmcnt(7)
buffer_load_dwordx4 v1, s[4:7], s12 offen offset:1024 sc1 lds
v_mfma_f32_16x16x32_bf16 v[152:155], a[88:91], v[96:99], v[152:155]
s_waitcnt lgkmcnt(6)
ds_read_b128 a[120:123], v2 offset:14336
v_add_f32 v26, v8, v9
v_cvt_pk_bf16_f32 v112, v8, v9
v_mfma_f32_16x16x32_bf16 v[152:155], a[92:95], v[100:103], v[152:155]
buffer_load_dwordx4 v1, s[4:7], s12 offen offset:2048 sc1 lds
v_mfma_f32_16x16x32_bf16 v[156:159], a[92:95], v[108:111], v[156:159]
ds_read_b128 a[124:127], v2 offset:15360
v_exp_f32 v10, v66
v_mfma_f32_16x16x32_bf16 v[156:159], a[88:91], v[104:107], v[156:159]
s_waitcnt lgkmcnt(4)
buffer_load_dwordx4 v1, s[4:7], s12 offen offset:3072 sc1 lds
v_mfma_f32_16x16x32_bf16 v[160:163], a[96:99], v[96:99], v[160:163]
s_add_u32 s12, s12, 28672
ds_read_b128 a[64:67], v2 offset:16384
v_add_f32 v26, v26, v10
v_mfma_f32_16x16x32_bf16 v[160:163], a[100:103], v[100:103], v[160:163]
s_sub_u32 s13, s13, 1
v_exp_f32 v11, v67
v_mfma_f32_16x16x32_bf16 v[164:167], a[100:103], v[108:111], v[164:167]
s_cmp_eq_u32 s13, 0
ds_read_b128 a[68:71], v2 offset:17408
v_exp_f32 v12, v68
v_mfma_f32_16x16x32_bf16 v[164:167], a[96:99], v[104:107], v[164:167]
s_cselect_b32 s12, s14, s12
v_exp_f32 v13, v69
v_mfma_f32_16x16x32_bf16 v[168:171], a[104:107], v[96:99], v[168:171]
s_cselect_b32 s13, s15, s13
ds_read_b128 a[72:75], v2 offset:18432
v_add_f32 v26, v26, v11
v_mfma_f32_16x16x32_bf16 v[168:171], a[108:111], v[100:103], v[168:171]
s_cselect_b32 s14, 3221225472, s14
v_exp_f32 v14, v70
v_mfma_f32_16x16x32_bf16 v[172:175], a[108:111], v[108:111], v[172:175]
ds_read_b128 a[76:79], v2 offset:19456
v_cvt_pk_bf16_f32 v113, v10, v11
v_add_f32 v27, v12, v13
v_cvt_pk_bf16_f32 v120, v12, v13
v_mfma_f32_16x16x32_bf16 v[172:175], a[104:107], v[104:107], v[172:175]
s_waitcnt lgkmcnt(7)
v_exp_f32 v15, v71
v_mfma_f32_16x16x32_bf16 v[176:179], a[112:115], v[96:99], v[176:179]
s_waitcnt lgkmcnt(6)
ds_read_b128 a[80:83], v2 offset:20480
v_exp_f32 v8, v72
v_mfma_f32_16x16x32_bf16 v[176:179], a[116:119], v[100:103], v[176:179]
v_exp_f32 v9, v73
v_mfma_f32_16x16x32_bf16 v[180:183], a[116:119], v[108:111], v[180:183]
ds_read_b128 a[84:87], v2 offset:21504
v_add_f32 v27, v27, v14
v_add_f32 v27, v27, v15
v_cvt_pk_bf16_f32 v121, v14, v15
v_add_f32 v26, v26, v8
v_mfma_f32_16x16x32_bf16 v[180:183], a[112:115], v[104:107], v[180:183]
s_waitcnt lgkmcnt(7)
v_exp_f32 v10, v74
v_mfma_f32_16x16x32_bf16 v[184:187], a[120:123], v[96:99], v[184:187]
s_waitcnt lgkmcnt(6)
ds_read_b128 a[88:91], v2 offset:22528
v_exp_f32 v11, v75
v_mfma_f32_16x16x32_bf16 v[184:187], a[124:127], v[100:103], v[184:187]
v_exp_f32 v12, v76
v_mfma_f32_16x16x32_bf16 v[188:191], a[124:127], v[108:111], v[188:191]
ds_read_b128 a[92:95], v2 offset:23552
v_add_f32 v26, v26, v9
v_cvt_pk_bf16_f32 v114, v8, v9
v_add_f32 v26, v26, v10
v_add_f32 v26, v26, v11
v_cvt_pk_bf16_f32 v115, v10, v11
v_mfma_f32_16x16x32_bf16 v[188:191], a[120:123], v[104:107], v[188:191]
s_waitcnt lgkmcnt(7)
v_exp_f32 v13, v77
v_mfma_f32_16x16x32_bf16 v[192:195], a[64:67], v[96:99], v[192:195]
s_waitcnt lgkmcnt(6)
ds_read_b128 a[96:99], v2 offset:24576
v_exp_f32 v14, v78
v_mfma_f32_16x16x32_bf16 v[192:195], a[68:71], v[100:103], v[192:195]
v_exp_f32 v15, v79
v_mfma_f32_16x16x32_bf16 v[196:199], a[68:71], v[108:111], v[196:199]
ds_read_b128 a[100:103], v2 offset:25600
v_add_f32 v27, v27, v12
v_add_f32 v27, v27, v13
v_cvt_pk_bf16_f32 v122, v12, v13
v_add_f32 v27, v27, v14
v_mfma_f32_16x16x32_bf16 v[196:199], a[64:67], v[104:107], v[196:199]
s_waitcnt lgkmcnt(7)
v_exp_f32 v8, v80
v_mfma_f32_16x16x32_bf16 v[200:203], a[72:75], v[96:99], v[200:203]
s_waitcnt lgkmcnt(6)
ds_read_b128 a[104:107], v2 offset:26624
v_exp_f32 v9, v81
v_mfma_f32_16x16x32_bf16 v[200:203], a[76:79], v[100:103], v[200:203]
v_exp_f32 v10, v82
v_mfma_f32_16x16x32_bf16 v[204:207], a[76:79], v[108:111], v[204:207]
ds_read_b128 a[108:111], v2 offset:27648
v_add_f32 v27, v27, v15
v_cvt_pk_bf16_f32 v123, v14, v15
v_mfma_f32_16x16x32_bf16 v[204:207], a[72:75], v[104:107], v[204:207]
s_waitcnt lgkmcnt(7)
v_exp_f32 v11, v83
v_mfma_f32_16x16x32_bf16 v[208:211], a[80:83], v[96:99], v[208:211]
s_waitcnt lgkmcnt(6)
ds_read_b128 a[112:115], v2 offset:28672
v_add_f32 v26, v26, v8
v_add_f32 v26, v26, v9
v_cvt_pk_bf16_f32 v116, v8, v9
v_add_f32 v26, v26, v10
v_mfma_f32_16x16x32_bf16 v[208:211], a[84:87], v[100:103], v[208:211]
v_exp_f32 v12, v84
v_mfma_f32_16x16x32_bf16 v[212:215], a[84:87], v[108:111], v[212:215]
ds_read_b128 a[116:119], v2 offset:29696
v_exp_f32 v13, v85
v_mfma_f32_16x16x32_bf16 v[212:215], a[80:83], v[104:107], v[212:215]
s_waitcnt lgkmcnt(7)
v_exp_f32 v14, v86
v_mfma_f32_16x16x32_bf16 v[216:219], a[88:91], v[96:99], v[216:219]
s_waitcnt lgkmcnt(6)
ds_read_b128 a[120:123], v2 offset:30720
v_add_f32 v26, v26, v11
v_cvt_pk_bf16_f32 v117, v10, v11
v_add_f32 v27, v27, v12
v_mfma_f32_16x16x32_bf16 v[216:219], a[92:95], v[100:103], v[216:219]
v_exp_f32 v15, v87
v_mfma_f32_16x16x32_bf16 v[220:223], a[92:95], v[108:111], v[220:223]
ds_read_b128 a[124:127], v2 offset:31744
v_exp_f32 v8, v88
v_mfma_f32_16x16x32_bf16 v[220:223], a[88:91], v[104:107], v[220:223]
s_waitcnt vmcnt(0) lgkmcnt(7)
s_barrier
v_add_f32 v27, v27, v13
v_cvt_pk_bf16_f32 v124, v12, v13
v_add_f32 v27, v27, v14
v_mfma_f32_16x16x32_bf16 v[224:227], a[96:99], v[96:99], v[224:227]
s_waitcnt lgkmcnt(6)
ds_read_b128 a[64:67], v2 offset:32768
v_exp_f32 v9, v89
v_mfma_f32_16x16x32_bf16 v[224:227], a[100:103], v[100:103], v[224:227]
v_exp_f32 v10, v90
v_mfma_f32_16x16x32_bf16 v[228:231], a[100:103], v[108:111], v[228:231]
ds_read_b128 a[68:71], v2 offset:33792
v_add_f32 v27, v27, v15
v_cvt_pk_bf16_f32 v125, v14, v15
v_add_f32 v26, v26, v8
v_add_f32 v26, v26, v9
v_cvt_pk_bf16_f32 v118, v8, v9
v_mfma_f32_16x16x32_bf16 v[228:231], a[96:99], v[104:107], v[228:231]
s_waitcnt lgkmcnt(7)
v_exp_f32 v11, v91
v_mfma_f32_16x16x32_bf16 v[232:235], a[104:107], v[96:99], v[232:235]
s_waitcnt lgkmcnt(6)
ds_read_b128 a[72:75], v2 offset:34816
v_exp_f32 v12, v92
v_mfma_f32_16x16x32_bf16 v[232:235], a[108:111], v[100:103], v[232:235]
v_exp_f32 v13, v93
v_mfma_f32_16x16x32_bf16 v[236:239], a[108:111], v[108:111], v[236:239]
ds_read_b128 a[76:79], v2 offset:35840
v_add_f32 v26, v26, v10
v_mfma_f32_16x16x32_bf16 v[236:239], a[104:107], v[104:107], v[236:239]
s_waitcnt lgkmcnt(7)
v_exp_f32 v14, v94
v_mfma_f32_16x16x32_bf16 v[240:243], a[112:115], v[96:99], v[240:243]
s_waitcnt lgkmcnt(6)
ds_read_b128 a[80:83], v2 offset:36864
v_add_f32 v26, v26, v11
v_cvt_pk_bf16_f32 v119, v10, v11
v_add_f32 v27, v27, v12
v_mfma_f32_16x16x32_bf16 v[240:243], a[116:119], v[100:103], v[240:243]
v_exp_f32 v15, v95
v_mfma_f32_16x16x32_bf16 v[244:247], a[116:119], v[108:111], v[244:247]
ds_read_b128 a[84:87], v2 offset:37888
v_add_f32 v27, v27, v13
v_cvt_pk_bf16_f32 v126, v12, v13
v_mfma_f32_16x16x32_bf16 v[244:247], a[112:115], v[104:107], v[244:247]
s_waitcnt lgkmcnt(7)
v_add_f32 v27, v27, v14
v_add_f32 v27, v27, v15
v_mfma_f32_16x16x32_bf16 v[248:251], a[120:123], v[96:99], v[248:251]
s_waitcnt lgkmcnt(6)
ds_read_b128 a[88:91], v2 offset:38912
v_cvt_pk_bf16_f32 v127, v14, v15
v_mfma_f32_16x16x32_bf16 v[248:251], a[124:127], v[100:103], v[248:251]
v_add_f32 v28, v26, v27
v_cmp_nge_f32 vcc, s25, v28
v_mfma_f32_16x16x32_bf16 v[252:255], a[124:127], v[108:111], v[252:255]
ds_read_b128 a[92:95], v2 offset:39936
v_mfma_f32_16x16x32_bf16 v[252:255], a[120:123], v[104:107], v[252:255]
s_waitcnt lgkmcnt(6)
s_cbranch_vccnz Lstub_13
Lback_14:
v_mfma_f32_16x16x32_bf16 v[128:131], a[64:67], v[112:115], v[128:131]
s_add_u32 m0, s18, 32768
ds_read_b128 a[96:99], v2 offset:40960
v_add_f32 v24, v24, v26
v_mfma_f32_16x16x32_bf16 v[128:131], a[68:71], v[116:119], v[128:131]
buffer_load_dwordx4 v1, s[4:7], s8 offen offset:0 sc1 lds
v_mfma_f32_16x16x32_bf16 v[132:135], a[68:71], v[124:127], v[132:135]
ds_read_b128 a[100:103], v2 offset:41984
v_add_f32 v25, v25, v27
v_mfma_f32_16x16x32_bf16 v[132:135], a[64:67], v[120:123], v[132:135]
s_waitcnt lgkmcnt(7)
buffer_load_dwordx4 v1, s[4:7], s8 offen offset:1024 sc1 lds
v_mfma_f32_16x16x32_bf16 v[136:139], a[72:75], v[112:115], v[136:139]
s_waitcnt lgkmcnt(6)
ds_read_b128 a[104:107], v2 offset:43008
v_mfma_f32_16x16x32_bf16 v[136:139], a[76:79], v[116:119], v[136:139]
buffer_load_dwordx4 v1, s[4:7], s8 offen offset:2048 sc1 lds
v_mfma_f32_16x16x32_bf16 v[140:143], a[76:79], v[124:127], v[140:143]
ds_read_b128 a[108:111], v2 offset:44032
v_mfma_f32_16x16x32_bf16 v[140:143], a[72:75], v[120:123], v[140:143]
s_waitcnt lgkmcnt(6)
buffer_load_dwordx4 v1, s[4:7], s8 offen offset:3072 sc1 lds
v_mfma_f32_16x16x32_bf16 v[144:147], a[80:83], v[112:115], v[144:147]
s_add_u32 s8, s8, 4096
s_add_u32 m0, s18, 36864
ds_read_b128 a[112:115], v2 offset:45056
v_mfma_f32_16x16x32_bf16 v[144:147], a[84:87], v[116:119], v[144:147]
buffer_load_dwordx4 v1, s[4:7], s8 offen offset:0 sc1 lds
v_mfma_f32_16x16x32_bf16 v[148:151], a[84:87], v[124:127], v[148:151]
ds_read_b128 a[116:119], v2 offset:46080
v_mfma_f32_16x16x32_bf16 v[148:151], a[80:83], v[120:123], v[148:151]
s_waitcnt lgkmcnt(7)
buffer_load_dwordx4 v1, s[4:7], s8 offen offset:1024 sc1 lds
v_mfma_f32_16x16x32_bf16 v[152:155], a[88:91], v[112:115], v[152:155]
s_waitcnt lgkmcnt(6)
ds_read_b128 a[120:123], v2 offset:47104
v_mfma_f32_16x16x32_bf16 v[152:155], a[92:95], v[116:119], v[152:155]
buffer_load_dwordx4 v1, s[4:7], s8 offen offset:2048 sc1 lds
v_mfma_f32_16x16x32_bf16 v[156:159], a[92:95], v[124:127], v[156:159]
ds_read_b128 a[124:127], v2 offset:48128
v_mfma_f32_16x16x32_bf16 v[156:159], a[88:91], v[120:123], v[156:159]
s_waitcnt lgkmcnt(7)
buffer_load_dwordx4 v1, s[4:7], s8 offen offset:3072 sc1 lds
v_mfma_f32_16x16x32_bf16 v[160:163], a[96:99], v[112:115], v[160:163]
s_waitcnt lgkmcnt(6)
s_add_u32 s8, s8, 28672
ds_read_b128 a[64:67], v2 offset:49152
v_mfma_f32_16x16x32_bf16 v[160:163], a[100:103], v[116:119], v[160:163]
s_sub_u32 s9, s9, 1
v_mfma_f32_16x16x32_bf16 v[164:167], a[100:103], v[124:127], v[164:167]
s_cmp_eq_u32 s9, 0
ds_read_b128 a[68:71], v2 offset:50176
v_mfma_f32_16x16x32_bf16 v[164:167], a[96:99], v[120:123], v[164:167]
s_waitcnt lgkmcnt(7)
s_cselect_b32 s8, s10, s8
v_mfma_f32_16x16x32_bf16 v[168:171], a[104:107], v[112:115], v[168:171]
s_waitcnt lgkmcnt(6)
s_cselect_b32 s9, s11, s9
ds_read_b128 a[72:75], v2 offset:51200
v_mfma_f32_16x16x32_bf16 v[168:171], a[108:111], v[116:119], v[168:171]
s_cselect_b32 s10, 3221225472, s10
v_mfma_f32_16x16x32_bf16 v[172:175], a[108:111], v[124:127], v[172:175]
ds_read_b128 a[76:79], v2 offset:52224
v_mfma_f32_16x16x32_bf16 v[172:175], a[104:107], v[120:123], v[172:175]
s_waitcnt lgkmcnt(7)
v_mfma_f32_16x16x32_bf16 v[176:179], a[112:115], v[112:115], v[176:179]
s_waitcnt lgkmcnt(6)
s_add_u32 s22, s26, 0
ds_read_b128 a[80:83], v2 offset:53248
v_mfma_f32_16x16x32_bf16 v[176:179], a[116:119], v[116:119], v[176:179]
buffer_load_dwordx4 a[0:3], v1, s[4:7], s22 offen offset:0 sc1
v_mfma_f32_16x16x32_bf16 v[180:183], a[116:119], v[124:127], v[180:183]
ds_read_b128 a[84:87], v2 offset:54272
v_mfma_f32_16x16x32_bf16 v[180:183], a[112:115], v[120:123], v[180:183]
s_waitcnt lgkmcnt(7)
buffer_load_dwordx4 a[4:7], v1, s[4:7], s22 offen offset:1024 sc1
v_mfma_f32_16x16x32_bf16 v[184:187], a[120:123], v[112:115], v[184:187]
s_waitcnt lgkmcnt(6)
ds_read_b128 a[88:91], v2 offset:55296
v_mfma_f32_16x16x32_bf16 v[184:187], a[124:127], v[116:119], v[184:187]
buffer_load_dwordx4 a[8:11], v1, s[4:7], s22 offen offset:2048 sc1
v_mfma_f32_16x16x32_bf16 v[188:191], a[124:127], v[124:127], v[188:191]
ds_read_b128 a[92:95], v2 offset:56320
v_mfma_f32_16x16x32_bf16 v[188:191], a[120:123], v[120:123], v[188:191]
s_waitcnt lgkmcnt(7)
buffer_load_dwordx4 a[12:15], v1, s[4:7], s22 offen offset:3072 sc1
v_mfma_f32_16x16x32_bf16 v[192:195], a[64:67], v[112:115], v[192:195]
s_waitcnt lgkmcnt(6)
s_add_u32 s22, s26, 4096
ds_read_b128 a[96:99], v2 offset:57344
v_mfma_f32_16x16x32_bf16 v[192:195], a[68:71], v[116:119], v[192:195]
buffer_load_dwordx4 a[16:19], v1, s[4:7], s22 offen offset:0 sc1
v_mfma_f32_16x16x32_bf16 v[196:199], a[68:71], v[124:127], v[196:199]
ds_read_b128 a[100:103], v2 offset:58368
v_mfma_f32_16x16x32_bf16 v[196:199], a[64:67], v[120:123], v[196:199]
s_waitcnt lgkmcnt(7)
buffer_load_dwordx4 a[20:23], v1, s[4:7], s22 offen offset:1024 sc1
v_mfma_f32_16x16x32_bf16 v[200:203], a[72:75], v[112:115], v[200:203]
s_waitcnt lgkmcnt(6)
ds_read_b128 a[104:107], v2 offset:59392
v_mfma_f32_16x16x32_bf16 v[200:203], a[76:79], v[116:119], v[200:203]
buffer_load_dwordx4 a[24:27], v1, s[4:7], s22 offen offset:2048 sc1
v_mfma_f32_16x16x32_bf16 v[204:207], a[76:79], v[124:127], v[204:207]
ds_read_b128 a[108:111], v2 offset:60416
v_mfma_f32_16x16x32_bf16 v[204:207], a[72:75], v[120:123], v[204:207]
s_waitcnt lgkmcnt(7)
buffer_load_dwordx4 a[28:31], v1, s[4:7], s22 offen offset:3072 sc1
v_mfma_f32_16x16x32_bf16 v[208:211], a[80:83], v[112:115], v[208:211]
s_waitcnt lgkmcnt(6)
s_add_u32 s22, s26, 32768
ds_read_b128 a[112:115], v2 offset:61440
v_mfma_f32_16x16x32_bf16 v[208:211], a[84:87], v[116:119], v[208:211]
buffer_load_dwordx4 a[32:35], v1, s[4:7], s22 offen offset:0 sc1
v_mfma_f32_16x16x32_bf16 v[212:215], a[84:87], v[124:127], v[212:215]
ds_read_b128 a[116:119], v2 offset:62464
v_mfma_f32_16x16x32_bf16 v[212:215], a[80:83], v[120:123], v[212:215]
s_waitcnt lgkmcnt(7)
buffer_load_dwordx4 a[36:39], v1, s[4:7], s22 offen offset:1024 sc1
v_mfma_f32_16x16x32_bf16 v[216:219], a[88:91], v[112:115], v[216:219]
s_waitcnt lgkmcnt(6)
ds_read_b128 a[120:123], v2 offset:63488
v_mfma_f32_16x16x32_bf16 v[216:219], a[92:95], v[116:119], v[216:219]
buffer_load_dwordx4 a[40:43], v1, s[4:7], s22 offen offset:2048 sc1
v_mfma_f32_16x16x32_bf16 v[220:223], a[92:95], v[124:127], v[220:223]
ds_read_b128 a[124:127], v2 offset:64512
v_mfma_f32_16x16x32_bf16 v[220:223], a[88:91], v[120:123], v[220:223]
s_waitcnt lgkmcnt(6)
buffer_load_dwordx4 a[44:47], v1, s[4:7], s22 offen offset:3072 sc1
v_mfma_f32_16x16x32_bf16 v[224:227], a[96:99], v[112:115], v[224:227]
s_add_u32 s22, s26, 36864
buffer_load_dwordx4 a[48:51], v1, s[4:7], s22 offen offset:0 sc1
v_mfma_f32_16x16x32_bf16 v[224:227], a[100:103], v[116:119], v[224:227]
buffer_load_dwordx4 a[52:55], v1, s[4:7], s22 offen offset:1024 sc1
v_mfma_f32_16x16x32_bf16 v[228:231], a[100:103], v[124:127], v[228:231]
buffer_load_dwordx4 a[56:59], v1, s[4:7], s22 offen offset:2048 sc1
v_mfma_f32_16x16x32_bf16 v[228:231], a[96:99], v[120:123], v[228:231]
s_waitcnt lgkmcnt(5)
buffer_load_dwordx4 a[60:63], v1, s[4:7], s22 offen offset:3072 sc1
v_mfma_f32_16x16x32_bf16 v[232:235], a[104:107], v[112:115], v[232:235]
s_waitcnt lgkmcnt(4)
v_mfma_f32_16x16x32_bf16 v[232:235], a[108:111], v[116:119], v[232:235]
v_mfma_f32_16x16x32_bf16 v[236:239], a[108:111], v[124:127], v[236:239]
v_mfma_f32_16x16x32_bf16 v[236:239], a[104:107], v[120:123], v[236:239]
s_waitcnt lgkmcnt(3)
v_mfma_f32_16x16x32_bf16 v[240:243], a[112:115], v[112:115], v[240:243]
s_waitcnt lgkmcnt(2)
v_mfma_f32_16x16x32_bf16 v[240:243], a[116:119], v[116:119], v[240:243]
v_mfma_f32_16x16x32_bf16 v[244:247], a[116:119], v[124:127], v[244:247]
v_mfma_f32_16x16x32_bf16 v[244:247], a[112:115], v[120:123], v[244:247]
s_waitcnt lgkmcnt(1)
v_mfma_f32_16x16x32_bf16 v[248:251], a[120:123], v[112:115], v[248:251]
s_waitcnt lgkmcnt(0)
v_mfma_f32_16x16x32_bf16 v[248:251], a[124:127], v[116:119], v[248:251]
v_mfma_f32_16x16x32_bf16 v[252:255], a[124:127], v[124:127], v[252:255]
v_mfma_f32_16x16x32_bf16 v[252:255], a[120:123], v[120:123], v[252:255]
v_mov_b32 v28, v24
s_nop 1
v_permlane16_swap_b32 v24, v28
v_add_f32 v24, v24, v28
v_mov_b32 v28, v24
s_nop 1
v_permlane32_swap_b32 v24, v28
v_add_f32 v24, v24, v28
v_mov_b32 v29, v25
s_nop 1
v_permlane16_swap_b32 v25, v29
v_add_f32 v25, v25, v29
v_mov_b32 v29, v25
s_nop 1
v_permlane32_swap_b32 v25, v29
v_add_f32 v25, v25, v29
v_mov_b32 v8, v16
v_mov_b32 v9, v24
v_mov_b32 v10, v20
v_mov_b32 v11, v25
v_rcp_f32 v24, v24
v_rcp_f32 v25, v25
buffer_store_dwordx4 v[8:11], v1, s[4:7], s27 offen sc1
v_mov_b32 v28, v24
v_mov_b32 v29, v24
s_add_u32 s22, s76, 0
v_pk_mul_f32 v[128:129], v[128:129], v[28:29]
v_pk_mul_f32 v[130:131], v[130:131], v[28:29]
v_pk_mul_f32 v[136:137], v[136:137], v[28:29]
v_pk_mul_f32 v[138:139], v[138:139], v[28:29]
v_cvt_pk_bf16_f32 v128, v128, v129
v_cvt_pk_bf16_f32 v129, v130, v131
v_cvt_pk_bf16_f32 v130, v136, v137
v_cvt_pk_bf16_f32 v131, v138, v139
buffer_store_dwordx4 v[128:131], v1, s[4:7], s22 offen offset:0 sc1
v_pk_mul_f32 v[144:145], v[144:145], v[28:29]
v_pk_mul_f32 v[146:147], v[146:147], v[28:29]
v_pk_mul_f32 v[152:153], v[152:153], v[28:29]
v_pk_mul_f32 v[154:155], v[154:155], v[28:29]
v_cvt_pk_bf16_f32 v144, v144, v145
v_cvt_pk_bf16_f32 v145, v146, v147
v_cvt_pk_bf16_f32 v146, v152, v153
v_cvt_pk_bf16_f32 v147, v154, v155
buffer_store_dwordx4 v[144:147], v1, s[4:7], s22 offen offset:1024 sc1
v_pk_mul_f32 v[160:161], v[160:161], v[28:29]
v_pk_mul_f32 v[162:163], v[162:163], v[28:29]
v_pk_mul_f32 v[168:169], v[168:169], v[28:29]
v_pk_mul_f32 v[170:171], v[170:171], v[28:29]
v_cvt_pk_bf16_f32 v160, v160, v161
v_cvt_pk_bf16_f32 v161, v162, v163
v_cvt_pk_bf16_f32 v162, v168, v169
v_cvt_pk_bf16_f32 v163, v170, v171
buffer_store_dwordx4 v[160:163], v1, s[4:7], s22 offen offset:2048 sc1
v_pk_mul_f32 v[176:177], v[176:177], v[28:29]
v_pk_mul_f32 v[178:179], v[178:179], v[28:29]
v_pk_mul_f32 v[184:185], v[184:185], v[28:29]
v_pk_mul_f32 v[186:187], v[186:187], v[28:29]
v_cvt_pk_bf16_f32 v176, v176, v177
v_cvt_pk_bf16_f32 v177, v178, v179
v_cvt_pk_bf16_f32 v178, v184, v185
v_cvt_pk_bf16_f32 v179, v186, v187
buffer_store_dwordx4 v[176:179], v1, s[4:7], s22 offen offset:3072 sc1
s_add_u32 s22, s76, 4096
v_pk_mul_f32 v[192:193], v[192:193], v[28:29]
v_pk_mul_f32 v[194:195], v[194:195], v[28:29]
v_pk_mul_f32 v[200:201], v[200:201], v[28:29]
v_pk_mul_f32 v[202:203], v[202:203], v[28:29]
v_cvt_pk_bf16_f32 v192, v192, v193
v_cvt_pk_bf16_f32 v193, v194, v195
v_cvt_pk_bf16_f32 v194, v200, v201
v_cvt_pk_bf16_f32 v195, v202, v203
buffer_store_dwordx4 v[192:195], v1, s[4:7], s22 offen offset:0 sc1
v_pk_mul_f32 v[208:209], v[208:209], v[28:29]
v_pk_mul_f32 v[210:211], v[210:211], v[28:29]
v_pk_mul_f32 v[216:217], v[216:217], v[28:29]
v_pk_mul_f32 v[218:219], v[218:219], v[28:29]
v_cvt_pk_bf16_f32 v208, v208, v209
v_cvt_pk_bf16_f32 v209, v210, v211
v_cvt_pk_bf16_f32 v210, v216, v217
v_cvt_pk_bf16_f32 v211, v218, v219
buffer_store_dwordx4 v[208:211], v1, s[4:7], s22 offen offset:1024 sc1
v_pk_mul_f32 v[224:225], v[224:225], v[28:29]
v_pk_mul_f32 v[226:227], v[226:227], v[28:29]
v_pk_mul_f32 v[232:233], v[232:233], v[28:29]
v_pk_mul_f32 v[234:235], v[234:235], v[28:29]
v_cvt_pk_bf16_f32 v224, v224, v225
v_cvt_pk_bf16_f32 v225, v226, v227
v_cvt_pk_bf16_f32 v226, v232, v233
v_cvt_pk_bf16_f32 v227, v234, v235
buffer_store_dwordx4 v[224:227], v1, s[4:7], s22 offen offset:2048 sc1
v_pk_mul_f32 v[240:241], v[240:241], v[28:29]
v_pk_mul_f32 v[242:243], v[242:243], v[28:29]
v_pk_mul_f32 v[248:249], v[248:249], v[28:29]
v_pk_mul_f32 v[250:251], v[250:251], v[28:29]
v_cvt_pk_bf16_f32 v240, v240, v241
v_cvt_pk_bf16_f32 v241, v242, v243
v_cvt_pk_bf16_f32 v242, v248, v249
v_cvt_pk_bf16_f32 v243, v250, v251
buffer_store_dwordx4 v[240:243], v1, s[4:7], s22 offen offset:3072 sc1
v_mov_b32 v28, v25
v_mov_b32 v29, v25
s_add_u32 s22, s76, 8192
v_pk_mul_f32 v[132:133], v[132:133], v[28:29]
v_pk_mul_f32 v[134:135], v[134:135], v[28:29]
v_pk_mul_f32 v[140:141], v[140:141], v[28:29]
v_pk_mul_f32 v[142:143], v[142:143], v[28:29]
v_cvt_pk_bf16_f32 v132, v132, v133
v_cvt_pk_bf16_f32 v133, v134, v135
v_cvt_pk_bf16_f32 v134, v140, v141
v_cvt_pk_bf16_f32 v135, v142, v143
buffer_store_dwordx4 v[132:135], v1, s[4:7], s22 offen offset:0 sc1
v_pk_mul_f32 v[148:149], v[148:149], v[28:29]
v_pk_mul_f32 v[150:151], v[150:151], v[28:29]
v_pk_mul_f32 v[156:157], v[156:157], v[28:29]
v_pk_mul_f32 v[158:159], v[158:159], v[28:29]
v_cvt_pk_bf16_f32 v148, v148, v149
v_cvt_pk_bf16_f32 v149, v150, v151
v_cvt_pk_bf16_f32 v150, v156, v157
v_cvt_pk_bf16_f32 v151, v158, v159
buffer_store_dwordx4 v[148:151], v1, s[4:7], s22 offen offset:1024 sc1
v_pk_mul_f32 v[164:165], v[164:165], v[28:29]
v_pk_mul_f32 v[166:167], v[166:167], v[28:29]
v_pk_mul_f32 v[172:173], v[172:173], v[28:29]
v_pk_mul_f32 v[174:175], v[174:175], v[28:29]
v_cvt_pk_bf16_f32 v164, v164, v165
v_cvt_pk_bf16_f32 v165, v166, v167
v_cvt_pk_bf16_f32 v166, v172, v173
v_cvt_pk_bf16_f32 v167, v174, v175
buffer_store_dwordx4 v[164:167], v1, s[4:7], s22 offen offset:2048 sc1
v_pk_mul_f32 v[180:181], v[180:181], v[28:29]
v_pk_mul_f32 v[182:183], v[182:183], v[28:29]
v_pk_mul_f32 v[188:189], v[188:189], v[28:29]
v_pk_mul_f32 v[190:191], v[190:191], v[28:29]
v_cvt_pk_bf16_f32 v180, v180, v181
v_cvt_pk_bf16_f32 v181, v182, v183
v_cvt_pk_bf16_f32 v182, v188, v189
v_cvt_pk_bf16_f32 v183, v190, v191
buffer_store_dwordx4 v[180:183], v1, s[4:7], s22 offen offset:3072 sc1
s_add_u32 s22, s76, 12288
v_pk_mul_f32 v[196:197], v[196:197], v[28:29]
v_pk_mul_f32 v[198:199], v[198:199], v[28:29]
v_pk_mul_f32 v[204:205], v[204:205], v[28:29]
v_pk_mul_f32 v[206:207], v[206:207], v[28:29]
v_cvt_pk_bf16_f32 v196, v196, v197
v_cvt_pk_bf16_f32 v197, v198, v199
v_cvt_pk_bf16_f32 v198, v204, v205
v_cvt_pk_bf16_f32 v199, v206, v207
buffer_store_dwordx4 v[196:199], v1, s[4:7], s22 offen offset:0 sc1
v_pk_mul_f32 v[212:213], v[212:213], v[28:29]
v_pk_mul_f32 v[214:215], v[214:215], v[28:29]
v_pk_mul_f32 v[220:221], v[220:221], v[28:29]
v_pk_mul_f32 v[222:223], v[222:223], v[28:29]
v_cvt_pk_bf16_f32 v212, v212, v213
v_cvt_pk_bf16_f32 v213, v214, v215
v_cvt_pk_bf16_f32 v214, v220, v221
v_cvt_pk_bf16_f32 v215, v222, v223
buffer_store_dwordx4 v[212:215], v1, s[4:7], s22 offen offset:1024 sc1
v_pk_mul_f32 v[228:229], v[228:229], v[28:29]
v_pk_mul_f32 v[230:231], v[230:231], v[28:29]
v_pk_mul_f32 v[236:237], v[236:237], v[28:29]
v_pk_mul_f32 v[238:239], v[238:239], v[28:29]
v_cvt_pk_bf16_f32 v228, v228, v229
v_cvt_pk_bf16_f32 v229, v230, v231
v_cvt_pk_bf16_f32 v230, v236, v237
v_cvt_pk_bf16_f32 v231, v238, v239
buffer_store_dwordx4 v[228:231], v1, s[4:7], s22 offen offset:2048 sc1
v_pk_mul_f32 v[244:245], v[244:245], v[28:29]
v_pk_mul_f32 v[246:247], v[246:247], v[28:29]
v_pk_mul_f32 v[252:253], v[252:253], v[28:29]
v_pk_mul_f32 v[254:255], v[254:255], v[28:29]
v_cvt_pk_bf16_f32 v244, v244, v245
v_cvt_pk_bf16_f32 v245, v246, v247
v_cvt_pk_bf16_f32 v246, v252, v253
v_cvt_pk_bf16_f32 v247, v254, v255
buffer_store_dwordx4 v[244:247], v1, s[4:7], s22 offen offset:3072 sc1
s_mov_b32 s24, 0
s_mov_b32 s29, s21
s_mov_b32 s19, s21
v_mov_b64 v[128:129], 0
v_mov_b64 v[130:131], 0
v_mov_b64 v[132:133], 0
v_mov_b64 v[134:135], 0
v_mov_b64 v[136:137], 0
v_mov_b64 v[138:139], 0
v_mov_b64 v[140:141], 0
v_mov_b64 v[142:143], 0
v_mov_b64 v[144:145], 0
v_mov_b64 v[146:147], 0
v_mov_b64 v[148:149], 0
v_mov_b64 v[150:151], 0
v_mov_b64 v[152:153], 0
v_mov_b64 v[154:155], 0
v_mov_b64 v[156:157], 0
v_mov_b64 v[158:159], 0
v_mov_b64 v[160:161], 0
v_mov_b64 v[162:163], 0
v_mov_b64 v[164:165], 0
v_mov_b64 v[166:167], 0
v_mov_b64 v[168:169], 0
v_mov_b64 v[170:171], 0
v_mov_b64 v[172:173], 0
v_mov_b64 v[174:175], 0
v_mov_b64 v[176:177], 0
v_mov_b64 v[178:179], 0
v_mov_b64 v[180:181], 0
v_mov_b64 v[182:183], 0
v_mov_b64 v[184:185], 0
v_mov_b64 v[186:187], 0
v_mov_b64 v[188:189], 0
v_mov_b64 v[190:191], 0
v_mov_b64 v[192:193], 0
v_mov_b64 v[194:195], 0
v_mov_b64 v[196:197], 0
v_mov_b64 v[198:199], 0
v_mov_b64 v[200:201], 0
v_mov_b64 v[202:203], 0
v_mov_b64 v[204:205], 0
v_mov_b64 v[206:207], 0
v_mov_b64 v[208:209], 0
v_mov_b64 v[210:211], 0
v_mov_b64 v[212:213], 0
v_mov_b64 v[214:215], 0
v_mov_b64 v[216:217], 0
v_mov_b64 v[218:219], 0
v_mov_b64 v[220:221], 0
v_mov_b64 v[222:223], 0
v_mov_b64 v[224:225], 0
v_mov_b64 v[226:227], 0
v_mov_b64 v[228:229], 0
v_mov_b64 v[230:231], 0
v_mov_b64 v[232:233], 0
v_mov_b64 v[234:235], 0
v_mov_b64 v[236:237], 0
v_mov_b64 v[238:239], 0
v_mov_b64 v[240:241], 0
v_mov_b64 v[242:243], 0
v_mov_b64 v[244:245], 0
v_mov_b64 v[246:247], 0
v_mov_b64 v[248:249], 0
v_mov_b64 v[250:251], 0
v_mov_b64 v[252:253], 0
v_mov_b64 v[254:255], 0
v_mov_b64 v[24:25], 0
s_mov_b32 s71, s28
s_waitcnt vmcnt(17)
s_barrier
s_branch K2_item
Lstub_3:
s_call_b64 s[16:17], K2_slow1
s_branch Lback_4
Lstub_5:
s_call_b64 s[16:17], K2_slow0
s_branch Lback_6
Lstub_7:
s_call_b64 s[16:17], K2_slow1
s_branch Lback_8
Lstub_9:
s_call_b64 s[16:17], K2_slow0
s_branch Lback_10
Lstub_11:
s_call_b64 s[16:17], K2_slow1
s_branch Lback_12
Lstub_13:
s_call_b64 s[16:17], K2_slow1
s_branch Lback_14
K2_slow0:
s_nop 7
s_nop 7
v_max3_f32 v28, v32, v33, 0
v_max3_f32 v28, v34, v35, v28
v_max3_f32 v28, v40, v41, v28
v_max3_f32 v28, v42, v43, v28
v_max3_f32 v28, v48, v49, v28
v_max3_f32 v28, v50, v51, v28
v_max3_f32 v28, v56, v57, v28
v_max3_f32 v28, v58, v59, v28
v_mov_b32 v29, v28
s_nop 1
v_permlane16_swap_b32 v28, v29
v_max_f32 v28, v28, v29
v_mov_b32 v29, v28
s_nop 1
v_permlane32_swap_b32 v28, v29
v_max_f32 v28, v28, v29
v_exp_f32 v29, -v28
v_sub_f32 v16, v16, v28
v_sub_f32 v17, v17, v28
v_sub_f32 v18, v18, v28
v_sub_f32 v19, v19, v28
v_mul_f32 v24, v24, v29
v_mul_f32 v128, v128, v29
v_mul_f32 v129, v129, v29
v_mul_f32 v130, v130, v29
v_mul_f32 v131, v131, v29
v_mul_f32 v136, v136, v29
v_mul_f32 v137, v137, v29
v_mul_f32 v138, v138, v29
v_mul_f32 v139, v139, v29
v_mul_f32 v144, v144, v29
v_mul_f32 v145, v145, v29
v_mul_f32 v146, v146, v29
v_mul_f32 v147, v147, v29
v_mul_f32 v152, v152, v29
v_mul_f32 v153, v153, v29
v_mul_f32 v154, v154, v29
v_mul_f32 v155, v155, v29
v_mul_f32 v160, v160, v29
v_mul_f32 v161, v161, v29
v_mul_f32 v162, v162, v29
v_mul_f32 v163, v163, v29
v_mul_f32 v168, v168, v29
v_mul_f32 v169, v169, v29
v_mul_f32 v170, v170, v29
v_mul_f32 v171, v171, v29
v_mul_f32 v176, v176, v29
v_mul_f32 v177, v177, v29
v_mul_f32 v178, v178, v29
v_mul_f32 v179, v179, v29
v_mul_f32 v184, v184, v29
v_mul_f32 v185, v185, v29
v_mul_f32 v186, v186, v29
v_mul_f32 v187, v187, v29
v_mul_f32 v192, v192, v29
v_mul_f32 v193, v193, v29
v_mul_f32 v194, v194, v29
v_mul_f32 v195, v195, v29
v_mul_f32 v200, v200, v29
v_mul_f32 v201, v201, v29
v_mul_f32 v202, v202, v29
v_mul_f32 v203, v203, v29
v_mul_f32 v208, v208, v29
v_mul_f32 v209, v209, v29
v_mul_f32 v210, v210, v29
v_mul_f32 v211, v211, v29
v_mul_f32 v216, v216, v29
v_mul_f32 v217, v217, v29
v_mul_f32 v218, v218, v29
v_mul_f32 v219, v219, v29
v_mul_f32 v224, v224, v29
v_mul_f32 v225, v225, v29
v_mul_f32 v226, v226, v29
v_mul_f32 v227, v227, v29
v_mul_f32 v232, v232, v29
v_mul_f32 v233, v233, v29
v_mul_f32 v234, v234, v29
v_mul_f32 v235, v235, v29
v_mul_f32 v240, v240, v29
v_mul_f32 v241, v241, v29
v_mul_f32 v242, v242, v29
v_mul_f32 v243, v243, v29
v_mul_f32 v248, v248, v29
v_mul_f32 v249, v249, v29
v_mul_f32 v250, v250, v29
v_mul_f32 v251, v251, v29
v_sub_f32 v32, v32, v28
v_sub_f32 v33, v33, v28
v_sub_f32 v34, v34, v28
v_sub_f32 v35, v35, v28
v_sub_f32 v40, v40, v28
v_sub_f32 v41, v41, v28
v_sub_f32 v42, v42, v28
v_sub_f32 v43, v43, v28
v_sub_f32 v48, v48, v28
v_sub_f32 v49, v49, v28
v_sub_f32 v50, v50, v28
v_sub_f32 v51, v51, v28
v_sub_f32 v56, v56, v28
v_sub_f32 v57, v57, v28
v_sub_f32 v58, v58, v28
v_sub_f32 v59, v59, v28
v_sub_f32 v64, v64, v28
v_sub_f32 v65, v65, v28
v_sub_f32 v66, v66, v28
v_sub_f32 v67, v67, v28
v_sub_f32 v72, v72, v28
v_sub_f32 v73, v73, v28
v_sub_f32 v74, v74, v28
v_sub_f32 v75, v75, v28
v_sub_f32 v80, v80, v28
v_sub_f32 v81, v81, v28
v_sub_f32 v82, v82, v28
v_sub_f32 v83, v83, v28
v_sub_f32 v88, v88, v28
v_sub_f32 v89, v89, v28
v_sub_f32 v90, v90, v28
v_sub_f32 v91, v91, v28
v_max3_f32 v28, v36, v37, 0
v_max3_f32 v28, v38, v39, v28
v_max3_f32 v28, v44, v45, v28
v_max3_f32 v28, v46, v47, v28
v_max3_f32 v28, v52, v53, v28
v_max3_f32 v28, v54, v55, v28
v_max3_f32 v28, v60, v61, v28
v_max3_f32 v28, v62, v63, v28
v_mov_b32 v29, v28
s_nop 1
v_permlane16_swap_b32 v28, v29
v_max_f32 v28, v28, v29
v_mov_b32 v29, v28
s_nop 1
v_permlane32_swap_b32 v28, v29
v_max_f32 v28, v28, v29
v_exp_f32 v29, -v28
v_sub_f32 v20, v20, v28
v_sub_f32 v21, v21, v28
v_sub_f32 v22, v22, v28
v_sub_f32 v23, v23, v28
v_mul_f32 v25, v25, v29
v_mul_f32 v132, v132, v29
v_mul_f32 v133, v133, v29
v_mul_f32 v134, v134, v29
v_mul_f32 v135, v135, v29
v_mul_f32 v140, v140, v29
v_mul_f32 v141, v141, v29
v_mul_f32 v142, v142, v29
v_mul_f32 v143, v143, v29
v_mul_f32 v148, v148, v29
v_mul_f32 v149, v149, v29
v_mul_f32 v150, v150, v29
v_mul_f32 v151, v151, v29
v_mul_f32 v156, v156, v29
v_mul_f32 v157, v157, v29
v_mul_f32 v158, v158, v29
v_mul_f32 v159, v159, v29
v_mul_f32 v164, v164, v29
v_mul_f32 v165, v165, v29
v_mul_f32 v166, v166, v29
v_mul_f32 v167, v167, v29
v_mul_f32 v172, v172, v29
v_mul_f32 v173, v173, v29
v_mul_f32 v174, v174, v29
v_mul_f32 v175, v175, v29
v_mul_f32 v180, v180, v29
v_mul_f32 v181, v181, v29
v_mul_f32 v182, v182, v29
v_mul_f32 v183, v183, v29
v_mul_f32 v188, v188, v29
v_mul_f32 v189, v189, v29
v_mul_f32 v190, v190, v29
v_mul_f32 v191, v191, v29
v_mul_f32 v196, v196, v29
v_mul_f32 v197, v197, v29
v_mul_f32 v198, v198, v29
v_mul_f32 v199, v199, v29
v_mul_f32 v204, v204, v29
v_mul_f32 v205, v205, v29
v_mul_f32 v206, v206, v29
v_mul_f32 v207, v207, v29
v_mul_f32 v212, v212, v29
v_mul_f32 v213, v213, v29
v_mul_f32 v214, v214, v29
v_mul_f32 v215, v215, v29
v_mul_f32 v220, v220, v29
v_mul_f32 v221, v221, v29
v_mul_f32 v222, v222, v29
v_mul_f32 v223, v223, v29
v_mul_f32 v228, v228, v29
v_mul_f32 v229, v229, v29
v_mul_f32 v230, v230, v29
v_mul_f32 v231, v231, v29
v_mul_f32 v236, v236, v29
v_mul_f32 v237, v237, v29
v_mul_f32 v238, v238, v29
v_mul_f32 v239, v239, v29
v_mul_f32 v244, v244, v29
v_mul_f32 v245, v245, v29
v_mul_f32 v246, v246, v29
v_mul_f32 v247, v247, v29
v_mul_f32 v252, v252, v29
v_mul_f32 v253, v253, v29
v_mul_f32 v254, v254, v29
v_mul_f32 v255, v255, v29
v_sub_f32 v36, v36, v28
v_sub_f32 v37, v37, v28
v_sub_f32 v38, v38, v28
v_sub_f32 v39, v39, v28
v_sub_f32 v44, v44, v28
v_sub_f32 v45, v45, v28
v_sub_f32 v46, v46, v28
v_sub_f32 v47, v47, v28
v_sub_f32 v52, v52, v28
v_sub_f32 v53, v53, v28
v_sub_f32 v54, v54, v28
v_sub_f32 v55, v55, v28
v_sub_f32 v60, v60, v28
v_sub_f32 v61, v61, v28
v_sub_f32 v62, v62, v28
v_sub_f32 v63, v63, v28
v_sub_f32 v68, v68, v28
v_sub_f32 v69, v69, v28
v_sub_f32 v70, v70, v28
v_sub_f32 v71, v71, v28
v_sub_f32 v76, v76, v28
v_sub_f32 v77, v77, v28
v_sub_f32 v78, v78, v28
v_sub_f32 v79, v79, v28
v_sub_f32 v84, v84, v28
v_sub_f32 v85, v85, v28
v_sub_f32 v86, v86, v28
v_sub_f32 v87, v87, v28
v_sub_f32 v92, v92, v28
v_sub_f32 v93, v93, v28
v_sub_f32 v94, v94, v28
v_sub_f32 v95, v95, v28
v_exp_f32 v8, v32
v_exp_f32 v9, v33
v_exp_f32 v10, v34
v_exp_f32 v11, v35
s_nop 0
v_add_f32 v26, v8, v9
v_cvt_pk_bf16_f32 v96, v8, v9
v_add_f32 v26, v26, v10
v_add_f32 v26, v26, v11
v_cvt_pk_bf16_f32 v97, v10, v11
v_exp_f32 v12, v36
v_exp_f32 v13, v37
v_exp_f32 v14, v38
v_exp_f32 v15, v39
s_nop 0
v_add_f32 v27, v12, v13
v_cvt_pk_bf16_f32 v104, v12, v13
v_add_f32 v27, v27, v14
v_add_f32 v27, v27, v15
v_cvt_pk_bf16_f32 v105, v14, v15
v_exp_f32 v8, v40
v_exp_f32 v9, v41
v_exp_f32 v10, v42
v_exp_f32 v11, v43
s_nop 0
v_add_f32 v26, v26, v8
v_add_f32 v26, v26, v9
v_cvt_pk_bf16_f32 v98, v8, v9
v_add_f32 v26, v26, v10
v_add_f32 v26, v26, v11
v_cvt_pk_bf16_f32 v99, v10, v11
v_exp_f32 v12, v44
v_exp_f32 v13, v45
v_exp_f32 v14, v46
v_exp_f32 v15, v47
s_nop 0
v_add_f32 v27, v27, v12
v_add_f32 v27, v27, v13
v_cvt_pk_bf16_f32 v106, v12, v13
v_add_f32 v27, v27, v14
v_add_f32 v27, v27, v15
v_cvt_pk_bf16_f32 v107, v14, v15
v_exp_f32 v8, v48
v_exp_f32 v9, v49
v_exp_f32 v10, v50
v_exp_f32 v11, v51
s_nop 0
v_add_f32 v26, v26, v8
v_add_f32 v26, v26, v9
v_cvt_pk_bf16_f32 v100, v8, v9
v_add_f32 v26, v26, v10
v_add_f32 v26, v26, v11
v_cvt_pk_bf16_f32 v101, v10, v11
v_exp_f32 v12, v52
v_exp_f32 v13, v53
v_exp_f32 v14, v54
v_exp_f32 v15, v55
s_nop 0
v_add_f32 v27, v27, v12
v_add_f32 v27, v27, v13
v_cvt_pk_bf16_f32 v108, v12, v13
v_add_f32 v27, v27, v14
v_add_f32 v27, v27, v15
v_cvt_pk_bf16_f32 v109, v14, v15
v_exp_f32 v8, v56
v_exp_f32 v9, v57
v_exp_f32 v10, v58
v_exp_f32 v11, v59
s_nop 0
v_add_f32 v26, v26, v8
v_add_f32 v26, v26, v9
v_cvt_pk_bf16_f32 v102, v8, v9
v_add_f32 v26, v26, v10
v_add_f32 v26, v26, v11
v_cvt_pk_bf16_f32 v103, v10, v11
v_exp_f32 v12, v60
v_exp_f32 v13, v61
v_exp_f32 v14, v62
v_exp_f32 v15, v63
s_nop 0
v_add_f32 v27, v27, v12
v_add_f32 v27, v27, v13
v_cvt_pk_bf16_f32 v110, v12, v13
v_add_f32 v27, v27, v14
v_add_f32 v27, v27, v15
v_cvt_pk_bf16_f32 v111, v14, v15
s_nop 1
s_setpc_b64 s[16:17]
K2_slow1:
s_nop 7
s_nop 7
v_max3_f32 v28, v64, v65, 0
v_max3_f32 v28, v66, v67, v28
v_max3_f32 v28, v72, v73, v28
v_max3_f32 v28, v74, v75, v28
v_max3_f32 v28, v80, v81, v28
v_max3_f32 v28, v82, v83, v28
v_max3_f32 v28, v88, v89, v28
v_max3_f32 v28, v90, v91, v28
v_mov_b32 v29, v28
s_nop 1
v_permlane16_swap_b32 v28, v29
v_max_f32 v28, v28, v29
v_mov_b32 v29, v28
s_nop 1
v_permlane32_swap_b32 v28, v29
v_max_f32 v28, v28, v29
v_exp_f32 v29, -v28
v_sub_f32 v16, v16, v28
v_sub_f32 v17, v17, v28
v_sub_f32 v18, v18, v28
v_sub_f32 v19, v19, v28
v_mul_f32 v24, v24, v29
v_mul_f32 v128, v128, v29
v_mul_f32 v129, v129, v29
v_mul_f32 v130, v130, v29
v_mul_f32 v131, v131, v29
v_mul_f32 v136, v136, v29
v_mul_f32 v137, v137, v29
v_mul_f32 v138, v138, v29
v_mul_f32 v139, v139, v29
v_mul_f32 v144, v144, v29
v_mul_f32 v145, v145, v29
v_mul_f32 v146, v146, v29
v_mul_f32 v147, v147, v29
v_mul_f32 v152, v152, v29
v_mul_f32 v153, v153, v29
v_mul_f32 v154, v154, v29
v_mul_f32 v155, v155, v29
v_mul_f32 v160, v160, v29
v_mul_f32 v161, v161, v29
v_mul_f32 v162, v162, v29
v_mul_f32 v163, v163, v29
v_mul_f32 v168, v168, v29
v_mul_f32 v169, v169, v29
v_mul_f32 v170, v170, v29
v_mul_f32 v171, v171, v29
v_mul_f32 v176, v176, v29
v_mul_f32 v177, v177, v29
v_mul_f32 v178, v178, v29
v_mul_f32 v179, v179, v29
v_mul_f32 v184, v184, v29
v_mul_f32 v185, v185, v29
v_mul_f32 v186, v186, v29
v_mul_f32 v187, v187, v29
v_mul_f32 v192, v192, v29
v_mul_f32 v193, v193, v29
v_mul_f32 v194, v194, v29
v_mul_f32 v195, v195, v29
v_mul_f32 v200, v200, v29
v_mul_f32 v201, v201, v29
v_mul_f32 v202, v202, v29
v_mul_f32 v203, v203, v29
v_mul_f32 v208, v208, v29
v_mul_f32 v209, v209, v29
v_mul_f32 v210, v210, v29
v_mul_f32 v211, v211, v29
v_mul_f32 v216, v216, v29
v_mul_f32 v217, v217, v29
v_mul_f32 v218, v218, v29
v_mul_f32 v219, v219, v29
v_mul_f32 v224, v224, v29
v_mul_f32 v225, v225, v29
v_mul_f32 v226, v226, v29
v_mul_f32 v227, v227, v29
v_mul_f32 v232, v232, v29
v_mul_f32 v233, v233, v29
v_mul_f32 v234, v234, v29
v_mul_f32 v235, v235, v29
v_mul_f32 v240, v240, v29
v_mul_f32 v241, v241, v29
v_mul_f32 v242, v242, v29
v_mul_f32 v243, v243, v29
v_mul_f32 v248, v248, v29
v_mul_f32 v249, v249, v29
v_mul_f32 v250, v250, v29
v_mul_f32 v251, v251, v29
v_sub_f32 v32, v32, v28
v_sub_f32 v33, v33, v28
v_sub_f32 v34, v34, v28
v_sub_f32 v35, v35, v28
v_sub_f32 v40, v40, v28
v_sub_f32 v41, v41, v28
v_sub_f32 v42, v42, v28
v_sub_f32 v43, v43, v28
v_sub_f32 v48, v48, v28
v_sub_f32 v49, v49, v28
v_sub_f32 v50, v50, v28
v_sub_f32 v51, v51, v28
v_sub_f32 v56, v56, v28
v_sub_f32 v57, v57, v28
v_sub_f32 v58, v58, v28
v_sub_f32 v59, v59, v28
v_sub_f32 v64, v64, v28
v_sub_f32 v65, v65, v28
v_sub_f32 v66, v66, v28
v_sub_f32 v67, v67, v28
v_sub_f32 v72, v72, v28
v_sub_f32 v73, v73, v28
v_sub_f32 v74, v74, v28
v_sub_f32 v75, v75, v28
v_sub_f32 v80, v80, v28
v_sub_f32 v81, v81, v28
v_sub_f32 v82, v82, v28
v_sub_f32 v83, v83, v28
v_sub_f32 v88, v88, v28
v_sub_f32 v89, v89, v28
v_sub_f32 v90, v90, v28
v_sub_f32 v91, v91, v28
v_max3_f32 v28, v68, v69, 0
v_max3_f32 v28, v70, v71, v28
v_max3_f32 v28, v76, v77, v28
v_max3_f32 v28, v78, v79, v28
v_max3_f32 v28, v84, v85, v28
v_max3_f32 v28, v86, v87, v28
v_max3_f32 v28, v92, v93, v28
v_max3_f32 v28, v94, v95, v28
v_mov_b32 v29, v28
s_nop 1
v_permlane16_swap_b32 v28, v29
v_max_f32 v28, v28, v29
v_mov_b32 v29, v28
s_nop 1
v_permlane32_swap_b32 v28, v29
v_max_f32 v28, v28, v29
v_exp_f32 v29, -v28
v_sub_f32 v20, v20, v28
v_sub_f32 v21, v21, v28
v_sub_f32 v22, v22, v28
v_sub_f32 v23, v23, v28
v_mul_f32 v25, v25, v29
v_mul_f32 v132, v132, v29
v_mul_f32 v133, v133, v29
v_mul_f32 v134, v134, v29
v_mul_f32 v135, v135, v29
v_mul_f32 v140, v140, v29
v_mul_f32 v141, v141, v29
v_mul_f32 v142, v142, v29
v_mul_f32 v143, v143, v29
v_mul_f32 v148, v148, v29
v_mul_f32 v149, v149, v29
v_mul_f32 v150, v150, v29
v_mul_f32 v151, v151, v29
v_mul_f32 v156, v156, v29
v_mul_f32 v157, v157, v29
v_mul_f32 v158, v158, v29
v_mul_f32 v159, v159, v29
v_mul_f32 v164, v164, v29
v_mul_f32 v165, v165, v29
v_mul_f32 v166, v166, v29
v_mul_f32 v167, v167, v29
v_mul_f32 v172, v172, v29
v_mul_f32 v173, v173, v29
v_mul_f32 v174, v174, v29
v_mul_f32 v175, v175, v29
v_mul_f32 v180, v180, v29
v_mul_f32 v181, v181, v29
v_mul_f32 v182, v182, v29
v_mul_f32 v183, v183, v29
v_mul_f32 v188, v188, v29
v_mul_f32 v189, v189, v29
v_mul_f32 v190, v190, v29
v_mul_f32 v191, v191, v29
v_mul_f32 v196, v196, v29
v_mul_f32 v197, v197, v29
v_mul_f32 v198, v198, v29
v_mul_f32 v199, v199, v29
v_mul_f32 v204, v204, v29
v_mul_f32 v205, v205, v29
v_mul_f32 v206, v206, v29
v_mul_f32 v207, v207, v29
v_mul_f32 v212, v212, v29
v_mul_f32 v213, v213, v29
v_mul_f32 v214, v214, v29
v_mul_f32 v215, v215, v29
v_mul_f32 v220, v220, v29
v_mul_f32 v221, v221, v29
v_mul_f32 v222, v222, v29
v_mul_f32 v223, v223, v29
v_mul_f32 v228, v228, v29
v_mul_f32 v229, v229, v29
v_mul_f32 v230, v230, v29
v_mul_f32 v231, v231, v29
v_mul_f32 v236, v236, v29
v_mul_f32 v237, v237, v29
v_mul_f32 v238, v238, v29
v_mul_f32 v239, v239, v29
v_mul_f32 v244, v244, v29
v_mul_f32 v245, v245, v29
v_mul_f32 v246, v246, v29
v_mul_f32 v247, v247, v29
v_mul_f32 v252, v252, v29
v_mul_f32 v253, v253, v29
v_mul_f32 v254, v254, v29
v_mul_f32 v255, v255, v29
v_sub_f32 v36, v36, v28
v_sub_f32 v37, v37, v28
v_sub_f32 v38, v38, v28
v_sub_f32 v39, v39, v28
v_sub_f32 v44, v44, v28
v_sub_f32 v45, v45, v28
v_sub_f32 v46, v46, v28
v_sub_f32 v47, v47, v28
v_sub_f32 v52, v52, v28
v_sub_f32 v53, v53, v28
v_sub_f32 v54, v54, v28
v_sub_f32 v55, v55, v28
v_sub_f32 v60, v60, v28
v_sub_f32 v61, v61, v28
v_sub_f32 v62, v62, v28
v_sub_f32 v63, v63, v28
v_sub_f32 v68, v68, v28
v_sub_f32 v69, v69, v28
v_sub_f32 v70, v70, v28
v_sub_f32 v71, v71, v28
v_sub_f32 v76, v76, v28
v_sub_f32 v77, v77, v28
v_sub_f32 v78, v78, v28
v_sub_f32 v79, v79, v28
v_sub_f32 v84, v84, v28
v_sub_f32 v85, v85, v28
v_sub_f32 v86, v86, v28
v_sub_f32 v87, v87, v28
v_sub_f32 v92, v92, v28
v_sub_f32 v93, v93, v28
v_sub_f32 v94, v94, v28
v_sub_f32 v95, v95, v28
v_exp_f32 v8, v64
v_exp_f32 v9, v65
v_exp_f32 v10, v66
v_exp_f32 v11, v67
s_nop 0
v_add_f32 v26, v8, v9
v_cvt_pk_bf16_f32 v112, v8, v9
v_add_f32 v26, v26, v10
v_add_f32 v26, v26, v11
v_cvt_pk_bf16_f32 v113, v10, v11
v_exp_f32 v12, v68
v_exp_f32 v13, v69
v_exp_f32 v14, v70
v_exp_f32 v15, v71
s_nop 0
v_add_f32 v27, v12, v13
v_cvt_pk_bf16_f32 v120, v12, v13
v_add_f32 v27, v27, v14
v_add_f32 v27, v27, v15
v_cvt_pk_bf16_f32 v121, v14, v15
v_exp_f32 v8, v72
v_exp_f32 v9, v73
v_exp_f32 v10, v74
v_exp_f32 v11, v75
s_nop 0
v_add_f32 v26, v26, v8
v_add_f32 v26, v26, v9
v_cvt_pk_bf16_f32 v114, v8, v9
v_add_f32 v26, v26, v10
v_add_f32 v26, v26, v11
v_cvt_pk_bf16_f32 v115, v10, v11
v_exp_f32 v12, v76
v_exp_f32 v13, v77
v_exp_f32 v14, v78
v_exp_f32 v15, v79
s_nop 0
v_add_f32 v27, v27, v12
v_add_f32 v27, v27, v13
v_cvt_pk_bf16_f32 v122, v12, v13
v_add_f32 v27, v27, v14
v_add_f32 v27, v27, v15
v_cvt_pk_bf16_f32 v123, v14, v15
v_exp_f32 v8, v80
v_exp_f32 v9, v81
v_exp_f32 v10, v82
v_exp_f32 v11, v83
s_nop 0
v_add_f32 v26, v26, v8
v_add_f32 v26, v26, v9
v_cvt_pk_bf16_f32 v116, v8, v9
v_add_f32 v26, v26, v10
v_add_f32 v26, v26, v11
v_cvt_pk_bf16_f32 v117, v10, v11
v_exp_f32 v12, v84
v_exp_f32 v13, v85
v_exp_f32 v14, v86
v_exp_f32 v15, v87
s_nop 0
v_add_f32 v27, v27, v12
v_add_f32 v27, v27, v13
v_cvt_pk_bf16_f32 v124, v12, v13
v_add_f32 v27, v27, v14
v_add_f32 v27, v27, v15
v_cvt_pk_bf16_f32 v125, v14, v15
v_exp_f32 v8, v88
v_exp_f32 v9, v89
v_exp_f32 v10, v90
v_exp_f32 v11, v91
s_nop 0
v_add_f32 v26, v26, v8
v_add_f32 v26, v26, v9
v_cvt_pk_bf16_f32 v118, v8, v9
v_add_f32 v26, v26, v10
v_add_f32 v26, v26, v11
v_cvt_pk_bf16_f32 v119, v10, v11
v_exp_f32 v12, v92
v_exp_f32 v13, v93
v_exp_f32 v14, v94
v_exp_f32 v15, v95
s_nop 0
v_add_f32 v27, v27, v12
v_add_f32 v27, v27, v13
v_cvt_pk_bf16_f32 v126, v12, v13
v_add_f32 v27, v27, v14
v_add_f32 v27, v27, v15
v_cvt_pk_bf16_f32 v127, v14, v15
s_nop 1
s_setpc_b64 s[16:17]
M_cntspinK:
Lp_9801:
buffer_load_dword v245, off, s[60:63], 0 sc1
s_waitcnt vmcnt(0)
v_cmp_gt_u32 vcc, 0x100, v245
s_cbranch_vccz Lpd_9802
s_sleep 8
s_sub_u32 s101, s101, 1
s_cbranch_scc0 Lp_9801
s_mov_b32 s101, 0
Lpd_9802:
s_branch Lg_1
M_ppspinK:
Lp_9803:
buffer_load_dword v230, v231, s[4:7], s52 offen sc1
s_waitcnt vmcnt(0)
v_cmp_gt_u32 vcc, 1, v230
s_cbranch_vccz Lpd_9804
s_sleep 8
s_sub_u32 s101, s101, 1
s_cbranch_scc0 Lp_9803
s_mov_b32 s101, 0
Lpd_9804:
s_branch M_ppokK
M_cntspinV:
Lp_9805:
buffer_load_dword v245, off, s[60:63], 0 sc1
s_waitcnt vmcnt(0)
v_cmp_gt_u32 vcc, 0x100, v245
s_cbranch_vccz Lpd_9806
s_sleep 8
s_sub_u32 s101, s101, 1
s_cbranch_scc0 Lp_9805
s_mov_b32 s101, 0
Lpd_9806:
s_branch Lg_2
M_ppspinV:
Lp_9807:
buffer_load_dword v230, v231, s[4:7], s52 offen sc1
s_waitcnt vmcnt(0)
v_cmp_gt_u32 vcc, 1, v230
s_cbranch_vccz Lpd_9808
s_sleep 8
s_sub_u32 s101, s101, 1
s_cbranch_scc0 Lp_9807
s_mov_b32 s101, 0
Lpd_9808:
s_branch M_ppokV
M_end:
s_endpgm
.section .rodata,"a"
.p2align 6
.amdhsa_kernel concat_heads__ssm_conv_h3__compressed_kv_cla__prompt_kernel
  .amdhsa_next_free_vgpr 512
  .amdhsa_next_free_sgpr 102
  .amdhsa_accum_offset 256
  .amdhsa_group_segment_fixed_size 0
  .amdhsa_kernarg_size 120
  .amdhsa_user_sgpr_count 2
  .amdhsa_user_sgpr_kernarg_segment_ptr 1
  .amdhsa_system_sgpr_workgroup_id_x 1
  .amdhsa_float_denorm_mode_32 3
  .amdhsa_float_denorm_mode_16_64 3
  .amdhsa_ieee_mode 0
  .amdhsa_dx10_clamp 0
.end_amdhsa_kernel
```

```asm
; @launch grid=(256,1,1) block=(256,1,1) lds=163840
.amdgcn_target "amdgcn-amd-amdhsa--gfx950"
.text
.globl concat_heads__ssm_conv_h3__compressed_kv_cla__prompt_kernel
.p2align 8
.type concat_heads__ssm_conv_h3__compressed_kv_cla__prompt_kernel,@function
concat_heads__ssm_conv_h3__compressed_kv_cla__prompt_kernel:
s_cmp_ge_u32 s2, 256
s_cbranch_scc1 M_end
s_load_dwordx16 s[64:79], s[0:1], 0
s_load_dwordx8 s[80:87], s[0:1], 64
s_load_dwordx4 s[88:91], s[0:1], 96
s_load_dwordx2 s[92:93], s[0:1], 112
v_lshrrev_b32 v28, 6, v0
v_and_b32 v29, 63, v0
v_lshlrev_b32 v1, 4, v29
v_readfirstlane_b32 s3, v28
s_and_b32 s20, s2, 7
s_lshl_b32 s20, s20, 1
s_bfe_u32 s22, s2, 0x10003
s_add_u32 s20, s20, s22
s_lshr_b32 s21, s2, 5
s_mov_b32 s101, 0x40000
v_lshrrev_b32 v26, 7, v1
v_lshrrev_b32 v27, 1, v26
v_lshlrev_b32 v27, 4, v27
v_and_b32 v28, 0x70, v1
v_xor_b32 v27, v27, v28
v_mul_u32_u24 v26, 2048, v26
v_add_u32 v12, v26, v27
v_xor_b32 v27, 64, v27
v_add_u32 v26, v26, v27
v_add_u32 v13, 15360, v26
v_add_u32 v14, 30720, v12
v_add_u32 v15, 46080, v26
v_lshrrev_b32 v26, 5, v29
v_and_b32 v27, 31, v29
s_and_b32 s22, s3, 1
s_lshl_b32 s22, s22, 2
v_or_b32 v28, s22, v26
v_lshlrev_b32 v28, 1, v28
v_xor_b32 v27, v27, v28
v_lshlrev_b32 v27, 4, v27
v_lshl_add_u32 v16, v26, 13, v27
v_xor_b32 v26, 64, v16
v_add_u32 v17, 15360, v26
v_add_u32 v18, 30720, v16
v_add_u32 v19, 46080, v26
s_lshl_b32 s28, s3, 13
s_lshl_b32 s29, s3, 12
s_lshl_b32 s24, s21, 19
s_lshl_b32 s22, s3, 17
s_add_u32 s24, s24, s22
s_add_u32 s25, s24, 65536
s_lshl_b32 s26, s3, 16
s_lshl_b32 s22, s20, 9
s_add_u32 s26, s26, s22
s_add_u32 s27, s26, 262144
s_mov_b32 s10, 4194304
s_mov_b32 s11, 0x20000
s_mov_b32 s14, 8388608
s_mov_b32 s15, 0x20000
s_bitcmp1_b32 s2, 4
s_waitcnt lgkmcnt(0)
s_mov_b64 s[8:9], s[78:79]
s_cselect_b64 s[12:13], s[84:85], s[82:83]
s_add_u32 m0, s28, 0
s_nop 0
buffer_load_dwordx4 v12, s[8:11], s24 offen offset:0 lds
buffer_load_dwordx4 v13, s[8:11], s24 offen offset:1024 lds
buffer_load_dwordx4 v14, s[8:11], s24 offen offset:2048 lds
buffer_load_dwordx4 v15, s[8:11], s24 offen offset:3072 lds
s_add_u32 s24, s24, 128
s_add_u32 m0, s28, 4096
s_nop 0
buffer_load_dwordx4 v12, s[8:11], s25 offen offset:0 lds
buffer_load_dwordx4 v13, s[8:11], s25 offen offset:1024 lds
buffer_load_dwordx4 v14, s[8:11], s25 offen offset:2048 lds
buffer_load_dwordx4 v15, s[8:11], s25 offen offset:3072 lds
s_add_u32 s25, s25, 128
s_add_u32 m0, s29, 65536
s_nop 0
buffer_load_dwordx4 v16, s[12:15], s26 offen offset:0 lds
buffer_load_dwordx4 v17, s[12:15], s26 offen offset:1024 lds
buffer_load_dwordx4 v18, s[12:15], s26 offen offset:2048 lds
buffer_load_dwordx4 v19, s[12:15], s26 offen offset:3072 lds
s_add_u32 s26, s26, 524288
s_add_u32 m0, s29, 81920
s_nop 0
buffer_load_dwordx4 v16, s[12:15], s27 offen offset:0 lds
buffer_load_dwordx4 v17, s[12:15], s27 offen offset:1024 lds
buffer_load_dwordx4 v18, s[12:15], s27 offen offset:2048 lds
buffer_load_dwordx4 v19, s[12:15], s27 offen offset:3072 lds
s_add_u32 s27, s27, 524288
s_mov_b32 s4, s92
s_mov_b32 s5, s93
s_mov_b32 s6, 268435456
s_mov_b32 s7, 0x20000
s_add_u32 m0, s28, 32768
s_nop 0
buffer_load_dwordx4 v12, s[8:11], s24 offen offset:0 lds
buffer_load_dwordx4 v13, s[8:11], s24 offen offset:1024 lds
buffer_load_dwordx4 v14, s[8:11], s24 offen offset:2048 lds
buffer_load_dwordx4 v15, s[8:11], s24 offen offset:3072 lds
s_add_u32 s24, s24, 128
s_add_u32 m0, s28, 36864
s_nop 0
buffer_load_dwordx4 v12, s[8:11], s25 offen offset:0 lds
buffer_load_dwordx4 v13, s[8:11], s25 offen offset:1024 lds
buffer_load_dwordx4 v14, s[8:11], s25 offen offset:2048 lds
buffer_load_dwordx4 v15, s[8:11], s25 offen offset:3072 lds
s_add_u32 s25, s25, 128
s_add_u32 m0, s29, 98304
s_nop 0
buffer_load_dwordx4 v16, s[12:15], s26 offen offset:0 lds
buffer_load_dwordx4 v17, s[12:15], s26 offen offset:1024 lds
buffer_load_dwordx4 v18, s[12:15], s26 offen offset:2048 lds
buffer_load_dwordx4 v19, s[12:15], s26 offen offset:3072 lds
s_add_u32 s26, s26, 524288
s_mul_hi_u32 s38, s2, 613566757
s_mul_i32 s39, s38, 7
s_sub_u32 s39, s2, s39
v_mov_b32 v246, 0
v_mov_b32 v229, 0
v_mov_b32 v231, 0
s_cmp_eq_u32 s3, 3
s_cselect_b64 s[40:41], s[76:77], s[80:81]
s_cselect_b32 s42, 1835008, 0
s_cmp_eq_u32 s3, 1
s_cselect_b32 s42, 3670016, s42
s_cmp_eq_u32 s3, 3
s_cselect_b64 s[44:45], s[86:87], s[72:73]
s_cselect_b32 s46, 3670016, 0
s_cmp_eq_u32 s3, 1
s_cselect_b32 s46, 1835008, s46
s_mov_b32 s19, 0x20000
s_cmp_eq_u32 s3, 2
s_cbranch_scc1 M_pf2
s_cmp_lg_u32 s3, 0
s_cbranch_scc1 M_pf3
s_mov_b64 s[16:17], s[12:13]
s_mov_b32 s18, 8388608
s_mov_b32 s51, 8388608
s_mov_b32 s47, 524288
s_mov_b32 s43, 1048576
s_lshl_b32 s22, s21, 16
s_lshl_b32 s23, s20, 9
s_add_u32 s22, s22, s23
v_lshrrev_b32 v26, 2, v29
v_lshl_add_u32 v26, v26, 13, s22
v_and_b32 v27, 3, v29
v_lshl_add_u32 v20, v27, 7, v26
v_cmp_gt_u32 vcc, 32, v29
v_mov_b32 v26, 3221225472
s_nop 0
v_cndmask_b32 v20, v26, v20, vcc
buffer_load_dword v21, v20, s[16:19], s43 offen
s_add_u32 s43, s43, s47
s_branch M_pfd
M_pf2:
s_mov_b64 s[16:17], s[78:79]
s_mov_b32 s18, 4194304
s_mov_b32 s51, 2048
s_mov_b64 s[40:41], s[64:65]
s_mov_b32 s42, 1835008
s_mov_b32 s47, 256
s_mov_b32 s43, 256
s_lshl_b32 s22, s2, 14
v_lshrrev_b32 v26, 1, v29
v_lshl_add_u32 v26, v26, 11, s22
v_and_b32 v27, 1, v29
v_lshl_add_u32 v20, v27, 7, v26
v_cmp_gt_u32 vcc, 16, v29
s_branch M_pfd
M_pf3:
s_mov_b64 s[16:17], s[76:77]
s_mov_b32 s18, 0
s_mov_b32 s51, 2490368
s_mov_b32 s47, 622592
s_mov_b32 s43, 0
s_mul_i32 s22, s2, 2432
v_lshl_add_u32 v20, v29, 7, s22
v_cmp_gt_u32 vcc, 19, v29
M_pfd:
v_mov_b32 v26, 3221225472
s_nop 0
v_cndmask_b32 v20, v26, v20, vcc
buffer_load_dword v21, v20, s[16:19], s43 offen
s_add_u32 s43, s43, s47
s_mov_b32 s60, s90
s_mov_b32 s61, s91
s_mov_b32 s62, 256
s_mov_b32 s63, 0x20000
s_bfe_u32 s55, s2, 0x20003
s_add_u32 s55, s55, 5
s_getpc_b64 s[56:57]
M_pc:
s_lshr_b32 s22, s2, 3
s_lshl_b32 s22, s22, 5
v_and_b32 v26, 31, v0
v_add_u32 v26, s22, v26
v_lshlrev_b32 v26, 7, v26
v_min_u32 v26, M_end-M_pc, v26
v_mov_b32 v27, s57
v_add_co_u32 v26, vcc, s56, v26
s_nop 1
v_addc_co_u32 v27, vcc, 0, v27, vcc
global_load_dword v21, v[26:27], off
v_and_b32 v30, 15, v29
v_lshrrev_b32 v31, 4, v29
v_lshrrev_b32 v26, 1, v30
v_xor_b32 v26, v31, v26
v_lshlrev_b32 v26, 4, v26
v_lshl_add_u32 v2, v30, 7, v26
s_lshr_b32 s22, s3, 1
s_lshl_b32 s22, s22, 14
v_add_u32 v2, s22, v2
v_xor_b32 v3, 64, v2
v_lshrrev_b32 v26, 2, v30
v_and_b32 v27, 1, v31
v_lshl_or_b32 v27, v27, 2, v26
v_lshl_add_u32 v26, v31, 3, v26
v_lshlrev_b32 v26, 9, v26
v_lshl_add_u32 v26, v27, 5, v26
v_and_b32 v27, 3, v29
v_lshl_add_u32 v26, v27, 3, v26
s_and_b32 s22, s3, 1
s_lshl_b32 s22, s22, 8
s_add_u32 s22, s22, 0x10000
v_xor_b32 v4, s22, v26
v_xor_b32 v5, 32, v4
v_xor_b32 v6, 64, v4
v_xor_b32 v7, 96, v4
v_xor_b32 v8, 128, v4
v_xor_b32 v9, 160, v4
v_xor_b32 v10, 192, v4
v_xor_b32 v11, 224, v4
s_lshr_b32 s22, s2, 4
s_lshl_b32 s23, s20, 5
s_add_u32 s23, s23, s22
s_lshl_b32 s23, s23, 2
s_and_b32 s22, s2, 16
s_lshl_b32 s22, s22, 7
s_add_u32 s23, s23, s22
v_mov_b32 v28, 3221225472
v_writelane_b32 v28, s23, 0
s_add_u32 s30, s23, 16384
v_writelane_b32 v28, s30, 1
s_add_u32 s30, s23, 4096
v_writelane_b32 v28, s30, 2
s_sub_u32 s37, 15, s21
s_bitcmp1_b32 s2, 4
s_cselect_b32 s37, s21, s37
s_lshl_b32 s30, s37, 5
s_add_u32 s30, s30, s20
s_lshl_b32 s30, s30, 2
s_add_u32 s30, s30, 8192
v_writelane_b32 v28, s30, 3
s_add_u32 s30, s30, 2048
v_writelane_b32 v28, s30, 6
s_lshl_b32 s30, s2, 2
s_add_u32 s30, s30, 12288
v_writelane_b32 v28, s30, 4
s_lshl_b32 s30, s39, 5
s_add_u32 s30, s30, s38
s_lshl_b32 s30, s30, 2
s_add_u32 s30, s30, 20480
s_cmp_lt_u32 s2, 224
s_cselect_b32 s30, s30, 3221225472
v_writelane_b32 v28, s30, 7
s_cmp_eq_u32 s3, 0
s_cselect_b32 s30, 94371840, 3221225472
buffer_store_dword v246, v28, s[4:7], s30 offen sc1
v_mov_b32 v27, 1
v_cmp_eq_u32 vcc, 0, v0
v_mov_b32 v26, 3221225472
s_lshl_b32 s31, s20, 20
s_lshl_b32 s22, s21, 17
v_cndmask_b32 v26, v26, v246, vcc
s_add_u32 s31, s31, s22
s_lshr_b32 s22, s3, 1
s_lshl_b32 s22, s22, 16
s_add_u32 s31, s31, s22
s_and_b32 s22, s3, 1
s_waitcnt vmcnt(15)
s_barrier
ds_read_b128 a[0:3], v2 offset:0
ds_read_b128 a[4:7], v3 offset:0
ds_read_b128 a[8:11], v2 offset:2048
ds_read_b128 a[12:15], v3 offset:2048
ds_read_b128 a[16:19], v2 offset:4096
ds_read_b128 a[20:23], v3 offset:4096
ds_read_b128 a[24:27], v2 offset:6144
ds_read_b128 a[28:31], v3 offset:6144
ds_read_b128 a[32:35], v2 offset:8192
ds_read_b128 a[36:39], v3 offset:8192
ds_read_b128 a[40:43], v2 offset:10240
ds_read_b128 a[44:47], v3 offset:10240
ds_read_b128 a[48:51], v2 offset:12288
ds_read_b128 a[52:55], v3 offset:12288
ds_read_b128 a[56:59], v2 offset:14336
ds_read_b128 a[60:63], v3 offset:14336
ds_read_b64_tr_b16 a[128:129], v4 offset:0
ds_read_b64_tr_b16 a[130:131], v4 offset:2048
ds_read_b64_tr_b16 a[132:133], v4 offset:16384
ds_read_b64_tr_b16 a[134:135], v4 offset:18432
s_waitcnt vmcnt(7) lgkmcnt(0)
s_barrier
s_bitcmp1_b32 s2, 4
s_cbranch_scc1 M_V
s_lshl_b32 s22, s22, 12
s_add_u32 s31, s31, s22
s_mov_b32 s32, 8192
s_mov_b32 s33, 8192
s_mov_b32 s34, 8192
s_mov_b32 s35, 4294910976
s_mov_b32 s36, 4294910976
s_mov_b32 s30, 8
s_mov_b32 s82, 3221225472
v_mfma_f32_16x16x32_bf16 v[32:35], a[128:131], a[0:3], 0
s_add_u32 m0, s29, 114688
ds_read_b64_tr_b16 a[136:137], v5 offset:0
v_mfma_f32_16x16x32_bf16 v[32:35], a[132:135], a[4:7], v[32:35]
buffer_load_dwordx4 v16, s[12:15], s27 offen offset:0 lds
v_mfma_f32_16x16x32_bf16 v[40:43], a[128:131], a[8:11], 0
ds_read_b64_tr_b16 a[138:139], v5 offset:2048
v_mfma_f32_16x16x32_bf16 v[40:43], a[132:135], a[12:15], v[40:43]
v_mfma_f32_16x16x32_bf16 v[48:51], a[128:131], a[16:19], 0
ds_read_b64_tr_b16 a[140:141], v5 offset:16384
v_mfma_f32_16x16x32_bf16 v[48:51], a[132:135], a[20:23], v[48:51]
buffer_load_dwordx4 v17, s[12:15], s27 offen offset:1024 lds
v_mfma_f32_16x16x32_bf16 v[56:59], a[128:131], a[24:27], 0
ds_read_b64_tr_b16 a[142:143], v5 offset:18432
v_mfma_f32_16x16x32_bf16 v[56:59], a[132:135], a[28:31], v[56:59]
v_mfma_f32_16x16x32_bf16 v[64:67], a[128:131], a[32:35], 0
ds_read_b128 a[64:67], v2 offset:32768
v_mfma_f32_16x16x32_bf16 v[64:67], a[132:135], a[36:39], v[64:67]
buffer_load_dwordx4 v18, s[12:15], s27 offen offset:2048 lds
v_mfma_f32_16x16x32_bf16 v[72:75], a[128:131], a[40:43], 0
ds_read_b128 a[68:71], v3 offset:32768
v_mfma_f32_16x16x32_bf16 v[72:75], a[132:135], a[44:47], v[72:75]
v_mfma_f32_16x16x32_bf16 v[80:83], a[128:131], a[48:51], 0
v_mfma_f32_16x16x32_bf16 v[80:83], a[132:135], a[52:55], v[80:83]
buffer_load_dwordx4 v19, s[12:15], s27 offen offset:3072 lds
v_mfma_f32_16x16x32_bf16 v[88:91], a[128:131], a[56:59], 0
s_add_u32 s27, s27, 524288
ds_read_b128 a[72:75], v2 offset:34816
v_mfma_f32_16x16x32_bf16 v[88:91], a[132:135], a[60:63], v[88:91]
s_waitcnt lgkmcnt(5)
v_mfma_f32_16x16x32_bf16 v[36:39], a[136:139], a[0:3], 0
s_waitcnt lgkmcnt(3)
s_add_u32 m0, s28, 0
ds_read_b64_tr_b16 a[128:129], v6 offset:0
v_mfma_f32_16x16x32_bf16 v[36:39], a[140:143], a[4:7], v[36:39]
buffer_load_dwordx4 v12, s[8:11], s24 offen offset:0 lds
v_mfma_f32_16x16x32_bf16 v[44:47], a[136:139], a[8:11], 0
ds_read_b64_tr_b16 a[130:131], v6 offset:2048
v_mfma_f32_16x16x32_bf16 v[44:47], a[140:143], a[12:15], v[44:47]
v_mfma_f32_16x16x32_bf16 v[52:55], a[136:139], a[16:19], 0
ds_read_b64_tr_b16 a[132:133], v6 offset:16384
v_mfma_f32_16x16x32_bf16 v[52:55], a[140:143], a[20:23], v[52:55]
buffer_load_dwordx4 v13, s[8:11], s24 offen offset:1024 lds
v_mfma_f32_16x16x32_bf16 v[60:63], a[136:139], a[24:27], 0
ds_read_b64_tr_b16 a[134:135], v6 offset:18432
v_mfma_f32_16x16x32_bf16 v[60:63], a[140:143], a[28:31], v[60:63]
v_mfma_f32_16x16x32_bf16 v[68:71], a[136:139], a[32:35], 0
ds_read_b128 a[76:79], v3 offset:34816
v_mfma_f32_16x16x32_bf16 v[68:71], a[140:143], a[36:39], v[68:71]
buffer_load_dwordx4 v14, s[8:11], s24 offen offset:2048 lds
v_mfma_f32_16x16x32_bf16 v[76:79], a[136:139], a[40:43], 0
v_mfma_f32_16x16x32_bf16 v[76:79], a[140:143], a[44:47], v[76:79]
v_mfma_f32_16x16x32_bf16 v[84:87], a[136:139], a[48:51], 0
ds_read_b128 a[80:83], v2 offset:36864
v_mfma_f32_16x16x32_bf16 v[84:87], a[140:143], a[52:55], v[84:87]
buffer_load_dwordx4 v15, s[8:11], s24 offen offset:3072 lds
v_mfma_f32_16x16x32_bf16 v[92:95], a[136:139], a[56:59], 0
s_add_u32 s24, s24, 128
ds_read_b128 a[84:87], v3 offset:36864
v_mfma_f32_16x16x32_bf16 v[92:95], a[140:143], a[60:63], v[92:95]
s_waitcnt lgkmcnt(5)
v_mfma_f32_16x16x32_bf16 v[96:99], a[128:131], a[0:3], 0
s_waitcnt lgkmcnt(3)
s_add_u32 m0, s28, 4096
ds_read_b64_tr_b16 a[136:137], v7 offset:0
v_mfma_f32_16x16x32_bf16 v[96:99], a[132:135], a[4:7], v[96:99]
buffer_load_dwordx4 v12, s[8:11], s25 offen offset:0 lds
v_mfma_f32_16x16x32_bf16 v[104:107], a[128:131], a[8:11], 0
ds_read_b64_tr_b16 a[138:139], v7 offset:2048
v_mfma_f32_16x16x32_bf16 v[104:107], a[132:135], a[12:15], v[104:107]
v_mfma_f32_16x16x32_bf16 v[112:115], a[128:131], a[16:19], 0
ds_read_b64_tr_b16 a[140:141], v7 offset:16384
v_mfma_f32_16x16x32_bf16 v[112:115], a[132:135], a[20:23], v[112:115]
buffer_load_dwordx4 v13, s[8:11], s25 offen offset:1024 lds
v_mfma_f32_16x16x32_bf16 v[120:123], a[128:131], a[24:27], 0
ds_read_b64_tr_b16 a[142:143], v7 offset:18432
v_mfma_f32_16x16x32_bf16 v[120:123], a[132:135], a[28:31], v[120:123]
v_mfma_f32_16x16x32_bf16 v[128:131], a[128:131], a[32:35], 0
v_mfma_f32_16x16x32_bf16 v[128:131], a[132:135], a[36:39], v[128:131]
buffer_load_dwordx4 v14, s[8:11], s25 offen offset:2048 lds
v_mfma_f32_16x16x32_bf16 v[136:139], a[128:131], a[40:43], 0
ds_read_b128 a[88:91], v2 offset:38912
v_mfma_f32_16x16x32_bf16 v[136:139], a[132:135], a[44:47], v[136:139]
v_mfma_f32_16x16x32_bf16 v[144:147], a[128:131], a[48:51], 0
ds_read_b128 a[92:95], v3 offset:38912
v_mfma_f32_16x16x32_bf16 v[144:147], a[132:135], a[52:55], v[144:147]
buffer_load_dwordx4 v15, s[8:11], s25 offen offset:3072 lds
v_mfma_f32_16x16x32_bf16 v[152:155], a[128:131], a[56:59], 0
s_add_u32 s25, s25, 128
v_mfma_f32_16x16x32_bf16 v[152:155], a[132:135], a[60:63], v[152:155]
s_waitcnt lgkmcnt(4)
v_mfma_f32_16x16x32_bf16 v[100:103], a[136:139], a[0:3], 0
s_waitcnt lgkmcnt(2)
ds_read_b64_tr_b16 a[128:129], v8 offset:0
v_mfma_f32_16x16x32_bf16 v[100:103], a[140:143], a[4:7], v[100:103]
buffer_load_dword v21, v20, s[16:19], s43 offen
v_mfma_f32_16x16x32_bf16 v[108:111], a[136:139], a[8:11], 0
s_add_u32 s43, s43, s47
ds_read_b64_tr_b16 a[130:131], v8 offset:2048
v_mfma_f32_16x16x32_bf16 v[108:111], a[140:143], a[12:15], v[108:111]
s_cmp_ge_u32 s43, s51
v_mfma_f32_16x16x32_bf16 v[116:119], a[136:139], a[16:19], 0
s_cselect_b32 s43, 0, s43
ds_read_b64_tr_b16 a[132:133], v8 offset:16384
v_mfma_f32_16x16x32_bf16 v[116:119], a[140:143], a[20:23], v[116:119]
s_cselect_b32 s51, s42, s51
v_mfma_f32_16x16x32_bf16 v[124:127], a[136:139], a[24:27], 0
s_cselect_b64 s[16:17], s[40:41], s[16:17]
ds_read_b64_tr_b16 a[134:135], v8 offset:18432
v_mfma_f32_16x16x32_bf16 v[124:127], a[140:143], a[28:31], v[124:127]
s_cselect_b32 s18, s42, s18
v_mfma_f32_16x16x32_bf16 v[132:135], a[136:139], a[32:35], 0
s_cselect_b64 s[40:41], s[44:45], s[40:41]
ds_read_b128 a[96:99], v2 offset:40960
v_mfma_f32_16x16x32_bf16 v[132:135], a[140:143], a[36:39], v[132:135]
s_cselect_b32 s42, s46, s42
v_mfma_f32_16x16x32_bf16 v[140:143], a[136:139], a[40:43], 0
s_cselect_b32 s46, 0, s46
v_mfma_f32_16x16x32_bf16 v[140:143], a[140:143], a[44:47], v[140:143]
buffer_load_dword v21, v20, s[16:19], s43 offen
v_mfma_f32_16x16x32_bf16 v[148:151], a[136:139], a[48:51], 0
s_add_u32 s43, s43, s47
ds_read_b128 a[100:103], v3 offset:40960
v_mfma_f32_16x16x32_bf16 v[148:151], a[140:143], a[52:55], v[148:151]
s_cmp_ge_u32 s43, s51
v_mfma_f32_16x16x32_bf16 v[156:159], a[136:139], a[56:59], 0
s_cselect_b32 s43, 0, s43
ds_read_b128 a[104:107], v2 offset:43008
v_mfma_f32_16x16x32_bf16 v[156:159], a[140:143], a[60:63], v[156:159]
s_waitcnt lgkmcnt(5)
s_cselect_b32 s51, s42, s51
v_mfma_f32_16x16x32_bf16 v[160:163], a[128:131], a[0:3], 0
s_waitcnt lgkmcnt(3)
s_cselect_b64 s[16:17], s[40:41], s[16:17]
ds_read_b64_tr_b16 a[136:137], v9 offset:0
v_mfma_f32_16x16x32_bf16 v[160:163], a[132:135], a[4:7], v[160:163]
s_cselect_b32 s18, s42, s18
v_mfma_f32_16x16x32_bf16 v[168:171], a[128:131], a[8:11], 0
s_cselect_b64 s[40:41], s[44:45], s[40:41]
ds_read_b64_tr_b16 a[138:139], v9 offset:2048
v_mfma_f32_16x16x32_bf16 v[168:171], a[132:135], a[12:15], v[168:171]
s_cselect_b32 s42, s46, s42
v_mfma_f32_16x16x32_bf16 v[176:179], a[128:131], a[16:19], 0
s_cselect_b32 s46, 0, s46
ds_read_b64_tr_b16 a[140:141], v9 offset:16384
v_mfma_f32_16x16x32_bf16 v[176:179], a[132:135], a[20:23], v[176:179]
v_mfma_f32_16x16x32_bf16 v[184:187], a[128:131], a[24:27], 0
ds_read_b64_tr_b16 a[142:143], v9 offset:18432
v_mfma_f32_16x16x32_bf16 v[184:187], a[132:135], a[28:31], v[184:187]
v_mfma_f32_16x16x32_bf16 v[192:195], a[128:131], a[32:35], 0
v_mfma_f32_16x16x32_bf16 v[192:195], a[132:135], a[36:39], v[192:195]
v_mfma_f32_16x16x32_bf16 v[200:203], a[128:131], a[40:43], 0
ds_read_b128 a[108:111], v3 offset:43008
v_mfma_f32_16x16x32_bf16 v[200:203], a[132:135], a[44:47], v[200:203]
v_mfma_f32_16x16x32_bf16 v[208:211], a[128:131], a[48:51], 0
ds_read_b128 a[112:115], v2 offset:45056
v_mfma_f32_16x16x32_bf16 v[208:211], a[132:135], a[52:55], v[208:211]
v_mfma_f32_16x16x32_bf16 v[216:219], a[128:131], a[56:59], 0
v_mfma_f32_16x16x32_bf16 v[216:219], a[132:135], a[60:63], v[216:219]
s_waitcnt lgkmcnt(4)
v_mfma_f32_16x16x32_bf16 v[164:167], a[136:139], a[0:3], 0
s_waitcnt lgkmcnt(2)
ds_read_b64_tr_b16 a[128:129], v10 offset:0
v_mfma_f32_16x16x32_bf16 v[164:167], a[140:143], a[4:7], v[164:167]
v_mfma_f32_16x16x32_bf16 v[172:175], a[136:139], a[8:11], 0
ds_read_b64_tr_b16 a[130:131], v10 offset:2048
v_mfma_f32_16x16x32_bf16 v[172:175], a[140:143], a[12:15], v[172:175]
v_mfma_f32_16x16x32_bf16 v[180:183], a[136:139], a[16:19], 0
ds_read_b64_tr_b16 a[132:133], v10 offset:16384
v_mfma_f32_16x16x32_bf16 v[180:183], a[140:143], a[20:23], v[180:183]
v_mfma_f32_16x16x32_bf16 v[188:191], a[136:139], a[24:27], 0
ds_read_b64_tr_b16 a[134:135], v10 offset:18432
v_mfma_f32_16x16x32_bf16 v[188:191], a[140:143], a[28:31], v[188:191]
v_mfma_f32_16x16x32_bf16 v[196:199], a[136:139], a[32:35], 0
ds_read_b128 a[116:119], v3 offset:45056
v_mfma_f32_16x16x32_bf16 v[196:199], a[140:143], a[36:39], v[196:199]
v_mfma_f32_16x16x32_bf16 v[204:207], a[136:139], a[40:43], 0
ds_read_b128 a[120:123], v2 offset:47104
v_mfma_f32_16x16x32_bf16 v[204:207], a[140:143], a[44:47], v[204:207]
v_mfma_f32_16x16x32_bf16 v[212:215], a[136:139], a[48:51], 0
v_mfma_f32_16x16x32_bf16 v[212:215], a[140:143], a[52:55], v[212:215]
v_mfma_f32_16x16x32_bf16 v[220:223], a[136:139], a[56:59], 0
ds_read_b128 a[124:127], v3 offset:47104
v_mfma_f32_16x16x32_bf16 v[220:223], a[140:143], a[60:63], v[220:223]
s_waitcnt lgkmcnt(5)
v_mfma_f32_16x16x32_bf16 a[192:195], a[128:131], a[0:3], 0
s_waitcnt lgkmcnt(3)
ds_read_b64_tr_b16 a[136:137], v11 offset:0
v_mfma_f32_16x16x32_bf16 a[192:195], a[132:135], a[4:7], a[192:195]
v_mfma_f32_16x16x32_bf16 a[200:203], a[128:131], a[8:11], 0
ds_read_b64_tr_b16 a[138:139], v11 offset:2048
v_mfma_f32_16x16x32_bf16 a[200:203], a[132:135], a[12:15], a[200:203]
v_mfma_f32_16x16x32_bf16 a[208:211], a[128:131], a[16:19], 0
ds_read_b64_tr_b16 a[140:141], v11 offset:16384
v_mfma_f32_16x16x32_bf16 a[208:211], a[132:135], a[20:23], a[208:211]
v_mfma_f32_16x16x32_bf16 a[216:219], a[128:131], a[24:27], 0
ds_read_b64_tr_b16 a[142:143], v11 offset:18432
v_mfma_f32_16x16x32_bf16 a[216:219], a[132:135], a[28:31], a[216:219]
v_mfma_f32_16x16x32_bf16 a[224:227], a[128:131], a[32:35], 0
v_mfma_f32_16x16x32_bf16 a[224:227], a[132:135], a[36:39], a[224:227]
v_mfma_f32_16x16x32_bf16 a[232:235], a[128:131], a[40:43], 0
v_mfma_f32_16x16x32_bf16 a[232:235], a[132:135], a[44:47], a[232:235]
v_mfma_f32_16x16x32_bf16 a[240:243], a[128:131], a[48:51], 0
v_mfma_f32_16x16x32_bf16 a[240:243], a[132:135], a[52:55], a[240:243]
v_mfma_f32_16x16x32_bf16 a[248:251], a[128:131], a[56:59], 0
v_mfma_f32_16x16x32_bf16 a[248:251], a[132:135], a[60:63], a[248:251]
s_waitcnt vmcnt(2) lgkmcnt(0)
s_barrier
v_mfma_f32_16x16x32_bf16 a[196:199], a[136:139], a[0:3], 0
s_add_u32 m0, s29, 65536
ds_read_b64_tr_b16 a[128:129], v4 offset:32768
v_mfma_f32_16x16x32_bf16 a[196:199], a[140:143], a[4:7], a[196:199]
buffer_load_dwordx4 v16, s[12:15], s26 offen offset:0 lds
v_mfma_f32_16x16x32_bf16 a[204:207], a[136:139], a[8:11], 0
ds_read_b64_tr_b16 a[130:131], v4 offset:34816
v_mfma_f32_16x16x32_bf16 a[204:207], a[140:143], a[12:15], a[204:207]
v_mfma_f32_16x16x32_bf16 a[212:215], a[136:139], a[16:19], 0
ds_read_b64_tr_b16 a[132:133], v4 offset:49152
v_mfma_f32_16x16x32_bf16 a[212:215], a[140:143], a[20:23], a[212:215]
buffer_load_dwordx4 v17, s[12:15], s26 offen offset:1024 lds
v_mfma_f32_16x16x32_bf16 a[220:223], a[136:139], a[24:27], 0
ds_read_b64_tr_b16 a[134:135], v4 offset:51200
v_mfma_f32_16x16x32_bf16 a[220:223], a[140:143], a[28:31], a[220:223]
v_mfma_f32_16x16x32_bf16 a[228:231], a[136:139], a[32:35], 0
v_mfma_f32_16x16x32_bf16 a[228:231], a[140:143], a[36:39], a[228:231]
buffer_load_dwordx4 v18, s[12:15], s26 offen offset:2048 lds
v_mfma_f32_16x16x32_bf16 a[236:239], a[136:139], a[40:43], 0
v_mfma_f32_16x16x32_bf16 a[236:239], a[140:143], a[44:47], a[236:239]
v_mfma_f32_16x16x32_bf16 a[244:247], a[136:139], a[48:51], 0
v_mfma_f32_16x16x32_bf16 a[244:247], a[140:143], a[52:55], a[244:247]
buffer_load_dwordx4 v19, s[12:15], s26 offen offset:3072 lds
v_mfma_f32_16x16x32_bf16 a[252:255], a[136:139], a[56:59], 0
s_add_u32 s26, s26, 524288
v_mfma_f32_16x16x32_bf16 a[252:255], a[140:143], a[60:63], a[252:255]
s_waitcnt lgkmcnt(2)
Lg_1:
v_mfma_f32_16x16x32_bf16 v[32:35], a[128:131], a[64:67], v[32:35]
s_waitcnt lgkmcnt(0)
s_add_u32 m0, s29, 81920
ds_read_b64_tr_b16 a[136:137], v5 offset:32768
v_mfma_f32_16x16x32_bf16 v[32:35], a[132:135], a[68:71], v[32:35]
buffer_load_dwordx4 v16, s[12:15], s27 offen offset:0 lds
v_mfma_f32_16x16x32_bf16 v[40:43], a[128:131], a[72:75], v[40:43]
ds_read_b64_tr_b16 a[138:139], v5 offset:34816
v_mfma_f32_16x16x32_bf16 v[40:43], a[132:135], a[76:79], v[40:43]
v_mfma_f32_16x16x32_bf16 v[48:51], a[128:131], a[80:83], v[48:51]
ds_read_b64_tr_b16 a[140:141], v5 offset:49152
v_mfma_f32_16x16x32_bf16 v[48:51], a[132:135], a[84:87], v[48:51]
buffer_load_dwordx4 v17, s[12:15], s27 offen offset:1024 lds
v_mfma_f32_16x16x32_bf16 v[56:59], a[128:131], a[88:91], v[56:59]
ds_read_b64_tr_b16 a[142:143], v5 offset:51200
v_mfma_f32_16x16x32_bf16 v[56:59], a[132:135], a[92:95], v[56:59]
v_mfma_f32_16x16x32_bf16 v[64:67], a[128:131], a[96:99], v[64:67]
ds_read_b128 a[0:3], v2 offset:0
v_mfma_f32_16x16x32_bf16 v[64:67], a[132:135], a[100:103], v[64:67]
buffer_load_dwordx4 v18, s[12:15], s27 offen offset:2048 lds
v_mfma_f32_16x16x32_bf16 v[72:75], a[128:131], a[104:107], v[72:75]
ds_read_b128 a[4:7], v3 offset:0
v_mfma_f32_16x16x32_bf16 v[72:75], a[132:135], a[108:111], v[72:75]
v_mfma_f32_16x16x32_bf16 v[80:83], a[128:131], a[112:115], v[80:83]
v_mfma_f32_16x16x32_bf16 v[80:83], a[132:135], a[116:119], v[80:83]
buffer_load_dwordx4 v19, s[12:15], s27 offen offset:3072 lds
v_mfma_f32_16x16x32_bf16 v[88:91], a[128:131], a[120:123], v[88:91]
s_add_u32 s27, s27, 524288
ds_read_b128 a[8:11], v2 offset:2048
v_mfma_f32_16x16x32_bf16 v[88:91], a[132:135], a[124:127], v[88:91]
s_waitcnt lgkmcnt(5)
v_mfma_f32_16x16x32_bf16 v[36:39], a[136:139], a[64:67], v[36:39]
s_waitcnt lgkmcnt(3)
s_add_u32 m0, s28, 32768
ds_read_b64_tr_b16 a[128:129], v6 offset:32768
v_mfma_f32_16x16x32_bf16 v[36:39], a[140:143], a[68:71], v[36:39]
buffer_load_dwordx4 v12, s[8:11], s24 offen offset:0 lds
v_mfma_f32_16x16x32_bf16 v[44:47], a[136:139], a[72:75], v[44:47]
ds_read_b64_tr_b16 a[130:131], v6 offset:34816
v_mfma_f32_16x16x32_bf16 v[44:47], a[140:143], a[76:79], v[44:47]
v_mfma_f32_16x16x32_bf16 v[52:55], a[136:139], a[80:83], v[52:55]
ds_read_b64_tr_b16 a[132:133], v6 offset:49152
v_mfma_f32_16x16x32_bf16 v[52:55], a[140:143], a[84:87], v[52:55]
buffer_load_dwordx4 v13, s[8:11], s24 offen offset:1024 lds
v_mfma_f32_16x16x32_bf16 v[60:63], a[136:139], a[88:91], v[60:63]
ds_read_b64_tr_b16 a[134:135], v6 offset:51200
v_mfma_f32_16x16x32_bf16 v[60:63], a[140:143], a[92:95], v[60:63]
v_mfma_f32_16x16x32_bf16 v[68:71], a[136:139], a[96:99], v[68:71]
ds_read_b128 a[12:15], v3 offset:2048
v_mfma_f32_16x16x32_bf16 v[68:71], a[140:143], a[100:103], v[68:71]
buffer_load_dwordx4 v14, s[8:11], s24 offen offset:2048 lds
v_mfma_f32_16x16x32_bf16 v[76:79], a[136:139], a[104:107], v[76:79]
v_mfma_f32_16x16x32_bf16 v[76:79], a[140:143], a[108:111], v[76:79]
v_mfma_f32_16x16x32_bf16 v[84:87], a[136:139], a[112:115], v[84:87]
ds_read_b128 a[16:19], v2 offset:4096
v_mfma_f32_16x16x32_bf16 v[84:87], a[140:143], a[116:119], v[84:87]
buffer_load_dwordx4 v15, s[8:11], s24 offen offset:3072 lds
v_mfma_f32_16x16x32_bf16 v[92:95], a[136:139], a[120:123], v[92:95]
s_add_u32 s24, s24, 128
ds_read_b128 a[20:23], v3 offset:4096
v_mfma_f32_16x16x32_bf16 v[92:95], a[140:143], a[124:127], v[92:95]
s_waitcnt lgkmcnt(5)
v_mfma_f32_16x16x32_bf16 v[96:99], a[128:131], a[64:67], v[96:99]
s_waitcnt lgkmcnt(3)
s_add_u32 m0, s28, 36864
ds_read_b64_tr_b16 a[136:137], v7 offset:32768
v_mfma_f32_16x16x32_bf16 v[96:99], a[132:135], a[68:71], v[96:99]
buffer_load_dwordx4 v12, s[8:11], s25 offen offset:0 lds
v_mfma_f32_16x16x32_bf16 v[104:107], a[128:131], a[72:75], v[104:107]
ds_read_b64_tr_b16 a[138:139], v7 offset:34816
v_mfma_f32_16x16x32_bf16 v[104:107], a[132:135], a[76:79], v[104:107]
v_mfma_f32_16x16x32_bf16 v[112:115], a[128:131], a[80:83], v[112:115]
ds_read_b64_tr_b16 a[140:141], v7 offset:49152
v_mfma_f32_16x16x32_bf16 v[112:115], a[132:135], a[84:87], v[112:115]
buffer_load_dwordx4 v13, s[8:11], s25 offen offset:1024 lds
v_mfma_f32_16x16x32_bf16 v[120:123], a[128:131], a[88:91], v[120:123]
ds_read_b64_tr_b16 a[142:143], v7 offset:51200
v_mfma_f32_16x16x32_bf16 v[120:123], a[132:135], a[92:95], v[120:123]
v_mfma_f32_16x16x32_bf16 v[128:131], a[128:131], a[96:99], v[128:131]
v_mfma_f32_16x16x32_bf16 v[128:131], a[132:135], a[100:103], v[128:131]
buffer_load_dwordx4 v14, s[8:11], s25 offen offset:2048 lds
v_mfma_f32_16x16x32_bf16 v[136:139], a[128:131], a[104:107], v[136:139]
ds_read_b128 a[24:27], v2 offset:6144
v_mfma_f32_16x16x32_bf16 v[136:139], a[132:135], a[108:111], v[136:139]
v_mfma_f32_16x16x32_bf16 v[144:147], a[128:131], a[112:115], v[144:147]
ds_read_b128 a[28:31], v3 offset:6144
v_mfma_f32_16x16x32_bf16 v[144:147], a[132:135], a[116:119], v[144:147]
buffer_load_dwordx4 v15, s[8:11], s25 offen offset:3072 lds
v_mfma_f32_16x16x32_bf16 v[152:155], a[128:131], a[120:123], v[152:155]
s_add_u32 s25, s25, 128
v_mfma_f32_16x16x32_bf16 v[152:155], a[132:135], a[124:127], v[152:155]
s_waitcnt lgkmcnt(4)
v_mfma_f32_16x16x32_bf16 v[100:103], a[136:139], a[64:67], v[100:103]
s_waitcnt lgkmcnt(2)
ds_read_b64_tr_b16 a[128:129], v8 offset:32768
v_mfma_f32_16x16x32_bf16 v[100:103], a[140:143], a[68:71], v[100:103]
buffer_load_dword v21, v20, s[16:19], s43 offen
v_mfma_f32_16x16x32_bf16 v[108:111], a[136:139], a[72:75], v[108:111]
s_add_u32 s43, s43, s47
ds_read_b64_tr_b16 a[130:131], v8 offset:34816
v_mfma_f32_16x16x32_bf16 v[108:111], a[140:143], a[76:79], v[108:111]
s_cmp_ge_u32 s43, s51
v_mfma_f32_16x16x32_bf16 v[116:119], a[136:139], a[80:83], v[116:119]
s_cselect_b32 s43, 0, s43
ds_read_b64_tr_b16 a[132:133], v8 offset:49152
v_mfma_f32_16x16x32_bf16 v[116:119], a[140:143], a[84:87], v[116:119]
s_cselect_b32 s51, s42, s51
v_mfma_f32_16x16x32_bf16 v[124:127], a[136:139], a[88:91], v[124:127]
s_cselect_b64 s[16:17], s[40:41], s[16:17]
ds_read_b64_tr_b16 a[134:135], v8 offset:51200
v_mfma_f32_16x16x32_bf16 v[124:127], a[140:143], a[92:95], v[124:127]
s_cselect_b32 s18, s42, s18
v_mfma_f32_16x16x32_bf16 v[132:135], a[136:139], a[96:99], v[132:135]
s_cselect_b64 s[40:41], s[44:45], s[40:41]
ds_read_b128 a[32:35], v2 offset:8192
v_mfma_f32_16x16x32_bf16 v[132:135], a[140:143], a[100:103], v[132:135]
s_cselect_b32 s42, s46, s42
v_mfma_f32_16x16x32_bf16 v[140:143], a[136:139], a[104:107], v[140:143]
s_cselect_b32 s46, 0, s46
v_mfma_f32_16x16x32_bf16 v[140:143], a[140:143], a[108:111], v[140:143]
s_cmp_eq_u32 s30, s55
v_mfma_f32_16x16x32_bf16 v[148:151], a[136:139], a[112:115], v[148:151]
s_cselect_b32 s22, 0, 3221225472
ds_read_b128 a[36:39], v3 offset:8192
v_mfma_f32_16x16x32_bf16 v[148:151], a[140:143], a[116:119], v[148:151]
s_sub_u32 s30, s30, 1
buffer_atomic_add v27, v26, s[60:63], s22 offen sc1
v_mfma_f32_16x16x32_bf16 v[156:159], a[136:139], a[120:123], v[156:159]
ds_read_b128 a[40:43], v2 offset:10240
v_mfma_f32_16x16x32_bf16 v[156:159], a[140:143], a[124:127], v[156:159]
s_waitcnt lgkmcnt(5)
v_mfma_f32_16x16x32_bf16 v[160:163], a[128:131], a[64:67], v[160:163]
s_waitcnt lgkmcnt(3)
ds_read_b64_tr_b16 a[136:137], v9 offset:32768
v_mfma_f32_16x16x32_bf16 v[160:163], a[132:135], a[68:71], v[160:163]
v_mfma_f32_16x16x32_bf16 v[168:171], a[128:131], a[72:75], v[168:171]
ds_read_b64_tr_b16 a[138:139], v9 offset:34816
v_mfma_f32_16x16x32_bf16 v[168:171], a[132:135], a[76:79], v[168:171]
v_mfma_f32_16x16x32_bf16 v[176:179], a[128:131], a[80:83], v[176:179]
ds_read_b64_tr_b16 a[140:141], v9 offset:49152
v_mfma_f32_16x16x32_bf16 v[176:179], a[132:135], a[84:87], v[176:179]
v_mfma_f32_16x16x32_bf16 v[184:187], a[128:131], a[88:91], v[184:187]
ds_read_b64_tr_b16 a[142:143], v9 offset:51200
v_mfma_f32_16x16x32_bf16 v[184:187], a[132:135], a[92:95], v[184:187]
v_mfma_f32_16x16x32_bf16 v[192:195], a[128:131], a[96:99], v[192:195]
v_mfma_f32_16x16x32_bf16 v[192:195], a[132:135], a[100:103], v[192:195]
v_mfma_f32_16x16x32_bf16 v[200:203], a[128:131], a[104:107], v[200:203]
ds_read_b128 a[44:47], v3 offset:10240
v_mfma_f32_16x16x32_bf16 v[200:203], a[132:135], a[108:111], v[200:203]
v_mfma_f32_16x16x32_bf16 v[208:211], a[128:131], a[112:115], v[208:211]
ds_read_b128 a[48:51], v2 offset:12288
v_mfma_f32_16x16x32_bf16 v[208:211], a[132:135], a[116:119], v[208:211]
v_mfma_f32_16x16x32_bf16 v[216:219], a[128:131], a[120:123], v[216:219]
v_mfma_f32_16x16x32_bf16 v[216:219], a[132:135], a[124:127], v[216:219]
s_waitcnt lgkmcnt(4)
v_mfma_f32_16x16x32_bf16 v[164:167], a[136:139], a[64:67], v[164:167]
s_waitcnt lgkmcnt(2)
ds_read_b64_tr_b16 a[128:129], v10 offset:32768
v_mfma_f32_16x16x32_bf16 v[164:167], a[140:143], a[68:71], v[164:167]
v_mfma_f32_16x16x32_bf16 v[172:175], a[136:139], a[72:75], v[172:175]
ds_read_b64_tr_b16 a[130:131], v10 offset:34816
v_mfma_f32_16x16x32_bf16 v[172:175], a[140:143], a[76:79], v[172:175]
v_mfma_f32_16x16x32_bf16 v[180:183], a[136:139], a[80:83], v[180:183]
ds_read_b64_tr_b16 a[132:133], v10 offset:49152
v_mfma_f32_16x16x32_bf16 v[180:183], a[140:143], a[84:87], v[180:183]
v_mfma_f32_16x16x32_bf16 v[188:191], a[136:139], a[88:91], v[188:191]
ds_read_b64_tr_b16 a[134:135], v10 offset:51200
v_mfma_f32_16x16x32_bf16 v[188:191], a[140:143], a[92:95], v[188:191]
v_mfma_f32_16x16x32_bf16 v[196:199], a[136:139], a[96:99], v[196:199]
ds_read_b128 a[52:55], v3 offset:12288
v_mfma_f32_16x16x32_bf16 v[196:199], a[140:143], a[100:103], v[196:199]
v_mfma_f32_16x16x32_bf16 v[204:207], a[136:139], a[104:107], v[204:207]
ds_read_b128 a[56:59], v2 offset:14336
v_mfma_f32_16x16x32_bf16 v[204:207], a[140:143], a[108:111], v[204:207]
v_mfma_f32_16x16x32_bf16 v[212:215], a[136:139], a[112:115], v[212:215]
v_mfma_f32_16x16x32_bf16 v[212:215], a[140:143], a[116:119], v[212:215]
v_mfma_f32_16x16x32_bf16 v[220:223], a[136:139], a[120:123], v[220:223]
ds_read_b128 a[60:63], v3 offset:14336
v_mfma_f32_16x16x32_bf16 v[220:223], a[140:143], a[124:127], v[220:223]
s_waitcnt lgkmcnt(5)
v_mfma_f32_16x16x32_bf16 a[192:195], a[128:131], a[64:67], a[192:195]
s_waitcnt lgkmcnt(3)
ds_read_b64_tr_b16 a[136:137], v11 offset:32768
v_mfma_f32_16x16x32_bf16 a[192:195], a[132:135], a[68:71], a[192:195]
v_mfma_f32_16x16x32_bf16 a[200:203], a[128:131], a[72:75], a[200:203]
ds_read_b64_tr_b16 a[138:139], v11 offset:34816
v_mfma_f32_16x16x32_bf16 a[200:203], a[132:135], a[76:79], a[200:203]
v_mfma_f32_16x16x32_bf16 a[208:211], a[128:131], a[80:83], a[208:211]
ds_read_b64_tr_b16 a[140:141], v11 offset:49152
v_mfma_f32_16x16x32_bf16 a[208:211], a[132:135], a[84:87], a[208:211]
v_mfma_f32_16x16x32_bf16 a[216:219], a[128:131], a[88:91], a[216:219]
ds_read_b64_tr_b16 a[142:143], v11 offset:51200
v_mfma_f32_16x16x32_bf16 a[216:219], a[132:135], a[92:95], a[216:219]
v_mfma_f32_16x16x32_bf16 a[224:227], a[128:131], a[96:99], a[224:227]
v_mfma_f32_16x16x32_bf16 a[224:227], a[132:135], a[100:103], a[224:227]
v_mfma_f32_16x16x32_bf16 a[232:235], a[128:131], a[104:107], a[232:235]
v_mfma_f32_16x16x32_bf16 a[232:235], a[132:135], a[108:111], a[232:235]
v_mfma_f32_16x16x32_bf16 a[240:243], a[128:131], a[112:115], a[240:243]
v_mfma_f32_16x16x32_bf16 a[240:243], a[132:135], a[116:119], a[240:243]
v_mfma_f32_16x16x32_bf16 a[248:251], a[128:131], a[120:123], a[248:251]
v_mfma_f32_16x16x32_bf16 a[248:251], a[132:135], a[124:127], a[248:251]
s_waitcnt vmcnt(2) lgkmcnt(0)
s_barrier
v_mfma_f32_16x16x32_bf16 a[196:199], a[136:139], a[64:67], a[196:199]
s_add_u32 m0, s29, 98304
ds_read_b64_tr_b16 a[128:129], v4 offset:0
v_mfma_f32_16x16x32_bf16 a[196:199], a[140:143], a[68:71], a[196:199]
buffer_load_dwordx4 v16, s[12:15], s26 offen offset:0 lds
v_mfma_f32_16x16x32_bf16 a[204:207], a[136:139], a[72:75], a[204:207]
ds_read_b64_tr_b16 a[130:131], v4 offset:2048
v_mfma_f32_16x16x32_bf16 a[204:207], a[140:143], a[76:79], a[204:207]
v_mfma_f32_16x16x32_bf16 a[212:215], a[136:139], a[80:83], a[212:215]
ds_read_b64_tr_b16 a[132:133], v4 offset:16384
v_mfma_f32_16x16x32_bf16 a[212:215], a[140:143], a[84:87], a[212:215]
buffer_load_dwordx4 v17, s[12:15], s26 offen offset:1024 lds
v_mfma_f32_16x16x32_bf16 a[220:223], a[136:139], a[88:91], a[220:223]
ds_read_b64_tr_b16 a[134:135], v4 offset:18432
v_mfma_f32_16x16x32_bf16 a[220:223], a[140:143], a[92:95], a[220:223]
v_mfma_f32_16x16x32_bf16 a[228:231], a[136:139], a[96:99], a[228:231]
v_mfma_f32_16x16x32_bf16 a[228:231], a[140:143], a[100:103], a[228:231]
buffer_load_dwordx4 v18, s[12:15], s26 offen offset:2048 lds
v_mfma_f32_16x16x32_bf16 a[236:239], a[136:139], a[104:107], a[236:239]
v_mfma_f32_16x16x32_bf16 a[236:239], a[140:143], a[108:111], a[236:239]
v_mfma_f32_16x16x32_bf16 a[244:247], a[136:139], a[112:115], a[244:247]
v_mfma_f32_16x16x32_bf16 a[244:247], a[140:143], a[116:119], a[244:247]
buffer_load_dwordx4 v19, s[12:15], s26 offen offset:3072 lds
v_mfma_f32_16x16x32_bf16 a[252:255], a[136:139], a[120:123], a[252:255]
s_add_u32 s26, s26, 524288
v_mfma_f32_16x16x32_bf16 a[252:255], a[140:143], a[124:127], a[252:255]
s_waitcnt lgkmcnt(2)
buffer_store_dword v27, v26, s[4:7], s82 offen sc1
v_mfma_f32_16x16x32_bf16 v[32:35], a[128:131], a[0:3], v[32:35]
s_waitcnt lgkmcnt(0)
s_add_u32 m0, s29, 114688
ds_read_b64_tr_b16 a[136:137], v5 offset:0
v_mfma_f32_16x16x32_bf16 v[32:35], a[132:135], a[4:7], v[32:35]
buffer_load_dwordx4 v16, s[12:15], s27 offen offset:0 lds
v_mfma_f32_16x16x32_bf16 v[40:43], a[128:131], a[8:11], v[40:43]
ds_read_b64_tr_b16 a[138:139], v5 offset:2048
v_mfma_f32_16x16x32_bf16 v[40:43], a[132:135], a[12:15], v[40:43]
v_mfma_f32_16x16x32_bf16 v[48:51], a[128:131], a[16:19], v[48:51]
ds_read_b64_tr_b16 a[140:141], v5 offset:16384
v_mfma_f32_16x16x32_bf16 v[48:51], a[132:135], a[20:23], v[48:51]
buffer_load_dwordx4 v17, s[12:15], s27 offen offset:1024 lds
v_mfma_f32_16x16x32_bf16 v[56:59], a[128:131], a[24:27], v[56:59]
ds_read_b64_tr_b16 a[142:143], v5 offset:18432
v_mfma_f32_16x16x32_bf16 v[56:59], a[132:135], a[28:31], v[56:59]
v_mfma_f32_16x16x32_bf16 v[64:67], a[128:131], a[32:35], v[64:67]
ds_read_b128 a[64:67], v2 offset:32768
v_mfma_f32_16x16x32_bf16 v[64:67], a[132:135], a[36:39], v[64:67]
buffer_load_dwordx4 v18, s[12:15], s27 offen offset:2048 lds
v_mfma_f32_16x16x32_bf16 v[72:75], a[128:131], a[40:43], v[72:75]
ds_read_b128 a[68:71], v3 offset:32768
v_mfma_f32_16x16x32_bf16 v[72:75], a[132:135], a[44:47], v[72:75]
v_mfma_f32_16x16x32_bf16 v[80:83], a[128:131], a[48:51], v[80:83]
v_mfma_f32_16x16x32_bf16 v[80:83], a[132:135], a[52:55], v[80:83]
buffer_load_dwordx4 v19, s[12:15], s27 offen offset:3072 lds
v_mfma_f32_16x16x32_bf16 v[88:91], a[128:131], a[56:59], v[88:91]
s_add_u32 s27, s27, 524288
ds_read_b128 a[72:75], v2 offset:34816
v_mfma_f32_16x16x32_bf16 v[88:91], a[132:135], a[60:63], v[88:91]
s_waitcnt lgkmcnt(5)
v_mfma_f32_16x16x32_bf16 v[36:39], a[136:139], a[0:3], v[36:39]
s_waitcnt lgkmcnt(3)
s_add_u32 m0, s28, 0
ds_read_b64_tr_b16 a[128:129], v6 offset:0
v_mfma_f32_16x16x32_bf16 v[36:39], a[140:143], a[4:7], v[36:39]
buffer_load_dwordx4 v12, s[8:11], s24 offen offset:0 lds
v_mfma_f32_16x16x32_bf16 v[44:47], a[136:139], a[8:11], v[44:47]
ds_read_b64_tr_b16 a[130:131], v6 offset:2048
v_mfma_f32_16x16x32_bf16 v[44:47], a[140:143], a[12:15], v[44:47]
v_mfma_f32_16x16x32_bf16 v[52:55], a[136:139], a[16:19], v[52:55]
ds_read_b64_tr_b16 a[132:133], v6 offset:16384
v_mfma_f32_16x16x32_bf16 v[52:55], a[140:143], a[20:23], v[52:55]
buffer_load_dwordx4 v13, s[8:11], s24 offen offset:1024 lds
v_mfma_f32_16x16x32_bf16 v[60:63], a[136:139], a[24:27], v[60:63]
ds_read_b64_tr_b16 a[134:135], v6 offset:18432
v_mfma_f32_16x16x32_bf16 v[60:63], a[140:143], a[28:31], v[60:63]
v_mfma_f32_16x16x32_bf16 v[68:71], a[136:139], a[32:35], v[68:71]
ds_read_b128 a[76:79], v3 offset:34816
v_mfma_f32_16x16x32_bf16 v[68:71], a[140:143], a[36:39], v[68:71]
buffer_load_dwordx4 v14, s[8:11], s24 offen offset:2048 lds
v_mfma_f32_16x16x32_bf16 v[76:79], a[136:139], a[40:43], v[76:79]
v_mfma_f32_16x16x32_bf16 v[76:79], a[140:143], a[44:47], v[76:79]
v_mfma_f32_16x16x32_bf16 v[84:87], a[136:139], a[48:51], v[84:87]
ds_read_b128 a[80:83], v2 offset:36864
v_mfma_f32_16x16x32_bf16 v[84:87], a[140:143], a[52:55], v[84:87]
buffer_load_dwordx4 v15, s[8:11], s24 offen offset:3072 lds
v_mfma_f32_16x16x32_bf16 v[92:95], a[136:139], a[56:59], v[92:95]
s_add_u32 s24, s24, 128
ds_read_b128 a[84:87], v3 offset:36864
v_mfma_f32_16x16x32_bf16 v[92:95], a[140:143], a[60:63], v[92:95]
s_waitcnt lgkmcnt(5)
v_mfma_f32_16x16x32_bf16 v[96:99], a[128:131], a[0:3], v[96:99]
s_waitcnt lgkmcnt(3)
s_add_u32 m0, s28, 4096
ds_read_b64_tr_b16 a[136:137], v7 offset:0
v_mfma_f32_16x16x32_bf16 v[96:99], a[132:135], a[4:7], v[96:99]
buffer_load_dwordx4 v12, s[8:11], s25 offen offset:0 lds
v_mfma_f32_16x16x32_bf16 v[104:107], a[128:131], a[8:11], v[104:107]
ds_read_b64_tr_b16 a[138:139], v7 offset:2048
v_mfma_f32_16x16x32_bf16 v[104:107], a[132:135], a[12:15], v[104:107]
v_mfma_f32_16x16x32_bf16 v[112:115], a[128:131], a[16:19], v[112:115]
ds_read_b64_tr_b16 a[140:141], v7 offset:16384
v_mfma_f32_16x16x32_bf16 v[112:115], a[132:135], a[20:23], v[112:115]
buffer_load_dwordx4 v13, s[8:11], s25 offen offset:1024 lds
v_mfma_f32_16x16x32_bf16 v[120:123], a[128:131], a[24:27], v[120:123]
ds_read_b64_tr_b16 a[142:143], v7 offset:18432
v_mfma_f32_16x16x32_bf16 v[120:123], a[132:135], a[28:31], v[120:123]
v_mfma_f32_16x16x32_bf16 v[128:131], a[128:131], a[32:35], v[128:131]
v_mfma_f32_16x16x32_bf16 v[128:131], a[132:135], a[36:39], v[128:131]
buffer_load_dwordx4 v14, s[8:11], s25 offen offset:2048 lds
v_mfma_f32_16x16x32_bf16 v[136:139], a[128:131], a[40:43], v[136:139]
ds_read_b128 a[88:91], v2 offset:38912
v_mfma_f32_16x16x32_bf16 v[136:139], a[132:135], a[44:47], v[136:139]
v_mfma_f32_16x16x32_bf16 v[144:147], a[128:131], a[48:51], v[144:147]
ds_read_b128 a[92:95], v3 offset:38912
v_mfma_f32_16x16x32_bf16 v[144:147], a[132:135], a[52:55], v[144:147]
buffer_load_dwordx4 v15, s[8:11], s25 offen offset:3072 lds
v_mfma_f32_16x16x32_bf16 v[152:155], a[128:131], a[56:59], v[152:155]
s_add_u32 s25, s25, 128
v_mfma_f32_16x16x32_bf16 v[152:155], a[132:135], a[60:63], v[152:155]
s_waitcnt lgkmcnt(4)
v_mfma_f32_16x16x32_bf16 v[100:103], a[136:139], a[0:3], v[100:103]
s_waitcnt lgkmcnt(2)
ds_read_b64_tr_b16 a[128:129], v8 offset:0
v_mfma_f32_16x16x32_bf16 v[100:103], a[140:143], a[4:7], v[100:103]
buffer_load_dword v21, v20, s[16:19], s43 offen
v_mfma_f32_16x16x32_bf16 v[108:111], a[136:139], a[8:11], v[108:111]
s_add_u32 s43, s43, s47
ds_read_b64_tr_b16 a[130:131], v8 offset:2048
v_mfma_f32_16x16x32_bf16 v[108:111], a[140:143], a[12:15], v[108:111]
s_cmp_ge_u32 s43, s51
v_mfma_f32_16x16x32_bf16 v[116:119], a[136:139], a[16:19], v[116:119]
s_cselect_b32 s43, 0, s43
ds_read_b64_tr_b16 a[132:133], v8 offset:16384
v_mfma_f32_16x16x32_bf16 v[116:119], a[140:143], a[20:23], v[116:119]
s_cselect_b32 s51, s42, s51
v_mfma_f32_16x16x32_bf16 v[124:127], a[136:139], a[24:27], v[124:127]
s_cselect_b64 s[16:17], s[40:41], s[16:17]
ds_read_b64_tr_b16 a[134:135], v8 offset:18432
v_mfma_f32_16x16x32_bf16 v[124:127], a[140:143], a[28:31], v[124:127]
s_cselect_b32 s18, s42, s18
v_mfma_f32_16x16x32_bf16 v[132:135], a[136:139], a[32:35], v[132:135]
s_cselect_b64 s[40:41], s[44:45], s[40:41]
ds_read_b128 a[96:99], v2 offset:40960
v_mfma_f32_16x16x32_bf16 v[132:135], a[140:143], a[36:39], v[132:135]
s_cselect_b32 s42, s46, s42
v_mfma_f32_16x16x32_bf16 v[140:143], a[136:139], a[40:43], v[140:143]
s_cselect_b32 s46, 0, s46
v_mfma_f32_16x16x32_bf16 v[140:143], a[140:143], a[44:47], v[140:143]
s_cmp_eq_u32 s30, s55
v_mfma_f32_16x16x32_bf16 v[148:151], a[136:139], a[48:51], v[148:151]
s_cselect_b32 s22, 0, 3221225472
ds_read_b128 a[100:103], v3 offset:40960
v_mfma_f32_16x16x32_bf16 v[148:151], a[140:143], a[52:55], v[148:151]
s_sub_u32 s30, s30, 1
buffer_atomic_add v27, v26, s[60:63], s22 offen sc1
v_mfma_f32_16x16x32_bf16 v[156:159], a[136:139], a[56:59], v[156:159]
ds_read_b128 a[104:107], v2 offset:43008
v_mfma_f32_16x16x32_bf16 v[156:159], a[140:143], a[60:63], v[156:159]
s_waitcnt lgkmcnt(5)
v_mfma_f32_16x16x32_bf16 v[160:163], a[128:131], a[0:3], v[160:163]
s_waitcnt lgkmcnt(3)
ds_read_b64_tr_b16 a[136:137], v9 offset:0
v_mfma_f32_16x16x32_bf16 v[160:163], a[132:135], a[4:7], v[160:163]
v_mfma_f32_16x16x32_bf16 v[168:171], a[128:131], a[8:11], v[168:171]
ds_read_b64_tr_b16 a[138:139], v9 offset:2048
v_mfma_f32_16x16x32_bf16 v[168:171], a[132:135], a[12:15], v[168:171]
v_mfma_f32_16x16x32_bf16 v[176:179], a[128:131], a[16:19], v[176:179]
ds_read_b64_tr_b16 a[140:141], v9 offset:16384
v_mfma_f32_16x16x32_bf16 v[176:179], a[132:135], a[20:23], v[176:179]
v_mfma_f32_16x16x32_bf16 v[184:187], a[128:131], a[24:27], v[184:187]
ds_read_b64_tr_b16 a[142:143], v9 offset:18432
v_mfma_f32_16x16x32_bf16 v[184:187], a[132:135], a[28:31], v[184:187]
v_mfma_f32_16x16x32_bf16 v[192:195], a[128:131], a[32:35], v[192:195]
v_mfma_f32_16x16x32_bf16 v[192:195], a[132:135], a[36:39], v[192:195]
v_mfma_f32_16x16x32_bf16 v[200:203], a[128:131], a[40:43], v[200:203]
ds_read_b128 a[108:111], v3 offset:43008
v_mfma_f32_16x16x32_bf16 v[200:203], a[132:135], a[44:47], v[200:203]
v_mfma_f32_16x16x32_bf16 v[208:211], a[128:131], a[48:51], v[208:211]
ds_read_b128 a[112:115], v2 offset:45056
v_mfma_f32_16x16x32_bf16 v[208:211], a[132:135], a[52:55], v[208:211]
v_mfma_f32_16x16x32_bf16 v[216:219], a[128:131], a[56:59], v[216:219]
v_mfma_f32_16x16x32_bf16 v[216:219], a[132:135], a[60:63], v[216:219]
s_waitcnt lgkmcnt(4)
v_mfma_f32_16x16x32_bf16 v[164:167], a[136:139], a[0:3], v[164:167]
s_waitcnt lgkmcnt(2)
ds_read_b64_tr_b16 a[128:129], v10 offset:0
v_mfma_f32_16x16x32_bf16 v[164:167], a[140:143], a[4:7], v[164:167]
v_mfma_f32_16x16x32_bf16 v[172:175], a[136:139], a[8:11], v[172:175]
ds_read_b64_tr_b16 a[130:131], v10 offset:2048
v_mfma_f32_16x16x32_bf16 v[172:175], a[140:143], a[12:15], v[172:175]
v_mfma_f32_16x16x32_bf16 v[180:183], a[136:139], a[16:19], v[180:183]
ds_read_b64_tr_b16 a[132:133], v10 offset:16384
v_mfma_f32_16x16x32_bf16 v[180:183], a[140:143], a[20:23], v[180:183]
v_mfma_f32_16x16x32_bf16 v[188:191], a[136:139], a[24:27], v[188:191]
ds_read_b64_tr_b16 a[134:135], v10 offset:18432
v_mfma_f32_16x16x32_bf16 v[188:191], a[140:143], a[28:31], v[188:191]
v_mfma_f32_16x16x32_bf16 v[196:199], a[136:139], a[32:35], v[196:199]
ds_read_b128 a[116:119], v3 offset:45056
v_mfma_f32_16x16x32_bf16 v[196:199], a[140:143], a[36:39], v[196:199]
v_mfma_f32_16x16x32_bf16 v[204:207], a[136:139], a[40:43], v[204:207]
ds_read_b128 a[120:123], v2 offset:47104
v_mfma_f32_16x16x32_bf16 v[204:207], a[140:143], a[44:47], v[204:207]
v_mfma_f32_16x16x32_bf16 v[212:215], a[136:139], a[48:51], v[212:215]
v_mfma_f32_16x16x32_bf16 v[212:215], a[140:143], a[52:55], v[212:215]
v_mfma_f32_16x16x32_bf16 v[220:223], a[136:139], a[56:59], v[220:223]
ds_read_b128 a[124:127], v3 offset:47104
v_mfma_f32_16x16x32_bf16 v[220:223], a[140:143], a[60:63], v[220:223]
s_waitcnt lgkmcnt(5)
v_mfma_f32_16x16x32_bf16 a[192:195], a[128:131], a[0:3], a[192:195]
s_waitcnt lgkmcnt(3)
ds_read_b64_tr_b16 a[136:137], v11 offset:0
v_mfma_f32_16x16x32_bf16 a[192:195], a[132:135], a[4:7], a[192:195]
v_mfma_f32_16x16x32_bf16 a[200:203], a[128:131], a[8:11], a[200:203]
ds_read_b64_tr_b16 a[138:139], v11 offset:2048
v_mfma_f32_16x16x32_bf16 a[200:203], a[132:135], a[12:15], a[200:203]
v_mfma_f32_16x16x32_bf16 a[208:211], a[128:131], a[16:19], a[208:211]
ds_read_b64_tr_b16 a[140:141], v11 offset:16384
v_mfma_f32_16x16x32_bf16 a[208:211], a[132:135], a[20:23], a[208:211]
v_mfma_f32_16x16x32_bf16 a[216:219], a[128:131], a[24:27], a[216:219]
ds_read_b64_tr_b16 a[142:143], v11 offset:18432
v_mfma_f32_16x16x32_bf16 a[216:219], a[132:135], a[28:31], a[216:219]
v_mfma_f32_16x16x32_bf16 a[224:227], a[128:131], a[32:35], a[224:227]
v_mfma_f32_16x16x32_bf16 a[224:227], a[132:135], a[36:39], a[224:227]
v_mfma_f32_16x16x32_bf16 a[232:235], a[128:131], a[40:43], a[232:235]
v_mfma_f32_16x16x32_bf16 a[232:235], a[132:135], a[44:47], a[232:235]
v_mfma_f32_16x16x32_bf16 a[240:243], a[128:131], a[48:51], a[240:243]
v_mfma_f32_16x16x32_bf16 a[240:243], a[132:135], a[52:55], a[240:243]
v_mfma_f32_16x16x32_bf16 a[248:251], a[128:131], a[56:59], a[248:251]
v_mfma_f32_16x16x32_bf16 a[248:251], a[132:135], a[60:63], a[248:251]
s_waitcnt vmcnt(2) lgkmcnt(0)
s_barrier
v_mfma_f32_16x16x32_bf16 a[196:199], a[136:139], a[0:3], a[196:199]
s_add_u32 m0, s29, 65536
ds_read_b64_tr_b16 a[128:129], v4 offset:32768
v_mfma_f32_16x16x32_bf16 a[196:199], a[140:143], a[4:7], a[196:199]
buffer_load_dwordx4 v16, s[12:15], s26 offen offset:0 lds
v_mfma_f32_16x16x32_bf16 a[204:207], a[136:139], a[8:11], a[204:207]
ds_read_b64_tr_b16 a[130:131], v4 offset:34816
v_mfma_f32_16x16x32_bf16 a[204:207], a[140:143], a[12:15], a[204:207]
v_mfma_f32_16x16x32_bf16 a[212:215], a[136:139], a[16:19], a[212:215]
ds_read_b64_tr_b16 a[132:133], v4 offset:49152
v_mfma_f32_16x16x32_bf16 a[212:215], a[140:143], a[20:23], a[212:215]
buffer_load_dwordx4 v17, s[12:15], s26 offen offset:1024 lds
v_mfma_f32_16x16x32_bf16 a[220:223], a[136:139], a[24:27], a[220:223]
ds_read_b64_tr_b16 a[134:135], v4 offset:51200
v_mfma_f32_16x16x32_bf16 a[220:223], a[140:143], a[28:31], a[220:223]
v_mfma_f32_16x16x32_bf16 a[228:231], a[136:139], a[32:35], a[228:231]
v_mfma_f32_16x16x32_bf16 a[228:231], a[140:143], a[36:39], a[228:231]
buffer_load_dwordx4 v18, s[12:15], s26 offen offset:2048 lds
v_mfma_f32_16x16x32_bf16 a[236:239], a[136:139], a[40:43], a[236:239]
v_mfma_f32_16x16x32_bf16 a[236:239], a[140:143], a[44:47], a[236:239]
v_mfma_f32_16x16x32_bf16 a[244:247], a[136:139], a[48:51], a[244:247]
v_mfma_f32_16x16x32_bf16 a[244:247], a[140:143], a[52:55], a[244:247]
buffer_load_dwordx4 v19, s[12:15], s26 offen offset:3072 lds
v_mfma_f32_16x16x32_bf16 a[252:255], a[136:139], a[56:59], a[252:255]
s_add_u32 s26, s26, 524288
v_mfma_f32_16x16x32_bf16 a[252:255], a[140:143], a[60:63], a[252:255]
s_waitcnt lgkmcnt(2)
s_bitcmp1_b32 s30, 1
s_cbranch_scc1 Lg_1
s_cmp_eq_u32 s30, 0
s_cbranch_scc1 Lg_1t
v_mfma_f32_16x16x32_bf16 v[32:35], a[128:131], a[64:67], v[32:35]
s_waitcnt lgkmcnt(0)
s_add_u32 m0, s29, 81920
ds_read_b64_tr_b16 a[136:137], v5 offset:32768
v_mfma_f32_16x16x32_bf16 v[32:35], a[132:135], a[68:71], v[32:35]
buffer_load_dwordx4 v16, s[12:15], s27 offen offset:0 lds
v_mfma_f32_16x16x32_bf16 v[40:43], a[128:131], a[72:75], v[40:43]
s_lshl_b32 s22, s38, 3
ds_read_b64_tr_b16 a[138:139], v5 offset:34816
v_mfma_f32_16x16x32_bf16 v[40:43], a[132:135], a[76:79], v[40:43]
s_lshl_b32 s23, s39, 5
v_and_b32 v252, 31, v0
v_lshrrev_b32 v253, 5, v0
v_mfma_f32_16x16x32_bf16 v[48:51], a[128:131], a[80:83], v[48:51]
ds_read_b64_tr_b16 a[140:141], v5 offset:49152
v_add_u32 v253, s22, v253
v_mfma_f32_16x16x32_bf16 v[48:51], a[132:135], a[84:87], v[48:51]
buffer_load_dwordx4 v17, s[12:15], s27 offen offset:1024 lds
v_mfma_f32_16x16x32_bf16 v[56:59], a[128:131], a[88:91], v[56:59]
ds_read_b64_tr_b16 a[142:143], v5 offset:51200
v_add_u32 v252, s23, v252
v_mfma_f32_16x16x32_bf16 v[56:59], a[132:135], a[92:95], v[56:59]
v_mul_u32_u24 v254, 7168, v253
v_lshl_add_u32 v254, v252, 2, v254
v_mfma_f32_16x16x32_bf16 v[64:67], a[128:131], a[96:99], v[64:67]
ds_read_b128 a[0:3], v2 offset:0
v_lshlrev_b32 v252, 4, v252
v_mfma_f32_16x16x32_bf16 v[64:67], a[132:135], a[100:103], v[64:67]
buffer_load_dwordx4 v18, s[12:15], s27 offen offset:2048 lds
v_mfma_f32_16x16x32_bf16 v[72:75], a[128:131], a[104:107], v[72:75]
ds_read_b128 a[4:7], v3 offset:0
v_add_u32 v255, 3584, v254
v_mfma_f32_16x16x32_bf16 v[72:75], a[132:135], a[108:111], v[72:75]
v_subrev_u32 v22, 3584, v254
v_subrev_u32 v23, 2688, v254
v_mfma_f32_16x16x32_bf16 v[80:83], a[128:131], a[112:115], v[80:83]
v_subrev_u32 v24, 1792, v254
v_subrev_u32 v25, 896, v254
v_mfma_f32_16x16x32_bf16 v[80:83], a[132:135], a[116:119], v[80:83]
buffer_load_dwordx4 v19, s[12:15], s27 offen offset:3072 lds
v_mfma_f32_16x16x32_bf16 v[88:91], a[128:131], a[120:123], v[88:91]
s_add_u32 s27, s27, 524288
ds_read_b128 a[8:11], v2 offset:2048
v_mfma_f32_16x16x32_bf16 v[88:91], a[132:135], a[124:127], v[88:91]
s_waitcnt lgkmcnt(5)
v_mfma_f32_16x16x32_bf16 v[36:39], a[136:139], a[64:67], v[36:39]
s_waitcnt lgkmcnt(3)
s_add_u32 m0, s28, 32768
ds_read_b64_tr_b16 a[128:129], v6 offset:32768
v_mfma_f32_16x16x32_bf16 v[36:39], a[140:143], a[68:71], v[36:39]
buffer_load_dwordx4 v12, s[8:11], s24 offen offset:0 lds
v_mfma_f32_16x16x32_bf16 v[44:47], a[136:139], a[72:75], v[44:47]
ds_read_b64_tr_b16 a[130:131], v6 offset:34816
v_mfma_f32_16x16x32_bf16 v[44:47], a[140:143], a[76:79], v[44:47]
v_mfma_f32_16x16x32_bf16 v[52:55], a[136:139], a[80:83], v[52:55]
ds_read_b64_tr_b16 a[132:133], v6 offset:49152
v_mfma_f32_16x16x32_bf16 v[52:55], a[140:143], a[84:87], v[52:55]
buffer_load_dwordx4 v13, s[8:11], s24 offen offset:1024 lds
v_mfma_f32_16x16x32_bf16 v[60:63], a[136:139], a[88:91], v[60:63]
ds_read_b64_tr_b16 a[134:135], v6 offset:51200
v_mfma_f32_16x16x32_bf16 v[60:63], a[140:143], a[92:95], v[60:63]
v_mfma_f32_16x16x32_bf16 v[68:71], a[136:139], a[96:99], v[68:71]
ds_read_b128 a[12:15], v3 offset:2048
v_mfma_f32_16x16x32_bf16 v[68:71], a[140:143], a[100:103], v[68:71]
buffer_load_dwordx4 v14, s[8:11], s24 offen offset:2048 lds
v_mfma_f32_16x16x32_bf16 v[76:79], a[136:139], a[104:107], v[76:79]
v_mfma_f32_16x16x32_bf16 v[76:79], a[140:143], a[108:111], v[76:79]
v_mfma_f32_16x16x32_bf16 v[84:87], a[136:139], a[112:115], v[84:87]
ds_read_b128 a[16:19], v2 offset:4096
v_mfma_f32_16x16x32_bf16 v[84:87], a[140:143], a[116:119], v[84:87]
buffer_load_dwordx4 v15, s[8:11], s24 offen offset:3072 lds
v_mfma_f32_16x16x32_bf16 v[92:95], a[136:139], a[120:123], v[92:95]
s_add_u32 s24, s24, 128
ds_read_b128 a[20:23], v3 offset:4096
v_mfma_f32_16x16x32_bf16 v[92:95], a[140:143], a[124:127], v[92:95]
s_waitcnt lgkmcnt(5)
v_mfma_f32_16x16x32_bf16 v[96:99], a[128:131], a[64:67], v[96:99]
s_waitcnt lgkmcnt(3)
s_add_u32 m0, s28, 36864
ds_read_b64_tr_b16 a[136:137], v7 offset:32768
v_mfma_f32_16x16x32_bf16 v[96:99], a[132:135], a[68:71], v[96:99]
buffer_load_dwordx4 v12, s[8:11], s25 offen offset:0 lds
v_mfma_f32_16x16x32_bf16 v[104:107], a[128:131], a[72:75], v[104:107]
ds_read_b64_tr_b16 a[138:139], v7 offset:34816
v_mfma_f32_16x16x32_bf16 v[104:107], a[132:135], a[76:79], v[104:107]
v_mfma_f32_16x16x32_bf16 v[112:115], a[128:131], a[80:83], v[112:115]
ds_read_b64_tr_b16 a[140:141], v7 offset:49152
v_mfma_f32_16x16x32_bf16 v[112:115], a[132:135], a[84:87], v[112:115]
buffer_load_dwordx4 v13, s[8:11], s25 offen offset:1024 lds
v_mfma_f32_16x16x32_bf16 v[120:123], a[128:131], a[88:91], v[120:123]
ds_read_b64_tr_b16 a[142:143], v7 offset:51200
v_mfma_f32_16x16x32_bf16 v[120:123], a[132:135], a[92:95], v[120:123]
v_mfma_f32_16x16x32_bf16 v[128:131], a[128:131], a[96:99], v[128:131]
v_mfma_f32_16x16x32_bf16 v[128:131], a[132:135], a[100:103], v[128:131]
buffer_load_dwordx4 v14, s[8:11], s25 offen offset:2048 lds
v_mfma_f32_16x16x32_bf16 v[136:139], a[128:131], a[104:107], v[136:139]
ds_read_b128 a[24:27], v2 offset:6144
v_mfma_f32_16x16x32_bf16 v[136:139], a[132:135], a[108:111], v[136:139]
v_mfma_f32_16x16x32_bf16 v[144:147], a[128:131], a[112:115], v[144:147]
ds_read_b128 a[28:31], v3 offset:6144
v_mfma_f32_16x16x32_bf16 v[144:147], a[132:135], a[116:119], v[144:147]
buffer_load_dwordx4 v15, s[8:11], s25 offen offset:3072 lds
v_mfma_f32_16x16x32_bf16 v[152:155], a[128:131], a[120:123], v[152:155]
s_add_u32 s25, s25, 128
v_mfma_f32_16x16x32_bf16 v[152:155], a[132:135], a[124:127], v[152:155]
s_waitcnt lgkmcnt(2)
v_mfma_f32_16x16x32_bf16 v[100:103], a[136:139], a[64:67], v[100:103]
s_mov_b64 s[56:57], s[70:71]
s_mov_b32 s58, 3584
s_mov_b32 s59, 0x20000
ds_read_b64_tr_b16 a[128:129], v8 offset:32768
buffer_load_dwordx4 v[248:251], v252, s[56:59], 0 offen
v_mfma_f32_16x16x32_bf16 v[100:103], a[140:143], a[68:71], v[100:103]
s_mov_b64 s[56:57], s[66:67]
s_mov_b32 s58, 1835008
buffer_load_dword v224, v22, s[56:59], 0 offen nt
v_mfma_f32_16x16x32_bf16 v[108:111], a[136:139], a[72:75], v[108:111]
ds_read_b64_tr_b16 a[130:131], v8 offset:34816
buffer_load_dword v225, v23, s[56:59], 0 offen nt
v_mfma_f32_16x16x32_bf16 v[108:111], a[140:143], a[76:79], v[108:111]
buffer_load_dword v226, v24, s[56:59], 0 offen nt
v_mfma_f32_16x16x32_bf16 v[116:119], a[136:139], a[80:83], v[116:119]
ds_read_b64_tr_b16 a[132:133], v8 offset:49152
buffer_load_dword v227, v25, s[56:59], 0 offen nt
v_mfma_f32_16x16x32_bf16 v[116:119], a[140:143], a[84:87], v[116:119]
buffer_load_dword v228, v254, s[56:59], 0 offen offset:0 nt
v_mfma_f32_16x16x32_bf16 v[124:127], a[136:139], a[88:91], v[124:127]
ds_read_b64_tr_b16 a[134:135], v8 offset:51200
buffer_load_dword v229, v254, s[56:59], 0 offen offset:896 nt
v_mfma_f32_16x16x32_bf16 v[124:127], a[140:143], a[92:95], v[124:127]
buffer_load_dword v230, v254, s[56:59], 0 offen offset:1792 nt
v_mfma_f32_16x16x32_bf16 v[132:135], a[136:139], a[96:99], v[132:135]
ds_read_b128 a[32:35], v2 offset:8192
buffer_load_dword v231, v254, s[56:59], 0 offen offset:2688 nt
v_mfma_f32_16x16x32_bf16 v[132:135], a[140:143], a[100:103], v[132:135]
buffer_load_dword v232, v255, s[56:59], 0 offen offset:0 nt
v_mfma_f32_16x16x32_bf16 v[140:143], a[136:139], a[104:107], v[140:143]
buffer_load_dword v233, v255, s[56:59], 0 offen offset:896 nt
v_mfma_f32_16x16x32_bf16 v[140:143], a[140:143], a[108:111], v[140:143]
buffer_load_dword v234, v255, s[56:59], 0 offen offset:1792 nt
v_mfma_f32_16x16x32_bf16 v[148:151], a[136:139], a[112:115], v[148:151]
ds_read_b128 a[36:39], v3 offset:8192
buffer_load_dword v235, v255, s[56:59], 0 offen offset:2688 nt
v_mfma_f32_16x16x32_bf16 v[148:151], a[140:143], a[116:119], v[148:151]
s_mov_b64 s[56:57], s[68:69]
buffer_load_dword v236, v25, s[56:59], 0 offen nt
v_mfma_f32_16x16x32_bf16 v[156:159], a[136:139], a[120:123], v[156:159]
ds_read_b128 a[40:43], v2 offset:10240
buffer_load_dword v237, v254, s[56:59], 0 offen offset:0 nt
v_mfma_f32_16x16x32_bf16 v[156:159], a[140:143], a[124:127], v[156:159]
s_waitcnt lgkmcnt(5)
buffer_load_dword v238, v254, s[56:59], 0 offen offset:896 nt
v_mfma_f32_16x16x32_bf16 v[160:163], a[128:131], a[64:67], v[160:163]
s_waitcnt lgkmcnt(3)
ds_read_b64_tr_b16 a[136:137], v9 offset:32768
buffer_load_dword v239, v254, s[56:59], 0 offen offset:1792 nt
v_mfma_f32_16x16x32_bf16 v[160:163], a[132:135], a[68:71], v[160:163]
buffer_load_dword v240, v254, s[56:59], 0 offen offset:2688 nt
v_mfma_f32_16x16x32_bf16 v[168:171], a[128:131], a[72:75], v[168:171]
ds_read_b64_tr_b16 a[138:139], v9 offset:34816
buffer_load_dword v241, v255, s[56:59], 0 offen offset:0 nt
v_mfma_f32_16x16x32_bf16 v[168:171], a[132:135], a[76:79], v[168:171]
buffer_load_dword v242, v255, s[56:59], 0 offen offset:896 nt
v_mfma_f32_16x16x32_bf16 v[176:179], a[128:131], a[80:83], v[176:179]
ds_read_b64_tr_b16 a[140:141], v9 offset:49152
buffer_load_dword v243, v255, s[56:59], 0 offen offset:1792 nt
v_mfma_f32_16x16x32_bf16 v[176:179], a[132:135], a[84:87], v[176:179]
buffer_load_dword v244, v255, s[56:59], 0 offen offset:2688 nt
v_mfma_f32_16x16x32_bf16 v[184:187], a[128:131], a[88:91], v[184:187]
ds_read_b64_tr_b16 a[142:143], v9 offset:51200
v_mfma_f32_16x16x32_bf16 v[184:187], a[132:135], a[92:95], v[184:187]
v_mfma_f32_16x16x32_bf16 v[192:195], a[128:131], a[96:99], v[192:195]
v_mfma_f32_16x16x32_bf16 v[192:195], a[132:135], a[100:103], v[192:195]
v_mfma_f32_16x16x32_bf16 v[200:203], a[128:131], a[104:107], v[200:203]
ds_read_b128 a[44:47], v3 offset:10240
v_mfma_f32_16x16x32_bf16 v[200:203], a[132:135], a[108:111], v[200:203]
v_mfma_f32_16x16x32_bf16 v[208:211], a[128:131], a[112:115], v[208:211]
ds_read_b128 a[48:51], v2 offset:12288
v_mfma_f32_16x16x32_bf16 v[208:211], a[132:135], a[116:119], v[208:211]
v_mfma_f32_16x16x32_bf16 v[216:219], a[128:131], a[120:123], v[216:219]
v_mfma_f32_16x16x32_bf16 v[216:219], a[132:135], a[124:127], v[216:219]
s_waitcnt lgkmcnt(4)
v_mfma_f32_16x16x32_bf16 v[164:167], a[136:139], a[64:67], v[164:167]
s_waitcnt lgkmcnt(2)
ds_read_b64_tr_b16 a[128:129], v10 offset:32768
v_mfma_f32_16x16x32_bf16 v[164:167], a[140:143], a[68:71], v[164:167]
v_mfma_f32_16x16x32_bf16 v[172:175], a[136:139], a[72:75], v[172:175]
ds_read_b64_tr_b16 a[130:131], v10 offset:34816
v_mfma_f32_16x16x32_bf16 v[172:175], a[140:143], a[76:79], v[172:175]
v_mfma_f32_16x16x32_bf16 v[180:183], a[136:139], a[80:83], v[180:183]
ds_read_b64_tr_b16 a[132:133], v10 offset:49152
v_mfma_f32_16x16x32_bf16 v[180:183], a[140:143], a[84:87], v[180:183]
v_mfma_f32_16x16x32_bf16 v[188:191], a[136:139], a[88:91], v[188:191]
ds_read_b64_tr_b16 a[134:135], v10 offset:51200
v_mfma_f32_16x16x32_bf16 v[188:191], a[140:143], a[92:95], v[188:191]
v_mfma_f32_16x16x32_bf16 v[196:199], a[136:139], a[96:99], v[196:199]
ds_read_b128 a[52:55], v3 offset:12288
v_mfma_f32_16x16x32_bf16 v[196:199], a[140:143], a[100:103], v[196:199]
v_mfma_f32_16x16x32_bf16 v[204:207], a[136:139], a[104:107], v[204:207]
ds_read_b128 a[56:59], v2 offset:14336
v_mfma_f32_16x16x32_bf16 v[204:207], a[140:143], a[108:111], v[204:207]
v_mfma_f32_16x16x32_bf16 v[212:215], a[136:139], a[112:115], v[212:215]
v_mfma_f32_16x16x32_bf16 v[212:215], a[140:143], a[116:119], v[212:215]
v_mfma_f32_16x16x32_bf16 v[220:223], a[136:139], a[120:123], v[220:223]
ds_read_b128 a[60:63], v3 offset:14336
v_mfma_f32_16x16x32_bf16 v[220:223], a[140:143], a[124:127], v[220:223]
s_waitcnt lgkmcnt(5)
v_mfma_f32_16x16x32_bf16 a[192:195], a[128:131], a[64:67], a[192:195]
s_waitcnt lgkmcnt(3)
ds_read_b64_tr_b16 a[136:137], v11 offset:32768
v_mfma_f32_16x16x32_bf16 a[192:195], a[132:135], a[68:71], a[192:195]
v_mfma_f32_16x16x32_bf16 a[200:203], a[128:131], a[72:75], a[200:203]
ds_read_b64_tr_b16 a[138:139], v11 offset:34816
v_mfma_f32_16x16x32_bf16 a[200:203], a[132:135], a[76:79], a[200:203]
v_mfma_f32_16x16x32_bf16 a[208:211], a[128:131], a[80:83], a[208:211]
ds_read_b64_tr_b16 a[140:141], v11 offset:49152
v_mfma_f32_16x16x32_bf16 a[208:211], a[132:135], a[84:87], a[208:211]
v_mfma_f32_16x16x32_bf16 a[216:219], a[128:131], a[88:91], a[216:219]
ds_read_b64_tr_b16 a[142:143], v11 offset:51200
v_mfma_f32_16x16x32_bf16 a[216:219], a[132:135], a[92:95], a[216:219]
v_mfma_f32_16x16x32_bf16 a[224:227], a[128:131], a[96:99], a[224:227]
v_mfma_f32_16x16x32_bf16 a[224:227], a[132:135], a[100:103], a[224:227]
v_mfma_f32_16x16x32_bf16 a[232:235], a[128:131], a[104:107], a[232:235]
v_mfma_f32_16x16x32_bf16 a[232:235], a[132:135], a[108:111], a[232:235]
v_mfma_f32_16x16x32_bf16 a[240:243], a[128:131], a[112:115], a[240:243]
v_mfma_f32_16x16x32_bf16 a[240:243], a[132:135], a[116:119], a[240:243]
v_mfma_f32_16x16x32_bf16 a[248:251], a[128:131], a[120:123], a[248:251]
v_mfma_f32_16x16x32_bf16 a[248:251], a[132:135], a[124:127], a[248:251]
s_waitcnt vmcnt(22) lgkmcnt(0)
s_barrier
v_mfma_f32_16x16x32_bf16 a[196:199], a[136:139], a[64:67], a[196:199]
s_add_u32 m0, s29, 98304
ds_read_b64_tr_b16 a[128:129], v4 offset:0
v_mfma_f32_16x16x32_bf16 a[196:199], a[140:143], a[68:71], a[196:199]
buffer_load_dwordx4 v16, s[12:15], s26 offen offset:0 lds
v_mfma_f32_16x16x32_bf16 a[204:207], a[136:139], a[72:75], a[204:207]
ds_read_b64_tr_b16 a[130:131], v4 offset:2048
v_mfma_f32_16x16x32_bf16 a[204:207], a[140:143], a[76:79], a[204:207]
v_mfma_f32_16x16x32_bf16 a[212:215], a[136:139], a[80:83], a[212:215]
ds_read_b64_tr_b16 a[132:133], v4 offset:16384
v_mfma_f32_16x16x32_bf16 a[212:215], a[140:143], a[84:87], a[212:215]
buffer_load_dwordx4 v17, s[12:15], s26 offen offset:1024 lds
v_mfma_f32_16x16x32_bf16 a[220:223], a[136:139], a[88:91], a[220:223]
ds_read_b64_tr_b16 a[134:135], v4 offset:18432
v_mfma_f32_16x16x32_bf16 a[220:223], a[140:143], a[92:95], a[220:223]
v_mfma_f32_16x16x32_bf16 a[228:231], a[136:139], a[96:99], a[228:231]
v_mfma_f32_16x16x32_bf16 a[228:231], a[140:143], a[100:103], a[228:231]
buffer_load_dwordx4 v18, s[12:15], s26 offen offset:2048 lds
v_mfma_f32_16x16x32_bf16 a[236:239], a[136:139], a[104:107], a[236:239]
v_mfma_f32_16x16x32_bf16 a[236:239], a[140:143], a[108:111], a[236:239]
v_mfma_f32_16x16x32_bf16 a[244:247], a[136:139], a[112:115], a[244:247]
v_mfma_f32_16x16x32_bf16 a[244:247], a[140:143], a[116:119], a[244:247]
buffer_load_dwordx4 v19, s[12:15], s26 offen offset:3072 lds
v_mfma_f32_16x16x32_bf16 a[252:255], a[136:139], a[120:123], a[252:255]
s_add_u32 s26, s26, 524288
v_mfma_f32_16x16x32_bf16 a[252:255], a[140:143], a[124:127], a[252:255]
s_waitcnt lgkmcnt(2)
v_mfma_f32_16x16x32_bf16 v[32:35], a[128:131], a[0:3], v[32:35]
s_waitcnt lgkmcnt(0)
s_add_u32 m0, s29, 114688
ds_read_b64_tr_b16 a[136:137], v5 offset:0
v_mfma_f32_16x16x32_bf16 v[32:35], a[132:135], a[4:7], v[32:35]
buffer_load_dwordx4 v16, s[12:15], s27 offen offset:0 lds
v_mfma_f32_16x16x32_bf16 v[40:43], a[128:131], a[8:11], v[40:43]
ds_read_b64_tr_b16 a[138:139], v5 offset:2048
v_mfma_f32_16x16x32_bf16 v[40:43], a[132:135], a[12:15], v[40:43]
v_mfma_f32_16x16x32_bf16 v[48:51], a[128:131], a[16:19], v[48:51]
ds_read_b64_tr_b16 a[140:141], v5 offset:16384
v_mfma_f32_16x16x32_bf16 v[48:51], a[132:135], a[20:23], v[48:51]
buffer_load_dwordx4 v17, s[12:15], s27 offen offset:1024 lds
v_mfma_f32_16x16x32_bf16 v[56:59], a[128:131], a[24:27], v[56:59]
ds_read_b64_tr_b16 a[142:143], v5 offset:18432
v_mfma_f32_16x16x32_bf16 v[56:59], a[132:135], a[28:31], v[56:59]
v_mfma_f32_16x16x32_bf16 v[64:67], a[128:131], a[32:35], v[64:67]
ds_read_b128 a[64:67], v2 offset:32768
v_mfma_f32_16x16x32_bf16 v[64:67], a[132:135], a[36:39], v[64:67]
buffer_load_dwordx4 v18, s[12:15], s27 offen offset:2048 lds
v_mfma_f32_16x16x32_bf16 v[72:75], a[128:131], a[40:43], v[72:75]
ds_read_b128 a[68:71], v3 offset:32768
v_mfma_f32_16x16x32_bf16 v[72:75], a[132:135], a[44:47], v[72:75]
v_mfma_f32_16x16x32_bf16 v[80:83], a[128:131], a[48:51], v[80:83]
v_mfma_f32_16x16x32_bf16 v[80:83], a[132:135], a[52:55], v[80:83]
buffer_load_dwordx4 v19, s[12:15], s27 offen offset:3072 lds
v_mfma_f32_16x16x32_bf16 v[88:91], a[128:131], a[56:59], v[88:91]
s_add_u32 s27, s27, 524288
ds_read_b128 a[72:75], v2 offset:34816
v_mfma_f32_16x16x32_bf16 v[88:91], a[132:135], a[60:63], v[88:91]
s_waitcnt lgkmcnt(5)
v_mfma_f32_16x16x32_bf16 v[36:39], a[136:139], a[0:3], v[36:39]
s_waitcnt lgkmcnt(3)
s_add_u32 m0, s28, 0
ds_read_b64_tr_b16 a[128:129], v6 offset:0
v_mfma_f32_16x16x32_bf16 v[36:39], a[140:143], a[4:7], v[36:39]
buffer_load_dwordx4 v12, s[8:11], s24 offen offset:0 lds
v_mfma_f32_16x16x32_bf16 v[44:47], a[136:139], a[8:11], v[44:47]
ds_read_b64_tr_b16 a[130:131], v6 offset:2048
v_mfma_f32_16x16x32_bf16 v[44:47], a[140:143], a[12:15], v[44:47]
v_mfma_f32_16x16x32_bf16 v[52:55], a[136:139], a[16:19], v[52:55]
ds_read_b64_tr_b16 a[132:133], v6 offset:16384
v_mfma_f32_16x16x32_bf16 v[52:55], a[140:143], a[20:23], v[52:55]
buffer_load_dwordx4 v13, s[8:11], s24 offen offset:1024 lds
v_mfma_f32_16x16x32_bf16 v[60:63], a[136:139], a[24:27], v[60:63]
ds_read_b64_tr_b16 a[134:135], v6 offset:18432
v_mfma_f32_16x16x32_bf16 v[60:63], a[140:143], a[28:31], v[60:63]
v_mfma_f32_16x16x32_bf16 v[68:71], a[136:139], a[32:35], v[68:71]
ds_read_b128 a[76:79], v3 offset:34816
v_mfma_f32_16x16x32_bf16 v[68:71], a[140:143], a[36:39], v[68:71]
buffer_load_dwordx4 v14, s[8:11], s24 offen offset:2048 lds
v_mfma_f32_16x16x32_bf16 v[76:79], a[136:139], a[40:43], v[76:79]
v_mfma_f32_16x16x32_bf16 v[76:79], a[140:143], a[44:47], v[76:79]
v_mfma_f32_16x16x32_bf16 v[84:87], a[136:139], a[48:51], v[84:87]
ds_read_b128 a[80:83], v2 offset:36864
v_mfma_f32_16x16x32_bf16 v[84:87], a[140:143], a[52:55], v[84:87]
buffer_load_dwordx4 v15, s[8:11], s24 offen offset:3072 lds
v_mfma_f32_16x16x32_bf16 v[92:95], a[136:139], a[56:59], v[92:95]
s_add_u32 s24, s24, 128
ds_read_b128 a[84:87], v3 offset:36864
v_mfma_f32_16x16x32_bf16 v[92:95], a[140:143], a[60:63], v[92:95]
s_waitcnt lgkmcnt(5)
v_mfma_f32_16x16x32_bf16 v[96:99], a[128:131], a[0:3], v[96:99]
s_waitcnt lgkmcnt(3)
s_add_u32 m0, s28, 4096
ds_read_b64_tr_b16 a[136:137], v7 offset:0
v_mfma_f32_16x16x32_bf16 v[96:99], a[132:135], a[4:7], v[96:99]
buffer_load_dwordx4 v12, s[8:11], s25 offen offset:0 lds
v_mfma_f32_16x16x32_bf16 v[104:107], a[128:131], a[8:11], v[104:107]
ds_read_b64_tr_b16 a[138:139], v7 offset:2048
v_mfma_f32_16x16x32_bf16 v[104:107], a[132:135], a[12:15], v[104:107]
v_mfma_f32_16x16x32_bf16 v[112:115], a[128:131], a[16:19], v[112:115]
ds_read_b64_tr_b16 a[140:141], v7 offset:16384
v_mfma_f32_16x16x32_bf16 v[112:115], a[132:135], a[20:23], v[112:115]
buffer_load_dwordx4 v13, s[8:11], s25 offen offset:1024 lds
v_mfma_f32_16x16x32_bf16 v[120:123], a[128:131], a[24:27], v[120:123]
ds_read_b64_tr_b16 a[142:143], v7 offset:18432
v_mfma_f32_16x16x32_bf16 v[120:123], a[132:135], a[28:31], v[120:123]
v_mfma_f32_16x16x32_bf16 v[128:131], a[128:131], a[32:35], v[128:131]
v_mfma_f32_16x16x32_bf16 v[128:131], a[132:135], a[36:39], v[128:131]
buffer_load_dwordx4 v14, s[8:11], s25 offen offset:2048 lds
v_mfma_f32_16x16x32_bf16 v[136:139], a[128:131], a[40:43], v[136:139]
ds_read_b128 a[88:91], v2 offset:38912
v_mfma_f32_16x16x32_bf16 v[136:139], a[132:135], a[44:47], v[136:139]
v_mfma_f32_16x16x32_bf16 v[144:147], a[128:131], a[48:51], v[144:147]
ds_read_b128 a[92:95], v3 offset:38912
v_mfma_f32_16x16x32_bf16 v[144:147], a[132:135], a[52:55], v[144:147]
buffer_load_dwordx4 v15, s[8:11], s25 offen offset:3072 lds
v_mfma_f32_16x16x32_bf16 v[152:155], a[128:131], a[56:59], v[152:155]
s_add_u32 s25, s25, 128
v_mfma_f32_16x16x32_bf16 v[152:155], a[132:135], a[60:63], v[152:155]
s_waitcnt lgkmcnt(4)
v_mfma_f32_16x16x32_bf16 v[100:103], a[136:139], a[0:3], v[100:103]
s_waitcnt lgkmcnt(2)
ds_read_b64_tr_b16 a[128:129], v8 offset:0
v_mfma_f32_16x16x32_bf16 v[100:103], a[140:143], a[4:7], v[100:103]
buffer_load_dword v21, v20, s[16:19], s43 offen
v_mfma_f32_16x16x32_bf16 v[108:111], a[136:139], a[8:11], v[108:111]
s_add_u32 s43, s43, s47
ds_read_b64_tr_b16 a[130:131], v8 offset:2048
v_mfma_f32_16x16x32_bf16 v[108:111], a[140:143], a[12:15], v[108:111]
s_cmp_ge_u32 s43, s51
v_mfma_f32_16x16x32_bf16 v[116:119], a[136:139], a[16:19], v[116:119]
s_cselect_b32 s43, 0, s43
ds_read_b64_tr_b16 a[132:133], v8 offset:16384
v_mfma_f32_16x16x32_bf16 v[116:119], a[140:143], a[20:23], v[116:119]
s_cselect_b32 s51, s42, s51
v_mfma_f32_16x16x32_bf16 v[124:127], a[136:139], a[24:27], v[124:127]
s_cselect_b64 s[16:17], s[40:41], s[16:17]
ds_read_b64_tr_b16 a[134:135], v8 offset:18432
v_mfma_f32_16x16x32_bf16 v[124:127], a[140:143], a[28:31], v[124:127]
s_cselect_b32 s18, s42, s18
v_mfma_f32_16x16x32_bf16 v[132:135], a[136:139], a[32:35], v[132:135]
s_cselect_b64 s[40:41], s[44:45], s[40:41]
ds_read_b128 a[96:99], v2 offset:40960
v_mfma_f32_16x16x32_bf16 v[132:135], a[140:143], a[36:39], v[132:135]
s_cselect_b32 s42, s46, s42
v_mfma_f32_16x16x32_bf16 v[140:143], a[136:139], a[40:43], v[140:143]
s_cselect_b32 s46, 0, s46
v_mfma_f32_16x16x32_bf16 v[140:143], a[140:143], a[44:47], v[140:143]
s_lshl_b32 s59, s39, 5
v_mfma_f32_16x16x32_bf16 v[148:151], a[136:139], a[48:51], v[148:151]
s_add_u32 s59, s59, s38
ds_read_b128 a[100:103], v3 offset:40960
v_mfma_f32_16x16x32_bf16 v[148:151], a[140:143], a[52:55], v[148:151]
s_lshl_b32 s59, s59, 2
v_mfma_f32_16x16x32_bf16 v[156:159], a[136:139], a[56:59], v[156:159]
s_add_u32 s59, s59, 94392320
ds_read_b128 a[104:107], v2 offset:43008
v_mfma_f32_16x16x32_bf16 v[156:159], a[140:143], a[60:63], v[156:159]
s_waitcnt lgkmcnt(5)
s_cmp_lt_u32 s2, 224
v_mfma_f32_16x16x32_bf16 v[160:163], a[128:131], a[0:3], v[160:163]
s_waitcnt lgkmcnt(3)
s_cselect_b32 s59, s59, 3221225472
ds_read_b64_tr_b16 a[136:137], v9 offset:0
v_mfma_f32_16x16x32_bf16 v[160:163], a[132:135], a[4:7], v[160:163]
s_mov_b32 s58, 0xffff0000
v_mfma_f32_16x16x32_bf16 v[168:171], a[128:131], a[8:11], v[168:171]
ds_read_b64_tr_b16 a[138:139], v9 offset:2048
v_mfma_f32_16x16x32_bf16 v[168:171], a[132:135], a[12:15], v[168:171]
buffer_load_dword v21, v20, s[16:19], s43 offen
v_mfma_f32_16x16x32_bf16 v[176:179], a[128:131], a[16:19], v[176:179]
s_add_u32 s43, s43, s47
ds_read_b64_tr_b16 a[140:141], v9 offset:16384
v_mfma_f32_16x16x32_bf16 v[176:179], a[132:135], a[20:23], v[176:179]
s_cmp_ge_u32 s43, s51
v_mfma_f32_16x16x32_bf16 v[184:187], a[128:131], a[24:27], v[184:187]
s_cselect_b32 s43, 0, s43
ds_read_b64_tr_b16 a[142:143], v9 offset:18432
v_mfma_f32_16x16x32_bf16 v[184:187], a[132:135], a[28:31], v[184:187]
s_cselect_b32 s51, s42, s51
v_mfma_f32_16x16x32_bf16 v[192:195], a[128:131], a[32:35], v[192:195]
s_cselect_b64 s[16:17], s[40:41], s[16:17]
v_mfma_f32_16x16x32_bf16 v[192:195], a[132:135], a[36:39], v[192:195]
s_cselect_b32 s18, s42, s18
v_mfma_f32_16x16x32_bf16 v[200:203], a[128:131], a[40:43], v[200:203]
s_cselect_b64 s[40:41], s[44:45], s[40:41]
ds_read_b128 a[108:111], v3 offset:43008
v_mfma_f32_16x16x32_bf16 v[200:203], a[132:135], a[44:47], v[200:203]
s_cselect_b32 s42, s46, s42
v_mfma_f32_16x16x32_bf16 v[208:211], a[128:131], a[48:51], v[208:211]
s_cselect_b32 s46, 0, s46
ds_read_b128 a[112:115], v2 offset:45056
v_mfma_f32_16x16x32_bf16 v[208:211], a[132:135], a[52:55], v[208:211]
v_mfma_f32_16x16x32_bf16 v[216:219], a[128:131], a[56:59], v[216:219]
v_mfma_f32_16x16x32_bf16 v[216:219], a[132:135], a[60:63], v[216:219]
s_waitcnt lgkmcnt(4)
v_mfma_f32_16x16x32_bf16 v[164:167], a[136:139], a[0:3], v[164:167]
s_waitcnt lgkmcnt(2)
ds_read_b64_tr_b16 a[128:129], v10 offset:0
v_mfma_f32_16x16x32_bf16 v[164:167], a[140:143], a[4:7], v[164:167]
v_mfma_f32_16x16x32_bf16 v[172:175], a[136:139], a[8:11], v[172:175]
ds_read_b64_tr_b16 a[130:131], v10 offset:2048
v_mfma_f32_16x16x32_bf16 v[172:175], a[140:143], a[12:15], v[172:175]
v_mfma_f32_16x16x32_bf16 v[180:183], a[136:139], a[16:19], v[180:183]
ds_read_b64_tr_b16 a[132:133], v10 offset:16384
v_mfma_f32_16x16x32_bf16 v[180:183], a[140:143], a[20:23], v[180:183]
v_mfma_f32_16x16x32_bf16 v[188:191], a[136:139], a[24:27], v[188:191]
ds_read_b64_tr_b16 a[134:135], v10 offset:18432
v_mfma_f32_16x16x32_bf16 v[188:191], a[140:143], a[28:31], v[188:191]
v_mfma_f32_16x16x32_bf16 v[196:199], a[136:139], a[32:35], v[196:199]
ds_read_b128 a[116:119], v3 offset:45056
v_mfma_f32_16x16x32_bf16 v[196:199], a[140:143], a[36:39], v[196:199]
v_mfma_f32_16x16x32_bf16 v[204:207], a[136:139], a[40:43], v[204:207]
ds_read_b128 a[120:123], v2 offset:47104
v_and_b32 v252, 31, v0
v_mfma_f32_16x16x32_bf16 v[204:207], a[140:143], a[44:47], v[204:207]
v_lshrrev_b32 v253, 5, v0
v_xor_b32 v253, v253, v252
v_mfma_f32_16x16x32_bf16 v[212:215], a[136:139], a[48:51], v[212:215]
v_and_b32 v253, 7, v253
v_lshlrev_b32 v252, 8, v252
v_mfma_f32_16x16x32_bf16 v[212:215], a[140:143], a[52:55], v[212:215]
v_lshl_add_u32 v252, v253, 4, v252
v_add_u32 v252, 147456, v252
v_mfma_f32_16x16x32_bf16 v[220:223], a[136:139], a[56:59], v[220:223]
ds_read_b128 a[124:127], v3 offset:47104
v_mfma_f32_16x16x32_bf16 v[220:223], a[140:143], a[60:63], v[220:223]
s_waitcnt lgkmcnt(5)
v_mfma_f32_16x16x32_bf16 a[192:195], a[128:131], a[0:3], a[192:195]
s_waitcnt lgkmcnt(3)
ds_read_b64_tr_b16 a[136:137], v11 offset:0
v_mfma_f32_16x16x32_bf16 a[192:195], a[132:135], a[4:7], a[192:195]
v_mfma_f32_16x16x32_bf16 a[200:203], a[128:131], a[8:11], a[200:203]
ds_read_b64_tr_b16 a[138:139], v11 offset:2048
v_mfma_f32_16x16x32_bf16 a[200:203], a[132:135], a[12:15], a[200:203]
v_mfma_f32_16x16x32_bf16 a[208:211], a[128:131], a[16:19], a[208:211]
ds_read_b64_tr_b16 a[140:141], v11 offset:16384
v_mfma_f32_16x16x32_bf16 a[208:211], a[132:135], a[20:23], a[208:211]
v_mfma_f32_16x16x32_bf16 a[216:219], a[128:131], a[24:27], a[216:219]
ds_read_b64_tr_b16 a[142:143], v11 offset:18432
v_mfma_f32_16x16x32_bf16 a[216:219], a[132:135], a[28:31], a[216:219]
v_mfma_f32_16x16x32_bf16 a[224:227], a[128:131], a[32:35], a[224:227]
v_mfma_f32_16x16x32_bf16 a[224:227], a[132:135], a[36:39], a[224:227]
v_mfma_f32_16x16x32_bf16 a[232:235], a[128:131], a[40:43], a[232:235]
v_mfma_f32_16x16x32_bf16 a[232:235], a[132:135], a[44:47], a[232:235]
v_mfma_f32_16x16x32_bf16 a[240:243], a[128:131], a[48:51], a[240:243]
v_mfma_f32_16x16x32_bf16 a[240:243], a[132:135], a[52:55], a[240:243]
v_mfma_f32_16x16x32_bf16 a[248:251], a[128:131], a[56:59], a[248:251]
v_mfma_f32_16x16x32_bf16 a[248:251], a[132:135], a[60:63], a[248:251]
s_waitcnt vmcnt(2) lgkmcnt(0)
s_barrier
v_mfma_f32_16x16x32_bf16 a[196:199], a[136:139], a[0:3], a[196:199]
s_add_u32 m0, s29, 65536
ds_read_b64_tr_b16 a[128:129], v4 offset:32768
v_lshlrev_b32 v28, 16, v248
v_mfma_f32_16x16x32_bf16 a[196:199], a[140:143], a[4:7], a[196:199]
buffer_load_dwordx4 v16, s[12:15], s26 offen offset:0 lds
v_mfma_f32_16x16x32_bf16 a[204:207], a[136:139], a[8:11], a[204:207]
ds_read_b64_tr_b16 a[130:131], v4 offset:34816
v_and_b32 v29, s58, v248
v_mfma_f32_16x16x32_bf16 a[204:207], a[140:143], a[12:15], a[204:207]
v_lshlrev_b32 v30, 16, v249
v_and_b32 v253, s58, v249
v_mfma_f32_16x16x32_bf16 a[212:215], a[136:139], a[16:19], a[212:215]
ds_read_b64_tr_b16 a[132:133], v4 offset:49152
v_lshlrev_b32 v22, 16, v224
v_mfma_f32_16x16x32_bf16 a[212:215], a[140:143], a[20:23], a[212:215]
buffer_load_dwordx4 v17, s[12:15], s26 offen offset:1024 lds
v_mfma_f32_16x16x32_bf16 a[220:223], a[136:139], a[24:27], a[220:223]
ds_read_b64_tr_b16 a[134:135], v4 offset:51200
v_lshlrev_b32 v23, 16, v225
v_mfma_f32_16x16x32_bf16 a[220:223], a[140:143], a[28:31], a[220:223]
v_lshlrev_b32 v24, 16, v226
v_mul_f32 v254, v22, v253
v_mfma_f32_16x16x32_bf16 a[228:231], a[136:139], a[32:35], a[228:231]
v_lshlrev_b32 v25, 16, v227
v_lshlrev_b32 v247, 16, v236
v_mfma_f32_16x16x32_bf16 a[228:231], a[140:143], a[36:39], a[228:231]
buffer_load_dwordx4 v18, s[12:15], s26 offen offset:2048 lds
v_mfma_f32_16x16x32_bf16 a[236:239], a[136:139], a[40:43], a[236:239]
v_fmac_f32 v254, v23, v30
v_fmac_f32 v254, v24, v29
v_mfma_f32_16x16x32_bf16 a[236:239], a[140:143], a[44:47], a[236:239]
v_fmac_f32 v254, v25, v28
v_mul_f32 v254, v254, v247
v_mfma_f32_16x16x32_bf16 a[244:247], a[136:139], a[48:51], a[244:247]
v_mul_f32 v255, v23, v253
v_lshlrev_b32 v22, 16, v228
v_mfma_f32_16x16x32_bf16 a[244:247], a[140:143], a[52:55], a[244:247]
buffer_load_dwordx4 v19, s[12:15], s26 offen offset:3072 lds
v_mfma_f32_16x16x32_bf16 a[252:255], a[136:139], a[56:59], a[252:255]
s_add_u32 s26, s26, 524288
v_lshlrev_b32 v247, 16, v237
v_fmac_f32 v255, v24, v30
v_mfma_f32_16x16x32_bf16 a[252:255], a[140:143], a[60:63], a[252:255]
s_waitcnt lgkmcnt(0)
v_fmac_f32 v255, v25, v29
v_fmac_f32 v255, v22, v28
v_mfma_f32_16x16x32_bf16 v[32:35], a[128:131], a[64:67], v[32:35]
s_add_u32 m0, s29, 81920
ds_read_b64_tr_b16 a[136:137], v5 offset:32768
v_mul_f32 v255, v255, v247
v_mfma_f32_16x16x32_bf16 v[32:35], a[132:135], a[68:71], v[32:35]
buffer_load_dwordx4 v16, s[12:15], s27 offen offset:0 lds
v_mfma_f32_16x16x32_bf16 v[40:43], a[128:131], a[72:75], v[40:43]
ds_read_b64_tr_b16 a[138:139], v5 offset:34816
v_cvt_pk_bf16_f32 v246, v254, v255
v_mfma_f32_16x16x32_bf16 v[40:43], a[132:135], a[76:79], v[40:43]
v_accvgpr_write_b32 a180, v246
v_mul_f32 v254, v24, v253
v_mfma_f32_16x16x32_bf16 v[48:51], a[128:131], a[80:83], v[48:51]
ds_read_b64_tr_b16 a[140:141], v5 offset:49152
v_lshlrev_b32 v23, 16, v229
v_mfma_f32_16x16x32_bf16 v[48:51], a[132:135], a[84:87], v[48:51]
buffer_load_dwordx4 v17, s[12:15], s27 offen offset:1024 lds
v_lshlrev_b32 v247, 16, v238
v_mfma_f32_16x16x32_bf16 v[56:59], a[128:131], a[88:91], v[56:59]
ds_read_b64_tr_b16 a[142:143], v5 offset:51200
v_fmac_f32 v254, v25, v30
v_mfma_f32_16x16x32_bf16 v[56:59], a[132:135], a[92:95], v[56:59]
v_fmac_f32 v254, v22, v29
v_fmac_f32 v254, v23, v28
v_mfma_f32_16x16x32_bf16 v[64:67], a[128:131], a[96:99], v[64:67]
ds_read_b128 a[0:3], v2 offset:0
v_mul_f32 v254, v254, v247
v_mfma_f32_16x16x32_bf16 v[64:67], a[132:135], a[100:103], v[64:67]
buffer_load_dwordx4 v18, s[12:15], s27 offen offset:2048 lds
v_mfma_f32_16x16x32_bf16 v[72:75], a[128:131], a[104:107], v[72:75]
ds_read_b128 a[4:7], v3 offset:0
v_cvt_pk_bf16_f32 v246, v255, v254
v_accvgpr_write_b32 a176, v246
v_mfma_f32_16x16x32_bf16 v[72:75], a[132:135], a[108:111], v[72:75]
v_mul_f32 v255, v25, v253
v_lshlrev_b32 v24, 16, v230
v_mfma_f32_16x16x32_bf16 v[80:83], a[128:131], a[112:115], v[80:83]
v_lshlrev_b32 v247, 16, v239
v_fmac_f32 v255, v22, v30
v_mfma_f32_16x16x32_bf16 v[80:83], a[132:135], a[116:119], v[80:83]
buffer_load_dwordx4 v19, s[12:15], s27 offen offset:3072 lds
v_mfma_f32_16x16x32_bf16 v[88:91], a[128:131], a[120:123], v[88:91]
s_add_u32 s27, s27, 524288
ds_read_b128 a[8:11], v2 offset:2048
v_fmac_f32 v255, v23, v29
v_mfma_f32_16x16x32_bf16 v[88:91], a[132:135], a[124:127], v[88:91]
s_waitcnt lgkmcnt(3)
v_fmac_f32 v255, v24, v28
v_mul_f32 v255, v255, v247
v_mfma_f32_16x16x32_bf16 v[36:39], a[136:139], a[64:67], v[36:39]
s_add_u32 m0, s28, 32768
ds_read_b64_tr_b16 a[128:129], v6 offset:32768
v_cvt_pk_bf16_f32 v246, v254, v255
v_accvgpr_write_b32 a181, v246
v_mfma_f32_16x16x32_bf16 v[36:39], a[140:143], a[68:71], v[36:39]
buffer_load_dwordx4 v12, s[8:11], s24 offen offset:0 lds
v_mfma_f32_16x16x32_bf16 v[44:47], a[136:139], a[72:75], v[44:47]
ds_read_b64_tr_b16 a[130:131], v6 offset:34816
v_mul_f32 v254, v22, v253
v_mfma_f32_16x16x32_bf16 v[44:47], a[140:143], a[76:79], v[44:47]
v_lshlrev_b32 v25, 16, v231
v_lshlrev_b32 v247, 16, v240
v_mfma_f32_16x16x32_bf16 v[52:55], a[136:139], a[80:83], v[52:55]
ds_read_b64_tr_b16 a[132:133], v6 offset:49152
v_fmac_f32 v254, v23, v30
v_mfma_f32_16x16x32_bf16 v[52:55], a[140:143], a[84:87], v[52:55]
buffer_load_dwordx4 v13, s[8:11], s24 offen offset:1024 lds
v_fmac_f32 v254, v24, v29
v_mfma_f32_16x16x32_bf16 v[60:63], a[136:139], a[88:91], v[60:63]
ds_read_b64_tr_b16 a[134:135], v6 offset:51200
v_fmac_f32 v254, v25, v28
v_mfma_f32_16x16x32_bf16 v[60:63], a[140:143], a[92:95], v[60:63]
v_mul_f32 v254, v254, v247
v_cvt_pk_bf16_f32 v246, v255, v254
v_mfma_f32_16x16x32_bf16 v[68:71], a[136:139], a[96:99], v[68:71]
ds_read_b128 a[12:15], v3 offset:2048
v_accvgpr_write_b32 a177, v246
v_mfma_f32_16x16x32_bf16 v[68:71], a[140:143], a[100:103], v[68:71]
buffer_load_dwordx4 v14, s[8:11], s24 offen offset:2048 lds
v_mfma_f32_16x16x32_bf16 v[76:79], a[136:139], a[104:107], v[76:79]
v_mul_f32 v255, v23, v253
v_lshlrev_b32 v22, 16, v232
v_lshlrev_b32 v247, 16, v241
v_mfma_f32_16x16x32_bf16 v[76:79], a[140:143], a[108:111], v[76:79]
v_fmac_f32 v255, v24, v30
v_fmac_f32 v255, v25, v29
v_mfma_f32_16x16x32_bf16 v[84:87], a[136:139], a[112:115], v[84:87]
ds_read_b128 a[16:19], v2 offset:4096
v_fmac_f32 v255, v22, v28
v_mfma_f32_16x16x32_bf16 v[84:87], a[140:143], a[116:119], v[84:87]
buffer_load_dwordx4 v15, s[8:11], s24 offen offset:3072 lds
v_mfma_f32_16x16x32_bf16 v[92:95], a[136:139], a[120:123], v[92:95]
s_add_u32 s24, s24, 128
ds_read_b128 a[20:23], v3 offset:4096
v_mul_f32 v255, v255, v247
v_mfma_f32_16x16x32_bf16 v[92:95], a[140:143], a[124:127], v[92:95]
s_waitcnt lgkmcnt(3)
v_cvt_pk_bf16_f32 v246, v254, v255
v_accvgpr_write_b32 a182, v246
v_mfma_f32_16x16x32_bf16 v[96:99], a[128:131], a[64:67], v[96:99]
s_add_u32 m0, s28, 36864
ds_read_b64_tr_b16 a[136:137], v7 offset:32768
v_mul_f32 v254, v24, v253
v_lshlrev_b32 v23, 16, v233
v_mfma_f32_16x16x32_bf16 v[96:99], a[132:135], a[68:71], v[96:99]
buffer_load_dwordx4 v12, s[8:11], s25 offen offset:0 lds
v_mfma_f32_16x16x32_bf16 v[104:107], a[128:131], a[72:75], v[104:107]
ds_read_b64_tr_b16 a[138:139], v7 offset:34816
v_lshlrev_b32 v247, 16, v242
v_mfma_f32_16x16x32_bf16 v[104:107], a[132:135], a[76:79], v[104:107]
v_fmac_f32 v254, v25, v30
v_fmac_f32 v254, v22, v29
v_mfma_f32_16x16x32_bf16 v[112:115], a[128:131], a[80:83], v[112:115]
ds_read_b64_tr_b16 a[140:141], v7 offset:49152
v_fmac_f32 v254, v23, v28
v_mfma_f32_16x16x32_bf16 v[112:115], a[132:135], a[84:87], v[112:115]
buffer_load_dwordx4 v13, s[8:11], s25 offen offset:1024 lds
v_mul_f32 v254, v254, v247
v_mfma_f32_16x16x32_bf16 v[120:123], a[128:131], a[88:91], v[120:123]
ds_read_b64_tr_b16 a[142:143], v7 offset:51200
v_cvt_pk_bf16_f32 v246, v255, v254
v_mfma_f32_16x16x32_bf16 v[120:123], a[132:135], a[92:95], v[120:123]
v_accvgpr_write_b32 a178, v246
v_mul_f32 v255, v25, v253
v_mfma_f32_16x16x32_bf16 v[128:131], a[128:131], a[96:99], v[128:131]
v_lshlrev_b32 v24, 16, v234
v_lshlrev_b32 v247, 16, v243
v_mfma_f32_16x16x32_bf16 v[128:131], a[132:135], a[100:103], v[128:131]
buffer_load_dwordx4 v14, s[8:11], s25 offen offset:2048 lds
v_mfma_f32_16x16x32_bf16 v[136:139], a[128:131], a[104:107], v[136:139]
ds_read_b128 a[24:27], v2 offset:6144
v_fmac_f32 v255, v22, v30
v_fmac_f32 v255, v23, v29
v_mfma_f32_16x16x32_bf16 v[136:139], a[132:135], a[108:111], v[136:139]
v_fmac_f32 v255, v24, v28
v_mul_f32 v255, v255, v247
v_mfma_f32_16x16x32_bf16 v[144:147], a[128:131], a[112:115], v[144:147]
ds_read_b128 a[28:31], v3 offset:6144
v_cvt_pk_bf16_f32 v246, v254, v255
v_mfma_f32_16x16x32_bf16 v[144:147], a[132:135], a[116:119], v[144:147]
buffer_load_dwordx4 v15, s[8:11], s25 offen offset:3072 lds
v_mfma_f32_16x16x32_bf16 v[152:155], a[128:131], a[120:123], v[152:155]
s_add_u32 s25, s25, 128
v_accvgpr_write_b32 a183, v246
v_mul_f32 v254, v22, v253
v_mfma_f32_16x16x32_bf16 v[152:155], a[132:135], a[124:127], v[152:155]
s_waitcnt lgkmcnt(4)
v_lshlrev_b32 v25, 16, v235
v_lshlrev_b32 v247, 16, v244
v_mfma_f32_16x16x32_bf16 v[100:103], a[136:139], a[64:67], v[100:103]
s_waitcnt lgkmcnt(2)
ds_read_b64_tr_b16 a[128:129], v8 offset:32768
v_fmac_f32 v254, v23, v30
v_fmac_f32 v254, v24, v29
v_mfma_f32_16x16x32_bf16 v[100:103], a[140:143], a[68:71], v[100:103]
buffer_load_dword v21, v20, s[16:19], s43 offen
v_mfma_f32_16x16x32_bf16 v[108:111], a[136:139], a[72:75], v[108:111]
s_add_u32 s43, s43, s47
ds_read_b64_tr_b16 a[130:131], v8 offset:34816
v_fmac_f32 v254, v25, v28
v_mfma_f32_16x16x32_bf16 v[108:111], a[140:143], a[76:79], v[108:111]
s_cmp_ge_u32 s43, s51
v_mul_f32 v254, v254, v247
v_cvt_pk_bf16_f32 v246, v255, v254
v_mfma_f32_16x16x32_bf16 v[116:119], a[136:139], a[80:83], v[116:119]
s_cselect_b32 s43, 0, s43
ds_read_b64_tr_b16 a[132:133], v8 offset:49152
v_accvgpr_write_b32 a179, v246
v_mfma_f32_16x16x32_bf16 v[116:119], a[140:143], a[84:87], v[116:119]
s_cselect_b32 s51, s42, s51
v_lshlrev_b32 v28, 16, v250
v_and_b32 v29, s58, v250
v_lshlrev_b32 v30, 16, v251
v_mfma_f32_16x16x32_bf16 v[124:127], a[136:139], a[88:91], v[124:127]
s_cselect_b64 s[16:17], s[40:41], s[16:17]
ds_read_b64_tr_b16 a[134:135], v8 offset:51200
v_and_b32 v253, s58, v251
v_mfma_f32_16x16x32_bf16 v[124:127], a[140:143], a[92:95], v[124:127]
s_cselect_b32 s18, s42, s18
v_and_b32 v22, s58, v224
v_and_b32 v23, s58, v225
v_mfma_f32_16x16x32_bf16 v[132:135], a[136:139], a[96:99], v[132:135]
s_cselect_b64 s[40:41], s[44:45], s[40:41]
ds_read_b128 a[32:35], v2 offset:8192
v_and_b32 v24, s58, v226
v_mfma_f32_16x16x32_bf16 v[132:135], a[140:143], a[100:103], v[132:135]
s_cselect_b32 s42, s46, s42
v_mul_f32 v254, v22, v253
v_and_b32 v25, s58, v227
v_mfma_f32_16x16x32_bf16 v[140:143], a[136:139], a[104:107], v[140:143]
s_cselect_b32 s46, 0, s46
v_and_b32 v247, s58, v236
v_fmac_f32 v254, v23, v30
v_mfma_f32_16x16x32_bf16 v[140:143], a[140:143], a[108:111], v[140:143]
buffer_load_dword v245, off, s[60:63], 0 sc1
v_fmac_f32 v254, v24, v29
v_mfma_f32_16x16x32_bf16 v[148:151], a[136:139], a[112:115], v[148:151]
ds_read_b128 a[36:39], v3 offset:8192
v_fmac_f32 v254, v25, v28
v_mfma_f32_16x16x32_bf16 v[148:151], a[140:143], a[116:119], v[148:151]
v_mul_f32 v254, v254, v247
v_mul_f32 v255, v23, v253
v_mfma_f32_16x16x32_bf16 v[156:159], a[136:139], a[120:123], v[156:159]
ds_read_b128 a[40:43], v2 offset:10240
v_and_b32 v22, s58, v228
v_mfma_f32_16x16x32_bf16 v[156:159], a[140:143], a[124:127], v[156:159]
s_waitcnt lgkmcnt(5)
v_and_b32 v247, s58, v237
v_fmac_f32 v255, v24, v30
v_mfma_f32_16x16x32_bf16 v[160:163], a[128:131], a[64:67], v[160:163]
s_waitcnt lgkmcnt(3)
ds_read_b64_tr_b16 a[136:137], v9 offset:32768
v_fmac_f32 v255, v25, v29
v_fmac_f32 v255, v22, v28
v_mfma_f32_16x16x32_bf16 v[160:163], a[132:135], a[68:71], v[160:163]
v_mul_f32 v255, v255, v247
v_cvt_pk_bf16_f32 v246, v254, v255
v_mfma_f32_16x16x32_bf16 v[168:171], a[128:131], a[72:75], v[168:171]
ds_read_b64_tr_b16 a[138:139], v9 offset:34816
v_accvgpr_write_b32 a188, v246
v_mfma_f32_16x16x32_bf16 v[168:171], a[132:135], a[76:79], v[168:171]
v_mul_f32 v254, v24, v253
v_and_b32 v23, s58, v229
v_mfma_f32_16x16x32_bf16 v[176:179], a[128:131], a[80:83], v[176:179]
ds_read_b64_tr_b16 a[140:141], v9 offset:49152
v_and_b32 v247, s58, v238
v_mfma_f32_16x16x32_bf16 v[176:179], a[132:135], a[84:87], v[176:179]
v_fmac_f32 v254, v25, v30
v_fmac_f32 v254, v22, v29
v_fmac_f32 v254, v23, v28
v_mfma_f32_16x16x32_bf16 v[184:187], a[128:131], a[88:91], v[184:187]
ds_read_b64_tr_b16 a[142:143], v9 offset:51200
v_mul_f32 v254, v254, v247
v_mfma_f32_16x16x32_bf16 v[184:187], a[132:135], a[92:95], v[184:187]
v_cvt_pk_bf16_f32 v246, v255, v254
v_accvgpr_write_b32 a184, v246
v_mfma_f32_16x16x32_bf16 v[192:195], a[128:131], a[96:99], v[192:195]
v_mul_f32 v255, v25, v253
v_and_b32 v24, s58, v230
v_mfma_f32_16x16x32_bf16 v[192:195], a[132:135], a[100:103], v[192:195]
v_and_b32 v247, s58, v239
v_fmac_f32 v255, v22, v30
v_mfma_f32_16x16x32_bf16 v[200:203], a[128:131], a[104:107], v[200:203]
ds_read_b128 a[44:47], v3 offset:10240
v_fmac_f32 v255, v23, v29
v_mfma_f32_16x16x32_bf16 v[200:203], a[132:135], a[108:111], v[200:203]
v_fmac_f32 v255, v24, v28
v_mul_f32 v255, v255, v247
v_cvt_pk_bf16_f32 v246, v254, v255
v_mfma_f32_16x16x32_bf16 v[208:211], a[128:131], a[112:115], v[208:211]
ds_read_b128 a[48:51], v2 offset:12288
v_accvgpr_write_b32 a189, v246
v_mfma_f32_16x16x32_bf16 v[208:211], a[132:135], a[116:119], v[208:211]
v_mul_f32 v254, v22, v253
v_and_b32 v25, s58, v231
v_mfma_f32_16x16x32_bf16 v[216:219], a[128:131], a[120:123], v[216:219]
v_and_b32 v247, s58, v240
v_fmac_f32 v254, v23, v30
v_mfma_f32_16x16x32_bf16 v[216:219], a[132:135], a[124:127], v[216:219]
s_waitcnt lgkmcnt(4)
v_fmac_f32 v254, v24, v29
v_fmac_f32 v254, v25, v28
v_mfma_f32_16x16x32_bf16 v[164:167], a[136:139], a[64:67], v[164:167]
s_waitcnt lgkmcnt(2)
ds_read_b64_tr_b16 a[128:129], v10 offset:32768
v_mul_f32 v254, v254, v247
v_cvt_pk_bf16_f32 v246, v255, v254
v_mfma_f32_16x16x32_bf16 v[164:167], a[140:143], a[68:71], v[164:167]
v_accvgpr_write_b32 a185, v246
v_mul_f32 v255, v23, v253
v_mfma_f32_16x16x32_bf16 v[172:175], a[136:139], a[72:75], v[172:175]
ds_read_b64_tr_b16 a[130:131], v10 offset:34816
v_and_b32 v22, s58, v232
v_mfma_f32_16x16x32_bf16 v[172:175], a[140:143], a[76:79], v[172:175]
v_and_b32 v247, s58, v241
v_fmac_f32 v255, v24, v30
v_mfma_f32_16x16x32_bf16 v[180:183], a[136:139], a[80:83], v[180:183]
s_lshr_b32 s22, s3, 1
ds_read_b64_tr_b16 a[132:133], v10 offset:49152
v_fmac_f32 v255, v25, v29
v_mfma_f32_16x16x32_bf16 v[180:183], a[140:143], a[84:87], v[180:183]
s_mul_i32 s22, s22, 2097152
v_fmac_f32 v255, v22, v28
v_mul_f32 v255, v255, v247
v_cvt_pk_bf16_f32 v246, v254, v255
v_mfma_f32_16x16x32_bf16 v[188:191], a[136:139], a[88:91], v[188:191]
s_and_b32 s23, s3, 1
ds_read_b64_tr_b16 a[134:135], v10 offset:51200
v_accvgpr_write_b32 a190, v246
v_mfma_f32_16x16x32_bf16 v[188:191], a[140:143], a[92:95], v[188:191]
s_lshl_b32 s23, s23, 5
v_mul_f32 v254, v24, v253
v_and_b32 v23, s58, v233
v_mfma_f32_16x16x32_bf16 v[196:199], a[136:139], a[96:99], v[196:199]
s_lshl_b32 s56, s39, 6
ds_read_b128 a[52:55], v3 offset:12288
v_and_b32 v247, s58, v242
v_mfma_f32_16x16x32_bf16 v[196:199], a[140:143], a[100:103], v[196:199]
s_add_u32 s23, s23, s56
v_fmac_f32 v254, v25, v30
v_fmac_f32 v254, v22, v29
v_mfma_f32_16x16x32_bf16 v[204:207], a[136:139], a[104:107], v[204:207]
s_mul_i32 s23, s23, 4224
ds_read_b128 a[56:59], v2 offset:14336
v_fmac_f32 v254, v23, v28
v_mfma_f32_16x16x32_bf16 v[204:207], a[140:143], a[108:111], v[204:207]
s_add_u32 s22, s22, s23
v_mul_f32 v254, v254, v247
v_cvt_pk_bf16_f32 v246, v255, v254
v_accvgpr_write_b32 a186, v246
v_mfma_f32_16x16x32_bf16 v[212:215], a[136:139], a[112:115], v[212:215]
s_add_u32 s57, s22, 83886200
v_mul_f32 v255, v25, v253
v_and_b32 v24, s58, v234
v_mfma_f32_16x16x32_bf16 v[212:215], a[140:143], a[116:119], v[212:215]
s_lshl_b32 s23, s38, 7
v_and_b32 v247, s58, v243
v_fmac_f32 v255, v22, v30
v_mfma_f32_16x16x32_bf16 v[220:223], a[136:139], a[120:123], v[220:223]
s_add_u32 s22, s22, s23
ds_read_b128 a[60:63], v3 offset:14336
v_fmac_f32 v255, v23, v29
v_mfma_f32_16x16x32_bf16 v[220:223], a[140:143], a[124:127], v[220:223]
s_waitcnt lgkmcnt(3)
s_add_u32 s56, s22, 83886208
v_fmac_f32 v255, v24, v28
v_mul_f32 v255, v255, v247
v_mfma_f32_16x16x32_bf16 a[192:195], a[128:131], a[64:67], a[192:195]
s_cmp_lt_u32 s2, 224
ds_read_b64_tr_b16 a[136:137], v11 offset:32768
v_cvt_pk_bf16_f32 v246, v254, v255
v_accvgpr_write_b32 a191, v246
v_mfma_f32_16x16x32_bf16 a[192:195], a[132:135], a[68:71], a[192:195]
s_cselect_b32 s56, s56, 3221225472
v_mul_f32 v254, v22, v253
v_and_b32 v25, s58, v235
v_mfma_f32_16x16x32_bf16 a[200:203], a[128:131], a[72:75], a[200:203]
s_cmp_eq_u32 s38, 0
ds_read_b64_tr_b16 a[138:139], v11 offset:34816
v_and_b32 v247, s58, v244
v_mfma_f32_16x16x32_bf16 a[200:203], a[132:135], a[76:79], a[200:203]
s_cselect_b32 s57, s57, 3221225472
v_fmac_f32 v254, v23, v30
v_fmac_f32 v254, v24, v29
v_mfma_f32_16x16x32_bf16 a[208:211], a[128:131], a[80:83], a[208:211]
ds_read_b64_tr_b16 a[140:141], v11 offset:49152
v_fmac_f32 v254, v25, v28
v_mfma_f32_16x16x32_bf16 a[208:211], a[132:135], a[84:87], a[208:211]
v_mul_f32 v254, v254, v247
v_cvt_pk_bf16_f32 v246, v255, v254
v_accvgpr_write_b32 a187, v246
v_mfma_f32_16x16x32_bf16 a[216:219], a[128:131], a[88:91], a[216:219]
ds_read_b64_tr_b16 a[142:143], v11 offset:51200
v_mfma_f32_16x16x32_bf16 a[216:219], a[132:135], a[92:95], a[216:219]
ds_write_b128 v252, a[176:179] offset:0
v_mfma_f32_16x16x32_bf16 a[224:227], a[128:131], a[96:99], a[224:227]
v_mfma_f32_16x16x32_bf16 a[224:227], a[132:135], a[100:103], a[224:227]
ds_write_b128 v252, a[180:183] offset:8192
v_mfma_f32_16x16x32_bf16 a[232:235], a[128:131], a[104:107], a[232:235]
v_mfma_f32_16x16x32_bf16 a[232:235], a[132:135], a[108:111], a[232:235]
ds_write_b128 v252, a[184:187] offset:128
v_mfma_f32_16x16x32_bf16 a[240:243], a[128:131], a[112:115], a[240:243]
v_mfma_f32_16x16x32_bf16 a[240:243], a[132:135], a[116:119], a[240:243]
ds_write_b128 v252, a[188:191] offset:8320
v_mfma_f32_16x16x32_bf16 a[248:251], a[128:131], a[120:123], a[248:251]
v_mfma_f32_16x16x32_bf16 a[248:251], a[132:135], a[124:127], a[248:251]
s_waitcnt vmcnt(2) lgkmcnt(0)
s_barrier
v_mfma_f32_16x16x32_bf16 a[196:199], a[136:139], a[64:67], a[196:199]
s_add_u32 m0, s29, 98304
ds_read_b64_tr_b16 a[128:129], v4 offset:0
v_lshrrev_b32 v22, 8, v1
v_mfma_f32_16x16x32_bf16 a[196:199], a[140:143], a[68:71], a[196:199]
buffer_load_dwordx4 v16, s[12:15], s26 offen offset:0 lds
v_mfma_f32_16x16x32_bf16 a[204:207], a[136:139], a[72:75], a[204:207]
ds_read_b64_tr_b16 a[130:131], v4 offset:2048
v_lshlrev_b32 v22, 4, v22
v_mfma_f32_16x16x32_bf16 a[204:207], a[140:143], a[76:79], a[204:207]
v_xor_b32 v22, v22, v1
v_add_u32 v22, s29, v22
v_mfma_f32_16x16x32_bf16 a[212:215], a[136:139], a[80:83], a[212:215]
ds_read_b64_tr_b16 a[132:133], v4 offset:16384
v_add_u32 v22, 147456, v22
v_mfma_f32_16x16x32_bf16 a[212:215], a[140:143], a[84:87], a[212:215]
buffer_load_dwordx4 v17, s[12:15], s26 offen offset:1024 lds
v_mfma_f32_16x16x32_bf16 a[220:223], a[136:139], a[88:91], a[220:223]
ds_read_b64_tr_b16 a[134:135], v4 offset:18432
v_xor_b32 v23, 64, v22
v_mfma_f32_16x16x32_bf16 a[220:223], a[140:143], a[92:95], a[220:223]
v_lshrrev_b32 v224, 7, v1
v_mul_u32_u24 v224, 4224, v224
v_mfma_f32_16x16x32_bf16 a[228:231], a[136:139], a[96:99], a[228:231]
v_and_b32 v225, 0x70, v1
v_add_u32 v224, v224, v225
v_mfma_f32_16x16x32_bf16 a[228:231], a[140:143], a[100:103], a[228:231]
buffer_load_dwordx4 v18, s[12:15], s26 offen offset:2048 lds
v_mfma_f32_16x16x32_bf16 a[236:239], a[136:139], a[104:107], a[236:239]
v_bfe_u32 v225, v1, 4, 5
v_mul_u32_u24 v225, 4224, v225
v_mfma_f32_16x16x32_bf16 a[236:239], a[140:143], a[108:111], a[236:239]
v_mov_b32 v226, 0
v_mov_b32 v227, 0
v_mfma_f32_16x16x32_bf16 a[244:247], a[136:139], a[112:115], a[244:247]
v_mfma_f32_16x16x32_bf16 a[244:247], a[140:143], a[116:119], a[244:247]
buffer_load_dwordx4 v19, s[12:15], s26 offen offset:3072 lds
v_mfma_f32_16x16x32_bf16 a[252:255], a[136:139], a[120:123], a[252:255]
s_add_u32 s26, s26, 524288
v_mfma_f32_16x16x32_bf16 a[252:255], a[140:143], a[124:127], a[252:255]
s_waitcnt lgkmcnt(2)
v_mfma_f32_16x16x32_bf16 v[32:35], a[128:131], a[0:3], v[32:35]
s_waitcnt lgkmcnt(0)
s_add_u32 m0, s29, 114688
ds_read_b64_tr_b16 a[136:137], v5 offset:0
v_mfma_f32_16x16x32_bf16 v[32:35], a[132:135], a[4:7], v[32:35]
buffer_load_dwordx4 v16, s[12:15], s27 offen offset:0 lds
v_mfma_f32_16x16x32_bf16 v[40:43], a[128:131], a[8:11], v[40:43]
s_mul_i32 s52, s20, 7
ds_read_b64_tr_b16 a[138:139], v5 offset:2048
v_mfma_f32_16x16x32_bf16 v[40:43], a[132:135], a[12:15], v[40:43]
s_add_u32 s52, s52, s21
buffer_store_dwordx2 v[226:227], v225, s[4:7], s57 offen sc1
v_mfma_f32_16x16x32_bf16 v[48:51], a[128:131], a[16:19], v[48:51]
s_lshl_b32 s53, s52, 2
ds_read_b64_tr_b16 a[140:141], v5 offset:16384
v_mfma_f32_16x16x32_bf16 v[48:51], a[132:135], a[20:23], v[48:51]
s_add_u32 s53, s53, s3
buffer_load_dwordx4 v17, s[12:15], s27 offen offset:1024 lds
v_mfma_f32_16x16x32_bf16 v[56:59], a[128:131], a[24:27], v[56:59]
s_lshl_b32 s49, s53, 12
ds_read_b64_tr_b16 a[142:143], v5 offset:18432
v_mfma_f32_16x16x32_bf16 v[56:59], a[132:135], a[28:31], v[56:59]
s_mul_i32 s53, s53, 4224
v_mfma_f32_16x16x32_bf16 v[64:67], a[128:131], a[32:35], v[64:67]
s_add_u32 s53, s53, 83886080
ds_read_b128 a[64:67], v2 offset:32768
v_mfma_f32_16x16x32_bf16 v[64:67], a[132:135], a[36:39], v[64:67]
s_lshr_b32 s52, s52, 4
buffer_load_dwordx4 v18, s[12:15], s27 offen offset:2048 lds
v_mfma_f32_16x16x32_bf16 v[72:75], a[128:131], a[40:43], v[72:75]
s_min_u32 s52, s52, 6
ds_read_b128 a[68:71], v3 offset:32768
v_mfma_f32_16x16x32_bf16 v[72:75], a[132:135], a[44:47], v[72:75]
s_lshl_b32 s52, s52, 7
ds_read_b128 a[176:179], v22 offset:0
v_mfma_f32_16x16x32_bf16 v[80:83], a[128:131], a[48:51], v[80:83]
s_add_u32 s52, s52, 94392320
ds_read_b128 a[180:183], v23 offset:1024
v_mfma_f32_16x16x32_bf16 v[80:83], a[132:135], a[52:55], v[80:83]
buffer_load_dwordx4 v19, s[12:15], s27 offen offset:3072 lds
v_mfma_f32_16x16x32_bf16 v[88:91], a[128:131], a[56:59], v[88:91]
s_add_u32 s27, s27, 524288
ds_read_b128 a[72:75], v2 offset:34816
v_mfma_f32_16x16x32_bf16 v[88:91], a[132:135], a[60:63], v[88:91]
s_waitcnt lgkmcnt(7)
ds_read_b128 a[184:187], v22 offset:2048
v_mfma_f32_16x16x32_bf16 v[36:39], a[136:139], a[0:3], v[36:39]
s_waitcnt lgkmcnt(6)
s_add_u32 m0, s28, 0
ds_read_b64_tr_b16 a[128:129], v6 offset:0
v_mfma_f32_16x16x32_bf16 v[36:39], a[140:143], a[4:7], v[36:39]
buffer_load_dwordx4 v12, s[8:11], s24 offen offset:0 lds
v_mfma_f32_16x16x32_bf16 v[44:47], a[136:139], a[8:11], v[44:47]
ds_read_b64_tr_b16 a[130:131], v6 offset:2048
v_mfma_f32_16x16x32_bf16 v[44:47], a[140:143], a[12:15], v[44:47]
ds_read_b128 a[188:191], v23 offset:3072
v_mfma_f32_16x16x32_bf16 v[52:55], a[136:139], a[16:19], v[52:55]
ds_read_b64_tr_b16 a[132:133], v6 offset:16384
v_bfe_u32 v231, v1, 4, 5
v_mfma_f32_16x16x32_bf16 v[52:55], a[140:143], a[20:23], v[52:55]
buffer_load_dwordx4 v13, s[8:11], s24 offen offset:1024 lds
v_mfma_f32_16x16x32_bf16 v[60:63], a[136:139], a[24:27], v[60:63]
ds_read_b64_tr_b16 a[134:135], v6 offset:18432
v_lshlrev_b32 v231, 2, v231
v_mfma_f32_16x16x32_bf16 v[60:63], a[140:143], a[28:31], v[60:63]
v_lshlrev_b32 v229, 3, v1
v_min_u32 v229, 4096, v229
v_mfma_f32_16x16x32_bf16 v[68:71], a[136:139], a[32:35], v[68:71]
ds_read_b128 a[76:79], v3 offset:34816
v_mfma_f32_16x16x32_bf16 v[68:71], a[140:143], a[36:39], v[68:71]
buffer_load_dwordx4 v14, s[8:11], s24 offen offset:2048 lds
v_mfma_f32_16x16x32_bf16 v[76:79], a[136:139], a[40:43], v[76:79]
v_mfma_f32_16x16x32_bf16 v[76:79], a[140:143], a[44:47], v[76:79]
v_mfma_f32_16x16x32_bf16 v[84:87], a[136:139], a[48:51], v[84:87]
ds_read_b128 a[80:83], v2 offset:36864
v_mfma_f32_16x16x32_bf16 v[84:87], a[140:143], a[52:55], v[84:87]
buffer_load_dwordx4 v15, s[8:11], s24 offen offset:3072 lds
v_mfma_f32_16x16x32_bf16 v[92:95], a[136:139], a[56:59], v[92:95]
s_add_u32 s24, s24, 128
ds_read_b128 a[84:87], v3 offset:36864
v_mfma_f32_16x16x32_bf16 v[92:95], a[140:143], a[60:63], v[92:95]
s_waitcnt lgkmcnt(6)
v_mfma_f32_16x16x32_bf16 v[96:99], a[128:131], a[0:3], v[96:99]
s_waitcnt lgkmcnt(3)
s_add_u32 m0, s28, 4096
ds_read_b64_tr_b16 a[136:137], v7 offset:0
v_mfma_f32_16x16x32_bf16 v[96:99], a[132:135], a[4:7], v[96:99]
buffer_load_dwordx4 v12, s[8:11], s25 offen offset:0 lds
v_mfma_f32_16x16x32_bf16 v[104:107], a[128:131], a[8:11], v[104:107]
ds_read_b64_tr_b16 a[138:139], v7 offset:2048
v_mfma_f32_16x16x32_bf16 v[104:107], a[132:135], a[12:15], v[104:107]
v_mfma_f32_16x16x32_bf16 v[112:115], a[128:131], a[16:19], v[112:115]
ds_read_b64_tr_b16 a[140:141], v7 offset:16384
v_mfma_f32_16x16x32_bf16 v[112:115], a[132:135], a[20:23], v[112:115]
buffer_load_dwordx4 v13, s[8:11], s25 offen offset:1024 lds
v_mfma_f32_16x16x32_bf16 v[120:123], a[128:131], a[24:27], v[120:123]
ds_read_b64_tr_b16 a[142:143], v7 offset:18432
v_mfma_f32_16x16x32_bf16 v[120:123], a[132:135], a[28:31], v[120:123]
v_mfma_f32_16x16x32_bf16 v[128:131], a[128:131], a[32:35], v[128:131]
v_mfma_f32_16x16x32_bf16 v[128:131], a[132:135], a[36:39], v[128:131]
buffer_load_dwordx4 v14, s[8:11], s25 offen offset:2048 lds
v_mfma_f32_16x16x32_bf16 v[136:139], a[128:131], a[40:43], v[136:139]
ds_read_b128 a[88:91], v2 offset:38912
v_mfma_f32_16x16x32_bf16 v[136:139], a[132:135], a[44:47], v[136:139]
v_mfma_f32_16x16x32_bf16 v[144:147], a[128:131], a[48:51], v[144:147]
ds_read_b128 a[92:95], v3 offset:38912
v_mfma_f32_16x16x32_bf16 v[144:147], a[132:135], a[52:55], v[144:147]
buffer_load_dwordx4 v15, s[8:11], s25 offen offset:3072 lds
v_mfma_f32_16x16x32_bf16 v[152:155], a[128:131], a[56:59], v[152:155]
s_add_u32 s25, s25, 128
v_mfma_f32_16x16x32_bf16 v[152:155], a[132:135], a[60:63], v[152:155]
s_waitcnt lgkmcnt(4)
v_mfma_f32_16x16x32_bf16 v[100:103], a[136:139], a[0:3], v[100:103]
s_waitcnt lgkmcnt(2)
ds_read_b64_tr_b16 a[128:129], v8 offset:0
v_mfma_f32_16x16x32_bf16 v[100:103], a[140:143], a[4:7], v[100:103]
buffer_store_dwordx4 a[176:179], v224, s[4:7], s56 offen sc1
v_mfma_f32_16x16x32_bf16 v[108:111], a[136:139], a[8:11], v[108:111]
s_add_u32 s56, s56, 33792
ds_read_b64_tr_b16 a[130:131], v8 offset:2048
v_mfma_f32_16x16x32_bf16 v[108:111], a[140:143], a[12:15], v[108:111]
v_mfma_f32_16x16x32_bf16 v[116:119], a[136:139], a[16:19], v[116:119]
ds_read_b64_tr_b16 a[132:133], v8 offset:16384
v_mfma_f32_16x16x32_bf16 v[116:119], a[140:143], a[20:23], v[116:119]
v_mfma_f32_16x16x32_bf16 v[124:127], a[136:139], a[24:27], v[124:127]
s_cmp_lt_u32 s21, 0
ds_read_b64_tr_b16 a[134:135], v8 offset:18432
v_mfma_f32_16x16x32_bf16 v[124:127], a[140:143], a[28:31], v[124:127]
s_cselect_b32 s53, s53, 3221225472
v_mfma_f32_16x16x32_bf16 v[132:135], a[136:139], a[32:35], v[132:135]
s_cselect_b32 s49, s49, 3221225472
ds_read_b128 a[96:99], v2 offset:40960
v_mfma_f32_16x16x32_bf16 v[132:135], a[140:143], a[36:39], v[132:135]
s_add_u32 s48, s53, 2097152
v_mfma_f32_16x16x32_bf16 v[140:143], a[136:139], a[40:43], v[140:143]
v_mfma_f32_16x16x32_bf16 v[140:143], a[140:143], a[44:47], v[140:143]
v_mfma_f32_16x16x32_bf16 v[148:151], a[136:139], a[48:51], v[148:151]
ds_read_b128 a[100:103], v3 offset:40960
v_mfma_f32_16x16x32_bf16 v[148:151], a[140:143], a[52:55], v[148:151]
v_mfma_f32_16x16x32_bf16 v[156:159], a[136:139], a[56:59], v[156:159]
ds_read_b128 a[104:107], v2 offset:43008
v_mfma_f32_16x16x32_bf16 v[156:159], a[140:143], a[60:63], v[156:159]
s_waitcnt lgkmcnt(5)
v_mfma_f32_16x16x32_bf16 v[160:163], a[128:131], a[0:3], v[160:163]
s_waitcnt lgkmcnt(3)
ds_read_b64_tr_b16 a[136:137], v9 offset:0
v_mfma_f32_16x16x32_bf16 v[160:163], a[132:135], a[4:7], v[160:163]
v_mfma_f32_16x16x32_bf16 v[168:171], a[128:131], a[8:11], v[168:171]
ds_read_b64_tr_b16 a[138:139], v9 offset:2048
v_mfma_f32_16x16x32_bf16 v[168:171], a[132:135], a[12:15], v[168:171]
buffer_store_dwordx4 a[180:183], v224, s[4:7], s56 offen sc1
v_mfma_f32_16x16x32_bf16 v[176:179], a[128:131], a[16:19], v[176:179]
s_add_u32 s56, s56, 33792
ds_read_b64_tr_b16 a[140:141], v9 offset:16384
v_mfma_f32_16x16x32_bf16 v[176:179], a[132:135], a[20:23], v[176:179]
v_mfma_f32_16x16x32_bf16 v[184:187], a[128:131], a[24:27], v[184:187]
ds_read_b64_tr_b16 a[142:143], v9 offset:18432
v_mfma_f32_16x16x32_bf16 v[184:187], a[132:135], a[28:31], v[184:187]
v_mfma_f32_16x16x32_bf16 v[192:195], a[128:131], a[32:35], v[192:195]
v_mfma_f32_16x16x32_bf16 v[192:195], a[132:135], a[36:39], v[192:195]
v_mfma_f32_16x16x32_bf16 v[200:203], a[128:131], a[40:43], v[200:203]
ds_read_b128 a[108:111], v3 offset:43008
v_mfma_f32_16x16x32_bf16 v[200:203], a[132:135], a[44:47], v[200:203]
v_mfma_f32_16x16x32_bf16 v[208:211], a[128:131], a[48:51], v[208:211]
ds_read_b128 a[112:115], v2 offset:45056
v_mfma_f32_16x16x32_bf16 v[208:211], a[132:135], a[52:55], v[208:211]
v_mfma_f32_16x16x32_bf16 v[216:219], a[128:131], a[56:59], v[216:219]
v_mfma_f32_16x16x32_bf16 v[216:219], a[132:135], a[60:63], v[216:219]
s_waitcnt lgkmcnt(4)
v_mfma_f32_16x16x32_bf16 v[164:167], a[136:139], a[0:3], v[164:167]
s_waitcnt lgkmcnt(2)
ds_read_b64_tr_b16 a[128:129], v10 offset:0
v_mfma_f32_16x16x32_bf16 v[164:167], a[140:143], a[4:7], v[164:167]
v_mfma_f32_16x16x32_bf16 v[172:175], a[136:139], a[8:11], v[172:175]
ds_read_b64_tr_b16 a[130:131], v10 offset:2048
v_mfma_f32_16x16x32_bf16 v[172:175], a[140:143], a[12:15], v[172:175]
v_mfma_f32_16x16x32_bf16 v[180:183], a[136:139], a[16:19], v[180:183]
ds_read_b64_tr_b16 a[132:133], v10 offset:16384
v_mfma_f32_16x16x32_bf16 v[180:183], a[140:143], a[20:23], v[180:183]
buffer_store_dwordx4 a[184:187], v224, s[4:7], s56 offen sc1
v_mfma_f32_16x16x32_bf16 v[188:191], a[136:139], a[24:27], v[188:191]
s_add_u32 s56, s56, 33792
ds_read_b64_tr_b16 a[134:135], v10 offset:18432
v_mfma_f32_16x16x32_bf16 v[188:191], a[140:143], a[28:31], v[188:191]
v_mfma_f32_16x16x32_bf16 v[196:199], a[136:139], a[32:35], v[196:199]
ds_read_b128 a[116:119], v3 offset:45056
v_mfma_f32_16x16x32_bf16 v[196:199], a[140:143], a[36:39], v[196:199]
v_mfma_f32_16x16x32_bf16 v[204:207], a[136:139], a[40:43], v[204:207]
ds_read_b128 a[120:123], v2 offset:47104
v_mfma_f32_16x16x32_bf16 v[204:207], a[140:143], a[44:47], v[204:207]
v_mfma_f32_16x16x32_bf16 v[212:215], a[136:139], a[48:51], v[212:215]
v_mfma_f32_16x16x32_bf16 v[212:215], a[140:143], a[52:55], v[212:215]
v_mfma_f32_16x16x32_bf16 v[220:223], a[136:139], a[56:59], v[220:223]
ds_read_b128 a[124:127], v3 offset:47104
v_mfma_f32_16x16x32_bf16 v[220:223], a[140:143], a[60:63], v[220:223]
s_waitcnt lgkmcnt(5)
v_mfma_f32_16x16x32_bf16 a[192:195], a[128:131], a[0:3], a[192:195]
s_waitcnt lgkmcnt(3)
ds_read_b64_tr_b16 a[136:137], v11 offset:0
v_mfma_f32_16x16x32_bf16 a[192:195], a[132:135], a[4:7], a[192:195]
v_mfma_f32_16x16x32_bf16 a[200:203], a[128:131], a[8:11], a[200:203]
ds_read_b64_tr_b16 a[138:139], v11 offset:2048
v_mfma_f32_16x16x32_bf16 a[200:203], a[132:135], a[12:15], a[200:203]
v_mfma_f32_16x16x32_bf16 a[208:211], a[128:131], a[16:19], a[208:211]
ds_read_b64_tr_b16 a[140:141], v11 offset:16384
v_mfma_f32_16x16x32_bf16 a[208:211], a[132:135], a[20:23], a[208:211]
v_mfma_f32_16x16x32_bf16 a[216:219], a[128:131], a[24:27], a[216:219]
ds_read_b64_tr_b16 a[142:143], v11 offset:18432
v_mfma_f32_16x16x32_bf16 a[216:219], a[132:135], a[28:31], a[216:219]
buffer_store_dwordx4 a[188:191], v224, s[4:7], s56 offen sc1
v_mfma_f32_16x16x32_bf16 a[224:227], a[128:131], a[32:35], a[224:227]
s_add_u32 s56, s56, 33792
v_mfma_f32_16x16x32_bf16 a[224:227], a[132:135], a[36:39], a[224:227]
v_mfma_f32_16x16x32_bf16 a[232:235], a[128:131], a[40:43], a[232:235]
v_mfma_f32_16x16x32_bf16 a[232:235], a[132:135], a[44:47], a[232:235]
v_mfma_f32_16x16x32_bf16 a[240:243], a[128:131], a[48:51], a[240:243]
v_mfma_f32_16x16x32_bf16 a[240:243], a[132:135], a[52:55], a[240:243]
v_mfma_f32_16x16x32_bf16 a[248:251], a[128:131], a[56:59], a[248:251]
v_mfma_f32_16x16x32_bf16 a[248:251], a[132:135], a[60:63], a[248:251]
s_waitcnt vmcnt(4) lgkmcnt(0)
s_barrier
v_mfma_f32_16x16x32_bf16 a[196:199], a[136:139], a[0:3], a[196:199]
s_add_u32 m0, s29, 65536
ds_read_b64_tr_b16 a[128:129], v4 offset:32768
v_mfma_f32_16x16x32_bf16 a[196:199], a[140:143], a[4:7], a[196:199]
buffer_load_dwordx4 v16, s[12:15], s26 offen offset:0 lds
v_mfma_f32_16x16x32_bf16 a[204:207], a[136:139], a[8:11], a[204:207]
ds_read_b64_tr_b16 a[130:131], v4 offset:34816
v_cmp_gt_u32 vcc, 0x100, v245
v_mfma_f32_16x16x32_bf16 a[204:207], a[140:143], a[12:15], a[204:207]
v_mfma_f32_16x16x32_bf16 a[212:215], a[136:139], a[16:19], a[212:215]
ds_read_b64_tr_b16 a[132:133], v4 offset:49152
v_mfma_f32_16x16x32_bf16 a[212:215], a[140:143], a[20:23], a[212:215]
buffer_load_dwordx4 v17, s[12:15], s26 offen offset:1024 lds
v_mfma_f32_16x16x32_bf16 a[220:223], a[136:139], a[24:27], a[220:223]
ds_read_b64_tr_b16 a[134:135], v4 offset:51200
v_mfma_f32_16x16x32_bf16 a[220:223], a[140:143], a[28:31], a[220:223]
v_mfma_f32_16x16x32_bf16 a[228:231], a[136:139], a[32:35], a[228:231]
v_mfma_f32_16x16x32_bf16 a[228:231], a[140:143], a[36:39], a[228:231]
buffer_load_dwordx4 v18, s[12:15], s26 offen offset:2048 lds
v_mfma_f32_16x16x32_bf16 a[236:239], a[136:139], a[40:43], a[236:239]
v_mfma_f32_16x16x32_bf16 a[236:239], a[140:143], a[44:47], a[236:239]
v_mfma_f32_16x16x32_bf16 a[244:247], a[136:139], a[48:51], a[244:247]
v_mfma_f32_16x16x32_bf16 a[244:247], a[140:143], a[52:55], a[244:247]
buffer_load_dwordx4 v19, s[12:15], s26 offen offset:3072 lds
v_mfma_f32_16x16x32_bf16 a[252:255], a[136:139], a[56:59], a[252:255]
s_add_u32 s26, s26, 524288
v_mfma_f32_16x16x32_bf16 a[252:255], a[140:143], a[60:63], a[252:255]
s_waitcnt lgkmcnt(2)
s_mov_b32 s82, s59
s_cbranch_vccnz M_cntspinK
s_branch Lg_1
Lg_1t:
buffer_load_dword v230, v231, s[4:7], s52 offen sc1
v_mfma_f32_16x16x32_bf16 v[32:35], a[128:131], a[64:67], v[32:35]
s_waitcnt lgkmcnt(0)
s_add_u32 m0, s29, 81920
ds_read_b64_tr_b16 a[136:137], v5 offset:32768
v_mfma_f32_16x16x32_bf16 v[32:35], a[132:135], a[68:71], v[32:35]
buffer_load_dwordx4 v16, s[12:15], s27 offen offset:0 lds
v_mfma_f32_16x16x32_bf16 v[40:43], a[128:131], a[72:75], v[40:43]
s_and_b32 s44, s3, 1
ds_read_b64_tr_b16 a[138:139], v5 offset:34816
v_mfma_f32_16x16x32_bf16 v[40:43], a[132:135], a[76:79], v[40:43]
s_lshl_b32 s44, s44, 8
v_mfma_f32_16x16x32_bf16 v[48:51], a[128:131], a[80:83], v[48:51]
s_lshl_b32 s45, s3, 7
ds_read_b64_tr_b16 a[140:141], v5 offset:49152
v_mfma_f32_16x16x32_bf16 v[48:51], a[132:135], a[84:87], v[48:51]
s_xor_b32 s44, s44, s45
buffer_load_dwordx4 v17, s[12:15], s27 offen offset:1024 lds
v_mfma_f32_16x16x32_bf16 v[56:59], a[128:131], a[88:91], v[56:59]
s_xor_b32 s44, s44, 196608
ds_read_b64_tr_b16 a[142:143], v5 offset:51200
v_mfma_f32_16x16x32_bf16 v[56:59], a[132:135], a[92:95], v[56:59]
v_mfma_f32_16x16x32_bf16 v[64:67], a[128:131], a[96:99], v[64:67]
ds_read_b128 a[0:3], v2 offset:0
v_mfma_f32_16x16x32_bf16 v[64:67], a[132:135], a[100:103], v[64:67]
buffer_load_dwordx4 v18, s[12:15], s27 offen offset:2048 lds
v_mfma_f32_16x16x32_bf16 v[72:75], a[128:131], a[104:107], v[72:75]
ds_read_b128 a[4:7], v3 offset:0
v_mfma_f32_16x16x32_bf16 v[72:75], a[132:135], a[108:111], v[72:75]
v_mfma_f32_16x16x32_bf16 v[80:83], a[128:131], a[112:115], v[80:83]
v_mfma_f32_16x16x32_bf16 v[80:83], a[132:135], a[116:119], v[80:83]
buffer_load_dwordx4 v19, s[12:15], s27 offen offset:3072 lds
v_mfma_f32_16x16x32_bf16 v[88:91], a[128:131], a[120:123], v[88:91]
s_add_u32 s27, s27, 524288
ds_read_b128 a[8:11], v2 offset:2048
v_mfma_f32_16x16x32_bf16 v[88:91], a[132:135], a[124:127], v[88:91]
s_waitcnt lgkmcnt(5)
v_mfma_f32_16x16x32_bf16 v[36:39], a[136:139], a[64:67], v[36:39]
s_waitcnt lgkmcnt(3)
s_add_u32 m0, s28, 32768
ds_read_b64_tr_b16 a[128:129], v6 offset:32768
v_mfma_f32_16x16x32_bf16 v[36:39], a[140:143], a[68:71], v[36:39]
buffer_load_dwordx4 v12, s[8:11], s24 offen offset:0 lds
v_mfma_f32_16x16x32_bf16 v[44:47], a[136:139], a[72:75], v[44:47]
ds_read_b64_tr_b16 a[130:131], v6 offset:34816
v_mfma_f32_16x16x32_bf16 v[44:47], a[140:143], a[76:79], v[44:47]
v_mfma_f32_16x16x32_bf16 v[52:55], a[136:139], a[80:83], v[52:55]
s_mov_b64 s[56:57], s[72:73]
ds_read_b64_tr_b16 a[132:133], v6 offset:49152
v_mfma_f32_16x16x32_bf16 v[52:55], a[140:143], a[84:87], v[52:55]
s_mov_b32 s58, 1835008
buffer_load_dwordx4 v13, s[8:11], s24 offen offset:1024 lds
v_mfma_f32_16x16x32_bf16 v[60:63], a[136:139], a[88:91], v[60:63]
s_mov_b32 s59, 0x20000
ds_read_b64_tr_b16 a[134:135], v6 offset:51200
v_mfma_f32_16x16x32_bf16 v[60:63], a[140:143], a[92:95], v[60:63]
v_mfma_f32_16x16x32_bf16 v[68:71], a[136:139], a[96:99], v[68:71]
ds_read_b128 a[12:15], v3 offset:2048
v_mfma_f32_16x16x32_bf16 v[68:71], a[140:143], a[100:103], v[68:71]
buffer_load_dwordx4 v14, s[8:11], s24 offen offset:2048 lds
v_mfma_f32_16x16x32_bf16 v[76:79], a[136:139], a[104:107], v[76:79]
v_mfma_f32_16x16x32_bf16 v[76:79], a[140:143], a[108:111], v[76:79]
v_mfma_f32_16x16x32_bf16 v[84:87], a[136:139], a[112:115], v[84:87]
ds_read_b128 a[16:19], v2 offset:4096
v_mfma_f32_16x16x32_bf16 v[84:87], a[140:143], a[116:119], v[84:87]
buffer_load_dwordx4 v15, s[8:11], s24 offen offset:3072 lds
v_mfma_f32_16x16x32_bf16 v[92:95], a[136:139], a[120:123], v[92:95]
s_add_u32 s24, s24, 128
ds_read_b128 a[20:23], v3 offset:4096
v_mfma_f32_16x16x32_bf16 v[92:95], a[140:143], a[124:127], v[92:95]
s_waitcnt lgkmcnt(5)
v_mfma_f32_16x16x32_bf16 v[96:99], a[128:131], a[64:67], v[96:99]
s_waitcnt lgkmcnt(3)
s_add_u32 m0, s28, 36864
ds_read_b64_tr_b16 a[136:137], v7 offset:32768
v_mfma_f32_16x16x32_bf16 v[96:99], a[132:135], a[68:71], v[96:99]
buffer_load_dwordx4 v12, s[8:11], s25 offen offset:0 lds
v_mfma_f32_16x16x32_bf16 v[104:107], a[128:131], a[72:75], v[104:107]
ds_read_b64_tr_b16 a[138:139], v7 offset:34816
v_mfma_f32_16x16x32_bf16 v[104:107], a[132:135], a[76:79], v[104:107]
v_mfma_f32_16x16x32_bf16 v[112:115], a[128:131], a[80:83], v[112:115]
ds_read_b64_tr_b16 a[140:141], v7 offset:49152
v_mfma_f32_16x16x32_bf16 v[112:115], a[132:135], a[84:87], v[112:115]
buffer_load_dwordx4 v13, s[8:11], s25 offen offset:1024 lds
v_mfma_f32_16x16x32_bf16 v[120:123], a[128:131], a[88:91], v[120:123]
ds_read_b64_tr_b16 a[142:143], v7 offset:51200
v_mfma_f32_16x16x32_bf16 v[120:123], a[132:135], a[92:95], v[120:123]
v_mfma_f32_16x16x32_bf16 v[128:131], a[128:131], a[96:99], v[128:131]
v_mfma_f32_16x16x32_bf16 v[128:131], a[132:135], a[100:103], v[128:131]
buffer_load_dwordx4 v14, s[8:11], s25 offen offset:2048 lds
v_mfma_f32_16x16x32_bf16 v[136:139], a[128:131], a[104:107], v[136:139]
ds_read_b128 a[24:27], v2 offset:6144
v_mfma_f32_16x16x32_bf16 v[136:139], a[132:135], a[108:111], v[136:139]
v_mfma_f32_16x16x32_bf16 v[144:147], a[128:131], a[112:115], v[144:147]
ds_read_b128 a[28:31], v3 offset:6144
v_mfma_f32_16x16x32_bf16 v[144:147], a[132:135], a[116:119], v[144:147]
buffer_load_dwordx4 v15, s[8:11], s25 offen offset:3072 lds
v_mfma_f32_16x16x32_bf16 v[152:155], a[128:131], a[120:123], v[152:155]
s_add_u32 s25, s25, 128
s_waitcnt vmcnt(12)
v_mfma_f32_16x16x32_bf16 v[152:155], a[132:135], a[124:127], v[152:155]
s_waitcnt lgkmcnt(4)
v_cmp_gt_u32 vcc, 1, v230
v_mfma_f32_16x16x32_bf16 v[100:103], a[136:139], a[64:67], v[100:103]
s_waitcnt lgkmcnt(2)
s_cbranch_vccnz M_ppspinK
M_ppokK:
ds_read_b64_tr_b16 a[128:129], v8 offset:32768
v_mfma_f32_16x16x32_bf16 v[100:103], a[140:143], a[68:71], v[100:103]
buffer_load_dword v230, v229, s[4:7], s53 offen sc1
v_mfma_f32_16x16x32_bf16 v[108:111], a[136:139], a[72:75], v[108:111]
s_mov_b64 s[8:9], s[76:77]
ds_read_b64_tr_b16 a[130:131], v8 offset:34816
v_mfma_f32_16x16x32_bf16 v[108:111], a[140:143], a[76:79], v[108:111]
s_mov_b32 s10, 1835008
buffer_load_dword v230, v229, s[4:7], s48 offen sc1
v_mfma_f32_16x16x32_bf16 v[116:119], a[136:139], a[80:83], v[116:119]
s_lshl_b32 s24, s37, 2
ds_read_b64_tr_b16 a[132:133], v8 offset:49152
v_mfma_f32_16x16x32_bf16 v[116:119], a[140:143], a[84:87], v[116:119]
s_add_u32 s24, s24, s3
buffer_load_dword v230, v229, s[56:59], s49 offen
v_mfma_f32_16x16x32_bf16 v[124:127], a[136:139], a[88:91], v[124:127]
s_mul_i32 s24, s24, 28672
ds_read_b64_tr_b16 a[134:135], v8 offset:51200
v_mfma_f32_16x16x32_bf16 v[124:127], a[140:143], a[92:95], v[124:127]
s_mov_b32 s28, s29
buffer_load_dword v21, v20, s[16:19], s43 offen
v_mfma_f32_16x16x32_bf16 v[132:135], a[136:139], a[96:99], v[132:135]
ds_read_b128 a[32:35], v2 offset:8192
v_mfma_f32_16x16x32_bf16 v[132:135], a[140:143], a[100:103], v[132:135]
v_mfma_f32_16x16x32_bf16 v[140:143], a[136:139], a[104:107], v[140:143]
v_mfma_f32_16x16x32_bf16 v[140:143], a[140:143], a[108:111], v[140:143]
v_mfma_f32_16x16x32_bf16 v[148:151], a[136:139], a[112:115], v[148:151]
ds_read_b128 a[36:39], v3 offset:8192
v_lshrrev_b32 v28, 7, v1
v_mfma_f32_16x16x32_bf16 v[148:151], a[140:143], a[116:119], v[148:151]
v_lshrrev_b32 v29, 1, v28
v_lshlrev_b32 v29, 4, v29
v_mfma_f32_16x16x32_bf16 v[156:159], a[136:139], a[120:123], v[156:159]
ds_read_b128 a[40:43], v2 offset:10240
v_and_b32 v30, 0x70, v1
v_mfma_f32_16x16x32_bf16 v[156:159], a[140:143], a[124:127], v[156:159]
s_waitcnt lgkmcnt(5)
v_xor_b32 v29, v29, v30
v_mul_u32_u24 v28, 896, v28
v_mfma_f32_16x16x32_bf16 v[160:163], a[128:131], a[64:67], v[160:163]
s_waitcnt lgkmcnt(3)
ds_read_b64_tr_b16 a[136:137], v9 offset:32768
v_add_u32 v12, v28, v29
v_mfma_f32_16x16x32_bf16 v[160:163], a[132:135], a[68:71], v[160:163]
v_xor_b32 v29, 64, v29
v_add_u32 v28, v28, v29
v_mfma_f32_16x16x32_bf16 v[168:171], a[128:131], a[72:75], v[168:171]
ds_read_b64_tr_b16 a[138:139], v9 offset:34816
v_add_u32 v13, 6144, v28
v_mfma_f32_16x16x32_bf16 v[168:171], a[132:135], a[76:79], v[168:171]
v_add_u32 v14, 12288, v12
v_add_u32 v15, 18432, v28
v_mfma_f32_16x16x32_bf16 v[176:179], a[128:131], a[80:83], v[176:179]
ds_read_b64_tr_b16 a[140:141], v9 offset:49152
v_xor_b32 v22, s44, v4
v_mfma_f32_16x16x32_bf16 v[176:179], a[132:135], a[84:87], v[176:179]
v_xor_b32 v23, 32, v22
v_xor_b32 v24, 64, v22
v_mfma_f32_16x16x32_bf16 v[184:187], a[128:131], a[88:91], v[184:187]
ds_read_b64_tr_b16 a[142:143], v9 offset:51200
v_xor_b32 v25, 96, v22
v_mfma_f32_16x16x32_bf16 v[184:187], a[132:135], a[92:95], v[184:187]
v_mfma_f32_16x16x32_bf16 v[192:195], a[128:131], a[96:99], v[192:195]
v_mfma_f32_16x16x32_bf16 v[192:195], a[132:135], a[100:103], v[192:195]
v_mfma_f32_16x16x32_bf16 v[200:203], a[128:131], a[104:107], v[200:203]
ds_read_b128 a[44:47], v3 offset:10240
v_mfma_f32_16x16x32_bf16 v[200:203], a[132:135], a[108:111], v[200:203]
v_mfma_f32_16x16x32_bf16 v[208:211], a[128:131], a[112:115], v[208:211]
ds_read_b128 a[48:51], v2 offset:12288
v_mfma_f32_16x16x32_bf16 v[208:211], a[132:135], a[116:119], v[208:211]
v_mfma_f32_16x16x32_bf16 v[216:219], a[128:131], a[120:123], v[216:219]
v_mfma_f32_16x16x32_bf16 v[216:219], a[132:135], a[124:127], v[216:219]
s_waitcnt lgkmcnt(4)
v_mfma_f32_16x16x32_bf16 v[164:167], a[136:139], a[64:67], v[164:167]
s_waitcnt lgkmcnt(2)
ds_read_b64_tr_b16 a[128:129], v10 offset:32768
v_mfma_f32_16x16x32_bf16 v[164:167], a[140:143], a[68:71], v[164:167]
v_mfma_f32_16x16x32_bf16 v[172:175], a[136:139], a[72:75], v[172:175]
ds_read_b64_tr_b16 a[130:131], v10 offset:34816
v_mfma_f32_16x16x32_bf16 v[172:175], a[140:143], a[76:79], v[172:175]
v_mfma_f32_16x16x32_bf16 v[180:183], a[136:139], a[80:83], v[180:183]
ds_read_b64_tr_b16 a[132:133], v10 offset:49152
v_mfma_f32_16x16x32_bf16 v[180:183], a[140:143], a[84:87], v[180:183]
v_mfma_f32_16x16x32_bf16 v[188:191], a[136:139], a[88:91], v[188:191]
ds_read_b64_tr_b16 a[134:135], v10 offset:51200
v_mfma_f32_16x16x32_bf16 v[188:191], a[140:143], a[92:95], v[188:191]
v_mfma_f32_16x16x32_bf16 v[196:199], a[136:139], a[96:99], v[196:199]
ds_read_b128 a[52:55], v3 offset:12288
v_mfma_f32_16x16x32_bf16 v[196:199], a[140:143], a[100:103], v[196:199]
v_mfma_f32_16x16x32_bf16 v[204:207], a[136:139], a[104:107], v[204:207]
ds_read_b128 a[56:59], v2 offset:14336
v_mfma_f32_16x16x32_bf16 v[204:207], a[140:143], a[108:111], v[204:207]
v_mfma_f32_16x16x32_bf16 v[212:215], a[136:139], a[112:115], v[212:215]
v_mfma_f32_16x16x32_bf16 v[212:215], a[140:143], a[116:119], v[212:215]
v_mfma_f32_16x16x32_bf16 v[220:223], a[136:139], a[120:123], v[220:223]
ds_read_b128 a[60:63], v3 offset:14336
v_mfma_f32_16x16x32_bf16 v[220:223], a[140:143], a[124:127], v[220:223]
s_waitcnt lgkmcnt(5)
v_mfma_f32_16x16x32_bf16 a[192:195], a[128:131], a[64:67], a[192:195]
s_waitcnt lgkmcnt(3)
ds_read_b64_tr_b16 a[136:137], v11 offset:32768
v_mfma_f32_16x16x32_bf16 a[192:195], a[132:135], a[68:71], a[192:195]
v_mfma_f32_16x16x32_bf16 a[200:203], a[128:131], a[72:75], a[200:203]
ds_read_b64_tr_b16 a[138:139], v11 offset:34816
v_mfma_f32_16x16x32_bf16 a[200:203], a[132:135], a[76:79], a[200:203]
v_mfma_f32_16x16x32_bf16 a[208:211], a[128:131], a[80:83], a[208:211]
ds_read_b64_tr_b16 a[140:141], v11 offset:49152
v_mfma_f32_16x16x32_bf16 a[208:211], a[132:135], a[84:87], a[208:211]
v_mfma_f32_16x16x32_bf16 a[216:219], a[128:131], a[88:91], a[216:219]
ds_read_b64_tr_b16 a[142:143], v11 offset:51200
v_mfma_f32_16x16x32_bf16 a[216:219], a[132:135], a[92:95], a[216:219]
v_mfma_f32_16x16x32_bf16 a[224:227], a[128:131], a[96:99], a[224:227]
v_mfma_f32_16x16x32_bf16 a[224:227], a[132:135], a[100:103], a[224:227]
v_mfma_f32_16x16x32_bf16 a[232:235], a[128:131], a[104:107], a[232:235]
v_mfma_f32_16x16x32_bf16 a[232:235], a[132:135], a[108:111], a[232:235]
v_mfma_f32_16x16x32_bf16 a[240:243], a[128:131], a[112:115], a[240:243]
v_mfma_f32_16x16x32_bf16 a[240:243], a[132:135], a[116:119], a[240:243]
v_mfma_f32_16x16x32_bf16 a[248:251], a[128:131], a[120:123], a[248:251]
v_mfma_f32_16x16x32_bf16 a[248:251], a[132:135], a[124:127], a[248:251]
s_waitcnt vmcnt(4) lgkmcnt(0)
s_barrier
v_mfma_f32_16x16x32_bf16 a[196:199], a[136:139], a[64:67], a[196:199]
s_add_u32 m0, s29, 98304
ds_read_b64_tr_b16 a[128:129], v4 offset:0
v_mfma_f32_16x16x32_bf16 a[196:199], a[140:143], a[68:71], a[196:199]
buffer_load_dwordx4 v16, s[12:15], s26 offen offset:0 lds
v_mfma_f32_16x16x32_bf16 a[204:207], a[136:139], a[72:75], a[204:207]
ds_read_b64_tr_b16 a[130:131], v4 offset:2048
v_mfma_f32_16x16x32_bf16 a[204:207], a[140:143], a[76:79], a[204:207]
v_mfma_f32_16x16x32_bf16 a[212:215], a[136:139], a[80:83], a[212:215]
ds_read_b64_tr_b16 a[132:133], v4 offset:16384
v_mfma_f32_16x16x32_bf16 a[212:215], a[140:143], a[84:87], a[212:215]
buffer_load_dwordx4 v17, s[12:15], s26 offen offset:1024 lds
v_mfma_f32_16x16x32_bf16 a[220:223], a[136:139], a[88:91], a[220:223]
ds_read_b64_tr_b16 a[134:135], v4 offset:18432
v_mfma_f32_16x16x32_bf16 a[220:223], a[140:143], a[92:95], a[220:223]
v_mfma_f32_16x16x32_bf16 a[228:231], a[136:139], a[96:99], a[228:231]
v_mfma_f32_16x16x32_bf16 a[228:231], a[140:143], a[100:103], a[228:231]
buffer_load_dwordx4 v18, s[12:15], s26 offen offset:2048 lds
v_mfma_f32_16x16x32_bf16 a[236:239], a[136:139], a[104:107], a[236:239]
v_mfma_f32_16x16x32_bf16 a[236:239], a[140:143], a[108:111], a[236:239]
v_mfma_f32_16x16x32_bf16 a[244:247], a[136:139], a[112:115], a[244:247]
v_mfma_f32_16x16x32_bf16 a[244:247], a[140:143], a[116:119], a[244:247]
buffer_load_dwordx4 v19, s[12:15], s26 offen offset:3072 lds
v_mfma_f32_16x16x32_bf16 a[252:255], a[136:139], a[120:123], a[252:255]
s_add_u32 s26, s26, 524288
v_mfma_f32_16x16x32_bf16 a[252:255], a[140:143], a[124:127], a[252:255]
s_waitcnt lgkmcnt(2)
v_mfma_f32_16x16x32_bf16 v[32:35], a[128:131], a[0:3], v[32:35]
s_waitcnt lgkmcnt(0)
s_add_u32 m0, s29, 114688
ds_read_b64_tr_b16 a[136:137], v5 offset:0
v_mfma_f32_16x16x32_bf16 v[32:35], a[132:135], a[4:7], v[32:35]
buffer_load_dwordx4 v16, s[12:15], s27 offen offset:0 lds
v_mfma_f32_16x16x32_bf16 v[40:43], a[128:131], a[8:11], v[40:43]
ds_read_b64_tr_b16 a[138:139], v5 offset:2048
v_mfma_f32_16x16x32_bf16 v[40:43], a[132:135], a[12:15], v[40:43]
v_mfma_f32_16x16x32_bf16 v[48:51], a[128:131], a[16:19], v[48:51]
ds_read_b64_tr_b16 a[140:141], v5 offset:16384
v_mfma_f32_16x16x32_bf16 v[48:51], a[132:135], a[20:23], v[48:51]
buffer_load_dwordx4 v17, s[12:15], s27 offen offset:1024 lds
v_mfma_f32_16x16x32_bf16 v[56:59], a[128:131], a[24:27], v[56:59]
ds_read_b64_tr_b16 a[142:143], v5 offset:18432
v_mfma_f32_16x16x32_bf16 v[56:59], a[132:135], a[28:31], v[56:59]
v_mfma_f32_16x16x32_bf16 v[64:67], a[128:131], a[32:35], v[64:67]
ds_read_b128 a[64:67], v2 offset:32768
v_mfma_f32_16x16x32_bf16 v[64:67], a[132:135], a[36:39], v[64:67]
buffer_load_dwordx4 v18, s[12:15], s27 offen offset:2048 lds
v_mfma_f32_16x16x32_bf16 v[72:75], a[128:131], a[40:43], v[72:75]
ds_read_b128 a[68:71], v3 offset:32768
v_mfma_f32_16x16x32_bf16 v[72:75], a[132:135], a[44:47], v[72:75]
v_mfma_f32_16x16x32_bf16 v[80:83], a[128:131], a[48:51], v[80:83]
v_mfma_f32_16x16x32_bf16 v[80:83], a[132:135], a[52:55], v[80:83]
buffer_load_dwordx4 v19, s[12:15], s27 offen offset:3072 lds
v_mfma_f32_16x16x32_bf16 v[88:91], a[128:131], a[56:59], v[88:91]
s_add_u32 s27, s27, 524288
ds_read_b128 a[72:75], v2 offset:34816
v_mfma_f32_16x16x32_bf16 v[88:91], a[132:135], a[60:63], v[88:91]
s_waitcnt lgkmcnt(5)
v_mfma_f32_16x16x32_bf16 v[36:39], a[136:139], a[0:3], v[36:39]
s_waitcnt lgkmcnt(3)
s_add_u32 m0, s28, 0
ds_read_b64_tr_b16 a[128:129], v6 offset:0
v_mfma_f32_16x16x32_bf16 v[36:39], a[140:143], a[4:7], v[36:39]
buffer_load_dwordx4 v12, s[8:11], s24 offen offset:0 lds
v_mfma_f32_16x16x32_bf16 v[44:47], a[136:139], a[8:11], v[44:47]
ds_read_b64_tr_b16 a[130:131], v6 offset:2048
v_mfma_f32_16x16x32_bf16 v[44:47], a[140:143], a[12:15], v[44:47]
v_mfma_f32_16x16x32_bf16 v[52:55], a[136:139], a[16:19], v[52:55]
ds_read_b64_tr_b16 a[132:133], v6 offset:16384
v_mfma_f32_16x16x32_bf16 v[52:55], a[140:143], a[20:23], v[52:55]
buffer_load_dwordx4 v13, s[8:11], s24 offen offset:1024 lds
v_mfma_f32_16x16x32_bf16 v[60:63], a[136:139], a[24:27], v[60:63]
ds_read_b64_tr_b16 a[134:135], v6 offset:18432
v_mfma_f32_16x16x32_bf16 v[60:63], a[140:143], a[28:31], v[60:63]
v_mfma_f32_16x16x32_bf16 v[68:71], a[136:139], a[32:35], v[68:71]
ds_read_b128 a[76:79], v3 offset:34816
v_mfma_f32_16x16x32_bf16 v[68:71], a[140:143], a[36:39], v[68:71]
buffer_load_dwordx4 v14, s[8:11], s24 offen offset:2048 lds
v_mfma_f32_16x16x32_bf16 v[76:79], a[136:139], a[40:43], v[76:79]
v_mfma_f32_16x16x32_bf16 v[76:79], a[140:143], a[44:47], v[76:79]
v_mfma_f32_16x16x32_bf16 v[84:87], a[136:139], a[48:51], v[84:87]
ds_read_b128 a[80:83], v2 offset:36864
v_mfma_f32_16x16x32_bf16 v[84:87], a[140:143], a[52:55], v[84:87]
buffer_load_dwordx4 v15, s[8:11], s24 offen offset:3072 lds
v_mfma_f32_16x16x32_bf16 v[92:95], a[136:139], a[56:59], v[92:95]
s_add_u32 s24, s24, 128
ds_read_b128 a[84:87], v3 offset:36864
v_mfma_f32_16x16x32_bf16 v[92:95], a[140:143], a[60:63], v[92:95]
s_waitcnt lgkmcnt(3)
s_mov_b64 s[12:13], s[80:81]
v_mfma_f32_16x16x32_bf16 v[96:99], a[128:131], a[0:3], v[96:99]
s_mov_b32 s14, 3670016
s_add_u32 m0, s28, 16384
ds_read_b64_tr_b16 a[136:137], v7 offset:0
v_mfma_f32_16x16x32_bf16 v[96:99], a[132:135], a[4:7], v[96:99]
buffer_load_dwordx4 v12, s[8:11], s24 offen offset:0 lds
v_mfma_f32_16x16x32_bf16 v[104:107], a[128:131], a[8:11], v[104:107]
ds_read_b64_tr_b16 a[138:139], v7 offset:2048
v_mfma_f32_16x16x32_bf16 v[104:107], a[132:135], a[12:15], v[104:107]
v_mfma_f32_16x16x32_bf16 v[112:115], a[128:131], a[16:19], v[112:115]
ds_read_b64_tr_b16 a[140:141], v7 offset:16384
v_mfma_f32_16x16x32_bf16 v[112:115], a[132:135], a[20:23], v[112:115]
buffer_load_dwordx4 v13, s[8:11], s24 offen offset:1024 lds
v_mfma_f32_16x16x32_bf16 v[120:123], a[128:131], a[24:27], v[120:123]
ds_read_b64_tr_b16 a[142:143], v7 offset:18432
v_mfma_f32_16x16x32_bf16 v[120:123], a[132:135], a[28:31], v[120:123]
v_mfma_f32_16x16x32_bf16 v[128:131], a[128:131], a[32:35], v[128:131]
v_mfma_f32_16x16x32_bf16 v[128:131], a[132:135], a[36:39], v[128:131]
buffer_load_dwordx4 v14, s[8:11], s24 offen offset:2048 lds
v_mfma_f32_16x16x32_bf16 v[136:139], a[128:131], a[40:43], v[136:139]
ds_read_b128 a[88:91], v2 offset:38912
v_mfma_f32_16x16x32_bf16 v[136:139], a[132:135], a[44:47], v[136:139]
v_mfma_f32_16x16x32_bf16 v[144:147], a[128:131], a[48:51], v[144:147]
ds_read_b128 a[92:95], v3 offset:38912
v_mfma_f32_16x16x32_bf16 v[144:147], a[132:135], a[52:55], v[144:147]
buffer_load_dwordx4 v15, s[8:11], s24 offen offset:3072 lds
v_mfma_f32_16x16x32_bf16 v[152:155], a[128:131], a[56:59], v[152:155]
s_add_u32 s24, s24, 128
v_mfma_f32_16x16x32_bf16 v[152:155], a[132:135], a[60:63], v[152:155]
s_waitcnt lgkmcnt(2)
s_sub_u32 s26, s26, 8388608
v_mfma_f32_16x16x32_bf16 v[100:103], a[136:139], a[0:3], v[100:103]
s_sub_u32 s27, s27, 8388608
s_add_u32 m0, s29, 131072
ds_read_b64_tr_b16 a[128:129], v8 offset:0
v_mfma_f32_16x16x32_bf16 v[100:103], a[140:143], a[4:7], v[100:103]
buffer_load_dwordx4 v16, s[12:15], s26 offen offset:0 lds
v_mfma_f32_16x16x32_bf16 v[108:111], a[136:139], a[8:11], v[108:111]
ds_read_b64_tr_b16 a[130:131], v8 offset:2048
v_mfma_f32_16x16x32_bf16 v[108:111], a[140:143], a[12:15], v[108:111]
v_mfma_f32_16x16x32_bf16 v[116:119], a[136:139], a[16:19], v[116:119]
ds_read_b64_tr_b16 a[132:133], v8 offset:16384
v_mfma_f32_16x16x32_bf16 v[116:119], a[140:143], a[20:23], v[116:119]
buffer_load_dwordx4 v17, s[12:15], s26 offen offset:1024 lds
v_mfma_f32_16x16x32_bf16 v[124:127], a[136:139], a[24:27], v[124:127]
ds_read_b64_tr_b16 a[134:135], v8 offset:18432
v_mfma_f32_16x16x32_bf16 v[124:127], a[140:143], a[28:31], v[124:127]
v_mfma_f32_16x16x32_bf16 v[132:135], a[136:139], a[32:35], v[132:135]
ds_read_b128 a[96:99], v2 offset:40960
v_mfma_f32_16x16x32_bf16 v[132:135], a[140:143], a[36:39], v[132:135]
buffer_load_dwordx4 v18, s[12:15], s26 offen offset:2048 lds
v_mfma_f32_16x16x32_bf16 v[140:143], a[136:139], a[40:43], v[140:143]
v_mfma_f32_16x16x32_bf16 v[140:143], a[140:143], a[44:47], v[140:143]
v_mfma_f32_16x16x32_bf16 v[148:151], a[136:139], a[48:51], v[148:151]
ds_read_b128 a[100:103], v3 offset:40960
v_mfma_f32_16x16x32_bf16 v[148:151], a[140:143], a[52:55], v[148:151]
buffer_load_dwordx4 v19, s[12:15], s26 offen offset:3072 lds
v_mfma_f32_16x16x32_bf16 v[156:159], a[136:139], a[56:59], v[156:159]
s_add_u32 s26, s26, 524288
ds_read_b128 a[104:107], v2 offset:43008
v_mfma_f32_16x16x32_bf16 v[156:159], a[140:143], a[60:63], v[156:159]
s_waitcnt lgkmcnt(5)
v_mfma_f32_16x16x32_bf16 v[160:163], a[128:131], a[0:3], v[160:163]
s_waitcnt lgkmcnt(3)
s_add_u32 m0, s29, 147456
ds_read_b64_tr_b16 a[136:137], v9 offset:0
v_mfma_f32_16x16x32_bf16 v[160:163], a[132:135], a[4:7], v[160:163]
buffer_load_dwordx4 v16, s[12:15], s27 offen offset:0 lds
v_mfma_f32_16x16x32_bf16 v[168:171], a[128:131], a[8:11], v[168:171]
ds_read_b64_tr_b16 a[138:139], v9 offset:2048
v_mfma_f32_16x16x32_bf16 v[168:171], a[132:135], a[12:15], v[168:171]
v_mfma_f32_16x16x32_bf16 v[176:179], a[128:131], a[16:19], v[176:179]
ds_read_b64_tr_b16 a[140:141], v9 offset:16384
v_mfma_f32_16x16x32_bf16 v[176:179], a[132:135], a[20:23], v[176:179]
buffer_load_dwordx4 v17, s[12:15], s27 offen offset:1024 lds
v_mfma_f32_16x16x32_bf16 v[184:187], a[128:131], a[24:27], v[184:187]
ds_read_b64_tr_b16 a[142:143], v9 offset:18432
v_mfma_f32_16x16x32_bf16 v[184:187], a[132:135], a[28:31], v[184:187]
v_mfma_f32_16x16x32_bf16 v[192:195], a[128:131], a[32:35], v[192:195]
v_mfma_f32_16x16x32_bf16 v[192:195], a[132:135], a[36:39], v[192:195]
buffer_load_dwordx4 v18, s[12:15], s27 offen offset:2048 lds
v_mfma_f32_16x16x32_bf16 v[200:203], a[128:131], a[40:43], v[200:203]
ds_read_b128 a[108:111], v3 offset:43008
v_mfma_f32_16x16x32_bf16 v[200:203], a[132:135], a[44:47], v[200:203]
v_mfma_f32_16x16x32_bf16 v[208:211], a[128:131], a[48:51], v[208:211]
ds_read_b128 a[112:115], v2 offset:45056
v_mfma_f32_16x16x32_bf16 v[208:211], a[132:135], a[52:55], v[208:211]
buffer_load_dwordx4 v19, s[12:15], s27 offen offset:3072 lds
v_mfma_f32_16x16x32_bf16 v[216:219], a[128:131], a[56:59], v[216:219]
s_add_u32 s27, s27, 524288
v_mfma_f32_16x16x32_bf16 v[216:219], a[132:135], a[60:63], v[216:219]
s_waitcnt lgkmcnt(4)
v_mfma_f32_16x16x32_bf16 v[164:167], a[136:139], a[0:3], v[164:167]
s_waitcnt lgkmcnt(2)
ds_read_b64_tr_b16 a[128:129], v10 offset:0
v_mfma_f32_16x16x32_bf16 v[164:167], a[140:143], a[4:7], v[164:167]
v_mfma_f32_16x16x32_bf16 v[172:175], a[136:139], a[8:11], v[172:175]
ds_read_b64_tr_b16 a[130:131], v10 offset:2048
v_mfma_f32_16x16x32_bf16 v[172:175], a[140:143], a[12:15], v[172:175]
v_mfma_f32_16x16x32_bf16 v[180:183], a[136:139], a[16:19], v[180:183]
ds_read_b64_tr_b16 a[132:133], v10 offset:16384
v_mfma_f32_16x16x32_bf16 v[180:183], a[140:143], a[20:23], v[180:183]
v_mfma_f32_16x16x32_bf16 v[188:191], a[136:139], a[24:27], v[188:191]
ds_read_b64_tr_b16 a[134:135], v10 offset:18432
v_mfma_f32_16x16x32_bf16 v[188:191], a[140:143], a[28:31], v[188:191]
v_mfma_f32_16x16x32_bf16 v[196:199], a[136:139], a[32:35], v[196:199]
ds_read_b128 a[116:119], v3 offset:45056
v_mfma_f32_16x16x32_bf16 v[196:199], a[140:143], a[36:39], v[196:199]
v_mfma_f32_16x16x32_bf16 v[204:207], a[136:139], a[40:43], v[204:207]
ds_read_b128 a[120:123], v2 offset:47104
v_mfma_f32_16x16x32_bf16 v[204:207], a[140:143], a[44:47], v[204:207]
v_mfma_f32_16x16x32_bf16 v[212:215], a[136:139], a[48:51], v[212:215]
v_mfma_f32_16x16x32_bf16 v[212:215], a[140:143], a[52:55], v[212:215]
v_mfma_f32_16x16x32_bf16 v[220:223], a[136:139], a[56:59], v[220:223]
ds_read_b128 a[124:127], v3 offset:47104
v_mfma_f32_16x16x32_bf16 v[220:223], a[140:143], a[60:63], v[220:223]
s_waitcnt lgkmcnt(5)
v_mfma_f32_16x16x32_bf16 a[192:195], a[128:131], a[0:3], a[192:195]
s_waitcnt lgkmcnt(3)
ds_read_b64_tr_b16 a[136:137], v11 offset:0
v_mfma_f32_16x16x32_bf16 a[192:195], a[132:135], a[4:7], a[192:195]
v_mfma_f32_16x16x32_bf16 a[200:203], a[128:131], a[8:11], a[200:203]
ds_read_b64_tr_b16 a[138:139], v11 offset:2048
v_mfma_f32_16x16x32_bf16 a[200:203], a[132:135], a[12:15], a[200:203]
v_mfma_f32_16x16x32_bf16 a[208:211], a[128:131], a[16:19], a[208:211]
ds_read_b64_tr_b16 a[140:141], v11 offset:16384
v_mfma_f32_16x16x32_bf16 a[208:211], a[132:135], a[20:23], a[208:211]
v_mfma_f32_16x16x32_bf16 a[216:219], a[128:131], a[24:27], a[216:219]
ds_read_b64_tr_b16 a[142:143], v11 offset:18432
v_mfma_f32_16x16x32_bf16 a[216:219], a[132:135], a[28:31], a[216:219]
v_mfma_f32_16x16x32_bf16 a[224:227], a[128:131], a[32:35], a[224:227]
v_mfma_f32_16x16x32_bf16 a[224:227], a[132:135], a[36:39], a[224:227]
v_mfma_f32_16x16x32_bf16 a[232:235], a[128:131], a[40:43], a[232:235]
v_mfma_f32_16x16x32_bf16 a[232:235], a[132:135], a[44:47], a[232:235]
v_mfma_f32_16x16x32_bf16 a[240:243], a[128:131], a[48:51], a[240:243]
v_mfma_f32_16x16x32_bf16 a[240:243], a[132:135], a[52:55], a[240:243]
v_mfma_f32_16x16x32_bf16 a[248:251], a[128:131], a[56:59], a[248:251]
v_mfma_f32_16x16x32_bf16 a[248:251], a[132:135], a[60:63], a[248:251]
s_waitcnt vmcnt(12) lgkmcnt(0)
s_barrier
v_mfma_f32_16x16x32_bf16 a[196:199], a[136:139], a[0:3], a[196:199]
s_add_u32 m0, s28, 32768
ds_read_b64_tr_b16 a[128:129], v4 offset:32768
v_mfma_f32_16x16x32_bf16 a[196:199], a[140:143], a[4:7], a[196:199]
s_lshr_b32 s22, s3, 1
buffer_load_dwordx4 v12, s[8:11], s24 offen offset:0 lds
v_mfma_f32_16x16x32_bf16 a[204:207], a[136:139], a[8:11], a[204:207]
s_lshl_b32 s22, s22, 14
ds_read_b64_tr_b16 a[130:131], v4 offset:34816
v_subrev_u32 v2, s22, v2
v_mfma_f32_16x16x32_bf16 a[204:207], a[140:143], a[12:15], a[204:207]
v_subrev_u32 v3, s22, v3
v_mfma_f32_16x16x32_bf16 a[212:215], a[136:139], a[16:19], a[212:215]
ds_read_b64_tr_b16 a[132:133], v4 offset:49152
v_mfma_f32_16x16x32_bf16 a[212:215], a[140:143], a[20:23], a[212:215]
buffer_load_dwordx4 v13, s[8:11], s24 offen offset:1024 lds
v_mfma_f32_16x16x32_bf16 a[220:223], a[136:139], a[24:27], a[220:223]
ds_read_b64_tr_b16 a[134:135], v4 offset:51200
v_mfma_f32_16x16x32_bf16 a[220:223], a[140:143], a[28:31], a[220:223]
v_mfma_f32_16x16x32_bf16 a[228:231], a[136:139], a[32:35], a[228:231]
v_mfma_f32_16x16x32_bf16 a[228:231], a[140:143], a[36:39], a[228:231]
buffer_load_dwordx4 v14, s[8:11], s24 offen offset:2048 lds
v_mfma_f32_16x16x32_bf16 a[236:239], a[136:139], a[40:43], a[236:239]
v_mfma_f32_16x16x32_bf16 a[236:239], a[140:143], a[44:47], a[236:239]
v_mfma_f32_16x16x32_bf16 a[244:247], a[136:139], a[48:51], a[244:247]
v_mfma_f32_16x16x32_bf16 a[244:247], a[140:143], a[52:55], a[244:247]
buffer_load_dwordx4 v15, s[8:11], s24 offen offset:3072 lds
v_mfma_f32_16x16x32_bf16 a[252:255], a[136:139], a[56:59], a[252:255]
s_add_u32 s24, s24, 128
v_mfma_f32_16x16x32_bf16 a[252:255], a[140:143], a[60:63], a[252:255]
s_waitcnt lgkmcnt(2)
v_mfma_f32_16x16x32_bf16 v[32:35], a[128:131], a[64:67], v[32:35]
s_waitcnt lgkmcnt(0)
s_add_u32 m0, s29, 65536
ds_read_b64_tr_b16 a[136:137], v5 offset:32768
v_mfma_f32_16x16x32_bf16 v[32:35], a[132:135], a[68:71], v[32:35]
buffer_load_dwordx4 v16, s[12:15], s26 offen offset:0 lds
v_mfma_f32_16x16x32_bf16 v[40:43], a[128:131], a[72:75], v[40:43]
ds_read_b64_tr_b16 a[138:139], v5 offset:34816
v_mfma_f32_16x16x32_bf16 v[40:43], a[132:135], a[76:79], v[40:43]
v_mfma_f32_16x16x32_bf16 v[48:51], a[128:131], a[80:83], v[48:51]
ds_read_b64_tr_b16 a[140:141], v5 offset:49152
v_mfma_f32_16x16x32_bf16 v[48:51], a[132:135], a[84:87], v[48:51]
buffer_load_dwordx4 v17, s[12:15], s26 offen offset:1024 lds
v_mfma_f32_16x16x32_bf16 v[56:59], a[128:131], a[88:91], v[56:59]
ds_read_b64_tr_b16 a[142:143], v5 offset:51200
v_mfma_f32_16x16x32_bf16 v[56:59], a[132:135], a[92:95], v[56:59]
v_mfma_f32_16x16x32_bf16 v[64:67], a[128:131], a[96:99], v[64:67]
ds_read_b128 a[0:3], v2 offset:0
v_mfma_f32_16x16x32_bf16 v[64:67], a[132:135], a[100:103], v[64:67]
buffer_load_dwordx4 v18, s[12:15], s26 offen offset:2048 lds
v_mfma_f32_16x16x32_bf16 v[72:75], a[128:131], a[104:107], v[72:75]
ds_read_b128 a[4:7], v3 offset:0
v_mfma_f32_16x16x32_bf16 v[72:75], a[132:135], a[108:111], v[72:75]
v_mfma_f32_16x16x32_bf16 v[80:83], a[128:131], a[112:115], v[80:83]
v_mfma_f32_16x16x32_bf16 v[80:83], a[132:135], a[116:119], v[80:83]
buffer_load_dwordx4 v19, s[12:15], s26 offen offset:3072 lds
v_mfma_f32_16x16x32_bf16 v[88:91], a[128:131], a[120:123], v[88:91]
s_add_u32 s26, s26, 524288
ds_read_b128 a[8:11], v2 offset:2048
v_mfma_f32_16x16x32_bf16 v[88:91], a[132:135], a[124:127], v[88:91]
s_waitcnt lgkmcnt(5)
v_mfma_f32_16x16x32_bf16 v[36:39], a[136:139], a[64:67], v[36:39]
s_waitcnt lgkmcnt(3)
s_add_u32 m0, s29, 81920
ds_read_b64_tr_b16 a[128:129], v6 offset:32768
v_mfma_f32_16x16x32_bf16 v[36:39], a[140:143], a[68:71], v[36:39]
buffer_load_dwordx4 v16, s[12:15], s27 offen offset:0 lds
v_mfma_f32_16x16x32_bf16 v[44:47], a[136:139], a[72:75], v[44:47]
ds_read_b64_tr_b16 a[130:131], v6 offset:34816
v_mfma_f32_16x16x32_bf16 v[44:47], a[140:143], a[76:79], v[44:47]
v_mfma_f32_16x16x32_bf16 v[52:55], a[136:139], a[80:83], v[52:55]
ds_read_b64_tr_b16 a[132:133], v6 offset:49152
v_mfma_f32_16x16x32_bf16 v[52:55], a[140:143], a[84:87], v[52:55]
buffer_load_dwordx4 v17, s[12:15], s27 offen offset:1024 lds
v_mfma_f32_16x16x32_bf16 v[60:63], a[136:139], a[88:91], v[60:63]
ds_read_b64_tr_b16 a[134:135], v6 offset:51200
v_cvt_pk_bf16_f32 v32, v32, v33
v_mfma_f32_16x16x32_bf16 v[60:63], a[140:143], a[92:95], v[60:63]
v_cvt_pk_bf16_f32 v33, v34, v35
v_cvt_pk_bf16_f32 v34, v36, v37
v_mfma_f32_16x16x32_bf16 v[68:71], a[136:139], a[96:99], v[68:71]
ds_read_b128 a[12:15], v3 offset:2048
v_cvt_pk_bf16_f32 v35, v38, v39
v_mfma_f32_16x16x32_bf16 v[68:71], a[140:143], a[100:103], v[68:71]
buffer_load_dwordx4 v18, s[12:15], s27 offen offset:2048 lds
v_mfma_f32_16x16x32_bf16 v[76:79], a[136:139], a[104:107], v[76:79]
v_cvt_pk_bf16_f32 v40, v40, v41
v_cvt_pk_bf16_f32 v41, v42, v43
v_mfma_f32_16x16x32_bf16 v[76:79], a[140:143], a[108:111], v[76:79]
v_cvt_pk_bf16_f32 v42, v44, v45
v_cvt_pk_bf16_f32 v43, v46, v47
v_mfma_f32_16x16x32_bf16 v[84:87], a[136:139], a[112:115], v[84:87]
ds_read_b128 a[16:19], v2 offset:4096
v_cvt_pk_bf16_f32 v48, v48, v49
v_mfma_f32_16x16x32_bf16 v[84:87], a[140:143], a[116:119], v[84:87]
buffer_load_dwordx4 v19, s[12:15], s27 offen offset:3072 lds
v_mfma_f32_16x16x32_bf16 v[92:95], a[136:139], a[120:123], v[92:95]
s_add_u32 s27, s27, 524288
ds_read_b128 a[20:23], v3 offset:4096
v_cvt_pk_bf16_f32 v49, v50, v51
v_mfma_f32_16x16x32_bf16 v[92:95], a[140:143], a[124:127], v[92:95]
s_waitcnt lgkmcnt(3)
v_cvt_pk_bf16_f32 v50, v52, v53
v_cvt_pk_bf16_f32 v51, v54, v55
v_mfma_f32_16x16x32_bf16 v[96:99], a[128:131], a[64:67], v[96:99]
s_add_u32 m0, s28, 49152
ds_read_b64_tr_b16 a[136:137], v7 offset:32768
v_cvt_pk_bf16_f32 v56, v56, v57
v_mfma_f32_16x16x32_bf16 v[96:99], a[132:135], a[68:71], v[96:99]
buffer_load_dwordx4 v12, s[8:11], s24 offen offset:0 lds
v_mfma_f32_16x16x32_bf16 v[104:107], a[128:131], a[72:75], v[104:107]
ds_read_b64_tr_b16 a[138:139], v7 offset:34816
v_cvt_pk_bf16_f32 v57, v58, v59
v_mfma_f32_16x16x32_bf16 v[104:107], a[132:135], a[76:79], v[104:107]
v_cvt_pk_bf16_f32 v58, v60, v61
v_cvt_pk_bf16_f32 v59, v62, v63
v_mfma_f32_16x16x32_bf16 v[112:115], a[128:131], a[80:83], v[112:115]
ds_read_b64_tr_b16 a[140:141], v7 offset:49152
v_cvt_pk_bf16_f32 v64, v64, v65
v_mfma_f32_16x16x32_bf16 v[112:115], a[132:135], a[84:87], v[112:115]
buffer_load_dwordx4 v13, s[8:11], s24 offen offset:1024 lds
v_mfma_f32_16x16x32_bf16 v[120:123], a[128:131], a[88:91], v[120:123]
ds_read_b64_tr_b16 a[142:143], v7 offset:51200
v_cvt_pk_bf16_f32 v65, v66, v67
v_mfma_f32_16x16x32_bf16 v[120:123], a[132:135], a[92:95], v[120:123]
v_cvt_pk_bf16_f32 v66, v68, v69
v_cvt_pk_bf16_f32 v67, v70, v71
v_mfma_f32_16x16x32_bf16 v[128:131], a[128:131], a[96:99], v[128:131]
v_cvt_pk_bf16_f32 v72, v72, v73
v_cvt_pk_bf16_f32 v73, v74, v75
v_mfma_f32_16x16x32_bf16 v[128:131], a[132:135], a[100:103], v[128:131]
buffer_load_dwordx4 v14, s[8:11], s24 offen offset:2048 lds
v_mfma_f32_16x16x32_bf16 v[136:139], a[128:131], a[104:107], v[136:139]
ds_read_b128 a[24:27], v2 offset:6144
v_cvt_pk_bf16_f32 v74, v76, v77
v_mfma_f32_16x16x32_bf16 v[136:139], a[132:135], a[108:111], v[136:139]
buffer_store_dwordx4 v[32:35], v1, s[4:7], s31 offen sc1
v_mfma_f32_16x16x32_bf16 v[144:147], a[128:131], a[112:115], v[144:147]
s_add_u32 s31, s31, s32
ds_read_b128 a[28:31], v3 offset:6144
v_cvt_pk_bf16_f32 v75, v78, v79
v_mfma_f32_16x16x32_bf16 v[144:147], a[132:135], a[116:119], v[144:147]
buffer_load_dwordx4 v15, s[8:11], s24 offen offset:3072 lds
v_mfma_f32_16x16x32_bf16 v[152:155], a[128:131], a[120:123], v[152:155]
s_add_u32 s24, s24, 128
v_cvt_pk_bf16_f32 v80, v80, v81
v_cvt_pk_bf16_f32 v81, v82, v83
v_mfma_f32_16x16x32_bf16 v[152:155], a[132:135], a[124:127], v[152:155]
s_waitcnt lgkmcnt(4)
v_cvt_pk_bf16_f32 v82, v84, v85
v_cvt_pk_bf16_f32 v83, v86, v87
v_mfma_f32_16x16x32_bf16 v[100:103], a[136:139], a[64:67], v[100:103]
s_waitcnt lgkmcnt(2)
ds_read_b64_tr_b16 a[128:129], v8 offset:32768
v_cvt_pk_bf16_f32 v88, v88, v89
v_mfma_f32_16x16x32_bf16 v[100:103], a[140:143], a[68:71], v[100:103]
v_cvt_pk_bf16_f32 v89, v90, v91
v_cvt_pk_bf16_f32 v90, v92, v93
v_mfma_f32_16x16x32_bf16 v[108:111], a[136:139], a[72:75], v[108:111]
ds_read_b64_tr_b16 a[130:131], v8 offset:34816
v_cvt_pk_bf16_f32 v91, v94, v95
v_mfma_f32_16x16x32_bf16 v[108:111], a[140:143], a[76:79], v[108:111]
buffer_store_dwordx4 v[40:43], v1, s[4:7], s31 offen sc1
v_mfma_f32_16x16x32_bf16 v[116:119], a[136:139], a[80:83], v[116:119]
s_add_u32 s31, s31, s33
ds_read_b64_tr_b16 a[132:133], v8 offset:49152
v_mfma_f32_16x16x32_bf16 v[116:119], a[140:143], a[84:87], v[116:119]
v_mfma_f32_16x16x32_bf16 v[124:127], a[136:139], a[88:91], v[124:127]
ds_read_b64_tr_b16 a[134:135], v8 offset:51200
v_cvt_pk_bf16_f32 v96, v96, v97
v_mfma_f32_16x16x32_bf16 v[124:127], a[140:143], a[92:95], v[124:127]
v_cvt_pk_bf16_f32 v97, v98, v99
v_cvt_pk_bf16_f32 v98, v100, v101
v_mfma_f32_16x16x32_bf16 v[132:135], a[136:139], a[96:99], v[132:135]
ds_read_b128 a[32:35], v2 offset:8192
v_cvt_pk_bf16_f32 v99, v102, v103
v_mfma_f32_16x16x32_bf16 v[132:135], a[140:143], a[100:103], v[132:135]
v_cvt_pk_bf16_f32 v104, v104, v105
v_cvt_pk_bf16_f32 v105, v106, v107
v_mfma_f32_16x16x32_bf16 v[140:143], a[136:139], a[104:107], v[140:143]
v_cvt_pk_bf16_f32 v106, v108, v109
v_cvt_pk_bf16_f32 v107, v110, v111
v_mfma_f32_16x16x32_bf16 v[140:143], a[140:143], a[108:111], v[140:143]
v_cvt_pk_bf16_f32 v112, v112, v113
v_cvt_pk_bf16_f32 v113, v114, v115
v_mfma_f32_16x16x32_bf16 v[148:151], a[136:139], a[112:115], v[148:151]
ds_read_b128 a[36:39], v3 offset:8192
v_cvt_pk_bf16_f32 v114, v116, v117
v_mfma_f32_16x16x32_bf16 v[148:151], a[140:143], a[116:119], v[148:151]
v_cvt_pk_bf16_f32 v115, v118, v119
v_cvt_pk_bf16_f32 v120, v120, v121
v_mfma_f32_16x16x32_bf16 v[156:159], a[136:139], a[120:123], v[156:159]
ds_read_b128 a[40:43], v2 offset:10240
v_cvt_pk_bf16_f32 v121, v122, v123
v_mfma_f32_16x16x32_bf16 v[156:159], a[140:143], a[124:127], v[156:159]
s_waitcnt lgkmcnt(3)
buffer_store_dwordx4 v[48:51], v1, s[4:7], s31 offen sc1
v_mfma_f32_16x16x32_bf16 v[160:163], a[128:131], a[64:67], v[160:163]
s_add_u32 s31, s31, s32
ds_read_b64_tr_b16 a[136:137], v9 offset:32768
v_cvt_pk_bf16_f32 v122, v124, v125
v_mfma_f32_16x16x32_bf16 v[160:163], a[132:135], a[68:71], v[160:163]
v_cvt_pk_bf16_f32 v123, v126, v127
v_cvt_pk_bf16_f32 v128, v128, v129
v_mfma_f32_16x16x32_bf16 v[168:171], a[128:131], a[72:75], v[168:171]
ds_read_b64_tr_b16 a[138:139], v9 offset:34816
v_cvt_pk_bf16_f32 v129, v130, v131
v_mfma_f32_16x16x32_bf16 v[168:171], a[132:135], a[76:79], v[168:171]
v_cvt_pk_bf16_f32 v130, v132, v133
v_cvt_pk_bf16_f32 v131, v134, v135
v_mfma_f32_16x16x32_bf16 v[176:179], a[128:131], a[80:83], v[176:179]
ds_read_b64_tr_b16 a[140:141], v9 offset:49152
v_cvt_pk_bf16_f32 v136, v136, v137
v_mfma_f32_16x16x32_bf16 v[176:179], a[132:135], a[84:87], v[176:179]
v_cvt_pk_bf16_f32 v137, v138, v139
v_cvt_pk_bf16_f32 v138, v140, v141
v_mfma_f32_16x16x32_bf16 v[184:187], a[128:131], a[88:91], v[184:187]
ds_read_b64_tr_b16 a[142:143], v9 offset:51200
v_cvt_pk_bf16_f32 v139, v142, v143
v_mfma_f32_16x16x32_bf16 v[184:187], a[132:135], a[92:95], v[184:187]
v_cvt_pk_bf16_f32 v144, v144, v145
v_cvt_pk_bf16_f32 v145, v146, v147
v_mfma_f32_16x16x32_bf16 v[192:195], a[128:131], a[96:99], v[192:195]
buffer_store_dwordx4 v[56:59], v1, s[4:7], s31 offen sc1
v_mfma_f32_16x16x32_bf16 v[192:195], a[132:135], a[100:103], v[192:195]
s_add_u32 s31, s31, s34
v_cvt_pk_bf16_f32 v146, v148, v149
v_cvt_pk_bf16_f32 v147, v150, v151
v_mfma_f32_16x16x32_bf16 v[200:203], a[128:131], a[104:107], v[200:203]
ds_read_b128 a[44:47], v3 offset:10240
v_cvt_pk_bf16_f32 v152, v152, v153
v_mfma_f32_16x16x32_bf16 v[200:203], a[132:135], a[108:111], v[200:203]
v_cvt_pk_bf16_f32 v153, v154, v155
v_cvt_pk_bf16_f32 v154, v156, v157
v_mfma_f32_16x16x32_bf16 v[208:211], a[128:131], a[112:115], v[208:211]
ds_read_b128 a[48:51], v2 offset:12288
v_cvt_pk_bf16_f32 v155, v158, v159
v_mfma_f32_16x16x32_bf16 v[208:211], a[132:135], a[116:119], v[208:211]
v_mfma_f32_16x16x32_bf16 v[216:219], a[128:131], a[120:123], v[216:219]
v_mfma_f32_16x16x32_bf16 v[216:219], a[132:135], a[124:127], v[216:219]
s_waitcnt lgkmcnt(4)
v_mfma_f32_16x16x32_bf16 v[164:167], a[136:139], a[64:67], v[164:167]
s_waitcnt lgkmcnt(2)
ds_read_b64_tr_b16 a[128:129], v10 offset:32768
v_mfma_f32_16x16x32_bf16 v[164:167], a[140:143], a[68:71], v[164:167]
v_mfma_f32_16x16x32_bf16 v[172:175], a[136:139], a[72:75], v[172:175]
ds_read_b64_tr_b16 a[130:131], v10 offset:34816
v_mfma_f32_16x16x32_bf16 v[172:175], a[140:143], a[76:79], v[172:175]
buffer_store_dwordx4 v[64:67], v1, s[4:7], s31 offen sc1
v_mfma_f32_16x16x32_bf16 v[180:183], a[136:139], a[80:83], v[180:183]
s_add_u32 s31, s31, s32
ds_read_b64_tr_b16 a[132:133], v10 offset:49152
v_mfma_f32_16x16x32_bf16 v[180:183], a[140:143], a[84:87], v[180:183]
v_mfma_f32_16x16x32_bf16 v[188:191], a[136:139], a[88:91], v[188:191]
ds_read_b64_tr_b16 a[134:135], v10 offset:51200
v_cvt_pk_bf16_f32 v160, v160, v161
v_mfma_f32_16x16x32_bf16 v[188:191], a[140:143], a[92:95], v[188:191]
v_cvt_pk_bf16_f32 v161, v162, v163
v_cvt_pk_bf16_f32 v162, v164, v165
v_mfma_f32_16x16x32_bf16 v[196:199], a[136:139], a[96:99], v[196:199]
ds_read_b128 a[52:55], v3 offset:12288
v_cvt_pk_bf16_f32 v163, v166, v167
v_mfma_f32_16x16x32_bf16 v[196:199], a[140:143], a[100:103], v[196:199]
v_cvt_pk_bf16_f32 v168, v168, v169
v_cvt_pk_bf16_f32 v169, v170, v171
v_mfma_f32_16x16x32_bf16 v[204:207], a[136:139], a[104:107], v[204:207]
ds_read_b128 a[56:59], v2 offset:14336
v_cvt_pk_bf16_f32 v170, v172, v173
v_mfma_f32_16x16x32_bf16 v[204:207], a[140:143], a[108:111], v[204:207]
v_cvt_pk_bf16_f32 v171, v174, v175
v_cvt_pk_bf16_f32 v176, v176, v177
v_mfma_f32_16x16x32_bf16 v[212:215], a[136:139], a[112:115], v[212:215]
v_cvt_pk_bf16_f32 v177, v178, v179
v_cvt_pk_bf16_f32 v178, v180, v181
v_mfma_f32_16x16x32_bf16 v[212:215], a[140:143], a[116:119], v[212:215]
buffer_store_dwordx4 v[72:75], v1, s[4:7], s31 offen sc1
v_mfma_f32_16x16x32_bf16 v[220:223], a[136:139], a[120:123], v[220:223]
s_add_u32 s31, s31, s33
ds_read_b128 a[60:63], v3 offset:14336
v_cvt_pk_bf16_f32 v179, v182, v183
v_mfma_f32_16x16x32_bf16 v[220:223], a[140:143], a[124:127], v[220:223]
s_waitcnt lgkmcnt(5)
v_cvt_pk_bf16_f32 v184, v184, v185
v_cvt_pk_bf16_f32 v185, v186, v187
v_mfma_f32_16x16x32_bf16 a[192:195], a[128:131], a[64:67], a[192:195]
s_waitcnt lgkmcnt(3)
ds_read_b64_tr_b16 a[136:137], v11 offset:32768
v_cvt_pk_bf16_f32 v186, v188, v189
v_mfma_f32_16x16x32_bf16 a[192:195], a[132:135], a[68:71], a[192:195]
v_cvt_pk_bf16_f32 v187, v190, v191
v_cvt_pk_bf16_f32 v192, v192, v193
v_mfma_f32_16x16x32_bf16 a[200:203], a[128:131], a[72:75], a[200:203]
ds_read_b64_tr_b16 a[138:139], v11 offset:34816
v_cvt_pk_bf16_f32 v193, v194, v195
v_mfma_f32_16x16x32_bf16 a[200:203], a[132:135], a[76:79], a[200:203]
v_cvt_pk_bf16_f32 v194, v196, v197
v_cvt_pk_bf16_f32 v195, v198, v199
v_mfma_f32_16x16x32_bf16 a[208:211], a[128:131], a[80:83], a[208:211]
ds_read_b64_tr_b16 a[140:141], v11 offset:49152
v_cvt_pk_bf16_f32 v200, v200, v201
v_mfma_f32_16x16x32_bf16 a[208:211], a[132:135], a[84:87], a[208:211]
v_cvt_pk_bf16_f32 v201, v202, v203
v_cvt_pk_bf16_f32 v202, v204, v205
v_mfma_f32_16x16x32_bf16 a[216:219], a[128:131], a[88:91], a[216:219]
ds_read_b64_tr_b16 a[142:143], v11 offset:51200
v_cvt_pk_bf16_f32 v203, v206, v207
v_mfma_f32_16x16x32_bf16 a[216:219], a[132:135], a[92:95], a[216:219]
v_cvt_pk_bf16_f32 v208, v208, v209
v_cvt_pk_bf16_f32 v209, v210, v211
v_mfma_f32_16x16x32_bf16 a[224:227], a[128:131], a[96:99], a[224:227]
buffer_store_dwordx4 v[80:83], v1, s[4:7], s31 offen sc1
v_mfma_f32_16x16x32_bf16 a[224:227], a[132:135], a[100:103], a[224:227]
s_add_u32 s31, s31, s32
v_cvt_pk_bf16_f32 v210, v212, v213
v_cvt_pk_bf16_f32 v211, v214, v215
v_mfma_f32_16x16x32_bf16 a[232:235], a[128:131], a[104:107], a[232:235]
v_cvt_pk_bf16_f32 v216, v216, v217
v_cvt_pk_bf16_f32 v217, v218, v219
v_mfma_f32_16x16x32_bf16 a[232:235], a[132:135], a[108:111], a[232:235]
v_cvt_pk_bf16_f32 v218, v220, v221
v_cvt_pk_bf16_f32 v219, v222, v223
v_mfma_f32_16x16x32_bf16 a[240:243], a[128:131], a[112:115], a[240:243]
v_mfma_f32_16x16x32_bf16 a[240:243], a[132:135], a[116:119], a[240:243]
v_mfma_f32_16x16x32_bf16 a[248:251], a[128:131], a[120:123], a[248:251]
v_mfma_f32_16x16x32_bf16 a[248:251], a[132:135], a[124:127], a[248:251]
s_waitcnt vmcnt(23) lgkmcnt(0)
s_barrier
v_mfma_f32_16x16x32_bf16 a[196:199], a[136:139], a[64:67], a[196:199]
s_add_u32 m0, s29, 98304
ds_read_b64_tr_b16 a[128:129], v22 offset:0
v_mfma_f32_16x16x32_bf16 a[196:199], a[140:143], a[68:71], a[196:199]
buffer_load_dwordx4 v16, s[12:15], s26 offen offset:0 lds
v_mfma_f32_16x16x32_bf16 a[204:207], a[136:139], a[72:75], a[204:207]
ds_read_b64_tr_b16 a[130:131], v22 offset:2048
v_mfma_f32_16x16x32_bf16 a[204:207], a[140:143], a[76:79], a[204:207]
buffer_store_dwordx4 v[88:91], v1, s[4:7], s31 offen sc1
v_mfma_f32_16x16x32_bf16 a[212:215], a[136:139], a[80:83], a[212:215]
s_add_u32 s31, s31, s35
ds_read_b64_tr_b16 a[132:133], v22 offset:16384
v_mfma_f32_16x16x32_bf16 a[212:215], a[140:143], a[84:87], a[212:215]
buffer_load_dwordx4 v17, s[12:15], s26 offen offset:1024 lds
v_mfma_f32_16x16x32_bf16 a[220:223], a[136:139], a[88:91], a[220:223]
ds_read_b64_tr_b16 a[134:135], v22 offset:18432
v_add_u32 v22, 4294901760, v22
v_mfma_f32_16x16x32_bf16 a[220:223], a[140:143], a[92:95], a[220:223]
v_mfma_f32_16x16x32_bf16 a[228:231], a[136:139], a[96:99], a[228:231]
v_mfma_f32_16x16x32_bf16 a[228:231], a[140:143], a[100:103], a[228:231]
buffer_load_dwordx4 v18, s[12:15], s26 offen offset:2048 lds
v_mfma_f32_16x16x32_bf16 a[236:239], a[136:139], a[104:107], a[236:239]
v_mfma_f32_16x16x32_bf16 a[236:239], a[140:143], a[108:111], a[236:239]
v_mfma_f32_16x16x32_bf16 a[244:247], a[136:139], a[112:115], a[244:247]
v_mfma_f32_16x16x32_bf16 a[244:247], a[140:143], a[116:119], a[244:247]
buffer_load_dwordx4 v19, s[12:15], s26 offen offset:3072 lds
v_mfma_f32_16x16x32_bf16 a[252:255], a[136:139], a[120:123], a[252:255]
s_add_u32 s26, s26, 524288
v_mfma_f32_16x16x32_bf16 a[252:255], a[140:143], a[124:127], a[252:255]
s_waitcnt lgkmcnt(2)
s_branch M_Q
M_V:
s_lshl_b32 s22, s22, 14
s_add_u32 s31, s31, s22
s_add_u32 s31, s31, 16777216
s_mov_b32 s32, 1024
s_mov_b32 s33, 31744
s_mov_b32 s34, 4294935552
s_mov_b32 s35, 4294935552
s_mov_b32 s36, 4294935552
s_mov_b32 s30, 8
s_mov_b32 s82, 3221225472
v_mfma_f32_16x16x32_bf16 v[32:35], a[0:3], a[128:131], 0
s_add_u32 m0, s29, 114688
ds_read_b64_tr_b16 a[136:137], v5 offset:0
v_mfma_f32_16x16x32_bf16 v[32:35], a[4:7], a[132:135], v[32:35]
buffer_load_dwordx4 v16, s[12:15], s27 offen offset:0 lds
v_mfma_f32_16x16x32_bf16 v[36:39], a[8:11], a[128:131], 0
ds_read_b64_tr_b16 a[138:139], v5 offset:2048
v_mfma_f32_16x16x32_bf16 v[36:39], a[12:15], a[132:135], v[36:39]
v_mfma_f32_16x16x32_bf16 v[40:43], a[16:19], a[128:131], 0
ds_read_b64_tr_b16 a[140:141], v5 offset:16384
v_mfma_f32_16x16x32_bf16 v[40:43], a[20:23], a[132:135], v[40:43]
buffer_load_dwordx4 v17, s[12:15], s27 offen offset:1024 lds
v_mfma_f32_16x16x32_bf16 v[44:47], a[24:27], a[128:131], 0
ds_read_b64_tr_b16 a[142:143], v5 offset:18432
v_mfma_f32_16x16x32_bf16 v[44:47], a[28:31], a[132:135], v[44:47]
v_mfma_f32_16x16x32_bf16 v[48:51], a[32:35], a[128:131], 0
ds_read_b128 a[64:67], v2 offset:32768
v_mfma_f32_16x16x32_bf16 v[48:51], a[36:39], a[132:135], v[48:51]
buffer_load_dwordx4 v18, s[12:15], s27 offen offset:2048 lds
v_mfma_f32_16x16x32_bf16 v[52:55], a[40:43], a[128:131], 0
ds_read_b128 a[68:71], v3 offset:32768
v_mfma_f32_16x16x32_bf16 v[52:55], a[44:47], a[132:135], v[52:55]
v_mfma_f32_16x16x32_bf16 v[56:59], a[48:51], a[128:131], 0
v_mfma_f32_16x16x32_bf16 v[56:59], a[52:55], a[132:135], v[56:59]
buffer_load_dwordx4 v19, s[12:15], s27 offen offset:3072 lds
v_mfma_f32_16x16x32_bf16 v[60:63], a[56:59], a[128:131], 0
s_add_u32 s27, s27, 524288
ds_read_b128 a[72:75], v2 offset:34816
v_mfma_f32_16x16x32_bf16 v[60:63], a[60:63], a[132:135], v[60:63]
s_waitcnt lgkmcnt(5)
v_mfma_f32_16x16x32_bf16 v[64:67], a[0:3], a[136:139], 0
s_waitcnt lgkmcnt(3)
s_add_u32 m0, s28, 0
ds_read_b64_tr_b16 a[128:129], v6 offset:0
v_mfma_f32_16x16x32_bf16 v[64:67], a[4:7], a[140:143], v[64:67]
buffer_load_dwordx4 v12, s[8:11], s24 offen offset:0 lds
v_mfma_f32_16x16x32_bf16 v[68:71], a[8:11], a[136:139], 0
ds_read_b64_tr_b16 a[130:131], v6 offset:2048
v_mfma_f32_16x16x32_bf16 v[68:71], a[12:15], a[140:143], v[68:71]
v_mfma_f32_16x16x32_bf16 v[72:75], a[16:19], a[136:139], 0
ds_read_b64_tr_b16 a[132:133], v6 offset:16384
v_mfma_f32_16x16x32_bf16 v[72:75], a[20:23], a[140:143], v[72:75]
buffer_load_dwordx4 v13, s[8:11], s24 offen offset:1024 lds
v_mfma_f32_16x16x32_bf16 v[76:79], a[24:27], a[136:139], 0
ds_read_b64_tr_b16 a[134:135], v6 offset:18432
v_mfma_f32_16x16x32_bf16 v[76:79], a[28:31], a[140:143], v[76:79]
v_mfma_f32_16x16x32_bf16 v[80:83], a[32:35], a[136:139], 0
ds_read_b128 a[76:79], v3 offset:34816
v_mfma_f32_16x16x32_bf16 v[80:83], a[36:39], a[140:143], v[80:83]
buffer_load_dwordx4 v14, s[8:11], s24 offen offset:2048 lds
v_mfma_f32_16x16x32_bf16 v[84:87], a[40:43], a[136:139], 0
v_mfma_f32_16x16x32_bf16 v[84:87], a[44:47], a[140:143], v[84:87]
v_mfma_f32_16x16x32_bf16 v[88:91], a[48:51], a[136:139], 0
ds_read_b128 a[80:83], v2 offset:36864
v_mfma_f32_16x16x32_bf16 v[88:91], a[52:55], a[140:143], v[88:91]
buffer_load_dwordx4 v15, s[8:11], s24 offen offset:3072 lds
v_mfma_f32_16x16x32_bf16 v[92:95], a[56:59], a[136:139], 0
s_add_u32 s24, s24, 128
ds_read_b128 a[84:87], v3 offset:36864
v_mfma_f32_16x16x32_bf16 v[92:95], a[60:63], a[140:143], v[92:95]
s_waitcnt lgkmcnt(5)
v_mfma_f32_16x16x32_bf16 v[96:99], a[0:3], a[128:131], 0
s_waitcnt lgkmcnt(3)
s_add_u32 m0, s28, 4096
ds_read_b64_tr_b16 a[136:137], v7 offset:0
v_mfma_f32_16x16x32_bf16 v[96:99], a[4:7], a[132:135], v[96:99]
buffer_load_dwordx4 v12, s[8:11], s25 offen offset:0 lds
v_mfma_f32_16x16x32_bf16 v[100:103], a[8:11], a[128:131], 0
ds_read_b64_tr_b16 a[138:139], v7 offset:2048
v_mfma_f32_16x16x32_bf16 v[100:103], a[12:15], a[132:135], v[100:103]
v_mfma_f32_16x16x32_bf16 v[104:107], a[16:19], a[128:131], 0
ds_read_b64_tr_b16 a[140:141], v7 offset:16384
v_mfma_f32_16x16x32_bf16 v[104:107], a[20:23], a[132:135], v[104:107]
buffer_load_dwordx4 v13, s[8:11], s25 offen offset:1024 lds
v_mfma_f32_16x16x32_bf16 v[108:111], a[24:27], a[128:131], 0
ds_read_b64_tr_b16 a[142:143], v7 offset:18432
v_mfma_f32_16x16x32_bf16 v[108:111], a[28:31], a[132:135], v[108:111]
v_mfma_f32_16x16x32_bf16 v[112:115], a[32:35], a[128:131], 0
v_mfma_f32_16x16x32_bf16 v[112:115], a[36:39], a[132:135], v[112:115]
buffer_load_dwordx4 v14, s[8:11], s25 offen offset:2048 lds
v_mfma_f32_16x16x32_bf16 v[116:119], a[40:43], a[128:131], 0
ds_read_b128 a[88:91], v2 offset:38912
v_mfma_f32_16x16x32_bf16 v[116:119], a[44:47], a[132:135], v[116:119]
v_mfma_f32_16x16x32_bf16 v[120:123], a[48:51], a[128:131], 0
ds_read_b128 a[92:95], v3 offset:38912
v_mfma_f32_16x16x32_bf16 v[120:123], a[52:55], a[132:135], v[120:123]
buffer_load_dwordx4 v15, s[8:11], s25 offen offset:3072 lds
v_mfma_f32_16x16x32_bf16 v[124:127], a[56:59], a[128:131], 0
s_add_u32 s25, s25, 128
v_mfma_f32_16x16x32_bf16 v[124:127], a[60:63], a[132:135], v[124:127]
s_waitcnt lgkmcnt(4)
v_mfma_f32_16x16x32_bf16 v[128:131], a[0:3], a[136:139], 0
s_waitcnt lgkmcnt(2)
ds_read_b64_tr_b16 a[128:129], v8 offset:0
v_mfma_f32_16x16x32_bf16 v[128:131], a[4:7], a[140:143], v[128:131]
buffer_load_dword v21, v20, s[16:19], s43 offen
v_mfma_f32_16x16x32_bf16 v[132:135], a[8:11], a[136:139], 0
s_add_u32 s43, s43, s47
ds_read_b64_tr_b16 a[130:131], v8 offset:2048
v_mfma_f32_16x16x32_bf16 v[132:135], a[12:15], a[140:143], v[132:135]
s_cmp_ge_u32 s43, s51
v_mfma_f32_16x16x32_bf16 v[136:139], a[16:19], a[136:139], 0
s_cselect_b32 s43, 0, s43
ds_read_b64_tr_b16 a[132:133], v8 offset:16384
v_mfma_f32_16x16x32_bf16 v[136:139], a[20:23], a[140:143], v[136:139]
s_cselect_b32 s51, s42, s51
v_mfma_f32_16x16x32_bf16 v[140:143], a[24:27], a[136:139], 0
s_cselect_b64 s[16:17], s[40:41], s[16:17]
ds_read_b64_tr_b16 a[134:135], v8 offset:18432
v_mfma_f32_16x16x32_bf16 v[140:143], a[28:31], a[140:143], v[140:143]
s_cselect_b32 s18, s42, s18
v_mfma_f32_16x16x32_bf16 v[144:147], a[32:35], a[136:139], 0
s_cselect_b64 s[40:41], s[44:45], s[40:41]
ds_read_b128 a[96:99], v2 offset:40960
v_mfma_f32_16x16x32_bf16 v[144:147], a[36:39], a[140:143], v[144:147]
s_cselect_b32 s42, s46, s42
v_mfma_f32_16x16x32_bf16 v[148:151], a[40:43], a[136:139], 0
s_cselect_b32 s46, 0, s46
v_mfma_f32_16x16x32_bf16 v[148:151], a[44:47], a[140:143], v[148:151]
buffer_load_dword v21, v20, s[16:19], s43 offen
v_mfma_f32_16x16x32_bf16 v[152:155], a[48:51], a[136:139], 0
s_add_u32 s43, s43, s47
ds_read_b128 a[100:103], v3 offset:40960
v_mfma_f32_16x16x32_bf16 v[152:155], a[52:55], a[140:143], v[152:155]
s_cmp_ge_u32 s43, s51
v_mfma_f32_16x16x32_bf16 v[156:159], a[56:59], a[136:139], 0
s_cselect_b32 s43, 0, s43
ds_read_b128 a[104:107], v2 offset:43008
v_mfma_f32_16x16x32_bf16 v[156:159], a[60:63], a[140:143], v[156:159]
s_waitcnt lgkmcnt(5)
s_cselect_b32 s51, s42, s51
v_mfma_f32_16x16x32_bf16 v[160:163], a[0:3], a[128:131], 0
s_waitcnt lgkmcnt(3)
s_cselect_b64 s[16:17], s[40:41], s[16:17]
ds_read_b64_tr_b16 a[136:137], v9 offset:0
v_mfma_f32_16x16x32_bf16 v[160:163], a[4:7], a[132:135], v[160:163]
s_cselect_b32 s18, s42, s18
v_mfma_f32_16x16x32_bf16 v[164:167], a[8:11], a[128:131], 0
s_cselect_b64 s[40:41], s[44:45], s[40:41]
ds_read_b64_tr_b16 a[138:139], v9 offset:2048
v_mfma_f32_16x16x32_bf16 v[164:167], a[12:15], a[132:135], v[164:167]
s_cselect_b32 s42, s46, s42
v_mfma_f32_16x16x32_bf16 v[168:171], a[16:19], a[128:131], 0
s_cselect_b32 s46, 0, s46
ds_read_b64_tr_b16 a[140:141], v9 offset:16384
v_mfma_f32_16x16x32_bf16 v[168:171], a[20:23], a[132:135], v[168:171]
v_mfma_f32_16x16x32_bf16 v[172:175], a[24:27], a[128:131], 0
ds_read_b64_tr_b16 a[142:143], v9 offset:18432
v_mfma_f32_16x16x32_bf16 v[172:175], a[28:31], a[132:135], v[172:175]
v_mfma_f32_16x16x32_bf16 v[176:179], a[32:35], a[128:131], 0
v_mfma_f32_16x16x32_bf16 v[176:179], a[36:39], a[132:135], v[176:179]
v_mfma_f32_16x16x32_bf16 v[180:183], a[40:43], a[128:131], 0
ds_read_b128 a[108:111], v3 offset:43008
v_mfma_f32_16x16x32_bf16 v[180:183], a[44:47], a[132:135], v[180:183]
v_mfma_f32_16x16x32_bf16 v[184:187], a[48:51], a[128:131], 0
ds_read_b128 a[112:115], v2 offset:45056
v_mfma_f32_16x16x32_bf16 v[184:187], a[52:55], a[132:135], v[184:187]
v_mfma_f32_16x16x32_bf16 v[188:191], a[56:59], a[128:131], 0
v_mfma_f32_16x16x32_bf16 v[188:191], a[60:63], a[132:135], v[188:191]
s_waitcnt lgkmcnt(4)
v_mfma_f32_16x16x32_bf16 v[192:195], a[0:3], a[136:139], 0
s_waitcnt lgkmcnt(2)
ds_read_b64_tr_b16 a[128:129], v10 offset:0
v_mfma_f32_16x16x32_bf16 v[192:195], a[4:7], a[140:143], v[192:195]
v_mfma_f32_16x16x32_bf16 v[196:199], a[8:11], a[136:139], 0
ds_read_b64_tr_b16 a[130:131], v10 offset:2048
v_mfma_f32_16x16x32_bf16 v[196:199], a[12:15], a[140:143], v[196:199]
v_mfma_f32_16x16x32_bf16 v[200:203], a[16:19], a[136:139], 0
ds_read_b64_tr_b16 a[132:133], v10 offset:16384
v_mfma_f32_16x16x32_bf16 v[200:203], a[20:23], a[140:143], v[200:203]
v_mfma_f32_16x16x32_bf16 v[204:207], a[24:27], a[136:139], 0
ds_read_b64_tr_b16 a[134:135], v10 offset:18432
v_mfma_f32_16x16x32_bf16 v[204:207], a[28:31], a[140:143], v[204:207]
v_mfma_f32_16x16x32_bf16 v[208:211], a[32:35], a[136:139], 0
ds_read_b128 a[116:119], v3 offset:45056
v_mfma_f32_16x16x32_bf16 v[208:211], a[36:39], a[140:143], v[208:211]
v_mfma_f32_16x16x32_bf16 v[212:215], a[40:43], a[136:139], 0
ds_read_b128 a[120:123], v2 offset:47104
v_mfma_f32_16x16x32_bf16 v[212:215], a[44:47], a[140:143], v[212:215]
v_mfma_f32_16x16x32_bf16 v[216:219], a[48:51], a[136:139], 0
v_mfma_f32_16x16x32_bf16 v[216:219], a[52:55], a[140:143], v[216:219]
v_mfma_f32_16x16x32_bf16 v[220:223], a[56:59], a[136:139], 0
ds_read_b128 a[124:127], v3 offset:47104
v_mfma_f32_16x16x32_bf16 v[220:223], a[60:63], a[140:143], v[220:223]
s_waitcnt lgkmcnt(5)
v_mfma_f32_16x16x32_bf16 a[192:195], a[0:3], a[128:131], 0
s_waitcnt lgkmcnt(3)
ds_read_b64_tr_b16 a[136:137], v11 offset:0
v_mfma_f32_16x16x32_bf16 a[192:195], a[4:7], a[132:135], a[192:195]
v_mfma_f32_16x16x32_bf16 a[196:199], a[8:11], a[128:131], 0
ds_read_b64_tr_b16 a[138:139], v11 offset:2048
v_mfma_f32_16x16x32_bf16 a[196:199], a[12:15], a[132:135], a[196:199]
v_mfma_f32_16x16x32_bf16 a[200:203], a[16:19], a[128:131], 0
ds_read_b64_tr_b16 a[140:141], v11 offset:16384
v_mfma_f32_16x16x32_bf16 a[200:203], a[20:23], a[132:135], a[200:203]
v_mfma_f32_16x16x32_bf16 a[204:207], a[24:27], a[128:131], 0
ds_read_b64_tr_b16 a[142:143], v11 offset:18432
v_mfma_f32_16x16x32_bf16 a[204:207], a[28:31], a[132:135], a[204:207]
v_mfma_f32_16x16x32_bf16 a[208:211], a[32:35], a[128:131], 0
v_mfma_f32_16x16x32_bf16 a[208:211], a[36:39], a[132:135], a[208:211]
v_mfma_f32_16x16x32_bf16 a[212:215], a[40:43], a[128:131], 0
v_mfma_f32_16x16x32_bf16 a[212:215], a[44:47], a[132:135], a[212:215]
v_mfma_f32_16x16x32_bf16 a[216:219], a[48:51], a[128:131], 0
v_mfma_f32_16x16x32_bf16 a[216:219], a[52:55], a[132:135], a[216:219]
v_mfma_f32_16x16x32_bf16 a[220:223], a[56:59], a[128:131], 0
v_mfma_f32_16x16x32_bf16 a[220:223], a[60:63], a[132:135], a[220:223]
s_waitcnt vmcnt(2) lgkmcnt(0)
s_barrier
v_mfma_f32_16x16x32_bf16 a[224:227], a[0:3], a[136:139], 0
s_add_u32 m0, s29, 65536
ds_read_b64_tr_b16 a[128:129], v4 offset:32768
v_mfma_f32_16x16x32_bf16 a[224:227], a[4:7], a[140:143], a[224:227]
buffer_load_dwordx4 v16, s[12:15], s26 offen offset:0 lds
v_mfma_f32_16x16x32_bf16 a[228:231], a[8:11], a[136:139], 0
ds_read_b64_tr_b16 a[130:131], v4 offset:34816
v_mfma_f32_16x16x32_bf16 a[228:231], a[12:15], a[140:143], a[228:231]
v_mfma_f32_16x16x32_bf16 a[232:235], a[16:19], a[136:139], 0
ds_read_b64_tr_b16 a[132:133], v4 offset:49152
v_mfma_f32_16x16x32_bf16 a[232:235], a[20:23], a[140:143], a[232:235]
buffer_load_dwordx4 v17, s[12:15], s26 offen offset:1024 lds
v_mfma_f32_16x16x32_bf16 a[236:239], a[24:27], a[136:139], 0
ds_read_b64_tr_b16 a[134:135], v4 offset:51200
v_mfma_f32_16x16x32_bf16 a[236:239], a[28:31], a[140:143], a[236:239]
v_mfma_f32_16x16x32_bf16 a[240:243], a[32:35], a[136:139], 0
v_mfma_f32_16x16x32_bf16 a[240:243], a[36:39], a[140:143], a[240:243]
buffer_load_dwordx4 v18, s[12:15], s26 offen offset:2048 lds
v_mfma_f32_16x16x32_bf16 a[244:247], a[40:43], a[136:139], 0
v_mfma_f32_16x16x32_bf16 a[244:247], a[44:47], a[140:143], a[244:247]
v_mfma_f32_16x16x32_bf16 a[248:251], a[48:51], a[136:139], 0
v_mfma_f32_16x16x32_bf16 a[248:251], a[52:55], a[140:143], a[248:251]
buffer_load_dwordx4 v19, s[12:15], s26 offen offset:3072 lds
v_mfma_f32_16x16x32_bf16 a[252:255], a[56:59], a[136:139], 0
s_add_u32 s26, s26, 524288
v_mfma_f32_16x16x32_bf16 a[252:255], a[60:63], a[140:143], a[252:255]
s_waitcnt lgkmcnt(2)
Lg_2:
v_mfma_f32_16x16x32_bf16 v[32:35], a[64:67], a[128:131], v[32:35]
s_waitcnt lgkmcnt(0)
s_add_u32 m0, s29, 81920
ds_read_b64_tr_b16 a[136:137], v5 offset:32768
v_mfma_f32_16x16x32_bf16 v[32:35], a[68:71], a[132:135], v[32:35]
buffer_load_dwordx4 v16, s[12:15], s27 offen offset:0 lds
v_mfma_f32_16x16x32_bf16 v[36:39], a[72:75], a[128:131], v[36:39]
ds_read_b64_tr_b16 a[138:139], v5 offset:34816
v_mfma_f32_16x16x32_bf16 v[36:39], a[76:79], a[132:135], v[36:39]
v_mfma_f32_16x16x32_bf16 v[40:43], a[80:83], a[128:131], v[40:43]
ds_read_b64_tr_b16 a[140:141], v5 offset:49152
v_mfma_f32_16x16x32_bf16 v[40:43], a[84:87], a[132:135], v[40:43]
buffer_load_dwordx4 v17, s[12:15], s27 offen offset:1024 lds
v_mfma_f32_16x16x32_bf16 v[44:47], a[88:91], a[128:131], v[44:47]
ds_read_b64_tr_b16 a[142:143], v5 offset:51200
v_mfma_f32_16x16x32_bf16 v[44:47], a[92:95], a[132:135], v[44:47]
v_mfma_f32_16x16x32_bf16 v[48:51], a[96:99], a[128:131], v[48:51]
ds_read_b128 a[0:3], v2 offset:0
v_mfma_f32_16x16x32_bf16 v[48:51], a[100:103], a[132:135], v[48:51]
buffer_load_dwordx4 v18, s[12:15], s27 offen offset:2048 lds
v_mfma_f32_16x16x32_bf16 v[52:55], a[104:107], a[128:131], v[52:55]
ds_read_b128 a[4:7], v3 offset:0
v_mfma_f32_16x16x32_bf16 v[52:55], a[108:111], a[132:135], v[52:55]
v_mfma_f32_16x16x32_bf16 v[56:59], a[112:115], a[128:131], v[56:59]
v_mfma_f32_16x16x32_bf16 v[56:59], a[116:119], a[132:135], v[56:59]
buffer_load_dwordx4 v19, s[12:15], s27 offen offset:3072 lds
v_mfma_f32_16x16x32_bf16 v[60:63], a[120:123], a[128:131], v[60:63]
s_add_u32 s27, s27, 524288
ds_read_b128 a[8:11], v2 offset:2048
v_mfma_f32_16x16x32_bf16 v[60:63], a[124:127], a[132:135], v[60:63]
s_waitcnt lgkmcnt(5)
v_mfma_f32_16x16x32_bf16 v[64:67], a[64:67], a[136:139], v[64:67]
s_waitcnt lgkmcnt(3)
s_add_u32 m0, s28, 32768
ds_read_b64_tr_b16 a[128:129], v6 offset:32768
v_mfma_f32_16x16x32_bf16 v[64:67], a[68:71], a[140:143], v[64:67]
buffer_load_dwordx4 v12, s[8:11], s24 offen offset:0 lds
v_mfma_f32_16x16x32_bf16 v[68:71], a[72:75], a[136:139], v[68:71]
ds_read_b64_tr_b16 a[130:131], v6 offset:34816
v_mfma_f32_16x16x32_bf16 v[68:71], a[76:79], a[140:143], v[68:71]
v_mfma_f32_16x16x32_bf16 v[72:75], a[80:83], a[136:139], v[72:75]
ds_read_b64_tr_b16 a[132:133], v6 offset:49152
v_mfma_f32_16x16x32_bf16 v[72:75], a[84:87], a[140:143], v[72:75]
buffer_load_dwordx4 v13, s[8:11], s24 offen offset:1024 lds
v_mfma_f32_16x16x32_bf16 v[76:79], a[88:91], a[136:139], v[76:79]
ds_read_b64_tr_b16 a[134:135], v6 offset:51200
v_mfma_f32_16x16x32_bf16 v[76:79], a[92:95], a[140:143], v[76:79]
v_mfma_f32_16x16x32_bf16 v[80:83], a[96:99], a[136:139], v[80:83]
ds_read_b128 a[12:15], v3 offset:2048
v_mfma_f32_16x16x32_bf16 v[80:83], a[100:103], a[140:143], v[80:83]
buffer_load_dwordx4 v14, s[8:11], s24 offen offset:2048 lds
v_mfma_f32_16x16x32_bf16 v[84:87], a[104:107], a[136:139], v[84:87]
v_mfma_f32_16x16x32_bf16 v[84:87], a[108:111], a[140:143], v[84:87]
v_mfma_f32_16x16x32_bf16 v[88:91], a[112:115], a[136:139], v[88:91]
ds_read_b128 a[16:19], v2 offset:4096
v_mfma_f32_16x16x32_bf16 v[88:91], a[116:119], a[140:143], v[88:91]
buffer_load_dwordx4 v15, s[8:11], s24 offen offset:3072 lds
v_mfma_f32_16x16x32_bf16 v[92:95], a[120:123], a[136:139], v[92:95]
s_add_u32 s24, s24, 128
ds_read_b128 a[20:23], v3 offset:4096
v_mfma_f32_16x16x32_bf16 v[92:95], a[124:127], a[140:143], v[92:95]
s_waitcnt lgkmcnt(5)
v_mfma_f32_16x16x32_bf16 v[96:99], a[64:67], a[128:131], v[96:99]
s_waitcnt lgkmcnt(3)
s_add_u32 m0, s28, 36864
ds_read_b64_tr_b16 a[136:137], v7 offset:32768
v_mfma_f32_16x16x32_bf16 v[96:99], a[68:71], a[132:135], v[96:99]
buffer_load_dwordx4 v12, s[8:11], s25 offen offset:0 lds
v_mfma_f32_16x16x32_bf16 v[100:103], a[72:75], a[128:131], v[100:103]
ds_read_b64_tr_b16 a[138:139], v7 offset:34816
v_mfma_f32_16x16x32_bf16 v[100:103], a[76:79], a[132:135], v[100:103]
v_mfma_f32_16x16x32_bf16 v[104:107], a[80:83], a[128:131], v[104:107]
ds_read_b64_tr_b16 a[140:141], v7 offset:49152
v_mfma_f32_16x16x32_bf16 v[104:107], a[84:87], a[132:135], v[104:107]
buffer_load_dwordx4 v13, s[8:11], s25 offen offset:1024 lds
v_mfma_f32_16x16x32_bf16 v[108:111], a[88:91], a[128:131], v[108:111]
ds_read_b64_tr_b16 a[142:143], v7 offset:51200
v_mfma_f32_16x16x32_bf16 v[108:111], a[92:95], a[132:135], v[108:111]
v_mfma_f32_16x16x32_bf16 v[112:115], a[96:99], a[128:131], v[112:115]
v_mfma_f32_16x16x32_bf16 v[112:115], a[100:103], a[132:135], v[112:115]
buffer_load_dwordx4 v14, s[8:11], s25 offen offset:2048 lds
v_mfma_f32_16x16x32_bf16 v[116:119], a[104:107], a[128:131], v[116:119]
ds_read_b128 a[24:27], v2 offset:6144
v_mfma_f32_16x16x32_bf16 v[116:119], a[108:111], a[132:135], v[116:119]
v_mfma_f32_16x16x32_bf16 v[120:123], a[112:115], a[128:131], v[120:123]
ds_read_b128 a[28:31], v3 offset:6144
v_mfma_f32_16x16x32_bf16 v[120:123], a[116:119], a[132:135], v[120:123]
buffer_load_dwordx4 v15, s[8:11], s25 offen offset:3072 lds
v_mfma_f32_16x16x32_bf16 v[124:127], a[120:123], a[128:131], v[124:127]
s_add_u32 s25, s25, 128
v_mfma_f32_16x16x32_bf16 v[124:127], a[124:127], a[132:135], v[124:127]
s_waitcnt lgkmcnt(4)
v_mfma_f32_16x16x32_bf16 v[128:131], a[64:67], a[136:139], v[128:131]
s_waitcnt lgkmcnt(2)
ds_read_b64_tr_b16 a[128:129], v8 offset:32768
v_mfma_f32_16x16x32_bf16 v[128:131], a[68:71], a[140:143], v[128:131]
buffer_load_dword v21, v20, s[16:19], s43 offen
v_mfma_f32_16x16x32_bf16 v[132:135], a[72:75], a[136:139], v[132:135]
s_add_u32 s43, s43, s47
ds_read_b64_tr_b16 a[130:131], v8 offset:34816
v_mfma_f32_16x16x32_bf16 v[132:135], a[76:79], a[140:143], v[132:135]
s_cmp_ge_u32 s43, s51
v_mfma_f32_16x16x32_bf16 v[136:139], a[80:83], a[136:139], v[136:139]
s_cselect_b32 s43, 0, s43
ds_read_b64_tr_b16 a[132:133], v8 offset:49152
v_mfma_f32_16x16x32_bf16 v[136:139], a[84:87], a[140:143], v[136:139]
s_cselect_b32 s51, s42, s51
v_mfma_f32_16x16x32_bf16 v[140:143], a[88:91], a[136:139], v[140:143]
s_cselect_b64 s[16:17], s[40:41], s[16:17]
ds_read_b64_tr_b16 a[134:135], v8 offset:51200
v_mfma_f32_16x16x32_bf16 v[140:143], a[92:95], a[140:143], v[140:143]
s_cselect_b32 s18, s42, s18
v_mfma_f32_16x16x32_bf16 v[144:147], a[96:99], a[136:139], v[144:147]
s_cselect_b64 s[40:41], s[44:45], s[40:41]
ds_read_b128 a[32:35], v2 offset:8192
v_mfma_f32_16x16x32_bf16 v[144:147], a[100:103], a[140:143], v[144:147]
s_cselect_b32 s42, s46, s42
v_mfma_f32_16x16x32_bf16 v[148:151], a[104:107], a[136:139], v[148:151]
s_cselect_b32 s46, 0, s46
v_mfma_f32_16x16x32_bf16 v[148:151], a[108:111], a[140:143], v[148:151]
s_cmp_eq_u32 s30, s55
v_mfma_f32_16x16x32_bf16 v[152:155], a[112:115], a[136:139], v[152:155]
s_cselect_b32 s22, 0, 3221225472
ds_read_b128 a[36:39], v3 offset:8192
v_mfma_f32_16x16x32_bf16 v[152:155], a[116:119], a[140:143], v[152:155]
s_sub_u32 s30, s30, 1
buffer_atomic_add v27, v26, s[60:63], s22 offen sc1
v_mfma_f32_16x16x32_bf16 v[156:159], a[120:123], a[136:139], v[156:159]
ds_read_b128 a[40:43], v2 offset:10240
v_mfma_f32_16x16x32_bf16 v[156:159], a[124:127], a[140:143], v[156:159]
s_waitcnt lgkmcnt(5)
v_mfma_f32_16x16x32_bf16 v[160:163], a[64:67], a[128:131], v[160:163]
s_waitcnt lgkmcnt(3)
ds_read_b64_tr_b16 a[136:137], v9 offset:32768
v_mfma_f32_16x16x32_bf16 v[160:163], a[68:71], a[132:135], v[160:163]
v_mfma_f32_16x16x32_bf16 v[164:167], a[72:75], a[128:131], v[164:167]
ds_read_b64_tr_b16 a[138:139], v9 offset:34816
v_mfma_f32_16x16x32_bf16 v[164:167], a[76:79], a[132:135], v[164:167]
v_mfma_f32_16x16x32_bf16 v[168:171], a[80:83], a[128:131], v[168:171]
ds_read_b64_tr_b16 a[140:141], v9 offset:49152
v_mfma_f32_16x16x32_bf16 v[168:171], a[84:87], a[132:135], v[168:171]
v_mfma_f32_16x16x32_bf16 v[172:175], a[88:91], a[128:131], v[172:175]
ds_read_b64_tr_b16 a[142:143], v9 offset:51200
v_mfma_f32_16x16x32_bf16 v[172:175], a[92:95], a[132:135], v[172:175]
v_mfma_f32_16x16x32_bf16 v[176:179], a[96:99], a[128:131], v[176:179]
v_mfma_f32_16x16x32_bf16 v[176:179], a[100:103], a[132:135], v[176:179]
v_mfma_f32_16x16x32_bf16 v[180:183], a[104:107], a[128:131], v[180:183]
ds_read_b128 a[44:47], v3 offset:10240
v_mfma_f32_16x16x32_bf16 v[180:183], a[108:111], a[132:135], v[180:183]
v_mfma_f32_16x16x32_bf16 v[184:187], a[112:115], a[128:131], v[184:187]
ds_read_b128 a[48:51], v2 offset:12288
v_mfma_f32_16x16x32_bf16 v[184:187], a[116:119], a[132:135], v[184:187]
v_mfma_f32_16x16x32_bf16 v[188:191], a[120:123], a[128:131], v[188:191]
v_mfma_f32_16x16x32_bf16 v[188:191], a[124:127], a[132:135], v[188:191]
s_waitcnt lgkmcnt(4)
v_mfma_f32_16x16x32_bf16 v[192:195], a[64:67], a[136:139], v[192:195]
s_waitcnt lgkmcnt(2)
ds_read_b64_tr_b16 a[128:129], v10 offset:32768
v_mfma_f32_16x16x32_bf16 v[192:195], a[68:71], a[140:143], v[192:195]
v_mfma_f32_16x16x32_bf16 v[196:199], a[72:75], a[136:139], v[196:199]
ds_read_b64_tr_b16 a[130:131], v10 offset:34816
v_mfma_f32_16x16x32_bf16 v[196:199], a[76:79], a[140:143], v[196:199]
v_mfma_f32_16x16x32_bf16 v[200:203], a[80:83], a[136:139], v[200:203]
ds_read_b64_tr_b16 a[132:133], v10 offset:49152
v_mfma_f32_16x16x32_bf16 v[200:203], a[84:87], a[140:143], v[200:203]
v_mfma_f32_16x16x32_bf16 v[204:207], a[88:91], a[136:139], v[204:207]
ds_read_b64_tr_b16 a[134:135], v10 offset:51200
v_mfma_f32_16x16x32_bf16 v[204:207], a[92:95], a[140:143], v[204:207]
v_mfma_f32_16x16x32_bf16 v[208:211], a[96:99], a[136:139], v[208:211]
ds_read_b128 a[52:55], v3 offset:12288
v_mfma_f32_16x16x32_bf16 v[208:211], a[100:103], a[140:143], v[208:211]
v_mfma_f32_16x16x32_bf16 v[212:215], a[104:107], a[136:139], v[212:215]
ds_read_b128 a[56:59], v2 offset:14336
v_mfma_f32_16x16x32_bf16 v[212:215], a[108:111], a[140:143], v[212:215]
v_mfma_f32_16x16x32_bf16 v[216:219], a[112:115], a[136:139], v[216:219]
v_mfma_f32_16x16x32_bf16 v[216:219], a[116:119], a[140:143], v[216:219]
v_mfma_f32_16x16x32_bf16 v[220:223], a[120:123], a[136:139], v[220:223]
ds_read_b128 a[60:63], v3 offset:14336
v_mfma_f32_16x16x32_bf16 v[220:223], a[124:127], a[140:143], v[220:223]
s_waitcnt lgkmcnt(5)
v_mfma_f32_16x16x32_bf16 a[192:195], a[64:67], a[128:131], a[192:195]
s_waitcnt lgkmcnt(3)
ds_read_b64_tr_b16 a[136:137], v11 offset:32768
v_mfma_f32_16x16x32_bf16 a[192:195], a[68:71], a[132:135], a[192:195]
v_mfma_f32_16x16x32_bf16 a[196:199], a[72:75], a[128:131], a[196:199]
ds_read_b64_tr_b16 a[138:139], v11 offset:34816
v_mfma_f32_16x16x32_bf16 a[196:199], a[76:79], a[132:135], a[196:199]
v_mfma_f32_16x16x32_bf16 a[200:203], a[80:83], a[128:131], a[200:203]
ds_read_b64_tr_b16 a[140:141], v11 offset:49152
v_mfma_f32_16x16x32_bf16 a[200:203], a[84:87], a[132:135], a[200:203]
v_mfma_f32_16x16x32_bf16 a[204:207], a[88:91], a[128:131], a[204:207]
ds_read_b64_tr_b16 a[142:143], v11 offset:51200
v_mfma_f32_16x16x32_bf16 a[204:207], a[92:95], a[132:135], a[204:207]
v_mfma_f32_16x16x32_bf16 a[208:211], a[96:99], a[128:131], a[208:211]
v_mfma_f32_16x16x32_bf16 a[208:211], a[100:103], a[132:135], a[208:211]
v_mfma_f32_16x16x32_bf16 a[212:215], a[104:107], a[128:131], a[212:215]
v_mfma_f32_16x16x32_bf16 a[212:215], a[108:111], a[132:135], a[212:215]
v_mfma_f32_16x16x32_bf16 a[216:219], a[112:115], a[128:131], a[216:219]
v_mfma_f32_16x16x32_bf16 a[216:219], a[116:119], a[132:135], a[216:219]
v_mfma_f32_16x16x32_bf16 a[220:223], a[120:123], a[128:131], a[220:223]
v_mfma_f32_16x16x32_bf16 a[220:223], a[124:127], a[132:135], a[220:223]
s_waitcnt vmcnt(2) lgkmcnt(0)
s_barrier
v_mfma_f32_16x16x32_bf16 a[224:227], a[64:67], a[136:139], a[224:227]
s_add_u32 m0, s29, 98304
ds_read_b64_tr_b16 a[128:129], v4 offset:0
v_mfma_f32_16x16x32_bf16 a[224:227], a[68:71], a[140:143], a[224:227]
buffer_load_dwordx4 v16, s[12:15], s26 offen offset:0 lds
v_mfma_f32_16x16x32_bf16 a[228:231], a[72:75], a[136:139], a[228:231]
ds_read_b64_tr_b16 a[130:131], v4 offset:2048
v_mfma_f32_16x16x32_bf16 a[228:231], a[76:79], a[140:143], a[228:231]
v_mfma_f32_16x16x32_bf16 a[232:235], a[80:83], a[136:139], a[232:235]
ds_read_b64_tr_b16 a[132:133], v4 offset:16384
v_mfma_f32_16x16x32_bf16 a[232:235], a[84:87], a[140:143], a[232:235]
buffer_load_dwordx4 v17, s[12:15], s26 offen offset:1024 lds
v_mfma_f32_16x16x32_bf16 a[236:239], a[88:91], a[136:139], a[236:239]
ds_read_b64_tr_b16 a[134:135], v4 offset:18432
v_mfma_f32_16x16x32_bf16 a[236:239], a[92:95], a[140:143], a[236:239]
v_mfma_f32_16x16x32_bf16 a[240:243], a[96:99], a[136:139], a[240:243]
v_mfma_f32_16x16x32_bf16 a[240:243], a[100:103], a[140:143], a[240:243]
buffer_load_dwordx4 v18, s[12:15], s26 offen offset:2048 lds
v_mfma_f32_16x16x32_bf16 a[244:247], a[104:107], a[136:139], a[244:247]
v_mfma_f32_16x16x32_bf16 a[244:247], a[108:111], a[140:143], a[244:247]
v_mfma_f32_16x16x32_bf16 a[248:251], a[112:115], a[136:139], a[248:251]
v_mfma_f32_16x16x32_bf16 a[248:251], a[116:119], a[140:143], a[248:251]
buffer_load_dwordx4 v19, s[12:15], s26 offen offset:3072 lds
v_mfma_f32_16x16x32_bf16 a[252:255], a[120:123], a[136:139], a[252:255]
s_add_u32 s26, s26, 524288
v_mfma_f32_16x16x32_bf16 a[252:255], a[124:127], a[140:143], a[252:255]
s_waitcnt lgkmcnt(2)
buffer_store_dword v27, v26, s[4:7], s82 offen sc1
v_mfma_f32_16x16x32_bf16 v[32:35], a[0:3], a[128:131], v[32:35]
s_waitcnt lgkmcnt(0)
s_add_u32 m0, s29, 114688
ds_read_b64_tr_b16 a[136:137], v5 offset:0
v_mfma_f32_16x16x32_bf16 v[32:35], a[4:7], a[132:135], v[32:35]
buffer_load_dwordx4 v16, s[12:15], s27 offen offset:0 lds
v_mfma_f32_16x16x32_bf16 v[36:39], a[8:11], a[128:131], v[36:39]
ds_read_b64_tr_b16 a[138:139], v5 offset:2048
v_mfma_f32_16x16x32_bf16 v[36:39], a[12:15], a[132:135], v[36:39]
v_mfma_f32_16x16x32_bf16 v[40:43], a[16:19], a[128:131], v[40:43]
ds_read_b64_tr_b16 a[140:141], v5 offset:16384
v_mfma_f32_16x16x32_bf16 v[40:43], a[20:23], a[132:135], v[40:43]
buffer_load_dwordx4 v17, s[12:15], s27 offen offset:1024 lds
v_mfma_f32_16x16x32_bf16 v[44:47], a[24:27], a[128:131], v[44:47]
ds_read_b64_tr_b16 a[142:143], v5 offset:18432
v_mfma_f32_16x16x32_bf16 v[44:47], a[28:31], a[132:135], v[44:47]
v_mfma_f32_16x16x32_bf16 v[48:51], a[32:35], a[128:131], v[48:51]
ds_read_b128 a[64:67], v2 offset:32768
v_mfma_f32_16x16x32_bf16 v[48:51], a[36:39], a[132:135], v[48:51]
buffer_load_dwordx4 v18, s[12:15], s27 offen offset:2048 lds
v_mfma_f32_16x16x32_bf16 v[52:55], a[40:43], a[128:131], v[52:55]
ds_read_b128 a[68:71], v3 offset:32768
v_mfma_f32_16x16x32_bf16 v[52:55], a[44:47], a[132:135], v[52:55]
v_mfma_f32_16x16x32_bf16 v[56:59], a[48:51], a[128:131], v[56:59]
v_mfma_f32_16x16x32_bf16 v[56:59], a[52:55], a[132:135], v[56:59]
buffer_load_dwordx4 v19, s[12:15], s27 offen offset:3072 lds
v_mfma_f32_16x16x32_bf16 v[60:63], a[56:59], a[128:131], v[60:63]
s_add_u32 s27, s27, 524288
ds_read_b128 a[72:75], v2 offset:34816
v_mfma_f32_16x16x32_bf16 v[60:63], a[60:63], a[132:135], v[60:63]
s_waitcnt lgkmcnt(5)
v_mfma_f32_16x16x32_bf16 v[64:67], a[0:3], a[136:139], v[64:67]
s_waitcnt lgkmcnt(3)
s_add_u32 m0, s28, 0
ds_read_b64_tr_b16 a[128:129], v6 offset:0
v_mfma_f32_16x16x32_bf16 v[64:67], a[4:7], a[140:143], v[64:67]
buffer_load_dwordx4 v12, s[8:11], s24 offen offset:0 lds
v_mfma_f32_16x16x32_bf16 v[68:71], a[8:11], a[136:139], v[68:71]
ds_read_b64_tr_b16 a[130:131], v6 offset:2048
v_mfma_f32_16x16x32_bf16 v[68:71], a[12:15], a[140:143], v[68:71]
v_mfma_f32_16x16x32_bf16 v[72:75], a[16:19], a[136:139], v[72:75]
ds_read_b64_tr_b16 a[132:133], v6 offset:16384
v_mfma_f32_16x16x32_bf16 v[72:75], a[20:23], a[140:143], v[72:75]
buffer_load_dwordx4 v13, s[8:11], s24 offen offset:1024 lds
v_mfma_f32_16x16x32_bf16 v[76:79], a[24:27], a[136:139], v[76:79]
ds_read_b64_tr_b16 a[134:135], v6 offset:18432
v_mfma_f32_16x16x32_bf16 v[76:79], a[28:31], a[140:143], v[76:79]
v_mfma_f32_16x16x32_bf16 v[80:83], a[32:35], a[136:139], v[80:83]
ds_read_b128 a[76:79], v3 offset:34816
v_mfma_f32_16x16x32_bf16 v[80:83], a[36:39], a[140:143], v[80:83]
buffer_load_dwordx4 v14, s[8:11], s24 offen offset:2048 lds
v_mfma_f32_16x16x32_bf16 v[84:87], a[40:43], a[136:139], v[84:87]
v_mfma_f32_16x16x32_bf16 v[84:87], a[44:47], a[140:143], v[84:87]
v_mfma_f32_16x16x32_bf16 v[88:91], a[48:51], a[136:139], v[88:91]
ds_read_b128 a[80:83], v2 offset:36864
v_mfma_f32_16x16x32_bf16 v[88:91], a[52:55], a[140:143], v[88:91]
buffer_load_dwordx4 v15, s[8:11], s24 offen offset:3072 lds
v_mfma_f32_16x16x32_bf16 v[92:95], a[56:59], a[136:139], v[92:95]
s_add_u32 s24, s24, 128
ds_read_b128 a[84:87], v3 offset:36864
v_mfma_f32_16x16x32_bf16 v[92:95], a[60:63], a[140:143], v[92:95]
s_waitcnt lgkmcnt(5)
v_mfma_f32_16x16x32_bf16 v[96:99], a[0:3], a[128:131], v[96:99]
s_waitcnt lgkmcnt(3)
s_add_u32 m0, s28, 4096
ds_read_b64_tr_b16 a[136:137], v7 offset:0
v_mfma_f32_16x16x32_bf16 v[96:99], a[4:7], a[132:135], v[96:99]
buffer_load_dwordx4 v12, s[8:11], s25 offen offset:0 lds
v_mfma_f32_16x16x32_bf16 v[100:103], a[8:11], a[128:131], v[100:103]
ds_read_b64_tr_b16 a[138:139], v7 offset:2048
v_mfma_f32_16x16x32_bf16 v[100:103], a[12:15], a[132:135], v[100:103]
v_mfma_f32_16x16x32_bf16 v[104:107], a[16:19], a[128:131], v[104:107]
ds_read_b64_tr_b16 a[140:141], v7 offset:16384
v_mfma_f32_16x16x32_bf16 v[104:107], a[20:23], a[132:135], v[104:107]
buffer_load_dwordx4 v13, s[8:11], s25 offen offset:1024 lds
v_mfma_f32_16x16x32_bf16 v[108:111], a[24:27], a[128:131], v[108:111]
ds_read_b64_tr_b16 a[142:143], v7 offset:18432
v_mfma_f32_16x16x32_bf16 v[108:111], a[28:31], a[132:135], v[108:111]
v_mfma_f32_16x16x32_bf16 v[112:115], a[32:35], a[128:131], v[112:115]
v_mfma_f32_16x16x32_bf16 v[112:115], a[36:39], a[132:135], v[112:115]
buffer_load_dwordx4 v14, s[8:11], s25 offen offset:2048 lds
v_mfma_f32_16x16x32_bf16 v[116:119], a[40:43], a[128:131], v[116:119]
ds_read_b128 a[88:91], v2 offset:38912
v_mfma_f32_16x16x32_bf16 v[116:119], a[44:47], a[132:135], v[116:119]
v_mfma_f32_16x16x32_bf16 v[120:123], a[48:51], a[128:131], v[120:123]
ds_read_b128 a[92:95], v3 offset:38912
v_mfma_f32_16x16x32_bf16 v[120:123], a[52:55], a[132:135], v[120:123]
buffer_load_dwordx4 v15, s[8:11], s25 offen offset:3072 lds
v_mfma_f32_16x16x32_bf16 v[124:127], a[56:59], a[128:131], v[124:127]
s_add_u32 s25, s25, 128
v_mfma_f32_16x16x32_bf16 v[124:127], a[60:63], a[132:135], v[124:127]
s_waitcnt lgkmcnt(4)
v_mfma_f32_16x16x32_bf16 v[128:131], a[0:3], a[136:139], v[128:131]
s_waitcnt lgkmcnt(2)
ds_read_b64_tr_b16 a[128:129], v8 offset:0
v_mfma_f32_16x16x32_bf16 v[128:131], a[4:7], a[140:143], v[128:131]
buffer_load_dword v21, v20, s[16:19], s43 offen
v_mfma_f32_16x16x32_bf16 v[132:135], a[8:11], a[136:139], v[132:135]
s_add_u32 s43, s43, s47
ds_read_b64_tr_b16 a[130:131], v8 offset:2048
v_mfma_f32_16x16x32_bf16 v[132:135], a[12:15], a[140:143], v[132:135]
s_cmp_ge_u32 s43, s51
v_mfma_f32_16x16x32_bf16 v[136:139], a[16:19], a[136:139], v[136:139]
s_cselect_b32 s43, 0, s43
ds_read_b64_tr_b16 a[132:133], v8 offset:16384
v_mfma_f32_16x16x32_bf16 v[136:139], a[20:23], a[140:143], v[136:139]
s_cselect_b32 s51, s42, s51
v_mfma_f32_16x16x32_bf16 v[140:143], a[24:27], a[136:139], v[140:143]
s_cselect_b64 s[16:17], s[40:41], s[16:17]
ds_read_b64_tr_b16 a[134:135], v8 offset:18432
v_mfma_f32_16x16x32_bf16 v[140:143], a[28:31], a[140:143], v[140:143]
s_cselect_b32 s18, s42, s18
v_mfma_f32_16x16x32_bf16 v[144:147], a[32:35], a[136:139], v[144:147]
s_cselect_b64 s[40:41], s[44:45], s[40:41]
ds_read_b128 a[96:99], v2 offset:40960
v_mfma_f32_16x16x32_bf16 v[144:147], a[36:39], a[140:143], v[144:147]
s_cselect_b32 s42, s46, s42
v_mfma_f32_16x16x32_bf16 v[148:151], a[40:43], a[136:139], v[148:151]
s_cselect_b32 s46, 0, s46
v_mfma_f32_16x16x32_bf16 v[148:151], a[44:47], a[140:143], v[148:151]
s_cmp_eq_u32 s30, s55
v_mfma_f32_16x16x32_bf16 v[152:155], a[48:51], a[136:139], v[152:155]
s_cselect_b32 s22, 0, 3221225472
ds_read_b128 a[100:103], v3 offset:40960
v_mfma_f32_16x16x32_bf16 v[152:155], a[52:55], a[140:143], v[152:155]
s_sub_u32 s30, s30, 1
buffer_atomic_add v27, v26, s[60:63], s22 offen sc1
v_mfma_f32_16x16x32_bf16 v[156:159], a[56:59], a[136:139], v[156:159]
ds_read_b128 a[104:107], v2 offset:43008
v_mfma_f32_16x16x32_bf16 v[156:159], a[60:63], a[140:143], v[156:159]
s_waitcnt lgkmcnt(5)
v_mfma_f32_16x16x32_bf16 v[160:163], a[0:3], a[128:131], v[160:163]
s_waitcnt lgkmcnt(3)
ds_read_b64_tr_b16 a[136:137], v9 offset:0
v_mfma_f32_16x16x32_bf16 v[160:163], a[4:7], a[132:135], v[160:163]
v_mfma_f32_16x16x32_bf16 v[164:167], a[8:11], a[128:131], v[164:167]
ds_read_b64_tr_b16 a[138:139], v9 offset:2048
v_mfma_f32_16x16x32_bf16 v[164:167], a[12:15], a[132:135], v[164:167]
v_mfma_f32_16x16x32_bf16 v[168:171], a[16:19], a[128:131], v[168:171]
ds_read_b64_tr_b16 a[140:141], v9 offset:16384
v_mfma_f32_16x16x32_bf16 v[168:171], a[20:23], a[132:135], v[168:171]
v_mfma_f32_16x16x32_bf16 v[172:175], a[24:27], a[128:131], v[172:175]
ds_read_b64_tr_b16 a[142:143], v9 offset:18432
v_mfma_f32_16x16x32_bf16 v[172:175], a[28:31], a[132:135], v[172:175]
v_mfma_f32_16x16x32_bf16 v[176:179], a[32:35], a[128:131], v[176:179]
v_mfma_f32_16x16x32_bf16 v[176:179], a[36:39], a[132:135], v[176:179]
v_mfma_f32_16x16x32_bf16 v[180:183], a[40:43], a[128:131], v[180:183]
ds_read_b128 a[108:111], v3 offset:43008
v_mfma_f32_16x16x32_bf16 v[180:183], a[44:47], a[132:135], v[180:183]
v_mfma_f32_16x16x32_bf16 v[184:187], a[48:51], a[128:131], v[184:187]
ds_read_b128 a[112:115], v2 offset:45056
v_mfma_f32_16x16x32_bf16 v[184:187], a[52:55], a[132:135], v[184:187]
v_mfma_f32_16x16x32_bf16 v[188:191], a[56:59], a[128:131], v[188:191]
v_mfma_f32_16x16x32_bf16 v[188:191], a[60:63], a[132:135], v[188:191]
s_waitcnt lgkmcnt(4)
v_mfma_f32_16x16x32_bf16 v[192:195], a[0:3], a[136:139], v[192:195]
s_waitcnt lgkmcnt(2)
ds_read_b64_tr_b16 a[128:129], v10 offset:0
v_mfma_f32_16x16x32_bf16 v[192:195], a[4:7], a[140:143], v[192:195]
v_mfma_f32_16x16x32_bf16 v[196:199], a[8:11], a[136:139], v[196:199]
ds_read_b64_tr_b16 a[130:131], v10 offset:2048
v_mfma_f32_16x16x32_bf16 v[196:199], a[12:15], a[140:143], v[196:199]
v_mfma_f32_16x16x32_bf16 v[200:203], a[16:19], a[136:139], v[200:203]
ds_read_b64_tr_b16 a[132:133], v10 offset:16384
v_mfma_f32_16x16x32_bf16 v[200:203], a[20:23], a[140:143], v[200:203]
v_mfma_f32_16x16x32_bf16 v[204:207], a[24:27], a[136:139], v[204:207]
ds_read_b64_tr_b16 a[134:135], v10 offset:18432
v_mfma_f32_16x16x32_bf16 v[204:207], a[28:31], a[140:143], v[204:207]
v_mfma_f32_16x16x32_bf16 v[208:211], a[32:35], a[136:139], v[208:211]
ds_read_b128 a[116:119], v3 offset:45056
v_mfma_f32_16x16x32_bf16 v[208:211], a[36:39], a[140:143], v[208:211]
v_mfma_f32_16x16x32_bf16 v[212:215], a[40:43], a[136:139], v[212:215]
ds_read_b128 a[120:123], v2 offset:47104
v_mfma_f32_16x16x32_bf16 v[212:215], a[44:47], a[140:143], v[212:215]
v_mfma_f32_16x16x32_bf16 v[216:219], a[48:51], a[136:139], v[216:219]
v_mfma_f32_16x16x32_bf16 v[216:219], a[52:55], a[140:143], v[216:219]
v_mfma_f32_16x16x32_bf16 v[220:223], a[56:59], a[136:139], v[220:223]
ds_read_b128 a[124:127], v3 offset:47104
v_mfma_f32_16x16x32_bf16 v[220:223], a[60:63], a[140:143], v[220:223]
s_waitcnt lgkmcnt(5)
v_mfma_f32_16x16x32_bf16 a[192:195], a[0:3], a[128:131], a[192:195]
s_waitcnt lgkmcnt(3)
ds_read_b64_tr_b16 a[136:137], v11 offset:0
v_mfma_f32_16x16x32_bf16 a[192:195], a[4:7], a[132:135], a[192:195]
v_mfma_f32_16x16x32_bf16 a[196:199], a[8:11], a[128:131], a[196:199]
ds_read_b64_tr_b16 a[138:139], v11 offset:2048
v_mfma_f32_16x16x32_bf16 a[196:199], a[12:15], a[132:135], a[196:199]
v_mfma_f32_16x16x32_bf16 a[200:203], a[16:19], a[128:131], a[200:203]
ds_read_b64_tr_b16 a[140:141], v11 offset:16384
v_mfma_f32_16x16x32_bf16 a[200:203], a[20:23], a[132:135], a[200:203]
v_mfma_f32_16x16x32_bf16 a[204:207], a[24:27], a[128:131], a[204:207]
ds_read_b64_tr_b16 a[142:143], v11 offset:18432
v_mfma_f32_16x16x32_bf16 a[204:207], a[28:31], a[132:135], a[204:207]
v_mfma_f32_16x16x32_bf16 a[208:211], a[32:35], a[128:131], a[208:211]
v_mfma_f32_16x16x32_bf16 a[208:211], a[36:39], a[132:135], a[208:211]
v_mfma_f32_16x16x32_bf16 a[212:215], a[40:43], a[128:131], a[212:215]
v_mfma_f32_16x16x32_bf16 a[212:215], a[44:47], a[132:135], a[212:215]
v_mfma_f32_16x16x32_bf16 a[216:219], a[48:51], a[128:131], a[216:219]
v_mfma_f32_16x16x32_bf16 a[216:219], a[52:55], a[132:135], a[216:219]
v_mfma_f32_16x16x32_bf16 a[220:223], a[56:59], a[128:131], a[220:223]
v_mfma_f32_16x16x32_bf16 a[220:223], a[60:63], a[132:135], a[220:223]
s_waitcnt vmcnt(2) lgkmcnt(0)
s_barrier
v_mfma_f32_16x16x32_bf16 a[224:227], a[0:3], a[136:139], a[224:227]
s_add_u32 m0, s29, 65536
ds_read_b64_tr_b16 a[128:129], v4 offset:32768
v_mfma_f32_16x16x32_bf16 a[224:227], a[4:7], a[140:143], a[224:227]
buffer_load_dwordx4 v16, s[12:15], s26 offen offset:0 lds
v_mfma_f32_16x16x32_bf16 a[228:231], a[8:11], a[136:139], a[228:231]
ds_read_b64_tr_b16 a[130:131], v4 offset:34816
v_mfma_f32_16x16x32_bf16 a[228:231], a[12:15], a[140:143], a[228:231]
v_mfma_f32_16x16x32_bf16 a[232:235], a[16:19], a[136:139], a[232:235]
ds_read_b64_tr_b16 a[132:133], v4 offset:49152
v_mfma_f32_16x16x32_bf16 a[232:235], a[20:23], a[140:143], a[232:235]
buffer_load_dwordx4 v17, s[12:15], s26 offen offset:1024 lds
v_mfma_f32_16x16x32_bf16 a[236:239], a[24:27], a[136:139], a[236:239]
ds_read_b64_tr_b16 a[134:135], v4 offset:51200
v_mfma_f32_16x16x32_bf16 a[236:239], a[28:31], a[140:143], a[236:239]
v_mfma_f32_16x16x32_bf16 a[240:243], a[32:35], a[136:139], a[240:243]
v_mfma_f32_16x16x32_bf16 a[240:243], a[36:39], a[140:143], a[240:243]
buffer_load_dwordx4 v18, s[12:15], s26 offen offset:2048 lds
v_mfma_f32_16x16x32_bf16 a[244:247], a[40:43], a[136:139], a[244:247]
v_mfma_f32_16x16x32_bf16 a[244:247], a[44:47], a[140:143], a[244:247]
v_mfma_f32_16x16x32_bf16 a[248:251], a[48:51], a[136:139], a[248:251]
v_mfma_f32_16x16x32_bf16 a[248:251], a[52:55], a[140:143], a[248:251]
buffer_load_dwordx4 v19, s[12:15], s26 offen offset:3072 lds
v_mfma_f32_16x16x32_bf16 a[252:255], a[56:59], a[136:139], a[252:255]
s_add_u32 s26, s26, 524288
v_mfma_f32_16x16x32_bf16 a[252:255], a[60:63], a[140:143], a[252:255]
s_waitcnt lgkmcnt(2)
s_bitcmp1_b32 s30, 1
s_cbranch_scc1 Lg_2
s_cmp_eq_u32 s30, 0
s_cbranch_scc1 Lg_2t
v_mfma_f32_16x16x32_bf16 v[32:35], a[64:67], a[128:131], v[32:35]
s_waitcnt lgkmcnt(0)
s_add_u32 m0, s29, 81920
ds_read_b64_tr_b16 a[136:137], v5 offset:32768
v_mfma_f32_16x16x32_bf16 v[32:35], a[68:71], a[132:135], v[32:35]
buffer_load_dwordx4 v16, s[12:15], s27 offen offset:0 lds
v_mfma_f32_16x16x32_bf16 v[36:39], a[72:75], a[128:131], v[36:39]
s_lshl_b32 s22, s38, 3
ds_read_b64_tr_b16 a[138:139], v5 offset:34816
v_mfma_f32_16x16x32_bf16 v[36:39], a[76:79], a[132:135], v[36:39]
s_lshl_b32 s23, s39, 5
v_and_b32 v252, 31, v0
v_lshrrev_b32 v253, 5, v0
v_mfma_f32_16x16x32_bf16 v[40:43], a[80:83], a[128:131], v[40:43]
ds_read_b64_tr_b16 a[140:141], v5 offset:49152
v_add_u32 v253, s22, v253
v_mfma_f32_16x16x32_bf16 v[40:43], a[84:87], a[132:135], v[40:43]
buffer_load_dwordx4 v17, s[12:15], s27 offen offset:1024 lds
v_mfma_f32_16x16x32_bf16 v[44:47], a[88:91], a[128:131], v[44:47]
ds_read_b64_tr_b16 a[142:143], v5 offset:51200
v_add_u32 v252, s23, v252
v_mfma_f32_16x16x32_bf16 v[44:47], a[92:95], a[132:135], v[44:47]
v_mul_u32_u24 v254, 7168, v253
v_lshl_add_u32 v254, v252, 2, v254
v_mfma_f32_16x16x32_bf16 v[48:51], a[96:99], a[128:131], v[48:51]
ds_read_b128 a[0:3], v2 offset:0
v_lshlrev_b32 v252, 4, v252
v_mfma_f32_16x16x32_bf16 v[48:51], a[100:103], a[132:135], v[48:51]
buffer_load_dwordx4 v18, s[12:15], s27 offen offset:2048 lds
v_mfma_f32_16x16x32_bf16 v[52:55], a[104:107], a[128:131], v[52:55]
ds_read_b128 a[4:7], v3 offset:0
v_add_u32 v255, 3584, v254
v_mfma_f32_16x16x32_bf16 v[52:55], a[108:111], a[132:135], v[52:55]
v_subrev_u32 v22, 3584, v254
v_subrev_u32 v23, 2688, v254
v_mfma_f32_16x16x32_bf16 v[56:59], a[112:115], a[128:131], v[56:59]
v_subrev_u32 v24, 1792, v254
v_subrev_u32 v25, 896, v254
v_mfma_f32_16x16x32_bf16 v[56:59], a[116:119], a[132:135], v[56:59]
buffer_load_dwordx4 v19, s[12:15], s27 offen offset:3072 lds
v_mfma_f32_16x16x32_bf16 v[60:63], a[120:123], a[128:131], v[60:63]
s_add_u32 s27, s27, 524288
ds_read_b128 a[8:11], v2 offset:2048
v_mfma_f32_16x16x32_bf16 v[60:63], a[124:127], a[132:135], v[60:63]
s_waitcnt lgkmcnt(5)
v_mfma_f32_16x16x32_bf16 v[64:67], a[64:67], a[136:139], v[64:67]
s_waitcnt lgkmcnt(3)
s_add_u32 m0, s28, 32768
ds_read_b64_tr_b16 a[128:129], v6 offset:32768
v_mfma_f32_16x16x32_bf16 v[64:67], a[68:71], a[140:143], v[64:67]
buffer_load_dwordx4 v12, s[8:11], s24 offen offset:0 lds
v_mfma_f32_16x16x32_bf16 v[68:71], a[72:75], a[136:139], v[68:71]
ds_read_b64_tr_b16 a[130:131], v6 offset:34816
v_mfma_f32_16x16x32_bf16 v[68:71], a[76:79], a[140:143], v[68:71]
v_mfma_f32_16x16x32_bf16 v[72:75], a[80:83], a[136:139], v[72:75]
ds_read_b64_tr_b16 a[132:133], v6 offset:49152
v_mfma_f32_16x16x32_bf16 v[72:75], a[84:87], a[140:143], v[72:75]
buffer_load_dwordx4 v13, s[8:11], s24 offen offset:1024 lds
v_mfma_f32_16x16x32_bf16 v[76:79], a[88:91], a[136:139], v[76:79]
ds_read_b64_tr_b16 a[134:135], v6 offset:51200
v_mfma_f32_16x16x32_bf16 v[76:79], a[92:95], a[140:143], v[76:79]
v_mfma_f32_16x16x32_bf16 v[80:83], a[96:99], a[136:139], v[80:83]
ds_read_b128 a[12:15], v3 offset:2048
v_mfma_f32_16x16x32_bf16 v[80:83], a[100:103], a[140:143], v[80:83]
buffer_load_dwordx4 v14, s[8:11], s24 offen offset:2048 lds
v_mfma_f32_16x16x32_bf16 v[84:87], a[104:107], a[136:139], v[84:87]
v_mfma_f32_16x16x32_bf16 v[84:87], a[108:111], a[140:143], v[84:87]
v_mfma_f32_16x16x32_bf16 v[88:91], a[112:115], a[136:139], v[88:91]
ds_read_b128 a[16:19], v2 offset:4096
v_mfma_f32_16x16x32_bf16 v[88:91], a[116:119], a[140:143], v[88:91]
buffer_load_dwordx4 v15, s[8:11], s24 offen offset:3072 lds
v_mfma_f32_16x16x32_bf16 v[92:95], a[120:123], a[136:139], v[92:95]
s_add_u32 s24, s24, 128
ds_read_b128 a[20:23], v3 offset:4096
v_mfma_f32_16x16x32_bf16 v[92:95], a[124:127], a[140:143], v[92:95]
s_waitcnt lgkmcnt(5)
v_mfma_f32_16x16x32_bf16 v[96:99], a[64:67], a[128:131], v[96:99]
s_waitcnt lgkmcnt(3)
s_add_u32 m0, s28, 36864
ds_read_b64_tr_b16 a[136:137], v7 offset:32768
v_mfma_f32_16x16x32_bf16 v[96:99], a[68:71], a[132:135], v[96:99]
buffer_load_dwordx4 v12, s[8:11], s25 offen offset:0 lds
v_mfma_f32_16x16x32_bf16 v[100:103], a[72:75], a[128:131], v[100:103]
ds_read_b64_tr_b16 a[138:139], v7 offset:34816
v_mfma_f32_16x16x32_bf16 v[100:103], a[76:79], a[132:135], v[100:103]
v_mfma_f32_16x16x32_bf16 v[104:107], a[80:83], a[128:131], v[104:107]
ds_read_b64_tr_b16 a[140:141], v7 offset:49152
v_mfma_f32_16x16x32_bf16 v[104:107], a[84:87], a[132:135], v[104:107]
buffer_load_dwordx4 v13, s[8:11], s25 offen offset:1024 lds
v_mfma_f32_16x16x32_bf16 v[108:111], a[88:91], a[128:131], v[108:111]
ds_read_b64_tr_b16 a[142:143], v7 offset:51200
v_mfma_f32_16x16x32_bf16 v[108:111], a[92:95], a[132:135], v[108:111]
v_mfma_f32_16x16x32_bf16 v[112:115], a[96:99], a[128:131], v[112:115]
v_mfma_f32_16x16x32_bf16 v[112:115], a[100:103], a[132:135], v[112:115]
buffer_load_dwordx4 v14, s[8:11], s25 offen offset:2048 lds
v_mfma_f32_16x16x32_bf16 v[116:119], a[104:107], a[128:131], v[116:119]
ds_read_b128 a[24:27], v2 offset:6144
v_mfma_f32_16x16x32_bf16 v[116:119], a[108:111], a[132:135], v[116:119]
v_mfma_f32_16x16x32_bf16 v[120:123], a[112:115], a[128:131], v[120:123]
ds_read_b128 a[28:31], v3 offset:6144
v_mfma_f32_16x16x32_bf16 v[120:123], a[116:119], a[132:135], v[120:123]
buffer_load_dwordx4 v15, s[8:11], s25 offen offset:3072 lds
v_mfma_f32_16x16x32_bf16 v[124:127], a[120:123], a[128:131], v[124:127]
s_add_u32 s25, s25, 128
v_mfma_f32_16x16x32_bf16 v[124:127], a[124:127], a[132:135], v[124:127]
s_waitcnt lgkmcnt(2)
v_mfma_f32_16x16x32_bf16 v[128:131], a[64:67], a[136:139], v[128:131]
s_mov_b64 s[56:57], s[70:71]
s_mov_b32 s58, 3584
s_mov_b32 s59, 0x20000
ds_read_b64_tr_b16 a[128:129], v8 offset:32768
buffer_load_dwordx4 v[248:251], v252, s[56:59], 0 offen
v_mfma_f32_16x16x32_bf16 v[128:131], a[68:71], a[140:143], v[128:131]
s_mov_b64 s[56:57], s[66:67]
s_mov_b32 s58, 1835008
buffer_load_dword v224, v22, s[56:59], 0 offen nt
v_mfma_f32_16x16x32_bf16 v[132:135], a[72:75], a[136:139], v[132:135]
ds_read_b64_tr_b16 a[130:131], v8 offset:34816
buffer_load_dword v225, v23, s[56:59], 0 offen nt
v_mfma_f32_16x16x32_bf16 v[132:135], a[76:79], a[140:143], v[132:135]
buffer_load_dword v226, v24, s[56:59], 0 offen nt
v_mfma_f32_16x16x32_bf16 v[136:139], a[80:83], a[136:139], v[136:139]
ds_read_b64_tr_b16 a[132:133], v8 offset:49152
buffer_load_dword v227, v25, s[56:59], 0 offen nt
v_mfma_f32_16x16x32_bf16 v[136:139], a[84:87], a[140:143], v[136:139]
buffer_load_dword v228, v254, s[56:59], 0 offen offset:0 nt
v_mfma_f32_16x16x32_bf16 v[140:143], a[88:91], a[136:139], v[140:143]
ds_read_b64_tr_b16 a[134:135], v8 offset:51200
buffer_load_dword v229, v254, s[56:59], 0 offen offset:896 nt
v_mfma_f32_16x16x32_bf16 v[140:143], a[92:95], a[140:143], v[140:143]
buffer_load_dword v230, v254, s[56:59], 0 offen offset:1792 nt
v_mfma_f32_16x16x32_bf16 v[144:147], a[96:99], a[136:139], v[144:147]
ds_read_b128 a[32:35], v2 offset:8192
buffer_load_dword v231, v254, s[56:59], 0 offen offset:2688 nt
v_mfma_f32_16x16x32_bf16 v[144:147], a[100:103], a[140:143], v[144:147]
buffer_load_dword v232, v255, s[56:59], 0 offen offset:0 nt
v_mfma_f32_16x16x32_bf16 v[148:151], a[104:107], a[136:139], v[148:151]
buffer_load_dword v233, v255, s[56:59], 0 offen offset:896 nt
v_mfma_f32_16x16x32_bf16 v[148:151], a[108:111], a[140:143], v[148:151]
buffer_load_dword v234, v255, s[56:59], 0 offen offset:1792 nt
v_mfma_f32_16x16x32_bf16 v[152:155], a[112:115], a[136:139], v[152:155]
ds_read_b128 a[36:39], v3 offset:8192
buffer_load_dword v235, v255, s[56:59], 0 offen offset:2688 nt
v_mfma_f32_16x16x32_bf16 v[152:155], a[116:119], a[140:143], v[152:155]
s_mov_b64 s[56:57], s[68:69]
buffer_load_dword v236, v25, s[56:59], 0 offen nt
v_mfma_f32_16x16x32_bf16 v[156:159], a[120:123], a[136:139], v[156:159]
ds_read_b128 a[40:43], v2 offset:10240
buffer_load_dword v237, v254, s[56:59], 0 offen offset:0 nt
v_mfma_f32_16x16x32_bf16 v[156:159], a[124:127], a[140:143], v[156:159]
s_waitcnt lgkmcnt(5)
buffer_load_dword v238, v254, s[56:59], 0 offen offset:896 nt
v_mfma_f32_16x16x32_bf16 v[160:163], a[64:67], a[128:131], v[160:163]
s_waitcnt lgkmcnt(3)
ds_read_b64_tr_b16 a[136:137], v9 offset:32768
buffer_load_dword v239, v254, s[56:59], 0 offen offset:1792 nt
v_mfma_f32_16x16x32_bf16 v[160:163], a[68:71], a[132:135], v[160:163]
buffer_load_dword v240, v254, s[56:59], 0 offen offset:2688 nt
v_mfma_f32_16x16x32_bf16 v[164:167], a[72:75], a[128:131], v[164:167]
ds_read_b64_tr_b16 a[138:139], v9 offset:34816
buffer_load_dword v241, v255, s[56:59], 0 offen offset:0 nt
v_mfma_f32_16x16x32_bf16 v[164:167], a[76:79], a[132:135], v[164:167]
buffer_load_dword v242, v255, s[56:59], 0 offen offset:896 nt
v_mfma_f32_16x16x32_bf16 v[168:171], a[80:83], a[128:131], v[168:171]
ds_read_b64_tr_b16 a[140:141], v9 offset:49152
buffer_load_dword v243, v255, s[56:59], 0 offen offset:1792 nt
v_mfma_f32_16x16x32_bf16 v[168:171], a[84:87], a[132:135], v[168:171]
buffer_load_dword v244, v255, s[56:59], 0 offen offset:2688 nt
v_mfma_f32_16x16x32_bf16 v[172:175], a[88:91], a[128:131], v[172:175]
ds_read_b64_tr_b16 a[142:143], v9 offset:51200
v_mfma_f32_16x16x32_bf16 v[172:175], a[92:95], a[132:135], v[172:175]
v_mfma_f32_16x16x32_bf16 v[176:179], a[96:99], a[128:131], v[176:179]
v_mfma_f32_16x16x32_bf16 v[176:179], a[100:103], a[132:135], v[176:179]
v_mfma_f32_16x16x32_bf16 v[180:183], a[104:107], a[128:131], v[180:183]
ds_read_b128 a[44:47], v3 offset:10240
v_mfma_f32_16x16x32_bf16 v[180:183], a[108:111], a[132:135], v[180:183]
v_mfma_f32_16x16x32_bf16 v[184:187], a[112:115], a[128:131], v[184:187]
ds_read_b128 a[48:51], v2 offset:12288
v_mfma_f32_16x16x32_bf16 v[184:187], a[116:119], a[132:135], v[184:187]
v_mfma_f32_16x16x32_bf16 v[188:191], a[120:123], a[128:131], v[188:191]
v_mfma_f32_16x16x32_bf16 v[188:191], a[124:127], a[132:135], v[188:191]
s_waitcnt lgkmcnt(4)
v_mfma_f32_16x16x32_bf16 v[192:195], a[64:67], a[136:139], v[192:195]
s_waitcnt lgkmcnt(2)
ds_read_b64_tr_b16 a[128:129], v10 offset:32768
v_mfma_f32_16x16x32_bf16 v[192:195], a[68:71], a[140:143], v[192:195]
v_mfma_f32_16x16x32_bf16 v[196:199], a[72:75], a[136:139], v[196:199]
ds_read_b64_tr_b16 a[130:131], v10 offset:34816
v_mfma_f32_16x16x32_bf16 v[196:199], a[76:79], a[140:143], v[196:199]
v_mfma_f32_16x16x32_bf16 v[200:203], a[80:83], a[136:139], v[200:203]
ds_read_b64_tr_b16 a[132:133], v10 offset:49152
v_mfma_f32_16x16x32_bf16 v[200:203], a[84:87], a[140:143], v[200:203]
v_mfma_f32_16x16x32_bf16 v[204:207], a[88:91], a[136:139], v[204:207]
ds_read_b64_tr_b16 a[134:135], v10 offset:51200
v_mfma_f32_16x16x32_bf16 v[204:207], a[92:95], a[140:143], v[204:207]
v_mfma_f32_16x16x32_bf16 v[208:211], a[96:99], a[136:139], v[208:211]
ds_read_b128 a[52:55], v3 offset:12288
v_mfma_f32_16x16x32_bf16 v[208:211], a[100:103], a[140:143], v[208:211]
v_mfma_f32_16x16x32_bf16 v[212:215], a[104:107], a[136:139], v[212:215]
ds_read_b128 a[56:59], v2 offset:14336
v_mfma_f32_16x16x32_bf16 v[212:215], a[108:111], a[140:143], v[212:215]
v_mfma_f32_16x16x32_bf16 v[216:219], a[112:115], a[136:139], v[216:219]
v_mfma_f32_16x16x32_bf16 v[216:219], a[116:119], a[140:143], v[216:219]
v_mfma_f32_16x16x32_bf16 v[220:223], a[120:123], a[136:139], v[220:223]
ds_read_b128 a[60:63], v3 offset:14336
v_mfma_f32_16x16x32_bf16 v[220:223], a[124:127], a[140:143], v[220:223]
s_waitcnt lgkmcnt(5)
v_mfma_f32_16x16x32_bf16 a[192:195], a[64:67], a[128:131], a[192:195]
s_waitcnt lgkmcnt(3)
ds_read_b64_tr_b16 a[136:137], v11 offset:32768
v_mfma_f32_16x16x32_bf16 a[192:195], a[68:71], a[132:135], a[192:195]
v_mfma_f32_16x16x32_bf16 a[196:199], a[72:75], a[128:131], a[196:199]
ds_read_b64_tr_b16 a[138:139], v11 offset:34816
v_mfma_f32_16x16x32_bf16 a[196:199], a[76:79], a[132:135], a[196:199]
v_mfma_f32_16x16x32_bf16 a[200:203], a[80:83], a[128:131], a[200:203]
ds_read_b64_tr_b16 a[140:141], v11 offset:49152
v_mfma_f32_16x16x32_bf16 a[200:203], a[84:87], a[132:135], a[200:203]
v_mfma_f32_16x16x32_bf16 a[204:207], a[88:91], a[128:131], a[204:207]
ds_read_b64_tr_b16 a[142:143], v11 offset:51200
v_mfma_f32_16x16x32_bf16 a[204:207], a[92:95], a[132:135], a[204:207]
v_mfma_f32_16x16x32_bf16 a[208:211], a[96:99], a[128:131], a[208:211]
v_mfma_f32_16x16x32_bf16 a[208:211], a[100:103], a[132:135], a[208:211]
v_mfma_f32_16x16x32_bf16 a[212:215], a[104:107], a[128:131], a[212:215]
v_mfma_f32_16x16x32_bf16 a[212:215], a[108:111], a[132:135], a[212:215]
v_mfma_f32_16x16x32_bf16 a[216:219], a[112:115], a[128:131], a[216:219]
v_mfma_f32_16x16x32_bf16 a[216:219], a[116:119], a[132:135], a[216:219]
v_mfma_f32_16x16x32_bf16 a[220:223], a[120:123], a[128:131], a[220:223]
v_mfma_f32_16x16x32_bf16 a[220:223], a[124:127], a[132:135], a[220:223]
s_waitcnt vmcnt(22) lgkmcnt(0)
s_barrier
v_mfma_f32_16x16x32_bf16 a[224:227], a[64:67], a[136:139], a[224:227]
s_add_u32 m0, s29, 98304
ds_read_b64_tr_b16 a[128:129], v4 offset:0
v_mfma_f32_16x16x32_bf16 a[224:227], a[68:71], a[140:143], a[224:227]
buffer_load_dwordx4 v16, s[12:15], s26 offen offset:0 lds
v_mfma_f32_16x16x32_bf16 a[228:231], a[72:75], a[136:139], a[228:231]
ds_read_b64_tr_b16 a[130:131], v4 offset:2048
v_mfma_f32_16x16x32_bf16 a[228:231], a[76:79], a[140:143], a[228:231]
v_mfma_f32_16x16x32_bf16 a[232:235], a[80:83], a[136:139], a[232:235]
ds_read_b64_tr_b16 a[132:133], v4 offset:16384
v_mfma_f32_16x16x32_bf16 a[232:235], a[84:87], a[140:143], a[232:235]
buffer_load_dwordx4 v17, s[12:15], s26 offen offset:1024 lds
v_mfma_f32_16x16x32_bf16 a[236:239], a[88:91], a[136:139], a[236:239]
ds_read_b64_tr_b16 a[134:135], v4 offset:18432
v_mfma_f32_16x16x32_bf16 a[236:239], a[92:95], a[140:143], a[236:239]
v_mfma_f32_16x16x32_bf16 a[240:243], a[96:99], a[136:139], a[240:243]
v_mfma_f32_16x16x32_bf16 a[240:243], a[100:103], a[140:143], a[240:243]
buffer_load_dwordx4 v18, s[12:15], s26 offen offset:2048 lds
v_mfma_f32_16x16x32_bf16 a[244:247], a[104:107], a[136:139], a[244:247]
v_mfma_f32_16x16x32_bf16 a[244:247], a[108:111], a[140:143], a[244:247]
v_mfma_f32_16x16x32_bf16 a[248:251], a[112:115], a[136:139], a[248:251]
v_mfma_f32_16x16x32_bf16 a[248:251], a[116:119], a[140:143], a[248:251]
buffer_load_dwordx4 v19, s[12:15], s26 offen offset:3072 lds
v_mfma_f32_16x16x32_bf16 a[252:255], a[120:123], a[136:139], a[252:255]
s_add_u32 s26, s26, 524288
v_mfma_f32_16x16x32_bf16 a[252:255], a[124:127], a[140:143], a[252:255]
s_waitcnt lgkmcnt(2)
v_mfma_f32_16x16x32_bf16 v[32:35], a[0:3], a[128:131], v[32:35]
s_waitcnt lgkmcnt(0)
s_add_u32 m0, s29, 114688
ds_read_b64_tr_b16 a[136:137], v5 offset:0
v_mfma_f32_16x16x32_bf16 v[32:35], a[4:7], a[132:135], v[32:35]
buffer_load_dwordx4 v16, s[12:15], s27 offen offset:0 lds
v_mfma_f32_16x16x32_bf16 v[36:39], a[8:11], a[128:131], v[36:39]
ds_read_b64_tr_b16 a[138:139], v5 offset:2048
v_mfma_f32_16x16x32_bf16 v[36:39], a[12:15], a[132:135], v[36:39]
v_mfma_f32_16x16x32_bf16 v[40:43], a[16:19], a[128:131], v[40:43]
ds_read_b64_tr_b16 a[140:141], v5 offset:16384
v_mfma_f32_16x16x32_bf16 v[40:43], a[20:23], a[132:135], v[40:43]
buffer_load_dwordx4 v17, s[12:15], s27 offen offset:1024 lds
v_mfma_f32_16x16x32_bf16 v[44:47], a[24:27], a[128:131], v[44:47]
ds_read_b64_tr_b16 a[142:143], v5 offset:18432
v_mfma_f32_16x16x32_bf16 v[44:47], a[28:31], a[132:135], v[44:47]
v_mfma_f32_16x16x32_bf16 v[48:51], a[32:35], a[128:131], v[48:51]
ds_read_b128 a[64:67], v2 offset:32768
v_mfma_f32_16x16x32_bf16 v[48:51], a[36:39], a[132:135], v[48:51]
buffer_load_dwordx4 v18, s[12:15], s27 offen offset:2048 lds
v_mfma_f32_16x16x32_bf16 v[52:55], a[40:43], a[128:131], v[52:55]
ds_read_b128 a[68:71], v3 offset:32768
v_mfma_f32_16x16x32_bf16 v[52:55], a[44:47], a[132:135], v[52:55]
v_mfma_f32_16x16x32_bf16 v[56:59], a[48:51], a[128:131], v[56:59]
v_mfma_f32_16x16x32_bf16 v[56:59], a[52:55], a[132:135], v[56:59]
buffer_load_dwordx4 v19, s[12:15], s27 offen offset:3072 lds
v_mfma_f32_16x16x32_bf16 v[60:63], a[56:59], a[128:131], v[60:63]
s_add_u32 s27, s27, 524288
ds_read_b128 a[72:75], v2 offset:34816
v_mfma_f32_16x16x32_bf16 v[60:63], a[60:63], a[132:135], v[60:63]
s_waitcnt lgkmcnt(5)
v_mfma_f32_16x16x32_bf16 v[64:67], a[0:3], a[136:139], v[64:67]
s_waitcnt lgkmcnt(3)
s_add_u32 m0, s28, 0
ds_read_b64_tr_b16 a[128:129], v6 offset:0
v_mfma_f32_16x16x32_bf16 v[64:67], a[4:7], a[140:143], v[64:67]
buffer_load_dwordx4 v12, s[8:11], s24 offen offset:0 lds
v_mfma_f32_16x16x32_bf16 v[68:71], a[8:11], a[136:139], v[68:71]
ds_read_b64_tr_b16 a[130:131], v6 offset:2048
v_mfma_f32_16x16x32_bf16 v[68:71], a[12:15], a[140:143], v[68:71]
v_mfma_f32_16x16x32_bf16 v[72:75], a[16:19], a[136:139], v[72:75]
ds_read_b64_tr_b16 a[132:133], v6 offset:16384
v_mfma_f32_16x16x32_bf16 v[72:75], a[20:23], a[140:143], v[72:75]
buffer_load_dwordx4 v13, s[8:11], s24 offen offset:1024 lds
v_mfma_f32_16x16x32_bf16 v[76:79], a[24:27], a[136:139], v[76:79]
ds_read_b64_tr_b16 a[134:135], v6 offset:18432
v_mfma_f32_16x16x32_bf16 v[76:79], a[28:31], a[140:143], v[76:79]
v_mfma_f32_16x16x32_bf16 v[80:83], a[32:35], a[136:139], v[80:83]
ds_read_b128 a[76:79], v3 offset:34816
v_mfma_f32_16x16x32_bf16 v[80:83], a[36:39], a[140:143], v[80:83]
buffer_load_dwordx4 v14, s[8:11], s24 offen offset:2048 lds
v_mfma_f32_16x16x32_bf16 v[84:87], a[40:43], a[136:139], v[84:87]
v_mfma_f32_16x16x32_bf16 v[84:87], a[44:47], a[140:143], v[84:87]
v_mfma_f32_16x16x32_bf16 v[88:91], a[48:51], a[136:139], v[88:91]
ds_read_b128 a[80:83], v2 offset:36864
v_mfma_f32_16x16x32_bf16 v[88:91], a[52:55], a[140:143], v[88:91]
buffer_load_dwordx4 v15, s[8:11], s24 offen offset:3072 lds
v_mfma_f32_16x16x32_bf16 v[92:95], a[56:59], a[136:139], v[92:95]
s_add_u32 s24, s24, 128
ds_read_b128 a[84:87], v3 offset:36864
v_mfma_f32_16x16x32_bf16 v[92:95], a[60:63], a[140:143], v[92:95]
s_waitcnt lgkmcnt(5)
v_mfma_f32_16x16x32_bf16 v[96:99], a[0:3], a[128:131], v[96:99]
s_waitcnt lgkmcnt(3)
s_add_u32 m0, s28, 4096
ds_read_b64_tr_b16 a[136:137], v7 offset:0
v_mfma_f32_16x16x32_bf16 v[96:99], a[4:7], a[132:135], v[96:99]
buffer_load_dwordx4 v12, s[8:11], s25 offen offset:0 lds
v_mfma_f32_16x16x32_bf16 v[100:103], a[8:11], a[128:131], v[100:103]
ds_read_b64_tr_b16 a[138:139], v7 offset:2048
v_mfma_f32_16x16x32_bf16 v[100:103], a[12:15], a[132:135], v[100:103]
v_mfma_f32_16x16x32_bf16 v[104:107], a[16:19], a[128:131], v[104:107]
ds_read_b64_tr_b16 a[140:141], v7 offset:16384
v_mfma_f32_16x16x32_bf16 v[104:107], a[20:23], a[132:135], v[104:107]
buffer_load_dwordx4 v13, s[8:11], s25 offen offset:1024 lds
v_mfma_f32_16x16x32_bf16 v[108:111], a[24:27], a[128:131], v[108:111]
ds_read_b64_tr_b16 a[142:143], v7 offset:18432
v_mfma_f32_16x16x32_bf16 v[108:111], a[28:31], a[132:135], v[108:111]
v_mfma_f32_16x16x32_bf16 v[112:115], a[32:35], a[128:131], v[112:115]
v_mfma_f32_16x16x32_bf16 v[112:115], a[36:39], a[132:135], v[112:115]
buffer_load_dwordx4 v14, s[8:11], s25 offen offset:2048 lds
v_mfma_f32_16x16x32_bf16 v[116:119], a[40:43], a[128:131], v[116:119]
ds_read_b128 a[88:91], v2 offset:38912
v_mfma_f32_16x16x32_bf16 v[116:119], a[44:47], a[132:135], v[116:119]
v_mfma_f32_16x16x32_bf16 v[120:123], a[48:51], a[128:131], v[120:123]
ds_read_b128 a[92:95], v3 offset:38912
v_mfma_f32_16x16x32_bf16 v[120:123], a[52:55], a[132:135], v[120:123]
buffer_load_dwordx4 v15, s[8:11], s25 offen offset:3072 lds
v_mfma_f32_16x16x32_bf16 v[124:127], a[56:59], a[128:131], v[124:127]
s_add_u32 s25, s25, 128
v_mfma_f32_16x16x32_bf16 v[124:127], a[60:63], a[132:135], v[124:127]
s_waitcnt lgkmcnt(4)
v_mfma_f32_16x16x32_bf16 v[128:131], a[0:3], a[136:139], v[128:131]
s_waitcnt lgkmcnt(2)
ds_read_b64_tr_b16 a[128:129], v8 offset:0
v_mfma_f32_16x16x32_bf16 v[128:131], a[4:7], a[140:143], v[128:131]
buffer_load_dword v21, v20, s[16:19], s43 offen
v_mfma_f32_16x16x32_bf16 v[132:135], a[8:11], a[136:139], v[132:135]
s_add_u32 s43, s43, s47
ds_read_b64_tr_b16 a[130:131], v8 offset:2048
v_mfma_f32_16x16x32_bf16 v[132:135], a[12:15], a[140:143], v[132:135]
s_cmp_ge_u32 s43, s51
v_mfma_f32_16x16x32_bf16 v[136:139], a[16:19], a[136:139], v[136:139]
s_cselect_b32 s43, 0, s43
ds_read_b64_tr_b16 a[132:133], v8 offset:16384
v_mfma_f32_16x16x32_bf16 v[136:139], a[20:23], a[140:143], v[136:139]
s_cselect_b32 s51, s42, s51
v_mfma_f32_16x16x32_bf16 v[140:143], a[24:27], a[136:139], v[140:143]
s_cselect_b64 s[16:17], s[40:41], s[16:17]
ds_read_b64_tr_b16 a[134:135], v8 offset:18432
v_mfma_f32_16x16x32_bf16 v[140:143], a[28:31], a[140:143], v[140:143]
s_cselect_b32 s18, s42, s18
v_mfma_f32_16x16x32_bf16 v[144:147], a[32:35], a[136:139], v[144:147]
s_cselect_b64 s[40:41], s[44:45], s[40:41]
ds_read_b128 a[96:99], v2 offset:40960
v_mfma_f32_16x16x32_bf16 v[144:147], a[36:39], a[140:143], v[144:147]
s_cselect_b32 s42, s46, s42
v_mfma_f32_16x16x32_bf16 v[148:151], a[40:43], a[136:139], v[148:151]
s_cselect_b32 s46, 0, s46
v_mfma_f32_16x16x32_bf16 v[148:151], a[44:47], a[140:143], v[148:151]
s_lshl_b32 s59, s39, 5
v_mfma_f32_16x16x32_bf16 v[152:155], a[48:51], a[136:139], v[152:155]
s_add_u32 s59, s59, s38
ds_read_b128 a[100:103], v3 offset:40960
v_mfma_f32_16x16x32_bf16 v[152:155], a[52:55], a[140:143], v[152:155]
s_lshl_b32 s59, s59, 2
v_mfma_f32_16x16x32_bf16 v[156:159], a[56:59], a[136:139], v[156:159]
s_add_u32 s59, s59, 94392320
ds_read_b128 a[104:107], v2 offset:43008
v_mfma_f32_16x16x32_bf16 v[156:159], a[60:63], a[140:143], v[156:159]
s_waitcnt lgkmcnt(5)
s_cmp_lt_u32 s2, 224
v_mfma_f32_16x16x32_bf16 v[160:163], a[0:3], a[128:131], v[160:163]
s_waitcnt lgkmcnt(3)
s_cselect_b32 s59, s59, 3221225472
ds_read_b64_tr_b16 a[136:137], v9 offset:0
v_mfma_f32_16x16x32_bf16 v[160:163], a[4:7], a[132:135], v[160:163]
s_mov_b32 s58, 0xffff0000
v_mfma_f32_16x16x32_bf16 v[164:167], a[8:11], a[128:131], v[164:167]
ds_read_b64_tr_b16 a[138:139], v9 offset:2048
v_mfma_f32_16x16x32_bf16 v[164:167], a[12:15], a[132:135], v[164:167]
buffer_load_dword v21, v20, s[16:19], s43 offen
v_mfma_f32_16x16x32_bf16 v[168:171], a[16:19], a[128:131], v[168:171]
s_add_u32 s43, s43, s47
ds_read_b64_tr_b16 a[140:141], v9 offset:16384
v_mfma_f32_16x16x32_bf16 v[168:171], a[20:23], a[132:135], v[168:171]
s_cmp_ge_u32 s43, s51
v_mfma_f32_16x16x32_bf16 v[172:175], a[24:27], a[128:131], v[172:175]
s_cselect_b32 s43, 0, s43
ds_read_b64_tr_b16 a[142:143], v9 offset:18432
v_mfma_f32_16x16x32_bf16 v[172:175], a[28:31], a[132:135], v[172:175]
s_cselect_b32 s51, s42, s51
v_mfma_f32_16x16x32_bf16 v[176:179], a[32:35], a[128:131], v[176:179]
s_cselect_b64 s[16:17], s[40:41], s[16:17]
v_mfma_f32_16x16x32_bf16 v[176:179], a[36:39], a[132:135], v[176:179]
s_cselect_b32 s18, s42, s18
v_mfma_f32_16x16x32_bf16 v[180:183], a[40:43], a[128:131], v[180:183]
s_cselect_b64 s[40:41], s[44:45], s[40:41]
ds_read_b128 a[108:111], v3 offset:43008
v_mfma_f32_16x16x32_bf16 v[180:183], a[44:47], a[132:135], v[180:183]
s_cselect_b32 s42, s46, s42
v_mfma_f32_16x16x32_bf16 v[184:187], a[48:51], a[128:131], v[184:187]
s_cselect_b32 s46, 0, s46
ds_read_b128 a[112:115], v2 offset:45056
v_mfma_f32_16x16x32_bf16 v[184:187], a[52:55], a[132:135], v[184:187]
v_mfma_f32_16x16x32_bf16 v[188:191], a[56:59], a[128:131], v[188:191]
v_mfma_f32_16x16x32_bf16 v[188:191], a[60:63], a[132:135], v[188:191]
s_waitcnt lgkmcnt(4)
v_mfma_f32_16x16x32_bf16 v[192:195], a[0:3], a[136:139], v[192:195]
s_waitcnt lgkmcnt(2)
ds_read_b64_tr_b16 a[128:129], v10 offset:0
v_mfma_f32_16x16x32_bf16 v[192:195], a[4:7], a[140:143], v[192:195]
v_mfma_f32_16x16x32_bf16 v[196:199], a[8:11], a[136:139], v[196:199]
ds_read_b64_tr_b16 a[130:131], v10 offset:2048
v_mfma_f32_16x16x32_bf16 v[196:199], a[12:15], a[140:143], v[196:199]
v_mfma_f32_16x16x32_bf16 v[200:203], a[16:19], a[136:139], v[200:203]
ds_read_b64_tr_b16 a[132:133], v10 offset:16384
v_mfma_f32_16x16x32_bf16 v[200:203], a[20:23], a[140:143], v[200:203]
v_mfma_f32_16x16x32_bf16 v[204:207], a[24:27], a[136:139], v[204:207]
ds_read_b64_tr_b16 a[134:135], v10 offset:18432
v_mfma_f32_16x16x32_bf16 v[204:207], a[28:31], a[140:143], v[204:207]
v_mfma_f32_16x16x32_bf16 v[208:211], a[32:35], a[136:139], v[208:211]
ds_read_b128 a[116:119], v3 offset:45056
v_mfma_f32_16x16x32_bf16 v[208:211], a[36:39], a[140:143], v[208:211]
v_mfma_f32_16x16x32_bf16 v[212:215], a[40:43], a[136:139], v[212:215]
ds_read_b128 a[120:123], v2 offset:47104
v_and_b32 v252, 31, v0
v_mfma_f32_16x16x32_bf16 v[212:215], a[44:47], a[140:143], v[212:215]
v_lshrrev_b32 v253, 5, v0
v_xor_b32 v253, v253, v252
v_mfma_f32_16x16x32_bf16 v[216:219], a[48:51], a[136:139], v[216:219]
v_and_b32 v253, 7, v253
v_lshlrev_b32 v252, 8, v252
v_mfma_f32_16x16x32_bf16 v[216:219], a[52:55], a[140:143], v[216:219]
v_lshl_add_u32 v252, v253, 4, v252
v_add_u32 v252, 147456, v252
v_mfma_f32_16x16x32_bf16 v[220:223], a[56:59], a[136:139], v[220:223]
ds_read_b128 a[124:127], v3 offset:47104
v_mfma_f32_16x16x32_bf16 v[220:223], a[60:63], a[140:143], v[220:223]
s_waitcnt lgkmcnt(5)
v_mfma_f32_16x16x32_bf16 a[192:195], a[0:3], a[128:131], a[192:195]
s_waitcnt lgkmcnt(3)
ds_read_b64_tr_b16 a[136:137], v11 offset:0
v_mfma_f32_16x16x32_bf16 a[192:195], a[4:7], a[132:135], a[192:195]
v_mfma_f32_16x16x32_bf16 a[196:199], a[8:11], a[128:131], a[196:199]
ds_read_b64_tr_b16 a[138:139], v11 offset:2048
v_mfma_f32_16x16x32_bf16 a[196:199], a[12:15], a[132:135], a[196:199]
v_mfma_f32_16x16x32_bf16 a[200:203], a[16:19], a[128:131], a[200:203]
ds_read_b64_tr_b16 a[140:141], v11 offset:16384
v_mfma_f32_16x16x32_bf16 a[200:203], a[20:23], a[132:135], a[200:203]
v_mfma_f32_16x16x32_bf16 a[204:207], a[24:27], a[128:131], a[204:207]
ds_read_b64_tr_b16 a[142:143], v11 offset:18432
v_mfma_f32_16x16x32_bf16 a[204:207], a[28:31], a[132:135], a[204:207]
v_mfma_f32_16x16x32_bf16 a[208:211], a[32:35], a[128:131], a[208:211]
v_mfma_f32_16x16x32_bf16 a[208:211], a[36:39], a[132:135], a[208:211]
v_mfma_f32_16x16x32_bf16 a[212:215], a[40:43], a[128:131], a[212:215]
v_mfma_f32_16x16x32_bf16 a[212:215], a[44:47], a[132:135], a[212:215]
v_mfma_f32_16x16x32_bf16 a[216:219], a[48:51], a[128:131], a[216:219]
v_mfma_f32_16x16x32_bf16 a[216:219], a[52:55], a[132:135], a[216:219]
v_mfma_f32_16x16x32_bf16 a[220:223], a[56:59], a[128:131], a[220:223]
v_mfma_f32_16x16x32_bf16 a[220:223], a[60:63], a[132:135], a[220:223]
s_waitcnt vmcnt(2) lgkmcnt(0)
s_barrier
v_mfma_f32_16x16x32_bf16 a[224:227], a[0:3], a[136:139], a[224:227]
s_add_u32 m0, s29, 65536
ds_read_b64_tr_b16 a[128:129], v4 offset:32768
v_lshlrev_b32 v28, 16, v248
v_mfma_f32_16x16x32_bf16 a[224:227], a[4:7], a[140:143], a[224:227]
buffer_load_dwordx4 v16, s[12:15], s26 offen offset:0 lds
v_mfma_f32_16x16x32_bf16 a[228:231], a[8:11], a[136:139], a[228:231]
ds_read_b64_tr_b16 a[130:131], v4 offset:34816
v_and_b32 v29, s58, v248
v_mfma_f32_16x16x32_bf16 a[228:231], a[12:15], a[140:143], a[228:231]
v_lshlrev_b32 v30, 16, v249
v_and_b32 v253, s58, v249
v_mfma_f32_16x16x32_bf16 a[232:235], a[16:19], a[136:139], a[232:235]
ds_read_b64_tr_b16 a[132:133], v4 offset:49152
v_lshlrev_b32 v22, 16, v224
v_mfma_f32_16x16x32_bf16 a[232:235], a[20:23], a[140:143], a[232:235]
buffer_load_dwordx4 v17, s[12:15], s26 offen offset:1024 lds
v_mfma_f32_16x16x32_bf16 a[236:239], a[24:27], a[136:139], a[236:239]
ds_read_b64_tr_b16 a[134:135], v4 offset:51200
v_lshlrev_b32 v23, 16, v225
v_mfma_f32_16x16x32_bf16 a[236:239], a[28:31], a[140:143], a[236:239]
v_lshlrev_b32 v24, 16, v226
v_mul_f32 v254, v22, v253
v_mfma_f32_16x16x32_bf16 a[240:243], a[32:35], a[136:139], a[240:243]
v_lshlrev_b32 v25, 16, v227
v_lshlrev_b32 v247, 16, v236
v_mfma_f32_16x16x32_bf16 a[240:243], a[36:39], a[140:143], a[240:243]
buffer_load_dwordx4 v18, s[12:15], s26 offen offset:2048 lds
v_mfma_f32_16x16x32_bf16 a[244:247], a[40:43], a[136:139], a[244:247]
v_fmac_f32 v254, v23, v30
v_fmac_f32 v254, v24, v29
v_mfma_f32_16x16x32_bf16 a[244:247], a[44:47], a[140:143], a[244:247]
v_fmac_f32 v254, v25, v28
v_mul_f32 v254, v254, v247
v_mfma_f32_16x16x32_bf16 a[248:251], a[48:51], a[136:139], a[248:251]
v_mul_f32 v255, v23, v253
v_lshlrev_b32 v22, 16, v228
v_mfma_f32_16x16x32_bf16 a[248:251], a[52:55], a[140:143], a[248:251]
buffer_load_dwordx4 v19, s[12:15], s26 offen offset:3072 lds
v_mfma_f32_16x16x32_bf16 a[252:255], a[56:59], a[136:139], a[252:255]
s_add_u32 s26, s26, 524288
v_lshlrev_b32 v247, 16, v237
v_fmac_f32 v255, v24, v30
v_mfma_f32_16x16x32_bf16 a[252:255], a[60:63], a[140:143], a[252:255]
s_waitcnt lgkmcnt(0)
v_fmac_f32 v255, v25, v29
v_fmac_f32 v255, v22, v28
v_mfma_f32_16x16x32_bf16 v[32:35], a[64:67], a[128:131], v[32:35]
s_add_u32 m0, s29, 81920
ds_read_b64_tr_b16 a[136:137], v5 offset:32768
v_mul_f32 v255, v255, v247
v_mfma_f32_16x16x32_bf16 v[32:35], a[68:71], a[132:135], v[32:35]
buffer_load_dwordx4 v16, s[12:15], s27 offen offset:0 lds
v_mfma_f32_16x16x32_bf16 v[36:39], a[72:75], a[128:131], v[36:39]
ds_read_b64_tr_b16 a[138:139], v5 offset:34816
v_cvt_pk_bf16_f32 v246, v254, v255
v_mfma_f32_16x16x32_bf16 v[36:39], a[76:79], a[132:135], v[36:39]
v_accvgpr_write_b32 a180, v246
v_mul_f32 v254, v24, v253
v_mfma_f32_16x16x32_bf16 v[40:43], a[80:83], a[128:131], v[40:43]
ds_read_b64_tr_b16 a[140:141], v5 offset:49152
v_lshlrev_b32 v23, 16, v229
v_mfma_f32_16x16x32_bf16 v[40:43], a[84:87], a[132:135], v[40:43]
buffer_load_dwordx4 v17, s[12:15], s27 offen offset:1024 lds
v_lshlrev_b32 v247, 16, v238
v_mfma_f32_16x16x32_bf16 v[44:47], a[88:91], a[128:131], v[44:47]
ds_read_b64_tr_b16 a[142:143], v5 offset:51200
v_fmac_f32 v254, v25, v30
v_mfma_f32_16x16x32_bf16 v[44:47], a[92:95], a[132:135], v[44:47]
v_fmac_f32 v254, v22, v29
v_fmac_f32 v254, v23, v28
v_mfma_f32_16x16x32_bf16 v[48:51], a[96:99], a[128:131], v[48:51]
ds_read_b128 a[0:3], v2 offset:0
v_mul_f32 v254, v254, v247
v_mfma_f32_16x16x32_bf16 v[48:51], a[100:103], a[132:135], v[48:51]
buffer_load_dwordx4 v18, s[12:15], s27 offen offset:2048 lds
v_mfma_f32_16x16x32_bf16 v[52:55], a[104:107], a[128:131], v[52:55]
ds_read_b128 a[4:7], v3 offset:0
v_cvt_pk_bf16_f32 v246, v255, v254
v_accvgpr_write_b32 a176, v246
v_mfma_f32_16x16x32_bf16 v[52:55], a[108:111], a[132:135], v[52:55]
v_mul_f32 v255, v25, v253
v_lshlrev_b32 v24, 16, v230
v_mfma_f32_16x16x32_bf16 v[56:59], a[112:115], a[128:131], v[56:59]
v_lshlrev_b32 v247, 16, v239
v_fmac_f32 v255, v22, v30
v_mfma_f32_16x16x32_bf16 v[56:59], a[116:119], a[132:135], v[56:59]
buffer_load_dwordx4 v19, s[12:15], s27 offen offset:3072 lds
v_mfma_f32_16x16x32_bf16 v[60:63], a[120:123], a[128:131], v[60:63]
s_add_u32 s27, s27, 524288
ds_read_b128 a[8:11], v2 offset:2048
v_fmac_f32 v255, v23, v29
v_mfma_f32_16x16x32_bf16 v[60:63], a[124:127], a[132:135], v[60:63]
s_waitcnt lgkmcnt(3)
v_fmac_f32 v255, v24, v28
v_mul_f32 v255, v255, v247
v_mfma_f32_16x16x32_bf16 v[64:67], a[64:67], a[136:139], v[64:67]
s_add_u32 m0, s28, 32768
ds_read_b64_tr_b16 a[128:129], v6 offset:32768
v_cvt_pk_bf16_f32 v246, v254, v255
v_accvgpr_write_b32 a181, v246
v_mfma_f32_16x16x32_bf16 v[64:67], a[68:71], a[140:143], v[64:67]
buffer_load_dwordx4 v12, s[8:11], s24 offen offset:0 lds
v_mfma_f32_16x16x32_bf16 v[68:71], a[72:75], a[136:139], v[68:71]
ds_read_b64_tr_b16 a[130:131], v6 offset:34816
v_mul_f32 v254, v22, v253
v_mfma_f32_16x16x32_bf16 v[68:71], a[76:79], a[140:143], v[68:71]
v_lshlrev_b32 v25, 16, v231
v_lshlrev_b32 v247, 16, v240
v_mfma_f32_16x16x32_bf16 v[72:75], a[80:83], a[136:139], v[72:75]
ds_read_b64_tr_b16 a[132:133], v6 offset:49152
v_fmac_f32 v254, v23, v30
v_mfma_f32_16x16x32_bf16 v[72:75], a[84:87], a[140:143], v[72:75]
buffer_load_dwordx4 v13, s[8:11], s24 offen offset:1024 lds
v_fmac_f32 v254, v24, v29
v_mfma_f32_16x16x32_bf16 v[76:79], a[88:91], a[136:139], v[76:79]
ds_read_b64_tr_b16 a[134:135], v6 offset:51200
v_fmac_f32 v254, v25, v28
v_mfma_f32_16x16x32_bf16 v[76:79], a[92:95], a[140:143], v[76:79]
v_mul_f32 v254, v254, v247
v_cvt_pk_bf16_f32 v246, v255, v254
v_mfma_f32_16x16x32_bf16 v[80:83], a[96:99], a[136:139], v[80:83]
ds_read_b128 a[12:15], v3 offset:2048
v_accvgpr_write_b32 a177, v246
v_mfma_f32_16x16x32_bf16 v[80:83], a[100:103], a[140:143], v[80:83]
buffer_load_dwordx4 v14, s[8:11], s24 offen offset:2048 lds
v_mfma_f32_16x16x32_bf16 v[84:87], a[104:107], a[136:139], v[84:87]
v_mul_f32 v255, v23, v253
v_lshlrev_b32 v22, 16, v232
v_lshlrev_b32 v247, 16, v241
v_mfma_f32_16x16x32_bf16 v[84:87], a[108:111], a[140:143], v[84:87]
v_fmac_f32 v255, v24, v30
v_fmac_f32 v255, v25, v29
v_mfma_f32_16x16x32_bf16 v[88:91], a[112:115], a[136:139], v[88:91]
ds_read_b128 a[16:19], v2 offset:4096
v_fmac_f32 v255, v22, v28
v_mfma_f32_16x16x32_bf16 v[88:91], a[116:119], a[140:143], v[88:91]
buffer_load_dwordx4 v15, s[8:11], s24 offen offset:3072 lds
v_mfma_f32_16x16x32_bf16 v[92:95], a[120:123], a[136:139], v[92:95]
s_add_u32 s24, s24, 128
ds_read_b128 a[20:23], v3 offset:4096
v_mul_f32 v255, v255, v247
v_mfma_f32_16x16x32_bf16 v[92:95], a[124:127], a[140:143], v[92:95]
s_waitcnt lgkmcnt(3)
v_cvt_pk_bf16_f32 v246, v254, v255
v_accvgpr_write_b32 a182, v246
v_mfma_f32_16x16x32_bf16 v[96:99], a[64:67], a[128:131], v[96:99]
s_add_u32 m0, s28, 36864
ds_read_b64_tr_b16 a[136:137], v7 offset:32768
v_mul_f32 v254, v24, v253
v_lshlrev_b32 v23, 16, v233
v_mfma_f32_16x16x32_bf16 v[96:99], a[68:71], a[132:135], v[96:99]
buffer_load_dwordx4 v12, s[8:11], s25 offen offset:0 lds
v_mfma_f32_16x16x32_bf16 v[100:103], a[72:75], a[128:131], v[100:103]
ds_read_b64_tr_b16 a[138:139], v7 offset:34816
v_lshlrev_b32 v247, 16, v242
v_mfma_f32_16x16x32_bf16 v[100:103], a[76:79], a[132:135], v[100:103]
v_fmac_f32 v254, v25, v30
v_fmac_f32 v254, v22, v29
v_mfma_f32_16x16x32_bf16 v[104:107], a[80:83], a[128:131], v[104:107]
ds_read_b64_tr_b16 a[140:141], v7 offset:49152
v_fmac_f32 v254, v23, v28
v_mfma_f32_16x16x32_bf16 v[104:107], a[84:87], a[132:135], v[104:107]
buffer_load_dwordx4 v13, s[8:11], s25 offen offset:1024 lds
v_mul_f32 v254, v254, v247
v_mfma_f32_16x16x32_bf16 v[108:111], a[88:91], a[128:131], v[108:111]
ds_read_b64_tr_b16 a[142:143], v7 offset:51200
v_cvt_pk_bf16_f32 v246, v255, v254
v_mfma_f32_16x16x32_bf16 v[108:111], a[92:95], a[132:135], v[108:111]
v_accvgpr_write_b32 a178, v246
v_mul_f32 v255, v25, v253
v_mfma_f32_16x16x32_bf16 v[112:115], a[96:99], a[128:131], v[112:115]
v_lshlrev_b32 v24, 16, v234
v_lshlrev_b32 v247, 16, v243
v_mfma_f32_16x16x32_bf16 v[112:115], a[100:103], a[132:135], v[112:115]
buffer_load_dwordx4 v14, s[8:11], s25 offen offset:2048 lds
v_mfma_f32_16x16x32_bf16 v[116:119], a[104:107], a[128:131], v[116:119]
ds_read_b128 a[24:27], v2 offset:6144
v_fmac_f32 v255, v22, v30
v_fmac_f32 v255, v23, v29
v_mfma_f32_16x16x32_bf16 v[116:119], a[108:111], a[132:135], v[116:119]
v_fmac_f32 v255, v24, v28
v_mul_f32 v255, v255, v247
v_mfma_f32_16x16x32_bf16 v[120:123], a[112:115], a[128:131], v[120:123]
ds_read_b128 a[28:31], v3 offset:6144
v_cvt_pk_bf16_f32 v246, v254, v255
v_mfma_f32_16x16x32_bf16 v[120:123], a[116:119], a[132:135], v[120:123]
buffer_load_dwordx4 v15, s[8:11], s25 offen offset:3072 lds
v_mfma_f32_16x16x32_bf16 v[124:127], a[120:123], a[128:131], v[124:127]
s_add_u32 s25, s25, 128
v_accvgpr_write_b32 a183, v246
v_mul_f32 v254, v22, v253
v_mfma_f32_16x16x32_bf16 v[124:127], a[124:127], a[132:135], v[124:127]
s_waitcnt lgkmcnt(4)
v_lshlrev_b32 v25, 16, v235
v_lshlrev_b32 v247, 16, v244
v_mfma_f32_16x16x32_bf16 v[128:131], a[64:67], a[136:139], v[128:131]
s_waitcnt lgkmcnt(2)
ds_read_b64_tr_b16 a[128:129], v8 offset:32768
v_fmac_f32 v254, v23, v30
v_fmac_f32 v254, v24, v29
v_mfma_f32_16x16x32_bf16 v[128:131], a[68:71], a[140:143], v[128:131]
buffer_load_dword v21, v20, s[16:19], s43 offen
v_mfma_f32_16x16x32_bf16 v[132:135], a[72:75], a[136:139], v[132:135]
s_add_u32 s43, s43, s47
ds_read_b64_tr_b16 a[130:131], v8 offset:34816
v_fmac_f32 v254, v25, v28
v_mfma_f32_16x16x32_bf16 v[132:135], a[76:79], a[140:143], v[132:135]
s_cmp_ge_u32 s43, s51
v_mul_f32 v254, v254, v247
v_cvt_pk_bf16_f32 v246, v255, v254
v_mfma_f32_16x16x32_bf16 v[136:139], a[80:83], a[136:139], v[136:139]
s_cselect_b32 s43, 0, s43
ds_read_b64_tr_b16 a[132:133], v8 offset:49152
v_accvgpr_write_b32 a179, v246
v_mfma_f32_16x16x32_bf16 v[136:139], a[84:87], a[140:143], v[136:139]
s_cselect_b32 s51, s42, s51
v_lshlrev_b32 v28, 16, v250
v_and_b32 v29, s58, v250
v_lshlrev_b32 v30, 16, v251
v_mfma_f32_16x16x32_bf16 v[140:143], a[88:91], a[136:139], v[140:143]
s_cselect_b64 s[16:17], s[40:41], s[16:17]
ds_read_b64_tr_b16 a[134:135], v8 offset:51200
v_and_b32 v253, s58, v251
v_mfma_f32_16x16x32_bf16 v[140:143], a[92:95], a[140:143], v[140:143]
s_cselect_b32 s18, s42, s18
v_and_b32 v22, s58, v224
v_and_b32 v23, s58, v225
v_mfma_f32_16x16x32_bf16 v[144:147], a[96:99], a[136:139], v[144:147]
s_cselect_b64 s[40:41], s[44:45], s[40:41]
ds_read_b128 a[32:35], v2 offset:8192
v_and_b32 v24, s58, v226
v_mfma_f32_16x16x32_bf16 v[144:147], a[100:103], a[140:143], v[144:147]
s_cselect_b32 s42, s46, s42
v_mul_f32 v254, v22, v253
v_and_b32 v25, s58, v227
v_mfma_f32_16x16x32_bf16 v[148:151], a[104:107], a[136:139], v[148:151]
s_cselect_b32 s46, 0, s46
v_and_b32 v247, s58, v236
v_fmac_f32 v254, v23, v30
v_mfma_f32_16x16x32_bf16 v[148:151], a[108:111], a[140:143], v[148:151]
buffer_load_dword v245, off, s[60:63], 0 sc1
v_fmac_f32 v254, v24, v29
v_mfma_f32_16x16x32_bf16 v[152:155], a[112:115], a[136:139], v[152:155]
ds_read_b128 a[36:39], v3 offset:8192
v_fmac_f32 v254, v25, v28
v_mfma_f32_16x16x32_bf16 v[152:155], a[116:119], a[140:143], v[152:155]
v_mul_f32 v254, v254, v247
v_mul_f32 v255, v23, v253
v_mfma_f32_16x16x32_bf16 v[156:159], a[120:123], a[136:139], v[156:159]
ds_read_b128 a[40:43], v2 offset:10240
v_and_b32 v22, s58, v228
v_mfma_f32_16x16x32_bf16 v[156:159], a[124:127], a[140:143], v[156:159]
s_waitcnt lgkmcnt(5)
v_and_b32 v247, s58, v237
v_fmac_f32 v255, v24, v30
v_mfma_f32_16x16x32_bf16 v[160:163], a[64:67], a[128:131], v[160:163]
s_waitcnt lgkmcnt(3)
ds_read_b64_tr_b16 a[136:137], v9 offset:32768
v_fmac_f32 v255, v25, v29
v_fmac_f32 v255, v22, v28
v_mfma_f32_16x16x32_bf16 v[160:163], a[68:71], a[132:135], v[160:163]
v_mul_f32 v255, v255, v247
v_cvt_pk_bf16_f32 v246, v254, v255
v_mfma_f32_16x16x32_bf16 v[164:167], a[72:75], a[128:131], v[164:167]
ds_read_b64_tr_b16 a[138:139], v9 offset:34816
v_accvgpr_write_b32 a188, v246
v_mfma_f32_16x16x32_bf16 v[164:167], a[76:79], a[132:135], v[164:167]
v_mul_f32 v254, v24, v253
v_and_b32 v23, s58, v229
v_mfma_f32_16x16x32_bf16 v[168:171], a[80:83], a[128:131], v[168:171]
ds_read_b64_tr_b16 a[140:141], v9 offset:49152
v_and_b32 v247, s58, v238
v_mfma_f32_16x16x32_bf16 v[168:171], a[84:87], a[132:135], v[168:171]
v_fmac_f32 v254, v25, v30
v_fmac_f32 v254, v22, v29
v_fmac_f32 v254, v23, v28
v_mfma_f32_16x16x32_bf16 v[172:175], a[88:91], a[128:131], v[172:175]
ds_read_b64_tr_b16 a[142:143], v9 offset:51200
v_mul_f32 v254, v254, v247
v_mfma_f32_16x16x32_bf16 v[172:175], a[92:95], a[132:135], v[172:175]
v_cvt_pk_bf16_f32 v246, v255, v254
v_accvgpr_write_b32 a184, v246
v_mfma_f32_16x16x32_bf16 v[176:179], a[96:99], a[128:131], v[176:179]
v_mul_f32 v255, v25, v253
v_and_b32 v24, s58, v230
v_mfma_f32_16x16x32_bf16 v[176:179], a[100:103], a[132:135], v[176:179]
v_and_b32 v247, s58, v239
v_fmac_f32 v255, v22, v30
v_mfma_f32_16x16x32_bf16 v[180:183], a[104:107], a[128:131], v[180:183]
ds_read_b128 a[44:47], v3 offset:10240
v_fmac_f32 v255, v23, v29
v_mfma_f32_16x16x32_bf16 v[180:183], a[108:111], a[132:135], v[180:183]
v_fmac_f32 v255, v24, v28
v_mul_f32 v255, v255, v247
v_cvt_pk_bf16_f32 v246, v254, v255
v_mfma_f32_16x16x32_bf16 v[184:187], a[112:115], a[128:131], v[184:187]
ds_read_b128 a[48:51], v2 offset:12288
v_accvgpr_write_b32 a189, v246
v_mfma_f32_16x16x32_bf16 v[184:187], a[116:119], a[132:135], v[184:187]
v_mul_f32 v254, v22, v253
v_and_b32 v25, s58, v231
v_mfma_f32_16x16x32_bf16 v[188:191], a[120:123], a[128:131], v[188:191]
v_and_b32 v247, s58, v240
v_fmac_f32 v254, v23, v30
v_mfma_f32_16x16x32_bf16 v[188:191], a[124:127], a[132:135], v[188:191]
s_waitcnt lgkmcnt(4)
v_fmac_f32 v254, v24, v29
v_fmac_f32 v254, v25, v28
v_mfma_f32_16x16x32_bf16 v[192:195], a[64:67], a[136:139], v[192:195]
s_waitcnt lgkmcnt(2)
ds_read_b64_tr_b16 a[128:129], v10 offset:32768
v_mul_f32 v254, v254, v247
v_cvt_pk_bf16_f32 v246, v255, v254
v_mfma_f32_16x16x32_bf16 v[192:195], a[68:71], a[140:143], v[192:195]
v_accvgpr_write_b32 a185, v246
v_mul_f32 v255, v23, v253
v_mfma_f32_16x16x32_bf16 v[196:199], a[72:75], a[136:139], v[196:199]
ds_read_b64_tr_b16 a[130:131], v10 offset:34816
v_and_b32 v22, s58, v232
v_mfma_f32_16x16x32_bf16 v[196:199], a[76:79], a[140:143], v[196:199]
v_and_b32 v247, s58, v241
v_fmac_f32 v255, v24, v30
v_mfma_f32_16x16x32_bf16 v[200:203], a[80:83], a[136:139], v[200:203]
s_lshr_b32 s22, s3, 1
ds_read_b64_tr_b16 a[132:133], v10 offset:49152
v_fmac_f32 v255, v25, v29
v_mfma_f32_16x16x32_bf16 v[200:203], a[84:87], a[140:143], v[200:203]
s_mul_i32 s22, s22, 2097152
v_fmac_f32 v255, v22, v28
v_mul_f32 v255, v255, v247
v_cvt_pk_bf16_f32 v246, v254, v255
v_mfma_f32_16x16x32_bf16 v[204:207], a[88:91], a[136:139], v[204:207]
s_and_b32 s23, s3, 1
ds_read_b64_tr_b16 a[134:135], v10 offset:51200
v_accvgpr_write_b32 a190, v246
v_mfma_f32_16x16x32_bf16 v[204:207], a[92:95], a[140:143], v[204:207]
s_lshl_b32 s23, s23, 5
v_mul_f32 v254, v24, v253
v_and_b32 v23, s58, v233
v_mfma_f32_16x16x32_bf16 v[208:211], a[96:99], a[136:139], v[208:211]
s_lshl_b32 s56, s39, 6
ds_read_b128 a[52:55], v3 offset:12288
v_and_b32 v247, s58, v242
v_mfma_f32_16x16x32_bf16 v[208:211], a[100:103], a[140:143], v[208:211]
s_add_u32 s23, s23, s56
v_fmac_f32 v254, v25, v30
v_fmac_f32 v254, v22, v29
v_mfma_f32_16x16x32_bf16 v[212:215], a[104:107], a[136:139], v[212:215]
s_mul_i32 s23, s23, 4224
ds_read_b128 a[56:59], v2 offset:14336
v_fmac_f32 v254, v23, v28
v_mfma_f32_16x16x32_bf16 v[212:215], a[108:111], a[140:143], v[212:215]
s_add_u32 s22, s22, s23
v_mul_f32 v254, v254, v247
v_cvt_pk_bf16_f32 v246, v255, v254
v_accvgpr_write_b32 a186, v246
v_mfma_f32_16x16x32_bf16 v[216:219], a[112:115], a[136:139], v[216:219]
s_add_u32 s57, s22, 83886200
v_mul_f32 v255, v25, v253
v_and_b32 v24, s58, v234
v_mfma_f32_16x16x32_bf16 v[216:219], a[116:119], a[140:143], v[216:219]
s_lshl_b32 s23, s38, 7
v_and_b32 v247, s58, v243
v_fmac_f32 v255, v22, v30
v_mfma_f32_16x16x32_bf16 v[220:223], a[120:123], a[136:139], v[220:223]
s_add_u32 s22, s22, s23
ds_read_b128 a[60:63], v3 offset:14336
v_fmac_f32 v255, v23, v29
v_mfma_f32_16x16x32_bf16 v[220:223], a[124:127], a[140:143], v[220:223]
s_waitcnt lgkmcnt(3)
s_add_u32 s56, s22, 83886208
v_fmac_f32 v255, v24, v28
v_mul_f32 v255, v255, v247
v_mfma_f32_16x16x32_bf16 a[192:195], a[64:67], a[128:131], a[192:195]
s_cmp_lt_u32 s2, 224
ds_read_b64_tr_b16 a[136:137], v11 offset:32768
v_cvt_pk_bf16_f32 v246, v254, v255
v_accvgpr_write_b32 a191, v246
v_mfma_f32_16x16x32_bf16 a[192:195], a[68:71], a[132:135], a[192:195]
s_cselect_b32 s56, s56, 3221225472
v_mul_f32 v254, v22, v253
v_and_b32 v25, s58, v235
v_mfma_f32_16x16x32_bf16 a[196:199], a[72:75], a[128:131], a[196:199]
s_cmp_eq_u32 s38, 0
ds_read_b64_tr_b16 a[138:139], v11 offset:34816
v_and_b32 v247, s58, v244
v_mfma_f32_16x16x32_bf16 a[196:199], a[76:79], a[132:135], a[196:199]
s_cselect_b32 s57, s57, 3221225472
v_fmac_f32 v254, v23, v30
v_fmac_f32 v254, v24, v29
v_mfma_f32_16x16x32_bf16 a[200:203], a[80:83], a[128:131], a[200:203]
ds_read_b64_tr_b16 a[140:141], v11 offset:49152
v_fmac_f32 v254, v25, v28
v_mfma_f32_16x16x32_bf16 a[200:203], a[84:87], a[132:135], a[200:203]
v_mul_f32 v254, v254, v247
v_cvt_pk_bf16_f32 v246, v255, v254
v_accvgpr_write_b32 a187, v246
v_mfma_f32_16x16x32_bf16 a[204:207], a[88:91], a[128:131], a[204:207]
ds_read_b64_tr_b16 a[142:143], v11 offset:51200
v_mfma_f32_16x16x32_bf16 a[204:207], a[92:95], a[132:135], a[204:207]
ds_write_b128 v252, a[176:179] offset:0
v_mfma_f32_16x16x32_bf16 a[208:211], a[96:99], a[128:131], a[208:211]
v_mfma_f32_16x16x32_bf16 a[208:211], a[100:103], a[132:135], a[208:211]
ds_write_b128 v252, a[180:183] offset:8192
v_mfma_f32_16x16x32_bf16 a[212:215], a[104:107], a[128:131], a[212:215]
v_mfma_f32_16x16x32_bf16 a[212:215], a[108:111], a[132:135], a[212:215]
ds_write_b128 v252, a[184:187] offset:128
v_mfma_f32_16x16x32_bf16 a[216:219], a[112:115], a[128:131], a[216:219]
v_mfma_f32_16x16x32_bf16 a[216:219], a[116:119], a[132:135], a[216:219]
ds_write_b128 v252, a[188:191] offset:8320
v_mfma_f32_16x16x32_bf16 a[220:223], a[120:123], a[128:131], a[220:223]
v_mfma_f32_16x16x32_bf16 a[220:223], a[124:127], a[132:135], a[220:223]
s_waitcnt vmcnt(2) lgkmcnt(0)
s_barrier
v_mfma_f32_16x16x32_bf16 a[224:227], a[64:67], a[136:139], a[224:227]
s_add_u32 m0, s29, 98304
ds_read_b64_tr_b16 a[128:129], v4 offset:0
v_lshrrev_b32 v22, 8, v1
v_mfma_f32_16x16x32_bf16 a[224:227], a[68:71], a[140:143], a[224:227]
buffer_load_dwordx4 v16, s[12:15], s26 offen offset:0 lds
v_mfma_f32_16x16x32_bf16 a[228:231], a[72:75], a[136:139], a[228:231]
ds_read_b64_tr_b16 a[130:131], v4 offset:2048
v_lshlrev_b32 v22, 4, v22
v_mfma_f32_16x16x32_bf16 a[228:231], a[76:79], a[140:143], a[228:231]
v_xor_b32 v22, v22, v1
v_add_u32 v22, s29, v22
v_mfma_f32_16x16x32_bf16 a[232:235], a[80:83], a[136:139], a[232:235]
ds_read_b64_tr_b16 a[132:133], v4 offset:16384
v_add_u32 v22, 147456, v22
v_mfma_f32_16x16x32_bf16 a[232:235], a[84:87], a[140:143], a[232:235]
buffer_load_dwordx4 v17, s[12:15], s26 offen offset:1024 lds
v_mfma_f32_16x16x32_bf16 a[236:239], a[88:91], a[136:139], a[236:239]
ds_read_b64_tr_b16 a[134:135], v4 offset:18432
v_xor_b32 v23, 64, v22
v_mfma_f32_16x16x32_bf16 a[236:239], a[92:95], a[140:143], a[236:239]
v_lshrrev_b32 v224, 7, v1
v_mul_u32_u24 v224, 4224, v224
v_mfma_f32_16x16x32_bf16 a[240:243], a[96:99], a[136:139], a[240:243]
v_and_b32 v225, 0x70, v1
v_add_u32 v224, v224, v225
v_mfma_f32_16x16x32_bf16 a[240:243], a[100:103], a[140:143], a[240:243]
buffer_load_dwordx4 v18, s[12:15], s26 offen offset:2048 lds
v_mfma_f32_16x16x32_bf16 a[244:247], a[104:107], a[136:139], a[244:247]
v_bfe_u32 v225, v1, 4, 5
v_mul_u32_u24 v225, 4224, v225
v_mfma_f32_16x16x32_bf16 a[244:247], a[108:111], a[140:143], a[244:247]
v_mov_b32 v226, 0
v_mov_b32 v227, 0
v_mfma_f32_16x16x32_bf16 a[248:251], a[112:115], a[136:139], a[248:251]
v_mfma_f32_16x16x32_bf16 a[248:251], a[116:119], a[140:143], a[248:251]
buffer_load_dwordx4 v19, s[12:15], s26 offen offset:3072 lds
v_mfma_f32_16x16x32_bf16 a[252:255], a[120:123], a[136:139], a[252:255]
s_add_u32 s26, s26, 524288
v_mfma_f32_16x16x32_bf16 a[252:255], a[124:127], a[140:143], a[252:255]
s_waitcnt lgkmcnt(2)
v_mfma_f32_16x16x32_bf16 v[32:35], a[0:3], a[128:131], v[32:35]
s_waitcnt lgkmcnt(0)
s_add_u32 m0, s29, 114688
ds_read_b64_tr_b16 a[136:137], v5 offset:0
v_mfma_f32_16x16x32_bf16 v[32:35], a[4:7], a[132:135], v[32:35]
buffer_load_dwordx4 v16, s[12:15], s27 offen offset:0 lds
v_mfma_f32_16x16x32_bf16 v[36:39], a[8:11], a[128:131], v[36:39]
s_mul_i32 s52, s20, 7
ds_read_b64_tr_b16 a[138:139], v5 offset:2048
v_mfma_f32_16x16x32_bf16 v[36:39], a[12:15], a[132:135], v[36:39]
s_add_u32 s52, s52, s21
buffer_store_dwordx2 v[226:227], v225, s[4:7], s57 offen sc1
v_mfma_f32_16x16x32_bf16 v[40:43], a[16:19], a[128:131], v[40:43]
s_lshl_b32 s53, s52, 2
ds_read_b64_tr_b16 a[140:141], v5 offset:16384
v_mfma_f32_16x16x32_bf16 v[40:43], a[20:23], a[132:135], v[40:43]
s_add_u32 s53, s53, s3
buffer_load_dwordx4 v17, s[12:15], s27 offen offset:1024 lds
v_mfma_f32_16x16x32_bf16 v[44:47], a[24:27], a[128:131], v[44:47]
s_lshl_b32 s49, s53, 12
ds_read_b64_tr_b16 a[142:143], v5 offset:18432
v_mfma_f32_16x16x32_bf16 v[44:47], a[28:31], a[132:135], v[44:47]
s_mul_i32 s53, s53, 4224
v_mfma_f32_16x16x32_bf16 v[48:51], a[32:35], a[128:131], v[48:51]
s_add_u32 s53, s53, 83886080
ds_read_b128 a[64:67], v2 offset:32768
v_mfma_f32_16x16x32_bf16 v[48:51], a[36:39], a[132:135], v[48:51]
s_lshr_b32 s52, s52, 4
buffer_load_dwordx4 v18, s[12:15], s27 offen offset:2048 lds
v_mfma_f32_16x16x32_bf16 v[52:55], a[40:43], a[128:131], v[52:55]
s_min_u32 s52, s52, 6
ds_read_b128 a[68:71], v3 offset:32768
v_mfma_f32_16x16x32_bf16 v[52:55], a[44:47], a[132:135], v[52:55]
s_lshl_b32 s52, s52, 7
ds_read_b128 a[176:179], v22 offset:0
v_mfma_f32_16x16x32_bf16 v[56:59], a[48:51], a[128:131], v[56:59]
s_add_u32 s52, s52, 94392320
ds_read_b128 a[180:183], v23 offset:1024
v_mfma_f32_16x16x32_bf16 v[56:59], a[52:55], a[132:135], v[56:59]
buffer_load_dwordx4 v19, s[12:15], s27 offen offset:3072 lds
v_mfma_f32_16x16x32_bf16 v[60:63], a[56:59], a[128:131], v[60:63]
s_add_u32 s27, s27, 524288
ds_read_b128 a[72:75], v2 offset:34816
v_mfma_f32_16x16x32_bf16 v[60:63], a[60:63], a[132:135], v[60:63]
s_waitcnt lgkmcnt(7)
ds_read_b128 a[184:187], v22 offset:2048
v_mfma_f32_16x16x32_bf16 v[64:67], a[0:3], a[136:139], v[64:67]
s_waitcnt lgkmcnt(6)
s_add_u32 m0, s28, 0
ds_read_b64_tr_b16 a[128:129], v6 offset:0
v_mfma_f32_16x16x32_bf16 v[64:67], a[4:7], a[140:143], v[64:67]
buffer_load_dwordx4 v12, s[8:11], s24 offen offset:0 lds
v_mfma_f32_16x16x32_bf16 v[68:71], a[8:11], a[136:139], v[68:71]
ds_read_b64_tr_b16 a[130:131], v6 offset:2048
v_mfma_f32_16x16x32_bf16 v[68:71], a[12:15], a[140:143], v[68:71]
ds_read_b128 a[188:191], v23 offset:3072
v_mfma_f32_16x16x32_bf16 v[72:75], a[16:19], a[136:139], v[72:75]
ds_read_b64_tr_b16 a[132:133], v6 offset:16384
v_bfe_u32 v231, v1, 4, 5
v_mfma_f32_16x16x32_bf16 v[72:75], a[20:23], a[140:143], v[72:75]
buffer_load_dwordx4 v13, s[8:11], s24 offen offset:1024 lds
v_mfma_f32_16x16x32_bf16 v[76:79], a[24:27], a[136:139], v[76:79]
ds_read_b64_tr_b16 a[134:135], v6 offset:18432
v_lshlrev_b32 v231, 2, v231
v_mfma_f32_16x16x32_bf16 v[76:79], a[28:31], a[140:143], v[76:79]
v_lshlrev_b32 v229, 3, v1
v_min_u32 v229, 4096, v229
v_mfma_f32_16x16x32_bf16 v[80:83], a[32:35], a[136:139], v[80:83]
ds_read_b128 a[76:79], v3 offset:34816
v_mfma_f32_16x16x32_bf16 v[80:83], a[36:39], a[140:143], v[80:83]
buffer_load_dwordx4 v14, s[8:11], s24 offen offset:2048 lds
v_mfma_f32_16x16x32_bf16 v[84:87], a[40:43], a[136:139], v[84:87]
v_mfma_f32_16x16x32_bf16 v[84:87], a[44:47], a[140:143], v[84:87]
v_mfma_f32_16x16x32_bf16 v[88:91], a[48:51], a[136:139], v[88:91]
ds_read_b128 a[80:83], v2 offset:36864
v_mfma_f32_16x16x32_bf16 v[88:91], a[52:55], a[140:143], v[88:91]
buffer_load_dwordx4 v15, s[8:11], s24 offen offset:3072 lds
v_mfma_f32_16x16x32_bf16 v[92:95], a[56:59], a[136:139], v[92:95]
s_add_u32 s24, s24, 128
ds_read_b128 a[84:87], v3 offset:36864
v_mfma_f32_16x16x32_bf16 v[92:95], a[60:63], a[140:143], v[92:95]
s_waitcnt lgkmcnt(6)
v_mfma_f32_16x16x32_bf16 v[96:99], a[0:3], a[128:131], v[96:99]
s_waitcnt lgkmcnt(3)
s_add_u32 m0, s28, 4096
ds_read_b64_tr_b16 a[136:137], v7 offset:0
v_mfma_f32_16x16x32_bf16 v[96:99], a[4:7], a[132:135], v[96:99]
buffer_load_dwordx4 v12, s[8:11], s25 offen offset:0 lds
v_mfma_f32_16x16x32_bf16 v[100:103], a[8:11], a[128:131], v[100:103]
ds_read_b64_tr_b16 a[138:139], v7 offset:2048
v_mfma_f32_16x16x32_bf16 v[100:103], a[12:15], a[132:135], v[100:103]
v_mfma_f32_16x16x32_bf16 v[104:107], a[16:19], a[128:131], v[104:107]
ds_read_b64_tr_b16 a[140:141], v7 offset:16384
v_mfma_f32_16x16x32_bf16 v[104:107], a[20:23], a[132:135], v[104:107]
buffer_load_dwordx4 v13, s[8:11], s25 offen offset:1024 lds
v_mfma_f32_16x16x32_bf16 v[108:111], a[24:27], a[128:131], v[108:111]
ds_read_b64_tr_b16 a[142:143], v7 offset:18432
v_mfma_f32_16x16x32_bf16 v[108:111], a[28:31], a[132:135], v[108:111]
v_mfma_f32_16x16x32_bf16 v[112:115], a[32:35], a[128:131], v[112:115]
v_mfma_f32_16x16x32_bf16 v[112:115], a[36:39], a[132:135], v[112:115]
buffer_load_dwordx4 v14, s[8:11], s25 offen offset:2048 lds
v_mfma_f32_16x16x32_bf16 v[116:119], a[40:43], a[128:131], v[116:119]
ds_read_b128 a[88:91], v2 offset:38912
v_mfma_f32_16x16x32_bf16 v[116:119], a[44:47], a[132:135], v[116:119]
v_mfma_f32_16x16x32_bf16 v[120:123], a[48:51], a[128:131], v[120:123]
ds_read_b128 a[92:95], v3 offset:38912
v_mfma_f32_16x16x32_bf16 v[120:123], a[52:55], a[132:135], v[120:123]
buffer_load_dwordx4 v15, s[8:11], s25 offen offset:3072 lds
v_mfma_f32_16x16x32_bf16 v[124:127], a[56:59], a[128:131], v[124:127]
s_add_u32 s25, s25, 128
v_mfma_f32_16x16x32_bf16 v[124:127], a[60:63], a[132:135], v[124:127]
s_waitcnt lgkmcnt(4)
v_mfma_f32_16x16x32_bf16 v[128:131], a[0:3], a[136:139], v[128:131]
s_waitcnt lgkmcnt(2)
ds_read_b64_tr_b16 a[128:129], v8 offset:0
v_mfma_f32_16x16x32_bf16 v[128:131], a[4:7], a[140:143], v[128:131]
buffer_store_dwordx4 a[176:179], v224, s[4:7], s56 offen sc1
v_mfma_f32_16x16x32_bf16 v[132:135], a[8:11], a[136:139], v[132:135]
s_add_u32 s56, s56, 33792
ds_read_b64_tr_b16 a[130:131], v8 offset:2048
v_mfma_f32_16x16x32_bf16 v[132:135], a[12:15], a[140:143], v[132:135]
v_mfma_f32_16x16x32_bf16 v[136:139], a[16:19], a[136:139], v[136:139]
ds_read_b64_tr_b16 a[132:133], v8 offset:16384
v_mfma_f32_16x16x32_bf16 v[136:139], a[20:23], a[140:143], v[136:139]
v_mfma_f32_16x16x32_bf16 v[140:143], a[24:27], a[136:139], v[140:143]
s_cmp_lt_u32 s21, 7
ds_read_b64_tr_b16 a[134:135], v8 offset:18432
v_mfma_f32_16x16x32_bf16 v[140:143], a[28:31], a[140:143], v[140:143]
s_cselect_b32 s53, s53, 3221225472
v_mfma_f32_16x16x32_bf16 v[144:147], a[32:35], a[136:139], v[144:147]
s_cselect_b32 s49, s49, 3221225472
ds_read_b128 a[96:99], v2 offset:40960
v_mfma_f32_16x16x32_bf16 v[144:147], a[36:39], a[140:143], v[144:147]
s_add_u32 s48, s53, 2097152
v_mfma_f32_16x16x32_bf16 v[148:151], a[40:43], a[136:139], v[148:151]
v_mfma_f32_16x16x32_bf16 v[148:151], a[44:47], a[140:143], v[148:151]
v_mfma_f32_16x16x32_bf16 v[152:155], a[48:51], a[136:139], v[152:155]
ds_read_b128 a[100:103], v3 offset:40960
v_mfma_f32_16x16x32_bf16 v[152:155], a[52:55], a[140:143], v[152:155]
v_mfma_f32_16x16x32_bf16 v[156:159], a[56:59], a[136:139], v[156:159]
ds_read_b128 a[104:107], v2 offset:43008
v_mfma_f32_16x16x32_bf16 v[156:159], a[60:63], a[140:143], v[156:159]
s_waitcnt lgkmcnt(5)
v_mfma_f32_16x16x32_bf16 v[160:163], a[0:3], a[128:131], v[160:163]
s_waitcnt lgkmcnt(3)
ds_read_b64_tr_b16 a[136:137], v9 offset:0
v_mfma_f32_16x16x32_bf16 v[160:163], a[4:7], a[132:135], v[160:163]
v_mfma_f32_16x16x32_bf16 v[164:167], a[8:11], a[128:131], v[164:167]
ds_read_b64_tr_b16 a[138:139], v9 offset:2048
v_mfma_f32_16x16x32_bf16 v[164:167], a[12:15], a[132:135], v[164:167]
buffer_store_dwordx4 a[180:183], v224, s[4:7], s56 offen sc1
v_mfma_f32_16x16x32_bf16 v[168:171], a[16:19], a[128:131], v[168:171]
s_add_u32 s56, s56, 33792
ds_read_b64_tr_b16 a[140:141], v9 offset:16384
v_mfma_f32_16x16x32_bf16 v[168:171], a[20:23], a[132:135], v[168:171]
v_mfma_f32_16x16x32_bf16 v[172:175], a[24:27], a[128:131], v[172:175]
ds_read_b64_tr_b16 a[142:143], v9 offset:18432
v_mfma_f32_16x16x32_bf16 v[172:175], a[28:31], a[132:135], v[172:175]
v_mfma_f32_16x16x32_bf16 v[176:179], a[32:35], a[128:131], v[176:179]
v_mfma_f32_16x16x32_bf16 v[176:179], a[36:39], a[132:135], v[176:179]
v_mfma_f32_16x16x32_bf16 v[180:183], a[40:43], a[128:131], v[180:183]
ds_read_b128 a[108:111], v3 offset:43008
v_mfma_f32_16x16x32_bf16 v[180:183], a[44:47], a[132:135], v[180:183]
v_mfma_f32_16x16x32_bf16 v[184:187], a[48:51], a[128:131], v[184:187]
ds_read_b128 a[112:115], v2 offset:45056
v_mfma_f32_16x16x32_bf16 v[184:187], a[52:55], a[132:135], v[184:187]
v_mfma_f32_16x16x32_bf16 v[188:191], a[56:59], a[128:131], v[188:191]
v_mfma_f32_16x16x32_bf16 v[188:191], a[60:63], a[132:135], v[188:191]
s_waitcnt lgkmcnt(4)
v_mfma_f32_16x16x32_bf16 v[192:195], a[0:3], a[136:139], v[192:195]
s_waitcnt lgkmcnt(2)
ds_read_b64_tr_b16 a[128:129], v10 offset:0
v_mfma_f32_16x16x32_bf16 v[192:195], a[4:7], a[140:143], v[192:195]
v_mfma_f32_16x16x32_bf16 v[196:199], a[8:11], a[136:139], v[196:199]
ds_read_b64_tr_b16 a[130:131], v10 offset:2048
v_mfma_f32_16x16x32_bf16 v[196:199], a[12:15], a[140:143], v[196:199]
v_mfma_f32_16x16x32_bf16 v[200:203], a[16:19], a[136:139], v[200:203]
ds_read_b64_tr_b16 a[132:133], v10 offset:16384
v_mfma_f32_16x16x32_bf16 v[200:203], a[20:23], a[140:143], v[200:203]
buffer_store_dwordx4 a[184:187], v224, s[4:7], s56 offen sc1
v_mfma_f32_16x16x32_bf16 v[204:207], a[24:27], a[136:139], v[204:207]
s_add_u32 s56, s56, 33792
ds_read_b64_tr_b16 a[134:135], v10 offset:18432
v_mfma_f32_16x16x32_bf16 v[204:207], a[28:31], a[140:143], v[204:207]
v_mfma_f32_16x16x32_bf16 v[208:211], a[32:35], a[136:139], v[208:211]
ds_read_b128 a[116:119], v3 offset:45056
v_mfma_f32_16x16x32_bf16 v[208:211], a[36:39], a[140:143], v[208:211]
v_mfma_f32_16x16x32_bf16 v[212:215], a[40:43], a[136:139], v[212:215]
ds_read_b128 a[120:123], v2 offset:47104
v_mfma_f32_16x16x32_bf16 v[212:215], a[44:47], a[140:143], v[212:215]
v_mfma_f32_16x16x32_bf16 v[216:219], a[48:51], a[136:139], v[216:219]
v_mfma_f32_16x16x32_bf16 v[216:219], a[52:55], a[140:143], v[216:219]
v_mfma_f32_16x16x32_bf16 v[220:223], a[56:59], a[136:139], v[220:223]
ds_read_b128 a[124:127], v3 offset:47104
v_mfma_f32_16x16x32_bf16 v[220:223], a[60:63], a[140:143], v[220:223]
s_waitcnt lgkmcnt(5)
v_mfma_f32_16x16x32_bf16 a[192:195], a[0:3], a[128:131], a[192:195]
s_waitcnt lgkmcnt(3)
ds_read_b64_tr_b16 a[136:137], v11 offset:0
v_mfma_f32_16x16x32_bf16 a[192:195], a[4:7], a[132:135], a[192:195]
v_mfma_f32_16x16x32_bf16 a[196:199], a[8:11], a[128:131], a[196:199]
ds_read_b64_tr_b16 a[138:139], v11 offset:2048
v_mfma_f32_16x16x32_bf16 a[196:199], a[12:15], a[132:135], a[196:199]
v_mfma_f32_16x16x32_bf16 a[200:203], a[16:19], a[128:131], a[200:203]
ds_read_b64_tr_b16 a[140:141], v11 offset:16384
v_mfma_f32_16x16x32_bf16 a[200:203], a[20:23], a[132:135], a[200:203]
v_mfma_f32_16x16x32_bf16 a[204:207], a[24:27], a[128:131], a[204:207]
ds_read_b64_tr_b16 a[142:143], v11 offset:18432
v_mfma_f32_16x16x32_bf16 a[204:207], a[28:31], a[132:135], a[204:207]
buffer_store_dwordx4 a[188:191], v224, s[4:7], s56 offen sc1
v_mfma_f32_16x16x32_bf16 a[208:211], a[32:35], a[128:131], a[208:211]
s_add_u32 s56, s56, 33792
v_mfma_f32_16x16x32_bf16 a[208:211], a[36:39], a[132:135], a[208:211]
v_mfma_f32_16x16x32_bf16 a[212:215], a[40:43], a[128:131], a[212:215]
v_mfma_f32_16x16x32_bf16 a[212:215], a[44:47], a[132:135], a[212:215]
v_mfma_f32_16x16x32_bf16 a[216:219], a[48:51], a[128:131], a[216:219]
v_mfma_f32_16x16x32_bf16 a[216:219], a[52:55], a[132:135], a[216:219]
v_mfma_f32_16x16x32_bf16 a[220:223], a[56:59], a[128:131], a[220:223]
v_mfma_f32_16x16x32_bf16 a[220:223], a[60:63], a[132:135], a[220:223]
s_waitcnt vmcnt(4) lgkmcnt(0)
s_barrier
v_mfma_f32_16x16x32_bf16 a[224:227], a[0:3], a[136:139], a[224:227]
s_add_u32 m0, s29, 65536
ds_read_b64_tr_b16 a[128:129], v4 offset:32768
v_mfma_f32_16x16x32_bf16 a[224:227], a[4:7], a[140:143], a[224:227]
buffer_load_dwordx4 v16, s[12:15], s26 offen offset:0 lds
v_mfma_f32_16x16x32_bf16 a[228:231], a[8:11], a[136:139], a[228:231]
ds_read_b64_tr_b16 a[130:131], v4 offset:34816
v_cmp_gt_u32 vcc, 0x100, v245
v_mfma_f32_16x16x32_bf16 a[228:231], a[12:15], a[140:143], a[228:231]
v_mfma_f32_16x16x32_bf16 a[232:235], a[16:19], a[136:139], a[232:235]
ds_read_b64_tr_b16 a[132:133], v4 offset:49152
v_mfma_f32_16x16x32_bf16 a[232:235], a[20:23], a[140:143], a[232:235]
buffer_load_dwordx4 v17, s[12:15], s26 offen offset:1024 lds
v_mfma_f32_16x16x32_bf16 a[236:239], a[24:27], a[136:139], a[236:239]
ds_read_b64_tr_b16 a[134:135], v4 offset:51200
v_mfma_f32_16x16x32_bf16 a[236:239], a[28:31], a[140:143], a[236:239]
v_mfma_f32_16x16x32_bf16 a[240:243], a[32:35], a[136:139], a[240:243]
v_mfma_f32_16x16x32_bf16 a[240:243], a[36:39], a[140:143], a[240:243]
buffer_load_dwordx4 v18, s[12:15], s26 offen offset:2048 lds
v_mfma_f32_16x16x32_bf16 a[244:247], a[40:43], a[136:139], a[244:247]
v_mfma_f32_16x16x32_bf16 a[244:247], a[44:47], a[140:143], a[244:247]
v_mfma_f32_16x16x32_bf16 a[248:251], a[48:51], a[136:139], a[248:251]
v_mfma_f32_16x16x32_bf16 a[248:251], a[52:55], a[140:143], a[248:251]
buffer_load_dwordx4 v19, s[12:15], s26 offen offset:3072 lds
v_mfma_f32_16x16x32_bf16 a[252:255], a[56:59], a[136:139], a[252:255]
s_add_u32 s26, s26, 524288
v_mfma_f32_16x16x32_bf16 a[252:255], a[60:63], a[140:143], a[252:255]
s_waitcnt lgkmcnt(2)
s_mov_b32 s82, s59
s_cbranch_vccnz M_cntspinV
s_branch Lg_2
Lg_2t:
buffer_load_dword v230, v231, s[4:7], s52 offen sc1
v_mfma_f32_16x16x32_bf16 v[32:35], a[64:67], a[128:131], v[32:35]
s_waitcnt lgkmcnt(0)
s_add_u32 m0, s29, 81920
ds_read_b64_tr_b16 a[136:137], v5 offset:32768
v_mfma_f32_16x16x32_bf16 v[32:35], a[68:71], a[132:135], v[32:35]
buffer_load_dwordx4 v16, s[12:15], s27 offen offset:0 lds
v_mfma_f32_16x16x32_bf16 v[36:39], a[72:75], a[128:131], v[36:39]
s_and_b32 s44, s3, 1
ds_read_b64_tr_b16 a[138:139], v5 offset:34816
v_mfma_f32_16x16x32_bf16 v[36:39], a[76:79], a[132:135], v[36:39]
s_lshl_b32 s44, s44, 8
v_mfma_f32_16x16x32_bf16 v[40:43], a[80:83], a[128:131], v[40:43]
s_lshl_b32 s45, s3, 7
ds_read_b64_tr_b16 a[140:141], v5 offset:49152
v_mfma_f32_16x16x32_bf16 v[40:43], a[84:87], a[132:135], v[40:43]
s_xor_b32 s44, s44, s45
buffer_load_dwordx4 v17, s[12:15], s27 offen offset:1024 lds
v_mfma_f32_16x16x32_bf16 v[44:47], a[88:91], a[128:131], v[44:47]
s_xor_b32 s44, s44, 196608
ds_read_b64_tr_b16 a[142:143], v5 offset:51200
v_mfma_f32_16x16x32_bf16 v[44:47], a[92:95], a[132:135], v[44:47]
v_mfma_f32_16x16x32_bf16 v[48:51], a[96:99], a[128:131], v[48:51]
ds_read_b128 a[0:3], v2 offset:0
v_mfma_f32_16x16x32_bf16 v[48:51], a[100:103], a[132:135], v[48:51]
buffer_load_dwordx4 v18, s[12:15], s27 offen offset:2048 lds
v_mfma_f32_16x16x32_bf16 v[52:55], a[104:107], a[128:131], v[52:55]
ds_read_b128 a[4:7], v3 offset:0
v_mfma_f32_16x16x32_bf16 v[52:55], a[108:111], a[132:135], v[52:55]
v_mfma_f32_16x16x32_bf16 v[56:59], a[112:115], a[128:131], v[56:59]
v_mfma_f32_16x16x32_bf16 v[56:59], a[116:119], a[132:135], v[56:59]
buffer_load_dwordx4 v19, s[12:15], s27 offen offset:3072 lds
v_mfma_f32_16x16x32_bf16 v[60:63], a[120:123], a[128:131], v[60:63]
s_add_u32 s27, s27, 524288
ds_read_b128 a[8:11], v2 offset:2048
v_mfma_f32_16x16x32_bf16 v[60:63], a[124:127], a[132:135], v[60:63]
s_waitcnt lgkmcnt(5)
v_mfma_f32_16x16x32_bf16 v[64:67], a[64:67], a[136:139], v[64:67]
s_waitcnt lgkmcnt(3)
s_add_u32 m0, s28, 32768
ds_read_b64_tr_b16 a[128:129], v6 offset:32768
v_mfma_f32_16x16x32_bf16 v[64:67], a[68:71], a[140:143], v[64:67]
buffer_load_dwordx4 v12, s[8:11], s24 offen offset:0 lds
v_mfma_f32_16x16x32_bf16 v[68:71], a[72:75], a[136:139], v[68:71]
ds_read_b64_tr_b16 a[130:131], v6 offset:34816
v_mfma_f32_16x16x32_bf16 v[68:71], a[76:79], a[140:143], v[68:71]
v_mfma_f32_16x16x32_bf16 v[72:75], a[80:83], a[136:139], v[72:75]
s_mov_b64 s[56:57], s[72:73]
ds_read_b64_tr_b16 a[132:133], v6 offset:49152
v_mfma_f32_16x16x32_bf16 v[72:75], a[84:87], a[140:143], v[72:75]
s_mov_b32 s58, 1835008
buffer_load_dwordx4 v13, s[8:11], s24 offen offset:1024 lds
v_mfma_f32_16x16x32_bf16 v[76:79], a[88:91], a[136:139], v[76:79]
s_mov_b32 s59, 0x20000
ds_read_b64_tr_b16 a[134:135], v6 offset:51200
v_mfma_f32_16x16x32_bf16 v[76:79], a[92:95], a[140:143], v[76:79]
v_mfma_f32_16x16x32_bf16 v[80:83], a[96:99], a[136:139], v[80:83]
ds_read_b128 a[12:15], v3 offset:2048
v_mfma_f32_16x16x32_bf16 v[80:83], a[100:103], a[140:143], v[80:83]
buffer_load_dwordx4 v14, s[8:11], s24 offen offset:2048 lds
v_mfma_f32_16x16x32_bf16 v[84:87], a[104:107], a[136:139], v[84:87]
v_mfma_f32_16x16x32_bf16 v[84:87], a[108:111], a[140:143], v[84:87]
v_mfma_f32_16x16x32_bf16 v[88:91], a[112:115], a[136:139], v[88:91]
ds_read_b128 a[16:19], v2 offset:4096
v_mfma_f32_16x16x32_bf16 v[88:91], a[116:119], a[140:143], v[88:91]
buffer_load_dwordx4 v15, s[8:11], s24 offen offset:3072 lds
v_mfma_f32_16x16x32_bf16 v[92:95], a[120:123], a[136:139], v[92:95]
s_add_u32 s24, s24, 128
ds_read_b128 a[20:23], v3 offset:4096
v_mfma_f32_16x16x32_bf16 v[92:95], a[124:127], a[140:143], v[92:95]
s_waitcnt lgkmcnt(5)
v_mfma_f32_16x16x32_bf16 v[96:99], a[64:67], a[128:131], v[96:99]
s_waitcnt lgkmcnt(3)
s_add_u32 m0, s28, 36864
ds_read_b64_tr_b16 a[136:137], v7 offset:32768
v_mfma_f32_16x16x32_bf16 v[96:99], a[68:71], a[132:135], v[96:99]
buffer_load_dwordx4 v12, s[8:11], s25 offen offset:0 lds
v_mfma_f32_16x16x32_bf16 v[100:103], a[72:75], a[128:131], v[100:103]
ds_read_b64_tr_b16 a[138:139], v7 offset:34816
v_mfma_f32_16x16x32_bf16 v[100:103], a[76:79], a[132:135], v[100:103]
v_mfma_f32_16x16x32_bf16 v[104:107], a[80:83], a[128:131], v[104:107]
ds_read_b64_tr_b16 a[140:141], v7 offset:49152
v_mfma_f32_16x16x32_bf16 v[104:107], a[84:87], a[132:135], v[104:107]
buffer_load_dwordx4 v13, s[8:11], s25 offen offset:1024 lds
v_mfma_f32_16x16x32_bf16 v[108:111], a[88:91], a[128:131], v[108:111]
ds_read_b64_tr_b16 a[142:143], v7 offset:51200
v_mfma_f32_16x16x32_bf16 v[108:111], a[92:95], a[132:135], v[108:111]
v_mfma_f32_16x16x32_bf16 v[112:115], a[96:99], a[128:131], v[112:115]
v_mfma_f32_16x16x32_bf16 v[112:115], a[100:103], a[132:135], v[112:115]
buffer_load_dwordx4 v14, s[8:11], s25 offen offset:2048 lds
v_mfma_f32_16x16x32_bf16 v[116:119], a[104:107], a[128:131], v[116:119]
ds_read_b128 a[24:27], v2 offset:6144
v_mfma_f32_16x16x32_bf16 v[116:119], a[108:111], a[132:135], v[116:119]
v_mfma_f32_16x16x32_bf16 v[120:123], a[112:115], a[128:131], v[120:123]
ds_read_b128 a[28:31], v3 offset:6144
v_mfma_f32_16x16x32_bf16 v[120:123], a[116:119], a[132:135], v[120:123]
buffer_load_dwordx4 v15, s[8:11], s25 offen offset:3072 lds
v_mfma_f32_16x16x32_bf16 v[124:127], a[120:123], a[128:131], v[124:127]
s_add_u32 s25, s25, 128
s_waitcnt vmcnt(12)
v_mfma_f32_16x16x32_bf16 v[124:127], a[124:127], a[132:135], v[124:127]
s_waitcnt lgkmcnt(4)
v_cmp_gt_u32 vcc, 1, v230
v_mfma_f32_16x16x32_bf16 v[128:131], a[64:67], a[136:139], v[128:131]
s_waitcnt lgkmcnt(2)
s_cbranch_vccnz M_ppspinV
M_ppokV:
ds_read_b64_tr_b16 a[128:129], v8 offset:32768
v_mfma_f32_16x16x32_bf16 v[128:131], a[68:71], a[140:143], v[128:131]
buffer_load_dword v230, v229, s[4:7], s53 offen sc1
v_mfma_f32_16x16x32_bf16 v[132:135], a[72:75], a[136:139], v[132:135]
s_mov_b64 s[8:9], s[76:77]
ds_read_b64_tr_b16 a[130:131], v8 offset:34816
v_mfma_f32_16x16x32_bf16 v[132:135], a[76:79], a[140:143], v[132:135]
s_mov_b32 s10, 1835008
buffer_load_dword v230, v229, s[4:7], s48 offen sc1
v_mfma_f32_16x16x32_bf16 v[136:139], a[80:83], a[136:139], v[136:139]
s_lshl_b32 s24, s37, 2
ds_read_b64_tr_b16 a[132:133], v8 offset:49152
v_mfma_f32_16x16x32_bf16 v[136:139], a[84:87], a[140:143], v[136:139]
s_add_u32 s24, s24, s3
buffer_load_dword v230, v229, s[56:59], s49 offen
v_mfma_f32_16x16x32_bf16 v[140:143], a[88:91], a[136:139], v[140:143]
s_mul_i32 s24, s24, 28672
ds_read_b64_tr_b16 a[134:135], v8 offset:51200
v_mfma_f32_16x16x32_bf16 v[140:143], a[92:95], a[140:143], v[140:143]
s_mov_b32 s28, s29
buffer_load_dword v21, v20, s[16:19], s43 offen
v_mfma_f32_16x16x32_bf16 v[144:147], a[96:99], a[136:139], v[144:147]
ds_read_b128 a[32:35], v2 offset:8192
v_mfma_f32_16x16x32_bf16 v[144:147], a[100:103], a[140:143], v[144:147]
v_mfma_f32_16x16x32_bf16 v[148:151], a[104:107], a[136:139], v[148:151]
v_mfma_f32_16x16x32_bf16 v[148:151], a[108:111], a[140:143], v[148:151]
v_mfma_f32_16x16x32_bf16 v[152:155], a[112:115], a[136:139], v[152:155]
ds_read_b128 a[36:39], v3 offset:8192
v_lshrrev_b32 v28, 7, v1
v_mfma_f32_16x16x32_bf16 v[152:155], a[116:119], a[140:143], v[152:155]
v_lshrrev_b32 v29, 1, v28
v_lshlrev_b32 v29, 4, v29
v_mfma_f32_16x16x32_bf16 v[156:159], a[120:123], a[136:139], v[156:159]
ds_read_b128 a[40:43], v2 offset:10240
v_and_b32 v30, 0x70, v1
v_mfma_f32_16x16x32_bf16 v[156:159], a[124:127], a[140:143], v[156:159]
s_waitcnt lgkmcnt(5)
v_xor_b32 v29, v29, v30
v_mul_u32_u24 v28, 896, v28
v_mfma_f32_16x16x32_bf16 v[160:163], a[64:67], a[128:131], v[160:163]
s_waitcnt lgkmcnt(3)
ds_read_b64_tr_b16 a[136:137], v9 offset:32768
v_add_u32 v12, v28, v29
v_mfma_f32_16x16x32_bf16 v[160:163], a[68:71], a[132:135], v[160:163]
v_xor_b32 v29, 64, v29
v_add_u32 v28, v28, v29
v_mfma_f32_16x16x32_bf16 v[164:167], a[72:75], a[128:131], v[164:167]
ds_read_b64_tr_b16 a[138:139], v9 offset:34816
v_add_u32 v13, 6144, v28
v_mfma_f32_16x16x32_bf16 v[164:167], a[76:79], a[132:135], v[164:167]
v_add_u32 v14, 12288, v12
v_add_u32 v15, 18432, v28
v_mfma_f32_16x16x32_bf16 v[168:171], a[80:83], a[128:131], v[168:171]
ds_read_b64_tr_b16 a[140:141], v9 offset:49152
v_xor_b32 v22, s44, v4
v_mfma_f32_16x16x32_bf16 v[168:171], a[84:87], a[132:135], v[168:171]
v_xor_b32 v23, 32, v22
v_xor_b32 v24, 64, v22
v_mfma_f32_16x16x32_bf16 v[172:175], a[88:91], a[128:131], v[172:175]
ds_read_b64_tr_b16 a[142:143], v9 offset:51200
v_xor_b32 v25, 96, v22
v_mfma_f32_16x16x32_bf16 v[172:175], a[92:95], a[132:135], v[172:175]
v_mfma_f32_16x16x32_bf16 v[176:179], a[96:99], a[128:131], v[176:179]
v_mfma_f32_16x16x32_bf16 v[176:179], a[100:103], a[132:135], v[176:179]
v_mfma_f32_16x16x32_bf16 v[180:183], a[104:107], a[128:131], v[180:183]
ds_read_b128 a[44:47], v3 offset:10240
v_mfma_f32_16x16x32_bf16 v[180:183], a[108:111], a[132:135], v[180:183]
v_mfma_f32_16x16x32_bf16 v[184:187], a[112:115], a[128:131], v[184:187]
ds_read_b128 a[48:51], v2 offset:12288
v_mfma_f32_16x16x32_bf16 v[184:187], a[116:119], a[132:135], v[184:187]
v_mfma_f32_16x16x32_bf16 v[188:191], a[120:123], a[128:131], v[188:191]
v_mfma_f32_16x16x32_bf16 v[188:191], a[124:127], a[132:135], v[188:191]
s_waitcnt lgkmcnt(4)
v_mfma_f32_16x16x32_bf16 v[192:195], a[64:67], a[136:139], v[192:195]
s_waitcnt lgkmcnt(2)
ds_read_b64_tr_b16 a[128:129], v10 offset:32768
v_mfma_f32_16x16x32_bf16 v[192:195], a[68:71], a[140:143], v[192:195]
v_mfma_f32_16x16x32_bf16 v[196:199], a[72:75], a[136:139], v[196:199]
ds_read_b64_tr_b16 a[130:131], v10 offset:34816
v_mfma_f32_16x16x32_bf16 v[196:199], a[76:79], a[140:143], v[196:199]
v_mfma_f32_16x16x32_bf16 v[200:203], a[80:83], a[136:139], v[200:203]
ds_read_b64_tr_b16 a[132:133], v10 offset:49152
v_mfma_f32_16x16x32_bf16 v[200:203], a[84:87], a[140:143], v[200:203]
v_mfma_f32_16x16x32_bf16 v[204:207], a[88:91], a[136:139], v[204:207]
ds_read_b64_tr_b16 a[134:135], v10 offset:51200
v_mfma_f32_16x16x32_bf16 v[204:207], a[92:95], a[140:143], v[204:207]
v_mfma_f32_16x16x32_bf16 v[208:211], a[96:99], a[136:139], v[208:211]
ds_read_b128 a[52:55], v3 offset:12288
v_mfma_f32_16x16x32_bf16 v[208:211], a[100:103], a[140:143], v[208:211]
v_mfma_f32_16x16x32_bf16 v[212:215], a[104:107], a[136:139], v[212:215]
ds_read_b128 a[56:59], v2 offset:14336
v_mfma_f32_16x16x32_bf16 v[212:215], a[108:111], a[140:143], v[212:215]
v_mfma_f32_16x16x32_bf16 v[216:219], a[112:115], a[136:139], v[216:219]
v_mfma_f32_16x16x32_bf16 v[216:219], a[116:119], a[140:143], v[216:219]
v_mfma_f32_16x16x32_bf16 v[220:223], a[120:123], a[136:139], v[220:223]
ds_read_b128 a[60:63], v3 offset:14336
v_mfma_f32_16x16x32_bf16 v[220:223], a[124:127], a[140:143], v[220:223]
s_waitcnt lgkmcnt(5)
v_mfma_f32_16x16x32_bf16 a[192:195], a[64:67], a[128:131], a[192:195]
s_waitcnt lgkmcnt(3)
ds_read_b64_tr_b16 a[136:137], v11 offset:32768
v_mfma_f32_16x16x32_bf16 a[192:195], a[68:71], a[132:135], a[192:195]
v_mfma_f32_16x16x32_bf16 a[196:199], a[72:75], a[128:131], a[196:199]
ds_read_b64_tr_b16 a[138:139], v11 offset:34816
v_mfma_f32_16x16x32_bf16 a[196:199], a[76:79], a[132:135], a[196:199]
v_mfma_f32_16x16x32_bf16 a[200:203], a[80:83], a[128:131], a[200:203]
ds_read_b64_tr_b16 a[140:141], v11 offset:49152
v_mfma_f32_16x16x32_bf16 a[200:203], a[84:87], a[132:135], a[200:203]
v_mfma_f32_16x16x32_bf16 a[204:207], a[88:91], a[128:131], a[204:207]
ds_read_b64_tr_b16 a[142:143], v11 offset:51200
v_mfma_f32_16x16x32_bf16 a[204:207], a[92:95], a[132:135], a[204:207]
v_mfma_f32_16x16x32_bf16 a[208:211], a[96:99], a[128:131], a[208:211]
v_mfma_f32_16x16x32_bf16 a[208:211], a[100:103], a[132:135], a[208:211]
v_mfma_f32_16x16x32_bf16 a[212:215], a[104:107], a[128:131], a[212:215]
v_mfma_f32_16x16x32_bf16 a[212:215], a[108:111], a[132:135], a[212:215]
v_mfma_f32_16x16x32_bf16 a[216:219], a[112:115], a[128:131], a[216:219]
v_mfma_f32_16x16x32_bf16 a[216:219], a[116:119], a[132:135], a[216:219]
v_mfma_f32_16x16x32_bf16 a[220:223], a[120:123], a[128:131], a[220:223]
v_mfma_f32_16x16x32_bf16 a[220:223], a[124:127], a[132:135], a[220:223]
s_waitcnt vmcnt(4) lgkmcnt(0)
s_barrier
v_mfma_f32_16x16x32_bf16 a[224:227], a[64:67], a[136:139], a[224:227]
s_add_u32 m0, s29, 98304
ds_read_b64_tr_b16 a[128:129], v4 offset:0
v_mfma_f32_16x16x32_bf16 a[224:227], a[68:71], a[140:143], a[224:227]
buffer_load_dwordx4 v16, s[12:15], s26 offen offset:0 lds
v_mfma_f32_16x16x32_bf16 a[228:231], a[72:75], a[136:139], a[228:231]
ds_read_b64_tr_b16 a[130:131], v4 offset:2048
v_mfma_f32_16x16x32_bf16 a[228:231], a[76:79], a[140:143], a[228:231]
v_mfma_f32_16x16x32_bf16 a[232:235], a[80:83], a[136:139], a[232:235]
ds_read_b64_tr_b16 a[132:133], v4 offset:16384
v_mfma_f32_16x16x32_bf16 a[232:235], a[84:87], a[140:143], a[232:235]
buffer_load_dwordx4 v17, s[12:15], s26 offen offset:1024 lds
v_mfma_f32_16x16x32_bf16 a[236:239], a[88:91], a[136:139], a[236:239]
ds_read_b64_tr_b16 a[134:135], v4 offset:18432
v_mfma_f32_16x16x32_bf16 a[236:239], a[92:95], a[140:143], a[236:239]
v_mfma_f32_16x16x32_bf16 a[240:243], a[96:99], a[136:139], a[240:243]
v_mfma_f32_16x16x32_bf16 a[240:243], a[100:103], a[140:143], a[240:243]
buffer_load_dwordx4 v18, s[12:15], s26 offen offset:2048 lds
v_mfma_f32_16x16x32_bf16 a[244:247], a[104:107], a[136:139], a[244:247]
v_mfma_f32_16x16x32_bf16 a[244:247], a[108:111], a[140:143], a[244:247]
v_mfma_f32_16x16x32_bf16 a[248:251], a[112:115], a[136:139], a[248:251]
v_mfma_f32_16x16x32_bf16 a[248:251], a[116:119], a[140:143], a[248:251]
buffer_load_dwordx4 v19, s[12:15], s26 offen offset:3072 lds
v_mfma_f32_16x16x32_bf16 a[252:255], a[120:123], a[136:139], a[252:255]
s_add_u32 s26, s26, 524288
v_mfma_f32_16x16x32_bf16 a[252:255], a[124:127], a[140:143], a[252:255]
s_waitcnt lgkmcnt(2)
v_mfma_f32_16x16x32_bf16 v[32:35], a[0:3], a[128:131], v[32:35]
s_waitcnt lgkmcnt(0)
s_add_u32 m0, s29, 114688
ds_read_b64_tr_b16 a[136:137], v5 offset:0
v_mfma_f32_16x16x32_bf16 v[32:35], a[4:7], a[132:135], v[32:35]
buffer_load_dwordx4 v16, s[12:15], s27 offen offset:0 lds
v_mfma_f32_16x16x32_bf16 v[36:39], a[8:11], a[128:131], v[36:39]
ds_read_b64_tr_b16 a[138:139], v5 offset:2048
v_mfma_f32_16x16x32_bf16 v[36:39], a[12:15], a[132:135], v[36:39]
v_mfma_f32_16x16x32_bf16 v[40:43], a[16:19], a[128:131], v[40:43]
ds_read_b64_tr_b16 a[140:141], v5 offset:16384
v_mfma_f32_16x16x32_bf16 v[40:43], a[20:23], a[132:135], v[40:43]
buffer_load_dwordx4 v17, s[12:15], s27 offen offset:1024 lds
v_mfma_f32_16x16x32_bf16 v[44:47], a[24:27], a[128:131], v[44:47]
ds_read_b64_tr_b16 a[142:143], v5 offset:18432
v_mfma_f32_16x16x32_bf16 v[44:47], a[28:31], a[132:135], v[44:47]
v_mfma_f32_16x16x32_bf16 v[48:51], a[32:35], a[128:131], v[48:51]
ds_read_b128 a[64:67], v2 offset:32768
v_mfma_f32_16x16x32_bf16 v[48:51], a[36:39], a[132:135], v[48:51]
buffer_load_dwordx4 v18, s[12:15], s27 offen offset:2048 lds
v_mfma_f32_16x16x32_bf16 v[52:55], a[40:43], a[128:131], v[52:55]
ds_read_b128 a[68:71], v3 offset:32768
v_mfma_f32_16x16x32_bf16 v[52:55], a[44:47], a[132:135], v[52:55]
v_mfma_f32_16x16x32_bf16 v[56:59], a[48:51], a[128:131], v[56:59]
v_mfma_f32_16x16x32_bf16 v[56:59], a[52:55], a[132:135], v[56:59]
buffer_load_dwordx4 v19, s[12:15], s27 offen offset:3072 lds
v_mfma_f32_16x16x32_bf16 v[60:63], a[56:59], a[128:131], v[60:63]
s_add_u32 s27, s27, 524288
ds_read_b128 a[72:75], v2 offset:34816
v_mfma_f32_16x16x32_bf16 v[60:63], a[60:63], a[132:135], v[60:63]
s_waitcnt lgkmcnt(5)
v_mfma_f32_16x16x32_bf16 v[64:67], a[0:3], a[136:139], v[64:67]
s_waitcnt lgkmcnt(3)
s_add_u32 m0, s28, 0
ds_read_b64_tr_b16 a[128:129], v6 offset:0
v_mfma_f32_16x16x32_bf16 v[64:67], a[4:7], a[140:143], v[64:67]
buffer_load_dwordx4 v12, s[8:11], s24 offen offset:0 lds
v_mfma_f32_16x16x32_bf16 v[68:71], a[8:11], a[136:139], v[68:71]
ds_read_b64_tr_b16 a[130:131], v6 offset:2048
v_mfma_f32_16x16x32_bf16 v[68:71], a[12:15], a[140:143], v[68:71]
v_mfma_f32_16x16x32_bf16 v[72:75], a[16:19], a[136:139], v[72:75]
ds_read_b64_tr_b16 a[132:133], v6 offset:16384
v_mfma_f32_16x16x32_bf16 v[72:75], a[20:23], a[140:143], v[72:75]
buffer_load_dwordx4 v13, s[8:11], s24 offen offset:1024 lds
v_mfma_f32_16x16x32_bf16 v[76:79], a[24:27], a[136:139], v[76:79]
ds_read_b64_tr_b16 a[134:135], v6 offset:18432
v_mfma_f32_16x16x32_bf16 v[76:79], a[28:31], a[140:143], v[76:79]
v_mfma_f32_16x16x32_bf16 v[80:83], a[32:35], a[136:139], v[80:83]
ds_read_b128 a[76:79], v3 offset:34816
v_mfma_f32_16x16x32_bf16 v[80:83], a[36:39], a[140:143], v[80:83]
buffer_load_dwordx4 v14, s[8:11], s24 offen offset:2048 lds
v_mfma_f32_16x16x32_bf16 v[84:87], a[40:43], a[136:139], v[84:87]
v_mfma_f32_16x16x32_bf16 v[84:87], a[44:47], a[140:143], v[84:87]
v_mfma_f32_16x16x32_bf16 v[88:91], a[48:51], a[136:139], v[88:91]
ds_read_b128 a[80:83], v2 offset:36864
v_mfma_f32_16x16x32_bf16 v[88:91], a[52:55], a[140:143], v[88:91]
buffer_load_dwordx4 v15, s[8:11], s24 offen offset:3072 lds
v_mfma_f32_16x16x32_bf16 v[92:95], a[56:59], a[136:139], v[92:95]
s_add_u32 s24, s24, 128
ds_read_b128 a[84:87], v3 offset:36864
v_mfma_f32_16x16x32_bf16 v[92:95], a[60:63], a[140:143], v[92:95]
s_waitcnt lgkmcnt(3)
s_mov_b64 s[12:13], s[80:81]
v_mfma_f32_16x16x32_bf16 v[96:99], a[0:3], a[128:131], v[96:99]
s_mov_b32 s14, 3670016
s_add_u32 m0, s28, 16384
ds_read_b64_tr_b16 a[136:137], v7 offset:0
v_mfma_f32_16x16x32_bf16 v[96:99], a[4:7], a[132:135], v[96:99]
buffer_load_dwordx4 v12, s[8:11], s24 offen offset:0 lds
v_mfma_f32_16x16x32_bf16 v[100:103], a[8:11], a[128:131], v[100:103]
ds_read_b64_tr_b16 a[138:139], v7 offset:2048
v_mfma_f32_16x16x32_bf16 v[100:103], a[12:15], a[132:135], v[100:103]
v_mfma_f32_16x16x32_bf16 v[104:107], a[16:19], a[128:131], v[104:107]
ds_read_b64_tr_b16 a[140:141], v7 offset:16384
v_mfma_f32_16x16x32_bf16 v[104:107], a[20:23], a[132:135], v[104:107]
buffer_load_dwordx4 v13, s[8:11], s24 offen offset:1024 lds
v_mfma_f32_16x16x32_bf16 v[108:111], a[24:27], a[128:131], v[108:111]
ds_read_b64_tr_b16 a[142:143], v7 offset:18432
v_mfma_f32_16x16x32_bf16 v[108:111], a[28:31], a[132:135], v[108:111]
v_mfma_f32_16x16x32_bf16 v[112:115], a[32:35], a[128:131], v[112:115]
v_mfma_f32_16x16x32_bf16 v[112:115], a[36:39], a[132:135], v[112:115]
buffer_load_dwordx4 v14, s[8:11], s24 offen offset:2048 lds
v_mfma_f32_16x16x32_bf16 v[116:119], a[40:43], a[128:131], v[116:119]
ds_read_b128 a[88:91], v2 offset:38912
v_mfma_f32_16x16x32_bf16 v[116:119], a[44:47], a[132:135], v[116:119]
v_mfma_f32_16x16x32_bf16 v[120:123], a[48:51], a[128:131], v[120:123]
ds_read_b128 a[92:95], v3 offset:38912
v_mfma_f32_16x16x32_bf16 v[120:123], a[52:55], a[132:135], v[120:123]
buffer_load_dwordx4 v15, s[8:11], s24 offen offset:3072 lds
v_mfma_f32_16x16x32_bf16 v[124:127], a[56:59], a[128:131], v[124:127]
s_add_u32 s24, s24, 128
v_mfma_f32_16x16x32_bf16 v[124:127], a[60:63], a[132:135], v[124:127]
s_waitcnt lgkmcnt(2)
s_sub_u32 s26, s26, 8388608
v_mfma_f32_16x16x32_bf16 v[128:131], a[0:3], a[136:139], v[128:131]
s_sub_u32 s27, s27, 8388608
s_add_u32 m0, s29, 131072
ds_read_b64_tr_b16 a[128:129], v8 offset:0
v_mfma_f32_16x16x32_bf16 v[128:131], a[4:7], a[140:143], v[128:131]
buffer_load_dwordx4 v16, s[12:15], s26 offen offset:0 lds
v_mfma_f32_16x16x32_bf16 v[132:135], a[8:11], a[136:139], v[132:135]
ds_read_b64_tr_b16 a[130:131], v8 offset:2048
v_mfma_f32_16x16x32_bf16 v[132:135], a[12:15], a[140:143], v[132:135]
v_mfma_f32_16x16x32_bf16 v[136:139], a[16:19], a[136:139], v[136:139]
ds_read_b64_tr_b16 a[132:133], v8 offset:16384
v_mfma_f32_16x16x32_bf16 v[136:139], a[20:23], a[140:143], v[136:139]
buffer_load_dwordx4 v17, s[12:15], s26 offen offset:1024 lds
v_mfma_f32_16x16x32_bf16 v[140:143], a[24:27], a[136:139], v[140:143]
ds_read_b64_tr_b16 a[134:135], v8 offset:18432
v_mfma_f32_16x16x32_bf16 v[140:143], a[28:31], a[140:143], v[140:143]
v_mfma_f32_16x16x32_bf16 v[144:147], a[32:35], a[136:139], v[144:147]
ds_read_b128 a[96:99], v2 offset:40960
v_mfma_f32_16x16x32_bf16 v[144:147], a[36:39], a[140:143], v[144:147]
buffer_load_dwordx4 v18, s[12:15], s26 offen offset:2048 lds
v_mfma_f32_16x16x32_bf16 v[148:151], a[40:43], a[136:139], v[148:151]
v_mfma_f32_16x16x32_bf16 v[148:151], a[44:47], a[140:143], v[148:151]
v_mfma_f32_16x16x32_bf16 v[152:155], a[48:51], a[136:139], v[152:155]
ds_read_b128 a[100:103], v3 offset:40960
v_mfma_f32_16x16x32_bf16 v[152:155], a[52:55], a[140:143], v[152:155]
buffer_load_dwordx4 v19, s[12:15], s26 offen offset:3072 lds
v_mfma_f32_16x16x32_bf16 v[156:159], a[56:59], a[136:139], v[156:159]
s_add_u32 s26, s26, 524288
ds_read_b128 a[104:107], v2 offset:43008
v_mfma_f32_16x16x32_bf16 v[156:159], a[60:63], a[140:143], v[156:159]
s_waitcnt lgkmcnt(5)
v_mfma_f32_16x16x32_bf16 v[160:163], a[0:3], a[128:131], v[160:163]
s_waitcnt lgkmcnt(3)
s_add_u32 m0, s29, 147456
ds_read_b64_tr_b16 a[136:137], v9 offset:0
v_mfma_f32_16x16x32_bf16 v[160:163], a[4:7], a[132:135], v[160:163]
buffer_load_dwordx4 v16, s[12:15], s27 offen offset:0 lds
v_mfma_f32_16x16x32_bf16 v[164:167], a[8:11], a[128:131], v[164:167]
ds_read_b64_tr_b16 a[138:139], v9 offset:2048
v_mfma_f32_16x16x32_bf16 v[164:167], a[12:15], a[132:135], v[164:167]
v_mfma_f32_16x16x32_bf16 v[168:171], a[16:19], a[128:131], v[168:171]
ds_read_b64_tr_b16 a[140:141], v9 offset:16384
v_mfma_f32_16x16x32_bf16 v[168:171], a[20:23], a[132:135], v[168:171]
buffer_load_dwordx4 v17, s[12:15], s27 offen offset:1024 lds
v_mfma_f32_16x16x32_bf16 v[172:175], a[24:27], a[128:131], v[172:175]
ds_read_b64_tr_b16 a[142:143], v9 offset:18432
v_mfma_f32_16x16x32_bf16 v[172:175], a[28:31], a[132:135], v[172:175]
v_mfma_f32_16x16x32_bf16 v[176:179], a[32:35], a[128:131], v[176:179]
v_mfma_f32_16x16x32_bf16 v[176:179], a[36:39], a[132:135], v[176:179]
buffer_load_dwordx4 v18, s[12:15], s27 offen offset:2048 lds
v_mfma_f32_16x16x32_bf16 v[180:183], a[40:43], a[128:131], v[180:183]
ds_read_b128 a[108:111], v3 offset:43008
v_mfma_f32_16x16x32_bf16 v[180:183], a[44:47], a[132:135], v[180:183]
v_mfma_f32_16x16x32_bf16 v[184:187], a[48:51], a[128:131], v[184:187]
ds_read_b128 a[112:115], v2 offset:45056
v_mfma_f32_16x16x32_bf16 v[184:187], a[52:55], a[132:135], v[184:187]
buffer_load_dwordx4 v19, s[12:15], s27 offen offset:3072 lds
v_mfma_f32_16x16x32_bf16 v[188:191], a[56:59], a[128:131], v[188:191]
s_add_u32 s27, s27, 524288
v_mfma_f32_16x16x32_bf16 v[188:191], a[60:63], a[132:135], v[188:191]
s_waitcnt lgkmcnt(4)
v_mfma_f32_16x16x32_bf16 v[192:195], a[0:3], a[136:139], v[192:195]
s_waitcnt lgkmcnt(2)
ds_read_b64_tr_b16 a[128:129], v10 offset:0
v_mfma_f32_16x16x32_bf16 v[192:195], a[4:7], a[140:143], v[192:195]
v_mfma_f32_16x16x32_bf16 v[196:199], a[8:11], a[136:139], v[196:199]
ds_read_b64_tr_b16 a[130:131], v10 offset:2048
v_mfma_f32_16x16x32_bf16 v[196:199], a[12:15], a[140:143], v[196:199]
v_mfma_f32_16x16x32_bf16 v[200:203], a[16:19], a[136:139], v[200:203]
ds_read_b64_tr_b16 a[132:133], v10 offset:16384
v_mfma_f32_16x16x32_bf16 v[200:203], a[20:23], a[140:143], v[200:203]
v_mfma_f32_16x16x32_bf16 v[204:207], a[24:27], a[136:139], v[204:207]
ds_read_b64_tr_b16 a[134:135], v10 offset:18432
v_mfma_f32_16x16x32_bf16 v[204:207], a[28:31], a[140:143], v[204:207]
v_mfma_f32_16x16x32_bf16 v[208:211], a[32:35], a[136:139], v[208:211]
ds_read_b128 a[116:119], v3 offset:45056
v_mfma_f32_16x16x32_bf16 v[208:211], a[36:39], a[140:143], v[208:211]
v_mfma_f32_16x16x32_bf16 v[212:215], a[40:43], a[136:139], v[212:215]
ds_read_b128 a[120:123], v2 offset:47104
v_mfma_f32_16x16x32_bf16 v[212:215], a[44:47], a[140:143], v[212:215]
v_mfma_f32_16x16x32_bf16 v[216:219], a[48:51], a[136:139], v[216:219]
v_mfma_f32_16x16x32_bf16 v[216:219], a[52:55], a[140:143], v[216:219]
v_mfma_f32_16x16x32_bf16 v[220:223], a[56:59], a[136:139], v[220:223]
ds_read_b128 a[124:127], v3 offset:47104
v_mfma_f32_16x16x32_bf16 v[220:223], a[60:63], a[140:143], v[220:223]
s_waitcnt lgkmcnt(5)
v_mfma_f32_16x16x32_bf16 a[192:195], a[0:3], a[128:131], a[192:195]
s_waitcnt lgkmcnt(3)
ds_read_b64_tr_b16 a[136:137], v11 offset:0
v_mfma_f32_16x16x32_bf16 a[192:195], a[4:7], a[132:135], a[192:195]
v_mfma_f32_16x16x32_bf16 a[196:199], a[8:11], a[128:131], a[196:199]
ds_read_b64_tr_b16 a[138:139], v11 offset:2048
v_mfma_f32_16x16x32_bf16 a[196:199], a[12:15], a[132:135], a[196:199]
v_mfma_f32_16x16x32_bf16 a[200:203], a[16:19], a[128:131], a[200:203]
ds_read_b64_tr_b16 a[140:141], v11 offset:16384
v_mfma_f32_16x16x32_bf16 a[200:203], a[20:23], a[132:135], a[200:203]
v_mfma_f32_16x16x32_bf16 a[204:207], a[24:27], a[128:131], a[204:207]
ds_read_b64_tr_b16 a[142:143], v11 offset:18432
v_mfma_f32_16x16x32_bf16 a[204:207], a[28:31], a[132:135], a[204:207]
v_mfma_f32_16x16x32_bf16 a[208:211], a[32:35], a[128:131], a[208:211]
v_mfma_f32_16x16x32_bf16 a[208:211], a[36:39], a[132:135], a[208:211]
v_mfma_f32_16x16x32_bf16 a[212:215], a[40:43], a[128:131], a[212:215]
v_mfma_f32_16x16x32_bf16 a[212:215], a[44:47], a[132:135], a[212:215]
v_mfma_f32_16x16x32_bf16 a[216:219], a[48:51], a[128:131], a[216:219]
v_mfma_f32_16x16x32_bf16 a[216:219], a[52:55], a[132:135], a[216:219]
v_mfma_f32_16x16x32_bf16 a[220:223], a[56:59], a[128:131], a[220:223]
v_mfma_f32_16x16x32_bf16 a[220:223], a[60:63], a[132:135], a[220:223]
s_waitcnt vmcnt(12) lgkmcnt(0)
s_barrier
v_mfma_f32_16x16x32_bf16 a[224:227], a[0:3], a[136:139], a[224:227]
s_add_u32 m0, s28, 32768
ds_read_b64_tr_b16 a[128:129], v4 offset:32768
v_mfma_f32_16x16x32_bf16 a[224:227], a[4:7], a[140:143], a[224:227]
s_lshr_b32 s22, s3, 1
buffer_load_dwordx4 v12, s[8:11], s24 offen offset:0 lds
v_mfma_f32_16x16x32_bf16 a[228:231], a[8:11], a[136:139], a[228:231]
s_lshl_b32 s22, s22, 14
ds_read_b64_tr_b16 a[130:131], v4 offset:34816
v_subrev_u32 v2, s22, v2
v_mfma_f32_16x16x32_bf16 a[228:231], a[12:15], a[140:143], a[228:231]
v_subrev_u32 v3, s22, v3
v_mfma_f32_16x16x32_bf16 a[232:235], a[16:19], a[136:139], a[232:235]
ds_read_b64_tr_b16 a[132:133], v4 offset:49152
v_mfma_f32_16x16x32_bf16 a[232:235], a[20:23], a[140:143], a[232:235]
buffer_load_dwordx4 v13, s[8:11], s24 offen offset:1024 lds
v_mfma_f32_16x16x32_bf16 a[236:239], a[24:27], a[136:139], a[236:239]
ds_read_b64_tr_b16 a[134:135], v4 offset:51200
v_mfma_f32_16x16x32_bf16 a[236:239], a[28:31], a[140:143], a[236:239]
v_mfma_f32_16x16x32_bf16 a[240:243], a[32:35], a[136:139], a[240:243]
v_mfma_f32_16x16x32_bf16 a[240:243], a[36:39], a[140:143], a[240:243]
buffer_load_dwordx4 v14, s[8:11], s24 offen offset:2048 lds
v_mfma_f32_16x16x32_bf16 a[244:247], a[40:43], a[136:139], a[244:247]
v_mfma_f32_16x16x32_bf16 a[244:247], a[44:47], a[140:143], a[244:247]
v_mfma_f32_16x16x32_bf16 a[248:251], a[48:51], a[136:139], a[248:251]
v_mfma_f32_16x16x32_bf16 a[248:251], a[52:55], a[140:143], a[248:251]
buffer_load_dwordx4 v15, s[8:11], s24 offen offset:3072 lds
v_mfma_f32_16x16x32_bf16 a[252:255], a[56:59], a[136:139], a[252:255]
s_add_u32 s24, s24, 128
v_mfma_f32_16x16x32_bf16 a[252:255], a[60:63], a[140:143], a[252:255]
s_waitcnt lgkmcnt(2)
v_mfma_f32_16x16x32_bf16 v[32:35], a[64:67], a[128:131], v[32:35]
s_waitcnt lgkmcnt(0)
s_add_u32 m0, s29, 65536
ds_read_b64_tr_b16 a[136:137], v5 offset:32768
v_mfma_f32_16x16x32_bf16 v[32:35], a[68:71], a[132:135], v[32:35]
buffer_load_dwordx4 v16, s[12:15], s26 offen offset:0 lds
v_mfma_f32_16x16x32_bf16 v[36:39], a[72:75], a[128:131], v[36:39]
ds_read_b64_tr_b16 a[138:139], v5 offset:34816
v_mfma_f32_16x16x32_bf16 v[36:39], a[76:79], a[132:135], v[36:39]
v_mfma_f32_16x16x32_bf16 v[40:43], a[80:83], a[128:131], v[40:43]
ds_read_b64_tr_b16 a[140:141], v5 offset:49152
v_mfma_f32_16x16x32_bf16 v[40:43], a[84:87], a[132:135], v[40:43]
buffer_load_dwordx4 v17, s[12:15], s26 offen offset:1024 lds
v_mfma_f32_16x16x32_bf16 v[44:47], a[88:91], a[128:131], v[44:47]
ds_read_b64_tr_b16 a[142:143], v5 offset:51200
v_mfma_f32_16x16x32_bf16 v[44:47], a[92:95], a[132:135], v[44:47]
v_mfma_f32_16x16x32_bf16 v[48:51], a[96:99], a[128:131], v[48:51]
ds_read_b128 a[0:3], v2 offset:0
v_cvt_pk_bf16_f32 v32, v32, v33
v_mfma_f32_16x16x32_bf16 v[48:51], a[100:103], a[132:135], v[48:51]
buffer_load_dwordx4 v18, s[12:15], s26 offen offset:2048 lds
v_mfma_f32_16x16x32_bf16 v[52:55], a[104:107], a[128:131], v[52:55]
ds_read_b128 a[4:7], v3 offset:0
v_cvt_pk_bf16_f32 v33, v34, v35
v_mfma_f32_16x16x32_bf16 v[52:55], a[108:111], a[132:135], v[52:55]
v_cvt_pk_bf16_f32 v34, v36, v37
v_cvt_pk_bf16_f32 v35, v38, v39
v_mfma_f32_16x16x32_bf16 v[56:59], a[112:115], a[128:131], v[56:59]
v_cvt_pk_bf16_f32 v40, v40, v41
v_cvt_pk_bf16_f32 v41, v42, v43
v_mfma_f32_16x16x32_bf16 v[56:59], a[116:119], a[132:135], v[56:59]
buffer_load_dwordx4 v19, s[12:15], s26 offen offset:3072 lds
v_mfma_f32_16x16x32_bf16 v[60:63], a[120:123], a[128:131], v[60:63]
s_add_u32 s26, s26, 524288
ds_read_b128 a[8:11], v2 offset:2048
v_cvt_pk_bf16_f32 v42, v44, v45
v_mfma_f32_16x16x32_bf16 v[60:63], a[124:127], a[132:135], v[60:63]
s_waitcnt lgkmcnt(3)
v_cvt_pk_bf16_f32 v43, v46, v47
v_mfma_f32_16x16x32_bf16 v[64:67], a[64:67], a[136:139], v[64:67]
s_add_u32 m0, s29, 81920
ds_read_b64_tr_b16 a[128:129], v6 offset:32768
v_cvt_pk_bf16_f32 v48, v48, v49
v_mfma_f32_16x16x32_bf16 v[64:67], a[68:71], a[140:143], v[64:67]
buffer_load_dwordx4 v16, s[12:15], s27 offen offset:0 lds
v_mfma_f32_16x16x32_bf16 v[68:71], a[72:75], a[136:139], v[68:71]
ds_read_b64_tr_b16 a[130:131], v6 offset:34816
v_cvt_pk_bf16_f32 v49, v50, v51
v_mfma_f32_16x16x32_bf16 v[68:71], a[76:79], a[140:143], v[68:71]
v_cvt_pk_bf16_f32 v50, v52, v53
v_cvt_pk_bf16_f32 v51, v54, v55
v_mfma_f32_16x16x32_bf16 v[72:75], a[80:83], a[136:139], v[72:75]
ds_read_b64_tr_b16 a[132:133], v6 offset:49152
v_cvt_pk_bf16_f32 v56, v56, v57
v_mfma_f32_16x16x32_bf16 v[72:75], a[84:87], a[140:143], v[72:75]
buffer_load_dwordx4 v17, s[12:15], s27 offen offset:1024 lds
v_mfma_f32_16x16x32_bf16 v[76:79], a[88:91], a[136:139], v[76:79]
ds_read_b64_tr_b16 a[134:135], v6 offset:51200
v_cvt_pk_bf16_f32 v57, v58, v59
v_mfma_f32_16x16x32_bf16 v[76:79], a[92:95], a[140:143], v[76:79]
v_cvt_pk_bf16_f32 v58, v60, v61
v_cvt_pk_bf16_f32 v59, v62, v63
v_mfma_f32_16x16x32_bf16 v[80:83], a[96:99], a[136:139], v[80:83]
ds_read_b128 a[12:15], v3 offset:2048
v_cvt_pk_bf16_f32 v64, v64, v65
v_mfma_f32_16x16x32_bf16 v[80:83], a[100:103], a[140:143], v[80:83]
buffer_load_dwordx4 v18, s[12:15], s27 offen offset:2048 lds
v_mfma_f32_16x16x32_bf16 v[84:87], a[104:107], a[136:139], v[84:87]
v_cvt_pk_bf16_f32 v65, v66, v67
v_cvt_pk_bf16_f32 v66, v68, v69
v_mfma_f32_16x16x32_bf16 v[84:87], a[108:111], a[140:143], v[84:87]
v_cvt_pk_bf16_f32 v67, v70, v71
v_mfma_f32_16x16x32_bf16 v[88:91], a[112:115], a[136:139], v[88:91]
ds_read_b128 a[16:19], v2 offset:4096
v_cvt_pk_bf16_f32 v72, v72, v73
v_mfma_f32_16x16x32_bf16 v[88:91], a[116:119], a[140:143], v[88:91]
buffer_load_dwordx4 v19, s[12:15], s27 offen offset:3072 lds
v_mfma_f32_16x16x32_bf16 v[92:95], a[120:123], a[136:139], v[92:95]
s_add_u32 s27, s27, 524288
ds_read_b128 a[20:23], v3 offset:4096
v_cvt_pk_bf16_f32 v73, v74, v75
v_mfma_f32_16x16x32_bf16 v[92:95], a[124:127], a[140:143], v[92:95]
s_waitcnt lgkmcnt(3)
v_cvt_pk_bf16_f32 v74, v76, v77
v_cvt_pk_bf16_f32 v75, v78, v79
v_mfma_f32_16x16x32_bf16 v[96:99], a[64:67], a[128:131], v[96:99]
s_add_u32 m0, s28, 49152
ds_read_b64_tr_b16 a[136:137], v7 offset:32768
v_cvt_pk_bf16_f32 v80, v80, v81
v_mfma_f32_16x16x32_bf16 v[96:99], a[68:71], a[132:135], v[96:99]
buffer_load_dwordx4 v12, s[8:11], s24 offen offset:0 lds
v_mfma_f32_16x16x32_bf16 v[100:103], a[72:75], a[128:131], v[100:103]
ds_read_b64_tr_b16 a[138:139], v7 offset:34816
v_cvt_pk_bf16_f32 v81, v82, v83
v_mfma_f32_16x16x32_bf16 v[100:103], a[76:79], a[132:135], v[100:103]
v_cvt_pk_bf16_f32 v82, v84, v85
v_cvt_pk_bf16_f32 v83, v86, v87
v_mfma_f32_16x16x32_bf16 v[104:107], a[80:83], a[128:131], v[104:107]
ds_read_b64_tr_b16 a[140:141], v7 offset:49152
v_cvt_pk_bf16_f32 v88, v88, v89
v_mfma_f32_16x16x32_bf16 v[104:107], a[84:87], a[132:135], v[104:107]
buffer_load_dwordx4 v13, s[8:11], s24 offen offset:1024 lds
v_mfma_f32_16x16x32_bf16 v[108:111], a[88:91], a[128:131], v[108:111]
ds_read_b64_tr_b16 a[142:143], v7 offset:51200
v_cvt_pk_bf16_f32 v89, v90, v91
v_mfma_f32_16x16x32_bf16 v[108:111], a[92:95], a[132:135], v[108:111]
v_cvt_pk_bf16_f32 v90, v92, v93
v_cvt_pk_bf16_f32 v91, v94, v95
v_mfma_f32_16x16x32_bf16 v[112:115], a[96:99], a[128:131], v[112:115]
v_cvt_pk_bf16_f32 v96, v96, v97
v_cvt_pk_bf16_f32 v97, v98, v99
v_mfma_f32_16x16x32_bf16 v[112:115], a[100:103], a[132:135], v[112:115]
buffer_load_dwordx4 v14, s[8:11], s24 offen offset:2048 lds
v_mfma_f32_16x16x32_bf16 v[116:119], a[104:107], a[128:131], v[116:119]
ds_read_b128 a[24:27], v2 offset:6144
v_cvt_pk_bf16_f32 v98, v100, v101
v_mfma_f32_16x16x32_bf16 v[116:119], a[108:111], a[132:135], v[116:119]
buffer_store_dwordx4 v[32:35], v1, s[4:7], s31 offen sc1
v_mfma_f32_16x16x32_bf16 v[120:123], a[112:115], a[128:131], v[120:123]
s_add_u32 s31, s31, s32
ds_read_b128 a[28:31], v3 offset:6144
v_cvt_pk_bf16_f32 v99, v102, v103
v_mfma_f32_16x16x32_bf16 v[120:123], a[116:119], a[132:135], v[120:123]
buffer_load_dwordx4 v15, s[8:11], s24 offen offset:3072 lds
v_mfma_f32_16x16x32_bf16 v[124:127], a[120:123], a[128:131], v[124:127]
s_add_u32 s24, s24, 128
v_cvt_pk_bf16_f32 v104, v104, v105
v_cvt_pk_bf16_f32 v105, v106, v107
v_mfma_f32_16x16x32_bf16 v[124:127], a[124:127], a[132:135], v[124:127]
s_waitcnt lgkmcnt(4)
v_cvt_pk_bf16_f32 v106, v108, v109
v_cvt_pk_bf16_f32 v107, v110, v111
v_mfma_f32_16x16x32_bf16 v[128:131], a[64:67], a[136:139], v[128:131]
s_waitcnt lgkmcnt(2)
ds_read_b64_tr_b16 a[128:129], v8 offset:32768
v_cvt_pk_bf16_f32 v112, v112, v113
v_mfma_f32_16x16x32_bf16 v[128:131], a[68:71], a[140:143], v[128:131]
v_cvt_pk_bf16_f32 v113, v114, v115
v_cvt_pk_bf16_f32 v114, v116, v117
v_mfma_f32_16x16x32_bf16 v[132:135], a[72:75], a[136:139], v[132:135]
ds_read_b64_tr_b16 a[130:131], v8 offset:34816
v_cvt_pk_bf16_f32 v115, v118, v119
v_mfma_f32_16x16x32_bf16 v[132:135], a[76:79], a[140:143], v[132:135]
buffer_store_dwordx4 v[40:43], v1, s[4:7], s31 offen sc1
v_mfma_f32_16x16x32_bf16 v[136:139], a[80:83], a[136:139], v[136:139]
s_add_u32 s31, s31, s33
ds_read_b64_tr_b16 a[132:133], v8 offset:49152
v_cvt_pk_bf16_f32 v120, v120, v121
v_mfma_f32_16x16x32_bf16 v[136:139], a[84:87], a[140:143], v[136:139]
v_cvt_pk_bf16_f32 v121, v122, v123
v_cvt_pk_bf16_f32 v122, v124, v125
v_mfma_f32_16x16x32_bf16 v[140:143], a[88:91], a[136:139], v[140:143]
ds_read_b64_tr_b16 a[134:135], v8 offset:51200
v_cvt_pk_bf16_f32 v123, v126, v127
v_mfma_f32_16x16x32_bf16 v[140:143], a[92:95], a[140:143], v[140:143]
v_mfma_f32_16x16x32_bf16 v[144:147], a[96:99], a[136:139], v[144:147]
ds_read_b128 a[32:35], v2 offset:8192
v_cvt_pk_bf16_f32 v128, v128, v129
v_mfma_f32_16x16x32_bf16 v[144:147], a[100:103], a[140:143], v[144:147]
v_cvt_pk_bf16_f32 v129, v130, v131
v_cvt_pk_bf16_f32 v130, v132, v133
v_mfma_f32_16x16x32_bf16 v[148:151], a[104:107], a[136:139], v[148:151]
v_cvt_pk_bf16_f32 v131, v134, v135
v_mfma_f32_16x16x32_bf16 v[148:151], a[108:111], a[140:143], v[148:151]
v_mfma_f32_16x16x32_bf16 v[152:155], a[112:115], a[136:139], v[152:155]
ds_read_b128 a[36:39], v3 offset:8192
v_cvt_pk_bf16_f32 v136, v136, v137
v_mfma_f32_16x16x32_bf16 v[152:155], a[116:119], a[140:143], v[152:155]
v_cvt_pk_bf16_f32 v137, v138, v139
v_cvt_pk_bf16_f32 v138, v140, v141
v_mfma_f32_16x16x32_bf16 v[156:159], a[120:123], a[136:139], v[156:159]
ds_read_b128 a[40:43], v2 offset:10240
v_cvt_pk_bf16_f32 v139, v142, v143
v_mfma_f32_16x16x32_bf16 v[156:159], a[124:127], a[140:143], v[156:159]
s_waitcnt lgkmcnt(3)
buffer_store_dwordx4 v[48:51], v1, s[4:7], s31 offen sc1
v_mfma_f32_16x16x32_bf16 v[160:163], a[64:67], a[128:131], v[160:163]
s_add_u32 s31, s31, s32
ds_read_b64_tr_b16 a[136:137], v9 offset:32768
v_cvt_pk_bf16_f32 v144, v144, v145
v_mfma_f32_16x16x32_bf16 v[160:163], a[68:71], a[132:135], v[160:163]
v_cvt_pk_bf16_f32 v145, v146, v147
v_cvt_pk_bf16_f32 v146, v148, v149
v_mfma_f32_16x16x32_bf16 v[164:167], a[72:75], a[128:131], v[164:167]
ds_read_b64_tr_b16 a[138:139], v9 offset:34816
v_cvt_pk_bf16_f32 v147, v150, v151
v_mfma_f32_16x16x32_bf16 v[164:167], a[76:79], a[132:135], v[164:167]
v_mfma_f32_16x16x32_bf16 v[168:171], a[80:83], a[128:131], v[168:171]
ds_read_b64_tr_b16 a[140:141], v9 offset:49152
v_cvt_pk_bf16_f32 v152, v152, v153
v_mfma_f32_16x16x32_bf16 v[168:171], a[84:87], a[132:135], v[168:171]
v_cvt_pk_bf16_f32 v153, v154, v155
v_cvt_pk_bf16_f32 v154, v156, v157
v_mfma_f32_16x16x32_bf16 v[172:175], a[88:91], a[128:131], v[172:175]
ds_read_b64_tr_b16 a[142:143], v9 offset:51200
v_cvt_pk_bf16_f32 v155, v158, v159
v_mfma_f32_16x16x32_bf16 v[172:175], a[92:95], a[132:135], v[172:175]
v_mfma_f32_16x16x32_bf16 v[176:179], a[96:99], a[128:131], v[176:179]
buffer_store_dwordx4 v[56:59], v1, s[4:7], s31 offen sc1
v_mfma_f32_16x16x32_bf16 v[176:179], a[100:103], a[132:135], v[176:179]
s_add_u32 s31, s31, s34
v_cvt_pk_bf16_f32 v160, v160, v161
v_cvt_pk_bf16_f32 v161, v162, v163
v_mfma_f32_16x16x32_bf16 v[180:183], a[104:107], a[128:131], v[180:183]
ds_read_b128 a[44:47], v3 offset:10240
v_cvt_pk_bf16_f32 v162, v164, v165
v_mfma_f32_16x16x32_bf16 v[180:183], a[108:111], a[132:135], v[180:183]
v_cvt_pk_bf16_f32 v163, v166, v167
v_mfma_f32_16x16x32_bf16 v[184:187], a[112:115], a[128:131], v[184:187]
ds_read_b128 a[48:51], v2 offset:12288
v_cvt_pk_bf16_f32 v168, v168, v169
v_mfma_f32_16x16x32_bf16 v[184:187], a[116:119], a[132:135], v[184:187]
v_cvt_pk_bf16_f32 v169, v170, v171
v_cvt_pk_bf16_f32 v170, v172, v173
v_mfma_f32_16x16x32_bf16 v[188:191], a[120:123], a[128:131], v[188:191]
v_cvt_pk_bf16_f32 v171, v174, v175
v_mfma_f32_16x16x32_bf16 v[188:191], a[124:127], a[132:135], v[188:191]
s_waitcnt lgkmcnt(4)
v_mfma_f32_16x16x32_bf16 v[192:195], a[64:67], a[136:139], v[192:195]
s_waitcnt lgkmcnt(2)
ds_read_b64_tr_b16 a[128:129], v10 offset:32768
v_cvt_pk_bf16_f32 v176, v176, v177
v_mfma_f32_16x16x32_bf16 v[192:195], a[68:71], a[140:143], v[192:195]
v_cvt_pk_bf16_f32 v177, v178, v179
v_cvt_pk_bf16_f32 v178, v180, v181
v_mfma_f32_16x16x32_bf16 v[196:199], a[72:75], a[136:139], v[196:199]
ds_read_b64_tr_b16 a[130:131], v10 offset:34816
v_cvt_pk_bf16_f32 v179, v182, v183
v_mfma_f32_16x16x32_bf16 v[196:199], a[76:79], a[140:143], v[196:199]
buffer_store_dwordx4 v[64:67], v1, s[4:7], s31 offen sc1
v_mfma_f32_16x16x32_bf16 v[200:203], a[80:83], a[136:139], v[200:203]
s_add_u32 s31, s31, s32
ds_read_b64_tr_b16 a[132:133], v10 offset:49152
v_cvt_pk_bf16_f32 v184, v184, v185
v_mfma_f32_16x16x32_bf16 v[200:203], a[84:87], a[140:143], v[200:203]
v_cvt_pk_bf16_f32 v185, v186, v187
v_cvt_pk_bf16_f32 v186, v188, v189
v_mfma_f32_16x16x32_bf16 v[204:207], a[88:91], a[136:139], v[204:207]
ds_read_b64_tr_b16 a[134:135], v10 offset:51200
v_cvt_pk_bf16_f32 v187, v190, v191
v_mfma_f32_16x16x32_bf16 v[204:207], a[92:95], a[140:143], v[204:207]
v_mfma_f32_16x16x32_bf16 v[208:211], a[96:99], a[136:139], v[208:211]
ds_read_b128 a[52:55], v3 offset:12288
v_cvt_pk_bf16_f32 v192, v192, v193
v_mfma_f32_16x16x32_bf16 v[208:211], a[100:103], a[140:143], v[208:211]
v_cvt_pk_bf16_f32 v193, v194, v195
v_cvt_pk_bf16_f32 v194, v196, v197
v_mfma_f32_16x16x32_bf16 v[212:215], a[104:107], a[136:139], v[212:215]
ds_read_b128 a[56:59], v2 offset:14336
v_cvt_pk_bf16_f32 v195, v198, v199
v_mfma_f32_16x16x32_bf16 v[212:215], a[108:111], a[140:143], v[212:215]
v_mfma_f32_16x16x32_bf16 v[216:219], a[112:115], a[136:139], v[216:219]
v_cvt_pk_bf16_f32 v200, v200, v201
v_cvt_pk_bf16_f32 v201, v202, v203
v_mfma_f32_16x16x32_bf16 v[216:219], a[116:119], a[140:143], v[216:219]
buffer_store_dwordx4 v[72:75], v1, s[4:7], s31 offen sc1
v_mfma_f32_16x16x32_bf16 v[220:223], a[120:123], a[136:139], v[220:223]
s_add_u32 s31, s31, s33
ds_read_b128 a[60:63], v3 offset:14336
v_cvt_pk_bf16_f32 v202, v204, v205
v_mfma_f32_16x16x32_bf16 v[220:223], a[124:127], a[140:143], v[220:223]
s_waitcnt lgkmcnt(5)
v_cvt_pk_bf16_f32 v203, v206, v207
v_mfma_f32_16x16x32_bf16 a[192:195], a[64:67], a[128:131], a[192:195]
s_waitcnt lgkmcnt(3)
ds_read_b64_tr_b16 a[136:137], v11 offset:32768
v_cvt_pk_bf16_f32 v208, v208, v209
v_mfma_f32_16x16x32_bf16 a[192:195], a[68:71], a[132:135], a[192:195]
v_cvt_pk_bf16_f32 v209, v210, v211
v_cvt_pk_bf16_f32 v210, v212, v213
v_mfma_f32_16x16x32_bf16 a[196:199], a[72:75], a[128:131], a[196:199]
ds_read_b64_tr_b16 a[138:139], v11 offset:34816
v_cvt_pk_bf16_f32 v211, v214, v215
v_mfma_f32_16x16x32_bf16 a[196:199], a[76:79], a[132:135], a[196:199]
v_mfma_f32_16x16x32_bf16 a[200:203], a[80:83], a[128:131], a[200:203]
ds_read_b64_tr_b16 a[140:141], v11 offset:49152
v_cvt_pk_bf16_f32 v216, v216, v217
v_mfma_f32_16x16x32_bf16 a[200:203], a[84:87], a[132:135], a[200:203]
v_cvt_pk_bf16_f32 v217, v218, v219
v_cvt_pk_bf16_f32 v218, v220, v221
v_mfma_f32_16x16x32_bf16 a[204:207], a[88:91], a[128:131], a[204:207]
ds_read_b64_tr_b16 a[142:143], v11 offset:51200
v_cvt_pk_bf16_f32 v219, v222, v223
v_mfma_f32_16x16x32_bf16 a[204:207], a[92:95], a[132:135], a[204:207]
v_mfma_f32_16x16x32_bf16 a[208:211], a[96:99], a[128:131], a[208:211]
buffer_store_dwordx4 v[80:83], v1, s[4:7], s31 offen sc1
v_mfma_f32_16x16x32_bf16 a[208:211], a[100:103], a[132:135], a[208:211]
s_add_u32 s31, s31, s32
v_mfma_f32_16x16x32_bf16 a[212:215], a[104:107], a[128:131], a[212:215]
v_mfma_f32_16x16x32_bf16 a[212:215], a[108:111], a[132:135], a[212:215]
v_mfma_f32_16x16x32_bf16 a[216:219], a[112:115], a[128:131], a[216:219]
v_mfma_f32_16x16x32_bf16 a[216:219], a[116:119], a[132:135], a[216:219]
v_mfma_f32_16x16x32_bf16 a[220:223], a[120:123], a[128:131], a[220:223]
v_mfma_f32_16x16x32_bf16 a[220:223], a[124:127], a[132:135], a[220:223]
s_waitcnt vmcnt(23) lgkmcnt(0)
s_barrier
v_mfma_f32_16x16x32_bf16 a[224:227], a[64:67], a[136:139], a[224:227]
s_add_u32 m0, s29, 98304
ds_read_b64_tr_b16 a[128:129], v22 offset:0
v_mfma_f32_16x16x32_bf16 a[224:227], a[68:71], a[140:143], a[224:227]
buffer_load_dwordx4 v16, s[12:15], s26 offen offset:0 lds
v_mfma_f32_16x16x32_bf16 a[228:231], a[72:75], a[136:139], a[228:231]
ds_read_b64_tr_b16 a[130:131], v22 offset:2048
v_mfma_f32_16x16x32_bf16 a[228:231], a[76:79], a[140:143], a[228:231]
buffer_store_dwordx4 v[88:91], v1, s[4:7], s31 offen sc1
v_mfma_f32_16x16x32_bf16 a[232:235], a[80:83], a[136:139], a[232:235]
s_add_u32 s31, s31, s35
ds_read_b64_tr_b16 a[132:133], v22 offset:16384
v_mfma_f32_16x16x32_bf16 a[232:235], a[84:87], a[140:143], a[232:235]
buffer_load_dwordx4 v17, s[12:15], s26 offen offset:1024 lds
v_mfma_f32_16x16x32_bf16 a[236:239], a[88:91], a[136:139], a[236:239]
ds_read_b64_tr_b16 a[134:135], v22 offset:18432
v_add_u32 v22, 4294901760, v22
v_mfma_f32_16x16x32_bf16 a[236:239], a[92:95], a[140:143], a[236:239]
v_mfma_f32_16x16x32_bf16 a[240:243], a[96:99], a[136:139], a[240:243]
v_mfma_f32_16x16x32_bf16 a[240:243], a[100:103], a[140:143], a[240:243]
buffer_load_dwordx4 v18, s[12:15], s26 offen offset:2048 lds
v_mfma_f32_16x16x32_bf16 a[244:247], a[104:107], a[136:139], a[244:247]
v_mfma_f32_16x16x32_bf16 a[244:247], a[108:111], a[140:143], a[244:247]
v_mfma_f32_16x16x32_bf16 a[248:251], a[112:115], a[136:139], a[248:251]
v_mfma_f32_16x16x32_bf16 a[248:251], a[116:119], a[140:143], a[248:251]
buffer_load_dwordx4 v19, s[12:15], s26 offen offset:3072 lds
v_mfma_f32_16x16x32_bf16 a[252:255], a[120:123], a[136:139], a[252:255]
s_add_u32 s26, s26, 524288
v_mfma_f32_16x16x32_bf16 a[252:255], a[124:127], a[140:143], a[252:255]
s_waitcnt lgkmcnt(2)
s_cmp_lt_u32 s21, 7
s_cbranch_scc1 M_conv
M_Q:
v_mfma_f32_16x16x32_bf16 v[36:39], a[128:131], a[0:3], 0
s_waitcnt lgkmcnt(0)
s_add_u32 m0, s29, 114688
ds_read_b64_tr_b16 a[136:137], v23 offset:0
v_mfma_f32_16x16x32_bf16 v[36:39], a[132:135], a[4:7], v[36:39]
buffer_load_dwordx4 v16, s[12:15], s27 offen offset:0 lds
v_mfma_f32_16x16x32_bf16 v[44:47], a[128:131], a[8:11], 0
ds_read_b64_tr_b16 a[138:139], v23 offset:2048
v_mfma_f32_16x16x32_bf16 v[44:47], a[132:135], a[12:15], v[44:47]
ds_read_b128 a[64:67], v2 offset:16384
ds_read_b128 a[68:71], v3 offset:16384
v_mfma_f32_16x16x32_bf16 v[52:55], a[128:131], a[16:19], 0
ds_read_b64_tr_b16 a[140:141], v23 offset:16384
v_mfma_f32_16x16x32_bf16 v[52:55], a[132:135], a[20:23], v[52:55]
buffer_load_dwordx4 v17, s[12:15], s27 offen offset:1024 lds
v_mfma_f32_16x16x32_bf16 v[60:63], a[128:131], a[24:27], 0
ds_read_b64_tr_b16 a[142:143], v23 offset:18432
v_add_u32 v23, 4294901760, v23
v_mfma_f32_16x16x32_bf16 v[60:63], a[132:135], a[28:31], v[60:63]
buffer_store_dwordx4 v[96:99], v1, s[4:7], s31 offen sc1
v_mfma_f32_16x16x32_bf16 v[68:71], a[128:131], a[32:35], 0
s_add_u32 s31, s31, s32
ds_read_b128 a[72:75], v2 offset:18432
v_mfma_f32_16x16x32_bf16 v[68:71], a[132:135], a[36:39], v[68:71]
buffer_load_dwordx4 v18, s[12:15], s27 offen offset:2048 lds
v_mfma_f32_16x16x32_bf16 v[76:79], a[128:131], a[40:43], 0
ds_read_b128 a[76:79], v3 offset:18432
v_mfma_f32_16x16x32_bf16 v[76:79], a[132:135], a[44:47], v[76:79]
ds_read_b128 a[80:83], v2 offset:20480
v_mfma_f32_16x16x32_bf16 v[84:87], a[128:131], a[48:51], 0
ds_read_b128 a[84:87], v3 offset:20480
v_mfma_f32_16x16x32_bf16 v[84:87], a[132:135], a[52:55], v[84:87]
buffer_load_dwordx4 v19, s[12:15], s27 offen offset:3072 lds
v_mfma_f32_16x16x32_bf16 v[92:95], a[128:131], a[56:59], 0
s_add_u32 s27, s27, 524288
ds_read_b128 a[88:91], v2 offset:22528
v_mfma_f32_16x16x32_bf16 v[92:95], a[132:135], a[60:63], v[92:95]
s_waitcnt lgkmcnt(9)
buffer_store_dwordx4 v[104:107], v1, s[4:7], s31 offen sc1
v_mfma_f32_16x16x32_bf16 v[100:103], a[136:139], a[0:3], 0
s_waitcnt lgkmcnt(5)
s_add_u32 m0, s28, 0
ds_read_b64_tr_b16 a[128:129], v24 offset:0
v_mfma_f32_16x16x32_bf16 v[100:103], a[140:143], a[4:7], v[100:103]
s_add_u32 s31, s31, s33
buffer_load_dwordx4 v12, s[8:11], s24 offen offset:0 lds
v_mfma_f32_16x16x32_bf16 v[108:111], a[136:139], a[8:11], 0
ds_read_b64_tr_b16 a[130:131], v24 offset:2048
v_mfma_f32_16x16x32_bf16 v[108:111], a[140:143], a[12:15], v[108:111]
ds_read_b128 a[92:95], v3 offset:22528
v_mfma_f32_16x16x32_bf16 v[116:119], a[136:139], a[16:19], 0
ds_read_b64_tr_b16 a[132:133], v24 offset:16384
v_mfma_f32_16x16x32_bf16 v[116:119], a[140:143], a[20:23], v[116:119]
buffer_load_dwordx4 v13, s[8:11], s24 offen offset:1024 lds
v_mfma_f32_16x16x32_bf16 v[124:127], a[136:139], a[24:27], 0
ds_read_b64_tr_b16 a[134:135], v24 offset:18432
v_add_u32 v24, 4294901760, v24
v_mfma_f32_16x16x32_bf16 v[124:127], a[140:143], a[28:31], v[124:127]
v_mfma_f32_16x16x32_bf16 v[132:135], a[136:139], a[32:35], 0
ds_read_b128 a[96:99], v2 offset:24576
v_mfma_f32_16x16x32_bf16 v[132:135], a[140:143], a[36:39], v[132:135]
buffer_load_dwordx4 v14, s[8:11], s24 offen offset:2048 lds
v_mfma_f32_16x16x32_bf16 v[140:143], a[136:139], a[40:43], 0
ds_read_b128 a[100:103], v3 offset:24576
v_mfma_f32_16x16x32_bf16 v[140:143], a[140:143], a[44:47], v[140:143]
ds_read_b128 a[104:107], v2 offset:26624
v_mfma_f32_16x16x32_bf16 v[148:151], a[136:139], a[48:51], 0
ds_read_b128 a[108:111], v3 offset:26624
v_mfma_f32_16x16x32_bf16 v[148:151], a[140:143], a[52:55], v[148:151]
buffer_load_dwordx4 v15, s[8:11], s24 offen offset:3072 lds
v_mfma_f32_16x16x32_bf16 v[156:159], a[136:139], a[56:59], 0
s_add_u32 s24, s24, 128
ds_read_b128 a[112:115], v2 offset:28672
v_mfma_f32_16x16x32_bf16 v[156:159], a[140:143], a[60:63], v[156:159]
s_waitcnt lgkmcnt(8)
buffer_store_dwordx4 v[112:115], v1, s[4:7], s31 offen sc1
v_mfma_f32_16x16x32_bf16 v[164:167], a[128:131], a[0:3], 0
s_waitcnt lgkmcnt(5)
s_add_u32 s31, s31, s32
ds_read_b64_tr_b16 a[136:137], v25 offset:0
v_mfma_f32_16x16x32_bf16 v[164:167], a[132:135], a[4:7], v[164:167]
v_mfma_f32_16x16x32_bf16 v[172:175], a[128:131], a[8:11], 0
ds_read_b64_tr_b16 a[138:139], v25 offset:2048
v_mfma_f32_16x16x32_bf16 v[172:175], a[132:135], a[12:15], v[172:175]
ds_read_b128 a[116:119], v3 offset:28672
v_mfma_f32_16x16x32_bf16 v[180:183], a[128:131], a[16:19], 0
ds_read_b64_tr_b16 a[140:141], v25 offset:16384
v_mfma_f32_16x16x32_bf16 v[180:183], a[132:135], a[20:23], v[180:183]
v_mfma_f32_16x16x32_bf16 v[188:191], a[128:131], a[24:27], 0
ds_read_b64_tr_b16 a[142:143], v25 offset:18432
v_add_u32 v25, 4294901760, v25
v_mfma_f32_16x16x32_bf16 v[188:191], a[132:135], a[28:31], v[188:191]
v_mfma_f32_16x16x32_bf16 v[196:199], a[128:131], a[32:35], 0
ds_read_b128 a[120:123], v2 offset:30720
v_mfma_f32_16x16x32_bf16 v[196:199], a[132:135], a[36:39], v[196:199]
v_mfma_f32_16x16x32_bf16 v[204:207], a[128:131], a[40:43], 0
ds_read_b128 a[124:127], v3 offset:30720
v_mfma_f32_16x16x32_bf16 v[204:207], a[132:135], a[44:47], v[204:207]
v_mfma_f32_16x16x32_bf16 v[212:215], a[128:131], a[48:51], 0
v_mfma_f32_16x16x32_bf16 v[212:215], a[132:135], a[52:55], v[212:215]
buffer_store_dwordx4 v[120:123], v1, s[4:7], s31 offen sc1
v_mfma_f32_16x16x32_bf16 v[220:223], a[128:131], a[56:59], 0
s_add_u32 s31, s31, s34
v_mfma_f32_16x16x32_bf16 v[220:223], a[132:135], a[60:63], v[220:223]
s_waitcnt vmcnt(28) lgkmcnt(0)
s_barrier
v_mfma_f32_16x16x32_bf16 v[224:227], a[136:139], a[0:3], 0
s_add_u32 m0, s29, 131072
ds_read_b64_tr_b16 a[128:129], v22 offset:0
v_mfma_f32_16x16x32_bf16 v[224:227], a[140:143], a[4:7], v[224:227]
buffer_load_dwordx4 v16, s[12:15], s26 offen offset:0 lds
v_mfma_f32_16x16x32_bf16 v[228:231], a[136:139], a[8:11], 0
ds_read_b64_tr_b16 a[130:131], v22 offset:2048
v_mfma_f32_16x16x32_bf16 v[228:231], a[140:143], a[12:15], v[228:231]
v_mfma_f32_16x16x32_bf16 v[232:235], a[136:139], a[16:19], 0
ds_read_b64_tr_b16 a[132:133], v22 offset:16384
v_mfma_f32_16x16x32_bf16 v[232:235], a[140:143], a[20:23], v[232:235]
buffer_load_dwordx4 v17, s[12:15], s26 offen offset:1024 lds
v_mfma_f32_16x16x32_bf16 v[236:239], a[136:139], a[24:27], 0
ds_read_b64_tr_b16 a[134:135], v22 offset:18432
v_add_u32 v22, 32768, v22
v_mfma_f32_16x16x32_bf16 v[236:239], a[140:143], a[28:31], v[236:239]
v_mfma_f32_16x16x32_bf16 v[240:243], a[136:139], a[32:35], 0
v_mfma_f32_16x16x32_bf16 v[240:243], a[140:143], a[36:39], v[240:243]
buffer_load_dwordx4 v18, s[12:15], s26 offen offset:2048 lds
v_mfma_f32_16x16x32_bf16 v[244:247], a[136:139], a[40:43], 0
v_mfma_f32_16x16x32_bf16 v[244:247], a[140:143], a[44:47], v[244:247]
v_mfma_f32_16x16x32_bf16 v[248:251], a[136:139], a[48:51], 0
v_mfma_f32_16x16x32_bf16 v[248:251], a[140:143], a[52:55], v[248:251]
buffer_load_dwordx4 v19, s[12:15], s26 offen offset:3072 lds
v_mfma_f32_16x16x32_bf16 v[252:255], a[136:139], a[56:59], 0
s_add_u32 s26, s26, 524288
v_mfma_f32_16x16x32_bf16 v[252:255], a[140:143], a[60:63], v[252:255]
s_waitcnt lgkmcnt(0)
v_mfma_f32_16x16x32_bf16 v[36:39], a[128:131], a[64:67], v[36:39]
s_add_u32 m0, s29, 147456
ds_read_b64_tr_b16 a[136:137], v23 offset:0
v_accvgpr_read_b32 v32, a192
v_mfma_f32_16x16x32_bf16 v[36:39], a[132:135], a[68:71], v[36:39]
buffer_load_dwordx4 v16, s[12:15], s27 offen offset:0 lds
v_mfma_f32_16x16x32_bf16 v[44:47], a[128:131], a[72:75], v[44:47]
ds_read_b64_tr_b16 a[138:139], v23 offset:2048
v_accvgpr_read_b32 v33, a193
v_mfma_f32_16x16x32_bf16 v[44:47], a[132:135], a[76:79], v[44:47]
ds_read_b128 a[0:3], v2 offset:32768
ds_read_b128 a[4:7], v3 offset:32768
v_mfma_f32_16x16x32_bf16 v[52:55], a[128:131], a[80:83], v[52:55]
ds_read_b64_tr_b16 a[140:141], v23 offset:16384
v_accvgpr_read_b32 v34, a194
v_mfma_f32_16x16x32_bf16 v[52:55], a[132:135], a[84:87], v[52:55]
buffer_load_dwordx4 v17, s[12:15], s27 offen offset:1024 lds
v_mfma_f32_16x16x32_bf16 v[60:63], a[128:131], a[88:91], v[60:63]
ds_read_b64_tr_b16 a[142:143], v23 offset:18432
v_add_u32 v23, 32768, v23
v_mfma_f32_16x16x32_bf16 v[60:63], a[132:135], a[92:95], v[60:63]
buffer_store_dwordx4 v[128:131], v1, s[4:7], s31 offen sc1
v_mfma_f32_16x16x32_bf16 v[68:71], a[128:131], a[96:99], v[68:71]
s_add_u32 s31, s31, s32
ds_read_b128 a[8:11], v2 offset:34816
v_accvgpr_read_b32 v35, a195
v_mfma_f32_16x16x32_bf16 v[68:71], a[132:135], a[100:103], v[68:71]
buffer_load_dwordx4 v18, s[12:15], s27 offen offset:2048 lds
v_mfma_f32_16x16x32_bf16 v[76:79], a[128:131], a[104:107], v[76:79]
ds_read_b128 a[12:15], v3 offset:34816
v_accvgpr_read_b32 v96, a196
v_mfma_f32_16x16x32_bf16 v[76:79], a[132:135], a[108:111], v[76:79]
ds_read_b128 a[16:19], v2 offset:36864
v_accvgpr_read_b32 v97, a197
v_mfma_f32_16x16x32_bf16 v[84:87], a[128:131], a[112:115], v[84:87]
ds_read_b128 a[20:23], v3 offset:36864
v_accvgpr_read_b32 v98, a198
v_mfma_f32_16x16x32_bf16 v[84:87], a[132:135], a[116:119], v[84:87]
buffer_load_dwordx4 v19, s[12:15], s27 offen offset:3072 lds
v_mfma_f32_16x16x32_bf16 v[92:95], a[128:131], a[120:123], v[92:95]
s_add_u32 s27, s27, 524288
ds_read_b128 a[24:27], v2 offset:38912
v_accvgpr_read_b32 v99, a199
v_mfma_f32_16x16x32_bf16 v[92:95], a[132:135], a[124:127], v[92:95]
s_waitcnt lgkmcnt(5)
buffer_store_dwordx4 v[136:139], v1, s[4:7], s31 offen sc1
v_mfma_f32_16x16x32_bf16 v[100:103], a[136:139], a[64:67], v[100:103]
s_add_u32 m0, s28, 16384
ds_read_b64_tr_b16 a[128:129], v24 offset:0
v_cvt_pk_bf16_f32 v32, v32, v33
v_mfma_f32_16x16x32_bf16 v[100:103], a[140:143], a[68:71], v[100:103]
s_add_u32 s31, s31, s33
buffer_load_dwordx4 v12, s[8:11], s24 offen offset:0 lds
v_mfma_f32_16x16x32_bf16 v[108:111], a[136:139], a[72:75], v[108:111]
ds_read_b64_tr_b16 a[130:131], v24 offset:2048
v_cvt_pk_bf16_f32 v33, v34, v35
v_mfma_f32_16x16x32_bf16 v[108:111], a[140:143], a[76:79], v[108:111]
ds_read_b128 a[28:31], v3 offset:38912
v_cvt_pk_bf16_f32 v34, v96, v97
v_mfma_f32_16x16x32_bf16 v[116:119], a[136:139], a[80:83], v[116:119]
ds_read_b64_tr_b16 a[132:133], v24 offset:16384
v_cvt_pk_bf16_f32 v35, v98, v99
v_mfma_f32_16x16x32_bf16 v[116:119], a[140:143], a[84:87], v[116:119]
buffer_load_dwordx4 v13, s[8:11], s24 offen offset:1024 lds
v_mfma_f32_16x16x32_bf16 v[124:127], a[136:139], a[88:91], v[124:127]
ds_read_b64_tr_b16 a[134:135], v24 offset:18432
v_add_u32 v24, 32768, v24
v_mfma_f32_16x16x32_bf16 v[124:127], a[140:143], a[92:95], v[124:127]
v_accvgpr_read_b32 v40, a200
v_accvgpr_read_b32 v41, a201
v_mfma_f32_16x16x32_bf16 v[132:135], a[136:139], a[96:99], v[132:135]
ds_read_b128 a[32:35], v2 offset:40960
v_accvgpr_read_b32 v42, a202
v_mfma_f32_16x16x32_bf16 v[132:135], a[140:143], a[100:103], v[132:135]
buffer_load_dwordx4 v14, s[8:11], s24 offen offset:2048 lds
v_mfma_f32_16x16x32_bf16 v[140:143], a[136:139], a[104:107], v[140:143]
ds_read_b128 a[36:39], v3 offset:40960
v_accvgpr_read_b32 v43, a203
v_mfma_f32_16x16x32_bf16 v[140:143], a[140:143], a[108:111], v[140:143]
ds_read_b128 a[40:43], v2 offset:43008
v_accvgpr_read_b32 v96, a204
v_mfma_f32_16x16x32_bf16 v[148:151], a[136:139], a[112:115], v[148:151]
ds_read_b128 a[44:47], v3 offset:43008
v_accvgpr_read_b32 v97, a205
v_mfma_f32_16x16x32_bf16 v[148:151], a[140:143], a[116:119], v[148:151]
buffer_load_dwordx4 v15, s[8:11], s24 offen offset:3072 lds
v_mfma_f32_16x16x32_bf16 v[156:159], a[136:139], a[120:123], v[156:159]
s_add_u32 s24, s24, 128
ds_read_b128 a[48:51], v2 offset:45056
v_accvgpr_read_b32 v98, a206
v_mfma_f32_16x16x32_bf16 v[156:159], a[140:143], a[124:127], v[156:159]
s_waitcnt lgkmcnt(5)
buffer_store_dwordx4 v[144:147], v1, s[4:7], s31 offen sc1
v_mfma_f32_16x16x32_bf16 v[164:167], a[128:131], a[64:67], v[164:167]
s_add_u32 s31, s31, s32
ds_read_b64_tr_b16 a[136:137], v25 offset:0
v_accvgpr_read_b32 v99, a207
v_mfma_f32_16x16x32_bf16 v[164:167], a[132:135], a[68:71], v[164:167]
v_cvt_pk_bf16_f32 v40, v40, v41
v_cvt_pk_bf16_f32 v41, v42, v43
v_mfma_f32_16x16x32_bf16 v[172:175], a[128:131], a[72:75], v[172:175]
ds_read_b64_tr_b16 a[138:139], v25 offset:2048
v_cvt_pk_bf16_f32 v42, v96, v97
v_mfma_f32_16x16x32_bf16 v[172:175], a[132:135], a[76:79], v[172:175]
ds_read_b128 a[52:55], v3 offset:45056
v_cvt_pk_bf16_f32 v43, v98, v99
v_mfma_f32_16x16x32_bf16 v[180:183], a[128:131], a[80:83], v[180:183]
ds_read_b64_tr_b16 a[140:141], v25 offset:16384
v_accvgpr_read_b32 v48, a208
v_mfma_f32_16x16x32_bf16 v[180:183], a[132:135], a[84:87], v[180:183]
v_accvgpr_read_b32 v49, a209
v_accvgpr_read_b32 v50, a210
v_mfma_f32_16x16x32_bf16 v[188:191], a[128:131], a[88:91], v[188:191]
ds_read_b64_tr_b16 a[142:143], v25 offset:18432
v_add_u32 v25, 32768, v25
v_mfma_f32_16x16x32_bf16 v[188:191], a[132:135], a[92:95], v[188:191]
v_accvgpr_read_b32 v51, a211
v_accvgpr_read_b32 v96, a212
v_mfma_f32_16x16x32_bf16 v[196:199], a[128:131], a[96:99], v[196:199]
ds_read_b128 a[56:59], v2 offset:47104
v_accvgpr_read_b32 v97, a213
v_mfma_f32_16x16x32_bf16 v[196:199], a[132:135], a[100:103], v[196:199]
v_accvgpr_read_b32 v98, a214
v_accvgpr_read_b32 v99, a215
v_mfma_f32_16x16x32_bf16 v[204:207], a[128:131], a[104:107], v[204:207]
ds_read_b128 a[60:63], v3 offset:47104
v_cvt_pk_bf16_f32 v48, v48, v49
v_mfma_f32_16x16x32_bf16 v[204:207], a[132:135], a[108:111], v[204:207]
v_cvt_pk_bf16_f32 v49, v50, v51
v_cvt_pk_bf16_f32 v50, v96, v97
v_mfma_f32_16x16x32_bf16 v[212:215], a[128:131], a[112:115], v[212:215]
v_cvt_pk_bf16_f32 v51, v98, v99
v_accvgpr_read_b32 v56, a216
v_mfma_f32_16x16x32_bf16 v[212:215], a[132:135], a[116:119], v[212:215]
buffer_store_dwordx4 v[152:155], v1, s[4:7], s31 offen sc1
v_mfma_f32_16x16x32_bf16 v[220:223], a[128:131], a[120:123], v[220:223]
s_add_u32 s31, s31, s36
v_accvgpr_read_b32 v57, a217
v_accvgpr_read_b32 v58, a218
v_mfma_f32_16x16x32_bf16 v[220:223], a[132:135], a[124:127], v[220:223]
s_waitcnt vmcnt(23) lgkmcnt(0)
s_barrier
v_accvgpr_read_b32 v59, a219
v_mfma_f32_16x16x32_bf16 v[224:227], a[136:139], a[64:67], v[224:227]
s_add_u32 m0, s29, 65536
ds_read_b64_tr_b16 a[128:129], v22 offset:0
v_accvgpr_read_b32 v96, a220
v_mfma_f32_16x16x32_bf16 v[224:227], a[140:143], a[68:71], v[224:227]
buffer_load_dwordx4 v16, s[12:15], s26 offen offset:0 lds
v_mfma_f32_16x16x32_bf16 v[228:231], a[136:139], a[72:75], v[228:231]
ds_read_b64_tr_b16 a[130:131], v22 offset:2048
v_accvgpr_read_b32 v97, a221
v_mfma_f32_16x16x32_bf16 v[228:231], a[140:143], a[76:79], v[228:231]
v_accvgpr_read_b32 v98, a222
v_accvgpr_read_b32 v99, a223
v_mfma_f32_16x16x32_bf16 v[232:235], a[136:139], a[80:83], v[232:235]
ds_read_b64_tr_b16 a[132:133], v22 offset:16384
v_cvt_pk_bf16_f32 v56, v56, v57
v_mfma_f32_16x16x32_bf16 v[232:235], a[140:143], a[84:87], v[232:235]
buffer_load_dwordx4 v17, s[12:15], s26 offen offset:1024 lds
v_mfma_f32_16x16x32_bf16 v[236:239], a[136:139], a[88:91], v[236:239]
ds_read_b64_tr_b16 a[134:135], v22 offset:18432
v_add_u32 v22, 32768, v22
v_mfma_f32_16x16x32_bf16 v[236:239], a[140:143], a[92:95], v[236:239]
v_cvt_pk_bf16_f32 v57, v58, v59
v_cvt_pk_bf16_f32 v58, v96, v97
v_mfma_f32_16x16x32_bf16 v[240:243], a[136:139], a[96:99], v[240:243]
v_cvt_pk_bf16_f32 v59, v98, v99
v_accvgpr_read_b32 v64, a224
v_mfma_f32_16x16x32_bf16 v[240:243], a[140:143], a[100:103], v[240:243]
buffer_load_dwordx4 v18, s[12:15], s26 offen offset:2048 lds
v_mfma_f32_16x16x32_bf16 v[244:247], a[136:139], a[104:107], v[244:247]
v_accvgpr_read_b32 v65, a225
v_accvgpr_read_b32 v66, a226
v_mfma_f32_16x16x32_bf16 v[244:247], a[140:143], a[108:111], v[244:247]
v_accvgpr_read_b32 v67, a227
v_accvgpr_read_b32 v96, a228
v_mfma_f32_16x16x32_bf16 v[248:251], a[136:139], a[112:115], v[248:251]
v_accvgpr_read_b32 v97, a229
v_accvgpr_read_b32 v98, a230
v_mfma_f32_16x16x32_bf16 v[248:251], a[140:143], a[116:119], v[248:251]
buffer_load_dwordx4 v19, s[12:15], s26 offen offset:3072 lds
v_mfma_f32_16x16x32_bf16 v[252:255], a[136:139], a[120:123], v[252:255]
s_add_u32 s26, s26, 524288
v_accvgpr_read_b32 v99, a231
v_cvt_pk_bf16_f32 v64, v64, v65
v_mfma_f32_16x16x32_bf16 v[252:255], a[140:143], a[124:127], v[252:255]
s_waitcnt lgkmcnt(0)
v_cvt_pk_bf16_f32 v65, v66, v67
v_cvt_pk_bf16_f32 v66, v96, v97
v_mfma_f32_16x16x32_bf16 v[36:39], a[128:131], a[0:3], v[36:39]
s_add_u32 m0, s29, 81920
ds_read_b64_tr_b16 a[136:137], v23 offset:0
v_cvt_pk_bf16_f32 v67, v98, v99
v_mfma_f32_16x16x32_bf16 v[36:39], a[132:135], a[4:7], v[36:39]
buffer_load_dwordx4 v16, s[12:15], s27 offen offset:0 lds
v_mfma_f32_16x16x32_bf16 v[44:47], a[128:131], a[8:11], v[44:47]
ds_read_b64_tr_b16 a[138:139], v23 offset:2048
v_accvgpr_read_b32 v72, a232
v_mfma_f32_16x16x32_bf16 v[44:47], a[132:135], a[12:15], v[44:47]
ds_read_b128 a[64:67], v2 offset:49152
ds_read_b128 a[68:71], v3 offset:49152
v_mfma_f32_16x16x32_bf16 v[52:55], a[128:131], a[16:19], v[52:55]
ds_read_b64_tr_b16 a[140:141], v23 offset:16384
v_accvgpr_read_b32 v73, a233
v_mfma_f32_16x16x32_bf16 v[52:55], a[132:135], a[20:23], v[52:55]
buffer_load_dwordx4 v17, s[12:15], s27 offen offset:1024 lds
v_mfma_f32_16x16x32_bf16 v[60:63], a[128:131], a[24:27], v[60:63]
ds_read_b64_tr_b16 a[142:143], v23 offset:18432
v_add_u32 v23, 32768, v23
v_mfma_f32_16x16x32_bf16 v[60:63], a[132:135], a[28:31], v[60:63]
buffer_store_dwordx4 v[160:163], v1, s[4:7], s31 offen sc1
v_mfma_f32_16x16x32_bf16 v[68:71], a[128:131], a[32:35], v[68:71]
s_add_u32 s31, s31, s32
ds_read_b128 a[72:75], v2 offset:51200
v_accvgpr_read_b32 v74, a234
v_mfma_f32_16x16x32_bf16 v[68:71], a[132:135], a[36:39], v[68:71]
buffer_load_dwordx4 v18, s[12:15], s27 offen offset:2048 lds
v_mfma_f32_16x16x32_bf16 v[76:79], a[128:131], a[40:43], v[76:79]
ds_read_b128 a[76:79], v3 offset:51200
v_accvgpr_read_b32 v75, a235
v_mfma_f32_16x16x32_bf16 v[76:79], a[132:135], a[44:47], v[76:79]
ds_read_b128 a[80:83], v2 offset:53248
v_accvgpr_read_b32 v96, a236
v_mfma_f32_16x16x32_bf16 v[84:87], a[128:131], a[48:51], v[84:87]
ds_read_b128 a[84:87], v3 offset:53248
v_accvgpr_read_b32 v97, a237
v_mfma_f32_16x16x32_bf16 v[84:87], a[132:135], a[52:55], v[84:87]
buffer_load_dwordx4 v19, s[12:15], s27 offen offset:3072 lds
v_mfma_f32_16x16x32_bf16 v[92:95], a[128:131], a[56:59], v[92:95]
s_add_u32 s27, s27, 524288
ds_read_b128 a[88:91], v2 offset:55296
v_accvgpr_read_b32 v98, a238
v_mfma_f32_16x16x32_bf16 v[92:95], a[132:135], a[60:63], v[92:95]
s_waitcnt lgkmcnt(5)
buffer_store_dwordx4 v[168:171], v1, s[4:7], s31 offen sc1
v_mfma_f32_16x16x32_bf16 v[100:103], a[136:139], a[0:3], v[100:103]
s_add_u32 m0, s28, 32768
ds_read_b64_tr_b16 a[128:129], v24 offset:0
v_accvgpr_read_b32 v99, a239
v_mfma_f32_16x16x32_bf16 v[100:103], a[140:143], a[4:7], v[100:103]
s_add_u32 s31, s31, s33
buffer_load_dwordx4 v12, s[8:11], s24 offen offset:0 lds
v_mfma_f32_16x16x32_bf16 v[108:111], a[136:139], a[8:11], v[108:111]
ds_read_b64_tr_b16 a[130:131], v24 offset:2048
v_cvt_pk_bf16_f32 v72, v72, v73
v_mfma_f32_16x16x32_bf16 v[108:111], a[140:143], a[12:15], v[108:111]
ds_read_b128 a[92:95], v3 offset:55296
v_cvt_pk_bf16_f32 v73, v74, v75
v_mfma_f32_16x16x32_bf16 v[116:119], a[136:139], a[16:19], v[116:119]
ds_read_b64_tr_b16 a[132:133], v24 offset:16384
v_cvt_pk_bf16_f32 v74, v96, v97
v_mfma_f32_16x16x32_bf16 v[116:119], a[140:143], a[20:23], v[116:119]
buffer_load_dwordx4 v13, s[8:11], s24 offen offset:1024 lds
v_mfma_f32_16x16x32_bf16 v[124:127], a[136:139], a[24:27], v[124:127]
ds_read_b64_tr_b16 a[134:135], v24 offset:18432
v_add_u32 v24, 32768, v24
v_mfma_f32_16x16x32_bf16 v[124:127], a[140:143], a[28:31], v[124:127]
v_cvt_pk_bf16_f32 v75, v98, v99
v_accvgpr_read_b32 v80, a240
v_mfma_f32_16x16x32_bf16 v[132:135], a[136:139], a[32:35], v[132:135]
ds_read_b128 a[96:99], v2 offset:57344
v_accvgpr_read_b32 v81, a241
v_mfma_f32_16x16x32_bf16 v[132:135], a[140:143], a[36:39], v[132:135]
buffer_load_dwordx4 v14, s[8:11], s24 offen offset:2048 lds
v_mfma_f32_16x16x32_bf16 v[140:143], a[136:139], a[40:43], v[140:143]
ds_read_b128 a[100:103], v3 offset:57344
v_accvgpr_read_b32 v82, a242
v_mfma_f32_16x16x32_bf16 v[140:143], a[140:143], a[44:47], v[140:143]
ds_read_b128 a[104:107], v2 offset:59392
v_accvgpr_read_b32 v83, a243
v_mfma_f32_16x16x32_bf16 v[148:151], a[136:139], a[48:51], v[148:151]
ds_read_b128 a[108:111], v3 offset:59392
v_accvgpr_read_b32 v96, a244
v_mfma_f32_16x16x32_bf16 v[148:151], a[140:143], a[52:55], v[148:151]
buffer_load_dwordx4 v15, s[8:11], s24 offen offset:3072 lds
v_mfma_f32_16x16x32_bf16 v[156:159], a[136:139], a[56:59], v[156:159]
s_add_u32 s24, s24, 128
ds_read_b128 a[112:115], v2 offset:61440
v_accvgpr_read_b32 v97, a245
v_mfma_f32_16x16x32_bf16 v[156:159], a[140:143], a[60:63], v[156:159]
s_waitcnt lgkmcnt(5)
buffer_store_dwordx4 v[176:179], v1, s[4:7], s31 offen sc1
v_mfma_f32_16x16x32_bf16 v[164:167], a[128:131], a[0:3], v[164:167]
s_add_u32 s31, s31, s32
ds_read_b64_tr_b16 a[136:137], v25 offset:0
v_accvgpr_read_b32 v98, a246
v_mfma_f32_16x16x32_bf16 v[164:167], a[132:135], a[4:7], v[164:167]
v_accvgpr_read_b32 v99, a247
v_cvt_pk_bf16_f32 v80, v80, v81
v_mfma_f32_16x16x32_bf16 v[172:175], a[128:131], a[8:11], v[172:175]
ds_read_b64_tr_b16 a[138:139], v25 offset:2048
v_cvt_pk_bf16_f32 v81, v82, v83
v_mfma_f32_16x16x32_bf16 v[172:175], a[132:135], a[12:15], v[172:175]
ds_read_b128 a[116:119], v3 offset:61440
v_cvt_pk_bf16_f32 v82, v96, v97
v_mfma_f32_16x16x32_bf16 v[180:183], a[128:131], a[16:19], v[180:183]
ds_read_b64_tr_b16 a[140:141], v25 offset:16384
v_cvt_pk_bf16_f32 v83, v98, v99
v_mfma_f32_16x16x32_bf16 v[180:183], a[132:135], a[20:23], v[180:183]
buffer_store_dwordx4 v[184:187], v1, s[4:7], s31 offen sc1
v_mfma_f32_16x16x32_bf16 v[188:191], a[128:131], a[24:27], v[188:191]
s_add_u32 s31, s31, s34
ds_read_b64_tr_b16 a[142:143], v25 offset:18432
v_add_u32 v25, 32768, v25
v_mfma_f32_16x16x32_bf16 v[188:191], a[132:135], a[28:31], v[188:191]
v_accvgpr_read_b32 v88, a248
v_accvgpr_read_b32 v89, a249
v_mfma_f32_16x16x32_bf16 v[196:199], a[128:131], a[32:35], v[196:199]
ds_read_b128 a[120:123], v2 offset:63488
v_accvgpr_read_b32 v90, a250
v_mfma_f32_16x16x32_bf16 v[196:199], a[132:135], a[36:39], v[196:199]
v_accvgpr_read_b32 v91, a251
v_accvgpr_read_b32 v96, a252
v_mfma_f32_16x16x32_bf16 v[204:207], a[128:131], a[40:43], v[204:207]
ds_read_b128 a[124:127], v3 offset:63488
v_accvgpr_read_b32 v97, a253
v_mfma_f32_16x16x32_bf16 v[204:207], a[132:135], a[44:47], v[204:207]
v_accvgpr_read_b32 v98, a254
v_accvgpr_read_b32 v99, a255
v_mfma_f32_16x16x32_bf16 v[212:215], a[128:131], a[48:51], v[212:215]
v_cvt_pk_bf16_f32 v88, v88, v89
v_cvt_pk_bf16_f32 v89, v90, v91
v_mfma_f32_16x16x32_bf16 v[212:215], a[132:135], a[52:55], v[212:215]
v_cvt_pk_bf16_f32 v90, v96, v97
v_cvt_pk_bf16_f32 v91, v98, v99
v_mfma_f32_16x16x32_bf16 v[220:223], a[128:131], a[56:59], v[220:223]
v_mfma_f32_16x16x32_bf16 v[220:223], a[132:135], a[60:63], v[220:223]
s_waitcnt vmcnt(23) lgkmcnt(0)
s_barrier
v_mfma_f32_16x16x32_bf16 v[224:227], a[136:139], a[0:3], v[224:227]
s_add_u32 m0, s29, 98304
ds_read_b64_tr_b16 a[128:129], v22 offset:0
v_mfma_f32_16x16x32_bf16 v[224:227], a[140:143], a[4:7], v[224:227]
buffer_load_dwordx4 v16, s[12:15], s26 offen offset:0 lds
v_mfma_f32_16x16x32_bf16 v[228:231], a[136:139], a[8:11], v[228:231]
ds_read_b64_tr_b16 a[130:131], v22 offset:2048
v_mfma_f32_16x16x32_bf16 v[228:231], a[140:143], a[12:15], v[228:231]
buffer_store_dwordx4 v[192:195], v1, s[4:7], s31 offen sc1
v_mfma_f32_16x16x32_bf16 v[232:235], a[136:139], a[16:19], v[232:235]
s_add_u32 s31, s31, s32
ds_read_b64_tr_b16 a[132:133], v22 offset:16384
v_mfma_f32_16x16x32_bf16 v[232:235], a[140:143], a[20:23], v[232:235]
buffer_load_dwordx4 v17, s[12:15], s26 offen offset:1024 lds
v_mfma_f32_16x16x32_bf16 v[236:239], a[136:139], a[24:27], v[236:239]
ds_read_b64_tr_b16 a[134:135], v22 offset:18432
v_add_u32 v22, 4294901760, v22
v_mfma_f32_16x16x32_bf16 v[236:239], a[140:143], a[28:31], v[236:239]
v_mfma_f32_16x16x32_bf16 v[240:243], a[136:139], a[32:35], v[240:243]
v_mfma_f32_16x16x32_bf16 v[240:243], a[140:143], a[36:39], v[240:243]
buffer_load_dwordx4 v18, s[12:15], s26 offen offset:2048 lds
v_mfma_f32_16x16x32_bf16 v[244:247], a[136:139], a[40:43], v[244:247]
v_mfma_f32_16x16x32_bf16 v[244:247], a[140:143], a[44:47], v[244:247]
v_mfma_f32_16x16x32_bf16 v[248:251], a[136:139], a[48:51], v[248:251]
v_mfma_f32_16x16x32_bf16 v[248:251], a[140:143], a[52:55], v[248:251]
buffer_load_dwordx4 v19, s[12:15], s26 offen offset:3072 lds
v_mfma_f32_16x16x32_bf16 v[252:255], a[136:139], a[56:59], v[252:255]
s_add_u32 s26, s26, 524288
v_mfma_f32_16x16x32_bf16 v[252:255], a[140:143], a[60:63], v[252:255]
s_waitcnt lgkmcnt(2)
v_mfma_f32_16x16x32_bf16 v[36:39], a[128:131], a[64:67], v[36:39]
s_waitcnt lgkmcnt(0)
s_add_u32 m0, s29, 114688
ds_read_b64_tr_b16 a[136:137], v23 offset:0
v_mfma_f32_16x16x32_bf16 v[36:39], a[132:135], a[68:71], v[36:39]
buffer_load_dwordx4 v16, s[12:15], s27 offen offset:0 lds
v_mfma_f32_16x16x32_bf16 v[44:47], a[128:131], a[72:75], v[44:47]
ds_read_b64_tr_b16 a[138:139], v23 offset:2048
v_mfma_f32_16x16x32_bf16 v[44:47], a[132:135], a[76:79], v[44:47]
ds_read_b128 a[0:3], v2 offset:0
ds_read_b128 a[4:7], v3 offset:0
v_mfma_f32_16x16x32_bf16 v[52:55], a[128:131], a[80:83], v[52:55]
ds_read_b64_tr_b16 a[140:141], v23 offset:16384
v_mfma_f32_16x16x32_bf16 v[52:55], a[132:135], a[84:87], v[52:55]
buffer_load_dwordx4 v17, s[12:15], s27 offen offset:1024 lds
v_mfma_f32_16x16x32_bf16 v[60:63], a[128:131], a[88:91], v[60:63]
ds_read_b64_tr_b16 a[142:143], v23 offset:18432
v_add_u32 v23, 4294901760, v23
v_mfma_f32_16x16x32_bf16 v[60:63], a[132:135], a[92:95], v[60:63]
buffer_store_dwordx4 v[200:203], v1, s[4:7], s31 offen sc1
v_mfma_f32_16x16x32_bf16 v[68:71], a[128:131], a[96:99], v[68:71]
s_add_u32 s31, s31, s33
ds_read_b128 a[8:11], v2 offset:2048
v_mfma_f32_16x16x32_bf16 v[68:71], a[132:135], a[100:103], v[68:71]
buffer_load_dwordx4 v18, s[12:15], s27 offen offset:2048 lds
v_mfma_f32_16x16x32_bf16 v[76:79], a[128:131], a[104:107], v[76:79]
ds_read_b128 a[12:15], v3 offset:2048
v_mfma_f32_16x16x32_bf16 v[76:79], a[132:135], a[108:111], v[76:79]
ds_read_b128 a[16:19], v2 offset:4096
v_mfma_f32_16x16x32_bf16 v[84:87], a[128:131], a[112:115], v[84:87]
ds_read_b128 a[20:23], v3 offset:4096
v_mfma_f32_16x16x32_bf16 v[84:87], a[132:135], a[116:119], v[84:87]
buffer_load_dwordx4 v19, s[12:15], s27 offen offset:3072 lds
v_mfma_f32_16x16x32_bf16 v[92:95], a[128:131], a[120:123], v[92:95]
s_add_u32 s27, s27, 524288
ds_read_b128 a[24:27], v2 offset:6144
v_mfma_f32_16x16x32_bf16 v[92:95], a[132:135], a[124:127], v[92:95]
s_waitcnt lgkmcnt(9)
buffer_store_dwordx4 v[208:211], v1, s[4:7], s31 offen sc1
v_mfma_f32_16x16x32_bf16 v[100:103], a[136:139], a[64:67], v[100:103]
s_waitcnt lgkmcnt(5)
s_add_u32 s31, s31, s32
ds_read_b64_tr_b16 a[128:129], v24 offset:0
v_mfma_f32_16x16x32_bf16 v[100:103], a[140:143], a[68:71], v[100:103]
v_mfma_f32_16x16x32_bf16 v[108:111], a[136:139], a[72:75], v[108:111]
ds_read_b64_tr_b16 a[130:131], v24 offset:2048
v_mfma_f32_16x16x32_bf16 v[108:111], a[140:143], a[76:79], v[108:111]
ds_read_b128 a[28:31], v3 offset:6144
v_mfma_f32_16x16x32_bf16 v[116:119], a[136:139], a[80:83], v[116:119]
ds_read_b64_tr_b16 a[132:133], v24 offset:16384
v_mfma_f32_16x16x32_bf16 v[116:119], a[140:143], a[84:87], v[116:119]
v_mfma_f32_16x16x32_bf16 v[124:127], a[136:139], a[88:91], v[124:127]
ds_read_b64_tr_b16 a[134:135], v24 offset:18432
v_add_u32 v24, 4294901760, v24
v_mfma_f32_16x16x32_bf16 v[124:127], a[140:143], a[92:95], v[124:127]
v_mfma_f32_16x16x32_bf16 v[132:135], a[136:139], a[96:99], v[132:135]
ds_read_b128 a[32:35], v2 offset:8192
v_mfma_f32_16x16x32_bf16 v[132:135], a[140:143], a[100:103], v[132:135]
buffer_store_dwordx4 v[216:219], v1, s[4:7], s31 offen sc1
v_mfma_f32_16x16x32_bf16 v[140:143], a[136:139], a[104:107], v[140:143]
s_add_u32 s31, s31, s35
ds_read_b128 a[36:39], v3 offset:8192
v_mfma_f32_16x16x32_bf16 v[140:143], a[140:143], a[108:111], v[140:143]
ds_read_b128 a[40:43], v2 offset:10240
v_mfma_f32_16x16x32_bf16 v[148:151], a[136:139], a[112:115], v[148:151]
ds_read_b128 a[44:47], v3 offset:10240
v_mfma_f32_16x16x32_bf16 v[148:151], a[140:143], a[116:119], v[148:151]
v_mfma_f32_16x16x32_bf16 v[156:159], a[136:139], a[120:123], v[156:159]
ds_read_b128 a[48:51], v2 offset:12288
v_mfma_f32_16x16x32_bf16 v[156:159], a[140:143], a[124:127], v[156:159]
s_waitcnt lgkmcnt(8)
v_mfma_f32_16x16x32_bf16 v[164:167], a[128:131], a[64:67], v[164:167]
s_waitcnt lgkmcnt(5)
ds_read_b64_tr_b16 a[136:137], v25 offset:0
v_mfma_f32_16x16x32_bf16 v[164:167], a[132:135], a[68:71], v[164:167]
v_mfma_f32_16x16x32_bf16 v[172:175], a[128:131], a[72:75], v[172:175]
ds_read_b64_tr_b16 a[138:139], v25 offset:2048
v_mfma_f32_16x16x32_bf16 v[172:175], a[132:135], a[76:79], v[172:175]
ds_read_b128 a[52:55], v3 offset:12288
v_mfma_f32_16x16x32_bf16 v[180:183], a[128:131], a[80:83], v[180:183]
ds_read_b64_tr_b16 a[140:141], v25 offset:16384
v_mfma_f32_16x16x32_bf16 v[180:183], a[132:135], a[84:87], v[180:183]
buffer_store_dwordx4 v[32:35], v1, s[4:7], s31 offen sc1
v_mfma_f32_16x16x32_bf16 v[188:191], a[128:131], a[88:91], v[188:191]
s_add_u32 s31, s31, s32
ds_read_b64_tr_b16 a[142:143], v25 offset:18432
v_add_u32 v25, 4294901760, v25
v_mfma_f32_16x16x32_bf16 v[188:191], a[132:135], a[92:95], v[188:191]
v_mfma_f32_16x16x32_bf16 v[196:199], a[128:131], a[96:99], v[196:199]
ds_read_b128 a[56:59], v2 offset:14336
v_mfma_f32_16x16x32_bf16 v[196:199], a[132:135], a[100:103], v[196:199]
v_mfma_f32_16x16x32_bf16 v[204:207], a[128:131], a[104:107], v[204:207]
ds_read_b128 a[60:63], v3 offset:14336
v_mfma_f32_16x16x32_bf16 v[204:207], a[132:135], a[108:111], v[204:207]
v_mfma_f32_16x16x32_bf16 v[212:215], a[128:131], a[112:115], v[212:215]
v_mfma_f32_16x16x32_bf16 v[212:215], a[132:135], a[116:119], v[212:215]
v_mfma_f32_16x16x32_bf16 v[220:223], a[128:131], a[120:123], v[220:223]
v_mfma_f32_16x16x32_bf16 v[220:223], a[132:135], a[124:127], v[220:223]
s_waitcnt vmcnt(20) lgkmcnt(0)
s_barrier
v_mfma_f32_16x16x32_bf16 v[224:227], a[136:139], a[64:67], v[224:227]
s_add_u32 m0, s29, 131072
ds_read_b64_tr_b16 a[128:129], v22 offset:0
v_mfma_f32_16x16x32_bf16 v[224:227], a[140:143], a[68:71], v[224:227]
buffer_load_dwordx4 v16, s[12:15], s26 offen offset:0 lds
v_mfma_f32_16x16x32_bf16 v[228:231], a[136:139], a[72:75], v[228:231]
ds_read_b64_tr_b16 a[130:131], v22 offset:2048
v_mfma_f32_16x16x32_bf16 v[228:231], a[140:143], a[76:79], v[228:231]
buffer_store_dwordx4 v[40:43], v1, s[4:7], s31 offen sc1
v_mfma_f32_16x16x32_bf16 v[232:235], a[136:139], a[80:83], v[232:235]
s_add_u32 s31, s31, s33
ds_read_b64_tr_b16 a[132:133], v22 offset:16384
v_mfma_f32_16x16x32_bf16 v[232:235], a[140:143], a[84:87], v[232:235]
buffer_load_dwordx4 v17, s[12:15], s26 offen offset:1024 lds
v_mfma_f32_16x16x32_bf16 v[236:239], a[136:139], a[88:91], v[236:239]
ds_read_b64_tr_b16 a[134:135], v22 offset:18432
v_add_u32 v22, 32768, v22
v_mfma_f32_16x16x32_bf16 v[236:239], a[140:143], a[92:95], v[236:239]
v_mfma_f32_16x16x32_bf16 v[240:243], a[136:139], a[96:99], v[240:243]
v_mfma_f32_16x16x32_bf16 v[240:243], a[140:143], a[100:103], v[240:243]
buffer_load_dwordx4 v18, s[12:15], s26 offen offset:2048 lds
v_mfma_f32_16x16x32_bf16 v[244:247], a[136:139], a[104:107], v[244:247]
v_mfma_f32_16x16x32_bf16 v[244:247], a[140:143], a[108:111], v[244:247]
v_mfma_f32_16x16x32_bf16 v[248:251], a[136:139], a[112:115], v[248:251]
v_mfma_f32_16x16x32_bf16 v[248:251], a[140:143], a[116:119], v[248:251]
buffer_load_dwordx4 v19, s[12:15], s26 offen offset:3072 lds
v_mfma_f32_16x16x32_bf16 v[252:255], a[136:139], a[120:123], v[252:255]
s_add_u32 s26, s26, 524288
v_mfma_f32_16x16x32_bf16 v[252:255], a[140:143], a[124:127], v[252:255]
s_waitcnt lgkmcnt(2)
v_mfma_f32_16x16x32_bf16 v[36:39], a[128:131], a[0:3], v[36:39]
s_waitcnt lgkmcnt(0)
s_add_u32 m0, s29, 147456
ds_read_b64_tr_b16 a[136:137], v23 offset:0
v_mfma_f32_16x16x32_bf16 v[36:39], a[132:135], a[4:7], v[36:39]
buffer_load_dwordx4 v16, s[12:15], s27 offen offset:0 lds
v_mfma_f32_16x16x32_bf16 v[44:47], a[128:131], a[8:11], v[44:47]
s_lshl_b32 s22, s20, 7
ds_read_b64_tr_b16 a[138:139], v23 offset:2048
v_bfe_u32 v20, v1, 4, 3
v_mfma_f32_16x16x32_bf16 v[44:47], a[132:135], a[12:15], v[44:47]
s_add_u32 s70, s22, 94371840
ds_read_b128 a[64:67], v2 offset:16384
ds_read_b128 a[68:71], v3 offset:16384
v_mfma_f32_16x16x32_bf16 v[52:55], a[128:131], a[16:19], v[52:55]
s_lshr_b32 s22, s2, 4
ds_read_b64_tr_b16 a[140:141], v23 offset:16384
v_lshlrev_b32 v20, 3, v20
v_mfma_f32_16x16x32_bf16 v[52:55], a[132:135], a[20:23], v[52:55]
s_lshl_b32 s22, s22, 2
buffer_load_dwordx4 v17, s[12:15], s27 offen offset:1024 lds
v_mfma_f32_16x16x32_bf16 v[60:63], a[128:131], a[24:27], v[60:63]
s_add_u32 s66, s70, s22
ds_read_b64_tr_b16 a[142:143], v23 offset:18432
v_add_u32 v23, 32768, v23
v_mfma_f32_16x16x32_bf16 v[60:63], a[132:135], a[28:31], v[60:63]
s_and_b32 s22, s2, 16
buffer_store_dwordx4 v[48:51], v1, s[4:7], s31 offen sc1
v_mfma_f32_16x16x32_bf16 v[68:71], a[128:131], a[32:35], v[68:71]
s_add_u32 s31, s31, s32
ds_read_b128 a[72:75], v2 offset:18432
v_add_u32 v15, 2052, v20
v_mfma_f32_16x16x32_bf16 v[68:71], a[132:135], a[36:39], v[68:71]
s_lshl_b32 s22, s22, 7
buffer_load_dwordx4 v18, s[12:15], s27 offen offset:2048 lds
v_mfma_f32_16x16x32_bf16 v[76:79], a[128:131], a[40:43], v[76:79]
s_add_u32 s66, s66, s22
ds_read_b128 a[76:79], v3 offset:18432
v_mfma_f32_16x16x32_bf16 v[76:79], a[132:135], a[44:47], v[76:79]
s_lshl_b32 s67, s20, 20
ds_read_b128 a[80:83], v2 offset:20480
v_mfma_f32_16x16x32_bf16 v[84:87], a[128:131], a[48:51], v[84:87]
s_lshl_b32 s22, s37, 16
ds_read_b128 a[84:87], v3 offset:20480
v_mfma_f32_16x16x32_bf16 v[84:87], a[132:135], a[52:55], v[84:87]
s_add_u32 s67, s67, s22
buffer_load_dwordx4 v19, s[12:15], s27 offen offset:3072 lds
v_mfma_f32_16x16x32_bf16 v[92:95], a[128:131], a[56:59], v[92:95]
s_waitcnt lgkmcnt(8)
s_add_u32 s27, s27, 524288
ds_read_b128 a[88:91], v2 offset:22528
v_mfma_f32_16x16x32_bf16 v[92:95], a[132:135], a[60:63], v[92:95]
s_lshl_b32 s22, s3, 11
buffer_store_dwordx4 v[56:59], v1, s[4:7], s31 offen sc1
v_mfma_f32_16x16x32_bf16 v[100:103], a[136:139], a[0:3], v[100:103]
s_waitcnt lgkmcnt(5)
s_add_u32 s31, s31, s34
ds_read_b64_tr_b16 a[128:129], v24 offset:0
v_mfma_f32_16x16x32_bf16 v[100:103], a[140:143], a[4:7], v[100:103]
s_add_u32 s67, s67, s22
v_mfma_f32_16x16x32_bf16 v[108:111], a[136:139], a[8:11], v[108:111]
s_add_u32 s67, s67, 33554432
ds_read_b64_tr_b16 a[130:131], v24 offset:2048
v_mfma_f32_16x16x32_bf16 v[108:111], a[140:143], a[12:15], v[108:111]
s_mov_b32 s68, 1035512379
ds_read_b128 a[92:95], v3 offset:22528
v_mfma_f32_16x16x32_bf16 v[116:119], a[136:139], a[16:19], v[116:119]
s_mov_b32 s69, 1035512379
ds_read_b64_tr_b16 a[132:133], v24 offset:16384
v_mfma_f32_16x16x32_bf16 v[116:119], a[140:143], a[20:23], v[116:119]
buffer_store_dwordx4 v[64:67], v1, s[4:7], s31 offen sc1
v_mfma_f32_16x16x32_bf16 v[124:127], a[136:139], a[24:27], v[124:127]
s_add_u32 s31, s31, s32
ds_read_b64_tr_b16 a[134:135], v24 offset:18432
v_add_u32 v24, 32768, v24
v_mfma_f32_16x16x32_bf16 v[124:127], a[140:143], a[28:31], v[124:127]
v_mfma_f32_16x16x32_bf16 v[132:135], a[136:139], a[32:35], v[132:135]
ds_read_b128 a[96:99], v2 offset:24576
v_mfma_f32_16x16x32_bf16 v[132:135], a[140:143], a[36:39], v[132:135]
v_mfma_f32_16x16x32_bf16 v[140:143], a[136:139], a[40:43], v[140:143]
ds_read_b128 a[100:103], v3 offset:24576
v_mfma_f32_16x16x32_bf16 v[140:143], a[140:143], a[44:47], v[140:143]
ds_read_b128 a[104:107], v2 offset:26624
v_mfma_f32_16x16x32_bf16 v[148:151], a[136:139], a[48:51], v[148:151]
ds_read_b128 a[108:111], v3 offset:26624
v_mfma_f32_16x16x32_bf16 v[148:151], a[140:143], a[52:55], v[148:151]
v_mfma_f32_16x16x32_bf16 v[156:159], a[136:139], a[56:59], v[156:159]
ds_read_b128 a[112:115], v2 offset:28672
v_mfma_f32_16x16x32_bf16 v[156:159], a[140:143], a[60:63], v[156:159]
s_waitcnt lgkmcnt(8)
buffer_store_dwordx4 v[72:75], v1, s[4:7], s31 offen sc1
v_mfma_f32_16x16x32_bf16 v[164:167], a[128:131], a[0:3], v[164:167]
s_waitcnt lgkmcnt(5)
s_add_u32 s31, s31, s33
ds_read_b64_tr_b16 a[136:137], v25 offset:0
v_mfma_f32_16x16x32_bf16 v[164:167], a[132:135], a[4:7], v[164:167]
v_mfma_f32_16x16x32_bf16 v[172:175], a[128:131], a[8:11], v[172:175]
ds_read_b64_tr_b16 a[138:139], v25 offset:2048
v_mfma_f32_16x16x32_bf16 v[172:175], a[132:135], a[12:15], v[172:175]
ds_read_b128 a[116:119], v3 offset:28672
v_mfma_f32_16x16x32_bf16 v[180:183], a[128:131], a[16:19], v[180:183]
ds_read_b64_tr_b16 a[140:141], v25 offset:16384
v_mfma_f32_16x16x32_bf16 v[180:183], a[132:135], a[20:23], v[180:183]
v_mfma_f32_16x16x32_bf16 v[188:191], a[128:131], a[24:27], v[188:191]
ds_read_b64_tr_b16 a[142:143], v25 offset:18432
v_add_u32 v25, 32768, v25
v_mfma_f32_16x16x32_bf16 v[188:191], a[132:135], a[28:31], v[188:191]
v_mfma_f32_16x16x32_bf16 v[196:199], a[128:131], a[32:35], v[196:199]
ds_read_b128 a[120:123], v2 offset:30720
v_mfma_f32_16x16x32_bf16 v[196:199], a[132:135], a[36:39], v[196:199]
buffer_store_dwordx4 v[80:83], v1, s[4:7], s31 offen sc1
v_mfma_f32_16x16x32_bf16 v[204:207], a[128:131], a[40:43], v[204:207]
s_add_u32 s31, s31, s32
ds_read_b128 a[124:127], v3 offset:30720
v_mfma_f32_16x16x32_bf16 v[204:207], a[132:135], a[44:47], v[204:207]
v_mfma_f32_16x16x32_bf16 v[212:215], a[128:131], a[48:51], v[212:215]
v_mfma_f32_16x16x32_bf16 v[212:215], a[132:135], a[52:55], v[212:215]
v_mfma_f32_16x16x32_bf16 v[220:223], a[128:131], a[56:59], v[220:223]
v_mfma_f32_16x16x32_bf16 v[220:223], a[132:135], a[60:63], v[220:223]
s_waitcnt vmcnt(17) lgkmcnt(0)
s_barrier
v_mfma_f32_16x16x32_bf16 v[224:227], a[136:139], a[0:3], v[224:227]
ds_read_b64_tr_b16 a[128:129], v22 offset:0
v_mfma_f32_16x16x32_bf16 v[224:227], a[140:143], a[4:7], v[224:227]
v_mfma_f32_16x16x32_bf16 v[228:231], a[136:139], a[8:11], v[228:231]
ds_read_b64_tr_b16 a[130:131], v22 offset:2048
v_mfma_f32_16x16x32_bf16 v[228:231], a[140:143], a[12:15], v[228:231]
buffer_store_dwordx4 v[88:91], v1, s[4:7], s31 offen sc1
v_mfma_f32_16x16x32_bf16 v[232:235], a[136:139], a[16:19], v[232:235]
ds_read_b64_tr_b16 a[132:133], v22 offset:16384
v_mfma_f32_16x16x32_bf16 v[232:235], a[140:143], a[20:23], v[232:235]
v_mfma_f32_16x16x32_bf16 v[236:239], a[136:139], a[24:27], v[236:239]
ds_read_b64_tr_b16 a[134:135], v22 offset:18432
v_add_u32 v22, 32768, v22
v_mfma_f32_16x16x32_bf16 v[236:239], a[140:143], a[28:31], v[236:239]
v_mfma_f32_16x16x32_bf16 v[240:243], a[136:139], a[32:35], v[240:243]
v_mfma_f32_16x16x32_bf16 v[240:243], a[140:143], a[36:39], v[240:243]
v_mfma_f32_16x16x32_bf16 v[244:247], a[136:139], a[40:43], v[244:247]
v_mfma_f32_16x16x32_bf16 v[244:247], a[140:143], a[44:47], v[244:247]
v_mfma_f32_16x16x32_bf16 v[248:251], a[136:139], a[48:51], v[248:251]
v_mfma_f32_16x16x32_bf16 v[248:251], a[140:143], a[52:55], v[248:251]
v_mfma_f32_16x16x32_bf16 v[252:255], a[136:139], a[56:59], v[252:255]
v_mfma_f32_16x16x32_bf16 v[252:255], a[140:143], a[60:63], v[252:255]
s_waitcnt lgkmcnt(2)
v_mfma_f32_16x16x32_bf16 v[36:39], a[128:131], a[64:67], v[36:39]
s_waitcnt lgkmcnt(0)
ds_read_b64_tr_b16 a[136:137], v23 offset:0
v_mfma_f32_16x16x32_bf16 v[36:39], a[132:135], a[68:71], v[36:39]
v_mfma_f32_16x16x32_bf16 v[44:47], a[128:131], a[72:75], v[44:47]
ds_read_b64_tr_b16 a[138:139], v23 offset:2048
v_mfma_f32_16x16x32_bf16 v[44:47], a[132:135], a[76:79], v[44:47]
ds_read_b128 a[0:3], v2 offset:32768
ds_read_b128 a[4:7], v3 offset:32768
v_mfma_f32_16x16x32_bf16 v[52:55], a[128:131], a[80:83], v[52:55]
ds_read_b64_tr_b16 a[140:141], v23 offset:16384
v_mfma_f32_16x16x32_bf16 v[52:55], a[132:135], a[84:87], v[52:55]
v_mfma_f32_16x16x32_bf16 v[60:63], a[128:131], a[88:91], v[60:63]
ds_read_b64_tr_b16 a[142:143], v23 offset:18432
v_add_u32 v23, 32768, v23
v_mfma_f32_16x16x32_bf16 v[60:63], a[132:135], a[92:95], v[60:63]
v_mfma_f32_16x16x32_bf16 v[68:71], a[128:131], a[96:99], v[68:71]
ds_read_b128 a[8:11], v2 offset:34816
v_mfma_f32_16x16x32_bf16 v[68:71], a[132:135], a[100:103], v[68:71]
v_mfma_f32_16x16x32_bf16 v[76:79], a[128:131], a[104:107], v[76:79]
ds_read_b128 a[12:15], v3 offset:34816
v_mfma_f32_16x16x32_bf16 v[76:79], a[132:135], a[108:111], v[76:79]
ds_read_b128 a[16:19], v2 offset:36864
v_mfma_f32_16x16x32_bf16 v[84:87], a[128:131], a[112:115], v[84:87]
ds_read_b128 a[20:23], v3 offset:36864
v_mfma_f32_16x16x32_bf16 v[84:87], a[132:135], a[116:119], v[84:87]
v_mfma_f32_16x16x32_bf16 v[92:95], a[128:131], a[120:123], v[92:95]
ds_read_b128 a[24:27], v2 offset:38912
v_mfma_f32_16x16x32_bf16 v[92:95], a[132:135], a[124:127], v[92:95]
s_waitcnt lgkmcnt(9)
v_mfma_f32_16x16x32_bf16 v[100:103], a[136:139], a[64:67], v[100:103]
s_waitcnt lgkmcnt(5)
ds_read_b64_tr_b16 a[128:129], v24 offset:0
v_mfma_f32_16x16x32_bf16 v[100:103], a[140:143], a[68:71], v[100:103]
v_mfma_f32_16x16x32_bf16 v[108:111], a[136:139], a[72:75], v[108:111]
ds_read_b64_tr_b16 a[130:131], v24 offset:2048
v_mfma_f32_16x16x32_bf16 v[108:111], a[140:143], a[76:79], v[108:111]
ds_read_b128 a[28:31], v3 offset:38912
v_mfma_f32_16x16x32_bf16 v[116:119], a[136:139], a[80:83], v[116:119]
ds_read_b64_tr_b16 a[132:133], v24 offset:16384
v_mfma_f32_16x16x32_bf16 v[116:119], a[140:143], a[84:87], v[116:119]
v_mfma_f32_16x16x32_bf16 v[124:127], a[136:139], a[88:91], v[124:127]
ds_read_b64_tr_b16 a[134:135], v24 offset:18432
v_add_u32 v24, 32768, v24
v_mfma_f32_16x16x32_bf16 v[124:127], a[140:143], a[92:95], v[124:127]
v_mfma_f32_16x16x32_bf16 v[132:135], a[136:139], a[96:99], v[132:135]
ds_read_b128 a[32:35], v2 offset:40960
v_mfma_f32_16x16x32_bf16 v[132:135], a[140:143], a[100:103], v[132:135]
v_mfma_f32_16x16x32_bf16 v[140:143], a[136:139], a[104:107], v[140:143]
ds_read_b128 a[36:39], v3 offset:40960
v_mfma_f32_16x16x32_bf16 v[140:143], a[140:143], a[108:111], v[140:143]
ds_read_b128 a[40:43], v2 offset:43008
v_mfma_f32_16x16x32_bf16 v[148:151], a[136:139], a[112:115], v[148:151]
ds_read_b128 a[44:47], v3 offset:43008
v_mfma_f32_16x16x32_bf16 v[148:151], a[140:143], a[116:119], v[148:151]
v_mfma_f32_16x16x32_bf16 v[156:159], a[136:139], a[120:123], v[156:159]
ds_read_b128 a[48:51], v2 offset:45056
v_mfma_f32_16x16x32_bf16 v[156:159], a[140:143], a[124:127], v[156:159]
s_waitcnt lgkmcnt(8)
v_mfma_f32_16x16x32_bf16 v[164:167], a[128:131], a[64:67], v[164:167]
s_waitcnt lgkmcnt(5)
ds_read_b64_tr_b16 a[136:137], v25 offset:0
v_mfma_f32_16x16x32_bf16 v[164:167], a[132:135], a[68:71], v[164:167]
v_mfma_f32_16x16x32_bf16 v[172:175], a[128:131], a[72:75], v[172:175]
ds_read_b64_tr_b16 a[138:139], v25 offset:2048
v_mfma_f32_16x16x32_bf16 v[172:175], a[132:135], a[76:79], v[172:175]
ds_read_b128 a[52:55], v3 offset:45056
v_mfma_f32_16x16x32_bf16 v[180:183], a[128:131], a[80:83], v[180:183]
ds_read_b64_tr_b16 a[140:141], v25 offset:16384
v_mfma_f32_16x16x32_bf16 v[180:183], a[132:135], a[84:87], v[180:183]
v_mfma_f32_16x16x32_bf16 v[188:191], a[128:131], a[88:91], v[188:191]
ds_read_b64_tr_b16 a[142:143], v25 offset:18432
v_add_u32 v25, 32768, v25
v_mfma_f32_16x16x32_bf16 v[188:191], a[132:135], a[92:95], v[188:191]
v_mfma_f32_16x16x32_bf16 v[196:199], a[128:131], a[96:99], v[196:199]
ds_read_b128 a[56:59], v2 offset:47104
v_mfma_f32_16x16x32_bf16 v[196:199], a[132:135], a[100:103], v[196:199]
v_mfma_f32_16x16x32_bf16 v[204:207], a[128:131], a[104:107], v[204:207]
ds_read_b128 a[60:63], v3 offset:47104
v_mfma_f32_16x16x32_bf16 v[204:207], a[132:135], a[108:111], v[204:207]
v_mfma_f32_16x16x32_bf16 v[212:215], a[128:131], a[112:115], v[212:215]
v_mfma_f32_16x16x32_bf16 v[212:215], a[132:135], a[116:119], v[212:215]
v_mfma_f32_16x16x32_bf16 v[220:223], a[128:131], a[120:123], v[220:223]
v_mfma_f32_16x16x32_bf16 v[220:223], a[132:135], a[124:127], v[220:223]
s_waitcnt vmcnt(0) lgkmcnt(0)
s_barrier
v_mfma_f32_16x16x32_bf16 v[224:227], a[136:139], a[64:67], v[224:227]
ds_read_b64_tr_b16 a[128:129], v22 offset:0
v_mfma_f32_16x16x32_bf16 v[224:227], a[140:143], a[68:71], v[224:227]
buffer_store_dword v27, v26, s[4:7], s66 offen sc1
v_mfma_f32_16x16x32_bf16 v[228:231], a[136:139], a[72:75], v[228:231]
ds_read_b64_tr_b16 a[130:131], v22 offset:2048
v_mfma_f32_16x16x32_bf16 v[228:231], a[140:143], a[76:79], v[228:231]
v_mfma_f32_16x16x32_bf16 v[232:235], a[136:139], a[80:83], v[232:235]
ds_read_b64_tr_b16 a[132:133], v22 offset:16384
v_mfma_f32_16x16x32_bf16 v[232:235], a[140:143], a[84:87], v[232:235]
v_mfma_f32_16x16x32_bf16 v[236:239], a[136:139], a[88:91], v[236:239]
ds_read_b64_tr_b16 a[134:135], v22 offset:18432
v_mfma_f32_16x16x32_bf16 v[236:239], a[140:143], a[92:95], v[236:239]
v_mfma_f32_16x16x32_bf16 v[240:243], a[136:139], a[96:99], v[240:243]
v_mfma_f32_16x16x32_bf16 v[240:243], a[140:143], a[100:103], v[240:243]
v_mfma_f32_16x16x32_bf16 v[244:247], a[136:139], a[104:107], v[244:247]
v_mfma_f32_16x16x32_bf16 v[244:247], a[140:143], a[108:111], v[244:247]
v_mfma_f32_16x16x32_bf16 v[248:251], a[136:139], a[112:115], v[248:251]
v_mfma_f32_16x16x32_bf16 v[248:251], a[140:143], a[116:119], v[248:251]
v_mfma_f32_16x16x32_bf16 v[252:255], a[136:139], a[120:123], v[252:255]
v_mfma_f32_16x16x32_bf16 v[252:255], a[140:143], a[124:127], v[252:255]
s_waitcnt lgkmcnt(2)
v_mfma_f32_16x16x32_bf16 v[36:39], a[128:131], a[0:3], v[36:39]
s_waitcnt lgkmcnt(0)
ds_read_b64_tr_b16 a[136:137], v23 offset:0
v_lshrrev_b32 v28, 6, v0
v_mfma_f32_16x16x32_bf16 v[36:39], a[132:135], a[4:7], v[36:39]
s_cmp_ge_u32 s21, 6
v_lshl_add_u32 v28, v28, 11, v1
v_add_u32 v28, 65536, v28
v_mfma_f32_16x16x32_bf16 v[44:47], a[128:131], a[8:11], v[44:47]
s_cselect_b32 s67, 3221225472, s67
ds_read_b64_tr_b16 a[138:139], v23 offset:2048
v_lshrrev_b32 v3, 6, v0
v_mfma_f32_16x16x32_bf16 v[44:47], a[132:135], a[12:15], v[44:47]
s_lshl_b32 s18, s3, 13
v_and_b32 v4, 63, v0
v_add_u32 v2, 0x10000, v1
v_mfma_f32_16x16x32_bf16 v[52:55], a[128:131], a[16:19], v[52:55]
s_lshl_b32 s30, s20, 20
ds_read_b64_tr_b16 a[140:141], v23 offset:16384
v_and_b32 v5, 15, v4
v_mfma_f32_16x16x32_bf16 v[52:55], a[132:135], a[20:23], v[52:55]
s_add_u32 s30, s30, s18
v_lshrrev_b32 v6, 4, v4
v_lshlrev_b32 v6, 2, v6
v_mfma_f32_16x16x32_bf16 v[60:63], a[128:131], a[24:27], v[60:63]
s_lshl_b32 s22, s21, 1
ds_read_b64_tr_b16 a[142:143], v23 offset:18432
v_sub_u32 v5, v5, v6
v_mfma_f32_16x16x32_bf16 v[60:63], a[132:135], a[28:31], v[60:63]
s_max_u32 s11, s22, 12
v_lshl_add_u32 v5, v3, 4, v5
v_cmp_gt_i32 s[32:33], 0, v5
v_mfma_f32_16x16x32_bf16 v[68:71], a[128:131], a[32:35], v[68:71]
s_sub_u32 s9, 32, s11
v_cmp_gt_i32 s[34:35], 1, v5
v_cmp_gt_i32 s[36:37], 2, v5
v_mfma_f32_16x16x32_bf16 v[68:71], a[132:135], a[36:39], v[68:71]
s_sub_u32 s22, s11, s22
v_cmp_gt_i32 s[38:39], 3, v5
v_cmp_gt_i32 s[40:41], 16, v5
v_mfma_f32_16x16x32_bf16 v[76:79], a[128:131], a[40:43], v[76:79]
s_lshl_b32 s22, s22, 15
v_cmp_gt_i32 s[42:43], 17, v5
v_cmp_gt_i32 s[44:45], 18, v5
v_mfma_f32_16x16x32_bf16 v[76:79], a[132:135], a[44:47], v[76:79]
s_add_u32 s8, s30, s22
v_cmp_gt_i32 s[46:47], 19, v5
v_cmp_gt_i32 s[48:49], 32, v5
v_mfma_f32_16x16x32_bf16 v[84:87], a[128:131], a[48:51], v[84:87]
s_mov_b32 s10, 3221225472
v_cmp_gt_i32 s[50:51], 33, v5
v_cmp_gt_i32 s[52:53], 34, v5
v_mfma_f32_16x16x32_bf16 v[84:87], a[132:135], a[52:55], v[84:87]
s_mov_b32 s14, 3221225472
v_cmp_gt_i32 s[54:55], 35, v5
v_cmp_gt_i32 s[56:57], 48, v5
v_mfma_f32_16x16x32_bf16 v[92:95], a[128:131], a[56:59], v[92:95]
s_sub_u32 s29, 15, s21
v_cmp_gt_i32 s[58:59], 49, v5
v_cmp_gt_i32 s[60:61], 50, v5
v_mfma_f32_16x16x32_bf16 v[92:95], a[132:135], a[60:63], v[92:95]
s_waitcnt lgkmcnt(2)
v_cmp_gt_i32 s[62:63], 51, v5
v_mov_b32 v7, 0xff800000
v_mfma_f32_16x16x32_bf16 v[100:103], a[136:139], a[0:3], v[100:103]
s_waitcnt lgkmcnt(0)
ds_read_b64_tr_b16 a[128:129], v24 offset:0
v_mov_b32 v6, 1
v_mfma_f32_16x16x32_bf16 v[100:103], a[140:143], a[4:7], v[100:103]
s_cmp_lt_u32 s21, 6
v_mov_b32 v5, v26
v_add_u32 v4, 0x20000, v1
v_mfma_f32_16x16x32_bf16 v[108:111], a[136:139], a[8:11], v[108:111]
s_cselect_b32 s24, 1, 0
ds_read_b64_tr_b16 a[130:131], v24 offset:2048
v_mfma_f32_16x16x32_bf16 v[108:111], a[140:143], a[12:15], v[108:111]
s_bitcmp1_b32 s2, 4
v_mfma_f32_16x16x32_bf16 v[116:119], a[136:139], a[16:19], v[116:119]
s_cselect_b32 s9, 16, s9
ds_read_b64_tr_b16 a[132:133], v24 offset:16384
v_mfma_f32_16x16x32_bf16 v[116:119], a[140:143], a[20:23], v[116:119]
s_cselect_b32 s29, 7, s29
v_mfma_f32_16x16x32_bf16 v[124:127], a[136:139], a[24:27], v[124:127]
s_lshr_b32 s19, s9, 1
ds_read_b64_tr_b16 a[134:135], v24 offset:18432
v_mul_f32 v36, s68, v36
v_mfma_f32_16x16x32_bf16 v[124:127], a[140:143], a[28:31], v[124:127]
s_sub_u32 s19, s19, 1
v_mul_f32 v37, s68, v37
v_mul_f32 v38, s68, v38
v_mfma_f32_16x16x32_bf16 v[132:135], a[136:139], a[32:35], v[132:135]
s_add_u32 s12, s8, 16777216
v_mul_f32 v39, s68, v39
v_mul_f32 v100, s68, v100
v_mfma_f32_16x16x32_bf16 v[132:135], a[140:143], a[36:39], v[132:135]
s_mov_b32 s13, s9
v_mul_f32 v101, s68, v101
v_mul_f32 v102, s68, v102
v_mfma_f32_16x16x32_bf16 v[140:143], a[136:139], a[40:43], v[140:143]
s_mov_b32 s15, s11
v_mul_f32 v103, s68, v103
v_cvt_pk_bf16_f32 v36, v36, v37
v_mfma_f32_16x16x32_bf16 v[140:143], a[140:143], a[44:47], v[140:143]
v_cvt_pk_bf16_f32 v37, v38, v39
v_cvt_pk_bf16_f32 v38, v100, v101
v_mfma_f32_16x16x32_bf16 v[148:151], a[136:139], a[48:51], v[148:151]
v_cvt_pk_bf16_f32 v39, v102, v103
v_mul_f32 v44, s68, v44
v_mfma_f32_16x16x32_bf16 v[148:151], a[140:143], a[52:55], v[148:151]
ds_write_b128 v28, v[36:39] offset:0
v_mul_f32 v45, s68, v45
v_mfma_f32_16x16x32_bf16 v[156:159], a[136:139], a[56:59], v[156:159]
s_add_u32 s23, s67, 0
buffer_store_dwordx4 v[36:39], v1, s[4:7], s23 offen offset:0 sc1
v_mfma_f32_16x16x32_bf16 v[156:159], a[140:143], a[60:63], v[156:159]
s_waitcnt lgkmcnt(3)
v_mul_f32 v46, s68, v46
v_mul_f32 v47, s68, v47
v_mfma_f32_16x16x32_bf16 v[164:167], a[128:131], a[0:3], v[164:167]
s_waitcnt lgkmcnt(1)
ds_read_b64_tr_b16 a[136:137], v25 offset:0
v_mul_f32 v108, s68, v108
v_mfma_f32_16x16x32_bf16 v[164:167], a[132:135], a[4:7], v[164:167]
v_mul_f32 v109, s68, v109
v_mul_f32 v110, s68, v110
v_mfma_f32_16x16x32_bf16 v[172:175], a[128:131], a[8:11], v[172:175]
ds_read_b64_tr_b16 a[138:139], v25 offset:2048
v_mul_f32 v111, s68, v111
v_mfma_f32_16x16x32_bf16 v[172:175], a[132:135], a[12:15], v[172:175]
v_cvt_pk_bf16_f32 v44, v44, v45
v_cvt_pk_bf16_f32 v45, v46, v47
v_mfma_f32_16x16x32_bf16 v[180:183], a[128:131], a[16:19], v[180:183]
ds_read_b64_tr_b16 a[140:141], v25 offset:16384
v_cvt_pk_bf16_f32 v46, v108, v109
v_mfma_f32_16x16x32_bf16 v[180:183], a[132:135], a[20:23], v[180:183]
v_cvt_pk_bf16_f32 v47, v110, v111
v_mul_f32 v52, s68, v52
v_mfma_f32_16x16x32_bf16 v[188:191], a[128:131], a[24:27], v[188:191]
ds_read_b64_tr_b16 a[142:143], v25 offset:18432
v_mul_f32 v53, s68, v53
v_mfma_f32_16x16x32_bf16 v[188:191], a[132:135], a[28:31], v[188:191]
ds_write_b128 v28, v[44:47] offset:8192
v_mul_f32 v54, s68, v54
v_mfma_f32_16x16x32_bf16 v[196:199], a[128:131], a[32:35], v[196:199]
s_add_u32 s23, s67, 8192
buffer_store_dwordx4 v[44:47], v1, s[4:7], s23 offen offset:0 sc1
v_mfma_f32_16x16x32_bf16 v[196:199], a[132:135], a[36:39], v[196:199]
v_mul_f32 v55, s68, v55
v_mul_f32 v116, s68, v116
v_mfma_f32_16x16x32_bf16 v[204:207], a[128:131], a[40:43], v[204:207]
v_mul_f32 v117, s68, v117
v_mul_f32 v118, s68, v118
v_mfma_f32_16x16x32_bf16 v[204:207], a[132:135], a[44:47], v[204:207]
v_mul_f32 v119, s68, v119
v_cvt_pk_bf16_f32 v52, v52, v53
v_mfma_f32_16x16x32_bf16 v[212:215], a[128:131], a[48:51], v[212:215]
v_cvt_pk_bf16_f32 v53, v54, v55
v_cvt_pk_bf16_f32 v54, v116, v117
v_mfma_f32_16x16x32_bf16 v[212:215], a[132:135], a[52:55], v[212:215]
v_cvt_pk_bf16_f32 v55, v118, v119
v_mul_f32 v60, s68, v60
v_mfma_f32_16x16x32_bf16 v[220:223], a[128:131], a[56:59], v[220:223]
s_waitcnt lgkmcnt(3)
ds_write_b128 v28, v[52:55] offset:16384
v_mul_f32 v61, s68, v61
v_mfma_f32_16x16x32_bf16 v[220:223], a[132:135], a[60:63], v[220:223]
s_add_u32 s23, s67, 16384
buffer_store_dwordx4 v[52:55], v1, s[4:7], s23 offen offset:0 sc1
v_mfma_f32_16x16x32_bf16 v[224:227], a[136:139], a[0:3], v[224:227]
s_waitcnt lgkmcnt(2)
v_mul_f32 v62, s68, v62
v_mul_f32 v63, s68, v63
v_mfma_f32_16x16x32_bf16 v[224:227], a[140:143], a[4:7], v[224:227]
v_mul_f32 v124, s68, v124
v_mul_f32 v125, s68, v125
v_mfma_f32_16x16x32_bf16 v[228:231], a[136:139], a[8:11], v[228:231]
v_mul_f32 v126, s68, v126
v_mul_f32 v127, s68, v127
v_mfma_f32_16x16x32_bf16 v[228:231], a[140:143], a[12:15], v[228:231]
v_cvt_pk_bf16_f32 v60, v60, v61
v_cvt_pk_bf16_f32 v61, v62, v63
v_mfma_f32_16x16x32_bf16 v[232:235], a[136:139], a[16:19], v[232:235]
v_cvt_pk_bf16_f32 v62, v124, v125
v_cvt_pk_bf16_f32 v63, v126, v127
v_mfma_f32_16x16x32_bf16 v[232:235], a[140:143], a[20:23], v[232:235]
ds_write_b128 v28, v[60:63] offset:24576
v_mul_f32 v68, s68, v68
v_mfma_f32_16x16x32_bf16 v[236:239], a[136:139], a[24:27], v[236:239]
s_add_u32 s23, s67, 24576
buffer_store_dwordx4 v[60:63], v1, s[4:7], s23 offen offset:0 sc1
v_mfma_f32_16x16x32_bf16 v[236:239], a[140:143], a[28:31], v[236:239]
v_mul_f32 v69, s68, v69
v_mul_f32 v70, s68, v70
v_mfma_f32_16x16x32_bf16 v[240:243], a[136:139], a[32:35], v[240:243]
v_mul_f32 v71, s68, v71
v_mul_f32 v132, s68, v132
v_mfma_f32_16x16x32_bf16 v[240:243], a[140:143], a[36:39], v[240:243]
v_mul_f32 v133, s68, v133
v_mul_f32 v134, s68, v134
v_mfma_f32_16x16x32_bf16 v[244:247], a[136:139], a[40:43], v[244:247]
v_mul_f32 v135, s68, v135
v_cvt_pk_bf16_f32 v68, v68, v69
v_mfma_f32_16x16x32_bf16 v[244:247], a[140:143], a[44:47], v[244:247]
v_cvt_pk_bf16_f32 v69, v70, v71
v_cvt_pk_bf16_f32 v70, v132, v133
v_mfma_f32_16x16x32_bf16 v[248:251], a[136:139], a[48:51], v[248:251]
v_cvt_pk_bf16_f32 v71, v134, v135
v_mfma_f32_16x16x32_bf16 v[248:251], a[140:143], a[52:55], v[248:251]
ds_write_b128 v28, v[68:71] offset:32768
v_mfma_f32_16x16x32_bf16 v[252:255], a[136:139], a[56:59], v[252:255]
s_add_u32 s23, s67, 32768
buffer_store_dwordx4 v[68:71], v1, s[4:7], s23 offen offset:0 sc1
v_mfma_f32_16x16x32_bf16 v[252:255], a[140:143], a[60:63], v[252:255]
buffer_load_dword v21, v20, s[4:7], s70 offen sc1
v_pk_mul_f32 v[76:77], v[76:77], s[68:69]
v_pk_mul_f32 v[78:79], v[78:79], s[68:69]
v_pk_mul_f32 v[140:141], v[140:141], s[68:69]
v_pk_mul_f32 v[142:143], v[142:143], s[68:69]
v_cvt_pk_bf16_f32 v76, v76, v77
v_cvt_pk_bf16_f32 v77, v78, v79
v_cvt_pk_bf16_f32 v78, v140, v141
v_cvt_pk_bf16_f32 v79, v142, v143
ds_write_b128 v28, v[76:79] offset:40960
s_add_u32 s23, s67, 40960
buffer_store_dwordx4 v[76:79], v1, s[4:7], s23 offen offset:0 sc1
v_pk_mul_f32 v[84:85], v[84:85], s[68:69]
v_pk_mul_f32 v[86:87], v[86:87], s[68:69]
v_pk_mul_f32 v[148:149], v[148:149], s[68:69]
v_pk_mul_f32 v[150:151], v[150:151], s[68:69]
v_cvt_pk_bf16_f32 v84, v84, v85
v_cvt_pk_bf16_f32 v85, v86, v87
v_cvt_pk_bf16_f32 v86, v148, v149
v_cvt_pk_bf16_f32 v87, v150, v151
ds_write_b128 v28, v[84:87] offset:49152
s_add_u32 s23, s67, 49152
buffer_store_dwordx4 v[84:87], v1, s[4:7], s23 offen offset:0 sc1
v_pk_mul_f32 v[92:93], v[92:93], s[68:69]
v_pk_mul_f32 v[94:95], v[94:95], s[68:69]
v_pk_mul_f32 v[156:157], v[156:157], s[68:69]
v_pk_mul_f32 v[158:159], v[158:159], s[68:69]
v_cvt_pk_bf16_f32 v92, v92, v93
v_cvt_pk_bf16_f32 v93, v94, v95
v_cvt_pk_bf16_f32 v94, v156, v157
v_cvt_pk_bf16_f32 v95, v158, v159
ds_write_b128 v28, v[92:95] offset:57344
s_add_u32 s23, s67, 57344
buffer_store_dwordx4 v[92:95], v1, s[4:7], s23 offen offset:0 sc1
v_pk_mul_f32 v[164:165], v[164:165], s[68:69]
v_pk_mul_f32 v[166:167], v[166:167], s[68:69]
v_pk_mul_f32 v[224:225], v[224:225], s[68:69]
v_pk_mul_f32 v[226:227], v[226:227], s[68:69]
v_cvt_pk_bf16_f32 v164, v164, v165
v_cvt_pk_bf16_f32 v165, v166, v167
v_cvt_pk_bf16_f32 v166, v224, v225
v_cvt_pk_bf16_f32 v167, v226, v227
ds_write_b128 v28, v[164:167] offset:1024
s_add_u32 s23, s67, 0
buffer_store_dwordx4 v[164:167], v1, s[4:7], s23 offen offset:1024 sc1
v_pk_mul_f32 v[172:173], v[172:173], s[68:69]
v_pk_mul_f32 v[174:175], v[174:175], s[68:69]
v_pk_mul_f32 v[228:229], v[228:229], s[68:69]
v_pk_mul_f32 v[230:231], v[230:231], s[68:69]
v_cvt_pk_bf16_f32 v172, v172, v173
v_cvt_pk_bf16_f32 v173, v174, v175
v_cvt_pk_bf16_f32 v174, v228, v229
v_cvt_pk_bf16_f32 v175, v230, v231
ds_write_b128 v28, v[172:175] offset:9216
s_add_u32 s23, s67, 8192
buffer_store_dwordx4 v[172:175], v1, s[4:7], s23 offen offset:1024 sc1
v_pk_mul_f32 v[180:181], v[180:181], s[68:69]
v_pk_mul_f32 v[182:183], v[182:183], s[68:69]
v_pk_mul_f32 v[232:233], v[232:233], s[68:69]
v_pk_mul_f32 v[234:235], v[234:235], s[68:69]
v_cvt_pk_bf16_f32 v180, v180, v181
v_cvt_pk_bf16_f32 v181, v182, v183
v_cvt_pk_bf16_f32 v182, v232, v233
v_cvt_pk_bf16_f32 v183, v234, v235
ds_write_b128 v28, v[180:183] offset:17408
s_add_u32 s23, s67, 16384
buffer_store_dwordx4 v[180:183], v1, s[4:7], s23 offen offset:1024 sc1
v_pk_mul_f32 v[188:189], v[188:189], s[68:69]
v_pk_mul_f32 v[190:191], v[190:191], s[68:69]
v_pk_mul_f32 v[236:237], v[236:237], s[68:69]
v_pk_mul_f32 v[238:239], v[238:239], s[68:69]
v_cvt_pk_bf16_f32 v188, v188, v189
v_cvt_pk_bf16_f32 v189, v190, v191
v_cvt_pk_bf16_f32 v190, v236, v237
v_cvt_pk_bf16_f32 v191, v238, v239
ds_write_b128 v28, v[188:191] offset:25600
s_add_u32 s23, s67, 24576
buffer_store_dwordx4 v[188:191], v1, s[4:7], s23 offen offset:1024 sc1
v_pk_mul_f32 v[196:197], v[196:197], s[68:69]
v_pk_mul_f32 v[198:199], v[198:199], s[68:69]
v_pk_mul_f32 v[240:241], v[240:241], s[68:69]
v_pk_mul_f32 v[242:243], v[242:243], s[68:69]
v_cvt_pk_bf16_f32 v196, v196, v197
v_cvt_pk_bf16_f32 v197, v198, v199
v_cvt_pk_bf16_f32 v198, v240, v241
v_cvt_pk_bf16_f32 v199, v242, v243
ds_write_b128 v28, v[196:199] offset:33792
s_add_u32 s23, s67, 32768
buffer_store_dwordx4 v[196:199], v1, s[4:7], s23 offen offset:1024 sc1
v_pk_mul_f32 v[204:205], v[204:205], s[68:69]
v_pk_mul_f32 v[206:207], v[206:207], s[68:69]
v_pk_mul_f32 v[244:245], v[244:245], s[68:69]
v_pk_mul_f32 v[246:247], v[246:247], s[68:69]
v_cvt_pk_bf16_f32 v204, v204, v205
v_cvt_pk_bf16_f32 v205, v206, v207
v_cvt_pk_bf16_f32 v206, v244, v245
v_cvt_pk_bf16_f32 v207, v246, v247
ds_write_b128 v28, v[204:207] offset:41984
s_add_u32 s23, s67, 40960
buffer_store_dwordx4 v[204:207], v1, s[4:7], s23 offen offset:1024 sc1
v_pk_mul_f32 v[212:213], v[212:213], s[68:69]
v_pk_mul_f32 v[214:215], v[214:215], s[68:69]
v_pk_mul_f32 v[248:249], v[248:249], s[68:69]
v_pk_mul_f32 v[250:251], v[250:251], s[68:69]
v_cvt_pk_bf16_f32 v212, v212, v213
v_cvt_pk_bf16_f32 v213, v214, v215
v_cvt_pk_bf16_f32 v214, v248, v249
v_cvt_pk_bf16_f32 v215, v250, v251
ds_write_b128 v28, v[212:215] offset:50176
s_add_u32 s23, s67, 49152
buffer_store_dwordx4 v[212:215], v1, s[4:7], s23 offen offset:1024 sc1
v_pk_mul_f32 v[220:221], v[220:221], s[68:69]
v_pk_mul_f32 v[222:223], v[222:223], s[68:69]
v_pk_mul_f32 v[252:253], v[252:253], s[68:69]
v_pk_mul_f32 v[254:255], v[254:255], s[68:69]
v_cvt_pk_bf16_f32 v220, v220, v221
v_cvt_pk_bf16_f32 v221, v222, v223
v_cvt_pk_bf16_f32 v222, v252, v253
v_cvt_pk_bf16_f32 v223, v254, v255
ds_write_b128 v28, v[220:223] offset:58368
s_add_u32 s23, s67, 57344
buffer_store_dwordx4 v[220:223], v1, s[4:7], s23 offen offset:1024 sc1
s_waitcnt vmcnt(11)
v_cmp_gt_u32 vcc, 1, v21
s_cbranch_vccnz M_kspin
M_kok:
buffer_load_dword v21, v15, s[4:7], s70 offen sc1
s_add_u32 m0, s18, 0
s_nop 0
buffer_load_dwordx4 v1, s[4:7], s8 offen offset:0 sc1 lds
buffer_load_dwordx4 v1, s[4:7], s8 offen offset:1024 sc1 lds
buffer_load_dwordx4 v1, s[4:7], s8 offen offset:2048 sc1 lds
buffer_load_dwordx4 v1, s[4:7], s8 offen offset:3072 sc1 lds
s_add_u32 s8, s8, 4096
s_add_u32 m0, s18, 4096
s_nop 0
buffer_load_dwordx4 v1, s[4:7], s8 offen offset:0 sc1 lds
buffer_load_dwordx4 v1, s[4:7], s8 offen offset:1024 sc1 lds
buffer_load_dwordx4 v1, s[4:7], s8 offen offset:2048 sc1 lds
buffer_load_dwordx4 v1, s[4:7], s8 offen offset:3072 sc1 lds
s_add_u32 s8, s8, 28672
s_sub_u32 s9, s9, 1
s_cmp_eq_u32 s9, 0
s_cselect_b32 s8, s10, s8
s_cselect_b32 s9, s11, s9
s_cselect_b32 s10, 3221225472, s10
v_add_u32 v28, s18, v2
s_waitcnt lgkmcnt(0)
s_barrier
ds_read_b128 a[0:3], v28 offset:0
ds_read_b128 a[4:7], v28 offset:1024
ds_read_b128 a[8:11], v28 offset:2048
ds_read_b128 a[12:15], v28 offset:3072
ds_read_b128 a[16:19], v28 offset:4096
ds_read_b128 a[20:23], v28 offset:5120
ds_read_b128 a[24:27], v28 offset:6144
ds_read_b128 a[28:31], v28 offset:7168
ds_read_b128 a[32:35], v28 offset:32768
ds_read_b128 a[36:39], v28 offset:33792
ds_read_b128 a[40:43], v28 offset:34816
ds_read_b128 a[44:47], v28 offset:35840
ds_read_b128 a[48:51], v28 offset:36864
ds_read_b128 a[52:55], v28 offset:37888
ds_read_b128 a[56:59], v28 offset:38912
ds_read_b128 a[60:63], v28 offset:39936
s_add_u32 m0, s18, 131072
s_nop 0
buffer_load_dwordx4 v1, s[4:7], s8 offen offset:0 sc1 lds
buffer_load_dwordx4 v1, s[4:7], s8 offen offset:1024 sc1 lds
buffer_load_dwordx4 v1, s[4:7], s8 offen offset:2048 sc1 lds
buffer_load_dwordx4 v1, s[4:7], s8 offen offset:3072 sc1 lds
s_add_u32 s8, s8, 4096
s_add_u32 m0, s18, 135168
s_nop 0
buffer_load_dwordx4 v1, s[4:7], s8 offen offset:0 sc1 lds
buffer_load_dwordx4 v1, s[4:7], s8 offen offset:1024 sc1 lds
buffer_load_dwordx4 v1, s[4:7], s8 offen offset:2048 sc1 lds
buffer_load_dwordx4 v1, s[4:7], s8 offen offset:3072 sc1 lds
s_add_u32 s8, s8, 28672
s_sub_u32 s9, s9, 1
s_cmp_eq_u32 s9, 0
s_cselect_b32 s8, s10, s8
s_cselect_b32 s9, s11, s9
s_cselect_b32 s10, 3221225472, s10
s_mov_b32 s25, 1266679808
s_lshl_b32 s22, s21, 3
s_add_u32 s28, s70, s22
s_add_u32 s28, s28, 6148
s_lshl_b32 s26, s21, 16
s_add_u32 s26, s26, s30
s_add_u32 s26, s26, 33554432
s_lshl_b32 s76, s20, 3
s_add_u32 s76, s76, s21
s_lshl_b32 s76, s76, 2
s_add_u32 s76, s76, s3
s_lshl_b32 s27, s76, 10
s_add_u32 s27, s27, 75497472
s_lshl_b32 s76, s76, 14
s_add_u32 s76, s76, 67108864
s_lshl_b32 s81, s20, 2
s_add_u32 s81, s81, s3
s_mul_i32 s81, s81, 57344
s_cmp_eq_u32 s24, 1
s_cselect_b32 s80, s28, s70
s_add_u32 s77, s76, 8192
v_lshrrev_b32 v8, 7, v1
v_and_b32 v9, 6, v8
v_lshlrev_b32 v9, 4, v9
v_and_b32 v10, 0x70, v1
v_xor_b32 v9, v9, v10
v_mul_u32_u24 v8, 896, v8
v_add_u32 v8, v8, v9
v_accvgpr_write_b32 a184, v8
v_add_u32 v8, 6144, v8
v_accvgpr_write_b32 a185, v8
v_add_u32 v8, 6144, v8
v_accvgpr_write_b32 a186, v8
v_add_u32 v8, 6144, v8
v_accvgpr_write_b32 a187, v8
v_lshrrev_b32 v8, 6, v1
v_bfe_u32 v9, v1, 7, 2
v_lshlrev_b32 v9, 5, v9
v_lshl_add_u32 v8, v8, 7, v9
v_bfe_u32 v9, v1, 4, 2
v_lshl_add_u32 v8, v9, 3, v8
v_add_u32 v8, 32768, v8
v_accvgpr_write_b32 a188, v8
v_xor_b32 v9, 32, v8
v_accvgpr_write_b32 a189, v9
v_xor_b32 v9, 64, v8
v_accvgpr_write_b32 a190, v9
v_xor_b32 v9, 96, v8
v_accvgpr_write_b32 a191, v9
s_add_u32 s22, s66, 16384
s_mov_b32 s71, 3221225472
s_waitcnt vmcnt(17)
s_barrier
buffer_store_dword v6, v5, s[4:7], s22 offen sc1
v_mov_b64 v[128:129], 0
v_mov_b64 v[130:131], 0
v_mov_b64 v[132:133], 0
v_mov_b64 v[134:135], 0
v_mov_b64 v[136:137], 0
v_mov_b64 v[138:139], 0
v_mov_b64 v[140:141], 0
v_mov_b64 v[142:143], 0
v_mov_b64 v[144:145], 0
v_mov_b64 v[146:147], 0
v_mov_b64 v[148:149], 0
v_mov_b64 v[150:151], 0
v_mov_b64 v[152:153], 0
v_mov_b64 v[154:155], 0
v_mov_b64 v[156:157], 0
v_mov_b64 v[158:159], 0
v_mov_b64 v[160:161], 0
v_mov_b64 v[162:163], 0
v_mov_b64 v[164:165], 0
v_mov_b64 v[166:167], 0
v_mov_b64 v[168:169], 0
v_mov_b64 v[170:171], 0
v_mov_b64 v[172:173], 0
v_mov_b64 v[174:175], 0
v_mov_b64 v[176:177], 0
v_mov_b64 v[178:179], 0
v_mov_b64 v[180:181], 0
v_mov_b64 v[182:183], 0
v_mov_b64 v[184:185], 0
v_mov_b64 v[186:187], 0
v_mov_b64 v[188:189], 0
v_mov_b64 v[190:191], 0
v_mov_b64 v[192:193], 0
v_mov_b64 v[194:195], 0
v_mov_b64 v[196:197], 0
v_mov_b64 v[198:199], 0
v_mov_b64 v[200:201], 0
v_mov_b64 v[202:203], 0
v_mov_b64 v[204:205], 0
v_mov_b64 v[206:207], 0
v_mov_b64 v[208:209], 0
v_mov_b64 v[210:211], 0
v_mov_b64 v[212:213], 0
v_mov_b64 v[214:215], 0
v_mov_b64 v[216:217], 0
v_mov_b64 v[218:219], 0
v_mov_b64 v[220:221], 0
v_mov_b64 v[222:223], 0
v_mov_b64 v[224:225], 0
v_mov_b64 v[226:227], 0
v_mov_b64 v[228:229], 0
v_mov_b64 v[230:231], 0
v_mov_b64 v[232:233], 0
v_mov_b64 v[234:235], 0
v_mov_b64 v[236:237], 0
v_mov_b64 v[238:239], 0
v_mov_b64 v[240:241], 0
v_mov_b64 v[242:243], 0
v_mov_b64 v[244:245], 0
v_mov_b64 v[246:247], 0
v_mov_b64 v[248:249], 0
v_mov_b64 v[250:251], 0
v_mov_b64 v[252:253], 0
v_mov_b64 v[254:255], 0
v_mov_b64 v[24:25], 0
s_waitcnt vmcnt(9) lgkmcnt(0)
v_cmp_gt_u32 vcc, 1, v21
s_cbranch_vccnz M_vspin
M_vok:
s_barrier
K2_item:
s_cmp_eq_u32 s19, 0
s_cbranch_scc1 K2_p0d
ds_read_b128 a[64:67], v1 offset:0
ds_read_b128 a[68:71], v1 offset:1024
ds_read_b128 a[72:75], v1 offset:2048
ds_read_b128 a[76:79], v1 offset:3072
ds_read_b128 a[80:83], v1 offset:4096
ds_read_b128 a[84:87], v1 offset:5120
ds_read_b128 a[88:91], v1 offset:6144
ds_read_b128 a[92:95], v1 offset:7168
s_waitcnt lgkmcnt(7)
v_mfma_f32_16x16x32_bf16 v[32:35], a[64:67], a[0:3], 0
s_waitcnt lgkmcnt(6)
s_add_u32 m0, s18, 65536
ds_read_b128 a[96:99], v1 offset:8192
v_mfma_f32_16x16x32_bf16 v[32:35], a[68:71], a[4:7], v[32:35]
s_waitcnt lgkmcnt(6)
buffer_load_dwordx4 v1, s[4:7], s12 offen offset:0 sc1 lds
v_mfma_f32_16x16x32_bf16 v[32:35], a[72:75], a[8:11], v[32:35]
s_waitcnt lgkmcnt(5)
ds_read_b128 a[100:103], v1 offset:9216
v_mfma_f32_16x16x32_bf16 v[32:35], a[76:79], a[12:15], v[32:35]
s_waitcnt lgkmcnt(5)
buffer_load_dwordx4 v1, s[4:7], s12 offen offset:1024 sc1 lds
v_mfma_f32_16x16x32_bf16 v[32:35], a[80:83], a[16:19], v[32:35]
s_waitcnt lgkmcnt(4)
ds_read_b128 a[104:107], v1 offset:10240
v_mfma_f32_16x16x32_bf16 v[32:35], a[84:87], a[20:23], v[32:35]
s_waitcnt lgkmcnt(4)
buffer_load_dwordx4 v1, s[4:7], s12 offen offset:2048 sc1 lds
v_mfma_f32_16x16x32_bf16 v[32:35], a[88:91], a[24:27], v[32:35]
s_waitcnt lgkmcnt(3)
ds_read_b128 a[108:111], v1 offset:11264
v_mfma_f32_16x16x32_bf16 v[32:35], a[92:95], a[28:31], v[32:35]
buffer_load_dwordx4 v1, s[4:7], s12 offen offset:3072 sc1 lds
v_mfma_f32_16x16x32_bf16 v[36:39], a[64:67], a[32:35], 0
s_add_u32 s12, s12, 4096
s_add_u32 m0, s18, 69632
ds_read_b128 a[112:115], v1 offset:12288
v_mfma_f32_16x16x32_bf16 v[36:39], a[68:71], a[36:39], v[36:39]
buffer_load_dwordx4 v1, s[4:7], s12 offen offset:0 sc1 lds
v_mfma_f32_16x16x32_bf16 v[36:39], a[72:75], a[40:43], v[36:39]
ds_read_b128 a[116:119], v1 offset:13312
v_mfma_f32_16x16x32_bf16 v[36:39], a[76:79], a[44:47], v[36:39]
buffer_load_dwordx4 v1, s[4:7], s12 offen offset:1024 sc1 lds
v_mfma_f32_16x16x32_bf16 v[36:39], a[80:83], a[48:51], v[36:39]
ds_read_b128 a[120:123], v1 offset:14336
v_max3_f32 v28, v32, v33, v34
v_mfma_f32_16x16x32_bf16 v[36:39], a[84:87], a[52:55], v[36:39]
buffer_load_dwordx4 v1, s[4:7], s12 offen offset:2048 sc1 lds
v_mfma_f32_16x16x32_bf16 v[36:39], a[88:91], a[56:59], v[36:39]
ds_read_b128 a[124:127], v1 offset:15360
v_max_f32 v28, v28, v35
v_mfma_f32_16x16x32_bf16 v[36:39], a[92:95], a[60:63], v[36:39]
s_waitcnt lgkmcnt(6)
buffer_load_dwordx4 v1, s[4:7], s12 offen offset:3072 sc1 lds
v_mfma_f32_16x16x32_bf16 v[40:43], a[96:99], a[0:3], 0
s_add_u32 s12, s12, 28672
ds_read_b128 a[64:67], v1 offset:16384
v_mov_b32 v30, v28
v_mfma_f32_16x16x32_bf16 v[40:43], a[100:103], a[4:7], v[40:43]
s_waitcnt lgkmcnt(2)
s_sub_u32 s13, s13, 1
v_mfma_f32_16x16x32_bf16 v[40:43], a[104:107], a[8:11], v[40:43]
s_cmp_eq_u32 s13, 0
ds_read_b128 a[68:71], v1 offset:17408
v_permlane16_swap_b32 v28, v30
v_mfma_f32_16x16x32_bf16 v[40:43], a[108:111], a[12:15], v[40:43]
s_cselect_b32 s12, s14, s12
v_max_f32 v28, v28, v30
v_mov_b32 v30, v28
v_mfma_f32_16x16x32_bf16 v[40:43], a[112:115], a[16:19], v[40:43]
s_cselect_b32 s13, s15, s13
ds_read_b128 a[72:75], v1 offset:18432
v_max3_f32 v29, v36, v37, v38
v_mfma_f32_16x16x32_bf16 v[40:43], a[116:119], a[20:23], v[40:43]
s_cselect_b32 s14, 3221225472, s14
v_permlane32_swap_b32 v28, v30
v_max_f32 v28, v28, v30
v_mfma_f32_16x16x32_bf16 v[40:43], a[120:123], a[24:27], v[40:43]
s_waitcnt lgkmcnt(3)
ds_read_b128 a[76:79], v1 offset:19456
v_sub_f32 v16, 0, v28
v_mfma_f32_16x16x32_bf16 v[40:43], a[124:127], a[28:31], v[40:43]
v_sub_f32 v17, 0, v28
v_sub_f32 v18, 0, v28
v_mfma_f32_16x16x32_bf16 v[44:47], a[96:99], a[32:35], 0
ds_read_b128 a[80:83], v1 offset:20480
v_sub_f32 v19, 0, v28
v_mfma_f32_16x16x32_bf16 v[44:47], a[100:103], a[36:39], v[44:47]
v_max_f32 v29, v29, v39
v_mov_b32 v31, v29
v_mfma_f32_16x16x32_bf16 v[44:47], a[104:107], a[40:43], v[44:47]
ds_read_b128 a[84:87], v1 offset:21504
v_mfma_f32_16x16x32_bf16 v[44:47], a[108:111], a[44:47], v[44:47]
v_permlane16_swap_b32 v29, v31
v_max_f32 v29, v29, v31
v_mfma_f32_16x16x32_bf16 v[44:47], a[112:115], a[48:51], v[44:47]
ds_read_b128 a[88:91], v1 offset:22528
v_mov_b32 v31, v29
v_mfma_f32_16x16x32_bf16 v[44:47], a[116:119], a[52:55], v[44:47]
v_mfma_f32_16x16x32_bf16 v[44:47], a[120:123], a[56:59], v[44:47]
ds_read_b128 a[92:95], v1 offset:23552
v_permlane32_swap_b32 v29, v31
v_mfma_f32_16x16x32_bf16 v[44:47], a[124:127], a[60:63], v[44:47]
s_waitcnt lgkmcnt(7)
v_max_f32 v29, v29, v31
v_sub_f32 v20, 0, v29
v_mfma_f32_16x16x32_bf16 v[48:51], a[64:67], a[0:3], v[16:19]
s_waitcnt lgkmcnt(6)
ds_read_b128 a[96:99], v1 offset:24576
v_sub_f32 v21, 0, v29
v_mfma_f32_16x16x32_bf16 v[48:51], a[68:71], a[4:7], v[48:51]
s_waitcnt lgkmcnt(6)
v_sub_f32 v22, 0, v29
v_sub_f32 v23, 0, v29
v_mfma_f32_16x16x32_bf16 v[48:51], a[72:75], a[8:11], v[48:51]
s_waitcnt lgkmcnt(5)
ds_read_b128 a[100:103], v1 offset:25600
v_mfma_f32_16x16x32_bf16 v[48:51], a[76:79], a[12:15], v[48:51]
s_waitcnt lgkmcnt(5)
v_mfma_f32_16x16x32_bf16 v[48:51], a[80:83], a[16:19], v[48:51]
s_waitcnt lgkmcnt(4)
ds_read_b128 a[104:107], v1 offset:26624
v_mfma_f32_16x16x32_bf16 v[48:51], a[84:87], a[20:23], v[48:51]
s_waitcnt lgkmcnt(4)
v_add_f32 v32, v32, v16
v_add_f32 v33, v33, v16
v_add_f32 v34, v34, v16
v_add_f32 v35, v35, v16
v_mfma_f32_16x16x32_bf16 v[48:51], a[88:91], a[24:27], v[48:51]
s_waitcnt lgkmcnt(3)
ds_read_b128 a[108:111], v1 offset:27648
v_add_f32 v36, v36, v20
v_add_f32 v37, v37, v20
v_add_f32 v38, v38, v20
v_add_f32 v39, v39, v20
v_mfma_f32_16x16x32_bf16 v[48:51], a[92:95], a[28:31], v[48:51]
v_add_f32 v40, v40, v16
v_add_f32 v41, v41, v16
v_add_f32 v42, v42, v16
v_add_f32 v43, v43, v16
v_mfma_f32_16x16x32_bf16 v[52:55], a[64:67], a[32:35], v[20:23]
ds_read_b128 a[112:115], v1 offset:28672
v_add_f32 v44, v44, v20
v_add_f32 v45, v45, v20
v_add_f32 v46, v46, v20
v_add_f32 v47, v47, v20
v_mfma_f32_16x16x32_bf16 v[52:55], a[68:71], a[36:39], v[52:55]
v_exp_f32 v8, v32
v_mfma_f32_16x16x32_bf16 v[52:55], a[72:75], a[40:43], v[52:55]
ds_read_b128 a[116:119], v1 offset:29696
v_exp_f32 v9, v33
v_mfma_f32_16x16x32_bf16 v[52:55], a[76:79], a[44:47], v[52:55]
v_exp_f32 v10, v34
v_mfma_f32_16x16x32_bf16 v[52:55], a[80:83], a[48:51], v[52:55]
ds_read_b128 a[120:123], v1 offset:30720
v_exp_f32 v11, v35
v_mfma_f32_16x16x32_bf16 v[52:55], a[84:87], a[52:55], v[52:55]
v_exp_f32 v12, v36
v_mfma_f32_16x16x32_bf16 v[52:55], a[88:91], a[56:59], v[52:55]
ds_read_b128 a[124:127], v1 offset:31744
v_exp_f32 v13, v37
v_mfma_f32_16x16x32_bf16 v[52:55], a[92:95], a[60:63], v[52:55]
s_waitcnt vmcnt(8) lgkmcnt(7)
s_barrier
v_add_f32 v26, v8, v9
v_cvt_pk_bf16_f32 v96, v8, v9
v_add_f32 v26, v26, v10
v_add_f32 v26, v26, v11
v_cvt_pk_bf16_f32 v97, v10, v11
v_add_f32 v27, v12, v13
v_cvt_pk_bf16_f32 v104, v12, v13
v_mfma_f32_16x16x32_bf16 v[56:59], a[96:99], a[0:3], v[16:19]
s_waitcnt lgkmcnt(6)
ds_read_b128 a[64:67], v4 offset:0
v_exp_f32 v14, v38
v_mfma_f32_16x16x32_bf16 v[56:59], a[100:103], a[4:7], v[56:59]
s_waitcnt lgkmcnt(6)
buffer_store_dword v6, v5, s[4:7], s71 offen sc1
v_add_f32 v27, v27, v14
v_mfma_f32_16x16x32_bf16 v[56:59], a[104:107], a[8:11], v[56:59]
s_waitcnt lgkmcnt(5)
ds_read_b128 a[68:71], v4 offset:1024
v_exp_f32 v15, v39
v_mfma_f32_16x16x32_bf16 v[56:59], a[108:111], a[12:15], v[56:59]
s_waitcnt lgkmcnt(5)
v_exp_f32 v8, v40
v_mfma_f32_16x16x32_bf16 v[56:59], a[112:115], a[16:19], v[56:59]
s_waitcnt lgkmcnt(4)
ds_read_b128 a[72:75], v4 offset:2048
v_exp_f32 v9, v41
v_mfma_f32_16x16x32_bf16 v[56:59], a[116:119], a[20:23], v[56:59]
s_waitcnt lgkmcnt(4)
v_exp_f32 v10, v42
v_mfma_f32_16x16x32_bf16 v[56:59], a[120:123], a[24:27], v[56:59]
s_waitcnt lgkmcnt(3)
ds_read_b128 a[76:79], v4 offset:3072
v_add_f32 v27, v27, v15
v_cvt_pk_bf16_f32 v105, v14, v15
v_add_f32 v26, v26, v8
v_add_f32 v26, v26, v9
v_cvt_pk_bf16_f32 v98, v8, v9
v_add_f32 v26, v26, v10
v_mfma_f32_16x16x32_bf16 v[56:59], a[124:127], a[28:31], v[56:59]
v_exp_f32 v11, v43
v_mfma_f32_16x16x32_bf16 v[60:63], a[96:99], a[32:35], v[20:23]
ds_read_b128 a[80:83], v4 offset:4096
v_exp_f32 v12, v44
v_mfma_f32_16x16x32_bf16 v[60:63], a[100:103], a[36:39], v[60:63]
v_exp_f32 v13, v45
v_mfma_f32_16x16x32_bf16 v[60:63], a[104:107], a[40:43], v[60:63]
ds_read_b128 a[84:87], v4 offset:5120
v_exp_f32 v14, v46
v_mfma_f32_16x16x32_bf16 v[60:63], a[108:111], a[44:47], v[60:63]
v_exp_f32 v15, v47
v_mfma_f32_16x16x32_bf16 v[60:63], a[112:115], a[48:51], v[60:63]
ds_read_b128 a[88:91], v4 offset:6144
v_add_f32 v26, v26, v11
v_cvt_pk_bf16_f32 v99, v10, v11
v_mfma_f32_16x16x32_bf16 v[60:63], a[116:119], a[52:55], v[60:63]
v_add_f32 v27, v27, v12
v_add_f32 v27, v27, v13
v_cvt_pk_bf16_f32 v106, v12, v13
v_mfma_f32_16x16x32_bf16 v[60:63], a[120:123], a[56:59], v[60:63]
s_waitcnt lgkmcnt(7)
s_barrier
ds_read_b128 a[92:95], v4 offset:7168
v_mfma_f32_16x16x32_bf16 v[60:63], a[124:127], a[60:63], v[60:63]
s_waitcnt lgkmcnt(7)
v_add_f32 v27, v27, v14
v_add_f32 v27, v27, v15
v_cvt_pk_bf16_f32 v107, v14, v15
s_branch K2_x1
.p2align 6
K2_loop:
v_mfma_f32_16x16x32_bf16 v[128:131], a[64:67], v[96:99], v[128:131]
s_add_u32 m0, s18, 98304
ds_read_b128 a[96:99], v2 offset:8192
v_add_f32 v24, v24, v26
v_mfma_f32_16x16x32_bf16 v[128:131], a[68:71], v[100:103], v[128:131]
buffer_load_dwordx4 v1, s[4:7], s12 offen offset:0 sc1 lds
v_mfma_f32_16x16x32_bf16 v[132:135], a[68:71], v[108:111], v[132:135]
ds_read_b128 a[100:103], v2 offset:9216
v_add_f32 v25, v25, v27
v_mfma_f32_16x16x32_bf16 v[132:135], a[64:67], v[104:107], v[132:135]
s_waitcnt lgkmcnt(7)
v_exp_f32 v8, v64
v_mfma_f32_16x16x32_bf16 v[136:139], a[72:75], v[96:99], v[136:139]
s_waitcnt lgkmcnt(6)
ds_read_b128 a[104:107], v2 offset:10240
v_mfma_f32_16x16x32_bf16 v[136:139], a[76:79], v[100:103], v[136:139]
buffer_load_dwordx4 v1, s[4:7], s12 offen offset:1024 sc1 lds
v_mfma_f32_16x16x32_bf16 v[140:143], a[76:79], v[108:111], v[140:143]
ds_read_b128 a[108:111], v2 offset:11264
v_mfma_f32_16x16x32_bf16 v[140:143], a[72:75], v[104:107], v[140:143]
s_waitcnt lgkmcnt(7)
v_exp_f32 v9, v65
v_mfma_f32_16x16x32_bf16 v[144:147], a[80:83], v[96:99], v[144:147]
s_waitcnt lgkmcnt(6)
ds_read_b128 a[112:115], v2 offset:12288
v_add_f32 v26, v8, v9
v_mfma_f32_16x16x32_bf16 v[144:147], a[84:87], v[100:103], v[144:147]
buffer_load_dwordx4 v1, s[4:7], s12 offen offset:2048 sc1 lds
v_mfma_f32_16x16x32_bf16 v[148:151], a[84:87], v[108:111], v[148:151]
ds_read_b128 a[116:119], v2 offset:13312
v_cvt_pk_bf16_f32 v112, v8, v9
v_mfma_f32_16x16x32_bf16 v[148:151], a[80:83], v[104:107], v[148:151]
s_waitcnt lgkmcnt(7)
v_exp_f32 v10, v66
v_mfma_f32_16x16x32_bf16 v[152:155], a[88:91], v[96:99], v[152:155]
s_waitcnt lgkmcnt(6)
ds_read_b128 a[120:123], v2 offset:14336
v_add_f32 v26, v26, v10
v_mfma_f32_16x16x32_bf16 v[152:155], a[92:95], v[100:103], v[152:155]
buffer_load_dwordx4 v1, s[4:7], s12 offen offset:3072 sc1 lds
v_mfma_f32_16x16x32_bf16 v[156:159], a[92:95], v[108:111], v[156:159]
s_add_u32 s12, s12, 4096
ds_read_b128 a[124:127], v2 offset:15360
v_mfma_f32_16x16x32_bf16 v[156:159], a[88:91], v[104:107], v[156:159]
s_waitcnt lgkmcnt(6)
v_exp_f32 v11, v67
v_mfma_f32_16x16x32_bf16 v[160:163], a[96:99], v[96:99], v[160:163]
s_add_u32 m0, s18, 102400
ds_read_b128 a[64:67], v2 offset:16384
v_add_f32 v26, v26, v11
v_mfma_f32_16x16x32_bf16 v[160:163], a[100:103], v[100:103], v[160:163]
buffer_load_dwordx4 v1, s[4:7], s12 offen offset:0 sc1 lds
v_mfma_f32_16x16x32_bf16 v[164:167], a[100:103], v[108:111], v[164:167]
ds_read_b128 a[68:71], v2 offset:17408
v_cvt_pk_bf16_f32 v113, v10, v11
v_mfma_f32_16x16x32_bf16 v[164:167], a[96:99], v[104:107], v[164:167]
s_waitcnt lgkmcnt(7)
v_mfma_f32_16x16x32_bf16 v[168:171], a[104:107], v[96:99], v[168:171]
s_waitcnt lgkmcnt(6)
ds_read_b128 a[72:75], v2 offset:18432
v_mfma_f32_16x16x32_bf16 v[168:171], a[108:111], v[100:103], v[168:171]
buffer_load_dwordx4 v1, s[4:7], s12 offen offset:1024 sc1 lds
v_mfma_f32_16x16x32_bf16 v[172:175], a[108:111], v[108:111], v[172:175]
ds_read_b128 a[76:79], v2 offset:19456
v_mfma_f32_16x16x32_bf16 v[172:175], a[104:107], v[104:107], v[172:175]
s_waitcnt lgkmcnt(7)
v_exp_f32 v12, v68
v_mfma_f32_16x16x32_bf16 v[176:179], a[112:115], v[96:99], v[176:179]
s_waitcnt lgkmcnt(6)
ds_read_b128 a[80:83], v2 offset:20480
v_mfma_f32_16x16x32_bf16 v[176:179], a[116:119], v[100:103], v[176:179]
buffer_load_dwordx4 v1, s[4:7], s12 offen offset:2048 sc1 lds
v_mfma_f32_16x16x32_bf16 v[180:183], a[116:119], v[108:111], v[180:183]
ds_read_b128 a[84:87], v2 offset:21504
v_mfma_f32_16x16x32_bf16 v[180:183], a[112:115], v[104:107], v[180:183]
s_waitcnt lgkmcnt(7)
v_exp_f32 v13, v69
v_mfma_f32_16x16x32_bf16 v[184:187], a[120:123], v[96:99], v[184:187]
s_waitcnt lgkmcnt(6)
ds_read_b128 a[88:91], v2 offset:22528
v_add_f32 v27, v12, v13
v_mfma_f32_16x16x32_bf16 v[184:187], a[124:127], v[100:103], v[184:187]
s_waitcnt lgkmcnt(5)
buffer_load_dwordx4 v1, s[4:7], s12 offen offset:3072 sc1 lds
v_mfma_f32_16x16x32_bf16 v[188:191], a[124:127], v[108:111], v[188:191]
s_add_u32 s12, s12, 28672
ds_read_b128 a[92:95], v2 offset:23552
v_cvt_pk_bf16_f32 v120, v12, v13
v_mfma_f32_16x16x32_bf16 v[188:191], a[120:123], v[104:107], v[188:191]
s_sub_u32 s13, s13, 1
v_exp_f32 v14, v70
v_mfma_f32_16x16x32_bf16 v[192:195], a[64:67], v[96:99], v[192:195]
s_cmp_eq_u32 s13, 0
ds_read_b128 a[96:99], v2 offset:24576
v_add_f32 v27, v27, v14
v_mfma_f32_16x16x32_bf16 v[192:195], a[68:71], v[100:103], v[192:195]
s_cselect_b32 s12, s14, s12
v_mfma_f32_16x16x32_bf16 v[196:199], a[68:71], v[108:111], v[196:199]
s_waitcnt lgkmcnt(6)
s_cselect_b32 s13, s15, s13
ds_read_b128 a[100:103], v2 offset:25600
v_mfma_f32_16x16x32_bf16 v[196:199], a[64:67], v[104:107], v[196:199]
s_cselect_b32 s14, 3221225472, s14
v_exp_f32 v15, v71
v_mfma_f32_16x16x32_bf16 v[200:203], a[72:75], v[96:99], v[200:203]
s_waitcnt lgkmcnt(6)
ds_read_b128 a[104:107], v2 offset:26624
v_add_f32 v27, v27, v15
v_mfma_f32_16x16x32_bf16 v[200:203], a[76:79], v[100:103], v[200:203]
v_exp_f32 v8, v72
v_mfma_f32_16x16x32_bf16 v[204:207], a[76:79], v[108:111], v[204:207]
ds_read_b128 a[108:111], v2 offset:27648
v_cvt_pk_bf16_f32 v121, v14, v15
v_mfma_f32_16x16x32_bf16 v[204:207], a[72:75], v[104:107], v[204:207]
s_waitcnt lgkmcnt(7)
v_exp_f32 v9, v73
v_mfma_f32_16x16x32_bf16 v[208:211], a[80:83], v[96:99], v[208:211]
s_waitcnt lgkmcnt(6)
ds_read_b128 a[112:115], v2 offset:28672
v_add_f32 v26, v26, v8
v_mfma_f32_16x16x32_bf16 v[208:211], a[84:87], v[100:103], v[208:211]
v_add_f32 v26, v26, v9
v_cvt_pk_bf16_f32 v114, v8, v9
v_mfma_f32_16x16x32_bf16 v[212:215], a[84:87], v[108:111], v[212:215]
ds_read_b128 a[116:119], v2 offset:29696
v_mfma_f32_16x16x32_bf16 v[212:215], a[80:83], v[104:107], v[212:215]
s_waitcnt lgkmcnt(7)
v_exp_f32 v10, v74
v_mfma_f32_16x16x32_bf16 v[216:219], a[88:91], v[96:99], v[216:219]
s_waitcnt lgkmcnt(6)
ds_read_b128 a[120:123], v2 offset:30720
v_add_f32 v26, v26, v10
v_mfma_f32_16x16x32_bf16 v[216:219], a[92:95], v[100:103], v[216:219]
v_exp_f32 v11, v75
v_mfma_f32_16x16x32_bf16 v[220:223], a[92:95], v[108:111], v[220:223]
ds_read_b128 a[124:127], v2 offset:31744
v_add_f32 v26, v26, v11
v_mfma_f32_16x16x32_bf16 v[220:223], a[88:91], v[104:107], v[220:223]
s_waitcnt vmcnt(8) lgkmcnt(7)
s_barrier
v_cvt_pk_bf16_f32 v115, v10, v11
v_mfma_f32_16x16x32_bf16 v[224:227], a[96:99], v[96:99], v[224:227]
s_waitcnt lgkmcnt(6)
ds_read_b128 a[64:67], v1 offset:0
v_mfma_f32_16x16x32_bf16 v[224:227], a[100:103], v[100:103], v[224:227]
v_exp_f32 v12, v76
v_mfma_f32_16x16x32_bf16 v[228:231], a[100:103], v[108:111], v[228:231]
ds_read_b128 a[68:71], v1 offset:1024
v_add_f32 v27, v27, v12
v_mfma_f32_16x16x32_bf16 v[228:231], a[96:99], v[104:107], v[228:231]
s_waitcnt lgkmcnt(7)
v_mfma_f32_16x16x32_bf16 v[232:235], a[104:107], v[96:99], v[232:235]
s_waitcnt lgkmcnt(6)
ds_read_b128 a[72:75], v1 offset:2048
v_mfma_f32_16x16x32_bf16 v[232:235], a[108:111], v[100:103], v[232:235]
v_exp_f32 v13, v77
v_mfma_f32_16x16x32_bf16 v[236:239], a[108:111], v[108:111], v[236:239]
ds_read_b128 a[76:79], v1 offset:3072
v_add_f32 v27, v27, v13
v_mfma_f32_16x16x32_bf16 v[236:239], a[104:107], v[104:107], v[236:239]
s_waitcnt lgkmcnt(7)
v_exp_f32 v14, v78
v_mfma_f32_16x16x32_bf16 v[240:243], a[112:115], v[96:99], v[240:243]
s_waitcnt lgkmcnt(6)
ds_read_b128 a[80:83], v1 offset:4096
v_cvt_pk_bf16_f32 v122, v12, v13
v_mfma_f32_16x16x32_bf16 v[240:243], a[116:119], v[100:103], v[240:243]
v_exp_f32 v15, v79
v_mfma_f32_16x16x32_bf16 v[244:247], a[116:119], v[108:111], v[244:247]
ds_read_b128 a[84:87], v1 offset:5120
v_add_f32 v27, v27, v14
v_mfma_f32_16x16x32_bf16 v[244:247], a[112:115], v[104:107], v[244:247]
s_waitcnt lgkmcnt(7)
v_add_f32 v27, v27, v15
v_cvt_pk_bf16_f32 v123, v14, v15
v_mfma_f32_16x16x32_bf16 v[248:251], a[120:123], v[96:99], v[248:251]
s_waitcnt lgkmcnt(6)
ds_read_b128 a[88:91], v1 offset:6144
v_mfma_f32_16x16x32_bf16 v[248:251], a[124:127], v[100:103], v[248:251]
v_mfma_f32_16x16x32_bf16 v[252:255], a[124:127], v[108:111], v[252:255]
ds_read_b128 a[92:95], v1 offset:7168
v_mfma_f32_16x16x32_bf16 v[252:255], a[120:123], v[104:107], v[252:255]
s_waitcnt lgkmcnt(7)
v_mfma_f32_16x16x32_bf16 v[32:35], a[64:67], a[0:3], v[16:19]
s_waitcnt lgkmcnt(6)
s_add_u32 m0, s18, 131072
ds_read_b128 a[96:99], v1 offset:8192
v_mfma_f32_16x16x32_bf16 v[32:35], a[68:71], a[4:7], v[32:35]
s_waitcnt lgkmcnt(6)
buffer_load_dwordx4 v1, s[4:7], s8 offen offset:0 sc1 lds
v_mfma_f32_16x16x32_bf16 v[32:35], a[72:75], a[8:11], v[32:35]
s_waitcnt lgkmcnt(5)
ds_read_b128 a[100:103], v1 offset:9216
v_mfma_f32_16x16x32_bf16 v[32:35], a[76:79], a[12:15], v[32:35]
s_waitcnt lgkmcnt(5)
v_exp_f32 v8, v80
v_mfma_f32_16x16x32_bf16 v[32:35], a[80:83], a[16:19], v[32:35]
s_waitcnt lgkmcnt(4)
ds_read_b128 a[104:107], v1 offset:10240
v_add_f32 v26, v26, v8
v_mfma_f32_16x16x32_bf16 v[32:35], a[84:87], a[20:23], v[32:35]
s_waitcnt lgkmcnt(4)
buffer_load_dwordx4 v1, s[4:7], s8 offen offset:1024 sc1 lds
v_mfma_f32_16x16x32_bf16 v[32:35], a[88:91], a[24:27], v[32:35]
s_waitcnt lgkmcnt(3)
ds_read_b128 a[108:111], v1 offset:11264
v_mfma_f32_16x16x32_bf16 v[32:35], a[92:95], a[28:31], v[32:35]
v_exp_f32 v9, v81
v_mfma_f32_16x16x32_bf16 v[36:39], a[64:67], a[32:35], v[20:23]
ds_read_b128 a[112:115], v1 offset:12288
v_add_f32 v26, v26, v9
v_mfma_f32_16x16x32_bf16 v[36:39], a[68:71], a[36:39], v[36:39]
buffer_load_dwordx4 v1, s[4:7], s8 offen offset:2048 sc1 lds
v_mfma_f32_16x16x32_bf16 v[36:39], a[72:75], a[40:43], v[36:39]
ds_read_b128 a[116:119], v1 offset:13312
v_cvt_pk_bf16_f32 v116, v8, v9
v_mfma_f32_16x16x32_bf16 v[36:39], a[76:79], a[44:47], v[36:39]
v_exp_f32 v10, v82
v_mfma_f32_16x16x32_bf16 v[36:39], a[80:83], a[48:51], v[36:39]
ds_read_b128 a[120:123], v1 offset:14336
v_add_f32 v26, v26, v10
v_mfma_f32_16x16x32_bf16 v[36:39], a[84:87], a[52:55], v[36:39]
buffer_load_dwordx4 v1, s[4:7], s8 offen offset:3072 sc1 lds
v_mfma_f32_16x16x32_bf16 v[36:39], a[88:91], a[56:59], v[36:39]
s_add_u32 s8, s8, 4096
ds_read_b128 a[124:127], v1 offset:15360
v_mfma_f32_16x16x32_bf16 v[36:39], a[92:95], a[60:63], v[36:39]
s_waitcnt lgkmcnt(6)
v_exp_f32 v11, v83
v_mfma_f32_16x16x32_bf16 v[40:43], a[96:99], a[0:3], v[16:19]
s_add_u32 m0, s18, 135168
ds_read_b128 a[64:67], v1 offset:16384
v_add_f32 v26, v26, v11
v_mfma_f32_16x16x32_bf16 v[40:43], a[100:103], a[4:7], v[40:43]
s_waitcnt lgkmcnt(6)
buffer_load_dwordx4 v1, s[4:7], s8 offen offset:0 sc1 lds
v_mfma_f32_16x16x32_bf16 v[40:43], a[104:107], a[8:11], v[40:43]
s_waitcnt lgkmcnt(5)
ds_read_b128 a[68:71], v1 offset:17408
v_cvt_pk_bf16_f32 v117, v10, v11
v_mfma_f32_16x16x32_bf16 v[40:43], a[108:111], a[12:15], v[40:43]
s_waitcnt lgkmcnt(5)
v_mfma_f32_16x16x32_bf16 v[40:43], a[112:115], a[16:19], v[40:43]
s_waitcnt lgkmcnt(4)
ds_read_b128 a[72:75], v1 offset:18432
v_mfma_f32_16x16x32_bf16 v[40:43], a[116:119], a[20:23], v[40:43]
s_waitcnt lgkmcnt(4)
buffer_load_dwordx4 v1, s[4:7], s8 offen offset:1024 sc1 lds
v_mfma_f32_16x16x32_bf16 v[40:43], a[120:123], a[24:27], v[40:43]
s_waitcnt lgkmcnt(3)
ds_read_b128 a[76:79], v1 offset:19456
v_mfma_f32_16x16x32_bf16 v[40:43], a[124:127], a[28:31], v[40:43]
v_exp_f32 v12, v84
v_mfma_f32_16x16x32_bf16 v[44:47], a[96:99], a[32:35], v[20:23]
ds_read_b128 a[80:83], v1 offset:20480
v_add_f32 v27, v27, v12
v_mfma_f32_16x16x32_bf16 v[44:47], a[100:103], a[36:39], v[44:47]
buffer_load_dwordx4 v1, s[4:7], s8 offen offset:2048 sc1 lds
v_mfma_f32_16x16x32_bf16 v[44:47], a[104:107], a[40:43], v[44:47]
ds_read_b128 a[84:87], v1 offset:21504
v_mfma_f32_16x16x32_bf16 v[44:47], a[108:111], a[44:47], v[44:47]
v_exp_f32 v13, v85
v_mfma_f32_16x16x32_bf16 v[44:47], a[112:115], a[48:51], v[44:47]
ds_read_b128 a[88:91], v1 offset:22528
v_add_f32 v27, v27, v13
v_mfma_f32_16x16x32_bf16 v[44:47], a[116:119], a[52:55], v[44:47]
s_waitcnt lgkmcnt(3)
buffer_load_dwordx4 v1, s[4:7], s8 offen offset:3072 sc1 lds
v_mfma_f32_16x16x32_bf16 v[44:47], a[120:123], a[56:59], v[44:47]
s_add_u32 s8, s8, 28672
ds_read_b128 a[92:95], v1 offset:23552
v_cvt_pk_bf16_f32 v124, v12, v13
v_mfma_f32_16x16x32_bf16 v[44:47], a[124:127], a[60:63], v[44:47]
s_sub_u32 s9, s9, 1
v_exp_f32 v14, v86
v_mfma_f32_16x16x32_bf16 v[48:51], a[64:67], a[0:3], v[16:19]
s_cmp_eq_u32 s9, 0
ds_read_b128 a[96:99], v1 offset:24576
v_add_f32 v27, v27, v14
v_mfma_f32_16x16x32_bf16 v[48:51], a[68:71], a[4:7], v[48:51]
s_cselect_b32 s8, s10, s8
v_exp_f32 v15, v87
v_mfma_f32_16x16x32_bf16 v[48:51], a[72:75], a[8:11], v[48:51]
s_cselect_b32 s9, s11, s9
ds_read_b128 a[100:103], v1 offset:25600
v_add_f32 v27, v27, v15
v_mfma_f32_16x16x32_bf16 v[48:51], a[76:79], a[12:15], v[48:51]
s_waitcnt lgkmcnt(5)
s_cselect_b32 s10, 3221225472, s10
v_cvt_pk_bf16_f32 v125, v14, v15
v_mfma_f32_16x16x32_bf16 v[48:51], a[80:83], a[16:19], v[48:51]
s_waitcnt lgkmcnt(4)
ds_read_b128 a[104:107], v1 offset:26624
v_mfma_f32_16x16x32_bf16 v[48:51], a[84:87], a[20:23], v[48:51]
s_waitcnt lgkmcnt(4)
v_exp_f32 v8, v88
v_mfma_f32_16x16x32_bf16 v[48:51], a[88:91], a[24:27], v[48:51]
s_waitcnt lgkmcnt(3)
ds_read_b128 a[108:111], v1 offset:27648
v_add_f32 v26, v26, v8
v_mfma_f32_16x16x32_bf16 v[48:51], a[92:95], a[28:31], v[48:51]
v_exp_f32 v9, v89
v_mfma_f32_16x16x32_bf16 v[52:55], a[64:67], a[32:35], v[20:23]
ds_read_b128 a[112:115], v1 offset:28672
v_add_f32 v26, v26, v9
v_mfma_f32_16x16x32_bf16 v[52:55], a[68:71], a[36:39], v[52:55]
v_exp_f32 v10, v90
v_mfma_f32_16x16x32_bf16 v[52:55], a[72:75], a[40:43], v[52:55]
ds_read_b128 a[116:119], v1 offset:29696
v_cvt_pk_bf16_f32 v118, v8, v9
v_mfma_f32_16x16x32_bf16 v[52:55], a[76:79], a[44:47], v[52:55]
v_exp_f32 v11, v91
v_mfma_f32_16x16x32_bf16 v[52:55], a[80:83], a[48:51], v[52:55]
ds_read_b128 a[120:123], v1 offset:30720
v_add_f32 v26, v26, v10
v_mfma_f32_16x16x32_bf16 v[52:55], a[84:87], a[52:55], v[52:55]
v_add_f32 v26, v26, v11
v_cvt_pk_bf16_f32 v119, v10, v11
v_mfma_f32_16x16x32_bf16 v[52:55], a[88:91], a[56:59], v[52:55]
ds_read_b128 a[124:127], v1 offset:31744
v_mfma_f32_16x16x32_bf16 v[52:55], a[92:95], a[60:63], v[52:55]
s_waitcnt vmcnt(8) lgkmcnt(7)
s_barrier
v_mfma_f32_16x16x32_bf16 v[56:59], a[96:99], a[0:3], v[16:19]
s_waitcnt lgkmcnt(6)
ds_read_b128 a[64:67], v2 offset:32768
v_mfma_f32_16x16x32_bf16 v[56:59], a[100:103], a[4:7], v[56:59]
s_waitcnt lgkmcnt(6)
v_exp_f32 v12, v92
v_mfma_f32_16x16x32_bf16 v[56:59], a[104:107], a[8:11], v[56:59]
s_waitcnt lgkmcnt(5)
ds_read_b128 a[68:71], v2 offset:33792
v_add_f32 v27, v27, v12
v_mfma_f32_16x16x32_bf16 v[56:59], a[108:111], a[12:15], v[56:59]
s_waitcnt lgkmcnt(5)
v_exp_f32 v13, v93
v_mfma_f32_16x16x32_bf16 v[56:59], a[112:115], a[16:19], v[56:59]
s_waitcnt lgkmcnt(4)
ds_read_b128 a[72:75], v2 offset:34816
v_add_f32 v27, v27, v13
v_mfma_f32_16x16x32_bf16 v[56:59], a[116:119], a[20:23], v[56:59]
s_waitcnt lgkmcnt(4)
v_exp_f32 v14, v94
v_mfma_f32_16x16x32_bf16 v[56:59], a[120:123], a[24:27], v[56:59]
s_waitcnt lgkmcnt(3)
ds_read_b128 a[76:79], v2 offset:35840
v_cvt_pk_bf16_f32 v126, v12, v13
v_mfma_f32_16x16x32_bf16 v[56:59], a[124:127], a[28:31], v[56:59]
v_exp_f32 v15, v95
v_mfma_f32_16x16x32_bf16 v[60:63], a[96:99], a[32:35], v[20:23]
ds_read_b128 a[80:83], v2 offset:36864
v_add_f32 v27, v27, v14
v_mfma_f32_16x16x32_bf16 v[60:63], a[100:103], a[36:39], v[60:63]
v_add_f32 v27, v27, v15
v_cvt_pk_bf16_f32 v127, v14, v15
v_mfma_f32_16x16x32_bf16 v[60:63], a[104:107], a[40:43], v[60:63]
ds_read_b128 a[84:87], v2 offset:37888
v_add_f32 v28, v26, v27
v_mfma_f32_16x16x32_bf16 v[60:63], a[108:111], a[44:47], v[60:63]
v_cmp_nge_f32 vcc, s25, v28
v_mfma_f32_16x16x32_bf16 v[60:63], a[112:115], a[48:51], v[60:63]
ds_read_b128 a[88:91], v2 offset:38912
v_mfma_f32_16x16x32_bf16 v[60:63], a[116:119], a[52:55], v[60:63]
v_mfma_f32_16x16x32_bf16 v[60:63], a[120:123], a[56:59], v[60:63]
ds_read_b128 a[92:95], v2 offset:39936
v_mfma_f32_16x16x32_bf16 v[60:63], a[124:127], a[60:63], v[60:63]
s_waitcnt lgkmcnt(6)
s_cbranch_vccnz Lstub_3
Lback_4:
v_mfma_f32_16x16x32_bf16 v[128:131], a[64:67], v[112:115], v[128:131]
s_add_u32 m0, s18, 65536
ds_read_b128 a[96:99], v2 offset:40960
v_add_f32 v24, v24, v26
v_mfma_f32_16x16x32_bf16 v[128:131], a[68:71], v[116:119], v[128:131]
buffer_load_dwordx4 v1, s[4:7], s12 offen offset:0 sc1 lds
v_mfma_f32_16x16x32_bf16 v[132:135], a[68:71], v[124:127], v[132:135]
ds_read_b128 a[100:103], v2 offset:41984
v_add_f32 v25, v25, v27
v_mfma_f32_16x16x32_bf16 v[132:135], a[64:67], v[120:123], v[132:135]
s_waitcnt lgkmcnt(7)
v_exp_f32 v8, v32
v_mfma_f32_16x16x32_bf16 v[136:139], a[72:75], v[112:115], v[136:139]
s_waitcnt lgkmcnt(6)
ds_read_b128 a[104:107], v2 offset:43008
v_mfma_f32_16x16x32_bf16 v[136:139], a[76:79], v[116:119], v[136:139]
buffer_load_dwordx4 v1, s[4:7], s12 offen offset:1024 sc1 lds
v_mfma_f32_16x16x32_bf16 v[140:143], a[76:79], v[124:127], v[140:143]
ds_read_b128 a[108:111], v2 offset:44032
v_mfma_f32_16x16x32_bf16 v[140:143], a[72:75], v[120:123], v[140:143]
s_waitcnt lgkmcnt(7)
v_exp_f32 v9, v33
v_mfma_f32_16x16x32_bf16 v[144:147], a[80:83], v[112:115], v[144:147]
s_waitcnt lgkmcnt(6)
ds_read_b128 a[112:115], v2 offset:45056
v_add_f32 v26, v8, v9
v_mfma_f32_16x16x32_bf16 v[144:147], a[84:87], v[116:119], v[144:147]
buffer_load_dwordx4 v1, s[4:7], s12 offen offset:2048 sc1 lds
v_mfma_f32_16x16x32_bf16 v[148:151], a[84:87], v[124:127], v[148:151]
ds_read_b128 a[116:119], v2 offset:46080
v_cvt_pk_bf16_f32 v96, v8, v9
v_mfma_f32_16x16x32_bf16 v[148:151], a[80:83], v[120:123], v[148:151]
s_waitcnt lgkmcnt(7)
v_exp_f32 v10, v34
v_mfma_f32_16x16x32_bf16 v[152:155], a[88:91], v[112:115], v[152:155]
s_waitcnt lgkmcnt(6)
ds_read_b128 a[120:123], v2 offset:47104
v_add_f32 v26, v26, v10
v_mfma_f32_16x16x32_bf16 v[152:155], a[92:95], v[116:119], v[152:155]
buffer_load_dwordx4 v1, s[4:7], s12 offen offset:3072 sc1 lds
v_mfma_f32_16x16x32_bf16 v[156:159], a[92:95], v[124:127], v[156:159]
s_add_u32 s12, s12, 4096
ds_read_b128 a[124:127], v2 offset:48128
v_mfma_f32_16x16x32_bf16 v[156:159], a[88:91], v[120:123], v[156:159]
s_waitcnt lgkmcnt(6)
v_exp_f32 v11, v35
v_mfma_f32_16x16x32_bf16 v[160:163], a[96:99], v[112:115], v[160:163]
s_add_u32 m0, s18, 69632
ds_read_b128 a[64:67], v2 offset:49152
v_add_f32 v26, v26, v11
v_mfma_f32_16x16x32_bf16 v[160:163], a[100:103], v[116:119], v[160:163]
buffer_load_dwordx4 v1, s[4:7], s12 offen offset:0 sc1 lds
v_mfma_f32_16x16x32_bf16 v[164:167], a[100:103], v[124:127], v[164:167]
ds_read_b128 a[68:71], v2 offset:50176
v_cvt_pk_bf16_f32 v97, v10, v11
v_mfma_f32_16x16x32_bf16 v[164:167], a[96:99], v[120:123], v[164:167]
s_waitcnt lgkmcnt(7)
v_mfma_f32_16x16x32_bf16 v[168:171], a[104:107], v[112:115], v[168:171]
s_waitcnt lgkmcnt(6)
ds_read_b128 a[72:75], v2 offset:51200
v_mfma_f32_16x16x32_bf16 v[168:171], a[108:111], v[116:119], v[168:171]
buffer_load_dwordx4 v1, s[4:7], s12 offen offset:1024 sc1 lds
v_mfma_f32_16x16x32_bf16 v[172:175], a[108:111], v[124:127], v[172:175]
ds_read_b128 a[76:79], v2 offset:52224
v_mfma_f32_16x16x32_bf16 v[172:175], a[104:107], v[120:123], v[172:175]
s_waitcnt lgkmcnt(7)
v_exp_f32 v12, v36
v_mfma_f32_16x16x32_bf16 v[176:179], a[112:115], v[112:115], v[176:179]
s_waitcnt lgkmcnt(6)
ds_read_b128 a[80:83], v2 offset:53248
v_mfma_f32_16x16x32_bf16 v[176:179], a[116:119], v[116:119], v[176:179]
buffer_load_dwordx4 v1, s[4:7], s12 offen offset:2048 sc1 lds
v_mfma_f32_16x16x32_bf16 v[180:183], a[116:119], v[124:127], v[180:183]
ds_read_b128 a[84:87], v2 offset:54272
v_mfma_f32_16x16x32_bf16 v[180:183], a[112:115], v[120:123], v[180:183]
s_waitcnt lgkmcnt(7)
v_exp_f32 v13, v37
v_mfma_f32_16x16x32_bf16 v[184:187], a[120:123], v[112:115], v[184:187]
s_waitcnt lgkmcnt(6)
ds_read_b128 a[88:91], v2 offset:55296
v_add_f32 v27, v12, v13
v_mfma_f32_16x16x32_bf16 v[184:187], a[124:127], v[116:119], v[184:187]
s_waitcnt lgkmcnt(5)
buffer_load_dwordx4 v1, s[4:7], s12 offen offset:3072 sc1 lds
v_mfma_f32_16x16x32_bf16 v[188:191], a[124:127], v[124:127], v[188:191]
s_add_u32 s12, s12, 28672
ds_read_b128 a[92:95], v2 offset:56320
v_cvt_pk_bf16_f32 v104, v12, v13
v_mfma_f32_16x16x32_bf16 v[188:191], a[120:123], v[120:123], v[188:191]
s_sub_u32 s13, s13, 1
v_exp_f32 v14, v38
v_mfma_f32_16x16x32_bf16 v[192:195], a[64:67], v[112:115], v[192:195]
s_cmp_eq_u32 s13, 0
ds_read_b128 a[96:99], v2 offset:57344
v_add_f32 v27, v27, v14
v_mfma_f32_16x16x32_bf16 v[192:195], a[68:71], v[116:119], v[192:195]
s_cselect_b32 s12, s14, s12
v_mfma_f32_16x16x32_bf16 v[196:199], a[68:71], v[124:127], v[196:199]
s_waitcnt lgkmcnt(6)
s_cselect_b32 s13, s15, s13
ds_read_b128 a[100:103], v2 offset:58368
v_mfma_f32_16x16x32_bf16 v[196:199], a[64:67], v[120:123], v[196:199]
s_cselect_b32 s14, 3221225472, s14
v_exp_f32 v15, v39
v_mfma_f32_16x16x32_bf16 v[200:203], a[72:75], v[112:115], v[200:203]
s_waitcnt lgkmcnt(6)
ds_read_b128 a[104:107], v2 offset:59392
v_add_f32 v27, v27, v15
v_mfma_f32_16x16x32_bf16 v[200:203], a[76:79], v[116:119], v[200:203]
v_exp_f32 v8, v40
v_mfma_f32_16x16x32_bf16 v[204:207], a[76:79], v[124:127], v[204:207]
ds_read_b128 a[108:111], v2 offset:60416
v_cvt_pk_bf16_f32 v105, v14, v15
v_mfma_f32_16x16x32_bf16 v[204:207], a[72:75], v[120:123], v[204:207]
s_waitcnt lgkmcnt(7)
v_exp_f32 v9, v41
v_mfma_f32_16x16x32_bf16 v[208:211], a[80:83], v[112:115], v[208:211]
s_waitcnt lgkmcnt(6)
ds_read_b128 a[112:115], v2 offset:61440
v_add_f32 v26, v26, v8
v_mfma_f32_16x16x32_bf16 v[208:211], a[84:87], v[116:119], v[208:211]
v_add_f32 v26, v26, v9
v_cvt_pk_bf16_f32 v98, v8, v9
v_mfma_f32_16x16x32_bf16 v[212:215], a[84:87], v[124:127], v[212:215]
ds_read_b128 a[116:119], v2 offset:62464
v_mfma_f32_16x16x32_bf16 v[212:215], a[80:83], v[120:123], v[212:215]
s_waitcnt lgkmcnt(7)
v_exp_f32 v10, v42
v_mfma_f32_16x16x32_bf16 v[216:219], a[88:91], v[112:115], v[216:219]
s_waitcnt lgkmcnt(6)
ds_read_b128 a[120:123], v2 offset:63488
v_add_f32 v26, v26, v10
v_mfma_f32_16x16x32_bf16 v[216:219], a[92:95], v[116:119], v[216:219]
v_exp_f32 v11, v43
v_mfma_f32_16x16x32_bf16 v[220:223], a[92:95], v[124:127], v[220:223]
ds_read_b128 a[124:127], v2 offset:64512
v_add_f32 v26, v26, v11
v_mfma_f32_16x16x32_bf16 v[220:223], a[88:91], v[120:123], v[220:223]
s_waitcnt vmcnt(8) lgkmcnt(7)
s_barrier
v_cvt_pk_bf16_f32 v99, v10, v11
v_mfma_f32_16x16x32_bf16 v[224:227], a[96:99], v[112:115], v[224:227]
s_waitcnt lgkmcnt(6)
ds_read_b128 a[64:67], v4 offset:0
v_mfma_f32_16x16x32_bf16 v[224:227], a[100:103], v[116:119], v[224:227]
v_exp_f32 v12, v44
v_mfma_f32_16x16x32_bf16 v[228:231], a[100:103], v[124:127], v[228:231]
ds_read_b128 a[68:71], v4 offset:1024
v_add_f32 v27, v27, v12
v_mfma_f32_16x16x32_bf16 v[228:231], a[96:99], v[120:123], v[228:231]
s_waitcnt lgkmcnt(7)
v_mfma_f32_16x16x32_bf16 v[232:235], a[104:107], v[112:115], v[232:235]
s_waitcnt lgkmcnt(6)
ds_read_b128 a[72:75], v4 offset:2048
v_mfma_f32_16x16x32_bf16 v[232:235], a[108:111], v[116:119], v[232:235]
v_exp_f32 v13, v45
v_mfma_f32_16x16x32_bf16 v[236:239], a[108:111], v[124:127], v[236:239]
ds_read_b128 a[76:79], v4 offset:3072
v_add_f32 v27, v27, v13
v_mfma_f32_16x16x32_bf16 v[236:239], a[104:107], v[120:123], v[236:239]
s_waitcnt lgkmcnt(7)
v_exp_f32 v14, v46
v_mfma_f32_16x16x32_bf16 v[240:243], a[112:115], v[112:115], v[240:243]
s_waitcnt lgkmcnt(6)
ds_read_b128 a[80:83], v4 offset:4096
v_cvt_pk_bf16_f32 v106, v12, v13
v_mfma_f32_16x16x32_bf16 v[240:243], a[116:119], v[116:119], v[240:243]
v_exp_f32 v15, v47
v_mfma_f32_16x16x32_bf16 v[244:247], a[116:119], v[124:127], v[244:247]
ds_read_b128 a[84:87], v4 offset:5120
v_add_f32 v27, v27, v14
v_mfma_f32_16x16x32_bf16 v[244:247], a[112:115], v[120:123], v[244:247]
s_waitcnt lgkmcnt(7)
v_add_f32 v27, v27, v15
v_cvt_pk_bf16_f32 v107, v14, v15
v_mfma_f32_16x16x32_bf16 v[248:251], a[120:123], v[112:115], v[248:251]
s_waitcnt lgkmcnt(6)
ds_read_b128 a[88:91], v4 offset:6144
v_mfma_f32_16x16x32_bf16 v[248:251], a[124:127], v[116:119], v[248:251]
v_mfma_f32_16x16x32_bf16 v[252:255], a[124:127], v[124:127], v[252:255]
ds_read_b128 a[92:95], v4 offset:7168
v_mfma_f32_16x16x32_bf16 v[252:255], a[120:123], v[120:123], v[252:255]
s_waitcnt lgkmcnt(7)
K2_x1:
v_mfma_f32_16x16x32_bf16 v[64:67], a[64:67], a[0:3], v[16:19]
s_waitcnt lgkmcnt(6)
s_add_u32 m0, s18, 0
ds_read_b128 a[96:99], v4 offset:8192
v_mfma_f32_16x16x32_bf16 v[64:67], a[68:71], a[4:7], v[64:67]
s_waitcnt lgkmcnt(6)
buffer_load_dwordx4 v1, s[4:7], s8 offen offset:0 sc1 lds
v_mfma_f32_16x16x32_bf16 v[64:67], a[72:75], a[8:11], v[64:67]
s_waitcnt lgkmcnt(5)
ds_read_b128 a[100:103], v4 offset:9216
v_mfma_f32_16x16x32_bf16 v[64:67], a[76:79], a[12:15], v[64:67]
s_waitcnt lgkmcnt(5)
v_exp_f32 v8, v48
v_mfma_f32_16x16x32_bf16 v[64:67], a[80:83], a[16:19], v[64:67]
s_waitcnt lgkmcnt(4)
ds_read_b128 a[104:107], v4 offset:10240
v_add_f32 v26, v26, v8
v_mfma_f32_16x16x32_bf16 v[64:67], a[84:87], a[20:23], v[64:67]
s_waitcnt lgkmcnt(4)
buffer_load_dwordx4 v1, s[4:7], s8 offen offset:1024 sc1 lds
v_mfma_f32_16x16x32_bf16 v[64:67], a[88:91], a[24:27], v[64:67]
s_waitcnt lgkmcnt(3)
ds_read_b128 a[108:111], v4 offset:11264
v_mfma_f32_16x16x32_bf16 v[64:67], a[92:95], a[28:31], v[64:67]
v_exp_f32 v9, v49
v_mfma_f32_16x16x32_bf16 v[68:71], a[64:67], a[32:35], v[20:23]
ds_read_b128 a[112:115], v4 offset:12288
v_add_f32 v26, v26, v9
v_mfma_f32_16x16x32_bf16 v[68:71], a[68:71], a[36:39], v[68:71]
buffer_load_dwordx4 v1, s[4:7], s8 offen offset:2048 sc1 lds
v_mfma_f32_16x16x32_bf16 v[68:71], a[72:75], a[40:43], v[68:71]
ds_read_b128 a[116:119], v4 offset:13312
v_cvt_pk_bf16_f32 v100, v8, v9
v_mfma_f32_16x16x32_bf16 v[68:71], a[76:79], a[44:47], v[68:71]
v_exp_f32 v10, v50
v_mfma_f32_16x16x32_bf16 v[68:71], a[80:83], a[48:51], v[68:71]
ds_read_b128 a[120:123], v4 offset:14336
v_add_f32 v26, v26, v10
v_mfma_f32_16x16x32_bf16 v[68:71], a[84:87], a[52:55], v[68:71]
buffer_load_dwordx4 v1, s[4:7], s8 offen offset:3072 sc1 lds
v_mfma_f32_16x16x32_bf16 v[68:71], a[88:91], a[56:59], v[68:71]
s_add_u32 s8, s8, 4096
ds_read_b128 a[124:127], v4 offset:15360
v_mfma_f32_16x16x32_bf16 v[68:71], a[92:95], a[60:63], v[68:71]
s_waitcnt lgkmcnt(6)
v_exp_f32 v11, v51
v_mfma_f32_16x16x32_bf16 v[72:75], a[96:99], a[0:3], v[16:19]
s_add_u32 m0, s18, 4096
ds_read_b128 a[64:67], v4 offset:16384
v_add_f32 v26, v26, v11
v_mfma_f32_16x16x32_bf16 v[72:75], a[100:103], a[4:7], v[72:75]
s_waitcnt lgkmcnt(6)
buffer_load_dwordx4 v1, s[4:7], s8 offen offset:0 sc1 lds
v_mfma_f32_16x16x32_bf16 v[72:75], a[104:107], a[8:11], v[72:75]
s_waitcnt lgkmcnt(5)
ds_read_b128 a[68:71], v4 offset:17408
v_cvt_pk_bf16_f32 v101, v10, v11
v_mfma_f32_16x16x32_bf16 v[72:75], a[108:111], a[12:15], v[72:75]
s_waitcnt lgkmcnt(5)
v_mfma_f32_16x16x32_bf16 v[72:75], a[112:115], a[16:19], v[72:75]
s_waitcnt lgkmcnt(4)
ds_read_b128 a[72:75], v4 offset:18432
v_mfma_f32_16x16x32_bf16 v[72:75], a[116:119], a[20:23], v[72:75]
s_waitcnt lgkmcnt(4)
buffer_load_dwordx4 v1, s[4:7], s8 offen offset:1024 sc1 lds
v_mfma_f32_16x16x32_bf16 v[72:75], a[120:123], a[24:27], v[72:75]
s_waitcnt lgkmcnt(3)
ds_read_b128 a[76:79], v4 offset:19456
v_mfma_f32_16x16x32_bf16 v[72:75], a[124:127], a[28:31], v[72:75]
v_exp_f32 v12, v52
v_mfma_f32_16x16x32_bf16 v[76:79], a[96:99], a[32:35], v[20:23]
ds_read_b128 a[80:83], v4 offset:20480
v_add_f32 v27, v27, v12
v_mfma_f32_16x16x32_bf16 v[76:79], a[100:103], a[36:39], v[76:79]
buffer_load_dwordx4 v1, s[4:7], s8 offen offset:2048 sc1 lds
v_mfma_f32_16x16x32_bf16 v[76:79], a[104:107], a[40:43], v[76:79]
ds_read_b128 a[84:87], v4 offset:21504
v_mfma_f32_16x16x32_bf16 v[76:79], a[108:111], a[44:47], v[76:79]
v_exp_f32 v13, v53
v_mfma_f32_16x16x32_bf16 v[76:79], a[112:115], a[48:51], v[76:79]
ds_read_b128 a[88:91], v4 offset:22528
v_add_f32 v27, v27, v13
v_mfma_f32_16x16x32_bf16 v[76:79], a[116:119], a[52:55], v[76:79]
s_waitcnt lgkmcnt(3)
buffer_load_dwordx4 v1, s[4:7], s8 offen offset:3072 sc1 lds
v_mfma_f32_16x16x32_bf16 v[76:79], a[120:123], a[56:59], v[76:79]
s_add_u32 s8, s8, 28672
ds_read_b128 a[92:95], v4 offset:23552
v_cvt_pk_bf16_f32 v108, v12, v13
v_mfma_f32_16x16x32_bf16 v[76:79], a[124:127], a[60:63], v[76:79]
s_sub_u32 s9, s9, 1
v_exp_f32 v14, v54
v_mfma_f32_16x16x32_bf16 v[80:83], a[64:67], a[0:3], v[16:19]
s_cmp_eq_u32 s9, 0
ds_read_b128 a[96:99], v4 offset:24576
v_add_f32 v27, v27, v14
v_mfma_f32_16x16x32_bf16 v[80:83], a[68:71], a[4:7], v[80:83]
s_cselect_b32 s8, s10, s8
v_exp_f32 v15, v55
v_mfma_f32_16x16x32_bf16 v[80:83], a[72:75], a[8:11], v[80:83]
s_cselect_b32 s9, s11, s9
ds_read_b128 a[100:103], v4 offset:25600
v_add_f32 v27, v27, v15
v_mfma_f32_16x16x32_bf16 v[80:83], a[76:79], a[12:15], v[80:83]
s_waitcnt lgkmcnt(5)
s_cselect_b32 s10, 3221225472, s10
v_cvt_pk_bf16_f32 v109, v14, v15
v_mfma_f32_16x16x32_bf16 v[80:83], a[80:83], a[16:19], v[80:83]
s_waitcnt lgkmcnt(4)
ds_read_b128 a[104:107], v4 offset:26624
v_mfma_f32_16x16x32_bf16 v[80:83], a[84:87], a[20:23], v[80:83]
s_waitcnt lgkmcnt(4)
v_exp_f32 v8, v56
v_mfma_f32_16x16x32_bf16 v[80:83], a[88:91], a[24:27], v[80:83]
s_waitcnt lgkmcnt(3)
ds_read_b128 a[108:111], v4 offset:27648
v_add_f32 v26, v26, v8
v_mfma_f32_16x16x32_bf16 v[80:83], a[92:95], a[28:31], v[80:83]
v_exp_f32 v9, v57
v_mfma_f32_16x16x32_bf16 v[84:87], a[64:67], a[32:35], v[20:23]
ds_read_b128 a[112:115], v4 offset:28672
v_add_f32 v26, v26, v9
v_mfma_f32_16x16x32_bf16 v[84:87], a[68:71], a[36:39], v[84:87]
v_exp_f32 v10, v58
v_mfma_f32_16x16x32_bf16 v[84:87], a[72:75], a[40:43], v[84:87]
ds_read_b128 a[116:119], v4 offset:29696
v_cvt_pk_bf16_f32 v102, v8, v9
v_mfma_f32_16x16x32_bf16 v[84:87], a[76:79], a[44:47], v[84:87]
v_exp_f32 v11, v59
v_mfma_f32_16x16x32_bf16 v[84:87], a[80:83], a[48:51], v[84:87]
ds_read_b128 a[120:123], v4 offset:30720
v_add_f32 v26, v26, v10
v_mfma_f32_16x16x32_bf16 v[84:87], a[84:87], a[52:55], v[84:87]
v_add_f32 v26, v26, v11
v_cvt_pk_bf16_f32 v103, v10, v11
v_mfma_f32_16x16x32_bf16 v[84:87], a[88:91], a[56:59], v[84:87]
ds_read_b128 a[124:127], v4 offset:31744
v_mfma_f32_16x16x32_bf16 v[84:87], a[92:95], a[60:63], v[84:87]
s_waitcnt vmcnt(8) lgkmcnt(7)
s_barrier
v_mfma_f32_16x16x32_bf16 v[88:91], a[96:99], a[0:3], v[16:19]
s_waitcnt lgkmcnt(6)
ds_read_b128 a[64:67], v2 offset:0
v_mfma_f32_16x16x32_bf16 v[88:91], a[100:103], a[4:7], v[88:91]
s_waitcnt lgkmcnt(6)
v_exp_f32 v12, v60
v_mfma_f32_16x16x32_bf16 v[88:91], a[104:107], a[8:11], v[88:91]
s_waitcnt lgkmcnt(5)
ds_read_b128 a[68:71], v2 offset:1024
v_add_f32 v27, v27, v12
v_mfma_f32_16x16x32_bf16 v[88:91], a[108:111], a[12:15], v[88:91]
s_waitcnt lgkmcnt(5)
v_exp_f32 v13, v61
v_mfma_f32_16x16x32_bf16 v[88:91], a[112:115], a[16:19], v[88:91]
s_waitcnt lgkmcnt(4)
ds_read_b128 a[72:75], v2 offset:2048
v_add_f32 v27, v27, v13
v_mfma_f32_16x16x32_bf16 v[88:91], a[116:119], a[20:23], v[88:91]
s_waitcnt lgkmcnt(4)
v_exp_f32 v14, v62
v_mfma_f32_16x16x32_bf16 v[88:91], a[120:123], a[24:27], v[88:91]
s_waitcnt lgkmcnt(3)
ds_read_b128 a[76:79], v2 offset:3072
v_cvt_pk_bf16_f32 v110, v12, v13
v_mfma_f32_16x16x32_bf16 v[88:91], a[124:127], a[28:31], v[88:91]
v_exp_f32 v15, v63
v_mfma_f32_16x16x32_bf16 v[92:95], a[96:99], a[32:35], v[20:23]
s_sub_u32 s19, s19, 1
ds_read_b128 a[80:83], v2 offset:4096
v_add_f32 v27, v27, v14
v_mfma_f32_16x16x32_bf16 v[92:95], a[100:103], a[36:39], v[92:95]
v_add_f32 v27, v27, v15
v_cvt_pk_bf16_f32 v111, v14, v15
v_mfma_f32_16x16x32_bf16 v[92:95], a[104:107], a[40:43], v[92:95]
ds_read_b128 a[84:87], v2 offset:5120
v_add_f32 v28, v26, v27
v_mfma_f32_16x16x32_bf16 v[92:95], a[108:111], a[44:47], v[92:95]
v_cmp_nge_f32 vcc, s25, v28
v_mfma_f32_16x16x32_bf16 v[92:95], a[112:115], a[48:51], v[92:95]
ds_read_b128 a[88:91], v2 offset:6144
v_mfma_f32_16x16x32_bf16 v[92:95], a[116:119], a[52:55], v[92:95]
v_mfma_f32_16x16x32_bf16 v[92:95], a[120:123], a[56:59], v[92:95]
ds_read_b128 a[92:95], v2 offset:7168
v_mfma_f32_16x16x32_bf16 v[92:95], a[124:127], a[60:63], v[92:95]
s_waitcnt lgkmcnt(6)
s_cbranch_vccnz Lstub_5
Lback_6:
s_cmp_lg_u32 s19, 0
s_cbranch_scc1 K2_loop
s_cmp_eq_u32 s24, 2
s_cbranch_scc1 K2_ntail
v_mfma_f32_16x16x32_bf16 v[128:131], a[64:67], v[96:99], v[128:131]
s_add_u32 m0, s18, 98304
ds_read_b128 a[96:99], v2 offset:8192
v_add_f32 v24, v24, v26
v_mfma_f32_16x16x32_bf16 v[128:131], a[68:71], v[100:103], v[128:131]
buffer_load_dwordx4 v1, s[4:7], s12 offen offset:0 sc1 lds
v_mfma_f32_16x16x32_bf16 v[132:135], a[68:71], v[108:111], v[132:135]
ds_read_b128 a[100:103], v2 offset:9216
v_add_f32 v25, v25, v27
v_mfma_f32_16x16x32_bf16 v[132:135], a[64:67], v[104:107], v[132:135]
s_waitcnt lgkmcnt(7)
v_exp_f32 v8, v64
v_mfma_f32_16x16x32_bf16 v[136:139], a[72:75], v[96:99], v[136:139]
s_waitcnt lgkmcnt(6)
ds_read_b128 a[104:107], v2 offset:10240
v_mfma_f32_16x16x32_bf16 v[136:139], a[76:79], v[100:103], v[136:139]
buffer_load_dwordx4 v1, s[4:7], s12 offen offset:1024 sc1 lds
v_mfma_f32_16x16x32_bf16 v[140:143], a[76:79], v[108:111], v[140:143]
ds_read_b128 a[108:111], v2 offset:11264
v_mfma_f32_16x16x32_bf16 v[140:143], a[72:75], v[104:107], v[140:143]
s_waitcnt lgkmcnt(7)
v_exp_f32 v9, v65
v_mfma_f32_16x16x32_bf16 v[144:147], a[80:83], v[96:99], v[144:147]
s_waitcnt lgkmcnt(6)
ds_read_b128 a[112:115], v2 offset:12288
v_add_f32 v26, v8, v9
v_mfma_f32_16x16x32_bf16 v[144:147], a[84:87], v[100:103], v[144:147]
buffer_load_dwordx4 v1, s[4:7], s12 offen offset:2048 sc1 lds
v_mfma_f32_16x16x32_bf16 v[148:151], a[84:87], v[108:111], v[148:151]
ds_read_b128 a[116:119], v2 offset:13312
v_cvt_pk_bf16_f32 v112, v8, v9
v_mfma_f32_16x16x32_bf16 v[148:151], a[80:83], v[104:107], v[148:151]
s_waitcnt lgkmcnt(7)
v_exp_f32 v10, v66
v_mfma_f32_16x16x32_bf16 v[152:155], a[88:91], v[96:99], v[152:155]
s_waitcnt lgkmcnt(6)
ds_read_b128 a[120:123], v2 offset:14336
v_add_f32 v26, v26, v10
v_mfma_f32_16x16x32_bf16 v[152:155], a[92:95], v[100:103], v[152:155]
buffer_load_dwordx4 v1, s[4:7], s12 offen offset:3072 sc1 lds
v_mfma_f32_16x16x32_bf16 v[156:159], a[92:95], v[108:111], v[156:159]
s_add_u32 s12, s12, 4096
ds_read_b128 a[124:127], v2 offset:15360
v_mfma_f32_16x16x32_bf16 v[156:159], a[88:91], v[104:107], v[156:159]
s_waitcnt lgkmcnt(6)
v_exp_f32 v11, v67
v_mfma_f32_16x16x32_bf16 v[160:163], a[96:99], v[96:99], v[160:163]
s_add_u32 m0, s18, 102400
ds_read_b128 a[64:67], v2 offset:16384
v_add_f32 v26, v26, v11
v_mfma_f32_16x16x32_bf16 v[160:163], a[100:103], v[100:103], v[160:163]
buffer_load_dwordx4 v1, s[4:7], s12 offen offset:0 sc1 lds
v_mfma_f32_16x16x32_bf16 v[164:167], a[100:103], v[108:111], v[164:167]
ds_read_b128 a[68:71], v2 offset:17408
v_cvt_pk_bf16_f32 v113, v10, v11
v_mfma_f32_16x16x32_bf16 v[164:167], a[96:99], v[104:107], v[164:167]
s_waitcnt lgkmcnt(7)
v_mfma_f32_16x16x32_bf16 v[168:171], a[104:107], v[96:99], v[168:171]
s_waitcnt lgkmcnt(6)
ds_read_b128 a[72:75], v2 offset:18432
v_mfma_f32_16x16x32_bf16 v[168:171], a[108:111], v[100:103], v[168:171]
buffer_load_dwordx4 v1, s[4:7], s12 offen offset:1024 sc1 lds
v_mfma_f32_16x16x32_bf16 v[172:175], a[108:111], v[108:111], v[172:175]
ds_read_b128 a[76:79], v2 offset:19456
v_mfma_f32_16x16x32_bf16 v[172:175], a[104:107], v[104:107], v[172:175]
s_waitcnt lgkmcnt(7)
v_exp_f32 v12, v68
v_mfma_f32_16x16x32_bf16 v[176:179], a[112:115], v[96:99], v[176:179]
s_waitcnt lgkmcnt(6)
ds_read_b128 a[80:83], v2 offset:20480
v_mfma_f32_16x16x32_bf16 v[176:179], a[116:119], v[100:103], v[176:179]
buffer_load_dwordx4 v1, s[4:7], s12 offen offset:2048 sc1 lds
v_mfma_f32_16x16x32_bf16 v[180:183], a[116:119], v[108:111], v[180:183]
ds_read_b128 a[84:87], v2 offset:21504
v_mfma_f32_16x16x32_bf16 v[180:183], a[112:115], v[104:107], v[180:183]
s_waitcnt lgkmcnt(7)
v_exp_f32 v13, v69
v_mfma_f32_16x16x32_bf16 v[184:187], a[120:123], v[96:99], v[184:187]
s_waitcnt lgkmcnt(6)
ds_read_b128 a[88:91], v2 offset:22528
v_add_f32 v27, v12, v13
v_mfma_f32_16x16x32_bf16 v[184:187], a[124:127], v[100:103], v[184:187]
s_waitcnt lgkmcnt(5)
buffer_load_dwordx4 v1, s[4:7], s12 offen offset:3072 sc1 lds
v_mfma_f32_16x16x32_bf16 v[188:191], a[124:127], v[108:111], v[188:191]
s_add_u32 s12, s12, 28672
ds_read_b128 a[92:95], v2 offset:23552
v_cvt_pk_bf16_f32 v120, v12, v13
v_mfma_f32_16x16x32_bf16 v[188:191], a[120:123], v[104:107], v[188:191]
s_sub_u32 s13, s13, 1
v_exp_f32 v14, v70
v_mfma_f32_16x16x32_bf16 v[192:195], a[64:67], v[96:99], v[192:195]
s_cmp_eq_u32 s13, 0
ds_read_b128 a[96:99], v2 offset:24576
v_add_f32 v27, v27, v14
v_mfma_f32_16x16x32_bf16 v[192:195], a[68:71], v[100:103], v[192:195]
s_cselect_b32 s12, s14, s12
v_mfma_f32_16x16x32_bf16 v[196:199], a[68:71], v[108:111], v[196:199]
s_waitcnt lgkmcnt(6)
s_cselect_b32 s13, s15, s13
ds_read_b128 a[100:103], v2 offset:25600
v_mfma_f32_16x16x32_bf16 v[196:199], a[64:67], v[104:107], v[196:199]
s_cselect_b32 s14, 3221225472, s14
v_exp_f32 v15, v71
v_mfma_f32_16x16x32_bf16 v[200:203], a[72:75], v[96:99], v[200:203]
s_waitcnt lgkmcnt(6)
ds_read_b128 a[104:107], v2 offset:26624
v_add_f32 v27, v27, v15
v_mfma_f32_16x16x32_bf16 v[200:203], a[76:79], v[100:103], v[200:203]
v_exp_f32 v8, v72
v_mfma_f32_16x16x32_bf16 v[204:207], a[76:79], v[108:111], v[204:207]
ds_read_b128 a[108:111], v2 offset:27648
v_cvt_pk_bf16_f32 v121, v14, v15
v_mfma_f32_16x16x32_bf16 v[204:207], a[72:75], v[104:107], v[204:207]
s_waitcnt lgkmcnt(7)
v_exp_f32 v9, v73
v_mfma_f32_16x16x32_bf16 v[208:211], a[80:83], v[96:99], v[208:211]
s_waitcnt lgkmcnt(6)
ds_read_b128 a[112:115], v2 offset:28672
v_add_f32 v26, v26, v8
v_mfma_f32_16x16x32_bf16 v[208:211], a[84:87], v[100:103], v[208:211]
v_add_f32 v26, v26, v9
v_cvt_pk_bf16_f32 v114, v8, v9
v_mfma_f32_16x16x32_bf16 v[212:215], a[84:87], v[108:111], v[212:215]
ds_read_b128 a[116:119], v2 offset:29696
v_mfma_f32_16x16x32_bf16 v[212:215], a[80:83], v[104:107], v[212:215]
s_waitcnt lgkmcnt(7)
v_exp_f32 v10, v74
v_mfma_f32_16x16x32_bf16 v[216:219], a[88:91], v[96:99], v[216:219]
s_waitcnt lgkmcnt(6)
ds_read_b128 a[120:123], v2 offset:30720
v_add_f32 v26, v26, v10
v_mfma_f32_16x16x32_bf16 v[216:219], a[92:95], v[100:103], v[216:219]
v_exp_f32 v11, v75
v_mfma_f32_16x16x32_bf16 v[220:223], a[92:95], v[108:111], v[220:223]
ds_read_b128 a[124:127], v2 offset:31744
v_add_f32 v26, v26, v11
v_mfma_f32_16x16x32_bf16 v[220:223], a[88:91], v[104:107], v[220:223]
s_waitcnt vmcnt(8) lgkmcnt(7)
s_barrier
v_cvt_pk_bf16_f32 v115, v10, v11
v_mfma_f32_16x16x32_bf16 v[224:227], a[96:99], v[96:99], v[224:227]
s_waitcnt lgkmcnt(6)
ds_read_b128 a[64:67], v1 offset:0
v_mfma_f32_16x16x32_bf16 v[224:227], a[100:103], v[100:103], v[224:227]
v_exp_f32 v12, v76
v_mfma_f32_16x16x32_bf16 v[228:231], a[100:103], v[108:111], v[228:231]
ds_read_b128 a[68:71], v1 offset:1024
v_add_f32 v27, v27, v12
v_mfma_f32_16x16x32_bf16 v[228:231], a[96:99], v[104:107], v[228:231]
s_waitcnt lgkmcnt(7)
v_mfma_f32_16x16x32_bf16 v[232:235], a[104:107], v[96:99], v[232:235]
s_waitcnt lgkmcnt(6)
ds_read_b128 a[72:75], v1 offset:2048
v_mfma_f32_16x16x32_bf16 v[232:235], a[108:111], v[100:103], v[232:235]
v_exp_f32 v13, v77
v_mfma_f32_16x16x32_bf16 v[236:239], a[108:111], v[108:111], v[236:239]
ds_read_b128 a[76:79], v1 offset:3072
v_add_f32 v27, v27, v13
v_mfma_f32_16x16x32_bf16 v[236:239], a[104:107], v[104:107], v[236:239]
s_waitcnt lgkmcnt(7)
v_exp_f32 v14, v78
v_mfma_f32_16x16x32_bf16 v[240:243], a[112:115], v[96:99], v[240:243]
s_waitcnt lgkmcnt(6)
ds_read_b128 a[80:83], v1 offset:4096
v_cvt_pk_bf16_f32 v122, v12, v13
v_mfma_f32_16x16x32_bf16 v[240:243], a[116:119], v[100:103], v[240:243]
v_exp_f32 v15, v79
v_mfma_f32_16x16x32_bf16 v[244:247], a[116:119], v[108:111], v[244:247]
ds_read_b128 a[84:87], v1 offset:5120
v_add_f32 v27, v27, v14
v_mfma_f32_16x16x32_bf16 v[244:247], a[112:115], v[104:107], v[244:247]
s_waitcnt lgkmcnt(7)
v_add_f32 v27, v27, v15
v_cvt_pk_bf16_f32 v123, v14, v15
v_mfma_f32_16x16x32_bf16 v[248:251], a[120:123], v[96:99], v[248:251]
s_waitcnt lgkmcnt(6)
ds_read_b128 a[88:91], v1 offset:6144
v_mfma_f32_16x16x32_bf16 v[248:251], a[124:127], v[100:103], v[248:251]
v_mfma_f32_16x16x32_bf16 v[252:255], a[124:127], v[108:111], v[252:255]
ds_read_b128 a[92:95], v1 offset:7168
v_mfma_f32_16x16x32_bf16 v[252:255], a[120:123], v[104:107], v[252:255]
s_waitcnt lgkmcnt(6)
v_cndmask_b32 v32, v16, v7, s[32:33]
v_cndmask_b32 v33, v16, v7, s[34:35]
v_cndmask_b32 v34, v16, v7, s[36:37]
v_cndmask_b32 v35, v16, v7, s[38:39]
s_nop 1
v_mfma_f32_16x16x32_bf16 v[32:35], a[64:67], a[0:3], v[32:35]
s_add_u32 m0, s18, 131072
ds_read_b128 a[96:99], v1 offset:8192
v_cndmask_b32 v40, v16, v7, s[40:41]
v_mfma_f32_16x16x32_bf16 v[32:35], a[68:71], a[4:7], v[32:35]
s_waitcnt lgkmcnt(6)
buffer_load_dwordx4 v1, s[4:7], s8 offen offset:0 sc1 lds
v_mfma_f32_16x16x32_bf16 v[32:35], a[72:75], a[8:11], v[32:35]
s_waitcnt lgkmcnt(5)
ds_read_b128 a[100:103], v1 offset:9216
v_cndmask_b32 v41, v16, v7, s[42:43]
v_mfma_f32_16x16x32_bf16 v[32:35], a[76:79], a[12:15], v[32:35]
s_waitcnt lgkmcnt(5)
v_cndmask_b32 v42, v16, v7, s[44:45]
v_cndmask_b32 v43, v16, v7, s[46:47]
v_mfma_f32_16x16x32_bf16 v[32:35], a[80:83], a[16:19], v[32:35]
s_waitcnt lgkmcnt(4)
ds_read_b128 a[104:107], v1 offset:10240
v_mfma_f32_16x16x32_bf16 v[32:35], a[84:87], a[20:23], v[32:35]
s_waitcnt lgkmcnt(4)
buffer_load_dwordx4 v1, s[4:7], s8 offen offset:1024 sc1 lds
v_mfma_f32_16x16x32_bf16 v[32:35], a[88:91], a[24:27], v[32:35]
s_waitcnt lgkmcnt(3)
ds_read_b128 a[108:111], v1 offset:11264
v_mfma_f32_16x16x32_bf16 v[32:35], a[92:95], a[28:31], v[32:35]
v_exp_f32 v8, v80
v_mfma_f32_16x16x32_bf16 v[36:39], a[64:67], a[32:35], v[20:23]
ds_read_b128 a[112:115], v1 offset:12288
v_add_f32 v26, v26, v8
v_mfma_f32_16x16x32_bf16 v[36:39], a[68:71], a[36:39], v[36:39]
buffer_load_dwordx4 v1, s[4:7], s8 offen offset:2048 sc1 lds
v_mfma_f32_16x16x32_bf16 v[36:39], a[72:75], a[40:43], v[36:39]
ds_read_b128 a[116:119], v1 offset:13312
v_mfma_f32_16x16x32_bf16 v[36:39], a[76:79], a[44:47], v[36:39]
v_exp_f32 v9, v81
v_mfma_f32_16x16x32_bf16 v[36:39], a[80:83], a[48:51], v[36:39]
ds_read_b128 a[120:123], v1 offset:14336
v_add_f32 v26, v26, v9
v_mfma_f32_16x16x32_bf16 v[36:39], a[84:87], a[52:55], v[36:39]
buffer_load_dwordx4 v1, s[4:7], s8 offen offset:3072 sc1 lds
v_mfma_f32_16x16x32_bf16 v[36:39], a[88:91], a[56:59], v[36:39]
s_add_u32 s8, s8, 4096
ds_read_b128 a[124:127], v1 offset:15360
v_cvt_pk_bf16_f32 v116, v8, v9
v_mfma_f32_16x16x32_bf16 v[36:39], a[92:95], a[60:63], v[36:39]
s_waitcnt lgkmcnt(6)
v_exp_f32 v10, v82
v_mfma_f32_16x16x32_bf16 v[40:43], a[96:99], a[0:3], v[40:43]
s_add_u32 m0, s18, 135168
ds_read_b128 a[64:67], v1 offset:16384
v_cndmask_b32 v48, v16, v7, s[48:49]
v_mfma_f32_16x16x32_bf16 v[40:43], a[100:103], a[4:7], v[40:43]
s_waitcnt lgkmcnt(6)
buffer_load_dwordx4 v1, s[4:7], s8 offen offset:0 sc1 lds
v_mfma_f32_16x16x32_bf16 v[40:43], a[104:107], a[8:11], v[40:43]
s_waitcnt lgkmcnt(5)
ds_read_b128 a[68:71], v1 offset:17408
v_cndmask_b32 v49, v16, v7, s[50:51]
v_mfma_f32_16x16x32_bf16 v[40:43], a[108:111], a[12:15], v[40:43]
s_waitcnt lgkmcnt(5)
v_cndmask_b32 v50, v16, v7, s[52:53]
v_cndmask_b32 v51, v16, v7, s[54:55]
v_mfma_f32_16x16x32_bf16 v[40:43], a[112:115], a[16:19], v[40:43]
s_waitcnt lgkmcnt(4)
ds_read_b128 a[72:75], v1 offset:18432
v_add_f32 v26, v26, v10
v_mfma_f32_16x16x32_bf16 v[40:43], a[116:119], a[20:23], v[40:43]
s_waitcnt lgkmcnt(4)
buffer_load_dwordx4 v1, s[4:7], s8 offen offset:1024 sc1 lds
v_mfma_f32_16x16x32_bf16 v[40:43], a[120:123], a[24:27], v[40:43]
s_waitcnt lgkmcnt(3)
ds_read_b128 a[76:79], v1 offset:19456
v_mfma_f32_16x16x32_bf16 v[40:43], a[124:127], a[28:31], v[40:43]
v_exp_f32 v11, v83
v_mfma_f32_16x16x32_bf16 v[44:47], a[96:99], a[32:35], v[20:23]
ds_read_b128 a[80:83], v1 offset:20480
v_add_f32 v26, v26, v11
v_mfma_f32_16x16x32_bf16 v[44:47], a[100:103], a[36:39], v[44:47]
buffer_load_dwordx4 v1, s[4:7], s8 offen offset:2048 sc1 lds
v_mfma_f32_16x16x32_bf16 v[44:47], a[104:107], a[40:43], v[44:47]
ds_read_b128 a[84:87], v1 offset:21504
v_cvt_pk_bf16_f32 v117, v10, v11
v_mfma_f32_16x16x32_bf16 v[44:47], a[108:111], a[44:47], v[44:47]
v_exp_f32 v12, v84
v_mfma_f32_16x16x32_bf16 v[44:47], a[112:115], a[48:51], v[44:47]
ds_read_b128 a[88:91], v1 offset:22528
v_add_f32 v27, v27, v12
v_mfma_f32_16x16x32_bf16 v[44:47], a[116:119], a[52:55], v[44:47]
buffer_load_dwordx4 v1, s[4:7], s8 offen offset:3072 sc1 lds
v_mfma_f32_16x16x32_bf16 v[44:47], a[120:123], a[56:59], v[44:47]
s_waitcnt lgkmcnt(2)
s_add_u32 s8, s8, 28672
ds_read_b128 a[92:95], v1 offset:23552
v_mfma_f32_16x16x32_bf16 v[44:47], a[124:127], a[60:63], v[44:47]
s_sub_u32 s9, s9, 1
v_exp_f32 v13, v85
v_mfma_f32_16x16x32_bf16 v[48:51], a[64:67], a[0:3], v[48:51]
s_cmp_eq_u32 s9, 0
ds_read_b128 a[96:99], v1 offset:24576
v_cndmask_b32 v56, v16, v7, s[56:57]
v_mfma_f32_16x16x32_bf16 v[48:51], a[68:71], a[4:7], v[48:51]
s_cselect_b32 s8, s10, s8
v_cndmask_b32 v57, v16, v7, s[58:59]
v_cndmask_b32 v58, v16, v7, s[60:61]
v_mfma_f32_16x16x32_bf16 v[48:51], a[72:75], a[8:11], v[48:51]
s_cselect_b32 s9, s11, s9
ds_read_b128 a[100:103], v1 offset:25600
v_cndmask_b32 v59, v16, v7, s[62:63]
v_mfma_f32_16x16x32_bf16 v[48:51], a[76:79], a[12:15], v[48:51]
s_cselect_b32 s10, 3221225472, s10
v_exp_f32 v14, v86
v_mfma_f32_16x16x32_bf16 v[48:51], a[80:83], a[16:19], v[48:51]
s_waitcnt lgkmcnt(4)
ds_read_b128 a[104:107], v1 offset:26624
v_add_f32 v27, v27, v13
v_cvt_pk_bf16_f32 v124, v12, v13
v_mfma_f32_16x16x32_bf16 v[48:51], a[84:87], a[20:23], v[48:51]
s_waitcnt lgkmcnt(4)
v_exp_f32 v15, v87
v_mfma_f32_16x16x32_bf16 v[48:51], a[88:91], a[24:27], v[48:51]
s_waitcnt lgkmcnt(3)
ds_read_b128 a[108:111], v1 offset:27648
v_add_f32 v27, v27, v14
v_mfma_f32_16x16x32_bf16 v[48:51], a[92:95], a[28:31], v[48:51]
v_exp_f32 v8, v88
v_mfma_f32_16x16x32_bf16 v[52:55], a[64:67], a[32:35], v[20:23]
ds_read_b128 a[112:115], v1 offset:28672
v_add_f32 v27, v27, v15
v_mfma_f32_16x16x32_bf16 v[52:55], a[68:71], a[36:39], v[52:55]
v_exp_f32 v9, v89
v_mfma_f32_16x16x32_bf16 v[52:55], a[72:75], a[40:43], v[52:55]
ds_read_b128 a[116:119], v1 offset:29696
v_cvt_pk_bf16_f32 v125, v14, v15
v_mfma_f32_16x16x32_bf16 v[52:55], a[76:79], a[44:47], v[52:55]
v_exp_f32 v10, v90
v_mfma_f32_16x16x32_bf16 v[52:55], a[80:83], a[48:51], v[52:55]
ds_read_b128 a[120:123], v1 offset:30720
v_add_f32 v26, v26, v8
v_mfma_f32_16x16x32_bf16 v[52:55], a[84:87], a[52:55], v[52:55]
v_exp_f32 v11, v91
v_mfma_f32_16x16x32_bf16 v[52:55], a[88:91], a[56:59], v[52:55]
ds_read_b128 a[124:127], v1 offset:31744
v_add_f32 v26, v26, v9
v_cvt_pk_bf16_f32 v118, v8, v9
v_mfma_f32_16x16x32_bf16 v[52:55], a[92:95], a[60:63], v[52:55]
s_waitcnt vmcnt(8) lgkmcnt(7)
s_barrier
v_add_f32 v26, v26, v10
v_mfma_f32_16x16x32_bf16 v[56:59], a[96:99], a[0:3], v[56:59]
s_waitcnt lgkmcnt(6)
ds_read_b128 a[64:67], v2 offset:32768
v_add_f32 v26, v26, v11
v_mfma_f32_16x16x32_bf16 v[56:59], a[100:103], a[4:7], v[56:59]
s_waitcnt lgkmcnt(6)
v_exp_f32 v12, v92
v_mfma_f32_16x16x32_bf16 v[56:59], a[104:107], a[8:11], v[56:59]
s_waitcnt lgkmcnt(5)
ds_read_b128 a[68:71], v2 offset:33792
v_cvt_pk_bf16_f32 v119, v10, v11
v_mfma_f32_16x16x32_bf16 v[56:59], a[108:111], a[12:15], v[56:59]
s_waitcnt lgkmcnt(5)
v_exp_f32 v13, v93
v_mfma_f32_16x16x32_bf16 v[56:59], a[112:115], a[16:19], v[56:59]
s_waitcnt lgkmcnt(4)
ds_read_b128 a[72:75], v2 offset:34816
v_add_f32 v27, v27, v12
v_mfma_f32_16x16x32_bf16 v[56:59], a[116:119], a[20:23], v[56:59]
s_waitcnt lgkmcnt(4)
v_exp_f32 v14, v94
v_mfma_f32_16x16x32_bf16 v[56:59], a[120:123], a[24:27], v[56:59]
s_waitcnt lgkmcnt(3)
ds_read_b128 a[76:79], v2 offset:35840
v_add_f32 v27, v27, v13
v_mfma_f32_16x16x32_bf16 v[56:59], a[124:127], a[28:31], v[56:59]
v_exp_f32 v15, v95
v_mfma_f32_16x16x32_bf16 v[60:63], a[96:99], a[32:35], v[20:23]
ds_read_b128 a[80:83], v2 offset:36864
v_cvt_pk_bf16_f32 v126, v12, v13
v_mfma_f32_16x16x32_bf16 v[60:63], a[100:103], a[36:39], v[60:63]
v_add_f32 v27, v27, v14
v_add_f32 v27, v27, v15
v_mfma_f32_16x16x32_bf16 v[60:63], a[104:107], a[40:43], v[60:63]
ds_read_b128 a[84:87], v2 offset:37888
v_cvt_pk_bf16_f32 v127, v14, v15
v_mfma_f32_16x16x32_bf16 v[60:63], a[108:111], a[44:47], v[60:63]
v_add_f32 v28, v26, v27
v_cmp_nge_f32 vcc, s25, v28
v_mfma_f32_16x16x32_bf16 v[60:63], a[112:115], a[48:51], v[60:63]
ds_read_b128 a[88:91], v2 offset:38912
v_mfma_f32_16x16x32_bf16 v[60:63], a[116:119], a[52:55], v[60:63]
v_mfma_f32_16x16x32_bf16 v[60:63], a[120:123], a[56:59], v[60:63]
ds_read_b128 a[92:95], v2 offset:39936
v_mfma_f32_16x16x32_bf16 v[60:63], a[124:127], a[60:63], v[60:63]
s_waitcnt lgkmcnt(6)
s_cbranch_vccnz Lstub_7
Lback_8:
v_mfma_f32_16x16x32_bf16 v[128:131], a[64:67], v[112:115], v[128:131]
s_add_u32 m0, s18, 65536
ds_read_b128 a[96:99], v2 offset:40960
v_add_f32 v24, v24, v26
v_mfma_f32_16x16x32_bf16 v[128:131], a[68:71], v[116:119], v[128:131]
buffer_load_dwordx4 v1, s[4:7], s12 offen offset:0 sc1 lds
v_mfma_f32_16x16x32_bf16 v[132:135], a[68:71], v[124:127], v[132:135]
ds_read_b128 a[100:103], v2 offset:41984
v_add_f32 v25, v25, v27
v_mfma_f32_16x16x32_bf16 v[132:135], a[64:67], v[120:123], v[132:135]
s_waitcnt lgkmcnt(7)
v_exp_f32 v8, v32
v_mfma_f32_16x16x32_bf16 v[136:139], a[72:75], v[112:115], v[136:139]
s_waitcnt lgkmcnt(6)
ds_read_b128 a[104:107], v2 offset:43008
v_mfma_f32_16x16x32_bf16 v[136:139], a[76:79], v[116:119], v[136:139]
buffer_load_dwordx4 v1, s[4:7], s12 offen offset:1024 sc1 lds
v_mfma_f32_16x16x32_bf16 v[140:143], a[76:79], v[124:127], v[140:143]
ds_read_b128 a[108:111], v2 offset:44032
v_mfma_f32_16x16x32_bf16 v[140:143], a[72:75], v[120:123], v[140:143]
s_waitcnt lgkmcnt(7)
v_exp_f32 v9, v33
v_mfma_f32_16x16x32_bf16 v[144:147], a[80:83], v[112:115], v[144:147]
s_waitcnt lgkmcnt(6)
ds_read_b128 a[112:115], v2 offset:45056
v_add_f32 v26, v8, v9
v_mfma_f32_16x16x32_bf16 v[144:147], a[84:87], v[116:119], v[144:147]
buffer_load_dwordx4 v1, s[4:7], s12 offen offset:2048 sc1 lds
v_mfma_f32_16x16x32_bf16 v[148:151], a[84:87], v[124:127], v[148:151]
ds_read_b128 a[116:119], v2 offset:46080
v_cvt_pk_bf16_f32 v96, v8, v9
v_mfma_f32_16x16x32_bf16 v[148:151], a[80:83], v[120:123], v[148:151]
s_waitcnt lgkmcnt(7)
v_exp_f32 v10, v34
v_mfma_f32_16x16x32_bf16 v[152:155], a[88:91], v[112:115], v[152:155]
s_waitcnt lgkmcnt(6)
ds_read_b128 a[120:123], v2 offset:47104
v_add_f32 v26, v26, v10
v_mfma_f32_16x16x32_bf16 v[152:155], a[92:95], v[116:119], v[152:155]
buffer_load_dwordx4 v1, s[4:7], s12 offen offset:3072 sc1 lds
v_mfma_f32_16x16x32_bf16 v[156:159], a[92:95], v[124:127], v[156:159]
s_add_u32 s12, s12, 4096
ds_read_b128 a[124:127], v2 offset:48128
v_mfma_f32_16x16x32_bf16 v[156:159], a[88:91], v[120:123], v[156:159]
s_waitcnt lgkmcnt(6)
v_exp_f32 v11, v35
v_mfma_f32_16x16x32_bf16 v[160:163], a[96:99], v[112:115], v[160:163]
s_add_u32 m0, s18, 69632
ds_read_b128 a[64:67], v2 offset:49152
v_add_f32 v26, v26, v11
v_mfma_f32_16x16x32_bf16 v[160:163], a[100:103], v[116:119], v[160:163]
buffer_load_dwordx4 v1, s[4:7], s12 offen offset:0 sc1 lds
v_mfma_f32_16x16x32_bf16 v[164:167], a[100:103], v[124:127], v[164:167]
ds_read_b128 a[68:71], v2 offset:50176
v_cvt_pk_bf16_f32 v97, v10, v11
v_mfma_f32_16x16x32_bf16 v[164:167], a[96:99], v[120:123], v[164:167]
s_waitcnt lgkmcnt(7)
v_mfma_f32_16x16x32_bf16 v[168:171], a[104:107], v[112:115], v[168:171]
s_waitcnt lgkmcnt(6)
ds_read_b128 a[72:75], v2 offset:51200
v_mfma_f32_16x16x32_bf16 v[168:171], a[108:111], v[116:119], v[168:171]
buffer_load_dwordx4 v1, s[4:7], s12 offen offset:1024 sc1 lds
v_mfma_f32_16x16x32_bf16 v[172:175], a[108:111], v[124:127], v[172:175]
ds_read_b128 a[76:79], v2 offset:52224
v_mfma_f32_16x16x32_bf16 v[172:175], a[104:107], v[120:123], v[172:175]
s_waitcnt lgkmcnt(7)
v_exp_f32 v12, v36
v_mfma_f32_16x16x32_bf16 v[176:179], a[112:115], v[112:115], v[176:179]
s_waitcnt lgkmcnt(6)
ds_read_b128 a[80:83], v2 offset:53248
v_mfma_f32_16x16x32_bf16 v[176:179], a[116:119], v[116:119], v[176:179]
buffer_load_dwordx4 v1, s[4:7], s12 offen offset:2048 sc1 lds
v_mfma_f32_16x16x32_bf16 v[180:183], a[116:119], v[124:127], v[180:183]
ds_read_b128 a[84:87], v2 offset:54272
v_mfma_f32_16x16x32_bf16 v[180:183], a[112:115], v[120:123], v[180:183]
s_waitcnt lgkmcnt(7)
v_exp_f32 v13, v37
v_mfma_f32_16x16x32_bf16 v[184:187], a[120:123], v[112:115], v[184:187]
s_waitcnt lgkmcnt(6)
ds_read_b128 a[88:91], v2 offset:55296
v_add_f32 v27, v12, v13
v_mfma_f32_16x16x32_bf16 v[184:187], a[124:127], v[116:119], v[184:187]
s_waitcnt lgkmcnt(5)
buffer_load_dwordx4 v1, s[4:7], s12 offen offset:3072 sc1 lds
v_mfma_f32_16x16x32_bf16 v[188:191], a[124:127], v[124:127], v[188:191]
s_add_u32 s12, s12, 28672
ds_read_b128 a[92:95], v2 offset:56320
v_cvt_pk_bf16_f32 v104, v12, v13
v_mfma_f32_16x16x32_bf16 v[188:191], a[120:123], v[120:123], v[188:191]
s_sub_u32 s13, s13, 1
v_exp_f32 v14, v38
v_mfma_f32_16x16x32_bf16 v[192:195], a[64:67], v[112:115], v[192:195]
s_cmp_eq_u32 s13, 0
ds_read_b128 a[96:99], v2 offset:57344
v_add_f32 v27, v27, v14
v_mfma_f32_16x16x32_bf16 v[192:195], a[68:71], v[116:119], v[192:195]
s_cselect_b32 s12, s14, s12
v_exp_f32 v15, v39
v_mfma_f32_16x16x32_bf16 v[196:199], a[68:71], v[124:127], v[196:199]
s_cselect_b32 s13, s15, s13
ds_read_b128 a[100:103], v2 offset:58368
v_add_f32 v27, v27, v15
v_mfma_f32_16x16x32_bf16 v[196:199], a[64:67], v[120:123], v[196:199]
s_waitcnt lgkmcnt(7)
s_cselect_b32 s14, 3221225472, s14
v_cvt_pk_bf16_f32 v105, v14, v15
v_mfma_f32_16x16x32_bf16 v[200:203], a[72:75], v[112:115], v[200:203]
s_waitcnt lgkmcnt(6)
ds_read_b128 a[104:107], v2 offset:59392
v_mfma_f32_16x16x32_bf16 v[200:203], a[76:79], v[116:119], v[200:203]
buffer_load_dword v3, off, s[4:7], s80 sc1
v_mfma_f32_16x16x32_bf16 v[204:207], a[76:79], v[124:127], v[204:207]
ds_read_b128 a[108:111], v2 offset:60416
v_mfma_f32_16x16x32_bf16 v[204:207], a[72:75], v[120:123], v[204:207]
s_waitcnt lgkmcnt(7)
v_exp_f32 v8, v40
v_mfma_f32_16x16x32_bf16 v[208:211], a[80:83], v[112:115], v[208:211]
s_waitcnt lgkmcnt(6)
ds_read_b128 a[112:115], v2 offset:61440
v_add_f32 v26, v26, v8
v_mfma_f32_16x16x32_bf16 v[208:211], a[84:87], v[116:119], v[208:211]
v_exp_f32 v9, v41
v_mfma_f32_16x16x32_bf16 v[212:215], a[84:87], v[124:127], v[212:215]
ds_read_b128 a[116:119], v2 offset:62464
v_add_f32 v26, v26, v9
v_mfma_f32_16x16x32_bf16 v[212:215], a[80:83], v[120:123], v[212:215]
s_waitcnt lgkmcnt(7)
v_exp_f32 v10, v42
v_mfma_f32_16x16x32_bf16 v[216:219], a[88:91], v[112:115], v[216:219]
s_waitcnt lgkmcnt(6)
ds_read_b128 a[120:123], v2 offset:63488
v_cvt_pk_bf16_f32 v98, v8, v9
v_mfma_f32_16x16x32_bf16 v[216:219], a[92:95], v[116:119], v[216:219]
v_exp_f32 v11, v43
v_mfma_f32_16x16x32_bf16 v[220:223], a[92:95], v[124:127], v[220:223]
ds_read_b128 a[124:127], v2 offset:64512
v_add_f32 v26, v26, v10
v_mfma_f32_16x16x32_bf16 v[220:223], a[88:91], v[120:123], v[220:223]
s_waitcnt vmcnt(9) lgkmcnt(7)
s_barrier
v_add_f32 v26, v26, v11
v_mfma_f32_16x16x32_bf16 v[224:227], a[96:99], v[112:115], v[224:227]
s_waitcnt lgkmcnt(6)
ds_read_b128 a[64:67], v4 offset:0
v_cvt_pk_bf16_f32 v99, v10, v11
v_mfma_f32_16x16x32_bf16 v[224:227], a[100:103], v[116:119], v[224:227]
v_mfma_f32_16x16x32_bf16 v[228:231], a[100:103], v[124:127], v[228:231]
ds_read_b128 a[68:71], v4 offset:1024
v_mfma_f32_16x16x32_bf16 v[228:231], a[96:99], v[120:123], v[228:231]
s_waitcnt lgkmcnt(7)
v_exp_f32 v12, v44
v_mfma_f32_16x16x32_bf16 v[232:235], a[104:107], v[112:115], v[232:235]
s_waitcnt lgkmcnt(6)
ds_read_b128 a[72:75], v4 offset:2048
v_add_f32 v27, v27, v12
v_mfma_f32_16x16x32_bf16 v[232:235], a[108:111], v[116:119], v[232:235]
v_exp_f32 v13, v45
v_mfma_f32_16x16x32_bf16 v[236:239], a[108:111], v[124:127], v[236:239]
ds_read_b128 a[76:79], v4 offset:3072
v_add_f32 v27, v27, v13
v_mfma_f32_16x16x32_bf16 v[236:239], a[104:107], v[120:123], v[236:239]
s_waitcnt lgkmcnt(7)
v_exp_f32 v14, v46
v_mfma_f32_16x16x32_bf16 v[240:243], a[112:115], v[112:115], v[240:243]
s_waitcnt lgkmcnt(6)
ds_read_b128 a[80:83], v4 offset:4096
v_cvt_pk_bf16_f32 v106, v12, v13
v_mfma_f32_16x16x32_bf16 v[240:243], a[116:119], v[116:119], v[240:243]
v_exp_f32 v15, v47
v_mfma_f32_16x16x32_bf16 v[244:247], a[116:119], v[124:127], v[244:247]
ds_read_b128 a[84:87], v4 offset:5120
v_add_f32 v27, v27, v14
v_mfma_f32_16x16x32_bf16 v[244:247], a[112:115], v[120:123], v[244:247]
s_waitcnt lgkmcnt(7)
v_add_f32 v27, v27, v15
v_cvt_pk_bf16_f32 v107, v14, v15
v_mfma_f32_16x16x32_bf16 v[248:251], a[120:123], v[112:115], v[248:251]
s_waitcnt lgkmcnt(6)
ds_read_b128 a[88:91], v4 offset:6144
v_mfma_f32_16x16x32_bf16 v[248:251], a[124:127], v[116:119], v[248:251]
v_mfma_f32_16x16x32_bf16 v[252:255], a[124:127], v[124:127], v[252:255]
ds_read_b128 a[92:95], v4 offset:7168
v_mfma_f32_16x16x32_bf16 v[252:255], a[120:123], v[120:123], v[252:255]
s_waitcnt lgkmcnt(6)
K2_dx1:
v_cndmask_b32 v68, v20, v7, s[32:33]
v_cndmask_b32 v69, v20, v7, s[34:35]
v_cndmask_b32 v70, v20, v7, s[36:37]
v_cndmask_b32 v71, v20, v7, s[38:39]
s_nop 1
v_mfma_f32_16x16x32_bf16 v[68:71], a[64:67], a[32:35], v[68:71]
s_add_u32 m0, s18, 0
ds_read_b128 a[96:99], v4 offset:8192
v_cndmask_b32 v76, v20, v7, s[40:41]
v_cndmask_b32 v79, v20, v7, s[46:47]
v_mfma_f32_16x16x32_bf16 v[68:71], a[68:71], a[36:39], v[68:71]
s_waitcnt lgkmcnt(6)
ds_read_b128 a[100:103], v4 offset:9216
buffer_load_dwordx4 v1, s[4:7], s12 offen offset:0 sc1 lds
v_mfma_f32_16x16x32_bf16 v[68:71], a[72:75], a[40:43], v[68:71]
s_waitcnt lgkmcnt(6)
ds_read_b128 a[104:107], v4 offset:10240
v_cndmask_b32 v77, v20, v7, s[42:43]
v_mfma_f32_16x16x32_bf16 v[68:71], a[76:79], a[44:47], v[68:71]
s_waitcnt lgkmcnt(6)
ds_read_b128 a[108:111], v4 offset:11264
buffer_load_dwordx4 v1, s[4:7], s12 offen offset:1024 sc1 lds
v_mfma_f32_16x16x32_bf16 v[68:71], a[80:83], a[48:51], v[68:71]
s_waitcnt lgkmcnt(6)
ds_read_b128 a[112:115], v4 offset:12288
v_cndmask_b32 v78, v20, v7, s[44:45]
v_mfma_f32_16x16x32_bf16 v[68:71], a[84:87], a[52:55], v[68:71]
s_waitcnt lgkmcnt(6)
ds_read_b128 a[116:119], v4 offset:13312
buffer_load_dwordx4 v1, s[4:7], s12 offen offset:2048 sc1 lds
v_mfma_f32_16x16x32_bf16 v[68:71], a[88:91], a[56:59], v[68:71]
s_waitcnt lgkmcnt(6)
ds_read_b128 a[120:123], v4 offset:14336
v_exp_f32 v8, v48
v_exp_f32 v9, v49
v_exp_f32 v10, v50
v_mfma_f32_16x16x32_bf16 v[68:71], a[92:95], a[60:63], v[68:71]
s_waitcnt lgkmcnt(5)
ds_read_b128 a[124:127], v4 offset:15360
buffer_load_dwordx4 v1, s[4:7], s12 offen offset:3072 sc1 lds
v_add_f32 v26, v26, v8
v_add_f32 v26, v26, v9
v_cvt_pk_bf16_f32 v100, v8, v9
v_add_f32 v26, v26, v10
v_mfma_f32_16x16x32_bf16 v[76:79], a[96:99], a[32:35], v[76:79]
s_add_u32 s12, s12, 4096
s_add_u32 m0, s18, 4096
ds_read_b128 a[64:67], v4 offset:16384
v_cndmask_b32 v86, v20, v7, s[52:53]
v_cndmask_b32 v87, v20, v7, s[54:55]
v_mfma_f32_16x16x32_bf16 v[76:79], a[100:103], a[36:39], v[76:79]
s_waitcnt lgkmcnt(6)
ds_read_b128 a[68:71], v4 offset:17408
buffer_load_dwordx4 v1, s[4:7], s12 offen offset:0 sc1 lds
v_mfma_f32_16x16x32_bf16 v[76:79], a[104:107], a[40:43], v[76:79]
s_waitcnt lgkmcnt(6)
ds_read_b128 a[72:75], v4 offset:18432
v_cndmask_b32 v84, v20, v7, s[48:49]
v_mfma_f32_16x16x32_bf16 v[76:79], a[108:111], a[44:47], v[76:79]
s_waitcnt lgkmcnt(6)
ds_read_b128 a[76:79], v4 offset:19456
buffer_load_dwordx4 v1, s[4:7], s12 offen offset:1024 sc1 lds
v_mfma_f32_16x16x32_bf16 v[76:79], a[112:115], a[48:51], v[76:79]
s_waitcnt lgkmcnt(6)
ds_read_b128 a[80:83], v4 offset:20480
v_cndmask_b32 v85, v20, v7, s[50:51]
v_mfma_f32_16x16x32_bf16 v[76:79], a[116:119], a[52:55], v[76:79]
s_waitcnt lgkmcnt(6)
ds_read_b128 a[84:87], v4 offset:21504
buffer_load_dwordx4 v1, s[4:7], s12 offen offset:2048 sc1 lds
v_mfma_f32_16x16x32_bf16 v[76:79], a[120:123], a[56:59], v[76:79]
s_waitcnt lgkmcnt(6)
ds_read_b128 a[88:91], v4 offset:22528
v_exp_f32 v11, v51
v_exp_f32 v12, v52
v_mfma_f32_16x16x32_bf16 v[76:79], a[124:127], a[60:63], v[76:79]
s_waitcnt lgkmcnt(1)
ds_read_b128 a[92:95], v4 offset:23552
buffer_load_dwordx4 v1, s[4:7], s12 offen offset:3072 sc1 lds
v_add_f32 v26, v26, v11
v_cvt_pk_bf16_f32 v101, v10, v11
v_add_f32 v27, v27, v12
v_mfma_f32_16x16x32_bf16 v[84:87], a[64:67], a[32:35], v[84:87]
s_add_u32 s12, s12, 28672
ds_read_b128 a[96:99], v4 offset:24576
v_cndmask_b32 v92, v20, v7, s[56:57]
v_mfma_f32_16x16x32_bf16 v[84:87], a[68:71], a[36:39], v[84:87]
s_sub_u32 s13, s13, 1
ds_read_b128 a[100:103], v4 offset:25600
v_cndmask_b32 v93, v20, v7, s[58:59]
v_mfma_f32_16x16x32_bf16 v[84:87], a[72:75], a[40:43], v[84:87]
s_cmp_eq_u32 s13, 0
ds_read_b128 a[104:107], v4 offset:26624
v_cndmask_b32 v94, v20, v7, s[60:61]
v_mfma_f32_16x16x32_bf16 v[84:87], a[76:79], a[44:47], v[84:87]
s_cselect_b32 s12, s14, s12
ds_read_b128 a[108:111], v4 offset:27648
v_cndmask_b32 v95, v20, v7, s[62:63]
v_mfma_f32_16x16x32_bf16 v[84:87], a[80:83], a[48:51], v[84:87]
s_cselect_b32 s13, s15, s13
ds_read_b128 a[112:115], v4 offset:28672
v_exp_f32 v13, v53
v_exp_f32 v14, v54
v_mfma_f32_16x16x32_bf16 v[84:87], a[84:87], a[52:55], v[84:87]
s_waitcnt lgkmcnt(6)
s_cselect_b32 s14, 3221225472, s14
ds_read_b128 a[116:119], v4 offset:29696
v_exp_f32 v15, v55
v_exp_f32 v8, v56
v_exp_f32 v9, v57
v_add_f32 v27, v27, v13
v_cvt_pk_bf16_f32 v108, v12, v13
v_add_f32 v27, v27, v14
v_mfma_f32_16x16x32_bf16 v[84:87], a[88:91], a[56:59], v[84:87]
s_waitcnt lgkmcnt(6)
ds_read_b128 a[120:123], v4 offset:30720
v_exp_f32 v10, v58
v_exp_f32 v11, v59
v_add_f32 v27, v27, v15
v_cvt_pk_bf16_f32 v109, v14, v15
v_mfma_f32_16x16x32_bf16 v[84:87], a[92:95], a[60:63], v[84:87]
s_waitcnt vmcnt(8) lgkmcnt(6)
s_barrier
ds_read_b128 a[124:127], v4 offset:31744
v_mfma_f32_16x16x32_bf16 v[92:95], a[96:99], a[32:35], v[92:95]
s_waitcnt lgkmcnt(6)
ds_read_b128 a[64:67], v2 offset:0
v_exp_f32 v12, v60
v_exp_f32 v13, v61
v_mfma_f32_16x16x32_bf16 v[92:95], a[100:103], a[36:39], v[92:95]
s_waitcnt lgkmcnt(6)
ds_read_b128 a[68:71], v2 offset:1024
v_exp_f32 v14, v62
v_exp_f32 v15, v63
v_mfma_f32_16x16x32_bf16 v[92:95], a[104:107], a[40:43], v[92:95]
s_waitcnt lgkmcnt(6)
ds_read_b128 a[72:75], v2 offset:2048
v_add_f32 v26, v26, v8
v_add_f32 v26, v26, v9
v_cvt_pk_bf16_f32 v102, v8, v9
v_mfma_f32_16x16x32_bf16 v[92:95], a[108:111], a[44:47], v[92:95]
s_waitcnt lgkmcnt(6)
ds_read_b128 a[76:79], v2 offset:3072
v_add_f32 v26, v26, v10
v_add_f32 v26, v26, v11
v_cvt_pk_bf16_f32 v103, v10, v11
v_mfma_f32_16x16x32_bf16 v[92:95], a[112:115], a[48:51], v[92:95]
s_waitcnt lgkmcnt(6)
ds_read_b128 a[80:83], v2 offset:4096
v_add_f32 v27, v27, v12
v_mfma_f32_16x16x32_bf16 v[92:95], a[116:119], a[52:55], v[92:95]
s_waitcnt lgkmcnt(6)
ds_read_b128 a[84:87], v2 offset:5120
v_add_f32 v27, v27, v13
v_cvt_pk_bf16_f32 v110, v12, v13
v_mfma_f32_16x16x32_bf16 v[92:95], a[120:123], a[56:59], v[92:95]
s_waitcnt lgkmcnt(6)
ds_read_b128 a[88:91], v2 offset:6144
v_add_f32 v27, v27, v14
v_add_f32 v27, v27, v15
v_cvt_pk_bf16_f32 v111, v14, v15
v_mfma_f32_16x16x32_bf16 v[92:95], a[124:127], a[60:63], v[92:95]
s_waitcnt lgkmcnt(6)
ds_read_b128 a[92:95], v2 offset:7168
v_add_f32 v28, v26, v27
v_cmp_nge_f32 vcc, s25, v28
s_cbranch_vccnz Lstub_9
Lback_10:
s_cmp_lg_u32 s24, 1
s_cbranch_scc1 K2_plain
v_cmp_gt_u32 vcc, 1, v3
s_cbranch_vccnz K2_tspin
K2_tok:
v_mfma_f32_16x16x32_bf16 v[128:131], a[64:67], v[96:99], v[128:131]
s_waitcnt lgkmcnt(6)
ds_read_b128 a[96:99], v2 offset:8192
v_add_f32 v24, v24, v26
v_mfma_f32_16x16x32_bf16 v[128:131], a[68:71], v[100:103], v[128:131]
buffer_load_dwordx4 v[28:31], v1, s[4:7], s27 offen sc1
v_mfma_f32_16x16x32_bf16 v[132:135], a[68:71], v[108:111], v[132:135]
ds_read_b128 a[100:103], v2 offset:9216
v_add_f32 v25, v25, v27
v_mfma_f32_16x16x32_bf16 v[132:135], a[64:67], v[104:107], v[132:135]
s_waitcnt lgkmcnt(6)
v_exp_f32 v8, v68
v_mfma_f32_16x16x32_bf16 v[136:139], a[72:75], v[96:99], v[136:139]
s_add_u32 s22, s76, 0
ds_read_b128 a[104:107], v2 offset:10240
v_exp_f32 v9, v69
v_mfma_f32_16x16x32_bf16 v[136:139], a[76:79], v[100:103], v[136:139]
buffer_load_dwordx4 v[32:35], v1, s[4:7], s22 offen offset:0 sc1
v_mfma_f32_16x16x32_bf16 v[140:143], a[76:79], v[108:111], v[140:143]
ds_read_b128 a[108:111], v2 offset:11264
v_add_f32 v27, v8, v9
v_mfma_f32_16x16x32_bf16 v[140:143], a[72:75], v[104:107], v[140:143]
s_waitcnt lgkmcnt(7)
v_exp_f32 v10, v70
v_mfma_f32_16x16x32_bf16 v[144:147], a[80:83], v[96:99], v[144:147]
s_waitcnt lgkmcnt(6)
ds_read_b128 a[112:115], v2 offset:12288
v_cvt_pk_bf16_f32 v120, v8, v9
v_mfma_f32_16x16x32_bf16 v[144:147], a[84:87], v[100:103], v[144:147]
buffer_load_dwordx4 v[36:39], v1, s[4:7], s22 offen offset:1024 sc1
v_mfma_f32_16x16x32_bf16 v[148:151], a[84:87], v[108:111], v[148:151]
ds_read_b128 a[116:119], v2 offset:13312
v_add_f32 v27, v27, v10
v_mfma_f32_16x16x32_bf16 v[148:151], a[80:83], v[104:107], v[148:151]
s_waitcnt lgkmcnt(7)
v_exp_f32 v11, v71
v_mfma_f32_16x16x32_bf16 v[152:155], a[88:91], v[96:99], v[152:155]
s_waitcnt lgkmcnt(6)
ds_read_b128 a[120:123], v2 offset:14336
v_add_f32 v27, v27, v11
v_mfma_f32_16x16x32_bf16 v[152:155], a[92:95], v[100:103], v[152:155]
buffer_load_dwordx4 v[40:43], v1, s[4:7], s22 offen offset:2048 sc1
v_mfma_f32_16x16x32_bf16 v[156:159], a[92:95], v[108:111], v[156:159]
ds_read_b128 a[124:127], v2 offset:15360
v_cvt_pk_bf16_f32 v121, v10, v11
v_mfma_f32_16x16x32_bf16 v[156:159], a[88:91], v[104:107], v[156:159]
s_waitcnt lgkmcnt(7)
v_exp_f32 v12, v76
v_mfma_f32_16x16x32_bf16 v[160:163], a[96:99], v[96:99], v[160:163]
s_waitcnt lgkmcnt(6)
ds_read_b128 a[64:67], v2 offset:16384
v_add_f32 v27, v27, v12
v_mfma_f32_16x16x32_bf16 v[160:163], a[100:103], v[100:103], v[160:163]
buffer_load_dwordx4 v[44:47], v1, s[4:7], s22 offen offset:3072 sc1
v_mfma_f32_16x16x32_bf16 v[164:167], a[100:103], v[108:111], v[164:167]
ds_read_b128 a[68:71], v2 offset:17408
v_mfma_f32_16x16x32_bf16 v[164:167], a[96:99], v[104:107], v[164:167]
s_waitcnt lgkmcnt(6)
v_exp_f32 v13, v77
v_mfma_f32_16x16x32_bf16 v[168:171], a[104:107], v[96:99], v[168:171]
s_add_u32 s22, s76, 4096
ds_read_b128 a[72:75], v2 offset:18432
v_add_f32 v27, v27, v13
v_mfma_f32_16x16x32_bf16 v[168:171], a[108:111], v[100:103], v[168:171]
buffer_load_dwordx4 v[48:51], v1, s[4:7], s22 offen offset:0 sc1
v_mfma_f32_16x16x32_bf16 v[172:175], a[108:111], v[108:111], v[172:175]
ds_read_b128 a[76:79], v2 offset:19456
v_exp_f32 v14, v78
v_mfma_f32_16x16x32_bf16 v[172:175], a[104:107], v[104:107], v[172:175]
s_waitcnt lgkmcnt(7)
v_exp_f32 v15, v79
v_mfma_f32_16x16x32_bf16 v[176:179], a[112:115], v[96:99], v[176:179]
s_waitcnt lgkmcnt(6)
ds_read_b128 a[80:83], v2 offset:20480
v_cvt_pk_bf16_f32 v122, v12, v13
v_mfma_f32_16x16x32_bf16 v[176:179], a[116:119], v[100:103], v[176:179]
buffer_load_dwordx4 v[52:55], v1, s[4:7], s22 offen offset:1024 sc1
v_mfma_f32_16x16x32_bf16 v[180:183], a[116:119], v[108:111], v[180:183]
ds_read_b128 a[84:87], v2 offset:21504
v_add_f32 v27, v27, v14
v_mfma_f32_16x16x32_bf16 v[180:183], a[112:115], v[104:107], v[180:183]
s_waitcnt lgkmcnt(7)
v_exp_f32 v8, v84
v_mfma_f32_16x16x32_bf16 v[184:187], a[120:123], v[96:99], v[184:187]
s_waitcnt lgkmcnt(6)
ds_read_b128 a[88:91], v2 offset:22528
v_add_f32 v27, v27, v15
v_cvt_pk_bf16_f32 v123, v14, v15
v_mfma_f32_16x16x32_bf16 v[184:187], a[124:127], v[100:103], v[184:187]
buffer_load_dwordx4 v[56:59], v1, s[4:7], s22 offen offset:2048 sc1
v_mfma_f32_16x16x32_bf16 v[188:191], a[124:127], v[108:111], v[188:191]
ds_read_b128 a[92:95], v2 offset:23552
v_add_f32 v27, v27, v8
v_mfma_f32_16x16x32_bf16 v[188:191], a[120:123], v[104:107], v[188:191]
s_waitcnt lgkmcnt(7)
v_exp_f32 v9, v85
v_mfma_f32_16x16x32_bf16 v[192:195], a[64:67], v[96:99], v[192:195]
s_waitcnt lgkmcnt(6)
ds_read_b128 a[96:99], v2 offset:24576
v_add_f32 v27, v27, v9
v_mfma_f32_16x16x32_bf16 v[192:195], a[68:71], v[100:103], v[192:195]
buffer_load_dwordx4 v[60:63], v1, s[4:7], s22 offen offset:3072 sc1
v_mfma_f32_16x16x32_bf16 v[196:199], a[68:71], v[108:111], v[196:199]
ds_read_b128 a[100:103], v2 offset:25600
v_cvt_pk_bf16_f32 v124, v8, v9
v_mfma_f32_16x16x32_bf16 v[196:199], a[64:67], v[104:107], v[196:199]
s_waitcnt lgkmcnt(6)
v_exp_f32 v10, v86
v_mfma_f32_16x16x32_bf16 v[200:203], a[72:75], v[96:99], v[200:203]
s_add_u32 s22, s76, 8192
ds_read_b128 a[104:107], v2 offset:26624
v_add_f32 v27, v27, v10
v_mfma_f32_16x16x32_bf16 v[200:203], a[76:79], v[100:103], v[200:203]
buffer_load_dwordx4 a[32:35], v1, s[4:7], s22 offen offset:0 sc1
v_mfma_f32_16x16x32_bf16 v[204:207], a[76:79], v[108:111], v[204:207]
ds_read_b128 a[108:111], v2 offset:27648
v_mfma_f32_16x16x32_bf16 v[204:207], a[72:75], v[104:107], v[204:207]
s_waitcnt lgkmcnt(7)
v_exp_f32 v11, v87
v_mfma_f32_16x16x32_bf16 v[208:211], a[80:83], v[96:99], v[208:211]
s_waitcnt lgkmcnt(6)
ds_read_b128 a[112:115], v2 offset:28672
v_exp_f32 v12, v92
v_mfma_f32_16x16x32_bf16 v[208:211], a[84:87], v[100:103], v[208:211]
buffer_load_dwordx4 a[36:39], v1, s[4:7], s22 offen offset:1024 sc1
v_mfma_f32_16x16x32_bf16 v[212:215], a[84:87], v[108:111], v[212:215]
ds_read_b128 a[116:119], v2 offset:29696
v_add_f32 v27, v27, v11
v_mfma_f32_16x16x32_bf16 v[212:215], a[80:83], v[104:107], v[212:215]
s_waitcnt lgkmcnt(7)
v_exp_f32 v13, v93
v_mfma_f32_16x16x32_bf16 v[216:219], a[88:91], v[96:99], v[216:219]
s_waitcnt lgkmcnt(6)
ds_read_b128 a[120:123], v2 offset:30720
v_cvt_pk_bf16_f32 v125, v10, v11
v_add_f32 v27, v27, v12
v_mfma_f32_16x16x32_bf16 v[216:219], a[92:95], v[100:103], v[216:219]
buffer_load_dwordx4 a[40:43], v1, s[4:7], s22 offen offset:2048 sc1
v_mfma_f32_16x16x32_bf16 v[220:223], a[92:95], v[108:111], v[220:223]
ds_read_b128 a[124:127], v2 offset:31744
v_add_f32 v27, v27, v13
v_mfma_f32_16x16x32_bf16 v[220:223], a[88:91], v[104:107], v[220:223]
s_waitcnt vmcnt(12) lgkmcnt(7)
s_barrier
v_cvt_pk_bf16_f32 v126, v12, v13
v_mfma_f32_16x16x32_bf16 v[224:227], a[96:99], v[96:99], v[224:227]
s_waitcnt lgkmcnt(6)
ds_read_b128 a[64:67], v1 offset:0
v_mfma_f32_16x16x32_bf16 v[224:227], a[100:103], v[100:103], v[224:227]
buffer_load_dwordx4 a[44:47], v1, s[4:7], s22 offen offset:3072 sc1
v_mfma_f32_16x16x32_bf16 v[228:231], a[100:103], v[108:111], v[228:231]
ds_read_b128 a[68:71], v1 offset:1024
v_mfma_f32_16x16x32_bf16 v[228:231], a[96:99], v[104:107], v[228:231]
s_waitcnt lgkmcnt(6)
v_exp_f32 v14, v94
v_mfma_f32_16x16x32_bf16 v[232:235], a[104:107], v[96:99], v[232:235]
s_add_u32 s22, s76, 12288
ds_read_b128 a[72:75], v1 offset:2048
v_add_f32 v27, v27, v14
v_mfma_f32_16x16x32_bf16 v[232:235], a[108:111], v[100:103], v[232:235]
buffer_load_dwordx4 a[48:51], v1, s[4:7], s22 offen offset:0 sc1
v_mfma_f32_16x16x32_bf16 v[236:239], a[108:111], v[108:111], v[236:239]
ds_read_b128 a[76:79], v1 offset:3072
v_mfma_f32_16x16x32_bf16 v[236:239], a[104:107], v[104:107], v[236:239]
s_waitcnt lgkmcnt(7)
v_exp_f32 v15, v95
v_mfma_f32_16x16x32_bf16 v[240:243], a[112:115], v[96:99], v[240:243]
s_waitcnt lgkmcnt(6)
ds_read_b128 a[80:83], v1 offset:4096
v_add_f32 v27, v27, v15
v_mfma_f32_16x16x32_bf16 v[240:243], a[116:119], v[100:103], v[240:243]
buffer_load_dwordx4 a[52:55], v1, s[4:7], s22 offen offset:1024 sc1
v_mfma_f32_16x16x32_bf16 v[244:247], a[116:119], v[108:111], v[244:247]
ds_read_b128 a[84:87], v1 offset:5120
v_cvt_pk_bf16_f32 v127, v14, v15
v_mfma_f32_16x16x32_bf16 v[244:247], a[112:115], v[104:107], v[244:247]
s_waitcnt lgkmcnt(7)
v_cmp_nge_f32 vcc, s25, v27
v_mfma_f32_16x16x32_bf16 v[248:251], a[120:123], v[96:99], v[248:251]
s_waitcnt lgkmcnt(6)
ds_read_b128 a[88:91], v1 offset:6144
v_mfma_f32_16x16x32_bf16 v[248:251], a[124:127], v[100:103], v[248:251]
buffer_load_dwordx4 a[56:59], v1, s[4:7], s22 offen offset:2048 sc1
v_mfma_f32_16x16x32_bf16 v[252:255], a[124:127], v[108:111], v[252:255]
ds_read_b128 a[92:95], v1 offset:7168
v_mfma_f32_16x16x32_bf16 v[252:255], a[120:123], v[104:107], v[252:255]
s_waitcnt lgkmcnt(2)
buffer_load_dwordx4 a[60:63], v1, s[4:7], s22 offen offset:3072 sc1
s_cbranch_vccnz Lstub_11
Lback_12:
v_mfma_f32_16x16x32_bf16 v[132:135], a[64:67], v[120:123], v[132:135]
s_mov_b64 s[36:37], s[86:87]
ds_read_b128 a[96:99], v1 offset:8192
v_add_f32 v25, v25, v27
v_mfma_f32_16x16x32_bf16 v[132:135], a[68:71], v[124:127], v[132:135]
s_mov_b32 s38, 3670016
ds_read_b128 a[100:103], v1 offset:9216
v_accvgpr_read_b32 v112, a184
v_mfma_f32_16x16x32_bf16 v[140:143], a[72:75], v[120:123], v[140:143]
s_mov_b32 s39, 0x20000
ds_read_b128 a[104:107], v1 offset:10240
v_accvgpr_read_b32 v113, a185
v_mfma_f32_16x16x32_bf16 v[140:143], a[76:79], v[124:127], v[140:143]
s_lshl_b32 s8, s29, 3
ds_read_b128 a[108:111], v1 offset:11264
v_accvgpr_read_b32 v114, a186
v_mfma_f32_16x16x32_bf16 v[148:151], a[80:83], v[120:123], v[148:151]
s_add_u32 s8, s8, s3
ds_read_b128 a[112:115], v1 offset:12288
v_accvgpr_read_b32 v115, a187
v_mfma_f32_16x16x32_bf16 v[148:151], a[84:87], v[124:127], v[148:151]
s_waitcnt lgkmcnt(3)
s_lshl_b32 s8, s8, 4
ds_read_b128 a[116:119], v1 offset:13312
v_accvgpr_read_b32 v116, a188
v_mfma_f32_16x16x32_bf16 v[156:159], a[88:91], v[120:123], v[156:159]
s_add_u32 s8, s8, s20
ds_read_b128 a[120:123], v1 offset:14336
v_accvgpr_read_b32 v117, a189
v_mfma_f32_16x16x32_bf16 v[156:159], a[92:95], v[124:127], v[156:159]
s_mul_i32 s8, s8, 14336
ds_read_b128 a[124:127], v1 offset:15360
v_accvgpr_read_b32 v118, a190
v_mfma_f32_16x16x32_bf16 v[164:167], a[96:99], v[120:123], v[164:167]
s_add_u32 s8, s8, 104857600
ds_read_b128 a[64:67], v1 offset:16384
v_accvgpr_read_b32 v119, a191
v_mfma_f32_16x16x32_bf16 v[164:167], a[100:103], v[124:127], v[164:167]
s_waitcnt lgkmcnt(6)
s_add_u32 s12, s8, 917504
ds_read_b128 a[68:71], v1 offset:17408
v_mfma_f32_16x16x32_bf16 v[172:175], a[104:107], v[120:123], v[172:175]
s_waitcnt lgkmcnt(6)
ds_read_b128 a[72:75], v1 offset:18432
v_mfma_f32_16x16x32_bf16 v[172:175], a[108:111], v[124:127], v[172:175]
s_waitcnt lgkmcnt(6)
ds_read_b128 a[76:79], v1 offset:19456
v_mfma_f32_16x16x32_bf16 v[180:183], a[112:115], v[120:123], v[180:183]
s_waitcnt lgkmcnt(6)
ds_read_b128 a[80:83], v1 offset:20480
v_mfma_f32_16x16x32_bf16 v[180:183], a[116:119], v[124:127], v[180:183]
s_waitcnt lgkmcnt(6)
ds_read_b128 a[84:87], v1 offset:21504
v_mfma_f32_16x16x32_bf16 v[188:191], a[120:123], v[120:123], v[188:191]
s_waitcnt lgkmcnt(6)
ds_read_b128 a[88:91], v1 offset:22528
v_mfma_f32_16x16x32_bf16 v[188:191], a[124:127], v[124:127], v[188:191]
s_waitcnt lgkmcnt(6)
ds_read_b128 a[92:95], v1 offset:23552
v_mfma_f32_16x16x32_bf16 v[196:199], a[64:67], v[120:123], v[196:199]
s_waitcnt lgkmcnt(6)
ds_read_b128 a[96:99], v1 offset:24576
v_mfma_f32_16x16x32_bf16 v[196:199], a[68:71], v[124:127], v[196:199]
s_waitcnt lgkmcnt(6)
ds_read_b128 a[100:103], v1 offset:25600
v_mfma_f32_16x16x32_bf16 v[204:207], a[72:75], v[120:123], v[204:207]
s_waitcnt lgkmcnt(6)
ds_read_b128 a[104:107], v1 offset:26624
v_mfma_f32_16x16x32_bf16 v[204:207], a[76:79], v[124:127], v[204:207]
s_waitcnt lgkmcnt(6)
ds_read_b128 a[108:111], v1 offset:27648
v_mfma_f32_16x16x32_bf16 v[212:215], a[80:83], v[120:123], v[212:215]
s_waitcnt lgkmcnt(6)
ds_read_b128 a[112:115], v1 offset:28672
v_mfma_f32_16x16x32_bf16 v[212:215], a[84:87], v[124:127], v[212:215]
s_waitcnt lgkmcnt(6)
ds_read_b128 a[116:119], v1 offset:29696
v_mfma_f32_16x16x32_bf16 v[220:223], a[88:91], v[120:123], v[220:223]
s_waitcnt lgkmcnt(6)
s_add_u32 m0, s18, 32768
ds_read_b128 a[120:123], v1 offset:30720
v_mfma_f32_16x16x32_bf16 v[220:223], a[92:95], v[124:127], v[220:223]
s_waitcnt lgkmcnt(6)
ds_read_b128 a[124:127], v1 offset:31744
v_mfma_f32_16x16x32_bf16 v[228:231], a[96:99], v[120:123], v[228:231]
s_waitcnt lgkmcnt(6)
buffer_load_dwordx4 v112, s[36:39], s81 offen offset:0 lds
v_mfma_f32_16x16x32_bf16 v[228:231], a[100:103], v[124:127], v[228:231]
s_waitcnt lgkmcnt(5)
buffer_load_dwordx4 v113, s[36:39], s81 offen offset:1024 lds
v_mfma_f32_16x16x32_bf16 v[236:239], a[104:107], v[120:123], v[236:239]
s_waitcnt lgkmcnt(4)
buffer_load_dwordx4 v114, s[36:39], s81 offen offset:2048 lds
v_mfma_f32_16x16x32_bf16 v[236:239], a[108:111], v[124:127], v[236:239]
s_waitcnt lgkmcnt(3)
buffer_load_dwordx4 v115, s[36:39], s81 offen offset:3072 lds
v_mfma_f32_16x16x32_bf16 v[244:247], a[112:115], v[120:123], v[244:247]
s_waitcnt lgkmcnt(2)
s_add_u32 s81, s81, 28672
v_mfma_f32_16x16x32_bf16 v[244:247], a[116:119], v[124:127], v[244:247]
s_waitcnt lgkmcnt(1)
s_add_u32 m0, s18, 36864
v_mfma_f32_16x16x32_bf16 v[252:255], a[120:123], v[120:123], v[252:255]
s_waitcnt lgkmcnt(0)
buffer_load_dwordx4 v112, s[36:39], s81 offen offset:0 lds
v_mfma_f32_16x16x32_bf16 v[252:255], a[124:127], v[124:127], v[252:255]
buffer_load_dwordx4 v113, s[36:39], s81 offen offset:1024 lds
buffer_load_dwordx4 v114, s[36:39], s81 offen offset:2048 lds
buffer_load_dwordx4 v115, s[36:39], s81 offen offset:3072 lds
s_sub_u32 s81, s81, 28544
s_waitcnt vmcnt(8)
v_sub_f32 v8, v16, v28
v_sub_f32 v10, v20, v30
v_max_f32 v9, v8, v10
v_cmp_lt_f32 vcc, 1114636288, v9
s_cbranch_vccnz K2_cfix
K2_cok:
v_exp_f32 v8, v8
v_exp_f32 v10, v10
s_nop 0
v_mov_b32 v9, v8
v_mov_b32 v11, v10
v_fmac_f32 v24, v8, v29
v_fmac_f32 v25, v10, v31
s_mov_b32 s23, 0xffff0000
v_lshlrev_b32 v64, 16, v32
v_and_b32 v65, s23, v32
v_lshlrev_b32 v66, 16, v33
v_and_b32 v67, s23, v33
v_lshlrev_b32 v68, 16, v34
v_and_b32 v69, s23, v34
v_lshlrev_b32 v70, 16, v35
v_and_b32 v71, s23, v35
v_pk_fma_f32 v[128:129], v[64:65], v[8:9], v[128:129]
v_pk_fma_f32 v[130:131], v[66:67], v[8:9], v[130:131]
v_pk_fma_f32 v[136:137], v[68:69], v[8:9], v[136:137]
v_pk_fma_f32 v[138:139], v[70:71], v[8:9], v[138:139]
v_cvt_pk_bf16_f32 v128, v128, v129
v_cvt_pk_bf16_f32 v129, v130, v131
v_cvt_pk_bf16_f32 v130, v136, v137
v_cvt_pk_bf16_f32 v131, v138, v139
s_add_u32 m0, s18, 98304
s_nop 0
buffer_load_dwordx4 v112, s[36:39], s81 offen offset:0 lds
v_lshlrev_b32 v64, 16, v36
v_and_b32 v65, s23, v36
v_lshlrev_b32 v66, 16, v37
v_and_b32 v67, s23, v37
v_lshlrev_b32 v68, 16, v38
v_and_b32 v69, s23, v38
v_lshlrev_b32 v70, 16, v39
v_and_b32 v71, s23, v39
v_pk_fma_f32 v[144:145], v[64:65], v[8:9], v[144:145]
v_pk_fma_f32 v[146:147], v[66:67], v[8:9], v[146:147]
v_pk_fma_f32 v[152:153], v[68:69], v[8:9], v[152:153]
v_pk_fma_f32 v[154:155], v[70:71], v[8:9], v[154:155]
v_cvt_pk_bf16_f32 v144, v144, v145
v_cvt_pk_bf16_f32 v145, v146, v147
v_cvt_pk_bf16_f32 v146, v152, v153
v_cvt_pk_bf16_f32 v147, v154, v155
buffer_load_dwordx4 v113, s[36:39], s81 offen offset:1024 lds
v_lshlrev_b32 v64, 16, v40
v_and_b32 v65, s23, v40
v_lshlrev_b32 v66, 16, v41
v_and_b32 v67, s23, v41
v_lshlrev_b32 v68, 16, v42
v_and_b32 v69, s23, v42
v_lshlrev_b32 v70, 16, v43
v_and_b32 v71, s23, v43
v_pk_fma_f32 v[160:161], v[64:65], v[8:9], v[160:161]
v_pk_fma_f32 v[162:163], v[66:67], v[8:9], v[162:163]
v_pk_fma_f32 v[168:169], v[68:69], v[8:9], v[168:169]
v_pk_fma_f32 v[170:171], v[70:71], v[8:9], v[170:171]
v_cvt_pk_bf16_f32 v160, v160, v161
v_cvt_pk_bf16_f32 v161, v162, v163
v_cvt_pk_bf16_f32 v162, v168, v169
v_cvt_pk_bf16_f32 v163, v170, v171
buffer_load_dwordx4 v114, s[36:39], s81 offen offset:2048 lds
v_lshlrev_b32 v64, 16, v44
v_and_b32 v65, s23, v44
v_lshlrev_b32 v66, 16, v45
v_and_b32 v67, s23, v45
v_lshlrev_b32 v68, 16, v46
v_and_b32 v69, s23, v46
v_lshlrev_b32 v70, 16, v47
v_and_b32 v71, s23, v47
v_pk_fma_f32 v[176:177], v[64:65], v[8:9], v[176:177]
v_pk_fma_f32 v[178:179], v[66:67], v[8:9], v[178:179]
v_pk_fma_f32 v[184:185], v[68:69], v[8:9], v[184:185]
v_pk_fma_f32 v[186:187], v[70:71], v[8:9], v[186:187]
v_cvt_pk_bf16_f32 v176, v176, v177
v_cvt_pk_bf16_f32 v177, v178, v179
v_cvt_pk_bf16_f32 v178, v184, v185
v_cvt_pk_bf16_f32 v179, v186, v187
buffer_load_dwordx4 v115, s[36:39], s81 offen offset:3072 lds
v_lshlrev_b32 v64, 16, v48
v_and_b32 v65, s23, v48
v_lshlrev_b32 v66, 16, v49
v_and_b32 v67, s23, v49
v_lshlrev_b32 v68, 16, v50
v_and_b32 v69, s23, v50
v_lshlrev_b32 v70, 16, v51
v_and_b32 v71, s23, v51
v_pk_fma_f32 v[192:193], v[64:65], v[8:9], v[192:193]
v_pk_fma_f32 v[194:195], v[66:67], v[8:9], v[194:195]
v_pk_fma_f32 v[200:201], v[68:69], v[8:9], v[200:201]
v_pk_fma_f32 v[202:203], v[70:71], v[8:9], v[202:203]
v_cvt_pk_bf16_f32 v192, v192, v193
v_cvt_pk_bf16_f32 v193, v194, v195
v_cvt_pk_bf16_f32 v194, v200, v201
v_cvt_pk_bf16_f32 v195, v202, v203
s_add_u32 s81, s81, 28672
s_add_u32 m0, s18, 102400
s_nop 0
buffer_load_dwordx4 v112, s[36:39], s81 offen offset:0 lds
v_lshlrev_b32 v64, 16, v52
v_and_b32 v65, s23, v52
v_lshlrev_b32 v66, 16, v53
v_and_b32 v67, s23, v53
v_lshlrev_b32 v68, 16, v54
v_and_b32 v69, s23, v54
v_lshlrev_b32 v70, 16, v55
v_and_b32 v71, s23, v55
v_pk_fma_f32 v[208:209], v[64:65], v[8:9], v[208:209]
v_pk_fma_f32 v[210:211], v[66:67], v[8:9], v[210:211]
v_pk_fma_f32 v[216:217], v[68:69], v[8:9], v[216:217]
v_pk_fma_f32 v[218:219], v[70:71], v[8:9], v[218:219]
v_cvt_pk_bf16_f32 v208, v208, v209
v_cvt_pk_bf16_f32 v209, v210, v211
v_cvt_pk_bf16_f32 v210, v216, v217
v_cvt_pk_bf16_f32 v211, v218, v219
buffer_load_dwordx4 v113, s[36:39], s81 offen offset:1024 lds
v_lshlrev_b32 v64, 16, v56
v_and_b32 v65, s23, v56
v_lshlrev_b32 v66, 16, v57
v_and_b32 v67, s23, v57
v_lshlrev_b32 v68, 16, v58
v_and_b32 v69, s23, v58
v_lshlrev_b32 v70, 16, v59
v_and_b32 v71, s23, v59
v_pk_fma_f32 v[224:225], v[64:65], v[8:9], v[224:225]
v_pk_fma_f32 v[226:227], v[66:67], v[8:9], v[226:227]
v_pk_fma_f32 v[232:233], v[68:69], v[8:9], v[232:233]
v_pk_fma_f32 v[234:235], v[70:71], v[8:9], v[234:235]
v_cvt_pk_bf16_f32 v224, v224, v225
v_cvt_pk_bf16_f32 v225, v226, v227
v_cvt_pk_bf16_f32 v226, v232, v233
v_cvt_pk_bf16_f32 v227, v234, v235
buffer_load_dwordx4 v114, s[36:39], s81 offen offset:2048 lds
v_lshlrev_b32 v64, 16, v60
v_and_b32 v65, s23, v60
v_lshlrev_b32 v66, 16, v61
v_and_b32 v67, s23, v61
v_lshlrev_b32 v68, 16, v62
v_and_b32 v69, s23, v62
v_lshlrev_b32 v70, 16, v63
v_and_b32 v71, s23, v63
v_pk_fma_f32 v[240:241], v[64:65], v[8:9], v[240:241]
v_pk_fma_f32 v[242:243], v[66:67], v[8:9], v[242:243]
v_pk_fma_f32 v[248:249], v[68:69], v[8:9], v[248:249]
v_pk_fma_f32 v[250:251], v[70:71], v[8:9], v[250:251]
v_cvt_pk_bf16_f32 v240, v240, v241
v_cvt_pk_bf16_f32 v241, v242, v243
v_cvt_pk_bf16_f32 v242, v248, v249
v_cvt_pk_bf16_f32 v243, v250, v251
buffer_load_dwordx4 v115, s[36:39], s81 offen offset:3072 lds
v_accvgpr_read_b32 v32, a32
v_accvgpr_read_b32 v33, a33
v_accvgpr_read_b32 v34, a34
v_accvgpr_read_b32 v35, a35
v_lshlrev_b32 v64, 16, v32
v_and_b32 v65, s23, v32
v_lshlrev_b32 v66, 16, v33
v_and_b32 v67, s23, v33
v_lshlrev_b32 v68, 16, v34
v_and_b32 v69, s23, v34
v_lshlrev_b32 v70, 16, v35
v_and_b32 v71, s23, v35
v_pk_fma_f32 v[132:133], v[64:65], v[10:11], v[132:133]
v_pk_fma_f32 v[134:135], v[66:67], v[10:11], v[134:135]
v_pk_fma_f32 v[140:141], v[68:69], v[10:11], v[140:141]
v_pk_fma_f32 v[142:143], v[70:71], v[10:11], v[142:143]
v_cvt_pk_bf16_f32 v132, v132, v133
v_cvt_pk_bf16_f32 v133, v134, v135
v_cvt_pk_bf16_f32 v134, v140, v141
v_cvt_pk_bf16_f32 v135, v142, v143
s_sub_u32 s81, s81, 28544
s_add_u32 m0, s18, 131072
s_nop 0
buffer_load_dwordx4 v112, s[36:39], s81 offen offset:0 lds
v_accvgpr_read_b32 v36, a36
v_accvgpr_read_b32 v37, a37
v_accvgpr_read_b32 v38, a38
v_accvgpr_read_b32 v39, a39
v_lshlrev_b32 v64, 16, v36
v_and_b32 v65, s23, v36
v_lshlrev_b32 v66, 16, v37
v_and_b32 v67, s23, v37
v_lshlrev_b32 v68, 16, v38
v_and_b32 v69, s23, v38
v_lshlrev_b32 v70, 16, v39
v_and_b32 v71, s23, v39
v_pk_fma_f32 v[148:149], v[64:65], v[10:11], v[148:149]
v_pk_fma_f32 v[150:151], v[66:67], v[10:11], v[150:151]
v_pk_fma_f32 v[156:157], v[68:69], v[10:11], v[156:157]
v_pk_fma_f32 v[158:159], v[70:71], v[10:11], v[158:159]
v_cvt_pk_bf16_f32 v148, v148, v149
v_cvt_pk_bf16_f32 v149, v150, v151
v_cvt_pk_bf16_f32 v150, v156, v157
v_cvt_pk_bf16_f32 v151, v158, v159
buffer_load_dwordx4 v113, s[36:39], s81 offen offset:1024 lds
v_accvgpr_read_b32 v40, a40
v_accvgpr_read_b32 v41, a41
v_accvgpr_read_b32 v42, a42
v_accvgpr_read_b32 v43, a43
v_lshlrev_b32 v64, 16, v40
v_and_b32 v65, s23, v40
v_lshlrev_b32 v66, 16, v41
v_and_b32 v67, s23, v41
v_lshlrev_b32 v68, 16, v42
v_and_b32 v69, s23, v42
v_lshlrev_b32 v70, 16, v43
v_and_b32 v71, s23, v43
v_pk_fma_f32 v[164:165], v[64:65], v[10:11], v[164:165]
v_pk_fma_f32 v[166:167], v[66:67], v[10:11], v[166:167]
v_pk_fma_f32 v[172:173], v[68:69], v[10:11], v[172:173]
v_pk_fma_f32 v[174:175], v[70:71], v[10:11], v[174:175]
v_cvt_pk_bf16_f32 v164, v164, v165
v_cvt_pk_bf16_f32 v165, v166, v167
v_cvt_pk_bf16_f32 v166, v172, v173
v_cvt_pk_bf16_f32 v167, v174, v175
buffer_load_dwordx4 v114, s[36:39], s81 offen offset:2048 lds
v_accvgpr_read_b32 v44, a44
v_accvgpr_read_b32 v45, a45
v_accvgpr_read_b32 v46, a46
v_accvgpr_read_b32 v47, a47
v_lshlrev_b32 v64, 16, v44
v_and_b32 v65, s23, v44
v_lshlrev_b32 v66, 16, v45
v_and_b32 v67, s23, v45
v_lshlrev_b32 v68, 16, v46
v_and_b32 v69, s23, v46
v_lshlrev_b32 v70, 16, v47
v_and_b32 v71, s23, v47
v_pk_fma_f32 v[180:181], v[64:65], v[10:11], v[180:181]
v_pk_fma_f32 v[182:183], v[66:67], v[10:11], v[182:183]
v_pk_fma_f32 v[188:189], v[68:69], v[10:11], v[188:189]
v_pk_fma_f32 v[190:191], v[70:71], v[10:11], v[190:191]
v_cvt_pk_bf16_f32 v180, v180, v181
v_cvt_pk_bf16_f32 v181, v182, v183
v_cvt_pk_bf16_f32 v182, v188, v189
v_cvt_pk_bf16_f32 v183, v190, v191
buffer_load_dwordx4 v115, s[36:39], s81 offen offset:3072 lds
v_accvgpr_read_b32 v48, a48
v_accvgpr_read_b32 v49, a49
v_accvgpr_read_b32 v50, a50
v_accvgpr_read_b32 v51, a51
v_lshlrev_b32 v64, 16, v48
v_and_b32 v65, s23, v48
v_lshlrev_b32 v66, 16, v49
v_and_b32 v67, s23, v49
v_lshlrev_b32 v68, 16, v50
v_and_b32 v69, s23, v50
v_lshlrev_b32 v70, 16, v51
v_and_b32 v71, s23, v51
v_pk_fma_f32 v[196:197], v[64:65], v[10:11], v[196:197]
v_pk_fma_f32 v[198:199], v[66:67], v[10:11], v[198:199]
v_pk_fma_f32 v[204:205], v[68:69], v[10:11], v[204:205]
v_pk_fma_f32 v[206:207], v[70:71], v[10:11], v[206:207]
v_cvt_pk_bf16_f32 v196, v196, v197
v_cvt_pk_bf16_f32 v197, v198, v199
v_cvt_pk_bf16_f32 v198, v204, v205
v_cvt_pk_bf16_f32 v199, v206, v207
s_add_u32 s81, s81, 28672
s_add_u32 m0, s18, 135168
s_nop 0
buffer_load_dwordx4 v112, s[36:39], s81 offen offset:0 lds
v_accvgpr_read_b32 v52, a52
v_accvgpr_read_b32 v53, a53
v_accvgpr_read_b32 v54, a54
v_accvgpr_read_b32 v55, a55
v_lshlrev_b32 v64, 16, v52
v_and_b32 v65, s23, v52
v_lshlrev_b32 v66, 16, v53
v_and_b32 v67, s23, v53
v_lshlrev_b32 v68, 16, v54
v_and_b32 v69, s23, v54
v_lshlrev_b32 v70, 16, v55
v_and_b32 v71, s23, v55
v_pk_fma_f32 v[212:213], v[64:65], v[10:11], v[212:213]
v_pk_fma_f32 v[214:215], v[66:67], v[10:11], v[214:215]
v_pk_fma_f32 v[220:221], v[68:69], v[10:11], v[220:221]
v_pk_fma_f32 v[222:223], v[70:71], v[10:11], v[222:223]
v_cvt_pk_bf16_f32 v212, v212, v213
v_cvt_pk_bf16_f32 v213, v214, v215
v_cvt_pk_bf16_f32 v214, v220, v221
v_cvt_pk_bf16_f32 v215, v222, v223
buffer_load_dwordx4 v113, s[36:39], s81 offen offset:1024 lds
v_accvgpr_read_b32 v56, a56
v_accvgpr_read_b32 v57, a57
v_accvgpr_read_b32 v58, a58
v_accvgpr_read_b32 v59, a59
v_lshlrev_b32 v64, 16, v56
v_and_b32 v65, s23, v56
v_lshlrev_b32 v66, 16, v57
v_and_b32 v67, s23, v57
v_lshlrev_b32 v68, 16, v58
v_and_b32 v69, s23, v58
v_lshlrev_b32 v70, 16, v59
v_and_b32 v71, s23, v59
v_pk_fma_f32 v[228:229], v[64:65], v[10:11], v[228:229]
v_pk_fma_f32 v[230:231], v[66:67], v[10:11], v[230:231]
v_pk_fma_f32 v[236:237], v[68:69], v[10:11], v[236:237]
v_pk_fma_f32 v[238:239], v[70:71], v[10:11], v[238:239]
v_cvt_pk_bf16_f32 v228, v228, v229
v_cvt_pk_bf16_f32 v229, v230, v231
v_cvt_pk_bf16_f32 v230, v236, v237
v_cvt_pk_bf16_f32 v231, v238, v239
buffer_load_dwordx4 v114, s[36:39], s81 offen offset:2048 lds
v_accvgpr_read_b32 v60, a60
v_accvgpr_read_b32 v61, a61
v_accvgpr_read_b32 v62, a62
v_accvgpr_read_b32 v63, a63
v_lshlrev_b32 v64, 16, v60
v_and_b32 v65, s23, v60
v_lshlrev_b32 v66, 16, v61
v_and_b32 v67, s23, v61
v_lshlrev_b32 v68, 16, v62
v_and_b32 v69, s23, v62
v_lshlrev_b32 v70, 16, v63
v_and_b32 v71, s23, v63
v_pk_fma_f32 v[244:245], v[64:65], v[10:11], v[244:245]
v_pk_fma_f32 v[246:247], v[66:67], v[10:11], v[246:247]
v_pk_fma_f32 v[252:253], v[68:69], v[10:11], v[252:253]
v_pk_fma_f32 v[254:255], v[70:71], v[10:11], v[254:255]
v_cvt_pk_bf16_f32 v244, v244, v245
v_cvt_pk_bf16_f32 v245, v246, v247
v_cvt_pk_bf16_f32 v246, v252, v253
v_cvt_pk_bf16_f32 v247, v254, v255
buffer_load_dwordx4 v115, s[36:39], s81 offen offset:3072 lds
s_sub_u32 s81, s81, 28544
K2_done:
s_waitcnt vmcnt(16)
s_barrier
ds_read_b64_tr_b16 a[64:65], v116 offset:0
ds_read_b64_tr_b16 a[66:67], v116 offset:2048
ds_read_b64_tr_b16 a[68:69], v116 offset:4096
ds_read_b64_tr_b16 a[70:71], v116 offset:6144
ds_read_b64_tr_b16 a[72:73], v116 offset:8192
ds_read_b64_tr_b16 a[74:75], v116 offset:10240
ds_read_b64_tr_b16 a[76:77], v116 offset:12288
ds_read_b64_tr_b16 a[78:79], v116 offset:14336
ds_read_b64_tr_b16 a[80:81], v116 offset:16384
ds_read_b64_tr_b16 a[82:83], v116 offset:18432
ds_read_b64_tr_b16 a[84:85], v116 offset:20480
ds_read_b64_tr_b16 a[86:87], v116 offset:22528
ds_read_b64_tr_b16 a[88:89], v116 offset:24576
ds_read_b64_tr_b16 a[90:91], v116 offset:26624
ds_read_b64_tr_b16 a[92:93], v116 offset:28672
ds_read_b64_tr_b16 a[94:95], v116 offset:30720
v_add_u32 v116, 65536, v116
s_waitcnt lgkmcnt(14)
v_mfma_f32_16x16x32_bf16 v[32:35], a[64:67], v[128:131], 0
s_waitcnt lgkmcnt(12)
s_add_u32 m0, s18, 65536
ds_read_b64_tr_b16 a[96:97], v117 offset:0
v_mov_b32 v28, v24
v_mfma_f32_16x16x32_bf16 v[32:35], a[68:71], v[144:147], v[32:35]
s_waitcnt lgkmcnt(11)
ds_read_b64_tr_b16 a[98:99], v117 offset:2048
buffer_load_dwordx4 v112, s[36:39], s81 offen offset:0 lds
v_mfma_f32_16x16x32_bf16 v[32:35], a[72:75], v[160:163], v[32:35]
s_waitcnt lgkmcnt(10)
ds_read_b64_tr_b16 a[100:101], v117 offset:4096
v_permlane16_swap_b32 v24, v28
v_mfma_f32_16x16x32_bf16 v[32:35], a[76:79], v[176:179], v[32:35]
s_waitcnt lgkmcnt(9)
ds_read_b64_tr_b16 a[102:103], v117 offset:6144
v_add_f32 v24, v24, v28
v_mfma_f32_16x16x32_bf16 v[32:35], a[80:83], v[192:195], v[32:35]
s_waitcnt lgkmcnt(8)
ds_read_b64_tr_b16 a[104:105], v117 offset:8192
v_mov_b32 v28, v24
v_mfma_f32_16x16x32_bf16 v[32:35], a[84:87], v[208:211], v[32:35]
s_waitcnt lgkmcnt(7)
ds_read_b64_tr_b16 a[106:107], v117 offset:10240
v_lshrrev_b32 v20, 4, v1
v_mfma_f32_16x16x32_bf16 v[32:35], a[88:91], v[224:227], v[32:35]
s_waitcnt lgkmcnt(6)
ds_read_b64_tr_b16 a[108:109], v117 offset:12288
v_permlane32_swap_b32 v24, v28
v_mfma_f32_16x16x32_bf16 v[32:35], a[92:95], v[240:243], v[32:35]
ds_read_b64_tr_b16 a[110:111], v117 offset:14336
v_add_f32 v24, v24, v28
v_mfma_f32_16x16x32_bf16 v[36:39], a[64:67], v[132:135], 0
ds_read_b64_tr_b16 a[112:113], v117 offset:16384
buffer_load_dwordx4 v113, s[36:39], s81 offen offset:1024 lds
v_mfma_f32_16x16x32_bf16 v[36:39], a[68:71], v[148:151], v[36:39]
ds_read_b64_tr_b16 a[114:115], v117 offset:18432
v_mov_b32 v29, v25
v_mfma_f32_16x16x32_bf16 v[36:39], a[72:75], v[164:167], v[36:39]
ds_read_b64_tr_b16 a[116:117], v117 offset:20480
v_and_b32 v19, 15, v20
v_mfma_f32_16x16x32_bf16 v[36:39], a[76:79], v[180:183], v[36:39]
ds_read_b64_tr_b16 a[118:119], v117 offset:22528
v_permlane16_swap_b32 v25, v29
v_mfma_f32_16x16x32_bf16 v[36:39], a[80:83], v[196:199], v[36:39]
ds_read_b64_tr_b16 a[120:121], v117 offset:24576
v_add_f32 v25, v25, v29
v_mfma_f32_16x16x32_bf16 v[36:39], a[84:87], v[212:215], v[36:39]
ds_read_b64_tr_b16 a[122:123], v117 offset:26624
v_mov_b32 v29, v25
v_mfma_f32_16x16x32_bf16 v[36:39], a[88:91], v[228:231], v[36:39]
ds_read_b64_tr_b16 a[124:125], v117 offset:28672
v_mul_u32_u24 v21, 1792, v19
v_mfma_f32_16x16x32_bf16 v[36:39], a[92:95], v[244:247], v[36:39]
s_waitcnt lgkmcnt(13)
ds_read_b64_tr_b16 a[126:127], v117 offset:30720
v_add_u32 v117, 65536, v117
v_mfma_f32_16x16x32_bf16 v[40:43], a[96:99], v[128:131], 0
s_waitcnt lgkmcnt(12)
ds_read_b64_tr_b16 a[64:65], v118 offset:0
buffer_load_dwordx4 v114, s[36:39], s81 offen offset:2048 lds
v_mfma_f32_16x16x32_bf16 v[40:43], a[100:103], v[144:147], v[40:43]
s_waitcnt lgkmcnt(11)
ds_read_b64_tr_b16 a[66:67], v118 offset:2048
v_permlane32_swap_b32 v25, v29
v_mfma_f32_16x16x32_bf16 v[40:43], a[104:107], v[160:163], v[40:43]
s_waitcnt lgkmcnt(10)
ds_read_b64_tr_b16 a[68:69], v118 offset:4096
v_add_f32 v25, v25, v29
v_mfma_f32_16x16x32_bf16 v[40:43], a[108:111], v[176:179], v[40:43]
s_waitcnt lgkmcnt(9)
ds_read_b64_tr_b16 a[70:71], v118 offset:6144
v_rcp_f32 v24, v24
v_mfma_f32_16x16x32_bf16 v[40:43], a[112:115], v[192:195], v[40:43]
s_waitcnt lgkmcnt(8)
ds_read_b64_tr_b16 a[72:73], v118 offset:8192
v_rcp_f32 v25, v25
v_mfma_f32_16x16x32_bf16 v[40:43], a[116:119], v[208:211], v[40:43]
s_waitcnt lgkmcnt(7)
ds_read_b64_tr_b16 a[74:75], v118 offset:10240
v_lshlrev_b32 v19, 2, v19
v_mfma_f32_16x16x32_bf16 v[40:43], a[120:123], v[224:227], v[40:43]
s_waitcnt lgkmcnt(6)
ds_read_b64_tr_b16 a[76:77], v118 offset:12288
v_lshrrev_b32 v22, 4, v20
v_mfma_f32_16x16x32_bf16 v[40:43], a[124:127], v[240:243], v[40:43]
ds_read_b64_tr_b16 a[78:79], v118 offset:14336
buffer_load_dwordx4 v115, s[36:39], s81 offen offset:3072 lds
v_mfma_f32_16x16x32_bf16 v[44:47], a[96:99], v[132:135], 0
ds_read_b64_tr_b16 a[80:81], v118 offset:16384
v_lshl_add_u32 v21, v22, 3, v21
v_mfma_f32_16x16x32_bf16 v[44:47], a[100:103], v[148:151], v[44:47]
ds_read_b64_tr_b16 a[82:83], v118 offset:18432
v_mfma_f32_16x16x32_bf16 v[44:47], a[104:107], v[164:167], v[44:47]
ds_read_b64_tr_b16 a[84:85], v118 offset:20480
v_mfma_f32_16x16x32_bf16 v[44:47], a[108:111], v[180:183], v[44:47]
ds_read_b64_tr_b16 a[86:87], v118 offset:22528
v_mfma_f32_16x16x32_bf16 v[44:47], a[112:115], v[196:199], v[44:47]
ds_read_b64_tr_b16 a[88:89], v118 offset:24576
v_mul_f32 v32, v32, v24
v_mfma_f32_16x16x32_bf16 v[44:47], a[116:119], v[212:215], v[44:47]
s_add_u32 s81, s81, 28672
s_add_u32 m0, s18, 69632
ds_read_b64_tr_b16 a[90:91], v118 offset:26624
v_mfma_f32_16x16x32_bf16 v[44:47], a[120:123], v[228:231], v[44:47]
ds_read_b64_tr_b16 a[92:93], v118 offset:28672
buffer_load_dwordx4 v112, s[36:39], s81 offen offset:0 lds
v_mfma_f32_16x16x32_bf16 v[44:47], a[124:127], v[244:247], v[44:47]
s_waitcnt lgkmcnt(13)
ds_read_b64_tr_b16 a[94:95], v118 offset:30720
v_add_u32 v118, 65536, v118
v_mfma_f32_16x16x32_bf16 v[48:51], a[64:67], v[128:131], 0
s_waitcnt lgkmcnt(12)
ds_read_b64_tr_b16 a[96:97], v119 offset:0
v_mul_f32 v33, v33, v24
v_mfma_f32_16x16x32_bf16 v[48:51], a[68:71], v[144:147], v[48:51]
s_waitcnt lgkmcnt(11)
ds_read_b64_tr_b16 a[98:99], v119 offset:2048
v_mul_f32 v34, v34, v24
v_mfma_f32_16x16x32_bf16 v[48:51], a[72:75], v[160:163], v[48:51]
s_waitcnt lgkmcnt(10)
ds_read_b64_tr_b16 a[100:101], v119 offset:4096
v_mul_f32 v35, v35, v24
v_mfma_f32_16x16x32_bf16 v[48:51], a[76:79], v[176:179], v[48:51]
s_waitcnt lgkmcnt(9)
ds_read_b64_tr_b16 a[102:103], v119 offset:6144
v_mul_f32 v40, v40, v24
v_mfma_f32_16x16x32_bf16 v[48:51], a[80:83], v[192:195], v[48:51]
s_waitcnt lgkmcnt(8)
ds_read_b64_tr_b16 a[104:105], v119 offset:8192
v_mul_f32 v41, v41, v24
v_mfma_f32_16x16x32_bf16 v[48:51], a[84:87], v[208:211], v[48:51]
s_waitcnt lgkmcnt(7)
ds_read_b64_tr_b16 a[106:107], v119 offset:10240
buffer_load_dwordx4 v113, s[36:39], s81 offen offset:1024 lds
v_mfma_f32_16x16x32_bf16 v[48:51], a[88:91], v[224:227], v[48:51]
s_waitcnt lgkmcnt(6)
ds_read_b64_tr_b16 a[108:109], v119 offset:12288
v_mul_f32 v42, v42, v24
v_mfma_f32_16x16x32_bf16 v[48:51], a[92:95], v[240:243], v[48:51]
ds_read_b64_tr_b16 a[110:111], v119 offset:14336
v_mul_f32 v43, v43, v24
v_mfma_f32_16x16x32_bf16 v[52:55], a[64:67], v[132:135], 0
ds_read_b64_tr_b16 a[112:113], v119 offset:16384
v_cvt_pk_bf16_f32 v32, v32, v33
v_mfma_f32_16x16x32_bf16 v[52:55], a[68:71], v[148:151], v[52:55]
ds_read_b64_tr_b16 a[114:115], v119 offset:18432
v_cvt_pk_bf16_f32 v33, v34, v35
v_mfma_f32_16x16x32_bf16 v[52:55], a[72:75], v[164:167], v[52:55]
ds_read_b64_tr_b16 a[116:117], v119 offset:20480
v_cvt_pk_bf16_f32 v34, v40, v41
v_mfma_f32_16x16x32_bf16 v[52:55], a[76:79], v[180:183], v[52:55]
ds_read_b64_tr_b16 a[118:119], v119 offset:22528
v_cvt_pk_bf16_f32 v35, v42, v43
v_mfma_f32_16x16x32_bf16 v[52:55], a[80:83], v[196:199], v[52:55]
ds_read_b64_tr_b16 a[120:121], v119 offset:24576
buffer_load_dwordx4 v114, s[36:39], s81 offen offset:2048 lds
v_mfma_f32_16x16x32_bf16 v[52:55], a[84:87], v[212:215], v[52:55]
ds_read_b64_tr_b16 a[122:123], v119 offset:26624
buffer_store_dwordx4 v[32:35], v1, s[4:7], s8 offen offset:0 sc1
v_mfma_f32_16x16x32_bf16 v[52:55], a[88:91], v[228:231], v[52:55]
ds_read_b64_tr_b16 a[124:125], v119 offset:28672
ds_read_b64_tr_b16 a[126:127], v119 offset:30720
v_mfma_f32_16x16x32_bf16 v[52:55], a[92:95], v[244:247], v[52:55]
s_waitcnt vmcnt(16) lgkmcnt(14)
s_barrier
v_add_u32 v119, 65536, v119
v_mfma_f32_16x16x32_bf16 v[56:59], a[96:99], v[128:131], 0
s_waitcnt lgkmcnt(12)
ds_read_b64_tr_b16 a[64:65], v116 offset:0
v_mul_f32 v36, v36, v25
v_mfma_f32_16x16x32_bf16 v[56:59], a[100:103], v[144:147], v[56:59]
s_waitcnt lgkmcnt(11)
ds_read_b64_tr_b16 a[66:67], v116 offset:2048
v_mul_f32 v37, v37, v25
v_mfma_f32_16x16x32_bf16 v[56:59], a[104:107], v[160:163], v[56:59]
s_waitcnt lgkmcnt(10)
ds_read_b64_tr_b16 a[68:69], v116 offset:4096
v_mul_f32 v38, v38, v25
v_mfma_f32_16x16x32_bf16 v[56:59], a[108:111], v[176:179], v[56:59]
s_waitcnt lgkmcnt(9)
ds_read_b64_tr_b16 a[70:71], v116 offset:6144
buffer_load_dwordx4 v115, s[36:39], s81 offen offset:3072 lds
v_mfma_f32_16x16x32_bf16 v[56:59], a[112:115], v[192:195], v[56:59]
s_waitcnt lgkmcnt(8)
ds_read_b64_tr_b16 a[72:73], v116 offset:8192
v_mul_f32 v39, v39, v25
v_mfma_f32_16x16x32_bf16 v[56:59], a[116:119], v[208:211], v[56:59]
s_waitcnt lgkmcnt(7)
ds_read_b64_tr_b16 a[74:75], v116 offset:10240
v_mul_f32 v44, v44, v25
v_mfma_f32_16x16x32_bf16 v[56:59], a[120:123], v[224:227], v[56:59]
s_waitcnt lgkmcnt(6)
ds_read_b64_tr_b16 a[76:77], v116 offset:12288
v_mul_f32 v45, v45, v25
v_mfma_f32_16x16x32_bf16 v[56:59], a[124:127], v[240:243], v[56:59]
ds_read_b64_tr_b16 a[78:79], v116 offset:14336
v_mul_f32 v46, v46, v25
v_mfma_f32_16x16x32_bf16 v[60:63], a[96:99], v[132:135], 0
ds_read_b64_tr_b16 a[80:81], v116 offset:16384
v_mul_f32 v47, v47, v25
v_mfma_f32_16x16x32_bf16 v[60:63], a[100:103], v[148:151], v[60:63]
s_sub_u32 s81, s81, 28544
ds_read_b64_tr_b16 a[82:83], v116 offset:18432
v_cvt_pk_bf16_f32 v36, v36, v37
v_mfma_f32_16x16x32_bf16 v[60:63], a[104:107], v[164:167], v[60:63]
ds_read_b64_tr_b16 a[84:85], v116 offset:20480
v_cvt_pk_bf16_f32 v37, v38, v39
v_mfma_f32_16x16x32_bf16 v[60:63], a[108:111], v[180:183], v[60:63]
ds_read_b64_tr_b16 a[86:87], v116 offset:22528
v_cvt_pk_bf16_f32 v38, v44, v45
v_mfma_f32_16x16x32_bf16 v[60:63], a[112:115], v[196:199], v[60:63]
ds_read_b64_tr_b16 a[88:89], v116 offset:24576
v_cvt_pk_bf16_f32 v39, v46, v47
v_mfma_f32_16x16x32_bf16 v[60:63], a[116:119], v[212:215], v[60:63]
ds_read_b64_tr_b16 a[90:91], v116 offset:26624
buffer_store_dwordx4 v[36:39], v1, s[4:7], s12 offen offset:0 sc1
v_mfma_f32_16x16x32_bf16 v[60:63], a[120:123], v[228:231], v[60:63]
ds_read_b64_tr_b16 a[92:93], v116 offset:28672
v_mfma_f32_16x16x32_bf16 v[60:63], a[124:127], v[244:247], v[60:63]
s_waitcnt lgkmcnt(3)
ds_read_b64_tr_b16 a[94:95], v116 offset:30720
v_add_u32 v116, 32768, v116
v_mfma_f32_16x16x32_bf16 v[64:67], a[64:67], v[128:131], 0
s_add_u32 m0, s18, 0
ds_read_b64_tr_b16 a[96:97], v117 offset:0
v_mul_f32 v48, v48, v24
v_mfma_f32_16x16x32_bf16 v[64:67], a[68:71], v[144:147], v[64:67]
s_lshl_b32 s34, s29, 5
ds_read_b64_tr_b16 a[98:99], v117 offset:2048
buffer_load_dwordx4 v112, s[36:39], s81 offen offset:0 lds
v_mfma_f32_16x16x32_bf16 v[64:67], a[72:75], v[160:163], v[64:67]
s_add_u32 s34, s34, s20
ds_read_b64_tr_b16 a[100:101], v117 offset:4096
v_mul_f32 v49, v49, v24
v_mfma_f32_16x16x32_bf16 v[64:67], a[76:79], v[176:179], v[64:67]
s_lshl_b32 s34, s34, 2
ds_read_b64_tr_b16 a[102:103], v117 offset:6144
v_mul_f32 v50, v50, v24
v_mfma_f32_16x16x32_bf16 v[64:67], a[80:83], v[192:195], v[64:67]
s_add_u32 s34, s34, 94380032
ds_read_b64_tr_b16 a[104:105], v117 offset:8192
v_mul_f32 v51, v51, v24
v_mfma_f32_16x16x32_bf16 v[64:67], a[84:87], v[208:211], v[64:67]
s_waitcnt lgkmcnt(5)
s_add_u32 s35, s34, 2048
ds_read_b64_tr_b16 a[106:107], v117 offset:10240
v_mul_f32 v56, v56, v24
v_mfma_f32_16x16x32_bf16 v[64:67], a[88:91], v[224:227], v[64:67]
s_mov_b32 s80, s21
ds_read_b64_tr_b16 a[108:109], v117 offset:12288
v_mul_f32 v57, v57, v24
v_mfma_f32_16x16x32_bf16 v[64:67], a[92:95], v[240:243], v[64:67]
s_and_b32 s79, s2, 16
ds_read_b64_tr_b16 a[110:111], v117 offset:14336
v_mul_f32 v58, v58, v24
v_mfma_f32_16x16x32_bf16 v[68:71], a[64:67], v[132:135], 0
s_xor_b32 s79, s79, 16
ds_read_b64_tr_b16 a[112:113], v117 offset:16384
buffer_load_dwordx4 v113, s[36:39], s81 offen offset:1024 lds
v_mfma_f32_16x16x32_bf16 v[68:71], a[68:71], v[148:151], v[68:71]
s_add_u32 s79, s79, s20
ds_read_b64_tr_b16 a[114:115], v117 offset:18432
v_mul_f32 v59, v59, v24
v_mfma_f32_16x16x32_bf16 v[68:71], a[72:75], v[164:167], v[68:71]
s_lshl_b32 s22, s79, 2
ds_read_b64_tr_b16 a[116:117], v117 offset:20480
v_cvt_pk_bf16_f32 v48, v48, v49
v_mfma_f32_16x16x32_bf16 v[68:71], a[76:79], v[180:183], v[68:71]
s_add_u32 s22, s22, s3
ds_read_b64_tr_b16 a[118:119], v117 offset:22528
v_cvt_pk_bf16_f32 v49, v50, v51
v_mfma_f32_16x16x32_bf16 v[68:71], a[80:83], v[196:199], v[68:71]
s_mul_i32 s25, s22, 28672
ds_read_b64_tr_b16 a[120:121], v117 offset:24576
v_cvt_pk_bf16_f32 v50, v56, v57
v_mfma_f32_16x16x32_bf16 v[68:71], a[84:87], v[212:215], v[68:71]
s_lshl_b32 s23, s80, 6
ds_read_b64_tr_b16 a[122:123], v117 offset:26624
v_cvt_pk_bf16_f32 v51, v58, v59
v_mfma_f32_16x16x32_bf16 v[68:71], a[88:91], v[228:231], v[68:71]
s_add_u32 s25, s25, s23
ds_read_b64_tr_b16 a[124:125], v117 offset:28672
buffer_store_dwordx4 v[48:51], v1, s[4:7], s8 offen offset:1024 sc1
v_mfma_f32_16x16x32_bf16 v[68:71], a[92:95], v[244:247], v[68:71]
s_waitcnt lgkmcnt(3)
s_mul_i32 s26, s22, 229376
ds_read_b64_tr_b16 a[126:127], v117 offset:30720
v_add_u32 v117, 32768, v117
v_mfma_f32_16x16x32_bf16 v[72:75], a[96:99], v[128:131], 0
s_lshl_b32 s23, s80, 10
ds_read_b64_tr_b16 a[64:65], v118 offset:0
buffer_load_dwordx4 v114, s[36:39], s81 offen offset:2048 lds
v_mfma_f32_16x16x32_bf16 v[72:75], a[100:103], v[144:147], v[72:75]
s_add_u32 s26, s26, s23
ds_read_b64_tr_b16 a[66:67], v118 offset:2048
v_mul_f32 v52, v52, v25
v_mfma_f32_16x16x32_bf16 v[72:75], a[104:107], v[160:163], v[72:75]
s_add_u32 s26, s26, 104857600
ds_read_b64_tr_b16 a[68:69], v118 offset:4096
v_mul_f32 v53, v53, v25
v_mfma_f32_16x16x32_bf16 v[72:75], a[108:111], v[176:179], v[72:75]
s_lshr_b32 s22, s79, 1
ds_read_b64_tr_b16 a[70:71], v118 offset:6144
v_mul_f32 v54, v54, v25
v_mfma_f32_16x16x32_bf16 v[72:75], a[112:115], v[192:195], v[72:75]
s_lshl_b32 s22, s22, 7
ds_read_b64_tr_b16 a[72:73], v118 offset:8192
v_mul_f32 v55, v55, v25
v_mfma_f32_16x16x32_bf16 v[72:75], a[116:119], v[208:211], v[72:75]
s_waitcnt lgkmcnt(5)
s_add_u32 s33, s22, 94380032
ds_read_b64_tr_b16 a[74:75], v118 offset:10240
v_mul_f32 v60, v60, v25
v_mfma_f32_16x16x32_bf16 v[72:75], a[120:123], v[224:227], v[72:75]
s_mov_b64 s[40:41], s[88:89]
ds_read_b64_tr_b16 a[76:77], v118 offset:12288
v_mul_f32 v61, v61, v25
v_mfma_f32_16x16x32_bf16 v[72:75], a[124:127], v[240:243], v[72:75]
s_mov_b32 s42, 3670016
ds_read_b64_tr_b16 a[78:79], v118 offset:14336
buffer_load_dwordx4 v115, s[36:39], s81 offen offset:3072 lds
v_mfma_f32_16x16x32_bf16 v[76:79], a[96:99], v[132:135], 0
s_mov_b32 s43, 0x20000
ds_read_b64_tr_b16 a[80:81], v118 offset:16384
v_mul_f32 v62, v62, v25
v_mfma_f32_16x16x32_bf16 v[76:79], a[100:103], v[148:151], v[76:79]
ds_read_b64_tr_b16 a[82:83], v118 offset:18432
v_mul_f32 v63, v63, v25
v_mfma_f32_16x16x32_bf16 v[76:79], a[104:107], v[164:167], v[76:79]
ds_read_b64_tr_b16 a[84:85], v118 offset:20480
v_cvt_pk_bf16_f32 v52, v52, v53
v_mfma_f32_16x16x32_bf16 v[76:79], a[108:111], v[180:183], v[76:79]
ds_read_b64_tr_b16 a[86:87], v118 offset:22528
v_cvt_pk_bf16_f32 v53, v54, v55
v_mfma_f32_16x16x32_bf16 v[76:79], a[112:115], v[196:199], v[76:79]
ds_read_b64_tr_b16 a[88:89], v118 offset:24576
v_cvt_pk_bf16_f32 v54, v60, v61
v_mfma_f32_16x16x32_bf16 v[76:79], a[116:119], v[212:215], v[76:79]
s_add_u32 s81, s81, 28672
s_add_u32 m0, s18, 4096
ds_read_b64_tr_b16 a[90:91], v118 offset:26624
v_mfma_f32_16x16x32_bf16 v[76:79], a[120:123], v[228:231], v[76:79]
ds_read_b64_tr_b16 a[92:93], v118 offset:28672
buffer_load_dwordx4 v112, s[36:39], s81 offen offset:0 lds
v_mfma_f32_16x16x32_bf16 v[76:79], a[124:127], v[244:247], v[76:79]
s_waitcnt lgkmcnt(13)
ds_read_b64_tr_b16 a[94:95], v118 offset:30720
v_add_u32 v118, 32768, v118
v_mfma_f32_16x16x32_bf16 v[80:83], a[64:67], v[128:131], 0
s_waitcnt lgkmcnt(12)
ds_read_b64_tr_b16 a[96:97], v119 offset:0
v_cvt_pk_bf16_f32 v55, v62, v63
v_mfma_f32_16x16x32_bf16 v[80:83], a[68:71], v[144:147], v[80:83]
s_waitcnt lgkmcnt(11)
ds_read_b64_tr_b16 a[98:99], v119 offset:2048
buffer_store_dwordx4 v[52:55], v1, s[4:7], s12 offen offset:1024 sc1
v_mfma_f32_16x16x32_bf16 v[80:83], a[72:75], v[160:163], v[80:83]
s_waitcnt lgkmcnt(10)
ds_read_b64_tr_b16 a[100:101], v119 offset:4096
v_mfma_f32_16x16x32_bf16 v[80:83], a[76:79], v[176:179], v[80:83]
s_waitcnt lgkmcnt(9)
ds_read_b64_tr_b16 a[102:103], v119 offset:6144
v_mul_f32 v64, v64, v24
v_mfma_f32_16x16x32_bf16 v[80:83], a[80:83], v[192:195], v[80:83]
s_waitcnt lgkmcnt(8)
ds_read_b64_tr_b16 a[104:105], v119 offset:8192
v_mul_f32 v65, v65, v24
v_mfma_f32_16x16x32_bf16 v[80:83], a[84:87], v[208:211], v[80:83]
s_waitcnt lgkmcnt(7)
ds_read_b64_tr_b16 a[106:107], v119 offset:10240
buffer_load_dwordx4 v113, s[36:39], s81 offen offset:1024 lds
v_mfma_f32_16x16x32_bf16 v[80:83], a[88:91], v[224:227], v[80:83]
s_waitcnt lgkmcnt(6)
ds_read_b64_tr_b16 a[108:109], v119 offset:12288
v_mul_f32 v66, v66, v24
v_mfma_f32_16x16x32_bf16 v[80:83], a[92:95], v[240:243], v[80:83]
ds_read_b64_tr_b16 a[110:111], v119 offset:14336
v_mul_f32 v67, v67, v24
v_mfma_f32_16x16x32_bf16 v[84:87], a[64:67], v[132:135], 0
ds_read_b64_tr_b16 a[112:113], v119 offset:16384
v_mul_f32 v72, v72, v24
v_mfma_f32_16x16x32_bf16 v[84:87], a[68:71], v[148:151], v[84:87]
ds_read_b64_tr_b16 a[114:115], v119 offset:18432
v_mul_f32 v73, v73, v24
v_mfma_f32_16x16x32_bf16 v[84:87], a[72:75], v[164:167], v[84:87]
ds_read_b64_tr_b16 a[116:117], v119 offset:20480
v_mul_f32 v74, v74, v24
v_mfma_f32_16x16x32_bf16 v[84:87], a[76:79], v[180:183], v[84:87]
ds_read_b64_tr_b16 a[118:119], v119 offset:22528
v_mul_f32 v75, v75, v24
v_mfma_f32_16x16x32_bf16 v[84:87], a[80:83], v[196:199], v[84:87]
ds_read_b64_tr_b16 a[120:121], v119 offset:24576
buffer_load_dwordx4 v114, s[36:39], s81 offen offset:2048 lds
v_mfma_f32_16x16x32_bf16 v[84:87], a[84:87], v[212:215], v[84:87]
ds_read_b64_tr_b16 a[122:123], v119 offset:26624
v_cvt_pk_bf16_f32 v64, v64, v65
v_mfma_f32_16x16x32_bf16 v[84:87], a[88:91], v[228:231], v[84:87]
ds_read_b64_tr_b16 a[124:125], v119 offset:28672
ds_read_b64_tr_b16 a[126:127], v119 offset:30720
v_mfma_f32_16x16x32_bf16 v[84:87], a[92:95], v[244:247], v[84:87]
s_waitcnt vmcnt(19) lgkmcnt(14)
s_barrier
v_add_u32 v119, 32768, v119
v_mfma_f32_16x16x32_bf16 v[88:91], a[96:99], v[128:131], 0
s_waitcnt lgkmcnt(12)
ds_read_b64_tr_b16 a[64:65], v116 offset:0
v_cvt_pk_bf16_f32 v65, v66, v67
v_mfma_f32_16x16x32_bf16 v[88:91], a[100:103], v[144:147], v[88:91]
s_waitcnt lgkmcnt(11)
ds_read_b64_tr_b16 a[66:67], v116 offset:2048
v_cvt_pk_bf16_f32 v66, v72, v73
v_mfma_f32_16x16x32_bf16 v[88:91], a[104:107], v[160:163], v[88:91]
s_waitcnt lgkmcnt(10)
ds_read_b64_tr_b16 a[68:69], v116 offset:4096
v_cvt_pk_bf16_f32 v67, v74, v75
v_mfma_f32_16x16x32_bf16 v[88:91], a[108:111], v[176:179], v[88:91]
s_waitcnt lgkmcnt(9)
ds_read_b64_tr_b16 a[70:71], v116 offset:6144
buffer_load_dwordx4 v115, s[36:39], s81 offen offset:3072 lds
v_mfma_f32_16x16x32_bf16 v[88:91], a[112:115], v[192:195], v[88:91]
s_waitcnt lgkmcnt(8)
ds_read_b64_tr_b16 a[72:73], v116 offset:8192
buffer_store_dwordx4 v[64:67], v1, s[4:7], s8 offen offset:2048 sc1
v_mfma_f32_16x16x32_bf16 v[88:91], a[116:119], v[208:211], v[88:91]
s_waitcnt lgkmcnt(7)
ds_read_b64_tr_b16 a[74:75], v116 offset:10240
v_mul_f32 v68, v68, v25
v_mfma_f32_16x16x32_bf16 v[88:91], a[120:123], v[224:227], v[88:91]
s_waitcnt lgkmcnt(6)
ds_read_b64_tr_b16 a[76:77], v116 offset:12288
v_mul_f32 v69, v69, v25
v_mfma_f32_16x16x32_bf16 v[88:91], a[124:127], v[240:243], v[88:91]
ds_read_b64_tr_b16 a[78:79], v116 offset:14336
v_mul_f32 v70, v70, v25
v_mfma_f32_16x16x32_bf16 v[92:95], a[96:99], v[132:135], 0
ds_read_b64_tr_b16 a[80:81], v116 offset:16384
v_mul_f32 v71, v71, v25
v_mfma_f32_16x16x32_bf16 v[92:95], a[100:103], v[148:151], v[92:95]
s_sub_u32 s81, s81, 28544
ds_read_b64_tr_b16 a[82:83], v116 offset:18432
v_mul_f32 v76, v76, v25
v_mfma_f32_16x16x32_bf16 v[92:95], a[104:107], v[164:167], v[92:95]
ds_read_b64_tr_b16 a[84:85], v116 offset:20480
v_mul_f32 v77, v77, v25
v_mfma_f32_16x16x32_bf16 v[92:95], a[108:111], v[180:183], v[92:95]
ds_read_b64_tr_b16 a[86:87], v116 offset:22528
v_mul_f32 v78, v78, v25
v_mfma_f32_16x16x32_bf16 v[92:95], a[112:115], v[196:199], v[92:95]
ds_read_b64_tr_b16 a[88:89], v116 offset:24576
v_mul_f32 v79, v79, v25
v_mfma_f32_16x16x32_bf16 v[92:95], a[116:119], v[212:215], v[92:95]
ds_read_b64_tr_b16 a[90:91], v116 offset:26624
v_cvt_pk_bf16_f32 v68, v68, v69
v_mfma_f32_16x16x32_bf16 v[92:95], a[120:123], v[228:231], v[92:95]
ds_read_b64_tr_b16 a[92:93], v116 offset:28672
v_cvt_pk_bf16_f32 v69, v70, v71
v_mfma_f32_16x16x32_bf16 v[92:95], a[124:127], v[244:247], v[92:95]
s_waitcnt lgkmcnt(11)
ds_read_b64_tr_b16 a[94:95], v116 offset:30720
v_add_u32 v116, 4294901760, v116
v_mfma_f32_16x16x32_bf16 v[32:35], a[64:67], v[128:131], 0
s_add_u32 m0, s18, 32768
ds_read_b64_tr_b16 a[96:97], v117 offset:0
v_cvt_pk_bf16_f32 v70, v76, v77
v_mfma_f32_16x16x32_bf16 v[32:35], a[68:71], v[144:147], v[32:35]
s_waitcnt lgkmcnt(11)
ds_read_b64_tr_b16 a[98:99], v117 offset:2048
buffer_load_dwordx4 v112, s[36:39], s81 offen offset:0 lds
v_mfma_f32_16x16x32_bf16 v[32:35], a[72:75], v[160:163], v[32:35]
s_waitcnt lgkmcnt(10)
ds_read_b64_tr_b16 a[100:101], v117 offset:4096
v_cvt_pk_bf16_f32 v71, v78, v79
v_mfma_f32_16x16x32_bf16 v[32:35], a[76:79], v[176:179], v[32:35]
s_waitcnt lgkmcnt(9)
ds_read_b64_tr_b16 a[102:103], v117 offset:6144
buffer_store_dwordx4 v[68:71], v1, s[4:7], s12 offen offset:2048 sc1
v_mfma_f32_16x16x32_bf16 v[32:35], a[80:83], v[192:195], v[32:35]
s_waitcnt lgkmcnt(8)
ds_read_b64_tr_b16 a[104:105], v117 offset:8192
v_mul_f32 v80, v80, v24
v_mfma_f32_16x16x32_bf16 v[32:35], a[84:87], v[208:211], v[32:35]
s_waitcnt lgkmcnt(7)
ds_read_b64_tr_b16 a[106:107], v117 offset:10240
v_mul_f32 v81, v81, v24
v_mfma_f32_16x16x32_bf16 v[32:35], a[88:91], v[224:227], v[32:35]
s_waitcnt lgkmcnt(6)
ds_read_b64_tr_b16 a[108:109], v117 offset:12288
v_mul_f32 v82, v82, v24
v_mfma_f32_16x16x32_bf16 v[32:35], a[92:95], v[240:243], v[32:35]
ds_read_b64_tr_b16 a[110:111], v117 offset:14336
v_mul_f32 v83, v83, v24
v_mfma_f32_16x16x32_bf16 v[36:39], a[64:67], v[132:135], 0
ds_read_b64_tr_b16 a[112:113], v117 offset:16384
buffer_load_dwordx4 v113, s[36:39], s81 offen offset:1024 lds
v_mfma_f32_16x16x32_bf16 v[36:39], a[68:71], v[148:151], v[36:39]
ds_read_b64_tr_b16 a[114:115], v117 offset:18432
v_mul_f32 v88, v88, v24
v_mfma_f32_16x16x32_bf16 v[36:39], a[72:75], v[164:167], v[36:39]
ds_read_b64_tr_b16 a[116:117], v117 offset:20480
v_mul_f32 v89, v89, v24
v_mfma_f32_16x16x32_bf16 v[36:39], a[76:79], v[180:183], v[36:39]
ds_read_b64_tr_b16 a[118:119], v117 offset:22528
v_mul_f32 v90, v90, v24
v_mfma_f32_16x16x32_bf16 v[36:39], a[80:83], v[196:199], v[36:39]
ds_read_b64_tr_b16 a[120:121], v117 offset:24576
v_mul_f32 v91, v91, v24
v_mfma_f32_16x16x32_bf16 v[36:39], a[84:87], v[212:215], v[36:39]
ds_read_b64_tr_b16 a[122:123], v117 offset:26624
v_cvt_pk_bf16_f32 v80, v80, v81
v_mfma_f32_16x16x32_bf16 v[36:39], a[88:91], v[228:231], v[36:39]
ds_read_b64_tr_b16 a[124:125], v117 offset:28672
v_cvt_pk_bf16_f32 v81, v82, v83
v_mfma_f32_16x16x32_bf16 v[36:39], a[92:95], v[244:247], v[36:39]
s_waitcnt lgkmcnt(13)
ds_read_b64_tr_b16 a[126:127], v117 offset:30720
v_add_u32 v117, 4294901760, v117
v_mfma_f32_16x16x32_bf16 v[40:43], a[96:99], v[128:131], 0
s_waitcnt lgkmcnt(12)
ds_read_b64_tr_b16 a[64:65], v118 offset:0
buffer_load_dwordx4 v114, s[36:39], s81 offen offset:2048 lds
v_mfma_f32_16x16x32_bf16 v[40:43], a[100:103], v[144:147], v[40:43]
s_waitcnt lgkmcnt(11)
ds_read_b64_tr_b16 a[66:67], v118 offset:2048
v_cvt_pk_bf16_f32 v82, v88, v89
v_mfma_f32_16x16x32_bf16 v[40:43], a[104:107], v[160:163], v[40:43]
s_waitcnt lgkmcnt(10)
ds_read_b64_tr_b16 a[68:69], v118 offset:4096
v_cvt_pk_bf16_f32 v83, v90, v91
v_mfma_f32_16x16x32_bf16 v[40:43], a[108:111], v[176:179], v[40:43]
s_waitcnt lgkmcnt(9)
ds_read_b64_tr_b16 a[70:71], v118 offset:6144
buffer_store_dwordx4 v[80:83], v1, s[4:7], s8 offen offset:3072 sc1
v_mfma_f32_16x16x32_bf16 v[40:43], a[112:115], v[192:195], v[40:43]
s_waitcnt lgkmcnt(8)
ds_read_b64_tr_b16 a[72:73], v118 offset:8192
v_mul_f32 v84, v84, v25
v_mfma_f32_16x16x32_bf16 v[40:43], a[116:119], v[208:211], v[40:43]
s_waitcnt lgkmcnt(7)
ds_read_b64_tr_b16 a[74:75], v118 offset:10240
v_mul_f32 v85, v85, v25
v_mfma_f32_16x16x32_bf16 v[40:43], a[120:123], v[224:227], v[40:43]
s_waitcnt lgkmcnt(6)
ds_read_b64_tr_b16 a[76:77], v118 offset:12288
v_mul_f32 v86, v86, v25
v_mfma_f32_16x16x32_bf16 v[40:43], a[124:127], v[240:243], v[40:43]
ds_read_b64_tr_b16 a[78:79], v118 offset:14336
buffer_load_dwordx4 v115, s[36:39], s81 offen offset:3072 lds
v_mfma_f32_16x16x32_bf16 v[44:47], a[96:99], v[132:135], 0
ds_read_b64_tr_b16 a[80:81], v118 offset:16384
v_mul_f32 v87, v87, v25
v_mfma_f32_16x16x32_bf16 v[44:47], a[100:103], v[148:151], v[44:47]
ds_read_b64_tr_b16 a[82:83], v118 offset:18432
v_mul_f32 v92, v92, v25
v_mfma_f32_16x16x32_bf16 v[44:47], a[104:107], v[164:167], v[44:47]
ds_read_b64_tr_b16 a[84:85], v118 offset:20480
v_mul_f32 v93, v93, v25
v_mfma_f32_16x16x32_bf16 v[44:47], a[108:111], v[180:183], v[44:47]
ds_read_b64_tr_b16 a[86:87], v118 offset:22528
v_mul_f32 v94, v94, v25
v_mfma_f32_16x16x32_bf16 v[44:47], a[112:115], v[196:199], v[44:47]
ds_read_b64_tr_b16 a[88:89], v118 offset:24576
v_mul_f32 v95, v95, v25
v_mfma_f32_16x16x32_bf16 v[44:47], a[116:119], v[212:215], v[44:47]
s_add_u32 s81, s81, 28672
s_add_u32 m0, s18, 36864
ds_read_b64_tr_b16 a[90:91], v118 offset:26624
v_mfma_f32_16x16x32_bf16 v[44:47], a[120:123], v[228:231], v[44:47]
ds_read_b64_tr_b16 a[92:93], v118 offset:28672
buffer_load_dwordx4 v112, s[36:39], s81 offen offset:0 lds
v_mfma_f32_16x16x32_bf16 v[44:47], a[124:127], v[244:247], v[44:47]
s_waitcnt lgkmcnt(13)
ds_read_b64_tr_b16 a[94:95], v118 offset:30720
v_add_u32 v118, 4294901760, v118
v_mfma_f32_16x16x32_bf16 v[48:51], a[64:67], v[128:131], 0
s_waitcnt lgkmcnt(12)
ds_read_b64_tr_b16 a[96:97], v119 offset:0
v_cvt_pk_bf16_f32 v84, v84, v85
v_mfma_f32_16x16x32_bf16 v[48:51], a[68:71], v[144:147], v[48:51]
s_waitcnt lgkmcnt(11)
ds_read_b64_tr_b16 a[98:99], v119 offset:2048
v_cvt_pk_bf16_f32 v85, v86, v87
v_mfma_f32_16x16x32_bf16 v[48:51], a[72:75], v[160:163], v[48:51]
s_waitcnt lgkmcnt(10)
ds_read_b64_tr_b16 a[100:101], v119 offset:4096
v_cvt_pk_bf16_f32 v86, v92, v93
v_mfma_f32_16x16x32_bf16 v[48:51], a[76:79], v[176:179], v[48:51]
s_waitcnt lgkmcnt(9)
ds_read_b64_tr_b16 a[102:103], v119 offset:6144
v_cvt_pk_bf16_f32 v87, v94, v95
v_mfma_f32_16x16x32_bf16 v[48:51], a[80:83], v[192:195], v[48:51]
s_waitcnt lgkmcnt(6)
ds_read_b64_tr_b16 a[104:105], v119 offset:8192
buffer_store_dwordx4 v[84:87], v1, s[4:7], s12 offen offset:3072 sc1
v_mfma_f32_16x16x32_bf16 v[48:51], a[84:87], v[208:211], v[48:51]
s_add_u32 s8, s8, 4096
s_add_u32 s12, s12, 4096
ds_read_b64_tr_b16 a[106:107], v119 offset:10240
buffer_load_dwordx4 v113, s[36:39], s81 offen offset:1024 lds
v_mfma_f32_16x16x32_bf16 v[48:51], a[88:91], v[224:227], v[48:51]
s_waitcnt lgkmcnt(6)
ds_read_b64_tr_b16 a[108:109], v119 offset:12288
v_mul_f32 v32, v32, v24
v_mfma_f32_16x16x32_bf16 v[48:51], a[92:95], v[240:243], v[48:51]
ds_read_b64_tr_b16 a[110:111], v119 offset:14336
v_mul_f32 v33, v33, v24
v_mfma_f32_16x16x32_bf16 v[52:55], a[64:67], v[132:135], 0
ds_read_b64_tr_b16 a[112:113], v119 offset:16384
v_mul_f32 v34, v34, v24
v_mfma_f32_16x16x32_bf16 v[52:55], a[68:71], v[148:151], v[52:55]
ds_read_b64_tr_b16 a[114:115], v119 offset:18432
v_mul_f32 v35, v35, v24
v_mfma_f32_16x16x32_bf16 v[52:55], a[72:75], v[164:167], v[52:55]
ds_read_b64_tr_b16 a[116:117], v119 offset:20480
v_mul_f32 v40, v40, v24
v_mfma_f32_16x16x32_bf16 v[52:55], a[76:79], v[180:183], v[52:55]
ds_read_b64_tr_b16 a[118:119], v119 offset:22528
v_mul_f32 v41, v41, v24
v_mfma_f32_16x16x32_bf16 v[52:55], a[80:83], v[196:199], v[52:55]
ds_read_b64_tr_b16 a[120:121], v119 offset:24576
buffer_load_dwordx4 v114, s[36:39], s81 offen offset:2048 lds
v_mfma_f32_16x16x32_bf16 v[52:55], a[84:87], v[212:215], v[52:55]
ds_read_b64_tr_b16 a[122:123], v119 offset:26624
v_mul_f32 v42, v42, v24
v_mfma_f32_16x16x32_bf16 v[52:55], a[88:91], v[228:231], v[52:55]
ds_read_b64_tr_b16 a[124:125], v119 offset:28672
ds_read_b64_tr_b16 a[126:127], v119 offset:30720
v_mfma_f32_16x16x32_bf16 v[52:55], a[92:95], v[244:247], v[52:55]
s_waitcnt vmcnt(22) lgkmcnt(14)
s_barrier
v_add_u32 v119, 4294901760, v119
v_mfma_f32_16x16x32_bf16 v[56:59], a[96:99], v[128:131], 0
s_waitcnt lgkmcnt(12)
ds_read_b64_tr_b16 a[64:65], v116 offset:0
v_mul_f32 v43, v43, v24
v_mfma_f32_16x16x32_bf16 v[56:59], a[100:103], v[144:147], v[56:59]
s_waitcnt lgkmcnt(11)
ds_read_b64_tr_b16 a[66:67], v116 offset:2048
v_cvt_pk_bf16_f32 v32, v32, v33
v_mfma_f32_16x16x32_bf16 v[56:59], a[104:107], v[160:163], v[56:59]
s_waitcnt lgkmcnt(10)
ds_read_b64_tr_b16 a[68:69], v116 offset:4096
v_cvt_pk_bf16_f32 v33, v34, v35
v_mfma_f32_16x16x32_bf16 v[56:59], a[108:111], v[176:179], v[56:59]
s_waitcnt lgkmcnt(9)
ds_read_b64_tr_b16 a[70:71], v116 offset:6144
buffer_load_dwordx4 v115, s[36:39], s81 offen offset:3072 lds
v_mfma_f32_16x16x32_bf16 v[56:59], a[112:115], v[192:195], v[56:59]
s_waitcnt lgkmcnt(8)
ds_read_b64_tr_b16 a[72:73], v116 offset:8192
v_cvt_pk_bf16_f32 v34, v40, v41
v_mfma_f32_16x16x32_bf16 v[56:59], a[116:119], v[208:211], v[56:59]
s_waitcnt lgkmcnt(7)
ds_read_b64_tr_b16 a[74:75], v116 offset:10240
v_cvt_pk_bf16_f32 v35, v42, v43
v_mfma_f32_16x16x32_bf16 v[56:59], a[120:123], v[224:227], v[56:59]
s_waitcnt lgkmcnt(6)
ds_read_b64_tr_b16 a[76:77], v116 offset:12288
buffer_store_dwordx4 v[32:35], v1, s[4:7], s8 offen offset:0 sc1
v_mfma_f32_16x16x32_bf16 v[56:59], a[124:127], v[240:243], v[56:59]
ds_read_b64_tr_b16 a[78:79], v116 offset:14336
v_mul_f32 v36, v36, v25
v_mfma_f32_16x16x32_bf16 v[60:63], a[96:99], v[132:135], 0
ds_read_b64_tr_b16 a[80:81], v116 offset:16384
v_mul_f32 v37, v37, v25
v_mfma_f32_16x16x32_bf16 v[60:63], a[100:103], v[148:151], v[60:63]
s_sub_u32 s81, s81, 28544
ds_read_b64_tr_b16 a[82:83], v116 offset:18432
v_mul_f32 v38, v38, v25
v_mfma_f32_16x16x32_bf16 v[60:63], a[104:107], v[164:167], v[60:63]
ds_read_b64_tr_b16 a[84:85], v116 offset:20480
v_mul_f32 v39, v39, v25
v_mfma_f32_16x16x32_bf16 v[60:63], a[108:111], v[180:183], v[60:63]
ds_read_b64_tr_b16 a[86:87], v116 offset:22528
v_mul_f32 v44, v44, v25
v_mfma_f32_16x16x32_bf16 v[60:63], a[112:115], v[196:199], v[60:63]
ds_read_b64_tr_b16 a[88:89], v116 offset:24576
v_mul_f32 v45, v45, v25
v_mfma_f32_16x16x32_bf16 v[60:63], a[116:119], v[212:215], v[60:63]
ds_read_b64_tr_b16 a[90:91], v116 offset:26624
v_mul_f32 v46, v46, v25
v_mfma_f32_16x16x32_bf16 v[60:63], a[120:123], v[228:231], v[60:63]
ds_read_b64_tr_b16 a[92:93], v116 offset:28672
v_mul_f32 v47, v47, v25
v_mfma_f32_16x16x32_bf16 v[60:63], a[124:127], v[244:247], v[60:63]
s_waitcnt lgkmcnt(11)
ds_read_b64_tr_b16 a[94:95], v116 offset:30720
v_add_u32 v116, 4294901760, v116
v_mfma_f32_16x16x32_bf16 v[64:67], a[64:67], v[128:131], 0
s_add_u32 m0, s18, 98304
ds_read_b64_tr_b16 a[96:97], v117 offset:0
v_cvt_pk_bf16_f32 v36, v36, v37
v_mfma_f32_16x16x32_bf16 v[64:67], a[68:71], v[144:147], v[64:67]
s_waitcnt lgkmcnt(11)
ds_read_b64_tr_b16 a[98:99], v117 offset:2048
buffer_load_dwordx4 v112, s[36:39], s81 offen offset:0 lds
v_mfma_f32_16x16x32_bf16 v[64:67], a[72:75], v[160:163], v[64:67]
s_waitcnt lgkmcnt(10)
ds_read_b64_tr_b16 a[100:101], v117 offset:4096
v_cvt_pk_bf16_f32 v37, v38, v39
v_mfma_f32_16x16x32_bf16 v[64:67], a[76:79], v[176:179], v[64:67]
s_waitcnt lgkmcnt(9)
ds_read_b64_tr_b16 a[102:103], v117 offset:6144
v_cvt_pk_bf16_f32 v38, v44, v45
v_mfma_f32_16x16x32_bf16 v[64:67], a[80:83], v[192:195], v[64:67]
s_waitcnt lgkmcnt(8)
ds_read_b64_tr_b16 a[104:105], v117 offset:8192
v_cvt_pk_bf16_f32 v39, v46, v47
v_mfma_f32_16x16x32_bf16 v[64:67], a[84:87], v[208:211], v[64:67]
s_waitcnt lgkmcnt(7)
ds_read_b64_tr_b16 a[106:107], v117 offset:10240
buffer_store_dwordx4 v[36:39], v1, s[4:7], s12 offen offset:0 sc1
v_mfma_f32_16x16x32_bf16 v[64:67], a[88:91], v[224:227], v[64:67]
s_waitcnt lgkmcnt(6)
ds_read_b64_tr_b16 a[108:109], v117 offset:12288
v_mul_f32 v48, v48, v24
v_mfma_f32_16x16x32_bf16 v[64:67], a[92:95], v[240:243], v[64:67]
ds_read_b64_tr_b16 a[110:111], v117 offset:14336
v_mul_f32 v49, v49, v24
v_mfma_f32_16x16x32_bf16 v[68:71], a[64:67], v[132:135], 0
ds_read_b64_tr_b16 a[112:113], v117 offset:16384
buffer_load_dwordx4 v113, s[36:39], s81 offen offset:1024 lds
v_mfma_f32_16x16x32_bf16 v[68:71], a[68:71], v[148:151], v[68:71]
ds_read_b64_tr_b16 a[114:115], v117 offset:18432
v_mul_f32 v50, v50, v24
v_mfma_f32_16x16x32_bf16 v[68:71], a[72:75], v[164:167], v[68:71]
ds_read_b64_tr_b16 a[116:117], v117 offset:20480
v_mul_f32 v51, v51, v24
v_mfma_f32_16x16x32_bf16 v[68:71], a[76:79], v[180:183], v[68:71]
ds_read_b64_tr_b16 a[118:119], v117 offset:22528
v_mul_f32 v56, v56, v24
v_mfma_f32_16x16x32_bf16 v[68:71], a[80:83], v[196:199], v[68:71]
ds_read_b64_tr_b16 a[120:121], v117 offset:24576
v_mul_f32 v57, v57, v24
v_mfma_f32_16x16x32_bf16 v[68:71], a[84:87], v[212:215], v[68:71]
ds_read_b64_tr_b16 a[122:123], v117 offset:26624
v_mul_f32 v58, v58, v24
v_mfma_f32_16x16x32_bf16 v[68:71], a[88:91], v[228:231], v[68:71]
ds_read_b64_tr_b16 a[124:125], v117 offset:28672
v_mul_f32 v59, v59, v24
v_mfma_f32_16x16x32_bf16 v[68:71], a[92:95], v[244:247], v[68:71]
s_waitcnt lgkmcnt(13)
ds_read_b64_tr_b16 a[126:127], v117 offset:30720
v_add_u32 v117, 4294901760, v117
v_mfma_f32_16x16x32_bf16 v[72:75], a[96:99], v[128:131], 0
s_waitcnt lgkmcnt(12)
ds_read_b64_tr_b16 a[64:65], v118 offset:0
buffer_load_dwordx4 v114, s[36:39], s81 offen offset:2048 lds
v_mfma_f32_16x16x32_bf16 v[72:75], a[100:103], v[144:147], v[72:75]
s_waitcnt lgkmcnt(11)
ds_read_b64_tr_b16 a[66:67], v118 offset:2048
v_cvt_pk_bf16_f32 v48, v48, v49
v_mfma_f32_16x16x32_bf16 v[72:75], a[104:107], v[160:163], v[72:75]
s_waitcnt lgkmcnt(10)
ds_read_b64_tr_b16 a[68:69], v118 offset:4096
v_cvt_pk_bf16_f32 v49, v50, v51
v_mfma_f32_16x16x32_bf16 v[72:75], a[108:111], v[176:179], v[72:75]
s_waitcnt lgkmcnt(9)
ds_read_b64_tr_b16 a[70:71], v118 offset:6144
v_cvt_pk_bf16_f32 v50, v56, v57
v_mfma_f32_16x16x32_bf16 v[72:75], a[112:115], v[192:195], v[72:75]
s_waitcnt lgkmcnt(8)
ds_read_b64_tr_b16 a[72:73], v118 offset:8192
v_cvt_pk_bf16_f32 v51, v58, v59
v_mfma_f32_16x16x32_bf16 v[72:75], a[116:119], v[208:211], v[72:75]
s_waitcnt lgkmcnt(7)
ds_read_b64_tr_b16 a[74:75], v118 offset:10240
buffer_store_dwordx4 v[48:51], v1, s[4:7], s8 offen offset:1024 sc1
v_mfma_f32_16x16x32_bf16 v[72:75], a[120:123], v[224:227], v[72:75]
s_waitcnt lgkmcnt(6)
ds_read_b64_tr_b16 a[76:77], v118 offset:12288
v_mul_f32 v52, v52, v25
v_mfma_f32_16x16x32_bf16 v[72:75], a[124:127], v[240:243], v[72:75]
ds_read_b64_tr_b16 a[78:79], v118 offset:14336
buffer_load_dwordx4 v115, s[36:39], s81 offen offset:3072 lds
v_mfma_f32_16x16x32_bf16 v[76:79], a[96:99], v[132:135], 0
ds_read_b64_tr_b16 a[80:81], v118 offset:16384
v_mul_f32 v53, v53, v25
v_mfma_f32_16x16x32_bf16 v[76:79], a[100:103], v[148:151], v[76:79]
ds_read_b64_tr_b16 a[82:83], v118 offset:18432
v_mul_f32 v54, v54, v25
v_mfma_f32_16x16x32_bf16 v[76:79], a[104:107], v[164:167], v[76:79]
ds_read_b64_tr_b16 a[84:85], v118 offset:20480
v_mul_f32 v55, v55, v25
v_mfma_f32_16x16x32_bf16 v[76:79], a[108:111], v[180:183], v[76:79]
ds_read_b64_tr_b16 a[86:87], v118 offset:22528
v_mul_f32 v60, v60, v25
v_mfma_f32_16x16x32_bf16 v[76:79], a[112:115], v[196:199], v[76:79]
ds_read_b64_tr_b16 a[88:89], v118 offset:24576
v_mul_f32 v61, v61, v25
v_mfma_f32_16x16x32_bf16 v[76:79], a[116:119], v[212:215], v[76:79]
s_add_u32 s81, s81, 28672
s_add_u32 m0, s18, 102400
ds_read_b64_tr_b16 a[90:91], v118 offset:26624
v_mfma_f32_16x16x32_bf16 v[76:79], a[120:123], v[228:231], v[76:79]
ds_read_b64_tr_b16 a[92:93], v118 offset:28672
buffer_load_dwordx4 v112, s[36:39], s81 offen offset:0 lds
v_mfma_f32_16x16x32_bf16 v[76:79], a[124:127], v[244:247], v[76:79]
s_waitcnt lgkmcnt(13)
ds_read_b64_tr_b16 a[94:95], v118 offset:30720
v_add_u32 v118, 4294901760, v118
v_mfma_f32_16x16x32_bf16 v[80:83], a[64:67], v[128:131], 0
s_waitcnt lgkmcnt(12)
ds_read_b64_tr_b16 a[96:97], v119 offset:0
v_mul_f32 v62, v62, v25
v_mfma_f32_16x16x32_bf16 v[80:83], a[68:71], v[144:147], v[80:83]
s_waitcnt lgkmcnt(11)
ds_read_b64_tr_b16 a[98:99], v119 offset:2048
v_mul_f32 v63, v63, v25
v_mfma_f32_16x16x32_bf16 v[80:83], a[72:75], v[160:163], v[80:83]
s_waitcnt lgkmcnt(10)
ds_read_b64_tr_b16 a[100:101], v119 offset:4096
v_cvt_pk_bf16_f32 v52, v52, v53
v_mfma_f32_16x16x32_bf16 v[80:83], a[76:79], v[176:179], v[80:83]
s_waitcnt lgkmcnt(9)
ds_read_b64_tr_b16 a[102:103], v119 offset:6144
v_cvt_pk_bf16_f32 v53, v54, v55
v_mfma_f32_16x16x32_bf16 v[80:83], a[80:83], v[192:195], v[80:83]
s_waitcnt lgkmcnt(8)
ds_read_b64_tr_b16 a[104:105], v119 offset:8192
v_cvt_pk_bf16_f32 v54, v60, v61
v_mfma_f32_16x16x32_bf16 v[80:83], a[84:87], v[208:211], v[80:83]
s_waitcnt lgkmcnt(7)
ds_read_b64_tr_b16 a[106:107], v119 offset:10240
buffer_load_dwordx4 v113, s[36:39], s81 offen offset:1024 lds
v_mfma_f32_16x16x32_bf16 v[80:83], a[88:91], v[224:227], v[80:83]
s_waitcnt lgkmcnt(6)
ds_read_b64_tr_b16 a[108:109], v119 offset:12288
v_cvt_pk_bf16_f32 v55, v62, v63
v_mfma_f32_16x16x32_bf16 v[80:83], a[92:95], v[240:243], v[80:83]
ds_read_b64_tr_b16 a[110:111], v119 offset:14336
buffer_store_dwordx4 v[52:55], v1, s[4:7], s12 offen offset:1024 sc1
v_mfma_f32_16x16x32_bf16 v[84:87], a[64:67], v[132:135], 0
ds_read_b64_tr_b16 a[112:113], v119 offset:16384
v_mfma_f32_16x16x32_bf16 v[84:87], a[68:71], v[148:151], v[84:87]
ds_read_b64_tr_b16 a[114:115], v119 offset:18432
v_mul_f32 v64, v64, v24
v_mfma_f32_16x16x32_bf16 v[84:87], a[72:75], v[164:167], v[84:87]
ds_read_b64_tr_b16 a[116:117], v119 offset:20480
v_mul_f32 v65, v65, v24
v_mfma_f32_16x16x32_bf16 v[84:87], a[76:79], v[180:183], v[84:87]
ds_read_b64_tr_b16 a[118:119], v119 offset:22528
v_mul_f32 v66, v66, v24
v_mfma_f32_16x16x32_bf16 v[84:87], a[80:83], v[196:199], v[84:87]
ds_read_b64_tr_b16 a[120:121], v119 offset:24576
buffer_load_dwordx4 v114, s[36:39], s81 offen offset:2048 lds
v_mfma_f32_16x16x32_bf16 v[84:87], a[84:87], v[212:215], v[84:87]
ds_read_b64_tr_b16 a[122:123], v119 offset:26624
v_mul_f32 v67, v67, v24
v_mfma_f32_16x16x32_bf16 v[84:87], a[88:91], v[228:231], v[84:87]
ds_read_b64_tr_b16 a[124:125], v119 offset:28672
ds_read_b64_tr_b16 a[126:127], v119 offset:30720
v_mfma_f32_16x16x32_bf16 v[84:87], a[92:95], v[244:247], v[84:87]
s_waitcnt vmcnt(23) lgkmcnt(14)
s_barrier
v_add_u32 v119, 4294901760, v119
v_mfma_f32_16x16x32_bf16 v[88:91], a[96:99], v[128:131], 0
s_waitcnt lgkmcnt(12)
ds_read_b64_tr_b16 a[64:65], v116 offset:0
v_mul_f32 v72, v72, v24
v_mfma_f32_16x16x32_bf16 v[88:91], a[100:103], v[144:147], v[88:91]
s_waitcnt lgkmcnt(11)
ds_read_b64_tr_b16 a[66:67], v116 offset:2048
v_mul_f32 v73, v73, v24
v_mfma_f32_16x16x32_bf16 v[88:91], a[104:107], v[160:163], v[88:91]
s_waitcnt lgkmcnt(10)
ds_read_b64_tr_b16 a[68:69], v116 offset:4096
v_mul_f32 v74, v74, v24
v_mfma_f32_16x16x32_bf16 v[88:91], a[108:111], v[176:179], v[88:91]
s_waitcnt lgkmcnt(9)
ds_read_b64_tr_b16 a[70:71], v116 offset:6144
buffer_load_dwordx4 v115, s[36:39], s81 offen offset:3072 lds
v_mfma_f32_16x16x32_bf16 v[88:91], a[112:115], v[192:195], v[88:91]
s_waitcnt lgkmcnt(8)
ds_read_b64_tr_b16 a[72:73], v116 offset:8192
v_mul_f32 v75, v75, v24
v_mfma_f32_16x16x32_bf16 v[88:91], a[116:119], v[208:211], v[88:91]
s_waitcnt lgkmcnt(7)
ds_read_b64_tr_b16 a[74:75], v116 offset:10240
v_cvt_pk_bf16_f32 v64, v64, v65
v_mfma_f32_16x16x32_bf16 v[88:91], a[120:123], v[224:227], v[88:91]
s_waitcnt lgkmcnt(6)
ds_read_b64_tr_b16 a[76:77], v116 offset:12288
v_cvt_pk_bf16_f32 v65, v66, v67
v_mfma_f32_16x16x32_bf16 v[88:91], a[124:127], v[240:243], v[88:91]
ds_read_b64_tr_b16 a[78:79], v116 offset:14336
v_cvt_pk_bf16_f32 v66, v72, v73
v_mfma_f32_16x16x32_bf16 v[92:95], a[96:99], v[132:135], 0
ds_read_b64_tr_b16 a[80:81], v116 offset:16384
v_cvt_pk_bf16_f32 v67, v74, v75
v_mfma_f32_16x16x32_bf16 v[92:95], a[100:103], v[148:151], v[92:95]
s_sub_u32 s81, s81, 28544
ds_read_b64_tr_b16 a[82:83], v116 offset:18432
buffer_store_dwordx4 v[64:67], v1, s[4:7], s8 offen offset:2048 sc1
v_mfma_f32_16x16x32_bf16 v[92:95], a[104:107], v[164:167], v[92:95]
ds_read_b64_tr_b16 a[84:85], v116 offset:20480
v_mul_f32 v68, v68, v25
v_mfma_f32_16x16x32_bf16 v[92:95], a[108:111], v[180:183], v[92:95]
ds_read_b64_tr_b16 a[86:87], v116 offset:22528
v_mul_f32 v69, v69, v25
v_mfma_f32_16x16x32_bf16 v[92:95], a[112:115], v[196:199], v[92:95]
ds_read_b64_tr_b16 a[88:89], v116 offset:24576
v_mul_f32 v70, v70, v25
v_mfma_f32_16x16x32_bf16 v[92:95], a[116:119], v[212:215], v[92:95]
ds_read_b64_tr_b16 a[90:91], v116 offset:26624
v_mul_f32 v71, v71, v25
v_mfma_f32_16x16x32_bf16 v[92:95], a[120:123], v[228:231], v[92:95]
ds_read_b64_tr_b16 a[92:93], v116 offset:28672
v_mul_f32 v76, v76, v25
v_mfma_f32_16x16x32_bf16 v[92:95], a[124:127], v[244:247], v[92:95]
s_waitcnt lgkmcnt(13)
ds_read_b64_tr_b16 a[94:95], v116 offset:30720
v_add_u32 v116, 32768, v116
v_mfma_f32_16x16x32_bf16 v[32:35], a[64:67], v[128:131], 0
s_waitcnt lgkmcnt(12)
ds_read_b64_tr_b16 a[96:97], v117 offset:0
v_mul_f32 v77, v77, v25
v_mfma_f32_16x16x32_bf16 v[32:35], a[68:71], v[144:147], v[32:35]
s_waitcnt lgkmcnt(11)
ds_read_b64_tr_b16 a[98:99], v117 offset:2048
v_mul_f32 v78, v78, v25
v_mfma_f32_16x16x32_bf16 v[32:35], a[72:75], v[160:163], v[32:35]
s_waitcnt lgkmcnt(10)
ds_read_b64_tr_b16 a[100:101], v117 offset:4096
v_mul_f32 v79, v79, v25
v_mfma_f32_16x16x32_bf16 v[32:35], a[76:79], v[176:179], v[32:35]
s_waitcnt lgkmcnt(9)
ds_read_b64_tr_b16 a[102:103], v117 offset:6144
v_cvt_pk_bf16_f32 v68, v68, v69
v_mfma_f32_16x16x32_bf16 v[32:35], a[80:83], v[192:195], v[32:35]
s_waitcnt lgkmcnt(8)
ds_read_b64_tr_b16 a[104:105], v117 offset:8192
v_cvt_pk_bf16_f32 v69, v70, v71
v_mfma_f32_16x16x32_bf16 v[32:35], a[84:87], v[208:211], v[32:35]
s_waitcnt lgkmcnt(7)
ds_read_b64_tr_b16 a[106:107], v117 offset:10240
v_cvt_pk_bf16_f32 v70, v76, v77
v_mfma_f32_16x16x32_bf16 v[32:35], a[88:91], v[224:227], v[32:35]
s_waitcnt lgkmcnt(6)
ds_read_b64_tr_b16 a[108:109], v117 offset:12288
v_cvt_pk_bf16_f32 v71, v78, v79
v_mfma_f32_16x16x32_bf16 v[32:35], a[92:95], v[240:243], v[32:35]
ds_read_b64_tr_b16 a[110:111], v117 offset:14336
buffer_store_dwordx4 v[68:71], v1, s[4:7], s12 offen offset:2048 sc1
v_mfma_f32_16x16x32_bf16 v[36:39], a[64:67], v[132:135], 0
ds_read_b64_tr_b16 a[112:113], v117 offset:16384
v_mul_f32 v80, v80, v24
v_mfma_f32_16x16x32_bf16 v[36:39], a[68:71], v[148:151], v[36:39]
ds_read_b64_tr_b16 a[114:115], v117 offset:18432
v_mul_f32 v81, v81, v24
v_mfma_f32_16x16x32_bf16 v[36:39], a[72:75], v[164:167], v[36:39]
ds_read_b64_tr_b16 a[116:117], v117 offset:20480
v_mul_f32 v82, v82, v24
v_mfma_f32_16x16x32_bf16 v[36:39], a[76:79], v[180:183], v[36:39]
ds_read_b64_tr_b16 a[118:119], v117 offset:22528
v_mul_f32 v83, v83, v24
v_mfma_f32_16x16x32_bf16 v[36:39], a[80:83], v[196:199], v[36:39]
ds_read_b64_tr_b16 a[120:121], v117 offset:24576
v_mul_f32 v88, v88, v24
v_mfma_f32_16x16x32_bf16 v[36:39], a[84:87], v[212:215], v[36:39]
ds_read_b64_tr_b16 a[122:123], v117 offset:26624
v_mul_f32 v89, v89, v24
v_mfma_f32_16x16x32_bf16 v[36:39], a[88:91], v[228:231], v[36:39]
ds_read_b64_tr_b16 a[124:125], v117 offset:28672
v_mul_f32 v90, v90, v24
v_mfma_f32_16x16x32_bf16 v[36:39], a[92:95], v[244:247], v[36:39]
s_waitcnt lgkmcnt(13)
ds_read_b64_tr_b16 a[126:127], v117 offset:30720
v_add_u32 v117, 32768, v117
v_mfma_f32_16x16x32_bf16 v[40:43], a[96:99], v[128:131], 0
s_waitcnt lgkmcnt(12)
ds_read_b64_tr_b16 a[64:65], v118 offset:0
v_mul_f32 v91, v91, v24
v_mfma_f32_16x16x32_bf16 v[40:43], a[100:103], v[144:147], v[40:43]
s_waitcnt lgkmcnt(11)
ds_read_b64_tr_b16 a[66:67], v118 offset:2048
v_cvt_pk_bf16_f32 v80, v80, v81
v_mfma_f32_16x16x32_bf16 v[40:43], a[104:107], v[160:163], v[40:43]
s_waitcnt lgkmcnt(10)
ds_read_b64_tr_b16 a[68:69], v118 offset:4096
v_cvt_pk_bf16_f32 v81, v82, v83
v_mfma_f32_16x16x32_bf16 v[40:43], a[108:111], v[176:179], v[40:43]
s_waitcnt lgkmcnt(9)
ds_read_b64_tr_b16 a[70:71], v118 offset:6144
v_cvt_pk_bf16_f32 v82, v88, v89
v_mfma_f32_16x16x32_bf16 v[40:43], a[112:115], v[192:195], v[40:43]
s_waitcnt lgkmcnt(8)
ds_read_b64_tr_b16 a[72:73], v118 offset:8192
v_cvt_pk_bf16_f32 v83, v90, v91
v_mfma_f32_16x16x32_bf16 v[40:43], a[116:119], v[208:211], v[40:43]
s_waitcnt lgkmcnt(7)
ds_read_b64_tr_b16 a[74:75], v118 offset:10240
buffer_store_dwordx4 v[80:83], v1, s[4:7], s8 offen offset:3072 sc1
v_mfma_f32_16x16x32_bf16 v[40:43], a[120:123], v[224:227], v[40:43]
s_waitcnt lgkmcnt(6)
ds_read_b64_tr_b16 a[76:77], v118 offset:12288
v_mul_f32 v84, v84, v25
v_mfma_f32_16x16x32_bf16 v[40:43], a[124:127], v[240:243], v[40:43]
ds_read_b64_tr_b16 a[78:79], v118 offset:14336
v_mul_f32 v85, v85, v25
v_mfma_f32_16x16x32_bf16 v[44:47], a[96:99], v[132:135], 0
ds_read_b64_tr_b16 a[80:81], v118 offset:16384
v_mul_f32 v86, v86, v25
v_mfma_f32_16x16x32_bf16 v[44:47], a[100:103], v[148:151], v[44:47]
ds_read_b64_tr_b16 a[82:83], v118 offset:18432
v_mul_f32 v87, v87, v25
v_mfma_f32_16x16x32_bf16 v[44:47], a[104:107], v[164:167], v[44:47]
ds_read_b64_tr_b16 a[84:85], v118 offset:20480
v_mul_f32 v92, v92, v25
v_mfma_f32_16x16x32_bf16 v[44:47], a[108:111], v[180:183], v[44:47]
ds_read_b64_tr_b16 a[86:87], v118 offset:22528
v_mul_f32 v93, v93, v25
v_mfma_f32_16x16x32_bf16 v[44:47], a[112:115], v[196:199], v[44:47]
ds_read_b64_tr_b16 a[88:89], v118 offset:24576
v_mul_f32 v94, v94, v25
v_mfma_f32_16x16x32_bf16 v[44:47], a[116:119], v[212:215], v[44:47]
ds_read_b64_tr_b16 a[90:91], v118 offset:26624
v_mul_f32 v95, v95, v25
v_mfma_f32_16x16x32_bf16 v[44:47], a[120:123], v[228:231], v[44:47]
ds_read_b64_tr_b16 a[92:93], v118 offset:28672
v_cvt_pk_bf16_f32 v84, v84, v85
v_mfma_f32_16x16x32_bf16 v[44:47], a[124:127], v[244:247], v[44:47]
s_waitcnt lgkmcnt(13)
ds_read_b64_tr_b16 a[94:95], v118 offset:30720
v_add_u32 v118, 32768, v118
v_mfma_f32_16x16x32_bf16 v[48:51], a[64:67], v[128:131], 0
s_waitcnt lgkmcnt(12)
ds_read_b64_tr_b16 a[96:97], v119 offset:0
v_cvt_pk_bf16_f32 v85, v86, v87
v_mfma_f32_16x16x32_bf16 v[48:51], a[68:71], v[144:147], v[48:51]
s_waitcnt lgkmcnt(11)
ds_read_b64_tr_b16 a[98:99], v119 offset:2048
v_cvt_pk_bf16_f32 v86, v92, v93
v_mfma_f32_16x16x32_bf16 v[48:51], a[72:75], v[160:163], v[48:51]
s_waitcnt lgkmcnt(10)
ds_read_b64_tr_b16 a[100:101], v119 offset:4096
v_cvt_pk_bf16_f32 v87, v94, v95
v_mfma_f32_16x16x32_bf16 v[48:51], a[76:79], v[176:179], v[48:51]
s_waitcnt lgkmcnt(7)
ds_read_b64_tr_b16 a[102:103], v119 offset:6144
buffer_store_dwordx4 v[84:87], v1, s[4:7], s12 offen offset:3072 sc1
v_mfma_f32_16x16x32_bf16 v[48:51], a[80:83], v[192:195], v[48:51]
s_add_u32 s8, s8, 4096
s_add_u32 s12, s12, 4096
ds_read_b64_tr_b16 a[104:105], v119 offset:8192
v_mfma_f32_16x16x32_bf16 v[48:51], a[84:87], v[208:211], v[48:51]
s_waitcnt lgkmcnt(7)
ds_read_b64_tr_b16 a[106:107], v119 offset:10240
v_mul_f32 v32, v32, v24
v_mfma_f32_16x16x32_bf16 v[48:51], a[88:91], v[224:227], v[48:51]
s_waitcnt lgkmcnt(6)
ds_read_b64_tr_b16 a[108:109], v119 offset:12288
v_mul_f32 v33, v33, v24
v_mfma_f32_16x16x32_bf16 v[48:51], a[92:95], v[240:243], v[48:51]
ds_read_b64_tr_b16 a[110:111], v119 offset:14336
v_mul_f32 v34, v34, v24
v_mfma_f32_16x16x32_bf16 v[52:55], a[64:67], v[132:135], 0
ds_read_b64_tr_b16 a[112:113], v119 offset:16384
v_mul_f32 v35, v35, v24
v_mfma_f32_16x16x32_bf16 v[52:55], a[68:71], v[148:151], v[52:55]
ds_read_b64_tr_b16 a[114:115], v119 offset:18432
v_mul_f32 v40, v40, v24
v_mfma_f32_16x16x32_bf16 v[52:55], a[72:75], v[164:167], v[52:55]
ds_read_b64_tr_b16 a[116:117], v119 offset:20480
v_mul_f32 v41, v41, v24
v_mfma_f32_16x16x32_bf16 v[52:55], a[76:79], v[180:183], v[52:55]
ds_read_b64_tr_b16 a[118:119], v119 offset:22528
v_mul_f32 v42, v42, v24
v_mfma_f32_16x16x32_bf16 v[52:55], a[80:83], v[196:199], v[52:55]
ds_read_b64_tr_b16 a[120:121], v119 offset:24576
v_mul_f32 v43, v43, v24
v_mfma_f32_16x16x32_bf16 v[52:55], a[84:87], v[212:215], v[52:55]
ds_read_b64_tr_b16 a[122:123], v119 offset:26624
v_cvt_pk_bf16_f32 v32, v32, v33
v_mfma_f32_16x16x32_bf16 v[52:55], a[88:91], v[228:231], v[52:55]
ds_read_b64_tr_b16 a[124:125], v119 offset:28672
ds_read_b64_tr_b16 a[126:127], v119 offset:30720
v_mfma_f32_16x16x32_bf16 v[52:55], a[92:95], v[244:247], v[52:55]
s_waitcnt vmcnt(2) lgkmcnt(14)
s_barrier
v_add_u32 v119, 32768, v119
v_mfma_f32_16x16x32_bf16 v[56:59], a[96:99], v[128:131], 0
s_waitcnt lgkmcnt(12)
ds_read_b64_tr_b16 a[64:65], v116 offset:0
v_cvt_pk_bf16_f32 v33, v34, v35
v_mfma_f32_16x16x32_bf16 v[56:59], a[100:103], v[144:147], v[56:59]
s_waitcnt lgkmcnt(11)
ds_read_b64_tr_b16 a[66:67], v116 offset:2048
buffer_store_dword v6, v5, s[4:7], s34 offen sc1
v_mfma_f32_16x16x32_bf16 v[56:59], a[104:107], v[160:163], v[56:59]
s_waitcnt lgkmcnt(10)
ds_read_b64_tr_b16 a[68:69], v116 offset:4096
v_cvt_pk_bf16_f32 v34, v40, v41
v_mfma_f32_16x16x32_bf16 v[56:59], a[108:111], v[176:179], v[56:59]
s_waitcnt lgkmcnt(9)
ds_read_b64_tr_b16 a[70:71], v116 offset:6144
v_cvt_pk_bf16_f32 v35, v42, v43
v_mfma_f32_16x16x32_bf16 v[56:59], a[112:115], v[192:195], v[56:59]
s_waitcnt lgkmcnt(8)
ds_read_b64_tr_b16 a[72:73], v116 offset:8192
buffer_store_dwordx4 v[32:35], v1, s[4:7], s8 offen offset:0 sc1
v_mfma_f32_16x16x32_bf16 v[56:59], a[116:119], v[208:211], v[56:59]
s_waitcnt lgkmcnt(7)
ds_read_b64_tr_b16 a[74:75], v116 offset:10240
v_mul_f32 v36, v36, v25
v_mfma_f32_16x16x32_bf16 v[56:59], a[120:123], v[224:227], v[56:59]
s_waitcnt lgkmcnt(6)
ds_read_b64_tr_b16 a[76:77], v116 offset:12288
v_mul_f32 v37, v37, v25
v_mfma_f32_16x16x32_bf16 v[56:59], a[124:127], v[240:243], v[56:59]
ds_read_b64_tr_b16 a[78:79], v116 offset:14336
v_mul_f32 v38, v38, v25
v_mfma_f32_16x16x32_bf16 v[60:63], a[96:99], v[132:135], 0
ds_read_b64_tr_b16 a[80:81], v116 offset:16384
v_mul_f32 v39, v39, v25
v_mfma_f32_16x16x32_bf16 v[60:63], a[100:103], v[148:151], v[60:63]
ds_read_b64_tr_b16 a[82:83], v116 offset:18432
v_mul_f32 v44, v44, v25
v_mfma_f32_16x16x32_bf16 v[60:63], a[104:107], v[164:167], v[60:63]
ds_read_b64_tr_b16 a[84:85], v116 offset:20480
v_mul_f32 v45, v45, v25
v_mfma_f32_16x16x32_bf16 v[60:63], a[108:111], v[180:183], v[60:63]
ds_read_b64_tr_b16 a[86:87], v116 offset:22528
v_mul_f32 v46, v46, v25
v_mfma_f32_16x16x32_bf16 v[60:63], a[112:115], v[196:199], v[60:63]
ds_read_b64_tr_b16 a[88:89], v116 offset:24576
v_mul_f32 v47, v47, v25
v_mfma_f32_16x16x32_bf16 v[60:63], a[116:119], v[212:215], v[60:63]
ds_read_b64_tr_b16 a[90:91], v116 offset:26624
v_cvt_pk_bf16_f32 v36, v36, v37
v_mfma_f32_16x16x32_bf16 v[60:63], a[120:123], v[228:231], v[60:63]
ds_read_b64_tr_b16 a[92:93], v116 offset:28672
v_cvt_pk_bf16_f32 v37, v38, v39
v_mfma_f32_16x16x32_bf16 v[60:63], a[124:127], v[244:247], v[60:63]
s_waitcnt lgkmcnt(13)
ds_read_b64_tr_b16 a[94:95], v116 offset:30720
v_add_u32 v116, 65536, v116
v_mfma_f32_16x16x32_bf16 v[64:67], a[64:67], v[128:131], 0
s_waitcnt lgkmcnt(12)
ds_read_b64_tr_b16 a[96:97], v117 offset:0
v_cvt_pk_bf16_f32 v38, v44, v45
v_mfma_f32_16x16x32_bf16 v[64:67], a[68:71], v[144:147], v[64:67]
s_waitcnt lgkmcnt(11)
ds_read_b64_tr_b16 a[98:99], v117 offset:2048
v_cvt_pk_bf16_f32 v39, v46, v47
v_mfma_f32_16x16x32_bf16 v[64:67], a[72:75], v[160:163], v[64:67]
s_waitcnt lgkmcnt(10)
ds_read_b64_tr_b16 a[100:101], v117 offset:4096
buffer_store_dwordx4 v[36:39], v1, s[4:7], s12 offen offset:0 sc1
v_mfma_f32_16x16x32_bf16 v[64:67], a[76:79], v[176:179], v[64:67]
s_waitcnt lgkmcnt(9)
ds_read_b64_tr_b16 a[102:103], v117 offset:6144
v_mul_f32 v48, v48, v24
v_mfma_f32_16x16x32_bf16 v[64:67], a[80:83], v[192:195], v[64:67]
s_waitcnt lgkmcnt(8)
ds_read_b64_tr_b16 a[104:105], v117 offset:8192
v_mul_f32 v49, v49, v24
v_mfma_f32_16x16x32_bf16 v[64:67], a[84:87], v[208:211], v[64:67]
s_waitcnt lgkmcnt(7)
ds_read_b64_tr_b16 a[106:107], v117 offset:10240
v_mul_f32 v50, v50, v24
v_mfma_f32_16x16x32_bf16 v[64:67], a[88:91], v[224:227], v[64:67]
s_waitcnt lgkmcnt(6)
ds_read_b64_tr_b16 a[108:109], v117 offset:12288
v_mul_f32 v51, v51, v24
v_mfma_f32_16x16x32_bf16 v[64:67], a[92:95], v[240:243], v[64:67]
ds_read_b64_tr_b16 a[110:111], v117 offset:14336
v_mul_f32 v56, v56, v24
v_mfma_f32_16x16x32_bf16 v[68:71], a[64:67], v[132:135], 0
ds_read_b64_tr_b16 a[112:113], v117 offset:16384
v_mul_f32 v57, v57, v24
v_mfma_f32_16x16x32_bf16 v[68:71], a[68:71], v[148:151], v[68:71]
ds_read_b64_tr_b16 a[114:115], v117 offset:18432
v_mul_f32 v58, v58, v24
v_mfma_f32_16x16x32_bf16 v[68:71], a[72:75], v[164:167], v[68:71]
ds_read_b64_tr_b16 a[116:117], v117 offset:20480
v_mul_f32 v59, v59, v24
v_mfma_f32_16x16x32_bf16 v[68:71], a[76:79], v[180:183], v[68:71]
ds_read_b64_tr_b16 a[118:119], v117 offset:22528
v_cvt_pk_bf16_f32 v48, v48, v49
v_mfma_f32_16x16x32_bf16 v[68:71], a[80:83], v[196:199], v[68:71]
ds_read_b64_tr_b16 a[120:121], v117 offset:24576
v_cvt_pk_bf16_f32 v49, v50, v51
v_mfma_f32_16x16x32_bf16 v[68:71], a[84:87], v[212:215], v[68:71]
ds_read_b64_tr_b16 a[122:123], v117 offset:26624
v_cvt_pk_bf16_f32 v50, v56, v57
v_mfma_f32_16x16x32_bf16 v[68:71], a[88:91], v[228:231], v[68:71]
ds_read_b64_tr_b16 a[124:125], v117 offset:28672
v_cvt_pk_bf16_f32 v51, v58, v59
v_mfma_f32_16x16x32_bf16 v[68:71], a[92:95], v[244:247], v[68:71]
s_waitcnt lgkmcnt(13)
ds_read_b64_tr_b16 a[126:127], v117 offset:30720
v_add_u32 v117, 65536, v117
v_mfma_f32_16x16x32_bf16 v[72:75], a[96:99], v[128:131], 0
s_waitcnt lgkmcnt(12)
ds_read_b64_tr_b16 a[64:65], v118 offset:0
buffer_store_dwordx4 v[48:51], v1, s[4:7], s8 offen offset:1024 sc1
v_mfma_f32_16x16x32_bf16 v[72:75], a[100:103], v[144:147], v[72:75]
s_waitcnt lgkmcnt(11)
ds_read_b64_tr_b16 a[66:67], v118 offset:2048
v_mul_f32 v52, v52, v25
v_mfma_f32_16x16x32_bf16 v[72:75], a[104:107], v[160:163], v[72:75]
s_waitcnt lgkmcnt(10)
ds_read_b64_tr_b16 a[68:69], v118 offset:4096
v_mul_f32 v53, v53, v25
v_mfma_f32_16x16x32_bf16 v[72:75], a[108:111], v[176:179], v[72:75]
s_waitcnt lgkmcnt(9)
ds_read_b64_tr_b16 a[70:71], v118 offset:6144
v_mul_f32 v54, v54, v25
v_mfma_f32_16x16x32_bf16 v[72:75], a[112:115], v[192:195], v[72:75]
s_waitcnt lgkmcnt(8)
ds_read_b64_tr_b16 a[72:73], v118 offset:8192
v_mul_f32 v55, v55, v25
v_mfma_f32_16x16x32_bf16 v[72:75], a[116:119], v[208:211], v[72:75]
s_waitcnt lgkmcnt(7)
ds_read_b64_tr_b16 a[74:75], v118 offset:10240
v_mul_f32 v60, v60, v25
v_mfma_f32_16x16x32_bf16 v[72:75], a[120:123], v[224:227], v[72:75]
s_waitcnt lgkmcnt(6)
ds_read_b64_tr_b16 a[76:77], v118 offset:12288
v_mul_f32 v61, v61, v25
v_mfma_f32_16x16x32_bf16 v[72:75], a[124:127], v[240:243], v[72:75]
ds_read_b64_tr_b16 a[78:79], v118 offset:14336
v_mul_f32 v62, v62, v25
v_mfma_f32_16x16x32_bf16 v[76:79], a[96:99], v[132:135], 0
ds_read_b64_tr_b16 a[80:81], v118 offset:16384
v_mul_f32 v63, v63, v25
v_mfma_f32_16x16x32_bf16 v[76:79], a[100:103], v[148:151], v[76:79]
ds_read_b64_tr_b16 a[82:83], v118 offset:18432
v_cvt_pk_bf16_f32 v52, v52, v53
v_mfma_f32_16x16x32_bf16 v[76:79], a[104:107], v[164:167], v[76:79]
ds_read_b64_tr_b16 a[84:85], v118 offset:20480
v_cvt_pk_bf16_f32 v53, v54, v55
v_mfma_f32_16x16x32_bf16 v[76:79], a[108:111], v[180:183], v[76:79]
ds_read_b64_tr_b16 a[86:87], v118 offset:22528
v_cvt_pk_bf16_f32 v54, v60, v61
v_mfma_f32_16x16x32_bf16 v[76:79], a[112:115], v[196:199], v[76:79]
ds_read_b64_tr_b16 a[88:89], v118 offset:24576
v_cvt_pk_bf16_f32 v55, v62, v63
v_mfma_f32_16x16x32_bf16 v[76:79], a[116:119], v[212:215], v[76:79]
ds_read_b64_tr_b16 a[90:91], v118 offset:26624
buffer_store_dwordx4 v[52:55], v1, s[4:7], s12 offen offset:1024 sc1
v_mfma_f32_16x16x32_bf16 v[76:79], a[120:123], v[228:231], v[76:79]
ds_read_b64_tr_b16 a[92:93], v118 offset:28672
v_mfma_f32_16x16x32_bf16 v[76:79], a[124:127], v[244:247], v[76:79]
s_waitcnt lgkmcnt(13)
ds_read_b64_tr_b16 a[94:95], v118 offset:30720
v_add_u32 v118, 65536, v118
v_mfma_f32_16x16x32_bf16 v[80:83], a[64:67], v[128:131], 0
s_waitcnt lgkmcnt(12)
ds_read_b64_tr_b16 a[96:97], v119 offset:0
v_mul_f32 v64, v64, v24
v_mfma_f32_16x16x32_bf16 v[80:83], a[68:71], v[144:147], v[80:83]
s_waitcnt lgkmcnt(11)
ds_read_b64_tr_b16 a[98:99], v119 offset:2048
v_mul_f32 v65, v65, v24
v_mfma_f32_16x16x32_bf16 v[80:83], a[72:75], v[160:163], v[80:83]
s_waitcnt lgkmcnt(10)
ds_read_b64_tr_b16 a[100:101], v119 offset:4096
v_mul_f32 v66, v66, v24
v_mfma_f32_16x16x32_bf16 v[80:83], a[76:79], v[176:179], v[80:83]
s_waitcnt lgkmcnt(9)
ds_read_b64_tr_b16 a[102:103], v119 offset:6144
v_mul_f32 v67, v67, v24
v_mfma_f32_16x16x32_bf16 v[80:83], a[80:83], v[192:195], v[80:83]
s_waitcnt lgkmcnt(8)
ds_read_b64_tr_b16 a[104:105], v119 offset:8192
v_mul_f32 v72, v72, v24
v_mfma_f32_16x16x32_bf16 v[80:83], a[84:87], v[208:211], v[80:83]
s_waitcnt lgkmcnt(7)
ds_read_b64_tr_b16 a[106:107], v119 offset:10240
v_mul_f32 v73, v73, v24
v_mfma_f32_16x16x32_bf16 v[80:83], a[88:91], v[224:227], v[80:83]
s_waitcnt lgkmcnt(6)
ds_read_b64_tr_b16 a[108:109], v119 offset:12288
v_mul_f32 v74, v74, v24
v_mfma_f32_16x16x32_bf16 v[80:83], a[92:95], v[240:243], v[80:83]
ds_read_b64_tr_b16 a[110:111], v119 offset:14336
v_mul_f32 v75, v75, v24
v_mfma_f32_16x16x32_bf16 v[84:87], a[64:67], v[132:135], 0
ds_read_b64_tr_b16 a[112:113], v119 offset:16384
v_cvt_pk_bf16_f32 v64, v64, v65
v_mfma_f32_16x16x32_bf16 v[84:87], a[68:71], v[148:151], v[84:87]
ds_read_b64_tr_b16 a[114:115], v119 offset:18432
v_cvt_pk_bf16_f32 v65, v66, v67
v_mfma_f32_16x16x32_bf16 v[84:87], a[72:75], v[164:167], v[84:87]
ds_read_b64_tr_b16 a[116:117], v119 offset:20480
v_cvt_pk_bf16_f32 v66, v72, v73
v_mfma_f32_16x16x32_bf16 v[84:87], a[76:79], v[180:183], v[84:87]
ds_read_b64_tr_b16 a[118:119], v119 offset:22528
v_cvt_pk_bf16_f32 v67, v74, v75
v_mfma_f32_16x16x32_bf16 v[84:87], a[80:83], v[196:199], v[84:87]
ds_read_b64_tr_b16 a[120:121], v119 offset:24576
buffer_store_dwordx4 v[64:67], v1, s[4:7], s8 offen offset:2048 sc1
v_mfma_f32_16x16x32_bf16 v[84:87], a[84:87], v[212:215], v[84:87]
ds_read_b64_tr_b16 a[122:123], v119 offset:26624
v_mul_f32 v68, v68, v25
v_mfma_f32_16x16x32_bf16 v[84:87], a[88:91], v[228:231], v[84:87]
ds_read_b64_tr_b16 a[124:125], v119 offset:28672
ds_read_b64_tr_b16 a[126:127], v119 offset:30720
v_mfma_f32_16x16x32_bf16 v[84:87], a[92:95], v[244:247], v[84:87]
s_waitcnt vmcnt(10) lgkmcnt(14)
s_barrier
v_add_u32 v119, 65536, v119
v_mfma_f32_16x16x32_bf16 v[88:91], a[96:99], v[128:131], 0
s_waitcnt lgkmcnt(12)
ds_read_b64_tr_b16 a[64:65], v116 offset:0
v_mul_f32 v69, v69, v25
v_mfma_f32_16x16x32_bf16 v[88:91], a[100:103], v[144:147], v[88:91]
s_waitcnt lgkmcnt(11)
ds_read_b64_tr_b16 a[66:67], v116 offset:2048
v_mul_f32 v70, v70, v25
v_mfma_f32_16x16x32_bf16 v[88:91], a[104:107], v[160:163], v[88:91]
s_waitcnt lgkmcnt(10)
ds_read_b64_tr_b16 a[68:69], v116 offset:4096
v_mul_f32 v71, v71, v25
v_mfma_f32_16x16x32_bf16 v[88:91], a[108:111], v[176:179], v[88:91]
s_waitcnt lgkmcnt(9)
ds_read_b64_tr_b16 a[70:71], v116 offset:6144
v_mul_f32 v76, v76, v25
v_mfma_f32_16x16x32_bf16 v[88:91], a[112:115], v[192:195], v[88:91]
s_waitcnt lgkmcnt(8)
ds_read_b64_tr_b16 a[72:73], v116 offset:8192
v_mul_f32 v77, v77, v25
v_mfma_f32_16x16x32_bf16 v[88:91], a[116:119], v[208:211], v[88:91]
s_waitcnt lgkmcnt(7)
ds_read_b64_tr_b16 a[74:75], v116 offset:10240
v_mul_f32 v78, v78, v25
v_mfma_f32_16x16x32_bf16 v[88:91], a[120:123], v[224:227], v[88:91]
s_waitcnt lgkmcnt(6)
ds_read_b64_tr_b16 a[76:77], v116 offset:12288
v_mul_f32 v79, v79, v25
v_mfma_f32_16x16x32_bf16 v[88:91], a[124:127], v[240:243], v[88:91]
ds_read_b64_tr_b16 a[78:79], v116 offset:14336
v_cvt_pk_bf16_f32 v68, v68, v69
v_mfma_f32_16x16x32_bf16 v[92:95], a[96:99], v[132:135], 0
ds_read_b64_tr_b16 a[80:81], v116 offset:16384
v_cvt_pk_bf16_f32 v69, v70, v71
v_mfma_f32_16x16x32_bf16 v[92:95], a[100:103], v[148:151], v[92:95]
ds_read_b64_tr_b16 a[82:83], v116 offset:18432
v_cvt_pk_bf16_f32 v70, v76, v77
v_mfma_f32_16x16x32_bf16 v[92:95], a[104:107], v[164:167], v[92:95]
ds_read_b64_tr_b16 a[84:85], v116 offset:20480
v_cvt_pk_bf16_f32 v71, v78, v79
v_mfma_f32_16x16x32_bf16 v[92:95], a[108:111], v[180:183], v[92:95]
ds_read_b64_tr_b16 a[86:87], v116 offset:22528
buffer_store_dwordx4 v[68:71], v1, s[4:7], s12 offen offset:2048 sc1
v_mfma_f32_16x16x32_bf16 v[92:95], a[112:115], v[196:199], v[92:95]
ds_read_b64_tr_b16 a[88:89], v116 offset:24576
v_mfma_f32_16x16x32_bf16 v[92:95], a[116:119], v[212:215], v[92:95]
ds_read_b64_tr_b16 a[90:91], v116 offset:26624
v_mfma_f32_16x16x32_bf16 v[92:95], a[120:123], v[228:231], v[92:95]
ds_read_b64_tr_b16 a[92:93], v116 offset:28672
v_mfma_f32_16x16x32_bf16 v[92:95], a[124:127], v[244:247], v[92:95]
s_waitcnt lgkmcnt(13)
ds_read_b64_tr_b16 a[94:95], v116 offset:30720
v_mfma_f32_16x16x32_bf16 v[32:35], a[64:67], v[128:131], 0
s_waitcnt lgkmcnt(12)
ds_read_b64_tr_b16 a[96:97], v117 offset:0
v_mul_f32 v80, v80, v24
v_mfma_f32_16x16x32_bf16 v[32:35], a[68:71], v[144:147], v[32:35]
s_waitcnt lgkmcnt(11)
ds_read_b64_tr_b16 a[98:99], v117 offset:2048
v_mul_f32 v81, v81, v24
v_mfma_f32_16x16x32_bf16 v[32:35], a[72:75], v[160:163], v[32:35]
s_waitcnt lgkmcnt(10)
ds_read_b64_tr_b16 a[100:101], v117 offset:4096
v_mul_f32 v82, v82, v24
v_mfma_f32_16x16x32_bf16 v[32:35], a[76:79], v[176:179], v[32:35]
s_waitcnt lgkmcnt(9)
ds_read_b64_tr_b16 a[102:103], v117 offset:6144
v_mul_f32 v83, v83, v24
v_mfma_f32_16x16x32_bf16 v[32:35], a[80:83], v[192:195], v[32:35]
s_waitcnt lgkmcnt(8)
ds_read_b64_tr_b16 a[104:105], v117 offset:8192
v_mul_f32 v88, v88, v24
v_mfma_f32_16x16x32_bf16 v[32:35], a[84:87], v[208:211], v[32:35]
s_waitcnt lgkmcnt(7)
ds_read_b64_tr_b16 a[106:107], v117 offset:10240
v_mul_f32 v89, v89, v24
v_mfma_f32_16x16x32_bf16 v[32:35], a[88:91], v[224:227], v[32:35]
s_waitcnt lgkmcnt(6)
ds_read_b64_tr_b16 a[108:109], v117 offset:12288
v_mul_f32 v90, v90, v24
v_mfma_f32_16x16x32_bf16 v[32:35], a[92:95], v[240:243], v[32:35]
ds_read_b64_tr_b16 a[110:111], v117 offset:14336
v_mul_f32 v91, v91, v24
v_mfma_f32_16x16x32_bf16 v[36:39], a[64:67], v[132:135], 0
ds_read_b64_tr_b16 a[112:113], v117 offset:16384
v_cvt_pk_bf16_f32 v80, v80, v81
v_mfma_f32_16x16x32_bf16 v[36:39], a[68:71], v[148:151], v[36:39]
ds_read_b64_tr_b16 a[114:115], v117 offset:18432
v_cvt_pk_bf16_f32 v81, v82, v83
v_mfma_f32_16x16x32_bf16 v[36:39], a[72:75], v[164:167], v[36:39]
ds_read_b64_tr_b16 a[116:117], v117 offset:20480
v_cvt_pk_bf16_f32 v82, v88, v89
v_mfma_f32_16x16x32_bf16 v[36:39], a[76:79], v[180:183], v[36:39]
ds_read_b64_tr_b16 a[118:119], v117 offset:22528
v_cvt_pk_bf16_f32 v83, v90, v91
v_mfma_f32_16x16x32_bf16 v[36:39], a[80:83], v[196:199], v[36:39]
ds_read_b64_tr_b16 a[120:121], v117 offset:24576
buffer_store_dwordx4 v[80:83], v1, s[4:7], s8 offen offset:3072 sc1
v_mfma_f32_16x16x32_bf16 v[36:39], a[84:87], v[212:215], v[36:39]
ds_read_b64_tr_b16 a[122:123], v117 offset:26624
v_mul_f32 v84, v84, v25
v_mfma_f32_16x16x32_bf16 v[36:39], a[88:91], v[228:231], v[36:39]
ds_read_b64_tr_b16 a[124:125], v117 offset:28672
v_mul_f32 v85, v85, v25
v_mfma_f32_16x16x32_bf16 v[36:39], a[92:95], v[244:247], v[36:39]
s_waitcnt lgkmcnt(13)
ds_read_b64_tr_b16 a[126:127], v117 offset:30720
v_mul_f32 v86, v86, v25
v_mfma_f32_16x16x32_bf16 v[40:43], a[96:99], v[128:131], 0
s_waitcnt lgkmcnt(12)
ds_read_b64_tr_b16 a[64:65], v118 offset:0
v_mul_f32 v87, v87, v25
v_mfma_f32_16x16x32_bf16 v[40:43], a[100:103], v[144:147], v[40:43]
s_waitcnt lgkmcnt(11)
ds_read_b64_tr_b16 a[66:67], v118 offset:2048
v_mul_f32 v92, v92, v25
v_mfma_f32_16x16x32_bf16 v[40:43], a[104:107], v[160:163], v[40:43]
s_waitcnt lgkmcnt(10)
ds_read_b64_tr_b16 a[68:69], v118 offset:4096
v_mul_f32 v93, v93, v25
v_mfma_f32_16x16x32_bf16 v[40:43], a[108:111], v[176:179], v[40:43]
s_waitcnt lgkmcnt(9)
ds_read_b64_tr_b16 a[70:71], v118 offset:6144
v_mul_f32 v94, v94, v25
v_mfma_f32_16x16x32_bf16 v[40:43], a[112:115], v[192:195], v[40:43]
s_waitcnt lgkmcnt(8)
ds_read_b64_tr_b16 a[72:73], v118 offset:8192
v_mul_f32 v95, v95, v25
v_mfma_f32_16x16x32_bf16 v[40:43], a[116:119], v[208:211], v[40:43]
s_waitcnt lgkmcnt(7)
ds_read_b64_tr_b16 a[74:75], v118 offset:10240
v_cvt_pk_bf16_f32 v84, v84, v85
v_mfma_f32_16x16x32_bf16 v[40:43], a[120:123], v[224:227], v[40:43]
s_waitcnt lgkmcnt(6)
ds_read_b64_tr_b16 a[76:77], v118 offset:12288
v_cvt_pk_bf16_f32 v85, v86, v87
v_mfma_f32_16x16x32_bf16 v[40:43], a[124:127], v[240:243], v[40:43]
ds_read_b64_tr_b16 a[78:79], v118 offset:14336
v_cvt_pk_bf16_f32 v86, v92, v93
v_mfma_f32_16x16x32_bf16 v[44:47], a[96:99], v[132:135], 0
ds_read_b64_tr_b16 a[80:81], v118 offset:16384
v_cvt_pk_bf16_f32 v87, v94, v95
v_mfma_f32_16x16x32_bf16 v[44:47], a[100:103], v[148:151], v[44:47]
ds_read_b64_tr_b16 a[82:83], v118 offset:18432
buffer_store_dwordx4 v[84:87], v1, s[4:7], s12 offen offset:3072 sc1
v_mfma_f32_16x16x32_bf16 v[44:47], a[104:107], v[164:167], v[44:47]
s_add_u32 s8, s8, 4096
s_add_u32 s12, s12, 4096
ds_read_b64_tr_b16 a[84:85], v118 offset:20480
v_mfma_f32_16x16x32_bf16 v[44:47], a[108:111], v[180:183], v[44:47]
ds_read_b64_tr_b16 a[86:87], v118 offset:22528
v_mfma_f32_16x16x32_bf16 v[44:47], a[112:115], v[196:199], v[44:47]
ds_read_b64_tr_b16 a[88:89], v118 offset:24576
v_mul_f32 v32, v32, v24
v_mfma_f32_16x16x32_bf16 v[44:47], a[116:119], v[212:215], v[44:47]
ds_read_b64_tr_b16 a[90:91], v118 offset:26624
v_mul_f32 v33, v33, v24
v_mfma_f32_16x16x32_bf16 v[44:47], a[120:123], v[228:231], v[44:47]
ds_read_b64_tr_b16 a[92:93], v118 offset:28672
v_mul_f32 v34, v34, v24
v_mfma_f32_16x16x32_bf16 v[44:47], a[124:127], v[244:247], v[44:47]
s_waitcnt lgkmcnt(13)
ds_read_b64_tr_b16 a[94:95], v118 offset:30720
v_mul_f32 v35, v35, v24
v_mfma_f32_16x16x32_bf16 v[48:51], a[64:67], v[128:131], 0
s_waitcnt lgkmcnt(12)
ds_read_b64_tr_b16 a[96:97], v119 offset:0
v_mul_f32 v40, v40, v24
v_mfma_f32_16x16x32_bf16 v[48:51], a[68:71], v[144:147], v[48:51]
s_waitcnt lgkmcnt(11)
ds_read_b64_tr_b16 a[98:99], v119 offset:2048
v_mul_f32 v41, v41, v24
v_mfma_f32_16x16x32_bf16 v[48:51], a[72:75], v[160:163], v[48:51]
s_waitcnt lgkmcnt(10)
ds_read_b64_tr_b16 a[100:101], v119 offset:4096
v_mul_f32 v42, v42, v24
v_mfma_f32_16x16x32_bf16 v[48:51], a[76:79], v[176:179], v[48:51]
s_waitcnt lgkmcnt(9)
ds_read_b64_tr_b16 a[102:103], v119 offset:6144
v_mul_f32 v43, v43, v24
v_mfma_f32_16x16x32_bf16 v[48:51], a[80:83], v[192:195], v[48:51]
s_waitcnt lgkmcnt(8)
ds_read_b64_tr_b16 a[104:105], v119 offset:8192
v_cvt_pk_bf16_f32 v32, v32, v33
v_mfma_f32_16x16x32_bf16 v[48:51], a[84:87], v[208:211], v[48:51]
s_waitcnt lgkmcnt(7)
ds_read_b64_tr_b16 a[106:107], v119 offset:10240
v_cvt_pk_bf16_f32 v33, v34, v35
v_mfma_f32_16x16x32_bf16 v[48:51], a[88:91], v[224:227], v[48:51]
s_waitcnt lgkmcnt(6)
ds_read_b64_tr_b16 a[108:109], v119 offset:12288
v_cvt_pk_bf16_f32 v34, v40, v41
v_mfma_f32_16x16x32_bf16 v[48:51], a[92:95], v[240:243], v[48:51]
ds_read_b64_tr_b16 a[110:111], v119 offset:14336
v_cvt_pk_bf16_f32 v35, v42, v43
v_mfma_f32_16x16x32_bf16 v[52:55], a[64:67], v[132:135], 0
ds_read_b64_tr_b16 a[112:113], v119 offset:16384
buffer_store_dwordx4 v[32:35], v1, s[4:7], s8 offen offset:0 sc1
v_mfma_f32_16x16x32_bf16 v[52:55], a[68:71], v[148:151], v[52:55]
ds_read_b64_tr_b16 a[114:115], v119 offset:18432
v_mul_f32 v36, v36, v25
v_mfma_f32_16x16x32_bf16 v[52:55], a[72:75], v[164:167], v[52:55]
ds_read_b64_tr_b16 a[116:117], v119 offset:20480
v_mul_f32 v37, v37, v25
v_mfma_f32_16x16x32_bf16 v[52:55], a[76:79], v[180:183], v[52:55]
ds_read_b64_tr_b16 a[118:119], v119 offset:22528
v_mul_f32 v38, v38, v25
v_mfma_f32_16x16x32_bf16 v[52:55], a[80:83], v[196:199], v[52:55]
ds_read_b64_tr_b16 a[120:121], v119 offset:24576
v_mul_f32 v39, v39, v25
v_mfma_f32_16x16x32_bf16 v[52:55], a[84:87], v[212:215], v[52:55]
ds_read_b64_tr_b16 a[122:123], v119 offset:26624
v_mul_f32 v44, v44, v25
v_mfma_f32_16x16x32_bf16 v[52:55], a[88:91], v[228:231], v[52:55]
ds_read_b64_tr_b16 a[124:125], v119 offset:28672
ds_read_b64_tr_b16 a[126:127], v119 offset:30720
v_mfma_f32_16x16x32_bf16 v[52:55], a[92:95], v[244:247], v[52:55]
s_waitcnt lgkmcnt(14)
v_mul_f32 v45, v45, v25
v_mul_f32 v46, v46, v25
v_mfma_f32_16x16x32_bf16 v[56:59], a[96:99], v[128:131], 0
s_waitcnt lgkmcnt(12)
v_mul_f32 v47, v47, v25
v_cvt_pk_bf16_f32 v36, v36, v37
v_mfma_f32_16x16x32_bf16 v[56:59], a[100:103], v[144:147], v[56:59]
s_waitcnt lgkmcnt(10)
v_cvt_pk_bf16_f32 v37, v38, v39
v_cvt_pk_bf16_f32 v38, v44, v45
v_mfma_f32_16x16x32_bf16 v[56:59], a[104:107], v[160:163], v[56:59]
s_waitcnt lgkmcnt(8)
v_cvt_pk_bf16_f32 v39, v46, v47
v_mfma_f32_16x16x32_bf16 v[56:59], a[108:111], v[176:179], v[56:59]
s_waitcnt lgkmcnt(6)
buffer_store_dwordx4 v[36:39], v1, s[4:7], s12 offen offset:0 sc1
v_mfma_f32_16x16x32_bf16 v[56:59], a[112:115], v[192:195], v[56:59]
s_waitcnt lgkmcnt(4)
v_mfma_f32_16x16x32_bf16 v[56:59], a[116:119], v[208:211], v[56:59]
s_waitcnt lgkmcnt(2)
v_mfma_f32_16x16x32_bf16 v[56:59], a[120:123], v[224:227], v[56:59]
s_waitcnt lgkmcnt(0)
v_mfma_f32_16x16x32_bf16 v[56:59], a[124:127], v[240:243], v[56:59]
v_mfma_f32_16x16x32_bf16 v[60:63], a[96:99], v[132:135], 0
v_mfma_f32_16x16x32_bf16 v[60:63], a[100:103], v[148:151], v[60:63]
v_mfma_f32_16x16x32_bf16 v[60:63], a[104:107], v[164:167], v[60:63]
v_mfma_f32_16x16x32_bf16 v[60:63], a[108:111], v[180:183], v[60:63]
v_mfma_f32_16x16x32_bf16 v[60:63], a[112:115], v[196:199], v[60:63]
buffer_load_dword v18, v19, s[4:7], s33 offen offset:0 sc1
v_mfma_f32_16x16x32_bf16 v[60:63], a[116:119], v[212:215], v[60:63]
v_mfma_f32_16x16x32_bf16 v[60:63], a[120:123], v[228:231], v[60:63]
v_mfma_f32_16x16x32_bf16 v[60:63], a[124:127], v[244:247], v[60:63]
v_mul_f32 v48, v48, v24
v_mul_f32 v49, v49, v24
v_mul_f32 v50, v50, v24
v_mul_f32 v51, v51, v24
v_mul_f32 v56, v56, v24
v_mul_f32 v57, v57, v24
v_mul_f32 v58, v58, v24
v_mul_f32 v59, v59, v24
v_cvt_pk_bf16_f32 v48, v48, v49
v_cvt_pk_bf16_f32 v49, v50, v51
v_cvt_pk_bf16_f32 v50, v56, v57
v_cvt_pk_bf16_f32 v51, v58, v59
buffer_store_dwordx4 v[48:51], v1, s[4:7], s8 offen offset:1024 sc1
v_mul_f32 v52, v52, v25
v_mul_f32 v53, v53, v25
v_mul_f32 v54, v54, v25
v_mul_f32 v55, v55, v25
v_mul_f32 v60, v60, v25
v_mul_f32 v61, v61, v25
v_mul_f32 v62, v62, v25
v_mul_f32 v63, v63, v25
v_cvt_pk_bf16_f32 v52, v52, v53
v_cvt_pk_bf16_f32 v53, v54, v55
v_cvt_pk_bf16_f32 v54, v60, v61
v_cvt_pk_bf16_f32 v55, v62, v63
buffer_store_dwordx4 v[52:55], v1, s[4:7], s12 offen offset:1024 sc1
s_and_b32 s22, s2, 224
s_cmp_eq_u32 s22, 224
s_cbranch_scc1 M_final
s_waitcnt vmcnt(0)
s_barrier
buffer_store_dword v6, v5, s[4:7], s35 offen sc1
s_cmp_eq_u32 s21, 7
s_cbranch_scc1 M_fin
v_cmp_gt_u32 vcc, 1, v18
s_cbranch_vccnz M_rslow
M_rjoin:
buffer_load_dwordx4 v[128:131], v1, s[4:7], s26 offen sc1
s_add_u32 s26, s26, 14336
buffer_load_dwordx4 v[132:135], v1, s[4:7], s26 offen sc1
s_add_u32 s26, s26, 14336
buffer_load_dwordx4 v[136:139], v1, s[4:7], s26 offen sc1
s_add_u32 s26, s26, 14336
buffer_load_dwordx4 v[140:143], v1, s[4:7], s26 offen sc1
s_add_u32 s26, s26, 14336
buffer_load_dwordx4 v[144:147], v1, s[4:7], s26 offen sc1
s_add_u32 s26, s26, 14336
buffer_load_dwordx4 v[148:151], v1, s[4:7], s26 offen sc1
s_add_u32 s26, s26, 14336
buffer_load_dwordx4 v[152:155], v1, s[4:7], s26 offen sc1
s_add_u32 s26, s26, 14336
buffer_load_dwordx4 v[156:159], v1, s[4:7], s26 offen sc1
s_add_u32 s26, s26, 14336
buffer_load_dwordx4 v[160:163], v1, s[4:7], s26 offen sc1
s_add_u32 s26, s26, 14336
buffer_load_dwordx4 v[164:167], v1, s[4:7], s26 offen sc1
s_add_u32 s26, s26, 14336
buffer_load_dwordx4 v[168:171], v1, s[4:7], s26 offen sc1
s_add_u32 s26, s26, 14336
buffer_load_dwordx4 v[172:175], v1, s[4:7], s26 offen sc1
s_add_u32 s26, s26, 14336
buffer_load_dwordx4 v[176:179], v1, s[4:7], s26 offen sc1
s_add_u32 s26, s26, 14336
buffer_load_dwordx4 v[180:183], v1, s[4:7], s26 offen sc1
s_add_u32 s26, s26, 14336
buffer_load_dwordx4 v[184:187], v1, s[4:7], s26 offen sc1
s_add_u32 s26, s26, 14336
buffer_load_dwordx4 v[188:191], v1, s[4:7], s26 offen sc1
Lp_9201:
buffer_load_dword v18, v19, s[4:7], s33 offen offset:2048 sc1
s_waitcnt vmcnt(0)
v_cmp_gt_u32 vcc, 1, v18
s_cbranch_vccz Lpd_9202
s_sleep 8
s_sub_u32 s101, s101, 1
s_cbranch_scc0 Lp_9201
s_mov_b32 s101, 0
Lpd_9202:
s_sub_u32 s26, s26, 207872
buffer_load_dwordx4 v[192:195], v1, s[4:7], s26 offen sc1
s_add_u32 s26, s26, 14336
buffer_load_dwordx4 v[196:199], v1, s[4:7], s26 offen sc1
s_add_u32 s26, s26, 14336
buffer_load_dwordx4 v[200:203], v1, s[4:7], s26 offen sc1
s_add_u32 s26, s26, 14336
buffer_load_dwordx4 v[204:207], v1, s[4:7], s26 offen sc1
s_add_u32 s26, s26, 14336
buffer_load_dwordx4 v[208:211], v1, s[4:7], s26 offen sc1
s_add_u32 s26, s26, 14336
buffer_load_dwordx4 v[212:215], v1, s[4:7], s26 offen sc1
s_add_u32 s26, s26, 14336
buffer_load_dwordx4 v[216:219], v1, s[4:7], s26 offen sc1
s_add_u32 s26, s26, 14336
buffer_load_dwordx4 v[220:223], v1, s[4:7], s26 offen sc1
s_add_u32 s26, s26, 14336
buffer_load_dwordx4 v[224:227], v1, s[4:7], s26 offen sc1
s_add_u32 s26, s26, 14336
buffer_load_dwordx4 v[228:231], v1, s[4:7], s26 offen sc1
s_add_u32 s26, s26, 14336
buffer_load_dwordx4 v[232:235], v1, s[4:7], s26 offen sc1
s_add_u32 s26, s26, 14336
buffer_load_dwordx4 v[236:239], v1, s[4:7], s26 offen sc1
s_add_u32 s26, s26, 14336
buffer_load_dwordx4 v[240:243], v1, s[4:7], s26 offen sc1
s_add_u32 s26, s26, 14336
buffer_load_dwordx4 v[244:247], v1, s[4:7], s26 offen sc1
s_add_u32 s26, s26, 14336
buffer_load_dwordx4 v[248:251], v1, s[4:7], s26 offen sc1
s_add_u32 s26, s26, 14336
buffer_load_dwordx4 v[252:255], v1, s[4:7], s26 offen sc1
v_lshlrev_b32 v96, 16, v128
v_and_b32 v97, 0xffff0000, v128
v_lshlrev_b32 v98, 16, v129
v_and_b32 v99, 0xffff0000, v129
v_lshlrev_b32 v100, 16, v130
v_and_b32 v101, 0xffff0000, v130
v_lshlrev_b32 v102, 16, v131
v_and_b32 v103, 0xffff0000, v131
v_lshlrev_b32 v10, 16, v132
v_and_b32 v11, 0xffff0000, v132
v_lshlrev_b32 v12, 16, v133
v_and_b32 v13, 0xffff0000, v133
v_lshlrev_b32 v14, 16, v134
v_and_b32 v15, 0xffff0000, v134
v_lshlrev_b32 v16, 16, v135
v_and_b32 v17, 0xffff0000, v135
v_pk_add_f32 v[96:97], v[96:97], v[10:11]
v_pk_add_f32 v[98:99], v[98:99], v[12:13]
v_pk_add_f32 v[100:101], v[100:101], v[14:15]
v_pk_add_f32 v[102:103], v[102:103], v[16:17]
v_lshlrev_b32 v10, 16, v136
v_and_b32 v11, 0xffff0000, v136
v_lshlrev_b32 v12, 16, v137
v_and_b32 v13, 0xffff0000, v137
v_lshlrev_b32 v14, 16, v138
v_and_b32 v15, 0xffff0000, v138
v_lshlrev_b32 v16, 16, v139
v_and_b32 v17, 0xffff0000, v139
v_pk_add_f32 v[96:97], v[96:97], v[10:11]
v_pk_add_f32 v[98:99], v[98:99], v[12:13]
v_pk_add_f32 v[100:101], v[100:101], v[14:15]
v_pk_add_f32 v[102:103], v[102:103], v[16:17]
v_lshlrev_b32 v10, 16, v140
v_and_b32 v11, 0xffff0000, v140
v_lshlrev_b32 v12, 16, v141
v_and_b32 v13, 0xffff0000, v141
v_lshlrev_b32 v14, 16, v142
v_and_b32 v15, 0xffff0000, v142
v_lshlrev_b32 v16, 16, v143
v_and_b32 v17, 0xffff0000, v143
v_pk_add_f32 v[96:97], v[96:97], v[10:11]
v_pk_add_f32 v[98:99], v[98:99], v[12:13]
v_pk_add_f32 v[100:101], v[100:101], v[14:15]
v_pk_add_f32 v[102:103], v[102:103], v[16:17]
v_lshlrev_b32 v10, 16, v144
v_and_b32 v11, 0xffff0000, v144
v_lshlrev_b32 v12, 16, v145
v_and_b32 v13, 0xffff0000, v145
v_lshlrev_b32 v14, 16, v146
v_and_b32 v15, 0xffff0000, v146
v_lshlrev_b32 v16, 16, v147
v_and_b32 v17, 0xffff0000, v147
v_pk_add_f32 v[96:97], v[96:97], v[10:11]
v_pk_add_f32 v[98:99], v[98:99], v[12:13]
v_pk_add_f32 v[100:101], v[100:101], v[14:15]
v_pk_add_f32 v[102:103], v[102:103], v[16:17]
v_lshlrev_b32 v10, 16, v148
v_and_b32 v11, 0xffff0000, v148
v_lshlrev_b32 v12, 16, v149
v_and_b32 v13, 0xffff0000, v149
v_lshlrev_b32 v14, 16, v150
v_and_b32 v15, 0xffff0000, v150
v_lshlrev_b32 v16, 16, v151
v_and_b32 v17, 0xffff0000, v151
v_pk_add_f32 v[96:97], v[96:97], v[10:11]
v_pk_add_f32 v[98:99], v[98:99], v[12:13]
v_pk_add_f32 v[100:101], v[100:101], v[14:15]
v_pk_add_f32 v[102:103], v[102:103], v[16:17]
v_lshlrev_b32 v10, 16, v152
v_and_b32 v11, 0xffff0000, v152
v_lshlrev_b32 v12, 16, v153
v_and_b32 v13, 0xffff0000, v153
v_lshlrev_b32 v14, 16, v154
v_and_b32 v15, 0xffff0000, v154
v_lshlrev_b32 v16, 16, v155
v_and_b32 v17, 0xffff0000, v155
v_pk_add_f32 v[96:97], v[96:97], v[10:11]
v_pk_add_f32 v[98:99], v[98:99], v[12:13]
v_pk_add_f32 v[100:101], v[100:101], v[14:15]
v_pk_add_f32 v[102:103], v[102:103], v[16:17]
v_lshlrev_b32 v10, 16, v156
v_and_b32 v11, 0xffff0000, v156
v_lshlrev_b32 v12, 16, v157
v_and_b32 v13, 0xffff0000, v157
v_lshlrev_b32 v14, 16, v158
v_and_b32 v15, 0xffff0000, v158
v_lshlrev_b32 v16, 16, v159
v_and_b32 v17, 0xffff0000, v159
v_pk_add_f32 v[96:97], v[96:97], v[10:11]
v_pk_add_f32 v[98:99], v[98:99], v[12:13]
v_pk_add_f32 v[100:101], v[100:101], v[14:15]
v_pk_add_f32 v[102:103], v[102:103], v[16:17]
v_lshlrev_b32 v10, 16, v160
v_and_b32 v11, 0xffff0000, v160
v_lshlrev_b32 v12, 16, v161
v_and_b32 v13, 0xffff0000, v161
v_lshlrev_b32 v14, 16, v162
v_and_b32 v15, 0xffff0000, v162
v_lshlrev_b32 v16, 16, v163
v_and_b32 v17, 0xffff0000, v163
v_pk_add_f32 v[96:97], v[96:97], v[10:11]
v_pk_add_f32 v[98:99], v[98:99], v[12:13]
v_pk_add_f32 v[100:101], v[100:101], v[14:15]
v_pk_add_f32 v[102:103], v[102:103], v[16:17]
v_lshlrev_b32 v10, 16, v164
v_and_b32 v11, 0xffff0000, v164
v_lshlrev_b32 v12, 16, v165
v_and_b32 v13, 0xffff0000, v165
v_lshlrev_b32 v14, 16, v166
v_and_b32 v15, 0xffff0000, v166
v_lshlrev_b32 v16, 16, v167
v_and_b32 v17, 0xffff0000, v167
v_pk_add_f32 v[96:97], v[96:97], v[10:11]
v_pk_add_f32 v[98:99], v[98:99], v[12:13]
v_pk_add_f32 v[100:101], v[100:101], v[14:15]
v_pk_add_f32 v[102:103], v[102:103], v[16:17]
v_lshlrev_b32 v10, 16, v168
v_and_b32 v11, 0xffff0000, v168
v_lshlrev_b32 v12, 16, v169
v_and_b32 v13, 0xffff0000, v169
v_lshlrev_b32 v14, 16, v170
v_and_b32 v15, 0xffff0000, v170
v_lshlrev_b32 v16, 16, v171
v_and_b32 v17, 0xffff0000, v171
v_pk_add_f32 v[96:97], v[96:97], v[10:11]
v_pk_add_f32 v[98:99], v[98:99], v[12:13]
v_pk_add_f32 v[100:101], v[100:101], v[14:15]
v_pk_add_f32 v[102:103], v[102:103], v[16:17]
v_lshlrev_b32 v10, 16, v172
v_and_b32 v11, 0xffff0000, v172
v_lshlrev_b32 v12, 16, v173
v_and_b32 v13, 0xffff0000, v173
v_lshlrev_b32 v14, 16, v174
v_and_b32 v15, 0xffff0000, v174
v_lshlrev_b32 v16, 16, v175
v_and_b32 v17, 0xffff0000, v175
v_pk_add_f32 v[96:97], v[96:97], v[10:11]
v_pk_add_f32 v[98:99], v[98:99], v[12:13]
v_pk_add_f32 v[100:101], v[100:101], v[14:15]
v_pk_add_f32 v[102:103], v[102:103], v[16:17]
v_lshlrev_b32 v10, 16, v176
v_and_b32 v11, 0xffff0000, v176
v_lshlrev_b32 v12, 16, v177
v_and_b32 v13, 0xffff0000, v177
v_lshlrev_b32 v14, 16, v178
v_and_b32 v15, 0xffff0000, v178
v_lshlrev_b32 v16, 16, v179
v_and_b32 v17, 0xffff0000, v179
v_pk_add_f32 v[96:97], v[96:97], v[10:11]
v_pk_add_f32 v[98:99], v[98:99], v[12:13]
v_pk_add_f32 v[100:101], v[100:101], v[14:15]
v_pk_add_f32 v[102:103], v[102:103], v[16:17]
v_lshlrev_b32 v10, 16, v180
v_and_b32 v11, 0xffff0000, v180
v_lshlrev_b32 v12, 16, v181
v_and_b32 v13, 0xffff0000, v181
v_lshlrev_b32 v14, 16, v182
v_and_b32 v15, 0xffff0000, v182
v_lshlrev_b32 v16, 16, v183
v_and_b32 v17, 0xffff0000, v183
v_pk_add_f32 v[96:97], v[96:97], v[10:11]
v_pk_add_f32 v[98:99], v[98:99], v[12:13]
v_pk_add_f32 v[100:101], v[100:101], v[14:15]
v_pk_add_f32 v[102:103], v[102:103], v[16:17]
v_lshlrev_b32 v10, 16, v184
v_and_b32 v11, 0xffff0000, v184
v_lshlrev_b32 v12, 16, v185
v_and_b32 v13, 0xffff0000, v185
v_lshlrev_b32 v14, 16, v186
v_and_b32 v15, 0xffff0000, v186
v_lshlrev_b32 v16, 16, v187
v_and_b32 v17, 0xffff0000, v187
v_pk_add_f32 v[96:97], v[96:97], v[10:11]
v_pk_add_f32 v[98:99], v[98:99], v[12:13]
v_pk_add_f32 v[100:101], v[100:101], v[14:15]
v_pk_add_f32 v[102:103], v[102:103], v[16:17]
v_lshlrev_b32 v10, 16, v188
v_and_b32 v11, 0xffff0000, v188
v_lshlrev_b32 v12, 16, v189
v_and_b32 v13, 0xffff0000, v189
v_lshlrev_b32 v14, 16, v190
v_and_b32 v15, 0xffff0000, v190
v_lshlrev_b32 v16, 16, v191
v_and_b32 v17, 0xffff0000, v191
v_pk_add_f32 v[96:97], v[96:97], v[10:11]
v_pk_add_f32 v[98:99], v[98:99], v[12:13]
v_pk_add_f32 v[100:101], v[100:101], v[14:15]
v_pk_add_f32 v[102:103], v[102:103], v[16:17]
v_cvt_pk_bf16_f32 v96, v96, v97
v_cvt_pk_bf16_f32 v97, v98, v99
v_cvt_pk_bf16_f32 v98, v100, v101
v_cvt_pk_bf16_f32 v99, v102, v103
buffer_store_dwordx2 v[96:97], v21, s[40:43], s25 offen offset:896
buffer_store_dwordx2 v[98:99], v21, s[40:43], s25 offen offset:928
s_waitcnt vmcnt(17)
v_lshlrev_b32 v104, 16, v192
v_and_b32 v105, 0xffff0000, v192
v_lshlrev_b32 v106, 16, v193
v_and_b32 v107, 0xffff0000, v193
v_lshlrev_b32 v108, 16, v194
v_and_b32 v109, 0xffff0000, v194
v_lshlrev_b32 v110, 16, v195
v_and_b32 v111, 0xffff0000, v195
s_waitcnt vmcnt(16)
v_lshlrev_b32 v10, 16, v196
v_and_b32 v11, 0xffff0000, v196
v_lshlrev_b32 v12, 16, v197
v_and_b32 v13, 0xffff0000, v197
v_lshlrev_b32 v14, 16, v198
v_and_b32 v15, 0xffff0000, v198
v_lshlrev_b32 v16, 16, v199
v_and_b32 v17, 0xffff0000, v199
v_pk_add_f32 v[104:105], v[104:105], v[10:11]
v_pk_add_f32 v[106:107], v[106:107], v[12:13]
v_pk_add_f32 v[108:109], v[108:109], v[14:15]
v_pk_add_f32 v[110:111], v[110:111], v[16:17]
s_waitcnt vmcnt(15)
v_lshlrev_b32 v10, 16, v200
v_and_b32 v11, 0xffff0000, v200
v_lshlrev_b32 v12, 16, v201
v_and_b32 v13, 0xffff0000, v201
v_lshlrev_b32 v14, 16, v202
v_and_b32 v15, 0xffff0000, v202
v_lshlrev_b32 v16, 16, v203
v_and_b32 v17, 0xffff0000, v203
v_pk_add_f32 v[104:105], v[104:105], v[10:11]
v_pk_add_f32 v[106:107], v[106:107], v[12:13]
v_pk_add_f32 v[108:109], v[108:109], v[14:15]
v_pk_add_f32 v[110:111], v[110:111], v[16:17]
s_waitcnt vmcnt(14)
v_lshlrev_b32 v10, 16, v204
v_and_b32 v11, 0xffff0000, v204
v_lshlrev_b32 v12, 16, v205
v_and_b32 v13, 0xffff0000, v205
v_lshlrev_b32 v14, 16, v206
v_and_b32 v15, 0xffff0000, v206
v_lshlrev_b32 v16, 16, v207
v_and_b32 v17, 0xffff0000, v207
v_pk_add_f32 v[104:105], v[104:105], v[10:11]
v_pk_add_f32 v[106:107], v[106:107], v[12:13]
v_pk_add_f32 v[108:109], v[108:109], v[14:15]
v_pk_add_f32 v[110:111], v[110:111], v[16:17]
s_waitcnt vmcnt(13)
v_lshlrev_b32 v10, 16, v208
v_and_b32 v11, 0xffff0000, v208
v_lshlrev_b32 v12, 16, v209
v_and_b32 v13, 0xffff0000, v209
v_lshlrev_b32 v14, 16, v210
v_and_b32 v15, 0xffff0000, v210
v_lshlrev_b32 v16, 16, v211
v_and_b32 v17, 0xffff0000, v211
v_pk_add_f32 v[104:105], v[104:105], v[10:11]
v_pk_add_f32 v[106:107], v[106:107], v[12:13]
v_pk_add_f32 v[108:109], v[108:109], v[14:15]
v_pk_add_f32 v[110:111], v[110:111], v[16:17]
s_waitcnt vmcnt(12)
v_lshlrev_b32 v10, 16, v212
v_and_b32 v11, 0xffff0000, v212
v_lshlrev_b32 v12, 16, v213
v_and_b32 v13, 0xffff0000, v213
v_lshlrev_b32 v14, 16, v214
v_and_b32 v15, 0xffff0000, v214
v_lshlrev_b32 v16, 16, v215
v_and_b32 v17, 0xffff0000, v215
v_pk_add_f32 v[104:105], v[104:105], v[10:11]
v_pk_add_f32 v[106:107], v[106:107], v[12:13]
v_pk_add_f32 v[108:109], v[108:109], v[14:15]
v_pk_add_f32 v[110:111], v[110:111], v[16:17]
s_waitcnt vmcnt(11)
v_lshlrev_b32 v10, 16, v216
v_and_b32 v11, 0xffff0000, v216
v_lshlrev_b32 v12, 16, v217
v_and_b32 v13, 0xffff0000, v217
v_lshlrev_b32 v14, 16, v218
v_and_b32 v15, 0xffff0000, v218
v_lshlrev_b32 v16, 16, v219
v_and_b32 v17, 0xffff0000, v219
v_pk_add_f32 v[104:105], v[104:105], v[10:11]
v_pk_add_f32 v[106:107], v[106:107], v[12:13]
v_pk_add_f32 v[108:109], v[108:109], v[14:15]
v_pk_add_f32 v[110:111], v[110:111], v[16:17]
s_waitcnt vmcnt(10)
v_lshlrev_b32 v10, 16, v220
v_and_b32 v11, 0xffff0000, v220
v_lshlrev_b32 v12, 16, v221
v_and_b32 v13, 0xffff0000, v221
v_lshlrev_b32 v14, 16, v222
v_and_b32 v15, 0xffff0000, v222
v_lshlrev_b32 v16, 16, v223
v_and_b32 v17, 0xffff0000, v223
v_pk_add_f32 v[104:105], v[104:105], v[10:11]
v_pk_add_f32 v[106:107], v[106:107], v[12:13]
v_pk_add_f32 v[108:109], v[108:109], v[14:15]
v_pk_add_f32 v[110:111], v[110:111], v[16:17]
s_waitcnt vmcnt(9)
v_lshlrev_b32 v10, 16, v224
v_and_b32 v11, 0xffff0000, v224
v_lshlrev_b32 v12, 16, v225
v_and_b32 v13, 0xffff0000, v225
v_lshlrev_b32 v14, 16, v226
v_and_b32 v15, 0xffff0000, v226
v_lshlrev_b32 v16, 16, v227
v_and_b32 v17, 0xffff0000, v227
v_pk_add_f32 v[104:105], v[104:105], v[10:11]
v_pk_add_f32 v[106:107], v[106:107], v[12:13]
v_pk_add_f32 v[108:109], v[108:109], v[14:15]
v_pk_add_f32 v[110:111], v[110:111], v[16:17]
s_waitcnt vmcnt(8)
v_lshlrev_b32 v10, 16, v228
v_and_b32 v11, 0xffff0000, v228
v_lshlrev_b32 v12, 16, v229
v_and_b32 v13, 0xffff0000, v229
v_lshlrev_b32 v14, 16, v230
v_and_b32 v15, 0xffff0000, v230
v_lshlrev_b32 v16, 16, v231
v_and_b32 v17, 0xffff0000, v231
v_pk_add_f32 v[104:105], v[104:105], v[10:11]
v_pk_add_f32 v[106:107], v[106:107], v[12:13]
v_pk_add_f32 v[108:109], v[108:109], v[14:15]
v_pk_add_f32 v[110:111], v[110:111], v[16:17]
s_waitcnt vmcnt(7)
v_lshlrev_b32 v10, 16, v232
v_and_b32 v11, 0xffff0000, v232
v_lshlrev_b32 v12, 16, v233
v_and_b32 v13, 0xffff0000, v233
v_lshlrev_b32 v14, 16, v234
v_and_b32 v15, 0xffff0000, v234
v_lshlrev_b32 v16, 16, v235
v_and_b32 v17, 0xffff0000, v235
v_pk_add_f32 v[104:105], v[104:105], v[10:11]
v_pk_add_f32 v[106:107], v[106:107], v[12:13]
v_pk_add_f32 v[108:109], v[108:109], v[14:15]
v_pk_add_f32 v[110:111], v[110:111], v[16:17]
s_waitcnt vmcnt(6)
v_lshlrev_b32 v10, 16, v236
v_and_b32 v11, 0xffff0000, v236
v_lshlrev_b32 v12, 16, v237
v_and_b32 v13, 0xffff0000, v237
v_lshlrev_b32 v14, 16, v238
v_and_b32 v15, 0xffff0000, v238
v_lshlrev_b32 v16, 16, v239
v_and_b32 v17, 0xffff0000, v239
v_pk_add_f32 v[104:105], v[104:105], v[10:11]
v_pk_add_f32 v[106:107], v[106:107], v[12:13]
v_pk_add_f32 v[108:109], v[108:109], v[14:15]
v_pk_add_f32 v[110:111], v[110:111], v[16:17]
s_waitcnt vmcnt(5)
v_lshlrev_b32 v10, 16, v240
v_and_b32 v11, 0xffff0000, v240
v_lshlrev_b32 v12, 16, v241
v_and_b32 v13, 0xffff0000, v241
v_lshlrev_b32 v14, 16, v242
v_and_b32 v15, 0xffff0000, v242
v_lshlrev_b32 v16, 16, v243
v_and_b32 v17, 0xffff0000, v243
v_pk_add_f32 v[104:105], v[104:105], v[10:11]
v_pk_add_f32 v[106:107], v[106:107], v[12:13]
v_pk_add_f32 v[108:109], v[108:109], v[14:15]
v_pk_add_f32 v[110:111], v[110:111], v[16:17]
s_waitcnt vmcnt(4)
v_lshlrev_b32 v10, 16, v244
v_and_b32 v11, 0xffff0000, v244
v_lshlrev_b32 v12, 16, v245
v_and_b32 v13, 0xffff0000, v245
v_lshlrev_b32 v14, 16, v246
v_and_b32 v15, 0xffff0000, v246
v_lshlrev_b32 v16, 16, v247
v_and_b32 v17, 0xffff0000, v247
v_pk_add_f32 v[104:105], v[104:105], v[10:11]
v_pk_add_f32 v[106:107], v[106:107], v[12:13]
v_pk_add_f32 v[108:109], v[108:109], v[14:15]
v_pk_add_f32 v[110:111], v[110:111], v[16:17]
s_waitcnt vmcnt(3)
v_lshlrev_b32 v10, 16, v248
v_and_b32 v11, 0xffff0000, v248
v_lshlrev_b32 v12, 16, v249
v_and_b32 v13, 0xffff0000, v249
v_lshlrev_b32 v14, 16, v250
v_and_b32 v15, 0xffff0000, v250
v_lshlrev_b32 v16, 16, v251
v_and_b32 v17, 0xffff0000, v251
v_pk_add_f32 v[104:105], v[104:105], v[10:11]
v_pk_add_f32 v[106:107], v[106:107], v[12:13]
v_pk_add_f32 v[108:109], v[108:109], v[14:15]
v_pk_add_f32 v[110:111], v[110:111], v[16:17]
s_waitcnt vmcnt(2)
v_lshlrev_b32 v10, 16, v252
v_and_b32 v11, 0xffff0000, v252
v_lshlrev_b32 v12, 16, v253
v_and_b32 v13, 0xffff0000, v253
v_lshlrev_b32 v14, 16, v254
v_and_b32 v15, 0xffff0000, v254
v_lshlrev_b32 v16, 16, v255
v_and_b32 v17, 0xffff0000, v255
v_pk_add_f32 v[104:105], v[104:105], v[10:11]
v_pk_add_f32 v[106:107], v[106:107], v[12:13]
v_pk_add_f32 v[108:109], v[108:109], v[14:15]
v_pk_add_f32 v[110:111], v[110:111], v[16:17]
v_cvt_pk_bf16_f32 v104, v104, v105
v_cvt_pk_bf16_f32 v105, v106, v107
v_cvt_pk_bf16_f32 v106, v108, v109
v_cvt_pk_bf16_f32 v107, v110, v111
buffer_store_dwordx2 v[104:105], v21, s[40:43], s25 offen offset:1344
buffer_store_dwordx2 v[106:107], v21, s[40:43], s25 offen offset:1376
M_fin:
s_endpgm
M_final:
s_mov_b32 s8, s64
s_mov_b32 s9, s65
s_mov_b32 s10, 1835008
s_mov_b32 s11, 0x20000
s_mov_b32 s12, s88
s_mov_b32 s13, s89
s_mov_b32 s14, 3670016
s_mov_b32 s15, 0x20000
s_and_b32 s24, s2, 16
s_add_u32 s24, s24, s20
v_lshrrev_b32 v20, 4, v1
v_and_b32 v21, 15, v20
v_lshrrev_b32 v22, 4, v20
v_mul_u32_u24 v2, 896, v21
v_lshlrev_b32 v9, 1, v2
v_lshl_add_u32 v2, v22, 4, v2
v_lshl_add_u32 v9, v22, 4, v9
s_lshl_b32 s22, s24, 2
s_add_u32 s22, s22, s3
s_mul_i32 s25, s22, 14336
s_lshl_b32 s26, s25, 1
v_lshlrev_b32 v10, 5, v22
v_add3_u32 v10, v10, v21, 16
v_lshlrev_b32 v10, 2, v10
v_min_u32 v11, 380, v10
v_add_u32 v11, 512, v11
s_mov_b32 s27, 94384128
Lfp:
buffer_load_dword v3, v10, s[4:7], s27 offen sc1
buffer_load_dword v4, v11, s[4:7], s27 offen sc1
s_waitcnt vmcnt(0)
v_and_b32 v3, v3, v4
v_cmp_gt_u32 vcc, 1, v3
s_cbranch_vccz Lfpd
s_sleep 2
s_sub_u32 s101, s101, 1
s_cbranch_scc0 Lfp
s_mov_b32 s101, 0
Lfpd:
s_barrier
buffer_store_dword v6, v5, s[4:7], s35 offen sc1
Lfg:
v_lshrrev_b32 v3, 3, v20
v_and_b32 v4, 7, v20
v_lshlrev_b32 v4, 4, v4
v_lshl_add_u32 v3, v3, 12, v4
s_mul_i32 s27, s3, 458752
s_lshl_b32 s22, s24, 7
s_add_u32 s27, s27, s22
s_add_u32 s27, s27, 88080384
s_mul_i32 s28, s3, 14336
s_add_u32 m0, s28, 0
s_nop 0
buffer_load_dwordx4 v3, s[4:7], s27 offen sc1 lds
s_add_u32 s27, s27, 32768
s_add_u32 m0, s28, 1024
s_nop 0
buffer_load_dwordx4 v3, s[4:7], s27 offen sc1 lds
s_add_u32 s27, s27, 32768
s_add_u32 m0, s28, 2048
s_nop 0
buffer_load_dwordx4 v3, s[4:7], s27 offen sc1 lds
s_add_u32 s27, s27, 32768
s_add_u32 m0, s28, 3072
s_nop 0
buffer_load_dwordx4 v3, s[4:7], s27 offen sc1 lds
s_add_u32 s27, s27, 32768
s_add_u32 m0, s28, 4096
s_nop 0
buffer_load_dwordx4 v3, s[4:7], s27 offen sc1 lds
s_add_u32 s27, s27, 32768
s_add_u32 m0, s28, 5120
s_nop 0
buffer_load_dwordx4 v3, s[4:7], s27 offen sc1 lds
s_add_u32 s27, s27, 32768
s_add_u32 m0, s28, 6144
s_nop 0
buffer_load_dwordx4 v3, s[4:7], s27 offen sc1 lds
s_add_u32 s27, s27, 32768
s_add_u32 m0, s28, 7168
s_nop 0
buffer_load_dwordx4 v3, s[4:7], s27 offen sc1 lds
s_add_u32 s27, s27, 32768
s_add_u32 m0, s28, 8192
s_nop 0
buffer_load_dwordx4 v3, s[4:7], s27 offen sc1 lds
s_add_u32 s27, s27, 32768
s_add_u32 m0, s28, 9216
s_nop 0
buffer_load_dwordx4 v3, s[4:7], s27 offen sc1 lds
s_add_u32 s27, s27, 32768
s_add_u32 m0, s28, 10240
s_nop 0
buffer_load_dwordx4 v3, s[4:7], s27 offen sc1 lds
s_add_u32 s27, s27, 32768
s_add_u32 m0, s28, 11264
s_nop 0
buffer_load_dwordx4 v3, s[4:7], s27 offen sc1 lds
s_add_u32 s27, s27, 32768
s_add_u32 m0, s28, 12288
s_nop 0
buffer_load_dwordx4 v3, s[4:7], s27 offen sc1 lds
s_add_u32 s27, s27, 32768
s_add_u32 m0, s28, 13312
s_nop 0
buffer_load_dwordx4 v3, s[4:7], s27 offen sc1 lds
s_add_u32 s27, s27, 32768
buffer_load_dwordx4 v[160:163], v2, s[8:11], s25 offen offset:0
buffer_load_dwordx4 v[164:167], v2, s[8:11], s25 offen offset:64
buffer_load_dwordx4 v[168:171], v2, s[8:11], s25 offen offset:128
buffer_load_dwordx4 v[172:175], v2, s[8:11], s25 offen offset:192
buffer_load_dwordx4 v[176:179], v2, s[8:11], s25 offen offset:256
buffer_load_dwordx4 v[180:183], v2, s[8:11], s25 offen offset:320
buffer_load_dwordx4 v[184:187], v2, s[8:11], s25 offen offset:384
buffer_load_dwordx4 v[188:191], v2, s[8:11], s25 offen offset:448
buffer_load_dwordx4 v[192:195], v2, s[8:11], s25 offen offset:512
buffer_load_dwordx4 v[196:199], v2, s[8:11], s25 offen offset:576
buffer_load_dwordx4 v[200:203], v2, s[8:11], s25 offen offset:640
buffer_load_dwordx4 v[204:207], v2, s[8:11], s25 offen offset:704
buffer_load_dwordx4 v[208:211], v2, s[8:11], s25 offen offset:768
buffer_load_dwordx4 v[212:215], v2, s[8:11], s25 offen offset:832
v_lshrrev_b32 v3, 2, v21
v_lshl_add_u32 v3, v22, 3, v3
v_lshlrev_b32 v3, 7, v3
v_and_b32 v4, 3, v20
v_lshl_add_u32 v3, v4, 3, v3
s_lshl_b32 s22, s3, 5
v_add_u32 v3, s22, v3
s_waitcnt vmcnt(14)
s_barrier
ds_read_b64_tr_b16 v[96:97], v3 offset:0
ds_read_b64_tr_b16 v[98:99], v3 offset:512
ds_read_b64_tr_b16 v[100:101], v3 offset:4096
ds_read_b64_tr_b16 v[102:103], v3 offset:4608
ds_read_b64_tr_b16 v[104:105], v3 offset:8192
ds_read_b64_tr_b16 v[106:107], v3 offset:8704
ds_read_b64_tr_b16 v[108:109], v3 offset:12288
ds_read_b64_tr_b16 v[110:111], v3 offset:12800
ds_read_b64_tr_b16 v[112:113], v3 offset:16384
ds_read_b64_tr_b16 v[114:115], v3 offset:16896
ds_read_b64_tr_b16 v[116:117], v3 offset:20480
ds_read_b64_tr_b16 v[118:119], v3 offset:20992
ds_read_b64_tr_b16 v[120:121], v3 offset:24576
ds_read_b64_tr_b16 v[122:123], v3 offset:25088
s_waitcnt lgkmcnt(0)
ds_read_b64_tr_b16 v[124:125], v3 offset:28672
ds_read_b64_tr_b16 v[126:127], v3 offset:29184
ds_read_b64_tr_b16 v[128:129], v3 offset:32768
ds_read_b64_tr_b16 v[130:131], v3 offset:33280
ds_read_b64_tr_b16 v[132:133], v3 offset:36864
ds_read_b64_tr_b16 v[134:135], v3 offset:37376
ds_read_b64_tr_b16 v[136:137], v3 offset:40960
ds_read_b64_tr_b16 v[138:139], v3 offset:41472
ds_read_b64_tr_b16 v[140:141], v3 offset:45056
ds_read_b64_tr_b16 v[142:143], v3 offset:45568
ds_read_b64_tr_b16 v[144:145], v3 offset:49152
ds_read_b64_tr_b16 v[146:147], v3 offset:49664
ds_read_b64_tr_b16 v[148:149], v3 offset:53248
ds_read_b64_tr_b16 v[150:151], v3 offset:53760
s_waitcnt vmcnt(13)
v_lshlrev_b32 v10, 16, v160
v_and_b32 v11, 0xffff0000, v160
v_lshlrev_b32 v12, 16, v96
v_and_b32 v13, 0xffff0000, v96
v_pk_mul_f32 v[10:11], v[10:11], v[12:13]
v_cvt_pk_bf16_f32 v160, v10, v11
v_lshlrev_b32 v10, 16, v161
v_and_b32 v11, 0xffff0000, v161
v_lshlrev_b32 v12, 16, v97
v_and_b32 v13, 0xffff0000, v97
v_pk_mul_f32 v[10:11], v[10:11], v[12:13]
v_cvt_pk_bf16_f32 v161, v10, v11
v_lshlrev_b32 v10, 16, v162
v_and_b32 v11, 0xffff0000, v162
v_lshlrev_b32 v12, 16, v98
v_and_b32 v13, 0xffff0000, v98
v_pk_mul_f32 v[10:11], v[10:11], v[12:13]
v_cvt_pk_bf16_f32 v162, v10, v11
v_lshlrev_b32 v10, 16, v163
v_and_b32 v11, 0xffff0000, v163
v_lshlrev_b32 v12, 16, v99
v_and_b32 v13, 0xffff0000, v99
v_pk_mul_f32 v[10:11], v[10:11], v[12:13]
v_cvt_pk_bf16_f32 v163, v10, v11
buffer_store_dwordx4 v[160:163], v9, s[12:15], s26 offen offset:0
s_waitcnt vmcnt(13)
v_lshlrev_b32 v10, 16, v164
v_and_b32 v11, 0xffff0000, v164
v_lshlrev_b32 v12, 16, v100
v_and_b32 v13, 0xffff0000, v100
v_pk_mul_f32 v[10:11], v[10:11], v[12:13]
v_cvt_pk_bf16_f32 v164, v10, v11
v_lshlrev_b32 v10, 16, v165
v_and_b32 v11, 0xffff0000, v165
v_lshlrev_b32 v12, 16, v101
v_and_b32 v13, 0xffff0000, v101
v_pk_mul_f32 v[10:11], v[10:11], v[12:13]
v_cvt_pk_bf16_f32 v165, v10, v11
v_lshlrev_b32 v10, 16, v166
v_and_b32 v11, 0xffff0000, v166
v_lshlrev_b32 v12, 16, v102
v_and_b32 v13, 0xffff0000, v102
v_pk_mul_f32 v[10:11], v[10:11], v[12:13]
v_cvt_pk_bf16_f32 v166, v10, v11
v_lshlrev_b32 v10, 16, v167
v_and_b32 v11, 0xffff0000, v167
v_lshlrev_b32 v12, 16, v103
v_and_b32 v13, 0xffff0000, v103
v_pk_mul_f32 v[10:11], v[10:11], v[12:13]
v_cvt_pk_bf16_f32 v167, v10, v11
buffer_store_dwordx4 v[164:167], v9, s[12:15], s26 offen offset:64
s_waitcnt vmcnt(13)
v_lshlrev_b32 v10, 16, v168
v_and_b32 v11, 0xffff0000, v168
v_lshlrev_b32 v12, 16, v104
v_and_b32 v13, 0xffff0000, v104
v_pk_mul_f32 v[10:11], v[10:11], v[12:13]
v_cvt_pk_bf16_f32 v168, v10, v11
v_lshlrev_b32 v10, 16, v169
v_and_b32 v11, 0xffff0000, v169
v_lshlrev_b32 v12, 16, v105
v_and_b32 v13, 0xffff0000, v105
v_pk_mul_f32 v[10:11], v[10:11], v[12:13]
v_cvt_pk_bf16_f32 v169, v10, v11
v_lshlrev_b32 v10, 16, v170
v_and_b32 v11, 0xffff0000, v170
v_lshlrev_b32 v12, 16, v106
v_and_b32 v13, 0xffff0000, v106
v_pk_mul_f32 v[10:11], v[10:11], v[12:13]
v_cvt_pk_bf16_f32 v170, v10, v11
v_lshlrev_b32 v10, 16, v171
v_and_b32 v11, 0xffff0000, v171
v_lshlrev_b32 v12, 16, v107
v_and_b32 v13, 0xffff0000, v107
v_pk_mul_f32 v[10:11], v[10:11], v[12:13]
v_cvt_pk_bf16_f32 v171, v10, v11
buffer_store_dwordx4 v[168:171], v9, s[12:15], s26 offen offset:128
s_waitcnt vmcnt(13)
v_lshlrev_b32 v10, 16, v172
v_and_b32 v11, 0xffff0000, v172
v_lshlrev_b32 v12, 16, v108
v_and_b32 v13, 0xffff0000, v108
v_pk_mul_f32 v[10:11], v[10:11], v[12:13]
v_cvt_pk_bf16_f32 v172, v10, v11
v_lshlrev_b32 v10, 16, v173
v_and_b32 v11, 0xffff0000, v173
v_lshlrev_b32 v12, 16, v109
v_and_b32 v13, 0xffff0000, v109
v_pk_mul_f32 v[10:11], v[10:11], v[12:13]
v_cvt_pk_bf16_f32 v173, v10, v11
v_lshlrev_b32 v10, 16, v174
v_and_b32 v11, 0xffff0000, v174
v_lshlrev_b32 v12, 16, v110
v_and_b32 v13, 0xffff0000, v110
v_pk_mul_f32 v[10:11], v[10:11], v[12:13]
v_cvt_pk_bf16_f32 v174, v10, v11
v_lshlrev_b32 v10, 16, v175
v_and_b32 v11, 0xffff0000, v175
v_lshlrev_b32 v12, 16, v111
v_and_b32 v13, 0xffff0000, v111
v_pk_mul_f32 v[10:11], v[10:11], v[12:13]
v_cvt_pk_bf16_f32 v175, v10, v11
buffer_store_dwordx4 v[172:175], v9, s[12:15], s26 offen offset:192
s_waitcnt vmcnt(13)
v_lshlrev_b32 v10, 16, v176
v_and_b32 v11, 0xffff0000, v176
v_lshlrev_b32 v12, 16, v112
v_and_b32 v13, 0xffff0000, v112
v_pk_mul_f32 v[10:11], v[10:11], v[12:13]
v_cvt_pk_bf16_f32 v176, v10, v11
v_lshlrev_b32 v10, 16, v177
v_and_b32 v11, 0xffff0000, v177
v_lshlrev_b32 v12, 16, v113
v_and_b32 v13, 0xffff0000, v113
v_pk_mul_f32 v[10:11], v[10:11], v[12:13]
v_cvt_pk_bf16_f32 v177, v10, v11
v_lshlrev_b32 v10, 16, v178
v_and_b32 v11, 0xffff0000, v178
v_lshlrev_b32 v12, 16, v114
v_and_b32 v13, 0xffff0000, v114
v_pk_mul_f32 v[10:11], v[10:11], v[12:13]
v_cvt_pk_bf16_f32 v178, v10, v11
v_lshlrev_b32 v10, 16, v179
v_and_b32 v11, 0xffff0000, v179
v_lshlrev_b32 v12, 16, v115
v_and_b32 v13, 0xffff0000, v115
v_pk_mul_f32 v[10:11], v[10:11], v[12:13]
v_cvt_pk_bf16_f32 v179, v10, v11
buffer_store_dwordx4 v[176:179], v9, s[12:15], s26 offen offset:256
s_waitcnt vmcnt(13)
v_lshlrev_b32 v10, 16, v180
v_and_b32 v11, 0xffff0000, v180
v_lshlrev_b32 v12, 16, v116
v_and_b32 v13, 0xffff0000, v116
v_pk_mul_f32 v[10:11], v[10:11], v[12:13]
v_cvt_pk_bf16_f32 v180, v10, v11
v_lshlrev_b32 v10, 16, v181
v_and_b32 v11, 0xffff0000, v181
v_lshlrev_b32 v12, 16, v117
v_and_b32 v13, 0xffff0000, v117
v_pk_mul_f32 v[10:11], v[10:11], v[12:13]
v_cvt_pk_bf16_f32 v181, v10, v11
v_lshlrev_b32 v10, 16, v182
v_and_b32 v11, 0xffff0000, v182
v_lshlrev_b32 v12, 16, v118
v_and_b32 v13, 0xffff0000, v118
v_pk_mul_f32 v[10:11], v[10:11], v[12:13]
v_cvt_pk_bf16_f32 v182, v10, v11
v_lshlrev_b32 v10, 16, v183
v_and_b32 v11, 0xffff0000, v183
v_lshlrev_b32 v12, 16, v119
v_and_b32 v13, 0xffff0000, v119
v_pk_mul_f32 v[10:11], v[10:11], v[12:13]
v_cvt_pk_bf16_f32 v183, v10, v11
buffer_store_dwordx4 v[180:183], v9, s[12:15], s26 offen offset:320
s_waitcnt vmcnt(13)
v_lshlrev_b32 v10, 16, v184
v_and_b32 v11, 0xffff0000, v184
v_lshlrev_b32 v12, 16, v120
v_and_b32 v13, 0xffff0000, v120
v_pk_mul_f32 v[10:11], v[10:11], v[12:13]
v_cvt_pk_bf16_f32 v184, v10, v11
v_lshlrev_b32 v10, 16, v185
v_and_b32 v11, 0xffff0000, v185
v_lshlrev_b32 v12, 16, v121
v_and_b32 v13, 0xffff0000, v121
v_pk_mul_f32 v[10:11], v[10:11], v[12:13]
v_cvt_pk_bf16_f32 v185, v10, v11
v_lshlrev_b32 v10, 16, v186
v_and_b32 v11, 0xffff0000, v186
v_lshlrev_b32 v12, 16, v122
v_and_b32 v13, 0xffff0000, v122
v_pk_mul_f32 v[10:11], v[10:11], v[12:13]
v_cvt_pk_bf16_f32 v186, v10, v11
v_lshlrev_b32 v10, 16, v187
v_and_b32 v11, 0xffff0000, v187
v_lshlrev_b32 v12, 16, v123
v_and_b32 v13, 0xffff0000, v123
v_pk_mul_f32 v[10:11], v[10:11], v[12:13]
v_cvt_pk_bf16_f32 v187, v10, v11
buffer_store_dwordx4 v[184:187], v9, s[12:15], s26 offen offset:384
s_waitcnt lgkmcnt(0)
s_waitcnt vmcnt(13)
v_lshlrev_b32 v10, 16, v188
v_and_b32 v11, 0xffff0000, v188
v_lshlrev_b32 v12, 16, v124
v_and_b32 v13, 0xffff0000, v124
v_pk_mul_f32 v[10:11], v[10:11], v[12:13]
v_cvt_pk_bf16_f32 v188, v10, v11
v_lshlrev_b32 v10, 16, v189
v_and_b32 v11, 0xffff0000, v189
v_lshlrev_b32 v12, 16, v125
v_and_b32 v13, 0xffff0000, v125
v_pk_mul_f32 v[10:11], v[10:11], v[12:13]
v_cvt_pk_bf16_f32 v189, v10, v11
v_lshlrev_b32 v10, 16, v190
v_and_b32 v11, 0xffff0000, v190
v_lshlrev_b32 v12, 16, v126
v_and_b32 v13, 0xffff0000, v126
v_pk_mul_f32 v[10:11], v[10:11], v[12:13]
v_cvt_pk_bf16_f32 v190, v10, v11
v_lshlrev_b32 v10, 16, v191
v_and_b32 v11, 0xffff0000, v191
v_lshlrev_b32 v12, 16, v127
v_and_b32 v13, 0xffff0000, v127
v_pk_mul_f32 v[10:11], v[10:11], v[12:13]
v_cvt_pk_bf16_f32 v191, v10, v11
buffer_store_dwordx4 v[188:191], v9, s[12:15], s26 offen offset:448
s_waitcnt vmcnt(13)
v_lshlrev_b32 v10, 16, v192
v_and_b32 v11, 0xffff0000, v192
v_lshlrev_b32 v12, 16, v128
v_and_b32 v13, 0xffff0000, v128
v_pk_mul_f32 v[10:11], v[10:11], v[12:13]
v_cvt_pk_bf16_f32 v192, v10, v11
v_lshlrev_b32 v10, 16, v193
v_and_b32 v11, 0xffff0000, v193
v_lshlrev_b32 v12, 16, v129
v_and_b32 v13, 0xffff0000, v129
v_pk_mul_f32 v[10:11], v[10:11], v[12:13]
v_cvt_pk_bf16_f32 v193, v10, v11
v_lshlrev_b32 v10, 16, v194
v_and_b32 v11, 0xffff0000, v194
v_lshlrev_b32 v12, 16, v130
v_and_b32 v13, 0xffff0000, v130
v_pk_mul_f32 v[10:11], v[10:11], v[12:13]
v_cvt_pk_bf16_f32 v194, v10, v11
v_lshlrev_b32 v10, 16, v195
v_and_b32 v11, 0xffff0000, v195
v_lshlrev_b32 v12, 16, v131
v_and_b32 v13, 0xffff0000, v131
v_pk_mul_f32 v[10:11], v[10:11], v[12:13]
v_cvt_pk_bf16_f32 v195, v10, v11
buffer_store_dwordx4 v[192:195], v9, s[12:15], s26 offen offset:512
s_waitcnt vmcnt(13)
v_lshlrev_b32 v10, 16, v196
v_and_b32 v11, 0xffff0000, v196
v_lshlrev_b32 v12, 16, v132
v_and_b32 v13, 0xffff0000, v132
v_pk_mul_f32 v[10:11], v[10:11], v[12:13]
v_cvt_pk_bf16_f32 v196, v10, v11
v_lshlrev_b32 v10, 16, v197
v_and_b32 v11, 0xffff0000, v197
v_lshlrev_b32 v12, 16, v133
v_and_b32 v13, 0xffff0000, v133
v_pk_mul_f32 v[10:11], v[10:11], v[12:13]
v_cvt_pk_bf16_f32 v197, v10, v11
v_lshlrev_b32 v10, 16, v198
v_and_b32 v11, 0xffff0000, v198
v_lshlrev_b32 v12, 16, v134
v_and_b32 v13, 0xffff0000, v134
v_pk_mul_f32 v[10:11], v[10:11], v[12:13]
v_cvt_pk_bf16_f32 v198, v10, v11
v_lshlrev_b32 v10, 16, v199
v_and_b32 v11, 0xffff0000, v199
v_lshlrev_b32 v12, 16, v135
v_and_b32 v13, 0xffff0000, v135
v_pk_mul_f32 v[10:11], v[10:11], v[12:13]
v_cvt_pk_bf16_f32 v199, v10, v11
buffer_store_dwordx4 v[196:199], v9, s[12:15], s26 offen offset:576
s_waitcnt vmcnt(13)
v_lshlrev_b32 v10, 16, v200
v_and_b32 v11, 0xffff0000, v200
v_lshlrev_b32 v12, 16, v136
v_and_b32 v13, 0xffff0000, v136
v_pk_mul_f32 v[10:11], v[10:11], v[12:13]
v_cvt_pk_bf16_f32 v200, v10, v11
v_lshlrev_b32 v10, 16, v201
v_and_b32 v11, 0xffff0000, v201
v_lshlrev_b32 v12, 16, v137
v_and_b32 v13, 0xffff0000, v137
v_pk_mul_f32 v[10:11], v[10:11], v[12:13]
v_cvt_pk_bf16_f32 v201, v10, v11
v_lshlrev_b32 v10, 16, v202
v_and_b32 v11, 0xffff0000, v202
v_lshlrev_b32 v12, 16, v138
v_and_b32 v13, 0xffff0000, v138
v_pk_mul_f32 v[10:11], v[10:11], v[12:13]
v_cvt_pk_bf16_f32 v202, v10, v11
v_lshlrev_b32 v10, 16, v203
v_and_b32 v11, 0xffff0000, v203
v_lshlrev_b32 v12, 16, v139
v_and_b32 v13, 0xffff0000, v139
v_pk_mul_f32 v[10:11], v[10:11], v[12:13]
v_cvt_pk_bf16_f32 v203, v10, v11
buffer_store_dwordx4 v[200:203], v9, s[12:15], s26 offen offset:640
s_waitcnt vmcnt(13)
v_lshlrev_b32 v10, 16, v204
v_and_b32 v11, 0xffff0000, v204
v_lshlrev_b32 v12, 16, v140
v_and_b32 v13, 0xffff0000, v140
v_pk_mul_f32 v[10:11], v[10:11], v[12:13]
v_cvt_pk_bf16_f32 v204, v10, v11
v_lshlrev_b32 v10, 16, v205
v_and_b32 v11, 0xffff0000, v205
v_lshlrev_b32 v12, 16, v141
v_and_b32 v13, 0xffff0000, v141
v_pk_mul_f32 v[10:11], v[10:11], v[12:13]
v_cvt_pk_bf16_f32 v205, v10, v11
v_lshlrev_b32 v10, 16, v206
v_and_b32 v11, 0xffff0000, v206
v_lshlrev_b32 v12, 16, v142
v_and_b32 v13, 0xffff0000, v142
v_pk_mul_f32 v[10:11], v[10:11], v[12:13]
v_cvt_pk_bf16_f32 v206, v10, v11
v_lshlrev_b32 v10, 16, v207
v_and_b32 v11, 0xffff0000, v207
v_lshlrev_b32 v12, 16, v143
v_and_b32 v13, 0xffff0000, v143
v_pk_mul_f32 v[10:11], v[10:11], v[12:13]
v_cvt_pk_bf16_f32 v207, v10, v11
buffer_store_dwordx4 v[204:207], v9, s[12:15], s26 offen offset:704
s_waitcnt vmcnt(13)
v_lshlrev_b32 v10, 16, v208
v_and_b32 v11, 0xffff0000, v208
v_lshlrev_b32 v12, 16, v144
v_and_b32 v13, 0xffff0000, v144
v_pk_mul_f32 v[10:11], v[10:11], v[12:13]
v_cvt_pk_bf16_f32 v208, v10, v11
v_lshlrev_b32 v10, 16, v209
v_and_b32 v11, 0xffff0000, v209
v_lshlrev_b32 v12, 16, v145
v_and_b32 v13, 0xffff0000, v145
v_pk_mul_f32 v[10:11], v[10:11], v[12:13]
v_cvt_pk_bf16_f32 v209, v10, v11
v_lshlrev_b32 v10, 16, v210
v_and_b32 v11, 0xffff0000, v210
v_lshlrev_b32 v12, 16, v146
v_and_b32 v13, 0xffff0000, v146
v_pk_mul_f32 v[10:11], v[10:11], v[12:13]
v_cvt_pk_bf16_f32 v210, v10, v11
v_lshlrev_b32 v10, 16, v211
v_and_b32 v11, 0xffff0000, v211
v_lshlrev_b32 v12, 16, v147
v_and_b32 v13, 0xffff0000, v147
v_pk_mul_f32 v[10:11], v[10:11], v[12:13]
v_cvt_pk_bf16_f32 v211, v10, v11
buffer_store_dwordx4 v[208:211], v9, s[12:15], s26 offen offset:768
s_waitcnt vmcnt(13)
v_lshlrev_b32 v10, 16, v212
v_and_b32 v11, 0xffff0000, v212
v_lshlrev_b32 v12, 16, v148
v_and_b32 v13, 0xffff0000, v148
v_pk_mul_f32 v[10:11], v[10:11], v[12:13]
v_cvt_pk_bf16_f32 v212, v10, v11
v_lshlrev_b32 v10, 16, v213
v_and_b32 v11, 0xffff0000, v213
v_lshlrev_b32 v12, 16, v149
v_and_b32 v13, 0xffff0000, v149
v_pk_mul_f32 v[10:11], v[10:11], v[12:13]
v_cvt_pk_bf16_f32 v213, v10, v11
v_lshlrev_b32 v10, 16, v214
v_and_b32 v11, 0xffff0000, v214
v_lshlrev_b32 v12, 16, v150
v_and_b32 v13, 0xffff0000, v150
v_pk_mul_f32 v[10:11], v[10:11], v[12:13]
v_cvt_pk_bf16_f32 v214, v10, v11
v_lshlrev_b32 v10, 16, v215
v_and_b32 v11, 0xffff0000, v215
v_lshlrev_b32 v12, 16, v151
v_and_b32 v13, 0xffff0000, v151
v_pk_mul_f32 v[10:11], v[10:11], v[12:13]
v_cvt_pk_bf16_f32 v215, v10, v11
buffer_store_dwordx4 v[212:215], v9, s[12:15], s26 offen offset:832
s_branch M_fin
M_rslow:
Lp_9251:
buffer_load_dword v18, v19, s[4:7], s33 offen offset:0 sc1
s_waitcnt vmcnt(0)
v_cmp_gt_u32 vcc, 1, v18
s_cbranch_vccz Lpd_9252
s_sleep 8
s_sub_u32 s101, s101, 1
s_cbranch_scc0 Lp_9251
s_mov_b32 s101, 0
Lpd_9252:
s_branch M_rjoin
M_conv:
v_mfma_f32_16x16x32_bf16 v[36:39], a[128:131], a[0:3], 0
s_waitcnt lgkmcnt(0)
s_add_u32 m0, s29, 114688
ds_read_b64_tr_b16 a[136:137], v23 offset:0
v_mfma_f32_16x16x32_bf16 v[36:39], a[132:135], a[4:7], v[36:39]
buffer_load_dwordx4 v16, s[12:15], s27 offen offset:0 lds
v_mfma_f32_16x16x32_bf16 v[44:47], a[128:131], a[8:11], 0
ds_read_b64_tr_b16 a[138:139], v23 offset:2048
v_mfma_f32_16x16x32_bf16 v[44:47], a[132:135], a[12:15], v[44:47]
ds_read_b128 a[64:67], v2 offset:16384
ds_read_b128 a[68:71], v3 offset:16384
v_mfma_f32_16x16x32_bf16 v[52:55], a[128:131], a[16:19], 0
ds_read_b64_tr_b16 a[140:141], v23 offset:16384
v_mfma_f32_16x16x32_bf16 v[52:55], a[132:135], a[20:23], v[52:55]
buffer_load_dwordx4 v17, s[12:15], s27 offen offset:1024 lds
v_mfma_f32_16x16x32_bf16 v[60:63], a[128:131], a[24:27], 0
ds_read_b64_tr_b16 a[142:143], v23 offset:18432
v_add_u32 v23, 4294901760, v23
v_mfma_f32_16x16x32_bf16 v[60:63], a[132:135], a[28:31], v[60:63]
buffer_store_dwordx4 v[96:99], v1, s[4:7], s31 offen sc1
v_mfma_f32_16x16x32_bf16 v[68:71], a[128:131], a[32:35], 0
s_add_u32 s31, s31, s32
ds_read_b128 a[72:75], v2 offset:18432
v_mfma_f32_16x16x32_bf16 v[68:71], a[132:135], a[36:39], v[68:71]
buffer_load_dwordx4 v18, s[12:15], s27 offen offset:2048 lds
v_mfma_f32_16x16x32_bf16 v[76:79], a[128:131], a[40:43], 0
ds_read_b128 a[76:79], v3 offset:18432
v_mfma_f32_16x16x32_bf16 v[76:79], a[132:135], a[44:47], v[76:79]
ds_read_b128 a[80:83], v2 offset:20480
v_mfma_f32_16x16x32_bf16 v[84:87], a[128:131], a[48:51], 0
ds_read_b128 a[84:87], v3 offset:20480
v_mfma_f32_16x16x32_bf16 v[84:87], a[132:135], a[52:55], v[84:87]
buffer_load_dwordx4 v19, s[12:15], s27 offen offset:3072 lds
v_mfma_f32_16x16x32_bf16 v[92:95], a[128:131], a[56:59], 0
s_add_u32 s27, s27, 524288
ds_read_b128 a[88:91], v2 offset:22528
v_mfma_f32_16x16x32_bf16 v[92:95], a[132:135], a[60:63], v[92:95]
s_waitcnt lgkmcnt(9)
buffer_store_dwordx4 v[104:107], v1, s[4:7], s31 offen sc1
v_mfma_f32_16x16x32_bf16 v[100:103], a[136:139], a[0:3], 0
s_waitcnt lgkmcnt(5)
s_add_u32 m0, s28, 0
ds_read_b64_tr_b16 a[128:129], v24 offset:0
v_mfma_f32_16x16x32_bf16 v[100:103], a[140:143], a[4:7], v[100:103]
s_add_u32 s31, s31, s33
buffer_load_dwordx4 v12, s[8:11], s24 offen offset:0 lds
v_mfma_f32_16x16x32_bf16 v[108:111], a[136:139], a[8:11], 0
ds_read_b64_tr_b16 a[130:131], v24 offset:2048
v_mfma_f32_16x16x32_bf16 v[108:111], a[140:143], a[12:15], v[108:111]
ds_read_b128 a[92:95], v3 offset:22528
v_mfma_f32_16x16x32_bf16 v[116:119], a[136:139], a[16:19], 0
ds_read_b64_tr_b16 a[132:133], v24 offset:16384
v_mfma_f32_16x16x32_bf16 v[116:119], a[140:143], a[20:23], v[116:119]
buffer_load_dwordx4 v13, s[8:11], s24 offen offset:1024 lds
v_mfma_f32_16x16x32_bf16 v[124:127], a[136:139], a[24:27], 0
ds_read_b64_tr_b16 a[134:135], v24 offset:18432
v_add_u32 v24, 4294901760, v24
v_mfma_f32_16x16x32_bf16 v[124:127], a[140:143], a[28:31], v[124:127]
v_mfma_f32_16x16x32_bf16 v[132:135], a[136:139], a[32:35], 0
ds_read_b128 a[96:99], v2 offset:24576
v_mfma_f32_16x16x32_bf16 v[132:135], a[140:143], a[36:39], v[132:135]
buffer_load_dwordx4 v14, s[8:11], s24 offen offset:2048 lds
v_mfma_f32_16x16x32_bf16 v[140:143], a[136:139], a[40:43], 0
ds_read_b128 a[100:103], v3 offset:24576
v_mfma_f32_16x16x32_bf16 v[140:143], a[140:143], a[44:47], v[140:143]
ds_read_b128 a[104:107], v2 offset:26624
v_mfma_f32_16x16x32_bf16 v[148:151], a[136:139], a[48:51], 0
ds_read_b128 a[108:111], v3 offset:26624
v_mfma_f32_16x16x32_bf16 v[148:151], a[140:143], a[52:55], v[148:151]
buffer_load_dwordx4 v15, s[8:11], s24 offen offset:3072 lds
v_mfma_f32_16x16x32_bf16 v[156:159], a[136:139], a[56:59], 0
s_add_u32 s24, s24, 128
ds_read_b128 a[112:115], v2 offset:28672
v_mfma_f32_16x16x32_bf16 v[156:159], a[140:143], a[60:63], v[156:159]
s_waitcnt lgkmcnt(8)
buffer_store_dwordx4 v[112:115], v1, s[4:7], s31 offen sc1
v_mfma_f32_16x16x32_bf16 v[164:167], a[128:131], a[0:3], 0
s_waitcnt lgkmcnt(5)
s_add_u32 s31, s31, s32
ds_read_b64_tr_b16 a[136:137], v25 offset:0
v_mfma_f32_16x16x32_bf16 v[164:167], a[132:135], a[4:7], v[164:167]
v_mfma_f32_16x16x32_bf16 v[172:175], a[128:131], a[8:11], 0
ds_read_b64_tr_b16 a[138:139], v25 offset:2048
v_mfma_f32_16x16x32_bf16 v[172:175], a[132:135], a[12:15], v[172:175]
ds_read_b128 a[116:119], v3 offset:28672
v_mfma_f32_16x16x32_bf16 v[180:183], a[128:131], a[16:19], 0
ds_read_b64_tr_b16 a[140:141], v25 offset:16384
v_mfma_f32_16x16x32_bf16 v[180:183], a[132:135], a[20:23], v[180:183]
v_mfma_f32_16x16x32_bf16 v[188:191], a[128:131], a[24:27], 0
ds_read_b64_tr_b16 a[142:143], v25 offset:18432
v_add_u32 v25, 4294901760, v25
v_mfma_f32_16x16x32_bf16 v[188:191], a[132:135], a[28:31], v[188:191]
v_mfma_f32_16x16x32_bf16 v[196:199], a[128:131], a[32:35], 0
ds_read_b128 a[120:123], v2 offset:30720
v_mfma_f32_16x16x32_bf16 v[196:199], a[132:135], a[36:39], v[196:199]
v_mfma_f32_16x16x32_bf16 v[204:207], a[128:131], a[40:43], 0
ds_read_b128 a[124:127], v3 offset:30720
v_mfma_f32_16x16x32_bf16 v[204:207], a[132:135], a[44:47], v[204:207]
v_mfma_f32_16x16x32_bf16 v[212:215], a[128:131], a[48:51], 0
v_mfma_f32_16x16x32_bf16 v[212:215], a[132:135], a[52:55], v[212:215]
buffer_store_dwordx4 v[120:123], v1, s[4:7], s31 offen sc1
v_mfma_f32_16x16x32_bf16 v[220:223], a[128:131], a[56:59], 0
s_add_u32 s31, s31, s34
v_mfma_f32_16x16x32_bf16 v[220:223], a[132:135], a[60:63], v[220:223]
s_waitcnt vmcnt(28) lgkmcnt(0)
s_barrier
v_mfma_f32_16x16x32_bf16 v[224:227], a[136:139], a[0:3], 0
s_add_u32 m0, s29, 131072
ds_read_b64_tr_b16 a[128:129], v22 offset:0
v_mfma_f32_16x16x32_bf16 v[224:227], a[140:143], a[4:7], v[224:227]
buffer_load_dwordx4 v16, s[12:15], s26 offen offset:0 lds
v_mfma_f32_16x16x32_bf16 v[228:231], a[136:139], a[8:11], 0
ds_read_b64_tr_b16 a[130:131], v22 offset:2048
v_mfma_f32_16x16x32_bf16 v[228:231], a[140:143], a[12:15], v[228:231]
v_mfma_f32_16x16x32_bf16 v[232:235], a[136:139], a[16:19], 0
ds_read_b64_tr_b16 a[132:133], v22 offset:16384
v_mfma_f32_16x16x32_bf16 v[232:235], a[140:143], a[20:23], v[232:235]
buffer_load_dwordx4 v17, s[12:15], s26 offen offset:1024 lds
v_mfma_f32_16x16x32_bf16 v[236:239], a[136:139], a[24:27], 0
ds_read_b64_tr_b16 a[134:135], v22 offset:18432
v_add_u32 v22, 32768, v22
v_mfma_f32_16x16x32_bf16 v[236:239], a[140:143], a[28:31], v[236:239]
v_mfma_f32_16x16x32_bf16 v[240:243], a[136:139], a[32:35], 0
v_mfma_f32_16x16x32_bf16 v[240:243], a[140:143], a[36:39], v[240:243]
buffer_load_dwordx4 v18, s[12:15], s26 offen offset:2048 lds
v_mfma_f32_16x16x32_bf16 v[244:247], a[136:139], a[40:43], 0
v_mfma_f32_16x16x32_bf16 v[244:247], a[140:143], a[44:47], v[244:247]
v_mfma_f32_16x16x32_bf16 v[248:251], a[136:139], a[48:51], 0
v_mfma_f32_16x16x32_bf16 v[248:251], a[140:143], a[52:55], v[248:251]
buffer_load_dwordx4 v19, s[12:15], s26 offen offset:3072 lds
v_mfma_f32_16x16x32_bf16 v[252:255], a[136:139], a[56:59], 0
s_add_u32 s26, s26, 524288
v_mfma_f32_16x16x32_bf16 v[252:255], a[140:143], a[60:63], v[252:255]
s_waitcnt lgkmcnt(0)
v_mfma_f32_16x16x32_bf16 v[36:39], a[128:131], a[64:67], v[36:39]
s_add_u32 m0, s29, 147456
ds_read_b64_tr_b16 a[136:137], v23 offset:0
v_accvgpr_read_b32 v32, a192
v_mfma_f32_16x16x32_bf16 v[36:39], a[132:135], a[68:71], v[36:39]
buffer_load_dwordx4 v16, s[12:15], s27 offen offset:0 lds
v_mfma_f32_16x16x32_bf16 v[44:47], a[128:131], a[72:75], v[44:47]
ds_read_b64_tr_b16 a[138:139], v23 offset:2048
v_accvgpr_read_b32 v33, a193
v_mfma_f32_16x16x32_bf16 v[44:47], a[132:135], a[76:79], v[44:47]
ds_read_b128 a[0:3], v2 offset:32768
ds_read_b128 a[4:7], v3 offset:32768
v_mfma_f32_16x16x32_bf16 v[52:55], a[128:131], a[80:83], v[52:55]
ds_read_b64_tr_b16 a[140:141], v23 offset:16384
v_accvgpr_read_b32 v34, a194
v_mfma_f32_16x16x32_bf16 v[52:55], a[132:135], a[84:87], v[52:55]
buffer_load_dwordx4 v17, s[12:15], s27 offen offset:1024 lds
v_mfma_f32_16x16x32_bf16 v[60:63], a[128:131], a[88:91], v[60:63]
ds_read_b64_tr_b16 a[142:143], v23 offset:18432
v_add_u32 v23, 32768, v23
v_mfma_f32_16x16x32_bf16 v[60:63], a[132:135], a[92:95], v[60:63]
buffer_store_dwordx4 v[128:131], v1, s[4:7], s31 offen sc1
v_mfma_f32_16x16x32_bf16 v[68:71], a[128:131], a[96:99], v[68:71]
s_add_u32 s31, s31, s32
ds_read_b128 a[8:11], v2 offset:34816
v_accvgpr_read_b32 v35, a195
v_mfma_f32_16x16x32_bf16 v[68:71], a[132:135], a[100:103], v[68:71]
buffer_load_dwordx4 v18, s[12:15], s27 offen offset:2048 lds
v_mfma_f32_16x16x32_bf16 v[76:79], a[128:131], a[104:107], v[76:79]
ds_read_b128 a[12:15], v3 offset:34816
v_accvgpr_read_b32 v96, a196
v_mfma_f32_16x16x32_bf16 v[76:79], a[132:135], a[108:111], v[76:79]
ds_read_b128 a[16:19], v2 offset:36864
v_accvgpr_read_b32 v97, a197
v_mfma_f32_16x16x32_bf16 v[84:87], a[128:131], a[112:115], v[84:87]
ds_read_b128 a[20:23], v3 offset:36864
v_accvgpr_read_b32 v98, a198
v_mfma_f32_16x16x32_bf16 v[84:87], a[132:135], a[116:119], v[84:87]
buffer_load_dwordx4 v19, s[12:15], s27 offen offset:3072 lds
v_mfma_f32_16x16x32_bf16 v[92:95], a[128:131], a[120:123], v[92:95]
s_add_u32 s27, s27, 524288
ds_read_b128 a[24:27], v2 offset:38912
v_accvgpr_read_b32 v99, a199
v_mfma_f32_16x16x32_bf16 v[92:95], a[132:135], a[124:127], v[92:95]
s_waitcnt lgkmcnt(5)
buffer_store_dwordx4 v[136:139], v1, s[4:7], s31 offen sc1
v_mfma_f32_16x16x32_bf16 v[100:103], a[136:139], a[64:67], v[100:103]
s_add_u32 m0, s28, 16384
ds_read_b64_tr_b16 a[128:129], v24 offset:0
v_cvt_pk_bf16_f32 v32, v32, v33
v_mfma_f32_16x16x32_bf16 v[100:103], a[140:143], a[68:71], v[100:103]
s_add_u32 s31, s31, s33
buffer_load_dwordx4 v12, s[8:11], s24 offen offset:0 lds
v_mfma_f32_16x16x32_bf16 v[108:111], a[136:139], a[72:75], v[108:111]
ds_read_b64_tr_b16 a[130:131], v24 offset:2048
v_cvt_pk_bf16_f32 v33, v34, v35
v_mfma_f32_16x16x32_bf16 v[108:111], a[140:143], a[76:79], v[108:111]
ds_read_b128 a[28:31], v3 offset:38912
v_cvt_pk_bf16_f32 v34, v96, v97
v_mfma_f32_16x16x32_bf16 v[116:119], a[136:139], a[80:83], v[116:119]
ds_read_b64_tr_b16 a[132:133], v24 offset:16384
v_cvt_pk_bf16_f32 v35, v98, v99
v_mfma_f32_16x16x32_bf16 v[116:119], a[140:143], a[84:87], v[116:119]
buffer_load_dwordx4 v13, s[8:11], s24 offen offset:1024 lds
v_mfma_f32_16x16x32_bf16 v[124:127], a[136:139], a[88:91], v[124:127]
ds_read_b64_tr_b16 a[134:135], v24 offset:18432
v_add_u32 v24, 32768, v24
v_mfma_f32_16x16x32_bf16 v[124:127], a[140:143], a[92:95], v[124:127]
v_accvgpr_read_b32 v40, a200
v_accvgpr_read_b32 v41, a201
v_mfma_f32_16x16x32_bf16 v[132:135], a[136:139], a[96:99], v[132:135]
ds_read_b128 a[32:35], v2 offset:40960
v_accvgpr_read_b32 v42, a202
v_mfma_f32_16x16x32_bf16 v[132:135], a[140:143], a[100:103], v[132:135]
buffer_load_dwordx4 v14, s[8:11], s24 offen offset:2048 lds
v_mfma_f32_16x16x32_bf16 v[140:143], a[136:139], a[104:107], v[140:143]
ds_read_b128 a[36:39], v3 offset:40960
v_accvgpr_read_b32 v43, a203
v_mfma_f32_16x16x32_bf16 v[140:143], a[140:143], a[108:111], v[140:143]
ds_read_b128 a[40:43], v2 offset:43008
v_accvgpr_read_b32 v96, a204
v_mfma_f32_16x16x32_bf16 v[148:151], a[136:139], a[112:115], v[148:151]
ds_read_b128 a[44:47], v3 offset:43008
v_accvgpr_read_b32 v97, a205
v_mfma_f32_16x16x32_bf16 v[148:151], a[140:143], a[116:119], v[148:151]
buffer_load_dwordx4 v15, s[8:11], s24 offen offset:3072 lds
v_mfma_f32_16x16x32_bf16 v[156:159], a[136:139], a[120:123], v[156:159]
s_add_u32 s24, s24, 128
ds_read_b128 a[48:51], v2 offset:45056
v_accvgpr_read_b32 v98, a206
v_mfma_f32_16x16x32_bf16 v[156:159], a[140:143], a[124:127], v[156:159]
s_waitcnt lgkmcnt(5)
buffer_store_dwordx4 v[144:147], v1, s[4:7], s31 offen sc1
v_mfma_f32_16x16x32_bf16 v[164:167], a[128:131], a[64:67], v[164:167]
s_add_u32 s31, s31, s32
ds_read_b64_tr_b16 a[136:137], v25 offset:0
v_accvgpr_read_b32 v99, a207
v_mfma_f32_16x16x32_bf16 v[164:167], a[132:135], a[68:71], v[164:167]
v_cvt_pk_bf16_f32 v40, v40, v41
v_cvt_pk_bf16_f32 v41, v42, v43
v_mfma_f32_16x16x32_bf16 v[172:175], a[128:131], a[72:75], v[172:175]
ds_read_b64_tr_b16 a[138:139], v25 offset:2048
v_cvt_pk_bf16_f32 v42, v96, v97
v_mfma_f32_16x16x32_bf16 v[172:175], a[132:135], a[76:79], v[172:175]
ds_read_b128 a[52:55], v3 offset:45056
v_cvt_pk_bf16_f32 v43, v98, v99
v_mfma_f32_16x16x32_bf16 v[180:183], a[128:131], a[80:83], v[180:183]
ds_read_b64_tr_b16 a[140:141], v25 offset:16384
v_accvgpr_read_b32 v48, a208
v_mfma_f32_16x16x32_bf16 v[180:183], a[132:135], a[84:87], v[180:183]
v_accvgpr_read_b32 v49, a209
v_accvgpr_read_b32 v50, a210
v_mfma_f32_16x16x32_bf16 v[188:191], a[128:131], a[88:91], v[188:191]
ds_read_b64_tr_b16 a[142:143], v25 offset:18432
v_add_u32 v25, 32768, v25
v_mfma_f32_16x16x32_bf16 v[188:191], a[132:135], a[92:95], v[188:191]
v_accvgpr_read_b32 v51, a211
v_accvgpr_read_b32 v96, a212
v_mfma_f32_16x16x32_bf16 v[196:199], a[128:131], a[96:99], v[196:199]
ds_read_b128 a[56:59], v2 offset:47104
v_accvgpr_read_b32 v97, a213
v_mfma_f32_16x16x32_bf16 v[196:199], a[132:135], a[100:103], v[196:199]
v_accvgpr_read_b32 v98, a214
v_accvgpr_read_b32 v99, a215
v_mfma_f32_16x16x32_bf16 v[204:207], a[128:131], a[104:107], v[204:207]
ds_read_b128 a[60:63], v3 offset:47104
v_cvt_pk_bf16_f32 v48, v48, v49
v_mfma_f32_16x16x32_bf16 v[204:207], a[132:135], a[108:111], v[204:207]
v_cvt_pk_bf16_f32 v49, v50, v51
v_cvt_pk_bf16_f32 v50, v96, v97
v_mfma_f32_16x16x32_bf16 v[212:215], a[128:131], a[112:115], v[212:215]
v_cvt_pk_bf16_f32 v51, v98, v99
v_accvgpr_read_b32 v56, a216
v_mfma_f32_16x16x32_bf16 v[212:215], a[132:135], a[116:119], v[212:215]
buffer_store_dwordx4 v[152:155], v1, s[4:7], s31 offen sc1
v_mfma_f32_16x16x32_bf16 v[220:223], a[128:131], a[120:123], v[220:223]
s_add_u32 s31, s31, s36
v_accvgpr_read_b32 v57, a217
v_accvgpr_read_b32 v58, a218
v_mfma_f32_16x16x32_bf16 v[220:223], a[132:135], a[124:127], v[220:223]
s_waitcnt vmcnt(23) lgkmcnt(0)
s_barrier
v_accvgpr_read_b32 v59, a219
v_mfma_f32_16x16x32_bf16 v[224:227], a[136:139], a[64:67], v[224:227]
s_add_u32 m0, s29, 65536
ds_read_b64_tr_b16 a[128:129], v22 offset:0
v_accvgpr_read_b32 v96, a220
v_mfma_f32_16x16x32_bf16 v[224:227], a[140:143], a[68:71], v[224:227]
buffer_load_dwordx4 v16, s[12:15], s26 offen offset:0 lds
v_mfma_f32_16x16x32_bf16 v[228:231], a[136:139], a[72:75], v[228:231]
ds_read_b64_tr_b16 a[130:131], v22 offset:2048
v_accvgpr_read_b32 v97, a221
v_mfma_f32_16x16x32_bf16 v[228:231], a[140:143], a[76:79], v[228:231]
v_accvgpr_read_b32 v98, a222
v_accvgpr_read_b32 v99, a223
v_mfma_f32_16x16x32_bf16 v[232:235], a[136:139], a[80:83], v[232:235]
ds_read_b64_tr_b16 a[132:133], v22 offset:16384
v_cvt_pk_bf16_f32 v56, v56, v57
v_mfma_f32_16x16x32_bf16 v[232:235], a[140:143], a[84:87], v[232:235]
buffer_load_dwordx4 v17, s[12:15], s26 offen offset:1024 lds
v_mfma_f32_16x16x32_bf16 v[236:239], a[136:139], a[88:91], v[236:239]
ds_read_b64_tr_b16 a[134:135], v22 offset:18432
v_add_u32 v22, 32768, v22
v_mfma_f32_16x16x32_bf16 v[236:239], a[140:143], a[92:95], v[236:239]
v_cvt_pk_bf16_f32 v57, v58, v59
v_cvt_pk_bf16_f32 v58, v96, v97
v_mfma_f32_16x16x32_bf16 v[240:243], a[136:139], a[96:99], v[240:243]
v_cvt_pk_bf16_f32 v59, v98, v99
v_accvgpr_read_b32 v64, a224
v_mfma_f32_16x16x32_bf16 v[240:243], a[140:143], a[100:103], v[240:243]
buffer_load_dwordx4 v18, s[12:15], s26 offen offset:2048 lds
v_mfma_f32_16x16x32_bf16 v[244:247], a[136:139], a[104:107], v[244:247]
v_accvgpr_read_b32 v65, a225
v_accvgpr_read_b32 v66, a226
v_mfma_f32_16x16x32_bf16 v[244:247], a[140:143], a[108:111], v[244:247]
v_accvgpr_read_b32 v67, a227
v_accvgpr_read_b32 v96, a228
v_mfma_f32_16x16x32_bf16 v[248:251], a[136:139], a[112:115], v[248:251]
v_accvgpr_read_b32 v97, a229
v_accvgpr_read_b32 v98, a230
v_mfma_f32_16x16x32_bf16 v[248:251], a[140:143], a[116:119], v[248:251]
buffer_load_dwordx4 v19, s[12:15], s26 offen offset:3072 lds
v_mfma_f32_16x16x32_bf16 v[252:255], a[136:139], a[120:123], v[252:255]
s_add_u32 s26, s26, 524288
v_accvgpr_read_b32 v99, a231
v_cvt_pk_bf16_f32 v64, v64, v65
v_mfma_f32_16x16x32_bf16 v[252:255], a[140:143], a[124:127], v[252:255]
s_waitcnt lgkmcnt(0)
v_cvt_pk_bf16_f32 v65, v66, v67
v_cvt_pk_bf16_f32 v66, v96, v97
v_mfma_f32_16x16x32_bf16 v[36:39], a[128:131], a[0:3], v[36:39]
s_add_u32 m0, s29, 81920
ds_read_b64_tr_b16 a[136:137], v23 offset:0
v_cvt_pk_bf16_f32 v67, v98, v99
v_mfma_f32_16x16x32_bf16 v[36:39], a[132:135], a[4:7], v[36:39]
buffer_load_dwordx4 v16, s[12:15], s27 offen offset:0 lds
v_mfma_f32_16x16x32_bf16 v[44:47], a[128:131], a[8:11], v[44:47]
ds_read_b64_tr_b16 a[138:139], v23 offset:2048
v_accvgpr_read_b32 v72, a232
v_mfma_f32_16x16x32_bf16 v[44:47], a[132:135], a[12:15], v[44:47]
ds_read_b128 a[64:67], v2 offset:49152
ds_read_b128 a[68:71], v3 offset:49152
v_mfma_f32_16x16x32_bf16 v[52:55], a[128:131], a[16:19], v[52:55]
ds_read_b64_tr_b16 a[140:141], v23 offset:16384
v_accvgpr_read_b32 v73, a233
v_mfma_f32_16x16x32_bf16 v[52:55], a[132:135], a[20:23], v[52:55]
buffer_load_dwordx4 v17, s[12:15], s27 offen offset:1024 lds
v_mfma_f32_16x16x32_bf16 v[60:63], a[128:131], a[24:27], v[60:63]
ds_read_b64_tr_b16 a[142:143], v23 offset:18432
v_add_u32 v23, 32768, v23
v_mfma_f32_16x16x32_bf16 v[60:63], a[132:135], a[28:31], v[60:63]
buffer_store_dwordx4 v[160:163], v1, s[4:7], s31 offen sc1
v_mfma_f32_16x16x32_bf16 v[68:71], a[128:131], a[32:35], v[68:71]
s_add_u32 s31, s31, s32
ds_read_b128 a[72:75], v2 offset:51200
v_accvgpr_read_b32 v74, a234
v_mfma_f32_16x16x32_bf16 v[68:71], a[132:135], a[36:39], v[68:71]
buffer_load_dwordx4 v18, s[12:15], s27 offen offset:2048 lds
v_mfma_f32_16x16x32_bf16 v[76:79], a[128:131], a[40:43], v[76:79]
ds_read_b128 a[76:79], v3 offset:51200
v_accvgpr_read_b32 v75, a235
v_mfma_f32_16x16x32_bf16 v[76:79], a[132:135], a[44:47], v[76:79]
ds_read_b128 a[80:83], v2 offset:53248
v_accvgpr_read_b32 v96, a236
v_mfma_f32_16x16x32_bf16 v[84:87], a[128:131], a[48:51], v[84:87]
ds_read_b128 a[84:87], v3 offset:53248
v_accvgpr_read_b32 v97, a237
v_mfma_f32_16x16x32_bf16 v[84:87], a[132:135], a[52:55], v[84:87]
buffer_load_dwordx4 v19, s[12:15], s27 offen offset:3072 lds
v_mfma_f32_16x16x32_bf16 v[92:95], a[128:131], a[56:59], v[92:95]
s_add_u32 s27, s27, 524288
ds_read_b128 a[88:91], v2 offset:55296
v_accvgpr_read_b32 v98, a238
v_mfma_f32_16x16x32_bf16 v[92:95], a[132:135], a[60:63], v[92:95]
s_waitcnt lgkmcnt(5)
buffer_store_dwordx4 v[168:171], v1, s[4:7], s31 offen sc1
v_mfma_f32_16x16x32_bf16 v[100:103], a[136:139], a[0:3], v[100:103]
s_add_u32 m0, s28, 32768
ds_read_b64_tr_b16 a[128:129], v24 offset:0
v_accvgpr_read_b32 v99, a239
v_mfma_f32_16x16x32_bf16 v[100:103], a[140:143], a[4:7], v[100:103]
s_add_u32 s31, s31, s33
buffer_load_dwordx4 v12, s[8:11], s24 offen offset:0 lds
v_mfma_f32_16x16x32_bf16 v[108:111], a[136:139], a[8:11], v[108:111]
ds_read_b64_tr_b16 a[130:131], v24 offset:2048
v_cvt_pk_bf16_f32 v72, v72, v73
v_mfma_f32_16x16x32_bf16 v[108:111], a[140:143], a[12:15], v[108:111]
ds_read_b128 a[92:95], v3 offset:55296
v_cvt_pk_bf16_f32 v73, v74, v75
v_mfma_f32_16x16x32_bf16 v[116:119], a[136:139], a[16:19], v[116:119]
ds_read_b64_tr_b16 a[132:133], v24 offset:16384
v_cvt_pk_bf16_f32 v74, v96, v97
v_mfma_f32_16x16x32_bf16 v[116:119], a[140:143], a[20:23], v[116:119]
buffer_load_dwordx4 v13, s[8:11], s24 offen offset:1024 lds
v_mfma_f32_16x16x32_bf16 v[124:127], a[136:139], a[24:27], v[124:127]
ds_read_b64_tr_b16 a[134:135], v24 offset:18432
v_add_u32 v24, 32768, v24
v_mfma_f32_16x16x32_bf16 v[124:127], a[140:143], a[28:31], v[124:127]
v_cvt_pk_bf16_f32 v75, v98, v99
v_accvgpr_read_b32 v80, a240
v_mfma_f32_16x16x32_bf16 v[132:135], a[136:139], a[32:35], v[132:135]
ds_read_b128 a[96:99], v2 offset:57344
v_accvgpr_read_b32 v81, a241
v_mfma_f32_16x16x32_bf16 v[132:135], a[140:143], a[36:39], v[132:135]
buffer_load_dwordx4 v14, s[8:11], s24 offen offset:2048 lds
v_mfma_f32_16x16x32_bf16 v[140:143], a[136:139], a[40:43], v[140:143]
ds_read_b128 a[100:103], v3 offset:57344
v_accvgpr_read_b32 v82, a242
v_mfma_f32_16x16x32_bf16 v[140:143], a[140:143], a[44:47], v[140:143]
ds_read_b128 a[104:107], v2 offset:59392
v_accvgpr_read_b32 v83, a243
v_mfma_f32_16x16x32_bf16 v[148:151], a[136:139], a[48:51], v[148:151]
ds_read_b128 a[108:111], v3 offset:59392
v_accvgpr_read_b32 v96, a244
v_mfma_f32_16x16x32_bf16 v[148:151], a[140:143], a[52:55], v[148:151]
buffer_load_dwordx4 v15, s[8:11], s24 offen offset:3072 lds
v_mfma_f32_16x16x32_bf16 v[156:159], a[136:139], a[56:59], v[156:159]
s_add_u32 s24, s24, 128
ds_read_b128 a[112:115], v2 offset:61440
v_accvgpr_read_b32 v97, a245
v_mfma_f32_16x16x32_bf16 v[156:159], a[140:143], a[60:63], v[156:159]
s_waitcnt lgkmcnt(5)
buffer_store_dwordx4 v[176:179], v1, s[4:7], s31 offen sc1
v_mfma_f32_16x16x32_bf16 v[164:167], a[128:131], a[0:3], v[164:167]
s_add_u32 s31, s31, s32
ds_read_b64_tr_b16 a[136:137], v25 offset:0
v_accvgpr_read_b32 v98, a246
v_mfma_f32_16x16x32_bf16 v[164:167], a[132:135], a[4:7], v[164:167]
v_accvgpr_read_b32 v99, a247
v_cvt_pk_bf16_f32 v80, v80, v81
v_mfma_f32_16x16x32_bf16 v[172:175], a[128:131], a[8:11], v[172:175]
ds_read_b64_tr_b16 a[138:139], v25 offset:2048
v_cvt_pk_bf16_f32 v81, v82, v83
v_mfma_f32_16x16x32_bf16 v[172:175], a[132:135], a[12:15], v[172:175]
ds_read_b128 a[116:119], v3 offset:61440
v_cvt_pk_bf16_f32 v82, v96, v97
v_mfma_f32_16x16x32_bf16 v[180:183], a[128:131], a[16:19], v[180:183]
ds_read_b64_tr_b16 a[140:141], v25 offset:16384
v_cvt_pk_bf16_f32 v83, v98, v99
v_mfma_f32_16x16x32_bf16 v[180:183], a[132:135], a[20:23], v[180:183]
buffer_store_dwordx4 v[184:187], v1, s[4:7], s31 offen sc1
v_mfma_f32_16x16x32_bf16 v[188:191], a[128:131], a[24:27], v[188:191]
s_add_u32 s31, s31, s34
ds_read_b64_tr_b16 a[142:143], v25 offset:18432
v_add_u32 v25, 32768, v25
v_mfma_f32_16x16x32_bf16 v[188:191], a[132:135], a[28:31], v[188:191]
v_accvgpr_read_b32 v88, a248
v_accvgpr_read_b32 v89, a249
v_mfma_f32_16x16x32_bf16 v[196:199], a[128:131], a[32:35], v[196:199]
ds_read_b128 a[120:123], v2 offset:63488
v_accvgpr_read_b32 v90, a250
v_mfma_f32_16x16x32_bf16 v[196:199], a[132:135], a[36:39], v[196:199]
v_accvgpr_read_b32 v91, a251
v_accvgpr_read_b32 v96, a252
v_mfma_f32_16x16x32_bf16 v[204:207], a[128:131], a[40:43], v[204:207]
ds_read_b128 a[124:127], v3 offset:63488
v_accvgpr_read_b32 v97, a253
v_mfma_f32_16x16x32_bf16 v[204:207], a[132:135], a[44:47], v[204:207]
v_accvgpr_read_b32 v98, a254
v_accvgpr_read_b32 v99, a255
v_mfma_f32_16x16x32_bf16 v[212:215], a[128:131], a[48:51], v[212:215]
v_cvt_pk_bf16_f32 v88, v88, v89
v_cvt_pk_bf16_f32 v89, v90, v91
v_mfma_f32_16x16x32_bf16 v[212:215], a[132:135], a[52:55], v[212:215]
v_cvt_pk_bf16_f32 v90, v96, v97
v_cvt_pk_bf16_f32 v91, v98, v99
v_mfma_f32_16x16x32_bf16 v[220:223], a[128:131], a[56:59], v[220:223]
v_mfma_f32_16x16x32_bf16 v[220:223], a[132:135], a[60:63], v[220:223]
s_waitcnt vmcnt(23) lgkmcnt(0)
s_barrier
v_mfma_f32_16x16x32_bf16 v[224:227], a[136:139], a[0:3], v[224:227]
s_add_u32 m0, s29, 98304
ds_read_b64_tr_b16 a[128:129], v22 offset:0
v_mfma_f32_16x16x32_bf16 v[224:227], a[140:143], a[4:7], v[224:227]
buffer_load_dwordx4 v16, s[12:15], s26 offen offset:0 lds
v_mfma_f32_16x16x32_bf16 v[228:231], a[136:139], a[8:11], v[228:231]
ds_read_b64_tr_b16 a[130:131], v22 offset:2048
v_mfma_f32_16x16x32_bf16 v[228:231], a[140:143], a[12:15], v[228:231]
buffer_store_dwordx4 v[192:195], v1, s[4:7], s31 offen sc1
v_mfma_f32_16x16x32_bf16 v[232:235], a[136:139], a[16:19], v[232:235]
s_add_u32 s31, s31, s32
ds_read_b64_tr_b16 a[132:133], v22 offset:16384
v_mfma_f32_16x16x32_bf16 v[232:235], a[140:143], a[20:23], v[232:235]
buffer_load_dwordx4 v17, s[12:15], s26 offen offset:1024 lds
v_mfma_f32_16x16x32_bf16 v[236:239], a[136:139], a[24:27], v[236:239]
ds_read_b64_tr_b16 a[134:135], v22 offset:18432
v_add_u32 v22, 4294901760, v22
v_mfma_f32_16x16x32_bf16 v[236:239], a[140:143], a[28:31], v[236:239]
v_mfma_f32_16x16x32_bf16 v[240:243], a[136:139], a[32:35], v[240:243]
v_mfma_f32_16x16x32_bf16 v[240:243], a[140:143], a[36:39], v[240:243]
buffer_load_dwordx4 v18, s[12:15], s26 offen offset:2048 lds
v_mfma_f32_16x16x32_bf16 v[244:247], a[136:139], a[40:43], v[244:247]
v_mfma_f32_16x16x32_bf16 v[244:247], a[140:143], a[44:47], v[244:247]
v_mfma_f32_16x16x32_bf16 v[248:251], a[136:139], a[48:51], v[248:251]
v_mfma_f32_16x16x32_bf16 v[248:251], a[140:143], a[52:55], v[248:251]
buffer_load_dwordx4 v19, s[12:15], s26 offen offset:3072 lds
v_mfma_f32_16x16x32_bf16 v[252:255], a[136:139], a[56:59], v[252:255]
s_add_u32 s26, s26, 524288
v_mfma_f32_16x16x32_bf16 v[252:255], a[140:143], a[60:63], v[252:255]
s_waitcnt lgkmcnt(2)
v_mfma_f32_16x16x32_bf16 v[36:39], a[128:131], a[64:67], v[36:39]
s_waitcnt lgkmcnt(0)
s_add_u32 m0, s29, 114688
ds_read_b64_tr_b16 a[136:137], v23 offset:0
v_mfma_f32_16x16x32_bf16 v[36:39], a[132:135], a[68:71], v[36:39]
buffer_load_dwordx4 v16, s[12:15], s27 offen offset:0 lds
v_mfma_f32_16x16x32_bf16 v[44:47], a[128:131], a[72:75], v[44:47]
ds_read_b64_tr_b16 a[138:139], v23 offset:2048
v_mfma_f32_16x16x32_bf16 v[44:47], a[132:135], a[76:79], v[44:47]
ds_read_b128 a[0:3], v2 offset:0
ds_read_b128 a[4:7], v3 offset:0
v_mfma_f32_16x16x32_bf16 v[52:55], a[128:131], a[80:83], v[52:55]
ds_read_b64_tr_b16 a[140:141], v23 offset:16384
v_mfma_f32_16x16x32_bf16 v[52:55], a[132:135], a[84:87], v[52:55]
buffer_load_dwordx4 v17, s[12:15], s27 offen offset:1024 lds
v_mfma_f32_16x16x32_bf16 v[60:63], a[128:131], a[88:91], v[60:63]
ds_read_b64_tr_b16 a[142:143], v23 offset:18432
v_add_u32 v23, 4294901760, v23
v_mfma_f32_16x16x32_bf16 v[60:63], a[132:135], a[92:95], v[60:63]
buffer_store_dwordx4 v[200:203], v1, s[4:7], s31 offen sc1
v_mfma_f32_16x16x32_bf16 v[68:71], a[128:131], a[96:99], v[68:71]
s_add_u32 s31, s31, s33
ds_read_b128 a[8:11], v2 offset:2048
v_mfma_f32_16x16x32_bf16 v[68:71], a[132:135], a[100:103], v[68:71]
buffer_load_dwordx4 v18, s[12:15], s27 offen offset:2048 lds
v_mfma_f32_16x16x32_bf16 v[76:79], a[128:131], a[104:107], v[76:79]
ds_read_b128 a[12:15], v3 offset:2048
v_mfma_f32_16x16x32_bf16 v[76:79], a[132:135], a[108:111], v[76:79]
ds_read_b128 a[16:19], v2 offset:4096
v_mfma_f32_16x16x32_bf16 v[84:87], a[128:131], a[112:115], v[84:87]
ds_read_b128 a[20:23], v3 offset:4096
v_mfma_f32_16x16x32_bf16 v[84:87], a[132:135], a[116:119], v[84:87]
buffer_load_dwordx4 v19, s[12:15], s27 offen offset:3072 lds
v_mfma_f32_16x16x32_bf16 v[92:95], a[128:131], a[120:123], v[92:95]
s_add_u32 s27, s27, 524288
ds_read_b128 a[24:27], v2 offset:6144
v_mfma_f32_16x16x32_bf16 v[92:95], a[132:135], a[124:127], v[92:95]
s_waitcnt lgkmcnt(9)
buffer_store_dwordx4 v[208:211], v1, s[4:7], s31 offen sc1
v_mfma_f32_16x16x32_bf16 v[100:103], a[136:139], a[64:67], v[100:103]
s_waitcnt lgkmcnt(5)
s_add_u32 s31, s31, s32
ds_read_b64_tr_b16 a[128:129], v24 offset:0
v_mfma_f32_16x16x32_bf16 v[100:103], a[140:143], a[68:71], v[100:103]
v_mfma_f32_16x16x32_bf16 v[108:111], a[136:139], a[72:75], v[108:111]
ds_read_b64_tr_b16 a[130:131], v24 offset:2048
v_mfma_f32_16x16x32_bf16 v[108:111], a[140:143], a[76:79], v[108:111]
ds_read_b128 a[28:31], v3 offset:6144
v_mfma_f32_16x16x32_bf16 v[116:119], a[136:139], a[80:83], v[116:119]
ds_read_b64_tr_b16 a[132:133], v24 offset:16384
v_mfma_f32_16x16x32_bf16 v[116:119], a[140:143], a[84:87], v[116:119]
v_mfma_f32_16x16x32_bf16 v[124:127], a[136:139], a[88:91], v[124:127]
ds_read_b64_tr_b16 a[134:135], v24 offset:18432
v_add_u32 v24, 4294901760, v24
v_mfma_f32_16x16x32_bf16 v[124:127], a[140:143], a[92:95], v[124:127]
v_mfma_f32_16x16x32_bf16 v[132:135], a[136:139], a[96:99], v[132:135]
ds_read_b128 a[32:35], v2 offset:8192
v_mfma_f32_16x16x32_bf16 v[132:135], a[140:143], a[100:103], v[132:135]
buffer_store_dwordx4 v[216:219], v1, s[4:7], s31 offen sc1
v_mfma_f32_16x16x32_bf16 v[140:143], a[136:139], a[104:107], v[140:143]
s_add_u32 s31, s31, s35
ds_read_b128 a[36:39], v3 offset:8192
v_mfma_f32_16x16x32_bf16 v[140:143], a[140:143], a[108:111], v[140:143]
ds_read_b128 a[40:43], v2 offset:10240
v_mfma_f32_16x16x32_bf16 v[148:151], a[136:139], a[112:115], v[148:151]
ds_read_b128 a[44:47], v3 offset:10240
v_mfma_f32_16x16x32_bf16 v[148:151], a[140:143], a[116:119], v[148:151]
v_mfma_f32_16x16x32_bf16 v[156:159], a[136:139], a[120:123], v[156:159]
ds_read_b128 a[48:51], v2 offset:12288
v_mfma_f32_16x16x32_bf16 v[156:159], a[140:143], a[124:127], v[156:159]
s_waitcnt lgkmcnt(8)
v_mfma_f32_16x16x32_bf16 v[164:167], a[128:131], a[64:67], v[164:167]
s_waitcnt lgkmcnt(5)
ds_read_b64_tr_b16 a[136:137], v25 offset:0
v_mfma_f32_16x16x32_bf16 v[164:167], a[132:135], a[68:71], v[164:167]
v_mfma_f32_16x16x32_bf16 v[172:175], a[128:131], a[72:75], v[172:175]
ds_read_b64_tr_b16 a[138:139], v25 offset:2048
v_mfma_f32_16x16x32_bf16 v[172:175], a[132:135], a[76:79], v[172:175]
ds_read_b128 a[52:55], v3 offset:12288
v_mfma_f32_16x16x32_bf16 v[180:183], a[128:131], a[80:83], v[180:183]
ds_read_b64_tr_b16 a[140:141], v25 offset:16384
v_mfma_f32_16x16x32_bf16 v[180:183], a[132:135], a[84:87], v[180:183]
buffer_store_dwordx4 v[32:35], v1, s[4:7], s31 offen sc1
v_mfma_f32_16x16x32_bf16 v[188:191], a[128:131], a[88:91], v[188:191]
s_add_u32 s31, s31, s32
ds_read_b64_tr_b16 a[142:143], v25 offset:18432
v_add_u32 v25, 4294901760, v25
v_mfma_f32_16x16x32_bf16 v[188:191], a[132:135], a[92:95], v[188:191]
v_mfma_f32_16x16x32_bf16 v[196:199], a[128:131], a[96:99], v[196:199]
ds_read_b128 a[56:59], v2 offset:14336
v_mfma_f32_16x16x32_bf16 v[196:199], a[132:135], a[100:103], v[196:199]
v_mfma_f32_16x16x32_bf16 v[204:207], a[128:131], a[104:107], v[204:207]
ds_read_b128 a[60:63], v3 offset:14336
v_mfma_f32_16x16x32_bf16 v[204:207], a[132:135], a[108:111], v[204:207]
v_mfma_f32_16x16x32_bf16 v[212:215], a[128:131], a[112:115], v[212:215]
v_mfma_f32_16x16x32_bf16 v[212:215], a[132:135], a[116:119], v[212:215]
v_mfma_f32_16x16x32_bf16 v[220:223], a[128:131], a[120:123], v[220:223]
v_mfma_f32_16x16x32_bf16 v[220:223], a[132:135], a[124:127], v[220:223]
s_waitcnt vmcnt(20) lgkmcnt(0)
s_barrier
v_mfma_f32_16x16x32_bf16 v[224:227], a[136:139], a[64:67], v[224:227]
s_add_u32 m0, s29, 131072
ds_read_b64_tr_b16 a[128:129], v22 offset:0
v_mfma_f32_16x16x32_bf16 v[224:227], a[140:143], a[68:71], v[224:227]
buffer_load_dwordx4 v16, s[12:15], s26 offen offset:0 lds
v_mfma_f32_16x16x32_bf16 v[228:231], a[136:139], a[72:75], v[228:231]
ds_read_b64_tr_b16 a[130:131], v22 offset:2048
v_mfma_f32_16x16x32_bf16 v[228:231], a[140:143], a[76:79], v[228:231]
buffer_store_dwordx4 v[40:43], v1, s[4:7], s31 offen sc1
v_mfma_f32_16x16x32_bf16 v[232:235], a[136:139], a[80:83], v[232:235]
s_add_u32 s31, s31, s33
ds_read_b64_tr_b16 a[132:133], v22 offset:16384
v_mfma_f32_16x16x32_bf16 v[232:235], a[140:143], a[84:87], v[232:235]
buffer_load_dwordx4 v17, s[12:15], s26 offen offset:1024 lds
v_mfma_f32_16x16x32_bf16 v[236:239], a[136:139], a[88:91], v[236:239]
ds_read_b64_tr_b16 a[134:135], v22 offset:18432
v_add_u32 v22, 32768, v22
v_mfma_f32_16x16x32_bf16 v[236:239], a[140:143], a[92:95], v[236:239]
v_mfma_f32_16x16x32_bf16 v[240:243], a[136:139], a[96:99], v[240:243]
v_mfma_f32_16x16x32_bf16 v[240:243], a[140:143], a[100:103], v[240:243]
buffer_load_dwordx4 v18, s[12:15], s26 offen offset:2048 lds
v_mfma_f32_16x16x32_bf16 v[244:247], a[136:139], a[104:107], v[244:247]
v_mfma_f32_16x16x32_bf16 v[244:247], a[140:143], a[108:111], v[244:247]
v_mfma_f32_16x16x32_bf16 v[248:251], a[136:139], a[112:115], v[248:251]
v_mfma_f32_16x16x32_bf16 v[248:251], a[140:143], a[116:119], v[248:251]
buffer_load_dwordx4 v19, s[12:15], s26 offen offset:3072 lds
v_mfma_f32_16x16x32_bf16 v[252:255], a[136:139], a[120:123], v[252:255]
s_add_u32 s26, s26, 524288
v_mfma_f32_16x16x32_bf16 v[252:255], a[140:143], a[124:127], v[252:255]
s_waitcnt lgkmcnt(2)
v_mfma_f32_16x16x32_bf16 v[36:39], a[128:131], a[0:3], v[36:39]
s_waitcnt lgkmcnt(0)
s_add_u32 m0, s29, 147456
ds_read_b64_tr_b16 a[136:137], v23 offset:0
v_mfma_f32_16x16x32_bf16 v[36:39], a[132:135], a[4:7], v[36:39]
buffer_load_dwordx4 v16, s[12:15], s27 offen offset:0 lds
v_mfma_f32_16x16x32_bf16 v[44:47], a[128:131], a[8:11], v[44:47]
s_lshl_b32 s22, s20, 7
ds_read_b64_tr_b16 a[138:139], v23 offset:2048
v_bfe_u32 v20, v1, 4, 3
v_mfma_f32_16x16x32_bf16 v[44:47], a[132:135], a[12:15], v[44:47]
s_add_u32 s70, s22, 94371840
ds_read_b128 a[64:67], v2 offset:16384
ds_read_b128 a[68:71], v3 offset:16384
v_mfma_f32_16x16x32_bf16 v[52:55], a[128:131], a[16:19], v[52:55]
s_lshr_b32 s22, s2, 4
ds_read_b64_tr_b16 a[140:141], v23 offset:16384
v_lshlrev_b32 v20, 3, v20
v_mfma_f32_16x16x32_bf16 v[52:55], a[132:135], a[20:23], v[52:55]
s_lshl_b32 s22, s22, 2
buffer_load_dwordx4 v17, s[12:15], s27 offen offset:1024 lds
v_mfma_f32_16x16x32_bf16 v[60:63], a[128:131], a[24:27], v[60:63]
s_add_u32 s66, s70, s22
ds_read_b64_tr_b16 a[142:143], v23 offset:18432
v_add_u32 v23, 32768, v23
v_mfma_f32_16x16x32_bf16 v[60:63], a[132:135], a[28:31], v[60:63]
s_and_b32 s22, s2, 16
buffer_store_dwordx4 v[48:51], v1, s[4:7], s31 offen sc1
v_mfma_f32_16x16x32_bf16 v[68:71], a[128:131], a[32:35], v[68:71]
s_add_u32 s31, s31, s32
ds_read_b128 a[72:75], v2 offset:18432
v_add_u32 v15, 2052, v20
v_mfma_f32_16x16x32_bf16 v[68:71], a[132:135], a[36:39], v[68:71]
s_lshl_b32 s22, s22, 7
buffer_load_dwordx4 v18, s[12:15], s27 offen offset:2048 lds
v_mfma_f32_16x16x32_bf16 v[76:79], a[128:131], a[40:43], v[76:79]
s_add_u32 s66, s66, s22
ds_read_b128 a[76:79], v3 offset:18432
v_mfma_f32_16x16x32_bf16 v[76:79], a[132:135], a[44:47], v[76:79]
s_lshl_b32 s67, s20, 20
ds_read_b128 a[80:83], v2 offset:20480
v_mfma_f32_16x16x32_bf16 v[84:87], a[128:131], a[48:51], v[84:87]
s_lshl_b32 s22, s37, 16
ds_read_b128 a[84:87], v3 offset:20480
v_mfma_f32_16x16x32_bf16 v[84:87], a[132:135], a[52:55], v[84:87]
s_add_u32 s67, s67, s22
buffer_load_dwordx4 v19, s[12:15], s27 offen offset:3072 lds
v_mfma_f32_16x16x32_bf16 v[92:95], a[128:131], a[56:59], v[92:95]
s_waitcnt lgkmcnt(8)
s_add_u32 s27, s27, 524288
ds_read_b128 a[88:91], v2 offset:22528
v_mfma_f32_16x16x32_bf16 v[92:95], a[132:135], a[60:63], v[92:95]
s_lshl_b32 s22, s3, 11
buffer_store_dwordx4 v[56:59], v1, s[4:7], s31 offen sc1
v_mfma_f32_16x16x32_bf16 v[100:103], a[136:139], a[0:3], v[100:103]
s_waitcnt lgkmcnt(5)
s_add_u32 s31, s31, s34
ds_read_b64_tr_b16 a[128:129], v24 offset:0
v_mfma_f32_16x16x32_bf16 v[100:103], a[140:143], a[4:7], v[100:103]
s_add_u32 s67, s67, s22
v_mfma_f32_16x16x32_bf16 v[108:111], a[136:139], a[8:11], v[108:111]
s_add_u32 s67, s67, 33554432
ds_read_b64_tr_b16 a[130:131], v24 offset:2048
v_mfma_f32_16x16x32_bf16 v[108:111], a[140:143], a[12:15], v[108:111]
s_mov_b32 s68, 1035512379
ds_read_b128 a[92:95], v3 offset:22528
v_mfma_f32_16x16x32_bf16 v[116:119], a[136:139], a[16:19], v[116:119]
s_mov_b32 s69, 1035512379
ds_read_b64_tr_b16 a[132:133], v24 offset:16384
v_mfma_f32_16x16x32_bf16 v[116:119], a[140:143], a[20:23], v[116:119]
buffer_store_dwordx4 v[64:67], v1, s[4:7], s31 offen sc1
v_mfma_f32_16x16x32_bf16 v[124:127], a[136:139], a[24:27], v[124:127]
s_add_u32 s31, s31, s32
ds_read_b64_tr_b16 a[134:135], v24 offset:18432
v_add_u32 v24, 32768, v24
v_mfma_f32_16x16x32_bf16 v[124:127], a[140:143], a[28:31], v[124:127]
v_mfma_f32_16x16x32_bf16 v[132:135], a[136:139], a[32:35], v[132:135]
ds_read_b128 a[96:99], v2 offset:24576
v_mfma_f32_16x16x32_bf16 v[132:135], a[140:143], a[36:39], v[132:135]
v_mfma_f32_16x16x32_bf16 v[140:143], a[136:139], a[40:43], v[140:143]
ds_read_b128 a[100:103], v3 offset:24576
v_mfma_f32_16x16x32_bf16 v[140:143], a[140:143], a[44:47], v[140:143]
ds_read_b128 a[104:107], v2 offset:26624
v_mfma_f32_16x16x32_bf16 v[148:151], a[136:139], a[48:51], v[148:151]
ds_read_b128 a[108:111], v3 offset:26624
v_mfma_f32_16x16x32_bf16 v[148:151], a[140:143], a[52:55], v[148:151]
v_mfma_f32_16x16x32_bf16 v[156:159], a[136:139], a[56:59], v[156:159]
ds_read_b128 a[112:115], v2 offset:28672
v_mfma_f32_16x16x32_bf16 v[156:159], a[140:143], a[60:63], v[156:159]
s_waitcnt lgkmcnt(8)
buffer_store_dwordx4 v[72:75], v1, s[4:7], s31 offen sc1
v_mfma_f32_16x16x32_bf16 v[164:167], a[128:131], a[0:3], v[164:167]
s_waitcnt lgkmcnt(5)
s_add_u32 s31, s31, s33
ds_read_b64_tr_b16 a[136:137], v25 offset:0
v_mfma_f32_16x16x32_bf16 v[164:167], a[132:135], a[4:7], v[164:167]
v_mfma_f32_16x16x32_bf16 v[172:175], a[128:131], a[8:11], v[172:175]
ds_read_b64_tr_b16 a[138:139], v25 offset:2048
v_mfma_f32_16x16x32_bf16 v[172:175], a[132:135], a[12:15], v[172:175]
ds_read_b128 a[116:119], v3 offset:28672
v_mfma_f32_16x16x32_bf16 v[180:183], a[128:131], a[16:19], v[180:183]
ds_read_b64_tr_b16 a[140:141], v25 offset:16384
v_mfma_f32_16x16x32_bf16 v[180:183], a[132:135], a[20:23], v[180:183]
v_mfma_f32_16x16x32_bf16 v[188:191], a[128:131], a[24:27], v[188:191]
ds_read_b64_tr_b16 a[142:143], v25 offset:18432
v_add_u32 v25, 32768, v25
v_mfma_f32_16x16x32_bf16 v[188:191], a[132:135], a[28:31], v[188:191]
v_mfma_f32_16x16x32_bf16 v[196:199], a[128:131], a[32:35], v[196:199]
ds_read_b128 a[120:123], v2 offset:30720
v_mfma_f32_16x16x32_bf16 v[196:199], a[132:135], a[36:39], v[196:199]
buffer_store_dwordx4 v[80:83], v1, s[4:7], s31 offen sc1
v_mfma_f32_16x16x32_bf16 v[204:207], a[128:131], a[40:43], v[204:207]
s_add_u32 s31, s31, s32
ds_read_b128 a[124:127], v3 offset:30720
v_mfma_f32_16x16x32_bf16 v[204:207], a[132:135], a[44:47], v[204:207]
v_mfma_f32_16x16x32_bf16 v[212:215], a[128:131], a[48:51], v[212:215]
v_mfma_f32_16x16x32_bf16 v[212:215], a[132:135], a[52:55], v[212:215]
v_mfma_f32_16x16x32_bf16 v[220:223], a[128:131], a[56:59], v[220:223]
v_mfma_f32_16x16x32_bf16 v[220:223], a[132:135], a[60:63], v[220:223]
s_waitcnt vmcnt(17) lgkmcnt(0)
s_barrier
v_mfma_f32_16x16x32_bf16 v[224:227], a[136:139], a[0:3], v[224:227]
ds_read_b64_tr_b16 a[128:129], v22 offset:0
v_mfma_f32_16x16x32_bf16 v[224:227], a[140:143], a[4:7], v[224:227]
v_mfma_f32_16x16x32_bf16 v[228:231], a[136:139], a[8:11], v[228:231]
ds_read_b64_tr_b16 a[130:131], v22 offset:2048
v_mfma_f32_16x16x32_bf16 v[228:231], a[140:143], a[12:15], v[228:231]
buffer_store_dwordx4 v[88:91], v1, s[4:7], s31 offen sc1
v_mfma_f32_16x16x32_bf16 v[232:235], a[136:139], a[16:19], v[232:235]
ds_read_b64_tr_b16 a[132:133], v22 offset:16384
v_mfma_f32_16x16x32_bf16 v[232:235], a[140:143], a[20:23], v[232:235]
v_mfma_f32_16x16x32_bf16 v[236:239], a[136:139], a[24:27], v[236:239]
ds_read_b64_tr_b16 a[134:135], v22 offset:18432
v_add_u32 v22, 32768, v22
v_mfma_f32_16x16x32_bf16 v[236:239], a[140:143], a[28:31], v[236:239]
v_mfma_f32_16x16x32_bf16 v[240:243], a[136:139], a[32:35], v[240:243]
v_mfma_f32_16x16x32_bf16 v[240:243], a[140:143], a[36:39], v[240:243]
v_mfma_f32_16x16x32_bf16 v[244:247], a[136:139], a[40:43], v[244:247]
v_mfma_f32_16x16x32_bf16 v[244:247], a[140:143], a[44:47], v[244:247]
v_mfma_f32_16x16x32_bf16 v[248:251], a[136:139], a[48:51], v[248:251]
v_mfma_f32_16x16x32_bf16 v[248:251], a[140:143], a[52:55], v[248:251]
v_mfma_f32_16x16x32_bf16 v[252:255], a[136:139], a[56:59], v[252:255]
v_mfma_f32_16x16x32_bf16 v[252:255], a[140:143], a[60:63], v[252:255]
s_waitcnt lgkmcnt(2)
v_mfma_f32_16x16x32_bf16 v[36:39], a[128:131], a[64:67], v[36:39]
s_waitcnt lgkmcnt(0)
ds_read_b64_tr_b16 a[136:137], v23 offset:0
v_mfma_f32_16x16x32_bf16 v[36:39], a[132:135], a[68:71], v[36:39]
v_mfma_f32_16x16x32_bf16 v[44:47], a[128:131], a[72:75], v[44:47]
s_mul_i32 s85, s20, 7
ds_read_b64_tr_b16 a[138:139], v23 offset:2048
v_mfma_f32_16x16x32_bf16 v[44:47], a[132:135], a[76:79], v[44:47]
s_add_u32 s85, s85, s21
ds_read_b128 a[0:3], v2 offset:32768
ds_read_b128 a[4:7], v3 offset:32768
v_mfma_f32_16x16x32_bf16 v[52:55], a[128:131], a[80:83], v[52:55]
s_lshl_b32 s85, s85, 2
ds_read_b64_tr_b16 a[140:141], v23 offset:16384
v_mfma_f32_16x16x32_bf16 v[52:55], a[132:135], a[84:87], v[52:55]
s_add_u32 s85, s85, s3
v_mfma_f32_16x16x32_bf16 v[60:63], a[128:131], a[88:91], v[60:63]
s_mul_i32 s82, s85, 4224
ds_read_b64_tr_b16 a[142:143], v23 offset:18432
v_add_u32 v23, 32768, v23
v_mfma_f32_16x16x32_bf16 v[60:63], a[132:135], a[92:95], v[60:63]
s_add_u32 s82, s82, 83886208
v_mfma_f32_16x16x32_bf16 v[68:71], a[128:131], a[96:99], v[68:71]
s_lshl_b32 s83, s85, 12
ds_read_b128 a[8:11], v2 offset:34816
v_mfma_f32_16x16x32_bf16 v[68:71], a[132:135], a[100:103], v[68:71]
s_mul_i32 s84, s3, 21248
v_mfma_f32_16x16x32_bf16 v[76:79], a[128:131], a[104:107], v[76:79]
s_add_u32 s84, s84, 46080
ds_read_b128 a[12:15], v3 offset:34816
v_mfma_f32_16x16x32_bf16 v[76:79], a[132:135], a[108:111], v[76:79]
s_mov_b64 s[60:61], s[72:73]
ds_read_b128 a[16:19], v2 offset:36864
v_mfma_f32_16x16x32_bf16 v[84:87], a[128:131], a[112:115], v[84:87]
s_mov_b32 s62, 1835008
ds_read_b128 a[20:23], v3 offset:36864
v_mfma_f32_16x16x32_bf16 v[84:87], a[132:135], a[116:119], v[84:87]
v_mfma_f32_16x16x32_bf16 v[92:95], a[128:131], a[120:123], v[92:95]
ds_read_b128 a[24:27], v2 offset:38912
v_mfma_f32_16x16x32_bf16 v[92:95], a[132:135], a[124:127], v[92:95]
s_waitcnt lgkmcnt(9)
v_mfma_f32_16x16x32_bf16 v[100:103], a[136:139], a[64:67], v[100:103]
s_waitcnt lgkmcnt(5)
ds_read_b64_tr_b16 a[128:129], v24 offset:0
v_mfma_f32_16x16x32_bf16 v[100:103], a[140:143], a[68:71], v[100:103]
v_mfma_f32_16x16x32_bf16 v[108:111], a[136:139], a[72:75], v[108:111]
ds_read_b64_tr_b16 a[130:131], v24 offset:2048
v_mfma_f32_16x16x32_bf16 v[108:111], a[140:143], a[76:79], v[108:111]
ds_read_b128 a[28:31], v3 offset:38912
v_mfma_f32_16x16x32_bf16 v[116:119], a[136:139], a[80:83], v[116:119]
ds_read_b64_tr_b16 a[132:133], v24 offset:16384
v_mfma_f32_16x16x32_bf16 v[116:119], a[140:143], a[84:87], v[116:119]
v_mfma_f32_16x16x32_bf16 v[124:127], a[136:139], a[88:91], v[124:127]
ds_read_b64_tr_b16 a[134:135], v24 offset:18432
v_add_u32 v24, 32768, v24
v_mfma_f32_16x16x32_bf16 v[124:127], a[140:143], a[92:95], v[124:127]
v_mfma_f32_16x16x32_bf16 v[132:135], a[136:139], a[96:99], v[132:135]
ds_read_b128 a[32:35], v2 offset:40960
v_mfma_f32_16x16x32_bf16 v[132:135], a[140:143], a[100:103], v[132:135]
v_mfma_f32_16x16x32_bf16 v[140:143], a[136:139], a[104:107], v[140:143]
ds_read_b128 a[36:39], v3 offset:40960
v_mfma_f32_16x16x32_bf16 v[140:143], a[140:143], a[108:111], v[140:143]
ds_read_b128 a[40:43], v2 offset:43008
v_mfma_f32_16x16x32_bf16 v[148:151], a[136:139], a[112:115], v[148:151]
ds_read_b128 a[44:47], v3 offset:43008
v_mfma_f32_16x16x32_bf16 v[148:151], a[140:143], a[116:119], v[148:151]
v_mfma_f32_16x16x32_bf16 v[156:159], a[136:139], a[120:123], v[156:159]
ds_read_b128 a[48:51], v2 offset:45056
v_mfma_f32_16x16x32_bf16 v[156:159], a[140:143], a[124:127], v[156:159]
s_waitcnt lgkmcnt(8)
v_mfma_f32_16x16x32_bf16 v[164:167], a[128:131], a[64:67], v[164:167]
s_waitcnt lgkmcnt(5)
ds_read_b64_tr_b16 a[136:137], v25 offset:0
v_mfma_f32_16x16x32_bf16 v[164:167], a[132:135], a[68:71], v[164:167]
v_mfma_f32_16x16x32_bf16 v[172:175], a[128:131], a[72:75], v[172:175]
ds_read_b64_tr_b16 a[138:139], v25 offset:2048
v_mfma_f32_16x16x32_bf16 v[172:175], a[132:135], a[76:79], v[172:175]
ds_read_b128 a[52:55], v3 offset:45056
v_mfma_f32_16x16x32_bf16 v[180:183], a[128:131], a[80:83], v[180:183]
ds_read_b64_tr_b16 a[140:141], v25 offset:16384
v_mfma_f32_16x16x32_bf16 v[180:183], a[132:135], a[84:87], v[180:183]
v_mfma_f32_16x16x32_bf16 v[188:191], a[128:131], a[88:91], v[188:191]
ds_read_b64_tr_b16 a[142:143], v25 offset:18432
v_add_u32 v25, 32768, v25
v_mfma_f32_16x16x32_bf16 v[188:191], a[132:135], a[92:95], v[188:191]
v_mfma_f32_16x16x32_bf16 v[196:199], a[128:131], a[96:99], v[196:199]
ds_read_b128 a[56:59], v2 offset:47104
v_mfma_f32_16x16x32_bf16 v[196:199], a[132:135], a[100:103], v[196:199]
v_mfma_f32_16x16x32_bf16 v[204:207], a[128:131], a[104:107], v[204:207]
ds_read_b128 a[60:63], v3 offset:47104
v_mfma_f32_16x16x32_bf16 v[204:207], a[132:135], a[108:111], v[204:207]
v_mfma_f32_16x16x32_bf16 v[212:215], a[128:131], a[112:115], v[212:215]
v_mfma_f32_16x16x32_bf16 v[212:215], a[132:135], a[116:119], v[212:215]
v_mfma_f32_16x16x32_bf16 v[220:223], a[128:131], a[120:123], v[220:223]
v_mfma_f32_16x16x32_bf16 v[220:223], a[132:135], a[124:127], v[220:223]
s_waitcnt vmcnt(0) lgkmcnt(0)
s_barrier
v_mfma_f32_16x16x32_bf16 v[224:227], a[136:139], a[64:67], v[224:227]
ds_read_b64_tr_b16 a[128:129], v22 offset:0
v_mfma_f32_16x16x32_bf16 v[224:227], a[140:143], a[68:71], v[224:227]
buffer_store_dword v27, v26, s[4:7], s66 offen sc1
v_mfma_f32_16x16x32_bf16 v[228:231], a[136:139], a[72:75], v[228:231]
ds_read_b64_tr_b16 a[130:131], v22 offset:2048
v_mfma_f32_16x16x32_bf16 v[228:231], a[140:143], a[76:79], v[228:231]
v_mfma_f32_16x16x32_bf16 v[232:235], a[136:139], a[80:83], v[232:235]
ds_read_b64_tr_b16 a[132:133], v22 offset:16384
v_mfma_f32_16x16x32_bf16 v[232:235], a[140:143], a[84:87], v[232:235]
v_mfma_f32_16x16x32_bf16 v[236:239], a[136:139], a[88:91], v[236:239]
ds_read_b64_tr_b16 a[134:135], v22 offset:18432
v_mfma_f32_16x16x32_bf16 v[236:239], a[140:143], a[92:95], v[236:239]
v_mfma_f32_16x16x32_bf16 v[240:243], a[136:139], a[96:99], v[240:243]
v_mfma_f32_16x16x32_bf16 v[240:243], a[140:143], a[100:103], v[240:243]
v_mfma_f32_16x16x32_bf16 v[244:247], a[136:139], a[104:107], v[244:247]
v_mfma_f32_16x16x32_bf16 v[244:247], a[140:143], a[108:111], v[244:247]
v_mfma_f32_16x16x32_bf16 v[248:251], a[136:139], a[112:115], v[248:251]
v_mfma_f32_16x16x32_bf16 v[248:251], a[140:143], a[116:119], v[248:251]
v_mfma_f32_16x16x32_bf16 v[252:255], a[136:139], a[120:123], v[252:255]
v_mfma_f32_16x16x32_bf16 v[252:255], a[140:143], a[124:127], v[252:255]
s_waitcnt lgkmcnt(2)
v_mfma_f32_16x16x32_bf16 v[36:39], a[128:131], a[0:3], v[36:39]
s_waitcnt lgkmcnt(0)
ds_read_b64_tr_b16 a[136:137], v23 offset:0
v_lshrrev_b32 v9, 4, v1
v_mfma_f32_16x16x32_bf16 v[36:39], a[132:135], a[4:7], v[36:39]
s_add_u32 m0, s84, 17152
v_and_b32 v10, 15, v9
v_lshrrev_b32 v11, 4, v9
v_mfma_f32_16x16x32_bf16 v[44:47], a[128:131], a[8:11], v[44:47]
ds_read_b64_tr_b16 a[138:139], v23 offset:2048
v_lshrrev_b32 v12, 2, v10
v_mfma_f32_16x16x32_bf16 v[44:47], a[132:135], a[12:15], v[44:47]
buffer_load_dwordx4 v1, s[60:63], s83 offen offset:0 lds
v_mfma_f32_16x16x32_bf16 v[52:55], a[128:131], a[16:19], v[52:55]
ds_read_b64_tr_b16 a[140:141], v23 offset:16384
v_mul_u32_u24 v12, 4160, v12
v_mfma_f32_16x16x32_bf16 v[52:55], a[132:135], a[20:23], v[52:55]
buffer_load_dwordx4 v1, s[60:63], s83 offen offset:1024 lds
v_mfma_f32_16x16x32_bf16 v[60:63], a[128:131], a[24:27], v[60:63]
ds_read_b64_tr_b16 a[142:143], v23 offset:18432
v_and_b32 v13, 3, v9
v_mfma_f32_16x16x32_bf16 v[60:63], a[132:135], a[28:31], v[60:63]
buffer_load_dwordx4 v1, s[60:63], s83 offen offset:2048 lds
v_mfma_f32_16x16x32_bf16 v[68:71], a[128:131], a[32:35], v[68:71]
buffer_load_dwordx4 v1, s[60:63], s83 offen offset:3072 lds
v_mfma_f32_16x16x32_bf16 v[68:71], a[132:135], a[36:39], v[68:71]
s_add_u32 m0, s84, 64
v_lshl_add_u32 v12, v13, 3, v12
v_lshlrev_b32 v13, 4, v11
v_mfma_f32_16x16x32_bf16 v[76:79], a[128:131], a[40:43], v[76:79]
buffer_load_dwordx4 v1, s[4:7], s82 offen offset:0 sc1 lds
v_mfma_f32_16x16x32_bf16 v[76:79], a[132:135], a[44:47], v[76:79]
buffer_load_dwordx4 v1, s[4:7], s82 offen offset:1024 sc1 lds
v_mfma_f32_16x16x32_bf16 v[84:87], a[128:131], a[48:51], v[84:87]
buffer_load_dwordx4 v1, s[4:7], s82 offen offset:2048 sc1 lds
v_mfma_f32_16x16x32_bf16 v[84:87], a[132:135], a[52:55], v[84:87]
buffer_load_dwordx4 v1, s[4:7], s82 offen offset:3072 sc1 lds
v_mfma_f32_16x16x32_bf16 v[92:95], a[128:131], a[56:59], v[92:95]
s_add_u32 s82, s82, 2097152
v_sub_u32 v12, v12, v13
v_add_u32 v12, 88, v12
v_mfma_f32_16x16x32_bf16 v[92:95], a[132:135], a[60:63], v[92:95]
s_waitcnt lgkmcnt(2)
v_add_u32 v16, s84, v12
v_lshl_add_u32 v12, v10, 5, v13
v_mfma_f32_16x16x32_bf16 v[100:103], a[136:139], a[0:3], v[100:103]
s_waitcnt lgkmcnt(0)
ds_read_b64_tr_b16 a[128:129], v24 offset:0
v_add_u32 v12, 16672, v12
v_mfma_f32_16x16x32_bf16 v[100:103], a[140:143], a[4:7], v[100:103]
s_add_u32 m0, s84, 4224
v_add_u32 v17, s84, v12
v_lshlrev_b32 v12, 5, v10
v_mfma_f32_16x16x32_bf16 v[108:111], a[136:139], a[8:11], v[108:111]
ds_read_b64_tr_b16 a[130:131], v24 offset:2048
v_lshl_add_u32 v8, v11, 3, v12
v_mfma_f32_16x16x32_bf16 v[108:111], a[140:143], a[12:15], v[108:111]
buffer_load_dwordx4 v1, s[4:7], s82 offen offset:0 sc1 lds
v_mfma_f32_16x16x32_bf16 v[116:119], a[136:139], a[16:19], v[116:119]
ds_read_b64_tr_b16 a[132:133], v24 offset:16384
v_add3_u32 v18, s84, 64, v8
v_mfma_f32_16x16x32_bf16 v[116:119], a[140:143], a[20:23], v[116:119]
buffer_load_dwordx4 v1, s[4:7], s82 offen offset:1024 sc1 lds
v_mfma_f32_16x16x32_bf16 v[124:127], a[136:139], a[24:27], v[124:127]
ds_read_b64_tr_b16 a[134:135], v24 offset:18432
v_mov_b32 v19, 0
v_mfma_f32_16x16x32_bf16 v[124:127], a[140:143], a[28:31], v[124:127]
buffer_load_dwordx4 v1, s[4:7], s82 offen offset:2048 sc1 lds
v_mfma_f32_16x16x32_bf16 v[132:135], a[136:139], a[32:35], v[132:135]
buffer_load_dwordx4 v1, s[4:7], s82 offen offset:3072 sc1 lds
v_mfma_f32_16x16x32_bf16 v[132:135], a[140:143], a[36:39], v[132:135]
s_add_u32 s82, s82, 4292870140
v_mov_b32 v12, 0
v_mov_b32 v13, 0
v_mfma_f32_16x16x32_bf16 v[140:143], a[136:139], a[40:43], v[140:143]
s_add_u32 m0, s84, 8384
v_lshl_add_u32 v14, v9, 3, s84
v_mfma_f32_16x16x32_bf16 v[140:143], a[140:143], a[44:47], v[140:143]
buffer_load_dwordx4 v1, s[4:7], s82 offen offset:0 sc1 lds
v_mfma_f32_16x16x32_bf16 v[148:151], a[136:139], a[48:51], v[148:151]
buffer_load_dwordx4 v1, s[4:7], s82 offen offset:1024 sc1 lds
v_mfma_f32_16x16x32_bf16 v[148:151], a[140:143], a[52:55], v[148:151]
buffer_load_dwordx4 v1, s[4:7], s82 offen offset:2048 sc1 lds
v_mfma_f32_16x16x32_bf16 v[156:159], a[136:139], a[56:59], v[156:159]
buffer_load_dwordx4 v1, s[4:7], s82 offen offset:3072 sc1 lds
v_mfma_f32_16x16x32_bf16 v[156:159], a[140:143], a[60:63], v[156:159]
s_waitcnt lgkmcnt(2)
ds_write_b64 v14, v[12:13] offset:16640
v_mul_u32_u24 v14, 4160, v11
v_mfma_f32_16x16x32_bf16 v[164:167], a[128:131], a[0:3], v[164:167]
s_waitcnt lgkmcnt(1)
ds_read_b64_tr_b16 a[136:137], v25 offset:0
v_lshl_add_u32 v14, v10, 2, v14
v_mfma_f32_16x16x32_bf16 v[164:167], a[132:135], a[4:7], v[164:167]
s_add_u32 s82, s82, 2097152
v_add_u32 v14, s84, v14
v_mfma_f32_16x16x32_bf16 v[172:175], a[128:131], a[8:11], v[172:175]
s_add_u32 m0, s84, 12544
ds_read_b64_tr_b16 a[138:139], v25 offset:2048
v_mfma_f32_16x16x32_bf16 v[172:175], a[132:135], a[12:15], v[172:175]
buffer_load_dwordx4 v1, s[4:7], s82 offen offset:0 sc1 lds
v_mfma_f32_16x16x32_bf16 v[180:183], a[128:131], a[16:19], v[180:183]
ds_read_b64_tr_b16 a[140:141], v25 offset:16384
v_mfma_f32_16x16x32_bf16 v[180:183], a[132:135], a[20:23], v[180:183]
buffer_load_dwordx4 v1, s[4:7], s82 offen offset:1024 sc1 lds
v_mfma_f32_16x16x32_bf16 v[188:191], a[128:131], a[24:27], v[188:191]
ds_read_b64_tr_b16 a[142:143], v25 offset:18432
v_mfma_f32_16x16x32_bf16 v[188:191], a[132:135], a[28:31], v[188:191]
buffer_load_dwordx4 v1, s[4:7], s82 offen offset:2048 sc1 lds
v_mfma_f32_16x16x32_bf16 v[196:199], a[128:131], a[32:35], v[196:199]
buffer_load_dwordx4 v1, s[4:7], s82 offen offset:3072 sc1 lds
v_mfma_f32_16x16x32_bf16 v[196:199], a[132:135], a[36:39], v[196:199]
ds_write_b32 v14, v12
v_lshrrev_b32 v30, 6, v0
v_mfma_f32_16x16x32_bf16 v[204:207], a[128:131], a[40:43], v[204:207]
v_lshl_add_u32 v28, v30, 11, v1
v_add_u32 v29, 0x20000, v28
v_mfma_f32_16x16x32_bf16 v[204:207], a[132:135], a[44:47], v[204:207]
v_lshl_add_u32 v30, v30, 13, v1
v_add_u32 v31, 0x20000, v30
v_mfma_f32_16x16x32_bf16 v[212:215], a[128:131], a[48:51], v[212:215]
v_mul_f32 v36, s68, v36
v_mul_f32 v37, s68, v37
v_mfma_f32_16x16x32_bf16 v[212:215], a[132:135], a[52:55], v[212:215]
v_mul_f32 v38, s68, v38
v_mul_f32 v39, s68, v39
v_mfma_f32_16x16x32_bf16 v[220:223], a[128:131], a[56:59], v[220:223]
v_mul_f32 v100, s68, v100
v_mul_f32 v101, s68, v101
v_mfma_f32_16x16x32_bf16 v[220:223], a[132:135], a[60:63], v[220:223]
s_waitcnt lgkmcnt(2)
s_waitcnt lgkmcnt(0)
s_barrier
v_mfma_f32_16x16x32_bf16 v[224:227], a[136:139], a[0:3], v[224:227]
v_mul_f32 v102, s68, v102
v_mul_f32 v103, s68, v103
v_mfma_f32_16x16x32_bf16 v[224:227], a[140:143], a[4:7], v[224:227]
v_cvt_pk_bf16_f32 v36, v36, v37
v_cvt_pk_bf16_f32 v37, v38, v39
v_mfma_f32_16x16x32_bf16 v[228:231], a[136:139], a[8:11], v[228:231]
v_cvt_pk_bf16_f32 v38, v100, v101
v_cvt_pk_bf16_f32 v39, v102, v103
v_mfma_f32_16x16x32_bf16 v[228:231], a[140:143], a[12:15], v[228:231]
v_mul_f32 v44, s68, v44
v_mul_f32 v45, s68, v45
v_mfma_f32_16x16x32_bf16 v[232:235], a[136:139], a[16:19], v[232:235]
v_mul_f32 v46, s68, v46
v_mul_f32 v47, s68, v47
v_mfma_f32_16x16x32_bf16 v[232:235], a[140:143], a[20:23], v[232:235]
v_mul_f32 v108, s68, v108
v_mul_f32 v109, s68, v109
v_mfma_f32_16x16x32_bf16 v[236:239], a[136:139], a[24:27], v[236:239]
v_mul_f32 v110, s68, v110
v_mul_f32 v111, s68, v111
v_mfma_f32_16x16x32_bf16 v[236:239], a[140:143], a[28:31], v[236:239]
v_cvt_pk_bf16_f32 v44, v44, v45
v_cvt_pk_bf16_f32 v45, v46, v47
v_mfma_f32_16x16x32_bf16 v[240:243], a[136:139], a[32:35], v[240:243]
v_cvt_pk_bf16_f32 v46, v108, v109
v_cvt_pk_bf16_f32 v47, v110, v111
v_mfma_f32_16x16x32_bf16 v[240:243], a[140:143], a[36:39], v[240:243]
v_mul_f32 v52, s68, v52
v_mul_f32 v53, s68, v53
v_mfma_f32_16x16x32_bf16 v[244:247], a[136:139], a[40:43], v[244:247]
v_mul_f32 v54, s68, v54
v_mul_f32 v55, s68, v55
v_mfma_f32_16x16x32_bf16 v[244:247], a[140:143], a[44:47], v[244:247]
v_mul_f32 v116, s68, v116
v_mul_f32 v117, s68, v117
v_mfma_f32_16x16x32_bf16 v[248:251], a[136:139], a[48:51], v[248:251]
v_mul_f32 v118, s68, v118
v_mul_f32 v119, s68, v119
v_mfma_f32_16x16x32_bf16 v[248:251], a[140:143], a[52:55], v[248:251]
v_cvt_pk_bf16_f32 v52, v52, v53
v_cvt_pk_bf16_f32 v53, v54, v55
v_mfma_f32_16x16x32_bf16 v[252:255], a[136:139], a[56:59], v[252:255]
v_cvt_pk_bf16_f32 v54, v116, v117
v_cvt_pk_bf16_f32 v55, v118, v119
v_mfma_f32_16x16x32_bf16 v[252:255], a[140:143], a[60:63], v[252:255]
s_mov_b64 s[60:61], s[74:75]
s_mov_b32 s62, 896
s_lshl_b32 s79, s85, 1
buffer_load_short_d16_hi v19, off, s[60:63], s79
s_lshl_b32 s83, s85, 12
s_add_u32 s83, s83, 88080384
ds_write_b128 v28, v[36:39] offset:0
ds_write_b128 v28, v[44:47] offset:8192
ds_write_b128 v28, v[52:55] offset:16384
v_pk_mul_f32 v[60:61], v[60:61], s[68:69]
v_pk_mul_f32 v[62:63], v[62:63], s[68:69]
v_pk_mul_f32 v[124:125], v[124:125], s[68:69]
v_pk_mul_f32 v[126:127], v[126:127], s[68:69]
v_cvt_pk_bf16_f32 v60, v60, v61
v_cvt_pk_bf16_f32 v61, v62, v63
v_cvt_pk_bf16_f32 v62, v124, v125
v_cvt_pk_bf16_f32 v63, v126, v127
ds_write_b128 v28, v[60:63] offset:24576
v_pk_mul_f32 v[68:69], v[68:69], s[68:69]
v_pk_mul_f32 v[70:71], v[70:71], s[68:69]
v_pk_mul_f32 v[132:133], v[132:133], s[68:69]
v_pk_mul_f32 v[134:135], v[134:135], s[68:69]
v_cvt_pk_bf16_f32 v68, v68, v69
v_cvt_pk_bf16_f32 v69, v70, v71
v_cvt_pk_bf16_f32 v70, v132, v133
v_cvt_pk_bf16_f32 v71, v134, v135
ds_write_b128 v29, v[68:71] offset:0
v_pk_mul_f32 v[76:77], v[76:77], s[68:69]
v_pk_mul_f32 v[78:79], v[78:79], s[68:69]
v_pk_mul_f32 v[140:141], v[140:141], s[68:69]
v_pk_mul_f32 v[142:143], v[142:143], s[68:69]
v_cvt_pk_bf16_f32 v76, v76, v77
v_cvt_pk_bf16_f32 v77, v78, v79
v_cvt_pk_bf16_f32 v78, v140, v141
v_cvt_pk_bf16_f32 v79, v142, v143
ds_write_b128 v29, v[76:79] offset:8192
v_pk_mul_f32 v[84:85], v[84:85], s[68:69]
v_pk_mul_f32 v[86:87], v[86:87], s[68:69]
v_pk_mul_f32 v[148:149], v[148:149], s[68:69]
v_pk_mul_f32 v[150:151], v[150:151], s[68:69]
v_cvt_pk_bf16_f32 v84, v84, v85
v_cvt_pk_bf16_f32 v85, v86, v87
v_cvt_pk_bf16_f32 v86, v148, v149
v_cvt_pk_bf16_f32 v87, v150, v151
ds_write_b128 v29, v[84:87] offset:16384
v_pk_mul_f32 v[92:93], v[92:93], s[68:69]
v_pk_mul_f32 v[94:95], v[94:95], s[68:69]
v_pk_mul_f32 v[156:157], v[156:157], s[68:69]
v_pk_mul_f32 v[158:159], v[158:159], s[68:69]
v_cvt_pk_bf16_f32 v92, v92, v93
v_cvt_pk_bf16_f32 v93, v94, v95
v_cvt_pk_bf16_f32 v94, v156, v157
v_cvt_pk_bf16_f32 v95, v158, v159
ds_write_b128 v29, v[92:95] offset:24576
v_pk_mul_f32 v[164:165], v[164:165], s[68:69]
v_pk_mul_f32 v[166:167], v[166:167], s[68:69]
v_pk_mul_f32 v[224:225], v[224:225], s[68:69]
v_pk_mul_f32 v[226:227], v[226:227], s[68:69]
v_cvt_pk_bf16_f32 v164, v164, v165
v_cvt_pk_bf16_f32 v165, v166, v167
v_cvt_pk_bf16_f32 v166, v224, v225
v_cvt_pk_bf16_f32 v167, v226, v227
ds_write_b128 v28, v[164:167] offset:1024
v_pk_mul_f32 v[172:173], v[172:173], s[68:69]
v_pk_mul_f32 v[174:175], v[174:175], s[68:69]
v_pk_mul_f32 v[228:229], v[228:229], s[68:69]
v_pk_mul_f32 v[230:231], v[230:231], s[68:69]
v_cvt_pk_bf16_f32 v172, v172, v173
v_cvt_pk_bf16_f32 v173, v174, v175
v_cvt_pk_bf16_f32 v174, v228, v229
v_cvt_pk_bf16_f32 v175, v230, v231
ds_write_b128 v28, v[172:175] offset:9216
v_pk_mul_f32 v[180:181], v[180:181], s[68:69]
v_pk_mul_f32 v[182:183], v[182:183], s[68:69]
v_pk_mul_f32 v[232:233], v[232:233], s[68:69]
v_pk_mul_f32 v[234:235], v[234:235], s[68:69]
v_cvt_pk_bf16_f32 v180, v180, v181
v_cvt_pk_bf16_f32 v181, v182, v183
v_cvt_pk_bf16_f32 v182, v232, v233
v_cvt_pk_bf16_f32 v183, v234, v235
ds_write_b128 v28, v[180:183] offset:17408
v_pk_mul_f32 v[188:189], v[188:189], s[68:69]
v_pk_mul_f32 v[190:191], v[190:191], s[68:69]
v_pk_mul_f32 v[236:237], v[236:237], s[68:69]
v_pk_mul_f32 v[238:239], v[238:239], s[68:69]
v_cvt_pk_bf16_f32 v188, v188, v189
v_cvt_pk_bf16_f32 v189, v190, v191
v_cvt_pk_bf16_f32 v190, v236, v237
v_cvt_pk_bf16_f32 v191, v238, v239
ds_write_b128 v28, v[188:191] offset:25600
v_pk_mul_f32 v[196:197], v[196:197], s[68:69]
v_pk_mul_f32 v[198:199], v[198:199], s[68:69]
v_pk_mul_f32 v[240:241], v[240:241], s[68:69]
v_pk_mul_f32 v[242:243], v[242:243], s[68:69]
v_cvt_pk_bf16_f32 v196, v196, v197
v_cvt_pk_bf16_f32 v197, v198, v199
v_cvt_pk_bf16_f32 v198, v240, v241
v_cvt_pk_bf16_f32 v199, v242, v243
ds_write_b128 v29, v[196:199] offset:1024
v_pk_mul_f32 v[204:205], v[204:205], s[68:69]
v_pk_mul_f32 v[206:207], v[206:207], s[68:69]
v_pk_mul_f32 v[244:245], v[244:245], s[68:69]
v_pk_mul_f32 v[246:247], v[246:247], s[68:69]
v_cvt_pk_bf16_f32 v204, v204, v205
v_cvt_pk_bf16_f32 v205, v206, v207
v_cvt_pk_bf16_f32 v206, v244, v245
v_cvt_pk_bf16_f32 v207, v246, v247
ds_write_b128 v29, v[204:207] offset:9216
v_pk_mul_f32 v[212:213], v[212:213], s[68:69]
v_pk_mul_f32 v[214:215], v[214:215], s[68:69]
v_pk_mul_f32 v[248:249], v[248:249], s[68:69]
v_pk_mul_f32 v[250:251], v[250:251], s[68:69]
v_cvt_pk_bf16_f32 v212, v212, v213
v_cvt_pk_bf16_f32 v213, v214, v215
v_cvt_pk_bf16_f32 v214, v248, v249
v_cvt_pk_bf16_f32 v215, v250, v251
ds_write_b128 v29, v[212:215] offset:17408
v_pk_mul_f32 v[220:221], v[220:221], s[68:69]
v_pk_mul_f32 v[222:223], v[222:223], s[68:69]
v_pk_mul_f32 v[252:253], v[252:253], s[68:69]
v_pk_mul_f32 v[254:255], v[254:255], s[68:69]
v_cvt_pk_bf16_f32 v220, v220, v221
v_cvt_pk_bf16_f32 v221, v222, v223
v_cvt_pk_bf16_f32 v222, v252, v253
v_cvt_pk_bf16_f32 v223, v254, v255
ds_write_b128 v29, v[220:223] offset:25600
s_waitcnt vmcnt(1) lgkmcnt(0)
s_barrier
buffer_load_dword v21, v20, s[4:7], s70 offen sc1
ds_read_b64_tr_b16 a[64:65], v16 offset:8
ds_read_b64_tr_b16 a[66:67], v16 offset:0
ds_read_b128 a[96:99], v17 offset:448
ds_read_b64_tr_b16 a[68:69], v16 offset:520
ds_read_b64_tr_b16 a[70:71], v16 offset:512
ds_read_b128 a[100:103], v17 offset:960
ds_read_b64_tr_b16 a[72:73], v16 offset:1032
ds_read_b64_tr_b16 a[74:75], v16 offset:1024
ds_read_b128 a[104:107], v17 offset:1472
ds_read_b64_tr_b16 a[76:77], v16 offset:1544
ds_read_b64_tr_b16 a[78:79], v16 offset:1536
ds_read_b128 a[108:111], v17 offset:1984
ds_read_b64_tr_b16 a[80:81], v16 offset:2056
ds_read_b64_tr_b16 a[82:83], v16 offset:2048
ds_read_b128 a[112:115], v17 offset:2496
ds_read_b64_tr_b16 a[84:85], v16 offset:2568
ds_read_b64_tr_b16 a[86:87], v16 offset:2560
ds_read_b128 a[116:119], v17 offset:3008
ds_read_b64_tr_b16 a[88:89], v16 offset:3080
ds_read_b64_tr_b16 a[90:91], v16 offset:3072
ds_read_b128 a[120:123], v17 offset:3520
ds_read_b64_tr_b16 a[92:93], v16 offset:3592
ds_read_b64_tr_b16 a[94:95], v16 offset:3584
ds_read_b128 a[124:127], v17 offset:4032
s_waitcnt lgkmcnt(15)
v_mfma_f32_16x16x32_bf16 v[96:99], a[64:67], a[96:99], 0
s_waitcnt lgkmcnt(12)
s_lshl_b32 s18, s3, 13
ds_read_b64_tr_b16 a[128:129], v16 offset:72
v_mov_b32 v24, 0
v_mfma_f32_16x16x32_bf16 v[100:103], a[64:67], a[100:103], 0
s_lshl_b32 s30, s20, 20
ds_read_b64_tr_b16 a[130:131], v16 offset:64
v_lshrrev_b32 v3, 6, v0
v_mfma_f32_16x16x32_bf16 v[100:103], a[68:71], a[96:99], v[100:103]
s_add_u32 s30, s30, s18
ds_read_b128 a[160:163], v17 offset:384
v_and_b32 v4, 63, v0
v_mfma_f32_16x16x32_bf16 v[104:107], a[64:67], a[104:107], 0
s_lshl_b32 s22, s21, 1
ds_read_b128 a[192:195], v30 offset:0
v_add_u32 v2, 0x10000, v1
v_mfma_f32_16x16x32_bf16 v[104:107], a[68:71], a[100:103], v[104:107]
s_mov_b32 s8, s30
ds_read_b64_tr_b16 a[132:133], v16 offset:584
v_and_b32 v5, 15, v4
v_mfma_f32_16x16x32_bf16 v[104:107], a[72:75], a[96:99], v[104:107]
s_sub_u32 s9, 12, s22
ds_read_b64_tr_b16 a[134:135], v16 offset:576
v_lshrrev_b32 v6, 4, v4
v_mfma_f32_16x16x32_bf16 v[108:111], a[64:67], a[108:111], 0
s_add_u32 s11, s22, 2
ds_read_b128 a[164:167], v17 offset:896
v_lshlrev_b32 v6, 2, v6
v_mfma_f32_16x16x32_bf16 v[108:111], a[68:71], a[104:107], v[108:111]
s_add_u32 s14, s30, 16777216
ds_read_b128 a[196:199], v30 offset:1024
v_sub_u32 v5, v5, v6
v_mfma_f32_16x16x32_bf16 v[108:111], a[72:75], a[100:103], v[108:111]
s_sub_u32 s19, 6, s21
ds_read_b64_tr_b16 a[136:137], v16 offset:1096
v_lshl_add_u32 v5, v3, 4, v5
v_mfma_f32_16x16x32_bf16 v[108:111], a[76:79], a[96:99], v[108:111]
s_waitcnt lgkmcnt(15)
s_sub_u32 s29, 15, s21
ds_read_b64_tr_b16 a[138:139], v16 offset:1088
v_cmp_gt_i32 s[32:33], 0, v5
v_mfma_f32_16x16x32_bf16 v[112:115], a[64:67], a[112:115], 0
s_cmp_lt_u32 s21, 6
ds_read_b128 a[168:171], v17 offset:1408
v_cmp_gt_i32 s[34:35], 1, v5
v_mfma_f32_16x16x32_bf16 v[112:115], a[68:71], a[108:111], v[112:115]
s_cselect_b32 s10, s30, 3221225472
ds_read_b128 a[200:203], v30 offset:2048
v_cmp_gt_i32 s[36:37], 2, v5
v_mfma_f32_16x16x32_bf16 v[112:115], a[72:75], a[104:107], v[112:115]
s_cselect_b32 s14, s14, 3221225472
ds_read_b64_tr_b16 a[140:141], v16 offset:1608
v_cmp_gt_i32 s[38:39], 3, v5
v_mfma_f32_16x16x32_bf16 v[112:115], a[76:79], a[100:103], v[112:115]
s_cselect_b32 s9, s9, s11
ds_read_b64_tr_b16 a[142:143], v16 offset:1600
v_cmp_gt_i32 s[40:41], 16, v5
v_mfma_f32_16x16x32_bf16 v[112:115], a[80:83], a[96:99], v[112:115]
s_cselect_b32 s19, s19, s21
ds_read_b128 a[172:175], v17 offset:1920
v_cmp_gt_i32 s[42:43], 17, v5
v_mfma_f32_16x16x32_bf16 v[116:119], a[64:67], a[116:119], 0
s_cselect_b32 s29, s29, s21
ds_read_b128 a[204:207], v30 offset:3072
v_cmp_gt_i32 s[44:45], 18, v5
v_mfma_f32_16x16x32_bf16 v[116:119], a[68:71], a[112:115], v[116:119]
s_cselect_b32 s24, 2, 0
ds_read_b64_tr_b16 a[144:145], v16 offset:2120
v_cmp_gt_i32 s[46:47], 19, v5
v_mfma_f32_16x16x32_bf16 v[116:119], a[72:75], a[108:111], v[116:119]
s_add_u32 s12, s8, 16777216
ds_read_b64_tr_b16 a[146:147], v16 offset:2112
v_cmp_gt_i32 s[48:49], 32, v5
v_mfma_f32_16x16x32_bf16 v[116:119], a[76:79], a[104:107], v[116:119]
s_mov_b32 s13, s9
ds_read_b128 a[176:179], v17 offset:2432
v_cmp_gt_i32 s[50:51], 33, v5
v_mfma_f32_16x16x32_bf16 v[116:119], a[80:83], a[100:103], v[116:119]
s_mov_b32 s15, s11
ds_read_b128 a[208:211], v30 offset:4096
v_cmp_gt_i32 s[52:53], 34, v5
v_mfma_f32_16x16x32_bf16 v[116:119], a[84:87], a[96:99], v[116:119]
s_waitcnt lgkmcnt(15)
s_mov_b32 s25, 1266679808
ds_read_b64_tr_b16 a[148:149], v16 offset:2632
v_cmp_gt_i32 s[54:55], 35, v5
v_mfma_f32_16x16x32_bf16 v[120:123], a[64:67], a[120:123], 0
s_lshl_b32 s22, s21, 3
ds_read_b64_tr_b16 a[150:151], v16 offset:2624
v_cmp_gt_i32 s[56:57], 48, v5
v_mfma_f32_16x16x32_bf16 v[120:123], a[68:71], a[116:119], v[120:123]
s_add_u32 s28, s70, s22
ds_read_b128 a[180:183], v17 offset:2944
v_cmp_gt_i32 s[58:59], 49, v5
v_mfma_f32_16x16x32_bf16 v[120:123], a[72:75], a[112:115], v[120:123]
s_add_u32 s28, s28, 6148
ds_read_b128 a[212:215], v30 offset:5120
v_cmp_gt_i32 s[60:61], 50, v5
v_mfma_f32_16x16x32_bf16 v[120:123], a[76:79], a[108:111], v[120:123]
s_lshl_b32 s26, s21, 16
ds_read_b64_tr_b16 a[152:153], v16 offset:3144
v_cmp_gt_i32 s[62:63], 51, v5
v_mfma_f32_16x16x32_bf16 v[120:123], a[80:83], a[104:107], v[120:123]
s_add_u32 s26, s26, s30
ds_read_b64_tr_b16 a[154:155], v16 offset:3136
v_mov_b32 v7, 0xff800000
v_mfma_f32_16x16x32_bf16 v[120:123], a[84:87], a[100:103], v[120:123]
s_add_u32 s26, s26, 33554432
ds_read_b128 a[184:187], v17 offset:3456
v_mov_b32 v6, 1
v_mfma_f32_16x16x32_bf16 v[120:123], a[88:91], a[96:99], v[120:123]
s_lshl_b32 s76, s20, 3
ds_read_b128 a[216:219], v30 offset:6144
v_mov_b32 v5, v26
v_mfma_f32_16x16x32_bf16 v[124:127], a[64:67], a[124:127], 0
s_add_u32 s76, s76, s21
ds_read_b64_tr_b16 a[156:157], v16 offset:3656
v_add_u32 v4, 0x20000, v1
v_mfma_f32_16x16x32_bf16 v[124:127], a[68:71], a[120:123], v[124:127]
s_lshl_b32 s76, s76, 2
ds_read_b64_tr_b16 a[158:159], v16 offset:3648
v_mfma_f32_16x16x32_bf16 v[124:127], a[72:75], a[116:119], v[124:127]
s_add_u32 s76, s76, s3
ds_read_b128 a[188:191], v17 offset:3968
v_mfma_f32_16x16x32_bf16 v[124:127], a[76:79], a[112:115], v[124:127]
s_lshl_b32 s27, s76, 10
ds_read_b128 a[220:223], v30 offset:7168
v_mfma_f32_16x16x32_bf16 v[124:127], a[80:83], a[108:111], v[124:127]
s_add_u32 s27, s27, 75497472
ds_read_b128 a[224:227], v31 offset:0
v_mfma_f32_16x16x32_bf16 v[124:127], a[84:87], a[104:107], v[124:127]
s_lshl_b32 s76, s76, 14
ds_read_b128 a[228:231], v31 offset:1024
v_mfma_f32_16x16x32_bf16 v[124:127], a[88:91], a[100:103], v[124:127]
s_add_u32 s76, s76, 67108864
ds_read_b128 a[232:235], v31 offset:2048
v_mfma_f32_16x16x32_bf16 v[124:127], a[92:95], a[96:99], v[124:127]
s_lshl_b32 s81, s20, 2
ds_read_b128 a[236:239], v31 offset:3072
v_mfma_f32_16x16x32_bf16 v[96:99], a[128:131], a[160:163], v[96:99]
s_waitcnt lgkmcnt(15)
s_add_u32 s81, s81, s3
ds_read_b64_tr_b16 a[64:65], v16 offset:136
v_mfma_f32_16x16x32_bf16 v[100:103], a[128:131], a[164:167], v[100:103]
s_mul_i32 s81, s81, 57344
ds_read_b64_tr_b16 a[66:67], v16 offset:128
v_mfma_f32_16x16x32_bf16 v[100:103], a[132:135], a[160:163], v[100:103]
s_cmp_eq_u32 s24, 1
ds_read_b128 a[96:99], v17 offset:320
v_mfma_f32_16x16x32_bf16 v[104:107], a[128:131], a[168:171], v[104:107]
s_cselect_b32 s80, s28, s70
ds_read_b128 a[240:243], v31 offset:4096
v_mfma_f32_16x16x32_bf16 v[104:107], a[132:135], a[164:167], v[104:107]
s_add_u32 s77, s76, 8192
ds_read_b64_tr_b16 a[68:69], v16 offset:648
v_mfma_f32_16x16x32_bf16 v[104:107], a[136:139], a[160:163], v[104:107]
s_lshl_b32 s71, s2, 2
ds_read_b64_tr_b16 a[70:71], v16 offset:640
v_mfma_f32_16x16x32_bf16 v[108:111], a[128:131], a[172:175], v[108:111]
s_add_u32 s71, s71, 94384128
ds_read_b128 a[100:103], v17 offset:832
v_mfma_f32_16x16x32_bf16 v[108:111], a[132:135], a[168:171], v[108:111]
s_lshl_b32 s78, s29, 16
ds_read_b128 a[244:247], v31 offset:5120
v_mfma_f32_16x16x32_bf16 v[108:111], a[136:139], a[164:167], v[108:111]
s_add_u32 s78, s78, s30
ds_read_b64_tr_b16 a[72:73], v16 offset:1160
v_mfma_f32_16x16x32_bf16 v[108:111], a[140:143], a[160:163], v[108:111]
s_add_u32 s78, s78, 33554432
ds_read_b64_tr_b16 a[74:75], v16 offset:1152
v_mfma_f32_16x16x32_bf16 v[112:115], a[128:131], a[176:179], v[112:115]
s_cmp_eq_u32 s24, 0
ds_read_b128 a[104:107], v17 offset:1344
v_mfma_f32_16x16x32_bf16 v[112:115], a[132:135], a[172:175], v[112:115]
s_cselect_b32 s78, 3221225472, s78
ds_read_b128 a[248:251], v31 offset:6144
v_mfma_f32_16x16x32_bf16 v[112:115], a[136:139], a[168:171], v[112:115]
s_lshl_b32 s22, s21, 3
ds_read_b64_tr_b16 a[76:77], v16 offset:1672
v_mfma_f32_16x16x32_bf16 v[112:115], a[140:143], a[164:167], v[112:115]
s_add_u32 s22, s22, 16384
ds_read_b64_tr_b16 a[78:79], v16 offset:1664
v_mfma_f32_16x16x32_bf16 v[112:115], a[144:147], a[160:163], v[112:115]
s_waitcnt lgkmcnt(15)
ds_read_b128 a[108:111], v17 offset:1856
v_writelane_b32 v15, s22, 63
v_mfma_f32_16x16x32_bf16 v[116:119], a[128:131], a[180:183], v[116:119]
ds_read_b128 a[252:255], v31 offset:7168
v_mov_b32 v25, 0
v_mfma_f32_16x16x32_bf16 v[116:119], a[132:135], a[176:179], v[116:119]
ds_read_b64_tr_b16 a[80:81], v16 offset:2184
v_mov_b32 v128, 0
v_mfma_f32_16x16x32_bf16 v[116:119], a[136:139], a[172:175], v[116:119]
ds_read_b64_tr_b16 a[82:83], v16 offset:2176
v_mov_b32 v129, 0
v_mfma_f32_16x16x32_bf16 v[116:119], a[140:143], a[168:171], v[116:119]
ds_read_b128 a[112:115], v17 offset:2368
v_mov_b32 v130, 0
v_mfma_f32_16x16x32_bf16 v[116:119], a[144:147], a[164:167], v[116:119]
v_mov_b32 v131, 0
v_mov_b32 v132, 0
v_mfma_f32_16x16x32_bf16 v[116:119], a[148:151], a[160:163], v[116:119]
ds_read_b64_tr_b16 a[84:85], v16 offset:2696
v_mov_b32 v133, 0
v_mfma_f32_16x16x32_bf16 v[120:123], a[128:131], a[184:187], v[120:123]
ds_read_b64_tr_b16 a[86:87], v16 offset:2688
v_mov_b32 v134, 0
v_mfma_f32_16x16x32_bf16 v[120:123], a[132:135], a[180:183], v[120:123]
s_waitcnt vmcnt(0) lgkmcnt(5)
s_barrier
ds_read_b128 a[116:119], v17 offset:2880
v_cmp_gt_u32 vcc, 1, v21
v_mfma_f32_16x16x32_bf16 v[120:123], a[136:139], a[176:179], v[120:123]
s_cbranch_vccnz M_kspin2
M_kok2:
v_mov_b32 v135, 0
v_mov_b32 v136, 0
v_mfma_f32_16x16x32_bf16 v[120:123], a[140:143], a[172:175], v[120:123]
s_add_u32 m0, s18, 0
ds_read_b64_tr_b16 a[88:89], v16 offset:3208
v_mov_b32 v137, 0
v_mfma_f32_16x16x32_bf16 v[120:123], a[144:147], a[168:171], v[120:123]
ds_read_b64_tr_b16 a[90:91], v16 offset:3200
v_mov_b32 v138, 0
v_mfma_f32_16x16x32_bf16 v[120:123], a[148:151], a[164:167], v[120:123]
ds_read_b128 a[120:123], v17 offset:3392
v_mov_b32 v139, 0
v_mfma_f32_16x16x32_bf16 v[120:123], a[152:155], a[160:163], v[120:123]
buffer_load_dwordx4 v1, s[4:7], s8 offen offset:0 sc1 lds
v_mfma_f32_16x16x32_bf16 v[124:127], a[128:131], a[188:191], v[124:127]
ds_read_b64_tr_b16 a[92:93], v16 offset:3720
v_mov_b32 v140, 0
v_mfma_f32_16x16x32_bf16 v[124:127], a[132:135], a[184:187], v[124:127]
ds_read_b64_tr_b16 a[94:95], v16 offset:3712
v_mov_b32 v141, 0
v_mfma_f32_16x16x32_bf16 v[124:127], a[136:139], a[180:183], v[124:127]
ds_read_b128 a[124:127], v17 offset:3904
v_mov_b32 v142, 0
v_mfma_f32_16x16x32_bf16 v[124:127], a[140:143], a[176:179], v[124:127]
buffer_load_dwordx4 v1, s[4:7], s8 offen offset:1024 sc1 lds
v_mfma_f32_16x16x32_bf16 v[124:127], a[144:147], a[172:175], v[124:127]
buffer_load_dwordx4 v1, s[4:7], s8 offen offset:2048 sc1 lds
v_mfma_f32_16x16x32_bf16 v[124:127], a[148:151], a[168:171], v[124:127]
buffer_load_dwordx4 v1, s[4:7], s8 offen offset:3072 sc1 lds
v_mfma_f32_16x16x32_bf16 v[124:127], a[152:155], a[164:167], v[124:127]
s_add_u32 s8, s8, 4096
v_mov_b32 v143, 0
v_mov_b32 v144, 0
v_mfma_f32_16x16x32_bf16 v[124:127], a[156:159], a[160:163], v[124:127]
s_add_u32 m0, s18, 4096
v_mov_b32 v145, 0
v_mov_b32 v146, 0
v_mfma_f32_16x16x32_bf16 v[96:99], a[64:67], a[96:99], v[96:99]
ds_read_b64_tr_b16 a[128:129], v16 offset:200
v_mov_b32 v147, 0
v_mfma_f32_16x16x32_bf16 v[100:103], a[64:67], a[100:103], v[100:103]
ds_read_b64_tr_b16 a[130:131], v16 offset:192
v_mov_b32 v148, 0
v_mfma_f32_16x16x32_bf16 v[100:103], a[68:71], a[96:99], v[100:103]
ds_read_b128 a[160:163], v17 offset:256
v_mov_b32 v149, 0
v_mfma_f32_16x16x32_bf16 v[104:107], a[64:67], a[104:107], v[104:107]
buffer_load_dwordx4 v1, s[4:7], s8 offen offset:0 sc1 lds
v_mfma_f32_16x16x32_bf16 v[104:107], a[68:71], a[100:103], v[104:107]
ds_read_b64_tr_b16 a[132:133], v16 offset:712
v_mov_b32 v150, 0
v_mfma_f32_16x16x32_bf16 v[104:107], a[72:75], a[96:99], v[104:107]
ds_read_b64_tr_b16 a[134:135], v16 offset:704
v_mov_b32 v151, 0
v_mfma_f32_16x16x32_bf16 v[108:111], a[64:67], a[108:111], v[108:111]
ds_read_b128 a[164:167], v17 offset:768
v_mov_b32 v152, 0
v_mfma_f32_16x16x32_bf16 v[108:111], a[68:71], a[104:107], v[108:111]
buffer_load_dwordx4 v1, s[4:7], s8 offen offset:1024 sc1 lds
v_mfma_f32_16x16x32_bf16 v[108:111], a[72:75], a[100:103], v[108:111]
ds_read_b64_tr_b16 a[136:137], v16 offset:1224
v_mov_b32 v153, 0
v_mfma_f32_16x16x32_bf16 v[108:111], a[76:79], a[96:99], v[108:111]
s_waitcnt lgkmcnt(15)
ds_read_b64_tr_b16 a[138:139], v16 offset:1216
v_mov_b32 v154, 0
v_mfma_f32_16x16x32_bf16 v[112:115], a[64:67], a[112:115], v[112:115]
ds_read_b128 a[168:171], v17 offset:1280
v_mov_b32 v155, 0
v_mfma_f32_16x16x32_bf16 v[112:115], a[68:71], a[108:111], v[112:115]
buffer_load_dwordx4 v1, s[4:7], s8 offen offset:2048 sc1 lds
v_mfma_f32_16x16x32_bf16 v[112:115], a[72:75], a[104:107], v[112:115]
ds_read_b64_tr_b16 a[140:141], v16 offset:1736
v_mov_b32 v156, 0
v_mfma_f32_16x16x32_bf16 v[112:115], a[76:79], a[100:103], v[112:115]
ds_read_b64_tr_b16 a[142:143], v16 offset:1728
v_mov_b32 v157, 0
v_mfma_f32_16x16x32_bf16 v[112:115], a[80:83], a[96:99], v[112:115]
s_waitcnt lgkmcnt(15)
ds_read_b128 a[172:175], v17 offset:1792
v_mov_b32 v158, 0
v_mfma_f32_16x16x32_bf16 v[116:119], a[64:67], a[116:119], v[116:119]
s_waitcnt lgkmcnt(15)
buffer_load_dwordx4 v1, s[4:7], s8 offen offset:3072 sc1 lds
v_mfma_f32_16x16x32_bf16 v[116:119], a[68:71], a[112:115], v[116:119]
s_add_u32 s8, s8, 28672
ds_read_b64_tr_b16 a[144:145], v16 offset:2248
v_mov_b32 v159, 0
v_mfma_f32_16x16x32_bf16 v[116:119], a[72:75], a[108:111], v[116:119]
s_sub_u32 s9, s9, 1
ds_read_b64_tr_b16 a[146:147], v16 offset:2240
v_mov_b32 v160, 0
v_mfma_f32_16x16x32_bf16 v[116:119], a[76:79], a[104:107], v[116:119]
s_cmp_eq_u32 s9, 0
ds_read_b128 a[176:179], v17 offset:2304
v_mov_b32 v161, 0
v_mfma_f32_16x16x32_bf16 v[116:119], a[80:83], a[100:103], v[116:119]
s_cselect_b32 s8, s10, s8
v_mov_b32 v162, 0
v_mov_b32 v163, 0
v_mfma_f32_16x16x32_bf16 v[116:119], a[84:87], a[96:99], v[116:119]
s_cselect_b32 s9, s11, s9
ds_read_b64_tr_b16 a[148:149], v16 offset:2760
v_mov_b32 v164, 0
v_mfma_f32_16x16x32_bf16 v[120:123], a[64:67], a[120:123], v[120:123]
s_cselect_b32 s10, 3221225472, s10
ds_read_b64_tr_b16 a[150:151], v16 offset:2752
v_mov_b32 v165, 0
v_mfma_f32_16x16x32_bf16 v[120:123], a[68:71], a[116:119], v[120:123]
s_add_u32 m0, s18, 131072
ds_read_b128 a[180:183], v17 offset:2816
v_mov_b32 v166, 0
v_mfma_f32_16x16x32_bf16 v[120:123], a[72:75], a[112:115], v[120:123]
buffer_load_dwordx4 v1, s[4:7], s8 offen offset:0 sc1 lds
v_mfma_f32_16x16x32_bf16 v[120:123], a[76:79], a[108:111], v[120:123]
ds_read_b64_tr_b16 a[152:153], v16 offset:3272
v_mov_b32 v167, 0
v_mfma_f32_16x16x32_bf16 v[120:123], a[80:83], a[104:107], v[120:123]
ds_read_b64_tr_b16 a[154:155], v16 offset:3264
v_mov_b32 v168, 0
v_mfma_f32_16x16x32_bf16 v[120:123], a[84:87], a[100:103], v[120:123]
ds_read_b128 a[184:187], v17 offset:3328
v_mov_b32 v169, 0
v_mfma_f32_16x16x32_bf16 v[120:123], a[88:91], a[96:99], v[120:123]
s_waitcnt lgkmcnt(15)
buffer_load_dwordx4 v1, s[4:7], s8 offen offset:1024 sc1 lds
v_mfma_f32_16x16x32_bf16 v[124:127], a[64:67], a[124:127], v[124:127]
ds_read_b64_tr_b16 a[156:157], v16 offset:3784
v_mov_b32 v170, 0
v_mfma_f32_16x16x32_bf16 v[124:127], a[68:71], a[120:123], v[124:127]
ds_read_b64_tr_b16 a[158:159], v16 offset:3776
v_mov_b32 v171, 0
v_mfma_f32_16x16x32_bf16 v[124:127], a[72:75], a[116:119], v[124:127]
ds_read_b128 a[188:191], v17 offset:3840
v_mov_b32 v172, 0
v_mfma_f32_16x16x32_bf16 v[124:127], a[76:79], a[112:115], v[124:127]
buffer_load_dwordx4 v1, s[4:7], s8 offen offset:2048 sc1 lds
v_mfma_f32_16x16x32_bf16 v[124:127], a[80:83], a[108:111], v[124:127]
buffer_load_dwordx4 v1, s[4:7], s8 offen offset:3072 sc1 lds
v_mfma_f32_16x16x32_bf16 v[124:127], a[84:87], a[104:107], v[124:127]
s_add_u32 s8, s8, 4096
v_mov_b32 v173, 0
v_mov_b32 v174, 0
v_mfma_f32_16x16x32_bf16 v[124:127], a[88:91], a[100:103], v[124:127]
s_add_u32 m0, s18, 135168
v_mov_b32 v175, 0
v_mov_b32 v176, 0
v_mfma_f32_16x16x32_bf16 v[124:127], a[92:95], a[96:99], v[124:127]
buffer_load_dwordx4 v1, s[4:7], s8 offen offset:0 sc1 lds
v_mfma_f32_16x16x32_bf16 v[96:99], a[128:131], a[160:163], v[96:99]
ds_read_b64_tr_b16 a[64:65], v16 offset:264
v_mov_b32 v177, 0
v_mfma_f32_16x16x32_bf16 v[100:103], a[128:131], a[164:167], v[100:103]
ds_read_b64_tr_b16 a[66:67], v16 offset:256
v_mov_b32 v178, 0
v_mfma_f32_16x16x32_bf16 v[100:103], a[132:135], a[160:163], v[100:103]
s_waitcnt lgkmcnt(15)
ds_read_b128 a[96:99], v17 offset:192
v_mov_b32 v179, 0
v_mfma_f32_16x16x32_bf16 v[104:107], a[128:131], a[168:171], v[104:107]
buffer_load_dwordx4 v1, s[4:7], s8 offen offset:1024 sc1 lds
v_mfma_f32_16x16x32_bf16 v[104:107], a[132:135], a[164:167], v[104:107]
ds_read_b64_tr_b16 a[68:69], v16 offset:776
v_mov_b32 v180, 0
v_mfma_f32_16x16x32_bf16 v[104:107], a[136:139], a[160:163], v[104:107]
s_waitcnt lgkmcnt(15)
ds_read_b64_tr_b16 a[70:71], v16 offset:768
v_mov_b32 v181, 0
v_mfma_f32_16x16x32_bf16 v[108:111], a[128:131], a[172:175], v[108:111]
ds_read_b128 a[100:103], v17 offset:704
v_mov_b32 v182, 0
v_mfma_f32_16x16x32_bf16 v[108:111], a[132:135], a[168:171], v[108:111]
buffer_load_dwordx4 v1, s[4:7], s8 offen offset:2048 sc1 lds
v_mfma_f32_16x16x32_bf16 v[108:111], a[136:139], a[164:167], v[108:111]
ds_read_b64_tr_b16 a[72:73], v16 offset:1288
v_mov_b32 v183, 0
v_mfma_f32_16x16x32_bf16 v[108:111], a[140:143], a[160:163], v[108:111]
s_waitcnt lgkmcnt(15)
ds_read_b64_tr_b16 a[74:75], v16 offset:1280
v_mov_b32 v184, 0
v_mfma_f32_16x16x32_bf16 v[112:115], a[128:131], a[176:179], v[112:115]
ds_read_b128 a[104:107], v17 offset:1216
v_mov_b32 v185, 0
v_mfma_f32_16x16x32_bf16 v[112:115], a[132:135], a[172:175], v[112:115]
s_waitcnt lgkmcnt(15)
buffer_load_dwordx4 v1, s[4:7], s8 offen offset:3072 sc1 lds
v_mfma_f32_16x16x32_bf16 v[112:115], a[136:139], a[168:171], v[112:115]
s_add_u32 s8, s8, 28672
ds_read_b64_tr_b16 a[76:77], v16 offset:1800
v_mov_b32 v186, 0
v_mfma_f32_16x16x32_bf16 v[112:115], a[140:143], a[164:167], v[112:115]
s_sub_u32 s9, s9, 1
ds_read_b64_tr_b16 a[78:79], v16 offset:1792
v_mov_b32 v187, 0
v_mfma_f32_16x16x32_bf16 v[112:115], a[144:147], a[160:163], v[112:115]
s_cmp_eq_u32 s9, 0
ds_read_b128 a[108:111], v17 offset:1728
v_mov_b32 v188, 0
v_mfma_f32_16x16x32_bf16 v[116:119], a[128:131], a[180:183], v[116:119]
s_cselect_b32 s8, s10, s8
buffer_load_dword v14, v15, s[4:7], s70 offen sc1
v_mfma_f32_16x16x32_bf16 v[116:119], a[132:135], a[176:179], v[116:119]
s_cselect_b32 s9, s11, s9
ds_read_b64_tr_b16 a[80:81], v16 offset:2312
v_mov_b32 v189, 0
v_mfma_f32_16x16x32_bf16 v[116:119], a[136:139], a[172:175], v[116:119]
s_cselect_b32 s10, 3221225472, s10
ds_read_b64_tr_b16 a[82:83], v16 offset:2304
v_mov_b32 v190, 0
v_mfma_f32_16x16x32_bf16 v[116:119], a[140:143], a[168:171], v[116:119]
ds_read_b128 a[112:115], v17 offset:2240
v_mov_b32 v191, 0
v_mfma_f32_16x16x32_bf16 v[116:119], a[144:147], a[164:167], v[116:119]
v_mov_b32 v192, 0
v_mov_b32 v193, 0
v_mfma_f32_16x16x32_bf16 v[116:119], a[148:151], a[160:163], v[116:119]
s_waitcnt lgkmcnt(15)
ds_read_b64_tr_b16 a[84:85], v16 offset:2824
v_mov_b32 v194, 0
v_mfma_f32_16x16x32_bf16 v[120:123], a[128:131], a[184:187], v[120:123]
ds_read_b64_tr_b16 a[86:87], v16 offset:2816
v_mov_b32 v195, 0
v_mfma_f32_16x16x32_bf16 v[120:123], a[132:135], a[180:183], v[120:123]
ds_read_b128 a[116:119], v17 offset:2752
v_mov_b32 v196, 0
v_mfma_f32_16x16x32_bf16 v[120:123], a[136:139], a[176:179], v[120:123]
v_mov_b32 v197, 0
v_mov_b32 v198, 0
v_mfma_f32_16x16x32_bf16 v[120:123], a[140:143], a[172:175], v[120:123]
ds_read_b64_tr_b16 a[88:89], v16 offset:3336
v_mov_b32 v199, 0
v_mfma_f32_16x16x32_bf16 v[120:123], a[144:147], a[168:171], v[120:123]
ds_read_b64_tr_b16 a[90:91], v16 offset:3328
v_mov_b32 v200, 0
v_mfma_f32_16x16x32_bf16 v[120:123], a[148:151], a[164:167], v[120:123]
ds_read_b128 a[120:123], v17 offset:3264
v_mov_b32 v201, 0
v_mfma_f32_16x16x32_bf16 v[120:123], a[152:155], a[160:163], v[120:123]
v_mov_b32 v202, 0
v_mov_b32 v203, 0
v_mfma_f32_16x16x32_bf16 v[124:127], a[128:131], a[188:191], v[124:127]
ds_read_b64_tr_b16 a[92:93], v16 offset:3848
v_mov_b32 v204, 0
v_mfma_f32_16x16x32_bf16 v[124:127], a[132:135], a[184:187], v[124:127]
ds_read_b64_tr_b16 a[94:95], v16 offset:3840
v_mov_b32 v205, 0
v_mfma_f32_16x16x32_bf16 v[124:127], a[136:139], a[180:183], v[124:127]
ds_read_b128 a[124:127], v17 offset:3776
v_mov_b32 v206, 0
v_mfma_f32_16x16x32_bf16 v[124:127], a[140:143], a[176:179], v[124:127]
v_mov_b32 v207, 0
v_mov_b32 v208, 0
v_mfma_f32_16x16x32_bf16 v[124:127], a[144:147], a[172:175], v[124:127]
v_mov_b32 v209, 0
v_mov_b32 v210, 0
v_mfma_f32_16x16x32_bf16 v[124:127], a[148:151], a[168:171], v[124:127]
v_mov_b32 v211, 0
v_mov_b32 v212, 0
v_mfma_f32_16x16x32_bf16 v[124:127], a[152:155], a[164:167], v[124:127]
v_mov_b32 v213, 0
v_mov_b32 v214, 0
v_mfma_f32_16x16x32_bf16 v[124:127], a[156:159], a[160:163], v[124:127]
s_waitcnt lgkmcnt(15)
v_mov_b32 v215, 0
v_mov_b32 v216, 0
s_waitcnt vmcnt(0)
v_cmp_gt_u32 vcc, 1, v14
s_cbranch_vccnz M_cspin
M_cok:
v_mfma_f32_16x16x32_bf16 v[96:99], a[64:67], a[96:99], v[96:99]
s_add_u32 s22, s78, 0
ds_read_b64_tr_b16 a[128:129], v16 offset:328
v_mov_b32 v217, 0
v_mfma_f32_16x16x32_bf16 v[100:103], a[64:67], a[100:103], v[100:103]
ds_read_b64_tr_b16 a[130:131], v16 offset:320
v_mov_b32 v218, 0
v_mfma_f32_16x16x32_bf16 v[100:103], a[68:71], a[96:99], v[100:103]
ds_read_b128 a[160:163], v17 offset:128
v_mov_b32 v219, 0
v_mfma_f32_16x16x32_bf16 v[104:107], a[64:67], a[104:107], v[104:107]
buffer_load_dwordx4 a[0:3], v1, s[4:7], s22 offen offset:0 sc1
v_mfma_f32_16x16x32_bf16 v[104:107], a[68:71], a[100:103], v[104:107]
ds_read_b64_tr_b16 a[132:133], v16 offset:840
v_mov_b32 v220, 0
v_mfma_f32_16x16x32_bf16 v[104:107], a[72:75], a[96:99], v[104:107]
s_waitcnt lgkmcnt(15)
ds_read_b64_tr_b16 a[134:135], v16 offset:832
v_mov_b32 v221, 0
v_mfma_f32_16x16x32_bf16 v[108:111], a[64:67], a[108:111], v[108:111]
ds_read_b128 a[164:167], v17 offset:640
v_mov_b32 v222, 0
v_mfma_f32_16x16x32_bf16 v[108:111], a[68:71], a[104:107], v[108:111]
buffer_load_dwordx4 a[4:7], v1, s[4:7], s22 offen offset:1024 sc1
v_mfma_f32_16x16x32_bf16 v[108:111], a[72:75], a[100:103], v[108:111]
ds_read_b64_tr_b16 a[136:137], v16 offset:1352
v_mov_b32 v223, 0
v_mfma_f32_16x16x32_bf16 v[108:111], a[76:79], a[96:99], v[108:111]
s_waitcnt lgkmcnt(15)
ds_read_b64_tr_b16 a[138:139], v16 offset:1344
v_mov_b32 v224, 0
v_mfma_f32_16x16x32_bf16 v[112:115], a[64:67], a[112:115], v[112:115]
ds_read_b128 a[168:171], v17 offset:1152
v_mov_b32 v225, 0
v_mfma_f32_16x16x32_bf16 v[112:115], a[68:71], a[108:111], v[112:115]
buffer_load_dwordx4 a[8:11], v1, s[4:7], s22 offen offset:2048 sc1
v_mfma_f32_16x16x32_bf16 v[112:115], a[72:75], a[104:107], v[112:115]
ds_read_b64_tr_b16 a[140:141], v16 offset:1864
v_mov_b32 v226, 0
v_mfma_f32_16x16x32_bf16 v[112:115], a[76:79], a[100:103], v[112:115]
ds_read_b64_tr_b16 a[142:143], v16 offset:1856
v_mov_b32 v227, 0
v_mfma_f32_16x16x32_bf16 v[112:115], a[80:83], a[96:99], v[112:115]
s_waitcnt lgkmcnt(15)
ds_read_b128 a[172:175], v17 offset:1664
v_mov_b32 v228, 0
v_mfma_f32_16x16x32_bf16 v[116:119], a[64:67], a[116:119], v[116:119]
buffer_load_dwordx4 a[12:15], v1, s[4:7], s22 offen offset:3072 sc1
v_mfma_f32_16x16x32_bf16 v[116:119], a[68:71], a[112:115], v[116:119]
s_add_u32 s22, s78, 4096
ds_read_b64_tr_b16 a[144:145], v16 offset:2376
v_mov_b32 v229, 0
v_mfma_f32_16x16x32_bf16 v[116:119], a[72:75], a[108:111], v[116:119]
ds_read_b64_tr_b16 a[146:147], v16 offset:2368
v_mov_b32 v230, 0
v_mfma_f32_16x16x32_bf16 v[116:119], a[76:79], a[104:107], v[116:119]
ds_read_b128 a[176:179], v17 offset:2176
v_mov_b32 v231, 0
v_mfma_f32_16x16x32_bf16 v[116:119], a[80:83], a[100:103], v[116:119]
buffer_load_dwordx4 a[16:19], v1, s[4:7], s22 offen offset:0 sc1
v_mfma_f32_16x16x32_bf16 v[116:119], a[84:87], a[96:99], v[116:119]
s_waitcnt lgkmcnt(15)
ds_read_b64_tr_b16 a[148:149], v16 offset:2888
v_mov_b32 v232, 0
v_mfma_f32_16x16x32_bf16 v[120:123], a[64:67], a[120:123], v[120:123]
ds_read_b64_tr_b16 a[150:151], v16 offset:2880
v_mov_b32 v233, 0
v_mfma_f32_16x16x32_bf16 v[120:123], a[68:71], a[116:119], v[120:123]
ds_read_b128 a[180:183], v17 offset:2688
v_mov_b32 v234, 0
v_mfma_f32_16x16x32_bf16 v[120:123], a[72:75], a[112:115], v[120:123]
buffer_load_dwordx4 a[20:23], v1, s[4:7], s22 offen offset:1024 sc1
v_mfma_f32_16x16x32_bf16 v[120:123], a[76:79], a[108:111], v[120:123]
ds_read_b64_tr_b16 a[152:153], v16 offset:3400
v_mov_b32 v235, 0
v_mfma_f32_16x16x32_bf16 v[120:123], a[80:83], a[104:107], v[120:123]
ds_read_b64_tr_b16 a[154:155], v16 offset:3392
v_mov_b32 v236, 0
v_mfma_f32_16x16x32_bf16 v[120:123], a[84:87], a[100:103], v[120:123]
ds_read_b128 a[184:187], v17 offset:3200
v_mov_b32 v237, 0
v_mfma_f32_16x16x32_bf16 v[120:123], a[88:91], a[96:99], v[120:123]
buffer_load_dwordx4 a[24:27], v1, s[4:7], s22 offen offset:2048 sc1
v_mfma_f32_16x16x32_bf16 v[124:127], a[64:67], a[124:127], v[124:127]
ds_read_b64_tr_b16 a[156:157], v16 offset:3912
v_mov_b32 v238, 0
v_mfma_f32_16x16x32_bf16 v[124:127], a[68:71], a[120:123], v[124:127]
ds_read_b64_tr_b16 a[158:159], v16 offset:3904
v_mov_b32 v239, 0
v_mfma_f32_16x16x32_bf16 v[124:127], a[72:75], a[116:119], v[124:127]
ds_read_b128 a[188:191], v17 offset:3712
v_mov_b32 v240, 0
v_mfma_f32_16x16x32_bf16 v[124:127], a[76:79], a[112:115], v[124:127]
buffer_load_dwordx4 a[28:31], v1, s[4:7], s22 offen offset:3072 sc1
v_mfma_f32_16x16x32_bf16 v[124:127], a[80:83], a[108:111], v[124:127]
s_add_u32 s22, s78, 32768
buffer_load_dwordx4 a[32:35], v1, s[4:7], s22 offen offset:0 sc1
v_mfma_f32_16x16x32_bf16 v[124:127], a[84:87], a[104:107], v[124:127]
buffer_load_dwordx4 a[36:39], v1, s[4:7], s22 offen offset:1024 sc1
v_mfma_f32_16x16x32_bf16 v[124:127], a[88:91], a[100:103], v[124:127]
buffer_load_dwordx4 a[40:43], v1, s[4:7], s22 offen offset:2048 sc1
v_mfma_f32_16x16x32_bf16 v[124:127], a[92:95], a[96:99], v[124:127]
s_waitcnt lgkmcnt(15)
buffer_load_dwordx4 a[44:47], v1, s[4:7], s22 offen offset:3072 sc1
v_mfma_f32_16x16x32_bf16 v[96:99], a[128:131], a[160:163], v[96:99]
s_add_u32 s22, s78, 36864
ds_read_b64_tr_b16 a[64:65], v16 offset:392
v_mov_b32 v241, 0
v_mfma_f32_16x16x32_bf16 v[100:103], a[128:131], a[164:167], v[100:103]
ds_read_b64_tr_b16 a[66:67], v16 offset:384
v_mov_b32 v242, 0
v_mfma_f32_16x16x32_bf16 v[100:103], a[132:135], a[160:163], v[100:103]
ds_read_b128 a[96:99], v17 offset:64
v_mov_b32 v243, 0
v_mfma_f32_16x16x32_bf16 v[104:107], a[128:131], a[168:171], v[104:107]
ds_read_b64 v[36:37], v18 offset:0
v_mov_b32 v244, 0
v_mfma_f32_16x16x32_bf16 v[104:107], a[132:135], a[164:167], v[104:107]
ds_read_b64_tr_b16 a[68:69], v16 offset:904
v_mov_b32 v245, 0
v_mfma_f32_16x16x32_bf16 v[104:107], a[136:139], a[160:163], v[104:107]
s_waitcnt lgkmcnt(15)
ds_read_b64_tr_b16 a[70:71], v16 offset:896
v_mov_b32 v246, 0
v_mfma_f32_16x16x32_bf16 v[108:111], a[128:131], a[172:175], v[108:111]
ds_read_b128 a[100:103], v17 offset:576
v_mov_b32 v247, 0
v_mfma_f32_16x16x32_bf16 v[108:111], a[132:135], a[168:171], v[108:111]
ds_read_b64 v[38:39], v18 offset:512
v_mov_b32 v248, 0
v_mfma_f32_16x16x32_bf16 v[108:111], a[136:139], a[164:167], v[108:111]
ds_read_b64_tr_b16 a[72:73], v16 offset:1416
v_mov_b32 v249, 0
v_mfma_f32_16x16x32_bf16 v[108:111], a[140:143], a[160:163], v[108:111]
s_waitcnt lgkmcnt(15)
ds_read_b64_tr_b16 a[74:75], v16 offset:1408
v_mov_b32 v250, 0
v_mfma_f32_16x16x32_bf16 v[112:115], a[128:131], a[176:179], v[112:115]
ds_read_b128 a[104:107], v17 offset:1088
v_mov_b32 v251, 0
v_mfma_f32_16x16x32_bf16 v[112:115], a[132:135], a[172:175], v[112:115]
ds_read_b64 v[44:45], v18 offset:1024
v_mov_b32 v252, 0
v_mfma_f32_16x16x32_bf16 v[112:115], a[136:139], a[168:171], v[112:115]
ds_read_b64_tr_b16 a[76:77], v16 offset:1928
v_mov_b32 v253, 0
v_mfma_f32_16x16x32_bf16 v[112:115], a[140:143], a[164:167], v[112:115]
ds_read_b64_tr_b16 a[78:79], v16 offset:1920
v_mov_b32 v254, 0
v_mfma_f32_16x16x32_bf16 v[112:115], a[144:147], a[160:163], v[112:115]
ds_read_b128 a[108:111], v17 offset:1600
v_mov_b32 v255, 0
v_mfma_f32_16x16x32_bf16 v[116:119], a[128:131], a[180:183], v[116:119]
ds_read_b64 v[46:47], v18 offset:1536
v_mfma_f32_16x16x32_bf16 v[116:119], a[132:135], a[176:179], v[116:119]
ds_read_b64_tr_b16 a[80:81], v16 offset:2440
v_mfma_f32_16x16x32_bf16 v[116:119], a[136:139], a[172:175], v[116:119]
ds_read_b64_tr_b16 a[82:83], v16 offset:2432
v_mfma_f32_16x16x32_bf16 v[116:119], a[140:143], a[168:171], v[116:119]
ds_read_b128 a[112:115], v17 offset:2112
v_mfma_f32_16x16x32_bf16 v[116:119], a[144:147], a[164:167], v[116:119]
ds_read_b64 v[52:53], v18 offset:2048
v_mfma_f32_16x16x32_bf16 v[116:119], a[148:151], a[160:163], v[116:119]
s_waitcnt lgkmcnt(15)
ds_read_b64_tr_b16 a[84:85], v16 offset:2952
v_mfma_f32_16x16x32_bf16 v[120:123], a[128:131], a[184:187], v[120:123]
ds_read_b64_tr_b16 a[86:87], v16 offset:2944
v_mfma_f32_16x16x32_bf16 v[120:123], a[132:135], a[180:183], v[120:123]
ds_read_b128 a[116:119], v17 offset:2624
v_mfma_f32_16x16x32_bf16 v[120:123], a[136:139], a[176:179], v[120:123]
ds_read_b64 v[54:55], v18 offset:2560
v_mfma_f32_16x16x32_bf16 v[120:123], a[140:143], a[172:175], v[120:123]
ds_read_b64_tr_b16 a[88:89], v16 offset:3464
v_mfma_f32_16x16x32_bf16 v[120:123], a[144:147], a[168:171], v[120:123]
ds_read_b64_tr_b16 a[90:91], v16 offset:3456
v_mfma_f32_16x16x32_bf16 v[120:123], a[148:151], a[164:167], v[120:123]
ds_read_b128 a[120:123], v17 offset:3136
v_mfma_f32_16x16x32_bf16 v[120:123], a[152:155], a[160:163], v[120:123]
ds_read_b64 v[60:61], v18 offset:3072
v_mfma_f32_16x16x32_bf16 v[124:127], a[128:131], a[188:191], v[124:127]
ds_read_b64_tr_b16 a[92:93], v16 offset:3976
v_mfma_f32_16x16x32_bf16 v[124:127], a[132:135], a[184:187], v[124:127]
ds_read_b64_tr_b16 a[94:95], v16 offset:3968
v_mfma_f32_16x16x32_bf16 v[124:127], a[136:139], a[180:183], v[124:127]
ds_read_b128 a[124:127], v17 offset:3648
v_mfma_f32_16x16x32_bf16 v[124:127], a[140:143], a[176:179], v[124:127]
ds_read_b64 v[62:63], v18 offset:3584
v_mfma_f32_16x16x32_bf16 v[124:127], a[144:147], a[172:175], v[124:127]
buffer_load_dwordx4 a[48:51], v1, s[4:7], s22 offen offset:0 sc1
v_mfma_f32_16x16x32_bf16 v[124:127], a[148:151], a[168:171], v[124:127]
buffer_load_dwordx4 a[52:55], v1, s[4:7], s22 offen offset:1024 sc1
v_mfma_f32_16x16x32_bf16 v[124:127], a[152:155], a[164:167], v[124:127]
buffer_load_dwordx4 a[56:59], v1, s[4:7], s22 offen offset:2048 sc1
v_mfma_f32_16x16x32_bf16 v[124:127], a[156:159], a[160:163], v[124:127]
buffer_load_dwordx4 a[60:63], v1, s[4:7], s22 offen offset:3072 sc1
v_mfma_f32_16x16x32_bf16 v[96:99], a[64:67], a[96:99], v[96:99]
s_waitcnt lgkmcnt(15)
ds_read_b64_tr_b16 a[128:129], v16 offset:456
v_mfma_f32_16x16x32_bf16 v[100:103], a[64:67], a[100:103], v[100:103]
ds_read_b64_tr_b16 a[130:131], v16 offset:448
v_mfma_f32_16x16x32_bf16 v[100:103], a[68:71], a[96:99], v[100:103]
ds_read_b128 a[160:163], v17 offset:0
v_mfma_f32_16x16x32_bf16 v[104:107], a[64:67], a[104:107], v[104:107]
v_mfma_f32_16x16x32_bf16 v[104:107], a[68:71], a[100:103], v[104:107]
ds_read_b64_tr_b16 a[132:133], v16 offset:968
v_mfma_f32_16x16x32_bf16 v[104:107], a[72:75], a[96:99], v[104:107]
ds_read_b64_tr_b16 a[134:135], v16 offset:960
v_mfma_f32_16x16x32_bf16 v[108:111], a[64:67], a[108:111], v[108:111]
ds_read_b128 a[164:167], v17 offset:512
v_mfma_f32_16x16x32_bf16 v[108:111], a[68:71], a[104:107], v[108:111]
v_mfma_f32_16x16x32_bf16 v[108:111], a[72:75], a[100:103], v[108:111]
ds_read_b64_tr_b16 a[136:137], v16 offset:1480
v_mfma_f32_16x16x32_bf16 v[108:111], a[76:79], a[96:99], v[108:111]
s_waitcnt lgkmcnt(15)
ds_read_b64_tr_b16 a[138:139], v16 offset:1472
v_mfma_f32_16x16x32_bf16 v[112:115], a[64:67], a[112:115], v[112:115]
ds_read_b128 a[168:171], v17 offset:1024
v_mfma_f32_16x16x32_bf16 v[112:115], a[68:71], a[108:111], v[112:115]
v_mfma_f32_16x16x32_bf16 v[112:115], a[72:75], a[104:107], v[112:115]
ds_read_b64_tr_b16 a[140:141], v16 offset:1992
v_mfma_f32_16x16x32_bf16 v[112:115], a[76:79], a[100:103], v[112:115]
ds_read_b64_tr_b16 a[142:143], v16 offset:1984
v_mfma_f32_16x16x32_bf16 v[112:115], a[80:83], a[96:99], v[112:115]
ds_read_b128 a[172:175], v17 offset:1536
v_mfma_f32_16x16x32_bf16 v[116:119], a[64:67], a[116:119], v[116:119]
v_mfma_f32_16x16x32_bf16 v[116:119], a[68:71], a[112:115], v[116:119]
ds_read_b64_tr_b16 a[144:145], v16 offset:2504
v_mfma_f32_16x16x32_bf16 v[116:119], a[72:75], a[108:111], v[116:119]
ds_read_b64_tr_b16 a[146:147], v16 offset:2496
v_mfma_f32_16x16x32_bf16 v[116:119], a[76:79], a[104:107], v[116:119]
ds_read_b128 a[176:179], v17 offset:2048
v_mfma_f32_16x16x32_bf16 v[116:119], a[80:83], a[100:103], v[116:119]
v_mfma_f32_16x16x32_bf16 v[116:119], a[84:87], a[96:99], v[116:119]
s_waitcnt lgkmcnt(15)
ds_read_b64_tr_b16 a[148:149], v16 offset:3016
v_mfma_f32_16x16x32_bf16 v[120:123], a[64:67], a[120:123], v[120:123]
ds_read_b64_tr_b16 a[150:151], v16 offset:3008
v_mfma_f32_16x16x32_bf16 v[120:123], a[68:71], a[116:119], v[120:123]
ds_read_b128 a[180:183], v17 offset:2560
v_mfma_f32_16x16x32_bf16 v[120:123], a[72:75], a[112:115], v[120:123]
v_mfma_f32_16x16x32_bf16 v[120:123], a[76:79], a[108:111], v[120:123]
ds_read_b64_tr_b16 a[152:153], v16 offset:3528
v_mfma_f32_16x16x32_bf16 v[120:123], a[80:83], a[104:107], v[120:123]
ds_read_b64_tr_b16 a[154:155], v16 offset:3520
v_mfma_f32_16x16x32_bf16 v[120:123], a[84:87], a[100:103], v[120:123]
ds_read_b128 a[184:187], v17 offset:3072
v_mfma_f32_16x16x32_bf16 v[120:123], a[88:91], a[96:99], v[120:123]
v_mfma_f32_16x16x32_bf16 v[124:127], a[64:67], a[124:127], v[124:127]
ds_read_b64_tr_b16 a[156:157], v16 offset:4040
v_mfma_f32_16x16x32_bf16 v[124:127], a[68:71], a[120:123], v[124:127]
ds_read_b64_tr_b16 a[158:159], v16 offset:4032
v_mfma_f32_16x16x32_bf16 v[124:127], a[72:75], a[116:119], v[124:127]
ds_read_b128 a[188:191], v17 offset:3584
v_mfma_f32_16x16x32_bf16 v[124:127], a[76:79], a[112:115], v[124:127]
v_mfma_f32_16x16x32_bf16 v[124:127], a[80:83], a[108:111], v[124:127]
v_mfma_f32_16x16x32_bf16 v[124:127], a[84:87], a[104:107], v[124:127]
v_mfma_f32_16x16x32_bf16 v[124:127], a[88:91], a[100:103], v[124:127]
v_mfma_f32_16x16x32_bf16 v[124:127], a[92:95], a[96:99], v[124:127]
s_waitcnt lgkmcnt(15)
v_mfma_f32_16x16x32_bf16 v[96:99], a[128:131], a[160:163], v[96:99]
v_mfma_f32_16x16x32_bf16 v[100:103], a[128:131], a[164:167], v[100:103]
v_mfma_f32_16x16x32_bf16 v[100:103], a[132:135], a[160:163], v[100:103]
v_mfma_f32_16x16x32_bf16 v[104:107], a[128:131], a[168:171], v[104:107]
v_mfma_f32_16x16x32_bf16 v[104:107], a[132:135], a[164:167], v[104:107]
v_mfma_f32_16x16x32_bf16 v[104:107], a[136:139], a[160:163], v[104:107]
s_waitcnt lgkmcnt(12)
v_mfma_f32_16x16x32_bf16 v[108:111], a[128:131], a[172:175], v[108:111]
v_mfma_f32_16x16x32_bf16 v[108:111], a[132:135], a[168:171], v[108:111]
v_mfma_f32_16x16x32_bf16 v[108:111], a[136:139], a[164:167], v[108:111]
v_lshlrev_b32 v10, 16, v36
v_fmac_f32 v96, v19, v10
v_mfma_f32_16x16x32_bf16 v[108:111], a[140:143], a[160:163], v[108:111]
s_waitcnt lgkmcnt(9)
v_and_b32 v11, 0xffff0000, v36
v_fmac_f32 v97, v19, v11
v_mfma_f32_16x16x32_bf16 v[112:115], a[128:131], a[176:179], v[112:115]
v_lshlrev_b32 v12, 16, v37
v_fmac_f32 v98, v19, v12
v_mfma_f32_16x16x32_bf16 v[112:115], a[132:135], a[172:175], v[112:115]
v_and_b32 v13, 0xffff0000, v37
v_fmac_f32 v99, v19, v13
v_mfma_f32_16x16x32_bf16 v[112:115], a[136:139], a[168:171], v[112:115]
v_cvt_pk_bf16_f32 v96, v96, v97
v_cvt_pk_bf16_f32 v97, v98, v99
v_mfma_f32_16x16x32_bf16 v[112:115], a[140:143], a[164:167], v[112:115]
buffer_store_dwordx2 v[96:97], v8, s[4:7], s83 offen offset:0 sc1
v_mfma_f32_16x16x32_bf16 v[112:115], a[144:147], a[160:163], v[112:115]
s_waitcnt lgkmcnt(6)
v_lshlrev_b32 v10, 16, v38
v_fmac_f32 v100, v19, v10
v_mfma_f32_16x16x32_bf16 v[116:119], a[128:131], a[180:183], v[116:119]
v_and_b32 v11, 0xffff0000, v38
v_fmac_f32 v101, v19, v11
v_mfma_f32_16x16x32_bf16 v[116:119], a[132:135], a[176:179], v[116:119]
v_lshlrev_b32 v12, 16, v39
v_fmac_f32 v102, v19, v12
v_mfma_f32_16x16x32_bf16 v[116:119], a[136:139], a[172:175], v[116:119]
v_and_b32 v13, 0xffff0000, v39
v_fmac_f32 v103, v19, v13
v_mfma_f32_16x16x32_bf16 v[116:119], a[140:143], a[168:171], v[116:119]
v_cvt_pk_bf16_f32 v100, v100, v101
v_cvt_pk_bf16_f32 v101, v102, v103
v_mfma_f32_16x16x32_bf16 v[116:119], a[144:147], a[164:167], v[116:119]
buffer_store_dwordx2 v[100:101], v8, s[4:7], s83 offen offset:512 sc1
v_mfma_f32_16x16x32_bf16 v[116:119], a[148:151], a[160:163], v[116:119]
s_waitcnt lgkmcnt(3)
v_lshlrev_b32 v10, 16, v44
v_fmac_f32 v104, v19, v10
v_mfma_f32_16x16x32_bf16 v[120:123], a[128:131], a[184:187], v[120:123]
v_and_b32 v11, 0xffff0000, v44
v_fmac_f32 v105, v19, v11
v_mfma_f32_16x16x32_bf16 v[120:123], a[132:135], a[180:183], v[120:123]
v_lshlrev_b32 v12, 16, v45
v_fmac_f32 v106, v19, v12
v_mfma_f32_16x16x32_bf16 v[120:123], a[136:139], a[176:179], v[120:123]
v_and_b32 v13, 0xffff0000, v45
v_fmac_f32 v107, v19, v13
v_mfma_f32_16x16x32_bf16 v[120:123], a[140:143], a[172:175], v[120:123]
v_cvt_pk_bf16_f32 v104, v104, v105
v_cvt_pk_bf16_f32 v105, v106, v107
v_mfma_f32_16x16x32_bf16 v[120:123], a[144:147], a[168:171], v[120:123]
buffer_store_dwordx2 v[104:105], v8, s[4:7], s83 offen offset:1024 sc1
v_mfma_f32_16x16x32_bf16 v[120:123], a[148:151], a[164:167], v[120:123]
v_lshlrev_b32 v10, 16, v46
v_fmac_f32 v108, v19, v10
v_mfma_f32_16x16x32_bf16 v[120:123], a[152:155], a[160:163], v[120:123]
s_waitcnt lgkmcnt(0)
v_and_b32 v11, 0xffff0000, v46
v_fmac_f32 v109, v19, v11
v_mfma_f32_16x16x32_bf16 v[124:127], a[128:131], a[188:191], v[124:127]
v_lshlrev_b32 v12, 16, v47
v_fmac_f32 v110, v19, v12
v_mfma_f32_16x16x32_bf16 v[124:127], a[132:135], a[184:187], v[124:127]
v_and_b32 v13, 0xffff0000, v47
v_fmac_f32 v111, v19, v13
v_mfma_f32_16x16x32_bf16 v[124:127], a[136:139], a[180:183], v[124:127]
v_cvt_pk_bf16_f32 v108, v108, v109
v_cvt_pk_bf16_f32 v109, v110, v111
v_mfma_f32_16x16x32_bf16 v[124:127], a[140:143], a[176:179], v[124:127]
buffer_store_dwordx2 v[108:109], v8, s[4:7], s83 offen offset:1536 sc1
v_mfma_f32_16x16x32_bf16 v[124:127], a[144:147], a[172:175], v[124:127]
v_lshlrev_b32 v10, 16, v52
v_fmac_f32 v112, v19, v10
v_mfma_f32_16x16x32_bf16 v[124:127], a[148:151], a[168:171], v[124:127]
v_and_b32 v11, 0xffff0000, v52
v_fmac_f32 v113, v19, v11
v_mfma_f32_16x16x32_bf16 v[124:127], a[152:155], a[164:167], v[124:127]
v_lshlrev_b32 v12, 16, v53
v_fmac_f32 v114, v19, v12
v_mfma_f32_16x16x32_bf16 v[124:127], a[156:159], a[160:163], v[124:127]
v_and_b32 v13, 0xffff0000, v53
v_fmac_f32 v115, v19, v13
v_cvt_pk_bf16_f32 v112, v112, v113
v_cvt_pk_bf16_f32 v113, v114, v115
buffer_store_dwordx2 v[112:113], v8, s[4:7], s83 offen offset:2048 sc1
v_lshlrev_b32 v10, 16, v54
v_fmac_f32 v116, v19, v10
v_and_b32 v11, 0xffff0000, v54
v_fmac_f32 v117, v19, v11
v_lshlrev_b32 v12, 16, v55
v_fmac_f32 v118, v19, v12
v_and_b32 v13, 0xffff0000, v55
v_fmac_f32 v119, v19, v13
v_cvt_pk_bf16_f32 v116, v116, v117
v_cvt_pk_bf16_f32 v117, v118, v119
buffer_store_dwordx2 v[116:117], v8, s[4:7], s83 offen offset:2560 sc1
v_lshlrev_b32 v10, 16, v60
v_fmac_f32 v120, v19, v10
v_and_b32 v11, 0xffff0000, v60
v_fmac_f32 v121, v19, v11
v_lshlrev_b32 v12, 16, v61
v_fmac_f32 v122, v19, v12
v_and_b32 v13, 0xffff0000, v61
v_fmac_f32 v123, v19, v13
v_cvt_pk_bf16_f32 v120, v120, v121
v_cvt_pk_bf16_f32 v121, v122, v123
buffer_store_dwordx2 v[120:121], v8, s[4:7], s83 offen offset:3072 sc1
v_lshlrev_b32 v10, 16, v62
v_fmac_f32 v124, v19, v10
v_and_b32 v11, 0xffff0000, v62
v_fmac_f32 v125, v19, v11
v_lshlrev_b32 v12, 16, v63
v_fmac_f32 v126, v19, v12
v_and_b32 v13, 0xffff0000, v63
v_fmac_f32 v127, v19, v13
v_cvt_pk_bf16_f32 v124, v124, v125
v_cvt_pk_bf16_f32 v125, v126, v127
buffer_store_dwordx2 v[124:125], v8, s[4:7], s83 offen offset:3584 sc1
v_lshrrev_b32 v8, 7, v1
v_and_b32 v9, 6, v8
v_lshlrev_b32 v9, 4, v9
v_and_b32 v10, 0x70, v1
v_xor_b32 v9, v9, v10
v_mul_u32_u24 v8, 896, v8
v_add_u32 v8, v8, v9
v_accvgpr_write_b32 a184, v8
v_add_u32 v8, 6144, v8
v_accvgpr_write_b32 a185, v8
v_add_u32 v8, 6144, v8
v_accvgpr_write_b32 a186, v8
v_add_u32 v8, 6144, v8
v_accvgpr_write_b32 a187, v8
v_lshrrev_b32 v8, 6, v1
v_bfe_u32 v9, v1, 7, 2
v_lshlrev_b32 v9, 5, v9
v_lshl_add_u32 v8, v8, 7, v9
v_bfe_u32 v9, v1, 4, 2
v_lshl_add_u32 v8, v9, 3, v8
v_add_u32 v8, 32768, v8
v_accvgpr_write_b32 a188, v8
v_xor_b32 v9, 32, v8
v_accvgpr_write_b32 a189, v9
v_xor_b32 v9, 64, v8
v_accvgpr_write_b32 a190, v9
v_xor_b32 v9, 96, v8
v_accvgpr_write_b32 a191, v9
s_waitcnt vmcnt(8)
s_barrier
s_cmp_lg_u32 s24, 0
s_cbranch_scc1 K2_item
v_accvgpr_mov_b32 a0, a192
v_accvgpr_mov_b32 a1, a193
v_accvgpr_mov_b32 a2, a194
v_accvgpr_mov_b32 a3, a195
v_accvgpr_mov_b32 a4, a196
v_accvgpr_mov_b32 a5, a197
v_accvgpr_mov_b32 a6, a198
v_accvgpr_mov_b32 a7, a199
v_accvgpr_mov_b32 a8, a200
v_accvgpr_mov_b32 a9, a201
v_accvgpr_mov_b32 a10, a202
v_accvgpr_mov_b32 a11, a203
v_accvgpr_mov_b32 a12, a204
v_accvgpr_mov_b32 a13, a205
v_accvgpr_mov_b32 a14, a206
v_accvgpr_mov_b32 a15, a207
v_accvgpr_mov_b32 a16, a208
v_accvgpr_mov_b32 a17, a209
v_accvgpr_mov_b32 a18, a210
v_accvgpr_mov_b32 a19, a211
v_accvgpr_mov_b32 a20, a212
v_accvgpr_mov_b32 a21, a213
v_accvgpr_mov_b32 a22, a214
v_accvgpr_mov_b32 a23, a215
v_accvgpr_mov_b32 a24, a216
v_accvgpr_mov_b32 a25, a217
v_accvgpr_mov_b32 a26, a218
v_accvgpr_mov_b32 a27, a219
v_accvgpr_mov_b32 a28, a220
v_accvgpr_mov_b32 a29, a221
v_accvgpr_mov_b32 a30, a222
v_accvgpr_mov_b32 a31, a223
v_accvgpr_mov_b32 a32, a224
v_accvgpr_mov_b32 a33, a225
v_accvgpr_mov_b32 a34, a226
v_accvgpr_mov_b32 a35, a227
v_accvgpr_mov_b32 a36, a228
v_accvgpr_mov_b32 a37, a229
v_accvgpr_mov_b32 a38, a230
v_accvgpr_mov_b32 a39, a231
v_accvgpr_mov_b32 a40, a232
v_accvgpr_mov_b32 a41, a233
v_accvgpr_mov_b32 a42, a234
v_accvgpr_mov_b32 a43, a235
v_accvgpr_mov_b32 a44, a236
v_accvgpr_mov_b32 a45, a237
v_accvgpr_mov_b32 a46, a238
v_accvgpr_mov_b32 a47, a239
v_accvgpr_mov_b32 a48, a240
v_accvgpr_mov_b32 a49, a241
v_accvgpr_mov_b32 a50, a242
v_accvgpr_mov_b32 a51, a243
v_accvgpr_mov_b32 a52, a244
v_accvgpr_mov_b32 a53, a245
v_accvgpr_mov_b32 a54, a246
v_accvgpr_mov_b32 a55, a247
v_accvgpr_mov_b32 a56, a248
v_accvgpr_mov_b32 a57, a249
v_accvgpr_mov_b32 a58, a250
v_accvgpr_mov_b32 a59, a251
v_accvgpr_mov_b32 a60, a252
v_accvgpr_mov_b32 a61, a253
v_accvgpr_mov_b32 a62, a254
v_accvgpr_mov_b32 a63, a255
s_branch K2_item
M_cspin:
Lp_17:
buffer_load_dword v14, v15, s[4:7], s70 offen sc1
s_waitcnt vmcnt(0)
v_cmp_gt_u32 vcc, 1, v14
s_cbranch_vccz Lpd_18
s_sleep 8
s_sub_u32 s101, s101, 1
s_cbranch_scc0 Lp_17
s_mov_b32 s101, 0
Lpd_18:
s_branch M_cok
M_kspin:
Lp_19:
buffer_load_dword v21, v20, s[4:7], s70 offen sc1
s_waitcnt vmcnt(0)
v_cmp_gt_u32 vcc, 1, v21
s_cbranch_vccz Lpd_20
s_sleep 8
s_sub_u32 s101, s101, 1
s_cbranch_scc0 Lp_19
s_mov_b32 s101, 0
Lpd_20:
s_branch M_kok
M_kspin2:
Lp_21:
buffer_load_dword v21, v20, s[4:7], s70 offen sc1
s_waitcnt vmcnt(0)
v_cmp_gt_u32 vcc, 1, v21
s_cbranch_vccz Lpd_22
s_sleep 8
s_sub_u32 s101, s101, 1
s_cbranch_scc0 Lp_21
s_mov_b32 s101, 0
Lpd_22:
s_branch M_kok2
M_vspin:
Lp_23:
buffer_load_dword v21, v15, s[4:7], s70 offen sc1
s_waitcnt vmcnt(0)
v_cmp_gt_u32 vcc, 1, v21
s_cbranch_vccz Lpd_24
s_sleep 8
s_sub_u32 s101, s101, 1
s_cbranch_scc0 Lp_23
s_mov_b32 s101, 0
Lpd_24:
s_branch M_vok
K2_plain:
v_mfma_f32_16x16x32_bf16 v[128:131], a[64:67], v[96:99], v[128:131]
s_waitcnt lgkmcnt(6)
ds_read_b128 a[96:99], v2 offset:8192
v_add_f32 v24, v24, v26
v_mfma_f32_16x16x32_bf16 v[128:131], a[68:71], v[100:103], v[128:131]
s_waitcnt lgkmcnt(5)
v_mfma_f32_16x16x32_bf16 v[132:135], a[68:71], v[108:111], v[132:135]
s_mov_b64 s[36:37], s[86:87]
ds_read_b128 a[100:103], v2 offset:9216
v_add_f32 v25, v25, v27
v_mfma_f32_16x16x32_bf16 v[132:135], a[64:67], v[104:107], v[132:135]
s_mov_b32 s38, 3670016
v_exp_f32 v8, v68
v_mfma_f32_16x16x32_bf16 v[136:139], a[72:75], v[96:99], v[136:139]
s_mov_b32 s39, 0x20000
ds_read_b128 a[104:107], v2 offset:10240
v_accvgpr_read_b32 v112, a184
v_mfma_f32_16x16x32_bf16 v[136:139], a[76:79], v[100:103], v[136:139]
v_accvgpr_read_b32 v113, a185
v_accvgpr_read_b32 v114, a186
v_mfma_f32_16x16x32_bf16 v[140:143], a[76:79], v[108:111], v[140:143]
ds_read_b128 a[108:111], v2 offset:11264
v_accvgpr_read_b32 v115, a187
v_mfma_f32_16x16x32_bf16 v[140:143], a[72:75], v[104:107], v[140:143]
s_waitcnt lgkmcnt(7)
v_accvgpr_read_b32 v116, a188
v_accvgpr_read_b32 v117, a189
v_mfma_f32_16x16x32_bf16 v[144:147], a[80:83], v[96:99], v[144:147]
s_waitcnt lgkmcnt(6)
ds_read_b128 a[112:115], v2 offset:12288
v_accvgpr_read_b32 v118, a190
v_mfma_f32_16x16x32_bf16 v[144:147], a[84:87], v[100:103], v[144:147]
v_accvgpr_read_b32 v119, a191
v_mfma_f32_16x16x32_bf16 v[148:151], a[84:87], v[108:111], v[148:151]
s_add_u32 m0, s18, 32768
ds_read_b128 a[116:119], v2 offset:13312
v_cvt_pk_bf16_f32 v128, v128, v129
v_mfma_f32_16x16x32_bf16 v[148:151], a[80:83], v[104:107], v[148:151]
s_waitcnt lgkmcnt(7)
buffer_load_dwordx4 v112, s[36:39], s81 offen offset:0 lds
v_mfma_f32_16x16x32_bf16 v[152:155], a[88:91], v[96:99], v[152:155]
s_waitcnt lgkmcnt(6)
ds_read_b128 a[120:123], v2 offset:14336
v_cvt_pk_bf16_f32 v129, v130, v131
v_mfma_f32_16x16x32_bf16 v[152:155], a[92:95], v[100:103], v[152:155]
v_exp_f32 v9, v69
v_mfma_f32_16x16x32_bf16 v[156:159], a[92:95], v[108:111], v[156:159]
ds_read_b128 a[124:127], v2 offset:15360
v_add_f32 v27, v8, v9
v_mfma_f32_16x16x32_bf16 v[156:159], a[88:91], v[104:107], v[156:159]
s_waitcnt lgkmcnt(7)
buffer_load_dwordx4 v113, s[36:39], s81 offen offset:1024 lds
v_mfma_f32_16x16x32_bf16 v[160:163], a[96:99], v[96:99], v[160:163]
s_waitcnt lgkmcnt(6)
ds_read_b128 a[64:67], v2 offset:16384
v_cvt_pk_bf16_f32 v120, v8, v9
v_mfma_f32_16x16x32_bf16 v[160:163], a[100:103], v[100:103], v[160:163]
v_exp_f32 v10, v70
v_mfma_f32_16x16x32_bf16 v[164:167], a[100:103], v[108:111], v[164:167]
ds_read_b128 a[68:71], v2 offset:17408
v_add_f32 v27, v27, v10
v_mfma_f32_16x16x32_bf16 v[164:167], a[96:99], v[104:107], v[164:167]
s_waitcnt lgkmcnt(7)
buffer_load_dwordx4 v114, s[36:39], s81 offen offset:2048 lds
v_mfma_f32_16x16x32_bf16 v[168:171], a[104:107], v[96:99], v[168:171]
s_waitcnt lgkmcnt(6)
ds_read_b128 a[72:75], v2 offset:18432
v_cvt_pk_bf16_f32 v130, v136, v137
v_mfma_f32_16x16x32_bf16 v[168:171], a[108:111], v[100:103], v[168:171]
v_exp_f32 v11, v71
v_mfma_f32_16x16x32_bf16 v[172:175], a[108:111], v[108:111], v[172:175]
ds_read_b128 a[76:79], v2 offset:19456
v_add_f32 v27, v27, v11
v_mfma_f32_16x16x32_bf16 v[172:175], a[104:107], v[104:107], v[172:175]
s_waitcnt lgkmcnt(7)
buffer_load_dwordx4 v115, s[36:39], s81 offen offset:3072 lds
v_mfma_f32_16x16x32_bf16 v[176:179], a[112:115], v[96:99], v[176:179]
s_waitcnt lgkmcnt(6)
ds_read_b128 a[80:83], v2 offset:20480
v_cvt_pk_bf16_f32 v121, v10, v11
v_mfma_f32_16x16x32_bf16 v[176:179], a[116:119], v[100:103], v[176:179]
s_waitcnt lgkmcnt(6)
v_exp_f32 v12, v76
v_mfma_f32_16x16x32_bf16 v[180:183], a[116:119], v[108:111], v[180:183]
s_add_u32 s81, s81, 28672
ds_read_b128 a[84:87], v2 offset:21504
v_add_f32 v27, v27, v12
v_mfma_f32_16x16x32_bf16 v[180:183], a[112:115], v[104:107], v[180:183]
s_add_u32 m0, s18, 36864
v_exp_f32 v13, v77
v_mfma_f32_16x16x32_bf16 v[184:187], a[120:123], v[96:99], v[184:187]
s_waitcnt lgkmcnt(6)
ds_read_b128 a[88:91], v2 offset:22528
v_add_f32 v27, v27, v13
v_mfma_f32_16x16x32_bf16 v[184:187], a[124:127], v[100:103], v[184:187]
buffer_load_dwordx4 v112, s[36:39], s81 offen offset:0 lds
v_mfma_f32_16x16x32_bf16 v[188:191], a[124:127], v[108:111], v[188:191]
ds_read_b128 a[92:95], v2 offset:23552
v_cvt_pk_bf16_f32 v122, v12, v13
v_mfma_f32_16x16x32_bf16 v[188:191], a[120:123], v[104:107], v[188:191]
s_waitcnt lgkmcnt(7)
v_exp_f32 v14, v78
v_mfma_f32_16x16x32_bf16 v[192:195], a[64:67], v[96:99], v[192:195]
s_waitcnt lgkmcnt(6)
ds_read_b128 a[96:99], v2 offset:24576
v_add_f32 v27, v27, v14
v_mfma_f32_16x16x32_bf16 v[192:195], a[68:71], v[100:103], v[192:195]
buffer_load_dwordx4 v113, s[36:39], s81 offen offset:1024 lds
v_mfma_f32_16x16x32_bf16 v[196:199], a[68:71], v[108:111], v[196:199]
ds_read_b128 a[100:103], v2 offset:25600
v_cvt_pk_bf16_f32 v131, v138, v139
v_mfma_f32_16x16x32_bf16 v[196:199], a[64:67], v[104:107], v[196:199]
s_waitcnt lgkmcnt(7)
v_exp_f32 v15, v79
v_mfma_f32_16x16x32_bf16 v[200:203], a[72:75], v[96:99], v[200:203]
s_waitcnt lgkmcnt(6)
ds_read_b128 a[104:107], v2 offset:26624
v_add_f32 v27, v27, v15
v_mfma_f32_16x16x32_bf16 v[200:203], a[76:79], v[100:103], v[200:203]
buffer_load_dwordx4 v114, s[36:39], s81 offen offset:2048 lds
v_mfma_f32_16x16x32_bf16 v[204:207], a[76:79], v[108:111], v[204:207]
ds_read_b128 a[108:111], v2 offset:27648
v_cvt_pk_bf16_f32 v123, v14, v15
v_mfma_f32_16x16x32_bf16 v[204:207], a[72:75], v[104:107], v[204:207]
s_waitcnt lgkmcnt(7)
v_exp_f32 v8, v84
v_mfma_f32_16x16x32_bf16 v[208:211], a[80:83], v[96:99], v[208:211]
s_waitcnt lgkmcnt(6)
ds_read_b128 a[112:115], v2 offset:28672
v_add_f32 v27, v27, v8
v_mfma_f32_16x16x32_bf16 v[208:211], a[84:87], v[100:103], v[208:211]
buffer_load_dwordx4 v115, s[36:39], s81 offen offset:3072 lds
v_mfma_f32_16x16x32_bf16 v[212:215], a[84:87], v[108:111], v[212:215]
ds_read_b128 a[116:119], v2 offset:29696
v_cvt_pk_bf16_f32 v144, v144, v145
v_mfma_f32_16x16x32_bf16 v[212:215], a[80:83], v[104:107], v[212:215]
s_waitcnt lgkmcnt(6)
v_exp_f32 v9, v85
v_mfma_f32_16x16x32_bf16 v[216:219], a[88:91], v[96:99], v[216:219]
s_sub_u32 s81, s81, 28544
ds_read_b128 a[120:123], v2 offset:30720
v_add_f32 v27, v27, v9
v_mfma_f32_16x16x32_bf16 v[216:219], a[92:95], v[100:103], v[216:219]
v_exp_f32 v10, v86
v_mfma_f32_16x16x32_bf16 v[220:223], a[92:95], v[108:111], v[220:223]
ds_read_b128 a[124:127], v2 offset:31744
v_cvt_pk_bf16_f32 v124, v8, v9
v_mfma_f32_16x16x32_bf16 v[220:223], a[88:91], v[104:107], v[220:223]
s_waitcnt vmcnt(8) lgkmcnt(7)
s_barrier
v_add_f32 v27, v27, v10
v_mfma_f32_16x16x32_bf16 v[224:227], a[96:99], v[96:99], v[224:227]
s_waitcnt lgkmcnt(6)
ds_read_b128 a[64:67], v1 offset:0
v_cvt_pk_bf16_f32 v145, v146, v147
v_mfma_f32_16x16x32_bf16 v[224:227], a[100:103], v[100:103], v[224:227]
v_exp_f32 v11, v87
v_mfma_f32_16x16x32_bf16 v[228:231], a[100:103], v[108:111], v[228:231]
ds_read_b128 a[68:71], v1 offset:1024
v_add_f32 v27, v27, v11
v_mfma_f32_16x16x32_bf16 v[228:231], a[96:99], v[104:107], v[228:231]
s_waitcnt lgkmcnt(7)
v_exp_f32 v12, v92
v_mfma_f32_16x16x32_bf16 v[232:235], a[104:107], v[96:99], v[232:235]
s_waitcnt lgkmcnt(6)
ds_read_b128 a[72:75], v1 offset:2048
v_cvt_pk_bf16_f32 v125, v10, v11
v_mfma_f32_16x16x32_bf16 v[232:235], a[108:111], v[100:103], v[232:235]
v_exp_f32 v13, v93
v_mfma_f32_16x16x32_bf16 v[236:239], a[108:111], v[108:111], v[236:239]
ds_read_b128 a[76:79], v1 offset:3072
v_add_f32 v27, v27, v12
v_mfma_f32_16x16x32_bf16 v[236:239], a[104:107], v[104:107], v[236:239]
s_waitcnt lgkmcnt(7)
v_exp_f32 v14, v94
v_mfma_f32_16x16x32_bf16 v[240:243], a[112:115], v[96:99], v[240:243]
s_waitcnt lgkmcnt(6)
ds_read_b128 a[80:83], v1 offset:4096
v_add_f32 v27, v27, v13
v_mfma_f32_16x16x32_bf16 v[240:243], a[116:119], v[100:103], v[240:243]
v_exp_f32 v15, v95
v_mfma_f32_16x16x32_bf16 v[244:247], a[116:119], v[108:111], v[244:247]
ds_read_b128 a[84:87], v1 offset:5120
v_cvt_pk_bf16_f32 v126, v12, v13
v_mfma_f32_16x16x32_bf16 v[244:247], a[112:115], v[104:107], v[244:247]
s_waitcnt lgkmcnt(7)
v_add_f32 v27, v27, v14
v_add_f32 v27, v27, v15
v_mfma_f32_16x16x32_bf16 v[248:251], a[120:123], v[96:99], v[248:251]
s_waitcnt lgkmcnt(6)
ds_read_b128 a[88:91], v1 offset:6144
v_cvt_pk_bf16_f32 v127, v14, v15
v_mfma_f32_16x16x32_bf16 v[248:251], a[124:127], v[100:103], v[248:251]
v_cmp_nge_f32 vcc, s25, v27
v_cvt_pk_bf16_f32 v146, v152, v153
v_mfma_f32_16x16x32_bf16 v[252:255], a[124:127], v[108:111], v[252:255]
ds_read_b128 a[92:95], v1 offset:7168
v_cvt_pk_bf16_f32 v147, v154, v155
v_mfma_f32_16x16x32_bf16 v[252:255], a[120:123], v[104:107], v[252:255]
s_waitcnt lgkmcnt(2)
v_cvt_pk_bf16_f32 v160, v160, v161
v_cvt_pk_bf16_f32 v161, v162, v163
s_cbranch_vccnz Lstub_13
Lback_14:
v_mfma_f32_16x16x32_bf16 v[132:135], a[64:67], v[120:123], v[132:135]
s_lshl_b32 s8, s29, 3
ds_read_b128 a[96:99], v1 offset:8192
v_add_f32 v25, v25, v27
v_mfma_f32_16x16x32_bf16 v[132:135], a[68:71], v[124:127], v[132:135]
s_add_u32 s8, s8, s3
ds_read_b128 a[100:103], v1 offset:9216
v_cvt_pk_bf16_f32 v162, v168, v169
v_mfma_f32_16x16x32_bf16 v[140:143], a[72:75], v[120:123], v[140:143]
s_lshl_b32 s8, s8, 4
ds_read_b128 a[104:107], v1 offset:10240
v_cvt_pk_bf16_f32 v163, v170, v171
v_mfma_f32_16x16x32_bf16 v[140:143], a[76:79], v[124:127], v[140:143]
s_add_u32 s8, s8, s20
ds_read_b128 a[108:111], v1 offset:11264
v_cvt_pk_bf16_f32 v176, v176, v177
v_mfma_f32_16x16x32_bf16 v[148:151], a[80:83], v[120:123], v[148:151]
s_mul_i32 s8, s8, 14336
ds_read_b128 a[112:115], v1 offset:12288
v_cvt_pk_bf16_f32 v177, v178, v179
v_mfma_f32_16x16x32_bf16 v[148:151], a[84:87], v[124:127], v[148:151]
s_waitcnt lgkmcnt(5)
s_add_u32 s8, s8, 104857600
ds_read_b128 a[116:119], v1 offset:13312
v_cvt_pk_bf16_f32 v178, v184, v185
v_mfma_f32_16x16x32_bf16 v[156:159], a[88:91], v[120:123], v[156:159]
s_add_u32 s12, s8, 917504
ds_read_b128 a[120:123], v1 offset:14336
v_cvt_pk_bf16_f32 v179, v186, v187
v_mfma_f32_16x16x32_bf16 v[156:159], a[92:95], v[124:127], v[156:159]
s_waitcnt lgkmcnt(6)
ds_read_b128 a[124:127], v1 offset:15360
v_cvt_pk_bf16_f32 v192, v192, v193
v_mfma_f32_16x16x32_bf16 v[164:167], a[96:99], v[120:123], v[164:167]
s_waitcnt lgkmcnt(6)
ds_read_b128 a[64:67], v1 offset:16384
v_cvt_pk_bf16_f32 v193, v194, v195
v_mfma_f32_16x16x32_bf16 v[164:167], a[100:103], v[124:127], v[164:167]
s_waitcnt lgkmcnt(6)
ds_read_b128 a[68:71], v1 offset:17408
v_cvt_pk_bf16_f32 v194, v200, v201
v_mfma_f32_16x16x32_bf16 v[172:175], a[104:107], v[120:123], v[172:175]
s_waitcnt lgkmcnt(6)
ds_read_b128 a[72:75], v1 offset:18432
v_cvt_pk_bf16_f32 v195, v202, v203
v_mfma_f32_16x16x32_bf16 v[172:175], a[108:111], v[124:127], v[172:175]
s_waitcnt lgkmcnt(6)
ds_read_b128 a[76:79], v1 offset:19456
v_cvt_pk_bf16_f32 v208, v208, v209
v_mfma_f32_16x16x32_bf16 v[180:183], a[112:115], v[120:123], v[180:183]
s_waitcnt lgkmcnt(6)
ds_read_b128 a[80:83], v1 offset:20480
v_cvt_pk_bf16_f32 v209, v210, v211
v_mfma_f32_16x16x32_bf16 v[180:183], a[116:119], v[124:127], v[180:183]
s_waitcnt lgkmcnt(6)
ds_read_b128 a[84:87], v1 offset:21504
v_cvt_pk_bf16_f32 v210, v216, v217
v_mfma_f32_16x16x32_bf16 v[188:191], a[120:123], v[120:123], v[188:191]
s_waitcnt lgkmcnt(6)
ds_read_b128 a[88:91], v1 offset:22528
v_cvt_pk_bf16_f32 v211, v218, v219
v_mfma_f32_16x16x32_bf16 v[188:191], a[124:127], v[124:127], v[188:191]
s_waitcnt lgkmcnt(6)
ds_read_b128 a[92:95], v1 offset:23552
v_cvt_pk_bf16_f32 v224, v224, v225
v_mfma_f32_16x16x32_bf16 v[196:199], a[64:67], v[120:123], v[196:199]
s_waitcnt lgkmcnt(6)
ds_read_b128 a[96:99], v1 offset:24576
v_cvt_pk_bf16_f32 v225, v226, v227
v_mfma_f32_16x16x32_bf16 v[196:199], a[68:71], v[124:127], v[196:199]
s_waitcnt lgkmcnt(6)
ds_read_b128 a[100:103], v1 offset:25600
v_cvt_pk_bf16_f32 v226, v232, v233
v_mfma_f32_16x16x32_bf16 v[204:207], a[72:75], v[120:123], v[204:207]
s_waitcnt lgkmcnt(6)
ds_read_b128 a[104:107], v1 offset:26624
v_cvt_pk_bf16_f32 v227, v234, v235
v_mfma_f32_16x16x32_bf16 v[204:207], a[76:79], v[124:127], v[204:207]
s_waitcnt lgkmcnt(6)
ds_read_b128 a[108:111], v1 offset:27648
v_cvt_pk_bf16_f32 v240, v240, v241
v_mfma_f32_16x16x32_bf16 v[212:215], a[80:83], v[120:123], v[212:215]
s_waitcnt lgkmcnt(6)
ds_read_b128 a[112:115], v1 offset:28672
v_cvt_pk_bf16_f32 v241, v242, v243
v_mfma_f32_16x16x32_bf16 v[212:215], a[84:87], v[124:127], v[212:215]
s_waitcnt lgkmcnt(5)
ds_read_b128 a[116:119], v1 offset:29696
v_cvt_pk_bf16_f32 v242, v248, v249
v_mfma_f32_16x16x32_bf16 v[220:223], a[88:91], v[120:123], v[220:223]
s_add_u32 m0, s18, 98304
ds_read_b128 a[120:123], v1 offset:30720
v_cvt_pk_bf16_f32 v243, v250, v251
v_mfma_f32_16x16x32_bf16 v[220:223], a[92:95], v[124:127], v[220:223]
s_waitcnt lgkmcnt(6)
ds_read_b128 a[124:127], v1 offset:31744
v_cvt_pk_bf16_f32 v132, v132, v133
v_mfma_f32_16x16x32_bf16 v[228:231], a[96:99], v[120:123], v[228:231]
s_waitcnt lgkmcnt(6)
buffer_load_dwordx4 v112, s[36:39], s81 offen offset:0 lds
v_mfma_f32_16x16x32_bf16 v[228:231], a[100:103], v[124:127], v[228:231]
s_waitcnt lgkmcnt(5)
buffer_load_dwordx4 v113, s[36:39], s81 offen offset:1024 lds
v_mfma_f32_16x16x32_bf16 v[236:239], a[104:107], v[120:123], v[236:239]
s_waitcnt lgkmcnt(4)
buffer_load_dwordx4 v114, s[36:39], s81 offen offset:2048 lds
v_mfma_f32_16x16x32_bf16 v[236:239], a[108:111], v[124:127], v[236:239]
s_waitcnt lgkmcnt(1)
buffer_load_dwordx4 v115, s[36:39], s81 offen offset:3072 lds
v_mfma_f32_16x16x32_bf16 v[244:247], a[112:115], v[120:123], v[244:247]
s_add_u32 s81, s81, 28672
v_cvt_pk_bf16_f32 v133, v134, v135
v_cvt_pk_bf16_f32 v134, v140, v141
v_mfma_f32_16x16x32_bf16 v[244:247], a[116:119], v[124:127], v[244:247]
s_add_u32 m0, s18, 102400
v_cvt_pk_bf16_f32 v135, v142, v143
v_cvt_pk_bf16_f32 v148, v148, v149
v_mfma_f32_16x16x32_bf16 v[252:255], a[120:123], v[120:123], v[252:255]
s_waitcnt lgkmcnt(0)
buffer_load_dwordx4 v112, s[36:39], s81 offen offset:0 lds
v_mfma_f32_16x16x32_bf16 v[252:255], a[124:127], v[124:127], v[252:255]
buffer_load_dwordx4 v113, s[36:39], s81 offen offset:1024 lds
buffer_load_dwordx4 v114, s[36:39], s81 offen offset:2048 lds
buffer_load_dwordx4 v115, s[36:39], s81 offen offset:3072 lds
s_sub_u32 s81, s81, 28544
s_add_u32 m0, s18, 131072
s_nop 0
buffer_load_dwordx4 v112, s[36:39], s81 offen offset:0 lds
v_cvt_pk_bf16_f32 v149, v150, v151
v_cvt_pk_bf16_f32 v150, v156, v157
v_cvt_pk_bf16_f32 v151, v158, v159
v_cvt_pk_bf16_f32 v164, v164, v165
buffer_load_dwordx4 v113, s[36:39], s81 offen offset:1024 lds
v_cvt_pk_bf16_f32 v165, v166, v167
v_cvt_pk_bf16_f32 v166, v172, v173
v_cvt_pk_bf16_f32 v167, v174, v175
v_cvt_pk_bf16_f32 v180, v180, v181
buffer_load_dwordx4 v114, s[36:39], s81 offen offset:2048 lds
v_cvt_pk_bf16_f32 v181, v182, v183
v_cvt_pk_bf16_f32 v182, v188, v189
v_cvt_pk_bf16_f32 v183, v190, v191
v_cvt_pk_bf16_f32 v196, v196, v197
buffer_load_dwordx4 v115, s[36:39], s81 offen offset:3072 lds
v_cvt_pk_bf16_f32 v197, v198, v199
v_cvt_pk_bf16_f32 v198, v204, v205
v_cvt_pk_bf16_f32 v199, v206, v207
v_cvt_pk_bf16_f32 v212, v212, v213
s_add_u32 s81, s81, 28672
s_add_u32 m0, s18, 135168
s_nop 0
buffer_load_dwordx4 v112, s[36:39], s81 offen offset:0 lds
v_cvt_pk_bf16_f32 v213, v214, v215
v_cvt_pk_bf16_f32 v214, v220, v221
v_cvt_pk_bf16_f32 v215, v222, v223
v_cvt_pk_bf16_f32 v228, v228, v229
buffer_load_dwordx4 v113, s[36:39], s81 offen offset:1024 lds
v_cvt_pk_bf16_f32 v229, v230, v231
v_cvt_pk_bf16_f32 v230, v236, v237
v_cvt_pk_bf16_f32 v231, v238, v239
v_cvt_pk_bf16_f32 v244, v244, v245
buffer_load_dwordx4 v114, s[36:39], s81 offen offset:2048 lds
v_cvt_pk_bf16_f32 v245, v246, v247
v_cvt_pk_bf16_f32 v246, v252, v253
v_cvt_pk_bf16_f32 v247, v254, v255
buffer_load_dwordx4 v115, s[36:39], s81 offen offset:3072 lds
s_sub_u32 s81, s81, 28544
s_branch K2_done
K2_cfix:
s_nop 7
v_max_f32 v12, 0, v8
v_exp_f32 v13, -v12
v_sub_f32 v8, v8, v12
v_mul_f32 v24, v24, v13
v_mul_f32 v128, v128, v13
v_mul_f32 v129, v129, v13
v_mul_f32 v130, v130, v13
v_mul_f32 v131, v131, v13
v_mul_f32 v136, v136, v13
v_mul_f32 v137, v137, v13
v_mul_f32 v138, v138, v13
v_mul_f32 v139, v139, v13
v_mul_f32 v144, v144, v13
v_mul_f32 v145, v145, v13
v_mul_f32 v146, v146, v13
v_mul_f32 v147, v147, v13
v_mul_f32 v152, v152, v13
v_mul_f32 v153, v153, v13
v_mul_f32 v154, v154, v13
v_mul_f32 v155, v155, v13
v_mul_f32 v160, v160, v13
v_mul_f32 v161, v161, v13
v_mul_f32 v162, v162, v13
v_mul_f32 v163, v163, v13
v_mul_f32 v168, v168, v13
v_mul_f32 v169, v169, v13
v_mul_f32 v170, v170, v13
v_mul_f32 v171, v171, v13
v_mul_f32 v176, v176, v13
v_mul_f32 v177, v177, v13
v_mul_f32 v178, v178, v13
v_mul_f32 v179, v179, v13
v_mul_f32 v184, v184, v13
v_mul_f32 v185, v185, v13
v_mul_f32 v186, v186, v13
v_mul_f32 v187, v187, v13
v_mul_f32 v192, v192, v13
v_mul_f32 v193, v193, v13
v_mul_f32 v194, v194, v13
v_mul_f32 v195, v195, v13
v_mul_f32 v200, v200, v13
v_mul_f32 v201, v201, v13
v_mul_f32 v202, v202, v13
v_mul_f32 v203, v203, v13
v_mul_f32 v208, v208, v13
v_mul_f32 v209, v209, v13
v_mul_f32 v210, v210, v13
v_mul_f32 v211, v211, v13
v_mul_f32 v216, v216, v13
v_mul_f32 v217, v217, v13
v_mul_f32 v218, v218, v13
v_mul_f32 v219, v219, v13
v_mul_f32 v224, v224, v13
v_mul_f32 v225, v225, v13
v_mul_f32 v226, v226, v13
v_mul_f32 v227, v227, v13
v_mul_f32 v232, v232, v13
v_mul_f32 v233, v233, v13
v_mul_f32 v234, v234, v13
v_mul_f32 v235, v235, v13
v_mul_f32 v240, v240, v13
v_mul_f32 v241, v241, v13
v_mul_f32 v242, v242, v13
v_mul_f32 v243, v243, v13
v_mul_f32 v248, v248, v13
v_mul_f32 v249, v249, v13
v_mul_f32 v250, v250, v13
v_mul_f32 v251, v251, v13
v_max_f32 v12, 0, v10
v_exp_f32 v13, -v12
v_sub_f32 v10, v10, v12
v_mul_f32 v25, v25, v13
v_mul_f32 v132, v132, v13
v_mul_f32 v133, v133, v13
v_mul_f32 v134, v134, v13
v_mul_f32 v135, v135, v13
v_mul_f32 v140, v140, v13
v_mul_f32 v141, v141, v13
v_mul_f32 v142, v142, v13
v_mul_f32 v143, v143, v13
v_mul_f32 v148, v148, v13
v_mul_f32 v149, v149, v13
v_mul_f32 v150, v150, v13
v_mul_f32 v151, v151, v13
v_mul_f32 v156, v156, v13
v_mul_f32 v157, v157, v13
v_mul_f32 v158, v158, v13
v_mul_f32 v159, v159, v13
v_mul_f32 v164, v164, v13
v_mul_f32 v165, v165, v13
v_mul_f32 v166, v166, v13
v_mul_f32 v167, v167, v13
v_mul_f32 v172, v172, v13
v_mul_f32 v173, v173, v13
v_mul_f32 v174, v174, v13
v_mul_f32 v175, v175, v13
v_mul_f32 v180, v180, v13
v_mul_f32 v181, v181, v13
v_mul_f32 v182, v182, v13
v_mul_f32 v183, v183, v13
v_mul_f32 v188, v188, v13
v_mul_f32 v189, v189, v13
v_mul_f32 v190, v190, v13
v_mul_f32 v191, v191, v13
v_mul_f32 v196, v196, v13
v_mul_f32 v197, v197, v13
v_mul_f32 v198, v198, v13
v_mul_f32 v199, v199, v13
v_mul_f32 v204, v204, v13
v_mul_f32 v205, v205, v13
v_mul_f32 v206, v206, v13
v_mul_f32 v207, v207, v13
v_mul_f32 v212, v212, v13
v_mul_f32 v213, v213, v13
v_mul_f32 v214, v214, v13
v_mul_f32 v215, v215, v13
v_mul_f32 v220, v220, v13
v_mul_f32 v221, v221, v13
v_mul_f32 v222, v222, v13
v_mul_f32 v223, v223, v13
v_mul_f32 v228, v228, v13
v_mul_f32 v229, v229, v13
v_mul_f32 v230, v230, v13
v_mul_f32 v231, v231, v13
v_mul_f32 v236, v236, v13
v_mul_f32 v237, v237, v13
v_mul_f32 v238, v238, v13
v_mul_f32 v239, v239, v13
v_mul_f32 v244, v244, v13
v_mul_f32 v245, v245, v13
v_mul_f32 v246, v246, v13
v_mul_f32 v247, v247, v13
v_mul_f32 v252, v252, v13
v_mul_f32 v253, v253, v13
v_mul_f32 v254, v254, v13
v_mul_f32 v255, v255, v13
s_branch K2_cok
K2_tspin:
Lp_9101:
buffer_load_dword v3, off, s[4:7], s80 sc1
s_waitcnt vmcnt(0)
v_cmp_gt_u32 vcc, 1, v3
s_cbranch_vccz Lpd_9102
s_sleep 8
s_sub_u32 s101, s101, 1
s_cbranch_scc0 Lp_9101
s_mov_b32 s101, 0
Lpd_9102:
s_branch K2_tok
K2_p0d:
ds_read_b128 a[64:67], v1 offset:0
ds_read_b128 a[68:71], v1 offset:1024
ds_read_b128 a[72:75], v1 offset:2048
ds_read_b128 a[76:79], v1 offset:3072
ds_read_b128 a[80:83], v1 offset:4096
ds_read_b128 a[84:87], v1 offset:5120
ds_read_b128 a[88:91], v1 offset:6144
ds_read_b128 a[92:95], v1 offset:7168
v_cndmask_b32 v32, 0, v7, s[32:33]
v_cndmask_b32 v33, 0, v7, s[34:35]
v_cndmask_b32 v34, 0, v7, s[36:37]
v_cndmask_b32 v35, 0, v7, s[38:39]
v_cndmask_b32 v40, 0, v7, s[40:41]
v_cndmask_b32 v41, 0, v7, s[42:43]
v_cndmask_b32 v42, 0, v7, s[44:45]
v_cndmask_b32 v43, 0, v7, s[46:47]
s_waitcnt lgkmcnt(7)
v_mfma_f32_16x16x32_bf16 v[32:35], a[64:67], a[0:3], v[32:35]
s_waitcnt lgkmcnt(6)
s_add_u32 m0, s18, 65536
ds_read_b128 a[96:99], v1 offset:8192
v_mfma_f32_16x16x32_bf16 v[32:35], a[68:71], a[4:7], v[32:35]
s_waitcnt lgkmcnt(6)
buffer_load_dwordx4 v1, s[4:7], s12 offen offset:0 sc1 lds
v_mfma_f32_16x16x32_bf16 v[32:35], a[72:75], a[8:11], v[32:35]
s_waitcnt lgkmcnt(5)
ds_read_b128 a[100:103], v1 offset:9216
v_mfma_f32_16x16x32_bf16 v[32:35], a[76:79], a[12:15], v[32:35]
s_waitcnt lgkmcnt(5)
buffer_load_dwordx4 v1, s[4:7], s12 offen offset:1024 sc1 lds
v_mfma_f32_16x16x32_bf16 v[32:35], a[80:83], a[16:19], v[32:35]
s_waitcnt lgkmcnt(4)
ds_read_b128 a[104:107], v1 offset:10240
v_mfma_f32_16x16x32_bf16 v[32:35], a[84:87], a[20:23], v[32:35]
s_waitcnt lgkmcnt(4)
buffer_load_dwordx4 v1, s[4:7], s12 offen offset:2048 sc1 lds
v_mfma_f32_16x16x32_bf16 v[32:35], a[88:91], a[24:27], v[32:35]
s_waitcnt lgkmcnt(3)
ds_read_b128 a[108:111], v1 offset:11264
v_mfma_f32_16x16x32_bf16 v[32:35], a[92:95], a[28:31], v[32:35]
buffer_load_dwordx4 v1, s[4:7], s12 offen offset:3072 sc1 lds
v_mfma_f32_16x16x32_bf16 v[36:39], a[64:67], a[32:35], 0
s_add_u32 s12, s12, 4096
s_add_u32 m0, s18, 69632
ds_read_b128 a[112:115], v1 offset:12288
v_mfma_f32_16x16x32_bf16 v[36:39], a[68:71], a[36:39], v[36:39]
buffer_load_dwordx4 v1, s[4:7], s12 offen offset:0 sc1 lds
v_mfma_f32_16x16x32_bf16 v[36:39], a[72:75], a[40:43], v[36:39]
ds_read_b128 a[116:119], v1 offset:13312
v_mfma_f32_16x16x32_bf16 v[36:39], a[76:79], a[44:47], v[36:39]
buffer_load_dwordx4 v1, s[4:7], s12 offen offset:1024 sc1 lds
v_mfma_f32_16x16x32_bf16 v[36:39], a[80:83], a[48:51], v[36:39]
ds_read_b128 a[120:123], v1 offset:14336
v_max3_f32 v28, v32, v33, v34
v_mfma_f32_16x16x32_bf16 v[36:39], a[84:87], a[52:55], v[36:39]
buffer_load_dwordx4 v1, s[4:7], s12 offen offset:2048 sc1 lds
v_mfma_f32_16x16x32_bf16 v[36:39], a[88:91], a[56:59], v[36:39]
ds_read_b128 a[124:127], v1 offset:15360
v_max_f32 v28, v28, v35
v_mfma_f32_16x16x32_bf16 v[36:39], a[92:95], a[60:63], v[36:39]
s_waitcnt lgkmcnt(6)
buffer_load_dwordx4 v1, s[4:7], s12 offen offset:3072 sc1 lds
v_mfma_f32_16x16x32_bf16 v[40:43], a[96:99], a[0:3], v[40:43]
s_add_u32 s12, s12, 28672
ds_read_b128 a[64:67], v1 offset:16384
v_mov_b32 v30, v28
v_mfma_f32_16x16x32_bf16 v[40:43], a[100:103], a[4:7], v[40:43]
s_waitcnt lgkmcnt(2)
s_sub_u32 s13, s13, 1
v_mfma_f32_16x16x32_bf16 v[40:43], a[104:107], a[8:11], v[40:43]
s_cmp_eq_u32 s13, 0
ds_read_b128 a[68:71], v1 offset:17408
v_permlane16_swap_b32 v28, v30
v_mfma_f32_16x16x32_bf16 v[40:43], a[108:111], a[12:15], v[40:43]
s_cselect_b32 s12, s14, s12
v_max_f32 v28, v28, v30
v_mov_b32 v30, v28
v_mfma_f32_16x16x32_bf16 v[40:43], a[112:115], a[16:19], v[40:43]
s_cselect_b32 s13, s15, s13
ds_read_b128 a[72:75], v1 offset:18432
v_max3_f32 v29, v36, v37, v38
v_mfma_f32_16x16x32_bf16 v[40:43], a[116:119], a[20:23], v[40:43]
s_cselect_b32 s14, 3221225472, s14
v_permlane32_swap_b32 v28, v30
v_max_f32 v28, v28, v30
v_mfma_f32_16x16x32_bf16 v[40:43], a[120:123], a[24:27], v[40:43]
s_waitcnt lgkmcnt(3)
ds_read_b128 a[76:79], v1 offset:19456
v_sub_f32 v16, 0, v28
v_mfma_f32_16x16x32_bf16 v[40:43], a[124:127], a[28:31], v[40:43]
v_sub_f32 v17, 0, v28
v_sub_f32 v18, 0, v28
v_mfma_f32_16x16x32_bf16 v[44:47], a[96:99], a[32:35], 0
ds_read_b128 a[80:83], v1 offset:20480
v_sub_f32 v19, 0, v28
v_mfma_f32_16x16x32_bf16 v[44:47], a[100:103], a[36:39], v[44:47]
v_max_f32 v29, v29, v39
v_mov_b32 v31, v29
v_cndmask_b32 v48, v16, v7, s[48:49]
v_mfma_f32_16x16x32_bf16 v[44:47], a[104:107], a[40:43], v[44:47]
ds_read_b128 a[84:87], v1 offset:21504
v_cndmask_b32 v49, v16, v7, s[50:51]
v_mfma_f32_16x16x32_bf16 v[44:47], a[108:111], a[44:47], v[44:47]
v_permlane16_swap_b32 v29, v31
v_max_f32 v29, v29, v31
v_cndmask_b32 v50, v16, v7, s[52:53]
v_mfma_f32_16x16x32_bf16 v[44:47], a[112:115], a[48:51], v[44:47]
ds_read_b128 a[88:91], v1 offset:22528
v_mov_b32 v31, v29
v_cndmask_b32 v51, v16, v7, s[54:55]
v_mfma_f32_16x16x32_bf16 v[44:47], a[116:119], a[52:55], v[44:47]
v_cndmask_b32 v56, v16, v7, s[56:57]
v_cndmask_b32 v57, v16, v7, s[58:59]
v_mfma_f32_16x16x32_bf16 v[44:47], a[120:123], a[56:59], v[44:47]
ds_read_b128 a[92:95], v1 offset:23552
v_permlane32_swap_b32 v29, v31
v_mfma_f32_16x16x32_bf16 v[44:47], a[124:127], a[60:63], v[44:47]
s_waitcnt lgkmcnt(7)
v_max_f32 v29, v29, v31
v_sub_f32 v20, 0, v29
v_mfma_f32_16x16x32_bf16 v[48:51], a[64:67], a[0:3], v[48:51]
s_waitcnt lgkmcnt(6)
ds_read_b128 a[96:99], v1 offset:24576
v_sub_f32 v21, 0, v29
v_mfma_f32_16x16x32_bf16 v[48:51], a[68:71], a[4:7], v[48:51]
s_waitcnt lgkmcnt(6)
v_sub_f32 v22, 0, v29
v_sub_f32 v23, 0, v29
v_mfma_f32_16x16x32_bf16 v[48:51], a[72:75], a[8:11], v[48:51]
s_waitcnt lgkmcnt(5)
ds_read_b128 a[100:103], v1 offset:25600
v_cndmask_b32 v58, v16, v7, s[60:61]
v_mfma_f32_16x16x32_bf16 v[48:51], a[76:79], a[12:15], v[48:51]
s_waitcnt lgkmcnt(5)
v_cndmask_b32 v59, v16, v7, s[62:63]
v_mfma_f32_16x16x32_bf16 v[48:51], a[80:83], a[16:19], v[48:51]
s_waitcnt lgkmcnt(4)
ds_read_b128 a[104:107], v1 offset:26624
v_mfma_f32_16x16x32_bf16 v[48:51], a[84:87], a[20:23], v[48:51]
s_waitcnt lgkmcnt(4)
v_add_f32 v32, v32, v16
v_add_f32 v33, v33, v16
v_add_f32 v34, v34, v16
v_add_f32 v35, v35, v16
v_mfma_f32_16x16x32_bf16 v[48:51], a[88:91], a[24:27], v[48:51]
s_waitcnt lgkmcnt(3)
ds_read_b128 a[108:111], v1 offset:27648
v_add_f32 v36, v36, v20
v_add_f32 v37, v37, v20
v_add_f32 v38, v38, v20
v_add_f32 v39, v39, v20
v_mfma_f32_16x16x32_bf16 v[48:51], a[92:95], a[28:31], v[48:51]
v_add_f32 v40, v40, v16
v_add_f32 v41, v41, v16
v_add_f32 v42, v42, v16
v_add_f32 v43, v43, v16
v_mfma_f32_16x16x32_bf16 v[52:55], a[64:67], a[32:35], v[20:23]
ds_read_b128 a[112:115], v1 offset:28672
v_add_f32 v44, v44, v20
v_add_f32 v45, v45, v20
v_add_f32 v46, v46, v20
v_add_f32 v47, v47, v20
v_mfma_f32_16x16x32_bf16 v[52:55], a[68:71], a[36:39], v[52:55]
v_exp_f32 v8, v32
v_mfma_f32_16x16x32_bf16 v[52:55], a[72:75], a[40:43], v[52:55]
ds_read_b128 a[116:119], v1 offset:29696
v_exp_f32 v9, v33
v_mfma_f32_16x16x32_bf16 v[52:55], a[76:79], a[44:47], v[52:55]
v_exp_f32 v10, v34
v_mfma_f32_16x16x32_bf16 v[52:55], a[80:83], a[48:51], v[52:55]
ds_read_b128 a[120:123], v1 offset:30720
v_exp_f32 v11, v35
v_mfma_f32_16x16x32_bf16 v[52:55], a[84:87], a[52:55], v[52:55]
v_exp_f32 v12, v36
v_mfma_f32_16x16x32_bf16 v[52:55], a[88:91], a[56:59], v[52:55]
ds_read_b128 a[124:127], v1 offset:31744
v_exp_f32 v13, v37
v_mfma_f32_16x16x32_bf16 v[52:55], a[92:95], a[60:63], v[52:55]
s_waitcnt vmcnt(8) lgkmcnt(7)
s_barrier
v_add_f32 v26, v8, v9
v_cvt_pk_bf16_f32 v96, v8, v9
v_add_f32 v26, v26, v10
v_add_f32 v26, v26, v11
v_cvt_pk_bf16_f32 v97, v10, v11
v_add_f32 v27, v12, v13
v_cvt_pk_bf16_f32 v104, v12, v13
v_mfma_f32_16x16x32_bf16 v[56:59], a[96:99], a[0:3], v[56:59]
s_waitcnt lgkmcnt(6)
ds_read_b128 a[64:67], v4 offset:0
v_exp_f32 v14, v38
v_mfma_f32_16x16x32_bf16 v[56:59], a[100:103], a[4:7], v[56:59]
s_waitcnt lgkmcnt(6)
buffer_store_dword v6, v5, s[4:7], s71 offen sc1
v_add_f32 v27, v27, v14
v_mfma_f32_16x16x32_bf16 v[56:59], a[104:107], a[8:11], v[56:59]
s_waitcnt lgkmcnt(5)
ds_read_b128 a[68:71], v4 offset:1024
v_exp_f32 v15, v39
v_mfma_f32_16x16x32_bf16 v[56:59], a[108:111], a[12:15], v[56:59]
s_waitcnt lgkmcnt(5)
v_exp_f32 v8, v40
v_mfma_f32_16x16x32_bf16 v[56:59], a[112:115], a[16:19], v[56:59]
s_waitcnt lgkmcnt(4)
ds_read_b128 a[72:75], v4 offset:2048
v_exp_f32 v9, v41
v_mfma_f32_16x16x32_bf16 v[56:59], a[116:119], a[20:23], v[56:59]
s_waitcnt lgkmcnt(4)
v_exp_f32 v10, v42
v_mfma_f32_16x16x32_bf16 v[56:59], a[120:123], a[24:27], v[56:59]
s_waitcnt lgkmcnt(3)
ds_read_b128 a[76:79], v4 offset:3072
v_add_f32 v27, v27, v15
v_cvt_pk_bf16_f32 v105, v14, v15
v_add_f32 v26, v26, v8
v_add_f32 v26, v26, v9
v_cvt_pk_bf16_f32 v98, v8, v9
v_add_f32 v26, v26, v10
v_mfma_f32_16x16x32_bf16 v[56:59], a[124:127], a[28:31], v[56:59]
v_exp_f32 v11, v43
v_mfma_f32_16x16x32_bf16 v[60:63], a[96:99], a[32:35], v[20:23]
ds_read_b128 a[80:83], v4 offset:4096
v_exp_f32 v12, v44
v_mfma_f32_16x16x32_bf16 v[60:63], a[100:103], a[36:39], v[60:63]
v_exp_f32 v13, v45
v_mfma_f32_16x16x32_bf16 v[60:63], a[104:107], a[40:43], v[60:63]
ds_read_b128 a[84:87], v4 offset:5120
v_exp_f32 v14, v46
v_mfma_f32_16x16x32_bf16 v[60:63], a[108:111], a[44:47], v[60:63]
v_exp_f32 v15, v47
v_mfma_f32_16x16x32_bf16 v[60:63], a[112:115], a[48:51], v[60:63]
ds_read_b128 a[88:91], v4 offset:6144
v_add_f32 v26, v26, v11
v_cvt_pk_bf16_f32 v99, v10, v11
v_mfma_f32_16x16x32_bf16 v[60:63], a[116:119], a[52:55], v[60:63]
v_add_f32 v27, v27, v12
v_add_f32 v27, v27, v13
v_cvt_pk_bf16_f32 v106, v12, v13
v_mfma_f32_16x16x32_bf16 v[60:63], a[120:123], a[56:59], v[60:63]
s_waitcnt lgkmcnt(7)
s_barrier
ds_read_b128 a[92:95], v4 offset:7168
v_mfma_f32_16x16x32_bf16 v[60:63], a[124:127], a[60:63], v[60:63]
s_waitcnt lgkmcnt(6)
v_add_f32 v27, v27, v14
v_add_f32 v27, v27, v15
v_cvt_pk_bf16_f32 v107, v14, v15
s_branch K2_dx1
K2_ntail:
v_mfma_f32_16x16x32_bf16 v[128:131], a[64:67], v[96:99], v[128:131]
s_add_u32 m0, s18, 98304
ds_read_b128 a[96:99], v2 offset:8192
v_add_f32 v24, v24, v26
v_mfma_f32_16x16x32_bf16 v[128:131], a[68:71], v[100:103], v[128:131]
buffer_load_dwordx4 v1, s[4:7], s12 offen offset:0 sc1 lds
v_mfma_f32_16x16x32_bf16 v[132:135], a[68:71], v[108:111], v[132:135]
ds_read_b128 a[100:103], v2 offset:9216
v_add_f32 v25, v25, v27
v_mfma_f32_16x16x32_bf16 v[132:135], a[64:67], v[104:107], v[132:135]
s_waitcnt lgkmcnt(7)
buffer_load_dwordx4 v1, s[4:7], s12 offen offset:1024 sc1 lds
v_mfma_f32_16x16x32_bf16 v[136:139], a[72:75], v[96:99], v[136:139]
s_waitcnt lgkmcnt(6)
ds_read_b128 a[104:107], v2 offset:10240
v_exp_f32 v8, v64
v_mfma_f32_16x16x32_bf16 v[136:139], a[76:79], v[100:103], v[136:139]
buffer_load_dwordx4 v1, s[4:7], s12 offen offset:2048 sc1 lds
v_mfma_f32_16x16x32_bf16 v[140:143], a[76:79], v[108:111], v[140:143]
ds_read_b128 a[108:111], v2 offset:11264
v_mfma_f32_16x16x32_bf16 v[140:143], a[72:75], v[104:107], v[140:143]
s_waitcnt lgkmcnt(6)
buffer_load_dwordx4 v1, s[4:7], s12 offen offset:3072 sc1 lds
v_mfma_f32_16x16x32_bf16 v[144:147], a[80:83], v[96:99], v[144:147]
s_add_u32 s12, s12, 4096
s_add_u32 m0, s18, 102400
ds_read_b128 a[112:115], v2 offset:12288
v_mfma_f32_16x16x32_bf16 v[144:147], a[84:87], v[100:103], v[144:147]
buffer_load_dwordx4 v1, s[4:7], s12 offen offset:0 sc1 lds
v_mfma_f32_16x16x32_bf16 v[148:151], a[84:87], v[108:111], v[148:151]
ds_read_b128 a[116:119], v2 offset:13312
v_exp_f32 v9, v65
v_mfma_f32_16x16x32_bf16 v[148:151], a[80:83], v[104:107], v[148:151]
s_waitcnt lgkmcnt(7)
buffer_load_dwordx4 v1, s[4:7], s12 offen offset:1024 sc1 lds
v_mfma_f32_16x16x32_bf16 v[152:155], a[88:91], v[96:99], v[152:155]
s_waitcnt lgkmcnt(6)
ds_read_b128 a[120:123], v2 offset:14336
v_add_f32 v26, v8, v9
v_cvt_pk_bf16_f32 v112, v8, v9
v_mfma_f32_16x16x32_bf16 v[152:155], a[92:95], v[100:103], v[152:155]
buffer_load_dwordx4 v1, s[4:7], s12 offen offset:2048 sc1 lds
v_mfma_f32_16x16x32_bf16 v[156:159], a[92:95], v[108:111], v[156:159]
ds_read_b128 a[124:127], v2 offset:15360
v_exp_f32 v10, v66
v_mfma_f32_16x16x32_bf16 v[156:159], a[88:91], v[104:107], v[156:159]
s_waitcnt lgkmcnt(4)
buffer_load_dwordx4 v1, s[4:7], s12 offen offset:3072 sc1 lds
v_mfma_f32_16x16x32_bf16 v[160:163], a[96:99], v[96:99], v[160:163]
s_add_u32 s12, s12, 28672
ds_read_b128 a[64:67], v2 offset:16384
v_add_f32 v26, v26, v10
v_mfma_f32_16x16x32_bf16 v[160:163], a[100:103], v[100:103], v[160:163]
s_sub_u32 s13, s13, 1
v_exp_f32 v11, v67
v_mfma_f32_16x16x32_bf16 v[164:167], a[100:103], v[108:111], v[164:167]
s_cmp_eq_u32 s13, 0
ds_read_b128 a[68:71], v2 offset:17408
v_exp_f32 v12, v68
v_mfma_f32_16x16x32_bf16 v[164:167], a[96:99], v[104:107], v[164:167]
s_cselect_b32 s12, s14, s12
v_exp_f32 v13, v69
v_mfma_f32_16x16x32_bf16 v[168:171], a[104:107], v[96:99], v[168:171]
s_cselect_b32 s13, s15, s13
ds_read_b128 a[72:75], v2 offset:18432
v_add_f32 v26, v26, v11
v_mfma_f32_16x16x32_bf16 v[168:171], a[108:111], v[100:103], v[168:171]
s_cselect_b32 s14, 3221225472, s14
v_exp_f32 v14, v70
v_mfma_f32_16x16x32_bf16 v[172:175], a[108:111], v[108:111], v[172:175]
ds_read_b128 a[76:79], v2 offset:19456
v_cvt_pk_bf16_f32 v113, v10, v11
v_add_f32 v27, v12, v13
v_cvt_pk_bf16_f32 v120, v12, v13
v_mfma_f32_16x16x32_bf16 v[172:175], a[104:107], v[104:107], v[172:175]
s_waitcnt lgkmcnt(7)
v_exp_f32 v15, v71
v_mfma_f32_16x16x32_bf16 v[176:179], a[112:115], v[96:99], v[176:179]
s_waitcnt lgkmcnt(6)
ds_read_b128 a[80:83], v2 offset:20480
v_exp_f32 v8, v72
v_mfma_f32_16x16x32_bf16 v[176:179], a[116:119], v[100:103], v[176:179]
v_exp_f32 v9, v73
v_mfma_f32_16x16x32_bf16 v[180:183], a[116:119], v[108:111], v[180:183]
ds_read_b128 a[84:87], v2 offset:21504
v_add_f32 v27, v27, v14
v_add_f32 v27, v27, v15
v_cvt_pk_bf16_f32 v121, v14, v15
v_add_f32 v26, v26, v8
v_mfma_f32_16x16x32_bf16 v[180:183], a[112:115], v[104:107], v[180:183]
s_waitcnt lgkmcnt(7)
v_exp_f32 v10, v74
v_mfma_f32_16x16x32_bf16 v[184:187], a[120:123], v[96:99], v[184:187]
s_waitcnt lgkmcnt(6)
ds_read_b128 a[88:91], v2 offset:22528
v_exp_f32 v11, v75
v_mfma_f32_16x16x32_bf16 v[184:187], a[124:127], v[100:103], v[184:187]
v_exp_f32 v12, v76
v_mfma_f32_16x16x32_bf16 v[188:191], a[124:127], v[108:111], v[188:191]
ds_read_b128 a[92:95], v2 offset:23552
v_add_f32 v26, v26, v9
v_cvt_pk_bf16_f32 v114, v8, v9
v_add_f32 v26, v26, v10
v_add_f32 v26, v26, v11
v_cvt_pk_bf16_f32 v115, v10, v11
v_mfma_f32_16x16x32_bf16 v[188:191], a[120:123], v[104:107], v[188:191]
s_waitcnt lgkmcnt(7)
v_exp_f32 v13, v77
v_mfma_f32_16x16x32_bf16 v[192:195], a[64:67], v[96:99], v[192:195]
s_waitcnt lgkmcnt(6)
ds_read_b128 a[96:99], v2 offset:24576
v_exp_f32 v14, v78
v_mfma_f32_16x16x32_bf16 v[192:195], a[68:71], v[100:103], v[192:195]
v_exp_f32 v15, v79
v_mfma_f32_16x16x32_bf16 v[196:199], a[68:71], v[108:111], v[196:199]
ds_read_b128 a[100:103], v2 offset:25600
v_add_f32 v27, v27, v12
v_add_f32 v27, v27, v13
v_cvt_pk_bf16_f32 v122, v12, v13
v_add_f32 v27, v27, v14
v_mfma_f32_16x16x32_bf16 v[196:199], a[64:67], v[104:107], v[196:199]
s_waitcnt lgkmcnt(7)
v_exp_f32 v8, v80
v_mfma_f32_16x16x32_bf16 v[200:203], a[72:75], v[96:99], v[200:203]
s_waitcnt lgkmcnt(6)
ds_read_b128 a[104:107], v2 offset:26624
v_exp_f32 v9, v81
v_mfma_f32_16x16x32_bf16 v[200:203], a[76:79], v[100:103], v[200:203]
v_exp_f32 v10, v82
v_mfma_f32_16x16x32_bf16 v[204:207], a[76:79], v[108:111], v[204:207]
ds_read_b128 a[108:111], v2 offset:27648
v_add_f32 v27, v27, v15
v_cvt_pk_bf16_f32 v123, v14, v15
v_mfma_f32_16x16x32_bf16 v[204:207], a[72:75], v[104:107], v[204:207]
s_waitcnt lgkmcnt(7)
v_exp_f32 v11, v83
v_mfma_f32_16x16x32_bf16 v[208:211], a[80:83], v[96:99], v[208:211]
s_waitcnt lgkmcnt(6)
ds_read_b128 a[112:115], v2 offset:28672
v_add_f32 v26, v26, v8
v_add_f32 v26, v26, v9
v_cvt_pk_bf16_f32 v116, v8, v9
v_add_f32 v26, v26, v10
v_mfma_f32_16x16x32_bf16 v[208:211], a[84:87], v[100:103], v[208:211]
v_exp_f32 v12, v84
v_mfma_f32_16x16x32_bf16 v[212:215], a[84:87], v[108:111], v[212:215]
ds_read_b128 a[116:119], v2 offset:29696
v_exp_f32 v13, v85
v_mfma_f32_16x16x32_bf16 v[212:215], a[80:83], v[104:107], v[212:215]
s_waitcnt lgkmcnt(7)
v_exp_f32 v14, v86
v_mfma_f32_16x16x32_bf16 v[216:219], a[88:91], v[96:99], v[216:219]
s_waitcnt lgkmcnt(6)
ds_read_b128 a[120:123], v2 offset:30720
v_add_f32 v26, v26, v11
v_cvt_pk_bf16_f32 v117, v10, v11
v_add_f32 v27, v27, v12
v_mfma_f32_16x16x32_bf16 v[216:219], a[92:95], v[100:103], v[216:219]
v_exp_f32 v15, v87
v_mfma_f32_16x16x32_bf16 v[220:223], a[92:95], v[108:111], v[220:223]
ds_read_b128 a[124:127], v2 offset:31744
v_exp_f32 v8, v88
v_mfma_f32_16x16x32_bf16 v[220:223], a[88:91], v[104:107], v[220:223]
s_waitcnt vmcnt(0) lgkmcnt(7)
s_barrier
v_add_f32 v27, v27, v13
v_cvt_pk_bf16_f32 v124, v12, v13
v_add_f32 v27, v27, v14
v_mfma_f32_16x16x32_bf16 v[224:227], a[96:99], v[96:99], v[224:227]
s_waitcnt lgkmcnt(6)
ds_read_b128 a[64:67], v2 offset:32768
v_exp_f32 v9, v89
v_mfma_f32_16x16x32_bf16 v[224:227], a[100:103], v[100:103], v[224:227]
v_exp_f32 v10, v90
v_mfma_f32_16x16x32_bf16 v[228:231], a[100:103], v[108:111], v[228:231]
ds_read_b128 a[68:71], v2 offset:33792
v_add_f32 v27, v27, v15
v_cvt_pk_bf16_f32 v125, v14, v15
v_add_f32 v26, v26, v8
v_add_f32 v26, v26, v9
v_cvt_pk_bf16_f32 v118, v8, v9
v_mfma_f32_16x16x32_bf16 v[228:231], a[96:99], v[104:107], v[228:231]
s_waitcnt lgkmcnt(7)
v_exp_f32 v11, v91
v_mfma_f32_16x16x32_bf16 v[232:235], a[104:107], v[96:99], v[232:235]
s_waitcnt lgkmcnt(6)
ds_read_b128 a[72:75], v2 offset:34816
v_exp_f32 v12, v92
v_mfma_f32_16x16x32_bf16 v[232:235], a[108:111], v[100:103], v[232:235]
v_exp_f32 v13, v93
v_mfma_f32_16x16x32_bf16 v[236:239], a[108:111], v[108:111], v[236:239]
ds_read_b128 a[76:79], v2 offset:35840
v_add_f32 v26, v26, v10
v_mfma_f32_16x16x32_bf16 v[236:239], a[104:107], v[104:107], v[236:239]
s_waitcnt lgkmcnt(7)
v_exp_f32 v14, v94
v_mfma_f32_16x16x32_bf16 v[240:243], a[112:115], v[96:99], v[240:243]
s_waitcnt lgkmcnt(6)
ds_read_b128 a[80:83], v2 offset:36864
v_add_f32 v26, v26, v11
v_cvt_pk_bf16_f32 v119, v10, v11
v_add_f32 v27, v27, v12
v_mfma_f32_16x16x32_bf16 v[240:243], a[116:119], v[100:103], v[240:243]
v_exp_f32 v15, v95
v_mfma_f32_16x16x32_bf16 v[244:247], a[116:119], v[108:111], v[244:247]
ds_read_b128 a[84:87], v2 offset:37888
v_add_f32 v27, v27, v13
v_cvt_pk_bf16_f32 v126, v12, v13
v_mfma_f32_16x16x32_bf16 v[244:247], a[112:115], v[104:107], v[244:247]
s_waitcnt lgkmcnt(7)
v_add_f32 v27, v27, v14
v_add_f32 v27, v27, v15
v_mfma_f32_16x16x32_bf16 v[248:251], a[120:123], v[96:99], v[248:251]
s_waitcnt lgkmcnt(6)
ds_read_b128 a[88:91], v2 offset:38912
v_cvt_pk_bf16_f32 v127, v14, v15
v_mfma_f32_16x16x32_bf16 v[248:251], a[124:127], v[100:103], v[248:251]
v_add_f32 v28, v26, v27
v_cmp_nge_f32 vcc, s25, v28
v_mfma_f32_16x16x32_bf16 v[252:255], a[124:127], v[108:111], v[252:255]
ds_read_b128 a[92:95], v2 offset:39936
v_mfma_f32_16x16x32_bf16 v[252:255], a[120:123], v[104:107], v[252:255]
s_waitcnt lgkmcnt(6)
s_cbranch_vccnz Lstub_15
Lback_16:
v_mfma_f32_16x16x32_bf16 v[128:131], a[64:67], v[112:115], v[128:131]
s_add_u32 m0, s18, 131072
ds_read_b128 a[96:99], v2 offset:40960
v_add_f32 v24, v24, v26
v_mfma_f32_16x16x32_bf16 v[128:131], a[68:71], v[116:119], v[128:131]
buffer_load_dwordx4 v1, s[4:7], s8 offen offset:0 sc1 lds
v_mfma_f32_16x16x32_bf16 v[132:135], a[68:71], v[124:127], v[132:135]
ds_read_b128 a[100:103], v2 offset:41984
v_add_f32 v25, v25, v27
v_mfma_f32_16x16x32_bf16 v[132:135], a[64:67], v[120:123], v[132:135]
s_waitcnt lgkmcnt(7)
buffer_load_dwordx4 v1, s[4:7], s8 offen offset:1024 sc1 lds
v_mfma_f32_16x16x32_bf16 v[136:139], a[72:75], v[112:115], v[136:139]
s_waitcnt lgkmcnt(6)
ds_read_b128 a[104:107], v2 offset:43008
v_mov_b32 v8, v16
v_mfma_f32_16x16x32_bf16 v[136:139], a[76:79], v[116:119], v[136:139]
buffer_load_dwordx4 v1, s[4:7], s8 offen offset:2048 sc1 lds
v_mfma_f32_16x16x32_bf16 v[140:143], a[76:79], v[124:127], v[140:143]
ds_read_b128 a[108:111], v2 offset:44032
v_mov_b32 v9, v24
v_mfma_f32_16x16x32_bf16 v[140:143], a[72:75], v[120:123], v[140:143]
s_waitcnt lgkmcnt(6)
buffer_load_dwordx4 v1, s[4:7], s8 offen offset:3072 sc1 lds
v_mfma_f32_16x16x32_bf16 v[144:147], a[80:83], v[112:115], v[144:147]
s_add_u32 s8, s8, 4096
s_add_u32 m0, s18, 135168
ds_read_b128 a[112:115], v2 offset:45056
v_mfma_f32_16x16x32_bf16 v[144:147], a[84:87], v[116:119], v[144:147]
buffer_load_dwordx4 v1, s[4:7], s8 offen offset:0 sc1 lds
v_mfma_f32_16x16x32_bf16 v[148:151], a[84:87], v[124:127], v[148:151]
ds_read_b128 a[116:119], v2 offset:46080
v_mov_b32 v10, v20
v_mfma_f32_16x16x32_bf16 v[148:151], a[80:83], v[120:123], v[148:151]
s_waitcnt lgkmcnt(7)
buffer_load_dwordx4 v1, s[4:7], s8 offen offset:1024 sc1 lds
v_mfma_f32_16x16x32_bf16 v[152:155], a[88:91], v[112:115], v[152:155]
s_waitcnt lgkmcnt(6)
ds_read_b128 a[120:123], v2 offset:47104
v_mov_b32 v11, v25
v_mfma_f32_16x16x32_bf16 v[152:155], a[92:95], v[116:119], v[152:155]
buffer_load_dwordx4 v1, s[4:7], s8 offen offset:2048 sc1 lds
v_mfma_f32_16x16x32_bf16 v[156:159], a[92:95], v[124:127], v[156:159]
ds_read_b128 a[124:127], v2 offset:48128
v_cvt_pk_bf16_f32 v128, v128, v129
v_mfma_f32_16x16x32_bf16 v[156:159], a[88:91], v[120:123], v[156:159]
s_waitcnt lgkmcnt(4)
buffer_load_dwordx4 v1, s[4:7], s8 offen offset:3072 sc1 lds
v_mfma_f32_16x16x32_bf16 v[160:163], a[96:99], v[112:115], v[160:163]
s_add_u32 s8, s8, 28672
ds_read_b128 a[64:67], v2 offset:49152
v_cvt_pk_bf16_f32 v129, v130, v131
v_mfma_f32_16x16x32_bf16 v[160:163], a[100:103], v[116:119], v[160:163]
s_sub_u32 s9, s9, 1
buffer_store_dwordx4 v[8:11], v1, s[4:7], s27 offen sc1
v_mfma_f32_16x16x32_bf16 v[164:167], a[100:103], v[124:127], v[164:167]
s_cmp_eq_u32 s9, 0
ds_read_b128 a[68:71], v2 offset:50176
v_cvt_pk_bf16_f32 v130, v136, v137
v_mfma_f32_16x16x32_bf16 v[164:167], a[96:99], v[120:123], v[164:167]
s_cselect_b32 s8, s10, s8
v_cvt_pk_bf16_f32 v131, v138, v139
v_accvgpr_mov_b32 a0, a192
v_mfma_f32_16x16x32_bf16 v[168:171], a[104:107], v[112:115], v[168:171]
s_cselect_b32 s9, s11, s9
ds_read_b128 a[72:75], v2 offset:51200
v_accvgpr_mov_b32 a1, a193
v_mfma_f32_16x16x32_bf16 v[168:171], a[108:111], v[116:119], v[168:171]
s_cselect_b32 s10, 3221225472, s10
buffer_store_dwordx4 v[128:131], v1, s[4:7], s76 offen offset:0 sc1
v_mfma_f32_16x16x32_bf16 v[172:175], a[108:111], v[124:127], v[172:175]
ds_read_b128 a[76:79], v2 offset:52224
v_cvt_pk_bf16_f32 v132, v132, v133
v_mfma_f32_16x16x32_bf16 v[172:175], a[104:107], v[120:123], v[172:175]
s_waitcnt lgkmcnt(7)
v_cvt_pk_bf16_f32 v133, v134, v135
v_cvt_pk_bf16_f32 v134, v140, v141
v_mfma_f32_16x16x32_bf16 v[176:179], a[112:115], v[112:115], v[176:179]
s_waitcnt lgkmcnt(6)
ds_read_b128 a[80:83], v2 offset:53248
v_cvt_pk_bf16_f32 v135, v142, v143
v_mfma_f32_16x16x32_bf16 v[176:179], a[116:119], v[116:119], v[176:179]
buffer_store_dwordx4 v[132:135], v1, s[4:7], s77 offen offset:0 sc1
v_mfma_f32_16x16x32_bf16 v[180:183], a[116:119], v[124:127], v[180:183]
ds_read_b128 a[84:87], v2 offset:54272
v_cvt_pk_bf16_f32 v144, v144, v145
v_mfma_f32_16x16x32_bf16 v[180:183], a[112:115], v[120:123], v[180:183]
s_waitcnt lgkmcnt(7)
v_cvt_pk_bf16_f32 v145, v146, v147
v_cvt_pk_bf16_f32 v146, v152, v153
v_mfma_f32_16x16x32_bf16 v[184:187], a[120:123], v[112:115], v[184:187]
s_waitcnt lgkmcnt(6)
ds_read_b128 a[88:91], v2 offset:55296
v_cvt_pk_bf16_f32 v147, v154, v155
v_mfma_f32_16x16x32_bf16 v[184:187], a[124:127], v[116:119], v[184:187]
buffer_store_dwordx4 v[144:147], v1, s[4:7], s76 offen offset:1024 sc1
v_mfma_f32_16x16x32_bf16 v[188:191], a[124:127], v[124:127], v[188:191]
ds_read_b128 a[92:95], v2 offset:56320
v_cvt_pk_bf16_f32 v148, v148, v149
v_mfma_f32_16x16x32_bf16 v[188:191], a[120:123], v[120:123], v[188:191]
s_waitcnt lgkmcnt(7)
v_cvt_pk_bf16_f32 v149, v150, v151
v_cvt_pk_bf16_f32 v150, v156, v157
v_mfma_f32_16x16x32_bf16 v[192:195], a[64:67], v[112:115], v[192:195]
s_waitcnt lgkmcnt(6)
ds_read_b128 a[96:99], v2 offset:57344
v_cvt_pk_bf16_f32 v151, v158, v159
v_mfma_f32_16x16x32_bf16 v[192:195], a[68:71], v[116:119], v[192:195]
buffer_store_dwordx4 v[148:151], v1, s[4:7], s77 offen offset:1024 sc1
v_mfma_f32_16x16x32_bf16 v[196:199], a[68:71], v[124:127], v[196:199]
ds_read_b128 a[100:103], v2 offset:58368
v_cvt_pk_bf16_f32 v160, v160, v161
v_mfma_f32_16x16x32_bf16 v[196:199], a[64:67], v[120:123], v[196:199]
s_waitcnt lgkmcnt(7)
v_cvt_pk_bf16_f32 v161, v162, v163
v_cvt_pk_bf16_f32 v162, v168, v169
v_mfma_f32_16x16x32_bf16 v[200:203], a[72:75], v[112:115], v[200:203]
s_waitcnt lgkmcnt(6)
ds_read_b128 a[104:107], v2 offset:59392
v_cvt_pk_bf16_f32 v163, v170, v171
v_mfma_f32_16x16x32_bf16 v[200:203], a[76:79], v[116:119], v[200:203]
buffer_store_dwordx4 v[160:163], v1, s[4:7], s76 offen offset:2048 sc1
v_mfma_f32_16x16x32_bf16 v[204:207], a[76:79], v[124:127], v[204:207]
ds_read_b128 a[108:111], v2 offset:60416
v_cvt_pk_bf16_f32 v164, v164, v165
v_mfma_f32_16x16x32_bf16 v[204:207], a[72:75], v[120:123], v[204:207]
s_waitcnt lgkmcnt(7)
v_cvt_pk_bf16_f32 v165, v166, v167
v_cvt_pk_bf16_f32 v166, v172, v173
v_mfma_f32_16x16x32_bf16 v[208:211], a[80:83], v[112:115], v[208:211]
s_waitcnt lgkmcnt(6)
ds_read_b128 a[112:115], v2 offset:61440
v_cvt_pk_bf16_f32 v167, v174, v175
v_mfma_f32_16x16x32_bf16 v[208:211], a[84:87], v[116:119], v[208:211]
buffer_store_dwordx4 v[164:167], v1, s[4:7], s77 offen offset:2048 sc1
v_mfma_f32_16x16x32_bf16 v[212:215], a[84:87], v[124:127], v[212:215]
ds_read_b128 a[116:119], v2 offset:62464
v_cvt_pk_bf16_f32 v176, v176, v177
v_mfma_f32_16x16x32_bf16 v[212:215], a[80:83], v[120:123], v[212:215]
s_waitcnt lgkmcnt(7)
v_cvt_pk_bf16_f32 v177, v178, v179
v_cvt_pk_bf16_f32 v178, v184, v185
v_mfma_f32_16x16x32_bf16 v[216:219], a[88:91], v[112:115], v[216:219]
s_waitcnt lgkmcnt(6)
ds_read_b128 a[120:123], v2 offset:63488
v_cvt_pk_bf16_f32 v179, v186, v187
v_mfma_f32_16x16x32_bf16 v[216:219], a[92:95], v[116:119], v[216:219]
buffer_store_dwordx4 v[176:179], v1, s[4:7], s76 offen offset:3072 sc1
v_mfma_f32_16x16x32_bf16 v[220:223], a[92:95], v[124:127], v[220:223]
ds_read_b128 a[124:127], v2 offset:64512
v_cvt_pk_bf16_f32 v180, v180, v181
v_mfma_f32_16x16x32_bf16 v[220:223], a[88:91], v[120:123], v[220:223]
s_waitcnt lgkmcnt(7)
v_cvt_pk_bf16_f32 v181, v182, v183
v_cvt_pk_bf16_f32 v182, v188, v189
v_mfma_f32_16x16x32_bf16 v[224:227], a[96:99], v[112:115], v[224:227]
s_waitcnt lgkmcnt(6)
v_cvt_pk_bf16_f32 v183, v190, v191
v_accvgpr_mov_b32 a2, a194
v_mfma_f32_16x16x32_bf16 v[224:227], a[100:103], v[116:119], v[224:227]
s_waitcnt lgkmcnt(5)
buffer_store_dwordx4 v[180:183], v1, s[4:7], s77 offen offset:3072 sc1
v_mfma_f32_16x16x32_bf16 v[228:231], a[100:103], v[124:127], v[228:231]
s_add_u32 s76, s76, 4096
v_accvgpr_mov_b32 a3, a195
v_accvgpr_mov_b32 a4, a196
v_mfma_f32_16x16x32_bf16 v[228:231], a[96:99], v[120:123], v[228:231]
s_add_u32 s77, s77, 4096
v_cvt_pk_bf16_f32 v192, v192, v193
v_cvt_pk_bf16_f32 v193, v194, v195
v_mfma_f32_16x16x32_bf16 v[232:235], a[104:107], v[112:115], v[232:235]
s_waitcnt lgkmcnt(4)
v_cvt_pk_bf16_f32 v194, v200, v201
v_cvt_pk_bf16_f32 v195, v202, v203
v_mfma_f32_16x16x32_bf16 v[232:235], a[108:111], v[116:119], v[232:235]
buffer_store_dwordx4 v[192:195], v1, s[4:7], s76 offen offset:0 sc1
v_mfma_f32_16x16x32_bf16 v[236:239], a[108:111], v[124:127], v[236:239]
v_cvt_pk_bf16_f32 v196, v196, v197
v_cvt_pk_bf16_f32 v197, v198, v199
v_mfma_f32_16x16x32_bf16 v[236:239], a[104:107], v[120:123], v[236:239]
s_waitcnt lgkmcnt(3)
v_cvt_pk_bf16_f32 v198, v204, v205
v_cvt_pk_bf16_f32 v199, v206, v207
v_mfma_f32_16x16x32_bf16 v[240:243], a[112:115], v[112:115], v[240:243]
s_waitcnt lgkmcnt(2)
buffer_store_dwordx4 v[196:199], v1, s[4:7], s77 offen offset:0 sc1
v_mfma_f32_16x16x32_bf16 v[240:243], a[116:119], v[116:119], v[240:243]
v_cvt_pk_bf16_f32 v208, v208, v209
v_cvt_pk_bf16_f32 v209, v210, v211
v_mfma_f32_16x16x32_bf16 v[244:247], a[116:119], v[124:127], v[244:247]
v_cvt_pk_bf16_f32 v210, v216, v217
v_cvt_pk_bf16_f32 v211, v218, v219
v_mfma_f32_16x16x32_bf16 v[244:247], a[112:115], v[120:123], v[244:247]
s_waitcnt lgkmcnt(1)
buffer_store_dwordx4 v[208:211], v1, s[4:7], s76 offen offset:1024 sc1
v_mfma_f32_16x16x32_bf16 v[248:251], a[120:123], v[112:115], v[248:251]
s_waitcnt lgkmcnt(0)
v_cvt_pk_bf16_f32 v212, v212, v213
v_cvt_pk_bf16_f32 v213, v214, v215
v_mfma_f32_16x16x32_bf16 v[248:251], a[124:127], v[116:119], v[248:251]
v_cvt_pk_bf16_f32 v214, v220, v221
v_cvt_pk_bf16_f32 v215, v222, v223
v_mfma_f32_16x16x32_bf16 v[252:255], a[124:127], v[124:127], v[252:255]
buffer_store_dwordx4 v[212:215], v1, s[4:7], s77 offen offset:1024 sc1
v_mfma_f32_16x16x32_bf16 v[252:255], a[120:123], v[120:123], v[252:255]
v_cvt_pk_bf16_f32 v224, v224, v225
v_cvt_pk_bf16_f32 v225, v226, v227
v_accvgpr_mov_b32 a5, a197
v_accvgpr_mov_b32 a6, a198
v_accvgpr_mov_b32 a7, a199
v_accvgpr_mov_b32 a8, a200
v_accvgpr_mov_b32 a9, a201
v_accvgpr_mov_b32 a10, a202
v_accvgpr_mov_b32 a11, a203
v_accvgpr_mov_b32 a12, a204
v_cvt_pk_bf16_f32 v226, v232, v233
v_cvt_pk_bf16_f32 v227, v234, v235
buffer_store_dwordx4 v[224:227], v1, s[4:7], s76 offen offset:2048 sc1
v_cvt_pk_bf16_f32 v228, v228, v229
v_cvt_pk_bf16_f32 v229, v230, v231
v_cvt_pk_bf16_f32 v230, v236, v237
v_cvt_pk_bf16_f32 v231, v238, v239
buffer_store_dwordx4 v[228:231], v1, s[4:7], s77 offen offset:2048 sc1
v_cvt_pk_bf16_f32 v240, v240, v241
v_cvt_pk_bf16_f32 v241, v242, v243
v_cvt_pk_bf16_f32 v242, v248, v249
v_cvt_pk_bf16_f32 v243, v250, v251
buffer_store_dwordx4 v[240:243], v1, s[4:7], s76 offen offset:3072 sc1
v_cvt_pk_bf16_f32 v244, v244, v245
v_cvt_pk_bf16_f32 v245, v246, v247
v_cvt_pk_bf16_f32 v246, v252, v253
v_cvt_pk_bf16_f32 v247, v254, v255
buffer_store_dwordx4 v[244:247], v1, s[4:7], s77 offen offset:3072 sc1
v_accvgpr_mov_b32 a13, a205
v_accvgpr_mov_b32 a14, a206
v_accvgpr_mov_b32 a15, a207
v_accvgpr_mov_b32 a16, a208
v_accvgpr_mov_b32 a17, a209
v_accvgpr_mov_b32 a18, a210
v_accvgpr_mov_b32 a19, a211
v_accvgpr_mov_b32 a20, a212
v_accvgpr_mov_b32 a21, a213
v_accvgpr_mov_b32 a22, a214
v_accvgpr_mov_b32 a23, a215
v_accvgpr_mov_b32 a24, a216
v_accvgpr_mov_b32 a25, a217
v_accvgpr_mov_b32 a26, a218
v_accvgpr_mov_b32 a27, a219
v_accvgpr_mov_b32 a28, a220
v_accvgpr_mov_b32 a29, a221
v_accvgpr_mov_b32 a30, a222
v_accvgpr_mov_b32 a31, a223
v_accvgpr_mov_b32 a32, a224
v_accvgpr_mov_b32 a33, a225
v_accvgpr_mov_b32 a34, a226
v_accvgpr_mov_b32 a35, a227
v_accvgpr_mov_b32 a36, a228
v_accvgpr_mov_b32 a37, a229
v_accvgpr_mov_b32 a38, a230
v_accvgpr_mov_b32 a39, a231
v_accvgpr_mov_b32 a40, a232
v_accvgpr_mov_b32 a41, a233
v_accvgpr_mov_b32 a42, a234
v_accvgpr_mov_b32 a43, a235
v_accvgpr_mov_b32 a44, a236
v_accvgpr_mov_b32 a45, a237
v_accvgpr_mov_b32 a46, a238
v_accvgpr_mov_b32 a47, a239
v_accvgpr_mov_b32 a48, a240
v_accvgpr_mov_b32 a49, a241
v_accvgpr_mov_b32 a50, a242
v_accvgpr_mov_b32 a51, a243
v_accvgpr_mov_b32 a52, a244
v_accvgpr_mov_b32 a53, a245
v_accvgpr_mov_b32 a54, a246
v_accvgpr_mov_b32 a55, a247
v_accvgpr_mov_b32 a56, a248
v_accvgpr_mov_b32 a57, a249
v_accvgpr_mov_b32 a58, a250
v_accvgpr_mov_b32 a59, a251
v_accvgpr_mov_b32 a60, a252
v_accvgpr_mov_b32 a61, a253
v_accvgpr_mov_b32 a62, a254
v_accvgpr_mov_b32 a63, a255
s_mov_b32 s24, 0
s_mov_b32 s29, s21
s_mov_b32 s19, s21
v_mov_b64 v[128:129], 0
v_mov_b64 v[130:131], 0
v_mov_b64 v[132:133], 0
v_mov_b64 v[134:135], 0
v_mov_b64 v[136:137], 0
v_mov_b64 v[138:139], 0
v_mov_b64 v[140:141], 0
v_mov_b64 v[142:143], 0
v_mov_b64 v[144:145], 0
v_mov_b64 v[146:147], 0
v_mov_b64 v[148:149], 0
v_mov_b64 v[150:151], 0
v_mov_b64 v[152:153], 0
v_mov_b64 v[154:155], 0
v_mov_b64 v[156:157], 0
v_mov_b64 v[158:159], 0
v_mov_b64 v[160:161], 0
v_mov_b64 v[162:163], 0
v_mov_b64 v[164:165], 0
v_mov_b64 v[166:167], 0
v_mov_b64 v[168:169], 0
v_mov_b64 v[170:171], 0
v_mov_b64 v[172:173], 0
v_mov_b64 v[174:175], 0
v_mov_b64 v[176:177], 0
v_mov_b64 v[178:179], 0
v_mov_b64 v[180:181], 0
v_mov_b64 v[182:183], 0
v_mov_b64 v[184:185], 0
v_mov_b64 v[186:187], 0
v_mov_b64 v[188:189], 0
v_mov_b64 v[190:191], 0
v_mov_b64 v[192:193], 0
v_mov_b64 v[194:195], 0
v_mov_b64 v[196:197], 0
v_mov_b64 v[198:199], 0
v_mov_b64 v[200:201], 0
v_mov_b64 v[202:203], 0
v_mov_b64 v[204:205], 0
v_mov_b64 v[206:207], 0
v_mov_b64 v[208:209], 0
v_mov_b64 v[210:211], 0
v_mov_b64 v[212:213], 0
v_mov_b64 v[214:215], 0
v_mov_b64 v[216:217], 0
v_mov_b64 v[218:219], 0
v_mov_b64 v[220:221], 0
v_mov_b64 v[222:223], 0
v_mov_b64 v[224:225], 0
v_mov_b64 v[226:227], 0
v_mov_b64 v[228:229], 0
v_mov_b64 v[230:231], 0
v_mov_b64 v[232:233], 0
v_mov_b64 v[234:235], 0
v_mov_b64 v[236:237], 0
v_mov_b64 v[238:239], 0
v_mov_b64 v[240:241], 0
v_mov_b64 v[242:243], 0
v_mov_b64 v[244:245], 0
v_mov_b64 v[246:247], 0
v_mov_b64 v[248:249], 0
v_mov_b64 v[250:251], 0
v_mov_b64 v[252:253], 0
v_mov_b64 v[254:255], 0
v_mov_b64 v[24:25], 0
s_mov_b32 s71, s28
s_barrier
s_branch K2_item
Lstub_3:
s_call_b64 s[16:17], K2_slow1
s_branch Lback_4
Lstub_5:
s_call_b64 s[16:17], K2_slow0
s_branch Lback_6
Lstub_7:
s_call_b64 s[16:17], K2_slow1
s_branch Lback_8
Lstub_9:
s_call_b64 s[16:17], K2_slow0
s_branch Lback_10
Lstub_11:
s_call_b64 s[16:17], K2_slow2
s_branch Lback_12
Lstub_13:
s_call_b64 s[16:17], K2_slow2
s_branch Lback_14
Lstub_15:
s_call_b64 s[16:17], K2_slow1
s_branch Lback_16
K2_slow0:
s_nop 7
s_nop 7
v_max3_f32 v8, v32, v33, 0
v_max3_f32 v8, v34, v35, v8
v_max3_f32 v8, v40, v41, v8
v_max3_f32 v8, v42, v43, v8
v_max3_f32 v8, v48, v49, v8
v_max3_f32 v8, v50, v51, v8
v_max3_f32 v8, v56, v57, v8
v_max3_f32 v8, v58, v59, v8
v_mov_b32 v9, v8
s_nop 1
v_permlane16_swap_b32 v8, v9
v_max_f32 v8, v8, v9
v_mov_b32 v9, v8
s_nop 1
v_permlane32_swap_b32 v8, v9
v_max_f32 v8, v8, v9
v_exp_f32 v9, -v8
v_sub_f32 v16, v16, v8
v_sub_f32 v17, v17, v8
v_sub_f32 v18, v18, v8
v_sub_f32 v19, v19, v8
v_mul_f32 v24, v24, v9
v_mul_f32 v128, v128, v9
v_mul_f32 v129, v129, v9
v_mul_f32 v130, v130, v9
v_mul_f32 v131, v131, v9
v_mul_f32 v136, v136, v9
v_mul_f32 v137, v137, v9
v_mul_f32 v138, v138, v9
v_mul_f32 v139, v139, v9
v_mul_f32 v144, v144, v9
v_mul_f32 v145, v145, v9
v_mul_f32 v146, v146, v9
v_mul_f32 v147, v147, v9
v_mul_f32 v152, v152, v9
v_mul_f32 v153, v153, v9
v_mul_f32 v154, v154, v9
v_mul_f32 v155, v155, v9
v_mul_f32 v160, v160, v9
v_mul_f32 v161, v161, v9
v_mul_f32 v162, v162, v9
v_mul_f32 v163, v163, v9
v_mul_f32 v168, v168, v9
v_mul_f32 v169, v169, v9
v_mul_f32 v170, v170, v9
v_mul_f32 v171, v171, v9
v_mul_f32 v176, v176, v9
v_mul_f32 v177, v177, v9
v_mul_f32 v178, v178, v9
v_mul_f32 v179, v179, v9
v_mul_f32 v184, v184, v9
v_mul_f32 v185, v185, v9
v_mul_f32 v186, v186, v9
v_mul_f32 v187, v187, v9
v_mul_f32 v192, v192, v9
v_mul_f32 v193, v193, v9
v_mul_f32 v194, v194, v9
v_mul_f32 v195, v195, v9
v_mul_f32 v200, v200, v9
v_mul_f32 v201, v201, v9
v_mul_f32 v202, v202, v9
v_mul_f32 v203, v203, v9
v_mul_f32 v208, v208, v9
v_mul_f32 v209, v209, v9
v_mul_f32 v210, v210, v9
v_mul_f32 v211, v211, v9
v_mul_f32 v216, v216, v9
v_mul_f32 v217, v217, v9
v_mul_f32 v218, v218, v9
v_mul_f32 v219, v219, v9
v_mul_f32 v224, v224, v9
v_mul_f32 v225, v225, v9
v_mul_f32 v226, v226, v9
v_mul_f32 v227, v227, v9
v_mul_f32 v232, v232, v9
v_mul_f32 v233, v233, v9
v_mul_f32 v234, v234, v9
v_mul_f32 v235, v235, v9
v_mul_f32 v240, v240, v9
v_mul_f32 v241, v241, v9
v_mul_f32 v242, v242, v9
v_mul_f32 v243, v243, v9
v_mul_f32 v248, v248, v9
v_mul_f32 v249, v249, v9
v_mul_f32 v250, v250, v9
v_mul_f32 v251, v251, v9
v_sub_f32 v32, v32, v8
v_sub_f32 v33, v33, v8
v_sub_f32 v34, v34, v8
v_sub_f32 v35, v35, v8
v_sub_f32 v40, v40, v8
v_sub_f32 v41, v41, v8
v_sub_f32 v42, v42, v8
v_sub_f32 v43, v43, v8
v_sub_f32 v48, v48, v8
v_sub_f32 v49, v49, v8
v_sub_f32 v50, v50, v8
v_sub_f32 v51, v51, v8
v_sub_f32 v56, v56, v8
v_sub_f32 v57, v57, v8
v_sub_f32 v58, v58, v8
v_sub_f32 v59, v59, v8
v_sub_f32 v64, v64, v8
v_sub_f32 v65, v65, v8
v_sub_f32 v66, v66, v8
v_sub_f32 v67, v67, v8
v_sub_f32 v72, v72, v8
v_sub_f32 v73, v73, v8
v_sub_f32 v74, v74, v8
v_sub_f32 v75, v75, v8
v_sub_f32 v80, v80, v8
v_sub_f32 v81, v81, v8
v_sub_f32 v82, v82, v8
v_sub_f32 v83, v83, v8
v_sub_f32 v88, v88, v8
v_sub_f32 v89, v89, v8
v_sub_f32 v90, v90, v8
v_sub_f32 v91, v91, v8
v_max3_f32 v8, v36, v37, 0
v_max3_f32 v8, v38, v39, v8
v_max3_f32 v8, v44, v45, v8
v_max3_f32 v8, v46, v47, v8
v_max3_f32 v8, v52, v53, v8
v_max3_f32 v8, v54, v55, v8
v_max3_f32 v8, v60, v61, v8
v_max3_f32 v8, v62, v63, v8
v_mov_b32 v9, v8
s_nop 1
v_permlane16_swap_b32 v8, v9
v_max_f32 v8, v8, v9
v_mov_b32 v9, v8
s_nop 1
v_permlane32_swap_b32 v8, v9
v_max_f32 v8, v8, v9
v_exp_f32 v9, -v8
v_sub_f32 v20, v20, v8
v_sub_f32 v21, v21, v8
v_sub_f32 v22, v22, v8
v_sub_f32 v23, v23, v8
v_mul_f32 v25, v25, v9
v_mul_f32 v132, v132, v9
v_mul_f32 v133, v133, v9
v_mul_f32 v134, v134, v9
v_mul_f32 v135, v135, v9
v_mul_f32 v140, v140, v9
v_mul_f32 v141, v141, v9
v_mul_f32 v142, v142, v9
v_mul_f32 v143, v143, v9
v_mul_f32 v148, v148, v9
v_mul_f32 v149, v149, v9
v_mul_f32 v150, v150, v9
v_mul_f32 v151, v151, v9
v_mul_f32 v156, v156, v9
v_mul_f32 v157, v157, v9
v_mul_f32 v158, v158, v9
v_mul_f32 v159, v159, v9
v_mul_f32 v164, v164, v9
v_mul_f32 v165, v165, v9
v_mul_f32 v166, v166, v9
v_mul_f32 v167, v167, v9
v_mul_f32 v172, v172, v9
v_mul_f32 v173, v173, v9
v_mul_f32 v174, v174, v9
v_mul_f32 v175, v175, v9
v_mul_f32 v180, v180, v9
v_mul_f32 v181, v181, v9
v_mul_f32 v182, v182, v9
v_mul_f32 v183, v183, v9
v_mul_f32 v188, v188, v9
v_mul_f32 v189, v189, v9
v_mul_f32 v190, v190, v9
v_mul_f32 v191, v191, v9
v_mul_f32 v196, v196, v9
v_mul_f32 v197, v197, v9
v_mul_f32 v198, v198, v9
v_mul_f32 v199, v199, v9
v_mul_f32 v204, v204, v9
v_mul_f32 v205, v205, v9
v_mul_f32 v206, v206, v9
v_mul_f32 v207, v207, v9
v_mul_f32 v212, v212, v9
v_mul_f32 v213, v213, v9
v_mul_f32 v214, v214, v9
v_mul_f32 v215, v215, v9
v_mul_f32 v220, v220, v9
v_mul_f32 v221, v221, v9
v_mul_f32 v222, v222, v9
v_mul_f32 v223, v223, v9
v_mul_f32 v228, v228, v9
v_mul_f32 v229, v229, v9
v_mul_f32 v230, v230, v9
v_mul_f32 v231, v231, v9
v_mul_f32 v236, v236, v9
v_mul_f32 v237, v237, v9
v_mul_f32 v238, v238, v9
v_mul_f32 v239, v239, v9
v_mul_f32 v244, v244, v9
v_mul_f32 v245, v245, v9
v_mul_f32 v246, v246, v9
v_mul_f32 v247, v247, v9
v_mul_f32 v252, v252, v9
v_mul_f32 v253, v253, v9
v_mul_f32 v254, v254, v9
v_mul_f32 v255, v255, v9
v_sub_f32 v36, v36, v8
v_sub_f32 v37, v37, v8
v_sub_f32 v38, v38, v8
v_sub_f32 v39, v39, v8
v_sub_f32 v44, v44, v8
v_sub_f32 v45, v45, v8
v_sub_f32 v46, v46, v8
v_sub_f32 v47, v47, v8
v_sub_f32 v52, v52, v8
v_sub_f32 v53, v53, v8
v_sub_f32 v54, v54, v8
v_sub_f32 v55, v55, v8
v_sub_f32 v60, v60, v8
v_sub_f32 v61, v61, v8
v_sub_f32 v62, v62, v8
v_sub_f32 v63, v63, v8
v_sub_f32 v68, v68, v8
v_sub_f32 v69, v69, v8
v_sub_f32 v70, v70, v8
v_sub_f32 v71, v71, v8
v_sub_f32 v76, v76, v8
v_sub_f32 v77, v77, v8
v_sub_f32 v78, v78, v8
v_sub_f32 v79, v79, v8
v_sub_f32 v84, v84, v8
v_sub_f32 v85, v85, v8
v_sub_f32 v86, v86, v8
v_sub_f32 v87, v87, v8
v_sub_f32 v92, v92, v8
v_sub_f32 v93, v93, v8
v_sub_f32 v94, v94, v8
v_sub_f32 v95, v95, v8
v_exp_f32 v8, v32
v_exp_f32 v9, v33
v_exp_f32 v10, v34
v_exp_f32 v11, v35
s_nop 0
v_add_f32 v26, v8, v9
v_cvt_pk_bf16_f32 v96, v8, v9
v_add_f32 v26, v26, v10
v_add_f32 v26, v26, v11
v_cvt_pk_bf16_f32 v97, v10, v11
v_exp_f32 v12, v36
v_exp_f32 v13, v37
v_exp_f32 v14, v38
v_exp_f32 v15, v39
s_nop 0
v_add_f32 v27, v12, v13
v_cvt_pk_bf16_f32 v104, v12, v13
v_add_f32 v27, v27, v14
v_add_f32 v27, v27, v15
v_cvt_pk_bf16_f32 v105, v14, v15
v_exp_f32 v8, v40
v_exp_f32 v9, v41
v_exp_f32 v10, v42
v_exp_f32 v11, v43
s_nop 0
v_add_f32 v26, v26, v8
v_add_f32 v26, v26, v9
v_cvt_pk_bf16_f32 v98, v8, v9
v_add_f32 v26, v26, v10
v_add_f32 v26, v26, v11
v_cvt_pk_bf16_f32 v99, v10, v11
v_exp_f32 v12, v44
v_exp_f32 v13, v45
v_exp_f32 v14, v46
v_exp_f32 v15, v47
s_nop 0
v_add_f32 v27, v27, v12
v_add_f32 v27, v27, v13
v_cvt_pk_bf16_f32 v106, v12, v13
v_add_f32 v27, v27, v14
v_add_f32 v27, v27, v15
v_cvt_pk_bf16_f32 v107, v14, v15
v_exp_f32 v8, v48
v_exp_f32 v9, v49
v_exp_f32 v10, v50
v_exp_f32 v11, v51
s_nop 0
v_add_f32 v26, v26, v8
v_add_f32 v26, v26, v9
v_cvt_pk_bf16_f32 v100, v8, v9
v_add_f32 v26, v26, v10
v_add_f32 v26, v26, v11
v_cvt_pk_bf16_f32 v101, v10, v11
v_exp_f32 v12, v52
v_exp_f32 v13, v53
v_exp_f32 v14, v54
v_exp_f32 v15, v55
s_nop 0
v_add_f32 v27, v27, v12
v_add_f32 v27, v27, v13
v_cvt_pk_bf16_f32 v108, v12, v13
v_add_f32 v27, v27, v14
v_add_f32 v27, v27, v15
v_cvt_pk_bf16_f32 v109, v14, v15
v_exp_f32 v8, v56
v_exp_f32 v9, v57
v_exp_f32 v10, v58
v_exp_f32 v11, v59
s_nop 0
v_add_f32 v26, v26, v8
v_add_f32 v26, v26, v9
v_cvt_pk_bf16_f32 v102, v8, v9
v_add_f32 v26, v26, v10
v_add_f32 v26, v26, v11
v_cvt_pk_bf16_f32 v103, v10, v11
v_exp_f32 v12, v60
v_exp_f32 v13, v61
v_exp_f32 v14, v62
v_exp_f32 v15, v63
s_nop 0
v_add_f32 v27, v27, v12
v_add_f32 v27, v27, v13
v_cvt_pk_bf16_f32 v110, v12, v13
v_add_f32 v27, v27, v14
v_add_f32 v27, v27, v15
v_cvt_pk_bf16_f32 v111, v14, v15
s_nop 1
s_setpc_b64 s[16:17]
K2_slow1:
s_nop 7
s_nop 7
v_max3_f32 v8, v64, v65, 0
v_max3_f32 v8, v66, v67, v8
v_max3_f32 v8, v72, v73, v8
v_max3_f32 v8, v74, v75, v8
v_max3_f32 v8, v80, v81, v8
v_max3_f32 v8, v82, v83, v8
v_max3_f32 v8, v88, v89, v8
v_max3_f32 v8, v90, v91, v8
v_mov_b32 v9, v8
s_nop 1
v_permlane16_swap_b32 v8, v9
v_max_f32 v8, v8, v9
v_mov_b32 v9, v8
s_nop 1
v_permlane32_swap_b32 v8, v9
v_max_f32 v8, v8, v9
v_exp_f32 v9, -v8
v_sub_f32 v16, v16, v8
v_sub_f32 v17, v17, v8
v_sub_f32 v18, v18, v8
v_sub_f32 v19, v19, v8
v_mul_f32 v24, v24, v9
v_mul_f32 v128, v128, v9
v_mul_f32 v129, v129, v9
v_mul_f32 v130, v130, v9
v_mul_f32 v131, v131, v9
v_mul_f32 v136, v136, v9
v_mul_f32 v137, v137, v9
v_mul_f32 v138, v138, v9
v_mul_f32 v139, v139, v9
v_mul_f32 v144, v144, v9
v_mul_f32 v145, v145, v9
v_mul_f32 v146, v146, v9
v_mul_f32 v147, v147, v9
v_mul_f32 v152, v152, v9
v_mul_f32 v153, v153, v9
v_mul_f32 v154, v154, v9
v_mul_f32 v155, v155, v9
v_mul_f32 v160, v160, v9
v_mul_f32 v161, v161, v9
v_mul_f32 v162, v162, v9
v_mul_f32 v163, v163, v9
v_mul_f32 v168, v168, v9
v_mul_f32 v169, v169, v9
v_mul_f32 v170, v170, v9
v_mul_f32 v171, v171, v9
v_mul_f32 v176, v176, v9
v_mul_f32 v177, v177, v9
v_mul_f32 v178, v178, v9
v_mul_f32 v179, v179, v9
v_mul_f32 v184, v184, v9
v_mul_f32 v185, v185, v9
v_mul_f32 v186, v186, v9
v_mul_f32 v187, v187, v9
v_mul_f32 v192, v192, v9
v_mul_f32 v193, v193, v9
v_mul_f32 v194, v194, v9
v_mul_f32 v195, v195, v9
v_mul_f32 v200, v200, v9
v_mul_f32 v201, v201, v9
v_mul_f32 v202, v202, v9
v_mul_f32 v203, v203, v9
v_mul_f32 v208, v208, v9
v_mul_f32 v209, v209, v9
v_mul_f32 v210, v210, v9
v_mul_f32 v211, v211, v9
v_mul_f32 v216, v216, v9
v_mul_f32 v217, v217, v9
v_mul_f32 v218, v218, v9
v_mul_f32 v219, v219, v9
v_mul_f32 v224, v224, v9
v_mul_f32 v225, v225, v9
v_mul_f32 v226, v226, v9
v_mul_f32 v227, v227, v9
v_mul_f32 v232, v232, v9
v_mul_f32 v233, v233, v9
v_mul_f32 v234, v234, v9
v_mul_f32 v235, v235, v9
v_mul_f32 v240, v240, v9
v_mul_f32 v241, v241, v9
v_mul_f32 v242, v242, v9
v_mul_f32 v243, v243, v9
v_mul_f32 v248, v248, v9
v_mul_f32 v249, v249, v9
v_mul_f32 v250, v250, v9
v_mul_f32 v251, v251, v9
v_sub_f32 v32, v32, v8
v_sub_f32 v33, v33, v8
v_sub_f32 v34, v34, v8
v_sub_f32 v35, v35, v8
v_sub_f32 v40, v40, v8
v_sub_f32 v41, v41, v8
v_sub_f32 v42, v42, v8
v_sub_f32 v43, v43, v8
v_sub_f32 v48, v48, v8
v_sub_f32 v49, v49, v8
v_sub_f32 v50, v50, v8
v_sub_f32 v51, v51, v8
v_sub_f32 v56, v56, v8
v_sub_f32 v57, v57, v8
v_sub_f32 v58, v58, v8
v_sub_f32 v59, v59, v8
v_sub_f32 v64, v64, v8
v_sub_f32 v65, v65, v8
v_sub_f32 v66, v66, v8
v_sub_f32 v67, v67, v8
v_sub_f32 v72, v72, v8
v_sub_f32 v73, v73, v8
v_sub_f32 v74, v74, v8
v_sub_f32 v75, v75, v8
v_sub_f32 v80, v80, v8
v_sub_f32 v81, v81, v8
v_sub_f32 v82, v82, v8
v_sub_f32 v83, v83, v8
v_sub_f32 v88, v88, v8
v_sub_f32 v89, v89, v8
v_sub_f32 v90, v90, v8
v_sub_f32 v91, v91, v8
v_max3_f32 v8, v68, v69, 0
v_max3_f32 v8, v70, v71, v8
v_max3_f32 v8, v76, v77, v8
v_max3_f32 v8, v78, v79, v8
v_max3_f32 v8, v84, v85, v8
v_max3_f32 v8, v86, v87, v8
v_max3_f32 v8, v92, v93, v8
v_max3_f32 v8, v94, v95, v8
v_mov_b32 v9, v8
s_nop 1
v_permlane16_swap_b32 v8, v9
v_max_f32 v8, v8, v9
v_mov_b32 v9, v8
s_nop 1
v_permlane32_swap_b32 v8, v9
v_max_f32 v8, v8, v9
v_exp_f32 v9, -v8
v_sub_f32 v20, v20, v8
v_sub_f32 v21, v21, v8
v_sub_f32 v22, v22, v8
v_sub_f32 v23, v23, v8
v_mul_f32 v25, v25, v9
v_mul_f32 v132, v132, v9
v_mul_f32 v133, v133, v9
v_mul_f32 v134, v134, v9
v_mul_f32 v135, v135, v9
v_mul_f32 v140, v140, v9
v_mul_f32 v141, v141, v9
v_mul_f32 v142, v142, v9
v_mul_f32 v143, v143, v9
v_mul_f32 v148, v148, v9
v_mul_f32 v149, v149, v9
v_mul_f32 v150, v150, v9
v_mul_f32 v151, v151, v9
v_mul_f32 v156, v156, v9
v_mul_f32 v157, v157, v9
v_mul_f32 v158, v158, v9
v_mul_f32 v159, v159, v9
v_mul_f32 v164, v164, v9
v_mul_f32 v165, v165, v9
v_mul_f32 v166, v166, v9
v_mul_f32 v167, v167, v9
v_mul_f32 v172, v172, v9
v_mul_f32 v173, v173, v9
v_mul_f32 v174, v174, v9
v_mul_f32 v175, v175, v9
v_mul_f32 v180, v180, v9
v_mul_f32 v181, v181, v9
v_mul_f32 v182, v182, v9
v_mul_f32 v183, v183, v9
v_mul_f32 v188, v188, v9
v_mul_f32 v189, v189, v9
v_mul_f32 v190, v190, v9
v_mul_f32 v191, v191, v9
v_mul_f32 v196, v196, v9
v_mul_f32 v197, v197, v9
v_mul_f32 v198, v198, v9
v_mul_f32 v199, v199, v9
v_mul_f32 v204, v204, v9
v_mul_f32 v205, v205, v9
v_mul_f32 v206, v206, v9
v_mul_f32 v207, v207, v9
v_mul_f32 v212, v212, v9
v_mul_f32 v213, v213, v9
v_mul_f32 v214, v214, v9
v_mul_f32 v215, v215, v9
v_mul_f32 v220, v220, v9
v_mul_f32 v221, v221, v9
v_mul_f32 v222, v222, v9
v_mul_f32 v223, v223, v9
v_mul_f32 v228, v228, v9
v_mul_f32 v229, v229, v9
v_mul_f32 v230, v230, v9
v_mul_f32 v231, v231, v9
v_mul_f32 v236, v236, v9
v_mul_f32 v237, v237, v9
v_mul_f32 v238, v238, v9
v_mul_f32 v239, v239, v9
v_mul_f32 v244, v244, v9
v_mul_f32 v245, v245, v9
v_mul_f32 v246, v246, v9
v_mul_f32 v247, v247, v9
v_mul_f32 v252, v252, v9
v_mul_f32 v253, v253, v9
v_mul_f32 v254, v254, v9
v_mul_f32 v255, v255, v9
v_sub_f32 v36, v36, v8
v_sub_f32 v37, v37, v8
v_sub_f32 v38, v38, v8
v_sub_f32 v39, v39, v8
v_sub_f32 v44, v44, v8
v_sub_f32 v45, v45, v8
v_sub_f32 v46, v46, v8
v_sub_f32 v47, v47, v8
v_sub_f32 v52, v52, v8
v_sub_f32 v53, v53, v8
v_sub_f32 v54, v54, v8
v_sub_f32 v55, v55, v8
v_sub_f32 v60, v60, v8
v_sub_f32 v61, v61, v8
v_sub_f32 v62, v62, v8
v_sub_f32 v63, v63, v8
v_sub_f32 v68, v68, v8
v_sub_f32 v69, v69, v8
v_sub_f32 v70, v70, v8
v_sub_f32 v71, v71, v8
v_sub_f32 v76, v76, v8
v_sub_f32 v77, v77, v8
v_sub_f32 v78, v78, v8
v_sub_f32 v79, v79, v8
v_sub_f32 v84, v84, v8
v_sub_f32 v85, v85, v8
v_sub_f32 v86, v86, v8
v_sub_f32 v87, v87, v8
v_sub_f32 v92, v92, v8
v_sub_f32 v93, v93, v8
v_sub_f32 v94, v94, v8
v_sub_f32 v95, v95, v8
v_exp_f32 v8, v64
v_exp_f32 v9, v65
v_exp_f32 v10, v66
v_exp_f32 v11, v67
s_nop 0
v_add_f32 v26, v8, v9
v_cvt_pk_bf16_f32 v112, v8, v9
v_add_f32 v26, v26, v10
v_add_f32 v26, v26, v11
v_cvt_pk_bf16_f32 v113, v10, v11
v_exp_f32 v12, v68
v_exp_f32 v13, v69
v_exp_f32 v14, v70
v_exp_f32 v15, v71
s_nop 0
v_add_f32 v27, v12, v13
v_cvt_pk_bf16_f32 v120, v12, v13
v_add_f32 v27, v27, v14
v_add_f32 v27, v27, v15
v_cvt_pk_bf16_f32 v121, v14, v15
v_exp_f32 v8, v72
v_exp_f32 v9, v73
v_exp_f32 v10, v74
v_exp_f32 v11, v75
s_nop 0
v_add_f32 v26, v26, v8
v_add_f32 v26, v26, v9
v_cvt_pk_bf16_f32 v114, v8, v9
v_add_f32 v26, v26, v10
v_add_f32 v26, v26, v11
v_cvt_pk_bf16_f32 v115, v10, v11
v_exp_f32 v12, v76
v_exp_f32 v13, v77
v_exp_f32 v14, v78
v_exp_f32 v15, v79
s_nop 0
v_add_f32 v27, v27, v12
v_add_f32 v27, v27, v13
v_cvt_pk_bf16_f32 v122, v12, v13
v_add_f32 v27, v27, v14
v_add_f32 v27, v27, v15
v_cvt_pk_bf16_f32 v123, v14, v15
v_exp_f32 v8, v80
v_exp_f32 v9, v81
v_exp_f32 v10, v82
v_exp_f32 v11, v83
s_nop 0
v_add_f32 v26, v26, v8
v_add_f32 v26, v26, v9
v_cvt_pk_bf16_f32 v116, v8, v9
v_add_f32 v26, v26, v10
v_add_f32 v26, v26, v11
v_cvt_pk_bf16_f32 v117, v10, v11
v_exp_f32 v12, v84
v_exp_f32 v13, v85
v_exp_f32 v14, v86
v_exp_f32 v15, v87
s_nop 0
v_add_f32 v27, v27, v12
v_add_f32 v27, v27, v13
v_cvt_pk_bf16_f32 v124, v12, v13
v_add_f32 v27, v27, v14
v_add_f32 v27, v27, v15
v_cvt_pk_bf16_f32 v125, v14, v15
v_exp_f32 v8, v88
v_exp_f32 v9, v89
v_exp_f32 v10, v90
v_exp_f32 v11, v91
s_nop 0
v_add_f32 v26, v26, v8
v_add_f32 v26, v26, v9
v_cvt_pk_bf16_f32 v118, v8, v9
v_add_f32 v26, v26, v10
v_add_f32 v26, v26, v11
v_cvt_pk_bf16_f32 v119, v10, v11
v_exp_f32 v12, v92
v_exp_f32 v13, v93
v_exp_f32 v14, v94
v_exp_f32 v15, v95
s_nop 0
v_add_f32 v27, v27, v12
v_add_f32 v27, v27, v13
v_cvt_pk_bf16_f32 v126, v12, v13
v_add_f32 v27, v27, v14
v_add_f32 v27, v27, v15
v_cvt_pk_bf16_f32 v127, v14, v15
s_nop 1
s_setpc_b64 s[16:17]
K2_slow2:
s_nop 7
s_nop 7
v_max3_f32 v8, v68, v69, 0
v_max3_f32 v8, v70, v71, v8
v_max3_f32 v8, v76, v77, v8
v_max3_f32 v8, v78, v79, v8
v_max3_f32 v8, v84, v85, v8
v_max3_f32 v8, v86, v87, v8
v_max3_f32 v8, v92, v93, v8
v_max3_f32 v8, v94, v95, v8
v_mov_b32 v9, v8
s_nop 1
v_permlane16_swap_b32 v8, v9
v_max_f32 v8, v8, v9
v_mov_b32 v9, v8
s_nop 1
v_permlane32_swap_b32 v8, v9
v_max_f32 v8, v8, v9
v_exp_f32 v9, -v8
v_sub_f32 v20, v20, v8
v_sub_f32 v21, v21, v8
v_sub_f32 v22, v22, v8
v_sub_f32 v23, v23, v8
v_mul_f32 v25, v25, v9
v_mul_f32 v132, v132, v9
v_mul_f32 v133, v133, v9
v_mul_f32 v134, v134, v9
v_mul_f32 v135, v135, v9
v_mul_f32 v140, v140, v9
v_mul_f32 v141, v141, v9
v_mul_f32 v142, v142, v9
v_mul_f32 v143, v143, v9
v_mul_f32 v148, v148, v9
v_mul_f32 v149, v149, v9
v_mul_f32 v150, v150, v9
v_mul_f32 v151, v151, v9
v_mul_f32 v156, v156, v9
v_mul_f32 v157, v157, v9
v_mul_f32 v158, v158, v9
v_mul_f32 v159, v159, v9
v_mul_f32 v164, v164, v9
v_mul_f32 v165, v165, v9
v_mul_f32 v166, v166, v9
v_mul_f32 v167, v167, v9
v_mul_f32 v172, v172, v9
v_mul_f32 v173, v173, v9
v_mul_f32 v174, v174, v9
v_mul_f32 v175, v175, v9
v_mul_f32 v180, v180, v9
v_mul_f32 v181, v181, v9
v_mul_f32 v182, v182, v9
v_mul_f32 v183, v183, v9
v_mul_f32 v188, v188, v9
v_mul_f32 v189, v189, v9
v_mul_f32 v190, v190, v9
v_mul_f32 v191, v191, v9
v_mul_f32 v196, v196, v9
v_mul_f32 v197, v197, v9
v_mul_f32 v198, v198, v9
v_mul_f32 v199, v199, v9
v_mul_f32 v204, v204, v9
v_mul_f32 v205, v205, v9
v_mul_f32 v206, v206, v9
v_mul_f32 v207, v207, v9
v_mul_f32 v212, v212, v9
v_mul_f32 v213, v213, v9
v_mul_f32 v214, v214, v9
v_mul_f32 v215, v215, v9
v_mul_f32 v220, v220, v9
v_mul_f32 v221, v221, v9
v_mul_f32 v222, v222, v9
v_mul_f32 v223, v223, v9
v_mul_f32 v228, v228, v9
v_mul_f32 v229, v229, v9
v_mul_f32 v230, v230, v9
v_mul_f32 v231, v231, v9
v_mul_f32 v236, v236, v9
v_mul_f32 v237, v237, v9
v_mul_f32 v238, v238, v9
v_mul_f32 v239, v239, v9
v_mul_f32 v244, v244, v9
v_mul_f32 v245, v245, v9
v_mul_f32 v246, v246, v9
v_mul_f32 v247, v247, v9
v_mul_f32 v252, v252, v9
v_mul_f32 v253, v253, v9
v_mul_f32 v254, v254, v9
v_mul_f32 v255, v255, v9
v_sub_f32 v68, v68, v8
v_sub_f32 v69, v69, v8
v_sub_f32 v70, v70, v8
v_sub_f32 v71, v71, v8
v_sub_f32 v76, v76, v8
v_sub_f32 v77, v77, v8
v_sub_f32 v78, v78, v8
v_sub_f32 v79, v79, v8
v_sub_f32 v84, v84, v8
v_sub_f32 v85, v85, v8
v_sub_f32 v86, v86, v8
v_sub_f32 v87, v87, v8
v_sub_f32 v92, v92, v8
v_sub_f32 v93, v93, v8
v_sub_f32 v94, v94, v8
v_sub_f32 v95, v95, v8
v_exp_f32 v8, v68
v_exp_f32 v9, v69
v_exp_f32 v10, v70
v_exp_f32 v11, v71
s_nop 0
v_add_f32 v27, v8, v9
v_cvt_pk_bf16_f32 v120, v8, v9
v_add_f32 v27, v27, v10
v_add_f32 v27, v27, v11
v_cvt_pk_bf16_f32 v121, v10, v11
v_exp_f32 v12, v76
v_exp_f32 v13, v77
v_exp_f32 v14, v78
v_exp_f32 v15, v79
s_nop 0
v_add_f32 v27, v27, v12
v_add_f32 v27, v27, v13
v_cvt_pk_bf16_f32 v122, v12, v13
v_add_f32 v27, v27, v14
v_add_f32 v27, v27, v15
v_cvt_pk_bf16_f32 v123, v14, v15
v_exp_f32 v8, v84
v_exp_f32 v9, v85
v_exp_f32 v10, v86
v_exp_f32 v11, v87
s_nop 0
v_add_f32 v27, v27, v8
v_add_f32 v27, v27, v9
v_cvt_pk_bf16_f32 v124, v8, v9
v_add_f32 v27, v27, v10
v_add_f32 v27, v27, v11
v_cvt_pk_bf16_f32 v125, v10, v11
v_exp_f32 v12, v92
v_exp_f32 v13, v93
v_exp_f32 v14, v94
v_exp_f32 v15, v95
s_nop 0
v_add_f32 v27, v27, v12
v_add_f32 v27, v27, v13
v_cvt_pk_bf16_f32 v126, v12, v13
v_add_f32 v27, v27, v14
v_add_f32 v27, v27, v15
v_cvt_pk_bf16_f32 v127, v14, v15
s_nop 1
s_setpc_b64 s[16:17]
M_cntspinK:
Lp_9801:
buffer_load_dword v245, off, s[60:63], 0 sc1
s_waitcnt vmcnt(0)
v_cmp_gt_u32 vcc, 0x100, v245
s_cbranch_vccz Lpd_9802
s_sleep 8
s_sub_u32 s101, s101, 1
s_cbranch_scc0 Lp_9801
s_mov_b32 s101, 0
Lpd_9802:
s_branch Lg_1
M_ppspinK:
Lp_9803:
buffer_load_dword v230, v231, s[4:7], s52 offen sc1
s_waitcnt vmcnt(0)
v_cmp_gt_u32 vcc, 1, v230
s_cbranch_vccz Lpd_9804
s_sleep 8
s_sub_u32 s101, s101, 1
s_cbranch_scc0 Lp_9803
s_mov_b32 s101, 0
Lpd_9804:
s_branch M_ppokK
M_cntspinV:
Lp_9805:
buffer_load_dword v245, off, s[60:63], 0 sc1
s_waitcnt vmcnt(0)
v_cmp_gt_u32 vcc, 0x100, v245
s_cbranch_vccz Lpd_9806
s_sleep 8
s_sub_u32 s101, s101, 1
s_cbranch_scc0 Lp_9805
s_mov_b32 s101, 0
Lpd_9806:
s_branch Lg_2
M_ppspinV:
Lp_9807:
buffer_load_dword v230, v231, s[4:7], s52 offen sc1
s_waitcnt vmcnt(0)
v_cmp_gt_u32 vcc, 1, v230
s_cbranch_vccz Lpd_9808
s_sleep 8
s_sub_u32 s101, s101, 1
s_cbranch_scc0 Lp_9807
s_mov_b32 s101, 0
Lpd_9808:
s_branch M_ppokV
M_end:
s_endpgm
.section .rodata,"a"
.p2align 6
.amdhsa_kernel concat_heads__ssm_conv_h3__compressed_kv_cla__prompt_kernel
  .amdhsa_next_free_vgpr 512
  .amdhsa_next_free_sgpr 102
  .amdhsa_accum_offset 256
  .amdhsa_group_segment_fixed_size 0
  .amdhsa_kernarg_size 120
  .amdhsa_user_sgpr_count 2
  .amdhsa_user_sgpr_kernarg_segment_ptr 1
  .amdhsa_system_sgpr_workgroup_id_x 1
  .amdhsa_float_denorm_mode_32 3
  .amdhsa_float_denorm_mode_16_64 3
  .amdhsa_ieee_mode 0
  .amdhsa_dx10_clamp 0
.end_amdhsa_kernel
```

```asm
; @launch grid=(256,1,1) block=(256,1,1) lds=163840
.amdgcn_target "amdgcn-amd-amdhsa--gfx950"
.text
.globl concat_heads__ssm_conv_h3__compressed_kv_cla__prompt_kernel
.p2align 8
.type concat_heads__ssm_conv_h3__compressed_kv_cla__prompt_kernel,@function
concat_heads__ssm_conv_h3__compressed_kv_cla__prompt_kernel:
s_cmp_ge_u32 s2, 256
s_cbranch_scc1 M_end
s_load_dwordx16 s[64:79], s[0:1], 0
s_load_dwordx8 s[80:87], s[0:1], 64
s_load_dwordx4 s[88:91], s[0:1], 96
s_load_dwordx2 s[92:93], s[0:1], 112
s_getpc_b64 s[58:59]
M_pc:
s_lshr_b32 s22, s2, 3
s_lshl_b32 s22, s22, 5
v_and_b32 v26, 31, v0
v_add_u32 v26, s22, v26
v_lshlrev_b32 v26, 7, v26
v_min_u32 v26, M_end-M_pc, v26
v_mov_b32 v27, s59
v_add_co_u32 v26, vcc, s58, v26
s_nop 1
v_addc_co_u32 v27, vcc, 0, v27, vcc
global_load_dword v21, v[26:27], off
v_lshrrev_b32 v28, 6, v0
v_and_b32 v29, 63, v0
v_lshlrev_b32 v1, 4, v29
v_readfirstlane_b32 s3, v28
s_and_b32 s20, s2, 7
s_lshl_b32 s20, s20, 1
s_bfe_u32 s22, s2, 0x10003
s_add_u32 s20, s20, s22
s_lshr_b32 s21, s2, 5
s_mov_b32 s101, 0x40000
v_lshrrev_b32 v26, 7, v1
v_lshrrev_b32 v27, 1, v26
v_lshlrev_b32 v27, 4, v27
v_and_b32 v28, 0x70, v1
v_xor_b32 v27, v27, v28
v_mul_u32_u24 v26, 2048, v26
v_add_u32 v12, v26, v27
v_xor_b32 v27, 64, v27
v_add_u32 v26, v26, v27
v_add_u32 v13, 15360, v26
v_add_u32 v14, 30720, v12
v_add_u32 v15, 46080, v26
v_lshrrev_b32 v26, 5, v29
v_and_b32 v27, 31, v29
s_and_b32 s22, s3, 1
s_lshl_b32 s22, s22, 2
v_or_b32 v28, s22, v26
v_lshlrev_b32 v28, 1, v28
v_xor_b32 v27, v27, v28
v_lshlrev_b32 v27, 4, v27
v_lshl_add_u32 v16, v26, 13, v27
v_xor_b32 v26, 64, v16
v_add_u32 v17, 15360, v26
v_add_u32 v18, 30720, v16
v_add_u32 v19, 46080, v26
s_lshl_b32 s28, s3, 13
s_lshl_b32 s29, s3, 12
s_lshl_b32 s24, s21, 19
s_lshl_b32 s22, s3, 17
s_add_u32 s24, s24, s22
s_add_u32 s25, s24, 65536
s_lshl_b32 s26, s3, 16
s_lshl_b32 s22, s20, 9
s_add_u32 s26, s26, s22
s_add_u32 s27, s26, 262144
s_mov_b32 s10, 4194304
s_mov_b32 s11, 0x20000
s_mov_b32 s14, 8388608
s_mov_b32 s15, 0x20000
v_and_b32 v30, 15, v29
v_lshrrev_b32 v31, 4, v29
v_lshrrev_b32 v26, 1, v30
v_xor_b32 v26, v31, v26
v_lshlrev_b32 v26, 4, v26
v_lshl_add_u32 v2, v30, 7, v26
s_lshr_b32 s22, s3, 1
s_lshl_b32 s22, s22, 14
v_add_u32 v2, s22, v2
v_xor_b32 v3, 64, v2
v_lshrrev_b32 v26, 2, v30
v_and_b32 v27, 1, v31
v_lshl_or_b32 v27, v27, 2, v26
v_lshl_add_u32 v26, v31, 3, v26
v_lshlrev_b32 v26, 9, v26
v_lshl_add_u32 v26, v27, 5, v26
v_and_b32 v27, 3, v29
v_lshl_add_u32 v26, v27, 3, v26
s_and_b32 s22, s3, 1
s_lshl_b32 s22, s22, 8
s_add_u32 s22, s22, 0x10000
v_xor_b32 v4, s22, v26
v_xor_b32 v5, 32, v4
v_xor_b32 v6, 64, v4
v_xor_b32 v7, 96, v4
v_xor_b32 v8, 128, v4
v_xor_b32 v9, 160, v4
v_xor_b32 v10, 192, v4
v_xor_b32 v11, 224, v4
s_mov_b32 s19, 0x20000
s_cmp_eq_u32 s3, 2
s_cbranch_scc1 M_pf2
s_cmp_lg_u32 s3, 0
s_cbranch_scc1 M_pf3
s_mov_b32 s18, 8388608
s_mov_b32 s51, 8388608
s_mov_b32 s47, 524288
s_mov_b32 s43, 524288
s_lshl_b32 s22, s21, 16
s_lshl_b32 s23, s20, 9
s_add_u32 s22, s22, s23
v_bfe_u32 v26, v29, 2, 3
v_lshl_add_u32 v26, v26, 13, s22
v_and_b32 v27, 3, v29
v_lshl_add_u32 v20, v27, 7, v26
v_lshrrev_b32 v27, 5, v29
v_lshl_add_u32 v22, v27, 19, v20
v_cmp_gt_u32 vcc, 32, v29
s_branch M_pfd
M_pf2:
s_mov_b32 s18, 4194304
s_mov_b32 s51, 2048
s_mov_b32 s47, 256
s_mov_b32 s43, 0
s_lshl_b32 s22, s2, 14
v_bfe_u32 v26, v29, 1, 3
v_lshl_add_u32 v26, v26, 11, s22
v_and_b32 v27, 1, v29
v_lshl_add_u32 v20, v27, 7, v26
v_bfe_u32 v27, v29, 4, 1
v_lshl_add_u32 v22, v27, 8, v20
v_cmp_gt_u32 vcc, 16, v29
s_branch M_pfd
M_pf3:
s_mov_b32 s18, 0
s_mov_b32 s51, 3112960
s_mov_b32 s47, 622592
s_mov_b32 s43, 0
s_mul_i32 s22, s2, 2432
v_lshl_add_u32 v20, v29, 7, s22
v_mov_b32 v22, v20
v_cmp_gt_u32 vcc, 19, v29
M_pfd:
v_mov_b32 v26, 3221225472
s_nop 0
v_cndmask_b32 v20, v26, v20, vcc
s_bitcmp1_b32 s2, 4
s_waitcnt lgkmcnt(0)
s_mov_b64 s[8:9], s[78:79]
s_cselect_b64 s[12:13], s[84:85], s[82:83]
s_add_u32 m0, s28, 0
s_nop 0
buffer_load_dwordx4 v12, s[8:11], s24 offen offset:0 lds
buffer_load_dwordx4 v13, s[8:11], s24 offen offset:1024 lds
buffer_load_dwordx4 v14, s[8:11], s24 offen offset:2048 lds
buffer_load_dwordx4 v15, s[8:11], s24 offen offset:3072 lds
s_add_u32 s24, s24, 128
s_add_u32 m0, s28, 4096
s_nop 0
buffer_load_dwordx4 v12, s[8:11], s25 offen offset:0 lds
buffer_load_dwordx4 v13, s[8:11], s25 offen offset:1024 lds
buffer_load_dwordx4 v14, s[8:11], s25 offen offset:2048 lds
buffer_load_dwordx4 v15, s[8:11], s25 offen offset:3072 lds
s_add_u32 s25, s25, 128
s_add_u32 m0, s29, 65536
s_nop 0
buffer_load_dwordx4 v16, s[12:15], s26 offen offset:0 lds
buffer_load_dwordx4 v17, s[12:15], s26 offen offset:1024 lds
buffer_load_dwordx4 v18, s[12:15], s26 offen offset:2048 lds
buffer_load_dwordx4 v19, s[12:15], s26 offen offset:3072 lds
s_add_u32 s26, s26, 524288
s_add_u32 m0, s29, 81920
s_nop 0
buffer_load_dwordx4 v16, s[12:15], s27 offen offset:0 lds
buffer_load_dwordx4 v17, s[12:15], s27 offen offset:1024 lds
buffer_load_dwordx4 v18, s[12:15], s27 offen offset:2048 lds
buffer_load_dwordx4 v19, s[12:15], s27 offen offset:3072 lds
s_add_u32 s27, s27, 524288
s_add_u32 m0, s28, 32768
s_nop 0
buffer_load_dwordx4 v12, s[8:11], s24 offen offset:0 lds
buffer_load_dwordx4 v13, s[8:11], s24 offen offset:1024 lds
buffer_load_dwordx4 v14, s[8:11], s24 offen offset:2048 lds
buffer_load_dwordx4 v15, s[8:11], s24 offen offset:3072 lds
s_add_u32 s24, s24, 128
s_add_u32 m0, s28, 36864
s_nop 0
buffer_load_dwordx4 v12, s[8:11], s25 offen offset:0 lds
buffer_load_dwordx4 v13, s[8:11], s25 offen offset:1024 lds
buffer_load_dwordx4 v14, s[8:11], s25 offen offset:2048 lds
buffer_load_dwordx4 v15, s[8:11], s25 offen offset:3072 lds
s_add_u32 s25, s25, 128
s_cmp_eq_u32 s3, 0
s_cselect_b64 s[16:17], s[12:13], s[8:9]
buffer_load_dword v21, v22, s[16:19], s43 offen
s_add_u32 s43, s43, s47
s_add_u32 s43, s43, s47
s_mov_b32 s4, s92
s_mov_b32 s5, s93
s_mov_b32 s6, 268435456
s_mov_b32 s7, 0x20000
s_cmp_eq_u32 s3, 3
s_cselect_b64 s[40:41], s[76:77], s[80:81]
s_cselect_b32 s42, 1835008, 0
s_cmp_eq_u32 s3, 1
s_cselect_b32 s42, 3670016, s42
s_cmp_eq_u32 s3, 3
s_cselect_b64 s[44:45], s[86:87], s[72:73]
s_cselect_b32 s46, 3670016, 0
s_cmp_eq_u32 s3, 1
s_cselect_b32 s46, 1835008, s46
s_cmp_eq_u32 s3, 2
s_cselect_b64 s[40:41], s[64:65], s[40:41]
s_cselect_b32 s42, 1835008, s42
s_waitcnt vmcnt(9)
s_barrier
ds_read_b64_tr_b16 a[128:129], v4 offset:0
ds_read_b64_tr_b16 a[130:131], v4 offset:2048
ds_read_b64_tr_b16 a[132:133], v4 offset:16384
ds_read_b64_tr_b16 a[134:135], v4 offset:18432
ds_read_b128 a[0:3], v2 offset:0
ds_read_b128 a[4:7], v3 offset:0
ds_read_b128 a[8:11], v2 offset:2048
ds_read_b128 a[12:15], v3 offset:2048
ds_read_b128 a[16:19], v2 offset:4096
ds_read_b128 a[20:23], v3 offset:4096
ds_read_b128 a[24:27], v2 offset:6144
ds_read_b128 a[28:31], v3 offset:6144
ds_read_b128 a[32:35], v2 offset:8192
ds_read_b128 a[36:39], v3 offset:8192
ds_read_b128 a[40:43], v2 offset:10240
ds_read_b128 a[44:47], v3 offset:10240
ds_read_b128 a[48:51], v2 offset:12288
ds_read_b128 a[52:55], v3 offset:12288
ds_read_b128 a[56:59], v2 offset:14336
ds_read_b128 a[60:63], v3 offset:14336
s_add_u32 m0, s29, 98304
s_nop 0
buffer_load_dwordx4 v16, s[12:15], s26 offen offset:0 lds
buffer_load_dwordx4 v17, s[12:15], s26 offen offset:1024 lds
buffer_load_dwordx4 v18, s[12:15], s26 offen offset:2048 lds
buffer_load_dwordx4 v19, s[12:15], s26 offen offset:3072 lds
s_add_u32 s26, s26, 524288
s_waitcnt lgkmcnt(0)
s_barrier
s_bitcmp1_b32 s2, 4
s_cbranch_scc1 M_V
v_mfma_f32_16x16x32_bf16 v[32:35], a[128:131], a[0:3], 0
s_add_u32 m0, s29, 114688
ds_read_b64_tr_b16 a[136:137], v5 offset:0
v_mfma_f32_16x16x32_bf16 v[32:35], a[132:135], a[4:7], v[32:35]
s_mov_b32 s32, 8192
buffer_load_dwordx4 v16, s[12:15], s27 offen offset:0 lds
v_mfma_f32_16x16x32_bf16 v[40:43], a[128:131], a[8:11], 0
s_mov_b32 s33, 8192
ds_read_b64_tr_b16 a[138:139], v5 offset:2048
v_mfma_f32_16x16x32_bf16 v[40:43], a[132:135], a[12:15], v[40:43]
s_mov_b32 s34, 8192
v_mfma_f32_16x16x32_bf16 v[48:51], a[128:131], a[16:19], 0
s_mov_b32 s35, 4294910976
ds_read_b64_tr_b16 a[140:141], v5 offset:16384
v_mfma_f32_16x16x32_bf16 v[48:51], a[132:135], a[20:23], v[48:51]
s_mov_b32 s36, 4294910976
buffer_load_dwordx4 v17, s[12:15], s27 offen offset:1024 lds
v_mfma_f32_16x16x32_bf16 v[56:59], a[128:131], a[24:27], 0
s_mov_b32 s30, 8
ds_read_b64_tr_b16 a[142:143], v5 offset:18432
v_mfma_f32_16x16x32_bf16 v[56:59], a[132:135], a[28:31], v[56:59]
s_mov_b32 s82, 3221225472
v_mfma_f32_16x16x32_bf16 v[64:67], a[128:131], a[32:35], 0
s_mul_hi_u32 s38, s2, 613566757
v_mfma_f32_16x16x32_bf16 v[64:67], a[132:135], a[36:39], v[64:67]
s_mul_i32 s39, s38, 7
buffer_load_dwordx4 v18, s[12:15], s27 offen offset:2048 lds
v_mfma_f32_16x16x32_bf16 v[72:75], a[128:131], a[40:43], 0
s_sub_u32 s39, s2, s39
v_mov_b32 v246, 0
v_mov_b32 v229, 0
v_mfma_f32_16x16x32_bf16 v[72:75], a[132:135], a[44:47], v[72:75]
v_mov_b32 v231, 0
v_mfma_f32_16x16x32_bf16 v[80:83], a[128:131], a[48:51], 0
s_mov_b32 s60, s90
v_mfma_f32_16x16x32_bf16 v[80:83], a[132:135], a[52:55], v[80:83]
s_mov_b32 s61, s91
buffer_load_dwordx4 v19, s[12:15], s27 offen offset:3072 lds
v_mfma_f32_16x16x32_bf16 v[88:91], a[128:131], a[56:59], 0
s_add_u32 s27, s27, 524288
v_mfma_f32_16x16x32_bf16 v[88:91], a[132:135], a[60:63], v[88:91]
s_waitcnt lgkmcnt(2)
s_mov_b32 s62, 256
v_mfma_f32_16x16x32_bf16 v[36:39], a[136:139], a[0:3], 0
s_waitcnt lgkmcnt(0)
s_add_u32 m0, s28, 0
ds_read_b64_tr_b16 a[128:129], v6 offset:0
v_mfma_f32_16x16x32_bf16 v[36:39], a[140:143], a[4:7], v[36:39]
s_mov_b32 s63, 0x20000
buffer_load_dwordx4 v12, s[8:11], s24 offen offset:0 lds
v_mfma_f32_16x16x32_bf16 v[44:47], a[136:139], a[8:11], 0
s_mul_hi_u32 s55, s2, 1431655766
ds_read_b64_tr_b16 a[130:131], v6 offset:2048
v_mfma_f32_16x16x32_bf16 v[44:47], a[140:143], a[12:15], v[44:47]
s_mul_i32 s55, s55, 3
v_mfma_f32_16x16x32_bf16 v[52:55], a[136:139], a[16:19], 0
s_sub_u32 s55, s2, s55
ds_read_b64_tr_b16 a[132:133], v6 offset:16384
v_mfma_f32_16x16x32_bf16 v[52:55], a[140:143], a[20:23], v[52:55]
s_add_u32 s55, s55, 5
buffer_load_dwordx4 v13, s[8:11], s24 offen offset:1024 lds
v_mfma_f32_16x16x32_bf16 v[60:63], a[136:139], a[24:27], 0
s_lshr_b32 s22, s2, 4
ds_read_b64_tr_b16 a[134:135], v6 offset:18432
v_mfma_f32_16x16x32_bf16 v[60:63], a[140:143], a[28:31], v[60:63]
s_lshl_b32 s23, s20, 5
v_mfma_f32_16x16x32_bf16 v[68:71], a[136:139], a[32:35], 0
s_add_u32 s23, s23, s22
v_mfma_f32_16x16x32_bf16 v[68:71], a[140:143], a[36:39], v[68:71]
s_lshl_b32 s23, s23, 2
buffer_load_dwordx4 v14, s[8:11], s24 offen offset:2048 lds
v_mfma_f32_16x16x32_bf16 v[76:79], a[136:139], a[40:43], 0
s_and_b32 s22, s2, 16
v_mfma_f32_16x16x32_bf16 v[76:79], a[140:143], a[44:47], v[76:79]
s_lshl_b32 s22, s22, 7
v_mfma_f32_16x16x32_bf16 v[84:87], a[136:139], a[48:51], 0
s_add_u32 s23, s23, s22
v_mov_b32 v28, 3221225472
v_writelane_b32 v28, s23, 0
v_mfma_f32_16x16x32_bf16 v[84:87], a[140:143], a[52:55], v[84:87]
s_add_u32 s56, s23, 16384
buffer_load_dwordx4 v15, s[8:11], s24 offen offset:3072 lds
v_mfma_f32_16x16x32_bf16 v[92:95], a[136:139], a[56:59], 0
s_add_u32 s24, s24, 128
v_writelane_b32 v28, s56, 1
v_mfma_f32_16x16x32_bf16 v[92:95], a[140:143], a[60:63], v[92:95]
s_waitcnt lgkmcnt(2)
s_add_u32 s56, s23, 4096
v_writelane_b32 v28, s56, 2
v_mfma_f32_16x16x32_bf16 v[96:99], a[128:131], a[0:3], 0
s_waitcnt lgkmcnt(0)
s_add_u32 m0, s28, 4096
ds_read_b64_tr_b16 a[136:137], v7 offset:0
v_mfma_f32_16x16x32_bf16 v[96:99], a[132:135], a[4:7], v[96:99]
s_sub_u32 s37, 15, s21
buffer_load_dwordx4 v12, s[8:11], s25 offen offset:0 lds
v_mfma_f32_16x16x32_bf16 v[104:107], a[128:131], a[8:11], 0
ds_read_b64_tr_b16 a[138:139], v7 offset:2048
v_mfma_f32_16x16x32_bf16 v[104:107], a[132:135], a[12:15], v[104:107]
v_mfma_f32_16x16x32_bf16 v[112:115], a[128:131], a[16:19], 0
ds_read_b64_tr_b16 a[140:141], v7 offset:16384
v_mfma_f32_16x16x32_bf16 v[112:115], a[132:135], a[20:23], v[112:115]
buffer_load_dwordx4 v13, s[8:11], s25 offen offset:1024 lds
v_mfma_f32_16x16x32_bf16 v[120:123], a[128:131], a[24:27], 0
ds_read_b64_tr_b16 a[142:143], v7 offset:18432
v_mfma_f32_16x16x32_bf16 v[120:123], a[132:135], a[28:31], v[120:123]
v_mfma_f32_16x16x32_bf16 v[128:131], a[128:131], a[32:35], 0
v_mfma_f32_16x16x32_bf16 v[128:131], a[132:135], a[36:39], v[128:131]
buffer_load_dwordx4 v14, s[8:11], s25 offen offset:2048 lds
v_mfma_f32_16x16x32_bf16 v[136:139], a[128:131], a[40:43], 0
v_mfma_f32_16x16x32_bf16 v[136:139], a[132:135], a[44:47], v[136:139]
v_mfma_f32_16x16x32_bf16 v[144:147], a[128:131], a[48:51], 0
v_mfma_f32_16x16x32_bf16 v[144:147], a[132:135], a[52:55], v[144:147]
buffer_load_dwordx4 v15, s[8:11], s25 offen offset:3072 lds
v_mfma_f32_16x16x32_bf16 v[152:155], a[128:131], a[56:59], 0
s_add_u32 s25, s25, 128
v_mfma_f32_16x16x32_bf16 v[152:155], a[132:135], a[60:63], v[152:155]
s_waitcnt vmcnt(17) lgkmcnt(2)
s_barrier
v_mfma_f32_16x16x32_bf16 v[100:103], a[136:139], a[0:3], 0
s_waitcnt lgkmcnt(0)
ds_read_b64_tr_b16 a[128:129], v8 offset:0
v_mfma_f32_16x16x32_bf16 v[100:103], a[140:143], a[4:7], v[100:103]
buffer_load_dword v21, v20, s[16:19], s43 offen
v_mfma_f32_16x16x32_bf16 v[108:111], a[136:139], a[8:11], 0
s_add_u32 s43, s43, s47
ds_read_b64_tr_b16 a[130:131], v8 offset:2048
v_mfma_f32_16x16x32_bf16 v[108:111], a[140:143], a[12:15], v[108:111]
s_cmp_ge_u32 s43, s51
v_mfma_f32_16x16x32_bf16 v[116:119], a[136:139], a[16:19], 0
s_cselect_b32 s43, 0, s43
ds_read_b64_tr_b16 a[132:133], v8 offset:16384
v_mfma_f32_16x16x32_bf16 v[116:119], a[140:143], a[20:23], v[116:119]
s_cselect_b32 s51, s42, s51
v_mfma_f32_16x16x32_bf16 v[124:127], a[136:139], a[24:27], 0
s_cselect_b64 s[16:17], s[40:41], s[16:17]
ds_read_b64_tr_b16 a[134:135], v8 offset:18432
v_mfma_f32_16x16x32_bf16 v[124:127], a[140:143], a[28:31], v[124:127]
s_cselect_b32 s18, s42, s18
v_mfma_f32_16x16x32_bf16 v[132:135], a[136:139], a[32:35], 0
s_cselect_b64 s[40:41], s[44:45], s[40:41]
ds_read_b128 a[64:67], v2 offset:32768
v_mfma_f32_16x16x32_bf16 v[132:135], a[140:143], a[36:39], v[132:135]
s_cselect_b32 s42, s46, s42
v_mfma_f32_16x16x32_bf16 v[140:143], a[136:139], a[40:43], 0
s_cselect_b32 s46, 0, s46
ds_read_b128 a[68:71], v3 offset:32768
v_mfma_f32_16x16x32_bf16 v[140:143], a[140:143], a[44:47], v[140:143]
ds_read_b128 a[72:75], v2 offset:34816
v_mfma_f32_16x16x32_bf16 v[148:151], a[136:139], a[48:51], 0
ds_read_b128 a[76:79], v3 offset:34816
v_mfma_f32_16x16x32_bf16 v[148:151], a[140:143], a[52:55], v[148:151]
buffer_load_dword v21, v20, s[16:19], s43 offen
v_mfma_f32_16x16x32_bf16 v[156:159], a[136:139], a[56:59], 0
s_add_u32 s43, s43, s47
ds_read_b128 a[80:83], v2 offset:36864
v_mfma_f32_16x16x32_bf16 v[156:159], a[140:143], a[60:63], v[156:159]
s_waitcnt lgkmcnt(7)
s_cmp_ge_u32 s43, s51
ds_read_b128 a[84:87], v3 offset:36864
v_mfma_f32_16x16x32_bf16 v[160:163], a[128:131], a[0:3], 0
s_waitcnt lgkmcnt(6)
s_cselect_b32 s43, 0, s43
ds_read_b64_tr_b16 a[136:137], v9 offset:0
v_mfma_f32_16x16x32_bf16 v[160:163], a[132:135], a[4:7], v[160:163]
s_cselect_b32 s51, s42, s51
v_mfma_f32_16x16x32_bf16 v[168:171], a[128:131], a[8:11], 0
s_cselect_b64 s[16:17], s[40:41], s[16:17]
ds_read_b64_tr_b16 a[138:139], v9 offset:2048
v_mfma_f32_16x16x32_bf16 v[168:171], a[132:135], a[12:15], v[168:171]
s_cselect_b32 s18, s42, s18
v_mfma_f32_16x16x32_bf16 v[176:179], a[128:131], a[16:19], 0
s_cselect_b64 s[40:41], s[44:45], s[40:41]
ds_read_b64_tr_b16 a[140:141], v9 offset:16384
v_mfma_f32_16x16x32_bf16 v[176:179], a[132:135], a[20:23], v[176:179]
s_cselect_b32 s42, s46, s42
v_mfma_f32_16x16x32_bf16 v[184:187], a[128:131], a[24:27], 0
s_cselect_b32 s46, 0, s46
ds_read_b64_tr_b16 a[142:143], v9 offset:18432
v_mfma_f32_16x16x32_bf16 v[184:187], a[132:135], a[28:31], v[184:187]
s_bitcmp1_b32 s2, 4
s_cselect_b32 s37, s21, s37
s_lshl_b32 s56, s37, 5
v_mfma_f32_16x16x32_bf16 v[192:195], a[128:131], a[32:35], 0
s_add_u32 s56, s56, s20
s_lshl_b32 s56, s56, 2
s_add_u32 s56, s56, 8192
v_mfma_f32_16x16x32_bf16 v[192:195], a[132:135], a[36:39], v[192:195]
v_writelane_b32 v28, s56, 3
v_mfma_f32_16x16x32_bf16 v[200:203], a[128:131], a[40:43], 0
s_add_u32 s56, s56, 2048
ds_read_b128 a[88:91], v2 offset:38912
v_writelane_b32 v28, s56, 6
v_mfma_f32_16x16x32_bf16 v[200:203], a[132:135], a[44:47], v[200:203]
s_lshl_b32 s56, s2, 2
s_add_u32 s56, s56, 12288
ds_read_b128 a[92:95], v3 offset:38912
v_mfma_f32_16x16x32_bf16 v[208:211], a[128:131], a[48:51], 0
s_waitcnt lgkmcnt(2)
ds_read_b128 a[96:99], v2 offset:40960
v_writelane_b32 v28, s56, 4
v_mfma_f32_16x16x32_bf16 v[208:211], a[132:135], a[52:55], v[208:211]
s_lshl_b32 s56, s39, 5
s_add_u32 s56, s56, s38
s_lshl_b32 s56, s56, 2
v_mfma_f32_16x16x32_bf16 v[216:219], a[128:131], a[56:59], 0
s_add_u32 s56, s56, 20480
s_cmp_lt_u32 s2, 224
ds_read_b128 a[100:103], v3 offset:40960
v_mfma_f32_16x16x32_bf16 v[216:219], a[132:135], a[60:63], v[216:219]
s_cselect_b32 s56, s56, 3221225472
ds_read_b128 a[104:107], v2 offset:43008
v_writelane_b32 v28, s56, 7
v_mfma_f32_16x16x32_bf16 v[164:167], a[136:139], a[0:3], 0
s_cmp_eq_u32 s3, 0
s_cselect_b32 s56, 94371840, 3221225472
ds_read_b64_tr_b16 a[128:129], v10 offset:0
v_mfma_f32_16x16x32_bf16 v[164:167], a[140:143], a[4:7], v[164:167]
buffer_store_dword v246, v28, s[4:7], s56 offen sc1
v_mfma_f32_16x16x32_bf16 v[172:175], a[136:139], a[8:11], 0
ds_read_b64_tr_b16 a[130:131], v10 offset:2048
v_mov_b32 v27, 1
v_mfma_f32_16x16x32_bf16 v[172:175], a[140:143], a[12:15], v[172:175]
v_cmp_eq_u32 vcc, 0, v0
v_mov_b32 v26, 3221225472
v_mfma_f32_16x16x32_bf16 v[180:183], a[136:139], a[16:19], 0
s_lshl_b32 s31, s20, 20
s_lshl_b32 s22, s21, 17
ds_read_b64_tr_b16 a[132:133], v10 offset:16384
v_mfma_f32_16x16x32_bf16 v[180:183], a[140:143], a[20:23], v[180:183]
v_cndmask_b32 v26, v26, v246, vcc
v_mfma_f32_16x16x32_bf16 v[188:191], a[136:139], a[24:27], 0
s_add_u32 s31, s31, s22
s_lshr_b32 s22, s3, 1
ds_read_b64_tr_b16 a[134:135], v10 offset:18432
v_mfma_f32_16x16x32_bf16 v[188:191], a[140:143], a[28:31], v[188:191]
s_lshl_b32 s22, s22, 16
s_add_u32 s31, s31, s22
s_and_b32 s22, s3, 1
v_mfma_f32_16x16x32_bf16 v[196:199], a[136:139], a[32:35], 0
s_lshl_b32 s22, s22, 12
s_add_u32 s31, s31, s22
v_mfma_f32_16x16x32_bf16 v[196:199], a[140:143], a[36:39], v[196:199]
v_mfma_f32_16x16x32_bf16 v[204:207], a[136:139], a[40:43], 0
ds_read_b128 a[108:111], v3 offset:43008
v_mfma_f32_16x16x32_bf16 v[204:207], a[140:143], a[44:47], v[204:207]
ds_read_b128 a[112:115], v2 offset:45056
v_mfma_f32_16x16x32_bf16 v[212:215], a[136:139], a[48:51], 0
ds_read_b128 a[116:119], v3 offset:45056
v_mfma_f32_16x16x32_bf16 v[212:215], a[140:143], a[52:55], v[212:215]
v_mfma_f32_16x16x32_bf16 v[220:223], a[136:139], a[56:59], 0
ds_read_b128 a[120:123], v2 offset:47104
v_mfma_f32_16x16x32_bf16 v[220:223], a[140:143], a[60:63], v[220:223]
s_waitcnt lgkmcnt(6)
ds_read_b128 a[124:127], v3 offset:47104
v_mfma_f32_16x16x32_bf16 a[192:195], a[128:131], a[0:3], 0
s_waitcnt lgkmcnt(5)
ds_read_b64_tr_b16 a[136:137], v11 offset:0
v_mfma_f32_16x16x32_bf16 a[192:195], a[132:135], a[4:7], a[192:195]
v_mfma_f32_16x16x32_bf16 a[200:203], a[128:131], a[8:11], 0
ds_read_b64_tr_b16 a[138:139], v11 offset:2048
v_mfma_f32_16x16x32_bf16 a[200:203], a[132:135], a[12:15], a[200:203]
v_mfma_f32_16x16x32_bf16 a[208:211], a[128:131], a[16:19], 0
ds_read_b64_tr_b16 a[140:141], v11 offset:16384
v_mfma_f32_16x16x32_bf16 a[208:211], a[132:135], a[20:23], a[208:211]
v_mfma_f32_16x16x32_bf16 a[216:219], a[128:131], a[24:27], 0
ds_read_b64_tr_b16 a[142:143], v11 offset:18432
v_mfma_f32_16x16x32_bf16 a[216:219], a[132:135], a[28:31], a[216:219]
v_mfma_f32_16x16x32_bf16 a[224:227], a[128:131], a[32:35], 0
v_mfma_f32_16x16x32_bf16 a[224:227], a[132:135], a[36:39], a[224:227]
v_mfma_f32_16x16x32_bf16 a[232:235], a[128:131], a[40:43], 0
v_mfma_f32_16x16x32_bf16 a[232:235], a[132:135], a[44:47], a[232:235]
v_mfma_f32_16x16x32_bf16 a[240:243], a[128:131], a[48:51], 0
v_mfma_f32_16x16x32_bf16 a[240:243], a[132:135], a[52:55], a[240:243]
v_mfma_f32_16x16x32_bf16 a[248:251], a[128:131], a[56:59], 0
v_mfma_f32_16x16x32_bf16 a[248:251], a[132:135], a[60:63], a[248:251]
s_waitcnt vmcnt(3) lgkmcnt(0)
s_barrier
v_mfma_f32_16x16x32_bf16 a[196:199], a[136:139], a[0:3], 0
s_add_u32 m0, s29, 65536
ds_read_b64_tr_b16 a[128:129], v4 offset:32768
v_mfma_f32_16x16x32_bf16 a[196:199], a[140:143], a[4:7], a[196:199]
buffer_load_dwordx4 v16, s[12:15], s26 offen offset:0 lds
v_mfma_f32_16x16x32_bf16 a[204:207], a[136:139], a[8:11], 0
ds_read_b64_tr_b16 a[130:131], v4 offset:34816
v_mfma_f32_16x16x32_bf16 a[204:207], a[140:143], a[12:15], a[204:207]
v_mfma_f32_16x16x32_bf16 a[212:215], a[136:139], a[16:19], 0
ds_read_b64_tr_b16 a[132:133], v4 offset:49152
v_mfma_f32_16x16x32_bf16 a[212:215], a[140:143], a[20:23], a[212:215]
buffer_load_dwordx4 v17, s[12:15], s26 offen offset:1024 lds
v_mfma_f32_16x16x32_bf16 a[220:223], a[136:139], a[24:27], 0
ds_read_b64_tr_b16 a[134:135], v4 offset:51200
v_mfma_f32_16x16x32_bf16 a[220:223], a[140:143], a[28:31], a[220:223]
v_mfma_f32_16x16x32_bf16 a[228:231], a[136:139], a[32:35], 0
v_mfma_f32_16x16x32_bf16 a[228:231], a[140:143], a[36:39], a[228:231]
buffer_load_dwordx4 v18, s[12:15], s26 offen offset:2048 lds
v_mfma_f32_16x16x32_bf16 a[236:239], a[136:139], a[40:43], 0
v_mfma_f32_16x16x32_bf16 a[236:239], a[140:143], a[44:47], a[236:239]
v_mfma_f32_16x16x32_bf16 a[244:247], a[136:139], a[48:51], 0
v_mfma_f32_16x16x32_bf16 a[244:247], a[140:143], a[52:55], a[244:247]
buffer_load_dwordx4 v19, s[12:15], s26 offen offset:3072 lds
v_mfma_f32_16x16x32_bf16 a[252:255], a[136:139], a[56:59], 0
s_add_u32 s26, s26, 524288
v_mfma_f32_16x16x32_bf16 a[252:255], a[140:143], a[60:63], a[252:255]
s_waitcnt lgkmcnt(2)
Lg_1:
v_mfma_f32_16x16x32_bf16 v[32:35], a[128:131], a[64:67], v[32:35]
s_waitcnt lgkmcnt(0)
s_add_u32 m0, s29, 81920
ds_read_b64_tr_b16 a[136:137], v5 offset:32768
v_mfma_f32_16x16x32_bf16 v[32:35], a[132:135], a[68:71], v[32:35]
buffer_load_dwordx4 v16, s[12:15], s27 offen offset:0 lds
v_mfma_f32_16x16x32_bf16 v[40:43], a[128:131], a[72:75], v[40:43]
ds_read_b64_tr_b16 a[138:139], v5 offset:34816
v_mfma_f32_16x16x32_bf16 v[40:43], a[132:135], a[76:79], v[40:43]
v_mfma_f32_16x16x32_bf16 v[48:51], a[128:131], a[80:83], v[48:51]
ds_read_b64_tr_b16 a[140:141], v5 offset:49152
v_mfma_f32_16x16x32_bf16 v[48:51], a[132:135], a[84:87], v[48:51]
buffer_load_dwordx4 v17, s[12:15], s27 offen offset:1024 lds
v_mfma_f32_16x16x32_bf16 v[56:59], a[128:131], a[88:91], v[56:59]
ds_read_b64_tr_b16 a[142:143], v5 offset:51200
v_mfma_f32_16x16x32_bf16 v[56:59], a[132:135], a[92:95], v[56:59]
v_mfma_f32_16x16x32_bf16 v[64:67], a[128:131], a[96:99], v[64:67]
ds_read_b128 a[0:3], v2 offset:0
v_mfma_f32_16x16x32_bf16 v[64:67], a[132:135], a[100:103], v[64:67]
buffer_load_dwordx4 v18, s[12:15], s27 offen offset:2048 lds
v_mfma_f32_16x16x32_bf16 v[72:75], a[128:131], a[104:107], v[72:75]
ds_read_b128 a[4:7], v3 offset:0
v_mfma_f32_16x16x32_bf16 v[72:75], a[132:135], a[108:111], v[72:75]
v_mfma_f32_16x16x32_bf16 v[80:83], a[128:131], a[112:115], v[80:83]
v_mfma_f32_16x16x32_bf16 v[80:83], a[132:135], a[116:119], v[80:83]
buffer_load_dwordx4 v19, s[12:15], s27 offen offset:3072 lds
v_mfma_f32_16x16x32_bf16 v[88:91], a[128:131], a[120:123], v[88:91]
s_add_u32 s27, s27, 524288
ds_read_b128 a[8:11], v2 offset:2048
v_mfma_f32_16x16x32_bf16 v[88:91], a[132:135], a[124:127], v[88:91]
s_waitcnt lgkmcnt(5)
v_mfma_f32_16x16x32_bf16 v[36:39], a[136:139], a[64:67], v[36:39]
s_waitcnt lgkmcnt(3)
s_add_u32 m0, s28, 32768
ds_read_b64_tr_b16 a[128:129], v6 offset:32768
v_mfma_f32_16x16x32_bf16 v[36:39], a[140:143], a[68:71], v[36:39]
buffer_load_dwordx4 v12, s[8:11], s24 offen offset:0 lds
v_mfma_f32_16x16x32_bf16 v[44:47], a[136:139], a[72:75], v[44:47]
ds_read_b64_tr_b16 a[130:131], v6 offset:34816
v_mfma_f32_16x16x32_bf16 v[44:47], a[140:143], a[76:79], v[44:47]
v_mfma_f32_16x16x32_bf16 v[52:55], a[136:139], a[80:83], v[52:55]
ds_read_b64_tr_b16 a[132:133], v6 offset:49152
v_mfma_f32_16x16x32_bf16 v[52:55], a[140:143], a[84:87], v[52:55]
buffer_load_dwordx4 v13, s[8:11], s24 offen offset:1024 lds
v_mfma_f32_16x16x32_bf16 v[60:63], a[136:139], a[88:91], v[60:63]
ds_read_b64_tr_b16 a[134:135], v6 offset:51200
v_mfma_f32_16x16x32_bf16 v[60:63], a[140:143], a[92:95], v[60:63]
v_mfma_f32_16x16x32_bf16 v[68:71], a[136:139], a[96:99], v[68:71]
ds_read_b128 a[12:15], v3 offset:2048
v_mfma_f32_16x16x32_bf16 v[68:71], a[140:143], a[100:103], v[68:71]
buffer_load_dwordx4 v14, s[8:11], s24 offen offset:2048 lds
v_mfma_f32_16x16x32_bf16 v[76:79], a[136:139], a[104:107], v[76:79]
v_mfma_f32_16x16x32_bf16 v[76:79], a[140:143], a[108:111], v[76:79]
v_mfma_f32_16x16x32_bf16 v[84:87], a[136:139], a[112:115], v[84:87]
ds_read_b128 a[16:19], v2 offset:4096
v_mfma_f32_16x16x32_bf16 v[84:87], a[140:143], a[116:119], v[84:87]
buffer_load_dwordx4 v15, s[8:11], s24 offen offset:3072 lds
v_mfma_f32_16x16x32_bf16 v[92:95], a[136:139], a[120:123], v[92:95]
s_add_u32 s24, s24, 128
ds_read_b128 a[20:23], v3 offset:4096
v_mfma_f32_16x16x32_bf16 v[92:95], a[140:143], a[124:127], v[92:95]
s_waitcnt lgkmcnt(5)
v_mfma_f32_16x16x32_bf16 v[96:99], a[128:131], a[64:67], v[96:99]
s_waitcnt lgkmcnt(3)
s_add_u32 m0, s28, 36864
ds_read_b64_tr_b16 a[136:137], v7 offset:32768
v_mfma_f32_16x16x32_bf16 v[96:99], a[132:135], a[68:71], v[96:99]
buffer_load_dwordx4 v12, s[8:11], s25 offen offset:0 lds
v_mfma_f32_16x16x32_bf16 v[104:107], a[128:131], a[72:75], v[104:107]
ds_read_b64_tr_b16 a[138:139], v7 offset:34816
v_mfma_f32_16x16x32_bf16 v[104:107], a[132:135], a[76:79], v[104:107]
v_mfma_f32_16x16x32_bf16 v[112:115], a[128:131], a[80:83], v[112:115]
ds_read_b64_tr_b16 a[140:141], v7 offset:49152
v_mfma_f32_16x16x32_bf16 v[112:115], a[132:135], a[84:87], v[112:115]
buffer_load_dwordx4 v13, s[8:11], s25 offen offset:1024 lds
v_mfma_f32_16x16x32_bf16 v[120:123], a[128:131], a[88:91], v[120:123]
ds_read_b64_tr_b16 a[142:143], v7 offset:51200
v_mfma_f32_16x16x32_bf16 v[120:123], a[132:135], a[92:95], v[120:123]
v_mfma_f32_16x16x32_bf16 v[128:131], a[128:131], a[96:99], v[128:131]
v_mfma_f32_16x16x32_bf16 v[128:131], a[132:135], a[100:103], v[128:131]
buffer_load_dwordx4 v14, s[8:11], s25 offen offset:2048 lds
v_mfma_f32_16x16x32_bf16 v[136:139], a[128:131], a[104:107], v[136:139]
ds_read_b128 a[24:27], v2 offset:6144
v_mfma_f32_16x16x32_bf16 v[136:139], a[132:135], a[108:111], v[136:139]
v_mfma_f32_16x16x32_bf16 v[144:147], a[128:131], a[112:115], v[144:147]
ds_read_b128 a[28:31], v3 offset:6144
v_mfma_f32_16x16x32_bf16 v[144:147], a[132:135], a[116:119], v[144:147]
buffer_load_dwordx4 v15, s[8:11], s25 offen offset:3072 lds
v_mfma_f32_16x16x32_bf16 v[152:155], a[128:131], a[120:123], v[152:155]
s_add_u32 s25, s25, 128
v_mfma_f32_16x16x32_bf16 v[152:155], a[132:135], a[124:127], v[152:155]
s_waitcnt lgkmcnt(4)
v_mfma_f32_16x16x32_bf16 v[100:103], a[136:139], a[64:67], v[100:103]
s_waitcnt lgkmcnt(2)
ds_read_b64_tr_b16 a[128:129], v8 offset:32768
v_mfma_f32_16x16x32_bf16 v[100:103], a[140:143], a[68:71], v[100:103]
buffer_load_dword v21, v20, s[16:19], s43 offen
v_mfma_f32_16x16x32_bf16 v[108:111], a[136:139], a[72:75], v[108:111]
s_add_u32 s43, s43, s47
ds_read_b64_tr_b16 a[130:131], v8 offset:34816
v_mfma_f32_16x16x32_bf16 v[108:111], a[140:143], a[76:79], v[108:111]
s_cmp_ge_u32 s43, s51
v_mfma_f32_16x16x32_bf16 v[116:119], a[136:139], a[80:83], v[116:119]
s_cselect_b32 s43, 0, s43
ds_read_b64_tr_b16 a[132:133], v8 offset:49152
v_mfma_f32_16x16x32_bf16 v[116:119], a[140:143], a[84:87], v[116:119]
s_cselect_b32 s51, s42, s51
v_mfma_f32_16x16x32_bf16 v[124:127], a[136:139], a[88:91], v[124:127]
s_cselect_b64 s[16:17], s[40:41], s[16:17]
ds_read_b64_tr_b16 a[134:135], v8 offset:51200
v_mfma_f32_16x16x32_bf16 v[124:127], a[140:143], a[92:95], v[124:127]
s_cselect_b32 s18, s42, s18
v_mfma_f32_16x16x32_bf16 v[132:135], a[136:139], a[96:99], v[132:135]
s_cselect_b64 s[40:41], s[44:45], s[40:41]
ds_read_b128 a[32:35], v2 offset:8192
v_mfma_f32_16x16x32_bf16 v[132:135], a[140:143], a[100:103], v[132:135]
s_cselect_b32 s42, s46, s42
v_mfma_f32_16x16x32_bf16 v[140:143], a[136:139], a[104:107], v[140:143]
s_cselect_b32 s46, 0, s46
v_mfma_f32_16x16x32_bf16 v[140:143], a[140:143], a[108:111], v[140:143]
s_cmp_eq_u32 s30, s55
v_mfma_f32_16x16x32_bf16 v[148:151], a[136:139], a[112:115], v[148:151]
s_cselect_b32 s22, 0, 3221225472
ds_read_b128 a[36:39], v3 offset:8192
v_mfma_f32_16x16x32_bf16 v[148:151], a[140:143], a[116:119], v[148:151]
s_sub_u32 s30, s30, 1
buffer_atomic_add v27, v26, s[60:63], s22 offen sc1
v_mfma_f32_16x16x32_bf16 v[156:159], a[136:139], a[120:123], v[156:159]
ds_read_b128 a[40:43], v2 offset:10240
v_mfma_f32_16x16x32_bf16 v[156:159], a[140:143], a[124:127], v[156:159]
s_waitcnt lgkmcnt(5)
v_mfma_f32_16x16x32_bf16 v[160:163], a[128:131], a[64:67], v[160:163]
s_waitcnt lgkmcnt(3)
ds_read_b64_tr_b16 a[136:137], v9 offset:32768
v_mfma_f32_16x16x32_bf16 v[160:163], a[132:135], a[68:71], v[160:163]
v_mfma_f32_16x16x32_bf16 v[168:171], a[128:131], a[72:75], v[168:171]
ds_read_b64_tr_b16 a[138:139], v9 offset:34816
v_mfma_f32_16x16x32_bf16 v[168:171], a[132:135], a[76:79], v[168:171]
v_mfma_f32_16x16x32_bf16 v[176:179], a[128:131], a[80:83], v[176:179]
ds_read_b64_tr_b16 a[140:141], v9 offset:49152
v_mfma_f32_16x16x32_bf16 v[176:179], a[132:135], a[84:87], v[176:179]
v_mfma_f32_16x16x32_bf16 v[184:187], a[128:131], a[88:91], v[184:187]
ds_read_b64_tr_b16 a[142:143], v9 offset:51200
v_mfma_f32_16x16x32_bf16 v[184:187], a[132:135], a[92:95], v[184:187]
v_mfma_f32_16x16x32_bf16 v[192:195], a[128:131], a[96:99], v[192:195]
v_mfma_f32_16x16x32_bf16 v[192:195], a[132:135], a[100:103], v[192:195]
v_mfma_f32_16x16x32_bf16 v[200:203], a[128:131], a[104:107], v[200:203]
ds_read_b128 a[44:47], v3 offset:10240
v_mfma_f32_16x16x32_bf16 v[200:203], a[132:135], a[108:111], v[200:203]
v_mfma_f32_16x16x32_bf16 v[208:211], a[128:131], a[112:115], v[208:211]
ds_read_b128 a[48:51], v2 offset:12288
v_mfma_f32_16x16x32_bf16 v[208:211], a[132:135], a[116:119], v[208:211]
v_mfma_f32_16x16x32_bf16 v[216:219], a[128:131], a[120:123], v[216:219]
v_mfma_f32_16x16x32_bf16 v[216:219], a[132:135], a[124:127], v[216:219]
s_waitcnt lgkmcnt(4)
v_mfma_f32_16x16x32_bf16 v[164:167], a[136:139], a[64:67], v[164:167]
s_waitcnt lgkmcnt(2)
ds_read_b64_tr_b16 a[128:129], v10 offset:32768
v_mfma_f32_16x16x32_bf16 v[164:167], a[140:143], a[68:71], v[164:167]
v_mfma_f32_16x16x32_bf16 v[172:175], a[136:139], a[72:75], v[172:175]
ds_read_b64_tr_b16 a[130:131], v10 offset:34816
v_mfma_f32_16x16x32_bf16 v[172:175], a[140:143], a[76:79], v[172:175]
v_mfma_f32_16x16x32_bf16 v[180:183], a[136:139], a[80:83], v[180:183]
ds_read_b64_tr_b16 a[132:133], v10 offset:49152
v_mfma_f32_16x16x32_bf16 v[180:183], a[140:143], a[84:87], v[180:183]
v_mfma_f32_16x16x32_bf16 v[188:191], a[136:139], a[88:91], v[188:191]
ds_read_b64_tr_b16 a[134:135], v10 offset:51200
v_mfma_f32_16x16x32_bf16 v[188:191], a[140:143], a[92:95], v[188:191]
v_mfma_f32_16x16x32_bf16 v[196:199], a[136:139], a[96:99], v[196:199]
ds_read_b128 a[52:55], v3 offset:12288
v_mfma_f32_16x16x32_bf16 v[196:199], a[140:143], a[100:103], v[196:199]
v_mfma_f32_16x16x32_bf16 v[204:207], a[136:139], a[104:107], v[204:207]
ds_read_b128 a[56:59], v2 offset:14336
v_mfma_f32_16x16x32_bf16 v[204:207], a[140:143], a[108:111], v[204:207]
v_mfma_f32_16x16x32_bf16 v[212:215], a[136:139], a[112:115], v[212:215]
v_mfma_f32_16x16x32_bf16 v[212:215], a[140:143], a[116:119], v[212:215]
v_mfma_f32_16x16x32_bf16 v[220:223], a[136:139], a[120:123], v[220:223]
ds_read_b128 a[60:63], v3 offset:14336
v_mfma_f32_16x16x32_bf16 v[220:223], a[140:143], a[124:127], v[220:223]
s_waitcnt lgkmcnt(5)
v_mfma_f32_16x16x32_bf16 a[192:195], a[128:131], a[64:67], a[192:195]
s_waitcnt lgkmcnt(3)
ds_read_b64_tr_b16 a[136:137], v11 offset:32768
v_mfma_f32_16x16x32_bf16 a[192:195], a[132:135], a[68:71], a[192:195]
v_mfma_f32_16x16x32_bf16 a[200:203], a[128:131], a[72:75], a[200:203]
ds_read_b64_tr_b16 a[138:139], v11 offset:34816
v_mfma_f32_16x16x32_bf16 a[200:203], a[132:135], a[76:79], a[200:203]
v_mfma_f32_16x16x32_bf16 a[208:211], a[128:131], a[80:83], a[208:211]
ds_read_b64_tr_b16 a[140:141], v11 offset:49152
v_mfma_f32_16x16x32_bf16 a[208:211], a[132:135], a[84:87], a[208:211]
v_mfma_f32_16x16x32_bf16 a[216:219], a[128:131], a[88:91], a[216:219]
ds_read_b64_tr_b16 a[142:143], v11 offset:51200
v_mfma_f32_16x16x32_bf16 a[216:219], a[132:135], a[92:95], a[216:219]
v_mfma_f32_16x16x32_bf16 a[224:227], a[128:131], a[96:99], a[224:227]
v_mfma_f32_16x16x32_bf16 a[224:227], a[132:135], a[100:103], a[224:227]
v_mfma_f32_16x16x32_bf16 a[232:235], a[128:131], a[104:107], a[232:235]
v_mfma_f32_16x16x32_bf16 a[232:235], a[132:135], a[108:111], a[232:235]
v_mfma_f32_16x16x32_bf16 a[240:243], a[128:131], a[112:115], a[240:243]
v_mfma_f32_16x16x32_bf16 a[240:243], a[132:135], a[116:119], a[240:243]
v_mfma_f32_16x16x32_bf16 a[248:251], a[128:131], a[120:123], a[248:251]
v_mfma_f32_16x16x32_bf16 a[248:251], a[132:135], a[124:127], a[248:251]
s_waitcnt vmcnt(2) lgkmcnt(0)
s_barrier
v_mfma_f32_16x16x32_bf16 a[196:199], a[136:139], a[64:67], a[196:199]
s_add_u32 m0, s29, 98304
ds_read_b64_tr_b16 a[128:129], v4 offset:0
v_mfma_f32_16x16x32_bf16 a[196:199], a[140:143], a[68:71], a[196:199]
buffer_load_dwordx4 v16, s[12:15], s26 offen offset:0 lds
v_mfma_f32_16x16x32_bf16 a[204:207], a[136:139], a[72:75], a[204:207]
ds_read_b64_tr_b16 a[130:131], v4 offset:2048
v_mfma_f32_16x16x32_bf16 a[204:207], a[140:143], a[76:79], a[204:207]
v_mfma_f32_16x16x32_bf16 a[212:215], a[136:139], a[80:83], a[212:215]
ds_read_b64_tr_b16 a[132:133], v4 offset:16384
v_mfma_f32_16x16x32_bf16 a[212:215], a[140:143], a[84:87], a[212:215]
buffer_load_dwordx4 v17, s[12:15], s26 offen offset:1024 lds
v_mfma_f32_16x16x32_bf16 a[220:223], a[136:139], a[88:91], a[220:223]
ds_read_b64_tr_b16 a[134:135], v4 offset:18432
v_mfma_f32_16x16x32_bf16 a[220:223], a[140:143], a[92:95], a[220:223]
v_mfma_f32_16x16x32_bf16 a[228:231], a[136:139], a[96:99], a[228:231]
v_mfma_f32_16x16x32_bf16 a[228:231], a[140:143], a[100:103], a[228:231]
buffer_load_dwordx4 v18, s[12:15], s26 offen offset:2048 lds
v_mfma_f32_16x16x32_bf16 a[236:239], a[136:139], a[104:107], a[236:239]
v_mfma_f32_16x16x32_bf16 a[236:239], a[140:143], a[108:111], a[236:239]
v_mfma_f32_16x16x32_bf16 a[244:247], a[136:139], a[112:115], a[244:247]
v_mfma_f32_16x16x32_bf16 a[244:247], a[140:143], a[116:119], a[244:247]
buffer_load_dwordx4 v19, s[12:15], s26 offen offset:3072 lds
v_mfma_f32_16x16x32_bf16 a[252:255], a[136:139], a[120:123], a[252:255]
s_add_u32 s26, s26, 524288
v_mfma_f32_16x16x32_bf16 a[252:255], a[140:143], a[124:127], a[252:255]
s_waitcnt lgkmcnt(2)
buffer_store_dword v27, v26, s[4:7], s82 offen sc1
v_mfma_f32_16x16x32_bf16 v[32:35], a[128:131], a[0:3], v[32:35]
s_waitcnt lgkmcnt(0)
s_add_u32 m0, s29, 114688
ds_read_b64_tr_b16 a[136:137], v5 offset:0
v_mfma_f32_16x16x32_bf16 v[32:35], a[132:135], a[4:7], v[32:35]
buffer_load_dwordx4 v16, s[12:15], s27 offen offset:0 lds
v_mfma_f32_16x16x32_bf16 v[40:43], a[128:131], a[8:11], v[40:43]
ds_read_b64_tr_b16 a[138:139], v5 offset:2048
v_mfma_f32_16x16x32_bf16 v[40:43], a[132:135], a[12:15], v[40:43]
v_mfma_f32_16x16x32_bf16 v[48:51], a[128:131], a[16:19], v[48:51]
ds_read_b64_tr_b16 a[140:141], v5 offset:16384
v_mfma_f32_16x16x32_bf16 v[48:51], a[132:135], a[20:23], v[48:51]
buffer_load_dwordx4 v17, s[12:15], s27 offen offset:1024 lds
v_mfma_f32_16x16x32_bf16 v[56:59], a[128:131], a[24:27], v[56:59]
ds_read_b64_tr_b16 a[142:143], v5 offset:18432
v_mfma_f32_16x16x32_bf16 v[56:59], a[132:135], a[28:31], v[56:59]
v_mfma_f32_16x16x32_bf16 v[64:67], a[128:131], a[32:35], v[64:67]
ds_read_b128 a[64:67], v2 offset:32768
v_mfma_f32_16x16x32_bf16 v[64:67], a[132:135], a[36:39], v[64:67]
buffer_load_dwordx4 v18, s[12:15], s27 offen offset:2048 lds
v_mfma_f32_16x16x32_bf16 v[72:75], a[128:131], a[40:43], v[72:75]
ds_read_b128 a[68:71], v3 offset:32768
v_mfma_f32_16x16x32_bf16 v[72:75], a[132:135], a[44:47], v[72:75]
v_mfma_f32_16x16x32_bf16 v[80:83], a[128:131], a[48:51], v[80:83]
v_mfma_f32_16x16x32_bf16 v[80:83], a[132:135], a[52:55], v[80:83]
buffer_load_dwordx4 v19, s[12:15], s27 offen offset:3072 lds
v_mfma_f32_16x16x32_bf16 v[88:91], a[128:131], a[56:59], v[88:91]
s_add_u32 s27, s27, 524288
ds_read_b128 a[72:75], v2 offset:34816
v_mfma_f32_16x16x32_bf16 v[88:91], a[132:135], a[60:63], v[88:91]
s_waitcnt lgkmcnt(5)
v_mfma_f32_16x16x32_bf16 v[36:39], a[136:139], a[0:3], v[36:39]
s_waitcnt lgkmcnt(3)
s_add_u32 m0, s28, 0
ds_read_b64_tr_b16 a[128:129], v6 offset:0
v_mfma_f32_16x16x32_bf16 v[36:39], a[140:143], a[4:7], v[36:39]
buffer_load_dwordx4 v12, s[8:11], s24 offen offset:0 lds
v_mfma_f32_16x16x32_bf16 v[44:47], a[136:139], a[8:11], v[44:47]
ds_read_b64_tr_b16 a[130:131], v6 offset:2048
v_mfma_f32_16x16x32_bf16 v[44:47], a[140:143], a[12:15], v[44:47]
v_mfma_f32_16x16x32_bf16 v[52:55], a[136:139], a[16:19], v[52:55]
ds_read_b64_tr_b16 a[132:133], v6 offset:16384
v_mfma_f32_16x16x32_bf16 v[52:55], a[140:143], a[20:23], v[52:55]
buffer_load_dwordx4 v13, s[8:11], s24 offen offset:1024 lds
v_mfma_f32_16x16x32_bf16 v[60:63], a[136:139], a[24:27], v[60:63]
ds_read_b64_tr_b16 a[134:135], v6 offset:18432
v_mfma_f32_16x16x32_bf16 v[60:63], a[140:143], a[28:31], v[60:63]
v_mfma_f32_16x16x32_bf16 v[68:71], a[136:139], a[32:35], v[68:71]
ds_read_b128 a[76:79], v3 offset:34816
v_mfma_f32_16x16x32_bf16 v[68:71], a[140:143], a[36:39], v[68:71]
buffer_load_dwordx4 v14, s[8:11], s24 offen offset:2048 lds
v_mfma_f32_16x16x32_bf16 v[76:79], a[136:139], a[40:43], v[76:79]
v_mfma_f32_16x16x32_bf16 v[76:79], a[140:143], a[44:47], v[76:79]
v_mfma_f32_16x16x32_bf16 v[84:87], a[136:139], a[48:51], v[84:87]
ds_read_b128 a[80:83], v2 offset:36864
v_mfma_f32_16x16x32_bf16 v[84:87], a[140:143], a[52:55], v[84:87]
buffer_load_dwordx4 v15, s[8:11], s24 offen offset:3072 lds
v_mfma_f32_16x16x32_bf16 v[92:95], a[136:139], a[56:59], v[92:95]
s_add_u32 s24, s24, 128
ds_read_b128 a[84:87], v3 offset:36864
v_mfma_f32_16x16x32_bf16 v[92:95], a[140:143], a[60:63], v[92:95]
s_waitcnt lgkmcnt(5)
v_mfma_f32_16x16x32_bf16 v[96:99], a[128:131], a[0:3], v[96:99]
s_waitcnt lgkmcnt(3)
s_add_u32 m0, s28, 4096
ds_read_b64_tr_b16 a[136:137], v7 offset:0
v_mfma_f32_16x16x32_bf16 v[96:99], a[132:135], a[4:7], v[96:99]
buffer_load_dwordx4 v12, s[8:11], s25 offen offset:0 lds
v_mfma_f32_16x16x32_bf16 v[104:107], a[128:131], a[8:11], v[104:107]
ds_read_b64_tr_b16 a[138:139], v7 offset:2048
v_mfma_f32_16x16x32_bf16 v[104:107], a[132:135], a[12:15], v[104:107]
v_mfma_f32_16x16x32_bf16 v[112:115], a[128:131], a[16:19], v[112:115]
ds_read_b64_tr_b16 a[140:141], v7 offset:16384
v_mfma_f32_16x16x32_bf16 v[112:115], a[132:135], a[20:23], v[112:115]
buffer_load_dwordx4 v13, s[8:11], s25 offen offset:1024 lds
v_mfma_f32_16x16x32_bf16 v[120:123], a[128:131], a[24:27], v[120:123]
ds_read_b64_tr_b16 a[142:143], v7 offset:18432
v_mfma_f32_16x16x32_bf16 v[120:123], a[132:135], a[28:31], v[120:123]
v_mfma_f32_16x16x32_bf16 v[128:131], a[128:131], a[32:35], v[128:131]
v_mfma_f32_16x16x32_bf16 v[128:131], a[132:135], a[36:39], v[128:131]
buffer_load_dwordx4 v14, s[8:11], s25 offen offset:2048 lds
v_mfma_f32_16x16x32_bf16 v[136:139], a[128:131], a[40:43], v[136:139]
ds_read_b128 a[88:91], v2 offset:38912
v_mfma_f32_16x16x32_bf16 v[136:139], a[132:135], a[44:47], v[136:139]
v_mfma_f32_16x16x32_bf16 v[144:147], a[128:131], a[48:51], v[144:147]
ds_read_b128 a[92:95], v3 offset:38912
v_mfma_f32_16x16x32_bf16 v[144:147], a[132:135], a[52:55], v[144:147]
buffer_load_dwordx4 v15, s[8:11], s25 offen offset:3072 lds
v_mfma_f32_16x16x32_bf16 v[152:155], a[128:131], a[56:59], v[152:155]
s_add_u32 s25, s25, 128
v_mfma_f32_16x16x32_bf16 v[152:155], a[132:135], a[60:63], v[152:155]
s_waitcnt lgkmcnt(4)
v_mfma_f32_16x16x32_bf16 v[100:103], a[136:139], a[0:3], v[100:103]
s_waitcnt lgkmcnt(2)
ds_read_b64_tr_b16 a[128:129], v8 offset:0
v_mfma_f32_16x16x32_bf16 v[100:103], a[140:143], a[4:7], v[100:103]
buffer_load_dword v21, v20, s[16:19], s43 offen
v_mfma_f32_16x16x32_bf16 v[108:111], a[136:139], a[8:11], v[108:111]
s_add_u32 s43, s43, s47
ds_read_b64_tr_b16 a[130:131], v8 offset:2048
v_mfma_f32_16x16x32_bf16 v[108:111], a[140:143], a[12:15], v[108:111]
s_cmp_ge_u32 s43, s51
v_mfma_f32_16x16x32_bf16 v[116:119], a[136:139], a[16:19], v[116:119]
s_cselect_b32 s43, 0, s43
ds_read_b64_tr_b16 a[132:133], v8 offset:16384
v_mfma_f32_16x16x32_bf16 v[116:119], a[140:143], a[20:23], v[116:119]
s_cselect_b32 s51, s42, s51
v_mfma_f32_16x16x32_bf16 v[124:127], a[136:139], a[24:27], v[124:127]
s_cselect_b64 s[16:17], s[40:41], s[16:17]
ds_read_b64_tr_b16 a[134:135], v8 offset:18432
v_mfma_f32_16x16x32_bf16 v[124:127], a[140:143], a[28:31], v[124:127]
s_cselect_b32 s18, s42, s18
v_mfma_f32_16x16x32_bf16 v[132:135], a[136:139], a[32:35], v[132:135]
s_cselect_b64 s[40:41], s[44:45], s[40:41]
ds_read_b128 a[96:99], v2 offset:40960
v_mfma_f32_16x16x32_bf16 v[132:135], a[140:143], a[36:39], v[132:135]
s_cselect_b32 s42, s46, s42
v_mfma_f32_16x16x32_bf16 v[140:143], a[136:139], a[40:43], v[140:143]
s_cselect_b32 s46, 0, s46
v_mfma_f32_16x16x32_bf16 v[140:143], a[140:143], a[44:47], v[140:143]
s_cmp_eq_u32 s30, s55
v_mfma_f32_16x16x32_bf16 v[148:151], a[136:139], a[48:51], v[148:151]
s_cselect_b32 s22, 0, 3221225472
ds_read_b128 a[100:103], v3 offset:40960
v_mfma_f32_16x16x32_bf16 v[148:151], a[140:143], a[52:55], v[148:151]
s_sub_u32 s30, s30, 1
buffer_atomic_add v27, v26, s[60:63], s22 offen sc1
v_mfma_f32_16x16x32_bf16 v[156:159], a[136:139], a[56:59], v[156:159]
ds_read_b128 a[104:107], v2 offset:43008
v_mfma_f32_16x16x32_bf16 v[156:159], a[140:143], a[60:63], v[156:159]
s_waitcnt lgkmcnt(5)
v_mfma_f32_16x16x32_bf16 v[160:163], a[128:131], a[0:3], v[160:163]
s_waitcnt lgkmcnt(3)
ds_read_b64_tr_b16 a[136:137], v9 offset:0
v_mfma_f32_16x16x32_bf16 v[160:163], a[132:135], a[4:7], v[160:163]
v_mfma_f32_16x16x32_bf16 v[168:171], a[128:131], a[8:11], v[168:171]
ds_read_b64_tr_b16 a[138:139], v9 offset:2048
v_mfma_f32_16x16x32_bf16 v[168:171], a[132:135], a[12:15], v[168:171]
v_mfma_f32_16x16x32_bf16 v[176:179], a[128:131], a[16:19], v[176:179]
ds_read_b64_tr_b16 a[140:141], v9 offset:16384
v_mfma_f32_16x16x32_bf16 v[176:179], a[132:135], a[20:23], v[176:179]
v_mfma_f32_16x16x32_bf16 v[184:187], a[128:131], a[24:27], v[184:187]
ds_read_b64_tr_b16 a[142:143], v9 offset:18432
v_mfma_f32_16x16x32_bf16 v[184:187], a[132:135], a[28:31], v[184:187]
v_mfma_f32_16x16x32_bf16 v[192:195], a[128:131], a[32:35], v[192:195]
v_mfma_f32_16x16x32_bf16 v[192:195], a[132:135], a[36:39], v[192:195]
v_mfma_f32_16x16x32_bf16 v[200:203], a[128:131], a[40:43], v[200:203]
ds_read_b128 a[108:111], v3 offset:43008
v_mfma_f32_16x16x32_bf16 v[200:203], a[132:135], a[44:47], v[200:203]
v_mfma_f32_16x16x32_bf16 v[208:211], a[128:131], a[48:51], v[208:211]
ds_read_b128 a[112:115], v2 offset:45056
v_mfma_f32_16x16x32_bf16 v[208:211], a[132:135], a[52:55], v[208:211]
v_mfma_f32_16x16x32_bf16 v[216:219], a[128:131], a[56:59], v[216:219]
v_mfma_f32_16x16x32_bf16 v[216:219], a[132:135], a[60:63], v[216:219]
s_waitcnt lgkmcnt(4)
v_mfma_f32_16x16x32_bf16 v[164:167], a[136:139], a[0:3], v[164:167]
s_waitcnt lgkmcnt(2)
ds_read_b64_tr_b16 a[128:129], v10 offset:0
v_mfma_f32_16x16x32_bf16 v[164:167], a[140:143], a[4:7], v[164:167]
v_mfma_f32_16x16x32_bf16 v[172:175], a[136:139], a[8:11], v[172:175]
ds_read_b64_tr_b16 a[130:131], v10 offset:2048
v_mfma_f32_16x16x32_bf16 v[172:175], a[140:143], a[12:15], v[172:175]
v_mfma_f32_16x16x32_bf16 v[180:183], a[136:139], a[16:19], v[180:183]
ds_read_b64_tr_b16 a[132:133], v10 offset:16384
v_mfma_f32_16x16x32_bf16 v[180:183], a[140:143], a[20:23], v[180:183]
v_mfma_f32_16x16x32_bf16 v[188:191], a[136:139], a[24:27], v[188:191]
ds_read_b64_tr_b16 a[134:135], v10 offset:18432
v_mfma_f32_16x16x32_bf16 v[188:191], a[140:143], a[28:31], v[188:191]
v_mfma_f32_16x16x32_bf16 v[196:199], a[136:139], a[32:35], v[196:199]
ds_read_b128 a[116:119], v3 offset:45056
v_mfma_f32_16x16x32_bf16 v[196:199], a[140:143], a[36:39], v[196:199]
v_mfma_f32_16x16x32_bf16 v[204:207], a[136:139], a[40:43], v[204:207]
ds_read_b128 a[120:123], v2 offset:47104
v_mfma_f32_16x16x32_bf16 v[204:207], a[140:143], a[44:47], v[204:207]
v_mfma_f32_16x16x32_bf16 v[212:215], a[136:139], a[48:51], v[212:215]
v_mfma_f32_16x16x32_bf16 v[212:215], a[140:143], a[52:55], v[212:215]
v_mfma_f32_16x16x32_bf16 v[220:223], a[136:139], a[56:59], v[220:223]
ds_read_b128 a[124:127], v3 offset:47104
v_mfma_f32_16x16x32_bf16 v[220:223], a[140:143], a[60:63], v[220:223]
s_waitcnt lgkmcnt(5)
v_mfma_f32_16x16x32_bf16 a[192:195], a[128:131], a[0:3], a[192:195]
s_waitcnt lgkmcnt(3)
ds_read_b64_tr_b16 a[136:137], v11 offset:0
v_mfma_f32_16x16x32_bf16 a[192:195], a[132:135], a[4:7], a[192:195]
v_mfma_f32_16x16x32_bf16 a[200:203], a[128:131], a[8:11], a[200:203]
ds_read_b64_tr_b16 a[138:139], v11 offset:2048
v_mfma_f32_16x16x32_bf16 a[200:203], a[132:135], a[12:15], a[200:203]
v_mfma_f32_16x16x32_bf16 a[208:211], a[128:131], a[16:19], a[208:211]
ds_read_b64_tr_b16 a[140:141], v11 offset:16384
v_mfma_f32_16x16x32_bf16 a[208:211], a[132:135], a[20:23], a[208:211]
v_mfma_f32_16x16x32_bf16 a[216:219], a[128:131], a[24:27], a[216:219]
ds_read_b64_tr_b16 a[142:143], v11 offset:18432
v_mfma_f32_16x16x32_bf16 a[216:219], a[132:135], a[28:31], a[216:219]
v_mfma_f32_16x16x32_bf16 a[224:227], a[128:131], a[32:35], a[224:227]
v_mfma_f32_16x16x32_bf16 a[224:227], a[132:135], a[36:39], a[224:227]
v_mfma_f32_16x16x32_bf16 a[232:235], a[128:131], a[40:43], a[232:235]
v_mfma_f32_16x16x32_bf16 a[232:235], a[132:135], a[44:47], a[232:235]
v_mfma_f32_16x16x32_bf16 a[240:243], a[128:131], a[48:51], a[240:243]
v_mfma_f32_16x16x32_bf16 a[240:243], a[132:135], a[52:55], a[240:243]
v_mfma_f32_16x16x32_bf16 a[248:251], a[128:131], a[56:59], a[248:251]
v_mfma_f32_16x16x32_bf16 a[248:251], a[132:135], a[60:63], a[248:251]
s_waitcnt vmcnt(2) lgkmcnt(0)
s_barrier
v_mfma_f32_16x16x32_bf16 a[196:199], a[136:139], a[0:3], a[196:199]
s_add_u32 m0, s29, 65536
ds_read_b64_tr_b16 a[128:129], v4 offset:32768
v_mfma_f32_16x16x32_bf16 a[196:199], a[140:143], a[4:7], a[196:199]
buffer_load_dwordx4 v16, s[12:15], s26 offen offset:0 lds
v_mfma_f32_16x16x32_bf16 a[204:207], a[136:139], a[8:11], a[204:207]
ds_read_b64_tr_b16 a[130:131], v4 offset:34816
v_mfma_f32_16x16x32_bf16 a[204:207], a[140:143], a[12:15], a[204:207]
v_mfma_f32_16x16x32_bf16 a[212:215], a[136:139], a[16:19], a[212:215]
ds_read_b64_tr_b16 a[132:133], v4 offset:49152
v_mfma_f32_16x16x32_bf16 a[212:215], a[140:143], a[20:23], a[212:215]
buffer_load_dwordx4 v17, s[12:15], s26 offen offset:1024 lds
v_mfma_f32_16x16x32_bf16 a[220:223], a[136:139], a[24:27], a[220:223]
ds_read_b64_tr_b16 a[134:135], v4 offset:51200
v_mfma_f32_16x16x32_bf16 a[220:223], a[140:143], a[28:31], a[220:223]
v_mfma_f32_16x16x32_bf16 a[228:231], a[136:139], a[32:35], a[228:231]
v_mfma_f32_16x16x32_bf16 a[228:231], a[140:143], a[36:39], a[228:231]
buffer_load_dwordx4 v18, s[12:15], s26 offen offset:2048 lds
v_mfma_f32_16x16x32_bf16 a[236:239], a[136:139], a[40:43], a[236:239]
v_mfma_f32_16x16x32_bf16 a[236:239], a[140:143], a[44:47], a[236:239]
v_mfma_f32_16x16x32_bf16 a[244:247], a[136:139], a[48:51], a[244:247]
v_mfma_f32_16x16x32_bf16 a[244:247], a[140:143], a[52:55], a[244:247]
buffer_load_dwordx4 v19, s[12:15], s26 offen offset:3072 lds
v_mfma_f32_16x16x32_bf16 a[252:255], a[136:139], a[56:59], a[252:255]
s_add_u32 s26, s26, 524288
v_mfma_f32_16x16x32_bf16 a[252:255], a[140:143], a[60:63], a[252:255]
s_waitcnt lgkmcnt(2)
s_bitcmp1_b32 s30, 1
s_cbranch_scc1 Lg_1
s_cmp_eq_u32 s30, 0
s_cbranch_scc1 Lg_1t
v_mfma_f32_16x16x32_bf16 v[32:35], a[128:131], a[64:67], v[32:35]
s_waitcnt lgkmcnt(0)
s_add_u32 m0, s29, 81920
ds_read_b64_tr_b16 a[136:137], v5 offset:32768
v_mfma_f32_16x16x32_bf16 v[32:35], a[132:135], a[68:71], v[32:35]
buffer_load_dwordx4 v16, s[12:15], s27 offen offset:0 lds
v_mfma_f32_16x16x32_bf16 v[40:43], a[128:131], a[72:75], v[40:43]
s_lshl_b32 s22, s38, 3
ds_read_b64_tr_b16 a[138:139], v5 offset:34816
v_mfma_f32_16x16x32_bf16 v[40:43], a[132:135], a[76:79], v[40:43]
s_lshl_b32 s23, s39, 5
v_and_b32 v252, 31, v0
v_lshrrev_b32 v253, 5, v0
v_mfma_f32_16x16x32_bf16 v[48:51], a[128:131], a[80:83], v[48:51]
ds_read_b64_tr_b16 a[140:141], v5 offset:49152
v_add_u32 v253, s22, v253
v_mfma_f32_16x16x32_bf16 v[48:51], a[132:135], a[84:87], v[48:51]
buffer_load_dwordx4 v17, s[12:15], s27 offen offset:1024 lds
v_mfma_f32_16x16x32_bf16 v[56:59], a[128:131], a[88:91], v[56:59]
ds_read_b64_tr_b16 a[142:143], v5 offset:51200
v_add_u32 v252, s23, v252
v_mfma_f32_16x16x32_bf16 v[56:59], a[132:135], a[92:95], v[56:59]
v_mul_u32_u24 v254, 7168, v253
v_lshl_add_u32 v254, v252, 2, v254
v_mfma_f32_16x16x32_bf16 v[64:67], a[128:131], a[96:99], v[64:67]
ds_read_b128 a[0:3], v2 offset:0
v_lshlrev_b32 v252, 4, v252
v_mfma_f32_16x16x32_bf16 v[64:67], a[132:135], a[100:103], v[64:67]
buffer_load_dwordx4 v18, s[12:15], s27 offen offset:2048 lds
v_mfma_f32_16x16x32_bf16 v[72:75], a[128:131], a[104:107], v[72:75]
ds_read_b128 a[4:7], v3 offset:0
v_add_u32 v255, 3584, v254
v_mfma_f32_16x16x32_bf16 v[72:75], a[132:135], a[108:111], v[72:75]
v_subrev_u32 v22, 3584, v254
v_subrev_u32 v23, 2688, v254
v_mfma_f32_16x16x32_bf16 v[80:83], a[128:131], a[112:115], v[80:83]
v_subrev_u32 v24, 1792, v254
v_subrev_u32 v25, 896, v254
v_mfma_f32_16x16x32_bf16 v[80:83], a[132:135], a[116:119], v[80:83]
buffer_load_dwordx4 v19, s[12:15], s27 offen offset:3072 lds
v_mfma_f32_16x16x32_bf16 v[88:91], a[128:131], a[120:123], v[88:91]
s_add_u32 s27, s27, 524288
ds_read_b128 a[8:11], v2 offset:2048
v_mfma_f32_16x16x32_bf16 v[88:91], a[132:135], a[124:127], v[88:91]
s_waitcnt lgkmcnt(5)
v_mfma_f32_16x16x32_bf16 v[36:39], a[136:139], a[64:67], v[36:39]
s_waitcnt lgkmcnt(3)
s_add_u32 m0, s28, 32768
ds_read_b64_tr_b16 a[128:129], v6 offset:32768
v_mfma_f32_16x16x32_bf16 v[36:39], a[140:143], a[68:71], v[36:39]
buffer_load_dwordx4 v12, s[8:11], s24 offen offset:0 lds
v_mfma_f32_16x16x32_bf16 v[44:47], a[136:139], a[72:75], v[44:47]
ds_read_b64_tr_b16 a[130:131], v6 offset:34816
v_mfma_f32_16x16x32_bf16 v[44:47], a[140:143], a[76:79], v[44:47]
v_mfma_f32_16x16x32_bf16 v[52:55], a[136:139], a[80:83], v[52:55]
ds_read_b64_tr_b16 a[132:133], v6 offset:49152
v_mfma_f32_16x16x32_bf16 v[52:55], a[140:143], a[84:87], v[52:55]
buffer_load_dwordx4 v13, s[8:11], s24 offen offset:1024 lds
v_mfma_f32_16x16x32_bf16 v[60:63], a[136:139], a[88:91], v[60:63]
ds_read_b64_tr_b16 a[134:135], v6 offset:51200
v_mfma_f32_16x16x32_bf16 v[60:63], a[140:143], a[92:95], v[60:63]
v_mfma_f32_16x16x32_bf16 v[68:71], a[136:139], a[96:99], v[68:71]
ds_read_b128 a[12:15], v3 offset:2048
v_mfma_f32_16x16x32_bf16 v[68:71], a[140:143], a[100:103], v[68:71]
buffer_load_dwordx4 v14, s[8:11], s24 offen offset:2048 lds
v_mfma_f32_16x16x32_bf16 v[76:79], a[136:139], a[104:107], v[76:79]
v_mfma_f32_16x16x32_bf16 v[76:79], a[140:143], a[108:111], v[76:79]
v_mfma_f32_16x16x32_bf16 v[84:87], a[136:139], a[112:115], v[84:87]
ds_read_b128 a[16:19], v2 offset:4096
v_mfma_f32_16x16x32_bf16 v[84:87], a[140:143], a[116:119], v[84:87]
buffer_load_dwordx4 v15, s[8:11], s24 offen offset:3072 lds
v_mfma_f32_16x16x32_bf16 v[92:95], a[136:139], a[120:123], v[92:95]
s_add_u32 s24, s24, 128
ds_read_b128 a[20:23], v3 offset:4096
v_mfma_f32_16x16x32_bf16 v[92:95], a[140:143], a[124:127], v[92:95]
s_waitcnt lgkmcnt(5)
v_mfma_f32_16x16x32_bf16 v[96:99], a[128:131], a[64:67], v[96:99]
s_waitcnt lgkmcnt(3)
s_add_u32 m0, s28, 36864
ds_read_b64_tr_b16 a[136:137], v7 offset:32768
v_mfma_f32_16x16x32_bf16 v[96:99], a[132:135], a[68:71], v[96:99]
buffer_load_dwordx4 v12, s[8:11], s25 offen offset:0 lds
v_mfma_f32_16x16x32_bf16 v[104:107], a[128:131], a[72:75], v[104:107]
ds_read_b64_tr_b16 a[138:139], v7 offset:34816
v_mfma_f32_16x16x32_bf16 v[104:107], a[132:135], a[76:79], v[104:107]
v_mfma_f32_16x16x32_bf16 v[112:115], a[128:131], a[80:83], v[112:115]
ds_read_b64_tr_b16 a[140:141], v7 offset:49152
v_mfma_f32_16x16x32_bf16 v[112:115], a[132:135], a[84:87], v[112:115]
buffer_load_dwordx4 v13, s[8:11], s25 offen offset:1024 lds
v_mfma_f32_16x16x32_bf16 v[120:123], a[128:131], a[88:91], v[120:123]
ds_read_b64_tr_b16 a[142:143], v7 offset:51200
v_mfma_f32_16x16x32_bf16 v[120:123], a[132:135], a[92:95], v[120:123]
v_mfma_f32_16x16x32_bf16 v[128:131], a[128:131], a[96:99], v[128:131]
v_mfma_f32_16x16x32_bf16 v[128:131], a[132:135], a[100:103], v[128:131]
buffer_load_dwordx4 v14, s[8:11], s25 offen offset:2048 lds
v_mfma_f32_16x16x32_bf16 v[136:139], a[128:131], a[104:107], v[136:139]
ds_read_b128 a[24:27], v2 offset:6144
v_mfma_f32_16x16x32_bf16 v[136:139], a[132:135], a[108:111], v[136:139]
v_mfma_f32_16x16x32_bf16 v[144:147], a[128:131], a[112:115], v[144:147]
ds_read_b128 a[28:31], v3 offset:6144
v_mfma_f32_16x16x32_bf16 v[144:147], a[132:135], a[116:119], v[144:147]
buffer_load_dwordx4 v15, s[8:11], s25 offen offset:3072 lds
v_mfma_f32_16x16x32_bf16 v[152:155], a[128:131], a[120:123], v[152:155]
s_add_u32 s25, s25, 128
v_mfma_f32_16x16x32_bf16 v[152:155], a[132:135], a[124:127], v[152:155]
s_waitcnt lgkmcnt(2)
v_mfma_f32_16x16x32_bf16 v[100:103], a[136:139], a[64:67], v[100:103]
s_mov_b64 s[56:57], s[70:71]
s_mov_b32 s58, 3584
s_mov_b32 s59, 0x20000
ds_read_b64_tr_b16 a[128:129], v8 offset:32768
buffer_load_dwordx4 v[248:251], v252, s[56:59], 0 offen
v_mfma_f32_16x16x32_bf16 v[100:103], a[140:143], a[68:71], v[100:103]
s_mov_b64 s[56:57], s[66:67]
s_mov_b32 s58, 1835008
buffer_load_dword v224, v22, s[56:59], 0 offen nt
v_mfma_f32_16x16x32_bf16 v[108:111], a[136:139], a[72:75], v[108:111]
ds_read_b64_tr_b16 a[130:131], v8 offset:34816
buffer_load_dword v225, v23, s[56:59], 0 offen nt
v_mfma_f32_16x16x32_bf16 v[108:111], a[140:143], a[76:79], v[108:111]
buffer_load_dword v226, v24, s[56:59], 0 offen nt
v_mfma_f32_16x16x32_bf16 v[116:119], a[136:139], a[80:83], v[116:119]
ds_read_b64_tr_b16 a[132:133], v8 offset:49152
buffer_load_dword v227, v25, s[56:59], 0 offen nt
v_mfma_f32_16x16x32_bf16 v[116:119], a[140:143], a[84:87], v[116:119]
buffer_load_dword v228, v254, s[56:59], 0 offen offset:0 nt
v_mfma_f32_16x16x32_bf16 v[124:127], a[136:139], a[88:91], v[124:127]
ds_read_b64_tr_b16 a[134:135], v8 offset:51200
buffer_load_dword v229, v254, s[56:59], 0 offen offset:896 nt
v_mfma_f32_16x16x32_bf16 v[124:127], a[140:143], a[92:95], v[124:127]
buffer_load_dword v230, v254, s[56:59], 0 offen offset:1792 nt
v_mfma_f32_16x16x32_bf16 v[132:135], a[136:139], a[96:99], v[132:135]
ds_read_b128 a[32:35], v2 offset:8192
buffer_load_dword v231, v254, s[56:59], 0 offen offset:2688 nt
v_mfma_f32_16x16x32_bf16 v[132:135], a[140:143], a[100:103], v[132:135]
buffer_load_dword v232, v255, s[56:59], 0 offen offset:0 nt
v_mfma_f32_16x16x32_bf16 v[140:143], a[136:139], a[104:107], v[140:143]
buffer_load_dword v233, v255, s[56:59], 0 offen offset:896 nt
v_mfma_f32_16x16x32_bf16 v[140:143], a[140:143], a[108:111], v[140:143]
buffer_load_dword v234, v255, s[56:59], 0 offen offset:1792 nt
v_mfma_f32_16x16x32_bf16 v[148:151], a[136:139], a[112:115], v[148:151]
ds_read_b128 a[36:39], v3 offset:8192
buffer_load_dword v235, v255, s[56:59], 0 offen offset:2688 nt
v_mfma_f32_16x16x32_bf16 v[148:151], a[140:143], a[116:119], v[148:151]
s_mov_b64 s[56:57], s[68:69]
buffer_load_dword v236, v25, s[56:59], 0 offen nt
v_mfma_f32_16x16x32_bf16 v[156:159], a[136:139], a[120:123], v[156:159]
ds_read_b128 a[40:43], v2 offset:10240
buffer_load_dword v237, v254, s[56:59], 0 offen offset:0 nt
v_mfma_f32_16x16x32_bf16 v[156:159], a[140:143], a[124:127], v[156:159]
s_waitcnt lgkmcnt(5)
buffer_load_dword v238, v254, s[56:59], 0 offen offset:896 nt
v_mfma_f32_16x16x32_bf16 v[160:163], a[128:131], a[64:67], v[160:163]
s_waitcnt lgkmcnt(3)
ds_read_b64_tr_b16 a[136:137], v9 offset:32768
buffer_load_dword v239, v254, s[56:59], 0 offen offset:1792 nt
v_mfma_f32_16x16x32_bf16 v[160:163], a[132:135], a[68:71], v[160:163]
buffer_load_dword v240, v254, s[56:59], 0 offen offset:2688 nt
v_mfma_f32_16x16x32_bf16 v[168:171], a[128:131], a[72:75], v[168:171]
ds_read_b64_tr_b16 a[138:139], v9 offset:34816
buffer_load_dword v241, v255, s[56:59], 0 offen offset:0 nt
v_mfma_f32_16x16x32_bf16 v[168:171], a[132:135], a[76:79], v[168:171]
buffer_load_dword v242, v255, s[56:59], 0 offen offset:896 nt
v_mfma_f32_16x16x32_bf16 v[176:179], a[128:131], a[80:83], v[176:179]
ds_read_b64_tr_b16 a[140:141], v9 offset:49152
buffer_load_dword v243, v255, s[56:59], 0 offen offset:1792 nt
v_mfma_f32_16x16x32_bf16 v[176:179], a[132:135], a[84:87], v[176:179]
buffer_load_dword v244, v255, s[56:59], 0 offen offset:2688 nt
v_mfma_f32_16x16x32_bf16 v[184:187], a[128:131], a[88:91], v[184:187]
ds_read_b64_tr_b16 a[142:143], v9 offset:51200
v_mfma_f32_16x16x32_bf16 v[184:187], a[132:135], a[92:95], v[184:187]
v_mfma_f32_16x16x32_bf16 v[192:195], a[128:131], a[96:99], v[192:195]
v_mfma_f32_16x16x32_bf16 v[192:195], a[132:135], a[100:103], v[192:195]
v_mfma_f32_16x16x32_bf16 v[200:203], a[128:131], a[104:107], v[200:203]
ds_read_b128 a[44:47], v3 offset:10240
v_mfma_f32_16x16x32_bf16 v[200:203], a[132:135], a[108:111], v[200:203]
v_mfma_f32_16x16x32_bf16 v[208:211], a[128:131], a[112:115], v[208:211]
ds_read_b128 a[48:51], v2 offset:12288
v_mfma_f32_16x16x32_bf16 v[208:211], a[132:135], a[116:119], v[208:211]
v_mfma_f32_16x16x32_bf16 v[216:219], a[128:131], a[120:123], v[216:219]
v_mfma_f32_16x16x32_bf16 v[216:219], a[132:135], a[124:127], v[216:219]
s_waitcnt lgkmcnt(4)
v_mfma_f32_16x16x32_bf16 v[164:167], a[136:139], a[64:67], v[164:167]
s_waitcnt lgkmcnt(2)
ds_read_b64_tr_b16 a[128:129], v10 offset:32768
v_mfma_f32_16x16x32_bf16 v[164:167], a[140:143], a[68:71], v[164:167]
v_mfma_f32_16x16x32_bf16 v[172:175], a[136:139], a[72:75], v[172:175]
ds_read_b64_tr_b16 a[130:131], v10 offset:34816
v_mfma_f32_16x16x32_bf16 v[172:175], a[140:143], a[76:79], v[172:175]
v_mfma_f32_16x16x32_bf16 v[180:183], a[136:139], a[80:83], v[180:183]
ds_read_b64_tr_b16 a[132:133], v10 offset:49152
v_mfma_f32_16x16x32_bf16 v[180:183], a[140:143], a[84:87], v[180:183]
v_mfma_f32_16x16x32_bf16 v[188:191], a[136:139], a[88:91], v[188:191]
ds_read_b64_tr_b16 a[134:135], v10 offset:51200
v_mfma_f32_16x16x32_bf16 v[188:191], a[140:143], a[92:95], v[188:191]
v_mfma_f32_16x16x32_bf16 v[196:199], a[136:139], a[96:99], v[196:199]
ds_read_b128 a[52:55], v3 offset:12288
v_mfma_f32_16x16x32_bf16 v[196:199], a[140:143], a[100:103], v[196:199]
v_mfma_f32_16x16x32_bf16 v[204:207], a[136:139], a[104:107], v[204:207]
ds_read_b128 a[56:59], v2 offset:14336
v_mfma_f32_16x16x32_bf16 v[204:207], a[140:143], a[108:111], v[204:207]
v_mfma_f32_16x16x32_bf16 v[212:215], a[136:139], a[112:115], v[212:215]
v_mfma_f32_16x16x32_bf16 v[212:215], a[140:143], a[116:119], v[212:215]
v_mfma_f32_16x16x32_bf16 v[220:223], a[136:139], a[120:123], v[220:223]
ds_read_b128 a[60:63], v3 offset:14336
v_mfma_f32_16x16x32_bf16 v[220:223], a[140:143], a[124:127], v[220:223]
s_waitcnt lgkmcnt(5)
v_mfma_f32_16x16x32_bf16 a[192:195], a[128:131], a[64:67], a[192:195]
s_waitcnt lgkmcnt(3)
ds_read_b64_tr_b16 a[136:137], v11 offset:32768
v_mfma_f32_16x16x32_bf16 a[192:195], a[132:135], a[68:71], a[192:195]
v_mfma_f32_16x16x32_bf16 a[200:203], a[128:131], a[72:75], a[200:203]
ds_read_b64_tr_b16 a[138:139], v11 offset:34816
v_mfma_f32_16x16x32_bf16 a[200:203], a[132:135], a[76:79], a[200:203]
v_mfma_f32_16x16x32_bf16 a[208:211], a[128:131], a[80:83], a[208:211]
ds_read_b64_tr_b16 a[140:141], v11 offset:49152
v_mfma_f32_16x16x32_bf16 a[208:211], a[132:135], a[84:87], a[208:211]
v_mfma_f32_16x16x32_bf16 a[216:219], a[128:131], a[88:91], a[216:219]
ds_read_b64_tr_b16 a[142:143], v11 offset:51200
v_mfma_f32_16x16x32_bf16 a[216:219], a[132:135], a[92:95], a[216:219]
v_mfma_f32_16x16x32_bf16 a[224:227], a[128:131], a[96:99], a[224:227]
v_mfma_f32_16x16x32_bf16 a[224:227], a[132:135], a[100:103], a[224:227]
v_mfma_f32_16x16x32_bf16 a[232:235], a[128:131], a[104:107], a[232:235]
v_mfma_f32_16x16x32_bf16 a[232:235], a[132:135], a[108:111], a[232:235]
v_mfma_f32_16x16x32_bf16 a[240:243], a[128:131], a[112:115], a[240:243]
v_mfma_f32_16x16x32_bf16 a[240:243], a[132:135], a[116:119], a[240:243]
v_mfma_f32_16x16x32_bf16 a[248:251], a[128:131], a[120:123], a[248:251]
v_mfma_f32_16x16x32_bf16 a[248:251], a[132:135], a[124:127], a[248:251]
s_waitcnt vmcnt(22) lgkmcnt(0)
s_barrier
v_mfma_f32_16x16x32_bf16 a[196:199], a[136:139], a[64:67], a[196:199]
s_add_u32 m0, s29, 98304
ds_read_b64_tr_b16 a[128:129], v4 offset:0
v_mfma_f32_16x16x32_bf16 a[196:199], a[140:143], a[68:71], a[196:199]
buffer_load_dwordx4 v16, s[12:15], s26 offen offset:0 lds
v_mfma_f32_16x16x32_bf16 a[204:207], a[136:139], a[72:75], a[204:207]
ds_read_b64_tr_b16 a[130:131], v4 offset:2048
v_mfma_f32_16x16x32_bf16 a[204:207], a[140:143], a[76:79], a[204:207]
v_mfma_f32_16x16x32_bf16 a[212:215], a[136:139], a[80:83], a[212:215]
ds_read_b64_tr_b16 a[132:133], v4 offset:16384
v_mfma_f32_16x16x32_bf16 a[212:215], a[140:143], a[84:87], a[212:215]
buffer_load_dwordx4 v17, s[12:15], s26 offen offset:1024 lds
v_mfma_f32_16x16x32_bf16 a[220:223], a[136:139], a[88:91], a[220:223]
ds_read_b64_tr_b16 a[134:135], v4 offset:18432
v_mfma_f32_16x16x32_bf16 a[220:223], a[140:143], a[92:95], a[220:223]
v_mfma_f32_16x16x32_bf16 a[228:231], a[136:139], a[96:99], a[228:231]
v_mfma_f32_16x16x32_bf16 a[228:231], a[140:143], a[100:103], a[228:231]
buffer_load_dwordx4 v18, s[12:15], s26 offen offset:2048 lds
v_mfma_f32_16x16x32_bf16 a[236:239], a[136:139], a[104:107], a[236:239]
v_mfma_f32_16x16x32_bf16 a[236:239], a[140:143], a[108:111], a[236:239]
v_mfma_f32_16x16x32_bf16 a[244:247], a[136:139], a[112:115], a[244:247]
v_mfma_f32_16x16x32_bf16 a[244:247], a[140:143], a[116:119], a[244:247]
buffer_load_dwordx4 v19, s[12:15], s26 offen offset:3072 lds
v_mfma_f32_16x16x32_bf16 a[252:255], a[136:139], a[120:123], a[252:255]
s_add_u32 s26, s26, 524288
v_mfma_f32_16x16x32_bf16 a[252:255], a[140:143], a[124:127], a[252:255]
s_waitcnt lgkmcnt(2)
v_mfma_f32_16x16x32_bf16 v[32:35], a[128:131], a[0:3], v[32:35]
s_waitcnt lgkmcnt(0)
s_add_u32 m0, s29, 114688
ds_read_b64_tr_b16 a[136:137], v5 offset:0
v_mfma_f32_16x16x32_bf16 v[32:35], a[132:135], a[4:7], v[32:35]
buffer_load_dwordx4 v16, s[12:15], s27 offen offset:0 lds
v_mfma_f32_16x16x32_bf16 v[40:43], a[128:131], a[8:11], v[40:43]
ds_read_b64_tr_b16 a[138:139], v5 offset:2048
v_mfma_f32_16x16x32_bf16 v[40:43], a[132:135], a[12:15], v[40:43]
v_mfma_f32_16x16x32_bf16 v[48:51], a[128:131], a[16:19], v[48:51]
ds_read_b64_tr_b16 a[140:141], v5 offset:16384
v_mfma_f32_16x16x32_bf16 v[48:51], a[132:135], a[20:23], v[48:51]
buffer_load_dwordx4 v17, s[12:15], s27 offen offset:1024 lds
v_mfma_f32_16x16x32_bf16 v[56:59], a[128:131], a[24:27], v[56:59]
ds_read_b64_tr_b16 a[142:143], v5 offset:18432
v_mfma_f32_16x16x32_bf16 v[56:59], a[132:135], a[28:31], v[56:59]
v_mfma_f32_16x16x32_bf16 v[64:67], a[128:131], a[32:35], v[64:67]
ds_read_b128 a[64:67], v2 offset:32768
v_mfma_f32_16x16x32_bf16 v[64:67], a[132:135], a[36:39], v[64:67]
buffer_load_dwordx4 v18, s[12:15], s27 offen offset:2048 lds
v_mfma_f32_16x16x32_bf16 v[72:75], a[128:131], a[40:43], v[72:75]
ds_read_b128 a[68:71], v3 offset:32768
v_mfma_f32_16x16x32_bf16 v[72:75], a[132:135], a[44:47], v[72:75]
v_mfma_f32_16x16x32_bf16 v[80:83], a[128:131], a[48:51], v[80:83]
v_mfma_f32_16x16x32_bf16 v[80:83], a[132:135], a[52:55], v[80:83]
buffer_load_dwordx4 v19, s[12:15], s27 offen offset:3072 lds
v_mfma_f32_16x16x32_bf16 v[88:91], a[128:131], a[56:59], v[88:91]
s_add_u32 s27, s27, 524288
ds_read_b128 a[72:75], v2 offset:34816
v_mfma_f32_16x16x32_bf16 v[88:91], a[132:135], a[60:63], v[88:91]
s_waitcnt lgkmcnt(5)
v_mfma_f32_16x16x32_bf16 v[36:39], a[136:139], a[0:3], v[36:39]
s_waitcnt lgkmcnt(3)
s_add_u32 m0, s28, 0
ds_read_b64_tr_b16 a[128:129], v6 offset:0
v_mfma_f32_16x16x32_bf16 v[36:39], a[140:143], a[4:7], v[36:39]
buffer_load_dwordx4 v12, s[8:11], s24 offen offset:0 lds
v_mfma_f32_16x16x32_bf16 v[44:47], a[136:139], a[8:11], v[44:47]
ds_read_b64_tr_b16 a[130:131], v6 offset:2048
v_mfma_f32_16x16x32_bf16 v[44:47], a[140:143], a[12:15], v[44:47]
v_mfma_f32_16x16x32_bf16 v[52:55], a[136:139], a[16:19], v[52:55]
ds_read_b64_tr_b16 a[132:133], v6 offset:16384
v_mfma_f32_16x16x32_bf16 v[52:55], a[140:143], a[20:23], v[52:55]
buffer_load_dwordx4 v13, s[8:11], s24 offen offset:1024 lds
v_mfma_f32_16x16x32_bf16 v[60:63], a[136:139], a[24:27], v[60:63]
ds_read_b64_tr_b16 a[134:135], v6 offset:18432
v_mfma_f32_16x16x32_bf16 v[60:63], a[140:143], a[28:31], v[60:63]
v_mfma_f32_16x16x32_bf16 v[68:71], a[136:139], a[32:35], v[68:71]
ds_read_b128 a[76:79], v3 offset:34816
v_mfma_f32_16x16x32_bf16 v[68:71], a[140:143], a[36:39], v[68:71]
buffer_load_dwordx4 v14, s[8:11], s24 offen offset:2048 lds
v_mfma_f32_16x16x32_bf16 v[76:79], a[136:139], a[40:43], v[76:79]
v_mfma_f32_16x16x32_bf16 v[76:79], a[140:143], a[44:47], v[76:79]
v_mfma_f32_16x16x32_bf16 v[84:87], a[136:139], a[48:51], v[84:87]
ds_read_b128 a[80:83], v2 offset:36864
v_mfma_f32_16x16x32_bf16 v[84:87], a[140:143], a[52:55], v[84:87]
buffer_load_dwordx4 v15, s[8:11], s24 offen offset:3072 lds
v_mfma_f32_16x16x32_bf16 v[92:95], a[136:139], a[56:59], v[92:95]
s_add_u32 s24, s24, 128
ds_read_b128 a[84:87], v3 offset:36864
v_mfma_f32_16x16x32_bf16 v[92:95], a[140:143], a[60:63], v[92:95]
s_waitcnt lgkmcnt(5)
v_mfma_f32_16x16x32_bf16 v[96:99], a[128:131], a[0:3], v[96:99]
s_waitcnt lgkmcnt(3)
s_add_u32 m0, s28, 4096
ds_read_b64_tr_b16 a[136:137], v7 offset:0
v_mfma_f32_16x16x32_bf16 v[96:99], a[132:135], a[4:7], v[96:99]
buffer_load_dwordx4 v12, s[8:11], s25 offen offset:0 lds
v_mfma_f32_16x16x32_bf16 v[104:107], a[128:131], a[8:11], v[104:107]
ds_read_b64_tr_b16 a[138:139], v7 offset:2048
v_mfma_f32_16x16x32_bf16 v[104:107], a[132:135], a[12:15], v[104:107]
v_mfma_f32_16x16x32_bf16 v[112:115], a[128:131], a[16:19], v[112:115]
ds_read_b64_tr_b16 a[140:141], v7 offset:16384
v_mfma_f32_16x16x32_bf16 v[112:115], a[132:135], a[20:23], v[112:115]
buffer_load_dwordx4 v13, s[8:11], s25 offen offset:1024 lds
v_mfma_f32_16x16x32_bf16 v[120:123], a[128:131], a[24:27], v[120:123]
ds_read_b64_tr_b16 a[142:143], v7 offset:18432
v_mfma_f32_16x16x32_bf16 v[120:123], a[132:135], a[28:31], v[120:123]
v_mfma_f32_16x16x32_bf16 v[128:131], a[128:131], a[32:35], v[128:131]
v_mfma_f32_16x16x32_bf16 v[128:131], a[132:135], a[36:39], v[128:131]
buffer_load_dwordx4 v14, s[8:11], s25 offen offset:2048 lds
v_mfma_f32_16x16x32_bf16 v[136:139], a[128:131], a[40:43], v[136:139]
ds_read_b128 a[88:91], v2 offset:38912
v_mfma_f32_16x16x32_bf16 v[136:139], a[132:135], a[44:47], v[136:139]
v_mfma_f32_16x16x32_bf16 v[144:147], a[128:131], a[48:51], v[144:147]
ds_read_b128 a[92:95], v3 offset:38912
v_mfma_f32_16x16x32_bf16 v[144:147], a[132:135], a[52:55], v[144:147]
buffer_load_dwordx4 v15, s[8:11], s25 offen offset:3072 lds
v_mfma_f32_16x16x32_bf16 v[152:155], a[128:131], a[56:59], v[152:155]
s_add_u32 s25, s25, 128
v_mfma_f32_16x16x32_bf16 v[152:155], a[132:135], a[60:63], v[152:155]
s_waitcnt lgkmcnt(4)
v_mfma_f32_16x16x32_bf16 v[100:103], a[136:139], a[0:3], v[100:103]
s_waitcnt lgkmcnt(2)
ds_read_b64_tr_b16 a[128:129], v8 offset:0
v_mfma_f32_16x16x32_bf16 v[100:103], a[140:143], a[4:7], v[100:103]
buffer_load_dword v21, v20, s[16:19], s43 offen
v_mfma_f32_16x16x32_bf16 v[108:111], a[136:139], a[8:11], v[108:111]
s_add_u32 s43, s43, s47
ds_read_b64_tr_b16 a[130:131], v8 offset:2048
v_mfma_f32_16x16x32_bf16 v[108:111], a[140:143], a[12:15], v[108:111]
s_cmp_ge_u32 s43, s51
v_mfma_f32_16x16x32_bf16 v[116:119], a[136:139], a[16:19], v[116:119]
s_cselect_b32 s43, 0, s43
ds_read_b64_tr_b16 a[132:133], v8 offset:16384
v_mfma_f32_16x16x32_bf16 v[116:119], a[140:143], a[20:23], v[116:119]
s_cselect_b32 s51, s42, s51
v_mfma_f32_16x16x32_bf16 v[124:127], a[136:139], a[24:27], v[124:127]
s_cselect_b64 s[16:17], s[40:41], s[16:17]
ds_read_b64_tr_b16 a[134:135], v8 offset:18432
v_mfma_f32_16x16x32_bf16 v[124:127], a[140:143], a[28:31], v[124:127]
s_cselect_b32 s18, s42, s18
v_mfma_f32_16x16x32_bf16 v[132:135], a[136:139], a[32:35], v[132:135]
s_cselect_b64 s[40:41], s[44:45], s[40:41]
ds_read_b128 a[96:99], v2 offset:40960
v_mfma_f32_16x16x32_bf16 v[132:135], a[140:143], a[36:39], v[132:135]
s_cselect_b32 s42, s46, s42
v_mfma_f32_16x16x32_bf16 v[140:143], a[136:139], a[40:43], v[140:143]
s_cselect_b32 s46, 0, s46
v_mfma_f32_16x16x32_bf16 v[140:143], a[140:143], a[44:47], v[140:143]
s_lshl_b32 s59, s39, 5
v_mfma_f32_16x16x32_bf16 v[148:151], a[136:139], a[48:51], v[148:151]
s_add_u32 s59, s59, s38
ds_read_b128 a[100:103], v3 offset:40960
v_mfma_f32_16x16x32_bf16 v[148:151], a[140:143], a[52:55], v[148:151]
s_lshl_b32 s59, s59, 2
v_mfma_f32_16x16x32_bf16 v[156:159], a[136:139], a[56:59], v[156:159]
s_add_u32 s59, s59, 94392320
ds_read_b128 a[104:107], v2 offset:43008
v_mfma_f32_16x16x32_bf16 v[156:159], a[140:143], a[60:63], v[156:159]
s_waitcnt lgkmcnt(5)
s_cmp_lt_u32 s2, 224
v_mfma_f32_16x16x32_bf16 v[160:163], a[128:131], a[0:3], v[160:163]
s_waitcnt lgkmcnt(3)
s_cselect_b32 s59, s59, 3221225472
ds_read_b64_tr_b16 a[136:137], v9 offset:0
v_mfma_f32_16x16x32_bf16 v[160:163], a[132:135], a[4:7], v[160:163]
s_mov_b32 s58, 0xffff0000
v_mfma_f32_16x16x32_bf16 v[168:171], a[128:131], a[8:11], v[168:171]
ds_read_b64_tr_b16 a[138:139], v9 offset:2048
v_mfma_f32_16x16x32_bf16 v[168:171], a[132:135], a[12:15], v[168:171]
buffer_load_dword v21, v20, s[16:19], s43 offen
v_mfma_f32_16x16x32_bf16 v[176:179], a[128:131], a[16:19], v[176:179]
s_add_u32 s43, s43, s47
ds_read_b64_tr_b16 a[140:141], v9 offset:16384
v_mfma_f32_16x16x32_bf16 v[176:179], a[132:135], a[20:23], v[176:179]
s_cmp_ge_u32 s43, s51
v_mfma_f32_16x16x32_bf16 v[184:187], a[128:131], a[24:27], v[184:187]
s_cselect_b32 s43, 0, s43
ds_read_b64_tr_b16 a[142:143], v9 offset:18432
v_mfma_f32_16x16x32_bf16 v[184:187], a[132:135], a[28:31], v[184:187]
s_cselect_b32 s51, s42, s51
v_mfma_f32_16x16x32_bf16 v[192:195], a[128:131], a[32:35], v[192:195]
s_cselect_b64 s[16:17], s[40:41], s[16:17]
v_mfma_f32_16x16x32_bf16 v[192:195], a[132:135], a[36:39], v[192:195]
s_cselect_b32 s18, s42, s18
v_mfma_f32_16x16x32_bf16 v[200:203], a[128:131], a[40:43], v[200:203]
s_cselect_b64 s[40:41], s[44:45], s[40:41]
ds_read_b128 a[108:111], v3 offset:43008
v_mfma_f32_16x16x32_bf16 v[200:203], a[132:135], a[44:47], v[200:203]
s_cselect_b32 s42, s46, s42
v_mfma_f32_16x16x32_bf16 v[208:211], a[128:131], a[48:51], v[208:211]
s_cselect_b32 s46, 0, s46
ds_read_b128 a[112:115], v2 offset:45056
v_mfma_f32_16x16x32_bf16 v[208:211], a[132:135], a[52:55], v[208:211]
v_mfma_f32_16x16x32_bf16 v[216:219], a[128:131], a[56:59], v[216:219]
v_mfma_f32_16x16x32_bf16 v[216:219], a[132:135], a[60:63], v[216:219]
s_waitcnt lgkmcnt(4)
v_mfma_f32_16x16x32_bf16 v[164:167], a[136:139], a[0:3], v[164:167]
s_waitcnt lgkmcnt(2)
ds_read_b64_tr_b16 a[128:129], v10 offset:0
v_mfma_f32_16x16x32_bf16 v[164:167], a[140:143], a[4:7], v[164:167]
v_mfma_f32_16x16x32_bf16 v[172:175], a[136:139], a[8:11], v[172:175]
ds_read_b64_tr_b16 a[130:131], v10 offset:2048
v_mfma_f32_16x16x32_bf16 v[172:175], a[140:143], a[12:15], v[172:175]
v_mfma_f32_16x16x32_bf16 v[180:183], a[136:139], a[16:19], v[180:183]
ds_read_b64_tr_b16 a[132:133], v10 offset:16384
v_mfma_f32_16x16x32_bf16 v[180:183], a[140:143], a[20:23], v[180:183]
v_mfma_f32_16x16x32_bf16 v[188:191], a[136:139], a[24:27], v[188:191]
ds_read_b64_tr_b16 a[134:135], v10 offset:18432
v_mfma_f32_16x16x32_bf16 v[188:191], a[140:143], a[28:31], v[188:191]
v_mfma_f32_16x16x32_bf16 v[196:199], a[136:139], a[32:35], v[196:199]
ds_read_b128 a[116:119], v3 offset:45056
v_mfma_f32_16x16x32_bf16 v[196:199], a[140:143], a[36:39], v[196:199]
v_mfma_f32_16x16x32_bf16 v[204:207], a[136:139], a[40:43], v[204:207]
ds_read_b128 a[120:123], v2 offset:47104
v_and_b32 v252, 31, v0
v_mfma_f32_16x16x32_bf16 v[204:207], a[140:143], a[44:47], v[204:207]
v_lshrrev_b32 v253, 5, v0
v_xor_b32 v253, v253, v252
v_mfma_f32_16x16x32_bf16 v[212:215], a[136:139], a[48:51], v[212:215]
v_and_b32 v253, 7, v253
v_lshlrev_b32 v252, 8, v252
v_mfma_f32_16x16x32_bf16 v[212:215], a[140:143], a[52:55], v[212:215]
v_lshl_add_u32 v252, v253, 4, v252
v_add_u32 v252, 147456, v252
v_mfma_f32_16x16x32_bf16 v[220:223], a[136:139], a[56:59], v[220:223]
ds_read_b128 a[124:127], v3 offset:47104
v_mfma_f32_16x16x32_bf16 v[220:223], a[140:143], a[60:63], v[220:223]
s_waitcnt lgkmcnt(5)
v_mfma_f32_16x16x32_bf16 a[192:195], a[128:131], a[0:3], a[192:195]
s_waitcnt lgkmcnt(3)
ds_read_b64_tr_b16 a[136:137], v11 offset:0
v_mfma_f32_16x16x32_bf16 a[192:195], a[132:135], a[4:7], a[192:195]
v_mfma_f32_16x16x32_bf16 a[200:203], a[128:131], a[8:11], a[200:203]
ds_read_b64_tr_b16 a[138:139], v11 offset:2048
v_mfma_f32_16x16x32_bf16 a[200:203], a[132:135], a[12:15], a[200:203]
v_mfma_f32_16x16x32_bf16 a[208:211], a[128:131], a[16:19], a[208:211]
ds_read_b64_tr_b16 a[140:141], v11 offset:16384
v_mfma_f32_16x16x32_bf16 a[208:211], a[132:135], a[20:23], a[208:211]
v_mfma_f32_16x16x32_bf16 a[216:219], a[128:131], a[24:27], a[216:219]
ds_read_b64_tr_b16 a[142:143], v11 offset:18432
v_mfma_f32_16x16x32_bf16 a[216:219], a[132:135], a[28:31], a[216:219]
v_mfma_f32_16x16x32_bf16 a[224:227], a[128:131], a[32:35], a[224:227]
v_mfma_f32_16x16x32_bf16 a[224:227], a[132:135], a[36:39], a[224:227]
v_mfma_f32_16x16x32_bf16 a[232:235], a[128:131], a[40:43], a[232:235]
v_mfma_f32_16x16x32_bf16 a[232:235], a[132:135], a[44:47], a[232:235]
v_mfma_f32_16x16x32_bf16 a[240:243], a[128:131], a[48:51], a[240:243]
v_mfma_f32_16x16x32_bf16 a[240:243], a[132:135], a[52:55], a[240:243]
v_mfma_f32_16x16x32_bf16 a[248:251], a[128:131], a[56:59], a[248:251]
v_mfma_f32_16x16x32_bf16 a[248:251], a[132:135], a[60:63], a[248:251]
s_waitcnt vmcnt(2) lgkmcnt(0)
s_barrier
v_mfma_f32_16x16x32_bf16 a[196:199], a[136:139], a[0:3], a[196:199]
s_add_u32 m0, s29, 65536
ds_read_b64_tr_b16 a[128:129], v4 offset:32768
v_lshlrev_b32 v28, 16, v248
v_mfma_f32_16x16x32_bf16 a[196:199], a[140:143], a[4:7], a[196:199]
buffer_load_dwordx4 v16, s[12:15], s26 offen offset:0 lds
v_mfma_f32_16x16x32_bf16 a[204:207], a[136:139], a[8:11], a[204:207]
ds_read_b64_tr_b16 a[130:131], v4 offset:34816
v_and_b32 v29, s58, v248
v_mfma_f32_16x16x32_bf16 a[204:207], a[140:143], a[12:15], a[204:207]
v_lshlrev_b32 v30, 16, v249
v_and_b32 v253, s58, v249
v_mfma_f32_16x16x32_bf16 a[212:215], a[136:139], a[16:19], a[212:215]
ds_read_b64_tr_b16 a[132:133], v4 offset:49152
v_lshlrev_b32 v22, 16, v224
v_mfma_f32_16x16x32_bf16 a[212:215], a[140:143], a[20:23], a[212:215]
buffer_load_dwordx4 v17, s[12:15], s26 offen offset:1024 lds
v_mfma_f32_16x16x32_bf16 a[220:223], a[136:139], a[24:27], a[220:223]
ds_read_b64_tr_b16 a[134:135], v4 offset:51200
v_lshlrev_b32 v23, 16, v225
v_mfma_f32_16x16x32_bf16 a[220:223], a[140:143], a[28:31], a[220:223]
v_lshlrev_b32 v24, 16, v226
v_mul_f32 v254, v22, v253
v_mfma_f32_16x16x32_bf16 a[228:231], a[136:139], a[32:35], a[228:231]
v_lshlrev_b32 v25, 16, v227
v_lshlrev_b32 v247, 16, v236
v_mfma_f32_16x16x32_bf16 a[228:231], a[140:143], a[36:39], a[228:231]
buffer_load_dwordx4 v18, s[12:15], s26 offen offset:2048 lds
v_mfma_f32_16x16x32_bf16 a[236:239], a[136:139], a[40:43], a[236:239]
v_fmac_f32 v254, v23, v30
v_fmac_f32 v254, v24, v29
v_mfma_f32_16x16x32_bf16 a[236:239], a[140:143], a[44:47], a[236:239]
v_fmac_f32 v254, v25, v28
v_mul_f32 v254, v254, v247
v_mfma_f32_16x16x32_bf16 a[244:247], a[136:139], a[48:51], a[244:247]
v_mul_f32 v255, v23, v253
v_lshlrev_b32 v22, 16, v228
v_mfma_f32_16x16x32_bf16 a[244:247], a[140:143], a[52:55], a[244:247]
buffer_load_dwordx4 v19, s[12:15], s26 offen offset:3072 lds
v_mfma_f32_16x16x32_bf16 a[252:255], a[136:139], a[56:59], a[252:255]
s_add_u32 s26, s26, 524288
v_lshlrev_b32 v247, 16, v237
v_fmac_f32 v255, v24, v30
v_mfma_f32_16x16x32_bf16 a[252:255], a[140:143], a[60:63], a[252:255]
s_waitcnt lgkmcnt(0)
v_fmac_f32 v255, v25, v29
v_fmac_f32 v255, v22, v28
v_mfma_f32_16x16x32_bf16 v[32:35], a[128:131], a[64:67], v[32:35]
s_add_u32 m0, s29, 81920
ds_read_b64_tr_b16 a[136:137], v5 offset:32768
v_mul_f32 v255, v255, v247
v_mfma_f32_16x16x32_bf16 v[32:35], a[132:135], a[68:71], v[32:35]
buffer_load_dwordx4 v16, s[12:15], s27 offen offset:0 lds
v_mfma_f32_16x16x32_bf16 v[40:43], a[128:131], a[72:75], v[40:43]
ds_read_b64_tr_b16 a[138:139], v5 offset:34816
v_cvt_pk_bf16_f32 v246, v254, v255
v_mfma_f32_16x16x32_bf16 v[40:43], a[132:135], a[76:79], v[40:43]
v_accvgpr_write_b32 a180, v246
v_mul_f32 v254, v24, v253
v_mfma_f32_16x16x32_bf16 v[48:51], a[128:131], a[80:83], v[48:51]
ds_read_b64_tr_b16 a[140:141], v5 offset:49152
v_lshlrev_b32 v23, 16, v229
v_mfma_f32_16x16x32_bf16 v[48:51], a[132:135], a[84:87], v[48:51]
buffer_load_dwordx4 v17, s[12:15], s27 offen offset:1024 lds
v_lshlrev_b32 v247, 16, v238
v_mfma_f32_16x16x32_bf16 v[56:59], a[128:131], a[88:91], v[56:59]
ds_read_b64_tr_b16 a[142:143], v5 offset:51200
v_fmac_f32 v254, v25, v30
v_mfma_f32_16x16x32_bf16 v[56:59], a[132:135], a[92:95], v[56:59]
v_fmac_f32 v254, v22, v29
v_fmac_f32 v254, v23, v28
v_mfma_f32_16x16x32_bf16 v[64:67], a[128:131], a[96:99], v[64:67]
ds_read_b128 a[0:3], v2 offset:0
v_mul_f32 v254, v254, v247
v_mfma_f32_16x16x32_bf16 v[64:67], a[132:135], a[100:103], v[64:67]
buffer_load_dwordx4 v18, s[12:15], s27 offen offset:2048 lds
v_mfma_f32_16x16x32_bf16 v[72:75], a[128:131], a[104:107], v[72:75]
ds_read_b128 a[4:7], v3 offset:0
v_cvt_pk_bf16_f32 v246, v255, v254
v_accvgpr_write_b32 a176, v246
v_mfma_f32_16x16x32_bf16 v[72:75], a[132:135], a[108:111], v[72:75]
v_mul_f32 v255, v25, v253
v_lshlrev_b32 v24, 16, v230
v_mfma_f32_16x16x32_bf16 v[80:83], a[128:131], a[112:115], v[80:83]
v_lshlrev_b32 v247, 16, v239
v_fmac_f32 v255, v22, v30
v_mfma_f32_16x16x32_bf16 v[80:83], a[132:135], a[116:119], v[80:83]
buffer_load_dwordx4 v19, s[12:15], s27 offen offset:3072 lds
v_mfma_f32_16x16x32_bf16 v[88:91], a[128:131], a[120:123], v[88:91]
s_add_u32 s27, s27, 524288
ds_read_b128 a[8:11], v2 offset:2048
v_fmac_f32 v255, v23, v29
v_mfma_f32_16x16x32_bf16 v[88:91], a[132:135], a[124:127], v[88:91]
s_waitcnt lgkmcnt(3)
v_fmac_f32 v255, v24, v28
v_mul_f32 v255, v255, v247
v_mfma_f32_16x16x32_bf16 v[36:39], a[136:139], a[64:67], v[36:39]
s_add_u32 m0, s28, 32768
ds_read_b64_tr_b16 a[128:129], v6 offset:32768
v_cvt_pk_bf16_f32 v246, v254, v255
v_accvgpr_write_b32 a181, v246
v_mfma_f32_16x16x32_bf16 v[36:39], a[140:143], a[68:71], v[36:39]
buffer_load_dwordx4 v12, s[8:11], s24 offen offset:0 lds
v_mfma_f32_16x16x32_bf16 v[44:47], a[136:139], a[72:75], v[44:47]
ds_read_b64_tr_b16 a[130:131], v6 offset:34816
v_mul_f32 v254, v22, v253
v_mfma_f32_16x16x32_bf16 v[44:47], a[140:143], a[76:79], v[44:47]
v_lshlrev_b32 v25, 16, v231
v_lshlrev_b32 v247, 16, v240
v_mfma_f32_16x16x32_bf16 v[52:55], a[136:139], a[80:83], v[52:55]
ds_read_b64_tr_b16 a[132:133], v6 offset:49152
v_fmac_f32 v254, v23, v30
v_mfma_f32_16x16x32_bf16 v[52:55], a[140:143], a[84:87], v[52:55]
buffer_load_dwordx4 v13, s[8:11], s24 offen offset:1024 lds
v_fmac_f32 v254, v24, v29
v_mfma_f32_16x16x32_bf16 v[60:63], a[136:139], a[88:91], v[60:63]
ds_read_b64_tr_b16 a[134:135], v6 offset:51200
v_fmac_f32 v254, v25, v28
v_mfma_f32_16x16x32_bf16 v[60:63], a[140:143], a[92:95], v[60:63]
v_mul_f32 v254, v254, v247
v_cvt_pk_bf16_f32 v246, v255, v254
v_mfma_f32_16x16x32_bf16 v[68:71], a[136:139], a[96:99], v[68:71]
ds_read_b128 a[12:15], v3 offset:2048
v_accvgpr_write_b32 a177, v246
v_mfma_f32_16x16x32_bf16 v[68:71], a[140:143], a[100:103], v[68:71]
buffer_load_dwordx4 v14, s[8:11], s24 offen offset:2048 lds
v_mfma_f32_16x16x32_bf16 v[76:79], a[136:139], a[104:107], v[76:79]
v_mul_f32 v255, v23, v253
v_lshlrev_b32 v22, 16, v232
v_lshlrev_b32 v247, 16, v241
v_mfma_f32_16x16x32_bf16 v[76:79], a[140:143], a[108:111], v[76:79]
v_fmac_f32 v255, v24, v30
v_fmac_f32 v255, v25, v29
v_mfma_f32_16x16x32_bf16 v[84:87], a[136:139], a[112:115], v[84:87]
ds_read_b128 a[16:19], v2 offset:4096
v_fmac_f32 v255, v22, v28
v_mfma_f32_16x16x32_bf16 v[84:87], a[140:143], a[116:119], v[84:87]
buffer_load_dwordx4 v15, s[8:11], s24 offen offset:3072 lds
v_mfma_f32_16x16x32_bf16 v[92:95], a[136:139], a[120:123], v[92:95]
s_add_u32 s24, s24, 128
ds_read_b128 a[20:23], v3 offset:4096
v_mul_f32 v255, v255, v247
v_mfma_f32_16x16x32_bf16 v[92:95], a[140:143], a[124:127], v[92:95]
s_waitcnt lgkmcnt(3)
v_cvt_pk_bf16_f32 v246, v254, v255
v_accvgpr_write_b32 a182, v246
v_mfma_f32_16x16x32_bf16 v[96:99], a[128:131], a[64:67], v[96:99]
s_add_u32 m0, s28, 36864
ds_read_b64_tr_b16 a[136:137], v7 offset:32768
v_mul_f32 v254, v24, v253
v_lshlrev_b32 v23, 16, v233
v_mfma_f32_16x16x32_bf16 v[96:99], a[132:135], a[68:71], v[96:99]
buffer_load_dwordx4 v12, s[8:11], s25 offen offset:0 lds
v_mfma_f32_16x16x32_bf16 v[104:107], a[128:131], a[72:75], v[104:107]
ds_read_b64_tr_b16 a[138:139], v7 offset:34816
v_lshlrev_b32 v247, 16, v242
v_mfma_f32_16x16x32_bf16 v[104:107], a[132:135], a[76:79], v[104:107]
v_fmac_f32 v254, v25, v30
v_fmac_f32 v254, v22, v29
v_mfma_f32_16x16x32_bf16 v[112:115], a[128:131], a[80:83], v[112:115]
ds_read_b64_tr_b16 a[140:141], v7 offset:49152
v_fmac_f32 v254, v23, v28
v_mfma_f32_16x16x32_bf16 v[112:115], a[132:135], a[84:87], v[112:115]
buffer_load_dwordx4 v13, s[8:11], s25 offen offset:1024 lds
v_mul_f32 v254, v254, v247
v_mfma_f32_16x16x32_bf16 v[120:123], a[128:131], a[88:91], v[120:123]
ds_read_b64_tr_b16 a[142:143], v7 offset:51200
v_cvt_pk_bf16_f32 v246, v255, v254
v_mfma_f32_16x16x32_bf16 v[120:123], a[132:135], a[92:95], v[120:123]
v_accvgpr_write_b32 a178, v246
v_mul_f32 v255, v25, v253
v_mfma_f32_16x16x32_bf16 v[128:131], a[128:131], a[96:99], v[128:131]
v_lshlrev_b32 v24, 16, v234
v_lshlrev_b32 v247, 16, v243
v_mfma_f32_16x16x32_bf16 v[128:131], a[132:135], a[100:103], v[128:131]
buffer_load_dwordx4 v14, s[8:11], s25 offen offset:2048 lds
v_mfma_f32_16x16x32_bf16 v[136:139], a[128:131], a[104:107], v[136:139]
ds_read_b128 a[24:27], v2 offset:6144
v_fmac_f32 v255, v22, v30
v_fmac_f32 v255, v23, v29
v_mfma_f32_16x16x32_bf16 v[136:139], a[132:135], a[108:111], v[136:139]
v_fmac_f32 v255, v24, v28
v_mul_f32 v255, v255, v247
v_mfma_f32_16x16x32_bf16 v[144:147], a[128:131], a[112:115], v[144:147]
ds_read_b128 a[28:31], v3 offset:6144
v_cvt_pk_bf16_f32 v246, v254, v255
v_mfma_f32_16x16x32_bf16 v[144:147], a[132:135], a[116:119], v[144:147]
buffer_load_dwordx4 v15, s[8:11], s25 offen offset:3072 lds
v_mfma_f32_16x16x32_bf16 v[152:155], a[128:131], a[120:123], v[152:155]
s_add_u32 s25, s25, 128
v_accvgpr_write_b32 a183, v246
v_mul_f32 v254, v22, v253
v_mfma_f32_16x16x32_bf16 v[152:155], a[132:135], a[124:127], v[152:155]
s_waitcnt lgkmcnt(4)
v_lshlrev_b32 v25, 16, v235
v_lshlrev_b32 v247, 16, v244
v_mfma_f32_16x16x32_bf16 v[100:103], a[136:139], a[64:67], v[100:103]
s_waitcnt lgkmcnt(2)
ds_read_b64_tr_b16 a[128:129], v8 offset:32768
v_fmac_f32 v254, v23, v30
v_fmac_f32 v254, v24, v29
v_mfma_f32_16x16x32_bf16 v[100:103], a[140:143], a[68:71], v[100:103]
buffer_load_dword v21, v20, s[16:19], s43 offen
v_mfma_f32_16x16x32_bf16 v[108:111], a[136:139], a[72:75], v[108:111]
s_add_u32 s43, s43, s47
ds_read_b64_tr_b16 a[130:131], v8 offset:34816
v_fmac_f32 v254, v25, v28
v_mfma_f32_16x16x32_bf16 v[108:111], a[140:143], a[76:79], v[108:111]
s_cmp_ge_u32 s43, s51
v_mul_f32 v254, v254, v247
v_cvt_pk_bf16_f32 v246, v255, v254
v_mfma_f32_16x16x32_bf16 v[116:119], a[136:139], a[80:83], v[116:119]
s_cselect_b32 s43, 0, s43
ds_read_b64_tr_b16 a[132:133], v8 offset:49152
v_accvgpr_write_b32 a179, v246
v_mfma_f32_16x16x32_bf16 v[116:119], a[140:143], a[84:87], v[116:119]
s_cselect_b32 s51, s42, s51
v_lshlrev_b32 v28, 16, v250
v_and_b32 v29, s58, v250
v_lshlrev_b32 v30, 16, v251
v_mfma_f32_16x16x32_bf16 v[124:127], a[136:139], a[88:91], v[124:127]
s_cselect_b64 s[16:17], s[40:41], s[16:17]
ds_read_b64_tr_b16 a[134:135], v8 offset:51200
v_and_b32 v253, s58, v251
v_mfma_f32_16x16x32_bf16 v[124:127], a[140:143], a[92:95], v[124:127]
s_cselect_b32 s18, s42, s18
v_and_b32 v22, s58, v224
v_and_b32 v23, s58, v225
v_mfma_f32_16x16x32_bf16 v[132:135], a[136:139], a[96:99], v[132:135]
s_cselect_b64 s[40:41], s[44:45], s[40:41]
ds_read_b128 a[32:35], v2 offset:8192
v_and_b32 v24, s58, v226
v_mfma_f32_16x16x32_bf16 v[132:135], a[140:143], a[100:103], v[132:135]
s_cselect_b32 s42, s46, s42
v_mul_f32 v254, v22, v253
v_and_b32 v25, s58, v227
v_mfma_f32_16x16x32_bf16 v[140:143], a[136:139], a[104:107], v[140:143]
s_cselect_b32 s46, 0, s46
v_and_b32 v247, s58, v236
v_fmac_f32 v254, v23, v30
v_mfma_f32_16x16x32_bf16 v[140:143], a[140:143], a[108:111], v[140:143]
buffer_load_dword v245, off, s[60:63], 0 sc1
v_fmac_f32 v254, v24, v29
v_mfma_f32_16x16x32_bf16 v[148:151], a[136:139], a[112:115], v[148:151]
ds_read_b128 a[36:39], v3 offset:8192
v_fmac_f32 v254, v25, v28
v_mfma_f32_16x16x32_bf16 v[148:151], a[140:143], a[116:119], v[148:151]
v_mul_f32 v254, v254, v247
v_mul_f32 v255, v23, v253
v_mfma_f32_16x16x32_bf16 v[156:159], a[136:139], a[120:123], v[156:159]
ds_read_b128 a[40:43], v2 offset:10240
v_and_b32 v22, s58, v228
v_mfma_f32_16x16x32_bf16 v[156:159], a[140:143], a[124:127], v[156:159]
s_waitcnt lgkmcnt(5)
v_and_b32 v247, s58, v237
v_fmac_f32 v255, v24, v30
v_mfma_f32_16x16x32_bf16 v[160:163], a[128:131], a[64:67], v[160:163]
s_waitcnt lgkmcnt(3)
ds_read_b64_tr_b16 a[136:137], v9 offset:32768
v_fmac_f32 v255, v25, v29
v_fmac_f32 v255, v22, v28
v_mfma_f32_16x16x32_bf16 v[160:163], a[132:135], a[68:71], v[160:163]
v_mul_f32 v255, v255, v247
v_cvt_pk_bf16_f32 v246, v254, v255
v_mfma_f32_16x16x32_bf16 v[168:171], a[128:131], a[72:75], v[168:171]
ds_read_b64_tr_b16 a[138:139], v9 offset:34816
v_accvgpr_write_b32 a188, v246
v_mfma_f32_16x16x32_bf16 v[168:171], a[132:135], a[76:79], v[168:171]
v_mul_f32 v254, v24, v253
v_and_b32 v23, s58, v229
v_mfma_f32_16x16x32_bf16 v[176:179], a[128:131], a[80:83], v[176:179]
ds_read_b64_tr_b16 a[140:141], v9 offset:49152
v_and_b32 v247, s58, v238
v_mfma_f32_16x16x32_bf16 v[176:179], a[132:135], a[84:87], v[176:179]
v_fmac_f32 v254, v25, v30
v_fmac_f32 v254, v22, v29
v_fmac_f32 v254, v23, v28
v_mfma_f32_16x16x32_bf16 v[184:187], a[128:131], a[88:91], v[184:187]
ds_read_b64_tr_b16 a[142:143], v9 offset:51200
v_mul_f32 v254, v254, v247
v_mfma_f32_16x16x32_bf16 v[184:187], a[132:135], a[92:95], v[184:187]
v_cvt_pk_bf16_f32 v246, v255, v254
v_accvgpr_write_b32 a184, v246
v_mfma_f32_16x16x32_bf16 v[192:195], a[128:131], a[96:99], v[192:195]
v_mul_f32 v255, v25, v253
v_and_b32 v24, s58, v230
v_mfma_f32_16x16x32_bf16 v[192:195], a[132:135], a[100:103], v[192:195]
v_and_b32 v247, s58, v239
v_fmac_f32 v255, v22, v30
v_mfma_f32_16x16x32_bf16 v[200:203], a[128:131], a[104:107], v[200:203]
ds_read_b128 a[44:47], v3 offset:10240
v_fmac_f32 v255, v23, v29
v_mfma_f32_16x16x32_bf16 v[200:203], a[132:135], a[108:111], v[200:203]
v_fmac_f32 v255, v24, v28
v_mul_f32 v255, v255, v247
v_cvt_pk_bf16_f32 v246, v254, v255
v_mfma_f32_16x16x32_bf16 v[208:211], a[128:131], a[112:115], v[208:211]
ds_read_b128 a[48:51], v2 offset:12288
v_accvgpr_write_b32 a189, v246
v_mfma_f32_16x16x32_bf16 v[208:211], a[132:135], a[116:119], v[208:211]
v_mul_f32 v254, v22, v253
v_and_b32 v25, s58, v231
v_mfma_f32_16x16x32_bf16 v[216:219], a[128:131], a[120:123], v[216:219]
v_and_b32 v247, s58, v240
v_fmac_f32 v254, v23, v30
v_mfma_f32_16x16x32_bf16 v[216:219], a[132:135], a[124:127], v[216:219]
s_waitcnt lgkmcnt(4)
v_fmac_f32 v254, v24, v29
v_fmac_f32 v254, v25, v28
v_mfma_f32_16x16x32_bf16 v[164:167], a[136:139], a[64:67], v[164:167]
s_waitcnt lgkmcnt(2)
ds_read_b64_tr_b16 a[128:129], v10 offset:32768
v_mul_f32 v254, v254, v247
v_cvt_pk_bf16_f32 v246, v255, v254
v_mfma_f32_16x16x32_bf16 v[164:167], a[140:143], a[68:71], v[164:167]
v_accvgpr_write_b32 a185, v246
v_mul_f32 v255, v23, v253
v_mfma_f32_16x16x32_bf16 v[172:175], a[136:139], a[72:75], v[172:175]
ds_read_b64_tr_b16 a[130:131], v10 offset:34816
v_and_b32 v22, s58, v232
v_mfma_f32_16x16x32_bf16 v[172:175], a[140:143], a[76:79], v[172:175]
v_and_b32 v247, s58, v241
v_fmac_f32 v255, v24, v30
v_mfma_f32_16x16x32_bf16 v[180:183], a[136:139], a[80:83], v[180:183]
s_lshr_b32 s22, s3, 1
ds_read_b64_tr_b16 a[132:133], v10 offset:49152
v_fmac_f32 v255, v25, v29
v_mfma_f32_16x16x32_bf16 v[180:183], a[140:143], a[84:87], v[180:183]
s_mul_i32 s22, s22, 2097152
v_fmac_f32 v255, v22, v28
v_mul_f32 v255, v255, v247
v_cvt_pk_bf16_f32 v246, v254, v255
v_mfma_f32_16x16x32_bf16 v[188:191], a[136:139], a[88:91], v[188:191]
s_and_b32 s23, s3, 1
ds_read_b64_tr_b16 a[134:135], v10 offset:51200
v_accvgpr_write_b32 a190, v246
v_mfma_f32_16x16x32_bf16 v[188:191], a[140:143], a[92:95], v[188:191]
s_lshl_b32 s23, s23, 5
v_mul_f32 v254, v24, v253
v_and_b32 v23, s58, v233
v_mfma_f32_16x16x32_bf16 v[196:199], a[136:139], a[96:99], v[196:199]
s_lshl_b32 s56, s39, 6
ds_read_b128 a[52:55], v3 offset:12288
v_and_b32 v247, s58, v242
v_mfma_f32_16x16x32_bf16 v[196:199], a[140:143], a[100:103], v[196:199]
s_add_u32 s23, s23, s56
v_fmac_f32 v254, v25, v30
v_fmac_f32 v254, v22, v29
v_mfma_f32_16x16x32_bf16 v[204:207], a[136:139], a[104:107], v[204:207]
s_mul_i32 s23, s23, 4224
ds_read_b128 a[56:59], v2 offset:14336
v_fmac_f32 v254, v23, v28
v_mfma_f32_16x16x32_bf16 v[204:207], a[140:143], a[108:111], v[204:207]
s_add_u32 s22, s22, s23
v_mul_f32 v254, v254, v247
v_cvt_pk_bf16_f32 v246, v255, v254
v_accvgpr_write_b32 a186, v246
v_mfma_f32_16x16x32_bf16 v[212:215], a[136:139], a[112:115], v[212:215]
s_add_u32 s57, s22, 83886200
v_mul_f32 v255, v25, v253
v_and_b32 v24, s58, v234
v_mfma_f32_16x16x32_bf16 v[212:215], a[140:143], a[116:119], v[212:215]
s_lshl_b32 s23, s38, 7
v_and_b32 v247, s58, v243
v_fmac_f32 v255, v22, v30
v_mfma_f32_16x16x32_bf16 v[220:223], a[136:139], a[120:123], v[220:223]
s_add_u32 s22, s22, s23
ds_read_b128 a[60:63], v3 offset:14336
v_fmac_f32 v255, v23, v29
v_mfma_f32_16x16x32_bf16 v[220:223], a[140:143], a[124:127], v[220:223]
s_waitcnt lgkmcnt(3)
s_add_u32 s56, s22, 83886208
v_fmac_f32 v255, v24, v28
v_mul_f32 v255, v255, v247
v_mfma_f32_16x16x32_bf16 a[192:195], a[128:131], a[64:67], a[192:195]
s_cmp_lt_u32 s2, 224
ds_read_b64_tr_b16 a[136:137], v11 offset:32768
v_cvt_pk_bf16_f32 v246, v254, v255
v_accvgpr_write_b32 a191, v246
v_mfma_f32_16x16x32_bf16 a[192:195], a[132:135], a[68:71], a[192:195]
s_cselect_b32 s56, s56, 3221225472
v_mul_f32 v254, v22, v253
v_and_b32 v25, s58, v235
v_mfma_f32_16x16x32_bf16 a[200:203], a[128:131], a[72:75], a[200:203]
s_cmp_eq_u32 s38, 0
ds_read_b64_tr_b16 a[138:139], v11 offset:34816
v_and_b32 v247, s58, v244
v_mfma_f32_16x16x32_bf16 a[200:203], a[132:135], a[76:79], a[200:203]
s_cselect_b32 s57, s57, 3221225472
v_fmac_f32 v254, v23, v30
v_fmac_f32 v254, v24, v29
v_mfma_f32_16x16x32_bf16 a[208:211], a[128:131], a[80:83], a[208:211]
ds_read_b64_tr_b16 a[140:141], v11 offset:49152
v_fmac_f32 v254, v25, v28
v_mfma_f32_16x16x32_bf16 a[208:211], a[132:135], a[84:87], a[208:211]
v_mul_f32 v254, v254, v247
v_cvt_pk_bf16_f32 v246, v255, v254
v_accvgpr_write_b32 a187, v246
v_mfma_f32_16x16x32_bf16 a[216:219], a[128:131], a[88:91], a[216:219]
ds_read_b64_tr_b16 a[142:143], v11 offset:51200
v_mfma_f32_16x16x32_bf16 a[216:219], a[132:135], a[92:95], a[216:219]
ds_write_b128 v252, a[176:179] offset:0
v_mfma_f32_16x16x32_bf16 a[224:227], a[128:131], a[96:99], a[224:227]
v_mfma_f32_16x16x32_bf16 a[224:227], a[132:135], a[100:103], a[224:227]
ds_write_b128 v252, a[180:183] offset:8192
v_mfma_f32_16x16x32_bf16 a[232:235], a[128:131], a[104:107], a[232:235]
v_mfma_f32_16x16x32_bf16 a[232:235], a[132:135], a[108:111], a[232:235]
ds_write_b128 v252, a[184:187] offset:128
v_mfma_f32_16x16x32_bf16 a[240:243], a[128:131], a[112:115], a[240:243]
v_mfma_f32_16x16x32_bf16 a[240:243], a[132:135], a[116:119], a[240:243]
ds_write_b128 v252, a[188:191] offset:8320
v_mfma_f32_16x16x32_bf16 a[248:251], a[128:131], a[120:123], a[248:251]
v_mfma_f32_16x16x32_bf16 a[248:251], a[132:135], a[124:127], a[248:251]
s_waitcnt vmcnt(2) lgkmcnt(0)
s_barrier
v_mfma_f32_16x16x32_bf16 a[196:199], a[136:139], a[64:67], a[196:199]
s_add_u32 m0, s29, 98304
ds_read_b64_tr_b16 a[128:129], v4 offset:0
v_lshrrev_b32 v22, 8, v1
v_mfma_f32_16x16x32_bf16 a[196:199], a[140:143], a[68:71], a[196:199]
buffer_load_dwordx4 v16, s[12:15], s26 offen offset:0 lds
v_mfma_f32_16x16x32_bf16 a[204:207], a[136:139], a[72:75], a[204:207]
ds_read_b64_tr_b16 a[130:131], v4 offset:2048
v_lshlrev_b32 v22, 4, v22
v_mfma_f32_16x16x32_bf16 a[204:207], a[140:143], a[76:79], a[204:207]
v_xor_b32 v22, v22, v1
v_add_u32 v22, s29, v22
v_mfma_f32_16x16x32_bf16 a[212:215], a[136:139], a[80:83], a[212:215]
ds_read_b64_tr_b16 a[132:133], v4 offset:16384
v_add_u32 v22, 147456, v22
v_mfma_f32_16x16x32_bf16 a[212:215], a[140:143], a[84:87], a[212:215]
buffer_load_dwordx4 v17, s[12:15], s26 offen offset:1024 lds
v_mfma_f32_16x16x32_bf16 a[220:223], a[136:139], a[88:91], a[220:223]
ds_read_b64_tr_b16 a[134:135], v4 offset:18432
v_xor_b32 v23, 64, v22
v_mfma_f32_16x16x32_bf16 a[220:223], a[140:143], a[92:95], a[220:223]
v_lshrrev_b32 v224, 7, v1
v_mul_u32_u24 v224, 4224, v224
v_mfma_f32_16x16x32_bf16 a[228:231], a[136:139], a[96:99], a[228:231]
v_and_b32 v225, 0x70, v1
v_add_u32 v224, v224, v225
v_mfma_f32_16x16x32_bf16 a[228:231], a[140:143], a[100:103], a[228:231]
buffer_load_dwordx4 v18, s[12:15], s26 offen offset:2048 lds
v_mfma_f32_16x16x32_bf16 a[236:239], a[136:139], a[104:107], a[236:239]
v_bfe_u32 v225, v1, 4, 5
v_mul_u32_u24 v225, 4224, v225
v_mfma_f32_16x16x32_bf16 a[236:239], a[140:143], a[108:111], a[236:239]
v_mov_b32 v226, 0
v_mov_b32 v227, 0
v_mfma_f32_16x16x32_bf16 a[244:247], a[136:139], a[112:115], a[244:247]
v_mfma_f32_16x16x32_bf16 a[244:247], a[140:143], a[116:119], a[244:247]
buffer_load_dwordx4 v19, s[12:15], s26 offen offset:3072 lds
v_mfma_f32_16x16x32_bf16 a[252:255], a[136:139], a[120:123], a[252:255]
s_add_u32 s26, s26, 524288
v_mfma_f32_16x16x32_bf16 a[252:255], a[140:143], a[124:127], a[252:255]
s_waitcnt lgkmcnt(2)
v_mfma_f32_16x16x32_bf16 v[32:35], a[128:131], a[0:3], v[32:35]
s_waitcnt lgkmcnt(0)
s_add_u32 m0, s29, 114688
ds_read_b64_tr_b16 a[136:137], v5 offset:0
v_mfma_f32_16x16x32_bf16 v[32:35], a[132:135], a[4:7], v[32:35]
buffer_load_dwordx4 v16, s[12:15], s27 offen offset:0 lds
v_mfma_f32_16x16x32_bf16 v[40:43], a[128:131], a[8:11], v[40:43]
s_mul_i32 s52, s20, 7
ds_read_b64_tr_b16 a[138:139], v5 offset:2048
v_mfma_f32_16x16x32_bf16 v[40:43], a[132:135], a[12:15], v[40:43]
s_add_u32 s52, s52, s21
buffer_store_dwordx2 v[226:227], v225, s[4:7], s57 offen sc1
v_mfma_f32_16x16x32_bf16 v[48:51], a[128:131], a[16:19], v[48:51]
s_lshl_b32 s53, s52, 2
ds_read_b64_tr_b16 a[140:141], v5 offset:16384
v_mfma_f32_16x16x32_bf16 v[48:51], a[132:135], a[20:23], v[48:51]
s_add_u32 s53, s53, s3
buffer_load_dwordx4 v17, s[12:15], s27 offen offset:1024 lds
v_mfma_f32_16x16x32_bf16 v[56:59], a[128:131], a[24:27], v[56:59]
s_lshl_b32 s49, s53, 12
ds_read_b64_tr_b16 a[142:143], v5 offset:18432
v_mfma_f32_16x16x32_bf16 v[56:59], a[132:135], a[28:31], v[56:59]
s_mul_i32 s53, s53, 4224
v_mfma_f32_16x16x32_bf16 v[64:67], a[128:131], a[32:35], v[64:67]
s_add_u32 s53, s53, 83886080
ds_read_b128 a[64:67], v2 offset:32768
v_mfma_f32_16x16x32_bf16 v[64:67], a[132:135], a[36:39], v[64:67]
s_lshr_b32 s52, s52, 4
buffer_load_dwordx4 v18, s[12:15], s27 offen offset:2048 lds
v_mfma_f32_16x16x32_bf16 v[72:75], a[128:131], a[40:43], v[72:75]
s_min_u32 s52, s52, 6
ds_read_b128 a[68:71], v3 offset:32768
v_mfma_f32_16x16x32_bf16 v[72:75], a[132:135], a[44:47], v[72:75]
s_lshl_b32 s52, s52, 7
ds_read_b128 a[176:179], v22 offset:0
v_mfma_f32_16x16x32_bf16 v[80:83], a[128:131], a[48:51], v[80:83]
s_add_u32 s52, s52, 94392320
ds_read_b128 a[180:183], v23 offset:1024
v_mfma_f32_16x16x32_bf16 v[80:83], a[132:135], a[52:55], v[80:83]
buffer_load_dwordx4 v19, s[12:15], s27 offen offset:3072 lds
v_mfma_f32_16x16x32_bf16 v[88:91], a[128:131], a[56:59], v[88:91]
s_add_u32 s27, s27, 524288
ds_read_b128 a[72:75], v2 offset:34816
v_mfma_f32_16x16x32_bf16 v[88:91], a[132:135], a[60:63], v[88:91]
s_waitcnt lgkmcnt(7)
ds_read_b128 a[184:187], v22 offset:2048
v_mfma_f32_16x16x32_bf16 v[36:39], a[136:139], a[0:3], v[36:39]
s_waitcnt lgkmcnt(6)
s_add_u32 m0, s28, 0
ds_read_b64_tr_b16 a[128:129], v6 offset:0
v_mfma_f32_16x16x32_bf16 v[36:39], a[140:143], a[4:7], v[36:39]
buffer_load_dwordx4 v12, s[8:11], s24 offen offset:0 lds
v_mfma_f32_16x16x32_bf16 v[44:47], a[136:139], a[8:11], v[44:47]
ds_read_b64_tr_b16 a[130:131], v6 offset:2048
v_mfma_f32_16x16x32_bf16 v[44:47], a[140:143], a[12:15], v[44:47]
ds_read_b128 a[188:191], v23 offset:3072
v_mfma_f32_16x16x32_bf16 v[52:55], a[136:139], a[16:19], v[52:55]
ds_read_b64_tr_b16 a[132:133], v6 offset:16384
v_bfe_u32 v231, v1, 4, 5
v_mfma_f32_16x16x32_bf16 v[52:55], a[140:143], a[20:23], v[52:55]
buffer_load_dwordx4 v13, s[8:11], s24 offen offset:1024 lds
v_mfma_f32_16x16x32_bf16 v[60:63], a[136:139], a[24:27], v[60:63]
ds_read_b64_tr_b16 a[134:135], v6 offset:18432
v_lshlrev_b32 v231, 2, v231
v_mfma_f32_16x16x32_bf16 v[60:63], a[140:143], a[28:31], v[60:63]
v_lshlrev_b32 v229, 3, v1
v_min_u32 v229, 4096, v229
v_mfma_f32_16x16x32_bf16 v[68:71], a[136:139], a[32:35], v[68:71]
ds_read_b128 a[76:79], v3 offset:34816
v_mfma_f32_16x16x32_bf16 v[68:71], a[140:143], a[36:39], v[68:71]
buffer_load_dwordx4 v14, s[8:11], s24 offen offset:2048 lds
v_mfma_f32_16x16x32_bf16 v[76:79], a[136:139], a[40:43], v[76:79]
v_mfma_f32_16x16x32_bf16 v[76:79], a[140:143], a[44:47], v[76:79]
v_mfma_f32_16x16x32_bf16 v[84:87], a[136:139], a[48:51], v[84:87]
ds_read_b128 a[80:83], v2 offset:36864
v_mfma_f32_16x16x32_bf16 v[84:87], a[140:143], a[52:55], v[84:87]
buffer_load_dwordx4 v15, s[8:11], s24 offen offset:3072 lds
v_mfma_f32_16x16x32_bf16 v[92:95], a[136:139], a[56:59], v[92:95]
s_add_u32 s24, s24, 128
ds_read_b128 a[84:87], v3 offset:36864
v_mfma_f32_16x16x32_bf16 v[92:95], a[140:143], a[60:63], v[92:95]
s_waitcnt lgkmcnt(6)
v_mfma_f32_16x16x32_bf16 v[96:99], a[128:131], a[0:3], v[96:99]
s_waitcnt lgkmcnt(3)
s_add_u32 m0, s28, 4096
ds_read_b64_tr_b16 a[136:137], v7 offset:0
v_mfma_f32_16x16x32_bf16 v[96:99], a[132:135], a[4:7], v[96:99]
buffer_load_dwordx4 v12, s[8:11], s25 offen offset:0 lds
v_mfma_f32_16x16x32_bf16 v[104:107], a[128:131], a[8:11], v[104:107]
ds_read_b64_tr_b16 a[138:139], v7 offset:2048
v_mfma_f32_16x16x32_bf16 v[104:107], a[132:135], a[12:15], v[104:107]
v_mfma_f32_16x16x32_bf16 v[112:115], a[128:131], a[16:19], v[112:115]
ds_read_b64_tr_b16 a[140:141], v7 offset:16384
v_mfma_f32_16x16x32_bf16 v[112:115], a[132:135], a[20:23], v[112:115]
buffer_load_dwordx4 v13, s[8:11], s25 offen offset:1024 lds
v_mfma_f32_16x16x32_bf16 v[120:123], a[128:131], a[24:27], v[120:123]
ds_read_b64_tr_b16 a[142:143], v7 offset:18432
v_mfma_f32_16x16x32_bf16 v[120:123], a[132:135], a[28:31], v[120:123]
v_mfma_f32_16x16x32_bf16 v[128:131], a[128:131], a[32:35], v[128:131]
v_mfma_f32_16x16x32_bf16 v[128:131], a[132:135], a[36:39], v[128:131]
buffer_load_dwordx4 v14, s[8:11], s25 offen offset:2048 lds
v_mfma_f32_16x16x32_bf16 v[136:139], a[128:131], a[40:43], v[136:139]
ds_read_b128 a[88:91], v2 offset:38912
v_mfma_f32_16x16x32_bf16 v[136:139], a[132:135], a[44:47], v[136:139]
v_mfma_f32_16x16x32_bf16 v[144:147], a[128:131], a[48:51], v[144:147]
ds_read_b128 a[92:95], v3 offset:38912
v_mfma_f32_16x16x32_bf16 v[144:147], a[132:135], a[52:55], v[144:147]
buffer_load_dwordx4 v15, s[8:11], s25 offen offset:3072 lds
v_mfma_f32_16x16x32_bf16 v[152:155], a[128:131], a[56:59], v[152:155]
s_add_u32 s25, s25, 128
v_mfma_f32_16x16x32_bf16 v[152:155], a[132:135], a[60:63], v[152:155]
s_waitcnt lgkmcnt(4)
v_mfma_f32_16x16x32_bf16 v[100:103], a[136:139], a[0:3], v[100:103]
s_waitcnt lgkmcnt(2)
ds_read_b64_tr_b16 a[128:129], v8 offset:0
v_mfma_f32_16x16x32_bf16 v[100:103], a[140:143], a[4:7], v[100:103]
buffer_store_dwordx4 a[176:179], v224, s[4:7], s56 offen sc1
v_mfma_f32_16x16x32_bf16 v[108:111], a[136:139], a[8:11], v[108:111]
s_add_u32 s56, s56, 33792
ds_read_b64_tr_b16 a[130:131], v8 offset:2048
v_mfma_f32_16x16x32_bf16 v[108:111], a[140:143], a[12:15], v[108:111]
v_mfma_f32_16x16x32_bf16 v[116:119], a[136:139], a[16:19], v[116:119]
ds_read_b64_tr_b16 a[132:133], v8 offset:16384
v_mfma_f32_16x16x32_bf16 v[116:119], a[140:143], a[20:23], v[116:119]
v_mfma_f32_16x16x32_bf16 v[124:127], a[136:139], a[24:27], v[124:127]
s_cmp_lt_u32 s21, 0
ds_read_b64_tr_b16 a[134:135], v8 offset:18432
v_mfma_f32_16x16x32_bf16 v[124:127], a[140:143], a[28:31], v[124:127]
s_cselect_b32 s53, s53, 3221225472
v_mfma_f32_16x16x32_bf16 v[132:135], a[136:139], a[32:35], v[132:135]
s_cselect_b32 s49, s49, 3221225472
ds_read_b128 a[96:99], v2 offset:40960
v_mfma_f32_16x16x32_bf16 v[132:135], a[140:143], a[36:39], v[132:135]
s_add_u32 s48, s53, 2097152
v_mfma_f32_16x16x32_bf16 v[140:143], a[136:139], a[40:43], v[140:143]
v_mfma_f32_16x16x32_bf16 v[140:143], a[140:143], a[44:47], v[140:143]
v_mfma_f32_16x16x32_bf16 v[148:151], a[136:139], a[48:51], v[148:151]
ds_read_b128 a[100:103], v3 offset:40960
v_mfma_f32_16x16x32_bf16 v[148:151], a[140:143], a[52:55], v[148:151]
v_mfma_f32_16x16x32_bf16 v[156:159], a[136:139], a[56:59], v[156:159]
ds_read_b128 a[104:107], v2 offset:43008
v_mfma_f32_16x16x32_bf16 v[156:159], a[140:143], a[60:63], v[156:159]
s_waitcnt lgkmcnt(5)
v_mfma_f32_16x16x32_bf16 v[160:163], a[128:131], a[0:3], v[160:163]
s_waitcnt lgkmcnt(3)
ds_read_b64_tr_b16 a[136:137], v9 offset:0
v_mfma_f32_16x16x32_bf16 v[160:163], a[132:135], a[4:7], v[160:163]
v_mfma_f32_16x16x32_bf16 v[168:171], a[128:131], a[8:11], v[168:171]
ds_read_b64_tr_b16 a[138:139], v9 offset:2048
v_mfma_f32_16x16x32_bf16 v[168:171], a[132:135], a[12:15], v[168:171]
buffer_store_dwordx4 a[180:183], v224, s[4:7], s56 offen sc1
v_mfma_f32_16x16x32_bf16 v[176:179], a[128:131], a[16:19], v[176:179]
s_add_u32 s56, s56, 33792
ds_read_b64_tr_b16 a[140:141], v9 offset:16384
v_mfma_f32_16x16x32_bf16 v[176:179], a[132:135], a[20:23], v[176:179]
v_mfma_f32_16x16x32_bf16 v[184:187], a[128:131], a[24:27], v[184:187]
ds_read_b64_tr_b16 a[142:143], v9 offset:18432
v_mfma_f32_16x16x32_bf16 v[184:187], a[132:135], a[28:31], v[184:187]
v_mfma_f32_16x16x32_bf16 v[192:195], a[128:131], a[32:35], v[192:195]
v_mfma_f32_16x16x32_bf16 v[192:195], a[132:135], a[36:39], v[192:195]
v_mfma_f32_16x16x32_bf16 v[200:203], a[128:131], a[40:43], v[200:203]
ds_read_b128 a[108:111], v3 offset:43008
v_mfma_f32_16x16x32_bf16 v[200:203], a[132:135], a[44:47], v[200:203]
v_mfma_f32_16x16x32_bf16 v[208:211], a[128:131], a[48:51], v[208:211]
ds_read_b128 a[112:115], v2 offset:45056
v_mfma_f32_16x16x32_bf16 v[208:211], a[132:135], a[52:55], v[208:211]
v_mfma_f32_16x16x32_bf16 v[216:219], a[128:131], a[56:59], v[216:219]
v_mfma_f32_16x16x32_bf16 v[216:219], a[132:135], a[60:63], v[216:219]
s_waitcnt lgkmcnt(4)
v_mfma_f32_16x16x32_bf16 v[164:167], a[136:139], a[0:3], v[164:167]
s_waitcnt lgkmcnt(2)
ds_read_b64_tr_b16 a[128:129], v10 offset:0
v_mfma_f32_16x16x32_bf16 v[164:167], a[140:143], a[4:7], v[164:167]
v_mfma_f32_16x16x32_bf16 v[172:175], a[136:139], a[8:11], v[172:175]
ds_read_b64_tr_b16 a[130:131], v10 offset:2048
v_mfma_f32_16x16x32_bf16 v[172:175], a[140:143], a[12:15], v[172:175]
v_mfma_f32_16x16x32_bf16 v[180:183], a[136:139], a[16:19], v[180:183]
ds_read_b64_tr_b16 a[132:133], v10 offset:16384
v_mfma_f32_16x16x32_bf16 v[180:183], a[140:143], a[20:23], v[180:183]
buffer_store_dwordx4 a[184:187], v224, s[4:7], s56 offen sc1
v_mfma_f32_16x16x32_bf16 v[188:191], a[136:139], a[24:27], v[188:191]
s_add_u32 s56, s56, 33792
ds_read_b64_tr_b16 a[134:135], v10 offset:18432
v_mfma_f32_16x16x32_bf16 v[188:191], a[140:143], a[28:31], v[188:191]
v_mfma_f32_16x16x32_bf16 v[196:199], a[136:139], a[32:35], v[196:199]
ds_read_b128 a[116:119], v3 offset:45056
v_mfma_f32_16x16x32_bf16 v[196:199], a[140:143], a[36:39], v[196:199]
v_mfma_f32_16x16x32_bf16 v[204:207], a[136:139], a[40:43], v[204:207]
ds_read_b128 a[120:123], v2 offset:47104
v_mfma_f32_16x16x32_bf16 v[204:207], a[140:143], a[44:47], v[204:207]
v_mfma_f32_16x16x32_bf16 v[212:215], a[136:139], a[48:51], v[212:215]
v_mfma_f32_16x16x32_bf16 v[212:215], a[140:143], a[52:55], v[212:215]
v_mfma_f32_16x16x32_bf16 v[220:223], a[136:139], a[56:59], v[220:223]
ds_read_b128 a[124:127], v3 offset:47104
v_mfma_f32_16x16x32_bf16 v[220:223], a[140:143], a[60:63], v[220:223]
s_waitcnt lgkmcnt(5)
v_mfma_f32_16x16x32_bf16 a[192:195], a[128:131], a[0:3], a[192:195]
s_waitcnt lgkmcnt(3)
ds_read_b64_tr_b16 a[136:137], v11 offset:0
v_mfma_f32_16x16x32_bf16 a[192:195], a[132:135], a[4:7], a[192:195]
v_mfma_f32_16x16x32_bf16 a[200:203], a[128:131], a[8:11], a[200:203]
ds_read_b64_tr_b16 a[138:139], v11 offset:2048
v_mfma_f32_16x16x32_bf16 a[200:203], a[132:135], a[12:15], a[200:203]
v_mfma_f32_16x16x32_bf16 a[208:211], a[128:131], a[16:19], a[208:211]
ds_read_b64_tr_b16 a[140:141], v11 offset:16384
v_mfma_f32_16x16x32_bf16 a[208:211], a[132:135], a[20:23], a[208:211]
v_mfma_f32_16x16x32_bf16 a[216:219], a[128:131], a[24:27], a[216:219]
ds_read_b64_tr_b16 a[142:143], v11 offset:18432
v_mfma_f32_16x16x32_bf16 a[216:219], a[132:135], a[28:31], a[216:219]
buffer_store_dwordx4 a[188:191], v224, s[4:7], s56 offen sc1
v_mfma_f32_16x16x32_bf16 a[224:227], a[128:131], a[32:35], a[224:227]
s_add_u32 s56, s56, 33792
v_mfma_f32_16x16x32_bf16 a[224:227], a[132:135], a[36:39], a[224:227]
v_mfma_f32_16x16x32_bf16 a[232:235], a[128:131], a[40:43], a[232:235]
v_mfma_f32_16x16x32_bf16 a[232:235], a[132:135], a[44:47], a[232:235]
v_mfma_f32_16x16x32_bf16 a[240:243], a[128:131], a[48:51], a[240:243]
v_mfma_f32_16x16x32_bf16 a[240:243], a[132:135], a[52:55], a[240:243]
v_mfma_f32_16x16x32_bf16 a[248:251], a[128:131], a[56:59], a[248:251]
v_mfma_f32_16x16x32_bf16 a[248:251], a[132:135], a[60:63], a[248:251]
s_waitcnt vmcnt(4) lgkmcnt(0)
s_barrier
v_mfma_f32_16x16x32_bf16 a[196:199], a[136:139], a[0:3], a[196:199]
s_add_u32 m0, s29, 65536
ds_read_b64_tr_b16 a[128:129], v4 offset:32768
v_mfma_f32_16x16x32_bf16 a[196:199], a[140:143], a[4:7], a[196:199]
buffer_load_dwordx4 v16, s[12:15], s26 offen offset:0 lds
v_mfma_f32_16x16x32_bf16 a[204:207], a[136:139], a[8:11], a[204:207]
ds_read_b64_tr_b16 a[130:131], v4 offset:34816
v_cmp_gt_u32 vcc, 0x100, v245
v_mfma_f32_16x16x32_bf16 a[204:207], a[140:143], a[12:15], a[204:207]
v_mfma_f32_16x16x32_bf16 a[212:215], a[136:139], a[16:19], a[212:215]
ds_read_b64_tr_b16 a[132:133], v4 offset:49152
v_mfma_f32_16x16x32_bf16 a[212:215], a[140:143], a[20:23], a[212:215]
buffer_load_dwordx4 v17, s[12:15], s26 offen offset:1024 lds
v_mfma_f32_16x16x32_bf16 a[220:223], a[136:139], a[24:27], a[220:223]
ds_read_b64_tr_b16 a[134:135], v4 offset:51200
v_mfma_f32_16x16x32_bf16 a[220:223], a[140:143], a[28:31], a[220:223]
v_mfma_f32_16x16x32_bf16 a[228:231], a[136:139], a[32:35], a[228:231]
v_mfma_f32_16x16x32_bf16 a[228:231], a[140:143], a[36:39], a[228:231]
buffer_load_dwordx4 v18, s[12:15], s26 offen offset:2048 lds
v_mfma_f32_16x16x32_bf16 a[236:239], a[136:139], a[40:43], a[236:239]
v_mfma_f32_16x16x32_bf16 a[236:239], a[140:143], a[44:47], a[236:239]
v_mfma_f32_16x16x32_bf16 a[244:247], a[136:139], a[48:51], a[244:247]
v_mfma_f32_16x16x32_bf16 a[244:247], a[140:143], a[52:55], a[244:247]
buffer_load_dwordx4 v19, s[12:15], s26 offen offset:3072 lds
v_mfma_f32_16x16x32_bf16 a[252:255], a[136:139], a[56:59], a[252:255]
s_add_u32 s26, s26, 524288
v_mfma_f32_16x16x32_bf16 a[252:255], a[140:143], a[60:63], a[252:255]
s_waitcnt lgkmcnt(2)
s_mov_b32 s82, s59
s_cbranch_vccnz M_cntspinK
s_branch Lg_1
Lg_1t:
buffer_load_dword v230, v231, s[4:7], s52 offen sc1
v_mfma_f32_16x16x32_bf16 v[32:35], a[128:131], a[64:67], v[32:35]
s_waitcnt lgkmcnt(0)
s_add_u32 m0, s29, 81920
ds_read_b64_tr_b16 a[136:137], v5 offset:32768
v_mfma_f32_16x16x32_bf16 v[32:35], a[132:135], a[68:71], v[32:35]
buffer_load_dwordx4 v16, s[12:15], s27 offen offset:0 lds
v_mfma_f32_16x16x32_bf16 v[40:43], a[128:131], a[72:75], v[40:43]
s_and_b32 s44, s3, 1
ds_read_b64_tr_b16 a[138:139], v5 offset:34816
v_mfma_f32_16x16x32_bf16 v[40:43], a[132:135], a[76:79], v[40:43]
s_lshl_b32 s44, s44, 8
v_mfma_f32_16x16x32_bf16 v[48:51], a[128:131], a[80:83], v[48:51]
s_lshl_b32 s45, s3, 7
ds_read_b64_tr_b16 a[140:141], v5 offset:49152
v_mfma_f32_16x16x32_bf16 v[48:51], a[132:135], a[84:87], v[48:51]
s_xor_b32 s44, s44, s45
buffer_load_dwordx4 v17, s[12:15], s27 offen offset:1024 lds
v_mfma_f32_16x16x32_bf16 v[56:59], a[128:131], a[88:91], v[56:59]
s_xor_b32 s44, s44, 196608
ds_read_b64_tr_b16 a[142:143], v5 offset:51200
v_mfma_f32_16x16x32_bf16 v[56:59], a[132:135], a[92:95], v[56:59]
v_mfma_f32_16x16x32_bf16 v[64:67], a[128:131], a[96:99], v[64:67]
ds_read_b128 a[0:3], v2 offset:0
v_mfma_f32_16x16x32_bf16 v[64:67], a[132:135], a[100:103], v[64:67]
buffer_load_dwordx4 v18, s[12:15], s27 offen offset:2048 lds
v_mfma_f32_16x16x32_bf16 v[72:75], a[128:131], a[104:107], v[72:75]
ds_read_b128 a[4:7], v3 offset:0
v_mfma_f32_16x16x32_bf16 v[72:75], a[132:135], a[108:111], v[72:75]
v_mfma_f32_16x16x32_bf16 v[80:83], a[128:131], a[112:115], v[80:83]
v_mfma_f32_16x16x32_bf16 v[80:83], a[132:135], a[116:119], v[80:83]
buffer_load_dwordx4 v19, s[12:15], s27 offen offset:3072 lds
v_mfma_f32_16x16x32_bf16 v[88:91], a[128:131], a[120:123], v[88:91]
s_add_u32 s27, s27, 524288
ds_read_b128 a[8:11], v2 offset:2048
v_mfma_f32_16x16x32_bf16 v[88:91], a[132:135], a[124:127], v[88:91]
s_waitcnt lgkmcnt(5)
v_mfma_f32_16x16x32_bf16 v[36:39], a[136:139], a[64:67], v[36:39]
s_waitcnt lgkmcnt(3)
s_add_u32 m0, s28, 32768
ds_read_b64_tr_b16 a[128:129], v6 offset:32768
v_mfma_f32_16x16x32_bf16 v[36:39], a[140:143], a[68:71], v[36:39]
buffer_load_dwordx4 v12, s[8:11], s24 offen offset:0 lds
v_mfma_f32_16x16x32_bf16 v[44:47], a[136:139], a[72:75], v[44:47]
ds_read_b64_tr_b16 a[130:131], v6 offset:34816
v_mfma_f32_16x16x32_bf16 v[44:47], a[140:143], a[76:79], v[44:47]
v_mfma_f32_16x16x32_bf16 v[52:55], a[136:139], a[80:83], v[52:55]
s_mov_b64 s[56:57], s[72:73]
ds_read_b64_tr_b16 a[132:133], v6 offset:49152
v_mfma_f32_16x16x32_bf16 v[52:55], a[140:143], a[84:87], v[52:55]
s_mov_b32 s58, 1835008
buffer_load_dwordx4 v13, s[8:11], s24 offen offset:1024 lds
v_mfma_f32_16x16x32_bf16 v[60:63], a[136:139], a[88:91], v[60:63]
s_mov_b32 s59, 0x20000
ds_read_b64_tr_b16 a[134:135], v6 offset:51200
v_mfma_f32_16x16x32_bf16 v[60:63], a[140:143], a[92:95], v[60:63]
v_mfma_f32_16x16x32_bf16 v[68:71], a[136:139], a[96:99], v[68:71]
ds_read_b128 a[12:15], v3 offset:2048
v_mfma_f32_16x16x32_bf16 v[68:71], a[140:143], a[100:103], v[68:71]
buffer_load_dwordx4 v14, s[8:11], s24 offen offset:2048 lds
v_mfma_f32_16x16x32_bf16 v[76:79], a[136:139], a[104:107], v[76:79]
v_mfma_f32_16x16x32_bf16 v[76:79], a[140:143], a[108:111], v[76:79]
v_mfma_f32_16x16x32_bf16 v[84:87], a[136:139], a[112:115], v[84:87]
ds_read_b128 a[16:19], v2 offset:4096
v_mfma_f32_16x16x32_bf16 v[84:87], a[140:143], a[116:119], v[84:87]
buffer_load_dwordx4 v15, s[8:11], s24 offen offset:3072 lds
v_mfma_f32_16x16x32_bf16 v[92:95], a[136:139], a[120:123], v[92:95]
s_add_u32 s24, s24, 128
ds_read_b128 a[20:23], v3 offset:4096
v_mfma_f32_16x16x32_bf16 v[92:95], a[140:143], a[124:127], v[92:95]
s_waitcnt lgkmcnt(5)
v_mfma_f32_16x16x32_bf16 v[96:99], a[128:131], a[64:67], v[96:99]
s_waitcnt lgkmcnt(3)
s_add_u32 m0, s28, 36864
ds_read_b64_tr_b16 a[136:137], v7 offset:32768
v_mfma_f32_16x16x32_bf16 v[96:99], a[132:135], a[68:71], v[96:99]
buffer_load_dwordx4 v12, s[8:11], s25 offen offset:0 lds
v_mfma_f32_16x16x32_bf16 v[104:107], a[128:131], a[72:75], v[104:107]
ds_read_b64_tr_b16 a[138:139], v7 offset:34816
v_mfma_f32_16x16x32_bf16 v[104:107], a[132:135], a[76:79], v[104:107]
v_mfma_f32_16x16x32_bf16 v[112:115], a[128:131], a[80:83], v[112:115]
ds_read_b64_tr_b16 a[140:141], v7 offset:49152
v_mfma_f32_16x16x32_bf16 v[112:115], a[132:135], a[84:87], v[112:115]
buffer_load_dwordx4 v13, s[8:11], s25 offen offset:1024 lds
v_mfma_f32_16x16x32_bf16 v[120:123], a[128:131], a[88:91], v[120:123]
ds_read_b64_tr_b16 a[142:143], v7 offset:51200
v_mfma_f32_16x16x32_bf16 v[120:123], a[132:135], a[92:95], v[120:123]
v_mfma_f32_16x16x32_bf16 v[128:131], a[128:131], a[96:99], v[128:131]
v_mfma_f32_16x16x32_bf16 v[128:131], a[132:135], a[100:103], v[128:131]
buffer_load_dwordx4 v14, s[8:11], s25 offen offset:2048 lds
v_mfma_f32_16x16x32_bf16 v[136:139], a[128:131], a[104:107], v[136:139]
ds_read_b128 a[24:27], v2 offset:6144
v_mfma_f32_16x16x32_bf16 v[136:139], a[132:135], a[108:111], v[136:139]
v_mfma_f32_16x16x32_bf16 v[144:147], a[128:131], a[112:115], v[144:147]
ds_read_b128 a[28:31], v3 offset:6144
v_mfma_f32_16x16x32_bf16 v[144:147], a[132:135], a[116:119], v[144:147]
buffer_load_dwordx4 v15, s[8:11], s25 offen offset:3072 lds
v_mfma_f32_16x16x32_bf16 v[152:155], a[128:131], a[120:123], v[152:155]
s_add_u32 s25, s25, 128
s_waitcnt vmcnt(12)
v_mfma_f32_16x16x32_bf16 v[152:155], a[132:135], a[124:127], v[152:155]
s_waitcnt lgkmcnt(4)
v_cmp_gt_u32 vcc, 1, v230
v_mfma_f32_16x16x32_bf16 v[100:103], a[136:139], a[64:67], v[100:103]
s_waitcnt lgkmcnt(2)
s_cbranch_vccnz M_ppspinK
M_ppokK:
ds_read_b64_tr_b16 a[128:129], v8 offset:32768
v_mfma_f32_16x16x32_bf16 v[100:103], a[140:143], a[68:71], v[100:103]
buffer_load_dword v230, v229, s[4:7], s53 offen sc1
v_mfma_f32_16x16x32_bf16 v[108:111], a[136:139], a[72:75], v[108:111]
s_mov_b64 s[8:9], s[76:77]
ds_read_b64_tr_b16 a[130:131], v8 offset:34816
v_mfma_f32_16x16x32_bf16 v[108:111], a[140:143], a[76:79], v[108:111]
s_mov_b32 s10, 1835008
buffer_load_dword v230, v229, s[4:7], s48 offen sc1
v_mfma_f32_16x16x32_bf16 v[116:119], a[136:139], a[80:83], v[116:119]
s_lshl_b32 s24, s37, 2
ds_read_b64_tr_b16 a[132:133], v8 offset:49152
v_mfma_f32_16x16x32_bf16 v[116:119], a[140:143], a[84:87], v[116:119]
s_add_u32 s24, s24, s3
buffer_load_dword v230, v229, s[56:59], s49 offen
v_mfma_f32_16x16x32_bf16 v[124:127], a[136:139], a[88:91], v[124:127]
s_mul_i32 s24, s24, 28672
ds_read_b64_tr_b16 a[134:135], v8 offset:51200
v_mfma_f32_16x16x32_bf16 v[124:127], a[140:143], a[92:95], v[124:127]
s_mov_b32 s28, s29
buffer_load_dword v21, v20, s[16:19], s43 offen
v_mfma_f32_16x16x32_bf16 v[132:135], a[136:139], a[96:99], v[132:135]
ds_read_b128 a[32:35], v2 offset:8192
v_mfma_f32_16x16x32_bf16 v[132:135], a[140:143], a[100:103], v[132:135]
v_mfma_f32_16x16x32_bf16 v[140:143], a[136:139], a[104:107], v[140:143]
v_mfma_f32_16x16x32_bf16 v[140:143], a[140:143], a[108:111], v[140:143]
v_mfma_f32_16x16x32_bf16 v[148:151], a[136:139], a[112:115], v[148:151]
ds_read_b128 a[36:39], v3 offset:8192
v_lshrrev_b32 v28, 7, v1
v_mfma_f32_16x16x32_bf16 v[148:151], a[140:143], a[116:119], v[148:151]
v_lshrrev_b32 v29, 1, v28
v_lshlrev_b32 v29, 4, v29
v_mfma_f32_16x16x32_bf16 v[156:159], a[136:139], a[120:123], v[156:159]
ds_read_b128 a[40:43], v2 offset:10240
v_and_b32 v30, 0x70, v1
v_mfma_f32_16x16x32_bf16 v[156:159], a[140:143], a[124:127], v[156:159]
s_waitcnt lgkmcnt(5)
v_xor_b32 v29, v29, v30
v_mul_u32_u24 v28, 896, v28
v_mfma_f32_16x16x32_bf16 v[160:163], a[128:131], a[64:67], v[160:163]
s_waitcnt lgkmcnt(3)
ds_read_b64_tr_b16 a[136:137], v9 offset:32768
v_add_u32 v12, v28, v29
v_mfma_f32_16x16x32_bf16 v[160:163], a[132:135], a[68:71], v[160:163]
v_xor_b32 v29, 64, v29
v_add_u32 v28, v28, v29
v_mfma_f32_16x16x32_bf16 v[168:171], a[128:131], a[72:75], v[168:171]
ds_read_b64_tr_b16 a[138:139], v9 offset:34816
v_add_u32 v13, 6144, v28
v_mfma_f32_16x16x32_bf16 v[168:171], a[132:135], a[76:79], v[168:171]
v_add_u32 v14, 12288, v12
v_add_u32 v15, 18432, v28
v_mfma_f32_16x16x32_bf16 v[176:179], a[128:131], a[80:83], v[176:179]
ds_read_b64_tr_b16 a[140:141], v9 offset:49152
v_xor_b32 v22, s44, v4
v_mfma_f32_16x16x32_bf16 v[176:179], a[132:135], a[84:87], v[176:179]
v_xor_b32 v23, 32, v22
v_xor_b32 v24, 64, v22
v_mfma_f32_16x16x32_bf16 v[184:187], a[128:131], a[88:91], v[184:187]
ds_read_b64_tr_b16 a[142:143], v9 offset:51200
v_xor_b32 v25, 96, v22
v_mfma_f32_16x16x32_bf16 v[184:187], a[132:135], a[92:95], v[184:187]
v_mfma_f32_16x16x32_bf16 v[192:195], a[128:131], a[96:99], v[192:195]
v_mfma_f32_16x16x32_bf16 v[192:195], a[132:135], a[100:103], v[192:195]
v_mfma_f32_16x16x32_bf16 v[200:203], a[128:131], a[104:107], v[200:203]
ds_read_b128 a[44:47], v3 offset:10240
v_mfma_f32_16x16x32_bf16 v[200:203], a[132:135], a[108:111], v[200:203]
v_mfma_f32_16x16x32_bf16 v[208:211], a[128:131], a[112:115], v[208:211]
ds_read_b128 a[48:51], v2 offset:12288
v_mfma_f32_16x16x32_bf16 v[208:211], a[132:135], a[116:119], v[208:211]
v_mfma_f32_16x16x32_bf16 v[216:219], a[128:131], a[120:123], v[216:219]
v_mfma_f32_16x16x32_bf16 v[216:219], a[132:135], a[124:127], v[216:219]
s_waitcnt lgkmcnt(4)
v_mfma_f32_16x16x32_bf16 v[164:167], a[136:139], a[64:67], v[164:167]
s_waitcnt lgkmcnt(2)
ds_read_b64_tr_b16 a[128:129], v10 offset:32768
v_mfma_f32_16x16x32_bf16 v[164:167], a[140:143], a[68:71], v[164:167]
v_mfma_f32_16x16x32_bf16 v[172:175], a[136:139], a[72:75], v[172:175]
ds_read_b64_tr_b16 a[130:131], v10 offset:34816
v_mfma_f32_16x16x32_bf16 v[172:175], a[140:143], a[76:79], v[172:175]
v_mfma_f32_16x16x32_bf16 v[180:183], a[136:139], a[80:83], v[180:183]
ds_read_b64_tr_b16 a[132:133], v10 offset:49152
v_mfma_f32_16x16x32_bf16 v[180:183], a[140:143], a[84:87], v[180:183]
v_mfma_f32_16x16x32_bf16 v[188:191], a[136:139], a[88:91], v[188:191]
ds_read_b64_tr_b16 a[134:135], v10 offset:51200
v_mfma_f32_16x16x32_bf16 v[188:191], a[140:143], a[92:95], v[188:191]
v_mfma_f32_16x16x32_bf16 v[196:199], a[136:139], a[96:99], v[196:199]
ds_read_b128 a[52:55], v3 offset:12288
v_mfma_f32_16x16x32_bf16 v[196:199], a[140:143], a[100:103], v[196:199]
v_mfma_f32_16x16x32_bf16 v[204:207], a[136:139], a[104:107], v[204:207]
ds_read_b128 a[56:59], v2 offset:14336
v_mfma_f32_16x16x32_bf16 v[204:207], a[140:143], a[108:111], v[204:207]
v_mfma_f32_16x16x32_bf16 v[212:215], a[136:139], a[112:115], v[212:215]
v_mfma_f32_16x16x32_bf16 v[212:215], a[140:143], a[116:119], v[212:215]
v_mfma_f32_16x16x32_bf16 v[220:223], a[136:139], a[120:123], v[220:223]
ds_read_b128 a[60:63], v3 offset:14336
v_mfma_f32_16x16x32_bf16 v[220:223], a[140:143], a[124:127], v[220:223]
s_waitcnt lgkmcnt(5)
v_mfma_f32_16x16x32_bf16 a[192:195], a[128:131], a[64:67], a[192:195]
s_waitcnt lgkmcnt(3)
ds_read_b64_tr_b16 a[136:137], v11 offset:32768
v_mfma_f32_16x16x32_bf16 a[192:195], a[132:135], a[68:71], a[192:195]
v_mfma_f32_16x16x32_bf16 a[200:203], a[128:131], a[72:75], a[200:203]
ds_read_b64_tr_b16 a[138:139], v11 offset:34816
v_mfma_f32_16x16x32_bf16 a[200:203], a[132:135], a[76:79], a[200:203]
v_mfma_f32_16x16x32_bf16 a[208:211], a[128:131], a[80:83], a[208:211]
ds_read_b64_tr_b16 a[140:141], v11 offset:49152
v_mfma_f32_16x16x32_bf16 a[208:211], a[132:135], a[84:87], a[208:211]
v_mfma_f32_16x16x32_bf16 a[216:219], a[128:131], a[88:91], a[216:219]
ds_read_b64_tr_b16 a[142:143], v11 offset:51200
v_mfma_f32_16x16x32_bf16 a[216:219], a[132:135], a[92:95], a[216:219]
v_mfma_f32_16x16x32_bf16 a[224:227], a[128:131], a[96:99], a[224:227]
v_mfma_f32_16x16x32_bf16 a[224:227], a[132:135], a[100:103], a[224:227]
v_mfma_f32_16x16x32_bf16 a[232:235], a[128:131], a[104:107], a[232:235]
v_mfma_f32_16x16x32_bf16 a[232:235], a[132:135], a[108:111], a[232:235]
v_mfma_f32_16x16x32_bf16 a[240:243], a[128:131], a[112:115], a[240:243]
v_mfma_f32_16x16x32_bf16 a[240:243], a[132:135], a[116:119], a[240:243]
v_mfma_f32_16x16x32_bf16 a[248:251], a[128:131], a[120:123], a[248:251]
v_mfma_f32_16x16x32_bf16 a[248:251], a[132:135], a[124:127], a[248:251]
s_waitcnt vmcnt(4) lgkmcnt(0)
s_barrier
v_mfma_f32_16x16x32_bf16 a[196:199], a[136:139], a[64:67], a[196:199]
s_add_u32 m0, s29, 98304
ds_read_b64_tr_b16 a[128:129], v4 offset:0
v_mfma_f32_16x16x32_bf16 a[196:199], a[140:143], a[68:71], a[196:199]
buffer_load_dwordx4 v16, s[12:15], s26 offen offset:0 lds
v_mfma_f32_16x16x32_bf16 a[204:207], a[136:139], a[72:75], a[204:207]
ds_read_b64_tr_b16 a[130:131], v4 offset:2048
v_mfma_f32_16x16x32_bf16 a[204:207], a[140:143], a[76:79], a[204:207]
v_mfma_f32_16x16x32_bf16 a[212:215], a[136:139], a[80:83], a[212:215]
ds_read_b64_tr_b16 a[132:133], v4 offset:16384
v_mfma_f32_16x16x32_bf16 a[212:215], a[140:143], a[84:87], a[212:215]
buffer_load_dwordx4 v17, s[12:15], s26 offen offset:1024 lds
v_mfma_f32_16x16x32_bf16 a[220:223], a[136:139], a[88:91], a[220:223]
ds_read_b64_tr_b16 a[134:135], v4 offset:18432
v_mfma_f32_16x16x32_bf16 a[220:223], a[140:143], a[92:95], a[220:223]
v_mfma_f32_16x16x32_bf16 a[228:231], a[136:139], a[96:99], a[228:231]
v_mfma_f32_16x16x32_bf16 a[228:231], a[140:143], a[100:103], a[228:231]
buffer_load_dwordx4 v18, s[12:15], s26 offen offset:2048 lds
v_mfma_f32_16x16x32_bf16 a[236:239], a[136:139], a[104:107], a[236:239]
v_mfma_f32_16x16x32_bf16 a[236:239], a[140:143], a[108:111], a[236:239]
v_mfma_f32_16x16x32_bf16 a[244:247], a[136:139], a[112:115], a[244:247]
v_mfma_f32_16x16x32_bf16 a[244:247], a[140:143], a[116:119], a[244:247]
buffer_load_dwordx4 v19, s[12:15], s26 offen offset:3072 lds
v_mfma_f32_16x16x32_bf16 a[252:255], a[136:139], a[120:123], a[252:255]
s_add_u32 s26, s26, 524288
v_mfma_f32_16x16x32_bf16 a[252:255], a[140:143], a[124:127], a[252:255]
s_waitcnt lgkmcnt(2)
v_mfma_f32_16x16x32_bf16 v[32:35], a[128:131], a[0:3], v[32:35]
s_waitcnt lgkmcnt(0)
s_add_u32 m0, s29, 114688
ds_read_b64_tr_b16 a[136:137], v5 offset:0
v_mfma_f32_16x16x32_bf16 v[32:35], a[132:135], a[4:7], v[32:35]
buffer_load_dwordx4 v16, s[12:15], s27 offen offset:0 lds
v_mfma_f32_16x16x32_bf16 v[40:43], a[128:131], a[8:11], v[40:43]
ds_read_b64_tr_b16 a[138:139], v5 offset:2048
v_mfma_f32_16x16x32_bf16 v[40:43], a[132:135], a[12:15], v[40:43]
v_mfma_f32_16x16x32_bf16 v[48:51], a[128:131], a[16:19], v[48:51]
ds_read_b64_tr_b16 a[140:141], v5 offset:16384
v_mfma_f32_16x16x32_bf16 v[48:51], a[132:135], a[20:23], v[48:51]
buffer_load_dwordx4 v17, s[12:15], s27 offen offset:1024 lds
v_mfma_f32_16x16x32_bf16 v[56:59], a[128:131], a[24:27], v[56:59]
ds_read_b64_tr_b16 a[142:143], v5 offset:18432
v_mfma_f32_16x16x32_bf16 v[56:59], a[132:135], a[28:31], v[56:59]
v_mfma_f32_16x16x32_bf16 v[64:67], a[128:131], a[32:35], v[64:67]
ds_read_b128 a[64:67], v2 offset:32768
v_mfma_f32_16x16x32_bf16 v[64:67], a[132:135], a[36:39], v[64:67]
buffer_load_dwordx4 v18, s[12:15], s27 offen offset:2048 lds
v_mfma_f32_16x16x32_bf16 v[72:75], a[128:131], a[40:43], v[72:75]
ds_read_b128 a[68:71], v3 offset:32768
v_mfma_f32_16x16x32_bf16 v[72:75], a[132:135], a[44:47], v[72:75]
v_mfma_f32_16x16x32_bf16 v[80:83], a[128:131], a[48:51], v[80:83]
v_mfma_f32_16x16x32_bf16 v[80:83], a[132:135], a[52:55], v[80:83]
buffer_load_dwordx4 v19, s[12:15], s27 offen offset:3072 lds
v_mfma_f32_16x16x32_bf16 v[88:91], a[128:131], a[56:59], v[88:91]
s_add_u32 s27, s27, 524288
ds_read_b128 a[72:75], v2 offset:34816
v_mfma_f32_16x16x32_bf16 v[88:91], a[132:135], a[60:63], v[88:91]
s_waitcnt lgkmcnt(5)
v_mfma_f32_16x16x32_bf16 v[36:39], a[136:139], a[0:3], v[36:39]
s_waitcnt lgkmcnt(3)
s_add_u32 m0, s28, 0
ds_read_b64_tr_b16 a[128:129], v6 offset:0
v_mfma_f32_16x16x32_bf16 v[36:39], a[140:143], a[4:7], v[36:39]
buffer_load_dwordx4 v12, s[8:11], s24 offen offset:0 lds
v_mfma_f32_16x16x32_bf16 v[44:47], a[136:139], a[8:11], v[44:47]
ds_read_b64_tr_b16 a[130:131], v6 offset:2048
v_mfma_f32_16x16x32_bf16 v[44:47], a[140:143], a[12:15], v[44:47]
v_mfma_f32_16x16x32_bf16 v[52:55], a[136:139], a[16:19], v[52:55]
ds_read_b64_tr_b16 a[132:133], v6 offset:16384
v_mfma_f32_16x16x32_bf16 v[52:55], a[140:143], a[20:23], v[52:55]
buffer_load_dwordx4 v13, s[8:11], s24 offen offset:1024 lds
v_mfma_f32_16x16x32_bf16 v[60:63], a[136:139], a[24:27], v[60:63]
ds_read_b64_tr_b16 a[134:135], v6 offset:18432
v_mfma_f32_16x16x32_bf16 v[60:63], a[140:143], a[28:31], v[60:63]
v_mfma_f32_16x16x32_bf16 v[68:71], a[136:139], a[32:35], v[68:71]
ds_read_b128 a[76:79], v3 offset:34816
v_mfma_f32_16x16x32_bf16 v[68:71], a[140:143], a[36:39], v[68:71]
buffer_load_dwordx4 v14, s[8:11], s24 offen offset:2048 lds
v_mfma_f32_16x16x32_bf16 v[76:79], a[136:139], a[40:43], v[76:79]
v_mfma_f32_16x16x32_bf16 v[76:79], a[140:143], a[44:47], v[76:79]
v_mfma_f32_16x16x32_bf16 v[84:87], a[136:139], a[48:51], v[84:87]
ds_read_b128 a[80:83], v2 offset:36864
v_mfma_f32_16x16x32_bf16 v[84:87], a[140:143], a[52:55], v[84:87]
buffer_load_dwordx4 v15, s[8:11], s24 offen offset:3072 lds
v_mfma_f32_16x16x32_bf16 v[92:95], a[136:139], a[56:59], v[92:95]
s_add_u32 s24, s24, 128
ds_read_b128 a[84:87], v3 offset:36864
v_mfma_f32_16x16x32_bf16 v[92:95], a[140:143], a[60:63], v[92:95]
s_waitcnt lgkmcnt(3)
s_mov_b64 s[12:13], s[80:81]
v_mfma_f32_16x16x32_bf16 v[96:99], a[128:131], a[0:3], v[96:99]
s_mov_b32 s14, 3670016
s_add_u32 m0, s28, 16384
ds_read_b64_tr_b16 a[136:137], v7 offset:0
v_mfma_f32_16x16x32_bf16 v[96:99], a[132:135], a[4:7], v[96:99]
buffer_load_dwordx4 v12, s[8:11], s24 offen offset:0 lds
v_mfma_f32_16x16x32_bf16 v[104:107], a[128:131], a[8:11], v[104:107]
ds_read_b64_tr_b16 a[138:139], v7 offset:2048
v_mfma_f32_16x16x32_bf16 v[104:107], a[132:135], a[12:15], v[104:107]
v_mfma_f32_16x16x32_bf16 v[112:115], a[128:131], a[16:19], v[112:115]
ds_read_b64_tr_b16 a[140:141], v7 offset:16384
v_mfma_f32_16x16x32_bf16 v[112:115], a[132:135], a[20:23], v[112:115]
buffer_load_dwordx4 v13, s[8:11], s24 offen offset:1024 lds
v_mfma_f32_16x16x32_bf16 v[120:123], a[128:131], a[24:27], v[120:123]
ds_read_b64_tr_b16 a[142:143], v7 offset:18432
v_mfma_f32_16x16x32_bf16 v[120:123], a[132:135], a[28:31], v[120:123]
v_mfma_f32_16x16x32_bf16 v[128:131], a[128:131], a[32:35], v[128:131]
v_mfma_f32_16x16x32_bf16 v[128:131], a[132:135], a[36:39], v[128:131]
buffer_load_dwordx4 v14, s[8:11], s24 offen offset:2048 lds
v_mfma_f32_16x16x32_bf16 v[136:139], a[128:131], a[40:43], v[136:139]
ds_read_b128 a[88:91], v2 offset:38912
v_mfma_f32_16x16x32_bf16 v[136:139], a[132:135], a[44:47], v[136:139]
v_mfma_f32_16x16x32_bf16 v[144:147], a[128:131], a[48:51], v[144:147]
ds_read_b128 a[92:95], v3 offset:38912
v_mfma_f32_16x16x32_bf16 v[144:147], a[132:135], a[52:55], v[144:147]
buffer_load_dwordx4 v15, s[8:11], s24 offen offset:3072 lds
v_mfma_f32_16x16x32_bf16 v[152:155], a[128:131], a[56:59], v[152:155]
s_add_u32 s24, s24, 128
v_mfma_f32_16x16x32_bf16 v[152:155], a[132:135], a[60:63], v[152:155]
s_waitcnt lgkmcnt(2)
s_sub_u32 s26, s26, 8388608
v_mfma_f32_16x16x32_bf16 v[100:103], a[136:139], a[0:3], v[100:103]
s_sub_u32 s27, s27, 8388608
s_add_u32 m0, s29, 131072
ds_read_b64_tr_b16 a[128:129], v8 offset:0
v_mfma_f32_16x16x32_bf16 v[100:103], a[140:143], a[4:7], v[100:103]
buffer_load_dwordx4 v16, s[12:15], s26 offen offset:0 lds
v_mfma_f32_16x16x32_bf16 v[108:111], a[136:139], a[8:11], v[108:111]
ds_read_b64_tr_b16 a[130:131], v8 offset:2048
v_mfma_f32_16x16x32_bf16 v[108:111], a[140:143], a[12:15], v[108:111]
v_mfma_f32_16x16x32_bf16 v[116:119], a[136:139], a[16:19], v[116:119]
ds_read_b64_tr_b16 a[132:133], v8 offset:16384
v_mfma_f32_16x16x32_bf16 v[116:119], a[140:143], a[20:23], v[116:119]
buffer_load_dwordx4 v17, s[12:15], s26 offen offset:1024 lds
v_mfma_f32_16x16x32_bf16 v[124:127], a[136:139], a[24:27], v[124:127]
ds_read_b64_tr_b16 a[134:135], v8 offset:18432
v_mfma_f32_16x16x32_bf16 v[124:127], a[140:143], a[28:31], v[124:127]
v_mfma_f32_16x16x32_bf16 v[132:135], a[136:139], a[32:35], v[132:135]
ds_read_b128 a[96:99], v2 offset:40960
v_mfma_f32_16x16x32_bf16 v[132:135], a[140:143], a[36:39], v[132:135]
buffer_load_dwordx4 v18, s[12:15], s26 offen offset:2048 lds
v_mfma_f32_16x16x32_bf16 v[140:143], a[136:139], a[40:43], v[140:143]
v_mfma_f32_16x16x32_bf16 v[140:143], a[140:143], a[44:47], v[140:143]
v_mfma_f32_16x16x32_bf16 v[148:151], a[136:139], a[48:51], v[148:151]
ds_read_b128 a[100:103], v3 offset:40960
v_mfma_f32_16x16x32_bf16 v[148:151], a[140:143], a[52:55], v[148:151]
buffer_load_dwordx4 v19, s[12:15], s26 offen offset:3072 lds
v_mfma_f32_16x16x32_bf16 v[156:159], a[136:139], a[56:59], v[156:159]
s_add_u32 s26, s26, 524288
ds_read_b128 a[104:107], v2 offset:43008
v_mfma_f32_16x16x32_bf16 v[156:159], a[140:143], a[60:63], v[156:159]
s_waitcnt lgkmcnt(5)
v_mfma_f32_16x16x32_bf16 v[160:163], a[128:131], a[0:3], v[160:163]
s_waitcnt lgkmcnt(3)
s_add_u32 m0, s29, 147456
ds_read_b64_tr_b16 a[136:137], v9 offset:0
v_mfma_f32_16x16x32_bf16 v[160:163], a[132:135], a[4:7], v[160:163]
buffer_load_dwordx4 v16, s[12:15], s27 offen offset:0 lds
v_mfma_f32_16x16x32_bf16 v[168:171], a[128:131], a[8:11], v[168:171]
ds_read_b64_tr_b16 a[138:139], v9 offset:2048
v_mfma_f32_16x16x32_bf16 v[168:171], a[132:135], a[12:15], v[168:171]
v_mfma_f32_16x16x32_bf16 v[176:179], a[128:131], a[16:19], v[176:179]
ds_read_b64_tr_b16 a[140:141], v9 offset:16384
v_mfma_f32_16x16x32_bf16 v[176:179], a[132:135], a[20:23], v[176:179]
buffer_load_dwordx4 v17, s[12:15], s27 offen offset:1024 lds
v_mfma_f32_16x16x32_bf16 v[184:187], a[128:131], a[24:27], v[184:187]
ds_read_b64_tr_b16 a[142:143], v9 offset:18432
v_mfma_f32_16x16x32_bf16 v[184:187], a[132:135], a[28:31], v[184:187]
v_mfma_f32_16x16x32_bf16 v[192:195], a[128:131], a[32:35], v[192:195]
v_mfma_f32_16x16x32_bf16 v[192:195], a[132:135], a[36:39], v[192:195]
buffer_load_dwordx4 v18, s[12:15], s27 offen offset:2048 lds
v_mfma_f32_16x16x32_bf16 v[200:203], a[128:131], a[40:43], v[200:203]
ds_read_b128 a[108:111], v3 offset:43008
v_mfma_f32_16x16x32_bf16 v[200:203], a[132:135], a[44:47], v[200:203]
v_mfma_f32_16x16x32_bf16 v[208:211], a[128:131], a[48:51], v[208:211]
ds_read_b128 a[112:115], v2 offset:45056
v_mfma_f32_16x16x32_bf16 v[208:211], a[132:135], a[52:55], v[208:211]
buffer_load_dwordx4 v19, s[12:15], s27 offen offset:3072 lds
v_mfma_f32_16x16x32_bf16 v[216:219], a[128:131], a[56:59], v[216:219]
s_add_u32 s27, s27, 524288
v_mfma_f32_16x16x32_bf16 v[216:219], a[132:135], a[60:63], v[216:219]
s_waitcnt lgkmcnt(4)
v_mfma_f32_16x16x32_bf16 v[164:167], a[136:139], a[0:3], v[164:167]
s_waitcnt lgkmcnt(2)
ds_read_b64_tr_b16 a[128:129], v10 offset:0
v_mfma_f32_16x16x32_bf16 v[164:167], a[140:143], a[4:7], v[164:167]
v_mfma_f32_16x16x32_bf16 v[172:175], a[136:139], a[8:11], v[172:175]
ds_read_b64_tr_b16 a[130:131], v10 offset:2048
v_mfma_f32_16x16x32_bf16 v[172:175], a[140:143], a[12:15], v[172:175]
v_mfma_f32_16x16x32_bf16 v[180:183], a[136:139], a[16:19], v[180:183]
ds_read_b64_tr_b16 a[132:133], v10 offset:16384
v_mfma_f32_16x16x32_bf16 v[180:183], a[140:143], a[20:23], v[180:183]
v_mfma_f32_16x16x32_bf16 v[188:191], a[136:139], a[24:27], v[188:191]
ds_read_b64_tr_b16 a[134:135], v10 offset:18432
v_mfma_f32_16x16x32_bf16 v[188:191], a[140:143], a[28:31], v[188:191]
v_mfma_f32_16x16x32_bf16 v[196:199], a[136:139], a[32:35], v[196:199]
ds_read_b128 a[116:119], v3 offset:45056
v_mfma_f32_16x16x32_bf16 v[196:199], a[140:143], a[36:39], v[196:199]
v_mfma_f32_16x16x32_bf16 v[204:207], a[136:139], a[40:43], v[204:207]
ds_read_b128 a[120:123], v2 offset:47104
v_mfma_f32_16x16x32_bf16 v[204:207], a[140:143], a[44:47], v[204:207]
v_mfma_f32_16x16x32_bf16 v[212:215], a[136:139], a[48:51], v[212:215]
v_mfma_f32_16x16x32_bf16 v[212:215], a[140:143], a[52:55], v[212:215]
v_mfma_f32_16x16x32_bf16 v[220:223], a[136:139], a[56:59], v[220:223]
ds_read_b128 a[124:127], v3 offset:47104
v_mfma_f32_16x16x32_bf16 v[220:223], a[140:143], a[60:63], v[220:223]
s_waitcnt lgkmcnt(5)
v_mfma_f32_16x16x32_bf16 a[192:195], a[128:131], a[0:3], a[192:195]
s_waitcnt lgkmcnt(3)
ds_read_b64_tr_b16 a[136:137], v11 offset:0
v_mfma_f32_16x16x32_bf16 a[192:195], a[132:135], a[4:7], a[192:195]
v_mfma_f32_16x16x32_bf16 a[200:203], a[128:131], a[8:11], a[200:203]
ds_read_b64_tr_b16 a[138:139], v11 offset:2048
v_mfma_f32_16x16x32_bf16 a[200:203], a[132:135], a[12:15], a[200:203]
v_mfma_f32_16x16x32_bf16 a[208:211], a[128:131], a[16:19], a[208:211]
ds_read_b64_tr_b16 a[140:141], v11 offset:16384
v_mfma_f32_16x16x32_bf16 a[208:211], a[132:135], a[20:23], a[208:211]
v_mfma_f32_16x16x32_bf16 a[216:219], a[128:131], a[24:27], a[216:219]
ds_read_b64_tr_b16 a[142:143], v11 offset:18432
v_mfma_f32_16x16x32_bf16 a[216:219], a[132:135], a[28:31], a[216:219]
v_mfma_f32_16x16x32_bf16 a[224:227], a[128:131], a[32:35], a[224:227]
v_mfma_f32_16x16x32_bf16 a[224:227], a[132:135], a[36:39], a[224:227]
v_mfma_f32_16x16x32_bf16 a[232:235], a[128:131], a[40:43], a[232:235]
v_mfma_f32_16x16x32_bf16 a[232:235], a[132:135], a[44:47], a[232:235]
v_mfma_f32_16x16x32_bf16 a[240:243], a[128:131], a[48:51], a[240:243]
v_mfma_f32_16x16x32_bf16 a[240:243], a[132:135], a[52:55], a[240:243]
v_mfma_f32_16x16x32_bf16 a[248:251], a[128:131], a[56:59], a[248:251]
v_mfma_f32_16x16x32_bf16 a[248:251], a[132:135], a[60:63], a[248:251]
s_waitcnt vmcnt(12) lgkmcnt(0)
s_barrier
v_mfma_f32_16x16x32_bf16 a[196:199], a[136:139], a[0:3], a[196:199]
s_add_u32 m0, s28, 32768
ds_read_b64_tr_b16 a[128:129], v4 offset:32768
v_mfma_f32_16x16x32_bf16 a[196:199], a[140:143], a[4:7], a[196:199]
s_lshr_b32 s22, s3, 1
buffer_load_dwordx4 v12, s[8:11], s24 offen offset:0 lds
v_mfma_f32_16x16x32_bf16 a[204:207], a[136:139], a[8:11], a[204:207]
s_lshl_b32 s22, s22, 14
ds_read_b64_tr_b16 a[130:131], v4 offset:34816
v_subrev_u32 v2, s22, v2
v_mfma_f32_16x16x32_bf16 a[204:207], a[140:143], a[12:15], a[204:207]
v_subrev_u32 v3, s22, v3
v_mfma_f32_16x16x32_bf16 a[212:215], a[136:139], a[16:19], a[212:215]
ds_read_b64_tr_b16 a[132:133], v4 offset:49152
v_mfma_f32_16x16x32_bf16 a[212:215], a[140:143], a[20:23], a[212:215]
buffer_load_dwordx4 v13, s[8:11], s24 offen offset:1024 lds
v_mfma_f32_16x16x32_bf16 a[220:223], a[136:139], a[24:27], a[220:223]
ds_read_b64_tr_b16 a[134:135], v4 offset:51200
v_mfma_f32_16x16x32_bf16 a[220:223], a[140:143], a[28:31], a[220:223]
v_mfma_f32_16x16x32_bf16 a[228:231], a[136:139], a[32:35], a[228:231]
v_mfma_f32_16x16x32_bf16 a[228:231], a[140:143], a[36:39], a[228:231]
buffer_load_dwordx4 v14, s[8:11], s24 offen offset:2048 lds
v_mfma_f32_16x16x32_bf16 a[236:239], a[136:139], a[40:43], a[236:239]
v_mfma_f32_16x16x32_bf16 a[236:239], a[140:143], a[44:47], a[236:239]
v_mfma_f32_16x16x32_bf16 a[244:247], a[136:139], a[48:51], a[244:247]
v_mfma_f32_16x16x32_bf16 a[244:247], a[140:143], a[52:55], a[244:247]
buffer_load_dwordx4 v15, s[8:11], s24 offen offset:3072 lds
v_mfma_f32_16x16x32_bf16 a[252:255], a[136:139], a[56:59], a[252:255]
s_add_u32 s24, s24, 128
v_mfma_f32_16x16x32_bf16 a[252:255], a[140:143], a[60:63], a[252:255]
s_waitcnt lgkmcnt(2)
v_mfma_f32_16x16x32_bf16 v[32:35], a[128:131], a[64:67], v[32:35]
s_waitcnt lgkmcnt(0)
s_add_u32 m0, s29, 65536
ds_read_b64_tr_b16 a[136:137], v5 offset:32768
v_mfma_f32_16x16x32_bf16 v[32:35], a[132:135], a[68:71], v[32:35]
buffer_load_dwordx4 v16, s[12:15], s26 offen offset:0 lds
v_mfma_f32_16x16x32_bf16 v[40:43], a[128:131], a[72:75], v[40:43]
ds_read_b64_tr_b16 a[138:139], v5 offset:34816
v_mfma_f32_16x16x32_bf16 v[40:43], a[132:135], a[76:79], v[40:43]
v_mfma_f32_16x16x32_bf16 v[48:51], a[128:131], a[80:83], v[48:51]
ds_read_b64_tr_b16 a[140:141], v5 offset:49152
v_mfma_f32_16x16x32_bf16 v[48:51], a[132:135], a[84:87], v[48:51]
buffer_load_dwordx4 v17, s[12:15], s26 offen offset:1024 lds
v_mfma_f32_16x16x32_bf16 v[56:59], a[128:131], a[88:91], v[56:59]
ds_read_b64_tr_b16 a[142:143], v5 offset:51200
v_mfma_f32_16x16x32_bf16 v[56:59], a[132:135], a[92:95], v[56:59]
v_mfma_f32_16x16x32_bf16 v[64:67], a[128:131], a[96:99], v[64:67]
ds_read_b128 a[0:3], v2 offset:0
v_mfma_f32_16x16x32_bf16 v[64:67], a[132:135], a[100:103], v[64:67]
buffer_load_dwordx4 v18, s[12:15], s26 offen offset:2048 lds
v_mfma_f32_16x16x32_bf16 v[72:75], a[128:131], a[104:107], v[72:75]
ds_read_b128 a[4:7], v3 offset:0
v_mfma_f32_16x16x32_bf16 v[72:75], a[132:135], a[108:111], v[72:75]
v_mfma_f32_16x16x32_bf16 v[80:83], a[128:131], a[112:115], v[80:83]
v_mfma_f32_16x16x32_bf16 v[80:83], a[132:135], a[116:119], v[80:83]
buffer_load_dwordx4 v19, s[12:15], s26 offen offset:3072 lds
v_mfma_f32_16x16x32_bf16 v[88:91], a[128:131], a[120:123], v[88:91]
s_add_u32 s26, s26, 524288
ds_read_b128 a[8:11], v2 offset:2048
v_mfma_f32_16x16x32_bf16 v[88:91], a[132:135], a[124:127], v[88:91]
s_waitcnt lgkmcnt(5)
v_mfma_f32_16x16x32_bf16 v[36:39], a[136:139], a[64:67], v[36:39]
s_waitcnt lgkmcnt(3)
s_add_u32 m0, s29, 81920
ds_read_b64_tr_b16 a[128:129], v6 offset:32768
v_mfma_f32_16x16x32_bf16 v[36:39], a[140:143], a[68:71], v[36:39]
buffer_load_dwordx4 v16, s[12:15], s27 offen offset:0 lds
v_mfma_f32_16x16x32_bf16 v[44:47], a[136:139], a[72:75], v[44:47]
ds_read_b64_tr_b16 a[130:131], v6 offset:34816
v_mfma_f32_16x16x32_bf16 v[44:47], a[140:143], a[76:79], v[44:47]
v_mfma_f32_16x16x32_bf16 v[52:55], a[136:139], a[80:83], v[52:55]
ds_read_b64_tr_b16 a[132:133], v6 offset:49152
v_mfma_f32_16x16x32_bf16 v[52:55], a[140:143], a[84:87], v[52:55]
buffer_load_dwordx4 v17, s[12:15], s27 offen offset:1024 lds
v_mfma_f32_16x16x32_bf16 v[60:63], a[136:139], a[88:91], v[60:63]
ds_read_b64_tr_b16 a[134:135], v6 offset:51200
v_cvt_pk_bf16_f32 v32, v32, v33
v_mfma_f32_16x16x32_bf16 v[60:63], a[140:143], a[92:95], v[60:63]
v_cvt_pk_bf16_f32 v33, v34, v35
v_cvt_pk_bf16_f32 v34, v36, v37
v_mfma_f32_16x16x32_bf16 v[68:71], a[136:139], a[96:99], v[68:71]
ds_read_b128 a[12:15], v3 offset:2048
v_cvt_pk_bf16_f32 v35, v38, v39
v_mfma_f32_16x16x32_bf16 v[68:71], a[140:143], a[100:103], v[68:71]
buffer_load_dwordx4 v18, s[12:15], s27 offen offset:2048 lds
v_mfma_f32_16x16x32_bf16 v[76:79], a[136:139], a[104:107], v[76:79]
v_cvt_pk_bf16_f32 v40, v40, v41
v_cvt_pk_bf16_f32 v41, v42, v43
v_mfma_f32_16x16x32_bf16 v[76:79], a[140:143], a[108:111], v[76:79]
v_cvt_pk_bf16_f32 v42, v44, v45
v_cvt_pk_bf16_f32 v43, v46, v47
v_mfma_f32_16x16x32_bf16 v[84:87], a[136:139], a[112:115], v[84:87]
ds_read_b128 a[16:19], v2 offset:4096
v_cvt_pk_bf16_f32 v48, v48, v49
v_mfma_f32_16x16x32_bf16 v[84:87], a[140:143], a[116:119], v[84:87]
buffer_load_dwordx4 v19, s[12:15], s27 offen offset:3072 lds
v_mfma_f32_16x16x32_bf16 v[92:95], a[136:139], a[120:123], v[92:95]
s_add_u32 s27, s27, 524288
ds_read_b128 a[20:23], v3 offset:4096
v_cvt_pk_bf16_f32 v49, v50, v51
v_mfma_f32_16x16x32_bf16 v[92:95], a[140:143], a[124:127], v[92:95]
s_waitcnt lgkmcnt(3)
v_cvt_pk_bf16_f32 v50, v52, v53
v_cvt_pk_bf16_f32 v51, v54, v55
v_mfma_f32_16x16x32_bf16 v[96:99], a[128:131], a[64:67], v[96:99]
s_add_u32 m0, s28, 49152
ds_read_b64_tr_b16 a[136:137], v7 offset:32768
v_cvt_pk_bf16_f32 v56, v56, v57
v_mfma_f32_16x16x32_bf16 v[96:99], a[132:135], a[68:71], v[96:99]
buffer_load_dwordx4 v12, s[8:11], s24 offen offset:0 lds
v_mfma_f32_16x16x32_bf16 v[104:107], a[128:131], a[72:75], v[104:107]
ds_read_b64_tr_b16 a[138:139], v7 offset:34816
v_cvt_pk_bf16_f32 v57, v58, v59
v_mfma_f32_16x16x32_bf16 v[104:107], a[132:135], a[76:79], v[104:107]
v_cvt_pk_bf16_f32 v58, v60, v61
v_cvt_pk_bf16_f32 v59, v62, v63
v_mfma_f32_16x16x32_bf16 v[112:115], a[128:131], a[80:83], v[112:115]
ds_read_b64_tr_b16 a[140:141], v7 offset:49152
v_cvt_pk_bf16_f32 v64, v64, v65
v_mfma_f32_16x16x32_bf16 v[112:115], a[132:135], a[84:87], v[112:115]
buffer_load_dwordx4 v13, s[8:11], s24 offen offset:1024 lds
v_mfma_f32_16x16x32_bf16 v[120:123], a[128:131], a[88:91], v[120:123]
ds_read_b64_tr_b16 a[142:143], v7 offset:51200
v_cvt_pk_bf16_f32 v65, v66, v67
v_mfma_f32_16x16x32_bf16 v[120:123], a[132:135], a[92:95], v[120:123]
v_cvt_pk_bf16_f32 v66, v68, v69
v_cvt_pk_bf16_f32 v67, v70, v71
v_mfma_f32_16x16x32_bf16 v[128:131], a[128:131], a[96:99], v[128:131]
v_cvt_pk_bf16_f32 v72, v72, v73
v_cvt_pk_bf16_f32 v73, v74, v75
v_mfma_f32_16x16x32_bf16 v[128:131], a[132:135], a[100:103], v[128:131]
buffer_load_dwordx4 v14, s[8:11], s24 offen offset:2048 lds
v_mfma_f32_16x16x32_bf16 v[136:139], a[128:131], a[104:107], v[136:139]
ds_read_b128 a[24:27], v2 offset:6144
v_cvt_pk_bf16_f32 v74, v76, v77
v_mfma_f32_16x16x32_bf16 v[136:139], a[132:135], a[108:111], v[136:139]
buffer_store_dwordx4 v[32:35], v1, s[4:7], s31 offen sc1
v_mfma_f32_16x16x32_bf16 v[144:147], a[128:131], a[112:115], v[144:147]
s_add_u32 s31, s31, s32
ds_read_b128 a[28:31], v3 offset:6144
v_cvt_pk_bf16_f32 v75, v78, v79
v_mfma_f32_16x16x32_bf16 v[144:147], a[132:135], a[116:119], v[144:147]
buffer_load_dwordx4 v15, s[8:11], s24 offen offset:3072 lds
v_mfma_f32_16x16x32_bf16 v[152:155], a[128:131], a[120:123], v[152:155]
s_add_u32 s24, s24, 128
v_cvt_pk_bf16_f32 v80, v80, v81
v_cvt_pk_bf16_f32 v81, v82, v83
v_mfma_f32_16x16x32_bf16 v[152:155], a[132:135], a[124:127], v[152:155]
s_waitcnt lgkmcnt(4)
v_cvt_pk_bf16_f32 v82, v84, v85
v_cvt_pk_bf16_f32 v83, v86, v87
v_mfma_f32_16x16x32_bf16 v[100:103], a[136:139], a[64:67], v[100:103]
s_waitcnt lgkmcnt(2)
ds_read_b64_tr_b16 a[128:129], v8 offset:32768
v_cvt_pk_bf16_f32 v88, v88, v89
v_mfma_f32_16x16x32_bf16 v[100:103], a[140:143], a[68:71], v[100:103]
v_cvt_pk_bf16_f32 v89, v90, v91
v_cvt_pk_bf16_f32 v90, v92, v93
v_mfma_f32_16x16x32_bf16 v[108:111], a[136:139], a[72:75], v[108:111]
ds_read_b64_tr_b16 a[130:131], v8 offset:34816
v_cvt_pk_bf16_f32 v91, v94, v95
v_mfma_f32_16x16x32_bf16 v[108:111], a[140:143], a[76:79], v[108:111]
buffer_store_dwordx4 v[40:43], v1, s[4:7], s31 offen sc1
v_mfma_f32_16x16x32_bf16 v[116:119], a[136:139], a[80:83], v[116:119]
s_add_u32 s31, s31, s33
ds_read_b64_tr_b16 a[132:133], v8 offset:49152
v_mfma_f32_16x16x32_bf16 v[116:119], a[140:143], a[84:87], v[116:119]
v_mfma_f32_16x16x32_bf16 v[124:127], a[136:139], a[88:91], v[124:127]
ds_read_b64_tr_b16 a[134:135], v8 offset:51200
v_cvt_pk_bf16_f32 v96, v96, v97
v_mfma_f32_16x16x32_bf16 v[124:127], a[140:143], a[92:95], v[124:127]
v_cvt_pk_bf16_f32 v97, v98, v99
v_cvt_pk_bf16_f32 v98, v100, v101
v_mfma_f32_16x16x32_bf16 v[132:135], a[136:139], a[96:99], v[132:135]
ds_read_b128 a[32:35], v2 offset:8192
v_cvt_pk_bf16_f32 v99, v102, v103
v_mfma_f32_16x16x32_bf16 v[132:135], a[140:143], a[100:103], v[132:135]
v_cvt_pk_bf16_f32 v104, v104, v105
v_cvt_pk_bf16_f32 v105, v106, v107
v_mfma_f32_16x16x32_bf16 v[140:143], a[136:139], a[104:107], v[140:143]
v_cvt_pk_bf16_f32 v106, v108, v109
v_cvt_pk_bf16_f32 v107, v110, v111
v_mfma_f32_16x16x32_bf16 v[140:143], a[140:143], a[108:111], v[140:143]
v_cvt_pk_bf16_f32 v112, v112, v113
v_cvt_pk_bf16_f32 v113, v114, v115
v_mfma_f32_16x16x32_bf16 v[148:151], a[136:139], a[112:115], v[148:151]
ds_read_b128 a[36:39], v3 offset:8192
v_cvt_pk_bf16_f32 v114, v116, v117
v_mfma_f32_16x16x32_bf16 v[148:151], a[140:143], a[116:119], v[148:151]
v_cvt_pk_bf16_f32 v115, v118, v119
v_cvt_pk_bf16_f32 v120, v120, v121
v_mfma_f32_16x16x32_bf16 v[156:159], a[136:139], a[120:123], v[156:159]
ds_read_b128 a[40:43], v2 offset:10240
v_cvt_pk_bf16_f32 v121, v122, v123
v_mfma_f32_16x16x32_bf16 v[156:159], a[140:143], a[124:127], v[156:159]
s_waitcnt lgkmcnt(3)
buffer_store_dwordx4 v[48:51], v1, s[4:7], s31 offen sc1
v_mfma_f32_16x16x32_bf16 v[160:163], a[128:131], a[64:67], v[160:163]
s_add_u32 s31, s31, s32
ds_read_b64_tr_b16 a[136:137], v9 offset:32768
v_cvt_pk_bf16_f32 v122, v124, v125
v_mfma_f32_16x16x32_bf16 v[160:163], a[132:135], a[68:71], v[160:163]
v_cvt_pk_bf16_f32 v123, v126, v127
v_cvt_pk_bf16_f32 v128, v128, v129
v_mfma_f32_16x16x32_bf16 v[168:171], a[128:131], a[72:75], v[168:171]
ds_read_b64_tr_b16 a[138:139], v9 offset:34816
v_cvt_pk_bf16_f32 v129, v130, v131
v_mfma_f32_16x16x32_bf16 v[168:171], a[132:135], a[76:79], v[168:171]
v_cvt_pk_bf16_f32 v130, v132, v133
v_cvt_pk_bf16_f32 v131, v134, v135
v_mfma_f32_16x16x32_bf16 v[176:179], a[128:131], a[80:83], v[176:179]
ds_read_b64_tr_b16 a[140:141], v9 offset:49152
v_cvt_pk_bf16_f32 v136, v136, v137
v_mfma_f32_16x16x32_bf16 v[176:179], a[132:135], a[84:87], v[176:179]
v_cvt_pk_bf16_f32 v137, v138, v139
v_cvt_pk_bf16_f32 v138, v140, v141
v_mfma_f32_16x16x32_bf16 v[184:187], a[128:131], a[88:91], v[184:187]
ds_read_b64_tr_b16 a[142:143], v9 offset:51200
v_cvt_pk_bf16_f32 v139, v142, v143
v_mfma_f32_16x16x32_bf16 v[184:187], a[132:135], a[92:95], v[184:187]
v_cvt_pk_bf16_f32 v144, v144, v145
v_cvt_pk_bf16_f32 v145, v146, v147
v_mfma_f32_16x16x32_bf16 v[192:195], a[128:131], a[96:99], v[192:195]
buffer_store_dwordx4 v[56:59], v1, s[4:7], s31 offen sc1
v_mfma_f32_16x16x32_bf16 v[192:195], a[132:135], a[100:103], v[192:195]
s_add_u32 s31, s31, s34
v_cvt_pk_bf16_f32 v146, v148, v149
v_cvt_pk_bf16_f32 v147, v150, v151
v_mfma_f32_16x16x32_bf16 v[200:203], a[128:131], a[104:107], v[200:203]
ds_read_b128 a[44:47], v3 offset:10240
v_cvt_pk_bf16_f32 v152, v152, v153
v_mfma_f32_16x16x32_bf16 v[200:203], a[132:135], a[108:111], v[200:203]
v_cvt_pk_bf16_f32 v153, v154, v155
v_cvt_pk_bf16_f32 v154, v156, v157
v_mfma_f32_16x16x32_bf16 v[208:211], a[128:131], a[112:115], v[208:211]
ds_read_b128 a[48:51], v2 offset:12288
v_cvt_pk_bf16_f32 v155, v158, v159
v_mfma_f32_16x16x32_bf16 v[208:211], a[132:135], a[116:119], v[208:211]
v_mfma_f32_16x16x32_bf16 v[216:219], a[128:131], a[120:123], v[216:219]
v_mfma_f32_16x16x32_bf16 v[216:219], a[132:135], a[124:127], v[216:219]
s_waitcnt lgkmcnt(4)
v_mfma_f32_16x16x32_bf16 v[164:167], a[136:139], a[64:67], v[164:167]
s_waitcnt lgkmcnt(2)
ds_read_b64_tr_b16 a[128:129], v10 offset:32768
v_mfma_f32_16x16x32_bf16 v[164:167], a[140:143], a[68:71], v[164:167]
v_mfma_f32_16x16x32_bf16 v[172:175], a[136:139], a[72:75], v[172:175]
ds_read_b64_tr_b16 a[130:131], v10 offset:34816
v_mfma_f32_16x16x32_bf16 v[172:175], a[140:143], a[76:79], v[172:175]
buffer_store_dwordx4 v[64:67], v1, s[4:7], s31 offen sc1
v_mfma_f32_16x16x32_bf16 v[180:183], a[136:139], a[80:83], v[180:183]
s_add_u32 s31, s31, s32
ds_read_b64_tr_b16 a[132:133], v10 offset:49152
v_mfma_f32_16x16x32_bf16 v[180:183], a[140:143], a[84:87], v[180:183]
v_mfma_f32_16x16x32_bf16 v[188:191], a[136:139], a[88:91], v[188:191]
ds_read_b64_tr_b16 a[134:135], v10 offset:51200
v_cvt_pk_bf16_f32 v160, v160, v161
v_mfma_f32_16x16x32_bf16 v[188:191], a[140:143], a[92:95], v[188:191]
v_cvt_pk_bf16_f32 v161, v162, v163
v_cvt_pk_bf16_f32 v162, v164, v165
v_mfma_f32_16x16x32_bf16 v[196:199], a[136:139], a[96:99], v[196:199]
ds_read_b128 a[52:55], v3 offset:12288
v_cvt_pk_bf16_f32 v163, v166, v167
v_mfma_f32_16x16x32_bf16 v[196:199], a[140:143], a[100:103], v[196:199]
v_cvt_pk_bf16_f32 v168, v168, v169
v_cvt_pk_bf16_f32 v169, v170, v171
v_mfma_f32_16x16x32_bf16 v[204:207], a[136:139], a[104:107], v[204:207]
ds_read_b128 a[56:59], v2 offset:14336
v_cvt_pk_bf16_f32 v170, v172, v173
v_mfma_f32_16x16x32_bf16 v[204:207], a[140:143], a[108:111], v[204:207]
v_cvt_pk_bf16_f32 v171, v174, v175
v_cvt_pk_bf16_f32 v176, v176, v177
v_mfma_f32_16x16x32_bf16 v[212:215], a[136:139], a[112:115], v[212:215]
v_cvt_pk_bf16_f32 v177, v178, v179
v_cvt_pk_bf16_f32 v178, v180, v181
v_mfma_f32_16x16x32_bf16 v[212:215], a[140:143], a[116:119], v[212:215]
buffer_store_dwordx4 v[72:75], v1, s[4:7], s31 offen sc1
v_mfma_f32_16x16x32_bf16 v[220:223], a[136:139], a[120:123], v[220:223]
s_add_u32 s31, s31, s33
ds_read_b128 a[60:63], v3 offset:14336
v_cvt_pk_bf16_f32 v179, v182, v183
v_mfma_f32_16x16x32_bf16 v[220:223], a[140:143], a[124:127], v[220:223]
s_waitcnt lgkmcnt(5)
v_cvt_pk_bf16_f32 v184, v184, v185
v_cvt_pk_bf16_f32 v185, v186, v187
v_mfma_f32_16x16x32_bf16 a[192:195], a[128:131], a[64:67], a[192:195]
s_waitcnt lgkmcnt(3)
ds_read_b64_tr_b16 a[136:137], v11 offset:32768
v_cvt_pk_bf16_f32 v186, v188, v189
v_mfma_f32_16x16x32_bf16 a[192:195], a[132:135], a[68:71], a[192:195]
v_cvt_pk_bf16_f32 v187, v190, v191
v_cvt_pk_bf16_f32 v192, v192, v193
v_mfma_f32_16x16x32_bf16 a[200:203], a[128:131], a[72:75], a[200:203]
ds_read_b64_tr_b16 a[138:139], v11 offset:34816
v_cvt_pk_bf16_f32 v193, v194, v195
v_mfma_f32_16x16x32_bf16 a[200:203], a[132:135], a[76:79], a[200:203]
v_cvt_pk_bf16_f32 v194, v196, v197
v_cvt_pk_bf16_f32 v195, v198, v199
v_mfma_f32_16x16x32_bf16 a[208:211], a[128:131], a[80:83], a[208:211]
ds_read_b64_tr_b16 a[140:141], v11 offset:49152
v_cvt_pk_bf16_f32 v200, v200, v201
v_mfma_f32_16x16x32_bf16 a[208:211], a[132:135], a[84:87], a[208:211]
v_cvt_pk_bf16_f32 v201, v202, v203
v_cvt_pk_bf16_f32 v202, v204, v205
v_mfma_f32_16x16x32_bf16 a[216:219], a[128:131], a[88:91], a[216:219]
ds_read_b64_tr_b16 a[142:143], v11 offset:51200
v_cvt_pk_bf16_f32 v203, v206, v207
v_mfma_f32_16x16x32_bf16 a[216:219], a[132:135], a[92:95], a[216:219]
v_cvt_pk_bf16_f32 v208, v208, v209
v_cvt_pk_bf16_f32 v209, v210, v211
v_mfma_f32_16x16x32_bf16 a[224:227], a[128:131], a[96:99], a[224:227]
buffer_store_dwordx4 v[80:83], v1, s[4:7], s31 offen sc1
v_mfma_f32_16x16x32_bf16 a[224:227], a[132:135], a[100:103], a[224:227]
s_add_u32 s31, s31, s32
v_cvt_pk_bf16_f32 v210, v212, v213
v_cvt_pk_bf16_f32 v211, v214, v215
v_mfma_f32_16x16x32_bf16 a[232:235], a[128:131], a[104:107], a[232:235]
v_cvt_pk_bf16_f32 v216, v216, v217
v_cvt_pk_bf16_f32 v217, v218, v219
v_mfma_f32_16x16x32_bf16 a[232:235], a[132:135], a[108:111], a[232:235]
v_cvt_pk_bf16_f32 v218, v220, v221
v_cvt_pk_bf16_f32 v219, v222, v223
v_mfma_f32_16x16x32_bf16 a[240:243], a[128:131], a[112:115], a[240:243]
v_mfma_f32_16x16x32_bf16 a[240:243], a[132:135], a[116:119], a[240:243]
v_mfma_f32_16x16x32_bf16 a[248:251], a[128:131], a[120:123], a[248:251]
v_mfma_f32_16x16x32_bf16 a[248:251], a[132:135], a[124:127], a[248:251]
s_waitcnt vmcnt(23) lgkmcnt(0)
s_barrier
v_mfma_f32_16x16x32_bf16 a[196:199], a[136:139], a[64:67], a[196:199]
s_add_u32 m0, s29, 98304
ds_read_b64_tr_b16 a[128:129], v22 offset:0
v_mfma_f32_16x16x32_bf16 a[196:199], a[140:143], a[68:71], a[196:199]
buffer_load_dwordx4 v16, s[12:15], s26 offen offset:0 lds
v_mfma_f32_16x16x32_bf16 a[204:207], a[136:139], a[72:75], a[204:207]
ds_read_b64_tr_b16 a[130:131], v22 offset:2048
v_mfma_f32_16x16x32_bf16 a[204:207], a[140:143], a[76:79], a[204:207]
buffer_store_dwordx4 v[88:91], v1, s[4:7], s31 offen sc1
v_mfma_f32_16x16x32_bf16 a[212:215], a[136:139], a[80:83], a[212:215]
s_add_u32 s31, s31, s35
ds_read_b64_tr_b16 a[132:133], v22 offset:16384
v_mfma_f32_16x16x32_bf16 a[212:215], a[140:143], a[84:87], a[212:215]
buffer_load_dwordx4 v17, s[12:15], s26 offen offset:1024 lds
v_mfma_f32_16x16x32_bf16 a[220:223], a[136:139], a[88:91], a[220:223]
ds_read_b64_tr_b16 a[134:135], v22 offset:18432
v_add_u32 v22, 4294901760, v22
v_mfma_f32_16x16x32_bf16 a[220:223], a[140:143], a[92:95], a[220:223]
v_mfma_f32_16x16x32_bf16 a[228:231], a[136:139], a[96:99], a[228:231]
v_mfma_f32_16x16x32_bf16 a[228:231], a[140:143], a[100:103], a[228:231]
buffer_load_dwordx4 v18, s[12:15], s26 offen offset:2048 lds
v_mfma_f32_16x16x32_bf16 a[236:239], a[136:139], a[104:107], a[236:239]
v_mfma_f32_16x16x32_bf16 a[236:239], a[140:143], a[108:111], a[236:239]
v_mfma_f32_16x16x32_bf16 a[244:247], a[136:139], a[112:115], a[244:247]
v_mfma_f32_16x16x32_bf16 a[244:247], a[140:143], a[116:119], a[244:247]
buffer_load_dwordx4 v19, s[12:15], s26 offen offset:3072 lds
v_mfma_f32_16x16x32_bf16 a[252:255], a[136:139], a[120:123], a[252:255]
s_add_u32 s26, s26, 524288
v_mfma_f32_16x16x32_bf16 a[252:255], a[140:143], a[124:127], a[252:255]
s_waitcnt lgkmcnt(2)
s_branch M_Q
M_V:
v_mfma_f32_16x16x32_bf16 v[32:35], a[0:3], a[128:131], 0
s_add_u32 m0, s29, 114688
ds_read_b64_tr_b16 a[136:137], v5 offset:0
v_mfma_f32_16x16x32_bf16 v[32:35], a[4:7], a[132:135], v[32:35]
s_mov_b32 s32, 1024
buffer_load_dwordx4 v16, s[12:15], s27 offen offset:0 lds
v_mfma_f32_16x16x32_bf16 v[36:39], a[8:11], a[128:131], 0
s_mov_b32 s33, 31744
ds_read_b64_tr_b16 a[138:139], v5 offset:2048
v_mfma_f32_16x16x32_bf16 v[36:39], a[12:15], a[132:135], v[36:39]
s_mov_b32 s34, 4294935552
v_mfma_f32_16x16x32_bf16 v[40:43], a[16:19], a[128:131], 0
s_mov_b32 s35, 4294935552
ds_read_b64_tr_b16 a[140:141], v5 offset:16384
v_mfma_f32_16x16x32_bf16 v[40:43], a[20:23], a[132:135], v[40:43]
s_mov_b32 s36, 4294935552
buffer_load_dwordx4 v17, s[12:15], s27 offen offset:1024 lds
v_mfma_f32_16x16x32_bf16 v[44:47], a[24:27], a[128:131], 0
s_mov_b32 s30, 8
ds_read_b64_tr_b16 a[142:143], v5 offset:18432
v_mfma_f32_16x16x32_bf16 v[44:47], a[28:31], a[132:135], v[44:47]
s_mov_b32 s82, 3221225472
v_mfma_f32_16x16x32_bf16 v[48:51], a[32:35], a[128:131], 0
s_mul_hi_u32 s38, s2, 613566757
v_mfma_f32_16x16x32_bf16 v[48:51], a[36:39], a[132:135], v[48:51]
s_mul_i32 s39, s38, 7
buffer_load_dwordx4 v18, s[12:15], s27 offen offset:2048 lds
v_mfma_f32_16x16x32_bf16 v[52:55], a[40:43], a[128:131], 0
s_sub_u32 s39, s2, s39
v_mov_b32 v246, 0
v_mov_b32 v229, 0
v_mfma_f32_16x16x32_bf16 v[52:55], a[44:47], a[132:135], v[52:55]
v_mov_b32 v231, 0
v_mfma_f32_16x16x32_bf16 v[56:59], a[48:51], a[128:131], 0
s_mov_b32 s60, s90
v_mfma_f32_16x16x32_bf16 v[56:59], a[52:55], a[132:135], v[56:59]
s_mov_b32 s61, s91
buffer_load_dwordx4 v19, s[12:15], s27 offen offset:3072 lds
v_mfma_f32_16x16x32_bf16 v[60:63], a[56:59], a[128:131], 0
s_add_u32 s27, s27, 524288
v_mfma_f32_16x16x32_bf16 v[60:63], a[60:63], a[132:135], v[60:63]
s_waitcnt lgkmcnt(2)
s_mov_b32 s62, 256
v_mfma_f32_16x16x32_bf16 v[64:67], a[0:3], a[136:139], 0
s_waitcnt lgkmcnt(0)
s_add_u32 m0, s28, 0
ds_read_b64_tr_b16 a[128:129], v6 offset:0
v_mfma_f32_16x16x32_bf16 v[64:67], a[4:7], a[140:143], v[64:67]
s_mov_b32 s63, 0x20000
buffer_load_dwordx4 v12, s[8:11], s24 offen offset:0 lds
v_mfma_f32_16x16x32_bf16 v[68:71], a[8:11], a[136:139], 0
s_mul_hi_u32 s55, s2, 1431655766
ds_read_b64_tr_b16 a[130:131], v6 offset:2048
v_mfma_f32_16x16x32_bf16 v[68:71], a[12:15], a[140:143], v[68:71]
s_mul_i32 s55, s55, 3
v_mfma_f32_16x16x32_bf16 v[72:75], a[16:19], a[136:139], 0
s_sub_u32 s55, s2, s55
ds_read_b64_tr_b16 a[132:133], v6 offset:16384
v_mfma_f32_16x16x32_bf16 v[72:75], a[20:23], a[140:143], v[72:75]
s_add_u32 s55, s55, 5
buffer_load_dwordx4 v13, s[8:11], s24 offen offset:1024 lds
v_mfma_f32_16x16x32_bf16 v[76:79], a[24:27], a[136:139], 0
s_lshr_b32 s22, s2, 4
ds_read_b64_tr_b16 a[134:135], v6 offset:18432
v_mfma_f32_16x16x32_bf16 v[76:79], a[28:31], a[140:143], v[76:79]
s_lshl_b32 s23, s20, 5
v_mfma_f32_16x16x32_bf16 v[80:83], a[32:35], a[136:139], 0
s_add_u32 s23, s23, s22
v_mfma_f32_16x16x32_bf16 v[80:83], a[36:39], a[140:143], v[80:83]
s_lshl_b32 s23, s23, 2
buffer_load_dwordx4 v14, s[8:11], s24 offen offset:2048 lds
v_mfma_f32_16x16x32_bf16 v[84:87], a[40:43], a[136:139], 0
s_and_b32 s22, s2, 16
v_mfma_f32_16x16x32_bf16 v[84:87], a[44:47], a[140:143], v[84:87]
s_lshl_b32 s22, s22, 7
v_mfma_f32_16x16x32_bf16 v[88:91], a[48:51], a[136:139], 0
s_add_u32 s23, s23, s22
v_mov_b32 v28, 3221225472
v_writelane_b32 v28, s23, 0
v_mfma_f32_16x16x32_bf16 v[88:91], a[52:55], a[140:143], v[88:91]
s_add_u32 s56, s23, 16384
buffer_load_dwordx4 v15, s[8:11], s24 offen offset:3072 lds
v_mfma_f32_16x16x32_bf16 v[92:95], a[56:59], a[136:139], 0
s_add_u32 s24, s24, 128
v_writelane_b32 v28, s56, 1
v_mfma_f32_16x16x32_bf16 v[92:95], a[60:63], a[140:143], v[92:95]
s_waitcnt lgkmcnt(2)
s_add_u32 s56, s23, 4096
v_writelane_b32 v28, s56, 2
v_mfma_f32_16x16x32_bf16 v[96:99], a[0:3], a[128:131], 0
s_waitcnt lgkmcnt(0)
s_add_u32 m0, s28, 4096
ds_read_b64_tr_b16 a[136:137], v7 offset:0
v_mfma_f32_16x16x32_bf16 v[96:99], a[4:7], a[132:135], v[96:99]
s_sub_u32 s37, 15, s21
buffer_load_dwordx4 v12, s[8:11], s25 offen offset:0 lds
v_mfma_f32_16x16x32_bf16 v[100:103], a[8:11], a[128:131], 0
ds_read_b64_tr_b16 a[138:139], v7 offset:2048
v_mfma_f32_16x16x32_bf16 v[100:103], a[12:15], a[132:135], v[100:103]
v_mfma_f32_16x16x32_bf16 v[104:107], a[16:19], a[128:131], 0
ds_read_b64_tr_b16 a[140:141], v7 offset:16384
v_mfma_f32_16x16x32_bf16 v[104:107], a[20:23], a[132:135], v[104:107]
buffer_load_dwordx4 v13, s[8:11], s25 offen offset:1024 lds
v_mfma_f32_16x16x32_bf16 v[108:111], a[24:27], a[128:131], 0
ds_read_b64_tr_b16 a[142:143], v7 offset:18432
v_mfma_f32_16x16x32_bf16 v[108:111], a[28:31], a[132:135], v[108:111]
v_mfma_f32_16x16x32_bf16 v[112:115], a[32:35], a[128:131], 0
v_mfma_f32_16x16x32_bf16 v[112:115], a[36:39], a[132:135], v[112:115]
buffer_load_dwordx4 v14, s[8:11], s25 offen offset:2048 lds
v_mfma_f32_16x16x32_bf16 v[116:119], a[40:43], a[128:131], 0
v_mfma_f32_16x16x32_bf16 v[116:119], a[44:47], a[132:135], v[116:119]
v_mfma_f32_16x16x32_bf16 v[120:123], a[48:51], a[128:131], 0
v_mfma_f32_16x16x32_bf16 v[120:123], a[52:55], a[132:135], v[120:123]
buffer_load_dwordx4 v15, s[8:11], s25 offen offset:3072 lds
v_mfma_f32_16x16x32_bf16 v[124:127], a[56:59], a[128:131], 0
s_add_u32 s25, s25, 128
v_mfma_f32_16x16x32_bf16 v[124:127], a[60:63], a[132:135], v[124:127]
s_waitcnt vmcnt(17) lgkmcnt(2)
s_barrier
v_mfma_f32_16x16x32_bf16 v[128:131], a[0:3], a[136:139], 0
s_waitcnt lgkmcnt(0)
ds_read_b64_tr_b16 a[128:129], v8 offset:0
v_mfma_f32_16x16x32_bf16 v[128:131], a[4:7], a[140:143], v[128:131]
buffer_load_dword v21, v20, s[16:19], s43 offen
v_mfma_f32_16x16x32_bf16 v[132:135], a[8:11], a[136:139], 0
s_add_u32 s43, s43, s47
ds_read_b64_tr_b16 a[130:131], v8 offset:2048
v_mfma_f32_16x16x32_bf16 v[132:135], a[12:15], a[140:143], v[132:135]
s_cmp_ge_u32 s43, s51
v_mfma_f32_16x16x32_bf16 v[136:139], a[16:19], a[136:139], 0
s_cselect_b32 s43, 0, s43
ds_read_b64_tr_b16 a[132:133], v8 offset:16384
v_mfma_f32_16x16x32_bf16 v[136:139], a[20:23], a[140:143], v[136:139]
s_cselect_b32 s51, s42, s51
v_mfma_f32_16x16x32_bf16 v[140:143], a[24:27], a[136:139], 0
s_cselect_b64 s[16:17], s[40:41], s[16:17]
ds_read_b64_tr_b16 a[134:135], v8 offset:18432
v_mfma_f32_16x16x32_bf16 v[140:143], a[28:31], a[140:143], v[140:143]
s_cselect_b32 s18, s42, s18
v_mfma_f32_16x16x32_bf16 v[144:147], a[32:35], a[136:139], 0
s_cselect_b64 s[40:41], s[44:45], s[40:41]
ds_read_b128 a[64:67], v2 offset:32768
v_mfma_f32_16x16x32_bf16 v[144:147], a[36:39], a[140:143], v[144:147]
s_cselect_b32 s42, s46, s42
v_mfma_f32_16x16x32_bf16 v[148:151], a[40:43], a[136:139], 0
s_cselect_b32 s46, 0, s46
ds_read_b128 a[68:71], v3 offset:32768
v_mfma_f32_16x16x32_bf16 v[148:151], a[44:47], a[140:143], v[148:151]
ds_read_b128 a[72:75], v2 offset:34816
v_mfma_f32_16x16x32_bf16 v[152:155], a[48:51], a[136:139], 0
ds_read_b128 a[76:79], v3 offset:34816
v_mfma_f32_16x16x32_bf16 v[152:155], a[52:55], a[140:143], v[152:155]
buffer_load_dword v21, v20, s[16:19], s43 offen
v_mfma_f32_16x16x32_bf16 v[156:159], a[56:59], a[136:139], 0
s_add_u32 s43, s43, s47
ds_read_b128 a[80:83], v2 offset:36864
v_mfma_f32_16x16x32_bf16 v[156:159], a[60:63], a[140:143], v[156:159]
s_waitcnt lgkmcnt(7)
s_cmp_ge_u32 s43, s51
ds_read_b128 a[84:87], v3 offset:36864
v_mfma_f32_16x16x32_bf16 v[160:163], a[0:3], a[128:131], 0
s_waitcnt lgkmcnt(6)
s_cselect_b32 s43, 0, s43
ds_read_b64_tr_b16 a[136:137], v9 offset:0
v_mfma_f32_16x16x32_bf16 v[160:163], a[4:7], a[132:135], v[160:163]
s_cselect_b32 s51, s42, s51
v_mfma_f32_16x16x32_bf16 v[164:167], a[8:11], a[128:131], 0
s_cselect_b64 s[16:17], s[40:41], s[16:17]
ds_read_b64_tr_b16 a[138:139], v9 offset:2048
v_mfma_f32_16x16x32_bf16 v[164:167], a[12:15], a[132:135], v[164:167]
s_cselect_b32 s18, s42, s18
v_mfma_f32_16x16x32_bf16 v[168:171], a[16:19], a[128:131], 0
s_cselect_b64 s[40:41], s[44:45], s[40:41]
ds_read_b64_tr_b16 a[140:141], v9 offset:16384
v_mfma_f32_16x16x32_bf16 v[168:171], a[20:23], a[132:135], v[168:171]
s_cselect_b32 s42, s46, s42
v_mfma_f32_16x16x32_bf16 v[172:175], a[24:27], a[128:131], 0
s_cselect_b32 s46, 0, s46
ds_read_b64_tr_b16 a[142:143], v9 offset:18432
v_mfma_f32_16x16x32_bf16 v[172:175], a[28:31], a[132:135], v[172:175]
s_bitcmp1_b32 s2, 4
s_cselect_b32 s37, s21, s37
s_lshl_b32 s56, s37, 5
v_mfma_f32_16x16x32_bf16 v[176:179], a[32:35], a[128:131], 0
s_add_u32 s56, s56, s20
s_lshl_b32 s56, s56, 2
s_add_u32 s56, s56, 8192
v_mfma_f32_16x16x32_bf16 v[176:179], a[36:39], a[132:135], v[176:179]
v_writelane_b32 v28, s56, 3
v_mfma_f32_16x16x32_bf16 v[180:183], a[40:43], a[128:131], 0
s_add_u32 s56, s56, 2048
ds_read_b128 a[88:91], v2 offset:38912
v_writelane_b32 v28, s56, 6
v_mfma_f32_16x16x32_bf16 v[180:183], a[44:47], a[132:135], v[180:183]
s_lshl_b32 s56, s2, 2
s_add_u32 s56, s56, 12288
ds_read_b128 a[92:95], v3 offset:38912
v_mfma_f32_16x16x32_bf16 v[184:187], a[48:51], a[128:131], 0
s_waitcnt lgkmcnt(2)
ds_read_b128 a[96:99], v2 offset:40960
v_writelane_b32 v28, s56, 4
v_mfma_f32_16x16x32_bf16 v[184:187], a[52:55], a[132:135], v[184:187]
s_lshl_b32 s56, s39, 5
s_add_u32 s56, s56, s38
s_lshl_b32 s56, s56, 2
v_mfma_f32_16x16x32_bf16 v[188:191], a[56:59], a[128:131], 0
s_add_u32 s56, s56, 20480
s_cmp_lt_u32 s2, 224
ds_read_b128 a[100:103], v3 offset:40960
v_mfma_f32_16x16x32_bf16 v[188:191], a[60:63], a[132:135], v[188:191]
s_cselect_b32 s56, s56, 3221225472
ds_read_b128 a[104:107], v2 offset:43008
v_writelane_b32 v28, s56, 7
v_mfma_f32_16x16x32_bf16 v[192:195], a[0:3], a[136:139], 0
s_cmp_eq_u32 s3, 0
s_cselect_b32 s56, 94371840, 3221225472
ds_read_b64_tr_b16 a[128:129], v10 offset:0
v_mfma_f32_16x16x32_bf16 v[192:195], a[4:7], a[140:143], v[192:195]
buffer_store_dword v246, v28, s[4:7], s56 offen sc1
v_mfma_f32_16x16x32_bf16 v[196:199], a[8:11], a[136:139], 0
ds_read_b64_tr_b16 a[130:131], v10 offset:2048
v_mov_b32 v27, 1
v_mfma_f32_16x16x32_bf16 v[196:199], a[12:15], a[140:143], v[196:199]
v_cmp_eq_u32 vcc, 0, v0
v_mov_b32 v26, 3221225472
v_mfma_f32_16x16x32_bf16 v[200:203], a[16:19], a[136:139], 0
s_lshl_b32 s31, s20, 20
s_lshl_b32 s22, s21, 17
ds_read_b64_tr_b16 a[132:133], v10 offset:16384
v_mfma_f32_16x16x32_bf16 v[200:203], a[20:23], a[140:143], v[200:203]
v_cndmask_b32 v26, v26, v246, vcc
v_mfma_f32_16x16x32_bf16 v[204:207], a[24:27], a[136:139], 0
s_add_u32 s31, s31, s22
s_lshr_b32 s22, s3, 1
ds_read_b64_tr_b16 a[134:135], v10 offset:18432
v_mfma_f32_16x16x32_bf16 v[204:207], a[28:31], a[140:143], v[204:207]
s_lshl_b32 s22, s22, 16
s_add_u32 s31, s31, s22
s_and_b32 s22, s3, 1
v_mfma_f32_16x16x32_bf16 v[208:211], a[32:35], a[136:139], 0
s_lshl_b32 s22, s22, 14
s_add_u32 s31, s31, s22
s_add_u32 s31, s31, 16777216
v_mfma_f32_16x16x32_bf16 v[208:211], a[36:39], a[140:143], v[208:211]
v_mfma_f32_16x16x32_bf16 v[212:215], a[40:43], a[136:139], 0
ds_read_b128 a[108:111], v3 offset:43008
v_mfma_f32_16x16x32_bf16 v[212:215], a[44:47], a[140:143], v[212:215]
ds_read_b128 a[112:115], v2 offset:45056
v_mfma_f32_16x16x32_bf16 v[216:219], a[48:51], a[136:139], 0
ds_read_b128 a[116:119], v3 offset:45056
v_mfma_f32_16x16x32_bf16 v[216:219], a[52:55], a[140:143], v[216:219]
v_mfma_f32_16x16x32_bf16 v[220:223], a[56:59], a[136:139], 0
ds_read_b128 a[120:123], v2 offset:47104
v_mfma_f32_16x16x32_bf16 v[220:223], a[60:63], a[140:143], v[220:223]
s_waitcnt lgkmcnt(6)
ds_read_b128 a[124:127], v3 offset:47104
v_mfma_f32_16x16x32_bf16 a[192:195], a[0:3], a[128:131], 0
s_waitcnt lgkmcnt(5)
ds_read_b64_tr_b16 a[136:137], v11 offset:0
v_mfma_f32_16x16x32_bf16 a[192:195], a[4:7], a[132:135], a[192:195]
v_mfma_f32_16x16x32_bf16 a[196:199], a[8:11], a[128:131], 0
ds_read_b64_tr_b16 a[138:139], v11 offset:2048
v_mfma_f32_16x16x32_bf16 a[196:199], a[12:15], a[132:135], a[196:199]
v_mfma_f32_16x16x32_bf16 a[200:203], a[16:19], a[128:131], 0
ds_read_b64_tr_b16 a[140:141], v11 offset:16384
v_mfma_f32_16x16x32_bf16 a[200:203], a[20:23], a[132:135], a[200:203]
v_mfma_f32_16x16x32_bf16 a[204:207], a[24:27], a[128:131], 0
ds_read_b64_tr_b16 a[142:143], v11 offset:18432
v_mfma_f32_16x16x32_bf16 a[204:207], a[28:31], a[132:135], a[204:207]
v_mfma_f32_16x16x32_bf16 a[208:211], a[32:35], a[128:131], 0
v_mfma_f32_16x16x32_bf16 a[208:211], a[36:39], a[132:135], a[208:211]
v_mfma_f32_16x16x32_bf16 a[212:215], a[40:43], a[128:131], 0
v_mfma_f32_16x16x32_bf16 a[212:215], a[44:47], a[132:135], a[212:215]
v_mfma_f32_16x16x32_bf16 a[216:219], a[48:51], a[128:131], 0
v_mfma_f32_16x16x32_bf16 a[216:219], a[52:55], a[132:135], a[216:219]
v_mfma_f32_16x16x32_bf16 a[220:223], a[56:59], a[128:131], 0
v_mfma_f32_16x16x32_bf16 a[220:223], a[60:63], a[132:135], a[220:223]
s_waitcnt vmcnt(3) lgkmcnt(0)
s_barrier
v_mfma_f32_16x16x32_bf16 a[224:227], a[0:3], a[136:139], 0
s_add_u32 m0, s29, 65536
ds_read_b64_tr_b16 a[128:129], v4 offset:32768
v_mfma_f32_16x16x32_bf16 a[224:227], a[4:7], a[140:143], a[224:227]
buffer_load_dwordx4 v16, s[12:15], s26 offen offset:0 lds
v_mfma_f32_16x16x32_bf16 a[228:231], a[8:11], a[136:139], 0
ds_read_b64_tr_b16 a[130:131], v4 offset:34816
v_mfma_f32_16x16x32_bf16 a[228:231], a[12:15], a[140:143], a[228:231]
v_mfma_f32_16x16x32_bf16 a[232:235], a[16:19], a[136:139], 0
ds_read_b64_tr_b16 a[132:133], v4 offset:49152
v_mfma_f32_16x16x32_bf16 a[232:235], a[20:23], a[140:143], a[232:235]
buffer_load_dwordx4 v17, s[12:15], s26 offen offset:1024 lds
v_mfma_f32_16x16x32_bf16 a[236:239], a[24:27], a[136:139], 0
ds_read_b64_tr_b16 a[134:135], v4 offset:51200
v_mfma_f32_16x16x32_bf16 a[236:239], a[28:31], a[140:143], a[236:239]
v_mfma_f32_16x16x32_bf16 a[240:243], a[32:35], a[136:139], 0
v_mfma_f32_16x16x32_bf16 a[240:243], a[36:39], a[140:143], a[240:243]
buffer_load_dwordx4 v18, s[12:15], s26 offen offset:2048 lds
v_mfma_f32_16x16x32_bf16 a[244:247], a[40:43], a[136:139], 0
v_mfma_f32_16x16x32_bf16 a[244:247], a[44:47], a[140:143], a[244:247]
v_mfma_f32_16x16x32_bf16 a[248:251], a[48:51], a[136:139], 0
v_mfma_f32_16x16x32_bf16 a[248:251], a[52:55], a[140:143], a[248:251]
buffer_load_dwordx4 v19, s[12:15], s26 offen offset:3072 lds
v_mfma_f32_16x16x32_bf16 a[252:255], a[56:59], a[136:139], 0
s_add_u32 s26, s26, 524288
v_mfma_f32_16x16x32_bf16 a[252:255], a[60:63], a[140:143], a[252:255]
s_waitcnt lgkmcnt(2)
Lg_2:
v_mfma_f32_16x16x32_bf16 v[32:35], a[64:67], a[128:131], v[32:35]
s_waitcnt lgkmcnt(0)
s_add_u32 m0, s29, 81920
ds_read_b64_tr_b16 a[136:137], v5 offset:32768
v_mfma_f32_16x16x32_bf16 v[32:35], a[68:71], a[132:135], v[32:35]
buffer_load_dwordx4 v16, s[12:15], s27 offen offset:0 lds
v_mfma_f32_16x16x32_bf16 v[36:39], a[72:75], a[128:131], v[36:39]
ds_read_b64_tr_b16 a[138:139], v5 offset:34816
v_mfma_f32_16x16x32_bf16 v[36:39], a[76:79], a[132:135], v[36:39]
v_mfma_f32_16x16x32_bf16 v[40:43], a[80:83], a[128:131], v[40:43]
ds_read_b64_tr_b16 a[140:141], v5 offset:49152
v_mfma_f32_16x16x32_bf16 v[40:43], a[84:87], a[132:135], v[40:43]
buffer_load_dwordx4 v17, s[12:15], s27 offen offset:1024 lds
v_mfma_f32_16x16x32_bf16 v[44:47], a[88:91], a[128:131], v[44:47]
ds_read_b64_tr_b16 a[142:143], v5 offset:51200
v_mfma_f32_16x16x32_bf16 v[44:47], a[92:95], a[132:135], v[44:47]
v_mfma_f32_16x16x32_bf16 v[48:51], a[96:99], a[128:131], v[48:51]
ds_read_b128 a[0:3], v2 offset:0
v_mfma_f32_16x16x32_bf16 v[48:51], a[100:103], a[132:135], v[48:51]
buffer_load_dwordx4 v18, s[12:15], s27 offen offset:2048 lds
v_mfma_f32_16x16x32_bf16 v[52:55], a[104:107], a[128:131], v[52:55]
ds_read_b128 a[4:7], v3 offset:0
v_mfma_f32_16x16x32_bf16 v[52:55], a[108:111], a[132:135], v[52:55]
v_mfma_f32_16x16x32_bf16 v[56:59], a[112:115], a[128:131], v[56:59]
v_mfma_f32_16x16x32_bf16 v[56:59], a[116:119], a[132:135], v[56:59]
buffer_load_dwordx4 v19, s[12:15], s27 offen offset:3072 lds
v_mfma_f32_16x16x32_bf16 v[60:63], a[120:123], a[128:131], v[60:63]
s_add_u32 s27, s27, 524288
ds_read_b128 a[8:11], v2 offset:2048
v_mfma_f32_16x16x32_bf16 v[60:63], a[124:127], a[132:135], v[60:63]
s_waitcnt lgkmcnt(5)
v_mfma_f32_16x16x32_bf16 v[64:67], a[64:67], a[136:139], v[64:67]
s_waitcnt lgkmcnt(3)
s_add_u32 m0, s28, 32768
ds_read_b64_tr_b16 a[128:129], v6 offset:32768
v_mfma_f32_16x16x32_bf16 v[64:67], a[68:71], a[140:143], v[64:67]
buffer_load_dwordx4 v12, s[8:11], s24 offen offset:0 lds
v_mfma_f32_16x16x32_bf16 v[68:71], a[72:75], a[136:139], v[68:71]
ds_read_b64_tr_b16 a[130:131], v6 offset:34816
v_mfma_f32_16x16x32_bf16 v[68:71], a[76:79], a[140:143], v[68:71]
v_mfma_f32_16x16x32_bf16 v[72:75], a[80:83], a[136:139], v[72:75]
ds_read_b64_tr_b16 a[132:133], v6 offset:49152
v_mfma_f32_16x16x32_bf16 v[72:75], a[84:87], a[140:143], v[72:75]
buffer_load_dwordx4 v13, s[8:11], s24 offen offset:1024 lds
v_mfma_f32_16x16x32_bf16 v[76:79], a[88:91], a[136:139], v[76:79]
ds_read_b64_tr_b16 a[134:135], v6 offset:51200
v_mfma_f32_16x16x32_bf16 v[76:79], a[92:95], a[140:143], v[76:79]
v_mfma_f32_16x16x32_bf16 v[80:83], a[96:99], a[136:139], v[80:83]
ds_read_b128 a[12:15], v3 offset:2048
v_mfma_f32_16x16x32_bf16 v[80:83], a[100:103], a[140:143], v[80:83]
buffer_load_dwordx4 v14, s[8:11], s24 offen offset:2048 lds
v_mfma_f32_16x16x32_bf16 v[84:87], a[104:107], a[136:139], v[84:87]
v_mfma_f32_16x16x32_bf16 v[84:87], a[108:111], a[140:143], v[84:87]
v_mfma_f32_16x16x32_bf16 v[88:91], a[112:115], a[136:139], v[88:91]
ds_read_b128 a[16:19], v2 offset:4096
v_mfma_f32_16x16x32_bf16 v[88:91], a[116:119], a[140:143], v[88:91]
buffer_load_dwordx4 v15, s[8:11], s24 offen offset:3072 lds
v_mfma_f32_16x16x32_bf16 v[92:95], a[120:123], a[136:139], v[92:95]
s_add_u32 s24, s24, 128
ds_read_b128 a[20:23], v3 offset:4096
v_mfma_f32_16x16x32_bf16 v[92:95], a[124:127], a[140:143], v[92:95]
s_waitcnt lgkmcnt(5)
v_mfma_f32_16x16x32_bf16 v[96:99], a[64:67], a[128:131], v[96:99]
s_waitcnt lgkmcnt(3)
s_add_u32 m0, s28, 36864
ds_read_b64_tr_b16 a[136:137], v7 offset:32768
v_mfma_f32_16x16x32_bf16 v[96:99], a[68:71], a[132:135], v[96:99]
buffer_load_dwordx4 v12, s[8:11], s25 offen offset:0 lds
v_mfma_f32_16x16x32_bf16 v[100:103], a[72:75], a[128:131], v[100:103]
ds_read_b64_tr_b16 a[138:139], v7 offset:34816
v_mfma_f32_16x16x32_bf16 v[100:103], a[76:79], a[132:135], v[100:103]
v_mfma_f32_16x16x32_bf16 v[104:107], a[80:83], a[128:131], v[104:107]
ds_read_b64_tr_b16 a[140:141], v7 offset:49152
v_mfma_f32_16x16x32_bf16 v[104:107], a[84:87], a[132:135], v[104:107]
buffer_load_dwordx4 v13, s[8:11], s25 offen offset:1024 lds
v_mfma_f32_16x16x32_bf16 v[108:111], a[88:91], a[128:131], v[108:111]
ds_read_b64_tr_b16 a[142:143], v7 offset:51200
v_mfma_f32_16x16x32_bf16 v[108:111], a[92:95], a[132:135], v[108:111]
v_mfma_f32_16x16x32_bf16 v[112:115], a[96:99], a[128:131], v[112:115]
v_mfma_f32_16x16x32_bf16 v[112:115], a[100:103], a[132:135], v[112:115]
buffer_load_dwordx4 v14, s[8:11], s25 offen offset:2048 lds
v_mfma_f32_16x16x32_bf16 v[116:119], a[104:107], a[128:131], v[116:119]
ds_read_b128 a[24:27], v2 offset:6144
v_mfma_f32_16x16x32_bf16 v[116:119], a[108:111], a[132:135], v[116:119]
v_mfma_f32_16x16x32_bf16 v[120:123], a[112:115], a[128:131], v[120:123]
ds_read_b128 a[28:31], v3 offset:6144
v_mfma_f32_16x16x32_bf16 v[120:123], a[116:119], a[132:135], v[120:123]
buffer_load_dwordx4 v15, s[8:11], s25 offen offset:3072 lds
v_mfma_f32_16x16x32_bf16 v[124:127], a[120:123], a[128:131], v[124:127]
s_add_u32 s25, s25, 128
v_mfma_f32_16x16x32_bf16 v[124:127], a[124:127], a[132:135], v[124:127]
s_waitcnt lgkmcnt(4)
v_mfma_f32_16x16x32_bf16 v[128:131], a[64:67], a[136:139], v[128:131]
s_waitcnt lgkmcnt(2)
ds_read_b64_tr_b16 a[128:129], v8 offset:32768
v_mfma_f32_16x16x32_bf16 v[128:131], a[68:71], a[140:143], v[128:131]
buffer_load_dword v21, v20, s[16:19], s43 offen
v_mfma_f32_16x16x32_bf16 v[132:135], a[72:75], a[136:139], v[132:135]
s_add_u32 s43, s43, s47
ds_read_b64_tr_b16 a[130:131], v8 offset:34816
v_mfma_f32_16x16x32_bf16 v[132:135], a[76:79], a[140:143], v[132:135]
s_cmp_ge_u32 s43, s51
v_mfma_f32_16x16x32_bf16 v[136:139], a[80:83], a[136:139], v[136:139]
s_cselect_b32 s43, 0, s43
ds_read_b64_tr_b16 a[132:133], v8 offset:49152
v_mfma_f32_16x16x32_bf16 v[136:139], a[84:87], a[140:143], v[136:139]
s_cselect_b32 s51, s42, s51
v_mfma_f32_16x16x32_bf16 v[140:143], a[88:91], a[136:139], v[140:143]
s_cselect_b64 s[16:17], s[40:41], s[16:17]
ds_read_b64_tr_b16 a[134:135], v8 offset:51200
v_mfma_f32_16x16x32_bf16 v[140:143], a[92:95], a[140:143], v[140:143]
s_cselect_b32 s18, s42, s18
v_mfma_f32_16x16x32_bf16 v[144:147], a[96:99], a[136:139], v[144:147]
s_cselect_b64 s[40:41], s[44:45], s[40:41]
ds_read_b128 a[32:35], v2 offset:8192
v_mfma_f32_16x16x32_bf16 v[144:147], a[100:103], a[140:143], v[144:147]
s_cselect_b32 s42, s46, s42
v_mfma_f32_16x16x32_bf16 v[148:151], a[104:107], a[136:139], v[148:151]
s_cselect_b32 s46, 0, s46
v_mfma_f32_16x16x32_bf16 v[148:151], a[108:111], a[140:143], v[148:151]
s_cmp_eq_u32 s30, s55
v_mfma_f32_16x16x32_bf16 v[152:155], a[112:115], a[136:139], v[152:155]
s_cselect_b32 s22, 0, 3221225472
ds_read_b128 a[36:39], v3 offset:8192
v_mfma_f32_16x16x32_bf16 v[152:155], a[116:119], a[140:143], v[152:155]
s_sub_u32 s30, s30, 1
buffer_atomic_add v27, v26, s[60:63], s22 offen sc1
v_mfma_f32_16x16x32_bf16 v[156:159], a[120:123], a[136:139], v[156:159]
ds_read_b128 a[40:43], v2 offset:10240
v_mfma_f32_16x16x32_bf16 v[156:159], a[124:127], a[140:143], v[156:159]
s_waitcnt lgkmcnt(5)
v_mfma_f32_16x16x32_bf16 v[160:163], a[64:67], a[128:131], v[160:163]
s_waitcnt lgkmcnt(3)
ds_read_b64_tr_b16 a[136:137], v9 offset:32768
v_mfma_f32_16x16x32_bf16 v[160:163], a[68:71], a[132:135], v[160:163]
v_mfma_f32_16x16x32_bf16 v[164:167], a[72:75], a[128:131], v[164:167]
ds_read_b64_tr_b16 a[138:139], v9 offset:34816
v_mfma_f32_16x16x32_bf16 v[164:167], a[76:79], a[132:135], v[164:167]
v_mfma_f32_16x16x32_bf16 v[168:171], a[80:83], a[128:131], v[168:171]
ds_read_b64_tr_b16 a[140:141], v9 offset:49152
v_mfma_f32_16x16x32_bf16 v[168:171], a[84:87], a[132:135], v[168:171]
v_mfma_f32_16x16x32_bf16 v[172:175], a[88:91], a[128:131], v[172:175]
ds_read_b64_tr_b16 a[142:143], v9 offset:51200
v_mfma_f32_16x16x32_bf16 v[172:175], a[92:95], a[132:135], v[172:175]
v_mfma_f32_16x16x32_bf16 v[176:179], a[96:99], a[128:131], v[176:179]
v_mfma_f32_16x16x32_bf16 v[176:179], a[100:103], a[132:135], v[176:179]
v_mfma_f32_16x16x32_bf16 v[180:183], a[104:107], a[128:131], v[180:183]
ds_read_b128 a[44:47], v3 offset:10240
v_mfma_f32_16x16x32_bf16 v[180:183], a[108:111], a[132:135], v[180:183]
v_mfma_f32_16x16x32_bf16 v[184:187], a[112:115], a[128:131], v[184:187]
ds_read_b128 a[48:51], v2 offset:12288
v_mfma_f32_16x16x32_bf16 v[184:187], a[116:119], a[132:135], v[184:187]
v_mfma_f32_16x16x32_bf16 v[188:191], a[120:123], a[128:131], v[188:191]
v_mfma_f32_16x16x32_bf16 v[188:191], a[124:127], a[132:135], v[188:191]
s_waitcnt lgkmcnt(4)
v_mfma_f32_16x16x32_bf16 v[192:195], a[64:67], a[136:139], v[192:195]
s_waitcnt lgkmcnt(2)
ds_read_b64_tr_b16 a[128:129], v10 offset:32768
v_mfma_f32_16x16x32_bf16 v[192:195], a[68:71], a[140:143], v[192:195]
v_mfma_f32_16x16x32_bf16 v[196:199], a[72:75], a[136:139], v[196:199]
ds_read_b64_tr_b16 a[130:131], v10 offset:34816
v_mfma_f32_16x16x32_bf16 v[196:199], a[76:79], a[140:143], v[196:199]
v_mfma_f32_16x16x32_bf16 v[200:203], a[80:83], a[136:139], v[200:203]
ds_read_b64_tr_b16 a[132:133], v10 offset:49152
v_mfma_f32_16x16x32_bf16 v[200:203], a[84:87], a[140:143], v[200:203]
v_mfma_f32_16x16x32_bf16 v[204:207], a[88:91], a[136:139], v[204:207]
ds_read_b64_tr_b16 a[134:135], v10 offset:51200
v_mfma_f32_16x16x32_bf16 v[204:207], a[92:95], a[140:143], v[204:207]
v_mfma_f32_16x16x32_bf16 v[208:211], a[96:99], a[136:139], v[208:211]
ds_read_b128 a[52:55], v3 offset:12288
v_mfma_f32_16x16x32_bf16 v[208:211], a[100:103], a[140:143], v[208:211]
v_mfma_f32_16x16x32_bf16 v[212:215], a[104:107], a[136:139], v[212:215]
ds_read_b128 a[56:59], v2 offset:14336
v_mfma_f32_16x16x32_bf16 v[212:215], a[108:111], a[140:143], v[212:215]
v_mfma_f32_16x16x32_bf16 v[216:219], a[112:115], a[136:139], v[216:219]
v_mfma_f32_16x16x32_bf16 v[216:219], a[116:119], a[140:143], v[216:219]
v_mfma_f32_16x16x32_bf16 v[220:223], a[120:123], a[136:139], v[220:223]
ds_read_b128 a[60:63], v3 offset:14336
v_mfma_f32_16x16x32_bf16 v[220:223], a[124:127], a[140:143], v[220:223]
s_waitcnt lgkmcnt(5)
v_mfma_f32_16x16x32_bf16 a[192:195], a[64:67], a[128:131], a[192:195]
s_waitcnt lgkmcnt(3)
ds_read_b64_tr_b16 a[136:137], v11 offset:32768
v_mfma_f32_16x16x32_bf16 a[192:195], a[68:71], a[132:135], a[192:195]
v_mfma_f32_16x16x32_bf16 a[196:199], a[72:75], a[128:131], a[196:199]
ds_read_b64_tr_b16 a[138:139], v11 offset:34816
v_mfma_f32_16x16x32_bf16 a[196:199], a[76:79], a[132:135], a[196:199]
v_mfma_f32_16x16x32_bf16 a[200:203], a[80:83], a[128:131], a[200:203]
ds_read_b64_tr_b16 a[140:141], v11 offset:49152
v_mfma_f32_16x16x32_bf16 a[200:203], a[84:87], a[132:135], a[200:203]
v_mfma_f32_16x16x32_bf16 a[204:207], a[88:91], a[128:131], a[204:207]
ds_read_b64_tr_b16 a[142:143], v11 offset:51200
v_mfma_f32_16x16x32_bf16 a[204:207], a[92:95], a[132:135], a[204:207]
v_mfma_f32_16x16x32_bf16 a[208:211], a[96:99], a[128:131], a[208:211]
v_mfma_f32_16x16x32_bf16 a[208:211], a[100:103], a[132:135], a[208:211]
v_mfma_f32_16x16x32_bf16 a[212:215], a[104:107], a[128:131], a[212:215]
v_mfma_f32_16x16x32_bf16 a[212:215], a[108:111], a[132:135], a[212:215]
v_mfma_f32_16x16x32_bf16 a[216:219], a[112:115], a[128:131], a[216:219]
v_mfma_f32_16x16x32_bf16 a[216:219], a[116:119], a[132:135], a[216:219]
v_mfma_f32_16x16x32_bf16 a[220:223], a[120:123], a[128:131], a[220:223]
v_mfma_f32_16x16x32_bf16 a[220:223], a[124:127], a[132:135], a[220:223]
s_waitcnt vmcnt(2) lgkmcnt(0)
s_barrier
v_mfma_f32_16x16x32_bf16 a[224:227], a[64:67], a[136:139], a[224:227]
s_add_u32 m0, s29, 98304
ds_read_b64_tr_b16 a[128:129], v4 offset:0
v_mfma_f32_16x16x32_bf16 a[224:227], a[68:71], a[140:143], a[224:227]
buffer_load_dwordx4 v16, s[12:15], s26 offen offset:0 lds
v_mfma_f32_16x16x32_bf16 a[228:231], a[72:75], a[136:139], a[228:231]
ds_read_b64_tr_b16 a[130:131], v4 offset:2048
v_mfma_f32_16x16x32_bf16 a[228:231], a[76:79], a[140:143], a[228:231]
v_mfma_f32_16x16x32_bf16 a[232:235], a[80:83], a[136:139], a[232:235]
ds_read_b64_tr_b16 a[132:133], v4 offset:16384
v_mfma_f32_16x16x32_bf16 a[232:235], a[84:87], a[140:143], a[232:235]
buffer_load_dwordx4 v17, s[12:15], s26 offen offset:1024 lds
v_mfma_f32_16x16x32_bf16 a[236:239], a[88:91], a[136:139], a[236:239]
ds_read_b64_tr_b16 a[134:135], v4 offset:18432
v_mfma_f32_16x16x32_bf16 a[236:239], a[92:95], a[140:143], a[236:239]
v_mfma_f32_16x16x32_bf16 a[240:243], a[96:99], a[136:139], a[240:243]
v_mfma_f32_16x16x32_bf16 a[240:243], a[100:103], a[140:143], a[240:243]
buffer_load_dwordx4 v18, s[12:15], s26 offen offset:2048 lds
v_mfma_f32_16x16x32_bf16 a[244:247], a[104:107], a[136:139], a[244:247]
v_mfma_f32_16x16x32_bf16 a[244:247], a[108:111], a[140:143], a[244:247]
v_mfma_f32_16x16x32_bf16 a[248:251], a[112:115], a[136:139], a[248:251]
v_mfma_f32_16x16x32_bf16 a[248:251], a[116:119], a[140:143], a[248:251]
buffer_load_dwordx4 v19, s[12:15], s26 offen offset:3072 lds
v_mfma_f32_16x16x32_bf16 a[252:255], a[120:123], a[136:139], a[252:255]
s_add_u32 s26, s26, 524288
v_mfma_f32_16x16x32_bf16 a[252:255], a[124:127], a[140:143], a[252:255]
s_waitcnt lgkmcnt(2)
buffer_store_dword v27, v26, s[4:7], s82 offen sc1
v_mfma_f32_16x16x32_bf16 v[32:35], a[0:3], a[128:131], v[32:35]
s_waitcnt lgkmcnt(0)
s_add_u32 m0, s29, 114688
ds_read_b64_tr_b16 a[136:137], v5 offset:0
v_mfma_f32_16x16x32_bf16 v[32:35], a[4:7], a[132:135], v[32:35]
buffer_load_dwordx4 v16, s[12:15], s27 offen offset:0 lds
v_mfma_f32_16x16x32_bf16 v[36:39], a[8:11], a[128:131], v[36:39]
ds_read_b64_tr_b16 a[138:139], v5 offset:2048
v_mfma_f32_16x16x32_bf16 v[36:39], a[12:15], a[132:135], v[36:39]
v_mfma_f32_16x16x32_bf16 v[40:43], a[16:19], a[128:131], v[40:43]
ds_read_b64_tr_b16 a[140:141], v5 offset:16384
v_mfma_f32_16x16x32_bf16 v[40:43], a[20:23], a[132:135], v[40:43]
buffer_load_dwordx4 v17, s[12:15], s27 offen offset:1024 lds
v_mfma_f32_16x16x32_bf16 v[44:47], a[24:27], a[128:131], v[44:47]
ds_read_b64_tr_b16 a[142:143], v5 offset:18432
v_mfma_f32_16x16x32_bf16 v[44:47], a[28:31], a[132:135], v[44:47]
v_mfma_f32_16x16x32_bf16 v[48:51], a[32:35], a[128:131], v[48:51]
ds_read_b128 a[64:67], v2 offset:32768
v_mfma_f32_16x16x32_bf16 v[48:51], a[36:39], a[132:135], v[48:51]
buffer_load_dwordx4 v18, s[12:15], s27 offen offset:2048 lds
v_mfma_f32_16x16x32_bf16 v[52:55], a[40:43], a[128:131], v[52:55]
ds_read_b128 a[68:71], v3 offset:32768
v_mfma_f32_16x16x32_bf16 v[52:55], a[44:47], a[132:135], v[52:55]
v_mfma_f32_16x16x32_bf16 v[56:59], a[48:51], a[128:131], v[56:59]
v_mfma_f32_16x16x32_bf16 v[56:59], a[52:55], a[132:135], v[56:59]
buffer_load_dwordx4 v19, s[12:15], s27 offen offset:3072 lds
v_mfma_f32_16x16x32_bf16 v[60:63], a[56:59], a[128:131], v[60:63]
s_add_u32 s27, s27, 524288
ds_read_b128 a[72:75], v2 offset:34816
v_mfma_f32_16x16x32_bf16 v[60:63], a[60:63], a[132:135], v[60:63]
s_waitcnt lgkmcnt(5)
v_mfma_f32_16x16x32_bf16 v[64:67], a[0:3], a[136:139], v[64:67]
s_waitcnt lgkmcnt(3)
s_add_u32 m0, s28, 0
ds_read_b64_tr_b16 a[128:129], v6 offset:0
v_mfma_f32_16x16x32_bf16 v[64:67], a[4:7], a[140:143], v[64:67]
buffer_load_dwordx4 v12, s[8:11], s24 offen offset:0 lds
v_mfma_f32_16x16x32_bf16 v[68:71], a[8:11], a[136:139], v[68:71]
ds_read_b64_tr_b16 a[130:131], v6 offset:2048
v_mfma_f32_16x16x32_bf16 v[68:71], a[12:15], a[140:143], v[68:71]
v_mfma_f32_16x16x32_bf16 v[72:75], a[16:19], a[136:139], v[72:75]
ds_read_b64_tr_b16 a[132:133], v6 offset:16384
v_mfma_f32_16x16x32_bf16 v[72:75], a[20:23], a[140:143], v[72:75]
buffer_load_dwordx4 v13, s[8:11], s24 offen offset:1024 lds
v_mfma_f32_16x16x32_bf16 v[76:79], a[24:27], a[136:139], v[76:79]
ds_read_b64_tr_b16 a[134:135], v6 offset:18432
v_mfma_f32_16x16x32_bf16 v[76:79], a[28:31], a[140:143], v[76:79]
v_mfma_f32_16x16x32_bf16 v[80:83], a[32:35], a[136:139], v[80:83]
ds_read_b128 a[76:79], v3 offset:34816
v_mfma_f32_16x16x32_bf16 v[80:83], a[36:39], a[140:143], v[80:83]
buffer_load_dwordx4 v14, s[8:11], s24 offen offset:2048 lds
v_mfma_f32_16x16x32_bf16 v[84:87], a[40:43], a[136:139], v[84:87]
v_mfma_f32_16x16x32_bf16 v[84:87], a[44:47], a[140:143], v[84:87]
v_mfma_f32_16x16x32_bf16 v[88:91], a[48:51], a[136:139], v[88:91]
ds_read_b128 a[80:83], v2 offset:36864
v_mfma_f32_16x16x32_bf16 v[88:91], a[52:55], a[140:143], v[88:91]
buffer_load_dwordx4 v15, s[8:11], s24 offen offset:3072 lds
v_mfma_f32_16x16x32_bf16 v[92:95], a[56:59], a[136:139], v[92:95]
s_add_u32 s24, s24, 128
ds_read_b128 a[84:87], v3 offset:36864
v_mfma_f32_16x16x32_bf16 v[92:95], a[60:63], a[140:143], v[92:95]
s_waitcnt lgkmcnt(5)
v_mfma_f32_16x16x32_bf16 v[96:99], a[0:3], a[128:131], v[96:99]
s_waitcnt lgkmcnt(3)
s_add_u32 m0, s28, 4096
ds_read_b64_tr_b16 a[136:137], v7 offset:0
v_mfma_f32_16x16x32_bf16 v[96:99], a[4:7], a[132:135], v[96:99]
buffer_load_dwordx4 v12, s[8:11], s25 offen offset:0 lds
v_mfma_f32_16x16x32_bf16 v[100:103], a[8:11], a[128:131], v[100:103]
ds_read_b64_tr_b16 a[138:139], v7 offset:2048
v_mfma_f32_16x16x32_bf16 v[100:103], a[12:15], a[132:135], v[100:103]
v_mfma_f32_16x16x32_bf16 v[104:107], a[16:19], a[128:131], v[104:107]
ds_read_b64_tr_b16 a[140:141], v7 offset:16384
v_mfma_f32_16x16x32_bf16 v[104:107], a[20:23], a[132:135], v[104:107]
buffer_load_dwordx4 v13, s[8:11], s25 offen offset:1024 lds
v_mfma_f32_16x16x32_bf16 v[108:111], a[24:27], a[128:131], v[108:111]
ds_read_b64_tr_b16 a[142:143], v7 offset:18432
v_mfma_f32_16x16x32_bf16 v[108:111], a[28:31], a[132:135], v[108:111]
v_mfma_f32_16x16x32_bf16 v[112:115], a[32:35], a[128:131], v[112:115]
v_mfma_f32_16x16x32_bf16 v[112:115], a[36:39], a[132:135], v[112:115]
buffer_load_dwordx4 v14, s[8:11], s25 offen offset:2048 lds
v_mfma_f32_16x16x32_bf16 v[116:119], a[40:43], a[128:131], v[116:119]
ds_read_b128 a[88:91], v2 offset:38912
v_mfma_f32_16x16x32_bf16 v[116:119], a[44:47], a[132:135], v[116:119]
v_mfma_f32_16x16x32_bf16 v[120:123], a[48:51], a[128:131], v[120:123]
ds_read_b128 a[92:95], v3 offset:38912
v_mfma_f32_16x16x32_bf16 v[120:123], a[52:55], a[132:135], v[120:123]
buffer_load_dwordx4 v15, s[8:11], s25 offen offset:3072 lds
v_mfma_f32_16x16x32_bf16 v[124:127], a[56:59], a[128:131], v[124:127]
s_add_u32 s25, s25, 128
v_mfma_f32_16x16x32_bf16 v[124:127], a[60:63], a[132:135], v[124:127]
s_waitcnt lgkmcnt(4)
v_mfma_f32_16x16x32_bf16 v[128:131], a[0:3], a[136:139], v[128:131]
s_waitcnt lgkmcnt(2)
ds_read_b64_tr_b16 a[128:129], v8 offset:0
v_mfma_f32_16x16x32_bf16 v[128:131], a[4:7], a[140:143], v[128:131]
buffer_load_dword v21, v20, s[16:19], s43 offen
v_mfma_f32_16x16x32_bf16 v[132:135], a[8:11], a[136:139], v[132:135]
s_add_u32 s43, s43, s47
ds_read_b64_tr_b16 a[130:131], v8 offset:2048
v_mfma_f32_16x16x32_bf16 v[132:135], a[12:15], a[140:143], v[132:135]
s_cmp_ge_u32 s43, s51
v_mfma_f32_16x16x32_bf16 v[136:139], a[16:19], a[136:139], v[136:139]
s_cselect_b32 s43, 0, s43
ds_read_b64_tr_b16 a[132:133], v8 offset:16384
v_mfma_f32_16x16x32_bf16 v[136:139], a[20:23], a[140:143], v[136:139]
s_cselect_b32 s51, s42, s51
v_mfma_f32_16x16x32_bf16 v[140:143], a[24:27], a[136:139], v[140:143]
s_cselect_b64 s[16:17], s[40:41], s[16:17]
ds_read_b64_tr_b16 a[134:135], v8 offset:18432
v_mfma_f32_16x16x32_bf16 v[140:143], a[28:31], a[140:143], v[140:143]
s_cselect_b32 s18, s42, s18
v_mfma_f32_16x16x32_bf16 v[144:147], a[32:35], a[136:139], v[144:147]
s_cselect_b64 s[40:41], s[44:45], s[40:41]
ds_read_b128 a[96:99], v2 offset:40960
v_mfma_f32_16x16x32_bf16 v[144:147], a[36:39], a[140:143], v[144:147]
s_cselect_b32 s42, s46, s42
v_mfma_f32_16x16x32_bf16 v[148:151], a[40:43], a[136:139], v[148:151]
s_cselect_b32 s46, 0, s46
v_mfma_f32_16x16x32_bf16 v[148:151], a[44:47], a[140:143], v[148:151]
s_cmp_eq_u32 s30, s55
v_mfma_f32_16x16x32_bf16 v[152:155], a[48:51], a[136:139], v[152:155]
s_cselect_b32 s22, 0, 3221225472
ds_read_b128 a[100:103], v3 offset:40960
v_mfma_f32_16x16x32_bf16 v[152:155], a[52:55], a[140:143], v[152:155]
s_sub_u32 s30, s30, 1
buffer_atomic_add v27, v26, s[60:63], s22 offen sc1
v_mfma_f32_16x16x32_bf16 v[156:159], a[56:59], a[136:139], v[156:159]
ds_read_b128 a[104:107], v2 offset:43008
v_mfma_f32_16x16x32_bf16 v[156:159], a[60:63], a[140:143], v[156:159]
s_waitcnt lgkmcnt(5)
v_mfma_f32_16x16x32_bf16 v[160:163], a[0:3], a[128:131], v[160:163]
s_waitcnt lgkmcnt(3)
ds_read_b64_tr_b16 a[136:137], v9 offset:0
v_mfma_f32_16x16x32_bf16 v[160:163], a[4:7], a[132:135], v[160:163]
v_mfma_f32_16x16x32_bf16 v[164:167], a[8:11], a[128:131], v[164:167]
ds_read_b64_tr_b16 a[138:139], v9 offset:2048
v_mfma_f32_16x16x32_bf16 v[164:167], a[12:15], a[132:135], v[164:167]
v_mfma_f32_16x16x32_bf16 v[168:171], a[16:19], a[128:131], v[168:171]
ds_read_b64_tr_b16 a[140:141], v9 offset:16384
v_mfma_f32_16x16x32_bf16 v[168:171], a[20:23], a[132:135], v[168:171]
v_mfma_f32_16x16x32_bf16 v[172:175], a[24:27], a[128:131], v[172:175]
ds_read_b64_tr_b16 a[142:143], v9 offset:18432
v_mfma_f32_16x16x32_bf16 v[172:175], a[28:31], a[132:135], v[172:175]
v_mfma_f32_16x16x32_bf16 v[176:179], a[32:35], a[128:131], v[176:179]
v_mfma_f32_16x16x32_bf16 v[176:179], a[36:39], a[132:135], v[176:179]
v_mfma_f32_16x16x32_bf16 v[180:183], a[40:43], a[128:131], v[180:183]
ds_read_b128 a[108:111], v3 offset:43008
v_mfma_f32_16x16x32_bf16 v[180:183], a[44:47], a[132:135], v[180:183]
v_mfma_f32_16x16x32_bf16 v[184:187], a[48:51], a[128:131], v[184:187]
ds_read_b128 a[112:115], v2 offset:45056
v_mfma_f32_16x16x32_bf16 v[184:187], a[52:55], a[132:135], v[184:187]
v_mfma_f32_16x16x32_bf16 v[188:191], a[56:59], a[128:131], v[188:191]
v_mfma_f32_16x16x32_bf16 v[188:191], a[60:63], a[132:135], v[188:191]
s_waitcnt lgkmcnt(4)
v_mfma_f32_16x16x32_bf16 v[192:195], a[0:3], a[136:139], v[192:195]
s_waitcnt lgkmcnt(2)
ds_read_b64_tr_b16 a[128:129], v10 offset:0
v_mfma_f32_16x16x32_bf16 v[192:195], a[4:7], a[140:143], v[192:195]
v_mfma_f32_16x16x32_bf16 v[196:199], a[8:11], a[136:139], v[196:199]
ds_read_b64_tr_b16 a[130:131], v10 offset:2048
v_mfma_f32_16x16x32_bf16 v[196:199], a[12:15], a[140:143], v[196:199]
v_mfma_f32_16x16x32_bf16 v[200:203], a[16:19], a[136:139], v[200:203]
ds_read_b64_tr_b16 a[132:133], v10 offset:16384
v_mfma_f32_16x16x32_bf16 v[200:203], a[20:23], a[140:143], v[200:203]
v_mfma_f32_16x16x32_bf16 v[204:207], a[24:27], a[136:139], v[204:207]
ds_read_b64_tr_b16 a[134:135], v10 offset:18432
v_mfma_f32_16x16x32_bf16 v[204:207], a[28:31], a[140:143], v[204:207]
v_mfma_f32_16x16x32_bf16 v[208:211], a[32:35], a[136:139], v[208:211]
ds_read_b128 a[116:119], v3 offset:45056
v_mfma_f32_16x16x32_bf16 v[208:211], a[36:39], a[140:143], v[208:211]
v_mfma_f32_16x16x32_bf16 v[212:215], a[40:43], a[136:139], v[212:215]
ds_read_b128 a[120:123], v2 offset:47104
v_mfma_f32_16x16x32_bf16 v[212:215], a[44:47], a[140:143], v[212:215]
v_mfma_f32_16x16x32_bf16 v[216:219], a[48:51], a[136:139], v[216:219]
v_mfma_f32_16x16x32_bf16 v[216:219], a[52:55], a[140:143], v[216:219]
v_mfma_f32_16x16x32_bf16 v[220:223], a[56:59], a[136:139], v[220:223]
ds_read_b128 a[124:127], v3 offset:47104
v_mfma_f32_16x16x32_bf16 v[220:223], a[60:63], a[140:143], v[220:223]
s_waitcnt lgkmcnt(5)
v_mfma_f32_16x16x32_bf16 a[192:195], a[0:3], a[128:131], a[192:195]
s_waitcnt lgkmcnt(3)
ds_read_b64_tr_b16 a[136:137], v11 offset:0
v_mfma_f32_16x16x32_bf16 a[192:195], a[4:7], a[132:135], a[192:195]
v_mfma_f32_16x16x32_bf16 a[196:199], a[8:11], a[128:131], a[196:199]
ds_read_b64_tr_b16 a[138:139], v11 offset:2048
v_mfma_f32_16x16x32_bf16 a[196:199], a[12:15], a[132:135], a[196:199]
v_mfma_f32_16x16x32_bf16 a[200:203], a[16:19], a[128:131], a[200:203]
ds_read_b64_tr_b16 a[140:141], v11 offset:16384
v_mfma_f32_16x16x32_bf16 a[200:203], a[20:23], a[132:135], a[200:203]
v_mfma_f32_16x16x32_bf16 a[204:207], a[24:27], a[128:131], a[204:207]
ds_read_b64_tr_b16 a[142:143], v11 offset:18432
v_mfma_f32_16x16x32_bf16 a[204:207], a[28:31], a[132:135], a[204:207]
v_mfma_f32_16x16x32_bf16 a[208:211], a[32:35], a[128:131], a[208:211]
v_mfma_f32_16x16x32_bf16 a[208:211], a[36:39], a[132:135], a[208:211]
v_mfma_f32_16x16x32_bf16 a[212:215], a[40:43], a[128:131], a[212:215]
v_mfma_f32_16x16x32_bf16 a[212:215], a[44:47], a[132:135], a[212:215]
v_mfma_f32_16x16x32_bf16 a[216:219], a[48:51], a[128:131], a[216:219]
v_mfma_f32_16x16x32_bf16 a[216:219], a[52:55], a[132:135], a[216:219]
v_mfma_f32_16x16x32_bf16 a[220:223], a[56:59], a[128:131], a[220:223]
v_mfma_f32_16x16x32_bf16 a[220:223], a[60:63], a[132:135], a[220:223]
s_waitcnt vmcnt(2) lgkmcnt(0)
s_barrier
v_mfma_f32_16x16x32_bf16 a[224:227], a[0:3], a[136:139], a[224:227]
s_add_u32 m0, s29, 65536
ds_read_b64_tr_b16 a[128:129], v4 offset:32768
v_mfma_f32_16x16x32_bf16 a[224:227], a[4:7], a[140:143], a[224:227]
buffer_load_dwordx4 v16, s[12:15], s26 offen offset:0 lds
v_mfma_f32_16x16x32_bf16 a[228:231], a[8:11], a[136:139], a[228:231]
ds_read_b64_tr_b16 a[130:131], v4 offset:34816
v_mfma_f32_16x16x32_bf16 a[228:231], a[12:15], a[140:143], a[228:231]
v_mfma_f32_16x16x32_bf16 a[232:235], a[16:19], a[136:139], a[232:235]
ds_read_b64_tr_b16 a[132:133], v4 offset:49152
v_mfma_f32_16x16x32_bf16 a[232:235], a[20:23], a[140:143], a[232:235]
buffer_load_dwordx4 v17, s[12:15], s26 offen offset:1024 lds
v_mfma_f32_16x16x32_bf16 a[236:239], a[24:27], a[136:139], a[236:239]
ds_read_b64_tr_b16 a[134:135], v4 offset:51200
v_mfma_f32_16x16x32_bf16 a[236:239], a[28:31], a[140:143], a[236:239]
v_mfma_f32_16x16x32_bf16 a[240:243], a[32:35], a[136:139], a[240:243]
v_mfma_f32_16x16x32_bf16 a[240:243], a[36:39], a[140:143], a[240:243]
buffer_load_dwordx4 v18, s[12:15], s26 offen offset:2048 lds
v_mfma_f32_16x16x32_bf16 a[244:247], a[40:43], a[136:139], a[244:247]
v_mfma_f32_16x16x32_bf16 a[244:247], a[44:47], a[140:143], a[244:247]
v_mfma_f32_16x16x32_bf16 a[248:251], a[48:51], a[136:139], a[248:251]
v_mfma_f32_16x16x32_bf16 a[248:251], a[52:55], a[140:143], a[248:251]
buffer_load_dwordx4 v19, s[12:15], s26 offen offset:3072 lds
v_mfma_f32_16x16x32_bf16 a[252:255], a[56:59], a[136:139], a[252:255]
s_add_u32 s26, s26, 524288
v_mfma_f32_16x16x32_bf16 a[252:255], a[60:63], a[140:143], a[252:255]
s_waitcnt lgkmcnt(2)
s_bitcmp1_b32 s30, 1
s_cbranch_scc1 Lg_2
s_cmp_eq_u32 s30, 0
s_cbranch_scc1 Lg_2t
v_mfma_f32_16x16x32_bf16 v[32:35], a[64:67], a[128:131], v[32:35]
s_waitcnt lgkmcnt(0)
s_add_u32 m0, s29, 81920
ds_read_b64_tr_b16 a[136:137], v5 offset:32768
v_mfma_f32_16x16x32_bf16 v[32:35], a[68:71], a[132:135], v[32:35]
buffer_load_dwordx4 v16, s[12:15], s27 offen offset:0 lds
v_mfma_f32_16x16x32_bf16 v[36:39], a[72:75], a[128:131], v[36:39]
s_lshl_b32 s22, s38, 3
ds_read_b64_tr_b16 a[138:139], v5 offset:34816
v_mfma_f32_16x16x32_bf16 v[36:39], a[76:79], a[132:135], v[36:39]
s_lshl_b32 s23, s39, 5
v_and_b32 v252, 31, v0
v_lshrrev_b32 v253, 5, v0
v_mfma_f32_16x16x32_bf16 v[40:43], a[80:83], a[128:131], v[40:43]
ds_read_b64_tr_b16 a[140:141], v5 offset:49152
v_add_u32 v253, s22, v253
v_mfma_f32_16x16x32_bf16 v[40:43], a[84:87], a[132:135], v[40:43]
buffer_load_dwordx4 v17, s[12:15], s27 offen offset:1024 lds
v_mfma_f32_16x16x32_bf16 v[44:47], a[88:91], a[128:131], v[44:47]
ds_read_b64_tr_b16 a[142:143], v5 offset:51200
v_add_u32 v252, s23, v252
v_mfma_f32_16x16x32_bf16 v[44:47], a[92:95], a[132:135], v[44:47]
v_mul_u32_u24 v254, 7168, v253
v_lshl_add_u32 v254, v252, 2, v254
v_mfma_f32_16x16x32_bf16 v[48:51], a[96:99], a[128:131], v[48:51]
ds_read_b128 a[0:3], v2 offset:0
v_lshlrev_b32 v252, 4, v252
v_mfma_f32_16x16x32_bf16 v[48:51], a[100:103], a[132:135], v[48:51]
buffer_load_dwordx4 v18, s[12:15], s27 offen offset:2048 lds
v_mfma_f32_16x16x32_bf16 v[52:55], a[104:107], a[128:131], v[52:55]
ds_read_b128 a[4:7], v3 offset:0
v_add_u32 v255, 3584, v254
v_mfma_f32_16x16x32_bf16 v[52:55], a[108:111], a[132:135], v[52:55]
v_subrev_u32 v22, 3584, v254
v_subrev_u32 v23, 2688, v254
v_mfma_f32_16x16x32_bf16 v[56:59], a[112:115], a[128:131], v[56:59]
v_subrev_u32 v24, 1792, v254
v_subrev_u32 v25, 896, v254
v_mfma_f32_16x16x32_bf16 v[56:59], a[116:119], a[132:135], v[56:59]
buffer_load_dwordx4 v19, s[12:15], s27 offen offset:3072 lds
v_mfma_f32_16x16x32_bf16 v[60:63], a[120:123], a[128:131], v[60:63]
s_add_u32 s27, s27, 524288
ds_read_b128 a[8:11], v2 offset:2048
v_mfma_f32_16x16x32_bf16 v[60:63], a[124:127], a[132:135], v[60:63]
s_waitcnt lgkmcnt(5)
v_mfma_f32_16x16x32_bf16 v[64:67], a[64:67], a[136:139], v[64:67]
s_waitcnt lgkmcnt(3)
s_add_u32 m0, s28, 32768
ds_read_b64_tr_b16 a[128:129], v6 offset:32768
v_mfma_f32_16x16x32_bf16 v[64:67], a[68:71], a[140:143], v[64:67]
buffer_load_dwordx4 v12, s[8:11], s24 offen offset:0 lds
v_mfma_f32_16x16x32_bf16 v[68:71], a[72:75], a[136:139], v[68:71]
ds_read_b64_tr_b16 a[130:131], v6 offset:34816
v_mfma_f32_16x16x32_bf16 v[68:71], a[76:79], a[140:143], v[68:71]
v_mfma_f32_16x16x32_bf16 v[72:75], a[80:83], a[136:139], v[72:75]
ds_read_b64_tr_b16 a[132:133], v6 offset:49152
v_mfma_f32_16x16x32_bf16 v[72:75], a[84:87], a[140:143], v[72:75]
buffer_load_dwordx4 v13, s[8:11], s24 offen offset:1024 lds
v_mfma_f32_16x16x32_bf16 v[76:79], a[88:91], a[136:139], v[76:79]
ds_read_b64_tr_b16 a[134:135], v6 offset:51200
v_mfma_f32_16x16x32_bf16 v[76:79], a[92:95], a[140:143], v[76:79]
v_mfma_f32_16x16x32_bf16 v[80:83], a[96:99], a[136:139], v[80:83]
ds_read_b128 a[12:15], v3 offset:2048
v_mfma_f32_16x16x32_bf16 v[80:83], a[100:103], a[140:143], v[80:83]
buffer_load_dwordx4 v14, s[8:11], s24 offen offset:2048 lds
v_mfma_f32_16x16x32_bf16 v[84:87], a[104:107], a[136:139], v[84:87]
v_mfma_f32_16x16x32_bf16 v[84:87], a[108:111], a[140:143], v[84:87]
v_mfma_f32_16x16x32_bf16 v[88:91], a[112:115], a[136:139], v[88:91]
ds_read_b128 a[16:19], v2 offset:4096
v_mfma_f32_16x16x32_bf16 v[88:91], a[116:119], a[140:143], v[88:91]
buffer_load_dwordx4 v15, s[8:11], s24 offen offset:3072 lds
v_mfma_f32_16x16x32_bf16 v[92:95], a[120:123], a[136:139], v[92:95]
s_add_u32 s24, s24, 128
ds_read_b128 a[20:23], v3 offset:4096
v_mfma_f32_16x16x32_bf16 v[92:95], a[124:127], a[140:143], v[92:95]
s_waitcnt lgkmcnt(5)
v_mfma_f32_16x16x32_bf16 v[96:99], a[64:67], a[128:131], v[96:99]
s_waitcnt lgkmcnt(3)
s_add_u32 m0, s28, 36864
ds_read_b64_tr_b16 a[136:137], v7 offset:32768
v_mfma_f32_16x16x32_bf16 v[96:99], a[68:71], a[132:135], v[96:99]
buffer_load_dwordx4 v12, s[8:11], s25 offen offset:0 lds
v_mfma_f32_16x16x32_bf16 v[100:103], a[72:75], a[128:131], v[100:103]
ds_read_b64_tr_b16 a[138:139], v7 offset:34816
v_mfma_f32_16x16x32_bf16 v[100:103], a[76:79], a[132:135], v[100:103]
v_mfma_f32_16x16x32_bf16 v[104:107], a[80:83], a[128:131], v[104:107]
ds_read_b64_tr_b16 a[140:141], v7 offset:49152
v_mfma_f32_16x16x32_bf16 v[104:107], a[84:87], a[132:135], v[104:107]
buffer_load_dwordx4 v13, s[8:11], s25 offen offset:1024 lds
v_mfma_f32_16x16x32_bf16 v[108:111], a[88:91], a[128:131], v[108:111]
ds_read_b64_tr_b16 a[142:143], v7 offset:51200
v_mfma_f32_16x16x32_bf16 v[108:111], a[92:95], a[132:135], v[108:111]
v_mfma_f32_16x16x32_bf16 v[112:115], a[96:99], a[128:131], v[112:115]
v_mfma_f32_16x16x32_bf16 v[112:115], a[100:103], a[132:135], v[112:115]
buffer_load_dwordx4 v14, s[8:11], s25 offen offset:2048 lds
v_mfma_f32_16x16x32_bf16 v[116:119], a[104:107], a[128:131], v[116:119]
ds_read_b128 a[24:27], v2 offset:6144
v_mfma_f32_16x16x32_bf16 v[116:119], a[108:111], a[132:135], v[116:119]
v_mfma_f32_16x16x32_bf16 v[120:123], a[112:115], a[128:131], v[120:123]
ds_read_b128 a[28:31], v3 offset:6144
v_mfma_f32_16x16x32_bf16 v[120:123], a[116:119], a[132:135], v[120:123]
buffer_load_dwordx4 v15, s[8:11], s25 offen offset:3072 lds
v_mfma_f32_16x16x32_bf16 v[124:127], a[120:123], a[128:131], v[124:127]
s_add_u32 s25, s25, 128
v_mfma_f32_16x16x32_bf16 v[124:127], a[124:127], a[132:135], v[124:127]
s_waitcnt lgkmcnt(2)
v_mfma_f32_16x16x32_bf16 v[128:131], a[64:67], a[136:139], v[128:131]
s_mov_b64 s[56:57], s[70:71]
s_mov_b32 s58, 3584
s_mov_b32 s59, 0x20000
ds_read_b64_tr_b16 a[128:129], v8 offset:32768
buffer_load_dwordx4 v[248:251], v252, s[56:59], 0 offen
v_mfma_f32_16x16x32_bf16 v[128:131], a[68:71], a[140:143], v[128:131]
s_mov_b64 s[56:57], s[66:67]
s_mov_b32 s58, 1835008
buffer_load_dword v224, v22, s[56:59], 0 offen nt
v_mfma_f32_16x16x32_bf16 v[132:135], a[72:75], a[136:139], v[132:135]
ds_read_b64_tr_b16 a[130:131], v8 offset:34816
buffer_load_dword v225, v23, s[56:59], 0 offen nt
v_mfma_f32_16x16x32_bf16 v[132:135], a[76:79], a[140:143], v[132:135]
buffer_load_dword v226, v24, s[56:59], 0 offen nt
v_mfma_f32_16x16x32_bf16 v[136:139], a[80:83], a[136:139], v[136:139]
ds_read_b64_tr_b16 a[132:133], v8 offset:49152
buffer_load_dword v227, v25, s[56:59], 0 offen nt
v_mfma_f32_16x16x32_bf16 v[136:139], a[84:87], a[140:143], v[136:139]
buffer_load_dword v228, v254, s[56:59], 0 offen offset:0 nt
v_mfma_f32_16x16x32_bf16 v[140:143], a[88:91], a[136:139], v[140:143]
ds_read_b64_tr_b16 a[134:135], v8 offset:51200
buffer_load_dword v229, v254, s[56:59], 0 offen offset:896 nt
v_mfma_f32_16x16x32_bf16 v[140:143], a[92:95], a[140:143], v[140:143]
buffer_load_dword v230, v254, s[56:59], 0 offen offset:1792 nt
v_mfma_f32_16x16x32_bf16 v[144:147], a[96:99], a[136:139], v[144:147]
ds_read_b128 a[32:35], v2 offset:8192
buffer_load_dword v231, v254, s[56:59], 0 offen offset:2688 nt
v_mfma_f32_16x16x32_bf16 v[144:147], a[100:103], a[140:143], v[144:147]
buffer_load_dword v232, v255, s[56:59], 0 offen offset:0 nt
v_mfma_f32_16x16x32_bf16 v[148:151], a[104:107], a[136:139], v[148:151]
buffer_load_dword v233, v255, s[56:59], 0 offen offset:896 nt
v_mfma_f32_16x16x32_bf16 v[148:151], a[108:111], a[140:143], v[148:151]
buffer_load_dword v234, v255, s[56:59], 0 offen offset:1792 nt
v_mfma_f32_16x16x32_bf16 v[152:155], a[112:115], a[136:139], v[152:155]
ds_read_b128 a[36:39], v3 offset:8192
buffer_load_dword v235, v255, s[56:59], 0 offen offset:2688 nt
v_mfma_f32_16x16x32_bf16 v[152:155], a[116:119], a[140:143], v[152:155]
s_mov_b64 s[56:57], s[68:69]
buffer_load_dword v236, v25, s[56:59], 0 offen nt
v_mfma_f32_16x16x32_bf16 v[156:159], a[120:123], a[136:139], v[156:159]
ds_read_b128 a[40:43], v2 offset:10240
buffer_load_dword v237, v254, s[56:59], 0 offen offset:0 nt
v_mfma_f32_16x16x32_bf16 v[156:159], a[124:127], a[140:143], v[156:159]
s_waitcnt lgkmcnt(5)
buffer_load_dword v238, v254, s[56:59], 0 offen offset:896 nt
v_mfma_f32_16x16x32_bf16 v[160:163], a[64:67], a[128:131], v[160:163]
s_waitcnt lgkmcnt(3)
ds_read_b64_tr_b16 a[136:137], v9 offset:32768
buffer_load_dword v239, v254, s[56:59], 0 offen offset:1792 nt
v_mfma_f32_16x16x32_bf16 v[160:163], a[68:71], a[132:135], v[160:163]
buffer_load_dword v240, v254, s[56:59], 0 offen offset:2688 nt
v_mfma_f32_16x16x32_bf16 v[164:167], a[72:75], a[128:131], v[164:167]
ds_read_b64_tr_b16 a[138:139], v9 offset:34816
buffer_load_dword v241, v255, s[56:59], 0 offen offset:0 nt
v_mfma_f32_16x16x32_bf16 v[164:167], a[76:79], a[132:135], v[164:167]
buffer_load_dword v242, v255, s[56:59], 0 offen offset:896 nt
v_mfma_f32_16x16x32_bf16 v[168:171], a[80:83], a[128:131], v[168:171]
ds_read_b64_tr_b16 a[140:141], v9 offset:49152
buffer_load_dword v243, v255, s[56:59], 0 offen offset:1792 nt
v_mfma_f32_16x16x32_bf16 v[168:171], a[84:87], a[132:135], v[168:171]
buffer_load_dword v244, v255, s[56:59], 0 offen offset:2688 nt
v_mfma_f32_16x16x32_bf16 v[172:175], a[88:91], a[128:131], v[172:175]
ds_read_b64_tr_b16 a[142:143], v9 offset:51200
v_mfma_f32_16x16x32_bf16 v[172:175], a[92:95], a[132:135], v[172:175]
v_mfma_f32_16x16x32_bf16 v[176:179], a[96:99], a[128:131], v[176:179]
v_mfma_f32_16x16x32_bf16 v[176:179], a[100:103], a[132:135], v[176:179]
v_mfma_f32_16x16x32_bf16 v[180:183], a[104:107], a[128:131], v[180:183]
ds_read_b128 a[44:47], v3 offset:10240
v_mfma_f32_16x16x32_bf16 v[180:183], a[108:111], a[132:135], v[180:183]
v_mfma_f32_16x16x32_bf16 v[184:187], a[112:115], a[128:131], v[184:187]
ds_read_b128 a[48:51], v2 offset:12288
v_mfma_f32_16x16x32_bf16 v[184:187], a[116:119], a[132:135], v[184:187]
v_mfma_f32_16x16x32_bf16 v[188:191], a[120:123], a[128:131], v[188:191]
v_mfma_f32_16x16x32_bf16 v[188:191], a[124:127], a[132:135], v[188:191]
s_waitcnt lgkmcnt(4)
v_mfma_f32_16x16x32_bf16 v[192:195], a[64:67], a[136:139], v[192:195]
s_waitcnt lgkmcnt(2)
ds_read_b64_tr_b16 a[128:129], v10 offset:32768
v_mfma_f32_16x16x32_bf16 v[192:195], a[68:71], a[140:143], v[192:195]
v_mfma_f32_16x16x32_bf16 v[196:199], a[72:75], a[136:139], v[196:199]
ds_read_b64_tr_b16 a[130:131], v10 offset:34816
v_mfma_f32_16x16x32_bf16 v[196:199], a[76:79], a[140:143], v[196:199]
v_mfma_f32_16x16x32_bf16 v[200:203], a[80:83], a[136:139], v[200:203]
ds_read_b64_tr_b16 a[132:133], v10 offset:49152
v_mfma_f32_16x16x32_bf16 v[200:203], a[84:87], a[140:143], v[200:203]
v_mfma_f32_16x16x32_bf16 v[204:207], a[88:91], a[136:139], v[204:207]
ds_read_b64_tr_b16 a[134:135], v10 offset:51200
v_mfma_f32_16x16x32_bf16 v[204:207], a[92:95], a[140:143], v[204:207]
v_mfma_f32_16x16x32_bf16 v[208:211], a[96:99], a[136:139], v[208:211]
ds_read_b128 a[52:55], v3 offset:12288
v_mfma_f32_16x16x32_bf16 v[208:211], a[100:103], a[140:143], v[208:211]
v_mfma_f32_16x16x32_bf16 v[212:215], a[104:107], a[136:139], v[212:215]
ds_read_b128 a[56:59], v2 offset:14336
v_mfma_f32_16x16x32_bf16 v[212:215], a[108:111], a[140:143], v[212:215]
v_mfma_f32_16x16x32_bf16 v[216:219], a[112:115], a[136:139], v[216:219]
v_mfma_f32_16x16x32_bf16 v[216:219], a[116:119], a[140:143], v[216:219]
v_mfma_f32_16x16x32_bf16 v[220:223], a[120:123], a[136:139], v[220:223]
ds_read_b128 a[60:63], v3 offset:14336
v_mfma_f32_16x16x32_bf16 v[220:223], a[124:127], a[140:143], v[220:223]
s_waitcnt lgkmcnt(5)
v_mfma_f32_16x16x32_bf16 a[192:195], a[64:67], a[128:131], a[192:195]
s_waitcnt lgkmcnt(3)
ds_read_b64_tr_b16 a[136:137], v11 offset:32768
v_mfma_f32_16x16x32_bf16 a[192:195], a[68:71], a[132:135], a[192:195]
v_mfma_f32_16x16x32_bf16 a[196:199], a[72:75], a[128:131], a[196:199]
ds_read_b64_tr_b16 a[138:139], v11 offset:34816
v_mfma_f32_16x16x32_bf16 a[196:199], a[76:79], a[132:135], a[196:199]
v_mfma_f32_16x16x32_bf16 a[200:203], a[80:83], a[128:131], a[200:203]
ds_read_b64_tr_b16 a[140:141], v11 offset:49152
v_mfma_f32_16x16x32_bf16 a[200:203], a[84:87], a[132:135], a[200:203]
v_mfma_f32_16x16x32_bf16 a[204:207], a[88:91], a[128:131], a[204:207]
ds_read_b64_tr_b16 a[142:143], v11 offset:51200
v_mfma_f32_16x16x32_bf16 a[204:207], a[92:95], a[132:135], a[204:207]
v_mfma_f32_16x16x32_bf16 a[208:211], a[96:99], a[128:131], a[208:211]
v_mfma_f32_16x16x32_bf16 a[208:211], a[100:103], a[132:135], a[208:211]
v_mfma_f32_16x16x32_bf16 a[212:215], a[104:107], a[128:131], a[212:215]
v_mfma_f32_16x16x32_bf16 a[212:215], a[108:111], a[132:135], a[212:215]
v_mfma_f32_16x16x32_bf16 a[216:219], a[112:115], a[128:131], a[216:219]
v_mfma_f32_16x16x32_bf16 a[216:219], a[116:119], a[132:135], a[216:219]
v_mfma_f32_16x16x32_bf16 a[220:223], a[120:123], a[128:131], a[220:223]
v_mfma_f32_16x16x32_bf16 a[220:223], a[124:127], a[132:135], a[220:223]
s_waitcnt vmcnt(22) lgkmcnt(0)
s_barrier
v_mfma_f32_16x16x32_bf16 a[224:227], a[64:67], a[136:139], a[224:227]
s_add_u32 m0, s29, 98304
ds_read_b64_tr_b16 a[128:129], v4 offset:0
v_mfma_f32_16x16x32_bf16 a[224:227], a[68:71], a[140:143], a[224:227]
buffer_load_dwordx4 v16, s[12:15], s26 offen offset:0 lds
v_mfma_f32_16x16x32_bf16 a[228:231], a[72:75], a[136:139], a[228:231]
ds_read_b64_tr_b16 a[130:131], v4 offset:2048
v_mfma_f32_16x16x32_bf16 a[228:231], a[76:79], a[140:143], a[228:231]
v_mfma_f32_16x16x32_bf16 a[232:235], a[80:83], a[136:139], a[232:235]
ds_read_b64_tr_b16 a[132:133], v4 offset:16384
v_mfma_f32_16x16x32_bf16 a[232:235], a[84:87], a[140:143], a[232:235]
buffer_load_dwordx4 v17, s[12:15], s26 offen offset:1024 lds
v_mfma_f32_16x16x32_bf16 a[236:239], a[88:91], a[136:139], a[236:239]
ds_read_b64_tr_b16 a[134:135], v4 offset:18432
v_mfma_f32_16x16x32_bf16 a[236:239], a[92:95], a[140:143], a[236:239]
v_mfma_f32_16x16x32_bf16 a[240:243], a[96:99], a[136:139], a[240:243]
v_mfma_f32_16x16x32_bf16 a[240:243], a[100:103], a[140:143], a[240:243]
buffer_load_dwordx4 v18, s[12:15], s26 offen offset:2048 lds
v_mfma_f32_16x16x32_bf16 a[244:247], a[104:107], a[136:139], a[244:247]
v_mfma_f32_16x16x32_bf16 a[244:247], a[108:111], a[140:143], a[244:247]
v_mfma_f32_16x16x32_bf16 a[248:251], a[112:115], a[136:139], a[248:251]
v_mfma_f32_16x16x32_bf16 a[248:251], a[116:119], a[140:143], a[248:251]
buffer_load_dwordx4 v19, s[12:15], s26 offen offset:3072 lds
v_mfma_f32_16x16x32_bf16 a[252:255], a[120:123], a[136:139], a[252:255]
s_add_u32 s26, s26, 524288
v_mfma_f32_16x16x32_bf16 a[252:255], a[124:127], a[140:143], a[252:255]
s_waitcnt lgkmcnt(2)
v_mfma_f32_16x16x32_bf16 v[32:35], a[0:3], a[128:131], v[32:35]
s_waitcnt lgkmcnt(0)
s_add_u32 m0, s29, 114688
ds_read_b64_tr_b16 a[136:137], v5 offset:0
v_mfma_f32_16x16x32_bf16 v[32:35], a[4:7], a[132:135], v[32:35]
buffer_load_dwordx4 v16, s[12:15], s27 offen offset:0 lds
v_mfma_f32_16x16x32_bf16 v[36:39], a[8:11], a[128:131], v[36:39]
ds_read_b64_tr_b16 a[138:139], v5 offset:2048
v_mfma_f32_16x16x32_bf16 v[36:39], a[12:15], a[132:135], v[36:39]
v_mfma_f32_16x16x32_bf16 v[40:43], a[16:19], a[128:131], v[40:43]
ds_read_b64_tr_b16 a[140:141], v5 offset:16384
v_mfma_f32_16x16x32_bf16 v[40:43], a[20:23], a[132:135], v[40:43]
buffer_load_dwordx4 v17, s[12:15], s27 offen offset:1024 lds
v_mfma_f32_16x16x32_bf16 v[44:47], a[24:27], a[128:131], v[44:47]
ds_read_b64_tr_b16 a[142:143], v5 offset:18432
v_mfma_f32_16x16x32_bf16 v[44:47], a[28:31], a[132:135], v[44:47]
v_mfma_f32_16x16x32_bf16 v[48:51], a[32:35], a[128:131], v[48:51]
ds_read_b128 a[64:67], v2 offset:32768
v_mfma_f32_16x16x32_bf16 v[48:51], a[36:39], a[132:135], v[48:51]
buffer_load_dwordx4 v18, s[12:15], s27 offen offset:2048 lds
v_mfma_f32_16x16x32_bf16 v[52:55], a[40:43], a[128:131], v[52:55]
ds_read_b128 a[68:71], v3 offset:32768
v_mfma_f32_16x16x32_bf16 v[52:55], a[44:47], a[132:135], v[52:55]
v_mfma_f32_16x16x32_bf16 v[56:59], a[48:51], a[128:131], v[56:59]
v_mfma_f32_16x16x32_bf16 v[56:59], a[52:55], a[132:135], v[56:59]
buffer_load_dwordx4 v19, s[12:15], s27 offen offset:3072 lds
v_mfma_f32_16x16x32_bf16 v[60:63], a[56:59], a[128:131], v[60:63]
s_add_u32 s27, s27, 524288
ds_read_b128 a[72:75], v2 offset:34816
v_mfma_f32_16x16x32_bf16 v[60:63], a[60:63], a[132:135], v[60:63]
s_waitcnt lgkmcnt(5)
v_mfma_f32_16x16x32_bf16 v[64:67], a[0:3], a[136:139], v[64:67]
s_waitcnt lgkmcnt(3)
s_add_u32 m0, s28, 0
ds_read_b64_tr_b16 a[128:129], v6 offset:0
v_mfma_f32_16x16x32_bf16 v[64:67], a[4:7], a[140:143], v[64:67]
buffer_load_dwordx4 v12, s[8:11], s24 offen offset:0 lds
v_mfma_f32_16x16x32_bf16 v[68:71], a[8:11], a[136:139], v[68:71]
ds_read_b64_tr_b16 a[130:131], v6 offset:2048
v_mfma_f32_16x16x32_bf16 v[68:71], a[12:15], a[140:143], v[68:71]
v_mfma_f32_16x16x32_bf16 v[72:75], a[16:19], a[136:139], v[72:75]
ds_read_b64_tr_b16 a[132:133], v6 offset:16384
v_mfma_f32_16x16x32_bf16 v[72:75], a[20:23], a[140:143], v[72:75]
buffer_load_dwordx4 v13, s[8:11], s24 offen offset:1024 lds
v_mfma_f32_16x16x32_bf16 v[76:79], a[24:27], a[136:139], v[76:79]
ds_read_b64_tr_b16 a[134:135], v6 offset:18432
v_mfma_f32_16x16x32_bf16 v[76:79], a[28:31], a[140:143], v[76:79]
v_mfma_f32_16x16x32_bf16 v[80:83], a[32:35], a[136:139], v[80:83]
ds_read_b128 a[76:79], v3 offset:34816
v_mfma_f32_16x16x32_bf16 v[80:83], a[36:39], a[140:143], v[80:83]
buffer_load_dwordx4 v14, s[8:11], s24 offen offset:2048 lds
v_mfma_f32_16x16x32_bf16 v[84:87], a[40:43], a[136:139], v[84:87]
v_mfma_f32_16x16x32_bf16 v[84:87], a[44:47], a[140:143], v[84:87]
v_mfma_f32_16x16x32_bf16 v[88:91], a[48:51], a[136:139], v[88:91]
ds_read_b128 a[80:83], v2 offset:36864
v_mfma_f32_16x16x32_bf16 v[88:91], a[52:55], a[140:143], v[88:91]
buffer_load_dwordx4 v15, s[8:11], s24 offen offset:3072 lds
v_mfma_f32_16x16x32_bf16 v[92:95], a[56:59], a[136:139], v[92:95]
s_add_u32 s24, s24, 128
ds_read_b128 a[84:87], v3 offset:36864
v_mfma_f32_16x16x32_bf16 v[92:95], a[60:63], a[140:143], v[92:95]
s_waitcnt lgkmcnt(5)
v_mfma_f32_16x16x32_bf16 v[96:99], a[0:3], a[128:131], v[96:99]
s_waitcnt lgkmcnt(3)
s_add_u32 m0, s28, 4096
ds_read_b64_tr_b16 a[136:137], v7 offset:0
v_mfma_f32_16x16x32_bf16 v[96:99], a[4:7], a[132:135], v[96:99]
buffer_load_dwordx4 v12, s[8:11], s25 offen offset:0 lds
v_mfma_f32_16x16x32_bf16 v[100:103], a[8:11], a[128:131], v[100:103]
ds_read_b64_tr_b16 a[138:139], v7 offset:2048
v_mfma_f32_16x16x32_bf16 v[100:103], a[12:15], a[132:135], v[100:103]
v_mfma_f32_16x16x32_bf16 v[104:107], a[16:19], a[128:131], v[104:107]
ds_read_b64_tr_b16 a[140:141], v7 offset:16384
v_mfma_f32_16x16x32_bf16 v[104:107], a[20:23], a[132:135], v[104:107]
buffer_load_dwordx4 v13, s[8:11], s25 offen offset:1024 lds
v_mfma_f32_16x16x32_bf16 v[108:111], a[24:27], a[128:131], v[108:111]
ds_read_b64_tr_b16 a[142:143], v7 offset:18432
v_mfma_f32_16x16x32_bf16 v[108:111], a[28:31], a[132:135], v[108:111]
v_mfma_f32_16x16x32_bf16 v[112:115], a[32:35], a[128:131], v[112:115]
v_mfma_f32_16x16x32_bf16 v[112:115], a[36:39], a[132:135], v[112:115]
buffer_load_dwordx4 v14, s[8:11], s25 offen offset:2048 lds
v_mfma_f32_16x16x32_bf16 v[116:119], a[40:43], a[128:131], v[116:119]
ds_read_b128 a[88:91], v2 offset:38912
v_mfma_f32_16x16x32_bf16 v[116:119], a[44:47], a[132:135], v[116:119]
v_mfma_f32_16x16x32_bf16 v[120:123], a[48:51], a[128:131], v[120:123]
ds_read_b128 a[92:95], v3 offset:38912
v_mfma_f32_16x16x32_bf16 v[120:123], a[52:55], a[132:135], v[120:123]
buffer_load_dwordx4 v15, s[8:11], s25 offen offset:3072 lds
v_mfma_f32_16x16x32_bf16 v[124:127], a[56:59], a[128:131], v[124:127]
s_add_u32 s25, s25, 128
v_mfma_f32_16x16x32_bf16 v[124:127], a[60:63], a[132:135], v[124:127]
s_waitcnt lgkmcnt(4)
v_mfma_f32_16x16x32_bf16 v[128:131], a[0:3], a[136:139], v[128:131]
s_waitcnt lgkmcnt(2)
ds_read_b64_tr_b16 a[128:129], v8 offset:0
v_mfma_f32_16x16x32_bf16 v[128:131], a[4:7], a[140:143], v[128:131]
buffer_load_dword v21, v20, s[16:19], s43 offen
v_mfma_f32_16x16x32_bf16 v[132:135], a[8:11], a[136:139], v[132:135]
s_add_u32 s43, s43, s47
ds_read_b64_tr_b16 a[130:131], v8 offset:2048
v_mfma_f32_16x16x32_bf16 v[132:135], a[12:15], a[140:143], v[132:135]
s_cmp_ge_u32 s43, s51
v_mfma_f32_16x16x32_bf16 v[136:139], a[16:19], a[136:139], v[136:139]
s_cselect_b32 s43, 0, s43
ds_read_b64_tr_b16 a[132:133], v8 offset:16384
v_mfma_f32_16x16x32_bf16 v[136:139], a[20:23], a[140:143], v[136:139]
s_cselect_b32 s51, s42, s51
v_mfma_f32_16x16x32_bf16 v[140:143], a[24:27], a[136:139], v[140:143]
s_cselect_b64 s[16:17], s[40:41], s[16:17]
ds_read_b64_tr_b16 a[134:135], v8 offset:18432
v_mfma_f32_16x16x32_bf16 v[140:143], a[28:31], a[140:143], v[140:143]
s_cselect_b32 s18, s42, s18
v_mfma_f32_16x16x32_bf16 v[144:147], a[32:35], a[136:139], v[144:147]
s_cselect_b64 s[40:41], s[44:45], s[40:41]
ds_read_b128 a[96:99], v2 offset:40960
v_mfma_f32_16x16x32_bf16 v[144:147], a[36:39], a[140:143], v[144:147]
s_cselect_b32 s42, s46, s42
v_mfma_f32_16x16x32_bf16 v[148:151], a[40:43], a[136:139], v[148:151]
s_cselect_b32 s46, 0, s46
v_mfma_f32_16x16x32_bf16 v[148:151], a[44:47], a[140:143], v[148:151]
s_lshl_b32 s59, s39, 5
v_mfma_f32_16x16x32_bf16 v[152:155], a[48:51], a[136:139], v[152:155]
s_add_u32 s59, s59, s38
ds_read_b128 a[100:103], v3 offset:40960
v_mfma_f32_16x16x32_bf16 v[152:155], a[52:55], a[140:143], v[152:155]
s_lshl_b32 s59, s59, 2
v_mfma_f32_16x16x32_bf16 v[156:159], a[56:59], a[136:139], v[156:159]
s_add_u32 s59, s59, 94392320
ds_read_b128 a[104:107], v2 offset:43008
v_mfma_f32_16x16x32_bf16 v[156:159], a[60:63], a[140:143], v[156:159]
s_waitcnt lgkmcnt(5)
s_cmp_lt_u32 s2, 224
v_mfma_f32_16x16x32_bf16 v[160:163], a[0:3], a[128:131], v[160:163]
s_waitcnt lgkmcnt(3)
s_cselect_b32 s59, s59, 3221225472
ds_read_b64_tr_b16 a[136:137], v9 offset:0
v_mfma_f32_16x16x32_bf16 v[160:163], a[4:7], a[132:135], v[160:163]
s_mov_b32 s58, 0xffff0000
v_mfma_f32_16x16x32_bf16 v[164:167], a[8:11], a[128:131], v[164:167]
ds_read_b64_tr_b16 a[138:139], v9 offset:2048
v_mfma_f32_16x16x32_bf16 v[164:167], a[12:15], a[132:135], v[164:167]
buffer_load_dword v21, v20, s[16:19], s43 offen
v_mfma_f32_16x16x32_bf16 v[168:171], a[16:19], a[128:131], v[168:171]
s_add_u32 s43, s43, s47
ds_read_b64_tr_b16 a[140:141], v9 offset:16384
v_mfma_f32_16x16x32_bf16 v[168:171], a[20:23], a[132:135], v[168:171]
s_cmp_ge_u32 s43, s51
v_mfma_f32_16x16x32_bf16 v[172:175], a[24:27], a[128:131], v[172:175]
s_cselect_b32 s43, 0, s43
ds_read_b64_tr_b16 a[142:143], v9 offset:18432
v_mfma_f32_16x16x32_bf16 v[172:175], a[28:31], a[132:135], v[172:175]
s_cselect_b32 s51, s42, s51
v_mfma_f32_16x16x32_bf16 v[176:179], a[32:35], a[128:131], v[176:179]
s_cselect_b64 s[16:17], s[40:41], s[16:17]
v_mfma_f32_16x16x32_bf16 v[176:179], a[36:39], a[132:135], v[176:179]
s_cselect_b32 s18, s42, s18
v_mfma_f32_16x16x32_bf16 v[180:183], a[40:43], a[128:131], v[180:183]
s_cselect_b64 s[40:41], s[44:45], s[40:41]
ds_read_b128 a[108:111], v3 offset:43008
v_mfma_f32_16x16x32_bf16 v[180:183], a[44:47], a[132:135], v[180:183]
s_cselect_b32 s42, s46, s42
v_mfma_f32_16x16x32_bf16 v[184:187], a[48:51], a[128:131], v[184:187]
s_cselect_b32 s46, 0, s46
ds_read_b128 a[112:115], v2 offset:45056
v_mfma_f32_16x16x32_bf16 v[184:187], a[52:55], a[132:135], v[184:187]
v_mfma_f32_16x16x32_bf16 v[188:191], a[56:59], a[128:131], v[188:191]
v_mfma_f32_16x16x32_bf16 v[188:191], a[60:63], a[132:135], v[188:191]
s_waitcnt lgkmcnt(4)
v_mfma_f32_16x16x32_bf16 v[192:195], a[0:3], a[136:139], v[192:195]
s_waitcnt lgkmcnt(2)
ds_read_b64_tr_b16 a[128:129], v10 offset:0
v_mfma_f32_16x16x32_bf16 v[192:195], a[4:7], a[140:143], v[192:195]
v_mfma_f32_16x16x32_bf16 v[196:199], a[8:11], a[136:139], v[196:199]
ds_read_b64_tr_b16 a[130:131], v10 offset:2048
v_mfma_f32_16x16x32_bf16 v[196:199], a[12:15], a[140:143], v[196:199]
v_mfma_f32_16x16x32_bf16 v[200:203], a[16:19], a[136:139], v[200:203]
ds_read_b64_tr_b16 a[132:133], v10 offset:16384
v_mfma_f32_16x16x32_bf16 v[200:203], a[20:23], a[140:143], v[200:203]
v_mfma_f32_16x16x32_bf16 v[204:207], a[24:27], a[136:139], v[204:207]
ds_read_b64_tr_b16 a[134:135], v10 offset:18432
v_mfma_f32_16x16x32_bf16 v[204:207], a[28:31], a[140:143], v[204:207]
v_mfma_f32_16x16x32_bf16 v[208:211], a[32:35], a[136:139], v[208:211]
ds_read_b128 a[116:119], v3 offset:45056
v_mfma_f32_16x16x32_bf16 v[208:211], a[36:39], a[140:143], v[208:211]
v_mfma_f32_16x16x32_bf16 v[212:215], a[40:43], a[136:139], v[212:215]
ds_read_b128 a[120:123], v2 offset:47104
v_and_b32 v252, 31, v0
v_mfma_f32_16x16x32_bf16 v[212:215], a[44:47], a[140:143], v[212:215]
v_lshrrev_b32 v253, 5, v0
v_xor_b32 v253, v253, v252
v_mfma_f32_16x16x32_bf16 v[216:219], a[48:51], a[136:139], v[216:219]
v_and_b32 v253, 7, v253
v_lshlrev_b32 v252, 8, v252
v_mfma_f32_16x16x32_bf16 v[216:219], a[52:55], a[140:143], v[216:219]
v_lshl_add_u32 v252, v253, 4, v252
v_add_u32 v252, 147456, v252
v_mfma_f32_16x16x32_bf16 v[220:223], a[56:59], a[136:139], v[220:223]
ds_read_b128 a[124:127], v3 offset:47104
v_mfma_f32_16x16x32_bf16 v[220:223], a[60:63], a[140:143], v[220:223]
s_waitcnt lgkmcnt(5)
v_mfma_f32_16x16x32_bf16 a[192:195], a[0:3], a[128:131], a[192:195]
s_waitcnt lgkmcnt(3)
ds_read_b64_tr_b16 a[136:137], v11 offset:0
v_mfma_f32_16x16x32_bf16 a[192:195], a[4:7], a[132:135], a[192:195]
v_mfma_f32_16x16x32_bf16 a[196:199], a[8:11], a[128:131], a[196:199]
ds_read_b64_tr_b16 a[138:139], v11 offset:2048
v_mfma_f32_16x16x32_bf16 a[196:199], a[12:15], a[132:135], a[196:199]
v_mfma_f32_16x16x32_bf16 a[200:203], a[16:19], a[128:131], a[200:203]
ds_read_b64_tr_b16 a[140:141], v11 offset:16384
v_mfma_f32_16x16x32_bf16 a[200:203], a[20:23], a[132:135], a[200:203]
v_mfma_f32_16x16x32_bf16 a[204:207], a[24:27], a[128:131], a[204:207]
ds_read_b64_tr_b16 a[142:143], v11 offset:18432
v_mfma_f32_16x16x32_bf16 a[204:207], a[28:31], a[132:135], a[204:207]
v_mfma_f32_16x16x32_bf16 a[208:211], a[32:35], a[128:131], a[208:211]
v_mfma_f32_16x16x32_bf16 a[208:211], a[36:39], a[132:135], a[208:211]
v_mfma_f32_16x16x32_bf16 a[212:215], a[40:43], a[128:131], a[212:215]
v_mfma_f32_16x16x32_bf16 a[212:215], a[44:47], a[132:135], a[212:215]
v_mfma_f32_16x16x32_bf16 a[216:219], a[48:51], a[128:131], a[216:219]
v_mfma_f32_16x16x32_bf16 a[216:219], a[52:55], a[132:135], a[216:219]
v_mfma_f32_16x16x32_bf16 a[220:223], a[56:59], a[128:131], a[220:223]
v_mfma_f32_16x16x32_bf16 a[220:223], a[60:63], a[132:135], a[220:223]
s_waitcnt vmcnt(2) lgkmcnt(0)
s_barrier
v_mfma_f32_16x16x32_bf16 a[224:227], a[0:3], a[136:139], a[224:227]
s_add_u32 m0, s29, 65536
ds_read_b64_tr_b16 a[128:129], v4 offset:32768
v_lshlrev_b32 v28, 16, v248
v_mfma_f32_16x16x32_bf16 a[224:227], a[4:7], a[140:143], a[224:227]
buffer_load_dwordx4 v16, s[12:15], s26 offen offset:0 lds
v_mfma_f32_16x16x32_bf16 a[228:231], a[8:11], a[136:139], a[228:231]
ds_read_b64_tr_b16 a[130:131], v4 offset:34816
v_and_b32 v29, s58, v248
v_mfma_f32_16x16x32_bf16 a[228:231], a[12:15], a[140:143], a[228:231]
v_lshlrev_b32 v30, 16, v249
v_and_b32 v253, s58, v249
v_mfma_f32_16x16x32_bf16 a[232:235], a[16:19], a[136:139], a[232:235]
ds_read_b64_tr_b16 a[132:133], v4 offset:49152
v_lshlrev_b32 v22, 16, v224
v_mfma_f32_16x16x32_bf16 a[232:235], a[20:23], a[140:143], a[232:235]
buffer_load_dwordx4 v17, s[12:15], s26 offen offset:1024 lds
v_mfma_f32_16x16x32_bf16 a[236:239], a[24:27], a[136:139], a[236:239]
ds_read_b64_tr_b16 a[134:135], v4 offset:51200
v_lshlrev_b32 v23, 16, v225
v_mfma_f32_16x16x32_bf16 a[236:239], a[28:31], a[140:143], a[236:239]
v_lshlrev_b32 v24, 16, v226
v_mul_f32 v254, v22, v253
v_mfma_f32_16x16x32_bf16 a[240:243], a[32:35], a[136:139], a[240:243]
v_lshlrev_b32 v25, 16, v227
v_lshlrev_b32 v247, 16, v236
v_mfma_f32_16x16x32_bf16 a[240:243], a[36:39], a[140:143], a[240:243]
buffer_load_dwordx4 v18, s[12:15], s26 offen offset:2048 lds
v_mfma_f32_16x16x32_bf16 a[244:247], a[40:43], a[136:139], a[244:247]
v_fmac_f32 v254, v23, v30
v_fmac_f32 v254, v24, v29
v_mfma_f32_16x16x32_bf16 a[244:247], a[44:47], a[140:143], a[244:247]
v_fmac_f32 v254, v25, v28
v_mul_f32 v254, v254, v247
v_mfma_f32_16x16x32_bf16 a[248:251], a[48:51], a[136:139], a[248:251]
v_mul_f32 v255, v23, v253
v_lshlrev_b32 v22, 16, v228
v_mfma_f32_16x16x32_bf16 a[248:251], a[52:55], a[140:143], a[248:251]
buffer_load_dwordx4 v19, s[12:15], s26 offen offset:3072 lds
v_mfma_f32_16x16x32_bf16 a[252:255], a[56:59], a[136:139], a[252:255]
s_add_u32 s26, s26, 524288
v_lshlrev_b32 v247, 16, v237
v_fmac_f32 v255, v24, v30
v_mfma_f32_16x16x32_bf16 a[252:255], a[60:63], a[140:143], a[252:255]
s_waitcnt lgkmcnt(0)
v_fmac_f32 v255, v25, v29
v_fmac_f32 v255, v22, v28
v_mfma_f32_16x16x32_bf16 v[32:35], a[64:67], a[128:131], v[32:35]
s_add_u32 m0, s29, 81920
ds_read_b64_tr_b16 a[136:137], v5 offset:32768
v_mul_f32 v255, v255, v247
v_mfma_f32_16x16x32_bf16 v[32:35], a[68:71], a[132:135], v[32:35]
buffer_load_dwordx4 v16, s[12:15], s27 offen offset:0 lds
v_mfma_f32_16x16x32_bf16 v[36:39], a[72:75], a[128:131], v[36:39]
ds_read_b64_tr_b16 a[138:139], v5 offset:34816
v_cvt_pk_bf16_f32 v246, v254, v255
v_mfma_f32_16x16x32_bf16 v[36:39], a[76:79], a[132:135], v[36:39]
v_accvgpr_write_b32 a180, v246
v_mul_f32 v254, v24, v253
v_mfma_f32_16x16x32_bf16 v[40:43], a[80:83], a[128:131], v[40:43]
ds_read_b64_tr_b16 a[140:141], v5 offset:49152
v_lshlrev_b32 v23, 16, v229
v_mfma_f32_16x16x32_bf16 v[40:43], a[84:87], a[132:135], v[40:43]
buffer_load_dwordx4 v17, s[12:15], s27 offen offset:1024 lds
v_lshlrev_b32 v247, 16, v238
v_mfma_f32_16x16x32_bf16 v[44:47], a[88:91], a[128:131], v[44:47]
ds_read_b64_tr_b16 a[142:143], v5 offset:51200
v_fmac_f32 v254, v25, v30
v_mfma_f32_16x16x32_bf16 v[44:47], a[92:95], a[132:135], v[44:47]
v_fmac_f32 v254, v22, v29
v_fmac_f32 v254, v23, v28
v_mfma_f32_16x16x32_bf16 v[48:51], a[96:99], a[128:131], v[48:51]
ds_read_b128 a[0:3], v2 offset:0
v_mul_f32 v254, v254, v247
v_mfma_f32_16x16x32_bf16 v[48:51], a[100:103], a[132:135], v[48:51]
buffer_load_dwordx4 v18, s[12:15], s27 offen offset:2048 lds
v_mfma_f32_16x16x32_bf16 v[52:55], a[104:107], a[128:131], v[52:55]
ds_read_b128 a[4:7], v3 offset:0
v_cvt_pk_bf16_f32 v246, v255, v254
v_accvgpr_write_b32 a176, v246
v_mfma_f32_16x16x32_bf16 v[52:55], a[108:111], a[132:135], v[52:55]
v_mul_f32 v255, v25, v253
v_lshlrev_b32 v24, 16, v230
v_mfma_f32_16x16x32_bf16 v[56:59], a[112:115], a[128:131], v[56:59]
v_lshlrev_b32 v247, 16, v239
v_fmac_f32 v255, v22, v30
v_mfma_f32_16x16x32_bf16 v[56:59], a[116:119], a[132:135], v[56:59]
buffer_load_dwordx4 v19, s[12:15], s27 offen offset:3072 lds
v_mfma_f32_16x16x32_bf16 v[60:63], a[120:123], a[128:131], v[60:63]
s_add_u32 s27, s27, 524288
ds_read_b128 a[8:11], v2 offset:2048
v_fmac_f32 v255, v23, v29
v_mfma_f32_16x16x32_bf16 v[60:63], a[124:127], a[132:135], v[60:63]
s_waitcnt lgkmcnt(3)
v_fmac_f32 v255, v24, v28
v_mul_f32 v255, v255, v247
v_mfma_f32_16x16x32_bf16 v[64:67], a[64:67], a[136:139], v[64:67]
s_add_u32 m0, s28, 32768
ds_read_b64_tr_b16 a[128:129], v6 offset:32768
v_cvt_pk_bf16_f32 v246, v254, v255
v_accvgpr_write_b32 a181, v246
v_mfma_f32_16x16x32_bf16 v[64:67], a[68:71], a[140:143], v[64:67]
buffer_load_dwordx4 v12, s[8:11], s24 offen offset:0 lds
v_mfma_f32_16x16x32_bf16 v[68:71], a[72:75], a[136:139], v[68:71]
ds_read_b64_tr_b16 a[130:131], v6 offset:34816
v_mul_f32 v254, v22, v253
v_mfma_f32_16x16x32_bf16 v[68:71], a[76:79], a[140:143], v[68:71]
v_lshlrev_b32 v25, 16, v231
v_lshlrev_b32 v247, 16, v240
v_mfma_f32_16x16x32_bf16 v[72:75], a[80:83], a[136:139], v[72:75]
ds_read_b64_tr_b16 a[132:133], v6 offset:49152
v_fmac_f32 v254, v23, v30
v_mfma_f32_16x16x32_bf16 v[72:75], a[84:87], a[140:143], v[72:75]
buffer_load_dwordx4 v13, s[8:11], s24 offen offset:1024 lds
v_fmac_f32 v254, v24, v29
v_mfma_f32_16x16x32_bf16 v[76:79], a[88:91], a[136:139], v[76:79]
ds_read_b64_tr_b16 a[134:135], v6 offset:51200
v_fmac_f32 v254, v25, v28
v_mfma_f32_16x16x32_bf16 v[76:79], a[92:95], a[140:143], v[76:79]
v_mul_f32 v254, v254, v247
v_cvt_pk_bf16_f32 v246, v255, v254
v_mfma_f32_16x16x32_bf16 v[80:83], a[96:99], a[136:139], v[80:83]
ds_read_b128 a[12:15], v3 offset:2048
v_accvgpr_write_b32 a177, v246
v_mfma_f32_16x16x32_bf16 v[80:83], a[100:103], a[140:143], v[80:83]
buffer_load_dwordx4 v14, s[8:11], s24 offen offset:2048 lds
v_mfma_f32_16x16x32_bf16 v[84:87], a[104:107], a[136:139], v[84:87]
v_mul_f32 v255, v23, v253
v_lshlrev_b32 v22, 16, v232
v_lshlrev_b32 v247, 16, v241
v_mfma_f32_16x16x32_bf16 v[84:87], a[108:111], a[140:143], v[84:87]
v_fmac_f32 v255, v24, v30
v_fmac_f32 v255, v25, v29
v_mfma_f32_16x16x32_bf16 v[88:91], a[112:115], a[136:139], v[88:91]
ds_read_b128 a[16:19], v2 offset:4096
v_fmac_f32 v255, v22, v28
v_mfma_f32_16x16x32_bf16 v[88:91], a[116:119], a[140:143], v[88:91]
buffer_load_dwordx4 v15, s[8:11], s24 offen offset:3072 lds
v_mfma_f32_16x16x32_bf16 v[92:95], a[120:123], a[136:139], v[92:95]
s_add_u32 s24, s24, 128
ds_read_b128 a[20:23], v3 offset:4096
v_mul_f32 v255, v255, v247
v_mfma_f32_16x16x32_bf16 v[92:95], a[124:127], a[140:143], v[92:95]
s_waitcnt lgkmcnt(3)
v_cvt_pk_bf16_f32 v246, v254, v255
v_accvgpr_write_b32 a182, v246
v_mfma_f32_16x16x32_bf16 v[96:99], a[64:67], a[128:131], v[96:99]
s_add_u32 m0, s28, 36864
ds_read_b64_tr_b16 a[136:137], v7 offset:32768
v_mul_f32 v254, v24, v253
v_lshlrev_b32 v23, 16, v233
v_mfma_f32_16x16x32_bf16 v[96:99], a[68:71], a[132:135], v[96:99]
buffer_load_dwordx4 v12, s[8:11], s25 offen offset:0 lds
v_mfma_f32_16x16x32_bf16 v[100:103], a[72:75], a[128:131], v[100:103]
ds_read_b64_tr_b16 a[138:139], v7 offset:34816
v_lshlrev_b32 v247, 16, v242
v_mfma_f32_16x16x32_bf16 v[100:103], a[76:79], a[132:135], v[100:103]
v_fmac_f32 v254, v25, v30
v_fmac_f32 v254, v22, v29
v_mfma_f32_16x16x32_bf16 v[104:107], a[80:83], a[128:131], v[104:107]
ds_read_b64_tr_b16 a[140:141], v7 offset:49152
v_fmac_f32 v254, v23, v28
v_mfma_f32_16x16x32_bf16 v[104:107], a[84:87], a[132:135], v[104:107]
buffer_load_dwordx4 v13, s[8:11], s25 offen offset:1024 lds
v_mul_f32 v254, v254, v247
v_mfma_f32_16x16x32_bf16 v[108:111], a[88:91], a[128:131], v[108:111]
ds_read_b64_tr_b16 a[142:143], v7 offset:51200
v_cvt_pk_bf16_f32 v246, v255, v254
v_mfma_f32_16x16x32_bf16 v[108:111], a[92:95], a[132:135], v[108:111]
v_accvgpr_write_b32 a178, v246
v_mul_f32 v255, v25, v253
v_mfma_f32_16x16x32_bf16 v[112:115], a[96:99], a[128:131], v[112:115]
v_lshlrev_b32 v24, 16, v234
v_lshlrev_b32 v247, 16, v243
v_mfma_f32_16x16x32_bf16 v[112:115], a[100:103], a[132:135], v[112:115]
buffer_load_dwordx4 v14, s[8:11], s25 offen offset:2048 lds
v_mfma_f32_16x16x32_bf16 v[116:119], a[104:107], a[128:131], v[116:119]
ds_read_b128 a[24:27], v2 offset:6144
v_fmac_f32 v255, v22, v30
v_fmac_f32 v255, v23, v29
v_mfma_f32_16x16x32_bf16 v[116:119], a[108:111], a[132:135], v[116:119]
v_fmac_f32 v255, v24, v28
v_mul_f32 v255, v255, v247
v_mfma_f32_16x16x32_bf16 v[120:123], a[112:115], a[128:131], v[120:123]
ds_read_b128 a[28:31], v3 offset:6144
v_cvt_pk_bf16_f32 v246, v254, v255
v_mfma_f32_16x16x32_bf16 v[120:123], a[116:119], a[132:135], v[120:123]
buffer_load_dwordx4 v15, s[8:11], s25 offen offset:3072 lds
v_mfma_f32_16x16x32_bf16 v[124:127], a[120:123], a[128:131], v[124:127]
s_add_u32 s25, s25, 128
v_accvgpr_write_b32 a183, v246
v_mul_f32 v254, v22, v253
v_mfma_f32_16x16x32_bf16 v[124:127], a[124:127], a[132:135], v[124:127]
s_waitcnt lgkmcnt(4)
v_lshlrev_b32 v25, 16, v235
v_lshlrev_b32 v247, 16, v244
v_mfma_f32_16x16x32_bf16 v[128:131], a[64:67], a[136:139], v[128:131]
s_waitcnt lgkmcnt(2)
ds_read_b64_tr_b16 a[128:129], v8 offset:32768
v_fmac_f32 v254, v23, v30
v_fmac_f32 v254, v24, v29
v_mfma_f32_16x16x32_bf16 v[128:131], a[68:71], a[140:143], v[128:131]
buffer_load_dword v21, v20, s[16:19], s43 offen
v_mfma_f32_16x16x32_bf16 v[132:135], a[72:75], a[136:139], v[132:135]
s_add_u32 s43, s43, s47
ds_read_b64_tr_b16 a[130:131], v8 offset:34816
v_fmac_f32 v254, v25, v28
v_mfma_f32_16x16x32_bf16 v[132:135], a[76:79], a[140:143], v[132:135]
s_cmp_ge_u32 s43, s51
v_mul_f32 v254, v254, v247
v_cvt_pk_bf16_f32 v246, v255, v254
v_mfma_f32_16x16x32_bf16 v[136:139], a[80:83], a[136:139], v[136:139]
s_cselect_b32 s43, 0, s43
ds_read_b64_tr_b16 a[132:133], v8 offset:49152
v_accvgpr_write_b32 a179, v246
v_mfma_f32_16x16x32_bf16 v[136:139], a[84:87], a[140:143], v[136:139]
s_cselect_b32 s51, s42, s51
v_lshlrev_b32 v28, 16, v250
v_and_b32 v29, s58, v250
v_lshlrev_b32 v30, 16, v251
v_mfma_f32_16x16x32_bf16 v[140:143], a[88:91], a[136:139], v[140:143]
s_cselect_b64 s[16:17], s[40:41], s[16:17]
ds_read_b64_tr_b16 a[134:135], v8 offset:51200
v_and_b32 v253, s58, v251
v_mfma_f32_16x16x32_bf16 v[140:143], a[92:95], a[140:143], v[140:143]
s_cselect_b32 s18, s42, s18
v_and_b32 v22, s58, v224
v_and_b32 v23, s58, v225
v_mfma_f32_16x16x32_bf16 v[144:147], a[96:99], a[136:139], v[144:147]
s_cselect_b64 s[40:41], s[44:45], s[40:41]
ds_read_b128 a[32:35], v2 offset:8192
v_and_b32 v24, s58, v226
v_mfma_f32_16x16x32_bf16 v[144:147], a[100:103], a[140:143], v[144:147]
s_cselect_b32 s42, s46, s42
v_mul_f32 v254, v22, v253
v_and_b32 v25, s58, v227
v_mfma_f32_16x16x32_bf16 v[148:151], a[104:107], a[136:139], v[148:151]
s_cselect_b32 s46, 0, s46
v_and_b32 v247, s58, v236
v_fmac_f32 v254, v23, v30
v_mfma_f32_16x16x32_bf16 v[148:151], a[108:111], a[140:143], v[148:151]
buffer_load_dword v245, off, s[60:63], 0 sc1
v_fmac_f32 v254, v24, v29
v_mfma_f32_16x16x32_bf16 v[152:155], a[112:115], a[136:139], v[152:155]
ds_read_b128 a[36:39], v3 offset:8192
v_fmac_f32 v254, v25, v28
v_mfma_f32_16x16x32_bf16 v[152:155], a[116:119], a[140:143], v[152:155]
v_mul_f32 v254, v254, v247
v_mul_f32 v255, v23, v253
v_mfma_f32_16x16x32_bf16 v[156:159], a[120:123], a[136:139], v[156:159]
ds_read_b128 a[40:43], v2 offset:10240
v_and_b32 v22, s58, v228
v_mfma_f32_16x16x32_bf16 v[156:159], a[124:127], a[140:143], v[156:159]
s_waitcnt lgkmcnt(5)
v_and_b32 v247, s58, v237
v_fmac_f32 v255, v24, v30
v_mfma_f32_16x16x32_bf16 v[160:163], a[64:67], a[128:131], v[160:163]
s_waitcnt lgkmcnt(3)
ds_read_b64_tr_b16 a[136:137], v9 offset:32768
v_fmac_f32 v255, v25, v29
v_fmac_f32 v255, v22, v28
v_mfma_f32_16x16x32_bf16 v[160:163], a[68:71], a[132:135], v[160:163]
v_mul_f32 v255, v255, v247
v_cvt_pk_bf16_f32 v246, v254, v255
v_mfma_f32_16x16x32_bf16 v[164:167], a[72:75], a[128:131], v[164:167]
ds_read_b64_tr_b16 a[138:139], v9 offset:34816
v_accvgpr_write_b32 a188, v246
v_mfma_f32_16x16x32_bf16 v[164:167], a[76:79], a[132:135], v[164:167]
v_mul_f32 v254, v24, v253
v_and_b32 v23, s58, v229
v_mfma_f32_16x16x32_bf16 v[168:171], a[80:83], a[128:131], v[168:171]
ds_read_b64_tr_b16 a[140:141], v9 offset:49152
v_and_b32 v247, s58, v238
v_mfma_f32_16x16x32_bf16 v[168:171], a[84:87], a[132:135], v[168:171]
v_fmac_f32 v254, v25, v30
v_fmac_f32 v254, v22, v29
v_fmac_f32 v254, v23, v28
v_mfma_f32_16x16x32_bf16 v[172:175], a[88:91], a[128:131], v[172:175]
ds_read_b64_tr_b16 a[142:143], v9 offset:51200
v_mul_f32 v254, v254, v247
v_mfma_f32_16x16x32_bf16 v[172:175], a[92:95], a[132:135], v[172:175]
v_cvt_pk_bf16_f32 v246, v255, v254
v_accvgpr_write_b32 a184, v246
v_mfma_f32_16x16x32_bf16 v[176:179], a[96:99], a[128:131], v[176:179]
v_mul_f32 v255, v25, v253
v_and_b32 v24, s58, v230
v_mfma_f32_16x16x32_bf16 v[176:179], a[100:103], a[132:135], v[176:179]
v_and_b32 v247, s58, v239
v_fmac_f32 v255, v22, v30
v_mfma_f32_16x16x32_bf16 v[180:183], a[104:107], a[128:131], v[180:183]
ds_read_b128 a[44:47], v3 offset:10240
v_fmac_f32 v255, v23, v29
v_mfma_f32_16x16x32_bf16 v[180:183], a[108:111], a[132:135], v[180:183]
v_fmac_f32 v255, v24, v28
v_mul_f32 v255, v255, v247
v_cvt_pk_bf16_f32 v246, v254, v255
v_mfma_f32_16x16x32_bf16 v[184:187], a[112:115], a[128:131], v[184:187]
ds_read_b128 a[48:51], v2 offset:12288
v_accvgpr_write_b32 a189, v246
v_mfma_f32_16x16x32_bf16 v[184:187], a[116:119], a[132:135], v[184:187]
v_mul_f32 v254, v22, v253
v_and_b32 v25, s58, v231
v_mfma_f32_16x16x32_bf16 v[188:191], a[120:123], a[128:131], v[188:191]
v_and_b32 v247, s58, v240
v_fmac_f32 v254, v23, v30
v_mfma_f32_16x16x32_bf16 v[188:191], a[124:127], a[132:135], v[188:191]
s_waitcnt lgkmcnt(4)
v_fmac_f32 v254, v24, v29
v_fmac_f32 v254, v25, v28
v_mfma_f32_16x16x32_bf16 v[192:195], a[64:67], a[136:139], v[192:195]
s_waitcnt lgkmcnt(2)
ds_read_b64_tr_b16 a[128:129], v10 offset:32768
v_mul_f32 v254, v254, v247
v_cvt_pk_bf16_f32 v246, v255, v254
v_mfma_f32_16x16x32_bf16 v[192:195], a[68:71], a[140:143], v[192:195]
v_accvgpr_write_b32 a185, v246
v_mul_f32 v255, v23, v253
v_mfma_f32_16x16x32_bf16 v[196:199], a[72:75], a[136:139], v[196:199]
ds_read_b64_tr_b16 a[130:131], v10 offset:34816
v_and_b32 v22, s58, v232
v_mfma_f32_16x16x32_bf16 v[196:199], a[76:79], a[140:143], v[196:199]
v_and_b32 v247, s58, v241
v_fmac_f32 v255, v24, v30
v_mfma_f32_16x16x32_bf16 v[200:203], a[80:83], a[136:139], v[200:203]
s_lshr_b32 s22, s3, 1
ds_read_b64_tr_b16 a[132:133], v10 offset:49152
v_fmac_f32 v255, v25, v29
v_mfma_f32_16x16x32_bf16 v[200:203], a[84:87], a[140:143], v[200:203]
s_mul_i32 s22, s22, 2097152
v_fmac_f32 v255, v22, v28
v_mul_f32 v255, v255, v247
v_cvt_pk_bf16_f32 v246, v254, v255
v_mfma_f32_16x16x32_bf16 v[204:207], a[88:91], a[136:139], v[204:207]
s_and_b32 s23, s3, 1
ds_read_b64_tr_b16 a[134:135], v10 offset:51200
v_accvgpr_write_b32 a190, v246
v_mfma_f32_16x16x32_bf16 v[204:207], a[92:95], a[140:143], v[204:207]
s_lshl_b32 s23, s23, 5
v_mul_f32 v254, v24, v253
v_and_b32 v23, s58, v233
v_mfma_f32_16x16x32_bf16 v[208:211], a[96:99], a[136:139], v[208:211]
s_lshl_b32 s56, s39, 6
ds_read_b128 a[52:55], v3 offset:12288
v_and_b32 v247, s58, v242
v_mfma_f32_16x16x32_bf16 v[208:211], a[100:103], a[140:143], v[208:211]
s_add_u32 s23, s23, s56
v_fmac_f32 v254, v25, v30
v_fmac_f32 v254, v22, v29
v_mfma_f32_16x16x32_bf16 v[212:215], a[104:107], a[136:139], v[212:215]
s_mul_i32 s23, s23, 4224
ds_read_b128 a[56:59], v2 offset:14336
v_fmac_f32 v254, v23, v28
v_mfma_f32_16x16x32_bf16 v[212:215], a[108:111], a[140:143], v[212:215]
s_add_u32 s22, s22, s23
v_mul_f32 v254, v254, v247
v_cvt_pk_bf16_f32 v246, v255, v254
v_accvgpr_write_b32 a186, v246
v_mfma_f32_16x16x32_bf16 v[216:219], a[112:115], a[136:139], v[216:219]
s_add_u32 s57, s22, 83886200
v_mul_f32 v255, v25, v253
v_and_b32 v24, s58, v234
v_mfma_f32_16x16x32_bf16 v[216:219], a[116:119], a[140:143], v[216:219]
s_lshl_b32 s23, s38, 7
v_and_b32 v247, s58, v243
v_fmac_f32 v255, v22, v30
v_mfma_f32_16x16x32_bf16 v[220:223], a[120:123], a[136:139], v[220:223]
s_add_u32 s22, s22, s23
ds_read_b128 a[60:63], v3 offset:14336
v_fmac_f32 v255, v23, v29
v_mfma_f32_16x16x32_bf16 v[220:223], a[124:127], a[140:143], v[220:223]
s_waitcnt lgkmcnt(3)
s_add_u32 s56, s22, 83886208
v_fmac_f32 v255, v24, v28
v_mul_f32 v255, v255, v247
v_mfma_f32_16x16x32_bf16 a[192:195], a[64:67], a[128:131], a[192:195]
s_cmp_lt_u32 s2, 224
ds_read_b64_tr_b16 a[136:137], v11 offset:32768
v_cvt_pk_bf16_f32 v246, v254, v255
v_accvgpr_write_b32 a191, v246
v_mfma_f32_16x16x32_bf16 a[192:195], a[68:71], a[132:135], a[192:195]
s_cselect_b32 s56, s56, 3221225472
v_mul_f32 v254, v22, v253
v_and_b32 v25, s58, v235
v_mfma_f32_16x16x32_bf16 a[196:199], a[72:75], a[128:131], a[196:199]
s_cmp_eq_u32 s38, 0
ds_read_b64_tr_b16 a[138:139], v11 offset:34816
v_and_b32 v247, s58, v244
v_mfma_f32_16x16x32_bf16 a[196:199], a[76:79], a[132:135], a[196:199]
s_cselect_b32 s57, s57, 3221225472
v_fmac_f32 v254, v23, v30
v_fmac_f32 v254, v24, v29
v_mfma_f32_16x16x32_bf16 a[200:203], a[80:83], a[128:131], a[200:203]
ds_read_b64_tr_b16 a[140:141], v11 offset:49152
v_fmac_f32 v254, v25, v28
v_mfma_f32_16x16x32_bf16 a[200:203], a[84:87], a[132:135], a[200:203]
v_mul_f32 v254, v254, v247
v_cvt_pk_bf16_f32 v246, v255, v254
v_accvgpr_write_b32 a187, v246
v_mfma_f32_16x16x32_bf16 a[204:207], a[88:91], a[128:131], a[204:207]
ds_read_b64_tr_b16 a[142:143], v11 offset:51200
v_mfma_f32_16x16x32_bf16 a[204:207], a[92:95], a[132:135], a[204:207]
ds_write_b128 v252, a[176:179] offset:0
v_mfma_f32_16x16x32_bf16 a[208:211], a[96:99], a[128:131], a[208:211]
v_mfma_f32_16x16x32_bf16 a[208:211], a[100:103], a[132:135], a[208:211]
ds_write_b128 v252, a[180:183] offset:8192
v_mfma_f32_16x16x32_bf16 a[212:215], a[104:107], a[128:131], a[212:215]
v_mfma_f32_16x16x32_bf16 a[212:215], a[108:111], a[132:135], a[212:215]
ds_write_b128 v252, a[184:187] offset:128
v_mfma_f32_16x16x32_bf16 a[216:219], a[112:115], a[128:131], a[216:219]
v_mfma_f32_16x16x32_bf16 a[216:219], a[116:119], a[132:135], a[216:219]
ds_write_b128 v252, a[188:191] offset:8320
v_mfma_f32_16x16x32_bf16 a[220:223], a[120:123], a[128:131], a[220:223]
v_mfma_f32_16x16x32_bf16 a[220:223], a[124:127], a[132:135], a[220:223]
s_waitcnt vmcnt(2) lgkmcnt(0)
s_barrier
v_mfma_f32_16x16x32_bf16 a[224:227], a[64:67], a[136:139], a[224:227]
s_add_u32 m0, s29, 98304
ds_read_b64_tr_b16 a[128:129], v4 offset:0
v_lshrrev_b32 v22, 8, v1
v_mfma_f32_16x16x32_bf16 a[224:227], a[68:71], a[140:143], a[224:227]
buffer_load_dwordx4 v16, s[12:15], s26 offen offset:0 lds
v_mfma_f32_16x16x32_bf16 a[228:231], a[72:75], a[136:139], a[228:231]
ds_read_b64_tr_b16 a[130:131], v4 offset:2048
v_lshlrev_b32 v22, 4, v22
v_mfma_f32_16x16x32_bf16 a[228:231], a[76:79], a[140:143], a[228:231]
v_xor_b32 v22, v22, v1
v_add_u32 v22, s29, v22
v_mfma_f32_16x16x32_bf16 a[232:235], a[80:83], a[136:139], a[232:235]
ds_read_b64_tr_b16 a[132:133], v4 offset:16384
v_add_u32 v22, 147456, v22
v_mfma_f32_16x16x32_bf16 a[232:235], a[84:87], a[140:143], a[232:235]
buffer_load_dwordx4 v17, s[12:15], s26 offen offset:1024 lds
v_mfma_f32_16x16x32_bf16 a[236:239], a[88:91], a[136:139], a[236:239]
ds_read_b64_tr_b16 a[134:135], v4 offset:18432
v_xor_b32 v23, 64, v22
v_mfma_f32_16x16x32_bf16 a[236:239], a[92:95], a[140:143], a[236:239]
v_lshrrev_b32 v224, 7, v1
v_mul_u32_u24 v224, 4224, v224
v_mfma_f32_16x16x32_bf16 a[240:243], a[96:99], a[136:139], a[240:243]
v_and_b32 v225, 0x70, v1
v_add_u32 v224, v224, v225
v_mfma_f32_16x16x32_bf16 a[240:243], a[100:103], a[140:143], a[240:243]
buffer_load_dwordx4 v18, s[12:15], s26 offen offset:2048 lds
v_mfma_f32_16x16x32_bf16 a[244:247], a[104:107], a[136:139], a[244:247]
v_bfe_u32 v225, v1, 4, 5
v_mul_u32_u24 v225, 4224, v225
v_mfma_f32_16x16x32_bf16 a[244:247], a[108:111], a[140:143], a[244:247]
v_mov_b32 v226, 0
v_mov_b32 v227, 0
v_mfma_f32_16x16x32_bf16 a[248:251], a[112:115], a[136:139], a[248:251]
v_mfma_f32_16x16x32_bf16 a[248:251], a[116:119], a[140:143], a[248:251]
buffer_load_dwordx4 v19, s[12:15], s26 offen offset:3072 lds
v_mfma_f32_16x16x32_bf16 a[252:255], a[120:123], a[136:139], a[252:255]
s_add_u32 s26, s26, 524288
v_mfma_f32_16x16x32_bf16 a[252:255], a[124:127], a[140:143], a[252:255]
s_waitcnt lgkmcnt(2)
v_mfma_f32_16x16x32_bf16 v[32:35], a[0:3], a[128:131], v[32:35]
s_waitcnt lgkmcnt(0)
s_add_u32 m0, s29, 114688
ds_read_b64_tr_b16 a[136:137], v5 offset:0
v_mfma_f32_16x16x32_bf16 v[32:35], a[4:7], a[132:135], v[32:35]
buffer_load_dwordx4 v16, s[12:15], s27 offen offset:0 lds
v_mfma_f32_16x16x32_bf16 v[36:39], a[8:11], a[128:131], v[36:39]
s_mul_i32 s52, s20, 7
ds_read_b64_tr_b16 a[138:139], v5 offset:2048
v_mfma_f32_16x16x32_bf16 v[36:39], a[12:15], a[132:135], v[36:39]
s_add_u32 s52, s52, s21
buffer_store_dwordx2 v[226:227], v225, s[4:7], s57 offen sc1
v_mfma_f32_16x16x32_bf16 v[40:43], a[16:19], a[128:131], v[40:43]
s_lshl_b32 s53, s52, 2
ds_read_b64_tr_b16 a[140:141], v5 offset:16384
v_mfma_f32_16x16x32_bf16 v[40:43], a[20:23], a[132:135], v[40:43]
s_add_u32 s53, s53, s3
buffer_load_dwordx4 v17, s[12:15], s27 offen offset:1024 lds
v_mfma_f32_16x16x32_bf16 v[44:47], a[24:27], a[128:131], v[44:47]
s_lshl_b32 s49, s53, 12
ds_read_b64_tr_b16 a[142:143], v5 offset:18432
v_mfma_f32_16x16x32_bf16 v[44:47], a[28:31], a[132:135], v[44:47]
s_mul_i32 s53, s53, 4224
v_mfma_f32_16x16x32_bf16 v[48:51], a[32:35], a[128:131], v[48:51]
s_add_u32 s53, s53, 83886080
ds_read_b128 a[64:67], v2 offset:32768
v_mfma_f32_16x16x32_bf16 v[48:51], a[36:39], a[132:135], v[48:51]
s_lshr_b32 s52, s52, 4
buffer_load_dwordx4 v18, s[12:15], s27 offen offset:2048 lds
v_mfma_f32_16x16x32_bf16 v[52:55], a[40:43], a[128:131], v[52:55]
s_min_u32 s52, s52, 6
ds_read_b128 a[68:71], v3 offset:32768
v_mfma_f32_16x16x32_bf16 v[52:55], a[44:47], a[132:135], v[52:55]
s_lshl_b32 s52, s52, 7
ds_read_b128 a[176:179], v22 offset:0
v_mfma_f32_16x16x32_bf16 v[56:59], a[48:51], a[128:131], v[56:59]
s_add_u32 s52, s52, 94392320
ds_read_b128 a[180:183], v23 offset:1024
v_mfma_f32_16x16x32_bf16 v[56:59], a[52:55], a[132:135], v[56:59]
buffer_load_dwordx4 v19, s[12:15], s27 offen offset:3072 lds
v_mfma_f32_16x16x32_bf16 v[60:63], a[56:59], a[128:131], v[60:63]
s_add_u32 s27, s27, 524288
ds_read_b128 a[72:75], v2 offset:34816
v_mfma_f32_16x16x32_bf16 v[60:63], a[60:63], a[132:135], v[60:63]
s_waitcnt lgkmcnt(7)
ds_read_b128 a[184:187], v22 offset:2048
v_mfma_f32_16x16x32_bf16 v[64:67], a[0:3], a[136:139], v[64:67]
s_waitcnt lgkmcnt(6)
s_add_u32 m0, s28, 0
ds_read_b64_tr_b16 a[128:129], v6 offset:0
v_mfma_f32_16x16x32_bf16 v[64:67], a[4:7], a[140:143], v[64:67]
buffer_load_dwordx4 v12, s[8:11], s24 offen offset:0 lds
v_mfma_f32_16x16x32_bf16 v[68:71], a[8:11], a[136:139], v[68:71]
ds_read_b64_tr_b16 a[130:131], v6 offset:2048
v_mfma_f32_16x16x32_bf16 v[68:71], a[12:15], a[140:143], v[68:71]
ds_read_b128 a[188:191], v23 offset:3072
v_mfma_f32_16x16x32_bf16 v[72:75], a[16:19], a[136:139], v[72:75]
ds_read_b64_tr_b16 a[132:133], v6 offset:16384
v_bfe_u32 v231, v1, 4, 5
v_mfma_f32_16x16x32_bf16 v[72:75], a[20:23], a[140:143], v[72:75]
buffer_load_dwordx4 v13, s[8:11], s24 offen offset:1024 lds
v_mfma_f32_16x16x32_bf16 v[76:79], a[24:27], a[136:139], v[76:79]
ds_read_b64_tr_b16 a[134:135], v6 offset:18432
v_lshlrev_b32 v231, 2, v231
v_mfma_f32_16x16x32_bf16 v[76:79], a[28:31], a[140:143], v[76:79]
v_lshlrev_b32 v229, 3, v1
v_min_u32 v229, 4096, v229
v_mfma_f32_16x16x32_bf16 v[80:83], a[32:35], a[136:139], v[80:83]
ds_read_b128 a[76:79], v3 offset:34816
v_mfma_f32_16x16x32_bf16 v[80:83], a[36:39], a[140:143], v[80:83]
buffer_load_dwordx4 v14, s[8:11], s24 offen offset:2048 lds
v_mfma_f32_16x16x32_bf16 v[84:87], a[40:43], a[136:139], v[84:87]
v_mfma_f32_16x16x32_bf16 v[84:87], a[44:47], a[140:143], v[84:87]
v_mfma_f32_16x16x32_bf16 v[88:91], a[48:51], a[136:139], v[88:91]
ds_read_b128 a[80:83], v2 offset:36864
v_mfma_f32_16x16x32_bf16 v[88:91], a[52:55], a[140:143], v[88:91]
buffer_load_dwordx4 v15, s[8:11], s24 offen offset:3072 lds
v_mfma_f32_16x16x32_bf16 v[92:95], a[56:59], a[136:139], v[92:95]
s_add_u32 s24, s24, 128
ds_read_b128 a[84:87], v3 offset:36864
v_mfma_f32_16x16x32_bf16 v[92:95], a[60:63], a[140:143], v[92:95]
s_waitcnt lgkmcnt(6)
v_mfma_f32_16x16x32_bf16 v[96:99], a[0:3], a[128:131], v[96:99]
s_waitcnt lgkmcnt(3)
s_add_u32 m0, s28, 4096
ds_read_b64_tr_b16 a[136:137], v7 offset:0
v_mfma_f32_16x16x32_bf16 v[96:99], a[4:7], a[132:135], v[96:99]
buffer_load_dwordx4 v12, s[8:11], s25 offen offset:0 lds
v_mfma_f32_16x16x32_bf16 v[100:103], a[8:11], a[128:131], v[100:103]
ds_read_b64_tr_b16 a[138:139], v7 offset:2048
v_mfma_f32_16x16x32_bf16 v[100:103], a[12:15], a[132:135], v[100:103]
v_mfma_f32_16x16x32_bf16 v[104:107], a[16:19], a[128:131], v[104:107]
ds_read_b64_tr_b16 a[140:141], v7 offset:16384
v_mfma_f32_16x16x32_bf16 v[104:107], a[20:23], a[132:135], v[104:107]
buffer_load_dwordx4 v13, s[8:11], s25 offen offset:1024 lds
v_mfma_f32_16x16x32_bf16 v[108:111], a[24:27], a[128:131], v[108:111]
ds_read_b64_tr_b16 a[142:143], v7 offset:18432
v_mfma_f32_16x16x32_bf16 v[108:111], a[28:31], a[132:135], v[108:111]
v_mfma_f32_16x16x32_bf16 v[112:115], a[32:35], a[128:131], v[112:115]
v_mfma_f32_16x16x32_bf16 v[112:115], a[36:39], a[132:135], v[112:115]
buffer_load_dwordx4 v14, s[8:11], s25 offen offset:2048 lds
v_mfma_f32_16x16x32_bf16 v[116:119], a[40:43], a[128:131], v[116:119]
ds_read_b128 a[88:91], v2 offset:38912
v_mfma_f32_16x16x32_bf16 v[116:119], a[44:47], a[132:135], v[116:119]
v_mfma_f32_16x16x32_bf16 v[120:123], a[48:51], a[128:131], v[120:123]
ds_read_b128 a[92:95], v3 offset:38912
v_mfma_f32_16x16x32_bf16 v[120:123], a[52:55], a[132:135], v[120:123]
buffer_load_dwordx4 v15, s[8:11], s25 offen offset:3072 lds
v_mfma_f32_16x16x32_bf16 v[124:127], a[56:59], a[128:131], v[124:127]
s_add_u32 s25, s25, 128
v_mfma_f32_16x16x32_bf16 v[124:127], a[60:63], a[132:135], v[124:127]
s_waitcnt lgkmcnt(4)
v_mfma_f32_16x16x32_bf16 v[128:131], a[0:3], a[136:139], v[128:131]
s_waitcnt lgkmcnt(2)
ds_read_b64_tr_b16 a[128:129], v8 offset:0
v_mfma_f32_16x16x32_bf16 v[128:131], a[4:7], a[140:143], v[128:131]
buffer_store_dwordx4 a[176:179], v224, s[4:7], s56 offen sc1
v_mfma_f32_16x16x32_bf16 v[132:135], a[8:11], a[136:139], v[132:135]
s_add_u32 s56, s56, 33792
ds_read_b64_tr_b16 a[130:131], v8 offset:2048
v_mfma_f32_16x16x32_bf16 v[132:135], a[12:15], a[140:143], v[132:135]
v_mfma_f32_16x16x32_bf16 v[136:139], a[16:19], a[136:139], v[136:139]
ds_read_b64_tr_b16 a[132:133], v8 offset:16384
v_mfma_f32_16x16x32_bf16 v[136:139], a[20:23], a[140:143], v[136:139]
v_mfma_f32_16x16x32_bf16 v[140:143], a[24:27], a[136:139], v[140:143]
s_cmp_lt_u32 s21, 7
ds_read_b64_tr_b16 a[134:135], v8 offset:18432
v_mfma_f32_16x16x32_bf16 v[140:143], a[28:31], a[140:143], v[140:143]
s_cselect_b32 s53, s53, 3221225472
v_mfma_f32_16x16x32_bf16 v[144:147], a[32:35], a[136:139], v[144:147]
s_cselect_b32 s49, s49, 3221225472
ds_read_b128 a[96:99], v2 offset:40960
v_mfma_f32_16x16x32_bf16 v[144:147], a[36:39], a[140:143], v[144:147]
s_add_u32 s48, s53, 2097152
v_mfma_f32_16x16x32_bf16 v[148:151], a[40:43], a[136:139], v[148:151]
v_mfma_f32_16x16x32_bf16 v[148:151], a[44:47], a[140:143], v[148:151]
v_mfma_f32_16x16x32_bf16 v[152:155], a[48:51], a[136:139], v[152:155]
ds_read_b128 a[100:103], v3 offset:40960
v_mfma_f32_16x16x32_bf16 v[152:155], a[52:55], a[140:143], v[152:155]
v_mfma_f32_16x16x32_bf16 v[156:159], a[56:59], a[136:139], v[156:159]
ds_read_b128 a[104:107], v2 offset:43008
v_mfma_f32_16x16x32_bf16 v[156:159], a[60:63], a[140:143], v[156:159]
s_waitcnt lgkmcnt(5)
v_mfma_f32_16x16x32_bf16 v[160:163], a[0:3], a[128:131], v[160:163]
s_waitcnt lgkmcnt(3)
ds_read_b64_tr_b16 a[136:137], v9 offset:0
v_mfma_f32_16x16x32_bf16 v[160:163], a[4:7], a[132:135], v[160:163]
v_mfma_f32_16x16x32_bf16 v[164:167], a[8:11], a[128:131], v[164:167]
ds_read_b64_tr_b16 a[138:139], v9 offset:2048
v_mfma_f32_16x16x32_bf16 v[164:167], a[12:15], a[132:135], v[164:167]
buffer_store_dwordx4 a[180:183], v224, s[4:7], s56 offen sc1
v_mfma_f32_16x16x32_bf16 v[168:171], a[16:19], a[128:131], v[168:171]
s_add_u32 s56, s56, 33792
ds_read_b64_tr_b16 a[140:141], v9 offset:16384
v_mfma_f32_16x16x32_bf16 v[168:171], a[20:23], a[132:135], v[168:171]
v_mfma_f32_16x16x32_bf16 v[172:175], a[24:27], a[128:131], v[172:175]
ds_read_b64_tr_b16 a[142:143], v9 offset:18432
v_mfma_f32_16x16x32_bf16 v[172:175], a[28:31], a[132:135], v[172:175]
v_mfma_f32_16x16x32_bf16 v[176:179], a[32:35], a[128:131], v[176:179]
v_mfma_f32_16x16x32_bf16 v[176:179], a[36:39], a[132:135], v[176:179]
v_mfma_f32_16x16x32_bf16 v[180:183], a[40:43], a[128:131], v[180:183]
ds_read_b128 a[108:111], v3 offset:43008
v_mfma_f32_16x16x32_bf16 v[180:183], a[44:47], a[132:135], v[180:183]
v_mfma_f32_16x16x32_bf16 v[184:187], a[48:51], a[128:131], v[184:187]
ds_read_b128 a[112:115], v2 offset:45056
v_mfma_f32_16x16x32_bf16 v[184:187], a[52:55], a[132:135], v[184:187]
v_mfma_f32_16x16x32_bf16 v[188:191], a[56:59], a[128:131], v[188:191]
v_mfma_f32_16x16x32_bf16 v[188:191], a[60:63], a[132:135], v[188:191]
s_waitcnt lgkmcnt(4)
v_mfma_f32_16x16x32_bf16 v[192:195], a[0:3], a[136:139], v[192:195]
s_waitcnt lgkmcnt(2)
ds_read_b64_tr_b16 a[128:129], v10 offset:0
v_mfma_f32_16x16x32_bf16 v[192:195], a[4:7], a[140:143], v[192:195]
v_mfma_f32_16x16x32_bf16 v[196:199], a[8:11], a[136:139], v[196:199]
ds_read_b64_tr_b16 a[130:131], v10 offset:2048
v_mfma_f32_16x16x32_bf16 v[196:199], a[12:15], a[140:143], v[196:199]
v_mfma_f32_16x16x32_bf16 v[200:203], a[16:19], a[136:139], v[200:203]
ds_read_b64_tr_b16 a[132:133], v10 offset:16384
v_mfma_f32_16x16x32_bf16 v[200:203], a[20:23], a[140:143], v[200:203]
buffer_store_dwordx4 a[184:187], v224, s[4:7], s56 offen sc1
v_mfma_f32_16x16x32_bf16 v[204:207], a[24:27], a[136:139], v[204:207]
s_add_u32 s56, s56, 33792
ds_read_b64_tr_b16 a[134:135], v10 offset:18432
v_mfma_f32_16x16x32_bf16 v[204:207], a[28:31], a[140:143], v[204:207]
v_mfma_f32_16x16x32_bf16 v[208:211], a[32:35], a[136:139], v[208:211]
ds_read_b128 a[116:119], v3 offset:45056
v_mfma_f32_16x16x32_bf16 v[208:211], a[36:39], a[140:143], v[208:211]
v_mfma_f32_16x16x32_bf16 v[212:215], a[40:43], a[136:139], v[212:215]
ds_read_b128 a[120:123], v2 offset:47104
v_mfma_f32_16x16x32_bf16 v[212:215], a[44:47], a[140:143], v[212:215]
v_mfma_f32_16x16x32_bf16 v[216:219], a[48:51], a[136:139], v[216:219]
v_mfma_f32_16x16x32_bf16 v[216:219], a[52:55], a[140:143], v[216:219]
v_mfma_f32_16x16x32_bf16 v[220:223], a[56:59], a[136:139], v[220:223]
ds_read_b128 a[124:127], v3 offset:47104
v_mfma_f32_16x16x32_bf16 v[220:223], a[60:63], a[140:143], v[220:223]
s_waitcnt lgkmcnt(5)
v_mfma_f32_16x16x32_bf16 a[192:195], a[0:3], a[128:131], a[192:195]
s_waitcnt lgkmcnt(3)
ds_read_b64_tr_b16 a[136:137], v11 offset:0
v_mfma_f32_16x16x32_bf16 a[192:195], a[4:7], a[132:135], a[192:195]
v_mfma_f32_16x16x32_bf16 a[196:199], a[8:11], a[128:131], a[196:199]
ds_read_b64_tr_b16 a[138:139], v11 offset:2048
v_mfma_f32_16x16x32_bf16 a[196:199], a[12:15], a[132:135], a[196:199]
v_mfma_f32_16x16x32_bf16 a[200:203], a[16:19], a[128:131], a[200:203]
ds_read_b64_tr_b16 a[140:141], v11 offset:16384
v_mfma_f32_16x16x32_bf16 a[200:203], a[20:23], a[132:135], a[200:203]
v_mfma_f32_16x16x32_bf16 a[204:207], a[24:27], a[128:131], a[204:207]
ds_read_b64_tr_b16 a[142:143], v11 offset:18432
v_mfma_f32_16x16x32_bf16 a[204:207], a[28:31], a[132:135], a[204:207]
buffer_store_dwordx4 a[188:191], v224, s[4:7], s56 offen sc1
v_mfma_f32_16x16x32_bf16 a[208:211], a[32:35], a[128:131], a[208:211]
s_add_u32 s56, s56, 33792
v_mfma_f32_16x16x32_bf16 a[208:211], a[36:39], a[132:135], a[208:211]
v_mfma_f32_16x16x32_bf16 a[212:215], a[40:43], a[128:131], a[212:215]
v_mfma_f32_16x16x32_bf16 a[212:215], a[44:47], a[132:135], a[212:215]
v_mfma_f32_16x16x32_bf16 a[216:219], a[48:51], a[128:131], a[216:219]
v_mfma_f32_16x16x32_bf16 a[216:219], a[52:55], a[132:135], a[216:219]
v_mfma_f32_16x16x32_bf16 a[220:223], a[56:59], a[128:131], a[220:223]
v_mfma_f32_16x16x32_bf16 a[220:223], a[60:63], a[132:135], a[220:223]
s_waitcnt vmcnt(4) lgkmcnt(0)
s_barrier
v_mfma_f32_16x16x32_bf16 a[224:227], a[0:3], a[136:139], a[224:227]
s_add_u32 m0, s29, 65536
ds_read_b64_tr_b16 a[128:129], v4 offset:32768
v_mfma_f32_16x16x32_bf16 a[224:227], a[4:7], a[140:143], a[224:227]
buffer_load_dwordx4 v16, s[12:15], s26 offen offset:0 lds
v_mfma_f32_16x16x32_bf16 a[228:231], a[8:11], a[136:139], a[228:231]
ds_read_b64_tr_b16 a[130:131], v4 offset:34816
v_cmp_gt_u32 vcc, 0x100, v245
v_mfma_f32_16x16x32_bf16 a[228:231], a[12:15], a[140:143], a[228:231]
v_mfma_f32_16x16x32_bf16 a[232:235], a[16:19], a[136:139], a[232:235]
ds_read_b64_tr_b16 a[132:133], v4 offset:49152
v_mfma_f32_16x16x32_bf16 a[232:235], a[20:23], a[140:143], a[232:235]
buffer_load_dwordx4 v17, s[12:15], s26 offen offset:1024 lds
v_mfma_f32_16x16x32_bf16 a[236:239], a[24:27], a[136:139], a[236:239]
ds_read_b64_tr_b16 a[134:135], v4 offset:51200
v_mfma_f32_16x16x32_bf16 a[236:239], a[28:31], a[140:143], a[236:239]
v_mfma_f32_16x16x32_bf16 a[240:243], a[32:35], a[136:139], a[240:243]
v_mfma_f32_16x16x32_bf16 a[240:243], a[36:39], a[140:143], a[240:243]
buffer_load_dwordx4 v18, s[12:15], s26 offen offset:2048 lds
v_mfma_f32_16x16x32_bf16 a[244:247], a[40:43], a[136:139], a[244:247]
v_mfma_f32_16x16x32_bf16 a[244:247], a[44:47], a[140:143], a[244:247]
v_mfma_f32_16x16x32_bf16 a[248:251], a[48:51], a[136:139], a[248:251]
v_mfma_f32_16x16x32_bf16 a[248:251], a[52:55], a[140:143], a[248:251]
buffer_load_dwordx4 v19, s[12:15], s26 offen offset:3072 lds
v_mfma_f32_16x16x32_bf16 a[252:255], a[56:59], a[136:139], a[252:255]
s_add_u32 s26, s26, 524288
v_mfma_f32_16x16x32_bf16 a[252:255], a[60:63], a[140:143], a[252:255]
s_waitcnt lgkmcnt(2)
s_mov_b32 s82, s59
s_cbranch_vccnz M_cntspinV
s_branch Lg_2
Lg_2t:
buffer_load_dword v230, v231, s[4:7], s52 offen sc1
v_mfma_f32_16x16x32_bf16 v[32:35], a[64:67], a[128:131], v[32:35]
s_waitcnt lgkmcnt(0)
s_add_u32 m0, s29, 81920
ds_read_b64_tr_b16 a[136:137], v5 offset:32768
v_mfma_f32_16x16x32_bf16 v[32:35], a[68:71], a[132:135], v[32:35]
buffer_load_dwordx4 v16, s[12:15], s27 offen offset:0 lds
v_mfma_f32_16x16x32_bf16 v[36:39], a[72:75], a[128:131], v[36:39]
s_and_b32 s44, s3, 1
ds_read_b64_tr_b16 a[138:139], v5 offset:34816
v_mfma_f32_16x16x32_bf16 v[36:39], a[76:79], a[132:135], v[36:39]
s_lshl_b32 s44, s44, 8
v_mfma_f32_16x16x32_bf16 v[40:43], a[80:83], a[128:131], v[40:43]
s_lshl_b32 s45, s3, 7
ds_read_b64_tr_b16 a[140:141], v5 offset:49152
v_mfma_f32_16x16x32_bf16 v[40:43], a[84:87], a[132:135], v[40:43]
s_xor_b32 s44, s44, s45
buffer_load_dwordx4 v17, s[12:15], s27 offen offset:1024 lds
v_mfma_f32_16x16x32_bf16 v[44:47], a[88:91], a[128:131], v[44:47]
s_xor_b32 s44, s44, 196608
ds_read_b64_tr_b16 a[142:143], v5 offset:51200
v_mfma_f32_16x16x32_bf16 v[44:47], a[92:95], a[132:135], v[44:47]
v_mfma_f32_16x16x32_bf16 v[48:51], a[96:99], a[128:131], v[48:51]
ds_read_b128 a[0:3], v2 offset:0
v_mfma_f32_16x16x32_bf16 v[48:51], a[100:103], a[132:135], v[48:51]
buffer_load_dwordx4 v18, s[12:15], s27 offen offset:2048 lds
v_mfma_f32_16x16x32_bf16 v[52:55], a[104:107], a[128:131], v[52:55]
ds_read_b128 a[4:7], v3 offset:0
v_mfma_f32_16x16x32_bf16 v[52:55], a[108:111], a[132:135], v[52:55]
v_mfma_f32_16x16x32_bf16 v[56:59], a[112:115], a[128:131], v[56:59]
v_mfma_f32_16x16x32_bf16 v[56:59], a[116:119], a[132:135], v[56:59]
buffer_load_dwordx4 v19, s[12:15], s27 offen offset:3072 lds
v_mfma_f32_16x16x32_bf16 v[60:63], a[120:123], a[128:131], v[60:63]
s_add_u32 s27, s27, 524288
ds_read_b128 a[8:11], v2 offset:2048
v_mfma_f32_16x16x32_bf16 v[60:63], a[124:127], a[132:135], v[60:63]
s_waitcnt lgkmcnt(5)
v_mfma_f32_16x16x32_bf16 v[64:67], a[64:67], a[136:139], v[64:67]
s_waitcnt lgkmcnt(3)
s_add_u32 m0, s28, 32768
ds_read_b64_tr_b16 a[128:129], v6 offset:32768
v_mfma_f32_16x16x32_bf16 v[64:67], a[68:71], a[140:143], v[64:67]
buffer_load_dwordx4 v12, s[8:11], s24 offen offset:0 lds
v_mfma_f32_16x16x32_bf16 v[68:71], a[72:75], a[136:139], v[68:71]
ds_read_b64_tr_b16 a[130:131], v6 offset:34816
v_mfma_f32_16x16x32_bf16 v[68:71], a[76:79], a[140:143], v[68:71]
v_mfma_f32_16x16x32_bf16 v[72:75], a[80:83], a[136:139], v[72:75]
s_mov_b64 s[56:57], s[72:73]
ds_read_b64_tr_b16 a[132:133], v6 offset:49152
v_mfma_f32_16x16x32_bf16 v[72:75], a[84:87], a[140:143], v[72:75]
s_mov_b32 s58, 1835008
buffer_load_dwordx4 v13, s[8:11], s24 offen offset:1024 lds
v_mfma_f32_16x16x32_bf16 v[76:79], a[88:91], a[136:139], v[76:79]
s_mov_b32 s59, 0x20000
ds_read_b64_tr_b16 a[134:135], v6 offset:51200
v_mfma_f32_16x16x32_bf16 v[76:79], a[92:95], a[140:143], v[76:79]
v_mfma_f32_16x16x32_bf16 v[80:83], a[96:99], a[136:139], v[80:83]
ds_read_b128 a[12:15], v3 offset:2048
v_mfma_f32_16x16x32_bf16 v[80:83], a[100:103], a[140:143], v[80:83]
buffer_load_dwordx4 v14, s[8:11], s24 offen offset:2048 lds
v_mfma_f32_16x16x32_bf16 v[84:87], a[104:107], a[136:139], v[84:87]
v_mfma_f32_16x16x32_bf16 v[84:87], a[108:111], a[140:143], v[84:87]
v_mfma_f32_16x16x32_bf16 v[88:91], a[112:115], a[136:139], v[88:91]
ds_read_b128 a[16:19], v2 offset:4096
v_mfma_f32_16x16x32_bf16 v[88:91], a[116:119], a[140:143], v[88:91]
buffer_load_dwordx4 v15, s[8:11], s24 offen offset:3072 lds
v_mfma_f32_16x16x32_bf16 v[92:95], a[120:123], a[136:139], v[92:95]
s_add_u32 s24, s24, 128
ds_read_b128 a[20:23], v3 offset:4096
v_mfma_f32_16x16x32_bf16 v[92:95], a[124:127], a[140:143], v[92:95]
s_waitcnt lgkmcnt(5)
v_mfma_f32_16x16x32_bf16 v[96:99], a[64:67], a[128:131], v[96:99]
s_waitcnt lgkmcnt(3)
s_add_u32 m0, s28, 36864
ds_read_b64_tr_b16 a[136:137], v7 offset:32768
v_mfma_f32_16x16x32_bf16 v[96:99], a[68:71], a[132:135], v[96:99]
buffer_load_dwordx4 v12, s[8:11], s25 offen offset:0 lds
v_mfma_f32_16x16x32_bf16 v[100:103], a[72:75], a[128:131], v[100:103]
ds_read_b64_tr_b16 a[138:139], v7 offset:34816
v_mfma_f32_16x16x32_bf16 v[100:103], a[76:79], a[132:135], v[100:103]
v_mfma_f32_16x16x32_bf16 v[104:107], a[80:83], a[128:131], v[104:107]
ds_read_b64_tr_b16 a[140:141], v7 offset:49152
v_mfma_f32_16x16x32_bf16 v[104:107], a[84:87], a[132:135], v[104:107]
buffer_load_dwordx4 v13, s[8:11], s25 offen offset:1024 lds
v_mfma_f32_16x16x32_bf16 v[108:111], a[88:91], a[128:131], v[108:111]
ds_read_b64_tr_b16 a[142:143], v7 offset:51200
v_mfma_f32_16x16x32_bf16 v[108:111], a[92:95], a[132:135], v[108:111]
v_mfma_f32_16x16x32_bf16 v[112:115], a[96:99], a[128:131], v[112:115]
v_mfma_f32_16x16x32_bf16 v[112:115], a[100:103], a[132:135], v[112:115]
buffer_load_dwordx4 v14, s[8:11], s25 offen offset:2048 lds
v_mfma_f32_16x16x32_bf16 v[116:119], a[104:107], a[128:131], v[116:119]
ds_read_b128 a[24:27], v2 offset:6144
v_mfma_f32_16x16x32_bf16 v[116:119], a[108:111], a[132:135], v[116:119]
v_mfma_f32_16x16x32_bf16 v[120:123], a[112:115], a[128:131], v[120:123]
ds_read_b128 a[28:31], v3 offset:6144
v_mfma_f32_16x16x32_bf16 v[120:123], a[116:119], a[132:135], v[120:123]
buffer_load_dwordx4 v15, s[8:11], s25 offen offset:3072 lds
v_mfma_f32_16x16x32_bf16 v[124:127], a[120:123], a[128:131], v[124:127]
s_add_u32 s25, s25, 128
s_waitcnt vmcnt(12)
v_mfma_f32_16x16x32_bf16 v[124:127], a[124:127], a[132:135], v[124:127]
s_waitcnt lgkmcnt(4)
v_cmp_gt_u32 vcc, 1, v230
v_mfma_f32_16x16x32_bf16 v[128:131], a[64:67], a[136:139], v[128:131]
s_waitcnt lgkmcnt(2)
s_cbranch_vccnz M_ppspinV
M_ppokV:
ds_read_b64_tr_b16 a[128:129], v8 offset:32768
v_mfma_f32_16x16x32_bf16 v[128:131], a[68:71], a[140:143], v[128:131]
buffer_load_dword v230, v229, s[4:7], s53 offen sc1
v_mfma_f32_16x16x32_bf16 v[132:135], a[72:75], a[136:139], v[132:135]
s_mov_b64 s[8:9], s[76:77]
ds_read_b64_tr_b16 a[130:131], v8 offset:34816
v_mfma_f32_16x16x32_bf16 v[132:135], a[76:79], a[140:143], v[132:135]
s_mov_b32 s10, 1835008
buffer_load_dword v230, v229, s[4:7], s48 offen sc1
v_mfma_f32_16x16x32_bf16 v[136:139], a[80:83], a[136:139], v[136:139]
s_lshl_b32 s24, s37, 2
ds_read_b64_tr_b16 a[132:133], v8 offset:49152
v_mfma_f32_16x16x32_bf16 v[136:139], a[84:87], a[140:143], v[136:139]
s_add_u32 s24, s24, s3
buffer_load_dword v230, v229, s[56:59], s49 offen
v_mfma_f32_16x16x32_bf16 v[140:143], a[88:91], a[136:139], v[140:143]
s_mul_i32 s24, s24, 28672
ds_read_b64_tr_b16 a[134:135], v8 offset:51200
v_mfma_f32_16x16x32_bf16 v[140:143], a[92:95], a[140:143], v[140:143]
s_mov_b32 s28, s29
buffer_load_dword v21, v20, s[16:19], s43 offen
v_mfma_f32_16x16x32_bf16 v[144:147], a[96:99], a[136:139], v[144:147]
ds_read_b128 a[32:35], v2 offset:8192
v_mfma_f32_16x16x32_bf16 v[144:147], a[100:103], a[140:143], v[144:147]
v_mfma_f32_16x16x32_bf16 v[148:151], a[104:107], a[136:139], v[148:151]
v_mfma_f32_16x16x32_bf16 v[148:151], a[108:111], a[140:143], v[148:151]
v_mfma_f32_16x16x32_bf16 v[152:155], a[112:115], a[136:139], v[152:155]
ds_read_b128 a[36:39], v3 offset:8192
v_lshrrev_b32 v28, 7, v1
v_mfma_f32_16x16x32_bf16 v[152:155], a[116:119], a[140:143], v[152:155]
v_lshrrev_b32 v29, 1, v28
v_lshlrev_b32 v29, 4, v29
v_mfma_f32_16x16x32_bf16 v[156:159], a[120:123], a[136:139], v[156:159]
ds_read_b128 a[40:43], v2 offset:10240
v_and_b32 v30, 0x70, v1
v_mfma_f32_16x16x32_bf16 v[156:159], a[124:127], a[140:143], v[156:159]
s_waitcnt lgkmcnt(5)
v_xor_b32 v29, v29, v30
v_mul_u32_u24 v28, 896, v28
v_mfma_f32_16x16x32_bf16 v[160:163], a[64:67], a[128:131], v[160:163]
s_waitcnt lgkmcnt(3)
ds_read_b64_tr_b16 a[136:137], v9 offset:32768
v_add_u32 v12, v28, v29
v_mfma_f32_16x16x32_bf16 v[160:163], a[68:71], a[132:135], v[160:163]
v_xor_b32 v29, 64, v29
v_add_u32 v28, v28, v29
v_mfma_f32_16x16x32_bf16 v[164:167], a[72:75], a[128:131], v[164:167]
ds_read_b64_tr_b16 a[138:139], v9 offset:34816
v_add_u32 v13, 6144, v28
v_mfma_f32_16x16x32_bf16 v[164:167], a[76:79], a[132:135], v[164:167]
v_add_u32 v14, 12288, v12
v_add_u32 v15, 18432, v28
v_mfma_f32_16x16x32_bf16 v[168:171], a[80:83], a[128:131], v[168:171]
ds_read_b64_tr_b16 a[140:141], v9 offset:49152
v_xor_b32 v22, s44, v4
v_mfma_f32_16x16x32_bf16 v[168:171], a[84:87], a[132:135], v[168:171]
v_xor_b32 v23, 32, v22
v_xor_b32 v24, 64, v22
v_mfma_f32_16x16x32_bf16 v[172:175], a[88:91], a[128:131], v[172:175]
ds_read_b64_tr_b16 a[142:143], v9 offset:51200
v_xor_b32 v25, 96, v22
v_mfma_f32_16x16x32_bf16 v[172:175], a[92:95], a[132:135], v[172:175]
v_mfma_f32_16x16x32_bf16 v[176:179], a[96:99], a[128:131], v[176:179]
v_mfma_f32_16x16x32_bf16 v[176:179], a[100:103], a[132:135], v[176:179]
v_mfma_f32_16x16x32_bf16 v[180:183], a[104:107], a[128:131], v[180:183]
ds_read_b128 a[44:47], v3 offset:10240
v_mfma_f32_16x16x32_bf16 v[180:183], a[108:111], a[132:135], v[180:183]
v_mfma_f32_16x16x32_bf16 v[184:187], a[112:115], a[128:131], v[184:187]
ds_read_b128 a[48:51], v2 offset:12288
v_mfma_f32_16x16x32_bf16 v[184:187], a[116:119], a[132:135], v[184:187]
v_mfma_f32_16x16x32_bf16 v[188:191], a[120:123], a[128:131], v[188:191]
v_mfma_f32_16x16x32_bf16 v[188:191], a[124:127], a[132:135], v[188:191]
s_waitcnt lgkmcnt(4)
v_mfma_f32_16x16x32_bf16 v[192:195], a[64:67], a[136:139], v[192:195]
s_waitcnt lgkmcnt(2)
ds_read_b64_tr_b16 a[128:129], v10 offset:32768
v_mfma_f32_16x16x32_bf16 v[192:195], a[68:71], a[140:143], v[192:195]
v_mfma_f32_16x16x32_bf16 v[196:199], a[72:75], a[136:139], v[196:199]
ds_read_b64_tr_b16 a[130:131], v10 offset:34816
v_mfma_f32_16x16x32_bf16 v[196:199], a[76:79], a[140:143], v[196:199]
v_mfma_f32_16x16x32_bf16 v[200:203], a[80:83], a[136:139], v[200:203]
ds_read_b64_tr_b16 a[132:133], v10 offset:49152
v_mfma_f32_16x16x32_bf16 v[200:203], a[84:87], a[140:143], v[200:203]
v_mfma_f32_16x16x32_bf16 v[204:207], a[88:91], a[136:139], v[204:207]
ds_read_b64_tr_b16 a[134:135], v10 offset:51200
v_mfma_f32_16x16x32_bf16 v[204:207], a[92:95], a[140:143], v[204:207]
v_mfma_f32_16x16x32_bf16 v[208:211], a[96:99], a[136:139], v[208:211]
ds_read_b128 a[52:55], v3 offset:12288
v_mfma_f32_16x16x32_bf16 v[208:211], a[100:103], a[140:143], v[208:211]
v_mfma_f32_16x16x32_bf16 v[212:215], a[104:107], a[136:139], v[212:215]
ds_read_b128 a[56:59], v2 offset:14336
v_mfma_f32_16x16x32_bf16 v[212:215], a[108:111], a[140:143], v[212:215]
v_mfma_f32_16x16x32_bf16 v[216:219], a[112:115], a[136:139], v[216:219]
v_mfma_f32_16x16x32_bf16 v[216:219], a[116:119], a[140:143], v[216:219]
v_mfma_f32_16x16x32_bf16 v[220:223], a[120:123], a[136:139], v[220:223]
ds_read_b128 a[60:63], v3 offset:14336
v_mfma_f32_16x16x32_bf16 v[220:223], a[124:127], a[140:143], v[220:223]
s_waitcnt lgkmcnt(5)
v_mfma_f32_16x16x32_bf16 a[192:195], a[64:67], a[128:131], a[192:195]
s_waitcnt lgkmcnt(3)
ds_read_b64_tr_b16 a[136:137], v11 offset:32768
v_mfma_f32_16x16x32_bf16 a[192:195], a[68:71], a[132:135], a[192:195]
v_mfma_f32_16x16x32_bf16 a[196:199], a[72:75], a[128:131], a[196:199]
ds_read_b64_tr_b16 a[138:139], v11 offset:34816
v_mfma_f32_16x16x32_bf16 a[196:199], a[76:79], a[132:135], a[196:199]
v_mfma_f32_16x16x32_bf16 a[200:203], a[80:83], a[128:131], a[200:203]
ds_read_b64_tr_b16 a[140:141], v11 offset:49152
v_mfma_f32_16x16x32_bf16 a[200:203], a[84:87], a[132:135], a[200:203]
v_mfma_f32_16x16x32_bf16 a[204:207], a[88:91], a[128:131], a[204:207]
ds_read_b64_tr_b16 a[142:143], v11 offset:51200
v_mfma_f32_16x16x32_bf16 a[204:207], a[92:95], a[132:135], a[204:207]
v_mfma_f32_16x16x32_bf16 a[208:211], a[96:99], a[128:131], a[208:211]
v_mfma_f32_16x16x32_bf16 a[208:211], a[100:103], a[132:135], a[208:211]
v_mfma_f32_16x16x32_bf16 a[212:215], a[104:107], a[128:131], a[212:215]
v_mfma_f32_16x16x32_bf16 a[212:215], a[108:111], a[132:135], a[212:215]
v_mfma_f32_16x16x32_bf16 a[216:219], a[112:115], a[128:131], a[216:219]
v_mfma_f32_16x16x32_bf16 a[216:219], a[116:119], a[132:135], a[216:219]
v_mfma_f32_16x16x32_bf16 a[220:223], a[120:123], a[128:131], a[220:223]
v_mfma_f32_16x16x32_bf16 a[220:223], a[124:127], a[132:135], a[220:223]
s_waitcnt vmcnt(4) lgkmcnt(0)
s_barrier
v_mfma_f32_16x16x32_bf16 a[224:227], a[64:67], a[136:139], a[224:227]
s_add_u32 m0, s29, 98304
ds_read_b64_tr_b16 a[128:129], v4 offset:0
v_mfma_f32_16x16x32_bf16 a[224:227], a[68:71], a[140:143], a[224:227]
buffer_load_dwordx4 v16, s[12:15], s26 offen offset:0 lds
v_mfma_f32_16x16x32_bf16 a[228:231], a[72:75], a[136:139], a[228:231]
ds_read_b64_tr_b16 a[130:131], v4 offset:2048
v_mfma_f32_16x16x32_bf16 a[228:231], a[76:79], a[140:143], a[228:231]
v_mfma_f32_16x16x32_bf16 a[232:235], a[80:83], a[136:139], a[232:235]
ds_read_b64_tr_b16 a[132:133], v4 offset:16384
v_mfma_f32_16x16x32_bf16 a[232:235], a[84:87], a[140:143], a[232:235]
buffer_load_dwordx4 v17, s[12:15], s26 offen offset:1024 lds
v_mfma_f32_16x16x32_bf16 a[236:239], a[88:91], a[136:139], a[236:239]
ds_read_b64_tr_b16 a[134:135], v4 offset:18432
v_mfma_f32_16x16x32_bf16 a[236:239], a[92:95], a[140:143], a[236:239]
v_mfma_f32_16x16x32_bf16 a[240:243], a[96:99], a[136:139], a[240:243]
v_mfma_f32_16x16x32_bf16 a[240:243], a[100:103], a[140:143], a[240:243]
buffer_load_dwordx4 v18, s[12:15], s26 offen offset:2048 lds
v_mfma_f32_16x16x32_bf16 a[244:247], a[104:107], a[136:139], a[244:247]
v_mfma_f32_16x16x32_bf16 a[244:247], a[108:111], a[140:143], a[244:247]
v_mfma_f32_16x16x32_bf16 a[248:251], a[112:115], a[136:139], a[248:251]
v_mfma_f32_16x16x32_bf16 a[248:251], a[116:119], a[140:143], a[248:251]
buffer_load_dwordx4 v19, s[12:15], s26 offen offset:3072 lds
v_mfma_f32_16x16x32_bf16 a[252:255], a[120:123], a[136:139], a[252:255]
s_add_u32 s26, s26, 524288
v_mfma_f32_16x16x32_bf16 a[252:255], a[124:127], a[140:143], a[252:255]
s_waitcnt lgkmcnt(2)
v_mfma_f32_16x16x32_bf16 v[32:35], a[0:3], a[128:131], v[32:35]
s_waitcnt lgkmcnt(0)
s_add_u32 m0, s29, 114688
ds_read_b64_tr_b16 a[136:137], v5 offset:0
v_mfma_f32_16x16x32_bf16 v[32:35], a[4:7], a[132:135], v[32:35]
buffer_load_dwordx4 v16, s[12:15], s27 offen offset:0 lds
v_mfma_f32_16x16x32_bf16 v[36:39], a[8:11], a[128:131], v[36:39]
ds_read_b64_tr_b16 a[138:139], v5 offset:2048
v_mfma_f32_16x16x32_bf16 v[36:39], a[12:15], a[132:135], v[36:39]
v_mfma_f32_16x16x32_bf16 v[40:43], a[16:19], a[128:131], v[40:43]
ds_read_b64_tr_b16 a[140:141], v5 offset:16384
v_mfma_f32_16x16x32_bf16 v[40:43], a[20:23], a[132:135], v[40:43]
buffer_load_dwordx4 v17, s[12:15], s27 offen offset:1024 lds
v_mfma_f32_16x16x32_bf16 v[44:47], a[24:27], a[128:131], v[44:47]
ds_read_b64_tr_b16 a[142:143], v5 offset:18432
v_mfma_f32_16x16x32_bf16 v[44:47], a[28:31], a[132:135], v[44:47]
v_mfma_f32_16x16x32_bf16 v[48:51], a[32:35], a[128:131], v[48:51]
ds_read_b128 a[64:67], v2 offset:32768
v_mfma_f32_16x16x32_bf16 v[48:51], a[36:39], a[132:135], v[48:51]
buffer_load_dwordx4 v18, s[12:15], s27 offen offset:2048 lds
v_mfma_f32_16x16x32_bf16 v[52:55], a[40:43], a[128:131], v[52:55]
ds_read_b128 a[68:71], v3 offset:32768
v_mfma_f32_16x16x32_bf16 v[52:55], a[44:47], a[132:135], v[52:55]
v_mfma_f32_16x16x32_bf16 v[56:59], a[48:51], a[128:131], v[56:59]
v_mfma_f32_16x16x32_bf16 v[56:59], a[52:55], a[132:135], v[56:59]
buffer_load_dwordx4 v19, s[12:15], s27 offen offset:3072 lds
v_mfma_f32_16x16x32_bf16 v[60:63], a[56:59], a[128:131], v[60:63]
s_add_u32 s27, s27, 524288
ds_read_b128 a[72:75], v2 offset:34816
v_mfma_f32_16x16x32_bf16 v[60:63], a[60:63], a[132:135], v[60:63]
s_waitcnt lgkmcnt(5)
v_mfma_f32_16x16x32_bf16 v[64:67], a[0:3], a[136:139], v[64:67]
s_waitcnt lgkmcnt(3)
s_add_u32 m0, s28, 0
ds_read_b64_tr_b16 a[128:129], v6 offset:0
v_mfma_f32_16x16x32_bf16 v[64:67], a[4:7], a[140:143], v[64:67]
buffer_load_dwordx4 v12, s[8:11], s24 offen offset:0 lds
v_mfma_f32_16x16x32_bf16 v[68:71], a[8:11], a[136:139], v[68:71]
ds_read_b64_tr_b16 a[130:131], v6 offset:2048
v_mfma_f32_16x16x32_bf16 v[68:71], a[12:15], a[140:143], v[68:71]
v_mfma_f32_16x16x32_bf16 v[72:75], a[16:19], a[136:139], v[72:75]
ds_read_b64_tr_b16 a[132:133], v6 offset:16384
v_mfma_f32_16x16x32_bf16 v[72:75], a[20:23], a[140:143], v[72:75]
buffer_load_dwordx4 v13, s[8:11], s24 offen offset:1024 lds
v_mfma_f32_16x16x32_bf16 v[76:79], a[24:27], a[136:139], v[76:79]
ds_read_b64_tr_b16 a[134:135], v6 offset:18432
v_mfma_f32_16x16x32_bf16 v[76:79], a[28:31], a[140:143], v[76:79]
v_mfma_f32_16x16x32_bf16 v[80:83], a[32:35], a[136:139], v[80:83]
ds_read_b128 a[76:79], v3 offset:34816
v_mfma_f32_16x16x32_bf16 v[80:83], a[36:39], a[140:143], v[80:83]
buffer_load_dwordx4 v14, s[8:11], s24 offen offset:2048 lds
v_mfma_f32_16x16x32_bf16 v[84:87], a[40:43], a[136:139], v[84:87]
v_mfma_f32_16x16x32_bf16 v[84:87], a[44:47], a[140:143], v[84:87]
v_mfma_f32_16x16x32_bf16 v[88:91], a[48:51], a[136:139], v[88:91]
ds_read_b128 a[80:83], v2 offset:36864
v_mfma_f32_16x16x32_bf16 v[88:91], a[52:55], a[140:143], v[88:91]
buffer_load_dwordx4 v15, s[8:11], s24 offen offset:3072 lds
v_mfma_f32_16x16x32_bf16 v[92:95], a[56:59], a[136:139], v[92:95]
s_add_u32 s24, s24, 128
ds_read_b128 a[84:87], v3 offset:36864
v_mfma_f32_16x16x32_bf16 v[92:95], a[60:63], a[140:143], v[92:95]
s_waitcnt lgkmcnt(3)
s_mov_b64 s[12:13], s[80:81]
v_mfma_f32_16x16x32_bf16 v[96:99], a[0:3], a[128:131], v[96:99]
s_mov_b32 s14, 3670016
s_add_u32 m0, s28, 16384
ds_read_b64_tr_b16 a[136:137], v7 offset:0
v_mfma_f32_16x16x32_bf16 v[96:99], a[4:7], a[132:135], v[96:99]
buffer_load_dwordx4 v12, s[8:11], s24 offen offset:0 lds
v_mfma_f32_16x16x32_bf16 v[100:103], a[8:11], a[128:131], v[100:103]
ds_read_b64_tr_b16 a[138:139], v7 offset:2048
v_mfma_f32_16x16x32_bf16 v[100:103], a[12:15], a[132:135], v[100:103]
v_mfma_f32_16x16x32_bf16 v[104:107], a[16:19], a[128:131], v[104:107]
ds_read_b64_tr_b16 a[140:141], v7 offset:16384
v_mfma_f32_16x16x32_bf16 v[104:107], a[20:23], a[132:135], v[104:107]
buffer_load_dwordx4 v13, s[8:11], s24 offen offset:1024 lds
v_mfma_f32_16x16x32_bf16 v[108:111], a[24:27], a[128:131], v[108:111]
ds_read_b64_tr_b16 a[142:143], v7 offset:18432
v_mfma_f32_16x16x32_bf16 v[108:111], a[28:31], a[132:135], v[108:111]
v_mfma_f32_16x16x32_bf16 v[112:115], a[32:35], a[128:131], v[112:115]
v_mfma_f32_16x16x32_bf16 v[112:115], a[36:39], a[132:135], v[112:115]
buffer_load_dwordx4 v14, s[8:11], s24 offen offset:2048 lds
v_mfma_f32_16x16x32_bf16 v[116:119], a[40:43], a[128:131], v[116:119]
ds_read_b128 a[88:91], v2 offset:38912
v_mfma_f32_16x16x32_bf16 v[116:119], a[44:47], a[132:135], v[116:119]
v_mfma_f32_16x16x32_bf16 v[120:123], a[48:51], a[128:131], v[120:123]
ds_read_b128 a[92:95], v3 offset:38912
v_mfma_f32_16x16x32_bf16 v[120:123], a[52:55], a[132:135], v[120:123]
buffer_load_dwordx4 v15, s[8:11], s24 offen offset:3072 lds
v_mfma_f32_16x16x32_bf16 v[124:127], a[56:59], a[128:131], v[124:127]
s_add_u32 s24, s24, 128
v_mfma_f32_16x16x32_bf16 v[124:127], a[60:63], a[132:135], v[124:127]
s_waitcnt lgkmcnt(2)
s_sub_u32 s26, s26, 8388608
v_mfma_f32_16x16x32_bf16 v[128:131], a[0:3], a[136:139], v[128:131]
s_sub_u32 s27, s27, 8388608
s_add_u32 m0, s29, 131072
ds_read_b64_tr_b16 a[128:129], v8 offset:0
v_mfma_f32_16x16x32_bf16 v[128:131], a[4:7], a[140:143], v[128:131]
buffer_load_dwordx4 v16, s[12:15], s26 offen offset:0 lds
v_mfma_f32_16x16x32_bf16 v[132:135], a[8:11], a[136:139], v[132:135]
ds_read_b64_tr_b16 a[130:131], v8 offset:2048
v_mfma_f32_16x16x32_bf16 v[132:135], a[12:15], a[140:143], v[132:135]
v_mfma_f32_16x16x32_bf16 v[136:139], a[16:19], a[136:139], v[136:139]
ds_read_b64_tr_b16 a[132:133], v8 offset:16384
v_mfma_f32_16x16x32_bf16 v[136:139], a[20:23], a[140:143], v[136:139]
buffer_load_dwordx4 v17, s[12:15], s26 offen offset:1024 lds
v_mfma_f32_16x16x32_bf16 v[140:143], a[24:27], a[136:139], v[140:143]
ds_read_b64_tr_b16 a[134:135], v8 offset:18432
v_mfma_f32_16x16x32_bf16 v[140:143], a[28:31], a[140:143], v[140:143]
v_mfma_f32_16x16x32_bf16 v[144:147], a[32:35], a[136:139], v[144:147]
ds_read_b128 a[96:99], v2 offset:40960
v_mfma_f32_16x16x32_bf16 v[144:147], a[36:39], a[140:143], v[144:147]
buffer_load_dwordx4 v18, s[12:15], s26 offen offset:2048 lds
v_mfma_f32_16x16x32_bf16 v[148:151], a[40:43], a[136:139], v[148:151]
v_mfma_f32_16x16x32_bf16 v[148:151], a[44:47], a[140:143], v[148:151]
v_mfma_f32_16x16x32_bf16 v[152:155], a[48:51], a[136:139], v[152:155]
ds_read_b128 a[100:103], v3 offset:40960
v_mfma_f32_16x16x32_bf16 v[152:155], a[52:55], a[140:143], v[152:155]
buffer_load_dwordx4 v19, s[12:15], s26 offen offset:3072 lds
v_mfma_f32_16x16x32_bf16 v[156:159], a[56:59], a[136:139], v[156:159]
s_add_u32 s26, s26, 524288
ds_read_b128 a[104:107], v2 offset:43008
v_mfma_f32_16x16x32_bf16 v[156:159], a[60:63], a[140:143], v[156:159]
s_waitcnt lgkmcnt(5)
v_mfma_f32_16x16x32_bf16 v[160:163], a[0:3], a[128:131], v[160:163]
s_waitcnt lgkmcnt(3)
s_add_u32 m0, s29, 147456
ds_read_b64_tr_b16 a[136:137], v9 offset:0
v_mfma_f32_16x16x32_bf16 v[160:163], a[4:7], a[132:135], v[160:163]
buffer_load_dwordx4 v16, s[12:15], s27 offen offset:0 lds
v_mfma_f32_16x16x32_bf16 v[164:167], a[8:11], a[128:131], v[164:167]
ds_read_b64_tr_b16 a[138:139], v9 offset:2048
v_mfma_f32_16x16x32_bf16 v[164:167], a[12:15], a[132:135], v[164:167]
v_mfma_f32_16x16x32_bf16 v[168:171], a[16:19], a[128:131], v[168:171]
ds_read_b64_tr_b16 a[140:141], v9 offset:16384
v_mfma_f32_16x16x32_bf16 v[168:171], a[20:23], a[132:135], v[168:171]
buffer_load_dwordx4 v17, s[12:15], s27 offen offset:1024 lds
v_mfma_f32_16x16x32_bf16 v[172:175], a[24:27], a[128:131], v[172:175]
ds_read_b64_tr_b16 a[142:143], v9 offset:18432
v_mfma_f32_16x16x32_bf16 v[172:175], a[28:31], a[132:135], v[172:175]
v_mfma_f32_16x16x32_bf16 v[176:179], a[32:35], a[128:131], v[176:179]
v_mfma_f32_16x16x32_bf16 v[176:179], a[36:39], a[132:135], v[176:179]
buffer_load_dwordx4 v18, s[12:15], s27 offen offset:2048 lds
v_mfma_f32_16x16x32_bf16 v[180:183], a[40:43], a[128:131], v[180:183]
ds_read_b128 a[108:111], v3 offset:43008
v_mfma_f32_16x16x32_bf16 v[180:183], a[44:47], a[132:135], v[180:183]
v_mfma_f32_16x16x32_bf16 v[184:187], a[48:51], a[128:131], v[184:187]
ds_read_b128 a[112:115], v2 offset:45056
v_mfma_f32_16x16x32_bf16 v[184:187], a[52:55], a[132:135], v[184:187]
buffer_load_dwordx4 v19, s[12:15], s27 offen offset:3072 lds
v_mfma_f32_16x16x32_bf16 v[188:191], a[56:59], a[128:131], v[188:191]
s_add_u32 s27, s27, 524288
v_mfma_f32_16x16x32_bf16 v[188:191], a[60:63], a[132:135], v[188:191]
s_waitcnt lgkmcnt(4)
v_mfma_f32_16x16x32_bf16 v[192:195], a[0:3], a[136:139], v[192:195]
s_waitcnt lgkmcnt(2)
ds_read_b64_tr_b16 a[128:129], v10 offset:0
v_mfma_f32_16x16x32_bf16 v[192:195], a[4:7], a[140:143], v[192:195]
v_mfma_f32_16x16x32_bf16 v[196:199], a[8:11], a[136:139], v[196:199]
ds_read_b64_tr_b16 a[130:131], v10 offset:2048
v_mfma_f32_16x16x32_bf16 v[196:199], a[12:15], a[140:143], v[196:199]
v_mfma_f32_16x16x32_bf16 v[200:203], a[16:19], a[136:139], v[200:203]
ds_read_b64_tr_b16 a[132:133], v10 offset:16384
v_mfma_f32_16x16x32_bf16 v[200:203], a[20:23], a[140:143], v[200:203]
v_mfma_f32_16x16x32_bf16 v[204:207], a[24:27], a[136:139], v[204:207]
ds_read_b64_tr_b16 a[134:135], v10 offset:18432
v_mfma_f32_16x16x32_bf16 v[204:207], a[28:31], a[140:143], v[204:207]
v_mfma_f32_16x16x32_bf16 v[208:211], a[32:35], a[136:139], v[208:211]
ds_read_b128 a[116:119], v3 offset:45056
v_mfma_f32_16x16x32_bf16 v[208:211], a[36:39], a[140:143], v[208:211]
v_mfma_f32_16x16x32_bf16 v[212:215], a[40:43], a[136:139], v[212:215]
ds_read_b128 a[120:123], v2 offset:47104
v_mfma_f32_16x16x32_bf16 v[212:215], a[44:47], a[140:143], v[212:215]
v_mfma_f32_16x16x32_bf16 v[216:219], a[48:51], a[136:139], v[216:219]
v_mfma_f32_16x16x32_bf16 v[216:219], a[52:55], a[140:143], v[216:219]
v_mfma_f32_16x16x32_bf16 v[220:223], a[56:59], a[136:139], v[220:223]
ds_read_b128 a[124:127], v3 offset:47104
v_mfma_f32_16x16x32_bf16 v[220:223], a[60:63], a[140:143], v[220:223]
s_waitcnt lgkmcnt(5)
v_mfma_f32_16x16x32_bf16 a[192:195], a[0:3], a[128:131], a[192:195]
s_waitcnt lgkmcnt(3)
ds_read_b64_tr_b16 a[136:137], v11 offset:0
v_mfma_f32_16x16x32_bf16 a[192:195], a[4:7], a[132:135], a[192:195]
v_mfma_f32_16x16x32_bf16 a[196:199], a[8:11], a[128:131], a[196:199]
ds_read_b64_tr_b16 a[138:139], v11 offset:2048
v_mfma_f32_16x16x32_bf16 a[196:199], a[12:15], a[132:135], a[196:199]
v_mfma_f32_16x16x32_bf16 a[200:203], a[16:19], a[128:131], a[200:203]
ds_read_b64_tr_b16 a[140:141], v11 offset:16384
v_mfma_f32_16x16x32_bf16 a[200:203], a[20:23], a[132:135], a[200:203]
v_mfma_f32_16x16x32_bf16 a[204:207], a[24:27], a[128:131], a[204:207]
ds_read_b64_tr_b16 a[142:143], v11 offset:18432
v_mfma_f32_16x16x32_bf16 a[204:207], a[28:31], a[132:135], a[204:207]
v_mfma_f32_16x16x32_bf16 a[208:211], a[32:35], a[128:131], a[208:211]
v_mfma_f32_16x16x32_bf16 a[208:211], a[36:39], a[132:135], a[208:211]
v_mfma_f32_16x16x32_bf16 a[212:215], a[40:43], a[128:131], a[212:215]
v_mfma_f32_16x16x32_bf16 a[212:215], a[44:47], a[132:135], a[212:215]
v_mfma_f32_16x16x32_bf16 a[216:219], a[48:51], a[128:131], a[216:219]
v_mfma_f32_16x16x32_bf16 a[216:219], a[52:55], a[132:135], a[216:219]
v_mfma_f32_16x16x32_bf16 a[220:223], a[56:59], a[128:131], a[220:223]
v_mfma_f32_16x16x32_bf16 a[220:223], a[60:63], a[132:135], a[220:223]
s_waitcnt vmcnt(12) lgkmcnt(0)
s_barrier
v_mfma_f32_16x16x32_bf16 a[224:227], a[0:3], a[136:139], a[224:227]
s_add_u32 m0, s28, 32768
ds_read_b64_tr_b16 a[128:129], v4 offset:32768
v_mfma_f32_16x16x32_bf16 a[224:227], a[4:7], a[140:143], a[224:227]
s_lshr_b32 s22, s3, 1
buffer_load_dwordx4 v12, s[8:11], s24 offen offset:0 lds
v_mfma_f32_16x16x32_bf16 a[228:231], a[8:11], a[136:139], a[228:231]
s_lshl_b32 s22, s22, 14
ds_read_b64_tr_b16 a[130:131], v4 offset:34816
v_subrev_u32 v2, s22, v2
v_mfma_f32_16x16x32_bf16 a[228:231], a[12:15], a[140:143], a[228:231]
v_subrev_u32 v3, s22, v3
v_mfma_f32_16x16x32_bf16 a[232:235], a[16:19], a[136:139], a[232:235]
ds_read_b64_tr_b16 a[132:133], v4 offset:49152
v_mfma_f32_16x16x32_bf16 a[232:235], a[20:23], a[140:143], a[232:235]
buffer_load_dwordx4 v13, s[8:11], s24 offen offset:1024 lds
v_mfma_f32_16x16x32_bf16 a[236:239], a[24:27], a[136:139], a[236:239]
ds_read_b64_tr_b16 a[134:135], v4 offset:51200
v_mfma_f32_16x16x32_bf16 a[236:239], a[28:31], a[140:143], a[236:239]
v_mfma_f32_16x16x32_bf16 a[240:243], a[32:35], a[136:139], a[240:243]
v_mfma_f32_16x16x32_bf16 a[240:243], a[36:39], a[140:143], a[240:243]
buffer_load_dwordx4 v14, s[8:11], s24 offen offset:2048 lds
v_mfma_f32_16x16x32_bf16 a[244:247], a[40:43], a[136:139], a[244:247]
v_mfma_f32_16x16x32_bf16 a[244:247], a[44:47], a[140:143], a[244:247]
v_mfma_f32_16x16x32_bf16 a[248:251], a[48:51], a[136:139], a[248:251]
v_mfma_f32_16x16x32_bf16 a[248:251], a[52:55], a[140:143], a[248:251]
buffer_load_dwordx4 v15, s[8:11], s24 offen offset:3072 lds
v_mfma_f32_16x16x32_bf16 a[252:255], a[56:59], a[136:139], a[252:255]
s_add_u32 s24, s24, 128
v_mfma_f32_16x16x32_bf16 a[252:255], a[60:63], a[140:143], a[252:255]
s_waitcnt lgkmcnt(2)
v_mfma_f32_16x16x32_bf16 v[32:35], a[64:67], a[128:131], v[32:35]
s_waitcnt lgkmcnt(0)
s_add_u32 m0, s29, 65536
ds_read_b64_tr_b16 a[136:137], v5 offset:32768
v_mfma_f32_16x16x32_bf16 v[32:35], a[68:71], a[132:135], v[32:35]
buffer_load_dwordx4 v16, s[12:15], s26 offen offset:0 lds
v_mfma_f32_16x16x32_bf16 v[36:39], a[72:75], a[128:131], v[36:39]
ds_read_b64_tr_b16 a[138:139], v5 offset:34816
v_mfma_f32_16x16x32_bf16 v[36:39], a[76:79], a[132:135], v[36:39]
v_mfma_f32_16x16x32_bf16 v[40:43], a[80:83], a[128:131], v[40:43]
ds_read_b64_tr_b16 a[140:141], v5 offset:49152
v_mfma_f32_16x16x32_bf16 v[40:43], a[84:87], a[132:135], v[40:43]
buffer_load_dwordx4 v17, s[12:15], s26 offen offset:1024 lds
v_mfma_f32_16x16x32_bf16 v[44:47], a[88:91], a[128:131], v[44:47]
ds_read_b64_tr_b16 a[142:143], v5 offset:51200
v_mfma_f32_16x16x32_bf16 v[44:47], a[92:95], a[132:135], v[44:47]
v_mfma_f32_16x16x32_bf16 v[48:51], a[96:99], a[128:131], v[48:51]
ds_read_b128 a[0:3], v2 offset:0
v_cvt_pk_bf16_f32 v32, v32, v33
v_mfma_f32_16x16x32_bf16 v[48:51], a[100:103], a[132:135], v[48:51]
buffer_load_dwordx4 v18, s[12:15], s26 offen offset:2048 lds
v_mfma_f32_16x16x32_bf16 v[52:55], a[104:107], a[128:131], v[52:55]
ds_read_b128 a[4:7], v3 offset:0
v_cvt_pk_bf16_f32 v33, v34, v35
v_mfma_f32_16x16x32_bf16 v[52:55], a[108:111], a[132:135], v[52:55]
v_cvt_pk_bf16_f32 v34, v36, v37
v_cvt_pk_bf16_f32 v35, v38, v39
v_mfma_f32_16x16x32_bf16 v[56:59], a[112:115], a[128:131], v[56:59]
v_cvt_pk_bf16_f32 v40, v40, v41
v_cvt_pk_bf16_f32 v41, v42, v43
v_mfma_f32_16x16x32_bf16 v[56:59], a[116:119], a[132:135], v[56:59]
buffer_load_dwordx4 v19, s[12:15], s26 offen offset:3072 lds
v_mfma_f32_16x16x32_bf16 v[60:63], a[120:123], a[128:131], v[60:63]
s_add_u32 s26, s26, 524288
ds_read_b128 a[8:11], v2 offset:2048
v_cvt_pk_bf16_f32 v42, v44, v45
v_mfma_f32_16x16x32_bf16 v[60:63], a[124:127], a[132:135], v[60:63]
s_waitcnt lgkmcnt(3)
v_cvt_pk_bf16_f32 v43, v46, v47
v_mfma_f32_16x16x32_bf16 v[64:67], a[64:67], a[136:139], v[64:67]
s_add_u32 m0, s29, 81920
ds_read_b64_tr_b16 a[128:129], v6 offset:32768
v_cvt_pk_bf16_f32 v48, v48, v49
v_mfma_f32_16x16x32_bf16 v[64:67], a[68:71], a[140:143], v[64:67]
buffer_load_dwordx4 v16, s[12:15], s27 offen offset:0 lds
v_mfma_f32_16x16x32_bf16 v[68:71], a[72:75], a[136:139], v[68:71]
ds_read_b64_tr_b16 a[130:131], v6 offset:34816
v_cvt_pk_bf16_f32 v49, v50, v51
v_mfma_f32_16x16x32_bf16 v[68:71], a[76:79], a[140:143], v[68:71]
v_cvt_pk_bf16_f32 v50, v52, v53
v_cvt_pk_bf16_f32 v51, v54, v55
v_mfma_f32_16x16x32_bf16 v[72:75], a[80:83], a[136:139], v[72:75]
ds_read_b64_tr_b16 a[132:133], v6 offset:49152
v_cvt_pk_bf16_f32 v56, v56, v57
v_mfma_f32_16x16x32_bf16 v[72:75], a[84:87], a[140:143], v[72:75]
buffer_load_dwordx4 v17, s[12:15], s27 offen offset:1024 lds
v_mfma_f32_16x16x32_bf16 v[76:79], a[88:91], a[136:139], v[76:79]
ds_read_b64_tr_b16 a[134:135], v6 offset:51200
v_cvt_pk_bf16_f32 v57, v58, v59
v_mfma_f32_16x16x32_bf16 v[76:79], a[92:95], a[140:143], v[76:79]
v_cvt_pk_bf16_f32 v58, v60, v61
v_cvt_pk_bf16_f32 v59, v62, v63
v_mfma_f32_16x16x32_bf16 v[80:83], a[96:99], a[136:139], v[80:83]
ds_read_b128 a[12:15], v3 offset:2048
v_cvt_pk_bf16_f32 v64, v64, v65
v_mfma_f32_16x16x32_bf16 v[80:83], a[100:103], a[140:143], v[80:83]
buffer_load_dwordx4 v18, s[12:15], s27 offen offset:2048 lds
v_mfma_f32_16x16x32_bf16 v[84:87], a[104:107], a[136:139], v[84:87]
v_cvt_pk_bf16_f32 v65, v66, v67
v_cvt_pk_bf16_f32 v66, v68, v69
v_mfma_f32_16x16x32_bf16 v[84:87], a[108:111], a[140:143], v[84:87]
v_cvt_pk_bf16_f32 v67, v70, v71
v_mfma_f32_16x16x32_bf16 v[88:91], a[112:115], a[136:139], v[88:91]
ds_read_b128 a[16:19], v2 offset:4096
v_cvt_pk_bf16_f32 v72, v72, v73
v_mfma_f32_16x16x32_bf16 v[88:91], a[116:119], a[140:143], v[88:91]
buffer_load_dwordx4 v19, s[12:15], s27 offen offset:3072 lds
v_mfma_f32_16x16x32_bf16 v[92:95], a[120:123], a[136:139], v[92:95]
s_add_u32 s27, s27, 524288
ds_read_b128 a[20:23], v3 offset:4096
v_cvt_pk_bf16_f32 v73, v74, v75
v_mfma_f32_16x16x32_bf16 v[92:95], a[124:127], a[140:143], v[92:95]
s_waitcnt lgkmcnt(3)
v_cvt_pk_bf16_f32 v74, v76, v77
v_cvt_pk_bf16_f32 v75, v78, v79
v_mfma_f32_16x16x32_bf16 v[96:99], a[64:67], a[128:131], v[96:99]
s_add_u32 m0, s28, 49152
ds_read_b64_tr_b16 a[136:137], v7 offset:32768
v_cvt_pk_bf16_f32 v80, v80, v81
v_mfma_f32_16x16x32_bf16 v[96:99], a[68:71], a[132:135], v[96:99]
buffer_load_dwordx4 v12, s[8:11], s24 offen offset:0 lds
v_mfma_f32_16x16x32_bf16 v[100:103], a[72:75], a[128:131], v[100:103]
ds_read_b64_tr_b16 a[138:139], v7 offset:34816
v_cvt_pk_bf16_f32 v81, v82, v83
v_mfma_f32_16x16x32_bf16 v[100:103], a[76:79], a[132:135], v[100:103]
v_cvt_pk_bf16_f32 v82, v84, v85
v_cvt_pk_bf16_f32 v83, v86, v87
v_mfma_f32_16x16x32_bf16 v[104:107], a[80:83], a[128:131], v[104:107]
ds_read_b64_tr_b16 a[140:141], v7 offset:49152
v_cvt_pk_bf16_f32 v88, v88, v89
v_mfma_f32_16x16x32_bf16 v[104:107], a[84:87], a[132:135], v[104:107]
buffer_load_dwordx4 v13, s[8:11], s24 offen offset:1024 lds
v_mfma_f32_16x16x32_bf16 v[108:111], a[88:91], a[128:131], v[108:111]
ds_read_b64_tr_b16 a[142:143], v7 offset:51200
v_cvt_pk_bf16_f32 v89, v90, v91
v_mfma_f32_16x16x32_bf16 v[108:111], a[92:95], a[132:135], v[108:111]
v_cvt_pk_bf16_f32 v90, v92, v93
v_cvt_pk_bf16_f32 v91, v94, v95
v_mfma_f32_16x16x32_bf16 v[112:115], a[96:99], a[128:131], v[112:115]
v_cvt_pk_bf16_f32 v96, v96, v97
v_cvt_pk_bf16_f32 v97, v98, v99
v_mfma_f32_16x16x32_bf16 v[112:115], a[100:103], a[132:135], v[112:115]
buffer_load_dwordx4 v14, s[8:11], s24 offen offset:2048 lds
v_mfma_f32_16x16x32_bf16 v[116:119], a[104:107], a[128:131], v[116:119]
ds_read_b128 a[24:27], v2 offset:6144
v_cvt_pk_bf16_f32 v98, v100, v101
v_mfma_f32_16x16x32_bf16 v[116:119], a[108:111], a[132:135], v[116:119]
buffer_store_dwordx4 v[32:35], v1, s[4:7], s31 offen sc1
v_mfma_f32_16x16x32_bf16 v[120:123], a[112:115], a[128:131], v[120:123]
s_add_u32 s31, s31, s32
ds_read_b128 a[28:31], v3 offset:6144
v_cvt_pk_bf16_f32 v99, v102, v103
v_mfma_f32_16x16x32_bf16 v[120:123], a[116:119], a[132:135], v[120:123]
buffer_load_dwordx4 v15, s[8:11], s24 offen offset:3072 lds
v_mfma_f32_16x16x32_bf16 v[124:127], a[120:123], a[128:131], v[124:127]
s_add_u32 s24, s24, 128
v_cvt_pk_bf16_f32 v104, v104, v105
v_cvt_pk_bf16_f32 v105, v106, v107
v_mfma_f32_16x16x32_bf16 v[124:127], a[124:127], a[132:135], v[124:127]
s_waitcnt lgkmcnt(4)
v_cvt_pk_bf16_f32 v106, v108, v109
v_cvt_pk_bf16_f32 v107, v110, v111
v_mfma_f32_16x16x32_bf16 v[128:131], a[64:67], a[136:139], v[128:131]
s_waitcnt lgkmcnt(2)
ds_read_b64_tr_b16 a[128:129], v8 offset:32768
v_cvt_pk_bf16_f32 v112, v112, v113
v_mfma_f32_16x16x32_bf16 v[128:131], a[68:71], a[140:143], v[128:131]
v_cvt_pk_bf16_f32 v113, v114, v115
v_cvt_pk_bf16_f32 v114, v116, v117
v_mfma_f32_16x16x32_bf16 v[132:135], a[72:75], a[136:139], v[132:135]
ds_read_b64_tr_b16 a[130:131], v8 offset:34816
v_cvt_pk_bf16_f32 v115, v118, v119
v_mfma_f32_16x16x32_bf16 v[132:135], a[76:79], a[140:143], v[132:135]
buffer_store_dwordx4 v[40:43], v1, s[4:7], s31 offen sc1
v_mfma_f32_16x16x32_bf16 v[136:139], a[80:83], a[136:139], v[136:139]
s_add_u32 s31, s31, s33
ds_read_b64_tr_b16 a[132:133], v8 offset:49152
v_cvt_pk_bf16_f32 v120, v120, v121
v_mfma_f32_16x16x32_bf16 v[136:139], a[84:87], a[140:143], v[136:139]
v_cvt_pk_bf16_f32 v121, v122, v123
v_cvt_pk_bf16_f32 v122, v124, v125
v_mfma_f32_16x16x32_bf16 v[140:143], a[88:91], a[136:139], v[140:143]
ds_read_b64_tr_b16 a[134:135], v8 offset:51200
v_cvt_pk_bf16_f32 v123, v126, v127
v_mfma_f32_16x16x32_bf16 v[140:143], a[92:95], a[140:143], v[140:143]
v_mfma_f32_16x16x32_bf16 v[144:147], a[96:99], a[136:139], v[144:147]
ds_read_b128 a[32:35], v2 offset:8192
v_cvt_pk_bf16_f32 v128, v128, v129
v_mfma_f32_16x16x32_bf16 v[144:147], a[100:103], a[140:143], v[144:147]
v_cvt_pk_bf16_f32 v129, v130, v131
v_cvt_pk_bf16_f32 v130, v132, v133
v_mfma_f32_16x16x32_bf16 v[148:151], a[104:107], a[136:139], v[148:151]
v_cvt_pk_bf16_f32 v131, v134, v135
v_mfma_f32_16x16x32_bf16 v[148:151], a[108:111], a[140:143], v[148:151]
v_mfma_f32_16x16x32_bf16 v[152:155], a[112:115], a[136:139], v[152:155]
ds_read_b128 a[36:39], v3 offset:8192
v_cvt_pk_bf16_f32 v136, v136, v137
v_mfma_f32_16x16x32_bf16 v[152:155], a[116:119], a[140:143], v[152:155]
v_cvt_pk_bf16_f32 v137, v138, v139
v_cvt_pk_bf16_f32 v138, v140, v141
v_mfma_f32_16x16x32_bf16 v[156:159], a[120:123], a[136:139], v[156:159]
ds_read_b128 a[40:43], v2 offset:10240
v_cvt_pk_bf16_f32 v139, v142, v143
v_mfma_f32_16x16x32_bf16 v[156:159], a[124:127], a[140:143], v[156:159]
s_waitcnt lgkmcnt(3)
buffer_store_dwordx4 v[48:51], v1, s[4:7], s31 offen sc1
v_mfma_f32_16x16x32_bf16 v[160:163], a[64:67], a[128:131], v[160:163]
s_add_u32 s31, s31, s32
ds_read_b64_tr_b16 a[136:137], v9 offset:32768
v_cvt_pk_bf16_f32 v144, v144, v145
v_mfma_f32_16x16x32_bf16 v[160:163], a[68:71], a[132:135], v[160:163]
v_cvt_pk_bf16_f32 v145, v146, v147
v_cvt_pk_bf16_f32 v146, v148, v149
v_mfma_f32_16x16x32_bf16 v[164:167], a[72:75], a[128:131], v[164:167]
ds_read_b64_tr_b16 a[138:139], v9 offset:34816
v_cvt_pk_bf16_f32 v147, v150, v151
v_mfma_f32_16x16x32_bf16 v[164:167], a[76:79], a[132:135], v[164:167]
v_mfma_f32_16x16x32_bf16 v[168:171], a[80:83], a[128:131], v[168:171]
ds_read_b64_tr_b16 a[140:141], v9 offset:49152
v_cvt_pk_bf16_f32 v152, v152, v153
v_mfma_f32_16x16x32_bf16 v[168:171], a[84:87], a[132:135], v[168:171]
v_cvt_pk_bf16_f32 v153, v154, v155
v_cvt_pk_bf16_f32 v154, v156, v157
v_mfma_f32_16x16x32_bf16 v[172:175], a[88:91], a[128:131], v[172:175]
ds_read_b64_tr_b16 a[142:143], v9 offset:51200
v_cvt_pk_bf16_f32 v155, v158, v159
v_mfma_f32_16x16x32_bf16 v[172:175], a[92:95], a[132:135], v[172:175]
v_mfma_f32_16x16x32_bf16 v[176:179], a[96:99], a[128:131], v[176:179]
buffer_store_dwordx4 v[56:59], v1, s[4:7], s31 offen sc1
v_mfma_f32_16x16x32_bf16 v[176:179], a[100:103], a[132:135], v[176:179]
s_add_u32 s31, s31, s34
v_cvt_pk_bf16_f32 v160, v160, v161
v_cvt_pk_bf16_f32 v161, v162, v163
v_mfma_f32_16x16x32_bf16 v[180:183], a[104:107], a[128:131], v[180:183]
ds_read_b128 a[44:47], v3 offset:10240
v_cvt_pk_bf16_f32 v162, v164, v165
v_mfma_f32_16x16x32_bf16 v[180:183], a[108:111], a[132:135], v[180:183]
v_cvt_pk_bf16_f32 v163, v166, v167
v_mfma_f32_16x16x32_bf16 v[184:187], a[112:115], a[128:131], v[184:187]
ds_read_b128 a[48:51], v2 offset:12288
v_cvt_pk_bf16_f32 v168, v168, v169
v_mfma_f32_16x16x32_bf16 v[184:187], a[116:119], a[132:135], v[184:187]
v_cvt_pk_bf16_f32 v169, v170, v171
v_cvt_pk_bf16_f32 v170, v172, v173
v_mfma_f32_16x16x32_bf16 v[188:191], a[120:123], a[128:131], v[188:191]
v_cvt_pk_bf16_f32 v171, v174, v175
v_mfma_f32_16x16x32_bf16 v[188:191], a[124:127], a[132:135], v[188:191]
s_waitcnt lgkmcnt(4)
v_mfma_f32_16x16x32_bf16 v[192:195], a[64:67], a[136:139], v[192:195]
s_waitcnt lgkmcnt(2)
ds_read_b64_tr_b16 a[128:129], v10 offset:32768
v_cvt_pk_bf16_f32 v176, v176, v177
v_mfma_f32_16x16x32_bf16 v[192:195], a[68:71], a[140:143], v[192:195]
v_cvt_pk_bf16_f32 v177, v178, v179
v_cvt_pk_bf16_f32 v178, v180, v181
v_mfma_f32_16x16x32_bf16 v[196:199], a[72:75], a[136:139], v[196:199]
ds_read_b64_tr_b16 a[130:131], v10 offset:34816
v_cvt_pk_bf16_f32 v179, v182, v183
v_mfma_f32_16x16x32_bf16 v[196:199], a[76:79], a[140:143], v[196:199]
buffer_store_dwordx4 v[64:67], v1, s[4:7], s31 offen sc1
v_mfma_f32_16x16x32_bf16 v[200:203], a[80:83], a[136:139], v[200:203]
s_add_u32 s31, s31, s32
ds_read_b64_tr_b16 a[132:133], v10 offset:49152
v_cvt_pk_bf16_f32 v184, v184, v185
v_mfma_f32_16x16x32_bf16 v[200:203], a[84:87], a[140:143], v[200:203]
v_cvt_pk_bf16_f32 v185, v186, v187
v_cvt_pk_bf16_f32 v186, v188, v189
v_mfma_f32_16x16x32_bf16 v[204:207], a[88:91], a[136:139], v[204:207]
ds_read_b64_tr_b16 a[134:135], v10 offset:51200
v_cvt_pk_bf16_f32 v187, v190, v191
v_mfma_f32_16x16x32_bf16 v[204:207], a[92:95], a[140:143], v[204:207]
v_mfma_f32_16x16x32_bf16 v[208:211], a[96:99], a[136:139], v[208:211]
ds_read_b128 a[52:55], v3 offset:12288
v_cvt_pk_bf16_f32 v192, v192, v193
v_mfma_f32_16x16x32_bf16 v[208:211], a[100:103], a[140:143], v[208:211]
v_cvt_pk_bf16_f32 v193, v194, v195
v_cvt_pk_bf16_f32 v194, v196, v197
v_mfma_f32_16x16x32_bf16 v[212:215], a[104:107], a[136:139], v[212:215]
ds_read_b128 a[56:59], v2 offset:14336
v_cvt_pk_bf16_f32 v195, v198, v199
v_mfma_f32_16x16x32_bf16 v[212:215], a[108:111], a[140:143], v[212:215]
v_mfma_f32_16x16x32_bf16 v[216:219], a[112:115], a[136:139], v[216:219]
v_cvt_pk_bf16_f32 v200, v200, v201
v_cvt_pk_bf16_f32 v201, v202, v203
v_mfma_f32_16x16x32_bf16 v[216:219], a[116:119], a[140:143], v[216:219]
buffer_store_dwordx4 v[72:75], v1, s[4:7], s31 offen sc1
v_mfma_f32_16x16x32_bf16 v[220:223], a[120:123], a[136:139], v[220:223]
s_add_u32 s31, s31, s33
ds_read_b128 a[60:63], v3 offset:14336
v_cvt_pk_bf16_f32 v202, v204, v205
v_mfma_f32_16x16x32_bf16 v[220:223], a[124:127], a[140:143], v[220:223]
s_waitcnt lgkmcnt(5)
v_cvt_pk_bf16_f32 v203, v206, v207
v_mfma_f32_16x16x32_bf16 a[192:195], a[64:67], a[128:131], a[192:195]
s_waitcnt lgkmcnt(3)
ds_read_b64_tr_b16 a[136:137], v11 offset:32768
v_cvt_pk_bf16_f32 v208, v208, v209
v_mfma_f32_16x16x32_bf16 a[192:195], a[68:71], a[132:135], a[192:195]
v_cvt_pk_bf16_f32 v209, v210, v211
v_cvt_pk_bf16_f32 v210, v212, v213
v_mfma_f32_16x16x32_bf16 a[196:199], a[72:75], a[128:131], a[196:199]
ds_read_b64_tr_b16 a[138:139], v11 offset:34816
v_cvt_pk_bf16_f32 v211, v214, v215
v_mfma_f32_16x16x32_bf16 a[196:199], a[76:79], a[132:135], a[196:199]
v_mfma_f32_16x16x32_bf16 a[200:203], a[80:83], a[128:131], a[200:203]
ds_read_b64_tr_b16 a[140:141], v11 offset:49152
v_cvt_pk_bf16_f32 v216, v216, v217
v_mfma_f32_16x16x32_bf16 a[200:203], a[84:87], a[132:135], a[200:203]
v_cvt_pk_bf16_f32 v217, v218, v219
v_cvt_pk_bf16_f32 v218, v220, v221
v_mfma_f32_16x16x32_bf16 a[204:207], a[88:91], a[128:131], a[204:207]
ds_read_b64_tr_b16 a[142:143], v11 offset:51200
v_cvt_pk_bf16_f32 v219, v222, v223
v_mfma_f32_16x16x32_bf16 a[204:207], a[92:95], a[132:135], a[204:207]
v_mfma_f32_16x16x32_bf16 a[208:211], a[96:99], a[128:131], a[208:211]
buffer_store_dwordx4 v[80:83], v1, s[4:7], s31 offen sc1
v_mfma_f32_16x16x32_bf16 a[208:211], a[100:103], a[132:135], a[208:211]
s_add_u32 s31, s31, s32
v_mfma_f32_16x16x32_bf16 a[212:215], a[104:107], a[128:131], a[212:215]
v_mfma_f32_16x16x32_bf16 a[212:215], a[108:111], a[132:135], a[212:215]
v_mfma_f32_16x16x32_bf16 a[216:219], a[112:115], a[128:131], a[216:219]
v_mfma_f32_16x16x32_bf16 a[216:219], a[116:119], a[132:135], a[216:219]
v_mfma_f32_16x16x32_bf16 a[220:223], a[120:123], a[128:131], a[220:223]
v_mfma_f32_16x16x32_bf16 a[220:223], a[124:127], a[132:135], a[220:223]
s_waitcnt vmcnt(23) lgkmcnt(0)
s_barrier
v_mfma_f32_16x16x32_bf16 a[224:227], a[64:67], a[136:139], a[224:227]
s_add_u32 m0, s29, 98304
ds_read_b64_tr_b16 a[128:129], v22 offset:0
v_mfma_f32_16x16x32_bf16 a[224:227], a[68:71], a[140:143], a[224:227]
buffer_load_dwordx4 v16, s[12:15], s26 offen offset:0 lds
v_mfma_f32_16x16x32_bf16 a[228:231], a[72:75], a[136:139], a[228:231]
ds_read_b64_tr_b16 a[130:131], v22 offset:2048
v_mfma_f32_16x16x32_bf16 a[228:231], a[76:79], a[140:143], a[228:231]
buffer_store_dwordx4 v[88:91], v1, s[4:7], s31 offen sc1
v_mfma_f32_16x16x32_bf16 a[232:235], a[80:83], a[136:139], a[232:235]
s_add_u32 s31, s31, s35
ds_read_b64_tr_b16 a[132:133], v22 offset:16384
v_mfma_f32_16x16x32_bf16 a[232:235], a[84:87], a[140:143], a[232:235]
buffer_load_dwordx4 v17, s[12:15], s26 offen offset:1024 lds
v_mfma_f32_16x16x32_bf16 a[236:239], a[88:91], a[136:139], a[236:239]
ds_read_b64_tr_b16 a[134:135], v22 offset:18432
v_add_u32 v22, 4294901760, v22
v_mfma_f32_16x16x32_bf16 a[236:239], a[92:95], a[140:143], a[236:239]
v_mfma_f32_16x16x32_bf16 a[240:243], a[96:99], a[136:139], a[240:243]
v_mfma_f32_16x16x32_bf16 a[240:243], a[100:103], a[140:143], a[240:243]
buffer_load_dwordx4 v18, s[12:15], s26 offen offset:2048 lds
v_mfma_f32_16x16x32_bf16 a[244:247], a[104:107], a[136:139], a[244:247]
v_mfma_f32_16x16x32_bf16 a[244:247], a[108:111], a[140:143], a[244:247]
v_mfma_f32_16x16x32_bf16 a[248:251], a[112:115], a[136:139], a[248:251]
v_mfma_f32_16x16x32_bf16 a[248:251], a[116:119], a[140:143], a[248:251]
buffer_load_dwordx4 v19, s[12:15], s26 offen offset:3072 lds
v_mfma_f32_16x16x32_bf16 a[252:255], a[120:123], a[136:139], a[252:255]
s_add_u32 s26, s26, 524288
v_mfma_f32_16x16x32_bf16 a[252:255], a[124:127], a[140:143], a[252:255]
s_waitcnt lgkmcnt(2)
s_cmp_lt_u32 s21, 7
s_cbranch_scc1 M_conv
M_Q:
v_mfma_f32_16x16x32_bf16 v[36:39], a[128:131], a[0:3], 0
s_waitcnt lgkmcnt(0)
s_add_u32 m0, s29, 114688
ds_read_b64_tr_b16 a[136:137], v23 offset:0
v_mfma_f32_16x16x32_bf16 v[36:39], a[132:135], a[4:7], v[36:39]
buffer_load_dwordx4 v16, s[12:15], s27 offen offset:0 lds
v_mfma_f32_16x16x32_bf16 v[44:47], a[128:131], a[8:11], 0
ds_read_b64_tr_b16 a[138:139], v23 offset:2048
v_mfma_f32_16x16x32_bf16 v[44:47], a[132:135], a[12:15], v[44:47]
ds_read_b128 a[64:67], v2 offset:16384
ds_read_b128 a[68:71], v3 offset:16384
v_mfma_f32_16x16x32_bf16 v[52:55], a[128:131], a[16:19], 0
ds_read_b64_tr_b16 a[140:141], v23 offset:16384
v_mfma_f32_16x16x32_bf16 v[52:55], a[132:135], a[20:23], v[52:55]
buffer_load_dwordx4 v17, s[12:15], s27 offen offset:1024 lds
v_mfma_f32_16x16x32_bf16 v[60:63], a[128:131], a[24:27], 0
ds_read_b64_tr_b16 a[142:143], v23 offset:18432
v_add_u32 v23, 4294901760, v23
v_mfma_f32_16x16x32_bf16 v[60:63], a[132:135], a[28:31], v[60:63]
buffer_store_dwordx4 v[96:99], v1, s[4:7], s31 offen sc1
v_mfma_f32_16x16x32_bf16 v[68:71], a[128:131], a[32:35], 0
s_add_u32 s31, s31, s32
ds_read_b128 a[72:75], v2 offset:18432
v_mfma_f32_16x16x32_bf16 v[68:71], a[132:135], a[36:39], v[68:71]
buffer_load_dwordx4 v18, s[12:15], s27 offen offset:2048 lds
v_mfma_f32_16x16x32_bf16 v[76:79], a[128:131], a[40:43], 0
ds_read_b128 a[76:79], v3 offset:18432
v_mfma_f32_16x16x32_bf16 v[76:79], a[132:135], a[44:47], v[76:79]
ds_read_b128 a[80:83], v2 offset:20480
v_mfma_f32_16x16x32_bf16 v[84:87], a[128:131], a[48:51], 0
ds_read_b128 a[84:87], v3 offset:20480
v_mfma_f32_16x16x32_bf16 v[84:87], a[132:135], a[52:55], v[84:87]
buffer_load_dwordx4 v19, s[12:15], s27 offen offset:3072 lds
v_mfma_f32_16x16x32_bf16 v[92:95], a[128:131], a[56:59], 0
s_add_u32 s27, s27, 524288
ds_read_b128 a[88:91], v2 offset:22528
v_mfma_f32_16x16x32_bf16 v[92:95], a[132:135], a[60:63], v[92:95]
s_waitcnt lgkmcnt(9)
buffer_store_dwordx4 v[104:107], v1, s[4:7], s31 offen sc1
v_mfma_f32_16x16x32_bf16 v[100:103], a[136:139], a[0:3], 0
s_waitcnt lgkmcnt(5)
s_add_u32 m0, s28, 0
ds_read_b64_tr_b16 a[128:129], v24 offset:0
v_mfma_f32_16x16x32_bf16 v[100:103], a[140:143], a[4:7], v[100:103]
s_add_u32 s31, s31, s33
buffer_load_dwordx4 v12, s[8:11], s24 offen offset:0 lds
v_mfma_f32_16x16x32_bf16 v[108:111], a[136:139], a[8:11], 0
ds_read_b64_tr_b16 a[130:131], v24 offset:2048
v_mfma_f32_16x16x32_bf16 v[108:111], a[140:143], a[12:15], v[108:111]
ds_read_b128 a[92:95], v3 offset:22528
v_mfma_f32_16x16x32_bf16 v[116:119], a[136:139], a[16:19], 0
ds_read_b64_tr_b16 a[132:133], v24 offset:16384
v_mfma_f32_16x16x32_bf16 v[116:119], a[140:143], a[20:23], v[116:119]
buffer_load_dwordx4 v13, s[8:11], s24 offen offset:1024 lds
v_mfma_f32_16x16x32_bf16 v[124:127], a[136:139], a[24:27], 0
ds_read_b64_tr_b16 a[134:135], v24 offset:18432
v_add_u32 v24, 4294901760, v24
v_mfma_f32_16x16x32_bf16 v[124:127], a[140:143], a[28:31], v[124:127]
v_mfma_f32_16x16x32_bf16 v[132:135], a[136:139], a[32:35], 0
ds_read_b128 a[96:99], v2 offset:24576
v_mfma_f32_16x16x32_bf16 v[132:135], a[140:143], a[36:39], v[132:135]
buffer_load_dwordx4 v14, s[8:11], s24 offen offset:2048 lds
v_mfma_f32_16x16x32_bf16 v[140:143], a[136:139], a[40:43], 0
ds_read_b128 a[100:103], v3 offset:24576
v_mfma_f32_16x16x32_bf16 v[140:143], a[140:143], a[44:47], v[140:143]
ds_read_b128 a[104:107], v2 offset:26624
v_mfma_f32_16x16x32_bf16 v[148:151], a[136:139], a[48:51], 0
ds_read_b128 a[108:111], v3 offset:26624
v_mfma_f32_16x16x32_bf16 v[148:151], a[140:143], a[52:55], v[148:151]
buffer_load_dwordx4 v15, s[8:11], s24 offen offset:3072 lds
v_mfma_f32_16x16x32_bf16 v[156:159], a[136:139], a[56:59], 0
s_add_u32 s24, s24, 128
ds_read_b128 a[112:115], v2 offset:28672
v_mfma_f32_16x16x32_bf16 v[156:159], a[140:143], a[60:63], v[156:159]
s_waitcnt lgkmcnt(8)
buffer_store_dwordx4 v[112:115], v1, s[4:7], s31 offen sc1
v_mfma_f32_16x16x32_bf16 v[164:167], a[128:131], a[0:3], 0
s_waitcnt lgkmcnt(5)
s_add_u32 s31, s31, s32
ds_read_b64_tr_b16 a[136:137], v25 offset:0
v_mfma_f32_16x16x32_bf16 v[164:167], a[132:135], a[4:7], v[164:167]
v_mfma_f32_16x16x32_bf16 v[172:175], a[128:131], a[8:11], 0
ds_read_b64_tr_b16 a[138:139], v25 offset:2048
v_mfma_f32_16x16x32_bf16 v[172:175], a[132:135], a[12:15], v[172:175]
ds_read_b128 a[116:119], v3 offset:28672
v_mfma_f32_16x16x32_bf16 v[180:183], a[128:131], a[16:19], 0
ds_read_b64_tr_b16 a[140:141], v25 offset:16384
v_mfma_f32_16x16x32_bf16 v[180:183], a[132:135], a[20:23], v[180:183]
v_mfma_f32_16x16x32_bf16 v[188:191], a[128:131], a[24:27], 0
ds_read_b64_tr_b16 a[142:143], v25 offset:18432
v_add_u32 v25, 4294901760, v25
v_mfma_f32_16x16x32_bf16 v[188:191], a[132:135], a[28:31], v[188:191]
v_mfma_f32_16x16x32_bf16 v[196:199], a[128:131], a[32:35], 0
ds_read_b128 a[120:123], v2 offset:30720
v_mfma_f32_16x16x32_bf16 v[196:199], a[132:135], a[36:39], v[196:199]
v_mfma_f32_16x16x32_bf16 v[204:207], a[128:131], a[40:43], 0
ds_read_b128 a[124:127], v3 offset:30720
v_mfma_f32_16x16x32_bf16 v[204:207], a[132:135], a[44:47], v[204:207]
v_mfma_f32_16x16x32_bf16 v[212:215], a[128:131], a[48:51], 0
v_mfma_f32_16x16x32_bf16 v[212:215], a[132:135], a[52:55], v[212:215]
buffer_store_dwordx4 v[120:123], v1, s[4:7], s31 offen sc1
v_mfma_f32_16x16x32_bf16 v[220:223], a[128:131], a[56:59], 0
s_add_u32 s31, s31, s34
v_mfma_f32_16x16x32_bf16 v[220:223], a[132:135], a[60:63], v[220:223]
s_waitcnt vmcnt(28) lgkmcnt(0)
s_barrier
v_mfma_f32_16x16x32_bf16 v[224:227], a[136:139], a[0:3], 0
s_add_u32 m0, s29, 131072
ds_read_b64_tr_b16 a[128:129], v22 offset:0
v_mfma_f32_16x16x32_bf16 v[224:227], a[140:143], a[4:7], v[224:227]
buffer_load_dwordx4 v16, s[12:15], s26 offen offset:0 lds
v_mfma_f32_16x16x32_bf16 v[228:231], a[136:139], a[8:11], 0
ds_read_b64_tr_b16 a[130:131], v22 offset:2048
v_mfma_f32_16x16x32_bf16 v[228:231], a[140:143], a[12:15], v[228:231]
v_mfma_f32_16x16x32_bf16 v[232:235], a[136:139], a[16:19], 0
ds_read_b64_tr_b16 a[132:133], v22 offset:16384
v_mfma_f32_16x16x32_bf16 v[232:235], a[140:143], a[20:23], v[232:235]
buffer_load_dwordx4 v17, s[12:15], s26 offen offset:1024 lds
v_mfma_f32_16x16x32_bf16 v[236:239], a[136:139], a[24:27], 0
ds_read_b64_tr_b16 a[134:135], v22 offset:18432
v_add_u32 v22, 32768, v22
v_mfma_f32_16x16x32_bf16 v[236:239], a[140:143], a[28:31], v[236:239]
v_mfma_f32_16x16x32_bf16 v[240:243], a[136:139], a[32:35], 0
v_mfma_f32_16x16x32_bf16 v[240:243], a[140:143], a[36:39], v[240:243]
buffer_load_dwordx4 v18, s[12:15], s26 offen offset:2048 lds
v_mfma_f32_16x16x32_bf16 v[244:247], a[136:139], a[40:43], 0
v_mfma_f32_16x16x32_bf16 v[244:247], a[140:143], a[44:47], v[244:247]
v_mfma_f32_16x16x32_bf16 v[248:251], a[136:139], a[48:51], 0
v_mfma_f32_16x16x32_bf16 v[248:251], a[140:143], a[52:55], v[248:251]
buffer_load_dwordx4 v19, s[12:15], s26 offen offset:3072 lds
v_mfma_f32_16x16x32_bf16 v[252:255], a[136:139], a[56:59], 0
s_add_u32 s26, s26, 524288
v_mfma_f32_16x16x32_bf16 v[252:255], a[140:143], a[60:63], v[252:255]
s_waitcnt lgkmcnt(0)
v_mfma_f32_16x16x32_bf16 v[36:39], a[128:131], a[64:67], v[36:39]
s_add_u32 m0, s29, 147456
ds_read_b64_tr_b16 a[136:137], v23 offset:0
v_accvgpr_read_b32 v32, a192
v_mfma_f32_16x16x32_bf16 v[36:39], a[132:135], a[68:71], v[36:39]
buffer_load_dwordx4 v16, s[12:15], s27 offen offset:0 lds
v_mfma_f32_16x16x32_bf16 v[44:47], a[128:131], a[72:75], v[44:47]
ds_read_b64_tr_b16 a[138:139], v23 offset:2048
v_accvgpr_read_b32 v33, a193
v_mfma_f32_16x16x32_bf16 v[44:47], a[132:135], a[76:79], v[44:47]
ds_read_b128 a[0:3], v2 offset:32768
ds_read_b128 a[4:7], v3 offset:32768
v_mfma_f32_16x16x32_bf16 v[52:55], a[128:131], a[80:83], v[52:55]
ds_read_b64_tr_b16 a[140:141], v23 offset:16384
v_accvgpr_read_b32 v34, a194
v_mfma_f32_16x16x32_bf16 v[52:55], a[132:135], a[84:87], v[52:55]
buffer_load_dwordx4 v17, s[12:15], s27 offen offset:1024 lds
v_mfma_f32_16x16x32_bf16 v[60:63], a[128:131], a[88:91], v[60:63]
ds_read_b64_tr_b16 a[142:143], v23 offset:18432
v_add_u32 v23, 32768, v23
v_mfma_f32_16x16x32_bf16 v[60:63], a[132:135], a[92:95], v[60:63]
buffer_store_dwordx4 v[128:131], v1, s[4:7], s31 offen sc1
v_mfma_f32_16x16x32_bf16 v[68:71], a[128:131], a[96:99], v[68:71]
s_add_u32 s31, s31, s32
ds_read_b128 a[8:11], v2 offset:34816
v_accvgpr_read_b32 v35, a195
v_mfma_f32_16x16x32_bf16 v[68:71], a[132:135], a[100:103], v[68:71]
buffer_load_dwordx4 v18, s[12:15], s27 offen offset:2048 lds
v_mfma_f32_16x16x32_bf16 v[76:79], a[128:131], a[104:107], v[76:79]
ds_read_b128 a[12:15], v3 offset:34816
v_accvgpr_read_b32 v96, a196
v_mfma_f32_16x16x32_bf16 v[76:79], a[132:135], a[108:111], v[76:79]
ds_read_b128 a[16:19], v2 offset:36864
v_accvgpr_read_b32 v97, a197
v_mfma_f32_16x16x32_bf16 v[84:87], a[128:131], a[112:115], v[84:87]
ds_read_b128 a[20:23], v3 offset:36864
v_accvgpr_read_b32 v98, a198
v_mfma_f32_16x16x32_bf16 v[84:87], a[132:135], a[116:119], v[84:87]
buffer_load_dwordx4 v19, s[12:15], s27 offen offset:3072 lds
v_mfma_f32_16x16x32_bf16 v[92:95], a[128:131], a[120:123], v[92:95]
s_add_u32 s27, s27, 524288
ds_read_b128 a[24:27], v2 offset:38912
v_accvgpr_read_b32 v99, a199
v_mfma_f32_16x16x32_bf16 v[92:95], a[132:135], a[124:127], v[92:95]
s_waitcnt lgkmcnt(5)
buffer_store_dwordx4 v[136:139], v1, s[4:7], s31 offen sc1
v_mfma_f32_16x16x32_bf16 v[100:103], a[136:139], a[64:67], v[100:103]
s_add_u32 m0, s28, 16384
ds_read_b64_tr_b16 a[128:129], v24 offset:0
v_cvt_pk_bf16_f32 v32, v32, v33
v_mfma_f32_16x16x32_bf16 v[100:103], a[140:143], a[68:71], v[100:103]
s_add_u32 s31, s31, s33
buffer_load_dwordx4 v12, s[8:11], s24 offen offset:0 lds
v_mfma_f32_16x16x32_bf16 v[108:111], a[136:139], a[72:75], v[108:111]
ds_read_b64_tr_b16 a[130:131], v24 offset:2048
v_cvt_pk_bf16_f32 v33, v34, v35
v_mfma_f32_16x16x32_bf16 v[108:111], a[140:143], a[76:79], v[108:111]
ds_read_b128 a[28:31], v3 offset:38912
v_cvt_pk_bf16_f32 v34, v96, v97
v_mfma_f32_16x16x32_bf16 v[116:119], a[136:139], a[80:83], v[116:119]
ds_read_b64_tr_b16 a[132:133], v24 offset:16384
v_cvt_pk_bf16_f32 v35, v98, v99
v_mfma_f32_16x16x32_bf16 v[116:119], a[140:143], a[84:87], v[116:119]
buffer_load_dwordx4 v13, s[8:11], s24 offen offset:1024 lds
v_mfma_f32_16x16x32_bf16 v[124:127], a[136:139], a[88:91], v[124:127]
ds_read_b64_tr_b16 a[134:135], v24 offset:18432
v_add_u32 v24, 32768, v24
v_mfma_f32_16x16x32_bf16 v[124:127], a[140:143], a[92:95], v[124:127]
v_accvgpr_read_b32 v40, a200
v_accvgpr_read_b32 v41, a201
v_mfma_f32_16x16x32_bf16 v[132:135], a[136:139], a[96:99], v[132:135]
ds_read_b128 a[32:35], v2 offset:40960
v_accvgpr_read_b32 v42, a202
v_mfma_f32_16x16x32_bf16 v[132:135], a[140:143], a[100:103], v[132:135]
buffer_load_dwordx4 v14, s[8:11], s24 offen offset:2048 lds
v_mfma_f32_16x16x32_bf16 v[140:143], a[136:139], a[104:107], v[140:143]
ds_read_b128 a[36:39], v3 offset:40960
v_accvgpr_read_b32 v43, a203
v_mfma_f32_16x16x32_bf16 v[140:143], a[140:143], a[108:111], v[140:143]
ds_read_b128 a[40:43], v2 offset:43008
v_accvgpr_read_b32 v96, a204
v_mfma_f32_16x16x32_bf16 v[148:151], a[136:139], a[112:115], v[148:151]
ds_read_b128 a[44:47], v3 offset:43008
v_accvgpr_read_b32 v97, a205
v_mfma_f32_16x16x32_bf16 v[148:151], a[140:143], a[116:119], v[148:151]
buffer_load_dwordx4 v15, s[8:11], s24 offen offset:3072 lds
v_mfma_f32_16x16x32_bf16 v[156:159], a[136:139], a[120:123], v[156:159]
s_add_u32 s24, s24, 128
ds_read_b128 a[48:51], v2 offset:45056
v_accvgpr_read_b32 v98, a206
v_mfma_f32_16x16x32_bf16 v[156:159], a[140:143], a[124:127], v[156:159]
s_waitcnt lgkmcnt(5)
buffer_store_dwordx4 v[144:147], v1, s[4:7], s31 offen sc1
v_mfma_f32_16x16x32_bf16 v[164:167], a[128:131], a[64:67], v[164:167]
s_add_u32 s31, s31, s32
ds_read_b64_tr_b16 a[136:137], v25 offset:0
v_accvgpr_read_b32 v99, a207
v_mfma_f32_16x16x32_bf16 v[164:167], a[132:135], a[68:71], v[164:167]
v_cvt_pk_bf16_f32 v40, v40, v41
v_cvt_pk_bf16_f32 v41, v42, v43
v_mfma_f32_16x16x32_bf16 v[172:175], a[128:131], a[72:75], v[172:175]
ds_read_b64_tr_b16 a[138:139], v25 offset:2048
v_cvt_pk_bf16_f32 v42, v96, v97
v_mfma_f32_16x16x32_bf16 v[172:175], a[132:135], a[76:79], v[172:175]
ds_read_b128 a[52:55], v3 offset:45056
v_cvt_pk_bf16_f32 v43, v98, v99
v_mfma_f32_16x16x32_bf16 v[180:183], a[128:131], a[80:83], v[180:183]
ds_read_b64_tr_b16 a[140:141], v25 offset:16384
v_accvgpr_read_b32 v48, a208
v_mfma_f32_16x16x32_bf16 v[180:183], a[132:135], a[84:87], v[180:183]
v_accvgpr_read_b32 v49, a209
v_accvgpr_read_b32 v50, a210
v_mfma_f32_16x16x32_bf16 v[188:191], a[128:131], a[88:91], v[188:191]
ds_read_b64_tr_b16 a[142:143], v25 offset:18432
v_add_u32 v25, 32768, v25
v_mfma_f32_16x16x32_bf16 v[188:191], a[132:135], a[92:95], v[188:191]
v_accvgpr_read_b32 v51, a211
v_accvgpr_read_b32 v96, a212
v_mfma_f32_16x16x32_bf16 v[196:199], a[128:131], a[96:99], v[196:199]
ds_read_b128 a[56:59], v2 offset:47104
v_accvgpr_read_b32 v97, a213
v_mfma_f32_16x16x32_bf16 v[196:199], a[132:135], a[100:103], v[196:199]
v_accvgpr_read_b32 v98, a214
v_accvgpr_read_b32 v99, a215
v_mfma_f32_16x16x32_bf16 v[204:207], a[128:131], a[104:107], v[204:207]
ds_read_b128 a[60:63], v3 offset:47104
v_cvt_pk_bf16_f32 v48, v48, v49
v_mfma_f32_16x16x32_bf16 v[204:207], a[132:135], a[108:111], v[204:207]
v_cvt_pk_bf16_f32 v49, v50, v51
v_cvt_pk_bf16_f32 v50, v96, v97
v_mfma_f32_16x16x32_bf16 v[212:215], a[128:131], a[112:115], v[212:215]
v_cvt_pk_bf16_f32 v51, v98, v99
v_accvgpr_read_b32 v56, a216
v_mfma_f32_16x16x32_bf16 v[212:215], a[132:135], a[116:119], v[212:215]
buffer_store_dwordx4 v[152:155], v1, s[4:7], s31 offen sc1
v_mfma_f32_16x16x32_bf16 v[220:223], a[128:131], a[120:123], v[220:223]
s_add_u32 s31, s31, s36
v_accvgpr_read_b32 v57, a217
v_accvgpr_read_b32 v58, a218
v_mfma_f32_16x16x32_bf16 v[220:223], a[132:135], a[124:127], v[220:223]
s_waitcnt vmcnt(23) lgkmcnt(0)
s_barrier
v_accvgpr_read_b32 v59, a219
v_mfma_f32_16x16x32_bf16 v[224:227], a[136:139], a[64:67], v[224:227]
s_add_u32 m0, s29, 65536
ds_read_b64_tr_b16 a[128:129], v22 offset:0
v_accvgpr_read_b32 v96, a220
v_mfma_f32_16x16x32_bf16 v[224:227], a[140:143], a[68:71], v[224:227]
buffer_load_dwordx4 v16, s[12:15], s26 offen offset:0 lds
v_mfma_f32_16x16x32_bf16 v[228:231], a[136:139], a[72:75], v[228:231]
ds_read_b64_tr_b16 a[130:131], v22 offset:2048
v_accvgpr_read_b32 v97, a221
v_mfma_f32_16x16x32_bf16 v[228:231], a[140:143], a[76:79], v[228:231]
v_accvgpr_read_b32 v98, a222
v_accvgpr_read_b32 v99, a223
v_mfma_f32_16x16x32_bf16 v[232:235], a[136:139], a[80:83], v[232:235]
ds_read_b64_tr_b16 a[132:133], v22 offset:16384
v_cvt_pk_bf16_f32 v56, v56, v57
v_mfma_f32_16x16x32_bf16 v[232:235], a[140:143], a[84:87], v[232:235]
buffer_load_dwordx4 v17, s[12:15], s26 offen offset:1024 lds
v_mfma_f32_16x16x32_bf16 v[236:239], a[136:139], a[88:91], v[236:239]
ds_read_b64_tr_b16 a[134:135], v22 offset:18432
v_add_u32 v22, 32768, v22
v_mfma_f32_16x16x32_bf16 v[236:239], a[140:143], a[92:95], v[236:239]
v_cvt_pk_bf16_f32 v57, v58, v59
v_cvt_pk_bf16_f32 v58, v96, v97
v_mfma_f32_16x16x32_bf16 v[240:243], a[136:139], a[96:99], v[240:243]
v_cvt_pk_bf16_f32 v59, v98, v99
v_accvgpr_read_b32 v64, a224
v_mfma_f32_16x16x32_bf16 v[240:243], a[140:143], a[100:103], v[240:243]
buffer_load_dwordx4 v18, s[12:15], s26 offen offset:2048 lds
v_mfma_f32_16x16x32_bf16 v[244:247], a[136:139], a[104:107], v[244:247]
v_accvgpr_read_b32 v65, a225
v_accvgpr_read_b32 v66, a226
v_mfma_f32_16x16x32_bf16 v[244:247], a[140:143], a[108:111], v[244:247]
v_accvgpr_read_b32 v67, a227
v_accvgpr_read_b32 v96, a228
v_mfma_f32_16x16x32_bf16 v[248:251], a[136:139], a[112:115], v[248:251]
v_accvgpr_read_b32 v97, a229
v_accvgpr_read_b32 v98, a230
v_mfma_f32_16x16x32_bf16 v[248:251], a[140:143], a[116:119], v[248:251]
buffer_load_dwordx4 v19, s[12:15], s26 offen offset:3072 lds
v_mfma_f32_16x16x32_bf16 v[252:255], a[136:139], a[120:123], v[252:255]
s_add_u32 s26, s26, 524288
v_accvgpr_read_b32 v99, a231
v_cvt_pk_bf16_f32 v64, v64, v65
v_mfma_f32_16x16x32_bf16 v[252:255], a[140:143], a[124:127], v[252:255]
s_waitcnt lgkmcnt(0)
v_cvt_pk_bf16_f32 v65, v66, v67
v_cvt_pk_bf16_f32 v66, v96, v97
v_mfma_f32_16x16x32_bf16 v[36:39], a[128:131], a[0:3], v[36:39]
s_add_u32 m0, s29, 81920
ds_read_b64_tr_b16 a[136:137], v23 offset:0
v_cvt_pk_bf16_f32 v67, v98, v99
v_mfma_f32_16x16x32_bf16 v[36:39], a[132:135], a[4:7], v[36:39]
buffer_load_dwordx4 v16, s[12:15], s27 offen offset:0 lds
v_mfma_f32_16x16x32_bf16 v[44:47], a[128:131], a[8:11], v[44:47]
ds_read_b64_tr_b16 a[138:139], v23 offset:2048
v_accvgpr_read_b32 v72, a232
v_mfma_f32_16x16x32_bf16 v[44:47], a[132:135], a[12:15], v[44:47]
ds_read_b128 a[64:67], v2 offset:49152
ds_read_b128 a[68:71], v3 offset:49152
v_mfma_f32_16x16x32_bf16 v[52:55], a[128:131], a[16:19], v[52:55]
ds_read_b64_tr_b16 a[140:141], v23 offset:16384
v_accvgpr_read_b32 v73, a233
v_mfma_f32_16x16x32_bf16 v[52:55], a[132:135], a[20:23], v[52:55]
buffer_load_dwordx4 v17, s[12:15], s27 offen offset:1024 lds
v_mfma_f32_16x16x32_bf16 v[60:63], a[128:131], a[24:27], v[60:63]
ds_read_b64_tr_b16 a[142:143], v23 offset:18432
v_add_u32 v23, 32768, v23
v_mfma_f32_16x16x32_bf16 v[60:63], a[132:135], a[28:31], v[60:63]
buffer_store_dwordx4 v[160:163], v1, s[4:7], s31 offen sc1
v_mfma_f32_16x16x32_bf16 v[68:71], a[128:131], a[32:35], v[68:71]
s_add_u32 s31, s31, s32
ds_read_b128 a[72:75], v2 offset:51200
v_accvgpr_read_b32 v74, a234
v_mfma_f32_16x16x32_bf16 v[68:71], a[132:135], a[36:39], v[68:71]
buffer_load_dwordx4 v18, s[12:15], s27 offen offset:2048 lds
v_mfma_f32_16x16x32_bf16 v[76:79], a[128:131], a[40:43], v[76:79]
ds_read_b128 a[76:79], v3 offset:51200
v_accvgpr_read_b32 v75, a235
v_mfma_f32_16x16x32_bf16 v[76:79], a[132:135], a[44:47], v[76:79]
ds_read_b128 a[80:83], v2 offset:53248
v_accvgpr_read_b32 v96, a236
v_mfma_f32_16x16x32_bf16 v[84:87], a[128:131], a[48:51], v[84:87]
ds_read_b128 a[84:87], v3 offset:53248
v_accvgpr_read_b32 v97, a237
v_mfma_f32_16x16x32_bf16 v[84:87], a[132:135], a[52:55], v[84:87]
buffer_load_dwordx4 v19, s[12:15], s27 offen offset:3072 lds
v_mfma_f32_16x16x32_bf16 v[92:95], a[128:131], a[56:59], v[92:95]
s_add_u32 s27, s27, 524288
ds_read_b128 a[88:91], v2 offset:55296
v_accvgpr_read_b32 v98, a238
v_mfma_f32_16x16x32_bf16 v[92:95], a[132:135], a[60:63], v[92:95]
s_waitcnt lgkmcnt(5)
buffer_store_dwordx4 v[168:171], v1, s[4:7], s31 offen sc1
v_mfma_f32_16x16x32_bf16 v[100:103], a[136:139], a[0:3], v[100:103]
s_add_u32 m0, s28, 32768
ds_read_b64_tr_b16 a[128:129], v24 offset:0
v_accvgpr_read_b32 v99, a239
v_mfma_f32_16x16x32_bf16 v[100:103], a[140:143], a[4:7], v[100:103]
s_add_u32 s31, s31, s33
buffer_load_dwordx4 v12, s[8:11], s24 offen offset:0 lds
v_mfma_f32_16x16x32_bf16 v[108:111], a[136:139], a[8:11], v[108:111]
ds_read_b64_tr_b16 a[130:131], v24 offset:2048
v_cvt_pk_bf16_f32 v72, v72, v73
v_mfma_f32_16x16x32_bf16 v[108:111], a[140:143], a[12:15], v[108:111]
ds_read_b128 a[92:95], v3 offset:55296
v_cvt_pk_bf16_f32 v73, v74, v75
v_mfma_f32_16x16x32_bf16 v[116:119], a[136:139], a[16:19], v[116:119]
ds_read_b64_tr_b16 a[132:133], v24 offset:16384
v_cvt_pk_bf16_f32 v74, v96, v97
v_mfma_f32_16x16x32_bf16 v[116:119], a[140:143], a[20:23], v[116:119]
buffer_load_dwordx4 v13, s[8:11], s24 offen offset:1024 lds
v_mfma_f32_16x16x32_bf16 v[124:127], a[136:139], a[24:27], v[124:127]
ds_read_b64_tr_b16 a[134:135], v24 offset:18432
v_add_u32 v24, 32768, v24
v_mfma_f32_16x16x32_bf16 v[124:127], a[140:143], a[28:31], v[124:127]
v_cvt_pk_bf16_f32 v75, v98, v99
v_accvgpr_read_b32 v80, a240
v_mfma_f32_16x16x32_bf16 v[132:135], a[136:139], a[32:35], v[132:135]
ds_read_b128 a[96:99], v2 offset:57344
v_accvgpr_read_b32 v81, a241
v_mfma_f32_16x16x32_bf16 v[132:135], a[140:143], a[36:39], v[132:135]
buffer_load_dwordx4 v14, s[8:11], s24 offen offset:2048 lds
v_mfma_f32_16x16x32_bf16 v[140:143], a[136:139], a[40:43], v[140:143]
ds_read_b128 a[100:103], v3 offset:57344
v_accvgpr_read_b32 v82, a242
v_mfma_f32_16x16x32_bf16 v[140:143], a[140:143], a[44:47], v[140:143]
ds_read_b128 a[104:107], v2 offset:59392
v_accvgpr_read_b32 v83, a243
v_mfma_f32_16x16x32_bf16 v[148:151], a[136:139], a[48:51], v[148:151]
ds_read_b128 a[108:111], v3 offset:59392
v_accvgpr_read_b32 v96, a244
v_mfma_f32_16x16x32_bf16 v[148:151], a[140:143], a[52:55], v[148:151]
buffer_load_dwordx4 v15, s[8:11], s24 offen offset:3072 lds
v_mfma_f32_16x16x32_bf16 v[156:159], a[136:139], a[56:59], v[156:159]
s_add_u32 s24, s24, 128
ds_read_b128 a[112:115], v2 offset:61440
v_accvgpr_read_b32 v97, a245
v_mfma_f32_16x16x32_bf16 v[156:159], a[140:143], a[60:63], v[156:159]
s_waitcnt lgkmcnt(5)
buffer_store_dwordx4 v[176:179], v1, s[4:7], s31 offen sc1
v_mfma_f32_16x16x32_bf16 v[164:167], a[128:131], a[0:3], v[164:167]
s_add_u32 s31, s31, s32
ds_read_b64_tr_b16 a[136:137], v25 offset:0
v_accvgpr_read_b32 v98, a246
v_mfma_f32_16x16x32_bf16 v[164:167], a[132:135], a[4:7], v[164:167]
v_accvgpr_read_b32 v99, a247
v_cvt_pk_bf16_f32 v80, v80, v81
v_mfma_f32_16x16x32_bf16 v[172:175], a[128:131], a[8:11], v[172:175]
ds_read_b64_tr_b16 a[138:139], v25 offset:2048
v_cvt_pk_bf16_f32 v81, v82, v83
v_mfma_f32_16x16x32_bf16 v[172:175], a[132:135], a[12:15], v[172:175]
ds_read_b128 a[116:119], v3 offset:61440
v_cvt_pk_bf16_f32 v82, v96, v97
v_mfma_f32_16x16x32_bf16 v[180:183], a[128:131], a[16:19], v[180:183]
ds_read_b64_tr_b16 a[140:141], v25 offset:16384
v_cvt_pk_bf16_f32 v83, v98, v99
v_mfma_f32_16x16x32_bf16 v[180:183], a[132:135], a[20:23], v[180:183]
buffer_store_dwordx4 v[184:187], v1, s[4:7], s31 offen sc1
v_mfma_f32_16x16x32_bf16 v[188:191], a[128:131], a[24:27], v[188:191]
s_add_u32 s31, s31, s34
ds_read_b64_tr_b16 a[142:143], v25 offset:18432
v_add_u32 v25, 32768, v25
v_mfma_f32_16x16x32_bf16 v[188:191], a[132:135], a[28:31], v[188:191]
v_accvgpr_read_b32 v88, a248
v_accvgpr_read_b32 v89, a249
v_mfma_f32_16x16x32_bf16 v[196:199], a[128:131], a[32:35], v[196:199]
ds_read_b128 a[120:123], v2 offset:63488
v_accvgpr_read_b32 v90, a250
v_mfma_f32_16x16x32_bf16 v[196:199], a[132:135], a[36:39], v[196:199]
v_accvgpr_read_b32 v91, a251
v_accvgpr_read_b32 v96, a252
v_mfma_f32_16x16x32_bf16 v[204:207], a[128:131], a[40:43], v[204:207]
ds_read_b128 a[124:127], v3 offset:63488
v_accvgpr_read_b32 v97, a253
v_mfma_f32_16x16x32_bf16 v[204:207], a[132:135], a[44:47], v[204:207]
v_accvgpr_read_b32 v98, a254
v_accvgpr_read_b32 v99, a255
v_mfma_f32_16x16x32_bf16 v[212:215], a[128:131], a[48:51], v[212:215]
v_cvt_pk_bf16_f32 v88, v88, v89
v_cvt_pk_bf16_f32 v89, v90, v91
v_mfma_f32_16x16x32_bf16 v[212:215], a[132:135], a[52:55], v[212:215]
v_cvt_pk_bf16_f32 v90, v96, v97
v_cvt_pk_bf16_f32 v91, v98, v99
v_mfma_f32_16x16x32_bf16 v[220:223], a[128:131], a[56:59], v[220:223]
v_mfma_f32_16x16x32_bf16 v[220:223], a[132:135], a[60:63], v[220:223]
s_waitcnt vmcnt(23) lgkmcnt(0)
s_barrier
v_mfma_f32_16x16x32_bf16 v[224:227], a[136:139], a[0:3], v[224:227]
s_add_u32 m0, s29, 98304
ds_read_b64_tr_b16 a[128:129], v22 offset:0
v_mfma_f32_16x16x32_bf16 v[224:227], a[140:143], a[4:7], v[224:227]
buffer_load_dwordx4 v16, s[12:15], s26 offen offset:0 lds
v_mfma_f32_16x16x32_bf16 v[228:231], a[136:139], a[8:11], v[228:231]
ds_read_b64_tr_b16 a[130:131], v22 offset:2048
v_mfma_f32_16x16x32_bf16 v[228:231], a[140:143], a[12:15], v[228:231]
buffer_store_dwordx4 v[192:195], v1, s[4:7], s31 offen sc1
v_mfma_f32_16x16x32_bf16 v[232:235], a[136:139], a[16:19], v[232:235]
s_add_u32 s31, s31, s32
ds_read_b64_tr_b16 a[132:133], v22 offset:16384
v_mfma_f32_16x16x32_bf16 v[232:235], a[140:143], a[20:23], v[232:235]
buffer_load_dwordx4 v17, s[12:15], s26 offen offset:1024 lds
v_mfma_f32_16x16x32_bf16 v[236:239], a[136:139], a[24:27], v[236:239]
ds_read_b64_tr_b16 a[134:135], v22 offset:18432
v_add_u32 v22, 4294901760, v22
v_mfma_f32_16x16x32_bf16 v[236:239], a[140:143], a[28:31], v[236:239]
v_mfma_f32_16x16x32_bf16 v[240:243], a[136:139], a[32:35], v[240:243]
v_mfma_f32_16x16x32_bf16 v[240:243], a[140:143], a[36:39], v[240:243]
buffer_load_dwordx4 v18, s[12:15], s26 offen offset:2048 lds
v_mfma_f32_16x16x32_bf16 v[244:247], a[136:139], a[40:43], v[244:247]
v_mfma_f32_16x16x32_bf16 v[244:247], a[140:143], a[44:47], v[244:247]
v_mfma_f32_16x16x32_bf16 v[248:251], a[136:139], a[48:51], v[248:251]
v_mfma_f32_16x16x32_bf16 v[248:251], a[140:143], a[52:55], v[248:251]
buffer_load_dwordx4 v19, s[12:15], s26 offen offset:3072 lds
v_mfma_f32_16x16x32_bf16 v[252:255], a[136:139], a[56:59], v[252:255]
s_add_u32 s26, s26, 524288
v_mfma_f32_16x16x32_bf16 v[252:255], a[140:143], a[60:63], v[252:255]
s_waitcnt lgkmcnt(2)
v_mfma_f32_16x16x32_bf16 v[36:39], a[128:131], a[64:67], v[36:39]
s_waitcnt lgkmcnt(0)
s_add_u32 m0, s29, 114688
ds_read_b64_tr_b16 a[136:137], v23 offset:0
v_mfma_f32_16x16x32_bf16 v[36:39], a[132:135], a[68:71], v[36:39]
buffer_load_dwordx4 v16, s[12:15], s27 offen offset:0 lds
v_mfma_f32_16x16x32_bf16 v[44:47], a[128:131], a[72:75], v[44:47]
ds_read_b64_tr_b16 a[138:139], v23 offset:2048
v_mfma_f32_16x16x32_bf16 v[44:47], a[132:135], a[76:79], v[44:47]
ds_read_b128 a[0:3], v2 offset:0
ds_read_b128 a[4:7], v3 offset:0
v_mfma_f32_16x16x32_bf16 v[52:55], a[128:131], a[80:83], v[52:55]
ds_read_b64_tr_b16 a[140:141], v23 offset:16384
v_mfma_f32_16x16x32_bf16 v[52:55], a[132:135], a[84:87], v[52:55]
buffer_load_dwordx4 v17, s[12:15], s27 offen offset:1024 lds
v_mfma_f32_16x16x32_bf16 v[60:63], a[128:131], a[88:91], v[60:63]
ds_read_b64_tr_b16 a[142:143], v23 offset:18432
v_add_u32 v23, 4294901760, v23
v_mfma_f32_16x16x32_bf16 v[60:63], a[132:135], a[92:95], v[60:63]
buffer_store_dwordx4 v[200:203], v1, s[4:7], s31 offen sc1
v_mfma_f32_16x16x32_bf16 v[68:71], a[128:131], a[96:99], v[68:71]
s_add_u32 s31, s31, s33
ds_read_b128 a[8:11], v2 offset:2048
v_mfma_f32_16x16x32_bf16 v[68:71], a[132:135], a[100:103], v[68:71]
buffer_load_dwordx4 v18, s[12:15], s27 offen offset:2048 lds
v_mfma_f32_16x16x32_bf16 v[76:79], a[128:131], a[104:107], v[76:79]
ds_read_b128 a[12:15], v3 offset:2048
v_mfma_f32_16x16x32_bf16 v[76:79], a[132:135], a[108:111], v[76:79]
ds_read_b128 a[16:19], v2 offset:4096
v_mfma_f32_16x16x32_bf16 v[84:87], a[128:131], a[112:115], v[84:87]
ds_read_b128 a[20:23], v3 offset:4096
v_mfma_f32_16x16x32_bf16 v[84:87], a[132:135], a[116:119], v[84:87]
buffer_load_dwordx4 v19, s[12:15], s27 offen offset:3072 lds
v_mfma_f32_16x16x32_bf16 v[92:95], a[128:131], a[120:123], v[92:95]
s_add_u32 s27, s27, 524288
ds_read_b128 a[24:27], v2 offset:6144
v_mfma_f32_16x16x32_bf16 v[92:95], a[132:135], a[124:127], v[92:95]
s_waitcnt lgkmcnt(9)
buffer_store_dwordx4 v[208:211], v1, s[4:7], s31 offen sc1
v_mfma_f32_16x16x32_bf16 v[100:103], a[136:139], a[64:67], v[100:103]
s_waitcnt lgkmcnt(5)
s_add_u32 s31, s31, s32
ds_read_b64_tr_b16 a[128:129], v24 offset:0
v_mfma_f32_16x16x32_bf16 v[100:103], a[140:143], a[68:71], v[100:103]
v_mfma_f32_16x16x32_bf16 v[108:111], a[136:139], a[72:75], v[108:111]
ds_read_b64_tr_b16 a[130:131], v24 offset:2048
v_mfma_f32_16x16x32_bf16 v[108:111], a[140:143], a[76:79], v[108:111]
ds_read_b128 a[28:31], v3 offset:6144
v_mfma_f32_16x16x32_bf16 v[116:119], a[136:139], a[80:83], v[116:119]
ds_read_b64_tr_b16 a[132:133], v24 offset:16384
v_mfma_f32_16x16x32_bf16 v[116:119], a[140:143], a[84:87], v[116:119]
v_mfma_f32_16x16x32_bf16 v[124:127], a[136:139], a[88:91], v[124:127]
ds_read_b64_tr_b16 a[134:135], v24 offset:18432
v_add_u32 v24, 4294901760, v24
v_mfma_f32_16x16x32_bf16 v[124:127], a[140:143], a[92:95], v[124:127]
v_mfma_f32_16x16x32_bf16 v[132:135], a[136:139], a[96:99], v[132:135]
ds_read_b128 a[32:35], v2 offset:8192
v_mfma_f32_16x16x32_bf16 v[132:135], a[140:143], a[100:103], v[132:135]
buffer_store_dwordx4 v[216:219], v1, s[4:7], s31 offen sc1
v_mfma_f32_16x16x32_bf16 v[140:143], a[136:139], a[104:107], v[140:143]
s_add_u32 s31, s31, s35
ds_read_b128 a[36:39], v3 offset:8192
v_mfma_f32_16x16x32_bf16 v[140:143], a[140:143], a[108:111], v[140:143]
ds_read_b128 a[40:43], v2 offset:10240
v_mfma_f32_16x16x32_bf16 v[148:151], a[136:139], a[112:115], v[148:151]
ds_read_b128 a[44:47], v3 offset:10240
v_mfma_f32_16x16x32_bf16 v[148:151], a[140:143], a[116:119], v[148:151]
v_mfma_f32_16x16x32_bf16 v[156:159], a[136:139], a[120:123], v[156:159]
ds_read_b128 a[48:51], v2 offset:12288
v_mfma_f32_16x16x32_bf16 v[156:159], a[140:143], a[124:127], v[156:159]
s_waitcnt lgkmcnt(8)
v_mfma_f32_16x16x32_bf16 v[164:167], a[128:131], a[64:67], v[164:167]
s_waitcnt lgkmcnt(5)
ds_read_b64_tr_b16 a[136:137], v25 offset:0
v_mfma_f32_16x16x32_bf16 v[164:167], a[132:135], a[68:71], v[164:167]
v_mfma_f32_16x16x32_bf16 v[172:175], a[128:131], a[72:75], v[172:175]
ds_read_b64_tr_b16 a[138:139], v25 offset:2048
v_mfma_f32_16x16x32_bf16 v[172:175], a[132:135], a[76:79], v[172:175]
ds_read_b128 a[52:55], v3 offset:12288
v_mfma_f32_16x16x32_bf16 v[180:183], a[128:131], a[80:83], v[180:183]
ds_read_b64_tr_b16 a[140:141], v25 offset:16384
v_mfma_f32_16x16x32_bf16 v[180:183], a[132:135], a[84:87], v[180:183]
buffer_store_dwordx4 v[32:35], v1, s[4:7], s31 offen sc1
v_mfma_f32_16x16x32_bf16 v[188:191], a[128:131], a[88:91], v[188:191]
s_add_u32 s31, s31, s32
ds_read_b64_tr_b16 a[142:143], v25 offset:18432
v_add_u32 v25, 4294901760, v25
v_mfma_f32_16x16x32_bf16 v[188:191], a[132:135], a[92:95], v[188:191]
v_mfma_f32_16x16x32_bf16 v[196:199], a[128:131], a[96:99], v[196:199]
ds_read_b128 a[56:59], v2 offset:14336
v_mfma_f32_16x16x32_bf16 v[196:199], a[132:135], a[100:103], v[196:199]
v_mfma_f32_16x16x32_bf16 v[204:207], a[128:131], a[104:107], v[204:207]
ds_read_b128 a[60:63], v3 offset:14336
v_mfma_f32_16x16x32_bf16 v[204:207], a[132:135], a[108:111], v[204:207]
v_mfma_f32_16x16x32_bf16 v[212:215], a[128:131], a[112:115], v[212:215]
v_mfma_f32_16x16x32_bf16 v[212:215], a[132:135], a[116:119], v[212:215]
v_mfma_f32_16x16x32_bf16 v[220:223], a[128:131], a[120:123], v[220:223]
v_mfma_f32_16x16x32_bf16 v[220:223], a[132:135], a[124:127], v[220:223]
s_waitcnt vmcnt(20) lgkmcnt(0)
s_barrier
v_mfma_f32_16x16x32_bf16 v[224:227], a[136:139], a[64:67], v[224:227]
s_add_u32 m0, s29, 131072
ds_read_b64_tr_b16 a[128:129], v22 offset:0
v_mfma_f32_16x16x32_bf16 v[224:227], a[140:143], a[68:71], v[224:227]
buffer_load_dwordx4 v16, s[12:15], s26 offen offset:0 lds
v_mfma_f32_16x16x32_bf16 v[228:231], a[136:139], a[72:75], v[228:231]
ds_read_b64_tr_b16 a[130:131], v22 offset:2048
v_mfma_f32_16x16x32_bf16 v[228:231], a[140:143], a[76:79], v[228:231]
buffer_store_dwordx4 v[40:43], v1, s[4:7], s31 offen sc1
v_mfma_f32_16x16x32_bf16 v[232:235], a[136:139], a[80:83], v[232:235]
s_add_u32 s31, s31, s33
ds_read_b64_tr_b16 a[132:133], v22 offset:16384
v_mfma_f32_16x16x32_bf16 v[232:235], a[140:143], a[84:87], v[232:235]
buffer_load_dwordx4 v17, s[12:15], s26 offen offset:1024 lds
v_mfma_f32_16x16x32_bf16 v[236:239], a[136:139], a[88:91], v[236:239]
ds_read_b64_tr_b16 a[134:135], v22 offset:18432
v_add_u32 v22, 32768, v22
v_mfma_f32_16x16x32_bf16 v[236:239], a[140:143], a[92:95], v[236:239]
v_mfma_f32_16x16x32_bf16 v[240:243], a[136:139], a[96:99], v[240:243]
v_mfma_f32_16x16x32_bf16 v[240:243], a[140:143], a[100:103], v[240:243]
buffer_load_dwordx4 v18, s[12:15], s26 offen offset:2048 lds
v_mfma_f32_16x16x32_bf16 v[244:247], a[136:139], a[104:107], v[244:247]
v_mfma_f32_16x16x32_bf16 v[244:247], a[140:143], a[108:111], v[244:247]
v_mfma_f32_16x16x32_bf16 v[248:251], a[136:139], a[112:115], v[248:251]
v_mfma_f32_16x16x32_bf16 v[248:251], a[140:143], a[116:119], v[248:251]
buffer_load_dwordx4 v19, s[12:15], s26 offen offset:3072 lds
v_mfma_f32_16x16x32_bf16 v[252:255], a[136:139], a[120:123], v[252:255]
s_add_u32 s26, s26, 524288
v_mfma_f32_16x16x32_bf16 v[252:255], a[140:143], a[124:127], v[252:255]
s_waitcnt lgkmcnt(2)
v_mfma_f32_16x16x32_bf16 v[36:39], a[128:131], a[0:3], v[36:39]
s_waitcnt lgkmcnt(0)
s_add_u32 m0, s29, 147456
ds_read_b64_tr_b16 a[136:137], v23 offset:0
v_mfma_f32_16x16x32_bf16 v[36:39], a[132:135], a[4:7], v[36:39]
buffer_load_dwordx4 v16, s[12:15], s27 offen offset:0 lds
v_mfma_f32_16x16x32_bf16 v[44:47], a[128:131], a[8:11], v[44:47]
s_lshl_b32 s22, s20, 7
ds_read_b64_tr_b16 a[138:139], v23 offset:2048
v_bfe_u32 v20, v1, 4, 3
v_mfma_f32_16x16x32_bf16 v[44:47], a[132:135], a[12:15], v[44:47]
s_add_u32 s70, s22, 94371840
ds_read_b128 a[64:67], v2 offset:16384
ds_read_b128 a[68:71], v3 offset:16384
v_mfma_f32_16x16x32_bf16 v[52:55], a[128:131], a[16:19], v[52:55]
s_lshr_b32 s22, s2, 4
ds_read_b64_tr_b16 a[140:141], v23 offset:16384
v_lshlrev_b32 v20, 3, v20
v_mfma_f32_16x16x32_bf16 v[52:55], a[132:135], a[20:23], v[52:55]
s_lshl_b32 s22, s22, 2
buffer_load_dwordx4 v17, s[12:15], s27 offen offset:1024 lds
v_mfma_f32_16x16x32_bf16 v[60:63], a[128:131], a[24:27], v[60:63]
s_add_u32 s66, s70, s22
ds_read_b64_tr_b16 a[142:143], v23 offset:18432
v_add_u32 v23, 32768, v23
v_mfma_f32_16x16x32_bf16 v[60:63], a[132:135], a[28:31], v[60:63]
s_and_b32 s22, s2, 16
buffer_store_dwordx4 v[48:51], v1, s[4:7], s31 offen sc1
v_mfma_f32_16x16x32_bf16 v[68:71], a[128:131], a[32:35], v[68:71]
s_add_u32 s31, s31, s32
ds_read_b128 a[72:75], v2 offset:18432
v_add_u32 v15, 2052, v20
v_mfma_f32_16x16x32_bf16 v[68:71], a[132:135], a[36:39], v[68:71]
s_lshl_b32 s22, s22, 7
buffer_load_dwordx4 v18, s[12:15], s27 offen offset:2048 lds
v_mfma_f32_16x16x32_bf16 v[76:79], a[128:131], a[40:43], v[76:79]
s_add_u32 s66, s66, s22
ds_read_b128 a[76:79], v3 offset:18432
v_mfma_f32_16x16x32_bf16 v[76:79], a[132:135], a[44:47], v[76:79]
s_lshl_b32 s67, s20, 20
ds_read_b128 a[80:83], v2 offset:20480
v_mfma_f32_16x16x32_bf16 v[84:87], a[128:131], a[48:51], v[84:87]
s_lshl_b32 s22, s37, 16
ds_read_b128 a[84:87], v3 offset:20480
v_mfma_f32_16x16x32_bf16 v[84:87], a[132:135], a[52:55], v[84:87]
s_add_u32 s67, s67, s22
buffer_load_dwordx4 v19, s[12:15], s27 offen offset:3072 lds
v_mfma_f32_16x16x32_bf16 v[92:95], a[128:131], a[56:59], v[92:95]
s_waitcnt lgkmcnt(8)
s_add_u32 s27, s27, 524288
ds_read_b128 a[88:91], v2 offset:22528
v_mfma_f32_16x16x32_bf16 v[92:95], a[132:135], a[60:63], v[92:95]
s_lshl_b32 s22, s3, 11
buffer_store_dwordx4 v[56:59], v1, s[4:7], s31 offen sc1
v_mfma_f32_16x16x32_bf16 v[100:103], a[136:139], a[0:3], v[100:103]
s_waitcnt lgkmcnt(5)
s_add_u32 s31, s31, s34
ds_read_b64_tr_b16 a[128:129], v24 offset:0
v_mfma_f32_16x16x32_bf16 v[100:103], a[140:143], a[4:7], v[100:103]
s_add_u32 s67, s67, s22
v_mfma_f32_16x16x32_bf16 v[108:111], a[136:139], a[8:11], v[108:111]
s_add_u32 s67, s67, 33554432
ds_read_b64_tr_b16 a[130:131], v24 offset:2048
v_mfma_f32_16x16x32_bf16 v[108:111], a[140:143], a[12:15], v[108:111]
s_mov_b32 s68, 1035512379
ds_read_b128 a[92:95], v3 offset:22528
v_mfma_f32_16x16x32_bf16 v[116:119], a[136:139], a[16:19], v[116:119]
s_mov_b32 s69, 1035512379
ds_read_b64_tr_b16 a[132:133], v24 offset:16384
v_mfma_f32_16x16x32_bf16 v[116:119], a[140:143], a[20:23], v[116:119]
buffer_store_dwordx4 v[64:67], v1, s[4:7], s31 offen sc1
v_mfma_f32_16x16x32_bf16 v[124:127], a[136:139], a[24:27], v[124:127]
s_add_u32 s31, s31, s32
ds_read_b64_tr_b16 a[134:135], v24 offset:18432
v_add_u32 v24, 32768, v24
v_mfma_f32_16x16x32_bf16 v[124:127], a[140:143], a[28:31], v[124:127]
v_mfma_f32_16x16x32_bf16 v[132:135], a[136:139], a[32:35], v[132:135]
ds_read_b128 a[96:99], v2 offset:24576
v_mfma_f32_16x16x32_bf16 v[132:135], a[140:143], a[36:39], v[132:135]
v_mfma_f32_16x16x32_bf16 v[140:143], a[136:139], a[40:43], v[140:143]
ds_read_b128 a[100:103], v3 offset:24576
v_mfma_f32_16x16x32_bf16 v[140:143], a[140:143], a[44:47], v[140:143]
ds_read_b128 a[104:107], v2 offset:26624
v_mfma_f32_16x16x32_bf16 v[148:151], a[136:139], a[48:51], v[148:151]
ds_read_b128 a[108:111], v3 offset:26624
v_mfma_f32_16x16x32_bf16 v[148:151], a[140:143], a[52:55], v[148:151]
v_mfma_f32_16x16x32_bf16 v[156:159], a[136:139], a[56:59], v[156:159]
ds_read_b128 a[112:115], v2 offset:28672
v_mfma_f32_16x16x32_bf16 v[156:159], a[140:143], a[60:63], v[156:159]
s_waitcnt lgkmcnt(8)
buffer_store_dwordx4 v[72:75], v1, s[4:7], s31 offen sc1
v_mfma_f32_16x16x32_bf16 v[164:167], a[128:131], a[0:3], v[164:167]
s_waitcnt lgkmcnt(5)
s_add_u32 s31, s31, s33
ds_read_b64_tr_b16 a[136:137], v25 offset:0
v_mfma_f32_16x16x32_bf16 v[164:167], a[132:135], a[4:7], v[164:167]
v_mfma_f32_16x16x32_bf16 v[172:175], a[128:131], a[8:11], v[172:175]
ds_read_b64_tr_b16 a[138:139], v25 offset:2048
v_mfma_f32_16x16x32_bf16 v[172:175], a[132:135], a[12:15], v[172:175]
ds_read_b128 a[116:119], v3 offset:28672
v_mfma_f32_16x16x32_bf16 v[180:183], a[128:131], a[16:19], v[180:183]
ds_read_b64_tr_b16 a[140:141], v25 offset:16384
v_mfma_f32_16x16x32_bf16 v[180:183], a[132:135], a[20:23], v[180:183]
v_mfma_f32_16x16x32_bf16 v[188:191], a[128:131], a[24:27], v[188:191]
ds_read_b64_tr_b16 a[142:143], v25 offset:18432
v_add_u32 v25, 32768, v25
v_mfma_f32_16x16x32_bf16 v[188:191], a[132:135], a[28:31], v[188:191]
v_mfma_f32_16x16x32_bf16 v[196:199], a[128:131], a[32:35], v[196:199]
ds_read_b128 a[120:123], v2 offset:30720
v_mfma_f32_16x16x32_bf16 v[196:199], a[132:135], a[36:39], v[196:199]
buffer_store_dwordx4 v[80:83], v1, s[4:7], s31 offen sc1
v_mfma_f32_16x16x32_bf16 v[204:207], a[128:131], a[40:43], v[204:207]
s_add_u32 s31, s31, s32
ds_read_b128 a[124:127], v3 offset:30720
v_mfma_f32_16x16x32_bf16 v[204:207], a[132:135], a[44:47], v[204:207]
v_mfma_f32_16x16x32_bf16 v[212:215], a[128:131], a[48:51], v[212:215]
v_mfma_f32_16x16x32_bf16 v[212:215], a[132:135], a[52:55], v[212:215]
v_mfma_f32_16x16x32_bf16 v[220:223], a[128:131], a[56:59], v[220:223]
v_mfma_f32_16x16x32_bf16 v[220:223], a[132:135], a[60:63], v[220:223]
s_waitcnt vmcnt(17) lgkmcnt(0)
s_barrier
v_mfma_f32_16x16x32_bf16 v[224:227], a[136:139], a[0:3], v[224:227]
ds_read_b64_tr_b16 a[128:129], v22 offset:0
v_mfma_f32_16x16x32_bf16 v[224:227], a[140:143], a[4:7], v[224:227]
v_mfma_f32_16x16x32_bf16 v[228:231], a[136:139], a[8:11], v[228:231]
ds_read_b64_tr_b16 a[130:131], v22 offset:2048
v_mfma_f32_16x16x32_bf16 v[228:231], a[140:143], a[12:15], v[228:231]
buffer_store_dwordx4 v[88:91], v1, s[4:7], s31 offen sc1
v_mfma_f32_16x16x32_bf16 v[232:235], a[136:139], a[16:19], v[232:235]
ds_read_b64_tr_b16 a[132:133], v22 offset:16384
v_mfma_f32_16x16x32_bf16 v[232:235], a[140:143], a[20:23], v[232:235]
v_mfma_f32_16x16x32_bf16 v[236:239], a[136:139], a[24:27], v[236:239]
ds_read_b64_tr_b16 a[134:135], v22 offset:18432
v_add_u32 v22, 32768, v22
v_mfma_f32_16x16x32_bf16 v[236:239], a[140:143], a[28:31], v[236:239]
v_mfma_f32_16x16x32_bf16 v[240:243], a[136:139], a[32:35], v[240:243]
v_mfma_f32_16x16x32_bf16 v[240:243], a[140:143], a[36:39], v[240:243]
v_mfma_f32_16x16x32_bf16 v[244:247], a[136:139], a[40:43], v[244:247]
v_mfma_f32_16x16x32_bf16 v[244:247], a[140:143], a[44:47], v[244:247]
v_mfma_f32_16x16x32_bf16 v[248:251], a[136:139], a[48:51], v[248:251]
v_mfma_f32_16x16x32_bf16 v[248:251], a[140:143], a[52:55], v[248:251]
v_mfma_f32_16x16x32_bf16 v[252:255], a[136:139], a[56:59], v[252:255]
v_mfma_f32_16x16x32_bf16 v[252:255], a[140:143], a[60:63], v[252:255]
s_waitcnt lgkmcnt(2)
v_mfma_f32_16x16x32_bf16 v[36:39], a[128:131], a[64:67], v[36:39]
s_waitcnt lgkmcnt(0)
ds_read_b64_tr_b16 a[136:137], v23 offset:0
v_mfma_f32_16x16x32_bf16 v[36:39], a[132:135], a[68:71], v[36:39]
v_mfma_f32_16x16x32_bf16 v[44:47], a[128:131], a[72:75], v[44:47]
ds_read_b64_tr_b16 a[138:139], v23 offset:2048
v_mfma_f32_16x16x32_bf16 v[44:47], a[132:135], a[76:79], v[44:47]
ds_read_b128 a[0:3], v2 offset:32768
ds_read_b128 a[4:7], v3 offset:32768
v_mfma_f32_16x16x32_bf16 v[52:55], a[128:131], a[80:83], v[52:55]
ds_read_b64_tr_b16 a[140:141], v23 offset:16384
v_mfma_f32_16x16x32_bf16 v[52:55], a[132:135], a[84:87], v[52:55]
v_mfma_f32_16x16x32_bf16 v[60:63], a[128:131], a[88:91], v[60:63]
ds_read_b64_tr_b16 a[142:143], v23 offset:18432
v_add_u32 v23, 32768, v23
v_mfma_f32_16x16x32_bf16 v[60:63], a[132:135], a[92:95], v[60:63]
v_mfma_f32_16x16x32_bf16 v[68:71], a[128:131], a[96:99], v[68:71]
ds_read_b128 a[8:11], v2 offset:34816
v_mfma_f32_16x16x32_bf16 v[68:71], a[132:135], a[100:103], v[68:71]
v_mfma_f32_16x16x32_bf16 v[76:79], a[128:131], a[104:107], v[76:79]
ds_read_b128 a[12:15], v3 offset:34816
v_mfma_f32_16x16x32_bf16 v[76:79], a[132:135], a[108:111], v[76:79]
ds_read_b128 a[16:19], v2 offset:36864
v_mfma_f32_16x16x32_bf16 v[84:87], a[128:131], a[112:115], v[84:87]
ds_read_b128 a[20:23], v3 offset:36864
v_mfma_f32_16x16x32_bf16 v[84:87], a[132:135], a[116:119], v[84:87]
v_mfma_f32_16x16x32_bf16 v[92:95], a[128:131], a[120:123], v[92:95]
ds_read_b128 a[24:27], v2 offset:38912
v_mfma_f32_16x16x32_bf16 v[92:95], a[132:135], a[124:127], v[92:95]
s_waitcnt lgkmcnt(9)
v_mfma_f32_16x16x32_bf16 v[100:103], a[136:139], a[64:67], v[100:103]
s_waitcnt lgkmcnt(5)
ds_read_b64_tr_b16 a[128:129], v24 offset:0
v_mfma_f32_16x16x32_bf16 v[100:103], a[140:143], a[68:71], v[100:103]
v_mfma_f32_16x16x32_bf16 v[108:111], a[136:139], a[72:75], v[108:111]
ds_read_b64_tr_b16 a[130:131], v24 offset:2048
v_mfma_f32_16x16x32_bf16 v[108:111], a[140:143], a[76:79], v[108:111]
ds_read_b128 a[28:31], v3 offset:38912
v_mfma_f32_16x16x32_bf16 v[116:119], a[136:139], a[80:83], v[116:119]
ds_read_b64_tr_b16 a[132:133], v24 offset:16384
v_mfma_f32_16x16x32_bf16 v[116:119], a[140:143], a[84:87], v[116:119]
v_mfma_f32_16x16x32_bf16 v[124:127], a[136:139], a[88:91], v[124:127]
ds_read_b64_tr_b16 a[134:135], v24 offset:18432
v_add_u32 v24, 32768, v24
v_mfma_f32_16x16x32_bf16 v[124:127], a[140:143], a[92:95], v[124:127]
v_mfma_f32_16x16x32_bf16 v[132:135], a[136:139], a[96:99], v[132:135]
ds_read_b128 a[32:35], v2 offset:40960
v_mfma_f32_16x16x32_bf16 v[132:135], a[140:143], a[100:103], v[132:135]
v_mfma_f32_16x16x32_bf16 v[140:143], a[136:139], a[104:107], v[140:143]
ds_read_b128 a[36:39], v3 offset:40960
v_mfma_f32_16x16x32_bf16 v[140:143], a[140:143], a[108:111], v[140:143]
ds_read_b128 a[40:43], v2 offset:43008
v_mfma_f32_16x16x32_bf16 v[148:151], a[136:139], a[112:115], v[148:151]
ds_read_b128 a[44:47], v3 offset:43008
v_mfma_f32_16x16x32_bf16 v[148:151], a[140:143], a[116:119], v[148:151]
v_mfma_f32_16x16x32_bf16 v[156:159], a[136:139], a[120:123], v[156:159]
ds_read_b128 a[48:51], v2 offset:45056
v_mfma_f32_16x16x32_bf16 v[156:159], a[140:143], a[124:127], v[156:159]
s_waitcnt lgkmcnt(8)
v_mfma_f32_16x16x32_bf16 v[164:167], a[128:131], a[64:67], v[164:167]
s_waitcnt lgkmcnt(5)
ds_read_b64_tr_b16 a[136:137], v25 offset:0
v_mfma_f32_16x16x32_bf16 v[164:167], a[132:135], a[68:71], v[164:167]
v_mfma_f32_16x16x32_bf16 v[172:175], a[128:131], a[72:75], v[172:175]
ds_read_b64_tr_b16 a[138:139], v25 offset:2048
v_mfma_f32_16x16x32_bf16 v[172:175], a[132:135], a[76:79], v[172:175]
ds_read_b128 a[52:55], v3 offset:45056
v_mfma_f32_16x16x32_bf16 v[180:183], a[128:131], a[80:83], v[180:183]
ds_read_b64_tr_b16 a[140:141], v25 offset:16384
v_mfma_f32_16x16x32_bf16 v[180:183], a[132:135], a[84:87], v[180:183]
v_mfma_f32_16x16x32_bf16 v[188:191], a[128:131], a[88:91], v[188:191]
ds_read_b64_tr_b16 a[142:143], v25 offset:18432
v_add_u32 v25, 32768, v25
v_mfma_f32_16x16x32_bf16 v[188:191], a[132:135], a[92:95], v[188:191]
v_mfma_f32_16x16x32_bf16 v[196:199], a[128:131], a[96:99], v[196:199]
ds_read_b128 a[56:59], v2 offset:47104
v_mfma_f32_16x16x32_bf16 v[196:199], a[132:135], a[100:103], v[196:199]
v_mfma_f32_16x16x32_bf16 v[204:207], a[128:131], a[104:107], v[204:207]
ds_read_b128 a[60:63], v3 offset:47104
v_mfma_f32_16x16x32_bf16 v[204:207], a[132:135], a[108:111], v[204:207]
v_mfma_f32_16x16x32_bf16 v[212:215], a[128:131], a[112:115], v[212:215]
v_mfma_f32_16x16x32_bf16 v[212:215], a[132:135], a[116:119], v[212:215]
v_mfma_f32_16x16x32_bf16 v[220:223], a[128:131], a[120:123], v[220:223]
v_mfma_f32_16x16x32_bf16 v[220:223], a[132:135], a[124:127], v[220:223]
s_waitcnt vmcnt(0) lgkmcnt(0)
s_barrier
v_mfma_f32_16x16x32_bf16 v[224:227], a[136:139], a[64:67], v[224:227]
ds_read_b64_tr_b16 a[128:129], v22 offset:0
v_mfma_f32_16x16x32_bf16 v[224:227], a[140:143], a[68:71], v[224:227]
buffer_store_dword v27, v26, s[4:7], s66 offen sc1
v_mfma_f32_16x16x32_bf16 v[228:231], a[136:139], a[72:75], v[228:231]
ds_read_b64_tr_b16 a[130:131], v22 offset:2048
v_mfma_f32_16x16x32_bf16 v[228:231], a[140:143], a[76:79], v[228:231]
v_mfma_f32_16x16x32_bf16 v[232:235], a[136:139], a[80:83], v[232:235]
ds_read_b64_tr_b16 a[132:133], v22 offset:16384
v_mfma_f32_16x16x32_bf16 v[232:235], a[140:143], a[84:87], v[232:235]
v_mfma_f32_16x16x32_bf16 v[236:239], a[136:139], a[88:91], v[236:239]
ds_read_b64_tr_b16 a[134:135], v22 offset:18432
v_mfma_f32_16x16x32_bf16 v[236:239], a[140:143], a[92:95], v[236:239]
v_mfma_f32_16x16x32_bf16 v[240:243], a[136:139], a[96:99], v[240:243]
v_mfma_f32_16x16x32_bf16 v[240:243], a[140:143], a[100:103], v[240:243]
v_mfma_f32_16x16x32_bf16 v[244:247], a[136:139], a[104:107], v[244:247]
v_mfma_f32_16x16x32_bf16 v[244:247], a[140:143], a[108:111], v[244:247]
v_mfma_f32_16x16x32_bf16 v[248:251], a[136:139], a[112:115], v[248:251]
v_mfma_f32_16x16x32_bf16 v[248:251], a[140:143], a[116:119], v[248:251]
v_mfma_f32_16x16x32_bf16 v[252:255], a[136:139], a[120:123], v[252:255]
v_mfma_f32_16x16x32_bf16 v[252:255], a[140:143], a[124:127], v[252:255]
s_waitcnt lgkmcnt(2)
v_mfma_f32_16x16x32_bf16 v[36:39], a[128:131], a[0:3], v[36:39]
s_waitcnt lgkmcnt(0)
ds_read_b64_tr_b16 a[136:137], v23 offset:0
v_lshrrev_b32 v28, 6, v0
v_mfma_f32_16x16x32_bf16 v[36:39], a[132:135], a[4:7], v[36:39]
s_lshl_b32 s18, s3, 13
v_lshl_add_u32 v28, v28, 11, v1
v_add_u32 v28, 65536, v28
v_mfma_f32_16x16x32_bf16 v[44:47], a[128:131], a[8:11], v[44:47]
s_lshl_b32 s30, s20, 20
ds_read_b64_tr_b16 a[138:139], v23 offset:2048
v_lshrrev_b32 v3, 6, v0
v_mfma_f32_16x16x32_bf16 v[44:47], a[132:135], a[12:15], v[44:47]
s_add_u32 s30, s30, s18
v_and_b32 v4, 63, v0
v_add_u32 v2, 0x10000, v1
v_mfma_f32_16x16x32_bf16 v[52:55], a[128:131], a[16:19], v[52:55]
s_lshl_b32 s22, s21, 1
ds_read_b64_tr_b16 a[140:141], v23 offset:16384
v_and_b32 v5, 15, v4
v_mfma_f32_16x16x32_bf16 v[52:55], a[132:135], a[20:23], v[52:55]
s_lshl_b32 s85, s21, 2
v_lshrrev_b32 v6, 4, v4
v_lshlrev_b32 v6, 2, v6
v_mfma_f32_16x16x32_bf16 v[60:63], a[128:131], a[24:27], v[60:63]
s_lshr_b32 s85, 2386092, s85
ds_read_b64_tr_b16 a[142:143], v23 offset:18432
v_sub_u32 v5, v5, v6
v_mfma_f32_16x16x32_bf16 v[60:63], a[132:135], a[28:31], v[60:63]
s_and_b32 s9, s85, 15
v_lshl_add_u32 v5, v3, 4, v5
v_cmp_gt_i32 s[32:33], 0, v5
v_mfma_f32_16x16x32_bf16 v[68:71], a[128:131], a[32:35], v[68:71]
s_and_b32 s84, s85, 1
v_cmp_gt_i32 s[34:35], 1, v5
v_cmp_gt_i32 s[36:37], 2, v5
v_mfma_f32_16x16x32_bf16 v[68:71], a[132:135], a[36:39], v[68:71]
s_lshl_b32 s84, s84, 17
v_cmp_gt_i32 s[38:39], 3, v5
v_cmp_gt_i32 s[40:41], 16, v5
v_mfma_f32_16x16x32_bf16 v[76:79], a[128:131], a[40:43], v[76:79]
s_add_u32 s84, s84, s18
v_cmp_gt_i32 s[42:43], 17, v5
v_cmp_gt_i32 s[44:45], 18, v5
v_mfma_f32_16x16x32_bf16 v[76:79], a[132:135], a[44:47], v[76:79]
s_xor_b32 s85, s84, 0x20000
v_cmp_gt_i32 s[46:47], 19, v5
v_cmp_gt_i32 s[48:49], 32, v5
v_mfma_f32_16x16x32_bf16 v[84:87], a[128:131], a[48:51], v[84:87]
s_sub_u32 s29, 15, s21
v_cmp_gt_i32 s[50:51], 33, v5
v_cmp_gt_i32 s[52:53], 34, v5
v_mfma_f32_16x16x32_bf16 v[84:87], a[132:135], a[52:55], v[84:87]
s_cmp_lg_u32 s9, 0
v_cmp_gt_i32 s[54:55], 35, v5
v_cmp_gt_i32 s[56:57], 48, v5
v_mfma_f32_16x16x32_bf16 v[92:95], a[128:131], a[56:59], v[92:95]
s_cselect_b32 s24, 1, 0
v_cmp_gt_i32 s[58:59], 49, v5
v_cmp_gt_i32 s[60:61], 50, v5
v_mfma_f32_16x16x32_bf16 v[92:95], a[132:135], a[60:63], v[92:95]
s_waitcnt lgkmcnt(2)
v_cmp_gt_i32 s[62:63], 51, v5
v_mov_b32 v7, 0xff800000
v_mfma_f32_16x16x32_bf16 v[100:103], a[136:139], a[0:3], v[100:103]
s_waitcnt lgkmcnt(0)
ds_read_b64_tr_b16 a[128:129], v24 offset:0
v_mov_b32 v6, 1
v_mfma_f32_16x16x32_bf16 v[100:103], a[140:143], a[4:7], v[100:103]
s_cselect_b32 s67, s67, 3221225472
v_mov_b32 v5, v26
v_add_u32 v4, 0x20000, v1
v_mfma_f32_16x16x32_bf16 v[108:111], a[136:139], a[8:11], v[108:111]
s_lshl_b32 s8, s9, 15
ds_read_b64_tr_b16 a[130:131], v24 offset:2048
v_mfma_f32_16x16x32_bf16 v[108:111], a[140:143], a[12:15], v[108:111]
s_add_u32 s8, s8, s30
v_mfma_f32_16x16x32_bf16 v[116:119], a[136:139], a[16:19], v[116:119]
s_add_u32 s9, s9, s22
ds_read_b64_tr_b16 a[132:133], v24 offset:16384
v_mfma_f32_16x16x32_bf16 v[116:119], a[140:143], a[20:23], v[116:119]
s_sub_u32 s9, 32, s9
v_mfma_f32_16x16x32_bf16 v[124:127], a[136:139], a[24:27], v[124:127]
s_bitcmp1_b32 s2, 4
ds_read_b64_tr_b16 a[134:135], v24 offset:18432
v_mul_f32 v36, s68, v36
v_mfma_f32_16x16x32_bf16 v[124:127], a[140:143], a[28:31], v[124:127]
s_cselect_b32 s9, 16, s9
v_mul_f32 v37, s68, v37
v_mul_f32 v38, s68, v38
v_mfma_f32_16x16x32_bf16 v[132:135], a[136:139], a[32:35], v[132:135]
s_cselect_b32 s29, 7, s29
v_mul_f32 v39, s68, v39
v_mul_f32 v100, s68, v100
v_mfma_f32_16x16x32_bf16 v[132:135], a[140:143], a[36:39], v[132:135]
s_mov_b32 s10, 3221225472
v_mul_f32 v101, s68, v101
v_mul_f32 v102, s68, v102
v_mfma_f32_16x16x32_bf16 v[140:143], a[136:139], a[40:43], v[140:143]
s_mov_b32 s14, 3221225472
v_mul_f32 v103, s68, v103
v_cvt_pk_bf16_f32 v36, v36, v37
v_mfma_f32_16x16x32_bf16 v[140:143], a[140:143], a[44:47], v[140:143]
s_mov_b32 s11, 0
v_cvt_pk_bf16_f32 v37, v38, v39
v_cvt_pk_bf16_f32 v38, v100, v101
v_mfma_f32_16x16x32_bf16 v[148:151], a[136:139], a[48:51], v[148:151]
s_lshr_b32 s19, s9, 1
v_cvt_pk_bf16_f32 v39, v102, v103
v_mul_f32 v44, s68, v44
v_mfma_f32_16x16x32_bf16 v[148:151], a[140:143], a[52:55], v[148:151]
s_sub_u32 s19, s19, 1
ds_write_b128 v28, v[36:39] offset:0
v_mul_f32 v45, s68, v45
v_mfma_f32_16x16x32_bf16 v[156:159], a[136:139], a[56:59], v[156:159]
s_add_u32 s12, s8, 16777216
s_add_u32 s23, s67, 0
buffer_store_dwordx4 v[36:39], v1, s[4:7], s23 offen offset:0 sc1
v_mfma_f32_16x16x32_bf16 v[156:159], a[140:143], a[60:63], v[156:159]
s_waitcnt lgkmcnt(3)
v_mul_f32 v46, s68, v46
v_mul_f32 v47, s68, v47
v_mfma_f32_16x16x32_bf16 v[164:167], a[128:131], a[0:3], v[164:167]
s_waitcnt lgkmcnt(1)
ds_read_b64_tr_b16 a[136:137], v25 offset:0
v_mul_f32 v108, s68, v108
v_mfma_f32_16x16x32_bf16 v[164:167], a[132:135], a[4:7], v[164:167]
s_mov_b32 s13, s9
v_mul_f32 v109, s68, v109
v_mul_f32 v110, s68, v110
v_mfma_f32_16x16x32_bf16 v[172:175], a[128:131], a[8:11], v[172:175]
s_mov_b32 s15, s11
ds_read_b64_tr_b16 a[138:139], v25 offset:2048
v_mul_f32 v111, s68, v111
v_mfma_f32_16x16x32_bf16 v[172:175], a[132:135], a[12:15], v[172:175]
v_cvt_pk_bf16_f32 v44, v44, v45
v_cvt_pk_bf16_f32 v45, v46, v47
v_mfma_f32_16x16x32_bf16 v[180:183], a[128:131], a[16:19], v[180:183]
ds_read_b64_tr_b16 a[140:141], v25 offset:16384
v_cvt_pk_bf16_f32 v46, v108, v109
v_mfma_f32_16x16x32_bf16 v[180:183], a[132:135], a[20:23], v[180:183]
v_cvt_pk_bf16_f32 v47, v110, v111
v_mul_f32 v52, s68, v52
v_mfma_f32_16x16x32_bf16 v[188:191], a[128:131], a[24:27], v[188:191]
ds_read_b64_tr_b16 a[142:143], v25 offset:18432
v_mul_f32 v53, s68, v53
v_mfma_f32_16x16x32_bf16 v[188:191], a[132:135], a[28:31], v[188:191]
ds_write_b128 v28, v[44:47] offset:8192
v_mul_f32 v54, s68, v54
v_mfma_f32_16x16x32_bf16 v[196:199], a[128:131], a[32:35], v[196:199]
s_add_u32 s23, s67, 8192
buffer_store_dwordx4 v[44:47], v1, s[4:7], s23 offen offset:0 sc1
v_mfma_f32_16x16x32_bf16 v[196:199], a[132:135], a[36:39], v[196:199]
v_mul_f32 v55, s68, v55
v_mul_f32 v116, s68, v116
v_mfma_f32_16x16x32_bf16 v[204:207], a[128:131], a[40:43], v[204:207]
v_mul_f32 v117, s68, v117
v_mul_f32 v118, s68, v118
v_mfma_f32_16x16x32_bf16 v[204:207], a[132:135], a[44:47], v[204:207]
v_mul_f32 v119, s68, v119
v_cvt_pk_bf16_f32 v52, v52, v53
v_mfma_f32_16x16x32_bf16 v[212:215], a[128:131], a[48:51], v[212:215]
v_cvt_pk_bf16_f32 v53, v54, v55
v_cvt_pk_bf16_f32 v54, v116, v117
v_mfma_f32_16x16x32_bf16 v[212:215], a[132:135], a[52:55], v[212:215]
v_cvt_pk_bf16_f32 v55, v118, v119
v_mul_f32 v60, s68, v60
v_mfma_f32_16x16x32_bf16 v[220:223], a[128:131], a[56:59], v[220:223]
ds_write_b128 v28, v[52:55] offset:16384
v_mul_f32 v61, s68, v61
v_mfma_f32_16x16x32_bf16 v[220:223], a[132:135], a[60:63], v[220:223]
s_waitcnt lgkmcnt(2)
s_waitcnt lgkmcnt(0)
s_barrier
v_mfma_f32_16x16x32_bf16 v[224:227], a[136:139], a[0:3], v[224:227]
s_add_u32 s23, s67, 16384
buffer_store_dwordx4 v[52:55], v1, s[4:7], s23 offen offset:0 sc1
v_mfma_f32_16x16x32_bf16 v[224:227], a[140:143], a[4:7], v[224:227]
v_mul_f32 v62, s68, v62
v_mul_f32 v63, s68, v63
v_mfma_f32_16x16x32_bf16 v[228:231], a[136:139], a[8:11], v[228:231]
v_mul_f32 v124, s68, v124
v_mul_f32 v125, s68, v125
v_mfma_f32_16x16x32_bf16 v[228:231], a[140:143], a[12:15], v[228:231]
v_mul_f32 v126, s68, v126
v_mul_f32 v127, s68, v127
v_mfma_f32_16x16x32_bf16 v[232:235], a[136:139], a[16:19], v[232:235]
v_cvt_pk_bf16_f32 v60, v60, v61
v_cvt_pk_bf16_f32 v61, v62, v63
v_mfma_f32_16x16x32_bf16 v[232:235], a[140:143], a[20:23], v[232:235]
v_cvt_pk_bf16_f32 v62, v124, v125
v_cvt_pk_bf16_f32 v63, v126, v127
v_mfma_f32_16x16x32_bf16 v[236:239], a[136:139], a[24:27], v[236:239]
ds_write_b128 v28, v[60:63] offset:24576
v_mul_f32 v68, s68, v68
v_mfma_f32_16x16x32_bf16 v[236:239], a[140:143], a[28:31], v[236:239]
s_add_u32 s23, s67, 24576
buffer_store_dwordx4 v[60:63], v1, s[4:7], s23 offen offset:0 sc1
v_mfma_f32_16x16x32_bf16 v[240:243], a[136:139], a[32:35], v[240:243]
v_mul_f32 v69, s68, v69
v_mul_f32 v70, s68, v70
v_mfma_f32_16x16x32_bf16 v[240:243], a[140:143], a[36:39], v[240:243]
v_mul_f32 v71, s68, v71
v_mul_f32 v132, s68, v132
v_mfma_f32_16x16x32_bf16 v[244:247], a[136:139], a[40:43], v[244:247]
v_mul_f32 v133, s68, v133
v_mul_f32 v134, s68, v134
v_mfma_f32_16x16x32_bf16 v[244:247], a[140:143], a[44:47], v[244:247]
v_mul_f32 v135, s68, v135
v_cvt_pk_bf16_f32 v68, v68, v69
v_mfma_f32_16x16x32_bf16 v[248:251], a[136:139], a[48:51], v[248:251]
v_cvt_pk_bf16_f32 v69, v70, v71
v_cvt_pk_bf16_f32 v70, v132, v133
v_mfma_f32_16x16x32_bf16 v[248:251], a[140:143], a[52:55], v[248:251]
v_cvt_pk_bf16_f32 v71, v134, v135
v_mfma_f32_16x16x32_bf16 v[252:255], a[136:139], a[56:59], v[252:255]
ds_write_b128 v28, v[68:71] offset:32768
v_mfma_f32_16x16x32_bf16 v[252:255], a[140:143], a[60:63], v[252:255]
s_add_u32 s23, s67, 32768
buffer_store_dwordx4 v[68:71], v1, s[4:7], s23 offen offset:0 sc1
buffer_load_dword v21, v20, s[4:7], s70 offen sc1
v_pk_mul_f32 v[76:77], v[76:77], s[68:69]
v_pk_mul_f32 v[78:79], v[78:79], s[68:69]
v_pk_mul_f32 v[140:141], v[140:141], s[68:69]
v_pk_mul_f32 v[142:143], v[142:143], s[68:69]
v_cvt_pk_bf16_f32 v76, v76, v77
v_cvt_pk_bf16_f32 v77, v78, v79
v_cvt_pk_bf16_f32 v78, v140, v141
v_cvt_pk_bf16_f32 v79, v142, v143
ds_write_b128 v28, v[76:79] offset:40960
s_add_u32 s23, s67, 40960
buffer_store_dwordx4 v[76:79], v1, s[4:7], s23 offen offset:0 sc1
v_pk_mul_f32 v[84:85], v[84:85], s[68:69]
v_pk_mul_f32 v[86:87], v[86:87], s[68:69]
v_pk_mul_f32 v[148:149], v[148:149], s[68:69]
v_pk_mul_f32 v[150:151], v[150:151], s[68:69]
v_cvt_pk_bf16_f32 v84, v84, v85
v_cvt_pk_bf16_f32 v85, v86, v87
v_cvt_pk_bf16_f32 v86, v148, v149
v_cvt_pk_bf16_f32 v87, v150, v151
ds_write_b128 v28, v[84:87] offset:49152
s_add_u32 s23, s67, 49152
buffer_store_dwordx4 v[84:87], v1, s[4:7], s23 offen offset:0 sc1
v_pk_mul_f32 v[92:93], v[92:93], s[68:69]
v_pk_mul_f32 v[94:95], v[94:95], s[68:69]
v_pk_mul_f32 v[156:157], v[156:157], s[68:69]
v_pk_mul_f32 v[158:159], v[158:159], s[68:69]
v_cvt_pk_bf16_f32 v92, v92, v93
v_cvt_pk_bf16_f32 v93, v94, v95
v_cvt_pk_bf16_f32 v94, v156, v157
v_cvt_pk_bf16_f32 v95, v158, v159
ds_write_b128 v28, v[92:95] offset:57344
s_add_u32 s23, s67, 57344
buffer_store_dwordx4 v[92:95], v1, s[4:7], s23 offen offset:0 sc1
v_pk_mul_f32 v[164:165], v[164:165], s[68:69]
v_pk_mul_f32 v[166:167], v[166:167], s[68:69]
v_pk_mul_f32 v[224:225], v[224:225], s[68:69]
v_pk_mul_f32 v[226:227], v[226:227], s[68:69]
v_cvt_pk_bf16_f32 v164, v164, v165
v_cvt_pk_bf16_f32 v165, v166, v167
v_cvt_pk_bf16_f32 v166, v224, v225
v_cvt_pk_bf16_f32 v167, v226, v227
ds_write_b128 v28, v[164:167] offset:1024
s_add_u32 s23, s67, 0
buffer_store_dwordx4 v[164:167], v1, s[4:7], s23 offen offset:1024 sc1
v_pk_mul_f32 v[172:173], v[172:173], s[68:69]
v_pk_mul_f32 v[174:175], v[174:175], s[68:69]
v_pk_mul_f32 v[228:229], v[228:229], s[68:69]
v_pk_mul_f32 v[230:231], v[230:231], s[68:69]
v_cvt_pk_bf16_f32 v172, v172, v173
v_cvt_pk_bf16_f32 v173, v174, v175
v_cvt_pk_bf16_f32 v174, v228, v229
v_cvt_pk_bf16_f32 v175, v230, v231
ds_write_b128 v28, v[172:175] offset:9216
s_add_u32 s23, s67, 8192
buffer_store_dwordx4 v[172:175], v1, s[4:7], s23 offen offset:1024 sc1
v_pk_mul_f32 v[180:181], v[180:181], s[68:69]
v_pk_mul_f32 v[182:183], v[182:183], s[68:69]
v_pk_mul_f32 v[232:233], v[232:233], s[68:69]
v_pk_mul_f32 v[234:235], v[234:235], s[68:69]
v_cvt_pk_bf16_f32 v180, v180, v181
v_cvt_pk_bf16_f32 v181, v182, v183
v_cvt_pk_bf16_f32 v182, v232, v233
v_cvt_pk_bf16_f32 v183, v234, v235
ds_write_b128 v28, v[180:183] offset:17408
s_add_u32 s23, s67, 16384
buffer_store_dwordx4 v[180:183], v1, s[4:7], s23 offen offset:1024 sc1
v_pk_mul_f32 v[188:189], v[188:189], s[68:69]
v_pk_mul_f32 v[190:191], v[190:191], s[68:69]
v_pk_mul_f32 v[236:237], v[236:237], s[68:69]
v_pk_mul_f32 v[238:239], v[238:239], s[68:69]
v_cvt_pk_bf16_f32 v188, v188, v189
v_cvt_pk_bf16_f32 v189, v190, v191
v_cvt_pk_bf16_f32 v190, v236, v237
v_cvt_pk_bf16_f32 v191, v238, v239
ds_write_b128 v28, v[188:191] offset:25600
s_add_u32 s23, s67, 24576
buffer_store_dwordx4 v[188:191], v1, s[4:7], s23 offen offset:1024 sc1
v_pk_mul_f32 v[196:197], v[196:197], s[68:69]
v_pk_mul_f32 v[198:199], v[198:199], s[68:69]
v_pk_mul_f32 v[240:241], v[240:241], s[68:69]
v_pk_mul_f32 v[242:243], v[242:243], s[68:69]
v_cvt_pk_bf16_f32 v196, v196, v197
v_cvt_pk_bf16_f32 v197, v198, v199
v_cvt_pk_bf16_f32 v198, v240, v241
v_cvt_pk_bf16_f32 v199, v242, v243
ds_write_b128 v28, v[196:199] offset:33792
s_add_u32 s23, s67, 32768
buffer_store_dwordx4 v[196:199], v1, s[4:7], s23 offen offset:1024 sc1
v_pk_mul_f32 v[204:205], v[204:205], s[68:69]
v_pk_mul_f32 v[206:207], v[206:207], s[68:69]
v_pk_mul_f32 v[244:245], v[244:245], s[68:69]
v_pk_mul_f32 v[246:247], v[246:247], s[68:69]
v_cvt_pk_bf16_f32 v204, v204, v205
v_cvt_pk_bf16_f32 v205, v206, v207
v_cvt_pk_bf16_f32 v206, v244, v245
v_cvt_pk_bf16_f32 v207, v246, v247
ds_write_b128 v28, v[204:207] offset:41984
s_add_u32 s23, s67, 40960
buffer_store_dwordx4 v[204:207], v1, s[4:7], s23 offen offset:1024 sc1
v_pk_mul_f32 v[212:213], v[212:213], s[68:69]
v_pk_mul_f32 v[214:215], v[214:215], s[68:69]
v_pk_mul_f32 v[248:249], v[248:249], s[68:69]
v_pk_mul_f32 v[250:251], v[250:251], s[68:69]
v_cvt_pk_bf16_f32 v212, v212, v213
v_cvt_pk_bf16_f32 v213, v214, v215
v_cvt_pk_bf16_f32 v214, v248, v249
v_cvt_pk_bf16_f32 v215, v250, v251
ds_write_b128 v28, v[212:215] offset:50176
s_add_u32 s23, s67, 49152
buffer_store_dwordx4 v[212:215], v1, s[4:7], s23 offen offset:1024 sc1
v_pk_mul_f32 v[220:221], v[220:221], s[68:69]
v_pk_mul_f32 v[222:223], v[222:223], s[68:69]
v_pk_mul_f32 v[252:253], v[252:253], s[68:69]
v_pk_mul_f32 v[254:255], v[254:255], s[68:69]
v_cvt_pk_bf16_f32 v220, v220, v221
v_cvt_pk_bf16_f32 v221, v222, v223
v_cvt_pk_bf16_f32 v222, v252, v253
v_cvt_pk_bf16_f32 v223, v254, v255
ds_write_b128 v28, v[220:223] offset:58368
s_add_u32 s23, s67, 57344
buffer_store_dwordx4 v[220:223], v1, s[4:7], s23 offen offset:1024 sc1
s_waitcnt vmcnt(11)
v_cmp_gt_u32 vcc, 1, v21
s_cbranch_vccnz M_kspin
M_kok:
buffer_load_dword v21, v15, s[4:7], s70 offen sc1
s_mov_b32 m0, s84
s_nop 0
buffer_load_dwordx4 v1, s[4:7], s8 offen offset:0 sc1 lds
buffer_load_dwordx4 v1, s[4:7], s8 offen offset:1024 sc1 lds
buffer_load_dwordx4 v1, s[4:7], s8 offen offset:2048 sc1 lds
buffer_load_dwordx4 v1, s[4:7], s8 offen offset:3072 sc1 lds
s_add_u32 s8, s8, 4096
s_add_u32 m0, s84, 4096
s_nop 0
buffer_load_dwordx4 v1, s[4:7], s8 offen offset:0 sc1 lds
buffer_load_dwordx4 v1, s[4:7], s8 offen offset:1024 sc1 lds
buffer_load_dwordx4 v1, s[4:7], s8 offen offset:2048 sc1 lds
buffer_load_dwordx4 v1, s[4:7], s8 offen offset:3072 sc1 lds
s_add_u32 s8, s8, 28672
s_sub_u32 s9, s9, 1
s_cmp_eq_u32 s9, 0
s_cselect_b32 s8, s10, s8
s_cselect_b32 s9, s11, s9
s_cselect_b32 s10, 3221225472, s10
v_add_u32 v28, s18, v2
s_waitcnt lgkmcnt(0)
s_barrier
ds_read_b128 a[0:3], v28 offset:0
ds_read_b128 a[4:7], v28 offset:1024
ds_read_b128 a[8:11], v28 offset:2048
ds_read_b128 a[12:15], v28 offset:3072
ds_read_b128 a[16:19], v28 offset:4096
ds_read_b128 a[20:23], v28 offset:5120
ds_read_b128 a[24:27], v28 offset:6144
ds_read_b128 a[28:31], v28 offset:7168
ds_read_b128 a[32:35], v28 offset:32768
ds_read_b128 a[36:39], v28 offset:33792
ds_read_b128 a[40:43], v28 offset:34816
ds_read_b128 a[44:47], v28 offset:35840
ds_read_b128 a[48:51], v28 offset:36864
ds_read_b128 a[52:55], v28 offset:37888
ds_read_b128 a[56:59], v28 offset:38912
ds_read_b128 a[60:63], v28 offset:39936
s_mov_b32 m0, s85
s_nop 0
buffer_load_dwordx4 v1, s[4:7], s8 offen offset:0 sc1 lds
buffer_load_dwordx4 v1, s[4:7], s8 offen offset:1024 sc1 lds
buffer_load_dwordx4 v1, s[4:7], s8 offen offset:2048 sc1 lds
buffer_load_dwordx4 v1, s[4:7], s8 offen offset:3072 sc1 lds
s_add_u32 s8, s8, 4096
s_add_u32 m0, s85, 4096
s_nop 0
buffer_load_dwordx4 v1, s[4:7], s8 offen offset:0 sc1 lds
buffer_load_dwordx4 v1, s[4:7], s8 offen offset:1024 sc1 lds
buffer_load_dwordx4 v1, s[4:7], s8 offen offset:2048 sc1 lds
buffer_load_dwordx4 v1, s[4:7], s8 offen offset:3072 sc1 lds
s_add_u32 s8, s8, 28672
s_sub_u32 s9, s9, 1
s_cmp_eq_u32 s9, 0
s_cselect_b32 s8, s10, s8
s_cselect_b32 s9, s11, s9
s_cselect_b32 s10, 3221225472, s10
s_mov_b32 s25, 1266679808
s_lshl_b32 s22, s21, 3
s_add_u32 s28, s70, s22
s_add_u32 s28, s28, 6148
s_lshl_b32 s26, s21, 16
s_add_u32 s26, s26, s30
s_add_u32 s26, s26, 33554432
s_lshl_b32 s76, s20, 3
s_add_u32 s76, s76, s21
s_lshl_b32 s76, s76, 2
s_add_u32 s76, s76, s3
s_lshl_b32 s27, s76, 10
s_add_u32 s27, s27, 75497472
s_lshl_b32 s76, s76, 14
s_add_u32 s76, s76, 67108864
s_lshl_b32 s81, s20, 2
s_add_u32 s81, s81, s3
s_mul_i32 s81, s81, 57344
s_cmp_eq_u32 s24, 1
s_cselect_b32 s80, s28, s70
s_add_u32 s77, s76, 8192
v_lshrrev_b32 v8, 7, v1
v_and_b32 v9, 6, v8
v_lshlrev_b32 v9, 4, v9
v_and_b32 v10, 0x70, v1
v_xor_b32 v9, v9, v10
v_mul_u32_u24 v8, 896, v8
v_add_u32 v8, v8, v9
v_accvgpr_write_b32 a184, v8
v_add_u32 v8, 6144, v8
v_accvgpr_write_b32 a185, v8
v_add_u32 v8, 6144, v8
v_accvgpr_write_b32 a186, v8
v_add_u32 v8, 6144, v8
v_accvgpr_write_b32 a187, v8
v_lshrrev_b32 v8, 6, v1
v_bfe_u32 v9, v1, 7, 2
v_lshlrev_b32 v9, 5, v9
v_lshl_add_u32 v8, v8, 7, v9
v_bfe_u32 v9, v1, 4, 2
v_lshl_add_u32 v8, v9, 3, v8
v_add_u32 v8, 32768, v8
v_accvgpr_write_b32 a188, v8
v_xor_b32 v9, 32, v8
v_accvgpr_write_b32 a189, v9
v_xor_b32 v9, 64, v8
v_accvgpr_write_b32 a190, v9
v_xor_b32 v9, 96, v8
v_accvgpr_write_b32 a191, v9
s_add_u32 s22, s66, 16384
s_mov_b32 s71, 3221225472
s_waitcnt vmcnt(17)
s_barrier
buffer_store_dword v6, v5, s[4:7], s22 offen sc1
v_mov_b64 v[128:129], 0
v_mov_b64 v[130:131], 0
v_mov_b64 v[132:133], 0
v_mov_b64 v[134:135], 0
v_mov_b64 v[136:137], 0
v_mov_b64 v[138:139], 0
v_mov_b64 v[140:141], 0
v_mov_b64 v[142:143], 0
v_mov_b64 v[144:145], 0
v_mov_b64 v[146:147], 0
v_mov_b64 v[148:149], 0
v_mov_b64 v[150:151], 0
v_mov_b64 v[152:153], 0
v_mov_b64 v[154:155], 0
v_mov_b64 v[156:157], 0
v_mov_b64 v[158:159], 0
v_mov_b64 v[160:161], 0
v_mov_b64 v[162:163], 0
v_mov_b64 v[164:165], 0
v_mov_b64 v[166:167], 0
v_mov_b64 v[168:169], 0
v_mov_b64 v[170:171], 0
v_mov_b64 v[172:173], 0
v_mov_b64 v[174:175], 0
v_mov_b64 v[176:177], 0
v_mov_b64 v[178:179], 0
v_mov_b64 v[180:181], 0
v_mov_b64 v[182:183], 0
v_mov_b64 v[184:185], 0
v_mov_b64 v[186:187], 0
v_mov_b64 v[188:189], 0
v_mov_b64 v[190:191], 0
v_mov_b64 v[192:193], 0
v_mov_b64 v[194:195], 0
v_mov_b64 v[196:197], 0
v_mov_b64 v[198:199], 0
v_mov_b64 v[200:201], 0
v_mov_b64 v[202:203], 0
v_mov_b64 v[204:205], 0
v_mov_b64 v[206:207], 0
v_mov_b64 v[208:209], 0
v_mov_b64 v[210:211], 0
v_mov_b64 v[212:213], 0
v_mov_b64 v[214:215], 0
v_mov_b64 v[216:217], 0
v_mov_b64 v[218:219], 0
v_mov_b64 v[220:221], 0
v_mov_b64 v[222:223], 0
v_mov_b64 v[224:225], 0
v_mov_b64 v[226:227], 0
v_mov_b64 v[228:229], 0
v_mov_b64 v[230:231], 0
v_mov_b64 v[232:233], 0
v_mov_b64 v[234:235], 0
v_mov_b64 v[236:237], 0
v_mov_b64 v[238:239], 0
v_mov_b64 v[240:241], 0
v_mov_b64 v[242:243], 0
v_mov_b64 v[244:245], 0
v_mov_b64 v[246:247], 0
v_mov_b64 v[248:249], 0
v_mov_b64 v[250:251], 0
v_mov_b64 v[252:253], 0
v_mov_b64 v[254:255], 0
v_mov_b64 v[24:25], 0
s_waitcnt vmcnt(9) lgkmcnt(0)
v_cmp_gt_u32 vcc, 1, v21
s_cbranch_vccnz M_vspin
M_vok:
s_barrier
K2_item:
s_cmp_eq_u32 s19, 0
s_cbranch_scc1 K2_p0d
s_bitcmp0_b32 s84, 17
s_cbranch_scc1 K2_p0f
ds_read_b128 a[64:67], v4 offset:0
ds_read_b128 a[68:71], v4 offset:1024
ds_read_b128 a[72:75], v4 offset:2048
ds_read_b128 a[76:79], v4 offset:3072
ds_read_b128 a[80:83], v4 offset:4096
ds_read_b128 a[84:87], v4 offset:5120
ds_read_b128 a[88:91], v4 offset:6144
ds_read_b128 a[92:95], v4 offset:7168
s_waitcnt lgkmcnt(7)
v_mfma_f32_16x16x32_bf16 v[64:67], a[64:67], a[0:3], 0
s_waitcnt lgkmcnt(6)
s_add_u32 m0, s18, 98304
ds_read_b128 a[96:99], v4 offset:8192
v_mfma_f32_16x16x32_bf16 v[64:67], a[68:71], a[4:7], v[64:67]
s_waitcnt lgkmcnt(6)
buffer_load_dwordx4 v1, s[4:7], s12 offen offset:0 sc1 lds
v_mfma_f32_16x16x32_bf16 v[64:67], a[72:75], a[8:11], v[64:67]
s_waitcnt lgkmcnt(5)
ds_read_b128 a[100:103], v4 offset:9216
v_mfma_f32_16x16x32_bf16 v[64:67], a[76:79], a[12:15], v[64:67]
s_waitcnt lgkmcnt(5)
buffer_load_dwordx4 v1, s[4:7], s12 offen offset:1024 sc1 lds
v_mfma_f32_16x16x32_bf16 v[64:67], a[80:83], a[16:19], v[64:67]
s_waitcnt lgkmcnt(4)
ds_read_b128 a[104:107], v4 offset:10240
v_mfma_f32_16x16x32_bf16 v[64:67], a[84:87], a[20:23], v[64:67]
s_waitcnt lgkmcnt(4)
buffer_load_dwordx4 v1, s[4:7], s12 offen offset:2048 sc1 lds
v_mfma_f32_16x16x32_bf16 v[64:67], a[88:91], a[24:27], v[64:67]
s_waitcnt lgkmcnt(3)
ds_read_b128 a[108:111], v4 offset:11264
v_mfma_f32_16x16x32_bf16 v[64:67], a[92:95], a[28:31], v[64:67]
buffer_load_dwordx4 v1, s[4:7], s12 offen offset:3072 sc1 lds
v_mfma_f32_16x16x32_bf16 v[68:71], a[64:67], a[32:35], 0
s_add_u32 s12, s12, 4096
s_add_u32 m0, s18, 102400
ds_read_b128 a[112:115], v4 offset:12288
v_mfma_f32_16x16x32_bf16 v[68:71], a[68:71], a[36:39], v[68:71]
buffer_load_dwordx4 v1, s[4:7], s12 offen offset:0 sc1 lds
v_mfma_f32_16x16x32_bf16 v[68:71], a[72:75], a[40:43], v[68:71]
ds_read_b128 a[116:119], v4 offset:13312
v_mfma_f32_16x16x32_bf16 v[68:71], a[76:79], a[44:47], v[68:71]
buffer_load_dwordx4 v1, s[4:7], s12 offen offset:1024 sc1 lds
v_mfma_f32_16x16x32_bf16 v[68:71], a[80:83], a[48:51], v[68:71]
ds_read_b128 a[120:123], v4 offset:14336
v_max3_f32 v28, v64, v65, v66
v_mfma_f32_16x16x32_bf16 v[68:71], a[84:87], a[52:55], v[68:71]
buffer_load_dwordx4 v1, s[4:7], s12 offen offset:2048 sc1 lds
v_mfma_f32_16x16x32_bf16 v[68:71], a[88:91], a[56:59], v[68:71]
ds_read_b128 a[124:127], v4 offset:15360
v_max_f32 v28, v28, v67
v_mfma_f32_16x16x32_bf16 v[68:71], a[92:95], a[60:63], v[68:71]
s_waitcnt lgkmcnt(6)
buffer_load_dwordx4 v1, s[4:7], s12 offen offset:3072 sc1 lds
v_mfma_f32_16x16x32_bf16 v[72:75], a[96:99], a[0:3], 0
s_add_u32 s12, s12, 28672
ds_read_b128 a[64:67], v4 offset:16384
v_mov_b32 v30, v28
v_mfma_f32_16x16x32_bf16 v[72:75], a[100:103], a[4:7], v[72:75]
s_waitcnt lgkmcnt(2)
s_sub_u32 s13, s13, 1
v_mfma_f32_16x16x32_bf16 v[72:75], a[104:107], a[8:11], v[72:75]
s_cmp_eq_u32 s13, 0
ds_read_b128 a[68:71], v4 offset:17408
v_permlane16_swap_b32 v28, v30
v_mfma_f32_16x16x32_bf16 v[72:75], a[108:111], a[12:15], v[72:75]
s_cselect_b32 s12, s14, s12
v_max_f32 v28, v28, v30
v_mov_b32 v30, v28
v_mfma_f32_16x16x32_bf16 v[72:75], a[112:115], a[16:19], v[72:75]
s_cselect_b32 s13, s15, s13
ds_read_b128 a[72:75], v4 offset:18432
v_max3_f32 v29, v68, v69, v70
v_mfma_f32_16x16x32_bf16 v[72:75], a[116:119], a[20:23], v[72:75]
s_cselect_b32 s14, 3221225472, s14
v_permlane32_swap_b32 v28, v30
v_max_f32 v28, v28, v30
v_mfma_f32_16x16x32_bf16 v[72:75], a[120:123], a[24:27], v[72:75]
s_waitcnt lgkmcnt(3)
ds_read_b128 a[76:79], v4 offset:19456
v_sub_f32 v16, 0, v28
v_mfma_f32_16x16x32_bf16 v[72:75], a[124:127], a[28:31], v[72:75]
v_sub_f32 v17, 0, v28
v_sub_f32 v18, 0, v28
v_mfma_f32_16x16x32_bf16 v[76:79], a[96:99], a[32:35], 0
ds_read_b128 a[80:83], v4 offset:20480
v_sub_f32 v19, 0, v28
v_mfma_f32_16x16x32_bf16 v[76:79], a[100:103], a[36:39], v[76:79]
v_max_f32 v29, v29, v71
v_mov_b32 v31, v29
v_mfma_f32_16x16x32_bf16 v[76:79], a[104:107], a[40:43], v[76:79]
ds_read_b128 a[84:87], v4 offset:21504
v_mfma_f32_16x16x32_bf16 v[76:79], a[108:111], a[44:47], v[76:79]
v_permlane16_swap_b32 v29, v31
v_max_f32 v29, v29, v31
v_mfma_f32_16x16x32_bf16 v[76:79], a[112:115], a[48:51], v[76:79]
ds_read_b128 a[88:91], v4 offset:22528
v_mov_b32 v31, v29
v_mfma_f32_16x16x32_bf16 v[76:79], a[116:119], a[52:55], v[76:79]
v_mfma_f32_16x16x32_bf16 v[76:79], a[120:123], a[56:59], v[76:79]
ds_read_b128 a[92:95], v4 offset:23552
v_permlane32_swap_b32 v29, v31
v_mfma_f32_16x16x32_bf16 v[76:79], a[124:127], a[60:63], v[76:79]
s_waitcnt lgkmcnt(7)
v_max_f32 v29, v29, v31
v_sub_f32 v20, 0, v29
v_mfma_f32_16x16x32_bf16 v[80:83], a[64:67], a[0:3], v[16:19]
s_waitcnt lgkmcnt(6)
ds_read_b128 a[96:99], v4 offset:24576
v_sub_f32 v21, 0, v29
v_mfma_f32_16x16x32_bf16 v[80:83], a[68:71], a[4:7], v[80:83]
s_waitcnt lgkmcnt(6)
v_sub_f32 v22, 0, v29
v_sub_f32 v23, 0, v29
v_mfma_f32_16x16x32_bf16 v[80:83], a[72:75], a[8:11], v[80:83]
s_waitcnt lgkmcnt(5)
ds_read_b128 a[100:103], v4 offset:25600
v_mfma_f32_16x16x32_bf16 v[80:83], a[76:79], a[12:15], v[80:83]
s_waitcnt lgkmcnt(5)
v_mfma_f32_16x16x32_bf16 v[80:83], a[80:83], a[16:19], v[80:83]
s_waitcnt lgkmcnt(4)
ds_read_b128 a[104:107], v4 offset:26624
v_mfma_f32_16x16x32_bf16 v[80:83], a[84:87], a[20:23], v[80:83]
s_waitcnt lgkmcnt(4)
v_add_f32 v64, v64, v16
v_add_f32 v65, v65, v16
v_add_f32 v66, v66, v16
v_add_f32 v67, v67, v16
v_mfma_f32_16x16x32_bf16 v[80:83], a[88:91], a[24:27], v[80:83]
s_waitcnt lgkmcnt(3)
ds_read_b128 a[108:111], v4 offset:27648
v_add_f32 v68, v68, v20
v_add_f32 v69, v69, v20
v_add_f32 v70, v70, v20
v_add_f32 v71, v71, v20
v_mfma_f32_16x16x32_bf16 v[80:83], a[92:95], a[28:31], v[80:83]
v_add_f32 v72, v72, v16
v_add_f32 v73, v73, v16
v_add_f32 v74, v74, v16
v_add_f32 v75, v75, v16
v_mfma_f32_16x16x32_bf16 v[84:87], a[64:67], a[32:35], v[20:23]
ds_read_b128 a[112:115], v4 offset:28672
v_add_f32 v76, v76, v20
v_add_f32 v77, v77, v20
v_add_f32 v78, v78, v20
v_add_f32 v79, v79, v20
v_mfma_f32_16x16x32_bf16 v[84:87], a[68:71], a[36:39], v[84:87]
v_exp_f32 v8, v64
v_mfma_f32_16x16x32_bf16 v[84:87], a[72:75], a[40:43], v[84:87]
ds_read_b128 a[116:119], v4 offset:29696
v_exp_f32 v9, v65
v_mfma_f32_16x16x32_bf16 v[84:87], a[76:79], a[44:47], v[84:87]
v_exp_f32 v10, v66
v_mfma_f32_16x16x32_bf16 v[84:87], a[80:83], a[48:51], v[84:87]
ds_read_b128 a[120:123], v4 offset:30720
v_exp_f32 v11, v67
v_mfma_f32_16x16x32_bf16 v[84:87], a[84:87], a[52:55], v[84:87]
v_exp_f32 v12, v68
v_mfma_f32_16x16x32_bf16 v[84:87], a[88:91], a[56:59], v[84:87]
ds_read_b128 a[124:127], v4 offset:31744
v_exp_f32 v13, v69
v_mfma_f32_16x16x32_bf16 v[84:87], a[92:95], a[60:63], v[84:87]
s_waitcnt vmcnt(8) lgkmcnt(7)
s_barrier
v_add_f32 v26, v8, v9
v_cvt_pk_bf16_f32 v112, v8, v9
v_add_f32 v26, v26, v10
v_add_f32 v26, v26, v11
v_cvt_pk_bf16_f32 v113, v10, v11
v_add_f32 v27, v12, v13
v_cvt_pk_bf16_f32 v120, v12, v13
v_mfma_f32_16x16x32_bf16 v[88:91], a[96:99], a[0:3], v[16:19]
s_waitcnt lgkmcnt(6)
ds_read_b128 a[64:67], v1 offset:0
v_exp_f32 v14, v70
v_mfma_f32_16x16x32_bf16 v[88:91], a[100:103], a[4:7], v[88:91]
s_waitcnt lgkmcnt(6)
buffer_store_dword v6, v5, s[4:7], s71 offen sc1
v_add_f32 v27, v27, v14
v_mfma_f32_16x16x32_bf16 v[88:91], a[104:107], a[8:11], v[88:91]
s_waitcnt lgkmcnt(5)
ds_read_b128 a[68:71], v1 offset:1024
v_exp_f32 v15, v71
v_mfma_f32_16x16x32_bf16 v[88:91], a[108:111], a[12:15], v[88:91]
s_waitcnt lgkmcnt(5)
v_exp_f32 v8, v72
v_mfma_f32_16x16x32_bf16 v[88:91], a[112:115], a[16:19], v[88:91]
s_waitcnt lgkmcnt(4)
ds_read_b128 a[72:75], v1 offset:2048
v_exp_f32 v9, v73
v_mfma_f32_16x16x32_bf16 v[88:91], a[116:119], a[20:23], v[88:91]
s_waitcnt lgkmcnt(4)
v_exp_f32 v10, v74
v_mfma_f32_16x16x32_bf16 v[88:91], a[120:123], a[24:27], v[88:91]
s_waitcnt lgkmcnt(3)
ds_read_b128 a[76:79], v1 offset:3072
v_add_f32 v27, v27, v15
v_cvt_pk_bf16_f32 v121, v14, v15
v_add_f32 v26, v26, v8
v_add_f32 v26, v26, v9
v_cvt_pk_bf16_f32 v114, v8, v9
v_add_f32 v26, v26, v10
v_mfma_f32_16x16x32_bf16 v[88:91], a[124:127], a[28:31], v[88:91]
v_exp_f32 v11, v75
v_mfma_f32_16x16x32_bf16 v[92:95], a[96:99], a[32:35], v[20:23]
ds_read_b128 a[80:83], v1 offset:4096
v_exp_f32 v12, v76
v_mfma_f32_16x16x32_bf16 v[92:95], a[100:103], a[36:39], v[92:95]
v_exp_f32 v13, v77
v_mfma_f32_16x16x32_bf16 v[92:95], a[104:107], a[40:43], v[92:95]
ds_read_b128 a[84:87], v1 offset:5120
v_exp_f32 v14, v78
v_mfma_f32_16x16x32_bf16 v[92:95], a[108:111], a[44:47], v[92:95]
v_exp_f32 v15, v79
v_mfma_f32_16x16x32_bf16 v[92:95], a[112:115], a[48:51], v[92:95]
ds_read_b128 a[88:91], v1 offset:6144
v_add_f32 v26, v26, v11
v_cvt_pk_bf16_f32 v115, v10, v11
v_mfma_f32_16x16x32_bf16 v[92:95], a[116:119], a[52:55], v[92:95]
v_add_f32 v27, v27, v12
v_add_f32 v27, v27, v13
v_cvt_pk_bf16_f32 v122, v12, v13
v_mfma_f32_16x16x32_bf16 v[92:95], a[120:123], a[56:59], v[92:95]
s_waitcnt lgkmcnt(7)
s_barrier
ds_read_b128 a[92:95], v1 offset:7168
v_mfma_f32_16x16x32_bf16 v[92:95], a[124:127], a[60:63], v[92:95]
s_waitcnt lgkmcnt(7)
v_add_f32 v27, v27, v14
v_add_f32 v27, v27, v15
v_cvt_pk_bf16_f32 v123, v14, v15
s_branch K2_x0
K2_p0f:
ds_read_b128 a[64:67], v1 offset:0
ds_read_b128 a[68:71], v1 offset:1024
ds_read_b128 a[72:75], v1 offset:2048
ds_read_b128 a[76:79], v1 offset:3072
ds_read_b128 a[80:83], v1 offset:4096
ds_read_b128 a[84:87], v1 offset:5120
ds_read_b128 a[88:91], v1 offset:6144
ds_read_b128 a[92:95], v1 offset:7168
s_waitcnt lgkmcnt(7)
v_mfma_f32_16x16x32_bf16 v[32:35], a[64:67], a[0:3], 0
s_waitcnt lgkmcnt(6)
s_add_u32 m0, s18, 65536
ds_read_b128 a[96:99], v1 offset:8192
v_mfma_f32_16x16x32_bf16 v[32:35], a[68:71], a[4:7], v[32:35]
s_waitcnt lgkmcnt(6)
buffer_load_dwordx4 v1, s[4:7], s12 offen offset:0 sc1 lds
v_mfma_f32_16x16x32_bf16 v[32:35], a[72:75], a[8:11], v[32:35]
s_waitcnt lgkmcnt(5)
ds_read_b128 a[100:103], v1 offset:9216
v_mfma_f32_16x16x32_bf16 v[32:35], a[76:79], a[12:15], v[32:35]
s_waitcnt lgkmcnt(5)
buffer_load_dwordx4 v1, s[4:7], s12 offen offset:1024 sc1 lds
v_mfma_f32_16x16x32_bf16 v[32:35], a[80:83], a[16:19], v[32:35]
s_waitcnt lgkmcnt(4)
ds_read_b128 a[104:107], v1 offset:10240
v_mfma_f32_16x16x32_bf16 v[32:35], a[84:87], a[20:23], v[32:35]
s_waitcnt lgkmcnt(4)
buffer_load_dwordx4 v1, s[4:7], s12 offen offset:2048 sc1 lds
v_mfma_f32_16x16x32_bf16 v[32:35], a[88:91], a[24:27], v[32:35]
s_waitcnt lgkmcnt(3)
ds_read_b128 a[108:111], v1 offset:11264
v_mfma_f32_16x16x32_bf16 v[32:35], a[92:95], a[28:31], v[32:35]
buffer_load_dwordx4 v1, s[4:7], s12 offen offset:3072 sc1 lds
v_mfma_f32_16x16x32_bf16 v[36:39], a[64:67], a[32:35], 0
s_add_u32 s12, s12, 4096
s_add_u32 m0, s18, 69632
ds_read_b128 a[112:115], v1 offset:12288
v_mfma_f32_16x16x32_bf16 v[36:39], a[68:71], a[36:39], v[36:39]
buffer_load_dwordx4 v1, s[4:7], s12 offen offset:0 sc1 lds
v_mfma_f32_16x16x32_bf16 v[36:39], a[72:75], a[40:43], v[36:39]
ds_read_b128 a[116:119], v1 offset:13312
v_mfma_f32_16x16x32_bf16 v[36:39], a[76:79], a[44:47], v[36:39]
buffer_load_dwordx4 v1, s[4:7], s12 offen offset:1024 sc1 lds
v_mfma_f32_16x16x32_bf16 v[36:39], a[80:83], a[48:51], v[36:39]
ds_read_b128 a[120:123], v1 offset:14336
v_max3_f32 v28, v32, v33, v34
v_mfma_f32_16x16x32_bf16 v[36:39], a[84:87], a[52:55], v[36:39]
buffer_load_dwordx4 v1, s[4:7], s12 offen offset:2048 sc1 lds
v_mfma_f32_16x16x32_bf16 v[36:39], a[88:91], a[56:59], v[36:39]
ds_read_b128 a[124:127], v1 offset:15360
v_max_f32 v28, v28, v35
v_mfma_f32_16x16x32_bf16 v[36:39], a[92:95], a[60:63], v[36:39]
s_waitcnt lgkmcnt(6)
buffer_load_dwordx4 v1, s[4:7], s12 offen offset:3072 sc1 lds
v_mfma_f32_16x16x32_bf16 v[40:43], a[96:99], a[0:3], 0
s_add_u32 s12, s12, 28672
ds_read_b128 a[64:67], v1 offset:16384
v_mov_b32 v30, v28
v_mfma_f32_16x16x32_bf16 v[40:43], a[100:103], a[4:7], v[40:43]
s_waitcnt lgkmcnt(2)
s_sub_u32 s13, s13, 1
v_mfma_f32_16x16x32_bf16 v[40:43], a[104:107], a[8:11], v[40:43]
s_cmp_eq_u32 s13, 0
ds_read_b128 a[68:71], v1 offset:17408
v_permlane16_swap_b32 v28, v30
v_mfma_f32_16x16x32_bf16 v[40:43], a[108:111], a[12:15], v[40:43]
s_cselect_b32 s12, s14, s12
v_max_f32 v28, v28, v30
v_mov_b32 v30, v28
v_mfma_f32_16x16x32_bf16 v[40:43], a[112:115], a[16:19], v[40:43]
s_cselect_b32 s13, s15, s13
ds_read_b128 a[72:75], v1 offset:18432
v_max3_f32 v29, v36, v37, v38
v_mfma_f32_16x16x32_bf16 v[40:43], a[116:119], a[20:23], v[40:43]
s_cselect_b32 s14, 3221225472, s14
v_permlane32_swap_b32 v28, v30
v_max_f32 v28, v28, v30
v_mfma_f32_16x16x32_bf16 v[40:43], a[120:123], a[24:27], v[40:43]
s_waitcnt lgkmcnt(3)
ds_read_b128 a[76:79], v1 offset:19456
v_sub_f32 v16, 0, v28
v_mfma_f32_16x16x32_bf16 v[40:43], a[124:127], a[28:31], v[40:43]
v_sub_f32 v17, 0, v28
v_sub_f32 v18, 0, v28
v_mfma_f32_16x16x32_bf16 v[44:47], a[96:99], a[32:35], 0
ds_read_b128 a[80:83], v1 offset:20480
v_sub_f32 v19, 0, v28
v_mfma_f32_16x16x32_bf16 v[44:47], a[100:103], a[36:39], v[44:47]
v_max_f32 v29, v29, v39
v_mov_b32 v31, v29
v_mfma_f32_16x16x32_bf16 v[44:47], a[104:107], a[40:43], v[44:47]
ds_read_b128 a[84:87], v1 offset:21504
v_mfma_f32_16x16x32_bf16 v[44:47], a[108:111], a[44:47], v[44:47]
v_permlane16_swap_b32 v29, v31
v_max_f32 v29, v29, v31
v_mfma_f32_16x16x32_bf16 v[44:47], a[112:115], a[48:51], v[44:47]
ds_read_b128 a[88:91], v1 offset:22528
v_mov_b32 v31, v29
v_mfma_f32_16x16x32_bf16 v[44:47], a[116:119], a[52:55], v[44:47]
v_mfma_f32_16x16x32_bf16 v[44:47], a[120:123], a[56:59], v[44:47]
ds_read_b128 a[92:95], v1 offset:23552
v_permlane32_swap_b32 v29, v31
v_mfma_f32_16x16x32_bf16 v[44:47], a[124:127], a[60:63], v[44:47]
s_waitcnt lgkmcnt(7)
v_max_f32 v29, v29, v31
v_sub_f32 v20, 0, v29
v_mfma_f32_16x16x32_bf16 v[48:51], a[64:67], a[0:3], v[16:19]
s_waitcnt lgkmcnt(6)
ds_read_b128 a[96:99], v1 offset:24576
v_sub_f32 v21, 0, v29
v_mfma_f32_16x16x32_bf16 v[48:51], a[68:71], a[4:7], v[48:51]
s_waitcnt lgkmcnt(6)
v_sub_f32 v22, 0, v29
v_sub_f32 v23, 0, v29
v_mfma_f32_16x16x32_bf16 v[48:51], a[72:75], a[8:11], v[48:51]
s_waitcnt lgkmcnt(5)
ds_read_b128 a[100:103], v1 offset:25600
v_mfma_f32_16x16x32_bf16 v[48:51], a[76:79], a[12:15], v[48:51]
s_waitcnt lgkmcnt(5)
v_mfma_f32_16x16x32_bf16 v[48:51], a[80:83], a[16:19], v[48:51]
s_waitcnt lgkmcnt(4)
ds_read_b128 a[104:107], v1 offset:26624
v_mfma_f32_16x16x32_bf16 v[48:51], a[84:87], a[20:23], v[48:51]
s_waitcnt lgkmcnt(4)
v_add_f32 v32, v32, v16
v_add_f32 v33, v33, v16
v_add_f32 v34, v34, v16
v_add_f32 v35, v35, v16
v_mfma_f32_16x16x32_bf16 v[48:51], a[88:91], a[24:27], v[48:51]
s_waitcnt lgkmcnt(3)
ds_read_b128 a[108:111], v1 offset:27648
v_add_f32 v36, v36, v20
v_add_f32 v37, v37, v20
v_add_f32 v38, v38, v20
v_add_f32 v39, v39, v20
v_mfma_f32_16x16x32_bf16 v[48:51], a[92:95], a[28:31], v[48:51]
v_add_f32 v40, v40, v16
v_add_f32 v41, v41, v16
v_add_f32 v42, v42, v16
v_add_f32 v43, v43, v16
v_mfma_f32_16x16x32_bf16 v[52:55], a[64:67], a[32:35], v[20:23]
ds_read_b128 a[112:115], v1 offset:28672
v_add_f32 v44, v44, v20
v_add_f32 v45, v45, v20
v_add_f32 v46, v46, v20
v_add_f32 v47, v47, v20
v_mfma_f32_16x16x32_bf16 v[52:55], a[68:71], a[36:39], v[52:55]
v_exp_f32 v8, v32
v_mfma_f32_16x16x32_bf16 v[52:55], a[72:75], a[40:43], v[52:55]
ds_read_b128 a[116:119], v1 offset:29696
v_exp_f32 v9, v33
v_mfma_f32_16x16x32_bf16 v[52:55], a[76:79], a[44:47], v[52:55]
v_exp_f32 v10, v34
v_mfma_f32_16x16x32_bf16 v[52:55], a[80:83], a[48:51], v[52:55]
ds_read_b128 a[120:123], v1 offset:30720
v_exp_f32 v11, v35
v_mfma_f32_16x16x32_bf16 v[52:55], a[84:87], a[52:55], v[52:55]
v_exp_f32 v12, v36
v_mfma_f32_16x16x32_bf16 v[52:55], a[88:91], a[56:59], v[52:55]
ds_read_b128 a[124:127], v1 offset:31744
v_exp_f32 v13, v37
v_mfma_f32_16x16x32_bf16 v[52:55], a[92:95], a[60:63], v[52:55]
s_waitcnt vmcnt(8) lgkmcnt(7)
s_barrier
v_add_f32 v26, v8, v9
v_cvt_pk_bf16_f32 v96, v8, v9
v_add_f32 v26, v26, v10
v_add_f32 v26, v26, v11
v_cvt_pk_bf16_f32 v97, v10, v11
v_add_f32 v27, v12, v13
v_cvt_pk_bf16_f32 v104, v12, v13
v_mfma_f32_16x16x32_bf16 v[56:59], a[96:99], a[0:3], v[16:19]
s_waitcnt lgkmcnt(6)
ds_read_b128 a[64:67], v4 offset:0
v_exp_f32 v14, v38
v_mfma_f32_16x16x32_bf16 v[56:59], a[100:103], a[4:7], v[56:59]
s_waitcnt lgkmcnt(6)
buffer_store_dword v6, v5, s[4:7], s71 offen sc1
v_add_f32 v27, v27, v14
v_mfma_f32_16x16x32_bf16 v[56:59], a[104:107], a[8:11], v[56:59]
s_waitcnt lgkmcnt(5)
ds_read_b128 a[68:71], v4 offset:1024
v_exp_f32 v15, v39
v_mfma_f32_16x16x32_bf16 v[56:59], a[108:111], a[12:15], v[56:59]
s_waitcnt lgkmcnt(5)
v_exp_f32 v8, v40
v_mfma_f32_16x16x32_bf16 v[56:59], a[112:115], a[16:19], v[56:59]
s_waitcnt lgkmcnt(4)
ds_read_b128 a[72:75], v4 offset:2048
v_exp_f32 v9, v41
v_mfma_f32_16x16x32_bf16 v[56:59], a[116:119], a[20:23], v[56:59]
s_waitcnt lgkmcnt(4)
v_exp_f32 v10, v42
v_mfma_f32_16x16x32_bf16 v[56:59], a[120:123], a[24:27], v[56:59]
s_waitcnt lgkmcnt(3)
ds_read_b128 a[76:79], v4 offset:3072
v_add_f32 v27, v27, v15
v_cvt_pk_bf16_f32 v105, v14, v15
v_add_f32 v26, v26, v8
v_add_f32 v26, v26, v9
v_cvt_pk_bf16_f32 v98, v8, v9
v_add_f32 v26, v26, v10
v_mfma_f32_16x16x32_bf16 v[56:59], a[124:127], a[28:31], v[56:59]
v_exp_f32 v11, v43
v_mfma_f32_16x16x32_bf16 v[60:63], a[96:99], a[32:35], v[20:23]
ds_read_b128 a[80:83], v4 offset:4096
v_exp_f32 v12, v44
v_mfma_f32_16x16x32_bf16 v[60:63], a[100:103], a[36:39], v[60:63]
v_exp_f32 v13, v45
v_mfma_f32_16x16x32_bf16 v[60:63], a[104:107], a[40:43], v[60:63]
ds_read_b128 a[84:87], v4 offset:5120
v_exp_f32 v14, v46
v_mfma_f32_16x16x32_bf16 v[60:63], a[108:111], a[44:47], v[60:63]
v_exp_f32 v15, v47
v_mfma_f32_16x16x32_bf16 v[60:63], a[112:115], a[48:51], v[60:63]
ds_read_b128 a[88:91], v4 offset:6144
v_add_f32 v26, v26, v11
v_cvt_pk_bf16_f32 v99, v10, v11
v_mfma_f32_16x16x32_bf16 v[60:63], a[116:119], a[52:55], v[60:63]
v_add_f32 v27, v27, v12
v_add_f32 v27, v27, v13
v_cvt_pk_bf16_f32 v106, v12, v13
v_mfma_f32_16x16x32_bf16 v[60:63], a[120:123], a[56:59], v[60:63]
s_waitcnt lgkmcnt(7)
s_barrier
ds_read_b128 a[92:95], v4 offset:7168
v_mfma_f32_16x16x32_bf16 v[60:63], a[124:127], a[60:63], v[60:63]
s_waitcnt lgkmcnt(7)
v_add_f32 v27, v27, v14
v_add_f32 v27, v27, v15
v_cvt_pk_bf16_f32 v107, v14, v15
s_branch K2_x1
.p2align 6
K2_loop:
v_mfma_f32_16x16x32_bf16 v[128:131], a[64:67], v[96:99], v[128:131]
s_add_u32 m0, s18, 98304
ds_read_b128 a[96:99], v2 offset:8192
v_add_f32 v24, v24, v26
v_mfma_f32_16x16x32_bf16 v[128:131], a[68:71], v[100:103], v[128:131]
buffer_load_dwordx4 v1, s[4:7], s12 offen offset:0 sc1 lds
v_mfma_f32_16x16x32_bf16 v[132:135], a[68:71], v[108:111], v[132:135]
ds_read_b128 a[100:103], v2 offset:9216
v_add_f32 v25, v25, v27
v_mfma_f32_16x16x32_bf16 v[132:135], a[64:67], v[104:107], v[132:135]
s_waitcnt lgkmcnt(7)
v_exp_f32 v8, v64
v_mfma_f32_16x16x32_bf16 v[136:139], a[72:75], v[96:99], v[136:139]
s_waitcnt lgkmcnt(6)
ds_read_b128 a[104:107], v2 offset:10240
v_mfma_f32_16x16x32_bf16 v[136:139], a[76:79], v[100:103], v[136:139]
buffer_load_dwordx4 v1, s[4:7], s12 offen offset:1024 sc1 lds
v_mfma_f32_16x16x32_bf16 v[140:143], a[76:79], v[108:111], v[140:143]
ds_read_b128 a[108:111], v2 offset:11264
v_mfma_f32_16x16x32_bf16 v[140:143], a[72:75], v[104:107], v[140:143]
s_waitcnt lgkmcnt(7)
v_exp_f32 v9, v65
v_mfma_f32_16x16x32_bf16 v[144:147], a[80:83], v[96:99], v[144:147]
s_waitcnt lgkmcnt(6)
ds_read_b128 a[112:115], v2 offset:12288
v_add_f32 v26, v8, v9
v_mfma_f32_16x16x32_bf16 v[144:147], a[84:87], v[100:103], v[144:147]
buffer_load_dwordx4 v1, s[4:7], s12 offen offset:2048 sc1 lds
v_mfma_f32_16x16x32_bf16 v[148:151], a[84:87], v[108:111], v[148:151]
ds_read_b128 a[116:119], v2 offset:13312
v_cvt_pk_bf16_f32 v112, v8, v9
v_mfma_f32_16x16x32_bf16 v[148:151], a[80:83], v[104:107], v[148:151]
s_waitcnt lgkmcnt(7)
v_exp_f32 v10, v66
v_mfma_f32_16x16x32_bf16 v[152:155], a[88:91], v[96:99], v[152:155]
s_waitcnt lgkmcnt(6)
ds_read_b128 a[120:123], v2 offset:14336
v_add_f32 v26, v26, v10
v_mfma_f32_16x16x32_bf16 v[152:155], a[92:95], v[100:103], v[152:155]
buffer_load_dwordx4 v1, s[4:7], s12 offen offset:3072 sc1 lds
v_mfma_f32_16x16x32_bf16 v[156:159], a[92:95], v[108:111], v[156:159]
s_add_u32 s12, s12, 4096
ds_read_b128 a[124:127], v2 offset:15360
v_mfma_f32_16x16x32_bf16 v[156:159], a[88:91], v[104:107], v[156:159]
s_waitcnt lgkmcnt(6)
v_exp_f32 v11, v67
v_mfma_f32_16x16x32_bf16 v[160:163], a[96:99], v[96:99], v[160:163]
s_add_u32 m0, s18, 102400
ds_read_b128 a[64:67], v2 offset:16384
v_add_f32 v26, v26, v11
v_mfma_f32_16x16x32_bf16 v[160:163], a[100:103], v[100:103], v[160:163]
buffer_load_dwordx4 v1, s[4:7], s12 offen offset:0 sc1 lds
v_mfma_f32_16x16x32_bf16 v[164:167], a[100:103], v[108:111], v[164:167]
ds_read_b128 a[68:71], v2 offset:17408
v_cvt_pk_bf16_f32 v113, v10, v11
v_mfma_f32_16x16x32_bf16 v[164:167], a[96:99], v[104:107], v[164:167]
s_waitcnt lgkmcnt(7)
v_mfma_f32_16x16x32_bf16 v[168:171], a[104:107], v[96:99], v[168:171]
s_waitcnt lgkmcnt(6)
ds_read_b128 a[72:75], v2 offset:18432
v_mfma_f32_16x16x32_bf16 v[168:171], a[108:111], v[100:103], v[168:171]
buffer_load_dwordx4 v1, s[4:7], s12 offen offset:1024 sc1 lds
v_mfma_f32_16x16x32_bf16 v[172:175], a[108:111], v[108:111], v[172:175]
ds_read_b128 a[76:79], v2 offset:19456
v_mfma_f32_16x16x32_bf16 v[172:175], a[104:107], v[104:107], v[172:175]
s_waitcnt lgkmcnt(7)
v_exp_f32 v12, v68
v_mfma_f32_16x16x32_bf16 v[176:179], a[112:115], v[96:99], v[176:179]
s_waitcnt lgkmcnt(6)
ds_read_b128 a[80:83], v2 offset:20480
v_mfma_f32_16x16x32_bf16 v[176:179], a[116:119], v[100:103], v[176:179]
buffer_load_dwordx4 v1, s[4:7], s12 offen offset:2048 sc1 lds
v_mfma_f32_16x16x32_bf16 v[180:183], a[116:119], v[108:111], v[180:183]
ds_read_b128 a[84:87], v2 offset:21504
v_mfma_f32_16x16x32_bf16 v[180:183], a[112:115], v[104:107], v[180:183]
s_waitcnt lgkmcnt(7)
v_exp_f32 v13, v69
v_mfma_f32_16x16x32_bf16 v[184:187], a[120:123], v[96:99], v[184:187]
s_waitcnt lgkmcnt(6)
ds_read_b128 a[88:91], v2 offset:22528
v_add_f32 v27, v12, v13
v_mfma_f32_16x16x32_bf16 v[184:187], a[124:127], v[100:103], v[184:187]
s_waitcnt lgkmcnt(5)
buffer_load_dwordx4 v1, s[4:7], s12 offen offset:3072 sc1 lds
v_mfma_f32_16x16x32_bf16 v[188:191], a[124:127], v[108:111], v[188:191]
s_add_u32 s12, s12, 28672
ds_read_b128 a[92:95], v2 offset:23552
v_cvt_pk_bf16_f32 v120, v12, v13
v_mfma_f32_16x16x32_bf16 v[188:191], a[120:123], v[104:107], v[188:191]
s_sub_u32 s13, s13, 1
v_exp_f32 v14, v70
v_mfma_f32_16x16x32_bf16 v[192:195], a[64:67], v[96:99], v[192:195]
s_cmp_eq_u32 s13, 0
ds_read_b128 a[96:99], v2 offset:24576
v_add_f32 v27, v27, v14
v_mfma_f32_16x16x32_bf16 v[192:195], a[68:71], v[100:103], v[192:195]
s_cselect_b32 s12, s14, s12
v_mfma_f32_16x16x32_bf16 v[196:199], a[68:71], v[108:111], v[196:199]
s_waitcnt lgkmcnt(6)
s_cselect_b32 s13, s15, s13
ds_read_b128 a[100:103], v2 offset:25600
v_mfma_f32_16x16x32_bf16 v[196:199], a[64:67], v[104:107], v[196:199]
s_cselect_b32 s14, 3221225472, s14
v_exp_f32 v15, v71
v_mfma_f32_16x16x32_bf16 v[200:203], a[72:75], v[96:99], v[200:203]
s_waitcnt lgkmcnt(6)
ds_read_b128 a[104:107], v2 offset:26624
v_add_f32 v27, v27, v15
v_mfma_f32_16x16x32_bf16 v[200:203], a[76:79], v[100:103], v[200:203]
v_exp_f32 v8, v72
v_mfma_f32_16x16x32_bf16 v[204:207], a[76:79], v[108:111], v[204:207]
ds_read_b128 a[108:111], v2 offset:27648
v_cvt_pk_bf16_f32 v121, v14, v15
v_mfma_f32_16x16x32_bf16 v[204:207], a[72:75], v[104:107], v[204:207]
s_waitcnt lgkmcnt(7)
v_exp_f32 v9, v73
v_mfma_f32_16x16x32_bf16 v[208:211], a[80:83], v[96:99], v[208:211]
s_waitcnt lgkmcnt(6)
ds_read_b128 a[112:115], v2 offset:28672
v_add_f32 v26, v26, v8
v_mfma_f32_16x16x32_bf16 v[208:211], a[84:87], v[100:103], v[208:211]
v_add_f32 v26, v26, v9
v_cvt_pk_bf16_f32 v114, v8, v9
v_mfma_f32_16x16x32_bf16 v[212:215], a[84:87], v[108:111], v[212:215]
ds_read_b128 a[116:119], v2 offset:29696
v_mfma_f32_16x16x32_bf16 v[212:215], a[80:83], v[104:107], v[212:215]
s_waitcnt lgkmcnt(7)
v_exp_f32 v10, v74
v_mfma_f32_16x16x32_bf16 v[216:219], a[88:91], v[96:99], v[216:219]
s_waitcnt lgkmcnt(6)
ds_read_b128 a[120:123], v2 offset:30720
v_add_f32 v26, v26, v10
v_mfma_f32_16x16x32_bf16 v[216:219], a[92:95], v[100:103], v[216:219]
v_exp_f32 v11, v75
v_mfma_f32_16x16x32_bf16 v[220:223], a[92:95], v[108:111], v[220:223]
ds_read_b128 a[124:127], v2 offset:31744
v_add_f32 v26, v26, v11
v_mfma_f32_16x16x32_bf16 v[220:223], a[88:91], v[104:107], v[220:223]
s_waitcnt vmcnt(8) lgkmcnt(7)
s_barrier
v_cvt_pk_bf16_f32 v115, v10, v11
v_mfma_f32_16x16x32_bf16 v[224:227], a[96:99], v[96:99], v[224:227]
s_waitcnt lgkmcnt(6)
ds_read_b128 a[64:67], v1 offset:0
v_mfma_f32_16x16x32_bf16 v[224:227], a[100:103], v[100:103], v[224:227]
v_exp_f32 v12, v76
v_mfma_f32_16x16x32_bf16 v[228:231], a[100:103], v[108:111], v[228:231]
ds_read_b128 a[68:71], v1 offset:1024
v_add_f32 v27, v27, v12
v_mfma_f32_16x16x32_bf16 v[228:231], a[96:99], v[104:107], v[228:231]
s_waitcnt lgkmcnt(7)
v_mfma_f32_16x16x32_bf16 v[232:235], a[104:107], v[96:99], v[232:235]
s_waitcnt lgkmcnt(6)
ds_read_b128 a[72:75], v1 offset:2048
v_mfma_f32_16x16x32_bf16 v[232:235], a[108:111], v[100:103], v[232:235]
v_exp_f32 v13, v77
v_mfma_f32_16x16x32_bf16 v[236:239], a[108:111], v[108:111], v[236:239]
ds_read_b128 a[76:79], v1 offset:3072
v_add_f32 v27, v27, v13
v_mfma_f32_16x16x32_bf16 v[236:239], a[104:107], v[104:107], v[236:239]
s_waitcnt lgkmcnt(7)
v_exp_f32 v14, v78
v_mfma_f32_16x16x32_bf16 v[240:243], a[112:115], v[96:99], v[240:243]
s_waitcnt lgkmcnt(6)
ds_read_b128 a[80:83], v1 offset:4096
v_cvt_pk_bf16_f32 v122, v12, v13
v_mfma_f32_16x16x32_bf16 v[240:243], a[116:119], v[100:103], v[240:243]
v_exp_f32 v15, v79
v_mfma_f32_16x16x32_bf16 v[244:247], a[116:119], v[108:111], v[244:247]
ds_read_b128 a[84:87], v1 offset:5120
v_add_f32 v27, v27, v14
v_mfma_f32_16x16x32_bf16 v[244:247], a[112:115], v[104:107], v[244:247]
s_waitcnt lgkmcnt(7)
v_add_f32 v27, v27, v15
v_cvt_pk_bf16_f32 v123, v14, v15
v_mfma_f32_16x16x32_bf16 v[248:251], a[120:123], v[96:99], v[248:251]
s_waitcnt lgkmcnt(6)
ds_read_b128 a[88:91], v1 offset:6144
v_mfma_f32_16x16x32_bf16 v[248:251], a[124:127], v[100:103], v[248:251]
v_mfma_f32_16x16x32_bf16 v[252:255], a[124:127], v[108:111], v[252:255]
ds_read_b128 a[92:95], v1 offset:7168
v_mfma_f32_16x16x32_bf16 v[252:255], a[120:123], v[104:107], v[252:255]
s_waitcnt lgkmcnt(7)
K2_x0:
v_mfma_f32_16x16x32_bf16 v[32:35], a[64:67], a[0:3], v[16:19]
s_waitcnt lgkmcnt(6)
s_add_u32 m0, s18, 131072
ds_read_b128 a[96:99], v1 offset:8192
v_mfma_f32_16x16x32_bf16 v[32:35], a[68:71], a[4:7], v[32:35]
s_waitcnt lgkmcnt(6)
buffer_load_dwordx4 v1, s[4:7], s8 offen offset:0 sc1 lds
v_mfma_f32_16x16x32_bf16 v[32:35], a[72:75], a[8:11], v[32:35]
s_waitcnt lgkmcnt(5)
ds_read_b128 a[100:103], v1 offset:9216
v_mfma_f32_16x16x32_bf16 v[32:35], a[76:79], a[12:15], v[32:35]
s_waitcnt lgkmcnt(5)
v_exp_f32 v8, v80
v_mfma_f32_16x16x32_bf16 v[32:35], a[80:83], a[16:19], v[32:35]
s_waitcnt lgkmcnt(4)
ds_read_b128 a[104:107], v1 offset:10240
v_add_f32 v26, v26, v8
v_mfma_f32_16x16x32_bf16 v[32:35], a[84:87], a[20:23], v[32:35]
s_waitcnt lgkmcnt(4)
buffer_load_dwordx4 v1, s[4:7], s8 offen offset:1024 sc1 lds
v_mfma_f32_16x16x32_bf16 v[32:35], a[88:91], a[24:27], v[32:35]
s_waitcnt lgkmcnt(3)
ds_read_b128 a[108:111], v1 offset:11264
v_mfma_f32_16x16x32_bf16 v[32:35], a[92:95], a[28:31], v[32:35]
v_exp_f32 v9, v81
v_mfma_f32_16x16x32_bf16 v[36:39], a[64:67], a[32:35], v[20:23]
ds_read_b128 a[112:115], v1 offset:12288
v_add_f32 v26, v26, v9
v_mfma_f32_16x16x32_bf16 v[36:39], a[68:71], a[36:39], v[36:39]
buffer_load_dwordx4 v1, s[4:7], s8 offen offset:2048 sc1 lds
v_mfma_f32_16x16x32_bf16 v[36:39], a[72:75], a[40:43], v[36:39]
ds_read_b128 a[116:119], v1 offset:13312
v_cvt_pk_bf16_f32 v116, v8, v9
v_mfma_f32_16x16x32_bf16 v[36:39], a[76:79], a[44:47], v[36:39]
v_exp_f32 v10, v82
v_mfma_f32_16x16x32_bf16 v[36:39], a[80:83], a[48:51], v[36:39]
ds_read_b128 a[120:123], v1 offset:14336
v_add_f32 v26, v26, v10
v_mfma_f32_16x16x32_bf16 v[36:39], a[84:87], a[52:55], v[36:39]
buffer_load_dwordx4 v1, s[4:7], s8 offen offset:3072 sc1 lds
v_mfma_f32_16x16x32_bf16 v[36:39], a[88:91], a[56:59], v[36:39]
s_add_u32 s8, s8, 4096
ds_read_b128 a[124:127], v1 offset:15360
v_mfma_f32_16x16x32_bf16 v[36:39], a[92:95], a[60:63], v[36:39]
s_waitcnt lgkmcnt(6)
v_exp_f32 v11, v83
v_mfma_f32_16x16x32_bf16 v[40:43], a[96:99], a[0:3], v[16:19]
s_add_u32 m0, s18, 135168
ds_read_b128 a[64:67], v1 offset:16384
v_add_f32 v26, v26, v11
v_mfma_f32_16x16x32_bf16 v[40:43], a[100:103], a[4:7], v[40:43]
s_waitcnt lgkmcnt(6)
buffer_load_dwordx4 v1, s[4:7], s8 offen offset:0 sc1 lds
v_mfma_f32_16x16x32_bf16 v[40:43], a[104:107], a[8:11], v[40:43]
s_waitcnt lgkmcnt(5)
ds_read_b128 a[68:71], v1 offset:17408
v_cvt_pk_bf16_f32 v117, v10, v11
v_mfma_f32_16x16x32_bf16 v[40:43], a[108:111], a[12:15], v[40:43]
s_waitcnt lgkmcnt(5)
v_mfma_f32_16x16x32_bf16 v[40:43], a[112:115], a[16:19], v[40:43]
s_waitcnt lgkmcnt(4)
ds_read_b128 a[72:75], v1 offset:18432
v_mfma_f32_16x16x32_bf16 v[40:43], a[116:119], a[20:23], v[40:43]
s_waitcnt lgkmcnt(4)
buffer_load_dwordx4 v1, s[4:7], s8 offen offset:1024 sc1 lds
v_mfma_f32_16x16x32_bf16 v[40:43], a[120:123], a[24:27], v[40:43]
s_waitcnt lgkmcnt(3)
ds_read_b128 a[76:79], v1 offset:19456
v_mfma_f32_16x16x32_bf16 v[40:43], a[124:127], a[28:31], v[40:43]
v_exp_f32 v12, v84
v_mfma_f32_16x16x32_bf16 v[44:47], a[96:99], a[32:35], v[20:23]
ds_read_b128 a[80:83], v1 offset:20480
v_add_f32 v27, v27, v12
v_mfma_f32_16x16x32_bf16 v[44:47], a[100:103], a[36:39], v[44:47]
buffer_load_dwordx4 v1, s[4:7], s8 offen offset:2048 sc1 lds
v_mfma_f32_16x16x32_bf16 v[44:47], a[104:107], a[40:43], v[44:47]
ds_read_b128 a[84:87], v1 offset:21504
v_mfma_f32_16x16x32_bf16 v[44:47], a[108:111], a[44:47], v[44:47]
v_exp_f32 v13, v85
v_mfma_f32_16x16x32_bf16 v[44:47], a[112:115], a[48:51], v[44:47]
ds_read_b128 a[88:91], v1 offset:22528
v_add_f32 v27, v27, v13
v_mfma_f32_16x16x32_bf16 v[44:47], a[116:119], a[52:55], v[44:47]
s_waitcnt lgkmcnt(3)
buffer_load_dwordx4 v1, s[4:7], s8 offen offset:3072 sc1 lds
v_mfma_f32_16x16x32_bf16 v[44:47], a[120:123], a[56:59], v[44:47]
s_add_u32 s8, s8, 28672
ds_read_b128 a[92:95], v1 offset:23552
v_cvt_pk_bf16_f32 v124, v12, v13
v_mfma_f32_16x16x32_bf16 v[44:47], a[124:127], a[60:63], v[44:47]
s_sub_u32 s9, s9, 1
v_exp_f32 v14, v86
v_mfma_f32_16x16x32_bf16 v[48:51], a[64:67], a[0:3], v[16:19]
s_cmp_eq_u32 s9, 0
ds_read_b128 a[96:99], v1 offset:24576
v_add_f32 v27, v27, v14
v_mfma_f32_16x16x32_bf16 v[48:51], a[68:71], a[4:7], v[48:51]
s_cselect_b32 s8, s10, s8
v_exp_f32 v15, v87
v_mfma_f32_16x16x32_bf16 v[48:51], a[72:75], a[8:11], v[48:51]
s_cselect_b32 s9, s11, s9
ds_read_b128 a[100:103], v1 offset:25600
v_add_f32 v27, v27, v15
v_mfma_f32_16x16x32_bf16 v[48:51], a[76:79], a[12:15], v[48:51]
s_waitcnt lgkmcnt(5)
s_cselect_b32 s10, 3221225472, s10
v_cvt_pk_bf16_f32 v125, v14, v15
v_mfma_f32_16x16x32_bf16 v[48:51], a[80:83], a[16:19], v[48:51]
s_waitcnt lgkmcnt(4)
ds_read_b128 a[104:107], v1 offset:26624
v_mfma_f32_16x16x32_bf16 v[48:51], a[84:87], a[20:23], v[48:51]
s_waitcnt lgkmcnt(4)
v_exp_f32 v8, v88
v_mfma_f32_16x16x32_bf16 v[48:51], a[88:91], a[24:27], v[48:51]
s_waitcnt lgkmcnt(3)
ds_read_b128 a[108:111], v1 offset:27648
v_add_f32 v26, v26, v8
v_mfma_f32_16x16x32_bf16 v[48:51], a[92:95], a[28:31], v[48:51]
v_exp_f32 v9, v89
v_mfma_f32_16x16x32_bf16 v[52:55], a[64:67], a[32:35], v[20:23]
ds_read_b128 a[112:115], v1 offset:28672
v_add_f32 v26, v26, v9
v_mfma_f32_16x16x32_bf16 v[52:55], a[68:71], a[36:39], v[52:55]
v_exp_f32 v10, v90
v_mfma_f32_16x16x32_bf16 v[52:55], a[72:75], a[40:43], v[52:55]
ds_read_b128 a[116:119], v1 offset:29696
v_cvt_pk_bf16_f32 v118, v8, v9
v_mfma_f32_16x16x32_bf16 v[52:55], a[76:79], a[44:47], v[52:55]
v_exp_f32 v11, v91
v_mfma_f32_16x16x32_bf16 v[52:55], a[80:83], a[48:51], v[52:55]
ds_read_b128 a[120:123], v1 offset:30720
v_add_f32 v26, v26, v10
v_mfma_f32_16x16x32_bf16 v[52:55], a[84:87], a[52:55], v[52:55]
v_add_f32 v26, v26, v11
v_cvt_pk_bf16_f32 v119, v10, v11
v_mfma_f32_16x16x32_bf16 v[52:55], a[88:91], a[56:59], v[52:55]
ds_read_b128 a[124:127], v1 offset:31744
v_mfma_f32_16x16x32_bf16 v[52:55], a[92:95], a[60:63], v[52:55]
s_waitcnt vmcnt(8) lgkmcnt(7)
s_barrier
v_mfma_f32_16x16x32_bf16 v[56:59], a[96:99], a[0:3], v[16:19]
s_waitcnt lgkmcnt(6)
ds_read_b128 a[64:67], v2 offset:32768
v_mfma_f32_16x16x32_bf16 v[56:59], a[100:103], a[4:7], v[56:59]
s_waitcnt lgkmcnt(6)
v_exp_f32 v12, v92
v_mfma_f32_16x16x32_bf16 v[56:59], a[104:107], a[8:11], v[56:59]
s_waitcnt lgkmcnt(5)
ds_read_b128 a[68:71], v2 offset:33792
v_add_f32 v27, v27, v12
v_mfma_f32_16x16x32_bf16 v[56:59], a[108:111], a[12:15], v[56:59]
s_waitcnt lgkmcnt(5)
v_exp_f32 v13, v93
v_mfma_f32_16x16x32_bf16 v[56:59], a[112:115], a[16:19], v[56:59]
s_waitcnt lgkmcnt(4)
ds_read_b128 a[72:75], v2 offset:34816
v_add_f32 v27, v27, v13
v_mfma_f32_16x16x32_bf16 v[56:59], a[116:119], a[20:23], v[56:59]
s_waitcnt lgkmcnt(4)
v_exp_f32 v14, v94
v_mfma_f32_16x16x32_bf16 v[56:59], a[120:123], a[24:27], v[56:59]
s_waitcnt lgkmcnt(3)
ds_read_b128 a[76:79], v2 offset:35840
v_cvt_pk_bf16_f32 v126, v12, v13
v_mfma_f32_16x16x32_bf16 v[56:59], a[124:127], a[28:31], v[56:59]
v_exp_f32 v15, v95
v_mfma_f32_16x16x32_bf16 v[60:63], a[96:99], a[32:35], v[20:23]
ds_read_b128 a[80:83], v2 offset:36864
v_add_f32 v27, v27, v14
v_mfma_f32_16x16x32_bf16 v[60:63], a[100:103], a[36:39], v[60:63]
v_add_f32 v27, v27, v15
v_cvt_pk_bf16_f32 v127, v14, v15
v_mfma_f32_16x16x32_bf16 v[60:63], a[104:107], a[40:43], v[60:63]
ds_read_b128 a[84:87], v2 offset:37888
v_add_f32 v28, v26, v27
v_mfma_f32_16x16x32_bf16 v[60:63], a[108:111], a[44:47], v[60:63]
v_cmp_nge_f32 vcc, s25, v28
v_mfma_f32_16x16x32_bf16 v[60:63], a[112:115], a[48:51], v[60:63]
ds_read_b128 a[88:91], v2 offset:38912
v_mfma_f32_16x16x32_bf16 v[60:63], a[116:119], a[52:55], v[60:63]
v_mfma_f32_16x16x32_bf16 v[60:63], a[120:123], a[56:59], v[60:63]
ds_read_b128 a[92:95], v2 offset:39936
v_mfma_f32_16x16x32_bf16 v[60:63], a[124:127], a[60:63], v[60:63]
s_waitcnt lgkmcnt(6)
s_cbranch_vccnz Lstub_3
Lback_4:
v_mfma_f32_16x16x32_bf16 v[128:131], a[64:67], v[112:115], v[128:131]
s_add_u32 m0, s18, 65536
ds_read_b128 a[96:99], v2 offset:40960
v_add_f32 v24, v24, v26
v_mfma_f32_16x16x32_bf16 v[128:131], a[68:71], v[116:119], v[128:131]
buffer_load_dwordx4 v1, s[4:7], s12 offen offset:0 sc1 lds
v_mfma_f32_16x16x32_bf16 v[132:135], a[68:71], v[124:127], v[132:135]
ds_read_b128 a[100:103], v2 offset:41984
v_add_f32 v25, v25, v27
v_mfma_f32_16x16x32_bf16 v[132:135], a[64:67], v[120:123], v[132:135]
s_waitcnt lgkmcnt(7)
v_exp_f32 v8, v32
v_mfma_f32_16x16x32_bf16 v[136:139], a[72:75], v[112:115], v[136:139]
s_waitcnt lgkmcnt(6)
ds_read_b128 a[104:107], v2 offset:43008
v_mfma_f32_16x16x32_bf16 v[136:139], a[76:79], v[116:119], v[136:139]
buffer_load_dwordx4 v1, s[4:7], s12 offen offset:1024 sc1 lds
v_mfma_f32_16x16x32_bf16 v[140:143], a[76:79], v[124:127], v[140:143]
ds_read_b128 a[108:111], v2 offset:44032
v_mfma_f32_16x16x32_bf16 v[140:143], a[72:75], v[120:123], v[140:143]
s_waitcnt lgkmcnt(7)
v_exp_f32 v9, v33
v_mfma_f32_16x16x32_bf16 v[144:147], a[80:83], v[112:115], v[144:147]
s_waitcnt lgkmcnt(6)
ds_read_b128 a[112:115], v2 offset:45056
v_add_f32 v26, v8, v9
v_mfma_f32_16x16x32_bf16 v[144:147], a[84:87], v[116:119], v[144:147]
buffer_load_dwordx4 v1, s[4:7], s12 offen offset:2048 sc1 lds
v_mfma_f32_16x16x32_bf16 v[148:151], a[84:87], v[124:127], v[148:151]
ds_read_b128 a[116:119], v2 offset:46080
v_cvt_pk_bf16_f32 v96, v8, v9
v_mfma_f32_16x16x32_bf16 v[148:151], a[80:83], v[120:123], v[148:151]
s_waitcnt lgkmcnt(7)
v_exp_f32 v10, v34
v_mfma_f32_16x16x32_bf16 v[152:155], a[88:91], v[112:115], v[152:155]
s_waitcnt lgkmcnt(6)
ds_read_b128 a[120:123], v2 offset:47104
v_add_f32 v26, v26, v10
v_mfma_f32_16x16x32_bf16 v[152:155], a[92:95], v[116:119], v[152:155]
buffer_load_dwordx4 v1, s[4:7], s12 offen offset:3072 sc1 lds
v_mfma_f32_16x16x32_bf16 v[156:159], a[92:95], v[124:127], v[156:159]
s_add_u32 s12, s12, 4096
ds_read_b128 a[124:127], v2 offset:48128
v_mfma_f32_16x16x32_bf16 v[156:159], a[88:91], v[120:123], v[156:159]
s_waitcnt lgkmcnt(6)
v_exp_f32 v11, v35
v_mfma_f32_16x16x32_bf16 v[160:163], a[96:99], v[112:115], v[160:163]
s_add_u32 m0, s18, 69632
ds_read_b128 a[64:67], v2 offset:49152
v_add_f32 v26, v26, v11
v_mfma_f32_16x16x32_bf16 v[160:163], a[100:103], v[116:119], v[160:163]
buffer_load_dwordx4 v1, s[4:7], s12 offen offset:0 sc1 lds
v_mfma_f32_16x16x32_bf16 v[164:167], a[100:103], v[124:127], v[164:167]
ds_read_b128 a[68:71], v2 offset:50176
v_cvt_pk_bf16_f32 v97, v10, v11
v_mfma_f32_16x16x32_bf16 v[164:167], a[96:99], v[120:123], v[164:167]
s_waitcnt lgkmcnt(7)
v_mfma_f32_16x16x32_bf16 v[168:171], a[104:107], v[112:115], v[168:171]
s_waitcnt lgkmcnt(6)
ds_read_b128 a[72:75], v2 offset:51200
v_mfma_f32_16x16x32_bf16 v[168:171], a[108:111], v[116:119], v[168:171]
buffer_load_dwordx4 v1, s[4:7], s12 offen offset:1024 sc1 lds
v_mfma_f32_16x16x32_bf16 v[172:175], a[108:111], v[124:127], v[172:175]
ds_read_b128 a[76:79], v2 offset:52224
v_mfma_f32_16x16x32_bf16 v[172:175], a[104:107], v[120:123], v[172:175]
s_waitcnt lgkmcnt(7)
v_exp_f32 v12, v36
v_mfma_f32_16x16x32_bf16 v[176:179], a[112:115], v[112:115], v[176:179]
s_waitcnt lgkmcnt(6)
ds_read_b128 a[80:83], v2 offset:53248
v_mfma_f32_16x16x32_bf16 v[176:179], a[116:119], v[116:119], v[176:179]
buffer_load_dwordx4 v1, s[4:7], s12 offen offset:2048 sc1 lds
v_mfma_f32_16x16x32_bf16 v[180:183], a[116:119], v[124:127], v[180:183]
ds_read_b128 a[84:87], v2 offset:54272
v_mfma_f32_16x16x32_bf16 v[180:183], a[112:115], v[120:123], v[180:183]
s_waitcnt lgkmcnt(7)
v_exp_f32 v13, v37
v_mfma_f32_16x16x32_bf16 v[184:187], a[120:123], v[112:115], v[184:187]
s_waitcnt lgkmcnt(6)
ds_read_b128 a[88:91], v2 offset:55296
v_add_f32 v27, v12, v13
v_mfma_f32_16x16x32_bf16 v[184:187], a[124:127], v[116:119], v[184:187]
s_waitcnt lgkmcnt(5)
buffer_load_dwordx4 v1, s[4:7], s12 offen offset:3072 sc1 lds
v_mfma_f32_16x16x32_bf16 v[188:191], a[124:127], v[124:127], v[188:191]
s_add_u32 s12, s12, 28672
ds_read_b128 a[92:95], v2 offset:56320
v_cvt_pk_bf16_f32 v104, v12, v13
v_mfma_f32_16x16x32_bf16 v[188:191], a[120:123], v[120:123], v[188:191]
s_sub_u32 s13, s13, 1
v_exp_f32 v14, v38
v_mfma_f32_16x16x32_bf16 v[192:195], a[64:67], v[112:115], v[192:195]
s_cmp_eq_u32 s13, 0
ds_read_b128 a[96:99], v2 offset:57344
v_add_f32 v27, v27, v14
v_mfma_f32_16x16x32_bf16 v[192:195], a[68:71], v[116:119], v[192:195]
s_cselect_b32 s12, s14, s12
v_mfma_f32_16x16x32_bf16 v[196:199], a[68:71], v[124:127], v[196:199]
s_waitcnt lgkmcnt(6)
s_cselect_b32 s13, s15, s13
ds_read_b128 a[100:103], v2 offset:58368
v_mfma_f32_16x16x32_bf16 v[196:199], a[64:67], v[120:123], v[196:199]
s_cselect_b32 s14, 3221225472, s14
v_exp_f32 v15, v39
v_mfma_f32_16x16x32_bf16 v[200:203], a[72:75], v[112:115], v[200:203]
s_waitcnt lgkmcnt(6)
ds_read_b128 a[104:107], v2 offset:59392
v_add_f32 v27, v27, v15
v_mfma_f32_16x16x32_bf16 v[200:203], a[76:79], v[116:119], v[200:203]
v_exp_f32 v8, v40
v_mfma_f32_16x16x32_bf16 v[204:207], a[76:79], v[124:127], v[204:207]
ds_read_b128 a[108:111], v2 offset:60416
v_cvt_pk_bf16_f32 v105, v14, v15
v_mfma_f32_16x16x32_bf16 v[204:207], a[72:75], v[120:123], v[204:207]
s_waitcnt lgkmcnt(7)
v_exp_f32 v9, v41
v_mfma_f32_16x16x32_bf16 v[208:211], a[80:83], v[112:115], v[208:211]
s_waitcnt lgkmcnt(6)
ds_read_b128 a[112:115], v2 offset:61440
v_add_f32 v26, v26, v8
v_mfma_f32_16x16x32_bf16 v[208:211], a[84:87], v[116:119], v[208:211]
v_add_f32 v26, v26, v9
v_cvt_pk_bf16_f32 v98, v8, v9
v_mfma_f32_16x16x32_bf16 v[212:215], a[84:87], v[124:127], v[212:215]
ds_read_b128 a[116:119], v2 offset:62464
v_mfma_f32_16x16x32_bf16 v[212:215], a[80:83], v[120:123], v[212:215]
s_waitcnt lgkmcnt(7)
v_exp_f32 v10, v42
v_mfma_f32_16x16x32_bf16 v[216:219], a[88:91], v[112:115], v[216:219]
s_waitcnt lgkmcnt(6)
ds_read_b128 a[120:123], v2 offset:63488
v_add_f32 v26, v26, v10
v_mfma_f32_16x16x32_bf16 v[216:219], a[92:95], v[116:119], v[216:219]
v_exp_f32 v11, v43
v_mfma_f32_16x16x32_bf16 v[220:223], a[92:95], v[124:127], v[220:223]
ds_read_b128 a[124:127], v2 offset:64512
v_add_f32 v26, v26, v11
v_mfma_f32_16x16x32_bf16 v[220:223], a[88:91], v[120:123], v[220:223]
s_waitcnt vmcnt(8) lgkmcnt(7)
s_barrier
v_cvt_pk_bf16_f32 v99, v10, v11
v_mfma_f32_16x16x32_bf16 v[224:227], a[96:99], v[112:115], v[224:227]
s_waitcnt lgkmcnt(6)
ds_read_b128 a[64:67], v4 offset:0
v_mfma_f32_16x16x32_bf16 v[224:227], a[100:103], v[116:119], v[224:227]
v_exp_f32 v12, v44
v_mfma_f32_16x16x32_bf16 v[228:231], a[100:103], v[124:127], v[228:231]
ds_read_b128 a[68:71], v4 offset:1024
v_add_f32 v27, v27, v12
v_mfma_f32_16x16x32_bf16 v[228:231], a[96:99], v[120:123], v[228:231]
s_waitcnt lgkmcnt(7)
v_mfma_f32_16x16x32_bf16 v[232:235], a[104:107], v[112:115], v[232:235]
s_waitcnt lgkmcnt(6)
ds_read_b128 a[72:75], v4 offset:2048
v_mfma_f32_16x16x32_bf16 v[232:235], a[108:111], v[116:119], v[232:235]
v_exp_f32 v13, v45
v_mfma_f32_16x16x32_bf16 v[236:239], a[108:111], v[124:127], v[236:239]
ds_read_b128 a[76:79], v4 offset:3072
v_add_f32 v27, v27, v13
v_mfma_f32_16x16x32_bf16 v[236:239], a[104:107], v[120:123], v[236:239]
s_waitcnt lgkmcnt(7)
v_exp_f32 v14, v46
v_mfma_f32_16x16x32_bf16 v[240:243], a[112:115], v[112:115], v[240:243]
s_waitcnt lgkmcnt(6)
ds_read_b128 a[80:83], v4 offset:4096
v_cvt_pk_bf16_f32 v106, v12, v13
v_mfma_f32_16x16x32_bf16 v[240:243], a[116:119], v[116:119], v[240:243]
v_exp_f32 v15, v47
v_mfma_f32_16x16x32_bf16 v[244:247], a[116:119], v[124:127], v[244:247]
ds_read_b128 a[84:87], v4 offset:5120
v_add_f32 v27, v27, v14
v_mfma_f32_16x16x32_bf16 v[244:247], a[112:115], v[120:123], v[244:247]
s_waitcnt lgkmcnt(7)
v_add_f32 v27, v27, v15
v_cvt_pk_bf16_f32 v107, v14, v15
v_mfma_f32_16x16x32_bf16 v[248:251], a[120:123], v[112:115], v[248:251]
s_waitcnt lgkmcnt(6)
ds_read_b128 a[88:91], v4 offset:6144
v_mfma_f32_16x16x32_bf16 v[248:251], a[124:127], v[116:119], v[248:251]
v_mfma_f32_16x16x32_bf16 v[252:255], a[124:127], v[124:127], v[252:255]
ds_read_b128 a[92:95], v4 offset:7168
v_mfma_f32_16x16x32_bf16 v[252:255], a[120:123], v[120:123], v[252:255]
s_waitcnt lgkmcnt(7)
K2_x1:
v_mfma_f32_16x16x32_bf16 v[64:67], a[64:67], a[0:3], v[16:19]
s_waitcnt lgkmcnt(6)
s_add_u32 m0, s18, 0
ds_read_b128 a[96:99], v4 offset:8192
v_mfma_f32_16x16x32_bf16 v[64:67], a[68:71], a[4:7], v[64:67]
s_waitcnt lgkmcnt(6)
buffer_load_dwordx4 v1, s[4:7], s8 offen offset:0 sc1 lds
v_mfma_f32_16x16x32_bf16 v[64:67], a[72:75], a[8:11], v[64:67]
s_waitcnt lgkmcnt(5)
ds_read_b128 a[100:103], v4 offset:9216
v_mfma_f32_16x16x32_bf16 v[64:67], a[76:79], a[12:15], v[64:67]
s_waitcnt lgkmcnt(5)
v_exp_f32 v8, v48
v_mfma_f32_16x16x32_bf16 v[64:67], a[80:83], a[16:19], v[64:67]
s_waitcnt lgkmcnt(4)
ds_read_b128 a[104:107], v4 offset:10240
v_add_f32 v26, v26, v8
v_mfma_f32_16x16x32_bf16 v[64:67], a[84:87], a[20:23], v[64:67]
s_waitcnt lgkmcnt(4)
buffer_load_dwordx4 v1, s[4:7], s8 offen offset:1024 sc1 lds
v_mfma_f32_16x16x32_bf16 v[64:67], a[88:91], a[24:27], v[64:67]
s_waitcnt lgkmcnt(3)
ds_read_b128 a[108:111], v4 offset:11264
v_mfma_f32_16x16x32_bf16 v[64:67], a[92:95], a[28:31], v[64:67]
v_exp_f32 v9, v49
v_mfma_f32_16x16x32_bf16 v[68:71], a[64:67], a[32:35], v[20:23]
ds_read_b128 a[112:115], v4 offset:12288
v_add_f32 v26, v26, v9
v_mfma_f32_16x16x32_bf16 v[68:71], a[68:71], a[36:39], v[68:71]
buffer_load_dwordx4 v1, s[4:7], s8 offen offset:2048 sc1 lds
v_mfma_f32_16x16x32_bf16 v[68:71], a[72:75], a[40:43], v[68:71]
ds_read_b128 a[116:119], v4 offset:13312
v_cvt_pk_bf16_f32 v100, v8, v9
v_mfma_f32_16x16x32_bf16 v[68:71], a[76:79], a[44:47], v[68:71]
v_exp_f32 v10, v50
v_mfma_f32_16x16x32_bf16 v[68:71], a[80:83], a[48:51], v[68:71]
ds_read_b128 a[120:123], v4 offset:14336
v_add_f32 v26, v26, v10
v_mfma_f32_16x16x32_bf16 v[68:71], a[84:87], a[52:55], v[68:71]
buffer_load_dwordx4 v1, s[4:7], s8 offen offset:3072 sc1 lds
v_mfma_f32_16x16x32_bf16 v[68:71], a[88:91], a[56:59], v[68:71]
s_add_u32 s8, s8, 4096
ds_read_b128 a[124:127], v4 offset:15360
v_mfma_f32_16x16x32_bf16 v[68:71], a[92:95], a[60:63], v[68:71]
s_waitcnt lgkmcnt(6)
v_exp_f32 v11, v51
v_mfma_f32_16x16x32_bf16 v[72:75], a[96:99], a[0:3], v[16:19]
s_add_u32 m0, s18, 4096
ds_read_b128 a[64:67], v4 offset:16384
v_add_f32 v26, v26, v11
v_mfma_f32_16x16x32_bf16 v[72:75], a[100:103], a[4:7], v[72:75]
s_waitcnt lgkmcnt(6)
buffer_load_dwordx4 v1, s[4:7], s8 offen offset:0 sc1 lds
v_mfma_f32_16x16x32_bf16 v[72:75], a[104:107], a[8:11], v[72:75]
s_waitcnt lgkmcnt(5)
ds_read_b128 a[68:71], v4 offset:17408
v_cvt_pk_bf16_f32 v101, v10, v11
v_mfma_f32_16x16x32_bf16 v[72:75], a[108:111], a[12:15], v[72:75]
s_waitcnt lgkmcnt(5)
v_mfma_f32_16x16x32_bf16 v[72:75], a[112:115], a[16:19], v[72:75]
s_waitcnt lgkmcnt(4)
ds_read_b128 a[72:75], v4 offset:18432
v_mfma_f32_16x16x32_bf16 v[72:75], a[116:119], a[20:23], v[72:75]
s_waitcnt lgkmcnt(4)
buffer_load_dwordx4 v1, s[4:7], s8 offen offset:1024 sc1 lds
v_mfma_f32_16x16x32_bf16 v[72:75], a[120:123], a[24:27], v[72:75]
s_waitcnt lgkmcnt(3)
ds_read_b128 a[76:79], v4 offset:19456
v_mfma_f32_16x16x32_bf16 v[72:75], a[124:127], a[28:31], v[72:75]
v_exp_f32 v12, v52
v_mfma_f32_16x16x32_bf16 v[76:79], a[96:99], a[32:35], v[20:23]
ds_read_b128 a[80:83], v4 offset:20480
v_add_f32 v27, v27, v12
v_mfma_f32_16x16x32_bf16 v[76:79], a[100:103], a[36:39], v[76:79]
buffer_load_dwordx4 v1, s[4:7], s8 offen offset:2048 sc1 lds
v_mfma_f32_16x16x32_bf16 v[76:79], a[104:107], a[40:43], v[76:79]
ds_read_b128 a[84:87], v4 offset:21504
v_mfma_f32_16x16x32_bf16 v[76:79], a[108:111], a[44:47], v[76:79]
v_exp_f32 v13, v53
v_mfma_f32_16x16x32_bf16 v[76:79], a[112:115], a[48:51], v[76:79]
ds_read_b128 a[88:91], v4 offset:22528
v_add_f32 v27, v27, v13
v_mfma_f32_16x16x32_bf16 v[76:79], a[116:119], a[52:55], v[76:79]
s_waitcnt lgkmcnt(3)
buffer_load_dwordx4 v1, s[4:7], s8 offen offset:3072 sc1 lds
v_mfma_f32_16x16x32_bf16 v[76:79], a[120:123], a[56:59], v[76:79]
s_add_u32 s8, s8, 28672
ds_read_b128 a[92:95], v4 offset:23552
v_cvt_pk_bf16_f32 v108, v12, v13
v_mfma_f32_16x16x32_bf16 v[76:79], a[124:127], a[60:63], v[76:79]
s_sub_u32 s9, s9, 1
v_exp_f32 v14, v54
v_mfma_f32_16x16x32_bf16 v[80:83], a[64:67], a[0:3], v[16:19]
s_cmp_eq_u32 s9, 0
ds_read_b128 a[96:99], v4 offset:24576
v_add_f32 v27, v27, v14
v_mfma_f32_16x16x32_bf16 v[80:83], a[68:71], a[4:7], v[80:83]
s_cselect_b32 s8, s10, s8
v_exp_f32 v15, v55
v_mfma_f32_16x16x32_bf16 v[80:83], a[72:75], a[8:11], v[80:83]
s_cselect_b32 s9, s11, s9
ds_read_b128 a[100:103], v4 offset:25600
v_add_f32 v27, v27, v15
v_mfma_f32_16x16x32_bf16 v[80:83], a[76:79], a[12:15], v[80:83]
s_waitcnt lgkmcnt(5)
s_cselect_b32 s10, 3221225472, s10
v_cvt_pk_bf16_f32 v109, v14, v15
v_mfma_f32_16x16x32_bf16 v[80:83], a[80:83], a[16:19], v[80:83]
s_waitcnt lgkmcnt(4)
ds_read_b128 a[104:107], v4 offset:26624
v_mfma_f32_16x16x32_bf16 v[80:83], a[84:87], a[20:23], v[80:83]
s_waitcnt lgkmcnt(4)
v_exp_f32 v8, v56
v_mfma_f32_16x16x32_bf16 v[80:83], a[88:91], a[24:27], v[80:83]
s_waitcnt lgkmcnt(3)
ds_read_b128 a[108:111], v4 offset:27648
v_add_f32 v26, v26, v8
v_mfma_f32_16x16x32_bf16 v[80:83], a[92:95], a[28:31], v[80:83]
v_exp_f32 v9, v57
v_mfma_f32_16x16x32_bf16 v[84:87], a[64:67], a[32:35], v[20:23]
ds_read_b128 a[112:115], v4 offset:28672
v_add_f32 v26, v26, v9
v_mfma_f32_16x16x32_bf16 v[84:87], a[68:71], a[36:39], v[84:87]
v_exp_f32 v10, v58
v_mfma_f32_16x16x32_bf16 v[84:87], a[72:75], a[40:43], v[84:87]
ds_read_b128 a[116:119], v4 offset:29696
v_cvt_pk_bf16_f32 v102, v8, v9
v_mfma_f32_16x16x32_bf16 v[84:87], a[76:79], a[44:47], v[84:87]
v_exp_f32 v11, v59
v_mfma_f32_16x16x32_bf16 v[84:87], a[80:83], a[48:51], v[84:87]
ds_read_b128 a[120:123], v4 offset:30720
v_add_f32 v26, v26, v10
v_mfma_f32_16x16x32_bf16 v[84:87], a[84:87], a[52:55], v[84:87]
v_add_f32 v26, v26, v11
v_cvt_pk_bf16_f32 v103, v10, v11
v_mfma_f32_16x16x32_bf16 v[84:87], a[88:91], a[56:59], v[84:87]
ds_read_b128 a[124:127], v4 offset:31744
v_mfma_f32_16x16x32_bf16 v[84:87], a[92:95], a[60:63], v[84:87]
s_waitcnt vmcnt(8) lgkmcnt(7)
s_barrier
v_mfma_f32_16x16x32_bf16 v[88:91], a[96:99], a[0:3], v[16:19]
s_waitcnt lgkmcnt(6)
ds_read_b128 a[64:67], v2 offset:0
v_mfma_f32_16x16x32_bf16 v[88:91], a[100:103], a[4:7], v[88:91]
s_waitcnt lgkmcnt(6)
v_exp_f32 v12, v60
v_mfma_f32_16x16x32_bf16 v[88:91], a[104:107], a[8:11], v[88:91]
s_waitcnt lgkmcnt(5)
ds_read_b128 a[68:71], v2 offset:1024
v_add_f32 v27, v27, v12
v_mfma_f32_16x16x32_bf16 v[88:91], a[108:111], a[12:15], v[88:91]
s_waitcnt lgkmcnt(5)
v_exp_f32 v13, v61
v_mfma_f32_16x16x32_bf16 v[88:91], a[112:115], a[16:19], v[88:91]
s_waitcnt lgkmcnt(4)
ds_read_b128 a[72:75], v2 offset:2048
v_add_f32 v27, v27, v13
v_mfma_f32_16x16x32_bf16 v[88:91], a[116:119], a[20:23], v[88:91]
s_waitcnt lgkmcnt(4)
v_exp_f32 v14, v62
v_mfma_f32_16x16x32_bf16 v[88:91], a[120:123], a[24:27], v[88:91]
s_waitcnt lgkmcnt(3)
ds_read_b128 a[76:79], v2 offset:3072
v_cvt_pk_bf16_f32 v110, v12, v13
v_mfma_f32_16x16x32_bf16 v[88:91], a[124:127], a[28:31], v[88:91]
v_exp_f32 v15, v63
v_mfma_f32_16x16x32_bf16 v[92:95], a[96:99], a[32:35], v[20:23]
s_sub_u32 s19, s19, 1
ds_read_b128 a[80:83], v2 offset:4096
v_add_f32 v27, v27, v14
v_mfma_f32_16x16x32_bf16 v[92:95], a[100:103], a[36:39], v[92:95]
v_add_f32 v27, v27, v15
v_cvt_pk_bf16_f32 v111, v14, v15
v_mfma_f32_16x16x32_bf16 v[92:95], a[104:107], a[40:43], v[92:95]
ds_read_b128 a[84:87], v2 offset:5120
v_add_f32 v28, v26, v27
v_mfma_f32_16x16x32_bf16 v[92:95], a[108:111], a[44:47], v[92:95]
v_cmp_nge_f32 vcc, s25, v28
v_mfma_f32_16x16x32_bf16 v[92:95], a[112:115], a[48:51], v[92:95]
ds_read_b128 a[88:91], v2 offset:6144
v_mfma_f32_16x16x32_bf16 v[92:95], a[116:119], a[52:55], v[92:95]
v_mfma_f32_16x16x32_bf16 v[92:95], a[120:123], a[56:59], v[92:95]
ds_read_b128 a[92:95], v2 offset:7168
v_mfma_f32_16x16x32_bf16 v[92:95], a[124:127], a[60:63], v[92:95]
s_waitcnt lgkmcnt(6)
s_cbranch_vccnz Lstub_5
Lback_6:
s_cmp_lg_u32 s19, 0
s_cbranch_scc1 K2_loop
s_cmp_eq_u32 s24, 2
s_cbranch_scc1 K2_ntail
v_mfma_f32_16x16x32_bf16 v[128:131], a[64:67], v[96:99], v[128:131]
s_add_u32 m0, s18, 98304
ds_read_b128 a[96:99], v2 offset:8192
v_add_f32 v24, v24, v26
v_mfma_f32_16x16x32_bf16 v[128:131], a[68:71], v[100:103], v[128:131]
buffer_load_dwordx4 v1, s[4:7], s12 offen offset:0 sc1 lds
v_mfma_f32_16x16x32_bf16 v[132:135], a[68:71], v[108:111], v[132:135]
ds_read_b128 a[100:103], v2 offset:9216
v_add_f32 v25, v25, v27
v_mfma_f32_16x16x32_bf16 v[132:135], a[64:67], v[104:107], v[132:135]
s_waitcnt lgkmcnt(7)
v_exp_f32 v8, v64
v_mfma_f32_16x16x32_bf16 v[136:139], a[72:75], v[96:99], v[136:139]
s_waitcnt lgkmcnt(6)
ds_read_b128 a[104:107], v2 offset:10240
v_mfma_f32_16x16x32_bf16 v[136:139], a[76:79], v[100:103], v[136:139]
buffer_load_dwordx4 v1, s[4:7], s12 offen offset:1024 sc1 lds
v_mfma_f32_16x16x32_bf16 v[140:143], a[76:79], v[108:111], v[140:143]
ds_read_b128 a[108:111], v2 offset:11264
v_mfma_f32_16x16x32_bf16 v[140:143], a[72:75], v[104:107], v[140:143]
s_waitcnt lgkmcnt(7)
v_exp_f32 v9, v65
v_mfma_f32_16x16x32_bf16 v[144:147], a[80:83], v[96:99], v[144:147]
s_waitcnt lgkmcnt(6)
ds_read_b128 a[112:115], v2 offset:12288
v_add_f32 v26, v8, v9
v_mfma_f32_16x16x32_bf16 v[144:147], a[84:87], v[100:103], v[144:147]
buffer_load_dwordx4 v1, s[4:7], s12 offen offset:2048 sc1 lds
v_mfma_f32_16x16x32_bf16 v[148:151], a[84:87], v[108:111], v[148:151]
ds_read_b128 a[116:119], v2 offset:13312
v_cvt_pk_bf16_f32 v112, v8, v9
v_mfma_f32_16x16x32_bf16 v[148:151], a[80:83], v[104:107], v[148:151]
s_waitcnt lgkmcnt(7)
v_exp_f32 v10, v66
v_mfma_f32_16x16x32_bf16 v[152:155], a[88:91], v[96:99], v[152:155]
s_waitcnt lgkmcnt(6)
ds_read_b128 a[120:123], v2 offset:14336
v_add_f32 v26, v26, v10
v_mfma_f32_16x16x32_bf16 v[152:155], a[92:95], v[100:103], v[152:155]
buffer_load_dwordx4 v1, s[4:7], s12 offen offset:3072 sc1 lds
v_mfma_f32_16x16x32_bf16 v[156:159], a[92:95], v[108:111], v[156:159]
s_add_u32 s12, s12, 4096
ds_read_b128 a[124:127], v2 offset:15360
v_mfma_f32_16x16x32_bf16 v[156:159], a[88:91], v[104:107], v[156:159]
s_waitcnt lgkmcnt(6)
v_exp_f32 v11, v67
v_mfma_f32_16x16x32_bf16 v[160:163], a[96:99], v[96:99], v[160:163]
s_add_u32 m0, s18, 102400
ds_read_b128 a[64:67], v2 offset:16384
v_add_f32 v26, v26, v11
v_mfma_f32_16x16x32_bf16 v[160:163], a[100:103], v[100:103], v[160:163]
buffer_load_dwordx4 v1, s[4:7], s12 offen offset:0 sc1 lds
v_mfma_f32_16x16x32_bf16 v[164:167], a[100:103], v[108:111], v[164:167]
ds_read_b128 a[68:71], v2 offset:17408
v_cvt_pk_bf16_f32 v113, v10, v11
v_mfma_f32_16x16x32_bf16 v[164:167], a[96:99], v[104:107], v[164:167]
s_waitcnt lgkmcnt(7)
v_mfma_f32_16x16x32_bf16 v[168:171], a[104:107], v[96:99], v[168:171]
s_waitcnt lgkmcnt(6)
ds_read_b128 a[72:75], v2 offset:18432
v_mfma_f32_16x16x32_bf16 v[168:171], a[108:111], v[100:103], v[168:171]
buffer_load_dwordx4 v1, s[4:7], s12 offen offset:1024 sc1 lds
v_mfma_f32_16x16x32_bf16 v[172:175], a[108:111], v[108:111], v[172:175]
ds_read_b128 a[76:79], v2 offset:19456
v_mfma_f32_16x16x32_bf16 v[172:175], a[104:107], v[104:107], v[172:175]
s_waitcnt lgkmcnt(7)
v_exp_f32 v12, v68
v_mfma_f32_16x16x32_bf16 v[176:179], a[112:115], v[96:99], v[176:179]
s_waitcnt lgkmcnt(6)
ds_read_b128 a[80:83], v2 offset:20480
v_mfma_f32_16x16x32_bf16 v[176:179], a[116:119], v[100:103], v[176:179]
buffer_load_dwordx4 v1, s[4:7], s12 offen offset:2048 sc1 lds
v_mfma_f32_16x16x32_bf16 v[180:183], a[116:119], v[108:111], v[180:183]
ds_read_b128 a[84:87], v2 offset:21504
v_mfma_f32_16x16x32_bf16 v[180:183], a[112:115], v[104:107], v[180:183]
s_waitcnt lgkmcnt(7)
v_exp_f32 v13, v69
v_mfma_f32_16x16x32_bf16 v[184:187], a[120:123], v[96:99], v[184:187]
s_waitcnt lgkmcnt(6)
ds_read_b128 a[88:91], v2 offset:22528
v_add_f32 v27, v12, v13
v_mfma_f32_16x16x32_bf16 v[184:187], a[124:127], v[100:103], v[184:187]
s_waitcnt lgkmcnt(5)
buffer_load_dwordx4 v1, s[4:7], s12 offen offset:3072 sc1 lds
v_mfma_f32_16x16x32_bf16 v[188:191], a[124:127], v[108:111], v[188:191]
s_add_u32 s12, s12, 28672
ds_read_b128 a[92:95], v2 offset:23552
v_cvt_pk_bf16_f32 v120, v12, v13
v_mfma_f32_16x16x32_bf16 v[188:191], a[120:123], v[104:107], v[188:191]
s_sub_u32 s13, s13, 1
v_exp_f32 v14, v70
v_mfma_f32_16x16x32_bf16 v[192:195], a[64:67], v[96:99], v[192:195]
s_cmp_eq_u32 s13, 0
ds_read_b128 a[96:99], v2 offset:24576
v_add_f32 v27, v27, v14
v_mfma_f32_16x16x32_bf16 v[192:195], a[68:71], v[100:103], v[192:195]
s_cselect_b32 s12, s14, s12
v_mfma_f32_16x16x32_bf16 v[196:199], a[68:71], v[108:111], v[196:199]
s_waitcnt lgkmcnt(6)
s_cselect_b32 s13, s15, s13
ds_read_b128 a[100:103], v2 offset:25600
v_mfma_f32_16x16x32_bf16 v[196:199], a[64:67], v[104:107], v[196:199]
s_cselect_b32 s14, 3221225472, s14
v_exp_f32 v15, v71
v_mfma_f32_16x16x32_bf16 v[200:203], a[72:75], v[96:99], v[200:203]
s_waitcnt lgkmcnt(6)
ds_read_b128 a[104:107], v2 offset:26624
v_add_f32 v27, v27, v15
v_mfma_f32_16x16x32_bf16 v[200:203], a[76:79], v[100:103], v[200:203]
v_exp_f32 v8, v72
v_mfma_f32_16x16x32_bf16 v[204:207], a[76:79], v[108:111], v[204:207]
ds_read_b128 a[108:111], v2 offset:27648
v_cvt_pk_bf16_f32 v121, v14, v15
v_mfma_f32_16x16x32_bf16 v[204:207], a[72:75], v[104:107], v[204:207]
s_waitcnt lgkmcnt(7)
v_exp_f32 v9, v73
v_mfma_f32_16x16x32_bf16 v[208:211], a[80:83], v[96:99], v[208:211]
s_waitcnt lgkmcnt(6)
ds_read_b128 a[112:115], v2 offset:28672
v_add_f32 v26, v26, v8
v_mfma_f32_16x16x32_bf16 v[208:211], a[84:87], v[100:103], v[208:211]
v_add_f32 v26, v26, v9
v_cvt_pk_bf16_f32 v114, v8, v9
v_mfma_f32_16x16x32_bf16 v[212:215], a[84:87], v[108:111], v[212:215]
ds_read_b128 a[116:119], v2 offset:29696
v_mfma_f32_16x16x32_bf16 v[212:215], a[80:83], v[104:107], v[212:215]
s_waitcnt lgkmcnt(7)
v_exp_f32 v10, v74
v_mfma_f32_16x16x32_bf16 v[216:219], a[88:91], v[96:99], v[216:219]
s_waitcnt lgkmcnt(6)
ds_read_b128 a[120:123], v2 offset:30720
v_add_f32 v26, v26, v10
v_mfma_f32_16x16x32_bf16 v[216:219], a[92:95], v[100:103], v[216:219]
v_exp_f32 v11, v75
v_mfma_f32_16x16x32_bf16 v[220:223], a[92:95], v[108:111], v[220:223]
ds_read_b128 a[124:127], v2 offset:31744
v_add_f32 v26, v26, v11
v_mfma_f32_16x16x32_bf16 v[220:223], a[88:91], v[104:107], v[220:223]
s_waitcnt vmcnt(8) lgkmcnt(7)
s_barrier
v_cvt_pk_bf16_f32 v115, v10, v11
v_mfma_f32_16x16x32_bf16 v[224:227], a[96:99], v[96:99], v[224:227]
s_waitcnt lgkmcnt(6)
ds_read_b128 a[64:67], v1 offset:0
v_mfma_f32_16x16x32_bf16 v[224:227], a[100:103], v[100:103], v[224:227]
v_exp_f32 v12, v76
v_mfma_f32_16x16x32_bf16 v[228:231], a[100:103], v[108:111], v[228:231]
ds_read_b128 a[68:71], v1 offset:1024
v_add_f32 v27, v27, v12
v_mfma_f32_16x16x32_bf16 v[228:231], a[96:99], v[104:107], v[228:231]
s_waitcnt lgkmcnt(7)
v_mfma_f32_16x16x32_bf16 v[232:235], a[104:107], v[96:99], v[232:235]
s_waitcnt lgkmcnt(6)
ds_read_b128 a[72:75], v1 offset:2048
v_mfma_f32_16x16x32_bf16 v[232:235], a[108:111], v[100:103], v[232:235]
v_exp_f32 v13, v77
v_mfma_f32_16x16x32_bf16 v[236:239], a[108:111], v[108:111], v[236:239]
ds_read_b128 a[76:79], v1 offset:3072
v_add_f32 v27, v27, v13
v_mfma_f32_16x16x32_bf16 v[236:239], a[104:107], v[104:107], v[236:239]
s_waitcnt lgkmcnt(7)
v_exp_f32 v14, v78
v_mfma_f32_16x16x32_bf16 v[240:243], a[112:115], v[96:99], v[240:243]
s_waitcnt lgkmcnt(6)
ds_read_b128 a[80:83], v1 offset:4096
v_cvt_pk_bf16_f32 v122, v12, v13
v_mfma_f32_16x16x32_bf16 v[240:243], a[116:119], v[100:103], v[240:243]
v_exp_f32 v15, v79
v_mfma_f32_16x16x32_bf16 v[244:247], a[116:119], v[108:111], v[244:247]
ds_read_b128 a[84:87], v1 offset:5120
v_add_f32 v27, v27, v14
v_mfma_f32_16x16x32_bf16 v[244:247], a[112:115], v[104:107], v[244:247]
s_waitcnt lgkmcnt(7)
v_add_f32 v27, v27, v15
v_cvt_pk_bf16_f32 v123, v14, v15
v_mfma_f32_16x16x32_bf16 v[248:251], a[120:123], v[96:99], v[248:251]
s_waitcnt lgkmcnt(6)
ds_read_b128 a[88:91], v1 offset:6144
v_mfma_f32_16x16x32_bf16 v[248:251], a[124:127], v[100:103], v[248:251]
v_mfma_f32_16x16x32_bf16 v[252:255], a[124:127], v[108:111], v[252:255]
ds_read_b128 a[92:95], v1 offset:7168
v_mfma_f32_16x16x32_bf16 v[252:255], a[120:123], v[104:107], v[252:255]
s_waitcnt lgkmcnt(6)
v_cndmask_b32 v32, v16, v7, s[32:33]
v_cndmask_b32 v33, v16, v7, s[34:35]
v_cndmask_b32 v34, v16, v7, s[36:37]
v_cndmask_b32 v35, v16, v7, s[38:39]
s_nop 1
v_mfma_f32_16x16x32_bf16 v[32:35], a[64:67], a[0:3], v[32:35]
s_add_u32 m0, s18, 131072
ds_read_b128 a[96:99], v1 offset:8192
v_cndmask_b32 v40, v16, v7, s[40:41]
v_mfma_f32_16x16x32_bf16 v[32:35], a[68:71], a[4:7], v[32:35]
s_waitcnt lgkmcnt(6)
buffer_load_dwordx4 v1, s[4:7], s8 offen offset:0 sc1 lds
v_mfma_f32_16x16x32_bf16 v[32:35], a[72:75], a[8:11], v[32:35]
s_waitcnt lgkmcnt(5)
ds_read_b128 a[100:103], v1 offset:9216
v_cndmask_b32 v41, v16, v7, s[42:43]
v_mfma_f32_16x16x32_bf16 v[32:35], a[76:79], a[12:15], v[32:35]
s_waitcnt lgkmcnt(5)
v_cndmask_b32 v42, v16, v7, s[44:45]
v_cndmask_b32 v43, v16, v7, s[46:47]
v_mfma_f32_16x16x32_bf16 v[32:35], a[80:83], a[16:19], v[32:35]
s_waitcnt lgkmcnt(4)
ds_read_b128 a[104:107], v1 offset:10240
v_mfma_f32_16x16x32_bf16 v[32:35], a[84:87], a[20:23], v[32:35]
s_waitcnt lgkmcnt(4)
buffer_load_dwordx4 v1, s[4:7], s8 offen offset:1024 sc1 lds
v_mfma_f32_16x16x32_bf16 v[32:35], a[88:91], a[24:27], v[32:35]
s_waitcnt lgkmcnt(3)
ds_read_b128 a[108:111], v1 offset:11264
v_mfma_f32_16x16x32_bf16 v[32:35], a[92:95], a[28:31], v[32:35]
v_exp_f32 v8, v80
v_mfma_f32_16x16x32_bf16 v[36:39], a[64:67], a[32:35], v[20:23]
ds_read_b128 a[112:115], v1 offset:12288
v_add_f32 v26, v26, v8
v_mfma_f32_16x16x32_bf16 v[36:39], a[68:71], a[36:39], v[36:39]
buffer_load_dwordx4 v1, s[4:7], s8 offen offset:2048 sc1 lds
v_mfma_f32_16x16x32_bf16 v[36:39], a[72:75], a[40:43], v[36:39]
ds_read_b128 a[116:119], v1 offset:13312
v_mfma_f32_16x16x32_bf16 v[36:39], a[76:79], a[44:47], v[36:39]
v_exp_f32 v9, v81
v_mfma_f32_16x16x32_bf16 v[36:39], a[80:83], a[48:51], v[36:39]
ds_read_b128 a[120:123], v1 offset:14336
v_add_f32 v26, v26, v9
v_mfma_f32_16x16x32_bf16 v[36:39], a[84:87], a[52:55], v[36:39]
buffer_load_dwordx4 v1, s[4:7], s8 offen offset:3072 sc1 lds
v_mfma_f32_16x16x32_bf16 v[36:39], a[88:91], a[56:59], v[36:39]
s_add_u32 s8, s8, 4096
ds_read_b128 a[124:127], v1 offset:15360
v_cvt_pk_bf16_f32 v116, v8, v9
v_mfma_f32_16x16x32_bf16 v[36:39], a[92:95], a[60:63], v[36:39]
s_waitcnt lgkmcnt(6)
v_exp_f32 v10, v82
v_mfma_f32_16x16x32_bf16 v[40:43], a[96:99], a[0:3], v[40:43]
s_add_u32 m0, s18, 135168
ds_read_b128 a[64:67], v1 offset:16384
v_cndmask_b32 v48, v16, v7, s[48:49]
v_mfma_f32_16x16x32_bf16 v[40:43], a[100:103], a[4:7], v[40:43]
s_waitcnt lgkmcnt(6)
buffer_load_dwordx4 v1, s[4:7], s8 offen offset:0 sc1 lds
v_mfma_f32_16x16x32_bf16 v[40:43], a[104:107], a[8:11], v[40:43]
s_waitcnt lgkmcnt(5)
ds_read_b128 a[68:71], v1 offset:17408
v_cndmask_b32 v49, v16, v7, s[50:51]
v_mfma_f32_16x16x32_bf16 v[40:43], a[108:111], a[12:15], v[40:43]
s_waitcnt lgkmcnt(5)
v_cndmask_b32 v50, v16, v7, s[52:53]
v_cndmask_b32 v51, v16, v7, s[54:55]
v_mfma_f32_16x16x32_bf16 v[40:43], a[112:115], a[16:19], v[40:43]
s_waitcnt lgkmcnt(4)
ds_read_b128 a[72:75], v1 offset:18432
v_add_f32 v26, v26, v10
v_mfma_f32_16x16x32_bf16 v[40:43], a[116:119], a[20:23], v[40:43]
s_waitcnt lgkmcnt(4)
buffer_load_dwordx4 v1, s[4:7], s8 offen offset:1024 sc1 lds
v_mfma_f32_16x16x32_bf16 v[40:43], a[120:123], a[24:27], v[40:43]
s_waitcnt lgkmcnt(3)
ds_read_b128 a[76:79], v1 offset:19456
v_mfma_f32_16x16x32_bf16 v[40:43], a[124:127], a[28:31], v[40:43]
v_exp_f32 v11, v83
v_mfma_f32_16x16x32_bf16 v[44:47], a[96:99], a[32:35], v[20:23]
ds_read_b128 a[80:83], v1 offset:20480
v_add_f32 v26, v26, v11
v_mfma_f32_16x16x32_bf16 v[44:47], a[100:103], a[36:39], v[44:47]
buffer_load_dwordx4 v1, s[4:7], s8 offen offset:2048 sc1 lds
v_mfma_f32_16x16x32_bf16 v[44:47], a[104:107], a[40:43], v[44:47]
ds_read_b128 a[84:87], v1 offset:21504
v_cvt_pk_bf16_f32 v117, v10, v11
v_mfma_f32_16x16x32_bf16 v[44:47], a[108:111], a[44:47], v[44:47]
v_exp_f32 v12, v84
v_mfma_f32_16x16x32_bf16 v[44:47], a[112:115], a[48:51], v[44:47]
ds_read_b128 a[88:91], v1 offset:22528
v_add_f32 v27, v27, v12
v_mfma_f32_16x16x32_bf16 v[44:47], a[116:119], a[52:55], v[44:47]
buffer_load_dwordx4 v1, s[4:7], s8 offen offset:3072 sc1 lds
v_mfma_f32_16x16x32_bf16 v[44:47], a[120:123], a[56:59], v[44:47]
s_waitcnt lgkmcnt(2)
s_add_u32 s8, s8, 28672
ds_read_b128 a[92:95], v1 offset:23552
v_mfma_f32_16x16x32_bf16 v[44:47], a[124:127], a[60:63], v[44:47]
s_sub_u32 s9, s9, 1
v_exp_f32 v13, v85
v_mfma_f32_16x16x32_bf16 v[48:51], a[64:67], a[0:3], v[48:51]
s_cmp_eq_u32 s9, 0
ds_read_b128 a[96:99], v1 offset:24576
v_cndmask_b32 v56, v16, v7, s[56:57]
v_mfma_f32_16x16x32_bf16 v[48:51], a[68:71], a[4:7], v[48:51]
s_cselect_b32 s8, s10, s8
v_cndmask_b32 v57, v16, v7, s[58:59]
v_cndmask_b32 v58, v16, v7, s[60:61]
v_mfma_f32_16x16x32_bf16 v[48:51], a[72:75], a[8:11], v[48:51]
s_cselect_b32 s9, s11, s9
ds_read_b128 a[100:103], v1 offset:25600
v_cndmask_b32 v59, v16, v7, s[62:63]
v_mfma_f32_16x16x32_bf16 v[48:51], a[76:79], a[12:15], v[48:51]
s_cselect_b32 s10, 3221225472, s10
v_exp_f32 v14, v86
v_mfma_f32_16x16x32_bf16 v[48:51], a[80:83], a[16:19], v[48:51]
s_waitcnt lgkmcnt(4)
ds_read_b128 a[104:107], v1 offset:26624
v_add_f32 v27, v27, v13
v_cvt_pk_bf16_f32 v124, v12, v13
v_mfma_f32_16x16x32_bf16 v[48:51], a[84:87], a[20:23], v[48:51]
s_waitcnt lgkmcnt(4)
v_exp_f32 v15, v87
v_mfma_f32_16x16x32_bf16 v[48:51], a[88:91], a[24:27], v[48:51]
s_waitcnt lgkmcnt(3)
ds_read_b128 a[108:111], v1 offset:27648
v_add_f32 v27, v27, v14
v_mfma_f32_16x16x32_bf16 v[48:51], a[92:95], a[28:31], v[48:51]
v_exp_f32 v8, v88
v_mfma_f32_16x16x32_bf16 v[52:55], a[64:67], a[32:35], v[20:23]
ds_read_b128 a[112:115], v1 offset:28672
v_add_f32 v27, v27, v15
v_mfma_f32_16x16x32_bf16 v[52:55], a[68:71], a[36:39], v[52:55]
v_exp_f32 v9, v89
v_mfma_f32_16x16x32_bf16 v[52:55], a[72:75], a[40:43], v[52:55]
ds_read_b128 a[116:119], v1 offset:29696
v_cvt_pk_bf16_f32 v125, v14, v15
v_mfma_f32_16x16x32_bf16 v[52:55], a[76:79], a[44:47], v[52:55]
v_exp_f32 v10, v90
v_mfma_f32_16x16x32_bf16 v[52:55], a[80:83], a[48:51], v[52:55]
ds_read_b128 a[120:123], v1 offset:30720
v_add_f32 v26, v26, v8
v_mfma_f32_16x16x32_bf16 v[52:55], a[84:87], a[52:55], v[52:55]
v_exp_f32 v11, v91
v_mfma_f32_16x16x32_bf16 v[52:55], a[88:91], a[56:59], v[52:55]
ds_read_b128 a[124:127], v1 offset:31744
v_add_f32 v26, v26, v9
v_cvt_pk_bf16_f32 v118, v8, v9
v_mfma_f32_16x16x32_bf16 v[52:55], a[92:95], a[60:63], v[52:55]
s_waitcnt vmcnt(8) lgkmcnt(7)
s_barrier
v_add_f32 v26, v26, v10
v_mfma_f32_16x16x32_bf16 v[56:59], a[96:99], a[0:3], v[56:59]
s_waitcnt lgkmcnt(6)
ds_read_b128 a[64:67], v2 offset:32768
v_add_f32 v26, v26, v11
v_mfma_f32_16x16x32_bf16 v[56:59], a[100:103], a[4:7], v[56:59]
s_waitcnt lgkmcnt(6)
v_exp_f32 v12, v92
v_mfma_f32_16x16x32_bf16 v[56:59], a[104:107], a[8:11], v[56:59]
s_waitcnt lgkmcnt(5)
ds_read_b128 a[68:71], v2 offset:33792
v_cvt_pk_bf16_f32 v119, v10, v11
v_mfma_f32_16x16x32_bf16 v[56:59], a[108:111], a[12:15], v[56:59]
s_waitcnt lgkmcnt(5)
v_exp_f32 v13, v93
v_mfma_f32_16x16x32_bf16 v[56:59], a[112:115], a[16:19], v[56:59]
s_waitcnt lgkmcnt(4)
ds_read_b128 a[72:75], v2 offset:34816
v_add_f32 v27, v27, v12
v_mfma_f32_16x16x32_bf16 v[56:59], a[116:119], a[20:23], v[56:59]
s_waitcnt lgkmcnt(4)
v_exp_f32 v14, v94
v_mfma_f32_16x16x32_bf16 v[56:59], a[120:123], a[24:27], v[56:59]
s_waitcnt lgkmcnt(3)
ds_read_b128 a[76:79], v2 offset:35840
v_add_f32 v27, v27, v13
v_mfma_f32_16x16x32_bf16 v[56:59], a[124:127], a[28:31], v[56:59]
v_exp_f32 v15, v95
v_mfma_f32_16x16x32_bf16 v[60:63], a[96:99], a[32:35], v[20:23]
ds_read_b128 a[80:83], v2 offset:36864
v_cvt_pk_bf16_f32 v126, v12, v13
v_mfma_f32_16x16x32_bf16 v[60:63], a[100:103], a[36:39], v[60:63]
v_add_f32 v27, v27, v14
v_add_f32 v27, v27, v15
v_mfma_f32_16x16x32_bf16 v[60:63], a[104:107], a[40:43], v[60:63]
ds_read_b128 a[84:87], v2 offset:37888
v_cvt_pk_bf16_f32 v127, v14, v15
v_mfma_f32_16x16x32_bf16 v[60:63], a[108:111], a[44:47], v[60:63]
v_add_f32 v28, v26, v27
v_cmp_nge_f32 vcc, s25, v28
v_mfma_f32_16x16x32_bf16 v[60:63], a[112:115], a[48:51], v[60:63]
ds_read_b128 a[88:91], v2 offset:38912
v_mfma_f32_16x16x32_bf16 v[60:63], a[116:119], a[52:55], v[60:63]
v_mfma_f32_16x16x32_bf16 v[60:63], a[120:123], a[56:59], v[60:63]
ds_read_b128 a[92:95], v2 offset:39936
v_mfma_f32_16x16x32_bf16 v[60:63], a[124:127], a[60:63], v[60:63]
s_waitcnt lgkmcnt(6)
s_cbranch_vccnz Lstub_7
Lback_8:
v_mfma_f32_16x16x32_bf16 v[128:131], a[64:67], v[112:115], v[128:131]
s_add_u32 m0, s18, 65536
ds_read_b128 a[96:99], v2 offset:40960
v_add_f32 v24, v24, v26
v_mfma_f32_16x16x32_bf16 v[128:131], a[68:71], v[116:119], v[128:131]
buffer_load_dwordx4 v1, s[4:7], s12 offen offset:0 sc1 lds
v_mfma_f32_16x16x32_bf16 v[132:135], a[68:71], v[124:127], v[132:135]
ds_read_b128 a[100:103], v2 offset:41984
v_add_f32 v25, v25, v27
v_mfma_f32_16x16x32_bf16 v[132:135], a[64:67], v[120:123], v[132:135]
s_waitcnt lgkmcnt(7)
v_exp_f32 v8, v32
v_mfma_f32_16x16x32_bf16 v[136:139], a[72:75], v[112:115], v[136:139]
s_waitcnt lgkmcnt(6)
ds_read_b128 a[104:107], v2 offset:43008
v_mfma_f32_16x16x32_bf16 v[136:139], a[76:79], v[116:119], v[136:139]
buffer_load_dwordx4 v1, s[4:7], s12 offen offset:1024 sc1 lds
v_mfma_f32_16x16x32_bf16 v[140:143], a[76:79], v[124:127], v[140:143]
ds_read_b128 a[108:111], v2 offset:44032
v_mfma_f32_16x16x32_bf16 v[140:143], a[72:75], v[120:123], v[140:143]
s_waitcnt lgkmcnt(7)
v_exp_f32 v9, v33
v_mfma_f32_16x16x32_bf16 v[144:147], a[80:83], v[112:115], v[144:147]
s_waitcnt lgkmcnt(6)
ds_read_b128 a[112:115], v2 offset:45056
v_add_f32 v26, v8, v9
v_mfma_f32_16x16x32_bf16 v[144:147], a[84:87], v[116:119], v[144:147]
buffer_load_dwordx4 v1, s[4:7], s12 offen offset:2048 sc1 lds
v_mfma_f32_16x16x32_bf16 v[148:151], a[84:87], v[124:127], v[148:151]
ds_read_b128 a[116:119], v2 offset:46080
v_cvt_pk_bf16_f32 v96, v8, v9
v_mfma_f32_16x16x32_bf16 v[148:151], a[80:83], v[120:123], v[148:151]
s_waitcnt lgkmcnt(7)
v_exp_f32 v10, v34
v_mfma_f32_16x16x32_bf16 v[152:155], a[88:91], v[112:115], v[152:155]
s_waitcnt lgkmcnt(6)
ds_read_b128 a[120:123], v2 offset:47104
v_add_f32 v26, v26, v10
v_mfma_f32_16x16x32_bf16 v[152:155], a[92:95], v[116:119], v[152:155]
buffer_load_dwordx4 v1, s[4:7], s12 offen offset:3072 sc1 lds
v_mfma_f32_16x16x32_bf16 v[156:159], a[92:95], v[124:127], v[156:159]
s_add_u32 s12, s12, 4096
ds_read_b128 a[124:127], v2 offset:48128
v_mfma_f32_16x16x32_bf16 v[156:159], a[88:91], v[120:123], v[156:159]
s_waitcnt lgkmcnt(6)
v_exp_f32 v11, v35
v_mfma_f32_16x16x32_bf16 v[160:163], a[96:99], v[112:115], v[160:163]
s_add_u32 m0, s18, 69632
ds_read_b128 a[64:67], v2 offset:49152
v_add_f32 v26, v26, v11
v_mfma_f32_16x16x32_bf16 v[160:163], a[100:103], v[116:119], v[160:163]
buffer_load_dwordx4 v1, s[4:7], s12 offen offset:0 sc1 lds
v_mfma_f32_16x16x32_bf16 v[164:167], a[100:103], v[124:127], v[164:167]
ds_read_b128 a[68:71], v2 offset:50176
v_cvt_pk_bf16_f32 v97, v10, v11
v_mfma_f32_16x16x32_bf16 v[164:167], a[96:99], v[120:123], v[164:167]
s_waitcnt lgkmcnt(7)
v_mfma_f32_16x16x32_bf16 v[168:171], a[104:107], v[112:115], v[168:171]
s_waitcnt lgkmcnt(6)
ds_read_b128 a[72:75], v2 offset:51200
v_mfma_f32_16x16x32_bf16 v[168:171], a[108:111], v[116:119], v[168:171]
buffer_load_dwordx4 v1, s[4:7], s12 offen offset:1024 sc1 lds
v_mfma_f32_16x16x32_bf16 v[172:175], a[108:111], v[124:127], v[172:175]
ds_read_b128 a[76:79], v2 offset:52224
v_mfma_f32_16x16x32_bf16 v[172:175], a[104:107], v[120:123], v[172:175]
s_waitcnt lgkmcnt(7)
v_exp_f32 v12, v36
v_mfma_f32_16x16x32_bf16 v[176:179], a[112:115], v[112:115], v[176:179]
s_waitcnt lgkmcnt(6)
ds_read_b128 a[80:83], v2 offset:53248
v_mfma_f32_16x16x32_bf16 v[176:179], a[116:119], v[116:119], v[176:179]
buffer_load_dwordx4 v1, s[4:7], s12 offen offset:2048 sc1 lds
v_mfma_f32_16x16x32_bf16 v[180:183], a[116:119], v[124:127], v[180:183]
ds_read_b128 a[84:87], v2 offset:54272
v_mfma_f32_16x16x32_bf16 v[180:183], a[112:115], v[120:123], v[180:183]
s_waitcnt lgkmcnt(7)
v_exp_f32 v13, v37
v_mfma_f32_16x16x32_bf16 v[184:187], a[120:123], v[112:115], v[184:187]
s_waitcnt lgkmcnt(6)
ds_read_b128 a[88:91], v2 offset:55296
v_add_f32 v27, v12, v13
v_mfma_f32_16x16x32_bf16 v[184:187], a[124:127], v[116:119], v[184:187]
s_waitcnt lgkmcnt(5)
buffer_load_dwordx4 v1, s[4:7], s12 offen offset:3072 sc1 lds
v_mfma_f32_16x16x32_bf16 v[188:191], a[124:127], v[124:127], v[188:191]
s_add_u32 s12, s12, 28672
ds_read_b128 a[92:95], v2 offset:56320
v_cvt_pk_bf16_f32 v104, v12, v13
v_mfma_f32_16x16x32_bf16 v[188:191], a[120:123], v[120:123], v[188:191]
s_sub_u32 s13, s13, 1
v_exp_f32 v14, v38
v_mfma_f32_16x16x32_bf16 v[192:195], a[64:67], v[112:115], v[192:195]
s_cmp_eq_u32 s13, 0
ds_read_b128 a[96:99], v2 offset:57344
v_add_f32 v27, v27, v14
v_mfma_f32_16x16x32_bf16 v[192:195], a[68:71], v[116:119], v[192:195]
s_cselect_b32 s12, s14, s12
v_exp_f32 v15, v39
v_mfma_f32_16x16x32_bf16 v[196:199], a[68:71], v[124:127], v[196:199]
s_cselect_b32 s13, s15, s13
ds_read_b128 a[100:103], v2 offset:58368
v_add_f32 v27, v27, v15
v_mfma_f32_16x16x32_bf16 v[196:199], a[64:67], v[120:123], v[196:199]
s_waitcnt lgkmcnt(7)
s_cselect_b32 s14, 3221225472, s14
v_cvt_pk_bf16_f32 v105, v14, v15
v_mfma_f32_16x16x32_bf16 v[200:203], a[72:75], v[112:115], v[200:203]
s_waitcnt lgkmcnt(6)
ds_read_b128 a[104:107], v2 offset:59392
v_mfma_f32_16x16x32_bf16 v[200:203], a[76:79], v[116:119], v[200:203]
buffer_load_dword v3, off, s[4:7], s80 sc1
v_mfma_f32_16x16x32_bf16 v[204:207], a[76:79], v[124:127], v[204:207]
ds_read_b128 a[108:111], v2 offset:60416
v_mfma_f32_16x16x32_bf16 v[204:207], a[72:75], v[120:123], v[204:207]
s_waitcnt lgkmcnt(7)
v_exp_f32 v8, v40
v_mfma_f32_16x16x32_bf16 v[208:211], a[80:83], v[112:115], v[208:211]
s_waitcnt lgkmcnt(6)
ds_read_b128 a[112:115], v2 offset:61440
v_add_f32 v26, v26, v8
v_mfma_f32_16x16x32_bf16 v[208:211], a[84:87], v[116:119], v[208:211]
v_exp_f32 v9, v41
v_mfma_f32_16x16x32_bf16 v[212:215], a[84:87], v[124:127], v[212:215]
ds_read_b128 a[116:119], v2 offset:62464
v_add_f32 v26, v26, v9
v_mfma_f32_16x16x32_bf16 v[212:215], a[80:83], v[120:123], v[212:215]
s_waitcnt lgkmcnt(7)
v_exp_f32 v10, v42
v_mfma_f32_16x16x32_bf16 v[216:219], a[88:91], v[112:115], v[216:219]
s_waitcnt lgkmcnt(6)
ds_read_b128 a[120:123], v2 offset:63488
v_cvt_pk_bf16_f32 v98, v8, v9
v_mfma_f32_16x16x32_bf16 v[216:219], a[92:95], v[116:119], v[216:219]
v_exp_f32 v11, v43
v_mfma_f32_16x16x32_bf16 v[220:223], a[92:95], v[124:127], v[220:223]
ds_read_b128 a[124:127], v2 offset:64512
v_add_f32 v26, v26, v10
v_mfma_f32_16x16x32_bf16 v[220:223], a[88:91], v[120:123], v[220:223]
s_waitcnt vmcnt(9) lgkmcnt(7)
s_barrier
v_add_f32 v26, v26, v11
v_mfma_f32_16x16x32_bf16 v[224:227], a[96:99], v[112:115], v[224:227]
s_waitcnt lgkmcnt(6)
ds_read_b128 a[64:67], v4 offset:0
v_cvt_pk_bf16_f32 v99, v10, v11
v_mfma_f32_16x16x32_bf16 v[224:227], a[100:103], v[116:119], v[224:227]
v_mfma_f32_16x16x32_bf16 v[228:231], a[100:103], v[124:127], v[228:231]
ds_read_b128 a[68:71], v4 offset:1024
v_mfma_f32_16x16x32_bf16 v[228:231], a[96:99], v[120:123], v[228:231]
s_waitcnt lgkmcnt(7)
v_exp_f32 v12, v44
v_mfma_f32_16x16x32_bf16 v[232:235], a[104:107], v[112:115], v[232:235]
s_waitcnt lgkmcnt(6)
ds_read_b128 a[72:75], v4 offset:2048
v_add_f32 v27, v27, v12
v_mfma_f32_16x16x32_bf16 v[232:235], a[108:111], v[116:119], v[232:235]
v_exp_f32 v13, v45
v_mfma_f32_16x16x32_bf16 v[236:239], a[108:111], v[124:127], v[236:239]
ds_read_b128 a[76:79], v4 offset:3072
v_add_f32 v27, v27, v13
v_mfma_f32_16x16x32_bf16 v[236:239], a[104:107], v[120:123], v[236:239]
s_waitcnt lgkmcnt(7)
v_exp_f32 v14, v46
v_mfma_f32_16x16x32_bf16 v[240:243], a[112:115], v[112:115], v[240:243]
s_waitcnt lgkmcnt(6)
ds_read_b128 a[80:83], v4 offset:4096
v_cvt_pk_bf16_f32 v106, v12, v13
v_mfma_f32_16x16x32_bf16 v[240:243], a[116:119], v[116:119], v[240:243]
v_exp_f32 v15, v47
v_mfma_f32_16x16x32_bf16 v[244:247], a[116:119], v[124:127], v[244:247]
ds_read_b128 a[84:87], v4 offset:5120
v_add_f32 v27, v27, v14
v_mfma_f32_16x16x32_bf16 v[244:247], a[112:115], v[120:123], v[244:247]
s_waitcnt lgkmcnt(7)
v_add_f32 v27, v27, v15
v_cvt_pk_bf16_f32 v107, v14, v15
v_mfma_f32_16x16x32_bf16 v[248:251], a[120:123], v[112:115], v[248:251]
s_waitcnt lgkmcnt(6)
ds_read_b128 a[88:91], v4 offset:6144
v_mfma_f32_16x16x32_bf16 v[248:251], a[124:127], v[116:119], v[248:251]
v_mfma_f32_16x16x32_bf16 v[252:255], a[124:127], v[124:127], v[252:255]
ds_read_b128 a[92:95], v4 offset:7168
v_mfma_f32_16x16x32_bf16 v[252:255], a[120:123], v[120:123], v[252:255]
s_waitcnt lgkmcnt(6)
K2_dx1:
v_cndmask_b32 v68, v20, v7, s[32:33]
v_cndmask_b32 v69, v20, v7, s[34:35]
v_cndmask_b32 v70, v20, v7, s[36:37]
v_cndmask_b32 v71, v20, v7, s[38:39]
s_nop 1
v_mfma_f32_16x16x32_bf16 v[68:71], a[64:67], a[32:35], v[68:71]
s_add_u32 m0, s18, 0
ds_read_b128 a[96:99], v4 offset:8192
v_cndmask_b32 v76, v20, v7, s[40:41]
v_cndmask_b32 v79, v20, v7, s[46:47]
v_mfma_f32_16x16x32_bf16 v[68:71], a[68:71], a[36:39], v[68:71]
s_waitcnt lgkmcnt(6)
ds_read_b128 a[100:103], v4 offset:9216
buffer_load_dwordx4 v1, s[4:7], s12 offen offset:0 sc1 lds
v_mfma_f32_16x16x32_bf16 v[68:71], a[72:75], a[40:43], v[68:71]
s_waitcnt lgkmcnt(6)
ds_read_b128 a[104:107], v4 offset:10240
v_cndmask_b32 v77, v20, v7, s[42:43]
v_mfma_f32_16x16x32_bf16 v[68:71], a[76:79], a[44:47], v[68:71]
s_waitcnt lgkmcnt(6)
ds_read_b128 a[108:111], v4 offset:11264
buffer_load_dwordx4 v1, s[4:7], s12 offen offset:1024 sc1 lds
v_mfma_f32_16x16x32_bf16 v[68:71], a[80:83], a[48:51], v[68:71]
s_waitcnt lgkmcnt(6)
ds_read_b128 a[112:115], v4 offset:12288
v_cndmask_b32 v78, v20, v7, s[44:45]
v_mfma_f32_16x16x32_bf16 v[68:71], a[84:87], a[52:55], v[68:71]
s_waitcnt lgkmcnt(6)
ds_read_b128 a[116:119], v4 offset:13312
buffer_load_dwordx4 v1, s[4:7], s12 offen offset:2048 sc1 lds
v_mfma_f32_16x16x32_bf16 v[68:71], a[88:91], a[56:59], v[68:71]
s_waitcnt lgkmcnt(6)
ds_read_b128 a[120:123], v4 offset:14336
v_exp_f32 v8, v48
v_exp_f32 v9, v49
v_exp_f32 v10, v50
v_mfma_f32_16x16x32_bf16 v[68:71], a[92:95], a[60:63], v[68:71]
s_waitcnt lgkmcnt(5)
ds_read_b128 a[124:127], v4 offset:15360
buffer_load_dwordx4 v1, s[4:7], s12 offen offset:3072 sc1 lds
v_add_f32 v26, v26, v8
v_add_f32 v26, v26, v9
v_cvt_pk_bf16_f32 v100, v8, v9
v_add_f32 v26, v26, v10
v_mfma_f32_16x16x32_bf16 v[76:79], a[96:99], a[32:35], v[76:79]
s_add_u32 s12, s12, 4096
s_add_u32 m0, s18, 4096
ds_read_b128 a[64:67], v4 offset:16384
v_cndmask_b32 v86, v20, v7, s[52:53]
v_cndmask_b32 v87, v20, v7, s[54:55]
v_mfma_f32_16x16x32_bf16 v[76:79], a[100:103], a[36:39], v[76:79]
s_waitcnt lgkmcnt(6)
ds_read_b128 a[68:71], v4 offset:17408
buffer_load_dwordx4 v1, s[4:7], s12 offen offset:0 sc1 lds
v_mfma_f32_16x16x32_bf16 v[76:79], a[104:107], a[40:43], v[76:79]
s_waitcnt lgkmcnt(6)
ds_read_b128 a[72:75], v4 offset:18432
v_cndmask_b32 v84, v20, v7, s[48:49]
v_mfma_f32_16x16x32_bf16 v[76:79], a[108:111], a[44:47], v[76:79]
s_waitcnt lgkmcnt(6)
ds_read_b128 a[76:79], v4 offset:19456
buffer_load_dwordx4 v1, s[4:7], s12 offen offset:1024 sc1 lds
v_mfma_f32_16x16x32_bf16 v[76:79], a[112:115], a[48:51], v[76:79]
s_waitcnt lgkmcnt(6)
ds_read_b128 a[80:83], v4 offset:20480
v_cndmask_b32 v85, v20, v7, s[50:51]
v_mfma_f32_16x16x32_bf16 v[76:79], a[116:119], a[52:55], v[76:79]
s_waitcnt lgkmcnt(6)
ds_read_b128 a[84:87], v4 offset:21504
buffer_load_dwordx4 v1, s[4:7], s12 offen offset:2048 sc1 lds
v_mfma_f32_16x16x32_bf16 v[76:79], a[120:123], a[56:59], v[76:79]
s_waitcnt lgkmcnt(6)
ds_read_b128 a[88:91], v4 offset:22528
v_exp_f32 v11, v51
v_exp_f32 v12, v52
v_mfma_f32_16x16x32_bf16 v[76:79], a[124:127], a[60:63], v[76:79]
s_waitcnt lgkmcnt(1)
ds_read_b128 a[92:95], v4 offset:23552
buffer_load_dwordx4 v1, s[4:7], s12 offen offset:3072 sc1 lds
v_add_f32 v26, v26, v11
v_cvt_pk_bf16_f32 v101, v10, v11
v_add_f32 v27, v27, v12
v_mfma_f32_16x16x32_bf16 v[84:87], a[64:67], a[32:35], v[84:87]
s_add_u32 s12, s12, 28672
ds_read_b128 a[96:99], v4 offset:24576
v_cndmask_b32 v92, v20, v7, s[56:57]
v_mfma_f32_16x16x32_bf16 v[84:87], a[68:71], a[36:39], v[84:87]
s_sub_u32 s13, s13, 1
ds_read_b128 a[100:103], v4 offset:25600
v_cndmask_b32 v93, v20, v7, s[58:59]
v_mfma_f32_16x16x32_bf16 v[84:87], a[72:75], a[40:43], v[84:87]
s_cmp_eq_u32 s13, 0
ds_read_b128 a[104:107], v4 offset:26624
v_cndmask_b32 v94, v20, v7, s[60:61]
v_mfma_f32_16x16x32_bf16 v[84:87], a[76:79], a[44:47], v[84:87]
s_cselect_b32 s12, s14, s12
ds_read_b128 a[108:111], v4 offset:27648
v_cndmask_b32 v95, v20, v7, s[62:63]
v_mfma_f32_16x16x32_bf16 v[84:87], a[80:83], a[48:51], v[84:87]
s_cselect_b32 s13, s15, s13
ds_read_b128 a[112:115], v4 offset:28672
v_exp_f32 v13, v53
v_exp_f32 v14, v54
v_mfma_f32_16x16x32_bf16 v[84:87], a[84:87], a[52:55], v[84:87]
s_waitcnt lgkmcnt(6)
s_cselect_b32 s14, 3221225472, s14
ds_read_b128 a[116:119], v4 offset:29696
v_exp_f32 v15, v55
v_exp_f32 v8, v56
v_exp_f32 v9, v57
v_add_f32 v27, v27, v13
v_cvt_pk_bf16_f32 v108, v12, v13
v_add_f32 v27, v27, v14
v_mfma_f32_16x16x32_bf16 v[84:87], a[88:91], a[56:59], v[84:87]
s_waitcnt lgkmcnt(6)
ds_read_b128 a[120:123], v4 offset:30720
v_exp_f32 v10, v58
v_exp_f32 v11, v59
v_add_f32 v27, v27, v15
v_cvt_pk_bf16_f32 v109, v14, v15
v_mfma_f32_16x16x32_bf16 v[84:87], a[92:95], a[60:63], v[84:87]
s_waitcnt vmcnt(8) lgkmcnt(6)
s_barrier
ds_read_b128 a[124:127], v4 offset:31744
v_mfma_f32_16x16x32_bf16 v[92:95], a[96:99], a[32:35], v[92:95]
s_waitcnt lgkmcnt(6)
ds_read_b128 a[64:67], v2 offset:0
v_exp_f32 v12, v60
v_exp_f32 v13, v61
v_mfma_f32_16x16x32_bf16 v[92:95], a[100:103], a[36:39], v[92:95]
s_waitcnt lgkmcnt(6)
ds_read_b128 a[68:71], v2 offset:1024
v_exp_f32 v14, v62
v_exp_f32 v15, v63
v_mfma_f32_16x16x32_bf16 v[92:95], a[104:107], a[40:43], v[92:95]
s_waitcnt lgkmcnt(6)
ds_read_b128 a[72:75], v2 offset:2048
v_add_f32 v26, v26, v8
v_add_f32 v26, v26, v9
v_cvt_pk_bf16_f32 v102, v8, v9
v_mfma_f32_16x16x32_bf16 v[92:95], a[108:111], a[44:47], v[92:95]
s_waitcnt lgkmcnt(6)
ds_read_b128 a[76:79], v2 offset:3072
v_add_f32 v26, v26, v10
v_add_f32 v26, v26, v11
v_cvt_pk_bf16_f32 v103, v10, v11
v_mfma_f32_16x16x32_bf16 v[92:95], a[112:115], a[48:51], v[92:95]
s_waitcnt lgkmcnt(6)
ds_read_b128 a[80:83], v2 offset:4096
v_add_f32 v27, v27, v12
v_mfma_f32_16x16x32_bf16 v[92:95], a[116:119], a[52:55], v[92:95]
s_waitcnt lgkmcnt(6)
ds_read_b128 a[84:87], v2 offset:5120
v_add_f32 v27, v27, v13
v_cvt_pk_bf16_f32 v110, v12, v13
v_mfma_f32_16x16x32_bf16 v[92:95], a[120:123], a[56:59], v[92:95]
s_waitcnt lgkmcnt(6)
ds_read_b128 a[88:91], v2 offset:6144
v_add_f32 v27, v27, v14
v_add_f32 v27, v27, v15
v_cvt_pk_bf16_f32 v111, v14, v15
v_mfma_f32_16x16x32_bf16 v[92:95], a[124:127], a[60:63], v[92:95]
s_waitcnt lgkmcnt(6)
ds_read_b128 a[92:95], v2 offset:7168
v_add_f32 v28, v26, v27
v_cmp_nge_f32 vcc, s25, v28
s_cbranch_vccnz Lstub_9
Lback_10:
s_cmp_lg_u32 s24, 1
s_cbranch_scc1 K2_plain
v_cmp_gt_u32 vcc, 1, v3
s_cbranch_vccnz K2_tspin
K2_tok:
v_mfma_f32_16x16x32_bf16 v[128:131], a[64:67], v[96:99], v[128:131]
s_waitcnt lgkmcnt(6)
ds_read_b128 a[96:99], v2 offset:8192
v_add_f32 v24, v24, v26
v_mfma_f32_16x16x32_bf16 v[128:131], a[68:71], v[100:103], v[128:131]
buffer_load_dwordx4 v[28:31], v1, s[4:7], s27 offen sc1
v_mfma_f32_16x16x32_bf16 v[132:135], a[68:71], v[108:111], v[132:135]
ds_read_b128 a[100:103], v2 offset:9216
v_add_f32 v25, v25, v27
v_mfma_f32_16x16x32_bf16 v[132:135], a[64:67], v[104:107], v[132:135]
s_waitcnt lgkmcnt(6)
v_exp_f32 v8, v68
v_mfma_f32_16x16x32_bf16 v[136:139], a[72:75], v[96:99], v[136:139]
s_add_u32 s22, s76, 0
ds_read_b128 a[104:107], v2 offset:10240
v_exp_f32 v9, v69
v_mfma_f32_16x16x32_bf16 v[136:139], a[76:79], v[100:103], v[136:139]
buffer_load_dwordx4 v[32:35], v1, s[4:7], s22 offen offset:0 sc1
v_mfma_f32_16x16x32_bf16 v[140:143], a[76:79], v[108:111], v[140:143]
ds_read_b128 a[108:111], v2 offset:11264
v_add_f32 v27, v8, v9
v_mfma_f32_16x16x32_bf16 v[140:143], a[72:75], v[104:107], v[140:143]
s_waitcnt lgkmcnt(7)
v_exp_f32 v10, v70
v_mfma_f32_16x16x32_bf16 v[144:147], a[80:83], v[96:99], v[144:147]
s_waitcnt lgkmcnt(6)
ds_read_b128 a[112:115], v2 offset:12288
v_cvt_pk_bf16_f32 v120, v8, v9
v_mfma_f32_16x16x32_bf16 v[144:147], a[84:87], v[100:103], v[144:147]
buffer_load_dwordx4 v[36:39], v1, s[4:7], s22 offen offset:1024 sc1
v_mfma_f32_16x16x32_bf16 v[148:151], a[84:87], v[108:111], v[148:151]
ds_read_b128 a[116:119], v2 offset:13312
v_add_f32 v27, v27, v10
v_mfma_f32_16x16x32_bf16 v[148:151], a[80:83], v[104:107], v[148:151]
s_waitcnt lgkmcnt(7)
v_exp_f32 v11, v71
v_mfma_f32_16x16x32_bf16 v[152:155], a[88:91], v[96:99], v[152:155]
s_waitcnt lgkmcnt(6)
ds_read_b128 a[120:123], v2 offset:14336
v_add_f32 v27, v27, v11
v_mfma_f32_16x16x32_bf16 v[152:155], a[92:95], v[100:103], v[152:155]
buffer_load_dwordx4 v[40:43], v1, s[4:7], s22 offen offset:2048 sc1
v_mfma_f32_16x16x32_bf16 v[156:159], a[92:95], v[108:111], v[156:159]
ds_read_b128 a[124:127], v2 offset:15360
v_cvt_pk_bf16_f32 v121, v10, v11
v_mfma_f32_16x16x32_bf16 v[156:159], a[88:91], v[104:107], v[156:159]
s_waitcnt lgkmcnt(7)
v_exp_f32 v12, v76
v_mfma_f32_16x16x32_bf16 v[160:163], a[96:99], v[96:99], v[160:163]
s_waitcnt lgkmcnt(6)
ds_read_b128 a[64:67], v2 offset:16384
v_add_f32 v27, v27, v12
v_mfma_f32_16x16x32_bf16 v[160:163], a[100:103], v[100:103], v[160:163]
buffer_load_dwordx4 v[44:47], v1, s[4:7], s22 offen offset:3072 sc1
v_mfma_f32_16x16x32_bf16 v[164:167], a[100:103], v[108:111], v[164:167]
ds_read_b128 a[68:71], v2 offset:17408
v_mfma_f32_16x16x32_bf16 v[164:167], a[96:99], v[104:107], v[164:167]
s_waitcnt lgkmcnt(6)
v_exp_f32 v13, v77
v_mfma_f32_16x16x32_bf16 v[168:171], a[104:107], v[96:99], v[168:171]
s_add_u32 s22, s76, 4096
ds_read_b128 a[72:75], v2 offset:18432
v_add_f32 v27, v27, v13
v_mfma_f32_16x16x32_bf16 v[168:171], a[108:111], v[100:103], v[168:171]
buffer_load_dwordx4 v[48:51], v1, s[4:7], s22 offen offset:0 sc1
v_mfma_f32_16x16x32_bf16 v[172:175], a[108:111], v[108:111], v[172:175]
ds_read_b128 a[76:79], v2 offset:19456
v_exp_f32 v14, v78
v_mfma_f32_16x16x32_bf16 v[172:175], a[104:107], v[104:107], v[172:175]
s_waitcnt lgkmcnt(7)
v_exp_f32 v15, v79
v_mfma_f32_16x16x32_bf16 v[176:179], a[112:115], v[96:99], v[176:179]
s_waitcnt lgkmcnt(6)
ds_read_b128 a[80:83], v2 offset:20480
v_cvt_pk_bf16_f32 v122, v12, v13
v_mfma_f32_16x16x32_bf16 v[176:179], a[116:119], v[100:103], v[176:179]
buffer_load_dwordx4 v[52:55], v1, s[4:7], s22 offen offset:1024 sc1
v_mfma_f32_16x16x32_bf16 v[180:183], a[116:119], v[108:111], v[180:183]
ds_read_b128 a[84:87], v2 offset:21504
v_add_f32 v27, v27, v14
v_mfma_f32_16x16x32_bf16 v[180:183], a[112:115], v[104:107], v[180:183]
s_waitcnt lgkmcnt(7)
v_exp_f32 v8, v84
v_mfma_f32_16x16x32_bf16 v[184:187], a[120:123], v[96:99], v[184:187]
s_waitcnt lgkmcnt(6)
ds_read_b128 a[88:91], v2 offset:22528
v_add_f32 v27, v27, v15
v_cvt_pk_bf16_f32 v123, v14, v15
v_mfma_f32_16x16x32_bf16 v[184:187], a[124:127], v[100:103], v[184:187]
buffer_load_dwordx4 v[56:59], v1, s[4:7], s22 offen offset:2048 sc1
v_mfma_f32_16x16x32_bf16 v[188:191], a[124:127], v[108:111], v[188:191]
ds_read_b128 a[92:95], v2 offset:23552
v_add_f32 v27, v27, v8
v_mfma_f32_16x16x32_bf16 v[188:191], a[120:123], v[104:107], v[188:191]
s_waitcnt lgkmcnt(7)
v_exp_f32 v9, v85
v_mfma_f32_16x16x32_bf16 v[192:195], a[64:67], v[96:99], v[192:195]
s_waitcnt lgkmcnt(6)
ds_read_b128 a[96:99], v2 offset:24576
v_add_f32 v27, v27, v9
v_mfma_f32_16x16x32_bf16 v[192:195], a[68:71], v[100:103], v[192:195]
buffer_load_dwordx4 v[60:63], v1, s[4:7], s22 offen offset:3072 sc1
v_mfma_f32_16x16x32_bf16 v[196:199], a[68:71], v[108:111], v[196:199]
ds_read_b128 a[100:103], v2 offset:25600
v_cvt_pk_bf16_f32 v124, v8, v9
v_mfma_f32_16x16x32_bf16 v[196:199], a[64:67], v[104:107], v[196:199]
s_waitcnt lgkmcnt(6)
v_exp_f32 v10, v86
v_mfma_f32_16x16x32_bf16 v[200:203], a[72:75], v[96:99], v[200:203]
s_add_u32 s22, s76, 8192
ds_read_b128 a[104:107], v2 offset:26624
v_add_f32 v27, v27, v10
v_mfma_f32_16x16x32_bf16 v[200:203], a[76:79], v[100:103], v[200:203]
buffer_load_dwordx4 a[32:35], v1, s[4:7], s22 offen offset:0 sc1
v_mfma_f32_16x16x32_bf16 v[204:207], a[76:79], v[108:111], v[204:207]
ds_read_b128 a[108:111], v2 offset:27648
v_mfma_f32_16x16x32_bf16 v[204:207], a[72:75], v[104:107], v[204:207]
s_waitcnt lgkmcnt(7)
v_exp_f32 v11, v87
v_mfma_f32_16x16x32_bf16 v[208:211], a[80:83], v[96:99], v[208:211]
s_waitcnt lgkmcnt(6)
ds_read_b128 a[112:115], v2 offset:28672
v_exp_f32 v12, v92
v_mfma_f32_16x16x32_bf16 v[208:211], a[84:87], v[100:103], v[208:211]
buffer_load_dwordx4 a[36:39], v1, s[4:7], s22 offen offset:1024 sc1
v_mfma_f32_16x16x32_bf16 v[212:215], a[84:87], v[108:111], v[212:215]
ds_read_b128 a[116:119], v2 offset:29696
v_add_f32 v27, v27, v11
v_mfma_f32_16x16x32_bf16 v[212:215], a[80:83], v[104:107], v[212:215]
s_waitcnt lgkmcnt(7)
v_exp_f32 v13, v93
v_mfma_f32_16x16x32_bf16 v[216:219], a[88:91], v[96:99], v[216:219]
s_waitcnt lgkmcnt(6)
ds_read_b128 a[120:123], v2 offset:30720
v_cvt_pk_bf16_f32 v125, v10, v11
v_add_f32 v27, v27, v12
v_mfma_f32_16x16x32_bf16 v[216:219], a[92:95], v[100:103], v[216:219]
buffer_load_dwordx4 a[40:43], v1, s[4:7], s22 offen offset:2048 sc1
v_mfma_f32_16x16x32_bf16 v[220:223], a[92:95], v[108:111], v[220:223]
ds_read_b128 a[124:127], v2 offset:31744
v_add_f32 v27, v27, v13
v_mfma_f32_16x16x32_bf16 v[220:223], a[88:91], v[104:107], v[220:223]
s_waitcnt vmcnt(12) lgkmcnt(7)
s_barrier
v_cvt_pk_bf16_f32 v126, v12, v13
v_mfma_f32_16x16x32_bf16 v[224:227], a[96:99], v[96:99], v[224:227]
s_waitcnt lgkmcnt(6)
ds_read_b128 a[64:67], v1 offset:0
v_mfma_f32_16x16x32_bf16 v[224:227], a[100:103], v[100:103], v[224:227]
buffer_load_dwordx4 a[44:47], v1, s[4:7], s22 offen offset:3072 sc1
v_mfma_f32_16x16x32_bf16 v[228:231], a[100:103], v[108:111], v[228:231]
ds_read_b128 a[68:71], v1 offset:1024
v_mfma_f32_16x16x32_bf16 v[228:231], a[96:99], v[104:107], v[228:231]
s_waitcnt lgkmcnt(6)
v_exp_f32 v14, v94
v_mfma_f32_16x16x32_bf16 v[232:235], a[104:107], v[96:99], v[232:235]
s_add_u32 s22, s76, 12288
ds_read_b128 a[72:75], v1 offset:2048
v_add_f32 v27, v27, v14
v_mfma_f32_16x16x32_bf16 v[232:235], a[108:111], v[100:103], v[232:235]
buffer_load_dwordx4 a[48:51], v1, s[4:7], s22 offen offset:0 sc1
v_mfma_f32_16x16x32_bf16 v[236:239], a[108:111], v[108:111], v[236:239]
ds_read_b128 a[76:79], v1 offset:3072
v_mfma_f32_16x16x32_bf16 v[236:239], a[104:107], v[104:107], v[236:239]
s_waitcnt lgkmcnt(7)
v_exp_f32 v15, v95
v_mfma_f32_16x16x32_bf16 v[240:243], a[112:115], v[96:99], v[240:243]
s_waitcnt lgkmcnt(6)
ds_read_b128 a[80:83], v1 offset:4096
v_add_f32 v27, v27, v15
v_mfma_f32_16x16x32_bf16 v[240:243], a[116:119], v[100:103], v[240:243]
buffer_load_dwordx4 a[52:55], v1, s[4:7], s22 offen offset:1024 sc1
v_mfma_f32_16x16x32_bf16 v[244:247], a[116:119], v[108:111], v[244:247]
ds_read_b128 a[84:87], v1 offset:5120
v_cvt_pk_bf16_f32 v127, v14, v15
v_mfma_f32_16x16x32_bf16 v[244:247], a[112:115], v[104:107], v[244:247]
s_waitcnt lgkmcnt(7)
v_cmp_nge_f32 vcc, s25, v27
v_mfma_f32_16x16x32_bf16 v[248:251], a[120:123], v[96:99], v[248:251]
s_waitcnt lgkmcnt(6)
ds_read_b128 a[88:91], v1 offset:6144
v_mfma_f32_16x16x32_bf16 v[248:251], a[124:127], v[100:103], v[248:251]
buffer_load_dwordx4 a[56:59], v1, s[4:7], s22 offen offset:2048 sc1
v_mfma_f32_16x16x32_bf16 v[252:255], a[124:127], v[108:111], v[252:255]
ds_read_b128 a[92:95], v1 offset:7168
v_mfma_f32_16x16x32_bf16 v[252:255], a[120:123], v[104:107], v[252:255]
s_waitcnt lgkmcnt(2)
buffer_load_dwordx4 a[60:63], v1, s[4:7], s22 offen offset:3072 sc1
s_cbranch_vccnz Lstub_11
Lback_12:
v_mfma_f32_16x16x32_bf16 v[132:135], a[64:67], v[120:123], v[132:135]
s_mov_b64 s[36:37], s[86:87]
ds_read_b128 a[96:99], v1 offset:8192
v_add_f32 v25, v25, v27
v_mfma_f32_16x16x32_bf16 v[132:135], a[68:71], v[124:127], v[132:135]
s_mov_b32 s38, 3670016
ds_read_b128 a[100:103], v1 offset:9216
v_accvgpr_read_b32 v112, a184
v_mfma_f32_16x16x32_bf16 v[140:143], a[72:75], v[120:123], v[140:143]
s_mov_b32 s39, 0x20000
ds_read_b128 a[104:107], v1 offset:10240
v_accvgpr_read_b32 v113, a185
v_mfma_f32_16x16x32_bf16 v[140:143], a[76:79], v[124:127], v[140:143]
s_lshl_b32 s8, s29, 3
ds_read_b128 a[108:111], v1 offset:11264
v_accvgpr_read_b32 v114, a186
v_mfma_f32_16x16x32_bf16 v[148:151], a[80:83], v[120:123], v[148:151]
s_add_u32 s8, s8, s3
ds_read_b128 a[112:115], v1 offset:12288
v_accvgpr_read_b32 v115, a187
v_mfma_f32_16x16x32_bf16 v[148:151], a[84:87], v[124:127], v[148:151]
s_waitcnt lgkmcnt(3)
s_lshl_b32 s8, s8, 4
ds_read_b128 a[116:119], v1 offset:13312
v_accvgpr_read_b32 v116, a188
v_mfma_f32_16x16x32_bf16 v[156:159], a[88:91], v[120:123], v[156:159]
s_add_u32 s8, s8, s20
ds_read_b128 a[120:123], v1 offset:14336
v_accvgpr_read_b32 v117, a189
v_mfma_f32_16x16x32_bf16 v[156:159], a[92:95], v[124:127], v[156:159]
s_mul_i32 s8, s8, 14336
ds_read_b128 a[124:127], v1 offset:15360
v_accvgpr_read_b32 v118, a190
v_mfma_f32_16x16x32_bf16 v[164:167], a[96:99], v[120:123], v[164:167]
s_add_u32 s8, s8, 104857600
ds_read_b128 a[64:67], v1 offset:16384
v_accvgpr_read_b32 v119, a191
v_mfma_f32_16x16x32_bf16 v[164:167], a[100:103], v[124:127], v[164:167]
s_waitcnt lgkmcnt(6)
s_add_u32 s12, s8, 917504
ds_read_b128 a[68:71], v1 offset:17408
v_mfma_f32_16x16x32_bf16 v[172:175], a[104:107], v[120:123], v[172:175]
s_waitcnt lgkmcnt(6)
ds_read_b128 a[72:75], v1 offset:18432
v_mfma_f32_16x16x32_bf16 v[172:175], a[108:111], v[124:127], v[172:175]
s_waitcnt lgkmcnt(6)
ds_read_b128 a[76:79], v1 offset:19456
v_mfma_f32_16x16x32_bf16 v[180:183], a[112:115], v[120:123], v[180:183]
s_waitcnt lgkmcnt(6)
ds_read_b128 a[80:83], v1 offset:20480
v_mfma_f32_16x16x32_bf16 v[180:183], a[116:119], v[124:127], v[180:183]
s_waitcnt lgkmcnt(6)
ds_read_b128 a[84:87], v1 offset:21504
v_mfma_f32_16x16x32_bf16 v[188:191], a[120:123], v[120:123], v[188:191]
s_waitcnt lgkmcnt(6)
ds_read_b128 a[88:91], v1 offset:22528
v_mfma_f32_16x16x32_bf16 v[188:191], a[124:127], v[124:127], v[188:191]
s_waitcnt lgkmcnt(6)
ds_read_b128 a[92:95], v1 offset:23552
v_mfma_f32_16x16x32_bf16 v[196:199], a[64:67], v[120:123], v[196:199]
s_waitcnt lgkmcnt(6)
ds_read_b128 a[96:99], v1 offset:24576
v_mfma_f32_16x16x32_bf16 v[196:199], a[68:71], v[124:127], v[196:199]
s_waitcnt lgkmcnt(6)
ds_read_b128 a[100:103], v1 offset:25600
v_mfma_f32_16x16x32_bf16 v[204:207], a[72:75], v[120:123], v[204:207]
s_waitcnt lgkmcnt(6)
ds_read_b128 a[104:107], v1 offset:26624
v_mfma_f32_16x16x32_bf16 v[204:207], a[76:79], v[124:127], v[204:207]
s_waitcnt lgkmcnt(6)
ds_read_b128 a[108:111], v1 offset:27648
v_mfma_f32_16x16x32_bf16 v[212:215], a[80:83], v[120:123], v[212:215]
s_waitcnt lgkmcnt(6)
ds_read_b128 a[112:115], v1 offset:28672
v_mfma_f32_16x16x32_bf16 v[212:215], a[84:87], v[124:127], v[212:215]
s_waitcnt lgkmcnt(6)
ds_read_b128 a[116:119], v1 offset:29696
v_mfma_f32_16x16x32_bf16 v[220:223], a[88:91], v[120:123], v[220:223]
s_waitcnt lgkmcnt(6)
s_add_u32 m0, s18, 32768
ds_read_b128 a[120:123], v1 offset:30720
v_mfma_f32_16x16x32_bf16 v[220:223], a[92:95], v[124:127], v[220:223]
s_waitcnt lgkmcnt(6)
ds_read_b128 a[124:127], v1 offset:31744
v_mfma_f32_16x16x32_bf16 v[228:231], a[96:99], v[120:123], v[228:231]
s_waitcnt lgkmcnt(6)
buffer_load_dwordx4 v112, s[36:39], s81 offen offset:0 lds
v_mfma_f32_16x16x32_bf16 v[228:231], a[100:103], v[124:127], v[228:231]
s_waitcnt lgkmcnt(5)
buffer_load_dwordx4 v113, s[36:39], s81 offen offset:1024 lds
v_mfma_f32_16x16x32_bf16 v[236:239], a[104:107], v[120:123], v[236:239]
s_waitcnt lgkmcnt(4)
buffer_load_dwordx4 v114, s[36:39], s81 offen offset:2048 lds
v_mfma_f32_16x16x32_bf16 v[236:239], a[108:111], v[124:127], v[236:239]
s_waitcnt lgkmcnt(3)
buffer_load_dwordx4 v115, s[36:39], s81 offen offset:3072 lds
v_mfma_f32_16x16x32_bf16 v[244:247], a[112:115], v[120:123], v[244:247]
s_waitcnt lgkmcnt(2)
s_add_u32 s81, s81, 28672
v_mfma_f32_16x16x32_bf16 v[244:247], a[116:119], v[124:127], v[244:247]
s_waitcnt lgkmcnt(1)
s_add_u32 m0, s18, 36864
v_mfma_f32_16x16x32_bf16 v[252:255], a[120:123], v[120:123], v[252:255]
s_waitcnt lgkmcnt(0)
buffer_load_dwordx4 v112, s[36:39], s81 offen offset:0 lds
v_mfma_f32_16x16x32_bf16 v[252:255], a[124:127], v[124:127], v[252:255]
buffer_load_dwordx4 v113, s[36:39], s81 offen offset:1024 lds
buffer_load_dwordx4 v114, s[36:39], s81 offen offset:2048 lds
buffer_load_dwordx4 v115, s[36:39], s81 offen offset:3072 lds
s_sub_u32 s81, s81, 28544
s_waitcnt vmcnt(8)
v_sub_f32 v8, v16, v28
v_sub_f32 v10, v20, v30
v_max_f32 v9, v8, v10
v_cmp_lt_f32 vcc, 1114636288, v9
s_cbranch_vccnz K2_cfix
K2_cok:
v_exp_f32 v8, v8
v_exp_f32 v10, v10
s_nop 0
v_mov_b32 v9, v8
v_mov_b32 v11, v10
v_fmac_f32 v24, v8, v29
v_fmac_f32 v25, v10, v31
s_mov_b32 s23, 0xffff0000
v_lshlrev_b32 v64, 16, v32
v_and_b32 v65, s23, v32
v_lshlrev_b32 v66, 16, v33
v_and_b32 v67, s23, v33
v_lshlrev_b32 v68, 16, v34
v_and_b32 v69, s23, v34
v_lshlrev_b32 v70, 16, v35
v_and_b32 v71, s23, v35
v_pk_fma_f32 v[128:129], v[64:65], v[8:9], v[128:129]
v_pk_fma_f32 v[130:131], v[66:67], v[8:9], v[130:131]
v_pk_fma_f32 v[136:137], v[68:69], v[8:9], v[136:137]
v_pk_fma_f32 v[138:139], v[70:71], v[8:9], v[138:139]
v_cvt_pk_bf16_f32 v128, v128, v129
v_cvt_pk_bf16_f32 v129, v130, v131
v_cvt_pk_bf16_f32 v130, v136, v137
v_cvt_pk_bf16_f32 v131, v138, v139
s_add_u32 m0, s18, 98304
s_nop 0
buffer_load_dwordx4 v112, s[36:39], s81 offen offset:0 lds
v_lshlrev_b32 v64, 16, v36
v_and_b32 v65, s23, v36
v_lshlrev_b32 v66, 16, v37
v_and_b32 v67, s23, v37
v_lshlrev_b32 v68, 16, v38
v_and_b32 v69, s23, v38
v_lshlrev_b32 v70, 16, v39
v_and_b32 v71, s23, v39
v_pk_fma_f32 v[144:145], v[64:65], v[8:9], v[144:145]
v_pk_fma_f32 v[146:147], v[66:67], v[8:9], v[146:147]
v_pk_fma_f32 v[152:153], v[68:69], v[8:9], v[152:153]
v_pk_fma_f32 v[154:155], v[70:71], v[8:9], v[154:155]
v_cvt_pk_bf16_f32 v144, v144, v145
v_cvt_pk_bf16_f32 v145, v146, v147
v_cvt_pk_bf16_f32 v146, v152, v153
v_cvt_pk_bf16_f32 v147, v154, v155
buffer_load_dwordx4 v113, s[36:39], s81 offen offset:1024 lds
v_lshlrev_b32 v64, 16, v40
v_and_b32 v65, s23, v40
v_lshlrev_b32 v66, 16, v41
v_and_b32 v67, s23, v41
v_lshlrev_b32 v68, 16, v42
v_and_b32 v69, s23, v42
v_lshlrev_b32 v70, 16, v43
v_and_b32 v71, s23, v43
v_pk_fma_f32 v[160:161], v[64:65], v[8:9], v[160:161]
v_pk_fma_f32 v[162:163], v[66:67], v[8:9], v[162:163]
v_pk_fma_f32 v[168:169], v[68:69], v[8:9], v[168:169]
v_pk_fma_f32 v[170:171], v[70:71], v[8:9], v[170:171]
v_cvt_pk_bf16_f32 v160, v160, v161
v_cvt_pk_bf16_f32 v161, v162, v163
v_cvt_pk_bf16_f32 v162, v168, v169
v_cvt_pk_bf16_f32 v163, v170, v171
buffer_load_dwordx4 v114, s[36:39], s81 offen offset:2048 lds
v_lshlrev_b32 v64, 16, v44
v_and_b32 v65, s23, v44
v_lshlrev_b32 v66, 16, v45
v_and_b32 v67, s23, v45
v_lshlrev_b32 v68, 16, v46
v_and_b32 v69, s23, v46
v_lshlrev_b32 v70, 16, v47
v_and_b32 v71, s23, v47
v_pk_fma_f32 v[176:177], v[64:65], v[8:9], v[176:177]
v_pk_fma_f32 v[178:179], v[66:67], v[8:9], v[178:179]
v_pk_fma_f32 v[184:185], v[68:69], v[8:9], v[184:185]
v_pk_fma_f32 v[186:187], v[70:71], v[8:9], v[186:187]
v_cvt_pk_bf16_f32 v176, v176, v177
v_cvt_pk_bf16_f32 v177, v178, v179
v_cvt_pk_bf16_f32 v178, v184, v185
v_cvt_pk_bf16_f32 v179, v186, v187
buffer_load_dwordx4 v115, s[36:39], s81 offen offset:3072 lds
v_lshlrev_b32 v64, 16, v48
v_and_b32 v65, s23, v48
v_lshlrev_b32 v66, 16, v49
v_and_b32 v67, s23, v49
v_lshlrev_b32 v68, 16, v50
v_and_b32 v69, s23, v50
v_lshlrev_b32 v70, 16, v51
v_and_b32 v71, s23, v51
v_pk_fma_f32 v[192:193], v[64:65], v[8:9], v[192:193]
v_pk_fma_f32 v[194:195], v[66:67], v[8:9], v[194:195]
v_pk_fma_f32 v[200:201], v[68:69], v[8:9], v[200:201]
v_pk_fma_f32 v[202:203], v[70:71], v[8:9], v[202:203]
v_cvt_pk_bf16_f32 v192, v192, v193
v_cvt_pk_bf16_f32 v193, v194, v195
v_cvt_pk_bf16_f32 v194, v200, v201
v_cvt_pk_bf16_f32 v195, v202, v203
s_add_u32 s81, s81, 28672
s_add_u32 m0, s18, 102400
s_nop 0
buffer_load_dwordx4 v112, s[36:39], s81 offen offset:0 lds
v_lshlrev_b32 v64, 16, v52
v_and_b32 v65, s23, v52
v_lshlrev_b32 v66, 16, v53
v_and_b32 v67, s23, v53
v_lshlrev_b32 v68, 16, v54
v_and_b32 v69, s23, v54
v_lshlrev_b32 v70, 16, v55
v_and_b32 v71, s23, v55
v_pk_fma_f32 v[208:209], v[64:65], v[8:9], v[208:209]
v_pk_fma_f32 v[210:211], v[66:67], v[8:9], v[210:211]
v_pk_fma_f32 v[216:217], v[68:69], v[8:9], v[216:217]
v_pk_fma_f32 v[218:219], v[70:71], v[8:9], v[218:219]
v_cvt_pk_bf16_f32 v208, v208, v209
v_cvt_pk_bf16_f32 v209, v210, v211
v_cvt_pk_bf16_f32 v210, v216, v217
v_cvt_pk_bf16_f32 v211, v218, v219
buffer_load_dwordx4 v113, s[36:39], s81 offen offset:1024 lds
v_lshlrev_b32 v64, 16, v56
v_and_b32 v65, s23, v56
v_lshlrev_b32 v66, 16, v57
v_and_b32 v67, s23, v57
v_lshlrev_b32 v68, 16, v58
v_and_b32 v69, s23, v58
v_lshlrev_b32 v70, 16, v59
v_and_b32 v71, s23, v59
v_pk_fma_f32 v[224:225], v[64:65], v[8:9], v[224:225]
v_pk_fma_f32 v[226:227], v[66:67], v[8:9], v[226:227]
v_pk_fma_f32 v[232:233], v[68:69], v[8:9], v[232:233]
v_pk_fma_f32 v[234:235], v[70:71], v[8:9], v[234:235]
v_cvt_pk_bf16_f32 v224, v224, v225
v_cvt_pk_bf16_f32 v225, v226, v227
v_cvt_pk_bf16_f32 v226, v232, v233
v_cvt_pk_bf16_f32 v227, v234, v235
buffer_load_dwordx4 v114, s[36:39], s81 offen offset:2048 lds
v_lshlrev_b32 v64, 16, v60
v_and_b32 v65, s23, v60
v_lshlrev_b32 v66, 16, v61
v_and_b32 v67, s23, v61
v_lshlrev_b32 v68, 16, v62
v_and_b32 v69, s23, v62
v_lshlrev_b32 v70, 16, v63
v_and_b32 v71, s23, v63
v_pk_fma_f32 v[240:241], v[64:65], v[8:9], v[240:241]
v_pk_fma_f32 v[242:243], v[66:67], v[8:9], v[242:243]
v_pk_fma_f32 v[248:249], v[68:69], v[8:9], v[248:249]
v_pk_fma_f32 v[250:251], v[70:71], v[8:9], v[250:251]
v_cvt_pk_bf16_f32 v240, v240, v241
v_cvt_pk_bf16_f32 v241, v242, v243
v_cvt_pk_bf16_f32 v242, v248, v249
v_cvt_pk_bf16_f32 v243, v250, v251
buffer_load_dwordx4 v115, s[36:39], s81 offen offset:3072 lds
v_accvgpr_read_b32 v32, a32
v_accvgpr_read_b32 v33, a33
v_accvgpr_read_b32 v34, a34
v_accvgpr_read_b32 v35, a35
v_lshlrev_b32 v64, 16, v32
v_and_b32 v65, s23, v32
v_lshlrev_b32 v66, 16, v33
v_and_b32 v67, s23, v33
v_lshlrev_b32 v68, 16, v34
v_and_b32 v69, s23, v34
v_lshlrev_b32 v70, 16, v35
v_and_b32 v71, s23, v35
v_pk_fma_f32 v[132:133], v[64:65], v[10:11], v[132:133]
v_pk_fma_f32 v[134:135], v[66:67], v[10:11], v[134:135]
v_pk_fma_f32 v[140:141], v[68:69], v[10:11], v[140:141]
v_pk_fma_f32 v[142:143], v[70:71], v[10:11], v[142:143]
v_cvt_pk_bf16_f32 v132, v132, v133
v_cvt_pk_bf16_f32 v133, v134, v135
v_cvt_pk_bf16_f32 v134, v140, v141
v_cvt_pk_bf16_f32 v135, v142, v143
s_sub_u32 s81, s81, 28544
s_add_u32 m0, s18, 131072
s_nop 0
buffer_load_dwordx4 v112, s[36:39], s81 offen offset:0 lds
v_accvgpr_read_b32 v36, a36
v_accvgpr_read_b32 v37, a37
v_accvgpr_read_b32 v38, a38
v_accvgpr_read_b32 v39, a39
v_lshlrev_b32 v64, 16, v36
v_and_b32 v65, s23, v36
v_lshlrev_b32 v66, 16, v37
v_and_b32 v67, s23, v37
v_lshlrev_b32 v68, 16, v38
v_and_b32 v69, s23, v38
v_lshlrev_b32 v70, 16, v39
v_and_b32 v71, s23, v39
v_pk_fma_f32 v[148:149], v[64:65], v[10:11], v[148:149]
v_pk_fma_f32 v[150:151], v[66:67], v[10:11], v[150:151]
v_pk_fma_f32 v[156:157], v[68:69], v[10:11], v[156:157]
v_pk_fma_f32 v[158:159], v[70:71], v[10:11], v[158:159]
v_cvt_pk_bf16_f32 v148, v148, v149
v_cvt_pk_bf16_f32 v149, v150, v151
v_cvt_pk_bf16_f32 v150, v156, v157
v_cvt_pk_bf16_f32 v151, v158, v159
buffer_load_dwordx4 v113, s[36:39], s81 offen offset:1024 lds
v_accvgpr_read_b32 v40, a40
v_accvgpr_read_b32 v41, a41
v_accvgpr_read_b32 v42, a42
v_accvgpr_read_b32 v43, a43
v_lshlrev_b32 v64, 16, v40
v_and_b32 v65, s23, v40
v_lshlrev_b32 v66, 16, v41
v_and_b32 v67, s23, v41
v_lshlrev_b32 v68, 16, v42
v_and_b32 v69, s23, v42
v_lshlrev_b32 v70, 16, v43
v_and_b32 v71, s23, v43
v_pk_fma_f32 v[164:165], v[64:65], v[10:11], v[164:165]
v_pk_fma_f32 v[166:167], v[66:67], v[10:11], v[166:167]
v_pk_fma_f32 v[172:173], v[68:69], v[10:11], v[172:173]
v_pk_fma_f32 v[174:175], v[70:71], v[10:11], v[174:175]
v_cvt_pk_bf16_f32 v164, v164, v165
v_cvt_pk_bf16_f32 v165, v166, v167
v_cvt_pk_bf16_f32 v166, v172, v173
v_cvt_pk_bf16_f32 v167, v174, v175
buffer_load_dwordx4 v114, s[36:39], s81 offen offset:2048 lds
v_accvgpr_read_b32 v44, a44
v_accvgpr_read_b32 v45, a45
v_accvgpr_read_b32 v46, a46
v_accvgpr_read_b32 v47, a47
v_lshlrev_b32 v64, 16, v44
v_and_b32 v65, s23, v44
v_lshlrev_b32 v66, 16, v45
v_and_b32 v67, s23, v45
v_lshlrev_b32 v68, 16, v46
v_and_b32 v69, s23, v46
v_lshlrev_b32 v70, 16, v47
v_and_b32 v71, s23, v47
v_pk_fma_f32 v[180:181], v[64:65], v[10:11], v[180:181]
v_pk_fma_f32 v[182:183], v[66:67], v[10:11], v[182:183]
v_pk_fma_f32 v[188:189], v[68:69], v[10:11], v[188:189]
v_pk_fma_f32 v[190:191], v[70:71], v[10:11], v[190:191]
v_cvt_pk_bf16_f32 v180, v180, v181
v_cvt_pk_bf16_f32 v181, v182, v183
v_cvt_pk_bf16_f32 v182, v188, v189
v_cvt_pk_bf16_f32 v183, v190, v191
buffer_load_dwordx4 v115, s[36:39], s81 offen offset:3072 lds
v_accvgpr_read_b32 v48, a48
v_accvgpr_read_b32 v49, a49
v_accvgpr_read_b32 v50, a50
v_accvgpr_read_b32 v51, a51
v_lshlrev_b32 v64, 16, v48
v_and_b32 v65, s23, v48
v_lshlrev_b32 v66, 16, v49
v_and_b32 v67, s23, v49
v_lshlrev_b32 v68, 16, v50
v_and_b32 v69, s23, v50
v_lshlrev_b32 v70, 16, v51
v_and_b32 v71, s23, v51
v_pk_fma_f32 v[196:197], v[64:65], v[10:11], v[196:197]
v_pk_fma_f32 v[198:199], v[66:67], v[10:11], v[198:199]
v_pk_fma_f32 v[204:205], v[68:69], v[10:11], v[204:205]
v_pk_fma_f32 v[206:207], v[70:71], v[10:11], v[206:207]
v_cvt_pk_bf16_f32 v196, v196, v197
v_cvt_pk_bf16_f32 v197, v198, v199
v_cvt_pk_bf16_f32 v198, v204, v205
v_cvt_pk_bf16_f32 v199, v206, v207
s_add_u32 s81, s81, 28672
s_add_u32 m0, s18, 135168
s_nop 0
buffer_load_dwordx4 v112, s[36:39], s81 offen offset:0 lds
v_accvgpr_read_b32 v52, a52
v_accvgpr_read_b32 v53, a53
v_accvgpr_read_b32 v54, a54
v_accvgpr_read_b32 v55, a55
v_lshlrev_b32 v64, 16, v52
v_and_b32 v65, s23, v52
v_lshlrev_b32 v66, 16, v53
v_and_b32 v67, s23, v53
v_lshlrev_b32 v68, 16, v54
v_and_b32 v69, s23, v54
v_lshlrev_b32 v70, 16, v55
v_and_b32 v71, s23, v55
v_pk_fma_f32 v[212:213], v[64:65], v[10:11], v[212:213]
v_pk_fma_f32 v[214:215], v[66:67], v[10:11], v[214:215]
v_pk_fma_f32 v[220:221], v[68:69], v[10:11], v[220:221]
v_pk_fma_f32 v[222:223], v[70:71], v[10:11], v[222:223]
v_cvt_pk_bf16_f32 v212, v212, v213
v_cvt_pk_bf16_f32 v213, v214, v215
v_cvt_pk_bf16_f32 v214, v220, v221
v_cvt_pk_bf16_f32 v215, v222, v223
buffer_load_dwordx4 v113, s[36:39], s81 offen offset:1024 lds
v_accvgpr_read_b32 v56, a56
v_accvgpr_read_b32 v57, a57
v_accvgpr_read_b32 v58, a58
v_accvgpr_read_b32 v59, a59
v_lshlrev_b32 v64, 16, v56
v_and_b32 v65, s23, v56
v_lshlrev_b32 v66, 16, v57
v_and_b32 v67, s23, v57
v_lshlrev_b32 v68, 16, v58
v_and_b32 v69, s23, v58
v_lshlrev_b32 v70, 16, v59
v_and_b32 v71, s23, v59
v_pk_fma_f32 v[228:229], v[64:65], v[10:11], v[228:229]
v_pk_fma_f32 v[230:231], v[66:67], v[10:11], v[230:231]
v_pk_fma_f32 v[236:237], v[68:69], v[10:11], v[236:237]
v_pk_fma_f32 v[238:239], v[70:71], v[10:11], v[238:239]
v_cvt_pk_bf16_f32 v228, v228, v229
v_cvt_pk_bf16_f32 v229, v230, v231
v_cvt_pk_bf16_f32 v230, v236, v237
v_cvt_pk_bf16_f32 v231, v238, v239
buffer_load_dwordx4 v114, s[36:39], s81 offen offset:2048 lds
v_accvgpr_read_b32 v60, a60
v_accvgpr_read_b32 v61, a61
v_accvgpr_read_b32 v62, a62
v_accvgpr_read_b32 v63, a63
v_lshlrev_b32 v64, 16, v60
v_and_b32 v65, s23, v60
v_lshlrev_b32 v66, 16, v61
v_and_b32 v67, s23, v61
v_lshlrev_b32 v68, 16, v62
v_and_b32 v69, s23, v62
v_lshlrev_b32 v70, 16, v63
v_and_b32 v71, s23, v63
v_pk_fma_f32 v[244:245], v[64:65], v[10:11], v[244:245]
v_pk_fma_f32 v[246:247], v[66:67], v[10:11], v[246:247]
v_pk_fma_f32 v[252:253], v[68:69], v[10:11], v[252:253]
v_pk_fma_f32 v[254:255], v[70:71], v[10:11], v[254:255]
v_cvt_pk_bf16_f32 v244, v244, v245
v_cvt_pk_bf16_f32 v245, v246, v247
v_cvt_pk_bf16_f32 v246, v252, v253
v_cvt_pk_bf16_f32 v247, v254, v255
buffer_load_dwordx4 v115, s[36:39], s81 offen offset:3072 lds
s_sub_u32 s81, s81, 28544
K2_done:
s_waitcnt vmcnt(16)
s_barrier
ds_read_b64_tr_b16 a[64:65], v116 offset:0
ds_read_b64_tr_b16 a[66:67], v116 offset:2048
ds_read_b64_tr_b16 a[68:69], v116 offset:4096
ds_read_b64_tr_b16 a[70:71], v116 offset:6144
ds_read_b64_tr_b16 a[72:73], v116 offset:8192
ds_read_b64_tr_b16 a[74:75], v116 offset:10240
ds_read_b64_tr_b16 a[76:77], v116 offset:12288
ds_read_b64_tr_b16 a[78:79], v116 offset:14336
ds_read_b64_tr_b16 a[80:81], v116 offset:16384
ds_read_b64_tr_b16 a[82:83], v116 offset:18432
ds_read_b64_tr_b16 a[84:85], v116 offset:20480
ds_read_b64_tr_b16 a[86:87], v116 offset:22528
ds_read_b64_tr_b16 a[88:89], v116 offset:24576
ds_read_b64_tr_b16 a[90:91], v116 offset:26624
ds_read_b64_tr_b16 a[92:93], v116 offset:28672
ds_read_b64_tr_b16 a[94:95], v116 offset:30720
v_add_u32 v116, 65536, v116
s_waitcnt lgkmcnt(14)
v_mfma_f32_16x16x32_bf16 v[32:35], a[64:67], v[128:131], 0
s_waitcnt lgkmcnt(12)
s_add_u32 m0, s18, 65536
ds_read_b64_tr_b16 a[96:97], v117 offset:0
v_mov_b32 v28, v24
v_mfma_f32_16x16x32_bf16 v[32:35], a[68:71], v[144:147], v[32:35]
s_waitcnt lgkmcnt(11)
ds_read_b64_tr_b16 a[98:99], v117 offset:2048
buffer_load_dwordx4 v112, s[36:39], s81 offen offset:0 lds
v_mfma_f32_16x16x32_bf16 v[32:35], a[72:75], v[160:163], v[32:35]
s_waitcnt lgkmcnt(10)
ds_read_b64_tr_b16 a[100:101], v117 offset:4096
v_permlane16_swap_b32 v24, v28
v_mfma_f32_16x16x32_bf16 v[32:35], a[76:79], v[176:179], v[32:35]
s_waitcnt lgkmcnt(9)
ds_read_b64_tr_b16 a[102:103], v117 offset:6144
v_add_f32 v24, v24, v28
v_mfma_f32_16x16x32_bf16 v[32:35], a[80:83], v[192:195], v[32:35]
s_waitcnt lgkmcnt(8)
ds_read_b64_tr_b16 a[104:105], v117 offset:8192
buffer_load_dwordx4 v113, s[36:39], s81 offen offset:1024 lds
v_mfma_f32_16x16x32_bf16 v[32:35], a[84:87], v[208:211], v[32:35]
s_waitcnt lgkmcnt(7)
ds_read_b64_tr_b16 a[106:107], v117 offset:10240
v_mov_b32 v28, v24
v_mfma_f32_16x16x32_bf16 v[32:35], a[88:91], v[224:227], v[32:35]
s_waitcnt lgkmcnt(6)
ds_read_b64_tr_b16 a[108:109], v117 offset:12288
v_lshrrev_b32 v20, 4, v1
v_mfma_f32_16x16x32_bf16 v[32:35], a[92:95], v[240:243], v[32:35]
ds_read_b64_tr_b16 a[110:111], v117 offset:14336
buffer_load_dwordx4 v114, s[36:39], s81 offen offset:2048 lds
v_mfma_f32_16x16x32_bf16 v[36:39], a[64:67], v[132:135], 0
ds_read_b64_tr_b16 a[112:113], v117 offset:16384
v_permlane32_swap_b32 v24, v28
v_mfma_f32_16x16x32_bf16 v[36:39], a[68:71], v[148:151], v[36:39]
ds_read_b64_tr_b16 a[114:115], v117 offset:18432
v_add_f32 v24, v24, v28
v_mfma_f32_16x16x32_bf16 v[36:39], a[72:75], v[164:167], v[36:39]
ds_read_b64_tr_b16 a[116:117], v117 offset:20480
buffer_load_dwordx4 v115, s[36:39], s81 offen offset:3072 lds
v_mfma_f32_16x16x32_bf16 v[36:39], a[76:79], v[180:183], v[36:39]
ds_read_b64_tr_b16 a[118:119], v117 offset:22528
v_mov_b32 v29, v25
v_mfma_f32_16x16x32_bf16 v[36:39], a[80:83], v[196:199], v[36:39]
s_add_u32 s81, s81, 28672
s_add_u32 m0, s18, 69632
ds_read_b64_tr_b16 a[120:121], v117 offset:24576
v_mfma_f32_16x16x32_bf16 v[36:39], a[84:87], v[212:215], v[36:39]
ds_read_b64_tr_b16 a[122:123], v117 offset:26624
buffer_load_dwordx4 v112, s[36:39], s81 offen offset:0 lds
v_mfma_f32_16x16x32_bf16 v[36:39], a[88:91], v[228:231], v[36:39]
ds_read_b64_tr_b16 a[124:125], v117 offset:28672
v_permlane16_swap_b32 v25, v29
v_mfma_f32_16x16x32_bf16 v[36:39], a[92:95], v[244:247], v[36:39]
s_waitcnt lgkmcnt(13)
ds_read_b64_tr_b16 a[126:127], v117 offset:30720
v_add_u32 v117, 65536, v117
v_mfma_f32_16x16x32_bf16 v[40:43], a[96:99], v[128:131], 0
s_waitcnt lgkmcnt(12)
ds_read_b64_tr_b16 a[64:65], v118 offset:0
buffer_load_dwordx4 v113, s[36:39], s81 offen offset:1024 lds
v_mfma_f32_16x16x32_bf16 v[40:43], a[100:103], v[144:147], v[40:43]
s_waitcnt lgkmcnt(11)
ds_read_b64_tr_b16 a[66:67], v118 offset:2048
v_add_f32 v25, v25, v29
v_mfma_f32_16x16x32_bf16 v[40:43], a[104:107], v[160:163], v[40:43]
s_waitcnt lgkmcnt(10)
ds_read_b64_tr_b16 a[68:69], v118 offset:4096
v_mov_b32 v29, v25
v_mfma_f32_16x16x32_bf16 v[40:43], a[108:111], v[176:179], v[40:43]
s_waitcnt lgkmcnt(9)
ds_read_b64_tr_b16 a[70:71], v118 offset:6144
buffer_load_dwordx4 v114, s[36:39], s81 offen offset:2048 lds
v_mfma_f32_16x16x32_bf16 v[40:43], a[112:115], v[192:195], v[40:43]
s_waitcnt lgkmcnt(8)
ds_read_b64_tr_b16 a[72:73], v118 offset:8192
v_permlane32_swap_b32 v25, v29
v_mfma_f32_16x16x32_bf16 v[40:43], a[116:119], v[208:211], v[40:43]
s_waitcnt lgkmcnt(7)
ds_read_b64_tr_b16 a[74:75], v118 offset:10240
v_add_f32 v25, v25, v29
v_mfma_f32_16x16x32_bf16 v[40:43], a[120:123], v[224:227], v[40:43]
s_waitcnt lgkmcnt(6)
ds_read_b64_tr_b16 a[76:77], v118 offset:12288
buffer_load_dwordx4 v115, s[36:39], s81 offen offset:3072 lds
v_mfma_f32_16x16x32_bf16 v[40:43], a[124:127], v[240:243], v[40:43]
ds_read_b64_tr_b16 a[78:79], v118 offset:14336
v_rcp_f32 v24, v24
v_mfma_f32_16x16x32_bf16 v[44:47], a[96:99], v[132:135], 0
s_sub_u32 s81, s81, 28544
s_add_u32 m0, s18, 0
ds_read_b64_tr_b16 a[80:81], v118 offset:16384
v_mfma_f32_16x16x32_bf16 v[44:47], a[100:103], v[148:151], v[44:47]
ds_read_b64_tr_b16 a[82:83], v118 offset:18432
buffer_load_dwordx4 v112, s[36:39], s81 offen offset:0 lds
v_mfma_f32_16x16x32_bf16 v[44:47], a[104:107], v[164:167], v[44:47]
ds_read_b64_tr_b16 a[84:85], v118 offset:20480
v_rcp_f32 v25, v25
v_mfma_f32_16x16x32_bf16 v[44:47], a[108:111], v[180:183], v[44:47]
ds_read_b64_tr_b16 a[86:87], v118 offset:22528
v_and_b32 v19, 15, v20
v_mfma_f32_16x16x32_bf16 v[44:47], a[112:115], v[196:199], v[44:47]
ds_read_b64_tr_b16 a[88:89], v118 offset:24576
buffer_load_dwordx4 v113, s[36:39], s81 offen offset:1024 lds
v_mfma_f32_16x16x32_bf16 v[44:47], a[116:119], v[212:215], v[44:47]
ds_read_b64_tr_b16 a[90:91], v118 offset:26624
v_mul_f32 v32, v32, v24
v_mfma_f32_16x16x32_bf16 v[44:47], a[120:123], v[228:231], v[44:47]
ds_read_b64_tr_b16 a[92:93], v118 offset:28672
v_mul_f32 v33, v33, v24
v_mfma_f32_16x16x32_bf16 v[44:47], a[124:127], v[244:247], v[44:47]
s_waitcnt lgkmcnt(13)
ds_read_b64_tr_b16 a[94:95], v118 offset:30720
v_add_u32 v118, 65536, v118
v_mfma_f32_16x16x32_bf16 v[48:51], a[64:67], v[128:131], 0
s_waitcnt lgkmcnt(12)
ds_read_b64_tr_b16 a[96:97], v119 offset:0
buffer_load_dwordx4 v114, s[36:39], s81 offen offset:2048 lds
v_mfma_f32_16x16x32_bf16 v[48:51], a[68:71], v[144:147], v[48:51]
s_waitcnt lgkmcnt(11)
ds_read_b64_tr_b16 a[98:99], v119 offset:2048
v_mul_f32 v34, v34, v24
v_mfma_f32_16x16x32_bf16 v[48:51], a[72:75], v[160:163], v[48:51]
s_waitcnt lgkmcnt(10)
ds_read_b64_tr_b16 a[100:101], v119 offset:4096
v_mul_f32 v35, v35, v24
v_mfma_f32_16x16x32_bf16 v[48:51], a[76:79], v[176:179], v[48:51]
s_waitcnt lgkmcnt(9)
ds_read_b64_tr_b16 a[102:103], v119 offset:6144
buffer_load_dwordx4 v115, s[36:39], s81 offen offset:3072 lds
v_mfma_f32_16x16x32_bf16 v[48:51], a[80:83], v[192:195], v[48:51]
s_waitcnt lgkmcnt(6)
ds_read_b64_tr_b16 a[104:105], v119 offset:8192
v_mul_f32 v40, v40, v24
v_mfma_f32_16x16x32_bf16 v[48:51], a[84:87], v[208:211], v[48:51]
s_add_u32 s81, s81, 28672
s_add_u32 m0, s18, 4096
ds_read_b64_tr_b16 a[106:107], v119 offset:10240
v_mfma_f32_16x16x32_bf16 v[48:51], a[88:91], v[224:227], v[48:51]
s_waitcnt lgkmcnt(6)
ds_read_b64_tr_b16 a[108:109], v119 offset:12288
buffer_load_dwordx4 v112, s[36:39], s81 offen offset:0 lds
v_mfma_f32_16x16x32_bf16 v[48:51], a[92:95], v[240:243], v[48:51]
ds_read_b64_tr_b16 a[110:111], v119 offset:14336
v_mul_f32 v41, v41, v24
v_mfma_f32_16x16x32_bf16 v[52:55], a[64:67], v[132:135], 0
ds_read_b64_tr_b16 a[112:113], v119 offset:16384
v_mul_f32 v42, v42, v24
v_mfma_f32_16x16x32_bf16 v[52:55], a[68:71], v[148:151], v[52:55]
ds_read_b64_tr_b16 a[114:115], v119 offset:18432
buffer_load_dwordx4 v113, s[36:39], s81 offen offset:1024 lds
v_mfma_f32_16x16x32_bf16 v[52:55], a[72:75], v[164:167], v[52:55]
ds_read_b64_tr_b16 a[116:117], v119 offset:20480
v_mul_f32 v43, v43, v24
v_mfma_f32_16x16x32_bf16 v[52:55], a[76:79], v[180:183], v[52:55]
ds_read_b64_tr_b16 a[118:119], v119 offset:22528
v_cvt_pk_bf16_f32 v32, v32, v33
v_mfma_f32_16x16x32_bf16 v[52:55], a[80:83], v[196:199], v[52:55]
ds_read_b64_tr_b16 a[120:121], v119 offset:24576
buffer_load_dwordx4 v114, s[36:39], s81 offen offset:2048 lds
v_mfma_f32_16x16x32_bf16 v[52:55], a[84:87], v[212:215], v[52:55]
ds_read_b64_tr_b16 a[122:123], v119 offset:26624
v_cvt_pk_bf16_f32 v33, v34, v35
v_mfma_f32_16x16x32_bf16 v[52:55], a[88:91], v[228:231], v[52:55]
ds_read_b64_tr_b16 a[124:125], v119 offset:28672
ds_read_b64_tr_b16 a[126:127], v119 offset:30720
v_mfma_f32_16x16x32_bf16 v[52:55], a[92:95], v[244:247], v[52:55]
s_waitcnt vmcnt(23) lgkmcnt(14)
s_barrier
v_add_u32 v119, 65536, v119
v_mfma_f32_16x16x32_bf16 v[56:59], a[96:99], v[128:131], 0
s_waitcnt lgkmcnt(12)
ds_read_b64_tr_b16 a[64:65], v116 offset:0
buffer_load_dwordx4 v115, s[36:39], s81 offen offset:3072 lds
v_mfma_f32_16x16x32_bf16 v[56:59], a[100:103], v[144:147], v[56:59]
s_waitcnt lgkmcnt(9)
ds_read_b64_tr_b16 a[66:67], v116 offset:2048
v_cvt_pk_bf16_f32 v34, v40, v41
v_mfma_f32_16x16x32_bf16 v[56:59], a[104:107], v[160:163], v[56:59]
s_sub_u32 s81, s81, 28544
ds_read_b64_tr_b16 a[68:69], v116 offset:4096
v_cvt_pk_bf16_f32 v35, v42, v43
v_mfma_f32_16x16x32_bf16 v[56:59], a[108:111], v[176:179], v[56:59]
s_waitcnt lgkmcnt(9)
ds_read_b64_tr_b16 a[70:71], v116 offset:6144
buffer_store_dwordx4 v[32:35], v1, s[4:7], s8 offen offset:0 sc1
v_mfma_f32_16x16x32_bf16 v[56:59], a[112:115], v[192:195], v[56:59]
s_waitcnt lgkmcnt(8)
ds_read_b64_tr_b16 a[72:73], v116 offset:8192
v_mul_f32 v36, v36, v25
v_mfma_f32_16x16x32_bf16 v[56:59], a[116:119], v[208:211], v[56:59]
s_waitcnt lgkmcnt(7)
ds_read_b64_tr_b16 a[74:75], v116 offset:10240
v_mul_f32 v37, v37, v25
v_mfma_f32_16x16x32_bf16 v[56:59], a[120:123], v[224:227], v[56:59]
s_waitcnt lgkmcnt(6)
ds_read_b64_tr_b16 a[76:77], v116 offset:12288
v_mul_f32 v38, v38, v25
v_mfma_f32_16x16x32_bf16 v[56:59], a[124:127], v[240:243], v[56:59]
ds_read_b64_tr_b16 a[78:79], v116 offset:14336
v_mul_f32 v39, v39, v25
v_mfma_f32_16x16x32_bf16 v[60:63], a[96:99], v[132:135], 0
ds_read_b64_tr_b16 a[80:81], v116 offset:16384
v_mul_f32 v44, v44, v25
v_mfma_f32_16x16x32_bf16 v[60:63], a[100:103], v[148:151], v[60:63]
ds_read_b64_tr_b16 a[82:83], v116 offset:18432
v_mul_f32 v45, v45, v25
v_mfma_f32_16x16x32_bf16 v[60:63], a[104:107], v[164:167], v[60:63]
ds_read_b64_tr_b16 a[84:85], v116 offset:20480
v_mul_f32 v46, v46, v25
v_mfma_f32_16x16x32_bf16 v[60:63], a[108:111], v[180:183], v[60:63]
ds_read_b64_tr_b16 a[86:87], v116 offset:22528
v_mul_f32 v47, v47, v25
v_mfma_f32_16x16x32_bf16 v[60:63], a[112:115], v[196:199], v[60:63]
ds_read_b64_tr_b16 a[88:89], v116 offset:24576
v_cvt_pk_bf16_f32 v36, v36, v37
v_mfma_f32_16x16x32_bf16 v[60:63], a[116:119], v[212:215], v[60:63]
ds_read_b64_tr_b16 a[90:91], v116 offset:26624
v_cvt_pk_bf16_f32 v37, v38, v39
v_mfma_f32_16x16x32_bf16 v[60:63], a[120:123], v[228:231], v[60:63]
ds_read_b64_tr_b16 a[92:93], v116 offset:28672
v_cvt_pk_bf16_f32 v38, v44, v45
v_mfma_f32_16x16x32_bf16 v[60:63], a[124:127], v[244:247], v[60:63]
s_waitcnt lgkmcnt(3)
ds_read_b64_tr_b16 a[94:95], v116 offset:30720
v_add_u32 v116, 32768, v116
v_mfma_f32_16x16x32_bf16 v[64:67], a[64:67], v[128:131], 0
s_lshl_b32 s34, s29, 5
ds_read_b64_tr_b16 a[96:97], v117 offset:0
v_cvt_pk_bf16_f32 v39, v46, v47
v_mfma_f32_16x16x32_bf16 v[64:67], a[68:71], v[144:147], v[64:67]
s_add_u32 s34, s34, s20
ds_read_b64_tr_b16 a[98:99], v117 offset:2048
buffer_store_dwordx4 v[36:39], v1, s[4:7], s12 offen offset:0 sc1
v_mfma_f32_16x16x32_bf16 v[64:67], a[72:75], v[160:163], v[64:67]
s_lshl_b32 s34, s34, 2
ds_read_b64_tr_b16 a[100:101], v117 offset:4096
v_mul_f32 v48, v48, v24
v_mfma_f32_16x16x32_bf16 v[64:67], a[76:79], v[176:179], v[64:67]
s_add_u32 s34, s34, 94380032
ds_read_b64_tr_b16 a[102:103], v117 offset:6144
v_mul_f32 v49, v49, v24
v_mfma_f32_16x16x32_bf16 v[64:67], a[80:83], v[192:195], v[64:67]
s_add_u32 s35, s34, 2048
ds_read_b64_tr_b16 a[104:105], v117 offset:8192
v_mul_f32 v50, v50, v24
v_mfma_f32_16x16x32_bf16 v[64:67], a[84:87], v[208:211], v[64:67]
s_waitcnt lgkmcnt(5)
s_mov_b32 s80, s21
ds_read_b64_tr_b16 a[106:107], v117 offset:10240
v_mul_f32 v51, v51, v24
v_mfma_f32_16x16x32_bf16 v[64:67], a[88:91], v[224:227], v[64:67]
s_and_b32 s79, s2, 16
ds_read_b64_tr_b16 a[108:109], v117 offset:12288
v_mul_f32 v56, v56, v24
v_mfma_f32_16x16x32_bf16 v[64:67], a[92:95], v[240:243], v[64:67]
s_xor_b32 s79, s79, 16
ds_read_b64_tr_b16 a[110:111], v117 offset:14336
v_mul_f32 v57, v57, v24
v_mfma_f32_16x16x32_bf16 v[68:71], a[64:67], v[132:135], 0
s_add_u32 s79, s79, s20
ds_read_b64_tr_b16 a[112:113], v117 offset:16384
v_mul_f32 v58, v58, v24
v_mfma_f32_16x16x32_bf16 v[68:71], a[68:71], v[148:151], v[68:71]
s_lshl_b32 s22, s79, 2
ds_read_b64_tr_b16 a[114:115], v117 offset:18432
v_mul_f32 v59, v59, v24
v_mfma_f32_16x16x32_bf16 v[68:71], a[72:75], v[164:167], v[68:71]
s_add_u32 s22, s22, s3
ds_read_b64_tr_b16 a[116:117], v117 offset:20480
v_cvt_pk_bf16_f32 v48, v48, v49
v_mfma_f32_16x16x32_bf16 v[68:71], a[76:79], v[180:183], v[68:71]
s_mul_i32 s25, s22, 28672
ds_read_b64_tr_b16 a[118:119], v117 offset:22528
v_cvt_pk_bf16_f32 v49, v50, v51
v_mfma_f32_16x16x32_bf16 v[68:71], a[80:83], v[196:199], v[68:71]
s_lshl_b32 s23, s80, 6
ds_read_b64_tr_b16 a[120:121], v117 offset:24576
v_cvt_pk_bf16_f32 v50, v56, v57
v_mfma_f32_16x16x32_bf16 v[68:71], a[84:87], v[212:215], v[68:71]
s_add_u32 s25, s25, s23
ds_read_b64_tr_b16 a[122:123], v117 offset:26624
v_cvt_pk_bf16_f32 v51, v58, v59
v_mfma_f32_16x16x32_bf16 v[68:71], a[88:91], v[228:231], v[68:71]
s_mul_i32 s26, s22, 229376
ds_read_b64_tr_b16 a[124:125], v117 offset:28672
buffer_store_dwordx4 v[48:51], v1, s[4:7], s8 offen offset:1024 sc1
v_mfma_f32_16x16x32_bf16 v[68:71], a[92:95], v[244:247], v[68:71]
s_waitcnt lgkmcnt(3)
s_lshl_b32 s23, s80, 10
ds_read_b64_tr_b16 a[126:127], v117 offset:30720
v_add_u32 v117, 32768, v117
v_mfma_f32_16x16x32_bf16 v[72:75], a[96:99], v[128:131], 0
s_add_u32 s26, s26, s23
ds_read_b64_tr_b16 a[64:65], v118 offset:0
v_mul_f32 v52, v52, v25
v_mfma_f32_16x16x32_bf16 v[72:75], a[100:103], v[144:147], v[72:75]
s_add_u32 s26, s26, 104857600
ds_read_b64_tr_b16 a[66:67], v118 offset:2048
v_mul_f32 v53, v53, v25
v_mfma_f32_16x16x32_bf16 v[72:75], a[104:107], v[160:163], v[72:75]
s_lshr_b32 s22, s79, 1
ds_read_b64_tr_b16 a[68:69], v118 offset:4096
v_mul_f32 v54, v54, v25
v_mfma_f32_16x16x32_bf16 v[72:75], a[108:111], v[176:179], v[72:75]
s_lshl_b32 s22, s22, 7
ds_read_b64_tr_b16 a[70:71], v118 offset:6144
v_mul_f32 v55, v55, v25
v_mfma_f32_16x16x32_bf16 v[72:75], a[112:115], v[192:195], v[72:75]
s_add_u32 s33, s22, 94380032
ds_read_b64_tr_b16 a[72:73], v118 offset:8192
v_mul_f32 v60, v60, v25
v_mfma_f32_16x16x32_bf16 v[72:75], a[116:119], v[208:211], v[72:75]
s_waitcnt lgkmcnt(5)
s_mov_b64 s[40:41], s[88:89]
ds_read_b64_tr_b16 a[74:75], v118 offset:10240
v_mul_f32 v61, v61, v25
v_mfma_f32_16x16x32_bf16 v[72:75], a[120:123], v[224:227], v[72:75]
s_mov_b32 s42, 3670016
ds_read_b64_tr_b16 a[76:77], v118 offset:12288
v_mul_f32 v62, v62, v25
v_mfma_f32_16x16x32_bf16 v[72:75], a[124:127], v[240:243], v[72:75]
s_mov_b32 s43, 0x20000
ds_read_b64_tr_b16 a[78:79], v118 offset:14336
v_mul_f32 v63, v63, v25
v_mfma_f32_16x16x32_bf16 v[76:79], a[96:99], v[132:135], 0
ds_read_b64_tr_b16 a[80:81], v118 offset:16384
v_cvt_pk_bf16_f32 v52, v52, v53
v_mfma_f32_16x16x32_bf16 v[76:79], a[100:103], v[148:151], v[76:79]
ds_read_b64_tr_b16 a[82:83], v118 offset:18432
v_cvt_pk_bf16_f32 v53, v54, v55
v_mfma_f32_16x16x32_bf16 v[76:79], a[104:107], v[164:167], v[76:79]
ds_read_b64_tr_b16 a[84:85], v118 offset:20480
v_cvt_pk_bf16_f32 v54, v60, v61
v_mfma_f32_16x16x32_bf16 v[76:79], a[108:111], v[180:183], v[76:79]
ds_read_b64_tr_b16 a[86:87], v118 offset:22528
v_cvt_pk_bf16_f32 v55, v62, v63
v_mfma_f32_16x16x32_bf16 v[76:79], a[112:115], v[196:199], v[76:79]
ds_read_b64_tr_b16 a[88:89], v118 offset:24576
buffer_store_dwordx4 v[52:55], v1, s[4:7], s12 offen offset:1024 sc1
v_mfma_f32_16x16x32_bf16 v[76:79], a[116:119], v[212:215], v[76:79]
ds_read_b64_tr_b16 a[90:91], v118 offset:26624
v_mfma_f32_16x16x32_bf16 v[76:79], a[120:123], v[228:231], v[76:79]
ds_read_b64_tr_b16 a[92:93], v118 offset:28672
v_mul_f32 v64, v64, v24
v_mfma_f32_16x16x32_bf16 v[76:79], a[124:127], v[244:247], v[76:79]
s_waitcnt lgkmcnt(13)
ds_read_b64_tr_b16 a[94:95], v118 offset:30720
v_add_u32 v118, 32768, v118
v_mfma_f32_16x16x32_bf16 v[80:83], a[64:67], v[128:131], 0
s_waitcnt lgkmcnt(12)
ds_read_b64_tr_b16 a[96:97], v119 offset:0
v_mul_f32 v65, v65, v24
v_mfma_f32_16x16x32_bf16 v[80:83], a[68:71], v[144:147], v[80:83]
s_waitcnt lgkmcnt(11)
ds_read_b64_tr_b16 a[98:99], v119 offset:2048
v_mul_f32 v66, v66, v24
v_mfma_f32_16x16x32_bf16 v[80:83], a[72:75], v[160:163], v[80:83]
s_waitcnt lgkmcnt(10)
ds_read_b64_tr_b16 a[100:101], v119 offset:4096
v_mul_f32 v67, v67, v24
v_mfma_f32_16x16x32_bf16 v[80:83], a[76:79], v[176:179], v[80:83]
s_waitcnt lgkmcnt(9)
ds_read_b64_tr_b16 a[102:103], v119 offset:6144
v_mul_f32 v72, v72, v24
v_mfma_f32_16x16x32_bf16 v[80:83], a[80:83], v[192:195], v[80:83]
s_waitcnt lgkmcnt(8)
ds_read_b64_tr_b16 a[104:105], v119 offset:8192
v_mul_f32 v73, v73, v24
v_mfma_f32_16x16x32_bf16 v[80:83], a[84:87], v[208:211], v[80:83]
s_waitcnt lgkmcnt(7)
ds_read_b64_tr_b16 a[106:107], v119 offset:10240
v_mul_f32 v74, v74, v24
v_mfma_f32_16x16x32_bf16 v[80:83], a[88:91], v[224:227], v[80:83]
s_waitcnt lgkmcnt(6)
ds_read_b64_tr_b16 a[108:109], v119 offset:12288
v_mul_f32 v75, v75, v24
v_mfma_f32_16x16x32_bf16 v[80:83], a[92:95], v[240:243], v[80:83]
ds_read_b64_tr_b16 a[110:111], v119 offset:14336
v_cvt_pk_bf16_f32 v64, v64, v65
v_mfma_f32_16x16x32_bf16 v[84:87], a[64:67], v[132:135], 0
ds_read_b64_tr_b16 a[112:113], v119 offset:16384
v_cvt_pk_bf16_f32 v65, v66, v67
v_mfma_f32_16x16x32_bf16 v[84:87], a[68:71], v[148:151], v[84:87]
ds_read_b64_tr_b16 a[114:115], v119 offset:18432
v_cvt_pk_bf16_f32 v66, v72, v73
v_mfma_f32_16x16x32_bf16 v[84:87], a[72:75], v[164:167], v[84:87]
ds_read_b64_tr_b16 a[116:117], v119 offset:20480
v_cvt_pk_bf16_f32 v67, v74, v75
v_mfma_f32_16x16x32_bf16 v[84:87], a[76:79], v[180:183], v[84:87]
ds_read_b64_tr_b16 a[118:119], v119 offset:22528
buffer_store_dwordx4 v[64:67], v1, s[4:7], s8 offen offset:2048 sc1
v_mfma_f32_16x16x32_bf16 v[84:87], a[80:83], v[196:199], v[84:87]
ds_read_b64_tr_b16 a[120:121], v119 offset:24576
v_mul_f32 v68, v68, v25
v_mfma_f32_16x16x32_bf16 v[84:87], a[84:87], v[212:215], v[84:87]
ds_read_b64_tr_b16 a[122:123], v119 offset:26624
v_mul_f32 v69, v69, v25
v_mfma_f32_16x16x32_bf16 v[84:87], a[88:91], v[228:231], v[84:87]
ds_read_b64_tr_b16 a[124:125], v119 offset:28672
ds_read_b64_tr_b16 a[126:127], v119 offset:30720
v_mfma_f32_16x16x32_bf16 v[84:87], a[92:95], v[244:247], v[84:87]
s_waitcnt vmcnt(21) lgkmcnt(14)
s_barrier
v_add_u32 v119, 32768, v119
v_mfma_f32_16x16x32_bf16 v[88:91], a[96:99], v[128:131], 0
s_waitcnt lgkmcnt(12)
ds_read_b64_tr_b16 a[64:65], v116 offset:0
v_mul_f32 v70, v70, v25
v_mfma_f32_16x16x32_bf16 v[88:91], a[100:103], v[144:147], v[88:91]
s_waitcnt lgkmcnt(11)
ds_read_b64_tr_b16 a[66:67], v116 offset:2048
v_mul_f32 v71, v71, v25
v_mfma_f32_16x16x32_bf16 v[88:91], a[104:107], v[160:163], v[88:91]
s_waitcnt lgkmcnt(10)
ds_read_b64_tr_b16 a[68:69], v116 offset:4096
v_mul_f32 v76, v76, v25
v_mfma_f32_16x16x32_bf16 v[88:91], a[108:111], v[176:179], v[88:91]
s_waitcnt lgkmcnt(9)
ds_read_b64_tr_b16 a[70:71], v116 offset:6144
v_mul_f32 v77, v77, v25
v_mfma_f32_16x16x32_bf16 v[88:91], a[112:115], v[192:195], v[88:91]
s_waitcnt lgkmcnt(8)
ds_read_b64_tr_b16 a[72:73], v116 offset:8192
v_mul_f32 v78, v78, v25
v_mfma_f32_16x16x32_bf16 v[88:91], a[116:119], v[208:211], v[88:91]
s_waitcnt lgkmcnt(7)
ds_read_b64_tr_b16 a[74:75], v116 offset:10240
v_mul_f32 v79, v79, v25
v_mfma_f32_16x16x32_bf16 v[88:91], a[120:123], v[224:227], v[88:91]
s_waitcnt lgkmcnt(6)
ds_read_b64_tr_b16 a[76:77], v116 offset:12288
v_cvt_pk_bf16_f32 v68, v68, v69
v_mfma_f32_16x16x32_bf16 v[88:91], a[124:127], v[240:243], v[88:91]
ds_read_b64_tr_b16 a[78:79], v116 offset:14336
v_cvt_pk_bf16_f32 v69, v70, v71
v_mfma_f32_16x16x32_bf16 v[92:95], a[96:99], v[132:135], 0
ds_read_b64_tr_b16 a[80:81], v116 offset:16384
v_cvt_pk_bf16_f32 v70, v76, v77
v_mfma_f32_16x16x32_bf16 v[92:95], a[100:103], v[148:151], v[92:95]
ds_read_b64_tr_b16 a[82:83], v116 offset:18432
v_cvt_pk_bf16_f32 v71, v78, v79
v_mfma_f32_16x16x32_bf16 v[92:95], a[104:107], v[164:167], v[92:95]
ds_read_b64_tr_b16 a[84:85], v116 offset:20480
buffer_store_dwordx4 v[68:71], v1, s[4:7], s12 offen offset:2048 sc1
v_mfma_f32_16x16x32_bf16 v[92:95], a[108:111], v[180:183], v[92:95]
ds_read_b64_tr_b16 a[86:87], v116 offset:22528
v_mfma_f32_16x16x32_bf16 v[92:95], a[112:115], v[196:199], v[92:95]
ds_read_b64_tr_b16 a[88:89], v116 offset:24576
v_mfma_f32_16x16x32_bf16 v[92:95], a[116:119], v[212:215], v[92:95]
ds_read_b64_tr_b16 a[90:91], v116 offset:26624
v_mfma_f32_16x16x32_bf16 v[92:95], a[120:123], v[228:231], v[92:95]
ds_read_b64_tr_b16 a[92:93], v116 offset:28672
v_mfma_f32_16x16x32_bf16 v[92:95], a[124:127], v[244:247], v[92:95]
s_waitcnt lgkmcnt(11)
ds_read_b64_tr_b16 a[94:95], v116 offset:30720
v_add_u32 v116, 4294901760, v116
v_mfma_f32_16x16x32_bf16 v[32:35], a[64:67], v[128:131], 0
s_add_u32 m0, s18, 32768
ds_read_b64_tr_b16 a[96:97], v117 offset:0
v_mul_f32 v80, v80, v24
v_mfma_f32_16x16x32_bf16 v[32:35], a[68:71], v[144:147], v[32:35]
s_waitcnt lgkmcnt(11)
ds_read_b64_tr_b16 a[98:99], v117 offset:2048
buffer_load_dwordx4 v112, s[36:39], s81 offen offset:0 lds
v_mfma_f32_16x16x32_bf16 v[32:35], a[72:75], v[160:163], v[32:35]
s_waitcnt lgkmcnt(10)
ds_read_b64_tr_b16 a[100:101], v117 offset:4096
v_mul_f32 v81, v81, v24
v_mfma_f32_16x16x32_bf16 v[32:35], a[76:79], v[176:179], v[32:35]
s_waitcnt lgkmcnt(9)
ds_read_b64_tr_b16 a[102:103], v117 offset:6144
v_mul_f32 v82, v82, v24
v_mfma_f32_16x16x32_bf16 v[32:35], a[80:83], v[192:195], v[32:35]
s_waitcnt lgkmcnt(8)
ds_read_b64_tr_b16 a[104:105], v117 offset:8192
v_mul_f32 v83, v83, v24
v_mfma_f32_16x16x32_bf16 v[32:35], a[84:87], v[208:211], v[32:35]
s_waitcnt lgkmcnt(7)
ds_read_b64_tr_b16 a[106:107], v117 offset:10240
v_mul_f32 v88, v88, v24
v_mfma_f32_16x16x32_bf16 v[32:35], a[88:91], v[224:227], v[32:35]
s_waitcnt lgkmcnt(6)
ds_read_b64_tr_b16 a[108:109], v117 offset:12288
v_mul_f32 v89, v89, v24
v_mfma_f32_16x16x32_bf16 v[32:35], a[92:95], v[240:243], v[32:35]
ds_read_b64_tr_b16 a[110:111], v117 offset:14336
v_mul_f32 v90, v90, v24
v_mfma_f32_16x16x32_bf16 v[36:39], a[64:67], v[132:135], 0
ds_read_b64_tr_b16 a[112:113], v117 offset:16384
buffer_load_dwordx4 v113, s[36:39], s81 offen offset:1024 lds
v_mfma_f32_16x16x32_bf16 v[36:39], a[68:71], v[148:151], v[36:39]
ds_read_b64_tr_b16 a[114:115], v117 offset:18432
v_mul_f32 v91, v91, v24
v_mfma_f32_16x16x32_bf16 v[36:39], a[72:75], v[164:167], v[36:39]
ds_read_b64_tr_b16 a[116:117], v117 offset:20480
v_cvt_pk_bf16_f32 v80, v80, v81
v_mfma_f32_16x16x32_bf16 v[36:39], a[76:79], v[180:183], v[36:39]
ds_read_b64_tr_b16 a[118:119], v117 offset:22528
v_cvt_pk_bf16_f32 v81, v82, v83
v_mfma_f32_16x16x32_bf16 v[36:39], a[80:83], v[196:199], v[36:39]
ds_read_b64_tr_b16 a[120:121], v117 offset:24576
v_cvt_pk_bf16_f32 v82, v88, v89
v_mfma_f32_16x16x32_bf16 v[36:39], a[84:87], v[212:215], v[36:39]
ds_read_b64_tr_b16 a[122:123], v117 offset:26624
v_cvt_pk_bf16_f32 v83, v90, v91
v_mfma_f32_16x16x32_bf16 v[36:39], a[88:91], v[228:231], v[36:39]
ds_read_b64_tr_b16 a[124:125], v117 offset:28672
buffer_store_dwordx4 v[80:83], v1, s[4:7], s8 offen offset:3072 sc1
v_mfma_f32_16x16x32_bf16 v[36:39], a[92:95], v[244:247], v[36:39]
s_waitcnt lgkmcnt(13)
ds_read_b64_tr_b16 a[126:127], v117 offset:30720
v_add_u32 v117, 4294901760, v117
v_mfma_f32_16x16x32_bf16 v[40:43], a[96:99], v[128:131], 0
s_waitcnt lgkmcnt(12)
ds_read_b64_tr_b16 a[64:65], v118 offset:0
buffer_load_dwordx4 v114, s[36:39], s81 offen offset:2048 lds
v_mfma_f32_16x16x32_bf16 v[40:43], a[100:103], v[144:147], v[40:43]
s_waitcnt lgkmcnt(11)
ds_read_b64_tr_b16 a[66:67], v118 offset:2048
v_mul_f32 v84, v84, v25
v_mfma_f32_16x16x32_bf16 v[40:43], a[104:107], v[160:163], v[40:43]
s_waitcnt lgkmcnt(10)
ds_read_b64_tr_b16 a[68:69], v118 offset:4096
v_mul_f32 v85, v85, v25
v_mfma_f32_16x16x32_bf16 v[40:43], a[108:111], v[176:179], v[40:43]
s_waitcnt lgkmcnt(9)
ds_read_b64_tr_b16 a[70:71], v118 offset:6144
v_mul_f32 v86, v86, v25
v_mfma_f32_16x16x32_bf16 v[40:43], a[112:115], v[192:195], v[40:43]
s_waitcnt lgkmcnt(8)
ds_read_b64_tr_b16 a[72:73], v118 offset:8192
v_mul_f32 v87, v87, v25
v_mfma_f32_16x16x32_bf16 v[40:43], a[116:119], v[208:211], v[40:43]
s_waitcnt lgkmcnt(7)
ds_read_b64_tr_b16 a[74:75], v118 offset:10240
v_mul_f32 v92, v92, v25
v_mfma_f32_16x16x32_bf16 v[40:43], a[120:123], v[224:227], v[40:43]
s_waitcnt lgkmcnt(6)
ds_read_b64_tr_b16 a[76:77], v118 offset:12288
v_mul_f32 v93, v93, v25
v_mfma_f32_16x16x32_bf16 v[40:43], a[124:127], v[240:243], v[40:43]
ds_read_b64_tr_b16 a[78:79], v118 offset:14336
buffer_load_dwordx4 v115, s[36:39], s81 offen offset:3072 lds
v_mfma_f32_16x16x32_bf16 v[44:47], a[96:99], v[132:135], 0
ds_read_b64_tr_b16 a[80:81], v118 offset:16384
v_mul_f32 v94, v94, v25
v_mfma_f32_16x16x32_bf16 v[44:47], a[100:103], v[148:151], v[44:47]
ds_read_b64_tr_b16 a[82:83], v118 offset:18432
v_mul_f32 v95, v95, v25
v_mfma_f32_16x16x32_bf16 v[44:47], a[104:107], v[164:167], v[44:47]
ds_read_b64_tr_b16 a[84:85], v118 offset:20480
v_cvt_pk_bf16_f32 v84, v84, v85
v_mfma_f32_16x16x32_bf16 v[44:47], a[108:111], v[180:183], v[44:47]
ds_read_b64_tr_b16 a[86:87], v118 offset:22528
v_cvt_pk_bf16_f32 v85, v86, v87
v_mfma_f32_16x16x32_bf16 v[44:47], a[112:115], v[196:199], v[44:47]
ds_read_b64_tr_b16 a[88:89], v118 offset:24576
v_cvt_pk_bf16_f32 v86, v92, v93
v_mfma_f32_16x16x32_bf16 v[44:47], a[116:119], v[212:215], v[44:47]
s_add_u32 s81, s81, 28672
s_add_u32 m0, s18, 36864
ds_read_b64_tr_b16 a[90:91], v118 offset:26624
v_mfma_f32_16x16x32_bf16 v[44:47], a[120:123], v[228:231], v[44:47]
ds_read_b64_tr_b16 a[92:93], v118 offset:28672
buffer_load_dwordx4 v112, s[36:39], s81 offen offset:0 lds
v_mfma_f32_16x16x32_bf16 v[44:47], a[124:127], v[244:247], v[44:47]
s_waitcnt lgkmcnt(13)
ds_read_b64_tr_b16 a[94:95], v118 offset:30720
v_add_u32 v118, 4294901760, v118
v_mfma_f32_16x16x32_bf16 v[48:51], a[64:67], v[128:131], 0
s_waitcnt lgkmcnt(12)
ds_read_b64_tr_b16 a[96:97], v119 offset:0
v_cvt_pk_bf16_f32 v87, v94, v95
v_mfma_f32_16x16x32_bf16 v[48:51], a[68:71], v[144:147], v[48:51]
s_waitcnt lgkmcnt(9)
ds_read_b64_tr_b16 a[98:99], v119 offset:2048
buffer_store_dwordx4 v[84:87], v1, s[4:7], s12 offen offset:3072 sc1
v_mfma_f32_16x16x32_bf16 v[48:51], a[72:75], v[160:163], v[48:51]
s_add_u32 s8, s8, 4096
s_add_u32 s12, s12, 4096
ds_read_b64_tr_b16 a[100:101], v119 offset:4096
v_mfma_f32_16x16x32_bf16 v[48:51], a[76:79], v[176:179], v[48:51]
s_waitcnt lgkmcnt(9)
ds_read_b64_tr_b16 a[102:103], v119 offset:6144
v_mul_f32 v32, v32, v24
v_mfma_f32_16x16x32_bf16 v[48:51], a[80:83], v[192:195], v[48:51]
s_waitcnt lgkmcnt(8)
ds_read_b64_tr_b16 a[104:105], v119 offset:8192
v_mul_f32 v33, v33, v24
v_mfma_f32_16x16x32_bf16 v[48:51], a[84:87], v[208:211], v[48:51]
s_waitcnt lgkmcnt(7)
ds_read_b64_tr_b16 a[106:107], v119 offset:10240
buffer_load_dwordx4 v113, s[36:39], s81 offen offset:1024 lds
v_mfma_f32_16x16x32_bf16 v[48:51], a[88:91], v[224:227], v[48:51]
s_waitcnt lgkmcnt(6)
ds_read_b64_tr_b16 a[108:109], v119 offset:12288
v_mul_f32 v34, v34, v24
v_mfma_f32_16x16x32_bf16 v[48:51], a[92:95], v[240:243], v[48:51]
ds_read_b64_tr_b16 a[110:111], v119 offset:14336
v_mul_f32 v35, v35, v24
v_mfma_f32_16x16x32_bf16 v[52:55], a[64:67], v[132:135], 0
ds_read_b64_tr_b16 a[112:113], v119 offset:16384
v_mul_f32 v40, v40, v24
v_mfma_f32_16x16x32_bf16 v[52:55], a[68:71], v[148:151], v[52:55]
ds_read_b64_tr_b16 a[114:115], v119 offset:18432
v_mul_f32 v41, v41, v24
v_mfma_f32_16x16x32_bf16 v[52:55], a[72:75], v[164:167], v[52:55]
ds_read_b64_tr_b16 a[116:117], v119 offset:20480
v_mul_f32 v42, v42, v24
v_mfma_f32_16x16x32_bf16 v[52:55], a[76:79], v[180:183], v[52:55]
ds_read_b64_tr_b16 a[118:119], v119 offset:22528
v_mul_f32 v43, v43, v24
v_mfma_f32_16x16x32_bf16 v[52:55], a[80:83], v[196:199], v[52:55]
ds_read_b64_tr_b16 a[120:121], v119 offset:24576
buffer_load_dwordx4 v114, s[36:39], s81 offen offset:2048 lds
v_mfma_f32_16x16x32_bf16 v[52:55], a[84:87], v[212:215], v[52:55]
ds_read_b64_tr_b16 a[122:123], v119 offset:26624
v_cvt_pk_bf16_f32 v32, v32, v33
v_mfma_f32_16x16x32_bf16 v[52:55], a[88:91], v[228:231], v[52:55]
ds_read_b64_tr_b16 a[124:125], v119 offset:28672
ds_read_b64_tr_b16 a[126:127], v119 offset:30720
v_mfma_f32_16x16x32_bf16 v[52:55], a[92:95], v[244:247], v[52:55]
s_waitcnt vmcnt(23) lgkmcnt(14)
s_barrier
v_add_u32 v119, 4294901760, v119
v_mfma_f32_16x16x32_bf16 v[56:59], a[96:99], v[128:131], 0
s_waitcnt lgkmcnt(12)
ds_read_b64_tr_b16 a[64:65], v116 offset:0
v_cvt_pk_bf16_f32 v33, v34, v35
v_mfma_f32_16x16x32_bf16 v[56:59], a[100:103], v[144:147], v[56:59]
s_waitcnt lgkmcnt(11)
ds_read_b64_tr_b16 a[66:67], v116 offset:2048
v_cvt_pk_bf16_f32 v34, v40, v41
v_mfma_f32_16x16x32_bf16 v[56:59], a[104:107], v[160:163], v[56:59]
s_waitcnt lgkmcnt(10)
ds_read_b64_tr_b16 a[68:69], v116 offset:4096
v_cvt_pk_bf16_f32 v35, v42, v43
v_mfma_f32_16x16x32_bf16 v[56:59], a[108:111], v[176:179], v[56:59]
s_waitcnt lgkmcnt(9)
ds_read_b64_tr_b16 a[70:71], v116 offset:6144
buffer_load_dwordx4 v115, s[36:39], s81 offen offset:3072 lds
v_mfma_f32_16x16x32_bf16 v[56:59], a[112:115], v[192:195], v[56:59]
s_waitcnt lgkmcnt(8)
ds_read_b64_tr_b16 a[72:73], v116 offset:8192
buffer_store_dwordx4 v[32:35], v1, s[4:7], s8 offen offset:0 sc1
v_mfma_f32_16x16x32_bf16 v[56:59], a[116:119], v[208:211], v[56:59]
s_waitcnt lgkmcnt(7)
ds_read_b64_tr_b16 a[74:75], v116 offset:10240
v_mul_f32 v36, v36, v25
v_mfma_f32_16x16x32_bf16 v[56:59], a[120:123], v[224:227], v[56:59]
s_waitcnt lgkmcnt(6)
ds_read_b64_tr_b16 a[76:77], v116 offset:12288
v_mul_f32 v37, v37, v25
v_mfma_f32_16x16x32_bf16 v[56:59], a[124:127], v[240:243], v[56:59]
ds_read_b64_tr_b16 a[78:79], v116 offset:14336
v_mul_f32 v38, v38, v25
v_mfma_f32_16x16x32_bf16 v[60:63], a[96:99], v[132:135], 0
ds_read_b64_tr_b16 a[80:81], v116 offset:16384
v_mul_f32 v39, v39, v25
v_mfma_f32_16x16x32_bf16 v[60:63], a[100:103], v[148:151], v[60:63]
s_sub_u32 s81, s81, 28544
ds_read_b64_tr_b16 a[82:83], v116 offset:18432
v_mul_f32 v44, v44, v25
v_mfma_f32_16x16x32_bf16 v[60:63], a[104:107], v[164:167], v[60:63]
ds_read_b64_tr_b16 a[84:85], v116 offset:20480
v_mul_f32 v45, v45, v25
v_mfma_f32_16x16x32_bf16 v[60:63], a[108:111], v[180:183], v[60:63]
ds_read_b64_tr_b16 a[86:87], v116 offset:22528
v_mul_f32 v46, v46, v25
v_mfma_f32_16x16x32_bf16 v[60:63], a[112:115], v[196:199], v[60:63]
ds_read_b64_tr_b16 a[88:89], v116 offset:24576
v_mul_f32 v47, v47, v25
v_mfma_f32_16x16x32_bf16 v[60:63], a[116:119], v[212:215], v[60:63]
ds_read_b64_tr_b16 a[90:91], v116 offset:26624
v_cvt_pk_bf16_f32 v36, v36, v37
v_mfma_f32_16x16x32_bf16 v[60:63], a[120:123], v[228:231], v[60:63]
ds_read_b64_tr_b16 a[92:93], v116 offset:28672
v_cvt_pk_bf16_f32 v37, v38, v39
v_mfma_f32_16x16x32_bf16 v[60:63], a[124:127], v[244:247], v[60:63]
s_waitcnt lgkmcnt(11)
ds_read_b64_tr_b16 a[94:95], v116 offset:30720
v_add_u32 v116, 4294901760, v116
v_mfma_f32_16x16x32_bf16 v[64:67], a[64:67], v[128:131], 0
s_add_u32 m0, s18, 98304
ds_read_b64_tr_b16 a[96:97], v117 offset:0
v_cvt_pk_bf16_f32 v38, v44, v45
v_mfma_f32_16x16x32_bf16 v[64:67], a[68:71], v[144:147], v[64:67]
s_waitcnt lgkmcnt(11)
ds_read_b64_tr_b16 a[98:99], v117 offset:2048
buffer_load_dwordx4 v112, s[36:39], s81 offen offset:0 lds
v_mfma_f32_16x16x32_bf16 v[64:67], a[72:75], v[160:163], v[64:67]
s_waitcnt lgkmcnt(10)
ds_read_b64_tr_b16 a[100:101], v117 offset:4096
v_cvt_pk_bf16_f32 v39, v46, v47
v_mfma_f32_16x16x32_bf16 v[64:67], a[76:79], v[176:179], v[64:67]
s_waitcnt lgkmcnt(9)
ds_read_b64_tr_b16 a[102:103], v117 offset:6144
buffer_store_dwordx4 v[36:39], v1, s[4:7], s12 offen offset:0 sc1
v_mfma_f32_16x16x32_bf16 v[64:67], a[80:83], v[192:195], v[64:67]
s_waitcnt lgkmcnt(8)
ds_read_b64_tr_b16 a[104:105], v117 offset:8192
v_mul_f32 v48, v48, v24
v_mfma_f32_16x16x32_bf16 v[64:67], a[84:87], v[208:211], v[64:67]
s_waitcnt lgkmcnt(7)
ds_read_b64_tr_b16 a[106:107], v117 offset:10240
v_mul_f32 v49, v49, v24
v_mfma_f32_16x16x32_bf16 v[64:67], a[88:91], v[224:227], v[64:67]
s_waitcnt lgkmcnt(6)
ds_read_b64_tr_b16 a[108:109], v117 offset:12288
v_mul_f32 v50, v50, v24
v_mfma_f32_16x16x32_bf16 v[64:67], a[92:95], v[240:243], v[64:67]
ds_read_b64_tr_b16 a[110:111], v117 offset:14336
v_mul_f32 v51, v51, v24
v_mfma_f32_16x16x32_bf16 v[68:71], a[64:67], v[132:135], 0
ds_read_b64_tr_b16 a[112:113], v117 offset:16384
buffer_load_dwordx4 v113, s[36:39], s81 offen offset:1024 lds
v_mfma_f32_16x16x32_bf16 v[68:71], a[68:71], v[148:151], v[68:71]
ds_read_b64_tr_b16 a[114:115], v117 offset:18432
v_mul_f32 v56, v56, v24
v_mfma_f32_16x16x32_bf16 v[68:71], a[72:75], v[164:167], v[68:71]
ds_read_b64_tr_b16 a[116:117], v117 offset:20480
v_mul_f32 v57, v57, v24
v_mfma_f32_16x16x32_bf16 v[68:71], a[76:79], v[180:183], v[68:71]
ds_read_b64_tr_b16 a[118:119], v117 offset:22528
v_mul_f32 v58, v58, v24
v_mfma_f32_16x16x32_bf16 v[68:71], a[80:83], v[196:199], v[68:71]
ds_read_b64_tr_b16 a[120:121], v117 offset:24576
v_mul_f32 v59, v59, v24
v_mfma_f32_16x16x32_bf16 v[68:71], a[84:87], v[212:215], v[68:71]
ds_read_b64_tr_b16 a[122:123], v117 offset:26624
v_cvt_pk_bf16_f32 v48, v48, v49
v_mfma_f32_16x16x32_bf16 v[68:71], a[88:91], v[228:231], v[68:71]
ds_read_b64_tr_b16 a[124:125], v117 offset:28672
v_cvt_pk_bf16_f32 v49, v50, v51
v_mfma_f32_16x16x32_bf16 v[68:71], a[92:95], v[244:247], v[68:71]
s_waitcnt lgkmcnt(13)
ds_read_b64_tr_b16 a[126:127], v117 offset:30720
v_add_u32 v117, 4294901760, v117
v_mfma_f32_16x16x32_bf16 v[72:75], a[96:99], v[128:131], 0
s_waitcnt lgkmcnt(12)
ds_read_b64_tr_b16 a[64:65], v118 offset:0
buffer_load_dwordx4 v114, s[36:39], s81 offen offset:2048 lds
v_mfma_f32_16x16x32_bf16 v[72:75], a[100:103], v[144:147], v[72:75]
s_waitcnt lgkmcnt(11)
ds_read_b64_tr_b16 a[66:67], v118 offset:2048
v_cvt_pk_bf16_f32 v50, v56, v57
v_mfma_f32_16x16x32_bf16 v[72:75], a[104:107], v[160:163], v[72:75]
s_waitcnt lgkmcnt(10)
ds_read_b64_tr_b16 a[68:69], v118 offset:4096
v_cvt_pk_bf16_f32 v51, v58, v59
v_mfma_f32_16x16x32_bf16 v[72:75], a[108:111], v[176:179], v[72:75]
s_waitcnt lgkmcnt(9)
ds_read_b64_tr_b16 a[70:71], v118 offset:6144
buffer_store_dwordx4 v[48:51], v1, s[4:7], s8 offen offset:1024 sc1
v_mfma_f32_16x16x32_bf16 v[72:75], a[112:115], v[192:195], v[72:75]
s_waitcnt lgkmcnt(8)
ds_read_b64_tr_b16 a[72:73], v118 offset:8192
v_mul_f32 v52, v52, v25
v_mfma_f32_16x16x32_bf16 v[72:75], a[116:119], v[208:211], v[72:75]
s_waitcnt lgkmcnt(7)
ds_read_b64_tr_b16 a[74:75], v118 offset:10240
v_mul_f32 v53, v53, v25
v_mfma_f32_16x16x32_bf16 v[72:75], a[120:123], v[224:227], v[72:75]
s_waitcnt lgkmcnt(6)
ds_read_b64_tr_b16 a[76:77], v118 offset:12288
v_mul_f32 v54, v54, v25
v_mfma_f32_16x16x32_bf16 v[72:75], a[124:127], v[240:243], v[72:75]
ds_read_b64_tr_b16 a[78:79], v118 offset:14336
buffer_load_dwordx4 v115, s[36:39], s81 offen offset:3072 lds
v_mfma_f32_16x16x32_bf16 v[76:79], a[96:99], v[132:135], 0
ds_read_b64_tr_b16 a[80:81], v118 offset:16384
v_mul_f32 v55, v55, v25
v_mfma_f32_16x16x32_bf16 v[76:79], a[100:103], v[148:151], v[76:79]
ds_read_b64_tr_b16 a[82:83], v118 offset:18432
v_mul_f32 v60, v60, v25
v_mfma_f32_16x16x32_bf16 v[76:79], a[104:107], v[164:167], v[76:79]
ds_read_b64_tr_b16 a[84:85], v118 offset:20480
v_mul_f32 v61, v61, v25
v_mfma_f32_16x16x32_bf16 v[76:79], a[108:111], v[180:183], v[76:79]
ds_read_b64_tr_b16 a[86:87], v118 offset:22528
v_mul_f32 v62, v62, v25
v_mfma_f32_16x16x32_bf16 v[76:79], a[112:115], v[196:199], v[76:79]
ds_read_b64_tr_b16 a[88:89], v118 offset:24576
v_mul_f32 v63, v63, v25
v_mfma_f32_16x16x32_bf16 v[76:79], a[116:119], v[212:215], v[76:79]
s_add_u32 s81, s81, 28672
s_add_u32 m0, s18, 102400
ds_read_b64_tr_b16 a[90:91], v118 offset:26624
v_mfma_f32_16x16x32_bf16 v[76:79], a[120:123], v[228:231], v[76:79]
ds_read_b64_tr_b16 a[92:93], v118 offset:28672
buffer_load_dwordx4 v112, s[36:39], s81 offen offset:0 lds
v_mfma_f32_16x16x32_bf16 v[76:79], a[124:127], v[244:247], v[76:79]
s_waitcnt lgkmcnt(13)
ds_read_b64_tr_b16 a[94:95], v118 offset:30720
v_add_u32 v118, 4294901760, v118
v_mfma_f32_16x16x32_bf16 v[80:83], a[64:67], v[128:131], 0
s_waitcnt lgkmcnt(12)
ds_read_b64_tr_b16 a[96:97], v119 offset:0
v_cvt_pk_bf16_f32 v52, v52, v53
v_mfma_f32_16x16x32_bf16 v[80:83], a[68:71], v[144:147], v[80:83]
s_waitcnt lgkmcnt(11)
ds_read_b64_tr_b16 a[98:99], v119 offset:2048
v_cvt_pk_bf16_f32 v53, v54, v55
v_mfma_f32_16x16x32_bf16 v[80:83], a[72:75], v[160:163], v[80:83]
s_waitcnt lgkmcnt(10)
ds_read_b64_tr_b16 a[100:101], v119 offset:4096
v_cvt_pk_bf16_f32 v54, v60, v61
v_mfma_f32_16x16x32_bf16 v[80:83], a[76:79], v[176:179], v[80:83]
s_waitcnt lgkmcnt(9)
ds_read_b64_tr_b16 a[102:103], v119 offset:6144
v_cvt_pk_bf16_f32 v55, v62, v63
v_mfma_f32_16x16x32_bf16 v[80:83], a[80:83], v[192:195], v[80:83]
s_waitcnt lgkmcnt(8)
ds_read_b64_tr_b16 a[104:105], v119 offset:8192
buffer_store_dwordx4 v[52:55], v1, s[4:7], s12 offen offset:1024 sc1
v_mfma_f32_16x16x32_bf16 v[80:83], a[84:87], v[208:211], v[80:83]
s_waitcnt lgkmcnt(7)
ds_read_b64_tr_b16 a[106:107], v119 offset:10240
buffer_load_dwordx4 v113, s[36:39], s81 offen offset:1024 lds
v_mfma_f32_16x16x32_bf16 v[80:83], a[88:91], v[224:227], v[80:83]
s_waitcnt lgkmcnt(6)
ds_read_b64_tr_b16 a[108:109], v119 offset:12288
v_mul_f32 v64, v64, v24
v_mfma_f32_16x16x32_bf16 v[80:83], a[92:95], v[240:243], v[80:83]
ds_read_b64_tr_b16 a[110:111], v119 offset:14336
v_mul_f32 v65, v65, v24
v_mfma_f32_16x16x32_bf16 v[84:87], a[64:67], v[132:135], 0
ds_read_b64_tr_b16 a[112:113], v119 offset:16384
v_mul_f32 v66, v66, v24
v_mfma_f32_16x16x32_bf16 v[84:87], a[68:71], v[148:151], v[84:87]
ds_read_b64_tr_b16 a[114:115], v119 offset:18432
v_mul_f32 v67, v67, v24
v_mfma_f32_16x16x32_bf16 v[84:87], a[72:75], v[164:167], v[84:87]
ds_read_b64_tr_b16 a[116:117], v119 offset:20480
v_mul_f32 v72, v72, v24
v_mfma_f32_16x16x32_bf16 v[84:87], a[76:79], v[180:183], v[84:87]
ds_read_b64_tr_b16 a[118:119], v119 offset:22528
v_mul_f32 v73, v73, v24
v_mfma_f32_16x16x32_bf16 v[84:87], a[80:83], v[196:199], v[84:87]
ds_read_b64_tr_b16 a[120:121], v119 offset:24576
buffer_load_dwordx4 v114, s[36:39], s81 offen offset:2048 lds
v_mfma_f32_16x16x32_bf16 v[84:87], a[84:87], v[212:215], v[84:87]
ds_read_b64_tr_b16 a[122:123], v119 offset:26624
v_mul_f32 v74, v74, v24
v_mfma_f32_16x16x32_bf16 v[84:87], a[88:91], v[228:231], v[84:87]
ds_read_b64_tr_b16 a[124:125], v119 offset:28672
ds_read_b64_tr_b16 a[126:127], v119 offset:30720
v_mfma_f32_16x16x32_bf16 v[84:87], a[92:95], v[244:247], v[84:87]
s_waitcnt vmcnt(27) lgkmcnt(14)
s_barrier
v_add_u32 v119, 4294901760, v119
v_mfma_f32_16x16x32_bf16 v[88:91], a[96:99], v[128:131], 0
s_waitcnt lgkmcnt(12)
ds_read_b64_tr_b16 a[64:65], v116 offset:0
v_mul_f32 v75, v75, v24
v_mfma_f32_16x16x32_bf16 v[88:91], a[100:103], v[144:147], v[88:91]
s_waitcnt lgkmcnt(11)
ds_read_b64_tr_b16 a[66:67], v116 offset:2048
v_cvt_pk_bf16_f32 v64, v64, v65
v_mfma_f32_16x16x32_bf16 v[88:91], a[104:107], v[160:163], v[88:91]
s_waitcnt lgkmcnt(10)
ds_read_b64_tr_b16 a[68:69], v116 offset:4096
v_cvt_pk_bf16_f32 v65, v66, v67
v_mfma_f32_16x16x32_bf16 v[88:91], a[108:111], v[176:179], v[88:91]
s_waitcnt lgkmcnt(9)
ds_read_b64_tr_b16 a[70:71], v116 offset:6144
buffer_load_dwordx4 v115, s[36:39], s81 offen offset:3072 lds
v_mfma_f32_16x16x32_bf16 v[88:91], a[112:115], v[192:195], v[88:91]
s_waitcnt lgkmcnt(8)
ds_read_b64_tr_b16 a[72:73], v116 offset:8192
v_cvt_pk_bf16_f32 v66, v72, v73
v_mfma_f32_16x16x32_bf16 v[88:91], a[116:119], v[208:211], v[88:91]
s_waitcnt lgkmcnt(7)
ds_read_b64_tr_b16 a[74:75], v116 offset:10240
v_cvt_pk_bf16_f32 v67, v74, v75
v_mfma_f32_16x16x32_bf16 v[88:91], a[120:123], v[224:227], v[88:91]
s_waitcnt lgkmcnt(6)
ds_read_b64_tr_b16 a[76:77], v116 offset:12288
buffer_store_dwordx4 v[64:67], v1, s[4:7], s8 offen offset:2048 sc1
v_mfma_f32_16x16x32_bf16 v[88:91], a[124:127], v[240:243], v[88:91]
ds_read_b64_tr_b16 a[78:79], v116 offset:14336
v_mul_f32 v68, v68, v25
v_mfma_f32_16x16x32_bf16 v[92:95], a[96:99], v[132:135], 0
ds_read_b64_tr_b16 a[80:81], v116 offset:16384
v_mul_f32 v69, v69, v25
v_mfma_f32_16x16x32_bf16 v[92:95], a[100:103], v[148:151], v[92:95]
s_sub_u32 s81, s81, 28544
ds_read_b64_tr_b16 a[82:83], v116 offset:18432
v_mul_f32 v70, v70, v25
v_mfma_f32_16x16x32_bf16 v[92:95], a[104:107], v[164:167], v[92:95]
ds_read_b64_tr_b16 a[84:85], v116 offset:20480
v_mul_f32 v71, v71, v25
v_mfma_f32_16x16x32_bf16 v[92:95], a[108:111], v[180:183], v[92:95]
ds_read_b64_tr_b16 a[86:87], v116 offset:22528
v_mul_f32 v76, v76, v25
v_mfma_f32_16x16x32_bf16 v[92:95], a[112:115], v[196:199], v[92:95]
ds_read_b64_tr_b16 a[88:89], v116 offset:24576
v_mul_f32 v77, v77, v25
v_mfma_f32_16x16x32_bf16 v[92:95], a[116:119], v[212:215], v[92:95]
ds_read_b64_tr_b16 a[90:91], v116 offset:26624
v_mul_f32 v78, v78, v25
v_mfma_f32_16x16x32_bf16 v[92:95], a[120:123], v[228:231], v[92:95]
ds_read_b64_tr_b16 a[92:93], v116 offset:28672
v_mul_f32 v79, v79, v25
v_mfma_f32_16x16x32_bf16 v[92:95], a[124:127], v[244:247], v[92:95]
s_waitcnt lgkmcnt(13)
ds_read_b64_tr_b16 a[94:95], v116 offset:30720
v_add_u32 v116, 32768, v116
v_mfma_f32_16x16x32_bf16 v[32:35], a[64:67], v[128:131], 0
s_waitcnt lgkmcnt(12)
ds_read_b64_tr_b16 a[96:97], v117 offset:0
v_cvt_pk_bf16_f32 v68, v68, v69
v_mfma_f32_16x16x32_bf16 v[32:35], a[68:71], v[144:147], v[32:35]
s_waitcnt lgkmcnt(11)
ds_read_b64_tr_b16 a[98:99], v117 offset:2048
v_cvt_pk_bf16_f32 v69, v70, v71
v_mfma_f32_16x16x32_bf16 v[32:35], a[72:75], v[160:163], v[32:35]
s_waitcnt lgkmcnt(10)
ds_read_b64_tr_b16 a[100:101], v117 offset:4096
v_cvt_pk_bf16_f32 v70, v76, v77
v_mfma_f32_16x16x32_bf16 v[32:35], a[76:79], v[176:179], v[32:35]
s_waitcnt lgkmcnt(9)
ds_read_b64_tr_b16 a[102:103], v117 offset:6144
v_cvt_pk_bf16_f32 v71, v78, v79
v_mfma_f32_16x16x32_bf16 v[32:35], a[80:83], v[192:195], v[32:35]
s_waitcnt lgkmcnt(8)
ds_read_b64_tr_b16 a[104:105], v117 offset:8192
buffer_store_dwordx4 v[68:71], v1, s[4:7], s12 offen offset:2048 sc1
v_mfma_f32_16x16x32_bf16 v[32:35], a[84:87], v[208:211], v[32:35]
s_waitcnt lgkmcnt(7)
ds_read_b64_tr_b16 a[106:107], v117 offset:10240
v_mul_f32 v80, v80, v24
v_mfma_f32_16x16x32_bf16 v[32:35], a[88:91], v[224:227], v[32:35]
s_waitcnt lgkmcnt(6)
ds_read_b64_tr_b16 a[108:109], v117 offset:12288
v_mul_f32 v81, v81, v24
v_mfma_f32_16x16x32_bf16 v[32:35], a[92:95], v[240:243], v[32:35]
ds_read_b64_tr_b16 a[110:111], v117 offset:14336
v_mul_f32 v82, v82, v24
v_mfma_f32_16x16x32_bf16 v[36:39], a[64:67], v[132:135], 0
ds_read_b64_tr_b16 a[112:113], v117 offset:16384
v_mul_f32 v83, v83, v24
v_mfma_f32_16x16x32_bf16 v[36:39], a[68:71], v[148:151], v[36:39]
ds_read_b64_tr_b16 a[114:115], v117 offset:18432
v_mul_f32 v88, v88, v24
v_mfma_f32_16x16x32_bf16 v[36:39], a[72:75], v[164:167], v[36:39]
ds_read_b64_tr_b16 a[116:117], v117 offset:20480
v_mul_f32 v89, v89, v24
v_mfma_f32_16x16x32_bf16 v[36:39], a[76:79], v[180:183], v[36:39]
ds_read_b64_tr_b16 a[118:119], v117 offset:22528
v_mul_f32 v90, v90, v24
v_mfma_f32_16x16x32_bf16 v[36:39], a[80:83], v[196:199], v[36:39]
ds_read_b64_tr_b16 a[120:121], v117 offset:24576
v_mul_f32 v91, v91, v24
v_mfma_f32_16x16x32_bf16 v[36:39], a[84:87], v[212:215], v[36:39]
ds_read_b64_tr_b16 a[122:123], v117 offset:26624
v_cvt_pk_bf16_f32 v80, v80, v81
v_mfma_f32_16x16x32_bf16 v[36:39], a[88:91], v[228:231], v[36:39]
ds_read_b64_tr_b16 a[124:125], v117 offset:28672
v_cvt_pk_bf16_f32 v81, v82, v83
v_mfma_f32_16x16x32_bf16 v[36:39], a[92:95], v[244:247], v[36:39]
s_waitcnt lgkmcnt(13)
ds_read_b64_tr_b16 a[126:127], v117 offset:30720
v_add_u32 v117, 32768, v117
v_mfma_f32_16x16x32_bf16 v[40:43], a[96:99], v[128:131], 0
s_waitcnt lgkmcnt(12)
ds_read_b64_tr_b16 a[64:65], v118 offset:0
v_cvt_pk_bf16_f32 v82, v88, v89
v_mfma_f32_16x16x32_bf16 v[40:43], a[100:103], v[144:147], v[40:43]
s_waitcnt lgkmcnt(11)
ds_read_b64_tr_b16 a[66:67], v118 offset:2048
v_cvt_pk_bf16_f32 v83, v90, v91
v_mfma_f32_16x16x32_bf16 v[40:43], a[104:107], v[160:163], v[40:43]
s_waitcnt lgkmcnt(10)
ds_read_b64_tr_b16 a[68:69], v118 offset:4096
buffer_store_dwordx4 v[80:83], v1, s[4:7], s8 offen offset:3072 sc1
v_mfma_f32_16x16x32_bf16 v[40:43], a[108:111], v[176:179], v[40:43]
s_waitcnt lgkmcnt(9)
ds_read_b64_tr_b16 a[70:71], v118 offset:6144
v_mul_f32 v84, v84, v25
v_mfma_f32_16x16x32_bf16 v[40:43], a[112:115], v[192:195], v[40:43]
s_waitcnt lgkmcnt(8)
ds_read_b64_tr_b16 a[72:73], v118 offset:8192
v_mul_f32 v85, v85, v25
v_mfma_f32_16x16x32_bf16 v[40:43], a[116:119], v[208:211], v[40:43]
s_waitcnt lgkmcnt(7)
ds_read_b64_tr_b16 a[74:75], v118 offset:10240
v_mul_f32 v86, v86, v25
v_mfma_f32_16x16x32_bf16 v[40:43], a[120:123], v[224:227], v[40:43]
s_waitcnt lgkmcnt(6)
ds_read_b64_tr_b16 a[76:77], v118 offset:12288
v_mul_f32 v87, v87, v25
v_mfma_f32_16x16x32_bf16 v[40:43], a[124:127], v[240:243], v[40:43]
ds_read_b64_tr_b16 a[78:79], v118 offset:14336
v_mul_f32 v92, v92, v25
v_mfma_f32_16x16x32_bf16 v[44:47], a[96:99], v[132:135], 0
ds_read_b64_tr_b16 a[80:81], v118 offset:16384
v_mul_f32 v93, v93, v25
v_mfma_f32_16x16x32_bf16 v[44:47], a[100:103], v[148:151], v[44:47]
ds_read_b64_tr_b16 a[82:83], v118 offset:18432
v_mul_f32 v94, v94, v25
v_mfma_f32_16x16x32_bf16 v[44:47], a[104:107], v[164:167], v[44:47]
ds_read_b64_tr_b16 a[84:85], v118 offset:20480
v_mul_f32 v95, v95, v25
v_mfma_f32_16x16x32_bf16 v[44:47], a[108:111], v[180:183], v[44:47]
ds_read_b64_tr_b16 a[86:87], v118 offset:22528
v_cvt_pk_bf16_f32 v84, v84, v85
v_mfma_f32_16x16x32_bf16 v[44:47], a[112:115], v[196:199], v[44:47]
ds_read_b64_tr_b16 a[88:89], v118 offset:24576
v_cvt_pk_bf16_f32 v85, v86, v87
v_mfma_f32_16x16x32_bf16 v[44:47], a[116:119], v[212:215], v[44:47]
ds_read_b64_tr_b16 a[90:91], v118 offset:26624
v_cvt_pk_bf16_f32 v86, v92, v93
v_mfma_f32_16x16x32_bf16 v[44:47], a[120:123], v[228:231], v[44:47]
ds_read_b64_tr_b16 a[92:93], v118 offset:28672
v_cvt_pk_bf16_f32 v87, v94, v95
v_mfma_f32_16x16x32_bf16 v[44:47], a[124:127], v[244:247], v[44:47]
s_waitcnt lgkmcnt(13)
ds_read_b64_tr_b16 a[94:95], v118 offset:30720
v_add_u32 v118, 32768, v118
v_mfma_f32_16x16x32_bf16 v[48:51], a[64:67], v[128:131], 0
s_waitcnt lgkmcnt(10)
ds_read_b64_tr_b16 a[96:97], v119 offset:0
buffer_store_dwordx4 v[84:87], v1, s[4:7], s12 offen offset:3072 sc1
v_mfma_f32_16x16x32_bf16 v[48:51], a[68:71], v[144:147], v[48:51]
s_add_u32 s8, s8, 4096
s_add_u32 s12, s12, 4096
ds_read_b64_tr_b16 a[98:99], v119 offset:2048
v_mfma_f32_16x16x32_bf16 v[48:51], a[72:75], v[160:163], v[48:51]
s_waitcnt lgkmcnt(10)
ds_read_b64_tr_b16 a[100:101], v119 offset:4096
v_mul_f32 v32, v32, v24
v_mfma_f32_16x16x32_bf16 v[48:51], a[76:79], v[176:179], v[48:51]
s_waitcnt lgkmcnt(9)
ds_read_b64_tr_b16 a[102:103], v119 offset:6144
v_mul_f32 v33, v33, v24
v_mfma_f32_16x16x32_bf16 v[48:51], a[80:83], v[192:195], v[48:51]
s_waitcnt lgkmcnt(8)
ds_read_b64_tr_b16 a[104:105], v119 offset:8192
v_mul_f32 v34, v34, v24
v_mfma_f32_16x16x32_bf16 v[48:51], a[84:87], v[208:211], v[48:51]
s_waitcnt lgkmcnt(7)
ds_read_b64_tr_b16 a[106:107], v119 offset:10240
v_mul_f32 v35, v35, v24
v_mfma_f32_16x16x32_bf16 v[48:51], a[88:91], v[224:227], v[48:51]
s_waitcnt lgkmcnt(6)
ds_read_b64_tr_b16 a[108:109], v119 offset:12288
v_mul_f32 v40, v40, v24
v_mfma_f32_16x16x32_bf16 v[48:51], a[92:95], v[240:243], v[48:51]
ds_read_b64_tr_b16 a[110:111], v119 offset:14336
v_mul_f32 v41, v41, v24
v_mfma_f32_16x16x32_bf16 v[52:55], a[64:67], v[132:135], 0
ds_read_b64_tr_b16 a[112:113], v119 offset:16384
v_mul_f32 v42, v42, v24
v_mfma_f32_16x16x32_bf16 v[52:55], a[68:71], v[148:151], v[52:55]
ds_read_b64_tr_b16 a[114:115], v119 offset:18432
v_mul_f32 v43, v43, v24
v_mfma_f32_16x16x32_bf16 v[52:55], a[72:75], v[164:167], v[52:55]
ds_read_b64_tr_b16 a[116:117], v119 offset:20480
v_cvt_pk_bf16_f32 v32, v32, v33
v_mfma_f32_16x16x32_bf16 v[52:55], a[76:79], v[180:183], v[52:55]
ds_read_b64_tr_b16 a[118:119], v119 offset:22528
v_cvt_pk_bf16_f32 v33, v34, v35
v_mfma_f32_16x16x32_bf16 v[52:55], a[80:83], v[196:199], v[52:55]
ds_read_b64_tr_b16 a[120:121], v119 offset:24576
v_cvt_pk_bf16_f32 v34, v40, v41
v_mfma_f32_16x16x32_bf16 v[52:55], a[84:87], v[212:215], v[52:55]
ds_read_b64_tr_b16 a[122:123], v119 offset:26624
v_cvt_pk_bf16_f32 v35, v42, v43
v_mfma_f32_16x16x32_bf16 v[52:55], a[88:91], v[228:231], v[52:55]
ds_read_b64_tr_b16 a[124:125], v119 offset:28672
ds_read_b64_tr_b16 a[126:127], v119 offset:30720
v_mfma_f32_16x16x32_bf16 v[52:55], a[92:95], v[244:247], v[52:55]
s_waitcnt vmcnt(16) lgkmcnt(14)
s_barrier
v_add_u32 v119, 32768, v119
v_mfma_f32_16x16x32_bf16 v[56:59], a[96:99], v[128:131], 0
s_waitcnt lgkmcnt(12)
ds_read_b64_tr_b16 a[64:65], v116 offset:0
buffer_store_dwordx4 v[32:35], v1, s[4:7], s8 offen offset:0 sc1
v_mfma_f32_16x16x32_bf16 v[56:59], a[100:103], v[144:147], v[56:59]
s_waitcnt lgkmcnt(11)
ds_read_b64_tr_b16 a[66:67], v116 offset:2048
v_mul_f32 v36, v36, v25
v_mfma_f32_16x16x32_bf16 v[56:59], a[104:107], v[160:163], v[56:59]
s_waitcnt lgkmcnt(10)
ds_read_b64_tr_b16 a[68:69], v116 offset:4096
v_mul_f32 v37, v37, v25
v_mfma_f32_16x16x32_bf16 v[56:59], a[108:111], v[176:179], v[56:59]
s_waitcnt lgkmcnt(9)
ds_read_b64_tr_b16 a[70:71], v116 offset:6144
v_mul_f32 v38, v38, v25
v_mfma_f32_16x16x32_bf16 v[56:59], a[112:115], v[192:195], v[56:59]
s_waitcnt lgkmcnt(8)
ds_read_b64_tr_b16 a[72:73], v116 offset:8192
v_mul_f32 v39, v39, v25
v_mfma_f32_16x16x32_bf16 v[56:59], a[116:119], v[208:211], v[56:59]
s_waitcnt lgkmcnt(7)
ds_read_b64_tr_b16 a[74:75], v116 offset:10240
v_mul_f32 v44, v44, v25
v_mfma_f32_16x16x32_bf16 v[56:59], a[120:123], v[224:227], v[56:59]
s_waitcnt lgkmcnt(6)
ds_read_b64_tr_b16 a[76:77], v116 offset:12288
v_mul_f32 v45, v45, v25
v_mfma_f32_16x16x32_bf16 v[56:59], a[124:127], v[240:243], v[56:59]
ds_read_b64_tr_b16 a[78:79], v116 offset:14336
v_mul_f32 v46, v46, v25
v_mfma_f32_16x16x32_bf16 v[60:63], a[96:99], v[132:135], 0
ds_read_b64_tr_b16 a[80:81], v116 offset:16384
v_mul_f32 v47, v47, v25
v_mfma_f32_16x16x32_bf16 v[60:63], a[100:103], v[148:151], v[60:63]
ds_read_b64_tr_b16 a[82:83], v116 offset:18432
v_cvt_pk_bf16_f32 v36, v36, v37
v_mfma_f32_16x16x32_bf16 v[60:63], a[104:107], v[164:167], v[60:63]
ds_read_b64_tr_b16 a[84:85], v116 offset:20480
v_cvt_pk_bf16_f32 v37, v38, v39
v_mfma_f32_16x16x32_bf16 v[60:63], a[108:111], v[180:183], v[60:63]
ds_read_b64_tr_b16 a[86:87], v116 offset:22528
v_cvt_pk_bf16_f32 v38, v44, v45
v_mfma_f32_16x16x32_bf16 v[60:63], a[112:115], v[196:199], v[60:63]
ds_read_b64_tr_b16 a[88:89], v116 offset:24576
v_cvt_pk_bf16_f32 v39, v46, v47
v_mfma_f32_16x16x32_bf16 v[60:63], a[116:119], v[212:215], v[60:63]
ds_read_b64_tr_b16 a[90:91], v116 offset:26624
buffer_store_dwordx4 v[36:39], v1, s[4:7], s12 offen offset:0 sc1
v_mfma_f32_16x16x32_bf16 v[60:63], a[120:123], v[228:231], v[60:63]
ds_read_b64_tr_b16 a[92:93], v116 offset:28672
v_mfma_f32_16x16x32_bf16 v[60:63], a[124:127], v[244:247], v[60:63]
s_waitcnt lgkmcnt(13)
ds_read_b64_tr_b16 a[94:95], v116 offset:30720
v_add_u32 v116, 65536, v116
v_mfma_f32_16x16x32_bf16 v[64:67], a[64:67], v[128:131], 0
s_waitcnt lgkmcnt(12)
ds_read_b64_tr_b16 a[96:97], v117 offset:0
v_mul_f32 v48, v48, v24
v_mfma_f32_16x16x32_bf16 v[64:67], a[68:71], v[144:147], v[64:67]
s_waitcnt lgkmcnt(11)
ds_read_b64_tr_b16 a[98:99], v117 offset:2048
v_mul_f32 v49, v49, v24
v_mfma_f32_16x16x32_bf16 v[64:67], a[72:75], v[160:163], v[64:67]
s_waitcnt lgkmcnt(10)
ds_read_b64_tr_b16 a[100:101], v117 offset:4096
v_mul_f32 v50, v50, v24
v_mfma_f32_16x16x32_bf16 v[64:67], a[76:79], v[176:179], v[64:67]
s_waitcnt lgkmcnt(9)
ds_read_b64_tr_b16 a[102:103], v117 offset:6144
v_mul_f32 v51, v51, v24
v_mfma_f32_16x16x32_bf16 v[64:67], a[80:83], v[192:195], v[64:67]
s_waitcnt lgkmcnt(8)
ds_read_b64_tr_b16 a[104:105], v117 offset:8192
v_mul_f32 v56, v56, v24
v_mfma_f32_16x16x32_bf16 v[64:67], a[84:87], v[208:211], v[64:67]
s_waitcnt lgkmcnt(7)
ds_read_b64_tr_b16 a[106:107], v117 offset:10240
v_mul_f32 v57, v57, v24
v_mfma_f32_16x16x32_bf16 v[64:67], a[88:91], v[224:227], v[64:67]
s_waitcnt lgkmcnt(6)
ds_read_b64_tr_b16 a[108:109], v117 offset:12288
v_mul_f32 v58, v58, v24
v_mfma_f32_16x16x32_bf16 v[64:67], a[92:95], v[240:243], v[64:67]
ds_read_b64_tr_b16 a[110:111], v117 offset:14336
v_mul_f32 v59, v59, v24
v_mfma_f32_16x16x32_bf16 v[68:71], a[64:67], v[132:135], 0
ds_read_b64_tr_b16 a[112:113], v117 offset:16384
v_cvt_pk_bf16_f32 v48, v48, v49
v_mfma_f32_16x16x32_bf16 v[68:71], a[68:71], v[148:151], v[68:71]
ds_read_b64_tr_b16 a[114:115], v117 offset:18432
v_cvt_pk_bf16_f32 v49, v50, v51
v_mfma_f32_16x16x32_bf16 v[68:71], a[72:75], v[164:167], v[68:71]
ds_read_b64_tr_b16 a[116:117], v117 offset:20480
v_cvt_pk_bf16_f32 v50, v56, v57
v_mfma_f32_16x16x32_bf16 v[68:71], a[76:79], v[180:183], v[68:71]
ds_read_b64_tr_b16 a[118:119], v117 offset:22528
v_cvt_pk_bf16_f32 v51, v58, v59
v_mfma_f32_16x16x32_bf16 v[68:71], a[80:83], v[196:199], v[68:71]
ds_read_b64_tr_b16 a[120:121], v117 offset:24576
buffer_store_dwordx4 v[48:51], v1, s[4:7], s8 offen offset:1024 sc1
v_mfma_f32_16x16x32_bf16 v[68:71], a[84:87], v[212:215], v[68:71]
ds_read_b64_tr_b16 a[122:123], v117 offset:26624
v_mul_f32 v52, v52, v25
v_mfma_f32_16x16x32_bf16 v[68:71], a[88:91], v[228:231], v[68:71]
ds_read_b64_tr_b16 a[124:125], v117 offset:28672
v_mul_f32 v53, v53, v25
v_mfma_f32_16x16x32_bf16 v[68:71], a[92:95], v[244:247], v[68:71]
s_waitcnt lgkmcnt(13)
ds_read_b64_tr_b16 a[126:127], v117 offset:30720
v_add_u32 v117, 65536, v117
v_mfma_f32_16x16x32_bf16 v[72:75], a[96:99], v[128:131], 0
s_waitcnt lgkmcnt(12)
ds_read_b64_tr_b16 a[64:65], v118 offset:0
v_mul_f32 v54, v54, v25
v_mfma_f32_16x16x32_bf16 v[72:75], a[100:103], v[144:147], v[72:75]
s_waitcnt lgkmcnt(11)
ds_read_b64_tr_b16 a[66:67], v118 offset:2048
v_mul_f32 v55, v55, v25
v_mfma_f32_16x16x32_bf16 v[72:75], a[104:107], v[160:163], v[72:75]
s_waitcnt lgkmcnt(10)
ds_read_b64_tr_b16 a[68:69], v118 offset:4096
v_mul_f32 v60, v60, v25
v_mfma_f32_16x16x32_bf16 v[72:75], a[108:111], v[176:179], v[72:75]
s_waitcnt lgkmcnt(9)
ds_read_b64_tr_b16 a[70:71], v118 offset:6144
v_mul_f32 v61, v61, v25
v_mfma_f32_16x16x32_bf16 v[72:75], a[112:115], v[192:195], v[72:75]
s_waitcnt lgkmcnt(8)
ds_read_b64_tr_b16 a[72:73], v118 offset:8192
v_mul_f32 v62, v62, v25
v_mfma_f32_16x16x32_bf16 v[72:75], a[116:119], v[208:211], v[72:75]
s_waitcnt lgkmcnt(7)
ds_read_b64_tr_b16 a[74:75], v118 offset:10240
v_mul_f32 v63, v63, v25
v_mfma_f32_16x16x32_bf16 v[72:75], a[120:123], v[224:227], v[72:75]
s_waitcnt lgkmcnt(6)
ds_read_b64_tr_b16 a[76:77], v118 offset:12288
v_cvt_pk_bf16_f32 v52, v52, v53
v_mfma_f32_16x16x32_bf16 v[72:75], a[124:127], v[240:243], v[72:75]
ds_read_b64_tr_b16 a[78:79], v118 offset:14336
v_cvt_pk_bf16_f32 v53, v54, v55
v_mfma_f32_16x16x32_bf16 v[76:79], a[96:99], v[132:135], 0
ds_read_b64_tr_b16 a[80:81], v118 offset:16384
v_cvt_pk_bf16_f32 v54, v60, v61
v_mfma_f32_16x16x32_bf16 v[76:79], a[100:103], v[148:151], v[76:79]
ds_read_b64_tr_b16 a[82:83], v118 offset:18432
v_cvt_pk_bf16_f32 v55, v62, v63
v_mfma_f32_16x16x32_bf16 v[76:79], a[104:107], v[164:167], v[76:79]
ds_read_b64_tr_b16 a[84:85], v118 offset:20480
buffer_store_dwordx4 v[52:55], v1, s[4:7], s12 offen offset:1024 sc1
v_mfma_f32_16x16x32_bf16 v[76:79], a[108:111], v[180:183], v[76:79]
ds_read_b64_tr_b16 a[86:87], v118 offset:22528
v_mul_u32_u24 v21, 1792, v19
v_mfma_f32_16x16x32_bf16 v[76:79], a[112:115], v[196:199], v[76:79]
ds_read_b64_tr_b16 a[88:89], v118 offset:24576
v_mul_f32 v64, v64, v24
v_mfma_f32_16x16x32_bf16 v[76:79], a[116:119], v[212:215], v[76:79]
ds_read_b64_tr_b16 a[90:91], v118 offset:26624
v_mul_f32 v65, v65, v24
v_mfma_f32_16x16x32_bf16 v[76:79], a[120:123], v[228:231], v[76:79]
ds_read_b64_tr_b16 a[92:93], v118 offset:28672
v_mul_f32 v66, v66, v24
v_mfma_f32_16x16x32_bf16 v[76:79], a[124:127], v[244:247], v[76:79]
s_waitcnt lgkmcnt(13)
ds_read_b64_tr_b16 a[94:95], v118 offset:30720
v_add_u32 v118, 65536, v118
v_mfma_f32_16x16x32_bf16 v[80:83], a[64:67], v[128:131], 0
s_waitcnt lgkmcnt(12)
ds_read_b64_tr_b16 a[96:97], v119 offset:0
v_mul_f32 v67, v67, v24
v_mfma_f32_16x16x32_bf16 v[80:83], a[68:71], v[144:147], v[80:83]
s_waitcnt lgkmcnt(11)
ds_read_b64_tr_b16 a[98:99], v119 offset:2048
v_mul_f32 v72, v72, v24
v_mfma_f32_16x16x32_bf16 v[80:83], a[72:75], v[160:163], v[80:83]
s_waitcnt lgkmcnt(10)
ds_read_b64_tr_b16 a[100:101], v119 offset:4096
v_mul_f32 v73, v73, v24
v_mfma_f32_16x16x32_bf16 v[80:83], a[76:79], v[176:179], v[80:83]
s_waitcnt lgkmcnt(9)
ds_read_b64_tr_b16 a[102:103], v119 offset:6144
v_mul_f32 v74, v74, v24
v_mfma_f32_16x16x32_bf16 v[80:83], a[80:83], v[192:195], v[80:83]
s_waitcnt lgkmcnt(8)
ds_read_b64_tr_b16 a[104:105], v119 offset:8192
v_mul_f32 v75, v75, v24
v_mfma_f32_16x16x32_bf16 v[80:83], a[84:87], v[208:211], v[80:83]
s_waitcnt lgkmcnt(7)
ds_read_b64_tr_b16 a[106:107], v119 offset:10240
v_cvt_pk_bf16_f32 v64, v64, v65
v_mfma_f32_16x16x32_bf16 v[80:83], a[88:91], v[224:227], v[80:83]
s_waitcnt lgkmcnt(6)
ds_read_b64_tr_b16 a[108:109], v119 offset:12288
v_cvt_pk_bf16_f32 v65, v66, v67
v_mfma_f32_16x16x32_bf16 v[80:83], a[92:95], v[240:243], v[80:83]
ds_read_b64_tr_b16 a[110:111], v119 offset:14336
v_cvt_pk_bf16_f32 v66, v72, v73
v_mfma_f32_16x16x32_bf16 v[84:87], a[64:67], v[132:135], 0
ds_read_b64_tr_b16 a[112:113], v119 offset:16384
v_cvt_pk_bf16_f32 v67, v74, v75
v_mfma_f32_16x16x32_bf16 v[84:87], a[68:71], v[148:151], v[84:87]
ds_read_b64_tr_b16 a[114:115], v119 offset:18432
buffer_store_dwordx4 v[64:67], v1, s[4:7], s8 offen offset:2048 sc1
v_mfma_f32_16x16x32_bf16 v[84:87], a[72:75], v[164:167], v[84:87]
ds_read_b64_tr_b16 a[116:117], v119 offset:20480
v_mul_f32 v68, v68, v25
v_mfma_f32_16x16x32_bf16 v[84:87], a[76:79], v[180:183], v[84:87]
ds_read_b64_tr_b16 a[118:119], v119 offset:22528
v_mul_f32 v69, v69, v25
v_mfma_f32_16x16x32_bf16 v[84:87], a[80:83], v[196:199], v[84:87]
ds_read_b64_tr_b16 a[120:121], v119 offset:24576
v_mul_f32 v70, v70, v25
v_mfma_f32_16x16x32_bf16 v[84:87], a[84:87], v[212:215], v[84:87]
ds_read_b64_tr_b16 a[122:123], v119 offset:26624
v_mul_f32 v71, v71, v25
v_mfma_f32_16x16x32_bf16 v[84:87], a[88:91], v[228:231], v[84:87]
ds_read_b64_tr_b16 a[124:125], v119 offset:28672
ds_read_b64_tr_b16 a[126:127], v119 offset:30720
v_mfma_f32_16x16x32_bf16 v[84:87], a[92:95], v[244:247], v[84:87]
s_waitcnt vmcnt(7) lgkmcnt(14)
s_barrier
v_add_u32 v119, 65536, v119
v_mfma_f32_16x16x32_bf16 v[88:91], a[96:99], v[128:131], 0
s_waitcnt lgkmcnt(12)
ds_read_b64_tr_b16 a[64:65], v116 offset:0
v_mul_f32 v76, v76, v25
v_mfma_f32_16x16x32_bf16 v[88:91], a[100:103], v[144:147], v[88:91]
s_waitcnt lgkmcnt(11)
ds_read_b64_tr_b16 a[66:67], v116 offset:2048
buffer_store_dword v6, v5, s[4:7], s34 offen sc1
v_mfma_f32_16x16x32_bf16 v[88:91], a[104:107], v[160:163], v[88:91]
s_waitcnt lgkmcnt(10)
ds_read_b64_tr_b16 a[68:69], v116 offset:4096
v_mul_f32 v77, v77, v25
v_mfma_f32_16x16x32_bf16 v[88:91], a[108:111], v[176:179], v[88:91]
s_waitcnt lgkmcnt(9)
ds_read_b64_tr_b16 a[70:71], v116 offset:6144
v_mul_f32 v78, v78, v25
v_mfma_f32_16x16x32_bf16 v[88:91], a[112:115], v[192:195], v[88:91]
s_waitcnt lgkmcnt(8)
ds_read_b64_tr_b16 a[72:73], v116 offset:8192
v_mul_f32 v79, v79, v25
v_mfma_f32_16x16x32_bf16 v[88:91], a[116:119], v[208:211], v[88:91]
s_waitcnt lgkmcnt(7)
ds_read_b64_tr_b16 a[74:75], v116 offset:10240
v_cvt_pk_bf16_f32 v68, v68, v69
v_mfma_f32_16x16x32_bf16 v[88:91], a[120:123], v[224:227], v[88:91]
s_waitcnt lgkmcnt(6)
ds_read_b64_tr_b16 a[76:77], v116 offset:12288
v_cvt_pk_bf16_f32 v69, v70, v71
v_mfma_f32_16x16x32_bf16 v[88:91], a[124:127], v[240:243], v[88:91]
ds_read_b64_tr_b16 a[78:79], v116 offset:14336
v_cvt_pk_bf16_f32 v70, v76, v77
v_mfma_f32_16x16x32_bf16 v[92:95], a[96:99], v[132:135], 0
ds_read_b64_tr_b16 a[80:81], v116 offset:16384
v_cvt_pk_bf16_f32 v71, v78, v79
v_mfma_f32_16x16x32_bf16 v[92:95], a[100:103], v[148:151], v[92:95]
ds_read_b64_tr_b16 a[82:83], v116 offset:18432
buffer_store_dwordx4 v[68:71], v1, s[4:7], s12 offen offset:2048 sc1
v_mfma_f32_16x16x32_bf16 v[92:95], a[104:107], v[164:167], v[92:95]
ds_read_b64_tr_b16 a[84:85], v116 offset:20480
v_lshlrev_b32 v19, 2, v19
v_mfma_f32_16x16x32_bf16 v[92:95], a[108:111], v[180:183], v[92:95]
ds_read_b64_tr_b16 a[86:87], v116 offset:22528
v_mfma_f32_16x16x32_bf16 v[92:95], a[112:115], v[196:199], v[92:95]
ds_read_b64_tr_b16 a[88:89], v116 offset:24576
v_mfma_f32_16x16x32_bf16 v[92:95], a[116:119], v[212:215], v[92:95]
ds_read_b64_tr_b16 a[90:91], v116 offset:26624
v_mfma_f32_16x16x32_bf16 v[92:95], a[120:123], v[228:231], v[92:95]
ds_read_b64_tr_b16 a[92:93], v116 offset:28672
v_mfma_f32_16x16x32_bf16 v[92:95], a[124:127], v[244:247], v[92:95]
s_waitcnt lgkmcnt(13)
ds_read_b64_tr_b16 a[94:95], v116 offset:30720
v_mfma_f32_16x16x32_bf16 v[32:35], a[64:67], v[128:131], 0
s_waitcnt lgkmcnt(12)
ds_read_b64_tr_b16 a[96:97], v117 offset:0
v_mul_f32 v80, v80, v24
v_mfma_f32_16x16x32_bf16 v[32:35], a[68:71], v[144:147], v[32:35]
s_waitcnt lgkmcnt(11)
ds_read_b64_tr_b16 a[98:99], v117 offset:2048
v_mul_f32 v81, v81, v24
v_mfma_f32_16x16x32_bf16 v[32:35], a[72:75], v[160:163], v[32:35]
s_waitcnt lgkmcnt(10)
ds_read_b64_tr_b16 a[100:101], v117 offset:4096
v_mul_f32 v82, v82, v24
v_mfma_f32_16x16x32_bf16 v[32:35], a[76:79], v[176:179], v[32:35]
s_waitcnt lgkmcnt(9)
ds_read_b64_tr_b16 a[102:103], v117 offset:6144
v_mul_f32 v83, v83, v24
v_mfma_f32_16x16x32_bf16 v[32:35], a[80:83], v[192:195], v[32:35]
s_waitcnt lgkmcnt(8)
ds_read_b64_tr_b16 a[104:105], v117 offset:8192
v_mul_f32 v88, v88, v24
v_mfma_f32_16x16x32_bf16 v[32:35], a[84:87], v[208:211], v[32:35]
s_waitcnt lgkmcnt(7)
ds_read_b64_tr_b16 a[106:107], v117 offset:10240
v_mul_f32 v89, v89, v24
v_mfma_f32_16x16x32_bf16 v[32:35], a[88:91], v[224:227], v[32:35]
s_waitcnt lgkmcnt(6)
ds_read_b64_tr_b16 a[108:109], v117 offset:12288
v_mul_f32 v90, v90, v24
v_mfma_f32_16x16x32_bf16 v[32:35], a[92:95], v[240:243], v[32:35]
ds_read_b64_tr_b16 a[110:111], v117 offset:14336
v_mul_f32 v91, v91, v24
v_mfma_f32_16x16x32_bf16 v[36:39], a[64:67], v[132:135], 0
ds_read_b64_tr_b16 a[112:113], v117 offset:16384
v_cvt_pk_bf16_f32 v80, v80, v81
v_mfma_f32_16x16x32_bf16 v[36:39], a[68:71], v[148:151], v[36:39]
ds_read_b64_tr_b16 a[114:115], v117 offset:18432
v_cvt_pk_bf16_f32 v81, v82, v83
v_mfma_f32_16x16x32_bf16 v[36:39], a[72:75], v[164:167], v[36:39]
ds_read_b64_tr_b16 a[116:117], v117 offset:20480
v_cvt_pk_bf16_f32 v82, v88, v89
v_mfma_f32_16x16x32_bf16 v[36:39], a[76:79], v[180:183], v[36:39]
ds_read_b64_tr_b16 a[118:119], v117 offset:22528
v_cvt_pk_bf16_f32 v83, v90, v91
v_mfma_f32_16x16x32_bf16 v[36:39], a[80:83], v[196:199], v[36:39]
ds_read_b64_tr_b16 a[120:121], v117 offset:24576
buffer_store_dwordx4 v[80:83], v1, s[4:7], s8 offen offset:3072 sc1
v_mfma_f32_16x16x32_bf16 v[36:39], a[84:87], v[212:215], v[36:39]
ds_read_b64_tr_b16 a[122:123], v117 offset:26624
v_mul_f32 v84, v84, v25
v_mfma_f32_16x16x32_bf16 v[36:39], a[88:91], v[228:231], v[36:39]
ds_read_b64_tr_b16 a[124:125], v117 offset:28672
v_mul_f32 v85, v85, v25
v_mfma_f32_16x16x32_bf16 v[36:39], a[92:95], v[244:247], v[36:39]
s_waitcnt lgkmcnt(13)
ds_read_b64_tr_b16 a[126:127], v117 offset:30720
v_mul_f32 v86, v86, v25
v_mfma_f32_16x16x32_bf16 v[40:43], a[96:99], v[128:131], 0
s_waitcnt lgkmcnt(12)
ds_read_b64_tr_b16 a[64:65], v118 offset:0
v_mul_f32 v87, v87, v25
v_mfma_f32_16x16x32_bf16 v[40:43], a[100:103], v[144:147], v[40:43]
s_waitcnt lgkmcnt(11)
ds_read_b64_tr_b16 a[66:67], v118 offset:2048
v_mul_f32 v92, v92, v25
v_mfma_f32_16x16x32_bf16 v[40:43], a[104:107], v[160:163], v[40:43]
s_waitcnt lgkmcnt(10)
ds_read_b64_tr_b16 a[68:69], v118 offset:4096
v_mul_f32 v93, v93, v25
v_mfma_f32_16x16x32_bf16 v[40:43], a[108:111], v[176:179], v[40:43]
s_waitcnt lgkmcnt(9)
ds_read_b64_tr_b16 a[70:71], v118 offset:6144
v_mul_f32 v94, v94, v25
v_mfma_f32_16x16x32_bf16 v[40:43], a[112:115], v[192:195], v[40:43]
s_waitcnt lgkmcnt(8)
ds_read_b64_tr_b16 a[72:73], v118 offset:8192
v_mul_f32 v95, v95, v25
v_mfma_f32_16x16x32_bf16 v[40:43], a[116:119], v[208:211], v[40:43]
s_waitcnt lgkmcnt(7)
ds_read_b64_tr_b16 a[74:75], v118 offset:10240
v_cvt_pk_bf16_f32 v84, v84, v85
v_mfma_f32_16x16x32_bf16 v[40:43], a[120:123], v[224:227], v[40:43]
s_waitcnt lgkmcnt(6)
ds_read_b64_tr_b16 a[76:77], v118 offset:12288
v_cvt_pk_bf16_f32 v85, v86, v87
v_mfma_f32_16x16x32_bf16 v[40:43], a[124:127], v[240:243], v[40:43]
ds_read_b64_tr_b16 a[78:79], v118 offset:14336
v_cvt_pk_bf16_f32 v86, v92, v93
v_mfma_f32_16x16x32_bf16 v[44:47], a[96:99], v[132:135], 0
ds_read_b64_tr_b16 a[80:81], v118 offset:16384
v_cvt_pk_bf16_f32 v87, v94, v95
v_mfma_f32_16x16x32_bf16 v[44:47], a[100:103], v[148:151], v[44:47]
ds_read_b64_tr_b16 a[82:83], v118 offset:18432
buffer_store_dwordx4 v[84:87], v1, s[4:7], s12 offen offset:3072 sc1
v_mfma_f32_16x16x32_bf16 v[44:47], a[104:107], v[164:167], v[44:47]
s_add_u32 s8, s8, 4096
s_add_u32 s12, s12, 4096
ds_read_b64_tr_b16 a[84:85], v118 offset:20480
v_mfma_f32_16x16x32_bf16 v[44:47], a[108:111], v[180:183], v[44:47]
ds_read_b64_tr_b16 a[86:87], v118 offset:22528
v_lshrrev_b32 v22, 4, v20
v_mfma_f32_16x16x32_bf16 v[44:47], a[112:115], v[196:199], v[44:47]
ds_read_b64_tr_b16 a[88:89], v118 offset:24576
v_mul_f32 v32, v32, v24
v_mfma_f32_16x16x32_bf16 v[44:47], a[116:119], v[212:215], v[44:47]
ds_read_b64_tr_b16 a[90:91], v118 offset:26624
v_mul_f32 v33, v33, v24
v_mfma_f32_16x16x32_bf16 v[44:47], a[120:123], v[228:231], v[44:47]
ds_read_b64_tr_b16 a[92:93], v118 offset:28672
v_mul_f32 v34, v34, v24
v_mfma_f32_16x16x32_bf16 v[44:47], a[124:127], v[244:247], v[44:47]
s_waitcnt lgkmcnt(13)
ds_read_b64_tr_b16 a[94:95], v118 offset:30720
v_mul_f32 v35, v35, v24
v_mfma_f32_16x16x32_bf16 v[48:51], a[64:67], v[128:131], 0
s_waitcnt lgkmcnt(12)
ds_read_b64_tr_b16 a[96:97], v119 offset:0
v_mul_f32 v40, v40, v24
v_mfma_f32_16x16x32_bf16 v[48:51], a[68:71], v[144:147], v[48:51]
s_waitcnt lgkmcnt(11)
ds_read_b64_tr_b16 a[98:99], v119 offset:2048
v_mul_f32 v41, v41, v24
v_mfma_f32_16x16x32_bf16 v[48:51], a[72:75], v[160:163], v[48:51]
s_waitcnt lgkmcnt(10)
ds_read_b64_tr_b16 a[100:101], v119 offset:4096
v_mul_f32 v42, v42, v24
v_mfma_f32_16x16x32_bf16 v[48:51], a[76:79], v[176:179], v[48:51]
s_waitcnt lgkmcnt(9)
ds_read_b64_tr_b16 a[102:103], v119 offset:6144
v_mul_f32 v43, v43, v24
v_mfma_f32_16x16x32_bf16 v[48:51], a[80:83], v[192:195], v[48:51]
s_waitcnt lgkmcnt(8)
ds_read_b64_tr_b16 a[104:105], v119 offset:8192
v_cvt_pk_bf16_f32 v32, v32, v33
v_mfma_f32_16x16x32_bf16 v[48:51], a[84:87], v[208:211], v[48:51]
s_waitcnt lgkmcnt(7)
ds_read_b64_tr_b16 a[106:107], v119 offset:10240
v_cvt_pk_bf16_f32 v33, v34, v35
v_mfma_f32_16x16x32_bf16 v[48:51], a[88:91], v[224:227], v[48:51]
s_waitcnt lgkmcnt(6)
ds_read_b64_tr_b16 a[108:109], v119 offset:12288
v_cvt_pk_bf16_f32 v34, v40, v41
v_mfma_f32_16x16x32_bf16 v[48:51], a[92:95], v[240:243], v[48:51]
ds_read_b64_tr_b16 a[110:111], v119 offset:14336
v_cvt_pk_bf16_f32 v35, v42, v43
v_mfma_f32_16x16x32_bf16 v[52:55], a[64:67], v[132:135], 0
ds_read_b64_tr_b16 a[112:113], v119 offset:16384
buffer_store_dwordx4 v[32:35], v1, s[4:7], s8 offen offset:0 sc1
v_mfma_f32_16x16x32_bf16 v[52:55], a[68:71], v[148:151], v[52:55]
ds_read_b64_tr_b16 a[114:115], v119 offset:18432
v_mul_f32 v36, v36, v25
v_mfma_f32_16x16x32_bf16 v[52:55], a[72:75], v[164:167], v[52:55]
ds_read_b64_tr_b16 a[116:117], v119 offset:20480
v_mul_f32 v37, v37, v25
v_mfma_f32_16x16x32_bf16 v[52:55], a[76:79], v[180:183], v[52:55]
ds_read_b64_tr_b16 a[118:119], v119 offset:22528
v_mul_f32 v38, v38, v25
v_mfma_f32_16x16x32_bf16 v[52:55], a[80:83], v[196:199], v[52:55]
ds_read_b64_tr_b16 a[120:121], v119 offset:24576
v_mul_f32 v39, v39, v25
v_mfma_f32_16x16x32_bf16 v[52:55], a[84:87], v[212:215], v[52:55]
ds_read_b64_tr_b16 a[122:123], v119 offset:26624
v_mul_f32 v44, v44, v25
v_mfma_f32_16x16x32_bf16 v[52:55], a[88:91], v[228:231], v[52:55]
ds_read_b64_tr_b16 a[124:125], v119 offset:28672
ds_read_b64_tr_b16 a[126:127], v119 offset:30720
v_mfma_f32_16x16x32_bf16 v[52:55], a[92:95], v[244:247], v[52:55]
s_waitcnt lgkmcnt(14)
v_mul_f32 v45, v45, v25
v_mul_f32 v46, v46, v25
v_mfma_f32_16x16x32_bf16 v[56:59], a[96:99], v[128:131], 0
s_waitcnt lgkmcnt(12)
v_mul_f32 v47, v47, v25
v_cvt_pk_bf16_f32 v36, v36, v37
v_mfma_f32_16x16x32_bf16 v[56:59], a[100:103], v[144:147], v[56:59]
s_waitcnt lgkmcnt(10)
v_cvt_pk_bf16_f32 v37, v38, v39
v_cvt_pk_bf16_f32 v38, v44, v45
v_mfma_f32_16x16x32_bf16 v[56:59], a[104:107], v[160:163], v[56:59]
s_waitcnt lgkmcnt(8)
v_cvt_pk_bf16_f32 v39, v46, v47
v_lshl_add_u32 v21, v22, 3, v21
v_mfma_f32_16x16x32_bf16 v[56:59], a[108:111], v[176:179], v[56:59]
s_waitcnt lgkmcnt(6)
buffer_store_dwordx4 v[36:39], v1, s[4:7], s12 offen offset:0 sc1
v_mfma_f32_16x16x32_bf16 v[56:59], a[112:115], v[192:195], v[56:59]
s_waitcnt lgkmcnt(4)
v_mfma_f32_16x16x32_bf16 v[56:59], a[116:119], v[208:211], v[56:59]
s_waitcnt lgkmcnt(2)
v_mfma_f32_16x16x32_bf16 v[56:59], a[120:123], v[224:227], v[56:59]
s_waitcnt lgkmcnt(0)
v_mfma_f32_16x16x32_bf16 v[56:59], a[124:127], v[240:243], v[56:59]
v_mfma_f32_16x16x32_bf16 v[60:63], a[96:99], v[132:135], 0
v_mfma_f32_16x16x32_bf16 v[60:63], a[100:103], v[148:151], v[60:63]
v_mfma_f32_16x16x32_bf16 v[60:63], a[104:107], v[164:167], v[60:63]
v_mfma_f32_16x16x32_bf16 v[60:63], a[108:111], v[180:183], v[60:63]
v_mfma_f32_16x16x32_bf16 v[60:63], a[112:115], v[196:199], v[60:63]
buffer_load_dword v18, v19, s[4:7], s33 offen offset:0 sc1
v_mfma_f32_16x16x32_bf16 v[60:63], a[116:119], v[212:215], v[60:63]
v_mfma_f32_16x16x32_bf16 v[60:63], a[120:123], v[228:231], v[60:63]
v_mfma_f32_16x16x32_bf16 v[60:63], a[124:127], v[244:247], v[60:63]
v_mul_f32 v48, v48, v24
v_mul_f32 v49, v49, v24
v_mul_f32 v50, v50, v24
v_mul_f32 v51, v51, v24
v_mul_f32 v56, v56, v24
v_mul_f32 v57, v57, v24
v_mul_f32 v58, v58, v24
v_mul_f32 v59, v59, v24
v_cvt_pk_bf16_f32 v48, v48, v49
v_cvt_pk_bf16_f32 v49, v50, v51
v_cvt_pk_bf16_f32 v50, v56, v57
v_cvt_pk_bf16_f32 v51, v58, v59
buffer_store_dwordx4 v[48:51], v1, s[4:7], s8 offen offset:1024 sc1
v_mul_f32 v52, v52, v25
v_mul_f32 v53, v53, v25
v_mul_f32 v54, v54, v25
v_mul_f32 v55, v55, v25
v_mul_f32 v60, v60, v25
v_mul_f32 v61, v61, v25
v_mul_f32 v62, v62, v25
v_mul_f32 v63, v63, v25
v_cvt_pk_bf16_f32 v52, v52, v53
v_cvt_pk_bf16_f32 v53, v54, v55
v_cvt_pk_bf16_f32 v54, v60, v61
v_cvt_pk_bf16_f32 v55, v62, v63
buffer_store_dwordx4 v[52:55], v1, s[4:7], s12 offen offset:1024 sc1
s_and_b32 s22, s2, 224
s_cmp_eq_u32 s22, 224
s_cbranch_scc1 M_final
s_waitcnt vmcnt(0)
s_barrier
buffer_store_dword v6, v5, s[4:7], s35 offen sc1
s_bitcmp0_b32 s2, 4
s_cbranch_scc1 M_rA
v_cmp_gt_u32 vcc, 1, v18
s_cbranch_vccnz M_rslow
M_rjoin:
buffer_load_dwordx4 v[128:131], v1, s[4:7], s26 offen sc1
s_add_u32 s26, s26, 14336
buffer_load_dwordx4 v[132:135], v1, s[4:7], s26 offen sc1
s_add_u32 s26, s26, 14336
buffer_load_dwordx4 v[136:139], v1, s[4:7], s26 offen sc1
s_add_u32 s26, s26, 14336
buffer_load_dwordx4 v[140:143], v1, s[4:7], s26 offen sc1
s_add_u32 s26, s26, 14336
buffer_load_dwordx4 v[144:147], v1, s[4:7], s26 offen sc1
s_add_u32 s26, s26, 14336
buffer_load_dwordx4 v[148:151], v1, s[4:7], s26 offen sc1
s_add_u32 s26, s26, 14336
buffer_load_dwordx4 v[152:155], v1, s[4:7], s26 offen sc1
s_add_u32 s26, s26, 14336
buffer_load_dwordx4 v[156:159], v1, s[4:7], s26 offen sc1
s_add_u32 s26, s26, 14336
buffer_load_dwordx4 v[160:163], v1, s[4:7], s26 offen sc1
s_add_u32 s26, s26, 14336
buffer_load_dwordx4 v[164:167], v1, s[4:7], s26 offen sc1
s_add_u32 s26, s26, 14336
buffer_load_dwordx4 v[168:171], v1, s[4:7], s26 offen sc1
s_add_u32 s26, s26, 14336
buffer_load_dwordx4 v[172:175], v1, s[4:7], s26 offen sc1
s_add_u32 s26, s26, 14336
buffer_load_dwordx4 v[176:179], v1, s[4:7], s26 offen sc1
s_add_u32 s26, s26, 14336
buffer_load_dwordx4 v[180:183], v1, s[4:7], s26 offen sc1
s_add_u32 s26, s26, 14336
buffer_load_dwordx4 v[184:187], v1, s[4:7], s26 offen sc1
s_add_u32 s26, s26, 14336
buffer_load_dwordx4 v[188:191], v1, s[4:7], s26 offen sc1
Lp_9201:
buffer_load_dword v18, v19, s[4:7], s33 offen offset:2048 sc1
s_waitcnt vmcnt(0)
v_cmp_gt_u32 vcc, 1, v18
s_cbranch_vccz Lpd_9202
s_sleep 8
s_sub_u32 s101, s101, 1
s_cbranch_scc0 Lp_9201
s_mov_b32 s101, 0
Lpd_9202:
s_sub_u32 s26, s26, 207872
buffer_load_dwordx4 v[192:195], v1, s[4:7], s26 offen sc1
s_add_u32 s26, s26, 14336
buffer_load_dwordx4 v[196:199], v1, s[4:7], s26 offen sc1
s_add_u32 s26, s26, 14336
buffer_load_dwordx4 v[200:203], v1, s[4:7], s26 offen sc1
s_add_u32 s26, s26, 14336
buffer_load_dwordx4 v[204:207], v1, s[4:7], s26 offen sc1
s_add_u32 s26, s26, 14336
buffer_load_dwordx4 v[208:211], v1, s[4:7], s26 offen sc1
s_add_u32 s26, s26, 14336
buffer_load_dwordx4 v[212:215], v1, s[4:7], s26 offen sc1
s_add_u32 s26, s26, 14336
buffer_load_dwordx4 v[216:219], v1, s[4:7], s26 offen sc1
s_add_u32 s26, s26, 14336
buffer_load_dwordx4 v[220:223], v1, s[4:7], s26 offen sc1
s_add_u32 s26, s26, 14336
buffer_load_dwordx4 v[224:227], v1, s[4:7], s26 offen sc1
s_add_u32 s26, s26, 14336
buffer_load_dwordx4 v[228:231], v1, s[4:7], s26 offen sc1
s_add_u32 s26, s26, 14336
buffer_load_dwordx4 v[232:235], v1, s[4:7], s26 offen sc1
s_add_u32 s26, s26, 14336
buffer_load_dwordx4 v[236:239], v1, s[4:7], s26 offen sc1
s_add_u32 s26, s26, 14336
buffer_load_dwordx4 v[240:243], v1, s[4:7], s26 offen sc1
s_add_u32 s26, s26, 14336
buffer_load_dwordx4 v[244:247], v1, s[4:7], s26 offen sc1
s_add_u32 s26, s26, 14336
buffer_load_dwordx4 v[248:251], v1, s[4:7], s26 offen sc1
s_add_u32 s26, s26, 14336
buffer_load_dwordx4 v[252:255], v1, s[4:7], s26 offen sc1
v_lshlrev_b32 v96, 16, v128
v_and_b32 v97, 0xffff0000, v128
v_lshlrev_b32 v98, 16, v129
v_and_b32 v99, 0xffff0000, v129
v_lshlrev_b32 v100, 16, v130
v_and_b32 v101, 0xffff0000, v130
v_lshlrev_b32 v102, 16, v131
v_and_b32 v103, 0xffff0000, v131
v_lshlrev_b32 v10, 16, v132
v_and_b32 v11, 0xffff0000, v132
v_lshlrev_b32 v12, 16, v133
v_and_b32 v13, 0xffff0000, v133
v_lshlrev_b32 v14, 16, v134
v_and_b32 v15, 0xffff0000, v134
v_lshlrev_b32 v16, 16, v135
v_and_b32 v17, 0xffff0000, v135
v_pk_add_f32 v[96:97], v[96:97], v[10:11]
v_pk_add_f32 v[98:99], v[98:99], v[12:13]
v_pk_add_f32 v[100:101], v[100:101], v[14:15]
v_pk_add_f32 v[102:103], v[102:103], v[16:17]
v_lshlrev_b32 v10, 16, v136
v_and_b32 v11, 0xffff0000, v136
v_lshlrev_b32 v12, 16, v137
v_and_b32 v13, 0xffff0000, v137
v_lshlrev_b32 v14, 16, v138
v_and_b32 v15, 0xffff0000, v138
v_lshlrev_b32 v16, 16, v139
v_and_b32 v17, 0xffff0000, v139
v_pk_add_f32 v[96:97], v[96:97], v[10:11]
v_pk_add_f32 v[98:99], v[98:99], v[12:13]
v_pk_add_f32 v[100:101], v[100:101], v[14:15]
v_pk_add_f32 v[102:103], v[102:103], v[16:17]
v_lshlrev_b32 v10, 16, v140
v_and_b32 v11, 0xffff0000, v140
v_lshlrev_b32 v12, 16, v141
v_and_b32 v13, 0xffff0000, v141
v_lshlrev_b32 v14, 16, v142
v_and_b32 v15, 0xffff0000, v142
v_lshlrev_b32 v16, 16, v143
v_and_b32 v17, 0xffff0000, v143
v_pk_add_f32 v[96:97], v[96:97], v[10:11]
v_pk_add_f32 v[98:99], v[98:99], v[12:13]
v_pk_add_f32 v[100:101], v[100:101], v[14:15]
v_pk_add_f32 v[102:103], v[102:103], v[16:17]
v_lshlrev_b32 v10, 16, v144
v_and_b32 v11, 0xffff0000, v144
v_lshlrev_b32 v12, 16, v145
v_and_b32 v13, 0xffff0000, v145
v_lshlrev_b32 v14, 16, v146
v_and_b32 v15, 0xffff0000, v146
v_lshlrev_b32 v16, 16, v147
v_and_b32 v17, 0xffff0000, v147
v_pk_add_f32 v[96:97], v[96:97], v[10:11]
v_pk_add_f32 v[98:99], v[98:99], v[12:13]
v_pk_add_f32 v[100:101], v[100:101], v[14:15]
v_pk_add_f32 v[102:103], v[102:103], v[16:17]
v_lshlrev_b32 v10, 16, v148
v_and_b32 v11, 0xffff0000, v148
v_lshlrev_b32 v12, 16, v149
v_and_b32 v13, 0xffff0000, v149
v_lshlrev_b32 v14, 16, v150
v_and_b32 v15, 0xffff0000, v150
v_lshlrev_b32 v16, 16, v151
v_and_b32 v17, 0xffff0000, v151
v_pk_add_f32 v[96:97], v[96:97], v[10:11]
v_pk_add_f32 v[98:99], v[98:99], v[12:13]
v_pk_add_f32 v[100:101], v[100:101], v[14:15]
v_pk_add_f32 v[102:103], v[102:103], v[16:17]
v_lshlrev_b32 v10, 16, v152
v_and_b32 v11, 0xffff0000, v152
v_lshlrev_b32 v12, 16, v153
v_and_b32 v13, 0xffff0000, v153
v_lshlrev_b32 v14, 16, v154
v_and_b32 v15, 0xffff0000, v154
v_lshlrev_b32 v16, 16, v155
v_and_b32 v17, 0xffff0000, v155
v_pk_add_f32 v[96:97], v[96:97], v[10:11]
v_pk_add_f32 v[98:99], v[98:99], v[12:13]
v_pk_add_f32 v[100:101], v[100:101], v[14:15]
v_pk_add_f32 v[102:103], v[102:103], v[16:17]
v_lshlrev_b32 v10, 16, v156
v_and_b32 v11, 0xffff0000, v156
v_lshlrev_b32 v12, 16, v157
v_and_b32 v13, 0xffff0000, v157
v_lshlrev_b32 v14, 16, v158
v_and_b32 v15, 0xffff0000, v158
v_lshlrev_b32 v16, 16, v159
v_and_b32 v17, 0xffff0000, v159
v_pk_add_f32 v[96:97], v[96:97], v[10:11]
v_pk_add_f32 v[98:99], v[98:99], v[12:13]
v_pk_add_f32 v[100:101], v[100:101], v[14:15]
v_pk_add_f32 v[102:103], v[102:103], v[16:17]
v_lshlrev_b32 v10, 16, v160
v_and_b32 v11, 0xffff0000, v160
v_lshlrev_b32 v12, 16, v161
v_and_b32 v13, 0xffff0000, v161
v_lshlrev_b32 v14, 16, v162
v_and_b32 v15, 0xffff0000, v162
v_lshlrev_b32 v16, 16, v163
v_and_b32 v17, 0xffff0000, v163
v_pk_add_f32 v[96:97], v[96:97], v[10:11]
v_pk_add_f32 v[98:99], v[98:99], v[12:13]
v_pk_add_f32 v[100:101], v[100:101], v[14:15]
v_pk_add_f32 v[102:103], v[102:103], v[16:17]
v_lshlrev_b32 v10, 16, v164
v_and_b32 v11, 0xffff0000, v164
v_lshlrev_b32 v12, 16, v165
v_and_b32 v13, 0xffff0000, v165
v_lshlrev_b32 v14, 16, v166
v_and_b32 v15, 0xffff0000, v166
v_lshlrev_b32 v16, 16, v167
v_and_b32 v17, 0xffff0000, v167
v_pk_add_f32 v[96:97], v[96:97], v[10:11]
v_pk_add_f32 v[98:99], v[98:99], v[12:13]
v_pk_add_f32 v[100:101], v[100:101], v[14:15]
v_pk_add_f32 v[102:103], v[102:103], v[16:17]
v_lshlrev_b32 v10, 16, v168
v_and_b32 v11, 0xffff0000, v168
v_lshlrev_b32 v12, 16, v169
v_and_b32 v13, 0xffff0000, v169
v_lshlrev_b32 v14, 16, v170
v_and_b32 v15, 0xffff0000, v170
v_lshlrev_b32 v16, 16, v171
v_and_b32 v17, 0xffff0000, v171
v_pk_add_f32 v[96:97], v[96:97], v[10:11]
v_pk_add_f32 v[98:99], v[98:99], v[12:13]
v_pk_add_f32 v[100:101], v[100:101], v[14:15]
v_pk_add_f32 v[102:103], v[102:103], v[16:17]
v_lshlrev_b32 v10, 16, v172
v_and_b32 v11, 0xffff0000, v172
v_lshlrev_b32 v12, 16, v173
v_and_b32 v13, 0xffff0000, v173
v_lshlrev_b32 v14, 16, v174
v_and_b32 v15, 0xffff0000, v174
v_lshlrev_b32 v16, 16, v175
v_and_b32 v17, 0xffff0000, v175
v_pk_add_f32 v[96:97], v[96:97], v[10:11]
v_pk_add_f32 v[98:99], v[98:99], v[12:13]
v_pk_add_f32 v[100:101], v[100:101], v[14:15]
v_pk_add_f32 v[102:103], v[102:103], v[16:17]
v_lshlrev_b32 v10, 16, v176
v_and_b32 v11, 0xffff0000, v176
v_lshlrev_b32 v12, 16, v177
v_and_b32 v13, 0xffff0000, v177
v_lshlrev_b32 v14, 16, v178
v_and_b32 v15, 0xffff0000, v178
v_lshlrev_b32 v16, 16, v179
v_and_b32 v17, 0xffff0000, v179
v_pk_add_f32 v[96:97], v[96:97], v[10:11]
v_pk_add_f32 v[98:99], v[98:99], v[12:13]
v_pk_add_f32 v[100:101], v[100:101], v[14:15]
v_pk_add_f32 v[102:103], v[102:103], v[16:17]
v_lshlrev_b32 v10, 16, v180
v_and_b32 v11, 0xffff0000, v180
v_lshlrev_b32 v12, 16, v181
v_and_b32 v13, 0xffff0000, v181
v_lshlrev_b32 v14, 16, v182
v_and_b32 v15, 0xffff0000, v182
v_lshlrev_b32 v16, 16, v183
v_and_b32 v17, 0xffff0000, v183
v_pk_add_f32 v[96:97], v[96:97], v[10:11]
v_pk_add_f32 v[98:99], v[98:99], v[12:13]
v_pk_add_f32 v[100:101], v[100:101], v[14:15]
v_pk_add_f32 v[102:103], v[102:103], v[16:17]
v_lshlrev_b32 v10, 16, v184
v_and_b32 v11, 0xffff0000, v184
v_lshlrev_b32 v12, 16, v185
v_and_b32 v13, 0xffff0000, v185
v_lshlrev_b32 v14, 16, v186
v_and_b32 v15, 0xffff0000, v186
v_lshlrev_b32 v16, 16, v187
v_and_b32 v17, 0xffff0000, v187
v_pk_add_f32 v[96:97], v[96:97], v[10:11]
v_pk_add_f32 v[98:99], v[98:99], v[12:13]
v_pk_add_f32 v[100:101], v[100:101], v[14:15]
v_pk_add_f32 v[102:103], v[102:103], v[16:17]
v_lshlrev_b32 v10, 16, v188
v_and_b32 v11, 0xffff0000, v188
v_lshlrev_b32 v12, 16, v189
v_and_b32 v13, 0xffff0000, v189
v_lshlrev_b32 v14, 16, v190
v_and_b32 v15, 0xffff0000, v190
v_lshlrev_b32 v16, 16, v191
v_and_b32 v17, 0xffff0000, v191
v_pk_add_f32 v[96:97], v[96:97], v[10:11]
v_pk_add_f32 v[98:99], v[98:99], v[12:13]
v_pk_add_f32 v[100:101], v[100:101], v[14:15]
v_pk_add_f32 v[102:103], v[102:103], v[16:17]
v_cvt_pk_bf16_f32 v96, v96, v97
v_cvt_pk_bf16_f32 v97, v98, v99
v_cvt_pk_bf16_f32 v98, v100, v101
v_cvt_pk_bf16_f32 v99, v102, v103
buffer_store_dwordx2 v[96:97], v21, s[40:43], s25 offen offset:896
buffer_store_dwordx2 v[98:99], v21, s[40:43], s25 offen offset:928
s_waitcnt vmcnt(17)
v_lshlrev_b32 v104, 16, v192
v_and_b32 v105, 0xffff0000, v192
v_lshlrev_b32 v106, 16, v193
v_and_b32 v107, 0xffff0000, v193
v_lshlrev_b32 v108, 16, v194
v_and_b32 v109, 0xffff0000, v194
v_lshlrev_b32 v110, 16, v195
v_and_b32 v111, 0xffff0000, v195
s_waitcnt vmcnt(16)
v_lshlrev_b32 v10, 16, v196
v_and_b32 v11, 0xffff0000, v196
v_lshlrev_b32 v12, 16, v197
v_and_b32 v13, 0xffff0000, v197
v_lshlrev_b32 v14, 16, v198
v_and_b32 v15, 0xffff0000, v198
v_lshlrev_b32 v16, 16, v199
v_and_b32 v17, 0xffff0000, v199
v_pk_add_f32 v[104:105], v[104:105], v[10:11]
v_pk_add_f32 v[106:107], v[106:107], v[12:13]
v_pk_add_f32 v[108:109], v[108:109], v[14:15]
v_pk_add_f32 v[110:111], v[110:111], v[16:17]
s_waitcnt vmcnt(15)
v_lshlrev_b32 v10, 16, v200
v_and_b32 v11, 0xffff0000, v200
v_lshlrev_b32 v12, 16, v201
v_and_b32 v13, 0xffff0000, v201
v_lshlrev_b32 v14, 16, v202
v_and_b32 v15, 0xffff0000, v202
v_lshlrev_b32 v16, 16, v203
v_and_b32 v17, 0xffff0000, v203
v_pk_add_f32 v[104:105], v[104:105], v[10:11]
v_pk_add_f32 v[106:107], v[106:107], v[12:13]
v_pk_add_f32 v[108:109], v[108:109], v[14:15]
v_pk_add_f32 v[110:111], v[110:111], v[16:17]
s_waitcnt vmcnt(14)
v_lshlrev_b32 v10, 16, v204
v_and_b32 v11, 0xffff0000, v204
v_lshlrev_b32 v12, 16, v205
v_and_b32 v13, 0xffff0000, v205
v_lshlrev_b32 v14, 16, v206
v_and_b32 v15, 0xffff0000, v206
v_lshlrev_b32 v16, 16, v207
v_and_b32 v17, 0xffff0000, v207
v_pk_add_f32 v[104:105], v[104:105], v[10:11]
v_pk_add_f32 v[106:107], v[106:107], v[12:13]
v_pk_add_f32 v[108:109], v[108:109], v[14:15]
v_pk_add_f32 v[110:111], v[110:111], v[16:17]
s_waitcnt vmcnt(13)
v_lshlrev_b32 v10, 16, v208
v_and_b32 v11, 0xffff0000, v208
v_lshlrev_b32 v12, 16, v209
v_and_b32 v13, 0xffff0000, v209
v_lshlrev_b32 v14, 16, v210
v_and_b32 v15, 0xffff0000, v210
v_lshlrev_b32 v16, 16, v211
v_and_b32 v17, 0xffff0000, v211
v_pk_add_f32 v[104:105], v[104:105], v[10:11]
v_pk_add_f32 v[106:107], v[106:107], v[12:13]
v_pk_add_f32 v[108:109], v[108:109], v[14:15]
v_pk_add_f32 v[110:111], v[110:111], v[16:17]
s_waitcnt vmcnt(12)
v_lshlrev_b32 v10, 16, v212
v_and_b32 v11, 0xffff0000, v212
v_lshlrev_b32 v12, 16, v213
v_and_b32 v13, 0xffff0000, v213
v_lshlrev_b32 v14, 16, v214
v_and_b32 v15, 0xffff0000, v214
v_lshlrev_b32 v16, 16, v215
v_and_b32 v17, 0xffff0000, v215
v_pk_add_f32 v[104:105], v[104:105], v[10:11]
v_pk_add_f32 v[106:107], v[106:107], v[12:13]
v_pk_add_f32 v[108:109], v[108:109], v[14:15]
v_pk_add_f32 v[110:111], v[110:111], v[16:17]
s_waitcnt vmcnt(11)
v_lshlrev_b32 v10, 16, v216
v_and_b32 v11, 0xffff0000, v216
v_lshlrev_b32 v12, 16, v217
v_and_b32 v13, 0xffff0000, v217
v_lshlrev_b32 v14, 16, v218
v_and_b32 v15, 0xffff0000, v218
v_lshlrev_b32 v16, 16, v219
v_and_b32 v17, 0xffff0000, v219
v_pk_add_f32 v[104:105], v[104:105], v[10:11]
v_pk_add_f32 v[106:107], v[106:107], v[12:13]
v_pk_add_f32 v[108:109], v[108:109], v[14:15]
v_pk_add_f32 v[110:111], v[110:111], v[16:17]
s_waitcnt vmcnt(10)
v_lshlrev_b32 v10, 16, v220
v_and_b32 v11, 0xffff0000, v220
v_lshlrev_b32 v12, 16, v221
v_and_b32 v13, 0xffff0000, v221
v_lshlrev_b32 v14, 16, v222
v_and_b32 v15, 0xffff0000, v222
v_lshlrev_b32 v16, 16, v223
v_and_b32 v17, 0xffff0000, v223
v_pk_add_f32 v[104:105], v[104:105], v[10:11]
v_pk_add_f32 v[106:107], v[106:107], v[12:13]
v_pk_add_f32 v[108:109], v[108:109], v[14:15]
v_pk_add_f32 v[110:111], v[110:111], v[16:17]
s_waitcnt vmcnt(9)
v_lshlrev_b32 v10, 16, v224
v_and_b32 v11, 0xffff0000, v224
v_lshlrev_b32 v12, 16, v225
v_and_b32 v13, 0xffff0000, v225
v_lshlrev_b32 v14, 16, v226
v_and_b32 v15, 0xffff0000, v226
v_lshlrev_b32 v16, 16, v227
v_and_b32 v17, 0xffff0000, v227
v_pk_add_f32 v[104:105], v[104:105], v[10:11]
v_pk_add_f32 v[106:107], v[106:107], v[12:13]
v_pk_add_f32 v[108:109], v[108:109], v[14:15]
v_pk_add_f32 v[110:111], v[110:111], v[16:17]
s_waitcnt vmcnt(8)
v_lshlrev_b32 v10, 16, v228
v_and_b32 v11, 0xffff0000, v228
v_lshlrev_b32 v12, 16, v229
v_and_b32 v13, 0xffff0000, v229
v_lshlrev_b32 v14, 16, v230
v_and_b32 v15, 0xffff0000, v230
v_lshlrev_b32 v16, 16, v231
v_and_b32 v17, 0xffff0000, v231
v_pk_add_f32 v[104:105], v[104:105], v[10:11]
v_pk_add_f32 v[106:107], v[106:107], v[12:13]
v_pk_add_f32 v[108:109], v[108:109], v[14:15]
v_pk_add_f32 v[110:111], v[110:111], v[16:17]
s_waitcnt vmcnt(7)
v_lshlrev_b32 v10, 16, v232
v_and_b32 v11, 0xffff0000, v232
v_lshlrev_b32 v12, 16, v233
v_and_b32 v13, 0xffff0000, v233
v_lshlrev_b32 v14, 16, v234
v_and_b32 v15, 0xffff0000, v234
v_lshlrev_b32 v16, 16, v235
v_and_b32 v17, 0xffff0000, v235
v_pk_add_f32 v[104:105], v[104:105], v[10:11]
v_pk_add_f32 v[106:107], v[106:107], v[12:13]
v_pk_add_f32 v[108:109], v[108:109], v[14:15]
v_pk_add_f32 v[110:111], v[110:111], v[16:17]
s_waitcnt vmcnt(6)
v_lshlrev_b32 v10, 16, v236
v_and_b32 v11, 0xffff0000, v236
v_lshlrev_b32 v12, 16, v237
v_and_b32 v13, 0xffff0000, v237
v_lshlrev_b32 v14, 16, v238
v_and_b32 v15, 0xffff0000, v238
v_lshlrev_b32 v16, 16, v239
v_and_b32 v17, 0xffff0000, v239
v_pk_add_f32 v[104:105], v[104:105], v[10:11]
v_pk_add_f32 v[106:107], v[106:107], v[12:13]
v_pk_add_f32 v[108:109], v[108:109], v[14:15]
v_pk_add_f32 v[110:111], v[110:111], v[16:17]
s_waitcnt vmcnt(5)
v_lshlrev_b32 v10, 16, v240
v_and_b32 v11, 0xffff0000, v240
v_lshlrev_b32 v12, 16, v241
v_and_b32 v13, 0xffff0000, v241
v_lshlrev_b32 v14, 16, v242
v_and_b32 v15, 0xffff0000, v242
v_lshlrev_b32 v16, 16, v243
v_and_b32 v17, 0xffff0000, v243
v_pk_add_f32 v[104:105], v[104:105], v[10:11]
v_pk_add_f32 v[106:107], v[106:107], v[12:13]
v_pk_add_f32 v[108:109], v[108:109], v[14:15]
v_pk_add_f32 v[110:111], v[110:111], v[16:17]
s_waitcnt vmcnt(4)
v_lshlrev_b32 v10, 16, v244
v_and_b32 v11, 0xffff0000, v244
v_lshlrev_b32 v12, 16, v245
v_and_b32 v13, 0xffff0000, v245
v_lshlrev_b32 v14, 16, v246
v_and_b32 v15, 0xffff0000, v246
v_lshlrev_b32 v16, 16, v247
v_and_b32 v17, 0xffff0000, v247
v_pk_add_f32 v[104:105], v[104:105], v[10:11]
v_pk_add_f32 v[106:107], v[106:107], v[12:13]
v_pk_add_f32 v[108:109], v[108:109], v[14:15]
v_pk_add_f32 v[110:111], v[110:111], v[16:17]
s_waitcnt vmcnt(3)
v_lshlrev_b32 v10, 16, v248
v_and_b32 v11, 0xffff0000, v248
v_lshlrev_b32 v12, 16, v249
v_and_b32 v13, 0xffff0000, v249
v_lshlrev_b32 v14, 16, v250
v_and_b32 v15, 0xffff0000, v250
v_lshlrev_b32 v16, 16, v251
v_and_b32 v17, 0xffff0000, v251
v_pk_add_f32 v[104:105], v[104:105], v[10:11]
v_pk_add_f32 v[106:107], v[106:107], v[12:13]
v_pk_add_f32 v[108:109], v[108:109], v[14:15]
v_pk_add_f32 v[110:111], v[110:111], v[16:17]
s_waitcnt vmcnt(2)
v_lshlrev_b32 v10, 16, v252
v_and_b32 v11, 0xffff0000, v252
v_lshlrev_b32 v12, 16, v253
v_and_b32 v13, 0xffff0000, v253
v_lshlrev_b32 v14, 16, v254
v_and_b32 v15, 0xffff0000, v254
v_lshlrev_b32 v16, 16, v255
v_and_b32 v17, 0xffff0000, v255
v_pk_add_f32 v[104:105], v[104:105], v[10:11]
v_pk_add_f32 v[106:107], v[106:107], v[12:13]
v_pk_add_f32 v[108:109], v[108:109], v[14:15]
v_pk_add_f32 v[110:111], v[110:111], v[16:17]
v_cvt_pk_bf16_f32 v104, v104, v105
v_cvt_pk_bf16_f32 v105, v106, v107
v_cvt_pk_bf16_f32 v106, v108, v109
v_cvt_pk_bf16_f32 v107, v110, v111
buffer_store_dwordx2 v[104:105], v21, s[40:43], s25 offen offset:1344
buffer_store_dwordx2 v[106:107], v21, s[40:43], s25 offen offset:1376
s_add_u32 s25, s25, 1835008
s_add_u32 s26, s26, 14457856
s_add_u32 s33, s33, 1024
s_branch M_r1
M_rA:
s_add_u32 s25, s25, 448
s_add_u32 s26, s26, 7168
s_add_u32 s33, s33, 2048
M_r1:
Lp_9203:
buffer_load_dword v18, v19, s[4:7], s33 offen offset:0 sc1
s_waitcnt vmcnt(0)
v_cmp_gt_u32 vcc, 1, v18
s_cbranch_vccz Lpd_9204
s_sleep 8
s_sub_u32 s101, s101, 1
s_cbranch_scc0 Lp_9203
s_mov_b32 s101, 0
Lpd_9204:
buffer_load_dwordx4 v[128:131], v1, s[4:7], s26 offen sc1
s_add_u32 s26, s26, 14336
buffer_load_dwordx4 v[132:135], v1, s[4:7], s26 offen sc1
s_add_u32 s26, s26, 14336
buffer_load_dwordx4 v[136:139], v1, s[4:7], s26 offen sc1
s_add_u32 s26, s26, 14336
buffer_load_dwordx4 v[140:143], v1, s[4:7], s26 offen sc1
s_add_u32 s26, s26, 14336
buffer_load_dwordx4 v[144:147], v1, s[4:7], s26 offen sc1
s_add_u32 s26, s26, 14336
buffer_load_dwordx4 v[148:151], v1, s[4:7], s26 offen sc1
s_add_u32 s26, s26, 14336
buffer_load_dwordx4 v[152:155], v1, s[4:7], s26 offen sc1
s_add_u32 s26, s26, 14336
buffer_load_dwordx4 v[156:159], v1, s[4:7], s26 offen sc1
s_add_u32 s26, s26, 14336
buffer_load_dwordx4 v[160:163], v1, s[4:7], s26 offen sc1
s_add_u32 s26, s26, 14336
buffer_load_dwordx4 v[164:167], v1, s[4:7], s26 offen sc1
s_add_u32 s26, s26, 14336
buffer_load_dwordx4 v[168:171], v1, s[4:7], s26 offen sc1
s_add_u32 s26, s26, 14336
buffer_load_dwordx4 v[172:175], v1, s[4:7], s26 offen sc1
s_add_u32 s26, s26, 14336
buffer_load_dwordx4 v[176:179], v1, s[4:7], s26 offen sc1
s_add_u32 s26, s26, 14336
buffer_load_dwordx4 v[180:183], v1, s[4:7], s26 offen sc1
s_add_u32 s26, s26, 14336
buffer_load_dwordx4 v[184:187], v1, s[4:7], s26 offen sc1
s_add_u32 s26, s26, 14336
buffer_load_dwordx4 v[188:191], v1, s[4:7], s26 offen sc1
s_waitcnt vmcnt(15)
v_lshlrev_b32 v96, 16, v128
v_and_b32 v97, 0xffff0000, v128
v_lshlrev_b32 v98, 16, v129
v_and_b32 v99, 0xffff0000, v129
v_lshlrev_b32 v100, 16, v130
v_and_b32 v101, 0xffff0000, v130
v_lshlrev_b32 v102, 16, v131
v_and_b32 v103, 0xffff0000, v131
s_waitcnt vmcnt(14)
v_lshlrev_b32 v10, 16, v132
v_and_b32 v11, 0xffff0000, v132
v_lshlrev_b32 v12, 16, v133
v_and_b32 v13, 0xffff0000, v133
v_lshlrev_b32 v14, 16, v134
v_and_b32 v15, 0xffff0000, v134
v_lshlrev_b32 v16, 16, v135
v_and_b32 v17, 0xffff0000, v135
v_pk_add_f32 v[96:97], v[96:97], v[10:11]
v_pk_add_f32 v[98:99], v[98:99], v[12:13]
v_pk_add_f32 v[100:101], v[100:101], v[14:15]
v_pk_add_f32 v[102:103], v[102:103], v[16:17]
s_waitcnt vmcnt(13)
v_lshlrev_b32 v10, 16, v136
v_and_b32 v11, 0xffff0000, v136
v_lshlrev_b32 v12, 16, v137
v_and_b32 v13, 0xffff0000, v137
v_lshlrev_b32 v14, 16, v138
v_and_b32 v15, 0xffff0000, v138
v_lshlrev_b32 v16, 16, v139
v_and_b32 v17, 0xffff0000, v139
v_pk_add_f32 v[96:97], v[96:97], v[10:11]
v_pk_add_f32 v[98:99], v[98:99], v[12:13]
v_pk_add_f32 v[100:101], v[100:101], v[14:15]
v_pk_add_f32 v[102:103], v[102:103], v[16:17]
s_waitcnt vmcnt(12)
v_lshlrev_b32 v10, 16, v140
v_and_b32 v11, 0xffff0000, v140
v_lshlrev_b32 v12, 16, v141
v_and_b32 v13, 0xffff0000, v141
v_lshlrev_b32 v14, 16, v142
v_and_b32 v15, 0xffff0000, v142
v_lshlrev_b32 v16, 16, v143
v_and_b32 v17, 0xffff0000, v143
v_pk_add_f32 v[96:97], v[96:97], v[10:11]
v_pk_add_f32 v[98:99], v[98:99], v[12:13]
v_pk_add_f32 v[100:101], v[100:101], v[14:15]
v_pk_add_f32 v[102:103], v[102:103], v[16:17]
s_waitcnt vmcnt(11)
v_lshlrev_b32 v10, 16, v144
v_and_b32 v11, 0xffff0000, v144
v_lshlrev_b32 v12, 16, v145
v_and_b32 v13, 0xffff0000, v145
v_lshlrev_b32 v14, 16, v146
v_and_b32 v15, 0xffff0000, v146
v_lshlrev_b32 v16, 16, v147
v_and_b32 v17, 0xffff0000, v147
v_pk_add_f32 v[96:97], v[96:97], v[10:11]
v_pk_add_f32 v[98:99], v[98:99], v[12:13]
v_pk_add_f32 v[100:101], v[100:101], v[14:15]
v_pk_add_f32 v[102:103], v[102:103], v[16:17]
s_waitcnt vmcnt(10)
v_lshlrev_b32 v10, 16, v148
v_and_b32 v11, 0xffff0000, v148
v_lshlrev_b32 v12, 16, v149
v_and_b32 v13, 0xffff0000, v149
v_lshlrev_b32 v14, 16, v150
v_and_b32 v15, 0xffff0000, v150
v_lshlrev_b32 v16, 16, v151
v_and_b32 v17, 0xffff0000, v151
v_pk_add_f32 v[96:97], v[96:97], v[10:11]
v_pk_add_f32 v[98:99], v[98:99], v[12:13]
v_pk_add_f32 v[100:101], v[100:101], v[14:15]
v_pk_add_f32 v[102:103], v[102:103], v[16:17]
s_waitcnt vmcnt(9)
v_lshlrev_b32 v10, 16, v152
v_and_b32 v11, 0xffff0000, v152
v_lshlrev_b32 v12, 16, v153
v_and_b32 v13, 0xffff0000, v153
v_lshlrev_b32 v14, 16, v154
v_and_b32 v15, 0xffff0000, v154
v_lshlrev_b32 v16, 16, v155
v_and_b32 v17, 0xffff0000, v155
v_pk_add_f32 v[96:97], v[96:97], v[10:11]
v_pk_add_f32 v[98:99], v[98:99], v[12:13]
v_pk_add_f32 v[100:101], v[100:101], v[14:15]
v_pk_add_f32 v[102:103], v[102:103], v[16:17]
s_waitcnt vmcnt(8)
v_lshlrev_b32 v10, 16, v156
v_and_b32 v11, 0xffff0000, v156
v_lshlrev_b32 v12, 16, v157
v_and_b32 v13, 0xffff0000, v157
v_lshlrev_b32 v14, 16, v158
v_and_b32 v15, 0xffff0000, v158
v_lshlrev_b32 v16, 16, v159
v_and_b32 v17, 0xffff0000, v159
v_pk_add_f32 v[96:97], v[96:97], v[10:11]
v_pk_add_f32 v[98:99], v[98:99], v[12:13]
v_pk_add_f32 v[100:101], v[100:101], v[14:15]
v_pk_add_f32 v[102:103], v[102:103], v[16:17]
s_waitcnt vmcnt(7)
v_lshlrev_b32 v10, 16, v160
v_and_b32 v11, 0xffff0000, v160
v_lshlrev_b32 v12, 16, v161
v_and_b32 v13, 0xffff0000, v161
v_lshlrev_b32 v14, 16, v162
v_and_b32 v15, 0xffff0000, v162
v_lshlrev_b32 v16, 16, v163
v_and_b32 v17, 0xffff0000, v163
v_pk_add_f32 v[96:97], v[96:97], v[10:11]
v_pk_add_f32 v[98:99], v[98:99], v[12:13]
v_pk_add_f32 v[100:101], v[100:101], v[14:15]
v_pk_add_f32 v[102:103], v[102:103], v[16:17]
s_waitcnt vmcnt(6)
v_lshlrev_b32 v10, 16, v164
v_and_b32 v11, 0xffff0000, v164
v_lshlrev_b32 v12, 16, v165
v_and_b32 v13, 0xffff0000, v165
v_lshlrev_b32 v14, 16, v166
v_and_b32 v15, 0xffff0000, v166
v_lshlrev_b32 v16, 16, v167
v_and_b32 v17, 0xffff0000, v167
v_pk_add_f32 v[96:97], v[96:97], v[10:11]
v_pk_add_f32 v[98:99], v[98:99], v[12:13]
v_pk_add_f32 v[100:101], v[100:101], v[14:15]
v_pk_add_f32 v[102:103], v[102:103], v[16:17]
s_waitcnt vmcnt(5)
v_lshlrev_b32 v10, 16, v168
v_and_b32 v11, 0xffff0000, v168
v_lshlrev_b32 v12, 16, v169
v_and_b32 v13, 0xffff0000, v169
v_lshlrev_b32 v14, 16, v170
v_and_b32 v15, 0xffff0000, v170
v_lshlrev_b32 v16, 16, v171
v_and_b32 v17, 0xffff0000, v171
v_pk_add_f32 v[96:97], v[96:97], v[10:11]
v_pk_add_f32 v[98:99], v[98:99], v[12:13]
v_pk_add_f32 v[100:101], v[100:101], v[14:15]
v_pk_add_f32 v[102:103], v[102:103], v[16:17]
s_waitcnt vmcnt(4)
v_lshlrev_b32 v10, 16, v172
v_and_b32 v11, 0xffff0000, v172
v_lshlrev_b32 v12, 16, v173
v_and_b32 v13, 0xffff0000, v173
v_lshlrev_b32 v14, 16, v174
v_and_b32 v15, 0xffff0000, v174
v_lshlrev_b32 v16, 16, v175
v_and_b32 v17, 0xffff0000, v175
v_pk_add_f32 v[96:97], v[96:97], v[10:11]
v_pk_add_f32 v[98:99], v[98:99], v[12:13]
v_pk_add_f32 v[100:101], v[100:101], v[14:15]
v_pk_add_f32 v[102:103], v[102:103], v[16:17]
s_waitcnt vmcnt(3)
v_lshlrev_b32 v10, 16, v176
v_and_b32 v11, 0xffff0000, v176
v_lshlrev_b32 v12, 16, v177
v_and_b32 v13, 0xffff0000, v177
v_lshlrev_b32 v14, 16, v178
v_and_b32 v15, 0xffff0000, v178
v_lshlrev_b32 v16, 16, v179
v_and_b32 v17, 0xffff0000, v179
v_pk_add_f32 v[96:97], v[96:97], v[10:11]
v_pk_add_f32 v[98:99], v[98:99], v[12:13]
v_pk_add_f32 v[100:101], v[100:101], v[14:15]
v_pk_add_f32 v[102:103], v[102:103], v[16:17]
s_waitcnt vmcnt(2)
v_lshlrev_b32 v10, 16, v180
v_and_b32 v11, 0xffff0000, v180
v_lshlrev_b32 v12, 16, v181
v_and_b32 v13, 0xffff0000, v181
v_lshlrev_b32 v14, 16, v182
v_and_b32 v15, 0xffff0000, v182
v_lshlrev_b32 v16, 16, v183
v_and_b32 v17, 0xffff0000, v183
v_pk_add_f32 v[96:97], v[96:97], v[10:11]
v_pk_add_f32 v[98:99], v[98:99], v[12:13]
v_pk_add_f32 v[100:101], v[100:101], v[14:15]
v_pk_add_f32 v[102:103], v[102:103], v[16:17]
s_waitcnt vmcnt(1)
v_lshlrev_b32 v10, 16, v184
v_and_b32 v11, 0xffff0000, v184
v_lshlrev_b32 v12, 16, v185
v_and_b32 v13, 0xffff0000, v185
v_lshlrev_b32 v14, 16, v186
v_and_b32 v15, 0xffff0000, v186
v_lshlrev_b32 v16, 16, v187
v_and_b32 v17, 0xffff0000, v187
v_pk_add_f32 v[96:97], v[96:97], v[10:11]
v_pk_add_f32 v[98:99], v[98:99], v[12:13]
v_pk_add_f32 v[100:101], v[100:101], v[14:15]
v_pk_add_f32 v[102:103], v[102:103], v[16:17]
s_waitcnt vmcnt(0)
v_lshlrev_b32 v10, 16, v188
v_and_b32 v11, 0xffff0000, v188
v_lshlrev_b32 v12, 16, v189
v_and_b32 v13, 0xffff0000, v189
v_lshlrev_b32 v14, 16, v190
v_and_b32 v15, 0xffff0000, v190
v_lshlrev_b32 v16, 16, v191
v_and_b32 v17, 0xffff0000, v191
v_pk_add_f32 v[96:97], v[96:97], v[10:11]
v_pk_add_f32 v[98:99], v[98:99], v[12:13]
v_pk_add_f32 v[100:101], v[100:101], v[14:15]
v_pk_add_f32 v[102:103], v[102:103], v[16:17]
v_cvt_pk_bf16_f32 v96, v96, v97
v_cvt_pk_bf16_f32 v97, v98, v99
v_cvt_pk_bf16_f32 v98, v100, v101
v_cvt_pk_bf16_f32 v99, v102, v103
buffer_store_dwordx2 v[96:97], v21, s[40:43], s25 offen offset:896
buffer_store_dwordx2 v[98:99], v21, s[40:43], s25 offen offset:928
M_fin:
s_endpgm
M_final:
s_mov_b32 s8, s64
s_mov_b32 s9, s65
s_mov_b32 s10, 1835008
s_mov_b32 s11, 0x20000
s_mov_b32 s12, s88
s_mov_b32 s13, s89
s_mov_b32 s14, 3670016
s_mov_b32 s15, 0x20000
s_and_b32 s24, s2, 16
s_add_u32 s24, s24, s20
v_lshrrev_b32 v20, 4, v1
v_and_b32 v21, 15, v20
v_lshrrev_b32 v22, 4, v20
v_mul_u32_u24 v2, 896, v21
v_lshlrev_b32 v9, 1, v2
v_lshl_add_u32 v2, v22, 4, v2
v_lshl_add_u32 v9, v22, 4, v9
s_lshl_b32 s22, s24, 2
s_add_u32 s22, s22, s3
s_mul_i32 s25, s22, 14336
s_lshl_b32 s26, s25, 1
v_lshlrev_b32 v10, 5, v22
v_add3_u32 v10, v10, v21, 16
v_lshlrev_b32 v10, 2, v10
v_min_u32 v11, 380, v10
v_add_u32 v11, 512, v11
s_mov_b32 s27, 94384128
Lfp:
buffer_load_dword v3, v10, s[4:7], s27 offen sc1
buffer_load_dword v4, v11, s[4:7], s27 offen sc1
s_waitcnt vmcnt(0)
v_and_b32 v3, v3, v4
v_cmp_gt_u32 vcc, 1, v3
s_cbranch_vccz Lfpd
s_sleep 2
s_sub_u32 s101, s101, 1
s_cbranch_scc0 Lfp
s_mov_b32 s101, 0
Lfpd:
s_barrier
buffer_store_dword v6, v5, s[4:7], s35 offen sc1
Lfg:
v_lshrrev_b32 v3, 3, v20
v_and_b32 v4, 7, v20
v_lshlrev_b32 v4, 4, v4
v_lshl_add_u32 v3, v3, 12, v4
s_mul_i32 s27, s3, 458752
s_lshl_b32 s22, s24, 7
s_add_u32 s27, s27, s22
s_add_u32 s27, s27, 88080384
s_mul_i32 s28, s3, 14336
s_add_u32 m0, s28, 0
s_nop 0
buffer_load_dwordx4 v3, s[4:7], s27 offen sc1 lds
s_add_u32 s27, s27, 32768
s_add_u32 m0, s28, 1024
s_nop 0
buffer_load_dwordx4 v3, s[4:7], s27 offen sc1 lds
s_add_u32 s27, s27, 32768
s_add_u32 m0, s28, 2048
s_nop 0
buffer_load_dwordx4 v3, s[4:7], s27 offen sc1 lds
s_add_u32 s27, s27, 32768
s_add_u32 m0, s28, 3072
s_nop 0
buffer_load_dwordx4 v3, s[4:7], s27 offen sc1 lds
s_add_u32 s27, s27, 32768
s_add_u32 m0, s28, 4096
s_nop 0
buffer_load_dwordx4 v3, s[4:7], s27 offen sc1 lds
s_add_u32 s27, s27, 32768
s_add_u32 m0, s28, 5120
s_nop 0
buffer_load_dwordx4 v3, s[4:7], s27 offen sc1 lds
s_add_u32 s27, s27, 32768
s_add_u32 m0, s28, 6144
s_nop 0
buffer_load_dwordx4 v3, s[4:7], s27 offen sc1 lds
s_add_u32 s27, s27, 32768
s_add_u32 m0, s28, 7168
s_nop 0
buffer_load_dwordx4 v3, s[4:7], s27 offen sc1 lds
s_add_u32 s27, s27, 32768
s_add_u32 m0, s28, 8192
s_nop 0
buffer_load_dwordx4 v3, s[4:7], s27 offen sc1 lds
s_add_u32 s27, s27, 32768
s_add_u32 m0, s28, 9216
s_nop 0
buffer_load_dwordx4 v3, s[4:7], s27 offen sc1 lds
s_add_u32 s27, s27, 32768
s_add_u32 m0, s28, 10240
s_nop 0
buffer_load_dwordx4 v3, s[4:7], s27 offen sc1 lds
s_add_u32 s27, s27, 32768
s_add_u32 m0, s28, 11264
s_nop 0
buffer_load_dwordx4 v3, s[4:7], s27 offen sc1 lds
s_add_u32 s27, s27, 32768
s_add_u32 m0, s28, 12288
s_nop 0
buffer_load_dwordx4 v3, s[4:7], s27 offen sc1 lds
s_add_u32 s27, s27, 32768
s_add_u32 m0, s28, 13312
s_nop 0
buffer_load_dwordx4 v3, s[4:7], s27 offen sc1 lds
s_add_u32 s27, s27, 32768
buffer_load_dwordx4 v[160:163], v2, s[8:11], s25 offen offset:0
buffer_load_dwordx4 v[164:167], v2, s[8:11], s25 offen offset:64
buffer_load_dwordx4 v[168:171], v2, s[8:11], s25 offen offset:128
buffer_load_dwordx4 v[172:175], v2, s[8:11], s25 offen offset:192
buffer_load_dwordx4 v[176:179], v2, s[8:11], s25 offen offset:256
buffer_load_dwordx4 v[180:183], v2, s[8:11], s25 offen offset:320
buffer_load_dwordx4 v[184:187], v2, s[8:11], s25 offen offset:384
buffer_load_dwordx4 v[188:191], v2, s[8:11], s25 offen offset:448
buffer_load_dwordx4 v[192:195], v2, s[8:11], s25 offen offset:512
buffer_load_dwordx4 v[196:199], v2, s[8:11], s25 offen offset:576
buffer_load_dwordx4 v[200:203], v2, s[8:11], s25 offen offset:640
buffer_load_dwordx4 v[204:207], v2, s[8:11], s25 offen offset:704
buffer_load_dwordx4 v[208:211], v2, s[8:11], s25 offen offset:768
buffer_load_dwordx4 v[212:215], v2, s[8:11], s25 offen offset:832
v_lshrrev_b32 v3, 2, v21
v_lshl_add_u32 v3, v22, 3, v3
v_lshlrev_b32 v3, 7, v3
v_and_b32 v4, 3, v20
v_lshl_add_u32 v3, v4, 3, v3
s_lshl_b32 s22, s3, 5
v_add_u32 v3, s22, v3
s_waitcnt vmcnt(14)
s_barrier
ds_read_b64_tr_b16 v[96:97], v3 offset:0
ds_read_b64_tr_b16 v[98:99], v3 offset:512
ds_read_b64_tr_b16 v[100:101], v3 offset:4096
ds_read_b64_tr_b16 v[102:103], v3 offset:4608
ds_read_b64_tr_b16 v[104:105], v3 offset:8192
ds_read_b64_tr_b16 v[106:107], v3 offset:8704
ds_read_b64_tr_b16 v[108:109], v3 offset:12288
ds_read_b64_tr_b16 v[110:111], v3 offset:12800
ds_read_b64_tr_b16 v[112:113], v3 offset:16384
ds_read_b64_tr_b16 v[114:115], v3 offset:16896
ds_read_b64_tr_b16 v[116:117], v3 offset:20480
ds_read_b64_tr_b16 v[118:119], v3 offset:20992
ds_read_b64_tr_b16 v[120:121], v3 offset:24576
ds_read_b64_tr_b16 v[122:123], v3 offset:25088
s_waitcnt lgkmcnt(0)
ds_read_b64_tr_b16 v[124:125], v3 offset:28672
ds_read_b64_tr_b16 v[126:127], v3 offset:29184
ds_read_b64_tr_b16 v[128:129], v3 offset:32768
ds_read_b64_tr_b16 v[130:131], v3 offset:33280
ds_read_b64_tr_b16 v[132:133], v3 offset:36864
ds_read_b64_tr_b16 v[134:135], v3 offset:37376
ds_read_b64_tr_b16 v[136:137], v3 offset:40960
ds_read_b64_tr_b16 v[138:139], v3 offset:41472
ds_read_b64_tr_b16 v[140:141], v3 offset:45056
ds_read_b64_tr_b16 v[142:143], v3 offset:45568
ds_read_b64_tr_b16 v[144:145], v3 offset:49152
ds_read_b64_tr_b16 v[146:147], v3 offset:49664
ds_read_b64_tr_b16 v[148:149], v3 offset:53248
ds_read_b64_tr_b16 v[150:151], v3 offset:53760
s_waitcnt vmcnt(13)
v_lshlrev_b32 v10, 16, v160
v_and_b32 v11, 0xffff0000, v160
v_lshlrev_b32 v12, 16, v96
v_and_b32 v13, 0xffff0000, v96
v_pk_mul_f32 v[10:11], v[10:11], v[12:13]
v_cvt_pk_bf16_f32 v160, v10, v11
v_lshlrev_b32 v10, 16, v161
v_and_b32 v11, 0xffff0000, v161
v_lshlrev_b32 v12, 16, v97
v_and_b32 v13, 0xffff0000, v97
v_pk_mul_f32 v[10:11], v[10:11], v[12:13]
v_cvt_pk_bf16_f32 v161, v10, v11
v_lshlrev_b32 v10, 16, v162
v_and_b32 v11, 0xffff0000, v162
v_lshlrev_b32 v12, 16, v98
v_and_b32 v13, 0xffff0000, v98
v_pk_mul_f32 v[10:11], v[10:11], v[12:13]
v_cvt_pk_bf16_f32 v162, v10, v11
v_lshlrev_b32 v10, 16, v163
v_and_b32 v11, 0xffff0000, v163
v_lshlrev_b32 v12, 16, v99
v_and_b32 v13, 0xffff0000, v99
v_pk_mul_f32 v[10:11], v[10:11], v[12:13]
v_cvt_pk_bf16_f32 v163, v10, v11
buffer_store_dwordx4 v[160:163], v9, s[12:15], s26 offen offset:0
s_waitcnt vmcnt(13)
v_lshlrev_b32 v10, 16, v164
v_and_b32 v11, 0xffff0000, v164
v_lshlrev_b32 v12, 16, v100
v_and_b32 v13, 0xffff0000, v100
v_pk_mul_f32 v[10:11], v[10:11], v[12:13]
v_cvt_pk_bf16_f32 v164, v10, v11
v_lshlrev_b32 v10, 16, v165
v_and_b32 v11, 0xffff0000, v165
v_lshlrev_b32 v12, 16, v101
v_and_b32 v13, 0xffff0000, v101
v_pk_mul_f32 v[10:11], v[10:11], v[12:13]
v_cvt_pk_bf16_f32 v165, v10, v11
v_lshlrev_b32 v10, 16, v166
v_and_b32 v11, 0xffff0000, v166
v_lshlrev_b32 v12, 16, v102
v_and_b32 v13, 0xffff0000, v102
v_pk_mul_f32 v[10:11], v[10:11], v[12:13]
v_cvt_pk_bf16_f32 v166, v10, v11
v_lshlrev_b32 v10, 16, v167
v_and_b32 v11, 0xffff0000, v167
v_lshlrev_b32 v12, 16, v103
v_and_b32 v13, 0xffff0000, v103
v_pk_mul_f32 v[10:11], v[10:11], v[12:13]
v_cvt_pk_bf16_f32 v167, v10, v11
buffer_store_dwordx4 v[164:167], v9, s[12:15], s26 offen offset:64
s_waitcnt vmcnt(13)
v_lshlrev_b32 v10, 16, v168
v_and_b32 v11, 0xffff0000, v168
v_lshlrev_b32 v12, 16, v104
v_and_b32 v13, 0xffff0000, v104
v_pk_mul_f32 v[10:11], v[10:11], v[12:13]
v_cvt_pk_bf16_f32 v168, v10, v11
v_lshlrev_b32 v10, 16, v169
v_and_b32 v11, 0xffff0000, v169
v_lshlrev_b32 v12, 16, v105
v_and_b32 v13, 0xffff0000, v105
v_pk_mul_f32 v[10:11], v[10:11], v[12:13]
v_cvt_pk_bf16_f32 v169, v10, v11
v_lshlrev_b32 v10, 16, v170
v_and_b32 v11, 0xffff0000, v170
v_lshlrev_b32 v12, 16, v106
v_and_b32 v13, 0xffff0000, v106
v_pk_mul_f32 v[10:11], v[10:11], v[12:13]
v_cvt_pk_bf16_f32 v170, v10, v11
v_lshlrev_b32 v10, 16, v171
v_and_b32 v11, 0xffff0000, v171
v_lshlrev_b32 v12, 16, v107
v_and_b32 v13, 0xffff0000, v107
v_pk_mul_f32 v[10:11], v[10:11], v[12:13]
v_cvt_pk_bf16_f32 v171, v10, v11
buffer_store_dwordx4 v[168:171], v9, s[12:15], s26 offen offset:128
s_waitcnt vmcnt(13)
v_lshlrev_b32 v10, 16, v172
v_and_b32 v11, 0xffff0000, v172
v_lshlrev_b32 v12, 16, v108
v_and_b32 v13, 0xffff0000, v108
v_pk_mul_f32 v[10:11], v[10:11], v[12:13]
v_cvt_pk_bf16_f32 v172, v10, v11
v_lshlrev_b32 v10, 16, v173
v_and_b32 v11, 0xffff0000, v173
v_lshlrev_b32 v12, 16, v109
v_and_b32 v13, 0xffff0000, v109
v_pk_mul_f32 v[10:11], v[10:11], v[12:13]
v_cvt_pk_bf16_f32 v173, v10, v11
v_lshlrev_b32 v10, 16, v174
v_and_b32 v11, 0xffff0000, v174
v_lshlrev_b32 v12, 16, v110
v_and_b32 v13, 0xffff0000, v110
v_pk_mul_f32 v[10:11], v[10:11], v[12:13]
v_cvt_pk_bf16_f32 v174, v10, v11
v_lshlrev_b32 v10, 16, v175
v_and_b32 v11, 0xffff0000, v175
v_lshlrev_b32 v12, 16, v111
v_and_b32 v13, 0xffff0000, v111
v_pk_mul_f32 v[10:11], v[10:11], v[12:13]
v_cvt_pk_bf16_f32 v175, v10, v11
buffer_store_dwordx4 v[172:175], v9, s[12:15], s26 offen offset:192
s_waitcnt vmcnt(13)
v_lshlrev_b32 v10, 16, v176
v_and_b32 v11, 0xffff0000, v176
v_lshlrev_b32 v12, 16, v112
v_and_b32 v13, 0xffff0000, v112
v_pk_mul_f32 v[10:11], v[10:11], v[12:13]
v_cvt_pk_bf16_f32 v176, v10, v11
v_lshlrev_b32 v10, 16, v177
v_and_b32 v11, 0xffff0000, v177
v_lshlrev_b32 v12, 16, v113
v_and_b32 v13, 0xffff0000, v113
v_pk_mul_f32 v[10:11], v[10:11], v[12:13]
v_cvt_pk_bf16_f32 v177, v10, v11
v_lshlrev_b32 v10, 16, v178
v_and_b32 v11, 0xffff0000, v178
v_lshlrev_b32 v12, 16, v114
v_and_b32 v13, 0xffff0000, v114
v_pk_mul_f32 v[10:11], v[10:11], v[12:13]
v_cvt_pk_bf16_f32 v178, v10, v11
v_lshlrev_b32 v10, 16, v179
v_and_b32 v11, 0xffff0000, v179
v_lshlrev_b32 v12, 16, v115
v_and_b32 v13, 0xffff0000, v115
v_pk_mul_f32 v[10:11], v[10:11], v[12:13]
v_cvt_pk_bf16_f32 v179, v10, v11
buffer_store_dwordx4 v[176:179], v9, s[12:15], s26 offen offset:256
s_waitcnt vmcnt(13)
v_lshlrev_b32 v10, 16, v180
v_and_b32 v11, 0xffff0000, v180
v_lshlrev_b32 v12, 16, v116
v_and_b32 v13, 0xffff0000, v116
v_pk_mul_f32 v[10:11], v[10:11], v[12:13]
v_cvt_pk_bf16_f32 v180, v10, v11
v_lshlrev_b32 v10, 16, v181
v_and_b32 v11, 0xffff0000, v181
v_lshlrev_b32 v12, 16, v117
v_and_b32 v13, 0xffff0000, v117
v_pk_mul_f32 v[10:11], v[10:11], v[12:13]
v_cvt_pk_bf16_f32 v181, v10, v11
v_lshlrev_b32 v10, 16, v182
v_and_b32 v11, 0xffff0000, v182
v_lshlrev_b32 v12, 16, v118
v_and_b32 v13, 0xffff0000, v118
v_pk_mul_f32 v[10:11], v[10:11], v[12:13]
v_cvt_pk_bf16_f32 v182, v10, v11
v_lshlrev_b32 v10, 16, v183
v_and_b32 v11, 0xffff0000, v183
v_lshlrev_b32 v12, 16, v119
v_and_b32 v13, 0xffff0000, v119
v_pk_mul_f32 v[10:11], v[10:11], v[12:13]
v_cvt_pk_bf16_f32 v183, v10, v11
buffer_store_dwordx4 v[180:183], v9, s[12:15], s26 offen offset:320
s_waitcnt vmcnt(13)
v_lshlrev_b32 v10, 16, v184
v_and_b32 v11, 0xffff0000, v184
v_lshlrev_b32 v12, 16, v120
v_and_b32 v13, 0xffff0000, v120
v_pk_mul_f32 v[10:11], v[10:11], v[12:13]
v_cvt_pk_bf16_f32 v184, v10, v11
v_lshlrev_b32 v10, 16, v185
v_and_b32 v11, 0xffff0000, v185
v_lshlrev_b32 v12, 16, v121
v_and_b32 v13, 0xffff0000, v121
v_pk_mul_f32 v[10:11], v[10:11], v[12:13]
v_cvt_pk_bf16_f32 v185, v10, v11
v_lshlrev_b32 v10, 16, v186
v_and_b32 v11, 0xffff0000, v186
v_lshlrev_b32 v12, 16, v122
v_and_b32 v13, 0xffff0000, v122
v_pk_mul_f32 v[10:11], v[10:11], v[12:13]
v_cvt_pk_bf16_f32 v186, v10, v11
v_lshlrev_b32 v10, 16, v187
v_and_b32 v11, 0xffff0000, v187
v_lshlrev_b32 v12, 16, v123
v_and_b32 v13, 0xffff0000, v123
v_pk_mul_f32 v[10:11], v[10:11], v[12:13]
v_cvt_pk_bf16_f32 v187, v10, v11
buffer_store_dwordx4 v[184:187], v9, s[12:15], s26 offen offset:384
s_waitcnt lgkmcnt(0)
s_waitcnt vmcnt(13)
v_lshlrev_b32 v10, 16, v188
v_and_b32 v11, 0xffff0000, v188
v_lshlrev_b32 v12, 16, v124
v_and_b32 v13, 0xffff0000, v124
v_pk_mul_f32 v[10:11], v[10:11], v[12:13]
v_cvt_pk_bf16_f32 v188, v10, v11
v_lshlrev_b32 v10, 16, v189
v_and_b32 v11, 0xffff0000, v189
v_lshlrev_b32 v12, 16, v125
v_and_b32 v13, 0xffff0000, v125
v_pk_mul_f32 v[10:11], v[10:11], v[12:13]
v_cvt_pk_bf16_f32 v189, v10, v11
v_lshlrev_b32 v10, 16, v190
v_and_b32 v11, 0xffff0000, v190
v_lshlrev_b32 v12, 16, v126
v_and_b32 v13, 0xffff0000, v126
v_pk_mul_f32 v[10:11], v[10:11], v[12:13]
v_cvt_pk_bf16_f32 v190, v10, v11
v_lshlrev_b32 v10, 16, v191
v_and_b32 v11, 0xffff0000, v191
v_lshlrev_b32 v12, 16, v127
v_and_b32 v13, 0xffff0000, v127
v_pk_mul_f32 v[10:11], v[10:11], v[12:13]
v_cvt_pk_bf16_f32 v191, v10, v11
buffer_store_dwordx4 v[188:191], v9, s[12:15], s26 offen offset:448
s_waitcnt vmcnt(13)
v_lshlrev_b32 v10, 16, v192
v_and_b32 v11, 0xffff0000, v192
v_lshlrev_b32 v12, 16, v128
v_and_b32 v13, 0xffff0000, v128
v_pk_mul_f32 v[10:11], v[10:11], v[12:13]
v_cvt_pk_bf16_f32 v192, v10, v11
v_lshlrev_b32 v10, 16, v193
v_and_b32 v11, 0xffff0000, v193
v_lshlrev_b32 v12, 16, v129
v_and_b32 v13, 0xffff0000, v129
v_pk_mul_f32 v[10:11], v[10:11], v[12:13]
v_cvt_pk_bf16_f32 v193, v10, v11
v_lshlrev_b32 v10, 16, v194
v_and_b32 v11, 0xffff0000, v194
v_lshlrev_b32 v12, 16, v130
v_and_b32 v13, 0xffff0000, v130
v_pk_mul_f32 v[10:11], v[10:11], v[12:13]
v_cvt_pk_bf16_f32 v194, v10, v11
v_lshlrev_b32 v10, 16, v195
v_and_b32 v11, 0xffff0000, v195
v_lshlrev_b32 v12, 16, v131
v_and_b32 v13, 0xffff0000, v131
v_pk_mul_f32 v[10:11], v[10:11], v[12:13]
v_cvt_pk_bf16_f32 v195, v10, v11
buffer_store_dwordx4 v[192:195], v9, s[12:15], s26 offen offset:512
s_waitcnt vmcnt(13)
v_lshlrev_b32 v10, 16, v196
v_and_b32 v11, 0xffff0000, v196
v_lshlrev_b32 v12, 16, v132
v_and_b32 v13, 0xffff0000, v132
v_pk_mul_f32 v[10:11], v[10:11], v[12:13]
v_cvt_pk_bf16_f32 v196, v10, v11
v_lshlrev_b32 v10, 16, v197
v_and_b32 v11, 0xffff0000, v197
v_lshlrev_b32 v12, 16, v133
v_and_b32 v13, 0xffff0000, v133
v_pk_mul_f32 v[10:11], v[10:11], v[12:13]
v_cvt_pk_bf16_f32 v197, v10, v11
v_lshlrev_b32 v10, 16, v198
v_and_b32 v11, 0xffff0000, v198
v_lshlrev_b32 v12, 16, v134
v_and_b32 v13, 0xffff0000, v134
v_pk_mul_f32 v[10:11], v[10:11], v[12:13]
v_cvt_pk_bf16_f32 v198, v10, v11
v_lshlrev_b32 v10, 16, v199
v_and_b32 v11, 0xffff0000, v199
v_lshlrev_b32 v12, 16, v135
v_and_b32 v13, 0xffff0000, v135
v_pk_mul_f32 v[10:11], v[10:11], v[12:13]
v_cvt_pk_bf16_f32 v199, v10, v11
buffer_store_dwordx4 v[196:199], v9, s[12:15], s26 offen offset:576
s_waitcnt vmcnt(13)
v_lshlrev_b32 v10, 16, v200
v_and_b32 v11, 0xffff0000, v200
v_lshlrev_b32 v12, 16, v136
v_and_b32 v13, 0xffff0000, v136
v_pk_mul_f32 v[10:11], v[10:11], v[12:13]
v_cvt_pk_bf16_f32 v200, v10, v11
v_lshlrev_b32 v10, 16, v201
v_and_b32 v11, 0xffff0000, v201
v_lshlrev_b32 v12, 16, v137
v_and_b32 v13, 0xffff0000, v137
v_pk_mul_f32 v[10:11], v[10:11], v[12:13]
v_cvt_pk_bf16_f32 v201, v10, v11
v_lshlrev_b32 v10, 16, v202
v_and_b32 v11, 0xffff0000, v202
v_lshlrev_b32 v12, 16, v138
v_and_b32 v13, 0xffff0000, v138
v_pk_mul_f32 v[10:11], v[10:11], v[12:13]
v_cvt_pk_bf16_f32 v202, v10, v11
v_lshlrev_b32 v10, 16, v203
v_and_b32 v11, 0xffff0000, v203
v_lshlrev_b32 v12, 16, v139
v_and_b32 v13, 0xffff0000, v139
v_pk_mul_f32 v[10:11], v[10:11], v[12:13]
v_cvt_pk_bf16_f32 v203, v10, v11
buffer_store_dwordx4 v[200:203], v9, s[12:15], s26 offen offset:640
s_waitcnt vmcnt(13)
v_lshlrev_b32 v10, 16, v204
v_and_b32 v11, 0xffff0000, v204
v_lshlrev_b32 v12, 16, v140
v_and_b32 v13, 0xffff0000, v140
v_pk_mul_f32 v[10:11], v[10:11], v[12:13]
v_cvt_pk_bf16_f32 v204, v10, v11
v_lshlrev_b32 v10, 16, v205
v_and_b32 v11, 0xffff0000, v205
v_lshlrev_b32 v12, 16, v141
v_and_b32 v13, 0xffff0000, v141
v_pk_mul_f32 v[10:11], v[10:11], v[12:13]
v_cvt_pk_bf16_f32 v205, v10, v11
v_lshlrev_b32 v10, 16, v206
v_and_b32 v11, 0xffff0000, v206
v_lshlrev_b32 v12, 16, v142
v_and_b32 v13, 0xffff0000, v142
v_pk_mul_f32 v[10:11], v[10:11], v[12:13]
v_cvt_pk_bf16_f32 v206, v10, v11
v_lshlrev_b32 v10, 16, v207
v_and_b32 v11, 0xffff0000, v207
v_lshlrev_b32 v12, 16, v143
v_and_b32 v13, 0xffff0000, v143
v_pk_mul_f32 v[10:11], v[10:11], v[12:13]
v_cvt_pk_bf16_f32 v207, v10, v11
buffer_store_dwordx4 v[204:207], v9, s[12:15], s26 offen offset:704
s_waitcnt vmcnt(13)
v_lshlrev_b32 v10, 16, v208
v_and_b32 v11, 0xffff0000, v208
v_lshlrev_b32 v12, 16, v144
v_and_b32 v13, 0xffff0000, v144
v_pk_mul_f32 v[10:11], v[10:11], v[12:13]
v_cvt_pk_bf16_f32 v208, v10, v11
v_lshlrev_b32 v10, 16, v209
v_and_b32 v11, 0xffff0000, v209
v_lshlrev_b32 v12, 16, v145
v_and_b32 v13, 0xffff0000, v145
v_pk_mul_f32 v[10:11], v[10:11], v[12:13]
v_cvt_pk_bf16_f32 v209, v10, v11
v_lshlrev_b32 v10, 16, v210
v_and_b32 v11, 0xffff0000, v210
v_lshlrev_b32 v12, 16, v146
v_and_b32 v13, 0xffff0000, v146
v_pk_mul_f32 v[10:11], v[10:11], v[12:13]
v_cvt_pk_bf16_f32 v210, v10, v11
v_lshlrev_b32 v10, 16, v211
v_and_b32 v11, 0xffff0000, v211
v_lshlrev_b32 v12, 16, v147
v_and_b32 v13, 0xffff0000, v147
v_pk_mul_f32 v[10:11], v[10:11], v[12:13]
v_cvt_pk_bf16_f32 v211, v10, v11
buffer_store_dwordx4 v[208:211], v9, s[12:15], s26 offen offset:768
s_waitcnt vmcnt(13)
v_lshlrev_b32 v10, 16, v212
v_and_b32 v11, 0xffff0000, v212
v_lshlrev_b32 v12, 16, v148
v_and_b32 v13, 0xffff0000, v148
v_pk_mul_f32 v[10:11], v[10:11], v[12:13]
v_cvt_pk_bf16_f32 v212, v10, v11
v_lshlrev_b32 v10, 16, v213
v_and_b32 v11, 0xffff0000, v213
v_lshlrev_b32 v12, 16, v149
v_and_b32 v13, 0xffff0000, v149
v_pk_mul_f32 v[10:11], v[10:11], v[12:13]
v_cvt_pk_bf16_f32 v213, v10, v11
v_lshlrev_b32 v10, 16, v214
v_and_b32 v11, 0xffff0000, v214
v_lshlrev_b32 v12, 16, v150
v_and_b32 v13, 0xffff0000, v150
v_pk_mul_f32 v[10:11], v[10:11], v[12:13]
v_cvt_pk_bf16_f32 v214, v10, v11
v_lshlrev_b32 v10, 16, v215
v_and_b32 v11, 0xffff0000, v215
v_lshlrev_b32 v12, 16, v151
v_and_b32 v13, 0xffff0000, v151
v_pk_mul_f32 v[10:11], v[10:11], v[12:13]
v_cvt_pk_bf16_f32 v215, v10, v11
buffer_store_dwordx4 v[212:215], v9, s[12:15], s26 offen offset:832
s_branch M_fin
M_rslow:
Lp_9251:
buffer_load_dword v18, v19, s[4:7], s33 offen offset:0 sc1
s_waitcnt vmcnt(0)
v_cmp_gt_u32 vcc, 1, v18
s_cbranch_vccz Lpd_9252
s_sleep 8
s_sub_u32 s101, s101, 1
s_cbranch_scc0 Lp_9251
s_mov_b32 s101, 0
Lpd_9252:
s_branch M_rjoin
M_conv:
v_mfma_f32_16x16x32_bf16 v[36:39], a[128:131], a[0:3], 0
s_waitcnt lgkmcnt(0)
s_add_u32 m0, s29, 114688
ds_read_b64_tr_b16 a[136:137], v23 offset:0
v_mfma_f32_16x16x32_bf16 v[36:39], a[132:135], a[4:7], v[36:39]
buffer_load_dwordx4 v16, s[12:15], s27 offen offset:0 lds
v_mfma_f32_16x16x32_bf16 v[44:47], a[128:131], a[8:11], 0
ds_read_b64_tr_b16 a[138:139], v23 offset:2048
v_mfma_f32_16x16x32_bf16 v[44:47], a[132:135], a[12:15], v[44:47]
ds_read_b128 a[64:67], v2 offset:16384
ds_read_b128 a[68:71], v3 offset:16384
v_mfma_f32_16x16x32_bf16 v[52:55], a[128:131], a[16:19], 0
ds_read_b64_tr_b16 a[140:141], v23 offset:16384
v_mfma_f32_16x16x32_bf16 v[52:55], a[132:135], a[20:23], v[52:55]
buffer_load_dwordx4 v17, s[12:15], s27 offen offset:1024 lds
v_mfma_f32_16x16x32_bf16 v[60:63], a[128:131], a[24:27], 0
ds_read_b64_tr_b16 a[142:143], v23 offset:18432
v_add_u32 v23, 4294901760, v23
v_mfma_f32_16x16x32_bf16 v[60:63], a[132:135], a[28:31], v[60:63]
buffer_store_dwordx4 v[96:99], v1, s[4:7], s31 offen sc1
v_mfma_f32_16x16x32_bf16 v[68:71], a[128:131], a[32:35], 0
s_add_u32 s31, s31, s32
ds_read_b128 a[72:75], v2 offset:18432
v_mfma_f32_16x16x32_bf16 v[68:71], a[132:135], a[36:39], v[68:71]
buffer_load_dwordx4 v18, s[12:15], s27 offen offset:2048 lds
v_mfma_f32_16x16x32_bf16 v[76:79], a[128:131], a[40:43], 0
ds_read_b128 a[76:79], v3 offset:18432
v_mfma_f32_16x16x32_bf16 v[76:79], a[132:135], a[44:47], v[76:79]
ds_read_b128 a[80:83], v2 offset:20480
v_mfma_f32_16x16x32_bf16 v[84:87], a[128:131], a[48:51], 0
ds_read_b128 a[84:87], v3 offset:20480
v_mfma_f32_16x16x32_bf16 v[84:87], a[132:135], a[52:55], v[84:87]
buffer_load_dwordx4 v19, s[12:15], s27 offen offset:3072 lds
v_mfma_f32_16x16x32_bf16 v[92:95], a[128:131], a[56:59], 0
s_add_u32 s27, s27, 524288
ds_read_b128 a[88:91], v2 offset:22528
v_mfma_f32_16x16x32_bf16 v[92:95], a[132:135], a[60:63], v[92:95]
s_waitcnt lgkmcnt(9)
buffer_store_dwordx4 v[104:107], v1, s[4:7], s31 offen sc1
v_mfma_f32_16x16x32_bf16 v[100:103], a[136:139], a[0:3], 0
s_waitcnt lgkmcnt(5)
s_add_u32 m0, s28, 0
ds_read_b64_tr_b16 a[128:129], v24 offset:0
v_mfma_f32_16x16x32_bf16 v[100:103], a[140:143], a[4:7], v[100:103]
s_add_u32 s31, s31, s33
buffer_load_dwordx4 v12, s[8:11], s24 offen offset:0 lds
v_mfma_f32_16x16x32_bf16 v[108:111], a[136:139], a[8:11], 0
ds_read_b64_tr_b16 a[130:131], v24 offset:2048
v_mfma_f32_16x16x32_bf16 v[108:111], a[140:143], a[12:15], v[108:111]
ds_read_b128 a[92:95], v3 offset:22528
v_mfma_f32_16x16x32_bf16 v[116:119], a[136:139], a[16:19], 0
ds_read_b64_tr_b16 a[132:133], v24 offset:16384
v_mfma_f32_16x16x32_bf16 v[116:119], a[140:143], a[20:23], v[116:119]
buffer_load_dwordx4 v13, s[8:11], s24 offen offset:1024 lds
v_mfma_f32_16x16x32_bf16 v[124:127], a[136:139], a[24:27], 0
ds_read_b64_tr_b16 a[134:135], v24 offset:18432
v_add_u32 v24, 4294901760, v24
v_mfma_f32_16x16x32_bf16 v[124:127], a[140:143], a[28:31], v[124:127]
v_mfma_f32_16x16x32_bf16 v[132:135], a[136:139], a[32:35], 0
ds_read_b128 a[96:99], v2 offset:24576
v_mfma_f32_16x16x32_bf16 v[132:135], a[140:143], a[36:39], v[132:135]
buffer_load_dwordx4 v14, s[8:11], s24 offen offset:2048 lds
v_mfma_f32_16x16x32_bf16 v[140:143], a[136:139], a[40:43], 0
ds_read_b128 a[100:103], v3 offset:24576
v_mfma_f32_16x16x32_bf16 v[140:143], a[140:143], a[44:47], v[140:143]
ds_read_b128 a[104:107], v2 offset:26624
v_mfma_f32_16x16x32_bf16 v[148:151], a[136:139], a[48:51], 0
ds_read_b128 a[108:111], v3 offset:26624
v_mfma_f32_16x16x32_bf16 v[148:151], a[140:143], a[52:55], v[148:151]
buffer_load_dwordx4 v15, s[8:11], s24 offen offset:3072 lds
v_mfma_f32_16x16x32_bf16 v[156:159], a[136:139], a[56:59], 0
s_add_u32 s24, s24, 128
ds_read_b128 a[112:115], v2 offset:28672
v_mfma_f32_16x16x32_bf16 v[156:159], a[140:143], a[60:63], v[156:159]
s_waitcnt lgkmcnt(8)
buffer_store_dwordx4 v[112:115], v1, s[4:7], s31 offen sc1
v_mfma_f32_16x16x32_bf16 v[164:167], a[128:131], a[0:3], 0
s_waitcnt lgkmcnt(5)
s_add_u32 s31, s31, s32
ds_read_b64_tr_b16 a[136:137], v25 offset:0
v_mfma_f32_16x16x32_bf16 v[164:167], a[132:135], a[4:7], v[164:167]
v_mfma_f32_16x16x32_bf16 v[172:175], a[128:131], a[8:11], 0
ds_read_b64_tr_b16 a[138:139], v25 offset:2048
v_mfma_f32_16x16x32_bf16 v[172:175], a[132:135], a[12:15], v[172:175]
ds_read_b128 a[116:119], v3 offset:28672
v_mfma_f32_16x16x32_bf16 v[180:183], a[128:131], a[16:19], 0
ds_read_b64_tr_b16 a[140:141], v25 offset:16384
v_mfma_f32_16x16x32_bf16 v[180:183], a[132:135], a[20:23], v[180:183]
v_mfma_f32_16x16x32_bf16 v[188:191], a[128:131], a[24:27], 0
ds_read_b64_tr_b16 a[142:143], v25 offset:18432
v_add_u32 v25, 4294901760, v25
v_mfma_f32_16x16x32_bf16 v[188:191], a[132:135], a[28:31], v[188:191]
v_mfma_f32_16x16x32_bf16 v[196:199], a[128:131], a[32:35], 0
ds_read_b128 a[120:123], v2 offset:30720
v_mfma_f32_16x16x32_bf16 v[196:199], a[132:135], a[36:39], v[196:199]
v_mfma_f32_16x16x32_bf16 v[204:207], a[128:131], a[40:43], 0
ds_read_b128 a[124:127], v3 offset:30720
v_mfma_f32_16x16x32_bf16 v[204:207], a[132:135], a[44:47], v[204:207]
v_mfma_f32_16x16x32_bf16 v[212:215], a[128:131], a[48:51], 0
v_mfma_f32_16x16x32_bf16 v[212:215], a[132:135], a[52:55], v[212:215]
buffer_store_dwordx4 v[120:123], v1, s[4:7], s31 offen sc1
v_mfma_f32_16x16x32_bf16 v[220:223], a[128:131], a[56:59], 0
s_add_u32 s31, s31, s34
v_mfma_f32_16x16x32_bf16 v[220:223], a[132:135], a[60:63], v[220:223]
s_waitcnt vmcnt(28) lgkmcnt(0)
s_barrier
v_mfma_f32_16x16x32_bf16 v[224:227], a[136:139], a[0:3], 0
s_add_u32 m0, s29, 131072
ds_read_b64_tr_b16 a[128:129], v22 offset:0
v_mfma_f32_16x16x32_bf16 v[224:227], a[140:143], a[4:7], v[224:227]
buffer_load_dwordx4 v16, s[12:15], s26 offen offset:0 lds
v_mfma_f32_16x16x32_bf16 v[228:231], a[136:139], a[8:11], 0
ds_read_b64_tr_b16 a[130:131], v22 offset:2048
v_mfma_f32_16x16x32_bf16 v[228:231], a[140:143], a[12:15], v[228:231]
v_mfma_f32_16x16x32_bf16 v[232:235], a[136:139], a[16:19], 0
ds_read_b64_tr_b16 a[132:133], v22 offset:16384
v_mfma_f32_16x16x32_bf16 v[232:235], a[140:143], a[20:23], v[232:235]
buffer_load_dwordx4 v17, s[12:15], s26 offen offset:1024 lds
v_mfma_f32_16x16x32_bf16 v[236:239], a[136:139], a[24:27], 0
ds_read_b64_tr_b16 a[134:135], v22 offset:18432
v_add_u32 v22, 32768, v22
v_mfma_f32_16x16x32_bf16 v[236:239], a[140:143], a[28:31], v[236:239]
v_mfma_f32_16x16x32_bf16 v[240:243], a[136:139], a[32:35], 0
v_mfma_f32_16x16x32_bf16 v[240:243], a[140:143], a[36:39], v[240:243]
buffer_load_dwordx4 v18, s[12:15], s26 offen offset:2048 lds
v_mfma_f32_16x16x32_bf16 v[244:247], a[136:139], a[40:43], 0
v_mfma_f32_16x16x32_bf16 v[244:247], a[140:143], a[44:47], v[244:247]
v_mfma_f32_16x16x32_bf16 v[248:251], a[136:139], a[48:51], 0
v_mfma_f32_16x16x32_bf16 v[248:251], a[140:143], a[52:55], v[248:251]
buffer_load_dwordx4 v19, s[12:15], s26 offen offset:3072 lds
v_mfma_f32_16x16x32_bf16 v[252:255], a[136:139], a[56:59], 0
s_add_u32 s26, s26, 524288
v_mfma_f32_16x16x32_bf16 v[252:255], a[140:143], a[60:63], v[252:255]
s_waitcnt lgkmcnt(0)
v_mfma_f32_16x16x32_bf16 v[36:39], a[128:131], a[64:67], v[36:39]
s_add_u32 m0, s29, 147456
ds_read_b64_tr_b16 a[136:137], v23 offset:0
v_accvgpr_read_b32 v32, a192
v_mfma_f32_16x16x32_bf16 v[36:39], a[132:135], a[68:71], v[36:39]
buffer_load_dwordx4 v16, s[12:15], s27 offen offset:0 lds
v_mfma_f32_16x16x32_bf16 v[44:47], a[128:131], a[72:75], v[44:47]
ds_read_b64_tr_b16 a[138:139], v23 offset:2048
v_accvgpr_read_b32 v33, a193
v_mfma_f32_16x16x32_bf16 v[44:47], a[132:135], a[76:79], v[44:47]
ds_read_b128 a[0:3], v2 offset:32768
ds_read_b128 a[4:7], v3 offset:32768
v_mfma_f32_16x16x32_bf16 v[52:55], a[128:131], a[80:83], v[52:55]
ds_read_b64_tr_b16 a[140:141], v23 offset:16384
v_accvgpr_read_b32 v34, a194
v_mfma_f32_16x16x32_bf16 v[52:55], a[132:135], a[84:87], v[52:55]
buffer_load_dwordx4 v17, s[12:15], s27 offen offset:1024 lds
v_mfma_f32_16x16x32_bf16 v[60:63], a[128:131], a[88:91], v[60:63]
ds_read_b64_tr_b16 a[142:143], v23 offset:18432
v_add_u32 v23, 32768, v23
v_mfma_f32_16x16x32_bf16 v[60:63], a[132:135], a[92:95], v[60:63]
buffer_store_dwordx4 v[128:131], v1, s[4:7], s31 offen sc1
v_mfma_f32_16x16x32_bf16 v[68:71], a[128:131], a[96:99], v[68:71]
s_add_u32 s31, s31, s32
ds_read_b128 a[8:11], v2 offset:34816
v_accvgpr_read_b32 v35, a195
v_mfma_f32_16x16x32_bf16 v[68:71], a[132:135], a[100:103], v[68:71]
buffer_load_dwordx4 v18, s[12:15], s27 offen offset:2048 lds
v_mfma_f32_16x16x32_bf16 v[76:79], a[128:131], a[104:107], v[76:79]
ds_read_b128 a[12:15], v3 offset:34816
v_accvgpr_read_b32 v96, a196
v_mfma_f32_16x16x32_bf16 v[76:79], a[132:135], a[108:111], v[76:79]
ds_read_b128 a[16:19], v2 offset:36864
v_accvgpr_read_b32 v97, a197
v_mfma_f32_16x16x32_bf16 v[84:87], a[128:131], a[112:115], v[84:87]
ds_read_b128 a[20:23], v3 offset:36864
v_accvgpr_read_b32 v98, a198
v_mfma_f32_16x16x32_bf16 v[84:87], a[132:135], a[116:119], v[84:87]
buffer_load_dwordx4 v19, s[12:15], s27 offen offset:3072 lds
v_mfma_f32_16x16x32_bf16 v[92:95], a[128:131], a[120:123], v[92:95]
s_add_u32 s27, s27, 524288
ds_read_b128 a[24:27], v2 offset:38912
v_accvgpr_read_b32 v99, a199
v_mfma_f32_16x16x32_bf16 v[92:95], a[132:135], a[124:127], v[92:95]
s_waitcnt lgkmcnt(5)
buffer_store_dwordx4 v[136:139], v1, s[4:7], s31 offen sc1
v_mfma_f32_16x16x32_bf16 v[100:103], a[136:139], a[64:67], v[100:103]
s_add_u32 m0, s28, 16384
ds_read_b64_tr_b16 a[128:129], v24 offset:0
v_cvt_pk_bf16_f32 v32, v32, v33
v_mfma_f32_16x16x32_bf16 v[100:103], a[140:143], a[68:71], v[100:103]
s_add_u32 s31, s31, s33
buffer_load_dwordx4 v12, s[8:11], s24 offen offset:0 lds
v_mfma_f32_16x16x32_bf16 v[108:111], a[136:139], a[72:75], v[108:111]
ds_read_b64_tr_b16 a[130:131], v24 offset:2048
v_cvt_pk_bf16_f32 v33, v34, v35
v_mfma_f32_16x16x32_bf16 v[108:111], a[140:143], a[76:79], v[108:111]
ds_read_b128 a[28:31], v3 offset:38912
v_cvt_pk_bf16_f32 v34, v96, v97
v_mfma_f32_16x16x32_bf16 v[116:119], a[136:139], a[80:83], v[116:119]
ds_read_b64_tr_b16 a[132:133], v24 offset:16384
v_cvt_pk_bf16_f32 v35, v98, v99
v_mfma_f32_16x16x32_bf16 v[116:119], a[140:143], a[84:87], v[116:119]
buffer_load_dwordx4 v13, s[8:11], s24 offen offset:1024 lds
v_mfma_f32_16x16x32_bf16 v[124:127], a[136:139], a[88:91], v[124:127]
ds_read_b64_tr_b16 a[134:135], v24 offset:18432
v_add_u32 v24, 32768, v24
v_mfma_f32_16x16x32_bf16 v[124:127], a[140:143], a[92:95], v[124:127]
v_accvgpr_read_b32 v40, a200
v_accvgpr_read_b32 v41, a201
v_mfma_f32_16x16x32_bf16 v[132:135], a[136:139], a[96:99], v[132:135]
ds_read_b128 a[32:35], v2 offset:40960
v_accvgpr_read_b32 v42, a202
v_mfma_f32_16x16x32_bf16 v[132:135], a[140:143], a[100:103], v[132:135]
buffer_load_dwordx4 v14, s[8:11], s24 offen offset:2048 lds
v_mfma_f32_16x16x32_bf16 v[140:143], a[136:139], a[104:107], v[140:143]
ds_read_b128 a[36:39], v3 offset:40960
v_accvgpr_read_b32 v43, a203
v_mfma_f32_16x16x32_bf16 v[140:143], a[140:143], a[108:111], v[140:143]
ds_read_b128 a[40:43], v2 offset:43008
v_accvgpr_read_b32 v96, a204
v_mfma_f32_16x16x32_bf16 v[148:151], a[136:139], a[112:115], v[148:151]
ds_read_b128 a[44:47], v3 offset:43008
v_accvgpr_read_b32 v97, a205
v_mfma_f32_16x16x32_bf16 v[148:151], a[140:143], a[116:119], v[148:151]
buffer_load_dwordx4 v15, s[8:11], s24 offen offset:3072 lds
v_mfma_f32_16x16x32_bf16 v[156:159], a[136:139], a[120:123], v[156:159]
s_add_u32 s24, s24, 128
ds_read_b128 a[48:51], v2 offset:45056
v_accvgpr_read_b32 v98, a206
v_mfma_f32_16x16x32_bf16 v[156:159], a[140:143], a[124:127], v[156:159]
s_waitcnt lgkmcnt(5)
buffer_store_dwordx4 v[144:147], v1, s[4:7], s31 offen sc1
v_mfma_f32_16x16x32_bf16 v[164:167], a[128:131], a[64:67], v[164:167]
s_add_u32 s31, s31, s32
ds_read_b64_tr_b16 a[136:137], v25 offset:0
v_accvgpr_read_b32 v99, a207
v_mfma_f32_16x16x32_bf16 v[164:167], a[132:135], a[68:71], v[164:167]
v_cvt_pk_bf16_f32 v40, v40, v41
v_cvt_pk_bf16_f32 v41, v42, v43
v_mfma_f32_16x16x32_bf16 v[172:175], a[128:131], a[72:75], v[172:175]
ds_read_b64_tr_b16 a[138:139], v25 offset:2048
v_cvt_pk_bf16_f32 v42, v96, v97
v_mfma_f32_16x16x32_bf16 v[172:175], a[132:135], a[76:79], v[172:175]
ds_read_b128 a[52:55], v3 offset:45056
v_cvt_pk_bf16_f32 v43, v98, v99
v_mfma_f32_16x16x32_bf16 v[180:183], a[128:131], a[80:83], v[180:183]
ds_read_b64_tr_b16 a[140:141], v25 offset:16384
v_accvgpr_read_b32 v48, a208
v_mfma_f32_16x16x32_bf16 v[180:183], a[132:135], a[84:87], v[180:183]
v_accvgpr_read_b32 v49, a209
v_accvgpr_read_b32 v50, a210
v_mfma_f32_16x16x32_bf16 v[188:191], a[128:131], a[88:91], v[188:191]
ds_read_b64_tr_b16 a[142:143], v25 offset:18432
v_add_u32 v25, 32768, v25
v_mfma_f32_16x16x32_bf16 v[188:191], a[132:135], a[92:95], v[188:191]
v_accvgpr_read_b32 v51, a211
v_accvgpr_read_b32 v96, a212
v_mfma_f32_16x16x32_bf16 v[196:199], a[128:131], a[96:99], v[196:199]
ds_read_b128 a[56:59], v2 offset:47104
v_accvgpr_read_b32 v97, a213
v_mfma_f32_16x16x32_bf16 v[196:199], a[132:135], a[100:103], v[196:199]
v_accvgpr_read_b32 v98, a214
v_accvgpr_read_b32 v99, a215
v_mfma_f32_16x16x32_bf16 v[204:207], a[128:131], a[104:107], v[204:207]
ds_read_b128 a[60:63], v3 offset:47104
v_cvt_pk_bf16_f32 v48, v48, v49
v_mfma_f32_16x16x32_bf16 v[204:207], a[132:135], a[108:111], v[204:207]
v_cvt_pk_bf16_f32 v49, v50, v51
v_cvt_pk_bf16_f32 v50, v96, v97
v_mfma_f32_16x16x32_bf16 v[212:215], a[128:131], a[112:115], v[212:215]
v_cvt_pk_bf16_f32 v51, v98, v99
v_accvgpr_read_b32 v56, a216
v_mfma_f32_16x16x32_bf16 v[212:215], a[132:135], a[116:119], v[212:215]
buffer_store_dwordx4 v[152:155], v1, s[4:7], s31 offen sc1
v_mfma_f32_16x16x32_bf16 v[220:223], a[128:131], a[120:123], v[220:223]
s_add_u32 s31, s31, s36
v_accvgpr_read_b32 v57, a217
v_accvgpr_read_b32 v58, a218
v_mfma_f32_16x16x32_bf16 v[220:223], a[132:135], a[124:127], v[220:223]
s_waitcnt vmcnt(23) lgkmcnt(0)
s_barrier
v_accvgpr_read_b32 v59, a219
v_mfma_f32_16x16x32_bf16 v[224:227], a[136:139], a[64:67], v[224:227]
s_add_u32 m0, s29, 65536
ds_read_b64_tr_b16 a[128:129], v22 offset:0
v_accvgpr_read_b32 v96, a220
v_mfma_f32_16x16x32_bf16 v[224:227], a[140:143], a[68:71], v[224:227]
buffer_load_dwordx4 v16, s[12:15], s26 offen offset:0 lds
v_mfma_f32_16x16x32_bf16 v[228:231], a[136:139], a[72:75], v[228:231]
ds_read_b64_tr_b16 a[130:131], v22 offset:2048
v_accvgpr_read_b32 v97, a221
v_mfma_f32_16x16x32_bf16 v[228:231], a[140:143], a[76:79], v[228:231]
v_accvgpr_read_b32 v98, a222
v_accvgpr_read_b32 v99, a223
v_mfma_f32_16x16x32_bf16 v[232:235], a[136:139], a[80:83], v[232:235]
ds_read_b64_tr_b16 a[132:133], v22 offset:16384
v_cvt_pk_bf16_f32 v56, v56, v57
v_mfma_f32_16x16x32_bf16 v[232:235], a[140:143], a[84:87], v[232:235]
buffer_load_dwordx4 v17, s[12:15], s26 offen offset:1024 lds
v_mfma_f32_16x16x32_bf16 v[236:239], a[136:139], a[88:91], v[236:239]
ds_read_b64_tr_b16 a[134:135], v22 offset:18432
v_add_u32 v22, 32768, v22
v_mfma_f32_16x16x32_bf16 v[236:239], a[140:143], a[92:95], v[236:239]
v_cvt_pk_bf16_f32 v57, v58, v59
v_cvt_pk_bf16_f32 v58, v96, v97
v_mfma_f32_16x16x32_bf16 v[240:243], a[136:139], a[96:99], v[240:243]
v_cvt_pk_bf16_f32 v59, v98, v99
v_accvgpr_read_b32 v64, a224
v_mfma_f32_16x16x32_bf16 v[240:243], a[140:143], a[100:103], v[240:243]
buffer_load_dwordx4 v18, s[12:15], s26 offen offset:2048 lds
v_mfma_f32_16x16x32_bf16 v[244:247], a[136:139], a[104:107], v[244:247]
v_accvgpr_read_b32 v65, a225
v_accvgpr_read_b32 v66, a226
v_mfma_f32_16x16x32_bf16 v[244:247], a[140:143], a[108:111], v[244:247]
v_accvgpr_read_b32 v67, a227
v_accvgpr_read_b32 v96, a228
v_mfma_f32_16x16x32_bf16 v[248:251], a[136:139], a[112:115], v[248:251]
v_accvgpr_read_b32 v97, a229
v_accvgpr_read_b32 v98, a230
v_mfma_f32_16x16x32_bf16 v[248:251], a[140:143], a[116:119], v[248:251]
buffer_load_dwordx4 v19, s[12:15], s26 offen offset:3072 lds
v_mfma_f32_16x16x32_bf16 v[252:255], a[136:139], a[120:123], v[252:255]
s_add_u32 s26, s26, 524288
v_accvgpr_read_b32 v99, a231
v_cvt_pk_bf16_f32 v64, v64, v65
v_mfma_f32_16x16x32_bf16 v[252:255], a[140:143], a[124:127], v[252:255]
s_waitcnt lgkmcnt(0)
v_cvt_pk_bf16_f32 v65, v66, v67
v_cvt_pk_bf16_f32 v66, v96, v97
v_mfma_f32_16x16x32_bf16 v[36:39], a[128:131], a[0:3], v[36:39]
s_add_u32 m0, s29, 81920
ds_read_b64_tr_b16 a[136:137], v23 offset:0
v_cvt_pk_bf16_f32 v67, v98, v99
v_mfma_f32_16x16x32_bf16 v[36:39], a[132:135], a[4:7], v[36:39]
buffer_load_dwordx4 v16, s[12:15], s27 offen offset:0 lds
v_mfma_f32_16x16x32_bf16 v[44:47], a[128:131], a[8:11], v[44:47]
ds_read_b64_tr_b16 a[138:139], v23 offset:2048
v_accvgpr_read_b32 v72, a232
v_mfma_f32_16x16x32_bf16 v[44:47], a[132:135], a[12:15], v[44:47]
ds_read_b128 a[64:67], v2 offset:49152
ds_read_b128 a[68:71], v3 offset:49152
v_mfma_f32_16x16x32_bf16 v[52:55], a[128:131], a[16:19], v[52:55]
ds_read_b64_tr_b16 a[140:141], v23 offset:16384
v_accvgpr_read_b32 v73, a233
v_mfma_f32_16x16x32_bf16 v[52:55], a[132:135], a[20:23], v[52:55]
buffer_load_dwordx4 v17, s[12:15], s27 offen offset:1024 lds
v_mfma_f32_16x16x32_bf16 v[60:63], a[128:131], a[24:27], v[60:63]
ds_read_b64_tr_b16 a[142:143], v23 offset:18432
v_add_u32 v23, 32768, v23
v_mfma_f32_16x16x32_bf16 v[60:63], a[132:135], a[28:31], v[60:63]
buffer_store_dwordx4 v[160:163], v1, s[4:7], s31 offen sc1
v_mfma_f32_16x16x32_bf16 v[68:71], a[128:131], a[32:35], v[68:71]
s_add_u32 s31, s31, s32
ds_read_b128 a[72:75], v2 offset:51200
v_accvgpr_read_b32 v74, a234
v_mfma_f32_16x16x32_bf16 v[68:71], a[132:135], a[36:39], v[68:71]
buffer_load_dwordx4 v18, s[12:15], s27 offen offset:2048 lds
v_mfma_f32_16x16x32_bf16 v[76:79], a[128:131], a[40:43], v[76:79]
ds_read_b128 a[76:79], v3 offset:51200
v_accvgpr_read_b32 v75, a235
v_mfma_f32_16x16x32_bf16 v[76:79], a[132:135], a[44:47], v[76:79]
ds_read_b128 a[80:83], v2 offset:53248
v_accvgpr_read_b32 v96, a236
v_mfma_f32_16x16x32_bf16 v[84:87], a[128:131], a[48:51], v[84:87]
ds_read_b128 a[84:87], v3 offset:53248
v_accvgpr_read_b32 v97, a237
v_mfma_f32_16x16x32_bf16 v[84:87], a[132:135], a[52:55], v[84:87]
buffer_load_dwordx4 v19, s[12:15], s27 offen offset:3072 lds
v_mfma_f32_16x16x32_bf16 v[92:95], a[128:131], a[56:59], v[92:95]
s_add_u32 s27, s27, 524288
ds_read_b128 a[88:91], v2 offset:55296
v_accvgpr_read_b32 v98, a238
v_mfma_f32_16x16x32_bf16 v[92:95], a[132:135], a[60:63], v[92:95]
s_waitcnt lgkmcnt(5)
buffer_store_dwordx4 v[168:171], v1, s[4:7], s31 offen sc1
v_mfma_f32_16x16x32_bf16 v[100:103], a[136:139], a[0:3], v[100:103]
s_add_u32 m0, s28, 32768
ds_read_b64_tr_b16 a[128:129], v24 offset:0
v_accvgpr_read_b32 v99, a239
v_mfma_f32_16x16x32_bf16 v[100:103], a[140:143], a[4:7], v[100:103]
s_add_u32 s31, s31, s33
buffer_load_dwordx4 v12, s[8:11], s24 offen offset:0 lds
v_mfma_f32_16x16x32_bf16 v[108:111], a[136:139], a[8:11], v[108:111]
ds_read_b64_tr_b16 a[130:131], v24 offset:2048
v_cvt_pk_bf16_f32 v72, v72, v73
v_mfma_f32_16x16x32_bf16 v[108:111], a[140:143], a[12:15], v[108:111]
ds_read_b128 a[92:95], v3 offset:55296
v_cvt_pk_bf16_f32 v73, v74, v75
v_mfma_f32_16x16x32_bf16 v[116:119], a[136:139], a[16:19], v[116:119]
ds_read_b64_tr_b16 a[132:133], v24 offset:16384
v_cvt_pk_bf16_f32 v74, v96, v97
v_mfma_f32_16x16x32_bf16 v[116:119], a[140:143], a[20:23], v[116:119]
buffer_load_dwordx4 v13, s[8:11], s24 offen offset:1024 lds
v_mfma_f32_16x16x32_bf16 v[124:127], a[136:139], a[24:27], v[124:127]
ds_read_b64_tr_b16 a[134:135], v24 offset:18432
v_add_u32 v24, 32768, v24
v_mfma_f32_16x16x32_bf16 v[124:127], a[140:143], a[28:31], v[124:127]
v_cvt_pk_bf16_f32 v75, v98, v99
v_accvgpr_read_b32 v80, a240
v_mfma_f32_16x16x32_bf16 v[132:135], a[136:139], a[32:35], v[132:135]
ds_read_b128 a[96:99], v2 offset:57344
v_accvgpr_read_b32 v81, a241
v_mfma_f32_16x16x32_bf16 v[132:135], a[140:143], a[36:39], v[132:135]
buffer_load_dwordx4 v14, s[8:11], s24 offen offset:2048 lds
v_mfma_f32_16x16x32_bf16 v[140:143], a[136:139], a[40:43], v[140:143]
ds_read_b128 a[100:103], v3 offset:57344
v_accvgpr_read_b32 v82, a242
v_mfma_f32_16x16x32_bf16 v[140:143], a[140:143], a[44:47], v[140:143]
ds_read_b128 a[104:107], v2 offset:59392
v_accvgpr_read_b32 v83, a243
v_mfma_f32_16x16x32_bf16 v[148:151], a[136:139], a[48:51], v[148:151]
ds_read_b128 a[108:111], v3 offset:59392
v_accvgpr_read_b32 v96, a244
v_mfma_f32_16x16x32_bf16 v[148:151], a[140:143], a[52:55], v[148:151]
buffer_load_dwordx4 v15, s[8:11], s24 offen offset:3072 lds
v_mfma_f32_16x16x32_bf16 v[156:159], a[136:139], a[56:59], v[156:159]
s_add_u32 s24, s24, 128
ds_read_b128 a[112:115], v2 offset:61440
v_accvgpr_read_b32 v97, a245
v_mfma_f32_16x16x32_bf16 v[156:159], a[140:143], a[60:63], v[156:159]
s_waitcnt lgkmcnt(5)
buffer_store_dwordx4 v[176:179], v1, s[4:7], s31 offen sc1
v_mfma_f32_16x16x32_bf16 v[164:167], a[128:131], a[0:3], v[164:167]
s_add_u32 s31, s31, s32
ds_read_b64_tr_b16 a[136:137], v25 offset:0
v_accvgpr_read_b32 v98, a246
v_mfma_f32_16x16x32_bf16 v[164:167], a[132:135], a[4:7], v[164:167]
v_accvgpr_read_b32 v99, a247
v_cvt_pk_bf16_f32 v80, v80, v81
v_mfma_f32_16x16x32_bf16 v[172:175], a[128:131], a[8:11], v[172:175]
ds_read_b64_tr_b16 a[138:139], v25 offset:2048
v_cvt_pk_bf16_f32 v81, v82, v83
v_mfma_f32_16x16x32_bf16 v[172:175], a[132:135], a[12:15], v[172:175]
ds_read_b128 a[116:119], v3 offset:61440
v_cvt_pk_bf16_f32 v82, v96, v97
v_mfma_f32_16x16x32_bf16 v[180:183], a[128:131], a[16:19], v[180:183]
ds_read_b64_tr_b16 a[140:141], v25 offset:16384
v_cvt_pk_bf16_f32 v83, v98, v99
v_mfma_f32_16x16x32_bf16 v[180:183], a[132:135], a[20:23], v[180:183]
buffer_store_dwordx4 v[184:187], v1, s[4:7], s31 offen sc1
v_mfma_f32_16x16x32_bf16 v[188:191], a[128:131], a[24:27], v[188:191]
s_add_u32 s31, s31, s34
ds_read_b64_tr_b16 a[142:143], v25 offset:18432
v_add_u32 v25, 32768, v25
v_mfma_f32_16x16x32_bf16 v[188:191], a[132:135], a[28:31], v[188:191]
v_accvgpr_read_b32 v88, a248
v_accvgpr_read_b32 v89, a249
v_mfma_f32_16x16x32_bf16 v[196:199], a[128:131], a[32:35], v[196:199]
ds_read_b128 a[120:123], v2 offset:63488
v_accvgpr_read_b32 v90, a250
v_mfma_f32_16x16x32_bf16 v[196:199], a[132:135], a[36:39], v[196:199]
v_accvgpr_read_b32 v91, a251
v_accvgpr_read_b32 v96, a252
v_mfma_f32_16x16x32_bf16 v[204:207], a[128:131], a[40:43], v[204:207]
ds_read_b128 a[124:127], v3 offset:63488
v_accvgpr_read_b32 v97, a253
v_mfma_f32_16x16x32_bf16 v[204:207], a[132:135], a[44:47], v[204:207]
v_accvgpr_read_b32 v98, a254
v_accvgpr_read_b32 v99, a255
v_mfma_f32_16x16x32_bf16 v[212:215], a[128:131], a[48:51], v[212:215]
v_cvt_pk_bf16_f32 v88, v88, v89
v_cvt_pk_bf16_f32 v89, v90, v91
v_mfma_f32_16x16x32_bf16 v[212:215], a[132:135], a[52:55], v[212:215]
v_cvt_pk_bf16_f32 v90, v96, v97
v_cvt_pk_bf16_f32 v91, v98, v99
v_mfma_f32_16x16x32_bf16 v[220:223], a[128:131], a[56:59], v[220:223]
v_mfma_f32_16x16x32_bf16 v[220:223], a[132:135], a[60:63], v[220:223]
s_waitcnt vmcnt(23) lgkmcnt(0)
s_barrier
v_mfma_f32_16x16x32_bf16 v[224:227], a[136:139], a[0:3], v[224:227]
s_add_u32 m0, s29, 98304
ds_read_b64_tr_b16 a[128:129], v22 offset:0
v_mfma_f32_16x16x32_bf16 v[224:227], a[140:143], a[4:7], v[224:227]
buffer_load_dwordx4 v16, s[12:15], s26 offen offset:0 lds
v_mfma_f32_16x16x32_bf16 v[228:231], a[136:139], a[8:11], v[228:231]
ds_read_b64_tr_b16 a[130:131], v22 offset:2048
v_mfma_f32_16x16x32_bf16 v[228:231], a[140:143], a[12:15], v[228:231]
buffer_store_dwordx4 v[192:195], v1, s[4:7], s31 offen sc1
v_mfma_f32_16x16x32_bf16 v[232:235], a[136:139], a[16:19], v[232:235]
s_add_u32 s31, s31, s32
ds_read_b64_tr_b16 a[132:133], v22 offset:16384
v_mfma_f32_16x16x32_bf16 v[232:235], a[140:143], a[20:23], v[232:235]
buffer_load_dwordx4 v17, s[12:15], s26 offen offset:1024 lds
v_mfma_f32_16x16x32_bf16 v[236:239], a[136:139], a[24:27], v[236:239]
ds_read_b64_tr_b16 a[134:135], v22 offset:18432
v_add_u32 v22, 4294901760, v22
v_mfma_f32_16x16x32_bf16 v[236:239], a[140:143], a[28:31], v[236:239]
v_mfma_f32_16x16x32_bf16 v[240:243], a[136:139], a[32:35], v[240:243]
v_mfma_f32_16x16x32_bf16 v[240:243], a[140:143], a[36:39], v[240:243]
buffer_load_dwordx4 v18, s[12:15], s26 offen offset:2048 lds
v_mfma_f32_16x16x32_bf16 v[244:247], a[136:139], a[40:43], v[244:247]
v_mfma_f32_16x16x32_bf16 v[244:247], a[140:143], a[44:47], v[244:247]
v_mfma_f32_16x16x32_bf16 v[248:251], a[136:139], a[48:51], v[248:251]
v_mfma_f32_16x16x32_bf16 v[248:251], a[140:143], a[52:55], v[248:251]
buffer_load_dwordx4 v19, s[12:15], s26 offen offset:3072 lds
v_mfma_f32_16x16x32_bf16 v[252:255], a[136:139], a[56:59], v[252:255]
s_add_u32 s26, s26, 524288
v_mfma_f32_16x16x32_bf16 v[252:255], a[140:143], a[60:63], v[252:255]
s_waitcnt lgkmcnt(2)
v_mfma_f32_16x16x32_bf16 v[36:39], a[128:131], a[64:67], v[36:39]
s_waitcnt lgkmcnt(0)
s_add_u32 m0, s29, 114688
ds_read_b64_tr_b16 a[136:137], v23 offset:0
v_mfma_f32_16x16x32_bf16 v[36:39], a[132:135], a[68:71], v[36:39]
buffer_load_dwordx4 v16, s[12:15], s27 offen offset:0 lds
v_mfma_f32_16x16x32_bf16 v[44:47], a[128:131], a[72:75], v[44:47]
ds_read_b64_tr_b16 a[138:139], v23 offset:2048
v_mfma_f32_16x16x32_bf16 v[44:47], a[132:135], a[76:79], v[44:47]
ds_read_b128 a[0:3], v2 offset:0
ds_read_b128 a[4:7], v3 offset:0
v_mfma_f32_16x16x32_bf16 v[52:55], a[128:131], a[80:83], v[52:55]
ds_read_b64_tr_b16 a[140:141], v23 offset:16384
v_mfma_f32_16x16x32_bf16 v[52:55], a[132:135], a[84:87], v[52:55]
buffer_load_dwordx4 v17, s[12:15], s27 offen offset:1024 lds
v_mfma_f32_16x16x32_bf16 v[60:63], a[128:131], a[88:91], v[60:63]
ds_read_b64_tr_b16 a[142:143], v23 offset:18432
v_add_u32 v23, 4294901760, v23
v_mfma_f32_16x16x32_bf16 v[60:63], a[132:135], a[92:95], v[60:63]
buffer_store_dwordx4 v[200:203], v1, s[4:7], s31 offen sc1
v_mfma_f32_16x16x32_bf16 v[68:71], a[128:131], a[96:99], v[68:71]
s_add_u32 s31, s31, s33
ds_read_b128 a[8:11], v2 offset:2048
v_mfma_f32_16x16x32_bf16 v[68:71], a[132:135], a[100:103], v[68:71]
buffer_load_dwordx4 v18, s[12:15], s27 offen offset:2048 lds
v_mfma_f32_16x16x32_bf16 v[76:79], a[128:131], a[104:107], v[76:79]
ds_read_b128 a[12:15], v3 offset:2048
v_mfma_f32_16x16x32_bf16 v[76:79], a[132:135], a[108:111], v[76:79]
ds_read_b128 a[16:19], v2 offset:4096
v_mfma_f32_16x16x32_bf16 v[84:87], a[128:131], a[112:115], v[84:87]
ds_read_b128 a[20:23], v3 offset:4096
v_mfma_f32_16x16x32_bf16 v[84:87], a[132:135], a[116:119], v[84:87]
buffer_load_dwordx4 v19, s[12:15], s27 offen offset:3072 lds
v_mfma_f32_16x16x32_bf16 v[92:95], a[128:131], a[120:123], v[92:95]
s_add_u32 s27, s27, 524288
ds_read_b128 a[24:27], v2 offset:6144
v_mfma_f32_16x16x32_bf16 v[92:95], a[132:135], a[124:127], v[92:95]
s_waitcnt lgkmcnt(9)
buffer_store_dwordx4 v[208:211], v1, s[4:7], s31 offen sc1
v_mfma_f32_16x16x32_bf16 v[100:103], a[136:139], a[64:67], v[100:103]
s_waitcnt lgkmcnt(5)
s_add_u32 s31, s31, s32
ds_read_b64_tr_b16 a[128:129], v24 offset:0
v_mfma_f32_16x16x32_bf16 v[100:103], a[140:143], a[68:71], v[100:103]
v_mfma_f32_16x16x32_bf16 v[108:111], a[136:139], a[72:75], v[108:111]
ds_read_b64_tr_b16 a[130:131], v24 offset:2048
v_mfma_f32_16x16x32_bf16 v[108:111], a[140:143], a[76:79], v[108:111]
ds_read_b128 a[28:31], v3 offset:6144
v_mfma_f32_16x16x32_bf16 v[116:119], a[136:139], a[80:83], v[116:119]
ds_read_b64_tr_b16 a[132:133], v24 offset:16384
v_mfma_f32_16x16x32_bf16 v[116:119], a[140:143], a[84:87], v[116:119]
v_mfma_f32_16x16x32_bf16 v[124:127], a[136:139], a[88:91], v[124:127]
ds_read_b64_tr_b16 a[134:135], v24 offset:18432
v_add_u32 v24, 4294901760, v24
v_mfma_f32_16x16x32_bf16 v[124:127], a[140:143], a[92:95], v[124:127]
v_mfma_f32_16x16x32_bf16 v[132:135], a[136:139], a[96:99], v[132:135]
ds_read_b128 a[32:35], v2 offset:8192
v_mfma_f32_16x16x32_bf16 v[132:135], a[140:143], a[100:103], v[132:135]
buffer_store_dwordx4 v[216:219], v1, s[4:7], s31 offen sc1
v_mfma_f32_16x16x32_bf16 v[140:143], a[136:139], a[104:107], v[140:143]
s_add_u32 s31, s31, s35
ds_read_b128 a[36:39], v3 offset:8192
v_mfma_f32_16x16x32_bf16 v[140:143], a[140:143], a[108:111], v[140:143]
ds_read_b128 a[40:43], v2 offset:10240
v_mfma_f32_16x16x32_bf16 v[148:151], a[136:139], a[112:115], v[148:151]
ds_read_b128 a[44:47], v3 offset:10240
v_mfma_f32_16x16x32_bf16 v[148:151], a[140:143], a[116:119], v[148:151]
v_mfma_f32_16x16x32_bf16 v[156:159], a[136:139], a[120:123], v[156:159]
ds_read_b128 a[48:51], v2 offset:12288
v_mfma_f32_16x16x32_bf16 v[156:159], a[140:143], a[124:127], v[156:159]
s_waitcnt lgkmcnt(8)
v_mfma_f32_16x16x32_bf16 v[164:167], a[128:131], a[64:67], v[164:167]
s_waitcnt lgkmcnt(5)
ds_read_b64_tr_b16 a[136:137], v25 offset:0
v_mfma_f32_16x16x32_bf16 v[164:167], a[132:135], a[68:71], v[164:167]
v_mfma_f32_16x16x32_bf16 v[172:175], a[128:131], a[72:75], v[172:175]
ds_read_b64_tr_b16 a[138:139], v25 offset:2048
v_mfma_f32_16x16x32_bf16 v[172:175], a[132:135], a[76:79], v[172:175]
ds_read_b128 a[52:55], v3 offset:12288
v_mfma_f32_16x16x32_bf16 v[180:183], a[128:131], a[80:83], v[180:183]
ds_read_b64_tr_b16 a[140:141], v25 offset:16384
v_mfma_f32_16x16x32_bf16 v[180:183], a[132:135], a[84:87], v[180:183]
buffer_store_dwordx4 v[32:35], v1, s[4:7], s31 offen sc1
v_mfma_f32_16x16x32_bf16 v[188:191], a[128:131], a[88:91], v[188:191]
s_add_u32 s31, s31, s32
ds_read_b64_tr_b16 a[142:143], v25 offset:18432
v_add_u32 v25, 4294901760, v25
v_mfma_f32_16x16x32_bf16 v[188:191], a[132:135], a[92:95], v[188:191]
v_mfma_f32_16x16x32_bf16 v[196:199], a[128:131], a[96:99], v[196:199]
ds_read_b128 a[56:59], v2 offset:14336
v_mfma_f32_16x16x32_bf16 v[196:199], a[132:135], a[100:103], v[196:199]
v_mfma_f32_16x16x32_bf16 v[204:207], a[128:131], a[104:107], v[204:207]
ds_read_b128 a[60:63], v3 offset:14336
v_mfma_f32_16x16x32_bf16 v[204:207], a[132:135], a[108:111], v[204:207]
v_mfma_f32_16x16x32_bf16 v[212:215], a[128:131], a[112:115], v[212:215]
v_mfma_f32_16x16x32_bf16 v[212:215], a[132:135], a[116:119], v[212:215]
v_mfma_f32_16x16x32_bf16 v[220:223], a[128:131], a[120:123], v[220:223]
v_mfma_f32_16x16x32_bf16 v[220:223], a[132:135], a[124:127], v[220:223]
s_waitcnt vmcnt(20) lgkmcnt(0)
s_barrier
v_mfma_f32_16x16x32_bf16 v[224:227], a[136:139], a[64:67], v[224:227]
s_add_u32 m0, s29, 131072
ds_read_b64_tr_b16 a[128:129], v22 offset:0
v_mfma_f32_16x16x32_bf16 v[224:227], a[140:143], a[68:71], v[224:227]
buffer_load_dwordx4 v16, s[12:15], s26 offen offset:0 lds
v_mfma_f32_16x16x32_bf16 v[228:231], a[136:139], a[72:75], v[228:231]
ds_read_b64_tr_b16 a[130:131], v22 offset:2048
v_mfma_f32_16x16x32_bf16 v[228:231], a[140:143], a[76:79], v[228:231]
buffer_store_dwordx4 v[40:43], v1, s[4:7], s31 offen sc1
v_mfma_f32_16x16x32_bf16 v[232:235], a[136:139], a[80:83], v[232:235]
s_add_u32 s31, s31, s33
ds_read_b64_tr_b16 a[132:133], v22 offset:16384
v_mfma_f32_16x16x32_bf16 v[232:235], a[140:143], a[84:87], v[232:235]
buffer_load_dwordx4 v17, s[12:15], s26 offen offset:1024 lds
v_mfma_f32_16x16x32_bf16 v[236:239], a[136:139], a[88:91], v[236:239]
ds_read_b64_tr_b16 a[134:135], v22 offset:18432
v_add_u32 v22, 32768, v22
v_mfma_f32_16x16x32_bf16 v[236:239], a[140:143], a[92:95], v[236:239]
v_mfma_f32_16x16x32_bf16 v[240:243], a[136:139], a[96:99], v[240:243]
v_mfma_f32_16x16x32_bf16 v[240:243], a[140:143], a[100:103], v[240:243]
buffer_load_dwordx4 v18, s[12:15], s26 offen offset:2048 lds
v_mfma_f32_16x16x32_bf16 v[244:247], a[136:139], a[104:107], v[244:247]
v_mfma_f32_16x16x32_bf16 v[244:247], a[140:143], a[108:111], v[244:247]
v_mfma_f32_16x16x32_bf16 v[248:251], a[136:139], a[112:115], v[248:251]
v_mfma_f32_16x16x32_bf16 v[248:251], a[140:143], a[116:119], v[248:251]
buffer_load_dwordx4 v19, s[12:15], s26 offen offset:3072 lds
v_mfma_f32_16x16x32_bf16 v[252:255], a[136:139], a[120:123], v[252:255]
s_add_u32 s26, s26, 524288
v_mfma_f32_16x16x32_bf16 v[252:255], a[140:143], a[124:127], v[252:255]
s_waitcnt lgkmcnt(2)
v_mfma_f32_16x16x32_bf16 v[36:39], a[128:131], a[0:3], v[36:39]
s_waitcnt lgkmcnt(0)
s_add_u32 m0, s29, 147456
ds_read_b64_tr_b16 a[136:137], v23 offset:0
v_mfma_f32_16x16x32_bf16 v[36:39], a[132:135], a[4:7], v[36:39]
buffer_load_dwordx4 v16, s[12:15], s27 offen offset:0 lds
v_mfma_f32_16x16x32_bf16 v[44:47], a[128:131], a[8:11], v[44:47]
s_lshl_b32 s22, s20, 7
ds_read_b64_tr_b16 a[138:139], v23 offset:2048
v_bfe_u32 v20, v1, 4, 3
v_mfma_f32_16x16x32_bf16 v[44:47], a[132:135], a[12:15], v[44:47]
s_add_u32 s70, s22, 94371840
ds_read_b128 a[64:67], v2 offset:16384
ds_read_b128 a[68:71], v3 offset:16384
v_mfma_f32_16x16x32_bf16 v[52:55], a[128:131], a[16:19], v[52:55]
s_lshr_b32 s22, s2, 4
ds_read_b64_tr_b16 a[140:141], v23 offset:16384
v_lshlrev_b32 v20, 3, v20
v_mfma_f32_16x16x32_bf16 v[52:55], a[132:135], a[20:23], v[52:55]
s_lshl_b32 s22, s22, 2
buffer_load_dwordx4 v17, s[12:15], s27 offen offset:1024 lds
v_mfma_f32_16x16x32_bf16 v[60:63], a[128:131], a[24:27], v[60:63]
s_add_u32 s66, s70, s22
ds_read_b64_tr_b16 a[142:143], v23 offset:18432
v_add_u32 v23, 32768, v23
v_mfma_f32_16x16x32_bf16 v[60:63], a[132:135], a[28:31], v[60:63]
s_and_b32 s22, s2, 16
buffer_store_dwordx4 v[48:51], v1, s[4:7], s31 offen sc1
v_mfma_f32_16x16x32_bf16 v[68:71], a[128:131], a[32:35], v[68:71]
s_add_u32 s31, s31, s32
ds_read_b128 a[72:75], v2 offset:18432
v_add_u32 v15, 2052, v20
v_mfma_f32_16x16x32_bf16 v[68:71], a[132:135], a[36:39], v[68:71]
s_lshl_b32 s22, s22, 7
buffer_load_dwordx4 v18, s[12:15], s27 offen offset:2048 lds
v_mfma_f32_16x16x32_bf16 v[76:79], a[128:131], a[40:43], v[76:79]
s_add_u32 s66, s66, s22
ds_read_b128 a[76:79], v3 offset:18432
v_mfma_f32_16x16x32_bf16 v[76:79], a[132:135], a[44:47], v[76:79]
s_lshl_b32 s67, s20, 20
ds_read_b128 a[80:83], v2 offset:20480
v_mfma_f32_16x16x32_bf16 v[84:87], a[128:131], a[48:51], v[84:87]
s_lshl_b32 s22, s37, 16
ds_read_b128 a[84:87], v3 offset:20480
v_mfma_f32_16x16x32_bf16 v[84:87], a[132:135], a[52:55], v[84:87]
s_add_u32 s67, s67, s22
buffer_load_dwordx4 v19, s[12:15], s27 offen offset:3072 lds
v_mfma_f32_16x16x32_bf16 v[92:95], a[128:131], a[56:59], v[92:95]
s_waitcnt lgkmcnt(8)
s_add_u32 s27, s27, 524288
ds_read_b128 a[88:91], v2 offset:22528
v_mfma_f32_16x16x32_bf16 v[92:95], a[132:135], a[60:63], v[92:95]
s_lshl_b32 s22, s3, 11
buffer_store_dwordx4 v[56:59], v1, s[4:7], s31 offen sc1
v_mfma_f32_16x16x32_bf16 v[100:103], a[136:139], a[0:3], v[100:103]
s_waitcnt lgkmcnt(5)
s_add_u32 s31, s31, s34
ds_read_b64_tr_b16 a[128:129], v24 offset:0
v_mfma_f32_16x16x32_bf16 v[100:103], a[140:143], a[4:7], v[100:103]
s_add_u32 s67, s67, s22
v_mfma_f32_16x16x32_bf16 v[108:111], a[136:139], a[8:11], v[108:111]
s_add_u32 s67, s67, 33554432
ds_read_b64_tr_b16 a[130:131], v24 offset:2048
v_mfma_f32_16x16x32_bf16 v[108:111], a[140:143], a[12:15], v[108:111]
s_mov_b32 s68, 1035512379
ds_read_b128 a[92:95], v3 offset:22528
v_mfma_f32_16x16x32_bf16 v[116:119], a[136:139], a[16:19], v[116:119]
s_mov_b32 s69, 1035512379
ds_read_b64_tr_b16 a[132:133], v24 offset:16384
v_mfma_f32_16x16x32_bf16 v[116:119], a[140:143], a[20:23], v[116:119]
buffer_store_dwordx4 v[64:67], v1, s[4:7], s31 offen sc1
v_mfma_f32_16x16x32_bf16 v[124:127], a[136:139], a[24:27], v[124:127]
s_add_u32 s31, s31, s32
ds_read_b64_tr_b16 a[134:135], v24 offset:18432
v_add_u32 v24, 32768, v24
v_mfma_f32_16x16x32_bf16 v[124:127], a[140:143], a[28:31], v[124:127]
v_mfma_f32_16x16x32_bf16 v[132:135], a[136:139], a[32:35], v[132:135]
ds_read_b128 a[96:99], v2 offset:24576
v_mfma_f32_16x16x32_bf16 v[132:135], a[140:143], a[36:39], v[132:135]
v_mfma_f32_16x16x32_bf16 v[140:143], a[136:139], a[40:43], v[140:143]
ds_read_b128 a[100:103], v3 offset:24576
v_mfma_f32_16x16x32_bf16 v[140:143], a[140:143], a[44:47], v[140:143]
ds_read_b128 a[104:107], v2 offset:26624
v_mfma_f32_16x16x32_bf16 v[148:151], a[136:139], a[48:51], v[148:151]
ds_read_b128 a[108:111], v3 offset:26624
v_mfma_f32_16x16x32_bf16 v[148:151], a[140:143], a[52:55], v[148:151]
v_mfma_f32_16x16x32_bf16 v[156:159], a[136:139], a[56:59], v[156:159]
ds_read_b128 a[112:115], v2 offset:28672
v_mfma_f32_16x16x32_bf16 v[156:159], a[140:143], a[60:63], v[156:159]
s_waitcnt lgkmcnt(8)
buffer_store_dwordx4 v[72:75], v1, s[4:7], s31 offen sc1
v_mfma_f32_16x16x32_bf16 v[164:167], a[128:131], a[0:3], v[164:167]
s_waitcnt lgkmcnt(5)
s_add_u32 s31, s31, s33
ds_read_b64_tr_b16 a[136:137], v25 offset:0
v_mfma_f32_16x16x32_bf16 v[164:167], a[132:135], a[4:7], v[164:167]
v_mfma_f32_16x16x32_bf16 v[172:175], a[128:131], a[8:11], v[172:175]
ds_read_b64_tr_b16 a[138:139], v25 offset:2048
v_mfma_f32_16x16x32_bf16 v[172:175], a[132:135], a[12:15], v[172:175]
ds_read_b128 a[116:119], v3 offset:28672
v_mfma_f32_16x16x32_bf16 v[180:183], a[128:131], a[16:19], v[180:183]
ds_read_b64_tr_b16 a[140:141], v25 offset:16384
v_mfma_f32_16x16x32_bf16 v[180:183], a[132:135], a[20:23], v[180:183]
v_mfma_f32_16x16x32_bf16 v[188:191], a[128:131], a[24:27], v[188:191]
ds_read_b64_tr_b16 a[142:143], v25 offset:18432
v_add_u32 v25, 32768, v25
v_mfma_f32_16x16x32_bf16 v[188:191], a[132:135], a[28:31], v[188:191]
v_mfma_f32_16x16x32_bf16 v[196:199], a[128:131], a[32:35], v[196:199]
ds_read_b128 a[120:123], v2 offset:30720
v_mfma_f32_16x16x32_bf16 v[196:199], a[132:135], a[36:39], v[196:199]
buffer_store_dwordx4 v[80:83], v1, s[4:7], s31 offen sc1
v_mfma_f32_16x16x32_bf16 v[204:207], a[128:131], a[40:43], v[204:207]
s_add_u32 s31, s31, s32
ds_read_b128 a[124:127], v3 offset:30720
v_mfma_f32_16x16x32_bf16 v[204:207], a[132:135], a[44:47], v[204:207]
v_mfma_f32_16x16x32_bf16 v[212:215], a[128:131], a[48:51], v[212:215]
v_mfma_f32_16x16x32_bf16 v[212:215], a[132:135], a[52:55], v[212:215]
v_mfma_f32_16x16x32_bf16 v[220:223], a[128:131], a[56:59], v[220:223]
v_mfma_f32_16x16x32_bf16 v[220:223], a[132:135], a[60:63], v[220:223]
s_waitcnt vmcnt(17) lgkmcnt(0)
s_barrier
v_mfma_f32_16x16x32_bf16 v[224:227], a[136:139], a[0:3], v[224:227]
ds_read_b64_tr_b16 a[128:129], v22 offset:0
v_mfma_f32_16x16x32_bf16 v[224:227], a[140:143], a[4:7], v[224:227]
v_mfma_f32_16x16x32_bf16 v[228:231], a[136:139], a[8:11], v[228:231]
ds_read_b64_tr_b16 a[130:131], v22 offset:2048
v_mfma_f32_16x16x32_bf16 v[228:231], a[140:143], a[12:15], v[228:231]
buffer_store_dwordx4 v[88:91], v1, s[4:7], s31 offen sc1
v_mfma_f32_16x16x32_bf16 v[232:235], a[136:139], a[16:19], v[232:235]
ds_read_b64_tr_b16 a[132:133], v22 offset:16384
v_mfma_f32_16x16x32_bf16 v[232:235], a[140:143], a[20:23], v[232:235]
v_mfma_f32_16x16x32_bf16 v[236:239], a[136:139], a[24:27], v[236:239]
ds_read_b64_tr_b16 a[134:135], v22 offset:18432
v_add_u32 v22, 32768, v22
v_mfma_f32_16x16x32_bf16 v[236:239], a[140:143], a[28:31], v[236:239]
v_mfma_f32_16x16x32_bf16 v[240:243], a[136:139], a[32:35], v[240:243]
v_mfma_f32_16x16x32_bf16 v[240:243], a[140:143], a[36:39], v[240:243]
v_mfma_f32_16x16x32_bf16 v[244:247], a[136:139], a[40:43], v[244:247]
v_mfma_f32_16x16x32_bf16 v[244:247], a[140:143], a[44:47], v[244:247]
v_mfma_f32_16x16x32_bf16 v[248:251], a[136:139], a[48:51], v[248:251]
v_mfma_f32_16x16x32_bf16 v[248:251], a[140:143], a[52:55], v[248:251]
v_mfma_f32_16x16x32_bf16 v[252:255], a[136:139], a[56:59], v[252:255]
v_mfma_f32_16x16x32_bf16 v[252:255], a[140:143], a[60:63], v[252:255]
s_waitcnt lgkmcnt(2)
v_mfma_f32_16x16x32_bf16 v[36:39], a[128:131], a[64:67], v[36:39]
s_waitcnt lgkmcnt(0)
ds_read_b64_tr_b16 a[136:137], v23 offset:0
v_mfma_f32_16x16x32_bf16 v[36:39], a[132:135], a[68:71], v[36:39]
v_mfma_f32_16x16x32_bf16 v[44:47], a[128:131], a[72:75], v[44:47]
s_mul_i32 s85, s20, 7
ds_read_b64_tr_b16 a[138:139], v23 offset:2048
v_mfma_f32_16x16x32_bf16 v[44:47], a[132:135], a[76:79], v[44:47]
s_add_u32 s85, s85, s21
ds_read_b128 a[0:3], v2 offset:32768
ds_read_b128 a[4:7], v3 offset:32768
v_mfma_f32_16x16x32_bf16 v[52:55], a[128:131], a[80:83], v[52:55]
s_lshl_b32 s85, s85, 2
ds_read_b64_tr_b16 a[140:141], v23 offset:16384
v_mfma_f32_16x16x32_bf16 v[52:55], a[132:135], a[84:87], v[52:55]
s_add_u32 s85, s85, s3
v_mfma_f32_16x16x32_bf16 v[60:63], a[128:131], a[88:91], v[60:63]
s_mul_i32 s82, s85, 4224
ds_read_b64_tr_b16 a[142:143], v23 offset:18432
v_add_u32 v23, 32768, v23
v_mfma_f32_16x16x32_bf16 v[60:63], a[132:135], a[92:95], v[60:63]
s_add_u32 s82, s82, 83886208
v_mfma_f32_16x16x32_bf16 v[68:71], a[128:131], a[96:99], v[68:71]
s_lshl_b32 s83, s85, 12
ds_read_b128 a[8:11], v2 offset:34816
v_mfma_f32_16x16x32_bf16 v[68:71], a[132:135], a[100:103], v[68:71]
s_mul_i32 s84, s3, 21248
v_mfma_f32_16x16x32_bf16 v[76:79], a[128:131], a[104:107], v[76:79]
s_add_u32 s84, s84, 46080
ds_read_b128 a[12:15], v3 offset:34816
v_mfma_f32_16x16x32_bf16 v[76:79], a[132:135], a[108:111], v[76:79]
s_mov_b64 s[60:61], s[72:73]
ds_read_b128 a[16:19], v2 offset:36864
v_mfma_f32_16x16x32_bf16 v[84:87], a[128:131], a[112:115], v[84:87]
s_mov_b32 s62, 1835008
ds_read_b128 a[20:23], v3 offset:36864
v_mfma_f32_16x16x32_bf16 v[84:87], a[132:135], a[116:119], v[84:87]
v_mfma_f32_16x16x32_bf16 v[92:95], a[128:131], a[120:123], v[92:95]
ds_read_b128 a[24:27], v2 offset:38912
v_mfma_f32_16x16x32_bf16 v[92:95], a[132:135], a[124:127], v[92:95]
s_waitcnt lgkmcnt(9)
v_mfma_f32_16x16x32_bf16 v[100:103], a[136:139], a[64:67], v[100:103]
s_waitcnt lgkmcnt(5)
ds_read_b64_tr_b16 a[128:129], v24 offset:0
v_mfma_f32_16x16x32_bf16 v[100:103], a[140:143], a[68:71], v[100:103]
v_mfma_f32_16x16x32_bf16 v[108:111], a[136:139], a[72:75], v[108:111]
ds_read_b64_tr_b16 a[130:131], v24 offset:2048
v_mfma_f32_16x16x32_bf16 v[108:111], a[140:143], a[76:79], v[108:111]
ds_read_b128 a[28:31], v3 offset:38912
v_mfma_f32_16x16x32_bf16 v[116:119], a[136:139], a[80:83], v[116:119]
ds_read_b64_tr_b16 a[132:133], v24 offset:16384
v_mfma_f32_16x16x32_bf16 v[116:119], a[140:143], a[84:87], v[116:119]
v_mfma_f32_16x16x32_bf16 v[124:127], a[136:139], a[88:91], v[124:127]
ds_read_b64_tr_b16 a[134:135], v24 offset:18432
v_add_u32 v24, 32768, v24
v_mfma_f32_16x16x32_bf16 v[124:127], a[140:143], a[92:95], v[124:127]
v_mfma_f32_16x16x32_bf16 v[132:135], a[136:139], a[96:99], v[132:135]
ds_read_b128 a[32:35], v2 offset:40960
v_mfma_f32_16x16x32_bf16 v[132:135], a[140:143], a[100:103], v[132:135]
v_mfma_f32_16x16x32_bf16 v[140:143], a[136:139], a[104:107], v[140:143]
ds_read_b128 a[36:39], v3 offset:40960
v_mfma_f32_16x16x32_bf16 v[140:143], a[140:143], a[108:111], v[140:143]
ds_read_b128 a[40:43], v2 offset:43008
v_mfma_f32_16x16x32_bf16 v[148:151], a[136:139], a[112:115], v[148:151]
ds_read_b128 a[44:47], v3 offset:43008
v_mfma_f32_16x16x32_bf16 v[148:151], a[140:143], a[116:119], v[148:151]
v_mfma_f32_16x16x32_bf16 v[156:159], a[136:139], a[120:123], v[156:159]
ds_read_b128 a[48:51], v2 offset:45056
v_mfma_f32_16x16x32_bf16 v[156:159], a[140:143], a[124:127], v[156:159]
s_waitcnt lgkmcnt(8)
v_mfma_f32_16x16x32_bf16 v[164:167], a[128:131], a[64:67], v[164:167]
s_waitcnt lgkmcnt(5)
ds_read_b64_tr_b16 a[136:137], v25 offset:0
v_mfma_f32_16x16x32_bf16 v[164:167], a[132:135], a[68:71], v[164:167]
v_mfma_f32_16x16x32_bf16 v[172:175], a[128:131], a[72:75], v[172:175]
ds_read_b64_tr_b16 a[138:139], v25 offset:2048
v_mfma_f32_16x16x32_bf16 v[172:175], a[132:135], a[76:79], v[172:175]
ds_read_b128 a[52:55], v3 offset:45056
v_mfma_f32_16x16x32_bf16 v[180:183], a[128:131], a[80:83], v[180:183]
ds_read_b64_tr_b16 a[140:141], v25 offset:16384
v_mfma_f32_16x16x32_bf16 v[180:183], a[132:135], a[84:87], v[180:183]
v_mfma_f32_16x16x32_bf16 v[188:191], a[128:131], a[88:91], v[188:191]
ds_read_b64_tr_b16 a[142:143], v25 offset:18432
v_add_u32 v25, 32768, v25
v_mfma_f32_16x16x32_bf16 v[188:191], a[132:135], a[92:95], v[188:191]
v_mfma_f32_16x16x32_bf16 v[196:199], a[128:131], a[96:99], v[196:199]
ds_read_b128 a[56:59], v2 offset:47104
v_mfma_f32_16x16x32_bf16 v[196:199], a[132:135], a[100:103], v[196:199]
v_mfma_f32_16x16x32_bf16 v[204:207], a[128:131], a[104:107], v[204:207]
ds_read_b128 a[60:63], v3 offset:47104
v_mfma_f32_16x16x32_bf16 v[204:207], a[132:135], a[108:111], v[204:207]
v_mfma_f32_16x16x32_bf16 v[212:215], a[128:131], a[112:115], v[212:215]
v_mfma_f32_16x16x32_bf16 v[212:215], a[132:135], a[116:119], v[212:215]
v_mfma_f32_16x16x32_bf16 v[220:223], a[128:131], a[120:123], v[220:223]
v_mfma_f32_16x16x32_bf16 v[220:223], a[132:135], a[124:127], v[220:223]
s_waitcnt vmcnt(0) lgkmcnt(0)
s_barrier
v_mfma_f32_16x16x32_bf16 v[224:227], a[136:139], a[64:67], v[224:227]
ds_read_b64_tr_b16 a[128:129], v22 offset:0
v_mfma_f32_16x16x32_bf16 v[224:227], a[140:143], a[68:71], v[224:227]
buffer_store_dword v27, v26, s[4:7], s66 offen sc1
v_mfma_f32_16x16x32_bf16 v[228:231], a[136:139], a[72:75], v[228:231]
ds_read_b64_tr_b16 a[130:131], v22 offset:2048
v_mfma_f32_16x16x32_bf16 v[228:231], a[140:143], a[76:79], v[228:231]
v_mfma_f32_16x16x32_bf16 v[232:235], a[136:139], a[80:83], v[232:235]
ds_read_b64_tr_b16 a[132:133], v22 offset:16384
v_mfma_f32_16x16x32_bf16 v[232:235], a[140:143], a[84:87], v[232:235]
v_mfma_f32_16x16x32_bf16 v[236:239], a[136:139], a[88:91], v[236:239]
ds_read_b64_tr_b16 a[134:135], v22 offset:18432
v_mfma_f32_16x16x32_bf16 v[236:239], a[140:143], a[92:95], v[236:239]
v_mfma_f32_16x16x32_bf16 v[240:243], a[136:139], a[96:99], v[240:243]
v_mfma_f32_16x16x32_bf16 v[240:243], a[140:143], a[100:103], v[240:243]
v_mfma_f32_16x16x32_bf16 v[244:247], a[136:139], a[104:107], v[244:247]
v_mfma_f32_16x16x32_bf16 v[244:247], a[140:143], a[108:111], v[244:247]
v_mfma_f32_16x16x32_bf16 v[248:251], a[136:139], a[112:115], v[248:251]
v_mfma_f32_16x16x32_bf16 v[248:251], a[140:143], a[116:119], v[248:251]
v_mfma_f32_16x16x32_bf16 v[252:255], a[136:139], a[120:123], v[252:255]
v_mfma_f32_16x16x32_bf16 v[252:255], a[140:143], a[124:127], v[252:255]
s_waitcnt lgkmcnt(2)
v_mfma_f32_16x16x32_bf16 v[36:39], a[128:131], a[0:3], v[36:39]
s_waitcnt lgkmcnt(0)
ds_read_b64_tr_b16 a[136:137], v23 offset:0
v_lshrrev_b32 v9, 4, v1
v_mfma_f32_16x16x32_bf16 v[36:39], a[132:135], a[4:7], v[36:39]
s_add_u32 m0, s84, 17152
v_and_b32 v10, 15, v9
v_lshrrev_b32 v11, 4, v9
v_mfma_f32_16x16x32_bf16 v[44:47], a[128:131], a[8:11], v[44:47]
ds_read_b64_tr_b16 a[138:139], v23 offset:2048
v_lshrrev_b32 v12, 2, v10
v_mfma_f32_16x16x32_bf16 v[44:47], a[132:135], a[12:15], v[44:47]
buffer_load_dwordx4 v1, s[60:63], s83 offen offset:0 lds
v_mfma_f32_16x16x32_bf16 v[52:55], a[128:131], a[16:19], v[52:55]
ds_read_b64_tr_b16 a[140:141], v23 offset:16384
v_mul_u32_u24 v12, 4160, v12
v_mfma_f32_16x16x32_bf16 v[52:55], a[132:135], a[20:23], v[52:55]
buffer_load_dwordx4 v1, s[60:63], s83 offen offset:1024 lds
v_mfma_f32_16x16x32_bf16 v[60:63], a[128:131], a[24:27], v[60:63]
ds_read_b64_tr_b16 a[142:143], v23 offset:18432
v_and_b32 v13, 3, v9
v_mfma_f32_16x16x32_bf16 v[60:63], a[132:135], a[28:31], v[60:63]
buffer_load_dwordx4 v1, s[60:63], s83 offen offset:2048 lds
v_mfma_f32_16x16x32_bf16 v[68:71], a[128:131], a[32:35], v[68:71]
buffer_load_dwordx4 v1, s[60:63], s83 offen offset:3072 lds
v_mfma_f32_16x16x32_bf16 v[68:71], a[132:135], a[36:39], v[68:71]
s_add_u32 m0, s84, 64
v_lshl_add_u32 v12, v13, 3, v12
v_lshlrev_b32 v13, 4, v11
v_mfma_f32_16x16x32_bf16 v[76:79], a[128:131], a[40:43], v[76:79]
buffer_load_dwordx4 v1, s[4:7], s82 offen offset:0 sc1 lds
v_mfma_f32_16x16x32_bf16 v[76:79], a[132:135], a[44:47], v[76:79]
buffer_load_dwordx4 v1, s[4:7], s82 offen offset:1024 sc1 lds
v_mfma_f32_16x16x32_bf16 v[84:87], a[128:131], a[48:51], v[84:87]
buffer_load_dwordx4 v1, s[4:7], s82 offen offset:2048 sc1 lds
v_mfma_f32_16x16x32_bf16 v[84:87], a[132:135], a[52:55], v[84:87]
buffer_load_dwordx4 v1, s[4:7], s82 offen offset:3072 sc1 lds
v_mfma_f32_16x16x32_bf16 v[92:95], a[128:131], a[56:59], v[92:95]
s_add_u32 s82, s82, 2097152
v_sub_u32 v12, v12, v13
v_add_u32 v12, 88, v12
v_mfma_f32_16x16x32_bf16 v[92:95], a[132:135], a[60:63], v[92:95]
s_waitcnt lgkmcnt(2)
v_add_u32 v16, s84, v12
v_lshl_add_u32 v12, v10, 5, v13
v_mfma_f32_16x16x32_bf16 v[100:103], a[136:139], a[0:3], v[100:103]
s_waitcnt lgkmcnt(0)
ds_read_b64_tr_b16 a[128:129], v24 offset:0
v_add_u32 v12, 16672, v12
v_mfma_f32_16x16x32_bf16 v[100:103], a[140:143], a[4:7], v[100:103]
s_add_u32 m0, s84, 4224
v_add_u32 v17, s84, v12
v_lshlrev_b32 v12, 5, v10
v_mfma_f32_16x16x32_bf16 v[108:111], a[136:139], a[8:11], v[108:111]
ds_read_b64_tr_b16 a[130:131], v24 offset:2048
v_lshl_add_u32 v8, v11, 3, v12
v_mfma_f32_16x16x32_bf16 v[108:111], a[140:143], a[12:15], v[108:111]
buffer_load_dwordx4 v1, s[4:7], s82 offen offset:0 sc1 lds
v_mfma_f32_16x16x32_bf16 v[116:119], a[136:139], a[16:19], v[116:119]
ds_read_b64_tr_b16 a[132:133], v24 offset:16384
v_add3_u32 v18, s84, 64, v8
v_mfma_f32_16x16x32_bf16 v[116:119], a[140:143], a[20:23], v[116:119]
buffer_load_dwordx4 v1, s[4:7], s82 offen offset:1024 sc1 lds
v_mfma_f32_16x16x32_bf16 v[124:127], a[136:139], a[24:27], v[124:127]
ds_read_b64_tr_b16 a[134:135], v24 offset:18432
v_mov_b32 v19, 0
v_mfma_f32_16x16x32_bf16 v[124:127], a[140:143], a[28:31], v[124:127]
buffer_load_dwordx4 v1, s[4:7], s82 offen offset:2048 sc1 lds
v_mfma_f32_16x16x32_bf16 v[132:135], a[136:139], a[32:35], v[132:135]
buffer_load_dwordx4 v1, s[4:7], s82 offen offset:3072 sc1 lds
v_mfma_f32_16x16x32_bf16 v[132:135], a[140:143], a[36:39], v[132:135]
s_add_u32 s82, s82, 4292870140
v_mov_b32 v12, 0
v_mov_b32 v13, 0
v_mfma_f32_16x16x32_bf16 v[140:143], a[136:139], a[40:43], v[140:143]
s_add_u32 m0, s84, 8384
v_lshl_add_u32 v14, v9, 3, s84
v_mfma_f32_16x16x32_bf16 v[140:143], a[140:143], a[44:47], v[140:143]
buffer_load_dwordx4 v1, s[4:7], s82 offen offset:0 sc1 lds
v_mfma_f32_16x16x32_bf16 v[148:151], a[136:139], a[48:51], v[148:151]
buffer_load_dwordx4 v1, s[4:7], s82 offen offset:1024 sc1 lds
v_mfma_f32_16x16x32_bf16 v[148:151], a[140:143], a[52:55], v[148:151]
buffer_load_dwordx4 v1, s[4:7], s82 offen offset:2048 sc1 lds
v_mfma_f32_16x16x32_bf16 v[156:159], a[136:139], a[56:59], v[156:159]
buffer_load_dwordx4 v1, s[4:7], s82 offen offset:3072 sc1 lds
v_mfma_f32_16x16x32_bf16 v[156:159], a[140:143], a[60:63], v[156:159]
s_waitcnt lgkmcnt(2)
ds_write_b64 v14, v[12:13] offset:16640
v_mul_u32_u24 v14, 4160, v11
v_mfma_f32_16x16x32_bf16 v[164:167], a[128:131], a[0:3], v[164:167]
s_waitcnt lgkmcnt(1)
ds_read_b64_tr_b16 a[136:137], v25 offset:0
v_lshl_add_u32 v14, v10, 2, v14
v_mfma_f32_16x16x32_bf16 v[164:167], a[132:135], a[4:7], v[164:167]
s_add_u32 s82, s82, 2097152
v_add_u32 v14, s84, v14
v_mfma_f32_16x16x32_bf16 v[172:175], a[128:131], a[8:11], v[172:175]
s_add_u32 m0, s84, 12544
ds_read_b64_tr_b16 a[138:139], v25 offset:2048
v_mfma_f32_16x16x32_bf16 v[172:175], a[132:135], a[12:15], v[172:175]
buffer_load_dwordx4 v1, s[4:7], s82 offen offset:0 sc1 lds
v_mfma_f32_16x16x32_bf16 v[180:183], a[128:131], a[16:19], v[180:183]
ds_read_b64_tr_b16 a[140:141], v25 offset:16384
v_mfma_f32_16x16x32_bf16 v[180:183], a[132:135], a[20:23], v[180:183]
buffer_load_dwordx4 v1, s[4:7], s82 offen offset:1024 sc1 lds
v_mfma_f32_16x16x32_bf16 v[188:191], a[128:131], a[24:27], v[188:191]
ds_read_b64_tr_b16 a[142:143], v25 offset:18432
v_mfma_f32_16x16x32_bf16 v[188:191], a[132:135], a[28:31], v[188:191]
buffer_load_dwordx4 v1, s[4:7], s82 offen offset:2048 sc1 lds
v_mfma_f32_16x16x32_bf16 v[196:199], a[128:131], a[32:35], v[196:199]
buffer_load_dwordx4 v1, s[4:7], s82 offen offset:3072 sc1 lds
v_mfma_f32_16x16x32_bf16 v[196:199], a[132:135], a[36:39], v[196:199]
ds_write_b32 v14, v12
v_lshrrev_b32 v30, 6, v0
v_mfma_f32_16x16x32_bf16 v[204:207], a[128:131], a[40:43], v[204:207]
v_lshl_add_u32 v28, v30, 11, v1
v_add_u32 v29, 0x20000, v28
v_mfma_f32_16x16x32_bf16 v[204:207], a[132:135], a[44:47], v[204:207]
v_lshl_add_u32 v30, v30, 13, v1
v_add_u32 v31, 0x20000, v30
v_mfma_f32_16x16x32_bf16 v[212:215], a[128:131], a[48:51], v[212:215]
v_mul_f32 v36, s68, v36
v_mul_f32 v37, s68, v37
v_mfma_f32_16x16x32_bf16 v[212:215], a[132:135], a[52:55], v[212:215]
v_mul_f32 v38, s68, v38
v_mul_f32 v39, s68, v39
v_mfma_f32_16x16x32_bf16 v[220:223], a[128:131], a[56:59], v[220:223]
v_mul_f32 v100, s68, v100
v_mul_f32 v101, s68, v101
v_mfma_f32_16x16x32_bf16 v[220:223], a[132:135], a[60:63], v[220:223]
s_waitcnt lgkmcnt(2)
s_waitcnt lgkmcnt(0)
s_barrier
v_mfma_f32_16x16x32_bf16 v[224:227], a[136:139], a[0:3], v[224:227]
v_mul_f32 v102, s68, v102
v_mul_f32 v103, s68, v103
v_mfma_f32_16x16x32_bf16 v[224:227], a[140:143], a[4:7], v[224:227]
v_cvt_pk_bf16_f32 v36, v36, v37
v_cvt_pk_bf16_f32 v37, v38, v39
v_mfma_f32_16x16x32_bf16 v[228:231], a[136:139], a[8:11], v[228:231]
v_cvt_pk_bf16_f32 v38, v100, v101
v_cvt_pk_bf16_f32 v39, v102, v103
v_mfma_f32_16x16x32_bf16 v[228:231], a[140:143], a[12:15], v[228:231]
v_mul_f32 v44, s68, v44
v_mul_f32 v45, s68, v45
v_mfma_f32_16x16x32_bf16 v[232:235], a[136:139], a[16:19], v[232:235]
v_mul_f32 v46, s68, v46
v_mul_f32 v47, s68, v47
v_mfma_f32_16x16x32_bf16 v[232:235], a[140:143], a[20:23], v[232:235]
v_mul_f32 v108, s68, v108
v_mul_f32 v109, s68, v109
v_mfma_f32_16x16x32_bf16 v[236:239], a[136:139], a[24:27], v[236:239]
v_mul_f32 v110, s68, v110
v_mul_f32 v111, s68, v111
v_mfma_f32_16x16x32_bf16 v[236:239], a[140:143], a[28:31], v[236:239]
v_cvt_pk_bf16_f32 v44, v44, v45
v_cvt_pk_bf16_f32 v45, v46, v47
v_mfma_f32_16x16x32_bf16 v[240:243], a[136:139], a[32:35], v[240:243]
v_cvt_pk_bf16_f32 v46, v108, v109
v_cvt_pk_bf16_f32 v47, v110, v111
v_mfma_f32_16x16x32_bf16 v[240:243], a[140:143], a[36:39], v[240:243]
v_mul_f32 v52, s68, v52
v_mul_f32 v53, s68, v53
v_mfma_f32_16x16x32_bf16 v[244:247], a[136:139], a[40:43], v[244:247]
v_mul_f32 v54, s68, v54
v_mul_f32 v55, s68, v55
v_mfma_f32_16x16x32_bf16 v[244:247], a[140:143], a[44:47], v[244:247]
v_mul_f32 v116, s68, v116
v_mul_f32 v117, s68, v117
v_mfma_f32_16x16x32_bf16 v[248:251], a[136:139], a[48:51], v[248:251]
v_mul_f32 v118, s68, v118
v_mul_f32 v119, s68, v119
v_mfma_f32_16x16x32_bf16 v[248:251], a[140:143], a[52:55], v[248:251]
v_cvt_pk_bf16_f32 v52, v52, v53
v_cvt_pk_bf16_f32 v53, v54, v55
v_mfma_f32_16x16x32_bf16 v[252:255], a[136:139], a[56:59], v[252:255]
v_cvt_pk_bf16_f32 v54, v116, v117
v_cvt_pk_bf16_f32 v55, v118, v119
v_mfma_f32_16x16x32_bf16 v[252:255], a[140:143], a[60:63], v[252:255]
s_mov_b64 s[60:61], s[74:75]
s_mov_b32 s62, 896
s_lshl_b32 s79, s85, 1
buffer_load_short_d16_hi v19, off, s[60:63], s79
s_lshl_b32 s83, s85, 12
s_add_u32 s83, s83, 88080384
ds_write_b128 v28, v[36:39] offset:0
ds_write_b128 v28, v[44:47] offset:8192
ds_write_b128 v28, v[52:55] offset:16384
v_pk_mul_f32 v[60:61], v[60:61], s[68:69]
v_pk_mul_f32 v[62:63], v[62:63], s[68:69]
v_pk_mul_f32 v[124:125], v[124:125], s[68:69]
v_pk_mul_f32 v[126:127], v[126:127], s[68:69]
v_cvt_pk_bf16_f32 v60, v60, v61
v_cvt_pk_bf16_f32 v61, v62, v63
v_cvt_pk_bf16_f32 v62, v124, v125
v_cvt_pk_bf16_f32 v63, v126, v127
ds_write_b128 v28, v[60:63] offset:24576
v_pk_mul_f32 v[68:69], v[68:69], s[68:69]
v_pk_mul_f32 v[70:71], v[70:71], s[68:69]
v_pk_mul_f32 v[132:133], v[132:133], s[68:69]
v_pk_mul_f32 v[134:135], v[134:135], s[68:69]
v_cvt_pk_bf16_f32 v68, v68, v69
v_cvt_pk_bf16_f32 v69, v70, v71
v_cvt_pk_bf16_f32 v70, v132, v133
v_cvt_pk_bf16_f32 v71, v134, v135
ds_write_b128 v29, v[68:71] offset:0
v_pk_mul_f32 v[76:77], v[76:77], s[68:69]
v_pk_mul_f32 v[78:79], v[78:79], s[68:69]
v_pk_mul_f32 v[140:141], v[140:141], s[68:69]
v_pk_mul_f32 v[142:143], v[142:143], s[68:69]
v_cvt_pk_bf16_f32 v76, v76, v77
v_cvt_pk_bf16_f32 v77, v78, v79
v_cvt_pk_bf16_f32 v78, v140, v141
v_cvt_pk_bf16_f32 v79, v142, v143
ds_write_b128 v29, v[76:79] offset:8192
v_pk_mul_f32 v[84:85], v[84:85], s[68:69]
v_pk_mul_f32 v[86:87], v[86:87], s[68:69]
v_pk_mul_f32 v[148:149], v[148:149], s[68:69]
v_pk_mul_f32 v[150:151], v[150:151], s[68:69]
v_cvt_pk_bf16_f32 v84, v84, v85
v_cvt_pk_bf16_f32 v85, v86, v87
v_cvt_pk_bf16_f32 v86, v148, v149
v_cvt_pk_bf16_f32 v87, v150, v151
ds_write_b128 v29, v[84:87] offset:16384
v_pk_mul_f32 v[92:93], v[92:93], s[68:69]
v_pk_mul_f32 v[94:95], v[94:95], s[68:69]
v_pk_mul_f32 v[156:157], v[156:157], s[68:69]
v_pk_mul_f32 v[158:159], v[158:159], s[68:69]
v_cvt_pk_bf16_f32 v92, v92, v93
v_cvt_pk_bf16_f32 v93, v94, v95
v_cvt_pk_bf16_f32 v94, v156, v157
v_cvt_pk_bf16_f32 v95, v158, v159
ds_write_b128 v29, v[92:95] offset:24576
v_pk_mul_f32 v[164:165], v[164:165], s[68:69]
v_pk_mul_f32 v[166:167], v[166:167], s[68:69]
v_pk_mul_f32 v[224:225], v[224:225], s[68:69]
v_pk_mul_f32 v[226:227], v[226:227], s[68:69]
v_cvt_pk_bf16_f32 v164, v164, v165
v_cvt_pk_bf16_f32 v165, v166, v167
v_cvt_pk_bf16_f32 v166, v224, v225
v_cvt_pk_bf16_f32 v167, v226, v227
ds_write_b128 v28, v[164:167] offset:1024
v_pk_mul_f32 v[172:173], v[172:173], s[68:69]
v_pk_mul_f32 v[174:175], v[174:175], s[68:69]
v_pk_mul_f32 v[228:229], v[228:229], s[68:69]
v_pk_mul_f32 v[230:231], v[230:231], s[68:69]
v_cvt_pk_bf16_f32 v172, v172, v173
v_cvt_pk_bf16_f32 v173, v174, v175
v_cvt_pk_bf16_f32 v174, v228, v229
v_cvt_pk_bf16_f32 v175, v230, v231
ds_write_b128 v28, v[172:175] offset:9216
v_pk_mul_f32 v[180:181], v[180:181], s[68:69]
v_pk_mul_f32 v[182:183], v[182:183], s[68:69]
v_pk_mul_f32 v[232:233], v[232:233], s[68:69]
v_pk_mul_f32 v[234:235], v[234:235], s[68:69]
v_cvt_pk_bf16_f32 v180, v180, v181
v_cvt_pk_bf16_f32 v181, v182, v183
v_cvt_pk_bf16_f32 v182, v232, v233
v_cvt_pk_bf16_f32 v183, v234, v235
ds_write_b128 v28, v[180:183] offset:17408
v_pk_mul_f32 v[188:189], v[188:189], s[68:69]
v_pk_mul_f32 v[190:191], v[190:191], s[68:69]
v_pk_mul_f32 v[236:237], v[236:237], s[68:69]
v_pk_mul_f32 v[238:239], v[238:239], s[68:69]
v_cvt_pk_bf16_f32 v188, v188, v189
v_cvt_pk_bf16_f32 v189, v190, v191
v_cvt_pk_bf16_f32 v190, v236, v237
v_cvt_pk_bf16_f32 v191, v238, v239
ds_write_b128 v28, v[188:191] offset:25600
v_pk_mul_f32 v[196:197], v[196:197], s[68:69]
v_pk_mul_f32 v[198:199], v[198:199], s[68:69]
v_pk_mul_f32 v[240:241], v[240:241], s[68:69]
v_pk_mul_f32 v[242:243], v[242:243], s[68:69]
v_cvt_pk_bf16_f32 v196, v196, v197
v_cvt_pk_bf16_f32 v197, v198, v199
v_cvt_pk_bf16_f32 v198, v240, v241
v_cvt_pk_bf16_f32 v199, v242, v243
ds_write_b128 v29, v[196:199] offset:1024
v_pk_mul_f32 v[204:205], v[204:205], s[68:69]
v_pk_mul_f32 v[206:207], v[206:207], s[68:69]
v_pk_mul_f32 v[244:245], v[244:245], s[68:69]
v_pk_mul_f32 v[246:247], v[246:247], s[68:69]
v_cvt_pk_bf16_f32 v204, v204, v205
v_cvt_pk_bf16_f32 v205, v206, v207
v_cvt_pk_bf16_f32 v206, v244, v245
v_cvt_pk_bf16_f32 v207, v246, v247
ds_write_b128 v29, v[204:207] offset:9216
v_pk_mul_f32 v[212:213], v[212:213], s[68:69]
v_pk_mul_f32 v[214:215], v[214:215], s[68:69]
v_pk_mul_f32 v[248:249], v[248:249], s[68:69]
v_pk_mul_f32 v[250:251], v[250:251], s[68:69]
v_cvt_pk_bf16_f32 v212, v212, v213
v_cvt_pk_bf16_f32 v213, v214, v215
v_cvt_pk_bf16_f32 v214, v248, v249
v_cvt_pk_bf16_f32 v215, v250, v251
ds_write_b128 v29, v[212:215] offset:17408
v_pk_mul_f32 v[220:221], v[220:221], s[68:69]
v_pk_mul_f32 v[222:223], v[222:223], s[68:69]
v_pk_mul_f32 v[252:253], v[252:253], s[68:69]
v_pk_mul_f32 v[254:255], v[254:255], s[68:69]
v_cvt_pk_bf16_f32 v220, v220, v221
v_cvt_pk_bf16_f32 v221, v222, v223
v_cvt_pk_bf16_f32 v222, v252, v253
v_cvt_pk_bf16_f32 v223, v254, v255
ds_write_b128 v29, v[220:223] offset:25600
s_waitcnt vmcnt(1) lgkmcnt(0)
s_barrier
buffer_load_dword v21, v20, s[4:7], s70 offen sc1
ds_read_b64_tr_b16 a[64:65], v16 offset:8
ds_read_b64_tr_b16 a[66:67], v16 offset:0
ds_read_b128 a[96:99], v17 offset:448
ds_read_b64_tr_b16 a[68:69], v16 offset:520
ds_read_b64_tr_b16 a[70:71], v16 offset:512
ds_read_b128 a[100:103], v17 offset:960
ds_read_b64_tr_b16 a[72:73], v16 offset:1032
ds_read_b64_tr_b16 a[74:75], v16 offset:1024
ds_read_b128 a[104:107], v17 offset:1472
ds_read_b64_tr_b16 a[76:77], v16 offset:1544
ds_read_b64_tr_b16 a[78:79], v16 offset:1536
ds_read_b128 a[108:111], v17 offset:1984
ds_read_b64_tr_b16 a[80:81], v16 offset:2056
ds_read_b64_tr_b16 a[82:83], v16 offset:2048
ds_read_b128 a[112:115], v17 offset:2496
ds_read_b64_tr_b16 a[84:85], v16 offset:2568
ds_read_b64_tr_b16 a[86:87], v16 offset:2560
ds_read_b128 a[116:119], v17 offset:3008
ds_read_b64_tr_b16 a[88:89], v16 offset:3080
ds_read_b64_tr_b16 a[90:91], v16 offset:3072
ds_read_b128 a[120:123], v17 offset:3520
ds_read_b64_tr_b16 a[92:93], v16 offset:3592
ds_read_b64_tr_b16 a[94:95], v16 offset:3584
ds_read_b128 a[124:127], v17 offset:4032
s_waitcnt lgkmcnt(15)
v_mfma_f32_16x16x32_bf16 v[96:99], a[64:67], a[96:99], 0
s_waitcnt lgkmcnt(12)
s_lshl_b32 s18, s3, 13
ds_read_b64_tr_b16 a[128:129], v16 offset:72
v_mov_b32 v24, 0
v_mfma_f32_16x16x32_bf16 v[100:103], a[64:67], a[100:103], 0
s_lshl_b32 s30, s20, 20
ds_read_b64_tr_b16 a[130:131], v16 offset:64
v_lshrrev_b32 v3, 6, v0
v_mfma_f32_16x16x32_bf16 v[100:103], a[68:71], a[96:99], v[100:103]
s_add_u32 s30, s30, s18
ds_read_b128 a[160:163], v17 offset:384
v_and_b32 v4, 63, v0
v_mfma_f32_16x16x32_bf16 v[104:107], a[64:67], a[104:107], 0
s_lshl_b32 s22, s21, 1
ds_read_b128 a[192:195], v30 offset:0
v_add_u32 v2, 0x10000, v1
v_mfma_f32_16x16x32_bf16 v[104:107], a[68:71], a[100:103], v[104:107]
s_lshl_b32 s85, s21, 2
ds_read_b64_tr_b16 a[132:133], v16 offset:584
v_and_b32 v5, 15, v4
v_mfma_f32_16x16x32_bf16 v[104:107], a[72:75], a[96:99], v[104:107]
s_lshr_b32 s85, 2386092, s85
ds_read_b64_tr_b16 a[134:135], v16 offset:576
v_lshrrev_b32 v6, 4, v4
v_mfma_f32_16x16x32_bf16 v[108:111], a[64:67], a[108:111], 0
s_and_b32 s9, s85, 15
ds_read_b128 a[164:167], v17 offset:896
v_lshlrev_b32 v6, 2, v6
v_mfma_f32_16x16x32_bf16 v[108:111], a[68:71], a[104:107], v[108:111]
s_and_b32 s84, s85, 1
ds_read_b128 a[196:199], v30 offset:1024
v_sub_u32 v5, v5, v6
v_mfma_f32_16x16x32_bf16 v[108:111], a[72:75], a[100:103], v[108:111]
s_lshl_b32 s84, s84, 17
ds_read_b64_tr_b16 a[136:137], v16 offset:1096
v_lshl_add_u32 v5, v3, 4, v5
v_mfma_f32_16x16x32_bf16 v[108:111], a[76:79], a[96:99], v[108:111]
s_waitcnt lgkmcnt(15)
s_add_u32 s84, s84, s18
ds_read_b64_tr_b16 a[138:139], v16 offset:1088
v_cmp_gt_i32 s[32:33], 0, v5
v_mfma_f32_16x16x32_bf16 v[112:115], a[64:67], a[112:115], 0
s_xor_b32 s85, s84, 0x20000
ds_read_b128 a[168:171], v17 offset:1408
v_cmp_gt_i32 s[34:35], 1, v5
v_mfma_f32_16x16x32_bf16 v[112:115], a[68:71], a[108:111], v[112:115]
s_sub_u32 s29, 15, s21
ds_read_b128 a[200:203], v30 offset:2048
v_cmp_gt_i32 s[36:37], 2, v5
v_mfma_f32_16x16x32_bf16 v[112:115], a[72:75], a[104:107], v[112:115]
s_mov_b32 s8, s30
ds_read_b64_tr_b16 a[140:141], v16 offset:1608
v_cmp_gt_i32 s[38:39], 3, v5
v_mfma_f32_16x16x32_bf16 v[112:115], a[76:79], a[100:103], v[112:115]
s_add_u32 s11, s22, 2
ds_read_b64_tr_b16 a[142:143], v16 offset:1600
v_cmp_gt_i32 s[40:41], 16, v5
v_mfma_f32_16x16x32_bf16 v[112:115], a[80:83], a[96:99], v[112:115]
s_add_u32 s14, s30, 16777216
ds_read_b128 a[172:175], v17 offset:1920
v_cmp_gt_i32 s[42:43], 17, v5
v_mfma_f32_16x16x32_bf16 v[116:119], a[64:67], a[116:119], 0
s_lshr_b32 s19, s9, 1
ds_read_b128 a[204:207], v30 offset:3072
v_cmp_gt_i32 s[44:45], 18, v5
v_mfma_f32_16x16x32_bf16 v[116:119], a[68:71], a[112:115], v[116:119]
s_cmp_lg_u32 s9, 0
ds_read_b64_tr_b16 a[144:145], v16 offset:2120
v_cmp_gt_i32 s[46:47], 19, v5
v_mfma_f32_16x16x32_bf16 v[116:119], a[72:75], a[108:111], v[116:119]
s_cselect_b32 s10, s30, 3221225472
ds_read_b64_tr_b16 a[146:147], v16 offset:2112
v_cmp_gt_i32 s[48:49], 32, v5
v_mfma_f32_16x16x32_bf16 v[116:119], a[76:79], a[104:107], v[116:119]
s_cselect_b32 s14, s14, 3221225472
ds_read_b128 a[176:179], v17 offset:2432
v_cmp_gt_i32 s[50:51], 33, v5
v_mfma_f32_16x16x32_bf16 v[116:119], a[80:83], a[100:103], v[116:119]
s_cselect_b32 s9, s9, s11
ds_read_b128 a[208:211], v30 offset:4096
v_cmp_gt_i32 s[52:53], 34, v5
v_mfma_f32_16x16x32_bf16 v[116:119], a[84:87], a[96:99], v[116:119]
s_waitcnt lgkmcnt(15)
s_cselect_b32 s19, s19, s21
ds_read_b64_tr_b16 a[148:149], v16 offset:2632
v_cmp_gt_i32 s[54:55], 35, v5
v_mfma_f32_16x16x32_bf16 v[120:123], a[64:67], a[120:123], 0
s_cselect_b32 s29, s29, s21
ds_read_b64_tr_b16 a[150:151], v16 offset:2624
v_cmp_gt_i32 s[56:57], 48, v5
v_mfma_f32_16x16x32_bf16 v[120:123], a[68:71], a[116:119], v[120:123]
s_cselect_b32 s24, 2, 0
ds_read_b128 a[180:183], v17 offset:2944
v_cmp_gt_i32 s[58:59], 49, v5
v_mfma_f32_16x16x32_bf16 v[120:123], a[72:75], a[112:115], v[120:123]
s_add_u32 s12, s8, 16777216
ds_read_b128 a[212:215], v30 offset:5120
v_cmp_gt_i32 s[60:61], 50, v5
v_mfma_f32_16x16x32_bf16 v[120:123], a[76:79], a[108:111], v[120:123]
s_mov_b32 s13, s9
ds_read_b64_tr_b16 a[152:153], v16 offset:3144
v_cmp_gt_i32 s[62:63], 51, v5
v_mfma_f32_16x16x32_bf16 v[120:123], a[80:83], a[104:107], v[120:123]
s_mov_b32 s15, s11
ds_read_b64_tr_b16 a[154:155], v16 offset:3136
v_mov_b32 v7, 0xff800000
v_mfma_f32_16x16x32_bf16 v[120:123], a[84:87], a[100:103], v[120:123]
s_mov_b32 s25, 1266679808
ds_read_b128 a[184:187], v17 offset:3456
v_mov_b32 v6, 1
v_mfma_f32_16x16x32_bf16 v[120:123], a[88:91], a[96:99], v[120:123]
s_lshl_b32 s22, s21, 3
ds_read_b128 a[216:219], v30 offset:6144
v_mov_b32 v5, v26
v_mfma_f32_16x16x32_bf16 v[124:127], a[64:67], a[124:127], 0
s_add_u32 s28, s70, s22
ds_read_b64_tr_b16 a[156:157], v16 offset:3656
v_add_u32 v4, 0x20000, v1
v_mfma_f32_16x16x32_bf16 v[124:127], a[68:71], a[120:123], v[124:127]
s_add_u32 s28, s28, 6148
ds_read_b64_tr_b16 a[158:159], v16 offset:3648
v_mfma_f32_16x16x32_bf16 v[124:127], a[72:75], a[116:119], v[124:127]
s_lshl_b32 s26, s21, 16
ds_read_b128 a[188:191], v17 offset:3968
v_mfma_f32_16x16x32_bf16 v[124:127], a[76:79], a[112:115], v[124:127]
s_add_u32 s26, s26, s30
ds_read_b128 a[220:223], v30 offset:7168
v_mfma_f32_16x16x32_bf16 v[124:127], a[80:83], a[108:111], v[124:127]
s_add_u32 s26, s26, 33554432
ds_read_b128 a[224:227], v31 offset:0
v_mfma_f32_16x16x32_bf16 v[124:127], a[84:87], a[104:107], v[124:127]
s_lshl_b32 s76, s20, 3
ds_read_b128 a[228:231], v31 offset:1024
v_mfma_f32_16x16x32_bf16 v[124:127], a[88:91], a[100:103], v[124:127]
s_add_u32 s76, s76, s21
ds_read_b128 a[232:235], v31 offset:2048
v_mfma_f32_16x16x32_bf16 v[124:127], a[92:95], a[96:99], v[124:127]
s_lshl_b32 s76, s76, 2
ds_read_b128 a[236:239], v31 offset:3072
v_mfma_f32_16x16x32_bf16 v[96:99], a[128:131], a[160:163], v[96:99]
s_waitcnt lgkmcnt(15)
s_add_u32 s76, s76, s3
ds_read_b64_tr_b16 a[64:65], v16 offset:136
v_mfma_f32_16x16x32_bf16 v[100:103], a[128:131], a[164:167], v[100:103]
s_lshl_b32 s27, s76, 10
ds_read_b64_tr_b16 a[66:67], v16 offset:128
v_mfma_f32_16x16x32_bf16 v[100:103], a[132:135], a[160:163], v[100:103]
s_add_u32 s27, s27, 75497472
ds_read_b128 a[96:99], v17 offset:320
v_mfma_f32_16x16x32_bf16 v[104:107], a[128:131], a[168:171], v[104:107]
s_lshl_b32 s76, s76, 14
ds_read_b128 a[240:243], v31 offset:4096
v_mfma_f32_16x16x32_bf16 v[104:107], a[132:135], a[164:167], v[104:107]
s_add_u32 s76, s76, 67108864
ds_read_b64_tr_b16 a[68:69], v16 offset:648
v_mfma_f32_16x16x32_bf16 v[104:107], a[136:139], a[160:163], v[104:107]
s_lshl_b32 s81, s20, 2
ds_read_b64_tr_b16 a[70:71], v16 offset:640
v_mfma_f32_16x16x32_bf16 v[108:111], a[128:131], a[172:175], v[108:111]
s_add_u32 s81, s81, s3
ds_read_b128 a[100:103], v17 offset:832
v_mfma_f32_16x16x32_bf16 v[108:111], a[132:135], a[168:171], v[108:111]
s_mul_i32 s81, s81, 57344
ds_read_b128 a[244:247], v31 offset:5120
v_mfma_f32_16x16x32_bf16 v[108:111], a[136:139], a[164:167], v[108:111]
s_cmp_eq_u32 s24, 1
ds_read_b64_tr_b16 a[72:73], v16 offset:1160
v_mfma_f32_16x16x32_bf16 v[108:111], a[140:143], a[160:163], v[108:111]
s_cselect_b32 s80, s28, s70
ds_read_b64_tr_b16 a[74:75], v16 offset:1152
v_mfma_f32_16x16x32_bf16 v[112:115], a[128:131], a[176:179], v[112:115]
s_add_u32 s77, s76, 8192
ds_read_b128 a[104:107], v17 offset:1344
v_mfma_f32_16x16x32_bf16 v[112:115], a[132:135], a[172:175], v[112:115]
s_lshl_b32 s71, s2, 2
ds_read_b128 a[248:251], v31 offset:6144
v_mfma_f32_16x16x32_bf16 v[112:115], a[136:139], a[168:171], v[112:115]
s_add_u32 s71, s71, 94384128
ds_read_b64_tr_b16 a[76:77], v16 offset:1672
v_mfma_f32_16x16x32_bf16 v[112:115], a[140:143], a[164:167], v[112:115]
s_lshl_b32 s78, s29, 16
ds_read_b64_tr_b16 a[78:79], v16 offset:1664
v_mfma_f32_16x16x32_bf16 v[112:115], a[144:147], a[160:163], v[112:115]
s_waitcnt lgkmcnt(15)
s_add_u32 s78, s78, s30
ds_read_b128 a[108:111], v17 offset:1856
v_mfma_f32_16x16x32_bf16 v[116:119], a[128:131], a[180:183], v[116:119]
s_add_u32 s78, s78, 33554432
ds_read_b128 a[252:255], v31 offset:7168
v_mfma_f32_16x16x32_bf16 v[116:119], a[132:135], a[176:179], v[116:119]
s_cmp_eq_u32 s24, 0
ds_read_b64_tr_b16 a[80:81], v16 offset:2184
v_mfma_f32_16x16x32_bf16 v[116:119], a[136:139], a[172:175], v[116:119]
s_cselect_b32 s78, 3221225472, s78
ds_read_b64_tr_b16 a[82:83], v16 offset:2176
v_mfma_f32_16x16x32_bf16 v[116:119], a[140:143], a[168:171], v[116:119]
s_lshl_b32 s22, s21, 3
ds_read_b128 a[112:115], v17 offset:2368
v_mfma_f32_16x16x32_bf16 v[116:119], a[144:147], a[164:167], v[116:119]
s_add_u32 s22, s22, 16384
v_mfma_f32_16x16x32_bf16 v[116:119], a[148:151], a[160:163], v[116:119]
ds_read_b64_tr_b16 a[84:85], v16 offset:2696
v_writelane_b32 v15, s22, 63
v_mfma_f32_16x16x32_bf16 v[120:123], a[128:131], a[184:187], v[120:123]
ds_read_b64_tr_b16 a[86:87], v16 offset:2688
v_mov_b32 v25, 0
v_mfma_f32_16x16x32_bf16 v[120:123], a[132:135], a[180:183], v[120:123]
s_waitcnt vmcnt(0) lgkmcnt(5)
s_barrier
ds_read_b128 a[116:119], v17 offset:2880
v_cmp_gt_u32 vcc, 1, v21
v_mfma_f32_16x16x32_bf16 v[120:123], a[136:139], a[176:179], v[120:123]
s_cbranch_vccnz M_kspin2
M_kok2:
v_mov_b32 v128, 0
v_mov_b32 v129, 0
v_mfma_f32_16x16x32_bf16 v[120:123], a[140:143], a[172:175], v[120:123]
s_mov_b32 m0, s84
ds_read_b64_tr_b16 a[88:89], v16 offset:3208
v_mov_b32 v130, 0
v_mfma_f32_16x16x32_bf16 v[120:123], a[144:147], a[168:171], v[120:123]
ds_read_b64_tr_b16 a[90:91], v16 offset:3200
v_mov_b32 v131, 0
v_mfma_f32_16x16x32_bf16 v[120:123], a[148:151], a[164:167], v[120:123]
ds_read_b128 a[120:123], v17 offset:3392
v_mov_b32 v132, 0
v_mfma_f32_16x16x32_bf16 v[120:123], a[152:155], a[160:163], v[120:123]
buffer_load_dwordx4 v1, s[4:7], s8 offen offset:0 sc1 lds
v_mfma_f32_16x16x32_bf16 v[124:127], a[128:131], a[188:191], v[124:127]
ds_read_b64_tr_b16 a[92:93], v16 offset:3720
v_mov_b32 v133, 0
v_mfma_f32_16x16x32_bf16 v[124:127], a[132:135], a[184:187], v[124:127]
ds_read_b64_tr_b16 a[94:95], v16 offset:3712
v_mov_b32 v134, 0
v_mfma_f32_16x16x32_bf16 v[124:127], a[136:139], a[180:183], v[124:127]
ds_read_b128 a[124:127], v17 offset:3904
v_mov_b32 v135, 0
v_mfma_f32_16x16x32_bf16 v[124:127], a[140:143], a[176:179], v[124:127]
buffer_load_dwordx4 v1, s[4:7], s8 offen offset:1024 sc1 lds
v_mfma_f32_16x16x32_bf16 v[124:127], a[144:147], a[172:175], v[124:127]
buffer_load_dwordx4 v1, s[4:7], s8 offen offset:2048 sc1 lds
v_mfma_f32_16x16x32_bf16 v[124:127], a[148:151], a[168:171], v[124:127]
buffer_load_dwordx4 v1, s[4:7], s8 offen offset:3072 sc1 lds
v_mfma_f32_16x16x32_bf16 v[124:127], a[152:155], a[164:167], v[124:127]
s_add_u32 s8, s8, 4096
v_mov_b32 v136, 0
v_mov_b32 v137, 0
v_mfma_f32_16x16x32_bf16 v[124:127], a[156:159], a[160:163], v[124:127]
s_add_u32 m0, s84, 4096
v_mov_b32 v138, 0
v_mov_b32 v139, 0
v_mfma_f32_16x16x32_bf16 v[96:99], a[64:67], a[96:99], v[96:99]
ds_read_b64_tr_b16 a[128:129], v16 offset:200
v_mov_b32 v140, 0
v_mfma_f32_16x16x32_bf16 v[100:103], a[64:67], a[100:103], v[100:103]
ds_read_b64_tr_b16 a[130:131], v16 offset:192
v_mov_b32 v141, 0
v_mfma_f32_16x16x32_bf16 v[100:103], a[68:71], a[96:99], v[100:103]
ds_read_b128 a[160:163], v17 offset:256
v_mov_b32 v142, 0
v_mfma_f32_16x16x32_bf16 v[104:107], a[64:67], a[104:107], v[104:107]
buffer_load_dwordx4 v1, s[4:7], s8 offen offset:0 sc1 lds
v_mfma_f32_16x16x32_bf16 v[104:107], a[68:71], a[100:103], v[104:107]
ds_read_b64_tr_b16 a[132:133], v16 offset:712
v_mov_b32 v143, 0
v_mfma_f32_16x16x32_bf16 v[104:107], a[72:75], a[96:99], v[104:107]
ds_read_b64_tr_b16 a[134:135], v16 offset:704
v_mov_b32 v144, 0
v_mfma_f32_16x16x32_bf16 v[108:111], a[64:67], a[108:111], v[108:111]
ds_read_b128 a[164:167], v17 offset:768
v_mov_b32 v145, 0
v_mfma_f32_16x16x32_bf16 v[108:111], a[68:71], a[104:107], v[108:111]
buffer_load_dwordx4 v1, s[4:7], s8 offen offset:1024 sc1 lds
v_mfma_f32_16x16x32_bf16 v[108:111], a[72:75], a[100:103], v[108:111]
ds_read_b64_tr_b16 a[136:137], v16 offset:1224
v_mov_b32 v146, 0
v_mfma_f32_16x16x32_bf16 v[108:111], a[76:79], a[96:99], v[108:111]
s_waitcnt lgkmcnt(15)
ds_read_b64_tr_b16 a[138:139], v16 offset:1216
v_mov_b32 v147, 0
v_mfma_f32_16x16x32_bf16 v[112:115], a[64:67], a[112:115], v[112:115]
ds_read_b128 a[168:171], v17 offset:1280
v_mov_b32 v148, 0
v_mfma_f32_16x16x32_bf16 v[112:115], a[68:71], a[108:111], v[112:115]
buffer_load_dwordx4 v1, s[4:7], s8 offen offset:2048 sc1 lds
v_mfma_f32_16x16x32_bf16 v[112:115], a[72:75], a[104:107], v[112:115]
ds_read_b64_tr_b16 a[140:141], v16 offset:1736
v_mov_b32 v149, 0
v_mfma_f32_16x16x32_bf16 v[112:115], a[76:79], a[100:103], v[112:115]
ds_read_b64_tr_b16 a[142:143], v16 offset:1728
v_mov_b32 v150, 0
v_mfma_f32_16x16x32_bf16 v[112:115], a[80:83], a[96:99], v[112:115]
s_waitcnt lgkmcnt(15)
ds_read_b128 a[172:175], v17 offset:1792
v_mov_b32 v151, 0
v_mfma_f32_16x16x32_bf16 v[116:119], a[64:67], a[116:119], v[116:119]
s_waitcnt lgkmcnt(15)
buffer_load_dwordx4 v1, s[4:7], s8 offen offset:3072 sc1 lds
v_mfma_f32_16x16x32_bf16 v[116:119], a[68:71], a[112:115], v[116:119]
s_add_u32 s8, s8, 28672
ds_read_b64_tr_b16 a[144:145], v16 offset:2248
v_mov_b32 v152, 0
v_mfma_f32_16x16x32_bf16 v[116:119], a[72:75], a[108:111], v[116:119]
s_sub_u32 s9, s9, 1
ds_read_b64_tr_b16 a[146:147], v16 offset:2240
v_mov_b32 v153, 0
v_mfma_f32_16x16x32_bf16 v[116:119], a[76:79], a[104:107], v[116:119]
s_cmp_eq_u32 s9, 0
ds_read_b128 a[176:179], v17 offset:2304
v_mov_b32 v154, 0
v_mfma_f32_16x16x32_bf16 v[116:119], a[80:83], a[100:103], v[116:119]
s_cselect_b32 s8, s10, s8
v_mov_b32 v155, 0
v_mov_b32 v156, 0
v_mfma_f32_16x16x32_bf16 v[116:119], a[84:87], a[96:99], v[116:119]
s_cselect_b32 s9, s11, s9
ds_read_b64_tr_b16 a[148:149], v16 offset:2760
v_mov_b32 v157, 0
v_mfma_f32_16x16x32_bf16 v[120:123], a[64:67], a[120:123], v[120:123]
s_cselect_b32 s10, 3221225472, s10
ds_read_b64_tr_b16 a[150:151], v16 offset:2752
v_mov_b32 v158, 0
v_mfma_f32_16x16x32_bf16 v[120:123], a[68:71], a[116:119], v[120:123]
s_mov_b32 m0, s85
ds_read_b128 a[180:183], v17 offset:2816
v_mov_b32 v159, 0
v_mfma_f32_16x16x32_bf16 v[120:123], a[72:75], a[112:115], v[120:123]
buffer_load_dwordx4 v1, s[4:7], s8 offen offset:0 sc1 lds
v_mfma_f32_16x16x32_bf16 v[120:123], a[76:79], a[108:111], v[120:123]
ds_read_b64_tr_b16 a[152:153], v16 offset:3272
v_mov_b32 v160, 0
v_mfma_f32_16x16x32_bf16 v[120:123], a[80:83], a[104:107], v[120:123]
ds_read_b64_tr_b16 a[154:155], v16 offset:3264
v_mov_b32 v161, 0
v_mfma_f32_16x16x32_bf16 v[120:123], a[84:87], a[100:103], v[120:123]
ds_read_b128 a[184:187], v17 offset:3328
v_mov_b32 v162, 0
v_mfma_f32_16x16x32_bf16 v[120:123], a[88:91], a[96:99], v[120:123]
s_waitcnt lgkmcnt(15)
buffer_load_dwordx4 v1, s[4:7], s8 offen offset:1024 sc1 lds
v_mfma_f32_16x16x32_bf16 v[124:127], a[64:67], a[124:127], v[124:127]
ds_read_b64_tr_b16 a[156:157], v16 offset:3784
v_mov_b32 v163, 0
v_mfma_f32_16x16x32_bf16 v[124:127], a[68:71], a[120:123], v[124:127]
ds_read_b64_tr_b16 a[158:159], v16 offset:3776
v_mov_b32 v164, 0
v_mfma_f32_16x16x32_bf16 v[124:127], a[72:75], a[116:119], v[124:127]
ds_read_b128 a[188:191], v17 offset:3840
v_mov_b32 v165, 0
v_mfma_f32_16x16x32_bf16 v[124:127], a[76:79], a[112:115], v[124:127]
buffer_load_dwordx4 v1, s[4:7], s8 offen offset:2048 sc1 lds
v_mfma_f32_16x16x32_bf16 v[124:127], a[80:83], a[108:111], v[124:127]
buffer_load_dwordx4 v1, s[4:7], s8 offen offset:3072 sc1 lds
v_mfma_f32_16x16x32_bf16 v[124:127], a[84:87], a[104:107], v[124:127]
s_add_u32 s8, s8, 4096
v_mov_b32 v166, 0
v_mov_b32 v167, 0
v_mfma_f32_16x16x32_bf16 v[124:127], a[88:91], a[100:103], v[124:127]
s_add_u32 m0, s85, 4096
v_mov_b32 v168, 0
v_mov_b32 v169, 0
v_mfma_f32_16x16x32_bf16 v[124:127], a[92:95], a[96:99], v[124:127]
buffer_load_dwordx4 v1, s[4:7], s8 offen offset:0 sc1 lds
v_mfma_f32_16x16x32_bf16 v[96:99], a[128:131], a[160:163], v[96:99]
ds_read_b64_tr_b16 a[64:65], v16 offset:264
v_mov_b32 v170, 0
v_mfma_f32_16x16x32_bf16 v[100:103], a[128:131], a[164:167], v[100:103]
ds_read_b64_tr_b16 a[66:67], v16 offset:256
v_mov_b32 v171, 0
v_mfma_f32_16x16x32_bf16 v[100:103], a[132:135], a[160:163], v[100:103]
s_waitcnt lgkmcnt(15)
ds_read_b128 a[96:99], v17 offset:192
v_mov_b32 v172, 0
v_mfma_f32_16x16x32_bf16 v[104:107], a[128:131], a[168:171], v[104:107]
buffer_load_dwordx4 v1, s[4:7], s8 offen offset:1024 sc1 lds
v_mfma_f32_16x16x32_bf16 v[104:107], a[132:135], a[164:167], v[104:107]
ds_read_b64_tr_b16 a[68:69], v16 offset:776
v_mov_b32 v173, 0
v_mfma_f32_16x16x32_bf16 v[104:107], a[136:139], a[160:163], v[104:107]
s_waitcnt lgkmcnt(15)
ds_read_b64_tr_b16 a[70:71], v16 offset:768
v_mov_b32 v174, 0
v_mfma_f32_16x16x32_bf16 v[108:111], a[128:131], a[172:175], v[108:111]
ds_read_b128 a[100:103], v17 offset:704
v_mov_b32 v175, 0
v_mfma_f32_16x16x32_bf16 v[108:111], a[132:135], a[168:171], v[108:111]
buffer_load_dwordx4 v1, s[4:7], s8 offen offset:2048 sc1 lds
v_mfma_f32_16x16x32_bf16 v[108:111], a[136:139], a[164:167], v[108:111]
ds_read_b64_tr_b16 a[72:73], v16 offset:1288
v_mov_b32 v176, 0
v_mfma_f32_16x16x32_bf16 v[108:111], a[140:143], a[160:163], v[108:111]
s_waitcnt lgkmcnt(15)
ds_read_b64_tr_b16 a[74:75], v16 offset:1280
v_mov_b32 v177, 0
v_mfma_f32_16x16x32_bf16 v[112:115], a[128:131], a[176:179], v[112:115]
ds_read_b128 a[104:107], v17 offset:1216
v_mov_b32 v178, 0
v_mfma_f32_16x16x32_bf16 v[112:115], a[132:135], a[172:175], v[112:115]
s_waitcnt lgkmcnt(15)
buffer_load_dwordx4 v1, s[4:7], s8 offen offset:3072 sc1 lds
v_mfma_f32_16x16x32_bf16 v[112:115], a[136:139], a[168:171], v[112:115]
s_add_u32 s8, s8, 28672
ds_read_b64_tr_b16 a[76:77], v16 offset:1800
v_mov_b32 v179, 0
v_mfma_f32_16x16x32_bf16 v[112:115], a[140:143], a[164:167], v[112:115]
s_sub_u32 s9, s9, 1
ds_read_b64_tr_b16 a[78:79], v16 offset:1792
v_mov_b32 v180, 0
v_mfma_f32_16x16x32_bf16 v[112:115], a[144:147], a[160:163], v[112:115]
s_cmp_eq_u32 s9, 0
ds_read_b128 a[108:111], v17 offset:1728
v_mov_b32 v181, 0
v_mfma_f32_16x16x32_bf16 v[116:119], a[128:131], a[180:183], v[116:119]
s_cselect_b32 s8, s10, s8
buffer_load_dword v14, v15, s[4:7], s70 offen sc1
v_mfma_f32_16x16x32_bf16 v[116:119], a[132:135], a[176:179], v[116:119]
s_cselect_b32 s9, s11, s9
ds_read_b64_tr_b16 a[80:81], v16 offset:2312
v_mov_b32 v182, 0
v_mfma_f32_16x16x32_bf16 v[116:119], a[136:139], a[172:175], v[116:119]
s_cselect_b32 s10, 3221225472, s10
ds_read_b64_tr_b16 a[82:83], v16 offset:2304
v_mov_b32 v183, 0
v_mfma_f32_16x16x32_bf16 v[116:119], a[140:143], a[168:171], v[116:119]
ds_read_b128 a[112:115], v17 offset:2240
v_mov_b32 v184, 0
v_mfma_f32_16x16x32_bf16 v[116:119], a[144:147], a[164:167], v[116:119]
v_mov_b32 v185, 0
v_mov_b32 v186, 0
v_mfma_f32_16x16x32_bf16 v[116:119], a[148:151], a[160:163], v[116:119]
s_waitcnt lgkmcnt(15)
ds_read_b64_tr_b16 a[84:85], v16 offset:2824
v_mov_b32 v187, 0
v_mfma_f32_16x16x32_bf16 v[120:123], a[128:131], a[184:187], v[120:123]
ds_read_b64_tr_b16 a[86:87], v16 offset:2816
v_mov_b32 v188, 0
v_mfma_f32_16x16x32_bf16 v[120:123], a[132:135], a[180:183], v[120:123]
ds_read_b128 a[116:119], v17 offset:2752
v_mov_b32 v189, 0
v_mfma_f32_16x16x32_bf16 v[120:123], a[136:139], a[176:179], v[120:123]
v_mov_b32 v190, 0
v_mov_b32 v191, 0
v_mfma_f32_16x16x32_bf16 v[120:123], a[140:143], a[172:175], v[120:123]
ds_read_b64_tr_b16 a[88:89], v16 offset:3336
v_mov_b32 v192, 0
v_mfma_f32_16x16x32_bf16 v[120:123], a[144:147], a[168:171], v[120:123]
ds_read_b64_tr_b16 a[90:91], v16 offset:3328
v_mov_b32 v193, 0
v_mfma_f32_16x16x32_bf16 v[120:123], a[148:151], a[164:167], v[120:123]
ds_read_b128 a[120:123], v17 offset:3264
v_mov_b32 v194, 0
v_mfma_f32_16x16x32_bf16 v[120:123], a[152:155], a[160:163], v[120:123]
v_mov_b32 v195, 0
v_mov_b32 v196, 0
v_mfma_f32_16x16x32_bf16 v[124:127], a[128:131], a[188:191], v[124:127]
ds_read_b64_tr_b16 a[92:93], v16 offset:3848
v_mov_b32 v197, 0
v_mfma_f32_16x16x32_bf16 v[124:127], a[132:135], a[184:187], v[124:127]
ds_read_b64_tr_b16 a[94:95], v16 offset:3840
v_mov_b32 v198, 0
v_mfma_f32_16x16x32_bf16 v[124:127], a[136:139], a[180:183], v[124:127]
ds_read_b128 a[124:127], v17 offset:3776
v_mov_b32 v199, 0
v_mfma_f32_16x16x32_bf16 v[124:127], a[140:143], a[176:179], v[124:127]
v_mov_b32 v200, 0
v_mov_b32 v201, 0
v_mfma_f32_16x16x32_bf16 v[124:127], a[144:147], a[172:175], v[124:127]
v_mov_b32 v202, 0
v_mov_b32 v203, 0
v_mfma_f32_16x16x32_bf16 v[124:127], a[148:151], a[168:171], v[124:127]
v_mov_b32 v204, 0
v_mov_b32 v205, 0
v_mfma_f32_16x16x32_bf16 v[124:127], a[152:155], a[164:167], v[124:127]
v_mov_b32 v206, 0
v_mov_b32 v207, 0
v_mfma_f32_16x16x32_bf16 v[124:127], a[156:159], a[160:163], v[124:127]
s_waitcnt lgkmcnt(15)
v_mov_b32 v208, 0
v_mov_b32 v209, 0
s_waitcnt vmcnt(0)
v_cmp_gt_u32 vcc, 1, v14
s_cbranch_vccnz M_cspin
M_cok:
v_mfma_f32_16x16x32_bf16 v[96:99], a[64:67], a[96:99], v[96:99]
s_add_u32 s22, s78, 0
ds_read_b64_tr_b16 a[128:129], v16 offset:328
v_mov_b32 v210, 0
v_mfma_f32_16x16x32_bf16 v[100:103], a[64:67], a[100:103], v[100:103]
ds_read_b64_tr_b16 a[130:131], v16 offset:320
v_mov_b32 v211, 0
v_mfma_f32_16x16x32_bf16 v[100:103], a[68:71], a[96:99], v[100:103]
ds_read_b128 a[160:163], v17 offset:128
v_mov_b32 v212, 0
v_mfma_f32_16x16x32_bf16 v[104:107], a[64:67], a[104:107], v[104:107]
buffer_load_dwordx4 a[0:3], v1, s[4:7], s22 offen offset:0 sc1
v_mfma_f32_16x16x32_bf16 v[104:107], a[68:71], a[100:103], v[104:107]
ds_read_b64_tr_b16 a[132:133], v16 offset:840
v_mov_b32 v213, 0
v_mfma_f32_16x16x32_bf16 v[104:107], a[72:75], a[96:99], v[104:107]
s_waitcnt lgkmcnt(15)
ds_read_b64_tr_b16 a[134:135], v16 offset:832
v_mov_b32 v214, 0
v_mfma_f32_16x16x32_bf16 v[108:111], a[64:67], a[108:111], v[108:111]
ds_read_b128 a[164:167], v17 offset:640
v_mov_b32 v215, 0
v_mfma_f32_16x16x32_bf16 v[108:111], a[68:71], a[104:107], v[108:111]
buffer_load_dwordx4 a[4:7], v1, s[4:7], s22 offen offset:1024 sc1
v_mfma_f32_16x16x32_bf16 v[108:111], a[72:75], a[100:103], v[108:111]
ds_read_b64_tr_b16 a[136:137], v16 offset:1352
v_mov_b32 v216, 0
v_mfma_f32_16x16x32_bf16 v[108:111], a[76:79], a[96:99], v[108:111]
s_waitcnt lgkmcnt(15)
ds_read_b64_tr_b16 a[138:139], v16 offset:1344
v_mov_b32 v217, 0
v_mfma_f32_16x16x32_bf16 v[112:115], a[64:67], a[112:115], v[112:115]
ds_read_b128 a[168:171], v17 offset:1152
v_mov_b32 v218, 0
v_mfma_f32_16x16x32_bf16 v[112:115], a[68:71], a[108:111], v[112:115]
buffer_load_dwordx4 a[8:11], v1, s[4:7], s22 offen offset:2048 sc1
v_mfma_f32_16x16x32_bf16 v[112:115], a[72:75], a[104:107], v[112:115]
ds_read_b64_tr_b16 a[140:141], v16 offset:1864
v_mov_b32 v219, 0
v_mfma_f32_16x16x32_bf16 v[112:115], a[76:79], a[100:103], v[112:115]
ds_read_b64_tr_b16 a[142:143], v16 offset:1856
v_mov_b32 v220, 0
v_mfma_f32_16x16x32_bf16 v[112:115], a[80:83], a[96:99], v[112:115]
s_waitcnt lgkmcnt(15)
ds_read_b128 a[172:175], v17 offset:1664
v_mov_b32 v221, 0
v_mfma_f32_16x16x32_bf16 v[116:119], a[64:67], a[116:119], v[116:119]
buffer_load_dwordx4 a[12:15], v1, s[4:7], s22 offen offset:3072 sc1
v_mfma_f32_16x16x32_bf16 v[116:119], a[68:71], a[112:115], v[116:119]
s_add_u32 s22, s78, 4096
ds_read_b64_tr_b16 a[144:145], v16 offset:2376
v_mov_b32 v222, 0
v_mfma_f32_16x16x32_bf16 v[116:119], a[72:75], a[108:111], v[116:119]
ds_read_b64_tr_b16 a[146:147], v16 offset:2368
v_mov_b32 v223, 0
v_mfma_f32_16x16x32_bf16 v[116:119], a[76:79], a[104:107], v[116:119]
ds_read_b128 a[176:179], v17 offset:2176
v_mov_b32 v224, 0
v_mfma_f32_16x16x32_bf16 v[116:119], a[80:83], a[100:103], v[116:119]
buffer_load_dwordx4 a[16:19], v1, s[4:7], s22 offen offset:0 sc1
v_mfma_f32_16x16x32_bf16 v[116:119], a[84:87], a[96:99], v[116:119]
s_waitcnt lgkmcnt(15)
ds_read_b64_tr_b16 a[148:149], v16 offset:2888
v_mov_b32 v225, 0
v_mfma_f32_16x16x32_bf16 v[120:123], a[64:67], a[120:123], v[120:123]
ds_read_b64_tr_b16 a[150:151], v16 offset:2880
v_mov_b32 v226, 0
v_mfma_f32_16x16x32_bf16 v[120:123], a[68:71], a[116:119], v[120:123]
ds_read_b128 a[180:183], v17 offset:2688
v_mov_b32 v227, 0
v_mfma_f32_16x16x32_bf16 v[120:123], a[72:75], a[112:115], v[120:123]
buffer_load_dwordx4 a[20:23], v1, s[4:7], s22 offen offset:1024 sc1
v_mfma_f32_16x16x32_bf16 v[120:123], a[76:79], a[108:111], v[120:123]
ds_read_b64_tr_b16 a[152:153], v16 offset:3400
v_mov_b32 v228, 0
v_mfma_f32_16x16x32_bf16 v[120:123], a[80:83], a[104:107], v[120:123]
ds_read_b64_tr_b16 a[154:155], v16 offset:3392
v_mov_b32 v229, 0
v_mfma_f32_16x16x32_bf16 v[120:123], a[84:87], a[100:103], v[120:123]
ds_read_b128 a[184:187], v17 offset:3200
v_mov_b32 v230, 0
v_mfma_f32_16x16x32_bf16 v[120:123], a[88:91], a[96:99], v[120:123]
buffer_load_dwordx4 a[24:27], v1, s[4:7], s22 offen offset:2048 sc1
v_mfma_f32_16x16x32_bf16 v[124:127], a[64:67], a[124:127], v[124:127]
ds_read_b64_tr_b16 a[156:157], v16 offset:3912
v_mov_b32 v231, 0
v_mfma_f32_16x16x32_bf16 v[124:127], a[68:71], a[120:123], v[124:127]
ds_read_b64_tr_b16 a[158:159], v16 offset:3904
v_mov_b32 v232, 0
v_mfma_f32_16x16x32_bf16 v[124:127], a[72:75], a[116:119], v[124:127]
ds_read_b128 a[188:191], v17 offset:3712
v_mov_b32 v233, 0
v_mfma_f32_16x16x32_bf16 v[124:127], a[76:79], a[112:115], v[124:127]
buffer_load_dwordx4 a[28:31], v1, s[4:7], s22 offen offset:3072 sc1
v_mfma_f32_16x16x32_bf16 v[124:127], a[80:83], a[108:111], v[124:127]
s_add_u32 s22, s78, 32768
buffer_load_dwordx4 a[32:35], v1, s[4:7], s22 offen offset:0 sc1
v_mfma_f32_16x16x32_bf16 v[124:127], a[84:87], a[104:107], v[124:127]
buffer_load_dwordx4 a[36:39], v1, s[4:7], s22 offen offset:1024 sc1
v_mfma_f32_16x16x32_bf16 v[124:127], a[88:91], a[100:103], v[124:127]
buffer_load_dwordx4 a[40:43], v1, s[4:7], s22 offen offset:2048 sc1
v_mfma_f32_16x16x32_bf16 v[124:127], a[92:95], a[96:99], v[124:127]
s_waitcnt lgkmcnt(15)
buffer_load_dwordx4 a[44:47], v1, s[4:7], s22 offen offset:3072 sc1
v_mfma_f32_16x16x32_bf16 v[96:99], a[128:131], a[160:163], v[96:99]
s_add_u32 s22, s78, 36864
ds_read_b64_tr_b16 a[64:65], v16 offset:392
v_mov_b32 v234, 0
v_mfma_f32_16x16x32_bf16 v[100:103], a[128:131], a[164:167], v[100:103]
ds_read_b64_tr_b16 a[66:67], v16 offset:384
v_mov_b32 v235, 0
v_mfma_f32_16x16x32_bf16 v[100:103], a[132:135], a[160:163], v[100:103]
ds_read_b128 a[96:99], v17 offset:64
v_mov_b32 v236, 0
v_mfma_f32_16x16x32_bf16 v[104:107], a[128:131], a[168:171], v[104:107]
ds_read_b64 v[36:37], v18 offset:0
v_mov_b32 v237, 0
v_mfma_f32_16x16x32_bf16 v[104:107], a[132:135], a[164:167], v[104:107]
ds_read_b64_tr_b16 a[68:69], v16 offset:904
v_mov_b32 v238, 0
v_mfma_f32_16x16x32_bf16 v[104:107], a[136:139], a[160:163], v[104:107]
s_waitcnt lgkmcnt(15)
ds_read_b64_tr_b16 a[70:71], v16 offset:896
v_mov_b32 v239, 0
v_mfma_f32_16x16x32_bf16 v[108:111], a[128:131], a[172:175], v[108:111]
ds_read_b128 a[100:103], v17 offset:576
v_mov_b32 v240, 0
v_mfma_f32_16x16x32_bf16 v[108:111], a[132:135], a[168:171], v[108:111]
ds_read_b64 v[38:39], v18 offset:512
v_mov_b32 v241, 0
v_mfma_f32_16x16x32_bf16 v[108:111], a[136:139], a[164:167], v[108:111]
ds_read_b64_tr_b16 a[72:73], v16 offset:1416
v_mov_b32 v242, 0
v_mfma_f32_16x16x32_bf16 v[108:111], a[140:143], a[160:163], v[108:111]
s_waitcnt lgkmcnt(15)
ds_read_b64_tr_b16 a[74:75], v16 offset:1408
v_mov_b32 v243, 0
v_mfma_f32_16x16x32_bf16 v[112:115], a[128:131], a[176:179], v[112:115]
ds_read_b128 a[104:107], v17 offset:1088
v_mov_b32 v244, 0
v_mfma_f32_16x16x32_bf16 v[112:115], a[132:135], a[172:175], v[112:115]
ds_read_b64 v[44:45], v18 offset:1024
v_mov_b32 v245, 0
v_mfma_f32_16x16x32_bf16 v[112:115], a[136:139], a[168:171], v[112:115]
ds_read_b64_tr_b16 a[76:77], v16 offset:1928
v_mov_b32 v246, 0
v_mfma_f32_16x16x32_bf16 v[112:115], a[140:143], a[164:167], v[112:115]
ds_read_b64_tr_b16 a[78:79], v16 offset:1920
v_mov_b32 v247, 0
v_mfma_f32_16x16x32_bf16 v[112:115], a[144:147], a[160:163], v[112:115]
ds_read_b128 a[108:111], v17 offset:1600
v_mov_b32 v248, 0
v_mfma_f32_16x16x32_bf16 v[116:119], a[128:131], a[180:183], v[116:119]
ds_read_b64 v[46:47], v18 offset:1536
v_mov_b32 v249, 0
v_mfma_f32_16x16x32_bf16 v[116:119], a[132:135], a[176:179], v[116:119]
ds_read_b64_tr_b16 a[80:81], v16 offset:2440
v_mov_b32 v250, 0
v_mfma_f32_16x16x32_bf16 v[116:119], a[136:139], a[172:175], v[116:119]
ds_read_b64_tr_b16 a[82:83], v16 offset:2432
v_mov_b32 v251, 0
v_mfma_f32_16x16x32_bf16 v[116:119], a[140:143], a[168:171], v[116:119]
ds_read_b128 a[112:115], v17 offset:2112
v_mov_b32 v252, 0
v_mfma_f32_16x16x32_bf16 v[116:119], a[144:147], a[164:167], v[116:119]
ds_read_b64 v[52:53], v18 offset:2048
v_mov_b32 v253, 0
v_mfma_f32_16x16x32_bf16 v[116:119], a[148:151], a[160:163], v[116:119]
s_waitcnt lgkmcnt(15)
ds_read_b64_tr_b16 a[84:85], v16 offset:2952
v_mov_b32 v254, 0
v_mfma_f32_16x16x32_bf16 v[120:123], a[128:131], a[184:187], v[120:123]
ds_read_b64_tr_b16 a[86:87], v16 offset:2944
v_mov_b32 v255, 0
v_mfma_f32_16x16x32_bf16 v[120:123], a[132:135], a[180:183], v[120:123]
ds_read_b128 a[116:119], v17 offset:2624
v_mfma_f32_16x16x32_bf16 v[120:123], a[136:139], a[176:179], v[120:123]
ds_read_b64 v[54:55], v18 offset:2560
v_mfma_f32_16x16x32_bf16 v[120:123], a[140:143], a[172:175], v[120:123]
ds_read_b64_tr_b16 a[88:89], v16 offset:3464
v_mfma_f32_16x16x32_bf16 v[120:123], a[144:147], a[168:171], v[120:123]
ds_read_b64_tr_b16 a[90:91], v16 offset:3456
v_mfma_f32_16x16x32_bf16 v[120:123], a[148:151], a[164:167], v[120:123]
ds_read_b128 a[120:123], v17 offset:3136
v_mfma_f32_16x16x32_bf16 v[120:123], a[152:155], a[160:163], v[120:123]
ds_read_b64 v[60:61], v18 offset:3072
v_mfma_f32_16x16x32_bf16 v[124:127], a[128:131], a[188:191], v[124:127]
ds_read_b64_tr_b16 a[92:93], v16 offset:3976
v_mfma_f32_16x16x32_bf16 v[124:127], a[132:135], a[184:187], v[124:127]
ds_read_b64_tr_b16 a[94:95], v16 offset:3968
v_mfma_f32_16x16x32_bf16 v[124:127], a[136:139], a[180:183], v[124:127]
ds_read_b128 a[124:127], v17 offset:3648
v_mfma_f32_16x16x32_bf16 v[124:127], a[140:143], a[176:179], v[124:127]
ds_read_b64 v[62:63], v18 offset:3584
v_mfma_f32_16x16x32_bf16 v[124:127], a[144:147], a[172:175], v[124:127]
buffer_load_dwordx4 a[48:51], v1, s[4:7], s22 offen offset:0 sc1
v_mfma_f32_16x16x32_bf16 v[124:127], a[148:151], a[168:171], v[124:127]
buffer_load_dwordx4 a[52:55], v1, s[4:7], s22 offen offset:1024 sc1
v_mfma_f32_16x16x32_bf16 v[124:127], a[152:155], a[164:167], v[124:127]
buffer_load_dwordx4 a[56:59], v1, s[4:7], s22 offen offset:2048 sc1
v_mfma_f32_16x16x32_bf16 v[124:127], a[156:159], a[160:163], v[124:127]
buffer_load_dwordx4 a[60:63], v1, s[4:7], s22 offen offset:3072 sc1
v_mfma_f32_16x16x32_bf16 v[96:99], a[64:67], a[96:99], v[96:99]
s_waitcnt lgkmcnt(15)
ds_read_b64_tr_b16 a[128:129], v16 offset:456
v_mfma_f32_16x16x32_bf16 v[100:103], a[64:67], a[100:103], v[100:103]
ds_read_b64_tr_b16 a[130:131], v16 offset:448
v_mfma_f32_16x16x32_bf16 v[100:103], a[68:71], a[96:99], v[100:103]
ds_read_b128 a[160:163], v17 offset:0
v_mfma_f32_16x16x32_bf16 v[104:107], a[64:67], a[104:107], v[104:107]
v_mfma_f32_16x16x32_bf16 v[104:107], a[68:71], a[100:103], v[104:107]
ds_read_b64_tr_b16 a[132:133], v16 offset:968
v_mfma_f32_16x16x32_bf16 v[104:107], a[72:75], a[96:99], v[104:107]
ds_read_b64_tr_b16 a[134:135], v16 offset:960
v_mfma_f32_16x16x32_bf16 v[108:111], a[64:67], a[108:111], v[108:111]
ds_read_b128 a[164:167], v17 offset:512
v_mfma_f32_16x16x32_bf16 v[108:111], a[68:71], a[104:107], v[108:111]
v_mfma_f32_16x16x32_bf16 v[108:111], a[72:75], a[100:103], v[108:111]
ds_read_b64_tr_b16 a[136:137], v16 offset:1480
v_mfma_f32_16x16x32_bf16 v[108:111], a[76:79], a[96:99], v[108:111]
s_waitcnt lgkmcnt(15)
ds_read_b64_tr_b16 a[138:139], v16 offset:1472
v_mfma_f32_16x16x32_bf16 v[112:115], a[64:67], a[112:115], v[112:115]
ds_read_b128 a[168:171], v17 offset:1024
v_mfma_f32_16x16x32_bf16 v[112:115], a[68:71], a[108:111], v[112:115]
v_mfma_f32_16x16x32_bf16 v[112:115], a[72:75], a[104:107], v[112:115]
ds_read_b64_tr_b16 a[140:141], v16 offset:1992
v_mfma_f32_16x16x32_bf16 v[112:115], a[76:79], a[100:103], v[112:115]
ds_read_b64_tr_b16 a[142:143], v16 offset:1984
v_mfma_f32_16x16x32_bf16 v[112:115], a[80:83], a[96:99], v[112:115]
ds_read_b128 a[172:175], v17 offset:1536
v_mfma_f32_16x16x32_bf16 v[116:119], a[64:67], a[116:119], v[116:119]
v_mfma_f32_16x16x32_bf16 v[116:119], a[68:71], a[112:115], v[116:119]
ds_read_b64_tr_b16 a[144:145], v16 offset:2504
v_mfma_f32_16x16x32_bf16 v[116:119], a[72:75], a[108:111], v[116:119]
ds_read_b64_tr_b16 a[146:147], v16 offset:2496
v_mfma_f32_16x16x32_bf16 v[116:119], a[76:79], a[104:107], v[116:119]
ds_read_b128 a[176:179], v17 offset:2048
v_mfma_f32_16x16x32_bf16 v[116:119], a[80:83], a[100:103], v[116:119]
v_mfma_f32_16x16x32_bf16 v[116:119], a[84:87], a[96:99], v[116:119]
s_waitcnt lgkmcnt(15)
ds_read_b64_tr_b16 a[148:149], v16 offset:3016
v_mfma_f32_16x16x32_bf16 v[120:123], a[64:67], a[120:123], v[120:123]
ds_read_b64_tr_b16 a[150:151], v16 offset:3008
v_mfma_f32_16x16x32_bf16 v[120:123], a[68:71], a[116:119], v[120:123]
ds_read_b128 a[180:183], v17 offset:2560
v_mfma_f32_16x16x32_bf16 v[120:123], a[72:75], a[112:115], v[120:123]
v_mfma_f32_16x16x32_bf16 v[120:123], a[76:79], a[108:111], v[120:123]
ds_read_b64_tr_b16 a[152:153], v16 offset:3528
v_mfma_f32_16x16x32_bf16 v[120:123], a[80:83], a[104:107], v[120:123]
ds_read_b64_tr_b16 a[154:155], v16 offset:3520
v_mfma_f32_16x16x32_bf16 v[120:123], a[84:87], a[100:103], v[120:123]
ds_read_b128 a[184:187], v17 offset:3072
v_mfma_f32_16x16x32_bf16 v[120:123], a[88:91], a[96:99], v[120:123]
v_mfma_f32_16x16x32_bf16 v[124:127], a[64:67], a[124:127], v[124:127]
ds_read_b64_tr_b16 a[156:157], v16 offset:4040
v_mfma_f32_16x16x32_bf16 v[124:127], a[68:71], a[120:123], v[124:127]
ds_read_b64_tr_b16 a[158:159], v16 offset:4032
v_mfma_f32_16x16x32_bf16 v[124:127], a[72:75], a[116:119], v[124:127]
ds_read_b128 a[188:191], v17 offset:3584
v_mfma_f32_16x16x32_bf16 v[124:127], a[76:79], a[112:115], v[124:127]
v_mfma_f32_16x16x32_bf16 v[124:127], a[80:83], a[108:111], v[124:127]
v_mfma_f32_16x16x32_bf16 v[124:127], a[84:87], a[104:107], v[124:127]
v_mfma_f32_16x16x32_bf16 v[124:127], a[88:91], a[100:103], v[124:127]
v_mfma_f32_16x16x32_bf16 v[124:127], a[92:95], a[96:99], v[124:127]
s_waitcnt lgkmcnt(15)
v_mfma_f32_16x16x32_bf16 v[96:99], a[128:131], a[160:163], v[96:99]
v_mfma_f32_16x16x32_bf16 v[100:103], a[128:131], a[164:167], v[100:103]
v_mfma_f32_16x16x32_bf16 v[100:103], a[132:135], a[160:163], v[100:103]
v_mfma_f32_16x16x32_bf16 v[104:107], a[128:131], a[168:171], v[104:107]
v_mfma_f32_16x16x32_bf16 v[104:107], a[132:135], a[164:167], v[104:107]
v_mfma_f32_16x16x32_bf16 v[104:107], a[136:139], a[160:163], v[104:107]
s_waitcnt lgkmcnt(12)
v_mfma_f32_16x16x32_bf16 v[108:111], a[128:131], a[172:175], v[108:111]
v_mfma_f32_16x16x32_bf16 v[108:111], a[132:135], a[168:171], v[108:111]
v_mfma_f32_16x16x32_bf16 v[108:111], a[136:139], a[164:167], v[108:111]
v_lshlrev_b32 v10, 16, v36
v_fmac_f32 v96, v19, v10
v_mfma_f32_16x16x32_bf16 v[108:111], a[140:143], a[160:163], v[108:111]
s_waitcnt lgkmcnt(9)
v_and_b32 v11, 0xffff0000, v36
v_fmac_f32 v97, v19, v11
v_mfma_f32_16x16x32_bf16 v[112:115], a[128:131], a[176:179], v[112:115]
v_lshlrev_b32 v12, 16, v37
v_fmac_f32 v98, v19, v12
v_mfma_f32_16x16x32_bf16 v[112:115], a[132:135], a[172:175], v[112:115]
v_and_b32 v13, 0xffff0000, v37
v_fmac_f32 v99, v19, v13
v_mfma_f32_16x16x32_bf16 v[112:115], a[136:139], a[168:171], v[112:115]
v_cvt_pk_bf16_f32 v96, v96, v97
v_cvt_pk_bf16_f32 v97, v98, v99
v_mfma_f32_16x16x32_bf16 v[112:115], a[140:143], a[164:167], v[112:115]
buffer_store_dwordx2 v[96:97], v8, s[4:7], s83 offen offset:0 sc1
v_mfma_f32_16x16x32_bf16 v[112:115], a[144:147], a[160:163], v[112:115]
s_waitcnt lgkmcnt(6)
v_lshlrev_b32 v10, 16, v38
v_fmac_f32 v100, v19, v10
v_mfma_f32_16x16x32_bf16 v[116:119], a[128:131], a[180:183], v[116:119]
v_and_b32 v11, 0xffff0000, v38
v_fmac_f32 v101, v19, v11
v_mfma_f32_16x16x32_bf16 v[116:119], a[132:135], a[176:179], v[116:119]
v_lshlrev_b32 v12, 16, v39
v_fmac_f32 v102, v19, v12
v_mfma_f32_16x16x32_bf16 v[116:119], a[136:139], a[172:175], v[116:119]
v_and_b32 v13, 0xffff0000, v39
v_fmac_f32 v103, v19, v13
v_mfma_f32_16x16x32_bf16 v[116:119], a[140:143], a[168:171], v[116:119]
v_cvt_pk_bf16_f32 v100, v100, v101
v_cvt_pk_bf16_f32 v101, v102, v103
v_mfma_f32_16x16x32_bf16 v[116:119], a[144:147], a[164:167], v[116:119]
buffer_store_dwordx2 v[100:101], v8, s[4:7], s83 offen offset:512 sc1
v_mfma_f32_16x16x32_bf16 v[116:119], a[148:151], a[160:163], v[116:119]
s_waitcnt lgkmcnt(3)
v_lshlrev_b32 v10, 16, v44
v_fmac_f32 v104, v19, v10
v_mfma_f32_16x16x32_bf16 v[120:123], a[128:131], a[184:187], v[120:123]
v_and_b32 v11, 0xffff0000, v44
v_fmac_f32 v105, v19, v11
v_mfma_f32_16x16x32_bf16 v[120:123], a[132:135], a[180:183], v[120:123]
v_lshlrev_b32 v12, 16, v45
v_fmac_f32 v106, v19, v12
v_mfma_f32_16x16x32_bf16 v[120:123], a[136:139], a[176:179], v[120:123]
v_and_b32 v13, 0xffff0000, v45
v_fmac_f32 v107, v19, v13
v_mfma_f32_16x16x32_bf16 v[120:123], a[140:143], a[172:175], v[120:123]
v_cvt_pk_bf16_f32 v104, v104, v105
v_cvt_pk_bf16_f32 v105, v106, v107
v_mfma_f32_16x16x32_bf16 v[120:123], a[144:147], a[168:171], v[120:123]
buffer_store_dwordx2 v[104:105], v8, s[4:7], s83 offen offset:1024 sc1
v_mfma_f32_16x16x32_bf16 v[120:123], a[148:151], a[164:167], v[120:123]
v_lshlrev_b32 v10, 16, v46
v_fmac_f32 v108, v19, v10
v_mfma_f32_16x16x32_bf16 v[120:123], a[152:155], a[160:163], v[120:123]
s_waitcnt lgkmcnt(0)
v_and_b32 v11, 0xffff0000, v46
v_fmac_f32 v109, v19, v11
v_mfma_f32_16x16x32_bf16 v[124:127], a[128:131], a[188:191], v[124:127]
v_lshlrev_b32 v12, 16, v47
v_fmac_f32 v110, v19, v12
v_mfma_f32_16x16x32_bf16 v[124:127], a[132:135], a[184:187], v[124:127]
v_and_b32 v13, 0xffff0000, v47
v_fmac_f32 v111, v19, v13
v_mfma_f32_16x16x32_bf16 v[124:127], a[136:139], a[180:183], v[124:127]
v_cvt_pk_bf16_f32 v108, v108, v109
v_cvt_pk_bf16_f32 v109, v110, v111
v_mfma_f32_16x16x32_bf16 v[124:127], a[140:143], a[176:179], v[124:127]
buffer_store_dwordx2 v[108:109], v8, s[4:7], s83 offen offset:1536 sc1
v_mfma_f32_16x16x32_bf16 v[124:127], a[144:147], a[172:175], v[124:127]
v_lshlrev_b32 v10, 16, v52
v_fmac_f32 v112, v19, v10
v_mfma_f32_16x16x32_bf16 v[124:127], a[148:151], a[168:171], v[124:127]
v_and_b32 v11, 0xffff0000, v52
v_fmac_f32 v113, v19, v11
v_mfma_f32_16x16x32_bf16 v[124:127], a[152:155], a[164:167], v[124:127]
v_lshlrev_b32 v12, 16, v53
v_fmac_f32 v114, v19, v12
v_mfma_f32_16x16x32_bf16 v[124:127], a[156:159], a[160:163], v[124:127]
v_and_b32 v13, 0xffff0000, v53
v_fmac_f32 v115, v19, v13
v_cvt_pk_bf16_f32 v112, v112, v113
v_cvt_pk_bf16_f32 v113, v114, v115
buffer_store_dwordx2 v[112:113], v8, s[4:7], s83 offen offset:2048 sc1
v_lshlrev_b32 v10, 16, v54
v_fmac_f32 v116, v19, v10
v_and_b32 v11, 0xffff0000, v54
v_fmac_f32 v117, v19, v11
v_lshlrev_b32 v12, 16, v55
v_fmac_f32 v118, v19, v12
v_and_b32 v13, 0xffff0000, v55
v_fmac_f32 v119, v19, v13
v_cvt_pk_bf16_f32 v116, v116, v117
v_cvt_pk_bf16_f32 v117, v118, v119
buffer_store_dwordx2 v[116:117], v8, s[4:7], s83 offen offset:2560 sc1
v_lshlrev_b32 v10, 16, v60
v_fmac_f32 v120, v19, v10
v_and_b32 v11, 0xffff0000, v60
v_fmac_f32 v121, v19, v11
v_lshlrev_b32 v12, 16, v61
v_fmac_f32 v122, v19, v12
v_and_b32 v13, 0xffff0000, v61
v_fmac_f32 v123, v19, v13
v_cvt_pk_bf16_f32 v120, v120, v121
v_cvt_pk_bf16_f32 v121, v122, v123
buffer_store_dwordx2 v[120:121], v8, s[4:7], s83 offen offset:3072 sc1
v_lshlrev_b32 v10, 16, v62
v_fmac_f32 v124, v19, v10
v_and_b32 v11, 0xffff0000, v62
v_fmac_f32 v125, v19, v11
v_lshlrev_b32 v12, 16, v63
v_fmac_f32 v126, v19, v12
v_and_b32 v13, 0xffff0000, v63
v_fmac_f32 v127, v19, v13
v_cvt_pk_bf16_f32 v124, v124, v125
v_cvt_pk_bf16_f32 v125, v126, v127
buffer_store_dwordx2 v[124:125], v8, s[4:7], s83 offen offset:3584 sc1
v_lshrrev_b32 v8, 7, v1
v_and_b32 v9, 6, v8
v_lshlrev_b32 v9, 4, v9
v_and_b32 v10, 0x70, v1
v_xor_b32 v9, v9, v10
v_mul_u32_u24 v8, 896, v8
v_add_u32 v8, v8, v9
v_accvgpr_write_b32 a184, v8
v_add_u32 v8, 6144, v8
v_accvgpr_write_b32 a185, v8
v_add_u32 v8, 6144, v8
v_accvgpr_write_b32 a186, v8
v_add_u32 v8, 6144, v8
v_accvgpr_write_b32 a187, v8
v_lshrrev_b32 v8, 6, v1
v_bfe_u32 v9, v1, 7, 2
v_lshlrev_b32 v9, 5, v9
v_lshl_add_u32 v8, v8, 7, v9
v_bfe_u32 v9, v1, 4, 2
v_lshl_add_u32 v8, v9, 3, v8
v_add_u32 v8, 32768, v8
v_accvgpr_write_b32 a188, v8
v_xor_b32 v9, 32, v8
v_accvgpr_write_b32 a189, v9
v_xor_b32 v9, 64, v8
v_accvgpr_write_b32 a190, v9
v_xor_b32 v9, 96, v8
v_accvgpr_write_b32 a191, v9
s_waitcnt vmcnt(8)
s_barrier
s_cmp_lg_u32 s24, 0
s_cbranch_scc1 K2_item
v_accvgpr_mov_b32 a0, a192
v_accvgpr_mov_b32 a1, a193
v_accvgpr_mov_b32 a2, a194
v_accvgpr_mov_b32 a3, a195
v_accvgpr_mov_b32 a4, a196
v_accvgpr_mov_b32 a5, a197
v_accvgpr_mov_b32 a6, a198
v_accvgpr_mov_b32 a7, a199
v_accvgpr_mov_b32 a8, a200
v_accvgpr_mov_b32 a9, a201
v_accvgpr_mov_b32 a10, a202
v_accvgpr_mov_b32 a11, a203
v_accvgpr_mov_b32 a12, a204
v_accvgpr_mov_b32 a13, a205
v_accvgpr_mov_b32 a14, a206
v_accvgpr_mov_b32 a15, a207
v_accvgpr_mov_b32 a16, a208
v_accvgpr_mov_b32 a17, a209
v_accvgpr_mov_b32 a18, a210
v_accvgpr_mov_b32 a19, a211
v_accvgpr_mov_b32 a20, a212
v_accvgpr_mov_b32 a21, a213
v_accvgpr_mov_b32 a22, a214
v_accvgpr_mov_b32 a23, a215
v_accvgpr_mov_b32 a24, a216
v_accvgpr_mov_b32 a25, a217
v_accvgpr_mov_b32 a26, a218
v_accvgpr_mov_b32 a27, a219
v_accvgpr_mov_b32 a28, a220
v_accvgpr_mov_b32 a29, a221
v_accvgpr_mov_b32 a30, a222
v_accvgpr_mov_b32 a31, a223
v_accvgpr_mov_b32 a32, a224
v_accvgpr_mov_b32 a33, a225
v_accvgpr_mov_b32 a34, a226
v_accvgpr_mov_b32 a35, a227
v_accvgpr_mov_b32 a36, a228
v_accvgpr_mov_b32 a37, a229
v_accvgpr_mov_b32 a38, a230
v_accvgpr_mov_b32 a39, a231
v_accvgpr_mov_b32 a40, a232
v_accvgpr_mov_b32 a41, a233
v_accvgpr_mov_b32 a42, a234
v_accvgpr_mov_b32 a43, a235
v_accvgpr_mov_b32 a44, a236
v_accvgpr_mov_b32 a45, a237
v_accvgpr_mov_b32 a46, a238
v_accvgpr_mov_b32 a47, a239
v_accvgpr_mov_b32 a48, a240
v_accvgpr_mov_b32 a49, a241
v_accvgpr_mov_b32 a50, a242
v_accvgpr_mov_b32 a51, a243
v_accvgpr_mov_b32 a52, a244
v_accvgpr_mov_b32 a53, a245
v_accvgpr_mov_b32 a54, a246
v_accvgpr_mov_b32 a55, a247
v_accvgpr_mov_b32 a56, a248
v_accvgpr_mov_b32 a57, a249
v_accvgpr_mov_b32 a58, a250
v_accvgpr_mov_b32 a59, a251
v_accvgpr_mov_b32 a60, a252
v_accvgpr_mov_b32 a61, a253
v_accvgpr_mov_b32 a62, a254
v_accvgpr_mov_b32 a63, a255
s_branch K2_item
M_cspin:
Lp_17:
buffer_load_dword v14, v15, s[4:7], s70 offen sc1
s_waitcnt vmcnt(0)
v_cmp_gt_u32 vcc, 1, v14
s_cbranch_vccz Lpd_18
s_sleep 8
s_sub_u32 s101, s101, 1
s_cbranch_scc0 Lp_17
s_mov_b32 s101, 0
Lpd_18:
s_branch M_cok
M_kspin:
Lp_19:
buffer_load_dword v21, v20, s[4:7], s70 offen sc1
s_waitcnt vmcnt(0)
v_cmp_gt_u32 vcc, 1, v21
s_cbranch_vccz Lpd_20
s_sleep 8
s_sub_u32 s101, s101, 1
s_cbranch_scc0 Lp_19
s_mov_b32 s101, 0
Lpd_20:
s_branch M_kok
M_kspin2:
Lp_21:
buffer_load_dword v21, v20, s[4:7], s70 offen sc1
s_waitcnt vmcnt(0)
v_cmp_gt_u32 vcc, 1, v21
s_cbranch_vccz Lpd_22
s_sleep 8
s_sub_u32 s101, s101, 1
s_cbranch_scc0 Lp_21
s_mov_b32 s101, 0
Lpd_22:
s_branch M_kok2
M_vspin:
Lp_23:
buffer_load_dword v21, v15, s[4:7], s70 offen sc1
s_waitcnt vmcnt(0)
v_cmp_gt_u32 vcc, 1, v21
s_cbranch_vccz Lpd_24
s_sleep 8
s_sub_u32 s101, s101, 1
s_cbranch_scc0 Lp_23
s_mov_b32 s101, 0
Lpd_24:
s_branch M_vok
K2_plain:
v_mfma_f32_16x16x32_bf16 v[128:131], a[64:67], v[96:99], v[128:131]
s_waitcnt lgkmcnt(6)
ds_read_b128 a[96:99], v2 offset:8192
v_add_f32 v24, v24, v26
v_mfma_f32_16x16x32_bf16 v[128:131], a[68:71], v[100:103], v[128:131]
s_waitcnt lgkmcnt(5)
v_mfma_f32_16x16x32_bf16 v[132:135], a[68:71], v[108:111], v[132:135]
s_mov_b64 s[36:37], s[86:87]
ds_read_b128 a[100:103], v2 offset:9216
v_add_f32 v25, v25, v27
v_mfma_f32_16x16x32_bf16 v[132:135], a[64:67], v[104:107], v[132:135]
s_mov_b32 s38, 3670016
v_exp_f32 v8, v68
v_mfma_f32_16x16x32_bf16 v[136:139], a[72:75], v[96:99], v[136:139]
s_mov_b32 s39, 0x20000
ds_read_b128 a[104:107], v2 offset:10240
v_accvgpr_read_b32 v112, a184
v_mfma_f32_16x16x32_bf16 v[136:139], a[76:79], v[100:103], v[136:139]
v_accvgpr_read_b32 v113, a185
v_accvgpr_read_b32 v114, a186
v_mfma_f32_16x16x32_bf16 v[140:143], a[76:79], v[108:111], v[140:143]
ds_read_b128 a[108:111], v2 offset:11264
v_accvgpr_read_b32 v115, a187
v_mfma_f32_16x16x32_bf16 v[140:143], a[72:75], v[104:107], v[140:143]
s_waitcnt lgkmcnt(7)
v_accvgpr_read_b32 v116, a188
v_accvgpr_read_b32 v117, a189
v_mfma_f32_16x16x32_bf16 v[144:147], a[80:83], v[96:99], v[144:147]
s_waitcnt lgkmcnt(6)
ds_read_b128 a[112:115], v2 offset:12288
v_accvgpr_read_b32 v118, a190
v_mfma_f32_16x16x32_bf16 v[144:147], a[84:87], v[100:103], v[144:147]
v_accvgpr_read_b32 v119, a191
v_mfma_f32_16x16x32_bf16 v[148:151], a[84:87], v[108:111], v[148:151]
s_add_u32 m0, s18, 32768
ds_read_b128 a[116:119], v2 offset:13312
v_cvt_pk_bf16_f32 v128, v128, v129
v_mfma_f32_16x16x32_bf16 v[148:151], a[80:83], v[104:107], v[148:151]
s_waitcnt lgkmcnt(7)
buffer_load_dwordx4 v112, s[36:39], s81 offen offset:0 lds
v_mfma_f32_16x16x32_bf16 v[152:155], a[88:91], v[96:99], v[152:155]
s_waitcnt lgkmcnt(6)
ds_read_b128 a[120:123], v2 offset:14336
v_cvt_pk_bf16_f32 v129, v130, v131
v_mfma_f32_16x16x32_bf16 v[152:155], a[92:95], v[100:103], v[152:155]
v_exp_f32 v9, v69
v_mfma_f32_16x16x32_bf16 v[156:159], a[92:95], v[108:111], v[156:159]
ds_read_b128 a[124:127], v2 offset:15360
v_add_f32 v27, v8, v9
v_mfma_f32_16x16x32_bf16 v[156:159], a[88:91], v[104:107], v[156:159]
s_waitcnt lgkmcnt(7)
buffer_load_dwordx4 v113, s[36:39], s81 offen offset:1024 lds
v_mfma_f32_16x16x32_bf16 v[160:163], a[96:99], v[96:99], v[160:163]
s_waitcnt lgkmcnt(6)
ds_read_b128 a[64:67], v2 offset:16384
v_cvt_pk_bf16_f32 v120, v8, v9
v_mfma_f32_16x16x32_bf16 v[160:163], a[100:103], v[100:103], v[160:163]
v_exp_f32 v10, v70
v_mfma_f32_16x16x32_bf16 v[164:167], a[100:103], v[108:111], v[164:167]
ds_read_b128 a[68:71], v2 offset:17408
v_add_f32 v27, v27, v10
v_mfma_f32_16x16x32_bf16 v[164:167], a[96:99], v[104:107], v[164:167]
s_waitcnt lgkmcnt(7)
buffer_load_dwordx4 v114, s[36:39], s81 offen offset:2048 lds
v_mfma_f32_16x16x32_bf16 v[168:171], a[104:107], v[96:99], v[168:171]
s_waitcnt lgkmcnt(6)
ds_read_b128 a[72:75], v2 offset:18432
v_cvt_pk_bf16_f32 v130, v136, v137
v_mfma_f32_16x16x32_bf16 v[168:171], a[108:111], v[100:103], v[168:171]
v_exp_f32 v11, v71
v_mfma_f32_16x16x32_bf16 v[172:175], a[108:111], v[108:111], v[172:175]
ds_read_b128 a[76:79], v2 offset:19456
v_add_f32 v27, v27, v11
v_mfma_f32_16x16x32_bf16 v[172:175], a[104:107], v[104:107], v[172:175]
s_waitcnt lgkmcnt(7)
buffer_load_dwordx4 v115, s[36:39], s81 offen offset:3072 lds
v_mfma_f32_16x16x32_bf16 v[176:179], a[112:115], v[96:99], v[176:179]
s_waitcnt lgkmcnt(6)
ds_read_b128 a[80:83], v2 offset:20480
v_cvt_pk_bf16_f32 v121, v10, v11
v_mfma_f32_16x16x32_bf16 v[176:179], a[116:119], v[100:103], v[176:179]
s_waitcnt lgkmcnt(6)
v_exp_f32 v12, v76
v_mfma_f32_16x16x32_bf16 v[180:183], a[116:119], v[108:111], v[180:183]
s_add_u32 s81, s81, 28672
ds_read_b128 a[84:87], v2 offset:21504
v_add_f32 v27, v27, v12
v_mfma_f32_16x16x32_bf16 v[180:183], a[112:115], v[104:107], v[180:183]
s_add_u32 m0, s18, 36864
v_exp_f32 v13, v77
v_mfma_f32_16x16x32_bf16 v[184:187], a[120:123], v[96:99], v[184:187]
s_waitcnt lgkmcnt(6)
ds_read_b128 a[88:91], v2 offset:22528
v_add_f32 v27, v27, v13
v_mfma_f32_16x16x32_bf16 v[184:187], a[124:127], v[100:103], v[184:187]
buffer_load_dwordx4 v112, s[36:39], s81 offen offset:0 lds
v_mfma_f32_16x16x32_bf16 v[188:191], a[124:127], v[108:111], v[188:191]
ds_read_b128 a[92:95], v2 offset:23552
v_cvt_pk_bf16_f32 v122, v12, v13
v_mfma_f32_16x16x32_bf16 v[188:191], a[120:123], v[104:107], v[188:191]
s_waitcnt lgkmcnt(7)
v_exp_f32 v14, v78
v_mfma_f32_16x16x32_bf16 v[192:195], a[64:67], v[96:99], v[192:195]
s_waitcnt lgkmcnt(6)
ds_read_b128 a[96:99], v2 offset:24576
v_add_f32 v27, v27, v14
v_mfma_f32_16x16x32_bf16 v[192:195], a[68:71], v[100:103], v[192:195]
buffer_load_dwordx4 v113, s[36:39], s81 offen offset:1024 lds
v_mfma_f32_16x16x32_bf16 v[196:199], a[68:71], v[108:111], v[196:199]
ds_read_b128 a[100:103], v2 offset:25600
v_cvt_pk_bf16_f32 v131, v138, v139
v_mfma_f32_16x16x32_bf16 v[196:199], a[64:67], v[104:107], v[196:199]
s_waitcnt lgkmcnt(7)
v_exp_f32 v15, v79
v_mfma_f32_16x16x32_bf16 v[200:203], a[72:75], v[96:99], v[200:203]
s_waitcnt lgkmcnt(6)
ds_read_b128 a[104:107], v2 offset:26624
v_add_f32 v27, v27, v15
v_mfma_f32_16x16x32_bf16 v[200:203], a[76:79], v[100:103], v[200:203]
buffer_load_dwordx4 v114, s[36:39], s81 offen offset:2048 lds
v_mfma_f32_16x16x32_bf16 v[204:207], a[76:79], v[108:111], v[204:207]
ds_read_b128 a[108:111], v2 offset:27648
v_cvt_pk_bf16_f32 v123, v14, v15
v_mfma_f32_16x16x32_bf16 v[204:207], a[72:75], v[104:107], v[204:207]
s_waitcnt lgkmcnt(7)
v_exp_f32 v8, v84
v_mfma_f32_16x16x32_bf16 v[208:211], a[80:83], v[96:99], v[208:211]
s_waitcnt lgkmcnt(6)
ds_read_b128 a[112:115], v2 offset:28672
v_add_f32 v27, v27, v8
v_mfma_f32_16x16x32_bf16 v[208:211], a[84:87], v[100:103], v[208:211]
buffer_load_dwordx4 v115, s[36:39], s81 offen offset:3072 lds
v_mfma_f32_16x16x32_bf16 v[212:215], a[84:87], v[108:111], v[212:215]
ds_read_b128 a[116:119], v2 offset:29696
v_cvt_pk_bf16_f32 v144, v144, v145
v_mfma_f32_16x16x32_bf16 v[212:215], a[80:83], v[104:107], v[212:215]
s_waitcnt lgkmcnt(6)
v_exp_f32 v9, v85
v_mfma_f32_16x16x32_bf16 v[216:219], a[88:91], v[96:99], v[216:219]
s_sub_u32 s81, s81, 28544
ds_read_b128 a[120:123], v2 offset:30720
v_add_f32 v27, v27, v9
v_mfma_f32_16x16x32_bf16 v[216:219], a[92:95], v[100:103], v[216:219]
v_exp_f32 v10, v86
v_mfma_f32_16x16x32_bf16 v[220:223], a[92:95], v[108:111], v[220:223]
ds_read_b128 a[124:127], v2 offset:31744
v_cvt_pk_bf16_f32 v124, v8, v9
v_mfma_f32_16x16x32_bf16 v[220:223], a[88:91], v[104:107], v[220:223]
s_waitcnt vmcnt(8) lgkmcnt(7)
s_barrier
v_add_f32 v27, v27, v10
v_mfma_f32_16x16x32_bf16 v[224:227], a[96:99], v[96:99], v[224:227]
s_waitcnt lgkmcnt(6)
ds_read_b128 a[64:67], v1 offset:0
v_cvt_pk_bf16_f32 v145, v146, v147
v_mfma_f32_16x16x32_bf16 v[224:227], a[100:103], v[100:103], v[224:227]
v_exp_f32 v11, v87
v_mfma_f32_16x16x32_bf16 v[228:231], a[100:103], v[108:111], v[228:231]
ds_read_b128 a[68:71], v1 offset:1024
v_add_f32 v27, v27, v11
v_mfma_f32_16x16x32_bf16 v[228:231], a[96:99], v[104:107], v[228:231]
s_waitcnt lgkmcnt(7)
v_exp_f32 v12, v92
v_mfma_f32_16x16x32_bf16 v[232:235], a[104:107], v[96:99], v[232:235]
s_waitcnt lgkmcnt(6)
ds_read_b128 a[72:75], v1 offset:2048
v_cvt_pk_bf16_f32 v125, v10, v11
v_mfma_f32_16x16x32_bf16 v[232:235], a[108:111], v[100:103], v[232:235]
v_exp_f32 v13, v93
v_mfma_f32_16x16x32_bf16 v[236:239], a[108:111], v[108:111], v[236:239]
ds_read_b128 a[76:79], v1 offset:3072
v_add_f32 v27, v27, v12
v_mfma_f32_16x16x32_bf16 v[236:239], a[104:107], v[104:107], v[236:239]
s_waitcnt lgkmcnt(7)
v_exp_f32 v14, v94
v_mfma_f32_16x16x32_bf16 v[240:243], a[112:115], v[96:99], v[240:243]
s_waitcnt lgkmcnt(6)
ds_read_b128 a[80:83], v1 offset:4096
v_add_f32 v27, v27, v13
v_mfma_f32_16x16x32_bf16 v[240:243], a[116:119], v[100:103], v[240:243]
v_exp_f32 v15, v95
v_mfma_f32_16x16x32_bf16 v[244:247], a[116:119], v[108:111], v[244:247]
ds_read_b128 a[84:87], v1 offset:5120
v_cvt_pk_bf16_f32 v126, v12, v13
v_mfma_f32_16x16x32_bf16 v[244:247], a[112:115], v[104:107], v[244:247]
s_waitcnt lgkmcnt(7)
v_add_f32 v27, v27, v14
v_add_f32 v27, v27, v15
v_mfma_f32_16x16x32_bf16 v[248:251], a[120:123], v[96:99], v[248:251]
s_waitcnt lgkmcnt(6)
ds_read_b128 a[88:91], v1 offset:6144
v_cvt_pk_bf16_f32 v127, v14, v15
v_mfma_f32_16x16x32_bf16 v[248:251], a[124:127], v[100:103], v[248:251]
v_cmp_nge_f32 vcc, s25, v27
v_cvt_pk_bf16_f32 v146, v152, v153
v_mfma_f32_16x16x32_bf16 v[252:255], a[124:127], v[108:111], v[252:255]
ds_read_b128 a[92:95], v1 offset:7168
v_cvt_pk_bf16_f32 v147, v154, v155
v_mfma_f32_16x16x32_bf16 v[252:255], a[120:123], v[104:107], v[252:255]
s_waitcnt lgkmcnt(2)
v_cvt_pk_bf16_f32 v160, v160, v161
v_cvt_pk_bf16_f32 v161, v162, v163
s_cbranch_vccnz Lstub_13
Lback_14:
v_mfma_f32_16x16x32_bf16 v[132:135], a[64:67], v[120:123], v[132:135]
s_lshl_b32 s8, s29, 3
ds_read_b128 a[96:99], v1 offset:8192
v_add_f32 v25, v25, v27
v_mfma_f32_16x16x32_bf16 v[132:135], a[68:71], v[124:127], v[132:135]
s_add_u32 s8, s8, s3
ds_read_b128 a[100:103], v1 offset:9216
v_cvt_pk_bf16_f32 v162, v168, v169
v_mfma_f32_16x16x32_bf16 v[140:143], a[72:75], v[120:123], v[140:143]
s_lshl_b32 s8, s8, 4
ds_read_b128 a[104:107], v1 offset:10240
v_cvt_pk_bf16_f32 v163, v170, v171
v_mfma_f32_16x16x32_bf16 v[140:143], a[76:79], v[124:127], v[140:143]
s_add_u32 s8, s8, s20
ds_read_b128 a[108:111], v1 offset:11264
v_cvt_pk_bf16_f32 v176, v176, v177
v_mfma_f32_16x16x32_bf16 v[148:151], a[80:83], v[120:123], v[148:151]
s_mul_i32 s8, s8, 14336
ds_read_b128 a[112:115], v1 offset:12288
v_cvt_pk_bf16_f32 v177, v178, v179
v_mfma_f32_16x16x32_bf16 v[148:151], a[84:87], v[124:127], v[148:151]
s_waitcnt lgkmcnt(5)
s_add_u32 s8, s8, 104857600
ds_read_b128 a[116:119], v1 offset:13312
v_cvt_pk_bf16_f32 v178, v184, v185
v_mfma_f32_16x16x32_bf16 v[156:159], a[88:91], v[120:123], v[156:159]
s_add_u32 s12, s8, 917504
ds_read_b128 a[120:123], v1 offset:14336
v_cvt_pk_bf16_f32 v179, v186, v187
v_mfma_f32_16x16x32_bf16 v[156:159], a[92:95], v[124:127], v[156:159]
s_waitcnt lgkmcnt(6)
ds_read_b128 a[124:127], v1 offset:15360
v_cvt_pk_bf16_f32 v192, v192, v193
v_mfma_f32_16x16x32_bf16 v[164:167], a[96:99], v[120:123], v[164:167]
s_waitcnt lgkmcnt(6)
ds_read_b128 a[64:67], v1 offset:16384
v_cvt_pk_bf16_f32 v193, v194, v195
v_mfma_f32_16x16x32_bf16 v[164:167], a[100:103], v[124:127], v[164:167]
s_waitcnt lgkmcnt(6)
ds_read_b128 a[68:71], v1 offset:17408
v_cvt_pk_bf16_f32 v194, v200, v201
v_mfma_f32_16x16x32_bf16 v[172:175], a[104:107], v[120:123], v[172:175]
s_waitcnt lgkmcnt(6)
ds_read_b128 a[72:75], v1 offset:18432
v_cvt_pk_bf16_f32 v195, v202, v203
v_mfma_f32_16x16x32_bf16 v[172:175], a[108:111], v[124:127], v[172:175]
s_waitcnt lgkmcnt(6)
ds_read_b128 a[76:79], v1 offset:19456
v_cvt_pk_bf16_f32 v208, v208, v209
v_mfma_f32_16x16x32_bf16 v[180:183], a[112:115], v[120:123], v[180:183]
s_waitcnt lgkmcnt(6)
ds_read_b128 a[80:83], v1 offset:20480
v_cvt_pk_bf16_f32 v209, v210, v211
v_mfma_f32_16x16x32_bf16 v[180:183], a[116:119], v[124:127], v[180:183]
s_waitcnt lgkmcnt(6)
ds_read_b128 a[84:87], v1 offset:21504
v_cvt_pk_bf16_f32 v210, v216, v217
v_mfma_f32_16x16x32_bf16 v[188:191], a[120:123], v[120:123], v[188:191]
s_waitcnt lgkmcnt(6)
ds_read_b128 a[88:91], v1 offset:22528
v_cvt_pk_bf16_f32 v211, v218, v219
v_mfma_f32_16x16x32_bf16 v[188:191], a[124:127], v[124:127], v[188:191]
s_waitcnt lgkmcnt(6)
ds_read_b128 a[92:95], v1 offset:23552
v_cvt_pk_bf16_f32 v224, v224, v225
v_mfma_f32_16x16x32_bf16 v[196:199], a[64:67], v[120:123], v[196:199]
s_waitcnt lgkmcnt(6)
ds_read_b128 a[96:99], v1 offset:24576
v_cvt_pk_bf16_f32 v225, v226, v227
v_mfma_f32_16x16x32_bf16 v[196:199], a[68:71], v[124:127], v[196:199]
s_waitcnt lgkmcnt(6)
ds_read_b128 a[100:103], v1 offset:25600
v_cvt_pk_bf16_f32 v226, v232, v233
v_mfma_f32_16x16x32_bf16 v[204:207], a[72:75], v[120:123], v[204:207]
s_waitcnt lgkmcnt(6)
ds_read_b128 a[104:107], v1 offset:26624
v_cvt_pk_bf16_f32 v227, v234, v235
v_mfma_f32_16x16x32_bf16 v[204:207], a[76:79], v[124:127], v[204:207]
s_waitcnt lgkmcnt(6)
ds_read_b128 a[108:111], v1 offset:27648
v_cvt_pk_bf16_f32 v240, v240, v241
v_mfma_f32_16x16x32_bf16 v[212:215], a[80:83], v[120:123], v[212:215]
s_waitcnt lgkmcnt(6)
ds_read_b128 a[112:115], v1 offset:28672
v_cvt_pk_bf16_f32 v241, v242, v243
v_mfma_f32_16x16x32_bf16 v[212:215], a[84:87], v[124:127], v[212:215]
s_waitcnt lgkmcnt(5)
ds_read_b128 a[116:119], v1 offset:29696
v_cvt_pk_bf16_f32 v242, v248, v249
v_mfma_f32_16x16x32_bf16 v[220:223], a[88:91], v[120:123], v[220:223]
s_add_u32 m0, s18, 98304
ds_read_b128 a[120:123], v1 offset:30720
v_cvt_pk_bf16_f32 v243, v250, v251
v_mfma_f32_16x16x32_bf16 v[220:223], a[92:95], v[124:127], v[220:223]
s_waitcnt lgkmcnt(6)
ds_read_b128 a[124:127], v1 offset:31744
v_cvt_pk_bf16_f32 v132, v132, v133
v_mfma_f32_16x16x32_bf16 v[228:231], a[96:99], v[120:123], v[228:231]
s_waitcnt lgkmcnt(6)
buffer_load_dwordx4 v112, s[36:39], s81 offen offset:0 lds
v_mfma_f32_16x16x32_bf16 v[228:231], a[100:103], v[124:127], v[228:231]
s_waitcnt lgkmcnt(5)
buffer_load_dwordx4 v113, s[36:39], s81 offen offset:1024 lds
v_mfma_f32_16x16x32_bf16 v[236:239], a[104:107], v[120:123], v[236:239]
s_waitcnt lgkmcnt(4)
buffer_load_dwordx4 v114, s[36:39], s81 offen offset:2048 lds
v_mfma_f32_16x16x32_bf16 v[236:239], a[108:111], v[124:127], v[236:239]
s_waitcnt lgkmcnt(1)
buffer_load_dwordx4 v115, s[36:39], s81 offen offset:3072 lds
v_mfma_f32_16x16x32_bf16 v[244:247], a[112:115], v[120:123], v[244:247]
s_add_u32 s81, s81, 28672
v_cvt_pk_bf16_f32 v133, v134, v135
v_cvt_pk_bf16_f32 v134, v140, v141
v_mfma_f32_16x16x32_bf16 v[244:247], a[116:119], v[124:127], v[244:247]
s_add_u32 m0, s18, 102400
v_cvt_pk_bf16_f32 v135, v142, v143
v_cvt_pk_bf16_f32 v148, v148, v149
v_mfma_f32_16x16x32_bf16 v[252:255], a[120:123], v[120:123], v[252:255]
s_waitcnt lgkmcnt(0)
buffer_load_dwordx4 v112, s[36:39], s81 offen offset:0 lds
v_mfma_f32_16x16x32_bf16 v[252:255], a[124:127], v[124:127], v[252:255]
buffer_load_dwordx4 v113, s[36:39], s81 offen offset:1024 lds
buffer_load_dwordx4 v114, s[36:39], s81 offen offset:2048 lds
buffer_load_dwordx4 v115, s[36:39], s81 offen offset:3072 lds
s_sub_u32 s81, s81, 28544
s_add_u32 m0, s18, 131072
s_nop 0
buffer_load_dwordx4 v112, s[36:39], s81 offen offset:0 lds
v_cvt_pk_bf16_f32 v149, v150, v151
v_cvt_pk_bf16_f32 v150, v156, v157
v_cvt_pk_bf16_f32 v151, v158, v159
v_cvt_pk_bf16_f32 v164, v164, v165
buffer_load_dwordx4 v113, s[36:39], s81 offen offset:1024 lds
v_cvt_pk_bf16_f32 v165, v166, v167
v_cvt_pk_bf16_f32 v166, v172, v173
v_cvt_pk_bf16_f32 v167, v174, v175
v_cvt_pk_bf16_f32 v180, v180, v181
buffer_load_dwordx4 v114, s[36:39], s81 offen offset:2048 lds
v_cvt_pk_bf16_f32 v181, v182, v183
v_cvt_pk_bf16_f32 v182, v188, v189
v_cvt_pk_bf16_f32 v183, v190, v191
v_cvt_pk_bf16_f32 v196, v196, v197
buffer_load_dwordx4 v115, s[36:39], s81 offen offset:3072 lds
v_cvt_pk_bf16_f32 v197, v198, v199
v_cvt_pk_bf16_f32 v198, v204, v205
v_cvt_pk_bf16_f32 v199, v206, v207
v_cvt_pk_bf16_f32 v212, v212, v213
s_add_u32 s81, s81, 28672
s_add_u32 m0, s18, 135168
s_nop 0
buffer_load_dwordx4 v112, s[36:39], s81 offen offset:0 lds
v_cvt_pk_bf16_f32 v213, v214, v215
v_cvt_pk_bf16_f32 v214, v220, v221
v_cvt_pk_bf16_f32 v215, v222, v223
v_cvt_pk_bf16_f32 v228, v228, v229
buffer_load_dwordx4 v113, s[36:39], s81 offen offset:1024 lds
v_cvt_pk_bf16_f32 v229, v230, v231
v_cvt_pk_bf16_f32 v230, v236, v237
v_cvt_pk_bf16_f32 v231, v238, v239
v_cvt_pk_bf16_f32 v244, v244, v245
buffer_load_dwordx4 v114, s[36:39], s81 offen offset:2048 lds
v_cvt_pk_bf16_f32 v245, v246, v247
v_cvt_pk_bf16_f32 v246, v252, v253
v_cvt_pk_bf16_f32 v247, v254, v255
buffer_load_dwordx4 v115, s[36:39], s81 offen offset:3072 lds
s_sub_u32 s81, s81, 28544
s_branch K2_done
K2_cfix:
s_nop 7
v_max_f32 v12, 0, v8
v_exp_f32 v13, -v12
v_sub_f32 v8, v8, v12
v_mul_f32 v24, v24, v13
v_mul_f32 v128, v128, v13
v_mul_f32 v129, v129, v13
v_mul_f32 v130, v130, v13
v_mul_f32 v131, v131, v13
v_mul_f32 v136, v136, v13
v_mul_f32 v137, v137, v13
v_mul_f32 v138, v138, v13
v_mul_f32 v139, v139, v13
v_mul_f32 v144, v144, v13
v_mul_f32 v145, v145, v13
v_mul_f32 v146, v146, v13
v_mul_f32 v147, v147, v13
v_mul_f32 v152, v152, v13
v_mul_f32 v153, v153, v13
v_mul_f32 v154, v154, v13
v_mul_f32 v155, v155, v13
v_mul_f32 v160, v160, v13
v_mul_f32 v161, v161, v13
v_mul_f32 v162, v162, v13
v_mul_f32 v163, v163, v13
v_mul_f32 v168, v168, v13
v_mul_f32 v169, v169, v13
v_mul_f32 v170, v170, v13
v_mul_f32 v171, v171, v13
v_mul_f32 v176, v176, v13
v_mul_f32 v177, v177, v13
v_mul_f32 v178, v178, v13
v_mul_f32 v179, v179, v13
v_mul_f32 v184, v184, v13
v_mul_f32 v185, v185, v13
v_mul_f32 v186, v186, v13
v_mul_f32 v187, v187, v13
v_mul_f32 v192, v192, v13
v_mul_f32 v193, v193, v13
v_mul_f32 v194, v194, v13
v_mul_f32 v195, v195, v13
v_mul_f32 v200, v200, v13
v_mul_f32 v201, v201, v13
v_mul_f32 v202, v202, v13
v_mul_f32 v203, v203, v13
v_mul_f32 v208, v208, v13
v_mul_f32 v209, v209, v13
v_mul_f32 v210, v210, v13
v_mul_f32 v211, v211, v13
v_mul_f32 v216, v216, v13
v_mul_f32 v217, v217, v13
v_mul_f32 v218, v218, v13
v_mul_f32 v219, v219, v13
v_mul_f32 v224, v224, v13
v_mul_f32 v225, v225, v13
v_mul_f32 v226, v226, v13
v_mul_f32 v227, v227, v13
v_mul_f32 v232, v232, v13
v_mul_f32 v233, v233, v13
v_mul_f32 v234, v234, v13
v_mul_f32 v235, v235, v13
v_mul_f32 v240, v240, v13
v_mul_f32 v241, v241, v13
v_mul_f32 v242, v242, v13
v_mul_f32 v243, v243, v13
v_mul_f32 v248, v248, v13
v_mul_f32 v249, v249, v13
v_mul_f32 v250, v250, v13
v_mul_f32 v251, v251, v13
v_max_f32 v12, 0, v10
v_exp_f32 v13, -v12
v_sub_f32 v10, v10, v12
v_mul_f32 v25, v25, v13
v_mul_f32 v132, v132, v13
v_mul_f32 v133, v133, v13
v_mul_f32 v134, v134, v13
v_mul_f32 v135, v135, v13
v_mul_f32 v140, v140, v13
v_mul_f32 v141, v141, v13
v_mul_f32 v142, v142, v13
v_mul_f32 v143, v143, v13
v_mul_f32 v148, v148, v13
v_mul_f32 v149, v149, v13
v_mul_f32 v150, v150, v13
v_mul_f32 v151, v151, v13
v_mul_f32 v156, v156, v13
v_mul_f32 v157, v157, v13
v_mul_f32 v158, v158, v13
v_mul_f32 v159, v159, v13
v_mul_f32 v164, v164, v13
v_mul_f32 v165, v165, v13
v_mul_f32 v166, v166, v13
v_mul_f32 v167, v167, v13
v_mul_f32 v172, v172, v13
v_mul_f32 v173, v173, v13
v_mul_f32 v174, v174, v13
v_mul_f32 v175, v175, v13
v_mul_f32 v180, v180, v13
v_mul_f32 v181, v181, v13
v_mul_f32 v182, v182, v13
v_mul_f32 v183, v183, v13
v_mul_f32 v188, v188, v13
v_mul_f32 v189, v189, v13
v_mul_f32 v190, v190, v13
v_mul_f32 v191, v191, v13
v_mul_f32 v196, v196, v13
v_mul_f32 v197, v197, v13
v_mul_f32 v198, v198, v13
v_mul_f32 v199, v199, v13
v_mul_f32 v204, v204, v13
v_mul_f32 v205, v205, v13
v_mul_f32 v206, v206, v13
v_mul_f32 v207, v207, v13
v_mul_f32 v212, v212, v13
v_mul_f32 v213, v213, v13
v_mul_f32 v214, v214, v13
v_mul_f32 v215, v215, v13
v_mul_f32 v220, v220, v13
v_mul_f32 v221, v221, v13
v_mul_f32 v222, v222, v13
v_mul_f32 v223, v223, v13
v_mul_f32 v228, v228, v13
v_mul_f32 v229, v229, v13
v_mul_f32 v230, v230, v13
v_mul_f32 v231, v231, v13
v_mul_f32 v236, v236, v13
v_mul_f32 v237, v237, v13
v_mul_f32 v238, v238, v13
v_mul_f32 v239, v239, v13
v_mul_f32 v244, v244, v13
v_mul_f32 v245, v245, v13
v_mul_f32 v246, v246, v13
v_mul_f32 v247, v247, v13
v_mul_f32 v252, v252, v13
v_mul_f32 v253, v253, v13
v_mul_f32 v254, v254, v13
v_mul_f32 v255, v255, v13
s_branch K2_cok
K2_tspin:
Lp_9101:
buffer_load_dword v3, off, s[4:7], s80 sc1
s_waitcnt vmcnt(0)
v_cmp_gt_u32 vcc, 1, v3
s_cbranch_vccz Lpd_9102
s_sleep 8
s_sub_u32 s101, s101, 1
s_cbranch_scc0 Lp_9101
s_mov_b32 s101, 0
Lpd_9102:
s_branch K2_tok
K2_p0d:
ds_read_b128 a[64:67], v1 offset:0
ds_read_b128 a[68:71], v1 offset:1024
ds_read_b128 a[72:75], v1 offset:2048
ds_read_b128 a[76:79], v1 offset:3072
ds_read_b128 a[80:83], v1 offset:4096
ds_read_b128 a[84:87], v1 offset:5120
ds_read_b128 a[88:91], v1 offset:6144
ds_read_b128 a[92:95], v1 offset:7168
v_cndmask_b32 v32, 0, v7, s[32:33]
v_cndmask_b32 v33, 0, v7, s[34:35]
v_cndmask_b32 v34, 0, v7, s[36:37]
v_cndmask_b32 v35, 0, v7, s[38:39]
v_cndmask_b32 v40, 0, v7, s[40:41]
v_cndmask_b32 v41, 0, v7, s[42:43]
v_cndmask_b32 v42, 0, v7, s[44:45]
v_cndmask_b32 v43, 0, v7, s[46:47]
s_waitcnt lgkmcnt(7)
v_mfma_f32_16x16x32_bf16 v[32:35], a[64:67], a[0:3], v[32:35]
s_waitcnt lgkmcnt(6)
s_add_u32 m0, s18, 65536
ds_read_b128 a[96:99], v1 offset:8192
v_mfma_f32_16x16x32_bf16 v[32:35], a[68:71], a[4:7], v[32:35]
s_waitcnt lgkmcnt(6)
buffer_load_dwordx4 v1, s[4:7], s12 offen offset:0 sc1 lds
v_mfma_f32_16x16x32_bf16 v[32:35], a[72:75], a[8:11], v[32:35]
s_waitcnt lgkmcnt(5)
ds_read_b128 a[100:103], v1 offset:9216
v_mfma_f32_16x16x32_bf16 v[32:35], a[76:79], a[12:15], v[32:35]
s_waitcnt lgkmcnt(5)
buffer_load_dwordx4 v1, s[4:7], s12 offen offset:1024 sc1 lds
v_mfma_f32_16x16x32_bf16 v[32:35], a[80:83], a[16:19], v[32:35]
s_waitcnt lgkmcnt(4)
ds_read_b128 a[104:107], v1 offset:10240
v_mfma_f32_16x16x32_bf16 v[32:35], a[84:87], a[20:23], v[32:35]
s_waitcnt lgkmcnt(4)
buffer_load_dwordx4 v1, s[4:7], s12 offen offset:2048 sc1 lds
v_mfma_f32_16x16x32_bf16 v[32:35], a[88:91], a[24:27], v[32:35]
s_waitcnt lgkmcnt(3)
ds_read_b128 a[108:111], v1 offset:11264
v_mfma_f32_16x16x32_bf16 v[32:35], a[92:95], a[28:31], v[32:35]
buffer_load_dwordx4 v1, s[4:7], s12 offen offset:3072 sc1 lds
v_mfma_f32_16x16x32_bf16 v[36:39], a[64:67], a[32:35], 0
s_add_u32 s12, s12, 4096
s_add_u32 m0, s18, 69632
ds_read_b128 a[112:115], v1 offset:12288
v_mfma_f32_16x16x32_bf16 v[36:39], a[68:71], a[36:39], v[36:39]
buffer_load_dwordx4 v1, s[4:7], s12 offen offset:0 sc1 lds
v_mfma_f32_16x16x32_bf16 v[36:39], a[72:75], a[40:43], v[36:39]
ds_read_b128 a[116:119], v1 offset:13312
v_mfma_f32_16x16x32_bf16 v[36:39], a[76:79], a[44:47], v[36:39]
buffer_load_dwordx4 v1, s[4:7], s12 offen offset:1024 sc1 lds
v_mfma_f32_16x16x32_bf16 v[36:39], a[80:83], a[48:51], v[36:39]
ds_read_b128 a[120:123], v1 offset:14336
v_max3_f32 v28, v32, v33, v34
v_mfma_f32_16x16x32_bf16 v[36:39], a[84:87], a[52:55], v[36:39]
buffer_load_dwordx4 v1, s[4:7], s12 offen offset:2048 sc1 lds
v_mfma_f32_16x16x32_bf16 v[36:39], a[88:91], a[56:59], v[36:39]
ds_read_b128 a[124:127], v1 offset:15360
v_max_f32 v28, v28, v35
v_mfma_f32_16x16x32_bf16 v[36:39], a[92:95], a[60:63], v[36:39]
s_waitcnt lgkmcnt(6)
buffer_load_dwordx4 v1, s[4:7], s12 offen offset:3072 sc1 lds
v_mfma_f32_16x16x32_bf16 v[40:43], a[96:99], a[0:3], v[40:43]
s_add_u32 s12, s12, 28672
ds_read_b128 a[64:67], v1 offset:16384
v_mov_b32 v30, v28
v_mfma_f32_16x16x32_bf16 v[40:43], a[100:103], a[4:7], v[40:43]
s_waitcnt lgkmcnt(2)
s_sub_u32 s13, s13, 1
v_mfma_f32_16x16x32_bf16 v[40:43], a[104:107], a[8:11], v[40:43]
s_cmp_eq_u32 s13, 0
ds_read_b128 a[68:71], v1 offset:17408
v_permlane16_swap_b32 v28, v30
v_mfma_f32_16x16x32_bf16 v[40:43], a[108:111], a[12:15], v[40:43]
s_cselect_b32 s12, s14, s12
v_max_f32 v28, v28, v30
v_mov_b32 v30, v28
v_mfma_f32_16x16x32_bf16 v[40:43], a[112:115], a[16:19], v[40:43]
s_cselect_b32 s13, s15, s13
ds_read_b128 a[72:75], v1 offset:18432
v_max3_f32 v29, v36, v37, v38
v_mfma_f32_16x16x32_bf16 v[40:43], a[116:119], a[20:23], v[40:43]
s_cselect_b32 s14, 3221225472, s14
v_permlane32_swap_b32 v28, v30
v_max_f32 v28, v28, v30
v_mfma_f32_16x16x32_bf16 v[40:43], a[120:123], a[24:27], v[40:43]
s_waitcnt lgkmcnt(3)
ds_read_b128 a[76:79], v1 offset:19456
v_sub_f32 v16, 0, v28
v_mfma_f32_16x16x32_bf16 v[40:43], a[124:127], a[28:31], v[40:43]
v_sub_f32 v17, 0, v28
v_sub_f32 v18, 0, v28
v_mfma_f32_16x16x32_bf16 v[44:47], a[96:99], a[32:35], 0
ds_read_b128 a[80:83], v1 offset:20480
v_sub_f32 v19, 0, v28
v_mfma_f32_16x16x32_bf16 v[44:47], a[100:103], a[36:39], v[44:47]
v_max_f32 v29, v29, v39
v_mov_b32 v31, v29
v_cndmask_b32 v48, v16, v7, s[48:49]
v_mfma_f32_16x16x32_bf16 v[44:47], a[104:107], a[40:43], v[44:47]
ds_read_b128 a[84:87], v1 offset:21504
v_cndmask_b32 v49, v16, v7, s[50:51]
v_mfma_f32_16x16x32_bf16 v[44:47], a[108:111], a[44:47], v[44:47]
v_permlane16_swap_b32 v29, v31
v_max_f32 v29, v29, v31
v_cndmask_b32 v50, v16, v7, s[52:53]
v_mfma_f32_16x16x32_bf16 v[44:47], a[112:115], a[48:51], v[44:47]
ds_read_b128 a[88:91], v1 offset:22528
v_mov_b32 v31, v29
v_cndmask_b32 v51, v16, v7, s[54:55]
v_mfma_f32_16x16x32_bf16 v[44:47], a[116:119], a[52:55], v[44:47]
v_cndmask_b32 v56, v16, v7, s[56:57]
v_cndmask_b32 v57, v16, v7, s[58:59]
v_mfma_f32_16x16x32_bf16 v[44:47], a[120:123], a[56:59], v[44:47]
ds_read_b128 a[92:95], v1 offset:23552
v_permlane32_swap_b32 v29, v31
v_mfma_f32_16x16x32_bf16 v[44:47], a[124:127], a[60:63], v[44:47]
s_waitcnt lgkmcnt(7)
v_max_f32 v29, v29, v31
v_sub_f32 v20, 0, v29
v_mfma_f32_16x16x32_bf16 v[48:51], a[64:67], a[0:3], v[48:51]
s_waitcnt lgkmcnt(6)
ds_read_b128 a[96:99], v1 offset:24576
v_sub_f32 v21, 0, v29
v_mfma_f32_16x16x32_bf16 v[48:51], a[68:71], a[4:7], v[48:51]
s_waitcnt lgkmcnt(6)
v_sub_f32 v22, 0, v29
v_sub_f32 v23, 0, v29
v_mfma_f32_16x16x32_bf16 v[48:51], a[72:75], a[8:11], v[48:51]
s_waitcnt lgkmcnt(5)
ds_read_b128 a[100:103], v1 offset:25600
v_cndmask_b32 v58, v16, v7, s[60:61]
v_mfma_f32_16x16x32_bf16 v[48:51], a[76:79], a[12:15], v[48:51]
s_waitcnt lgkmcnt(5)
v_cndmask_b32 v59, v16, v7, s[62:63]
v_mfma_f32_16x16x32_bf16 v[48:51], a[80:83], a[16:19], v[48:51]
s_waitcnt lgkmcnt(4)
ds_read_b128 a[104:107], v1 offset:26624
v_mfma_f32_16x16x32_bf16 v[48:51], a[84:87], a[20:23], v[48:51]
s_waitcnt lgkmcnt(4)
v_add_f32 v32, v32, v16
v_add_f32 v33, v33, v16
v_add_f32 v34, v34, v16
v_add_f32 v35, v35, v16
v_mfma_f32_16x16x32_bf16 v[48:51], a[88:91], a[24:27], v[48:51]
s_waitcnt lgkmcnt(3)
ds_read_b128 a[108:111], v1 offset:27648
v_add_f32 v36, v36, v20
v_add_f32 v37, v37, v20
v_add_f32 v38, v38, v20
v_add_f32 v39, v39, v20
v_mfma_f32_16x16x32_bf16 v[48:51], a[92:95], a[28:31], v[48:51]
v_add_f32 v40, v40, v16
v_add_f32 v41, v41, v16
v_add_f32 v42, v42, v16
v_add_f32 v43, v43, v16
v_mfma_f32_16x16x32_bf16 v[52:55], a[64:67], a[32:35], v[20:23]
ds_read_b128 a[112:115], v1 offset:28672
v_add_f32 v44, v44, v20
v_add_f32 v45, v45, v20
v_add_f32 v46, v46, v20
v_add_f32 v47, v47, v20
v_mfma_f32_16x16x32_bf16 v[52:55], a[68:71], a[36:39], v[52:55]
v_exp_f32 v8, v32
v_mfma_f32_16x16x32_bf16 v[52:55], a[72:75], a[40:43], v[52:55]
ds_read_b128 a[116:119], v1 offset:29696
v_exp_f32 v9, v33
v_mfma_f32_16x16x32_bf16 v[52:55], a[76:79], a[44:47], v[52:55]
v_exp_f32 v10, v34
v_mfma_f32_16x16x32_bf16 v[52:55], a[80:83], a[48:51], v[52:55]
ds_read_b128 a[120:123], v1 offset:30720
v_exp_f32 v11, v35
v_mfma_f32_16x16x32_bf16 v[52:55], a[84:87], a[52:55], v[52:55]
v_exp_f32 v12, v36
v_mfma_f32_16x16x32_bf16 v[52:55], a[88:91], a[56:59], v[52:55]
ds_read_b128 a[124:127], v1 offset:31744
v_exp_f32 v13, v37
v_mfma_f32_16x16x32_bf16 v[52:55], a[92:95], a[60:63], v[52:55]
s_waitcnt vmcnt(8) lgkmcnt(7)
s_barrier
v_add_f32 v26, v8, v9
v_cvt_pk_bf16_f32 v96, v8, v9
v_add_f32 v26, v26, v10
v_add_f32 v26, v26, v11
v_cvt_pk_bf16_f32 v97, v10, v11
v_add_f32 v27, v12, v13
v_cvt_pk_bf16_f32 v104, v12, v13
v_mfma_f32_16x16x32_bf16 v[56:59], a[96:99], a[0:3], v[56:59]
s_waitcnt lgkmcnt(6)
ds_read_b128 a[64:67], v4 offset:0
v_exp_f32 v14, v38
v_mfma_f32_16x16x32_bf16 v[56:59], a[100:103], a[4:7], v[56:59]
s_waitcnt lgkmcnt(6)
buffer_store_dword v6, v5, s[4:7], s71 offen sc1
v_add_f32 v27, v27, v14
v_mfma_f32_16x16x32_bf16 v[56:59], a[104:107], a[8:11], v[56:59]
s_waitcnt lgkmcnt(5)
ds_read_b128 a[68:71], v4 offset:1024
v_exp_f32 v15, v39
v_mfma_f32_16x16x32_bf16 v[56:59], a[108:111], a[12:15], v[56:59]
s_waitcnt lgkmcnt(5)
v_exp_f32 v8, v40
v_mfma_f32_16x16x32_bf16 v[56:59], a[112:115], a[16:19], v[56:59]
s_waitcnt lgkmcnt(4)
ds_read_b128 a[72:75], v4 offset:2048
v_exp_f32 v9, v41
v_mfma_f32_16x16x32_bf16 v[56:59], a[116:119], a[20:23], v[56:59]
s_waitcnt lgkmcnt(4)
v_exp_f32 v10, v42
v_mfma_f32_16x16x32_bf16 v[56:59], a[120:123], a[24:27], v[56:59]
s_waitcnt lgkmcnt(3)
ds_read_b128 a[76:79], v4 offset:3072
v_add_f32 v27, v27, v15
v_cvt_pk_bf16_f32 v105, v14, v15
v_add_f32 v26, v26, v8
v_add_f32 v26, v26, v9
v_cvt_pk_bf16_f32 v98, v8, v9
v_add_f32 v26, v26, v10
v_mfma_f32_16x16x32_bf16 v[56:59], a[124:127], a[28:31], v[56:59]
v_exp_f32 v11, v43
v_mfma_f32_16x16x32_bf16 v[60:63], a[96:99], a[32:35], v[20:23]
ds_read_b128 a[80:83], v4 offset:4096
v_exp_f32 v12, v44
v_mfma_f32_16x16x32_bf16 v[60:63], a[100:103], a[36:39], v[60:63]
v_exp_f32 v13, v45
v_mfma_f32_16x16x32_bf16 v[60:63], a[104:107], a[40:43], v[60:63]
ds_read_b128 a[84:87], v4 offset:5120
v_exp_f32 v14, v46
v_mfma_f32_16x16x32_bf16 v[60:63], a[108:111], a[44:47], v[60:63]
v_exp_f32 v15, v47
v_mfma_f32_16x16x32_bf16 v[60:63], a[112:115], a[48:51], v[60:63]
ds_read_b128 a[88:91], v4 offset:6144
v_add_f32 v26, v26, v11
v_cvt_pk_bf16_f32 v99, v10, v11
v_mfma_f32_16x16x32_bf16 v[60:63], a[116:119], a[52:55], v[60:63]
v_add_f32 v27, v27, v12
v_add_f32 v27, v27, v13
v_cvt_pk_bf16_f32 v106, v12, v13
v_mfma_f32_16x16x32_bf16 v[60:63], a[120:123], a[56:59], v[60:63]
s_waitcnt lgkmcnt(7)
s_barrier
ds_read_b128 a[92:95], v4 offset:7168
v_mfma_f32_16x16x32_bf16 v[60:63], a[124:127], a[60:63], v[60:63]
s_waitcnt lgkmcnt(6)
v_add_f32 v27, v27, v14
v_add_f32 v27, v27, v15
v_cvt_pk_bf16_f32 v107, v14, v15
s_branch K2_dx1
K2_ntail:
v_mfma_f32_16x16x32_bf16 v[128:131], a[64:67], v[96:99], v[128:131]
s_add_u32 m0, s18, 98304
ds_read_b128 a[96:99], v2 offset:8192
v_add_f32 v24, v24, v26
v_mfma_f32_16x16x32_bf16 v[128:131], a[68:71], v[100:103], v[128:131]
buffer_load_dwordx4 v1, s[4:7], s12 offen offset:0 sc1 lds
v_mfma_f32_16x16x32_bf16 v[132:135], a[68:71], v[108:111], v[132:135]
ds_read_b128 a[100:103], v2 offset:9216
v_add_f32 v25, v25, v27
v_mfma_f32_16x16x32_bf16 v[132:135], a[64:67], v[104:107], v[132:135]
s_waitcnt lgkmcnt(7)
buffer_load_dwordx4 v1, s[4:7], s12 offen offset:1024 sc1 lds
v_mfma_f32_16x16x32_bf16 v[136:139], a[72:75], v[96:99], v[136:139]
s_waitcnt lgkmcnt(6)
ds_read_b128 a[104:107], v2 offset:10240
v_exp_f32 v8, v64
v_mfma_f32_16x16x32_bf16 v[136:139], a[76:79], v[100:103], v[136:139]
buffer_load_dwordx4 v1, s[4:7], s12 offen offset:2048 sc1 lds
v_mfma_f32_16x16x32_bf16 v[140:143], a[76:79], v[108:111], v[140:143]
ds_read_b128 a[108:111], v2 offset:11264
v_mfma_f32_16x16x32_bf16 v[140:143], a[72:75], v[104:107], v[140:143]
s_waitcnt lgkmcnt(6)
buffer_load_dwordx4 v1, s[4:7], s12 offen offset:3072 sc1 lds
v_mfma_f32_16x16x32_bf16 v[144:147], a[80:83], v[96:99], v[144:147]
s_add_u32 s12, s12, 4096
s_add_u32 m0, s18, 102400
ds_read_b128 a[112:115], v2 offset:12288
v_mfma_f32_16x16x32_bf16 v[144:147], a[84:87], v[100:103], v[144:147]
buffer_load_dwordx4 v1, s[4:7], s12 offen offset:0 sc1 lds
v_mfma_f32_16x16x32_bf16 v[148:151], a[84:87], v[108:111], v[148:151]
ds_read_b128 a[116:119], v2 offset:13312
v_exp_f32 v9, v65
v_mfma_f32_16x16x32_bf16 v[148:151], a[80:83], v[104:107], v[148:151]
s_waitcnt lgkmcnt(7)
buffer_load_dwordx4 v1, s[4:7], s12 offen offset:1024 sc1 lds
v_mfma_f32_16x16x32_bf16 v[152:155], a[88:91], v[96:99], v[152:155]
s_waitcnt lgkmcnt(6)
ds_read_b128 a[120:123], v2 offset:14336
v_add_f32 v26, v8, v9
v_cvt_pk_bf16_f32 v112, v8, v9
v_mfma_f32_16x16x32_bf16 v[152:155], a[92:95], v[100:103], v[152:155]
buffer_load_dwordx4 v1, s[4:7], s12 offen offset:2048 sc1 lds
v_mfma_f32_16x16x32_bf16 v[156:159], a[92:95], v[108:111], v[156:159]
ds_read_b128 a[124:127], v2 offset:15360
v_exp_f32 v10, v66
v_mfma_f32_16x16x32_bf16 v[156:159], a[88:91], v[104:107], v[156:159]
s_waitcnt lgkmcnt(4)
buffer_load_dwordx4 v1, s[4:7], s12 offen offset:3072 sc1 lds
v_mfma_f32_16x16x32_bf16 v[160:163], a[96:99], v[96:99], v[160:163]
s_add_u32 s12, s12, 28672
ds_read_b128 a[64:67], v2 offset:16384
v_add_f32 v26, v26, v10
v_mfma_f32_16x16x32_bf16 v[160:163], a[100:103], v[100:103], v[160:163]
s_sub_u32 s13, s13, 1
v_exp_f32 v11, v67
v_mfma_f32_16x16x32_bf16 v[164:167], a[100:103], v[108:111], v[164:167]
s_cmp_eq_u32 s13, 0
ds_read_b128 a[68:71], v2 offset:17408
v_exp_f32 v12, v68
v_mfma_f32_16x16x32_bf16 v[164:167], a[96:99], v[104:107], v[164:167]
s_cselect_b32 s12, s14, s12
v_exp_f32 v13, v69
v_mfma_f32_16x16x32_bf16 v[168:171], a[104:107], v[96:99], v[168:171]
s_cselect_b32 s13, s15, s13
ds_read_b128 a[72:75], v2 offset:18432
v_add_f32 v26, v26, v11
v_mfma_f32_16x16x32_bf16 v[168:171], a[108:111], v[100:103], v[168:171]
s_cselect_b32 s14, 3221225472, s14
v_exp_f32 v14, v70
v_mfma_f32_16x16x32_bf16 v[172:175], a[108:111], v[108:111], v[172:175]
ds_read_b128 a[76:79], v2 offset:19456
v_cvt_pk_bf16_f32 v113, v10, v11
v_add_f32 v27, v12, v13
v_cvt_pk_bf16_f32 v120, v12, v13
v_mfma_f32_16x16x32_bf16 v[172:175], a[104:107], v[104:107], v[172:175]
s_waitcnt lgkmcnt(7)
v_exp_f32 v15, v71
v_mfma_f32_16x16x32_bf16 v[176:179], a[112:115], v[96:99], v[176:179]
s_waitcnt lgkmcnt(6)
ds_read_b128 a[80:83], v2 offset:20480
v_exp_f32 v8, v72
v_mfma_f32_16x16x32_bf16 v[176:179], a[116:119], v[100:103], v[176:179]
v_exp_f32 v9, v73
v_mfma_f32_16x16x32_bf16 v[180:183], a[116:119], v[108:111], v[180:183]
ds_read_b128 a[84:87], v2 offset:21504
v_add_f32 v27, v27, v14
v_add_f32 v27, v27, v15
v_cvt_pk_bf16_f32 v121, v14, v15
v_add_f32 v26, v26, v8
v_mfma_f32_16x16x32_bf16 v[180:183], a[112:115], v[104:107], v[180:183]
s_waitcnt lgkmcnt(7)
v_exp_f32 v10, v74
v_mfma_f32_16x16x32_bf16 v[184:187], a[120:123], v[96:99], v[184:187]
s_waitcnt lgkmcnt(6)
ds_read_b128 a[88:91], v2 offset:22528
v_exp_f32 v11, v75
v_mfma_f32_16x16x32_bf16 v[184:187], a[124:127], v[100:103], v[184:187]
v_exp_f32 v12, v76
v_mfma_f32_16x16x32_bf16 v[188:191], a[124:127], v[108:111], v[188:191]
ds_read_b128 a[92:95], v2 offset:23552
v_add_f32 v26, v26, v9
v_cvt_pk_bf16_f32 v114, v8, v9
v_add_f32 v26, v26, v10
v_add_f32 v26, v26, v11
v_cvt_pk_bf16_f32 v115, v10, v11
v_mfma_f32_16x16x32_bf16 v[188:191], a[120:123], v[104:107], v[188:191]
s_waitcnt lgkmcnt(7)
v_exp_f32 v13, v77
v_mfma_f32_16x16x32_bf16 v[192:195], a[64:67], v[96:99], v[192:195]
s_waitcnt lgkmcnt(6)
ds_read_b128 a[96:99], v2 offset:24576
v_exp_f32 v14, v78
v_mfma_f32_16x16x32_bf16 v[192:195], a[68:71], v[100:103], v[192:195]
v_exp_f32 v15, v79
v_mfma_f32_16x16x32_bf16 v[196:199], a[68:71], v[108:111], v[196:199]
ds_read_b128 a[100:103], v2 offset:25600
v_add_f32 v27, v27, v12
v_add_f32 v27, v27, v13
v_cvt_pk_bf16_f32 v122, v12, v13
v_add_f32 v27, v27, v14
v_mfma_f32_16x16x32_bf16 v[196:199], a[64:67], v[104:107], v[196:199]
s_waitcnt lgkmcnt(7)
v_exp_f32 v8, v80
v_mfma_f32_16x16x32_bf16 v[200:203], a[72:75], v[96:99], v[200:203]
s_waitcnt lgkmcnt(6)
ds_read_b128 a[104:107], v2 offset:26624
v_exp_f32 v9, v81
v_mfma_f32_16x16x32_bf16 v[200:203], a[76:79], v[100:103], v[200:203]
v_exp_f32 v10, v82
v_mfma_f32_16x16x32_bf16 v[204:207], a[76:79], v[108:111], v[204:207]
ds_read_b128 a[108:111], v2 offset:27648
v_add_f32 v27, v27, v15
v_cvt_pk_bf16_f32 v123, v14, v15
v_mfma_f32_16x16x32_bf16 v[204:207], a[72:75], v[104:107], v[204:207]
s_waitcnt lgkmcnt(7)
v_exp_f32 v11, v83
v_mfma_f32_16x16x32_bf16 v[208:211], a[80:83], v[96:99], v[208:211]
s_waitcnt lgkmcnt(6)
ds_read_b128 a[112:115], v2 offset:28672
v_add_f32 v26, v26, v8
v_add_f32 v26, v26, v9
v_cvt_pk_bf16_f32 v116, v8, v9
v_add_f32 v26, v26, v10
v_mfma_f32_16x16x32_bf16 v[208:211], a[84:87], v[100:103], v[208:211]
v_exp_f32 v12, v84
v_mfma_f32_16x16x32_bf16 v[212:215], a[84:87], v[108:111], v[212:215]
ds_read_b128 a[116:119], v2 offset:29696
v_exp_f32 v13, v85
v_mfma_f32_16x16x32_bf16 v[212:215], a[80:83], v[104:107], v[212:215]
s_waitcnt lgkmcnt(7)
v_exp_f32 v14, v86
v_mfma_f32_16x16x32_bf16 v[216:219], a[88:91], v[96:99], v[216:219]
s_waitcnt lgkmcnt(6)
ds_read_b128 a[120:123], v2 offset:30720
v_add_f32 v26, v26, v11
v_cvt_pk_bf16_f32 v117, v10, v11
v_add_f32 v27, v27, v12
v_mfma_f32_16x16x32_bf16 v[216:219], a[92:95], v[100:103], v[216:219]
v_exp_f32 v15, v87
v_mfma_f32_16x16x32_bf16 v[220:223], a[92:95], v[108:111], v[220:223]
ds_read_b128 a[124:127], v2 offset:31744
v_exp_f32 v8, v88
v_mfma_f32_16x16x32_bf16 v[220:223], a[88:91], v[104:107], v[220:223]
s_waitcnt vmcnt(0) lgkmcnt(7)
s_barrier
v_add_f32 v27, v27, v13
v_cvt_pk_bf16_f32 v124, v12, v13
v_add_f32 v27, v27, v14
v_mfma_f32_16x16x32_bf16 v[224:227], a[96:99], v[96:99], v[224:227]
s_waitcnt lgkmcnt(6)
ds_read_b128 a[64:67], v2 offset:32768
v_exp_f32 v9, v89
v_mfma_f32_16x16x32_bf16 v[224:227], a[100:103], v[100:103], v[224:227]
v_exp_f32 v10, v90
v_mfma_f32_16x16x32_bf16 v[228:231], a[100:103], v[108:111], v[228:231]
ds_read_b128 a[68:71], v2 offset:33792
v_add_f32 v27, v27, v15
v_cvt_pk_bf16_f32 v125, v14, v15
v_add_f32 v26, v26, v8
v_add_f32 v26, v26, v9
v_cvt_pk_bf16_f32 v118, v8, v9
v_mfma_f32_16x16x32_bf16 v[228:231], a[96:99], v[104:107], v[228:231]
s_waitcnt lgkmcnt(7)
v_exp_f32 v11, v91
v_mfma_f32_16x16x32_bf16 v[232:235], a[104:107], v[96:99], v[232:235]
s_waitcnt lgkmcnt(6)
ds_read_b128 a[72:75], v2 offset:34816
v_exp_f32 v12, v92
v_mfma_f32_16x16x32_bf16 v[232:235], a[108:111], v[100:103], v[232:235]
v_exp_f32 v13, v93
v_mfma_f32_16x16x32_bf16 v[236:239], a[108:111], v[108:111], v[236:239]
ds_read_b128 a[76:79], v2 offset:35840
v_add_f32 v26, v26, v10
v_mfma_f32_16x16x32_bf16 v[236:239], a[104:107], v[104:107], v[236:239]
s_waitcnt lgkmcnt(7)
v_exp_f32 v14, v94
v_mfma_f32_16x16x32_bf16 v[240:243], a[112:115], v[96:99], v[240:243]
s_waitcnt lgkmcnt(6)
ds_read_b128 a[80:83], v2 offset:36864
v_add_f32 v26, v26, v11
v_cvt_pk_bf16_f32 v119, v10, v11
v_add_f32 v27, v27, v12
v_mfma_f32_16x16x32_bf16 v[240:243], a[116:119], v[100:103], v[240:243]
v_exp_f32 v15, v95
v_mfma_f32_16x16x32_bf16 v[244:247], a[116:119], v[108:111], v[244:247]
ds_read_b128 a[84:87], v2 offset:37888
v_add_f32 v27, v27, v13
v_cvt_pk_bf16_f32 v126, v12, v13
v_mfma_f32_16x16x32_bf16 v[244:247], a[112:115], v[104:107], v[244:247]
s_waitcnt lgkmcnt(7)
v_add_f32 v27, v27, v14
v_add_f32 v27, v27, v15
v_mfma_f32_16x16x32_bf16 v[248:251], a[120:123], v[96:99], v[248:251]
s_waitcnt lgkmcnt(6)
ds_read_b128 a[88:91], v2 offset:38912
v_cvt_pk_bf16_f32 v127, v14, v15
v_mfma_f32_16x16x32_bf16 v[248:251], a[124:127], v[100:103], v[248:251]
v_add_f32 v28, v26, v27
v_cmp_nge_f32 vcc, s25, v28
v_mfma_f32_16x16x32_bf16 v[252:255], a[124:127], v[108:111], v[252:255]
ds_read_b128 a[92:95], v2 offset:39936
v_mfma_f32_16x16x32_bf16 v[252:255], a[120:123], v[104:107], v[252:255]
s_waitcnt lgkmcnt(6)
s_cbranch_vccnz Lstub_15
Lback_16:
v_mfma_f32_16x16x32_bf16 v[128:131], a[64:67], v[112:115], v[128:131]
s_add_u32 m0, s18, 131072
ds_read_b128 a[96:99], v2 offset:40960
v_add_f32 v24, v24, v26
v_mfma_f32_16x16x32_bf16 v[128:131], a[68:71], v[116:119], v[128:131]
buffer_load_dwordx4 v1, s[4:7], s8 offen offset:0 sc1 lds
v_mfma_f32_16x16x32_bf16 v[132:135], a[68:71], v[124:127], v[132:135]
ds_read_b128 a[100:103], v2 offset:41984
v_add_f32 v25, v25, v27
v_mfma_f32_16x16x32_bf16 v[132:135], a[64:67], v[120:123], v[132:135]
s_waitcnt lgkmcnt(7)
buffer_load_dwordx4 v1, s[4:7], s8 offen offset:1024 sc1 lds
v_mfma_f32_16x16x32_bf16 v[136:139], a[72:75], v[112:115], v[136:139]
s_waitcnt lgkmcnt(6)
ds_read_b128 a[104:107], v2 offset:43008
v_mov_b32 v8, v16
v_mfma_f32_16x16x32_bf16 v[136:139], a[76:79], v[116:119], v[136:139]
buffer_load_dwordx4 v1, s[4:7], s8 offen offset:2048 sc1 lds
v_mfma_f32_16x16x32_bf16 v[140:143], a[76:79], v[124:127], v[140:143]
ds_read_b128 a[108:111], v2 offset:44032
v_mov_b32 v9, v24
v_mfma_f32_16x16x32_bf16 v[140:143], a[72:75], v[120:123], v[140:143]
s_waitcnt lgkmcnt(6)
buffer_load_dwordx4 v1, s[4:7], s8 offen offset:3072 sc1 lds
v_mfma_f32_16x16x32_bf16 v[144:147], a[80:83], v[112:115], v[144:147]
s_add_u32 s8, s8, 4096
s_add_u32 m0, s18, 135168
ds_read_b128 a[112:115], v2 offset:45056
v_mfma_f32_16x16x32_bf16 v[144:147], a[84:87], v[116:119], v[144:147]
buffer_load_dwordx4 v1, s[4:7], s8 offen offset:0 sc1 lds
v_mfma_f32_16x16x32_bf16 v[148:151], a[84:87], v[124:127], v[148:151]
ds_read_b128 a[116:119], v2 offset:46080
v_mov_b32 v10, v20
v_mfma_f32_16x16x32_bf16 v[148:151], a[80:83], v[120:123], v[148:151]
s_waitcnt lgkmcnt(7)
buffer_load_dwordx4 v1, s[4:7], s8 offen offset:1024 sc1 lds
v_mfma_f32_16x16x32_bf16 v[152:155], a[88:91], v[112:115], v[152:155]
s_waitcnt lgkmcnt(6)
ds_read_b128 a[120:123], v2 offset:47104
v_mov_b32 v11, v25
v_mfma_f32_16x16x32_bf16 v[152:155], a[92:95], v[116:119], v[152:155]
buffer_load_dwordx4 v1, s[4:7], s8 offen offset:2048 sc1 lds
v_mfma_f32_16x16x32_bf16 v[156:159], a[92:95], v[124:127], v[156:159]
ds_read_b128 a[124:127], v2 offset:48128
v_cvt_pk_bf16_f32 v128, v128, v129
v_mfma_f32_16x16x32_bf16 v[156:159], a[88:91], v[120:123], v[156:159]
s_waitcnt lgkmcnt(4)
buffer_load_dwordx4 v1, s[4:7], s8 offen offset:3072 sc1 lds
v_mfma_f32_16x16x32_bf16 v[160:163], a[96:99], v[112:115], v[160:163]
s_add_u32 s8, s8, 28672
ds_read_b128 a[64:67], v2 offset:49152
v_cvt_pk_bf16_f32 v129, v130, v131
v_mfma_f32_16x16x32_bf16 v[160:163], a[100:103], v[116:119], v[160:163]
s_sub_u32 s9, s9, 1
buffer_store_dwordx4 v[8:11], v1, s[4:7], s27 offen sc1
v_mfma_f32_16x16x32_bf16 v[164:167], a[100:103], v[124:127], v[164:167]
s_cmp_eq_u32 s9, 0
ds_read_b128 a[68:71], v2 offset:50176
v_cvt_pk_bf16_f32 v130, v136, v137
v_mfma_f32_16x16x32_bf16 v[164:167], a[96:99], v[120:123], v[164:167]
s_cselect_b32 s8, s10, s8
v_cvt_pk_bf16_f32 v131, v138, v139
v_accvgpr_mov_b32 a0, a192
v_mfma_f32_16x16x32_bf16 v[168:171], a[104:107], v[112:115], v[168:171]
s_cselect_b32 s9, s11, s9
ds_read_b128 a[72:75], v2 offset:51200
v_accvgpr_mov_b32 a1, a193
v_mfma_f32_16x16x32_bf16 v[168:171], a[108:111], v[116:119], v[168:171]
s_cselect_b32 s10, 3221225472, s10
buffer_store_dwordx4 v[128:131], v1, s[4:7], s76 offen offset:0 sc1
v_mfma_f32_16x16x32_bf16 v[172:175], a[108:111], v[124:127], v[172:175]
ds_read_b128 a[76:79], v2 offset:52224
v_cvt_pk_bf16_f32 v132, v132, v133
v_mfma_f32_16x16x32_bf16 v[172:175], a[104:107], v[120:123], v[172:175]
s_waitcnt lgkmcnt(7)
v_cvt_pk_bf16_f32 v133, v134, v135
v_cvt_pk_bf16_f32 v134, v140, v141
v_mfma_f32_16x16x32_bf16 v[176:179], a[112:115], v[112:115], v[176:179]
s_waitcnt lgkmcnt(6)
ds_read_b128 a[80:83], v2 offset:53248
v_cvt_pk_bf16_f32 v135, v142, v143
v_mfma_f32_16x16x32_bf16 v[176:179], a[116:119], v[116:119], v[176:179]
buffer_store_dwordx4 v[132:135], v1, s[4:7], s77 offen offset:0 sc1
v_mfma_f32_16x16x32_bf16 v[180:183], a[116:119], v[124:127], v[180:183]
ds_read_b128 a[84:87], v2 offset:54272
v_cvt_pk_bf16_f32 v144, v144, v145
v_mfma_f32_16x16x32_bf16 v[180:183], a[112:115], v[120:123], v[180:183]
s_waitcnt lgkmcnt(7)
v_cvt_pk_bf16_f32 v145, v146, v147
v_cvt_pk_bf16_f32 v146, v152, v153
v_mfma_f32_16x16x32_bf16 v[184:187], a[120:123], v[112:115], v[184:187]
s_waitcnt lgkmcnt(6)
ds_read_b128 a[88:91], v2 offset:55296
v_cvt_pk_bf16_f32 v147, v154, v155
v_mfma_f32_16x16x32_bf16 v[184:187], a[124:127], v[116:119], v[184:187]
buffer_store_dwordx4 v[144:147], v1, s[4:7], s76 offen offset:1024 sc1
v_mfma_f32_16x16x32_bf16 v[188:191], a[124:127], v[124:127], v[188:191]
ds_read_b128 a[92:95], v2 offset:56320
v_cvt_pk_bf16_f32 v148, v148, v149
v_mfma_f32_16x16x32_bf16 v[188:191], a[120:123], v[120:123], v[188:191]
s_waitcnt lgkmcnt(7)
v_cvt_pk_bf16_f32 v149, v150, v151
v_cvt_pk_bf16_f32 v150, v156, v157
v_mfma_f32_16x16x32_bf16 v[192:195], a[64:67], v[112:115], v[192:195]
s_waitcnt lgkmcnt(6)
ds_read_b128 a[96:99], v2 offset:57344
v_cvt_pk_bf16_f32 v151, v158, v159
v_mfma_f32_16x16x32_bf16 v[192:195], a[68:71], v[116:119], v[192:195]
buffer_store_dwordx4 v[148:151], v1, s[4:7], s77 offen offset:1024 sc1
v_mfma_f32_16x16x32_bf16 v[196:199], a[68:71], v[124:127], v[196:199]
ds_read_b128 a[100:103], v2 offset:58368
v_cvt_pk_bf16_f32 v160, v160, v161
v_mfma_f32_16x16x32_bf16 v[196:199], a[64:67], v[120:123], v[196:199]
s_waitcnt lgkmcnt(7)
v_cvt_pk_bf16_f32 v161, v162, v163
v_cvt_pk_bf16_f32 v162, v168, v169
v_mfma_f32_16x16x32_bf16 v[200:203], a[72:75], v[112:115], v[200:203]
s_waitcnt lgkmcnt(6)
ds_read_b128 a[104:107], v2 offset:59392
v_cvt_pk_bf16_f32 v163, v170, v171
v_mfma_f32_16x16x32_bf16 v[200:203], a[76:79], v[116:119], v[200:203]
buffer_store_dwordx4 v[160:163], v1, s[4:7], s76 offen offset:2048 sc1
v_mfma_f32_16x16x32_bf16 v[204:207], a[76:79], v[124:127], v[204:207]
ds_read_b128 a[108:111], v2 offset:60416
v_cvt_pk_bf16_f32 v164, v164, v165
v_mfma_f32_16x16x32_bf16 v[204:207], a[72:75], v[120:123], v[204:207]
s_waitcnt lgkmcnt(7)
v_cvt_pk_bf16_f32 v165, v166, v167
v_cvt_pk_bf16_f32 v166, v172, v173
v_mfma_f32_16x16x32_bf16 v[208:211], a[80:83], v[112:115], v[208:211]
s_waitcnt lgkmcnt(6)
ds_read_b128 a[112:115], v2 offset:61440
v_cvt_pk_bf16_f32 v167, v174, v175
v_mfma_f32_16x16x32_bf16 v[208:211], a[84:87], v[116:119], v[208:211]
buffer_store_dwordx4 v[164:167], v1, s[4:7], s77 offen offset:2048 sc1
v_mfma_f32_16x16x32_bf16 v[212:215], a[84:87], v[124:127], v[212:215]
ds_read_b128 a[116:119], v2 offset:62464
v_cvt_pk_bf16_f32 v176, v176, v177
v_mfma_f32_16x16x32_bf16 v[212:215], a[80:83], v[120:123], v[212:215]
s_waitcnt lgkmcnt(7)
v_cvt_pk_bf16_f32 v177, v178, v179
v_cvt_pk_bf16_f32 v178, v184, v185
v_mfma_f32_16x16x32_bf16 v[216:219], a[88:91], v[112:115], v[216:219]
s_waitcnt lgkmcnt(6)
ds_read_b128 a[120:123], v2 offset:63488
v_cvt_pk_bf16_f32 v179, v186, v187
v_mfma_f32_16x16x32_bf16 v[216:219], a[92:95], v[116:119], v[216:219]
buffer_store_dwordx4 v[176:179], v1, s[4:7], s76 offen offset:3072 sc1
v_mfma_f32_16x16x32_bf16 v[220:223], a[92:95], v[124:127], v[220:223]
ds_read_b128 a[124:127], v2 offset:64512
v_cvt_pk_bf16_f32 v180, v180, v181
v_mfma_f32_16x16x32_bf16 v[220:223], a[88:91], v[120:123], v[220:223]
s_waitcnt lgkmcnt(7)
v_cvt_pk_bf16_f32 v181, v182, v183
v_cvt_pk_bf16_f32 v182, v188, v189
v_mfma_f32_16x16x32_bf16 v[224:227], a[96:99], v[112:115], v[224:227]
s_waitcnt lgkmcnt(6)
v_cvt_pk_bf16_f32 v183, v190, v191
v_accvgpr_mov_b32 a2, a194
v_mfma_f32_16x16x32_bf16 v[224:227], a[100:103], v[116:119], v[224:227]
s_waitcnt lgkmcnt(5)
buffer_store_dwordx4 v[180:183], v1, s[4:7], s77 offen offset:3072 sc1
v_mfma_f32_16x16x32_bf16 v[228:231], a[100:103], v[124:127], v[228:231]
s_add_u32 s76, s76, 4096
v_accvgpr_mov_b32 a3, a195
v_accvgpr_mov_b32 a4, a196
v_mfma_f32_16x16x32_bf16 v[228:231], a[96:99], v[120:123], v[228:231]
s_add_u32 s77, s77, 4096
v_cvt_pk_bf16_f32 v192, v192, v193
v_cvt_pk_bf16_f32 v193, v194, v195
v_mfma_f32_16x16x32_bf16 v[232:235], a[104:107], v[112:115], v[232:235]
s_waitcnt lgkmcnt(4)
v_cvt_pk_bf16_f32 v194, v200, v201
v_cvt_pk_bf16_f32 v195, v202, v203
v_mfma_f32_16x16x32_bf16 v[232:235], a[108:111], v[116:119], v[232:235]
buffer_store_dwordx4 v[192:195], v1, s[4:7], s76 offen offset:0 sc1
v_mfma_f32_16x16x32_bf16 v[236:239], a[108:111], v[124:127], v[236:239]
v_cvt_pk_bf16_f32 v196, v196, v197
v_cvt_pk_bf16_f32 v197, v198, v199
v_mfma_f32_16x16x32_bf16 v[236:239], a[104:107], v[120:123], v[236:239]
s_waitcnt lgkmcnt(3)
v_cvt_pk_bf16_f32 v198, v204, v205
v_cvt_pk_bf16_f32 v199, v206, v207
v_mfma_f32_16x16x32_bf16 v[240:243], a[112:115], v[112:115], v[240:243]
s_waitcnt lgkmcnt(2)
buffer_store_dwordx4 v[196:199], v1, s[4:7], s77 offen offset:0 sc1
v_mfma_f32_16x16x32_bf16 v[240:243], a[116:119], v[116:119], v[240:243]
v_cvt_pk_bf16_f32 v208, v208, v209
v_cvt_pk_bf16_f32 v209, v210, v211
v_mfma_f32_16x16x32_bf16 v[244:247], a[116:119], v[124:127], v[244:247]
v_cvt_pk_bf16_f32 v210, v216, v217
v_cvt_pk_bf16_f32 v211, v218, v219
v_mfma_f32_16x16x32_bf16 v[244:247], a[112:115], v[120:123], v[244:247]
s_waitcnt lgkmcnt(1)
buffer_store_dwordx4 v[208:211], v1, s[4:7], s76 offen offset:1024 sc1
v_mfma_f32_16x16x32_bf16 v[248:251], a[120:123], v[112:115], v[248:251]
s_waitcnt lgkmcnt(0)
v_cvt_pk_bf16_f32 v212, v212, v213
v_cvt_pk_bf16_f32 v213, v214, v215
v_mfma_f32_16x16x32_bf16 v[248:251], a[124:127], v[116:119], v[248:251]
v_cvt_pk_bf16_f32 v214, v220, v221
v_cvt_pk_bf16_f32 v215, v222, v223
v_mfma_f32_16x16x32_bf16 v[252:255], a[124:127], v[124:127], v[252:255]
buffer_store_dwordx4 v[212:215], v1, s[4:7], s77 offen offset:1024 sc1
v_mfma_f32_16x16x32_bf16 v[252:255], a[120:123], v[120:123], v[252:255]
v_cvt_pk_bf16_f32 v224, v224, v225
v_cvt_pk_bf16_f32 v225, v226, v227
v_accvgpr_mov_b32 a5, a197
v_accvgpr_mov_b32 a6, a198
v_accvgpr_mov_b32 a7, a199
v_accvgpr_mov_b32 a8, a200
v_accvgpr_mov_b32 a9, a201
v_accvgpr_mov_b32 a10, a202
v_accvgpr_mov_b32 a11, a203
v_accvgpr_mov_b32 a12, a204
v_cvt_pk_bf16_f32 v226, v232, v233
v_cvt_pk_bf16_f32 v227, v234, v235
buffer_store_dwordx4 v[224:227], v1, s[4:7], s76 offen offset:2048 sc1
v_cvt_pk_bf16_f32 v228, v228, v229
v_cvt_pk_bf16_f32 v229, v230, v231
v_cvt_pk_bf16_f32 v230, v236, v237
v_cvt_pk_bf16_f32 v231, v238, v239
buffer_store_dwordx4 v[228:231], v1, s[4:7], s77 offen offset:2048 sc1
v_cvt_pk_bf16_f32 v240, v240, v241
v_cvt_pk_bf16_f32 v241, v242, v243
v_cvt_pk_bf16_f32 v242, v248, v249
v_cvt_pk_bf16_f32 v243, v250, v251
buffer_store_dwordx4 v[240:243], v1, s[4:7], s76 offen offset:3072 sc1
v_cvt_pk_bf16_f32 v244, v244, v245
v_cvt_pk_bf16_f32 v245, v246, v247
v_cvt_pk_bf16_f32 v246, v252, v253
v_cvt_pk_bf16_f32 v247, v254, v255
buffer_store_dwordx4 v[244:247], v1, s[4:7], s77 offen offset:3072 sc1
v_accvgpr_mov_b32 a13, a205
v_accvgpr_mov_b32 a14, a206
v_accvgpr_mov_b32 a15, a207
v_accvgpr_mov_b32 a16, a208
v_accvgpr_mov_b32 a17, a209
v_accvgpr_mov_b32 a18, a210
v_accvgpr_mov_b32 a19, a211
v_accvgpr_mov_b32 a20, a212
v_accvgpr_mov_b32 a21, a213
v_accvgpr_mov_b32 a22, a214
v_accvgpr_mov_b32 a23, a215
v_accvgpr_mov_b32 a24, a216
v_accvgpr_mov_b32 a25, a217
v_accvgpr_mov_b32 a26, a218
v_accvgpr_mov_b32 a27, a219
v_accvgpr_mov_b32 a28, a220
v_accvgpr_mov_b32 a29, a221
v_accvgpr_mov_b32 a30, a222
v_accvgpr_mov_b32 a31, a223
v_accvgpr_mov_b32 a32, a224
v_accvgpr_mov_b32 a33, a225
v_accvgpr_mov_b32 a34, a226
v_accvgpr_mov_b32 a35, a227
v_accvgpr_mov_b32 a36, a228
v_accvgpr_mov_b32 a37, a229
v_accvgpr_mov_b32 a38, a230
v_accvgpr_mov_b32 a39, a231
v_accvgpr_mov_b32 a40, a232
v_accvgpr_mov_b32 a41, a233
v_accvgpr_mov_b32 a42, a234
v_accvgpr_mov_b32 a43, a235
v_accvgpr_mov_b32 a44, a236
v_accvgpr_mov_b32 a45, a237
v_accvgpr_mov_b32 a46, a238
v_accvgpr_mov_b32 a47, a239
v_accvgpr_mov_b32 a48, a240
v_accvgpr_mov_b32 a49, a241
v_accvgpr_mov_b32 a50, a242
v_accvgpr_mov_b32 a51, a243
v_accvgpr_mov_b32 a52, a244
v_accvgpr_mov_b32 a53, a245
v_accvgpr_mov_b32 a54, a246
v_accvgpr_mov_b32 a55, a247
v_accvgpr_mov_b32 a56, a248
v_accvgpr_mov_b32 a57, a249
v_accvgpr_mov_b32 a58, a250
v_accvgpr_mov_b32 a59, a251
v_accvgpr_mov_b32 a60, a252
v_accvgpr_mov_b32 a61, a253
v_accvgpr_mov_b32 a62, a254
v_accvgpr_mov_b32 a63, a255
s_mov_b32 s24, 0
s_mov_b32 s29, s21
s_mov_b32 s19, s21
v_mov_b64 v[128:129], 0
v_mov_b64 v[130:131], 0
v_mov_b64 v[132:133], 0
v_mov_b64 v[134:135], 0
v_mov_b64 v[136:137], 0
v_mov_b64 v[138:139], 0
v_mov_b64 v[140:141], 0
v_mov_b64 v[142:143], 0
v_mov_b64 v[144:145], 0
v_mov_b64 v[146:147], 0
v_mov_b64 v[148:149], 0
v_mov_b64 v[150:151], 0
v_mov_b64 v[152:153], 0
v_mov_b64 v[154:155], 0
v_mov_b64 v[156:157], 0
v_mov_b64 v[158:159], 0
v_mov_b64 v[160:161], 0
v_mov_b64 v[162:163], 0
v_mov_b64 v[164:165], 0
v_mov_b64 v[166:167], 0
v_mov_b64 v[168:169], 0
v_mov_b64 v[170:171], 0
v_mov_b64 v[172:173], 0
v_mov_b64 v[174:175], 0
v_mov_b64 v[176:177], 0
v_mov_b64 v[178:179], 0
v_mov_b64 v[180:181], 0
v_mov_b64 v[182:183], 0
v_mov_b64 v[184:185], 0
v_mov_b64 v[186:187], 0
v_mov_b64 v[188:189], 0
v_mov_b64 v[190:191], 0
v_mov_b64 v[192:193], 0
v_mov_b64 v[194:195], 0
v_mov_b64 v[196:197], 0
v_mov_b64 v[198:199], 0
v_mov_b64 v[200:201], 0
v_mov_b64 v[202:203], 0
v_mov_b64 v[204:205], 0
v_mov_b64 v[206:207], 0
v_mov_b64 v[208:209], 0
v_mov_b64 v[210:211], 0
v_mov_b64 v[212:213], 0
v_mov_b64 v[214:215], 0
v_mov_b64 v[216:217], 0
v_mov_b64 v[218:219], 0
v_mov_b64 v[220:221], 0
v_mov_b64 v[222:223], 0
v_mov_b64 v[224:225], 0
v_mov_b64 v[226:227], 0
v_mov_b64 v[228:229], 0
v_mov_b64 v[230:231], 0
v_mov_b64 v[232:233], 0
v_mov_b64 v[234:235], 0
v_mov_b64 v[236:237], 0
v_mov_b64 v[238:239], 0
v_mov_b64 v[240:241], 0
v_mov_b64 v[242:243], 0
v_mov_b64 v[244:245], 0
v_mov_b64 v[246:247], 0
v_mov_b64 v[248:249], 0
v_mov_b64 v[250:251], 0
v_mov_b64 v[252:253], 0
v_mov_b64 v[254:255], 0
v_mov_b64 v[24:25], 0
s_mov_b32 s71, s28
s_mov_b32 s84, 0
s_barrier
s_branch K2_item
Lstub_3:
s_call_b64 s[16:17], K2_slow1
s_branch Lback_4
Lstub_5:
s_call_b64 s[16:17], K2_slow0
s_branch Lback_6
Lstub_7:
s_call_b64 s[16:17], K2_slow1
s_branch Lback_8
Lstub_9:
s_call_b64 s[16:17], K2_slow0
s_branch Lback_10
Lstub_11:
s_call_b64 s[16:17], K2_slow2
s_branch Lback_12
Lstub_13:
s_call_b64 s[16:17], K2_slow2
s_branch Lback_14
Lstub_15:
s_call_b64 s[16:17], K2_slow1
s_branch Lback_16
K2_slow0:
s_nop 7
s_nop 7
v_max3_f32 v8, v32, v33, 0
v_max3_f32 v8, v34, v35, v8
v_max3_f32 v8, v40, v41, v8
v_max3_f32 v8, v42, v43, v8
v_max3_f32 v8, v48, v49, v8
v_max3_f32 v8, v50, v51, v8
v_max3_f32 v8, v56, v57, v8
v_max3_f32 v8, v58, v59, v8
v_mov_b32 v9, v8
s_nop 1
v_permlane16_swap_b32 v8, v9
v_max_f32 v8, v8, v9
v_mov_b32 v9, v8
s_nop 1
v_permlane32_swap_b32 v8, v9
v_max_f32 v8, v8, v9
v_exp_f32 v9, -v8
v_sub_f32 v16, v16, v8
v_sub_f32 v17, v17, v8
v_sub_f32 v18, v18, v8
v_sub_f32 v19, v19, v8
v_mul_f32 v24, v24, v9
v_mul_f32 v128, v128, v9
v_mul_f32 v129, v129, v9
v_mul_f32 v130, v130, v9
v_mul_f32 v131, v131, v9
v_mul_f32 v136, v136, v9
v_mul_f32 v137, v137, v9
v_mul_f32 v138, v138, v9
v_mul_f32 v139, v139, v9
v_mul_f32 v144, v144, v9
v_mul_f32 v145, v145, v9
v_mul_f32 v146, v146, v9
v_mul_f32 v147, v147, v9
v_mul_f32 v152, v152, v9
v_mul_f32 v153, v153, v9
v_mul_f32 v154, v154, v9
v_mul_f32 v155, v155, v9
v_mul_f32 v160, v160, v9
v_mul_f32 v161, v161, v9
v_mul_f32 v162, v162, v9
v_mul_f32 v163, v163, v9
v_mul_f32 v168, v168, v9
v_mul_f32 v169, v169, v9
v_mul_f32 v170, v170, v9
v_mul_f32 v171, v171, v9
v_mul_f32 v176, v176, v9
v_mul_f32 v177, v177, v9
v_mul_f32 v178, v178, v9
v_mul_f32 v179, v179, v9
v_mul_f32 v184, v184, v9
v_mul_f32 v185, v185, v9
v_mul_f32 v186, v186, v9
v_mul_f32 v187, v187, v9
v_mul_f32 v192, v192, v9
v_mul_f32 v193, v193, v9
v_mul_f32 v194, v194, v9
v_mul_f32 v195, v195, v9
v_mul_f32 v200, v200, v9
v_mul_f32 v201, v201, v9
v_mul_f32 v202, v202, v9
v_mul_f32 v203, v203, v9
v_mul_f32 v208, v208, v9
v_mul_f32 v209, v209, v9
v_mul_f32 v210, v210, v9
v_mul_f32 v211, v211, v9
v_mul_f32 v216, v216, v9
v_mul_f32 v217, v217, v9
v_mul_f32 v218, v218, v9
v_mul_f32 v219, v219, v9
v_mul_f32 v224, v224, v9
v_mul_f32 v225, v225, v9
v_mul_f32 v226, v226, v9
v_mul_f32 v227, v227, v9
v_mul_f32 v232, v232, v9
v_mul_f32 v233, v233, v9
v_mul_f32 v234, v234, v9
v_mul_f32 v235, v235, v9
v_mul_f32 v240, v240, v9
v_mul_f32 v241, v241, v9
v_mul_f32 v242, v242, v9
v_mul_f32 v243, v243, v9
v_mul_f32 v248, v248, v9
v_mul_f32 v249, v249, v9
v_mul_f32 v250, v250, v9
v_mul_f32 v251, v251, v9
v_sub_f32 v32, v32, v8
v_sub_f32 v33, v33, v8
v_sub_f32 v34, v34, v8
v_sub_f32 v35, v35, v8
v_sub_f32 v40, v40, v8
v_sub_f32 v41, v41, v8
v_sub_f32 v42, v42, v8
v_sub_f32 v43, v43, v8
v_sub_f32 v48, v48, v8
v_sub_f32 v49, v49, v8
v_sub_f32 v50, v50, v8
v_sub_f32 v51, v51, v8
v_sub_f32 v56, v56, v8
v_sub_f32 v57, v57, v8
v_sub_f32 v58, v58, v8
v_sub_f32 v59, v59, v8
v_sub_f32 v64, v64, v8
v_sub_f32 v65, v65, v8
v_sub_f32 v66, v66, v8
v_sub_f32 v67, v67, v8
v_sub_f32 v72, v72, v8
v_sub_f32 v73, v73, v8
v_sub_f32 v74, v74, v8
v_sub_f32 v75, v75, v8
v_sub_f32 v80, v80, v8
v_sub_f32 v81, v81, v8
v_sub_f32 v82, v82, v8
v_sub_f32 v83, v83, v8
v_sub_f32 v88, v88, v8
v_sub_f32 v89, v89, v8
v_sub_f32 v90, v90, v8
v_sub_f32 v91, v91, v8
v_max3_f32 v8, v36, v37, 0
v_max3_f32 v8, v38, v39, v8
v_max3_f32 v8, v44, v45, v8
v_max3_f32 v8, v46, v47, v8
v_max3_f32 v8, v52, v53, v8
v_max3_f32 v8, v54, v55, v8
v_max3_f32 v8, v60, v61, v8
v_max3_f32 v8, v62, v63, v8
v_mov_b32 v9, v8
s_nop 1
v_permlane16_swap_b32 v8, v9
v_max_f32 v8, v8, v9
v_mov_b32 v9, v8
s_nop 1
v_permlane32_swap_b32 v8, v9
v_max_f32 v8, v8, v9
v_exp_f32 v9, -v8
v_sub_f32 v20, v20, v8
v_sub_f32 v21, v21, v8
v_sub_f32 v22, v22, v8
v_sub_f32 v23, v23, v8
v_mul_f32 v25, v25, v9
v_mul_f32 v132, v132, v9
v_mul_f32 v133, v133, v9
v_mul_f32 v134, v134, v9
v_mul_f32 v135, v135, v9
v_mul_f32 v140, v140, v9
v_mul_f32 v141, v141, v9
v_mul_f32 v142, v142, v9
v_mul_f32 v143, v143, v9
v_mul_f32 v148, v148, v9
v_mul_f32 v149, v149, v9
v_mul_f32 v150, v150, v9
v_mul_f32 v151, v151, v9
v_mul_f32 v156, v156, v9
v_mul_f32 v157, v157, v9
v_mul_f32 v158, v158, v9
v_mul_f32 v159, v159, v9
v_mul_f32 v164, v164, v9
v_mul_f32 v165, v165, v9
v_mul_f32 v166, v166, v9
v_mul_f32 v167, v167, v9
v_mul_f32 v172, v172, v9
v_mul_f32 v173, v173, v9
v_mul_f32 v174, v174, v9
v_mul_f32 v175, v175, v9
v_mul_f32 v180, v180, v9
v_mul_f32 v181, v181, v9
v_mul_f32 v182, v182, v9
v_mul_f32 v183, v183, v9
v_mul_f32 v188, v188, v9
v_mul_f32 v189, v189, v9
v_mul_f32 v190, v190, v9
v_mul_f32 v191, v191, v9
v_mul_f32 v196, v196, v9
v_mul_f32 v197, v197, v9
v_mul_f32 v198, v198, v9
v_mul_f32 v199, v199, v9
v_mul_f32 v204, v204, v9
v_mul_f32 v205, v205, v9
v_mul_f32 v206, v206, v9
v_mul_f32 v207, v207, v9
v_mul_f32 v212, v212, v9
v_mul_f32 v213, v213, v9
v_mul_f32 v214, v214, v9
v_mul_f32 v215, v215, v9
v_mul_f32 v220, v220, v9
v_mul_f32 v221, v221, v9
v_mul_f32 v222, v222, v9
v_mul_f32 v223, v223, v9
v_mul_f32 v228, v228, v9
v_mul_f32 v229, v229, v9
v_mul_f32 v230, v230, v9
v_mul_f32 v231, v231, v9
v_mul_f32 v236, v236, v9
v_mul_f32 v237, v237, v9
v_mul_f32 v238, v238, v9
v_mul_f32 v239, v239, v9
v_mul_f32 v244, v244, v9
v_mul_f32 v245, v245, v9
v_mul_f32 v246, v246, v9
v_mul_f32 v247, v247, v9
v_mul_f32 v252, v252, v9
v_mul_f32 v253, v253, v9
v_mul_f32 v254, v254, v9
v_mul_f32 v255, v255, v9
v_sub_f32 v36, v36, v8
v_sub_f32 v37, v37, v8
v_sub_f32 v38, v38, v8
v_sub_f32 v39, v39, v8
v_sub_f32 v44, v44, v8
v_sub_f32 v45, v45, v8
v_sub_f32 v46, v46, v8
v_sub_f32 v47, v47, v8
v_sub_f32 v52, v52, v8
v_sub_f32 v53, v53, v8
v_sub_f32 v54, v54, v8
v_sub_f32 v55, v55, v8
v_sub_f32 v60, v60, v8
v_sub_f32 v61, v61, v8
v_sub_f32 v62, v62, v8
v_sub_f32 v63, v63, v8
v_sub_f32 v68, v68, v8
v_sub_f32 v69, v69, v8
v_sub_f32 v70, v70, v8
v_sub_f32 v71, v71, v8
v_sub_f32 v76, v76, v8
v_sub_f32 v77, v77, v8
v_sub_f32 v78, v78, v8
v_sub_f32 v79, v79, v8
v_sub_f32 v84, v84, v8
v_sub_f32 v85, v85, v8
v_sub_f32 v86, v86, v8
v_sub_f32 v87, v87, v8
v_sub_f32 v92, v92, v8
v_sub_f32 v93, v93, v8
v_sub_f32 v94, v94, v8
v_sub_f32 v95, v95, v8
v_exp_f32 v8, v32
v_exp_f32 v9, v33
v_exp_f32 v10, v34
v_exp_f32 v11, v35
s_nop 0
v_add_f32 v26, v8, v9
v_cvt_pk_bf16_f32 v96, v8, v9
v_add_f32 v26, v26, v10
v_add_f32 v26, v26, v11
v_cvt_pk_bf16_f32 v97, v10, v11
v_exp_f32 v12, v36
v_exp_f32 v13, v37
v_exp_f32 v14, v38
v_exp_f32 v15, v39
s_nop 0
v_add_f32 v27, v12, v13
v_cvt_pk_bf16_f32 v104, v12, v13
v_add_f32 v27, v27, v14
v_add_f32 v27, v27, v15
v_cvt_pk_bf16_f32 v105, v14, v15
v_exp_f32 v8, v40
v_exp_f32 v9, v41
v_exp_f32 v10, v42
v_exp_f32 v11, v43
s_nop 0
v_add_f32 v26, v26, v8
v_add_f32 v26, v26, v9
v_cvt_pk_bf16_f32 v98, v8, v9
v_add_f32 v26, v26, v10
v_add_f32 v26, v26, v11
v_cvt_pk_bf16_f32 v99, v10, v11
v_exp_f32 v12, v44
v_exp_f32 v13, v45
v_exp_f32 v14, v46
v_exp_f32 v15, v47
s_nop 0
v_add_f32 v27, v27, v12
v_add_f32 v27, v27, v13
v_cvt_pk_bf16_f32 v106, v12, v13
v_add_f32 v27, v27, v14
v_add_f32 v27, v27, v15
v_cvt_pk_bf16_f32 v107, v14, v15
v_exp_f32 v8, v48
v_exp_f32 v9, v49
v_exp_f32 v10, v50
v_exp_f32 v11, v51
s_nop 0
v_add_f32 v26, v26, v8
v_add_f32 v26, v26, v9
v_cvt_pk_bf16_f32 v100, v8, v9
v_add_f32 v26, v26, v10
v_add_f32 v26, v26, v11
v_cvt_pk_bf16_f32 v101, v10, v11
v_exp_f32 v12, v52
v_exp_f32 v13, v53
v_exp_f32 v14, v54
v_exp_f32 v15, v55
s_nop 0
v_add_f32 v27, v27, v12
v_add_f32 v27, v27, v13
v_cvt_pk_bf16_f32 v108, v12, v13
v_add_f32 v27, v27, v14
v_add_f32 v27, v27, v15
v_cvt_pk_bf16_f32 v109, v14, v15
v_exp_f32 v8, v56
v_exp_f32 v9, v57
v_exp_f32 v10, v58
v_exp_f32 v11, v59
s_nop 0
v_add_f32 v26, v26, v8
v_add_f32 v26, v26, v9
v_cvt_pk_bf16_f32 v102, v8, v9
v_add_f32 v26, v26, v10
v_add_f32 v26, v26, v11
v_cvt_pk_bf16_f32 v103, v10, v11
v_exp_f32 v12, v60
v_exp_f32 v13, v61
v_exp_f32 v14, v62
v_exp_f32 v15, v63
s_nop 0
v_add_f32 v27, v27, v12
v_add_f32 v27, v27, v13
v_cvt_pk_bf16_f32 v110, v12, v13
v_add_f32 v27, v27, v14
v_add_f32 v27, v27, v15
v_cvt_pk_bf16_f32 v111, v14, v15
s_nop 1
s_setpc_b64 s[16:17]
K2_slow1:
s_nop 7
s_nop 7
v_max3_f32 v8, v64, v65, 0
v_max3_f32 v8, v66, v67, v8
v_max3_f32 v8, v72, v73, v8
v_max3_f32 v8, v74, v75, v8
v_max3_f32 v8, v80, v81, v8
v_max3_f32 v8, v82, v83, v8
v_max3_f32 v8, v88, v89, v8
v_max3_f32 v8, v90, v91, v8
v_mov_b32 v9, v8
s_nop 1
v_permlane16_swap_b32 v8, v9
v_max_f32 v8, v8, v9
v_mov_b32 v9, v8
s_nop 1
v_permlane32_swap_b32 v8, v9
v_max_f32 v8, v8, v9
v_exp_f32 v9, -v8
v_sub_f32 v16, v16, v8
v_sub_f32 v17, v17, v8
v_sub_f32 v18, v18, v8
v_sub_f32 v19, v19, v8
v_mul_f32 v24, v24, v9
v_mul_f32 v128, v128, v9
v_mul_f32 v129, v129, v9
v_mul_f32 v130, v130, v9
v_mul_f32 v131, v131, v9
v_mul_f32 v136, v136, v9
v_mul_f32 v137, v137, v9
v_mul_f32 v138, v138, v9
v_mul_f32 v139, v139, v9
v_mul_f32 v144, v144, v9
v_mul_f32 v145, v145, v9
v_mul_f32 v146, v146, v9
v_mul_f32 v147, v147, v9
v_mul_f32 v152, v152, v9
v_mul_f32 v153, v153, v9
v_mul_f32 v154, v154, v9
v_mul_f32 v155, v155, v9
v_mul_f32 v160, v160, v9
v_mul_f32 v161, v161, v9
v_mul_f32 v162, v162, v9
v_mul_f32 v163, v163, v9
v_mul_f32 v168, v168, v9
v_mul_f32 v169, v169, v9
v_mul_f32 v170, v170, v9
v_mul_f32 v171, v171, v9
v_mul_f32 v176, v176, v9
v_mul_f32 v177, v177, v9
v_mul_f32 v178, v178, v9
v_mul_f32 v179, v179, v9
v_mul_f32 v184, v184, v9
v_mul_f32 v185, v185, v9
v_mul_f32 v186, v186, v9
v_mul_f32 v187, v187, v9
v_mul_f32 v192, v192, v9
v_mul_f32 v193, v193, v9
v_mul_f32 v194, v194, v9
v_mul_f32 v195, v195, v9
v_mul_f32 v200, v200, v9
v_mul_f32 v201, v201, v9
v_mul_f32 v202, v202, v9
v_mul_f32 v203, v203, v9
v_mul_f32 v208, v208, v9
v_mul_f32 v209, v209, v9
v_mul_f32 v210, v210, v9
v_mul_f32 v211, v211, v9
v_mul_f32 v216, v216, v9
v_mul_f32 v217, v217, v9
v_mul_f32 v218, v218, v9
v_mul_f32 v219, v219, v9
v_mul_f32 v224, v224, v9
v_mul_f32 v225, v225, v9
v_mul_f32 v226, v226, v9
v_mul_f32 v227, v227, v9
v_mul_f32 v232, v232, v9
v_mul_f32 v233, v233, v9
v_mul_f32 v234, v234, v9
v_mul_f32 v235, v235, v9
v_mul_f32 v240, v240, v9
v_mul_f32 v241, v241, v9
v_mul_f32 v242, v242, v9
v_mul_f32 v243, v243, v9
v_mul_f32 v248, v248, v9
v_mul_f32 v249, v249, v9
v_mul_f32 v250, v250, v9
v_mul_f32 v251, v251, v9
v_sub_f32 v32, v32, v8
v_sub_f32 v33, v33, v8
v_sub_f32 v34, v34, v8
v_sub_f32 v35, v35, v8
v_sub_f32 v40, v40, v8
v_sub_f32 v41, v41, v8
v_sub_f32 v42, v42, v8
v_sub_f32 v43, v43, v8
v_sub_f32 v48, v48, v8
v_sub_f32 v49, v49, v8
v_sub_f32 v50, v50, v8
v_sub_f32 v51, v51, v8
v_sub_f32 v56, v56, v8
v_sub_f32 v57, v57, v8
v_sub_f32 v58, v58, v8
v_sub_f32 v59, v59, v8
v_sub_f32 v64, v64, v8
v_sub_f32 v65, v65, v8
v_sub_f32 v66, v66, v8
v_sub_f32 v67, v67, v8
v_sub_f32 v72, v72, v8
v_sub_f32 v73, v73, v8
v_sub_f32 v74, v74, v8
v_sub_f32 v75, v75, v8
v_sub_f32 v80, v80, v8
v_sub_f32 v81, v81, v8
v_sub_f32 v82, v82, v8
v_sub_f32 v83, v83, v8
v_sub_f32 v88, v88, v8
v_sub_f32 v89, v89, v8
v_sub_f32 v90, v90, v8
v_sub_f32 v91, v91, v8
v_max3_f32 v8, v68, v69, 0
v_max3_f32 v8, v70, v71, v8
v_max3_f32 v8, v76, v77, v8
v_max3_f32 v8, v78, v79, v8
v_max3_f32 v8, v84, v85, v8
v_max3_f32 v8, v86, v87, v8
v_max3_f32 v8, v92, v93, v8
v_max3_f32 v8, v94, v95, v8
v_mov_b32 v9, v8
s_nop 1
v_permlane16_swap_b32 v8, v9
v_max_f32 v8, v8, v9
v_mov_b32 v9, v8
s_nop 1
v_permlane32_swap_b32 v8, v9
v_max_f32 v8, v8, v9
v_exp_f32 v9, -v8
v_sub_f32 v20, v20, v8
v_sub_f32 v21, v21, v8
v_sub_f32 v22, v22, v8
v_sub_f32 v23, v23, v8
v_mul_f32 v25, v25, v9
v_mul_f32 v132, v132, v9
v_mul_f32 v133, v133, v9
v_mul_f32 v134, v134, v9
v_mul_f32 v135, v135, v9
v_mul_f32 v140, v140, v9
v_mul_f32 v141, v141, v9
v_mul_f32 v142, v142, v9
v_mul_f32 v143, v143, v9
v_mul_f32 v148, v148, v9
v_mul_f32 v149, v149, v9
v_mul_f32 v150, v150, v9
v_mul_f32 v151, v151, v9
v_mul_f32 v156, v156, v9
v_mul_f32 v157, v157, v9
v_mul_f32 v158, v158, v9
v_mul_f32 v159, v159, v9
v_mul_f32 v164, v164, v9
v_mul_f32 v165, v165, v9
v_mul_f32 v166, v166, v9
v_mul_f32 v167, v167, v9
v_mul_f32 v172, v172, v9
v_mul_f32 v173, v173, v9
v_mul_f32 v174, v174, v9
v_mul_f32 v175, v175, v9
v_mul_f32 v180, v180, v9
v_mul_f32 v181, v181, v9
v_mul_f32 v182, v182, v9
v_mul_f32 v183, v183, v9
v_mul_f32 v188, v188, v9
v_mul_f32 v189, v189, v9
v_mul_f32 v190, v190, v9
v_mul_f32 v191, v191, v9
v_mul_f32 v196, v196, v9
v_mul_f32 v197, v197, v9
v_mul_f32 v198, v198, v9
v_mul_f32 v199, v199, v9
v_mul_f32 v204, v204, v9
v_mul_f32 v205, v205, v9
v_mul_f32 v206, v206, v9
v_mul_f32 v207, v207, v9
v_mul_f32 v212, v212, v9
v_mul_f32 v213, v213, v9
v_mul_f32 v214, v214, v9
v_mul_f32 v215, v215, v9
v_mul_f32 v220, v220, v9
v_mul_f32 v221, v221, v9
v_mul_f32 v222, v222, v9
v_mul_f32 v223, v223, v9
v_mul_f32 v228, v228, v9
v_mul_f32 v229, v229, v9
v_mul_f32 v230, v230, v9
v_mul_f32 v231, v231, v9
v_mul_f32 v236, v236, v9
v_mul_f32 v237, v237, v9
v_mul_f32 v238, v238, v9
v_mul_f32 v239, v239, v9
v_mul_f32 v244, v244, v9
v_mul_f32 v245, v245, v9
v_mul_f32 v246, v246, v9
v_mul_f32 v247, v247, v9
v_mul_f32 v252, v252, v9
v_mul_f32 v253, v253, v9
v_mul_f32 v254, v254, v9
v_mul_f32 v255, v255, v9
v_sub_f32 v36, v36, v8
v_sub_f32 v37, v37, v8
v_sub_f32 v38, v38, v8
v_sub_f32 v39, v39, v8
v_sub_f32 v44, v44, v8
v_sub_f32 v45, v45, v8
v_sub_f32 v46, v46, v8
v_sub_f32 v47, v47, v8
v_sub_f32 v52, v52, v8
v_sub_f32 v53, v53, v8
v_sub_f32 v54, v54, v8
v_sub_f32 v55, v55, v8
v_sub_f32 v60, v60, v8
v_sub_f32 v61, v61, v8
v_sub_f32 v62, v62, v8
v_sub_f32 v63, v63, v8
v_sub_f32 v68, v68, v8
v_sub_f32 v69, v69, v8
v_sub_f32 v70, v70, v8
v_sub_f32 v71, v71, v8
v_sub_f32 v76, v76, v8
v_sub_f32 v77, v77, v8
v_sub_f32 v78, v78, v8
v_sub_f32 v79, v79, v8
v_sub_f32 v84, v84, v8
v_sub_f32 v85, v85, v8
v_sub_f32 v86, v86, v8
v_sub_f32 v87, v87, v8
v_sub_f32 v92, v92, v8
v_sub_f32 v93, v93, v8
v_sub_f32 v94, v94, v8
v_sub_f32 v95, v95, v8
v_exp_f32 v8, v64
v_exp_f32 v9, v65
v_exp_f32 v10, v66
v_exp_f32 v11, v67
s_nop 0
v_add_f32 v26, v8, v9
v_cvt_pk_bf16_f32 v112, v8, v9
v_add_f32 v26, v26, v10
v_add_f32 v26, v26, v11
v_cvt_pk_bf16_f32 v113, v10, v11
v_exp_f32 v12, v68
v_exp_f32 v13, v69
v_exp_f32 v14, v70
v_exp_f32 v15, v71
s_nop 0
v_add_f32 v27, v12, v13
v_cvt_pk_bf16_f32 v120, v12, v13
v_add_f32 v27, v27, v14
v_add_f32 v27, v27, v15
v_cvt_pk_bf16_f32 v121, v14, v15
v_exp_f32 v8, v72
v_exp_f32 v9, v73
v_exp_f32 v10, v74
v_exp_f32 v11, v75
s_nop 0
v_add_f32 v26, v26, v8
v_add_f32 v26, v26, v9
v_cvt_pk_bf16_f32 v114, v8, v9
v_add_f32 v26, v26, v10
v_add_f32 v26, v26, v11
v_cvt_pk_bf16_f32 v115, v10, v11
v_exp_f32 v12, v76
v_exp_f32 v13, v77
v_exp_f32 v14, v78
v_exp_f32 v15, v79
s_nop 0
v_add_f32 v27, v27, v12
v_add_f32 v27, v27, v13
v_cvt_pk_bf16_f32 v122, v12, v13
v_add_f32 v27, v27, v14
v_add_f32 v27, v27, v15
v_cvt_pk_bf16_f32 v123, v14, v15
v_exp_f32 v8, v80
v_exp_f32 v9, v81
v_exp_f32 v10, v82
v_exp_f32 v11, v83
s_nop 0
v_add_f32 v26, v26, v8
v_add_f32 v26, v26, v9
v_cvt_pk_bf16_f32 v116, v8, v9
v_add_f32 v26, v26, v10
v_add_f32 v26, v26, v11
v_cvt_pk_bf16_f32 v117, v10, v11
v_exp_f32 v12, v84
v_exp_f32 v13, v85
v_exp_f32 v14, v86
v_exp_f32 v15, v87
s_nop 0
v_add_f32 v27, v27, v12
v_add_f32 v27, v27, v13
v_cvt_pk_bf16_f32 v124, v12, v13
v_add_f32 v27, v27, v14
v_add_f32 v27, v27, v15
v_cvt_pk_bf16_f32 v125, v14, v15
v_exp_f32 v8, v88
v_exp_f32 v9, v89
v_exp_f32 v10, v90
v_exp_f32 v11, v91
s_nop 0
v_add_f32 v26, v26, v8
v_add_f32 v26, v26, v9
v_cvt_pk_bf16_f32 v118, v8, v9
v_add_f32 v26, v26, v10
v_add_f32 v26, v26, v11
v_cvt_pk_bf16_f32 v119, v10, v11
v_exp_f32 v12, v92
v_exp_f32 v13, v93
v_exp_f32 v14, v94
v_exp_f32 v15, v95
s_nop 0
v_add_f32 v27, v27, v12
v_add_f32 v27, v27, v13
v_cvt_pk_bf16_f32 v126, v12, v13
v_add_f32 v27, v27, v14
v_add_f32 v27, v27, v15
v_cvt_pk_bf16_f32 v127, v14, v15
s_nop 1
s_setpc_b64 s[16:17]
K2_slow2:
s_nop 7
s_nop 7
v_max3_f32 v8, v68, v69, 0
v_max3_f32 v8, v70, v71, v8
v_max3_f32 v8, v76, v77, v8
v_max3_f32 v8, v78, v79, v8
v_max3_f32 v8, v84, v85, v8
v_max3_f32 v8, v86, v87, v8
v_max3_f32 v8, v92, v93, v8
v_max3_f32 v8, v94, v95, v8
v_mov_b32 v9, v8
s_nop 1
v_permlane16_swap_b32 v8, v9
v_max_f32 v8, v8, v9
v_mov_b32 v9, v8
s_nop 1
v_permlane32_swap_b32 v8, v9
v_max_f32 v8, v8, v9
v_exp_f32 v9, -v8
v_sub_f32 v20, v20, v8
v_sub_f32 v21, v21, v8
v_sub_f32 v22, v22, v8
v_sub_f32 v23, v23, v8
v_mul_f32 v25, v25, v9
v_mul_f32 v132, v132, v9
v_mul_f32 v133, v133, v9
v_mul_f32 v134, v134, v9
v_mul_f32 v135, v135, v9
v_mul_f32 v140, v140, v9
v_mul_f32 v141, v141, v9
v_mul_f32 v142, v142, v9
v_mul_f32 v143, v143, v9
v_mul_f32 v148, v148, v9
v_mul_f32 v149, v149, v9
v_mul_f32 v150, v150, v9
v_mul_f32 v151, v151, v9
v_mul_f32 v156, v156, v9
v_mul_f32 v157, v157, v9
v_mul_f32 v158, v158, v9
v_mul_f32 v159, v159, v9
v_mul_f32 v164, v164, v9
v_mul_f32 v165, v165, v9
v_mul_f32 v166, v166, v9
v_mul_f32 v167, v167, v9
v_mul_f32 v172, v172, v9
v_mul_f32 v173, v173, v9
v_mul_f32 v174, v174, v9
v_mul_f32 v175, v175, v9
v_mul_f32 v180, v180, v9
v_mul_f32 v181, v181, v9
v_mul_f32 v182, v182, v9
v_mul_f32 v183, v183, v9
v_mul_f32 v188, v188, v9
v_mul_f32 v189, v189, v9
v_mul_f32 v190, v190, v9
v_mul_f32 v191, v191, v9
v_mul_f32 v196, v196, v9
v_mul_f32 v197, v197, v9
v_mul_f32 v198, v198, v9
v_mul_f32 v199, v199, v9
v_mul_f32 v204, v204, v9
v_mul_f32 v205, v205, v9
v_mul_f32 v206, v206, v9
v_mul_f32 v207, v207, v9
v_mul_f32 v212, v212, v9
v_mul_f32 v213, v213, v9
v_mul_f32 v214, v214, v9
v_mul_f32 v215, v215, v9
v_mul_f32 v220, v220, v9
v_mul_f32 v221, v221, v9
v_mul_f32 v222, v222, v9
v_mul_f32 v223, v223, v9
v_mul_f32 v228, v228, v9
v_mul_f32 v229, v229, v9
v_mul_f32 v230, v230, v9
v_mul_f32 v231, v231, v9
v_mul_f32 v236, v236, v9
v_mul_f32 v237, v237, v9
v_mul_f32 v238, v238, v9
v_mul_f32 v239, v239, v9
v_mul_f32 v244, v244, v9
v_mul_f32 v245, v245, v9
v_mul_f32 v246, v246, v9
v_mul_f32 v247, v247, v9
v_mul_f32 v252, v252, v9
v_mul_f32 v253, v253, v9
v_mul_f32 v254, v254, v9
v_mul_f32 v255, v255, v9
v_sub_f32 v68, v68, v8
v_sub_f32 v69, v69, v8
v_sub_f32 v70, v70, v8
v_sub_f32 v71, v71, v8
v_sub_f32 v76, v76, v8
v_sub_f32 v77, v77, v8
v_sub_f32 v78, v78, v8
v_sub_f32 v79, v79, v8
v_sub_f32 v84, v84, v8
v_sub_f32 v85, v85, v8
v_sub_f32 v86, v86, v8
v_sub_f32 v87, v87, v8
v_sub_f32 v92, v92, v8
v_sub_f32 v93, v93, v8
v_sub_f32 v94, v94, v8
v_sub_f32 v95, v95, v8
v_exp_f32 v8, v68
v_exp_f32 v9, v69
v_exp_f32 v10, v70
v_exp_f32 v11, v71
s_nop 0
v_add_f32 v27, v8, v9
v_cvt_pk_bf16_f32 v120, v8, v9
v_add_f32 v27, v27, v10
v_add_f32 v27, v27, v11
v_cvt_pk_bf16_f32 v121, v10, v11
v_exp_f32 v12, v76
v_exp_f32 v13, v77
v_exp_f32 v14, v78
v_exp_f32 v15, v79
s_nop 0
v_add_f32 v27, v27, v12
v_add_f32 v27, v27, v13
v_cvt_pk_bf16_f32 v122, v12, v13
v_add_f32 v27, v27, v14
v_add_f32 v27, v27, v15
v_cvt_pk_bf16_f32 v123, v14, v15
v_exp_f32 v8, v84
v_exp_f32 v9, v85
v_exp_f32 v10, v86
v_exp_f32 v11, v87
s_nop 0
v_add_f32 v27, v27, v8
v_add_f32 v27, v27, v9
v_cvt_pk_bf16_f32 v124, v8, v9
v_add_f32 v27, v27, v10
v_add_f32 v27, v27, v11
v_cvt_pk_bf16_f32 v125, v10, v11
v_exp_f32 v12, v92
v_exp_f32 v13, v93
v_exp_f32 v14, v94
v_exp_f32 v15, v95
s_nop 0
v_add_f32 v27, v27, v12
v_add_f32 v27, v27, v13
v_cvt_pk_bf16_f32 v126, v12, v13
v_add_f32 v27, v27, v14
v_add_f32 v27, v27, v15
v_cvt_pk_bf16_f32 v127, v14, v15
s_nop 1
s_setpc_b64 s[16:17]
M_cntspinK:
Lp_9801:
buffer_load_dword v245, off, s[60:63], 0 sc1
s_waitcnt vmcnt(0)
v_cmp_gt_u32 vcc, 0x100, v245
s_cbranch_vccz Lpd_9802
s_sleep 8
s_sub_u32 s101, s101, 1
s_cbranch_scc0 Lp_9801
s_mov_b32 s101, 0
Lpd_9802:
s_branch Lg_1
M_ppspinK:
Lp_9803:
buffer_load_dword v230, v231, s[4:7], s52 offen sc1
s_waitcnt vmcnt(0)
v_cmp_gt_u32 vcc, 1, v230
s_cbranch_vccz Lpd_9804
s_sleep 8
s_sub_u32 s101, s101, 1
s_cbranch_scc0 Lp_9803
s_mov_b32 s101, 0
Lpd_9804:
s_branch M_ppokK
M_cntspinV:
Lp_9805:
buffer_load_dword v245, off, s[60:63], 0 sc1
s_waitcnt vmcnt(0)
v_cmp_gt_u32 vcc, 0x100, v245
s_cbranch_vccz Lpd_9806
s_sleep 8
s_sub_u32 s101, s101, 1
s_cbranch_scc0 Lp_9805
s_mov_b32 s101, 0
Lpd_9806:
s_branch Lg_2
M_ppspinV:
Lp_9807:
buffer_load_dword v230, v231, s[4:7], s52 offen sc1
s_waitcnt vmcnt(0)
v_cmp_gt_u32 vcc, 1, v230
s_cbranch_vccz Lpd_9808
s_sleep 8
s_sub_u32 s101, s101, 1
s_cbranch_scc0 Lp_9807
s_mov_b32 s101, 0
Lpd_9808:
s_branch M_ppokV
M_end:
s_endpgm
.section .rodata,"a"
.p2align 6
.amdhsa_kernel concat_heads__ssm_conv_h3__compressed_kv_cla__prompt_kernel
  .amdhsa_next_free_vgpr 512
  .amdhsa_next_free_sgpr 102
  .amdhsa_accum_offset 256
  .amdhsa_group_segment_fixed_size 0
  .amdhsa_kernarg_size 120
  .amdhsa_user_sgpr_count 2
  .amdhsa_user_sgpr_kernarg_segment_ptr 1
  .amdhsa_system_sgpr_workgroup_id_x 1
  .amdhsa_float_denorm_mode_32 3
  .amdhsa_float_denorm_mode_16_64 3
  .amdhsa_ieee_mode 0
  .amdhsa_dx10_clamp 0
.end_amdhsa_kernel
```

```asm
; @launch grid=(256,1,1) block=(256,1,1) lds=163840
.amdgcn_target "amdgcn-amd-amdhsa--gfx950"
.text
.globl concat_heads__ssm_conv_h3__compressed_kv_cla__prompt_kernel
.p2align 8
.type concat_heads__ssm_conv_h3__compressed_kv_cla__prompt_kernel,@function
concat_heads__ssm_conv_h3__compressed_kv_cla__prompt_kernel:
s_cmp_ge_u32 s2, 256
s_cbranch_scc1 M_end
s_load_dwordx16 s[64:79], s[0:1], 0
s_load_dwordx8 s[80:87], s[0:1], 64
s_load_dwordx4 s[88:91], s[0:1], 96
s_load_dwordx2 s[92:93], s[0:1], 112
s_getpc_b64 s[58:59]
M_pc:
s_lshr_b32 s22, s2, 3
s_lshl_b32 s22, s22, 5
v_and_b32 v26, 31, v0
v_add_u32 v26, s22, v26
v_lshlrev_b32 v26, 7, v26
v_min_u32 v26, M_end-M_pc, v26
v_mov_b32 v27, s59
v_add_co_u32 v26, vcc, s58, v26
s_nop 1
v_addc_co_u32 v27, vcc, 0, v27, vcc
global_load_dword v21, v[26:27], off
v_lshrrev_b32 v28, 6, v0
v_and_b32 v29, 63, v0
v_lshlrev_b32 v1, 4, v29
v_readfirstlane_b32 s3, v28
s_and_b32 s20, s2, 7
s_lshl_b32 s20, s20, 1
s_bfe_u32 s22, s2, 0x10003
s_add_u32 s20, s20, s22
s_lshr_b32 s21, s2, 5
s_mov_b32 s101, 0x40000
v_lshrrev_b32 v26, 7, v1
v_lshrrev_b32 v27, 1, v26
v_lshlrev_b32 v27, 4, v27
v_and_b32 v28, 0x70, v1
v_xor_b32 v27, v27, v28
v_mul_u32_u24 v26, 2048, v26
v_add_u32 v12, v26, v27
v_xor_b32 v27, 64, v27
v_add_u32 v26, v26, v27
v_add_u32 v13, 15360, v26
v_add_u32 v14, 30720, v12
v_add_u32 v15, 46080, v26
v_lshrrev_b32 v26, 5, v29
v_and_b32 v27, 31, v29
s_and_b32 s22, s3, 1
s_lshl_b32 s22, s22, 2
v_or_b32 v28, s22, v26
v_lshlrev_b32 v28, 1, v28
v_xor_b32 v27, v27, v28
v_lshlrev_b32 v27, 4, v27
v_lshl_add_u32 v16, v26, 13, v27
v_xor_b32 v26, 64, v16
v_add_u32 v17, 15360, v26
v_add_u32 v18, 30720, v16
v_add_u32 v19, 46080, v26
s_lshl_b32 s28, s3, 13
s_lshl_b32 s29, s3, 12
s_lshl_b32 s24, s21, 19
s_lshl_b32 s22, s3, 17
s_add_u32 s24, s24, s22
s_add_u32 s25, s24, 65536
s_lshl_b32 s26, s3, 16
s_lshl_b32 s22, s20, 9
s_add_u32 s26, s26, s22
s_add_u32 s27, s26, 262144
s_mov_b32 s10, 4194304
s_mov_b32 s11, 0x20000
s_mov_b32 s14, 8388608
s_mov_b32 s15, 0x20000
v_and_b32 v30, 15, v29
v_lshrrev_b32 v31, 4, v29
v_lshrrev_b32 v26, 1, v30
v_xor_b32 v26, v31, v26
v_lshlrev_b32 v26, 4, v26
v_lshl_add_u32 v2, v30, 7, v26
s_lshr_b32 s22, s3, 1
s_lshl_b32 s22, s22, 14
v_add_u32 v2, s22, v2
v_xor_b32 v3, 64, v2
v_lshrrev_b32 v26, 2, v30
v_and_b32 v27, 1, v31
v_lshl_or_b32 v27, v27, 2, v26
v_lshl_add_u32 v26, v31, 3, v26
v_lshlrev_b32 v26, 9, v26
v_lshl_add_u32 v26, v27, 5, v26
v_and_b32 v27, 3, v29
v_lshl_add_u32 v26, v27, 3, v26
s_and_b32 s22, s3, 1
s_lshl_b32 s22, s22, 8
s_add_u32 s22, s22, 0x10000
v_xor_b32 v4, s22, v26
v_xor_b32 v5, 32, v4
v_xor_b32 v6, 64, v4
v_xor_b32 v7, 96, v4
v_xor_b32 v8, 128, v4
v_xor_b32 v9, 160, v4
v_xor_b32 v10, 192, v4
v_xor_b32 v11, 224, v4
s_mov_b32 s19, 0x20000
s_cmp_eq_u32 s3, 2
s_cbranch_scc1 M_pf2
s_cmp_lg_u32 s3, 0
s_cbranch_scc1 M_pf3
s_mov_b32 s18, 8388608
s_mov_b32 s51, 8388608
s_mov_b32 s47, 524288
s_mov_b32 s43, 524288
s_lshl_b32 s22, s21, 16
s_lshl_b32 s23, s20, 9
s_add_u32 s22, s22, s23
v_bfe_u32 v26, v29, 2, 3
v_lshl_add_u32 v26, v26, 13, s22
v_and_b32 v27, 3, v29
v_lshl_add_u32 v20, v27, 7, v26
v_lshrrev_b32 v27, 5, v29
v_lshl_add_u32 v22, v27, 19, v20
v_cmp_gt_u32 vcc, 32, v29
s_branch M_pfd
M_pf2:
s_mov_b32 s18, 4194304
s_mov_b32 s51, 2048
s_mov_b32 s47, 256
s_mov_b32 s43, 0
s_lshl_b32 s22, s2, 14
v_bfe_u32 v26, v29, 1, 3
v_lshl_add_u32 v26, v26, 11, s22
v_and_b32 v27, 1, v29
v_lshl_add_u32 v20, v27, 7, v26
v_bfe_u32 v27, v29, 4, 1
v_lshl_add_u32 v22, v27, 8, v20
v_cmp_gt_u32 vcc, 16, v29
s_branch M_pfd
M_pf3:
s_mov_b32 s18, 0
s_mov_b32 s51, 3112960
s_mov_b32 s47, 622592
s_mov_b32 s43, 0
s_mul_i32 s22, s2, 2432
v_lshl_add_u32 v20, v29, 7, s22
v_mov_b32 v22, v20
v_cmp_gt_u32 vcc, 19, v29
M_pfd:
v_mov_b32 v26, 3221225472
s_nop 0
v_cndmask_b32 v20, v26, v20, vcc
s_bitcmp1_b32 s2, 4
s_waitcnt lgkmcnt(0)
s_mov_b64 s[8:9], s[78:79]
s_cselect_b64 s[12:13], s[84:85], s[82:83]
s_add_u32 m0, s28, 0
s_nop 0
buffer_load_dwordx4 v12, s[8:11], s24 offen offset:0 lds
buffer_load_dwordx4 v13, s[8:11], s24 offen offset:1024 lds
buffer_load_dwordx4 v14, s[8:11], s24 offen offset:2048 lds
buffer_load_dwordx4 v15, s[8:11], s24 offen offset:3072 lds
s_add_u32 s24, s24, 128
s_add_u32 m0, s28, 4096
s_nop 0
buffer_load_dwordx4 v12, s[8:11], s25 offen offset:0 lds
buffer_load_dwordx4 v13, s[8:11], s25 offen offset:1024 lds
buffer_load_dwordx4 v14, s[8:11], s25 offen offset:2048 lds
buffer_load_dwordx4 v15, s[8:11], s25 offen offset:3072 lds
s_add_u32 s25, s25, 128
s_add_u32 m0, s29, 65536
s_nop 0
buffer_load_dwordx4 v16, s[12:15], s26 offen offset:0 lds
buffer_load_dwordx4 v17, s[12:15], s26 offen offset:1024 lds
buffer_load_dwordx4 v18, s[12:15], s26 offen offset:2048 lds
buffer_load_dwordx4 v19, s[12:15], s26 offen offset:3072 lds
s_add_u32 s26, s26, 524288
s_add_u32 m0, s29, 81920
s_nop 0
buffer_load_dwordx4 v16, s[12:15], s27 offen offset:0 lds
buffer_load_dwordx4 v17, s[12:15], s27 offen offset:1024 lds
buffer_load_dwordx4 v18, s[12:15], s27 offen offset:2048 lds
buffer_load_dwordx4 v19, s[12:15], s27 offen offset:3072 lds
s_add_u32 s27, s27, 524288
s_mov_b64 exec, 0
s_bfe_u32 s22, s2, 0x10004
s_lshl_b32 s22, s22, 2
s_add_u32 s22, s22, s3
s_cmp_lg_u32 s22, 0
s_cbranch_scc1 M_tw1
s_call_b64 s[98:99], PAD_0
s_call_b64 s[98:99], PAD_8
s_call_b64 s[98:99], PAD_12
s_call_b64 s[98:99], PAD_16
s_branch M_twd
M_tw1:
s_cmp_lg_u32 s22, 1
s_cbranch_scc1 M_tw2
s_call_b64 s[98:99], PAD_1
s_call_b64 s[98:99], PAD_9
s_call_b64 s[98:99], PAD_13
s_branch M_twd
M_tw2:
s_cmp_lg_u32 s22, 2
s_cbranch_scc1 M_tw3
s_call_b64 s[98:99], PAD_2
s_call_b64 s[98:99], PAD_6
s_call_b64 s[98:99], PAD_10
s_call_b64 s[98:99], PAD_14
s_branch M_twd
M_tw3:
s_cmp_lg_u32 s22, 3
s_cbranch_scc1 M_tw4
s_call_b64 s[98:99], PAD_3
s_call_b64 s[98:99], PAD_7
s_call_b64 s[98:99], PAD_11
s_call_b64 s[98:99], PAD_15
s_branch M_twd
M_tw4:
s_cmp_lg_u32 s22, 4
s_cbranch_scc1 M_tw5
s_call_b64 s[98:99], PAD_20
s_branch M_twd
M_tw5:
s_cmp_lg_u32 s22, 5
s_cbranch_scc1 M_tw6
s_call_b64 s[98:99], PAD_17
s_call_b64 s[98:99], PAD_9
s_branch M_twd
M_tw6:
s_cmp_lg_u32 s22, 6
s_cbranch_scc1 M_tw7
s_call_b64 s[98:99], PAD_18
s_call_b64 s[98:99], PAD_10
s_branch M_twd
M_tw7:
s_call_b64 s[98:99], PAD_19
s_call_b64 s[98:99], PAD_11
M_twd:
s_mov_b64 exec, -1
s_add_u32 m0, s28, 32768
s_nop 0
buffer_load_dwordx4 v12, s[8:11], s24 offen offset:0 lds
buffer_load_dwordx4 v13, s[8:11], s24 offen offset:1024 lds
buffer_load_dwordx4 v14, s[8:11], s24 offen offset:2048 lds
buffer_load_dwordx4 v15, s[8:11], s24 offen offset:3072 lds
s_add_u32 s24, s24, 128
s_add_u32 m0, s28, 36864
s_nop 0
buffer_load_dwordx4 v12, s[8:11], s25 offen offset:0 lds
buffer_load_dwordx4 v13, s[8:11], s25 offen offset:1024 lds
buffer_load_dwordx4 v14, s[8:11], s25 offen offset:2048 lds
buffer_load_dwordx4 v15, s[8:11], s25 offen offset:3072 lds
s_add_u32 s25, s25, 128
s_cmp_eq_u32 s3, 0
s_cselect_b64 s[16:17], s[12:13], s[8:9]
buffer_load_dword v21, v22, s[16:19], s43 offen
s_add_u32 s43, s43, s47
s_add_u32 s43, s43, s47
s_mov_b32 s4, s92
s_mov_b32 s5, s93
s_mov_b32 s6, 268435456
s_mov_b32 s7, 0x20000
s_cmp_eq_u32 s3, 3
s_cselect_b64 s[40:41], s[76:77], s[80:81]
s_cselect_b32 s42, 1835008, 0
s_cmp_eq_u32 s3, 1
s_cselect_b32 s42, 3670016, s42
s_cmp_eq_u32 s3, 3
s_cselect_b64 s[44:45], s[86:87], s[72:73]
s_cselect_b32 s46, 3670016, 0
s_cmp_eq_u32 s3, 1
s_cselect_b32 s46, 1835008, s46
s_cmp_eq_u32 s3, 2
s_cselect_b64 s[40:41], s[64:65], s[40:41]
s_cselect_b32 s42, 1835008, s42
s_waitcnt vmcnt(9)
s_barrier
ds_read_b64_tr_b16 a[128:129], v4 offset:0
ds_read_b64_tr_b16 a[130:131], v4 offset:2048
ds_read_b64_tr_b16 a[132:133], v4 offset:16384
ds_read_b64_tr_b16 a[134:135], v4 offset:18432
ds_read_b128 a[0:3], v2 offset:0
ds_read_b128 a[4:7], v3 offset:0
ds_read_b128 a[8:11], v2 offset:2048
ds_read_b128 a[12:15], v3 offset:2048
ds_read_b128 a[16:19], v2 offset:4096
ds_read_b128 a[20:23], v3 offset:4096
ds_read_b128 a[24:27], v2 offset:6144
ds_read_b128 a[28:31], v3 offset:6144
ds_read_b128 a[32:35], v2 offset:8192
ds_read_b128 a[36:39], v3 offset:8192
ds_read_b128 a[40:43], v2 offset:10240
ds_read_b128 a[44:47], v3 offset:10240
ds_read_b128 a[48:51], v2 offset:12288
ds_read_b128 a[52:55], v3 offset:12288
ds_read_b128 a[56:59], v2 offset:14336
ds_read_b128 a[60:63], v3 offset:14336
s_add_u32 m0, s29, 98304
s_nop 0
buffer_load_dwordx4 v16, s[12:15], s26 offen offset:0 lds
buffer_load_dwordx4 v17, s[12:15], s26 offen offset:1024 lds
buffer_load_dwordx4 v18, s[12:15], s26 offen offset:2048 lds
buffer_load_dwordx4 v19, s[12:15], s26 offen offset:3072 lds
s_add_u32 s26, s26, 524288
s_waitcnt lgkmcnt(0)
s_barrier
s_bitcmp1_b32 s2, 4
s_cbranch_scc1 M_V
s_branch M_K
M_tret:
s_setpc_b64 s[98:99]
.p2align 12
PAD_0:
s_cbranch_execz PAD_4
M_K:
v_mfma_f32_16x16x32_bf16 v[32:35], a[128:131], a[0:3], 0
s_add_u32 m0, s29, 114688
ds_read_b64_tr_b16 a[136:137], v5 offset:0
v_mfma_f32_16x16x32_bf16 v[32:35], a[132:135], a[4:7], v[32:35]
s_mov_b32 s32, 8192
buffer_load_dwordx4 v16, s[12:15], s27 offen offset:0 lds
v_mfma_f32_16x16x32_bf16 v[40:43], a[128:131], a[8:11], 0
s_mov_b32 s33, 8192
ds_read_b64_tr_b16 a[138:139], v5 offset:2048
v_mfma_f32_16x16x32_bf16 v[40:43], a[132:135], a[12:15], v[40:43]
s_mov_b32 s34, 8192
v_mfma_f32_16x16x32_bf16 v[48:51], a[128:131], a[16:19], 0
s_mov_b32 s35, 4294910976
ds_read_b64_tr_b16 a[140:141], v5 offset:16384
v_mfma_f32_16x16x32_bf16 v[48:51], a[132:135], a[20:23], v[48:51]
s_mov_b32 s36, 4294910976
buffer_load_dwordx4 v17, s[12:15], s27 offen offset:1024 lds
v_mfma_f32_16x16x32_bf16 v[56:59], a[128:131], a[24:27], 0
s_mov_b32 s30, 8
ds_read_b64_tr_b16 a[142:143], v5 offset:18432
v_mfma_f32_16x16x32_bf16 v[56:59], a[132:135], a[28:31], v[56:59]
s_mov_b32 s82, 3221225472
v_mfma_f32_16x16x32_bf16 v[64:67], a[128:131], a[32:35], 0
s_mul_hi_u32 s38, s2, 613566757
v_mfma_f32_16x16x32_bf16 v[64:67], a[132:135], a[36:39], v[64:67]
s_mul_i32 s39, s38, 7
buffer_load_dwordx4 v18, s[12:15], s27 offen offset:2048 lds
v_mfma_f32_16x16x32_bf16 v[72:75], a[128:131], a[40:43], 0
s_sub_u32 s39, s2, s39
v_mov_b32 v246, 0
v_mov_b32 v229, 0
v_mfma_f32_16x16x32_bf16 v[72:75], a[132:135], a[44:47], v[72:75]
v_mov_b32 v231, 0
v_mfma_f32_16x16x32_bf16 v[80:83], a[128:131], a[48:51], 0
s_mov_b32 s60, s90
v_mfma_f32_16x16x32_bf16 v[80:83], a[132:135], a[52:55], v[80:83]
s_mov_b32 s61, s91
buffer_load_dwordx4 v19, s[12:15], s27 offen offset:3072 lds
v_mfma_f32_16x16x32_bf16 v[88:91], a[128:131], a[56:59], 0
s_add_u32 s27, s27, 524288
v_mfma_f32_16x16x32_bf16 v[88:91], a[132:135], a[60:63], v[88:91]
s_waitcnt lgkmcnt(0)
s_mov_b32 s62, 256
v_mfma_f32_16x16x32_bf16 v[36:39], a[136:139], a[0:3], 0
s_add_u32 m0, s28, 0
ds_read_b64_tr_b16 a[128:129], v6 offset:0
v_mfma_f32_16x16x32_bf16 v[36:39], a[140:143], a[4:7], v[36:39]
s_mov_b32 s63, 0x20000
buffer_load_dwordx4 v12, s[8:11], s24 offen offset:0 lds
v_mfma_f32_16x16x32_bf16 v[44:47], a[136:139], a[8:11], 0
s_mul_hi_u32 s55, s2, 1431655766
ds_read_b64_tr_b16 a[130:131], v6 offset:2048
v_mfma_f32_16x16x32_bf16 v[44:47], a[140:143], a[12:15], v[44:47]
s_mul_i32 s55, s55, 3
v_mfma_f32_16x16x32_bf16 v[52:55], a[136:139], a[16:19], 0
s_sub_u32 s55, s2, s55
ds_read_b64_tr_b16 a[132:133], v6 offset:16384
v_mfma_f32_16x16x32_bf16 v[52:55], a[140:143], a[20:23], v[52:55]
s_add_u32 s55, s55, 5
buffer_load_dwordx4 v13, s[8:11], s24 offen offset:1024 lds
v_mfma_f32_16x16x32_bf16 v[60:63], a[136:139], a[24:27], 0
s_lshr_b32 s22, s2, 4
ds_read_b64_tr_b16 a[134:135], v6 offset:18432
v_mfma_f32_16x16x32_bf16 v[60:63], a[140:143], a[28:31], v[60:63]
s_lshl_b32 s23, s20, 5
v_mfma_f32_16x16x32_bf16 v[68:71], a[136:139], a[32:35], 0
s_add_u32 s23, s23, s22
v_mfma_f32_16x16x32_bf16 v[68:71], a[140:143], a[36:39], v[68:71]
s_lshl_b32 s23, s23, 2
buffer_load_dwordx4 v14, s[8:11], s24 offen offset:2048 lds
v_mfma_f32_16x16x32_bf16 v[76:79], a[136:139], a[40:43], 0
s_and_b32 s22, s2, 16
v_mfma_f32_16x16x32_bf16 v[76:79], a[140:143], a[44:47], v[76:79]
s_lshl_b32 s22, s22, 7
v_mfma_f32_16x16x32_bf16 v[84:87], a[136:139], a[48:51], 0
s_add_u32 s23, s23, s22
v_mov_b32 v28, 3221225472
v_writelane_b32 v28, s23, 0
v_mfma_f32_16x16x32_bf16 v[84:87], a[140:143], a[52:55], v[84:87]
s_add_u32 s56, s23, 16384
buffer_load_dwordx4 v15, s[8:11], s24 offen offset:3072 lds
v_mfma_f32_16x16x32_bf16 v[92:95], a[136:139], a[56:59], 0
s_add_u32 s24, s24, 128
v_writelane_b32 v28, s56, 1
v_mfma_f32_16x16x32_bf16 v[92:95], a[140:143], a[60:63], v[92:95]
s_waitcnt lgkmcnt(0)
s_add_u32 s56, s23, 4096
v_writelane_b32 v28, s56, 2
v_mfma_f32_16x16x32_bf16 v[96:99], a[128:131], a[0:3], 0
s_add_u32 m0, s28, 4096
ds_read_b64_tr_b16 a[136:137], v7 offset:0
v_mfma_f32_16x16x32_bf16 v[96:99], a[132:135], a[4:7], v[96:99]
s_sub_u32 s37, 15, s21
buffer_load_dwordx4 v12, s[8:11], s25 offen offset:0 lds
v_mfma_f32_16x16x32_bf16 v[104:107], a[128:131], a[8:11], 0
ds_read_b64_tr_b16 a[138:139], v7 offset:2048
v_mfma_f32_16x16x32_bf16 v[104:107], a[132:135], a[12:15], v[104:107]
v_mfma_f32_16x16x32_bf16 v[112:115], a[128:131], a[16:19], 0
ds_read_b64_tr_b16 a[140:141], v7 offset:16384
v_mfma_f32_16x16x32_bf16 v[112:115], a[132:135], a[20:23], v[112:115]
buffer_load_dwordx4 v13, s[8:11], s25 offen offset:1024 lds
v_mfma_f32_16x16x32_bf16 v[120:123], a[128:131], a[24:27], 0
ds_read_b64_tr_b16 a[142:143], v7 offset:18432
v_mfma_f32_16x16x32_bf16 v[120:123], a[132:135], a[28:31], v[120:123]
v_mfma_f32_16x16x32_bf16 v[128:131], a[128:131], a[32:35], 0
v_mfma_f32_16x16x32_bf16 v[128:131], a[132:135], a[36:39], v[128:131]
buffer_load_dwordx4 v14, s[8:11], s25 offen offset:2048 lds
v_mfma_f32_16x16x32_bf16 v[136:139], a[128:131], a[40:43], 0
v_mfma_f32_16x16x32_bf16 v[136:139], a[132:135], a[44:47], v[136:139]
v_mfma_f32_16x16x32_bf16 v[144:147], a[128:131], a[48:51], 0
v_mfma_f32_16x16x32_bf16 v[144:147], a[132:135], a[52:55], v[144:147]
buffer_load_dwordx4 v15, s[8:11], s25 offen offset:3072 lds
v_mfma_f32_16x16x32_bf16 v[152:155], a[128:131], a[56:59], 0
s_add_u32 s25, s25, 128
v_mfma_f32_16x16x32_bf16 v[152:155], a[132:135], a[60:63], v[152:155]
s_waitcnt vmcnt(17) lgkmcnt(0)
s_barrier
v_mfma_f32_16x16x32_bf16 v[100:103], a[136:139], a[0:3], 0
ds_read_b64_tr_b16 a[128:129], v8 offset:0
v_mfma_f32_16x16x32_bf16 v[100:103], a[140:143], a[4:7], v[100:103]
buffer_load_dword v21, v20, s[16:19], s43 offen
v_mfma_f32_16x16x32_bf16 v[108:111], a[136:139], a[8:11], 0
s_add_u32 s43, s43, s47
ds_read_b64_tr_b16 a[130:131], v8 offset:2048
v_mfma_f32_16x16x32_bf16 v[108:111], a[140:143], a[12:15], v[108:111]
s_cmp_ge_u32 s43, s51
v_mfma_f32_16x16x32_bf16 v[116:119], a[136:139], a[16:19], 0
s_cselect_b32 s43, 0, s43
ds_read_b64_tr_b16 a[132:133], v8 offset:16384
v_mfma_f32_16x16x32_bf16 v[116:119], a[140:143], a[20:23], v[116:119]
s_cselect_b32 s51, s42, s51
v_mfma_f32_16x16x32_bf16 v[124:127], a[136:139], a[24:27], 0
s_cselect_b64 s[16:17], s[40:41], s[16:17]
ds_read_b64_tr_b16 a[134:135], v8 offset:18432
v_mfma_f32_16x16x32_bf16 v[124:127], a[140:143], a[28:31], v[124:127]
s_cselect_b32 s18, s42, s18
v_mfma_f32_16x16x32_bf16 v[132:135], a[136:139], a[32:35], 0
s_cselect_b64 s[40:41], s[44:45], s[40:41]
ds_read_b128 a[64:67], v2 offset:32768
v_mfma_f32_16x16x32_bf16 v[132:135], a[140:143], a[36:39], v[132:135]
s_cselect_b32 s42, s46, s42
v_mfma_f32_16x16x32_bf16 v[140:143], a[136:139], a[40:43], 0
s_cselect_b32 s46, 0, s46
ds_read_b128 a[68:71], v3 offset:32768
v_mfma_f32_16x16x32_bf16 v[140:143], a[140:143], a[44:47], v[140:143]
ds_read_b128 a[72:75], v2 offset:34816
v_mfma_f32_16x16x32_bf16 v[148:151], a[136:139], a[48:51], 0
ds_read_b128 a[76:79], v3 offset:34816
v_mfma_f32_16x16x32_bf16 v[148:151], a[140:143], a[52:55], v[148:151]
buffer_load_dword v21, v20, s[16:19], s43 offen
v_mfma_f32_16x16x32_bf16 v[156:159], a[136:139], a[56:59], 0
s_add_u32 s43, s43, s47
ds_read_b128 a[80:83], v2 offset:36864
v_mfma_f32_16x16x32_bf16 v[156:159], a[140:143], a[60:63], v[156:159]
s_waitcnt lgkmcnt(4)
s_cmp_ge_u32 s43, s51
ds_read_b128 a[84:87], v3 offset:36864
v_mfma_f32_16x16x32_bf16 v[160:163], a[128:131], a[0:3], 0
s_cselect_b32 s43, 0, s43
ds_read_b64_tr_b16 a[136:137], v9 offset:0
v_mfma_f32_16x16x32_bf16 v[160:163], a[132:135], a[4:7], v[160:163]
s_cselect_b32 s51, s42, s51
v_mfma_f32_16x16x32_bf16 v[168:171], a[128:131], a[8:11], 0
s_cselect_b64 s[16:17], s[40:41], s[16:17]
ds_read_b64_tr_b16 a[138:139], v9 offset:2048
v_mfma_f32_16x16x32_bf16 v[168:171], a[132:135], a[12:15], v[168:171]
s_cselect_b32 s18, s42, s18
v_mfma_f32_16x16x32_bf16 v[176:179], a[128:131], a[16:19], 0
s_cselect_b64 s[40:41], s[44:45], s[40:41]
ds_read_b64_tr_b16 a[140:141], v9 offset:16384
v_mfma_f32_16x16x32_bf16 v[176:179], a[132:135], a[20:23], v[176:179]
s_cselect_b32 s42, s46, s42
v_mfma_f32_16x16x32_bf16 v[184:187], a[128:131], a[24:27], 0
s_cselect_b32 s46, 0, s46
ds_read_b64_tr_b16 a[142:143], v9 offset:18432
v_mfma_f32_16x16x32_bf16 v[184:187], a[132:135], a[28:31], v[184:187]
s_bitcmp1_b32 s2, 4
s_cselect_b32 s37, s21, s37
s_lshl_b32 s56, s37, 5
v_mfma_f32_16x16x32_bf16 v[192:195], a[128:131], a[32:35], 0
s_add_u32 s56, s56, s20
s_lshl_b32 s56, s56, 2
s_add_u32 s56, s56, 8192
v_mfma_f32_16x16x32_bf16 v[192:195], a[132:135], a[36:39], v[192:195]
v_writelane_b32 v28, s56, 3
v_mfma_f32_16x16x32_bf16 v[200:203], a[128:131], a[40:43], 0
s_add_u32 s56, s56, 2048
ds_read_b128 a[88:91], v2 offset:38912
v_writelane_b32 v28, s56, 6
v_mfma_f32_16x16x32_bf16 v[200:203], a[132:135], a[44:47], v[200:203]
s_lshl_b32 s56, s2, 2
s_add_u32 s56, s56, 12288
ds_read_b128 a[92:95], v3 offset:38912
v_mfma_f32_16x16x32_bf16 v[208:211], a[128:131], a[48:51], 0
s_waitcnt lgkmcnt(2)
ds_read_b128 a[96:99], v2 offset:40960
v_writelane_b32 v28, s56, 4
v_mfma_f32_16x16x32_bf16 v[208:211], a[132:135], a[52:55], v[208:211]
s_lshl_b32 s56, s39, 5
s_add_u32 s56, s56, s38
s_lshl_b32 s56, s56, 2
v_mfma_f32_16x16x32_bf16 v[216:219], a[128:131], a[56:59], 0
s_add_u32 s56, s56, 20480
s_cmp_lt_u32 s2, 224
ds_read_b128 a[100:103], v3 offset:40960
v_mfma_f32_16x16x32_bf16 v[216:219], a[132:135], a[60:63], v[216:219]
s_cselect_b32 s56, s56, 3221225472
ds_read_b128 a[104:107], v2 offset:43008
v_writelane_b32 v28, s56, 7
v_mfma_f32_16x16x32_bf16 v[164:167], a[136:139], a[0:3], 0
s_cmp_eq_u32 s3, 0
s_cselect_b32 s56, 94371840, 3221225472
ds_read_b64_tr_b16 a[128:129], v10 offset:0
v_mfma_f32_16x16x32_bf16 v[164:167], a[140:143], a[4:7], v[164:167]
buffer_store_dword v246, v28, s[4:7], s56 offen sc1
v_mfma_f32_16x16x32_bf16 v[172:175], a[136:139], a[8:11], 0
ds_read_b64_tr_b16 a[130:131], v10 offset:2048
v_mov_b32 v27, 1
v_mfma_f32_16x16x32_bf16 v[172:175], a[140:143], a[12:15], v[172:175]
v_cmp_eq_u32 vcc, 0, v0
v_mov_b32 v26, 3221225472
v_mfma_f32_16x16x32_bf16 v[180:183], a[136:139], a[16:19], 0
s_lshl_b32 s31, s20, 20
s_lshl_b32 s22, s21, 17
ds_read_b64_tr_b16 a[132:133], v10 offset:16384
v_mfma_f32_16x16x32_bf16 v[180:183], a[140:143], a[20:23], v[180:183]
v_cndmask_b32 v26, v26, v246, vcc
v_mfma_f32_16x16x32_bf16 v[188:191], a[136:139], a[24:27], 0
s_add_u32 s31, s31, s22
s_lshr_b32 s22, s3, 1
ds_read_b64_tr_b16 a[134:135], v10 offset:18432
v_mfma_f32_16x16x32_bf16 v[188:191], a[140:143], a[28:31], v[188:191]
s_lshl_b32 s22, s22, 16
s_add_u32 s31, s31, s22
s_and_b32 s22, s3, 1
v_mfma_f32_16x16x32_bf16 v[196:199], a[136:139], a[32:35], 0
s_lshl_b32 s22, s22, 12
s_add_u32 s31, s31, s22
v_mfma_f32_16x16x32_bf16 v[196:199], a[140:143], a[36:39], v[196:199]
v_mfma_f32_16x16x32_bf16 v[204:207], a[136:139], a[40:43], 0
ds_read_b128 a[108:111], v3 offset:43008
v_mfma_f32_16x16x32_bf16 v[204:207], a[140:143], a[44:47], v[204:207]
ds_read_b128 a[112:115], v2 offset:45056
v_mfma_f32_16x16x32_bf16 v[212:215], a[136:139], a[48:51], 0
ds_read_b128 a[116:119], v3 offset:45056
v_mfma_f32_16x16x32_bf16 v[212:215], a[140:143], a[52:55], v[212:215]
v_mfma_f32_16x16x32_bf16 v[220:223], a[136:139], a[56:59], 0
ds_read_b128 a[120:123], v2 offset:47104
v_mfma_f32_16x16x32_bf16 v[220:223], a[140:143], a[60:63], v[220:223]
s_waitcnt lgkmcnt(4)
ds_read_b128 a[124:127], v3 offset:47104
v_mfma_f32_16x16x32_bf16 a[192:195], a[128:131], a[0:3], 0
ds_read_b64_tr_b16 a[136:137], v11 offset:0
v_mfma_f32_16x16x32_bf16 a[192:195], a[132:135], a[4:7], a[192:195]
v_mfma_f32_16x16x32_bf16 a[200:203], a[128:131], a[8:11], 0
ds_read_b64_tr_b16 a[138:139], v11 offset:2048
v_mfma_f32_16x16x32_bf16 a[200:203], a[132:135], a[12:15], a[200:203]
v_mfma_f32_16x16x32_bf16 a[208:211], a[128:131], a[16:19], 0
ds_read_b64_tr_b16 a[140:141], v11 offset:16384
v_mfma_f32_16x16x32_bf16 a[208:211], a[132:135], a[20:23], a[208:211]
v_mfma_f32_16x16x32_bf16 a[216:219], a[128:131], a[24:27], 0
ds_read_b64_tr_b16 a[142:143], v11 offset:18432
v_mfma_f32_16x16x32_bf16 a[216:219], a[132:135], a[28:31], a[216:219]
v_mfma_f32_16x16x32_bf16 a[224:227], a[128:131], a[32:35], 0
v_mfma_f32_16x16x32_bf16 a[224:227], a[132:135], a[36:39], a[224:227]
v_mfma_f32_16x16x32_bf16 a[232:235], a[128:131], a[40:43], 0
v_mfma_f32_16x16x32_bf16 a[232:235], a[132:135], a[44:47], a[232:235]
v_mfma_f32_16x16x32_bf16 a[240:243], a[128:131], a[48:51], 0
v_mfma_f32_16x16x32_bf16 a[240:243], a[132:135], a[52:55], a[240:243]
v_mfma_f32_16x16x32_bf16 a[248:251], a[128:131], a[56:59], 0
v_mfma_f32_16x16x32_bf16 a[248:251], a[132:135], a[60:63], a[248:251]
s_waitcnt vmcnt(3) lgkmcnt(0)
s_barrier
v_mfma_f32_16x16x32_bf16 a[196:199], a[136:139], a[0:3], 0
s_add_u32 m0, s29, 65536
ds_read_b64_tr_b16 a[128:129], v4 offset:32768
v_mfma_f32_16x16x32_bf16 a[196:199], a[140:143], a[4:7], a[196:199]
buffer_load_dwordx4 v16, s[12:15], s26 offen offset:0 lds
v_mfma_f32_16x16x32_bf16 a[204:207], a[136:139], a[8:11], 0
ds_read_b64_tr_b16 a[130:131], v4 offset:34816
v_mfma_f32_16x16x32_bf16 a[204:207], a[140:143], a[12:15], a[204:207]
v_mfma_f32_16x16x32_bf16 a[212:215], a[136:139], a[16:19], 0
ds_read_b64_tr_b16 a[132:133], v4 offset:49152
v_mfma_f32_16x16x32_bf16 a[212:215], a[140:143], a[20:23], a[212:215]
buffer_load_dwordx4 v17, s[12:15], s26 offen offset:1024 lds
v_mfma_f32_16x16x32_bf16 a[220:223], a[136:139], a[24:27], 0
ds_read_b64_tr_b16 a[134:135], v4 offset:51200
v_mfma_f32_16x16x32_bf16 a[220:223], a[140:143], a[28:31], a[220:223]
v_mfma_f32_16x16x32_bf16 a[228:231], a[136:139], a[32:35], 0
v_mfma_f32_16x16x32_bf16 a[228:231], a[140:143], a[36:39], a[228:231]
buffer_load_dwordx4 v18, s[12:15], s26 offen offset:2048 lds
v_mfma_f32_16x16x32_bf16 a[236:239], a[136:139], a[40:43], 0
v_mfma_f32_16x16x32_bf16 a[236:239], a[140:143], a[44:47], a[236:239]
v_mfma_f32_16x16x32_bf16 a[244:247], a[136:139], a[48:51], 0
v_mfma_f32_16x16x32_bf16 a[244:247], a[140:143], a[52:55], a[244:247]
buffer_load_dwordx4 v19, s[12:15], s26 offen offset:3072 lds
v_mfma_f32_16x16x32_bf16 a[252:255], a[136:139], a[56:59], 0
s_add_u32 s26, s26, 524288
v_mfma_f32_16x16x32_bf16 a[252:255], a[140:143], a[60:63], a[252:255]
s_waitcnt lgkmcnt(0)
Lg_1:
v_mfma_f32_16x16x32_bf16 v[32:35], a[128:131], a[64:67], v[32:35]
s_add_u32 m0, s29, 81920
ds_read_b64_tr_b16 a[136:137], v5 offset:32768
v_mfma_f32_16x16x32_bf16 v[32:35], a[132:135], a[68:71], v[32:35]
buffer_load_dwordx4 v16, s[12:15], s27 offen offset:0 lds
v_mfma_f32_16x16x32_bf16 v[40:43], a[128:131], a[72:75], v[40:43]
ds_read_b64_tr_b16 a[138:139], v5 offset:34816
v_mfma_f32_16x16x32_bf16 v[40:43], a[132:135], a[76:79], v[40:43]
v_mfma_f32_16x16x32_bf16 v[48:51], a[128:131], a[80:83], v[48:51]
ds_read_b64_tr_b16 a[140:141], v5 offset:49152
v_mfma_f32_16x16x32_bf16 v[48:51], a[132:135], a[84:87], v[48:51]
buffer_load_dwordx4 v17, s[12:15], s27 offen offset:1024 lds
v_mfma_f32_16x16x32_bf16 v[56:59], a[128:131], a[88:91], v[56:59]
ds_read_b64_tr_b16 a[142:143], v5 offset:51200
v_mfma_f32_16x16x32_bf16 v[56:59], a[132:135], a[92:95], v[56:59]
v_mfma_f32_16x16x32_bf16 v[64:67], a[128:131], a[96:99], v[64:67]
ds_read_b128 a[0:3], v2 offset:0
v_mfma_f32_16x16x32_bf16 v[64:67], a[132:135], a[100:103], v[64:67]
buffer_load_dwordx4 v18, s[12:15], s27 offen offset:2048 lds
v_mfma_f32_16x16x32_bf16 v[72:75], a[128:131], a[104:107], v[72:75]
ds_read_b128 a[4:7], v3 offset:0
v_mfma_f32_16x16x32_bf16 v[72:75], a[132:135], a[108:111], v[72:75]
v_mfma_f32_16x16x32_bf16 v[80:83], a[128:131], a[112:115], v[80:83]
v_mfma_f32_16x16x32_bf16 v[80:83], a[132:135], a[116:119], v[80:83]
buffer_load_dwordx4 v19, s[12:15], s27 offen offset:3072 lds
v_mfma_f32_16x16x32_bf16 v[88:91], a[128:131], a[120:123], v[88:91]
s_add_u32 s27, s27, 524288
ds_read_b128 a[8:11], v2 offset:2048
v_mfma_f32_16x16x32_bf16 v[88:91], a[132:135], a[124:127], v[88:91]
s_waitcnt lgkmcnt(2)
v_mfma_f32_16x16x32_bf16 v[36:39], a[136:139], a[64:67], v[36:39]
s_add_u32 m0, s28, 32768
ds_read_b64_tr_b16 a[128:129], v6 offset:32768
v_mfma_f32_16x16x32_bf16 v[36:39], a[140:143], a[68:71], v[36:39]
buffer_load_dwordx4 v12, s[8:11], s24 offen offset:0 lds
v_mfma_f32_16x16x32_bf16 v[44:47], a[136:139], a[72:75], v[44:47]
ds_read_b64_tr_b16 a[130:131], v6 offset:34816
v_mfma_f32_16x16x32_bf16 v[44:47], a[140:143], a[76:79], v[44:47]
v_mfma_f32_16x16x32_bf16 v[52:55], a[136:139], a[80:83], v[52:55]
ds_read_b64_tr_b16 a[132:133], v6 offset:49152
v_mfma_f32_16x16x32_bf16 v[52:55], a[140:143], a[84:87], v[52:55]
buffer_load_dwordx4 v13, s[8:11], s24 offen offset:1024 lds
v_mfma_f32_16x16x32_bf16 v[60:63], a[136:139], a[88:91], v[60:63]
ds_read_b64_tr_b16 a[134:135], v6 offset:51200
v_mfma_f32_16x16x32_bf16 v[60:63], a[140:143], a[92:95], v[60:63]
v_mfma_f32_16x16x32_bf16 v[68:71], a[136:139], a[96:99], v[68:71]
ds_read_b128 a[12:15], v3 offset:2048
v_mfma_f32_16x16x32_bf16 v[68:71], a[140:143], a[100:103], v[68:71]
buffer_load_dwordx4 v14, s[8:11], s24 offen offset:2048 lds
v_mfma_f32_16x16x32_bf16 v[76:79], a[136:139], a[104:107], v[76:79]
v_mfma_f32_16x16x32_bf16 v[76:79], a[140:143], a[108:111], v[76:79]
v_mfma_f32_16x16x32_bf16 v[84:87], a[136:139], a[112:115], v[84:87]
ds_read_b128 a[16:19], v2 offset:4096
v_mfma_f32_16x16x32_bf16 v[84:87], a[140:143], a[116:119], v[84:87]
buffer_load_dwordx4 v15, s[8:11], s24 offen offset:3072 lds
v_mfma_f32_16x16x32_bf16 v[92:95], a[136:139], a[120:123], v[92:95]
s_add_u32 s24, s24, 128
ds_read_b128 a[20:23], v3 offset:4096
v_mfma_f32_16x16x32_bf16 v[92:95], a[140:143], a[124:127], v[92:95]
s_waitcnt lgkmcnt(2)
v_mfma_f32_16x16x32_bf16 v[96:99], a[128:131], a[64:67], v[96:99]
s_add_u32 m0, s28, 36864
ds_read_b64_tr_b16 a[136:137], v7 offset:32768
v_mfma_f32_16x16x32_bf16 v[96:99], a[132:135], a[68:71], v[96:99]
buffer_load_dwordx4 v12, s[8:11], s25 offen offset:0 lds
v_mfma_f32_16x16x32_bf16 v[104:107], a[128:131], a[72:75], v[104:107]
ds_read_b64_tr_b16 a[138:139], v7 offset:34816
v_mfma_f32_16x16x32_bf16 v[104:107], a[132:135], a[76:79], v[104:107]
v_mfma_f32_16x16x32_bf16 v[112:115], a[128:131], a[80:83], v[112:115]
ds_read_b64_tr_b16 a[140:141], v7 offset:49152
v_mfma_f32_16x16x32_bf16 v[112:115], a[132:135], a[84:87], v[112:115]
buffer_load_dwordx4 v13, s[8:11], s25 offen offset:1024 lds
v_mfma_f32_16x16x32_bf16 v[120:123], a[128:131], a[88:91], v[120:123]
ds_read_b64_tr_b16 a[142:143], v7 offset:51200
v_mfma_f32_16x16x32_bf16 v[120:123], a[132:135], a[92:95], v[120:123]
v_mfma_f32_16x16x32_bf16 v[128:131], a[128:131], a[96:99], v[128:131]
v_mfma_f32_16x16x32_bf16 v[128:131], a[132:135], a[100:103], v[128:131]
buffer_load_dwordx4 v14, s[8:11], s25 offen offset:2048 lds
v_mfma_f32_16x16x32_bf16 v[136:139], a[128:131], a[104:107], v[136:139]
ds_read_b128 a[24:27], v2 offset:6144
v_mfma_f32_16x16x32_bf16 v[136:139], a[132:135], a[108:111], v[136:139]
v_mfma_f32_16x16x32_bf16 v[144:147], a[128:131], a[112:115], v[144:147]
ds_read_b128 a[28:31], v3 offset:6144
v_mfma_f32_16x16x32_bf16 v[144:147], a[132:135], a[116:119], v[144:147]
buffer_load_dwordx4 v15, s[8:11], s25 offen offset:3072 lds
v_mfma_f32_16x16x32_bf16 v[152:155], a[128:131], a[120:123], v[152:155]
s_add_u32 s25, s25, 128
v_mfma_f32_16x16x32_bf16 v[152:155], a[132:135], a[124:127], v[152:155]
s_waitcnt lgkmcnt(2)
v_mfma_f32_16x16x32_bf16 v[100:103], a[136:139], a[64:67], v[100:103]
ds_read_b64_tr_b16 a[128:129], v8 offset:32768
v_mfma_f32_16x16x32_bf16 v[100:103], a[140:143], a[68:71], v[100:103]
buffer_load_dword v21, v20, s[16:19], s43 offen
v_mfma_f32_16x16x32_bf16 v[108:111], a[136:139], a[72:75], v[108:111]
s_add_u32 s43, s43, s47
ds_read_b64_tr_b16 a[130:131], v8 offset:34816
v_mfma_f32_16x16x32_bf16 v[108:111], a[140:143], a[76:79], v[108:111]
s_cmp_ge_u32 s43, s51
v_mfma_f32_16x16x32_bf16 v[116:119], a[136:139], a[80:83], v[116:119]
s_cselect_b32 s43, 0, s43
ds_read_b64_tr_b16 a[132:133], v8 offset:49152
v_mfma_f32_16x16x32_bf16 v[116:119], a[140:143], a[84:87], v[116:119]
s_cselect_b32 s51, s42, s51
v_mfma_f32_16x16x32_bf16 v[124:127], a[136:139], a[88:91], v[124:127]
s_cselect_b64 s[16:17], s[40:41], s[16:17]
ds_read_b64_tr_b16 a[134:135], v8 offset:51200
v_mfma_f32_16x16x32_bf16 v[124:127], a[140:143], a[92:95], v[124:127]
s_cselect_b32 s18, s42, s18
v_mfma_f32_16x16x32_bf16 v[132:135], a[136:139], a[96:99], v[132:135]
s_cselect_b64 s[40:41], s[44:45], s[40:41]
ds_read_b128 a[32:35], v2 offset:8192
v_mfma_f32_16x16x32_bf16 v[132:135], a[140:143], a[100:103], v[132:135]
s_cselect_b32 s42, s46, s42
v_mfma_f32_16x16x32_bf16 v[140:143], a[136:139], a[104:107], v[140:143]
s_cselect_b32 s46, 0, s46
v_mfma_f32_16x16x32_bf16 v[140:143], a[140:143], a[108:111], v[140:143]
s_cmp_eq_u32 s30, s55
v_mfma_f32_16x16x32_bf16 v[148:151], a[136:139], a[112:115], v[148:151]
s_cselect_b32 s22, 0, 3221225472
ds_read_b128 a[36:39], v3 offset:8192
v_mfma_f32_16x16x32_bf16 v[148:151], a[140:143], a[116:119], v[148:151]
s_sub_u32 s30, s30, 1
buffer_atomic_add v27, v26, s[60:63], s22 offen sc1
v_mfma_f32_16x16x32_bf16 v[156:159], a[136:139], a[120:123], v[156:159]
ds_read_b128 a[40:43], v2 offset:10240
v_mfma_f32_16x16x32_bf16 v[156:159], a[140:143], a[124:127], v[156:159]
s_waitcnt lgkmcnt(2)
v_mfma_f32_16x16x32_bf16 v[160:163], a[128:131], a[64:67], v[160:163]
ds_read_b64_tr_b16 a[136:137], v9 offset:32768
v_mfma_f32_16x16x32_bf16 v[160:163], a[132:135], a[68:71], v[160:163]
v_mfma_f32_16x16x32_bf16 v[168:171], a[128:131], a[72:75], v[168:171]
ds_read_b64_tr_b16 a[138:139], v9 offset:34816
v_mfma_f32_16x16x32_bf16 v[168:171], a[132:135], a[76:79], v[168:171]
v_mfma_f32_16x16x32_bf16 v[176:179], a[128:131], a[80:83], v[176:179]
ds_read_b64_tr_b16 a[140:141], v9 offset:49152
v_mfma_f32_16x16x32_bf16 v[176:179], a[132:135], a[84:87], v[176:179]
v_mfma_f32_16x16x32_bf16 v[184:187], a[128:131], a[88:91], v[184:187]
ds_read_b64_tr_b16 a[142:143], v9 offset:51200
v_mfma_f32_16x16x32_bf16 v[184:187], a[132:135], a[92:95], v[184:187]
v_mfma_f32_16x16x32_bf16 v[192:195], a[128:131], a[96:99], v[192:195]
v_mfma_f32_16x16x32_bf16 v[192:195], a[132:135], a[100:103], v[192:195]
v_mfma_f32_16x16x32_bf16 v[200:203], a[128:131], a[104:107], v[200:203]
ds_read_b128 a[44:47], v3 offset:10240
v_mfma_f32_16x16x32_bf16 v[200:203], a[132:135], a[108:111], v[200:203]
v_mfma_f32_16x16x32_bf16 v[208:211], a[128:131], a[112:115], v[208:211]
ds_read_b128 a[48:51], v2 offset:12288
v_mfma_f32_16x16x32_bf16 v[208:211], a[132:135], a[116:119], v[208:211]
v_mfma_f32_16x16x32_bf16 v[216:219], a[128:131], a[120:123], v[216:219]
v_mfma_f32_16x16x32_bf16 v[216:219], a[132:135], a[124:127], v[216:219]
s_waitcnt lgkmcnt(2)
v_mfma_f32_16x16x32_bf16 v[164:167], a[136:139], a[64:67], v[164:167]
ds_read_b64_tr_b16 a[128:129], v10 offset:32768
v_mfma_f32_16x16x32_bf16 v[164:167], a[140:143], a[68:71], v[164:167]
v_mfma_f32_16x16x32_bf16 v[172:175], a[136:139], a[72:75], v[172:175]
ds_read_b64_tr_b16 a[130:131], v10 offset:34816
v_mfma_f32_16x16x32_bf16 v[172:175], a[140:143], a[76:79], v[172:175]
v_mfma_f32_16x16x32_bf16 v[180:183], a[136:139], a[80:83], v[180:183]
ds_read_b64_tr_b16 a[132:133], v10 offset:49152
v_mfma_f32_16x16x32_bf16 v[180:183], a[140:143], a[84:87], v[180:183]
v_mfma_f32_16x16x32_bf16 v[188:191], a[136:139], a[88:91], v[188:191]
ds_read_b64_tr_b16 a[134:135], v10 offset:51200
v_mfma_f32_16x16x32_bf16 v[188:191], a[140:143], a[92:95], v[188:191]
v_mfma_f32_16x16x32_bf16 v[196:199], a[136:139], a[96:99], v[196:199]
ds_read_b128 a[52:55], v3 offset:12288
v_mfma_f32_16x16x32_bf16 v[196:199], a[140:143], a[100:103], v[196:199]
v_mfma_f32_16x16x32_bf16 v[204:207], a[136:139], a[104:107], v[204:207]
ds_read_b128 a[56:59], v2 offset:14336
v_mfma_f32_16x16x32_bf16 v[204:207], a[140:143], a[108:111], v[204:207]
v_mfma_f32_16x16x32_bf16 v[212:215], a[136:139], a[112:115], v[212:215]
v_mfma_f32_16x16x32_bf16 v[212:215], a[140:143], a[116:119], v[212:215]
v_mfma_f32_16x16x32_bf16 v[220:223], a[136:139], a[120:123], v[220:223]
ds_read_b128 a[60:63], v3 offset:14336
v_mfma_f32_16x16x32_bf16 v[220:223], a[140:143], a[124:127], v[220:223]
s_waitcnt lgkmcnt(2)
v_mfma_f32_16x16x32_bf16 a[192:195], a[128:131], a[64:67], a[192:195]
ds_read_b64_tr_b16 a[136:137], v11 offset:32768
v_mfma_f32_16x16x32_bf16 a[192:195], a[132:135], a[68:71], a[192:195]
v_mfma_f32_16x16x32_bf16 a[200:203], a[128:131], a[72:75], a[200:203]
ds_read_b64_tr_b16 a[138:139], v11 offset:34816
v_mfma_f32_16x16x32_bf16 a[200:203], a[132:135], a[76:79], a[200:203]
v_mfma_f32_16x16x32_bf16 a[208:211], a[128:131], a[80:83], a[208:211]
ds_read_b64_tr_b16 a[140:141], v11 offset:49152
v_mfma_f32_16x16x32_bf16 a[208:211], a[132:135], a[84:87], a[208:211]
v_mfma_f32_16x16x32_bf16 a[216:219], a[128:131], a[88:91], a[216:219]
ds_read_b64_tr_b16 a[142:143], v11 offset:51200
v_mfma_f32_16x16x32_bf16 a[216:219], a[132:135], a[92:95], a[216:219]
v_mfma_f32_16x16x32_bf16 a[224:227], a[128:131], a[96:99], a[224:227]
v_mfma_f32_16x16x32_bf16 a[224:227], a[132:135], a[100:103], a[224:227]
v_mfma_f32_16x16x32_bf16 a[232:235], a[128:131], a[104:107], a[232:235]
v_mfma_f32_16x16x32_bf16 a[232:235], a[132:135], a[108:111], a[232:235]
v_mfma_f32_16x16x32_bf16 a[240:243], a[128:131], a[112:115], a[240:243]
v_mfma_f32_16x16x32_bf16 a[240:243], a[132:135], a[116:119], a[240:243]
v_mfma_f32_16x16x32_bf16 a[248:251], a[128:131], a[120:123], a[248:251]
v_mfma_f32_16x16x32_bf16 a[248:251], a[132:135], a[124:127], a[248:251]
s_waitcnt vmcnt(2) lgkmcnt(0)
s_barrier
v_mfma_f32_16x16x32_bf16 a[196:199], a[136:139], a[64:67], a[196:199]
s_add_u32 m0, s29, 98304
ds_read_b64_tr_b16 a[128:129], v4 offset:0
v_mfma_f32_16x16x32_bf16 a[196:199], a[140:143], a[68:71], a[196:199]
buffer_load_dwordx4 v16, s[12:15], s26 offen offset:0 lds
v_mfma_f32_16x16x32_bf16 a[204:207], a[136:139], a[72:75], a[204:207]
ds_read_b64_tr_b16 a[130:131], v4 offset:2048
v_mfma_f32_16x16x32_bf16 a[204:207], a[140:143], a[76:79], a[204:207]
v_mfma_f32_16x16x32_bf16 a[212:215], a[136:139], a[80:83], a[212:215]
ds_read_b64_tr_b16 a[132:133], v4 offset:16384
v_mfma_f32_16x16x32_bf16 a[212:215], a[140:143], a[84:87], a[212:215]
buffer_load_dwordx4 v17, s[12:15], s26 offen offset:1024 lds
v_mfma_f32_16x16x32_bf16 a[220:223], a[136:139], a[88:91], a[220:223]
ds_read_b64_tr_b16 a[134:135], v4 offset:18432
v_mfma_f32_16x16x32_bf16 a[220:223], a[140:143], a[92:95], a[220:223]
v_mfma_f32_16x16x32_bf16 a[228:231], a[136:139], a[96:99], a[228:231]
v_mfma_f32_16x16x32_bf16 a[228:231], a[140:143], a[100:103], a[228:231]
buffer_load_dwordx4 v18, s[12:15], s26 offen offset:2048 lds
v_mfma_f32_16x16x32_bf16 a[236:239], a[136:139], a[104:107], a[236:239]
v_mfma_f32_16x16x32_bf16 a[236:239], a[140:143], a[108:111], a[236:239]
v_mfma_f32_16x16x32_bf16 a[244:247], a[136:139], a[112:115], a[244:247]
v_mfma_f32_16x16x32_bf16 a[244:247], a[140:143], a[116:119], a[244:247]
buffer_load_dwordx4 v19, s[12:15], s26 offen offset:3072 lds
v_mfma_f32_16x16x32_bf16 a[252:255], a[136:139], a[120:123], a[252:255]
s_add_u32 s26, s26, 524288
v_mfma_f32_16x16x32_bf16 a[252:255], a[140:143], a[124:127], a[252:255]
s_waitcnt lgkmcnt(0)
buffer_store_dword v27, v26, s[4:7], s82 offen sc1
v_mfma_f32_16x16x32_bf16 v[32:35], a[128:131], a[0:3], v[32:35]
s_add_u32 m0, s29, 114688
ds_read_b64_tr_b16 a[136:137], v5 offset:0
v_mfma_f32_16x16x32_bf16 v[32:35], a[132:135], a[4:7], v[32:35]
buffer_load_dwordx4 v16, s[12:15], s27 offen offset:0 lds
v_mfma_f32_16x16x32_bf16 v[40:43], a[128:131], a[8:11], v[40:43]
ds_read_b64_tr_b16 a[138:139], v5 offset:2048
v_mfma_f32_16x16x32_bf16 v[40:43], a[132:135], a[12:15], v[40:43]
v_mfma_f32_16x16x32_bf16 v[48:51], a[128:131], a[16:19], v[48:51]
ds_read_b64_tr_b16 a[140:141], v5 offset:16384
v_mfma_f32_16x16x32_bf16 v[48:51], a[132:135], a[20:23], v[48:51]
buffer_load_dwordx4 v17, s[12:15], s27 offen offset:1024 lds
v_mfma_f32_16x16x32_bf16 v[56:59], a[128:131], a[24:27], v[56:59]
ds_read_b64_tr_b16 a[142:143], v5 offset:18432
v_mfma_f32_16x16x32_bf16 v[56:59], a[132:135], a[28:31], v[56:59]
v_mfma_f32_16x16x32_bf16 v[64:67], a[128:131], a[32:35], v[64:67]
ds_read_b128 a[64:67], v2 offset:32768
v_mfma_f32_16x16x32_bf16 v[64:67], a[132:135], a[36:39], v[64:67]
buffer_load_dwordx4 v18, s[12:15], s27 offen offset:2048 lds
v_mfma_f32_16x16x32_bf16 v[72:75], a[128:131], a[40:43], v[72:75]
ds_read_b128 a[68:71], v3 offset:32768
v_mfma_f32_16x16x32_bf16 v[72:75], a[132:135], a[44:47], v[72:75]
v_mfma_f32_16x16x32_bf16 v[80:83], a[128:131], a[48:51], v[80:83]
v_mfma_f32_16x16x32_bf16 v[80:83], a[132:135], a[52:55], v[80:83]
buffer_load_dwordx4 v19, s[12:15], s27 offen offset:3072 lds
v_mfma_f32_16x16x32_bf16 v[88:91], a[128:131], a[56:59], v[88:91]
s_add_u32 s27, s27, 524288
ds_read_b128 a[72:75], v2 offset:34816
v_mfma_f32_16x16x32_bf16 v[88:91], a[132:135], a[60:63], v[88:91]
s_waitcnt lgkmcnt(2)
v_mfma_f32_16x16x32_bf16 v[36:39], a[136:139], a[0:3], v[36:39]
s_add_u32 m0, s28, 0
ds_read_b64_tr_b16 a[128:129], v6 offset:0
v_mfma_f32_16x16x32_bf16 v[36:39], a[140:143], a[4:7], v[36:39]
buffer_load_dwordx4 v12, s[8:11], s24 offen offset:0 lds
v_mfma_f32_16x16x32_bf16 v[44:47], a[136:139], a[8:11], v[44:47]
ds_read_b64_tr_b16 a[130:131], v6 offset:2048
v_mfma_f32_16x16x32_bf16 v[44:47], a[140:143], a[12:15], v[44:47]
PAD_1:
s_cbranch_execz PAD_5
v_mfma_f32_16x16x32_bf16 v[52:55], a[136:139], a[16:19], v[52:55]
ds_read_b64_tr_b16 a[132:133], v6 offset:16384
v_mfma_f32_16x16x32_bf16 v[52:55], a[140:143], a[20:23], v[52:55]
buffer_load_dwordx4 v13, s[8:11], s24 offen offset:1024 lds
v_mfma_f32_16x16x32_bf16 v[60:63], a[136:139], a[24:27], v[60:63]
ds_read_b64_tr_b16 a[134:135], v6 offset:18432
v_mfma_f32_16x16x32_bf16 v[60:63], a[140:143], a[28:31], v[60:63]
v_mfma_f32_16x16x32_bf16 v[68:71], a[136:139], a[32:35], v[68:71]
ds_read_b128 a[76:79], v3 offset:34816
v_mfma_f32_16x16x32_bf16 v[68:71], a[140:143], a[36:39], v[68:71]
buffer_load_dwordx4 v14, s[8:11], s24 offen offset:2048 lds
v_mfma_f32_16x16x32_bf16 v[76:79], a[136:139], a[40:43], v[76:79]
v_mfma_f32_16x16x32_bf16 v[76:79], a[140:143], a[44:47], v[76:79]
v_mfma_f32_16x16x32_bf16 v[84:87], a[136:139], a[48:51], v[84:87]
ds_read_b128 a[80:83], v2 offset:36864
v_mfma_f32_16x16x32_bf16 v[84:87], a[140:143], a[52:55], v[84:87]
buffer_load_dwordx4 v15, s[8:11], s24 offen offset:3072 lds
v_mfma_f32_16x16x32_bf16 v[92:95], a[136:139], a[56:59], v[92:95]
s_add_u32 s24, s24, 128
ds_read_b128 a[84:87], v3 offset:36864
v_mfma_f32_16x16x32_bf16 v[92:95], a[140:143], a[60:63], v[92:95]
s_waitcnt lgkmcnt(2)
v_mfma_f32_16x16x32_bf16 v[96:99], a[128:131], a[0:3], v[96:99]
s_add_u32 m0, s28, 4096
ds_read_b64_tr_b16 a[136:137], v7 offset:0
v_mfma_f32_16x16x32_bf16 v[96:99], a[132:135], a[4:7], v[96:99]
buffer_load_dwordx4 v12, s[8:11], s25 offen offset:0 lds
v_mfma_f32_16x16x32_bf16 v[104:107], a[128:131], a[8:11], v[104:107]
ds_read_b64_tr_b16 a[138:139], v7 offset:2048
v_mfma_f32_16x16x32_bf16 v[104:107], a[132:135], a[12:15], v[104:107]
v_mfma_f32_16x16x32_bf16 v[112:115], a[128:131], a[16:19], v[112:115]
ds_read_b64_tr_b16 a[140:141], v7 offset:16384
v_mfma_f32_16x16x32_bf16 v[112:115], a[132:135], a[20:23], v[112:115]
buffer_load_dwordx4 v13, s[8:11], s25 offen offset:1024 lds
v_mfma_f32_16x16x32_bf16 v[120:123], a[128:131], a[24:27], v[120:123]
ds_read_b64_tr_b16 a[142:143], v7 offset:18432
v_mfma_f32_16x16x32_bf16 v[120:123], a[132:135], a[28:31], v[120:123]
v_mfma_f32_16x16x32_bf16 v[128:131], a[128:131], a[32:35], v[128:131]
v_mfma_f32_16x16x32_bf16 v[128:131], a[132:135], a[36:39], v[128:131]
buffer_load_dwordx4 v14, s[8:11], s25 offen offset:2048 lds
v_mfma_f32_16x16x32_bf16 v[136:139], a[128:131], a[40:43], v[136:139]
ds_read_b128 a[88:91], v2 offset:38912
v_mfma_f32_16x16x32_bf16 v[136:139], a[132:135], a[44:47], v[136:139]
v_mfma_f32_16x16x32_bf16 v[144:147], a[128:131], a[48:51], v[144:147]
ds_read_b128 a[92:95], v3 offset:38912
v_mfma_f32_16x16x32_bf16 v[144:147], a[132:135], a[52:55], v[144:147]
buffer_load_dwordx4 v15, s[8:11], s25 offen offset:3072 lds
v_mfma_f32_16x16x32_bf16 v[152:155], a[128:131], a[56:59], v[152:155]
s_add_u32 s25, s25, 128
v_mfma_f32_16x16x32_bf16 v[152:155], a[132:135], a[60:63], v[152:155]
s_waitcnt lgkmcnt(2)
v_mfma_f32_16x16x32_bf16 v[100:103], a[136:139], a[0:3], v[100:103]
ds_read_b64_tr_b16 a[128:129], v8 offset:0
v_mfma_f32_16x16x32_bf16 v[100:103], a[140:143], a[4:7], v[100:103]
buffer_load_dword v21, v20, s[16:19], s43 offen
v_mfma_f32_16x16x32_bf16 v[108:111], a[136:139], a[8:11], v[108:111]
s_add_u32 s43, s43, s47
ds_read_b64_tr_b16 a[130:131], v8 offset:2048
v_mfma_f32_16x16x32_bf16 v[108:111], a[140:143], a[12:15], v[108:111]
s_cmp_ge_u32 s43, s51
v_mfma_f32_16x16x32_bf16 v[116:119], a[136:139], a[16:19], v[116:119]
s_cselect_b32 s43, 0, s43
ds_read_b64_tr_b16 a[132:133], v8 offset:16384
v_mfma_f32_16x16x32_bf16 v[116:119], a[140:143], a[20:23], v[116:119]
s_cselect_b32 s51, s42, s51
v_mfma_f32_16x16x32_bf16 v[124:127], a[136:139], a[24:27], v[124:127]
s_cselect_b64 s[16:17], s[40:41], s[16:17]
ds_read_b64_tr_b16 a[134:135], v8 offset:18432
v_mfma_f32_16x16x32_bf16 v[124:127], a[140:143], a[28:31], v[124:127]
s_cselect_b32 s18, s42, s18
v_mfma_f32_16x16x32_bf16 v[132:135], a[136:139], a[32:35], v[132:135]
s_cselect_b64 s[40:41], s[44:45], s[40:41]
ds_read_b128 a[96:99], v2 offset:40960
v_mfma_f32_16x16x32_bf16 v[132:135], a[140:143], a[36:39], v[132:135]
s_cselect_b32 s42, s46, s42
v_mfma_f32_16x16x32_bf16 v[140:143], a[136:139], a[40:43], v[140:143]
s_cselect_b32 s46, 0, s46
v_mfma_f32_16x16x32_bf16 v[140:143], a[140:143], a[44:47], v[140:143]
s_cmp_eq_u32 s30, s55
v_mfma_f32_16x16x32_bf16 v[148:151], a[136:139], a[48:51], v[148:151]
s_cselect_b32 s22, 0, 3221225472
ds_read_b128 a[100:103], v3 offset:40960
v_mfma_f32_16x16x32_bf16 v[148:151], a[140:143], a[52:55], v[148:151]
s_sub_u32 s30, s30, 1
buffer_atomic_add v27, v26, s[60:63], s22 offen sc1
v_mfma_f32_16x16x32_bf16 v[156:159], a[136:139], a[56:59], v[156:159]
ds_read_b128 a[104:107], v2 offset:43008
v_mfma_f32_16x16x32_bf16 v[156:159], a[140:143], a[60:63], v[156:159]
s_waitcnt lgkmcnt(2)
v_mfma_f32_16x16x32_bf16 v[160:163], a[128:131], a[0:3], v[160:163]
ds_read_b64_tr_b16 a[136:137], v9 offset:0
v_mfma_f32_16x16x32_bf16 v[160:163], a[132:135], a[4:7], v[160:163]
v_mfma_f32_16x16x32_bf16 v[168:171], a[128:131], a[8:11], v[168:171]
ds_read_b64_tr_b16 a[138:139], v9 offset:2048
v_mfma_f32_16x16x32_bf16 v[168:171], a[132:135], a[12:15], v[168:171]
v_mfma_f32_16x16x32_bf16 v[176:179], a[128:131], a[16:19], v[176:179]
ds_read_b64_tr_b16 a[140:141], v9 offset:16384
v_mfma_f32_16x16x32_bf16 v[176:179], a[132:135], a[20:23], v[176:179]
v_mfma_f32_16x16x32_bf16 v[184:187], a[128:131], a[24:27], v[184:187]
ds_read_b64_tr_b16 a[142:143], v9 offset:18432
v_mfma_f32_16x16x32_bf16 v[184:187], a[132:135], a[28:31], v[184:187]
v_mfma_f32_16x16x32_bf16 v[192:195], a[128:131], a[32:35], v[192:195]
v_mfma_f32_16x16x32_bf16 v[192:195], a[132:135], a[36:39], v[192:195]
v_mfma_f32_16x16x32_bf16 v[200:203], a[128:131], a[40:43], v[200:203]
ds_read_b128 a[108:111], v3 offset:43008
v_mfma_f32_16x16x32_bf16 v[200:203], a[132:135], a[44:47], v[200:203]
v_mfma_f32_16x16x32_bf16 v[208:211], a[128:131], a[48:51], v[208:211]
ds_read_b128 a[112:115], v2 offset:45056
v_mfma_f32_16x16x32_bf16 v[208:211], a[132:135], a[52:55], v[208:211]
v_mfma_f32_16x16x32_bf16 v[216:219], a[128:131], a[56:59], v[216:219]
v_mfma_f32_16x16x32_bf16 v[216:219], a[132:135], a[60:63], v[216:219]
s_waitcnt lgkmcnt(2)
v_mfma_f32_16x16x32_bf16 v[164:167], a[136:139], a[0:3], v[164:167]
ds_read_b64_tr_b16 a[128:129], v10 offset:0
v_mfma_f32_16x16x32_bf16 v[164:167], a[140:143], a[4:7], v[164:167]
v_mfma_f32_16x16x32_bf16 v[172:175], a[136:139], a[8:11], v[172:175]
ds_read_b64_tr_b16 a[130:131], v10 offset:2048
v_mfma_f32_16x16x32_bf16 v[172:175], a[140:143], a[12:15], v[172:175]
v_mfma_f32_16x16x32_bf16 v[180:183], a[136:139], a[16:19], v[180:183]
ds_read_b64_tr_b16 a[132:133], v10 offset:16384
v_mfma_f32_16x16x32_bf16 v[180:183], a[140:143], a[20:23], v[180:183]
v_mfma_f32_16x16x32_bf16 v[188:191], a[136:139], a[24:27], v[188:191]
ds_read_b64_tr_b16 a[134:135], v10 offset:18432
v_mfma_f32_16x16x32_bf16 v[188:191], a[140:143], a[28:31], v[188:191]
v_mfma_f32_16x16x32_bf16 v[196:199], a[136:139], a[32:35], v[196:199]
ds_read_b128 a[116:119], v3 offset:45056
v_mfma_f32_16x16x32_bf16 v[196:199], a[140:143], a[36:39], v[196:199]
v_mfma_f32_16x16x32_bf16 v[204:207], a[136:139], a[40:43], v[204:207]
ds_read_b128 a[120:123], v2 offset:47104
v_mfma_f32_16x16x32_bf16 v[204:207], a[140:143], a[44:47], v[204:207]
v_mfma_f32_16x16x32_bf16 v[212:215], a[136:139], a[48:51], v[212:215]
v_mfma_f32_16x16x32_bf16 v[212:215], a[140:143], a[52:55], v[212:215]
v_mfma_f32_16x16x32_bf16 v[220:223], a[136:139], a[56:59], v[220:223]
ds_read_b128 a[124:127], v3 offset:47104
v_mfma_f32_16x16x32_bf16 v[220:223], a[140:143], a[60:63], v[220:223]
s_waitcnt lgkmcnt(2)
v_mfma_f32_16x16x32_bf16 a[192:195], a[128:131], a[0:3], a[192:195]
ds_read_b64_tr_b16 a[136:137], v11 offset:0
v_mfma_f32_16x16x32_bf16 a[192:195], a[132:135], a[4:7], a[192:195]
v_mfma_f32_16x16x32_bf16 a[200:203], a[128:131], a[8:11], a[200:203]
ds_read_b64_tr_b16 a[138:139], v11 offset:2048
v_mfma_f32_16x16x32_bf16 a[200:203], a[132:135], a[12:15], a[200:203]
v_mfma_f32_16x16x32_bf16 a[208:211], a[128:131], a[16:19], a[208:211]
ds_read_b64_tr_b16 a[140:141], v11 offset:16384
v_mfma_f32_16x16x32_bf16 a[208:211], a[132:135], a[20:23], a[208:211]
v_mfma_f32_16x16x32_bf16 a[216:219], a[128:131], a[24:27], a[216:219]
ds_read_b64_tr_b16 a[142:143], v11 offset:18432
v_mfma_f32_16x16x32_bf16 a[216:219], a[132:135], a[28:31], a[216:219]
v_mfma_f32_16x16x32_bf16 a[224:227], a[128:131], a[32:35], a[224:227]
v_mfma_f32_16x16x32_bf16 a[224:227], a[132:135], a[36:39], a[224:227]
v_mfma_f32_16x16x32_bf16 a[232:235], a[128:131], a[40:43], a[232:235]
v_mfma_f32_16x16x32_bf16 a[232:235], a[132:135], a[44:47], a[232:235]
v_mfma_f32_16x16x32_bf16 a[240:243], a[128:131], a[48:51], a[240:243]
v_mfma_f32_16x16x32_bf16 a[240:243], a[132:135], a[52:55], a[240:243]
v_mfma_f32_16x16x32_bf16 a[248:251], a[128:131], a[56:59], a[248:251]
v_mfma_f32_16x16x32_bf16 a[248:251], a[132:135], a[60:63], a[248:251]
s_waitcnt vmcnt(2) lgkmcnt(0)
s_barrier
v_mfma_f32_16x16x32_bf16 a[196:199], a[136:139], a[0:3], a[196:199]
s_add_u32 m0, s29, 65536
ds_read_b64_tr_b16 a[128:129], v4 offset:32768
v_mfma_f32_16x16x32_bf16 a[196:199], a[140:143], a[4:7], a[196:199]
buffer_load_dwordx4 v16, s[12:15], s26 offen offset:0 lds
v_mfma_f32_16x16x32_bf16 a[204:207], a[136:139], a[8:11], a[204:207]
ds_read_b64_tr_b16 a[130:131], v4 offset:34816
v_mfma_f32_16x16x32_bf16 a[204:207], a[140:143], a[12:15], a[204:207]
v_mfma_f32_16x16x32_bf16 a[212:215], a[136:139], a[16:19], a[212:215]
ds_read_b64_tr_b16 a[132:133], v4 offset:49152
v_mfma_f32_16x16x32_bf16 a[212:215], a[140:143], a[20:23], a[212:215]
buffer_load_dwordx4 v17, s[12:15], s26 offen offset:1024 lds
v_mfma_f32_16x16x32_bf16 a[220:223], a[136:139], a[24:27], a[220:223]
ds_read_b64_tr_b16 a[134:135], v4 offset:51200
v_mfma_f32_16x16x32_bf16 a[220:223], a[140:143], a[28:31], a[220:223]
v_mfma_f32_16x16x32_bf16 a[228:231], a[136:139], a[32:35], a[228:231]
v_mfma_f32_16x16x32_bf16 a[228:231], a[140:143], a[36:39], a[228:231]
buffer_load_dwordx4 v18, s[12:15], s26 offen offset:2048 lds
v_mfma_f32_16x16x32_bf16 a[236:239], a[136:139], a[40:43], a[236:239]
v_mfma_f32_16x16x32_bf16 a[236:239], a[140:143], a[44:47], a[236:239]
v_mfma_f32_16x16x32_bf16 a[244:247], a[136:139], a[48:51], a[244:247]
v_mfma_f32_16x16x32_bf16 a[244:247], a[140:143], a[52:55], a[244:247]
buffer_load_dwordx4 v19, s[12:15], s26 offen offset:3072 lds
v_mfma_f32_16x16x32_bf16 a[252:255], a[136:139], a[56:59], a[252:255]
s_add_u32 s26, s26, 524288
v_mfma_f32_16x16x32_bf16 a[252:255], a[140:143], a[60:63], a[252:255]
s_waitcnt lgkmcnt(0)
s_bitcmp1_b32 s30, 1
s_cbranch_scc1 Lg_1
s_cmp_eq_u32 s30, 0
s_cbranch_scc1 Lg_1t
v_mfma_f32_16x16x32_bf16 v[32:35], a[128:131], a[64:67], v[32:35]
s_add_u32 m0, s29, 81920
ds_read_b64_tr_b16 a[136:137], v5 offset:32768
v_mfma_f32_16x16x32_bf16 v[32:35], a[132:135], a[68:71], v[32:35]
buffer_load_dwordx4 v16, s[12:15], s27 offen offset:0 lds
v_mfma_f32_16x16x32_bf16 v[40:43], a[128:131], a[72:75], v[40:43]
s_lshl_b32 s22, s38, 3
ds_read_b64_tr_b16 a[138:139], v5 offset:34816
v_mfma_f32_16x16x32_bf16 v[40:43], a[132:135], a[76:79], v[40:43]
s_lshl_b32 s23, s39, 5
v_and_b32 v252, 31, v0
v_lshrrev_b32 v253, 5, v0
v_mfma_f32_16x16x32_bf16 v[48:51], a[128:131], a[80:83], v[48:51]
ds_read_b64_tr_b16 a[140:141], v5 offset:49152
v_add_u32 v253, s22, v253
v_mfma_f32_16x16x32_bf16 v[48:51], a[132:135], a[84:87], v[48:51]
buffer_load_dwordx4 v17, s[12:15], s27 offen offset:1024 lds
v_mfma_f32_16x16x32_bf16 v[56:59], a[128:131], a[88:91], v[56:59]
ds_read_b64_tr_b16 a[142:143], v5 offset:51200
v_add_u32 v252, s23, v252
v_mfma_f32_16x16x32_bf16 v[56:59], a[132:135], a[92:95], v[56:59]
v_mul_u32_u24 v254, 7168, v253
v_lshl_add_u32 v254, v252, 2, v254
v_mfma_f32_16x16x32_bf16 v[64:67], a[128:131], a[96:99], v[64:67]
ds_read_b128 a[0:3], v2 offset:0
v_lshlrev_b32 v252, 4, v252
v_mfma_f32_16x16x32_bf16 v[64:67], a[132:135], a[100:103], v[64:67]
buffer_load_dwordx4 v18, s[12:15], s27 offen offset:2048 lds
v_mfma_f32_16x16x32_bf16 v[72:75], a[128:131], a[104:107], v[72:75]
ds_read_b128 a[4:7], v3 offset:0
v_add_u32 v255, 3584, v254
v_mfma_f32_16x16x32_bf16 v[72:75], a[132:135], a[108:111], v[72:75]
v_subrev_u32 v22, 3584, v254
v_subrev_u32 v23, 2688, v254
v_mfma_f32_16x16x32_bf16 v[80:83], a[128:131], a[112:115], v[80:83]
v_subrev_u32 v24, 1792, v254
v_subrev_u32 v25, 896, v254
v_mfma_f32_16x16x32_bf16 v[80:83], a[132:135], a[116:119], v[80:83]
buffer_load_dwordx4 v19, s[12:15], s27 offen offset:3072 lds
v_mfma_f32_16x16x32_bf16 v[88:91], a[128:131], a[120:123], v[88:91]
s_add_u32 s27, s27, 524288
ds_read_b128 a[8:11], v2 offset:2048
v_mfma_f32_16x16x32_bf16 v[88:91], a[132:135], a[124:127], v[88:91]
s_waitcnt lgkmcnt(2)
v_mfma_f32_16x16x32_bf16 v[36:39], a[136:139], a[64:67], v[36:39]
s_add_u32 m0, s28, 32768
ds_read_b64_tr_b16 a[128:129], v6 offset:32768
v_mfma_f32_16x16x32_bf16 v[36:39], a[140:143], a[68:71], v[36:39]
buffer_load_dwordx4 v12, s[8:11], s24 offen offset:0 lds
v_mfma_f32_16x16x32_bf16 v[44:47], a[136:139], a[72:75], v[44:47]
ds_read_b64_tr_b16 a[130:131], v6 offset:34816
v_mfma_f32_16x16x32_bf16 v[44:47], a[140:143], a[76:79], v[44:47]
v_mfma_f32_16x16x32_bf16 v[52:55], a[136:139], a[80:83], v[52:55]
ds_read_b64_tr_b16 a[132:133], v6 offset:49152
v_mfma_f32_16x16x32_bf16 v[52:55], a[140:143], a[84:87], v[52:55]
buffer_load_dwordx4 v13, s[8:11], s24 offen offset:1024 lds
v_mfma_f32_16x16x32_bf16 v[60:63], a[136:139], a[88:91], v[60:63]
ds_read_b64_tr_b16 a[134:135], v6 offset:51200
v_mfma_f32_16x16x32_bf16 v[60:63], a[140:143], a[92:95], v[60:63]
v_mfma_f32_16x16x32_bf16 v[68:71], a[136:139], a[96:99], v[68:71]
ds_read_b128 a[12:15], v3 offset:2048
v_mfma_f32_16x16x32_bf16 v[68:71], a[140:143], a[100:103], v[68:71]
buffer_load_dwordx4 v14, s[8:11], s24 offen offset:2048 lds
v_mfma_f32_16x16x32_bf16 v[76:79], a[136:139], a[104:107], v[76:79]
v_mfma_f32_16x16x32_bf16 v[76:79], a[140:143], a[108:111], v[76:79]
v_mfma_f32_16x16x32_bf16 v[84:87], a[136:139], a[112:115], v[84:87]
ds_read_b128 a[16:19], v2 offset:4096
v_mfma_f32_16x16x32_bf16 v[84:87], a[140:143], a[116:119], v[84:87]
buffer_load_dwordx4 v15, s[8:11], s24 offen offset:3072 lds
v_mfma_f32_16x16x32_bf16 v[92:95], a[136:139], a[120:123], v[92:95]
s_add_u32 s24, s24, 128
ds_read_b128 a[20:23], v3 offset:4096
v_mfma_f32_16x16x32_bf16 v[92:95], a[140:143], a[124:127], v[92:95]
s_waitcnt lgkmcnt(2)
v_mfma_f32_16x16x32_bf16 v[96:99], a[128:131], a[64:67], v[96:99]
s_add_u32 m0, s28, 36864
ds_read_b64_tr_b16 a[136:137], v7 offset:32768
v_mfma_f32_16x16x32_bf16 v[96:99], a[132:135], a[68:71], v[96:99]
buffer_load_dwordx4 v12, s[8:11], s25 offen offset:0 lds
v_mfma_f32_16x16x32_bf16 v[104:107], a[128:131], a[72:75], v[104:107]
ds_read_b64_tr_b16 a[138:139], v7 offset:34816
v_mfma_f32_16x16x32_bf16 v[104:107], a[132:135], a[76:79], v[104:107]
v_mfma_f32_16x16x32_bf16 v[112:115], a[128:131], a[80:83], v[112:115]
ds_read_b64_tr_b16 a[140:141], v7 offset:49152
v_mfma_f32_16x16x32_bf16 v[112:115], a[132:135], a[84:87], v[112:115]
buffer_load_dwordx4 v13, s[8:11], s25 offen offset:1024 lds
v_mfma_f32_16x16x32_bf16 v[120:123], a[128:131], a[88:91], v[120:123]
ds_read_b64_tr_b16 a[142:143], v7 offset:51200
v_mfma_f32_16x16x32_bf16 v[120:123], a[132:135], a[92:95], v[120:123]
v_mfma_f32_16x16x32_bf16 v[128:131], a[128:131], a[96:99], v[128:131]
v_mfma_f32_16x16x32_bf16 v[128:131], a[132:135], a[100:103], v[128:131]
buffer_load_dwordx4 v14, s[8:11], s25 offen offset:2048 lds
v_mfma_f32_16x16x32_bf16 v[136:139], a[128:131], a[104:107], v[136:139]
ds_read_b128 a[24:27], v2 offset:6144
v_mfma_f32_16x16x32_bf16 v[136:139], a[132:135], a[108:111], v[136:139]
v_mfma_f32_16x16x32_bf16 v[144:147], a[128:131], a[112:115], v[144:147]
ds_read_b128 a[28:31], v3 offset:6144
v_mfma_f32_16x16x32_bf16 v[144:147], a[132:135], a[116:119], v[144:147]
buffer_load_dwordx4 v15, s[8:11], s25 offen offset:3072 lds
v_mfma_f32_16x16x32_bf16 v[152:155], a[128:131], a[120:123], v[152:155]
s_add_u32 s25, s25, 128
v_mfma_f32_16x16x32_bf16 v[152:155], a[132:135], a[124:127], v[152:155]
s_waitcnt lgkmcnt(2)
v_mfma_f32_16x16x32_bf16 v[100:103], a[136:139], a[64:67], v[100:103]
s_mov_b64 s[56:57], s[70:71]
s_mov_b32 s58, 3584
s_mov_b32 s59, 0x20000
ds_read_b64_tr_b16 a[128:129], v8 offset:32768
buffer_load_dwordx4 v[248:251], v252, s[56:59], 0 offen
v_mfma_f32_16x16x32_bf16 v[100:103], a[140:143], a[68:71], v[100:103]
s_mov_b64 s[56:57], s[66:67]
s_mov_b32 s58, 1835008
buffer_load_dword v224, v22, s[56:59], 0 offen nt
v_mfma_f32_16x16x32_bf16 v[108:111], a[136:139], a[72:75], v[108:111]
ds_read_b64_tr_b16 a[130:131], v8 offset:34816
buffer_load_dword v225, v23, s[56:59], 0 offen nt
v_mfma_f32_16x16x32_bf16 v[108:111], a[140:143], a[76:79], v[108:111]
buffer_load_dword v226, v24, s[56:59], 0 offen nt
v_mfma_f32_16x16x32_bf16 v[116:119], a[136:139], a[80:83], v[116:119]
ds_read_b64_tr_b16 a[132:133], v8 offset:49152
buffer_load_dword v227, v25, s[56:59], 0 offen nt
v_mfma_f32_16x16x32_bf16 v[116:119], a[140:143], a[84:87], v[116:119]
buffer_load_dword v228, v254, s[56:59], 0 offen offset:0 nt
v_mfma_f32_16x16x32_bf16 v[124:127], a[136:139], a[88:91], v[124:127]
ds_read_b64_tr_b16 a[134:135], v8 offset:51200
buffer_load_dword v229, v254, s[56:59], 0 offen offset:896 nt
v_mfma_f32_16x16x32_bf16 v[124:127], a[140:143], a[92:95], v[124:127]
buffer_load_dword v230, v254, s[56:59], 0 offen offset:1792 nt
v_mfma_f32_16x16x32_bf16 v[132:135], a[136:139], a[96:99], v[132:135]
ds_read_b128 a[32:35], v2 offset:8192
buffer_load_dword v231, v254, s[56:59], 0 offen offset:2688 nt
v_mfma_f32_16x16x32_bf16 v[132:135], a[140:143], a[100:103], v[132:135]
buffer_load_dword v232, v255, s[56:59], 0 offen offset:0 nt
v_mfma_f32_16x16x32_bf16 v[140:143], a[136:139], a[104:107], v[140:143]
buffer_load_dword v233, v255, s[56:59], 0 offen offset:896 nt
v_mfma_f32_16x16x32_bf16 v[140:143], a[140:143], a[108:111], v[140:143]
buffer_load_dword v234, v255, s[56:59], 0 offen offset:1792 nt
v_mfma_f32_16x16x32_bf16 v[148:151], a[136:139], a[112:115], v[148:151]
ds_read_b128 a[36:39], v3 offset:8192
buffer_load_dword v235, v255, s[56:59], 0 offen offset:2688 nt
v_mfma_f32_16x16x32_bf16 v[148:151], a[140:143], a[116:119], v[148:151]
s_mov_b64 s[56:57], s[68:69]
buffer_load_dword v236, v25, s[56:59], 0 offen nt
v_mfma_f32_16x16x32_bf16 v[156:159], a[136:139], a[120:123], v[156:159]
ds_read_b128 a[40:43], v2 offset:10240
buffer_load_dword v237, v254, s[56:59], 0 offen offset:0 nt
v_mfma_f32_16x16x32_bf16 v[156:159], a[140:143], a[124:127], v[156:159]
s_waitcnt lgkmcnt(2)
buffer_load_dword v238, v254, s[56:59], 0 offen offset:896 nt
v_mfma_f32_16x16x32_bf16 v[160:163], a[128:131], a[64:67], v[160:163]
ds_read_b64_tr_b16 a[136:137], v9 offset:32768
buffer_load_dword v239, v254, s[56:59], 0 offen offset:1792 nt
v_mfma_f32_16x16x32_bf16 v[160:163], a[132:135], a[68:71], v[160:163]
buffer_load_dword v240, v254, s[56:59], 0 offen offset:2688 nt
v_mfma_f32_16x16x32_bf16 v[168:171], a[128:131], a[72:75], v[168:171]
ds_read_b64_tr_b16 a[138:139], v9 offset:34816
buffer_load_dword v241, v255, s[56:59], 0 offen offset:0 nt
v_mfma_f32_16x16x32_bf16 v[168:171], a[132:135], a[76:79], v[168:171]
buffer_load_dword v242, v255, s[56:59], 0 offen offset:896 nt
v_mfma_f32_16x16x32_bf16 v[176:179], a[128:131], a[80:83], v[176:179]
ds_read_b64_tr_b16 a[140:141], v9 offset:49152
buffer_load_dword v243, v255, s[56:59], 0 offen offset:1792 nt
v_mfma_f32_16x16x32_bf16 v[176:179], a[132:135], a[84:87], v[176:179]
buffer_load_dword v244, v255, s[56:59], 0 offen offset:2688 nt
v_mfma_f32_16x16x32_bf16 v[184:187], a[128:131], a[88:91], v[184:187]
ds_read_b64_tr_b16 a[142:143], v9 offset:51200
v_mfma_f32_16x16x32_bf16 v[184:187], a[132:135], a[92:95], v[184:187]
v_mfma_f32_16x16x32_bf16 v[192:195], a[128:131], a[96:99], v[192:195]
v_mfma_f32_16x16x32_bf16 v[192:195], a[132:135], a[100:103], v[192:195]
v_mfma_f32_16x16x32_bf16 v[200:203], a[128:131], a[104:107], v[200:203]
ds_read_b128 a[44:47], v3 offset:10240
v_mfma_f32_16x16x32_bf16 v[200:203], a[132:135], a[108:111], v[200:203]
v_mfma_f32_16x16x32_bf16 v[208:211], a[128:131], a[112:115], v[208:211]
ds_read_b128 a[48:51], v2 offset:12288
v_mfma_f32_16x16x32_bf16 v[208:211], a[132:135], a[116:119], v[208:211]
v_mfma_f32_16x16x32_bf16 v[216:219], a[128:131], a[120:123], v[216:219]
v_mfma_f32_16x16x32_bf16 v[216:219], a[132:135], a[124:127], v[216:219]
s_waitcnt lgkmcnt(2)
v_mfma_f32_16x16x32_bf16 v[164:167], a[136:139], a[64:67], v[164:167]
ds_read_b64_tr_b16 a[128:129], v10 offset:32768
v_mfma_f32_16x16x32_bf16 v[164:167], a[140:143], a[68:71], v[164:167]
v_mfma_f32_16x16x32_bf16 v[172:175], a[136:139], a[72:75], v[172:175]
ds_read_b64_tr_b16 a[130:131], v10 offset:34816
v_mfma_f32_16x16x32_bf16 v[172:175], a[140:143], a[76:79], v[172:175]
v_mfma_f32_16x16x32_bf16 v[180:183], a[136:139], a[80:83], v[180:183]
ds_read_b64_tr_b16 a[132:133], v10 offset:49152
v_mfma_f32_16x16x32_bf16 v[180:183], a[140:143], a[84:87], v[180:183]
v_mfma_f32_16x16x32_bf16 v[188:191], a[136:139], a[88:91], v[188:191]
ds_read_b64_tr_b16 a[134:135], v10 offset:51200
v_mfma_f32_16x16x32_bf16 v[188:191], a[140:143], a[92:95], v[188:191]
v_mfma_f32_16x16x32_bf16 v[196:199], a[136:139], a[96:99], v[196:199]
ds_read_b128 a[52:55], v3 offset:12288
v_mfma_f32_16x16x32_bf16 v[196:199], a[140:143], a[100:103], v[196:199]
v_mfma_f32_16x16x32_bf16 v[204:207], a[136:139], a[104:107], v[204:207]
ds_read_b128 a[56:59], v2 offset:14336
v_mfma_f32_16x16x32_bf16 v[204:207], a[140:143], a[108:111], v[204:207]
v_mfma_f32_16x16x32_bf16 v[212:215], a[136:139], a[112:115], v[212:215]
v_mfma_f32_16x16x32_bf16 v[212:215], a[140:143], a[116:119], v[212:215]
v_mfma_f32_16x16x32_bf16 v[220:223], a[136:139], a[120:123], v[220:223]
ds_read_b128 a[60:63], v3 offset:14336
v_mfma_f32_16x16x32_bf16 v[220:223], a[140:143], a[124:127], v[220:223]
s_waitcnt lgkmcnt(2)
v_mfma_f32_16x16x32_bf16 a[192:195], a[128:131], a[64:67], a[192:195]
ds_read_b64_tr_b16 a[136:137], v11 offset:32768
v_mfma_f32_16x16x32_bf16 a[192:195], a[132:135], a[68:71], a[192:195]
v_mfma_f32_16x16x32_bf16 a[200:203], a[128:131], a[72:75], a[200:203]
ds_read_b64_tr_b16 a[138:139], v11 offset:34816
v_mfma_f32_16x16x32_bf16 a[200:203], a[132:135], a[76:79], a[200:203]
v_mfma_f32_16x16x32_bf16 a[208:211], a[128:131], a[80:83], a[208:211]
ds_read_b64_tr_b16 a[140:141], v11 offset:49152
v_mfma_f32_16x16x32_bf16 a[208:211], a[132:135], a[84:87], a[208:211]
v_mfma_f32_16x16x32_bf16 a[216:219], a[128:131], a[88:91], a[216:219]
ds_read_b64_tr_b16 a[142:143], v11 offset:51200
v_mfma_f32_16x16x32_bf16 a[216:219], a[132:135], a[92:95], a[216:219]
v_mfma_f32_16x16x32_bf16 a[224:227], a[128:131], a[96:99], a[224:227]
v_mfma_f32_16x16x32_bf16 a[224:227], a[132:135], a[100:103], a[224:227]
v_mfma_f32_16x16x32_bf16 a[232:235], a[128:131], a[104:107], a[232:235]
v_mfma_f32_16x16x32_bf16 a[232:235], a[132:135], a[108:111], a[232:235]
v_mfma_f32_16x16x32_bf16 a[240:243], a[128:131], a[112:115], a[240:243]
v_mfma_f32_16x16x32_bf16 a[240:243], a[132:135], a[116:119], a[240:243]
v_mfma_f32_16x16x32_bf16 a[248:251], a[128:131], a[120:123], a[248:251]
v_mfma_f32_16x16x32_bf16 a[248:251], a[132:135], a[124:127], a[248:251]
s_waitcnt vmcnt(22) lgkmcnt(0)
s_barrier
v_mfma_f32_16x16x32_bf16 a[196:199], a[136:139], a[64:67], a[196:199]
s_add_u32 m0, s29, 98304
ds_read_b64_tr_b16 a[128:129], v4 offset:0
v_mfma_f32_16x16x32_bf16 a[196:199], a[140:143], a[68:71], a[196:199]
buffer_load_dwordx4 v16, s[12:15], s26 offen offset:0 lds
v_mfma_f32_16x16x32_bf16 a[204:207], a[136:139], a[72:75], a[204:207]
ds_read_b64_tr_b16 a[130:131], v4 offset:2048
v_mfma_f32_16x16x32_bf16 a[204:207], a[140:143], a[76:79], a[204:207]
v_mfma_f32_16x16x32_bf16 a[212:215], a[136:139], a[80:83], a[212:215]
ds_read_b64_tr_b16 a[132:133], v4 offset:16384
v_mfma_f32_16x16x32_bf16 a[212:215], a[140:143], a[84:87], a[212:215]
buffer_load_dwordx4 v17, s[12:15], s26 offen offset:1024 lds
v_mfma_f32_16x16x32_bf16 a[220:223], a[136:139], a[88:91], a[220:223]
ds_read_b64_tr_b16 a[134:135], v4 offset:18432
v_mfma_f32_16x16x32_bf16 a[220:223], a[140:143], a[92:95], a[220:223]
v_mfma_f32_16x16x32_bf16 a[228:231], a[136:139], a[96:99], a[228:231]
v_mfma_f32_16x16x32_bf16 a[228:231], a[140:143], a[100:103], a[228:231]
buffer_load_dwordx4 v18, s[12:15], s26 offen offset:2048 lds
v_mfma_f32_16x16x32_bf16 a[236:239], a[136:139], a[104:107], a[236:239]
v_mfma_f32_16x16x32_bf16 a[236:239], a[140:143], a[108:111], a[236:239]
v_mfma_f32_16x16x32_bf16 a[244:247], a[136:139], a[112:115], a[244:247]
v_mfma_f32_16x16x32_bf16 a[244:247], a[140:143], a[116:119], a[244:247]
buffer_load_dwordx4 v19, s[12:15], s26 offen offset:3072 lds
v_mfma_f32_16x16x32_bf16 a[252:255], a[136:139], a[120:123], a[252:255]
s_add_u32 s26, s26, 524288
v_mfma_f32_16x16x32_bf16 a[252:255], a[140:143], a[124:127], a[252:255]
s_waitcnt lgkmcnt(0)
v_mfma_f32_16x16x32_bf16 v[32:35], a[128:131], a[0:3], v[32:35]
s_add_u32 m0, s29, 114688
ds_read_b64_tr_b16 a[136:137], v5 offset:0
v_mfma_f32_16x16x32_bf16 v[32:35], a[132:135], a[4:7], v[32:35]
buffer_load_dwordx4 v16, s[12:15], s27 offen offset:0 lds
v_mfma_f32_16x16x32_bf16 v[40:43], a[128:131], a[8:11], v[40:43]
ds_read_b64_tr_b16 a[138:139], v5 offset:2048
v_mfma_f32_16x16x32_bf16 v[40:43], a[132:135], a[12:15], v[40:43]
v_mfma_f32_16x16x32_bf16 v[48:51], a[128:131], a[16:19], v[48:51]
ds_read_b64_tr_b16 a[140:141], v5 offset:16384
v_mfma_f32_16x16x32_bf16 v[48:51], a[132:135], a[20:23], v[48:51]
buffer_load_dwordx4 v17, s[12:15], s27 offen offset:1024 lds
v_mfma_f32_16x16x32_bf16 v[56:59], a[128:131], a[24:27], v[56:59]
ds_read_b64_tr_b16 a[142:143], v5 offset:18432
v_mfma_f32_16x16x32_bf16 v[56:59], a[132:135], a[28:31], v[56:59]
v_mfma_f32_16x16x32_bf16 v[64:67], a[128:131], a[32:35], v[64:67]
ds_read_b128 a[64:67], v2 offset:32768
v_mfma_f32_16x16x32_bf16 v[64:67], a[132:135], a[36:39], v[64:67]
buffer_load_dwordx4 v18, s[12:15], s27 offen offset:2048 lds
v_mfma_f32_16x16x32_bf16 v[72:75], a[128:131], a[40:43], v[72:75]
ds_read_b128 a[68:71], v3 offset:32768
v_mfma_f32_16x16x32_bf16 v[72:75], a[132:135], a[44:47], v[72:75]
v_mfma_f32_16x16x32_bf16 v[80:83], a[128:131], a[48:51], v[80:83]
v_mfma_f32_16x16x32_bf16 v[80:83], a[132:135], a[52:55], v[80:83]
buffer_load_dwordx4 v19, s[12:15], s27 offen offset:3072 lds
v_mfma_f32_16x16x32_bf16 v[88:91], a[128:131], a[56:59], v[88:91]
s_add_u32 s27, s27, 524288
ds_read_b128 a[72:75], v2 offset:34816
v_mfma_f32_16x16x32_bf16 v[88:91], a[132:135], a[60:63], v[88:91]
s_waitcnt lgkmcnt(2)
v_mfma_f32_16x16x32_bf16 v[36:39], a[136:139], a[0:3], v[36:39]
s_add_u32 m0, s28, 0
ds_read_b64_tr_b16 a[128:129], v6 offset:0
v_mfma_f32_16x16x32_bf16 v[36:39], a[140:143], a[4:7], v[36:39]
buffer_load_dwordx4 v12, s[8:11], s24 offen offset:0 lds
v_mfma_f32_16x16x32_bf16 v[44:47], a[136:139], a[8:11], v[44:47]
ds_read_b64_tr_b16 a[130:131], v6 offset:2048
v_mfma_f32_16x16x32_bf16 v[44:47], a[140:143], a[12:15], v[44:47]
v_mfma_f32_16x16x32_bf16 v[52:55], a[136:139], a[16:19], v[52:55]
ds_read_b64_tr_b16 a[132:133], v6 offset:16384
v_mfma_f32_16x16x32_bf16 v[52:55], a[140:143], a[20:23], v[52:55]
buffer_load_dwordx4 v13, s[8:11], s24 offen offset:1024 lds
v_mfma_f32_16x16x32_bf16 v[60:63], a[136:139], a[24:27], v[60:63]
ds_read_b64_tr_b16 a[134:135], v6 offset:18432
v_mfma_f32_16x16x32_bf16 v[60:63], a[140:143], a[28:31], v[60:63]
v_mfma_f32_16x16x32_bf16 v[68:71], a[136:139], a[32:35], v[68:71]
ds_read_b128 a[76:79], v3 offset:34816
v_mfma_f32_16x16x32_bf16 v[68:71], a[140:143], a[36:39], v[68:71]
buffer_load_dwordx4 v14, s[8:11], s24 offen offset:2048 lds
v_mfma_f32_16x16x32_bf16 v[76:79], a[136:139], a[40:43], v[76:79]
v_mfma_f32_16x16x32_bf16 v[76:79], a[140:143], a[44:47], v[76:79]
v_mfma_f32_16x16x32_bf16 v[84:87], a[136:139], a[48:51], v[84:87]
ds_read_b128 a[80:83], v2 offset:36864
v_mfma_f32_16x16x32_bf16 v[84:87], a[140:143], a[52:55], v[84:87]
buffer_load_dwordx4 v15, s[8:11], s24 offen offset:3072 lds
v_mfma_f32_16x16x32_bf16 v[92:95], a[136:139], a[56:59], v[92:95]
s_add_u32 s24, s24, 128
ds_read_b128 a[84:87], v3 offset:36864
v_mfma_f32_16x16x32_bf16 v[92:95], a[140:143], a[60:63], v[92:95]
s_waitcnt lgkmcnt(2)
v_mfma_f32_16x16x32_bf16 v[96:99], a[128:131], a[0:3], v[96:99]
s_add_u32 m0, s28, 4096
ds_read_b64_tr_b16 a[136:137], v7 offset:0
v_mfma_f32_16x16x32_bf16 v[96:99], a[132:135], a[4:7], v[96:99]
buffer_load_dwordx4 v12, s[8:11], s25 offen offset:0 lds
v_mfma_f32_16x16x32_bf16 v[104:107], a[128:131], a[8:11], v[104:107]
ds_read_b64_tr_b16 a[138:139], v7 offset:2048
v_mfma_f32_16x16x32_bf16 v[104:107], a[132:135], a[12:15], v[104:107]
v_mfma_f32_16x16x32_bf16 v[112:115], a[128:131], a[16:19], v[112:115]
ds_read_b64_tr_b16 a[140:141], v7 offset:16384
v_mfma_f32_16x16x32_bf16 v[112:115], a[132:135], a[20:23], v[112:115]
buffer_load_dwordx4 v13, s[8:11], s25 offen offset:1024 lds
v_mfma_f32_16x16x32_bf16 v[120:123], a[128:131], a[24:27], v[120:123]
ds_read_b64_tr_b16 a[142:143], v7 offset:18432
v_mfma_f32_16x16x32_bf16 v[120:123], a[132:135], a[28:31], v[120:123]
v_mfma_f32_16x16x32_bf16 v[128:131], a[128:131], a[32:35], v[128:131]
v_mfma_f32_16x16x32_bf16 v[128:131], a[132:135], a[36:39], v[128:131]
buffer_load_dwordx4 v14, s[8:11], s25 offen offset:2048 lds
v_mfma_f32_16x16x32_bf16 v[136:139], a[128:131], a[40:43], v[136:139]
ds_read_b128 a[88:91], v2 offset:38912
v_mfma_f32_16x16x32_bf16 v[136:139], a[132:135], a[44:47], v[136:139]
v_mfma_f32_16x16x32_bf16 v[144:147], a[128:131], a[48:51], v[144:147]
ds_read_b128 a[92:95], v3 offset:38912
v_mfma_f32_16x16x32_bf16 v[144:147], a[132:135], a[52:55], v[144:147]
buffer_load_dwordx4 v15, s[8:11], s25 offen offset:3072 lds
v_mfma_f32_16x16x32_bf16 v[152:155], a[128:131], a[56:59], v[152:155]
s_add_u32 s25, s25, 128
v_mfma_f32_16x16x32_bf16 v[152:155], a[132:135], a[60:63], v[152:155]
s_waitcnt lgkmcnt(2)
v_mfma_f32_16x16x32_bf16 v[100:103], a[136:139], a[0:3], v[100:103]
ds_read_b64_tr_b16 a[128:129], v8 offset:0
v_mfma_f32_16x16x32_bf16 v[100:103], a[140:143], a[4:7], v[100:103]
buffer_load_dword v21, v20, s[16:19], s43 offen
v_mfma_f32_16x16x32_bf16 v[108:111], a[136:139], a[8:11], v[108:111]
s_add_u32 s43, s43, s47
ds_read_b64_tr_b16 a[130:131], v8 offset:2048
v_mfma_f32_16x16x32_bf16 v[108:111], a[140:143], a[12:15], v[108:111]
PAD_2:
s_cbranch_execz M_tret
s_cmp_ge_u32 s43, s51
v_mfma_f32_16x16x32_bf16 v[116:119], a[136:139], a[16:19], v[116:119]
s_cselect_b32 s43, 0, s43
ds_read_b64_tr_b16 a[132:133], v8 offset:16384
v_mfma_f32_16x16x32_bf16 v[116:119], a[140:143], a[20:23], v[116:119]
s_cselect_b32 s51, s42, s51
v_mfma_f32_16x16x32_bf16 v[124:127], a[136:139], a[24:27], v[124:127]
s_cselect_b64 s[16:17], s[40:41], s[16:17]
ds_read_b64_tr_b16 a[134:135], v8 offset:18432
v_mfma_f32_16x16x32_bf16 v[124:127], a[140:143], a[28:31], v[124:127]
s_cselect_b32 s18, s42, s18
v_mfma_f32_16x16x32_bf16 v[132:135], a[136:139], a[32:35], v[132:135]
s_cselect_b64 s[40:41], s[44:45], s[40:41]
ds_read_b128 a[96:99], v2 offset:40960
v_mfma_f32_16x16x32_bf16 v[132:135], a[140:143], a[36:39], v[132:135]
s_cselect_b32 s42, s46, s42
v_mfma_f32_16x16x32_bf16 v[140:143], a[136:139], a[40:43], v[140:143]
s_cselect_b32 s46, 0, s46
v_mfma_f32_16x16x32_bf16 v[140:143], a[140:143], a[44:47], v[140:143]
s_lshl_b32 s59, s39, 5
v_mfma_f32_16x16x32_bf16 v[148:151], a[136:139], a[48:51], v[148:151]
s_add_u32 s59, s59, s38
ds_read_b128 a[100:103], v3 offset:40960
v_mfma_f32_16x16x32_bf16 v[148:151], a[140:143], a[52:55], v[148:151]
s_lshl_b32 s59, s59, 2
v_mfma_f32_16x16x32_bf16 v[156:159], a[136:139], a[56:59], v[156:159]
s_add_u32 s59, s59, 94392320
ds_read_b128 a[104:107], v2 offset:43008
v_mfma_f32_16x16x32_bf16 v[156:159], a[140:143], a[60:63], v[156:159]
s_waitcnt lgkmcnt(2)
s_cmp_lt_u32 s2, 224
v_mfma_f32_16x16x32_bf16 v[160:163], a[128:131], a[0:3], v[160:163]
s_cselect_b32 s59, s59, 3221225472
ds_read_b64_tr_b16 a[136:137], v9 offset:0
v_mfma_f32_16x16x32_bf16 v[160:163], a[132:135], a[4:7], v[160:163]
s_mov_b32 s58, 0xffff0000
v_mfma_f32_16x16x32_bf16 v[168:171], a[128:131], a[8:11], v[168:171]
ds_read_b64_tr_b16 a[138:139], v9 offset:2048
v_mfma_f32_16x16x32_bf16 v[168:171], a[132:135], a[12:15], v[168:171]
buffer_load_dword v21, v20, s[16:19], s43 offen
v_mfma_f32_16x16x32_bf16 v[176:179], a[128:131], a[16:19], v[176:179]
s_add_u32 s43, s43, s47
ds_read_b64_tr_b16 a[140:141], v9 offset:16384
v_mfma_f32_16x16x32_bf16 v[176:179], a[132:135], a[20:23], v[176:179]
s_cmp_ge_u32 s43, s51
v_mfma_f32_16x16x32_bf16 v[184:187], a[128:131], a[24:27], v[184:187]
s_cselect_b32 s43, 0, s43
ds_read_b64_tr_b16 a[142:143], v9 offset:18432
v_mfma_f32_16x16x32_bf16 v[184:187], a[132:135], a[28:31], v[184:187]
s_cselect_b32 s51, s42, s51
v_mfma_f32_16x16x32_bf16 v[192:195], a[128:131], a[32:35], v[192:195]
s_cselect_b64 s[16:17], s[40:41], s[16:17]
v_mfma_f32_16x16x32_bf16 v[192:195], a[132:135], a[36:39], v[192:195]
s_cselect_b32 s18, s42, s18
v_mfma_f32_16x16x32_bf16 v[200:203], a[128:131], a[40:43], v[200:203]
s_cselect_b64 s[40:41], s[44:45], s[40:41]
ds_read_b128 a[108:111], v3 offset:43008
v_mfma_f32_16x16x32_bf16 v[200:203], a[132:135], a[44:47], v[200:203]
s_cselect_b32 s42, s46, s42
v_mfma_f32_16x16x32_bf16 v[208:211], a[128:131], a[48:51], v[208:211]
s_cselect_b32 s46, 0, s46
ds_read_b128 a[112:115], v2 offset:45056
v_mfma_f32_16x16x32_bf16 v[208:211], a[132:135], a[52:55], v[208:211]
v_mfma_f32_16x16x32_bf16 v[216:219], a[128:131], a[56:59], v[216:219]
v_mfma_f32_16x16x32_bf16 v[216:219], a[132:135], a[60:63], v[216:219]
s_waitcnt lgkmcnt(2)
v_mfma_f32_16x16x32_bf16 v[164:167], a[136:139], a[0:3], v[164:167]
ds_read_b64_tr_b16 a[128:129], v10 offset:0
v_mfma_f32_16x16x32_bf16 v[164:167], a[140:143], a[4:7], v[164:167]
v_mfma_f32_16x16x32_bf16 v[172:175], a[136:139], a[8:11], v[172:175]
ds_read_b64_tr_b16 a[130:131], v10 offset:2048
v_mfma_f32_16x16x32_bf16 v[172:175], a[140:143], a[12:15], v[172:175]
v_mfma_f32_16x16x32_bf16 v[180:183], a[136:139], a[16:19], v[180:183]
ds_read_b64_tr_b16 a[132:133], v10 offset:16384
v_mfma_f32_16x16x32_bf16 v[180:183], a[140:143], a[20:23], v[180:183]
v_mfma_f32_16x16x32_bf16 v[188:191], a[136:139], a[24:27], v[188:191]
ds_read_b64_tr_b16 a[134:135], v10 offset:18432
v_mfma_f32_16x16x32_bf16 v[188:191], a[140:143], a[28:31], v[188:191]
v_mfma_f32_16x16x32_bf16 v[196:199], a[136:139], a[32:35], v[196:199]
ds_read_b128 a[116:119], v3 offset:45056
v_mfma_f32_16x16x32_bf16 v[196:199], a[140:143], a[36:39], v[196:199]
v_mfma_f32_16x16x32_bf16 v[204:207], a[136:139], a[40:43], v[204:207]
ds_read_b128 a[120:123], v2 offset:47104
v_and_b32 v252, 31, v0
v_mfma_f32_16x16x32_bf16 v[204:207], a[140:143], a[44:47], v[204:207]
v_lshrrev_b32 v253, 5, v0
v_xor_b32 v253, v253, v252
v_mfma_f32_16x16x32_bf16 v[212:215], a[136:139], a[48:51], v[212:215]
v_and_b32 v253, 7, v253
v_lshlrev_b32 v252, 8, v252
v_mfma_f32_16x16x32_bf16 v[212:215], a[140:143], a[52:55], v[212:215]
v_lshl_add_u32 v252, v253, 4, v252
v_add_u32 v252, 147456, v252
v_mfma_f32_16x16x32_bf16 v[220:223], a[136:139], a[56:59], v[220:223]
ds_read_b128 a[124:127], v3 offset:47104
v_mfma_f32_16x16x32_bf16 v[220:223], a[140:143], a[60:63], v[220:223]
s_waitcnt lgkmcnt(2)
v_mfma_f32_16x16x32_bf16 a[192:195], a[128:131], a[0:3], a[192:195]
ds_read_b64_tr_b16 a[136:137], v11 offset:0
v_mfma_f32_16x16x32_bf16 a[192:195], a[132:135], a[4:7], a[192:195]
v_mfma_f32_16x16x32_bf16 a[200:203], a[128:131], a[8:11], a[200:203]
ds_read_b64_tr_b16 a[138:139], v11 offset:2048
v_mfma_f32_16x16x32_bf16 a[200:203], a[132:135], a[12:15], a[200:203]
v_mfma_f32_16x16x32_bf16 a[208:211], a[128:131], a[16:19], a[208:211]
ds_read_b64_tr_b16 a[140:141], v11 offset:16384
v_mfma_f32_16x16x32_bf16 a[208:211], a[132:135], a[20:23], a[208:211]
v_mfma_f32_16x16x32_bf16 a[216:219], a[128:131], a[24:27], a[216:219]
ds_read_b64_tr_b16 a[142:143], v11 offset:18432
v_mfma_f32_16x16x32_bf16 a[216:219], a[132:135], a[28:31], a[216:219]
v_mfma_f32_16x16x32_bf16 a[224:227], a[128:131], a[32:35], a[224:227]
v_mfma_f32_16x16x32_bf16 a[224:227], a[132:135], a[36:39], a[224:227]
v_mfma_f32_16x16x32_bf16 a[232:235], a[128:131], a[40:43], a[232:235]
v_mfma_f32_16x16x32_bf16 a[232:235], a[132:135], a[44:47], a[232:235]
v_mfma_f32_16x16x32_bf16 a[240:243], a[128:131], a[48:51], a[240:243]
v_mfma_f32_16x16x32_bf16 a[240:243], a[132:135], a[52:55], a[240:243]
v_mfma_f32_16x16x32_bf16 a[248:251], a[128:131], a[56:59], a[248:251]
v_mfma_f32_16x16x32_bf16 a[248:251], a[132:135], a[60:63], a[248:251]
s_waitcnt vmcnt(2) lgkmcnt(0)
s_barrier
v_mfma_f32_16x16x32_bf16 a[196:199], a[136:139], a[0:3], a[196:199]
s_add_u32 m0, s29, 65536
ds_read_b64_tr_b16 a[128:129], v4 offset:32768
v_lshlrev_b32 v28, 16, v248
v_mfma_f32_16x16x32_bf16 a[196:199], a[140:143], a[4:7], a[196:199]
buffer_load_dwordx4 v16, s[12:15], s26 offen offset:0 lds
v_mfma_f32_16x16x32_bf16 a[204:207], a[136:139], a[8:11], a[204:207]
ds_read_b64_tr_b16 a[130:131], v4 offset:34816
v_and_b32 v29, s58, v248
v_mfma_f32_16x16x32_bf16 a[204:207], a[140:143], a[12:15], a[204:207]
v_lshlrev_b32 v30, 16, v249
v_and_b32 v253, s58, v249
v_mfma_f32_16x16x32_bf16 a[212:215], a[136:139], a[16:19], a[212:215]
ds_read_b64_tr_b16 a[132:133], v4 offset:49152
v_lshlrev_b32 v22, 16, v224
v_mfma_f32_16x16x32_bf16 a[212:215], a[140:143], a[20:23], a[212:215]
buffer_load_dwordx4 v17, s[12:15], s26 offen offset:1024 lds
v_mfma_f32_16x16x32_bf16 a[220:223], a[136:139], a[24:27], a[220:223]
ds_read_b64_tr_b16 a[134:135], v4 offset:51200
v_lshlrev_b32 v23, 16, v225
v_mfma_f32_16x16x32_bf16 a[220:223], a[140:143], a[28:31], a[220:223]
v_lshlrev_b32 v24, 16, v226
v_mul_f32 v254, v22, v253
v_mfma_f32_16x16x32_bf16 a[228:231], a[136:139], a[32:35], a[228:231]
v_lshlrev_b32 v25, 16, v227
v_lshlrev_b32 v247, 16, v236
v_mfma_f32_16x16x32_bf16 a[228:231], a[140:143], a[36:39], a[228:231]
buffer_load_dwordx4 v18, s[12:15], s26 offen offset:2048 lds
v_mfma_f32_16x16x32_bf16 a[236:239], a[136:139], a[40:43], a[236:239]
v_fmac_f32 v254, v23, v30
v_fmac_f32 v254, v24, v29
v_mfma_f32_16x16x32_bf16 a[236:239], a[140:143], a[44:47], a[236:239]
v_fmac_f32 v254, v25, v28
v_mul_f32 v254, v254, v247
v_mfma_f32_16x16x32_bf16 a[244:247], a[136:139], a[48:51], a[244:247]
v_mul_f32 v255, v23, v253
v_lshlrev_b32 v22, 16, v228
v_mfma_f32_16x16x32_bf16 a[244:247], a[140:143], a[52:55], a[244:247]
buffer_load_dwordx4 v19, s[12:15], s26 offen offset:3072 lds
v_mfma_f32_16x16x32_bf16 a[252:255], a[136:139], a[56:59], a[252:255]
s_add_u32 s26, s26, 524288
v_lshlrev_b32 v247, 16, v237
v_fmac_f32 v255, v24, v30
v_mfma_f32_16x16x32_bf16 a[252:255], a[140:143], a[60:63], a[252:255]
s_waitcnt lgkmcnt(0)
v_fmac_f32 v255, v25, v29
v_fmac_f32 v255, v22, v28
v_mfma_f32_16x16x32_bf16 v[32:35], a[128:131], a[64:67], v[32:35]
s_add_u32 m0, s29, 81920
ds_read_b64_tr_b16 a[136:137], v5 offset:32768
v_mul_f32 v255, v255, v247
v_mfma_f32_16x16x32_bf16 v[32:35], a[132:135], a[68:71], v[32:35]
buffer_load_dwordx4 v16, s[12:15], s27 offen offset:0 lds
v_mfma_f32_16x16x32_bf16 v[40:43], a[128:131], a[72:75], v[40:43]
ds_read_b64_tr_b16 a[138:139], v5 offset:34816
v_cvt_pk_bf16_f32 v246, v254, v255
v_mfma_f32_16x16x32_bf16 v[40:43], a[132:135], a[76:79], v[40:43]
v_accvgpr_write_b32 a180, v246
v_mul_f32 v254, v24, v253
v_mfma_f32_16x16x32_bf16 v[48:51], a[128:131], a[80:83], v[48:51]
ds_read_b64_tr_b16 a[140:141], v5 offset:49152
v_lshlrev_b32 v23, 16, v229
v_mfma_f32_16x16x32_bf16 v[48:51], a[132:135], a[84:87], v[48:51]
buffer_load_dwordx4 v17, s[12:15], s27 offen offset:1024 lds
v_lshlrev_b32 v247, 16, v238
v_mfma_f32_16x16x32_bf16 v[56:59], a[128:131], a[88:91], v[56:59]
ds_read_b64_tr_b16 a[142:143], v5 offset:51200
v_fmac_f32 v254, v25, v30
v_mfma_f32_16x16x32_bf16 v[56:59], a[132:135], a[92:95], v[56:59]
v_fmac_f32 v254, v22, v29
v_fmac_f32 v254, v23, v28
v_mfma_f32_16x16x32_bf16 v[64:67], a[128:131], a[96:99], v[64:67]
ds_read_b128 a[0:3], v2 offset:0
v_mul_f32 v254, v254, v247
v_mfma_f32_16x16x32_bf16 v[64:67], a[132:135], a[100:103], v[64:67]
buffer_load_dwordx4 v18, s[12:15], s27 offen offset:2048 lds
v_mfma_f32_16x16x32_bf16 v[72:75], a[128:131], a[104:107], v[72:75]
ds_read_b128 a[4:7], v3 offset:0
v_cvt_pk_bf16_f32 v246, v255, v254
v_accvgpr_write_b32 a176, v246
v_mfma_f32_16x16x32_bf16 v[72:75], a[132:135], a[108:111], v[72:75]
v_mul_f32 v255, v25, v253
v_lshlrev_b32 v24, 16, v230
v_mfma_f32_16x16x32_bf16 v[80:83], a[128:131], a[112:115], v[80:83]
v_lshlrev_b32 v247, 16, v239
v_fmac_f32 v255, v22, v30
v_mfma_f32_16x16x32_bf16 v[80:83], a[132:135], a[116:119], v[80:83]
buffer_load_dwordx4 v19, s[12:15], s27 offen offset:3072 lds
v_mfma_f32_16x16x32_bf16 v[88:91], a[128:131], a[120:123], v[88:91]
s_add_u32 s27, s27, 524288
ds_read_b128 a[8:11], v2 offset:2048
v_fmac_f32 v255, v23, v29
v_mfma_f32_16x16x32_bf16 v[88:91], a[132:135], a[124:127], v[88:91]
s_waitcnt lgkmcnt(2)
v_fmac_f32 v255, v24, v28
v_mul_f32 v255, v255, v247
v_mfma_f32_16x16x32_bf16 v[36:39], a[136:139], a[64:67], v[36:39]
s_add_u32 m0, s28, 32768
ds_read_b64_tr_b16 a[128:129], v6 offset:32768
v_cvt_pk_bf16_f32 v246, v254, v255
v_accvgpr_write_b32 a181, v246
v_mfma_f32_16x16x32_bf16 v[36:39], a[140:143], a[68:71], v[36:39]
buffer_load_dwordx4 v12, s[8:11], s24 offen offset:0 lds
v_mfma_f32_16x16x32_bf16 v[44:47], a[136:139], a[72:75], v[44:47]
ds_read_b64_tr_b16 a[130:131], v6 offset:34816
v_mul_f32 v254, v22, v253
v_mfma_f32_16x16x32_bf16 v[44:47], a[140:143], a[76:79], v[44:47]
v_lshlrev_b32 v25, 16, v231
v_lshlrev_b32 v247, 16, v240
v_mfma_f32_16x16x32_bf16 v[52:55], a[136:139], a[80:83], v[52:55]
ds_read_b64_tr_b16 a[132:133], v6 offset:49152
v_fmac_f32 v254, v23, v30
v_mfma_f32_16x16x32_bf16 v[52:55], a[140:143], a[84:87], v[52:55]
buffer_load_dwordx4 v13, s[8:11], s24 offen offset:1024 lds
v_fmac_f32 v254, v24, v29
v_mfma_f32_16x16x32_bf16 v[60:63], a[136:139], a[88:91], v[60:63]
ds_read_b64_tr_b16 a[134:135], v6 offset:51200
v_fmac_f32 v254, v25, v28
v_mfma_f32_16x16x32_bf16 v[60:63], a[140:143], a[92:95], v[60:63]
v_mul_f32 v254, v254, v247
v_cvt_pk_bf16_f32 v246, v255, v254
v_mfma_f32_16x16x32_bf16 v[68:71], a[136:139], a[96:99], v[68:71]
ds_read_b128 a[12:15], v3 offset:2048
v_accvgpr_write_b32 a177, v246
v_mfma_f32_16x16x32_bf16 v[68:71], a[140:143], a[100:103], v[68:71]
buffer_load_dwordx4 v14, s[8:11], s24 offen offset:2048 lds
v_mfma_f32_16x16x32_bf16 v[76:79], a[136:139], a[104:107], v[76:79]
v_mul_f32 v255, v23, v253
v_lshlrev_b32 v22, 16, v232
v_lshlrev_b32 v247, 16, v241
v_mfma_f32_16x16x32_bf16 v[76:79], a[140:143], a[108:111], v[76:79]
v_fmac_f32 v255, v24, v30
v_fmac_f32 v255, v25, v29
v_mfma_f32_16x16x32_bf16 v[84:87], a[136:139], a[112:115], v[84:87]
ds_read_b128 a[16:19], v2 offset:4096
v_fmac_f32 v255, v22, v28
v_mfma_f32_16x16x32_bf16 v[84:87], a[140:143], a[116:119], v[84:87]
buffer_load_dwordx4 v15, s[8:11], s24 offen offset:3072 lds
v_mfma_f32_16x16x32_bf16 v[92:95], a[136:139], a[120:123], v[92:95]
s_add_u32 s24, s24, 128
ds_read_b128 a[20:23], v3 offset:4096
v_mul_f32 v255, v255, v247
v_mfma_f32_16x16x32_bf16 v[92:95], a[140:143], a[124:127], v[92:95]
s_waitcnt lgkmcnt(2)
v_cvt_pk_bf16_f32 v246, v254, v255
v_accvgpr_write_b32 a182, v246
v_mfma_f32_16x16x32_bf16 v[96:99], a[128:131], a[64:67], v[96:99]
s_add_u32 m0, s28, 36864
ds_read_b64_tr_b16 a[136:137], v7 offset:32768
v_mul_f32 v254, v24, v253
v_lshlrev_b32 v23, 16, v233
v_mfma_f32_16x16x32_bf16 v[96:99], a[132:135], a[68:71], v[96:99]
buffer_load_dwordx4 v12, s[8:11], s25 offen offset:0 lds
v_mfma_f32_16x16x32_bf16 v[104:107], a[128:131], a[72:75], v[104:107]
ds_read_b64_tr_b16 a[138:139], v7 offset:34816
v_lshlrev_b32 v247, 16, v242
v_mfma_f32_16x16x32_bf16 v[104:107], a[132:135], a[76:79], v[104:107]
v_fmac_f32 v254, v25, v30
v_fmac_f32 v254, v22, v29
v_mfma_f32_16x16x32_bf16 v[112:115], a[128:131], a[80:83], v[112:115]
ds_read_b64_tr_b16 a[140:141], v7 offset:49152
v_fmac_f32 v254, v23, v28
v_mfma_f32_16x16x32_bf16 v[112:115], a[132:135], a[84:87], v[112:115]
buffer_load_dwordx4 v13, s[8:11], s25 offen offset:1024 lds
v_mul_f32 v254, v254, v247
v_mfma_f32_16x16x32_bf16 v[120:123], a[128:131], a[88:91], v[120:123]
ds_read_b64_tr_b16 a[142:143], v7 offset:51200
v_cvt_pk_bf16_f32 v246, v255, v254
v_mfma_f32_16x16x32_bf16 v[120:123], a[132:135], a[92:95], v[120:123]
v_accvgpr_write_b32 a178, v246
v_mul_f32 v255, v25, v253
v_mfma_f32_16x16x32_bf16 v[128:131], a[128:131], a[96:99], v[128:131]
v_lshlrev_b32 v24, 16, v234
v_lshlrev_b32 v247, 16, v243
v_mfma_f32_16x16x32_bf16 v[128:131], a[132:135], a[100:103], v[128:131]
buffer_load_dwordx4 v14, s[8:11], s25 offen offset:2048 lds
v_mfma_f32_16x16x32_bf16 v[136:139], a[128:131], a[104:107], v[136:139]
ds_read_b128 a[24:27], v2 offset:6144
v_fmac_f32 v255, v22, v30
v_fmac_f32 v255, v23, v29
v_mfma_f32_16x16x32_bf16 v[136:139], a[132:135], a[108:111], v[136:139]
v_fmac_f32 v255, v24, v28
v_mul_f32 v255, v255, v247
v_mfma_f32_16x16x32_bf16 v[144:147], a[128:131], a[112:115], v[144:147]
ds_read_b128 a[28:31], v3 offset:6144
v_cvt_pk_bf16_f32 v246, v254, v255
v_mfma_f32_16x16x32_bf16 v[144:147], a[132:135], a[116:119], v[144:147]
buffer_load_dwordx4 v15, s[8:11], s25 offen offset:3072 lds
v_mfma_f32_16x16x32_bf16 v[152:155], a[128:131], a[120:123], v[152:155]
s_add_u32 s25, s25, 128
v_accvgpr_write_b32 a183, v246
v_mul_f32 v254, v22, v253
v_mfma_f32_16x16x32_bf16 v[152:155], a[132:135], a[124:127], v[152:155]
s_waitcnt lgkmcnt(2)
v_lshlrev_b32 v25, 16, v235
v_lshlrev_b32 v247, 16, v244
v_mfma_f32_16x16x32_bf16 v[100:103], a[136:139], a[64:67], v[100:103]
ds_read_b64_tr_b16 a[128:129], v8 offset:32768
v_fmac_f32 v254, v23, v30
v_fmac_f32 v254, v24, v29
v_mfma_f32_16x16x32_bf16 v[100:103], a[140:143], a[68:71], v[100:103]
buffer_load_dword v21, v20, s[16:19], s43 offen
v_mfma_f32_16x16x32_bf16 v[108:111], a[136:139], a[72:75], v[108:111]
s_add_u32 s43, s43, s47
ds_read_b64_tr_b16 a[130:131], v8 offset:34816
v_fmac_f32 v254, v25, v28
v_mfma_f32_16x16x32_bf16 v[108:111], a[140:143], a[76:79], v[108:111]
s_cmp_ge_u32 s43, s51
v_mul_f32 v254, v254, v247
v_cvt_pk_bf16_f32 v246, v255, v254
v_mfma_f32_16x16x32_bf16 v[116:119], a[136:139], a[80:83], v[116:119]
s_cselect_b32 s43, 0, s43
ds_read_b64_tr_b16 a[132:133], v8 offset:49152
v_accvgpr_write_b32 a179, v246
v_mfma_f32_16x16x32_bf16 v[116:119], a[140:143], a[84:87], v[116:119]
s_cselect_b32 s51, s42, s51
v_lshlrev_b32 v28, 16, v250
v_and_b32 v29, s58, v250
v_lshlrev_b32 v30, 16, v251
v_mfma_f32_16x16x32_bf16 v[124:127], a[136:139], a[88:91], v[124:127]
s_cselect_b64 s[16:17], s[40:41], s[16:17]
ds_read_b64_tr_b16 a[134:135], v8 offset:51200
v_and_b32 v253, s58, v251
v_mfma_f32_16x16x32_bf16 v[124:127], a[140:143], a[92:95], v[124:127]
s_cselect_b32 s18, s42, s18
v_and_b32 v22, s58, v224
v_and_b32 v23, s58, v225
v_mfma_f32_16x16x32_bf16 v[132:135], a[136:139], a[96:99], v[132:135]
s_cselect_b64 s[40:41], s[44:45], s[40:41]
ds_read_b128 a[32:35], v2 offset:8192
v_and_b32 v24, s58, v226
v_mfma_f32_16x16x32_bf16 v[132:135], a[140:143], a[100:103], v[132:135]
s_cselect_b32 s42, s46, s42
v_mul_f32 v254, v22, v253
v_and_b32 v25, s58, v227
v_mfma_f32_16x16x32_bf16 v[140:143], a[136:139], a[104:107], v[140:143]
s_cselect_b32 s46, 0, s46
v_and_b32 v247, s58, v236
v_fmac_f32 v254, v23, v30
v_mfma_f32_16x16x32_bf16 v[140:143], a[140:143], a[108:111], v[140:143]
buffer_load_dword v245, off, s[60:63], 0 sc1
v_fmac_f32 v254, v24, v29
v_mfma_f32_16x16x32_bf16 v[148:151], a[136:139], a[112:115], v[148:151]
ds_read_b128 a[36:39], v3 offset:8192
v_fmac_f32 v254, v25, v28
v_mfma_f32_16x16x32_bf16 v[148:151], a[140:143], a[116:119], v[148:151]
v_mul_f32 v254, v254, v247
v_mul_f32 v255, v23, v253
v_mfma_f32_16x16x32_bf16 v[156:159], a[136:139], a[120:123], v[156:159]
ds_read_b128 a[40:43], v2 offset:10240
v_and_b32 v22, s58, v228
v_mfma_f32_16x16x32_bf16 v[156:159], a[140:143], a[124:127], v[156:159]
s_waitcnt lgkmcnt(2)
v_and_b32 v247, s58, v237
v_fmac_f32 v255, v24, v30
v_mfma_f32_16x16x32_bf16 v[160:163], a[128:131], a[64:67], v[160:163]
ds_read_b64_tr_b16 a[136:137], v9 offset:32768
v_fmac_f32 v255, v25, v29
v_fmac_f32 v255, v22, v28
v_mfma_f32_16x16x32_bf16 v[160:163], a[132:135], a[68:71], v[160:163]
v_mul_f32 v255, v255, v247
v_cvt_pk_bf16_f32 v246, v254, v255
v_mfma_f32_16x16x32_bf16 v[168:171], a[128:131], a[72:75], v[168:171]
ds_read_b64_tr_b16 a[138:139], v9 offset:34816
v_accvgpr_write_b32 a188, v246
v_mfma_f32_16x16x32_bf16 v[168:171], a[132:135], a[76:79], v[168:171]
v_mul_f32 v254, v24, v253
v_and_b32 v23, s58, v229
v_mfma_f32_16x16x32_bf16 v[176:179], a[128:131], a[80:83], v[176:179]
ds_read_b64_tr_b16 a[140:141], v9 offset:49152
v_and_b32 v247, s58, v238
v_mfma_f32_16x16x32_bf16 v[176:179], a[132:135], a[84:87], v[176:179]
v_fmac_f32 v254, v25, v30
v_fmac_f32 v254, v22, v29
v_fmac_f32 v254, v23, v28
v_mfma_f32_16x16x32_bf16 v[184:187], a[128:131], a[88:91], v[184:187]
ds_read_b64_tr_b16 a[142:143], v9 offset:51200
v_mul_f32 v254, v254, v247
v_mfma_f32_16x16x32_bf16 v[184:187], a[132:135], a[92:95], v[184:187]
v_cvt_pk_bf16_f32 v246, v255, v254
v_accvgpr_write_b32 a184, v246
v_mfma_f32_16x16x32_bf16 v[192:195], a[128:131], a[96:99], v[192:195]
v_mul_f32 v255, v25, v253
v_and_b32 v24, s58, v230
v_mfma_f32_16x16x32_bf16 v[192:195], a[132:135], a[100:103], v[192:195]
v_and_b32 v247, s58, v239
v_fmac_f32 v255, v22, v30
v_mfma_f32_16x16x32_bf16 v[200:203], a[128:131], a[104:107], v[200:203]
ds_read_b128 a[44:47], v3 offset:10240
v_fmac_f32 v255, v23, v29
v_mfma_f32_16x16x32_bf16 v[200:203], a[132:135], a[108:111], v[200:203]
v_fmac_f32 v255, v24, v28
v_mul_f32 v255, v255, v247
v_cvt_pk_bf16_f32 v246, v254, v255
v_mfma_f32_16x16x32_bf16 v[208:211], a[128:131], a[112:115], v[208:211]
ds_read_b128 a[48:51], v2 offset:12288
v_accvgpr_write_b32 a189, v246
v_mfma_f32_16x16x32_bf16 v[208:211], a[132:135], a[116:119], v[208:211]
v_mul_f32 v254, v22, v253
v_and_b32 v25, s58, v231
v_mfma_f32_16x16x32_bf16 v[216:219], a[128:131], a[120:123], v[216:219]
v_and_b32 v247, s58, v240
v_fmac_f32 v254, v23, v30
v_mfma_f32_16x16x32_bf16 v[216:219], a[132:135], a[124:127], v[216:219]
s_waitcnt lgkmcnt(2)
v_fmac_f32 v254, v24, v29
v_fmac_f32 v254, v25, v28
v_mfma_f32_16x16x32_bf16 v[164:167], a[136:139], a[64:67], v[164:167]
ds_read_b64_tr_b16 a[128:129], v10 offset:32768
v_mul_f32 v254, v254, v247
v_cvt_pk_bf16_f32 v246, v255, v254
v_mfma_f32_16x16x32_bf16 v[164:167], a[140:143], a[68:71], v[164:167]
v_accvgpr_write_b32 a185, v246
v_mul_f32 v255, v23, v253
v_mfma_f32_16x16x32_bf16 v[172:175], a[136:139], a[72:75], v[172:175]
ds_read_b64_tr_b16 a[130:131], v10 offset:34816
v_and_b32 v22, s58, v232
v_mfma_f32_16x16x32_bf16 v[172:175], a[140:143], a[76:79], v[172:175]
v_and_b32 v247, s58, v241
v_fmac_f32 v255, v24, v30
v_mfma_f32_16x16x32_bf16 v[180:183], a[136:139], a[80:83], v[180:183]
s_lshr_b32 s22, s3, 1
ds_read_b64_tr_b16 a[132:133], v10 offset:49152
v_fmac_f32 v255, v25, v29
v_mfma_f32_16x16x32_bf16 v[180:183], a[140:143], a[84:87], v[180:183]
s_mul_i32 s22, s22, 2097152
v_fmac_f32 v255, v22, v28
v_mul_f32 v255, v255, v247
v_cvt_pk_bf16_f32 v246, v254, v255
v_mfma_f32_16x16x32_bf16 v[188:191], a[136:139], a[88:91], v[188:191]
s_and_b32 s23, s3, 1
ds_read_b64_tr_b16 a[134:135], v10 offset:51200
v_accvgpr_write_b32 a190, v246
v_mfma_f32_16x16x32_bf16 v[188:191], a[140:143], a[92:95], v[188:191]
s_lshl_b32 s23, s23, 5
v_mul_f32 v254, v24, v253
v_and_b32 v23, s58, v233
v_mfma_f32_16x16x32_bf16 v[196:199], a[136:139], a[96:99], v[196:199]
s_lshl_b32 s56, s39, 6
ds_read_b128 a[52:55], v3 offset:12288
v_and_b32 v247, s58, v242
v_mfma_f32_16x16x32_bf16 v[196:199], a[140:143], a[100:103], v[196:199]
s_add_u32 s23, s23, s56
v_fmac_f32 v254, v25, v30
v_fmac_f32 v254, v22, v29
v_mfma_f32_16x16x32_bf16 v[204:207], a[136:139], a[104:107], v[204:207]
s_mul_i32 s23, s23, 4224
ds_read_b128 a[56:59], v2 offset:14336
v_fmac_f32 v254, v23, v28
v_mfma_f32_16x16x32_bf16 v[204:207], a[140:143], a[108:111], v[204:207]
s_add_u32 s22, s22, s23
v_mul_f32 v254, v254, v247
v_cvt_pk_bf16_f32 v246, v255, v254
v_accvgpr_write_b32 a186, v246
v_mfma_f32_16x16x32_bf16 v[212:215], a[136:139], a[112:115], v[212:215]
s_add_u32 s57, s22, 83886200
v_mul_f32 v255, v25, v253
v_and_b32 v24, s58, v234
v_mfma_f32_16x16x32_bf16 v[212:215], a[140:143], a[116:119], v[212:215]
s_lshl_b32 s23, s38, 7
v_and_b32 v247, s58, v243
v_fmac_f32 v255, v22, v30
v_mfma_f32_16x16x32_bf16 v[220:223], a[136:139], a[120:123], v[220:223]
s_add_u32 s22, s22, s23
ds_read_b128 a[60:63], v3 offset:14336
v_fmac_f32 v255, v23, v29
v_mfma_f32_16x16x32_bf16 v[220:223], a[140:143], a[124:127], v[220:223]
s_waitcnt lgkmcnt(2)
s_add_u32 s56, s22, 83886208
v_fmac_f32 v255, v24, v28
v_mul_f32 v255, v255, v247
v_mfma_f32_16x16x32_bf16 a[192:195], a[128:131], a[64:67], a[192:195]
s_cmp_lt_u32 s2, 224
ds_read_b64_tr_b16 a[136:137], v11 offset:32768
v_cvt_pk_bf16_f32 v246, v254, v255
v_accvgpr_write_b32 a191, v246
v_mfma_f32_16x16x32_bf16 a[192:195], a[132:135], a[68:71], a[192:195]
s_cselect_b32 s56, s56, 3221225472
v_mul_f32 v254, v22, v253
v_and_b32 v25, s58, v235
v_mfma_f32_16x16x32_bf16 a[200:203], a[128:131], a[72:75], a[200:203]
s_cmp_eq_u32 s38, 0
ds_read_b64_tr_b16 a[138:139], v11 offset:34816
v_and_b32 v247, s58, v244
v_mfma_f32_16x16x32_bf16 a[200:203], a[132:135], a[76:79], a[200:203]
s_cselect_b32 s57, s57, 3221225472
v_fmac_f32 v254, v23, v30
v_fmac_f32 v254, v24, v29
v_mfma_f32_16x16x32_bf16 a[208:211], a[128:131], a[80:83], a[208:211]
ds_read_b64_tr_b16 a[140:141], v11 offset:49152
v_fmac_f32 v254, v25, v28
v_mfma_f32_16x16x32_bf16 a[208:211], a[132:135], a[84:87], a[208:211]
v_mul_f32 v254, v254, v247
v_cvt_pk_bf16_f32 v246, v255, v254
v_accvgpr_write_b32 a187, v246
v_mfma_f32_16x16x32_bf16 a[216:219], a[128:131], a[88:91], a[216:219]
ds_read_b64_tr_b16 a[142:143], v11 offset:51200
v_mfma_f32_16x16x32_bf16 a[216:219], a[132:135], a[92:95], a[216:219]
ds_write_b128 v252, a[176:179] offset:0
v_mfma_f32_16x16x32_bf16 a[224:227], a[128:131], a[96:99], a[224:227]
v_mfma_f32_16x16x32_bf16 a[224:227], a[132:135], a[100:103], a[224:227]
ds_write_b128 v252, a[180:183] offset:8192
v_mfma_f32_16x16x32_bf16 a[232:235], a[128:131], a[104:107], a[232:235]
v_mfma_f32_16x16x32_bf16 a[232:235], a[132:135], a[108:111], a[232:235]
ds_write_b128 v252, a[184:187] offset:128
v_mfma_f32_16x16x32_bf16 a[240:243], a[128:131], a[112:115], a[240:243]
v_mfma_f32_16x16x32_bf16 a[240:243], a[132:135], a[116:119], a[240:243]
ds_write_b128 v252, a[188:191] offset:8320
v_mfma_f32_16x16x32_bf16 a[248:251], a[128:131], a[120:123], a[248:251]
v_mfma_f32_16x16x32_bf16 a[248:251], a[132:135], a[124:127], a[248:251]
s_waitcnt vmcnt(2) lgkmcnt(0)
s_barrier
v_mfma_f32_16x16x32_bf16 a[196:199], a[136:139], a[64:67], a[196:199]
s_add_u32 m0, s29, 98304
ds_read_b64_tr_b16 a[128:129], v4 offset:0
v_lshrrev_b32 v22, 8, v1
v_mfma_f32_16x16x32_bf16 a[196:199], a[140:143], a[68:71], a[196:199]
buffer_load_dwordx4 v16, s[12:15], s26 offen offset:0 lds
v_mfma_f32_16x16x32_bf16 a[204:207], a[136:139], a[72:75], a[204:207]
ds_read_b64_tr_b16 a[130:131], v4 offset:2048
v_lshlrev_b32 v22, 4, v22
v_mfma_f32_16x16x32_bf16 a[204:207], a[140:143], a[76:79], a[204:207]
v_xor_b32 v22, v22, v1
v_add_u32 v22, s29, v22
v_mfma_f32_16x16x32_bf16 a[212:215], a[136:139], a[80:83], a[212:215]
ds_read_b64_tr_b16 a[132:133], v4 offset:16384
v_add_u32 v22, 147456, v22
v_mfma_f32_16x16x32_bf16 a[212:215], a[140:143], a[84:87], a[212:215]
buffer_load_dwordx4 v17, s[12:15], s26 offen offset:1024 lds
v_mfma_f32_16x16x32_bf16 a[220:223], a[136:139], a[88:91], a[220:223]
ds_read_b64_tr_b16 a[134:135], v4 offset:18432
v_xor_b32 v23, 64, v22
v_mfma_f32_16x16x32_bf16 a[220:223], a[140:143], a[92:95], a[220:223]
v_lshrrev_b32 v224, 7, v1
v_mul_u32_u24 v224, 4224, v224
v_mfma_f32_16x16x32_bf16 a[228:231], a[136:139], a[96:99], a[228:231]
v_and_b32 v225, 0x70, v1
v_add_u32 v224, v224, v225
v_mfma_f32_16x16x32_bf16 a[228:231], a[140:143], a[100:103], a[228:231]
buffer_load_dwordx4 v18, s[12:15], s26 offen offset:2048 lds
v_mfma_f32_16x16x32_bf16 a[236:239], a[136:139], a[104:107], a[236:239]
v_bfe_u32 v225, v1, 4, 5
v_mul_u32_u24 v225, 4224, v225
v_mfma_f32_16x16x32_bf16 a[236:239], a[140:143], a[108:111], a[236:239]
v_mov_b32 v226, 0
v_mov_b32 v227, 0
v_mfma_f32_16x16x32_bf16 a[244:247], a[136:139], a[112:115], a[244:247]
v_mfma_f32_16x16x32_bf16 a[244:247], a[140:143], a[116:119], a[244:247]
buffer_load_dwordx4 v19, s[12:15], s26 offen offset:3072 lds
v_mfma_f32_16x16x32_bf16 a[252:255], a[136:139], a[120:123], a[252:255]
s_add_u32 s26, s26, 524288
v_mfma_f32_16x16x32_bf16 a[252:255], a[140:143], a[124:127], a[252:255]
s_waitcnt lgkmcnt(0)
v_mfma_f32_16x16x32_bf16 v[32:35], a[128:131], a[0:3], v[32:35]
s_add_u32 m0, s29, 114688
ds_read_b64_tr_b16 a[136:137], v5 offset:0
v_mfma_f32_16x16x32_bf16 v[32:35], a[132:135], a[4:7], v[32:35]
buffer_load_dwordx4 v16, s[12:15], s27 offen offset:0 lds
v_mfma_f32_16x16x32_bf16 v[40:43], a[128:131], a[8:11], v[40:43]
s_mul_i32 s52, s20, 7
ds_read_b64_tr_b16 a[138:139], v5 offset:2048
v_mfma_f32_16x16x32_bf16 v[40:43], a[132:135], a[12:15], v[40:43]
s_add_u32 s52, s52, s21
buffer_store_dwordx2 v[226:227], v225, s[4:7], s57 offen sc1
v_mfma_f32_16x16x32_bf16 v[48:51], a[128:131], a[16:19], v[48:51]
s_lshl_b32 s53, s52, 2
ds_read_b64_tr_b16 a[140:141], v5 offset:16384
v_mfma_f32_16x16x32_bf16 v[48:51], a[132:135], a[20:23], v[48:51]
s_add_u32 s53, s53, s3
buffer_load_dwordx4 v17, s[12:15], s27 offen offset:1024 lds
v_mfma_f32_16x16x32_bf16 v[56:59], a[128:131], a[24:27], v[56:59]
s_lshl_b32 s49, s53, 12
ds_read_b64_tr_b16 a[142:143], v5 offset:18432
v_mfma_f32_16x16x32_bf16 v[56:59], a[132:135], a[28:31], v[56:59]
s_mul_i32 s53, s53, 4224
v_mfma_f32_16x16x32_bf16 v[64:67], a[128:131], a[32:35], v[64:67]
s_add_u32 s53, s53, 83886080
ds_read_b128 a[64:67], v2 offset:32768
v_mfma_f32_16x16x32_bf16 v[64:67], a[132:135], a[36:39], v[64:67]
s_lshr_b32 s52, s52, 4
buffer_load_dwordx4 v18, s[12:15], s27 offen offset:2048 lds
v_mfma_f32_16x16x32_bf16 v[72:75], a[128:131], a[40:43], v[72:75]
s_min_u32 s52, s52, 6
ds_read_b128 a[68:71], v3 offset:32768
v_mfma_f32_16x16x32_bf16 v[72:75], a[132:135], a[44:47], v[72:75]
s_lshl_b32 s52, s52, 7
ds_read_b128 a[176:179], v22 offset:0
v_mfma_f32_16x16x32_bf16 v[80:83], a[128:131], a[48:51], v[80:83]
s_add_u32 s52, s52, 94392320
ds_read_b128 a[180:183], v23 offset:1024
v_mfma_f32_16x16x32_bf16 v[80:83], a[132:135], a[52:55], v[80:83]
buffer_load_dwordx4 v19, s[12:15], s27 offen offset:3072 lds
v_mfma_f32_16x16x32_bf16 v[88:91], a[128:131], a[56:59], v[88:91]
s_add_u32 s27, s27, 524288
ds_read_b128 a[72:75], v2 offset:34816
v_mfma_f32_16x16x32_bf16 v[88:91], a[132:135], a[60:63], v[88:91]
s_waitcnt lgkmcnt(4)
ds_read_b128 a[184:187], v22 offset:2048
v_mfma_f32_16x16x32_bf16 v[36:39], a[136:139], a[0:3], v[36:39]
s_add_u32 m0, s28, 0
ds_read_b64_tr_b16 a[128:129], v6 offset:0
v_mfma_f32_16x16x32_bf16 v[36:39], a[140:143], a[4:7], v[36:39]
buffer_load_dwordx4 v12, s[8:11], s24 offen offset:0 lds
v_mfma_f32_16x16x32_bf16 v[44:47], a[136:139], a[8:11], v[44:47]
PAD_3:
s_cbranch_execz M_tret
ds_read_b64_tr_b16 a[130:131], v6 offset:2048
v_mfma_f32_16x16x32_bf16 v[44:47], a[140:143], a[12:15], v[44:47]
ds_read_b128 a[188:191], v23 offset:3072
v_mfma_f32_16x16x32_bf16 v[52:55], a[136:139], a[16:19], v[52:55]
ds_read_b64_tr_b16 a[132:133], v6 offset:16384
v_bfe_u32 v231, v1, 4, 5
v_mfma_f32_16x16x32_bf16 v[52:55], a[140:143], a[20:23], v[52:55]
buffer_load_dwordx4 v13, s[8:11], s24 offen offset:1024 lds
v_mfma_f32_16x16x32_bf16 v[60:63], a[136:139], a[24:27], v[60:63]
ds_read_b64_tr_b16 a[134:135], v6 offset:18432
v_lshlrev_b32 v231, 2, v231
v_mfma_f32_16x16x32_bf16 v[60:63], a[140:143], a[28:31], v[60:63]
v_lshlrev_b32 v229, 3, v1
v_min_u32 v229, 4096, v229
v_mfma_f32_16x16x32_bf16 v[68:71], a[136:139], a[32:35], v[68:71]
ds_read_b128 a[76:79], v3 offset:34816
v_mfma_f32_16x16x32_bf16 v[68:71], a[140:143], a[36:39], v[68:71]
buffer_load_dwordx4 v14, s[8:11], s24 offen offset:2048 lds
v_mfma_f32_16x16x32_bf16 v[76:79], a[136:139], a[40:43], v[76:79]
v_mfma_f32_16x16x32_bf16 v[76:79], a[140:143], a[44:47], v[76:79]
v_mfma_f32_16x16x32_bf16 v[84:87], a[136:139], a[48:51], v[84:87]
ds_read_b128 a[80:83], v2 offset:36864
v_mfma_f32_16x16x32_bf16 v[84:87], a[140:143], a[52:55], v[84:87]
buffer_load_dwordx4 v15, s[8:11], s24 offen offset:3072 lds
v_mfma_f32_16x16x32_bf16 v[92:95], a[136:139], a[56:59], v[92:95]
s_add_u32 s24, s24, 128
ds_read_b128 a[84:87], v3 offset:36864
v_mfma_f32_16x16x32_bf16 v[92:95], a[140:143], a[60:63], v[92:95]
s_waitcnt lgkmcnt(2)
v_mfma_f32_16x16x32_bf16 v[96:99], a[128:131], a[0:3], v[96:99]
s_add_u32 m0, s28, 4096
ds_read_b64_tr_b16 a[136:137], v7 offset:0
v_mfma_f32_16x16x32_bf16 v[96:99], a[132:135], a[4:7], v[96:99]
buffer_load_dwordx4 v12, s[8:11], s25 offen offset:0 lds
v_mfma_f32_16x16x32_bf16 v[104:107], a[128:131], a[8:11], v[104:107]
ds_read_b64_tr_b16 a[138:139], v7 offset:2048
v_mfma_f32_16x16x32_bf16 v[104:107], a[132:135], a[12:15], v[104:107]
v_mfma_f32_16x16x32_bf16 v[112:115], a[128:131], a[16:19], v[112:115]
ds_read_b64_tr_b16 a[140:141], v7 offset:16384
v_mfma_f32_16x16x32_bf16 v[112:115], a[132:135], a[20:23], v[112:115]
buffer_load_dwordx4 v13, s[8:11], s25 offen offset:1024 lds
v_mfma_f32_16x16x32_bf16 v[120:123], a[128:131], a[24:27], v[120:123]
ds_read_b64_tr_b16 a[142:143], v7 offset:18432
v_mfma_f32_16x16x32_bf16 v[120:123], a[132:135], a[28:31], v[120:123]
v_mfma_f32_16x16x32_bf16 v[128:131], a[128:131], a[32:35], v[128:131]
v_mfma_f32_16x16x32_bf16 v[128:131], a[132:135], a[36:39], v[128:131]
buffer_load_dwordx4 v14, s[8:11], s25 offen offset:2048 lds
v_mfma_f32_16x16x32_bf16 v[136:139], a[128:131], a[40:43], v[136:139]
ds_read_b128 a[88:91], v2 offset:38912
v_mfma_f32_16x16x32_bf16 v[136:139], a[132:135], a[44:47], v[136:139]
v_mfma_f32_16x16x32_bf16 v[144:147], a[128:131], a[48:51], v[144:147]
ds_read_b128 a[92:95], v3 offset:38912
v_mfma_f32_16x16x32_bf16 v[144:147], a[132:135], a[52:55], v[144:147]
buffer_load_dwordx4 v15, s[8:11], s25 offen offset:3072 lds
v_mfma_f32_16x16x32_bf16 v[152:155], a[128:131], a[56:59], v[152:155]
s_add_u32 s25, s25, 128
v_mfma_f32_16x16x32_bf16 v[152:155], a[132:135], a[60:63], v[152:155]
s_waitcnt lgkmcnt(2)
v_mfma_f32_16x16x32_bf16 v[100:103], a[136:139], a[0:3], v[100:103]
ds_read_b64_tr_b16 a[128:129], v8 offset:0
v_mfma_f32_16x16x32_bf16 v[100:103], a[140:143], a[4:7], v[100:103]
buffer_store_dwordx4 a[176:179], v224, s[4:7], s56 offen sc1
v_mfma_f32_16x16x32_bf16 v[108:111], a[136:139], a[8:11], v[108:111]
s_add_u32 s56, s56, 33792
ds_read_b64_tr_b16 a[130:131], v8 offset:2048
v_mfma_f32_16x16x32_bf16 v[108:111], a[140:143], a[12:15], v[108:111]
v_mfma_f32_16x16x32_bf16 v[116:119], a[136:139], a[16:19], v[116:119]
ds_read_b64_tr_b16 a[132:133], v8 offset:16384
v_mfma_f32_16x16x32_bf16 v[116:119], a[140:143], a[20:23], v[116:119]
v_mfma_f32_16x16x32_bf16 v[124:127], a[136:139], a[24:27], v[124:127]
s_cmp_lt_u32 s21, 0
ds_read_b64_tr_b16 a[134:135], v8 offset:18432
v_mfma_f32_16x16x32_bf16 v[124:127], a[140:143], a[28:31], v[124:127]
s_cselect_b32 s53, s53, 3221225472
v_mfma_f32_16x16x32_bf16 v[132:135], a[136:139], a[32:35], v[132:135]
s_cselect_b32 s49, s49, 3221225472
ds_read_b128 a[96:99], v2 offset:40960
v_mfma_f32_16x16x32_bf16 v[132:135], a[140:143], a[36:39], v[132:135]
s_add_u32 s48, s53, 2097152
v_mfma_f32_16x16x32_bf16 v[140:143], a[136:139], a[40:43], v[140:143]
v_mfma_f32_16x16x32_bf16 v[140:143], a[140:143], a[44:47], v[140:143]
v_mfma_f32_16x16x32_bf16 v[148:151], a[136:139], a[48:51], v[148:151]
ds_read_b128 a[100:103], v3 offset:40960
v_mfma_f32_16x16x32_bf16 v[148:151], a[140:143], a[52:55], v[148:151]
v_mfma_f32_16x16x32_bf16 v[156:159], a[136:139], a[56:59], v[156:159]
ds_read_b128 a[104:107], v2 offset:43008
v_mfma_f32_16x16x32_bf16 v[156:159], a[140:143], a[60:63], v[156:159]
s_waitcnt lgkmcnt(2)
v_mfma_f32_16x16x32_bf16 v[160:163], a[128:131], a[0:3], v[160:163]
ds_read_b64_tr_b16 a[136:137], v9 offset:0
v_mfma_f32_16x16x32_bf16 v[160:163], a[132:135], a[4:7], v[160:163]
v_mfma_f32_16x16x32_bf16 v[168:171], a[128:131], a[8:11], v[168:171]
ds_read_b64_tr_b16 a[138:139], v9 offset:2048
v_mfma_f32_16x16x32_bf16 v[168:171], a[132:135], a[12:15], v[168:171]
buffer_store_dwordx4 a[180:183], v224, s[4:7], s56 offen sc1
v_mfma_f32_16x16x32_bf16 v[176:179], a[128:131], a[16:19], v[176:179]
s_add_u32 s56, s56, 33792
ds_read_b64_tr_b16 a[140:141], v9 offset:16384
v_mfma_f32_16x16x32_bf16 v[176:179], a[132:135], a[20:23], v[176:179]
v_mfma_f32_16x16x32_bf16 v[184:187], a[128:131], a[24:27], v[184:187]
ds_read_b64_tr_b16 a[142:143], v9 offset:18432
v_mfma_f32_16x16x32_bf16 v[184:187], a[132:135], a[28:31], v[184:187]
v_mfma_f32_16x16x32_bf16 v[192:195], a[128:131], a[32:35], v[192:195]
v_mfma_f32_16x16x32_bf16 v[192:195], a[132:135], a[36:39], v[192:195]
v_mfma_f32_16x16x32_bf16 v[200:203], a[128:131], a[40:43], v[200:203]
ds_read_b128 a[108:111], v3 offset:43008
v_mfma_f32_16x16x32_bf16 v[200:203], a[132:135], a[44:47], v[200:203]
v_mfma_f32_16x16x32_bf16 v[208:211], a[128:131], a[48:51], v[208:211]
ds_read_b128 a[112:115], v2 offset:45056
v_mfma_f32_16x16x32_bf16 v[208:211], a[132:135], a[52:55], v[208:211]
v_mfma_f32_16x16x32_bf16 v[216:219], a[128:131], a[56:59], v[216:219]
v_mfma_f32_16x16x32_bf16 v[216:219], a[132:135], a[60:63], v[216:219]
s_waitcnt lgkmcnt(2)
v_mfma_f32_16x16x32_bf16 v[164:167], a[136:139], a[0:3], v[164:167]
ds_read_b64_tr_b16 a[128:129], v10 offset:0
v_mfma_f32_16x16x32_bf16 v[164:167], a[140:143], a[4:7], v[164:167]
v_mfma_f32_16x16x32_bf16 v[172:175], a[136:139], a[8:11], v[172:175]
ds_read_b64_tr_b16 a[130:131], v10 offset:2048
v_mfma_f32_16x16x32_bf16 v[172:175], a[140:143], a[12:15], v[172:175]
v_mfma_f32_16x16x32_bf16 v[180:183], a[136:139], a[16:19], v[180:183]
ds_read_b64_tr_b16 a[132:133], v10 offset:16384
v_mfma_f32_16x16x32_bf16 v[180:183], a[140:143], a[20:23], v[180:183]
buffer_store_dwordx4 a[184:187], v224, s[4:7], s56 offen sc1
v_mfma_f32_16x16x32_bf16 v[188:191], a[136:139], a[24:27], v[188:191]
s_add_u32 s56, s56, 33792
ds_read_b64_tr_b16 a[134:135], v10 offset:18432
v_mfma_f32_16x16x32_bf16 v[188:191], a[140:143], a[28:31], v[188:191]
v_mfma_f32_16x16x32_bf16 v[196:199], a[136:139], a[32:35], v[196:199]
ds_read_b128 a[116:119], v3 offset:45056
v_mfma_f32_16x16x32_bf16 v[196:199], a[140:143], a[36:39], v[196:199]
v_mfma_f32_16x16x32_bf16 v[204:207], a[136:139], a[40:43], v[204:207]
ds_read_b128 a[120:123], v2 offset:47104
v_mfma_f32_16x16x32_bf16 v[204:207], a[140:143], a[44:47], v[204:207]
v_mfma_f32_16x16x32_bf16 v[212:215], a[136:139], a[48:51], v[212:215]
v_mfma_f32_16x16x32_bf16 v[212:215], a[140:143], a[52:55], v[212:215]
v_mfma_f32_16x16x32_bf16 v[220:223], a[136:139], a[56:59], v[220:223]
ds_read_b128 a[124:127], v3 offset:47104
v_mfma_f32_16x16x32_bf16 v[220:223], a[140:143], a[60:63], v[220:223]
s_waitcnt lgkmcnt(2)
v_mfma_f32_16x16x32_bf16 a[192:195], a[128:131], a[0:3], a[192:195]
ds_read_b64_tr_b16 a[136:137], v11 offset:0
v_mfma_f32_16x16x32_bf16 a[192:195], a[132:135], a[4:7], a[192:195]
v_mfma_f32_16x16x32_bf16 a[200:203], a[128:131], a[8:11], a[200:203]
ds_read_b64_tr_b16 a[138:139], v11 offset:2048
v_mfma_f32_16x16x32_bf16 a[200:203], a[132:135], a[12:15], a[200:203]
v_mfma_f32_16x16x32_bf16 a[208:211], a[128:131], a[16:19], a[208:211]
ds_read_b64_tr_b16 a[140:141], v11 offset:16384
v_mfma_f32_16x16x32_bf16 a[208:211], a[132:135], a[20:23], a[208:211]
v_mfma_f32_16x16x32_bf16 a[216:219], a[128:131], a[24:27], a[216:219]
ds_read_b64_tr_b16 a[142:143], v11 offset:18432
v_mfma_f32_16x16x32_bf16 a[216:219], a[132:135], a[28:31], a[216:219]
buffer_store_dwordx4 a[188:191], v224, s[4:7], s56 offen sc1
v_mfma_f32_16x16x32_bf16 a[224:227], a[128:131], a[32:35], a[224:227]
s_add_u32 s56, s56, 33792
v_mfma_f32_16x16x32_bf16 a[224:227], a[132:135], a[36:39], a[224:227]
v_mfma_f32_16x16x32_bf16 a[232:235], a[128:131], a[40:43], a[232:235]
v_mfma_f32_16x16x32_bf16 a[232:235], a[132:135], a[44:47], a[232:235]
v_mfma_f32_16x16x32_bf16 a[240:243], a[128:131], a[48:51], a[240:243]
v_mfma_f32_16x16x32_bf16 a[240:243], a[132:135], a[52:55], a[240:243]
v_mfma_f32_16x16x32_bf16 a[248:251], a[128:131], a[56:59], a[248:251]
v_mfma_f32_16x16x32_bf16 a[248:251], a[132:135], a[60:63], a[248:251]
s_waitcnt vmcnt(4) lgkmcnt(0)
s_barrier
v_mfma_f32_16x16x32_bf16 a[196:199], a[136:139], a[0:3], a[196:199]
s_add_u32 m0, s29, 65536
ds_read_b64_tr_b16 a[128:129], v4 offset:32768
v_mfma_f32_16x16x32_bf16 a[196:199], a[140:143], a[4:7], a[196:199]
buffer_load_dwordx4 v16, s[12:15], s26 offen offset:0 lds
v_mfma_f32_16x16x32_bf16 a[204:207], a[136:139], a[8:11], a[204:207]
ds_read_b64_tr_b16 a[130:131], v4 offset:34816
v_cmp_gt_u32 vcc, 0x100, v245
v_mfma_f32_16x16x32_bf16 a[204:207], a[140:143], a[12:15], a[204:207]
v_mfma_f32_16x16x32_bf16 a[212:215], a[136:139], a[16:19], a[212:215]
ds_read_b64_tr_b16 a[132:133], v4 offset:49152
v_mfma_f32_16x16x32_bf16 a[212:215], a[140:143], a[20:23], a[212:215]
buffer_load_dwordx4 v17, s[12:15], s26 offen offset:1024 lds
v_mfma_f32_16x16x32_bf16 a[220:223], a[136:139], a[24:27], a[220:223]
ds_read_b64_tr_b16 a[134:135], v4 offset:51200
v_mfma_f32_16x16x32_bf16 a[220:223], a[140:143], a[28:31], a[220:223]
v_mfma_f32_16x16x32_bf16 a[228:231], a[136:139], a[32:35], a[228:231]
v_mfma_f32_16x16x32_bf16 a[228:231], a[140:143], a[36:39], a[228:231]
buffer_load_dwordx4 v18, s[12:15], s26 offen offset:2048 lds
v_mfma_f32_16x16x32_bf16 a[236:239], a[136:139], a[40:43], a[236:239]
v_mfma_f32_16x16x32_bf16 a[236:239], a[140:143], a[44:47], a[236:239]
v_mfma_f32_16x16x32_bf16 a[244:247], a[136:139], a[48:51], a[244:247]
v_mfma_f32_16x16x32_bf16 a[244:247], a[140:143], a[52:55], a[244:247]
buffer_load_dwordx4 v19, s[12:15], s26 offen offset:3072 lds
v_mfma_f32_16x16x32_bf16 a[252:255], a[136:139], a[56:59], a[252:255]
s_add_u32 s26, s26, 524288
v_mfma_f32_16x16x32_bf16 a[252:255], a[140:143], a[60:63], a[252:255]
s_waitcnt lgkmcnt(0)
s_mov_b32 s82, s59
s_cbranch_vccnz M_cntspinK
s_branch Lg_1
Lg_1t:
PAD_4:
s_cbranch_execz M_tret
buffer_load_dword v230, v231, s[4:7], s52 offen sc1
v_mfma_f32_16x16x32_bf16 v[32:35], a[128:131], a[64:67], v[32:35]
s_add_u32 m0, s29, 81920
ds_read_b64_tr_b16 a[136:137], v5 offset:32768
v_mfma_f32_16x16x32_bf16 v[32:35], a[132:135], a[68:71], v[32:35]
buffer_load_dwordx4 v16, s[12:15], s27 offen offset:0 lds
v_mfma_f32_16x16x32_bf16 v[40:43], a[128:131], a[72:75], v[40:43]
s_and_b32 s44, s3, 1
ds_read_b64_tr_b16 a[138:139], v5 offset:34816
v_mfma_f32_16x16x32_bf16 v[40:43], a[132:135], a[76:79], v[40:43]
s_lshl_b32 s44, s44, 8
v_mfma_f32_16x16x32_bf16 v[48:51], a[128:131], a[80:83], v[48:51]
s_lshl_b32 s45, s3, 7
ds_read_b64_tr_b16 a[140:141], v5 offset:49152
v_mfma_f32_16x16x32_bf16 v[48:51], a[132:135], a[84:87], v[48:51]
s_xor_b32 s44, s44, s45
buffer_load_dwordx4 v17, s[12:15], s27 offen offset:1024 lds
v_mfma_f32_16x16x32_bf16 v[56:59], a[128:131], a[88:91], v[56:59]
s_xor_b32 s44, s44, 196608
ds_read_b64_tr_b16 a[142:143], v5 offset:51200
v_mfma_f32_16x16x32_bf16 v[56:59], a[132:135], a[92:95], v[56:59]
v_mfma_f32_16x16x32_bf16 v[64:67], a[128:131], a[96:99], v[64:67]
ds_read_b128 a[0:3], v2 offset:0
v_mfma_f32_16x16x32_bf16 v[64:67], a[132:135], a[100:103], v[64:67]
buffer_load_dwordx4 v18, s[12:15], s27 offen offset:2048 lds
v_mfma_f32_16x16x32_bf16 v[72:75], a[128:131], a[104:107], v[72:75]
ds_read_b128 a[4:7], v3 offset:0
v_mfma_f32_16x16x32_bf16 v[72:75], a[132:135], a[108:111], v[72:75]
v_mfma_f32_16x16x32_bf16 v[80:83], a[128:131], a[112:115], v[80:83]
v_mfma_f32_16x16x32_bf16 v[80:83], a[132:135], a[116:119], v[80:83]
buffer_load_dwordx4 v19, s[12:15], s27 offen offset:3072 lds
v_mfma_f32_16x16x32_bf16 v[88:91], a[128:131], a[120:123], v[88:91]
s_add_u32 s27, s27, 524288
ds_read_b128 a[8:11], v2 offset:2048
v_mfma_f32_16x16x32_bf16 v[88:91], a[132:135], a[124:127], v[88:91]
s_waitcnt lgkmcnt(2)
v_mfma_f32_16x16x32_bf16 v[36:39], a[136:139], a[64:67], v[36:39]
s_add_u32 m0, s28, 32768
ds_read_b64_tr_b16 a[128:129], v6 offset:32768
v_mfma_f32_16x16x32_bf16 v[36:39], a[140:143], a[68:71], v[36:39]
buffer_load_dwordx4 v12, s[8:11], s24 offen offset:0 lds
v_mfma_f32_16x16x32_bf16 v[44:47], a[136:139], a[72:75], v[44:47]
ds_read_b64_tr_b16 a[130:131], v6 offset:34816
v_mfma_f32_16x16x32_bf16 v[44:47], a[140:143], a[76:79], v[44:47]
v_mfma_f32_16x16x32_bf16 v[52:55], a[136:139], a[80:83], v[52:55]
s_mov_b64 s[56:57], s[72:73]
ds_read_b64_tr_b16 a[132:133], v6 offset:49152
v_mfma_f32_16x16x32_bf16 v[52:55], a[140:143], a[84:87], v[52:55]
s_mov_b32 s58, 1835008
buffer_load_dwordx4 v13, s[8:11], s24 offen offset:1024 lds
v_mfma_f32_16x16x32_bf16 v[60:63], a[136:139], a[88:91], v[60:63]
s_mov_b32 s59, 0x20000
ds_read_b64_tr_b16 a[134:135], v6 offset:51200
v_mfma_f32_16x16x32_bf16 v[60:63], a[140:143], a[92:95], v[60:63]
v_mfma_f32_16x16x32_bf16 v[68:71], a[136:139], a[96:99], v[68:71]
ds_read_b128 a[12:15], v3 offset:2048
v_mfma_f32_16x16x32_bf16 v[68:71], a[140:143], a[100:103], v[68:71]
buffer_load_dwordx4 v14, s[8:11], s24 offen offset:2048 lds
v_mfma_f32_16x16x32_bf16 v[76:79], a[136:139], a[104:107], v[76:79]
v_mfma_f32_16x16x32_bf16 v[76:79], a[140:143], a[108:111], v[76:79]
v_mfma_f32_16x16x32_bf16 v[84:87], a[136:139], a[112:115], v[84:87]
ds_read_b128 a[16:19], v2 offset:4096
v_mfma_f32_16x16x32_bf16 v[84:87], a[140:143], a[116:119], v[84:87]
buffer_load_dwordx4 v15, s[8:11], s24 offen offset:3072 lds
v_mfma_f32_16x16x32_bf16 v[92:95], a[136:139], a[120:123], v[92:95]
s_add_u32 s24, s24, 128
ds_read_b128 a[20:23], v3 offset:4096
v_mfma_f32_16x16x32_bf16 v[92:95], a[140:143], a[124:127], v[92:95]
s_waitcnt lgkmcnt(2)
v_mfma_f32_16x16x32_bf16 v[96:99], a[128:131], a[64:67], v[96:99]
s_add_u32 m0, s28, 36864
ds_read_b64_tr_b16 a[136:137], v7 offset:32768
v_mfma_f32_16x16x32_bf16 v[96:99], a[132:135], a[68:71], v[96:99]
buffer_load_dwordx4 v12, s[8:11], s25 offen offset:0 lds
v_mfma_f32_16x16x32_bf16 v[104:107], a[128:131], a[72:75], v[104:107]
ds_read_b64_tr_b16 a[138:139], v7 offset:34816
v_mfma_f32_16x16x32_bf16 v[104:107], a[132:135], a[76:79], v[104:107]
v_mfma_f32_16x16x32_bf16 v[112:115], a[128:131], a[80:83], v[112:115]
ds_read_b64_tr_b16 a[140:141], v7 offset:49152
v_mfma_f32_16x16x32_bf16 v[112:115], a[132:135], a[84:87], v[112:115]
buffer_load_dwordx4 v13, s[8:11], s25 offen offset:1024 lds
v_mfma_f32_16x16x32_bf16 v[120:123], a[128:131], a[88:91], v[120:123]
ds_read_b64_tr_b16 a[142:143], v7 offset:51200
v_mfma_f32_16x16x32_bf16 v[120:123], a[132:135], a[92:95], v[120:123]
v_mfma_f32_16x16x32_bf16 v[128:131], a[128:131], a[96:99], v[128:131]
v_mfma_f32_16x16x32_bf16 v[128:131], a[132:135], a[100:103], v[128:131]
buffer_load_dwordx4 v14, s[8:11], s25 offen offset:2048 lds
v_mfma_f32_16x16x32_bf16 v[136:139], a[128:131], a[104:107], v[136:139]
ds_read_b128 a[24:27], v2 offset:6144
v_mfma_f32_16x16x32_bf16 v[136:139], a[132:135], a[108:111], v[136:139]
v_mfma_f32_16x16x32_bf16 v[144:147], a[128:131], a[112:115], v[144:147]
ds_read_b128 a[28:31], v3 offset:6144
v_mfma_f32_16x16x32_bf16 v[144:147], a[132:135], a[116:119], v[144:147]
buffer_load_dwordx4 v15, s[8:11], s25 offen offset:3072 lds
v_mfma_f32_16x16x32_bf16 v[152:155], a[128:131], a[120:123], v[152:155]
s_add_u32 s25, s25, 128
s_waitcnt vmcnt(12)
v_mfma_f32_16x16x32_bf16 v[152:155], a[132:135], a[124:127], v[152:155]
s_waitcnt lgkmcnt(2)
v_cmp_gt_u32 vcc, 1, v230
v_mfma_f32_16x16x32_bf16 v[100:103], a[136:139], a[64:67], v[100:103]
s_cbranch_vccnz M_ppspinK
M_ppokK:
ds_read_b64_tr_b16 a[128:129], v8 offset:32768
v_mfma_f32_16x16x32_bf16 v[100:103], a[140:143], a[68:71], v[100:103]
buffer_load_dword v230, v229, s[4:7], s53 offen sc1
v_mfma_f32_16x16x32_bf16 v[108:111], a[136:139], a[72:75], v[108:111]
s_mov_b64 s[8:9], s[76:77]
ds_read_b64_tr_b16 a[130:131], v8 offset:34816
v_mfma_f32_16x16x32_bf16 v[108:111], a[140:143], a[76:79], v[108:111]
s_mov_b32 s10, 1835008
buffer_load_dword v230, v229, s[4:7], s48 offen sc1
v_mfma_f32_16x16x32_bf16 v[116:119], a[136:139], a[80:83], v[116:119]
s_lshl_b32 s24, s37, 2
ds_read_b64_tr_b16 a[132:133], v8 offset:49152
v_mfma_f32_16x16x32_bf16 v[116:119], a[140:143], a[84:87], v[116:119]
s_add_u32 s24, s24, s3
buffer_load_dword v230, v229, s[56:59], s49 offen
v_mfma_f32_16x16x32_bf16 v[124:127], a[136:139], a[88:91], v[124:127]
s_mul_i32 s24, s24, 28672
ds_read_b64_tr_b16 a[134:135], v8 offset:51200
v_mfma_f32_16x16x32_bf16 v[124:127], a[140:143], a[92:95], v[124:127]
s_mov_b32 s28, s29
buffer_load_dword v21, v20, s[16:19], s43 offen
v_mfma_f32_16x16x32_bf16 v[132:135], a[136:139], a[96:99], v[132:135]
ds_read_b128 a[32:35], v2 offset:8192
v_mfma_f32_16x16x32_bf16 v[132:135], a[140:143], a[100:103], v[132:135]
v_mfma_f32_16x16x32_bf16 v[140:143], a[136:139], a[104:107], v[140:143]
v_mfma_f32_16x16x32_bf16 v[140:143], a[140:143], a[108:111], v[140:143]
v_mfma_f32_16x16x32_bf16 v[148:151], a[136:139], a[112:115], v[148:151]
ds_read_b128 a[36:39], v3 offset:8192
v_lshrrev_b32 v28, 7, v1
v_mfma_f32_16x16x32_bf16 v[148:151], a[140:143], a[116:119], v[148:151]
v_lshrrev_b32 v29, 1, v28
v_lshlrev_b32 v29, 4, v29
v_mfma_f32_16x16x32_bf16 v[156:159], a[136:139], a[120:123], v[156:159]
ds_read_b128 a[40:43], v2 offset:10240
v_and_b32 v30, 0x70, v1
v_mfma_f32_16x16x32_bf16 v[156:159], a[140:143], a[124:127], v[156:159]
s_waitcnt lgkmcnt(2)
v_xor_b32 v29, v29, v30
v_mul_u32_u24 v28, 896, v28
v_mfma_f32_16x16x32_bf16 v[160:163], a[128:131], a[64:67], v[160:163]
ds_read_b64_tr_b16 a[136:137], v9 offset:32768
v_add_u32 v12, v28, v29
v_mfma_f32_16x16x32_bf16 v[160:163], a[132:135], a[68:71], v[160:163]
v_xor_b32 v29, 64, v29
v_add_u32 v28, v28, v29
v_mfma_f32_16x16x32_bf16 v[168:171], a[128:131], a[72:75], v[168:171]
ds_read_b64_tr_b16 a[138:139], v9 offset:34816
v_add_u32 v13, 6144, v28
v_mfma_f32_16x16x32_bf16 v[168:171], a[132:135], a[76:79], v[168:171]
v_add_u32 v14, 12288, v12
v_add_u32 v15, 18432, v28
v_mfma_f32_16x16x32_bf16 v[176:179], a[128:131], a[80:83], v[176:179]
ds_read_b64_tr_b16 a[140:141], v9 offset:49152
v_xor_b32 v22, s44, v4
v_mfma_f32_16x16x32_bf16 v[176:179], a[132:135], a[84:87], v[176:179]
v_xor_b32 v23, 32, v22
v_xor_b32 v24, 64, v22
v_mfma_f32_16x16x32_bf16 v[184:187], a[128:131], a[88:91], v[184:187]
ds_read_b64_tr_b16 a[142:143], v9 offset:51200
v_xor_b32 v25, 96, v22
v_mfma_f32_16x16x32_bf16 v[184:187], a[132:135], a[92:95], v[184:187]
v_mfma_f32_16x16x32_bf16 v[192:195], a[128:131], a[96:99], v[192:195]
v_mfma_f32_16x16x32_bf16 v[192:195], a[132:135], a[100:103], v[192:195]
v_mfma_f32_16x16x32_bf16 v[200:203], a[128:131], a[104:107], v[200:203]
ds_read_b128 a[44:47], v3 offset:10240
v_mfma_f32_16x16x32_bf16 v[200:203], a[132:135], a[108:111], v[200:203]
v_mfma_f32_16x16x32_bf16 v[208:211], a[128:131], a[112:115], v[208:211]
ds_read_b128 a[48:51], v2 offset:12288
v_mfma_f32_16x16x32_bf16 v[208:211], a[132:135], a[116:119], v[208:211]
v_mfma_f32_16x16x32_bf16 v[216:219], a[128:131], a[120:123], v[216:219]
v_mfma_f32_16x16x32_bf16 v[216:219], a[132:135], a[124:127], v[216:219]
s_waitcnt lgkmcnt(2)
v_mfma_f32_16x16x32_bf16 v[164:167], a[136:139], a[64:67], v[164:167]
ds_read_b64_tr_b16 a[128:129], v10 offset:32768
v_mfma_f32_16x16x32_bf16 v[164:167], a[140:143], a[68:71], v[164:167]
v_mfma_f32_16x16x32_bf16 v[172:175], a[136:139], a[72:75], v[172:175]
ds_read_b64_tr_b16 a[130:131], v10 offset:34816
v_mfma_f32_16x16x32_bf16 v[172:175], a[140:143], a[76:79], v[172:175]
v_mfma_f32_16x16x32_bf16 v[180:183], a[136:139], a[80:83], v[180:183]
ds_read_b64_tr_b16 a[132:133], v10 offset:49152
v_mfma_f32_16x16x32_bf16 v[180:183], a[140:143], a[84:87], v[180:183]
v_mfma_f32_16x16x32_bf16 v[188:191], a[136:139], a[88:91], v[188:191]
ds_read_b64_tr_b16 a[134:135], v10 offset:51200
v_mfma_f32_16x16x32_bf16 v[188:191], a[140:143], a[92:95], v[188:191]
v_mfma_f32_16x16x32_bf16 v[196:199], a[136:139], a[96:99], v[196:199]
ds_read_b128 a[52:55], v3 offset:12288
v_mfma_f32_16x16x32_bf16 v[196:199], a[140:143], a[100:103], v[196:199]
v_mfma_f32_16x16x32_bf16 v[204:207], a[136:139], a[104:107], v[204:207]
ds_read_b128 a[56:59], v2 offset:14336
v_mfma_f32_16x16x32_bf16 v[204:207], a[140:143], a[108:111], v[204:207]
v_mfma_f32_16x16x32_bf16 v[212:215], a[136:139], a[112:115], v[212:215]
v_mfma_f32_16x16x32_bf16 v[212:215], a[140:143], a[116:119], v[212:215]
v_mfma_f32_16x16x32_bf16 v[220:223], a[136:139], a[120:123], v[220:223]
ds_read_b128 a[60:63], v3 offset:14336
v_mfma_f32_16x16x32_bf16 v[220:223], a[140:143], a[124:127], v[220:223]
s_waitcnt lgkmcnt(2)
v_mfma_f32_16x16x32_bf16 a[192:195], a[128:131], a[64:67], a[192:195]
ds_read_b64_tr_b16 a[136:137], v11 offset:32768
v_mfma_f32_16x16x32_bf16 a[192:195], a[132:135], a[68:71], a[192:195]
v_mfma_f32_16x16x32_bf16 a[200:203], a[128:131], a[72:75], a[200:203]
ds_read_b64_tr_b16 a[138:139], v11 offset:34816
v_mfma_f32_16x16x32_bf16 a[200:203], a[132:135], a[76:79], a[200:203]
v_mfma_f32_16x16x32_bf16 a[208:211], a[128:131], a[80:83], a[208:211]
ds_read_b64_tr_b16 a[140:141], v11 offset:49152
v_mfma_f32_16x16x32_bf16 a[208:211], a[132:135], a[84:87], a[208:211]
v_mfma_f32_16x16x32_bf16 a[216:219], a[128:131], a[88:91], a[216:219]
ds_read_b64_tr_b16 a[142:143], v11 offset:51200
v_mfma_f32_16x16x32_bf16 a[216:219], a[132:135], a[92:95], a[216:219]
v_mfma_f32_16x16x32_bf16 a[224:227], a[128:131], a[96:99], a[224:227]
v_mfma_f32_16x16x32_bf16 a[224:227], a[132:135], a[100:103], a[224:227]
v_mfma_f32_16x16x32_bf16 a[232:235], a[128:131], a[104:107], a[232:235]
v_mfma_f32_16x16x32_bf16 a[232:235], a[132:135], a[108:111], a[232:235]
v_mfma_f32_16x16x32_bf16 a[240:243], a[128:131], a[112:115], a[240:243]
v_mfma_f32_16x16x32_bf16 a[240:243], a[132:135], a[116:119], a[240:243]
v_mfma_f32_16x16x32_bf16 a[248:251], a[128:131], a[120:123], a[248:251]
v_mfma_f32_16x16x32_bf16 a[248:251], a[132:135], a[124:127], a[248:251]
s_waitcnt vmcnt(4) lgkmcnt(0)
s_barrier
v_mfma_f32_16x16x32_bf16 a[196:199], a[136:139], a[64:67], a[196:199]
s_add_u32 m0, s29, 98304
ds_read_b64_tr_b16 a[128:129], v4 offset:0
v_mfma_f32_16x16x32_bf16 a[196:199], a[140:143], a[68:71], a[196:199]
buffer_load_dwordx4 v16, s[12:15], s26 offen offset:0 lds
v_mfma_f32_16x16x32_bf16 a[204:207], a[136:139], a[72:75], a[204:207]
ds_read_b64_tr_b16 a[130:131], v4 offset:2048
v_mfma_f32_16x16x32_bf16 a[204:207], a[140:143], a[76:79], a[204:207]
v_mfma_f32_16x16x32_bf16 a[212:215], a[136:139], a[80:83], a[212:215]
ds_read_b64_tr_b16 a[132:133], v4 offset:16384
v_mfma_f32_16x16x32_bf16 a[212:215], a[140:143], a[84:87], a[212:215]
buffer_load_dwordx4 v17, s[12:15], s26 offen offset:1024 lds
v_mfma_f32_16x16x32_bf16 a[220:223], a[136:139], a[88:91], a[220:223]
ds_read_b64_tr_b16 a[134:135], v4 offset:18432
v_mfma_f32_16x16x32_bf16 a[220:223], a[140:143], a[92:95], a[220:223]
v_mfma_f32_16x16x32_bf16 a[228:231], a[136:139], a[96:99], a[228:231]
v_mfma_f32_16x16x32_bf16 a[228:231], a[140:143], a[100:103], a[228:231]
buffer_load_dwordx4 v18, s[12:15], s26 offen offset:2048 lds
v_mfma_f32_16x16x32_bf16 a[236:239], a[136:139], a[104:107], a[236:239]
v_mfma_f32_16x16x32_bf16 a[236:239], a[140:143], a[108:111], a[236:239]
v_mfma_f32_16x16x32_bf16 a[244:247], a[136:139], a[112:115], a[244:247]
v_mfma_f32_16x16x32_bf16 a[244:247], a[140:143], a[116:119], a[244:247]
buffer_load_dwordx4 v19, s[12:15], s26 offen offset:3072 lds
v_mfma_f32_16x16x32_bf16 a[252:255], a[136:139], a[120:123], a[252:255]
s_add_u32 s26, s26, 524288
v_mfma_f32_16x16x32_bf16 a[252:255], a[140:143], a[124:127], a[252:255]
s_waitcnt lgkmcnt(0)
v_mfma_f32_16x16x32_bf16 v[32:35], a[128:131], a[0:3], v[32:35]
s_add_u32 m0, s29, 114688
ds_read_b64_tr_b16 a[136:137], v5 offset:0
v_mfma_f32_16x16x32_bf16 v[32:35], a[132:135], a[4:7], v[32:35]
buffer_load_dwordx4 v16, s[12:15], s27 offen offset:0 lds
v_mfma_f32_16x16x32_bf16 v[40:43], a[128:131], a[8:11], v[40:43]
ds_read_b64_tr_b16 a[138:139], v5 offset:2048
v_mfma_f32_16x16x32_bf16 v[40:43], a[132:135], a[12:15], v[40:43]
v_mfma_f32_16x16x32_bf16 v[48:51], a[128:131], a[16:19], v[48:51]
ds_read_b64_tr_b16 a[140:141], v5 offset:16384
v_mfma_f32_16x16x32_bf16 v[48:51], a[132:135], a[20:23], v[48:51]
buffer_load_dwordx4 v17, s[12:15], s27 offen offset:1024 lds
v_mfma_f32_16x16x32_bf16 v[56:59], a[128:131], a[24:27], v[56:59]
ds_read_b64_tr_b16 a[142:143], v5 offset:18432
v_mfma_f32_16x16x32_bf16 v[56:59], a[132:135], a[28:31], v[56:59]
v_mfma_f32_16x16x32_bf16 v[64:67], a[128:131], a[32:35], v[64:67]
ds_read_b128 a[64:67], v2 offset:32768
v_mfma_f32_16x16x32_bf16 v[64:67], a[132:135], a[36:39], v[64:67]
buffer_load_dwordx4 v18, s[12:15], s27 offen offset:2048 lds
v_mfma_f32_16x16x32_bf16 v[72:75], a[128:131], a[40:43], v[72:75]
ds_read_b128 a[68:71], v3 offset:32768
v_mfma_f32_16x16x32_bf16 v[72:75], a[132:135], a[44:47], v[72:75]
v_mfma_f32_16x16x32_bf16 v[80:83], a[128:131], a[48:51], v[80:83]
v_mfma_f32_16x16x32_bf16 v[80:83], a[132:135], a[52:55], v[80:83]
buffer_load_dwordx4 v19, s[12:15], s27 offen offset:3072 lds
v_mfma_f32_16x16x32_bf16 v[88:91], a[128:131], a[56:59], v[88:91]
s_add_u32 s27, s27, 524288
ds_read_b128 a[72:75], v2 offset:34816
v_mfma_f32_16x16x32_bf16 v[88:91], a[132:135], a[60:63], v[88:91]
s_waitcnt lgkmcnt(2)
v_mfma_f32_16x16x32_bf16 v[36:39], a[136:139], a[0:3], v[36:39]
s_add_u32 m0, s28, 0
ds_read_b64_tr_b16 a[128:129], v6 offset:0
v_mfma_f32_16x16x32_bf16 v[36:39], a[140:143], a[4:7], v[36:39]
buffer_load_dwordx4 v12, s[8:11], s24 offen offset:0 lds
v_mfma_f32_16x16x32_bf16 v[44:47], a[136:139], a[8:11], v[44:47]
ds_read_b64_tr_b16 a[130:131], v6 offset:2048
v_mfma_f32_16x16x32_bf16 v[44:47], a[140:143], a[12:15], v[44:47]
v_mfma_f32_16x16x32_bf16 v[52:55], a[136:139], a[16:19], v[52:55]
ds_read_b64_tr_b16 a[132:133], v6 offset:16384
v_mfma_f32_16x16x32_bf16 v[52:55], a[140:143], a[20:23], v[52:55]
buffer_load_dwordx4 v13, s[8:11], s24 offen offset:1024 lds
v_mfma_f32_16x16x32_bf16 v[60:63], a[136:139], a[24:27], v[60:63]
ds_read_b64_tr_b16 a[134:135], v6 offset:18432
v_mfma_f32_16x16x32_bf16 v[60:63], a[140:143], a[28:31], v[60:63]
v_mfma_f32_16x16x32_bf16 v[68:71], a[136:139], a[32:35], v[68:71]
ds_read_b128 a[76:79], v3 offset:34816
v_mfma_f32_16x16x32_bf16 v[68:71], a[140:143], a[36:39], v[68:71]
buffer_load_dwordx4 v14, s[8:11], s24 offen offset:2048 lds
v_mfma_f32_16x16x32_bf16 v[76:79], a[136:139], a[40:43], v[76:79]
v_mfma_f32_16x16x32_bf16 v[76:79], a[140:143], a[44:47], v[76:79]
v_mfma_f32_16x16x32_bf16 v[84:87], a[136:139], a[48:51], v[84:87]
ds_read_b128 a[80:83], v2 offset:36864
v_mfma_f32_16x16x32_bf16 v[84:87], a[140:143], a[52:55], v[84:87]
buffer_load_dwordx4 v15, s[8:11], s24 offen offset:3072 lds
v_mfma_f32_16x16x32_bf16 v[92:95], a[136:139], a[56:59], v[92:95]
s_add_u32 s24, s24, 128
ds_read_b128 a[84:87], v3 offset:36864
v_mfma_f32_16x16x32_bf16 v[92:95], a[140:143], a[60:63], v[92:95]
s_waitcnt lgkmcnt(2)
s_mov_b64 s[12:13], s[80:81]
v_mfma_f32_16x16x32_bf16 v[96:99], a[128:131], a[0:3], v[96:99]
s_mov_b32 s14, 3670016
s_add_u32 m0, s28, 16384
ds_read_b64_tr_b16 a[136:137], v7 offset:0
v_mfma_f32_16x16x32_bf16 v[96:99], a[132:135], a[4:7], v[96:99]
buffer_load_dwordx4 v12, s[8:11], s24 offen offset:0 lds
v_mfma_f32_16x16x32_bf16 v[104:107], a[128:131], a[8:11], v[104:107]
ds_read_b64_tr_b16 a[138:139], v7 offset:2048
v_mfma_f32_16x16x32_bf16 v[104:107], a[132:135], a[12:15], v[104:107]
v_mfma_f32_16x16x32_bf16 v[112:115], a[128:131], a[16:19], v[112:115]
ds_read_b64_tr_b16 a[140:141], v7 offset:16384
v_mfma_f32_16x16x32_bf16 v[112:115], a[132:135], a[20:23], v[112:115]
buffer_load_dwordx4 v13, s[8:11], s24 offen offset:1024 lds
v_mfma_f32_16x16x32_bf16 v[120:123], a[128:131], a[24:27], v[120:123]
ds_read_b64_tr_b16 a[142:143], v7 offset:18432
v_mfma_f32_16x16x32_bf16 v[120:123], a[132:135], a[28:31], v[120:123]
v_mfma_f32_16x16x32_bf16 v[128:131], a[128:131], a[32:35], v[128:131]
v_mfma_f32_16x16x32_bf16 v[128:131], a[132:135], a[36:39], v[128:131]
buffer_load_dwordx4 v14, s[8:11], s24 offen offset:2048 lds
v_mfma_f32_16x16x32_bf16 v[136:139], a[128:131], a[40:43], v[136:139]
ds_read_b128 a[88:91], v2 offset:38912
v_mfma_f32_16x16x32_bf16 v[136:139], a[132:135], a[44:47], v[136:139]
v_mfma_f32_16x16x32_bf16 v[144:147], a[128:131], a[48:51], v[144:147]
ds_read_b128 a[92:95], v3 offset:38912
v_mfma_f32_16x16x32_bf16 v[144:147], a[132:135], a[52:55], v[144:147]
buffer_load_dwordx4 v15, s[8:11], s24 offen offset:3072 lds
v_mfma_f32_16x16x32_bf16 v[152:155], a[128:131], a[56:59], v[152:155]
s_add_u32 s24, s24, 128
v_mfma_f32_16x16x32_bf16 v[152:155], a[132:135], a[60:63], v[152:155]
s_waitcnt lgkmcnt(2)
s_sub_u32 s26, s26, 8388608
v_mfma_f32_16x16x32_bf16 v[100:103], a[136:139], a[0:3], v[100:103]
s_sub_u32 s27, s27, 8388608
s_add_u32 m0, s29, 131072
ds_read_b64_tr_b16 a[128:129], v8 offset:0
v_mfma_f32_16x16x32_bf16 v[100:103], a[140:143], a[4:7], v[100:103]
PAD_5:
s_cbranch_execz M_tret
buffer_load_dwordx4 v16, s[12:15], s26 offen offset:0 lds
v_mfma_f32_16x16x32_bf16 v[108:111], a[136:139], a[8:11], v[108:111]
ds_read_b64_tr_b16 a[130:131], v8 offset:2048
v_mfma_f32_16x16x32_bf16 v[108:111], a[140:143], a[12:15], v[108:111]
v_mfma_f32_16x16x32_bf16 v[116:119], a[136:139], a[16:19], v[116:119]
ds_read_b64_tr_b16 a[132:133], v8 offset:16384
v_mfma_f32_16x16x32_bf16 v[116:119], a[140:143], a[20:23], v[116:119]
buffer_load_dwordx4 v17, s[12:15], s26 offen offset:1024 lds
v_mfma_f32_16x16x32_bf16 v[124:127], a[136:139], a[24:27], v[124:127]
ds_read_b64_tr_b16 a[134:135], v8 offset:18432
v_mfma_f32_16x16x32_bf16 v[124:127], a[140:143], a[28:31], v[124:127]
v_mfma_f32_16x16x32_bf16 v[132:135], a[136:139], a[32:35], v[132:135]
ds_read_b128 a[96:99], v2 offset:40960
v_mfma_f32_16x16x32_bf16 v[132:135], a[140:143], a[36:39], v[132:135]
buffer_load_dwordx4 v18, s[12:15], s26 offen offset:2048 lds
v_mfma_f32_16x16x32_bf16 v[140:143], a[136:139], a[40:43], v[140:143]
v_mfma_f32_16x16x32_bf16 v[140:143], a[140:143], a[44:47], v[140:143]
v_mfma_f32_16x16x32_bf16 v[148:151], a[136:139], a[48:51], v[148:151]
ds_read_b128 a[100:103], v3 offset:40960
v_mfma_f32_16x16x32_bf16 v[148:151], a[140:143], a[52:55], v[148:151]
buffer_load_dwordx4 v19, s[12:15], s26 offen offset:3072 lds
v_mfma_f32_16x16x32_bf16 v[156:159], a[136:139], a[56:59], v[156:159]
s_add_u32 s26, s26, 524288
ds_read_b128 a[104:107], v2 offset:43008
v_mfma_f32_16x16x32_bf16 v[156:159], a[140:143], a[60:63], v[156:159]
s_waitcnt lgkmcnt(2)
v_mfma_f32_16x16x32_bf16 v[160:163], a[128:131], a[0:3], v[160:163]
s_add_u32 m0, s29, 147456
ds_read_b64_tr_b16 a[136:137], v9 offset:0
v_mfma_f32_16x16x32_bf16 v[160:163], a[132:135], a[4:7], v[160:163]
buffer_load_dwordx4 v16, s[12:15], s27 offen offset:0 lds
v_mfma_f32_16x16x32_bf16 v[168:171], a[128:131], a[8:11], v[168:171]
ds_read_b64_tr_b16 a[138:139], v9 offset:2048
v_mfma_f32_16x16x32_bf16 v[168:171], a[132:135], a[12:15], v[168:171]
v_mfma_f32_16x16x32_bf16 v[176:179], a[128:131], a[16:19], v[176:179]
ds_read_b64_tr_b16 a[140:141], v9 offset:16384
v_mfma_f32_16x16x32_bf16 v[176:179], a[132:135], a[20:23], v[176:179]
buffer_load_dwordx4 v17, s[12:15], s27 offen offset:1024 lds
v_mfma_f32_16x16x32_bf16 v[184:187], a[128:131], a[24:27], v[184:187]
ds_read_b64_tr_b16 a[142:143], v9 offset:18432
v_mfma_f32_16x16x32_bf16 v[184:187], a[132:135], a[28:31], v[184:187]
v_mfma_f32_16x16x32_bf16 v[192:195], a[128:131], a[32:35], v[192:195]
v_mfma_f32_16x16x32_bf16 v[192:195], a[132:135], a[36:39], v[192:195]
buffer_load_dwordx4 v18, s[12:15], s27 offen offset:2048 lds
v_mfma_f32_16x16x32_bf16 v[200:203], a[128:131], a[40:43], v[200:203]
ds_read_b128 a[108:111], v3 offset:43008
v_mfma_f32_16x16x32_bf16 v[200:203], a[132:135], a[44:47], v[200:203]
v_mfma_f32_16x16x32_bf16 v[208:211], a[128:131], a[48:51], v[208:211]
ds_read_b128 a[112:115], v2 offset:45056
v_mfma_f32_16x16x32_bf16 v[208:211], a[132:135], a[52:55], v[208:211]
buffer_load_dwordx4 v19, s[12:15], s27 offen offset:3072 lds
v_mfma_f32_16x16x32_bf16 v[216:219], a[128:131], a[56:59], v[216:219]
s_add_u32 s27, s27, 524288
v_mfma_f32_16x16x32_bf16 v[216:219], a[132:135], a[60:63], v[216:219]
s_waitcnt lgkmcnt(2)
v_mfma_f32_16x16x32_bf16 v[164:167], a[136:139], a[0:3], v[164:167]
ds_read_b64_tr_b16 a[128:129], v10 offset:0
v_mfma_f32_16x16x32_bf16 v[164:167], a[140:143], a[4:7], v[164:167]
v_mfma_f32_16x16x32_bf16 v[172:175], a[136:139], a[8:11], v[172:175]
ds_read_b64_tr_b16 a[130:131], v10 offset:2048
v_mfma_f32_16x16x32_bf16 v[172:175], a[140:143], a[12:15], v[172:175]
v_mfma_f32_16x16x32_bf16 v[180:183], a[136:139], a[16:19], v[180:183]
ds_read_b64_tr_b16 a[132:133], v10 offset:16384
v_mfma_f32_16x16x32_bf16 v[180:183], a[140:143], a[20:23], v[180:183]
v_mfma_f32_16x16x32_bf16 v[188:191], a[136:139], a[24:27], v[188:191]
ds_read_b64_tr_b16 a[134:135], v10 offset:18432
v_mfma_f32_16x16x32_bf16 v[188:191], a[140:143], a[28:31], v[188:191]
v_mfma_f32_16x16x32_bf16 v[196:199], a[136:139], a[32:35], v[196:199]
ds_read_b128 a[116:119], v3 offset:45056
v_mfma_f32_16x16x32_bf16 v[196:199], a[140:143], a[36:39], v[196:199]
v_mfma_f32_16x16x32_bf16 v[204:207], a[136:139], a[40:43], v[204:207]
ds_read_b128 a[120:123], v2 offset:47104
v_mfma_f32_16x16x32_bf16 v[204:207], a[140:143], a[44:47], v[204:207]
v_mfma_f32_16x16x32_bf16 v[212:215], a[136:139], a[48:51], v[212:215]
v_mfma_f32_16x16x32_bf16 v[212:215], a[140:143], a[52:55], v[212:215]
v_mfma_f32_16x16x32_bf16 v[220:223], a[136:139], a[56:59], v[220:223]
ds_read_b128 a[124:127], v3 offset:47104
v_mfma_f32_16x16x32_bf16 v[220:223], a[140:143], a[60:63], v[220:223]
s_waitcnt lgkmcnt(2)
v_mfma_f32_16x16x32_bf16 a[192:195], a[128:131], a[0:3], a[192:195]
ds_read_b64_tr_b16 a[136:137], v11 offset:0
v_mfma_f32_16x16x32_bf16 a[192:195], a[132:135], a[4:7], a[192:195]
v_mfma_f32_16x16x32_bf16 a[200:203], a[128:131], a[8:11], a[200:203]
ds_read_b64_tr_b16 a[138:139], v11 offset:2048
v_mfma_f32_16x16x32_bf16 a[200:203], a[132:135], a[12:15], a[200:203]
v_mfma_f32_16x16x32_bf16 a[208:211], a[128:131], a[16:19], a[208:211]
ds_read_b64_tr_b16 a[140:141], v11 offset:16384
v_mfma_f32_16x16x32_bf16 a[208:211], a[132:135], a[20:23], a[208:211]
v_mfma_f32_16x16x32_bf16 a[216:219], a[128:131], a[24:27], a[216:219]
ds_read_b64_tr_b16 a[142:143], v11 offset:18432
v_mfma_f32_16x16x32_bf16 a[216:219], a[132:135], a[28:31], a[216:219]
v_mfma_f32_16x16x32_bf16 a[224:227], a[128:131], a[32:35], a[224:227]
v_mfma_f32_16x16x32_bf16 a[224:227], a[132:135], a[36:39], a[224:227]
v_mfma_f32_16x16x32_bf16 a[232:235], a[128:131], a[40:43], a[232:235]
v_mfma_f32_16x16x32_bf16 a[232:235], a[132:135], a[44:47], a[232:235]
v_mfma_f32_16x16x32_bf16 a[240:243], a[128:131], a[48:51], a[240:243]
v_mfma_f32_16x16x32_bf16 a[240:243], a[132:135], a[52:55], a[240:243]
v_mfma_f32_16x16x32_bf16 a[248:251], a[128:131], a[56:59], a[248:251]
v_mfma_f32_16x16x32_bf16 a[248:251], a[132:135], a[60:63], a[248:251]
s_waitcnt vmcnt(12) lgkmcnt(0)
s_barrier
v_mfma_f32_16x16x32_bf16 a[196:199], a[136:139], a[0:3], a[196:199]
s_add_u32 m0, s28, 32768
ds_read_b64_tr_b16 a[128:129], v4 offset:32768
v_mfma_f32_16x16x32_bf16 a[196:199], a[140:143], a[4:7], a[196:199]
s_lshr_b32 s22, s3, 1
buffer_load_dwordx4 v12, s[8:11], s24 offen offset:0 lds
v_mfma_f32_16x16x32_bf16 a[204:207], a[136:139], a[8:11], a[204:207]
s_lshl_b32 s22, s22, 14
ds_read_b64_tr_b16 a[130:131], v4 offset:34816
v_subrev_u32 v2, s22, v2
v_mfma_f32_16x16x32_bf16 a[204:207], a[140:143], a[12:15], a[204:207]
v_subrev_u32 v3, s22, v3
v_mfma_f32_16x16x32_bf16 a[212:215], a[136:139], a[16:19], a[212:215]
ds_read_b64_tr_b16 a[132:133], v4 offset:49152
v_mfma_f32_16x16x32_bf16 a[212:215], a[140:143], a[20:23], a[212:215]
buffer_load_dwordx4 v13, s[8:11], s24 offen offset:1024 lds
v_mfma_f32_16x16x32_bf16 a[220:223], a[136:139], a[24:27], a[220:223]
ds_read_b64_tr_b16 a[134:135], v4 offset:51200
v_mfma_f32_16x16x32_bf16 a[220:223], a[140:143], a[28:31], a[220:223]
v_mfma_f32_16x16x32_bf16 a[228:231], a[136:139], a[32:35], a[228:231]
v_mfma_f32_16x16x32_bf16 a[228:231], a[140:143], a[36:39], a[228:231]
buffer_load_dwordx4 v14, s[8:11], s24 offen offset:2048 lds
v_mfma_f32_16x16x32_bf16 a[236:239], a[136:139], a[40:43], a[236:239]
v_mfma_f32_16x16x32_bf16 a[236:239], a[140:143], a[44:47], a[236:239]
v_mfma_f32_16x16x32_bf16 a[244:247], a[136:139], a[48:51], a[244:247]
v_mfma_f32_16x16x32_bf16 a[244:247], a[140:143], a[52:55], a[244:247]
buffer_load_dwordx4 v15, s[8:11], s24 offen offset:3072 lds
v_mfma_f32_16x16x32_bf16 a[252:255], a[136:139], a[56:59], a[252:255]
s_add_u32 s24, s24, 128
v_mfma_f32_16x16x32_bf16 a[252:255], a[140:143], a[60:63], a[252:255]
s_waitcnt lgkmcnt(0)
v_mfma_f32_16x16x32_bf16 v[32:35], a[128:131], a[64:67], v[32:35]
s_add_u32 m0, s29, 65536
ds_read_b64_tr_b16 a[136:137], v5 offset:32768
v_mfma_f32_16x16x32_bf16 v[32:35], a[132:135], a[68:71], v[32:35]
buffer_load_dwordx4 v16, s[12:15], s26 offen offset:0 lds
v_mfma_f32_16x16x32_bf16 v[40:43], a[128:131], a[72:75], v[40:43]
ds_read_b64_tr_b16 a[138:139], v5 offset:34816
v_mfma_f32_16x16x32_bf16 v[40:43], a[132:135], a[76:79], v[40:43]
v_mfma_f32_16x16x32_bf16 v[48:51], a[128:131], a[80:83], v[48:51]
ds_read_b64_tr_b16 a[140:141], v5 offset:49152
v_mfma_f32_16x16x32_bf16 v[48:51], a[132:135], a[84:87], v[48:51]
buffer_load_dwordx4 v17, s[12:15], s26 offen offset:1024 lds
v_mfma_f32_16x16x32_bf16 v[56:59], a[128:131], a[88:91], v[56:59]
ds_read_b64_tr_b16 a[142:143], v5 offset:51200
v_mfma_f32_16x16x32_bf16 v[56:59], a[132:135], a[92:95], v[56:59]
v_mfma_f32_16x16x32_bf16 v[64:67], a[128:131], a[96:99], v[64:67]
ds_read_b128 a[0:3], v2 offset:0
v_mfma_f32_16x16x32_bf16 v[64:67], a[132:135], a[100:103], v[64:67]
buffer_load_dwordx4 v18, s[12:15], s26 offen offset:2048 lds
v_mfma_f32_16x16x32_bf16 v[72:75], a[128:131], a[104:107], v[72:75]
ds_read_b128 a[4:7], v3 offset:0
v_mfma_f32_16x16x32_bf16 v[72:75], a[132:135], a[108:111], v[72:75]
v_mfma_f32_16x16x32_bf16 v[80:83], a[128:131], a[112:115], v[80:83]
v_mfma_f32_16x16x32_bf16 v[80:83], a[132:135], a[116:119], v[80:83]
buffer_load_dwordx4 v19, s[12:15], s26 offen offset:3072 lds
v_mfma_f32_16x16x32_bf16 v[88:91], a[128:131], a[120:123], v[88:91]
s_add_u32 s26, s26, 524288
ds_read_b128 a[8:11], v2 offset:2048
v_mfma_f32_16x16x32_bf16 v[88:91], a[132:135], a[124:127], v[88:91]
s_waitcnt lgkmcnt(2)
v_mfma_f32_16x16x32_bf16 v[36:39], a[136:139], a[64:67], v[36:39]
s_add_u32 m0, s29, 81920
ds_read_b64_tr_b16 a[128:129], v6 offset:32768
v_mfma_f32_16x16x32_bf16 v[36:39], a[140:143], a[68:71], v[36:39]
buffer_load_dwordx4 v16, s[12:15], s27 offen offset:0 lds
v_mfma_f32_16x16x32_bf16 v[44:47], a[136:139], a[72:75], v[44:47]
ds_read_b64_tr_b16 a[130:131], v6 offset:34816
v_mfma_f32_16x16x32_bf16 v[44:47], a[140:143], a[76:79], v[44:47]
v_mfma_f32_16x16x32_bf16 v[52:55], a[136:139], a[80:83], v[52:55]
ds_read_b64_tr_b16 a[132:133], v6 offset:49152
v_mfma_f32_16x16x32_bf16 v[52:55], a[140:143], a[84:87], v[52:55]
buffer_load_dwordx4 v17, s[12:15], s27 offen offset:1024 lds
v_mfma_f32_16x16x32_bf16 v[60:63], a[136:139], a[88:91], v[60:63]
ds_read_b64_tr_b16 a[134:135], v6 offset:51200
v_cvt_pk_bf16_f32 v32, v32, v33
v_mfma_f32_16x16x32_bf16 v[60:63], a[140:143], a[92:95], v[60:63]
v_cvt_pk_bf16_f32 v33, v34, v35
v_cvt_pk_bf16_f32 v34, v36, v37
v_mfma_f32_16x16x32_bf16 v[68:71], a[136:139], a[96:99], v[68:71]
ds_read_b128 a[12:15], v3 offset:2048
v_cvt_pk_bf16_f32 v35, v38, v39
v_mfma_f32_16x16x32_bf16 v[68:71], a[140:143], a[100:103], v[68:71]
buffer_load_dwordx4 v18, s[12:15], s27 offen offset:2048 lds
v_mfma_f32_16x16x32_bf16 v[76:79], a[136:139], a[104:107], v[76:79]
v_cvt_pk_bf16_f32 v40, v40, v41
v_cvt_pk_bf16_f32 v41, v42, v43
v_mfma_f32_16x16x32_bf16 v[76:79], a[140:143], a[108:111], v[76:79]
v_cvt_pk_bf16_f32 v42, v44, v45
v_cvt_pk_bf16_f32 v43, v46, v47
v_mfma_f32_16x16x32_bf16 v[84:87], a[136:139], a[112:115], v[84:87]
ds_read_b128 a[16:19], v2 offset:4096
v_cvt_pk_bf16_f32 v48, v48, v49
v_mfma_f32_16x16x32_bf16 v[84:87], a[140:143], a[116:119], v[84:87]
buffer_load_dwordx4 v19, s[12:15], s27 offen offset:3072 lds
v_mfma_f32_16x16x32_bf16 v[92:95], a[136:139], a[120:123], v[92:95]
s_add_u32 s27, s27, 524288
ds_read_b128 a[20:23], v3 offset:4096
v_cvt_pk_bf16_f32 v49, v50, v51
v_mfma_f32_16x16x32_bf16 v[92:95], a[140:143], a[124:127], v[92:95]
s_waitcnt lgkmcnt(2)
v_cvt_pk_bf16_f32 v50, v52, v53
v_cvt_pk_bf16_f32 v51, v54, v55
v_mfma_f32_16x16x32_bf16 v[96:99], a[128:131], a[64:67], v[96:99]
s_add_u32 m0, s28, 49152
ds_read_b64_tr_b16 a[136:137], v7 offset:32768
v_cvt_pk_bf16_f32 v56, v56, v57
v_mfma_f32_16x16x32_bf16 v[96:99], a[132:135], a[68:71], v[96:99]
buffer_load_dwordx4 v12, s[8:11], s24 offen offset:0 lds
v_mfma_f32_16x16x32_bf16 v[104:107], a[128:131], a[72:75], v[104:107]
ds_read_b64_tr_b16 a[138:139], v7 offset:34816
v_cvt_pk_bf16_f32 v57, v58, v59
v_mfma_f32_16x16x32_bf16 v[104:107], a[132:135], a[76:79], v[104:107]
v_cvt_pk_bf16_f32 v58, v60, v61
v_cvt_pk_bf16_f32 v59, v62, v63
v_mfma_f32_16x16x32_bf16 v[112:115], a[128:131], a[80:83], v[112:115]
ds_read_b64_tr_b16 a[140:141], v7 offset:49152
v_cvt_pk_bf16_f32 v64, v64, v65
v_mfma_f32_16x16x32_bf16 v[112:115], a[132:135], a[84:87], v[112:115]
buffer_load_dwordx4 v13, s[8:11], s24 offen offset:1024 lds
v_mfma_f32_16x16x32_bf16 v[120:123], a[128:131], a[88:91], v[120:123]
ds_read_b64_tr_b16 a[142:143], v7 offset:51200
v_cvt_pk_bf16_f32 v65, v66, v67
v_mfma_f32_16x16x32_bf16 v[120:123], a[132:135], a[92:95], v[120:123]
v_cvt_pk_bf16_f32 v66, v68, v69
v_cvt_pk_bf16_f32 v67, v70, v71
v_mfma_f32_16x16x32_bf16 v[128:131], a[128:131], a[96:99], v[128:131]
v_cvt_pk_bf16_f32 v72, v72, v73
v_cvt_pk_bf16_f32 v73, v74, v75
v_mfma_f32_16x16x32_bf16 v[128:131], a[132:135], a[100:103], v[128:131]
buffer_load_dwordx4 v14, s[8:11], s24 offen offset:2048 lds
v_mfma_f32_16x16x32_bf16 v[136:139], a[128:131], a[104:107], v[136:139]
ds_read_b128 a[24:27], v2 offset:6144
v_cvt_pk_bf16_f32 v74, v76, v77
v_mfma_f32_16x16x32_bf16 v[136:139], a[132:135], a[108:111], v[136:139]
buffer_store_dwordx4 v[32:35], v1, s[4:7], s31 offen sc1
v_mfma_f32_16x16x32_bf16 v[144:147], a[128:131], a[112:115], v[144:147]
s_add_u32 s31, s31, s32
ds_read_b128 a[28:31], v3 offset:6144
v_cvt_pk_bf16_f32 v75, v78, v79
v_mfma_f32_16x16x32_bf16 v[144:147], a[132:135], a[116:119], v[144:147]
buffer_load_dwordx4 v15, s[8:11], s24 offen offset:3072 lds
v_mfma_f32_16x16x32_bf16 v[152:155], a[128:131], a[120:123], v[152:155]
s_add_u32 s24, s24, 128
v_cvt_pk_bf16_f32 v80, v80, v81
v_cvt_pk_bf16_f32 v81, v82, v83
v_mfma_f32_16x16x32_bf16 v[152:155], a[132:135], a[124:127], v[152:155]
s_waitcnt lgkmcnt(2)
v_cvt_pk_bf16_f32 v82, v84, v85
v_cvt_pk_bf16_f32 v83, v86, v87
v_mfma_f32_16x16x32_bf16 v[100:103], a[136:139], a[64:67], v[100:103]
ds_read_b64_tr_b16 a[128:129], v8 offset:32768
v_cvt_pk_bf16_f32 v88, v88, v89
v_mfma_f32_16x16x32_bf16 v[100:103], a[140:143], a[68:71], v[100:103]
v_cvt_pk_bf16_f32 v89, v90, v91
v_cvt_pk_bf16_f32 v90, v92, v93
v_mfma_f32_16x16x32_bf16 v[108:111], a[136:139], a[72:75], v[108:111]
ds_read_b64_tr_b16 a[130:131], v8 offset:34816
v_cvt_pk_bf16_f32 v91, v94, v95
v_mfma_f32_16x16x32_bf16 v[108:111], a[140:143], a[76:79], v[108:111]
buffer_store_dwordx4 v[40:43], v1, s[4:7], s31 offen sc1
v_mfma_f32_16x16x32_bf16 v[116:119], a[136:139], a[80:83], v[116:119]
s_add_u32 s31, s31, s33
ds_read_b64_tr_b16 a[132:133], v8 offset:49152
v_mfma_f32_16x16x32_bf16 v[116:119], a[140:143], a[84:87], v[116:119]
v_mfma_f32_16x16x32_bf16 v[124:127], a[136:139], a[88:91], v[124:127]
ds_read_b64_tr_b16 a[134:135], v8 offset:51200
v_cvt_pk_bf16_f32 v96, v96, v97
v_mfma_f32_16x16x32_bf16 v[124:127], a[140:143], a[92:95], v[124:127]
v_cvt_pk_bf16_f32 v97, v98, v99
v_cvt_pk_bf16_f32 v98, v100, v101
v_mfma_f32_16x16x32_bf16 v[132:135], a[136:139], a[96:99], v[132:135]
ds_read_b128 a[32:35], v2 offset:8192
v_cvt_pk_bf16_f32 v99, v102, v103
v_mfma_f32_16x16x32_bf16 v[132:135], a[140:143], a[100:103], v[132:135]
v_cvt_pk_bf16_f32 v104, v104, v105
v_cvt_pk_bf16_f32 v105, v106, v107
v_mfma_f32_16x16x32_bf16 v[140:143], a[136:139], a[104:107], v[140:143]
v_cvt_pk_bf16_f32 v106, v108, v109
v_cvt_pk_bf16_f32 v107, v110, v111
v_mfma_f32_16x16x32_bf16 v[140:143], a[140:143], a[108:111], v[140:143]
v_cvt_pk_bf16_f32 v112, v112, v113
v_cvt_pk_bf16_f32 v113, v114, v115
v_mfma_f32_16x16x32_bf16 v[148:151], a[136:139], a[112:115], v[148:151]
ds_read_b128 a[36:39], v3 offset:8192
v_cvt_pk_bf16_f32 v114, v116, v117
v_mfma_f32_16x16x32_bf16 v[148:151], a[140:143], a[116:119], v[148:151]
v_cvt_pk_bf16_f32 v115, v118, v119
v_cvt_pk_bf16_f32 v120, v120, v121
v_mfma_f32_16x16x32_bf16 v[156:159], a[136:139], a[120:123], v[156:159]
ds_read_b128 a[40:43], v2 offset:10240
v_cvt_pk_bf16_f32 v121, v122, v123
v_mfma_f32_16x16x32_bf16 v[156:159], a[140:143], a[124:127], v[156:159]
s_waitcnt lgkmcnt(2)
buffer_store_dwordx4 v[48:51], v1, s[4:7], s31 offen sc1
v_mfma_f32_16x16x32_bf16 v[160:163], a[128:131], a[64:67], v[160:163]
s_add_u32 s31, s31, s32
ds_read_b64_tr_b16 a[136:137], v9 offset:32768
v_cvt_pk_bf16_f32 v122, v124, v125
v_mfma_f32_16x16x32_bf16 v[160:163], a[132:135], a[68:71], v[160:163]
v_cvt_pk_bf16_f32 v123, v126, v127
v_cvt_pk_bf16_f32 v128, v128, v129
v_mfma_f32_16x16x32_bf16 v[168:171], a[128:131], a[72:75], v[168:171]
ds_read_b64_tr_b16 a[138:139], v9 offset:34816
v_cvt_pk_bf16_f32 v129, v130, v131
v_mfma_f32_16x16x32_bf16 v[168:171], a[132:135], a[76:79], v[168:171]
v_cvt_pk_bf16_f32 v130, v132, v133
v_cvt_pk_bf16_f32 v131, v134, v135
v_mfma_f32_16x16x32_bf16 v[176:179], a[128:131], a[80:83], v[176:179]
ds_read_b64_tr_b16 a[140:141], v9 offset:49152
v_cvt_pk_bf16_f32 v136, v136, v137
v_mfma_f32_16x16x32_bf16 v[176:179], a[132:135], a[84:87], v[176:179]
v_cvt_pk_bf16_f32 v137, v138, v139
v_cvt_pk_bf16_f32 v138, v140, v141
v_mfma_f32_16x16x32_bf16 v[184:187], a[128:131], a[88:91], v[184:187]
ds_read_b64_tr_b16 a[142:143], v9 offset:51200
v_cvt_pk_bf16_f32 v139, v142, v143
v_mfma_f32_16x16x32_bf16 v[184:187], a[132:135], a[92:95], v[184:187]
v_cvt_pk_bf16_f32 v144, v144, v145
v_cvt_pk_bf16_f32 v145, v146, v147
v_mfma_f32_16x16x32_bf16 v[192:195], a[128:131], a[96:99], v[192:195]
buffer_store_dwordx4 v[56:59], v1, s[4:7], s31 offen sc1
v_mfma_f32_16x16x32_bf16 v[192:195], a[132:135], a[100:103], v[192:195]
s_add_u32 s31, s31, s34
v_cvt_pk_bf16_f32 v146, v148, v149
v_cvt_pk_bf16_f32 v147, v150, v151
v_mfma_f32_16x16x32_bf16 v[200:203], a[128:131], a[104:107], v[200:203]
ds_read_b128 a[44:47], v3 offset:10240
v_cvt_pk_bf16_f32 v152, v152, v153
v_mfma_f32_16x16x32_bf16 v[200:203], a[132:135], a[108:111], v[200:203]
v_cvt_pk_bf16_f32 v153, v154, v155
v_cvt_pk_bf16_f32 v154, v156, v157
v_mfma_f32_16x16x32_bf16 v[208:211], a[128:131], a[112:115], v[208:211]
ds_read_b128 a[48:51], v2 offset:12288
v_cvt_pk_bf16_f32 v155, v158, v159
v_mfma_f32_16x16x32_bf16 v[208:211], a[132:135], a[116:119], v[208:211]
v_mfma_f32_16x16x32_bf16 v[216:219], a[128:131], a[120:123], v[216:219]
v_mfma_f32_16x16x32_bf16 v[216:219], a[132:135], a[124:127], v[216:219]
s_waitcnt lgkmcnt(2)
v_mfma_f32_16x16x32_bf16 v[164:167], a[136:139], a[64:67], v[164:167]
ds_read_b64_tr_b16 a[128:129], v10 offset:32768
v_mfma_f32_16x16x32_bf16 v[164:167], a[140:143], a[68:71], v[164:167]
v_mfma_f32_16x16x32_bf16 v[172:175], a[136:139], a[72:75], v[172:175]
ds_read_b64_tr_b16 a[130:131], v10 offset:34816
v_mfma_f32_16x16x32_bf16 v[172:175], a[140:143], a[76:79], v[172:175]
buffer_store_dwordx4 v[64:67], v1, s[4:7], s31 offen sc1
v_mfma_f32_16x16x32_bf16 v[180:183], a[136:139], a[80:83], v[180:183]
s_add_u32 s31, s31, s32
ds_read_b64_tr_b16 a[132:133], v10 offset:49152
v_mfma_f32_16x16x32_bf16 v[180:183], a[140:143], a[84:87], v[180:183]
v_mfma_f32_16x16x32_bf16 v[188:191], a[136:139], a[88:91], v[188:191]
ds_read_b64_tr_b16 a[134:135], v10 offset:51200
v_cvt_pk_bf16_f32 v160, v160, v161
v_mfma_f32_16x16x32_bf16 v[188:191], a[140:143], a[92:95], v[188:191]
v_cvt_pk_bf16_f32 v161, v162, v163
v_cvt_pk_bf16_f32 v162, v164, v165
v_mfma_f32_16x16x32_bf16 v[196:199], a[136:139], a[96:99], v[196:199]
ds_read_b128 a[52:55], v3 offset:12288
v_cvt_pk_bf16_f32 v163, v166, v167
v_mfma_f32_16x16x32_bf16 v[196:199], a[140:143], a[100:103], v[196:199]
v_cvt_pk_bf16_f32 v168, v168, v169
v_cvt_pk_bf16_f32 v169, v170, v171
v_mfma_f32_16x16x32_bf16 v[204:207], a[136:139], a[104:107], v[204:207]
ds_read_b128 a[56:59], v2 offset:14336
v_cvt_pk_bf16_f32 v170, v172, v173
v_mfma_f32_16x16x32_bf16 v[204:207], a[140:143], a[108:111], v[204:207]
v_cvt_pk_bf16_f32 v171, v174, v175
v_cvt_pk_bf16_f32 v176, v176, v177
v_mfma_f32_16x16x32_bf16 v[212:215], a[136:139], a[112:115], v[212:215]
v_cvt_pk_bf16_f32 v177, v178, v179
v_cvt_pk_bf16_f32 v178, v180, v181
v_mfma_f32_16x16x32_bf16 v[212:215], a[140:143], a[116:119], v[212:215]
buffer_store_dwordx4 v[72:75], v1, s[4:7], s31 offen sc1
v_mfma_f32_16x16x32_bf16 v[220:223], a[136:139], a[120:123], v[220:223]
s_add_u32 s31, s31, s33
ds_read_b128 a[60:63], v3 offset:14336
v_cvt_pk_bf16_f32 v179, v182, v183
v_mfma_f32_16x16x32_bf16 v[220:223], a[140:143], a[124:127], v[220:223]
s_waitcnt lgkmcnt(2)
v_cvt_pk_bf16_f32 v184, v184, v185
v_cvt_pk_bf16_f32 v185, v186, v187
v_mfma_f32_16x16x32_bf16 a[192:195], a[128:131], a[64:67], a[192:195]
ds_read_b64_tr_b16 a[136:137], v11 offset:32768
v_cvt_pk_bf16_f32 v186, v188, v189
v_mfma_f32_16x16x32_bf16 a[192:195], a[132:135], a[68:71], a[192:195]
v_cvt_pk_bf16_f32 v187, v190, v191
v_cvt_pk_bf16_f32 v192, v192, v193
v_mfma_f32_16x16x32_bf16 a[200:203], a[128:131], a[72:75], a[200:203]
ds_read_b64_tr_b16 a[138:139], v11 offset:34816
v_cvt_pk_bf16_f32 v193, v194, v195
v_mfma_f32_16x16x32_bf16 a[200:203], a[132:135], a[76:79], a[200:203]
v_cvt_pk_bf16_f32 v194, v196, v197
v_cvt_pk_bf16_f32 v195, v198, v199
v_mfma_f32_16x16x32_bf16 a[208:211], a[128:131], a[80:83], a[208:211]
ds_read_b64_tr_b16 a[140:141], v11 offset:49152
v_cvt_pk_bf16_f32 v200, v200, v201
v_mfma_f32_16x16x32_bf16 a[208:211], a[132:135], a[84:87], a[208:211]
v_cvt_pk_bf16_f32 v201, v202, v203
v_cvt_pk_bf16_f32 v202, v204, v205
v_mfma_f32_16x16x32_bf16 a[216:219], a[128:131], a[88:91], a[216:219]
ds_read_b64_tr_b16 a[142:143], v11 offset:51200
v_cvt_pk_bf16_f32 v203, v206, v207
v_mfma_f32_16x16x32_bf16 a[216:219], a[132:135], a[92:95], a[216:219]
v_cvt_pk_bf16_f32 v208, v208, v209
v_cvt_pk_bf16_f32 v209, v210, v211
v_mfma_f32_16x16x32_bf16 a[224:227], a[128:131], a[96:99], a[224:227]
buffer_store_dwordx4 v[80:83], v1, s[4:7], s31 offen sc1
v_mfma_f32_16x16x32_bf16 a[224:227], a[132:135], a[100:103], a[224:227]
s_add_u32 s31, s31, s32
v_cvt_pk_bf16_f32 v210, v212, v213
v_cvt_pk_bf16_f32 v211, v214, v215
v_mfma_f32_16x16x32_bf16 a[232:235], a[128:131], a[104:107], a[232:235]
v_cvt_pk_bf16_f32 v216, v216, v217
v_cvt_pk_bf16_f32 v217, v218, v219
v_mfma_f32_16x16x32_bf16 a[232:235], a[132:135], a[108:111], a[232:235]
v_cvt_pk_bf16_f32 v218, v220, v221
v_cvt_pk_bf16_f32 v219, v222, v223
v_mfma_f32_16x16x32_bf16 a[240:243], a[128:131], a[112:115], a[240:243]
v_mfma_f32_16x16x32_bf16 a[240:243], a[132:135], a[116:119], a[240:243]
v_mfma_f32_16x16x32_bf16 a[248:251], a[128:131], a[120:123], a[248:251]
v_mfma_f32_16x16x32_bf16 a[248:251], a[132:135], a[124:127], a[248:251]
s_waitcnt vmcnt(23) lgkmcnt(0)
s_barrier
v_mfma_f32_16x16x32_bf16 a[196:199], a[136:139], a[64:67], a[196:199]
s_add_u32 m0, s29, 98304
ds_read_b64_tr_b16 a[128:129], v22 offset:0
v_mfma_f32_16x16x32_bf16 a[196:199], a[140:143], a[68:71], a[196:199]
buffer_load_dwordx4 v16, s[12:15], s26 offen offset:0 lds
v_mfma_f32_16x16x32_bf16 a[204:207], a[136:139], a[72:75], a[204:207]
ds_read_b64_tr_b16 a[130:131], v22 offset:2048
v_mfma_f32_16x16x32_bf16 a[204:207], a[140:143], a[76:79], a[204:207]
buffer_store_dwordx4 v[88:91], v1, s[4:7], s31 offen sc1
v_mfma_f32_16x16x32_bf16 a[212:215], a[136:139], a[80:83], a[212:215]
s_add_u32 s31, s31, s35
ds_read_b64_tr_b16 a[132:133], v22 offset:16384
v_mfma_f32_16x16x32_bf16 a[212:215], a[140:143], a[84:87], a[212:215]
buffer_load_dwordx4 v17, s[12:15], s26 offen offset:1024 lds
v_mfma_f32_16x16x32_bf16 a[220:223], a[136:139], a[88:91], a[220:223]
ds_read_b64_tr_b16 a[134:135], v22 offset:18432
v_add_u32 v22, 4294901760, v22
v_mfma_f32_16x16x32_bf16 a[220:223], a[140:143], a[92:95], a[220:223]
v_mfma_f32_16x16x32_bf16 a[228:231], a[136:139], a[96:99], a[228:231]
v_mfma_f32_16x16x32_bf16 a[228:231], a[140:143], a[100:103], a[228:231]
buffer_load_dwordx4 v18, s[12:15], s26 offen offset:2048 lds
v_mfma_f32_16x16x32_bf16 a[236:239], a[136:139], a[104:107], a[236:239]
v_mfma_f32_16x16x32_bf16 a[236:239], a[140:143], a[108:111], a[236:239]
v_mfma_f32_16x16x32_bf16 a[244:247], a[136:139], a[112:115], a[244:247]
v_mfma_f32_16x16x32_bf16 a[244:247], a[140:143], a[116:119], a[244:247]
buffer_load_dwordx4 v19, s[12:15], s26 offen offset:3072 lds
v_mfma_f32_16x16x32_bf16 a[252:255], a[136:139], a[120:123], a[252:255]
s_add_u32 s26, s26, 524288
v_mfma_f32_16x16x32_bf16 a[252:255], a[140:143], a[124:127], a[252:255]
s_waitcnt lgkmcnt(0)
M_Q:
v_mfma_f32_16x16x32_bf16 v[36:39], a[128:131], a[0:3], 0
s_add_u32 m0, s29, 114688
ds_read_b64_tr_b16 a[136:137], v23 offset:0
v_mfma_f32_16x16x32_bf16 v[36:39], a[132:135], a[4:7], v[36:39]
buffer_load_dwordx4 v16, s[12:15], s27 offen offset:0 lds
v_mfma_f32_16x16x32_bf16 v[44:47], a[128:131], a[8:11], 0
ds_read_b64_tr_b16 a[138:139], v23 offset:2048
v_mfma_f32_16x16x32_bf16 v[44:47], a[132:135], a[12:15], v[44:47]
ds_read_b128 a[64:67], v2 offset:16384
ds_read_b128 a[68:71], v3 offset:16384
v_mfma_f32_16x16x32_bf16 v[52:55], a[128:131], a[16:19], 0
ds_read_b64_tr_b16 a[140:141], v23 offset:16384
v_mfma_f32_16x16x32_bf16 v[52:55], a[132:135], a[20:23], v[52:55]
buffer_load_dwordx4 v17, s[12:15], s27 offen offset:1024 lds
v_mfma_f32_16x16x32_bf16 v[60:63], a[128:131], a[24:27], 0
ds_read_b64_tr_b16 a[142:143], v23 offset:18432
v_add_u32 v23, 4294901760, v23
v_mfma_f32_16x16x32_bf16 v[60:63], a[132:135], a[28:31], v[60:63]
buffer_store_dwordx4 v[96:99], v1, s[4:7], s31 offen sc1
v_mfma_f32_16x16x32_bf16 v[68:71], a[128:131], a[32:35], 0
s_add_u32 s31, s31, s32
ds_read_b128 a[72:75], v2 offset:18432
v_mfma_f32_16x16x32_bf16 v[68:71], a[132:135], a[36:39], v[68:71]
buffer_load_dwordx4 v18, s[12:15], s27 offen offset:2048 lds
v_mfma_f32_16x16x32_bf16 v[76:79], a[128:131], a[40:43], 0
ds_read_b128 a[76:79], v3 offset:18432
v_mfma_f32_16x16x32_bf16 v[76:79], a[132:135], a[44:47], v[76:79]
ds_read_b128 a[80:83], v2 offset:20480
v_mfma_f32_16x16x32_bf16 v[84:87], a[128:131], a[48:51], 0
ds_read_b128 a[84:87], v3 offset:20480
v_mfma_f32_16x16x32_bf16 v[84:87], a[132:135], a[52:55], v[84:87]
buffer_load_dwordx4 v19, s[12:15], s27 offen offset:3072 lds
v_mfma_f32_16x16x32_bf16 v[92:95], a[128:131], a[56:59], 0
s_add_u32 s27, s27, 524288
ds_read_b128 a[88:91], v2 offset:22528
v_mfma_f32_16x16x32_bf16 v[92:95], a[132:135], a[60:63], v[92:95]
s_waitcnt lgkmcnt(4)
buffer_store_dwordx4 v[104:107], v1, s[4:7], s31 offen sc1
v_mfma_f32_16x16x32_bf16 v[100:103], a[136:139], a[0:3], 0
s_add_u32 m0, s28, 0
ds_read_b64_tr_b16 a[128:129], v24 offset:0
v_mfma_f32_16x16x32_bf16 v[100:103], a[140:143], a[4:7], v[100:103]
s_add_u32 s31, s31, s33
buffer_load_dwordx4 v12, s[8:11], s24 offen offset:0 lds
v_mfma_f32_16x16x32_bf16 v[108:111], a[136:139], a[8:11], 0
ds_read_b64_tr_b16 a[130:131], v24 offset:2048
v_mfma_f32_16x16x32_bf16 v[108:111], a[140:143], a[12:15], v[108:111]
ds_read_b128 a[92:95], v3 offset:22528
v_mfma_f32_16x16x32_bf16 v[116:119], a[136:139], a[16:19], 0
ds_read_b64_tr_b16 a[132:133], v24 offset:16384
v_mfma_f32_16x16x32_bf16 v[116:119], a[140:143], a[20:23], v[116:119]
buffer_load_dwordx4 v13, s[8:11], s24 offen offset:1024 lds
v_mfma_f32_16x16x32_bf16 v[124:127], a[136:139], a[24:27], 0
ds_read_b64_tr_b16 a[134:135], v24 offset:18432
v_add_u32 v24, 4294901760, v24
v_mfma_f32_16x16x32_bf16 v[124:127], a[140:143], a[28:31], v[124:127]
v_mfma_f32_16x16x32_bf16 v[132:135], a[136:139], a[32:35], 0
ds_read_b128 a[96:99], v2 offset:24576
v_mfma_f32_16x16x32_bf16 v[132:135], a[140:143], a[36:39], v[132:135]
buffer_load_dwordx4 v14, s[8:11], s24 offen offset:2048 lds
v_mfma_f32_16x16x32_bf16 v[140:143], a[136:139], a[40:43], 0
ds_read_b128 a[100:103], v3 offset:24576
v_mfma_f32_16x16x32_bf16 v[140:143], a[140:143], a[44:47], v[140:143]
ds_read_b128 a[104:107], v2 offset:26624
v_mfma_f32_16x16x32_bf16 v[148:151], a[136:139], a[48:51], 0
ds_read_b128 a[108:111], v3 offset:26624
v_mfma_f32_16x16x32_bf16 v[148:151], a[140:143], a[52:55], v[148:151]
PAD_6:
s_cbranch_execz M_tret
buffer_load_dwordx4 v15, s[8:11], s24 offen offset:3072 lds
v_mfma_f32_16x16x32_bf16 v[156:159], a[136:139], a[56:59], 0
s_add_u32 s24, s24, 128
ds_read_b128 a[112:115], v2 offset:28672
v_mfma_f32_16x16x32_bf16 v[156:159], a[140:143], a[60:63], v[156:159]
s_waitcnt lgkmcnt(4)
buffer_store_dwordx4 v[112:115], v1, s[4:7], s31 offen sc1
v_mfma_f32_16x16x32_bf16 v[164:167], a[128:131], a[0:3], 0
s_add_u32 s31, s31, s32
ds_read_b64_tr_b16 a[136:137], v25 offset:0
v_mfma_f32_16x16x32_bf16 v[164:167], a[132:135], a[4:7], v[164:167]
v_mfma_f32_16x16x32_bf16 v[172:175], a[128:131], a[8:11], 0
ds_read_b64_tr_b16 a[138:139], v25 offset:2048
v_mfma_f32_16x16x32_bf16 v[172:175], a[132:135], a[12:15], v[172:175]
ds_read_b128 a[116:119], v3 offset:28672
v_mfma_f32_16x16x32_bf16 v[180:183], a[128:131], a[16:19], 0
ds_read_b64_tr_b16 a[140:141], v25 offset:16384
v_mfma_f32_16x16x32_bf16 v[180:183], a[132:135], a[20:23], v[180:183]
v_mfma_f32_16x16x32_bf16 v[188:191], a[128:131], a[24:27], 0
ds_read_b64_tr_b16 a[142:143], v25 offset:18432
v_add_u32 v25, 4294901760, v25
v_mfma_f32_16x16x32_bf16 v[188:191], a[132:135], a[28:31], v[188:191]
v_mfma_f32_16x16x32_bf16 v[196:199], a[128:131], a[32:35], 0
ds_read_b128 a[120:123], v2 offset:30720
v_mfma_f32_16x16x32_bf16 v[196:199], a[132:135], a[36:39], v[196:199]
v_mfma_f32_16x16x32_bf16 v[204:207], a[128:131], a[40:43], 0
ds_read_b128 a[124:127], v3 offset:30720
v_mfma_f32_16x16x32_bf16 v[204:207], a[132:135], a[44:47], v[204:207]
v_mfma_f32_16x16x32_bf16 v[212:215], a[128:131], a[48:51], 0
v_mfma_f32_16x16x32_bf16 v[212:215], a[132:135], a[52:55], v[212:215]
buffer_store_dwordx4 v[120:123], v1, s[4:7], s31 offen sc1
v_mfma_f32_16x16x32_bf16 v[220:223], a[128:131], a[56:59], 0
s_add_u32 s31, s31, s34
v_mfma_f32_16x16x32_bf16 v[220:223], a[132:135], a[60:63], v[220:223]
s_waitcnt vmcnt(28) lgkmcnt(0)
s_barrier
v_mfma_f32_16x16x32_bf16 v[224:227], a[136:139], a[0:3], 0
s_add_u32 m0, s29, 131072
ds_read_b64_tr_b16 a[128:129], v22 offset:0
v_mfma_f32_16x16x32_bf16 v[224:227], a[140:143], a[4:7], v[224:227]
buffer_load_dwordx4 v16, s[12:15], s26 offen offset:0 lds
v_mfma_f32_16x16x32_bf16 v[228:231], a[136:139], a[8:11], 0
ds_read_b64_tr_b16 a[130:131], v22 offset:2048
v_mfma_f32_16x16x32_bf16 v[228:231], a[140:143], a[12:15], v[228:231]
v_mfma_f32_16x16x32_bf16 v[232:235], a[136:139], a[16:19], 0
ds_read_b64_tr_b16 a[132:133], v22 offset:16384
v_mfma_f32_16x16x32_bf16 v[232:235], a[140:143], a[20:23], v[232:235]
buffer_load_dwordx4 v17, s[12:15], s26 offen offset:1024 lds
v_mfma_f32_16x16x32_bf16 v[236:239], a[136:139], a[24:27], 0
ds_read_b64_tr_b16 a[134:135], v22 offset:18432
v_add_u32 v22, 32768, v22
v_mfma_f32_16x16x32_bf16 v[236:239], a[140:143], a[28:31], v[236:239]
v_mfma_f32_16x16x32_bf16 v[240:243], a[136:139], a[32:35], 0
v_mfma_f32_16x16x32_bf16 v[240:243], a[140:143], a[36:39], v[240:243]
buffer_load_dwordx4 v18, s[12:15], s26 offen offset:2048 lds
v_mfma_f32_16x16x32_bf16 v[244:247], a[136:139], a[40:43], 0
v_mfma_f32_16x16x32_bf16 v[244:247], a[140:143], a[44:47], v[244:247]
v_mfma_f32_16x16x32_bf16 v[248:251], a[136:139], a[48:51], 0
v_mfma_f32_16x16x32_bf16 v[248:251], a[140:143], a[52:55], v[248:251]
buffer_load_dwordx4 v19, s[12:15], s26 offen offset:3072 lds
v_mfma_f32_16x16x32_bf16 v[252:255], a[136:139], a[56:59], 0
s_add_u32 s26, s26, 524288
v_mfma_f32_16x16x32_bf16 v[252:255], a[140:143], a[60:63], v[252:255]
s_waitcnt lgkmcnt(0)
v_mfma_f32_16x16x32_bf16 v[36:39], a[128:131], a[64:67], v[36:39]
s_add_u32 m0, s29, 147456
ds_read_b64_tr_b16 a[136:137], v23 offset:0
v_accvgpr_read_b32 v32, a192
v_mfma_f32_16x16x32_bf16 v[36:39], a[132:135], a[68:71], v[36:39]
buffer_load_dwordx4 v16, s[12:15], s27 offen offset:0 lds
v_mfma_f32_16x16x32_bf16 v[44:47], a[128:131], a[72:75], v[44:47]
ds_read_b64_tr_b16 a[138:139], v23 offset:2048
v_accvgpr_read_b32 v33, a193
v_mfma_f32_16x16x32_bf16 v[44:47], a[132:135], a[76:79], v[44:47]
ds_read_b128 a[0:3], v2 offset:32768
ds_read_b128 a[4:7], v3 offset:32768
v_mfma_f32_16x16x32_bf16 v[52:55], a[128:131], a[80:83], v[52:55]
ds_read_b64_tr_b16 a[140:141], v23 offset:16384
v_accvgpr_read_b32 v34, a194
v_mfma_f32_16x16x32_bf16 v[52:55], a[132:135], a[84:87], v[52:55]
buffer_load_dwordx4 v17, s[12:15], s27 offen offset:1024 lds
v_mfma_f32_16x16x32_bf16 v[60:63], a[128:131], a[88:91], v[60:63]
ds_read_b64_tr_b16 a[142:143], v23 offset:18432
v_add_u32 v23, 32768, v23
v_mfma_f32_16x16x32_bf16 v[60:63], a[132:135], a[92:95], v[60:63]
buffer_store_dwordx4 v[128:131], v1, s[4:7], s31 offen sc1
v_mfma_f32_16x16x32_bf16 v[68:71], a[128:131], a[96:99], v[68:71]
s_add_u32 s31, s31, s32
ds_read_b128 a[8:11], v2 offset:34816
v_accvgpr_read_b32 v35, a195
v_mfma_f32_16x16x32_bf16 v[68:71], a[132:135], a[100:103], v[68:71]
buffer_load_dwordx4 v18, s[12:15], s27 offen offset:2048 lds
v_mfma_f32_16x16x32_bf16 v[76:79], a[128:131], a[104:107], v[76:79]
ds_read_b128 a[12:15], v3 offset:34816
v_accvgpr_read_b32 v96, a196
v_mfma_f32_16x16x32_bf16 v[76:79], a[132:135], a[108:111], v[76:79]
ds_read_b128 a[16:19], v2 offset:36864
v_accvgpr_read_b32 v97, a197
v_mfma_f32_16x16x32_bf16 v[84:87], a[128:131], a[112:115], v[84:87]
ds_read_b128 a[20:23], v3 offset:36864
v_accvgpr_read_b32 v98, a198
v_mfma_f32_16x16x32_bf16 v[84:87], a[132:135], a[116:119], v[84:87]
buffer_load_dwordx4 v19, s[12:15], s27 offen offset:3072 lds
v_mfma_f32_16x16x32_bf16 v[92:95], a[128:131], a[120:123], v[92:95]
s_add_u32 s27, s27, 524288
ds_read_b128 a[24:27], v2 offset:38912
v_accvgpr_read_b32 v99, a199
v_mfma_f32_16x16x32_bf16 v[92:95], a[132:135], a[124:127], v[92:95]
s_waitcnt lgkmcnt(4)
buffer_store_dwordx4 v[136:139], v1, s[4:7], s31 offen sc1
v_mfma_f32_16x16x32_bf16 v[100:103], a[136:139], a[64:67], v[100:103]
s_add_u32 m0, s28, 16384
ds_read_b64_tr_b16 a[128:129], v24 offset:0
v_cvt_pk_bf16_f32 v32, v32, v33
v_mfma_f32_16x16x32_bf16 v[100:103], a[140:143], a[68:71], v[100:103]
s_add_u32 s31, s31, s33
buffer_load_dwordx4 v12, s[8:11], s24 offen offset:0 lds
v_mfma_f32_16x16x32_bf16 v[108:111], a[136:139], a[72:75], v[108:111]
ds_read_b64_tr_b16 a[130:131], v24 offset:2048
v_cvt_pk_bf16_f32 v33, v34, v35
v_mfma_f32_16x16x32_bf16 v[108:111], a[140:143], a[76:79], v[108:111]
ds_read_b128 a[28:31], v3 offset:38912
v_cvt_pk_bf16_f32 v34, v96, v97
v_mfma_f32_16x16x32_bf16 v[116:119], a[136:139], a[80:83], v[116:119]
ds_read_b64_tr_b16 a[132:133], v24 offset:16384
v_cvt_pk_bf16_f32 v35, v98, v99
v_mfma_f32_16x16x32_bf16 v[116:119], a[140:143], a[84:87], v[116:119]
buffer_load_dwordx4 v13, s[8:11], s24 offen offset:1024 lds
v_mfma_f32_16x16x32_bf16 v[124:127], a[136:139], a[88:91], v[124:127]
ds_read_b64_tr_b16 a[134:135], v24 offset:18432
v_add_u32 v24, 32768, v24
v_mfma_f32_16x16x32_bf16 v[124:127], a[140:143], a[92:95], v[124:127]
v_accvgpr_read_b32 v40, a200
v_accvgpr_read_b32 v41, a201
v_mfma_f32_16x16x32_bf16 v[132:135], a[136:139], a[96:99], v[132:135]
ds_read_b128 a[32:35], v2 offset:40960
v_accvgpr_read_b32 v42, a202
v_mfma_f32_16x16x32_bf16 v[132:135], a[140:143], a[100:103], v[132:135]
buffer_load_dwordx4 v14, s[8:11], s24 offen offset:2048 lds
v_mfma_f32_16x16x32_bf16 v[140:143], a[136:139], a[104:107], v[140:143]
ds_read_b128 a[36:39], v3 offset:40960
v_accvgpr_read_b32 v43, a203
v_mfma_f32_16x16x32_bf16 v[140:143], a[140:143], a[108:111], v[140:143]
ds_read_b128 a[40:43], v2 offset:43008
v_accvgpr_read_b32 v96, a204
v_mfma_f32_16x16x32_bf16 v[148:151], a[136:139], a[112:115], v[148:151]
ds_read_b128 a[44:47], v3 offset:43008
v_accvgpr_read_b32 v97, a205
v_mfma_f32_16x16x32_bf16 v[148:151], a[140:143], a[116:119], v[148:151]
buffer_load_dwordx4 v15, s[8:11], s24 offen offset:3072 lds
v_mfma_f32_16x16x32_bf16 v[156:159], a[136:139], a[120:123], v[156:159]
s_add_u32 s24, s24, 128
ds_read_b128 a[48:51], v2 offset:45056
v_accvgpr_read_b32 v98, a206
v_mfma_f32_16x16x32_bf16 v[156:159], a[140:143], a[124:127], v[156:159]
s_waitcnt lgkmcnt(4)
buffer_store_dwordx4 v[144:147], v1, s[4:7], s31 offen sc1
v_mfma_f32_16x16x32_bf16 v[164:167], a[128:131], a[64:67], v[164:167]
s_add_u32 s31, s31, s32
ds_read_b64_tr_b16 a[136:137], v25 offset:0
v_accvgpr_read_b32 v99, a207
v_mfma_f32_16x16x32_bf16 v[164:167], a[132:135], a[68:71], v[164:167]
v_cvt_pk_bf16_f32 v40, v40, v41
v_cvt_pk_bf16_f32 v41, v42, v43
v_mfma_f32_16x16x32_bf16 v[172:175], a[128:131], a[72:75], v[172:175]
ds_read_b64_tr_b16 a[138:139], v25 offset:2048
v_cvt_pk_bf16_f32 v42, v96, v97
v_mfma_f32_16x16x32_bf16 v[172:175], a[132:135], a[76:79], v[172:175]
ds_read_b128 a[52:55], v3 offset:45056
v_cvt_pk_bf16_f32 v43, v98, v99
v_mfma_f32_16x16x32_bf16 v[180:183], a[128:131], a[80:83], v[180:183]
ds_read_b64_tr_b16 a[140:141], v25 offset:16384
v_accvgpr_read_b32 v48, a208
v_mfma_f32_16x16x32_bf16 v[180:183], a[132:135], a[84:87], v[180:183]
v_accvgpr_read_b32 v49, a209
v_accvgpr_read_b32 v50, a210
v_mfma_f32_16x16x32_bf16 v[188:191], a[128:131], a[88:91], v[188:191]
ds_read_b64_tr_b16 a[142:143], v25 offset:18432
v_add_u32 v25, 32768, v25
v_mfma_f32_16x16x32_bf16 v[188:191], a[132:135], a[92:95], v[188:191]
v_accvgpr_read_b32 v51, a211
v_accvgpr_read_b32 v96, a212
v_mfma_f32_16x16x32_bf16 v[196:199], a[128:131], a[96:99], v[196:199]
ds_read_b128 a[56:59], v2 offset:47104
v_accvgpr_read_b32 v97, a213
v_mfma_f32_16x16x32_bf16 v[196:199], a[132:135], a[100:103], v[196:199]
v_accvgpr_read_b32 v98, a214
v_accvgpr_read_b32 v99, a215
v_mfma_f32_16x16x32_bf16 v[204:207], a[128:131], a[104:107], v[204:207]
ds_read_b128 a[60:63], v3 offset:47104
v_cvt_pk_bf16_f32 v48, v48, v49
v_mfma_f32_16x16x32_bf16 v[204:207], a[132:135], a[108:111], v[204:207]
v_cvt_pk_bf16_f32 v49, v50, v51
v_cvt_pk_bf16_f32 v50, v96, v97
v_mfma_f32_16x16x32_bf16 v[212:215], a[128:131], a[112:115], v[212:215]
v_cvt_pk_bf16_f32 v51, v98, v99
v_accvgpr_read_b32 v56, a216
v_mfma_f32_16x16x32_bf16 v[212:215], a[132:135], a[116:119], v[212:215]
buffer_store_dwordx4 v[152:155], v1, s[4:7], s31 offen sc1
v_mfma_f32_16x16x32_bf16 v[220:223], a[128:131], a[120:123], v[220:223]
s_add_u32 s31, s31, s36
v_accvgpr_read_b32 v57, a217
v_accvgpr_read_b32 v58, a218
v_mfma_f32_16x16x32_bf16 v[220:223], a[132:135], a[124:127], v[220:223]
s_waitcnt vmcnt(23) lgkmcnt(0)
s_barrier
v_accvgpr_read_b32 v59, a219
v_mfma_f32_16x16x32_bf16 v[224:227], a[136:139], a[64:67], v[224:227]
s_add_u32 m0, s29, 65536
ds_read_b64_tr_b16 a[128:129], v22 offset:0
v_accvgpr_read_b32 v96, a220
v_mfma_f32_16x16x32_bf16 v[224:227], a[140:143], a[68:71], v[224:227]
buffer_load_dwordx4 v16, s[12:15], s26 offen offset:0 lds
v_mfma_f32_16x16x32_bf16 v[228:231], a[136:139], a[72:75], v[228:231]
ds_read_b64_tr_b16 a[130:131], v22 offset:2048
v_accvgpr_read_b32 v97, a221
v_mfma_f32_16x16x32_bf16 v[228:231], a[140:143], a[76:79], v[228:231]
v_accvgpr_read_b32 v98, a222
v_accvgpr_read_b32 v99, a223
v_mfma_f32_16x16x32_bf16 v[232:235], a[136:139], a[80:83], v[232:235]
ds_read_b64_tr_b16 a[132:133], v22 offset:16384
v_cvt_pk_bf16_f32 v56, v56, v57
v_mfma_f32_16x16x32_bf16 v[232:235], a[140:143], a[84:87], v[232:235]
buffer_load_dwordx4 v17, s[12:15], s26 offen offset:1024 lds
v_mfma_f32_16x16x32_bf16 v[236:239], a[136:139], a[88:91], v[236:239]
ds_read_b64_tr_b16 a[134:135], v22 offset:18432
v_add_u32 v22, 32768, v22
v_mfma_f32_16x16x32_bf16 v[236:239], a[140:143], a[92:95], v[236:239]
v_cvt_pk_bf16_f32 v57, v58, v59
v_cvt_pk_bf16_f32 v58, v96, v97
v_mfma_f32_16x16x32_bf16 v[240:243], a[136:139], a[96:99], v[240:243]
v_cvt_pk_bf16_f32 v59, v98, v99
v_accvgpr_read_b32 v64, a224
v_mfma_f32_16x16x32_bf16 v[240:243], a[140:143], a[100:103], v[240:243]
buffer_load_dwordx4 v18, s[12:15], s26 offen offset:2048 lds
v_mfma_f32_16x16x32_bf16 v[244:247], a[136:139], a[104:107], v[244:247]
v_accvgpr_read_b32 v65, a225
v_accvgpr_read_b32 v66, a226
v_mfma_f32_16x16x32_bf16 v[244:247], a[140:143], a[108:111], v[244:247]
v_accvgpr_read_b32 v67, a227
v_accvgpr_read_b32 v96, a228
v_mfma_f32_16x16x32_bf16 v[248:251], a[136:139], a[112:115], v[248:251]
v_accvgpr_read_b32 v97, a229
v_accvgpr_read_b32 v98, a230
v_mfma_f32_16x16x32_bf16 v[248:251], a[140:143], a[116:119], v[248:251]
buffer_load_dwordx4 v19, s[12:15], s26 offen offset:3072 lds
v_mfma_f32_16x16x32_bf16 v[252:255], a[136:139], a[120:123], v[252:255]
s_add_u32 s26, s26, 524288
v_accvgpr_read_b32 v99, a231
v_cvt_pk_bf16_f32 v64, v64, v65
v_mfma_f32_16x16x32_bf16 v[252:255], a[140:143], a[124:127], v[252:255]
s_waitcnt lgkmcnt(0)
v_cvt_pk_bf16_f32 v65, v66, v67
v_cvt_pk_bf16_f32 v66, v96, v97
v_mfma_f32_16x16x32_bf16 v[36:39], a[128:131], a[0:3], v[36:39]
s_add_u32 m0, s29, 81920
ds_read_b64_tr_b16 a[136:137], v23 offset:0
v_cvt_pk_bf16_f32 v67, v98, v99
v_mfma_f32_16x16x32_bf16 v[36:39], a[132:135], a[4:7], v[36:39]
buffer_load_dwordx4 v16, s[12:15], s27 offen offset:0 lds
v_mfma_f32_16x16x32_bf16 v[44:47], a[128:131], a[8:11], v[44:47]
ds_read_b64_tr_b16 a[138:139], v23 offset:2048
v_accvgpr_read_b32 v72, a232
v_mfma_f32_16x16x32_bf16 v[44:47], a[132:135], a[12:15], v[44:47]
ds_read_b128 a[64:67], v2 offset:49152
ds_read_b128 a[68:71], v3 offset:49152
v_mfma_f32_16x16x32_bf16 v[52:55], a[128:131], a[16:19], v[52:55]
ds_read_b64_tr_b16 a[140:141], v23 offset:16384
v_accvgpr_read_b32 v73, a233
v_mfma_f32_16x16x32_bf16 v[52:55], a[132:135], a[20:23], v[52:55]
buffer_load_dwordx4 v17, s[12:15], s27 offen offset:1024 lds
v_mfma_f32_16x16x32_bf16 v[60:63], a[128:131], a[24:27], v[60:63]
ds_read_b64_tr_b16 a[142:143], v23 offset:18432
v_add_u32 v23, 32768, v23
v_mfma_f32_16x16x32_bf16 v[60:63], a[132:135], a[28:31], v[60:63]
buffer_store_dwordx4 v[160:163], v1, s[4:7], s31 offen sc1
v_mfma_f32_16x16x32_bf16 v[68:71], a[128:131], a[32:35], v[68:71]
s_add_u32 s31, s31, s32
ds_read_b128 a[72:75], v2 offset:51200
v_accvgpr_read_b32 v74, a234
v_mfma_f32_16x16x32_bf16 v[68:71], a[132:135], a[36:39], v[68:71]
buffer_load_dwordx4 v18, s[12:15], s27 offen offset:2048 lds
v_mfma_f32_16x16x32_bf16 v[76:79], a[128:131], a[40:43], v[76:79]
ds_read_b128 a[76:79], v3 offset:51200
v_accvgpr_read_b32 v75, a235
v_mfma_f32_16x16x32_bf16 v[76:79], a[132:135], a[44:47], v[76:79]
ds_read_b128 a[80:83], v2 offset:53248
v_accvgpr_read_b32 v96, a236
v_mfma_f32_16x16x32_bf16 v[84:87], a[128:131], a[48:51], v[84:87]
ds_read_b128 a[84:87], v3 offset:53248
v_accvgpr_read_b32 v97, a237
v_mfma_f32_16x16x32_bf16 v[84:87], a[132:135], a[52:55], v[84:87]
buffer_load_dwordx4 v19, s[12:15], s27 offen offset:3072 lds
v_mfma_f32_16x16x32_bf16 v[92:95], a[128:131], a[56:59], v[92:95]
s_add_u32 s27, s27, 524288
ds_read_b128 a[88:91], v2 offset:55296
v_accvgpr_read_b32 v98, a238
v_mfma_f32_16x16x32_bf16 v[92:95], a[132:135], a[60:63], v[92:95]
s_waitcnt lgkmcnt(4)
buffer_store_dwordx4 v[168:171], v1, s[4:7], s31 offen sc1
v_mfma_f32_16x16x32_bf16 v[100:103], a[136:139], a[0:3], v[100:103]
s_add_u32 m0, s28, 32768
ds_read_b64_tr_b16 a[128:129], v24 offset:0
v_accvgpr_read_b32 v99, a239
v_mfma_f32_16x16x32_bf16 v[100:103], a[140:143], a[4:7], v[100:103]
s_add_u32 s31, s31, s33
buffer_load_dwordx4 v12, s[8:11], s24 offen offset:0 lds
v_mfma_f32_16x16x32_bf16 v[108:111], a[136:139], a[8:11], v[108:111]
ds_read_b64_tr_b16 a[130:131], v24 offset:2048
v_cvt_pk_bf16_f32 v72, v72, v73
v_mfma_f32_16x16x32_bf16 v[108:111], a[140:143], a[12:15], v[108:111]
ds_read_b128 a[92:95], v3 offset:55296
v_cvt_pk_bf16_f32 v73, v74, v75
v_mfma_f32_16x16x32_bf16 v[116:119], a[136:139], a[16:19], v[116:119]
ds_read_b64_tr_b16 a[132:133], v24 offset:16384
v_cvt_pk_bf16_f32 v74, v96, v97
v_mfma_f32_16x16x32_bf16 v[116:119], a[140:143], a[20:23], v[116:119]
buffer_load_dwordx4 v13, s[8:11], s24 offen offset:1024 lds
v_mfma_f32_16x16x32_bf16 v[124:127], a[136:139], a[24:27], v[124:127]
ds_read_b64_tr_b16 a[134:135], v24 offset:18432
v_add_u32 v24, 32768, v24
v_mfma_f32_16x16x32_bf16 v[124:127], a[140:143], a[28:31], v[124:127]
v_cvt_pk_bf16_f32 v75, v98, v99
v_accvgpr_read_b32 v80, a240
v_mfma_f32_16x16x32_bf16 v[132:135], a[136:139], a[32:35], v[132:135]
ds_read_b128 a[96:99], v2 offset:57344
v_accvgpr_read_b32 v81, a241
v_mfma_f32_16x16x32_bf16 v[132:135], a[140:143], a[36:39], v[132:135]
buffer_load_dwordx4 v14, s[8:11], s24 offen offset:2048 lds
v_mfma_f32_16x16x32_bf16 v[140:143], a[136:139], a[40:43], v[140:143]
ds_read_b128 a[100:103], v3 offset:57344
v_accvgpr_read_b32 v82, a242
v_mfma_f32_16x16x32_bf16 v[140:143], a[140:143], a[44:47], v[140:143]
ds_read_b128 a[104:107], v2 offset:59392
v_accvgpr_read_b32 v83, a243
v_mfma_f32_16x16x32_bf16 v[148:151], a[136:139], a[48:51], v[148:151]
ds_read_b128 a[108:111], v3 offset:59392
v_accvgpr_read_b32 v96, a244
v_mfma_f32_16x16x32_bf16 v[148:151], a[140:143], a[52:55], v[148:151]
buffer_load_dwordx4 v15, s[8:11], s24 offen offset:3072 lds
v_mfma_f32_16x16x32_bf16 v[156:159], a[136:139], a[56:59], v[156:159]
s_add_u32 s24, s24, 128
ds_read_b128 a[112:115], v2 offset:61440
v_accvgpr_read_b32 v97, a245
v_mfma_f32_16x16x32_bf16 v[156:159], a[140:143], a[60:63], v[156:159]
s_waitcnt lgkmcnt(4)
buffer_store_dwordx4 v[176:179], v1, s[4:7], s31 offen sc1
v_mfma_f32_16x16x32_bf16 v[164:167], a[128:131], a[0:3], v[164:167]
s_add_u32 s31, s31, s32
ds_read_b64_tr_b16 a[136:137], v25 offset:0
v_accvgpr_read_b32 v98, a246
v_mfma_f32_16x16x32_bf16 v[164:167], a[132:135], a[4:7], v[164:167]
v_accvgpr_read_b32 v99, a247
v_cvt_pk_bf16_f32 v80, v80, v81
v_mfma_f32_16x16x32_bf16 v[172:175], a[128:131], a[8:11], v[172:175]
ds_read_b64_tr_b16 a[138:139], v25 offset:2048
v_cvt_pk_bf16_f32 v81, v82, v83
v_mfma_f32_16x16x32_bf16 v[172:175], a[132:135], a[12:15], v[172:175]
ds_read_b128 a[116:119], v3 offset:61440
v_cvt_pk_bf16_f32 v82, v96, v97
v_mfma_f32_16x16x32_bf16 v[180:183], a[128:131], a[16:19], v[180:183]
ds_read_b64_tr_b16 a[140:141], v25 offset:16384
v_cvt_pk_bf16_f32 v83, v98, v99
v_mfma_f32_16x16x32_bf16 v[180:183], a[132:135], a[20:23], v[180:183]
buffer_store_dwordx4 v[184:187], v1, s[4:7], s31 offen sc1
v_mfma_f32_16x16x32_bf16 v[188:191], a[128:131], a[24:27], v[188:191]
s_add_u32 s31, s31, s34
ds_read_b64_tr_b16 a[142:143], v25 offset:18432
v_add_u32 v25, 32768, v25
v_mfma_f32_16x16x32_bf16 v[188:191], a[132:135], a[28:31], v[188:191]
v_accvgpr_read_b32 v88, a248
v_accvgpr_read_b32 v89, a249
v_mfma_f32_16x16x32_bf16 v[196:199], a[128:131], a[32:35], v[196:199]
ds_read_b128 a[120:123], v2 offset:63488
v_accvgpr_read_b32 v90, a250
v_mfma_f32_16x16x32_bf16 v[196:199], a[132:135], a[36:39], v[196:199]
v_accvgpr_read_b32 v91, a251
v_accvgpr_read_b32 v96, a252
v_mfma_f32_16x16x32_bf16 v[204:207], a[128:131], a[40:43], v[204:207]
ds_read_b128 a[124:127], v3 offset:63488
v_accvgpr_read_b32 v97, a253
v_mfma_f32_16x16x32_bf16 v[204:207], a[132:135], a[44:47], v[204:207]
v_accvgpr_read_b32 v98, a254
v_accvgpr_read_b32 v99, a255
v_mfma_f32_16x16x32_bf16 v[212:215], a[128:131], a[48:51], v[212:215]
v_cvt_pk_bf16_f32 v88, v88, v89
v_cvt_pk_bf16_f32 v89, v90, v91
v_mfma_f32_16x16x32_bf16 v[212:215], a[132:135], a[52:55], v[212:215]
v_cvt_pk_bf16_f32 v90, v96, v97
v_cvt_pk_bf16_f32 v91, v98, v99
v_mfma_f32_16x16x32_bf16 v[220:223], a[128:131], a[56:59], v[220:223]
v_mfma_f32_16x16x32_bf16 v[220:223], a[132:135], a[60:63], v[220:223]
s_waitcnt vmcnt(23) lgkmcnt(0)
s_barrier
v_mfma_f32_16x16x32_bf16 v[224:227], a[136:139], a[0:3], v[224:227]
s_add_u32 m0, s29, 98304
ds_read_b64_tr_b16 a[128:129], v22 offset:0
v_mfma_f32_16x16x32_bf16 v[224:227], a[140:143], a[4:7], v[224:227]
buffer_load_dwordx4 v16, s[12:15], s26 offen offset:0 lds
v_mfma_f32_16x16x32_bf16 v[228:231], a[136:139], a[8:11], v[228:231]
ds_read_b64_tr_b16 a[130:131], v22 offset:2048
v_mfma_f32_16x16x32_bf16 v[228:231], a[140:143], a[12:15], v[228:231]
buffer_store_dwordx4 v[192:195], v1, s[4:7], s31 offen sc1
v_mfma_f32_16x16x32_bf16 v[232:235], a[136:139], a[16:19], v[232:235]
s_add_u32 s31, s31, s32
ds_read_b64_tr_b16 a[132:133], v22 offset:16384
v_mfma_f32_16x16x32_bf16 v[232:235], a[140:143], a[20:23], v[232:235]
buffer_load_dwordx4 v17, s[12:15], s26 offen offset:1024 lds
v_mfma_f32_16x16x32_bf16 v[236:239], a[136:139], a[24:27], v[236:239]
ds_read_b64_tr_b16 a[134:135], v22 offset:18432
v_add_u32 v22, 4294901760, v22
v_mfma_f32_16x16x32_bf16 v[236:239], a[140:143], a[28:31], v[236:239]
v_mfma_f32_16x16x32_bf16 v[240:243], a[136:139], a[32:35], v[240:243]
v_mfma_f32_16x16x32_bf16 v[240:243], a[140:143], a[36:39], v[240:243]
buffer_load_dwordx4 v18, s[12:15], s26 offen offset:2048 lds
v_mfma_f32_16x16x32_bf16 v[244:247], a[136:139], a[40:43], v[244:247]
v_mfma_f32_16x16x32_bf16 v[244:247], a[140:143], a[44:47], v[244:247]
v_mfma_f32_16x16x32_bf16 v[248:251], a[136:139], a[48:51], v[248:251]
v_mfma_f32_16x16x32_bf16 v[248:251], a[140:143], a[52:55], v[248:251]
buffer_load_dwordx4 v19, s[12:15], s26 offen offset:3072 lds
v_mfma_f32_16x16x32_bf16 v[252:255], a[136:139], a[56:59], v[252:255]
s_add_u32 s26, s26, 524288
v_mfma_f32_16x16x32_bf16 v[252:255], a[140:143], a[60:63], v[252:255]
s_waitcnt lgkmcnt(0)
v_mfma_f32_16x16x32_bf16 v[36:39], a[128:131], a[64:67], v[36:39]
s_add_u32 m0, s29, 114688
ds_read_b64_tr_b16 a[136:137], v23 offset:0
v_mfma_f32_16x16x32_bf16 v[36:39], a[132:135], a[68:71], v[36:39]
buffer_load_dwordx4 v16, s[12:15], s27 offen offset:0 lds
v_mfma_f32_16x16x32_bf16 v[44:47], a[128:131], a[72:75], v[44:47]
ds_read_b64_tr_b16 a[138:139], v23 offset:2048
v_mfma_f32_16x16x32_bf16 v[44:47], a[132:135], a[76:79], v[44:47]
ds_read_b128 a[0:3], v2 offset:0
ds_read_b128 a[4:7], v3 offset:0
v_mfma_f32_16x16x32_bf16 v[52:55], a[128:131], a[80:83], v[52:55]
ds_read_b64_tr_b16 a[140:141], v23 offset:16384
v_mfma_f32_16x16x32_bf16 v[52:55], a[132:135], a[84:87], v[52:55]
buffer_load_dwordx4 v17, s[12:15], s27 offen offset:1024 lds
v_mfma_f32_16x16x32_bf16 v[60:63], a[128:131], a[88:91], v[60:63]
ds_read_b64_tr_b16 a[142:143], v23 offset:18432
v_add_u32 v23, 4294901760, v23
v_mfma_f32_16x16x32_bf16 v[60:63], a[132:135], a[92:95], v[60:63]
buffer_store_dwordx4 v[200:203], v1, s[4:7], s31 offen sc1
v_mfma_f32_16x16x32_bf16 v[68:71], a[128:131], a[96:99], v[68:71]
s_add_u32 s31, s31, s33
ds_read_b128 a[8:11], v2 offset:2048
v_mfma_f32_16x16x32_bf16 v[68:71], a[132:135], a[100:103], v[68:71]
buffer_load_dwordx4 v18, s[12:15], s27 offen offset:2048 lds
v_mfma_f32_16x16x32_bf16 v[76:79], a[128:131], a[104:107], v[76:79]
ds_read_b128 a[12:15], v3 offset:2048
v_mfma_f32_16x16x32_bf16 v[76:79], a[132:135], a[108:111], v[76:79]
ds_read_b128 a[16:19], v2 offset:4096
v_mfma_f32_16x16x32_bf16 v[84:87], a[128:131], a[112:115], v[84:87]
ds_read_b128 a[20:23], v3 offset:4096
v_mfma_f32_16x16x32_bf16 v[84:87], a[132:135], a[116:119], v[84:87]
buffer_load_dwordx4 v19, s[12:15], s27 offen offset:3072 lds
v_mfma_f32_16x16x32_bf16 v[92:95], a[128:131], a[120:123], v[92:95]
s_add_u32 s27, s27, 524288
ds_read_b128 a[24:27], v2 offset:6144
v_mfma_f32_16x16x32_bf16 v[92:95], a[132:135], a[124:127], v[92:95]
s_waitcnt lgkmcnt(4)
buffer_store_dwordx4 v[208:211], v1, s[4:7], s31 offen sc1
v_mfma_f32_16x16x32_bf16 v[100:103], a[136:139], a[64:67], v[100:103]
s_add_u32 s31, s31, s32
ds_read_b64_tr_b16 a[128:129], v24 offset:0
v_mfma_f32_16x16x32_bf16 v[100:103], a[140:143], a[68:71], v[100:103]
v_mfma_f32_16x16x32_bf16 v[108:111], a[136:139], a[72:75], v[108:111]
ds_read_b64_tr_b16 a[130:131], v24 offset:2048
v_mfma_f32_16x16x32_bf16 v[108:111], a[140:143], a[76:79], v[108:111]
ds_read_b128 a[28:31], v3 offset:6144
v_mfma_f32_16x16x32_bf16 v[116:119], a[136:139], a[80:83], v[116:119]
ds_read_b64_tr_b16 a[132:133], v24 offset:16384
v_mfma_f32_16x16x32_bf16 v[116:119], a[140:143], a[84:87], v[116:119]
v_mfma_f32_16x16x32_bf16 v[124:127], a[136:139], a[88:91], v[124:127]
ds_read_b64_tr_b16 a[134:135], v24 offset:18432
v_add_u32 v24, 4294901760, v24
v_mfma_f32_16x16x32_bf16 v[124:127], a[140:143], a[92:95], v[124:127]
v_mfma_f32_16x16x32_bf16 v[132:135], a[136:139], a[96:99], v[132:135]
ds_read_b128 a[32:35], v2 offset:8192
v_mfma_f32_16x16x32_bf16 v[132:135], a[140:143], a[100:103], v[132:135]
buffer_store_dwordx4 v[216:219], v1, s[4:7], s31 offen sc1
v_mfma_f32_16x16x32_bf16 v[140:143], a[136:139], a[104:107], v[140:143]
s_add_u32 s31, s31, s35
ds_read_b128 a[36:39], v3 offset:8192
v_mfma_f32_16x16x32_bf16 v[140:143], a[140:143], a[108:111], v[140:143]
ds_read_b128 a[40:43], v2 offset:10240
v_mfma_f32_16x16x32_bf16 v[148:151], a[136:139], a[112:115], v[148:151]
ds_read_b128 a[44:47], v3 offset:10240
v_mfma_f32_16x16x32_bf16 v[148:151], a[140:143], a[116:119], v[148:151]
v_mfma_f32_16x16x32_bf16 v[156:159], a[136:139], a[120:123], v[156:159]
ds_read_b128 a[48:51], v2 offset:12288
v_mfma_f32_16x16x32_bf16 v[156:159], a[140:143], a[124:127], v[156:159]
s_waitcnt lgkmcnt(4)
v_mfma_f32_16x16x32_bf16 v[164:167], a[128:131], a[64:67], v[164:167]
ds_read_b64_tr_b16 a[136:137], v25 offset:0
v_mfma_f32_16x16x32_bf16 v[164:167], a[132:135], a[68:71], v[164:167]
v_mfma_f32_16x16x32_bf16 v[172:175], a[128:131], a[72:75], v[172:175]
ds_read_b64_tr_b16 a[138:139], v25 offset:2048
v_mfma_f32_16x16x32_bf16 v[172:175], a[132:135], a[76:79], v[172:175]
ds_read_b128 a[52:55], v3 offset:12288
v_mfma_f32_16x16x32_bf16 v[180:183], a[128:131], a[80:83], v[180:183]
ds_read_b64_tr_b16 a[140:141], v25 offset:16384
v_mfma_f32_16x16x32_bf16 v[180:183], a[132:135], a[84:87], v[180:183]
buffer_store_dwordx4 v[32:35], v1, s[4:7], s31 offen sc1
v_mfma_f32_16x16x32_bf16 v[188:191], a[128:131], a[88:91], v[188:191]
s_add_u32 s31, s31, s32
ds_read_b64_tr_b16 a[142:143], v25 offset:18432
v_add_u32 v25, 4294901760, v25
v_mfma_f32_16x16x32_bf16 v[188:191], a[132:135], a[92:95], v[188:191]
v_mfma_f32_16x16x32_bf16 v[196:199], a[128:131], a[96:99], v[196:199]
ds_read_b128 a[56:59], v2 offset:14336
v_mfma_f32_16x16x32_bf16 v[196:199], a[132:135], a[100:103], v[196:199]
v_mfma_f32_16x16x32_bf16 v[204:207], a[128:131], a[104:107], v[204:207]
ds_read_b128 a[60:63], v3 offset:14336
v_mfma_f32_16x16x32_bf16 v[204:207], a[132:135], a[108:111], v[204:207]
v_mfma_f32_16x16x32_bf16 v[212:215], a[128:131], a[112:115], v[212:215]
v_mfma_f32_16x16x32_bf16 v[212:215], a[132:135], a[116:119], v[212:215]
v_mfma_f32_16x16x32_bf16 v[220:223], a[128:131], a[120:123], v[220:223]
v_mfma_f32_16x16x32_bf16 v[220:223], a[132:135], a[124:127], v[220:223]
s_waitcnt vmcnt(20) lgkmcnt(0)
s_barrier
v_mfma_f32_16x16x32_bf16 v[224:227], a[136:139], a[64:67], v[224:227]
s_add_u32 m0, s29, 131072
ds_read_b64_tr_b16 a[128:129], v22 offset:0
v_mfma_f32_16x16x32_bf16 v[224:227], a[140:143], a[68:71], v[224:227]
buffer_load_dwordx4 v16, s[12:15], s26 offen offset:0 lds
v_mfma_f32_16x16x32_bf16 v[228:231], a[136:139], a[72:75], v[228:231]
ds_read_b64_tr_b16 a[130:131], v22 offset:2048
v_mfma_f32_16x16x32_bf16 v[228:231], a[140:143], a[76:79], v[228:231]
PAD_7:
s_cbranch_execz M_tret
buffer_store_dwordx4 v[40:43], v1, s[4:7], s31 offen sc1
v_mfma_f32_16x16x32_bf16 v[232:235], a[136:139], a[80:83], v[232:235]
s_add_u32 s31, s31, s33
ds_read_b64_tr_b16 a[132:133], v22 offset:16384
v_mfma_f32_16x16x32_bf16 v[232:235], a[140:143], a[84:87], v[232:235]
buffer_load_dwordx4 v17, s[12:15], s26 offen offset:1024 lds
v_mfma_f32_16x16x32_bf16 v[236:239], a[136:139], a[88:91], v[236:239]
ds_read_b64_tr_b16 a[134:135], v22 offset:18432
v_add_u32 v22, 32768, v22
v_mfma_f32_16x16x32_bf16 v[236:239], a[140:143], a[92:95], v[236:239]
v_mfma_f32_16x16x32_bf16 v[240:243], a[136:139], a[96:99], v[240:243]
v_mfma_f32_16x16x32_bf16 v[240:243], a[140:143], a[100:103], v[240:243]
buffer_load_dwordx4 v18, s[12:15], s26 offen offset:2048 lds
v_mfma_f32_16x16x32_bf16 v[244:247], a[136:139], a[104:107], v[244:247]
v_mfma_f32_16x16x32_bf16 v[244:247], a[140:143], a[108:111], v[244:247]
v_mfma_f32_16x16x32_bf16 v[248:251], a[136:139], a[112:115], v[248:251]
v_mfma_f32_16x16x32_bf16 v[248:251], a[140:143], a[116:119], v[248:251]
buffer_load_dwordx4 v19, s[12:15], s26 offen offset:3072 lds
v_mfma_f32_16x16x32_bf16 v[252:255], a[136:139], a[120:123], v[252:255]
s_add_u32 s26, s26, 524288
v_mfma_f32_16x16x32_bf16 v[252:255], a[140:143], a[124:127], v[252:255]
s_waitcnt lgkmcnt(0)
v_mfma_f32_16x16x32_bf16 v[36:39], a[128:131], a[0:3], v[36:39]
s_add_u32 m0, s29, 147456
ds_read_b64_tr_b16 a[136:137], v23 offset:0
v_mfma_f32_16x16x32_bf16 v[36:39], a[132:135], a[4:7], v[36:39]
buffer_load_dwordx4 v16, s[12:15], s27 offen offset:0 lds
v_mfma_f32_16x16x32_bf16 v[44:47], a[128:131], a[8:11], v[44:47]
s_lshl_b32 s22, s20, 7
ds_read_b64_tr_b16 a[138:139], v23 offset:2048
v_bfe_u32 v20, v1, 4, 3
v_mfma_f32_16x16x32_bf16 v[44:47], a[132:135], a[12:15], v[44:47]
s_add_u32 s70, s22, 94371840
ds_read_b128 a[64:67], v2 offset:16384
ds_read_b128 a[68:71], v3 offset:16384
v_mfma_f32_16x16x32_bf16 v[52:55], a[128:131], a[16:19], v[52:55]
s_lshr_b32 s22, s2, 4
ds_read_b64_tr_b16 a[140:141], v23 offset:16384
v_lshlrev_b32 v20, 3, v20
v_mfma_f32_16x16x32_bf16 v[52:55], a[132:135], a[20:23], v[52:55]
s_lshl_b32 s22, s22, 2
buffer_load_dwordx4 v17, s[12:15], s27 offen offset:1024 lds
v_mfma_f32_16x16x32_bf16 v[60:63], a[128:131], a[24:27], v[60:63]
s_add_u32 s66, s70, s22
ds_read_b64_tr_b16 a[142:143], v23 offset:18432
v_add_u32 v23, 32768, v23
v_mfma_f32_16x16x32_bf16 v[60:63], a[132:135], a[28:31], v[60:63]
s_and_b32 s22, s2, 16
buffer_store_dwordx4 v[48:51], v1, s[4:7], s31 offen sc1
v_mfma_f32_16x16x32_bf16 v[68:71], a[128:131], a[32:35], v[68:71]
s_add_u32 s31, s31, s32
ds_read_b128 a[72:75], v2 offset:18432
v_add_u32 v15, 2052, v20
v_mfma_f32_16x16x32_bf16 v[68:71], a[132:135], a[36:39], v[68:71]
s_lshl_b32 s22, s22, 7
buffer_load_dwordx4 v18, s[12:15], s27 offen offset:2048 lds
v_mfma_f32_16x16x32_bf16 v[76:79], a[128:131], a[40:43], v[76:79]
s_add_u32 s66, s66, s22
ds_read_b128 a[76:79], v3 offset:18432
v_mfma_f32_16x16x32_bf16 v[76:79], a[132:135], a[44:47], v[76:79]
s_lshl_b32 s67, s20, 20
ds_read_b128 a[80:83], v2 offset:20480
v_mfma_f32_16x16x32_bf16 v[84:87], a[128:131], a[48:51], v[84:87]
s_lshl_b32 s22, s37, 16
ds_read_b128 a[84:87], v3 offset:20480
v_mfma_f32_16x16x32_bf16 v[84:87], a[132:135], a[52:55], v[84:87]
s_add_u32 s67, s67, s22
buffer_load_dwordx4 v19, s[12:15], s27 offen offset:3072 lds
v_mfma_f32_16x16x32_bf16 v[92:95], a[128:131], a[56:59], v[92:95]
s_waitcnt lgkmcnt(4)
s_add_u32 s27, s27, 524288
ds_read_b128 a[88:91], v2 offset:22528
v_mfma_f32_16x16x32_bf16 v[92:95], a[132:135], a[60:63], v[92:95]
s_lshl_b32 s22, s3, 11
buffer_store_dwordx4 v[56:59], v1, s[4:7], s31 offen sc1
v_mfma_f32_16x16x32_bf16 v[100:103], a[136:139], a[0:3], v[100:103]
s_add_u32 s31, s31, s34
ds_read_b64_tr_b16 a[128:129], v24 offset:0
v_mfma_f32_16x16x32_bf16 v[100:103], a[140:143], a[4:7], v[100:103]
s_add_u32 s67, s67, s22
v_mfma_f32_16x16x32_bf16 v[108:111], a[136:139], a[8:11], v[108:111]
s_add_u32 s67, s67, 33554432
ds_read_b64_tr_b16 a[130:131], v24 offset:2048
v_mfma_f32_16x16x32_bf16 v[108:111], a[140:143], a[12:15], v[108:111]
s_mov_b32 s68, 1035512379
ds_read_b128 a[92:95], v3 offset:22528
v_mfma_f32_16x16x32_bf16 v[116:119], a[136:139], a[16:19], v[116:119]
s_mov_b32 s69, 1035512379
ds_read_b64_tr_b16 a[132:133], v24 offset:16384
v_mfma_f32_16x16x32_bf16 v[116:119], a[140:143], a[20:23], v[116:119]
buffer_store_dwordx4 v[64:67], v1, s[4:7], s31 offen sc1
v_mfma_f32_16x16x32_bf16 v[124:127], a[136:139], a[24:27], v[124:127]
s_add_u32 s31, s31, s32
ds_read_b64_tr_b16 a[134:135], v24 offset:18432
v_add_u32 v24, 32768, v24
v_mfma_f32_16x16x32_bf16 v[124:127], a[140:143], a[28:31], v[124:127]
v_mfma_f32_16x16x32_bf16 v[132:135], a[136:139], a[32:35], v[132:135]
ds_read_b128 a[96:99], v2 offset:24576
v_mfma_f32_16x16x32_bf16 v[132:135], a[140:143], a[36:39], v[132:135]
v_mfma_f32_16x16x32_bf16 v[140:143], a[136:139], a[40:43], v[140:143]
ds_read_b128 a[100:103], v3 offset:24576
v_mfma_f32_16x16x32_bf16 v[140:143], a[140:143], a[44:47], v[140:143]
ds_read_b128 a[104:107], v2 offset:26624
v_mfma_f32_16x16x32_bf16 v[148:151], a[136:139], a[48:51], v[148:151]
ds_read_b128 a[108:111], v3 offset:26624
v_mfma_f32_16x16x32_bf16 v[148:151], a[140:143], a[52:55], v[148:151]
v_mfma_f32_16x16x32_bf16 v[156:159], a[136:139], a[56:59], v[156:159]
ds_read_b128 a[112:115], v2 offset:28672
v_mfma_f32_16x16x32_bf16 v[156:159], a[140:143], a[60:63], v[156:159]
s_waitcnt lgkmcnt(4)
buffer_store_dwordx4 v[72:75], v1, s[4:7], s31 offen sc1
v_mfma_f32_16x16x32_bf16 v[164:167], a[128:131], a[0:3], v[164:167]
s_add_u32 s31, s31, s33
ds_read_b64_tr_b16 a[136:137], v25 offset:0
v_mfma_f32_16x16x32_bf16 v[164:167], a[132:135], a[4:7], v[164:167]
v_mfma_f32_16x16x32_bf16 v[172:175], a[128:131], a[8:11], v[172:175]
ds_read_b64_tr_b16 a[138:139], v25 offset:2048
v_mfma_f32_16x16x32_bf16 v[172:175], a[132:135], a[12:15], v[172:175]
ds_read_b128 a[116:119], v3 offset:28672
v_mfma_f32_16x16x32_bf16 v[180:183], a[128:131], a[16:19], v[180:183]
ds_read_b64_tr_b16 a[140:141], v25 offset:16384
v_mfma_f32_16x16x32_bf16 v[180:183], a[132:135], a[20:23], v[180:183]
v_mfma_f32_16x16x32_bf16 v[188:191], a[128:131], a[24:27], v[188:191]
ds_read_b64_tr_b16 a[142:143], v25 offset:18432
v_add_u32 v25, 32768, v25
v_mfma_f32_16x16x32_bf16 v[188:191], a[132:135], a[28:31], v[188:191]
v_mfma_f32_16x16x32_bf16 v[196:199], a[128:131], a[32:35], v[196:199]
ds_read_b128 a[120:123], v2 offset:30720
v_mfma_f32_16x16x32_bf16 v[196:199], a[132:135], a[36:39], v[196:199]
buffer_store_dwordx4 v[80:83], v1, s[4:7], s31 offen sc1
v_mfma_f32_16x16x32_bf16 v[204:207], a[128:131], a[40:43], v[204:207]
s_add_u32 s31, s31, s32
ds_read_b128 a[124:127], v3 offset:30720
v_mfma_f32_16x16x32_bf16 v[204:207], a[132:135], a[44:47], v[204:207]
v_mfma_f32_16x16x32_bf16 v[212:215], a[128:131], a[48:51], v[212:215]
v_mfma_f32_16x16x32_bf16 v[212:215], a[132:135], a[52:55], v[212:215]
v_mfma_f32_16x16x32_bf16 v[220:223], a[128:131], a[56:59], v[220:223]
v_mfma_f32_16x16x32_bf16 v[220:223], a[132:135], a[60:63], v[220:223]
s_waitcnt vmcnt(17) lgkmcnt(0)
s_barrier
v_mfma_f32_16x16x32_bf16 v[224:227], a[136:139], a[0:3], v[224:227]
ds_read_b64_tr_b16 a[128:129], v22 offset:0
v_mfma_f32_16x16x32_bf16 v[224:227], a[140:143], a[4:7], v[224:227]
v_mfma_f32_16x16x32_bf16 v[228:231], a[136:139], a[8:11], v[228:231]
ds_read_b64_tr_b16 a[130:131], v22 offset:2048
v_mfma_f32_16x16x32_bf16 v[228:231], a[140:143], a[12:15], v[228:231]
buffer_store_dwordx4 v[88:91], v1, s[4:7], s31 offen sc1
v_mfma_f32_16x16x32_bf16 v[232:235], a[136:139], a[16:19], v[232:235]
ds_read_b64_tr_b16 a[132:133], v22 offset:16384
v_mfma_f32_16x16x32_bf16 v[232:235], a[140:143], a[20:23], v[232:235]
v_mfma_f32_16x16x32_bf16 v[236:239], a[136:139], a[24:27], v[236:239]
ds_read_b64_tr_b16 a[134:135], v22 offset:18432
v_add_u32 v22, 32768, v22
v_mfma_f32_16x16x32_bf16 v[236:239], a[140:143], a[28:31], v[236:239]
v_mfma_f32_16x16x32_bf16 v[240:243], a[136:139], a[32:35], v[240:243]
v_mfma_f32_16x16x32_bf16 v[240:243], a[140:143], a[36:39], v[240:243]
v_mfma_f32_16x16x32_bf16 v[244:247], a[136:139], a[40:43], v[244:247]
v_mfma_f32_16x16x32_bf16 v[244:247], a[140:143], a[44:47], v[244:247]
v_mfma_f32_16x16x32_bf16 v[248:251], a[136:139], a[48:51], v[248:251]
v_mfma_f32_16x16x32_bf16 v[248:251], a[140:143], a[52:55], v[248:251]
v_mfma_f32_16x16x32_bf16 v[252:255], a[136:139], a[56:59], v[252:255]
v_mfma_f32_16x16x32_bf16 v[252:255], a[140:143], a[60:63], v[252:255]
s_waitcnt lgkmcnt(0)
v_mfma_f32_16x16x32_bf16 v[36:39], a[128:131], a[64:67], v[36:39]
ds_read_b64_tr_b16 a[136:137], v23 offset:0
v_mfma_f32_16x16x32_bf16 v[36:39], a[132:135], a[68:71], v[36:39]
v_mfma_f32_16x16x32_bf16 v[44:47], a[128:131], a[72:75], v[44:47]
ds_read_b64_tr_b16 a[138:139], v23 offset:2048
v_mfma_f32_16x16x32_bf16 v[44:47], a[132:135], a[76:79], v[44:47]
ds_read_b128 a[0:3], v2 offset:32768
ds_read_b128 a[4:7], v3 offset:32768
v_mfma_f32_16x16x32_bf16 v[52:55], a[128:131], a[80:83], v[52:55]
ds_read_b64_tr_b16 a[140:141], v23 offset:16384
v_mfma_f32_16x16x32_bf16 v[52:55], a[132:135], a[84:87], v[52:55]
v_mfma_f32_16x16x32_bf16 v[60:63], a[128:131], a[88:91], v[60:63]
ds_read_b64_tr_b16 a[142:143], v23 offset:18432
v_add_u32 v23, 32768, v23
v_mfma_f32_16x16x32_bf16 v[60:63], a[132:135], a[92:95], v[60:63]
v_mfma_f32_16x16x32_bf16 v[68:71], a[128:131], a[96:99], v[68:71]
ds_read_b128 a[8:11], v2 offset:34816
v_mfma_f32_16x16x32_bf16 v[68:71], a[132:135], a[100:103], v[68:71]
v_mfma_f32_16x16x32_bf16 v[76:79], a[128:131], a[104:107], v[76:79]
ds_read_b128 a[12:15], v3 offset:34816
v_mfma_f32_16x16x32_bf16 v[76:79], a[132:135], a[108:111], v[76:79]
ds_read_b128 a[16:19], v2 offset:36864
v_mfma_f32_16x16x32_bf16 v[84:87], a[128:131], a[112:115], v[84:87]
ds_read_b128 a[20:23], v3 offset:36864
v_mfma_f32_16x16x32_bf16 v[84:87], a[132:135], a[116:119], v[84:87]
v_mfma_f32_16x16x32_bf16 v[92:95], a[128:131], a[120:123], v[92:95]
ds_read_b128 a[24:27], v2 offset:38912
v_mfma_f32_16x16x32_bf16 v[92:95], a[132:135], a[124:127], v[92:95]
s_waitcnt lgkmcnt(4)
v_mfma_f32_16x16x32_bf16 v[100:103], a[136:139], a[64:67], v[100:103]
ds_read_b64_tr_b16 a[128:129], v24 offset:0
v_mfma_f32_16x16x32_bf16 v[100:103], a[140:143], a[68:71], v[100:103]
v_mfma_f32_16x16x32_bf16 v[108:111], a[136:139], a[72:75], v[108:111]
ds_read_b64_tr_b16 a[130:131], v24 offset:2048
v_mfma_f32_16x16x32_bf16 v[108:111], a[140:143], a[76:79], v[108:111]
ds_read_b128 a[28:31], v3 offset:38912
v_mfma_f32_16x16x32_bf16 v[116:119], a[136:139], a[80:83], v[116:119]
ds_read_b64_tr_b16 a[132:133], v24 offset:16384
v_mfma_f32_16x16x32_bf16 v[116:119], a[140:143], a[84:87], v[116:119]
v_mfma_f32_16x16x32_bf16 v[124:127], a[136:139], a[88:91], v[124:127]
ds_read_b64_tr_b16 a[134:135], v24 offset:18432
v_add_u32 v24, 32768, v24
v_mfma_f32_16x16x32_bf16 v[124:127], a[140:143], a[92:95], v[124:127]
v_mfma_f32_16x16x32_bf16 v[132:135], a[136:139], a[96:99], v[132:135]
ds_read_b128 a[32:35], v2 offset:40960
v_mfma_f32_16x16x32_bf16 v[132:135], a[140:143], a[100:103], v[132:135]
v_mfma_f32_16x16x32_bf16 v[140:143], a[136:139], a[104:107], v[140:143]
ds_read_b128 a[36:39], v3 offset:40960
v_mfma_f32_16x16x32_bf16 v[140:143], a[140:143], a[108:111], v[140:143]
ds_read_b128 a[40:43], v2 offset:43008
v_mfma_f32_16x16x32_bf16 v[148:151], a[136:139], a[112:115], v[148:151]
ds_read_b128 a[44:47], v3 offset:43008
v_mfma_f32_16x16x32_bf16 v[148:151], a[140:143], a[116:119], v[148:151]
v_mfma_f32_16x16x32_bf16 v[156:159], a[136:139], a[120:123], v[156:159]
ds_read_b128 a[48:51], v2 offset:45056
v_mfma_f32_16x16x32_bf16 v[156:159], a[140:143], a[124:127], v[156:159]
s_waitcnt lgkmcnt(4)
v_mfma_f32_16x16x32_bf16 v[164:167], a[128:131], a[64:67], v[164:167]
ds_read_b64_tr_b16 a[136:137], v25 offset:0
v_mfma_f32_16x16x32_bf16 v[164:167], a[132:135], a[68:71], v[164:167]
v_mfma_f32_16x16x32_bf16 v[172:175], a[128:131], a[72:75], v[172:175]
ds_read_b64_tr_b16 a[138:139], v25 offset:2048
v_mfma_f32_16x16x32_bf16 v[172:175], a[132:135], a[76:79], v[172:175]
ds_read_b128 a[52:55], v3 offset:45056
v_mfma_f32_16x16x32_bf16 v[180:183], a[128:131], a[80:83], v[180:183]
ds_read_b64_tr_b16 a[140:141], v25 offset:16384
v_mfma_f32_16x16x32_bf16 v[180:183], a[132:135], a[84:87], v[180:183]
v_mfma_f32_16x16x32_bf16 v[188:191], a[128:131], a[88:91], v[188:191]
ds_read_b64_tr_b16 a[142:143], v25 offset:18432
v_add_u32 v25, 32768, v25
v_mfma_f32_16x16x32_bf16 v[188:191], a[132:135], a[92:95], v[188:191]
v_mfma_f32_16x16x32_bf16 v[196:199], a[128:131], a[96:99], v[196:199]
ds_read_b128 a[56:59], v2 offset:47104
v_mfma_f32_16x16x32_bf16 v[196:199], a[132:135], a[100:103], v[196:199]
v_mfma_f32_16x16x32_bf16 v[204:207], a[128:131], a[104:107], v[204:207]
ds_read_b128 a[60:63], v3 offset:47104
v_mfma_f32_16x16x32_bf16 v[204:207], a[132:135], a[108:111], v[204:207]
v_mfma_f32_16x16x32_bf16 v[212:215], a[128:131], a[112:115], v[212:215]
v_mfma_f32_16x16x32_bf16 v[212:215], a[132:135], a[116:119], v[212:215]
v_mfma_f32_16x16x32_bf16 v[220:223], a[128:131], a[120:123], v[220:223]
v_mfma_f32_16x16x32_bf16 v[220:223], a[132:135], a[124:127], v[220:223]
s_waitcnt vmcnt(0) lgkmcnt(0)
s_barrier
v_mfma_f32_16x16x32_bf16 v[224:227], a[136:139], a[64:67], v[224:227]
ds_read_b64_tr_b16 a[128:129], v22 offset:0
v_mfma_f32_16x16x32_bf16 v[224:227], a[140:143], a[68:71], v[224:227]
buffer_store_dword v27, v26, s[4:7], s66 offen sc1
v_mfma_f32_16x16x32_bf16 v[228:231], a[136:139], a[72:75], v[228:231]
ds_read_b64_tr_b16 a[130:131], v22 offset:2048
v_mfma_f32_16x16x32_bf16 v[228:231], a[140:143], a[76:79], v[228:231]
v_mfma_f32_16x16x32_bf16 v[232:235], a[136:139], a[80:83], v[232:235]
ds_read_b64_tr_b16 a[132:133], v22 offset:16384
v_mfma_f32_16x16x32_bf16 v[232:235], a[140:143], a[84:87], v[232:235]
v_mfma_f32_16x16x32_bf16 v[236:239], a[136:139], a[88:91], v[236:239]
ds_read_b64_tr_b16 a[134:135], v22 offset:18432
v_mfma_f32_16x16x32_bf16 v[236:239], a[140:143], a[92:95], v[236:239]
v_mfma_f32_16x16x32_bf16 v[240:243], a[136:139], a[96:99], v[240:243]
v_mfma_f32_16x16x32_bf16 v[240:243], a[140:143], a[100:103], v[240:243]
v_mfma_f32_16x16x32_bf16 v[244:247], a[136:139], a[104:107], v[244:247]
v_mfma_f32_16x16x32_bf16 v[244:247], a[140:143], a[108:111], v[244:247]
v_mfma_f32_16x16x32_bf16 v[248:251], a[136:139], a[112:115], v[248:251]
v_mfma_f32_16x16x32_bf16 v[248:251], a[140:143], a[116:119], v[248:251]
v_mfma_f32_16x16x32_bf16 v[252:255], a[136:139], a[120:123], v[252:255]
v_mfma_f32_16x16x32_bf16 v[252:255], a[140:143], a[124:127], v[252:255]
s_waitcnt lgkmcnt(0)
v_mfma_f32_16x16x32_bf16 v[36:39], a[128:131], a[0:3], v[36:39]
s_lshl_b32 s18, s3, 13
ds_read_b64_tr_b16 a[136:137], v23 offset:0
v_lshrrev_b32 v28, 6, v0
v_mfma_f32_16x16x32_bf16 v[36:39], a[132:135], a[4:7], v[36:39]
s_lshl_b32 s30, s20, 20
v_lshl_add_u32 v28, v28, 11, v1
v_add_u32 v28, 65536, v28
v_mfma_f32_16x16x32_bf16 v[44:47], a[128:131], a[8:11], v[44:47]
s_add_u32 s30, s30, s18
ds_read_b64_tr_b16 a[138:139], v23 offset:2048
v_lshrrev_b32 v3, 6, v0
v_mfma_f32_16x16x32_bf16 v[44:47], a[132:135], a[12:15], v[44:47]
s_lshl_b32 s22, s21, 1
v_and_b32 v4, 63, v0
v_add_u32 v2, 0x10000, v1
v_mfma_f32_16x16x32_bf16 v[52:55], a[128:131], a[16:19], v[52:55]
s_lshl_b32 s85, s21, 2
ds_read_b64_tr_b16 a[140:141], v23 offset:16384
v_and_b32 v5, 15, v4
v_mfma_f32_16x16x32_bf16 v[52:55], a[132:135], a[20:23], v[52:55]
s_lshr_b32 s85, 2386092, s85
v_lshrrev_b32 v6, 4, v4
v_lshlrev_b32 v6, 2, v6
v_mfma_f32_16x16x32_bf16 v[60:63], a[128:131], a[24:27], v[60:63]
s_and_b32 s9, s85, 15
ds_read_b64_tr_b16 a[142:143], v23 offset:18432
v_sub_u32 v5, v5, v6
v_mfma_f32_16x16x32_bf16 v[60:63], a[132:135], a[28:31], v[60:63]
s_and_b32 s84, s85, 1
v_lshl_add_u32 v5, v3, 4, v5
v_cmp_gt_i32 s[32:33], 0, v5
v_mfma_f32_16x16x32_bf16 v[68:71], a[128:131], a[32:35], v[68:71]
s_lshl_b32 s84, s84, 17
v_cmp_gt_i32 s[34:35], 1, v5
v_cmp_gt_i32 s[36:37], 2, v5
v_mfma_f32_16x16x32_bf16 v[68:71], a[132:135], a[36:39], v[68:71]
s_add_u32 s84, s84, s18
v_cmp_gt_i32 s[38:39], 3, v5
v_cmp_gt_i32 s[40:41], 16, v5
v_mfma_f32_16x16x32_bf16 v[76:79], a[128:131], a[40:43], v[76:79]
s_xor_b32 s85, s84, 0x20000
v_cmp_gt_i32 s[42:43], 17, v5
v_cmp_gt_i32 s[44:45], 18, v5
v_mfma_f32_16x16x32_bf16 v[76:79], a[132:135], a[44:47], v[76:79]
s_sub_u32 s29, 15, s21
v_cmp_gt_i32 s[46:47], 19, v5
v_cmp_gt_i32 s[48:49], 32, v5
v_mfma_f32_16x16x32_bf16 v[84:87], a[128:131], a[48:51], v[84:87]
s_cmp_lg_u32 s9, 0
v_cmp_gt_i32 s[50:51], 33, v5
v_cmp_gt_i32 s[52:53], 34, v5
v_mfma_f32_16x16x32_bf16 v[84:87], a[132:135], a[52:55], v[84:87]
s_cselect_b32 s24, 1, 0
v_cmp_gt_i32 s[54:55], 35, v5
v_cmp_gt_i32 s[56:57], 48, v5
v_mfma_f32_16x16x32_bf16 v[92:95], a[128:131], a[56:59], v[92:95]
s_cselect_b32 s67, s67, 3221225472
v_cmp_gt_i32 s[58:59], 49, v5
v_cmp_gt_i32 s[60:61], 50, v5
v_mfma_f32_16x16x32_bf16 v[92:95], a[132:135], a[60:63], v[92:95]
s_waitcnt lgkmcnt(0)
v_cmp_gt_i32 s[62:63], 51, v5
v_mov_b32 v7, 0xff800000
v_mfma_f32_16x16x32_bf16 v[100:103], a[136:139], a[0:3], v[100:103]
s_lshl_b32 s8, s9, 15
ds_read_b64_tr_b16 a[128:129], v24 offset:0
v_mov_b32 v6, 1
v_mfma_f32_16x16x32_bf16 v[100:103], a[140:143], a[4:7], v[100:103]
s_add_u32 s8, s8, s30
v_mov_b32 v5, v26
v_add_u32 v4, 0x20000, v1
v_mfma_f32_16x16x32_bf16 v[108:111], a[136:139], a[8:11], v[108:111]
s_add_u32 s9, s9, s22
ds_read_b64_tr_b16 a[130:131], v24 offset:2048
v_mfma_f32_16x16x32_bf16 v[108:111], a[140:143], a[12:15], v[108:111]
s_sub_u32 s9, 32, s9
v_mfma_f32_16x16x32_bf16 v[116:119], a[136:139], a[16:19], v[116:119]
s_bitcmp1_b32 s2, 4
ds_read_b64_tr_b16 a[132:133], v24 offset:16384
v_mfma_f32_16x16x32_bf16 v[116:119], a[140:143], a[20:23], v[116:119]
s_cselect_b32 s9, 16, s9
v_mfma_f32_16x16x32_bf16 v[124:127], a[136:139], a[24:27], v[124:127]
s_cselect_b32 s29, 7, s29
ds_read_b64_tr_b16 a[134:135], v24 offset:18432
v_mul_f32 v36, s68, v36
v_mfma_f32_16x16x32_bf16 v[124:127], a[140:143], a[28:31], v[124:127]
s_mov_b32 s10, 3221225472
v_mul_f32 v37, s68, v37
v_mul_f32 v38, s68, v38
v_mfma_f32_16x16x32_bf16 v[132:135], a[136:139], a[32:35], v[132:135]
s_mov_b32 s14, 3221225472
v_mul_f32 v39, s68, v39
v_mul_f32 v100, s68, v100
v_mfma_f32_16x16x32_bf16 v[132:135], a[140:143], a[36:39], v[132:135]
s_mov_b32 s11, 0
v_mul_f32 v101, s68, v101
v_mul_f32 v102, s68, v102
v_mfma_f32_16x16x32_bf16 v[140:143], a[136:139], a[40:43], v[140:143]
s_lshr_b32 s19, s9, 1
v_mul_f32 v103, s68, v103
v_cvt_pk_bf16_f32 v36, v36, v37
v_mfma_f32_16x16x32_bf16 v[140:143], a[140:143], a[44:47], v[140:143]
s_sub_u32 s19, s19, 1
v_cvt_pk_bf16_f32 v37, v38, v39
v_cvt_pk_bf16_f32 v38, v100, v101
v_mfma_f32_16x16x32_bf16 v[148:151], a[136:139], a[48:51], v[148:151]
s_add_u32 s12, s8, 16777216
v_cvt_pk_bf16_f32 v39, v102, v103
v_mul_f32 v44, s68, v44
v_mfma_f32_16x16x32_bf16 v[148:151], a[140:143], a[52:55], v[148:151]
s_mov_b32 s13, s9
ds_write_b128 v28, v[36:39] offset:0
v_mul_f32 v45, s68, v45
v_mfma_f32_16x16x32_bf16 v[156:159], a[136:139], a[56:59], v[156:159]
s_mov_b32 s15, s11
s_add_u32 s23, s67, 0
buffer_store_dwordx4 v[36:39], v1, s[4:7], s23 offen offset:0 sc1
v_mfma_f32_16x16x32_bf16 v[156:159], a[140:143], a[60:63], v[156:159]
s_waitcnt lgkmcnt(1)
v_mul_f32 v46, s68, v46
v_mul_f32 v47, s68, v47
v_mfma_f32_16x16x32_bf16 v[164:167], a[128:131], a[0:3], v[164:167]
ds_read_b64_tr_b16 a[136:137], v25 offset:0
v_mul_f32 v108, s68, v108
v_mfma_f32_16x16x32_bf16 v[164:167], a[132:135], a[4:7], v[164:167]
v_mul_f32 v109, s68, v109
v_mul_f32 v110, s68, v110
v_mfma_f32_16x16x32_bf16 v[172:175], a[128:131], a[8:11], v[172:175]
ds_read_b64_tr_b16 a[138:139], v25 offset:2048
v_mul_f32 v111, s68, v111
v_mfma_f32_16x16x32_bf16 v[172:175], a[132:135], a[12:15], v[172:175]
v_cvt_pk_bf16_f32 v44, v44, v45
v_cvt_pk_bf16_f32 v45, v46, v47
v_mfma_f32_16x16x32_bf16 v[180:183], a[128:131], a[16:19], v[180:183]
ds_read_b64_tr_b16 a[140:141], v25 offset:16384
v_cvt_pk_bf16_f32 v46, v108, v109
v_mfma_f32_16x16x32_bf16 v[180:183], a[132:135], a[20:23], v[180:183]
v_cvt_pk_bf16_f32 v47, v110, v111
v_mul_f32 v52, s68, v52
v_mfma_f32_16x16x32_bf16 v[188:191], a[128:131], a[24:27], v[188:191]
ds_read_b64_tr_b16 a[142:143], v25 offset:18432
v_mul_f32 v53, s68, v53
v_mfma_f32_16x16x32_bf16 v[188:191], a[132:135], a[28:31], v[188:191]
ds_write_b128 v28, v[44:47] offset:8192
v_mul_f32 v54, s68, v54
v_mfma_f32_16x16x32_bf16 v[196:199], a[128:131], a[32:35], v[196:199]
s_add_u32 s23, s67, 8192
buffer_store_dwordx4 v[44:47], v1, s[4:7], s23 offen offset:0 sc1
v_mfma_f32_16x16x32_bf16 v[196:199], a[132:135], a[36:39], v[196:199]
v_mul_f32 v55, s68, v55
v_mul_f32 v116, s68, v116
v_mfma_f32_16x16x32_bf16 v[204:207], a[128:131], a[40:43], v[204:207]
v_mul_f32 v117, s68, v117
v_mul_f32 v118, s68, v118
v_mfma_f32_16x16x32_bf16 v[204:207], a[132:135], a[44:47], v[204:207]
v_mul_f32 v119, s68, v119
v_cvt_pk_bf16_f32 v52, v52, v53
v_mfma_f32_16x16x32_bf16 v[212:215], a[128:131], a[48:51], v[212:215]
v_cvt_pk_bf16_f32 v53, v54, v55
v_cvt_pk_bf16_f32 v54, v116, v117
v_mfma_f32_16x16x32_bf16 v[212:215], a[132:135], a[52:55], v[212:215]
v_cvt_pk_bf16_f32 v55, v118, v119
v_mul_f32 v60, s68, v60
v_mfma_f32_16x16x32_bf16 v[220:223], a[128:131], a[56:59], v[220:223]
ds_write_b128 v28, v[52:55] offset:16384
v_mul_f32 v61, s68, v61
v_mfma_f32_16x16x32_bf16 v[220:223], a[132:135], a[60:63], v[220:223]
s_waitcnt lgkmcnt(0)
s_waitcnt lgkmcnt(0)
s_barrier
v_mfma_f32_16x16x32_bf16 v[224:227], a[136:139], a[0:3], v[224:227]
s_add_u32 s23, s67, 16384
buffer_store_dwordx4 v[52:55], v1, s[4:7], s23 offen offset:0 sc1
v_mfma_f32_16x16x32_bf16 v[224:227], a[140:143], a[4:7], v[224:227]
v_mul_f32 v62, s68, v62
v_mul_f32 v63, s68, v63
v_mfma_f32_16x16x32_bf16 v[228:231], a[136:139], a[8:11], v[228:231]
v_mul_f32 v124, s68, v124
v_mul_f32 v125, s68, v125
v_mfma_f32_16x16x32_bf16 v[228:231], a[140:143], a[12:15], v[228:231]
v_mul_f32 v126, s68, v126
v_mul_f32 v127, s68, v127
v_mfma_f32_16x16x32_bf16 v[232:235], a[136:139], a[16:19], v[232:235]
v_cvt_pk_bf16_f32 v60, v60, v61
v_cvt_pk_bf16_f32 v61, v62, v63
v_mfma_f32_16x16x32_bf16 v[232:235], a[140:143], a[20:23], v[232:235]
v_cvt_pk_bf16_f32 v62, v124, v125
v_cvt_pk_bf16_f32 v63, v126, v127
v_mfma_f32_16x16x32_bf16 v[236:239], a[136:139], a[24:27], v[236:239]
ds_write_b128 v28, v[60:63] offset:24576
v_mul_f32 v68, s68, v68
v_mfma_f32_16x16x32_bf16 v[236:239], a[140:143], a[28:31], v[236:239]
s_add_u32 s23, s67, 24576
buffer_store_dwordx4 v[60:63], v1, s[4:7], s23 offen offset:0 sc1
v_mfma_f32_16x16x32_bf16 v[240:243], a[136:139], a[32:35], v[240:243]
v_mul_f32 v69, s68, v69
v_mul_f32 v70, s68, v70
v_mfma_f32_16x16x32_bf16 v[240:243], a[140:143], a[36:39], v[240:243]
v_mul_f32 v71, s68, v71
v_mul_f32 v132, s68, v132
v_mfma_f32_16x16x32_bf16 v[244:247], a[136:139], a[40:43], v[244:247]
v_mul_f32 v133, s68, v133
v_mul_f32 v134, s68, v134
v_mfma_f32_16x16x32_bf16 v[244:247], a[140:143], a[44:47], v[244:247]
v_mul_f32 v135, s68, v135
v_cvt_pk_bf16_f32 v68, v68, v69
v_mfma_f32_16x16x32_bf16 v[248:251], a[136:139], a[48:51], v[248:251]
v_cvt_pk_bf16_f32 v69, v70, v71
v_cvt_pk_bf16_f32 v70, v132, v133
v_mfma_f32_16x16x32_bf16 v[248:251], a[140:143], a[52:55], v[248:251]
v_cvt_pk_bf16_f32 v71, v134, v135
v_mfma_f32_16x16x32_bf16 v[252:255], a[136:139], a[56:59], v[252:255]
ds_write_b128 v28, v[68:71] offset:32768
v_mfma_f32_16x16x32_bf16 v[252:255], a[140:143], a[60:63], v[252:255]
s_add_u32 s23, s67, 32768
buffer_store_dwordx4 v[68:71], v1, s[4:7], s23 offen offset:0 sc1
buffer_load_dword v21, v20, s[4:7], s70 offen sc1
v_pk_mul_f32 v[76:77], v[76:77], s[68:69]
v_pk_mul_f32 v[78:79], v[78:79], s[68:69]
v_pk_mul_f32 v[140:141], v[140:141], s[68:69]
v_pk_mul_f32 v[142:143], v[142:143], s[68:69]
v_cvt_pk_bf16_f32 v76, v76, v77
v_cvt_pk_bf16_f32 v77, v78, v79
v_cvt_pk_bf16_f32 v78, v140, v141
v_cvt_pk_bf16_f32 v79, v142, v143
ds_write_b128 v28, v[76:79] offset:40960
s_add_u32 s23, s67, 40960
buffer_store_dwordx4 v[76:79], v1, s[4:7], s23 offen offset:0 sc1
v_pk_mul_f32 v[84:85], v[84:85], s[68:69]
v_pk_mul_f32 v[86:87], v[86:87], s[68:69]
v_pk_mul_f32 v[148:149], v[148:149], s[68:69]
v_pk_mul_f32 v[150:151], v[150:151], s[68:69]
v_cvt_pk_bf16_f32 v84, v84, v85
v_cvt_pk_bf16_f32 v85, v86, v87
v_cvt_pk_bf16_f32 v86, v148, v149
v_cvt_pk_bf16_f32 v87, v150, v151
ds_write_b128 v28, v[84:87] offset:49152
s_add_u32 s23, s67, 49152
buffer_store_dwordx4 v[84:87], v1, s[4:7], s23 offen offset:0 sc1
v_pk_mul_f32 v[92:93], v[92:93], s[68:69]
v_pk_mul_f32 v[94:95], v[94:95], s[68:69]
v_pk_mul_f32 v[156:157], v[156:157], s[68:69]
v_pk_mul_f32 v[158:159], v[158:159], s[68:69]
v_cvt_pk_bf16_f32 v92, v92, v93
v_cvt_pk_bf16_f32 v93, v94, v95
v_cvt_pk_bf16_f32 v94, v156, v157
v_cvt_pk_bf16_f32 v95, v158, v159
ds_write_b128 v28, v[92:95] offset:57344
s_add_u32 s23, s67, 57344
buffer_store_dwordx4 v[92:95], v1, s[4:7], s23 offen offset:0 sc1
v_pk_mul_f32 v[164:165], v[164:165], s[68:69]
v_pk_mul_f32 v[166:167], v[166:167], s[68:69]
v_pk_mul_f32 v[224:225], v[224:225], s[68:69]
v_pk_mul_f32 v[226:227], v[226:227], s[68:69]
v_cvt_pk_bf16_f32 v164, v164, v165
v_cvt_pk_bf16_f32 v165, v166, v167
v_cvt_pk_bf16_f32 v166, v224, v225
v_cvt_pk_bf16_f32 v167, v226, v227
ds_write_b128 v28, v[164:167] offset:1024
s_add_u32 s23, s67, 0
buffer_store_dwordx4 v[164:167], v1, s[4:7], s23 offen offset:1024 sc1
v_pk_mul_f32 v[172:173], v[172:173], s[68:69]
v_pk_mul_f32 v[174:175], v[174:175], s[68:69]
v_pk_mul_f32 v[228:229], v[228:229], s[68:69]
v_pk_mul_f32 v[230:231], v[230:231], s[68:69]
v_cvt_pk_bf16_f32 v172, v172, v173
v_cvt_pk_bf16_f32 v173, v174, v175
v_cvt_pk_bf16_f32 v174, v228, v229
v_cvt_pk_bf16_f32 v175, v230, v231
ds_write_b128 v28, v[172:175] offset:9216
s_add_u32 s23, s67, 8192
buffer_store_dwordx4 v[172:175], v1, s[4:7], s23 offen offset:1024 sc1
v_pk_mul_f32 v[180:181], v[180:181], s[68:69]
v_pk_mul_f32 v[182:183], v[182:183], s[68:69]
v_pk_mul_f32 v[232:233], v[232:233], s[68:69]
v_pk_mul_f32 v[234:235], v[234:235], s[68:69]
v_cvt_pk_bf16_f32 v180, v180, v181
v_cvt_pk_bf16_f32 v181, v182, v183
v_cvt_pk_bf16_f32 v182, v232, v233
v_cvt_pk_bf16_f32 v183, v234, v235
ds_write_b128 v28, v[180:183] offset:17408
s_add_u32 s23, s67, 16384
buffer_store_dwordx4 v[180:183], v1, s[4:7], s23 offen offset:1024 sc1
v_pk_mul_f32 v[188:189], v[188:189], s[68:69]
v_pk_mul_f32 v[190:191], v[190:191], s[68:69]
v_pk_mul_f32 v[236:237], v[236:237], s[68:69]
v_pk_mul_f32 v[238:239], v[238:239], s[68:69]
v_cvt_pk_bf16_f32 v188, v188, v189
v_cvt_pk_bf16_f32 v189, v190, v191
v_cvt_pk_bf16_f32 v190, v236, v237
v_cvt_pk_bf16_f32 v191, v238, v239
ds_write_b128 v28, v[188:191] offset:25600
s_add_u32 s23, s67, 24576
buffer_store_dwordx4 v[188:191], v1, s[4:7], s23 offen offset:1024 sc1
v_pk_mul_f32 v[196:197], v[196:197], s[68:69]
v_pk_mul_f32 v[198:199], v[198:199], s[68:69]
v_pk_mul_f32 v[240:241], v[240:241], s[68:69]
v_pk_mul_f32 v[242:243], v[242:243], s[68:69]
PAD_8:
s_cbranch_execz M_tret
v_cvt_pk_bf16_f32 v196, v196, v197
v_cvt_pk_bf16_f32 v197, v198, v199
v_cvt_pk_bf16_f32 v198, v240, v241
v_cvt_pk_bf16_f32 v199, v242, v243
ds_write_b128 v28, v[196:199] offset:33792
s_add_u32 s23, s67, 32768
buffer_store_dwordx4 v[196:199], v1, s[4:7], s23 offen offset:1024 sc1
v_pk_mul_f32 v[204:205], v[204:205], s[68:69]
v_pk_mul_f32 v[206:207], v[206:207], s[68:69]
v_pk_mul_f32 v[244:245], v[244:245], s[68:69]
v_pk_mul_f32 v[246:247], v[246:247], s[68:69]
v_cvt_pk_bf16_f32 v204, v204, v205
v_cvt_pk_bf16_f32 v205, v206, v207
v_cvt_pk_bf16_f32 v206, v244, v245
v_cvt_pk_bf16_f32 v207, v246, v247
ds_write_b128 v28, v[204:207] offset:41984
s_add_u32 s23, s67, 40960
buffer_store_dwordx4 v[204:207], v1, s[4:7], s23 offen offset:1024 sc1
v_pk_mul_f32 v[212:213], v[212:213], s[68:69]
v_pk_mul_f32 v[214:215], v[214:215], s[68:69]
v_pk_mul_f32 v[248:249], v[248:249], s[68:69]
v_pk_mul_f32 v[250:251], v[250:251], s[68:69]
v_cvt_pk_bf16_f32 v212, v212, v213
v_cvt_pk_bf16_f32 v213, v214, v215
v_cvt_pk_bf16_f32 v214, v248, v249
v_cvt_pk_bf16_f32 v215, v250, v251
ds_write_b128 v28, v[212:215] offset:50176
s_add_u32 s23, s67, 49152
buffer_store_dwordx4 v[212:215], v1, s[4:7], s23 offen offset:1024 sc1
v_pk_mul_f32 v[220:221], v[220:221], s[68:69]
v_pk_mul_f32 v[222:223], v[222:223], s[68:69]
v_pk_mul_f32 v[252:253], v[252:253], s[68:69]
v_pk_mul_f32 v[254:255], v[254:255], s[68:69]
v_cvt_pk_bf16_f32 v220, v220, v221
v_cvt_pk_bf16_f32 v221, v222, v223
v_cvt_pk_bf16_f32 v222, v252, v253
v_cvt_pk_bf16_f32 v223, v254, v255
ds_write_b128 v28, v[220:223] offset:58368
s_add_u32 s23, s67, 57344
buffer_store_dwordx4 v[220:223], v1, s[4:7], s23 offen offset:1024 sc1
s_waitcnt vmcnt(11)
v_cmp_gt_u32 vcc, 1, v21
s_cbranch_vccnz M_kspin
M_kok:
buffer_load_dword v21, v15, s[4:7], s70 offen sc1
s_mov_b32 m0, s84
s_nop 0
buffer_load_dwordx4 v1, s[4:7], s8 offen offset:0 sc1 lds
buffer_load_dwordx4 v1, s[4:7], s8 offen offset:1024 sc1 lds
buffer_load_dwordx4 v1, s[4:7], s8 offen offset:2048 sc1 lds
buffer_load_dwordx4 v1, s[4:7], s8 offen offset:3072 sc1 lds
s_add_u32 s8, s8, 4096
s_add_u32 m0, s84, 4096
s_nop 0
buffer_load_dwordx4 v1, s[4:7], s8 offen offset:0 sc1 lds
buffer_load_dwordx4 v1, s[4:7], s8 offen offset:1024 sc1 lds
buffer_load_dwordx4 v1, s[4:7], s8 offen offset:2048 sc1 lds
buffer_load_dwordx4 v1, s[4:7], s8 offen offset:3072 sc1 lds
s_add_u32 s8, s8, 28672
s_sub_u32 s9, s9, 1
s_cmp_eq_u32 s9, 0
s_cselect_b32 s8, s10, s8
s_cselect_b32 s9, s11, s9
s_cselect_b32 s10, 3221225472, s10
v_add_u32 v28, s18, v2
s_waitcnt lgkmcnt(0)
s_barrier
ds_read_b128 a[0:3], v28 offset:0
ds_read_b128 a[4:7], v28 offset:1024
ds_read_b128 a[8:11], v28 offset:2048
ds_read_b128 a[12:15], v28 offset:3072
ds_read_b128 a[16:19], v28 offset:4096
ds_read_b128 a[20:23], v28 offset:5120
ds_read_b128 a[24:27], v28 offset:6144
ds_read_b128 a[28:31], v28 offset:7168
ds_read_b128 a[32:35], v28 offset:32768
ds_read_b128 a[36:39], v28 offset:33792
ds_read_b128 a[40:43], v28 offset:34816
ds_read_b128 a[44:47], v28 offset:35840
ds_read_b128 a[48:51], v28 offset:36864
ds_read_b128 a[52:55], v28 offset:37888
ds_read_b128 a[56:59], v28 offset:38912
ds_read_b128 a[60:63], v28 offset:39936
s_mov_b32 m0, s85
s_nop 0
buffer_load_dwordx4 v1, s[4:7], s8 offen offset:0 sc1 lds
buffer_load_dwordx4 v1, s[4:7], s8 offen offset:1024 sc1 lds
buffer_load_dwordx4 v1, s[4:7], s8 offen offset:2048 sc1 lds
buffer_load_dwordx4 v1, s[4:7], s8 offen offset:3072 sc1 lds
s_add_u32 s8, s8, 4096
s_add_u32 m0, s85, 4096
s_nop 0
buffer_load_dwordx4 v1, s[4:7], s8 offen offset:0 sc1 lds
buffer_load_dwordx4 v1, s[4:7], s8 offen offset:1024 sc1 lds
buffer_load_dwordx4 v1, s[4:7], s8 offen offset:2048 sc1 lds
buffer_load_dwordx4 v1, s[4:7], s8 offen offset:3072 sc1 lds
s_add_u32 s8, s8, 28672
s_sub_u32 s9, s9, 1
s_cmp_eq_u32 s9, 0
s_cselect_b32 s8, s10, s8
s_cselect_b32 s9, s11, s9
s_cselect_b32 s10, 3221225472, s10
s_mov_b32 s25, 1266679808
s_lshl_b32 s22, s21, 3
s_add_u32 s28, s70, s22
s_add_u32 s28, s28, 6148
s_lshl_b32 s26, s21, 16
s_add_u32 s26, s26, s30
s_add_u32 s26, s26, 33554432
s_lshl_b32 s76, s20, 3
s_add_u32 s76, s76, s21
s_lshl_b32 s76, s76, 2
s_add_u32 s76, s76, s3
s_lshl_b32 s27, s76, 10
s_add_u32 s27, s27, 75497472
s_lshl_b32 s76, s76, 14
s_add_u32 s76, s76, 67108864
s_lshl_b32 s81, s20, 2
s_add_u32 s81, s81, s3
s_mul_i32 s81, s81, 57344
s_cmp_eq_u32 s24, 1
s_cselect_b32 s80, s28, s70
s_add_u32 s77, s76, 8192
v_lshrrev_b32 v8, 7, v1
v_and_b32 v9, 6, v8
v_lshlrev_b32 v9, 4, v9
v_and_b32 v10, 0x70, v1
v_xor_b32 v9, v9, v10
v_mul_u32_u24 v8, 896, v8
v_add_u32 v8, v8, v9
v_accvgpr_write_b32 a184, v8
v_add_u32 v8, 6144, v8
v_accvgpr_write_b32 a185, v8
v_add_u32 v8, 6144, v8
v_accvgpr_write_b32 a186, v8
v_add_u32 v8, 6144, v8
v_accvgpr_write_b32 a187, v8
v_lshrrev_b32 v8, 6, v1
v_bfe_u32 v9, v1, 7, 2
v_lshlrev_b32 v9, 5, v9
v_lshl_add_u32 v8, v8, 7, v9
v_bfe_u32 v9, v1, 4, 2
v_lshl_add_u32 v8, v9, 3, v8
v_add_u32 v8, 32768, v8
v_accvgpr_write_b32 a188, v8
v_xor_b32 v9, 32, v8
v_accvgpr_write_b32 a189, v9
v_xor_b32 v9, 64, v8
v_accvgpr_write_b32 a190, v9
v_xor_b32 v9, 96, v8
v_accvgpr_write_b32 a191, v9
s_add_u32 s22, s66, 16384
s_mov_b32 s71, 3221225472
s_waitcnt vmcnt(17)
s_barrier
buffer_store_dword v6, v5, s[4:7], s22 offen sc1
v_mov_b64 v[128:129], 0
v_mov_b64 v[130:131], 0
v_mov_b64 v[132:133], 0
v_mov_b64 v[134:135], 0
v_mov_b64 v[136:137], 0
v_mov_b64 v[138:139], 0
v_mov_b64 v[140:141], 0
v_mov_b64 v[142:143], 0
v_mov_b64 v[144:145], 0
v_mov_b64 v[146:147], 0
v_mov_b64 v[148:149], 0
v_mov_b64 v[150:151], 0
v_mov_b64 v[152:153], 0
v_mov_b64 v[154:155], 0
v_mov_b64 v[156:157], 0
v_mov_b64 v[158:159], 0
v_mov_b64 v[160:161], 0
v_mov_b64 v[162:163], 0
v_mov_b64 v[164:165], 0
v_mov_b64 v[166:167], 0
v_mov_b64 v[168:169], 0
v_mov_b64 v[170:171], 0
v_mov_b64 v[172:173], 0
v_mov_b64 v[174:175], 0
v_mov_b64 v[176:177], 0
v_mov_b64 v[178:179], 0
v_mov_b64 v[180:181], 0
v_mov_b64 v[182:183], 0
v_mov_b64 v[184:185], 0
v_mov_b64 v[186:187], 0
v_mov_b64 v[188:189], 0
v_mov_b64 v[190:191], 0
v_mov_b64 v[192:193], 0
v_mov_b64 v[194:195], 0
v_mov_b64 v[196:197], 0
v_mov_b64 v[198:199], 0
v_mov_b64 v[200:201], 0
v_mov_b64 v[202:203], 0
v_mov_b64 v[204:205], 0
v_mov_b64 v[206:207], 0
v_mov_b64 v[208:209], 0
v_mov_b64 v[210:211], 0
v_mov_b64 v[212:213], 0
v_mov_b64 v[214:215], 0
v_mov_b64 v[216:217], 0
v_mov_b64 v[218:219], 0
v_mov_b64 v[220:221], 0
v_mov_b64 v[222:223], 0
v_mov_b64 v[224:225], 0
v_mov_b64 v[226:227], 0
v_mov_b64 v[228:229], 0
v_mov_b64 v[230:231], 0
v_mov_b64 v[232:233], 0
v_mov_b64 v[234:235], 0
v_mov_b64 v[236:237], 0
v_mov_b64 v[238:239], 0
v_mov_b64 v[240:241], 0
v_mov_b64 v[242:243], 0
v_mov_b64 v[244:245], 0
v_mov_b64 v[246:247], 0
v_mov_b64 v[248:249], 0
v_mov_b64 v[250:251], 0
v_mov_b64 v[252:253], 0
v_mov_b64 v[254:255], 0
v_mov_b64 v[24:25], 0
s_waitcnt vmcnt(9) lgkmcnt(0)
v_cmp_gt_u32 vcc, 1, v21
s_cbranch_vccnz M_vspin
M_vok:
s_barrier
K2_item:
PAD_9:
s_cbranch_execz M_tret
s_cmp_eq_u32 s19, 0
s_cbranch_scc1 K2_p0d
ds_read_b128 a[64:67], v1 offset:0
ds_read_b128 a[68:71], v1 offset:1024
ds_read_b128 a[72:75], v1 offset:2048
ds_read_b128 a[76:79], v1 offset:3072
ds_read_b128 a[80:83], v1 offset:4096
ds_read_b128 a[84:87], v1 offset:5120
ds_read_b128 a[88:91], v1 offset:6144
ds_read_b128 a[92:95], v1 offset:7168
s_waitcnt lgkmcnt(7)
v_mfma_f32_16x16x32_bf16 v[32:35], a[64:67], a[0:3], 0
s_waitcnt lgkmcnt(6)
s_add_u32 m0, s18, 65536
ds_read_b128 a[96:99], v1 offset:8192
v_mfma_f32_16x16x32_bf16 v[32:35], a[68:71], a[4:7], v[32:35]
s_waitcnt lgkmcnt(6)
buffer_load_dwordx4 v1, s[4:7], s12 offen offset:0 sc1 lds
v_mfma_f32_16x16x32_bf16 v[32:35], a[72:75], a[8:11], v[32:35]
s_waitcnt lgkmcnt(5)
ds_read_b128 a[100:103], v1 offset:9216
v_mfma_f32_16x16x32_bf16 v[32:35], a[76:79], a[12:15], v[32:35]
s_waitcnt lgkmcnt(5)
buffer_load_dwordx4 v1, s[4:7], s12 offen offset:1024 sc1 lds
v_mfma_f32_16x16x32_bf16 v[32:35], a[80:83], a[16:19], v[32:35]
s_waitcnt lgkmcnt(4)
ds_read_b128 a[104:107], v1 offset:10240
v_mfma_f32_16x16x32_bf16 v[32:35], a[84:87], a[20:23], v[32:35]
s_waitcnt lgkmcnt(4)
buffer_load_dwordx4 v1, s[4:7], s12 offen offset:2048 sc1 lds
v_mfma_f32_16x16x32_bf16 v[32:35], a[88:91], a[24:27], v[32:35]
s_waitcnt lgkmcnt(3)
ds_read_b128 a[108:111], v1 offset:11264
v_mfma_f32_16x16x32_bf16 v[32:35], a[92:95], a[28:31], v[32:35]
buffer_load_dwordx4 v1, s[4:7], s12 offen offset:3072 sc1 lds
v_mfma_f32_16x16x32_bf16 v[36:39], a[64:67], a[32:35], 0
s_add_u32 s12, s12, 4096
s_add_u32 m0, s18, 69632
ds_read_b128 a[112:115], v1 offset:12288
v_mfma_f32_16x16x32_bf16 v[36:39], a[68:71], a[36:39], v[36:39]
buffer_load_dwordx4 v1, s[4:7], s12 offen offset:0 sc1 lds
v_mfma_f32_16x16x32_bf16 v[36:39], a[72:75], a[40:43], v[36:39]
ds_read_b128 a[116:119], v1 offset:13312
v_mfma_f32_16x16x32_bf16 v[36:39], a[76:79], a[44:47], v[36:39]
buffer_load_dwordx4 v1, s[4:7], s12 offen offset:1024 sc1 lds
v_mfma_f32_16x16x32_bf16 v[36:39], a[80:83], a[48:51], v[36:39]
ds_read_b128 a[120:123], v1 offset:14336
v_max3_f32 v28, v32, v33, v34
v_mfma_f32_16x16x32_bf16 v[36:39], a[84:87], a[52:55], v[36:39]
buffer_load_dwordx4 v1, s[4:7], s12 offen offset:2048 sc1 lds
v_mfma_f32_16x16x32_bf16 v[36:39], a[88:91], a[56:59], v[36:39]
ds_read_b128 a[124:127], v1 offset:15360
v_max_f32 v28, v28, v35
v_mfma_f32_16x16x32_bf16 v[36:39], a[92:95], a[60:63], v[36:39]
s_waitcnt lgkmcnt(3)
buffer_load_dwordx4 v1, s[4:7], s12 offen offset:3072 sc1 lds
v_mfma_f32_16x16x32_bf16 v[40:43], a[96:99], a[0:3], 0
s_add_u32 s12, s12, 28672
ds_read_b128 a[64:67], v1 offset:16384
v_mov_b32 v30, v28
v_mfma_f32_16x16x32_bf16 v[40:43], a[100:103], a[4:7], v[40:43]
s_waitcnt lgkmcnt(2)
s_sub_u32 s13, s13, 1
v_mfma_f32_16x16x32_bf16 v[40:43], a[104:107], a[8:11], v[40:43]
s_cmp_eq_u32 s13, 0
ds_read_b128 a[68:71], v1 offset:17408
v_permlane16_swap_b32 v28, v30
v_mfma_f32_16x16x32_bf16 v[40:43], a[108:111], a[12:15], v[40:43]
s_cselect_b32 s12, s14, s12
v_max_f32 v28, v28, v30
v_mov_b32 v30, v28
v_mfma_f32_16x16x32_bf16 v[40:43], a[112:115], a[16:19], v[40:43]
s_cselect_b32 s13, s15, s13
ds_read_b128 a[72:75], v1 offset:18432
v_max3_f32 v29, v36, v37, v38
v_mfma_f32_16x16x32_bf16 v[40:43], a[116:119], a[20:23], v[40:43]
s_cselect_b32 s14, 3221225472, s14
v_permlane32_swap_b32 v28, v30
v_max_f32 v28, v28, v30
v_mfma_f32_16x16x32_bf16 v[40:43], a[120:123], a[24:27], v[40:43]
s_waitcnt lgkmcnt(3)
ds_read_b128 a[76:79], v1 offset:19456
v_sub_f32 v16, 0, v28
v_mfma_f32_16x16x32_bf16 v[40:43], a[124:127], a[28:31], v[40:43]
v_sub_f32 v17, 0, v28
v_sub_f32 v18, 0, v28
v_mfma_f32_16x16x32_bf16 v[44:47], a[96:99], a[32:35], 0
ds_read_b128 a[80:83], v1 offset:20480
v_sub_f32 v19, 0, v28
v_mfma_f32_16x16x32_bf16 v[44:47], a[100:103], a[36:39], v[44:47]
v_max_f32 v29, v29, v39
v_mov_b32 v31, v29
v_mfma_f32_16x16x32_bf16 v[44:47], a[104:107], a[40:43], v[44:47]
ds_read_b128 a[84:87], v1 offset:21504
v_mfma_f32_16x16x32_bf16 v[44:47], a[108:111], a[44:47], v[44:47]
v_permlane16_swap_b32 v29, v31
v_max_f32 v29, v29, v31
v_mfma_f32_16x16x32_bf16 v[44:47], a[112:115], a[48:51], v[44:47]
ds_read_b128 a[88:91], v1 offset:22528
v_mov_b32 v31, v29
v_mfma_f32_16x16x32_bf16 v[44:47], a[116:119], a[52:55], v[44:47]
v_mfma_f32_16x16x32_bf16 v[44:47], a[120:123], a[56:59], v[44:47]
ds_read_b128 a[92:95], v1 offset:23552
v_permlane32_swap_b32 v29, v31
v_mfma_f32_16x16x32_bf16 v[44:47], a[124:127], a[60:63], v[44:47]
s_waitcnt lgkmcnt(3)
v_max_f32 v29, v29, v31
v_sub_f32 v20, 0, v29
v_mfma_f32_16x16x32_bf16 v[48:51], a[64:67], a[0:3], v[16:19]
ds_read_b128 a[96:99], v1 offset:24576
v_sub_f32 v21, 0, v29
v_mfma_f32_16x16x32_bf16 v[48:51], a[68:71], a[4:7], v[48:51]
v_sub_f32 v22, 0, v29
v_sub_f32 v23, 0, v29
v_mfma_f32_16x16x32_bf16 v[48:51], a[72:75], a[8:11], v[48:51]
ds_read_b128 a[100:103], v1 offset:25600
v_mfma_f32_16x16x32_bf16 v[48:51], a[76:79], a[12:15], v[48:51]
v_mfma_f32_16x16x32_bf16 v[48:51], a[80:83], a[16:19], v[48:51]
s_waitcnt lgkmcnt(3)
ds_read_b128 a[104:107], v1 offset:26624
v_mfma_f32_16x16x32_bf16 v[48:51], a[84:87], a[20:23], v[48:51]
v_add_f32 v32, v32, v16
v_add_f32 v33, v33, v16
v_add_f32 v34, v34, v16
v_add_f32 v35, v35, v16
v_mfma_f32_16x16x32_bf16 v[48:51], a[88:91], a[24:27], v[48:51]
s_waitcnt lgkmcnt(3)
ds_read_b128 a[108:111], v1 offset:27648
v_add_f32 v36, v36, v20
v_add_f32 v37, v37, v20
v_add_f32 v38, v38, v20
v_add_f32 v39, v39, v20
v_mfma_f32_16x16x32_bf16 v[48:51], a[92:95], a[28:31], v[48:51]
v_add_f32 v40, v40, v16
v_add_f32 v41, v41, v16
v_add_f32 v42, v42, v16
v_add_f32 v43, v43, v16
v_mfma_f32_16x16x32_bf16 v[52:55], a[64:67], a[32:35], v[20:23]
ds_read_b128 a[112:115], v1 offset:28672
v_add_f32 v44, v44, v20
v_add_f32 v45, v45, v20
v_add_f32 v46, v46, v20
v_add_f32 v47, v47, v20
v_mfma_f32_16x16x32_bf16 v[52:55], a[68:71], a[36:39], v[52:55]
v_exp_f32 v8, v32
v_mfma_f32_16x16x32_bf16 v[52:55], a[72:75], a[40:43], v[52:55]
ds_read_b128 a[116:119], v1 offset:29696
v_exp_f32 v9, v33
v_mfma_f32_16x16x32_bf16 v[52:55], a[76:79], a[44:47], v[52:55]
v_exp_f32 v10, v34
v_add_f32 v26, v8, v9
v_cvt_pk_bf16_f32 v96, v8, v9
v_mfma_f32_16x16x32_bf16 v[52:55], a[80:83], a[48:51], v[52:55]
ds_read_b128 a[120:123], v1 offset:30720
v_exp_f32 v11, v35
v_add_f32 v26, v26, v10
v_mfma_f32_16x16x32_bf16 v[52:55], a[84:87], a[52:55], v[52:55]
v_exp_f32 v12, v36
v_add_f32 v26, v26, v11
v_cvt_pk_bf16_f32 v97, v10, v11
v_mfma_f32_16x16x32_bf16 v[52:55], a[88:91], a[56:59], v[52:55]
s_waitcnt vmcnt(8) lgkmcnt(3)
ds_read_b128 a[124:127], v1 offset:31744
v_exp_f32 v13, v37
v_mfma_f32_16x16x32_bf16 v[52:55], a[92:95], a[60:63], v[52:55]
s_barrier
v_mfma_f32_16x16x32_bf16 v[56:59], a[96:99], a[0:3], v[16:19]
ds_read_b128 a[64:67], v4 offset:0
v_exp_f32 v14, v38
v_mfma_f32_16x16x32_bf16 v[56:59], a[100:103], a[4:7], v[56:59]
buffer_store_dword v6, v5, s[4:7], s71 offen sc1
v_mfma_f32_16x16x32_bf16 v[56:59], a[104:107], a[8:11], v[56:59]
ds_read_b128 a[68:71], v4 offset:1024
v_add_f32 v27, v12, v13
v_cvt_pk_bf16_f32 v104, v12, v13
v_add_f32 v27, v27, v14
v_mfma_f32_16x16x32_bf16 v[56:59], a[108:111], a[12:15], v[56:59]
s_waitcnt lgkmcnt(3)
v_exp_f32 v15, v39
v_mfma_f32_16x16x32_bf16 v[56:59], a[112:115], a[16:19], v[56:59]
ds_read_b128 a[72:75], v4 offset:2048
v_exp_f32 v8, v40
v_add_f32 v27, v27, v15
v_cvt_pk_bf16_f32 v105, v14, v15
v_mfma_f32_16x16x32_bf16 v[56:59], a[116:119], a[20:23], v[56:59]
v_exp_f32 v9, v41
v_add_f32 v26, v26, v8
v_mfma_f32_16x16x32_bf16 v[56:59], a[120:123], a[24:27], v[56:59]
s_waitcnt lgkmcnt(3)
ds_read_b128 a[76:79], v4 offset:3072
v_exp_f32 v10, v42
v_add_f32 v26, v26, v9
v_cvt_pk_bf16_f32 v98, v8, v9
v_mfma_f32_16x16x32_bf16 v[56:59], a[124:127], a[28:31], v[56:59]
v_exp_f32 v11, v43
v_add_f32 v26, v26, v10
v_mfma_f32_16x16x32_bf16 v[60:63], a[96:99], a[32:35], v[20:23]
ds_read_b128 a[80:83], v4 offset:4096
v_exp_f32 v12, v44
v_mfma_f32_16x16x32_bf16 v[60:63], a[100:103], a[36:39], v[60:63]
v_exp_f32 v13, v45
v_mfma_f32_16x16x32_bf16 v[60:63], a[104:107], a[40:43], v[60:63]
ds_read_b128 a[84:87], v4 offset:5120
v_exp_f32 v14, v46
v_mfma_f32_16x16x32_bf16 v[60:63], a[108:111], a[44:47], v[60:63]
v_exp_f32 v15, v47
v_mfma_f32_16x16x32_bf16 v[60:63], a[112:115], a[48:51], v[60:63]
ds_read_b128 a[88:91], v4 offset:6144
v_add_f32 v26, v26, v11
v_cvt_pk_bf16_f32 v99, v10, v11
v_mfma_f32_16x16x32_bf16 v[60:63], a[116:119], a[52:55], v[60:63]
v_add_f32 v27, v27, v12
v_add_f32 v27, v27, v13
v_cvt_pk_bf16_f32 v106, v12, v13
v_mfma_f32_16x16x32_bf16 v[60:63], a[120:123], a[56:59], v[60:63]
s_waitcnt lgkmcnt(7)
s_barrier
ds_read_b128 a[92:95], v4 offset:7168
v_mfma_f32_16x16x32_bf16 v[60:63], a[124:127], a[60:63], v[60:63]
s_waitcnt lgkmcnt(3)
v_add_f32 v27, v27, v14
v_add_f32 v27, v27, v15
v_cvt_pk_bf16_f32 v107, v14, v15
K2_x1:
v_mfma_f32_16x16x32_bf16 v[64:67], a[64:67], a[0:3], v[16:19]
s_add_u32 m0, s18, 0
ds_read_b128 a[96:99], v4 offset:8192
v_mfma_f32_16x16x32_bf16 v[64:67], a[68:71], a[4:7], v[64:67]
s_waitcnt lgkmcnt(3)
buffer_load_dwordx4 v1, s[4:7], s8 offen offset:0 sc1 lds
v_mfma_f32_16x16x32_bf16 v[64:67], a[72:75], a[8:11], v[64:67]
ds_read_b128 a[100:103], v4 offset:9216
v_mfma_f32_16x16x32_bf16 v[64:67], a[76:79], a[12:15], v[64:67]
v_exp_f32 v8, v48
v_mfma_f32_16x16x32_bf16 v[64:67], a[80:83], a[16:19], v[64:67]
s_waitcnt lgkmcnt(3)
ds_read_b128 a[104:107], v4 offset:10240
v_add_f32 v26, v26, v8
v_mfma_f32_16x16x32_bf16 v[64:67], a[84:87], a[20:23], v[64:67]
buffer_load_dwordx4 v1, s[4:7], s8 offen offset:1024 sc1 lds
v_mfma_f32_16x16x32_bf16 v[64:67], a[88:91], a[24:27], v[64:67]
s_waitcnt lgkmcnt(3)
ds_read_b128 a[108:111], v4 offset:11264
v_mfma_f32_16x16x32_bf16 v[64:67], a[92:95], a[28:31], v[64:67]
v_exp_f32 v9, v49
v_mfma_f32_16x16x32_bf16 v[68:71], a[64:67], a[32:35], v[20:23]
ds_read_b128 a[112:115], v4 offset:12288
v_add_f32 v26, v26, v9
v_mfma_f32_16x16x32_bf16 v[68:71], a[68:71], a[36:39], v[68:71]
buffer_load_dwordx4 v1, s[4:7], s8 offen offset:2048 sc1 lds
v_mfma_f32_16x16x32_bf16 v[68:71], a[72:75], a[40:43], v[68:71]
ds_read_b128 a[116:119], v4 offset:13312
v_cvt_pk_bf16_f32 v100, v8, v9
v_mfma_f32_16x16x32_bf16 v[68:71], a[76:79], a[44:47], v[68:71]
v_exp_f32 v10, v50
v_mfma_f32_16x16x32_bf16 v[68:71], a[80:83], a[48:51], v[68:71]
ds_read_b128 a[120:123], v4 offset:14336
v_add_f32 v26, v26, v10
v_mfma_f32_16x16x32_bf16 v[68:71], a[84:87], a[52:55], v[68:71]
buffer_load_dwordx4 v1, s[4:7], s8 offen offset:3072 sc1 lds
v_mfma_f32_16x16x32_bf16 v[68:71], a[88:91], a[56:59], v[68:71]
s_add_u32 s8, s8, 4096
ds_read_b128 a[124:127], v4 offset:15360
v_mfma_f32_16x16x32_bf16 v[68:71], a[92:95], a[60:63], v[68:71]
s_waitcnt lgkmcnt(3)
v_exp_f32 v11, v51
v_mfma_f32_16x16x32_bf16 v[72:75], a[96:99], a[0:3], v[16:19]
s_add_u32 m0, s18, 4096
ds_read_b128 a[64:67], v4 offset:16384
v_add_f32 v26, v26, v11
v_mfma_f32_16x16x32_bf16 v[72:75], a[100:103], a[4:7], v[72:75]
buffer_load_dwordx4 v1, s[4:7], s8 offen offset:0 sc1 lds
v_mfma_f32_16x16x32_bf16 v[72:75], a[104:107], a[8:11], v[72:75]
ds_read_b128 a[68:71], v4 offset:17408
v_cvt_pk_bf16_f32 v101, v10, v11
v_mfma_f32_16x16x32_bf16 v[72:75], a[108:111], a[12:15], v[72:75]
v_mfma_f32_16x16x32_bf16 v[72:75], a[112:115], a[16:19], v[72:75]
s_waitcnt lgkmcnt(3)
ds_read_b128 a[72:75], v4 offset:18432
v_mfma_f32_16x16x32_bf16 v[72:75], a[116:119], a[20:23], v[72:75]
buffer_load_dwordx4 v1, s[4:7], s8 offen offset:1024 sc1 lds
v_mfma_f32_16x16x32_bf16 v[72:75], a[120:123], a[24:27], v[72:75]
s_waitcnt lgkmcnt(3)
ds_read_b128 a[76:79], v4 offset:19456
v_mfma_f32_16x16x32_bf16 v[72:75], a[124:127], a[28:31], v[72:75]
v_exp_f32 v12, v52
v_mfma_f32_16x16x32_bf16 v[76:79], a[96:99], a[32:35], v[20:23]
ds_read_b128 a[80:83], v4 offset:20480
v_add_f32 v27, v27, v12
v_mfma_f32_16x16x32_bf16 v[76:79], a[100:103], a[36:39], v[76:79]
buffer_load_dwordx4 v1, s[4:7], s8 offen offset:2048 sc1 lds
v_mfma_f32_16x16x32_bf16 v[76:79], a[104:107], a[40:43], v[76:79]
ds_read_b128 a[84:87], v4 offset:21504
v_mfma_f32_16x16x32_bf16 v[76:79], a[108:111], a[44:47], v[76:79]
v_exp_f32 v13, v53
v_mfma_f32_16x16x32_bf16 v[76:79], a[112:115], a[48:51], v[76:79]
ds_read_b128 a[88:91], v4 offset:22528
v_add_f32 v27, v27, v13
v_mfma_f32_16x16x32_bf16 v[76:79], a[116:119], a[52:55], v[76:79]
s_waitcnt lgkmcnt(3)
buffer_load_dwordx4 v1, s[4:7], s8 offen offset:3072 sc1 lds
v_mfma_f32_16x16x32_bf16 v[76:79], a[120:123], a[56:59], v[76:79]
s_add_u32 s8, s8, 28672
ds_read_b128 a[92:95], v4 offset:23552
v_cvt_pk_bf16_f32 v108, v12, v13
v_mfma_f32_16x16x32_bf16 v[76:79], a[124:127], a[60:63], v[76:79]
s_sub_u32 s9, s9, 1
v_exp_f32 v14, v54
v_mfma_f32_16x16x32_bf16 v[80:83], a[64:67], a[0:3], v[16:19]
s_cmp_eq_u32 s9, 0
ds_read_b128 a[96:99], v4 offset:24576
v_add_f32 v27, v27, v14
v_mfma_f32_16x16x32_bf16 v[80:83], a[68:71], a[4:7], v[80:83]
s_cselect_b32 s8, s10, s8
v_exp_f32 v15, v55
v_mfma_f32_16x16x32_bf16 v[80:83], a[72:75], a[8:11], v[80:83]
s_cselect_b32 s9, s11, s9
ds_read_b128 a[100:103], v4 offset:25600
v_add_f32 v27, v27, v15
v_mfma_f32_16x16x32_bf16 v[80:83], a[76:79], a[12:15], v[80:83]
s_waitcnt lgkmcnt(3)
s_cselect_b32 s10, 3221225472, s10
v_cvt_pk_bf16_f32 v109, v14, v15
v_mfma_f32_16x16x32_bf16 v[80:83], a[80:83], a[16:19], v[80:83]
ds_read_b128 a[104:107], v4 offset:26624
v_mfma_f32_16x16x32_bf16 v[80:83], a[84:87], a[20:23], v[80:83]
v_exp_f32 v8, v56
v_mfma_f32_16x16x32_bf16 v[80:83], a[88:91], a[24:27], v[80:83]
s_waitcnt lgkmcnt(3)
ds_read_b128 a[108:111], v4 offset:27648
v_add_f32 v26, v26, v8
v_mfma_f32_16x16x32_bf16 v[80:83], a[92:95], a[28:31], v[80:83]
v_exp_f32 v9, v57
v_mfma_f32_16x16x32_bf16 v[84:87], a[64:67], a[32:35], v[20:23]
ds_read_b128 a[112:115], v4 offset:28672
v_add_f32 v26, v26, v9
v_mfma_f32_16x16x32_bf16 v[84:87], a[68:71], a[36:39], v[84:87]
v_exp_f32 v10, v58
v_mfma_f32_16x16x32_bf16 v[84:87], a[72:75], a[40:43], v[84:87]
ds_read_b128 a[116:119], v4 offset:29696
v_cvt_pk_bf16_f32 v102, v8, v9
v_mfma_f32_16x16x32_bf16 v[84:87], a[76:79], a[44:47], v[84:87]
v_exp_f32 v11, v59
v_mfma_f32_16x16x32_bf16 v[84:87], a[80:83], a[48:51], v[84:87]
ds_read_b128 a[120:123], v4 offset:30720
v_add_f32 v26, v26, v10
v_mfma_f32_16x16x32_bf16 v[84:87], a[84:87], a[52:55], v[84:87]
v_add_f32 v26, v26, v11
v_cvt_pk_bf16_f32 v103, v10, v11
v_mfma_f32_16x16x32_bf16 v[84:87], a[88:91], a[56:59], v[84:87]
s_waitcnt vmcnt(8) lgkmcnt(3)
ds_read_b128 a[124:127], v4 offset:31744
v_mfma_f32_16x16x32_bf16 v[84:87], a[92:95], a[60:63], v[84:87]
s_barrier
v_mfma_f32_16x16x32_bf16 v[88:91], a[96:99], a[0:3], v[16:19]
ds_read_b128 a[64:67], v2 offset:0
v_mfma_f32_16x16x32_bf16 v[88:91], a[100:103], a[4:7], v[88:91]
v_exp_f32 v12, v60
v_mfma_f32_16x16x32_bf16 v[88:91], a[104:107], a[8:11], v[88:91]
ds_read_b128 a[68:71], v2 offset:1024
v_add_f32 v27, v27, v12
v_mfma_f32_16x16x32_bf16 v[88:91], a[108:111], a[12:15], v[88:91]
s_waitcnt lgkmcnt(3)
v_exp_f32 v13, v61
v_mfma_f32_16x16x32_bf16 v[88:91], a[112:115], a[16:19], v[88:91]
ds_read_b128 a[72:75], v2 offset:2048
v_add_f32 v27, v27, v13
v_mfma_f32_16x16x32_bf16 v[88:91], a[116:119], a[20:23], v[88:91]
v_exp_f32 v14, v62
v_mfma_f32_16x16x32_bf16 v[88:91], a[120:123], a[24:27], v[88:91]
s_waitcnt lgkmcnt(3)
ds_read_b128 a[76:79], v2 offset:3072
v_cvt_pk_bf16_f32 v110, v12, v13
v_mfma_f32_16x16x32_bf16 v[88:91], a[124:127], a[28:31], v[88:91]
v_exp_f32 v15, v63
v_mfma_f32_16x16x32_bf16 v[92:95], a[96:99], a[32:35], v[20:23]
s_sub_u32 s19, s19, 1
ds_read_b128 a[80:83], v2 offset:4096
v_add_f32 v27, v27, v14
v_mfma_f32_16x16x32_bf16 v[92:95], a[100:103], a[36:39], v[92:95]
v_add_f32 v27, v27, v15
v_cvt_pk_bf16_f32 v111, v14, v15
v_mfma_f32_16x16x32_bf16 v[92:95], a[104:107], a[40:43], v[92:95]
ds_read_b128 a[84:87], v2 offset:5120
v_add_f32 v28, v26, v27
v_mfma_f32_16x16x32_bf16 v[92:95], a[108:111], a[44:47], v[92:95]
v_cmp_nge_f32 vcc, s25, v28
v_mfma_f32_16x16x32_bf16 v[92:95], a[112:115], a[48:51], v[92:95]
s_cmp_eq_u64 vcc, 0
ds_read_b128 a[88:91], v2 offset:6144
v_mfma_f32_16x16x32_bf16 v[92:95], a[116:119], a[52:55], v[92:95]
s_cselect_b32 s22, s19, 0
v_mfma_f32_16x16x32_bf16 v[92:95], a[120:123], a[56:59], v[92:95]
s_cmp_eq_u32 s22, 0
ds_read_b128 a[92:95], v2 offset:7168
v_mfma_f32_16x16x32_bf16 v[92:95], a[124:127], a[60:63], v[92:95]
s_waitcnt lgkmcnt(3)
s_cbranch_scc1 K2_xexit
K2_loop:
v_mfma_f32_16x16x32_bf16 v[128:131], a[64:67], v[96:99], v[128:131]
s_add_u32 m0, s18, 98304
ds_read_b128 a[96:99], v2 offset:8192
v_add_f32 v24, v24, v26
v_mfma_f32_16x16x32_bf16 v[128:131], a[68:71], v[100:103], v[128:131]
buffer_load_dwordx4 v1, s[4:7], s12 offen offset:0 sc1 lds
v_mfma_f32_16x16x32_bf16 v[132:135], a[68:71], v[108:111], v[132:135]
ds_read_b128 a[100:103], v2 offset:9216
v_add_f32 v25, v25, v27
v_mfma_f32_16x16x32_bf16 v[132:135], a[64:67], v[104:107], v[132:135]
v_exp_f32 v8, v64
v_mfma_f32_16x16x32_bf16 v[136:139], a[72:75], v[96:99], v[136:139]
ds_read_b128 a[104:107], v2 offset:10240
v_mfma_f32_16x16x32_bf16 v[136:139], a[76:79], v[100:103], v[136:139]
buffer_load_dwordx4 v1, s[4:7], s12 offen offset:1024 sc1 lds
v_mfma_f32_16x16x32_bf16 v[140:143], a[76:79], v[108:111], v[140:143]
ds_read_b128 a[108:111], v2 offset:11264
v_mfma_f32_16x16x32_bf16 v[140:143], a[72:75], v[104:107], v[140:143]
v_exp_f32 v9, v65
v_mfma_f32_16x16x32_bf16 v[144:147], a[80:83], v[96:99], v[144:147]
s_waitcnt lgkmcnt(3)
ds_read_b128 a[112:115], v2 offset:12288
v_add_f32 v26, v8, v9
v_mfma_f32_16x16x32_bf16 v[144:147], a[84:87], v[100:103], v[144:147]
buffer_load_dwordx4 v1, s[4:7], s12 offen offset:2048 sc1 lds
v_mfma_f32_16x16x32_bf16 v[148:151], a[84:87], v[108:111], v[148:151]
ds_read_b128 a[116:119], v2 offset:13312
v_cvt_pk_bf16_f32 v112, v8, v9
v_mfma_f32_16x16x32_bf16 v[148:151], a[80:83], v[104:107], v[148:151]
PAD_10:
s_cbranch_execz M_tret
v_exp_f32 v10, v66
v_mfma_f32_16x16x32_bf16 v[152:155], a[88:91], v[96:99], v[152:155]
ds_read_b128 a[120:123], v2 offset:14336
v_add_f32 v26, v26, v10
v_mfma_f32_16x16x32_bf16 v[152:155], a[92:95], v[100:103], v[152:155]
buffer_load_dwordx4 v1, s[4:7], s12 offen offset:3072 sc1 lds
v_mfma_f32_16x16x32_bf16 v[156:159], a[92:95], v[108:111], v[156:159]
s_add_u32 s12, s12, 4096
ds_read_b128 a[124:127], v2 offset:15360
v_mfma_f32_16x16x32_bf16 v[156:159], a[88:91], v[104:107], v[156:159]
s_waitcnt lgkmcnt(3)
v_exp_f32 v11, v67
v_mfma_f32_16x16x32_bf16 v[160:163], a[96:99], v[96:99], v[160:163]
s_add_u32 m0, s18, 102400
ds_read_b128 a[64:67], v2 offset:16384
v_add_f32 v26, v26, v11
v_mfma_f32_16x16x32_bf16 v[160:163], a[100:103], v[100:103], v[160:163]
buffer_load_dwordx4 v1, s[4:7], s12 offen offset:0 sc1 lds
v_mfma_f32_16x16x32_bf16 v[164:167], a[100:103], v[108:111], v[164:167]
ds_read_b128 a[68:71], v2 offset:17408
v_cvt_pk_bf16_f32 v113, v10, v11
v_mfma_f32_16x16x32_bf16 v[164:167], a[96:99], v[104:107], v[164:167]
v_mfma_f32_16x16x32_bf16 v[168:171], a[104:107], v[96:99], v[168:171]
ds_read_b128 a[72:75], v2 offset:18432
v_mfma_f32_16x16x32_bf16 v[168:171], a[108:111], v[100:103], v[168:171]
buffer_load_dwordx4 v1, s[4:7], s12 offen offset:1024 sc1 lds
v_mfma_f32_16x16x32_bf16 v[172:175], a[108:111], v[108:111], v[172:175]
ds_read_b128 a[76:79], v2 offset:19456
v_mfma_f32_16x16x32_bf16 v[172:175], a[104:107], v[104:107], v[172:175]
v_exp_f32 v12, v68
v_mfma_f32_16x16x32_bf16 v[176:179], a[112:115], v[96:99], v[176:179]
s_waitcnt lgkmcnt(3)
ds_read_b128 a[80:83], v2 offset:20480
v_mfma_f32_16x16x32_bf16 v[176:179], a[116:119], v[100:103], v[176:179]
buffer_load_dwordx4 v1, s[4:7], s12 offen offset:2048 sc1 lds
v_mfma_f32_16x16x32_bf16 v[180:183], a[116:119], v[108:111], v[180:183]
ds_read_b128 a[84:87], v2 offset:21504
v_mfma_f32_16x16x32_bf16 v[180:183], a[112:115], v[104:107], v[180:183]
v_exp_f32 v13, v69
v_mfma_f32_16x16x32_bf16 v[184:187], a[120:123], v[96:99], v[184:187]
ds_read_b128 a[88:91], v2 offset:22528
v_add_f32 v27, v12, v13
v_mfma_f32_16x16x32_bf16 v[184:187], a[124:127], v[100:103], v[184:187]
s_waitcnt lgkmcnt(3)
buffer_load_dwordx4 v1, s[4:7], s12 offen offset:3072 sc1 lds
v_mfma_f32_16x16x32_bf16 v[188:191], a[124:127], v[108:111], v[188:191]
s_add_u32 s12, s12, 28672
ds_read_b128 a[92:95], v2 offset:23552
v_cvt_pk_bf16_f32 v120, v12, v13
v_mfma_f32_16x16x32_bf16 v[188:191], a[120:123], v[104:107], v[188:191]
s_sub_u32 s13, s13, 1
v_exp_f32 v14, v70
v_mfma_f32_16x16x32_bf16 v[192:195], a[64:67], v[96:99], v[192:195]
s_cmp_eq_u32 s13, 0
ds_read_b128 a[96:99], v2 offset:24576
v_add_f32 v27, v27, v14
v_mfma_f32_16x16x32_bf16 v[192:195], a[68:71], v[100:103], v[192:195]
s_cselect_b32 s12, s14, s12
v_mfma_f32_16x16x32_bf16 v[196:199], a[68:71], v[108:111], v[196:199]
s_cselect_b32 s13, s15, s13
ds_read_b128 a[100:103], v2 offset:25600
v_mfma_f32_16x16x32_bf16 v[196:199], a[64:67], v[104:107], v[196:199]
s_cselect_b32 s14, 3221225472, s14
v_exp_f32 v15, v71
v_mfma_f32_16x16x32_bf16 v[200:203], a[72:75], v[96:99], v[200:203]
ds_read_b128 a[104:107], v2 offset:26624
v_add_f32 v27, v27, v15
v_mfma_f32_16x16x32_bf16 v[200:203], a[76:79], v[100:103], v[200:203]
v_exp_f32 v8, v72
v_mfma_f32_16x16x32_bf16 v[204:207], a[76:79], v[108:111], v[204:207]
ds_read_b128 a[108:111], v2 offset:27648
v_cvt_pk_bf16_f32 v121, v14, v15
v_mfma_f32_16x16x32_bf16 v[204:207], a[72:75], v[104:107], v[204:207]
s_waitcnt lgkmcnt(3)
v_exp_f32 v9, v73
v_mfma_f32_16x16x32_bf16 v[208:211], a[80:83], v[96:99], v[208:211]
ds_read_b128 a[112:115], v2 offset:28672
v_add_f32 v26, v26, v8
v_mfma_f32_16x16x32_bf16 v[208:211], a[84:87], v[100:103], v[208:211]
v_add_f32 v26, v26, v9
v_cvt_pk_bf16_f32 v114, v8, v9
v_mfma_f32_16x16x32_bf16 v[212:215], a[84:87], v[108:111], v[212:215]
ds_read_b128 a[116:119], v2 offset:29696
v_mfma_f32_16x16x32_bf16 v[212:215], a[80:83], v[104:107], v[212:215]
v_exp_f32 v10, v74
v_mfma_f32_16x16x32_bf16 v[216:219], a[88:91], v[96:99], v[216:219]
ds_read_b128 a[120:123], v2 offset:30720
v_add_f32 v26, v26, v10
v_mfma_f32_16x16x32_bf16 v[216:219], a[92:95], v[100:103], v[216:219]
v_exp_f32 v11, v75
v_mfma_f32_16x16x32_bf16 v[220:223], a[92:95], v[108:111], v[220:223]
s_waitcnt vmcnt(8)
ds_read_b128 a[124:127], v2 offset:31744
v_add_f32 v26, v26, v11
v_mfma_f32_16x16x32_bf16 v[220:223], a[88:91], v[104:107], v[220:223]
s_barrier
v_mfma_f32_16x16x32_bf16 v[224:227], a[96:99], v[96:99], v[224:227]
s_waitcnt lgkmcnt(3)
ds_read_b128 a[64:67], v1 offset:0
v_cvt_pk_bf16_f32 v115, v10, v11
v_mfma_f32_16x16x32_bf16 v[224:227], a[100:103], v[100:103], v[224:227]
v_exp_f32 v12, v76
v_mfma_f32_16x16x32_bf16 v[228:231], a[100:103], v[108:111], v[228:231]
ds_read_b128 a[68:71], v1 offset:1024
v_add_f32 v27, v27, v12
v_mfma_f32_16x16x32_bf16 v[228:231], a[96:99], v[104:107], v[228:231]
v_mfma_f32_16x16x32_bf16 v[232:235], a[104:107], v[96:99], v[232:235]
ds_read_b128 a[72:75], v1 offset:2048
v_mfma_f32_16x16x32_bf16 v[232:235], a[108:111], v[100:103], v[232:235]
v_exp_f32 v13, v77
v_mfma_f32_16x16x32_bf16 v[236:239], a[108:111], v[108:111], v[236:239]
ds_read_b128 a[76:79], v1 offset:3072
v_add_f32 v27, v27, v13
v_mfma_f32_16x16x32_bf16 v[236:239], a[104:107], v[104:107], v[236:239]
v_exp_f32 v14, v78
v_mfma_f32_16x16x32_bf16 v[240:243], a[112:115], v[96:99], v[240:243]
s_waitcnt lgkmcnt(3)
ds_read_b128 a[80:83], v1 offset:4096
v_cvt_pk_bf16_f32 v122, v12, v13
v_mfma_f32_16x16x32_bf16 v[240:243], a[116:119], v[100:103], v[240:243]
v_exp_f32 v15, v79
v_mfma_f32_16x16x32_bf16 v[244:247], a[116:119], v[108:111], v[244:247]
ds_read_b128 a[84:87], v1 offset:5120
v_add_f32 v27, v27, v14
v_mfma_f32_16x16x32_bf16 v[244:247], a[112:115], v[104:107], v[244:247]
v_add_f32 v27, v27, v15
v_cvt_pk_bf16_f32 v123, v14, v15
v_mfma_f32_16x16x32_bf16 v[248:251], a[120:123], v[96:99], v[248:251]
ds_read_b128 a[88:91], v1 offset:6144
v_mfma_f32_16x16x32_bf16 v[248:251], a[124:127], v[100:103], v[248:251]
v_mfma_f32_16x16x32_bf16 v[252:255], a[124:127], v[108:111], v[252:255]
ds_read_b128 a[92:95], v1 offset:7168
v_mfma_f32_16x16x32_bf16 v[252:255], a[120:123], v[104:107], v[252:255]
K2_x0:
v_mfma_f32_16x16x32_bf16 v[32:35], a[64:67], a[0:3], v[16:19]
s_waitcnt lgkmcnt(3)
s_add_u32 m0, s18, 131072
ds_read_b128 a[96:99], v1 offset:8192
v_mfma_f32_16x16x32_bf16 v[32:35], a[68:71], a[4:7], v[32:35]
buffer_load_dwordx4 v1, s[4:7], s8 offen offset:0 sc1 lds
v_mfma_f32_16x16x32_bf16 v[32:35], a[72:75], a[8:11], v[32:35]
ds_read_b128 a[100:103], v1 offset:9216
v_mfma_f32_16x16x32_bf16 v[32:35], a[76:79], a[12:15], v[32:35]
v_exp_f32 v8, v80
v_mfma_f32_16x16x32_bf16 v[32:35], a[80:83], a[16:19], v[32:35]
s_waitcnt lgkmcnt(3)
ds_read_b128 a[104:107], v1 offset:10240
v_add_f32 v26, v26, v8
v_mfma_f32_16x16x32_bf16 v[32:35], a[84:87], a[20:23], v[32:35]
buffer_load_dwordx4 v1, s[4:7], s8 offen offset:1024 sc1 lds
v_mfma_f32_16x16x32_bf16 v[32:35], a[88:91], a[24:27], v[32:35]
s_waitcnt lgkmcnt(3)
ds_read_b128 a[108:111], v1 offset:11264
v_mfma_f32_16x16x32_bf16 v[32:35], a[92:95], a[28:31], v[32:35]
v_exp_f32 v9, v81
v_mfma_f32_16x16x32_bf16 v[36:39], a[64:67], a[32:35], v[20:23]
ds_read_b128 a[112:115], v1 offset:12288
v_add_f32 v26, v26, v9
v_mfma_f32_16x16x32_bf16 v[36:39], a[68:71], a[36:39], v[36:39]
buffer_load_dwordx4 v1, s[4:7], s8 offen offset:2048 sc1 lds
v_mfma_f32_16x16x32_bf16 v[36:39], a[72:75], a[40:43], v[36:39]
ds_read_b128 a[116:119], v1 offset:13312
v_cvt_pk_bf16_f32 v116, v8, v9
v_mfma_f32_16x16x32_bf16 v[36:39], a[76:79], a[44:47], v[36:39]
v_exp_f32 v10, v82
v_mfma_f32_16x16x32_bf16 v[36:39], a[80:83], a[48:51], v[36:39]
ds_read_b128 a[120:123], v1 offset:14336
v_add_f32 v26, v26, v10
v_mfma_f32_16x16x32_bf16 v[36:39], a[84:87], a[52:55], v[36:39]
buffer_load_dwordx4 v1, s[4:7], s8 offen offset:3072 sc1 lds
v_mfma_f32_16x16x32_bf16 v[36:39], a[88:91], a[56:59], v[36:39]
s_add_u32 s8, s8, 4096
ds_read_b128 a[124:127], v1 offset:15360
v_mfma_f32_16x16x32_bf16 v[36:39], a[92:95], a[60:63], v[36:39]
s_waitcnt lgkmcnt(3)
v_exp_f32 v11, v83
v_mfma_f32_16x16x32_bf16 v[40:43], a[96:99], a[0:3], v[16:19]
s_add_u32 m0, s18, 135168
ds_read_b128 a[64:67], v1 offset:16384
v_add_f32 v26, v26, v11
v_mfma_f32_16x16x32_bf16 v[40:43], a[100:103], a[4:7], v[40:43]
buffer_load_dwordx4 v1, s[4:7], s8 offen offset:0 sc1 lds
v_mfma_f32_16x16x32_bf16 v[40:43], a[104:107], a[8:11], v[40:43]
ds_read_b128 a[68:71], v1 offset:17408
v_cvt_pk_bf16_f32 v117, v10, v11
v_mfma_f32_16x16x32_bf16 v[40:43], a[108:111], a[12:15], v[40:43]
v_mfma_f32_16x16x32_bf16 v[40:43], a[112:115], a[16:19], v[40:43]
s_waitcnt lgkmcnt(3)
ds_read_b128 a[72:75], v1 offset:18432
v_mfma_f32_16x16x32_bf16 v[40:43], a[116:119], a[20:23], v[40:43]
buffer_load_dwordx4 v1, s[4:7], s8 offen offset:1024 sc1 lds
v_mfma_f32_16x16x32_bf16 v[40:43], a[120:123], a[24:27], v[40:43]
s_waitcnt lgkmcnt(3)
ds_read_b128 a[76:79], v1 offset:19456
v_mfma_f32_16x16x32_bf16 v[40:43], a[124:127], a[28:31], v[40:43]
v_exp_f32 v12, v84
v_mfma_f32_16x16x32_bf16 v[44:47], a[96:99], a[32:35], v[20:23]
ds_read_b128 a[80:83], v1 offset:20480
v_add_f32 v27, v27, v12
v_mfma_f32_16x16x32_bf16 v[44:47], a[100:103], a[36:39], v[44:47]
buffer_load_dwordx4 v1, s[4:7], s8 offen offset:2048 sc1 lds
v_mfma_f32_16x16x32_bf16 v[44:47], a[104:107], a[40:43], v[44:47]
ds_read_b128 a[84:87], v1 offset:21504
v_mfma_f32_16x16x32_bf16 v[44:47], a[108:111], a[44:47], v[44:47]
v_exp_f32 v13, v85
v_mfma_f32_16x16x32_bf16 v[44:47], a[112:115], a[48:51], v[44:47]
ds_read_b128 a[88:91], v1 offset:22528
v_add_f32 v27, v27, v13
v_mfma_f32_16x16x32_bf16 v[44:47], a[116:119], a[52:55], v[44:47]
s_waitcnt lgkmcnt(3)
buffer_load_dwordx4 v1, s[4:7], s8 offen offset:3072 sc1 lds
v_mfma_f32_16x16x32_bf16 v[44:47], a[120:123], a[56:59], v[44:47]
s_add_u32 s8, s8, 28672
ds_read_b128 a[92:95], v1 offset:23552
v_cvt_pk_bf16_f32 v124, v12, v13
v_mfma_f32_16x16x32_bf16 v[44:47], a[124:127], a[60:63], v[44:47]
s_sub_u32 s9, s9, 1
v_exp_f32 v14, v86
v_mfma_f32_16x16x32_bf16 v[48:51], a[64:67], a[0:3], v[16:19]
s_cmp_eq_u32 s9, 0
ds_read_b128 a[96:99], v1 offset:24576
v_add_f32 v27, v27, v14
v_mfma_f32_16x16x32_bf16 v[48:51], a[68:71], a[4:7], v[48:51]
s_cselect_b32 s8, s10, s8
v_exp_f32 v15, v87
v_mfma_f32_16x16x32_bf16 v[48:51], a[72:75], a[8:11], v[48:51]
s_cselect_b32 s9, s11, s9
ds_read_b128 a[100:103], v1 offset:25600
v_add_f32 v27, v27, v15
v_mfma_f32_16x16x32_bf16 v[48:51], a[76:79], a[12:15], v[48:51]
s_waitcnt lgkmcnt(3)
s_cselect_b32 s10, 3221225472, s10
v_cvt_pk_bf16_f32 v125, v14, v15
v_mfma_f32_16x16x32_bf16 v[48:51], a[80:83], a[16:19], v[48:51]
ds_read_b128 a[104:107], v1 offset:26624
v_mfma_f32_16x16x32_bf16 v[48:51], a[84:87], a[20:23], v[48:51]
v_exp_f32 v8, v88
v_mfma_f32_16x16x32_bf16 v[48:51], a[88:91], a[24:27], v[48:51]
s_waitcnt lgkmcnt(3)
ds_read_b128 a[108:111], v1 offset:27648
v_add_f32 v26, v26, v8
v_mfma_f32_16x16x32_bf16 v[48:51], a[92:95], a[28:31], v[48:51]
v_exp_f32 v9, v89
v_mfma_f32_16x16x32_bf16 v[52:55], a[64:67], a[32:35], v[20:23]
ds_read_b128 a[112:115], v1 offset:28672
v_add_f32 v26, v26, v9
v_mfma_f32_16x16x32_bf16 v[52:55], a[68:71], a[36:39], v[52:55]
v_exp_f32 v10, v90
v_mfma_f32_16x16x32_bf16 v[52:55], a[72:75], a[40:43], v[52:55]
ds_read_b128 a[116:119], v1 offset:29696
v_cvt_pk_bf16_f32 v118, v8, v9
v_mfma_f32_16x16x32_bf16 v[52:55], a[76:79], a[44:47], v[52:55]
v_exp_f32 v11, v91
v_mfma_f32_16x16x32_bf16 v[52:55], a[80:83], a[48:51], v[52:55]
ds_read_b128 a[120:123], v1 offset:30720
v_add_f32 v26, v26, v10
v_mfma_f32_16x16x32_bf16 v[52:55], a[84:87], a[52:55], v[52:55]
v_add_f32 v26, v26, v11
v_cvt_pk_bf16_f32 v119, v10, v11
v_mfma_f32_16x16x32_bf16 v[52:55], a[88:91], a[56:59], v[52:55]
s_waitcnt vmcnt(8) lgkmcnt(3)
ds_read_b128 a[124:127], v1 offset:31744
v_mfma_f32_16x16x32_bf16 v[52:55], a[92:95], a[60:63], v[52:55]
s_barrier
v_mfma_f32_16x16x32_bf16 v[56:59], a[96:99], a[0:3], v[16:19]
ds_read_b128 a[64:67], v2 offset:32768
v_mfma_f32_16x16x32_bf16 v[56:59], a[100:103], a[4:7], v[56:59]
v_exp_f32 v12, v92
v_mfma_f32_16x16x32_bf16 v[56:59], a[104:107], a[8:11], v[56:59]
ds_read_b128 a[68:71], v2 offset:33792
v_add_f32 v27, v27, v12
v_mfma_f32_16x16x32_bf16 v[56:59], a[108:111], a[12:15], v[56:59]
s_waitcnt lgkmcnt(3)
v_exp_f32 v13, v93
v_mfma_f32_16x16x32_bf16 v[56:59], a[112:115], a[16:19], v[56:59]
ds_read_b128 a[72:75], v2 offset:34816
v_add_f32 v27, v27, v13
v_mfma_f32_16x16x32_bf16 v[56:59], a[116:119], a[20:23], v[56:59]
v_exp_f32 v14, v94
v_mfma_f32_16x16x32_bf16 v[56:59], a[120:123], a[24:27], v[56:59]
s_waitcnt lgkmcnt(3)
ds_read_b128 a[76:79], v2 offset:35840
v_cvt_pk_bf16_f32 v126, v12, v13
v_mfma_f32_16x16x32_bf16 v[56:59], a[124:127], a[28:31], v[56:59]
v_exp_f32 v15, v95
v_mfma_f32_16x16x32_bf16 v[60:63], a[96:99], a[32:35], v[20:23]
ds_read_b128 a[80:83], v2 offset:36864
v_add_f32 v27, v27, v14
v_mfma_f32_16x16x32_bf16 v[60:63], a[100:103], a[36:39], v[60:63]
v_add_f32 v27, v27, v15
v_cvt_pk_bf16_f32 v127, v14, v15
v_mfma_f32_16x16x32_bf16 v[60:63], a[104:107], a[40:43], v[60:63]
ds_read_b128 a[84:87], v2 offset:37888
v_add_f32 v28, v26, v27
v_mfma_f32_16x16x32_bf16 v[60:63], a[108:111], a[44:47], v[60:63]
v_cmp_nge_f32 vcc, s25, v28
v_mfma_f32_16x16x32_bf16 v[60:63], a[112:115], a[48:51], v[60:63]
ds_read_b128 a[88:91], v2 offset:38912
v_mfma_f32_16x16x32_bf16 v[60:63], a[116:119], a[52:55], v[60:63]
v_mfma_f32_16x16x32_bf16 v[60:63], a[120:123], a[56:59], v[60:63]
ds_read_b128 a[92:95], v2 offset:39936
v_mfma_f32_16x16x32_bf16 v[60:63], a[124:127], a[60:63], v[60:63]
s_waitcnt lgkmcnt(3)
s_cbranch_vccnz Lstub_2
Lback_3:
v_mfma_f32_16x16x32_bf16 v[128:131], a[64:67], v[112:115], v[128:131]
s_add_u32 m0, s18, 65536
ds_read_b128 a[96:99], v2 offset:40960
v_add_f32 v24, v24, v26
v_mfma_f32_16x16x32_bf16 v[128:131], a[68:71], v[116:119], v[128:131]
buffer_load_dwordx4 v1, s[4:7], s12 offen offset:0 sc1 lds
v_mfma_f32_16x16x32_bf16 v[132:135], a[68:71], v[124:127], v[132:135]
ds_read_b128 a[100:103], v2 offset:41984
v_add_f32 v25, v25, v27
v_mfma_f32_16x16x32_bf16 v[132:135], a[64:67], v[120:123], v[132:135]
v_exp_f32 v8, v32
v_mfma_f32_16x16x32_bf16 v[136:139], a[72:75], v[112:115], v[136:139]
ds_read_b128 a[104:107], v2 offset:43008
v_mfma_f32_16x16x32_bf16 v[136:139], a[76:79], v[116:119], v[136:139]
buffer_load_dwordx4 v1, s[4:7], s12 offen offset:1024 sc1 lds
v_mfma_f32_16x16x32_bf16 v[140:143], a[76:79], v[124:127], v[140:143]
ds_read_b128 a[108:111], v2 offset:44032
v_mfma_f32_16x16x32_bf16 v[140:143], a[72:75], v[120:123], v[140:143]
v_exp_f32 v9, v33
v_mfma_f32_16x16x32_bf16 v[144:147], a[80:83], v[112:115], v[144:147]
s_waitcnt lgkmcnt(3)
ds_read_b128 a[112:115], v2 offset:45056
v_add_f32 v26, v8, v9
v_mfma_f32_16x16x32_bf16 v[144:147], a[84:87], v[116:119], v[144:147]
buffer_load_dwordx4 v1, s[4:7], s12 offen offset:2048 sc1 lds
v_mfma_f32_16x16x32_bf16 v[148:151], a[84:87], v[124:127], v[148:151]
ds_read_b128 a[116:119], v2 offset:46080
v_cvt_pk_bf16_f32 v96, v8, v9
v_mfma_f32_16x16x32_bf16 v[148:151], a[80:83], v[120:123], v[148:151]
v_exp_f32 v10, v34
v_mfma_f32_16x16x32_bf16 v[152:155], a[88:91], v[112:115], v[152:155]
ds_read_b128 a[120:123], v2 offset:47104
v_add_f32 v26, v26, v10
v_mfma_f32_16x16x32_bf16 v[152:155], a[92:95], v[116:119], v[152:155]
buffer_load_dwordx4 v1, s[4:7], s12 offen offset:3072 sc1 lds
v_mfma_f32_16x16x32_bf16 v[156:159], a[92:95], v[124:127], v[156:159]
s_add_u32 s12, s12, 4096
ds_read_b128 a[124:127], v2 offset:48128
v_mfma_f32_16x16x32_bf16 v[156:159], a[88:91], v[120:123], v[156:159]
s_waitcnt lgkmcnt(3)
v_exp_f32 v11, v35
v_mfma_f32_16x16x32_bf16 v[160:163], a[96:99], v[112:115], v[160:163]
s_add_u32 m0, s18, 69632
ds_read_b128 a[64:67], v2 offset:49152
v_add_f32 v26, v26, v11
v_mfma_f32_16x16x32_bf16 v[160:163], a[100:103], v[116:119], v[160:163]
buffer_load_dwordx4 v1, s[4:7], s12 offen offset:0 sc1 lds
v_mfma_f32_16x16x32_bf16 v[164:167], a[100:103], v[124:127], v[164:167]
ds_read_b128 a[68:71], v2 offset:50176
v_cvt_pk_bf16_f32 v97, v10, v11
v_mfma_f32_16x16x32_bf16 v[164:167], a[96:99], v[120:123], v[164:167]
v_mfma_f32_16x16x32_bf16 v[168:171], a[104:107], v[112:115], v[168:171]
ds_read_b128 a[72:75], v2 offset:51200
v_mfma_f32_16x16x32_bf16 v[168:171], a[108:111], v[116:119], v[168:171]
buffer_load_dwordx4 v1, s[4:7], s12 offen offset:1024 sc1 lds
v_mfma_f32_16x16x32_bf16 v[172:175], a[108:111], v[124:127], v[172:175]
ds_read_b128 a[76:79], v2 offset:52224
v_mfma_f32_16x16x32_bf16 v[172:175], a[104:107], v[120:123], v[172:175]
v_exp_f32 v12, v36
v_mfma_f32_16x16x32_bf16 v[176:179], a[112:115], v[112:115], v[176:179]
s_waitcnt lgkmcnt(3)
ds_read_b128 a[80:83], v2 offset:53248
v_mfma_f32_16x16x32_bf16 v[176:179], a[116:119], v[116:119], v[176:179]
buffer_load_dwordx4 v1, s[4:7], s12 offen offset:2048 sc1 lds
v_mfma_f32_16x16x32_bf16 v[180:183], a[116:119], v[124:127], v[180:183]
ds_read_b128 a[84:87], v2 offset:54272
v_mfma_f32_16x16x32_bf16 v[180:183], a[112:115], v[120:123], v[180:183]
v_exp_f32 v13, v37
v_mfma_f32_16x16x32_bf16 v[184:187], a[120:123], v[112:115], v[184:187]
ds_read_b128 a[88:91], v2 offset:55296
v_add_f32 v27, v12, v13
v_mfma_f32_16x16x32_bf16 v[184:187], a[124:127], v[116:119], v[184:187]
s_waitcnt lgkmcnt(3)
buffer_load_dwordx4 v1, s[4:7], s12 offen offset:3072 sc1 lds
v_mfma_f32_16x16x32_bf16 v[188:191], a[124:127], v[124:127], v[188:191]
s_add_u32 s12, s12, 28672
ds_read_b128 a[92:95], v2 offset:56320
v_cvt_pk_bf16_f32 v104, v12, v13
v_mfma_f32_16x16x32_bf16 v[188:191], a[120:123], v[120:123], v[188:191]
s_sub_u32 s13, s13, 1
v_exp_f32 v14, v38
v_mfma_f32_16x16x32_bf16 v[192:195], a[64:67], v[112:115], v[192:195]
s_cmp_eq_u32 s13, 0
ds_read_b128 a[96:99], v2 offset:57344
v_add_f32 v27, v27, v14
v_mfma_f32_16x16x32_bf16 v[192:195], a[68:71], v[116:119], v[192:195]
s_cselect_b32 s12, s14, s12
v_mfma_f32_16x16x32_bf16 v[196:199], a[68:71], v[124:127], v[196:199]
s_cselect_b32 s13, s15, s13
ds_read_b128 a[100:103], v2 offset:58368
v_mfma_f32_16x16x32_bf16 v[196:199], a[64:67], v[120:123], v[196:199]
s_cselect_b32 s14, 3221225472, s14
v_exp_f32 v15, v39
v_mfma_f32_16x16x32_bf16 v[200:203], a[72:75], v[112:115], v[200:203]
ds_read_b128 a[104:107], v2 offset:59392
v_add_f32 v27, v27, v15
v_mfma_f32_16x16x32_bf16 v[200:203], a[76:79], v[116:119], v[200:203]
v_exp_f32 v8, v40
v_mfma_f32_16x16x32_bf16 v[204:207], a[76:79], v[124:127], v[204:207]
ds_read_b128 a[108:111], v2 offset:60416
v_cvt_pk_bf16_f32 v105, v14, v15
v_mfma_f32_16x16x32_bf16 v[204:207], a[72:75], v[120:123], v[204:207]
s_waitcnt lgkmcnt(3)
v_exp_f32 v9, v41
v_mfma_f32_16x16x32_bf16 v[208:211], a[80:83], v[112:115], v[208:211]
ds_read_b128 a[112:115], v2 offset:61440
v_add_f32 v26, v26, v8
v_mfma_f32_16x16x32_bf16 v[208:211], a[84:87], v[116:119], v[208:211]
v_add_f32 v26, v26, v9
v_cvt_pk_bf16_f32 v98, v8, v9
v_mfma_f32_16x16x32_bf16 v[212:215], a[84:87], v[124:127], v[212:215]
ds_read_b128 a[116:119], v2 offset:62464
v_mfma_f32_16x16x32_bf16 v[212:215], a[80:83], v[120:123], v[212:215]
v_exp_f32 v10, v42
v_mfma_f32_16x16x32_bf16 v[216:219], a[88:91], v[112:115], v[216:219]
ds_read_b128 a[120:123], v2 offset:63488
v_add_f32 v26, v26, v10
v_mfma_f32_16x16x32_bf16 v[216:219], a[92:95], v[116:119], v[216:219]
v_exp_f32 v11, v43
v_mfma_f32_16x16x32_bf16 v[220:223], a[92:95], v[124:127], v[220:223]
s_waitcnt vmcnt(8)
ds_read_b128 a[124:127], v2 offset:64512
v_add_f32 v26, v26, v11
v_mfma_f32_16x16x32_bf16 v[220:223], a[88:91], v[120:123], v[220:223]
s_barrier
v_mfma_f32_16x16x32_bf16 v[224:227], a[96:99], v[112:115], v[224:227]
s_waitcnt lgkmcnt(3)
ds_read_b128 a[64:67], v4 offset:0
v_cvt_pk_bf16_f32 v99, v10, v11
v_mfma_f32_16x16x32_bf16 v[224:227], a[100:103], v[116:119], v[224:227]
v_exp_f32 v12, v44
v_mfma_f32_16x16x32_bf16 v[228:231], a[100:103], v[124:127], v[228:231]
ds_read_b128 a[68:71], v4 offset:1024
v_add_f32 v27, v27, v12
v_mfma_f32_16x16x32_bf16 v[228:231], a[96:99], v[120:123], v[228:231]
v_mfma_f32_16x16x32_bf16 v[232:235], a[104:107], v[112:115], v[232:235]
ds_read_b128 a[72:75], v4 offset:2048
v_mfma_f32_16x16x32_bf16 v[232:235], a[108:111], v[116:119], v[232:235]
v_exp_f32 v13, v45
v_mfma_f32_16x16x32_bf16 v[236:239], a[108:111], v[124:127], v[236:239]
ds_read_b128 a[76:79], v4 offset:3072
v_add_f32 v27, v27, v13
v_mfma_f32_16x16x32_bf16 v[236:239], a[104:107], v[120:123], v[236:239]
v_exp_f32 v14, v46
v_mfma_f32_16x16x32_bf16 v[240:243], a[112:115], v[112:115], v[240:243]
s_waitcnt lgkmcnt(3)
ds_read_b128 a[80:83], v4 offset:4096
v_cvt_pk_bf16_f32 v106, v12, v13
v_mfma_f32_16x16x32_bf16 v[240:243], a[116:119], v[116:119], v[240:243]
v_exp_f32 v15, v47
v_mfma_f32_16x16x32_bf16 v[244:247], a[116:119], v[124:127], v[244:247]
ds_read_b128 a[84:87], v4 offset:5120
v_add_f32 v27, v27, v14
v_mfma_f32_16x16x32_bf16 v[244:247], a[112:115], v[120:123], v[244:247]
v_add_f32 v27, v27, v15
v_cvt_pk_bf16_f32 v107, v14, v15
v_mfma_f32_16x16x32_bf16 v[248:251], a[120:123], v[112:115], v[248:251]
ds_read_b128 a[88:91], v4 offset:6144
v_mfma_f32_16x16x32_bf16 v[248:251], a[124:127], v[116:119], v[248:251]
v_mfma_f32_16x16x32_bf16 v[252:255], a[124:127], v[124:127], v[252:255]
s_waitcnt lgkmcnt(5)
ds_read_b128 a[92:95], v4 offset:7168
v_mfma_f32_16x16x32_bf16 v[252:255], a[120:123], v[120:123], v[252:255]
s_branch K2_x1
K2_xexit:
s_cbranch_vccnz Lstub_4
Lback_5:
s_cmp_lg_u32 s19, 0
s_cbranch_scc1 K2_loop
s_cmp_eq_u32 s24, 2
s_cbranch_scc1 K2_ntail
v_mfma_f32_16x16x32_bf16 v[128:131], a[64:67], v[96:99], v[128:131]
s_add_u32 m0, s18, 98304
ds_read_b128 a[96:99], v2 offset:8192
v_add_f32 v24, v24, v26
v_mfma_f32_16x16x32_bf16 v[128:131], a[68:71], v[100:103], v[128:131]
buffer_load_dwordx4 v1, s[4:7], s12 offen offset:0 sc1 lds
v_mfma_f32_16x16x32_bf16 v[132:135], a[68:71], v[108:111], v[132:135]
ds_read_b128 a[100:103], v2 offset:9216
v_add_f32 v25, v25, v27
v_mfma_f32_16x16x32_bf16 v[132:135], a[64:67], v[104:107], v[132:135]
v_exp_f32 v8, v64
v_mfma_f32_16x16x32_bf16 v[136:139], a[72:75], v[96:99], v[136:139]
ds_read_b128 a[104:107], v2 offset:10240
v_mfma_f32_16x16x32_bf16 v[136:139], a[76:79], v[100:103], v[136:139]
buffer_load_dwordx4 v1, s[4:7], s12 offen offset:1024 sc1 lds
v_mfma_f32_16x16x32_bf16 v[140:143], a[76:79], v[108:111], v[140:143]
ds_read_b128 a[108:111], v2 offset:11264
v_mfma_f32_16x16x32_bf16 v[140:143], a[72:75], v[104:107], v[140:143]
v_exp_f32 v9, v65
v_mfma_f32_16x16x32_bf16 v[144:147], a[80:83], v[96:99], v[144:147]
s_waitcnt lgkmcnt(3)
ds_read_b128 a[112:115], v2 offset:12288
v_add_f32 v26, v8, v9
v_mfma_f32_16x16x32_bf16 v[144:147], a[84:87], v[100:103], v[144:147]
buffer_load_dwordx4 v1, s[4:7], s12 offen offset:2048 sc1 lds
v_mfma_f32_16x16x32_bf16 v[148:151], a[84:87], v[108:111], v[148:151]
ds_read_b128 a[116:119], v2 offset:13312
v_cvt_pk_bf16_f32 v112, v8, v9
v_mfma_f32_16x16x32_bf16 v[148:151], a[80:83], v[104:107], v[148:151]
v_exp_f32 v10, v66
v_mfma_f32_16x16x32_bf16 v[152:155], a[88:91], v[96:99], v[152:155]
ds_read_b128 a[120:123], v2 offset:14336
v_add_f32 v26, v26, v10
v_mfma_f32_16x16x32_bf16 v[152:155], a[92:95], v[100:103], v[152:155]
buffer_load_dwordx4 v1, s[4:7], s12 offen offset:3072 sc1 lds
v_mfma_f32_16x16x32_bf16 v[156:159], a[92:95], v[108:111], v[156:159]
s_add_u32 s12, s12, 4096
ds_read_b128 a[124:127], v2 offset:15360
v_mfma_f32_16x16x32_bf16 v[156:159], a[88:91], v[104:107], v[156:159]
s_waitcnt lgkmcnt(3)
v_exp_f32 v11, v67
v_mfma_f32_16x16x32_bf16 v[160:163], a[96:99], v[96:99], v[160:163]
s_add_u32 m0, s18, 102400
ds_read_b128 a[64:67], v2 offset:16384
v_add_f32 v26, v26, v11
v_mfma_f32_16x16x32_bf16 v[160:163], a[100:103], v[100:103], v[160:163]
buffer_load_dwordx4 v1, s[4:7], s12 offen offset:0 sc1 lds
v_mfma_f32_16x16x32_bf16 v[164:167], a[100:103], v[108:111], v[164:167]
ds_read_b128 a[68:71], v2 offset:17408
v_cvt_pk_bf16_f32 v113, v10, v11
v_mfma_f32_16x16x32_bf16 v[164:167], a[96:99], v[104:107], v[164:167]
v_mfma_f32_16x16x32_bf16 v[168:171], a[104:107], v[96:99], v[168:171]
ds_read_b128 a[72:75], v2 offset:18432
v_mfma_f32_16x16x32_bf16 v[168:171], a[108:111], v[100:103], v[168:171]
buffer_load_dwordx4 v1, s[4:7], s12 offen offset:1024 sc1 lds
v_mfma_f32_16x16x32_bf16 v[172:175], a[108:111], v[108:111], v[172:175]
ds_read_b128 a[76:79], v2 offset:19456
v_mfma_f32_16x16x32_bf16 v[172:175], a[104:107], v[104:107], v[172:175]
v_exp_f32 v12, v68
v_mfma_f32_16x16x32_bf16 v[176:179], a[112:115], v[96:99], v[176:179]
s_waitcnt lgkmcnt(3)
ds_read_b128 a[80:83], v2 offset:20480
v_mfma_f32_16x16x32_bf16 v[176:179], a[116:119], v[100:103], v[176:179]
buffer_load_dwordx4 v1, s[4:7], s12 offen offset:2048 sc1 lds
v_mfma_f32_16x16x32_bf16 v[180:183], a[116:119], v[108:111], v[180:183]
ds_read_b128 a[84:87], v2 offset:21504
v_mfma_f32_16x16x32_bf16 v[180:183], a[112:115], v[104:107], v[180:183]
v_exp_f32 v13, v69
v_mfma_f32_16x16x32_bf16 v[184:187], a[120:123], v[96:99], v[184:187]
ds_read_b128 a[88:91], v2 offset:22528
v_add_f32 v27, v12, v13
v_mfma_f32_16x16x32_bf16 v[184:187], a[124:127], v[100:103], v[184:187]
s_waitcnt lgkmcnt(3)
buffer_load_dwordx4 v1, s[4:7], s12 offen offset:3072 sc1 lds
v_mfma_f32_16x16x32_bf16 v[188:191], a[124:127], v[108:111], v[188:191]
s_add_u32 s12, s12, 28672
ds_read_b128 a[92:95], v2 offset:23552
v_cvt_pk_bf16_f32 v120, v12, v13
v_mfma_f32_16x16x32_bf16 v[188:191], a[120:123], v[104:107], v[188:191]
s_sub_u32 s13, s13, 1
v_exp_f32 v14, v70
v_mfma_f32_16x16x32_bf16 v[192:195], a[64:67], v[96:99], v[192:195]
s_cmp_eq_u32 s13, 0
ds_read_b128 a[96:99], v2 offset:24576
v_add_f32 v27, v27, v14
v_mfma_f32_16x16x32_bf16 v[192:195], a[68:71], v[100:103], v[192:195]
s_cselect_b32 s12, s14, s12
v_mfma_f32_16x16x32_bf16 v[196:199], a[68:71], v[108:111], v[196:199]
s_cselect_b32 s13, s15, s13
ds_read_b128 a[100:103], v2 offset:25600
v_mfma_f32_16x16x32_bf16 v[196:199], a[64:67], v[104:107], v[196:199]
s_cselect_b32 s14, 3221225472, s14
v_exp_f32 v15, v71
v_mfma_f32_16x16x32_bf16 v[200:203], a[72:75], v[96:99], v[200:203]
ds_read_b128 a[104:107], v2 offset:26624
v_add_f32 v27, v27, v15
v_mfma_f32_16x16x32_bf16 v[200:203], a[76:79], v[100:103], v[200:203]
v_exp_f32 v8, v72
v_mfma_f32_16x16x32_bf16 v[204:207], a[76:79], v[108:111], v[204:207]
ds_read_b128 a[108:111], v2 offset:27648
v_cvt_pk_bf16_f32 v121, v14, v15
v_mfma_f32_16x16x32_bf16 v[204:207], a[72:75], v[104:107], v[204:207]
s_waitcnt lgkmcnt(3)
v_exp_f32 v9, v73
v_mfma_f32_16x16x32_bf16 v[208:211], a[80:83], v[96:99], v[208:211]
ds_read_b128 a[112:115], v2 offset:28672
v_add_f32 v26, v26, v8
v_mfma_f32_16x16x32_bf16 v[208:211], a[84:87], v[100:103], v[208:211]
v_add_f32 v26, v26, v9
v_cvt_pk_bf16_f32 v114, v8, v9
v_mfma_f32_16x16x32_bf16 v[212:215], a[84:87], v[108:111], v[212:215]
ds_read_b128 a[116:119], v2 offset:29696
v_mfma_f32_16x16x32_bf16 v[212:215], a[80:83], v[104:107], v[212:215]
v_exp_f32 v10, v74
v_mfma_f32_16x16x32_bf16 v[216:219], a[88:91], v[96:99], v[216:219]
ds_read_b128 a[120:123], v2 offset:30720
v_add_f32 v26, v26, v10
v_mfma_f32_16x16x32_bf16 v[216:219], a[92:95], v[100:103], v[216:219]
v_exp_f32 v11, v75
v_mfma_f32_16x16x32_bf16 v[220:223], a[92:95], v[108:111], v[220:223]
s_waitcnt vmcnt(8)
ds_read_b128 a[124:127], v2 offset:31744
v_add_f32 v26, v26, v11
v_mfma_f32_16x16x32_bf16 v[220:223], a[88:91], v[104:107], v[220:223]
s_barrier
v_mfma_f32_16x16x32_bf16 v[224:227], a[96:99], v[96:99], v[224:227]
s_waitcnt lgkmcnt(3)
ds_read_b128 a[64:67], v1 offset:0
v_cvt_pk_bf16_f32 v115, v10, v11
v_mfma_f32_16x16x32_bf16 v[224:227], a[100:103], v[100:103], v[224:227]
v_exp_f32 v12, v76
v_mfma_f32_16x16x32_bf16 v[228:231], a[100:103], v[108:111], v[228:231]
ds_read_b128 a[68:71], v1 offset:1024
v_add_f32 v27, v27, v12
v_mfma_f32_16x16x32_bf16 v[228:231], a[96:99], v[104:107], v[228:231]
PAD_11:
s_cbranch_execz M_tret
v_mfma_f32_16x16x32_bf16 v[232:235], a[104:107], v[96:99], v[232:235]
ds_read_b128 a[72:75], v1 offset:2048
v_mfma_f32_16x16x32_bf16 v[232:235], a[108:111], v[100:103], v[232:235]
v_exp_f32 v13, v77
v_mfma_f32_16x16x32_bf16 v[236:239], a[108:111], v[108:111], v[236:239]
ds_read_b128 a[76:79], v1 offset:3072
v_add_f32 v27, v27, v13
v_mfma_f32_16x16x32_bf16 v[236:239], a[104:107], v[104:107], v[236:239]
v_exp_f32 v14, v78
v_mfma_f32_16x16x32_bf16 v[240:243], a[112:115], v[96:99], v[240:243]
s_waitcnt lgkmcnt(3)
ds_read_b128 a[80:83], v1 offset:4096
v_cvt_pk_bf16_f32 v122, v12, v13
v_mfma_f32_16x16x32_bf16 v[240:243], a[116:119], v[100:103], v[240:243]
v_exp_f32 v15, v79
v_mfma_f32_16x16x32_bf16 v[244:247], a[116:119], v[108:111], v[244:247]
ds_read_b128 a[84:87], v1 offset:5120
v_add_f32 v27, v27, v14
v_mfma_f32_16x16x32_bf16 v[244:247], a[112:115], v[104:107], v[244:247]
v_add_f32 v27, v27, v15
v_cvt_pk_bf16_f32 v123, v14, v15
v_mfma_f32_16x16x32_bf16 v[248:251], a[120:123], v[96:99], v[248:251]
ds_read_b128 a[88:91], v1 offset:6144
v_mfma_f32_16x16x32_bf16 v[248:251], a[124:127], v[100:103], v[248:251]
v_mfma_f32_16x16x32_bf16 v[252:255], a[124:127], v[108:111], v[252:255]
ds_read_b128 a[92:95], v1 offset:7168
v_mfma_f32_16x16x32_bf16 v[252:255], a[120:123], v[104:107], v[252:255]
s_waitcnt lgkmcnt(3)
v_cndmask_b32 v32, v16, v7, s[32:33]
v_cndmask_b32 v33, v16, v7, s[34:35]
v_cndmask_b32 v34, v16, v7, s[36:37]
v_cndmask_b32 v35, v16, v7, s[38:39]
s_nop 1
v_mfma_f32_16x16x32_bf16 v[32:35], a[64:67], a[0:3], v[32:35]
s_add_u32 m0, s18, 131072
ds_read_b128 a[96:99], v1 offset:8192
v_cndmask_b32 v40, v16, v7, s[40:41]
v_mfma_f32_16x16x32_bf16 v[32:35], a[68:71], a[4:7], v[32:35]
buffer_load_dwordx4 v1, s[4:7], s8 offen offset:0 sc1 lds
v_mfma_f32_16x16x32_bf16 v[32:35], a[72:75], a[8:11], v[32:35]
ds_read_b128 a[100:103], v1 offset:9216
v_cndmask_b32 v41, v16, v7, s[42:43]
v_mfma_f32_16x16x32_bf16 v[32:35], a[76:79], a[12:15], v[32:35]
v_cndmask_b32 v42, v16, v7, s[44:45]
v_cndmask_b32 v43, v16, v7, s[46:47]
v_mfma_f32_16x16x32_bf16 v[32:35], a[80:83], a[16:19], v[32:35]
s_waitcnt lgkmcnt(3)
ds_read_b128 a[104:107], v1 offset:10240
v_mfma_f32_16x16x32_bf16 v[32:35], a[84:87], a[20:23], v[32:35]
buffer_load_dwordx4 v1, s[4:7], s8 offen offset:1024 sc1 lds
v_mfma_f32_16x16x32_bf16 v[32:35], a[88:91], a[24:27], v[32:35]
s_waitcnt lgkmcnt(3)
ds_read_b128 a[108:111], v1 offset:11264
v_mfma_f32_16x16x32_bf16 v[32:35], a[92:95], a[28:31], v[32:35]
v_exp_f32 v8, v80
v_mfma_f32_16x16x32_bf16 v[36:39], a[64:67], a[32:35], v[20:23]
ds_read_b128 a[112:115], v1 offset:12288
v_add_f32 v26, v26, v8
v_mfma_f32_16x16x32_bf16 v[36:39], a[68:71], a[36:39], v[36:39]
buffer_load_dwordx4 v1, s[4:7], s8 offen offset:2048 sc1 lds
v_mfma_f32_16x16x32_bf16 v[36:39], a[72:75], a[40:43], v[36:39]
ds_read_b128 a[116:119], v1 offset:13312
v_mfma_f32_16x16x32_bf16 v[36:39], a[76:79], a[44:47], v[36:39]
v_exp_f32 v9, v81
v_mfma_f32_16x16x32_bf16 v[36:39], a[80:83], a[48:51], v[36:39]
ds_read_b128 a[120:123], v1 offset:14336
v_add_f32 v26, v26, v9
v_mfma_f32_16x16x32_bf16 v[36:39], a[84:87], a[52:55], v[36:39]
buffer_load_dwordx4 v1, s[4:7], s8 offen offset:3072 sc1 lds
v_mfma_f32_16x16x32_bf16 v[36:39], a[88:91], a[56:59], v[36:39]
s_add_u32 s8, s8, 4096
ds_read_b128 a[124:127], v1 offset:15360
v_cvt_pk_bf16_f32 v116, v8, v9
v_mfma_f32_16x16x32_bf16 v[36:39], a[92:95], a[60:63], v[36:39]
s_waitcnt lgkmcnt(3)
v_exp_f32 v10, v82
v_mfma_f32_16x16x32_bf16 v[40:43], a[96:99], a[0:3], v[40:43]
s_add_u32 m0, s18, 135168
ds_read_b128 a[64:67], v1 offset:16384
v_cndmask_b32 v48, v16, v7, s[48:49]
v_mfma_f32_16x16x32_bf16 v[40:43], a[100:103], a[4:7], v[40:43]
buffer_load_dwordx4 v1, s[4:7], s8 offen offset:0 sc1 lds
v_mfma_f32_16x16x32_bf16 v[40:43], a[104:107], a[8:11], v[40:43]
ds_read_b128 a[68:71], v1 offset:17408
v_cndmask_b32 v49, v16, v7, s[50:51]
v_mfma_f32_16x16x32_bf16 v[40:43], a[108:111], a[12:15], v[40:43]
v_cndmask_b32 v50, v16, v7, s[52:53]
v_cndmask_b32 v51, v16, v7, s[54:55]
v_mfma_f32_16x16x32_bf16 v[40:43], a[112:115], a[16:19], v[40:43]
s_waitcnt lgkmcnt(3)
ds_read_b128 a[72:75], v1 offset:18432
v_add_f32 v26, v26, v10
v_mfma_f32_16x16x32_bf16 v[40:43], a[116:119], a[20:23], v[40:43]
buffer_load_dwordx4 v1, s[4:7], s8 offen offset:1024 sc1 lds
v_mfma_f32_16x16x32_bf16 v[40:43], a[120:123], a[24:27], v[40:43]
s_waitcnt lgkmcnt(3)
ds_read_b128 a[76:79], v1 offset:19456
v_mfma_f32_16x16x32_bf16 v[40:43], a[124:127], a[28:31], v[40:43]
v_exp_f32 v11, v83
v_mfma_f32_16x16x32_bf16 v[44:47], a[96:99], a[32:35], v[20:23]
ds_read_b128 a[80:83], v1 offset:20480
v_add_f32 v26, v26, v11
v_mfma_f32_16x16x32_bf16 v[44:47], a[100:103], a[36:39], v[44:47]
buffer_load_dwordx4 v1, s[4:7], s8 offen offset:2048 sc1 lds
v_mfma_f32_16x16x32_bf16 v[44:47], a[104:107], a[40:43], v[44:47]
ds_read_b128 a[84:87], v1 offset:21504
v_cvt_pk_bf16_f32 v117, v10, v11
v_mfma_f32_16x16x32_bf16 v[44:47], a[108:111], a[44:47], v[44:47]
v_exp_f32 v12, v84
v_mfma_f32_16x16x32_bf16 v[44:47], a[112:115], a[48:51], v[44:47]
ds_read_b128 a[88:91], v1 offset:22528
v_add_f32 v27, v27, v12
v_mfma_f32_16x16x32_bf16 v[44:47], a[116:119], a[52:55], v[44:47]
buffer_load_dwordx4 v1, s[4:7], s8 offen offset:3072 sc1 lds
v_mfma_f32_16x16x32_bf16 v[44:47], a[120:123], a[56:59], v[44:47]
s_waitcnt lgkmcnt(2)
s_add_u32 s8, s8, 28672
ds_read_b128 a[92:95], v1 offset:23552
v_mfma_f32_16x16x32_bf16 v[44:47], a[124:127], a[60:63], v[44:47]
s_sub_u32 s9, s9, 1
v_exp_f32 v13, v85
v_mfma_f32_16x16x32_bf16 v[48:51], a[64:67], a[0:3], v[48:51]
s_cmp_eq_u32 s9, 0
ds_read_b128 a[96:99], v1 offset:24576
v_cndmask_b32 v56, v16, v7, s[56:57]
v_mfma_f32_16x16x32_bf16 v[48:51], a[68:71], a[4:7], v[48:51]
s_cselect_b32 s8, s10, s8
v_cndmask_b32 v57, v16, v7, s[58:59]
v_cndmask_b32 v58, v16, v7, s[60:61]
v_mfma_f32_16x16x32_bf16 v[48:51], a[72:75], a[8:11], v[48:51]
s_cselect_b32 s9, s11, s9
ds_read_b128 a[100:103], v1 offset:25600
v_cndmask_b32 v59, v16, v7, s[62:63]
v_mfma_f32_16x16x32_bf16 v[48:51], a[76:79], a[12:15], v[48:51]
s_cselect_b32 s10, 3221225472, s10
v_exp_f32 v14, v86
v_mfma_f32_16x16x32_bf16 v[48:51], a[80:83], a[16:19], v[48:51]
s_waitcnt lgkmcnt(3)
ds_read_b128 a[104:107], v1 offset:26624
v_add_f32 v27, v27, v13
v_cvt_pk_bf16_f32 v124, v12, v13
v_mfma_f32_16x16x32_bf16 v[48:51], a[84:87], a[20:23], v[48:51]
v_exp_f32 v15, v87
v_mfma_f32_16x16x32_bf16 v[48:51], a[88:91], a[24:27], v[48:51]
s_waitcnt lgkmcnt(3)
ds_read_b128 a[108:111], v1 offset:27648
v_add_f32 v27, v27, v14
v_mfma_f32_16x16x32_bf16 v[48:51], a[92:95], a[28:31], v[48:51]
v_exp_f32 v8, v88
v_mfma_f32_16x16x32_bf16 v[52:55], a[64:67], a[32:35], v[20:23]
ds_read_b128 a[112:115], v1 offset:28672
v_add_f32 v27, v27, v15
v_mfma_f32_16x16x32_bf16 v[52:55], a[68:71], a[36:39], v[52:55]
v_exp_f32 v9, v89
v_mfma_f32_16x16x32_bf16 v[52:55], a[72:75], a[40:43], v[52:55]
ds_read_b128 a[116:119], v1 offset:29696
v_cvt_pk_bf16_f32 v125, v14, v15
v_mfma_f32_16x16x32_bf16 v[52:55], a[76:79], a[44:47], v[52:55]
v_exp_f32 v10, v90
v_mfma_f32_16x16x32_bf16 v[52:55], a[80:83], a[48:51], v[52:55]
ds_read_b128 a[120:123], v1 offset:30720
v_add_f32 v26, v26, v8
v_mfma_f32_16x16x32_bf16 v[52:55], a[84:87], a[52:55], v[52:55]
v_exp_f32 v11, v91
v_mfma_f32_16x16x32_bf16 v[52:55], a[88:91], a[56:59], v[52:55]
s_waitcnt vmcnt(8) lgkmcnt(3)
ds_read_b128 a[124:127], v1 offset:31744
v_add_f32 v26, v26, v9
v_cvt_pk_bf16_f32 v118, v8, v9
v_mfma_f32_16x16x32_bf16 v[52:55], a[92:95], a[60:63], v[52:55]
s_barrier
v_mfma_f32_16x16x32_bf16 v[56:59], a[96:99], a[0:3], v[56:59]
ds_read_b128 a[64:67], v2 offset:32768
v_add_f32 v26, v26, v10
v_mfma_f32_16x16x32_bf16 v[56:59], a[100:103], a[4:7], v[56:59]
v_exp_f32 v12, v92
v_mfma_f32_16x16x32_bf16 v[56:59], a[104:107], a[8:11], v[56:59]
ds_read_b128 a[68:71], v2 offset:33792
v_add_f32 v26, v26, v11
v_cvt_pk_bf16_f32 v119, v10, v11
v_mfma_f32_16x16x32_bf16 v[56:59], a[108:111], a[12:15], v[56:59]
s_waitcnt lgkmcnt(3)
v_exp_f32 v13, v93
v_mfma_f32_16x16x32_bf16 v[56:59], a[112:115], a[16:19], v[56:59]
ds_read_b128 a[72:75], v2 offset:34816
v_add_f32 v27, v27, v12
v_mfma_f32_16x16x32_bf16 v[56:59], a[116:119], a[20:23], v[56:59]
v_exp_f32 v14, v94
v_mfma_f32_16x16x32_bf16 v[56:59], a[120:123], a[24:27], v[56:59]
s_waitcnt lgkmcnt(3)
ds_read_b128 a[76:79], v2 offset:35840
v_add_f32 v27, v27, v13
v_mfma_f32_16x16x32_bf16 v[56:59], a[124:127], a[28:31], v[56:59]
v_exp_f32 v15, v95
v_mfma_f32_16x16x32_bf16 v[60:63], a[96:99], a[32:35], v[20:23]
ds_read_b128 a[80:83], v2 offset:36864
v_cvt_pk_bf16_f32 v126, v12, v13
v_mfma_f32_16x16x32_bf16 v[60:63], a[100:103], a[36:39], v[60:63]
v_add_f32 v27, v27, v14
v_add_f32 v27, v27, v15
v_mfma_f32_16x16x32_bf16 v[60:63], a[104:107], a[40:43], v[60:63]
ds_read_b128 a[84:87], v2 offset:37888
v_cvt_pk_bf16_f32 v127, v14, v15
v_mfma_f32_16x16x32_bf16 v[60:63], a[108:111], a[44:47], v[60:63]
v_add_f32 v28, v26, v27
v_cmp_nge_f32 vcc, s25, v28
v_mfma_f32_16x16x32_bf16 v[60:63], a[112:115], a[48:51], v[60:63]
ds_read_b128 a[88:91], v2 offset:38912
v_mfma_f32_16x16x32_bf16 v[60:63], a[116:119], a[52:55], v[60:63]
v_mfma_f32_16x16x32_bf16 v[60:63], a[120:123], a[56:59], v[60:63]
ds_read_b128 a[92:95], v2 offset:39936
v_mfma_f32_16x16x32_bf16 v[60:63], a[124:127], a[60:63], v[60:63]
s_waitcnt lgkmcnt(3)
s_cbranch_vccnz Lstub_6
Lback_7:
v_mfma_f32_16x16x32_bf16 v[128:131], a[64:67], v[112:115], v[128:131]
s_add_u32 m0, s18, 65536
ds_read_b128 a[96:99], v2 offset:40960
v_add_f32 v24, v24, v26
v_mfma_f32_16x16x32_bf16 v[128:131], a[68:71], v[116:119], v[128:131]
buffer_load_dwordx4 v1, s[4:7], s12 offen offset:0 sc1 lds
v_mfma_f32_16x16x32_bf16 v[132:135], a[68:71], v[124:127], v[132:135]
ds_read_b128 a[100:103], v2 offset:41984
v_add_f32 v25, v25, v27
v_mfma_f32_16x16x32_bf16 v[132:135], a[64:67], v[120:123], v[132:135]
v_exp_f32 v8, v32
v_mfma_f32_16x16x32_bf16 v[136:139], a[72:75], v[112:115], v[136:139]
ds_read_b128 a[104:107], v2 offset:43008
v_mfma_f32_16x16x32_bf16 v[136:139], a[76:79], v[116:119], v[136:139]
buffer_load_dwordx4 v1, s[4:7], s12 offen offset:1024 sc1 lds
v_mfma_f32_16x16x32_bf16 v[140:143], a[76:79], v[124:127], v[140:143]
ds_read_b128 a[108:111], v2 offset:44032
v_mfma_f32_16x16x32_bf16 v[140:143], a[72:75], v[120:123], v[140:143]
v_exp_f32 v9, v33
v_mfma_f32_16x16x32_bf16 v[144:147], a[80:83], v[112:115], v[144:147]
s_waitcnt lgkmcnt(3)
ds_read_b128 a[112:115], v2 offset:45056
v_add_f32 v26, v8, v9
v_mfma_f32_16x16x32_bf16 v[144:147], a[84:87], v[116:119], v[144:147]
buffer_load_dwordx4 v1, s[4:7], s12 offen offset:2048 sc1 lds
v_mfma_f32_16x16x32_bf16 v[148:151], a[84:87], v[124:127], v[148:151]
ds_read_b128 a[116:119], v2 offset:46080
v_cvt_pk_bf16_f32 v96, v8, v9
v_mfma_f32_16x16x32_bf16 v[148:151], a[80:83], v[120:123], v[148:151]
v_exp_f32 v10, v34
v_mfma_f32_16x16x32_bf16 v[152:155], a[88:91], v[112:115], v[152:155]
ds_read_b128 a[120:123], v2 offset:47104
v_add_f32 v26, v26, v10
v_mfma_f32_16x16x32_bf16 v[152:155], a[92:95], v[116:119], v[152:155]
buffer_load_dwordx4 v1, s[4:7], s12 offen offset:3072 sc1 lds
v_mfma_f32_16x16x32_bf16 v[156:159], a[92:95], v[124:127], v[156:159]
s_add_u32 s12, s12, 4096
ds_read_b128 a[124:127], v2 offset:48128
v_mfma_f32_16x16x32_bf16 v[156:159], a[88:91], v[120:123], v[156:159]
s_waitcnt lgkmcnt(3)
v_exp_f32 v11, v35
v_mfma_f32_16x16x32_bf16 v[160:163], a[96:99], v[112:115], v[160:163]
s_add_u32 m0, s18, 69632
ds_read_b128 a[64:67], v2 offset:49152
v_add_f32 v26, v26, v11
v_mfma_f32_16x16x32_bf16 v[160:163], a[100:103], v[116:119], v[160:163]
buffer_load_dwordx4 v1, s[4:7], s12 offen offset:0 sc1 lds
v_mfma_f32_16x16x32_bf16 v[164:167], a[100:103], v[124:127], v[164:167]
ds_read_b128 a[68:71], v2 offset:50176
v_cvt_pk_bf16_f32 v97, v10, v11
v_mfma_f32_16x16x32_bf16 v[164:167], a[96:99], v[120:123], v[164:167]
v_mfma_f32_16x16x32_bf16 v[168:171], a[104:107], v[112:115], v[168:171]
ds_read_b128 a[72:75], v2 offset:51200
v_mfma_f32_16x16x32_bf16 v[168:171], a[108:111], v[116:119], v[168:171]
buffer_load_dwordx4 v1, s[4:7], s12 offen offset:1024 sc1 lds
v_mfma_f32_16x16x32_bf16 v[172:175], a[108:111], v[124:127], v[172:175]
ds_read_b128 a[76:79], v2 offset:52224
v_mfma_f32_16x16x32_bf16 v[172:175], a[104:107], v[120:123], v[172:175]
v_exp_f32 v12, v36
v_mfma_f32_16x16x32_bf16 v[176:179], a[112:115], v[112:115], v[176:179]
s_waitcnt lgkmcnt(3)
ds_read_b128 a[80:83], v2 offset:53248
v_mfma_f32_16x16x32_bf16 v[176:179], a[116:119], v[116:119], v[176:179]
buffer_load_dwordx4 v1, s[4:7], s12 offen offset:2048 sc1 lds
v_mfma_f32_16x16x32_bf16 v[180:183], a[116:119], v[124:127], v[180:183]
ds_read_b128 a[84:87], v2 offset:54272
v_mfma_f32_16x16x32_bf16 v[180:183], a[112:115], v[120:123], v[180:183]
v_exp_f32 v13, v37
v_mfma_f32_16x16x32_bf16 v[184:187], a[120:123], v[112:115], v[184:187]
ds_read_b128 a[88:91], v2 offset:55296
v_add_f32 v27, v12, v13
v_mfma_f32_16x16x32_bf16 v[184:187], a[124:127], v[116:119], v[184:187]
s_waitcnt lgkmcnt(3)
buffer_load_dwordx4 v1, s[4:7], s12 offen offset:3072 sc1 lds
v_mfma_f32_16x16x32_bf16 v[188:191], a[124:127], v[124:127], v[188:191]
s_add_u32 s12, s12, 28672
ds_read_b128 a[92:95], v2 offset:56320
v_cvt_pk_bf16_f32 v104, v12, v13
v_mfma_f32_16x16x32_bf16 v[188:191], a[120:123], v[120:123], v[188:191]
s_sub_u32 s13, s13, 1
v_exp_f32 v14, v38
v_mfma_f32_16x16x32_bf16 v[192:195], a[64:67], v[112:115], v[192:195]
s_cmp_eq_u32 s13, 0
ds_read_b128 a[96:99], v2 offset:57344
v_add_f32 v27, v27, v14
v_mfma_f32_16x16x32_bf16 v[192:195], a[68:71], v[116:119], v[192:195]
s_cselect_b32 s12, s14, s12
v_exp_f32 v15, v39
v_mfma_f32_16x16x32_bf16 v[196:199], a[68:71], v[124:127], v[196:199]
s_cselect_b32 s13, s15, s13
ds_read_b128 a[100:103], v2 offset:58368
v_add_f32 v27, v27, v15
v_mfma_f32_16x16x32_bf16 v[196:199], a[64:67], v[120:123], v[196:199]
s_cselect_b32 s14, 3221225472, s14
v_cvt_pk_bf16_f32 v105, v14, v15
v_mfma_f32_16x16x32_bf16 v[200:203], a[72:75], v[112:115], v[200:203]
ds_read_b128 a[104:107], v2 offset:59392
v_mfma_f32_16x16x32_bf16 v[200:203], a[76:79], v[116:119], v[200:203]
buffer_load_dword v3, off, s[4:7], s80 sc1
v_mfma_f32_16x16x32_bf16 v[204:207], a[76:79], v[124:127], v[204:207]
ds_read_b128 a[108:111], v2 offset:60416
v_mfma_f32_16x16x32_bf16 v[204:207], a[72:75], v[120:123], v[204:207]
s_waitcnt lgkmcnt(3)
v_exp_f32 v8, v40
v_mfma_f32_16x16x32_bf16 v[208:211], a[80:83], v[112:115], v[208:211]
ds_read_b128 a[112:115], v2 offset:61440
v_add_f32 v26, v26, v8
v_mfma_f32_16x16x32_bf16 v[208:211], a[84:87], v[116:119], v[208:211]
v_exp_f32 v9, v41
v_mfma_f32_16x16x32_bf16 v[212:215], a[84:87], v[124:127], v[212:215]
ds_read_b128 a[116:119], v2 offset:62464
v_add_f32 v26, v26, v9
v_mfma_f32_16x16x32_bf16 v[212:215], a[80:83], v[120:123], v[212:215]
v_exp_f32 v10, v42
v_mfma_f32_16x16x32_bf16 v[216:219], a[88:91], v[112:115], v[216:219]
ds_read_b128 a[120:123], v2 offset:63488
v_cvt_pk_bf16_f32 v98, v8, v9
v_mfma_f32_16x16x32_bf16 v[216:219], a[92:95], v[116:119], v[216:219]
v_exp_f32 v11, v43
v_mfma_f32_16x16x32_bf16 v[220:223], a[92:95], v[124:127], v[220:223]
s_waitcnt vmcnt(9)
ds_read_b128 a[124:127], v2 offset:64512
v_add_f32 v26, v26, v10
v_mfma_f32_16x16x32_bf16 v[220:223], a[88:91], v[120:123], v[220:223]
s_barrier
v_mfma_f32_16x16x32_bf16 v[224:227], a[96:99], v[112:115], v[224:227]
s_waitcnt lgkmcnt(3)
ds_read_b128 a[64:67], v4 offset:0
v_add_f32 v26, v26, v11
v_mfma_f32_16x16x32_bf16 v[224:227], a[100:103], v[116:119], v[224:227]
v_cvt_pk_bf16_f32 v99, v10, v11
v_mfma_f32_16x16x32_bf16 v[228:231], a[100:103], v[124:127], v[228:231]
ds_read_b128 a[68:71], v4 offset:1024
v_mfma_f32_16x16x32_bf16 v[228:231], a[96:99], v[120:123], v[228:231]
v_exp_f32 v12, v44
v_mfma_f32_16x16x32_bf16 v[232:235], a[104:107], v[112:115], v[232:235]
ds_read_b128 a[72:75], v4 offset:2048
v_add_f32 v27, v27, v12
v_mfma_f32_16x16x32_bf16 v[232:235], a[108:111], v[116:119], v[232:235]
v_exp_f32 v13, v45
v_mfma_f32_16x16x32_bf16 v[236:239], a[108:111], v[124:127], v[236:239]
ds_read_b128 a[76:79], v4 offset:3072
v_add_f32 v27, v27, v13
v_mfma_f32_16x16x32_bf16 v[236:239], a[104:107], v[120:123], v[236:239]
v_exp_f32 v14, v46
v_mfma_f32_16x16x32_bf16 v[240:243], a[112:115], v[112:115], v[240:243]
s_waitcnt lgkmcnt(3)
ds_read_b128 a[80:83], v4 offset:4096
v_cvt_pk_bf16_f32 v106, v12, v13
v_mfma_f32_16x16x32_bf16 v[240:243], a[116:119], v[116:119], v[240:243]
v_exp_f32 v15, v47
v_mfma_f32_16x16x32_bf16 v[244:247], a[116:119], v[124:127], v[244:247]
ds_read_b128 a[84:87], v4 offset:5120
v_add_f32 v27, v27, v14
v_mfma_f32_16x16x32_bf16 v[244:247], a[112:115], v[120:123], v[244:247]
v_add_f32 v27, v27, v15
v_cvt_pk_bf16_f32 v107, v14, v15
v_mfma_f32_16x16x32_bf16 v[248:251], a[120:123], v[112:115], v[248:251]
ds_read_b128 a[88:91], v4 offset:6144
v_mfma_f32_16x16x32_bf16 v[248:251], a[124:127], v[116:119], v[248:251]
v_mfma_f32_16x16x32_bf16 v[252:255], a[124:127], v[124:127], v[252:255]
ds_read_b128 a[92:95], v4 offset:7168
v_mfma_f32_16x16x32_bf16 v[252:255], a[120:123], v[120:123], v[252:255]
s_waitcnt lgkmcnt(3)
K2_dx1:
v_cndmask_b32 v68, v20, v7, s[32:33]
v_cndmask_b32 v69, v20, v7, s[34:35]
v_cndmask_b32 v70, v20, v7, s[36:37]
v_cndmask_b32 v71, v20, v7, s[38:39]
s_nop 1
v_mfma_f32_16x16x32_bf16 v[68:71], a[64:67], a[32:35], v[68:71]
s_add_u32 m0, s18, 0
ds_read_b128 a[96:99], v4 offset:8192
v_cndmask_b32 v76, v20, v7, s[40:41]
v_cndmask_b32 v79, v20, v7, s[46:47]
v_mfma_f32_16x16x32_bf16 v[68:71], a[68:71], a[36:39], v[68:71]
ds_read_b128 a[100:103], v4 offset:9216
buffer_load_dwordx4 v1, s[4:7], s12 offen offset:0 sc1 lds
v_mfma_f32_16x16x32_bf16 v[68:71], a[72:75], a[40:43], v[68:71]
ds_read_b128 a[104:107], v4 offset:10240
v_cndmask_b32 v77, v20, v7, s[42:43]
v_mfma_f32_16x16x32_bf16 v[68:71], a[76:79], a[44:47], v[68:71]
ds_read_b128 a[108:111], v4 offset:11264
buffer_load_dwordx4 v1, s[4:7], s12 offen offset:1024 sc1 lds
v_mfma_f32_16x16x32_bf16 v[68:71], a[80:83], a[48:51], v[68:71]
s_waitcnt lgkmcnt(5)
ds_read_b128 a[112:115], v4 offset:12288
v_cndmask_b32 v78, v20, v7, s[44:45]
v_mfma_f32_16x16x32_bf16 v[68:71], a[84:87], a[52:55], v[68:71]
ds_read_b128 a[116:119], v4 offset:13312
buffer_load_dwordx4 v1, s[4:7], s12 offen offset:2048 sc1 lds
v_mfma_f32_16x16x32_bf16 v[68:71], a[88:91], a[56:59], v[68:71]
s_waitcnt lgkmcnt(6)
ds_read_b128 a[120:123], v4 offset:14336
v_exp_f32 v8, v48
v_exp_f32 v9, v49
v_exp_f32 v10, v50
v_mfma_f32_16x16x32_bf16 v[68:71], a[92:95], a[60:63], v[68:71]
s_waitcnt lgkmcnt(5)
ds_read_b128 a[124:127], v4 offset:15360
buffer_load_dwordx4 v1, s[4:7], s12 offen offset:3072 sc1 lds
v_add_f32 v26, v26, v8
v_add_f32 v26, v26, v9
v_cvt_pk_bf16_f32 v100, v8, v9
v_add_f32 v26, v26, v10
v_mfma_f32_16x16x32_bf16 v[76:79], a[96:99], a[32:35], v[76:79]
s_add_u32 s12, s12, 4096
s_add_u32 m0, s18, 4096
ds_read_b128 a[64:67], v4 offset:16384
v_cndmask_b32 v86, v20, v7, s[52:53]
v_cndmask_b32 v87, v20, v7, s[54:55]
v_mfma_f32_16x16x32_bf16 v[76:79], a[100:103], a[36:39], v[76:79]
s_waitcnt lgkmcnt(6)
ds_read_b128 a[68:71], v4 offset:17408
buffer_load_dwordx4 v1, s[4:7], s12 offen offset:0 sc1 lds
v_mfma_f32_16x16x32_bf16 v[76:79], a[104:107], a[40:43], v[76:79]
s_waitcnt lgkmcnt(6)
ds_read_b128 a[72:75], v4 offset:18432
v_cndmask_b32 v84, v20, v7, s[48:49]
v_mfma_f32_16x16x32_bf16 v[76:79], a[108:111], a[44:47], v[76:79]
s_waitcnt lgkmcnt(6)
ds_read_b128 a[76:79], v4 offset:19456
buffer_load_dwordx4 v1, s[4:7], s12 offen offset:1024 sc1 lds
v_mfma_f32_16x16x32_bf16 v[76:79], a[112:115], a[48:51], v[76:79]
s_waitcnt lgkmcnt(6)
ds_read_b128 a[80:83], v4 offset:20480
v_cndmask_b32 v85, v20, v7, s[50:51]
v_mfma_f32_16x16x32_bf16 v[76:79], a[116:119], a[52:55], v[76:79]
s_waitcnt lgkmcnt(6)
ds_read_b128 a[84:87], v4 offset:21504
buffer_load_dwordx4 v1, s[4:7], s12 offen offset:2048 sc1 lds
v_mfma_f32_16x16x32_bf16 v[76:79], a[120:123], a[56:59], v[76:79]
s_waitcnt lgkmcnt(6)
ds_read_b128 a[88:91], v4 offset:22528
v_exp_f32 v11, v51
v_exp_f32 v12, v52
v_mfma_f32_16x16x32_bf16 v[76:79], a[124:127], a[60:63], v[76:79]
s_waitcnt lgkmcnt(1)
ds_read_b128 a[92:95], v4 offset:23552
buffer_load_dwordx4 v1, s[4:7], s12 offen offset:3072 sc1 lds
v_add_f32 v26, v26, v11
v_cvt_pk_bf16_f32 v101, v10, v11
v_add_f32 v27, v27, v12
v_mfma_f32_16x16x32_bf16 v[84:87], a[64:67], a[32:35], v[84:87]
s_add_u32 s12, s12, 28672
ds_read_b128 a[96:99], v4 offset:24576
v_cndmask_b32 v92, v20, v7, s[56:57]
v_mfma_f32_16x16x32_bf16 v[84:87], a[68:71], a[36:39], v[84:87]
s_sub_u32 s13, s13, 1
ds_read_b128 a[100:103], v4 offset:25600
v_cndmask_b32 v93, v20, v7, s[58:59]
v_mfma_f32_16x16x32_bf16 v[84:87], a[72:75], a[40:43], v[84:87]
s_cmp_eq_u32 s13, 0
ds_read_b128 a[104:107], v4 offset:26624
v_cndmask_b32 v94, v20, v7, s[60:61]
v_mfma_f32_16x16x32_bf16 v[84:87], a[76:79], a[44:47], v[84:87]
s_cselect_b32 s12, s14, s12
ds_read_b128 a[108:111], v4 offset:27648
v_cndmask_b32 v95, v20, v7, s[62:63]
v_mfma_f32_16x16x32_bf16 v[84:87], a[80:83], a[48:51], v[84:87]
s_cselect_b32 s13, s15, s13
ds_read_b128 a[112:115], v4 offset:28672
v_exp_f32 v13, v53
v_exp_f32 v14, v54
v_mfma_f32_16x16x32_bf16 v[84:87], a[84:87], a[52:55], v[84:87]
s_waitcnt lgkmcnt(6)
s_cselect_b32 s14, 3221225472, s14
ds_read_b128 a[116:119], v4 offset:29696
v_exp_f32 v15, v55
v_exp_f32 v8, v56
v_exp_f32 v9, v57
v_add_f32 v27, v27, v13
v_cvt_pk_bf16_f32 v108, v12, v13
v_add_f32 v27, v27, v14
v_mfma_f32_16x16x32_bf16 v[84:87], a[88:91], a[56:59], v[84:87]
s_waitcnt lgkmcnt(6)
ds_read_b128 a[120:123], v4 offset:30720
v_exp_f32 v10, v58
v_exp_f32 v11, v59
v_add_f32 v27, v27, v15
v_cvt_pk_bf16_f32 v109, v14, v15
v_mfma_f32_16x16x32_bf16 v[84:87], a[92:95], a[60:63], v[84:87]
s_waitcnt vmcnt(8) lgkmcnt(6)
s_barrier
ds_read_b128 a[124:127], v4 offset:31744
v_mfma_f32_16x16x32_bf16 v[92:95], a[96:99], a[32:35], v[92:95]
s_waitcnt lgkmcnt(6)
ds_read_b128 a[64:67], v2 offset:0
v_exp_f32 v12, v60
v_exp_f32 v13, v61
v_mfma_f32_16x16x32_bf16 v[92:95], a[100:103], a[36:39], v[92:95]
s_waitcnt lgkmcnt(6)
ds_read_b128 a[68:71], v2 offset:1024
v_exp_f32 v14, v62
v_exp_f32 v15, v63
v_mfma_f32_16x16x32_bf16 v[92:95], a[104:107], a[40:43], v[92:95]
s_waitcnt lgkmcnt(6)
ds_read_b128 a[72:75], v2 offset:2048
v_add_f32 v26, v26, v8
v_add_f32 v26, v26, v9
v_cvt_pk_bf16_f32 v102, v8, v9
v_mfma_f32_16x16x32_bf16 v[92:95], a[108:111], a[44:47], v[92:95]
s_waitcnt lgkmcnt(6)
ds_read_b128 a[76:79], v2 offset:3072
v_add_f32 v26, v26, v10
v_add_f32 v26, v26, v11
v_cvt_pk_bf16_f32 v103, v10, v11
v_mfma_f32_16x16x32_bf16 v[92:95], a[112:115], a[48:51], v[92:95]
s_waitcnt lgkmcnt(6)
ds_read_b128 a[80:83], v2 offset:4096
v_add_f32 v27, v27, v12
v_mfma_f32_16x16x32_bf16 v[92:95], a[116:119], a[52:55], v[92:95]
s_waitcnt lgkmcnt(6)
ds_read_b128 a[84:87], v2 offset:5120
v_add_f32 v27, v27, v13
v_cvt_pk_bf16_f32 v110, v12, v13
v_mfma_f32_16x16x32_bf16 v[92:95], a[120:123], a[56:59], v[92:95]
s_waitcnt lgkmcnt(6)
ds_read_b128 a[88:91], v2 offset:6144
v_add_f32 v27, v27, v14
v_add_f32 v27, v27, v15
v_cvt_pk_bf16_f32 v111, v14, v15
v_mfma_f32_16x16x32_bf16 v[92:95], a[124:127], a[60:63], v[92:95]
s_waitcnt lgkmcnt(6)
ds_read_b128 a[92:95], v2 offset:7168
v_add_f32 v28, v26, v27
v_cmp_nge_f32 vcc, s25, v28
s_cbranch_vccnz Lstub_8
Lback_9:
s_cmp_lg_u32 s24, 1
s_cbranch_scc1 K2_plain
v_cmp_gt_u32 vcc, 1, v3
s_cbranch_vccnz K2_tspin
K2_tok:
v_mfma_f32_16x16x32_bf16 v[128:131], a[64:67], v[96:99], v[128:131]
s_waitcnt lgkmcnt(6)
ds_read_b128 a[96:99], v2 offset:8192
v_add_f32 v24, v24, v26
v_mfma_f32_16x16x32_bf16 v[128:131], a[68:71], v[100:103], v[128:131]
buffer_load_dwordx4 v[28:31], v1, s[4:7], s27 offen sc1
v_mfma_f32_16x16x32_bf16 v[132:135], a[68:71], v[108:111], v[132:135]
ds_read_b128 a[100:103], v2 offset:9216
v_add_f32 v25, v25, v27
v_mfma_f32_16x16x32_bf16 v[132:135], a[64:67], v[104:107], v[132:135]
s_waitcnt lgkmcnt(5)
v_exp_f32 v8, v68
v_mfma_f32_16x16x32_bf16 v[136:139], a[72:75], v[96:99], v[136:139]
s_add_u32 s22, s76, 0
ds_read_b128 a[104:107], v2 offset:10240
v_exp_f32 v9, v69
v_mfma_f32_16x16x32_bf16 v[136:139], a[76:79], v[100:103], v[136:139]
buffer_load_dwordx4 v[32:35], v1, s[4:7], s22 offen offset:0 sc1
v_mfma_f32_16x16x32_bf16 v[140:143], a[76:79], v[108:111], v[140:143]
ds_read_b128 a[108:111], v2 offset:11264
v_add_f32 v27, v8, v9
v_mfma_f32_16x16x32_bf16 v[140:143], a[72:75], v[104:107], v[140:143]
v_exp_f32 v10, v70
v_mfma_f32_16x16x32_bf16 v[144:147], a[80:83], v[96:99], v[144:147]
s_waitcnt lgkmcnt(3)
ds_read_b128 a[112:115], v2 offset:12288
v_cvt_pk_bf16_f32 v120, v8, v9
v_mfma_f32_16x16x32_bf16 v[144:147], a[84:87], v[100:103], v[144:147]
buffer_load_dwordx4 v[36:39], v1, s[4:7], s22 offen offset:1024 sc1
v_mfma_f32_16x16x32_bf16 v[148:151], a[84:87], v[108:111], v[148:151]
ds_read_b128 a[116:119], v2 offset:13312
v_add_f32 v27, v27, v10
v_mfma_f32_16x16x32_bf16 v[148:151], a[80:83], v[104:107], v[148:151]
v_exp_f32 v11, v71
v_mfma_f32_16x16x32_bf16 v[152:155], a[88:91], v[96:99], v[152:155]
ds_read_b128 a[120:123], v2 offset:14336
v_add_f32 v27, v27, v11
v_mfma_f32_16x16x32_bf16 v[152:155], a[92:95], v[100:103], v[152:155]
buffer_load_dwordx4 v[40:43], v1, s[4:7], s22 offen offset:2048 sc1
v_mfma_f32_16x16x32_bf16 v[156:159], a[92:95], v[108:111], v[156:159]
ds_read_b128 a[124:127], v2 offset:15360
v_cvt_pk_bf16_f32 v121, v10, v11
v_mfma_f32_16x16x32_bf16 v[156:159], a[88:91], v[104:107], v[156:159]
v_exp_f32 v12, v76
v_mfma_f32_16x16x32_bf16 v[160:163], a[96:99], v[96:99], v[160:163]
s_waitcnt lgkmcnt(3)
ds_read_b128 a[64:67], v2 offset:16384
v_add_f32 v27, v27, v12
v_mfma_f32_16x16x32_bf16 v[160:163], a[100:103], v[100:103], v[160:163]
buffer_load_dwordx4 v[44:47], v1, s[4:7], s22 offen offset:3072 sc1
v_mfma_f32_16x16x32_bf16 v[164:167], a[100:103], v[108:111], v[164:167]
ds_read_b128 a[68:71], v2 offset:17408
v_mfma_f32_16x16x32_bf16 v[164:167], a[96:99], v[104:107], v[164:167]
v_exp_f32 v13, v77
v_mfma_f32_16x16x32_bf16 v[168:171], a[104:107], v[96:99], v[168:171]
s_add_u32 s22, s76, 4096
ds_read_b128 a[72:75], v2 offset:18432
v_add_f32 v27, v27, v13
v_mfma_f32_16x16x32_bf16 v[168:171], a[108:111], v[100:103], v[168:171]
buffer_load_dwordx4 v[48:51], v1, s[4:7], s22 offen offset:0 sc1
v_mfma_f32_16x16x32_bf16 v[172:175], a[108:111], v[108:111], v[172:175]
ds_read_b128 a[76:79], v2 offset:19456
v_exp_f32 v14, v78
v_mfma_f32_16x16x32_bf16 v[172:175], a[104:107], v[104:107], v[172:175]
PAD_12:
s_cbranch_execz M_tret
v_exp_f32 v15, v79
v_mfma_f32_16x16x32_bf16 v[176:179], a[112:115], v[96:99], v[176:179]
s_waitcnt lgkmcnt(3)
ds_read_b128 a[80:83], v2 offset:20480
v_cvt_pk_bf16_f32 v122, v12, v13
v_mfma_f32_16x16x32_bf16 v[176:179], a[116:119], v[100:103], v[176:179]
buffer_load_dwordx4 v[52:55], v1, s[4:7], s22 offen offset:1024 sc1
v_mfma_f32_16x16x32_bf16 v[180:183], a[116:119], v[108:111], v[180:183]
ds_read_b128 a[84:87], v2 offset:21504
v_add_f32 v27, v27, v14
v_mfma_f32_16x16x32_bf16 v[180:183], a[112:115], v[104:107], v[180:183]
v_exp_f32 v8, v84
v_mfma_f32_16x16x32_bf16 v[184:187], a[120:123], v[96:99], v[184:187]
ds_read_b128 a[88:91], v2 offset:22528
v_add_f32 v27, v27, v15
v_cvt_pk_bf16_f32 v123, v14, v15
v_mfma_f32_16x16x32_bf16 v[184:187], a[124:127], v[100:103], v[184:187]
buffer_load_dwordx4 v[56:59], v1, s[4:7], s22 offen offset:2048 sc1
v_mfma_f32_16x16x32_bf16 v[188:191], a[124:127], v[108:111], v[188:191]
ds_read_b128 a[92:95], v2 offset:23552
v_add_f32 v27, v27, v8
v_mfma_f32_16x16x32_bf16 v[188:191], a[120:123], v[104:107], v[188:191]
v_exp_f32 v9, v85
v_mfma_f32_16x16x32_bf16 v[192:195], a[64:67], v[96:99], v[192:195]
s_waitcnt lgkmcnt(3)
ds_read_b128 a[96:99], v2 offset:24576
v_add_f32 v27, v27, v9
v_mfma_f32_16x16x32_bf16 v[192:195], a[68:71], v[100:103], v[192:195]
buffer_load_dwordx4 v[60:63], v1, s[4:7], s22 offen offset:3072 sc1
v_mfma_f32_16x16x32_bf16 v[196:199], a[68:71], v[108:111], v[196:199]
ds_read_b128 a[100:103], v2 offset:25600
v_cvt_pk_bf16_f32 v124, v8, v9
v_mfma_f32_16x16x32_bf16 v[196:199], a[64:67], v[104:107], v[196:199]
v_exp_f32 v10, v86
v_mfma_f32_16x16x32_bf16 v[200:203], a[72:75], v[96:99], v[200:203]
s_add_u32 s22, s76, 8192
ds_read_b128 a[104:107], v2 offset:26624
v_add_f32 v27, v27, v10
v_mfma_f32_16x16x32_bf16 v[200:203], a[76:79], v[100:103], v[200:203]
buffer_load_dwordx4 a[32:35], v1, s[4:7], s22 offen offset:0 sc1
v_mfma_f32_16x16x32_bf16 v[204:207], a[76:79], v[108:111], v[204:207]
ds_read_b128 a[108:111], v2 offset:27648
v_mfma_f32_16x16x32_bf16 v[204:207], a[72:75], v[104:107], v[204:207]
v_exp_f32 v11, v87
v_mfma_f32_16x16x32_bf16 v[208:211], a[80:83], v[96:99], v[208:211]
s_waitcnt lgkmcnt(3)
ds_read_b128 a[112:115], v2 offset:28672
v_exp_f32 v12, v92
v_mfma_f32_16x16x32_bf16 v[208:211], a[84:87], v[100:103], v[208:211]
buffer_load_dwordx4 a[36:39], v1, s[4:7], s22 offen offset:1024 sc1
v_mfma_f32_16x16x32_bf16 v[212:215], a[84:87], v[108:111], v[212:215]
ds_read_b128 a[116:119], v2 offset:29696
v_add_f32 v27, v27, v11
v_mfma_f32_16x16x32_bf16 v[212:215], a[80:83], v[104:107], v[212:215]
v_exp_f32 v13, v93
v_mfma_f32_16x16x32_bf16 v[216:219], a[88:91], v[96:99], v[216:219]
ds_read_b128 a[120:123], v2 offset:30720
v_cvt_pk_bf16_f32 v125, v10, v11
v_add_f32 v27, v27, v12
v_mfma_f32_16x16x32_bf16 v[216:219], a[92:95], v[100:103], v[216:219]
buffer_load_dwordx4 a[40:43], v1, s[4:7], s22 offen offset:2048 sc1
v_mfma_f32_16x16x32_bf16 v[220:223], a[92:95], v[108:111], v[220:223]
s_waitcnt vmcnt(12)
ds_read_b128 a[124:127], v2 offset:31744
v_add_f32 v27, v27, v13
v_mfma_f32_16x16x32_bf16 v[220:223], a[88:91], v[104:107], v[220:223]
s_barrier
v_mfma_f32_16x16x32_bf16 v[224:227], a[96:99], v[96:99], v[224:227]
s_waitcnt lgkmcnt(3)
ds_read_b128 a[64:67], v1 offset:0
v_cvt_pk_bf16_f32 v126, v12, v13
v_mfma_f32_16x16x32_bf16 v[224:227], a[100:103], v[100:103], v[224:227]
buffer_load_dwordx4 a[44:47], v1, s[4:7], s22 offen offset:3072 sc1
v_mfma_f32_16x16x32_bf16 v[228:231], a[100:103], v[108:111], v[228:231]
ds_read_b128 a[68:71], v1 offset:1024
v_mfma_f32_16x16x32_bf16 v[228:231], a[96:99], v[104:107], v[228:231]
v_exp_f32 v14, v94
v_mfma_f32_16x16x32_bf16 v[232:235], a[104:107], v[96:99], v[232:235]
s_add_u32 s22, s76, 12288
ds_read_b128 a[72:75], v1 offset:2048
v_add_f32 v27, v27, v14
v_mfma_f32_16x16x32_bf16 v[232:235], a[108:111], v[100:103], v[232:235]
buffer_load_dwordx4 a[48:51], v1, s[4:7], s22 offen offset:0 sc1
v_mfma_f32_16x16x32_bf16 v[236:239], a[108:111], v[108:111], v[236:239]
ds_read_b128 a[76:79], v1 offset:3072
v_mfma_f32_16x16x32_bf16 v[236:239], a[104:107], v[104:107], v[236:239]
v_exp_f32 v15, v95
v_mfma_f32_16x16x32_bf16 v[240:243], a[112:115], v[96:99], v[240:243]
s_waitcnt lgkmcnt(3)
ds_read_b128 a[80:83], v1 offset:4096
v_add_f32 v27, v27, v15
v_mfma_f32_16x16x32_bf16 v[240:243], a[116:119], v[100:103], v[240:243]
buffer_load_dwordx4 a[52:55], v1, s[4:7], s22 offen offset:1024 sc1
v_mfma_f32_16x16x32_bf16 v[244:247], a[116:119], v[108:111], v[244:247]
ds_read_b128 a[84:87], v1 offset:5120
v_cvt_pk_bf16_f32 v127, v14, v15
v_mfma_f32_16x16x32_bf16 v[244:247], a[112:115], v[104:107], v[244:247]
v_cmp_nge_f32 vcc, s25, v27
v_mfma_f32_16x16x32_bf16 v[248:251], a[120:123], v[96:99], v[248:251]
ds_read_b128 a[88:91], v1 offset:6144
v_mfma_f32_16x16x32_bf16 v[248:251], a[124:127], v[100:103], v[248:251]
buffer_load_dwordx4 a[56:59], v1, s[4:7], s22 offen offset:2048 sc1
v_mfma_f32_16x16x32_bf16 v[252:255], a[124:127], v[108:111], v[252:255]
ds_read_b128 a[92:95], v1 offset:7168
v_mfma_f32_16x16x32_bf16 v[252:255], a[120:123], v[104:107], v[252:255]
s_waitcnt lgkmcnt(2)
buffer_load_dwordx4 a[60:63], v1, s[4:7], s22 offen offset:3072 sc1
s_cbranch_vccnz Lstub_10
Lback_11:
v_mfma_f32_16x16x32_bf16 v[132:135], a[64:67], v[120:123], v[132:135]
s_mov_b64 s[36:37], s[86:87]
ds_read_b128 a[96:99], v1 offset:8192
v_add_f32 v25, v25, v27
v_mfma_f32_16x16x32_bf16 v[132:135], a[68:71], v[124:127], v[132:135]
s_mov_b32 s38, 3670016
ds_read_b128 a[100:103], v1 offset:9216
v_accvgpr_read_b32 v112, a184
v_mfma_f32_16x16x32_bf16 v[140:143], a[72:75], v[120:123], v[140:143]
s_mov_b32 s39, 0x20000
ds_read_b128 a[104:107], v1 offset:10240
v_accvgpr_read_b32 v113, a185
v_mfma_f32_16x16x32_bf16 v[140:143], a[76:79], v[124:127], v[140:143]
s_lshl_b32 s8, s29, 3
ds_read_b128 a[108:111], v1 offset:11264
v_accvgpr_read_b32 v114, a186
v_mfma_f32_16x16x32_bf16 v[148:151], a[80:83], v[120:123], v[148:151]
s_add_u32 s8, s8, s3
ds_read_b128 a[112:115], v1 offset:12288
v_accvgpr_read_b32 v115, a187
v_mfma_f32_16x16x32_bf16 v[148:151], a[84:87], v[124:127], v[148:151]
s_waitcnt lgkmcnt(3)
s_lshl_b32 s8, s8, 4
ds_read_b128 a[116:119], v1 offset:13312
v_accvgpr_read_b32 v116, a188
v_mfma_f32_16x16x32_bf16 v[156:159], a[88:91], v[120:123], v[156:159]
s_add_u32 s8, s8, s20
ds_read_b128 a[120:123], v1 offset:14336
v_accvgpr_read_b32 v117, a189
v_mfma_f32_16x16x32_bf16 v[156:159], a[92:95], v[124:127], v[156:159]
s_mul_i32 s8, s8, 14336
ds_read_b128 a[124:127], v1 offset:15360
v_accvgpr_read_b32 v118, a190
v_mfma_f32_16x16x32_bf16 v[164:167], a[96:99], v[120:123], v[164:167]
s_add_u32 s8, s8, 104857600
ds_read_b128 a[64:67], v1 offset:16384
v_accvgpr_read_b32 v119, a191
v_mfma_f32_16x16x32_bf16 v[164:167], a[100:103], v[124:127], v[164:167]
s_waitcnt lgkmcnt(6)
s_add_u32 s12, s8, 917504
ds_read_b128 a[68:71], v1 offset:17408
v_mfma_f32_16x16x32_bf16 v[172:175], a[104:107], v[120:123], v[172:175]
s_waitcnt lgkmcnt(6)
ds_read_b128 a[72:75], v1 offset:18432
v_mfma_f32_16x16x32_bf16 v[172:175], a[108:111], v[124:127], v[172:175]
s_waitcnt lgkmcnt(6)
ds_read_b128 a[76:79], v1 offset:19456
v_mfma_f32_16x16x32_bf16 v[180:183], a[112:115], v[120:123], v[180:183]
s_waitcnt lgkmcnt(6)
ds_read_b128 a[80:83], v1 offset:20480
v_mfma_f32_16x16x32_bf16 v[180:183], a[116:119], v[124:127], v[180:183]
s_waitcnt lgkmcnt(6)
ds_read_b128 a[84:87], v1 offset:21504
v_mfma_f32_16x16x32_bf16 v[188:191], a[120:123], v[120:123], v[188:191]
s_waitcnt lgkmcnt(6)
ds_read_b128 a[88:91], v1 offset:22528
v_mfma_f32_16x16x32_bf16 v[188:191], a[124:127], v[124:127], v[188:191]
s_waitcnt lgkmcnt(6)
ds_read_b128 a[92:95], v1 offset:23552
v_mfma_f32_16x16x32_bf16 v[196:199], a[64:67], v[120:123], v[196:199]
s_waitcnt lgkmcnt(6)
ds_read_b128 a[96:99], v1 offset:24576
v_mfma_f32_16x16x32_bf16 v[196:199], a[68:71], v[124:127], v[196:199]
s_waitcnt lgkmcnt(6)
ds_read_b128 a[100:103], v1 offset:25600
v_mfma_f32_16x16x32_bf16 v[204:207], a[72:75], v[120:123], v[204:207]
s_waitcnt lgkmcnt(6)
ds_read_b128 a[104:107], v1 offset:26624
v_mfma_f32_16x16x32_bf16 v[204:207], a[76:79], v[124:127], v[204:207]
s_waitcnt lgkmcnt(6)
ds_read_b128 a[108:111], v1 offset:27648
v_mfma_f32_16x16x32_bf16 v[212:215], a[80:83], v[120:123], v[212:215]
s_waitcnt lgkmcnt(6)
ds_read_b128 a[112:115], v1 offset:28672
v_mfma_f32_16x16x32_bf16 v[212:215], a[84:87], v[124:127], v[212:215]
s_waitcnt lgkmcnt(6)
ds_read_b128 a[116:119], v1 offset:29696
v_mfma_f32_16x16x32_bf16 v[220:223], a[88:91], v[120:123], v[220:223]
s_waitcnt lgkmcnt(6)
s_add_u32 m0, s18, 32768
ds_read_b128 a[120:123], v1 offset:30720
v_mfma_f32_16x16x32_bf16 v[220:223], a[92:95], v[124:127], v[220:223]
s_waitcnt lgkmcnt(6)
ds_read_b128 a[124:127], v1 offset:31744
v_mfma_f32_16x16x32_bf16 v[228:231], a[96:99], v[120:123], v[228:231]
s_waitcnt lgkmcnt(6)
buffer_load_dwordx4 v112, s[36:39], s81 offen offset:0 lds
v_mfma_f32_16x16x32_bf16 v[228:231], a[100:103], v[124:127], v[228:231]
s_waitcnt lgkmcnt(5)
buffer_load_dwordx4 v113, s[36:39], s81 offen offset:1024 lds
v_mfma_f32_16x16x32_bf16 v[236:239], a[104:107], v[120:123], v[236:239]
s_waitcnt lgkmcnt(4)
buffer_load_dwordx4 v114, s[36:39], s81 offen offset:2048 lds
v_mfma_f32_16x16x32_bf16 v[236:239], a[108:111], v[124:127], v[236:239]
s_waitcnt lgkmcnt(3)
buffer_load_dwordx4 v115, s[36:39], s81 offen offset:3072 lds
v_mfma_f32_16x16x32_bf16 v[244:247], a[112:115], v[120:123], v[244:247]
s_waitcnt lgkmcnt(2)
s_add_u32 s81, s81, 28672
v_mfma_f32_16x16x32_bf16 v[244:247], a[116:119], v[124:127], v[244:247]
s_waitcnt lgkmcnt(1)
s_add_u32 m0, s18, 36864
v_mfma_f32_16x16x32_bf16 v[252:255], a[120:123], v[120:123], v[252:255]
s_waitcnt lgkmcnt(0)
buffer_load_dwordx4 v112, s[36:39], s81 offen offset:0 lds
v_mfma_f32_16x16x32_bf16 v[252:255], a[124:127], v[124:127], v[252:255]
buffer_load_dwordx4 v113, s[36:39], s81 offen offset:1024 lds
buffer_load_dwordx4 v114, s[36:39], s81 offen offset:2048 lds
buffer_load_dwordx4 v115, s[36:39], s81 offen offset:3072 lds
s_sub_u32 s81, s81, 28544
s_waitcnt vmcnt(8)
v_sub_f32 v8, v16, v28
v_sub_f32 v10, v20, v30
v_max_f32 v9, v8, v10
v_cmp_lt_f32 vcc, 1114636288, v9
s_cbranch_vccnz K2_cfix
K2_cok:
v_exp_f32 v8, v8
v_exp_f32 v10, v10
s_nop 0
v_mov_b32 v9, v8
v_mov_b32 v11, v10
v_fmac_f32 v24, v8, v29
v_fmac_f32 v25, v10, v31
s_mov_b32 s23, 0xffff0000
v_lshlrev_b32 v64, 16, v32
v_and_b32 v65, s23, v32
v_lshlrev_b32 v66, 16, v33
v_and_b32 v67, s23, v33
v_lshlrev_b32 v68, 16, v34
v_and_b32 v69, s23, v34
v_lshlrev_b32 v70, 16, v35
v_and_b32 v71, s23, v35
v_pk_fma_f32 v[128:129], v[64:65], v[8:9], v[128:129]
v_pk_fma_f32 v[130:131], v[66:67], v[8:9], v[130:131]
v_pk_fma_f32 v[136:137], v[68:69], v[8:9], v[136:137]
v_pk_fma_f32 v[138:139], v[70:71], v[8:9], v[138:139]
v_cvt_pk_bf16_f32 v128, v128, v129
v_cvt_pk_bf16_f32 v129, v130, v131
v_cvt_pk_bf16_f32 v130, v136, v137
v_cvt_pk_bf16_f32 v131, v138, v139
s_add_u32 m0, s18, 98304
s_nop 0
buffer_load_dwordx4 v112, s[36:39], s81 offen offset:0 lds
v_lshlrev_b32 v64, 16, v36
v_and_b32 v65, s23, v36
v_lshlrev_b32 v66, 16, v37
v_and_b32 v67, s23, v37
v_lshlrev_b32 v68, 16, v38
v_and_b32 v69, s23, v38
v_lshlrev_b32 v70, 16, v39
v_and_b32 v71, s23, v39
v_pk_fma_f32 v[144:145], v[64:65], v[8:9], v[144:145]
v_pk_fma_f32 v[146:147], v[66:67], v[8:9], v[146:147]
v_pk_fma_f32 v[152:153], v[68:69], v[8:9], v[152:153]
v_pk_fma_f32 v[154:155], v[70:71], v[8:9], v[154:155]
v_cvt_pk_bf16_f32 v144, v144, v145
v_cvt_pk_bf16_f32 v145, v146, v147
v_cvt_pk_bf16_f32 v146, v152, v153
v_cvt_pk_bf16_f32 v147, v154, v155
buffer_load_dwordx4 v113, s[36:39], s81 offen offset:1024 lds
v_lshlrev_b32 v64, 16, v40
v_and_b32 v65, s23, v40
v_lshlrev_b32 v66, 16, v41
v_and_b32 v67, s23, v41
v_lshlrev_b32 v68, 16, v42
v_and_b32 v69, s23, v42
v_lshlrev_b32 v70, 16, v43
v_and_b32 v71, s23, v43
v_pk_fma_f32 v[160:161], v[64:65], v[8:9], v[160:161]
v_pk_fma_f32 v[162:163], v[66:67], v[8:9], v[162:163]
v_pk_fma_f32 v[168:169], v[68:69], v[8:9], v[168:169]
v_pk_fma_f32 v[170:171], v[70:71], v[8:9], v[170:171]
v_cvt_pk_bf16_f32 v160, v160, v161
v_cvt_pk_bf16_f32 v161, v162, v163
v_cvt_pk_bf16_f32 v162, v168, v169
v_cvt_pk_bf16_f32 v163, v170, v171
buffer_load_dwordx4 v114, s[36:39], s81 offen offset:2048 lds
v_lshlrev_b32 v64, 16, v44
v_and_b32 v65, s23, v44
v_lshlrev_b32 v66, 16, v45
v_and_b32 v67, s23, v45
v_lshlrev_b32 v68, 16, v46
v_and_b32 v69, s23, v46
v_lshlrev_b32 v70, 16, v47
v_and_b32 v71, s23, v47
v_pk_fma_f32 v[176:177], v[64:65], v[8:9], v[176:177]
v_pk_fma_f32 v[178:179], v[66:67], v[8:9], v[178:179]
v_pk_fma_f32 v[184:185], v[68:69], v[8:9], v[184:185]
v_pk_fma_f32 v[186:187], v[70:71], v[8:9], v[186:187]
v_cvt_pk_bf16_f32 v176, v176, v177
v_cvt_pk_bf16_f32 v177, v178, v179
v_cvt_pk_bf16_f32 v178, v184, v185
v_cvt_pk_bf16_f32 v179, v186, v187
buffer_load_dwordx4 v115, s[36:39], s81 offen offset:3072 lds
v_lshlrev_b32 v64, 16, v48
v_and_b32 v65, s23, v48
v_lshlrev_b32 v66, 16, v49
v_and_b32 v67, s23, v49
v_lshlrev_b32 v68, 16, v50
v_and_b32 v69, s23, v50
v_lshlrev_b32 v70, 16, v51
v_and_b32 v71, s23, v51
v_pk_fma_f32 v[192:193], v[64:65], v[8:9], v[192:193]
v_pk_fma_f32 v[194:195], v[66:67], v[8:9], v[194:195]
v_pk_fma_f32 v[200:201], v[68:69], v[8:9], v[200:201]
v_pk_fma_f32 v[202:203], v[70:71], v[8:9], v[202:203]
v_cvt_pk_bf16_f32 v192, v192, v193
v_cvt_pk_bf16_f32 v193, v194, v195
v_cvt_pk_bf16_f32 v194, v200, v201
v_cvt_pk_bf16_f32 v195, v202, v203
s_add_u32 s81, s81, 28672
s_add_u32 m0, s18, 102400
s_nop 0
buffer_load_dwordx4 v112, s[36:39], s81 offen offset:0 lds
v_lshlrev_b32 v64, 16, v52
v_and_b32 v65, s23, v52
v_lshlrev_b32 v66, 16, v53
v_and_b32 v67, s23, v53
v_lshlrev_b32 v68, 16, v54
v_and_b32 v69, s23, v54
v_lshlrev_b32 v70, 16, v55
v_and_b32 v71, s23, v55
v_pk_fma_f32 v[208:209], v[64:65], v[8:9], v[208:209]
v_pk_fma_f32 v[210:211], v[66:67], v[8:9], v[210:211]
v_pk_fma_f32 v[216:217], v[68:69], v[8:9], v[216:217]
v_pk_fma_f32 v[218:219], v[70:71], v[8:9], v[218:219]
v_cvt_pk_bf16_f32 v208, v208, v209
v_cvt_pk_bf16_f32 v209, v210, v211
v_cvt_pk_bf16_f32 v210, v216, v217
v_cvt_pk_bf16_f32 v211, v218, v219
buffer_load_dwordx4 v113, s[36:39], s81 offen offset:1024 lds
v_lshlrev_b32 v64, 16, v56
v_and_b32 v65, s23, v56
v_lshlrev_b32 v66, 16, v57
v_and_b32 v67, s23, v57
v_lshlrev_b32 v68, 16, v58
v_and_b32 v69, s23, v58
v_lshlrev_b32 v70, 16, v59
v_and_b32 v71, s23, v59
v_pk_fma_f32 v[224:225], v[64:65], v[8:9], v[224:225]
v_pk_fma_f32 v[226:227], v[66:67], v[8:9], v[226:227]
v_pk_fma_f32 v[232:233], v[68:69], v[8:9], v[232:233]
v_pk_fma_f32 v[234:235], v[70:71], v[8:9], v[234:235]
v_cvt_pk_bf16_f32 v224, v224, v225
v_cvt_pk_bf16_f32 v225, v226, v227
v_cvt_pk_bf16_f32 v226, v232, v233
v_cvt_pk_bf16_f32 v227, v234, v235
buffer_load_dwordx4 v114, s[36:39], s81 offen offset:2048 lds
v_lshlrev_b32 v64, 16, v60
v_and_b32 v65, s23, v60
v_lshlrev_b32 v66, 16, v61
v_and_b32 v67, s23, v61
v_lshlrev_b32 v68, 16, v62
v_and_b32 v69, s23, v62
v_lshlrev_b32 v70, 16, v63
v_and_b32 v71, s23, v63
v_pk_fma_f32 v[240:241], v[64:65], v[8:9], v[240:241]
v_pk_fma_f32 v[242:243], v[66:67], v[8:9], v[242:243]
v_pk_fma_f32 v[248:249], v[68:69], v[8:9], v[248:249]
v_pk_fma_f32 v[250:251], v[70:71], v[8:9], v[250:251]
v_cvt_pk_bf16_f32 v240, v240, v241
v_cvt_pk_bf16_f32 v241, v242, v243
v_cvt_pk_bf16_f32 v242, v248, v249
v_cvt_pk_bf16_f32 v243, v250, v251
buffer_load_dwordx4 v115, s[36:39], s81 offen offset:3072 lds
v_accvgpr_read_b32 v32, a32
v_accvgpr_read_b32 v33, a33
v_accvgpr_read_b32 v34, a34
v_accvgpr_read_b32 v35, a35
v_lshlrev_b32 v64, 16, v32
v_and_b32 v65, s23, v32
v_lshlrev_b32 v66, 16, v33
v_and_b32 v67, s23, v33
v_lshlrev_b32 v68, 16, v34
v_and_b32 v69, s23, v34
v_lshlrev_b32 v70, 16, v35
v_and_b32 v71, s23, v35
v_pk_fma_f32 v[132:133], v[64:65], v[10:11], v[132:133]
v_pk_fma_f32 v[134:135], v[66:67], v[10:11], v[134:135]
v_pk_fma_f32 v[140:141], v[68:69], v[10:11], v[140:141]
v_pk_fma_f32 v[142:143], v[70:71], v[10:11], v[142:143]
v_cvt_pk_bf16_f32 v132, v132, v133
v_cvt_pk_bf16_f32 v133, v134, v135
v_cvt_pk_bf16_f32 v134, v140, v141
v_cvt_pk_bf16_f32 v135, v142, v143
s_sub_u32 s81, s81, 28544
s_add_u32 m0, s18, 131072
s_nop 0
buffer_load_dwordx4 v112, s[36:39], s81 offen offset:0 lds
v_accvgpr_read_b32 v36, a36
v_accvgpr_read_b32 v37, a37
v_accvgpr_read_b32 v38, a38
v_accvgpr_read_b32 v39, a39
v_lshlrev_b32 v64, 16, v36
v_and_b32 v65, s23, v36
v_lshlrev_b32 v66, 16, v37
v_and_b32 v67, s23, v37
v_lshlrev_b32 v68, 16, v38
v_and_b32 v69, s23, v38
v_lshlrev_b32 v70, 16, v39
v_and_b32 v71, s23, v39
v_pk_fma_f32 v[148:149], v[64:65], v[10:11], v[148:149]
v_pk_fma_f32 v[150:151], v[66:67], v[10:11], v[150:151]
v_pk_fma_f32 v[156:157], v[68:69], v[10:11], v[156:157]
v_pk_fma_f32 v[158:159], v[70:71], v[10:11], v[158:159]
v_cvt_pk_bf16_f32 v148, v148, v149
v_cvt_pk_bf16_f32 v149, v150, v151
v_cvt_pk_bf16_f32 v150, v156, v157
v_cvt_pk_bf16_f32 v151, v158, v159
buffer_load_dwordx4 v113, s[36:39], s81 offen offset:1024 lds
v_accvgpr_read_b32 v40, a40
v_accvgpr_read_b32 v41, a41
v_accvgpr_read_b32 v42, a42
v_accvgpr_read_b32 v43, a43
v_lshlrev_b32 v64, 16, v40
v_and_b32 v65, s23, v40
v_lshlrev_b32 v66, 16, v41
v_and_b32 v67, s23, v41
v_lshlrev_b32 v68, 16, v42
v_and_b32 v69, s23, v42
v_lshlrev_b32 v70, 16, v43
v_and_b32 v71, s23, v43
v_pk_fma_f32 v[164:165], v[64:65], v[10:11], v[164:165]
v_pk_fma_f32 v[166:167], v[66:67], v[10:11], v[166:167]
v_pk_fma_f32 v[172:173], v[68:69], v[10:11], v[172:173]
v_pk_fma_f32 v[174:175], v[70:71], v[10:11], v[174:175]
v_cvt_pk_bf16_f32 v164, v164, v165
v_cvt_pk_bf16_f32 v165, v166, v167
v_cvt_pk_bf16_f32 v166, v172, v173
v_cvt_pk_bf16_f32 v167, v174, v175
buffer_load_dwordx4 v114, s[36:39], s81 offen offset:2048 lds
v_accvgpr_read_b32 v44, a44
v_accvgpr_read_b32 v45, a45
v_accvgpr_read_b32 v46, a46
v_accvgpr_read_b32 v47, a47
v_lshlrev_b32 v64, 16, v44
v_and_b32 v65, s23, v44
v_lshlrev_b32 v66, 16, v45
v_and_b32 v67, s23, v45
v_lshlrev_b32 v68, 16, v46
v_and_b32 v69, s23, v46
v_lshlrev_b32 v70, 16, v47
v_and_b32 v71, s23, v47
v_pk_fma_f32 v[180:181], v[64:65], v[10:11], v[180:181]
v_pk_fma_f32 v[182:183], v[66:67], v[10:11], v[182:183]
v_pk_fma_f32 v[188:189], v[68:69], v[10:11], v[188:189]
v_pk_fma_f32 v[190:191], v[70:71], v[10:11], v[190:191]
v_cvt_pk_bf16_f32 v180, v180, v181
v_cvt_pk_bf16_f32 v181, v182, v183
v_cvt_pk_bf16_f32 v182, v188, v189
v_cvt_pk_bf16_f32 v183, v190, v191
buffer_load_dwordx4 v115, s[36:39], s81 offen offset:3072 lds
v_accvgpr_read_b32 v48, a48
v_accvgpr_read_b32 v49, a49
v_accvgpr_read_b32 v50, a50
v_accvgpr_read_b32 v51, a51
v_lshlrev_b32 v64, 16, v48
v_and_b32 v65, s23, v48
v_lshlrev_b32 v66, 16, v49
v_and_b32 v67, s23, v49
v_lshlrev_b32 v68, 16, v50
v_and_b32 v69, s23, v50
v_lshlrev_b32 v70, 16, v51
v_and_b32 v71, s23, v51
v_pk_fma_f32 v[196:197], v[64:65], v[10:11], v[196:197]
v_pk_fma_f32 v[198:199], v[66:67], v[10:11], v[198:199]
v_pk_fma_f32 v[204:205], v[68:69], v[10:11], v[204:205]
v_pk_fma_f32 v[206:207], v[70:71], v[10:11], v[206:207]
v_cvt_pk_bf16_f32 v196, v196, v197
v_cvt_pk_bf16_f32 v197, v198, v199
v_cvt_pk_bf16_f32 v198, v204, v205
v_cvt_pk_bf16_f32 v199, v206, v207
s_add_u32 s81, s81, 28672
s_add_u32 m0, s18, 135168
s_nop 0
buffer_load_dwordx4 v112, s[36:39], s81 offen offset:0 lds
v_accvgpr_read_b32 v52, a52
v_accvgpr_read_b32 v53, a53
v_accvgpr_read_b32 v54, a54
v_accvgpr_read_b32 v55, a55
v_lshlrev_b32 v64, 16, v52
v_and_b32 v65, s23, v52
v_lshlrev_b32 v66, 16, v53
v_and_b32 v67, s23, v53
v_lshlrev_b32 v68, 16, v54
v_and_b32 v69, s23, v54
v_lshlrev_b32 v70, 16, v55
v_and_b32 v71, s23, v55
v_pk_fma_f32 v[212:213], v[64:65], v[10:11], v[212:213]
v_pk_fma_f32 v[214:215], v[66:67], v[10:11], v[214:215]
v_pk_fma_f32 v[220:221], v[68:69], v[10:11], v[220:221]
v_pk_fma_f32 v[222:223], v[70:71], v[10:11], v[222:223]
v_cvt_pk_bf16_f32 v212, v212, v213
v_cvt_pk_bf16_f32 v213, v214, v215
v_cvt_pk_bf16_f32 v214, v220, v221
v_cvt_pk_bf16_f32 v215, v222, v223
buffer_load_dwordx4 v113, s[36:39], s81 offen offset:1024 lds
v_accvgpr_read_b32 v56, a56
v_accvgpr_read_b32 v57, a57
v_accvgpr_read_b32 v58, a58
v_accvgpr_read_b32 v59, a59
v_lshlrev_b32 v64, 16, v56
v_and_b32 v65, s23, v56
v_lshlrev_b32 v66, 16, v57
v_and_b32 v67, s23, v57
v_lshlrev_b32 v68, 16, v58
v_and_b32 v69, s23, v58
v_lshlrev_b32 v70, 16, v59
v_and_b32 v71, s23, v59
v_pk_fma_f32 v[228:229], v[64:65], v[10:11], v[228:229]
v_pk_fma_f32 v[230:231], v[66:67], v[10:11], v[230:231]
v_pk_fma_f32 v[236:237], v[68:69], v[10:11], v[236:237]
v_pk_fma_f32 v[238:239], v[70:71], v[10:11], v[238:239]
v_cvt_pk_bf16_f32 v228, v228, v229
v_cvt_pk_bf16_f32 v229, v230, v231
v_cvt_pk_bf16_f32 v230, v236, v237
v_cvt_pk_bf16_f32 v231, v238, v239
buffer_load_dwordx4 v114, s[36:39], s81 offen offset:2048 lds
v_accvgpr_read_b32 v60, a60
v_accvgpr_read_b32 v61, a61
v_accvgpr_read_b32 v62, a62
v_accvgpr_read_b32 v63, a63
v_lshlrev_b32 v64, 16, v60
v_and_b32 v65, s23, v60
v_lshlrev_b32 v66, 16, v61
v_and_b32 v67, s23, v61
v_lshlrev_b32 v68, 16, v62
v_and_b32 v69, s23, v62
v_lshlrev_b32 v70, 16, v63
v_and_b32 v71, s23, v63
v_pk_fma_f32 v[244:245], v[64:65], v[10:11], v[244:245]
v_pk_fma_f32 v[246:247], v[66:67], v[10:11], v[246:247]
v_pk_fma_f32 v[252:253], v[68:69], v[10:11], v[252:253]
v_pk_fma_f32 v[254:255], v[70:71], v[10:11], v[254:255]
v_cvt_pk_bf16_f32 v244, v244, v245
v_cvt_pk_bf16_f32 v245, v246, v247
v_cvt_pk_bf16_f32 v246, v252, v253
v_cvt_pk_bf16_f32 v247, v254, v255
buffer_load_dwordx4 v115, s[36:39], s81 offen offset:3072 lds
s_sub_u32 s81, s81, 28544
K2_done:
s_waitcnt vmcnt(16)
s_barrier
ds_read_b64_tr_b16 a[64:65], v116 offset:0
ds_read_b64_tr_b16 a[66:67], v116 offset:2048
ds_read_b64_tr_b16 a[68:69], v116 offset:4096
ds_read_b64_tr_b16 a[70:71], v116 offset:6144
ds_read_b64_tr_b16 a[72:73], v116 offset:8192
ds_read_b64_tr_b16 a[74:75], v116 offset:10240
ds_read_b64_tr_b16 a[76:77], v116 offset:12288
ds_read_b64_tr_b16 a[78:79], v116 offset:14336
ds_read_b64_tr_b16 a[80:81], v116 offset:16384
ds_read_b64_tr_b16 a[82:83], v116 offset:18432
ds_read_b64_tr_b16 a[84:85], v116 offset:20480
ds_read_b64_tr_b16 a[86:87], v116 offset:22528
ds_read_b64_tr_b16 a[88:89], v116 offset:24576
ds_read_b64_tr_b16 a[90:91], v116 offset:26624
ds_read_b64_tr_b16 a[92:93], v116 offset:28672
ds_read_b64_tr_b16 a[94:95], v116 offset:30720
v_add_u32 v116, 65536, v116
s_waitcnt lgkmcnt(14)
v_mfma_f32_16x16x32_bf16 v[32:35], a[64:67], v[128:131], 0
s_waitcnt lgkmcnt(12)
s_add_u32 m0, s18, 65536
ds_read_b64_tr_b16 a[96:97], v117 offset:0
v_mov_b32 v28, v24
v_mfma_f32_16x16x32_bf16 v[32:35], a[68:71], v[144:147], v[32:35]
s_waitcnt lgkmcnt(11)
ds_read_b64_tr_b16 a[98:99], v117 offset:2048
buffer_load_dwordx4 v112, s[36:39], s81 offen offset:0 lds
v_mfma_f32_16x16x32_bf16 v[32:35], a[72:75], v[160:163], v[32:35]
s_waitcnt lgkmcnt(10)
ds_read_b64_tr_b16 a[100:101], v117 offset:4096
v_permlane16_swap_b32 v24, v28
v_mfma_f32_16x16x32_bf16 v[32:35], a[76:79], v[176:179], v[32:35]
s_waitcnt lgkmcnt(9)
ds_read_b64_tr_b16 a[102:103], v117 offset:6144
v_add_f32 v24, v24, v28
v_mfma_f32_16x16x32_bf16 v[32:35], a[80:83], v[192:195], v[32:35]
s_waitcnt lgkmcnt(8)
ds_read_b64_tr_b16 a[104:105], v117 offset:8192
buffer_load_dwordx4 v113, s[36:39], s81 offen offset:1024 lds
v_mfma_f32_16x16x32_bf16 v[32:35], a[84:87], v[208:211], v[32:35]
s_waitcnt lgkmcnt(7)
ds_read_b64_tr_b16 a[106:107], v117 offset:10240
v_mov_b32 v28, v24
v_mfma_f32_16x16x32_bf16 v[32:35], a[88:91], v[224:227], v[32:35]
s_waitcnt lgkmcnt(6)
ds_read_b64_tr_b16 a[108:109], v117 offset:12288
v_lshrrev_b32 v20, 4, v1
v_mfma_f32_16x16x32_bf16 v[32:35], a[92:95], v[240:243], v[32:35]
ds_read_b64_tr_b16 a[110:111], v117 offset:14336
buffer_load_dwordx4 v114, s[36:39], s81 offen offset:2048 lds
v_mfma_f32_16x16x32_bf16 v[36:39], a[64:67], v[132:135], 0
ds_read_b64_tr_b16 a[112:113], v117 offset:16384
v_permlane32_swap_b32 v24, v28
v_mfma_f32_16x16x32_bf16 v[36:39], a[68:71], v[148:151], v[36:39]
ds_read_b64_tr_b16 a[114:115], v117 offset:18432
v_add_f32 v24, v24, v28
v_mfma_f32_16x16x32_bf16 v[36:39], a[72:75], v[164:167], v[36:39]
ds_read_b64_tr_b16 a[116:117], v117 offset:20480
buffer_load_dwordx4 v115, s[36:39], s81 offen offset:3072 lds
v_mfma_f32_16x16x32_bf16 v[36:39], a[76:79], v[180:183], v[36:39]
ds_read_b64_tr_b16 a[118:119], v117 offset:22528
v_mov_b32 v29, v25
v_mfma_f32_16x16x32_bf16 v[36:39], a[80:83], v[196:199], v[36:39]
s_add_u32 s81, s81, 28672
s_add_u32 m0, s18, 69632
ds_read_b64_tr_b16 a[120:121], v117 offset:24576
v_mfma_f32_16x16x32_bf16 v[36:39], a[84:87], v[212:215], v[36:39]
ds_read_b64_tr_b16 a[122:123], v117 offset:26624
buffer_load_dwordx4 v112, s[36:39], s81 offen offset:0 lds
v_mfma_f32_16x16x32_bf16 v[36:39], a[88:91], v[228:231], v[36:39]
PAD_13:
s_cbranch_execz M_tret
ds_read_b64_tr_b16 a[124:125], v117 offset:28672
v_permlane16_swap_b32 v25, v29
v_mfma_f32_16x16x32_bf16 v[36:39], a[92:95], v[244:247], v[36:39]
s_waitcnt lgkmcnt(6)
ds_read_b64_tr_b16 a[126:127], v117 offset:30720
v_add_u32 v117, 65536, v117
v_mfma_f32_16x16x32_bf16 v[40:43], a[96:99], v[128:131], 0
ds_read_b64_tr_b16 a[64:65], v118 offset:0
buffer_load_dwordx4 v113, s[36:39], s81 offen offset:1024 lds
v_mfma_f32_16x16x32_bf16 v[40:43], a[100:103], v[144:147], v[40:43]
ds_read_b64_tr_b16 a[66:67], v118 offset:2048
v_add_f32 v25, v25, v29
v_mfma_f32_16x16x32_bf16 v[40:43], a[104:107], v[160:163], v[40:43]
ds_read_b64_tr_b16 a[68:69], v118 offset:4096
v_mov_b32 v29, v25
v_mfma_f32_16x16x32_bf16 v[40:43], a[108:111], v[176:179], v[40:43]
s_waitcnt lgkmcnt(6)
ds_read_b64_tr_b16 a[70:71], v118 offset:6144
buffer_load_dwordx4 v114, s[36:39], s81 offen offset:2048 lds
v_mfma_f32_16x16x32_bf16 v[40:43], a[112:115], v[192:195], v[40:43]
ds_read_b64_tr_b16 a[72:73], v118 offset:8192
v_permlane32_swap_b32 v25, v29
v_mfma_f32_16x16x32_bf16 v[40:43], a[116:119], v[208:211], v[40:43]
s_waitcnt lgkmcnt(6)
ds_read_b64_tr_b16 a[74:75], v118 offset:10240
v_add_f32 v25, v25, v29
v_mfma_f32_16x16x32_bf16 v[40:43], a[120:123], v[224:227], v[40:43]
s_waitcnt lgkmcnt(6)
ds_read_b64_tr_b16 a[76:77], v118 offset:12288
buffer_load_dwordx4 v115, s[36:39], s81 offen offset:3072 lds
v_mfma_f32_16x16x32_bf16 v[40:43], a[124:127], v[240:243], v[40:43]
ds_read_b64_tr_b16 a[78:79], v118 offset:14336
v_rcp_f32 v24, v24
v_mfma_f32_16x16x32_bf16 v[44:47], a[96:99], v[132:135], 0
s_sub_u32 s81, s81, 28544
s_add_u32 m0, s18, 0
ds_read_b64_tr_b16 a[80:81], v118 offset:16384
v_mfma_f32_16x16x32_bf16 v[44:47], a[100:103], v[148:151], v[44:47]
ds_read_b64_tr_b16 a[82:83], v118 offset:18432
buffer_load_dwordx4 v112, s[36:39], s81 offen offset:0 lds
v_mfma_f32_16x16x32_bf16 v[44:47], a[104:107], v[164:167], v[44:47]
ds_read_b64_tr_b16 a[84:85], v118 offset:20480
v_rcp_f32 v25, v25
v_mfma_f32_16x16x32_bf16 v[44:47], a[108:111], v[180:183], v[44:47]
ds_read_b64_tr_b16 a[86:87], v118 offset:22528
v_and_b32 v19, 15, v20
v_mfma_f32_16x16x32_bf16 v[44:47], a[112:115], v[196:199], v[44:47]
ds_read_b64_tr_b16 a[88:89], v118 offset:24576
buffer_load_dwordx4 v113, s[36:39], s81 offen offset:1024 lds
v_mfma_f32_16x16x32_bf16 v[44:47], a[116:119], v[212:215], v[44:47]
ds_read_b64_tr_b16 a[90:91], v118 offset:26624
v_mul_f32 v32, v32, v24
v_mfma_f32_16x16x32_bf16 v[44:47], a[120:123], v[228:231], v[44:47]
ds_read_b64_tr_b16 a[92:93], v118 offset:28672
v_mul_f32 v33, v33, v24
v_mfma_f32_16x16x32_bf16 v[44:47], a[124:127], v[244:247], v[44:47]
s_waitcnt lgkmcnt(6)
ds_read_b64_tr_b16 a[94:95], v118 offset:30720
v_add_u32 v118, 65536, v118
v_mfma_f32_16x16x32_bf16 v[48:51], a[64:67], v[128:131], 0
ds_read_b64_tr_b16 a[96:97], v119 offset:0
buffer_load_dwordx4 v114, s[36:39], s81 offen offset:2048 lds
v_mfma_f32_16x16x32_bf16 v[48:51], a[68:71], v[144:147], v[48:51]
ds_read_b64_tr_b16 a[98:99], v119 offset:2048
v_mul_f32 v34, v34, v24
v_mfma_f32_16x16x32_bf16 v[48:51], a[72:75], v[160:163], v[48:51]
ds_read_b64_tr_b16 a[100:101], v119 offset:4096
v_mul_f32 v35, v35, v24
v_mfma_f32_16x16x32_bf16 v[48:51], a[76:79], v[176:179], v[48:51]
s_waitcnt lgkmcnt(6)
ds_read_b64_tr_b16 a[102:103], v119 offset:6144
buffer_load_dwordx4 v115, s[36:39], s81 offen offset:3072 lds
v_mfma_f32_16x16x32_bf16 v[48:51], a[80:83], v[192:195], v[48:51]
s_waitcnt lgkmcnt(6)
ds_read_b64_tr_b16 a[104:105], v119 offset:8192
v_mul_f32 v40, v40, v24
v_mfma_f32_16x16x32_bf16 v[48:51], a[84:87], v[208:211], v[48:51]
s_add_u32 s81, s81, 28672
s_add_u32 m0, s18, 4096
ds_read_b64_tr_b16 a[106:107], v119 offset:10240
v_mfma_f32_16x16x32_bf16 v[48:51], a[88:91], v[224:227], v[48:51]
s_waitcnt lgkmcnt(6)
ds_read_b64_tr_b16 a[108:109], v119 offset:12288
buffer_load_dwordx4 v112, s[36:39], s81 offen offset:0 lds
v_mfma_f32_16x16x32_bf16 v[48:51], a[92:95], v[240:243], v[48:51]
ds_read_b64_tr_b16 a[110:111], v119 offset:14336
v_mul_f32 v41, v41, v24
v_mfma_f32_16x16x32_bf16 v[52:55], a[64:67], v[132:135], 0
ds_read_b64_tr_b16 a[112:113], v119 offset:16384
v_mul_f32 v42, v42, v24
v_mfma_f32_16x16x32_bf16 v[52:55], a[68:71], v[148:151], v[52:55]
ds_read_b64_tr_b16 a[114:115], v119 offset:18432
buffer_load_dwordx4 v113, s[36:39], s81 offen offset:1024 lds
v_mfma_f32_16x16x32_bf16 v[52:55], a[72:75], v[164:167], v[52:55]
ds_read_b64_tr_b16 a[116:117], v119 offset:20480
v_mul_f32 v43, v43, v24
v_mfma_f32_16x16x32_bf16 v[52:55], a[76:79], v[180:183], v[52:55]
ds_read_b64_tr_b16 a[118:119], v119 offset:22528
v_cvt_pk_bf16_f32 v32, v32, v33
v_mfma_f32_16x16x32_bf16 v[52:55], a[80:83], v[196:199], v[52:55]
ds_read_b64_tr_b16 a[120:121], v119 offset:24576
buffer_load_dwordx4 v114, s[36:39], s81 offen offset:2048 lds
v_mfma_f32_16x16x32_bf16 v[52:55], a[84:87], v[212:215], v[52:55]
ds_read_b64_tr_b16 a[122:123], v119 offset:26624
v_cvt_pk_bf16_f32 v33, v34, v35
v_mfma_f32_16x16x32_bf16 v[52:55], a[88:91], v[228:231], v[52:55]
ds_read_b64_tr_b16 a[124:125], v119 offset:28672
ds_read_b64_tr_b16 a[126:127], v119 offset:30720
v_mfma_f32_16x16x32_bf16 v[52:55], a[92:95], v[244:247], v[52:55]
s_waitcnt vmcnt(23) lgkmcnt(7)
s_barrier
v_add_u32 v119, 65536, v119
v_mfma_f32_16x16x32_bf16 v[56:59], a[96:99], v[128:131], 0
ds_read_b64_tr_b16 a[64:65], v116 offset:0
buffer_load_dwordx4 v115, s[36:39], s81 offen offset:3072 lds
v_mfma_f32_16x16x32_bf16 v[56:59], a[100:103], v[144:147], v[56:59]
ds_read_b64_tr_b16 a[66:67], v116 offset:2048
v_cvt_pk_bf16_f32 v34, v40, v41
v_mfma_f32_16x16x32_bf16 v[56:59], a[104:107], v[160:163], v[56:59]
s_sub_u32 s81, s81, 28544
ds_read_b64_tr_b16 a[68:69], v116 offset:4096
v_cvt_pk_bf16_f32 v35, v42, v43
v_mfma_f32_16x16x32_bf16 v[56:59], a[108:111], v[176:179], v[56:59]
s_waitcnt lgkmcnt(6)
ds_read_b64_tr_b16 a[70:71], v116 offset:6144
buffer_store_dwordx4 v[32:35], v1, s[4:7], s8 offen offset:0 sc1
v_mfma_f32_16x16x32_bf16 v[56:59], a[112:115], v[192:195], v[56:59]
ds_read_b64_tr_b16 a[72:73], v116 offset:8192
v_mul_f32 v36, v36, v25
v_mfma_f32_16x16x32_bf16 v[56:59], a[116:119], v[208:211], v[56:59]
s_waitcnt lgkmcnt(5)
ds_read_b64_tr_b16 a[74:75], v116 offset:10240
v_mul_f32 v37, v37, v25
v_mfma_f32_16x16x32_bf16 v[56:59], a[120:123], v[224:227], v[56:59]
ds_read_b64_tr_b16 a[76:77], v116 offset:12288
v_mul_f32 v38, v38, v25
v_mfma_f32_16x16x32_bf16 v[56:59], a[124:127], v[240:243], v[56:59]
ds_read_b64_tr_b16 a[78:79], v116 offset:14336
v_mul_f32 v39, v39, v25
v_mfma_f32_16x16x32_bf16 v[60:63], a[96:99], v[132:135], 0
ds_read_b64_tr_b16 a[80:81], v116 offset:16384
v_mul_f32 v44, v44, v25
v_mfma_f32_16x16x32_bf16 v[60:63], a[100:103], v[148:151], v[60:63]
ds_read_b64_tr_b16 a[82:83], v116 offset:18432
v_mul_f32 v45, v45, v25
v_mfma_f32_16x16x32_bf16 v[60:63], a[104:107], v[164:167], v[60:63]
ds_read_b64_tr_b16 a[84:85], v116 offset:20480
v_mul_f32 v46, v46, v25
v_mfma_f32_16x16x32_bf16 v[60:63], a[108:111], v[180:183], v[60:63]
ds_read_b64_tr_b16 a[86:87], v116 offset:22528
v_mul_f32 v47, v47, v25
v_mfma_f32_16x16x32_bf16 v[60:63], a[112:115], v[196:199], v[60:63]
ds_read_b64_tr_b16 a[88:89], v116 offset:24576
v_cvt_pk_bf16_f32 v36, v36, v37
v_mfma_f32_16x16x32_bf16 v[60:63], a[116:119], v[212:215], v[60:63]
ds_read_b64_tr_b16 a[90:91], v116 offset:26624
v_cvt_pk_bf16_f32 v37, v38, v39
v_mfma_f32_16x16x32_bf16 v[60:63], a[120:123], v[228:231], v[60:63]
ds_read_b64_tr_b16 a[92:93], v116 offset:28672
v_cvt_pk_bf16_f32 v38, v44, v45
v_mfma_f32_16x16x32_bf16 v[60:63], a[124:127], v[244:247], v[60:63]
s_waitcnt lgkmcnt(3)
ds_read_b64_tr_b16 a[94:95], v116 offset:30720
v_add_u32 v116, 32768, v116
v_mfma_f32_16x16x32_bf16 v[64:67], a[64:67], v[128:131], 0
s_lshl_b32 s34, s29, 5
ds_read_b64_tr_b16 a[96:97], v117 offset:0
v_cvt_pk_bf16_f32 v39, v46, v47
v_mfma_f32_16x16x32_bf16 v[64:67], a[68:71], v[144:147], v[64:67]
s_add_u32 s34, s34, s20
ds_read_b64_tr_b16 a[98:99], v117 offset:2048
buffer_store_dwordx4 v[36:39], v1, s[4:7], s12 offen offset:0 sc1
v_mfma_f32_16x16x32_bf16 v[64:67], a[72:75], v[160:163], v[64:67]
s_lshl_b32 s34, s34, 2
ds_read_b64_tr_b16 a[100:101], v117 offset:4096
v_mul_f32 v48, v48, v24
v_mfma_f32_16x16x32_bf16 v[64:67], a[76:79], v[176:179], v[64:67]
s_add_u32 s34, s34, 94380032
ds_read_b64_tr_b16 a[102:103], v117 offset:6144
v_mul_f32 v49, v49, v24
v_mfma_f32_16x16x32_bf16 v[64:67], a[80:83], v[192:195], v[64:67]
s_add_u32 s35, s34, 2048
ds_read_b64_tr_b16 a[104:105], v117 offset:8192
v_mul_f32 v50, v50, v24
v_mfma_f32_16x16x32_bf16 v[64:67], a[84:87], v[208:211], v[64:67]
s_waitcnt lgkmcnt(5)
s_mov_b32 s80, s21
ds_read_b64_tr_b16 a[106:107], v117 offset:10240
v_mul_f32 v51, v51, v24
v_mfma_f32_16x16x32_bf16 v[64:67], a[88:91], v[224:227], v[64:67]
s_and_b32 s79, s2, 16
ds_read_b64_tr_b16 a[108:109], v117 offset:12288
v_mul_f32 v56, v56, v24
v_mfma_f32_16x16x32_bf16 v[64:67], a[92:95], v[240:243], v[64:67]
s_xor_b32 s79, s79, 16
ds_read_b64_tr_b16 a[110:111], v117 offset:14336
v_mul_f32 v57, v57, v24
v_mfma_f32_16x16x32_bf16 v[68:71], a[64:67], v[132:135], 0
s_add_u32 s79, s79, s20
ds_read_b64_tr_b16 a[112:113], v117 offset:16384
v_mul_f32 v58, v58, v24
v_mfma_f32_16x16x32_bf16 v[68:71], a[68:71], v[148:151], v[68:71]
s_lshl_b32 s22, s79, 2
ds_read_b64_tr_b16 a[114:115], v117 offset:18432
v_mul_f32 v59, v59, v24
v_mfma_f32_16x16x32_bf16 v[68:71], a[72:75], v[164:167], v[68:71]
s_add_u32 s22, s22, s3
ds_read_b64_tr_b16 a[116:117], v117 offset:20480
v_cvt_pk_bf16_f32 v48, v48, v49
v_mfma_f32_16x16x32_bf16 v[68:71], a[76:79], v[180:183], v[68:71]
s_mul_i32 s25, s22, 28672
ds_read_b64_tr_b16 a[118:119], v117 offset:22528
v_cvt_pk_bf16_f32 v49, v50, v51
v_mfma_f32_16x16x32_bf16 v[68:71], a[80:83], v[196:199], v[68:71]
s_lshl_b32 s23, s80, 6
ds_read_b64_tr_b16 a[120:121], v117 offset:24576
v_cvt_pk_bf16_f32 v50, v56, v57
v_mfma_f32_16x16x32_bf16 v[68:71], a[84:87], v[212:215], v[68:71]
s_add_u32 s25, s25, s23
ds_read_b64_tr_b16 a[122:123], v117 offset:26624
v_cvt_pk_bf16_f32 v51, v58, v59
v_mfma_f32_16x16x32_bf16 v[68:71], a[88:91], v[228:231], v[68:71]
s_mul_i32 s26, s22, 229376
ds_read_b64_tr_b16 a[124:125], v117 offset:28672
buffer_store_dwordx4 v[48:51], v1, s[4:7], s8 offen offset:1024 sc1
v_mfma_f32_16x16x32_bf16 v[68:71], a[92:95], v[244:247], v[68:71]
s_waitcnt lgkmcnt(3)
s_lshl_b32 s23, s80, 10
ds_read_b64_tr_b16 a[126:127], v117 offset:30720
v_add_u32 v117, 32768, v117
v_mfma_f32_16x16x32_bf16 v[72:75], a[96:99], v[128:131], 0
s_add_u32 s26, s26, s23
ds_read_b64_tr_b16 a[64:65], v118 offset:0
v_mul_f32 v52, v52, v25
v_mfma_f32_16x16x32_bf16 v[72:75], a[100:103], v[144:147], v[72:75]
s_add_u32 s26, s26, 104857600
ds_read_b64_tr_b16 a[66:67], v118 offset:2048
v_mul_f32 v53, v53, v25
v_mfma_f32_16x16x32_bf16 v[72:75], a[104:107], v[160:163], v[72:75]
s_lshr_b32 s22, s79, 1
ds_read_b64_tr_b16 a[68:69], v118 offset:4096
v_mul_f32 v54, v54, v25
v_mfma_f32_16x16x32_bf16 v[72:75], a[108:111], v[176:179], v[72:75]
s_lshl_b32 s22, s22, 7
ds_read_b64_tr_b16 a[70:71], v118 offset:6144
v_mul_f32 v55, v55, v25
v_mfma_f32_16x16x32_bf16 v[72:75], a[112:115], v[192:195], v[72:75]
s_add_u32 s33, s22, 94380032
ds_read_b64_tr_b16 a[72:73], v118 offset:8192
v_mul_f32 v60, v60, v25
v_mfma_f32_16x16x32_bf16 v[72:75], a[116:119], v[208:211], v[72:75]
s_waitcnt lgkmcnt(5)
s_mov_b64 s[40:41], s[88:89]
ds_read_b64_tr_b16 a[74:75], v118 offset:10240
v_mul_f32 v61, v61, v25
v_mfma_f32_16x16x32_bf16 v[72:75], a[120:123], v[224:227], v[72:75]
s_mov_b32 s42, 3670016
ds_read_b64_tr_b16 a[76:77], v118 offset:12288
v_mul_f32 v62, v62, v25
v_mfma_f32_16x16x32_bf16 v[72:75], a[124:127], v[240:243], v[72:75]
s_mov_b32 s43, 0x20000
ds_read_b64_tr_b16 a[78:79], v118 offset:14336
v_mul_f32 v63, v63, v25
v_mfma_f32_16x16x32_bf16 v[76:79], a[96:99], v[132:135], 0
ds_read_b64_tr_b16 a[80:81], v118 offset:16384
v_cvt_pk_bf16_f32 v52, v52, v53
v_mfma_f32_16x16x32_bf16 v[76:79], a[100:103], v[148:151], v[76:79]
ds_read_b64_tr_b16 a[82:83], v118 offset:18432
v_cvt_pk_bf16_f32 v53, v54, v55
v_mfma_f32_16x16x32_bf16 v[76:79], a[104:107], v[164:167], v[76:79]
ds_read_b64_tr_b16 a[84:85], v118 offset:20480
v_cvt_pk_bf16_f32 v54, v60, v61
v_mfma_f32_16x16x32_bf16 v[76:79], a[108:111], v[180:183], v[76:79]
ds_read_b64_tr_b16 a[86:87], v118 offset:22528
v_cvt_pk_bf16_f32 v55, v62, v63
v_mfma_f32_16x16x32_bf16 v[76:79], a[112:115], v[196:199], v[76:79]
ds_read_b64_tr_b16 a[88:89], v118 offset:24576
buffer_store_dwordx4 v[52:55], v1, s[4:7], s12 offen offset:1024 sc1
v_mfma_f32_16x16x32_bf16 v[76:79], a[116:119], v[212:215], v[76:79]
ds_read_b64_tr_b16 a[90:91], v118 offset:26624
v_mfma_f32_16x16x32_bf16 v[76:79], a[120:123], v[228:231], v[76:79]
ds_read_b64_tr_b16 a[92:93], v118 offset:28672
v_mul_f32 v64, v64, v24
v_mfma_f32_16x16x32_bf16 v[76:79], a[124:127], v[244:247], v[76:79]
s_waitcnt lgkmcnt(6)
ds_read_b64_tr_b16 a[94:95], v118 offset:30720
v_add_u32 v118, 32768, v118
v_mfma_f32_16x16x32_bf16 v[80:83], a[64:67], v[128:131], 0
ds_read_b64_tr_b16 a[96:97], v119 offset:0
v_mul_f32 v65, v65, v24
v_mfma_f32_16x16x32_bf16 v[80:83], a[68:71], v[144:147], v[80:83]
ds_read_b64_tr_b16 a[98:99], v119 offset:2048
v_mul_f32 v66, v66, v24
v_mfma_f32_16x16x32_bf16 v[80:83], a[72:75], v[160:163], v[80:83]
ds_read_b64_tr_b16 a[100:101], v119 offset:4096
v_mul_f32 v67, v67, v24
v_mfma_f32_16x16x32_bf16 v[80:83], a[76:79], v[176:179], v[80:83]
s_waitcnt lgkmcnt(6)
ds_read_b64_tr_b16 a[102:103], v119 offset:6144
v_mul_f32 v72, v72, v24
v_mfma_f32_16x16x32_bf16 v[80:83], a[80:83], v[192:195], v[80:83]
ds_read_b64_tr_b16 a[104:105], v119 offset:8192
v_mul_f32 v73, v73, v24
v_mfma_f32_16x16x32_bf16 v[80:83], a[84:87], v[208:211], v[80:83]
s_waitcnt lgkmcnt(6)
ds_read_b64_tr_b16 a[106:107], v119 offset:10240
v_mul_f32 v74, v74, v24
v_mfma_f32_16x16x32_bf16 v[80:83], a[88:91], v[224:227], v[80:83]
s_waitcnt lgkmcnt(6)
ds_read_b64_tr_b16 a[108:109], v119 offset:12288
v_mul_f32 v75, v75, v24
v_mfma_f32_16x16x32_bf16 v[80:83], a[92:95], v[240:243], v[80:83]
ds_read_b64_tr_b16 a[110:111], v119 offset:14336
v_cvt_pk_bf16_f32 v64, v64, v65
v_mfma_f32_16x16x32_bf16 v[84:87], a[64:67], v[132:135], 0
ds_read_b64_tr_b16 a[112:113], v119 offset:16384
v_cvt_pk_bf16_f32 v65, v66, v67
v_mfma_f32_16x16x32_bf16 v[84:87], a[68:71], v[148:151], v[84:87]
ds_read_b64_tr_b16 a[114:115], v119 offset:18432
v_cvt_pk_bf16_f32 v66, v72, v73
v_mfma_f32_16x16x32_bf16 v[84:87], a[72:75], v[164:167], v[84:87]
ds_read_b64_tr_b16 a[116:117], v119 offset:20480
v_cvt_pk_bf16_f32 v67, v74, v75
v_mfma_f32_16x16x32_bf16 v[84:87], a[76:79], v[180:183], v[84:87]
ds_read_b64_tr_b16 a[118:119], v119 offset:22528
buffer_store_dwordx4 v[64:67], v1, s[4:7], s8 offen offset:2048 sc1
v_mfma_f32_16x16x32_bf16 v[84:87], a[80:83], v[196:199], v[84:87]
ds_read_b64_tr_b16 a[120:121], v119 offset:24576
v_mul_f32 v68, v68, v25
v_mfma_f32_16x16x32_bf16 v[84:87], a[84:87], v[212:215], v[84:87]
ds_read_b64_tr_b16 a[122:123], v119 offset:26624
v_mul_f32 v69, v69, v25
v_mfma_f32_16x16x32_bf16 v[84:87], a[88:91], v[228:231], v[84:87]
ds_read_b64_tr_b16 a[124:125], v119 offset:28672
ds_read_b64_tr_b16 a[126:127], v119 offset:30720
v_mfma_f32_16x16x32_bf16 v[84:87], a[92:95], v[244:247], v[84:87]
s_waitcnt vmcnt(21) lgkmcnt(7)
s_barrier
v_add_u32 v119, 32768, v119
v_mfma_f32_16x16x32_bf16 v[88:91], a[96:99], v[128:131], 0
ds_read_b64_tr_b16 a[64:65], v116 offset:0
v_mul_f32 v70, v70, v25
v_mfma_f32_16x16x32_bf16 v[88:91], a[100:103], v[144:147], v[88:91]
ds_read_b64_tr_b16 a[66:67], v116 offset:2048
v_mul_f32 v71, v71, v25
v_mfma_f32_16x16x32_bf16 v[88:91], a[104:107], v[160:163], v[88:91]
ds_read_b64_tr_b16 a[68:69], v116 offset:4096
v_mul_f32 v76, v76, v25
v_mfma_f32_16x16x32_bf16 v[88:91], a[108:111], v[176:179], v[88:91]
s_waitcnt lgkmcnt(6)
ds_read_b64_tr_b16 a[70:71], v116 offset:6144
v_mul_f32 v77, v77, v25
v_mfma_f32_16x16x32_bf16 v[88:91], a[112:115], v[192:195], v[88:91]
ds_read_b64_tr_b16 a[72:73], v116 offset:8192
v_mul_f32 v78, v78, v25
v_mfma_f32_16x16x32_bf16 v[88:91], a[116:119], v[208:211], v[88:91]
s_waitcnt lgkmcnt(5)
ds_read_b64_tr_b16 a[74:75], v116 offset:10240
v_mul_f32 v79, v79, v25
v_mfma_f32_16x16x32_bf16 v[88:91], a[120:123], v[224:227], v[88:91]
ds_read_b64_tr_b16 a[76:77], v116 offset:12288
v_cvt_pk_bf16_f32 v68, v68, v69
v_mfma_f32_16x16x32_bf16 v[88:91], a[124:127], v[240:243], v[88:91]
ds_read_b64_tr_b16 a[78:79], v116 offset:14336
v_cvt_pk_bf16_f32 v69, v70, v71
v_mfma_f32_16x16x32_bf16 v[92:95], a[96:99], v[132:135], 0
ds_read_b64_tr_b16 a[80:81], v116 offset:16384
v_cvt_pk_bf16_f32 v70, v76, v77
v_mfma_f32_16x16x32_bf16 v[92:95], a[100:103], v[148:151], v[92:95]
ds_read_b64_tr_b16 a[82:83], v116 offset:18432
v_cvt_pk_bf16_f32 v71, v78, v79
v_mfma_f32_16x16x32_bf16 v[92:95], a[104:107], v[164:167], v[92:95]
ds_read_b64_tr_b16 a[84:85], v116 offset:20480
buffer_store_dwordx4 v[68:71], v1, s[4:7], s12 offen offset:2048 sc1
v_mfma_f32_16x16x32_bf16 v[92:95], a[108:111], v[180:183], v[92:95]
ds_read_b64_tr_b16 a[86:87], v116 offset:22528
v_mfma_f32_16x16x32_bf16 v[92:95], a[112:115], v[196:199], v[92:95]
ds_read_b64_tr_b16 a[88:89], v116 offset:24576
v_mfma_f32_16x16x32_bf16 v[92:95], a[116:119], v[212:215], v[92:95]
ds_read_b64_tr_b16 a[90:91], v116 offset:26624
v_mfma_f32_16x16x32_bf16 v[92:95], a[120:123], v[228:231], v[92:95]
ds_read_b64_tr_b16 a[92:93], v116 offset:28672
v_mfma_f32_16x16x32_bf16 v[92:95], a[124:127], v[244:247], v[92:95]
s_waitcnt lgkmcnt(6)
ds_read_b64_tr_b16 a[94:95], v116 offset:30720
v_add_u32 v116, 4294901760, v116
v_mfma_f32_16x16x32_bf16 v[32:35], a[64:67], v[128:131], 0
s_add_u32 m0, s18, 32768
ds_read_b64_tr_b16 a[96:97], v117 offset:0
v_mul_f32 v80, v80, v24
v_mfma_f32_16x16x32_bf16 v[32:35], a[68:71], v[144:147], v[32:35]
ds_read_b64_tr_b16 a[98:99], v117 offset:2048
buffer_load_dwordx4 v112, s[36:39], s81 offen offset:0 lds
v_mfma_f32_16x16x32_bf16 v[32:35], a[72:75], v[160:163], v[32:35]
ds_read_b64_tr_b16 a[100:101], v117 offset:4096
v_mul_f32 v81, v81, v24
v_mfma_f32_16x16x32_bf16 v[32:35], a[76:79], v[176:179], v[32:35]
s_waitcnt lgkmcnt(6)
ds_read_b64_tr_b16 a[102:103], v117 offset:6144
v_mul_f32 v82, v82, v24
v_mfma_f32_16x16x32_bf16 v[32:35], a[80:83], v[192:195], v[32:35]
ds_read_b64_tr_b16 a[104:105], v117 offset:8192
v_mul_f32 v83, v83, v24
v_mfma_f32_16x16x32_bf16 v[32:35], a[84:87], v[208:211], v[32:35]
s_waitcnt lgkmcnt(6)
ds_read_b64_tr_b16 a[106:107], v117 offset:10240
v_mul_f32 v88, v88, v24
v_mfma_f32_16x16x32_bf16 v[32:35], a[88:91], v[224:227], v[32:35]
s_waitcnt lgkmcnt(6)
ds_read_b64_tr_b16 a[108:109], v117 offset:12288
v_mul_f32 v89, v89, v24
v_mfma_f32_16x16x32_bf16 v[32:35], a[92:95], v[240:243], v[32:35]
ds_read_b64_tr_b16 a[110:111], v117 offset:14336
v_mul_f32 v90, v90, v24
v_mfma_f32_16x16x32_bf16 v[36:39], a[64:67], v[132:135], 0
ds_read_b64_tr_b16 a[112:113], v117 offset:16384
buffer_load_dwordx4 v113, s[36:39], s81 offen offset:1024 lds
v_mfma_f32_16x16x32_bf16 v[36:39], a[68:71], v[148:151], v[36:39]
ds_read_b64_tr_b16 a[114:115], v117 offset:18432
v_mul_f32 v91, v91, v24
v_mfma_f32_16x16x32_bf16 v[36:39], a[72:75], v[164:167], v[36:39]
ds_read_b64_tr_b16 a[116:117], v117 offset:20480
v_cvt_pk_bf16_f32 v80, v80, v81
v_mfma_f32_16x16x32_bf16 v[36:39], a[76:79], v[180:183], v[36:39]
ds_read_b64_tr_b16 a[118:119], v117 offset:22528
v_cvt_pk_bf16_f32 v81, v82, v83
v_mfma_f32_16x16x32_bf16 v[36:39], a[80:83], v[196:199], v[36:39]
ds_read_b64_tr_b16 a[120:121], v117 offset:24576
v_cvt_pk_bf16_f32 v82, v88, v89
v_mfma_f32_16x16x32_bf16 v[36:39], a[84:87], v[212:215], v[36:39]
ds_read_b64_tr_b16 a[122:123], v117 offset:26624
v_cvt_pk_bf16_f32 v83, v90, v91
v_mfma_f32_16x16x32_bf16 v[36:39], a[88:91], v[228:231], v[36:39]
ds_read_b64_tr_b16 a[124:125], v117 offset:28672
buffer_store_dwordx4 v[80:83], v1, s[4:7], s8 offen offset:3072 sc1
v_mfma_f32_16x16x32_bf16 v[36:39], a[92:95], v[244:247], v[36:39]
s_waitcnt lgkmcnt(6)
ds_read_b64_tr_b16 a[126:127], v117 offset:30720
v_add_u32 v117, 4294901760, v117
v_mfma_f32_16x16x32_bf16 v[40:43], a[96:99], v[128:131], 0
ds_read_b64_tr_b16 a[64:65], v118 offset:0
buffer_load_dwordx4 v114, s[36:39], s81 offen offset:2048 lds
v_mfma_f32_16x16x32_bf16 v[40:43], a[100:103], v[144:147], v[40:43]
ds_read_b64_tr_b16 a[66:67], v118 offset:2048
v_mul_f32 v84, v84, v25
v_mfma_f32_16x16x32_bf16 v[40:43], a[104:107], v[160:163], v[40:43]
ds_read_b64_tr_b16 a[68:69], v118 offset:4096
v_mul_f32 v85, v85, v25
v_mfma_f32_16x16x32_bf16 v[40:43], a[108:111], v[176:179], v[40:43]
s_waitcnt lgkmcnt(6)
ds_read_b64_tr_b16 a[70:71], v118 offset:6144
v_mul_f32 v86, v86, v25
v_mfma_f32_16x16x32_bf16 v[40:43], a[112:115], v[192:195], v[40:43]
ds_read_b64_tr_b16 a[72:73], v118 offset:8192
v_mul_f32 v87, v87, v25
v_mfma_f32_16x16x32_bf16 v[40:43], a[116:119], v[208:211], v[40:43]
s_waitcnt lgkmcnt(6)
ds_read_b64_tr_b16 a[74:75], v118 offset:10240
v_mul_f32 v92, v92, v25
v_mfma_f32_16x16x32_bf16 v[40:43], a[120:123], v[224:227], v[40:43]
s_waitcnt lgkmcnt(6)
ds_read_b64_tr_b16 a[76:77], v118 offset:12288
v_mul_f32 v93, v93, v25
v_mfma_f32_16x16x32_bf16 v[40:43], a[124:127], v[240:243], v[40:43]
ds_read_b64_tr_b16 a[78:79], v118 offset:14336
buffer_load_dwordx4 v115, s[36:39], s81 offen offset:3072 lds
v_mfma_f32_16x16x32_bf16 v[44:47], a[96:99], v[132:135], 0
ds_read_b64_tr_b16 a[80:81], v118 offset:16384
v_mul_f32 v94, v94, v25
v_mfma_f32_16x16x32_bf16 v[44:47], a[100:103], v[148:151], v[44:47]
ds_read_b64_tr_b16 a[82:83], v118 offset:18432
v_mul_f32 v95, v95, v25
v_mfma_f32_16x16x32_bf16 v[44:47], a[104:107], v[164:167], v[44:47]
ds_read_b64_tr_b16 a[84:85], v118 offset:20480
v_cvt_pk_bf16_f32 v84, v84, v85
v_mfma_f32_16x16x32_bf16 v[44:47], a[108:111], v[180:183], v[44:47]
ds_read_b64_tr_b16 a[86:87], v118 offset:22528
v_cvt_pk_bf16_f32 v85, v86, v87
v_mfma_f32_16x16x32_bf16 v[44:47], a[112:115], v[196:199], v[44:47]
ds_read_b64_tr_b16 a[88:89], v118 offset:24576
v_cvt_pk_bf16_f32 v86, v92, v93
v_mfma_f32_16x16x32_bf16 v[44:47], a[116:119], v[212:215], v[44:47]
s_add_u32 s81, s81, 28672
s_add_u32 m0, s18, 36864
ds_read_b64_tr_b16 a[90:91], v118 offset:26624
v_mfma_f32_16x16x32_bf16 v[44:47], a[120:123], v[228:231], v[44:47]
ds_read_b64_tr_b16 a[92:93], v118 offset:28672
buffer_load_dwordx4 v112, s[36:39], s81 offen offset:0 lds
v_mfma_f32_16x16x32_bf16 v[44:47], a[124:127], v[244:247], v[44:47]
s_waitcnt lgkmcnt(6)
ds_read_b64_tr_b16 a[94:95], v118 offset:30720
v_add_u32 v118, 4294901760, v118
v_mfma_f32_16x16x32_bf16 v[48:51], a[64:67], v[128:131], 0
ds_read_b64_tr_b16 a[96:97], v119 offset:0
v_cvt_pk_bf16_f32 v87, v94, v95
v_mfma_f32_16x16x32_bf16 v[48:51], a[68:71], v[144:147], v[48:51]
ds_read_b64_tr_b16 a[98:99], v119 offset:2048
buffer_store_dwordx4 v[84:87], v1, s[4:7], s12 offen offset:3072 sc1
v_mfma_f32_16x16x32_bf16 v[48:51], a[72:75], v[160:163], v[48:51]
s_add_u32 s8, s8, 4096
s_add_u32 s12, s12, 4096
ds_read_b64_tr_b16 a[100:101], v119 offset:4096
v_mfma_f32_16x16x32_bf16 v[48:51], a[76:79], v[176:179], v[48:51]
s_waitcnt lgkmcnt(6)
ds_read_b64_tr_b16 a[102:103], v119 offset:6144
v_mul_f32 v32, v32, v24
v_mfma_f32_16x16x32_bf16 v[48:51], a[80:83], v[192:195], v[48:51]
ds_read_b64_tr_b16 a[104:105], v119 offset:8192
v_mul_f32 v33, v33, v24
v_mfma_f32_16x16x32_bf16 v[48:51], a[84:87], v[208:211], v[48:51]
s_waitcnt lgkmcnt(6)
ds_read_b64_tr_b16 a[106:107], v119 offset:10240
buffer_load_dwordx4 v113, s[36:39], s81 offen offset:1024 lds
v_mfma_f32_16x16x32_bf16 v[48:51], a[88:91], v[224:227], v[48:51]
s_waitcnt lgkmcnt(6)
ds_read_b64_tr_b16 a[108:109], v119 offset:12288
v_mul_f32 v34, v34, v24
v_mfma_f32_16x16x32_bf16 v[48:51], a[92:95], v[240:243], v[48:51]
ds_read_b64_tr_b16 a[110:111], v119 offset:14336
v_mul_f32 v35, v35, v24
v_mfma_f32_16x16x32_bf16 v[52:55], a[64:67], v[132:135], 0
ds_read_b64_tr_b16 a[112:113], v119 offset:16384
v_mul_f32 v40, v40, v24
v_mfma_f32_16x16x32_bf16 v[52:55], a[68:71], v[148:151], v[52:55]
ds_read_b64_tr_b16 a[114:115], v119 offset:18432
v_mul_f32 v41, v41, v24
v_mfma_f32_16x16x32_bf16 v[52:55], a[72:75], v[164:167], v[52:55]
ds_read_b64_tr_b16 a[116:117], v119 offset:20480
v_mul_f32 v42, v42, v24
v_mfma_f32_16x16x32_bf16 v[52:55], a[76:79], v[180:183], v[52:55]
ds_read_b64_tr_b16 a[118:119], v119 offset:22528
v_mul_f32 v43, v43, v24
v_mfma_f32_16x16x32_bf16 v[52:55], a[80:83], v[196:199], v[52:55]
ds_read_b64_tr_b16 a[120:121], v119 offset:24576
buffer_load_dwordx4 v114, s[36:39], s81 offen offset:2048 lds
v_mfma_f32_16x16x32_bf16 v[52:55], a[84:87], v[212:215], v[52:55]
ds_read_b64_tr_b16 a[122:123], v119 offset:26624
v_cvt_pk_bf16_f32 v32, v32, v33
v_mfma_f32_16x16x32_bf16 v[52:55], a[88:91], v[228:231], v[52:55]
ds_read_b64_tr_b16 a[124:125], v119 offset:28672
ds_read_b64_tr_b16 a[126:127], v119 offset:30720
v_mfma_f32_16x16x32_bf16 v[52:55], a[92:95], v[244:247], v[52:55]
s_waitcnt vmcnt(23) lgkmcnt(7)
s_barrier
v_add_u32 v119, 4294901760, v119
v_mfma_f32_16x16x32_bf16 v[56:59], a[96:99], v[128:131], 0
ds_read_b64_tr_b16 a[64:65], v116 offset:0
v_cvt_pk_bf16_f32 v33, v34, v35
v_mfma_f32_16x16x32_bf16 v[56:59], a[100:103], v[144:147], v[56:59]
ds_read_b64_tr_b16 a[66:67], v116 offset:2048
v_cvt_pk_bf16_f32 v34, v40, v41
v_mfma_f32_16x16x32_bf16 v[56:59], a[104:107], v[160:163], v[56:59]
ds_read_b64_tr_b16 a[68:69], v116 offset:4096
v_cvt_pk_bf16_f32 v35, v42, v43
v_mfma_f32_16x16x32_bf16 v[56:59], a[108:111], v[176:179], v[56:59]
s_waitcnt lgkmcnt(6)
ds_read_b64_tr_b16 a[70:71], v116 offset:6144
buffer_load_dwordx4 v115, s[36:39], s81 offen offset:3072 lds
v_mfma_f32_16x16x32_bf16 v[56:59], a[112:115], v[192:195], v[56:59]
ds_read_b64_tr_b16 a[72:73], v116 offset:8192
buffer_store_dwordx4 v[32:35], v1, s[4:7], s8 offen offset:0 sc1
v_mfma_f32_16x16x32_bf16 v[56:59], a[116:119], v[208:211], v[56:59]
s_waitcnt lgkmcnt(5)
ds_read_b64_tr_b16 a[74:75], v116 offset:10240
v_mul_f32 v36, v36, v25
v_mfma_f32_16x16x32_bf16 v[56:59], a[120:123], v[224:227], v[56:59]
ds_read_b64_tr_b16 a[76:77], v116 offset:12288
v_mul_f32 v37, v37, v25
v_mfma_f32_16x16x32_bf16 v[56:59], a[124:127], v[240:243], v[56:59]
ds_read_b64_tr_b16 a[78:79], v116 offset:14336
v_mul_f32 v38, v38, v25
v_mfma_f32_16x16x32_bf16 v[60:63], a[96:99], v[132:135], 0
ds_read_b64_tr_b16 a[80:81], v116 offset:16384
v_mul_f32 v39, v39, v25
v_mfma_f32_16x16x32_bf16 v[60:63], a[100:103], v[148:151], v[60:63]
s_sub_u32 s81, s81, 28544
ds_read_b64_tr_b16 a[82:83], v116 offset:18432
v_mul_f32 v44, v44, v25
v_mfma_f32_16x16x32_bf16 v[60:63], a[104:107], v[164:167], v[60:63]
ds_read_b64_tr_b16 a[84:85], v116 offset:20480
v_mul_f32 v45, v45, v25
v_mfma_f32_16x16x32_bf16 v[60:63], a[108:111], v[180:183], v[60:63]
ds_read_b64_tr_b16 a[86:87], v116 offset:22528
v_mul_f32 v46, v46, v25
v_mfma_f32_16x16x32_bf16 v[60:63], a[112:115], v[196:199], v[60:63]
PAD_14:
s_cbranch_execz M_tret
ds_read_b64_tr_b16 a[88:89], v116 offset:24576
v_mul_f32 v47, v47, v25
v_mfma_f32_16x16x32_bf16 v[60:63], a[116:119], v[212:215], v[60:63]
ds_read_b64_tr_b16 a[90:91], v116 offset:26624
v_cvt_pk_bf16_f32 v36, v36, v37
v_mfma_f32_16x16x32_bf16 v[60:63], a[120:123], v[228:231], v[60:63]
ds_read_b64_tr_b16 a[92:93], v116 offset:28672
v_cvt_pk_bf16_f32 v37, v38, v39
v_mfma_f32_16x16x32_bf16 v[60:63], a[124:127], v[244:247], v[60:63]
s_waitcnt lgkmcnt(6)
ds_read_b64_tr_b16 a[94:95], v116 offset:30720
v_add_u32 v116, 4294901760, v116
v_mfma_f32_16x16x32_bf16 v[64:67], a[64:67], v[128:131], 0
s_add_u32 m0, s18, 98304
ds_read_b64_tr_b16 a[96:97], v117 offset:0
v_cvt_pk_bf16_f32 v38, v44, v45
v_mfma_f32_16x16x32_bf16 v[64:67], a[68:71], v[144:147], v[64:67]
ds_read_b64_tr_b16 a[98:99], v117 offset:2048
buffer_load_dwordx4 v112, s[36:39], s81 offen offset:0 lds
v_mfma_f32_16x16x32_bf16 v[64:67], a[72:75], v[160:163], v[64:67]
ds_read_b64_tr_b16 a[100:101], v117 offset:4096
v_cvt_pk_bf16_f32 v39, v46, v47
v_mfma_f32_16x16x32_bf16 v[64:67], a[76:79], v[176:179], v[64:67]
s_waitcnt lgkmcnt(6)
ds_read_b64_tr_b16 a[102:103], v117 offset:6144
buffer_store_dwordx4 v[36:39], v1, s[4:7], s12 offen offset:0 sc1
v_mfma_f32_16x16x32_bf16 v[64:67], a[80:83], v[192:195], v[64:67]
ds_read_b64_tr_b16 a[104:105], v117 offset:8192
v_mul_f32 v48, v48, v24
v_mfma_f32_16x16x32_bf16 v[64:67], a[84:87], v[208:211], v[64:67]
s_waitcnt lgkmcnt(6)
ds_read_b64_tr_b16 a[106:107], v117 offset:10240
v_mul_f32 v49, v49, v24
v_mfma_f32_16x16x32_bf16 v[64:67], a[88:91], v[224:227], v[64:67]
s_waitcnt lgkmcnt(6)
ds_read_b64_tr_b16 a[108:109], v117 offset:12288
v_mul_f32 v50, v50, v24
v_mfma_f32_16x16x32_bf16 v[64:67], a[92:95], v[240:243], v[64:67]
ds_read_b64_tr_b16 a[110:111], v117 offset:14336
v_mul_f32 v51, v51, v24
v_mfma_f32_16x16x32_bf16 v[68:71], a[64:67], v[132:135], 0
ds_read_b64_tr_b16 a[112:113], v117 offset:16384
buffer_load_dwordx4 v113, s[36:39], s81 offen offset:1024 lds
v_mfma_f32_16x16x32_bf16 v[68:71], a[68:71], v[148:151], v[68:71]
ds_read_b64_tr_b16 a[114:115], v117 offset:18432
v_mul_f32 v56, v56, v24
v_mfma_f32_16x16x32_bf16 v[68:71], a[72:75], v[164:167], v[68:71]
ds_read_b64_tr_b16 a[116:117], v117 offset:20480
v_mul_f32 v57, v57, v24
v_mfma_f32_16x16x32_bf16 v[68:71], a[76:79], v[180:183], v[68:71]
ds_read_b64_tr_b16 a[118:119], v117 offset:22528
v_mul_f32 v58, v58, v24
v_mfma_f32_16x16x32_bf16 v[68:71], a[80:83], v[196:199], v[68:71]
ds_read_b64_tr_b16 a[120:121], v117 offset:24576
v_mul_f32 v59, v59, v24
v_mfma_f32_16x16x32_bf16 v[68:71], a[84:87], v[212:215], v[68:71]
ds_read_b64_tr_b16 a[122:123], v117 offset:26624
v_cvt_pk_bf16_f32 v48, v48, v49
v_mfma_f32_16x16x32_bf16 v[68:71], a[88:91], v[228:231], v[68:71]
ds_read_b64_tr_b16 a[124:125], v117 offset:28672
v_cvt_pk_bf16_f32 v49, v50, v51
v_mfma_f32_16x16x32_bf16 v[68:71], a[92:95], v[244:247], v[68:71]
s_waitcnt lgkmcnt(6)
ds_read_b64_tr_b16 a[126:127], v117 offset:30720
v_add_u32 v117, 4294901760, v117
v_mfma_f32_16x16x32_bf16 v[72:75], a[96:99], v[128:131], 0
ds_read_b64_tr_b16 a[64:65], v118 offset:0
buffer_load_dwordx4 v114, s[36:39], s81 offen offset:2048 lds
v_mfma_f32_16x16x32_bf16 v[72:75], a[100:103], v[144:147], v[72:75]
ds_read_b64_tr_b16 a[66:67], v118 offset:2048
v_cvt_pk_bf16_f32 v50, v56, v57
v_mfma_f32_16x16x32_bf16 v[72:75], a[104:107], v[160:163], v[72:75]
ds_read_b64_tr_b16 a[68:69], v118 offset:4096
v_cvt_pk_bf16_f32 v51, v58, v59
v_mfma_f32_16x16x32_bf16 v[72:75], a[108:111], v[176:179], v[72:75]
s_waitcnt lgkmcnt(6)
ds_read_b64_tr_b16 a[70:71], v118 offset:6144
buffer_store_dwordx4 v[48:51], v1, s[4:7], s8 offen offset:1024 sc1
v_mfma_f32_16x16x32_bf16 v[72:75], a[112:115], v[192:195], v[72:75]
ds_read_b64_tr_b16 a[72:73], v118 offset:8192
v_mul_f32 v52, v52, v25
v_mfma_f32_16x16x32_bf16 v[72:75], a[116:119], v[208:211], v[72:75]
s_waitcnt lgkmcnt(6)
ds_read_b64_tr_b16 a[74:75], v118 offset:10240
v_mul_f32 v53, v53, v25
v_mfma_f32_16x16x32_bf16 v[72:75], a[120:123], v[224:227], v[72:75]
s_waitcnt lgkmcnt(6)
ds_read_b64_tr_b16 a[76:77], v118 offset:12288
v_mul_f32 v54, v54, v25
v_mfma_f32_16x16x32_bf16 v[72:75], a[124:127], v[240:243], v[72:75]
ds_read_b64_tr_b16 a[78:79], v118 offset:14336
buffer_load_dwordx4 v115, s[36:39], s81 offen offset:3072 lds
v_mfma_f32_16x16x32_bf16 v[76:79], a[96:99], v[132:135], 0
ds_read_b64_tr_b16 a[80:81], v118 offset:16384
v_mul_f32 v55, v55, v25
v_mfma_f32_16x16x32_bf16 v[76:79], a[100:103], v[148:151], v[76:79]
ds_read_b64_tr_b16 a[82:83], v118 offset:18432
v_mul_f32 v60, v60, v25
v_mfma_f32_16x16x32_bf16 v[76:79], a[104:107], v[164:167], v[76:79]
ds_read_b64_tr_b16 a[84:85], v118 offset:20480
v_mul_f32 v61, v61, v25
v_mfma_f32_16x16x32_bf16 v[76:79], a[108:111], v[180:183], v[76:79]
ds_read_b64_tr_b16 a[86:87], v118 offset:22528
v_mul_f32 v62, v62, v25
v_mfma_f32_16x16x32_bf16 v[76:79], a[112:115], v[196:199], v[76:79]
ds_read_b64_tr_b16 a[88:89], v118 offset:24576
v_mul_f32 v63, v63, v25
v_mfma_f32_16x16x32_bf16 v[76:79], a[116:119], v[212:215], v[76:79]
s_add_u32 s81, s81, 28672
s_add_u32 m0, s18, 102400
ds_read_b64_tr_b16 a[90:91], v118 offset:26624
v_mfma_f32_16x16x32_bf16 v[76:79], a[120:123], v[228:231], v[76:79]
ds_read_b64_tr_b16 a[92:93], v118 offset:28672
buffer_load_dwordx4 v112, s[36:39], s81 offen offset:0 lds
v_mfma_f32_16x16x32_bf16 v[76:79], a[124:127], v[244:247], v[76:79]
s_waitcnt lgkmcnt(6)
ds_read_b64_tr_b16 a[94:95], v118 offset:30720
v_add_u32 v118, 4294901760, v118
v_mfma_f32_16x16x32_bf16 v[80:83], a[64:67], v[128:131], 0
ds_read_b64_tr_b16 a[96:97], v119 offset:0
v_cvt_pk_bf16_f32 v52, v52, v53
v_mfma_f32_16x16x32_bf16 v[80:83], a[68:71], v[144:147], v[80:83]
ds_read_b64_tr_b16 a[98:99], v119 offset:2048
v_cvt_pk_bf16_f32 v53, v54, v55
v_mfma_f32_16x16x32_bf16 v[80:83], a[72:75], v[160:163], v[80:83]
ds_read_b64_tr_b16 a[100:101], v119 offset:4096
v_cvt_pk_bf16_f32 v54, v60, v61
v_mfma_f32_16x16x32_bf16 v[80:83], a[76:79], v[176:179], v[80:83]
s_waitcnt lgkmcnt(6)
ds_read_b64_tr_b16 a[102:103], v119 offset:6144
v_cvt_pk_bf16_f32 v55, v62, v63
v_mfma_f32_16x16x32_bf16 v[80:83], a[80:83], v[192:195], v[80:83]
ds_read_b64_tr_b16 a[104:105], v119 offset:8192
buffer_store_dwordx4 v[52:55], v1, s[4:7], s12 offen offset:1024 sc1
v_mfma_f32_16x16x32_bf16 v[80:83], a[84:87], v[208:211], v[80:83]
s_waitcnt lgkmcnt(6)
ds_read_b64_tr_b16 a[106:107], v119 offset:10240
buffer_load_dwordx4 v113, s[36:39], s81 offen offset:1024 lds
v_mfma_f32_16x16x32_bf16 v[80:83], a[88:91], v[224:227], v[80:83]
s_waitcnt lgkmcnt(6)
ds_read_b64_tr_b16 a[108:109], v119 offset:12288
v_mul_f32 v64, v64, v24
v_mfma_f32_16x16x32_bf16 v[80:83], a[92:95], v[240:243], v[80:83]
ds_read_b64_tr_b16 a[110:111], v119 offset:14336
v_mul_f32 v65, v65, v24
v_mfma_f32_16x16x32_bf16 v[84:87], a[64:67], v[132:135], 0
ds_read_b64_tr_b16 a[112:113], v119 offset:16384
v_mul_f32 v66, v66, v24
v_mfma_f32_16x16x32_bf16 v[84:87], a[68:71], v[148:151], v[84:87]
ds_read_b64_tr_b16 a[114:115], v119 offset:18432
v_mul_f32 v67, v67, v24
v_mfma_f32_16x16x32_bf16 v[84:87], a[72:75], v[164:167], v[84:87]
ds_read_b64_tr_b16 a[116:117], v119 offset:20480
v_mul_f32 v72, v72, v24
v_mfma_f32_16x16x32_bf16 v[84:87], a[76:79], v[180:183], v[84:87]
ds_read_b64_tr_b16 a[118:119], v119 offset:22528
v_mul_f32 v73, v73, v24
v_mfma_f32_16x16x32_bf16 v[84:87], a[80:83], v[196:199], v[84:87]
ds_read_b64_tr_b16 a[120:121], v119 offset:24576
buffer_load_dwordx4 v114, s[36:39], s81 offen offset:2048 lds
v_mfma_f32_16x16x32_bf16 v[84:87], a[84:87], v[212:215], v[84:87]
ds_read_b64_tr_b16 a[122:123], v119 offset:26624
v_mul_f32 v74, v74, v24
v_mfma_f32_16x16x32_bf16 v[84:87], a[88:91], v[228:231], v[84:87]
ds_read_b64_tr_b16 a[124:125], v119 offset:28672
ds_read_b64_tr_b16 a[126:127], v119 offset:30720
v_mfma_f32_16x16x32_bf16 v[84:87], a[92:95], v[244:247], v[84:87]
s_waitcnt vmcnt(27) lgkmcnt(7)
s_barrier
v_add_u32 v119, 4294901760, v119
v_mfma_f32_16x16x32_bf16 v[88:91], a[96:99], v[128:131], 0
ds_read_b64_tr_b16 a[64:65], v116 offset:0
v_mul_f32 v75, v75, v24
v_mfma_f32_16x16x32_bf16 v[88:91], a[100:103], v[144:147], v[88:91]
ds_read_b64_tr_b16 a[66:67], v116 offset:2048
v_cvt_pk_bf16_f32 v64, v64, v65
v_mfma_f32_16x16x32_bf16 v[88:91], a[104:107], v[160:163], v[88:91]
ds_read_b64_tr_b16 a[68:69], v116 offset:4096
v_cvt_pk_bf16_f32 v65, v66, v67
v_mfma_f32_16x16x32_bf16 v[88:91], a[108:111], v[176:179], v[88:91]
s_waitcnt lgkmcnt(6)
ds_read_b64_tr_b16 a[70:71], v116 offset:6144
buffer_load_dwordx4 v115, s[36:39], s81 offen offset:3072 lds
v_mfma_f32_16x16x32_bf16 v[88:91], a[112:115], v[192:195], v[88:91]
ds_read_b64_tr_b16 a[72:73], v116 offset:8192
v_cvt_pk_bf16_f32 v66, v72, v73
v_mfma_f32_16x16x32_bf16 v[88:91], a[116:119], v[208:211], v[88:91]
s_waitcnt lgkmcnt(5)
ds_read_b64_tr_b16 a[74:75], v116 offset:10240
v_cvt_pk_bf16_f32 v67, v74, v75
v_mfma_f32_16x16x32_bf16 v[88:91], a[120:123], v[224:227], v[88:91]
ds_read_b64_tr_b16 a[76:77], v116 offset:12288
buffer_store_dwordx4 v[64:67], v1, s[4:7], s8 offen offset:2048 sc1
v_mfma_f32_16x16x32_bf16 v[88:91], a[124:127], v[240:243], v[88:91]
ds_read_b64_tr_b16 a[78:79], v116 offset:14336
v_mul_f32 v68, v68, v25
v_mfma_f32_16x16x32_bf16 v[92:95], a[96:99], v[132:135], 0
ds_read_b64_tr_b16 a[80:81], v116 offset:16384
v_mul_f32 v69, v69, v25
v_mfma_f32_16x16x32_bf16 v[92:95], a[100:103], v[148:151], v[92:95]
s_sub_u32 s81, s81, 28544
ds_read_b64_tr_b16 a[82:83], v116 offset:18432
v_mul_f32 v70, v70, v25
v_mfma_f32_16x16x32_bf16 v[92:95], a[104:107], v[164:167], v[92:95]
ds_read_b64_tr_b16 a[84:85], v116 offset:20480
v_mul_f32 v71, v71, v25
v_mfma_f32_16x16x32_bf16 v[92:95], a[108:111], v[180:183], v[92:95]
ds_read_b64_tr_b16 a[86:87], v116 offset:22528
v_mul_f32 v76, v76, v25
v_mfma_f32_16x16x32_bf16 v[92:95], a[112:115], v[196:199], v[92:95]
ds_read_b64_tr_b16 a[88:89], v116 offset:24576
v_mul_f32 v77, v77, v25
v_mfma_f32_16x16x32_bf16 v[92:95], a[116:119], v[212:215], v[92:95]
ds_read_b64_tr_b16 a[90:91], v116 offset:26624
v_mul_f32 v78, v78, v25
v_mfma_f32_16x16x32_bf16 v[92:95], a[120:123], v[228:231], v[92:95]
ds_read_b64_tr_b16 a[92:93], v116 offset:28672
v_mul_f32 v79, v79, v25
v_mfma_f32_16x16x32_bf16 v[92:95], a[124:127], v[244:247], v[92:95]
s_waitcnt lgkmcnt(6)
ds_read_b64_tr_b16 a[94:95], v116 offset:30720
v_add_u32 v116, 32768, v116
v_mfma_f32_16x16x32_bf16 v[32:35], a[64:67], v[128:131], 0
ds_read_b64_tr_b16 a[96:97], v117 offset:0
v_cvt_pk_bf16_f32 v68, v68, v69
v_mfma_f32_16x16x32_bf16 v[32:35], a[68:71], v[144:147], v[32:35]
ds_read_b64_tr_b16 a[98:99], v117 offset:2048
v_cvt_pk_bf16_f32 v69, v70, v71
v_mfma_f32_16x16x32_bf16 v[32:35], a[72:75], v[160:163], v[32:35]
ds_read_b64_tr_b16 a[100:101], v117 offset:4096
v_cvt_pk_bf16_f32 v70, v76, v77
v_mfma_f32_16x16x32_bf16 v[32:35], a[76:79], v[176:179], v[32:35]
s_waitcnt lgkmcnt(6)
ds_read_b64_tr_b16 a[102:103], v117 offset:6144
v_cvt_pk_bf16_f32 v71, v78, v79
v_mfma_f32_16x16x32_bf16 v[32:35], a[80:83], v[192:195], v[32:35]
ds_read_b64_tr_b16 a[104:105], v117 offset:8192
buffer_store_dwordx4 v[68:71], v1, s[4:7], s12 offen offset:2048 sc1
v_mfma_f32_16x16x32_bf16 v[32:35], a[84:87], v[208:211], v[32:35]
s_waitcnt lgkmcnt(6)
ds_read_b64_tr_b16 a[106:107], v117 offset:10240
v_mul_f32 v80, v80, v24
v_mfma_f32_16x16x32_bf16 v[32:35], a[88:91], v[224:227], v[32:35]
s_waitcnt lgkmcnt(6)
ds_read_b64_tr_b16 a[108:109], v117 offset:12288
v_mul_f32 v81, v81, v24
v_mfma_f32_16x16x32_bf16 v[32:35], a[92:95], v[240:243], v[32:35]
ds_read_b64_tr_b16 a[110:111], v117 offset:14336
v_mul_f32 v82, v82, v24
v_mfma_f32_16x16x32_bf16 v[36:39], a[64:67], v[132:135], 0
ds_read_b64_tr_b16 a[112:113], v117 offset:16384
v_mul_f32 v83, v83, v24
v_mfma_f32_16x16x32_bf16 v[36:39], a[68:71], v[148:151], v[36:39]
ds_read_b64_tr_b16 a[114:115], v117 offset:18432
v_mul_f32 v88, v88, v24
v_mfma_f32_16x16x32_bf16 v[36:39], a[72:75], v[164:167], v[36:39]
ds_read_b64_tr_b16 a[116:117], v117 offset:20480
v_mul_f32 v89, v89, v24
v_mfma_f32_16x16x32_bf16 v[36:39], a[76:79], v[180:183], v[36:39]
ds_read_b64_tr_b16 a[118:119], v117 offset:22528
v_mul_f32 v90, v90, v24
v_mfma_f32_16x16x32_bf16 v[36:39], a[80:83], v[196:199], v[36:39]
ds_read_b64_tr_b16 a[120:121], v117 offset:24576
v_mul_f32 v91, v91, v24
v_mfma_f32_16x16x32_bf16 v[36:39], a[84:87], v[212:215], v[36:39]
ds_read_b64_tr_b16 a[122:123], v117 offset:26624
v_cvt_pk_bf16_f32 v80, v80, v81
v_mfma_f32_16x16x32_bf16 v[36:39], a[88:91], v[228:231], v[36:39]
ds_read_b64_tr_b16 a[124:125], v117 offset:28672
v_cvt_pk_bf16_f32 v81, v82, v83
v_mfma_f32_16x16x32_bf16 v[36:39], a[92:95], v[244:247], v[36:39]
s_waitcnt lgkmcnt(6)
ds_read_b64_tr_b16 a[126:127], v117 offset:30720
v_add_u32 v117, 32768, v117
v_mfma_f32_16x16x32_bf16 v[40:43], a[96:99], v[128:131], 0
ds_read_b64_tr_b16 a[64:65], v118 offset:0
v_cvt_pk_bf16_f32 v82, v88, v89
v_mfma_f32_16x16x32_bf16 v[40:43], a[100:103], v[144:147], v[40:43]
ds_read_b64_tr_b16 a[66:67], v118 offset:2048
v_cvt_pk_bf16_f32 v83, v90, v91
v_mfma_f32_16x16x32_bf16 v[40:43], a[104:107], v[160:163], v[40:43]
ds_read_b64_tr_b16 a[68:69], v118 offset:4096
buffer_store_dwordx4 v[80:83], v1, s[4:7], s8 offen offset:3072 sc1
v_mfma_f32_16x16x32_bf16 v[40:43], a[108:111], v[176:179], v[40:43]
s_waitcnt lgkmcnt(6)
ds_read_b64_tr_b16 a[70:71], v118 offset:6144
v_mul_f32 v84, v84, v25
v_mfma_f32_16x16x32_bf16 v[40:43], a[112:115], v[192:195], v[40:43]
ds_read_b64_tr_b16 a[72:73], v118 offset:8192
v_mul_f32 v85, v85, v25
v_mfma_f32_16x16x32_bf16 v[40:43], a[116:119], v[208:211], v[40:43]
s_waitcnt lgkmcnt(6)
ds_read_b64_tr_b16 a[74:75], v118 offset:10240
v_mul_f32 v86, v86, v25
v_mfma_f32_16x16x32_bf16 v[40:43], a[120:123], v[224:227], v[40:43]
s_waitcnt lgkmcnt(6)
ds_read_b64_tr_b16 a[76:77], v118 offset:12288
v_mul_f32 v87, v87, v25
v_mfma_f32_16x16x32_bf16 v[40:43], a[124:127], v[240:243], v[40:43]
ds_read_b64_tr_b16 a[78:79], v118 offset:14336
v_mul_f32 v92, v92, v25
v_mfma_f32_16x16x32_bf16 v[44:47], a[96:99], v[132:135], 0
ds_read_b64_tr_b16 a[80:81], v118 offset:16384
v_mul_f32 v93, v93, v25
v_mfma_f32_16x16x32_bf16 v[44:47], a[100:103], v[148:151], v[44:47]
ds_read_b64_tr_b16 a[82:83], v118 offset:18432
v_mul_f32 v94, v94, v25
v_mfma_f32_16x16x32_bf16 v[44:47], a[104:107], v[164:167], v[44:47]
ds_read_b64_tr_b16 a[84:85], v118 offset:20480
v_mul_f32 v95, v95, v25
v_mfma_f32_16x16x32_bf16 v[44:47], a[108:111], v[180:183], v[44:47]
ds_read_b64_tr_b16 a[86:87], v118 offset:22528
v_cvt_pk_bf16_f32 v84, v84, v85
v_mfma_f32_16x16x32_bf16 v[44:47], a[112:115], v[196:199], v[44:47]
ds_read_b64_tr_b16 a[88:89], v118 offset:24576
v_cvt_pk_bf16_f32 v85, v86, v87
v_mfma_f32_16x16x32_bf16 v[44:47], a[116:119], v[212:215], v[44:47]
ds_read_b64_tr_b16 a[90:91], v118 offset:26624
v_cvt_pk_bf16_f32 v86, v92, v93
v_mfma_f32_16x16x32_bf16 v[44:47], a[120:123], v[228:231], v[44:47]
ds_read_b64_tr_b16 a[92:93], v118 offset:28672
v_cvt_pk_bf16_f32 v87, v94, v95
v_mfma_f32_16x16x32_bf16 v[44:47], a[124:127], v[244:247], v[44:47]
s_waitcnt lgkmcnt(6)
ds_read_b64_tr_b16 a[94:95], v118 offset:30720
v_add_u32 v118, 32768, v118
v_mfma_f32_16x16x32_bf16 v[48:51], a[64:67], v[128:131], 0
ds_read_b64_tr_b16 a[96:97], v119 offset:0
buffer_store_dwordx4 v[84:87], v1, s[4:7], s12 offen offset:3072 sc1
v_mfma_f32_16x16x32_bf16 v[48:51], a[68:71], v[144:147], v[48:51]
s_add_u32 s8, s8, 4096
s_add_u32 s12, s12, 4096
ds_read_b64_tr_b16 a[98:99], v119 offset:2048
v_mfma_f32_16x16x32_bf16 v[48:51], a[72:75], v[160:163], v[48:51]
ds_read_b64_tr_b16 a[100:101], v119 offset:4096
v_mul_f32 v32, v32, v24
v_mfma_f32_16x16x32_bf16 v[48:51], a[76:79], v[176:179], v[48:51]
s_waitcnt lgkmcnt(6)
ds_read_b64_tr_b16 a[102:103], v119 offset:6144
v_mul_f32 v33, v33, v24
v_mfma_f32_16x16x32_bf16 v[48:51], a[80:83], v[192:195], v[48:51]
ds_read_b64_tr_b16 a[104:105], v119 offset:8192
v_mul_f32 v34, v34, v24
v_mfma_f32_16x16x32_bf16 v[48:51], a[84:87], v[208:211], v[48:51]
s_waitcnt lgkmcnt(6)
ds_read_b64_tr_b16 a[106:107], v119 offset:10240
v_mul_f32 v35, v35, v24
v_mfma_f32_16x16x32_bf16 v[48:51], a[88:91], v[224:227], v[48:51]
s_waitcnt lgkmcnt(6)
ds_read_b64_tr_b16 a[108:109], v119 offset:12288
v_mul_f32 v40, v40, v24
v_mfma_f32_16x16x32_bf16 v[48:51], a[92:95], v[240:243], v[48:51]
ds_read_b64_tr_b16 a[110:111], v119 offset:14336
v_mul_f32 v41, v41, v24
v_mfma_f32_16x16x32_bf16 v[52:55], a[64:67], v[132:135], 0
ds_read_b64_tr_b16 a[112:113], v119 offset:16384
v_mul_f32 v42, v42, v24
v_mfma_f32_16x16x32_bf16 v[52:55], a[68:71], v[148:151], v[52:55]
ds_read_b64_tr_b16 a[114:115], v119 offset:18432
v_mul_f32 v43, v43, v24
v_mfma_f32_16x16x32_bf16 v[52:55], a[72:75], v[164:167], v[52:55]
ds_read_b64_tr_b16 a[116:117], v119 offset:20480
v_cvt_pk_bf16_f32 v32, v32, v33
v_mfma_f32_16x16x32_bf16 v[52:55], a[76:79], v[180:183], v[52:55]
ds_read_b64_tr_b16 a[118:119], v119 offset:22528
v_cvt_pk_bf16_f32 v33, v34, v35
v_mfma_f32_16x16x32_bf16 v[52:55], a[80:83], v[196:199], v[52:55]
ds_read_b64_tr_b16 a[120:121], v119 offset:24576
v_cvt_pk_bf16_f32 v34, v40, v41
v_mfma_f32_16x16x32_bf16 v[52:55], a[84:87], v[212:215], v[52:55]
ds_read_b64_tr_b16 a[122:123], v119 offset:26624
v_cvt_pk_bf16_f32 v35, v42, v43
v_mfma_f32_16x16x32_bf16 v[52:55], a[88:91], v[228:231], v[52:55]
ds_read_b64_tr_b16 a[124:125], v119 offset:28672
ds_read_b64_tr_b16 a[126:127], v119 offset:30720
v_mfma_f32_16x16x32_bf16 v[52:55], a[92:95], v[244:247], v[52:55]
s_waitcnt vmcnt(16) lgkmcnt(7)
s_barrier
v_add_u32 v119, 32768, v119
v_mfma_f32_16x16x32_bf16 v[56:59], a[96:99], v[128:131], 0
ds_read_b64_tr_b16 a[64:65], v116 offset:0
buffer_store_dwordx4 v[32:35], v1, s[4:7], s8 offen offset:0 sc1
v_mfma_f32_16x16x32_bf16 v[56:59], a[100:103], v[144:147], v[56:59]
ds_read_b64_tr_b16 a[66:67], v116 offset:2048
v_mul_f32 v36, v36, v25
v_mfma_f32_16x16x32_bf16 v[56:59], a[104:107], v[160:163], v[56:59]
ds_read_b64_tr_b16 a[68:69], v116 offset:4096
v_mul_f32 v37, v37, v25
v_mfma_f32_16x16x32_bf16 v[56:59], a[108:111], v[176:179], v[56:59]
s_waitcnt lgkmcnt(6)
ds_read_b64_tr_b16 a[70:71], v116 offset:6144
v_mul_f32 v38, v38, v25
v_mfma_f32_16x16x32_bf16 v[56:59], a[112:115], v[192:195], v[56:59]
ds_read_b64_tr_b16 a[72:73], v116 offset:8192
v_mul_f32 v39, v39, v25
v_mfma_f32_16x16x32_bf16 v[56:59], a[116:119], v[208:211], v[56:59]
s_waitcnt lgkmcnt(5)
ds_read_b64_tr_b16 a[74:75], v116 offset:10240
v_mul_f32 v44, v44, v25
v_mfma_f32_16x16x32_bf16 v[56:59], a[120:123], v[224:227], v[56:59]
ds_read_b64_tr_b16 a[76:77], v116 offset:12288
v_mul_f32 v45, v45, v25
v_mfma_f32_16x16x32_bf16 v[56:59], a[124:127], v[240:243], v[56:59]
ds_read_b64_tr_b16 a[78:79], v116 offset:14336
v_mul_f32 v46, v46, v25
v_mfma_f32_16x16x32_bf16 v[60:63], a[96:99], v[132:135], 0
ds_read_b64_tr_b16 a[80:81], v116 offset:16384
v_mul_f32 v47, v47, v25
v_mfma_f32_16x16x32_bf16 v[60:63], a[100:103], v[148:151], v[60:63]
ds_read_b64_tr_b16 a[82:83], v116 offset:18432
v_cvt_pk_bf16_f32 v36, v36, v37
v_mfma_f32_16x16x32_bf16 v[60:63], a[104:107], v[164:167], v[60:63]
ds_read_b64_tr_b16 a[84:85], v116 offset:20480
v_cvt_pk_bf16_f32 v37, v38, v39
v_mfma_f32_16x16x32_bf16 v[60:63], a[108:111], v[180:183], v[60:63]
ds_read_b64_tr_b16 a[86:87], v116 offset:22528
v_cvt_pk_bf16_f32 v38, v44, v45
v_mfma_f32_16x16x32_bf16 v[60:63], a[112:115], v[196:199], v[60:63]
ds_read_b64_tr_b16 a[88:89], v116 offset:24576
v_cvt_pk_bf16_f32 v39, v46, v47
v_mfma_f32_16x16x32_bf16 v[60:63], a[116:119], v[212:215], v[60:63]
ds_read_b64_tr_b16 a[90:91], v116 offset:26624
buffer_store_dwordx4 v[36:39], v1, s[4:7], s12 offen offset:0 sc1
v_mfma_f32_16x16x32_bf16 v[60:63], a[120:123], v[228:231], v[60:63]
ds_read_b64_tr_b16 a[92:93], v116 offset:28672
v_mfma_f32_16x16x32_bf16 v[60:63], a[124:127], v[244:247], v[60:63]
s_waitcnt lgkmcnt(6)
ds_read_b64_tr_b16 a[94:95], v116 offset:30720
v_add_u32 v116, 65536, v116
v_mfma_f32_16x16x32_bf16 v[64:67], a[64:67], v[128:131], 0
ds_read_b64_tr_b16 a[96:97], v117 offset:0
v_mul_f32 v48, v48, v24
v_mfma_f32_16x16x32_bf16 v[64:67], a[68:71], v[144:147], v[64:67]
ds_read_b64_tr_b16 a[98:99], v117 offset:2048
v_mul_f32 v49, v49, v24
v_mfma_f32_16x16x32_bf16 v[64:67], a[72:75], v[160:163], v[64:67]
ds_read_b64_tr_b16 a[100:101], v117 offset:4096
v_mul_f32 v50, v50, v24
v_mfma_f32_16x16x32_bf16 v[64:67], a[76:79], v[176:179], v[64:67]
s_waitcnt lgkmcnt(6)
ds_read_b64_tr_b16 a[102:103], v117 offset:6144
v_mul_f32 v51, v51, v24
v_mfma_f32_16x16x32_bf16 v[64:67], a[80:83], v[192:195], v[64:67]
ds_read_b64_tr_b16 a[104:105], v117 offset:8192
v_mul_f32 v56, v56, v24
v_mfma_f32_16x16x32_bf16 v[64:67], a[84:87], v[208:211], v[64:67]
s_waitcnt lgkmcnt(6)
ds_read_b64_tr_b16 a[106:107], v117 offset:10240
v_mul_f32 v57, v57, v24
v_mfma_f32_16x16x32_bf16 v[64:67], a[88:91], v[224:227], v[64:67]
s_waitcnt lgkmcnt(6)
ds_read_b64_tr_b16 a[108:109], v117 offset:12288
v_mul_f32 v58, v58, v24
v_mfma_f32_16x16x32_bf16 v[64:67], a[92:95], v[240:243], v[64:67]
ds_read_b64_tr_b16 a[110:111], v117 offset:14336
v_mul_f32 v59, v59, v24
v_mfma_f32_16x16x32_bf16 v[68:71], a[64:67], v[132:135], 0
ds_read_b64_tr_b16 a[112:113], v117 offset:16384
v_cvt_pk_bf16_f32 v48, v48, v49
v_mfma_f32_16x16x32_bf16 v[68:71], a[68:71], v[148:151], v[68:71]
ds_read_b64_tr_b16 a[114:115], v117 offset:18432
v_cvt_pk_bf16_f32 v49, v50, v51
v_mfma_f32_16x16x32_bf16 v[68:71], a[72:75], v[164:167], v[68:71]
ds_read_b64_tr_b16 a[116:117], v117 offset:20480
v_cvt_pk_bf16_f32 v50, v56, v57
v_mfma_f32_16x16x32_bf16 v[68:71], a[76:79], v[180:183], v[68:71]
ds_read_b64_tr_b16 a[118:119], v117 offset:22528
v_cvt_pk_bf16_f32 v51, v58, v59
v_mfma_f32_16x16x32_bf16 v[68:71], a[80:83], v[196:199], v[68:71]
ds_read_b64_tr_b16 a[120:121], v117 offset:24576
buffer_store_dwordx4 v[48:51], v1, s[4:7], s8 offen offset:1024 sc1
v_mfma_f32_16x16x32_bf16 v[68:71], a[84:87], v[212:215], v[68:71]
ds_read_b64_tr_b16 a[122:123], v117 offset:26624
v_mul_f32 v52, v52, v25
v_mfma_f32_16x16x32_bf16 v[68:71], a[88:91], v[228:231], v[68:71]
ds_read_b64_tr_b16 a[124:125], v117 offset:28672
v_mul_f32 v53, v53, v25
v_mfma_f32_16x16x32_bf16 v[68:71], a[92:95], v[244:247], v[68:71]
s_waitcnt lgkmcnt(6)
ds_read_b64_tr_b16 a[126:127], v117 offset:30720
v_add_u32 v117, 65536, v117
v_mfma_f32_16x16x32_bf16 v[72:75], a[96:99], v[128:131], 0
ds_read_b64_tr_b16 a[64:65], v118 offset:0
v_mul_f32 v54, v54, v25
v_mfma_f32_16x16x32_bf16 v[72:75], a[100:103], v[144:147], v[72:75]
ds_read_b64_tr_b16 a[66:67], v118 offset:2048
v_mul_f32 v55, v55, v25
v_mfma_f32_16x16x32_bf16 v[72:75], a[104:107], v[160:163], v[72:75]
ds_read_b64_tr_b16 a[68:69], v118 offset:4096
v_mul_f32 v60, v60, v25
v_mfma_f32_16x16x32_bf16 v[72:75], a[108:111], v[176:179], v[72:75]
s_waitcnt lgkmcnt(6)
ds_read_b64_tr_b16 a[70:71], v118 offset:6144
v_mul_f32 v61, v61, v25
v_mfma_f32_16x16x32_bf16 v[72:75], a[112:115], v[192:195], v[72:75]
ds_read_b64_tr_b16 a[72:73], v118 offset:8192
v_mul_f32 v62, v62, v25
v_mfma_f32_16x16x32_bf16 v[72:75], a[116:119], v[208:211], v[72:75]
s_waitcnt lgkmcnt(6)
ds_read_b64_tr_b16 a[74:75], v118 offset:10240
v_mul_f32 v63, v63, v25
v_mfma_f32_16x16x32_bf16 v[72:75], a[120:123], v[224:227], v[72:75]
s_waitcnt lgkmcnt(6)
ds_read_b64_tr_b16 a[76:77], v118 offset:12288
v_cvt_pk_bf16_f32 v52, v52, v53
v_mfma_f32_16x16x32_bf16 v[72:75], a[124:127], v[240:243], v[72:75]
ds_read_b64_tr_b16 a[78:79], v118 offset:14336
v_cvt_pk_bf16_f32 v53, v54, v55
v_mfma_f32_16x16x32_bf16 v[76:79], a[96:99], v[132:135], 0
ds_read_b64_tr_b16 a[80:81], v118 offset:16384
v_cvt_pk_bf16_f32 v54, v60, v61
v_mfma_f32_16x16x32_bf16 v[76:79], a[100:103], v[148:151], v[76:79]
ds_read_b64_tr_b16 a[82:83], v118 offset:18432
v_cvt_pk_bf16_f32 v55, v62, v63
v_mfma_f32_16x16x32_bf16 v[76:79], a[104:107], v[164:167], v[76:79]
ds_read_b64_tr_b16 a[84:85], v118 offset:20480
buffer_store_dwordx4 v[52:55], v1, s[4:7], s12 offen offset:1024 sc1
v_mfma_f32_16x16x32_bf16 v[76:79], a[108:111], v[180:183], v[76:79]
ds_read_b64_tr_b16 a[86:87], v118 offset:22528
v_mul_u32_u24 v21, 1792, v19
v_mfma_f32_16x16x32_bf16 v[76:79], a[112:115], v[196:199], v[76:79]
ds_read_b64_tr_b16 a[88:89], v118 offset:24576
v_mul_f32 v64, v64, v24
v_mfma_f32_16x16x32_bf16 v[76:79], a[116:119], v[212:215], v[76:79]
ds_read_b64_tr_b16 a[90:91], v118 offset:26624
v_mul_f32 v65, v65, v24
v_mfma_f32_16x16x32_bf16 v[76:79], a[120:123], v[228:231], v[76:79]
ds_read_b64_tr_b16 a[92:93], v118 offset:28672
v_mul_f32 v66, v66, v24
v_mfma_f32_16x16x32_bf16 v[76:79], a[124:127], v[244:247], v[76:79]
s_waitcnt lgkmcnt(6)
ds_read_b64_tr_b16 a[94:95], v118 offset:30720
v_add_u32 v118, 65536, v118
v_mfma_f32_16x16x32_bf16 v[80:83], a[64:67], v[128:131], 0
ds_read_b64_tr_b16 a[96:97], v119 offset:0
v_mul_f32 v67, v67, v24
v_mfma_f32_16x16x32_bf16 v[80:83], a[68:71], v[144:147], v[80:83]
ds_read_b64_tr_b16 a[98:99], v119 offset:2048
v_mul_f32 v72, v72, v24
v_mfma_f32_16x16x32_bf16 v[80:83], a[72:75], v[160:163], v[80:83]
ds_read_b64_tr_b16 a[100:101], v119 offset:4096
v_mul_f32 v73, v73, v24
v_mfma_f32_16x16x32_bf16 v[80:83], a[76:79], v[176:179], v[80:83]
s_waitcnt lgkmcnt(6)
ds_read_b64_tr_b16 a[102:103], v119 offset:6144
v_mul_f32 v74, v74, v24
v_mfma_f32_16x16x32_bf16 v[80:83], a[80:83], v[192:195], v[80:83]
ds_read_b64_tr_b16 a[104:105], v119 offset:8192
v_mul_f32 v75, v75, v24
v_mfma_f32_16x16x32_bf16 v[80:83], a[84:87], v[208:211], v[80:83]
s_waitcnt lgkmcnt(6)
ds_read_b64_tr_b16 a[106:107], v119 offset:10240
v_cvt_pk_bf16_f32 v64, v64, v65
v_mfma_f32_16x16x32_bf16 v[80:83], a[88:91], v[224:227], v[80:83]
s_waitcnt lgkmcnt(6)
ds_read_b64_tr_b16 a[108:109], v119 offset:12288
v_cvt_pk_bf16_f32 v65, v66, v67
v_mfma_f32_16x16x32_bf16 v[80:83], a[92:95], v[240:243], v[80:83]
ds_read_b64_tr_b16 a[110:111], v119 offset:14336
v_cvt_pk_bf16_f32 v66, v72, v73
v_mfma_f32_16x16x32_bf16 v[84:87], a[64:67], v[132:135], 0
ds_read_b64_tr_b16 a[112:113], v119 offset:16384
v_cvt_pk_bf16_f32 v67, v74, v75
v_mfma_f32_16x16x32_bf16 v[84:87], a[68:71], v[148:151], v[84:87]
ds_read_b64_tr_b16 a[114:115], v119 offset:18432
buffer_store_dwordx4 v[64:67], v1, s[4:7], s8 offen offset:2048 sc1
v_mfma_f32_16x16x32_bf16 v[84:87], a[72:75], v[164:167], v[84:87]
ds_read_b64_tr_b16 a[116:117], v119 offset:20480
v_mul_f32 v68, v68, v25
v_mfma_f32_16x16x32_bf16 v[84:87], a[76:79], v[180:183], v[84:87]
ds_read_b64_tr_b16 a[118:119], v119 offset:22528
v_mul_f32 v69, v69, v25
v_mfma_f32_16x16x32_bf16 v[84:87], a[80:83], v[196:199], v[84:87]
ds_read_b64_tr_b16 a[120:121], v119 offset:24576
v_mul_f32 v70, v70, v25
v_mfma_f32_16x16x32_bf16 v[84:87], a[84:87], v[212:215], v[84:87]
ds_read_b64_tr_b16 a[122:123], v119 offset:26624
v_mul_f32 v71, v71, v25
v_mfma_f32_16x16x32_bf16 v[84:87], a[88:91], v[228:231], v[84:87]
PAD_15:
s_cbranch_execz M_tret
ds_read_b64_tr_b16 a[124:125], v119 offset:28672
ds_read_b64_tr_b16 a[126:127], v119 offset:30720
v_mfma_f32_16x16x32_bf16 v[84:87], a[92:95], v[244:247], v[84:87]
s_waitcnt vmcnt(7) lgkmcnt(7)
s_barrier
v_add_u32 v119, 65536, v119
v_mfma_f32_16x16x32_bf16 v[88:91], a[96:99], v[128:131], 0
ds_read_b64_tr_b16 a[64:65], v116 offset:0
v_mul_f32 v76, v76, v25
v_mfma_f32_16x16x32_bf16 v[88:91], a[100:103], v[144:147], v[88:91]
ds_read_b64_tr_b16 a[66:67], v116 offset:2048
buffer_store_dword v6, v5, s[4:7], s34 offen sc1
v_mfma_f32_16x16x32_bf16 v[88:91], a[104:107], v[160:163], v[88:91]
ds_read_b64_tr_b16 a[68:69], v116 offset:4096
v_mul_f32 v77, v77, v25
v_mfma_f32_16x16x32_bf16 v[88:91], a[108:111], v[176:179], v[88:91]
s_waitcnt lgkmcnt(6)
ds_read_b64_tr_b16 a[70:71], v116 offset:6144
v_mul_f32 v78, v78, v25
v_mfma_f32_16x16x32_bf16 v[88:91], a[112:115], v[192:195], v[88:91]
ds_read_b64_tr_b16 a[72:73], v116 offset:8192
v_mul_f32 v79, v79, v25
v_mfma_f32_16x16x32_bf16 v[88:91], a[116:119], v[208:211], v[88:91]
s_waitcnt lgkmcnt(5)
ds_read_b64_tr_b16 a[74:75], v116 offset:10240
v_cvt_pk_bf16_f32 v68, v68, v69
v_mfma_f32_16x16x32_bf16 v[88:91], a[120:123], v[224:227], v[88:91]
ds_read_b64_tr_b16 a[76:77], v116 offset:12288
v_cvt_pk_bf16_f32 v69, v70, v71
v_mfma_f32_16x16x32_bf16 v[88:91], a[124:127], v[240:243], v[88:91]
ds_read_b64_tr_b16 a[78:79], v116 offset:14336
v_cvt_pk_bf16_f32 v70, v76, v77
v_mfma_f32_16x16x32_bf16 v[92:95], a[96:99], v[132:135], 0
ds_read_b64_tr_b16 a[80:81], v116 offset:16384
v_cvt_pk_bf16_f32 v71, v78, v79
v_mfma_f32_16x16x32_bf16 v[92:95], a[100:103], v[148:151], v[92:95]
ds_read_b64_tr_b16 a[82:83], v116 offset:18432
buffer_store_dwordx4 v[68:71], v1, s[4:7], s12 offen offset:2048 sc1
v_mfma_f32_16x16x32_bf16 v[92:95], a[104:107], v[164:167], v[92:95]
ds_read_b64_tr_b16 a[84:85], v116 offset:20480
v_lshlrev_b32 v19, 2, v19
v_mfma_f32_16x16x32_bf16 v[92:95], a[108:111], v[180:183], v[92:95]
ds_read_b64_tr_b16 a[86:87], v116 offset:22528
v_mfma_f32_16x16x32_bf16 v[92:95], a[112:115], v[196:199], v[92:95]
ds_read_b64_tr_b16 a[88:89], v116 offset:24576
v_mfma_f32_16x16x32_bf16 v[92:95], a[116:119], v[212:215], v[92:95]
ds_read_b64_tr_b16 a[90:91], v116 offset:26624
v_mfma_f32_16x16x32_bf16 v[92:95], a[120:123], v[228:231], v[92:95]
ds_read_b64_tr_b16 a[92:93], v116 offset:28672
v_mfma_f32_16x16x32_bf16 v[92:95], a[124:127], v[244:247], v[92:95]
s_waitcnt lgkmcnt(6)
ds_read_b64_tr_b16 a[94:95], v116 offset:30720
v_mfma_f32_16x16x32_bf16 v[32:35], a[64:67], v[128:131], 0
ds_read_b64_tr_b16 a[96:97], v117 offset:0
v_mul_f32 v80, v80, v24
v_mfma_f32_16x16x32_bf16 v[32:35], a[68:71], v[144:147], v[32:35]
ds_read_b64_tr_b16 a[98:99], v117 offset:2048
v_mul_f32 v81, v81, v24
v_mfma_f32_16x16x32_bf16 v[32:35], a[72:75], v[160:163], v[32:35]
ds_read_b64_tr_b16 a[100:101], v117 offset:4096
v_mul_f32 v82, v82, v24
v_mfma_f32_16x16x32_bf16 v[32:35], a[76:79], v[176:179], v[32:35]
s_waitcnt lgkmcnt(6)
ds_read_b64_tr_b16 a[102:103], v117 offset:6144
v_mul_f32 v83, v83, v24
v_mfma_f32_16x16x32_bf16 v[32:35], a[80:83], v[192:195], v[32:35]
ds_read_b64_tr_b16 a[104:105], v117 offset:8192
v_mul_f32 v88, v88, v24
v_mfma_f32_16x16x32_bf16 v[32:35], a[84:87], v[208:211], v[32:35]
s_waitcnt lgkmcnt(6)
ds_read_b64_tr_b16 a[106:107], v117 offset:10240
v_mul_f32 v89, v89, v24
v_mfma_f32_16x16x32_bf16 v[32:35], a[88:91], v[224:227], v[32:35]
s_waitcnt lgkmcnt(6)
ds_read_b64_tr_b16 a[108:109], v117 offset:12288
v_mul_f32 v90, v90, v24
v_mfma_f32_16x16x32_bf16 v[32:35], a[92:95], v[240:243], v[32:35]
ds_read_b64_tr_b16 a[110:111], v117 offset:14336
v_mul_f32 v91, v91, v24
v_mfma_f32_16x16x32_bf16 v[36:39], a[64:67], v[132:135], 0
ds_read_b64_tr_b16 a[112:113], v117 offset:16384
v_cvt_pk_bf16_f32 v80, v80, v81
v_mfma_f32_16x16x32_bf16 v[36:39], a[68:71], v[148:151], v[36:39]
ds_read_b64_tr_b16 a[114:115], v117 offset:18432
v_cvt_pk_bf16_f32 v81, v82, v83
v_mfma_f32_16x16x32_bf16 v[36:39], a[72:75], v[164:167], v[36:39]
ds_read_b64_tr_b16 a[116:117], v117 offset:20480
v_cvt_pk_bf16_f32 v82, v88, v89
v_mfma_f32_16x16x32_bf16 v[36:39], a[76:79], v[180:183], v[36:39]
ds_read_b64_tr_b16 a[118:119], v117 offset:22528
v_cvt_pk_bf16_f32 v83, v90, v91
v_mfma_f32_16x16x32_bf16 v[36:39], a[80:83], v[196:199], v[36:39]
ds_read_b64_tr_b16 a[120:121], v117 offset:24576
buffer_store_dwordx4 v[80:83], v1, s[4:7], s8 offen offset:3072 sc1
v_mfma_f32_16x16x32_bf16 v[36:39], a[84:87], v[212:215], v[36:39]
ds_read_b64_tr_b16 a[122:123], v117 offset:26624
v_mul_f32 v84, v84, v25
v_mfma_f32_16x16x32_bf16 v[36:39], a[88:91], v[228:231], v[36:39]
ds_read_b64_tr_b16 a[124:125], v117 offset:28672
v_mul_f32 v85, v85, v25
v_mfma_f32_16x16x32_bf16 v[36:39], a[92:95], v[244:247], v[36:39]
s_waitcnt lgkmcnt(6)
ds_read_b64_tr_b16 a[126:127], v117 offset:30720
v_mul_f32 v86, v86, v25
v_mfma_f32_16x16x32_bf16 v[40:43], a[96:99], v[128:131], 0
ds_read_b64_tr_b16 a[64:65], v118 offset:0
v_mul_f32 v87, v87, v25
v_mfma_f32_16x16x32_bf16 v[40:43], a[100:103], v[144:147], v[40:43]
ds_read_b64_tr_b16 a[66:67], v118 offset:2048
v_mul_f32 v92, v92, v25
v_mfma_f32_16x16x32_bf16 v[40:43], a[104:107], v[160:163], v[40:43]
ds_read_b64_tr_b16 a[68:69], v118 offset:4096
v_mul_f32 v93, v93, v25
v_mfma_f32_16x16x32_bf16 v[40:43], a[108:111], v[176:179], v[40:43]
s_waitcnt lgkmcnt(6)
ds_read_b64_tr_b16 a[70:71], v118 offset:6144
v_mul_f32 v94, v94, v25
v_mfma_f32_16x16x32_bf16 v[40:43], a[112:115], v[192:195], v[40:43]
ds_read_b64_tr_b16 a[72:73], v118 offset:8192
v_mul_f32 v95, v95, v25
v_mfma_f32_16x16x32_bf16 v[40:43], a[116:119], v[208:211], v[40:43]
s_waitcnt lgkmcnt(6)
ds_read_b64_tr_b16 a[74:75], v118 offset:10240
v_cvt_pk_bf16_f32 v84, v84, v85
v_mfma_f32_16x16x32_bf16 v[40:43], a[120:123], v[224:227], v[40:43]
s_waitcnt lgkmcnt(6)
ds_read_b64_tr_b16 a[76:77], v118 offset:12288
v_cvt_pk_bf16_f32 v85, v86, v87
v_mfma_f32_16x16x32_bf16 v[40:43], a[124:127], v[240:243], v[40:43]
ds_read_b64_tr_b16 a[78:79], v118 offset:14336
v_cvt_pk_bf16_f32 v86, v92, v93
v_mfma_f32_16x16x32_bf16 v[44:47], a[96:99], v[132:135], 0
ds_read_b64_tr_b16 a[80:81], v118 offset:16384
v_cvt_pk_bf16_f32 v87, v94, v95
v_mfma_f32_16x16x32_bf16 v[44:47], a[100:103], v[148:151], v[44:47]
ds_read_b64_tr_b16 a[82:83], v118 offset:18432
buffer_store_dwordx4 v[84:87], v1, s[4:7], s12 offen offset:3072 sc1
v_mfma_f32_16x16x32_bf16 v[44:47], a[104:107], v[164:167], v[44:47]
s_add_u32 s8, s8, 4096
s_add_u32 s12, s12, 4096
ds_read_b64_tr_b16 a[84:85], v118 offset:20480
v_mfma_f32_16x16x32_bf16 v[44:47], a[108:111], v[180:183], v[44:47]
ds_read_b64_tr_b16 a[86:87], v118 offset:22528
v_lshrrev_b32 v22, 4, v20
v_mfma_f32_16x16x32_bf16 v[44:47], a[112:115], v[196:199], v[44:47]
ds_read_b64_tr_b16 a[88:89], v118 offset:24576
v_mul_f32 v32, v32, v24
v_mfma_f32_16x16x32_bf16 v[44:47], a[116:119], v[212:215], v[44:47]
ds_read_b64_tr_b16 a[90:91], v118 offset:26624
v_mul_f32 v33, v33, v24
v_mfma_f32_16x16x32_bf16 v[44:47], a[120:123], v[228:231], v[44:47]
ds_read_b64_tr_b16 a[92:93], v118 offset:28672
v_mul_f32 v34, v34, v24
v_mfma_f32_16x16x32_bf16 v[44:47], a[124:127], v[244:247], v[44:47]
s_waitcnt lgkmcnt(6)
ds_read_b64_tr_b16 a[94:95], v118 offset:30720
v_mul_f32 v35, v35, v24
v_mfma_f32_16x16x32_bf16 v[48:51], a[64:67], v[128:131], 0
ds_read_b64_tr_b16 a[96:97], v119 offset:0
v_mul_f32 v40, v40, v24
v_mfma_f32_16x16x32_bf16 v[48:51], a[68:71], v[144:147], v[48:51]
ds_read_b64_tr_b16 a[98:99], v119 offset:2048
v_mul_f32 v41, v41, v24
v_mfma_f32_16x16x32_bf16 v[48:51], a[72:75], v[160:163], v[48:51]
ds_read_b64_tr_b16 a[100:101], v119 offset:4096
v_mul_f32 v42, v42, v24
v_mfma_f32_16x16x32_bf16 v[48:51], a[76:79], v[176:179], v[48:51]
s_waitcnt lgkmcnt(6)
ds_read_b64_tr_b16 a[102:103], v119 offset:6144
v_mul_f32 v43, v43, v24
v_mfma_f32_16x16x32_bf16 v[48:51], a[80:83], v[192:195], v[48:51]
ds_read_b64_tr_b16 a[104:105], v119 offset:8192
v_cvt_pk_bf16_f32 v32, v32, v33
v_mfma_f32_16x16x32_bf16 v[48:51], a[84:87], v[208:211], v[48:51]
s_waitcnt lgkmcnt(6)
ds_read_b64_tr_b16 a[106:107], v119 offset:10240
v_cvt_pk_bf16_f32 v33, v34, v35
v_mfma_f32_16x16x32_bf16 v[48:51], a[88:91], v[224:227], v[48:51]
s_waitcnt lgkmcnt(6)
ds_read_b64_tr_b16 a[108:109], v119 offset:12288
v_cvt_pk_bf16_f32 v34, v40, v41
v_mfma_f32_16x16x32_bf16 v[48:51], a[92:95], v[240:243], v[48:51]
ds_read_b64_tr_b16 a[110:111], v119 offset:14336
v_cvt_pk_bf16_f32 v35, v42, v43
v_mfma_f32_16x16x32_bf16 v[52:55], a[64:67], v[132:135], 0
ds_read_b64_tr_b16 a[112:113], v119 offset:16384
buffer_store_dwordx4 v[32:35], v1, s[4:7], s8 offen offset:0 sc1
v_mfma_f32_16x16x32_bf16 v[52:55], a[68:71], v[148:151], v[52:55]
ds_read_b64_tr_b16 a[114:115], v119 offset:18432
v_mul_f32 v36, v36, v25
v_mfma_f32_16x16x32_bf16 v[52:55], a[72:75], v[164:167], v[52:55]
ds_read_b64_tr_b16 a[116:117], v119 offset:20480
v_mul_f32 v37, v37, v25
v_mfma_f32_16x16x32_bf16 v[52:55], a[76:79], v[180:183], v[52:55]
ds_read_b64_tr_b16 a[118:119], v119 offset:22528
v_mul_f32 v38, v38, v25
v_mfma_f32_16x16x32_bf16 v[52:55], a[80:83], v[196:199], v[52:55]
ds_read_b64_tr_b16 a[120:121], v119 offset:24576
v_mul_f32 v39, v39, v25
v_mfma_f32_16x16x32_bf16 v[52:55], a[84:87], v[212:215], v[52:55]
ds_read_b64_tr_b16 a[122:123], v119 offset:26624
v_mul_f32 v44, v44, v25
v_mfma_f32_16x16x32_bf16 v[52:55], a[88:91], v[228:231], v[52:55]
ds_read_b64_tr_b16 a[124:125], v119 offset:28672
ds_read_b64_tr_b16 a[126:127], v119 offset:30720
v_mfma_f32_16x16x32_bf16 v[52:55], a[92:95], v[244:247], v[52:55]
s_waitcnt lgkmcnt(7)
v_mul_f32 v45, v45, v25
v_mul_f32 v46, v46, v25
v_mfma_f32_16x16x32_bf16 v[56:59], a[96:99], v[128:131], 0
v_mul_f32 v47, v47, v25
v_cvt_pk_bf16_f32 v36, v36, v37
v_mfma_f32_16x16x32_bf16 v[56:59], a[100:103], v[144:147], v[56:59]
v_cvt_pk_bf16_f32 v37, v38, v39
v_cvt_pk_bf16_f32 v38, v44, v45
v_mfma_f32_16x16x32_bf16 v[56:59], a[104:107], v[160:163], v[56:59]
v_cvt_pk_bf16_f32 v39, v46, v47
v_lshl_add_u32 v21, v22, 3, v21
v_mfma_f32_16x16x32_bf16 v[56:59], a[108:111], v[176:179], v[56:59]
s_waitcnt lgkmcnt(3)
buffer_store_dwordx4 v[36:39], v1, s[4:7], s12 offen offset:0 sc1
v_mfma_f32_16x16x32_bf16 v[56:59], a[112:115], v[192:195], v[56:59]
v_mfma_f32_16x16x32_bf16 v[56:59], a[116:119], v[208:211], v[56:59]
s_waitcnt lgkmcnt(0)
v_mfma_f32_16x16x32_bf16 v[56:59], a[120:123], v[224:227], v[56:59]
v_mfma_f32_16x16x32_bf16 v[56:59], a[124:127], v[240:243], v[56:59]
v_mfma_f32_16x16x32_bf16 v[60:63], a[96:99], v[132:135], 0
v_mfma_f32_16x16x32_bf16 v[60:63], a[100:103], v[148:151], v[60:63]
v_mfma_f32_16x16x32_bf16 v[60:63], a[104:107], v[164:167], v[60:63]
v_mfma_f32_16x16x32_bf16 v[60:63], a[108:111], v[180:183], v[60:63]
v_mfma_f32_16x16x32_bf16 v[60:63], a[112:115], v[196:199], v[60:63]
buffer_load_dword v18, v19, s[4:7], s33 offen offset:0 sc1
v_mfma_f32_16x16x32_bf16 v[60:63], a[116:119], v[212:215], v[60:63]
v_mfma_f32_16x16x32_bf16 v[60:63], a[120:123], v[228:231], v[60:63]
v_mfma_f32_16x16x32_bf16 v[60:63], a[124:127], v[244:247], v[60:63]
v_mul_f32 v48, v48, v24
v_mul_f32 v49, v49, v24
v_mul_f32 v50, v50, v24
v_mul_f32 v51, v51, v24
v_mul_f32 v56, v56, v24
v_mul_f32 v57, v57, v24
v_mul_f32 v58, v58, v24
v_mul_f32 v59, v59, v24
v_cvt_pk_bf16_f32 v48, v48, v49
v_cvt_pk_bf16_f32 v49, v50, v51
v_cvt_pk_bf16_f32 v50, v56, v57
v_cvt_pk_bf16_f32 v51, v58, v59
buffer_store_dwordx4 v[48:51], v1, s[4:7], s8 offen offset:1024 sc1
v_mul_f32 v52, v52, v25
v_mul_f32 v53, v53, v25
v_mul_f32 v54, v54, v25
v_mul_f32 v55, v55, v25
v_mul_f32 v60, v60, v25
v_mul_f32 v61, v61, v25
v_mul_f32 v62, v62, v25
v_mul_f32 v63, v63, v25
v_cvt_pk_bf16_f32 v52, v52, v53
v_cvt_pk_bf16_f32 v53, v54, v55
v_cvt_pk_bf16_f32 v54, v60, v61
v_cvt_pk_bf16_f32 v55, v62, v63
buffer_store_dwordx4 v[52:55], v1, s[4:7], s12 offen offset:1024 sc1
s_and_b32 s22, s2, 224
s_cmp_eq_u32 s22, 224
s_cbranch_scc1 M_final
s_waitcnt vmcnt(0)
s_barrier
buffer_store_dword v6, v5, s[4:7], s35 offen sc1
s_bitcmp0_b32 s2, 4
s_cbranch_scc1 M_rA
v_cmp_gt_u32 vcc, 1, v18
s_cbranch_vccnz M_rslow
M_rjoin:
buffer_load_dwordx4 v[128:131], v1, s[4:7], s26 offen sc1
s_add_u32 s26, s26, 14336
buffer_load_dwordx4 v[132:135], v1, s[4:7], s26 offen sc1
s_add_u32 s26, s26, 14336
buffer_load_dwordx4 v[136:139], v1, s[4:7], s26 offen sc1
s_add_u32 s26, s26, 14336
buffer_load_dwordx4 v[140:143], v1, s[4:7], s26 offen sc1
s_add_u32 s26, s26, 14336
buffer_load_dwordx4 v[144:147], v1, s[4:7], s26 offen sc1
s_add_u32 s26, s26, 14336
buffer_load_dwordx4 v[148:151], v1, s[4:7], s26 offen sc1
s_add_u32 s26, s26, 14336
buffer_load_dwordx4 v[152:155], v1, s[4:7], s26 offen sc1
s_add_u32 s26, s26, 14336
buffer_load_dwordx4 v[156:159], v1, s[4:7], s26 offen sc1
s_add_u32 s26, s26, 14336
buffer_load_dwordx4 v[160:163], v1, s[4:7], s26 offen sc1
s_add_u32 s26, s26, 14336
buffer_load_dwordx4 v[164:167], v1, s[4:7], s26 offen sc1
s_add_u32 s26, s26, 14336
buffer_load_dwordx4 v[168:171], v1, s[4:7], s26 offen sc1
s_add_u32 s26, s26, 14336
buffer_load_dwordx4 v[172:175], v1, s[4:7], s26 offen sc1
s_add_u32 s26, s26, 14336
buffer_load_dwordx4 v[176:179], v1, s[4:7], s26 offen sc1
s_add_u32 s26, s26, 14336
buffer_load_dwordx4 v[180:183], v1, s[4:7], s26 offen sc1
s_add_u32 s26, s26, 14336
buffer_load_dwordx4 v[184:187], v1, s[4:7], s26 offen sc1
s_add_u32 s26, s26, 14336
buffer_load_dwordx4 v[188:191], v1, s[4:7], s26 offen sc1
Lp_9201:
buffer_load_dword v18, v19, s[4:7], s33 offen offset:2048 sc1
s_waitcnt vmcnt(0)
v_cmp_gt_u32 vcc, 1, v18
s_cbranch_vccz Lpd_9202
s_sleep 8
s_sub_u32 s101, s101, 1
s_cbranch_scc0 Lp_9201
s_mov_b32 s101, 0
Lpd_9202:
s_sub_u32 s26, s26, 207872
buffer_load_dwordx4 v[192:195], v1, s[4:7], s26 offen sc1
s_add_u32 s26, s26, 14336
buffer_load_dwordx4 v[196:199], v1, s[4:7], s26 offen sc1
s_add_u32 s26, s26, 14336
buffer_load_dwordx4 v[200:203], v1, s[4:7], s26 offen sc1
s_add_u32 s26, s26, 14336
buffer_load_dwordx4 v[204:207], v1, s[4:7], s26 offen sc1
s_add_u32 s26, s26, 14336
buffer_load_dwordx4 v[208:211], v1, s[4:7], s26 offen sc1
s_add_u32 s26, s26, 14336
buffer_load_dwordx4 v[212:215], v1, s[4:7], s26 offen sc1
s_add_u32 s26, s26, 14336
buffer_load_dwordx4 v[216:219], v1, s[4:7], s26 offen sc1
s_add_u32 s26, s26, 14336
buffer_load_dwordx4 v[220:223], v1, s[4:7], s26 offen sc1
s_add_u32 s26, s26, 14336
buffer_load_dwordx4 v[224:227], v1, s[4:7], s26 offen sc1
s_add_u32 s26, s26, 14336
buffer_load_dwordx4 v[228:231], v1, s[4:7], s26 offen sc1
s_add_u32 s26, s26, 14336
buffer_load_dwordx4 v[232:235], v1, s[4:7], s26 offen sc1
s_add_u32 s26, s26, 14336
buffer_load_dwordx4 v[236:239], v1, s[4:7], s26 offen sc1
s_add_u32 s26, s26, 14336
buffer_load_dwordx4 v[240:243], v1, s[4:7], s26 offen sc1
s_add_u32 s26, s26, 14336
buffer_load_dwordx4 v[244:247], v1, s[4:7], s26 offen sc1
s_add_u32 s26, s26, 14336
buffer_load_dwordx4 v[248:251], v1, s[4:7], s26 offen sc1
s_add_u32 s26, s26, 14336
buffer_load_dwordx4 v[252:255], v1, s[4:7], s26 offen sc1
v_lshlrev_b32 v96, 16, v128
v_and_b32 v97, 0xffff0000, v128
v_lshlrev_b32 v98, 16, v129
v_and_b32 v99, 0xffff0000, v129
v_lshlrev_b32 v100, 16, v130
v_and_b32 v101, 0xffff0000, v130
v_lshlrev_b32 v102, 16, v131
v_and_b32 v103, 0xffff0000, v131
v_lshlrev_b32 v10, 16, v132
v_and_b32 v11, 0xffff0000, v132
v_lshlrev_b32 v12, 16, v133
v_and_b32 v13, 0xffff0000, v133
v_lshlrev_b32 v14, 16, v134
v_and_b32 v15, 0xffff0000, v134
v_lshlrev_b32 v16, 16, v135
v_and_b32 v17, 0xffff0000, v135
v_pk_add_f32 v[96:97], v[96:97], v[10:11]
v_pk_add_f32 v[98:99], v[98:99], v[12:13]
v_pk_add_f32 v[100:101], v[100:101], v[14:15]
v_pk_add_f32 v[102:103], v[102:103], v[16:17]
v_lshlrev_b32 v10, 16, v136
v_and_b32 v11, 0xffff0000, v136
v_lshlrev_b32 v12, 16, v137
v_and_b32 v13, 0xffff0000, v137
v_lshlrev_b32 v14, 16, v138
v_and_b32 v15, 0xffff0000, v138
v_lshlrev_b32 v16, 16, v139
v_and_b32 v17, 0xffff0000, v139
v_pk_add_f32 v[96:97], v[96:97], v[10:11]
v_pk_add_f32 v[98:99], v[98:99], v[12:13]
v_pk_add_f32 v[100:101], v[100:101], v[14:15]
v_pk_add_f32 v[102:103], v[102:103], v[16:17]
v_lshlrev_b32 v10, 16, v140
v_and_b32 v11, 0xffff0000, v140
v_lshlrev_b32 v12, 16, v141
v_and_b32 v13, 0xffff0000, v141
v_lshlrev_b32 v14, 16, v142
v_and_b32 v15, 0xffff0000, v142
v_lshlrev_b32 v16, 16, v143
v_and_b32 v17, 0xffff0000, v143
v_pk_add_f32 v[96:97], v[96:97], v[10:11]
v_pk_add_f32 v[98:99], v[98:99], v[12:13]
v_pk_add_f32 v[100:101], v[100:101], v[14:15]
v_pk_add_f32 v[102:103], v[102:103], v[16:17]
v_lshlrev_b32 v10, 16, v144
v_and_b32 v11, 0xffff0000, v144
v_lshlrev_b32 v12, 16, v145
v_and_b32 v13, 0xffff0000, v145
v_lshlrev_b32 v14, 16, v146
v_and_b32 v15, 0xffff0000, v146
v_lshlrev_b32 v16, 16, v147
v_and_b32 v17, 0xffff0000, v147
v_pk_add_f32 v[96:97], v[96:97], v[10:11]
v_pk_add_f32 v[98:99], v[98:99], v[12:13]
v_pk_add_f32 v[100:101], v[100:101], v[14:15]
v_pk_add_f32 v[102:103], v[102:103], v[16:17]
v_lshlrev_b32 v10, 16, v148
v_and_b32 v11, 0xffff0000, v148
v_lshlrev_b32 v12, 16, v149
v_and_b32 v13, 0xffff0000, v149
v_lshlrev_b32 v14, 16, v150
v_and_b32 v15, 0xffff0000, v150
v_lshlrev_b32 v16, 16, v151
v_and_b32 v17, 0xffff0000, v151
v_pk_add_f32 v[96:97], v[96:97], v[10:11]
v_pk_add_f32 v[98:99], v[98:99], v[12:13]
v_pk_add_f32 v[100:101], v[100:101], v[14:15]
v_pk_add_f32 v[102:103], v[102:103], v[16:17]
v_lshlrev_b32 v10, 16, v152
v_and_b32 v11, 0xffff0000, v152
v_lshlrev_b32 v12, 16, v153
v_and_b32 v13, 0xffff0000, v153
v_lshlrev_b32 v14, 16, v154
v_and_b32 v15, 0xffff0000, v154
v_lshlrev_b32 v16, 16, v155
v_and_b32 v17, 0xffff0000, v155
v_pk_add_f32 v[96:97], v[96:97], v[10:11]
v_pk_add_f32 v[98:99], v[98:99], v[12:13]
v_pk_add_f32 v[100:101], v[100:101], v[14:15]
v_pk_add_f32 v[102:103], v[102:103], v[16:17]
v_lshlrev_b32 v10, 16, v156
v_and_b32 v11, 0xffff0000, v156
v_lshlrev_b32 v12, 16, v157
v_and_b32 v13, 0xffff0000, v157
v_lshlrev_b32 v14, 16, v158
v_and_b32 v15, 0xffff0000, v158
v_lshlrev_b32 v16, 16, v159
v_and_b32 v17, 0xffff0000, v159
v_pk_add_f32 v[96:97], v[96:97], v[10:11]
v_pk_add_f32 v[98:99], v[98:99], v[12:13]
v_pk_add_f32 v[100:101], v[100:101], v[14:15]
v_pk_add_f32 v[102:103], v[102:103], v[16:17]
v_lshlrev_b32 v10, 16, v160
v_and_b32 v11, 0xffff0000, v160
v_lshlrev_b32 v12, 16, v161
v_and_b32 v13, 0xffff0000, v161
v_lshlrev_b32 v14, 16, v162
v_and_b32 v15, 0xffff0000, v162
v_lshlrev_b32 v16, 16, v163
v_and_b32 v17, 0xffff0000, v163
v_pk_add_f32 v[96:97], v[96:97], v[10:11]
v_pk_add_f32 v[98:99], v[98:99], v[12:13]
v_pk_add_f32 v[100:101], v[100:101], v[14:15]
v_pk_add_f32 v[102:103], v[102:103], v[16:17]
v_lshlrev_b32 v10, 16, v164
v_and_b32 v11, 0xffff0000, v164
v_lshlrev_b32 v12, 16, v165
v_and_b32 v13, 0xffff0000, v165
v_lshlrev_b32 v14, 16, v166
v_and_b32 v15, 0xffff0000, v166
v_lshlrev_b32 v16, 16, v167
v_and_b32 v17, 0xffff0000, v167
v_pk_add_f32 v[96:97], v[96:97], v[10:11]
v_pk_add_f32 v[98:99], v[98:99], v[12:13]
v_pk_add_f32 v[100:101], v[100:101], v[14:15]
v_pk_add_f32 v[102:103], v[102:103], v[16:17]
v_lshlrev_b32 v10, 16, v168
v_and_b32 v11, 0xffff0000, v168
v_lshlrev_b32 v12, 16, v169
v_and_b32 v13, 0xffff0000, v169
v_lshlrev_b32 v14, 16, v170
v_and_b32 v15, 0xffff0000, v170
v_lshlrev_b32 v16, 16, v171
v_and_b32 v17, 0xffff0000, v171
v_pk_add_f32 v[96:97], v[96:97], v[10:11]
v_pk_add_f32 v[98:99], v[98:99], v[12:13]
v_pk_add_f32 v[100:101], v[100:101], v[14:15]
v_pk_add_f32 v[102:103], v[102:103], v[16:17]
v_lshlrev_b32 v10, 16, v172
v_and_b32 v11, 0xffff0000, v172
v_lshlrev_b32 v12, 16, v173
v_and_b32 v13, 0xffff0000, v173
v_lshlrev_b32 v14, 16, v174
v_and_b32 v15, 0xffff0000, v174
v_lshlrev_b32 v16, 16, v175
v_and_b32 v17, 0xffff0000, v175
v_pk_add_f32 v[96:97], v[96:97], v[10:11]
v_pk_add_f32 v[98:99], v[98:99], v[12:13]
v_pk_add_f32 v[100:101], v[100:101], v[14:15]
v_pk_add_f32 v[102:103], v[102:103], v[16:17]
v_lshlrev_b32 v10, 16, v176
v_and_b32 v11, 0xffff0000, v176
v_lshlrev_b32 v12, 16, v177
v_and_b32 v13, 0xffff0000, v177
v_lshlrev_b32 v14, 16, v178
v_and_b32 v15, 0xffff0000, v178
v_lshlrev_b32 v16, 16, v179
v_and_b32 v17, 0xffff0000, v179
v_pk_add_f32 v[96:97], v[96:97], v[10:11]
v_pk_add_f32 v[98:99], v[98:99], v[12:13]
v_pk_add_f32 v[100:101], v[100:101], v[14:15]
v_pk_add_f32 v[102:103], v[102:103], v[16:17]
v_lshlrev_b32 v10, 16, v180
v_and_b32 v11, 0xffff0000, v180
v_lshlrev_b32 v12, 16, v181
v_and_b32 v13, 0xffff0000, v181
v_lshlrev_b32 v14, 16, v182
v_and_b32 v15, 0xffff0000, v182
v_lshlrev_b32 v16, 16, v183
v_and_b32 v17, 0xffff0000, v183
v_pk_add_f32 v[96:97], v[96:97], v[10:11]
v_pk_add_f32 v[98:99], v[98:99], v[12:13]
v_pk_add_f32 v[100:101], v[100:101], v[14:15]
v_pk_add_f32 v[102:103], v[102:103], v[16:17]
v_lshlrev_b32 v10, 16, v184
v_and_b32 v11, 0xffff0000, v184
v_lshlrev_b32 v12, 16, v185
v_and_b32 v13, 0xffff0000, v185
v_lshlrev_b32 v14, 16, v186
v_and_b32 v15, 0xffff0000, v186
v_lshlrev_b32 v16, 16, v187
v_and_b32 v17, 0xffff0000, v187
v_pk_add_f32 v[96:97], v[96:97], v[10:11]
v_pk_add_f32 v[98:99], v[98:99], v[12:13]
v_pk_add_f32 v[100:101], v[100:101], v[14:15]
v_pk_add_f32 v[102:103], v[102:103], v[16:17]
v_lshlrev_b32 v10, 16, v188
v_and_b32 v11, 0xffff0000, v188
v_lshlrev_b32 v12, 16, v189
v_and_b32 v13, 0xffff0000, v189
v_lshlrev_b32 v14, 16, v190
v_and_b32 v15, 0xffff0000, v190
v_lshlrev_b32 v16, 16, v191
v_and_b32 v17, 0xffff0000, v191
v_pk_add_f32 v[96:97], v[96:97], v[10:11]
v_pk_add_f32 v[98:99], v[98:99], v[12:13]
v_pk_add_f32 v[100:101], v[100:101], v[14:15]
v_pk_add_f32 v[102:103], v[102:103], v[16:17]
v_cvt_pk_bf16_f32 v96, v96, v97
v_cvt_pk_bf16_f32 v97, v98, v99
v_cvt_pk_bf16_f32 v98, v100, v101
v_cvt_pk_bf16_f32 v99, v102, v103
buffer_store_dwordx2 v[96:97], v21, s[40:43], s25 offen offset:896
buffer_store_dwordx2 v[98:99], v21, s[40:43], s25 offen offset:928
s_waitcnt vmcnt(17)
v_lshlrev_b32 v104, 16, v192
v_and_b32 v105, 0xffff0000, v192
v_lshlrev_b32 v106, 16, v193
v_and_b32 v107, 0xffff0000, v193
v_lshlrev_b32 v108, 16, v194
v_and_b32 v109, 0xffff0000, v194
v_lshlrev_b32 v110, 16, v195
v_and_b32 v111, 0xffff0000, v195
s_waitcnt vmcnt(16)
v_lshlrev_b32 v10, 16, v196
v_and_b32 v11, 0xffff0000, v196
v_lshlrev_b32 v12, 16, v197
v_and_b32 v13, 0xffff0000, v197
v_lshlrev_b32 v14, 16, v198
v_and_b32 v15, 0xffff0000, v198
v_lshlrev_b32 v16, 16, v199
v_and_b32 v17, 0xffff0000, v199
v_pk_add_f32 v[104:105], v[104:105], v[10:11]
v_pk_add_f32 v[106:107], v[106:107], v[12:13]
v_pk_add_f32 v[108:109], v[108:109], v[14:15]
v_pk_add_f32 v[110:111], v[110:111], v[16:17]
s_waitcnt vmcnt(15)
v_lshlrev_b32 v10, 16, v200
v_and_b32 v11, 0xffff0000, v200
v_lshlrev_b32 v12, 16, v201
v_and_b32 v13, 0xffff0000, v201
v_lshlrev_b32 v14, 16, v202
v_and_b32 v15, 0xffff0000, v202
v_lshlrev_b32 v16, 16, v203
v_and_b32 v17, 0xffff0000, v203
v_pk_add_f32 v[104:105], v[104:105], v[10:11]
v_pk_add_f32 v[106:107], v[106:107], v[12:13]
v_pk_add_f32 v[108:109], v[108:109], v[14:15]
v_pk_add_f32 v[110:111], v[110:111], v[16:17]
s_waitcnt vmcnt(14)
v_lshlrev_b32 v10, 16, v204
v_and_b32 v11, 0xffff0000, v204
v_lshlrev_b32 v12, 16, v205
v_and_b32 v13, 0xffff0000, v205
v_lshlrev_b32 v14, 16, v206
v_and_b32 v15, 0xffff0000, v206
v_lshlrev_b32 v16, 16, v207
v_and_b32 v17, 0xffff0000, v207
v_pk_add_f32 v[104:105], v[104:105], v[10:11]
v_pk_add_f32 v[106:107], v[106:107], v[12:13]
v_pk_add_f32 v[108:109], v[108:109], v[14:15]
v_pk_add_f32 v[110:111], v[110:111], v[16:17]
s_waitcnt vmcnt(13)
v_lshlrev_b32 v10, 16, v208
v_and_b32 v11, 0xffff0000, v208
v_lshlrev_b32 v12, 16, v209
v_and_b32 v13, 0xffff0000, v209
v_lshlrev_b32 v14, 16, v210
v_and_b32 v15, 0xffff0000, v210
v_lshlrev_b32 v16, 16, v211
v_and_b32 v17, 0xffff0000, v211
v_pk_add_f32 v[104:105], v[104:105], v[10:11]
v_pk_add_f32 v[106:107], v[106:107], v[12:13]
v_pk_add_f32 v[108:109], v[108:109], v[14:15]
v_pk_add_f32 v[110:111], v[110:111], v[16:17]
s_waitcnt vmcnt(12)
v_lshlrev_b32 v10, 16, v212
v_and_b32 v11, 0xffff0000, v212
PAD_16:
s_cbranch_execz M_tret
v_lshlrev_b32 v12, 16, v213
v_and_b32 v13, 0xffff0000, v213
v_lshlrev_b32 v14, 16, v214
v_and_b32 v15, 0xffff0000, v214
v_lshlrev_b32 v16, 16, v215
v_and_b32 v17, 0xffff0000, v215
v_pk_add_f32 v[104:105], v[104:105], v[10:11]
v_pk_add_f32 v[106:107], v[106:107], v[12:13]
v_pk_add_f32 v[108:109], v[108:109], v[14:15]
v_pk_add_f32 v[110:111], v[110:111], v[16:17]
s_waitcnt vmcnt(11)
v_lshlrev_b32 v10, 16, v216
v_and_b32 v11, 0xffff0000, v216
v_lshlrev_b32 v12, 16, v217
v_and_b32 v13, 0xffff0000, v217
v_lshlrev_b32 v14, 16, v218
v_and_b32 v15, 0xffff0000, v218
v_lshlrev_b32 v16, 16, v219
v_and_b32 v17, 0xffff0000, v219
v_pk_add_f32 v[104:105], v[104:105], v[10:11]
v_pk_add_f32 v[106:107], v[106:107], v[12:13]
v_pk_add_f32 v[108:109], v[108:109], v[14:15]
v_pk_add_f32 v[110:111], v[110:111], v[16:17]
s_waitcnt vmcnt(10)
v_lshlrev_b32 v10, 16, v220
v_and_b32 v11, 0xffff0000, v220
v_lshlrev_b32 v12, 16, v221
v_and_b32 v13, 0xffff0000, v221
v_lshlrev_b32 v14, 16, v222
v_and_b32 v15, 0xffff0000, v222
v_lshlrev_b32 v16, 16, v223
v_and_b32 v17, 0xffff0000, v223
v_pk_add_f32 v[104:105], v[104:105], v[10:11]
v_pk_add_f32 v[106:107], v[106:107], v[12:13]
v_pk_add_f32 v[108:109], v[108:109], v[14:15]
v_pk_add_f32 v[110:111], v[110:111], v[16:17]
s_waitcnt vmcnt(9)
v_lshlrev_b32 v10, 16, v224
v_and_b32 v11, 0xffff0000, v224
v_lshlrev_b32 v12, 16, v225
v_and_b32 v13, 0xffff0000, v225
v_lshlrev_b32 v14, 16, v226
v_and_b32 v15, 0xffff0000, v226
v_lshlrev_b32 v16, 16, v227
v_and_b32 v17, 0xffff0000, v227
v_pk_add_f32 v[104:105], v[104:105], v[10:11]
v_pk_add_f32 v[106:107], v[106:107], v[12:13]
v_pk_add_f32 v[108:109], v[108:109], v[14:15]
v_pk_add_f32 v[110:111], v[110:111], v[16:17]
s_waitcnt vmcnt(8)
v_lshlrev_b32 v10, 16, v228
v_and_b32 v11, 0xffff0000, v228
v_lshlrev_b32 v12, 16, v229
v_and_b32 v13, 0xffff0000, v229
v_lshlrev_b32 v14, 16, v230
v_and_b32 v15, 0xffff0000, v230
v_lshlrev_b32 v16, 16, v231
v_and_b32 v17, 0xffff0000, v231
v_pk_add_f32 v[104:105], v[104:105], v[10:11]
v_pk_add_f32 v[106:107], v[106:107], v[12:13]
v_pk_add_f32 v[108:109], v[108:109], v[14:15]
v_pk_add_f32 v[110:111], v[110:111], v[16:17]
s_waitcnt vmcnt(7)
v_lshlrev_b32 v10, 16, v232
v_and_b32 v11, 0xffff0000, v232
v_lshlrev_b32 v12, 16, v233
v_and_b32 v13, 0xffff0000, v233
v_lshlrev_b32 v14, 16, v234
v_and_b32 v15, 0xffff0000, v234
v_lshlrev_b32 v16, 16, v235
v_and_b32 v17, 0xffff0000, v235
v_pk_add_f32 v[104:105], v[104:105], v[10:11]
v_pk_add_f32 v[106:107], v[106:107], v[12:13]
v_pk_add_f32 v[108:109], v[108:109], v[14:15]
v_pk_add_f32 v[110:111], v[110:111], v[16:17]
s_waitcnt vmcnt(6)
v_lshlrev_b32 v10, 16, v236
v_and_b32 v11, 0xffff0000, v236
v_lshlrev_b32 v12, 16, v237
v_and_b32 v13, 0xffff0000, v237
v_lshlrev_b32 v14, 16, v238
v_and_b32 v15, 0xffff0000, v238
v_lshlrev_b32 v16, 16, v239
v_and_b32 v17, 0xffff0000, v239
v_pk_add_f32 v[104:105], v[104:105], v[10:11]
v_pk_add_f32 v[106:107], v[106:107], v[12:13]
v_pk_add_f32 v[108:109], v[108:109], v[14:15]
v_pk_add_f32 v[110:111], v[110:111], v[16:17]
s_waitcnt vmcnt(5)
v_lshlrev_b32 v10, 16, v240
v_and_b32 v11, 0xffff0000, v240
v_lshlrev_b32 v12, 16, v241
v_and_b32 v13, 0xffff0000, v241
v_lshlrev_b32 v14, 16, v242
v_and_b32 v15, 0xffff0000, v242
v_lshlrev_b32 v16, 16, v243
v_and_b32 v17, 0xffff0000, v243
v_pk_add_f32 v[104:105], v[104:105], v[10:11]
v_pk_add_f32 v[106:107], v[106:107], v[12:13]
v_pk_add_f32 v[108:109], v[108:109], v[14:15]
v_pk_add_f32 v[110:111], v[110:111], v[16:17]
s_waitcnt vmcnt(4)
v_lshlrev_b32 v10, 16, v244
v_and_b32 v11, 0xffff0000, v244
v_lshlrev_b32 v12, 16, v245
v_and_b32 v13, 0xffff0000, v245
v_lshlrev_b32 v14, 16, v246
v_and_b32 v15, 0xffff0000, v246
v_lshlrev_b32 v16, 16, v247
v_and_b32 v17, 0xffff0000, v247
v_pk_add_f32 v[104:105], v[104:105], v[10:11]
v_pk_add_f32 v[106:107], v[106:107], v[12:13]
v_pk_add_f32 v[108:109], v[108:109], v[14:15]
v_pk_add_f32 v[110:111], v[110:111], v[16:17]
s_waitcnt vmcnt(3)
v_lshlrev_b32 v10, 16, v248
v_and_b32 v11, 0xffff0000, v248
v_lshlrev_b32 v12, 16, v249
v_and_b32 v13, 0xffff0000, v249
v_lshlrev_b32 v14, 16, v250
v_and_b32 v15, 0xffff0000, v250
v_lshlrev_b32 v16, 16, v251
v_and_b32 v17, 0xffff0000, v251
v_pk_add_f32 v[104:105], v[104:105], v[10:11]
v_pk_add_f32 v[106:107], v[106:107], v[12:13]
v_pk_add_f32 v[108:109], v[108:109], v[14:15]
v_pk_add_f32 v[110:111], v[110:111], v[16:17]
s_waitcnt vmcnt(2)
v_lshlrev_b32 v10, 16, v252
v_and_b32 v11, 0xffff0000, v252
v_lshlrev_b32 v12, 16, v253
v_and_b32 v13, 0xffff0000, v253
v_lshlrev_b32 v14, 16, v254
v_and_b32 v15, 0xffff0000, v254
v_lshlrev_b32 v16, 16, v255
v_and_b32 v17, 0xffff0000, v255
v_pk_add_f32 v[104:105], v[104:105], v[10:11]
v_pk_add_f32 v[106:107], v[106:107], v[12:13]
v_pk_add_f32 v[108:109], v[108:109], v[14:15]
v_pk_add_f32 v[110:111], v[110:111], v[16:17]
v_cvt_pk_bf16_f32 v104, v104, v105
v_cvt_pk_bf16_f32 v105, v106, v107
v_cvt_pk_bf16_f32 v106, v108, v109
v_cvt_pk_bf16_f32 v107, v110, v111
buffer_store_dwordx2 v[104:105], v21, s[40:43], s25 offen offset:1344
buffer_store_dwordx2 v[106:107], v21, s[40:43], s25 offen offset:1376
s_add_u32 s25, s25, 1835008
s_add_u32 s26, s26, 14457856
s_add_u32 s33, s33, 1024
s_branch M_r1
M_rA:
s_add_u32 s25, s25, 448
s_add_u32 s26, s26, 7168
s_add_u32 s33, s33, 2048
M_r1:
Lp_9203:
buffer_load_dword v18, v19, s[4:7], s33 offen offset:0 sc1
s_waitcnt vmcnt(0)
v_cmp_gt_u32 vcc, 1, v18
s_cbranch_vccz Lpd_9204
s_sleep 8
s_sub_u32 s101, s101, 1
s_cbranch_scc0 Lp_9203
s_mov_b32 s101, 0
Lpd_9204:
buffer_load_dwordx4 v[128:131], v1, s[4:7], s26 offen sc1
s_add_u32 s26, s26, 14336
buffer_load_dwordx4 v[132:135], v1, s[4:7], s26 offen sc1
s_add_u32 s26, s26, 14336
buffer_load_dwordx4 v[136:139], v1, s[4:7], s26 offen sc1
s_add_u32 s26, s26, 14336
buffer_load_dwordx4 v[140:143], v1, s[4:7], s26 offen sc1
s_add_u32 s26, s26, 14336
buffer_load_dwordx4 v[144:147], v1, s[4:7], s26 offen sc1
s_add_u32 s26, s26, 14336
buffer_load_dwordx4 v[148:151], v1, s[4:7], s26 offen sc1
s_add_u32 s26, s26, 14336
buffer_load_dwordx4 v[152:155], v1, s[4:7], s26 offen sc1
s_add_u32 s26, s26, 14336
buffer_load_dwordx4 v[156:159], v1, s[4:7], s26 offen sc1
s_add_u32 s26, s26, 14336
buffer_load_dwordx4 v[160:163], v1, s[4:7], s26 offen sc1
s_add_u32 s26, s26, 14336
buffer_load_dwordx4 v[164:167], v1, s[4:7], s26 offen sc1
s_add_u32 s26, s26, 14336
buffer_load_dwordx4 v[168:171], v1, s[4:7], s26 offen sc1
s_add_u32 s26, s26, 14336
buffer_load_dwordx4 v[172:175], v1, s[4:7], s26 offen sc1
s_add_u32 s26, s26, 14336
buffer_load_dwordx4 v[176:179], v1, s[4:7], s26 offen sc1
s_add_u32 s26, s26, 14336
buffer_load_dwordx4 v[180:183], v1, s[4:7], s26 offen sc1
s_add_u32 s26, s26, 14336
buffer_load_dwordx4 v[184:187], v1, s[4:7], s26 offen sc1
s_add_u32 s26, s26, 14336
buffer_load_dwordx4 v[188:191], v1, s[4:7], s26 offen sc1
s_waitcnt vmcnt(15)
v_lshlrev_b32 v96, 16, v128
v_and_b32 v97, 0xffff0000, v128
v_lshlrev_b32 v98, 16, v129
v_and_b32 v99, 0xffff0000, v129
v_lshlrev_b32 v100, 16, v130
v_and_b32 v101, 0xffff0000, v130
v_lshlrev_b32 v102, 16, v131
v_and_b32 v103, 0xffff0000, v131
s_waitcnt vmcnt(14)
v_lshlrev_b32 v10, 16, v132
v_and_b32 v11, 0xffff0000, v132
v_lshlrev_b32 v12, 16, v133
v_and_b32 v13, 0xffff0000, v133
v_lshlrev_b32 v14, 16, v134
v_and_b32 v15, 0xffff0000, v134
v_lshlrev_b32 v16, 16, v135
v_and_b32 v17, 0xffff0000, v135
v_pk_add_f32 v[96:97], v[96:97], v[10:11]
v_pk_add_f32 v[98:99], v[98:99], v[12:13]
v_pk_add_f32 v[100:101], v[100:101], v[14:15]
v_pk_add_f32 v[102:103], v[102:103], v[16:17]
s_waitcnt vmcnt(13)
v_lshlrev_b32 v10, 16, v136
v_and_b32 v11, 0xffff0000, v136
v_lshlrev_b32 v12, 16, v137
v_and_b32 v13, 0xffff0000, v137
v_lshlrev_b32 v14, 16, v138
v_and_b32 v15, 0xffff0000, v138
v_lshlrev_b32 v16, 16, v139
v_and_b32 v17, 0xffff0000, v139
v_pk_add_f32 v[96:97], v[96:97], v[10:11]
v_pk_add_f32 v[98:99], v[98:99], v[12:13]
v_pk_add_f32 v[100:101], v[100:101], v[14:15]
v_pk_add_f32 v[102:103], v[102:103], v[16:17]
s_waitcnt vmcnt(12)
v_lshlrev_b32 v10, 16, v140
v_and_b32 v11, 0xffff0000, v140
v_lshlrev_b32 v12, 16, v141
v_and_b32 v13, 0xffff0000, v141
v_lshlrev_b32 v14, 16, v142
v_and_b32 v15, 0xffff0000, v142
v_lshlrev_b32 v16, 16, v143
v_and_b32 v17, 0xffff0000, v143
v_pk_add_f32 v[96:97], v[96:97], v[10:11]
v_pk_add_f32 v[98:99], v[98:99], v[12:13]
v_pk_add_f32 v[100:101], v[100:101], v[14:15]
v_pk_add_f32 v[102:103], v[102:103], v[16:17]
s_waitcnt vmcnt(11)
v_lshlrev_b32 v10, 16, v144
v_and_b32 v11, 0xffff0000, v144
v_lshlrev_b32 v12, 16, v145
v_and_b32 v13, 0xffff0000, v145
v_lshlrev_b32 v14, 16, v146
v_and_b32 v15, 0xffff0000, v146
v_lshlrev_b32 v16, 16, v147
v_and_b32 v17, 0xffff0000, v147
v_pk_add_f32 v[96:97], v[96:97], v[10:11]
v_pk_add_f32 v[98:99], v[98:99], v[12:13]
v_pk_add_f32 v[100:101], v[100:101], v[14:15]
v_pk_add_f32 v[102:103], v[102:103], v[16:17]
s_waitcnt vmcnt(10)
v_lshlrev_b32 v10, 16, v148
v_and_b32 v11, 0xffff0000, v148
v_lshlrev_b32 v12, 16, v149
v_and_b32 v13, 0xffff0000, v149
v_lshlrev_b32 v14, 16, v150
v_and_b32 v15, 0xffff0000, v150
v_lshlrev_b32 v16, 16, v151
v_and_b32 v17, 0xffff0000, v151
v_pk_add_f32 v[96:97], v[96:97], v[10:11]
v_pk_add_f32 v[98:99], v[98:99], v[12:13]
v_pk_add_f32 v[100:101], v[100:101], v[14:15]
v_pk_add_f32 v[102:103], v[102:103], v[16:17]
s_waitcnt vmcnt(9)
v_lshlrev_b32 v10, 16, v152
v_and_b32 v11, 0xffff0000, v152
v_lshlrev_b32 v12, 16, v153
v_and_b32 v13, 0xffff0000, v153
v_lshlrev_b32 v14, 16, v154
v_and_b32 v15, 0xffff0000, v154
v_lshlrev_b32 v16, 16, v155
v_and_b32 v17, 0xffff0000, v155
v_pk_add_f32 v[96:97], v[96:97], v[10:11]
v_pk_add_f32 v[98:99], v[98:99], v[12:13]
v_pk_add_f32 v[100:101], v[100:101], v[14:15]
v_pk_add_f32 v[102:103], v[102:103], v[16:17]
s_waitcnt vmcnt(8)
v_lshlrev_b32 v10, 16, v156
v_and_b32 v11, 0xffff0000, v156
v_lshlrev_b32 v12, 16, v157
v_and_b32 v13, 0xffff0000, v157
v_lshlrev_b32 v14, 16, v158
v_and_b32 v15, 0xffff0000, v158
v_lshlrev_b32 v16, 16, v159
v_and_b32 v17, 0xffff0000, v159
v_pk_add_f32 v[96:97], v[96:97], v[10:11]
v_pk_add_f32 v[98:99], v[98:99], v[12:13]
v_pk_add_f32 v[100:101], v[100:101], v[14:15]
v_pk_add_f32 v[102:103], v[102:103], v[16:17]
s_waitcnt vmcnt(7)
v_lshlrev_b32 v10, 16, v160
v_and_b32 v11, 0xffff0000, v160
v_lshlrev_b32 v12, 16, v161
v_and_b32 v13, 0xffff0000, v161
v_lshlrev_b32 v14, 16, v162
v_and_b32 v15, 0xffff0000, v162
v_lshlrev_b32 v16, 16, v163
v_and_b32 v17, 0xffff0000, v163
v_pk_add_f32 v[96:97], v[96:97], v[10:11]
v_pk_add_f32 v[98:99], v[98:99], v[12:13]
v_pk_add_f32 v[100:101], v[100:101], v[14:15]
v_pk_add_f32 v[102:103], v[102:103], v[16:17]
s_waitcnt vmcnt(6)
v_lshlrev_b32 v10, 16, v164
v_and_b32 v11, 0xffff0000, v164
v_lshlrev_b32 v12, 16, v165
v_and_b32 v13, 0xffff0000, v165
v_lshlrev_b32 v14, 16, v166
v_and_b32 v15, 0xffff0000, v166
v_lshlrev_b32 v16, 16, v167
v_and_b32 v17, 0xffff0000, v167
v_pk_add_f32 v[96:97], v[96:97], v[10:11]
v_pk_add_f32 v[98:99], v[98:99], v[12:13]
v_pk_add_f32 v[100:101], v[100:101], v[14:15]
v_pk_add_f32 v[102:103], v[102:103], v[16:17]
s_waitcnt vmcnt(5)
v_lshlrev_b32 v10, 16, v168
v_and_b32 v11, 0xffff0000, v168
v_lshlrev_b32 v12, 16, v169
v_and_b32 v13, 0xffff0000, v169
v_lshlrev_b32 v14, 16, v170
v_and_b32 v15, 0xffff0000, v170
v_lshlrev_b32 v16, 16, v171
v_and_b32 v17, 0xffff0000, v171
v_pk_add_f32 v[96:97], v[96:97], v[10:11]
v_pk_add_f32 v[98:99], v[98:99], v[12:13]
v_pk_add_f32 v[100:101], v[100:101], v[14:15]
v_pk_add_f32 v[102:103], v[102:103], v[16:17]
s_waitcnt vmcnt(4)
v_lshlrev_b32 v10, 16, v172
v_and_b32 v11, 0xffff0000, v172
v_lshlrev_b32 v12, 16, v173
v_and_b32 v13, 0xffff0000, v173
v_lshlrev_b32 v14, 16, v174
v_and_b32 v15, 0xffff0000, v174
v_lshlrev_b32 v16, 16, v175
v_and_b32 v17, 0xffff0000, v175
v_pk_add_f32 v[96:97], v[96:97], v[10:11]
v_pk_add_f32 v[98:99], v[98:99], v[12:13]
v_pk_add_f32 v[100:101], v[100:101], v[14:15]
v_pk_add_f32 v[102:103], v[102:103], v[16:17]
s_waitcnt vmcnt(3)
v_lshlrev_b32 v10, 16, v176
v_and_b32 v11, 0xffff0000, v176
v_lshlrev_b32 v12, 16, v177
v_and_b32 v13, 0xffff0000, v177
v_lshlrev_b32 v14, 16, v178
v_and_b32 v15, 0xffff0000, v178
v_lshlrev_b32 v16, 16, v179
v_and_b32 v17, 0xffff0000, v179
v_pk_add_f32 v[96:97], v[96:97], v[10:11]
v_pk_add_f32 v[98:99], v[98:99], v[12:13]
v_pk_add_f32 v[100:101], v[100:101], v[14:15]
v_pk_add_f32 v[102:103], v[102:103], v[16:17]
s_waitcnt vmcnt(2)
v_lshlrev_b32 v10, 16, v180
v_and_b32 v11, 0xffff0000, v180
v_lshlrev_b32 v12, 16, v181
v_and_b32 v13, 0xffff0000, v181
v_lshlrev_b32 v14, 16, v182
v_and_b32 v15, 0xffff0000, v182
v_lshlrev_b32 v16, 16, v183
v_and_b32 v17, 0xffff0000, v183
v_pk_add_f32 v[96:97], v[96:97], v[10:11]
v_pk_add_f32 v[98:99], v[98:99], v[12:13]
v_pk_add_f32 v[100:101], v[100:101], v[14:15]
v_pk_add_f32 v[102:103], v[102:103], v[16:17]
s_waitcnt vmcnt(1)
v_lshlrev_b32 v10, 16, v184
v_and_b32 v11, 0xffff0000, v184
v_lshlrev_b32 v12, 16, v185
v_and_b32 v13, 0xffff0000, v185
v_lshlrev_b32 v14, 16, v186
v_and_b32 v15, 0xffff0000, v186
v_lshlrev_b32 v16, 16, v187
v_and_b32 v17, 0xffff0000, v187
v_pk_add_f32 v[96:97], v[96:97], v[10:11]
v_pk_add_f32 v[98:99], v[98:99], v[12:13]
v_pk_add_f32 v[100:101], v[100:101], v[14:15]
v_pk_add_f32 v[102:103], v[102:103], v[16:17]
s_waitcnt vmcnt(0)
v_lshlrev_b32 v10, 16, v188
v_and_b32 v11, 0xffff0000, v188
v_lshlrev_b32 v12, 16, v189
v_and_b32 v13, 0xffff0000, v189
v_lshlrev_b32 v14, 16, v190
v_and_b32 v15, 0xffff0000, v190
v_lshlrev_b32 v16, 16, v191
v_and_b32 v17, 0xffff0000, v191
v_pk_add_f32 v[96:97], v[96:97], v[10:11]
v_pk_add_f32 v[98:99], v[98:99], v[12:13]
v_pk_add_f32 v[100:101], v[100:101], v[14:15]
v_pk_add_f32 v[102:103], v[102:103], v[16:17]
v_cvt_pk_bf16_f32 v96, v96, v97
v_cvt_pk_bf16_f32 v97, v98, v99
v_cvt_pk_bf16_f32 v98, v100, v101
v_cvt_pk_bf16_f32 v99, v102, v103
buffer_store_dwordx2 v[96:97], v21, s[40:43], s25 offen offset:896
buffer_store_dwordx2 v[98:99], v21, s[40:43], s25 offen offset:928
M_fin:
s_endpgm
M_final:
s_mov_b32 s8, s64
s_mov_b32 s9, s65
s_mov_b32 s10, 1835008
s_mov_b32 s11, 0x20000
s_mov_b32 s12, s88
s_mov_b32 s13, s89
s_mov_b32 s14, 3670016
s_mov_b32 s15, 0x20000
s_and_b32 s24, s2, 16
s_add_u32 s24, s24, s20
v_lshrrev_b32 v20, 4, v1
v_and_b32 v21, 15, v20
v_lshrrev_b32 v22, 4, v20
v_mul_u32_u24 v2, 896, v21
v_lshlrev_b32 v9, 1, v2
v_lshl_add_u32 v2, v22, 4, v2
v_lshl_add_u32 v9, v22, 4, v9
s_lshl_b32 s22, s24, 2
s_add_u32 s22, s22, s3
s_mul_i32 s25, s22, 14336
s_lshl_b32 s26, s25, 1
v_lshlrev_b32 v10, 5, v22
v_add3_u32 v10, v10, v21, 16
v_lshlrev_b32 v10, 2, v10
v_min_u32 v11, 380, v10
v_add_u32 v11, 512, v11
s_mov_b32 s27, 94384128
Lfp:
buffer_load_dword v3, v10, s[4:7], s27 offen sc1
buffer_load_dword v4, v11, s[4:7], s27 offen sc1
s_waitcnt vmcnt(0)
v_and_b32 v3, v3, v4
v_cmp_gt_u32 vcc, 1, v3
s_cbranch_vccz Lfpd
s_sleep 2
s_sub_u32 s101, s101, 1
s_cbranch_scc0 Lfp
s_mov_b32 s101, 0
Lfpd:
s_barrier
buffer_store_dword v6, v5, s[4:7], s35 offen sc1
Lfg:
v_lshrrev_b32 v3, 3, v20
v_and_b32 v4, 7, v20
v_lshlrev_b32 v4, 4, v4
v_lshl_add_u32 v3, v3, 12, v4
s_mul_i32 s27, s3, 458752
s_lshl_b32 s22, s24, 7
s_add_u32 s27, s27, s22
s_add_u32 s27, s27, 88080384
s_mul_i32 s28, s3, 14336
s_add_u32 m0, s28, 0
s_nop 0
buffer_load_dwordx4 v3, s[4:7], s27 offen sc1 lds
s_add_u32 s27, s27, 32768
s_add_u32 m0, s28, 1024
s_nop 0
buffer_load_dwordx4 v3, s[4:7], s27 offen sc1 lds
s_add_u32 s27, s27, 32768
s_add_u32 m0, s28, 2048
s_nop 0
buffer_load_dwordx4 v3, s[4:7], s27 offen sc1 lds
s_add_u32 s27, s27, 32768
s_add_u32 m0, s28, 3072
s_nop 0
buffer_load_dwordx4 v3, s[4:7], s27 offen sc1 lds
s_add_u32 s27, s27, 32768
s_add_u32 m0, s28, 4096
s_nop 0
buffer_load_dwordx4 v3, s[4:7], s27 offen sc1 lds
s_add_u32 s27, s27, 32768
s_add_u32 m0, s28, 5120
s_nop 0
buffer_load_dwordx4 v3, s[4:7], s27 offen sc1 lds
s_add_u32 s27, s27, 32768
s_add_u32 m0, s28, 6144
s_nop 0
buffer_load_dwordx4 v3, s[4:7], s27 offen sc1 lds
s_add_u32 s27, s27, 32768
s_add_u32 m0, s28, 7168
s_nop 0
buffer_load_dwordx4 v3, s[4:7], s27 offen sc1 lds
s_add_u32 s27, s27, 32768
s_add_u32 m0, s28, 8192
s_nop 0
buffer_load_dwordx4 v3, s[4:7], s27 offen sc1 lds
s_add_u32 s27, s27, 32768
s_add_u32 m0, s28, 9216
s_nop 0
buffer_load_dwordx4 v3, s[4:7], s27 offen sc1 lds
s_add_u32 s27, s27, 32768
s_add_u32 m0, s28, 10240
s_nop 0
buffer_load_dwordx4 v3, s[4:7], s27 offen sc1 lds
s_add_u32 s27, s27, 32768
s_add_u32 m0, s28, 11264
s_nop 0
buffer_load_dwordx4 v3, s[4:7], s27 offen sc1 lds
s_add_u32 s27, s27, 32768
s_add_u32 m0, s28, 12288
s_nop 0
buffer_load_dwordx4 v3, s[4:7], s27 offen sc1 lds
s_add_u32 s27, s27, 32768
s_add_u32 m0, s28, 13312
s_nop 0
buffer_load_dwordx4 v3, s[4:7], s27 offen sc1 lds
s_add_u32 s27, s27, 32768
buffer_load_dwordx4 v[160:163], v2, s[8:11], s25 offen offset:0
buffer_load_dwordx4 v[164:167], v2, s[8:11], s25 offen offset:64
buffer_load_dwordx4 v[168:171], v2, s[8:11], s25 offen offset:128
buffer_load_dwordx4 v[172:175], v2, s[8:11], s25 offen offset:192
buffer_load_dwordx4 v[176:179], v2, s[8:11], s25 offen offset:256
buffer_load_dwordx4 v[180:183], v2, s[8:11], s25 offen offset:320
buffer_load_dwordx4 v[184:187], v2, s[8:11], s25 offen offset:384
buffer_load_dwordx4 v[188:191], v2, s[8:11], s25 offen offset:448
buffer_load_dwordx4 v[192:195], v2, s[8:11], s25 offen offset:512
buffer_load_dwordx4 v[196:199], v2, s[8:11], s25 offen offset:576
buffer_load_dwordx4 v[200:203], v2, s[8:11], s25 offen offset:640
buffer_load_dwordx4 v[204:207], v2, s[8:11], s25 offen offset:704
buffer_load_dwordx4 v[208:211], v2, s[8:11], s25 offen offset:768
buffer_load_dwordx4 v[212:215], v2, s[8:11], s25 offen offset:832
v_lshrrev_b32 v3, 2, v21
v_lshl_add_u32 v3, v22, 3, v3
v_lshlrev_b32 v3, 7, v3
v_and_b32 v4, 3, v20
v_lshl_add_u32 v3, v4, 3, v3
s_lshl_b32 s22, s3, 5
v_add_u32 v3, s22, v3
s_waitcnt vmcnt(14)
s_barrier
ds_read_b64_tr_b16 v[96:97], v3 offset:0
ds_read_b64_tr_b16 v[98:99], v3 offset:512
ds_read_b64_tr_b16 v[100:101], v3 offset:4096
ds_read_b64_tr_b16 v[102:103], v3 offset:4608
ds_read_b64_tr_b16 v[104:105], v3 offset:8192
ds_read_b64_tr_b16 v[106:107], v3 offset:8704
ds_read_b64_tr_b16 v[108:109], v3 offset:12288
ds_read_b64_tr_b16 v[110:111], v3 offset:12800
ds_read_b64_tr_b16 v[112:113], v3 offset:16384
ds_read_b64_tr_b16 v[114:115], v3 offset:16896
ds_read_b64_tr_b16 v[116:117], v3 offset:20480
ds_read_b64_tr_b16 v[118:119], v3 offset:20992
ds_read_b64_tr_b16 v[120:121], v3 offset:24576
ds_read_b64_tr_b16 v[122:123], v3 offset:25088
s_waitcnt lgkmcnt(0)
ds_read_b64_tr_b16 v[124:125], v3 offset:28672
ds_read_b64_tr_b16 v[126:127], v3 offset:29184
ds_read_b64_tr_b16 v[128:129], v3 offset:32768
ds_read_b64_tr_b16 v[130:131], v3 offset:33280
ds_read_b64_tr_b16 v[132:133], v3 offset:36864
ds_read_b64_tr_b16 v[134:135], v3 offset:37376
ds_read_b64_tr_b16 v[136:137], v3 offset:40960
ds_read_b64_tr_b16 v[138:139], v3 offset:41472
ds_read_b64_tr_b16 v[140:141], v3 offset:45056
ds_read_b64_tr_b16 v[142:143], v3 offset:45568
ds_read_b64_tr_b16 v[144:145], v3 offset:49152
ds_read_b64_tr_b16 v[146:147], v3 offset:49664
ds_read_b64_tr_b16 v[148:149], v3 offset:53248
ds_read_b64_tr_b16 v[150:151], v3 offset:53760
s_waitcnt vmcnt(13)
v_lshlrev_b32 v10, 16, v160
v_and_b32 v11, 0xffff0000, v160
v_lshlrev_b32 v12, 16, v96
v_and_b32 v13, 0xffff0000, v96
v_pk_mul_f32 v[10:11], v[10:11], v[12:13]
v_cvt_pk_bf16_f32 v160, v10, v11
v_lshlrev_b32 v10, 16, v161
v_and_b32 v11, 0xffff0000, v161
v_lshlrev_b32 v12, 16, v97
v_and_b32 v13, 0xffff0000, v97
v_pk_mul_f32 v[10:11], v[10:11], v[12:13]
v_cvt_pk_bf16_f32 v161, v10, v11
v_lshlrev_b32 v10, 16, v162
v_and_b32 v11, 0xffff0000, v162
v_lshlrev_b32 v12, 16, v98
v_and_b32 v13, 0xffff0000, v98
v_pk_mul_f32 v[10:11], v[10:11], v[12:13]
v_cvt_pk_bf16_f32 v162, v10, v11
v_lshlrev_b32 v10, 16, v163
v_and_b32 v11, 0xffff0000, v163
v_lshlrev_b32 v12, 16, v99
v_and_b32 v13, 0xffff0000, v99
v_pk_mul_f32 v[10:11], v[10:11], v[12:13]
v_cvt_pk_bf16_f32 v163, v10, v11
buffer_store_dwordx4 v[160:163], v9, s[12:15], s26 offen offset:0
s_waitcnt vmcnt(13)
v_lshlrev_b32 v10, 16, v164
v_and_b32 v11, 0xffff0000, v164
v_lshlrev_b32 v12, 16, v100
v_and_b32 v13, 0xffff0000, v100
v_pk_mul_f32 v[10:11], v[10:11], v[12:13]
v_cvt_pk_bf16_f32 v164, v10, v11
v_lshlrev_b32 v10, 16, v165
v_and_b32 v11, 0xffff0000, v165
v_lshlrev_b32 v12, 16, v101
v_and_b32 v13, 0xffff0000, v101
v_pk_mul_f32 v[10:11], v[10:11], v[12:13]
v_cvt_pk_bf16_f32 v165, v10, v11
v_lshlrev_b32 v10, 16, v166
v_and_b32 v11, 0xffff0000, v166
v_lshlrev_b32 v12, 16, v102
v_and_b32 v13, 0xffff0000, v102
v_pk_mul_f32 v[10:11], v[10:11], v[12:13]
v_cvt_pk_bf16_f32 v166, v10, v11
v_lshlrev_b32 v10, 16, v167
v_and_b32 v11, 0xffff0000, v167
v_lshlrev_b32 v12, 16, v103
v_and_b32 v13, 0xffff0000, v103
v_pk_mul_f32 v[10:11], v[10:11], v[12:13]
v_cvt_pk_bf16_f32 v167, v10, v11
buffer_store_dwordx4 v[164:167], v9, s[12:15], s26 offen offset:64
s_waitcnt vmcnt(13)
v_lshlrev_b32 v10, 16, v168
v_and_b32 v11, 0xffff0000, v168
v_lshlrev_b32 v12, 16, v104
v_and_b32 v13, 0xffff0000, v104
v_pk_mul_f32 v[10:11], v[10:11], v[12:13]
v_cvt_pk_bf16_f32 v168, v10, v11
v_lshlrev_b32 v10, 16, v169
v_and_b32 v11, 0xffff0000, v169
v_lshlrev_b32 v12, 16, v105
v_and_b32 v13, 0xffff0000, v105
v_pk_mul_f32 v[10:11], v[10:11], v[12:13]
v_cvt_pk_bf16_f32 v169, v10, v11
v_lshlrev_b32 v10, 16, v170
v_and_b32 v11, 0xffff0000, v170
v_lshlrev_b32 v12, 16, v106
v_and_b32 v13, 0xffff0000, v106
v_pk_mul_f32 v[10:11], v[10:11], v[12:13]
v_cvt_pk_bf16_f32 v170, v10, v11
v_lshlrev_b32 v10, 16, v171
v_and_b32 v11, 0xffff0000, v171
v_lshlrev_b32 v12, 16, v107
v_and_b32 v13, 0xffff0000, v107
v_pk_mul_f32 v[10:11], v[10:11], v[12:13]
v_cvt_pk_bf16_f32 v171, v10, v11
buffer_store_dwordx4 v[168:171], v9, s[12:15], s26 offen offset:128
s_waitcnt vmcnt(13)
v_lshlrev_b32 v10, 16, v172
v_and_b32 v11, 0xffff0000, v172
v_lshlrev_b32 v12, 16, v108
v_and_b32 v13, 0xffff0000, v108
v_pk_mul_f32 v[10:11], v[10:11], v[12:13]
v_cvt_pk_bf16_f32 v172, v10, v11
v_lshlrev_b32 v10, 16, v173
v_and_b32 v11, 0xffff0000, v173
v_lshlrev_b32 v12, 16, v109
v_and_b32 v13, 0xffff0000, v109
v_pk_mul_f32 v[10:11], v[10:11], v[12:13]
v_cvt_pk_bf16_f32 v173, v10, v11
v_lshlrev_b32 v10, 16, v174
v_and_b32 v11, 0xffff0000, v174
v_lshlrev_b32 v12, 16, v110
v_and_b32 v13, 0xffff0000, v110
v_pk_mul_f32 v[10:11], v[10:11], v[12:13]
v_cvt_pk_bf16_f32 v174, v10, v11
v_lshlrev_b32 v10, 16, v175
v_and_b32 v11, 0xffff0000, v175
v_lshlrev_b32 v12, 16, v111
v_and_b32 v13, 0xffff0000, v111
v_pk_mul_f32 v[10:11], v[10:11], v[12:13]
v_cvt_pk_bf16_f32 v175, v10, v11
buffer_store_dwordx4 v[172:175], v9, s[12:15], s26 offen offset:192
s_waitcnt vmcnt(13)
v_lshlrev_b32 v10, 16, v176
v_and_b32 v11, 0xffff0000, v176
v_lshlrev_b32 v12, 16, v112
v_and_b32 v13, 0xffff0000, v112
v_pk_mul_f32 v[10:11], v[10:11], v[12:13]
v_cvt_pk_bf16_f32 v176, v10, v11
v_lshlrev_b32 v10, 16, v177
v_and_b32 v11, 0xffff0000, v177
v_lshlrev_b32 v12, 16, v113
v_and_b32 v13, 0xffff0000, v113
v_pk_mul_f32 v[10:11], v[10:11], v[12:13]
v_cvt_pk_bf16_f32 v177, v10, v11
v_lshlrev_b32 v10, 16, v178
v_and_b32 v11, 0xffff0000, v178
v_lshlrev_b32 v12, 16, v114
v_and_b32 v13, 0xffff0000, v114
v_pk_mul_f32 v[10:11], v[10:11], v[12:13]
v_cvt_pk_bf16_f32 v178, v10, v11
v_lshlrev_b32 v10, 16, v179
v_and_b32 v11, 0xffff0000, v179
v_lshlrev_b32 v12, 16, v115
v_and_b32 v13, 0xffff0000, v115
v_pk_mul_f32 v[10:11], v[10:11], v[12:13]
v_cvt_pk_bf16_f32 v179, v10, v11
buffer_store_dwordx4 v[176:179], v9, s[12:15], s26 offen offset:256
s_waitcnt vmcnt(13)
v_lshlrev_b32 v10, 16, v180
v_and_b32 v11, 0xffff0000, v180
v_lshlrev_b32 v12, 16, v116
v_and_b32 v13, 0xffff0000, v116
v_pk_mul_f32 v[10:11], v[10:11], v[12:13]
v_cvt_pk_bf16_f32 v180, v10, v11
v_lshlrev_b32 v10, 16, v181
v_and_b32 v11, 0xffff0000, v181
v_lshlrev_b32 v12, 16, v117
v_and_b32 v13, 0xffff0000, v117
v_pk_mul_f32 v[10:11], v[10:11], v[12:13]
v_cvt_pk_bf16_f32 v181, v10, v11
v_lshlrev_b32 v10, 16, v182
v_and_b32 v11, 0xffff0000, v182
v_lshlrev_b32 v12, 16, v118
v_and_b32 v13, 0xffff0000, v118
v_pk_mul_f32 v[10:11], v[10:11], v[12:13]
v_cvt_pk_bf16_f32 v182, v10, v11
v_lshlrev_b32 v10, 16, v183
v_and_b32 v11, 0xffff0000, v183
v_lshlrev_b32 v12, 16, v119
v_and_b32 v13, 0xffff0000, v119
v_pk_mul_f32 v[10:11], v[10:11], v[12:13]
v_cvt_pk_bf16_f32 v183, v10, v11
buffer_store_dwordx4 v[180:183], v9, s[12:15], s26 offen offset:320
s_waitcnt vmcnt(13)
v_lshlrev_b32 v10, 16, v184
v_and_b32 v11, 0xffff0000, v184
v_lshlrev_b32 v12, 16, v120
v_and_b32 v13, 0xffff0000, v120
v_pk_mul_f32 v[10:11], v[10:11], v[12:13]
v_cvt_pk_bf16_f32 v184, v10, v11
v_lshlrev_b32 v10, 16, v185
v_and_b32 v11, 0xffff0000, v185
v_lshlrev_b32 v12, 16, v121
v_and_b32 v13, 0xffff0000, v121
v_pk_mul_f32 v[10:11], v[10:11], v[12:13]
v_cvt_pk_bf16_f32 v185, v10, v11
v_lshlrev_b32 v10, 16, v186
v_and_b32 v11, 0xffff0000, v186
v_lshlrev_b32 v12, 16, v122
v_and_b32 v13, 0xffff0000, v122
v_pk_mul_f32 v[10:11], v[10:11], v[12:13]
v_cvt_pk_bf16_f32 v186, v10, v11
v_lshlrev_b32 v10, 16, v187
v_and_b32 v11, 0xffff0000, v187
v_lshlrev_b32 v12, 16, v123
v_and_b32 v13, 0xffff0000, v123
v_pk_mul_f32 v[10:11], v[10:11], v[12:13]
v_cvt_pk_bf16_f32 v187, v10, v11
buffer_store_dwordx4 v[184:187], v9, s[12:15], s26 offen offset:384
s_waitcnt lgkmcnt(0)
s_waitcnt vmcnt(13)
v_lshlrev_b32 v10, 16, v188
v_and_b32 v11, 0xffff0000, v188
v_lshlrev_b32 v12, 16, v124
v_and_b32 v13, 0xffff0000, v124
v_pk_mul_f32 v[10:11], v[10:11], v[12:13]
v_cvt_pk_bf16_f32 v188, v10, v11
v_lshlrev_b32 v10, 16, v189
v_and_b32 v11, 0xffff0000, v189
v_lshlrev_b32 v12, 16, v125
v_and_b32 v13, 0xffff0000, v125
v_pk_mul_f32 v[10:11], v[10:11], v[12:13]
v_cvt_pk_bf16_f32 v189, v10, v11
v_lshlrev_b32 v10, 16, v190
v_and_b32 v11, 0xffff0000, v190
v_lshlrev_b32 v12, 16, v126
v_and_b32 v13, 0xffff0000, v126
v_pk_mul_f32 v[10:11], v[10:11], v[12:13]
v_cvt_pk_bf16_f32 v190, v10, v11
v_lshlrev_b32 v10, 16, v191
v_and_b32 v11, 0xffff0000, v191
v_lshlrev_b32 v12, 16, v127
v_and_b32 v13, 0xffff0000, v127
v_pk_mul_f32 v[10:11], v[10:11], v[12:13]
v_cvt_pk_bf16_f32 v191, v10, v11
buffer_store_dwordx4 v[188:191], v9, s[12:15], s26 offen offset:448
s_waitcnt vmcnt(13)
v_lshlrev_b32 v10, 16, v192
v_and_b32 v11, 0xffff0000, v192
v_lshlrev_b32 v12, 16, v128
v_and_b32 v13, 0xffff0000, v128
v_pk_mul_f32 v[10:11], v[10:11], v[12:13]
v_cvt_pk_bf16_f32 v192, v10, v11
v_lshlrev_b32 v10, 16, v193
v_and_b32 v11, 0xffff0000, v193
v_lshlrev_b32 v12, 16, v129
v_and_b32 v13, 0xffff0000, v129
v_pk_mul_f32 v[10:11], v[10:11], v[12:13]
v_cvt_pk_bf16_f32 v193, v10, v11
v_lshlrev_b32 v10, 16, v194
v_and_b32 v11, 0xffff0000, v194
v_lshlrev_b32 v12, 16, v130
v_and_b32 v13, 0xffff0000, v130
v_pk_mul_f32 v[10:11], v[10:11], v[12:13]
v_cvt_pk_bf16_f32 v194, v10, v11
v_lshlrev_b32 v10, 16, v195
v_and_b32 v11, 0xffff0000, v195
v_lshlrev_b32 v12, 16, v131
v_and_b32 v13, 0xffff0000, v131
v_pk_mul_f32 v[10:11], v[10:11], v[12:13]
v_cvt_pk_bf16_f32 v195, v10, v11
buffer_store_dwordx4 v[192:195], v9, s[12:15], s26 offen offset:512
s_waitcnt vmcnt(13)
v_lshlrev_b32 v10, 16, v196
v_and_b32 v11, 0xffff0000, v196
v_lshlrev_b32 v12, 16, v132
v_and_b32 v13, 0xffff0000, v132
v_pk_mul_f32 v[10:11], v[10:11], v[12:13]
v_cvt_pk_bf16_f32 v196, v10, v11
v_lshlrev_b32 v10, 16, v197
v_and_b32 v11, 0xffff0000, v197
v_lshlrev_b32 v12, 16, v133
v_and_b32 v13, 0xffff0000, v133
v_pk_mul_f32 v[10:11], v[10:11], v[12:13]
v_cvt_pk_bf16_f32 v197, v10, v11
v_lshlrev_b32 v10, 16, v198
v_and_b32 v11, 0xffff0000, v198
v_lshlrev_b32 v12, 16, v134
v_and_b32 v13, 0xffff0000, v134
v_pk_mul_f32 v[10:11], v[10:11], v[12:13]
v_cvt_pk_bf16_f32 v198, v10, v11
v_lshlrev_b32 v10, 16, v199
v_and_b32 v11, 0xffff0000, v199
v_lshlrev_b32 v12, 16, v135
v_and_b32 v13, 0xffff0000, v135
v_pk_mul_f32 v[10:11], v[10:11], v[12:13]
v_cvt_pk_bf16_f32 v199, v10, v11
buffer_store_dwordx4 v[196:199], v9, s[12:15], s26 offen offset:576
s_waitcnt vmcnt(13)
v_lshlrev_b32 v10, 16, v200
v_and_b32 v11, 0xffff0000, v200
v_lshlrev_b32 v12, 16, v136
v_and_b32 v13, 0xffff0000, v136
v_pk_mul_f32 v[10:11], v[10:11], v[12:13]
v_cvt_pk_bf16_f32 v200, v10, v11
v_lshlrev_b32 v10, 16, v201
v_and_b32 v11, 0xffff0000, v201
v_lshlrev_b32 v12, 16, v137
v_and_b32 v13, 0xffff0000, v137
v_pk_mul_f32 v[10:11], v[10:11], v[12:13]
v_cvt_pk_bf16_f32 v201, v10, v11
v_lshlrev_b32 v10, 16, v202
v_and_b32 v11, 0xffff0000, v202
v_lshlrev_b32 v12, 16, v138
v_and_b32 v13, 0xffff0000, v138
v_pk_mul_f32 v[10:11], v[10:11], v[12:13]
v_cvt_pk_bf16_f32 v202, v10, v11
v_lshlrev_b32 v10, 16, v203
v_and_b32 v11, 0xffff0000, v203
v_lshlrev_b32 v12, 16, v139
v_and_b32 v13, 0xffff0000, v139
v_pk_mul_f32 v[10:11], v[10:11], v[12:13]
v_cvt_pk_bf16_f32 v203, v10, v11
buffer_store_dwordx4 v[200:203], v9, s[12:15], s26 offen offset:640
s_waitcnt vmcnt(13)
v_lshlrev_b32 v10, 16, v204
v_and_b32 v11, 0xffff0000, v204
v_lshlrev_b32 v12, 16, v140
v_and_b32 v13, 0xffff0000, v140
v_pk_mul_f32 v[10:11], v[10:11], v[12:13]
v_cvt_pk_bf16_f32 v204, v10, v11
v_lshlrev_b32 v10, 16, v205
v_and_b32 v11, 0xffff0000, v205
v_lshlrev_b32 v12, 16, v141
v_and_b32 v13, 0xffff0000, v141
v_pk_mul_f32 v[10:11], v[10:11], v[12:13]
v_cvt_pk_bf16_f32 v205, v10, v11
v_lshlrev_b32 v10, 16, v206
v_and_b32 v11, 0xffff0000, v206
v_lshlrev_b32 v12, 16, v142
v_and_b32 v13, 0xffff0000, v142
v_pk_mul_f32 v[10:11], v[10:11], v[12:13]
v_cvt_pk_bf16_f32 v206, v10, v11
v_lshlrev_b32 v10, 16, v207
v_and_b32 v11, 0xffff0000, v207
v_lshlrev_b32 v12, 16, v143
v_and_b32 v13, 0xffff0000, v143
v_pk_mul_f32 v[10:11], v[10:11], v[12:13]
v_cvt_pk_bf16_f32 v207, v10, v11
buffer_store_dwordx4 v[204:207], v9, s[12:15], s26 offen offset:704
s_waitcnt vmcnt(13)
v_lshlrev_b32 v10, 16, v208
v_and_b32 v11, 0xffff0000, v208
v_lshlrev_b32 v12, 16, v144
v_and_b32 v13, 0xffff0000, v144
v_pk_mul_f32 v[10:11], v[10:11], v[12:13]
v_cvt_pk_bf16_f32 v208, v10, v11
v_lshlrev_b32 v10, 16, v209
v_and_b32 v11, 0xffff0000, v209
v_lshlrev_b32 v12, 16, v145
v_and_b32 v13, 0xffff0000, v145
v_pk_mul_f32 v[10:11], v[10:11], v[12:13]
v_cvt_pk_bf16_f32 v209, v10, v11
v_lshlrev_b32 v10, 16, v210
v_and_b32 v11, 0xffff0000, v210
v_lshlrev_b32 v12, 16, v146
v_and_b32 v13, 0xffff0000, v146
v_pk_mul_f32 v[10:11], v[10:11], v[12:13]
v_cvt_pk_bf16_f32 v210, v10, v11
v_lshlrev_b32 v10, 16, v211
v_and_b32 v11, 0xffff0000, v211
v_lshlrev_b32 v12, 16, v147
v_and_b32 v13, 0xffff0000, v147
v_pk_mul_f32 v[10:11], v[10:11], v[12:13]
v_cvt_pk_bf16_f32 v211, v10, v11
buffer_store_dwordx4 v[208:211], v9, s[12:15], s26 offen offset:768
s_waitcnt vmcnt(13)
v_lshlrev_b32 v10, 16, v212
v_and_b32 v11, 0xffff0000, v212
v_lshlrev_b32 v12, 16, v148
v_and_b32 v13, 0xffff0000, v148
v_pk_mul_f32 v[10:11], v[10:11], v[12:13]
v_cvt_pk_bf16_f32 v212, v10, v11
v_lshlrev_b32 v10, 16, v213
v_and_b32 v11, 0xffff0000, v213
v_lshlrev_b32 v12, 16, v149
v_and_b32 v13, 0xffff0000, v149
v_pk_mul_f32 v[10:11], v[10:11], v[12:13]
v_cvt_pk_bf16_f32 v213, v10, v11
v_lshlrev_b32 v10, 16, v214
v_and_b32 v11, 0xffff0000, v214
v_lshlrev_b32 v12, 16, v150
v_and_b32 v13, 0xffff0000, v150
v_pk_mul_f32 v[10:11], v[10:11], v[12:13]
v_cvt_pk_bf16_f32 v214, v10, v11
v_lshlrev_b32 v10, 16, v215
v_and_b32 v11, 0xffff0000, v215
v_lshlrev_b32 v12, 16, v151
v_and_b32 v13, 0xffff0000, v151
v_pk_mul_f32 v[10:11], v[10:11], v[12:13]
v_cvt_pk_bf16_f32 v215, v10, v11
buffer_store_dwordx4 v[212:215], v9, s[12:15], s26 offen offset:832
s_branch M_fin
M_rslow:
Lp_9251:
buffer_load_dword v18, v19, s[4:7], s33 offen offset:0 sc1
s_waitcnt vmcnt(0)
v_cmp_gt_u32 vcc, 1, v18
s_cbranch_vccz Lpd_9252
s_sleep 8
s_sub_u32 s101, s101, 1
s_cbranch_scc0 Lp_9251
s_mov_b32 s101, 0
Lpd_9252:
s_branch M_rjoin
PAD_17:
s_cbranch_execz PAD_21
M_V:
v_mfma_f32_16x16x32_bf16 v[32:35], a[0:3], a[128:131], 0
s_add_u32 m0, s29, 114688
ds_read_b64_tr_b16 a[136:137], v5 offset:0
v_mfma_f32_16x16x32_bf16 v[32:35], a[4:7], a[132:135], v[32:35]
s_mov_b32 s32, 1024
buffer_load_dwordx4 v16, s[12:15], s27 offen offset:0 lds
v_mfma_f32_16x16x32_bf16 v[36:39], a[8:11], a[128:131], 0
s_mov_b32 s33, 31744
ds_read_b64_tr_b16 a[138:139], v5 offset:2048
v_mfma_f32_16x16x32_bf16 v[36:39], a[12:15], a[132:135], v[36:39]
s_mov_b32 s34, 4294935552
v_mfma_f32_16x16x32_bf16 v[40:43], a[16:19], a[128:131], 0
s_mov_b32 s35, 4294935552
ds_read_b64_tr_b16 a[140:141], v5 offset:16384
v_mfma_f32_16x16x32_bf16 v[40:43], a[20:23], a[132:135], v[40:43]
s_mov_b32 s36, 4294935552
buffer_load_dwordx4 v17, s[12:15], s27 offen offset:1024 lds
v_mfma_f32_16x16x32_bf16 v[44:47], a[24:27], a[128:131], 0
s_mov_b32 s30, 8
ds_read_b64_tr_b16 a[142:143], v5 offset:18432
v_mfma_f32_16x16x32_bf16 v[44:47], a[28:31], a[132:135], v[44:47]
s_mov_b32 s82, 3221225472
v_mfma_f32_16x16x32_bf16 v[48:51], a[32:35], a[128:131], 0
s_mul_hi_u32 s38, s2, 613566757
v_mfma_f32_16x16x32_bf16 v[48:51], a[36:39], a[132:135], v[48:51]
s_mul_i32 s39, s38, 7
buffer_load_dwordx4 v18, s[12:15], s27 offen offset:2048 lds
v_mfma_f32_16x16x32_bf16 v[52:55], a[40:43], a[128:131], 0
s_sub_u32 s39, s2, s39
v_mov_b32 v246, 0
v_mov_b32 v229, 0
v_mfma_f32_16x16x32_bf16 v[52:55], a[44:47], a[132:135], v[52:55]
v_mov_b32 v231, 0
v_mfma_f32_16x16x32_bf16 v[56:59], a[48:51], a[128:131], 0
s_mov_b32 s60, s90
v_mfma_f32_16x16x32_bf16 v[56:59], a[52:55], a[132:135], v[56:59]
s_mov_b32 s61, s91
buffer_load_dwordx4 v19, s[12:15], s27 offen offset:3072 lds
v_mfma_f32_16x16x32_bf16 v[60:63], a[56:59], a[128:131], 0
s_add_u32 s27, s27, 524288
v_mfma_f32_16x16x32_bf16 v[60:63], a[60:63], a[132:135], v[60:63]
s_waitcnt lgkmcnt(0)
s_mov_b32 s62, 256
v_mfma_f32_16x16x32_bf16 v[64:67], a[0:3], a[136:139], 0
s_add_u32 m0, s28, 0
ds_read_b64_tr_b16 a[128:129], v6 offset:0
v_mfma_f32_16x16x32_bf16 v[64:67], a[4:7], a[140:143], v[64:67]
s_mov_b32 s63, 0x20000
buffer_load_dwordx4 v12, s[8:11], s24 offen offset:0 lds
v_mfma_f32_16x16x32_bf16 v[68:71], a[8:11], a[136:139], 0
s_mul_hi_u32 s55, s2, 1431655766
ds_read_b64_tr_b16 a[130:131], v6 offset:2048
v_mfma_f32_16x16x32_bf16 v[68:71], a[12:15], a[140:143], v[68:71]
s_mul_i32 s55, s55, 3
v_mfma_f32_16x16x32_bf16 v[72:75], a[16:19], a[136:139], 0
s_sub_u32 s55, s2, s55
ds_read_b64_tr_b16 a[132:133], v6 offset:16384
v_mfma_f32_16x16x32_bf16 v[72:75], a[20:23], a[140:143], v[72:75]
s_add_u32 s55, s55, 5
buffer_load_dwordx4 v13, s[8:11], s24 offen offset:1024 lds
v_mfma_f32_16x16x32_bf16 v[76:79], a[24:27], a[136:139], 0
s_lshr_b32 s22, s2, 4
ds_read_b64_tr_b16 a[134:135], v6 offset:18432
v_mfma_f32_16x16x32_bf16 v[76:79], a[28:31], a[140:143], v[76:79]
s_lshl_b32 s23, s20, 5
v_mfma_f32_16x16x32_bf16 v[80:83], a[32:35], a[136:139], 0
s_add_u32 s23, s23, s22
v_mfma_f32_16x16x32_bf16 v[80:83], a[36:39], a[140:143], v[80:83]
s_lshl_b32 s23, s23, 2
buffer_load_dwordx4 v14, s[8:11], s24 offen offset:2048 lds
v_mfma_f32_16x16x32_bf16 v[84:87], a[40:43], a[136:139], 0
s_and_b32 s22, s2, 16
v_mfma_f32_16x16x32_bf16 v[84:87], a[44:47], a[140:143], v[84:87]
s_lshl_b32 s22, s22, 7
v_mfma_f32_16x16x32_bf16 v[88:91], a[48:51], a[136:139], 0
s_add_u32 s23, s23, s22
v_mov_b32 v28, 3221225472
v_writelane_b32 v28, s23, 0
v_mfma_f32_16x16x32_bf16 v[88:91], a[52:55], a[140:143], v[88:91]
s_add_u32 s56, s23, 16384
buffer_load_dwordx4 v15, s[8:11], s24 offen offset:3072 lds
v_mfma_f32_16x16x32_bf16 v[92:95], a[56:59], a[136:139], 0
s_add_u32 s24, s24, 128
v_writelane_b32 v28, s56, 1
v_mfma_f32_16x16x32_bf16 v[92:95], a[60:63], a[140:143], v[92:95]
s_waitcnt lgkmcnt(0)
s_add_u32 s56, s23, 4096
v_writelane_b32 v28, s56, 2
v_mfma_f32_16x16x32_bf16 v[96:99], a[0:3], a[128:131], 0
s_add_u32 m0, s28, 4096
ds_read_b64_tr_b16 a[136:137], v7 offset:0
v_mfma_f32_16x16x32_bf16 v[96:99], a[4:7], a[132:135], v[96:99]
s_sub_u32 s37, 15, s21
buffer_load_dwordx4 v12, s[8:11], s25 offen offset:0 lds
v_mfma_f32_16x16x32_bf16 v[100:103], a[8:11], a[128:131], 0
ds_read_b64_tr_b16 a[138:139], v7 offset:2048
v_mfma_f32_16x16x32_bf16 v[100:103], a[12:15], a[132:135], v[100:103]
v_mfma_f32_16x16x32_bf16 v[104:107], a[16:19], a[128:131], 0
ds_read_b64_tr_b16 a[140:141], v7 offset:16384
v_mfma_f32_16x16x32_bf16 v[104:107], a[20:23], a[132:135], v[104:107]
buffer_load_dwordx4 v13, s[8:11], s25 offen offset:1024 lds
v_mfma_f32_16x16x32_bf16 v[108:111], a[24:27], a[128:131], 0
ds_read_b64_tr_b16 a[142:143], v7 offset:18432
v_mfma_f32_16x16x32_bf16 v[108:111], a[28:31], a[132:135], v[108:111]
v_mfma_f32_16x16x32_bf16 v[112:115], a[32:35], a[128:131], 0
v_mfma_f32_16x16x32_bf16 v[112:115], a[36:39], a[132:135], v[112:115]
buffer_load_dwordx4 v14, s[8:11], s25 offen offset:2048 lds
v_mfma_f32_16x16x32_bf16 v[116:119], a[40:43], a[128:131], 0
v_mfma_f32_16x16x32_bf16 v[116:119], a[44:47], a[132:135], v[116:119]
v_mfma_f32_16x16x32_bf16 v[120:123], a[48:51], a[128:131], 0
v_mfma_f32_16x16x32_bf16 v[120:123], a[52:55], a[132:135], v[120:123]
buffer_load_dwordx4 v15, s[8:11], s25 offen offset:3072 lds
v_mfma_f32_16x16x32_bf16 v[124:127], a[56:59], a[128:131], 0
s_add_u32 s25, s25, 128
v_mfma_f32_16x16x32_bf16 v[124:127], a[60:63], a[132:135], v[124:127]
s_waitcnt vmcnt(17) lgkmcnt(0)
s_barrier
v_mfma_f32_16x16x32_bf16 v[128:131], a[0:3], a[136:139], 0
ds_read_b64_tr_b16 a[128:129], v8 offset:0
v_mfma_f32_16x16x32_bf16 v[128:131], a[4:7], a[140:143], v[128:131]
buffer_load_dword v21, v20, s[16:19], s43 offen
v_mfma_f32_16x16x32_bf16 v[132:135], a[8:11], a[136:139], 0
s_add_u32 s43, s43, s47
ds_read_b64_tr_b16 a[130:131], v8 offset:2048
v_mfma_f32_16x16x32_bf16 v[132:135], a[12:15], a[140:143], v[132:135]
s_cmp_ge_u32 s43, s51
v_mfma_f32_16x16x32_bf16 v[136:139], a[16:19], a[136:139], 0
s_cselect_b32 s43, 0, s43
ds_read_b64_tr_b16 a[132:133], v8 offset:16384
v_mfma_f32_16x16x32_bf16 v[136:139], a[20:23], a[140:143], v[136:139]
s_cselect_b32 s51, s42, s51
v_mfma_f32_16x16x32_bf16 v[140:143], a[24:27], a[136:139], 0
s_cselect_b64 s[16:17], s[40:41], s[16:17]
ds_read_b64_tr_b16 a[134:135], v8 offset:18432
v_mfma_f32_16x16x32_bf16 v[140:143], a[28:31], a[140:143], v[140:143]
s_cselect_b32 s18, s42, s18
v_mfma_f32_16x16x32_bf16 v[144:147], a[32:35], a[136:139], 0
s_cselect_b64 s[40:41], s[44:45], s[40:41]
ds_read_b128 a[64:67], v2 offset:32768
v_mfma_f32_16x16x32_bf16 v[144:147], a[36:39], a[140:143], v[144:147]
s_cselect_b32 s42, s46, s42
v_mfma_f32_16x16x32_bf16 v[148:151], a[40:43], a[136:139], 0
s_cselect_b32 s46, 0, s46
ds_read_b128 a[68:71], v3 offset:32768
v_mfma_f32_16x16x32_bf16 v[148:151], a[44:47], a[140:143], v[148:151]
ds_read_b128 a[72:75], v2 offset:34816
v_mfma_f32_16x16x32_bf16 v[152:155], a[48:51], a[136:139], 0
ds_read_b128 a[76:79], v3 offset:34816
v_mfma_f32_16x16x32_bf16 v[152:155], a[52:55], a[140:143], v[152:155]
buffer_load_dword v21, v20, s[16:19], s43 offen
v_mfma_f32_16x16x32_bf16 v[156:159], a[56:59], a[136:139], 0
s_add_u32 s43, s43, s47
ds_read_b128 a[80:83], v2 offset:36864
v_mfma_f32_16x16x32_bf16 v[156:159], a[60:63], a[140:143], v[156:159]
s_waitcnt lgkmcnt(4)
s_cmp_ge_u32 s43, s51
ds_read_b128 a[84:87], v3 offset:36864
v_mfma_f32_16x16x32_bf16 v[160:163], a[0:3], a[128:131], 0
s_cselect_b32 s43, 0, s43
ds_read_b64_tr_b16 a[136:137], v9 offset:0
v_mfma_f32_16x16x32_bf16 v[160:163], a[4:7], a[132:135], v[160:163]
s_cselect_b32 s51, s42, s51
v_mfma_f32_16x16x32_bf16 v[164:167], a[8:11], a[128:131], 0
s_cselect_b64 s[16:17], s[40:41], s[16:17]
ds_read_b64_tr_b16 a[138:139], v9 offset:2048
v_mfma_f32_16x16x32_bf16 v[164:167], a[12:15], a[132:135], v[164:167]
s_cselect_b32 s18, s42, s18
v_mfma_f32_16x16x32_bf16 v[168:171], a[16:19], a[128:131], 0
s_cselect_b64 s[40:41], s[44:45], s[40:41]
ds_read_b64_tr_b16 a[140:141], v9 offset:16384
v_mfma_f32_16x16x32_bf16 v[168:171], a[20:23], a[132:135], v[168:171]
s_cselect_b32 s42, s46, s42
v_mfma_f32_16x16x32_bf16 v[172:175], a[24:27], a[128:131], 0
s_cselect_b32 s46, 0, s46
ds_read_b64_tr_b16 a[142:143], v9 offset:18432
v_mfma_f32_16x16x32_bf16 v[172:175], a[28:31], a[132:135], v[172:175]
s_bitcmp1_b32 s2, 4
s_cselect_b32 s37, s21, s37
s_lshl_b32 s56, s37, 5
v_mfma_f32_16x16x32_bf16 v[176:179], a[32:35], a[128:131], 0
s_add_u32 s56, s56, s20
s_lshl_b32 s56, s56, 2
s_add_u32 s56, s56, 8192
v_mfma_f32_16x16x32_bf16 v[176:179], a[36:39], a[132:135], v[176:179]
v_writelane_b32 v28, s56, 3
v_mfma_f32_16x16x32_bf16 v[180:183], a[40:43], a[128:131], 0
s_add_u32 s56, s56, 2048
ds_read_b128 a[88:91], v2 offset:38912
v_writelane_b32 v28, s56, 6
v_mfma_f32_16x16x32_bf16 v[180:183], a[44:47], a[132:135], v[180:183]
s_lshl_b32 s56, s2, 2
s_add_u32 s56, s56, 12288
ds_read_b128 a[92:95], v3 offset:38912
v_mfma_f32_16x16x32_bf16 v[184:187], a[48:51], a[128:131], 0
s_waitcnt lgkmcnt(2)
ds_read_b128 a[96:99], v2 offset:40960
v_writelane_b32 v28, s56, 4
v_mfma_f32_16x16x32_bf16 v[184:187], a[52:55], a[132:135], v[184:187]
s_lshl_b32 s56, s39, 5
s_add_u32 s56, s56, s38
s_lshl_b32 s56, s56, 2
v_mfma_f32_16x16x32_bf16 v[188:191], a[56:59], a[128:131], 0
s_add_u32 s56, s56, 20480
s_cmp_lt_u32 s2, 224
ds_read_b128 a[100:103], v3 offset:40960
v_mfma_f32_16x16x32_bf16 v[188:191], a[60:63], a[132:135], v[188:191]
s_cselect_b32 s56, s56, 3221225472
ds_read_b128 a[104:107], v2 offset:43008
v_writelane_b32 v28, s56, 7
v_mfma_f32_16x16x32_bf16 v[192:195], a[0:3], a[136:139], 0
s_cmp_eq_u32 s3, 0
s_cselect_b32 s56, 94371840, 3221225472
ds_read_b64_tr_b16 a[128:129], v10 offset:0
v_mfma_f32_16x16x32_bf16 v[192:195], a[4:7], a[140:143], v[192:195]
buffer_store_dword v246, v28, s[4:7], s56 offen sc1
v_mfma_f32_16x16x32_bf16 v[196:199], a[8:11], a[136:139], 0
ds_read_b64_tr_b16 a[130:131], v10 offset:2048
v_mov_b32 v27, 1
v_mfma_f32_16x16x32_bf16 v[196:199], a[12:15], a[140:143], v[196:199]
v_cmp_eq_u32 vcc, 0, v0
v_mov_b32 v26, 3221225472
v_mfma_f32_16x16x32_bf16 v[200:203], a[16:19], a[136:139], 0
s_lshl_b32 s31, s20, 20
s_lshl_b32 s22, s21, 17
ds_read_b64_tr_b16 a[132:133], v10 offset:16384
v_mfma_f32_16x16x32_bf16 v[200:203], a[20:23], a[140:143], v[200:203]
v_cndmask_b32 v26, v26, v246, vcc
v_mfma_f32_16x16x32_bf16 v[204:207], a[24:27], a[136:139], 0
s_add_u32 s31, s31, s22
s_lshr_b32 s22, s3, 1
ds_read_b64_tr_b16 a[134:135], v10 offset:18432
v_mfma_f32_16x16x32_bf16 v[204:207], a[28:31], a[140:143], v[204:207]
s_lshl_b32 s22, s22, 16
s_add_u32 s31, s31, s22
s_and_b32 s22, s3, 1
v_mfma_f32_16x16x32_bf16 v[208:211], a[32:35], a[136:139], 0
s_lshl_b32 s22, s22, 14
s_add_u32 s31, s31, s22
s_add_u32 s31, s31, 16777216
v_mfma_f32_16x16x32_bf16 v[208:211], a[36:39], a[140:143], v[208:211]
v_mfma_f32_16x16x32_bf16 v[212:215], a[40:43], a[136:139], 0
ds_read_b128 a[108:111], v3 offset:43008
v_mfma_f32_16x16x32_bf16 v[212:215], a[44:47], a[140:143], v[212:215]
ds_read_b128 a[112:115], v2 offset:45056
v_mfma_f32_16x16x32_bf16 v[216:219], a[48:51], a[136:139], 0
ds_read_b128 a[116:119], v3 offset:45056
v_mfma_f32_16x16x32_bf16 v[216:219], a[52:55], a[140:143], v[216:219]
v_mfma_f32_16x16x32_bf16 v[220:223], a[56:59], a[136:139], 0
ds_read_b128 a[120:123], v2 offset:47104
v_mfma_f32_16x16x32_bf16 v[220:223], a[60:63], a[140:143], v[220:223]
s_waitcnt lgkmcnt(4)
ds_read_b128 a[124:127], v3 offset:47104
v_mfma_f32_16x16x32_bf16 a[192:195], a[0:3], a[128:131], 0
ds_read_b64_tr_b16 a[136:137], v11 offset:0
v_mfma_f32_16x16x32_bf16 a[192:195], a[4:7], a[132:135], a[192:195]
v_mfma_f32_16x16x32_bf16 a[196:199], a[8:11], a[128:131], 0
ds_read_b64_tr_b16 a[138:139], v11 offset:2048
v_mfma_f32_16x16x32_bf16 a[196:199], a[12:15], a[132:135], a[196:199]
v_mfma_f32_16x16x32_bf16 a[200:203], a[16:19], a[128:131], 0
ds_read_b64_tr_b16 a[140:141], v11 offset:16384
v_mfma_f32_16x16x32_bf16 a[200:203], a[20:23], a[132:135], a[200:203]
v_mfma_f32_16x16x32_bf16 a[204:207], a[24:27], a[128:131], 0
ds_read_b64_tr_b16 a[142:143], v11 offset:18432
v_mfma_f32_16x16x32_bf16 a[204:207], a[28:31], a[132:135], a[204:207]
v_mfma_f32_16x16x32_bf16 a[208:211], a[32:35], a[128:131], 0
v_mfma_f32_16x16x32_bf16 a[208:211], a[36:39], a[132:135], a[208:211]
v_mfma_f32_16x16x32_bf16 a[212:215], a[40:43], a[128:131], 0
v_mfma_f32_16x16x32_bf16 a[212:215], a[44:47], a[132:135], a[212:215]
v_mfma_f32_16x16x32_bf16 a[216:219], a[48:51], a[128:131], 0
v_mfma_f32_16x16x32_bf16 a[216:219], a[52:55], a[132:135], a[216:219]
v_mfma_f32_16x16x32_bf16 a[220:223], a[56:59], a[128:131], 0
v_mfma_f32_16x16x32_bf16 a[220:223], a[60:63], a[132:135], a[220:223]
s_waitcnt vmcnt(3) lgkmcnt(0)
s_barrier
v_mfma_f32_16x16x32_bf16 a[224:227], a[0:3], a[136:139], 0
s_add_u32 m0, s29, 65536
ds_read_b64_tr_b16 a[128:129], v4 offset:32768
v_mfma_f32_16x16x32_bf16 a[224:227], a[4:7], a[140:143], a[224:227]
buffer_load_dwordx4 v16, s[12:15], s26 offen offset:0 lds
v_mfma_f32_16x16x32_bf16 a[228:231], a[8:11], a[136:139], 0
ds_read_b64_tr_b16 a[130:131], v4 offset:34816
v_mfma_f32_16x16x32_bf16 a[228:231], a[12:15], a[140:143], a[228:231]
v_mfma_f32_16x16x32_bf16 a[232:235], a[16:19], a[136:139], 0
ds_read_b64_tr_b16 a[132:133], v4 offset:49152
v_mfma_f32_16x16x32_bf16 a[232:235], a[20:23], a[140:143], a[232:235]
buffer_load_dwordx4 v17, s[12:15], s26 offen offset:1024 lds
v_mfma_f32_16x16x32_bf16 a[236:239], a[24:27], a[136:139], 0
ds_read_b64_tr_b16 a[134:135], v4 offset:51200
v_mfma_f32_16x16x32_bf16 a[236:239], a[28:31], a[140:143], a[236:239]
v_mfma_f32_16x16x32_bf16 a[240:243], a[32:35], a[136:139], 0
PAD_18:
s_cbranch_execz PAD_22
v_mfma_f32_16x16x32_bf16 a[240:243], a[36:39], a[140:143], a[240:243]
buffer_load_dwordx4 v18, s[12:15], s26 offen offset:2048 lds
v_mfma_f32_16x16x32_bf16 a[244:247], a[40:43], a[136:139], 0
v_mfma_f32_16x16x32_bf16 a[244:247], a[44:47], a[140:143], a[244:247]
v_mfma_f32_16x16x32_bf16 a[248:251], a[48:51], a[136:139], 0
v_mfma_f32_16x16x32_bf16 a[248:251], a[52:55], a[140:143], a[248:251]
buffer_load_dwordx4 v19, s[12:15], s26 offen offset:3072 lds
v_mfma_f32_16x16x32_bf16 a[252:255], a[56:59], a[136:139], 0
s_add_u32 s26, s26, 524288
v_mfma_f32_16x16x32_bf16 a[252:255], a[60:63], a[140:143], a[252:255]
s_waitcnt lgkmcnt(0)
Lg_501:
v_mfma_f32_16x16x32_bf16 v[32:35], a[64:67], a[128:131], v[32:35]
s_add_u32 m0, s29, 81920
ds_read_b64_tr_b16 a[136:137], v5 offset:32768
v_mfma_f32_16x16x32_bf16 v[32:35], a[68:71], a[132:135], v[32:35]
buffer_load_dwordx4 v16, s[12:15], s27 offen offset:0 lds
v_mfma_f32_16x16x32_bf16 v[36:39], a[72:75], a[128:131], v[36:39]
ds_read_b64_tr_b16 a[138:139], v5 offset:34816
v_mfma_f32_16x16x32_bf16 v[36:39], a[76:79], a[132:135], v[36:39]
v_mfma_f32_16x16x32_bf16 v[40:43], a[80:83], a[128:131], v[40:43]
ds_read_b64_tr_b16 a[140:141], v5 offset:49152
v_mfma_f32_16x16x32_bf16 v[40:43], a[84:87], a[132:135], v[40:43]
buffer_load_dwordx4 v17, s[12:15], s27 offen offset:1024 lds
v_mfma_f32_16x16x32_bf16 v[44:47], a[88:91], a[128:131], v[44:47]
ds_read_b64_tr_b16 a[142:143], v5 offset:51200
v_mfma_f32_16x16x32_bf16 v[44:47], a[92:95], a[132:135], v[44:47]
v_mfma_f32_16x16x32_bf16 v[48:51], a[96:99], a[128:131], v[48:51]
ds_read_b128 a[0:3], v2 offset:0
v_mfma_f32_16x16x32_bf16 v[48:51], a[100:103], a[132:135], v[48:51]
buffer_load_dwordx4 v18, s[12:15], s27 offen offset:2048 lds
v_mfma_f32_16x16x32_bf16 v[52:55], a[104:107], a[128:131], v[52:55]
ds_read_b128 a[4:7], v3 offset:0
v_mfma_f32_16x16x32_bf16 v[52:55], a[108:111], a[132:135], v[52:55]
v_mfma_f32_16x16x32_bf16 v[56:59], a[112:115], a[128:131], v[56:59]
v_mfma_f32_16x16x32_bf16 v[56:59], a[116:119], a[132:135], v[56:59]
buffer_load_dwordx4 v19, s[12:15], s27 offen offset:3072 lds
v_mfma_f32_16x16x32_bf16 v[60:63], a[120:123], a[128:131], v[60:63]
s_add_u32 s27, s27, 524288
ds_read_b128 a[8:11], v2 offset:2048
v_mfma_f32_16x16x32_bf16 v[60:63], a[124:127], a[132:135], v[60:63]
s_waitcnt lgkmcnt(2)
v_mfma_f32_16x16x32_bf16 v[64:67], a[64:67], a[136:139], v[64:67]
s_add_u32 m0, s28, 32768
ds_read_b64_tr_b16 a[128:129], v6 offset:32768
v_mfma_f32_16x16x32_bf16 v[64:67], a[68:71], a[140:143], v[64:67]
buffer_load_dwordx4 v12, s[8:11], s24 offen offset:0 lds
v_mfma_f32_16x16x32_bf16 v[68:71], a[72:75], a[136:139], v[68:71]
ds_read_b64_tr_b16 a[130:131], v6 offset:34816
v_mfma_f32_16x16x32_bf16 v[68:71], a[76:79], a[140:143], v[68:71]
v_mfma_f32_16x16x32_bf16 v[72:75], a[80:83], a[136:139], v[72:75]
ds_read_b64_tr_b16 a[132:133], v6 offset:49152
v_mfma_f32_16x16x32_bf16 v[72:75], a[84:87], a[140:143], v[72:75]
buffer_load_dwordx4 v13, s[8:11], s24 offen offset:1024 lds
v_mfma_f32_16x16x32_bf16 v[76:79], a[88:91], a[136:139], v[76:79]
ds_read_b64_tr_b16 a[134:135], v6 offset:51200
v_mfma_f32_16x16x32_bf16 v[76:79], a[92:95], a[140:143], v[76:79]
v_mfma_f32_16x16x32_bf16 v[80:83], a[96:99], a[136:139], v[80:83]
ds_read_b128 a[12:15], v3 offset:2048
v_mfma_f32_16x16x32_bf16 v[80:83], a[100:103], a[140:143], v[80:83]
buffer_load_dwordx4 v14, s[8:11], s24 offen offset:2048 lds
v_mfma_f32_16x16x32_bf16 v[84:87], a[104:107], a[136:139], v[84:87]
v_mfma_f32_16x16x32_bf16 v[84:87], a[108:111], a[140:143], v[84:87]
v_mfma_f32_16x16x32_bf16 v[88:91], a[112:115], a[136:139], v[88:91]
ds_read_b128 a[16:19], v2 offset:4096
v_mfma_f32_16x16x32_bf16 v[88:91], a[116:119], a[140:143], v[88:91]
buffer_load_dwordx4 v15, s[8:11], s24 offen offset:3072 lds
v_mfma_f32_16x16x32_bf16 v[92:95], a[120:123], a[136:139], v[92:95]
s_add_u32 s24, s24, 128
ds_read_b128 a[20:23], v3 offset:4096
v_mfma_f32_16x16x32_bf16 v[92:95], a[124:127], a[140:143], v[92:95]
s_waitcnt lgkmcnt(2)
v_mfma_f32_16x16x32_bf16 v[96:99], a[64:67], a[128:131], v[96:99]
s_add_u32 m0, s28, 36864
ds_read_b64_tr_b16 a[136:137], v7 offset:32768
v_mfma_f32_16x16x32_bf16 v[96:99], a[68:71], a[132:135], v[96:99]
buffer_load_dwordx4 v12, s[8:11], s25 offen offset:0 lds
v_mfma_f32_16x16x32_bf16 v[100:103], a[72:75], a[128:131], v[100:103]
ds_read_b64_tr_b16 a[138:139], v7 offset:34816
v_mfma_f32_16x16x32_bf16 v[100:103], a[76:79], a[132:135], v[100:103]
v_mfma_f32_16x16x32_bf16 v[104:107], a[80:83], a[128:131], v[104:107]
ds_read_b64_tr_b16 a[140:141], v7 offset:49152
v_mfma_f32_16x16x32_bf16 v[104:107], a[84:87], a[132:135], v[104:107]
buffer_load_dwordx4 v13, s[8:11], s25 offen offset:1024 lds
v_mfma_f32_16x16x32_bf16 v[108:111], a[88:91], a[128:131], v[108:111]
ds_read_b64_tr_b16 a[142:143], v7 offset:51200
v_mfma_f32_16x16x32_bf16 v[108:111], a[92:95], a[132:135], v[108:111]
v_mfma_f32_16x16x32_bf16 v[112:115], a[96:99], a[128:131], v[112:115]
v_mfma_f32_16x16x32_bf16 v[112:115], a[100:103], a[132:135], v[112:115]
buffer_load_dwordx4 v14, s[8:11], s25 offen offset:2048 lds
v_mfma_f32_16x16x32_bf16 v[116:119], a[104:107], a[128:131], v[116:119]
ds_read_b128 a[24:27], v2 offset:6144
v_mfma_f32_16x16x32_bf16 v[116:119], a[108:111], a[132:135], v[116:119]
v_mfma_f32_16x16x32_bf16 v[120:123], a[112:115], a[128:131], v[120:123]
ds_read_b128 a[28:31], v3 offset:6144
v_mfma_f32_16x16x32_bf16 v[120:123], a[116:119], a[132:135], v[120:123]
buffer_load_dwordx4 v15, s[8:11], s25 offen offset:3072 lds
v_mfma_f32_16x16x32_bf16 v[124:127], a[120:123], a[128:131], v[124:127]
s_add_u32 s25, s25, 128
v_mfma_f32_16x16x32_bf16 v[124:127], a[124:127], a[132:135], v[124:127]
s_waitcnt lgkmcnt(2)
v_mfma_f32_16x16x32_bf16 v[128:131], a[64:67], a[136:139], v[128:131]
ds_read_b64_tr_b16 a[128:129], v8 offset:32768
v_mfma_f32_16x16x32_bf16 v[128:131], a[68:71], a[140:143], v[128:131]
buffer_load_dword v21, v20, s[16:19], s43 offen
v_mfma_f32_16x16x32_bf16 v[132:135], a[72:75], a[136:139], v[132:135]
s_add_u32 s43, s43, s47
ds_read_b64_tr_b16 a[130:131], v8 offset:34816
v_mfma_f32_16x16x32_bf16 v[132:135], a[76:79], a[140:143], v[132:135]
s_cmp_ge_u32 s43, s51
v_mfma_f32_16x16x32_bf16 v[136:139], a[80:83], a[136:139], v[136:139]
s_cselect_b32 s43, 0, s43
ds_read_b64_tr_b16 a[132:133], v8 offset:49152
v_mfma_f32_16x16x32_bf16 v[136:139], a[84:87], a[140:143], v[136:139]
s_cselect_b32 s51, s42, s51
v_mfma_f32_16x16x32_bf16 v[140:143], a[88:91], a[136:139], v[140:143]
s_cselect_b64 s[16:17], s[40:41], s[16:17]
ds_read_b64_tr_b16 a[134:135], v8 offset:51200
v_mfma_f32_16x16x32_bf16 v[140:143], a[92:95], a[140:143], v[140:143]
s_cselect_b32 s18, s42, s18
v_mfma_f32_16x16x32_bf16 v[144:147], a[96:99], a[136:139], v[144:147]
s_cselect_b64 s[40:41], s[44:45], s[40:41]
ds_read_b128 a[32:35], v2 offset:8192
v_mfma_f32_16x16x32_bf16 v[144:147], a[100:103], a[140:143], v[144:147]
s_cselect_b32 s42, s46, s42
v_mfma_f32_16x16x32_bf16 v[148:151], a[104:107], a[136:139], v[148:151]
s_cselect_b32 s46, 0, s46
v_mfma_f32_16x16x32_bf16 v[148:151], a[108:111], a[140:143], v[148:151]
s_cmp_eq_u32 s30, s55
v_mfma_f32_16x16x32_bf16 v[152:155], a[112:115], a[136:139], v[152:155]
s_cselect_b32 s22, 0, 3221225472
ds_read_b128 a[36:39], v3 offset:8192
v_mfma_f32_16x16x32_bf16 v[152:155], a[116:119], a[140:143], v[152:155]
s_sub_u32 s30, s30, 1
buffer_atomic_add v27, v26, s[60:63], s22 offen sc1
v_mfma_f32_16x16x32_bf16 v[156:159], a[120:123], a[136:139], v[156:159]
ds_read_b128 a[40:43], v2 offset:10240
v_mfma_f32_16x16x32_bf16 v[156:159], a[124:127], a[140:143], v[156:159]
s_waitcnt lgkmcnt(2)
v_mfma_f32_16x16x32_bf16 v[160:163], a[64:67], a[128:131], v[160:163]
ds_read_b64_tr_b16 a[136:137], v9 offset:32768
v_mfma_f32_16x16x32_bf16 v[160:163], a[68:71], a[132:135], v[160:163]
v_mfma_f32_16x16x32_bf16 v[164:167], a[72:75], a[128:131], v[164:167]
ds_read_b64_tr_b16 a[138:139], v9 offset:34816
v_mfma_f32_16x16x32_bf16 v[164:167], a[76:79], a[132:135], v[164:167]
v_mfma_f32_16x16x32_bf16 v[168:171], a[80:83], a[128:131], v[168:171]
ds_read_b64_tr_b16 a[140:141], v9 offset:49152
v_mfma_f32_16x16x32_bf16 v[168:171], a[84:87], a[132:135], v[168:171]
v_mfma_f32_16x16x32_bf16 v[172:175], a[88:91], a[128:131], v[172:175]
ds_read_b64_tr_b16 a[142:143], v9 offset:51200
v_mfma_f32_16x16x32_bf16 v[172:175], a[92:95], a[132:135], v[172:175]
v_mfma_f32_16x16x32_bf16 v[176:179], a[96:99], a[128:131], v[176:179]
v_mfma_f32_16x16x32_bf16 v[176:179], a[100:103], a[132:135], v[176:179]
v_mfma_f32_16x16x32_bf16 v[180:183], a[104:107], a[128:131], v[180:183]
ds_read_b128 a[44:47], v3 offset:10240
v_mfma_f32_16x16x32_bf16 v[180:183], a[108:111], a[132:135], v[180:183]
v_mfma_f32_16x16x32_bf16 v[184:187], a[112:115], a[128:131], v[184:187]
ds_read_b128 a[48:51], v2 offset:12288
v_mfma_f32_16x16x32_bf16 v[184:187], a[116:119], a[132:135], v[184:187]
v_mfma_f32_16x16x32_bf16 v[188:191], a[120:123], a[128:131], v[188:191]
v_mfma_f32_16x16x32_bf16 v[188:191], a[124:127], a[132:135], v[188:191]
s_waitcnt lgkmcnt(2)
v_mfma_f32_16x16x32_bf16 v[192:195], a[64:67], a[136:139], v[192:195]
ds_read_b64_tr_b16 a[128:129], v10 offset:32768
v_mfma_f32_16x16x32_bf16 v[192:195], a[68:71], a[140:143], v[192:195]
v_mfma_f32_16x16x32_bf16 v[196:199], a[72:75], a[136:139], v[196:199]
ds_read_b64_tr_b16 a[130:131], v10 offset:34816
v_mfma_f32_16x16x32_bf16 v[196:199], a[76:79], a[140:143], v[196:199]
v_mfma_f32_16x16x32_bf16 v[200:203], a[80:83], a[136:139], v[200:203]
ds_read_b64_tr_b16 a[132:133], v10 offset:49152
v_mfma_f32_16x16x32_bf16 v[200:203], a[84:87], a[140:143], v[200:203]
v_mfma_f32_16x16x32_bf16 v[204:207], a[88:91], a[136:139], v[204:207]
ds_read_b64_tr_b16 a[134:135], v10 offset:51200
v_mfma_f32_16x16x32_bf16 v[204:207], a[92:95], a[140:143], v[204:207]
v_mfma_f32_16x16x32_bf16 v[208:211], a[96:99], a[136:139], v[208:211]
ds_read_b128 a[52:55], v3 offset:12288
v_mfma_f32_16x16x32_bf16 v[208:211], a[100:103], a[140:143], v[208:211]
v_mfma_f32_16x16x32_bf16 v[212:215], a[104:107], a[136:139], v[212:215]
ds_read_b128 a[56:59], v2 offset:14336
v_mfma_f32_16x16x32_bf16 v[212:215], a[108:111], a[140:143], v[212:215]
v_mfma_f32_16x16x32_bf16 v[216:219], a[112:115], a[136:139], v[216:219]
v_mfma_f32_16x16x32_bf16 v[216:219], a[116:119], a[140:143], v[216:219]
v_mfma_f32_16x16x32_bf16 v[220:223], a[120:123], a[136:139], v[220:223]
ds_read_b128 a[60:63], v3 offset:14336
v_mfma_f32_16x16x32_bf16 v[220:223], a[124:127], a[140:143], v[220:223]
s_waitcnt lgkmcnt(2)
v_mfma_f32_16x16x32_bf16 a[192:195], a[64:67], a[128:131], a[192:195]
ds_read_b64_tr_b16 a[136:137], v11 offset:32768
v_mfma_f32_16x16x32_bf16 a[192:195], a[68:71], a[132:135], a[192:195]
v_mfma_f32_16x16x32_bf16 a[196:199], a[72:75], a[128:131], a[196:199]
ds_read_b64_tr_b16 a[138:139], v11 offset:34816
v_mfma_f32_16x16x32_bf16 a[196:199], a[76:79], a[132:135], a[196:199]
v_mfma_f32_16x16x32_bf16 a[200:203], a[80:83], a[128:131], a[200:203]
ds_read_b64_tr_b16 a[140:141], v11 offset:49152
v_mfma_f32_16x16x32_bf16 a[200:203], a[84:87], a[132:135], a[200:203]
v_mfma_f32_16x16x32_bf16 a[204:207], a[88:91], a[128:131], a[204:207]
ds_read_b64_tr_b16 a[142:143], v11 offset:51200
v_mfma_f32_16x16x32_bf16 a[204:207], a[92:95], a[132:135], a[204:207]
v_mfma_f32_16x16x32_bf16 a[208:211], a[96:99], a[128:131], a[208:211]
v_mfma_f32_16x16x32_bf16 a[208:211], a[100:103], a[132:135], a[208:211]
v_mfma_f32_16x16x32_bf16 a[212:215], a[104:107], a[128:131], a[212:215]
v_mfma_f32_16x16x32_bf16 a[212:215], a[108:111], a[132:135], a[212:215]
v_mfma_f32_16x16x32_bf16 a[216:219], a[112:115], a[128:131], a[216:219]
v_mfma_f32_16x16x32_bf16 a[216:219], a[116:119], a[132:135], a[216:219]
v_mfma_f32_16x16x32_bf16 a[220:223], a[120:123], a[128:131], a[220:223]
v_mfma_f32_16x16x32_bf16 a[220:223], a[124:127], a[132:135], a[220:223]
s_waitcnt vmcnt(2) lgkmcnt(0)
s_barrier
v_mfma_f32_16x16x32_bf16 a[224:227], a[64:67], a[136:139], a[224:227]
s_add_u32 m0, s29, 98304
ds_read_b64_tr_b16 a[128:129], v4 offset:0
v_mfma_f32_16x16x32_bf16 a[224:227], a[68:71], a[140:143], a[224:227]
buffer_load_dwordx4 v16, s[12:15], s26 offen offset:0 lds
v_mfma_f32_16x16x32_bf16 a[228:231], a[72:75], a[136:139], a[228:231]
ds_read_b64_tr_b16 a[130:131], v4 offset:2048
v_mfma_f32_16x16x32_bf16 a[228:231], a[76:79], a[140:143], a[228:231]
v_mfma_f32_16x16x32_bf16 a[232:235], a[80:83], a[136:139], a[232:235]
ds_read_b64_tr_b16 a[132:133], v4 offset:16384
v_mfma_f32_16x16x32_bf16 a[232:235], a[84:87], a[140:143], a[232:235]
buffer_load_dwordx4 v17, s[12:15], s26 offen offset:1024 lds
v_mfma_f32_16x16x32_bf16 a[236:239], a[88:91], a[136:139], a[236:239]
ds_read_b64_tr_b16 a[134:135], v4 offset:18432
v_mfma_f32_16x16x32_bf16 a[236:239], a[92:95], a[140:143], a[236:239]
v_mfma_f32_16x16x32_bf16 a[240:243], a[96:99], a[136:139], a[240:243]
v_mfma_f32_16x16x32_bf16 a[240:243], a[100:103], a[140:143], a[240:243]
buffer_load_dwordx4 v18, s[12:15], s26 offen offset:2048 lds
v_mfma_f32_16x16x32_bf16 a[244:247], a[104:107], a[136:139], a[244:247]
v_mfma_f32_16x16x32_bf16 a[244:247], a[108:111], a[140:143], a[244:247]
v_mfma_f32_16x16x32_bf16 a[248:251], a[112:115], a[136:139], a[248:251]
v_mfma_f32_16x16x32_bf16 a[248:251], a[116:119], a[140:143], a[248:251]
buffer_load_dwordx4 v19, s[12:15], s26 offen offset:3072 lds
v_mfma_f32_16x16x32_bf16 a[252:255], a[120:123], a[136:139], a[252:255]
s_add_u32 s26, s26, 524288
v_mfma_f32_16x16x32_bf16 a[252:255], a[124:127], a[140:143], a[252:255]
s_waitcnt lgkmcnt(0)
buffer_store_dword v27, v26, s[4:7], s82 offen sc1
v_mfma_f32_16x16x32_bf16 v[32:35], a[0:3], a[128:131], v[32:35]
s_add_u32 m0, s29, 114688
ds_read_b64_tr_b16 a[136:137], v5 offset:0
v_mfma_f32_16x16x32_bf16 v[32:35], a[4:7], a[132:135], v[32:35]
buffer_load_dwordx4 v16, s[12:15], s27 offen offset:0 lds
v_mfma_f32_16x16x32_bf16 v[36:39], a[8:11], a[128:131], v[36:39]
ds_read_b64_tr_b16 a[138:139], v5 offset:2048
v_mfma_f32_16x16x32_bf16 v[36:39], a[12:15], a[132:135], v[36:39]
v_mfma_f32_16x16x32_bf16 v[40:43], a[16:19], a[128:131], v[40:43]
ds_read_b64_tr_b16 a[140:141], v5 offset:16384
v_mfma_f32_16x16x32_bf16 v[40:43], a[20:23], a[132:135], v[40:43]
buffer_load_dwordx4 v17, s[12:15], s27 offen offset:1024 lds
v_mfma_f32_16x16x32_bf16 v[44:47], a[24:27], a[128:131], v[44:47]
ds_read_b64_tr_b16 a[142:143], v5 offset:18432
v_mfma_f32_16x16x32_bf16 v[44:47], a[28:31], a[132:135], v[44:47]
v_mfma_f32_16x16x32_bf16 v[48:51], a[32:35], a[128:131], v[48:51]
ds_read_b128 a[64:67], v2 offset:32768
v_mfma_f32_16x16x32_bf16 v[48:51], a[36:39], a[132:135], v[48:51]
buffer_load_dwordx4 v18, s[12:15], s27 offen offset:2048 lds
v_mfma_f32_16x16x32_bf16 v[52:55], a[40:43], a[128:131], v[52:55]
ds_read_b128 a[68:71], v3 offset:32768
v_mfma_f32_16x16x32_bf16 v[52:55], a[44:47], a[132:135], v[52:55]
v_mfma_f32_16x16x32_bf16 v[56:59], a[48:51], a[128:131], v[56:59]
v_mfma_f32_16x16x32_bf16 v[56:59], a[52:55], a[132:135], v[56:59]
buffer_load_dwordx4 v19, s[12:15], s27 offen offset:3072 lds
v_mfma_f32_16x16x32_bf16 v[60:63], a[56:59], a[128:131], v[60:63]
s_add_u32 s27, s27, 524288
ds_read_b128 a[72:75], v2 offset:34816
v_mfma_f32_16x16x32_bf16 v[60:63], a[60:63], a[132:135], v[60:63]
s_waitcnt lgkmcnt(2)
v_mfma_f32_16x16x32_bf16 v[64:67], a[0:3], a[136:139], v[64:67]
s_add_u32 m0, s28, 0
ds_read_b64_tr_b16 a[128:129], v6 offset:0
v_mfma_f32_16x16x32_bf16 v[64:67], a[4:7], a[140:143], v[64:67]
buffer_load_dwordx4 v12, s[8:11], s24 offen offset:0 lds
v_mfma_f32_16x16x32_bf16 v[68:71], a[8:11], a[136:139], v[68:71]
ds_read_b64_tr_b16 a[130:131], v6 offset:2048
v_mfma_f32_16x16x32_bf16 v[68:71], a[12:15], a[140:143], v[68:71]
v_mfma_f32_16x16x32_bf16 v[72:75], a[16:19], a[136:139], v[72:75]
ds_read_b64_tr_b16 a[132:133], v6 offset:16384
v_mfma_f32_16x16x32_bf16 v[72:75], a[20:23], a[140:143], v[72:75]
buffer_load_dwordx4 v13, s[8:11], s24 offen offset:1024 lds
v_mfma_f32_16x16x32_bf16 v[76:79], a[24:27], a[136:139], v[76:79]
ds_read_b64_tr_b16 a[134:135], v6 offset:18432
v_mfma_f32_16x16x32_bf16 v[76:79], a[28:31], a[140:143], v[76:79]
v_mfma_f32_16x16x32_bf16 v[80:83], a[32:35], a[136:139], v[80:83]
ds_read_b128 a[76:79], v3 offset:34816
v_mfma_f32_16x16x32_bf16 v[80:83], a[36:39], a[140:143], v[80:83]
buffer_load_dwordx4 v14, s[8:11], s24 offen offset:2048 lds
v_mfma_f32_16x16x32_bf16 v[84:87], a[40:43], a[136:139], v[84:87]
v_mfma_f32_16x16x32_bf16 v[84:87], a[44:47], a[140:143], v[84:87]
v_mfma_f32_16x16x32_bf16 v[88:91], a[48:51], a[136:139], v[88:91]
ds_read_b128 a[80:83], v2 offset:36864
v_mfma_f32_16x16x32_bf16 v[88:91], a[52:55], a[140:143], v[88:91]
buffer_load_dwordx4 v15, s[8:11], s24 offen offset:3072 lds
v_mfma_f32_16x16x32_bf16 v[92:95], a[56:59], a[136:139], v[92:95]
s_add_u32 s24, s24, 128
ds_read_b128 a[84:87], v3 offset:36864
v_mfma_f32_16x16x32_bf16 v[92:95], a[60:63], a[140:143], v[92:95]
s_waitcnt lgkmcnt(2)
v_mfma_f32_16x16x32_bf16 v[96:99], a[0:3], a[128:131], v[96:99]
s_add_u32 m0, s28, 4096
ds_read_b64_tr_b16 a[136:137], v7 offset:0
v_mfma_f32_16x16x32_bf16 v[96:99], a[4:7], a[132:135], v[96:99]
buffer_load_dwordx4 v12, s[8:11], s25 offen offset:0 lds
v_mfma_f32_16x16x32_bf16 v[100:103], a[8:11], a[128:131], v[100:103]
ds_read_b64_tr_b16 a[138:139], v7 offset:2048
v_mfma_f32_16x16x32_bf16 v[100:103], a[12:15], a[132:135], v[100:103]
v_mfma_f32_16x16x32_bf16 v[104:107], a[16:19], a[128:131], v[104:107]
ds_read_b64_tr_b16 a[140:141], v7 offset:16384
v_mfma_f32_16x16x32_bf16 v[104:107], a[20:23], a[132:135], v[104:107]
buffer_load_dwordx4 v13, s[8:11], s25 offen offset:1024 lds
v_mfma_f32_16x16x32_bf16 v[108:111], a[24:27], a[128:131], v[108:111]
ds_read_b64_tr_b16 a[142:143], v7 offset:18432
v_mfma_f32_16x16x32_bf16 v[108:111], a[28:31], a[132:135], v[108:111]
v_mfma_f32_16x16x32_bf16 v[112:115], a[32:35], a[128:131], v[112:115]
v_mfma_f32_16x16x32_bf16 v[112:115], a[36:39], a[132:135], v[112:115]
buffer_load_dwordx4 v14, s[8:11], s25 offen offset:2048 lds
v_mfma_f32_16x16x32_bf16 v[116:119], a[40:43], a[128:131], v[116:119]
ds_read_b128 a[88:91], v2 offset:38912
v_mfma_f32_16x16x32_bf16 v[116:119], a[44:47], a[132:135], v[116:119]
v_mfma_f32_16x16x32_bf16 v[120:123], a[48:51], a[128:131], v[120:123]
ds_read_b128 a[92:95], v3 offset:38912
v_mfma_f32_16x16x32_bf16 v[120:123], a[52:55], a[132:135], v[120:123]
buffer_load_dwordx4 v15, s[8:11], s25 offen offset:3072 lds
v_mfma_f32_16x16x32_bf16 v[124:127], a[56:59], a[128:131], v[124:127]
s_add_u32 s25, s25, 128
v_mfma_f32_16x16x32_bf16 v[124:127], a[60:63], a[132:135], v[124:127]
s_waitcnt lgkmcnt(2)
v_mfma_f32_16x16x32_bf16 v[128:131], a[0:3], a[136:139], v[128:131]
ds_read_b64_tr_b16 a[128:129], v8 offset:0
v_mfma_f32_16x16x32_bf16 v[128:131], a[4:7], a[140:143], v[128:131]
buffer_load_dword v21, v20, s[16:19], s43 offen
v_mfma_f32_16x16x32_bf16 v[132:135], a[8:11], a[136:139], v[132:135]
s_add_u32 s43, s43, s47
ds_read_b64_tr_b16 a[130:131], v8 offset:2048
v_mfma_f32_16x16x32_bf16 v[132:135], a[12:15], a[140:143], v[132:135]
s_cmp_ge_u32 s43, s51
v_mfma_f32_16x16x32_bf16 v[136:139], a[16:19], a[136:139], v[136:139]
s_cselect_b32 s43, 0, s43
ds_read_b64_tr_b16 a[132:133], v8 offset:16384
v_mfma_f32_16x16x32_bf16 v[136:139], a[20:23], a[140:143], v[136:139]
s_cselect_b32 s51, s42, s51
v_mfma_f32_16x16x32_bf16 v[140:143], a[24:27], a[136:139], v[140:143]
s_cselect_b64 s[16:17], s[40:41], s[16:17]
ds_read_b64_tr_b16 a[134:135], v8 offset:18432
v_mfma_f32_16x16x32_bf16 v[140:143], a[28:31], a[140:143], v[140:143]
s_cselect_b32 s18, s42, s18
v_mfma_f32_16x16x32_bf16 v[144:147], a[32:35], a[136:139], v[144:147]
s_cselect_b64 s[40:41], s[44:45], s[40:41]
ds_read_b128 a[96:99], v2 offset:40960
v_mfma_f32_16x16x32_bf16 v[144:147], a[36:39], a[140:143], v[144:147]
s_cselect_b32 s42, s46, s42
v_mfma_f32_16x16x32_bf16 v[148:151], a[40:43], a[136:139], v[148:151]
s_cselect_b32 s46, 0, s46
v_mfma_f32_16x16x32_bf16 v[148:151], a[44:47], a[140:143], v[148:151]
s_cmp_eq_u32 s30, s55
v_mfma_f32_16x16x32_bf16 v[152:155], a[48:51], a[136:139], v[152:155]
s_cselect_b32 s22, 0, 3221225472
ds_read_b128 a[100:103], v3 offset:40960
v_mfma_f32_16x16x32_bf16 v[152:155], a[52:55], a[140:143], v[152:155]
s_sub_u32 s30, s30, 1
buffer_atomic_add v27, v26, s[60:63], s22 offen sc1
v_mfma_f32_16x16x32_bf16 v[156:159], a[56:59], a[136:139], v[156:159]
ds_read_b128 a[104:107], v2 offset:43008
v_mfma_f32_16x16x32_bf16 v[156:159], a[60:63], a[140:143], v[156:159]
s_waitcnt lgkmcnt(2)
v_mfma_f32_16x16x32_bf16 v[160:163], a[0:3], a[128:131], v[160:163]
ds_read_b64_tr_b16 a[136:137], v9 offset:0
v_mfma_f32_16x16x32_bf16 v[160:163], a[4:7], a[132:135], v[160:163]
v_mfma_f32_16x16x32_bf16 v[164:167], a[8:11], a[128:131], v[164:167]
ds_read_b64_tr_b16 a[138:139], v9 offset:2048
v_mfma_f32_16x16x32_bf16 v[164:167], a[12:15], a[132:135], v[164:167]
v_mfma_f32_16x16x32_bf16 v[168:171], a[16:19], a[128:131], v[168:171]
ds_read_b64_tr_b16 a[140:141], v9 offset:16384
v_mfma_f32_16x16x32_bf16 v[168:171], a[20:23], a[132:135], v[168:171]
v_mfma_f32_16x16x32_bf16 v[172:175], a[24:27], a[128:131], v[172:175]
ds_read_b64_tr_b16 a[142:143], v9 offset:18432
v_mfma_f32_16x16x32_bf16 v[172:175], a[28:31], a[132:135], v[172:175]
v_mfma_f32_16x16x32_bf16 v[176:179], a[32:35], a[128:131], v[176:179]
v_mfma_f32_16x16x32_bf16 v[176:179], a[36:39], a[132:135], v[176:179]
v_mfma_f32_16x16x32_bf16 v[180:183], a[40:43], a[128:131], v[180:183]
ds_read_b128 a[108:111], v3 offset:43008
v_mfma_f32_16x16x32_bf16 v[180:183], a[44:47], a[132:135], v[180:183]
v_mfma_f32_16x16x32_bf16 v[184:187], a[48:51], a[128:131], v[184:187]
ds_read_b128 a[112:115], v2 offset:45056
v_mfma_f32_16x16x32_bf16 v[184:187], a[52:55], a[132:135], v[184:187]
v_mfma_f32_16x16x32_bf16 v[188:191], a[56:59], a[128:131], v[188:191]
v_mfma_f32_16x16x32_bf16 v[188:191], a[60:63], a[132:135], v[188:191]
s_waitcnt lgkmcnt(2)
v_mfma_f32_16x16x32_bf16 v[192:195], a[0:3], a[136:139], v[192:195]
ds_read_b64_tr_b16 a[128:129], v10 offset:0
v_mfma_f32_16x16x32_bf16 v[192:195], a[4:7], a[140:143], v[192:195]
v_mfma_f32_16x16x32_bf16 v[196:199], a[8:11], a[136:139], v[196:199]
ds_read_b64_tr_b16 a[130:131], v10 offset:2048
v_mfma_f32_16x16x32_bf16 v[196:199], a[12:15], a[140:143], v[196:199]
v_mfma_f32_16x16x32_bf16 v[200:203], a[16:19], a[136:139], v[200:203]
ds_read_b64_tr_b16 a[132:133], v10 offset:16384
v_mfma_f32_16x16x32_bf16 v[200:203], a[20:23], a[140:143], v[200:203]
v_mfma_f32_16x16x32_bf16 v[204:207], a[24:27], a[136:139], v[204:207]
ds_read_b64_tr_b16 a[134:135], v10 offset:18432
v_mfma_f32_16x16x32_bf16 v[204:207], a[28:31], a[140:143], v[204:207]
v_mfma_f32_16x16x32_bf16 v[208:211], a[32:35], a[136:139], v[208:211]
ds_read_b128 a[116:119], v3 offset:45056
v_mfma_f32_16x16x32_bf16 v[208:211], a[36:39], a[140:143], v[208:211]
v_mfma_f32_16x16x32_bf16 v[212:215], a[40:43], a[136:139], v[212:215]
ds_read_b128 a[120:123], v2 offset:47104
v_mfma_f32_16x16x32_bf16 v[212:215], a[44:47], a[140:143], v[212:215]
v_mfma_f32_16x16x32_bf16 v[216:219], a[48:51], a[136:139], v[216:219]
v_mfma_f32_16x16x32_bf16 v[216:219], a[52:55], a[140:143], v[216:219]
v_mfma_f32_16x16x32_bf16 v[220:223], a[56:59], a[136:139], v[220:223]
ds_read_b128 a[124:127], v3 offset:47104
v_mfma_f32_16x16x32_bf16 v[220:223], a[60:63], a[140:143], v[220:223]
s_waitcnt lgkmcnt(2)
v_mfma_f32_16x16x32_bf16 a[192:195], a[0:3], a[128:131], a[192:195]
ds_read_b64_tr_b16 a[136:137], v11 offset:0
v_mfma_f32_16x16x32_bf16 a[192:195], a[4:7], a[132:135], a[192:195]
v_mfma_f32_16x16x32_bf16 a[196:199], a[8:11], a[128:131], a[196:199]
ds_read_b64_tr_b16 a[138:139], v11 offset:2048
v_mfma_f32_16x16x32_bf16 a[196:199], a[12:15], a[132:135], a[196:199]
v_mfma_f32_16x16x32_bf16 a[200:203], a[16:19], a[128:131], a[200:203]
ds_read_b64_tr_b16 a[140:141], v11 offset:16384
v_mfma_f32_16x16x32_bf16 a[200:203], a[20:23], a[132:135], a[200:203]
v_mfma_f32_16x16x32_bf16 a[204:207], a[24:27], a[128:131], a[204:207]
ds_read_b64_tr_b16 a[142:143], v11 offset:18432
v_mfma_f32_16x16x32_bf16 a[204:207], a[28:31], a[132:135], a[204:207]
v_mfma_f32_16x16x32_bf16 a[208:211], a[32:35], a[128:131], a[208:211]
v_mfma_f32_16x16x32_bf16 a[208:211], a[36:39], a[132:135], a[208:211]
v_mfma_f32_16x16x32_bf16 a[212:215], a[40:43], a[128:131], a[212:215]
v_mfma_f32_16x16x32_bf16 a[212:215], a[44:47], a[132:135], a[212:215]
v_mfma_f32_16x16x32_bf16 a[216:219], a[48:51], a[128:131], a[216:219]
v_mfma_f32_16x16x32_bf16 a[216:219], a[52:55], a[132:135], a[216:219]
v_mfma_f32_16x16x32_bf16 a[220:223], a[56:59], a[128:131], a[220:223]
v_mfma_f32_16x16x32_bf16 a[220:223], a[60:63], a[132:135], a[220:223]
s_waitcnt vmcnt(2) lgkmcnt(0)
s_barrier
v_mfma_f32_16x16x32_bf16 a[224:227], a[0:3], a[136:139], a[224:227]
s_add_u32 m0, s29, 65536
ds_read_b64_tr_b16 a[128:129], v4 offset:32768
v_mfma_f32_16x16x32_bf16 a[224:227], a[4:7], a[140:143], a[224:227]
buffer_load_dwordx4 v16, s[12:15], s26 offen offset:0 lds
v_mfma_f32_16x16x32_bf16 a[228:231], a[8:11], a[136:139], a[228:231]
ds_read_b64_tr_b16 a[130:131], v4 offset:34816
v_mfma_f32_16x16x32_bf16 a[228:231], a[12:15], a[140:143], a[228:231]
v_mfma_f32_16x16x32_bf16 a[232:235], a[16:19], a[136:139], a[232:235]
ds_read_b64_tr_b16 a[132:133], v4 offset:49152
v_mfma_f32_16x16x32_bf16 a[232:235], a[20:23], a[140:143], a[232:235]
buffer_load_dwordx4 v17, s[12:15], s26 offen offset:1024 lds
v_mfma_f32_16x16x32_bf16 a[236:239], a[24:27], a[136:139], a[236:239]
ds_read_b64_tr_b16 a[134:135], v4 offset:51200
v_mfma_f32_16x16x32_bf16 a[236:239], a[28:31], a[140:143], a[236:239]
v_mfma_f32_16x16x32_bf16 a[240:243], a[32:35], a[136:139], a[240:243]
v_mfma_f32_16x16x32_bf16 a[240:243], a[36:39], a[140:143], a[240:243]
buffer_load_dwordx4 v18, s[12:15], s26 offen offset:2048 lds
v_mfma_f32_16x16x32_bf16 a[244:247], a[40:43], a[136:139], a[244:247]
v_mfma_f32_16x16x32_bf16 a[244:247], a[44:47], a[140:143], a[244:247]
v_mfma_f32_16x16x32_bf16 a[248:251], a[48:51], a[136:139], a[248:251]
v_mfma_f32_16x16x32_bf16 a[248:251], a[52:55], a[140:143], a[248:251]
buffer_load_dwordx4 v19, s[12:15], s26 offen offset:3072 lds
v_mfma_f32_16x16x32_bf16 a[252:255], a[56:59], a[136:139], a[252:255]
s_add_u32 s26, s26, 524288
v_mfma_f32_16x16x32_bf16 a[252:255], a[60:63], a[140:143], a[252:255]
s_waitcnt lgkmcnt(0)
s_bitcmp1_b32 s30, 1
s_cbranch_scc1 Lg_501
s_cmp_eq_u32 s30, 0
s_cbranch_scc1 Lg_501t
v_mfma_f32_16x16x32_bf16 v[32:35], a[64:67], a[128:131], v[32:35]
s_add_u32 m0, s29, 81920
ds_read_b64_tr_b16 a[136:137], v5 offset:32768
v_mfma_f32_16x16x32_bf16 v[32:35], a[68:71], a[132:135], v[32:35]
buffer_load_dwordx4 v16, s[12:15], s27 offen offset:0 lds
v_mfma_f32_16x16x32_bf16 v[36:39], a[72:75], a[128:131], v[36:39]
s_lshl_b32 s22, s38, 3
ds_read_b64_tr_b16 a[138:139], v5 offset:34816
v_mfma_f32_16x16x32_bf16 v[36:39], a[76:79], a[132:135], v[36:39]
s_lshl_b32 s23, s39, 5
v_and_b32 v252, 31, v0
v_lshrrev_b32 v253, 5, v0
v_mfma_f32_16x16x32_bf16 v[40:43], a[80:83], a[128:131], v[40:43]
ds_read_b64_tr_b16 a[140:141], v5 offset:49152
v_add_u32 v253, s22, v253
v_mfma_f32_16x16x32_bf16 v[40:43], a[84:87], a[132:135], v[40:43]
buffer_load_dwordx4 v17, s[12:15], s27 offen offset:1024 lds
v_mfma_f32_16x16x32_bf16 v[44:47], a[88:91], a[128:131], v[44:47]
ds_read_b64_tr_b16 a[142:143], v5 offset:51200
v_add_u32 v252, s23, v252
v_mfma_f32_16x16x32_bf16 v[44:47], a[92:95], a[132:135], v[44:47]
v_mul_u32_u24 v254, 7168, v253
v_lshl_add_u32 v254, v252, 2, v254
v_mfma_f32_16x16x32_bf16 v[48:51], a[96:99], a[128:131], v[48:51]
ds_read_b128 a[0:3], v2 offset:0
v_lshlrev_b32 v252, 4, v252
v_mfma_f32_16x16x32_bf16 v[48:51], a[100:103], a[132:135], v[48:51]
buffer_load_dwordx4 v18, s[12:15], s27 offen offset:2048 lds
v_mfma_f32_16x16x32_bf16 v[52:55], a[104:107], a[128:131], v[52:55]
ds_read_b128 a[4:7], v3 offset:0
v_add_u32 v255, 3584, v254
v_mfma_f32_16x16x32_bf16 v[52:55], a[108:111], a[132:135], v[52:55]
v_subrev_u32 v22, 3584, v254
v_subrev_u32 v23, 2688, v254
v_mfma_f32_16x16x32_bf16 v[56:59], a[112:115], a[128:131], v[56:59]
v_subrev_u32 v24, 1792, v254
v_subrev_u32 v25, 896, v254
v_mfma_f32_16x16x32_bf16 v[56:59], a[116:119], a[132:135], v[56:59]
buffer_load_dwordx4 v19, s[12:15], s27 offen offset:3072 lds
v_mfma_f32_16x16x32_bf16 v[60:63], a[120:123], a[128:131], v[60:63]
s_add_u32 s27, s27, 524288
ds_read_b128 a[8:11], v2 offset:2048
v_mfma_f32_16x16x32_bf16 v[60:63], a[124:127], a[132:135], v[60:63]
s_waitcnt lgkmcnt(2)
v_mfma_f32_16x16x32_bf16 v[64:67], a[64:67], a[136:139], v[64:67]
s_add_u32 m0, s28, 32768
ds_read_b64_tr_b16 a[128:129], v6 offset:32768
v_mfma_f32_16x16x32_bf16 v[64:67], a[68:71], a[140:143], v[64:67]
buffer_load_dwordx4 v12, s[8:11], s24 offen offset:0 lds
v_mfma_f32_16x16x32_bf16 v[68:71], a[72:75], a[136:139], v[68:71]
ds_read_b64_tr_b16 a[130:131], v6 offset:34816
v_mfma_f32_16x16x32_bf16 v[68:71], a[76:79], a[140:143], v[68:71]
v_mfma_f32_16x16x32_bf16 v[72:75], a[80:83], a[136:139], v[72:75]
ds_read_b64_tr_b16 a[132:133], v6 offset:49152
v_mfma_f32_16x16x32_bf16 v[72:75], a[84:87], a[140:143], v[72:75]
buffer_load_dwordx4 v13, s[8:11], s24 offen offset:1024 lds
v_mfma_f32_16x16x32_bf16 v[76:79], a[88:91], a[136:139], v[76:79]
ds_read_b64_tr_b16 a[134:135], v6 offset:51200
v_mfma_f32_16x16x32_bf16 v[76:79], a[92:95], a[140:143], v[76:79]
v_mfma_f32_16x16x32_bf16 v[80:83], a[96:99], a[136:139], v[80:83]
ds_read_b128 a[12:15], v3 offset:2048
v_mfma_f32_16x16x32_bf16 v[80:83], a[100:103], a[140:143], v[80:83]
buffer_load_dwordx4 v14, s[8:11], s24 offen offset:2048 lds
v_mfma_f32_16x16x32_bf16 v[84:87], a[104:107], a[136:139], v[84:87]
v_mfma_f32_16x16x32_bf16 v[84:87], a[108:111], a[140:143], v[84:87]
v_mfma_f32_16x16x32_bf16 v[88:91], a[112:115], a[136:139], v[88:91]
ds_read_b128 a[16:19], v2 offset:4096
v_mfma_f32_16x16x32_bf16 v[88:91], a[116:119], a[140:143], v[88:91]
buffer_load_dwordx4 v15, s[8:11], s24 offen offset:3072 lds
v_mfma_f32_16x16x32_bf16 v[92:95], a[120:123], a[136:139], v[92:95]
s_add_u32 s24, s24, 128
ds_read_b128 a[20:23], v3 offset:4096
v_mfma_f32_16x16x32_bf16 v[92:95], a[124:127], a[140:143], v[92:95]
s_waitcnt lgkmcnt(2)
v_mfma_f32_16x16x32_bf16 v[96:99], a[64:67], a[128:131], v[96:99]
s_add_u32 m0, s28, 36864
ds_read_b64_tr_b16 a[136:137], v7 offset:32768
v_mfma_f32_16x16x32_bf16 v[96:99], a[68:71], a[132:135], v[96:99]
buffer_load_dwordx4 v12, s[8:11], s25 offen offset:0 lds
v_mfma_f32_16x16x32_bf16 v[100:103], a[72:75], a[128:131], v[100:103]
ds_read_b64_tr_b16 a[138:139], v7 offset:34816
v_mfma_f32_16x16x32_bf16 v[100:103], a[76:79], a[132:135], v[100:103]
PAD_19:
s_cbranch_execz PAD_23
v_mfma_f32_16x16x32_bf16 v[104:107], a[80:83], a[128:131], v[104:107]
ds_read_b64_tr_b16 a[140:141], v7 offset:49152
v_mfma_f32_16x16x32_bf16 v[104:107], a[84:87], a[132:135], v[104:107]
buffer_load_dwordx4 v13, s[8:11], s25 offen offset:1024 lds
v_mfma_f32_16x16x32_bf16 v[108:111], a[88:91], a[128:131], v[108:111]
ds_read_b64_tr_b16 a[142:143], v7 offset:51200
v_mfma_f32_16x16x32_bf16 v[108:111], a[92:95], a[132:135], v[108:111]
v_mfma_f32_16x16x32_bf16 v[112:115], a[96:99], a[128:131], v[112:115]
v_mfma_f32_16x16x32_bf16 v[112:115], a[100:103], a[132:135], v[112:115]
buffer_load_dwordx4 v14, s[8:11], s25 offen offset:2048 lds
v_mfma_f32_16x16x32_bf16 v[116:119], a[104:107], a[128:131], v[116:119]
ds_read_b128 a[24:27], v2 offset:6144
v_mfma_f32_16x16x32_bf16 v[116:119], a[108:111], a[132:135], v[116:119]
v_mfma_f32_16x16x32_bf16 v[120:123], a[112:115], a[128:131], v[120:123]
ds_read_b128 a[28:31], v3 offset:6144
v_mfma_f32_16x16x32_bf16 v[120:123], a[116:119], a[132:135], v[120:123]
buffer_load_dwordx4 v15, s[8:11], s25 offen offset:3072 lds
v_mfma_f32_16x16x32_bf16 v[124:127], a[120:123], a[128:131], v[124:127]
s_add_u32 s25, s25, 128
v_mfma_f32_16x16x32_bf16 v[124:127], a[124:127], a[132:135], v[124:127]
s_waitcnt lgkmcnt(2)
v_mfma_f32_16x16x32_bf16 v[128:131], a[64:67], a[136:139], v[128:131]
s_mov_b64 s[56:57], s[70:71]
s_mov_b32 s58, 3584
s_mov_b32 s59, 0x20000
ds_read_b64_tr_b16 a[128:129], v8 offset:32768
buffer_load_dwordx4 v[248:251], v252, s[56:59], 0 offen
v_mfma_f32_16x16x32_bf16 v[128:131], a[68:71], a[140:143], v[128:131]
s_mov_b64 s[56:57], s[66:67]
s_mov_b32 s58, 1835008
buffer_load_dword v224, v22, s[56:59], 0 offen nt
v_mfma_f32_16x16x32_bf16 v[132:135], a[72:75], a[136:139], v[132:135]
ds_read_b64_tr_b16 a[130:131], v8 offset:34816
buffer_load_dword v225, v23, s[56:59], 0 offen nt
v_mfma_f32_16x16x32_bf16 v[132:135], a[76:79], a[140:143], v[132:135]
buffer_load_dword v226, v24, s[56:59], 0 offen nt
v_mfma_f32_16x16x32_bf16 v[136:139], a[80:83], a[136:139], v[136:139]
ds_read_b64_tr_b16 a[132:133], v8 offset:49152
buffer_load_dword v227, v25, s[56:59], 0 offen nt
v_mfma_f32_16x16x32_bf16 v[136:139], a[84:87], a[140:143], v[136:139]
buffer_load_dword v228, v254, s[56:59], 0 offen offset:0 nt
v_mfma_f32_16x16x32_bf16 v[140:143], a[88:91], a[136:139], v[140:143]
ds_read_b64_tr_b16 a[134:135], v8 offset:51200
buffer_load_dword v229, v254, s[56:59], 0 offen offset:896 nt
v_mfma_f32_16x16x32_bf16 v[140:143], a[92:95], a[140:143], v[140:143]
buffer_load_dword v230, v254, s[56:59], 0 offen offset:1792 nt
v_mfma_f32_16x16x32_bf16 v[144:147], a[96:99], a[136:139], v[144:147]
ds_read_b128 a[32:35], v2 offset:8192
buffer_load_dword v231, v254, s[56:59], 0 offen offset:2688 nt
v_mfma_f32_16x16x32_bf16 v[144:147], a[100:103], a[140:143], v[144:147]
buffer_load_dword v232, v255, s[56:59], 0 offen offset:0 nt
v_mfma_f32_16x16x32_bf16 v[148:151], a[104:107], a[136:139], v[148:151]
buffer_load_dword v233, v255, s[56:59], 0 offen offset:896 nt
v_mfma_f32_16x16x32_bf16 v[148:151], a[108:111], a[140:143], v[148:151]
buffer_load_dword v234, v255, s[56:59], 0 offen offset:1792 nt
v_mfma_f32_16x16x32_bf16 v[152:155], a[112:115], a[136:139], v[152:155]
ds_read_b128 a[36:39], v3 offset:8192
buffer_load_dword v235, v255, s[56:59], 0 offen offset:2688 nt
v_mfma_f32_16x16x32_bf16 v[152:155], a[116:119], a[140:143], v[152:155]
s_mov_b64 s[56:57], s[68:69]
buffer_load_dword v236, v25, s[56:59], 0 offen nt
v_mfma_f32_16x16x32_bf16 v[156:159], a[120:123], a[136:139], v[156:159]
ds_read_b128 a[40:43], v2 offset:10240
buffer_load_dword v237, v254, s[56:59], 0 offen offset:0 nt
v_mfma_f32_16x16x32_bf16 v[156:159], a[124:127], a[140:143], v[156:159]
s_waitcnt lgkmcnt(2)
buffer_load_dword v238, v254, s[56:59], 0 offen offset:896 nt
v_mfma_f32_16x16x32_bf16 v[160:163], a[64:67], a[128:131], v[160:163]
ds_read_b64_tr_b16 a[136:137], v9 offset:32768
buffer_load_dword v239, v254, s[56:59], 0 offen offset:1792 nt
v_mfma_f32_16x16x32_bf16 v[160:163], a[68:71], a[132:135], v[160:163]
buffer_load_dword v240, v254, s[56:59], 0 offen offset:2688 nt
v_mfma_f32_16x16x32_bf16 v[164:167], a[72:75], a[128:131], v[164:167]
ds_read_b64_tr_b16 a[138:139], v9 offset:34816
buffer_load_dword v241, v255, s[56:59], 0 offen offset:0 nt
v_mfma_f32_16x16x32_bf16 v[164:167], a[76:79], a[132:135], v[164:167]
buffer_load_dword v242, v255, s[56:59], 0 offen offset:896 nt
v_mfma_f32_16x16x32_bf16 v[168:171], a[80:83], a[128:131], v[168:171]
ds_read_b64_tr_b16 a[140:141], v9 offset:49152
buffer_load_dword v243, v255, s[56:59], 0 offen offset:1792 nt
v_mfma_f32_16x16x32_bf16 v[168:171], a[84:87], a[132:135], v[168:171]
buffer_load_dword v244, v255, s[56:59], 0 offen offset:2688 nt
v_mfma_f32_16x16x32_bf16 v[172:175], a[88:91], a[128:131], v[172:175]
ds_read_b64_tr_b16 a[142:143], v9 offset:51200
v_mfma_f32_16x16x32_bf16 v[172:175], a[92:95], a[132:135], v[172:175]
v_mfma_f32_16x16x32_bf16 v[176:179], a[96:99], a[128:131], v[176:179]
v_mfma_f32_16x16x32_bf16 v[176:179], a[100:103], a[132:135], v[176:179]
v_mfma_f32_16x16x32_bf16 v[180:183], a[104:107], a[128:131], v[180:183]
ds_read_b128 a[44:47], v3 offset:10240
v_mfma_f32_16x16x32_bf16 v[180:183], a[108:111], a[132:135], v[180:183]
v_mfma_f32_16x16x32_bf16 v[184:187], a[112:115], a[128:131], v[184:187]
ds_read_b128 a[48:51], v2 offset:12288
v_mfma_f32_16x16x32_bf16 v[184:187], a[116:119], a[132:135], v[184:187]
v_mfma_f32_16x16x32_bf16 v[188:191], a[120:123], a[128:131], v[188:191]
v_mfma_f32_16x16x32_bf16 v[188:191], a[124:127], a[132:135], v[188:191]
s_waitcnt lgkmcnt(2)
v_mfma_f32_16x16x32_bf16 v[192:195], a[64:67], a[136:139], v[192:195]
ds_read_b64_tr_b16 a[128:129], v10 offset:32768
v_mfma_f32_16x16x32_bf16 v[192:195], a[68:71], a[140:143], v[192:195]
v_mfma_f32_16x16x32_bf16 v[196:199], a[72:75], a[136:139], v[196:199]
ds_read_b64_tr_b16 a[130:131], v10 offset:34816
v_mfma_f32_16x16x32_bf16 v[196:199], a[76:79], a[140:143], v[196:199]
v_mfma_f32_16x16x32_bf16 v[200:203], a[80:83], a[136:139], v[200:203]
ds_read_b64_tr_b16 a[132:133], v10 offset:49152
v_mfma_f32_16x16x32_bf16 v[200:203], a[84:87], a[140:143], v[200:203]
v_mfma_f32_16x16x32_bf16 v[204:207], a[88:91], a[136:139], v[204:207]
ds_read_b64_tr_b16 a[134:135], v10 offset:51200
v_mfma_f32_16x16x32_bf16 v[204:207], a[92:95], a[140:143], v[204:207]
v_mfma_f32_16x16x32_bf16 v[208:211], a[96:99], a[136:139], v[208:211]
ds_read_b128 a[52:55], v3 offset:12288
v_mfma_f32_16x16x32_bf16 v[208:211], a[100:103], a[140:143], v[208:211]
v_mfma_f32_16x16x32_bf16 v[212:215], a[104:107], a[136:139], v[212:215]
ds_read_b128 a[56:59], v2 offset:14336
v_mfma_f32_16x16x32_bf16 v[212:215], a[108:111], a[140:143], v[212:215]
v_mfma_f32_16x16x32_bf16 v[216:219], a[112:115], a[136:139], v[216:219]
v_mfma_f32_16x16x32_bf16 v[216:219], a[116:119], a[140:143], v[216:219]
v_mfma_f32_16x16x32_bf16 v[220:223], a[120:123], a[136:139], v[220:223]
ds_read_b128 a[60:63], v3 offset:14336
v_mfma_f32_16x16x32_bf16 v[220:223], a[124:127], a[140:143], v[220:223]
s_waitcnt lgkmcnt(2)
v_mfma_f32_16x16x32_bf16 a[192:195], a[64:67], a[128:131], a[192:195]
ds_read_b64_tr_b16 a[136:137], v11 offset:32768
v_mfma_f32_16x16x32_bf16 a[192:195], a[68:71], a[132:135], a[192:195]
v_mfma_f32_16x16x32_bf16 a[196:199], a[72:75], a[128:131], a[196:199]
ds_read_b64_tr_b16 a[138:139], v11 offset:34816
v_mfma_f32_16x16x32_bf16 a[196:199], a[76:79], a[132:135], a[196:199]
v_mfma_f32_16x16x32_bf16 a[200:203], a[80:83], a[128:131], a[200:203]
ds_read_b64_tr_b16 a[140:141], v11 offset:49152
v_mfma_f32_16x16x32_bf16 a[200:203], a[84:87], a[132:135], a[200:203]
v_mfma_f32_16x16x32_bf16 a[204:207], a[88:91], a[128:131], a[204:207]
ds_read_b64_tr_b16 a[142:143], v11 offset:51200
v_mfma_f32_16x16x32_bf16 a[204:207], a[92:95], a[132:135], a[204:207]
v_mfma_f32_16x16x32_bf16 a[208:211], a[96:99], a[128:131], a[208:211]
v_mfma_f32_16x16x32_bf16 a[208:211], a[100:103], a[132:135], a[208:211]
v_mfma_f32_16x16x32_bf16 a[212:215], a[104:107], a[128:131], a[212:215]
v_mfma_f32_16x16x32_bf16 a[212:215], a[108:111], a[132:135], a[212:215]
v_mfma_f32_16x16x32_bf16 a[216:219], a[112:115], a[128:131], a[216:219]
v_mfma_f32_16x16x32_bf16 a[216:219], a[116:119], a[132:135], a[216:219]
v_mfma_f32_16x16x32_bf16 a[220:223], a[120:123], a[128:131], a[220:223]
v_mfma_f32_16x16x32_bf16 a[220:223], a[124:127], a[132:135], a[220:223]
s_waitcnt vmcnt(22) lgkmcnt(0)
s_barrier
v_mfma_f32_16x16x32_bf16 a[224:227], a[64:67], a[136:139], a[224:227]
s_add_u32 m0, s29, 98304
ds_read_b64_tr_b16 a[128:129], v4 offset:0
v_mfma_f32_16x16x32_bf16 a[224:227], a[68:71], a[140:143], a[224:227]
buffer_load_dwordx4 v16, s[12:15], s26 offen offset:0 lds
v_mfma_f32_16x16x32_bf16 a[228:231], a[72:75], a[136:139], a[228:231]
ds_read_b64_tr_b16 a[130:131], v4 offset:2048
v_mfma_f32_16x16x32_bf16 a[228:231], a[76:79], a[140:143], a[228:231]
v_mfma_f32_16x16x32_bf16 a[232:235], a[80:83], a[136:139], a[232:235]
ds_read_b64_tr_b16 a[132:133], v4 offset:16384
v_mfma_f32_16x16x32_bf16 a[232:235], a[84:87], a[140:143], a[232:235]
buffer_load_dwordx4 v17, s[12:15], s26 offen offset:1024 lds
v_mfma_f32_16x16x32_bf16 a[236:239], a[88:91], a[136:139], a[236:239]
ds_read_b64_tr_b16 a[134:135], v4 offset:18432
v_mfma_f32_16x16x32_bf16 a[236:239], a[92:95], a[140:143], a[236:239]
v_mfma_f32_16x16x32_bf16 a[240:243], a[96:99], a[136:139], a[240:243]
v_mfma_f32_16x16x32_bf16 a[240:243], a[100:103], a[140:143], a[240:243]
buffer_load_dwordx4 v18, s[12:15], s26 offen offset:2048 lds
v_mfma_f32_16x16x32_bf16 a[244:247], a[104:107], a[136:139], a[244:247]
v_mfma_f32_16x16x32_bf16 a[244:247], a[108:111], a[140:143], a[244:247]
v_mfma_f32_16x16x32_bf16 a[248:251], a[112:115], a[136:139], a[248:251]
v_mfma_f32_16x16x32_bf16 a[248:251], a[116:119], a[140:143], a[248:251]
buffer_load_dwordx4 v19, s[12:15], s26 offen offset:3072 lds
v_mfma_f32_16x16x32_bf16 a[252:255], a[120:123], a[136:139], a[252:255]
s_add_u32 s26, s26, 524288
v_mfma_f32_16x16x32_bf16 a[252:255], a[124:127], a[140:143], a[252:255]
s_waitcnt lgkmcnt(0)
v_mfma_f32_16x16x32_bf16 v[32:35], a[0:3], a[128:131], v[32:35]
s_add_u32 m0, s29, 114688
ds_read_b64_tr_b16 a[136:137], v5 offset:0
v_mfma_f32_16x16x32_bf16 v[32:35], a[4:7], a[132:135], v[32:35]
buffer_load_dwordx4 v16, s[12:15], s27 offen offset:0 lds
v_mfma_f32_16x16x32_bf16 v[36:39], a[8:11], a[128:131], v[36:39]
ds_read_b64_tr_b16 a[138:139], v5 offset:2048
v_mfma_f32_16x16x32_bf16 v[36:39], a[12:15], a[132:135], v[36:39]
v_mfma_f32_16x16x32_bf16 v[40:43], a[16:19], a[128:131], v[40:43]
ds_read_b64_tr_b16 a[140:141], v5 offset:16384
v_mfma_f32_16x16x32_bf16 v[40:43], a[20:23], a[132:135], v[40:43]
buffer_load_dwordx4 v17, s[12:15], s27 offen offset:1024 lds
v_mfma_f32_16x16x32_bf16 v[44:47], a[24:27], a[128:131], v[44:47]
ds_read_b64_tr_b16 a[142:143], v5 offset:18432
v_mfma_f32_16x16x32_bf16 v[44:47], a[28:31], a[132:135], v[44:47]
v_mfma_f32_16x16x32_bf16 v[48:51], a[32:35], a[128:131], v[48:51]
ds_read_b128 a[64:67], v2 offset:32768
v_mfma_f32_16x16x32_bf16 v[48:51], a[36:39], a[132:135], v[48:51]
buffer_load_dwordx4 v18, s[12:15], s27 offen offset:2048 lds
v_mfma_f32_16x16x32_bf16 v[52:55], a[40:43], a[128:131], v[52:55]
ds_read_b128 a[68:71], v3 offset:32768
v_mfma_f32_16x16x32_bf16 v[52:55], a[44:47], a[132:135], v[52:55]
v_mfma_f32_16x16x32_bf16 v[56:59], a[48:51], a[128:131], v[56:59]
v_mfma_f32_16x16x32_bf16 v[56:59], a[52:55], a[132:135], v[56:59]
buffer_load_dwordx4 v19, s[12:15], s27 offen offset:3072 lds
v_mfma_f32_16x16x32_bf16 v[60:63], a[56:59], a[128:131], v[60:63]
s_add_u32 s27, s27, 524288
ds_read_b128 a[72:75], v2 offset:34816
v_mfma_f32_16x16x32_bf16 v[60:63], a[60:63], a[132:135], v[60:63]
s_waitcnt lgkmcnt(2)
v_mfma_f32_16x16x32_bf16 v[64:67], a[0:3], a[136:139], v[64:67]
s_add_u32 m0, s28, 0
ds_read_b64_tr_b16 a[128:129], v6 offset:0
v_mfma_f32_16x16x32_bf16 v[64:67], a[4:7], a[140:143], v[64:67]
buffer_load_dwordx4 v12, s[8:11], s24 offen offset:0 lds
v_mfma_f32_16x16x32_bf16 v[68:71], a[8:11], a[136:139], v[68:71]
ds_read_b64_tr_b16 a[130:131], v6 offset:2048
v_mfma_f32_16x16x32_bf16 v[68:71], a[12:15], a[140:143], v[68:71]
v_mfma_f32_16x16x32_bf16 v[72:75], a[16:19], a[136:139], v[72:75]
ds_read_b64_tr_b16 a[132:133], v6 offset:16384
v_mfma_f32_16x16x32_bf16 v[72:75], a[20:23], a[140:143], v[72:75]
buffer_load_dwordx4 v13, s[8:11], s24 offen offset:1024 lds
v_mfma_f32_16x16x32_bf16 v[76:79], a[24:27], a[136:139], v[76:79]
ds_read_b64_tr_b16 a[134:135], v6 offset:18432
v_mfma_f32_16x16x32_bf16 v[76:79], a[28:31], a[140:143], v[76:79]
v_mfma_f32_16x16x32_bf16 v[80:83], a[32:35], a[136:139], v[80:83]
ds_read_b128 a[76:79], v3 offset:34816
v_mfma_f32_16x16x32_bf16 v[80:83], a[36:39], a[140:143], v[80:83]
buffer_load_dwordx4 v14, s[8:11], s24 offen offset:2048 lds
v_mfma_f32_16x16x32_bf16 v[84:87], a[40:43], a[136:139], v[84:87]
v_mfma_f32_16x16x32_bf16 v[84:87], a[44:47], a[140:143], v[84:87]
v_mfma_f32_16x16x32_bf16 v[88:91], a[48:51], a[136:139], v[88:91]
ds_read_b128 a[80:83], v2 offset:36864
v_mfma_f32_16x16x32_bf16 v[88:91], a[52:55], a[140:143], v[88:91]
buffer_load_dwordx4 v15, s[8:11], s24 offen offset:3072 lds
v_mfma_f32_16x16x32_bf16 v[92:95], a[56:59], a[136:139], v[92:95]
s_add_u32 s24, s24, 128
ds_read_b128 a[84:87], v3 offset:36864
v_mfma_f32_16x16x32_bf16 v[92:95], a[60:63], a[140:143], v[92:95]
s_waitcnt lgkmcnt(2)
v_mfma_f32_16x16x32_bf16 v[96:99], a[0:3], a[128:131], v[96:99]
s_add_u32 m0, s28, 4096
ds_read_b64_tr_b16 a[136:137], v7 offset:0
v_mfma_f32_16x16x32_bf16 v[96:99], a[4:7], a[132:135], v[96:99]
buffer_load_dwordx4 v12, s[8:11], s25 offen offset:0 lds
v_mfma_f32_16x16x32_bf16 v[100:103], a[8:11], a[128:131], v[100:103]
ds_read_b64_tr_b16 a[138:139], v7 offset:2048
v_mfma_f32_16x16x32_bf16 v[100:103], a[12:15], a[132:135], v[100:103]
v_mfma_f32_16x16x32_bf16 v[104:107], a[16:19], a[128:131], v[104:107]
ds_read_b64_tr_b16 a[140:141], v7 offset:16384
v_mfma_f32_16x16x32_bf16 v[104:107], a[20:23], a[132:135], v[104:107]
buffer_load_dwordx4 v13, s[8:11], s25 offen offset:1024 lds
v_mfma_f32_16x16x32_bf16 v[108:111], a[24:27], a[128:131], v[108:111]
ds_read_b64_tr_b16 a[142:143], v7 offset:18432
v_mfma_f32_16x16x32_bf16 v[108:111], a[28:31], a[132:135], v[108:111]
v_mfma_f32_16x16x32_bf16 v[112:115], a[32:35], a[128:131], v[112:115]
v_mfma_f32_16x16x32_bf16 v[112:115], a[36:39], a[132:135], v[112:115]
buffer_load_dwordx4 v14, s[8:11], s25 offen offset:2048 lds
v_mfma_f32_16x16x32_bf16 v[116:119], a[40:43], a[128:131], v[116:119]
ds_read_b128 a[88:91], v2 offset:38912
v_mfma_f32_16x16x32_bf16 v[116:119], a[44:47], a[132:135], v[116:119]
v_mfma_f32_16x16x32_bf16 v[120:123], a[48:51], a[128:131], v[120:123]
ds_read_b128 a[92:95], v3 offset:38912
v_mfma_f32_16x16x32_bf16 v[120:123], a[52:55], a[132:135], v[120:123]
buffer_load_dwordx4 v15, s[8:11], s25 offen offset:3072 lds
v_mfma_f32_16x16x32_bf16 v[124:127], a[56:59], a[128:131], v[124:127]
s_add_u32 s25, s25, 128
v_mfma_f32_16x16x32_bf16 v[124:127], a[60:63], a[132:135], v[124:127]
s_waitcnt lgkmcnt(2)
v_mfma_f32_16x16x32_bf16 v[128:131], a[0:3], a[136:139], v[128:131]
ds_read_b64_tr_b16 a[128:129], v8 offset:0
v_mfma_f32_16x16x32_bf16 v[128:131], a[4:7], a[140:143], v[128:131]
buffer_load_dword v21, v20, s[16:19], s43 offen
v_mfma_f32_16x16x32_bf16 v[132:135], a[8:11], a[136:139], v[132:135]
s_add_u32 s43, s43, s47
ds_read_b64_tr_b16 a[130:131], v8 offset:2048
v_mfma_f32_16x16x32_bf16 v[132:135], a[12:15], a[140:143], v[132:135]
s_cmp_ge_u32 s43, s51
v_mfma_f32_16x16x32_bf16 v[136:139], a[16:19], a[136:139], v[136:139]
s_cselect_b32 s43, 0, s43
ds_read_b64_tr_b16 a[132:133], v8 offset:16384
v_mfma_f32_16x16x32_bf16 v[136:139], a[20:23], a[140:143], v[136:139]
s_cselect_b32 s51, s42, s51
v_mfma_f32_16x16x32_bf16 v[140:143], a[24:27], a[136:139], v[140:143]
s_cselect_b64 s[16:17], s[40:41], s[16:17]
ds_read_b64_tr_b16 a[134:135], v8 offset:18432
v_mfma_f32_16x16x32_bf16 v[140:143], a[28:31], a[140:143], v[140:143]
s_cselect_b32 s18, s42, s18
v_mfma_f32_16x16x32_bf16 v[144:147], a[32:35], a[136:139], v[144:147]
s_cselect_b64 s[40:41], s[44:45], s[40:41]
ds_read_b128 a[96:99], v2 offset:40960
v_mfma_f32_16x16x32_bf16 v[144:147], a[36:39], a[140:143], v[144:147]
s_cselect_b32 s42, s46, s42
v_mfma_f32_16x16x32_bf16 v[148:151], a[40:43], a[136:139], v[148:151]
s_cselect_b32 s46, 0, s46
v_mfma_f32_16x16x32_bf16 v[148:151], a[44:47], a[140:143], v[148:151]
s_lshl_b32 s59, s39, 5
v_mfma_f32_16x16x32_bf16 v[152:155], a[48:51], a[136:139], v[152:155]
s_add_u32 s59, s59, s38
ds_read_b128 a[100:103], v3 offset:40960
v_mfma_f32_16x16x32_bf16 v[152:155], a[52:55], a[140:143], v[152:155]
s_lshl_b32 s59, s59, 2
v_mfma_f32_16x16x32_bf16 v[156:159], a[56:59], a[136:139], v[156:159]
s_add_u32 s59, s59, 94392320
ds_read_b128 a[104:107], v2 offset:43008
v_mfma_f32_16x16x32_bf16 v[156:159], a[60:63], a[140:143], v[156:159]
s_waitcnt lgkmcnt(2)
s_cmp_lt_u32 s2, 224
v_mfma_f32_16x16x32_bf16 v[160:163], a[0:3], a[128:131], v[160:163]
s_cselect_b32 s59, s59, 3221225472
ds_read_b64_tr_b16 a[136:137], v9 offset:0
v_mfma_f32_16x16x32_bf16 v[160:163], a[4:7], a[132:135], v[160:163]
s_mov_b32 s58, 0xffff0000
v_mfma_f32_16x16x32_bf16 v[164:167], a[8:11], a[128:131], v[164:167]
ds_read_b64_tr_b16 a[138:139], v9 offset:2048
v_mfma_f32_16x16x32_bf16 v[164:167], a[12:15], a[132:135], v[164:167]
buffer_load_dword v21, v20, s[16:19], s43 offen
v_mfma_f32_16x16x32_bf16 v[168:171], a[16:19], a[128:131], v[168:171]
s_add_u32 s43, s43, s47
ds_read_b64_tr_b16 a[140:141], v9 offset:16384
v_mfma_f32_16x16x32_bf16 v[168:171], a[20:23], a[132:135], v[168:171]
s_cmp_ge_u32 s43, s51
v_mfma_f32_16x16x32_bf16 v[172:175], a[24:27], a[128:131], v[172:175]
s_cselect_b32 s43, 0, s43
ds_read_b64_tr_b16 a[142:143], v9 offset:18432
v_mfma_f32_16x16x32_bf16 v[172:175], a[28:31], a[132:135], v[172:175]
s_cselect_b32 s51, s42, s51
v_mfma_f32_16x16x32_bf16 v[176:179], a[32:35], a[128:131], v[176:179]
s_cselect_b64 s[16:17], s[40:41], s[16:17]
v_mfma_f32_16x16x32_bf16 v[176:179], a[36:39], a[132:135], v[176:179]
s_cselect_b32 s18, s42, s18
v_mfma_f32_16x16x32_bf16 v[180:183], a[40:43], a[128:131], v[180:183]
s_cselect_b64 s[40:41], s[44:45], s[40:41]
ds_read_b128 a[108:111], v3 offset:43008
v_mfma_f32_16x16x32_bf16 v[180:183], a[44:47], a[132:135], v[180:183]
s_cselect_b32 s42, s46, s42
v_mfma_f32_16x16x32_bf16 v[184:187], a[48:51], a[128:131], v[184:187]
s_cselect_b32 s46, 0, s46
ds_read_b128 a[112:115], v2 offset:45056
v_mfma_f32_16x16x32_bf16 v[184:187], a[52:55], a[132:135], v[184:187]
v_mfma_f32_16x16x32_bf16 v[188:191], a[56:59], a[128:131], v[188:191]
v_mfma_f32_16x16x32_bf16 v[188:191], a[60:63], a[132:135], v[188:191]
s_waitcnt lgkmcnt(2)
v_mfma_f32_16x16x32_bf16 v[192:195], a[0:3], a[136:139], v[192:195]
ds_read_b64_tr_b16 a[128:129], v10 offset:0
v_mfma_f32_16x16x32_bf16 v[192:195], a[4:7], a[140:143], v[192:195]
v_mfma_f32_16x16x32_bf16 v[196:199], a[8:11], a[136:139], v[196:199]
ds_read_b64_tr_b16 a[130:131], v10 offset:2048
v_mfma_f32_16x16x32_bf16 v[196:199], a[12:15], a[140:143], v[196:199]
v_mfma_f32_16x16x32_bf16 v[200:203], a[16:19], a[136:139], v[200:203]
ds_read_b64_tr_b16 a[132:133], v10 offset:16384
v_mfma_f32_16x16x32_bf16 v[200:203], a[20:23], a[140:143], v[200:203]
v_mfma_f32_16x16x32_bf16 v[204:207], a[24:27], a[136:139], v[204:207]
ds_read_b64_tr_b16 a[134:135], v10 offset:18432
v_mfma_f32_16x16x32_bf16 v[204:207], a[28:31], a[140:143], v[204:207]
v_mfma_f32_16x16x32_bf16 v[208:211], a[32:35], a[136:139], v[208:211]
ds_read_b128 a[116:119], v3 offset:45056
v_mfma_f32_16x16x32_bf16 v[208:211], a[36:39], a[140:143], v[208:211]
v_mfma_f32_16x16x32_bf16 v[212:215], a[40:43], a[136:139], v[212:215]
ds_read_b128 a[120:123], v2 offset:47104
v_and_b32 v252, 31, v0
v_mfma_f32_16x16x32_bf16 v[212:215], a[44:47], a[140:143], v[212:215]
v_lshrrev_b32 v253, 5, v0
v_xor_b32 v253, v253, v252
v_mfma_f32_16x16x32_bf16 v[216:219], a[48:51], a[136:139], v[216:219]
v_and_b32 v253, 7, v253
v_lshlrev_b32 v252, 8, v252
v_mfma_f32_16x16x32_bf16 v[216:219], a[52:55], a[140:143], v[216:219]
v_lshl_add_u32 v252, v253, 4, v252
v_add_u32 v252, 147456, v252
v_mfma_f32_16x16x32_bf16 v[220:223], a[56:59], a[136:139], v[220:223]
ds_read_b128 a[124:127], v3 offset:47104
v_mfma_f32_16x16x32_bf16 v[220:223], a[60:63], a[140:143], v[220:223]
s_waitcnt lgkmcnt(2)
v_mfma_f32_16x16x32_bf16 a[192:195], a[0:3], a[128:131], a[192:195]
ds_read_b64_tr_b16 a[136:137], v11 offset:0
v_mfma_f32_16x16x32_bf16 a[192:195], a[4:7], a[132:135], a[192:195]
v_mfma_f32_16x16x32_bf16 a[196:199], a[8:11], a[128:131], a[196:199]
ds_read_b64_tr_b16 a[138:139], v11 offset:2048
v_mfma_f32_16x16x32_bf16 a[196:199], a[12:15], a[132:135], a[196:199]
v_mfma_f32_16x16x32_bf16 a[200:203], a[16:19], a[128:131], a[200:203]
ds_read_b64_tr_b16 a[140:141], v11 offset:16384
v_mfma_f32_16x16x32_bf16 a[200:203], a[20:23], a[132:135], a[200:203]
v_mfma_f32_16x16x32_bf16 a[204:207], a[24:27], a[128:131], a[204:207]
ds_read_b64_tr_b16 a[142:143], v11 offset:18432
v_mfma_f32_16x16x32_bf16 a[204:207], a[28:31], a[132:135], a[204:207]
v_mfma_f32_16x16x32_bf16 a[208:211], a[32:35], a[128:131], a[208:211]
v_mfma_f32_16x16x32_bf16 a[208:211], a[36:39], a[132:135], a[208:211]
v_mfma_f32_16x16x32_bf16 a[212:215], a[40:43], a[128:131], a[212:215]
v_mfma_f32_16x16x32_bf16 a[212:215], a[44:47], a[132:135], a[212:215]
v_mfma_f32_16x16x32_bf16 a[216:219], a[48:51], a[128:131], a[216:219]
v_mfma_f32_16x16x32_bf16 a[216:219], a[52:55], a[132:135], a[216:219]
v_mfma_f32_16x16x32_bf16 a[220:223], a[56:59], a[128:131], a[220:223]
v_mfma_f32_16x16x32_bf16 a[220:223], a[60:63], a[132:135], a[220:223]
s_waitcnt vmcnt(2) lgkmcnt(0)
s_barrier
v_mfma_f32_16x16x32_bf16 a[224:227], a[0:3], a[136:139], a[224:227]
s_add_u32 m0, s29, 65536
ds_read_b64_tr_b16 a[128:129], v4 offset:32768
v_lshlrev_b32 v28, 16, v248
v_mfma_f32_16x16x32_bf16 a[224:227], a[4:7], a[140:143], a[224:227]
buffer_load_dwordx4 v16, s[12:15], s26 offen offset:0 lds
v_mfma_f32_16x16x32_bf16 a[228:231], a[8:11], a[136:139], a[228:231]
ds_read_b64_tr_b16 a[130:131], v4 offset:34816
v_and_b32 v29, s58, v248
v_mfma_f32_16x16x32_bf16 a[228:231], a[12:15], a[140:143], a[228:231]
v_lshlrev_b32 v30, 16, v249
v_and_b32 v253, s58, v249
v_mfma_f32_16x16x32_bf16 a[232:235], a[16:19], a[136:139], a[232:235]
ds_read_b64_tr_b16 a[132:133], v4 offset:49152
v_lshlrev_b32 v22, 16, v224
v_mfma_f32_16x16x32_bf16 a[232:235], a[20:23], a[140:143], a[232:235]
buffer_load_dwordx4 v17, s[12:15], s26 offen offset:1024 lds
v_mfma_f32_16x16x32_bf16 a[236:239], a[24:27], a[136:139], a[236:239]
ds_read_b64_tr_b16 a[134:135], v4 offset:51200
v_lshlrev_b32 v23, 16, v225
v_mfma_f32_16x16x32_bf16 a[236:239], a[28:31], a[140:143], a[236:239]
v_lshlrev_b32 v24, 16, v226
v_mul_f32 v254, v22, v253
v_mfma_f32_16x16x32_bf16 a[240:243], a[32:35], a[136:139], a[240:243]
v_lshlrev_b32 v25, 16, v227
v_lshlrev_b32 v247, 16, v236
v_mfma_f32_16x16x32_bf16 a[240:243], a[36:39], a[140:143], a[240:243]
buffer_load_dwordx4 v18, s[12:15], s26 offen offset:2048 lds
v_mfma_f32_16x16x32_bf16 a[244:247], a[40:43], a[136:139], a[244:247]
v_fmac_f32 v254, v23, v30
v_fmac_f32 v254, v24, v29
v_mfma_f32_16x16x32_bf16 a[244:247], a[44:47], a[140:143], a[244:247]
v_fmac_f32 v254, v25, v28
v_mul_f32 v254, v254, v247
v_mfma_f32_16x16x32_bf16 a[248:251], a[48:51], a[136:139], a[248:251]
v_mul_f32 v255, v23, v253
v_lshlrev_b32 v22, 16, v228
v_mfma_f32_16x16x32_bf16 a[248:251], a[52:55], a[140:143], a[248:251]
buffer_load_dwordx4 v19, s[12:15], s26 offen offset:3072 lds
v_mfma_f32_16x16x32_bf16 a[252:255], a[56:59], a[136:139], a[252:255]
s_add_u32 s26, s26, 524288
v_lshlrev_b32 v247, 16, v237
v_fmac_f32 v255, v24, v30
v_mfma_f32_16x16x32_bf16 a[252:255], a[60:63], a[140:143], a[252:255]
s_waitcnt lgkmcnt(0)
v_fmac_f32 v255, v25, v29
v_fmac_f32 v255, v22, v28
v_mfma_f32_16x16x32_bf16 v[32:35], a[64:67], a[128:131], v[32:35]
s_add_u32 m0, s29, 81920
ds_read_b64_tr_b16 a[136:137], v5 offset:32768
v_mul_f32 v255, v255, v247
v_mfma_f32_16x16x32_bf16 v[32:35], a[68:71], a[132:135], v[32:35]
buffer_load_dwordx4 v16, s[12:15], s27 offen offset:0 lds
v_mfma_f32_16x16x32_bf16 v[36:39], a[72:75], a[128:131], v[36:39]
ds_read_b64_tr_b16 a[138:139], v5 offset:34816
v_cvt_pk_bf16_f32 v246, v254, v255
v_mfma_f32_16x16x32_bf16 v[36:39], a[76:79], a[132:135], v[36:39]
v_accvgpr_write_b32 a180, v246
v_mul_f32 v254, v24, v253
v_mfma_f32_16x16x32_bf16 v[40:43], a[80:83], a[128:131], v[40:43]
ds_read_b64_tr_b16 a[140:141], v5 offset:49152
v_lshlrev_b32 v23, 16, v229
v_mfma_f32_16x16x32_bf16 v[40:43], a[84:87], a[132:135], v[40:43]
buffer_load_dwordx4 v17, s[12:15], s27 offen offset:1024 lds
v_lshlrev_b32 v247, 16, v238
v_mfma_f32_16x16x32_bf16 v[44:47], a[88:91], a[128:131], v[44:47]
ds_read_b64_tr_b16 a[142:143], v5 offset:51200
v_fmac_f32 v254, v25, v30
v_mfma_f32_16x16x32_bf16 v[44:47], a[92:95], a[132:135], v[44:47]
v_fmac_f32 v254, v22, v29
v_fmac_f32 v254, v23, v28
v_mfma_f32_16x16x32_bf16 v[48:51], a[96:99], a[128:131], v[48:51]
ds_read_b128 a[0:3], v2 offset:0
v_mul_f32 v254, v254, v247
v_mfma_f32_16x16x32_bf16 v[48:51], a[100:103], a[132:135], v[48:51]
buffer_load_dwordx4 v18, s[12:15], s27 offen offset:2048 lds
v_mfma_f32_16x16x32_bf16 v[52:55], a[104:107], a[128:131], v[52:55]
ds_read_b128 a[4:7], v3 offset:0
v_cvt_pk_bf16_f32 v246, v255, v254
v_accvgpr_write_b32 a176, v246
v_mfma_f32_16x16x32_bf16 v[52:55], a[108:111], a[132:135], v[52:55]
v_mul_f32 v255, v25, v253
v_lshlrev_b32 v24, 16, v230
v_mfma_f32_16x16x32_bf16 v[56:59], a[112:115], a[128:131], v[56:59]
v_lshlrev_b32 v247, 16, v239
v_fmac_f32 v255, v22, v30
v_mfma_f32_16x16x32_bf16 v[56:59], a[116:119], a[132:135], v[56:59]
buffer_load_dwordx4 v19, s[12:15], s27 offen offset:3072 lds
v_mfma_f32_16x16x32_bf16 v[60:63], a[120:123], a[128:131], v[60:63]
s_add_u32 s27, s27, 524288
ds_read_b128 a[8:11], v2 offset:2048
v_fmac_f32 v255, v23, v29
v_mfma_f32_16x16x32_bf16 v[60:63], a[124:127], a[132:135], v[60:63]
s_waitcnt lgkmcnt(2)
v_fmac_f32 v255, v24, v28
v_mul_f32 v255, v255, v247
v_mfma_f32_16x16x32_bf16 v[64:67], a[64:67], a[136:139], v[64:67]
s_add_u32 m0, s28, 32768
ds_read_b64_tr_b16 a[128:129], v6 offset:32768
v_cvt_pk_bf16_f32 v246, v254, v255
v_accvgpr_write_b32 a181, v246
v_mfma_f32_16x16x32_bf16 v[64:67], a[68:71], a[140:143], v[64:67]
buffer_load_dwordx4 v12, s[8:11], s24 offen offset:0 lds
v_mfma_f32_16x16x32_bf16 v[68:71], a[72:75], a[136:139], v[68:71]
ds_read_b64_tr_b16 a[130:131], v6 offset:34816
v_mul_f32 v254, v22, v253
v_mfma_f32_16x16x32_bf16 v[68:71], a[76:79], a[140:143], v[68:71]
v_lshlrev_b32 v25, 16, v231
v_lshlrev_b32 v247, 16, v240
v_mfma_f32_16x16x32_bf16 v[72:75], a[80:83], a[136:139], v[72:75]
ds_read_b64_tr_b16 a[132:133], v6 offset:49152
v_fmac_f32 v254, v23, v30
v_mfma_f32_16x16x32_bf16 v[72:75], a[84:87], a[140:143], v[72:75]
buffer_load_dwordx4 v13, s[8:11], s24 offen offset:1024 lds
v_fmac_f32 v254, v24, v29
v_mfma_f32_16x16x32_bf16 v[76:79], a[88:91], a[136:139], v[76:79]
ds_read_b64_tr_b16 a[134:135], v6 offset:51200
v_fmac_f32 v254, v25, v28
v_mfma_f32_16x16x32_bf16 v[76:79], a[92:95], a[140:143], v[76:79]
v_mul_f32 v254, v254, v247
v_cvt_pk_bf16_f32 v246, v255, v254
v_mfma_f32_16x16x32_bf16 v[80:83], a[96:99], a[136:139], v[80:83]
ds_read_b128 a[12:15], v3 offset:2048
v_accvgpr_write_b32 a177, v246
v_mfma_f32_16x16x32_bf16 v[80:83], a[100:103], a[140:143], v[80:83]
buffer_load_dwordx4 v14, s[8:11], s24 offen offset:2048 lds
v_mfma_f32_16x16x32_bf16 v[84:87], a[104:107], a[136:139], v[84:87]
v_mul_f32 v255, v23, v253
v_lshlrev_b32 v22, 16, v232
v_lshlrev_b32 v247, 16, v241
v_mfma_f32_16x16x32_bf16 v[84:87], a[108:111], a[140:143], v[84:87]
v_fmac_f32 v255, v24, v30
v_fmac_f32 v255, v25, v29
v_mfma_f32_16x16x32_bf16 v[88:91], a[112:115], a[136:139], v[88:91]
ds_read_b128 a[16:19], v2 offset:4096
v_fmac_f32 v255, v22, v28
v_mfma_f32_16x16x32_bf16 v[88:91], a[116:119], a[140:143], v[88:91]
buffer_load_dwordx4 v15, s[8:11], s24 offen offset:3072 lds
v_mfma_f32_16x16x32_bf16 v[92:95], a[120:123], a[136:139], v[92:95]
s_add_u32 s24, s24, 128
ds_read_b128 a[20:23], v3 offset:4096
v_mul_f32 v255, v255, v247
v_mfma_f32_16x16x32_bf16 v[92:95], a[124:127], a[140:143], v[92:95]
s_waitcnt lgkmcnt(2)
v_cvt_pk_bf16_f32 v246, v254, v255
v_accvgpr_write_b32 a182, v246
v_mfma_f32_16x16x32_bf16 v[96:99], a[64:67], a[128:131], v[96:99]
s_add_u32 m0, s28, 36864
ds_read_b64_tr_b16 a[136:137], v7 offset:32768
v_mul_f32 v254, v24, v253
v_lshlrev_b32 v23, 16, v233
v_mfma_f32_16x16x32_bf16 v[96:99], a[68:71], a[132:135], v[96:99]
buffer_load_dwordx4 v12, s[8:11], s25 offen offset:0 lds
v_mfma_f32_16x16x32_bf16 v[100:103], a[72:75], a[128:131], v[100:103]
ds_read_b64_tr_b16 a[138:139], v7 offset:34816
v_lshlrev_b32 v247, 16, v242
v_mfma_f32_16x16x32_bf16 v[100:103], a[76:79], a[132:135], v[100:103]
v_fmac_f32 v254, v25, v30
v_fmac_f32 v254, v22, v29
v_mfma_f32_16x16x32_bf16 v[104:107], a[80:83], a[128:131], v[104:107]
ds_read_b64_tr_b16 a[140:141], v7 offset:49152
v_fmac_f32 v254, v23, v28
v_mfma_f32_16x16x32_bf16 v[104:107], a[84:87], a[132:135], v[104:107]
buffer_load_dwordx4 v13, s[8:11], s25 offen offset:1024 lds
v_mul_f32 v254, v254, v247
v_mfma_f32_16x16x32_bf16 v[108:111], a[88:91], a[128:131], v[108:111]
ds_read_b64_tr_b16 a[142:143], v7 offset:51200
v_cvt_pk_bf16_f32 v246, v255, v254
v_mfma_f32_16x16x32_bf16 v[108:111], a[92:95], a[132:135], v[108:111]
v_accvgpr_write_b32 a178, v246
v_mul_f32 v255, v25, v253
v_mfma_f32_16x16x32_bf16 v[112:115], a[96:99], a[128:131], v[112:115]
v_lshlrev_b32 v24, 16, v234
v_lshlrev_b32 v247, 16, v243
v_mfma_f32_16x16x32_bf16 v[112:115], a[100:103], a[132:135], v[112:115]
buffer_load_dwordx4 v14, s[8:11], s25 offen offset:2048 lds
v_mfma_f32_16x16x32_bf16 v[116:119], a[104:107], a[128:131], v[116:119]
ds_read_b128 a[24:27], v2 offset:6144
v_fmac_f32 v255, v22, v30
v_fmac_f32 v255, v23, v29
v_mfma_f32_16x16x32_bf16 v[116:119], a[108:111], a[132:135], v[116:119]
PAD_20:
s_cbranch_execz PAD_24
v_fmac_f32 v255, v24, v28
v_mul_f32 v255, v255, v247
v_mfma_f32_16x16x32_bf16 v[120:123], a[112:115], a[128:131], v[120:123]
ds_read_b128 a[28:31], v3 offset:6144
v_cvt_pk_bf16_f32 v246, v254, v255
v_mfma_f32_16x16x32_bf16 v[120:123], a[116:119], a[132:135], v[120:123]
buffer_load_dwordx4 v15, s[8:11], s25 offen offset:3072 lds
v_mfma_f32_16x16x32_bf16 v[124:127], a[120:123], a[128:131], v[124:127]
s_add_u32 s25, s25, 128
v_accvgpr_write_b32 a183, v246
v_mul_f32 v254, v22, v253
v_mfma_f32_16x16x32_bf16 v[124:127], a[124:127], a[132:135], v[124:127]
s_waitcnt lgkmcnt(2)
v_lshlrev_b32 v25, 16, v235
v_lshlrev_b32 v247, 16, v244
v_mfma_f32_16x16x32_bf16 v[128:131], a[64:67], a[136:139], v[128:131]
ds_read_b64_tr_b16 a[128:129], v8 offset:32768
v_fmac_f32 v254, v23, v30
v_fmac_f32 v254, v24, v29
v_mfma_f32_16x16x32_bf16 v[128:131], a[68:71], a[140:143], v[128:131]
buffer_load_dword v21, v20, s[16:19], s43 offen
v_mfma_f32_16x16x32_bf16 v[132:135], a[72:75], a[136:139], v[132:135]
s_add_u32 s43, s43, s47
ds_read_b64_tr_b16 a[130:131], v8 offset:34816
v_fmac_f32 v254, v25, v28
v_mfma_f32_16x16x32_bf16 v[132:135], a[76:79], a[140:143], v[132:135]
s_cmp_ge_u32 s43, s51
v_mul_f32 v254, v254, v247
v_cvt_pk_bf16_f32 v246, v255, v254
v_mfma_f32_16x16x32_bf16 v[136:139], a[80:83], a[136:139], v[136:139]
s_cselect_b32 s43, 0, s43
ds_read_b64_tr_b16 a[132:133], v8 offset:49152
v_accvgpr_write_b32 a179, v246
v_mfma_f32_16x16x32_bf16 v[136:139], a[84:87], a[140:143], v[136:139]
s_cselect_b32 s51, s42, s51
v_lshlrev_b32 v28, 16, v250
v_and_b32 v29, s58, v250
v_lshlrev_b32 v30, 16, v251
v_mfma_f32_16x16x32_bf16 v[140:143], a[88:91], a[136:139], v[140:143]
s_cselect_b64 s[16:17], s[40:41], s[16:17]
ds_read_b64_tr_b16 a[134:135], v8 offset:51200
v_and_b32 v253, s58, v251
v_mfma_f32_16x16x32_bf16 v[140:143], a[92:95], a[140:143], v[140:143]
s_cselect_b32 s18, s42, s18
v_and_b32 v22, s58, v224
v_and_b32 v23, s58, v225
v_mfma_f32_16x16x32_bf16 v[144:147], a[96:99], a[136:139], v[144:147]
s_cselect_b64 s[40:41], s[44:45], s[40:41]
ds_read_b128 a[32:35], v2 offset:8192
v_and_b32 v24, s58, v226
v_mfma_f32_16x16x32_bf16 v[144:147], a[100:103], a[140:143], v[144:147]
s_cselect_b32 s42, s46, s42
v_mul_f32 v254, v22, v253
v_and_b32 v25, s58, v227
v_mfma_f32_16x16x32_bf16 v[148:151], a[104:107], a[136:139], v[148:151]
s_cselect_b32 s46, 0, s46
v_and_b32 v247, s58, v236
v_fmac_f32 v254, v23, v30
v_mfma_f32_16x16x32_bf16 v[148:151], a[108:111], a[140:143], v[148:151]
buffer_load_dword v245, off, s[60:63], 0 sc1
v_fmac_f32 v254, v24, v29
v_mfma_f32_16x16x32_bf16 v[152:155], a[112:115], a[136:139], v[152:155]
ds_read_b128 a[36:39], v3 offset:8192
v_fmac_f32 v254, v25, v28
v_mfma_f32_16x16x32_bf16 v[152:155], a[116:119], a[140:143], v[152:155]
v_mul_f32 v254, v254, v247
v_mul_f32 v255, v23, v253
v_mfma_f32_16x16x32_bf16 v[156:159], a[120:123], a[136:139], v[156:159]
ds_read_b128 a[40:43], v2 offset:10240
v_and_b32 v22, s58, v228
v_mfma_f32_16x16x32_bf16 v[156:159], a[124:127], a[140:143], v[156:159]
s_waitcnt lgkmcnt(2)
v_and_b32 v247, s58, v237
v_fmac_f32 v255, v24, v30
v_mfma_f32_16x16x32_bf16 v[160:163], a[64:67], a[128:131], v[160:163]
ds_read_b64_tr_b16 a[136:137], v9 offset:32768
v_fmac_f32 v255, v25, v29
v_fmac_f32 v255, v22, v28
v_mfma_f32_16x16x32_bf16 v[160:163], a[68:71], a[132:135], v[160:163]
v_mul_f32 v255, v255, v247
v_cvt_pk_bf16_f32 v246, v254, v255
v_mfma_f32_16x16x32_bf16 v[164:167], a[72:75], a[128:131], v[164:167]
ds_read_b64_tr_b16 a[138:139], v9 offset:34816
v_accvgpr_write_b32 a188, v246
v_mfma_f32_16x16x32_bf16 v[164:167], a[76:79], a[132:135], v[164:167]
v_mul_f32 v254, v24, v253
v_and_b32 v23, s58, v229
v_mfma_f32_16x16x32_bf16 v[168:171], a[80:83], a[128:131], v[168:171]
ds_read_b64_tr_b16 a[140:141], v9 offset:49152
v_and_b32 v247, s58, v238
v_mfma_f32_16x16x32_bf16 v[168:171], a[84:87], a[132:135], v[168:171]
v_fmac_f32 v254, v25, v30
v_fmac_f32 v254, v22, v29
v_fmac_f32 v254, v23, v28
v_mfma_f32_16x16x32_bf16 v[172:175], a[88:91], a[128:131], v[172:175]
ds_read_b64_tr_b16 a[142:143], v9 offset:51200
v_mul_f32 v254, v254, v247
v_mfma_f32_16x16x32_bf16 v[172:175], a[92:95], a[132:135], v[172:175]
v_cvt_pk_bf16_f32 v246, v255, v254
v_accvgpr_write_b32 a184, v246
v_mfma_f32_16x16x32_bf16 v[176:179], a[96:99], a[128:131], v[176:179]
v_mul_f32 v255, v25, v253
v_and_b32 v24, s58, v230
v_mfma_f32_16x16x32_bf16 v[176:179], a[100:103], a[132:135], v[176:179]
v_and_b32 v247, s58, v239
v_fmac_f32 v255, v22, v30
v_mfma_f32_16x16x32_bf16 v[180:183], a[104:107], a[128:131], v[180:183]
ds_read_b128 a[44:47], v3 offset:10240
v_fmac_f32 v255, v23, v29
v_mfma_f32_16x16x32_bf16 v[180:183], a[108:111], a[132:135], v[180:183]
v_fmac_f32 v255, v24, v28
v_mul_f32 v255, v255, v247
v_cvt_pk_bf16_f32 v246, v254, v255
v_mfma_f32_16x16x32_bf16 v[184:187], a[112:115], a[128:131], v[184:187]
ds_read_b128 a[48:51], v2 offset:12288
v_accvgpr_write_b32 a189, v246
v_mfma_f32_16x16x32_bf16 v[184:187], a[116:119], a[132:135], v[184:187]
v_mul_f32 v254, v22, v253
v_and_b32 v25, s58, v231
v_mfma_f32_16x16x32_bf16 v[188:191], a[120:123], a[128:131], v[188:191]
v_and_b32 v247, s58, v240
v_fmac_f32 v254, v23, v30
v_mfma_f32_16x16x32_bf16 v[188:191], a[124:127], a[132:135], v[188:191]
s_waitcnt lgkmcnt(2)
v_fmac_f32 v254, v24, v29
v_fmac_f32 v254, v25, v28
v_mfma_f32_16x16x32_bf16 v[192:195], a[64:67], a[136:139], v[192:195]
ds_read_b64_tr_b16 a[128:129], v10 offset:32768
v_mul_f32 v254, v254, v247
v_cvt_pk_bf16_f32 v246, v255, v254
v_mfma_f32_16x16x32_bf16 v[192:195], a[68:71], a[140:143], v[192:195]
v_accvgpr_write_b32 a185, v246
v_mul_f32 v255, v23, v253
v_mfma_f32_16x16x32_bf16 v[196:199], a[72:75], a[136:139], v[196:199]
ds_read_b64_tr_b16 a[130:131], v10 offset:34816
v_and_b32 v22, s58, v232
v_mfma_f32_16x16x32_bf16 v[196:199], a[76:79], a[140:143], v[196:199]
v_and_b32 v247, s58, v241
v_fmac_f32 v255, v24, v30
v_mfma_f32_16x16x32_bf16 v[200:203], a[80:83], a[136:139], v[200:203]
s_lshr_b32 s22, s3, 1
ds_read_b64_tr_b16 a[132:133], v10 offset:49152
v_fmac_f32 v255, v25, v29
v_mfma_f32_16x16x32_bf16 v[200:203], a[84:87], a[140:143], v[200:203]
s_mul_i32 s22, s22, 2097152
v_fmac_f32 v255, v22, v28
v_mul_f32 v255, v255, v247
v_cvt_pk_bf16_f32 v246, v254, v255
v_mfma_f32_16x16x32_bf16 v[204:207], a[88:91], a[136:139], v[204:207]
s_and_b32 s23, s3, 1
ds_read_b64_tr_b16 a[134:135], v10 offset:51200
v_accvgpr_write_b32 a190, v246
v_mfma_f32_16x16x32_bf16 v[204:207], a[92:95], a[140:143], v[204:207]
s_lshl_b32 s23, s23, 5
v_mul_f32 v254, v24, v253
v_and_b32 v23, s58, v233
v_mfma_f32_16x16x32_bf16 v[208:211], a[96:99], a[136:139], v[208:211]
s_lshl_b32 s56, s39, 6
ds_read_b128 a[52:55], v3 offset:12288
v_and_b32 v247, s58, v242
v_mfma_f32_16x16x32_bf16 v[208:211], a[100:103], a[140:143], v[208:211]
s_add_u32 s23, s23, s56
v_fmac_f32 v254, v25, v30
v_fmac_f32 v254, v22, v29
v_mfma_f32_16x16x32_bf16 v[212:215], a[104:107], a[136:139], v[212:215]
s_mul_i32 s23, s23, 4224
ds_read_b128 a[56:59], v2 offset:14336
v_fmac_f32 v254, v23, v28
v_mfma_f32_16x16x32_bf16 v[212:215], a[108:111], a[140:143], v[212:215]
s_add_u32 s22, s22, s23
v_mul_f32 v254, v254, v247
v_cvt_pk_bf16_f32 v246, v255, v254
v_accvgpr_write_b32 a186, v246
v_mfma_f32_16x16x32_bf16 v[216:219], a[112:115], a[136:139], v[216:219]
s_add_u32 s57, s22, 83886200
v_mul_f32 v255, v25, v253
v_and_b32 v24, s58, v234
v_mfma_f32_16x16x32_bf16 v[216:219], a[116:119], a[140:143], v[216:219]
s_lshl_b32 s23, s38, 7
v_and_b32 v247, s58, v243
v_fmac_f32 v255, v22, v30
v_mfma_f32_16x16x32_bf16 v[220:223], a[120:123], a[136:139], v[220:223]
s_add_u32 s22, s22, s23
ds_read_b128 a[60:63], v3 offset:14336
v_fmac_f32 v255, v23, v29
v_mfma_f32_16x16x32_bf16 v[220:223], a[124:127], a[140:143], v[220:223]
s_waitcnt lgkmcnt(2)
s_add_u32 s56, s22, 83886208
v_fmac_f32 v255, v24, v28
v_mul_f32 v255, v255, v247
v_mfma_f32_16x16x32_bf16 a[192:195], a[64:67], a[128:131], a[192:195]
s_cmp_lt_u32 s2, 224
ds_read_b64_tr_b16 a[136:137], v11 offset:32768
v_cvt_pk_bf16_f32 v246, v254, v255
v_accvgpr_write_b32 a191, v246
v_mfma_f32_16x16x32_bf16 a[192:195], a[68:71], a[132:135], a[192:195]
s_cselect_b32 s56, s56, 3221225472
v_mul_f32 v254, v22, v253
v_and_b32 v25, s58, v235
v_mfma_f32_16x16x32_bf16 a[196:199], a[72:75], a[128:131], a[196:199]
s_cmp_eq_u32 s38, 0
ds_read_b64_tr_b16 a[138:139], v11 offset:34816
v_and_b32 v247, s58, v244
v_mfma_f32_16x16x32_bf16 a[196:199], a[76:79], a[132:135], a[196:199]
s_cselect_b32 s57, s57, 3221225472
v_fmac_f32 v254, v23, v30
v_fmac_f32 v254, v24, v29
v_mfma_f32_16x16x32_bf16 a[200:203], a[80:83], a[128:131], a[200:203]
ds_read_b64_tr_b16 a[140:141], v11 offset:49152
v_fmac_f32 v254, v25, v28
v_mfma_f32_16x16x32_bf16 a[200:203], a[84:87], a[132:135], a[200:203]
v_mul_f32 v254, v254, v247
v_cvt_pk_bf16_f32 v246, v255, v254
v_accvgpr_write_b32 a187, v246
v_mfma_f32_16x16x32_bf16 a[204:207], a[88:91], a[128:131], a[204:207]
ds_read_b64_tr_b16 a[142:143], v11 offset:51200
v_mfma_f32_16x16x32_bf16 a[204:207], a[92:95], a[132:135], a[204:207]
ds_write_b128 v252, a[176:179] offset:0
v_mfma_f32_16x16x32_bf16 a[208:211], a[96:99], a[128:131], a[208:211]
v_mfma_f32_16x16x32_bf16 a[208:211], a[100:103], a[132:135], a[208:211]
ds_write_b128 v252, a[180:183] offset:8192
v_mfma_f32_16x16x32_bf16 a[212:215], a[104:107], a[128:131], a[212:215]
v_mfma_f32_16x16x32_bf16 a[212:215], a[108:111], a[132:135], a[212:215]
ds_write_b128 v252, a[184:187] offset:128
v_mfma_f32_16x16x32_bf16 a[216:219], a[112:115], a[128:131], a[216:219]
v_mfma_f32_16x16x32_bf16 a[216:219], a[116:119], a[132:135], a[216:219]
ds_write_b128 v252, a[188:191] offset:8320
v_mfma_f32_16x16x32_bf16 a[220:223], a[120:123], a[128:131], a[220:223]
v_mfma_f32_16x16x32_bf16 a[220:223], a[124:127], a[132:135], a[220:223]
s_waitcnt vmcnt(2) lgkmcnt(0)
s_barrier
v_mfma_f32_16x16x32_bf16 a[224:227], a[64:67], a[136:139], a[224:227]
s_add_u32 m0, s29, 98304
ds_read_b64_tr_b16 a[128:129], v4 offset:0
v_lshrrev_b32 v22, 8, v1
v_mfma_f32_16x16x32_bf16 a[224:227], a[68:71], a[140:143], a[224:227]
buffer_load_dwordx4 v16, s[12:15], s26 offen offset:0 lds
v_mfma_f32_16x16x32_bf16 a[228:231], a[72:75], a[136:139], a[228:231]
ds_read_b64_tr_b16 a[130:131], v4 offset:2048
v_lshlrev_b32 v22, 4, v22
v_mfma_f32_16x16x32_bf16 a[228:231], a[76:79], a[140:143], a[228:231]
v_xor_b32 v22, v22, v1
v_add_u32 v22, s29, v22
v_mfma_f32_16x16x32_bf16 a[232:235], a[80:83], a[136:139], a[232:235]
ds_read_b64_tr_b16 a[132:133], v4 offset:16384
v_add_u32 v22, 147456, v22
v_mfma_f32_16x16x32_bf16 a[232:235], a[84:87], a[140:143], a[232:235]
buffer_load_dwordx4 v17, s[12:15], s26 offen offset:1024 lds
v_mfma_f32_16x16x32_bf16 a[236:239], a[88:91], a[136:139], a[236:239]
ds_read_b64_tr_b16 a[134:135], v4 offset:18432
v_xor_b32 v23, 64, v22
v_mfma_f32_16x16x32_bf16 a[236:239], a[92:95], a[140:143], a[236:239]
v_lshrrev_b32 v224, 7, v1
v_mul_u32_u24 v224, 4224, v224
v_mfma_f32_16x16x32_bf16 a[240:243], a[96:99], a[136:139], a[240:243]
v_and_b32 v225, 0x70, v1
v_add_u32 v224, v224, v225
v_mfma_f32_16x16x32_bf16 a[240:243], a[100:103], a[140:143], a[240:243]
buffer_load_dwordx4 v18, s[12:15], s26 offen offset:2048 lds
v_mfma_f32_16x16x32_bf16 a[244:247], a[104:107], a[136:139], a[244:247]
v_bfe_u32 v225, v1, 4, 5
v_mul_u32_u24 v225, 4224, v225
v_mfma_f32_16x16x32_bf16 a[244:247], a[108:111], a[140:143], a[244:247]
v_mov_b32 v226, 0
v_mov_b32 v227, 0
v_mfma_f32_16x16x32_bf16 a[248:251], a[112:115], a[136:139], a[248:251]
v_mfma_f32_16x16x32_bf16 a[248:251], a[116:119], a[140:143], a[248:251]
buffer_load_dwordx4 v19, s[12:15], s26 offen offset:3072 lds
v_mfma_f32_16x16x32_bf16 a[252:255], a[120:123], a[136:139], a[252:255]
s_add_u32 s26, s26, 524288
v_mfma_f32_16x16x32_bf16 a[252:255], a[124:127], a[140:143], a[252:255]
s_waitcnt lgkmcnt(0)
v_mfma_f32_16x16x32_bf16 v[32:35], a[0:3], a[128:131], v[32:35]
s_add_u32 m0, s29, 114688
ds_read_b64_tr_b16 a[136:137], v5 offset:0
v_mfma_f32_16x16x32_bf16 v[32:35], a[4:7], a[132:135], v[32:35]
buffer_load_dwordx4 v16, s[12:15], s27 offen offset:0 lds
v_mfma_f32_16x16x32_bf16 v[36:39], a[8:11], a[128:131], v[36:39]
s_mul_i32 s52, s20, 7
ds_read_b64_tr_b16 a[138:139], v5 offset:2048
v_mfma_f32_16x16x32_bf16 v[36:39], a[12:15], a[132:135], v[36:39]
s_add_u32 s52, s52, s21
buffer_store_dwordx2 v[226:227], v225, s[4:7], s57 offen sc1
v_mfma_f32_16x16x32_bf16 v[40:43], a[16:19], a[128:131], v[40:43]
s_lshl_b32 s53, s52, 2
ds_read_b64_tr_b16 a[140:141], v5 offset:16384
v_mfma_f32_16x16x32_bf16 v[40:43], a[20:23], a[132:135], v[40:43]
s_add_u32 s53, s53, s3
buffer_load_dwordx4 v17, s[12:15], s27 offen offset:1024 lds
v_mfma_f32_16x16x32_bf16 v[44:47], a[24:27], a[128:131], v[44:47]
s_lshl_b32 s49, s53, 12
ds_read_b64_tr_b16 a[142:143], v5 offset:18432
v_mfma_f32_16x16x32_bf16 v[44:47], a[28:31], a[132:135], v[44:47]
s_mul_i32 s53, s53, 4224
v_mfma_f32_16x16x32_bf16 v[48:51], a[32:35], a[128:131], v[48:51]
s_add_u32 s53, s53, 83886080
ds_read_b128 a[64:67], v2 offset:32768
v_mfma_f32_16x16x32_bf16 v[48:51], a[36:39], a[132:135], v[48:51]
s_lshr_b32 s52, s52, 4
buffer_load_dwordx4 v18, s[12:15], s27 offen offset:2048 lds
v_mfma_f32_16x16x32_bf16 v[52:55], a[40:43], a[128:131], v[52:55]
s_min_u32 s52, s52, 6
ds_read_b128 a[68:71], v3 offset:32768
v_mfma_f32_16x16x32_bf16 v[52:55], a[44:47], a[132:135], v[52:55]
s_lshl_b32 s52, s52, 7
ds_read_b128 a[176:179], v22 offset:0
v_mfma_f32_16x16x32_bf16 v[56:59], a[48:51], a[128:131], v[56:59]
s_add_u32 s52, s52, 94392320
ds_read_b128 a[180:183], v23 offset:1024
v_mfma_f32_16x16x32_bf16 v[56:59], a[52:55], a[132:135], v[56:59]
buffer_load_dwordx4 v19, s[12:15], s27 offen offset:3072 lds
v_mfma_f32_16x16x32_bf16 v[60:63], a[56:59], a[128:131], v[60:63]
s_add_u32 s27, s27, 524288
ds_read_b128 a[72:75], v2 offset:34816
v_mfma_f32_16x16x32_bf16 v[60:63], a[60:63], a[132:135], v[60:63]
s_waitcnt lgkmcnt(4)
ds_read_b128 a[184:187], v22 offset:2048
v_mfma_f32_16x16x32_bf16 v[64:67], a[0:3], a[136:139], v[64:67]
s_add_u32 m0, s28, 0
ds_read_b64_tr_b16 a[128:129], v6 offset:0
v_mfma_f32_16x16x32_bf16 v[64:67], a[4:7], a[140:143], v[64:67]
buffer_load_dwordx4 v12, s[8:11], s24 offen offset:0 lds
v_mfma_f32_16x16x32_bf16 v[68:71], a[8:11], a[136:139], v[68:71]
ds_read_b64_tr_b16 a[130:131], v6 offset:2048
v_mfma_f32_16x16x32_bf16 v[68:71], a[12:15], a[140:143], v[68:71]
ds_read_b128 a[188:191], v23 offset:3072
v_mfma_f32_16x16x32_bf16 v[72:75], a[16:19], a[136:139], v[72:75]
ds_read_b64_tr_b16 a[132:133], v6 offset:16384
v_bfe_u32 v231, v1, 4, 5
v_mfma_f32_16x16x32_bf16 v[72:75], a[20:23], a[140:143], v[72:75]
buffer_load_dwordx4 v13, s[8:11], s24 offen offset:1024 lds
v_mfma_f32_16x16x32_bf16 v[76:79], a[24:27], a[136:139], v[76:79]
ds_read_b64_tr_b16 a[134:135], v6 offset:18432
v_lshlrev_b32 v231, 2, v231
v_mfma_f32_16x16x32_bf16 v[76:79], a[28:31], a[140:143], v[76:79]
v_lshlrev_b32 v229, 3, v1
v_min_u32 v229, 4096, v229
v_mfma_f32_16x16x32_bf16 v[80:83], a[32:35], a[136:139], v[80:83]
ds_read_b128 a[76:79], v3 offset:34816
v_mfma_f32_16x16x32_bf16 v[80:83], a[36:39], a[140:143], v[80:83]
buffer_load_dwordx4 v14, s[8:11], s24 offen offset:2048 lds
v_mfma_f32_16x16x32_bf16 v[84:87], a[40:43], a[136:139], v[84:87]
v_mfma_f32_16x16x32_bf16 v[84:87], a[44:47], a[140:143], v[84:87]
v_mfma_f32_16x16x32_bf16 v[88:91], a[48:51], a[136:139], v[88:91]
ds_read_b128 a[80:83], v2 offset:36864
v_mfma_f32_16x16x32_bf16 v[88:91], a[52:55], a[140:143], v[88:91]
buffer_load_dwordx4 v15, s[8:11], s24 offen offset:3072 lds
v_mfma_f32_16x16x32_bf16 v[92:95], a[56:59], a[136:139], v[92:95]
s_add_u32 s24, s24, 128
ds_read_b128 a[84:87], v3 offset:36864
v_mfma_f32_16x16x32_bf16 v[92:95], a[60:63], a[140:143], v[92:95]
s_waitcnt lgkmcnt(2)
v_mfma_f32_16x16x32_bf16 v[96:99], a[0:3], a[128:131], v[96:99]
s_add_u32 m0, s28, 4096
ds_read_b64_tr_b16 a[136:137], v7 offset:0
v_mfma_f32_16x16x32_bf16 v[96:99], a[4:7], a[132:135], v[96:99]
buffer_load_dwordx4 v12, s[8:11], s25 offen offset:0 lds
v_mfma_f32_16x16x32_bf16 v[100:103], a[8:11], a[128:131], v[100:103]
ds_read_b64_tr_b16 a[138:139], v7 offset:2048
v_mfma_f32_16x16x32_bf16 v[100:103], a[12:15], a[132:135], v[100:103]
v_mfma_f32_16x16x32_bf16 v[104:107], a[16:19], a[128:131], v[104:107]
ds_read_b64_tr_b16 a[140:141], v7 offset:16384
v_mfma_f32_16x16x32_bf16 v[104:107], a[20:23], a[132:135], v[104:107]
buffer_load_dwordx4 v13, s[8:11], s25 offen offset:1024 lds
v_mfma_f32_16x16x32_bf16 v[108:111], a[24:27], a[128:131], v[108:111]
ds_read_b64_tr_b16 a[142:143], v7 offset:18432
v_mfma_f32_16x16x32_bf16 v[108:111], a[28:31], a[132:135], v[108:111]
v_mfma_f32_16x16x32_bf16 v[112:115], a[32:35], a[128:131], v[112:115]
v_mfma_f32_16x16x32_bf16 v[112:115], a[36:39], a[132:135], v[112:115]
buffer_load_dwordx4 v14, s[8:11], s25 offen offset:2048 lds
v_mfma_f32_16x16x32_bf16 v[116:119], a[40:43], a[128:131], v[116:119]
ds_read_b128 a[88:91], v2 offset:38912
v_mfma_f32_16x16x32_bf16 v[116:119], a[44:47], a[132:135], v[116:119]
v_mfma_f32_16x16x32_bf16 v[120:123], a[48:51], a[128:131], v[120:123]
ds_read_b128 a[92:95], v3 offset:38912
v_mfma_f32_16x16x32_bf16 v[120:123], a[52:55], a[132:135], v[120:123]
buffer_load_dwordx4 v15, s[8:11], s25 offen offset:3072 lds
v_mfma_f32_16x16x32_bf16 v[124:127], a[56:59], a[128:131], v[124:127]
s_add_u32 s25, s25, 128
v_mfma_f32_16x16x32_bf16 v[124:127], a[60:63], a[132:135], v[124:127]
s_waitcnt lgkmcnt(2)
v_mfma_f32_16x16x32_bf16 v[128:131], a[0:3], a[136:139], v[128:131]
ds_read_b64_tr_b16 a[128:129], v8 offset:0
v_mfma_f32_16x16x32_bf16 v[128:131], a[4:7], a[140:143], v[128:131]
buffer_store_dwordx4 a[176:179], v224, s[4:7], s56 offen sc1
v_mfma_f32_16x16x32_bf16 v[132:135], a[8:11], a[136:139], v[132:135]
s_add_u32 s56, s56, 33792
ds_read_b64_tr_b16 a[130:131], v8 offset:2048
v_mfma_f32_16x16x32_bf16 v[132:135], a[12:15], a[140:143], v[132:135]
v_mfma_f32_16x16x32_bf16 v[136:139], a[16:19], a[136:139], v[136:139]
ds_read_b64_tr_b16 a[132:133], v8 offset:16384
v_mfma_f32_16x16x32_bf16 v[136:139], a[20:23], a[140:143], v[136:139]
v_mfma_f32_16x16x32_bf16 v[140:143], a[24:27], a[136:139], v[140:143]
s_cmp_lt_u32 s21, 7
ds_read_b64_tr_b16 a[134:135], v8 offset:18432
v_mfma_f32_16x16x32_bf16 v[140:143], a[28:31], a[140:143], v[140:143]
s_cselect_b32 s53, s53, 3221225472
v_mfma_f32_16x16x32_bf16 v[144:147], a[32:35], a[136:139], v[144:147]
s_cselect_b32 s49, s49, 3221225472
ds_read_b128 a[96:99], v2 offset:40960
v_mfma_f32_16x16x32_bf16 v[144:147], a[36:39], a[140:143], v[144:147]
s_add_u32 s48, s53, 2097152
v_mfma_f32_16x16x32_bf16 v[148:151], a[40:43], a[136:139], v[148:151]
v_mfma_f32_16x16x32_bf16 v[148:151], a[44:47], a[140:143], v[148:151]
v_mfma_f32_16x16x32_bf16 v[152:155], a[48:51], a[136:139], v[152:155]
ds_read_b128 a[100:103], v3 offset:40960
v_mfma_f32_16x16x32_bf16 v[152:155], a[52:55], a[140:143], v[152:155]
v_mfma_f32_16x16x32_bf16 v[156:159], a[56:59], a[136:139], v[156:159]
ds_read_b128 a[104:107], v2 offset:43008
v_mfma_f32_16x16x32_bf16 v[156:159], a[60:63], a[140:143], v[156:159]
s_waitcnt lgkmcnt(2)
v_mfma_f32_16x16x32_bf16 v[160:163], a[0:3], a[128:131], v[160:163]
ds_read_b64_tr_b16 a[136:137], v9 offset:0
v_mfma_f32_16x16x32_bf16 v[160:163], a[4:7], a[132:135], v[160:163]
v_mfma_f32_16x16x32_bf16 v[164:167], a[8:11], a[128:131], v[164:167]
ds_read_b64_tr_b16 a[138:139], v9 offset:2048
v_mfma_f32_16x16x32_bf16 v[164:167], a[12:15], a[132:135], v[164:167]
buffer_store_dwordx4 a[180:183], v224, s[4:7], s56 offen sc1
v_mfma_f32_16x16x32_bf16 v[168:171], a[16:19], a[128:131], v[168:171]
s_add_u32 s56, s56, 33792
ds_read_b64_tr_b16 a[140:141], v9 offset:16384
v_mfma_f32_16x16x32_bf16 v[168:171], a[20:23], a[132:135], v[168:171]
v_mfma_f32_16x16x32_bf16 v[172:175], a[24:27], a[128:131], v[172:175]
ds_read_b64_tr_b16 a[142:143], v9 offset:18432
v_mfma_f32_16x16x32_bf16 v[172:175], a[28:31], a[132:135], v[172:175]
v_mfma_f32_16x16x32_bf16 v[176:179], a[32:35], a[128:131], v[176:179]
v_mfma_f32_16x16x32_bf16 v[176:179], a[36:39], a[132:135], v[176:179]
v_mfma_f32_16x16x32_bf16 v[180:183], a[40:43], a[128:131], v[180:183]
ds_read_b128 a[108:111], v3 offset:43008
v_mfma_f32_16x16x32_bf16 v[180:183], a[44:47], a[132:135], v[180:183]
v_mfma_f32_16x16x32_bf16 v[184:187], a[48:51], a[128:131], v[184:187]
ds_read_b128 a[112:115], v2 offset:45056
v_mfma_f32_16x16x32_bf16 v[184:187], a[52:55], a[132:135], v[184:187]
v_mfma_f32_16x16x32_bf16 v[188:191], a[56:59], a[128:131], v[188:191]
v_mfma_f32_16x16x32_bf16 v[188:191], a[60:63], a[132:135], v[188:191]
s_waitcnt lgkmcnt(2)
v_mfma_f32_16x16x32_bf16 v[192:195], a[0:3], a[136:139], v[192:195]
ds_read_b64_tr_b16 a[128:129], v10 offset:0
v_mfma_f32_16x16x32_bf16 v[192:195], a[4:7], a[140:143], v[192:195]
v_mfma_f32_16x16x32_bf16 v[196:199], a[8:11], a[136:139], v[196:199]
ds_read_b64_tr_b16 a[130:131], v10 offset:2048
v_mfma_f32_16x16x32_bf16 v[196:199], a[12:15], a[140:143], v[196:199]
v_mfma_f32_16x16x32_bf16 v[200:203], a[16:19], a[136:139], v[200:203]
ds_read_b64_tr_b16 a[132:133], v10 offset:16384
v_mfma_f32_16x16x32_bf16 v[200:203], a[20:23], a[140:143], v[200:203]
buffer_store_dwordx4 a[184:187], v224, s[4:7], s56 offen sc1
v_mfma_f32_16x16x32_bf16 v[204:207], a[24:27], a[136:139], v[204:207]
s_add_u32 s56, s56, 33792
ds_read_b64_tr_b16 a[134:135], v10 offset:18432
v_mfma_f32_16x16x32_bf16 v[204:207], a[28:31], a[140:143], v[204:207]
v_mfma_f32_16x16x32_bf16 v[208:211], a[32:35], a[136:139], v[208:211]
ds_read_b128 a[116:119], v3 offset:45056
v_mfma_f32_16x16x32_bf16 v[208:211], a[36:39], a[140:143], v[208:211]
v_mfma_f32_16x16x32_bf16 v[212:215], a[40:43], a[136:139], v[212:215]
ds_read_b128 a[120:123], v2 offset:47104
v_mfma_f32_16x16x32_bf16 v[212:215], a[44:47], a[140:143], v[212:215]
v_mfma_f32_16x16x32_bf16 v[216:219], a[48:51], a[136:139], v[216:219]
v_mfma_f32_16x16x32_bf16 v[216:219], a[52:55], a[140:143], v[216:219]
v_mfma_f32_16x16x32_bf16 v[220:223], a[56:59], a[136:139], v[220:223]
ds_read_b128 a[124:127], v3 offset:47104
v_mfma_f32_16x16x32_bf16 v[220:223], a[60:63], a[140:143], v[220:223]
s_waitcnt lgkmcnt(2)
v_mfma_f32_16x16x32_bf16 a[192:195], a[0:3], a[128:131], a[192:195]
ds_read_b64_tr_b16 a[136:137], v11 offset:0
v_mfma_f32_16x16x32_bf16 a[192:195], a[4:7], a[132:135], a[192:195]
v_mfma_f32_16x16x32_bf16 a[196:199], a[8:11], a[128:131], a[196:199]
ds_read_b64_tr_b16 a[138:139], v11 offset:2048
v_mfma_f32_16x16x32_bf16 a[196:199], a[12:15], a[132:135], a[196:199]
v_mfma_f32_16x16x32_bf16 a[200:203], a[16:19], a[128:131], a[200:203]
ds_read_b64_tr_b16 a[140:141], v11 offset:16384
v_mfma_f32_16x16x32_bf16 a[200:203], a[20:23], a[132:135], a[200:203]
v_mfma_f32_16x16x32_bf16 a[204:207], a[24:27], a[128:131], a[204:207]
ds_read_b64_tr_b16 a[142:143], v11 offset:18432
v_mfma_f32_16x16x32_bf16 a[204:207], a[28:31], a[132:135], a[204:207]
buffer_store_dwordx4 a[188:191], v224, s[4:7], s56 offen sc1
v_mfma_f32_16x16x32_bf16 a[208:211], a[32:35], a[128:131], a[208:211]
s_add_u32 s56, s56, 33792
v_mfma_f32_16x16x32_bf16 a[208:211], a[36:39], a[132:135], a[208:211]
v_mfma_f32_16x16x32_bf16 a[212:215], a[40:43], a[128:131], a[212:215]
v_mfma_f32_16x16x32_bf16 a[212:215], a[44:47], a[132:135], a[212:215]
v_mfma_f32_16x16x32_bf16 a[216:219], a[48:51], a[128:131], a[216:219]
v_mfma_f32_16x16x32_bf16 a[216:219], a[52:55], a[132:135], a[216:219]
v_mfma_f32_16x16x32_bf16 a[220:223], a[56:59], a[128:131], a[220:223]
v_mfma_f32_16x16x32_bf16 a[220:223], a[60:63], a[132:135], a[220:223]
s_waitcnt vmcnt(4) lgkmcnt(0)
s_barrier
v_mfma_f32_16x16x32_bf16 a[224:227], a[0:3], a[136:139], a[224:227]
s_add_u32 m0, s29, 65536
ds_read_b64_tr_b16 a[128:129], v4 offset:32768
v_mfma_f32_16x16x32_bf16 a[224:227], a[4:7], a[140:143], a[224:227]
buffer_load_dwordx4 v16, s[12:15], s26 offen offset:0 lds
v_mfma_f32_16x16x32_bf16 a[228:231], a[8:11], a[136:139], a[228:231]
ds_read_b64_tr_b16 a[130:131], v4 offset:34816
v_cmp_gt_u32 vcc, 0x100, v245
v_mfma_f32_16x16x32_bf16 a[228:231], a[12:15], a[140:143], a[228:231]
v_mfma_f32_16x16x32_bf16 a[232:235], a[16:19], a[136:139], a[232:235]
ds_read_b64_tr_b16 a[132:133], v4 offset:49152
v_mfma_f32_16x16x32_bf16 a[232:235], a[20:23], a[140:143], a[232:235]
buffer_load_dwordx4 v17, s[12:15], s26 offen offset:1024 lds
v_mfma_f32_16x16x32_bf16 a[236:239], a[24:27], a[136:139], a[236:239]
ds_read_b64_tr_b16 a[134:135], v4 offset:51200
v_mfma_f32_16x16x32_bf16 a[236:239], a[28:31], a[140:143], a[236:239]
v_mfma_f32_16x16x32_bf16 a[240:243], a[32:35], a[136:139], a[240:243]
v_mfma_f32_16x16x32_bf16 a[240:243], a[36:39], a[140:143], a[240:243]
buffer_load_dwordx4 v18, s[12:15], s26 offen offset:2048 lds
v_mfma_f32_16x16x32_bf16 a[244:247], a[40:43], a[136:139], a[244:247]
v_mfma_f32_16x16x32_bf16 a[244:247], a[44:47], a[140:143], a[244:247]
v_mfma_f32_16x16x32_bf16 a[248:251], a[48:51], a[136:139], a[248:251]
v_mfma_f32_16x16x32_bf16 a[248:251], a[52:55], a[140:143], a[248:251]
buffer_load_dwordx4 v19, s[12:15], s26 offen offset:3072 lds
v_mfma_f32_16x16x32_bf16 a[252:255], a[56:59], a[136:139], a[252:255]
s_add_u32 s26, s26, 524288
v_mfma_f32_16x16x32_bf16 a[252:255], a[60:63], a[140:143], a[252:255]
s_waitcnt lgkmcnt(0)
s_mov_b32 s82, s59
s_cbranch_vccnz M_cntspinV
s_branch Lg_501
PAD_21:
s_cbranch_execz PAD_25
Lg_501t:
buffer_load_dword v230, v231, s[4:7], s52 offen sc1
v_mfma_f32_16x16x32_bf16 v[32:35], a[64:67], a[128:131], v[32:35]
s_add_u32 m0, s29, 81920
ds_read_b64_tr_b16 a[136:137], v5 offset:32768
v_mfma_f32_16x16x32_bf16 v[32:35], a[68:71], a[132:135], v[32:35]
buffer_load_dwordx4 v16, s[12:15], s27 offen offset:0 lds
v_mfma_f32_16x16x32_bf16 v[36:39], a[72:75], a[128:131], v[36:39]
s_and_b32 s44, s3, 1
ds_read_b64_tr_b16 a[138:139], v5 offset:34816
v_mfma_f32_16x16x32_bf16 v[36:39], a[76:79], a[132:135], v[36:39]
s_lshl_b32 s44, s44, 8
v_mfma_f32_16x16x32_bf16 v[40:43], a[80:83], a[128:131], v[40:43]
s_lshl_b32 s45, s3, 7
ds_read_b64_tr_b16 a[140:141], v5 offset:49152
v_mfma_f32_16x16x32_bf16 v[40:43], a[84:87], a[132:135], v[40:43]
s_xor_b32 s44, s44, s45
buffer_load_dwordx4 v17, s[12:15], s27 offen offset:1024 lds
v_mfma_f32_16x16x32_bf16 v[44:47], a[88:91], a[128:131], v[44:47]
s_xor_b32 s44, s44, 196608
ds_read_b64_tr_b16 a[142:143], v5 offset:51200
v_mfma_f32_16x16x32_bf16 v[44:47], a[92:95], a[132:135], v[44:47]
v_mfma_f32_16x16x32_bf16 v[48:51], a[96:99], a[128:131], v[48:51]
ds_read_b128 a[0:3], v2 offset:0
v_mfma_f32_16x16x32_bf16 v[48:51], a[100:103], a[132:135], v[48:51]
buffer_load_dwordx4 v18, s[12:15], s27 offen offset:2048 lds
v_mfma_f32_16x16x32_bf16 v[52:55], a[104:107], a[128:131], v[52:55]
ds_read_b128 a[4:7], v3 offset:0
v_mfma_f32_16x16x32_bf16 v[52:55], a[108:111], a[132:135], v[52:55]
v_mfma_f32_16x16x32_bf16 v[56:59], a[112:115], a[128:131], v[56:59]
v_mfma_f32_16x16x32_bf16 v[56:59], a[116:119], a[132:135], v[56:59]
buffer_load_dwordx4 v19, s[12:15], s27 offen offset:3072 lds
v_mfma_f32_16x16x32_bf16 v[60:63], a[120:123], a[128:131], v[60:63]
s_add_u32 s27, s27, 524288
ds_read_b128 a[8:11], v2 offset:2048
v_mfma_f32_16x16x32_bf16 v[60:63], a[124:127], a[132:135], v[60:63]
s_waitcnt lgkmcnt(2)
v_mfma_f32_16x16x32_bf16 v[64:67], a[64:67], a[136:139], v[64:67]
s_add_u32 m0, s28, 32768
ds_read_b64_tr_b16 a[128:129], v6 offset:32768
v_mfma_f32_16x16x32_bf16 v[64:67], a[68:71], a[140:143], v[64:67]
buffer_load_dwordx4 v12, s[8:11], s24 offen offset:0 lds
v_mfma_f32_16x16x32_bf16 v[68:71], a[72:75], a[136:139], v[68:71]
ds_read_b64_tr_b16 a[130:131], v6 offset:34816
v_mfma_f32_16x16x32_bf16 v[68:71], a[76:79], a[140:143], v[68:71]
v_mfma_f32_16x16x32_bf16 v[72:75], a[80:83], a[136:139], v[72:75]
s_mov_b64 s[56:57], s[72:73]
ds_read_b64_tr_b16 a[132:133], v6 offset:49152
v_mfma_f32_16x16x32_bf16 v[72:75], a[84:87], a[140:143], v[72:75]
s_mov_b32 s58, 1835008
buffer_load_dwordx4 v13, s[8:11], s24 offen offset:1024 lds
v_mfma_f32_16x16x32_bf16 v[76:79], a[88:91], a[136:139], v[76:79]
s_mov_b32 s59, 0x20000
ds_read_b64_tr_b16 a[134:135], v6 offset:51200
v_mfma_f32_16x16x32_bf16 v[76:79], a[92:95], a[140:143], v[76:79]
v_mfma_f32_16x16x32_bf16 v[80:83], a[96:99], a[136:139], v[80:83]
ds_read_b128 a[12:15], v3 offset:2048
v_mfma_f32_16x16x32_bf16 v[80:83], a[100:103], a[140:143], v[80:83]
buffer_load_dwordx4 v14, s[8:11], s24 offen offset:2048 lds
v_mfma_f32_16x16x32_bf16 v[84:87], a[104:107], a[136:139], v[84:87]
v_mfma_f32_16x16x32_bf16 v[84:87], a[108:111], a[140:143], v[84:87]
v_mfma_f32_16x16x32_bf16 v[88:91], a[112:115], a[136:139], v[88:91]
ds_read_b128 a[16:19], v2 offset:4096
v_mfma_f32_16x16x32_bf16 v[88:91], a[116:119], a[140:143], v[88:91]
buffer_load_dwordx4 v15, s[8:11], s24 offen offset:3072 lds
v_mfma_f32_16x16x32_bf16 v[92:95], a[120:123], a[136:139], v[92:95]
s_add_u32 s24, s24, 128
ds_read_b128 a[20:23], v3 offset:4096
v_mfma_f32_16x16x32_bf16 v[92:95], a[124:127], a[140:143], v[92:95]
PAD_22:
s_cbranch_execz PAD_26
s_waitcnt lgkmcnt(2)
v_mfma_f32_16x16x32_bf16 v[96:99], a[64:67], a[128:131], v[96:99]
s_add_u32 m0, s28, 36864
ds_read_b64_tr_b16 a[136:137], v7 offset:32768
v_mfma_f32_16x16x32_bf16 v[96:99], a[68:71], a[132:135], v[96:99]
buffer_load_dwordx4 v12, s[8:11], s25 offen offset:0 lds
v_mfma_f32_16x16x32_bf16 v[100:103], a[72:75], a[128:131], v[100:103]
ds_read_b64_tr_b16 a[138:139], v7 offset:34816
v_mfma_f32_16x16x32_bf16 v[100:103], a[76:79], a[132:135], v[100:103]
v_mfma_f32_16x16x32_bf16 v[104:107], a[80:83], a[128:131], v[104:107]
ds_read_b64_tr_b16 a[140:141], v7 offset:49152
v_mfma_f32_16x16x32_bf16 v[104:107], a[84:87], a[132:135], v[104:107]
buffer_load_dwordx4 v13, s[8:11], s25 offen offset:1024 lds
v_mfma_f32_16x16x32_bf16 v[108:111], a[88:91], a[128:131], v[108:111]
ds_read_b64_tr_b16 a[142:143], v7 offset:51200
v_mfma_f32_16x16x32_bf16 v[108:111], a[92:95], a[132:135], v[108:111]
v_mfma_f32_16x16x32_bf16 v[112:115], a[96:99], a[128:131], v[112:115]
v_mfma_f32_16x16x32_bf16 v[112:115], a[100:103], a[132:135], v[112:115]
buffer_load_dwordx4 v14, s[8:11], s25 offen offset:2048 lds
v_mfma_f32_16x16x32_bf16 v[116:119], a[104:107], a[128:131], v[116:119]
ds_read_b128 a[24:27], v2 offset:6144
v_mfma_f32_16x16x32_bf16 v[116:119], a[108:111], a[132:135], v[116:119]
v_mfma_f32_16x16x32_bf16 v[120:123], a[112:115], a[128:131], v[120:123]
ds_read_b128 a[28:31], v3 offset:6144
v_mfma_f32_16x16x32_bf16 v[120:123], a[116:119], a[132:135], v[120:123]
buffer_load_dwordx4 v15, s[8:11], s25 offen offset:3072 lds
v_mfma_f32_16x16x32_bf16 v[124:127], a[120:123], a[128:131], v[124:127]
s_add_u32 s25, s25, 128
s_waitcnt vmcnt(12)
v_mfma_f32_16x16x32_bf16 v[124:127], a[124:127], a[132:135], v[124:127]
s_waitcnt lgkmcnt(2)
v_cmp_gt_u32 vcc, 1, v230
v_mfma_f32_16x16x32_bf16 v[128:131], a[64:67], a[136:139], v[128:131]
s_cbranch_vccnz M_ppspinV
M_ppokV:
ds_read_b64_tr_b16 a[128:129], v8 offset:32768
v_mfma_f32_16x16x32_bf16 v[128:131], a[68:71], a[140:143], v[128:131]
buffer_load_dword v230, v229, s[4:7], s53 offen sc1
v_mfma_f32_16x16x32_bf16 v[132:135], a[72:75], a[136:139], v[132:135]
s_mov_b64 s[8:9], s[76:77]
ds_read_b64_tr_b16 a[130:131], v8 offset:34816
v_mfma_f32_16x16x32_bf16 v[132:135], a[76:79], a[140:143], v[132:135]
s_mov_b32 s10, 1835008
buffer_load_dword v230, v229, s[4:7], s48 offen sc1
v_mfma_f32_16x16x32_bf16 v[136:139], a[80:83], a[136:139], v[136:139]
s_lshl_b32 s24, s37, 2
ds_read_b64_tr_b16 a[132:133], v8 offset:49152
v_mfma_f32_16x16x32_bf16 v[136:139], a[84:87], a[140:143], v[136:139]
s_add_u32 s24, s24, s3
buffer_load_dword v230, v229, s[56:59], s49 offen
v_mfma_f32_16x16x32_bf16 v[140:143], a[88:91], a[136:139], v[140:143]
s_mul_i32 s24, s24, 28672
ds_read_b64_tr_b16 a[134:135], v8 offset:51200
v_mfma_f32_16x16x32_bf16 v[140:143], a[92:95], a[140:143], v[140:143]
s_mov_b32 s28, s29
buffer_load_dword v21, v20, s[16:19], s43 offen
v_mfma_f32_16x16x32_bf16 v[144:147], a[96:99], a[136:139], v[144:147]
ds_read_b128 a[32:35], v2 offset:8192
v_mfma_f32_16x16x32_bf16 v[144:147], a[100:103], a[140:143], v[144:147]
v_mfma_f32_16x16x32_bf16 v[148:151], a[104:107], a[136:139], v[148:151]
v_mfma_f32_16x16x32_bf16 v[148:151], a[108:111], a[140:143], v[148:151]
v_mfma_f32_16x16x32_bf16 v[152:155], a[112:115], a[136:139], v[152:155]
ds_read_b128 a[36:39], v3 offset:8192
v_lshrrev_b32 v28, 7, v1
v_mfma_f32_16x16x32_bf16 v[152:155], a[116:119], a[140:143], v[152:155]
v_lshrrev_b32 v29, 1, v28
v_lshlrev_b32 v29, 4, v29
v_mfma_f32_16x16x32_bf16 v[156:159], a[120:123], a[136:139], v[156:159]
ds_read_b128 a[40:43], v2 offset:10240
v_and_b32 v30, 0x70, v1
v_mfma_f32_16x16x32_bf16 v[156:159], a[124:127], a[140:143], v[156:159]
s_waitcnt lgkmcnt(2)
v_xor_b32 v29, v29, v30
v_mul_u32_u24 v28, 896, v28
v_mfma_f32_16x16x32_bf16 v[160:163], a[64:67], a[128:131], v[160:163]
ds_read_b64_tr_b16 a[136:137], v9 offset:32768
v_add_u32 v12, v28, v29
v_mfma_f32_16x16x32_bf16 v[160:163], a[68:71], a[132:135], v[160:163]
v_xor_b32 v29, 64, v29
v_add_u32 v28, v28, v29
v_mfma_f32_16x16x32_bf16 v[164:167], a[72:75], a[128:131], v[164:167]
ds_read_b64_tr_b16 a[138:139], v9 offset:34816
v_add_u32 v13, 6144, v28
v_mfma_f32_16x16x32_bf16 v[164:167], a[76:79], a[132:135], v[164:167]
v_add_u32 v14, 12288, v12
v_add_u32 v15, 18432, v28
v_mfma_f32_16x16x32_bf16 v[168:171], a[80:83], a[128:131], v[168:171]
ds_read_b64_tr_b16 a[140:141], v9 offset:49152
v_xor_b32 v22, s44, v4
v_mfma_f32_16x16x32_bf16 v[168:171], a[84:87], a[132:135], v[168:171]
v_xor_b32 v23, 32, v22
v_xor_b32 v24, 64, v22
v_mfma_f32_16x16x32_bf16 v[172:175], a[88:91], a[128:131], v[172:175]
ds_read_b64_tr_b16 a[142:143], v9 offset:51200
v_xor_b32 v25, 96, v22
v_mfma_f32_16x16x32_bf16 v[172:175], a[92:95], a[132:135], v[172:175]
v_mfma_f32_16x16x32_bf16 v[176:179], a[96:99], a[128:131], v[176:179]
v_mfma_f32_16x16x32_bf16 v[176:179], a[100:103], a[132:135], v[176:179]
v_mfma_f32_16x16x32_bf16 v[180:183], a[104:107], a[128:131], v[180:183]
ds_read_b128 a[44:47], v3 offset:10240
v_mfma_f32_16x16x32_bf16 v[180:183], a[108:111], a[132:135], v[180:183]
v_mfma_f32_16x16x32_bf16 v[184:187], a[112:115], a[128:131], v[184:187]
ds_read_b128 a[48:51], v2 offset:12288
v_mfma_f32_16x16x32_bf16 v[184:187], a[116:119], a[132:135], v[184:187]
v_mfma_f32_16x16x32_bf16 v[188:191], a[120:123], a[128:131], v[188:191]
v_mfma_f32_16x16x32_bf16 v[188:191], a[124:127], a[132:135], v[188:191]
s_waitcnt lgkmcnt(2)
v_mfma_f32_16x16x32_bf16 v[192:195], a[64:67], a[136:139], v[192:195]
ds_read_b64_tr_b16 a[128:129], v10 offset:32768
v_mfma_f32_16x16x32_bf16 v[192:195], a[68:71], a[140:143], v[192:195]
v_mfma_f32_16x16x32_bf16 v[196:199], a[72:75], a[136:139], v[196:199]
ds_read_b64_tr_b16 a[130:131], v10 offset:34816
v_mfma_f32_16x16x32_bf16 v[196:199], a[76:79], a[140:143], v[196:199]
v_mfma_f32_16x16x32_bf16 v[200:203], a[80:83], a[136:139], v[200:203]
ds_read_b64_tr_b16 a[132:133], v10 offset:49152
v_mfma_f32_16x16x32_bf16 v[200:203], a[84:87], a[140:143], v[200:203]
v_mfma_f32_16x16x32_bf16 v[204:207], a[88:91], a[136:139], v[204:207]
ds_read_b64_tr_b16 a[134:135], v10 offset:51200
v_mfma_f32_16x16x32_bf16 v[204:207], a[92:95], a[140:143], v[204:207]
v_mfma_f32_16x16x32_bf16 v[208:211], a[96:99], a[136:139], v[208:211]
ds_read_b128 a[52:55], v3 offset:12288
v_mfma_f32_16x16x32_bf16 v[208:211], a[100:103], a[140:143], v[208:211]
v_mfma_f32_16x16x32_bf16 v[212:215], a[104:107], a[136:139], v[212:215]
ds_read_b128 a[56:59], v2 offset:14336
v_mfma_f32_16x16x32_bf16 v[212:215], a[108:111], a[140:143], v[212:215]
v_mfma_f32_16x16x32_bf16 v[216:219], a[112:115], a[136:139], v[216:219]
v_mfma_f32_16x16x32_bf16 v[216:219], a[116:119], a[140:143], v[216:219]
v_mfma_f32_16x16x32_bf16 v[220:223], a[120:123], a[136:139], v[220:223]
ds_read_b128 a[60:63], v3 offset:14336
v_mfma_f32_16x16x32_bf16 v[220:223], a[124:127], a[140:143], v[220:223]
s_waitcnt lgkmcnt(2)
v_mfma_f32_16x16x32_bf16 a[192:195], a[64:67], a[128:131], a[192:195]
ds_read_b64_tr_b16 a[136:137], v11 offset:32768
v_mfma_f32_16x16x32_bf16 a[192:195], a[68:71], a[132:135], a[192:195]
v_mfma_f32_16x16x32_bf16 a[196:199], a[72:75], a[128:131], a[196:199]
ds_read_b64_tr_b16 a[138:139], v11 offset:34816
v_mfma_f32_16x16x32_bf16 a[196:199], a[76:79], a[132:135], a[196:199]
v_mfma_f32_16x16x32_bf16 a[200:203], a[80:83], a[128:131], a[200:203]
ds_read_b64_tr_b16 a[140:141], v11 offset:49152
v_mfma_f32_16x16x32_bf16 a[200:203], a[84:87], a[132:135], a[200:203]
v_mfma_f32_16x16x32_bf16 a[204:207], a[88:91], a[128:131], a[204:207]
ds_read_b64_tr_b16 a[142:143], v11 offset:51200
v_mfma_f32_16x16x32_bf16 a[204:207], a[92:95], a[132:135], a[204:207]
v_mfma_f32_16x16x32_bf16 a[208:211], a[96:99], a[128:131], a[208:211]
v_mfma_f32_16x16x32_bf16 a[208:211], a[100:103], a[132:135], a[208:211]
v_mfma_f32_16x16x32_bf16 a[212:215], a[104:107], a[128:131], a[212:215]
v_mfma_f32_16x16x32_bf16 a[212:215], a[108:111], a[132:135], a[212:215]
v_mfma_f32_16x16x32_bf16 a[216:219], a[112:115], a[128:131], a[216:219]
v_mfma_f32_16x16x32_bf16 a[216:219], a[116:119], a[132:135], a[216:219]
v_mfma_f32_16x16x32_bf16 a[220:223], a[120:123], a[128:131], a[220:223]
v_mfma_f32_16x16x32_bf16 a[220:223], a[124:127], a[132:135], a[220:223]
s_waitcnt vmcnt(4) lgkmcnt(0)
s_barrier
v_mfma_f32_16x16x32_bf16 a[224:227], a[64:67], a[136:139], a[224:227]
s_add_u32 m0, s29, 98304
ds_read_b64_tr_b16 a[128:129], v4 offset:0
v_mfma_f32_16x16x32_bf16 a[224:227], a[68:71], a[140:143], a[224:227]
buffer_load_dwordx4 v16, s[12:15], s26 offen offset:0 lds
v_mfma_f32_16x16x32_bf16 a[228:231], a[72:75], a[136:139], a[228:231]
ds_read_b64_tr_b16 a[130:131], v4 offset:2048
v_mfma_f32_16x16x32_bf16 a[228:231], a[76:79], a[140:143], a[228:231]
v_mfma_f32_16x16x32_bf16 a[232:235], a[80:83], a[136:139], a[232:235]
ds_read_b64_tr_b16 a[132:133], v4 offset:16384
v_mfma_f32_16x16x32_bf16 a[232:235], a[84:87], a[140:143], a[232:235]
buffer_load_dwordx4 v17, s[12:15], s26 offen offset:1024 lds
v_mfma_f32_16x16x32_bf16 a[236:239], a[88:91], a[136:139], a[236:239]
ds_read_b64_tr_b16 a[134:135], v4 offset:18432
v_mfma_f32_16x16x32_bf16 a[236:239], a[92:95], a[140:143], a[236:239]
v_mfma_f32_16x16x32_bf16 a[240:243], a[96:99], a[136:139], a[240:243]
v_mfma_f32_16x16x32_bf16 a[240:243], a[100:103], a[140:143], a[240:243]
buffer_load_dwordx4 v18, s[12:15], s26 offen offset:2048 lds
v_mfma_f32_16x16x32_bf16 a[244:247], a[104:107], a[136:139], a[244:247]
v_mfma_f32_16x16x32_bf16 a[244:247], a[108:111], a[140:143], a[244:247]
v_mfma_f32_16x16x32_bf16 a[248:251], a[112:115], a[136:139], a[248:251]
v_mfma_f32_16x16x32_bf16 a[248:251], a[116:119], a[140:143], a[248:251]
buffer_load_dwordx4 v19, s[12:15], s26 offen offset:3072 lds
v_mfma_f32_16x16x32_bf16 a[252:255], a[120:123], a[136:139], a[252:255]
s_add_u32 s26, s26, 524288
v_mfma_f32_16x16x32_bf16 a[252:255], a[124:127], a[140:143], a[252:255]
s_waitcnt lgkmcnt(0)
v_mfma_f32_16x16x32_bf16 v[32:35], a[0:3], a[128:131], v[32:35]
s_add_u32 m0, s29, 114688
ds_read_b64_tr_b16 a[136:137], v5 offset:0
v_mfma_f32_16x16x32_bf16 v[32:35], a[4:7], a[132:135], v[32:35]
buffer_load_dwordx4 v16, s[12:15], s27 offen offset:0 lds
v_mfma_f32_16x16x32_bf16 v[36:39], a[8:11], a[128:131], v[36:39]
ds_read_b64_tr_b16 a[138:139], v5 offset:2048
v_mfma_f32_16x16x32_bf16 v[36:39], a[12:15], a[132:135], v[36:39]
v_mfma_f32_16x16x32_bf16 v[40:43], a[16:19], a[128:131], v[40:43]
ds_read_b64_tr_b16 a[140:141], v5 offset:16384
v_mfma_f32_16x16x32_bf16 v[40:43], a[20:23], a[132:135], v[40:43]
buffer_load_dwordx4 v17, s[12:15], s27 offen offset:1024 lds
v_mfma_f32_16x16x32_bf16 v[44:47], a[24:27], a[128:131], v[44:47]
ds_read_b64_tr_b16 a[142:143], v5 offset:18432
v_mfma_f32_16x16x32_bf16 v[44:47], a[28:31], a[132:135], v[44:47]
v_mfma_f32_16x16x32_bf16 v[48:51], a[32:35], a[128:131], v[48:51]
ds_read_b128 a[64:67], v2 offset:32768
v_mfma_f32_16x16x32_bf16 v[48:51], a[36:39], a[132:135], v[48:51]
buffer_load_dwordx4 v18, s[12:15], s27 offen offset:2048 lds
v_mfma_f32_16x16x32_bf16 v[52:55], a[40:43], a[128:131], v[52:55]
ds_read_b128 a[68:71], v3 offset:32768
v_mfma_f32_16x16x32_bf16 v[52:55], a[44:47], a[132:135], v[52:55]
v_mfma_f32_16x16x32_bf16 v[56:59], a[48:51], a[128:131], v[56:59]
v_mfma_f32_16x16x32_bf16 v[56:59], a[52:55], a[132:135], v[56:59]
buffer_load_dwordx4 v19, s[12:15], s27 offen offset:3072 lds
v_mfma_f32_16x16x32_bf16 v[60:63], a[56:59], a[128:131], v[60:63]
s_add_u32 s27, s27, 524288
ds_read_b128 a[72:75], v2 offset:34816
v_mfma_f32_16x16x32_bf16 v[60:63], a[60:63], a[132:135], v[60:63]
s_waitcnt lgkmcnt(2)
v_mfma_f32_16x16x32_bf16 v[64:67], a[0:3], a[136:139], v[64:67]
s_add_u32 m0, s28, 0
ds_read_b64_tr_b16 a[128:129], v6 offset:0
v_mfma_f32_16x16x32_bf16 v[64:67], a[4:7], a[140:143], v[64:67]
buffer_load_dwordx4 v12, s[8:11], s24 offen offset:0 lds
v_mfma_f32_16x16x32_bf16 v[68:71], a[8:11], a[136:139], v[68:71]
ds_read_b64_tr_b16 a[130:131], v6 offset:2048
v_mfma_f32_16x16x32_bf16 v[68:71], a[12:15], a[140:143], v[68:71]
v_mfma_f32_16x16x32_bf16 v[72:75], a[16:19], a[136:139], v[72:75]
ds_read_b64_tr_b16 a[132:133], v6 offset:16384
v_mfma_f32_16x16x32_bf16 v[72:75], a[20:23], a[140:143], v[72:75]
buffer_load_dwordx4 v13, s[8:11], s24 offen offset:1024 lds
v_mfma_f32_16x16x32_bf16 v[76:79], a[24:27], a[136:139], v[76:79]
ds_read_b64_tr_b16 a[134:135], v6 offset:18432
v_mfma_f32_16x16x32_bf16 v[76:79], a[28:31], a[140:143], v[76:79]
v_mfma_f32_16x16x32_bf16 v[80:83], a[32:35], a[136:139], v[80:83]
ds_read_b128 a[76:79], v3 offset:34816
v_mfma_f32_16x16x32_bf16 v[80:83], a[36:39], a[140:143], v[80:83]
buffer_load_dwordx4 v14, s[8:11], s24 offen offset:2048 lds
v_mfma_f32_16x16x32_bf16 v[84:87], a[40:43], a[136:139], v[84:87]
v_mfma_f32_16x16x32_bf16 v[84:87], a[44:47], a[140:143], v[84:87]
v_mfma_f32_16x16x32_bf16 v[88:91], a[48:51], a[136:139], v[88:91]
ds_read_b128 a[80:83], v2 offset:36864
v_mfma_f32_16x16x32_bf16 v[88:91], a[52:55], a[140:143], v[88:91]
buffer_load_dwordx4 v15, s[8:11], s24 offen offset:3072 lds
v_mfma_f32_16x16x32_bf16 v[92:95], a[56:59], a[136:139], v[92:95]
s_add_u32 s24, s24, 128
ds_read_b128 a[84:87], v3 offset:36864
v_mfma_f32_16x16x32_bf16 v[92:95], a[60:63], a[140:143], v[92:95]
s_waitcnt lgkmcnt(2)
s_mov_b64 s[12:13], s[80:81]
v_mfma_f32_16x16x32_bf16 v[96:99], a[0:3], a[128:131], v[96:99]
s_mov_b32 s14, 3670016
s_add_u32 m0, s28, 16384
ds_read_b64_tr_b16 a[136:137], v7 offset:0
v_mfma_f32_16x16x32_bf16 v[96:99], a[4:7], a[132:135], v[96:99]
buffer_load_dwordx4 v12, s[8:11], s24 offen offset:0 lds
v_mfma_f32_16x16x32_bf16 v[100:103], a[8:11], a[128:131], v[100:103]
ds_read_b64_tr_b16 a[138:139], v7 offset:2048
v_mfma_f32_16x16x32_bf16 v[100:103], a[12:15], a[132:135], v[100:103]
v_mfma_f32_16x16x32_bf16 v[104:107], a[16:19], a[128:131], v[104:107]
ds_read_b64_tr_b16 a[140:141], v7 offset:16384
v_mfma_f32_16x16x32_bf16 v[104:107], a[20:23], a[132:135], v[104:107]
buffer_load_dwordx4 v13, s[8:11], s24 offen offset:1024 lds
v_mfma_f32_16x16x32_bf16 v[108:111], a[24:27], a[128:131], v[108:111]
ds_read_b64_tr_b16 a[142:143], v7 offset:18432
v_mfma_f32_16x16x32_bf16 v[108:111], a[28:31], a[132:135], v[108:111]
v_mfma_f32_16x16x32_bf16 v[112:115], a[32:35], a[128:131], v[112:115]
v_mfma_f32_16x16x32_bf16 v[112:115], a[36:39], a[132:135], v[112:115]
buffer_load_dwordx4 v14, s[8:11], s24 offen offset:2048 lds
v_mfma_f32_16x16x32_bf16 v[116:119], a[40:43], a[128:131], v[116:119]
ds_read_b128 a[88:91], v2 offset:38912
v_mfma_f32_16x16x32_bf16 v[116:119], a[44:47], a[132:135], v[116:119]
v_mfma_f32_16x16x32_bf16 v[120:123], a[48:51], a[128:131], v[120:123]
ds_read_b128 a[92:95], v3 offset:38912
v_mfma_f32_16x16x32_bf16 v[120:123], a[52:55], a[132:135], v[120:123]
buffer_load_dwordx4 v15, s[8:11], s24 offen offset:3072 lds
v_mfma_f32_16x16x32_bf16 v[124:127], a[56:59], a[128:131], v[124:127]
s_add_u32 s24, s24, 128
v_mfma_f32_16x16x32_bf16 v[124:127], a[60:63], a[132:135], v[124:127]
s_waitcnt lgkmcnt(2)
s_sub_u32 s26, s26, 8388608
v_mfma_f32_16x16x32_bf16 v[128:131], a[0:3], a[136:139], v[128:131]
s_sub_u32 s27, s27, 8388608
s_add_u32 m0, s29, 131072
ds_read_b64_tr_b16 a[128:129], v8 offset:0
v_mfma_f32_16x16x32_bf16 v[128:131], a[4:7], a[140:143], v[128:131]
buffer_load_dwordx4 v16, s[12:15], s26 offen offset:0 lds
v_mfma_f32_16x16x32_bf16 v[132:135], a[8:11], a[136:139], v[132:135]
ds_read_b64_tr_b16 a[130:131], v8 offset:2048
v_mfma_f32_16x16x32_bf16 v[132:135], a[12:15], a[140:143], v[132:135]
v_mfma_f32_16x16x32_bf16 v[136:139], a[16:19], a[136:139], v[136:139]
ds_read_b64_tr_b16 a[132:133], v8 offset:16384
v_mfma_f32_16x16x32_bf16 v[136:139], a[20:23], a[140:143], v[136:139]
buffer_load_dwordx4 v17, s[12:15], s26 offen offset:1024 lds
v_mfma_f32_16x16x32_bf16 v[140:143], a[24:27], a[136:139], v[140:143]
ds_read_b64_tr_b16 a[134:135], v8 offset:18432
v_mfma_f32_16x16x32_bf16 v[140:143], a[28:31], a[140:143], v[140:143]
v_mfma_f32_16x16x32_bf16 v[144:147], a[32:35], a[136:139], v[144:147]
ds_read_b128 a[96:99], v2 offset:40960
v_mfma_f32_16x16x32_bf16 v[144:147], a[36:39], a[140:143], v[144:147]
buffer_load_dwordx4 v18, s[12:15], s26 offen offset:2048 lds
v_mfma_f32_16x16x32_bf16 v[148:151], a[40:43], a[136:139], v[148:151]
v_mfma_f32_16x16x32_bf16 v[148:151], a[44:47], a[140:143], v[148:151]
v_mfma_f32_16x16x32_bf16 v[152:155], a[48:51], a[136:139], v[152:155]
ds_read_b128 a[100:103], v3 offset:40960
v_mfma_f32_16x16x32_bf16 v[152:155], a[52:55], a[140:143], v[152:155]
buffer_load_dwordx4 v19, s[12:15], s26 offen offset:3072 lds
v_mfma_f32_16x16x32_bf16 v[156:159], a[56:59], a[136:139], v[156:159]
s_add_u32 s26, s26, 524288
ds_read_b128 a[104:107], v2 offset:43008
v_mfma_f32_16x16x32_bf16 v[156:159], a[60:63], a[140:143], v[156:159]
s_waitcnt lgkmcnt(2)
v_mfma_f32_16x16x32_bf16 v[160:163], a[0:3], a[128:131], v[160:163]
s_add_u32 m0, s29, 147456
ds_read_b64_tr_b16 a[136:137], v9 offset:0
v_mfma_f32_16x16x32_bf16 v[160:163], a[4:7], a[132:135], v[160:163]
buffer_load_dwordx4 v16, s[12:15], s27 offen offset:0 lds
v_mfma_f32_16x16x32_bf16 v[164:167], a[8:11], a[128:131], v[164:167]
ds_read_b64_tr_b16 a[138:139], v9 offset:2048
v_mfma_f32_16x16x32_bf16 v[164:167], a[12:15], a[132:135], v[164:167]
v_mfma_f32_16x16x32_bf16 v[168:171], a[16:19], a[128:131], v[168:171]
ds_read_b64_tr_b16 a[140:141], v9 offset:16384
v_mfma_f32_16x16x32_bf16 v[168:171], a[20:23], a[132:135], v[168:171]
buffer_load_dwordx4 v17, s[12:15], s27 offen offset:1024 lds
v_mfma_f32_16x16x32_bf16 v[172:175], a[24:27], a[128:131], v[172:175]
ds_read_b64_tr_b16 a[142:143], v9 offset:18432
v_mfma_f32_16x16x32_bf16 v[172:175], a[28:31], a[132:135], v[172:175]
v_mfma_f32_16x16x32_bf16 v[176:179], a[32:35], a[128:131], v[176:179]
v_mfma_f32_16x16x32_bf16 v[176:179], a[36:39], a[132:135], v[176:179]
buffer_load_dwordx4 v18, s[12:15], s27 offen offset:2048 lds
v_mfma_f32_16x16x32_bf16 v[180:183], a[40:43], a[128:131], v[180:183]
ds_read_b128 a[108:111], v3 offset:43008
v_mfma_f32_16x16x32_bf16 v[180:183], a[44:47], a[132:135], v[180:183]
v_mfma_f32_16x16x32_bf16 v[184:187], a[48:51], a[128:131], v[184:187]
ds_read_b128 a[112:115], v2 offset:45056
v_mfma_f32_16x16x32_bf16 v[184:187], a[52:55], a[132:135], v[184:187]
buffer_load_dwordx4 v19, s[12:15], s27 offen offset:3072 lds
v_mfma_f32_16x16x32_bf16 v[188:191], a[56:59], a[128:131], v[188:191]
s_add_u32 s27, s27, 524288
v_mfma_f32_16x16x32_bf16 v[188:191], a[60:63], a[132:135], v[188:191]
s_waitcnt lgkmcnt(2)
v_mfma_f32_16x16x32_bf16 v[192:195], a[0:3], a[136:139], v[192:195]
ds_read_b64_tr_b16 a[128:129], v10 offset:0
v_mfma_f32_16x16x32_bf16 v[192:195], a[4:7], a[140:143], v[192:195]
v_mfma_f32_16x16x32_bf16 v[196:199], a[8:11], a[136:139], v[196:199]
ds_read_b64_tr_b16 a[130:131], v10 offset:2048
v_mfma_f32_16x16x32_bf16 v[196:199], a[12:15], a[140:143], v[196:199]
v_mfma_f32_16x16x32_bf16 v[200:203], a[16:19], a[136:139], v[200:203]
ds_read_b64_tr_b16 a[132:133], v10 offset:16384
v_mfma_f32_16x16x32_bf16 v[200:203], a[20:23], a[140:143], v[200:203]
v_mfma_f32_16x16x32_bf16 v[204:207], a[24:27], a[136:139], v[204:207]
ds_read_b64_tr_b16 a[134:135], v10 offset:18432
v_mfma_f32_16x16x32_bf16 v[204:207], a[28:31], a[140:143], v[204:207]
v_mfma_f32_16x16x32_bf16 v[208:211], a[32:35], a[136:139], v[208:211]
ds_read_b128 a[116:119], v3 offset:45056
v_mfma_f32_16x16x32_bf16 v[208:211], a[36:39], a[140:143], v[208:211]
v_mfma_f32_16x16x32_bf16 v[212:215], a[40:43], a[136:139], v[212:215]
ds_read_b128 a[120:123], v2 offset:47104
v_mfma_f32_16x16x32_bf16 v[212:215], a[44:47], a[140:143], v[212:215]
v_mfma_f32_16x16x32_bf16 v[216:219], a[48:51], a[136:139], v[216:219]
v_mfma_f32_16x16x32_bf16 v[216:219], a[52:55], a[140:143], v[216:219]
v_mfma_f32_16x16x32_bf16 v[220:223], a[56:59], a[136:139], v[220:223]
ds_read_b128 a[124:127], v3 offset:47104
v_mfma_f32_16x16x32_bf16 v[220:223], a[60:63], a[140:143], v[220:223]
s_waitcnt lgkmcnt(2)
v_mfma_f32_16x16x32_bf16 a[192:195], a[0:3], a[128:131], a[192:195]
ds_read_b64_tr_b16 a[136:137], v11 offset:0
v_mfma_f32_16x16x32_bf16 a[192:195], a[4:7], a[132:135], a[192:195]
v_mfma_f32_16x16x32_bf16 a[196:199], a[8:11], a[128:131], a[196:199]
ds_read_b64_tr_b16 a[138:139], v11 offset:2048
v_mfma_f32_16x16x32_bf16 a[196:199], a[12:15], a[132:135], a[196:199]
v_mfma_f32_16x16x32_bf16 a[200:203], a[16:19], a[128:131], a[200:203]
ds_read_b64_tr_b16 a[140:141], v11 offset:16384
v_mfma_f32_16x16x32_bf16 a[200:203], a[20:23], a[132:135], a[200:203]
v_mfma_f32_16x16x32_bf16 a[204:207], a[24:27], a[128:131], a[204:207]
ds_read_b64_tr_b16 a[142:143], v11 offset:18432
v_mfma_f32_16x16x32_bf16 a[204:207], a[28:31], a[132:135], a[204:207]
v_mfma_f32_16x16x32_bf16 a[208:211], a[32:35], a[128:131], a[208:211]
v_mfma_f32_16x16x32_bf16 a[208:211], a[36:39], a[132:135], a[208:211]
v_mfma_f32_16x16x32_bf16 a[212:215], a[40:43], a[128:131], a[212:215]
v_mfma_f32_16x16x32_bf16 a[212:215], a[44:47], a[132:135], a[212:215]
v_mfma_f32_16x16x32_bf16 a[216:219], a[48:51], a[128:131], a[216:219]
v_mfma_f32_16x16x32_bf16 a[216:219], a[52:55], a[132:135], a[216:219]
v_mfma_f32_16x16x32_bf16 a[220:223], a[56:59], a[128:131], a[220:223]
v_mfma_f32_16x16x32_bf16 a[220:223], a[60:63], a[132:135], a[220:223]
s_waitcnt vmcnt(12) lgkmcnt(0)
s_barrier
v_mfma_f32_16x16x32_bf16 a[224:227], a[0:3], a[136:139], a[224:227]
s_add_u32 m0, s28, 32768
ds_read_b64_tr_b16 a[128:129], v4 offset:32768
v_mfma_f32_16x16x32_bf16 a[224:227], a[4:7], a[140:143], a[224:227]
s_lshr_b32 s22, s3, 1
buffer_load_dwordx4 v12, s[8:11], s24 offen offset:0 lds
v_mfma_f32_16x16x32_bf16 a[228:231], a[8:11], a[136:139], a[228:231]
s_lshl_b32 s22, s22, 14
ds_read_b64_tr_b16 a[130:131], v4 offset:34816
v_subrev_u32 v2, s22, v2
v_mfma_f32_16x16x32_bf16 a[228:231], a[12:15], a[140:143], a[228:231]
v_subrev_u32 v3, s22, v3
v_mfma_f32_16x16x32_bf16 a[232:235], a[16:19], a[136:139], a[232:235]
ds_read_b64_tr_b16 a[132:133], v4 offset:49152
v_mfma_f32_16x16x32_bf16 a[232:235], a[20:23], a[140:143], a[232:235]
buffer_load_dwordx4 v13, s[8:11], s24 offen offset:1024 lds
v_mfma_f32_16x16x32_bf16 a[236:239], a[24:27], a[136:139], a[236:239]
ds_read_b64_tr_b16 a[134:135], v4 offset:51200
v_mfma_f32_16x16x32_bf16 a[236:239], a[28:31], a[140:143], a[236:239]
v_mfma_f32_16x16x32_bf16 a[240:243], a[32:35], a[136:139], a[240:243]
v_mfma_f32_16x16x32_bf16 a[240:243], a[36:39], a[140:143], a[240:243]
buffer_load_dwordx4 v14, s[8:11], s24 offen offset:2048 lds
v_mfma_f32_16x16x32_bf16 a[244:247], a[40:43], a[136:139], a[244:247]
v_mfma_f32_16x16x32_bf16 a[244:247], a[44:47], a[140:143], a[244:247]
v_mfma_f32_16x16x32_bf16 a[248:251], a[48:51], a[136:139], a[248:251]
v_mfma_f32_16x16x32_bf16 a[248:251], a[52:55], a[140:143], a[248:251]
buffer_load_dwordx4 v15, s[8:11], s24 offen offset:3072 lds
v_mfma_f32_16x16x32_bf16 a[252:255], a[56:59], a[136:139], a[252:255]
s_add_u32 s24, s24, 128
v_mfma_f32_16x16x32_bf16 a[252:255], a[60:63], a[140:143], a[252:255]
s_waitcnt lgkmcnt(0)
v_mfma_f32_16x16x32_bf16 v[32:35], a[64:67], a[128:131], v[32:35]
s_add_u32 m0, s29, 65536
ds_read_b64_tr_b16 a[136:137], v5 offset:32768
v_mfma_f32_16x16x32_bf16 v[32:35], a[68:71], a[132:135], v[32:35]
buffer_load_dwordx4 v16, s[12:15], s26 offen offset:0 lds
v_mfma_f32_16x16x32_bf16 v[36:39], a[72:75], a[128:131], v[36:39]
ds_read_b64_tr_b16 a[138:139], v5 offset:34816
v_mfma_f32_16x16x32_bf16 v[36:39], a[76:79], a[132:135], v[36:39]
v_mfma_f32_16x16x32_bf16 v[40:43], a[80:83], a[128:131], v[40:43]
ds_read_b64_tr_b16 a[140:141], v5 offset:49152
v_mfma_f32_16x16x32_bf16 v[40:43], a[84:87], a[132:135], v[40:43]
buffer_load_dwordx4 v17, s[12:15], s26 offen offset:1024 lds
v_mfma_f32_16x16x32_bf16 v[44:47], a[88:91], a[128:131], v[44:47]
ds_read_b64_tr_b16 a[142:143], v5 offset:51200
v_mfma_f32_16x16x32_bf16 v[44:47], a[92:95], a[132:135], v[44:47]
v_mfma_f32_16x16x32_bf16 v[48:51], a[96:99], a[128:131], v[48:51]
ds_read_b128 a[0:3], v2 offset:0
v_cvt_pk_bf16_f32 v32, v32, v33
v_mfma_f32_16x16x32_bf16 v[48:51], a[100:103], a[132:135], v[48:51]
buffer_load_dwordx4 v18, s[12:15], s26 offen offset:2048 lds
v_mfma_f32_16x16x32_bf16 v[52:55], a[104:107], a[128:131], v[52:55]
ds_read_b128 a[4:7], v3 offset:0
v_cvt_pk_bf16_f32 v33, v34, v35
v_mfma_f32_16x16x32_bf16 v[52:55], a[108:111], a[132:135], v[52:55]
v_cvt_pk_bf16_f32 v34, v36, v37
v_cvt_pk_bf16_f32 v35, v38, v39
v_mfma_f32_16x16x32_bf16 v[56:59], a[112:115], a[128:131], v[56:59]
v_cvt_pk_bf16_f32 v40, v40, v41
v_cvt_pk_bf16_f32 v41, v42, v43
v_mfma_f32_16x16x32_bf16 v[56:59], a[116:119], a[132:135], v[56:59]
buffer_load_dwordx4 v19, s[12:15], s26 offen offset:3072 lds
v_mfma_f32_16x16x32_bf16 v[60:63], a[120:123], a[128:131], v[60:63]
s_add_u32 s26, s26, 524288
ds_read_b128 a[8:11], v2 offset:2048
v_cvt_pk_bf16_f32 v42, v44, v45
v_mfma_f32_16x16x32_bf16 v[60:63], a[124:127], a[132:135], v[60:63]
s_waitcnt lgkmcnt(2)
v_cvt_pk_bf16_f32 v43, v46, v47
v_mfma_f32_16x16x32_bf16 v[64:67], a[64:67], a[136:139], v[64:67]
s_add_u32 m0, s29, 81920
ds_read_b64_tr_b16 a[128:129], v6 offset:32768
v_cvt_pk_bf16_f32 v48, v48, v49
v_mfma_f32_16x16x32_bf16 v[64:67], a[68:71], a[140:143], v[64:67]
buffer_load_dwordx4 v16, s[12:15], s27 offen offset:0 lds
v_mfma_f32_16x16x32_bf16 v[68:71], a[72:75], a[136:139], v[68:71]
ds_read_b64_tr_b16 a[130:131], v6 offset:34816
v_cvt_pk_bf16_f32 v49, v50, v51
v_mfma_f32_16x16x32_bf16 v[68:71], a[76:79], a[140:143], v[68:71]
v_cvt_pk_bf16_f32 v50, v52, v53
v_cvt_pk_bf16_f32 v51, v54, v55
v_mfma_f32_16x16x32_bf16 v[72:75], a[80:83], a[136:139], v[72:75]
ds_read_b64_tr_b16 a[132:133], v6 offset:49152
v_cvt_pk_bf16_f32 v56, v56, v57
v_mfma_f32_16x16x32_bf16 v[72:75], a[84:87], a[140:143], v[72:75]
buffer_load_dwordx4 v17, s[12:15], s27 offen offset:1024 lds
v_mfma_f32_16x16x32_bf16 v[76:79], a[88:91], a[136:139], v[76:79]
ds_read_b64_tr_b16 a[134:135], v6 offset:51200
v_cvt_pk_bf16_f32 v57, v58, v59
v_mfma_f32_16x16x32_bf16 v[76:79], a[92:95], a[140:143], v[76:79]
v_cvt_pk_bf16_f32 v58, v60, v61
v_cvt_pk_bf16_f32 v59, v62, v63
v_mfma_f32_16x16x32_bf16 v[80:83], a[96:99], a[136:139], v[80:83]
ds_read_b128 a[12:15], v3 offset:2048
v_cvt_pk_bf16_f32 v64, v64, v65
v_mfma_f32_16x16x32_bf16 v[80:83], a[100:103], a[140:143], v[80:83]
buffer_load_dwordx4 v18, s[12:15], s27 offen offset:2048 lds
v_mfma_f32_16x16x32_bf16 v[84:87], a[104:107], a[136:139], v[84:87]
v_cvt_pk_bf16_f32 v65, v66, v67
v_cvt_pk_bf16_f32 v66, v68, v69
v_mfma_f32_16x16x32_bf16 v[84:87], a[108:111], a[140:143], v[84:87]
v_cvt_pk_bf16_f32 v67, v70, v71
v_mfma_f32_16x16x32_bf16 v[88:91], a[112:115], a[136:139], v[88:91]
ds_read_b128 a[16:19], v2 offset:4096
v_cvt_pk_bf16_f32 v72, v72, v73
v_mfma_f32_16x16x32_bf16 v[88:91], a[116:119], a[140:143], v[88:91]
buffer_load_dwordx4 v19, s[12:15], s27 offen offset:3072 lds
v_mfma_f32_16x16x32_bf16 v[92:95], a[120:123], a[136:139], v[92:95]
s_add_u32 s27, s27, 524288
ds_read_b128 a[20:23], v3 offset:4096
v_cvt_pk_bf16_f32 v73, v74, v75
v_mfma_f32_16x16x32_bf16 v[92:95], a[124:127], a[140:143], v[92:95]
s_waitcnt lgkmcnt(2)
v_cvt_pk_bf16_f32 v74, v76, v77
v_cvt_pk_bf16_f32 v75, v78, v79
v_mfma_f32_16x16x32_bf16 v[96:99], a[64:67], a[128:131], v[96:99]
s_add_u32 m0, s28, 49152
ds_read_b64_tr_b16 a[136:137], v7 offset:32768
v_cvt_pk_bf16_f32 v80, v80, v81
v_mfma_f32_16x16x32_bf16 v[96:99], a[68:71], a[132:135], v[96:99]
buffer_load_dwordx4 v12, s[8:11], s24 offen offset:0 lds
v_mfma_f32_16x16x32_bf16 v[100:103], a[72:75], a[128:131], v[100:103]
ds_read_b64_tr_b16 a[138:139], v7 offset:34816
v_cvt_pk_bf16_f32 v81, v82, v83
v_mfma_f32_16x16x32_bf16 v[100:103], a[76:79], a[132:135], v[100:103]
v_cvt_pk_bf16_f32 v82, v84, v85
v_cvt_pk_bf16_f32 v83, v86, v87
v_mfma_f32_16x16x32_bf16 v[104:107], a[80:83], a[128:131], v[104:107]
ds_read_b64_tr_b16 a[140:141], v7 offset:49152
v_cvt_pk_bf16_f32 v88, v88, v89
v_mfma_f32_16x16x32_bf16 v[104:107], a[84:87], a[132:135], v[104:107]
buffer_load_dwordx4 v13, s[8:11], s24 offen offset:1024 lds
v_mfma_f32_16x16x32_bf16 v[108:111], a[88:91], a[128:131], v[108:111]
ds_read_b64_tr_b16 a[142:143], v7 offset:51200
v_cvt_pk_bf16_f32 v89, v90, v91
v_mfma_f32_16x16x32_bf16 v[108:111], a[92:95], a[132:135], v[108:111]
v_cvt_pk_bf16_f32 v90, v92, v93
v_cvt_pk_bf16_f32 v91, v94, v95
v_mfma_f32_16x16x32_bf16 v[112:115], a[96:99], a[128:131], v[112:115]
v_cvt_pk_bf16_f32 v96, v96, v97
v_cvt_pk_bf16_f32 v97, v98, v99
v_mfma_f32_16x16x32_bf16 v[112:115], a[100:103], a[132:135], v[112:115]
buffer_load_dwordx4 v14, s[8:11], s24 offen offset:2048 lds
v_mfma_f32_16x16x32_bf16 v[116:119], a[104:107], a[128:131], v[116:119]
ds_read_b128 a[24:27], v2 offset:6144
v_cvt_pk_bf16_f32 v98, v100, v101
v_mfma_f32_16x16x32_bf16 v[116:119], a[108:111], a[132:135], v[116:119]
buffer_store_dwordx4 v[32:35], v1, s[4:7], s31 offen sc1
v_mfma_f32_16x16x32_bf16 v[120:123], a[112:115], a[128:131], v[120:123]
s_add_u32 s31, s31, s32
ds_read_b128 a[28:31], v3 offset:6144
v_cvt_pk_bf16_f32 v99, v102, v103
v_mfma_f32_16x16x32_bf16 v[120:123], a[116:119], a[132:135], v[120:123]
PAD_23:
s_cbranch_execz PAD_27
buffer_load_dwordx4 v15, s[8:11], s24 offen offset:3072 lds
v_mfma_f32_16x16x32_bf16 v[124:127], a[120:123], a[128:131], v[124:127]
s_add_u32 s24, s24, 128
v_cvt_pk_bf16_f32 v104, v104, v105
v_cvt_pk_bf16_f32 v105, v106, v107
v_mfma_f32_16x16x32_bf16 v[124:127], a[124:127], a[132:135], v[124:127]
s_waitcnt lgkmcnt(2)
v_cvt_pk_bf16_f32 v106, v108, v109
v_cvt_pk_bf16_f32 v107, v110, v111
v_mfma_f32_16x16x32_bf16 v[128:131], a[64:67], a[136:139], v[128:131]
ds_read_b64_tr_b16 a[128:129], v8 offset:32768
v_cvt_pk_bf16_f32 v112, v112, v113
v_mfma_f32_16x16x32_bf16 v[128:131], a[68:71], a[140:143], v[128:131]
v_cvt_pk_bf16_f32 v113, v114, v115
v_cvt_pk_bf16_f32 v114, v116, v117
v_mfma_f32_16x16x32_bf16 v[132:135], a[72:75], a[136:139], v[132:135]
ds_read_b64_tr_b16 a[130:131], v8 offset:34816
v_cvt_pk_bf16_f32 v115, v118, v119
v_mfma_f32_16x16x32_bf16 v[132:135], a[76:79], a[140:143], v[132:135]
buffer_store_dwordx4 v[40:43], v1, s[4:7], s31 offen sc1
v_mfma_f32_16x16x32_bf16 v[136:139], a[80:83], a[136:139], v[136:139]
s_add_u32 s31, s31, s33
ds_read_b64_tr_b16 a[132:133], v8 offset:49152
v_cvt_pk_bf16_f32 v120, v120, v121
v_mfma_f32_16x16x32_bf16 v[136:139], a[84:87], a[140:143], v[136:139]
v_cvt_pk_bf16_f32 v121, v122, v123
v_cvt_pk_bf16_f32 v122, v124, v125
v_mfma_f32_16x16x32_bf16 v[140:143], a[88:91], a[136:139], v[140:143]
ds_read_b64_tr_b16 a[134:135], v8 offset:51200
v_cvt_pk_bf16_f32 v123, v126, v127
v_mfma_f32_16x16x32_bf16 v[140:143], a[92:95], a[140:143], v[140:143]
v_mfma_f32_16x16x32_bf16 v[144:147], a[96:99], a[136:139], v[144:147]
ds_read_b128 a[32:35], v2 offset:8192
v_cvt_pk_bf16_f32 v128, v128, v129
v_mfma_f32_16x16x32_bf16 v[144:147], a[100:103], a[140:143], v[144:147]
v_cvt_pk_bf16_f32 v129, v130, v131
v_cvt_pk_bf16_f32 v130, v132, v133
v_mfma_f32_16x16x32_bf16 v[148:151], a[104:107], a[136:139], v[148:151]
v_cvt_pk_bf16_f32 v131, v134, v135
v_mfma_f32_16x16x32_bf16 v[148:151], a[108:111], a[140:143], v[148:151]
v_mfma_f32_16x16x32_bf16 v[152:155], a[112:115], a[136:139], v[152:155]
ds_read_b128 a[36:39], v3 offset:8192
v_cvt_pk_bf16_f32 v136, v136, v137
v_mfma_f32_16x16x32_bf16 v[152:155], a[116:119], a[140:143], v[152:155]
v_cvt_pk_bf16_f32 v137, v138, v139
v_cvt_pk_bf16_f32 v138, v140, v141
v_mfma_f32_16x16x32_bf16 v[156:159], a[120:123], a[136:139], v[156:159]
ds_read_b128 a[40:43], v2 offset:10240
v_cvt_pk_bf16_f32 v139, v142, v143
v_mfma_f32_16x16x32_bf16 v[156:159], a[124:127], a[140:143], v[156:159]
s_waitcnt lgkmcnt(2)
buffer_store_dwordx4 v[48:51], v1, s[4:7], s31 offen sc1
v_mfma_f32_16x16x32_bf16 v[160:163], a[64:67], a[128:131], v[160:163]
s_add_u32 s31, s31, s32
ds_read_b64_tr_b16 a[136:137], v9 offset:32768
v_cvt_pk_bf16_f32 v144, v144, v145
v_mfma_f32_16x16x32_bf16 v[160:163], a[68:71], a[132:135], v[160:163]
v_cvt_pk_bf16_f32 v145, v146, v147
v_cvt_pk_bf16_f32 v146, v148, v149
v_mfma_f32_16x16x32_bf16 v[164:167], a[72:75], a[128:131], v[164:167]
ds_read_b64_tr_b16 a[138:139], v9 offset:34816
v_cvt_pk_bf16_f32 v147, v150, v151
v_mfma_f32_16x16x32_bf16 v[164:167], a[76:79], a[132:135], v[164:167]
v_mfma_f32_16x16x32_bf16 v[168:171], a[80:83], a[128:131], v[168:171]
ds_read_b64_tr_b16 a[140:141], v9 offset:49152
v_cvt_pk_bf16_f32 v152, v152, v153
v_mfma_f32_16x16x32_bf16 v[168:171], a[84:87], a[132:135], v[168:171]
v_cvt_pk_bf16_f32 v153, v154, v155
v_cvt_pk_bf16_f32 v154, v156, v157
v_mfma_f32_16x16x32_bf16 v[172:175], a[88:91], a[128:131], v[172:175]
ds_read_b64_tr_b16 a[142:143], v9 offset:51200
v_cvt_pk_bf16_f32 v155, v158, v159
v_mfma_f32_16x16x32_bf16 v[172:175], a[92:95], a[132:135], v[172:175]
v_mfma_f32_16x16x32_bf16 v[176:179], a[96:99], a[128:131], v[176:179]
buffer_store_dwordx4 v[56:59], v1, s[4:7], s31 offen sc1
v_mfma_f32_16x16x32_bf16 v[176:179], a[100:103], a[132:135], v[176:179]
s_add_u32 s31, s31, s34
v_cvt_pk_bf16_f32 v160, v160, v161
v_cvt_pk_bf16_f32 v161, v162, v163
v_mfma_f32_16x16x32_bf16 v[180:183], a[104:107], a[128:131], v[180:183]
ds_read_b128 a[44:47], v3 offset:10240
v_cvt_pk_bf16_f32 v162, v164, v165
v_mfma_f32_16x16x32_bf16 v[180:183], a[108:111], a[132:135], v[180:183]
v_cvt_pk_bf16_f32 v163, v166, v167
v_mfma_f32_16x16x32_bf16 v[184:187], a[112:115], a[128:131], v[184:187]
ds_read_b128 a[48:51], v2 offset:12288
v_cvt_pk_bf16_f32 v168, v168, v169
v_mfma_f32_16x16x32_bf16 v[184:187], a[116:119], a[132:135], v[184:187]
v_cvt_pk_bf16_f32 v169, v170, v171
v_cvt_pk_bf16_f32 v170, v172, v173
v_mfma_f32_16x16x32_bf16 v[188:191], a[120:123], a[128:131], v[188:191]
v_cvt_pk_bf16_f32 v171, v174, v175
v_mfma_f32_16x16x32_bf16 v[188:191], a[124:127], a[132:135], v[188:191]
s_waitcnt lgkmcnt(2)
v_mfma_f32_16x16x32_bf16 v[192:195], a[64:67], a[136:139], v[192:195]
ds_read_b64_tr_b16 a[128:129], v10 offset:32768
v_cvt_pk_bf16_f32 v176, v176, v177
v_mfma_f32_16x16x32_bf16 v[192:195], a[68:71], a[140:143], v[192:195]
v_cvt_pk_bf16_f32 v177, v178, v179
v_cvt_pk_bf16_f32 v178, v180, v181
v_mfma_f32_16x16x32_bf16 v[196:199], a[72:75], a[136:139], v[196:199]
ds_read_b64_tr_b16 a[130:131], v10 offset:34816
v_cvt_pk_bf16_f32 v179, v182, v183
v_mfma_f32_16x16x32_bf16 v[196:199], a[76:79], a[140:143], v[196:199]
buffer_store_dwordx4 v[64:67], v1, s[4:7], s31 offen sc1
v_mfma_f32_16x16x32_bf16 v[200:203], a[80:83], a[136:139], v[200:203]
s_add_u32 s31, s31, s32
ds_read_b64_tr_b16 a[132:133], v10 offset:49152
v_cvt_pk_bf16_f32 v184, v184, v185
v_mfma_f32_16x16x32_bf16 v[200:203], a[84:87], a[140:143], v[200:203]
v_cvt_pk_bf16_f32 v185, v186, v187
v_cvt_pk_bf16_f32 v186, v188, v189
v_mfma_f32_16x16x32_bf16 v[204:207], a[88:91], a[136:139], v[204:207]
ds_read_b64_tr_b16 a[134:135], v10 offset:51200
v_cvt_pk_bf16_f32 v187, v190, v191
v_mfma_f32_16x16x32_bf16 v[204:207], a[92:95], a[140:143], v[204:207]
v_mfma_f32_16x16x32_bf16 v[208:211], a[96:99], a[136:139], v[208:211]
ds_read_b128 a[52:55], v3 offset:12288
v_cvt_pk_bf16_f32 v192, v192, v193
v_mfma_f32_16x16x32_bf16 v[208:211], a[100:103], a[140:143], v[208:211]
v_cvt_pk_bf16_f32 v193, v194, v195
v_cvt_pk_bf16_f32 v194, v196, v197
v_mfma_f32_16x16x32_bf16 v[212:215], a[104:107], a[136:139], v[212:215]
ds_read_b128 a[56:59], v2 offset:14336
v_cvt_pk_bf16_f32 v195, v198, v199
v_mfma_f32_16x16x32_bf16 v[212:215], a[108:111], a[140:143], v[212:215]
v_mfma_f32_16x16x32_bf16 v[216:219], a[112:115], a[136:139], v[216:219]
v_cvt_pk_bf16_f32 v200, v200, v201
v_cvt_pk_bf16_f32 v201, v202, v203
v_mfma_f32_16x16x32_bf16 v[216:219], a[116:119], a[140:143], v[216:219]
buffer_store_dwordx4 v[72:75], v1, s[4:7], s31 offen sc1
v_mfma_f32_16x16x32_bf16 v[220:223], a[120:123], a[136:139], v[220:223]
s_add_u32 s31, s31, s33
ds_read_b128 a[60:63], v3 offset:14336
v_cvt_pk_bf16_f32 v202, v204, v205
v_mfma_f32_16x16x32_bf16 v[220:223], a[124:127], a[140:143], v[220:223]
s_waitcnt lgkmcnt(2)
v_cvt_pk_bf16_f32 v203, v206, v207
v_mfma_f32_16x16x32_bf16 a[192:195], a[64:67], a[128:131], a[192:195]
ds_read_b64_tr_b16 a[136:137], v11 offset:32768
v_cvt_pk_bf16_f32 v208, v208, v209
v_mfma_f32_16x16x32_bf16 a[192:195], a[68:71], a[132:135], a[192:195]
v_cvt_pk_bf16_f32 v209, v210, v211
v_cvt_pk_bf16_f32 v210, v212, v213
v_mfma_f32_16x16x32_bf16 a[196:199], a[72:75], a[128:131], a[196:199]
ds_read_b64_tr_b16 a[138:139], v11 offset:34816
v_cvt_pk_bf16_f32 v211, v214, v215
v_mfma_f32_16x16x32_bf16 a[196:199], a[76:79], a[132:135], a[196:199]
v_mfma_f32_16x16x32_bf16 a[200:203], a[80:83], a[128:131], a[200:203]
ds_read_b64_tr_b16 a[140:141], v11 offset:49152
v_cvt_pk_bf16_f32 v216, v216, v217
v_mfma_f32_16x16x32_bf16 a[200:203], a[84:87], a[132:135], a[200:203]
v_cvt_pk_bf16_f32 v217, v218, v219
v_cvt_pk_bf16_f32 v218, v220, v221
v_mfma_f32_16x16x32_bf16 a[204:207], a[88:91], a[128:131], a[204:207]
ds_read_b64_tr_b16 a[142:143], v11 offset:51200
v_cvt_pk_bf16_f32 v219, v222, v223
v_mfma_f32_16x16x32_bf16 a[204:207], a[92:95], a[132:135], a[204:207]
v_mfma_f32_16x16x32_bf16 a[208:211], a[96:99], a[128:131], a[208:211]
buffer_store_dwordx4 v[80:83], v1, s[4:7], s31 offen sc1
v_mfma_f32_16x16x32_bf16 a[208:211], a[100:103], a[132:135], a[208:211]
s_add_u32 s31, s31, s32
v_mfma_f32_16x16x32_bf16 a[212:215], a[104:107], a[128:131], a[212:215]
v_mfma_f32_16x16x32_bf16 a[212:215], a[108:111], a[132:135], a[212:215]
v_mfma_f32_16x16x32_bf16 a[216:219], a[112:115], a[128:131], a[216:219]
v_mfma_f32_16x16x32_bf16 a[216:219], a[116:119], a[132:135], a[216:219]
v_mfma_f32_16x16x32_bf16 a[220:223], a[120:123], a[128:131], a[220:223]
v_mfma_f32_16x16x32_bf16 a[220:223], a[124:127], a[132:135], a[220:223]
s_waitcnt vmcnt(23) lgkmcnt(0)
s_barrier
v_mfma_f32_16x16x32_bf16 a[224:227], a[64:67], a[136:139], a[224:227]
s_add_u32 m0, s29, 98304
ds_read_b64_tr_b16 a[128:129], v22 offset:0
v_mfma_f32_16x16x32_bf16 a[224:227], a[68:71], a[140:143], a[224:227]
buffer_load_dwordx4 v16, s[12:15], s26 offen offset:0 lds
v_mfma_f32_16x16x32_bf16 a[228:231], a[72:75], a[136:139], a[228:231]
ds_read_b64_tr_b16 a[130:131], v22 offset:2048
v_mfma_f32_16x16x32_bf16 a[228:231], a[76:79], a[140:143], a[228:231]
buffer_store_dwordx4 v[88:91], v1, s[4:7], s31 offen sc1
v_mfma_f32_16x16x32_bf16 a[232:235], a[80:83], a[136:139], a[232:235]
s_add_u32 s31, s31, s35
ds_read_b64_tr_b16 a[132:133], v22 offset:16384
v_mfma_f32_16x16x32_bf16 a[232:235], a[84:87], a[140:143], a[232:235]
buffer_load_dwordx4 v17, s[12:15], s26 offen offset:1024 lds
v_mfma_f32_16x16x32_bf16 a[236:239], a[88:91], a[136:139], a[236:239]
ds_read_b64_tr_b16 a[134:135], v22 offset:18432
v_add_u32 v22, 4294901760, v22
v_mfma_f32_16x16x32_bf16 a[236:239], a[92:95], a[140:143], a[236:239]
v_mfma_f32_16x16x32_bf16 a[240:243], a[96:99], a[136:139], a[240:243]
v_mfma_f32_16x16x32_bf16 a[240:243], a[100:103], a[140:143], a[240:243]
buffer_load_dwordx4 v18, s[12:15], s26 offen offset:2048 lds
v_mfma_f32_16x16x32_bf16 a[244:247], a[104:107], a[136:139], a[244:247]
v_mfma_f32_16x16x32_bf16 a[244:247], a[108:111], a[140:143], a[244:247]
v_mfma_f32_16x16x32_bf16 a[248:251], a[112:115], a[136:139], a[248:251]
v_mfma_f32_16x16x32_bf16 a[248:251], a[116:119], a[140:143], a[248:251]
buffer_load_dwordx4 v19, s[12:15], s26 offen offset:3072 lds
v_mfma_f32_16x16x32_bf16 a[252:255], a[120:123], a[136:139], a[252:255]
s_add_u32 s26, s26, 524288
v_mfma_f32_16x16x32_bf16 a[252:255], a[124:127], a[140:143], a[252:255]
s_waitcnt lgkmcnt(0)
s_cmp_ge_u32 s21, 7
s_cbranch_scc1 M_Q
M_conv:
v_mfma_f32_16x16x32_bf16 v[36:39], a[128:131], a[0:3], 0
s_add_u32 m0, s29, 114688
ds_read_b64_tr_b16 a[136:137], v23 offset:0
v_mfma_f32_16x16x32_bf16 v[36:39], a[132:135], a[4:7], v[36:39]
buffer_load_dwordx4 v16, s[12:15], s27 offen offset:0 lds
v_mfma_f32_16x16x32_bf16 v[44:47], a[128:131], a[8:11], 0
ds_read_b64_tr_b16 a[138:139], v23 offset:2048
v_mfma_f32_16x16x32_bf16 v[44:47], a[132:135], a[12:15], v[44:47]
ds_read_b128 a[64:67], v2 offset:16384
ds_read_b128 a[68:71], v3 offset:16384
v_mfma_f32_16x16x32_bf16 v[52:55], a[128:131], a[16:19], 0
ds_read_b64_tr_b16 a[140:141], v23 offset:16384
v_mfma_f32_16x16x32_bf16 v[52:55], a[132:135], a[20:23], v[52:55]
buffer_load_dwordx4 v17, s[12:15], s27 offen offset:1024 lds
v_mfma_f32_16x16x32_bf16 v[60:63], a[128:131], a[24:27], 0
ds_read_b64_tr_b16 a[142:143], v23 offset:18432
v_add_u32 v23, 4294901760, v23
v_mfma_f32_16x16x32_bf16 v[60:63], a[132:135], a[28:31], v[60:63]
buffer_store_dwordx4 v[96:99], v1, s[4:7], s31 offen sc1
v_mfma_f32_16x16x32_bf16 v[68:71], a[128:131], a[32:35], 0
s_add_u32 s31, s31, s32
ds_read_b128 a[72:75], v2 offset:18432
v_mfma_f32_16x16x32_bf16 v[68:71], a[132:135], a[36:39], v[68:71]
buffer_load_dwordx4 v18, s[12:15], s27 offen offset:2048 lds
v_mfma_f32_16x16x32_bf16 v[76:79], a[128:131], a[40:43], 0
ds_read_b128 a[76:79], v3 offset:18432
v_mfma_f32_16x16x32_bf16 v[76:79], a[132:135], a[44:47], v[76:79]
ds_read_b128 a[80:83], v2 offset:20480
v_mfma_f32_16x16x32_bf16 v[84:87], a[128:131], a[48:51], 0
ds_read_b128 a[84:87], v3 offset:20480
v_mfma_f32_16x16x32_bf16 v[84:87], a[132:135], a[52:55], v[84:87]
buffer_load_dwordx4 v19, s[12:15], s27 offen offset:3072 lds
v_mfma_f32_16x16x32_bf16 v[92:95], a[128:131], a[56:59], 0
s_add_u32 s27, s27, 524288
ds_read_b128 a[88:91], v2 offset:22528
v_mfma_f32_16x16x32_bf16 v[92:95], a[132:135], a[60:63], v[92:95]
s_waitcnt lgkmcnt(4)
buffer_store_dwordx4 v[104:107], v1, s[4:7], s31 offen sc1
v_mfma_f32_16x16x32_bf16 v[100:103], a[136:139], a[0:3], 0
s_add_u32 m0, s28, 0
ds_read_b64_tr_b16 a[128:129], v24 offset:0
v_mfma_f32_16x16x32_bf16 v[100:103], a[140:143], a[4:7], v[100:103]
s_add_u32 s31, s31, s33
buffer_load_dwordx4 v12, s[8:11], s24 offen offset:0 lds
v_mfma_f32_16x16x32_bf16 v[108:111], a[136:139], a[8:11], 0
ds_read_b64_tr_b16 a[130:131], v24 offset:2048
v_mfma_f32_16x16x32_bf16 v[108:111], a[140:143], a[12:15], v[108:111]
ds_read_b128 a[92:95], v3 offset:22528
v_mfma_f32_16x16x32_bf16 v[116:119], a[136:139], a[16:19], 0
ds_read_b64_tr_b16 a[132:133], v24 offset:16384
v_mfma_f32_16x16x32_bf16 v[116:119], a[140:143], a[20:23], v[116:119]
buffer_load_dwordx4 v13, s[8:11], s24 offen offset:1024 lds
v_mfma_f32_16x16x32_bf16 v[124:127], a[136:139], a[24:27], 0
ds_read_b64_tr_b16 a[134:135], v24 offset:18432
v_add_u32 v24, 4294901760, v24
v_mfma_f32_16x16x32_bf16 v[124:127], a[140:143], a[28:31], v[124:127]
v_mfma_f32_16x16x32_bf16 v[132:135], a[136:139], a[32:35], 0
ds_read_b128 a[96:99], v2 offset:24576
v_mfma_f32_16x16x32_bf16 v[132:135], a[140:143], a[36:39], v[132:135]
buffer_load_dwordx4 v14, s[8:11], s24 offen offset:2048 lds
v_mfma_f32_16x16x32_bf16 v[140:143], a[136:139], a[40:43], 0
ds_read_b128 a[100:103], v3 offset:24576
v_mfma_f32_16x16x32_bf16 v[140:143], a[140:143], a[44:47], v[140:143]
ds_read_b128 a[104:107], v2 offset:26624
v_mfma_f32_16x16x32_bf16 v[148:151], a[136:139], a[48:51], 0
ds_read_b128 a[108:111], v3 offset:26624
v_mfma_f32_16x16x32_bf16 v[148:151], a[140:143], a[52:55], v[148:151]
buffer_load_dwordx4 v15, s[8:11], s24 offen offset:3072 lds
v_mfma_f32_16x16x32_bf16 v[156:159], a[136:139], a[56:59], 0
s_add_u32 s24, s24, 128
ds_read_b128 a[112:115], v2 offset:28672
v_mfma_f32_16x16x32_bf16 v[156:159], a[140:143], a[60:63], v[156:159]
s_waitcnt lgkmcnt(4)
buffer_store_dwordx4 v[112:115], v1, s[4:7], s31 offen sc1
v_mfma_f32_16x16x32_bf16 v[164:167], a[128:131], a[0:3], 0
s_add_u32 s31, s31, s32
ds_read_b64_tr_b16 a[136:137], v25 offset:0
v_mfma_f32_16x16x32_bf16 v[164:167], a[132:135], a[4:7], v[164:167]
v_mfma_f32_16x16x32_bf16 v[172:175], a[128:131], a[8:11], 0
ds_read_b64_tr_b16 a[138:139], v25 offset:2048
v_mfma_f32_16x16x32_bf16 v[172:175], a[132:135], a[12:15], v[172:175]
ds_read_b128 a[116:119], v3 offset:28672
v_mfma_f32_16x16x32_bf16 v[180:183], a[128:131], a[16:19], 0
ds_read_b64_tr_b16 a[140:141], v25 offset:16384
v_mfma_f32_16x16x32_bf16 v[180:183], a[132:135], a[20:23], v[180:183]
v_mfma_f32_16x16x32_bf16 v[188:191], a[128:131], a[24:27], 0
ds_read_b64_tr_b16 a[142:143], v25 offset:18432
v_add_u32 v25, 4294901760, v25
v_mfma_f32_16x16x32_bf16 v[188:191], a[132:135], a[28:31], v[188:191]
v_mfma_f32_16x16x32_bf16 v[196:199], a[128:131], a[32:35], 0
ds_read_b128 a[120:123], v2 offset:30720
v_mfma_f32_16x16x32_bf16 v[196:199], a[132:135], a[36:39], v[196:199]
v_mfma_f32_16x16x32_bf16 v[204:207], a[128:131], a[40:43], 0
ds_read_b128 a[124:127], v3 offset:30720
v_mfma_f32_16x16x32_bf16 v[204:207], a[132:135], a[44:47], v[204:207]
v_mfma_f32_16x16x32_bf16 v[212:215], a[128:131], a[48:51], 0
v_mfma_f32_16x16x32_bf16 v[212:215], a[132:135], a[52:55], v[212:215]
buffer_store_dwordx4 v[120:123], v1, s[4:7], s31 offen sc1
v_mfma_f32_16x16x32_bf16 v[220:223], a[128:131], a[56:59], 0
s_add_u32 s31, s31, s34
v_mfma_f32_16x16x32_bf16 v[220:223], a[132:135], a[60:63], v[220:223]
s_waitcnt vmcnt(28) lgkmcnt(0)
s_barrier
v_mfma_f32_16x16x32_bf16 v[224:227], a[136:139], a[0:3], 0
s_add_u32 m0, s29, 131072
ds_read_b64_tr_b16 a[128:129], v22 offset:0
v_mfma_f32_16x16x32_bf16 v[224:227], a[140:143], a[4:7], v[224:227]
buffer_load_dwordx4 v16, s[12:15], s26 offen offset:0 lds
v_mfma_f32_16x16x32_bf16 v[228:231], a[136:139], a[8:11], 0
ds_read_b64_tr_b16 a[130:131], v22 offset:2048
v_mfma_f32_16x16x32_bf16 v[228:231], a[140:143], a[12:15], v[228:231]
v_mfma_f32_16x16x32_bf16 v[232:235], a[136:139], a[16:19], 0
ds_read_b64_tr_b16 a[132:133], v22 offset:16384
v_mfma_f32_16x16x32_bf16 v[232:235], a[140:143], a[20:23], v[232:235]
buffer_load_dwordx4 v17, s[12:15], s26 offen offset:1024 lds
v_mfma_f32_16x16x32_bf16 v[236:239], a[136:139], a[24:27], 0
ds_read_b64_tr_b16 a[134:135], v22 offset:18432
v_add_u32 v22, 32768, v22
v_mfma_f32_16x16x32_bf16 v[236:239], a[140:143], a[28:31], v[236:239]
v_mfma_f32_16x16x32_bf16 v[240:243], a[136:139], a[32:35], 0
v_mfma_f32_16x16x32_bf16 v[240:243], a[140:143], a[36:39], v[240:243]
buffer_load_dwordx4 v18, s[12:15], s26 offen offset:2048 lds
v_mfma_f32_16x16x32_bf16 v[244:247], a[136:139], a[40:43], 0
v_mfma_f32_16x16x32_bf16 v[244:247], a[140:143], a[44:47], v[244:247]
v_mfma_f32_16x16x32_bf16 v[248:251], a[136:139], a[48:51], 0
v_mfma_f32_16x16x32_bf16 v[248:251], a[140:143], a[52:55], v[248:251]
buffer_load_dwordx4 v19, s[12:15], s26 offen offset:3072 lds
v_mfma_f32_16x16x32_bf16 v[252:255], a[136:139], a[56:59], 0
s_add_u32 s26, s26, 524288
v_mfma_f32_16x16x32_bf16 v[252:255], a[140:143], a[60:63], v[252:255]
s_waitcnt lgkmcnt(0)
v_mfma_f32_16x16x32_bf16 v[36:39], a[128:131], a[64:67], v[36:39]
s_add_u32 m0, s29, 147456
ds_read_b64_tr_b16 a[136:137], v23 offset:0
v_accvgpr_read_b32 v32, a192
v_mfma_f32_16x16x32_bf16 v[36:39], a[132:135], a[68:71], v[36:39]
buffer_load_dwordx4 v16, s[12:15], s27 offen offset:0 lds
v_mfma_f32_16x16x32_bf16 v[44:47], a[128:131], a[72:75], v[44:47]
ds_read_b64_tr_b16 a[138:139], v23 offset:2048
v_accvgpr_read_b32 v33, a193
v_mfma_f32_16x16x32_bf16 v[44:47], a[132:135], a[76:79], v[44:47]
ds_read_b128 a[0:3], v2 offset:32768
ds_read_b128 a[4:7], v3 offset:32768
v_mfma_f32_16x16x32_bf16 v[52:55], a[128:131], a[80:83], v[52:55]
ds_read_b64_tr_b16 a[140:141], v23 offset:16384
v_accvgpr_read_b32 v34, a194
v_mfma_f32_16x16x32_bf16 v[52:55], a[132:135], a[84:87], v[52:55]
buffer_load_dwordx4 v17, s[12:15], s27 offen offset:1024 lds
v_mfma_f32_16x16x32_bf16 v[60:63], a[128:131], a[88:91], v[60:63]
ds_read_b64_tr_b16 a[142:143], v23 offset:18432
v_add_u32 v23, 32768, v23
v_mfma_f32_16x16x32_bf16 v[60:63], a[132:135], a[92:95], v[60:63]
buffer_store_dwordx4 v[128:131], v1, s[4:7], s31 offen sc1
v_mfma_f32_16x16x32_bf16 v[68:71], a[128:131], a[96:99], v[68:71]
s_add_u32 s31, s31, s32
ds_read_b128 a[8:11], v2 offset:34816
v_accvgpr_read_b32 v35, a195
v_mfma_f32_16x16x32_bf16 v[68:71], a[132:135], a[100:103], v[68:71]
buffer_load_dwordx4 v18, s[12:15], s27 offen offset:2048 lds
v_mfma_f32_16x16x32_bf16 v[76:79], a[128:131], a[104:107], v[76:79]
ds_read_b128 a[12:15], v3 offset:34816
v_accvgpr_read_b32 v96, a196
v_mfma_f32_16x16x32_bf16 v[76:79], a[132:135], a[108:111], v[76:79]
ds_read_b128 a[16:19], v2 offset:36864
v_accvgpr_read_b32 v97, a197
v_mfma_f32_16x16x32_bf16 v[84:87], a[128:131], a[112:115], v[84:87]
ds_read_b128 a[20:23], v3 offset:36864
v_accvgpr_read_b32 v98, a198
v_mfma_f32_16x16x32_bf16 v[84:87], a[132:135], a[116:119], v[84:87]
buffer_load_dwordx4 v19, s[12:15], s27 offen offset:3072 lds
v_mfma_f32_16x16x32_bf16 v[92:95], a[128:131], a[120:123], v[92:95]
s_add_u32 s27, s27, 524288
ds_read_b128 a[24:27], v2 offset:38912
v_accvgpr_read_b32 v99, a199
v_mfma_f32_16x16x32_bf16 v[92:95], a[132:135], a[124:127], v[92:95]
s_waitcnt lgkmcnt(4)
buffer_store_dwordx4 v[136:139], v1, s[4:7], s31 offen sc1
v_mfma_f32_16x16x32_bf16 v[100:103], a[136:139], a[64:67], v[100:103]
s_add_u32 m0, s28, 16384
ds_read_b64_tr_b16 a[128:129], v24 offset:0
v_cvt_pk_bf16_f32 v32, v32, v33
v_mfma_f32_16x16x32_bf16 v[100:103], a[140:143], a[68:71], v[100:103]
s_add_u32 s31, s31, s33
buffer_load_dwordx4 v12, s[8:11], s24 offen offset:0 lds
v_mfma_f32_16x16x32_bf16 v[108:111], a[136:139], a[72:75], v[108:111]
ds_read_b64_tr_b16 a[130:131], v24 offset:2048
v_cvt_pk_bf16_f32 v33, v34, v35
v_mfma_f32_16x16x32_bf16 v[108:111], a[140:143], a[76:79], v[108:111]
ds_read_b128 a[28:31], v3 offset:38912
v_cvt_pk_bf16_f32 v34, v96, v97
v_mfma_f32_16x16x32_bf16 v[116:119], a[136:139], a[80:83], v[116:119]
ds_read_b64_tr_b16 a[132:133], v24 offset:16384
v_cvt_pk_bf16_f32 v35, v98, v99
v_mfma_f32_16x16x32_bf16 v[116:119], a[140:143], a[84:87], v[116:119]
buffer_load_dwordx4 v13, s[8:11], s24 offen offset:1024 lds
v_mfma_f32_16x16x32_bf16 v[124:127], a[136:139], a[88:91], v[124:127]
ds_read_b64_tr_b16 a[134:135], v24 offset:18432
v_add_u32 v24, 32768, v24
v_mfma_f32_16x16x32_bf16 v[124:127], a[140:143], a[92:95], v[124:127]
v_accvgpr_read_b32 v40, a200
v_accvgpr_read_b32 v41, a201
v_mfma_f32_16x16x32_bf16 v[132:135], a[136:139], a[96:99], v[132:135]
ds_read_b128 a[32:35], v2 offset:40960
v_accvgpr_read_b32 v42, a202
v_mfma_f32_16x16x32_bf16 v[132:135], a[140:143], a[100:103], v[132:135]
buffer_load_dwordx4 v14, s[8:11], s24 offen offset:2048 lds
v_mfma_f32_16x16x32_bf16 v[140:143], a[136:139], a[104:107], v[140:143]
ds_read_b128 a[36:39], v3 offset:40960
v_accvgpr_read_b32 v43, a203
v_mfma_f32_16x16x32_bf16 v[140:143], a[140:143], a[108:111], v[140:143]
ds_read_b128 a[40:43], v2 offset:43008
v_accvgpr_read_b32 v96, a204
v_mfma_f32_16x16x32_bf16 v[148:151], a[136:139], a[112:115], v[148:151]
ds_read_b128 a[44:47], v3 offset:43008
v_accvgpr_read_b32 v97, a205
v_mfma_f32_16x16x32_bf16 v[148:151], a[140:143], a[116:119], v[148:151]
buffer_load_dwordx4 v15, s[8:11], s24 offen offset:3072 lds
v_mfma_f32_16x16x32_bf16 v[156:159], a[136:139], a[120:123], v[156:159]
s_add_u32 s24, s24, 128
ds_read_b128 a[48:51], v2 offset:45056
v_accvgpr_read_b32 v98, a206
v_mfma_f32_16x16x32_bf16 v[156:159], a[140:143], a[124:127], v[156:159]
s_waitcnt lgkmcnt(4)
buffer_store_dwordx4 v[144:147], v1, s[4:7], s31 offen sc1
v_mfma_f32_16x16x32_bf16 v[164:167], a[128:131], a[64:67], v[164:167]
s_add_u32 s31, s31, s32
ds_read_b64_tr_b16 a[136:137], v25 offset:0
v_accvgpr_read_b32 v99, a207
v_mfma_f32_16x16x32_bf16 v[164:167], a[132:135], a[68:71], v[164:167]
v_cvt_pk_bf16_f32 v40, v40, v41
v_cvt_pk_bf16_f32 v41, v42, v43
v_mfma_f32_16x16x32_bf16 v[172:175], a[128:131], a[72:75], v[172:175]
ds_read_b64_tr_b16 a[138:139], v25 offset:2048
v_cvt_pk_bf16_f32 v42, v96, v97
v_mfma_f32_16x16x32_bf16 v[172:175], a[132:135], a[76:79], v[172:175]
ds_read_b128 a[52:55], v3 offset:45056
v_cvt_pk_bf16_f32 v43, v98, v99
v_mfma_f32_16x16x32_bf16 v[180:183], a[128:131], a[80:83], v[180:183]
ds_read_b64_tr_b16 a[140:141], v25 offset:16384
v_accvgpr_read_b32 v48, a208
v_mfma_f32_16x16x32_bf16 v[180:183], a[132:135], a[84:87], v[180:183]
v_accvgpr_read_b32 v49, a209
v_accvgpr_read_b32 v50, a210
v_mfma_f32_16x16x32_bf16 v[188:191], a[128:131], a[88:91], v[188:191]
ds_read_b64_tr_b16 a[142:143], v25 offset:18432
v_add_u32 v25, 32768, v25
v_mfma_f32_16x16x32_bf16 v[188:191], a[132:135], a[92:95], v[188:191]
v_accvgpr_read_b32 v51, a211
v_accvgpr_read_b32 v96, a212
v_mfma_f32_16x16x32_bf16 v[196:199], a[128:131], a[96:99], v[196:199]
ds_read_b128 a[56:59], v2 offset:47104
v_accvgpr_read_b32 v97, a213
v_mfma_f32_16x16x32_bf16 v[196:199], a[132:135], a[100:103], v[196:199]
v_accvgpr_read_b32 v98, a214
v_accvgpr_read_b32 v99, a215
v_mfma_f32_16x16x32_bf16 v[204:207], a[128:131], a[104:107], v[204:207]
ds_read_b128 a[60:63], v3 offset:47104
v_cvt_pk_bf16_f32 v48, v48, v49
v_mfma_f32_16x16x32_bf16 v[204:207], a[132:135], a[108:111], v[204:207]
v_cvt_pk_bf16_f32 v49, v50, v51
v_cvt_pk_bf16_f32 v50, v96, v97
v_mfma_f32_16x16x32_bf16 v[212:215], a[128:131], a[112:115], v[212:215]
v_cvt_pk_bf16_f32 v51, v98, v99
v_accvgpr_read_b32 v56, a216
v_mfma_f32_16x16x32_bf16 v[212:215], a[132:135], a[116:119], v[212:215]
buffer_store_dwordx4 v[152:155], v1, s[4:7], s31 offen sc1
v_mfma_f32_16x16x32_bf16 v[220:223], a[128:131], a[120:123], v[220:223]
s_add_u32 s31, s31, s36
v_accvgpr_read_b32 v57, a217
v_accvgpr_read_b32 v58, a218
v_mfma_f32_16x16x32_bf16 v[220:223], a[132:135], a[124:127], v[220:223]
s_waitcnt vmcnt(23) lgkmcnt(0)
s_barrier
v_accvgpr_read_b32 v59, a219
v_mfma_f32_16x16x32_bf16 v[224:227], a[136:139], a[64:67], v[224:227]
s_add_u32 m0, s29, 65536
ds_read_b64_tr_b16 a[128:129], v22 offset:0
v_accvgpr_read_b32 v96, a220
v_mfma_f32_16x16x32_bf16 v[224:227], a[140:143], a[68:71], v[224:227]
buffer_load_dwordx4 v16, s[12:15], s26 offen offset:0 lds
v_mfma_f32_16x16x32_bf16 v[228:231], a[136:139], a[72:75], v[228:231]
ds_read_b64_tr_b16 a[130:131], v22 offset:2048
v_accvgpr_read_b32 v97, a221
v_mfma_f32_16x16x32_bf16 v[228:231], a[140:143], a[76:79], v[228:231]
v_accvgpr_read_b32 v98, a222
v_accvgpr_read_b32 v99, a223
v_mfma_f32_16x16x32_bf16 v[232:235], a[136:139], a[80:83], v[232:235]
ds_read_b64_tr_b16 a[132:133], v22 offset:16384
v_cvt_pk_bf16_f32 v56, v56, v57
v_mfma_f32_16x16x32_bf16 v[232:235], a[140:143], a[84:87], v[232:235]
buffer_load_dwordx4 v17, s[12:15], s26 offen offset:1024 lds
v_mfma_f32_16x16x32_bf16 v[236:239], a[136:139], a[88:91], v[236:239]
ds_read_b64_tr_b16 a[134:135], v22 offset:18432
v_add_u32 v22, 32768, v22
v_mfma_f32_16x16x32_bf16 v[236:239], a[140:143], a[92:95], v[236:239]
v_cvt_pk_bf16_f32 v57, v58, v59
v_cvt_pk_bf16_f32 v58, v96, v97
v_mfma_f32_16x16x32_bf16 v[240:243], a[136:139], a[96:99], v[240:243]
v_cvt_pk_bf16_f32 v59, v98, v99
v_accvgpr_read_b32 v64, a224
v_mfma_f32_16x16x32_bf16 v[240:243], a[140:143], a[100:103], v[240:243]
buffer_load_dwordx4 v18, s[12:15], s26 offen offset:2048 lds
v_mfma_f32_16x16x32_bf16 v[244:247], a[136:139], a[104:107], v[244:247]
v_accvgpr_read_b32 v65, a225
v_accvgpr_read_b32 v66, a226
v_mfma_f32_16x16x32_bf16 v[244:247], a[140:143], a[108:111], v[244:247]
v_accvgpr_read_b32 v67, a227
v_accvgpr_read_b32 v96, a228
v_mfma_f32_16x16x32_bf16 v[248:251], a[136:139], a[112:115], v[248:251]
v_accvgpr_read_b32 v97, a229
v_accvgpr_read_b32 v98, a230
v_mfma_f32_16x16x32_bf16 v[248:251], a[140:143], a[116:119], v[248:251]
buffer_load_dwordx4 v19, s[12:15], s26 offen offset:3072 lds
v_mfma_f32_16x16x32_bf16 v[252:255], a[136:139], a[120:123], v[252:255]
s_add_u32 s26, s26, 524288
v_accvgpr_read_b32 v99, a231
v_cvt_pk_bf16_f32 v64, v64, v65
v_mfma_f32_16x16x32_bf16 v[252:255], a[140:143], a[124:127], v[252:255]
s_waitcnt lgkmcnt(0)
v_cvt_pk_bf16_f32 v65, v66, v67
v_cvt_pk_bf16_f32 v66, v96, v97
v_mfma_f32_16x16x32_bf16 v[36:39], a[128:131], a[0:3], v[36:39]
s_add_u32 m0, s29, 81920
ds_read_b64_tr_b16 a[136:137], v23 offset:0
v_cvt_pk_bf16_f32 v67, v98, v99
v_mfma_f32_16x16x32_bf16 v[36:39], a[132:135], a[4:7], v[36:39]
PAD_24:
s_cbranch_execz M_tret
buffer_load_dwordx4 v16, s[12:15], s27 offen offset:0 lds
v_mfma_f32_16x16x32_bf16 v[44:47], a[128:131], a[8:11], v[44:47]
ds_read_b64_tr_b16 a[138:139], v23 offset:2048
v_accvgpr_read_b32 v72, a232
v_mfma_f32_16x16x32_bf16 v[44:47], a[132:135], a[12:15], v[44:47]
ds_read_b128 a[64:67], v2 offset:49152
ds_read_b128 a[68:71], v3 offset:49152
v_mfma_f32_16x16x32_bf16 v[52:55], a[128:131], a[16:19], v[52:55]
ds_read_b64_tr_b16 a[140:141], v23 offset:16384
v_accvgpr_read_b32 v73, a233
v_mfma_f32_16x16x32_bf16 v[52:55], a[132:135], a[20:23], v[52:55]
buffer_load_dwordx4 v17, s[12:15], s27 offen offset:1024 lds
v_mfma_f32_16x16x32_bf16 v[60:63], a[128:131], a[24:27], v[60:63]
ds_read_b64_tr_b16 a[142:143], v23 offset:18432
v_add_u32 v23, 32768, v23
v_mfma_f32_16x16x32_bf16 v[60:63], a[132:135], a[28:31], v[60:63]
buffer_store_dwordx4 v[160:163], v1, s[4:7], s31 offen sc1
v_mfma_f32_16x16x32_bf16 v[68:71], a[128:131], a[32:35], v[68:71]
s_add_u32 s31, s31, s32
ds_read_b128 a[72:75], v2 offset:51200
v_accvgpr_read_b32 v74, a234
v_mfma_f32_16x16x32_bf16 v[68:71], a[132:135], a[36:39], v[68:71]
buffer_load_dwordx4 v18, s[12:15], s27 offen offset:2048 lds
v_mfma_f32_16x16x32_bf16 v[76:79], a[128:131], a[40:43], v[76:79]
ds_read_b128 a[76:79], v3 offset:51200
v_accvgpr_read_b32 v75, a235
v_mfma_f32_16x16x32_bf16 v[76:79], a[132:135], a[44:47], v[76:79]
ds_read_b128 a[80:83], v2 offset:53248
v_accvgpr_read_b32 v96, a236
v_mfma_f32_16x16x32_bf16 v[84:87], a[128:131], a[48:51], v[84:87]
ds_read_b128 a[84:87], v3 offset:53248
v_accvgpr_read_b32 v97, a237
v_mfma_f32_16x16x32_bf16 v[84:87], a[132:135], a[52:55], v[84:87]
buffer_load_dwordx4 v19, s[12:15], s27 offen offset:3072 lds
v_mfma_f32_16x16x32_bf16 v[92:95], a[128:131], a[56:59], v[92:95]
s_add_u32 s27, s27, 524288
ds_read_b128 a[88:91], v2 offset:55296
v_accvgpr_read_b32 v98, a238
v_mfma_f32_16x16x32_bf16 v[92:95], a[132:135], a[60:63], v[92:95]
s_waitcnt lgkmcnt(4)
buffer_store_dwordx4 v[168:171], v1, s[4:7], s31 offen sc1
v_mfma_f32_16x16x32_bf16 v[100:103], a[136:139], a[0:3], v[100:103]
s_add_u32 m0, s28, 32768
ds_read_b64_tr_b16 a[128:129], v24 offset:0
v_accvgpr_read_b32 v99, a239
v_mfma_f32_16x16x32_bf16 v[100:103], a[140:143], a[4:7], v[100:103]
s_add_u32 s31, s31, s33
buffer_load_dwordx4 v12, s[8:11], s24 offen offset:0 lds
v_mfma_f32_16x16x32_bf16 v[108:111], a[136:139], a[8:11], v[108:111]
ds_read_b64_tr_b16 a[130:131], v24 offset:2048
v_cvt_pk_bf16_f32 v72, v72, v73
v_mfma_f32_16x16x32_bf16 v[108:111], a[140:143], a[12:15], v[108:111]
ds_read_b128 a[92:95], v3 offset:55296
v_cvt_pk_bf16_f32 v73, v74, v75
v_mfma_f32_16x16x32_bf16 v[116:119], a[136:139], a[16:19], v[116:119]
ds_read_b64_tr_b16 a[132:133], v24 offset:16384
v_cvt_pk_bf16_f32 v74, v96, v97
v_mfma_f32_16x16x32_bf16 v[116:119], a[140:143], a[20:23], v[116:119]
buffer_load_dwordx4 v13, s[8:11], s24 offen offset:1024 lds
v_mfma_f32_16x16x32_bf16 v[124:127], a[136:139], a[24:27], v[124:127]
ds_read_b64_tr_b16 a[134:135], v24 offset:18432
v_add_u32 v24, 32768, v24
v_mfma_f32_16x16x32_bf16 v[124:127], a[140:143], a[28:31], v[124:127]
v_cvt_pk_bf16_f32 v75, v98, v99
v_accvgpr_read_b32 v80, a240
v_mfma_f32_16x16x32_bf16 v[132:135], a[136:139], a[32:35], v[132:135]
ds_read_b128 a[96:99], v2 offset:57344
v_accvgpr_read_b32 v81, a241
v_mfma_f32_16x16x32_bf16 v[132:135], a[140:143], a[36:39], v[132:135]
buffer_load_dwordx4 v14, s[8:11], s24 offen offset:2048 lds
v_mfma_f32_16x16x32_bf16 v[140:143], a[136:139], a[40:43], v[140:143]
ds_read_b128 a[100:103], v3 offset:57344
v_accvgpr_read_b32 v82, a242
v_mfma_f32_16x16x32_bf16 v[140:143], a[140:143], a[44:47], v[140:143]
ds_read_b128 a[104:107], v2 offset:59392
v_accvgpr_read_b32 v83, a243
v_mfma_f32_16x16x32_bf16 v[148:151], a[136:139], a[48:51], v[148:151]
ds_read_b128 a[108:111], v3 offset:59392
v_accvgpr_read_b32 v96, a244
v_mfma_f32_16x16x32_bf16 v[148:151], a[140:143], a[52:55], v[148:151]
buffer_load_dwordx4 v15, s[8:11], s24 offen offset:3072 lds
v_mfma_f32_16x16x32_bf16 v[156:159], a[136:139], a[56:59], v[156:159]
s_add_u32 s24, s24, 128
ds_read_b128 a[112:115], v2 offset:61440
v_accvgpr_read_b32 v97, a245
v_mfma_f32_16x16x32_bf16 v[156:159], a[140:143], a[60:63], v[156:159]
s_waitcnt lgkmcnt(4)
buffer_store_dwordx4 v[176:179], v1, s[4:7], s31 offen sc1
v_mfma_f32_16x16x32_bf16 v[164:167], a[128:131], a[0:3], v[164:167]
s_add_u32 s31, s31, s32
ds_read_b64_tr_b16 a[136:137], v25 offset:0
v_accvgpr_read_b32 v98, a246
v_mfma_f32_16x16x32_bf16 v[164:167], a[132:135], a[4:7], v[164:167]
v_accvgpr_read_b32 v99, a247
v_cvt_pk_bf16_f32 v80, v80, v81
v_mfma_f32_16x16x32_bf16 v[172:175], a[128:131], a[8:11], v[172:175]
ds_read_b64_tr_b16 a[138:139], v25 offset:2048
v_cvt_pk_bf16_f32 v81, v82, v83
v_mfma_f32_16x16x32_bf16 v[172:175], a[132:135], a[12:15], v[172:175]
ds_read_b128 a[116:119], v3 offset:61440
v_cvt_pk_bf16_f32 v82, v96, v97
v_mfma_f32_16x16x32_bf16 v[180:183], a[128:131], a[16:19], v[180:183]
ds_read_b64_tr_b16 a[140:141], v25 offset:16384
v_cvt_pk_bf16_f32 v83, v98, v99
v_mfma_f32_16x16x32_bf16 v[180:183], a[132:135], a[20:23], v[180:183]
buffer_store_dwordx4 v[184:187], v1, s[4:7], s31 offen sc1
v_mfma_f32_16x16x32_bf16 v[188:191], a[128:131], a[24:27], v[188:191]
s_add_u32 s31, s31, s34
ds_read_b64_tr_b16 a[142:143], v25 offset:18432
v_add_u32 v25, 32768, v25
v_mfma_f32_16x16x32_bf16 v[188:191], a[132:135], a[28:31], v[188:191]
v_accvgpr_read_b32 v88, a248
v_accvgpr_read_b32 v89, a249
v_mfma_f32_16x16x32_bf16 v[196:199], a[128:131], a[32:35], v[196:199]
ds_read_b128 a[120:123], v2 offset:63488
v_accvgpr_read_b32 v90, a250
v_mfma_f32_16x16x32_bf16 v[196:199], a[132:135], a[36:39], v[196:199]
v_accvgpr_read_b32 v91, a251
v_accvgpr_read_b32 v96, a252
v_mfma_f32_16x16x32_bf16 v[204:207], a[128:131], a[40:43], v[204:207]
ds_read_b128 a[124:127], v3 offset:63488
v_accvgpr_read_b32 v97, a253
v_mfma_f32_16x16x32_bf16 v[204:207], a[132:135], a[44:47], v[204:207]
v_accvgpr_read_b32 v98, a254
v_accvgpr_read_b32 v99, a255
v_mfma_f32_16x16x32_bf16 v[212:215], a[128:131], a[48:51], v[212:215]
v_cvt_pk_bf16_f32 v88, v88, v89
v_cvt_pk_bf16_f32 v89, v90, v91
v_mfma_f32_16x16x32_bf16 v[212:215], a[132:135], a[52:55], v[212:215]
v_cvt_pk_bf16_f32 v90, v96, v97
v_cvt_pk_bf16_f32 v91, v98, v99
v_mfma_f32_16x16x32_bf16 v[220:223], a[128:131], a[56:59], v[220:223]
v_mfma_f32_16x16x32_bf16 v[220:223], a[132:135], a[60:63], v[220:223]
s_waitcnt vmcnt(23) lgkmcnt(0)
s_barrier
v_mfma_f32_16x16x32_bf16 v[224:227], a[136:139], a[0:3], v[224:227]
s_add_u32 m0, s29, 98304
ds_read_b64_tr_b16 a[128:129], v22 offset:0
v_mfma_f32_16x16x32_bf16 v[224:227], a[140:143], a[4:7], v[224:227]
buffer_load_dwordx4 v16, s[12:15], s26 offen offset:0 lds
v_mfma_f32_16x16x32_bf16 v[228:231], a[136:139], a[8:11], v[228:231]
ds_read_b64_tr_b16 a[130:131], v22 offset:2048
v_mfma_f32_16x16x32_bf16 v[228:231], a[140:143], a[12:15], v[228:231]
buffer_store_dwordx4 v[192:195], v1, s[4:7], s31 offen sc1
v_mfma_f32_16x16x32_bf16 v[232:235], a[136:139], a[16:19], v[232:235]
s_add_u32 s31, s31, s32
ds_read_b64_tr_b16 a[132:133], v22 offset:16384
v_mfma_f32_16x16x32_bf16 v[232:235], a[140:143], a[20:23], v[232:235]
buffer_load_dwordx4 v17, s[12:15], s26 offen offset:1024 lds
v_mfma_f32_16x16x32_bf16 v[236:239], a[136:139], a[24:27], v[236:239]
ds_read_b64_tr_b16 a[134:135], v22 offset:18432
v_add_u32 v22, 4294901760, v22
v_mfma_f32_16x16x32_bf16 v[236:239], a[140:143], a[28:31], v[236:239]
v_mfma_f32_16x16x32_bf16 v[240:243], a[136:139], a[32:35], v[240:243]
v_mfma_f32_16x16x32_bf16 v[240:243], a[140:143], a[36:39], v[240:243]
buffer_load_dwordx4 v18, s[12:15], s26 offen offset:2048 lds
v_mfma_f32_16x16x32_bf16 v[244:247], a[136:139], a[40:43], v[244:247]
v_mfma_f32_16x16x32_bf16 v[244:247], a[140:143], a[44:47], v[244:247]
v_mfma_f32_16x16x32_bf16 v[248:251], a[136:139], a[48:51], v[248:251]
v_mfma_f32_16x16x32_bf16 v[248:251], a[140:143], a[52:55], v[248:251]
buffer_load_dwordx4 v19, s[12:15], s26 offen offset:3072 lds
v_mfma_f32_16x16x32_bf16 v[252:255], a[136:139], a[56:59], v[252:255]
s_add_u32 s26, s26, 524288
v_mfma_f32_16x16x32_bf16 v[252:255], a[140:143], a[60:63], v[252:255]
s_waitcnt lgkmcnt(0)
v_mfma_f32_16x16x32_bf16 v[36:39], a[128:131], a[64:67], v[36:39]
s_add_u32 m0, s29, 114688
ds_read_b64_tr_b16 a[136:137], v23 offset:0
v_mfma_f32_16x16x32_bf16 v[36:39], a[132:135], a[68:71], v[36:39]
buffer_load_dwordx4 v16, s[12:15], s27 offen offset:0 lds
v_mfma_f32_16x16x32_bf16 v[44:47], a[128:131], a[72:75], v[44:47]
ds_read_b64_tr_b16 a[138:139], v23 offset:2048
v_mfma_f32_16x16x32_bf16 v[44:47], a[132:135], a[76:79], v[44:47]
ds_read_b128 a[0:3], v2 offset:0
ds_read_b128 a[4:7], v3 offset:0
v_mfma_f32_16x16x32_bf16 v[52:55], a[128:131], a[80:83], v[52:55]
ds_read_b64_tr_b16 a[140:141], v23 offset:16384
v_mfma_f32_16x16x32_bf16 v[52:55], a[132:135], a[84:87], v[52:55]
buffer_load_dwordx4 v17, s[12:15], s27 offen offset:1024 lds
v_mfma_f32_16x16x32_bf16 v[60:63], a[128:131], a[88:91], v[60:63]
ds_read_b64_tr_b16 a[142:143], v23 offset:18432
v_add_u32 v23, 4294901760, v23
v_mfma_f32_16x16x32_bf16 v[60:63], a[132:135], a[92:95], v[60:63]
buffer_store_dwordx4 v[200:203], v1, s[4:7], s31 offen sc1
v_mfma_f32_16x16x32_bf16 v[68:71], a[128:131], a[96:99], v[68:71]
s_add_u32 s31, s31, s33
ds_read_b128 a[8:11], v2 offset:2048
v_mfma_f32_16x16x32_bf16 v[68:71], a[132:135], a[100:103], v[68:71]
buffer_load_dwordx4 v18, s[12:15], s27 offen offset:2048 lds
v_mfma_f32_16x16x32_bf16 v[76:79], a[128:131], a[104:107], v[76:79]
ds_read_b128 a[12:15], v3 offset:2048
v_mfma_f32_16x16x32_bf16 v[76:79], a[132:135], a[108:111], v[76:79]
ds_read_b128 a[16:19], v2 offset:4096
v_mfma_f32_16x16x32_bf16 v[84:87], a[128:131], a[112:115], v[84:87]
ds_read_b128 a[20:23], v3 offset:4096
v_mfma_f32_16x16x32_bf16 v[84:87], a[132:135], a[116:119], v[84:87]
buffer_load_dwordx4 v19, s[12:15], s27 offen offset:3072 lds
v_mfma_f32_16x16x32_bf16 v[92:95], a[128:131], a[120:123], v[92:95]
s_add_u32 s27, s27, 524288
ds_read_b128 a[24:27], v2 offset:6144
v_mfma_f32_16x16x32_bf16 v[92:95], a[132:135], a[124:127], v[92:95]
s_waitcnt lgkmcnt(4)
buffer_store_dwordx4 v[208:211], v1, s[4:7], s31 offen sc1
v_mfma_f32_16x16x32_bf16 v[100:103], a[136:139], a[64:67], v[100:103]
s_add_u32 s31, s31, s32
ds_read_b64_tr_b16 a[128:129], v24 offset:0
v_mfma_f32_16x16x32_bf16 v[100:103], a[140:143], a[68:71], v[100:103]
v_mfma_f32_16x16x32_bf16 v[108:111], a[136:139], a[72:75], v[108:111]
ds_read_b64_tr_b16 a[130:131], v24 offset:2048
v_mfma_f32_16x16x32_bf16 v[108:111], a[140:143], a[76:79], v[108:111]
ds_read_b128 a[28:31], v3 offset:6144
v_mfma_f32_16x16x32_bf16 v[116:119], a[136:139], a[80:83], v[116:119]
ds_read_b64_tr_b16 a[132:133], v24 offset:16384
v_mfma_f32_16x16x32_bf16 v[116:119], a[140:143], a[84:87], v[116:119]
v_mfma_f32_16x16x32_bf16 v[124:127], a[136:139], a[88:91], v[124:127]
ds_read_b64_tr_b16 a[134:135], v24 offset:18432
v_add_u32 v24, 4294901760, v24
v_mfma_f32_16x16x32_bf16 v[124:127], a[140:143], a[92:95], v[124:127]
v_mfma_f32_16x16x32_bf16 v[132:135], a[136:139], a[96:99], v[132:135]
ds_read_b128 a[32:35], v2 offset:8192
v_mfma_f32_16x16x32_bf16 v[132:135], a[140:143], a[100:103], v[132:135]
buffer_store_dwordx4 v[216:219], v1, s[4:7], s31 offen sc1
v_mfma_f32_16x16x32_bf16 v[140:143], a[136:139], a[104:107], v[140:143]
s_add_u32 s31, s31, s35
ds_read_b128 a[36:39], v3 offset:8192
v_mfma_f32_16x16x32_bf16 v[140:143], a[140:143], a[108:111], v[140:143]
ds_read_b128 a[40:43], v2 offset:10240
v_mfma_f32_16x16x32_bf16 v[148:151], a[136:139], a[112:115], v[148:151]
ds_read_b128 a[44:47], v3 offset:10240
v_mfma_f32_16x16x32_bf16 v[148:151], a[140:143], a[116:119], v[148:151]
v_mfma_f32_16x16x32_bf16 v[156:159], a[136:139], a[120:123], v[156:159]
ds_read_b128 a[48:51], v2 offset:12288
v_mfma_f32_16x16x32_bf16 v[156:159], a[140:143], a[124:127], v[156:159]
s_waitcnt lgkmcnt(4)
v_mfma_f32_16x16x32_bf16 v[164:167], a[128:131], a[64:67], v[164:167]
ds_read_b64_tr_b16 a[136:137], v25 offset:0
v_mfma_f32_16x16x32_bf16 v[164:167], a[132:135], a[68:71], v[164:167]
v_mfma_f32_16x16x32_bf16 v[172:175], a[128:131], a[72:75], v[172:175]
ds_read_b64_tr_b16 a[138:139], v25 offset:2048
v_mfma_f32_16x16x32_bf16 v[172:175], a[132:135], a[76:79], v[172:175]
ds_read_b128 a[52:55], v3 offset:12288
v_mfma_f32_16x16x32_bf16 v[180:183], a[128:131], a[80:83], v[180:183]
ds_read_b64_tr_b16 a[140:141], v25 offset:16384
v_mfma_f32_16x16x32_bf16 v[180:183], a[132:135], a[84:87], v[180:183]
buffer_store_dwordx4 v[32:35], v1, s[4:7], s31 offen sc1
v_mfma_f32_16x16x32_bf16 v[188:191], a[128:131], a[88:91], v[188:191]
s_add_u32 s31, s31, s32
ds_read_b64_tr_b16 a[142:143], v25 offset:18432
v_add_u32 v25, 4294901760, v25
v_mfma_f32_16x16x32_bf16 v[188:191], a[132:135], a[92:95], v[188:191]
v_mfma_f32_16x16x32_bf16 v[196:199], a[128:131], a[96:99], v[196:199]
ds_read_b128 a[56:59], v2 offset:14336
v_mfma_f32_16x16x32_bf16 v[196:199], a[132:135], a[100:103], v[196:199]
v_mfma_f32_16x16x32_bf16 v[204:207], a[128:131], a[104:107], v[204:207]
ds_read_b128 a[60:63], v3 offset:14336
v_mfma_f32_16x16x32_bf16 v[204:207], a[132:135], a[108:111], v[204:207]
v_mfma_f32_16x16x32_bf16 v[212:215], a[128:131], a[112:115], v[212:215]
v_mfma_f32_16x16x32_bf16 v[212:215], a[132:135], a[116:119], v[212:215]
v_mfma_f32_16x16x32_bf16 v[220:223], a[128:131], a[120:123], v[220:223]
v_mfma_f32_16x16x32_bf16 v[220:223], a[132:135], a[124:127], v[220:223]
s_waitcnt vmcnt(20) lgkmcnt(0)
s_barrier
v_mfma_f32_16x16x32_bf16 v[224:227], a[136:139], a[64:67], v[224:227]
s_add_u32 m0, s29, 131072
ds_read_b64_tr_b16 a[128:129], v22 offset:0
v_mfma_f32_16x16x32_bf16 v[224:227], a[140:143], a[68:71], v[224:227]
buffer_load_dwordx4 v16, s[12:15], s26 offen offset:0 lds
v_mfma_f32_16x16x32_bf16 v[228:231], a[136:139], a[72:75], v[228:231]
ds_read_b64_tr_b16 a[130:131], v22 offset:2048
v_mfma_f32_16x16x32_bf16 v[228:231], a[140:143], a[76:79], v[228:231]
buffer_store_dwordx4 v[40:43], v1, s[4:7], s31 offen sc1
v_mfma_f32_16x16x32_bf16 v[232:235], a[136:139], a[80:83], v[232:235]
s_add_u32 s31, s31, s33
ds_read_b64_tr_b16 a[132:133], v22 offset:16384
v_mfma_f32_16x16x32_bf16 v[232:235], a[140:143], a[84:87], v[232:235]
buffer_load_dwordx4 v17, s[12:15], s26 offen offset:1024 lds
v_mfma_f32_16x16x32_bf16 v[236:239], a[136:139], a[88:91], v[236:239]
ds_read_b64_tr_b16 a[134:135], v22 offset:18432
v_add_u32 v22, 32768, v22
v_mfma_f32_16x16x32_bf16 v[236:239], a[140:143], a[92:95], v[236:239]
v_mfma_f32_16x16x32_bf16 v[240:243], a[136:139], a[96:99], v[240:243]
v_mfma_f32_16x16x32_bf16 v[240:243], a[140:143], a[100:103], v[240:243]
buffer_load_dwordx4 v18, s[12:15], s26 offen offset:2048 lds
v_mfma_f32_16x16x32_bf16 v[244:247], a[136:139], a[104:107], v[244:247]
v_mfma_f32_16x16x32_bf16 v[244:247], a[140:143], a[108:111], v[244:247]
v_mfma_f32_16x16x32_bf16 v[248:251], a[136:139], a[112:115], v[248:251]
v_mfma_f32_16x16x32_bf16 v[248:251], a[140:143], a[116:119], v[248:251]
buffer_load_dwordx4 v19, s[12:15], s26 offen offset:3072 lds
v_mfma_f32_16x16x32_bf16 v[252:255], a[136:139], a[120:123], v[252:255]
s_add_u32 s26, s26, 524288
v_mfma_f32_16x16x32_bf16 v[252:255], a[140:143], a[124:127], v[252:255]
s_waitcnt lgkmcnt(0)
v_mfma_f32_16x16x32_bf16 v[36:39], a[128:131], a[0:3], v[36:39]
s_add_u32 m0, s29, 147456
ds_read_b64_tr_b16 a[136:137], v23 offset:0
v_mfma_f32_16x16x32_bf16 v[36:39], a[132:135], a[4:7], v[36:39]
buffer_load_dwordx4 v16, s[12:15], s27 offen offset:0 lds
v_mfma_f32_16x16x32_bf16 v[44:47], a[128:131], a[8:11], v[44:47]
s_lshl_b32 s22, s20, 7
ds_read_b64_tr_b16 a[138:139], v23 offset:2048
v_bfe_u32 v20, v1, 4, 3
v_mfma_f32_16x16x32_bf16 v[44:47], a[132:135], a[12:15], v[44:47]
s_add_u32 s70, s22, 94371840
ds_read_b128 a[64:67], v2 offset:16384
ds_read_b128 a[68:71], v3 offset:16384
v_mfma_f32_16x16x32_bf16 v[52:55], a[128:131], a[16:19], v[52:55]
s_lshr_b32 s22, s2, 4
ds_read_b64_tr_b16 a[140:141], v23 offset:16384
v_lshlrev_b32 v20, 3, v20
v_mfma_f32_16x16x32_bf16 v[52:55], a[132:135], a[20:23], v[52:55]
s_lshl_b32 s22, s22, 2
buffer_load_dwordx4 v17, s[12:15], s27 offen offset:1024 lds
v_mfma_f32_16x16x32_bf16 v[60:63], a[128:131], a[24:27], v[60:63]
s_add_u32 s66, s70, s22
ds_read_b64_tr_b16 a[142:143], v23 offset:18432
v_add_u32 v23, 32768, v23
v_mfma_f32_16x16x32_bf16 v[60:63], a[132:135], a[28:31], v[60:63]
s_and_b32 s22, s2, 16
buffer_store_dwordx4 v[48:51], v1, s[4:7], s31 offen sc1
v_mfma_f32_16x16x32_bf16 v[68:71], a[128:131], a[32:35], v[68:71]
s_add_u32 s31, s31, s32
ds_read_b128 a[72:75], v2 offset:18432
v_add_u32 v15, 2052, v20
v_mfma_f32_16x16x32_bf16 v[68:71], a[132:135], a[36:39], v[68:71]
s_lshl_b32 s22, s22, 7
buffer_load_dwordx4 v18, s[12:15], s27 offen offset:2048 lds
v_mfma_f32_16x16x32_bf16 v[76:79], a[128:131], a[40:43], v[76:79]
s_add_u32 s66, s66, s22
ds_read_b128 a[76:79], v3 offset:18432
v_mfma_f32_16x16x32_bf16 v[76:79], a[132:135], a[44:47], v[76:79]
s_lshl_b32 s67, s20, 20
ds_read_b128 a[80:83], v2 offset:20480
v_mfma_f32_16x16x32_bf16 v[84:87], a[128:131], a[48:51], v[84:87]
s_lshl_b32 s22, s37, 16
ds_read_b128 a[84:87], v3 offset:20480
v_mfma_f32_16x16x32_bf16 v[84:87], a[132:135], a[52:55], v[84:87]
s_add_u32 s67, s67, s22
buffer_load_dwordx4 v19, s[12:15], s27 offen offset:3072 lds
v_mfma_f32_16x16x32_bf16 v[92:95], a[128:131], a[56:59], v[92:95]
s_waitcnt lgkmcnt(4)
s_add_u32 s27, s27, 524288
ds_read_b128 a[88:91], v2 offset:22528
v_mfma_f32_16x16x32_bf16 v[92:95], a[132:135], a[60:63], v[92:95]
s_lshl_b32 s22, s3, 11
buffer_store_dwordx4 v[56:59], v1, s[4:7], s31 offen sc1
v_mfma_f32_16x16x32_bf16 v[100:103], a[136:139], a[0:3], v[100:103]
s_add_u32 s31, s31, s34
ds_read_b64_tr_b16 a[128:129], v24 offset:0
v_mfma_f32_16x16x32_bf16 v[100:103], a[140:143], a[4:7], v[100:103]
s_add_u32 s67, s67, s22
v_mfma_f32_16x16x32_bf16 v[108:111], a[136:139], a[8:11], v[108:111]
s_add_u32 s67, s67, 33554432
ds_read_b64_tr_b16 a[130:131], v24 offset:2048
v_mfma_f32_16x16x32_bf16 v[108:111], a[140:143], a[12:15], v[108:111]
s_mov_b32 s68, 1035512379
ds_read_b128 a[92:95], v3 offset:22528
v_mfma_f32_16x16x32_bf16 v[116:119], a[136:139], a[16:19], v[116:119]
s_mov_b32 s69, 1035512379
ds_read_b64_tr_b16 a[132:133], v24 offset:16384
v_mfma_f32_16x16x32_bf16 v[116:119], a[140:143], a[20:23], v[116:119]
buffer_store_dwordx4 v[64:67], v1, s[4:7], s31 offen sc1
v_mfma_f32_16x16x32_bf16 v[124:127], a[136:139], a[24:27], v[124:127]
s_add_u32 s31, s31, s32
ds_read_b64_tr_b16 a[134:135], v24 offset:18432
v_add_u32 v24, 32768, v24
v_mfma_f32_16x16x32_bf16 v[124:127], a[140:143], a[28:31], v[124:127]
v_mfma_f32_16x16x32_bf16 v[132:135], a[136:139], a[32:35], v[132:135]
ds_read_b128 a[96:99], v2 offset:24576
v_mfma_f32_16x16x32_bf16 v[132:135], a[140:143], a[36:39], v[132:135]
v_mfma_f32_16x16x32_bf16 v[140:143], a[136:139], a[40:43], v[140:143]
ds_read_b128 a[100:103], v3 offset:24576
v_mfma_f32_16x16x32_bf16 v[140:143], a[140:143], a[44:47], v[140:143]
ds_read_b128 a[104:107], v2 offset:26624
v_mfma_f32_16x16x32_bf16 v[148:151], a[136:139], a[48:51], v[148:151]
ds_read_b128 a[108:111], v3 offset:26624
v_mfma_f32_16x16x32_bf16 v[148:151], a[140:143], a[52:55], v[148:151]
v_mfma_f32_16x16x32_bf16 v[156:159], a[136:139], a[56:59], v[156:159]
ds_read_b128 a[112:115], v2 offset:28672
v_mfma_f32_16x16x32_bf16 v[156:159], a[140:143], a[60:63], v[156:159]
s_waitcnt lgkmcnt(4)
buffer_store_dwordx4 v[72:75], v1, s[4:7], s31 offen sc1
v_mfma_f32_16x16x32_bf16 v[164:167], a[128:131], a[0:3], v[164:167]
s_add_u32 s31, s31, s33
ds_read_b64_tr_b16 a[136:137], v25 offset:0
v_mfma_f32_16x16x32_bf16 v[164:167], a[132:135], a[4:7], v[164:167]
v_mfma_f32_16x16x32_bf16 v[172:175], a[128:131], a[8:11], v[172:175]
ds_read_b64_tr_b16 a[138:139], v25 offset:2048
v_mfma_f32_16x16x32_bf16 v[172:175], a[132:135], a[12:15], v[172:175]
ds_read_b128 a[116:119], v3 offset:28672
v_mfma_f32_16x16x32_bf16 v[180:183], a[128:131], a[16:19], v[180:183]
ds_read_b64_tr_b16 a[140:141], v25 offset:16384
v_mfma_f32_16x16x32_bf16 v[180:183], a[132:135], a[20:23], v[180:183]
v_mfma_f32_16x16x32_bf16 v[188:191], a[128:131], a[24:27], v[188:191]
ds_read_b64_tr_b16 a[142:143], v25 offset:18432
v_add_u32 v25, 32768, v25
v_mfma_f32_16x16x32_bf16 v[188:191], a[132:135], a[28:31], v[188:191]
v_mfma_f32_16x16x32_bf16 v[196:199], a[128:131], a[32:35], v[196:199]
ds_read_b128 a[120:123], v2 offset:30720
v_mfma_f32_16x16x32_bf16 v[196:199], a[132:135], a[36:39], v[196:199]
buffer_store_dwordx4 v[80:83], v1, s[4:7], s31 offen sc1
v_mfma_f32_16x16x32_bf16 v[204:207], a[128:131], a[40:43], v[204:207]
s_add_u32 s31, s31, s32
ds_read_b128 a[124:127], v3 offset:30720
v_mfma_f32_16x16x32_bf16 v[204:207], a[132:135], a[44:47], v[204:207]
v_mfma_f32_16x16x32_bf16 v[212:215], a[128:131], a[48:51], v[212:215]
v_mfma_f32_16x16x32_bf16 v[212:215], a[132:135], a[52:55], v[212:215]
v_mfma_f32_16x16x32_bf16 v[220:223], a[128:131], a[56:59], v[220:223]
v_mfma_f32_16x16x32_bf16 v[220:223], a[132:135], a[60:63], v[220:223]
s_waitcnt vmcnt(17) lgkmcnt(0)
s_barrier
v_mfma_f32_16x16x32_bf16 v[224:227], a[136:139], a[0:3], v[224:227]
ds_read_b64_tr_b16 a[128:129], v22 offset:0
v_mfma_f32_16x16x32_bf16 v[224:227], a[140:143], a[4:7], v[224:227]
v_mfma_f32_16x16x32_bf16 v[228:231], a[136:139], a[8:11], v[228:231]
ds_read_b64_tr_b16 a[130:131], v22 offset:2048
v_mfma_f32_16x16x32_bf16 v[228:231], a[140:143], a[12:15], v[228:231]
buffer_store_dwordx4 v[88:91], v1, s[4:7], s31 offen sc1
v_mfma_f32_16x16x32_bf16 v[232:235], a[136:139], a[16:19], v[232:235]
ds_read_b64_tr_b16 a[132:133], v22 offset:16384
v_mfma_f32_16x16x32_bf16 v[232:235], a[140:143], a[20:23], v[232:235]
v_mfma_f32_16x16x32_bf16 v[236:239], a[136:139], a[24:27], v[236:239]
ds_read_b64_tr_b16 a[134:135], v22 offset:18432
v_add_u32 v22, 32768, v22
v_mfma_f32_16x16x32_bf16 v[236:239], a[140:143], a[28:31], v[236:239]
v_mfma_f32_16x16x32_bf16 v[240:243], a[136:139], a[32:35], v[240:243]
v_mfma_f32_16x16x32_bf16 v[240:243], a[140:143], a[36:39], v[240:243]
v_mfma_f32_16x16x32_bf16 v[244:247], a[136:139], a[40:43], v[244:247]
v_mfma_f32_16x16x32_bf16 v[244:247], a[140:143], a[44:47], v[244:247]
v_mfma_f32_16x16x32_bf16 v[248:251], a[136:139], a[48:51], v[248:251]
v_mfma_f32_16x16x32_bf16 v[248:251], a[140:143], a[52:55], v[248:251]
v_mfma_f32_16x16x32_bf16 v[252:255], a[136:139], a[56:59], v[252:255]
v_mfma_f32_16x16x32_bf16 v[252:255], a[140:143], a[60:63], v[252:255]
s_waitcnt lgkmcnt(0)
v_mfma_f32_16x16x32_bf16 v[36:39], a[128:131], a[64:67], v[36:39]
ds_read_b64_tr_b16 a[136:137], v23 offset:0
v_mfma_f32_16x16x32_bf16 v[36:39], a[132:135], a[68:71], v[36:39]
v_mfma_f32_16x16x32_bf16 v[44:47], a[128:131], a[72:75], v[44:47]
s_mul_i32 s85, s20, 7
ds_read_b64_tr_b16 a[138:139], v23 offset:2048
v_mfma_f32_16x16x32_bf16 v[44:47], a[132:135], a[76:79], v[44:47]
s_add_u32 s85, s85, s21
ds_read_b128 a[0:3], v2 offset:32768
ds_read_b128 a[4:7], v3 offset:32768
v_mfma_f32_16x16x32_bf16 v[52:55], a[128:131], a[80:83], v[52:55]
s_lshl_b32 s85, s85, 2
ds_read_b64_tr_b16 a[140:141], v23 offset:16384
v_mfma_f32_16x16x32_bf16 v[52:55], a[132:135], a[84:87], v[52:55]
s_add_u32 s85, s85, s3
v_mfma_f32_16x16x32_bf16 v[60:63], a[128:131], a[88:91], v[60:63]
s_mul_i32 s82, s85, 4224
ds_read_b64_tr_b16 a[142:143], v23 offset:18432
v_add_u32 v23, 32768, v23
v_mfma_f32_16x16x32_bf16 v[60:63], a[132:135], a[92:95], v[60:63]
s_add_u32 s82, s82, 83886208
v_mfma_f32_16x16x32_bf16 v[68:71], a[128:131], a[96:99], v[68:71]
s_lshl_b32 s83, s85, 12
ds_read_b128 a[8:11], v2 offset:34816
v_mfma_f32_16x16x32_bf16 v[68:71], a[132:135], a[100:103], v[68:71]
s_mul_i32 s84, s3, 21248
v_mfma_f32_16x16x32_bf16 v[76:79], a[128:131], a[104:107], v[76:79]
s_add_u32 s84, s84, 46080
ds_read_b128 a[12:15], v3 offset:34816
v_mfma_f32_16x16x32_bf16 v[76:79], a[132:135], a[108:111], v[76:79]
s_mov_b64 s[60:61], s[72:73]
ds_read_b128 a[16:19], v2 offset:36864
v_mfma_f32_16x16x32_bf16 v[84:87], a[128:131], a[112:115], v[84:87]
s_mov_b32 s62, 1835008
ds_read_b128 a[20:23], v3 offset:36864
v_mfma_f32_16x16x32_bf16 v[84:87], a[132:135], a[116:119], v[84:87]
v_mfma_f32_16x16x32_bf16 v[92:95], a[128:131], a[120:123], v[92:95]
ds_read_b128 a[24:27], v2 offset:38912
v_mfma_f32_16x16x32_bf16 v[92:95], a[132:135], a[124:127], v[92:95]
s_waitcnt lgkmcnt(4)
v_mfma_f32_16x16x32_bf16 v[100:103], a[136:139], a[64:67], v[100:103]
ds_read_b64_tr_b16 a[128:129], v24 offset:0
v_mfma_f32_16x16x32_bf16 v[100:103], a[140:143], a[68:71], v[100:103]
v_mfma_f32_16x16x32_bf16 v[108:111], a[136:139], a[72:75], v[108:111]
ds_read_b64_tr_b16 a[130:131], v24 offset:2048
v_mfma_f32_16x16x32_bf16 v[108:111], a[140:143], a[76:79], v[108:111]
ds_read_b128 a[28:31], v3 offset:38912
v_mfma_f32_16x16x32_bf16 v[116:119], a[136:139], a[80:83], v[116:119]
ds_read_b64_tr_b16 a[132:133], v24 offset:16384
v_mfma_f32_16x16x32_bf16 v[116:119], a[140:143], a[84:87], v[116:119]
v_mfma_f32_16x16x32_bf16 v[124:127], a[136:139], a[88:91], v[124:127]
ds_read_b64_tr_b16 a[134:135], v24 offset:18432
v_add_u32 v24, 32768, v24
v_mfma_f32_16x16x32_bf16 v[124:127], a[140:143], a[92:95], v[124:127]
v_mfma_f32_16x16x32_bf16 v[132:135], a[136:139], a[96:99], v[132:135]
ds_read_b128 a[32:35], v2 offset:40960
v_mfma_f32_16x16x32_bf16 v[132:135], a[140:143], a[100:103], v[132:135]
v_mfma_f32_16x16x32_bf16 v[140:143], a[136:139], a[104:107], v[140:143]
ds_read_b128 a[36:39], v3 offset:40960
v_mfma_f32_16x16x32_bf16 v[140:143], a[140:143], a[108:111], v[140:143]
ds_read_b128 a[40:43], v2 offset:43008
v_mfma_f32_16x16x32_bf16 v[148:151], a[136:139], a[112:115], v[148:151]
ds_read_b128 a[44:47], v3 offset:43008
v_mfma_f32_16x16x32_bf16 v[148:151], a[140:143], a[116:119], v[148:151]
v_mfma_f32_16x16x32_bf16 v[156:159], a[136:139], a[120:123], v[156:159]
ds_read_b128 a[48:51], v2 offset:45056
v_mfma_f32_16x16x32_bf16 v[156:159], a[140:143], a[124:127], v[156:159]
s_waitcnt lgkmcnt(4)
v_mfma_f32_16x16x32_bf16 v[164:167], a[128:131], a[64:67], v[164:167]
ds_read_b64_tr_b16 a[136:137], v25 offset:0
v_mfma_f32_16x16x32_bf16 v[164:167], a[132:135], a[68:71], v[164:167]
v_mfma_f32_16x16x32_bf16 v[172:175], a[128:131], a[72:75], v[172:175]
ds_read_b64_tr_b16 a[138:139], v25 offset:2048
v_mfma_f32_16x16x32_bf16 v[172:175], a[132:135], a[76:79], v[172:175]
ds_read_b128 a[52:55], v3 offset:45056
v_mfma_f32_16x16x32_bf16 v[180:183], a[128:131], a[80:83], v[180:183]
ds_read_b64_tr_b16 a[140:141], v25 offset:16384
v_mfma_f32_16x16x32_bf16 v[180:183], a[132:135], a[84:87], v[180:183]
v_mfma_f32_16x16x32_bf16 v[188:191], a[128:131], a[88:91], v[188:191]
ds_read_b64_tr_b16 a[142:143], v25 offset:18432
v_add_u32 v25, 32768, v25
v_mfma_f32_16x16x32_bf16 v[188:191], a[132:135], a[92:95], v[188:191]
v_mfma_f32_16x16x32_bf16 v[196:199], a[128:131], a[96:99], v[196:199]
ds_read_b128 a[56:59], v2 offset:47104
v_mfma_f32_16x16x32_bf16 v[196:199], a[132:135], a[100:103], v[196:199]
v_mfma_f32_16x16x32_bf16 v[204:207], a[128:131], a[104:107], v[204:207]
ds_read_b128 a[60:63], v3 offset:47104
v_mfma_f32_16x16x32_bf16 v[204:207], a[132:135], a[108:111], v[204:207]
v_mfma_f32_16x16x32_bf16 v[212:215], a[128:131], a[112:115], v[212:215]
v_mfma_f32_16x16x32_bf16 v[212:215], a[132:135], a[116:119], v[212:215]
v_mfma_f32_16x16x32_bf16 v[220:223], a[128:131], a[120:123], v[220:223]
v_mfma_f32_16x16x32_bf16 v[220:223], a[132:135], a[124:127], v[220:223]
s_waitcnt vmcnt(0) lgkmcnt(0)
s_barrier
v_mfma_f32_16x16x32_bf16 v[224:227], a[136:139], a[64:67], v[224:227]
ds_read_b64_tr_b16 a[128:129], v22 offset:0
v_mfma_f32_16x16x32_bf16 v[224:227], a[140:143], a[68:71], v[224:227]
buffer_store_dword v27, v26, s[4:7], s66 offen sc1
v_mfma_f32_16x16x32_bf16 v[228:231], a[136:139], a[72:75], v[228:231]
ds_read_b64_tr_b16 a[130:131], v22 offset:2048
v_mfma_f32_16x16x32_bf16 v[228:231], a[140:143], a[76:79], v[228:231]
v_mfma_f32_16x16x32_bf16 v[232:235], a[136:139], a[80:83], v[232:235]
ds_read_b64_tr_b16 a[132:133], v22 offset:16384
v_mfma_f32_16x16x32_bf16 v[232:235], a[140:143], a[84:87], v[232:235]
v_mfma_f32_16x16x32_bf16 v[236:239], a[136:139], a[88:91], v[236:239]
ds_read_b64_tr_b16 a[134:135], v22 offset:18432
v_mfma_f32_16x16x32_bf16 v[236:239], a[140:143], a[92:95], v[236:239]
PAD_25:
s_cbranch_execz M_tret
v_mfma_f32_16x16x32_bf16 v[240:243], a[136:139], a[96:99], v[240:243]
v_mfma_f32_16x16x32_bf16 v[240:243], a[140:143], a[100:103], v[240:243]
v_mfma_f32_16x16x32_bf16 v[244:247], a[136:139], a[104:107], v[244:247]
v_mfma_f32_16x16x32_bf16 v[244:247], a[140:143], a[108:111], v[244:247]
v_mfma_f32_16x16x32_bf16 v[248:251], a[136:139], a[112:115], v[248:251]
v_mfma_f32_16x16x32_bf16 v[248:251], a[140:143], a[116:119], v[248:251]
v_mfma_f32_16x16x32_bf16 v[252:255], a[136:139], a[120:123], v[252:255]
v_mfma_f32_16x16x32_bf16 v[252:255], a[140:143], a[124:127], v[252:255]
s_waitcnt lgkmcnt(0)
v_mfma_f32_16x16x32_bf16 v[36:39], a[128:131], a[0:3], v[36:39]
s_add_u32 m0, s84, 17152
ds_read_b64_tr_b16 a[136:137], v23 offset:0
v_lshrrev_b32 v9, 4, v1
v_mfma_f32_16x16x32_bf16 v[36:39], a[132:135], a[4:7], v[36:39]
buffer_load_dwordx4 v1, s[60:63], s83 offen offset:0 lds
v_mfma_f32_16x16x32_bf16 v[44:47], a[128:131], a[8:11], v[44:47]
ds_read_b64_tr_b16 a[138:139], v23 offset:2048
v_and_b32 v10, 15, v9
v_mfma_f32_16x16x32_bf16 v[44:47], a[132:135], a[12:15], v[44:47]
buffer_load_dwordx4 v1, s[60:63], s83 offen offset:1024 lds
v_mfma_f32_16x16x32_bf16 v[52:55], a[128:131], a[16:19], v[52:55]
ds_read_b64_tr_b16 a[140:141], v23 offset:16384
v_lshrrev_b32 v11, 4, v9
v_mfma_f32_16x16x32_bf16 v[52:55], a[132:135], a[20:23], v[52:55]
buffer_load_dwordx4 v1, s[60:63], s83 offen offset:2048 lds
v_mfma_f32_16x16x32_bf16 v[60:63], a[128:131], a[24:27], v[60:63]
ds_read_b64_tr_b16 a[142:143], v23 offset:18432
v_lshrrev_b32 v12, 2, v10
v_mfma_f32_16x16x32_bf16 v[60:63], a[132:135], a[28:31], v[60:63]
buffer_load_dwordx4 v1, s[60:63], s83 offen offset:3072 lds
v_mfma_f32_16x16x32_bf16 v[68:71], a[128:131], a[32:35], v[68:71]
s_add_u32 m0, s84, 64
v_mul_u32_u24 v12, 4160, v12
v_and_b32 v13, 3, v9
v_mfma_f32_16x16x32_bf16 v[68:71], a[132:135], a[36:39], v[68:71]
buffer_load_dwordx4 v1, s[4:7], s82 offen offset:0 sc1 lds
v_mfma_f32_16x16x32_bf16 v[76:79], a[128:131], a[40:43], v[76:79]
buffer_load_dwordx4 v1, s[4:7], s82 offen offset:1024 sc1 lds
v_mfma_f32_16x16x32_bf16 v[76:79], a[132:135], a[44:47], v[76:79]
buffer_load_dwordx4 v1, s[4:7], s82 offen offset:2048 sc1 lds
v_mfma_f32_16x16x32_bf16 v[84:87], a[128:131], a[48:51], v[84:87]
buffer_load_dwordx4 v1, s[4:7], s82 offen offset:3072 sc1 lds
v_mfma_f32_16x16x32_bf16 v[84:87], a[132:135], a[52:55], v[84:87]
s_add_u32 s82, s82, 2097152
v_lshl_add_u32 v12, v13, 3, v12
v_lshlrev_b32 v13, 4, v11
v_mfma_f32_16x16x32_bf16 v[92:95], a[128:131], a[56:59], v[92:95]
s_add_u32 m0, s84, 4224
v_sub_u32 v12, v12, v13
v_add_u32 v12, 88, v12
v_mfma_f32_16x16x32_bf16 v[92:95], a[132:135], a[60:63], v[92:95]
s_waitcnt lgkmcnt(0)
buffer_load_dwordx4 v1, s[4:7], s82 offen offset:0 sc1 lds
v_mfma_f32_16x16x32_bf16 v[100:103], a[136:139], a[0:3], v[100:103]
ds_read_b64_tr_b16 a[128:129], v24 offset:0
v_add_u32 v16, s84, v12
v_mfma_f32_16x16x32_bf16 v[100:103], a[140:143], a[4:7], v[100:103]
buffer_load_dwordx4 v1, s[4:7], s82 offen offset:1024 sc1 lds
v_mfma_f32_16x16x32_bf16 v[108:111], a[136:139], a[8:11], v[108:111]
ds_read_b64_tr_b16 a[130:131], v24 offset:2048
v_lshl_add_u32 v12, v10, 5, v13
v_mfma_f32_16x16x32_bf16 v[108:111], a[140:143], a[12:15], v[108:111]
buffer_load_dwordx4 v1, s[4:7], s82 offen offset:2048 sc1 lds
v_mfma_f32_16x16x32_bf16 v[116:119], a[136:139], a[16:19], v[116:119]
ds_read_b64_tr_b16 a[132:133], v24 offset:16384
v_add_u32 v12, 16672, v12
v_mfma_f32_16x16x32_bf16 v[116:119], a[140:143], a[20:23], v[116:119]
buffer_load_dwordx4 v1, s[4:7], s82 offen offset:3072 sc1 lds
v_mfma_f32_16x16x32_bf16 v[124:127], a[136:139], a[24:27], v[124:127]
s_add_u32 s82, s82, 4292870140
ds_read_b64_tr_b16 a[134:135], v24 offset:18432
v_add_u32 v17, s84, v12
v_mfma_f32_16x16x32_bf16 v[124:127], a[140:143], a[28:31], v[124:127]
s_add_u32 m0, s84, 8384
v_lshlrev_b32 v12, 5, v10
v_lshl_add_u32 v8, v11, 3, v12
v_mfma_f32_16x16x32_bf16 v[132:135], a[136:139], a[32:35], v[132:135]
buffer_load_dwordx4 v1, s[4:7], s82 offen offset:0 sc1 lds
v_mfma_f32_16x16x32_bf16 v[132:135], a[140:143], a[36:39], v[132:135]
buffer_load_dwordx4 v1, s[4:7], s82 offen offset:1024 sc1 lds
v_mfma_f32_16x16x32_bf16 v[140:143], a[136:139], a[40:43], v[140:143]
buffer_load_dwordx4 v1, s[4:7], s82 offen offset:2048 sc1 lds
v_mfma_f32_16x16x32_bf16 v[140:143], a[140:143], a[44:47], v[140:143]
buffer_load_dwordx4 v1, s[4:7], s82 offen offset:3072 sc1 lds
v_mfma_f32_16x16x32_bf16 v[148:151], a[136:139], a[48:51], v[148:151]
s_add_u32 s82, s82, 2097152
v_add3_u32 v18, s84, 64, v8
v_mov_b32 v19, 0
v_mfma_f32_16x16x32_bf16 v[148:151], a[140:143], a[52:55], v[148:151]
s_add_u32 m0, s84, 12544
v_mov_b32 v12, 0
v_mov_b32 v13, 0
v_mfma_f32_16x16x32_bf16 v[156:159], a[136:139], a[56:59], v[156:159]
buffer_load_dwordx4 v1, s[4:7], s82 offen offset:0 sc1 lds
v_mfma_f32_16x16x32_bf16 v[156:159], a[140:143], a[60:63], v[156:159]
s_waitcnt lgkmcnt(0)
buffer_load_dwordx4 v1, s[4:7], s82 offen offset:1024 sc1 lds
v_mfma_f32_16x16x32_bf16 v[164:167], a[128:131], a[0:3], v[164:167]
ds_read_b64_tr_b16 a[136:137], v25 offset:0
v_lshl_add_u32 v14, v9, 3, s84
v_mfma_f32_16x16x32_bf16 v[164:167], a[132:135], a[4:7], v[164:167]
buffer_load_dwordx4 v1, s[4:7], s82 offen offset:2048 sc1 lds
v_mfma_f32_16x16x32_bf16 v[172:175], a[128:131], a[8:11], v[172:175]
ds_read_b64_tr_b16 a[138:139], v25 offset:2048
v_mfma_f32_16x16x32_bf16 v[172:175], a[132:135], a[12:15], v[172:175]
buffer_load_dwordx4 v1, s[4:7], s82 offen offset:3072 sc1 lds
v_mfma_f32_16x16x32_bf16 v[180:183], a[128:131], a[16:19], v[180:183]
ds_read_b64_tr_b16 a[140:141], v25 offset:16384
v_mfma_f32_16x16x32_bf16 v[180:183], a[132:135], a[20:23], v[180:183]
ds_write_b64 v14, v[12:13] offset:16640
v_mul_u32_u24 v14, 4160, v11
v_mfma_f32_16x16x32_bf16 v[188:191], a[128:131], a[24:27], v[188:191]
ds_read_b64_tr_b16 a[142:143], v25 offset:18432
v_lshl_add_u32 v14, v10, 2, v14
v_mfma_f32_16x16x32_bf16 v[188:191], a[132:135], a[28:31], v[188:191]
v_add_u32 v14, s84, v14
v_mfma_f32_16x16x32_bf16 v[196:199], a[128:131], a[32:35], v[196:199]
ds_write_b32 v14, v12
v_lshrrev_b32 v30, 6, v0
v_mfma_f32_16x16x32_bf16 v[196:199], a[132:135], a[36:39], v[196:199]
v_lshl_add_u32 v28, v30, 11, v1
v_add_u32 v29, 0x20000, v28
v_mfma_f32_16x16x32_bf16 v[204:207], a[128:131], a[40:43], v[204:207]
v_lshl_add_u32 v30, v30, 13, v1
v_add_u32 v31, 0x20000, v30
v_mfma_f32_16x16x32_bf16 v[204:207], a[132:135], a[44:47], v[204:207]
v_mul_f32 v36, s68, v36
v_mul_f32 v37, s68, v37
v_mfma_f32_16x16x32_bf16 v[212:215], a[128:131], a[48:51], v[212:215]
v_mul_f32 v38, s68, v38
v_mul_f32 v39, s68, v39
v_mfma_f32_16x16x32_bf16 v[212:215], a[132:135], a[52:55], v[212:215]
v_mul_f32 v100, s68, v100
v_mul_f32 v101, s68, v101
v_mfma_f32_16x16x32_bf16 v[220:223], a[128:131], a[56:59], v[220:223]
v_mul_f32 v102, s68, v102
v_mul_f32 v103, s68, v103
v_mfma_f32_16x16x32_bf16 v[220:223], a[132:135], a[60:63], v[220:223]
s_waitcnt lgkmcnt(0)
s_waitcnt lgkmcnt(0)
s_barrier
v_mfma_f32_16x16x32_bf16 v[224:227], a[136:139], a[0:3], v[224:227]
v_cvt_pk_bf16_f32 v36, v36, v37
v_cvt_pk_bf16_f32 v37, v38, v39
v_mfma_f32_16x16x32_bf16 v[224:227], a[140:143], a[4:7], v[224:227]
v_cvt_pk_bf16_f32 v38, v100, v101
v_cvt_pk_bf16_f32 v39, v102, v103
v_mfma_f32_16x16x32_bf16 v[228:231], a[136:139], a[8:11], v[228:231]
v_mul_f32 v44, s68, v44
v_mul_f32 v45, s68, v45
v_mfma_f32_16x16x32_bf16 v[228:231], a[140:143], a[12:15], v[228:231]
v_mul_f32 v46, s68, v46
v_mul_f32 v47, s68, v47
v_mfma_f32_16x16x32_bf16 v[232:235], a[136:139], a[16:19], v[232:235]
v_mul_f32 v108, s68, v108
v_mul_f32 v109, s68, v109
v_mfma_f32_16x16x32_bf16 v[232:235], a[140:143], a[20:23], v[232:235]
v_mul_f32 v110, s68, v110
v_mul_f32 v111, s68, v111
v_mfma_f32_16x16x32_bf16 v[236:239], a[136:139], a[24:27], v[236:239]
v_cvt_pk_bf16_f32 v44, v44, v45
v_cvt_pk_bf16_f32 v45, v46, v47
v_mfma_f32_16x16x32_bf16 v[236:239], a[140:143], a[28:31], v[236:239]
v_cvt_pk_bf16_f32 v46, v108, v109
v_cvt_pk_bf16_f32 v47, v110, v111
v_mfma_f32_16x16x32_bf16 v[240:243], a[136:139], a[32:35], v[240:243]
v_mul_f32 v52, s68, v52
v_mul_f32 v53, s68, v53
v_mfma_f32_16x16x32_bf16 v[240:243], a[140:143], a[36:39], v[240:243]
v_mul_f32 v54, s68, v54
v_mul_f32 v55, s68, v55
v_mfma_f32_16x16x32_bf16 v[244:247], a[136:139], a[40:43], v[244:247]
v_mul_f32 v116, s68, v116
v_mul_f32 v117, s68, v117
v_mfma_f32_16x16x32_bf16 v[244:247], a[140:143], a[44:47], v[244:247]
v_mul_f32 v118, s68, v118
v_mul_f32 v119, s68, v119
v_mfma_f32_16x16x32_bf16 v[248:251], a[136:139], a[48:51], v[248:251]
v_cvt_pk_bf16_f32 v52, v52, v53
v_cvt_pk_bf16_f32 v53, v54, v55
v_mfma_f32_16x16x32_bf16 v[248:251], a[140:143], a[52:55], v[248:251]
v_cvt_pk_bf16_f32 v54, v116, v117
v_cvt_pk_bf16_f32 v55, v118, v119
v_mfma_f32_16x16x32_bf16 v[252:255], a[136:139], a[56:59], v[252:255]
v_mfma_f32_16x16x32_bf16 v[252:255], a[140:143], a[60:63], v[252:255]
s_mov_b64 s[60:61], s[74:75]
s_mov_b32 s62, 896
s_lshl_b32 s79, s85, 1
buffer_load_short_d16_hi v19, off, s[60:63], s79
s_lshl_b32 s83, s85, 12
s_add_u32 s83, s83, 88080384
ds_write_b128 v28, v[36:39] offset:0
ds_write_b128 v28, v[44:47] offset:8192
ds_write_b128 v28, v[52:55] offset:16384
v_pk_mul_f32 v[60:61], v[60:61], s[68:69]
v_pk_mul_f32 v[62:63], v[62:63], s[68:69]
v_pk_mul_f32 v[124:125], v[124:125], s[68:69]
v_pk_mul_f32 v[126:127], v[126:127], s[68:69]
v_cvt_pk_bf16_f32 v60, v60, v61
v_cvt_pk_bf16_f32 v61, v62, v63
v_cvt_pk_bf16_f32 v62, v124, v125
v_cvt_pk_bf16_f32 v63, v126, v127
ds_write_b128 v28, v[60:63] offset:24576
v_pk_mul_f32 v[68:69], v[68:69], s[68:69]
v_pk_mul_f32 v[70:71], v[70:71], s[68:69]
v_pk_mul_f32 v[132:133], v[132:133], s[68:69]
v_pk_mul_f32 v[134:135], v[134:135], s[68:69]
v_cvt_pk_bf16_f32 v68, v68, v69
v_cvt_pk_bf16_f32 v69, v70, v71
v_cvt_pk_bf16_f32 v70, v132, v133
v_cvt_pk_bf16_f32 v71, v134, v135
ds_write_b128 v29, v[68:71] offset:0
v_pk_mul_f32 v[76:77], v[76:77], s[68:69]
v_pk_mul_f32 v[78:79], v[78:79], s[68:69]
v_pk_mul_f32 v[140:141], v[140:141], s[68:69]
v_pk_mul_f32 v[142:143], v[142:143], s[68:69]
v_cvt_pk_bf16_f32 v76, v76, v77
v_cvt_pk_bf16_f32 v77, v78, v79
v_cvt_pk_bf16_f32 v78, v140, v141
v_cvt_pk_bf16_f32 v79, v142, v143
ds_write_b128 v29, v[76:79] offset:8192
v_pk_mul_f32 v[84:85], v[84:85], s[68:69]
v_pk_mul_f32 v[86:87], v[86:87], s[68:69]
v_pk_mul_f32 v[148:149], v[148:149], s[68:69]
v_pk_mul_f32 v[150:151], v[150:151], s[68:69]
v_cvt_pk_bf16_f32 v84, v84, v85
v_cvt_pk_bf16_f32 v85, v86, v87
v_cvt_pk_bf16_f32 v86, v148, v149
v_cvt_pk_bf16_f32 v87, v150, v151
ds_write_b128 v29, v[84:87] offset:16384
v_pk_mul_f32 v[92:93], v[92:93], s[68:69]
v_pk_mul_f32 v[94:95], v[94:95], s[68:69]
v_pk_mul_f32 v[156:157], v[156:157], s[68:69]
v_pk_mul_f32 v[158:159], v[158:159], s[68:69]
v_cvt_pk_bf16_f32 v92, v92, v93
v_cvt_pk_bf16_f32 v93, v94, v95
v_cvt_pk_bf16_f32 v94, v156, v157
v_cvt_pk_bf16_f32 v95, v158, v159
ds_write_b128 v29, v[92:95] offset:24576
v_pk_mul_f32 v[164:165], v[164:165], s[68:69]
v_pk_mul_f32 v[166:167], v[166:167], s[68:69]
v_pk_mul_f32 v[224:225], v[224:225], s[68:69]
v_pk_mul_f32 v[226:227], v[226:227], s[68:69]
v_cvt_pk_bf16_f32 v164, v164, v165
v_cvt_pk_bf16_f32 v165, v166, v167
v_cvt_pk_bf16_f32 v166, v224, v225
v_cvt_pk_bf16_f32 v167, v226, v227
ds_write_b128 v28, v[164:167] offset:1024
v_pk_mul_f32 v[172:173], v[172:173], s[68:69]
v_pk_mul_f32 v[174:175], v[174:175], s[68:69]
v_pk_mul_f32 v[228:229], v[228:229], s[68:69]
v_pk_mul_f32 v[230:231], v[230:231], s[68:69]
v_cvt_pk_bf16_f32 v172, v172, v173
v_cvt_pk_bf16_f32 v173, v174, v175
v_cvt_pk_bf16_f32 v174, v228, v229
v_cvt_pk_bf16_f32 v175, v230, v231
ds_write_b128 v28, v[172:175] offset:9216
v_pk_mul_f32 v[180:181], v[180:181], s[68:69]
v_pk_mul_f32 v[182:183], v[182:183], s[68:69]
v_pk_mul_f32 v[232:233], v[232:233], s[68:69]
v_pk_mul_f32 v[234:235], v[234:235], s[68:69]
v_cvt_pk_bf16_f32 v180, v180, v181
v_cvt_pk_bf16_f32 v181, v182, v183
v_cvt_pk_bf16_f32 v182, v232, v233
v_cvt_pk_bf16_f32 v183, v234, v235
ds_write_b128 v28, v[180:183] offset:17408
v_pk_mul_f32 v[188:189], v[188:189], s[68:69]
v_pk_mul_f32 v[190:191], v[190:191], s[68:69]
v_pk_mul_f32 v[236:237], v[236:237], s[68:69]
v_pk_mul_f32 v[238:239], v[238:239], s[68:69]
v_cvt_pk_bf16_f32 v188, v188, v189
v_cvt_pk_bf16_f32 v189, v190, v191
v_cvt_pk_bf16_f32 v190, v236, v237
v_cvt_pk_bf16_f32 v191, v238, v239
ds_write_b128 v28, v[188:191] offset:25600
v_pk_mul_f32 v[196:197], v[196:197], s[68:69]
v_pk_mul_f32 v[198:199], v[198:199], s[68:69]
v_pk_mul_f32 v[240:241], v[240:241], s[68:69]
v_pk_mul_f32 v[242:243], v[242:243], s[68:69]
v_cvt_pk_bf16_f32 v196, v196, v197
v_cvt_pk_bf16_f32 v197, v198, v199
v_cvt_pk_bf16_f32 v198, v240, v241
v_cvt_pk_bf16_f32 v199, v242, v243
ds_write_b128 v29, v[196:199] offset:1024
v_pk_mul_f32 v[204:205], v[204:205], s[68:69]
v_pk_mul_f32 v[206:207], v[206:207], s[68:69]
v_pk_mul_f32 v[244:245], v[244:245], s[68:69]
v_pk_mul_f32 v[246:247], v[246:247], s[68:69]
v_cvt_pk_bf16_f32 v204, v204, v205
v_cvt_pk_bf16_f32 v205, v206, v207
v_cvt_pk_bf16_f32 v206, v244, v245
v_cvt_pk_bf16_f32 v207, v246, v247
ds_write_b128 v29, v[204:207] offset:9216
v_pk_mul_f32 v[212:213], v[212:213], s[68:69]
v_pk_mul_f32 v[214:215], v[214:215], s[68:69]
v_pk_mul_f32 v[248:249], v[248:249], s[68:69]
v_pk_mul_f32 v[250:251], v[250:251], s[68:69]
v_cvt_pk_bf16_f32 v212, v212, v213
v_cvt_pk_bf16_f32 v213, v214, v215
v_cvt_pk_bf16_f32 v214, v248, v249
v_cvt_pk_bf16_f32 v215, v250, v251
ds_write_b128 v29, v[212:215] offset:17408
v_pk_mul_f32 v[220:221], v[220:221], s[68:69]
v_pk_mul_f32 v[222:223], v[222:223], s[68:69]
v_pk_mul_f32 v[252:253], v[252:253], s[68:69]
v_pk_mul_f32 v[254:255], v[254:255], s[68:69]
v_cvt_pk_bf16_f32 v220, v220, v221
v_cvt_pk_bf16_f32 v221, v222, v223
v_cvt_pk_bf16_f32 v222, v252, v253
v_cvt_pk_bf16_f32 v223, v254, v255
ds_write_b128 v29, v[220:223] offset:25600
s_waitcnt vmcnt(1) lgkmcnt(0)
s_barrier
buffer_load_dword v21, v20, s[4:7], s70 offen sc1
ds_read_b64_tr_b16 a[64:65], v16 offset:8
ds_read_b64_tr_b16 a[66:67], v16 offset:0
ds_read_b128 a[96:99], v17 offset:448
ds_read_b64_tr_b16 a[68:69], v16 offset:520
ds_read_b64_tr_b16 a[70:71], v16 offset:512
ds_read_b128 a[100:103], v17 offset:960
ds_read_b64_tr_b16 a[72:73], v16 offset:1032
ds_read_b64_tr_b16 a[74:75], v16 offset:1024
ds_read_b128 a[104:107], v17 offset:1472
ds_read_b64_tr_b16 a[76:77], v16 offset:1544
ds_read_b64_tr_b16 a[78:79], v16 offset:1536
ds_read_b128 a[108:111], v17 offset:1984
ds_read_b64_tr_b16 a[80:81], v16 offset:2056
ds_read_b64_tr_b16 a[82:83], v16 offset:2048
ds_read_b128 a[112:115], v17 offset:2496
ds_read_b64_tr_b16 a[84:85], v16 offset:2568
ds_read_b64_tr_b16 a[86:87], v16 offset:2560
ds_read_b128 a[116:119], v17 offset:3008
ds_read_b64_tr_b16 a[88:89], v16 offset:3080
ds_read_b64_tr_b16 a[90:91], v16 offset:3072
ds_read_b128 a[120:123], v17 offset:3520
ds_read_b64_tr_b16 a[92:93], v16 offset:3592
ds_read_b64_tr_b16 a[94:95], v16 offset:3584
ds_read_b128 a[124:127], v17 offset:4032
s_waitcnt lgkmcnt(15)
v_mfma_f32_16x16x32_bf16 v[96:99], a[64:67], a[96:99], 0
s_waitcnt lgkmcnt(12)
s_lshl_b32 s18, s3, 13
ds_read_b64_tr_b16 a[128:129], v16 offset:72
v_mov_b32 v24, 0
v_mfma_f32_16x16x32_bf16 v[100:103], a[64:67], a[100:103], 0
s_lshl_b32 s30, s20, 20
ds_read_b64_tr_b16 a[130:131], v16 offset:64
v_lshrrev_b32 v3, 6, v0
v_mfma_f32_16x16x32_bf16 v[100:103], a[68:71], a[96:99], v[100:103]
s_add_u32 s30, s30, s18
ds_read_b128 a[160:163], v17 offset:384
v_and_b32 v4, 63, v0
v_mfma_f32_16x16x32_bf16 v[104:107], a[64:67], a[104:107], 0
s_lshl_b32 s22, s21, 1
ds_read_b128 a[192:195], v30 offset:0
v_add_u32 v2, 0x10000, v1
v_mfma_f32_16x16x32_bf16 v[104:107], a[68:71], a[100:103], v[104:107]
s_lshl_b32 s85, s21, 2
ds_read_b64_tr_b16 a[132:133], v16 offset:584
v_and_b32 v5, 15, v4
v_mfma_f32_16x16x32_bf16 v[104:107], a[72:75], a[96:99], v[104:107]
s_lshr_b32 s85, 2386092, s85
ds_read_b64_tr_b16 a[134:135], v16 offset:576
v_lshrrev_b32 v6, 4, v4
v_mfma_f32_16x16x32_bf16 v[108:111], a[64:67], a[108:111], 0
s_and_b32 s9, s85, 15
ds_read_b128 a[164:167], v17 offset:896
v_lshlrev_b32 v6, 2, v6
v_mfma_f32_16x16x32_bf16 v[108:111], a[68:71], a[104:107], v[108:111]
s_and_b32 s84, s85, 1
ds_read_b128 a[196:199], v30 offset:1024
v_sub_u32 v5, v5, v6
v_mfma_f32_16x16x32_bf16 v[108:111], a[72:75], a[100:103], v[108:111]
s_lshl_b32 s84, s84, 17
ds_read_b64_tr_b16 a[136:137], v16 offset:1096
v_lshl_add_u32 v5, v3, 4, v5
v_mfma_f32_16x16x32_bf16 v[108:111], a[76:79], a[96:99], v[108:111]
s_waitcnt lgkmcnt(6)
s_add_u32 s84, s84, s18
ds_read_b64_tr_b16 a[138:139], v16 offset:1088
v_cmp_gt_i32 s[32:33], 0, v5
v_mfma_f32_16x16x32_bf16 v[112:115], a[64:67], a[112:115], 0
s_xor_b32 s85, s84, 0x20000
ds_read_b128 a[168:171], v17 offset:1408
v_cmp_gt_i32 s[34:35], 1, v5
v_mfma_f32_16x16x32_bf16 v[112:115], a[68:71], a[108:111], v[112:115]
s_sub_u32 s29, 15, s21
ds_read_b128 a[200:203], v30 offset:2048
v_cmp_gt_i32 s[36:37], 2, v5
v_mfma_f32_16x16x32_bf16 v[112:115], a[72:75], a[104:107], v[112:115]
s_mov_b32 s8, s30
ds_read_b64_tr_b16 a[140:141], v16 offset:1608
v_cmp_gt_i32 s[38:39], 3, v5
v_mfma_f32_16x16x32_bf16 v[112:115], a[76:79], a[100:103], v[112:115]
s_add_u32 s11, s22, 2
ds_read_b64_tr_b16 a[142:143], v16 offset:1600
v_cmp_gt_i32 s[40:41], 16, v5
v_mfma_f32_16x16x32_bf16 v[112:115], a[80:83], a[96:99], v[112:115]
s_add_u32 s14, s30, 16777216
ds_read_b128 a[172:175], v17 offset:1920
v_cmp_gt_i32 s[42:43], 17, v5
v_mfma_f32_16x16x32_bf16 v[116:119], a[64:67], a[116:119], 0
s_lshr_b32 s19, s9, 1
ds_read_b128 a[204:207], v30 offset:3072
v_cmp_gt_i32 s[44:45], 18, v5
v_mfma_f32_16x16x32_bf16 v[116:119], a[68:71], a[112:115], v[116:119]
s_cmp_lg_u32 s9, 0
ds_read_b64_tr_b16 a[144:145], v16 offset:2120
v_cmp_gt_i32 s[46:47], 19, v5
v_mfma_f32_16x16x32_bf16 v[116:119], a[72:75], a[108:111], v[116:119]
s_cselect_b32 s10, s30, 3221225472
ds_read_b64_tr_b16 a[146:147], v16 offset:2112
v_cmp_gt_i32 s[48:49], 32, v5
v_mfma_f32_16x16x32_bf16 v[116:119], a[76:79], a[104:107], v[116:119]
s_cselect_b32 s14, s14, 3221225472
ds_read_b128 a[176:179], v17 offset:2432
v_cmp_gt_i32 s[50:51], 33, v5
v_mfma_f32_16x16x32_bf16 v[116:119], a[80:83], a[100:103], v[116:119]
s_cselect_b32 s9, s9, s11
ds_read_b128 a[208:211], v30 offset:4096
v_cmp_gt_i32 s[52:53], 34, v5
v_mfma_f32_16x16x32_bf16 v[116:119], a[84:87], a[96:99], v[116:119]
s_cselect_b32 s19, s19, s21
ds_read_b64_tr_b16 a[148:149], v16 offset:2632
v_cmp_gt_i32 s[54:55], 35, v5
v_mfma_f32_16x16x32_bf16 v[120:123], a[64:67], a[120:123], 0
s_cselect_b32 s29, s29, s21
ds_read_b64_tr_b16 a[150:151], v16 offset:2624
v_cmp_gt_i32 s[56:57], 48, v5
v_mfma_f32_16x16x32_bf16 v[120:123], a[68:71], a[116:119], v[120:123]
s_cselect_b32 s24, 2, 0
ds_read_b128 a[180:183], v17 offset:2944
v_cmp_gt_i32 s[58:59], 49, v5
v_mfma_f32_16x16x32_bf16 v[120:123], a[72:75], a[112:115], v[120:123]
s_add_u32 s12, s8, 16777216
ds_read_b128 a[212:215], v30 offset:5120
v_cmp_gt_i32 s[60:61], 50, v5
v_mfma_f32_16x16x32_bf16 v[120:123], a[76:79], a[108:111], v[120:123]
s_mov_b32 s13, s9
ds_read_b64_tr_b16 a[152:153], v16 offset:3144
v_cmp_gt_i32 s[62:63], 51, v5
v_mfma_f32_16x16x32_bf16 v[120:123], a[80:83], a[104:107], v[120:123]
s_mov_b32 s15, s11
ds_read_b64_tr_b16 a[154:155], v16 offset:3136
v_mov_b32 v7, 0xff800000
v_mfma_f32_16x16x32_bf16 v[120:123], a[84:87], a[100:103], v[120:123]
s_mov_b32 s25, 1266679808
ds_read_b128 a[184:187], v17 offset:3456
v_mov_b32 v6, 1
v_mfma_f32_16x16x32_bf16 v[120:123], a[88:91], a[96:99], v[120:123]
s_lshl_b32 s22, s21, 3
ds_read_b128 a[216:219], v30 offset:6144
v_mov_b32 v5, v26
v_mfma_f32_16x16x32_bf16 v[124:127], a[64:67], a[124:127], 0
s_add_u32 s28, s70, s22
ds_read_b64_tr_b16 a[156:157], v16 offset:3656
v_add_u32 v4, 0x20000, v1
v_mfma_f32_16x16x32_bf16 v[124:127], a[68:71], a[120:123], v[124:127]
s_add_u32 s28, s28, 6148
ds_read_b64_tr_b16 a[158:159], v16 offset:3648
v_mfma_f32_16x16x32_bf16 v[124:127], a[72:75], a[116:119], v[124:127]
s_lshl_b32 s26, s21, 16
ds_read_b128 a[188:191], v17 offset:3968
v_mfma_f32_16x16x32_bf16 v[124:127], a[76:79], a[112:115], v[124:127]
s_add_u32 s26, s26, s30
ds_read_b128 a[220:223], v30 offset:7168
v_mfma_f32_16x16x32_bf16 v[124:127], a[80:83], a[108:111], v[124:127]
s_add_u32 s26, s26, 33554432
ds_read_b128 a[224:227], v31 offset:0
v_mfma_f32_16x16x32_bf16 v[124:127], a[84:87], a[104:107], v[124:127]
s_lshl_b32 s76, s20, 3
ds_read_b128 a[228:231], v31 offset:1024
v_mfma_f32_16x16x32_bf16 v[124:127], a[88:91], a[100:103], v[124:127]
s_add_u32 s76, s76, s21
ds_read_b128 a[232:235], v31 offset:2048
v_mfma_f32_16x16x32_bf16 v[124:127], a[92:95], a[96:99], v[124:127]
s_lshl_b32 s76, s76, 2
ds_read_b128 a[236:239], v31 offset:3072
v_mfma_f32_16x16x32_bf16 v[96:99], a[128:131], a[160:163], v[96:99]
s_waitcnt lgkmcnt(6)
s_add_u32 s76, s76, s3
ds_read_b64_tr_b16 a[64:65], v16 offset:136
v_mfma_f32_16x16x32_bf16 v[100:103], a[128:131], a[164:167], v[100:103]
s_lshl_b32 s27, s76, 10
ds_read_b64_tr_b16 a[66:67], v16 offset:128
v_mfma_f32_16x16x32_bf16 v[100:103], a[132:135], a[160:163], v[100:103]
s_add_u32 s27, s27, 75497472
ds_read_b128 a[96:99], v17 offset:320
v_mfma_f32_16x16x32_bf16 v[104:107], a[128:131], a[168:171], v[104:107]
s_lshl_b32 s76, s76, 14
ds_read_b128 a[240:243], v31 offset:4096
v_mfma_f32_16x16x32_bf16 v[104:107], a[132:135], a[164:167], v[104:107]
s_add_u32 s76, s76, 67108864
ds_read_b64_tr_b16 a[68:69], v16 offset:648
v_mfma_f32_16x16x32_bf16 v[104:107], a[136:139], a[160:163], v[104:107]
s_lshl_b32 s81, s20, 2
ds_read_b64_tr_b16 a[70:71], v16 offset:640
v_mfma_f32_16x16x32_bf16 v[108:111], a[128:131], a[172:175], v[108:111]
s_add_u32 s81, s81, s3
ds_read_b128 a[100:103], v17 offset:832
v_mfma_f32_16x16x32_bf16 v[108:111], a[132:135], a[168:171], v[108:111]
s_mul_i32 s81, s81, 57344
ds_read_b128 a[244:247], v31 offset:5120
v_mfma_f32_16x16x32_bf16 v[108:111], a[136:139], a[164:167], v[108:111]
s_cmp_eq_u32 s24, 1
ds_read_b64_tr_b16 a[72:73], v16 offset:1160
v_mfma_f32_16x16x32_bf16 v[108:111], a[140:143], a[160:163], v[108:111]
s_cselect_b32 s80, s28, s70
ds_read_b64_tr_b16 a[74:75], v16 offset:1152
v_mfma_f32_16x16x32_bf16 v[112:115], a[128:131], a[176:179], v[112:115]
s_add_u32 s77, s76, 8192
ds_read_b128 a[104:107], v17 offset:1344
v_mfma_f32_16x16x32_bf16 v[112:115], a[132:135], a[172:175], v[112:115]
s_lshl_b32 s71, s2, 2
ds_read_b128 a[248:251], v31 offset:6144
v_mfma_f32_16x16x32_bf16 v[112:115], a[136:139], a[168:171], v[112:115]
s_add_u32 s71, s71, 94384128
ds_read_b64_tr_b16 a[76:77], v16 offset:1672
v_mfma_f32_16x16x32_bf16 v[112:115], a[140:143], a[164:167], v[112:115]
s_lshl_b32 s78, s29, 16
ds_read_b64_tr_b16 a[78:79], v16 offset:1664
v_mfma_f32_16x16x32_bf16 v[112:115], a[144:147], a[160:163], v[112:115]
s_add_u32 s78, s78, s30
ds_read_b128 a[108:111], v17 offset:1856
v_mfma_f32_16x16x32_bf16 v[116:119], a[128:131], a[180:183], v[116:119]
s_add_u32 s78, s78, 33554432
ds_read_b128 a[252:255], v31 offset:7168
v_mfma_f32_16x16x32_bf16 v[116:119], a[132:135], a[176:179], v[116:119]
s_cmp_eq_u32 s24, 0
ds_read_b64_tr_b16 a[80:81], v16 offset:2184
v_mfma_f32_16x16x32_bf16 v[116:119], a[136:139], a[172:175], v[116:119]
s_cselect_b32 s78, 3221225472, s78
ds_read_b64_tr_b16 a[82:83], v16 offset:2176
v_mfma_f32_16x16x32_bf16 v[116:119], a[140:143], a[168:171], v[116:119]
s_lshl_b32 s22, s21, 3
ds_read_b128 a[112:115], v17 offset:2368
v_mfma_f32_16x16x32_bf16 v[116:119], a[144:147], a[164:167], v[116:119]
s_add_u32 s22, s22, 16384
v_mfma_f32_16x16x32_bf16 v[116:119], a[148:151], a[160:163], v[116:119]
ds_read_b64_tr_b16 a[84:85], v16 offset:2696
v_writelane_b32 v15, s22, 63
v_mfma_f32_16x16x32_bf16 v[120:123], a[128:131], a[184:187], v[120:123]
ds_read_b64_tr_b16 a[86:87], v16 offset:2688
v_mov_b32 v25, 0
v_mfma_f32_16x16x32_bf16 v[120:123], a[132:135], a[180:183], v[120:123]
s_waitcnt vmcnt(0) lgkmcnt(5)
s_barrier
ds_read_b128 a[116:119], v17 offset:2880
v_cmp_gt_u32 vcc, 1, v21
v_mfma_f32_16x16x32_bf16 v[120:123], a[136:139], a[176:179], v[120:123]
s_cbranch_vccnz M_kspin2
M_kok2:
v_mov_b32 v128, 0
v_mov_b32 v129, 0
v_mfma_f32_16x16x32_bf16 v[120:123], a[140:143], a[172:175], v[120:123]
s_mov_b32 m0, s84
ds_read_b64_tr_b16 a[88:89], v16 offset:3208
v_mov_b32 v130, 0
v_mfma_f32_16x16x32_bf16 v[120:123], a[144:147], a[168:171], v[120:123]
ds_read_b64_tr_b16 a[90:91], v16 offset:3200
v_mov_b32 v131, 0
v_mfma_f32_16x16x32_bf16 v[120:123], a[148:151], a[164:167], v[120:123]
ds_read_b128 a[120:123], v17 offset:3392
v_mov_b32 v132, 0
v_mfma_f32_16x16x32_bf16 v[120:123], a[152:155], a[160:163], v[120:123]
buffer_load_dwordx4 v1, s[4:7], s8 offen offset:0 sc1 lds
v_mfma_f32_16x16x32_bf16 v[124:127], a[128:131], a[188:191], v[124:127]
ds_read_b64_tr_b16 a[92:93], v16 offset:3720
v_mov_b32 v133, 0
v_mfma_f32_16x16x32_bf16 v[124:127], a[132:135], a[184:187], v[124:127]
PAD_26:
s_cbranch_execz M_tret
ds_read_b64_tr_b16 a[94:95], v16 offset:3712
v_mov_b32 v134, 0
v_mfma_f32_16x16x32_bf16 v[124:127], a[136:139], a[180:183], v[124:127]
ds_read_b128 a[124:127], v17 offset:3904
v_mov_b32 v135, 0
v_mfma_f32_16x16x32_bf16 v[124:127], a[140:143], a[176:179], v[124:127]
buffer_load_dwordx4 v1, s[4:7], s8 offen offset:1024 sc1 lds
v_mfma_f32_16x16x32_bf16 v[124:127], a[144:147], a[172:175], v[124:127]
buffer_load_dwordx4 v1, s[4:7], s8 offen offset:2048 sc1 lds
v_mfma_f32_16x16x32_bf16 v[124:127], a[148:151], a[168:171], v[124:127]
buffer_load_dwordx4 v1, s[4:7], s8 offen offset:3072 sc1 lds
v_mfma_f32_16x16x32_bf16 v[124:127], a[152:155], a[164:167], v[124:127]
s_add_u32 s8, s8, 4096
v_mov_b32 v136, 0
v_mov_b32 v137, 0
v_mfma_f32_16x16x32_bf16 v[124:127], a[156:159], a[160:163], v[124:127]
s_add_u32 m0, s84, 4096
v_mov_b32 v138, 0
v_mov_b32 v139, 0
v_mfma_f32_16x16x32_bf16 v[96:99], a[64:67], a[96:99], v[96:99]
ds_read_b64_tr_b16 a[128:129], v16 offset:200
v_mov_b32 v140, 0
v_mfma_f32_16x16x32_bf16 v[100:103], a[64:67], a[100:103], v[100:103]
ds_read_b64_tr_b16 a[130:131], v16 offset:192
v_mov_b32 v141, 0
v_mfma_f32_16x16x32_bf16 v[100:103], a[68:71], a[96:99], v[100:103]
ds_read_b128 a[160:163], v17 offset:256
v_mov_b32 v142, 0
v_mfma_f32_16x16x32_bf16 v[104:107], a[64:67], a[104:107], v[104:107]
buffer_load_dwordx4 v1, s[4:7], s8 offen offset:0 sc1 lds
v_mfma_f32_16x16x32_bf16 v[104:107], a[68:71], a[100:103], v[104:107]
ds_read_b64_tr_b16 a[132:133], v16 offset:712
v_mov_b32 v143, 0
v_mfma_f32_16x16x32_bf16 v[104:107], a[72:75], a[96:99], v[104:107]
ds_read_b64_tr_b16 a[134:135], v16 offset:704
v_mov_b32 v144, 0
v_mfma_f32_16x16x32_bf16 v[108:111], a[64:67], a[108:111], v[108:111]
ds_read_b128 a[164:167], v17 offset:768
v_mov_b32 v145, 0
v_mfma_f32_16x16x32_bf16 v[108:111], a[68:71], a[104:107], v[108:111]
buffer_load_dwordx4 v1, s[4:7], s8 offen offset:1024 sc1 lds
v_mfma_f32_16x16x32_bf16 v[108:111], a[72:75], a[100:103], v[108:111]
ds_read_b64_tr_b16 a[136:137], v16 offset:1224
v_mov_b32 v146, 0
v_mfma_f32_16x16x32_bf16 v[108:111], a[76:79], a[96:99], v[108:111]
s_waitcnt lgkmcnt(4)
ds_read_b64_tr_b16 a[138:139], v16 offset:1216
v_mov_b32 v147, 0
v_mfma_f32_16x16x32_bf16 v[112:115], a[64:67], a[112:115], v[112:115]
ds_read_b128 a[168:171], v17 offset:1280
v_mov_b32 v148, 0
v_mfma_f32_16x16x32_bf16 v[112:115], a[68:71], a[108:111], v[112:115]
buffer_load_dwordx4 v1, s[4:7], s8 offen offset:2048 sc1 lds
v_mfma_f32_16x16x32_bf16 v[112:115], a[72:75], a[104:107], v[112:115]
ds_read_b64_tr_b16 a[140:141], v16 offset:1736
v_mov_b32 v149, 0
v_mfma_f32_16x16x32_bf16 v[112:115], a[76:79], a[100:103], v[112:115]
ds_read_b64_tr_b16 a[142:143], v16 offset:1728
v_mov_b32 v150, 0
v_mfma_f32_16x16x32_bf16 v[112:115], a[80:83], a[96:99], v[112:115]
ds_read_b128 a[172:175], v17 offset:1792
v_mov_b32 v151, 0
v_mfma_f32_16x16x32_bf16 v[116:119], a[64:67], a[116:119], v[116:119]
buffer_load_dwordx4 v1, s[4:7], s8 offen offset:3072 sc1 lds
v_mfma_f32_16x16x32_bf16 v[116:119], a[68:71], a[112:115], v[116:119]
s_add_u32 s8, s8, 28672
ds_read_b64_tr_b16 a[144:145], v16 offset:2248
v_mov_b32 v152, 0
v_mfma_f32_16x16x32_bf16 v[116:119], a[72:75], a[108:111], v[116:119]
s_sub_u32 s9, s9, 1
ds_read_b64_tr_b16 a[146:147], v16 offset:2240
v_mov_b32 v153, 0
v_mfma_f32_16x16x32_bf16 v[116:119], a[76:79], a[104:107], v[116:119]
s_cmp_eq_u32 s9, 0
ds_read_b128 a[176:179], v17 offset:2304
v_mov_b32 v154, 0
v_mfma_f32_16x16x32_bf16 v[116:119], a[80:83], a[100:103], v[116:119]
s_cselect_b32 s8, s10, s8
v_mov_b32 v155, 0
v_mov_b32 v156, 0
v_mfma_f32_16x16x32_bf16 v[116:119], a[84:87], a[96:99], v[116:119]
s_cselect_b32 s9, s11, s9
ds_read_b64_tr_b16 a[148:149], v16 offset:2760
v_mov_b32 v157, 0
v_mfma_f32_16x16x32_bf16 v[120:123], a[64:67], a[120:123], v[120:123]
s_cselect_b32 s10, 3221225472, s10
ds_read_b64_tr_b16 a[150:151], v16 offset:2752
v_mov_b32 v158, 0
v_mfma_f32_16x16x32_bf16 v[120:123], a[68:71], a[116:119], v[120:123]
s_mov_b32 m0, s85
ds_read_b128 a[180:183], v17 offset:2816
v_mov_b32 v159, 0
v_mfma_f32_16x16x32_bf16 v[120:123], a[72:75], a[112:115], v[120:123]
buffer_load_dwordx4 v1, s[4:7], s8 offen offset:0 sc1 lds
v_mfma_f32_16x16x32_bf16 v[120:123], a[76:79], a[108:111], v[120:123]
ds_read_b64_tr_b16 a[152:153], v16 offset:3272
v_mov_b32 v160, 0
v_mfma_f32_16x16x32_bf16 v[120:123], a[80:83], a[104:107], v[120:123]
ds_read_b64_tr_b16 a[154:155], v16 offset:3264
v_mov_b32 v161, 0
v_mfma_f32_16x16x32_bf16 v[120:123], a[84:87], a[100:103], v[120:123]
ds_read_b128 a[184:187], v17 offset:3328
v_mov_b32 v162, 0
v_mfma_f32_16x16x32_bf16 v[120:123], a[88:91], a[96:99], v[120:123]
buffer_load_dwordx4 v1, s[4:7], s8 offen offset:1024 sc1 lds
v_mfma_f32_16x16x32_bf16 v[124:127], a[64:67], a[124:127], v[124:127]
ds_read_b64_tr_b16 a[156:157], v16 offset:3784
v_mov_b32 v163, 0
v_mfma_f32_16x16x32_bf16 v[124:127], a[68:71], a[120:123], v[124:127]
ds_read_b64_tr_b16 a[158:159], v16 offset:3776
v_mov_b32 v164, 0
v_mfma_f32_16x16x32_bf16 v[124:127], a[72:75], a[116:119], v[124:127]
ds_read_b128 a[188:191], v17 offset:3840
v_mov_b32 v165, 0
v_mfma_f32_16x16x32_bf16 v[124:127], a[76:79], a[112:115], v[124:127]
buffer_load_dwordx4 v1, s[4:7], s8 offen offset:2048 sc1 lds
v_mfma_f32_16x16x32_bf16 v[124:127], a[80:83], a[108:111], v[124:127]
buffer_load_dwordx4 v1, s[4:7], s8 offen offset:3072 sc1 lds
v_mfma_f32_16x16x32_bf16 v[124:127], a[84:87], a[104:107], v[124:127]
s_add_u32 s8, s8, 4096
v_mov_b32 v166, 0
v_mov_b32 v167, 0
v_mfma_f32_16x16x32_bf16 v[124:127], a[88:91], a[100:103], v[124:127]
s_add_u32 m0, s85, 4096
v_mov_b32 v168, 0
v_mov_b32 v169, 0
v_mfma_f32_16x16x32_bf16 v[124:127], a[92:95], a[96:99], v[124:127]
buffer_load_dwordx4 v1, s[4:7], s8 offen offset:0 sc1 lds
v_mfma_f32_16x16x32_bf16 v[96:99], a[128:131], a[160:163], v[96:99]
s_waitcnt lgkmcnt(1)
ds_read_b64_tr_b16 a[64:65], v16 offset:264
v_mov_b32 v170, 0
v_mfma_f32_16x16x32_bf16 v[100:103], a[128:131], a[164:167], v[100:103]
ds_read_b64_tr_b16 a[66:67], v16 offset:256
v_mov_b32 v171, 0
v_mfma_f32_16x16x32_bf16 v[100:103], a[132:135], a[160:163], v[100:103]
ds_read_b128 a[96:99], v17 offset:192
v_mov_b32 v172, 0
v_mfma_f32_16x16x32_bf16 v[104:107], a[128:131], a[168:171], v[104:107]
buffer_load_dwordx4 v1, s[4:7], s8 offen offset:1024 sc1 lds
v_mfma_f32_16x16x32_bf16 v[104:107], a[132:135], a[164:167], v[104:107]
ds_read_b64_tr_b16 a[68:69], v16 offset:776
v_mov_b32 v173, 0
v_mfma_f32_16x16x32_bf16 v[104:107], a[136:139], a[160:163], v[104:107]
ds_read_b64_tr_b16 a[70:71], v16 offset:768
v_mov_b32 v174, 0
v_mfma_f32_16x16x32_bf16 v[108:111], a[128:131], a[172:175], v[108:111]
ds_read_b128 a[100:103], v17 offset:704
v_mov_b32 v175, 0
v_mfma_f32_16x16x32_bf16 v[108:111], a[132:135], a[168:171], v[108:111]
buffer_load_dwordx4 v1, s[4:7], s8 offen offset:2048 sc1 lds
v_mfma_f32_16x16x32_bf16 v[108:111], a[136:139], a[164:167], v[108:111]
ds_read_b64_tr_b16 a[72:73], v16 offset:1288
v_mov_b32 v176, 0
v_mfma_f32_16x16x32_bf16 v[108:111], a[140:143], a[160:163], v[108:111]
ds_read_b64_tr_b16 a[74:75], v16 offset:1280
v_mov_b32 v177, 0
v_mfma_f32_16x16x32_bf16 v[112:115], a[128:131], a[176:179], v[112:115]
ds_read_b128 a[104:107], v17 offset:1216
v_mov_b32 v178, 0
v_mfma_f32_16x16x32_bf16 v[112:115], a[132:135], a[172:175], v[112:115]
buffer_load_dwordx4 v1, s[4:7], s8 offen offset:3072 sc1 lds
v_mfma_f32_16x16x32_bf16 v[112:115], a[136:139], a[168:171], v[112:115]
s_add_u32 s8, s8, 28672
ds_read_b64_tr_b16 a[76:77], v16 offset:1800
v_mov_b32 v179, 0
v_mfma_f32_16x16x32_bf16 v[112:115], a[140:143], a[164:167], v[112:115]
s_sub_u32 s9, s9, 1
ds_read_b64_tr_b16 a[78:79], v16 offset:1792
v_mov_b32 v180, 0
v_mfma_f32_16x16x32_bf16 v[112:115], a[144:147], a[160:163], v[112:115]
s_cmp_eq_u32 s9, 0
ds_read_b128 a[108:111], v17 offset:1728
v_mov_b32 v181, 0
v_mfma_f32_16x16x32_bf16 v[116:119], a[128:131], a[180:183], v[116:119]
s_cselect_b32 s8, s10, s8
buffer_load_dword v14, v15, s[4:7], s70 offen sc1
v_mfma_f32_16x16x32_bf16 v[116:119], a[132:135], a[176:179], v[116:119]
s_cselect_b32 s9, s11, s9
ds_read_b64_tr_b16 a[80:81], v16 offset:2312
v_mov_b32 v182, 0
v_mfma_f32_16x16x32_bf16 v[116:119], a[136:139], a[172:175], v[116:119]
s_cselect_b32 s10, 3221225472, s10
ds_read_b64_tr_b16 a[82:83], v16 offset:2304
v_mov_b32 v183, 0
v_mfma_f32_16x16x32_bf16 v[116:119], a[140:143], a[168:171], v[116:119]
ds_read_b128 a[112:115], v17 offset:2240
v_mov_b32 v184, 0
v_mfma_f32_16x16x32_bf16 v[116:119], a[144:147], a[164:167], v[116:119]
v_mov_b32 v185, 0
v_mov_b32 v186, 0
v_mfma_f32_16x16x32_bf16 v[116:119], a[148:151], a[160:163], v[116:119]
ds_read_b64_tr_b16 a[84:85], v16 offset:2824
v_mov_b32 v187, 0
v_mfma_f32_16x16x32_bf16 v[120:123], a[128:131], a[184:187], v[120:123]
ds_read_b64_tr_b16 a[86:87], v16 offset:2816
v_mov_b32 v188, 0
v_mfma_f32_16x16x32_bf16 v[120:123], a[132:135], a[180:183], v[120:123]
ds_read_b128 a[116:119], v17 offset:2752
v_mov_b32 v189, 0
v_mfma_f32_16x16x32_bf16 v[120:123], a[136:139], a[176:179], v[120:123]
v_mov_b32 v190, 0
v_mov_b32 v191, 0
v_mfma_f32_16x16x32_bf16 v[120:123], a[140:143], a[172:175], v[120:123]
ds_read_b64_tr_b16 a[88:89], v16 offset:3336
v_mov_b32 v192, 0
v_mfma_f32_16x16x32_bf16 v[120:123], a[144:147], a[168:171], v[120:123]
ds_read_b64_tr_b16 a[90:91], v16 offset:3328
v_mov_b32 v193, 0
v_mfma_f32_16x16x32_bf16 v[120:123], a[148:151], a[164:167], v[120:123]
ds_read_b128 a[120:123], v17 offset:3264
v_mov_b32 v194, 0
v_mfma_f32_16x16x32_bf16 v[120:123], a[152:155], a[160:163], v[120:123]
s_waitcnt lgkmcnt(5)
v_mov_b32 v195, 0
v_mov_b32 v196, 0
v_mfma_f32_16x16x32_bf16 v[124:127], a[128:131], a[188:191], v[124:127]
ds_read_b64_tr_b16 a[92:93], v16 offset:3848
v_mov_b32 v197, 0
v_mfma_f32_16x16x32_bf16 v[124:127], a[132:135], a[184:187], v[124:127]
ds_read_b64_tr_b16 a[94:95], v16 offset:3840
v_mov_b32 v198, 0
v_mfma_f32_16x16x32_bf16 v[124:127], a[136:139], a[180:183], v[124:127]
ds_read_b128 a[124:127], v17 offset:3776
v_mov_b32 v199, 0
v_mfma_f32_16x16x32_bf16 v[124:127], a[140:143], a[176:179], v[124:127]
v_mov_b32 v200, 0
v_mov_b32 v201, 0
v_mfma_f32_16x16x32_bf16 v[124:127], a[144:147], a[172:175], v[124:127]
v_mov_b32 v202, 0
v_mov_b32 v203, 0
v_mfma_f32_16x16x32_bf16 v[124:127], a[148:151], a[168:171], v[124:127]
v_mov_b32 v204, 0
v_mov_b32 v205, 0
v_mfma_f32_16x16x32_bf16 v[124:127], a[152:155], a[164:167], v[124:127]
v_mov_b32 v206, 0
v_mov_b32 v207, 0
v_mfma_f32_16x16x32_bf16 v[124:127], a[156:159], a[160:163], v[124:127]
v_mov_b32 v208, 0
v_mov_b32 v209, 0
s_waitcnt vmcnt(0)
v_cmp_gt_u32 vcc, 1, v14
s_cbranch_vccnz M_cspin
M_cok:
v_mfma_f32_16x16x32_bf16 v[96:99], a[64:67], a[96:99], v[96:99]
s_add_u32 s22, s78, 0
ds_read_b64_tr_b16 a[128:129], v16 offset:328
v_mov_b32 v210, 0
v_mfma_f32_16x16x32_bf16 v[100:103], a[64:67], a[100:103], v[100:103]
ds_read_b64_tr_b16 a[130:131], v16 offset:320
v_mov_b32 v211, 0
v_mfma_f32_16x16x32_bf16 v[100:103], a[68:71], a[96:99], v[100:103]
ds_read_b128 a[160:163], v17 offset:128
v_mov_b32 v212, 0
v_mfma_f32_16x16x32_bf16 v[104:107], a[64:67], a[104:107], v[104:107]
buffer_load_dwordx4 a[0:3], v1, s[4:7], s22 offen offset:0 sc1
v_mfma_f32_16x16x32_bf16 v[104:107], a[68:71], a[100:103], v[104:107]
ds_read_b64_tr_b16 a[132:133], v16 offset:840
v_mov_b32 v213, 0
v_mfma_f32_16x16x32_bf16 v[104:107], a[72:75], a[96:99], v[104:107]
ds_read_b64_tr_b16 a[134:135], v16 offset:832
v_mov_b32 v214, 0
v_mfma_f32_16x16x32_bf16 v[108:111], a[64:67], a[108:111], v[108:111]
ds_read_b128 a[164:167], v17 offset:640
v_mov_b32 v215, 0
v_mfma_f32_16x16x32_bf16 v[108:111], a[68:71], a[104:107], v[108:111]
buffer_load_dwordx4 a[4:7], v1, s[4:7], s22 offen offset:1024 sc1
v_mfma_f32_16x16x32_bf16 v[108:111], a[72:75], a[100:103], v[108:111]
ds_read_b64_tr_b16 a[136:137], v16 offset:1352
v_mov_b32 v216, 0
v_mfma_f32_16x16x32_bf16 v[108:111], a[76:79], a[96:99], v[108:111]
ds_read_b64_tr_b16 a[138:139], v16 offset:1344
v_mov_b32 v217, 0
v_mfma_f32_16x16x32_bf16 v[112:115], a[64:67], a[112:115], v[112:115]
ds_read_b128 a[168:171], v17 offset:1152
v_mov_b32 v218, 0
v_mfma_f32_16x16x32_bf16 v[112:115], a[68:71], a[108:111], v[112:115]
buffer_load_dwordx4 a[8:11], v1, s[4:7], s22 offen offset:2048 sc1
v_mfma_f32_16x16x32_bf16 v[112:115], a[72:75], a[104:107], v[112:115]
ds_read_b64_tr_b16 a[140:141], v16 offset:1864
v_mov_b32 v219, 0
v_mfma_f32_16x16x32_bf16 v[112:115], a[76:79], a[100:103], v[112:115]
ds_read_b64_tr_b16 a[142:143], v16 offset:1856
v_mov_b32 v220, 0
v_mfma_f32_16x16x32_bf16 v[112:115], a[80:83], a[96:99], v[112:115]
s_waitcnt lgkmcnt(5)
ds_read_b128 a[172:175], v17 offset:1664
v_mov_b32 v221, 0
v_mfma_f32_16x16x32_bf16 v[116:119], a[64:67], a[116:119], v[116:119]
buffer_load_dwordx4 a[12:15], v1, s[4:7], s22 offen offset:3072 sc1
v_mfma_f32_16x16x32_bf16 v[116:119], a[68:71], a[112:115], v[116:119]
s_add_u32 s22, s78, 4096
ds_read_b64_tr_b16 a[144:145], v16 offset:2376
v_mov_b32 v222, 0
v_mfma_f32_16x16x32_bf16 v[116:119], a[72:75], a[108:111], v[116:119]
ds_read_b64_tr_b16 a[146:147], v16 offset:2368
v_mov_b32 v223, 0
v_mfma_f32_16x16x32_bf16 v[116:119], a[76:79], a[104:107], v[116:119]
ds_read_b128 a[176:179], v17 offset:2176
v_mov_b32 v224, 0
v_mfma_f32_16x16x32_bf16 v[116:119], a[80:83], a[100:103], v[116:119]
buffer_load_dwordx4 a[16:19], v1, s[4:7], s22 offen offset:0 sc1
v_mfma_f32_16x16x32_bf16 v[116:119], a[84:87], a[96:99], v[116:119]
ds_read_b64_tr_b16 a[148:149], v16 offset:2888
v_mov_b32 v225, 0
v_mfma_f32_16x16x32_bf16 v[120:123], a[64:67], a[120:123], v[120:123]
ds_read_b64_tr_b16 a[150:151], v16 offset:2880
v_mov_b32 v226, 0
v_mfma_f32_16x16x32_bf16 v[120:123], a[68:71], a[116:119], v[120:123]
ds_read_b128 a[180:183], v17 offset:2688
v_mov_b32 v227, 0
v_mfma_f32_16x16x32_bf16 v[120:123], a[72:75], a[112:115], v[120:123]
buffer_load_dwordx4 a[20:23], v1, s[4:7], s22 offen offset:1024 sc1
v_mfma_f32_16x16x32_bf16 v[120:123], a[76:79], a[108:111], v[120:123]
ds_read_b64_tr_b16 a[152:153], v16 offset:3400
v_mov_b32 v228, 0
v_mfma_f32_16x16x32_bf16 v[120:123], a[80:83], a[104:107], v[120:123]
ds_read_b64_tr_b16 a[154:155], v16 offset:3392
v_mov_b32 v229, 0
v_mfma_f32_16x16x32_bf16 v[120:123], a[84:87], a[100:103], v[120:123]
ds_read_b128 a[184:187], v17 offset:3200
v_mov_b32 v230, 0
v_mfma_f32_16x16x32_bf16 v[120:123], a[88:91], a[96:99], v[120:123]
buffer_load_dwordx4 a[24:27], v1, s[4:7], s22 offen offset:2048 sc1
v_mfma_f32_16x16x32_bf16 v[124:127], a[64:67], a[124:127], v[124:127]
ds_read_b64_tr_b16 a[156:157], v16 offset:3912
v_mov_b32 v231, 0
v_mfma_f32_16x16x32_bf16 v[124:127], a[68:71], a[120:123], v[124:127]
ds_read_b64_tr_b16 a[158:159], v16 offset:3904
v_mov_b32 v232, 0
v_mfma_f32_16x16x32_bf16 v[124:127], a[72:75], a[116:119], v[124:127]
ds_read_b128 a[188:191], v17 offset:3712
v_mov_b32 v233, 0
v_mfma_f32_16x16x32_bf16 v[124:127], a[76:79], a[112:115], v[124:127]
buffer_load_dwordx4 a[28:31], v1, s[4:7], s22 offen offset:3072 sc1
v_mfma_f32_16x16x32_bf16 v[124:127], a[80:83], a[108:111], v[124:127]
s_add_u32 s22, s78, 32768
buffer_load_dwordx4 a[32:35], v1, s[4:7], s22 offen offset:0 sc1
v_mfma_f32_16x16x32_bf16 v[124:127], a[84:87], a[104:107], v[124:127]
buffer_load_dwordx4 a[36:39], v1, s[4:7], s22 offen offset:1024 sc1
v_mfma_f32_16x16x32_bf16 v[124:127], a[88:91], a[100:103], v[124:127]
buffer_load_dwordx4 a[40:43], v1, s[4:7], s22 offen offset:2048 sc1
v_mfma_f32_16x16x32_bf16 v[124:127], a[92:95], a[96:99], v[124:127]
buffer_load_dwordx4 a[44:47], v1, s[4:7], s22 offen offset:3072 sc1
v_mfma_f32_16x16x32_bf16 v[96:99], a[128:131], a[160:163], v[96:99]
s_add_u32 s22, s78, 36864
ds_read_b64_tr_b16 a[64:65], v16 offset:392
v_mov_b32 v234, 0
v_mfma_f32_16x16x32_bf16 v[100:103], a[128:131], a[164:167], v[100:103]
ds_read_b64_tr_b16 a[66:67], v16 offset:384
v_mov_b32 v235, 0
v_mfma_f32_16x16x32_bf16 v[100:103], a[132:135], a[160:163], v[100:103]
s_waitcnt lgkmcnt(2)
ds_read_b128 a[96:99], v17 offset:64
v_mov_b32 v236, 0
v_mfma_f32_16x16x32_bf16 v[104:107], a[128:131], a[168:171], v[104:107]
ds_read_b64 v[36:37], v18 offset:0
v_mov_b32 v237, 0
v_mfma_f32_16x16x32_bf16 v[104:107], a[132:135], a[164:167], v[104:107]
ds_read_b64_tr_b16 a[68:69], v16 offset:904
v_mov_b32 v238, 0
v_mfma_f32_16x16x32_bf16 v[104:107], a[136:139], a[160:163], v[104:107]
ds_read_b64_tr_b16 a[70:71], v16 offset:896
v_mov_b32 v239, 0
v_mfma_f32_16x16x32_bf16 v[108:111], a[128:131], a[172:175], v[108:111]
ds_read_b128 a[100:103], v17 offset:576
v_mov_b32 v240, 0
v_mfma_f32_16x16x32_bf16 v[108:111], a[132:135], a[168:171], v[108:111]
ds_read_b64 v[38:39], v18 offset:512
v_mov_b32 v241, 0
v_mfma_f32_16x16x32_bf16 v[108:111], a[136:139], a[164:167], v[108:111]
ds_read_b64_tr_b16 a[72:73], v16 offset:1416
v_mov_b32 v242, 0
v_mfma_f32_16x16x32_bf16 v[108:111], a[140:143], a[160:163], v[108:111]
ds_read_b64_tr_b16 a[74:75], v16 offset:1408
v_mov_b32 v243, 0
v_mfma_f32_16x16x32_bf16 v[112:115], a[128:131], a[176:179], v[112:115]
ds_read_b128 a[104:107], v17 offset:1088
v_mov_b32 v244, 0
v_mfma_f32_16x16x32_bf16 v[112:115], a[132:135], a[172:175], v[112:115]
ds_read_b64 v[44:45], v18 offset:1024
v_mov_b32 v245, 0
v_mfma_f32_16x16x32_bf16 v[112:115], a[136:139], a[168:171], v[112:115]
ds_read_b64_tr_b16 a[76:77], v16 offset:1928
v_mov_b32 v246, 0
v_mfma_f32_16x16x32_bf16 v[112:115], a[140:143], a[164:167], v[112:115]
ds_read_b64_tr_b16 a[78:79], v16 offset:1920
v_mov_b32 v247, 0
v_mfma_f32_16x16x32_bf16 v[112:115], a[144:147], a[160:163], v[112:115]
ds_read_b128 a[108:111], v17 offset:1600
v_mov_b32 v248, 0
v_mfma_f32_16x16x32_bf16 v[116:119], a[128:131], a[180:183], v[116:119]
ds_read_b64 v[46:47], v18 offset:1536
v_mov_b32 v249, 0
v_mfma_f32_16x16x32_bf16 v[116:119], a[132:135], a[176:179], v[116:119]
ds_read_b64_tr_b16 a[80:81], v16 offset:2440
v_mov_b32 v250, 0
v_mfma_f32_16x16x32_bf16 v[116:119], a[136:139], a[172:175], v[116:119]
ds_read_b64_tr_b16 a[82:83], v16 offset:2432
v_mov_b32 v251, 0
v_mfma_f32_16x16x32_bf16 v[116:119], a[140:143], a[168:171], v[116:119]
ds_read_b128 a[112:115], v17 offset:2112
v_mov_b32 v252, 0
v_mfma_f32_16x16x32_bf16 v[116:119], a[144:147], a[164:167], v[116:119]
ds_read_b64 v[52:53], v18 offset:2048
v_mov_b32 v253, 0
v_mfma_f32_16x16x32_bf16 v[116:119], a[148:151], a[160:163], v[116:119]
ds_read_b64_tr_b16 a[84:85], v16 offset:2952
v_mov_b32 v254, 0
v_mfma_f32_16x16x32_bf16 v[120:123], a[128:131], a[184:187], v[120:123]
ds_read_b64_tr_b16 a[86:87], v16 offset:2944
v_mov_b32 v255, 0
v_mfma_f32_16x16x32_bf16 v[120:123], a[132:135], a[180:183], v[120:123]
ds_read_b128 a[116:119], v17 offset:2624
v_mfma_f32_16x16x32_bf16 v[120:123], a[136:139], a[176:179], v[120:123]
ds_read_b64 v[54:55], v18 offset:2560
v_mfma_f32_16x16x32_bf16 v[120:123], a[140:143], a[172:175], v[120:123]
ds_read_b64_tr_b16 a[88:89], v16 offset:3464
v_mfma_f32_16x16x32_bf16 v[120:123], a[144:147], a[168:171], v[120:123]
ds_read_b64_tr_b16 a[90:91], v16 offset:3456
v_mfma_f32_16x16x32_bf16 v[120:123], a[148:151], a[164:167], v[120:123]
ds_read_b128 a[120:123], v17 offset:3136
v_mfma_f32_16x16x32_bf16 v[120:123], a[152:155], a[160:163], v[120:123]
ds_read_b64 v[60:61], v18 offset:3072
v_mfma_f32_16x16x32_bf16 v[124:127], a[128:131], a[188:191], v[124:127]
ds_read_b64_tr_b16 a[92:93], v16 offset:3976
v_mfma_f32_16x16x32_bf16 v[124:127], a[132:135], a[184:187], v[124:127]
ds_read_b64_tr_b16 a[94:95], v16 offset:3968
v_mfma_f32_16x16x32_bf16 v[124:127], a[136:139], a[180:183], v[124:127]
ds_read_b128 a[124:127], v17 offset:3648
v_mfma_f32_16x16x32_bf16 v[124:127], a[140:143], a[176:179], v[124:127]
ds_read_b64 v[62:63], v18 offset:3584
v_mfma_f32_16x16x32_bf16 v[124:127], a[144:147], a[172:175], v[124:127]
buffer_load_dwordx4 a[48:51], v1, s[4:7], s22 offen offset:0 sc1
v_mfma_f32_16x16x32_bf16 v[124:127], a[148:151], a[168:171], v[124:127]
buffer_load_dwordx4 a[52:55], v1, s[4:7], s22 offen offset:1024 sc1
v_mfma_f32_16x16x32_bf16 v[124:127], a[152:155], a[164:167], v[124:127]
buffer_load_dwordx4 a[56:59], v1, s[4:7], s22 offen offset:2048 sc1
v_mfma_f32_16x16x32_bf16 v[124:127], a[156:159], a[160:163], v[124:127]
s_waitcnt lgkmcnt(3)
buffer_load_dwordx4 a[60:63], v1, s[4:7], s22 offen offset:3072 sc1
v_mfma_f32_16x16x32_bf16 v[96:99], a[64:67], a[96:99], v[96:99]
ds_read_b64_tr_b16 a[128:129], v16 offset:456
v_mfma_f32_16x16x32_bf16 v[100:103], a[64:67], a[100:103], v[100:103]
ds_read_b64_tr_b16 a[130:131], v16 offset:448
v_mfma_f32_16x16x32_bf16 v[100:103], a[68:71], a[96:99], v[100:103]
ds_read_b128 a[160:163], v17 offset:0
v_mfma_f32_16x16x32_bf16 v[104:107], a[64:67], a[104:107], v[104:107]
v_mfma_f32_16x16x32_bf16 v[104:107], a[68:71], a[100:103], v[104:107]
ds_read_b64_tr_b16 a[132:133], v16 offset:968
v_mfma_f32_16x16x32_bf16 v[104:107], a[72:75], a[96:99], v[104:107]
ds_read_b64_tr_b16 a[134:135], v16 offset:960
v_mfma_f32_16x16x32_bf16 v[108:111], a[64:67], a[108:111], v[108:111]
ds_read_b128 a[164:167], v17 offset:512
v_mfma_f32_16x16x32_bf16 v[108:111], a[68:71], a[104:107], v[108:111]
v_mfma_f32_16x16x32_bf16 v[108:111], a[72:75], a[100:103], v[108:111]
ds_read_b64_tr_b16 a[136:137], v16 offset:1480
v_mfma_f32_16x16x32_bf16 v[108:111], a[76:79], a[96:99], v[108:111]
ds_read_b64_tr_b16 a[138:139], v16 offset:1472
v_mfma_f32_16x16x32_bf16 v[112:115], a[64:67], a[112:115], v[112:115]
ds_read_b128 a[168:171], v17 offset:1024
v_mfma_f32_16x16x32_bf16 v[112:115], a[68:71], a[108:111], v[112:115]
v_mfma_f32_16x16x32_bf16 v[112:115], a[72:75], a[104:107], v[112:115]
ds_read_b64_tr_b16 a[140:141], v16 offset:1992
v_mfma_f32_16x16x32_bf16 v[112:115], a[76:79], a[100:103], v[112:115]
ds_read_b64_tr_b16 a[142:143], v16 offset:1984
v_mfma_f32_16x16x32_bf16 v[112:115], a[80:83], a[96:99], v[112:115]
ds_read_b128 a[172:175], v17 offset:1536
v_mfma_f32_16x16x32_bf16 v[116:119], a[64:67], a[116:119], v[116:119]
v_mfma_f32_16x16x32_bf16 v[116:119], a[68:71], a[112:115], v[116:119]
ds_read_b64_tr_b16 a[144:145], v16 offset:2504
v_mfma_f32_16x16x32_bf16 v[116:119], a[72:75], a[108:111], v[116:119]
ds_read_b64_tr_b16 a[146:147], v16 offset:2496
v_mfma_f32_16x16x32_bf16 v[116:119], a[76:79], a[104:107], v[116:119]
ds_read_b128 a[176:179], v17 offset:2048
v_mfma_f32_16x16x32_bf16 v[116:119], a[80:83], a[100:103], v[116:119]
v_mfma_f32_16x16x32_bf16 v[116:119], a[84:87], a[96:99], v[116:119]
ds_read_b64_tr_b16 a[148:149], v16 offset:3016
v_mfma_f32_16x16x32_bf16 v[120:123], a[64:67], a[120:123], v[120:123]
ds_read_b64_tr_b16 a[150:151], v16 offset:3008
v_mfma_f32_16x16x32_bf16 v[120:123], a[68:71], a[116:119], v[120:123]
ds_read_b128 a[180:183], v17 offset:2560
v_mfma_f32_16x16x32_bf16 v[120:123], a[72:75], a[112:115], v[120:123]
v_mfma_f32_16x16x32_bf16 v[120:123], a[76:79], a[108:111], v[120:123]
ds_read_b64_tr_b16 a[152:153], v16 offset:3528
v_mfma_f32_16x16x32_bf16 v[120:123], a[80:83], a[104:107], v[120:123]
ds_read_b64_tr_b16 a[154:155], v16 offset:3520
v_mfma_f32_16x16x32_bf16 v[120:123], a[84:87], a[100:103], v[120:123]
ds_read_b128 a[184:187], v17 offset:3072
v_mfma_f32_16x16x32_bf16 v[120:123], a[88:91], a[96:99], v[120:123]
s_waitcnt lgkmcnt(5)
v_mfma_f32_16x16x32_bf16 v[124:127], a[64:67], a[124:127], v[124:127]
ds_read_b64_tr_b16 a[156:157], v16 offset:4040
v_mfma_f32_16x16x32_bf16 v[124:127], a[68:71], a[120:123], v[124:127]
ds_read_b64_tr_b16 a[158:159], v16 offset:4032
v_mfma_f32_16x16x32_bf16 v[124:127], a[72:75], a[116:119], v[124:127]
ds_read_b128 a[188:191], v17 offset:3584
v_mfma_f32_16x16x32_bf16 v[124:127], a[76:79], a[112:115], v[124:127]
v_mfma_f32_16x16x32_bf16 v[124:127], a[80:83], a[108:111], v[124:127]
v_mfma_f32_16x16x32_bf16 v[124:127], a[84:87], a[104:107], v[124:127]
v_mfma_f32_16x16x32_bf16 v[124:127], a[88:91], a[100:103], v[124:127]
v_mfma_f32_16x16x32_bf16 v[124:127], a[92:95], a[96:99], v[124:127]
v_mfma_f32_16x16x32_bf16 v[96:99], a[128:131], a[160:163], v[96:99]
v_mfma_f32_16x16x32_bf16 v[100:103], a[128:131], a[164:167], v[100:103]
v_mfma_f32_16x16x32_bf16 v[100:103], a[132:135], a[160:163], v[100:103]
v_mfma_f32_16x16x32_bf16 v[104:107], a[128:131], a[168:171], v[104:107]
v_mfma_f32_16x16x32_bf16 v[104:107], a[132:135], a[164:167], v[104:107]
v_mfma_f32_16x16x32_bf16 v[104:107], a[136:139], a[160:163], v[104:107]
v_mfma_f32_16x16x32_bf16 v[108:111], a[128:131], a[172:175], v[108:111]
v_mfma_f32_16x16x32_bf16 v[108:111], a[132:135], a[168:171], v[108:111]
v_mfma_f32_16x16x32_bf16 v[108:111], a[136:139], a[164:167], v[108:111]
v_lshlrev_b32 v10, 16, v36
v_fmac_f32 v96, v19, v10
v_mfma_f32_16x16x32_bf16 v[108:111], a[140:143], a[160:163], v[108:111]
v_and_b32 v11, 0xffff0000, v36
v_fmac_f32 v97, v19, v11
v_mfma_f32_16x16x32_bf16 v[112:115], a[128:131], a[176:179], v[112:115]
v_lshlrev_b32 v12, 16, v37
v_fmac_f32 v98, v19, v12
v_mfma_f32_16x16x32_bf16 v[112:115], a[132:135], a[172:175], v[112:115]
v_and_b32 v13, 0xffff0000, v37
v_fmac_f32 v99, v19, v13
v_mfma_f32_16x16x32_bf16 v[112:115], a[136:139], a[168:171], v[112:115]
v_cvt_pk_bf16_f32 v96, v96, v97
v_cvt_pk_bf16_f32 v97, v98, v99
v_mfma_f32_16x16x32_bf16 v[112:115], a[140:143], a[164:167], v[112:115]
buffer_store_dwordx2 v[96:97], v8, s[4:7], s83 offen offset:0 sc1
v_mfma_f32_16x16x32_bf16 v[112:115], a[144:147], a[160:163], v[112:115]
s_waitcnt lgkmcnt(0)
v_lshlrev_b32 v10, 16, v38
v_fmac_f32 v100, v19, v10
v_mfma_f32_16x16x32_bf16 v[116:119], a[128:131], a[180:183], v[116:119]
v_and_b32 v11, 0xffff0000, v38
v_fmac_f32 v101, v19, v11
v_mfma_f32_16x16x32_bf16 v[116:119], a[132:135], a[176:179], v[116:119]
v_lshlrev_b32 v12, 16, v39
v_fmac_f32 v102, v19, v12
v_mfma_f32_16x16x32_bf16 v[116:119], a[136:139], a[172:175], v[116:119]
v_and_b32 v13, 0xffff0000, v39
v_fmac_f32 v103, v19, v13
v_mfma_f32_16x16x32_bf16 v[116:119], a[140:143], a[168:171], v[116:119]
v_cvt_pk_bf16_f32 v100, v100, v101
v_cvt_pk_bf16_f32 v101, v102, v103
v_mfma_f32_16x16x32_bf16 v[116:119], a[144:147], a[164:167], v[116:119]
buffer_store_dwordx2 v[100:101], v8, s[4:7], s83 offen offset:512 sc1
v_mfma_f32_16x16x32_bf16 v[116:119], a[148:151], a[160:163], v[116:119]
v_lshlrev_b32 v10, 16, v44
v_fmac_f32 v104, v19, v10
v_mfma_f32_16x16x32_bf16 v[120:123], a[128:131], a[184:187], v[120:123]
v_and_b32 v11, 0xffff0000, v44
v_fmac_f32 v105, v19, v11
v_mfma_f32_16x16x32_bf16 v[120:123], a[132:135], a[180:183], v[120:123]
v_lshlrev_b32 v12, 16, v45
v_fmac_f32 v106, v19, v12
v_mfma_f32_16x16x32_bf16 v[120:123], a[136:139], a[176:179], v[120:123]
v_and_b32 v13, 0xffff0000, v45
v_fmac_f32 v107, v19, v13
v_mfma_f32_16x16x32_bf16 v[120:123], a[140:143], a[172:175], v[120:123]
v_cvt_pk_bf16_f32 v104, v104, v105
v_cvt_pk_bf16_f32 v105, v106, v107
v_mfma_f32_16x16x32_bf16 v[120:123], a[144:147], a[168:171], v[120:123]
buffer_store_dwordx2 v[104:105], v8, s[4:7], s83 offen offset:1024 sc1
v_mfma_f32_16x16x32_bf16 v[120:123], a[148:151], a[164:167], v[120:123]
v_lshlrev_b32 v10, 16, v46
v_fmac_f32 v108, v19, v10
v_mfma_f32_16x16x32_bf16 v[120:123], a[152:155], a[160:163], v[120:123]
v_and_b32 v11, 0xffff0000, v46
v_fmac_f32 v109, v19, v11
v_mfma_f32_16x16x32_bf16 v[124:127], a[128:131], a[188:191], v[124:127]
v_lshlrev_b32 v12, 16, v47
v_fmac_f32 v110, v19, v12
v_mfma_f32_16x16x32_bf16 v[124:127], a[132:135], a[184:187], v[124:127]
v_and_b32 v13, 0xffff0000, v47
v_fmac_f32 v111, v19, v13
v_mfma_f32_16x16x32_bf16 v[124:127], a[136:139], a[180:183], v[124:127]
v_cvt_pk_bf16_f32 v108, v108, v109
v_cvt_pk_bf16_f32 v109, v110, v111
v_mfma_f32_16x16x32_bf16 v[124:127], a[140:143], a[176:179], v[124:127]
buffer_store_dwordx2 v[108:109], v8, s[4:7], s83 offen offset:1536 sc1
v_mfma_f32_16x16x32_bf16 v[124:127], a[144:147], a[172:175], v[124:127]
v_lshlrev_b32 v10, 16, v52
v_fmac_f32 v112, v19, v10
v_mfma_f32_16x16x32_bf16 v[124:127], a[148:151], a[168:171], v[124:127]
v_and_b32 v11, 0xffff0000, v52
v_fmac_f32 v113, v19, v11
v_mfma_f32_16x16x32_bf16 v[124:127], a[152:155], a[164:167], v[124:127]
v_lshlrev_b32 v12, 16, v53
v_fmac_f32 v114, v19, v12
v_mfma_f32_16x16x32_bf16 v[124:127], a[156:159], a[160:163], v[124:127]
v_and_b32 v13, 0xffff0000, v53
v_fmac_f32 v115, v19, v13
v_cvt_pk_bf16_f32 v112, v112, v113
v_cvt_pk_bf16_f32 v113, v114, v115
buffer_store_dwordx2 v[112:113], v8, s[4:7], s83 offen offset:2048 sc1
v_lshlrev_b32 v10, 16, v54
v_fmac_f32 v116, v19, v10
v_and_b32 v11, 0xffff0000, v54
v_fmac_f32 v117, v19, v11
v_lshlrev_b32 v12, 16, v55
v_fmac_f32 v118, v19, v12
v_and_b32 v13, 0xffff0000, v55
v_fmac_f32 v119, v19, v13
v_cvt_pk_bf16_f32 v116, v116, v117
PAD_27:
s_cbranch_execz M_tret
v_cvt_pk_bf16_f32 v117, v118, v119
buffer_store_dwordx2 v[116:117], v8, s[4:7], s83 offen offset:2560 sc1
v_lshlrev_b32 v10, 16, v60
v_fmac_f32 v120, v19, v10
v_and_b32 v11, 0xffff0000, v60
v_fmac_f32 v121, v19, v11
v_lshlrev_b32 v12, 16, v61
v_fmac_f32 v122, v19, v12
v_and_b32 v13, 0xffff0000, v61
v_fmac_f32 v123, v19, v13
v_cvt_pk_bf16_f32 v120, v120, v121
v_cvt_pk_bf16_f32 v121, v122, v123
buffer_store_dwordx2 v[120:121], v8, s[4:7], s83 offen offset:3072 sc1
v_lshlrev_b32 v10, 16, v62
v_fmac_f32 v124, v19, v10
v_and_b32 v11, 0xffff0000, v62
v_fmac_f32 v125, v19, v11
v_lshlrev_b32 v12, 16, v63
v_fmac_f32 v126, v19, v12
v_and_b32 v13, 0xffff0000, v63
v_fmac_f32 v127, v19, v13
v_cvt_pk_bf16_f32 v124, v124, v125
v_cvt_pk_bf16_f32 v125, v126, v127
buffer_store_dwordx2 v[124:125], v8, s[4:7], s83 offen offset:3584 sc1
v_lshrrev_b32 v8, 7, v1
v_and_b32 v9, 6, v8
v_lshlrev_b32 v9, 4, v9
v_and_b32 v10, 0x70, v1
v_xor_b32 v9, v9, v10
v_mul_u32_u24 v8, 896, v8
v_add_u32 v8, v8, v9
v_accvgpr_write_b32 a184, v8
v_add_u32 v8, 6144, v8
v_accvgpr_write_b32 a185, v8
v_add_u32 v8, 6144, v8
v_accvgpr_write_b32 a186, v8
v_add_u32 v8, 6144, v8
v_accvgpr_write_b32 a187, v8
v_lshrrev_b32 v8, 6, v1
v_bfe_u32 v9, v1, 7, 2
v_lshlrev_b32 v9, 5, v9
v_lshl_add_u32 v8, v8, 7, v9
v_bfe_u32 v9, v1, 4, 2
v_lshl_add_u32 v8, v9, 3, v8
v_add_u32 v8, 32768, v8
v_accvgpr_write_b32 a188, v8
v_xor_b32 v9, 32, v8
v_accvgpr_write_b32 a189, v9
v_xor_b32 v9, 64, v8
v_accvgpr_write_b32 a190, v9
v_xor_b32 v9, 96, v8
v_accvgpr_write_b32 a191, v9
s_waitcnt vmcnt(8)
s_barrier
s_cmp_lg_u32 s24, 0
s_cbranch_scc1 K2_item
v_accvgpr_mov_b32 a0, a192
v_accvgpr_mov_b32 a1, a193
v_accvgpr_mov_b32 a2, a194
v_accvgpr_mov_b32 a3, a195
v_accvgpr_mov_b32 a4, a196
v_accvgpr_mov_b32 a5, a197
v_accvgpr_mov_b32 a6, a198
v_accvgpr_mov_b32 a7, a199
v_accvgpr_mov_b32 a8, a200
v_accvgpr_mov_b32 a9, a201
v_accvgpr_mov_b32 a10, a202
v_accvgpr_mov_b32 a11, a203
v_accvgpr_mov_b32 a12, a204
v_accvgpr_mov_b32 a13, a205
v_accvgpr_mov_b32 a14, a206
v_accvgpr_mov_b32 a15, a207
v_accvgpr_mov_b32 a16, a208
v_accvgpr_mov_b32 a17, a209
v_accvgpr_mov_b32 a18, a210
v_accvgpr_mov_b32 a19, a211
v_accvgpr_mov_b32 a20, a212
v_accvgpr_mov_b32 a21, a213
v_accvgpr_mov_b32 a22, a214
v_accvgpr_mov_b32 a23, a215
v_accvgpr_mov_b32 a24, a216
v_accvgpr_mov_b32 a25, a217
v_accvgpr_mov_b32 a26, a218
v_accvgpr_mov_b32 a27, a219
v_accvgpr_mov_b32 a28, a220
v_accvgpr_mov_b32 a29, a221
v_accvgpr_mov_b32 a30, a222
v_accvgpr_mov_b32 a31, a223
v_accvgpr_mov_b32 a32, a224
v_accvgpr_mov_b32 a33, a225
v_accvgpr_mov_b32 a34, a226
v_accvgpr_mov_b32 a35, a227
v_accvgpr_mov_b32 a36, a228
v_accvgpr_mov_b32 a37, a229
v_accvgpr_mov_b32 a38, a230
v_accvgpr_mov_b32 a39, a231
v_accvgpr_mov_b32 a40, a232
v_accvgpr_mov_b32 a41, a233
v_accvgpr_mov_b32 a42, a234
v_accvgpr_mov_b32 a43, a235
v_accvgpr_mov_b32 a44, a236
v_accvgpr_mov_b32 a45, a237
v_accvgpr_mov_b32 a46, a238
v_accvgpr_mov_b32 a47, a239
v_accvgpr_mov_b32 a48, a240
v_accvgpr_mov_b32 a49, a241
v_accvgpr_mov_b32 a50, a242
v_accvgpr_mov_b32 a51, a243
v_accvgpr_mov_b32 a52, a244
v_accvgpr_mov_b32 a53, a245
v_accvgpr_mov_b32 a54, a246
v_accvgpr_mov_b32 a55, a247
v_accvgpr_mov_b32 a56, a248
v_accvgpr_mov_b32 a57, a249
v_accvgpr_mov_b32 a58, a250
v_accvgpr_mov_b32 a59, a251
v_accvgpr_mov_b32 a60, a252
v_accvgpr_mov_b32 a61, a253
v_accvgpr_mov_b32 a62, a254
v_accvgpr_mov_b32 a63, a255
s_branch K2_item
M_cend:
M_cspin:
Lp_16:
buffer_load_dword v14, v15, s[4:7], s70 offen sc1
s_waitcnt vmcnt(0)
v_cmp_gt_u32 vcc, 1, v14
s_cbranch_vccz Lpd_17
s_sleep 8
s_sub_u32 s101, s101, 1
s_cbranch_scc0 Lp_16
s_mov_b32 s101, 0
Lpd_17:
s_branch M_cok
M_kspin:
Lp_18:
buffer_load_dword v21, v20, s[4:7], s70 offen sc1
s_waitcnt vmcnt(0)
v_cmp_gt_u32 vcc, 1, v21
s_cbranch_vccz Lpd_19
s_sleep 8
s_sub_u32 s101, s101, 1
s_cbranch_scc0 Lp_18
s_mov_b32 s101, 0
Lpd_19:
s_branch M_kok
M_kspin2:
Lp_20:
buffer_load_dword v21, v20, s[4:7], s70 offen sc1
s_waitcnt vmcnt(0)
v_cmp_gt_u32 vcc, 1, v21
s_cbranch_vccz Lpd_21
s_sleep 8
s_sub_u32 s101, s101, 1
s_cbranch_scc0 Lp_20
s_mov_b32 s101, 0
Lpd_21:
s_branch M_kok2
M_vspin:
Lp_22:
buffer_load_dword v21, v15, s[4:7], s70 offen sc1
s_waitcnt vmcnt(0)
v_cmp_gt_u32 vcc, 1, v21
s_cbranch_vccz Lpd_23
s_sleep 8
s_sub_u32 s101, s101, 1
s_cbranch_scc0 Lp_22
s_mov_b32 s101, 0
Lpd_23:
s_branch M_vok
K2_plain:
v_mfma_f32_16x16x32_bf16 v[128:131], a[64:67], v[96:99], v[128:131]
s_waitcnt lgkmcnt(6)
ds_read_b128 a[96:99], v2 offset:8192
v_add_f32 v24, v24, v26
v_mfma_f32_16x16x32_bf16 v[128:131], a[68:71], v[100:103], v[128:131]
s_waitcnt lgkmcnt(5)
v_mfma_f32_16x16x32_bf16 v[132:135], a[68:71], v[108:111], v[132:135]
s_mov_b64 s[36:37], s[86:87]
ds_read_b128 a[100:103], v2 offset:9216
v_add_f32 v25, v25, v27
v_mfma_f32_16x16x32_bf16 v[132:135], a[64:67], v[104:107], v[132:135]
s_mov_b32 s38, 3670016
v_exp_f32 v8, v68
v_mfma_f32_16x16x32_bf16 v[136:139], a[72:75], v[96:99], v[136:139]
s_mov_b32 s39, 0x20000
ds_read_b128 a[104:107], v2 offset:10240
v_accvgpr_read_b32 v112, a184
v_mfma_f32_16x16x32_bf16 v[136:139], a[76:79], v[100:103], v[136:139]
v_accvgpr_read_b32 v113, a185
v_accvgpr_read_b32 v114, a186
v_mfma_f32_16x16x32_bf16 v[140:143], a[76:79], v[108:111], v[140:143]
ds_read_b128 a[108:111], v2 offset:11264
v_accvgpr_read_b32 v115, a187
v_mfma_f32_16x16x32_bf16 v[140:143], a[72:75], v[104:107], v[140:143]
s_waitcnt lgkmcnt(3)
v_accvgpr_read_b32 v116, a188
v_accvgpr_read_b32 v117, a189
v_mfma_f32_16x16x32_bf16 v[144:147], a[80:83], v[96:99], v[144:147]
ds_read_b128 a[112:115], v2 offset:12288
v_accvgpr_read_b32 v118, a190
v_mfma_f32_16x16x32_bf16 v[144:147], a[84:87], v[100:103], v[144:147]
v_accvgpr_read_b32 v119, a191
v_mfma_f32_16x16x32_bf16 v[148:151], a[84:87], v[108:111], v[148:151]
s_add_u32 m0, s18, 32768
ds_read_b128 a[116:119], v2 offset:13312
v_cvt_pk_bf16_f32 v128, v128, v129
v_mfma_f32_16x16x32_bf16 v[148:151], a[80:83], v[104:107], v[148:151]
buffer_load_dwordx4 v112, s[36:39], s81 offen offset:0 lds
v_mfma_f32_16x16x32_bf16 v[152:155], a[88:91], v[96:99], v[152:155]
ds_read_b128 a[120:123], v2 offset:14336
v_cvt_pk_bf16_f32 v129, v130, v131
v_mfma_f32_16x16x32_bf16 v[152:155], a[92:95], v[100:103], v[152:155]
v_exp_f32 v9, v69
v_mfma_f32_16x16x32_bf16 v[156:159], a[92:95], v[108:111], v[156:159]
ds_read_b128 a[124:127], v2 offset:15360
v_add_f32 v27, v8, v9
v_mfma_f32_16x16x32_bf16 v[156:159], a[88:91], v[104:107], v[156:159]
buffer_load_dwordx4 v113, s[36:39], s81 offen offset:1024 lds
v_mfma_f32_16x16x32_bf16 v[160:163], a[96:99], v[96:99], v[160:163]
s_waitcnt lgkmcnt(3)
ds_read_b128 a[64:67], v2 offset:16384
v_cvt_pk_bf16_f32 v120, v8, v9
v_mfma_f32_16x16x32_bf16 v[160:163], a[100:103], v[100:103], v[160:163]
v_exp_f32 v10, v70
v_mfma_f32_16x16x32_bf16 v[164:167], a[100:103], v[108:111], v[164:167]
ds_read_b128 a[68:71], v2 offset:17408
v_add_f32 v27, v27, v10
v_mfma_f32_16x16x32_bf16 v[164:167], a[96:99], v[104:107], v[164:167]
buffer_load_dwordx4 v114, s[36:39], s81 offen offset:2048 lds
v_mfma_f32_16x16x32_bf16 v[168:171], a[104:107], v[96:99], v[168:171]
ds_read_b128 a[72:75], v2 offset:18432
v_cvt_pk_bf16_f32 v130, v136, v137
v_mfma_f32_16x16x32_bf16 v[168:171], a[108:111], v[100:103], v[168:171]
v_exp_f32 v11, v71
v_mfma_f32_16x16x32_bf16 v[172:175], a[108:111], v[108:111], v[172:175]
ds_read_b128 a[76:79], v2 offset:19456
v_add_f32 v27, v27, v11
v_mfma_f32_16x16x32_bf16 v[172:175], a[104:107], v[104:107], v[172:175]
buffer_load_dwordx4 v115, s[36:39], s81 offen offset:3072 lds
v_mfma_f32_16x16x32_bf16 v[176:179], a[112:115], v[96:99], v[176:179]
s_waitcnt lgkmcnt(3)
ds_read_b128 a[80:83], v2 offset:20480
v_cvt_pk_bf16_f32 v121, v10, v11
v_mfma_f32_16x16x32_bf16 v[176:179], a[116:119], v[100:103], v[176:179]
v_exp_f32 v12, v76
v_mfma_f32_16x16x32_bf16 v[180:183], a[116:119], v[108:111], v[180:183]
s_add_u32 s81, s81, 28672
ds_read_b128 a[84:87], v2 offset:21504
v_add_f32 v27, v27, v12
v_mfma_f32_16x16x32_bf16 v[180:183], a[112:115], v[104:107], v[180:183]
s_add_u32 m0, s18, 36864
v_exp_f32 v13, v77
v_mfma_f32_16x16x32_bf16 v[184:187], a[120:123], v[96:99], v[184:187]
ds_read_b128 a[88:91], v2 offset:22528
v_add_f32 v27, v27, v13
v_mfma_f32_16x16x32_bf16 v[184:187], a[124:127], v[100:103], v[184:187]
buffer_load_dwordx4 v112, s[36:39], s81 offen offset:0 lds
v_mfma_f32_16x16x32_bf16 v[188:191], a[124:127], v[108:111], v[188:191]
ds_read_b128 a[92:95], v2 offset:23552
v_cvt_pk_bf16_f32 v122, v12, v13
v_mfma_f32_16x16x32_bf16 v[188:191], a[120:123], v[104:107], v[188:191]
v_exp_f32 v14, v78
v_mfma_f32_16x16x32_bf16 v[192:195], a[64:67], v[96:99], v[192:195]
s_waitcnt lgkmcnt(3)
ds_read_b128 a[96:99], v2 offset:24576
v_add_f32 v27, v27, v14
v_mfma_f32_16x16x32_bf16 v[192:195], a[68:71], v[100:103], v[192:195]
buffer_load_dwordx4 v113, s[36:39], s81 offen offset:1024 lds
v_mfma_f32_16x16x32_bf16 v[196:199], a[68:71], v[108:111], v[196:199]
ds_read_b128 a[100:103], v2 offset:25600
v_cvt_pk_bf16_f32 v131, v138, v139
v_mfma_f32_16x16x32_bf16 v[196:199], a[64:67], v[104:107], v[196:199]
v_exp_f32 v15, v79
v_mfma_f32_16x16x32_bf16 v[200:203], a[72:75], v[96:99], v[200:203]
ds_read_b128 a[104:107], v2 offset:26624
v_add_f32 v27, v27, v15
v_mfma_f32_16x16x32_bf16 v[200:203], a[76:79], v[100:103], v[200:203]
buffer_load_dwordx4 v114, s[36:39], s81 offen offset:2048 lds
v_mfma_f32_16x16x32_bf16 v[204:207], a[76:79], v[108:111], v[204:207]
ds_read_b128 a[108:111], v2 offset:27648
v_cvt_pk_bf16_f32 v123, v14, v15
v_mfma_f32_16x16x32_bf16 v[204:207], a[72:75], v[104:107], v[204:207]
v_exp_f32 v8, v84
v_mfma_f32_16x16x32_bf16 v[208:211], a[80:83], v[96:99], v[208:211]
s_waitcnt lgkmcnt(3)
ds_read_b128 a[112:115], v2 offset:28672
v_add_f32 v27, v27, v8
v_mfma_f32_16x16x32_bf16 v[208:211], a[84:87], v[100:103], v[208:211]
buffer_load_dwordx4 v115, s[36:39], s81 offen offset:3072 lds
v_mfma_f32_16x16x32_bf16 v[212:215], a[84:87], v[108:111], v[212:215]
ds_read_b128 a[116:119], v2 offset:29696
v_cvt_pk_bf16_f32 v144, v144, v145
v_mfma_f32_16x16x32_bf16 v[212:215], a[80:83], v[104:107], v[212:215]
v_exp_f32 v9, v85
v_mfma_f32_16x16x32_bf16 v[216:219], a[88:91], v[96:99], v[216:219]
s_sub_u32 s81, s81, 28544
ds_read_b128 a[120:123], v2 offset:30720
v_add_f32 v27, v27, v9
v_mfma_f32_16x16x32_bf16 v[216:219], a[92:95], v[100:103], v[216:219]
v_exp_f32 v10, v86
v_mfma_f32_16x16x32_bf16 v[220:223], a[92:95], v[108:111], v[220:223]
s_waitcnt vmcnt(8)
ds_read_b128 a[124:127], v2 offset:31744
v_cvt_pk_bf16_f32 v124, v8, v9
v_mfma_f32_16x16x32_bf16 v[220:223], a[88:91], v[104:107], v[220:223]
s_barrier
v_mfma_f32_16x16x32_bf16 v[224:227], a[96:99], v[96:99], v[224:227]
s_waitcnt lgkmcnt(3)
ds_read_b128 a[64:67], v1 offset:0
v_add_f32 v27, v27, v10
v_mfma_f32_16x16x32_bf16 v[224:227], a[100:103], v[100:103], v[224:227]
v_exp_f32 v11, v87
v_mfma_f32_16x16x32_bf16 v[228:231], a[100:103], v[108:111], v[228:231]
ds_read_b128 a[68:71], v1 offset:1024
v_add_f32 v27, v27, v11
v_mfma_f32_16x16x32_bf16 v[228:231], a[96:99], v[104:107], v[228:231]
v_exp_f32 v12, v92
v_mfma_f32_16x16x32_bf16 v[232:235], a[104:107], v[96:99], v[232:235]
ds_read_b128 a[72:75], v1 offset:2048
v_cvt_pk_bf16_f32 v125, v10, v11
v_mfma_f32_16x16x32_bf16 v[232:235], a[108:111], v[100:103], v[232:235]
v_exp_f32 v13, v93
v_mfma_f32_16x16x32_bf16 v[236:239], a[108:111], v[108:111], v[236:239]
ds_read_b128 a[76:79], v1 offset:3072
v_add_f32 v27, v27, v12
v_mfma_f32_16x16x32_bf16 v[236:239], a[104:107], v[104:107], v[236:239]
v_exp_f32 v14, v94
v_mfma_f32_16x16x32_bf16 v[240:243], a[112:115], v[96:99], v[240:243]
s_waitcnt lgkmcnt(3)
ds_read_b128 a[80:83], v1 offset:4096
v_add_f32 v27, v27, v13
v_mfma_f32_16x16x32_bf16 v[240:243], a[116:119], v[100:103], v[240:243]
v_exp_f32 v15, v95
v_mfma_f32_16x16x32_bf16 v[244:247], a[116:119], v[108:111], v[244:247]
ds_read_b128 a[84:87], v1 offset:5120
v_cvt_pk_bf16_f32 v126, v12, v13
v_mfma_f32_16x16x32_bf16 v[244:247], a[112:115], v[104:107], v[244:247]
v_add_f32 v27, v27, v14
v_add_f32 v27, v27, v15
v_mfma_f32_16x16x32_bf16 v[248:251], a[120:123], v[96:99], v[248:251]
ds_read_b128 a[88:91], v1 offset:6144
v_cvt_pk_bf16_f32 v127, v14, v15
v_mfma_f32_16x16x32_bf16 v[248:251], a[124:127], v[100:103], v[248:251]
v_cmp_nge_f32 vcc, s25, v27
v_cvt_pk_bf16_f32 v145, v146, v147
v_mfma_f32_16x16x32_bf16 v[252:255], a[124:127], v[108:111], v[252:255]
ds_read_b128 a[92:95], v1 offset:7168
v_cvt_pk_bf16_f32 v146, v152, v153
v_mfma_f32_16x16x32_bf16 v[252:255], a[120:123], v[104:107], v[252:255]
s_waitcnt lgkmcnt(2)
v_cvt_pk_bf16_f32 v147, v154, v155
v_cvt_pk_bf16_f32 v160, v160, v161
s_cbranch_vccnz Lstub_12
Lback_13:
v_mfma_f32_16x16x32_bf16 v[132:135], a[64:67], v[120:123], v[132:135]
s_lshl_b32 s8, s29, 3
ds_read_b128 a[96:99], v1 offset:8192
v_add_f32 v25, v25, v27
v_mfma_f32_16x16x32_bf16 v[132:135], a[68:71], v[124:127], v[132:135]
s_add_u32 s8, s8, s3
ds_read_b128 a[100:103], v1 offset:9216
v_cvt_pk_bf16_f32 v161, v162, v163
v_mfma_f32_16x16x32_bf16 v[140:143], a[72:75], v[120:123], v[140:143]
s_lshl_b32 s8, s8, 4
ds_read_b128 a[104:107], v1 offset:10240
v_cvt_pk_bf16_f32 v162, v168, v169
v_mfma_f32_16x16x32_bf16 v[140:143], a[76:79], v[124:127], v[140:143]
s_add_u32 s8, s8, s20
ds_read_b128 a[108:111], v1 offset:11264
v_cvt_pk_bf16_f32 v163, v170, v171
v_mfma_f32_16x16x32_bf16 v[148:151], a[80:83], v[120:123], v[148:151]
s_mul_i32 s8, s8, 14336
ds_read_b128 a[112:115], v1 offset:12288
v_cvt_pk_bf16_f32 v176, v176, v177
v_mfma_f32_16x16x32_bf16 v[148:151], a[84:87], v[124:127], v[148:151]
s_waitcnt lgkmcnt(5)
s_add_u32 s8, s8, 104857600
ds_read_b128 a[116:119], v1 offset:13312
v_cvt_pk_bf16_f32 v177, v178, v179
v_mfma_f32_16x16x32_bf16 v[156:159], a[88:91], v[120:123], v[156:159]
s_add_u32 s12, s8, 917504
ds_read_b128 a[120:123], v1 offset:14336
v_cvt_pk_bf16_f32 v178, v184, v185
v_mfma_f32_16x16x32_bf16 v[156:159], a[92:95], v[124:127], v[156:159]
s_waitcnt lgkmcnt(6)
ds_read_b128 a[124:127], v1 offset:15360
v_cvt_pk_bf16_f32 v179, v186, v187
v_mfma_f32_16x16x32_bf16 v[164:167], a[96:99], v[120:123], v[164:167]
s_waitcnt lgkmcnt(6)
ds_read_b128 a[64:67], v1 offset:16384
v_cvt_pk_bf16_f32 v192, v192, v193
v_mfma_f32_16x16x32_bf16 v[164:167], a[100:103], v[124:127], v[164:167]
s_waitcnt lgkmcnt(6)
ds_read_b128 a[68:71], v1 offset:17408
v_cvt_pk_bf16_f32 v193, v194, v195
v_mfma_f32_16x16x32_bf16 v[172:175], a[104:107], v[120:123], v[172:175]
s_waitcnt lgkmcnt(6)
ds_read_b128 a[72:75], v1 offset:18432
v_cvt_pk_bf16_f32 v194, v200, v201
v_mfma_f32_16x16x32_bf16 v[172:175], a[108:111], v[124:127], v[172:175]
s_waitcnt lgkmcnt(6)
ds_read_b128 a[76:79], v1 offset:19456
v_cvt_pk_bf16_f32 v195, v202, v203
v_mfma_f32_16x16x32_bf16 v[180:183], a[112:115], v[120:123], v[180:183]
s_waitcnt lgkmcnt(6)
ds_read_b128 a[80:83], v1 offset:20480
v_cvt_pk_bf16_f32 v208, v208, v209
v_mfma_f32_16x16x32_bf16 v[180:183], a[116:119], v[124:127], v[180:183]
s_waitcnt lgkmcnt(6)
ds_read_b128 a[84:87], v1 offset:21504
v_cvt_pk_bf16_f32 v209, v210, v211
v_mfma_f32_16x16x32_bf16 v[188:191], a[120:123], v[120:123], v[188:191]
s_waitcnt lgkmcnt(6)
ds_read_b128 a[88:91], v1 offset:22528
v_cvt_pk_bf16_f32 v210, v216, v217
v_mfma_f32_16x16x32_bf16 v[188:191], a[124:127], v[124:127], v[188:191]
s_waitcnt lgkmcnt(6)
ds_read_b128 a[92:95], v1 offset:23552
v_cvt_pk_bf16_f32 v211, v218, v219
v_mfma_f32_16x16x32_bf16 v[196:199], a[64:67], v[120:123], v[196:199]
s_waitcnt lgkmcnt(6)
ds_read_b128 a[96:99], v1 offset:24576
v_cvt_pk_bf16_f32 v224, v224, v225
v_mfma_f32_16x16x32_bf16 v[196:199], a[68:71], v[124:127], v[196:199]
s_waitcnt lgkmcnt(6)
ds_read_b128 a[100:103], v1 offset:25600
v_cvt_pk_bf16_f32 v225, v226, v227
v_mfma_f32_16x16x32_bf16 v[204:207], a[72:75], v[120:123], v[204:207]
s_waitcnt lgkmcnt(6)
ds_read_b128 a[104:107], v1 offset:26624
v_cvt_pk_bf16_f32 v226, v232, v233
v_mfma_f32_16x16x32_bf16 v[204:207], a[76:79], v[124:127], v[204:207]
s_waitcnt lgkmcnt(6)
ds_read_b128 a[108:111], v1 offset:27648
v_cvt_pk_bf16_f32 v227, v234, v235
v_mfma_f32_16x16x32_bf16 v[212:215], a[80:83], v[120:123], v[212:215]
s_waitcnt lgkmcnt(6)
ds_read_b128 a[112:115], v1 offset:28672
v_cvt_pk_bf16_f32 v240, v240, v241
v_mfma_f32_16x16x32_bf16 v[212:215], a[84:87], v[124:127], v[212:215]
s_waitcnt lgkmcnt(5)
ds_read_b128 a[116:119], v1 offset:29696
v_cvt_pk_bf16_f32 v241, v242, v243
v_mfma_f32_16x16x32_bf16 v[220:223], a[88:91], v[120:123], v[220:223]
s_add_u32 m0, s18, 98304
ds_read_b128 a[120:123], v1 offset:30720
v_cvt_pk_bf16_f32 v242, v248, v249
v_mfma_f32_16x16x32_bf16 v[220:223], a[92:95], v[124:127], v[220:223]
s_waitcnt lgkmcnt(6)
ds_read_b128 a[124:127], v1 offset:31744
v_cvt_pk_bf16_f32 v243, v250, v251
v_mfma_f32_16x16x32_bf16 v[228:231], a[96:99], v[120:123], v[228:231]
s_waitcnt lgkmcnt(6)
buffer_load_dwordx4 v112, s[36:39], s81 offen offset:0 lds
v_mfma_f32_16x16x32_bf16 v[228:231], a[100:103], v[124:127], v[228:231]
s_waitcnt lgkmcnt(5)
buffer_load_dwordx4 v113, s[36:39], s81 offen offset:1024 lds
v_mfma_f32_16x16x32_bf16 v[236:239], a[104:107], v[120:123], v[236:239]
s_waitcnt lgkmcnt(4)
buffer_load_dwordx4 v114, s[36:39], s81 offen offset:2048 lds
v_mfma_f32_16x16x32_bf16 v[236:239], a[108:111], v[124:127], v[236:239]
s_waitcnt lgkmcnt(1)
buffer_load_dwordx4 v115, s[36:39], s81 offen offset:3072 lds
v_mfma_f32_16x16x32_bf16 v[244:247], a[112:115], v[120:123], v[244:247]
s_add_u32 s81, s81, 28672
v_cvt_pk_bf16_f32 v132, v132, v133
v_cvt_pk_bf16_f32 v133, v134, v135
v_mfma_f32_16x16x32_bf16 v[244:247], a[116:119], v[124:127], v[244:247]
s_add_u32 m0, s18, 102400
v_cvt_pk_bf16_f32 v134, v140, v141
v_cvt_pk_bf16_f32 v135, v142, v143
v_mfma_f32_16x16x32_bf16 v[252:255], a[120:123], v[120:123], v[252:255]
s_waitcnt lgkmcnt(0)
buffer_load_dwordx4 v112, s[36:39], s81 offen offset:0 lds
v_mfma_f32_16x16x32_bf16 v[252:255], a[124:127], v[124:127], v[252:255]
buffer_load_dwordx4 v113, s[36:39], s81 offen offset:1024 lds
buffer_load_dwordx4 v114, s[36:39], s81 offen offset:2048 lds
buffer_load_dwordx4 v115, s[36:39], s81 offen offset:3072 lds
s_sub_u32 s81, s81, 28544
s_add_u32 m0, s18, 131072
s_nop 0
buffer_load_dwordx4 v112, s[36:39], s81 offen offset:0 lds
v_cvt_pk_bf16_f32 v148, v148, v149
v_cvt_pk_bf16_f32 v149, v150, v151
v_cvt_pk_bf16_f32 v150, v156, v157
v_cvt_pk_bf16_f32 v151, v158, v159
buffer_load_dwordx4 v113, s[36:39], s81 offen offset:1024 lds
v_cvt_pk_bf16_f32 v164, v164, v165
v_cvt_pk_bf16_f32 v165, v166, v167
v_cvt_pk_bf16_f32 v166, v172, v173
v_cvt_pk_bf16_f32 v167, v174, v175
buffer_load_dwordx4 v114, s[36:39], s81 offen offset:2048 lds
v_cvt_pk_bf16_f32 v180, v180, v181
v_cvt_pk_bf16_f32 v181, v182, v183
v_cvt_pk_bf16_f32 v182, v188, v189
v_cvt_pk_bf16_f32 v183, v190, v191
buffer_load_dwordx4 v115, s[36:39], s81 offen offset:3072 lds
v_cvt_pk_bf16_f32 v196, v196, v197
v_cvt_pk_bf16_f32 v197, v198, v199
v_cvt_pk_bf16_f32 v198, v204, v205
v_cvt_pk_bf16_f32 v199, v206, v207
s_add_u32 s81, s81, 28672
s_add_u32 m0, s18, 135168
s_nop 0
buffer_load_dwordx4 v112, s[36:39], s81 offen offset:0 lds
v_cvt_pk_bf16_f32 v212, v212, v213
v_cvt_pk_bf16_f32 v213, v214, v215
v_cvt_pk_bf16_f32 v214, v220, v221
v_cvt_pk_bf16_f32 v215, v222, v223
buffer_load_dwordx4 v113, s[36:39], s81 offen offset:1024 lds
v_cvt_pk_bf16_f32 v228, v228, v229
v_cvt_pk_bf16_f32 v229, v230, v231
v_cvt_pk_bf16_f32 v230, v236, v237
v_cvt_pk_bf16_f32 v231, v238, v239
buffer_load_dwordx4 v114, s[36:39], s81 offen offset:2048 lds
v_cvt_pk_bf16_f32 v244, v244, v245
v_cvt_pk_bf16_f32 v245, v246, v247
v_cvt_pk_bf16_f32 v246, v252, v253
v_cvt_pk_bf16_f32 v247, v254, v255
buffer_load_dwordx4 v115, s[36:39], s81 offen offset:3072 lds
s_sub_u32 s81, s81, 28544
s_branch K2_done
K2_cfix:
s_nop 7
v_max_f32 v12, 0, v8
v_exp_f32 v13, -v12
v_sub_f32 v8, v8, v12
v_mul_f32 v24, v24, v13
v_mul_f32 v128, v128, v13
v_mul_f32 v129, v129, v13
v_mul_f32 v130, v130, v13
v_mul_f32 v131, v131, v13
v_mul_f32 v136, v136, v13
v_mul_f32 v137, v137, v13
v_mul_f32 v138, v138, v13
v_mul_f32 v139, v139, v13
v_mul_f32 v144, v144, v13
v_mul_f32 v145, v145, v13
v_mul_f32 v146, v146, v13
v_mul_f32 v147, v147, v13
v_mul_f32 v152, v152, v13
v_mul_f32 v153, v153, v13
v_mul_f32 v154, v154, v13
v_mul_f32 v155, v155, v13
v_mul_f32 v160, v160, v13
v_mul_f32 v161, v161, v13
v_mul_f32 v162, v162, v13
v_mul_f32 v163, v163, v13
v_mul_f32 v168, v168, v13
v_mul_f32 v169, v169, v13
v_mul_f32 v170, v170, v13
v_mul_f32 v171, v171, v13
v_mul_f32 v176, v176, v13
v_mul_f32 v177, v177, v13
v_mul_f32 v178, v178, v13
v_mul_f32 v179, v179, v13
v_mul_f32 v184, v184, v13
v_mul_f32 v185, v185, v13
v_mul_f32 v186, v186, v13
v_mul_f32 v187, v187, v13
v_mul_f32 v192, v192, v13
v_mul_f32 v193, v193, v13
v_mul_f32 v194, v194, v13
v_mul_f32 v195, v195, v13
v_mul_f32 v200, v200, v13
v_mul_f32 v201, v201, v13
v_mul_f32 v202, v202, v13
v_mul_f32 v203, v203, v13
v_mul_f32 v208, v208, v13
v_mul_f32 v209, v209, v13
v_mul_f32 v210, v210, v13
v_mul_f32 v211, v211, v13
v_mul_f32 v216, v216, v13
v_mul_f32 v217, v217, v13
v_mul_f32 v218, v218, v13
v_mul_f32 v219, v219, v13
v_mul_f32 v224, v224, v13
v_mul_f32 v225, v225, v13
v_mul_f32 v226, v226, v13
v_mul_f32 v227, v227, v13
v_mul_f32 v232, v232, v13
v_mul_f32 v233, v233, v13
v_mul_f32 v234, v234, v13
v_mul_f32 v235, v235, v13
v_mul_f32 v240, v240, v13
v_mul_f32 v241, v241, v13
v_mul_f32 v242, v242, v13
v_mul_f32 v243, v243, v13
v_mul_f32 v248, v248, v13
v_mul_f32 v249, v249, v13
v_mul_f32 v250, v250, v13
v_mul_f32 v251, v251, v13
v_max_f32 v12, 0, v10
v_exp_f32 v13, -v12
v_sub_f32 v10, v10, v12
v_mul_f32 v25, v25, v13
v_mul_f32 v132, v132, v13
v_mul_f32 v133, v133, v13
v_mul_f32 v134, v134, v13
v_mul_f32 v135, v135, v13
v_mul_f32 v140, v140, v13
v_mul_f32 v141, v141, v13
v_mul_f32 v142, v142, v13
v_mul_f32 v143, v143, v13
v_mul_f32 v148, v148, v13
v_mul_f32 v149, v149, v13
v_mul_f32 v150, v150, v13
v_mul_f32 v151, v151, v13
v_mul_f32 v156, v156, v13
v_mul_f32 v157, v157, v13
v_mul_f32 v158, v158, v13
v_mul_f32 v159, v159, v13
v_mul_f32 v164, v164, v13
v_mul_f32 v165, v165, v13
v_mul_f32 v166, v166, v13
v_mul_f32 v167, v167, v13
v_mul_f32 v172, v172, v13
v_mul_f32 v173, v173, v13
v_mul_f32 v174, v174, v13
v_mul_f32 v175, v175, v13
v_mul_f32 v180, v180, v13
v_mul_f32 v181, v181, v13
v_mul_f32 v182, v182, v13
v_mul_f32 v183, v183, v13
v_mul_f32 v188, v188, v13
v_mul_f32 v189, v189, v13
v_mul_f32 v190, v190, v13
v_mul_f32 v191, v191, v13
v_mul_f32 v196, v196, v13
v_mul_f32 v197, v197, v13
v_mul_f32 v198, v198, v13
v_mul_f32 v199, v199, v13
v_mul_f32 v204, v204, v13
v_mul_f32 v205, v205, v13
v_mul_f32 v206, v206, v13
v_mul_f32 v207, v207, v13
v_mul_f32 v212, v212, v13
v_mul_f32 v213, v213, v13
v_mul_f32 v214, v214, v13
v_mul_f32 v215, v215, v13
v_mul_f32 v220, v220, v13
v_mul_f32 v221, v221, v13
v_mul_f32 v222, v222, v13
v_mul_f32 v223, v223, v13
v_mul_f32 v228, v228, v13
v_mul_f32 v229, v229, v13
v_mul_f32 v230, v230, v13
v_mul_f32 v231, v231, v13
v_mul_f32 v236, v236, v13
v_mul_f32 v237, v237, v13
v_mul_f32 v238, v238, v13
v_mul_f32 v239, v239, v13
v_mul_f32 v244, v244, v13
v_mul_f32 v245, v245, v13
v_mul_f32 v246, v246, v13
v_mul_f32 v247, v247, v13
v_mul_f32 v252, v252, v13
v_mul_f32 v253, v253, v13
v_mul_f32 v254, v254, v13
v_mul_f32 v255, v255, v13
s_branch K2_cok
K2_tspin:
Lp_9101:
buffer_load_dword v3, off, s[4:7], s80 sc1
s_waitcnt vmcnt(0)
v_cmp_gt_u32 vcc, 1, v3
s_cbranch_vccz Lpd_9102
s_sleep 8
s_sub_u32 s101, s101, 1
s_cbranch_scc0 Lp_9101
s_mov_b32 s101, 0
Lpd_9102:
s_branch K2_tok
K2_p0d:
ds_read_b128 a[64:67], v1 offset:0
ds_read_b128 a[68:71], v1 offset:1024
ds_read_b128 a[72:75], v1 offset:2048
ds_read_b128 a[76:79], v1 offset:3072
ds_read_b128 a[80:83], v1 offset:4096
ds_read_b128 a[84:87], v1 offset:5120
ds_read_b128 a[88:91], v1 offset:6144
ds_read_b128 a[92:95], v1 offset:7168
v_cndmask_b32 v32, 0, v7, s[32:33]
v_cndmask_b32 v33, 0, v7, s[34:35]
v_cndmask_b32 v34, 0, v7, s[36:37]
v_cndmask_b32 v35, 0, v7, s[38:39]
v_cndmask_b32 v40, 0, v7, s[40:41]
v_cndmask_b32 v41, 0, v7, s[42:43]
v_cndmask_b32 v42, 0, v7, s[44:45]
v_cndmask_b32 v43, 0, v7, s[46:47]
s_waitcnt lgkmcnt(7)
v_mfma_f32_16x16x32_bf16 v[32:35], a[64:67], a[0:3], v[32:35]
s_waitcnt lgkmcnt(6)
s_add_u32 m0, s18, 65536
ds_read_b128 a[96:99], v1 offset:8192
v_mfma_f32_16x16x32_bf16 v[32:35], a[68:71], a[4:7], v[32:35]
s_waitcnt lgkmcnt(6)
buffer_load_dwordx4 v1, s[4:7], s12 offen offset:0 sc1 lds
v_mfma_f32_16x16x32_bf16 v[32:35], a[72:75], a[8:11], v[32:35]
s_waitcnt lgkmcnt(5)
ds_read_b128 a[100:103], v1 offset:9216
v_mfma_f32_16x16x32_bf16 v[32:35], a[76:79], a[12:15], v[32:35]
s_waitcnt lgkmcnt(5)
buffer_load_dwordx4 v1, s[4:7], s12 offen offset:1024 sc1 lds
v_mfma_f32_16x16x32_bf16 v[32:35], a[80:83], a[16:19], v[32:35]
s_waitcnt lgkmcnt(4)
ds_read_b128 a[104:107], v1 offset:10240
v_mfma_f32_16x16x32_bf16 v[32:35], a[84:87], a[20:23], v[32:35]
s_waitcnt lgkmcnt(4)
buffer_load_dwordx4 v1, s[4:7], s12 offen offset:2048 sc1 lds
v_mfma_f32_16x16x32_bf16 v[32:35], a[88:91], a[24:27], v[32:35]
s_waitcnt lgkmcnt(3)
ds_read_b128 a[108:111], v1 offset:11264
v_mfma_f32_16x16x32_bf16 v[32:35], a[92:95], a[28:31], v[32:35]
buffer_load_dwordx4 v1, s[4:7], s12 offen offset:3072 sc1 lds
v_mfma_f32_16x16x32_bf16 v[36:39], a[64:67], a[32:35], 0
s_add_u32 s12, s12, 4096
s_add_u32 m0, s18, 69632
ds_read_b128 a[112:115], v1 offset:12288
v_mfma_f32_16x16x32_bf16 v[36:39], a[68:71], a[36:39], v[36:39]
buffer_load_dwordx4 v1, s[4:7], s12 offen offset:0 sc1 lds
v_mfma_f32_16x16x32_bf16 v[36:39], a[72:75], a[40:43], v[36:39]
ds_read_b128 a[116:119], v1 offset:13312
v_mfma_f32_16x16x32_bf16 v[36:39], a[76:79], a[44:47], v[36:39]
buffer_load_dwordx4 v1, s[4:7], s12 offen offset:1024 sc1 lds
v_mfma_f32_16x16x32_bf16 v[36:39], a[80:83], a[48:51], v[36:39]
ds_read_b128 a[120:123], v1 offset:14336
v_max3_f32 v28, v32, v33, v34
v_mfma_f32_16x16x32_bf16 v[36:39], a[84:87], a[52:55], v[36:39]
buffer_load_dwordx4 v1, s[4:7], s12 offen offset:2048 sc1 lds
v_mfma_f32_16x16x32_bf16 v[36:39], a[88:91], a[56:59], v[36:39]
ds_read_b128 a[124:127], v1 offset:15360
v_max_f32 v28, v28, v35
v_mfma_f32_16x16x32_bf16 v[36:39], a[92:95], a[60:63], v[36:39]
s_waitcnt lgkmcnt(3)
buffer_load_dwordx4 v1, s[4:7], s12 offen offset:3072 sc1 lds
v_mfma_f32_16x16x32_bf16 v[40:43], a[96:99], a[0:3], v[40:43]
s_add_u32 s12, s12, 28672
ds_read_b128 a[64:67], v1 offset:16384
v_mov_b32 v30, v28
v_mfma_f32_16x16x32_bf16 v[40:43], a[100:103], a[4:7], v[40:43]
s_waitcnt lgkmcnt(2)
s_sub_u32 s13, s13, 1
v_mfma_f32_16x16x32_bf16 v[40:43], a[104:107], a[8:11], v[40:43]
s_cmp_eq_u32 s13, 0
ds_read_b128 a[68:71], v1 offset:17408
v_permlane16_swap_b32 v28, v30
v_mfma_f32_16x16x32_bf16 v[40:43], a[108:111], a[12:15], v[40:43]
s_cselect_b32 s12, s14, s12
v_max_f32 v28, v28, v30
v_mov_b32 v30, v28
v_mfma_f32_16x16x32_bf16 v[40:43], a[112:115], a[16:19], v[40:43]
s_cselect_b32 s13, s15, s13
ds_read_b128 a[72:75], v1 offset:18432
v_max3_f32 v29, v36, v37, v38
v_mfma_f32_16x16x32_bf16 v[40:43], a[116:119], a[20:23], v[40:43]
s_cselect_b32 s14, 3221225472, s14
v_permlane32_swap_b32 v28, v30
v_max_f32 v28, v28, v30
v_mfma_f32_16x16x32_bf16 v[40:43], a[120:123], a[24:27], v[40:43]
s_waitcnt lgkmcnt(3)
ds_read_b128 a[76:79], v1 offset:19456
v_sub_f32 v16, 0, v28
v_mfma_f32_16x16x32_bf16 v[40:43], a[124:127], a[28:31], v[40:43]
v_sub_f32 v17, 0, v28
v_sub_f32 v18, 0, v28
v_mfma_f32_16x16x32_bf16 v[44:47], a[96:99], a[32:35], 0
ds_read_b128 a[80:83], v1 offset:20480
v_sub_f32 v19, 0, v28
v_mfma_f32_16x16x32_bf16 v[44:47], a[100:103], a[36:39], v[44:47]
v_max_f32 v29, v29, v39
v_mov_b32 v31, v29
v_cndmask_b32 v48, v16, v7, s[48:49]
v_mfma_f32_16x16x32_bf16 v[44:47], a[104:107], a[40:43], v[44:47]
ds_read_b128 a[84:87], v1 offset:21504
v_cndmask_b32 v49, v16, v7, s[50:51]
v_mfma_f32_16x16x32_bf16 v[44:47], a[108:111], a[44:47], v[44:47]
v_permlane16_swap_b32 v29, v31
v_max_f32 v29, v29, v31
v_cndmask_b32 v50, v16, v7, s[52:53]
v_mfma_f32_16x16x32_bf16 v[44:47], a[112:115], a[48:51], v[44:47]
ds_read_b128 a[88:91], v1 offset:22528
v_mov_b32 v31, v29
v_cndmask_b32 v51, v16, v7, s[54:55]
v_mfma_f32_16x16x32_bf16 v[44:47], a[116:119], a[52:55], v[44:47]
v_cndmask_b32 v56, v16, v7, s[56:57]
v_cndmask_b32 v57, v16, v7, s[58:59]
v_mfma_f32_16x16x32_bf16 v[44:47], a[120:123], a[56:59], v[44:47]
ds_read_b128 a[92:95], v1 offset:23552
v_permlane32_swap_b32 v29, v31
v_mfma_f32_16x16x32_bf16 v[44:47], a[124:127], a[60:63], v[44:47]
s_waitcnt lgkmcnt(3)
v_max_f32 v29, v29, v31
v_sub_f32 v20, 0, v29
v_mfma_f32_16x16x32_bf16 v[48:51], a[64:67], a[0:3], v[48:51]
ds_read_b128 a[96:99], v1 offset:24576
v_sub_f32 v21, 0, v29
v_mfma_f32_16x16x32_bf16 v[48:51], a[68:71], a[4:7], v[48:51]
v_sub_f32 v22, 0, v29
v_sub_f32 v23, 0, v29
v_mfma_f32_16x16x32_bf16 v[48:51], a[72:75], a[8:11], v[48:51]
ds_read_b128 a[100:103], v1 offset:25600
v_cndmask_b32 v58, v16, v7, s[60:61]
v_mfma_f32_16x16x32_bf16 v[48:51], a[76:79], a[12:15], v[48:51]
v_cndmask_b32 v59, v16, v7, s[62:63]
v_mfma_f32_16x16x32_bf16 v[48:51], a[80:83], a[16:19], v[48:51]
s_waitcnt lgkmcnt(3)
ds_read_b128 a[104:107], v1 offset:26624
v_mfma_f32_16x16x32_bf16 v[48:51], a[84:87], a[20:23], v[48:51]
v_add_f32 v32, v32, v16
v_add_f32 v33, v33, v16
v_add_f32 v34, v34, v16
v_add_f32 v35, v35, v16
v_mfma_f32_16x16x32_bf16 v[48:51], a[88:91], a[24:27], v[48:51]
s_waitcnt lgkmcnt(3)
ds_read_b128 a[108:111], v1 offset:27648
v_add_f32 v36, v36, v20
v_add_f32 v37, v37, v20
v_add_f32 v38, v38, v20
v_add_f32 v39, v39, v20
v_mfma_f32_16x16x32_bf16 v[48:51], a[92:95], a[28:31], v[48:51]
v_add_f32 v40, v40, v16
v_add_f32 v41, v41, v16
v_add_f32 v42, v42, v16
v_add_f32 v43, v43, v16
v_mfma_f32_16x16x32_bf16 v[52:55], a[64:67], a[32:35], v[20:23]
ds_read_b128 a[112:115], v1 offset:28672
v_add_f32 v44, v44, v20
v_add_f32 v45, v45, v20
v_add_f32 v46, v46, v20
v_add_f32 v47, v47, v20
v_mfma_f32_16x16x32_bf16 v[52:55], a[68:71], a[36:39], v[52:55]
v_exp_f32 v8, v32
v_mfma_f32_16x16x32_bf16 v[52:55], a[72:75], a[40:43], v[52:55]
ds_read_b128 a[116:119], v1 offset:29696
v_exp_f32 v9, v33
v_mfma_f32_16x16x32_bf16 v[52:55], a[76:79], a[44:47], v[52:55]
v_exp_f32 v10, v34
v_add_f32 v26, v8, v9
v_cvt_pk_bf16_f32 v96, v8, v9
v_mfma_f32_16x16x32_bf16 v[52:55], a[80:83], a[48:51], v[52:55]
ds_read_b128 a[120:123], v1 offset:30720
v_exp_f32 v11, v35
v_add_f32 v26, v26, v10
v_mfma_f32_16x16x32_bf16 v[52:55], a[84:87], a[52:55], v[52:55]
v_exp_f32 v12, v36
v_add_f32 v26, v26, v11
v_cvt_pk_bf16_f32 v97, v10, v11
v_mfma_f32_16x16x32_bf16 v[52:55], a[88:91], a[56:59], v[52:55]
s_waitcnt vmcnt(8) lgkmcnt(3)
ds_read_b128 a[124:127], v1 offset:31744
v_exp_f32 v13, v37
v_mfma_f32_16x16x32_bf16 v[52:55], a[92:95], a[60:63], v[52:55]
s_barrier
v_mfma_f32_16x16x32_bf16 v[56:59], a[96:99], a[0:3], v[56:59]
ds_read_b128 a[64:67], v4 offset:0
v_exp_f32 v14, v38
v_mfma_f32_16x16x32_bf16 v[56:59], a[100:103], a[4:7], v[56:59]
buffer_store_dword v6, v5, s[4:7], s71 offen sc1
v_mfma_f32_16x16x32_bf16 v[56:59], a[104:107], a[8:11], v[56:59]
ds_read_b128 a[68:71], v4 offset:1024
v_add_f32 v27, v12, v13
v_cvt_pk_bf16_f32 v104, v12, v13
v_add_f32 v27, v27, v14
v_mfma_f32_16x16x32_bf16 v[56:59], a[108:111], a[12:15], v[56:59]
s_waitcnt lgkmcnt(3)
v_exp_f32 v15, v39
v_mfma_f32_16x16x32_bf16 v[56:59], a[112:115], a[16:19], v[56:59]
ds_read_b128 a[72:75], v4 offset:2048
v_exp_f32 v8, v40
v_add_f32 v27, v27, v15
v_cvt_pk_bf16_f32 v105, v14, v15
v_mfma_f32_16x16x32_bf16 v[56:59], a[116:119], a[20:23], v[56:59]
v_exp_f32 v9, v41
v_add_f32 v26, v26, v8
v_mfma_f32_16x16x32_bf16 v[56:59], a[120:123], a[24:27], v[56:59]
s_waitcnt lgkmcnt(3)
ds_read_b128 a[76:79], v4 offset:3072
v_exp_f32 v10, v42
v_add_f32 v26, v26, v9
v_cvt_pk_bf16_f32 v98, v8, v9
v_mfma_f32_16x16x32_bf16 v[56:59], a[124:127], a[28:31], v[56:59]
v_exp_f32 v11, v43
v_add_f32 v26, v26, v10
v_mfma_f32_16x16x32_bf16 v[60:63], a[96:99], a[32:35], v[20:23]
ds_read_b128 a[80:83], v4 offset:4096
v_exp_f32 v12, v44
v_mfma_f32_16x16x32_bf16 v[60:63], a[100:103], a[36:39], v[60:63]
v_exp_f32 v13, v45
v_mfma_f32_16x16x32_bf16 v[60:63], a[104:107], a[40:43], v[60:63]
ds_read_b128 a[84:87], v4 offset:5120
v_exp_f32 v14, v46
v_mfma_f32_16x16x32_bf16 v[60:63], a[108:111], a[44:47], v[60:63]
v_exp_f32 v15, v47
v_mfma_f32_16x16x32_bf16 v[60:63], a[112:115], a[48:51], v[60:63]
ds_read_b128 a[88:91], v4 offset:6144
v_add_f32 v26, v26, v11
v_cvt_pk_bf16_f32 v99, v10, v11
v_mfma_f32_16x16x32_bf16 v[60:63], a[116:119], a[52:55], v[60:63]
v_add_f32 v27, v27, v12
v_add_f32 v27, v27, v13
v_cvt_pk_bf16_f32 v106, v12, v13
v_mfma_f32_16x16x32_bf16 v[60:63], a[120:123], a[56:59], v[60:63]
s_waitcnt lgkmcnt(7)
s_barrier
ds_read_b128 a[92:95], v4 offset:7168
v_mfma_f32_16x16x32_bf16 v[60:63], a[124:127], a[60:63], v[60:63]
s_waitcnt lgkmcnt(3)
v_add_f32 v27, v27, v14
v_add_f32 v27, v27, v15
v_cvt_pk_bf16_f32 v107, v14, v15
s_branch K2_dx1
K2_ntail:
v_mfma_f32_16x16x32_bf16 v[128:131], a[64:67], v[96:99], v[128:131]
s_add_u32 m0, s18, 98304
ds_read_b128 a[96:99], v2 offset:8192
v_add_f32 v24, v24, v26
v_mfma_f32_16x16x32_bf16 v[128:131], a[68:71], v[100:103], v[128:131]
buffer_load_dwordx4 v1, s[4:7], s12 offen offset:0 sc1 lds
v_mfma_f32_16x16x32_bf16 v[132:135], a[68:71], v[108:111], v[132:135]
ds_read_b128 a[100:103], v2 offset:9216
v_add_f32 v25, v25, v27
v_mfma_f32_16x16x32_bf16 v[132:135], a[64:67], v[104:107], v[132:135]
buffer_load_dwordx4 v1, s[4:7], s12 offen offset:1024 sc1 lds
v_mfma_f32_16x16x32_bf16 v[136:139], a[72:75], v[96:99], v[136:139]
ds_read_b128 a[104:107], v2 offset:10240
v_exp_f32 v8, v64
v_mfma_f32_16x16x32_bf16 v[136:139], a[76:79], v[100:103], v[136:139]
buffer_load_dwordx4 v1, s[4:7], s12 offen offset:2048 sc1 lds
v_mfma_f32_16x16x32_bf16 v[140:143], a[76:79], v[108:111], v[140:143]
ds_read_b128 a[108:111], v2 offset:11264
v_mfma_f32_16x16x32_bf16 v[140:143], a[72:75], v[104:107], v[140:143]
s_waitcnt lgkmcnt(3)
buffer_load_dwordx4 v1, s[4:7], s12 offen offset:3072 sc1 lds
v_mfma_f32_16x16x32_bf16 v[144:147], a[80:83], v[96:99], v[144:147]
s_add_u32 s12, s12, 4096
s_add_u32 m0, s18, 102400
ds_read_b128 a[112:115], v2 offset:12288
v_mfma_f32_16x16x32_bf16 v[144:147], a[84:87], v[100:103], v[144:147]
buffer_load_dwordx4 v1, s[4:7], s12 offen offset:0 sc1 lds
v_mfma_f32_16x16x32_bf16 v[148:151], a[84:87], v[108:111], v[148:151]
ds_read_b128 a[116:119], v2 offset:13312
v_exp_f32 v9, v65
v_mfma_f32_16x16x32_bf16 v[148:151], a[80:83], v[104:107], v[148:151]
buffer_load_dwordx4 v1, s[4:7], s12 offen offset:1024 sc1 lds
v_mfma_f32_16x16x32_bf16 v[152:155], a[88:91], v[96:99], v[152:155]
ds_read_b128 a[120:123], v2 offset:14336
v_add_f32 v26, v8, v9
v_cvt_pk_bf16_f32 v112, v8, v9
v_mfma_f32_16x16x32_bf16 v[152:155], a[92:95], v[100:103], v[152:155]
buffer_load_dwordx4 v1, s[4:7], s12 offen offset:2048 sc1 lds
v_mfma_f32_16x16x32_bf16 v[156:159], a[92:95], v[108:111], v[156:159]
ds_read_b128 a[124:127], v2 offset:15360
v_exp_f32 v10, v66
v_mfma_f32_16x16x32_bf16 v[156:159], a[88:91], v[104:107], v[156:159]
s_waitcnt lgkmcnt(3)
buffer_load_dwordx4 v1, s[4:7], s12 offen offset:3072 sc1 lds
v_mfma_f32_16x16x32_bf16 v[160:163], a[96:99], v[96:99], v[160:163]
s_add_u32 s12, s12, 28672
ds_read_b128 a[64:67], v2 offset:16384
v_add_f32 v26, v26, v10
v_mfma_f32_16x16x32_bf16 v[160:163], a[100:103], v[100:103], v[160:163]
s_sub_u32 s13, s13, 1
v_exp_f32 v11, v67
v_mfma_f32_16x16x32_bf16 v[164:167], a[100:103], v[108:111], v[164:167]
s_cmp_eq_u32 s13, 0
ds_read_b128 a[68:71], v2 offset:17408
v_exp_f32 v12, v68
v_mfma_f32_16x16x32_bf16 v[164:167], a[96:99], v[104:107], v[164:167]
s_cselect_b32 s12, s14, s12
v_exp_f32 v13, v69
v_mfma_f32_16x16x32_bf16 v[168:171], a[104:107], v[96:99], v[168:171]
s_cselect_b32 s13, s15, s13
ds_read_b128 a[72:75], v2 offset:18432
v_add_f32 v26, v26, v11
v_cvt_pk_bf16_f32 v113, v10, v11
v_mfma_f32_16x16x32_bf16 v[168:171], a[108:111], v[100:103], v[168:171]
s_cselect_b32 s14, 3221225472, s14
v_exp_f32 v14, v70
v_mfma_f32_16x16x32_bf16 v[172:175], a[108:111], v[108:111], v[172:175]
ds_read_b128 a[76:79], v2 offset:19456
v_exp_f32 v15, v71
v_mfma_f32_16x16x32_bf16 v[172:175], a[104:107], v[104:107], v[172:175]
v_exp_f32 v8, v72
v_mfma_f32_16x16x32_bf16 v[176:179], a[112:115], v[96:99], v[176:179]
s_waitcnt lgkmcnt(3)
ds_read_b128 a[80:83], v2 offset:20480
v_add_f32 v27, v12, v13
v_cvt_pk_bf16_f32 v120, v12, v13
v_add_f32 v27, v27, v14
v_add_f32 v27, v27, v15
v_cvt_pk_bf16_f32 v121, v14, v15
v_mfma_f32_16x16x32_bf16 v[176:179], a[116:119], v[100:103], v[176:179]
v_exp_f32 v9, v73
v_mfma_f32_16x16x32_bf16 v[180:183], a[116:119], v[108:111], v[180:183]
ds_read_b128 a[84:87], v2 offset:21504
v_exp_f32 v10, v74
v_mfma_f32_16x16x32_bf16 v[180:183], a[112:115], v[104:107], v[180:183]
v_exp_f32 v11, v75
v_mfma_f32_16x16x32_bf16 v[184:187], a[120:123], v[96:99], v[184:187]
ds_read_b128 a[88:91], v2 offset:22528
v_add_f32 v26, v26, v8
v_mfma_f32_16x16x32_bf16 v[184:187], a[124:127], v[100:103], v[184:187]
v_exp_f32 v12, v76
v_mfma_f32_16x16x32_bf16 v[188:191], a[124:127], v[108:111], v[188:191]
ds_read_b128 a[92:95], v2 offset:23552
v_add_f32 v26, v26, v9
v_cvt_pk_bf16_f32 v114, v8, v9
v_add_f32 v26, v26, v10
v_add_f32 v26, v26, v11
v_cvt_pk_bf16_f32 v115, v10, v11
v_mfma_f32_16x16x32_bf16 v[188:191], a[120:123], v[104:107], v[188:191]
v_exp_f32 v13, v77
v_mfma_f32_16x16x32_bf16 v[192:195], a[64:67], v[96:99], v[192:195]
s_waitcnt lgkmcnt(3)
ds_read_b128 a[96:99], v2 offset:24576
v_exp_f32 v14, v78
v_mfma_f32_16x16x32_bf16 v[192:195], a[68:71], v[100:103], v[192:195]
v_exp_f32 v15, v79
v_mfma_f32_16x16x32_bf16 v[196:199], a[68:71], v[108:111], v[196:199]
ds_read_b128 a[100:103], v2 offset:25600
v_add_f32 v27, v27, v12
v_add_f32 v27, v27, v13
v_cvt_pk_bf16_f32 v122, v12, v13
v_add_f32 v27, v27, v14
v_mfma_f32_16x16x32_bf16 v[196:199], a[64:67], v[104:107], v[196:199]
v_exp_f32 v8, v80
v_mfma_f32_16x16x32_bf16 v[200:203], a[72:75], v[96:99], v[200:203]
ds_read_b128 a[104:107], v2 offset:26624
v_exp_f32 v9, v81
v_mfma_f32_16x16x32_bf16 v[200:203], a[76:79], v[100:103], v[200:203]
v_exp_f32 v10, v82
v_mfma_f32_16x16x32_bf16 v[204:207], a[76:79], v[108:111], v[204:207]
ds_read_b128 a[108:111], v2 offset:27648
v_add_f32 v27, v27, v15
v_cvt_pk_bf16_f32 v123, v14, v15
v_add_f32 v26, v26, v8
v_add_f32 v26, v26, v9
v_cvt_pk_bf16_f32 v116, v8, v9
v_mfma_f32_16x16x32_bf16 v[204:207], a[72:75], v[104:107], v[204:207]
v_exp_f32 v11, v83
v_mfma_f32_16x16x32_bf16 v[208:211], a[80:83], v[96:99], v[208:211]
s_waitcnt lgkmcnt(3)
ds_read_b128 a[112:115], v2 offset:28672
v_exp_f32 v12, v84
v_mfma_f32_16x16x32_bf16 v[208:211], a[84:87], v[100:103], v[208:211]
v_exp_f32 v13, v85
v_mfma_f32_16x16x32_bf16 v[212:215], a[84:87], v[108:111], v[212:215]
ds_read_b128 a[116:119], v2 offset:29696
v_add_f32 v26, v26, v10
v_add_f32 v26, v26, v11
v_cvt_pk_bf16_f32 v117, v10, v11
v_add_f32 v27, v27, v12
v_mfma_f32_16x16x32_bf16 v[212:215], a[80:83], v[104:107], v[212:215]
v_exp_f32 v14, v86
v_mfma_f32_16x16x32_bf16 v[216:219], a[88:91], v[96:99], v[216:219]
ds_read_b128 a[120:123], v2 offset:30720
v_exp_f32 v15, v87
v_mfma_f32_16x16x32_bf16 v[216:219], a[92:95], v[100:103], v[216:219]
v_exp_f32 v8, v88
v_mfma_f32_16x16x32_bf16 v[220:223], a[92:95], v[108:111], v[220:223]
s_waitcnt vmcnt(0)
ds_read_b128 a[124:127], v2 offset:31744
v_add_f32 v27, v27, v13
v_cvt_pk_bf16_f32 v124, v12, v13
v_add_f32 v27, v27, v14
v_add_f32 v27, v27, v15
v_cvt_pk_bf16_f32 v125, v14, v15
v_mfma_f32_16x16x32_bf16 v[220:223], a[88:91], v[104:107], v[220:223]
s_barrier
v_mfma_f32_16x16x32_bf16 v[224:227], a[96:99], v[96:99], v[224:227]
s_waitcnt lgkmcnt(3)
ds_read_b128 a[64:67], v2 offset:32768
v_exp_f32 v9, v89
v_mfma_f32_16x16x32_bf16 v[224:227], a[100:103], v[100:103], v[224:227]
v_exp_f32 v10, v90
v_mfma_f32_16x16x32_bf16 v[228:231], a[100:103], v[108:111], v[228:231]
ds_read_b128 a[68:71], v2 offset:33792
v_add_f32 v26, v26, v8
v_add_f32 v26, v26, v9
v_cvt_pk_bf16_f32 v118, v8, v9
v_mfma_f32_16x16x32_bf16 v[228:231], a[96:99], v[104:107], v[228:231]
v_exp_f32 v11, v91
v_mfma_f32_16x16x32_bf16 v[232:235], a[104:107], v[96:99], v[232:235]
ds_read_b128 a[72:75], v2 offset:34816
v_exp_f32 v12, v92
v_mfma_f32_16x16x32_bf16 v[232:235], a[108:111], v[100:103], v[232:235]
v_exp_f32 v13, v93
v_mfma_f32_16x16x32_bf16 v[236:239], a[108:111], v[108:111], v[236:239]
ds_read_b128 a[76:79], v2 offset:35840
v_add_f32 v26, v26, v10
v_mfma_f32_16x16x32_bf16 v[236:239], a[104:107], v[104:107], v[236:239]
v_exp_f32 v14, v94
v_mfma_f32_16x16x32_bf16 v[240:243], a[112:115], v[96:99], v[240:243]
s_waitcnt lgkmcnt(3)
ds_read_b128 a[80:83], v2 offset:36864
v_add_f32 v26, v26, v11
v_cvt_pk_bf16_f32 v119, v10, v11
v_add_f32 v27, v27, v12
v_mfma_f32_16x16x32_bf16 v[240:243], a[116:119], v[100:103], v[240:243]
v_exp_f32 v15, v95
v_mfma_f32_16x16x32_bf16 v[244:247], a[116:119], v[108:111], v[244:247]
ds_read_b128 a[84:87], v2 offset:37888
v_add_f32 v27, v27, v13
v_cvt_pk_bf16_f32 v126, v12, v13
v_mfma_f32_16x16x32_bf16 v[244:247], a[112:115], v[104:107], v[244:247]
v_add_f32 v27, v27, v14
v_add_f32 v27, v27, v15
v_mfma_f32_16x16x32_bf16 v[248:251], a[120:123], v[96:99], v[248:251]
ds_read_b128 a[88:91], v2 offset:38912
v_cvt_pk_bf16_f32 v127, v14, v15
v_mfma_f32_16x16x32_bf16 v[248:251], a[124:127], v[100:103], v[248:251]
v_add_f32 v28, v26, v27
v_cmp_nge_f32 vcc, s25, v28
v_mfma_f32_16x16x32_bf16 v[252:255], a[124:127], v[108:111], v[252:255]
ds_read_b128 a[92:95], v2 offset:39936
v_mfma_f32_16x16x32_bf16 v[252:255], a[120:123], v[104:107], v[252:255]
s_waitcnt lgkmcnt(3)
s_cbranch_vccnz Lstub_14
Lback_15:
v_mfma_f32_16x16x32_bf16 v[128:131], a[64:67], v[112:115], v[128:131]
s_add_u32 m0, s18, 131072
ds_read_b128 a[96:99], v2 offset:40960
v_add_f32 v24, v24, v26
v_mfma_f32_16x16x32_bf16 v[128:131], a[68:71], v[116:119], v[128:131]
buffer_load_dwordx4 v1, s[4:7], s8 offen offset:0 sc1 lds
v_mfma_f32_16x16x32_bf16 v[132:135], a[68:71], v[124:127], v[132:135]
ds_read_b128 a[100:103], v2 offset:41984
v_add_f32 v25, v25, v27
v_mfma_f32_16x16x32_bf16 v[132:135], a[64:67], v[120:123], v[132:135]
buffer_load_dwordx4 v1, s[4:7], s8 offen offset:1024 sc1 lds
v_mfma_f32_16x16x32_bf16 v[136:139], a[72:75], v[112:115], v[136:139]
ds_read_b128 a[104:107], v2 offset:43008
v_mov_b32 v8, v16
v_mfma_f32_16x16x32_bf16 v[136:139], a[76:79], v[116:119], v[136:139]
buffer_load_dwordx4 v1, s[4:7], s8 offen offset:2048 sc1 lds
v_mfma_f32_16x16x32_bf16 v[140:143], a[76:79], v[124:127], v[140:143]
ds_read_b128 a[108:111], v2 offset:44032
v_mov_b32 v9, v24
v_mfma_f32_16x16x32_bf16 v[140:143], a[72:75], v[120:123], v[140:143]
s_waitcnt lgkmcnt(3)
buffer_load_dwordx4 v1, s[4:7], s8 offen offset:3072 sc1 lds
v_mfma_f32_16x16x32_bf16 v[144:147], a[80:83], v[112:115], v[144:147]
s_add_u32 s8, s8, 4096
s_add_u32 m0, s18, 135168
ds_read_b128 a[112:115], v2 offset:45056
v_mfma_f32_16x16x32_bf16 v[144:147], a[84:87], v[116:119], v[144:147]
buffer_load_dwordx4 v1, s[4:7], s8 offen offset:0 sc1 lds
v_mfma_f32_16x16x32_bf16 v[148:151], a[84:87], v[124:127], v[148:151]
ds_read_b128 a[116:119], v2 offset:46080
v_mov_b32 v10, v20
v_mfma_f32_16x16x32_bf16 v[148:151], a[80:83], v[120:123], v[148:151]
buffer_load_dwordx4 v1, s[4:7], s8 offen offset:1024 sc1 lds
v_mfma_f32_16x16x32_bf16 v[152:155], a[88:91], v[112:115], v[152:155]
ds_read_b128 a[120:123], v2 offset:47104
v_mov_b32 v11, v25
v_mfma_f32_16x16x32_bf16 v[152:155], a[92:95], v[116:119], v[152:155]
buffer_load_dwordx4 v1, s[4:7], s8 offen offset:2048 sc1 lds
v_mfma_f32_16x16x32_bf16 v[156:159], a[92:95], v[124:127], v[156:159]
ds_read_b128 a[124:127], v2 offset:48128
v_cvt_pk_bf16_f32 v128, v128, v129
v_mfma_f32_16x16x32_bf16 v[156:159], a[88:91], v[120:123], v[156:159]
s_waitcnt lgkmcnt(3)
buffer_load_dwordx4 v1, s[4:7], s8 offen offset:3072 sc1 lds
v_mfma_f32_16x16x32_bf16 v[160:163], a[96:99], v[112:115], v[160:163]
s_add_u32 s8, s8, 28672
ds_read_b128 a[64:67], v2 offset:49152
v_cvt_pk_bf16_f32 v129, v130, v131
v_mfma_f32_16x16x32_bf16 v[160:163], a[100:103], v[116:119], v[160:163]
s_sub_u32 s9, s9, 1
buffer_store_dwordx4 v[8:11], v1, s[4:7], s27 offen sc1
v_mfma_f32_16x16x32_bf16 v[164:167], a[100:103], v[124:127], v[164:167]
s_cmp_eq_u32 s9, 0
ds_read_b128 a[68:71], v2 offset:50176
v_cvt_pk_bf16_f32 v130, v136, v137
v_mfma_f32_16x16x32_bf16 v[164:167], a[96:99], v[120:123], v[164:167]
s_cselect_b32 s8, s10, s8
v_cvt_pk_bf16_f32 v131, v138, v139
v_accvgpr_mov_b32 a0, a192
v_mfma_f32_16x16x32_bf16 v[168:171], a[104:107], v[112:115], v[168:171]
s_cselect_b32 s9, s11, s9
ds_read_b128 a[72:75], v2 offset:51200
v_accvgpr_mov_b32 a1, a193
v_mfma_f32_16x16x32_bf16 v[168:171], a[108:111], v[116:119], v[168:171]
s_cselect_b32 s10, 3221225472, s10
buffer_store_dwordx4 v[128:131], v1, s[4:7], s76 offen offset:0 sc1
v_mfma_f32_16x16x32_bf16 v[172:175], a[108:111], v[124:127], v[172:175]
ds_read_b128 a[76:79], v2 offset:52224
v_cvt_pk_bf16_f32 v132, v132, v133
v_mfma_f32_16x16x32_bf16 v[172:175], a[104:107], v[120:123], v[172:175]
v_cvt_pk_bf16_f32 v133, v134, v135
v_cvt_pk_bf16_f32 v134, v140, v141
v_mfma_f32_16x16x32_bf16 v[176:179], a[112:115], v[112:115], v[176:179]
s_waitcnt lgkmcnt(3)
ds_read_b128 a[80:83], v2 offset:53248
v_cvt_pk_bf16_f32 v135, v142, v143
v_mfma_f32_16x16x32_bf16 v[176:179], a[116:119], v[116:119], v[176:179]
buffer_store_dwordx4 v[132:135], v1, s[4:7], s77 offen offset:0 sc1
v_mfma_f32_16x16x32_bf16 v[180:183], a[116:119], v[124:127], v[180:183]
ds_read_b128 a[84:87], v2 offset:54272
v_cvt_pk_bf16_f32 v144, v144, v145
v_mfma_f32_16x16x32_bf16 v[180:183], a[112:115], v[120:123], v[180:183]
v_cvt_pk_bf16_f32 v145, v146, v147
v_cvt_pk_bf16_f32 v146, v152, v153
v_mfma_f32_16x16x32_bf16 v[184:187], a[120:123], v[112:115], v[184:187]
ds_read_b128 a[88:91], v2 offset:55296
v_cvt_pk_bf16_f32 v147, v154, v155
v_mfma_f32_16x16x32_bf16 v[184:187], a[124:127], v[116:119], v[184:187]
buffer_store_dwordx4 v[144:147], v1, s[4:7], s76 offen offset:1024 sc1
v_mfma_f32_16x16x32_bf16 v[188:191], a[124:127], v[124:127], v[188:191]
ds_read_b128 a[92:95], v2 offset:56320
v_cvt_pk_bf16_f32 v148, v148, v149
v_mfma_f32_16x16x32_bf16 v[188:191], a[120:123], v[120:123], v[188:191]
v_cvt_pk_bf16_f32 v149, v150, v151
v_cvt_pk_bf16_f32 v150, v156, v157
v_mfma_f32_16x16x32_bf16 v[192:195], a[64:67], v[112:115], v[192:195]
s_waitcnt lgkmcnt(3)
ds_read_b128 a[96:99], v2 offset:57344
v_cvt_pk_bf16_f32 v151, v158, v159
v_mfma_f32_16x16x32_bf16 v[192:195], a[68:71], v[116:119], v[192:195]
buffer_store_dwordx4 v[148:151], v1, s[4:7], s77 offen offset:1024 sc1
v_mfma_f32_16x16x32_bf16 v[196:199], a[68:71], v[124:127], v[196:199]
ds_read_b128 a[100:103], v2 offset:58368
v_cvt_pk_bf16_f32 v160, v160, v161
v_mfma_f32_16x16x32_bf16 v[196:199], a[64:67], v[120:123], v[196:199]
v_cvt_pk_bf16_f32 v161, v162, v163
v_cvt_pk_bf16_f32 v162, v168, v169
v_mfma_f32_16x16x32_bf16 v[200:203], a[72:75], v[112:115], v[200:203]
ds_read_b128 a[104:107], v2 offset:59392
v_cvt_pk_bf16_f32 v163, v170, v171
v_mfma_f32_16x16x32_bf16 v[200:203], a[76:79], v[116:119], v[200:203]
buffer_store_dwordx4 v[160:163], v1, s[4:7], s76 offen offset:2048 sc1
v_mfma_f32_16x16x32_bf16 v[204:207], a[76:79], v[124:127], v[204:207]
ds_read_b128 a[108:111], v2 offset:60416
v_cvt_pk_bf16_f32 v164, v164, v165
v_mfma_f32_16x16x32_bf16 v[204:207], a[72:75], v[120:123], v[204:207]
v_cvt_pk_bf16_f32 v165, v166, v167
v_cvt_pk_bf16_f32 v166, v172, v173
v_mfma_f32_16x16x32_bf16 v[208:211], a[80:83], v[112:115], v[208:211]
s_waitcnt lgkmcnt(3)
ds_read_b128 a[112:115], v2 offset:61440
v_cvt_pk_bf16_f32 v167, v174, v175
v_mfma_f32_16x16x32_bf16 v[208:211], a[84:87], v[116:119], v[208:211]
buffer_store_dwordx4 v[164:167], v1, s[4:7], s77 offen offset:2048 sc1
v_mfma_f32_16x16x32_bf16 v[212:215], a[84:87], v[124:127], v[212:215]
ds_read_b128 a[116:119], v2 offset:62464
v_cvt_pk_bf16_f32 v176, v176, v177
v_mfma_f32_16x16x32_bf16 v[212:215], a[80:83], v[120:123], v[212:215]
v_cvt_pk_bf16_f32 v177, v178, v179
v_cvt_pk_bf16_f32 v178, v184, v185
v_mfma_f32_16x16x32_bf16 v[216:219], a[88:91], v[112:115], v[216:219]
ds_read_b128 a[120:123], v2 offset:63488
v_cvt_pk_bf16_f32 v179, v186, v187
v_mfma_f32_16x16x32_bf16 v[216:219], a[92:95], v[116:119], v[216:219]
buffer_store_dwordx4 v[176:179], v1, s[4:7], s76 offen offset:3072 sc1
v_mfma_f32_16x16x32_bf16 v[220:223], a[92:95], v[124:127], v[220:223]
ds_read_b128 a[124:127], v2 offset:64512
v_cvt_pk_bf16_f32 v180, v180, v181
v_mfma_f32_16x16x32_bf16 v[220:223], a[88:91], v[120:123], v[220:223]
v_cvt_pk_bf16_f32 v181, v182, v183
v_cvt_pk_bf16_f32 v182, v188, v189
v_mfma_f32_16x16x32_bf16 v[224:227], a[96:99], v[112:115], v[224:227]
s_waitcnt lgkmcnt(3)
v_cvt_pk_bf16_f32 v183, v190, v191
v_accvgpr_mov_b32 a2, a194
v_mfma_f32_16x16x32_bf16 v[224:227], a[100:103], v[116:119], v[224:227]
buffer_store_dwordx4 v[180:183], v1, s[4:7], s77 offen offset:3072 sc1
v_mfma_f32_16x16x32_bf16 v[228:231], a[100:103], v[124:127], v[228:231]
s_add_u32 s76, s76, 4096
v_accvgpr_mov_b32 a3, a195
v_accvgpr_mov_b32 a4, a196
v_mfma_f32_16x16x32_bf16 v[228:231], a[96:99], v[120:123], v[228:231]
s_add_u32 s77, s77, 4096
v_cvt_pk_bf16_f32 v192, v192, v193
v_cvt_pk_bf16_f32 v193, v194, v195
v_mfma_f32_16x16x32_bf16 v[232:235], a[104:107], v[112:115], v[232:235]
v_cvt_pk_bf16_f32 v194, v200, v201
v_cvt_pk_bf16_f32 v195, v202, v203
v_mfma_f32_16x16x32_bf16 v[232:235], a[108:111], v[116:119], v[232:235]
buffer_store_dwordx4 v[192:195], v1, s[4:7], s76 offen offset:0 sc1
v_mfma_f32_16x16x32_bf16 v[236:239], a[108:111], v[124:127], v[236:239]
v_cvt_pk_bf16_f32 v196, v196, v197
v_cvt_pk_bf16_f32 v197, v198, v199
v_mfma_f32_16x16x32_bf16 v[236:239], a[104:107], v[120:123], v[236:239]
v_cvt_pk_bf16_f32 v198, v204, v205
v_cvt_pk_bf16_f32 v199, v206, v207
v_mfma_f32_16x16x32_bf16 v[240:243], a[112:115], v[112:115], v[240:243]
s_waitcnt lgkmcnt(0)
buffer_store_dwordx4 v[196:199], v1, s[4:7], s77 offen offset:0 sc1
v_mfma_f32_16x16x32_bf16 v[240:243], a[116:119], v[116:119], v[240:243]
v_cvt_pk_bf16_f32 v208, v208, v209
v_cvt_pk_bf16_f32 v209, v210, v211
v_mfma_f32_16x16x32_bf16 v[244:247], a[116:119], v[124:127], v[244:247]
v_cvt_pk_bf16_f32 v210, v216, v217
v_cvt_pk_bf16_f32 v211, v218, v219
v_mfma_f32_16x16x32_bf16 v[244:247], a[112:115], v[120:123], v[244:247]
buffer_store_dwordx4 v[208:211], v1, s[4:7], s76 offen offset:1024 sc1
v_mfma_f32_16x16x32_bf16 v[248:251], a[120:123], v[112:115], v[248:251]
v_cvt_pk_bf16_f32 v212, v212, v213
v_cvt_pk_bf16_f32 v213, v214, v215
v_mfma_f32_16x16x32_bf16 v[248:251], a[124:127], v[116:119], v[248:251]
v_cvt_pk_bf16_f32 v214, v220, v221
v_cvt_pk_bf16_f32 v215, v222, v223
v_mfma_f32_16x16x32_bf16 v[252:255], a[124:127], v[124:127], v[252:255]
buffer_store_dwordx4 v[212:215], v1, s[4:7], s77 offen offset:1024 sc1
v_mfma_f32_16x16x32_bf16 v[252:255], a[120:123], v[120:123], v[252:255]
v_cvt_pk_bf16_f32 v224, v224, v225
v_cvt_pk_bf16_f32 v225, v226, v227
v_accvgpr_mov_b32 a5, a197
v_accvgpr_mov_b32 a6, a198
v_accvgpr_mov_b32 a7, a199
v_accvgpr_mov_b32 a8, a200
v_accvgpr_mov_b32 a9, a201
v_accvgpr_mov_b32 a10, a202
v_accvgpr_mov_b32 a11, a203
v_accvgpr_mov_b32 a12, a204
v_cvt_pk_bf16_f32 v226, v232, v233
v_cvt_pk_bf16_f32 v227, v234, v235
buffer_store_dwordx4 v[224:227], v1, s[4:7], s76 offen offset:2048 sc1
v_cvt_pk_bf16_f32 v228, v228, v229
v_cvt_pk_bf16_f32 v229, v230, v231
v_cvt_pk_bf16_f32 v230, v236, v237
v_cvt_pk_bf16_f32 v231, v238, v239
buffer_store_dwordx4 v[228:231], v1, s[4:7], s77 offen offset:2048 sc1
v_cvt_pk_bf16_f32 v240, v240, v241
v_cvt_pk_bf16_f32 v241, v242, v243
v_cvt_pk_bf16_f32 v242, v248, v249
v_cvt_pk_bf16_f32 v243, v250, v251
buffer_store_dwordx4 v[240:243], v1, s[4:7], s76 offen offset:3072 sc1
v_cvt_pk_bf16_f32 v244, v244, v245
v_cvt_pk_bf16_f32 v245, v246, v247
v_cvt_pk_bf16_f32 v246, v252, v253
v_cvt_pk_bf16_f32 v247, v254, v255
buffer_store_dwordx4 v[244:247], v1, s[4:7], s77 offen offset:3072 sc1
v_accvgpr_mov_b32 a13, a205
v_accvgpr_mov_b32 a14, a206
v_accvgpr_mov_b32 a15, a207
v_accvgpr_mov_b32 a16, a208
v_accvgpr_mov_b32 a17, a209
v_accvgpr_mov_b32 a18, a210
v_accvgpr_mov_b32 a19, a211
v_accvgpr_mov_b32 a20, a212
v_accvgpr_mov_b32 a21, a213
v_accvgpr_mov_b32 a22, a214
v_accvgpr_mov_b32 a23, a215
v_accvgpr_mov_b32 a24, a216
v_accvgpr_mov_b32 a25, a217
v_accvgpr_mov_b32 a26, a218
v_accvgpr_mov_b32 a27, a219
v_accvgpr_mov_b32 a28, a220
v_accvgpr_mov_b32 a29, a221
v_accvgpr_mov_b32 a30, a222
v_accvgpr_mov_b32 a31, a223
v_accvgpr_mov_b32 a32, a224
v_accvgpr_mov_b32 a33, a225
v_accvgpr_mov_b32 a34, a226
v_accvgpr_mov_b32 a35, a227
v_accvgpr_mov_b32 a36, a228
v_accvgpr_mov_b32 a37, a229
v_accvgpr_mov_b32 a38, a230
v_accvgpr_mov_b32 a39, a231
v_accvgpr_mov_b32 a40, a232
v_accvgpr_mov_b32 a41, a233
v_accvgpr_mov_b32 a42, a234
v_accvgpr_mov_b32 a43, a235
v_accvgpr_mov_b32 a44, a236
v_accvgpr_mov_b32 a45, a237
v_accvgpr_mov_b32 a46, a238
v_accvgpr_mov_b32 a47, a239
v_accvgpr_mov_b32 a48, a240
v_accvgpr_mov_b32 a49, a241
v_accvgpr_mov_b32 a50, a242
v_accvgpr_mov_b32 a51, a243
v_accvgpr_mov_b32 a52, a244
v_accvgpr_mov_b32 a53, a245
v_accvgpr_mov_b32 a54, a246
v_accvgpr_mov_b32 a55, a247
v_accvgpr_mov_b32 a56, a248
v_accvgpr_mov_b32 a57, a249
v_accvgpr_mov_b32 a58, a250
v_accvgpr_mov_b32 a59, a251
v_accvgpr_mov_b32 a60, a252
v_accvgpr_mov_b32 a61, a253
v_accvgpr_mov_b32 a62, a254
v_accvgpr_mov_b32 a63, a255
s_mov_b32 s24, 0
s_mov_b32 s29, s21
s_mov_b32 s19, s21
v_mov_b64 v[128:129], 0
v_mov_b64 v[130:131], 0
v_mov_b64 v[132:133], 0
v_mov_b64 v[134:135], 0
v_mov_b64 v[136:137], 0
v_mov_b64 v[138:139], 0
v_mov_b64 v[140:141], 0
v_mov_b64 v[142:143], 0
v_mov_b64 v[144:145], 0
v_mov_b64 v[146:147], 0
v_mov_b64 v[148:149], 0
v_mov_b64 v[150:151], 0
v_mov_b64 v[152:153], 0
v_mov_b64 v[154:155], 0
v_mov_b64 v[156:157], 0
v_mov_b64 v[158:159], 0
v_mov_b64 v[160:161], 0
v_mov_b64 v[162:163], 0
v_mov_b64 v[164:165], 0
v_mov_b64 v[166:167], 0
v_mov_b64 v[168:169], 0
v_mov_b64 v[170:171], 0
v_mov_b64 v[172:173], 0
v_mov_b64 v[174:175], 0
v_mov_b64 v[176:177], 0
v_mov_b64 v[178:179], 0
v_mov_b64 v[180:181], 0
v_mov_b64 v[182:183], 0
v_mov_b64 v[184:185], 0
v_mov_b64 v[186:187], 0
v_mov_b64 v[188:189], 0
v_mov_b64 v[190:191], 0
v_mov_b64 v[192:193], 0
v_mov_b64 v[194:195], 0
v_mov_b64 v[196:197], 0
v_mov_b64 v[198:199], 0
v_mov_b64 v[200:201], 0
v_mov_b64 v[202:203], 0
v_mov_b64 v[204:205], 0
v_mov_b64 v[206:207], 0
v_mov_b64 v[208:209], 0
v_mov_b64 v[210:211], 0
v_mov_b64 v[212:213], 0
v_mov_b64 v[214:215], 0
v_mov_b64 v[216:217], 0
v_mov_b64 v[218:219], 0
v_mov_b64 v[220:221], 0
v_mov_b64 v[222:223], 0
v_mov_b64 v[224:225], 0
v_mov_b64 v[226:227], 0
v_mov_b64 v[228:229], 0
v_mov_b64 v[230:231], 0
v_mov_b64 v[232:233], 0
v_mov_b64 v[234:235], 0
v_mov_b64 v[236:237], 0
v_mov_b64 v[238:239], 0
v_mov_b64 v[240:241], 0
v_mov_b64 v[242:243], 0
v_mov_b64 v[244:245], 0
v_mov_b64 v[246:247], 0
v_mov_b64 v[248:249], 0
v_mov_b64 v[250:251], 0
v_mov_b64 v[252:253], 0
v_mov_b64 v[254:255], 0
v_mov_b64 v[24:25], 0
s_mov_b32 s71, s28
s_mov_b32 s84, 0
s_barrier
s_branch K2_item
Lstub_2:
s_call_b64 s[16:17], K2_slow1
s_branch Lback_3
Lstub_4:
s_call_b64 s[16:17], K2_slow0
s_branch Lback_5
Lstub_6:
s_call_b64 s[16:17], K2_slow1
s_branch Lback_7
Lstub_8:
s_call_b64 s[16:17], K2_slow0
s_branch Lback_9
Lstub_10:
s_call_b64 s[16:17], K2_slow2
s_branch Lback_11
Lstub_12:
s_call_b64 s[16:17], K2_slow2
s_branch Lback_13
Lstub_14:
s_call_b64 s[16:17], K2_slow1
s_branch Lback_15
K2_slow0:
s_nop 7
s_nop 7
v_max3_f32 v8, v32, v33, 0
v_max3_f32 v8, v34, v35, v8
v_max3_f32 v8, v40, v41, v8
v_max3_f32 v8, v42, v43, v8
v_max3_f32 v8, v48, v49, v8
v_max3_f32 v8, v50, v51, v8
v_max3_f32 v8, v56, v57, v8
v_max3_f32 v8, v58, v59, v8
v_mov_b32 v9, v8
s_nop 1
v_permlane16_swap_b32 v8, v9
v_max_f32 v8, v8, v9
v_mov_b32 v9, v8
s_nop 1
v_permlane32_swap_b32 v8, v9
v_max_f32 v8, v8, v9
v_exp_f32 v9, -v8
v_sub_f32 v16, v16, v8
v_sub_f32 v17, v17, v8
v_sub_f32 v18, v18, v8
v_sub_f32 v19, v19, v8
v_mul_f32 v24, v24, v9
v_mul_f32 v128, v128, v9
v_mul_f32 v129, v129, v9
v_mul_f32 v130, v130, v9
v_mul_f32 v131, v131, v9
v_mul_f32 v136, v136, v9
v_mul_f32 v137, v137, v9
v_mul_f32 v138, v138, v9
v_mul_f32 v139, v139, v9
v_mul_f32 v144, v144, v9
v_mul_f32 v145, v145, v9
v_mul_f32 v146, v146, v9
v_mul_f32 v147, v147, v9
v_mul_f32 v152, v152, v9
v_mul_f32 v153, v153, v9
v_mul_f32 v154, v154, v9
v_mul_f32 v155, v155, v9
v_mul_f32 v160, v160, v9
v_mul_f32 v161, v161, v9
v_mul_f32 v162, v162, v9
v_mul_f32 v163, v163, v9
v_mul_f32 v168, v168, v9
v_mul_f32 v169, v169, v9
v_mul_f32 v170, v170, v9
v_mul_f32 v171, v171, v9
v_mul_f32 v176, v176, v9
v_mul_f32 v177, v177, v9
v_mul_f32 v178, v178, v9
v_mul_f32 v179, v179, v9
v_mul_f32 v184, v184, v9
v_mul_f32 v185, v185, v9
v_mul_f32 v186, v186, v9
v_mul_f32 v187, v187, v9
v_mul_f32 v192, v192, v9
v_mul_f32 v193, v193, v9
v_mul_f32 v194, v194, v9
v_mul_f32 v195, v195, v9
v_mul_f32 v200, v200, v9
v_mul_f32 v201, v201, v9
v_mul_f32 v202, v202, v9
v_mul_f32 v203, v203, v9
v_mul_f32 v208, v208, v9
v_mul_f32 v209, v209, v9
v_mul_f32 v210, v210, v9
v_mul_f32 v211, v211, v9
v_mul_f32 v216, v216, v9
v_mul_f32 v217, v217, v9
v_mul_f32 v218, v218, v9
v_mul_f32 v219, v219, v9
v_mul_f32 v224, v224, v9
v_mul_f32 v225, v225, v9
v_mul_f32 v226, v226, v9
v_mul_f32 v227, v227, v9
v_mul_f32 v232, v232, v9
v_mul_f32 v233, v233, v9
v_mul_f32 v234, v234, v9
v_mul_f32 v235, v235, v9
v_mul_f32 v240, v240, v9
v_mul_f32 v241, v241, v9
v_mul_f32 v242, v242, v9
v_mul_f32 v243, v243, v9
v_mul_f32 v248, v248, v9
v_mul_f32 v249, v249, v9
v_mul_f32 v250, v250, v9
v_mul_f32 v251, v251, v9
v_sub_f32 v32, v32, v8
v_sub_f32 v33, v33, v8
v_sub_f32 v34, v34, v8
v_sub_f32 v35, v35, v8
v_sub_f32 v40, v40, v8
v_sub_f32 v41, v41, v8
v_sub_f32 v42, v42, v8
v_sub_f32 v43, v43, v8
v_sub_f32 v48, v48, v8
v_sub_f32 v49, v49, v8
v_sub_f32 v50, v50, v8
v_sub_f32 v51, v51, v8
v_sub_f32 v56, v56, v8
v_sub_f32 v57, v57, v8
v_sub_f32 v58, v58, v8
v_sub_f32 v59, v59, v8
v_sub_f32 v64, v64, v8
v_sub_f32 v65, v65, v8
v_sub_f32 v66, v66, v8
v_sub_f32 v67, v67, v8
v_sub_f32 v72, v72, v8
v_sub_f32 v73, v73, v8
v_sub_f32 v74, v74, v8
v_sub_f32 v75, v75, v8
v_sub_f32 v80, v80, v8
v_sub_f32 v81, v81, v8
v_sub_f32 v82, v82, v8
v_sub_f32 v83, v83, v8
v_sub_f32 v88, v88, v8
v_sub_f32 v89, v89, v8
v_sub_f32 v90, v90, v8
v_sub_f32 v91, v91, v8
v_max3_f32 v8, v36, v37, 0
v_max3_f32 v8, v38, v39, v8
v_max3_f32 v8, v44, v45, v8
v_max3_f32 v8, v46, v47, v8
v_max3_f32 v8, v52, v53, v8
v_max3_f32 v8, v54, v55, v8
v_max3_f32 v8, v60, v61, v8
v_max3_f32 v8, v62, v63, v8
v_mov_b32 v9, v8
s_nop 1
v_permlane16_swap_b32 v8, v9
v_max_f32 v8, v8, v9
v_mov_b32 v9, v8
s_nop 1
v_permlane32_swap_b32 v8, v9
v_max_f32 v8, v8, v9
v_exp_f32 v9, -v8
v_sub_f32 v20, v20, v8
v_sub_f32 v21, v21, v8
v_sub_f32 v22, v22, v8
v_sub_f32 v23, v23, v8
v_mul_f32 v25, v25, v9
v_mul_f32 v132, v132, v9
v_mul_f32 v133, v133, v9
v_mul_f32 v134, v134, v9
v_mul_f32 v135, v135, v9
v_mul_f32 v140, v140, v9
v_mul_f32 v141, v141, v9
v_mul_f32 v142, v142, v9
v_mul_f32 v143, v143, v9
v_mul_f32 v148, v148, v9
v_mul_f32 v149, v149, v9
v_mul_f32 v150, v150, v9
v_mul_f32 v151, v151, v9
v_mul_f32 v156, v156, v9
v_mul_f32 v157, v157, v9
v_mul_f32 v158, v158, v9
v_mul_f32 v159, v159, v9
v_mul_f32 v164, v164, v9
v_mul_f32 v165, v165, v9
v_mul_f32 v166, v166, v9
v_mul_f32 v167, v167, v9
v_mul_f32 v172, v172, v9
v_mul_f32 v173, v173, v9
v_mul_f32 v174, v174, v9
v_mul_f32 v175, v175, v9
v_mul_f32 v180, v180, v9
v_mul_f32 v181, v181, v9
v_mul_f32 v182, v182, v9
v_mul_f32 v183, v183, v9
v_mul_f32 v188, v188, v9
v_mul_f32 v189, v189, v9
v_mul_f32 v190, v190, v9
v_mul_f32 v191, v191, v9
v_mul_f32 v196, v196, v9
v_mul_f32 v197, v197, v9
v_mul_f32 v198, v198, v9
v_mul_f32 v199, v199, v9
v_mul_f32 v204, v204, v9
v_mul_f32 v205, v205, v9
v_mul_f32 v206, v206, v9
v_mul_f32 v207, v207, v9
v_mul_f32 v212, v212, v9
v_mul_f32 v213, v213, v9
v_mul_f32 v214, v214, v9
v_mul_f32 v215, v215, v9
v_mul_f32 v220, v220, v9
v_mul_f32 v221, v221, v9
v_mul_f32 v222, v222, v9
v_mul_f32 v223, v223, v9
v_mul_f32 v228, v228, v9
v_mul_f32 v229, v229, v9
v_mul_f32 v230, v230, v9
v_mul_f32 v231, v231, v9
v_mul_f32 v236, v236, v9
v_mul_f32 v237, v237, v9
v_mul_f32 v238, v238, v9
v_mul_f32 v239, v239, v9
v_mul_f32 v244, v244, v9
v_mul_f32 v245, v245, v9
v_mul_f32 v246, v246, v9
v_mul_f32 v247, v247, v9
v_mul_f32 v252, v252, v9
v_mul_f32 v253, v253, v9
v_mul_f32 v254, v254, v9
v_mul_f32 v255, v255, v9
v_sub_f32 v36, v36, v8
v_sub_f32 v37, v37, v8
v_sub_f32 v38, v38, v8
v_sub_f32 v39, v39, v8
v_sub_f32 v44, v44, v8
v_sub_f32 v45, v45, v8
v_sub_f32 v46, v46, v8
v_sub_f32 v47, v47, v8
v_sub_f32 v52, v52, v8
v_sub_f32 v53, v53, v8
v_sub_f32 v54, v54, v8
v_sub_f32 v55, v55, v8
v_sub_f32 v60, v60, v8
v_sub_f32 v61, v61, v8
v_sub_f32 v62, v62, v8
v_sub_f32 v63, v63, v8
v_sub_f32 v68, v68, v8
v_sub_f32 v69, v69, v8
v_sub_f32 v70, v70, v8
v_sub_f32 v71, v71, v8
v_sub_f32 v76, v76, v8
v_sub_f32 v77, v77, v8
v_sub_f32 v78, v78, v8
v_sub_f32 v79, v79, v8
v_sub_f32 v84, v84, v8
v_sub_f32 v85, v85, v8
v_sub_f32 v86, v86, v8
v_sub_f32 v87, v87, v8
v_sub_f32 v92, v92, v8
v_sub_f32 v93, v93, v8
v_sub_f32 v94, v94, v8
v_sub_f32 v95, v95, v8
v_exp_f32 v8, v32
v_exp_f32 v9, v33
v_exp_f32 v10, v34
v_exp_f32 v11, v35
s_nop 0
v_add_f32 v26, v8, v9
v_cvt_pk_bf16_f32 v96, v8, v9
v_add_f32 v26, v26, v10
v_add_f32 v26, v26, v11
v_cvt_pk_bf16_f32 v97, v10, v11
v_exp_f32 v12, v36
v_exp_f32 v13, v37
v_exp_f32 v14, v38
v_exp_f32 v15, v39
s_nop 0
v_add_f32 v27, v12, v13
v_cvt_pk_bf16_f32 v104, v12, v13
v_add_f32 v27, v27, v14
v_add_f32 v27, v27, v15
v_cvt_pk_bf16_f32 v105, v14, v15
v_exp_f32 v8, v40
v_exp_f32 v9, v41
v_exp_f32 v10, v42
v_exp_f32 v11, v43
s_nop 0
v_add_f32 v26, v26, v8
v_add_f32 v26, v26, v9
v_cvt_pk_bf16_f32 v98, v8, v9
v_add_f32 v26, v26, v10
v_add_f32 v26, v26, v11
v_cvt_pk_bf16_f32 v99, v10, v11
v_exp_f32 v12, v44
v_exp_f32 v13, v45
v_exp_f32 v14, v46
v_exp_f32 v15, v47
s_nop 0
v_add_f32 v27, v27, v12
v_add_f32 v27, v27, v13
v_cvt_pk_bf16_f32 v106, v12, v13
v_add_f32 v27, v27, v14
v_add_f32 v27, v27, v15
v_cvt_pk_bf16_f32 v107, v14, v15
v_exp_f32 v8, v48
v_exp_f32 v9, v49
v_exp_f32 v10, v50
v_exp_f32 v11, v51
s_nop 0
v_add_f32 v26, v26, v8
v_add_f32 v26, v26, v9
v_cvt_pk_bf16_f32 v100, v8, v9
v_add_f32 v26, v26, v10
v_add_f32 v26, v26, v11
v_cvt_pk_bf16_f32 v101, v10, v11
v_exp_f32 v12, v52
v_exp_f32 v13, v53
v_exp_f32 v14, v54
v_exp_f32 v15, v55
s_nop 0
v_add_f32 v27, v27, v12
v_add_f32 v27, v27, v13
v_cvt_pk_bf16_f32 v108, v12, v13
v_add_f32 v27, v27, v14
v_add_f32 v27, v27, v15
v_cvt_pk_bf16_f32 v109, v14, v15
v_exp_f32 v8, v56
v_exp_f32 v9, v57
v_exp_f32 v10, v58
v_exp_f32 v11, v59
s_nop 0
v_add_f32 v26, v26, v8
v_add_f32 v26, v26, v9
v_cvt_pk_bf16_f32 v102, v8, v9
v_add_f32 v26, v26, v10
v_add_f32 v26, v26, v11
v_cvt_pk_bf16_f32 v103, v10, v11
v_exp_f32 v12, v60
v_exp_f32 v13, v61
v_exp_f32 v14, v62
v_exp_f32 v15, v63
s_nop 0
v_add_f32 v27, v27, v12
v_add_f32 v27, v27, v13
v_cvt_pk_bf16_f32 v110, v12, v13
v_add_f32 v27, v27, v14
v_add_f32 v27, v27, v15
v_cvt_pk_bf16_f32 v111, v14, v15
s_nop 1
s_setpc_b64 s[16:17]
K2_slow1:
s_nop 7
s_nop 7
v_max3_f32 v8, v64, v65, 0
v_max3_f32 v8, v66, v67, v8
v_max3_f32 v8, v72, v73, v8
v_max3_f32 v8, v74, v75, v8
v_max3_f32 v8, v80, v81, v8
v_max3_f32 v8, v82, v83, v8
v_max3_f32 v8, v88, v89, v8
v_max3_f32 v8, v90, v91, v8
v_mov_b32 v9, v8
s_nop 1
v_permlane16_swap_b32 v8, v9
v_max_f32 v8, v8, v9
v_mov_b32 v9, v8
s_nop 1
v_permlane32_swap_b32 v8, v9
v_max_f32 v8, v8, v9
v_exp_f32 v9, -v8
v_sub_f32 v16, v16, v8
v_sub_f32 v17, v17, v8
v_sub_f32 v18, v18, v8
v_sub_f32 v19, v19, v8
v_mul_f32 v24, v24, v9
v_mul_f32 v128, v128, v9
v_mul_f32 v129, v129, v9
v_mul_f32 v130, v130, v9
v_mul_f32 v131, v131, v9
v_mul_f32 v136, v136, v9
v_mul_f32 v137, v137, v9
v_mul_f32 v138, v138, v9
v_mul_f32 v139, v139, v9
v_mul_f32 v144, v144, v9
v_mul_f32 v145, v145, v9
v_mul_f32 v146, v146, v9
v_mul_f32 v147, v147, v9
v_mul_f32 v152, v152, v9
v_mul_f32 v153, v153, v9
v_mul_f32 v154, v154, v9
v_mul_f32 v155, v155, v9
v_mul_f32 v160, v160, v9
v_mul_f32 v161, v161, v9
v_mul_f32 v162, v162, v9
v_mul_f32 v163, v163, v9
v_mul_f32 v168, v168, v9
v_mul_f32 v169, v169, v9
v_mul_f32 v170, v170, v9
v_mul_f32 v171, v171, v9
v_mul_f32 v176, v176, v9
v_mul_f32 v177, v177, v9
v_mul_f32 v178, v178, v9
v_mul_f32 v179, v179, v9
v_mul_f32 v184, v184, v9
v_mul_f32 v185, v185, v9
v_mul_f32 v186, v186, v9
v_mul_f32 v187, v187, v9
v_mul_f32 v192, v192, v9
v_mul_f32 v193, v193, v9
v_mul_f32 v194, v194, v9
v_mul_f32 v195, v195, v9
v_mul_f32 v200, v200, v9
v_mul_f32 v201, v201, v9
v_mul_f32 v202, v202, v9
v_mul_f32 v203, v203, v9
v_mul_f32 v208, v208, v9
v_mul_f32 v209, v209, v9
v_mul_f32 v210, v210, v9
v_mul_f32 v211, v211, v9
v_mul_f32 v216, v216, v9
v_mul_f32 v217, v217, v9
v_mul_f32 v218, v218, v9
v_mul_f32 v219, v219, v9
v_mul_f32 v224, v224, v9
v_mul_f32 v225, v225, v9
v_mul_f32 v226, v226, v9
v_mul_f32 v227, v227, v9
v_mul_f32 v232, v232, v9
v_mul_f32 v233, v233, v9
v_mul_f32 v234, v234, v9
v_mul_f32 v235, v235, v9
v_mul_f32 v240, v240, v9
v_mul_f32 v241, v241, v9
v_mul_f32 v242, v242, v9
v_mul_f32 v243, v243, v9
v_mul_f32 v248, v248, v9
v_mul_f32 v249, v249, v9
v_mul_f32 v250, v250, v9
v_mul_f32 v251, v251, v9
v_sub_f32 v32, v32, v8
v_sub_f32 v33, v33, v8
v_sub_f32 v34, v34, v8
v_sub_f32 v35, v35, v8
v_sub_f32 v40, v40, v8
v_sub_f32 v41, v41, v8
v_sub_f32 v42, v42, v8
v_sub_f32 v43, v43, v8
v_sub_f32 v48, v48, v8
v_sub_f32 v49, v49, v8
v_sub_f32 v50, v50, v8
v_sub_f32 v51, v51, v8
v_sub_f32 v56, v56, v8
v_sub_f32 v57, v57, v8
v_sub_f32 v58, v58, v8
v_sub_f32 v59, v59, v8
v_sub_f32 v64, v64, v8
v_sub_f32 v65, v65, v8
v_sub_f32 v66, v66, v8
v_sub_f32 v67, v67, v8
v_sub_f32 v72, v72, v8
v_sub_f32 v73, v73, v8
v_sub_f32 v74, v74, v8
v_sub_f32 v75, v75, v8
v_sub_f32 v80, v80, v8
v_sub_f32 v81, v81, v8
v_sub_f32 v82, v82, v8
v_sub_f32 v83, v83, v8
v_sub_f32 v88, v88, v8
v_sub_f32 v89, v89, v8
v_sub_f32 v90, v90, v8
v_sub_f32 v91, v91, v8
v_max3_f32 v8, v68, v69, 0
v_max3_f32 v8, v70, v71, v8
v_max3_f32 v8, v76, v77, v8
v_max3_f32 v8, v78, v79, v8
v_max3_f32 v8, v84, v85, v8
v_max3_f32 v8, v86, v87, v8
v_max3_f32 v8, v92, v93, v8
v_max3_f32 v8, v94, v95, v8
v_mov_b32 v9, v8
s_nop 1
v_permlane16_swap_b32 v8, v9
v_max_f32 v8, v8, v9
v_mov_b32 v9, v8
s_nop 1
v_permlane32_swap_b32 v8, v9
v_max_f32 v8, v8, v9
v_exp_f32 v9, -v8
v_sub_f32 v20, v20, v8
v_sub_f32 v21, v21, v8
v_sub_f32 v22, v22, v8
v_sub_f32 v23, v23, v8
v_mul_f32 v25, v25, v9
v_mul_f32 v132, v132, v9
v_mul_f32 v133, v133, v9
v_mul_f32 v134, v134, v9
v_mul_f32 v135, v135, v9
v_mul_f32 v140, v140, v9
v_mul_f32 v141, v141, v9
v_mul_f32 v142, v142, v9
v_mul_f32 v143, v143, v9
v_mul_f32 v148, v148, v9
v_mul_f32 v149, v149, v9
v_mul_f32 v150, v150, v9
v_mul_f32 v151, v151, v9
v_mul_f32 v156, v156, v9
v_mul_f32 v157, v157, v9
v_mul_f32 v158, v158, v9
v_mul_f32 v159, v159, v9
v_mul_f32 v164, v164, v9
v_mul_f32 v165, v165, v9
v_mul_f32 v166, v166, v9
v_mul_f32 v167, v167, v9
v_mul_f32 v172, v172, v9
v_mul_f32 v173, v173, v9
v_mul_f32 v174, v174, v9
v_mul_f32 v175, v175, v9
v_mul_f32 v180, v180, v9
v_mul_f32 v181, v181, v9
v_mul_f32 v182, v182, v9
v_mul_f32 v183, v183, v9
v_mul_f32 v188, v188, v9
v_mul_f32 v189, v189, v9
v_mul_f32 v190, v190, v9
v_mul_f32 v191, v191, v9
v_mul_f32 v196, v196, v9
v_mul_f32 v197, v197, v9
v_mul_f32 v198, v198, v9
v_mul_f32 v199, v199, v9
v_mul_f32 v204, v204, v9
v_mul_f32 v205, v205, v9
v_mul_f32 v206, v206, v9
v_mul_f32 v207, v207, v9
v_mul_f32 v212, v212, v9
v_mul_f32 v213, v213, v9
v_mul_f32 v214, v214, v9
v_mul_f32 v215, v215, v9
v_mul_f32 v220, v220, v9
v_mul_f32 v221, v221, v9
v_mul_f32 v222, v222, v9
v_mul_f32 v223, v223, v9
v_mul_f32 v228, v228, v9
v_mul_f32 v229, v229, v9
v_mul_f32 v230, v230, v9
v_mul_f32 v231, v231, v9
v_mul_f32 v236, v236, v9
v_mul_f32 v237, v237, v9
v_mul_f32 v238, v238, v9
v_mul_f32 v239, v239, v9
v_mul_f32 v244, v244, v9
v_mul_f32 v245, v245, v9
v_mul_f32 v246, v246, v9
v_mul_f32 v247, v247, v9
v_mul_f32 v252, v252, v9
v_mul_f32 v253, v253, v9
v_mul_f32 v254, v254, v9
v_mul_f32 v255, v255, v9
v_sub_f32 v36, v36, v8
v_sub_f32 v37, v37, v8
v_sub_f32 v38, v38, v8
v_sub_f32 v39, v39, v8
v_sub_f32 v44, v44, v8
v_sub_f32 v45, v45, v8
v_sub_f32 v46, v46, v8
v_sub_f32 v47, v47, v8
v_sub_f32 v52, v52, v8
v_sub_f32 v53, v53, v8
v_sub_f32 v54, v54, v8
v_sub_f32 v55, v55, v8
v_sub_f32 v60, v60, v8
v_sub_f32 v61, v61, v8
v_sub_f32 v62, v62, v8
v_sub_f32 v63, v63, v8
v_sub_f32 v68, v68, v8
v_sub_f32 v69, v69, v8
v_sub_f32 v70, v70, v8
v_sub_f32 v71, v71, v8
v_sub_f32 v76, v76, v8
v_sub_f32 v77, v77, v8
v_sub_f32 v78, v78, v8
v_sub_f32 v79, v79, v8
v_sub_f32 v84, v84, v8
v_sub_f32 v85, v85, v8
v_sub_f32 v86, v86, v8
v_sub_f32 v87, v87, v8
v_sub_f32 v92, v92, v8
v_sub_f32 v93, v93, v8
v_sub_f32 v94, v94, v8
v_sub_f32 v95, v95, v8
v_exp_f32 v8, v64
v_exp_f32 v9, v65
v_exp_f32 v10, v66
v_exp_f32 v11, v67
s_nop 0
v_add_f32 v26, v8, v9
v_cvt_pk_bf16_f32 v112, v8, v9
v_add_f32 v26, v26, v10
v_add_f32 v26, v26, v11
v_cvt_pk_bf16_f32 v113, v10, v11
v_exp_f32 v12, v68
v_exp_f32 v13, v69
v_exp_f32 v14, v70
v_exp_f32 v15, v71
s_nop 0
v_add_f32 v27, v12, v13
v_cvt_pk_bf16_f32 v120, v12, v13
v_add_f32 v27, v27, v14
v_add_f32 v27, v27, v15
v_cvt_pk_bf16_f32 v121, v14, v15
v_exp_f32 v8, v72
v_exp_f32 v9, v73
v_exp_f32 v10, v74
v_exp_f32 v11, v75
s_nop 0
v_add_f32 v26, v26, v8
v_add_f32 v26, v26, v9
v_cvt_pk_bf16_f32 v114, v8, v9
v_add_f32 v26, v26, v10
v_add_f32 v26, v26, v11
v_cvt_pk_bf16_f32 v115, v10, v11
v_exp_f32 v12, v76
v_exp_f32 v13, v77
v_exp_f32 v14, v78
v_exp_f32 v15, v79
s_nop 0
v_add_f32 v27, v27, v12
v_add_f32 v27, v27, v13
v_cvt_pk_bf16_f32 v122, v12, v13
v_add_f32 v27, v27, v14
v_add_f32 v27, v27, v15
v_cvt_pk_bf16_f32 v123, v14, v15
v_exp_f32 v8, v80
v_exp_f32 v9, v81
v_exp_f32 v10, v82
v_exp_f32 v11, v83
s_nop 0
v_add_f32 v26, v26, v8
v_add_f32 v26, v26, v9
v_cvt_pk_bf16_f32 v116, v8, v9
v_add_f32 v26, v26, v10
v_add_f32 v26, v26, v11
v_cvt_pk_bf16_f32 v117, v10, v11
v_exp_f32 v12, v84
v_exp_f32 v13, v85
v_exp_f32 v14, v86
v_exp_f32 v15, v87
s_nop 0
v_add_f32 v27, v27, v12
v_add_f32 v27, v27, v13
v_cvt_pk_bf16_f32 v124, v12, v13
v_add_f32 v27, v27, v14
v_add_f32 v27, v27, v15
v_cvt_pk_bf16_f32 v125, v14, v15
v_exp_f32 v8, v88
v_exp_f32 v9, v89
v_exp_f32 v10, v90
v_exp_f32 v11, v91
s_nop 0
v_add_f32 v26, v26, v8
v_add_f32 v26, v26, v9
v_cvt_pk_bf16_f32 v118, v8, v9
v_add_f32 v26, v26, v10
v_add_f32 v26, v26, v11
v_cvt_pk_bf16_f32 v119, v10, v11
v_exp_f32 v12, v92
v_exp_f32 v13, v93
v_exp_f32 v14, v94
v_exp_f32 v15, v95
s_nop 0
v_add_f32 v27, v27, v12
v_add_f32 v27, v27, v13
v_cvt_pk_bf16_f32 v126, v12, v13
v_add_f32 v27, v27, v14
v_add_f32 v27, v27, v15
v_cvt_pk_bf16_f32 v127, v14, v15
s_nop 1
s_setpc_b64 s[16:17]
K2_slow2:
s_nop 7
s_nop 7
v_max3_f32 v8, v68, v69, 0
v_max3_f32 v8, v70, v71, v8
v_max3_f32 v8, v76, v77, v8
v_max3_f32 v8, v78, v79, v8
v_max3_f32 v8, v84, v85, v8
v_max3_f32 v8, v86, v87, v8
v_max3_f32 v8, v92, v93, v8
v_max3_f32 v8, v94, v95, v8
v_mov_b32 v9, v8
s_nop 1
v_permlane16_swap_b32 v8, v9
v_max_f32 v8, v8, v9
v_mov_b32 v9, v8
s_nop 1
v_permlane32_swap_b32 v8, v9
v_max_f32 v8, v8, v9
v_exp_f32 v9, -v8
v_sub_f32 v20, v20, v8
v_sub_f32 v21, v21, v8
v_sub_f32 v22, v22, v8
v_sub_f32 v23, v23, v8
v_mul_f32 v25, v25, v9
v_mul_f32 v132, v132, v9
v_mul_f32 v133, v133, v9
v_mul_f32 v134, v134, v9
v_mul_f32 v135, v135, v9
v_mul_f32 v140, v140, v9
v_mul_f32 v141, v141, v9
v_mul_f32 v142, v142, v9
v_mul_f32 v143, v143, v9
v_mul_f32 v148, v148, v9
v_mul_f32 v149, v149, v9
v_mul_f32 v150, v150, v9
v_mul_f32 v151, v151, v9
v_mul_f32 v156, v156, v9
v_mul_f32 v157, v157, v9
v_mul_f32 v158, v158, v9
v_mul_f32 v159, v159, v9
v_mul_f32 v164, v164, v9
v_mul_f32 v165, v165, v9
v_mul_f32 v166, v166, v9
v_mul_f32 v167, v167, v9
v_mul_f32 v172, v172, v9
v_mul_f32 v173, v173, v9
v_mul_f32 v174, v174, v9
v_mul_f32 v175, v175, v9
v_mul_f32 v180, v180, v9
v_mul_f32 v181, v181, v9
v_mul_f32 v182, v182, v9
v_mul_f32 v183, v183, v9
v_mul_f32 v188, v188, v9
v_mul_f32 v189, v189, v9
v_mul_f32 v190, v190, v9
v_mul_f32 v191, v191, v9
v_mul_f32 v196, v196, v9
v_mul_f32 v197, v197, v9
v_mul_f32 v198, v198, v9
v_mul_f32 v199, v199, v9
v_mul_f32 v204, v204, v9
v_mul_f32 v205, v205, v9
v_mul_f32 v206, v206, v9
v_mul_f32 v207, v207, v9
v_mul_f32 v212, v212, v9
v_mul_f32 v213, v213, v9
v_mul_f32 v214, v214, v9
v_mul_f32 v215, v215, v9
v_mul_f32 v220, v220, v9
v_mul_f32 v221, v221, v9
v_mul_f32 v222, v222, v9
v_mul_f32 v223, v223, v9
v_mul_f32 v228, v228, v9
v_mul_f32 v229, v229, v9
v_mul_f32 v230, v230, v9
v_mul_f32 v231, v231, v9
v_mul_f32 v236, v236, v9
v_mul_f32 v237, v237, v9
v_mul_f32 v238, v238, v9
v_mul_f32 v239, v239, v9
v_mul_f32 v244, v244, v9
v_mul_f32 v245, v245, v9
v_mul_f32 v246, v246, v9
v_mul_f32 v247, v247, v9
v_mul_f32 v252, v252, v9
v_mul_f32 v253, v253, v9
v_mul_f32 v254, v254, v9
v_mul_f32 v255, v255, v9
v_sub_f32 v68, v68, v8
v_sub_f32 v69, v69, v8
v_sub_f32 v70, v70, v8
v_sub_f32 v71, v71, v8
v_sub_f32 v76, v76, v8
v_sub_f32 v77, v77, v8
v_sub_f32 v78, v78, v8
v_sub_f32 v79, v79, v8
v_sub_f32 v84, v84, v8
v_sub_f32 v85, v85, v8
v_sub_f32 v86, v86, v8
v_sub_f32 v87, v87, v8
v_sub_f32 v92, v92, v8
v_sub_f32 v93, v93, v8
v_sub_f32 v94, v94, v8
v_sub_f32 v95, v95, v8
v_exp_f32 v8, v68
v_exp_f32 v9, v69
v_exp_f32 v10, v70
v_exp_f32 v11, v71
s_nop 0
v_add_f32 v27, v8, v9
v_cvt_pk_bf16_f32 v120, v8, v9
v_add_f32 v27, v27, v10
v_add_f32 v27, v27, v11
v_cvt_pk_bf16_f32 v121, v10, v11
v_exp_f32 v12, v76
v_exp_f32 v13, v77
v_exp_f32 v14, v78
v_exp_f32 v15, v79
s_nop 0
v_add_f32 v27, v27, v12
v_add_f32 v27, v27, v13
v_cvt_pk_bf16_f32 v122, v12, v13
v_add_f32 v27, v27, v14
v_add_f32 v27, v27, v15
v_cvt_pk_bf16_f32 v123, v14, v15
v_exp_f32 v8, v84
v_exp_f32 v9, v85
v_exp_f32 v10, v86
v_exp_f32 v11, v87
s_nop 0
v_add_f32 v27, v27, v8
v_add_f32 v27, v27, v9
v_cvt_pk_bf16_f32 v124, v8, v9
v_add_f32 v27, v27, v10
v_add_f32 v27, v27, v11
v_cvt_pk_bf16_f32 v125, v10, v11
v_exp_f32 v12, v92
v_exp_f32 v13, v93
v_exp_f32 v14, v94
v_exp_f32 v15, v95
s_nop 0
v_add_f32 v27, v27, v12
v_add_f32 v27, v27, v13
v_cvt_pk_bf16_f32 v126, v12, v13
v_add_f32 v27, v27, v14
v_add_f32 v27, v27, v15
v_cvt_pk_bf16_f32 v127, v14, v15
s_nop 1
s_setpc_b64 s[16:17]
M_cntspinK:
Lp_9801:
buffer_load_dword v245, off, s[60:63], 0 sc1
s_waitcnt vmcnt(0)
v_cmp_gt_u32 vcc, 0x100, v245
s_cbranch_vccz Lpd_9802
s_sleep 8
s_sub_u32 s101, s101, 1
s_cbranch_scc0 Lp_9801
s_mov_b32 s101, 0
Lpd_9802:
s_branch Lg_1
M_ppspinK:
Lp_9803:
buffer_load_dword v230, v231, s[4:7], s52 offen sc1
s_waitcnt vmcnt(0)
v_cmp_gt_u32 vcc, 1, v230
s_cbranch_vccz Lpd_9804
s_sleep 8
s_sub_u32 s101, s101, 1
s_cbranch_scc0 Lp_9803
s_mov_b32 s101, 0
Lpd_9804:
s_branch M_ppokK
M_cntspinV:
Lp_9805:
buffer_load_dword v245, off, s[60:63], 0 sc1
s_waitcnt vmcnt(0)
v_cmp_gt_u32 vcc, 0x100, v245
s_cbranch_vccz Lpd_9806
s_sleep 8
s_sub_u32 s101, s101, 1
s_cbranch_scc0 Lp_9805
s_mov_b32 s101, 0
Lpd_9806:
s_branch Lg_501
M_ppspinV:
Lp_9807:
buffer_load_dword v230, v231, s[4:7], s52 offen sc1
s_waitcnt vmcnt(0)
v_cmp_gt_u32 vcc, 1, v230
s_cbranch_vccz Lpd_9808
s_sleep 8
s_sub_u32 s101, s101, 1
s_cbranch_scc0 Lp_9807
s_mov_b32 s101, 0
Lpd_9808:
s_branch M_ppokV
M_end:
s_endpgm
.section .rodata,"a"
.p2align 6
.amdhsa_kernel concat_heads__ssm_conv_h3__compressed_kv_cla__prompt_kernel
  .amdhsa_next_free_vgpr 512
  .amdhsa_next_free_sgpr 102
  .amdhsa_accum_offset 256
  .amdhsa_group_segment_fixed_size 0
  .amdhsa_kernarg_size 120
  .amdhsa_user_sgpr_count 2
  .amdhsa_user_sgpr_kernarg_segment_ptr 1
  .amdhsa_system_sgpr_workgroup_id_x 1
  .amdhsa_float_denorm_mode_32 3
  .amdhsa_float_denorm_mode_16_64 3
  .amdhsa_ieee_mode 0
  .amdhsa_dx10_clamp 0
.end_amdhsa_kernel
```

```asm
; @launch grid=(256,1,1) block=(256,1,1) lds=163840
.amdgcn_target "amdgcn-amd-amdhsa--gfx950"
.text
.globl concat_heads__ssm_conv_h3__compressed_kv_cla__prompt_kernel
.p2align 8
.type concat_heads__ssm_conv_h3__compressed_kv_cla__prompt_kernel,@function
concat_heads__ssm_conv_h3__compressed_kv_cla__prompt_kernel:
s_cmp_ge_u32 s2, 256
s_cbranch_scc1 M_end
s_load_dwordx16 s[64:79], s[0:1], 0
s_load_dwordx8 s[80:87], s[0:1], 64
s_load_dwordx4 s[88:91], s[0:1], 96
s_load_dwordx2 s[92:93], s[0:1], 112
s_getpc_b64 s[58:59]
M_pc:
s_lshr_b32 s22, s2, 3
s_lshl_b32 s22, s22, 5
v_and_b32 v26, 31, v0
v_add_u32 v26, s22, v26
v_lshlrev_b32 v26, 7, v26
v_min_u32 v26, M_end-M_pc, v26
v_mov_b32 v27, s59
v_add_co_u32 v26, vcc, s58, v26
s_nop 1
v_addc_co_u32 v27, vcc, 0, v27, vcc
global_load_dword v21, v[26:27], off
v_lshrrev_b32 v28, 6, v0
v_and_b32 v29, 63, v0
v_lshlrev_b32 v1, 4, v29
v_readfirstlane_b32 s3, v28
s_and_b32 s20, s2, 7
s_lshl_b32 s20, s20, 1
s_bfe_u32 s22, s2, 0x10003
s_add_u32 s20, s20, s22
s_lshr_b32 s21, s2, 5
s_mov_b32 s101, 0x40000
v_lshrrev_b32 v26, 7, v1
v_lshrrev_b32 v27, 1, v26
v_lshlrev_b32 v27, 4, v27
v_and_b32 v28, 0x70, v1
v_xor_b32 v27, v27, v28
v_mul_u32_u24 v26, 2048, v26
v_add_u32 v12, v26, v27
v_xor_b32 v27, 64, v27
v_add_u32 v26, v26, v27
v_add_u32 v13, 15360, v26
v_add_u32 v14, 30720, v12
v_add_u32 v15, 46080, v26
v_lshrrev_b32 v26, 5, v29
v_and_b32 v27, 31, v29
s_and_b32 s22, s3, 1
s_lshl_b32 s22, s22, 2
v_or_b32 v28, s22, v26
v_lshlrev_b32 v28, 1, v28
v_xor_b32 v27, v27, v28
v_lshlrev_b32 v27, 4, v27
v_lshl_add_u32 v16, v26, 13, v27
v_xor_b32 v26, 64, v16
v_add_u32 v17, 15360, v26
v_add_u32 v18, 30720, v16
v_add_u32 v19, 46080, v26
s_lshl_b32 s28, s3, 13
s_lshl_b32 s29, s3, 12
s_lshl_b32 s24, s21, 19
s_lshl_b32 s22, s3, 17
s_add_u32 s24, s24, s22
s_add_u32 s25, s24, 65536
s_lshl_b32 s26, s3, 16
s_lshl_b32 s22, s20, 9
s_add_u32 s26, s26, s22
s_add_u32 s27, s26, 262144
s_mov_b32 s10, 4194304
s_mov_b32 s11, 0x20000
s_mov_b32 s14, 8388608
s_mov_b32 s15, 0x20000
v_and_b32 v30, 15, v29
v_lshrrev_b32 v31, 4, v29
v_lshrrev_b32 v26, 1, v30
v_xor_b32 v26, v31, v26
v_lshlrev_b32 v26, 4, v26
v_lshl_add_u32 v2, v30, 7, v26
s_lshr_b32 s22, s3, 1
s_lshl_b32 s22, s22, 14
v_add_u32 v2, s22, v2
v_xor_b32 v3, 64, v2
v_lshrrev_b32 v26, 2, v30
v_and_b32 v27, 1, v31
v_lshl_or_b32 v27, v27, 2, v26
v_lshl_add_u32 v26, v31, 3, v26
v_lshlrev_b32 v26, 9, v26
v_lshl_add_u32 v26, v27, 5, v26
v_and_b32 v27, 3, v29
v_lshl_add_u32 v26, v27, 3, v26
s_and_b32 s22, s3, 1
s_lshl_b32 s22, s22, 8
s_add_u32 s22, s22, 0x10000
v_xor_b32 v4, s22, v26
v_xor_b32 v5, 32, v4
v_xor_b32 v6, 64, v4
v_xor_b32 v7, 96, v4
v_xor_b32 v8, 128, v4
v_xor_b32 v9, 160, v4
v_xor_b32 v10, 192, v4
v_xor_b32 v11, 224, v4
s_mov_b32 s19, 0x20000
s_cmp_eq_u32 s3, 2
s_cbranch_scc1 M_pf2
s_cmp_lg_u32 s3, 0
s_cbranch_scc1 M_pf3
s_mov_b32 s18, 8388608
s_mov_b32 s51, 8388608
s_mov_b32 s47, 524288
s_mov_b32 s43, 524288
s_lshl_b32 s22, s21, 16
s_lshl_b32 s23, s20, 9
s_add_u32 s22, s22, s23
v_bfe_u32 v26, v29, 2, 3
v_lshl_add_u32 v26, v26, 13, s22
v_and_b32 v27, 3, v29
v_lshl_add_u32 v20, v27, 7, v26
v_lshrrev_b32 v27, 5, v29
v_lshl_add_u32 v22, v27, 19, v20
v_cmp_gt_u32 vcc, 32, v29
s_branch M_pfd
M_pf2:
s_mov_b32 s18, 4194304
s_mov_b32 s51, 2048
s_mov_b32 s47, 256
s_mov_b32 s43, 0
s_lshl_b32 s22, s2, 14
v_bfe_u32 v26, v29, 1, 3
v_lshl_add_u32 v26, v26, 11, s22
v_and_b32 v27, 1, v29
v_lshl_add_u32 v20, v27, 7, v26
v_bfe_u32 v27, v29, 4, 1
v_lshl_add_u32 v22, v27, 8, v20
v_cmp_gt_u32 vcc, 16, v29
s_branch M_pfd
M_pf3:
s_mov_b32 s18, 0
s_mov_b32 s51, 3112960
s_mov_b32 s47, 622592
s_mov_b32 s43, 0
s_mul_i32 s22, s2, 2432
v_lshl_add_u32 v20, v29, 7, s22
v_mov_b32 v22, v20
v_cmp_gt_u32 vcc, 19, v29
M_pfd:
v_mov_b32 v26, 3221225472
s_nop 0
v_cndmask_b32 v20, v26, v20, vcc
s_bitcmp1_b32 s2, 4
s_waitcnt lgkmcnt(0)
s_mov_b64 s[8:9], s[78:79]
s_cselect_b64 s[12:13], s[84:85], s[82:83]
s_add_u32 m0, s28, 0
s_nop 0
buffer_load_dwordx4 v12, s[8:11], s24 offen offset:0 lds
buffer_load_dwordx4 v13, s[8:11], s24 offen offset:1024 lds
buffer_load_dwordx4 v14, s[8:11], s24 offen offset:2048 lds
buffer_load_dwordx4 v15, s[8:11], s24 offen offset:3072 lds
s_add_u32 s24, s24, 128
s_add_u32 m0, s28, 4096
s_nop 0
buffer_load_dwordx4 v12, s[8:11], s25 offen offset:0 lds
buffer_load_dwordx4 v13, s[8:11], s25 offen offset:1024 lds
buffer_load_dwordx4 v14, s[8:11], s25 offen offset:2048 lds
buffer_load_dwordx4 v15, s[8:11], s25 offen offset:3072 lds
s_add_u32 s25, s25, 128
s_add_u32 m0, s29, 65536
s_nop 0
buffer_load_dwordx4 v16, s[12:15], s26 offen offset:0 lds
buffer_load_dwordx4 v17, s[12:15], s26 offen offset:1024 lds
buffer_load_dwordx4 v18, s[12:15], s26 offen offset:2048 lds
buffer_load_dwordx4 v19, s[12:15], s26 offen offset:3072 lds
s_add_u32 s26, s26, 524288
s_add_u32 m0, s29, 81920
s_nop 0
buffer_load_dwordx4 v16, s[12:15], s27 offen offset:0 lds
buffer_load_dwordx4 v17, s[12:15], s27 offen offset:1024 lds
buffer_load_dwordx4 v18, s[12:15], s27 offen offset:2048 lds
buffer_load_dwordx4 v19, s[12:15], s27 offen offset:3072 lds
s_add_u32 s27, s27, 524288
s_mov_b64 exec, 0
s_bfe_u32 s22, s2, 0x10004
s_lshl_b32 s22, s22, 2
s_add_u32 s22, s22, s3
s_cmp_lg_u32 s22, 0
s_cbranch_scc1 M_tw1
s_call_b64 s[98:99], PAD_0
s_call_b64 s[98:99], PAD_8
s_call_b64 s[98:99], PAD_12
s_call_b64 s[98:99], PAD_16
s_branch M_td
M_tw1:
s_cmp_lg_u32 s22, 1
s_cbranch_scc1 M_tw2
s_call_b64 s[98:99], PAD_1
s_call_b64 s[98:99], PAD_9
s_call_b64 s[98:99], PAD_13
s_branch M_td
M_tw2:
s_cmp_lg_u32 s22, 2
s_cbranch_scc1 M_tw3
s_call_b64 s[98:99], PAD_2
s_call_b64 s[98:99], PAD_6
s_call_b64 s[98:99], PAD_10
s_call_b64 s[98:99], PAD_14
s_branch M_td
M_tw3:
s_cmp_lg_u32 s22, 3
s_cbranch_scc1 M_tw4
s_call_b64 s[98:99], PAD_3
s_call_b64 s[98:99], PAD_7
s_call_b64 s[98:99], PAD_11
s_call_b64 s[98:99], PAD_15
s_branch M_td
M_tw4:
s_cmp_lg_u32 s22, 4
s_cbranch_scc1 M_tw5
s_call_b64 s[98:99], PAD_22
s_branch M_td
M_tw5:
s_cmp_lg_u32 s22, 5
s_cbranch_scc1 M_tw6
s_call_b64 s[98:99], PAD_23
s_call_b64 s[98:99], PAD_9
s_branch M_td
M_tw6:
s_cmp_lg_u32 s22, 6
s_cbranch_scc1 M_tw7
s_call_b64 s[98:99], PAD_24
s_call_b64 s[98:99], PAD_10
s_branch M_td
M_tw7:
s_call_b64 s[98:99], PAD_21
s_call_b64 s[98:99], PAD_11
M_td:
s_mov_b64 exec, -1
s_add_u32 m0, s28, 32768
s_nop 0
buffer_load_dwordx4 v12, s[8:11], s24 offen offset:0 lds
buffer_load_dwordx4 v13, s[8:11], s24 offen offset:1024 lds
buffer_load_dwordx4 v14, s[8:11], s24 offen offset:2048 lds
buffer_load_dwordx4 v15, s[8:11], s24 offen offset:3072 lds
s_add_u32 s24, s24, 128
s_add_u32 m0, s28, 36864
s_nop 0
buffer_load_dwordx4 v12, s[8:11], s25 offen offset:0 lds
buffer_load_dwordx4 v13, s[8:11], s25 offen offset:1024 lds
buffer_load_dwordx4 v14, s[8:11], s25 offen offset:2048 lds
buffer_load_dwordx4 v15, s[8:11], s25 offen offset:3072 lds
s_add_u32 s25, s25, 128
s_cmp_eq_u32 s3, 0
s_cselect_b64 s[16:17], s[12:13], s[8:9]
buffer_load_dword v21, v22, s[16:19], s43 offen
s_add_u32 s43, s43, s47
s_add_u32 s43, s43, s47
s_mov_b32 s4, s92
s_mov_b32 s5, s93
s_mov_b32 s6, 268435456
s_mov_b32 s7, 0x20000
s_cmp_eq_u32 s3, 3
s_cselect_b64 s[40:41], s[76:77], s[80:81]
s_cselect_b32 s42, 1835008, 0
s_cmp_eq_u32 s3, 1
s_cselect_b32 s42, 3670016, s42
s_cmp_eq_u32 s3, 3
s_cselect_b64 s[44:45], s[86:87], s[72:73]
s_cselect_b32 s46, 3670016, 0
s_cmp_eq_u32 s3, 1
s_cselect_b32 s46, 1835008, s46
s_cmp_eq_u32 s3, 2
s_cselect_b64 s[40:41], s[64:65], s[40:41]
s_cselect_b32 s42, 1835008, s42
s_waitcnt vmcnt(9)
s_barrier
ds_read_b64_tr_b16 a[128:129], v4 offset:0
ds_read_b64_tr_b16 a[130:131], v4 offset:2048
ds_read_b64_tr_b16 a[132:133], v4 offset:16384
ds_read_b64_tr_b16 a[134:135], v4 offset:18432
ds_read_b128 a[0:3], v2 offset:0
ds_read_b128 a[4:7], v3 offset:0
ds_read_b128 a[8:11], v2 offset:2048
ds_read_b128 a[12:15], v3 offset:2048
ds_read_b128 a[16:19], v2 offset:4096
ds_read_b128 a[20:23], v3 offset:4096
ds_read_b128 a[24:27], v2 offset:6144
ds_read_b128 a[28:31], v3 offset:6144
ds_read_b128 a[32:35], v2 offset:8192
ds_read_b128 a[36:39], v3 offset:8192
ds_read_b128 a[40:43], v2 offset:10240
ds_read_b128 a[44:47], v3 offset:10240
ds_read_b128 a[48:51], v2 offset:12288
ds_read_b128 a[52:55], v3 offset:12288
ds_read_b128 a[56:59], v2 offset:14336
ds_read_b128 a[60:63], v3 offset:14336
s_add_u32 m0, s29, 98304
s_nop 0
buffer_load_dwordx4 v16, s[12:15], s26 offen offset:0 lds
buffer_load_dwordx4 v17, s[12:15], s26 offen offset:1024 lds
buffer_load_dwordx4 v18, s[12:15], s26 offen offset:2048 lds
buffer_load_dwordx4 v19, s[12:15], s26 offen offset:3072 lds
s_add_u32 s26, s26, 524288
s_waitcnt lgkmcnt(0)
s_barrier
s_bitcmp1_b32 s2, 4
s_cbranch_scc1 M_V
s_branch M_K
M_tret:
s_setpc_b64 s[98:99]
.p2align 12
PAD_0:
s_cbranch_execz PAD_4
M_K:
v_mfma_f32_16x16x32_bf16 v[32:35], a[128:131], a[0:3], 0
s_add_u32 m0, s29, 114688
ds_read_b64_tr_b16 a[136:137], v5 offset:0
v_mfma_f32_16x16x32_bf16 v[32:35], a[132:135], a[4:7], v[32:35]
s_mov_b32 s32, 8192
buffer_load_dwordx4 v16, s[12:15], s27 offen offset:0 lds
v_mfma_f32_16x16x32_bf16 v[40:43], a[128:131], a[8:11], 0
s_mov_b32 s33, 8192
ds_read_b64_tr_b16 a[138:139], v5 offset:2048
v_mfma_f32_16x16x32_bf16 v[40:43], a[132:135], a[12:15], v[40:43]
s_mov_b32 s34, 8192
v_mfma_f32_16x16x32_bf16 v[48:51], a[128:131], a[16:19], 0
s_mov_b32 s35, 4294910976
ds_read_b64_tr_b16 a[140:141], v5 offset:16384
v_mfma_f32_16x16x32_bf16 v[48:51], a[132:135], a[20:23], v[48:51]
s_mov_b32 s36, 4294910976
buffer_load_dwordx4 v17, s[12:15], s27 offen offset:1024 lds
v_mfma_f32_16x16x32_bf16 v[56:59], a[128:131], a[24:27], 0
s_mov_b32 s30, 8
ds_read_b64_tr_b16 a[142:143], v5 offset:18432
v_mfma_f32_16x16x32_bf16 v[56:59], a[132:135], a[28:31], v[56:59]
s_mov_b32 s82, 3221225472
v_mfma_f32_16x16x32_bf16 v[64:67], a[128:131], a[32:35], 0
s_mul_hi_u32 s38, s2, 613566757
v_mfma_f32_16x16x32_bf16 v[64:67], a[132:135], a[36:39], v[64:67]
s_mul_i32 s39, s38, 7
buffer_load_dwordx4 v18, s[12:15], s27 offen offset:2048 lds
v_mfma_f32_16x16x32_bf16 v[72:75], a[128:131], a[40:43], 0
s_sub_u32 s39, s2, s39
v_mov_b32 v246, 0
v_mov_b32 v229, 0
v_mfma_f32_16x16x32_bf16 v[72:75], a[132:135], a[44:47], v[72:75]
v_mov_b32 v231, 0
v_mfma_f32_16x16x32_bf16 v[80:83], a[128:131], a[48:51], 0
s_mov_b32 s60, s90
v_mfma_f32_16x16x32_bf16 v[80:83], a[132:135], a[52:55], v[80:83]
s_mov_b32 s61, s91
buffer_load_dwordx4 v19, s[12:15], s27 offen offset:3072 lds
v_mfma_f32_16x16x32_bf16 v[88:91], a[128:131], a[56:59], 0
s_add_u32 s27, s27, 524288
v_mfma_f32_16x16x32_bf16 v[88:91], a[132:135], a[60:63], v[88:91]
s_waitcnt lgkmcnt(0)
s_mov_b32 s62, 256
v_mfma_f32_16x16x32_bf16 v[36:39], a[136:139], a[0:3], 0
s_add_u32 m0, s28, 0
ds_read_b64_tr_b16 a[128:129], v6 offset:0
v_mfma_f32_16x16x32_bf16 v[36:39], a[140:143], a[4:7], v[36:39]
s_mov_b32 s63, 0x20000
buffer_load_dwordx4 v12, s[8:11], s24 offen offset:0 lds
v_mfma_f32_16x16x32_bf16 v[44:47], a[136:139], a[8:11], 0
s_mul_hi_u32 s55, s2, 1431655766
ds_read_b64_tr_b16 a[130:131], v6 offset:2048
v_mfma_f32_16x16x32_bf16 v[44:47], a[140:143], a[12:15], v[44:47]
s_mul_i32 s55, s55, 3
v_mfma_f32_16x16x32_bf16 v[52:55], a[136:139], a[16:19], 0
s_sub_u32 s55, s2, s55
ds_read_b64_tr_b16 a[132:133], v6 offset:16384
v_mfma_f32_16x16x32_bf16 v[52:55], a[140:143], a[20:23], v[52:55]
s_add_u32 s55, s55, 5
buffer_load_dwordx4 v13, s[8:11], s24 offen offset:1024 lds
v_mfma_f32_16x16x32_bf16 v[60:63], a[136:139], a[24:27], 0
s_lshr_b32 s22, s2, 4
ds_read_b64_tr_b16 a[134:135], v6 offset:18432
v_mfma_f32_16x16x32_bf16 v[60:63], a[140:143], a[28:31], v[60:63]
s_lshl_b32 s23, s20, 5
v_mfma_f32_16x16x32_bf16 v[68:71], a[136:139], a[32:35], 0
s_add_u32 s23, s23, s22
v_mfma_f32_16x16x32_bf16 v[68:71], a[140:143], a[36:39], v[68:71]
s_lshl_b32 s23, s23, 2
buffer_load_dwordx4 v14, s[8:11], s24 offen offset:2048 lds
v_mfma_f32_16x16x32_bf16 v[76:79], a[136:139], a[40:43], 0
s_and_b32 s22, s2, 16
v_mfma_f32_16x16x32_bf16 v[76:79], a[140:143], a[44:47], v[76:79]
s_lshl_b32 s22, s22, 7
v_mfma_f32_16x16x32_bf16 v[84:87], a[136:139], a[48:51], 0
s_add_u32 s23, s23, s22
v_mov_b32 v28, 3221225472
v_writelane_b32 v28, s23, 0
v_mfma_f32_16x16x32_bf16 v[84:87], a[140:143], a[52:55], v[84:87]
s_add_u32 s56, s23, 16384
buffer_load_dwordx4 v15, s[8:11], s24 offen offset:3072 lds
v_mfma_f32_16x16x32_bf16 v[92:95], a[136:139], a[56:59], 0
s_add_u32 s24, s24, 128
v_writelane_b32 v28, s56, 1
v_mfma_f32_16x16x32_bf16 v[92:95], a[140:143], a[60:63], v[92:95]
s_waitcnt lgkmcnt(0)
s_add_u32 s56, s23, 4096
v_writelane_b32 v28, s56, 2
v_mfma_f32_16x16x32_bf16 v[96:99], a[128:131], a[0:3], 0
s_add_u32 m0, s28, 4096
ds_read_b64_tr_b16 a[136:137], v7 offset:0
v_mfma_f32_16x16x32_bf16 v[96:99], a[132:135], a[4:7], v[96:99]
s_sub_u32 s37, 15, s21
buffer_load_dwordx4 v12, s[8:11], s25 offen offset:0 lds
v_mfma_f32_16x16x32_bf16 v[104:107], a[128:131], a[8:11], 0
ds_read_b64_tr_b16 a[138:139], v7 offset:2048
v_mfma_f32_16x16x32_bf16 v[104:107], a[132:135], a[12:15], v[104:107]
v_mfma_f32_16x16x32_bf16 v[112:115], a[128:131], a[16:19], 0
ds_read_b64_tr_b16 a[140:141], v7 offset:16384
v_mfma_f32_16x16x32_bf16 v[112:115], a[132:135], a[20:23], v[112:115]
buffer_load_dwordx4 v13, s[8:11], s25 offen offset:1024 lds
v_mfma_f32_16x16x32_bf16 v[120:123], a[128:131], a[24:27], 0
ds_read_b64_tr_b16 a[142:143], v7 offset:18432
v_mfma_f32_16x16x32_bf16 v[120:123], a[132:135], a[28:31], v[120:123]
v_mfma_f32_16x16x32_bf16 v[128:131], a[128:131], a[32:35], 0
v_mfma_f32_16x16x32_bf16 v[128:131], a[132:135], a[36:39], v[128:131]
buffer_load_dwordx4 v14, s[8:11], s25 offen offset:2048 lds
v_mfma_f32_16x16x32_bf16 v[136:139], a[128:131], a[40:43], 0
v_mfma_f32_16x16x32_bf16 v[136:139], a[132:135], a[44:47], v[136:139]
v_mfma_f32_16x16x32_bf16 v[144:147], a[128:131], a[48:51], 0
v_mfma_f32_16x16x32_bf16 v[144:147], a[132:135], a[52:55], v[144:147]
buffer_load_dwordx4 v15, s[8:11], s25 offen offset:3072 lds
v_mfma_f32_16x16x32_bf16 v[152:155], a[128:131], a[56:59], 0
s_add_u32 s25, s25, 128
v_mfma_f32_16x16x32_bf16 v[152:155], a[132:135], a[60:63], v[152:155]
s_waitcnt vmcnt(17) lgkmcnt(0)
s_barrier
v_mfma_f32_16x16x32_bf16 v[100:103], a[136:139], a[0:3], 0
ds_read_b64_tr_b16 a[128:129], v8 offset:0
v_mfma_f32_16x16x32_bf16 v[100:103], a[140:143], a[4:7], v[100:103]
buffer_load_dword v21, v20, s[16:19], s43 offen
v_mfma_f32_16x16x32_bf16 v[108:111], a[136:139], a[8:11], 0
s_add_u32 s43, s43, s47
ds_read_b64_tr_b16 a[130:131], v8 offset:2048
v_mfma_f32_16x16x32_bf16 v[108:111], a[140:143], a[12:15], v[108:111]
s_cmp_ge_u32 s43, s51
v_mfma_f32_16x16x32_bf16 v[116:119], a[136:139], a[16:19], 0
s_cselect_b32 s43, 0, s43
ds_read_b64_tr_b16 a[132:133], v8 offset:16384
v_mfma_f32_16x16x32_bf16 v[116:119], a[140:143], a[20:23], v[116:119]
s_cselect_b32 s51, s42, s51
v_mfma_f32_16x16x32_bf16 v[124:127], a[136:139], a[24:27], 0
s_cselect_b64 s[16:17], s[40:41], s[16:17]
ds_read_b64_tr_b16 a[134:135], v8 offset:18432
v_mfma_f32_16x16x32_bf16 v[124:127], a[140:143], a[28:31], v[124:127]
s_cselect_b32 s18, s42, s18
v_mfma_f32_16x16x32_bf16 v[132:135], a[136:139], a[32:35], 0
s_cselect_b64 s[40:41], s[44:45], s[40:41]
ds_read_b128 a[64:67], v2 offset:32768
v_mfma_f32_16x16x32_bf16 v[132:135], a[140:143], a[36:39], v[132:135]
s_cselect_b32 s42, s46, s42
v_mfma_f32_16x16x32_bf16 v[140:143], a[136:139], a[40:43], 0
s_cselect_b32 s46, 0, s46
ds_read_b128 a[68:71], v3 offset:32768
v_mfma_f32_16x16x32_bf16 v[140:143], a[140:143], a[44:47], v[140:143]
ds_read_b128 a[72:75], v2 offset:34816
v_mfma_f32_16x16x32_bf16 v[148:151], a[136:139], a[48:51], 0
ds_read_b128 a[76:79], v3 offset:34816
v_mfma_f32_16x16x32_bf16 v[148:151], a[140:143], a[52:55], v[148:151]
buffer_load_dword v21, v20, s[16:19], s43 offen
v_mfma_f32_16x16x32_bf16 v[156:159], a[136:139], a[56:59], 0
s_add_u32 s43, s43, s47
ds_read_b128 a[80:83], v2 offset:36864
v_mfma_f32_16x16x32_bf16 v[156:159], a[140:143], a[60:63], v[156:159]
s_waitcnt lgkmcnt(5)
s_cmp_ge_u32 s43, s51
ds_read_b128 a[84:87], v3 offset:36864
v_mfma_f32_16x16x32_bf16 v[160:163], a[128:131], a[0:3], 0
s_cselect_b32 s43, 0, s43
ds_read_b64_tr_b16 a[136:137], v9 offset:0
v_mfma_f32_16x16x32_bf16 v[160:163], a[132:135], a[4:7], v[160:163]
s_cselect_b32 s51, s42, s51
v_mfma_f32_16x16x32_bf16 v[168:171], a[128:131], a[8:11], 0
s_cselect_b64 s[16:17], s[40:41], s[16:17]
ds_read_b64_tr_b16 a[138:139], v9 offset:2048
v_mfma_f32_16x16x32_bf16 v[168:171], a[132:135], a[12:15], v[168:171]
s_cselect_b32 s18, s42, s18
v_mfma_f32_16x16x32_bf16 v[176:179], a[128:131], a[16:19], 0
s_cselect_b64 s[40:41], s[44:45], s[40:41]
ds_read_b64_tr_b16 a[140:141], v9 offset:16384
v_mfma_f32_16x16x32_bf16 v[176:179], a[132:135], a[20:23], v[176:179]
s_cselect_b32 s42, s46, s42
v_mfma_f32_16x16x32_bf16 v[184:187], a[128:131], a[24:27], 0
s_cselect_b32 s46, 0, s46
ds_read_b64_tr_b16 a[142:143], v9 offset:18432
v_mfma_f32_16x16x32_bf16 v[184:187], a[132:135], a[28:31], v[184:187]
s_bitcmp1_b32 s2, 4
s_cselect_b32 s37, s21, s37
s_lshl_b32 s56, s37, 5
v_mfma_f32_16x16x32_bf16 v[192:195], a[128:131], a[32:35], 0
s_add_u32 s56, s56, s20
s_lshl_b32 s56, s56, 2
s_add_u32 s56, s56, 8192
v_mfma_f32_16x16x32_bf16 v[192:195], a[132:135], a[36:39], v[192:195]
v_writelane_b32 v28, s56, 3
v_mfma_f32_16x16x32_bf16 v[200:203], a[128:131], a[40:43], 0
s_add_u32 s56, s56, 2048
ds_read_b128 a[88:91], v2 offset:38912
v_writelane_b32 v28, s56, 6
v_mfma_f32_16x16x32_bf16 v[200:203], a[132:135], a[44:47], v[200:203]
s_lshl_b32 s56, s2, 2
s_add_u32 s56, s56, 12288
ds_read_b128 a[92:95], v3 offset:38912
v_mfma_f32_16x16x32_bf16 v[208:211], a[128:131], a[48:51], 0
s_waitcnt lgkmcnt(2)
ds_read_b128 a[96:99], v2 offset:40960
v_writelane_b32 v28, s56, 4
v_mfma_f32_16x16x32_bf16 v[208:211], a[132:135], a[52:55], v[208:211]
s_lshl_b32 s56, s39, 5
s_add_u32 s56, s56, s38
s_lshl_b32 s56, s56, 2
v_mfma_f32_16x16x32_bf16 v[216:219], a[128:131], a[56:59], 0
s_add_u32 s56, s56, 20480
s_cmp_lt_u32 s2, 224
ds_read_b128 a[100:103], v3 offset:40960
v_mfma_f32_16x16x32_bf16 v[216:219], a[132:135], a[60:63], v[216:219]
s_cselect_b32 s56, s56, 3221225472
ds_read_b128 a[104:107], v2 offset:43008
v_writelane_b32 v28, s56, 7
v_mfma_f32_16x16x32_bf16 v[164:167], a[136:139], a[0:3], 0
s_cmp_eq_u32 s3, 0
s_cselect_b32 s56, 94371840, 3221225472
ds_read_b64_tr_b16 a[128:129], v10 offset:0
v_mfma_f32_16x16x32_bf16 v[164:167], a[140:143], a[4:7], v[164:167]
buffer_store_dword v246, v28, s[4:7], s56 offen sc1
v_mfma_f32_16x16x32_bf16 v[172:175], a[136:139], a[8:11], 0
ds_read_b64_tr_b16 a[130:131], v10 offset:2048
v_mov_b32 v27, 1
v_mfma_f32_16x16x32_bf16 v[172:175], a[140:143], a[12:15], v[172:175]
v_cmp_eq_u32 vcc, 0, v0
v_mov_b32 v26, 3221225472
v_mfma_f32_16x16x32_bf16 v[180:183], a[136:139], a[16:19], 0
s_lshl_b32 s31, s20, 20
s_lshl_b32 s22, s21, 17
ds_read_b64_tr_b16 a[132:133], v10 offset:16384
v_mfma_f32_16x16x32_bf16 v[180:183], a[140:143], a[20:23], v[180:183]
v_cndmask_b32 v26, v26, v246, vcc
v_mfma_f32_16x16x32_bf16 v[188:191], a[136:139], a[24:27], 0
s_add_u32 s31, s31, s22
s_lshr_b32 s22, s3, 1
ds_read_b64_tr_b16 a[134:135], v10 offset:18432
v_mfma_f32_16x16x32_bf16 v[188:191], a[140:143], a[28:31], v[188:191]
s_lshl_b32 s22, s22, 16
s_add_u32 s31, s31, s22
s_and_b32 s22, s3, 1
v_mfma_f32_16x16x32_bf16 v[196:199], a[136:139], a[32:35], 0
s_lshl_b32 s22, s22, 12
s_add_u32 s31, s31, s22
v_mfma_f32_16x16x32_bf16 v[196:199], a[140:143], a[36:39], v[196:199]
v_mfma_f32_16x16x32_bf16 v[204:207], a[136:139], a[40:43], 0
ds_read_b128 a[108:111], v3 offset:43008
v_mfma_f32_16x16x32_bf16 v[204:207], a[140:143], a[44:47], v[204:207]
ds_read_b128 a[112:115], v2 offset:45056
v_mfma_f32_16x16x32_bf16 v[212:215], a[136:139], a[48:51], 0
ds_read_b128 a[116:119], v3 offset:45056
v_mfma_f32_16x16x32_bf16 v[212:215], a[140:143], a[52:55], v[212:215]
v_mfma_f32_16x16x32_bf16 v[220:223], a[136:139], a[56:59], 0
ds_read_b128 a[120:123], v2 offset:47104
v_mfma_f32_16x16x32_bf16 v[220:223], a[140:143], a[60:63], v[220:223]
s_waitcnt lgkmcnt(4)
ds_read_b128 a[124:127], v3 offset:47104
v_mfma_f32_16x16x32_bf16 a[192:195], a[128:131], a[0:3], 0
ds_read_b64_tr_b16 a[136:137], v11 offset:0
v_mfma_f32_16x16x32_bf16 a[192:195], a[132:135], a[4:7], a[192:195]
v_mfma_f32_16x16x32_bf16 a[200:203], a[128:131], a[8:11], 0
ds_read_b64_tr_b16 a[138:139], v11 offset:2048
v_mfma_f32_16x16x32_bf16 a[200:203], a[132:135], a[12:15], a[200:203]
v_mfma_f32_16x16x32_bf16 a[208:211], a[128:131], a[16:19], 0
ds_read_b64_tr_b16 a[140:141], v11 offset:16384
v_mfma_f32_16x16x32_bf16 a[208:211], a[132:135], a[20:23], a[208:211]
v_mfma_f32_16x16x32_bf16 a[216:219], a[128:131], a[24:27], 0
ds_read_b64_tr_b16 a[142:143], v11 offset:18432
v_mfma_f32_16x16x32_bf16 a[216:219], a[132:135], a[28:31], a[216:219]
v_mfma_f32_16x16x32_bf16 a[224:227], a[128:131], a[32:35], 0
v_mfma_f32_16x16x32_bf16 a[224:227], a[132:135], a[36:39], a[224:227]
v_mfma_f32_16x16x32_bf16 a[232:235], a[128:131], a[40:43], 0
v_mfma_f32_16x16x32_bf16 a[232:235], a[132:135], a[44:47], a[232:235]
v_mfma_f32_16x16x32_bf16 a[240:243], a[128:131], a[48:51], 0
v_mfma_f32_16x16x32_bf16 a[240:243], a[132:135], a[52:55], a[240:243]
v_mfma_f32_16x16x32_bf16 a[248:251], a[128:131], a[56:59], 0
s_waitcnt vmcnt(3) lgkmcnt(0)
v_mfma_f32_16x16x32_bf16 a[248:251], a[132:135], a[60:63], a[248:251]
s_barrier
v_mfma_f32_16x16x32_bf16 a[196:199], a[136:139], a[0:3], 0
s_add_u32 m0, s29, 65536
ds_read_b64_tr_b16 a[128:129], v4 offset:32768
v_mfma_f32_16x16x32_bf16 a[196:199], a[140:143], a[4:7], a[196:199]
buffer_load_dwordx4 v16, s[12:15], s26 offen offset:0 lds
v_mfma_f32_16x16x32_bf16 a[204:207], a[136:139], a[8:11], 0
ds_read_b64_tr_b16 a[130:131], v4 offset:34816
v_mfma_f32_16x16x32_bf16 a[204:207], a[140:143], a[12:15], a[204:207]
v_mfma_f32_16x16x32_bf16 a[212:215], a[136:139], a[16:19], 0
ds_read_b64_tr_b16 a[132:133], v4 offset:49152
v_mfma_f32_16x16x32_bf16 a[212:215], a[140:143], a[20:23], a[212:215]
buffer_load_dwordx4 v17, s[12:15], s26 offen offset:1024 lds
v_mfma_f32_16x16x32_bf16 a[220:223], a[136:139], a[24:27], 0
ds_read_b64_tr_b16 a[134:135], v4 offset:51200
v_mfma_f32_16x16x32_bf16 a[220:223], a[140:143], a[28:31], a[220:223]
v_mfma_f32_16x16x32_bf16 a[228:231], a[136:139], a[32:35], 0
v_mfma_f32_16x16x32_bf16 a[228:231], a[140:143], a[36:39], a[228:231]
buffer_load_dwordx4 v18, s[12:15], s26 offen offset:2048 lds
v_mfma_f32_16x16x32_bf16 a[236:239], a[136:139], a[40:43], 0
v_mfma_f32_16x16x32_bf16 a[236:239], a[140:143], a[44:47], a[236:239]
v_mfma_f32_16x16x32_bf16 a[244:247], a[136:139], a[48:51], 0
v_mfma_f32_16x16x32_bf16 a[244:247], a[140:143], a[52:55], a[244:247]
buffer_load_dwordx4 v19, s[12:15], s26 offen offset:3072 lds
v_mfma_f32_16x16x32_bf16 a[252:255], a[136:139], a[56:59], 0
s_add_u32 s26, s26, 524288
v_mfma_f32_16x16x32_bf16 a[252:255], a[140:143], a[60:63], a[252:255]
s_waitcnt lgkmcnt(0)
Lg_1:
v_mfma_f32_16x16x32_bf16 v[32:35], a[128:131], a[64:67], v[32:35]
s_add_u32 m0, s29, 81920
ds_read_b64_tr_b16 a[136:137], v5 offset:32768
v_mfma_f32_16x16x32_bf16 v[32:35], a[132:135], a[68:71], v[32:35]
buffer_load_dwordx4 v16, s[12:15], s27 offen offset:0 lds
v_mfma_f32_16x16x32_bf16 v[40:43], a[128:131], a[72:75], v[40:43]
ds_read_b64_tr_b16 a[138:139], v5 offset:34816
v_mfma_f32_16x16x32_bf16 v[40:43], a[132:135], a[76:79], v[40:43]
v_mfma_f32_16x16x32_bf16 v[48:51], a[128:131], a[80:83], v[48:51]
ds_read_b64_tr_b16 a[140:141], v5 offset:49152
v_mfma_f32_16x16x32_bf16 v[48:51], a[132:135], a[84:87], v[48:51]
buffer_load_dwordx4 v17, s[12:15], s27 offen offset:1024 lds
v_mfma_f32_16x16x32_bf16 v[56:59], a[128:131], a[88:91], v[56:59]
ds_read_b64_tr_b16 a[142:143], v5 offset:51200
v_mfma_f32_16x16x32_bf16 v[56:59], a[132:135], a[92:95], v[56:59]
v_mfma_f32_16x16x32_bf16 v[64:67], a[128:131], a[96:99], v[64:67]
ds_read_b128 a[0:3], v2 offset:0
v_mfma_f32_16x16x32_bf16 v[64:67], a[132:135], a[100:103], v[64:67]
buffer_load_dwordx4 v18, s[12:15], s27 offen offset:2048 lds
v_mfma_f32_16x16x32_bf16 v[72:75], a[128:131], a[104:107], v[72:75]
ds_read_b128 a[4:7], v3 offset:0
v_mfma_f32_16x16x32_bf16 v[72:75], a[132:135], a[108:111], v[72:75]
v_mfma_f32_16x16x32_bf16 v[80:83], a[128:131], a[112:115], v[80:83]
v_mfma_f32_16x16x32_bf16 v[80:83], a[132:135], a[116:119], v[80:83]
buffer_load_dwordx4 v19, s[12:15], s27 offen offset:3072 lds
v_mfma_f32_16x16x32_bf16 v[88:91], a[128:131], a[120:123], v[88:91]
s_add_u32 s27, s27, 524288
ds_read_b128 a[8:11], v2 offset:2048
v_mfma_f32_16x16x32_bf16 v[88:91], a[132:135], a[124:127], v[88:91]
s_waitcnt lgkmcnt(3)
v_mfma_f32_16x16x32_bf16 v[36:39], a[136:139], a[64:67], v[36:39]
s_add_u32 m0, s28, 32768
ds_read_b64_tr_b16 a[128:129], v6 offset:32768
v_mfma_f32_16x16x32_bf16 v[36:39], a[140:143], a[68:71], v[36:39]
buffer_load_dwordx4 v12, s[8:11], s24 offen offset:0 lds
v_mfma_f32_16x16x32_bf16 v[44:47], a[136:139], a[72:75], v[44:47]
ds_read_b64_tr_b16 a[130:131], v6 offset:34816
v_mfma_f32_16x16x32_bf16 v[44:47], a[140:143], a[76:79], v[44:47]
v_mfma_f32_16x16x32_bf16 v[52:55], a[136:139], a[80:83], v[52:55]
ds_read_b64_tr_b16 a[132:133], v6 offset:49152
v_mfma_f32_16x16x32_bf16 v[52:55], a[140:143], a[84:87], v[52:55]
buffer_load_dwordx4 v13, s[8:11], s24 offen offset:1024 lds
v_mfma_f32_16x16x32_bf16 v[60:63], a[136:139], a[88:91], v[60:63]
ds_read_b64_tr_b16 a[134:135], v6 offset:51200
v_mfma_f32_16x16x32_bf16 v[60:63], a[140:143], a[92:95], v[60:63]
v_mfma_f32_16x16x32_bf16 v[68:71], a[136:139], a[96:99], v[68:71]
ds_read_b128 a[12:15], v3 offset:2048
v_mfma_f32_16x16x32_bf16 v[68:71], a[140:143], a[100:103], v[68:71]
buffer_load_dwordx4 v14, s[8:11], s24 offen offset:2048 lds
v_mfma_f32_16x16x32_bf16 v[76:79], a[136:139], a[104:107], v[76:79]
v_mfma_f32_16x16x32_bf16 v[76:79], a[140:143], a[108:111], v[76:79]
v_mfma_f32_16x16x32_bf16 v[84:87], a[136:139], a[112:115], v[84:87]
ds_read_b128 a[16:19], v2 offset:4096
v_mfma_f32_16x16x32_bf16 v[84:87], a[140:143], a[116:119], v[84:87]
buffer_load_dwordx4 v15, s[8:11], s24 offen offset:3072 lds
v_mfma_f32_16x16x32_bf16 v[92:95], a[136:139], a[120:123], v[92:95]
s_add_u32 s24, s24, 128
ds_read_b128 a[20:23], v3 offset:4096
v_mfma_f32_16x16x32_bf16 v[92:95], a[140:143], a[124:127], v[92:95]
s_waitcnt lgkmcnt(3)
v_mfma_f32_16x16x32_bf16 v[96:99], a[128:131], a[64:67], v[96:99]
s_add_u32 m0, s28, 36864
ds_read_b64_tr_b16 a[136:137], v7 offset:32768
v_mfma_f32_16x16x32_bf16 v[96:99], a[132:135], a[68:71], v[96:99]
buffer_load_dwordx4 v12, s[8:11], s25 offen offset:0 lds
v_mfma_f32_16x16x32_bf16 v[104:107], a[128:131], a[72:75], v[104:107]
ds_read_b64_tr_b16 a[138:139], v7 offset:34816
v_mfma_f32_16x16x32_bf16 v[104:107], a[132:135], a[76:79], v[104:107]
v_mfma_f32_16x16x32_bf16 v[112:115], a[128:131], a[80:83], v[112:115]
ds_read_b64_tr_b16 a[140:141], v7 offset:49152
v_mfma_f32_16x16x32_bf16 v[112:115], a[132:135], a[84:87], v[112:115]
buffer_load_dwordx4 v13, s[8:11], s25 offen offset:1024 lds
v_mfma_f32_16x16x32_bf16 v[120:123], a[128:131], a[88:91], v[120:123]
ds_read_b64_tr_b16 a[142:143], v7 offset:51200
v_mfma_f32_16x16x32_bf16 v[120:123], a[132:135], a[92:95], v[120:123]
v_mfma_f32_16x16x32_bf16 v[128:131], a[128:131], a[96:99], v[128:131]
v_mfma_f32_16x16x32_bf16 v[128:131], a[132:135], a[100:103], v[128:131]
buffer_load_dwordx4 v14, s[8:11], s25 offen offset:2048 lds
v_mfma_f32_16x16x32_bf16 v[136:139], a[128:131], a[104:107], v[136:139]
ds_read_b128 a[24:27], v2 offset:6144
v_mfma_f32_16x16x32_bf16 v[136:139], a[132:135], a[108:111], v[136:139]
v_mfma_f32_16x16x32_bf16 v[144:147], a[128:131], a[112:115], v[144:147]
ds_read_b128 a[28:31], v3 offset:6144
v_mfma_f32_16x16x32_bf16 v[144:147], a[132:135], a[116:119], v[144:147]
buffer_load_dwordx4 v15, s[8:11], s25 offen offset:3072 lds
v_mfma_f32_16x16x32_bf16 v[152:155], a[128:131], a[120:123], v[152:155]
s_add_u32 s25, s25, 128
v_mfma_f32_16x16x32_bf16 v[152:155], a[132:135], a[124:127], v[152:155]
s_waitcnt lgkmcnt(2)
v_mfma_f32_16x16x32_bf16 v[100:103], a[136:139], a[64:67], v[100:103]
ds_read_b64_tr_b16 a[128:129], v8 offset:32768
v_mfma_f32_16x16x32_bf16 v[100:103], a[140:143], a[68:71], v[100:103]
buffer_load_dword v21, v20, s[16:19], s43 offen
v_mfma_f32_16x16x32_bf16 v[108:111], a[136:139], a[72:75], v[108:111]
s_add_u32 s43, s43, s47
ds_read_b64_tr_b16 a[130:131], v8 offset:34816
v_mfma_f32_16x16x32_bf16 v[108:111], a[140:143], a[76:79], v[108:111]
s_cmp_ge_u32 s43, s51
v_mfma_f32_16x16x32_bf16 v[116:119], a[136:139], a[80:83], v[116:119]
s_cselect_b32 s43, 0, s43
ds_read_b64_tr_b16 a[132:133], v8 offset:49152
v_mfma_f32_16x16x32_bf16 v[116:119], a[140:143], a[84:87], v[116:119]
s_cselect_b32 s51, s42, s51
v_mfma_f32_16x16x32_bf16 v[124:127], a[136:139], a[88:91], v[124:127]
s_cselect_b64 s[16:17], s[40:41], s[16:17]
ds_read_b64_tr_b16 a[134:135], v8 offset:51200
v_mfma_f32_16x16x32_bf16 v[124:127], a[140:143], a[92:95], v[124:127]
s_cselect_b32 s18, s42, s18
v_mfma_f32_16x16x32_bf16 v[132:135], a[136:139], a[96:99], v[132:135]
s_cselect_b64 s[40:41], s[44:45], s[40:41]
ds_read_b128 a[32:35], v2 offset:8192
v_mfma_f32_16x16x32_bf16 v[132:135], a[140:143], a[100:103], v[132:135]
s_cselect_b32 s42, s46, s42
v_mfma_f32_16x16x32_bf16 v[140:143], a[136:139], a[104:107], v[140:143]
s_cselect_b32 s46, 0, s46
v_mfma_f32_16x16x32_bf16 v[140:143], a[140:143], a[108:111], v[140:143]
s_cmp_eq_u32 s30, s55
v_mfma_f32_16x16x32_bf16 v[148:151], a[136:139], a[112:115], v[148:151]
s_cselect_b32 s22, 0, 3221225472
ds_read_b128 a[36:39], v3 offset:8192
v_mfma_f32_16x16x32_bf16 v[148:151], a[140:143], a[116:119], v[148:151]
s_sub_u32 s30, s30, 1
buffer_atomic_add v27, v26, s[60:63], s22 offen sc1
v_mfma_f32_16x16x32_bf16 v[156:159], a[136:139], a[120:123], v[156:159]
ds_read_b128 a[40:43], v2 offset:10240
v_mfma_f32_16x16x32_bf16 v[156:159], a[140:143], a[124:127], v[156:159]
s_waitcnt lgkmcnt(3)
v_mfma_f32_16x16x32_bf16 v[160:163], a[128:131], a[64:67], v[160:163]
ds_read_b64_tr_b16 a[136:137], v9 offset:32768
v_mfma_f32_16x16x32_bf16 v[160:163], a[132:135], a[68:71], v[160:163]
v_mfma_f32_16x16x32_bf16 v[168:171], a[128:131], a[72:75], v[168:171]
ds_read_b64_tr_b16 a[138:139], v9 offset:34816
v_mfma_f32_16x16x32_bf16 v[168:171], a[132:135], a[76:79], v[168:171]
v_mfma_f32_16x16x32_bf16 v[176:179], a[128:131], a[80:83], v[176:179]
ds_read_b64_tr_b16 a[140:141], v9 offset:49152
v_mfma_f32_16x16x32_bf16 v[176:179], a[132:135], a[84:87], v[176:179]
v_mfma_f32_16x16x32_bf16 v[184:187], a[128:131], a[88:91], v[184:187]
ds_read_b64_tr_b16 a[142:143], v9 offset:51200
v_mfma_f32_16x16x32_bf16 v[184:187], a[132:135], a[92:95], v[184:187]
v_mfma_f32_16x16x32_bf16 v[192:195], a[128:131], a[96:99], v[192:195]
v_mfma_f32_16x16x32_bf16 v[192:195], a[132:135], a[100:103], v[192:195]
v_mfma_f32_16x16x32_bf16 v[200:203], a[128:131], a[104:107], v[200:203]
ds_read_b128 a[44:47], v3 offset:10240
v_mfma_f32_16x16x32_bf16 v[200:203], a[132:135], a[108:111], v[200:203]
v_mfma_f32_16x16x32_bf16 v[208:211], a[128:131], a[112:115], v[208:211]
ds_read_b128 a[48:51], v2 offset:12288
v_mfma_f32_16x16x32_bf16 v[208:211], a[132:135], a[116:119], v[208:211]
v_mfma_f32_16x16x32_bf16 v[216:219], a[128:131], a[120:123], v[216:219]
v_mfma_f32_16x16x32_bf16 v[216:219], a[132:135], a[124:127], v[216:219]
s_waitcnt lgkmcnt(2)
v_mfma_f32_16x16x32_bf16 v[164:167], a[136:139], a[64:67], v[164:167]
ds_read_b64_tr_b16 a[128:129], v10 offset:32768
v_mfma_f32_16x16x32_bf16 v[164:167], a[140:143], a[68:71], v[164:167]
v_mfma_f32_16x16x32_bf16 v[172:175], a[136:139], a[72:75], v[172:175]
ds_read_b64_tr_b16 a[130:131], v10 offset:34816
v_mfma_f32_16x16x32_bf16 v[172:175], a[140:143], a[76:79], v[172:175]
v_mfma_f32_16x16x32_bf16 v[180:183], a[136:139], a[80:83], v[180:183]
ds_read_b64_tr_b16 a[132:133], v10 offset:49152
v_mfma_f32_16x16x32_bf16 v[180:183], a[140:143], a[84:87], v[180:183]
v_mfma_f32_16x16x32_bf16 v[188:191], a[136:139], a[88:91], v[188:191]
ds_read_b64_tr_b16 a[134:135], v10 offset:51200
v_mfma_f32_16x16x32_bf16 v[188:191], a[140:143], a[92:95], v[188:191]
v_mfma_f32_16x16x32_bf16 v[196:199], a[136:139], a[96:99], v[196:199]
ds_read_b128 a[52:55], v3 offset:12288
v_mfma_f32_16x16x32_bf16 v[196:199], a[140:143], a[100:103], v[196:199]
v_mfma_f32_16x16x32_bf16 v[204:207], a[136:139], a[104:107], v[204:207]
ds_read_b128 a[56:59], v2 offset:14336
v_mfma_f32_16x16x32_bf16 v[204:207], a[140:143], a[108:111], v[204:207]
v_mfma_f32_16x16x32_bf16 v[212:215], a[136:139], a[112:115], v[212:215]
v_mfma_f32_16x16x32_bf16 v[212:215], a[140:143], a[116:119], v[212:215]
v_mfma_f32_16x16x32_bf16 v[220:223], a[136:139], a[120:123], v[220:223]
ds_read_b128 a[60:63], v3 offset:14336
v_mfma_f32_16x16x32_bf16 v[220:223], a[140:143], a[124:127], v[220:223]
s_waitcnt lgkmcnt(3)
v_mfma_f32_16x16x32_bf16 a[192:195], a[128:131], a[64:67], a[192:195]
ds_read_b64_tr_b16 a[136:137], v11 offset:32768
v_mfma_f32_16x16x32_bf16 a[192:195], a[132:135], a[68:71], a[192:195]
v_mfma_f32_16x16x32_bf16 a[200:203], a[128:131], a[72:75], a[200:203]
ds_read_b64_tr_b16 a[138:139], v11 offset:34816
v_mfma_f32_16x16x32_bf16 a[200:203], a[132:135], a[76:79], a[200:203]
v_mfma_f32_16x16x32_bf16 a[208:211], a[128:131], a[80:83], a[208:211]
ds_read_b64_tr_b16 a[140:141], v11 offset:49152
v_mfma_f32_16x16x32_bf16 a[208:211], a[132:135], a[84:87], a[208:211]
v_mfma_f32_16x16x32_bf16 a[216:219], a[128:131], a[88:91], a[216:219]
ds_read_b64_tr_b16 a[142:143], v11 offset:51200
v_mfma_f32_16x16x32_bf16 a[216:219], a[132:135], a[92:95], a[216:219]
v_mfma_f32_16x16x32_bf16 a[224:227], a[128:131], a[96:99], a[224:227]
v_mfma_f32_16x16x32_bf16 a[224:227], a[132:135], a[100:103], a[224:227]
v_mfma_f32_16x16x32_bf16 a[232:235], a[128:131], a[104:107], a[232:235]
v_mfma_f32_16x16x32_bf16 a[232:235], a[132:135], a[108:111], a[232:235]
v_mfma_f32_16x16x32_bf16 a[240:243], a[128:131], a[112:115], a[240:243]
v_mfma_f32_16x16x32_bf16 a[240:243], a[132:135], a[116:119], a[240:243]
v_mfma_f32_16x16x32_bf16 a[248:251], a[128:131], a[120:123], a[248:251]
s_waitcnt vmcnt(2) lgkmcnt(0)
v_mfma_f32_16x16x32_bf16 a[248:251], a[132:135], a[124:127], a[248:251]
s_barrier
v_mfma_f32_16x16x32_bf16 a[196:199], a[136:139], a[64:67], a[196:199]
s_add_u32 m0, s29, 98304
ds_read_b64_tr_b16 a[128:129], v4 offset:0
v_mfma_f32_16x16x32_bf16 a[196:199], a[140:143], a[68:71], a[196:199]
buffer_load_dwordx4 v16, s[12:15], s26 offen offset:0 lds
v_mfma_f32_16x16x32_bf16 a[204:207], a[136:139], a[72:75], a[204:207]
ds_read_b64_tr_b16 a[130:131], v4 offset:2048
v_mfma_f32_16x16x32_bf16 a[204:207], a[140:143], a[76:79], a[204:207]
v_mfma_f32_16x16x32_bf16 a[212:215], a[136:139], a[80:83], a[212:215]
ds_read_b64_tr_b16 a[132:133], v4 offset:16384
v_mfma_f32_16x16x32_bf16 a[212:215], a[140:143], a[84:87], a[212:215]
buffer_load_dwordx4 v17, s[12:15], s26 offen offset:1024 lds
v_mfma_f32_16x16x32_bf16 a[220:223], a[136:139], a[88:91], a[220:223]
ds_read_b64_tr_b16 a[134:135], v4 offset:18432
v_mfma_f32_16x16x32_bf16 a[220:223], a[140:143], a[92:95], a[220:223]
v_mfma_f32_16x16x32_bf16 a[228:231], a[136:139], a[96:99], a[228:231]
v_mfma_f32_16x16x32_bf16 a[228:231], a[140:143], a[100:103], a[228:231]
buffer_load_dwordx4 v18, s[12:15], s26 offen offset:2048 lds
v_mfma_f32_16x16x32_bf16 a[236:239], a[136:139], a[104:107], a[236:239]
v_mfma_f32_16x16x32_bf16 a[236:239], a[140:143], a[108:111], a[236:239]
v_mfma_f32_16x16x32_bf16 a[244:247], a[136:139], a[112:115], a[244:247]
v_mfma_f32_16x16x32_bf16 a[244:247], a[140:143], a[116:119], a[244:247]
buffer_load_dwordx4 v19, s[12:15], s26 offen offset:3072 lds
v_mfma_f32_16x16x32_bf16 a[252:255], a[136:139], a[120:123], a[252:255]
s_add_u32 s26, s26, 524288
v_mfma_f32_16x16x32_bf16 a[252:255], a[140:143], a[124:127], a[252:255]
s_waitcnt lgkmcnt(0)
buffer_store_dword v27, v26, s[4:7], s82 offen sc1
v_mfma_f32_16x16x32_bf16 v[32:35], a[128:131], a[0:3], v[32:35]
s_add_u32 m0, s29, 114688
ds_read_b64_tr_b16 a[136:137], v5 offset:0
v_mfma_f32_16x16x32_bf16 v[32:35], a[132:135], a[4:7], v[32:35]
buffer_load_dwordx4 v16, s[12:15], s27 offen offset:0 lds
v_mfma_f32_16x16x32_bf16 v[40:43], a[128:131], a[8:11], v[40:43]
ds_read_b64_tr_b16 a[138:139], v5 offset:2048
v_mfma_f32_16x16x32_bf16 v[40:43], a[132:135], a[12:15], v[40:43]
v_mfma_f32_16x16x32_bf16 v[48:51], a[128:131], a[16:19], v[48:51]
ds_read_b64_tr_b16 a[140:141], v5 offset:16384
v_mfma_f32_16x16x32_bf16 v[48:51], a[132:135], a[20:23], v[48:51]
buffer_load_dwordx4 v17, s[12:15], s27 offen offset:1024 lds
v_mfma_f32_16x16x32_bf16 v[56:59], a[128:131], a[24:27], v[56:59]
ds_read_b64_tr_b16 a[142:143], v5 offset:18432
v_mfma_f32_16x16x32_bf16 v[56:59], a[132:135], a[28:31], v[56:59]
v_mfma_f32_16x16x32_bf16 v[64:67], a[128:131], a[32:35], v[64:67]
ds_read_b128 a[64:67], v2 offset:32768
v_mfma_f32_16x16x32_bf16 v[64:67], a[132:135], a[36:39], v[64:67]
buffer_load_dwordx4 v18, s[12:15], s27 offen offset:2048 lds
v_mfma_f32_16x16x32_bf16 v[72:75], a[128:131], a[40:43], v[72:75]
ds_read_b128 a[68:71], v3 offset:32768
v_mfma_f32_16x16x32_bf16 v[72:75], a[132:135], a[44:47], v[72:75]
v_mfma_f32_16x16x32_bf16 v[80:83], a[128:131], a[48:51], v[80:83]
v_mfma_f32_16x16x32_bf16 v[80:83], a[132:135], a[52:55], v[80:83]
buffer_load_dwordx4 v19, s[12:15], s27 offen offset:3072 lds
v_mfma_f32_16x16x32_bf16 v[88:91], a[128:131], a[56:59], v[88:91]
s_add_u32 s27, s27, 524288
ds_read_b128 a[72:75], v2 offset:34816
v_mfma_f32_16x16x32_bf16 v[88:91], a[132:135], a[60:63], v[88:91]
s_waitcnt lgkmcnt(3)
v_mfma_f32_16x16x32_bf16 v[36:39], a[136:139], a[0:3], v[36:39]
s_add_u32 m0, s28, 0
ds_read_b64_tr_b16 a[128:129], v6 offset:0
v_mfma_f32_16x16x32_bf16 v[36:39], a[140:143], a[4:7], v[36:39]
buffer_load_dwordx4 v12, s[8:11], s24 offen offset:0 lds
v_mfma_f32_16x16x32_bf16 v[44:47], a[136:139], a[8:11], v[44:47]
ds_read_b64_tr_b16 a[130:131], v6 offset:2048
v_mfma_f32_16x16x32_bf16 v[44:47], a[140:143], a[12:15], v[44:47]
PAD_1:
s_cbranch_execz PAD_5
v_mfma_f32_16x16x32_bf16 v[52:55], a[136:139], a[16:19], v[52:55]
ds_read_b64_tr_b16 a[132:133], v6 offset:16384
v_mfma_f32_16x16x32_bf16 v[52:55], a[140:143], a[20:23], v[52:55]
buffer_load_dwordx4 v13, s[8:11], s24 offen offset:1024 lds
v_mfma_f32_16x16x32_bf16 v[60:63], a[136:139], a[24:27], v[60:63]
ds_read_b64_tr_b16 a[134:135], v6 offset:18432
v_mfma_f32_16x16x32_bf16 v[60:63], a[140:143], a[28:31], v[60:63]
v_mfma_f32_16x16x32_bf16 v[68:71], a[136:139], a[32:35], v[68:71]
ds_read_b128 a[76:79], v3 offset:34816
v_mfma_f32_16x16x32_bf16 v[68:71], a[140:143], a[36:39], v[68:71]
buffer_load_dwordx4 v14, s[8:11], s24 offen offset:2048 lds
v_mfma_f32_16x16x32_bf16 v[76:79], a[136:139], a[40:43], v[76:79]
v_mfma_f32_16x16x32_bf16 v[76:79], a[140:143], a[44:47], v[76:79]
v_mfma_f32_16x16x32_bf16 v[84:87], a[136:139], a[48:51], v[84:87]
ds_read_b128 a[80:83], v2 offset:36864
v_mfma_f32_16x16x32_bf16 v[84:87], a[140:143], a[52:55], v[84:87]
buffer_load_dwordx4 v15, s[8:11], s24 offen offset:3072 lds
v_mfma_f32_16x16x32_bf16 v[92:95], a[136:139], a[56:59], v[92:95]
s_add_u32 s24, s24, 128
ds_read_b128 a[84:87], v3 offset:36864
v_mfma_f32_16x16x32_bf16 v[92:95], a[140:143], a[60:63], v[92:95]
s_waitcnt lgkmcnt(3)
v_mfma_f32_16x16x32_bf16 v[96:99], a[128:131], a[0:3], v[96:99]
s_add_u32 m0, s28, 4096
ds_read_b64_tr_b16 a[136:137], v7 offset:0
v_mfma_f32_16x16x32_bf16 v[96:99], a[132:135], a[4:7], v[96:99]
buffer_load_dwordx4 v12, s[8:11], s25 offen offset:0 lds
v_mfma_f32_16x16x32_bf16 v[104:107], a[128:131], a[8:11], v[104:107]
ds_read_b64_tr_b16 a[138:139], v7 offset:2048
v_mfma_f32_16x16x32_bf16 v[104:107], a[132:135], a[12:15], v[104:107]
v_mfma_f32_16x16x32_bf16 v[112:115], a[128:131], a[16:19], v[112:115]
ds_read_b64_tr_b16 a[140:141], v7 offset:16384
v_mfma_f32_16x16x32_bf16 v[112:115], a[132:135], a[20:23], v[112:115]
buffer_load_dwordx4 v13, s[8:11], s25 offen offset:1024 lds
v_mfma_f32_16x16x32_bf16 v[120:123], a[128:131], a[24:27], v[120:123]
ds_read_b64_tr_b16 a[142:143], v7 offset:18432
v_mfma_f32_16x16x32_bf16 v[120:123], a[132:135], a[28:31], v[120:123]
v_mfma_f32_16x16x32_bf16 v[128:131], a[128:131], a[32:35], v[128:131]
v_mfma_f32_16x16x32_bf16 v[128:131], a[132:135], a[36:39], v[128:131]
buffer_load_dwordx4 v14, s[8:11], s25 offen offset:2048 lds
v_mfma_f32_16x16x32_bf16 v[136:139], a[128:131], a[40:43], v[136:139]
ds_read_b128 a[88:91], v2 offset:38912
v_mfma_f32_16x16x32_bf16 v[136:139], a[132:135], a[44:47], v[136:139]
v_mfma_f32_16x16x32_bf16 v[144:147], a[128:131], a[48:51], v[144:147]
ds_read_b128 a[92:95], v3 offset:38912
v_mfma_f32_16x16x32_bf16 v[144:147], a[132:135], a[52:55], v[144:147]
buffer_load_dwordx4 v15, s[8:11], s25 offen offset:3072 lds
v_mfma_f32_16x16x32_bf16 v[152:155], a[128:131], a[56:59], v[152:155]
s_add_u32 s25, s25, 128
v_mfma_f32_16x16x32_bf16 v[152:155], a[132:135], a[60:63], v[152:155]
s_waitcnt lgkmcnt(2)
v_mfma_f32_16x16x32_bf16 v[100:103], a[136:139], a[0:3], v[100:103]
ds_read_b64_tr_b16 a[128:129], v8 offset:0
v_mfma_f32_16x16x32_bf16 v[100:103], a[140:143], a[4:7], v[100:103]
buffer_load_dword v21, v20, s[16:19], s43 offen
v_mfma_f32_16x16x32_bf16 v[108:111], a[136:139], a[8:11], v[108:111]
s_add_u32 s43, s43, s47
ds_read_b64_tr_b16 a[130:131], v8 offset:2048
v_mfma_f32_16x16x32_bf16 v[108:111], a[140:143], a[12:15], v[108:111]
s_cmp_ge_u32 s43, s51
v_mfma_f32_16x16x32_bf16 v[116:119], a[136:139], a[16:19], v[116:119]
s_cselect_b32 s43, 0, s43
ds_read_b64_tr_b16 a[132:133], v8 offset:16384
v_mfma_f32_16x16x32_bf16 v[116:119], a[140:143], a[20:23], v[116:119]
s_cselect_b32 s51, s42, s51
v_mfma_f32_16x16x32_bf16 v[124:127], a[136:139], a[24:27], v[124:127]
s_cselect_b64 s[16:17], s[40:41], s[16:17]
ds_read_b64_tr_b16 a[134:135], v8 offset:18432
v_mfma_f32_16x16x32_bf16 v[124:127], a[140:143], a[28:31], v[124:127]
s_cselect_b32 s18, s42, s18
v_mfma_f32_16x16x32_bf16 v[132:135], a[136:139], a[32:35], v[132:135]
s_cselect_b64 s[40:41], s[44:45], s[40:41]
ds_read_b128 a[96:99], v2 offset:40960
v_mfma_f32_16x16x32_bf16 v[132:135], a[140:143], a[36:39], v[132:135]
s_cselect_b32 s42, s46, s42
v_mfma_f32_16x16x32_bf16 v[140:143], a[136:139], a[40:43], v[140:143]
s_cselect_b32 s46, 0, s46
v_mfma_f32_16x16x32_bf16 v[140:143], a[140:143], a[44:47], v[140:143]
s_cmp_eq_u32 s30, s55
v_mfma_f32_16x16x32_bf16 v[148:151], a[136:139], a[48:51], v[148:151]
s_cselect_b32 s22, 0, 3221225472
ds_read_b128 a[100:103], v3 offset:40960
v_mfma_f32_16x16x32_bf16 v[148:151], a[140:143], a[52:55], v[148:151]
s_sub_u32 s30, s30, 1
buffer_atomic_add v27, v26, s[60:63], s22 offen sc1
v_mfma_f32_16x16x32_bf16 v[156:159], a[136:139], a[56:59], v[156:159]
ds_read_b128 a[104:107], v2 offset:43008
v_mfma_f32_16x16x32_bf16 v[156:159], a[140:143], a[60:63], v[156:159]
s_waitcnt lgkmcnt(3)
v_mfma_f32_16x16x32_bf16 v[160:163], a[128:131], a[0:3], v[160:163]
ds_read_b64_tr_b16 a[136:137], v9 offset:0
v_mfma_f32_16x16x32_bf16 v[160:163], a[132:135], a[4:7], v[160:163]
v_mfma_f32_16x16x32_bf16 v[168:171], a[128:131], a[8:11], v[168:171]
ds_read_b64_tr_b16 a[138:139], v9 offset:2048
v_mfma_f32_16x16x32_bf16 v[168:171], a[132:135], a[12:15], v[168:171]
v_mfma_f32_16x16x32_bf16 v[176:179], a[128:131], a[16:19], v[176:179]
ds_read_b64_tr_b16 a[140:141], v9 offset:16384
v_mfma_f32_16x16x32_bf16 v[176:179], a[132:135], a[20:23], v[176:179]
v_mfma_f32_16x16x32_bf16 v[184:187], a[128:131], a[24:27], v[184:187]
ds_read_b64_tr_b16 a[142:143], v9 offset:18432
v_mfma_f32_16x16x32_bf16 v[184:187], a[132:135], a[28:31], v[184:187]
v_mfma_f32_16x16x32_bf16 v[192:195], a[128:131], a[32:35], v[192:195]
v_mfma_f32_16x16x32_bf16 v[192:195], a[132:135], a[36:39], v[192:195]
v_mfma_f32_16x16x32_bf16 v[200:203], a[128:131], a[40:43], v[200:203]
ds_read_b128 a[108:111], v3 offset:43008
v_mfma_f32_16x16x32_bf16 v[200:203], a[132:135], a[44:47], v[200:203]
v_mfma_f32_16x16x32_bf16 v[208:211], a[128:131], a[48:51], v[208:211]
ds_read_b128 a[112:115], v2 offset:45056
v_mfma_f32_16x16x32_bf16 v[208:211], a[132:135], a[52:55], v[208:211]
v_mfma_f32_16x16x32_bf16 v[216:219], a[128:131], a[56:59], v[216:219]
v_mfma_f32_16x16x32_bf16 v[216:219], a[132:135], a[60:63], v[216:219]
s_waitcnt lgkmcnt(2)
v_mfma_f32_16x16x32_bf16 v[164:167], a[136:139], a[0:3], v[164:167]
ds_read_b64_tr_b16 a[128:129], v10 offset:0
v_mfma_f32_16x16x32_bf16 v[164:167], a[140:143], a[4:7], v[164:167]
v_mfma_f32_16x16x32_bf16 v[172:175], a[136:139], a[8:11], v[172:175]
ds_read_b64_tr_b16 a[130:131], v10 offset:2048
v_mfma_f32_16x16x32_bf16 v[172:175], a[140:143], a[12:15], v[172:175]
v_mfma_f32_16x16x32_bf16 v[180:183], a[136:139], a[16:19], v[180:183]
ds_read_b64_tr_b16 a[132:133], v10 offset:16384
v_mfma_f32_16x16x32_bf16 v[180:183], a[140:143], a[20:23], v[180:183]
v_mfma_f32_16x16x32_bf16 v[188:191], a[136:139], a[24:27], v[188:191]
ds_read_b64_tr_b16 a[134:135], v10 offset:18432
v_mfma_f32_16x16x32_bf16 v[188:191], a[140:143], a[28:31], v[188:191]
v_mfma_f32_16x16x32_bf16 v[196:199], a[136:139], a[32:35], v[196:199]
ds_read_b128 a[116:119], v3 offset:45056
v_mfma_f32_16x16x32_bf16 v[196:199], a[140:143], a[36:39], v[196:199]
v_mfma_f32_16x16x32_bf16 v[204:207], a[136:139], a[40:43], v[204:207]
ds_read_b128 a[120:123], v2 offset:47104
v_mfma_f32_16x16x32_bf16 v[204:207], a[140:143], a[44:47], v[204:207]
v_mfma_f32_16x16x32_bf16 v[212:215], a[136:139], a[48:51], v[212:215]
v_mfma_f32_16x16x32_bf16 v[212:215], a[140:143], a[52:55], v[212:215]
v_mfma_f32_16x16x32_bf16 v[220:223], a[136:139], a[56:59], v[220:223]
ds_read_b128 a[124:127], v3 offset:47104
v_mfma_f32_16x16x32_bf16 v[220:223], a[140:143], a[60:63], v[220:223]
s_waitcnt lgkmcnt(3)
v_mfma_f32_16x16x32_bf16 a[192:195], a[128:131], a[0:3], a[192:195]
ds_read_b64_tr_b16 a[136:137], v11 offset:0
v_mfma_f32_16x16x32_bf16 a[192:195], a[132:135], a[4:7], a[192:195]
v_mfma_f32_16x16x32_bf16 a[200:203], a[128:131], a[8:11], a[200:203]
ds_read_b64_tr_b16 a[138:139], v11 offset:2048
v_mfma_f32_16x16x32_bf16 a[200:203], a[132:135], a[12:15], a[200:203]
v_mfma_f32_16x16x32_bf16 a[208:211], a[128:131], a[16:19], a[208:211]
ds_read_b64_tr_b16 a[140:141], v11 offset:16384
v_mfma_f32_16x16x32_bf16 a[208:211], a[132:135], a[20:23], a[208:211]
v_mfma_f32_16x16x32_bf16 a[216:219], a[128:131], a[24:27], a[216:219]
ds_read_b64_tr_b16 a[142:143], v11 offset:18432
v_mfma_f32_16x16x32_bf16 a[216:219], a[132:135], a[28:31], a[216:219]
v_mfma_f32_16x16x32_bf16 a[224:227], a[128:131], a[32:35], a[224:227]
v_mfma_f32_16x16x32_bf16 a[224:227], a[132:135], a[36:39], a[224:227]
v_mfma_f32_16x16x32_bf16 a[232:235], a[128:131], a[40:43], a[232:235]
v_mfma_f32_16x16x32_bf16 a[232:235], a[132:135], a[44:47], a[232:235]
v_mfma_f32_16x16x32_bf16 a[240:243], a[128:131], a[48:51], a[240:243]
v_mfma_f32_16x16x32_bf16 a[240:243], a[132:135], a[52:55], a[240:243]
v_mfma_f32_16x16x32_bf16 a[248:251], a[128:131], a[56:59], a[248:251]
s_waitcnt vmcnt(2) lgkmcnt(0)
v_mfma_f32_16x16x32_bf16 a[248:251], a[132:135], a[60:63], a[248:251]
s_barrier
v_mfma_f32_16x16x32_bf16 a[196:199], a[136:139], a[0:3], a[196:199]
s_add_u32 m0, s29, 65536
ds_read_b64_tr_b16 a[128:129], v4 offset:32768
v_mfma_f32_16x16x32_bf16 a[196:199], a[140:143], a[4:7], a[196:199]
buffer_load_dwordx4 v16, s[12:15], s26 offen offset:0 lds
v_mfma_f32_16x16x32_bf16 a[204:207], a[136:139], a[8:11], a[204:207]
ds_read_b64_tr_b16 a[130:131], v4 offset:34816
v_mfma_f32_16x16x32_bf16 a[204:207], a[140:143], a[12:15], a[204:207]
v_mfma_f32_16x16x32_bf16 a[212:215], a[136:139], a[16:19], a[212:215]
ds_read_b64_tr_b16 a[132:133], v4 offset:49152
v_mfma_f32_16x16x32_bf16 a[212:215], a[140:143], a[20:23], a[212:215]
buffer_load_dwordx4 v17, s[12:15], s26 offen offset:1024 lds
v_mfma_f32_16x16x32_bf16 a[220:223], a[136:139], a[24:27], a[220:223]
ds_read_b64_tr_b16 a[134:135], v4 offset:51200
v_mfma_f32_16x16x32_bf16 a[220:223], a[140:143], a[28:31], a[220:223]
v_mfma_f32_16x16x32_bf16 a[228:231], a[136:139], a[32:35], a[228:231]
v_mfma_f32_16x16x32_bf16 a[228:231], a[140:143], a[36:39], a[228:231]
buffer_load_dwordx4 v18, s[12:15], s26 offen offset:2048 lds
v_mfma_f32_16x16x32_bf16 a[236:239], a[136:139], a[40:43], a[236:239]
v_mfma_f32_16x16x32_bf16 a[236:239], a[140:143], a[44:47], a[236:239]
v_mfma_f32_16x16x32_bf16 a[244:247], a[136:139], a[48:51], a[244:247]
v_mfma_f32_16x16x32_bf16 a[244:247], a[140:143], a[52:55], a[244:247]
s_waitcnt lgkmcnt(0)
buffer_load_dwordx4 v19, s[12:15], s26 offen offset:3072 lds
v_mfma_f32_16x16x32_bf16 a[252:255], a[136:139], a[56:59], a[252:255]
s_add_u32 s26, s26, 524288
s_bitcmp1_b32 s30, 1
v_mfma_f32_16x16x32_bf16 a[252:255], a[140:143], a[60:63], a[252:255]
s_cbranch_scc1 Lg_1
s_cmp_eq_u32 s30, 0
s_cbranch_scc1 Lg_1t
v_mfma_f32_16x16x32_bf16 v[32:35], a[128:131], a[64:67], v[32:35]
s_add_u32 m0, s29, 81920
ds_read_b64_tr_b16 a[136:137], v5 offset:32768
v_mfma_f32_16x16x32_bf16 v[32:35], a[132:135], a[68:71], v[32:35]
buffer_load_dwordx4 v16, s[12:15], s27 offen offset:0 lds
v_mfma_f32_16x16x32_bf16 v[40:43], a[128:131], a[72:75], v[40:43]
s_lshl_b32 s22, s38, 3
ds_read_b64_tr_b16 a[138:139], v5 offset:34816
v_mfma_f32_16x16x32_bf16 v[40:43], a[132:135], a[76:79], v[40:43]
s_lshl_b32 s23, s39, 5
v_and_b32 v252, 31, v0
v_lshrrev_b32 v253, 5, v0
v_mfma_f32_16x16x32_bf16 v[48:51], a[128:131], a[80:83], v[48:51]
ds_read_b64_tr_b16 a[140:141], v5 offset:49152
v_add_u32 v253, s22, v253
v_mfma_f32_16x16x32_bf16 v[48:51], a[132:135], a[84:87], v[48:51]
buffer_load_dwordx4 v17, s[12:15], s27 offen offset:1024 lds
v_mfma_f32_16x16x32_bf16 v[56:59], a[128:131], a[88:91], v[56:59]
ds_read_b64_tr_b16 a[142:143], v5 offset:51200
v_add_u32 v252, s23, v252
v_mfma_f32_16x16x32_bf16 v[56:59], a[132:135], a[92:95], v[56:59]
v_mul_u32_u24 v254, 7168, v253
v_lshl_add_u32 v254, v252, 2, v254
v_mfma_f32_16x16x32_bf16 v[64:67], a[128:131], a[96:99], v[64:67]
ds_read_b128 a[0:3], v2 offset:0
v_lshlrev_b32 v252, 4, v252
v_mfma_f32_16x16x32_bf16 v[64:67], a[132:135], a[100:103], v[64:67]
buffer_load_dwordx4 v18, s[12:15], s27 offen offset:2048 lds
v_mfma_f32_16x16x32_bf16 v[72:75], a[128:131], a[104:107], v[72:75]
ds_read_b128 a[4:7], v3 offset:0
v_add_u32 v255, 3584, v254
v_mfma_f32_16x16x32_bf16 v[72:75], a[132:135], a[108:111], v[72:75]
v_subrev_u32 v22, 3584, v254
v_subrev_u32 v23, 2688, v254
v_mfma_f32_16x16x32_bf16 v[80:83], a[128:131], a[112:115], v[80:83]
v_subrev_u32 v24, 1792, v254
v_subrev_u32 v25, 896, v254
v_mfma_f32_16x16x32_bf16 v[80:83], a[132:135], a[116:119], v[80:83]
buffer_load_dwordx4 v19, s[12:15], s27 offen offset:3072 lds
v_mfma_f32_16x16x32_bf16 v[88:91], a[128:131], a[120:123], v[88:91]
s_add_u32 s27, s27, 524288
ds_read_b128 a[8:11], v2 offset:2048
v_mfma_f32_16x16x32_bf16 v[88:91], a[132:135], a[124:127], v[88:91]
s_waitcnt lgkmcnt(3)
v_mfma_f32_16x16x32_bf16 v[36:39], a[136:139], a[64:67], v[36:39]
s_add_u32 m0, s28, 32768
ds_read_b64_tr_b16 a[128:129], v6 offset:32768
v_mfma_f32_16x16x32_bf16 v[36:39], a[140:143], a[68:71], v[36:39]
buffer_load_dwordx4 v12, s[8:11], s24 offen offset:0 lds
v_mfma_f32_16x16x32_bf16 v[44:47], a[136:139], a[72:75], v[44:47]
ds_read_b64_tr_b16 a[130:131], v6 offset:34816
v_mfma_f32_16x16x32_bf16 v[44:47], a[140:143], a[76:79], v[44:47]
v_mfma_f32_16x16x32_bf16 v[52:55], a[136:139], a[80:83], v[52:55]
ds_read_b64_tr_b16 a[132:133], v6 offset:49152
v_mfma_f32_16x16x32_bf16 v[52:55], a[140:143], a[84:87], v[52:55]
buffer_load_dwordx4 v13, s[8:11], s24 offen offset:1024 lds
v_mfma_f32_16x16x32_bf16 v[60:63], a[136:139], a[88:91], v[60:63]
ds_read_b64_tr_b16 a[134:135], v6 offset:51200
v_mfma_f32_16x16x32_bf16 v[60:63], a[140:143], a[92:95], v[60:63]
v_mfma_f32_16x16x32_bf16 v[68:71], a[136:139], a[96:99], v[68:71]
ds_read_b128 a[12:15], v3 offset:2048
v_mfma_f32_16x16x32_bf16 v[68:71], a[140:143], a[100:103], v[68:71]
buffer_load_dwordx4 v14, s[8:11], s24 offen offset:2048 lds
v_mfma_f32_16x16x32_bf16 v[76:79], a[136:139], a[104:107], v[76:79]
v_mfma_f32_16x16x32_bf16 v[76:79], a[140:143], a[108:111], v[76:79]
v_mfma_f32_16x16x32_bf16 v[84:87], a[136:139], a[112:115], v[84:87]
ds_read_b128 a[16:19], v2 offset:4096
v_mfma_f32_16x16x32_bf16 v[84:87], a[140:143], a[116:119], v[84:87]
buffer_load_dwordx4 v15, s[8:11], s24 offen offset:3072 lds
v_mfma_f32_16x16x32_bf16 v[92:95], a[136:139], a[120:123], v[92:95]
s_add_u32 s24, s24, 128
ds_read_b128 a[20:23], v3 offset:4096
v_mfma_f32_16x16x32_bf16 v[92:95], a[140:143], a[124:127], v[92:95]
s_waitcnt lgkmcnt(3)
v_mfma_f32_16x16x32_bf16 v[96:99], a[128:131], a[64:67], v[96:99]
s_add_u32 m0, s28, 36864
ds_read_b64_tr_b16 a[136:137], v7 offset:32768
v_mfma_f32_16x16x32_bf16 v[96:99], a[132:135], a[68:71], v[96:99]
buffer_load_dwordx4 v12, s[8:11], s25 offen offset:0 lds
v_mfma_f32_16x16x32_bf16 v[104:107], a[128:131], a[72:75], v[104:107]
ds_read_b64_tr_b16 a[138:139], v7 offset:34816
v_mfma_f32_16x16x32_bf16 v[104:107], a[132:135], a[76:79], v[104:107]
v_mfma_f32_16x16x32_bf16 v[112:115], a[128:131], a[80:83], v[112:115]
ds_read_b64_tr_b16 a[140:141], v7 offset:49152
v_mfma_f32_16x16x32_bf16 v[112:115], a[132:135], a[84:87], v[112:115]
buffer_load_dwordx4 v13, s[8:11], s25 offen offset:1024 lds
v_mfma_f32_16x16x32_bf16 v[120:123], a[128:131], a[88:91], v[120:123]
ds_read_b64_tr_b16 a[142:143], v7 offset:51200
v_mfma_f32_16x16x32_bf16 v[120:123], a[132:135], a[92:95], v[120:123]
v_mfma_f32_16x16x32_bf16 v[128:131], a[128:131], a[96:99], v[128:131]
v_mfma_f32_16x16x32_bf16 v[128:131], a[132:135], a[100:103], v[128:131]
buffer_load_dwordx4 v14, s[8:11], s25 offen offset:2048 lds
v_mfma_f32_16x16x32_bf16 v[136:139], a[128:131], a[104:107], v[136:139]
ds_read_b128 a[24:27], v2 offset:6144
v_mfma_f32_16x16x32_bf16 v[136:139], a[132:135], a[108:111], v[136:139]
v_mfma_f32_16x16x32_bf16 v[144:147], a[128:131], a[112:115], v[144:147]
ds_read_b128 a[28:31], v3 offset:6144
v_mfma_f32_16x16x32_bf16 v[144:147], a[132:135], a[116:119], v[144:147]
buffer_load_dwordx4 v15, s[8:11], s25 offen offset:3072 lds
v_mfma_f32_16x16x32_bf16 v[152:155], a[128:131], a[120:123], v[152:155]
s_add_u32 s25, s25, 128
v_mfma_f32_16x16x32_bf16 v[152:155], a[132:135], a[124:127], v[152:155]
s_waitcnt lgkmcnt(2)
v_mfma_f32_16x16x32_bf16 v[100:103], a[136:139], a[64:67], v[100:103]
s_mov_b64 s[56:57], s[70:71]
s_mov_b32 s58, 3584
s_mov_b32 s59, 0x20000
ds_read_b64_tr_b16 a[128:129], v8 offset:32768
buffer_load_dwordx4 v[248:251], v252, s[56:59], 0 offen
v_mfma_f32_16x16x32_bf16 v[100:103], a[140:143], a[68:71], v[100:103]
s_mov_b64 s[56:57], s[66:67]
s_mov_b32 s58, 1835008
buffer_load_dword v224, v22, s[56:59], 0 offen nt
v_mfma_f32_16x16x32_bf16 v[108:111], a[136:139], a[72:75], v[108:111]
ds_read_b64_tr_b16 a[130:131], v8 offset:34816
buffer_load_dword v225, v23, s[56:59], 0 offen nt
v_mfma_f32_16x16x32_bf16 v[108:111], a[140:143], a[76:79], v[108:111]
buffer_load_dword v226, v24, s[56:59], 0 offen nt
v_mfma_f32_16x16x32_bf16 v[116:119], a[136:139], a[80:83], v[116:119]
ds_read_b64_tr_b16 a[132:133], v8 offset:49152
buffer_load_dword v227, v25, s[56:59], 0 offen nt
v_mfma_f32_16x16x32_bf16 v[116:119], a[140:143], a[84:87], v[116:119]
buffer_load_dword v228, v254, s[56:59], 0 offen offset:0 nt
v_mfma_f32_16x16x32_bf16 v[124:127], a[136:139], a[88:91], v[124:127]
ds_read_b64_tr_b16 a[134:135], v8 offset:51200
buffer_load_dword v229, v254, s[56:59], 0 offen offset:896 nt
v_mfma_f32_16x16x32_bf16 v[124:127], a[140:143], a[92:95], v[124:127]
buffer_load_dword v230, v254, s[56:59], 0 offen offset:1792 nt
v_mfma_f32_16x16x32_bf16 v[132:135], a[136:139], a[96:99], v[132:135]
ds_read_b128 a[32:35], v2 offset:8192
buffer_load_dword v231, v254, s[56:59], 0 offen offset:2688 nt
v_mfma_f32_16x16x32_bf16 v[132:135], a[140:143], a[100:103], v[132:135]
buffer_load_dword v232, v255, s[56:59], 0 offen offset:0 nt
v_mfma_f32_16x16x32_bf16 v[140:143], a[136:139], a[104:107], v[140:143]
buffer_load_dword v233, v255, s[56:59], 0 offen offset:896 nt
v_mfma_f32_16x16x32_bf16 v[140:143], a[140:143], a[108:111], v[140:143]
buffer_load_dword v234, v255, s[56:59], 0 offen offset:1792 nt
v_mfma_f32_16x16x32_bf16 v[148:151], a[136:139], a[112:115], v[148:151]
ds_read_b128 a[36:39], v3 offset:8192
buffer_load_dword v235, v255, s[56:59], 0 offen offset:2688 nt
v_mfma_f32_16x16x32_bf16 v[148:151], a[140:143], a[116:119], v[148:151]
s_mov_b64 s[56:57], s[68:69]
buffer_load_dword v236, v25, s[56:59], 0 offen nt
v_mfma_f32_16x16x32_bf16 v[156:159], a[136:139], a[120:123], v[156:159]
ds_read_b128 a[40:43], v2 offset:10240
buffer_load_dword v237, v254, s[56:59], 0 offen offset:0 nt
v_mfma_f32_16x16x32_bf16 v[156:159], a[140:143], a[124:127], v[156:159]
s_waitcnt lgkmcnt(3)
buffer_load_dword v238, v254, s[56:59], 0 offen offset:896 nt
v_mfma_f32_16x16x32_bf16 v[160:163], a[128:131], a[64:67], v[160:163]
ds_read_b64_tr_b16 a[136:137], v9 offset:32768
buffer_load_dword v239, v254, s[56:59], 0 offen offset:1792 nt
v_mfma_f32_16x16x32_bf16 v[160:163], a[132:135], a[68:71], v[160:163]
buffer_load_dword v240, v254, s[56:59], 0 offen offset:2688 nt
v_mfma_f32_16x16x32_bf16 v[168:171], a[128:131], a[72:75], v[168:171]
ds_read_b64_tr_b16 a[138:139], v9 offset:34816
buffer_load_dword v241, v255, s[56:59], 0 offen offset:0 nt
v_mfma_f32_16x16x32_bf16 v[168:171], a[132:135], a[76:79], v[168:171]
buffer_load_dword v242, v255, s[56:59], 0 offen offset:896 nt
v_mfma_f32_16x16x32_bf16 v[176:179], a[128:131], a[80:83], v[176:179]
ds_read_b64_tr_b16 a[140:141], v9 offset:49152
buffer_load_dword v243, v255, s[56:59], 0 offen offset:1792 nt
v_mfma_f32_16x16x32_bf16 v[176:179], a[132:135], a[84:87], v[176:179]
buffer_load_dword v244, v255, s[56:59], 0 offen offset:2688 nt
v_mfma_f32_16x16x32_bf16 v[184:187], a[128:131], a[88:91], v[184:187]
ds_read_b64_tr_b16 a[142:143], v9 offset:51200
v_mfma_f32_16x16x32_bf16 v[184:187], a[132:135], a[92:95], v[184:187]
v_mfma_f32_16x16x32_bf16 v[192:195], a[128:131], a[96:99], v[192:195]
v_mfma_f32_16x16x32_bf16 v[192:195], a[132:135], a[100:103], v[192:195]
v_mfma_f32_16x16x32_bf16 v[200:203], a[128:131], a[104:107], v[200:203]
ds_read_b128 a[44:47], v3 offset:10240
v_mfma_f32_16x16x32_bf16 v[200:203], a[132:135], a[108:111], v[200:203]
v_mfma_f32_16x16x32_bf16 v[208:211], a[128:131], a[112:115], v[208:211]
ds_read_b128 a[48:51], v2 offset:12288
v_mfma_f32_16x16x32_bf16 v[208:211], a[132:135], a[116:119], v[208:211]
v_mfma_f32_16x16x32_bf16 v[216:219], a[128:131], a[120:123], v[216:219]
v_mfma_f32_16x16x32_bf16 v[216:219], a[132:135], a[124:127], v[216:219]
s_waitcnt lgkmcnt(2)
v_mfma_f32_16x16x32_bf16 v[164:167], a[136:139], a[64:67], v[164:167]
ds_read_b64_tr_b16 a[128:129], v10 offset:32768
v_mfma_f32_16x16x32_bf16 v[164:167], a[140:143], a[68:71], v[164:167]
v_mfma_f32_16x16x32_bf16 v[172:175], a[136:139], a[72:75], v[172:175]
ds_read_b64_tr_b16 a[130:131], v10 offset:34816
v_mfma_f32_16x16x32_bf16 v[172:175], a[140:143], a[76:79], v[172:175]
v_mfma_f32_16x16x32_bf16 v[180:183], a[136:139], a[80:83], v[180:183]
ds_read_b64_tr_b16 a[132:133], v10 offset:49152
v_mfma_f32_16x16x32_bf16 v[180:183], a[140:143], a[84:87], v[180:183]
v_mfma_f32_16x16x32_bf16 v[188:191], a[136:139], a[88:91], v[188:191]
ds_read_b64_tr_b16 a[134:135], v10 offset:51200
v_mfma_f32_16x16x32_bf16 v[188:191], a[140:143], a[92:95], v[188:191]
v_mfma_f32_16x16x32_bf16 v[196:199], a[136:139], a[96:99], v[196:199]
ds_read_b128 a[52:55], v3 offset:12288
v_mfma_f32_16x16x32_bf16 v[196:199], a[140:143], a[100:103], v[196:199]
v_mfma_f32_16x16x32_bf16 v[204:207], a[136:139], a[104:107], v[204:207]
ds_read_b128 a[56:59], v2 offset:14336
v_mfma_f32_16x16x32_bf16 v[204:207], a[140:143], a[108:111], v[204:207]
v_mfma_f32_16x16x32_bf16 v[212:215], a[136:139], a[112:115], v[212:215]
v_mfma_f32_16x16x32_bf16 v[212:215], a[140:143], a[116:119], v[212:215]
v_mfma_f32_16x16x32_bf16 v[220:223], a[136:139], a[120:123], v[220:223]
ds_read_b128 a[60:63], v3 offset:14336
v_mfma_f32_16x16x32_bf16 v[220:223], a[140:143], a[124:127], v[220:223]
s_waitcnt lgkmcnt(3)
v_mfma_f32_16x16x32_bf16 a[192:195], a[128:131], a[64:67], a[192:195]
ds_read_b64_tr_b16 a[136:137], v11 offset:32768
v_mfma_f32_16x16x32_bf16 a[192:195], a[132:135], a[68:71], a[192:195]
v_mfma_f32_16x16x32_bf16 a[200:203], a[128:131], a[72:75], a[200:203]
ds_read_b64_tr_b16 a[138:139], v11 offset:34816
v_mfma_f32_16x16x32_bf16 a[200:203], a[132:135], a[76:79], a[200:203]
v_mfma_f32_16x16x32_bf16 a[208:211], a[128:131], a[80:83], a[208:211]
ds_read_b64_tr_b16 a[140:141], v11 offset:49152
v_mfma_f32_16x16x32_bf16 a[208:211], a[132:135], a[84:87], a[208:211]
v_mfma_f32_16x16x32_bf16 a[216:219], a[128:131], a[88:91], a[216:219]
ds_read_b64_tr_b16 a[142:143], v11 offset:51200
v_mfma_f32_16x16x32_bf16 a[216:219], a[132:135], a[92:95], a[216:219]
v_mfma_f32_16x16x32_bf16 a[224:227], a[128:131], a[96:99], a[224:227]
v_mfma_f32_16x16x32_bf16 a[224:227], a[132:135], a[100:103], a[224:227]
v_mfma_f32_16x16x32_bf16 a[232:235], a[128:131], a[104:107], a[232:235]
v_mfma_f32_16x16x32_bf16 a[232:235], a[132:135], a[108:111], a[232:235]
v_mfma_f32_16x16x32_bf16 a[240:243], a[128:131], a[112:115], a[240:243]
v_mfma_f32_16x16x32_bf16 a[240:243], a[132:135], a[116:119], a[240:243]
v_mfma_f32_16x16x32_bf16 a[248:251], a[128:131], a[120:123], a[248:251]
s_waitcnt vmcnt(22) lgkmcnt(0)
v_mfma_f32_16x16x32_bf16 a[248:251], a[132:135], a[124:127], a[248:251]
s_barrier
v_mfma_f32_16x16x32_bf16 a[196:199], a[136:139], a[64:67], a[196:199]
s_add_u32 m0, s29, 98304
ds_read_b64_tr_b16 a[128:129], v4 offset:0
v_mfma_f32_16x16x32_bf16 a[196:199], a[140:143], a[68:71], a[196:199]
buffer_load_dwordx4 v16, s[12:15], s26 offen offset:0 lds
v_mfma_f32_16x16x32_bf16 a[204:207], a[136:139], a[72:75], a[204:207]
ds_read_b64_tr_b16 a[130:131], v4 offset:2048
v_mfma_f32_16x16x32_bf16 a[204:207], a[140:143], a[76:79], a[204:207]
v_mfma_f32_16x16x32_bf16 a[212:215], a[136:139], a[80:83], a[212:215]
ds_read_b64_tr_b16 a[132:133], v4 offset:16384
v_mfma_f32_16x16x32_bf16 a[212:215], a[140:143], a[84:87], a[212:215]
buffer_load_dwordx4 v17, s[12:15], s26 offen offset:1024 lds
v_mfma_f32_16x16x32_bf16 a[220:223], a[136:139], a[88:91], a[220:223]
ds_read_b64_tr_b16 a[134:135], v4 offset:18432
v_mfma_f32_16x16x32_bf16 a[220:223], a[140:143], a[92:95], a[220:223]
v_mfma_f32_16x16x32_bf16 a[228:231], a[136:139], a[96:99], a[228:231]
v_mfma_f32_16x16x32_bf16 a[228:231], a[140:143], a[100:103], a[228:231]
buffer_load_dwordx4 v18, s[12:15], s26 offen offset:2048 lds
v_mfma_f32_16x16x32_bf16 a[236:239], a[136:139], a[104:107], a[236:239]
v_mfma_f32_16x16x32_bf16 a[236:239], a[140:143], a[108:111], a[236:239]
v_mfma_f32_16x16x32_bf16 a[244:247], a[136:139], a[112:115], a[244:247]
v_mfma_f32_16x16x32_bf16 a[244:247], a[140:143], a[116:119], a[244:247]
buffer_load_dwordx4 v19, s[12:15], s26 offen offset:3072 lds
v_mfma_f32_16x16x32_bf16 a[252:255], a[136:139], a[120:123], a[252:255]
s_add_u32 s26, s26, 524288
v_mfma_f32_16x16x32_bf16 a[252:255], a[140:143], a[124:127], a[252:255]
s_waitcnt lgkmcnt(0)
v_mfma_f32_16x16x32_bf16 v[32:35], a[128:131], a[0:3], v[32:35]
s_add_u32 m0, s29, 114688
ds_read_b64_tr_b16 a[136:137], v5 offset:0
v_mfma_f32_16x16x32_bf16 v[32:35], a[132:135], a[4:7], v[32:35]
buffer_load_dwordx4 v16, s[12:15], s27 offen offset:0 lds
v_mfma_f32_16x16x32_bf16 v[40:43], a[128:131], a[8:11], v[40:43]
ds_read_b64_tr_b16 a[138:139], v5 offset:2048
v_mfma_f32_16x16x32_bf16 v[40:43], a[132:135], a[12:15], v[40:43]
v_mfma_f32_16x16x32_bf16 v[48:51], a[128:131], a[16:19], v[48:51]
ds_read_b64_tr_b16 a[140:141], v5 offset:16384
v_mfma_f32_16x16x32_bf16 v[48:51], a[132:135], a[20:23], v[48:51]
buffer_load_dwordx4 v17, s[12:15], s27 offen offset:1024 lds
v_mfma_f32_16x16x32_bf16 v[56:59], a[128:131], a[24:27], v[56:59]
ds_read_b64_tr_b16 a[142:143], v5 offset:18432
v_mfma_f32_16x16x32_bf16 v[56:59], a[132:135], a[28:31], v[56:59]
v_mfma_f32_16x16x32_bf16 v[64:67], a[128:131], a[32:35], v[64:67]
ds_read_b128 a[64:67], v2 offset:32768
v_mfma_f32_16x16x32_bf16 v[64:67], a[132:135], a[36:39], v[64:67]
buffer_load_dwordx4 v18, s[12:15], s27 offen offset:2048 lds
v_mfma_f32_16x16x32_bf16 v[72:75], a[128:131], a[40:43], v[72:75]
ds_read_b128 a[68:71], v3 offset:32768
v_mfma_f32_16x16x32_bf16 v[72:75], a[132:135], a[44:47], v[72:75]
v_mfma_f32_16x16x32_bf16 v[80:83], a[128:131], a[48:51], v[80:83]
v_mfma_f32_16x16x32_bf16 v[80:83], a[132:135], a[52:55], v[80:83]
buffer_load_dwordx4 v19, s[12:15], s27 offen offset:3072 lds
v_mfma_f32_16x16x32_bf16 v[88:91], a[128:131], a[56:59], v[88:91]
s_add_u32 s27, s27, 524288
ds_read_b128 a[72:75], v2 offset:34816
v_mfma_f32_16x16x32_bf16 v[88:91], a[132:135], a[60:63], v[88:91]
s_waitcnt lgkmcnt(3)
v_mfma_f32_16x16x32_bf16 v[36:39], a[136:139], a[0:3], v[36:39]
s_add_u32 m0, s28, 0
ds_read_b64_tr_b16 a[128:129], v6 offset:0
v_mfma_f32_16x16x32_bf16 v[36:39], a[140:143], a[4:7], v[36:39]
buffer_load_dwordx4 v12, s[8:11], s24 offen offset:0 lds
v_mfma_f32_16x16x32_bf16 v[44:47], a[136:139], a[8:11], v[44:47]
ds_read_b64_tr_b16 a[130:131], v6 offset:2048
v_mfma_f32_16x16x32_bf16 v[44:47], a[140:143], a[12:15], v[44:47]
v_mfma_f32_16x16x32_bf16 v[52:55], a[136:139], a[16:19], v[52:55]
ds_read_b64_tr_b16 a[132:133], v6 offset:16384
v_mfma_f32_16x16x32_bf16 v[52:55], a[140:143], a[20:23], v[52:55]
buffer_load_dwordx4 v13, s[8:11], s24 offen offset:1024 lds
v_mfma_f32_16x16x32_bf16 v[60:63], a[136:139], a[24:27], v[60:63]
ds_read_b64_tr_b16 a[134:135], v6 offset:18432
v_mfma_f32_16x16x32_bf16 v[60:63], a[140:143], a[28:31], v[60:63]
v_mfma_f32_16x16x32_bf16 v[68:71], a[136:139], a[32:35], v[68:71]
ds_read_b128 a[76:79], v3 offset:34816
v_mfma_f32_16x16x32_bf16 v[68:71], a[140:143], a[36:39], v[68:71]
buffer_load_dwordx4 v14, s[8:11], s24 offen offset:2048 lds
v_mfma_f32_16x16x32_bf16 v[76:79], a[136:139], a[40:43], v[76:79]
v_mfma_f32_16x16x32_bf16 v[76:79], a[140:143], a[44:47], v[76:79]
v_mfma_f32_16x16x32_bf16 v[84:87], a[136:139], a[48:51], v[84:87]
ds_read_b128 a[80:83], v2 offset:36864
v_mfma_f32_16x16x32_bf16 v[84:87], a[140:143], a[52:55], v[84:87]
buffer_load_dwordx4 v15, s[8:11], s24 offen offset:3072 lds
v_mfma_f32_16x16x32_bf16 v[92:95], a[136:139], a[56:59], v[92:95]
s_add_u32 s24, s24, 128
ds_read_b128 a[84:87], v3 offset:36864
v_mfma_f32_16x16x32_bf16 v[92:95], a[140:143], a[60:63], v[92:95]
s_waitcnt lgkmcnt(3)
v_mfma_f32_16x16x32_bf16 v[96:99], a[128:131], a[0:3], v[96:99]
s_add_u32 m0, s28, 4096
ds_read_b64_tr_b16 a[136:137], v7 offset:0
v_mfma_f32_16x16x32_bf16 v[96:99], a[132:135], a[4:7], v[96:99]
buffer_load_dwordx4 v12, s[8:11], s25 offen offset:0 lds
v_mfma_f32_16x16x32_bf16 v[104:107], a[128:131], a[8:11], v[104:107]
ds_read_b64_tr_b16 a[138:139], v7 offset:2048
v_mfma_f32_16x16x32_bf16 v[104:107], a[132:135], a[12:15], v[104:107]
v_mfma_f32_16x16x32_bf16 v[112:115], a[128:131], a[16:19], v[112:115]
ds_read_b64_tr_b16 a[140:141], v7 offset:16384
v_mfma_f32_16x16x32_bf16 v[112:115], a[132:135], a[20:23], v[112:115]
buffer_load_dwordx4 v13, s[8:11], s25 offen offset:1024 lds
v_mfma_f32_16x16x32_bf16 v[120:123], a[128:131], a[24:27], v[120:123]
ds_read_b64_tr_b16 a[142:143], v7 offset:18432
v_mfma_f32_16x16x32_bf16 v[120:123], a[132:135], a[28:31], v[120:123]
v_mfma_f32_16x16x32_bf16 v[128:131], a[128:131], a[32:35], v[128:131]
v_mfma_f32_16x16x32_bf16 v[128:131], a[132:135], a[36:39], v[128:131]
buffer_load_dwordx4 v14, s[8:11], s25 offen offset:2048 lds
v_mfma_f32_16x16x32_bf16 v[136:139], a[128:131], a[40:43], v[136:139]
ds_read_b128 a[88:91], v2 offset:38912
v_mfma_f32_16x16x32_bf16 v[136:139], a[132:135], a[44:47], v[136:139]
v_mfma_f32_16x16x32_bf16 v[144:147], a[128:131], a[48:51], v[144:147]
ds_read_b128 a[92:95], v3 offset:38912
v_mfma_f32_16x16x32_bf16 v[144:147], a[132:135], a[52:55], v[144:147]
buffer_load_dwordx4 v15, s[8:11], s25 offen offset:3072 lds
v_mfma_f32_16x16x32_bf16 v[152:155], a[128:131], a[56:59], v[152:155]
s_add_u32 s25, s25, 128
v_mfma_f32_16x16x32_bf16 v[152:155], a[132:135], a[60:63], v[152:155]
s_waitcnt lgkmcnt(2)
v_mfma_f32_16x16x32_bf16 v[100:103], a[136:139], a[0:3], v[100:103]
ds_read_b64_tr_b16 a[128:129], v8 offset:0
v_mfma_f32_16x16x32_bf16 v[100:103], a[140:143], a[4:7], v[100:103]
buffer_load_dword v21, v20, s[16:19], s43 offen
v_mfma_f32_16x16x32_bf16 v[108:111], a[136:139], a[8:11], v[108:111]
s_add_u32 s43, s43, s47
ds_read_b64_tr_b16 a[130:131], v8 offset:2048
v_mfma_f32_16x16x32_bf16 v[108:111], a[140:143], a[12:15], v[108:111]
PAD_2:
s_cbranch_execz M_tret
s_cmp_ge_u32 s43, s51
v_mfma_f32_16x16x32_bf16 v[116:119], a[136:139], a[16:19], v[116:119]
s_cselect_b32 s43, 0, s43
ds_read_b64_tr_b16 a[132:133], v8 offset:16384
v_mfma_f32_16x16x32_bf16 v[116:119], a[140:143], a[20:23], v[116:119]
s_cselect_b32 s51, s42, s51
v_mfma_f32_16x16x32_bf16 v[124:127], a[136:139], a[24:27], v[124:127]
s_cselect_b64 s[16:17], s[40:41], s[16:17]
ds_read_b64_tr_b16 a[134:135], v8 offset:18432
v_mfma_f32_16x16x32_bf16 v[124:127], a[140:143], a[28:31], v[124:127]
s_cselect_b32 s18, s42, s18
v_mfma_f32_16x16x32_bf16 v[132:135], a[136:139], a[32:35], v[132:135]
s_cselect_b64 s[40:41], s[44:45], s[40:41]
ds_read_b128 a[96:99], v2 offset:40960
v_mfma_f32_16x16x32_bf16 v[132:135], a[140:143], a[36:39], v[132:135]
s_cselect_b32 s42, s46, s42
v_mfma_f32_16x16x32_bf16 v[140:143], a[136:139], a[40:43], v[140:143]
s_cselect_b32 s46, 0, s46
v_mfma_f32_16x16x32_bf16 v[140:143], a[140:143], a[44:47], v[140:143]
s_lshl_b32 s59, s39, 5
v_mfma_f32_16x16x32_bf16 v[148:151], a[136:139], a[48:51], v[148:151]
s_add_u32 s59, s59, s38
ds_read_b128 a[100:103], v3 offset:40960
v_mfma_f32_16x16x32_bf16 v[148:151], a[140:143], a[52:55], v[148:151]
s_lshl_b32 s59, s59, 2
v_mfma_f32_16x16x32_bf16 v[156:159], a[136:139], a[56:59], v[156:159]
s_add_u32 s59, s59, 94392320
ds_read_b128 a[104:107], v2 offset:43008
v_mfma_f32_16x16x32_bf16 v[156:159], a[140:143], a[60:63], v[156:159]
s_waitcnt lgkmcnt(3)
s_cmp_lt_u32 s2, 224
v_mfma_f32_16x16x32_bf16 v[160:163], a[128:131], a[0:3], v[160:163]
s_cselect_b32 s59, s59, 3221225472
ds_read_b64_tr_b16 a[136:137], v9 offset:0
v_mfma_f32_16x16x32_bf16 v[160:163], a[132:135], a[4:7], v[160:163]
s_mov_b32 s58, 0xffff0000
v_mfma_f32_16x16x32_bf16 v[168:171], a[128:131], a[8:11], v[168:171]
ds_read_b64_tr_b16 a[138:139], v9 offset:2048
v_mfma_f32_16x16x32_bf16 v[168:171], a[132:135], a[12:15], v[168:171]
buffer_load_dword v21, v20, s[16:19], s43 offen
v_mfma_f32_16x16x32_bf16 v[176:179], a[128:131], a[16:19], v[176:179]
s_add_u32 s43, s43, s47
ds_read_b64_tr_b16 a[140:141], v9 offset:16384
v_mfma_f32_16x16x32_bf16 v[176:179], a[132:135], a[20:23], v[176:179]
s_cmp_ge_u32 s43, s51
v_mfma_f32_16x16x32_bf16 v[184:187], a[128:131], a[24:27], v[184:187]
s_cselect_b32 s43, 0, s43
ds_read_b64_tr_b16 a[142:143], v9 offset:18432
v_mfma_f32_16x16x32_bf16 v[184:187], a[132:135], a[28:31], v[184:187]
s_cselect_b32 s51, s42, s51
v_mfma_f32_16x16x32_bf16 v[192:195], a[128:131], a[32:35], v[192:195]
s_cselect_b64 s[16:17], s[40:41], s[16:17]
v_mfma_f32_16x16x32_bf16 v[192:195], a[132:135], a[36:39], v[192:195]
s_cselect_b32 s18, s42, s18
v_mfma_f32_16x16x32_bf16 v[200:203], a[128:131], a[40:43], v[200:203]
s_cselect_b64 s[40:41], s[44:45], s[40:41]
ds_read_b128 a[108:111], v3 offset:43008
v_mfma_f32_16x16x32_bf16 v[200:203], a[132:135], a[44:47], v[200:203]
s_cselect_b32 s42, s46, s42
v_mfma_f32_16x16x32_bf16 v[208:211], a[128:131], a[48:51], v[208:211]
s_cselect_b32 s46, 0, s46
ds_read_b128 a[112:115], v2 offset:45056
v_mfma_f32_16x16x32_bf16 v[208:211], a[132:135], a[52:55], v[208:211]
v_mfma_f32_16x16x32_bf16 v[216:219], a[128:131], a[56:59], v[216:219]
v_mfma_f32_16x16x32_bf16 v[216:219], a[132:135], a[60:63], v[216:219]
s_waitcnt lgkmcnt(2)
v_mfma_f32_16x16x32_bf16 v[164:167], a[136:139], a[0:3], v[164:167]
ds_read_b64_tr_b16 a[128:129], v10 offset:0
v_mfma_f32_16x16x32_bf16 v[164:167], a[140:143], a[4:7], v[164:167]
v_mfma_f32_16x16x32_bf16 v[172:175], a[136:139], a[8:11], v[172:175]
ds_read_b64_tr_b16 a[130:131], v10 offset:2048
v_mfma_f32_16x16x32_bf16 v[172:175], a[140:143], a[12:15], v[172:175]
v_mfma_f32_16x16x32_bf16 v[180:183], a[136:139], a[16:19], v[180:183]
ds_read_b64_tr_b16 a[132:133], v10 offset:16384
v_mfma_f32_16x16x32_bf16 v[180:183], a[140:143], a[20:23], v[180:183]
v_mfma_f32_16x16x32_bf16 v[188:191], a[136:139], a[24:27], v[188:191]
ds_read_b64_tr_b16 a[134:135], v10 offset:18432
v_mfma_f32_16x16x32_bf16 v[188:191], a[140:143], a[28:31], v[188:191]
v_mfma_f32_16x16x32_bf16 v[196:199], a[136:139], a[32:35], v[196:199]
ds_read_b128 a[116:119], v3 offset:45056
v_mfma_f32_16x16x32_bf16 v[196:199], a[140:143], a[36:39], v[196:199]
v_mfma_f32_16x16x32_bf16 v[204:207], a[136:139], a[40:43], v[204:207]
ds_read_b128 a[120:123], v2 offset:47104
v_and_b32 v252, 31, v0
v_mfma_f32_16x16x32_bf16 v[204:207], a[140:143], a[44:47], v[204:207]
v_lshrrev_b32 v253, 5, v0
v_xor_b32 v253, v253, v252
v_mfma_f32_16x16x32_bf16 v[212:215], a[136:139], a[48:51], v[212:215]
v_and_b32 v253, 7, v253
v_lshlrev_b32 v252, 8, v252
v_mfma_f32_16x16x32_bf16 v[212:215], a[140:143], a[52:55], v[212:215]
v_lshl_add_u32 v252, v253, 4, v252
v_add_u32 v252, 147456, v252
v_mfma_f32_16x16x32_bf16 v[220:223], a[136:139], a[56:59], v[220:223]
ds_read_b128 a[124:127], v3 offset:47104
v_mfma_f32_16x16x32_bf16 v[220:223], a[140:143], a[60:63], v[220:223]
s_waitcnt lgkmcnt(3)
v_mfma_f32_16x16x32_bf16 a[192:195], a[128:131], a[0:3], a[192:195]
ds_read_b64_tr_b16 a[136:137], v11 offset:0
v_mfma_f32_16x16x32_bf16 a[192:195], a[132:135], a[4:7], a[192:195]
v_mfma_f32_16x16x32_bf16 a[200:203], a[128:131], a[8:11], a[200:203]
ds_read_b64_tr_b16 a[138:139], v11 offset:2048
v_mfma_f32_16x16x32_bf16 a[200:203], a[132:135], a[12:15], a[200:203]
v_mfma_f32_16x16x32_bf16 a[208:211], a[128:131], a[16:19], a[208:211]
ds_read_b64_tr_b16 a[140:141], v11 offset:16384
v_mfma_f32_16x16x32_bf16 a[208:211], a[132:135], a[20:23], a[208:211]
v_mfma_f32_16x16x32_bf16 a[216:219], a[128:131], a[24:27], a[216:219]
ds_read_b64_tr_b16 a[142:143], v11 offset:18432
v_mfma_f32_16x16x32_bf16 a[216:219], a[132:135], a[28:31], a[216:219]
v_mfma_f32_16x16x32_bf16 a[224:227], a[128:131], a[32:35], a[224:227]
v_mfma_f32_16x16x32_bf16 a[224:227], a[132:135], a[36:39], a[224:227]
v_mfma_f32_16x16x32_bf16 a[232:235], a[128:131], a[40:43], a[232:235]
v_mfma_f32_16x16x32_bf16 a[232:235], a[132:135], a[44:47], a[232:235]
v_mfma_f32_16x16x32_bf16 a[240:243], a[128:131], a[48:51], a[240:243]
v_mfma_f32_16x16x32_bf16 a[240:243], a[132:135], a[52:55], a[240:243]
v_mfma_f32_16x16x32_bf16 a[248:251], a[128:131], a[56:59], a[248:251]
s_waitcnt vmcnt(2) lgkmcnt(0)
v_mfma_f32_16x16x32_bf16 a[248:251], a[132:135], a[60:63], a[248:251]
s_barrier
v_mfma_f32_16x16x32_bf16 a[196:199], a[136:139], a[0:3], a[196:199]
s_add_u32 m0, s29, 65536
ds_read_b64_tr_b16 a[128:129], v4 offset:32768
v_lshlrev_b32 v28, 16, v248
v_mfma_f32_16x16x32_bf16 a[196:199], a[140:143], a[4:7], a[196:199]
buffer_load_dwordx4 v16, s[12:15], s26 offen offset:0 lds
v_mfma_f32_16x16x32_bf16 a[204:207], a[136:139], a[8:11], a[204:207]
ds_read_b64_tr_b16 a[130:131], v4 offset:34816
v_and_b32 v29, s58, v248
v_mfma_f32_16x16x32_bf16 a[204:207], a[140:143], a[12:15], a[204:207]
v_lshlrev_b32 v30, 16, v249
v_and_b32 v253, s58, v249
v_mfma_f32_16x16x32_bf16 a[212:215], a[136:139], a[16:19], a[212:215]
ds_read_b64_tr_b16 a[132:133], v4 offset:49152
v_lshlrev_b32 v22, 16, v224
v_mfma_f32_16x16x32_bf16 a[212:215], a[140:143], a[20:23], a[212:215]
buffer_load_dwordx4 v17, s[12:15], s26 offen offset:1024 lds
v_mfma_f32_16x16x32_bf16 a[220:223], a[136:139], a[24:27], a[220:223]
ds_read_b64_tr_b16 a[134:135], v4 offset:51200
v_lshlrev_b32 v23, 16, v225
v_mfma_f32_16x16x32_bf16 a[220:223], a[140:143], a[28:31], a[220:223]
v_lshlrev_b32 v24, 16, v226
v_mul_f32 v254, v22, v253
v_mfma_f32_16x16x32_bf16 a[228:231], a[136:139], a[32:35], a[228:231]
v_lshlrev_b32 v25, 16, v227
v_lshlrev_b32 v247, 16, v236
v_mfma_f32_16x16x32_bf16 a[228:231], a[140:143], a[36:39], a[228:231]
buffer_load_dwordx4 v18, s[12:15], s26 offen offset:2048 lds
v_mfma_f32_16x16x32_bf16 a[236:239], a[136:139], a[40:43], a[236:239]
v_fmac_f32 v254, v23, v30
v_fmac_f32 v254, v24, v29
v_mfma_f32_16x16x32_bf16 a[236:239], a[140:143], a[44:47], a[236:239]
v_fmac_f32 v254, v25, v28
v_mul_f32 v254, v254, v247
v_mfma_f32_16x16x32_bf16 a[244:247], a[136:139], a[48:51], a[244:247]
v_mul_f32 v255, v23, v253
v_lshlrev_b32 v22, 16, v228
v_mfma_f32_16x16x32_bf16 a[244:247], a[140:143], a[52:55], a[244:247]
buffer_load_dwordx4 v19, s[12:15], s26 offen offset:3072 lds
v_mfma_f32_16x16x32_bf16 a[252:255], a[136:139], a[56:59], a[252:255]
s_add_u32 s26, s26, 524288
v_lshlrev_b32 v247, 16, v237
v_fmac_f32 v255, v24, v30
v_mfma_f32_16x16x32_bf16 a[252:255], a[140:143], a[60:63], a[252:255]
s_waitcnt lgkmcnt(0)
v_fmac_f32 v255, v25, v29
v_fmac_f32 v255, v22, v28
v_mfma_f32_16x16x32_bf16 v[32:35], a[128:131], a[64:67], v[32:35]
s_add_u32 m0, s29, 81920
ds_read_b64_tr_b16 a[136:137], v5 offset:32768
v_mul_f32 v255, v255, v247
v_mfma_f32_16x16x32_bf16 v[32:35], a[132:135], a[68:71], v[32:35]
buffer_load_dwordx4 v16, s[12:15], s27 offen offset:0 lds
v_mfma_f32_16x16x32_bf16 v[40:43], a[128:131], a[72:75], v[40:43]
ds_read_b64_tr_b16 a[138:139], v5 offset:34816
v_cvt_pk_bf16_f32 v246, v254, v255
v_mfma_f32_16x16x32_bf16 v[40:43], a[132:135], a[76:79], v[40:43]
v_accvgpr_write_b32 a180, v246
v_mul_f32 v254, v24, v253
v_mfma_f32_16x16x32_bf16 v[48:51], a[128:131], a[80:83], v[48:51]
ds_read_b64_tr_b16 a[140:141], v5 offset:49152
v_lshlrev_b32 v23, 16, v229
v_mfma_f32_16x16x32_bf16 v[48:51], a[132:135], a[84:87], v[48:51]
buffer_load_dwordx4 v17, s[12:15], s27 offen offset:1024 lds
v_lshlrev_b32 v247, 16, v238
v_mfma_f32_16x16x32_bf16 v[56:59], a[128:131], a[88:91], v[56:59]
ds_read_b64_tr_b16 a[142:143], v5 offset:51200
v_fmac_f32 v254, v25, v30
v_mfma_f32_16x16x32_bf16 v[56:59], a[132:135], a[92:95], v[56:59]
v_fmac_f32 v254, v22, v29
v_fmac_f32 v254, v23, v28
v_mfma_f32_16x16x32_bf16 v[64:67], a[128:131], a[96:99], v[64:67]
ds_read_b128 a[0:3], v2 offset:0
v_mul_f32 v254, v254, v247
v_mfma_f32_16x16x32_bf16 v[64:67], a[132:135], a[100:103], v[64:67]
buffer_load_dwordx4 v18, s[12:15], s27 offen offset:2048 lds
v_mfma_f32_16x16x32_bf16 v[72:75], a[128:131], a[104:107], v[72:75]
ds_read_b128 a[4:7], v3 offset:0
v_cvt_pk_bf16_f32 v246, v255, v254
v_accvgpr_write_b32 a176, v246
v_mfma_f32_16x16x32_bf16 v[72:75], a[132:135], a[108:111], v[72:75]
v_mul_f32 v255, v25, v253
v_lshlrev_b32 v24, 16, v230
v_mfma_f32_16x16x32_bf16 v[80:83], a[128:131], a[112:115], v[80:83]
v_lshlrev_b32 v247, 16, v239
v_fmac_f32 v255, v22, v30
v_mfma_f32_16x16x32_bf16 v[80:83], a[132:135], a[116:119], v[80:83]
buffer_load_dwordx4 v19, s[12:15], s27 offen offset:3072 lds
v_mfma_f32_16x16x32_bf16 v[88:91], a[128:131], a[120:123], v[88:91]
s_add_u32 s27, s27, 524288
ds_read_b128 a[8:11], v2 offset:2048
v_fmac_f32 v255, v23, v29
v_mfma_f32_16x16x32_bf16 v[88:91], a[132:135], a[124:127], v[88:91]
s_waitcnt lgkmcnt(3)
v_fmac_f32 v255, v24, v28
v_mul_f32 v255, v255, v247
v_mfma_f32_16x16x32_bf16 v[36:39], a[136:139], a[64:67], v[36:39]
s_add_u32 m0, s28, 32768
ds_read_b64_tr_b16 a[128:129], v6 offset:32768
v_cvt_pk_bf16_f32 v246, v254, v255
v_accvgpr_write_b32 a181, v246
v_mfma_f32_16x16x32_bf16 v[36:39], a[140:143], a[68:71], v[36:39]
buffer_load_dwordx4 v12, s[8:11], s24 offen offset:0 lds
v_mfma_f32_16x16x32_bf16 v[44:47], a[136:139], a[72:75], v[44:47]
ds_read_b64_tr_b16 a[130:131], v6 offset:34816
v_mul_f32 v254, v22, v253
v_mfma_f32_16x16x32_bf16 v[44:47], a[140:143], a[76:79], v[44:47]
v_lshlrev_b32 v25, 16, v231
v_lshlrev_b32 v247, 16, v240
v_mfma_f32_16x16x32_bf16 v[52:55], a[136:139], a[80:83], v[52:55]
ds_read_b64_tr_b16 a[132:133], v6 offset:49152
v_fmac_f32 v254, v23, v30
v_mfma_f32_16x16x32_bf16 v[52:55], a[140:143], a[84:87], v[52:55]
buffer_load_dwordx4 v13, s[8:11], s24 offen offset:1024 lds
v_fmac_f32 v254, v24, v29
v_mfma_f32_16x16x32_bf16 v[60:63], a[136:139], a[88:91], v[60:63]
ds_read_b64_tr_b16 a[134:135], v6 offset:51200
v_fmac_f32 v254, v25, v28
v_mfma_f32_16x16x32_bf16 v[60:63], a[140:143], a[92:95], v[60:63]
v_mul_f32 v254, v254, v247
v_cvt_pk_bf16_f32 v246, v255, v254
v_mfma_f32_16x16x32_bf16 v[68:71], a[136:139], a[96:99], v[68:71]
ds_read_b128 a[12:15], v3 offset:2048
v_accvgpr_write_b32 a177, v246
v_mfma_f32_16x16x32_bf16 v[68:71], a[140:143], a[100:103], v[68:71]
buffer_load_dwordx4 v14, s[8:11], s24 offen offset:2048 lds
v_mfma_f32_16x16x32_bf16 v[76:79], a[136:139], a[104:107], v[76:79]
v_mul_f32 v255, v23, v253
v_lshlrev_b32 v22, 16, v232
v_lshlrev_b32 v247, 16, v241
v_mfma_f32_16x16x32_bf16 v[76:79], a[140:143], a[108:111], v[76:79]
v_fmac_f32 v255, v24, v30
v_fmac_f32 v255, v25, v29
v_mfma_f32_16x16x32_bf16 v[84:87], a[136:139], a[112:115], v[84:87]
ds_read_b128 a[16:19], v2 offset:4096
v_fmac_f32 v255, v22, v28
v_mfma_f32_16x16x32_bf16 v[84:87], a[140:143], a[116:119], v[84:87]
buffer_load_dwordx4 v15, s[8:11], s24 offen offset:3072 lds
v_mfma_f32_16x16x32_bf16 v[92:95], a[136:139], a[120:123], v[92:95]
s_add_u32 s24, s24, 128
ds_read_b128 a[20:23], v3 offset:4096
v_mul_f32 v255, v255, v247
v_mfma_f32_16x16x32_bf16 v[92:95], a[140:143], a[124:127], v[92:95]
s_waitcnt lgkmcnt(3)
v_cvt_pk_bf16_f32 v246, v254, v255
v_accvgpr_write_b32 a182, v246
v_mfma_f32_16x16x32_bf16 v[96:99], a[128:131], a[64:67], v[96:99]
s_add_u32 m0, s28, 36864
ds_read_b64_tr_b16 a[136:137], v7 offset:32768
v_mul_f32 v254, v24, v253
v_lshlrev_b32 v23, 16, v233
v_mfma_f32_16x16x32_bf16 v[96:99], a[132:135], a[68:71], v[96:99]
buffer_load_dwordx4 v12, s[8:11], s25 offen offset:0 lds
v_mfma_f32_16x16x32_bf16 v[104:107], a[128:131], a[72:75], v[104:107]
ds_read_b64_tr_b16 a[138:139], v7 offset:34816
v_lshlrev_b32 v247, 16, v242
v_mfma_f32_16x16x32_bf16 v[104:107], a[132:135], a[76:79], v[104:107]
v_fmac_f32 v254, v25, v30
v_fmac_f32 v254, v22, v29
v_mfma_f32_16x16x32_bf16 v[112:115], a[128:131], a[80:83], v[112:115]
ds_read_b64_tr_b16 a[140:141], v7 offset:49152
v_fmac_f32 v254, v23, v28
v_mfma_f32_16x16x32_bf16 v[112:115], a[132:135], a[84:87], v[112:115]
buffer_load_dwordx4 v13, s[8:11], s25 offen offset:1024 lds
v_mul_f32 v254, v254, v247
v_mfma_f32_16x16x32_bf16 v[120:123], a[128:131], a[88:91], v[120:123]
ds_read_b64_tr_b16 a[142:143], v7 offset:51200
v_cvt_pk_bf16_f32 v246, v255, v254
v_mfma_f32_16x16x32_bf16 v[120:123], a[132:135], a[92:95], v[120:123]
v_accvgpr_write_b32 a178, v246
v_mul_f32 v255, v25, v253
v_mfma_f32_16x16x32_bf16 v[128:131], a[128:131], a[96:99], v[128:131]
v_lshlrev_b32 v24, 16, v234
v_lshlrev_b32 v247, 16, v243
v_mfma_f32_16x16x32_bf16 v[128:131], a[132:135], a[100:103], v[128:131]
buffer_load_dwordx4 v14, s[8:11], s25 offen offset:2048 lds
v_mfma_f32_16x16x32_bf16 v[136:139], a[128:131], a[104:107], v[136:139]
ds_read_b128 a[24:27], v2 offset:6144
v_fmac_f32 v255, v22, v30
v_fmac_f32 v255, v23, v29
v_mfma_f32_16x16x32_bf16 v[136:139], a[132:135], a[108:111], v[136:139]
v_fmac_f32 v255, v24, v28
v_mul_f32 v255, v255, v247
v_mfma_f32_16x16x32_bf16 v[144:147], a[128:131], a[112:115], v[144:147]
ds_read_b128 a[28:31], v3 offset:6144
v_cvt_pk_bf16_f32 v246, v254, v255
v_mfma_f32_16x16x32_bf16 v[144:147], a[132:135], a[116:119], v[144:147]
buffer_load_dwordx4 v15, s[8:11], s25 offen offset:3072 lds
v_mfma_f32_16x16x32_bf16 v[152:155], a[128:131], a[120:123], v[152:155]
s_add_u32 s25, s25, 128
v_accvgpr_write_b32 a183, v246
v_mul_f32 v254, v22, v253
v_mfma_f32_16x16x32_bf16 v[152:155], a[132:135], a[124:127], v[152:155]
s_waitcnt lgkmcnt(2)
v_lshlrev_b32 v25, 16, v235
v_lshlrev_b32 v247, 16, v244
v_mfma_f32_16x16x32_bf16 v[100:103], a[136:139], a[64:67], v[100:103]
ds_read_b64_tr_b16 a[128:129], v8 offset:32768
v_fmac_f32 v254, v23, v30
v_fmac_f32 v254, v24, v29
v_mfma_f32_16x16x32_bf16 v[100:103], a[140:143], a[68:71], v[100:103]
buffer_load_dword v21, v20, s[16:19], s43 offen
v_mfma_f32_16x16x32_bf16 v[108:111], a[136:139], a[72:75], v[108:111]
s_add_u32 s43, s43, s47
ds_read_b64_tr_b16 a[130:131], v8 offset:34816
v_fmac_f32 v254, v25, v28
v_mfma_f32_16x16x32_bf16 v[108:111], a[140:143], a[76:79], v[108:111]
s_cmp_ge_u32 s43, s51
v_mul_f32 v254, v254, v247
v_cvt_pk_bf16_f32 v246, v255, v254
v_mfma_f32_16x16x32_bf16 v[116:119], a[136:139], a[80:83], v[116:119]
s_cselect_b32 s43, 0, s43
ds_read_b64_tr_b16 a[132:133], v8 offset:49152
v_accvgpr_write_b32 a179, v246
v_mfma_f32_16x16x32_bf16 v[116:119], a[140:143], a[84:87], v[116:119]
s_cselect_b32 s51, s42, s51
v_lshlrev_b32 v28, 16, v250
v_and_b32 v29, s58, v250
v_lshlrev_b32 v30, 16, v251
v_mfma_f32_16x16x32_bf16 v[124:127], a[136:139], a[88:91], v[124:127]
s_cselect_b64 s[16:17], s[40:41], s[16:17]
ds_read_b64_tr_b16 a[134:135], v8 offset:51200
v_and_b32 v253, s58, v251
v_mfma_f32_16x16x32_bf16 v[124:127], a[140:143], a[92:95], v[124:127]
s_cselect_b32 s18, s42, s18
v_and_b32 v22, s58, v224
v_and_b32 v23, s58, v225
v_mfma_f32_16x16x32_bf16 v[132:135], a[136:139], a[96:99], v[132:135]
s_cselect_b64 s[40:41], s[44:45], s[40:41]
ds_read_b128 a[32:35], v2 offset:8192
v_and_b32 v24, s58, v226
v_mfma_f32_16x16x32_bf16 v[132:135], a[140:143], a[100:103], v[132:135]
s_cselect_b32 s42, s46, s42
v_mul_f32 v254, v22, v253
v_and_b32 v25, s58, v227
v_mfma_f32_16x16x32_bf16 v[140:143], a[136:139], a[104:107], v[140:143]
s_cselect_b32 s46, 0, s46
v_and_b32 v247, s58, v236
v_fmac_f32 v254, v23, v30
v_mfma_f32_16x16x32_bf16 v[140:143], a[140:143], a[108:111], v[140:143]
buffer_load_dword v245, off, s[60:63], 0 sc1
v_fmac_f32 v254, v24, v29
v_mfma_f32_16x16x32_bf16 v[148:151], a[136:139], a[112:115], v[148:151]
ds_read_b128 a[36:39], v3 offset:8192
v_fmac_f32 v254, v25, v28
v_mfma_f32_16x16x32_bf16 v[148:151], a[140:143], a[116:119], v[148:151]
v_mul_f32 v254, v254, v247
v_mul_f32 v255, v23, v253
v_mfma_f32_16x16x32_bf16 v[156:159], a[136:139], a[120:123], v[156:159]
ds_read_b128 a[40:43], v2 offset:10240
v_and_b32 v22, s58, v228
v_mfma_f32_16x16x32_bf16 v[156:159], a[140:143], a[124:127], v[156:159]
s_waitcnt lgkmcnt(3)
v_and_b32 v247, s58, v237
v_fmac_f32 v255, v24, v30
v_mfma_f32_16x16x32_bf16 v[160:163], a[128:131], a[64:67], v[160:163]
ds_read_b64_tr_b16 a[136:137], v9 offset:32768
v_fmac_f32 v255, v25, v29
v_fmac_f32 v255, v22, v28
v_mfma_f32_16x16x32_bf16 v[160:163], a[132:135], a[68:71], v[160:163]
v_mul_f32 v255, v255, v247
v_cvt_pk_bf16_f32 v246, v254, v255
v_mfma_f32_16x16x32_bf16 v[168:171], a[128:131], a[72:75], v[168:171]
ds_read_b64_tr_b16 a[138:139], v9 offset:34816
v_accvgpr_write_b32 a188, v246
v_mfma_f32_16x16x32_bf16 v[168:171], a[132:135], a[76:79], v[168:171]
v_mul_f32 v254, v24, v253
v_and_b32 v23, s58, v229
v_mfma_f32_16x16x32_bf16 v[176:179], a[128:131], a[80:83], v[176:179]
ds_read_b64_tr_b16 a[140:141], v9 offset:49152
v_and_b32 v247, s58, v238
v_mfma_f32_16x16x32_bf16 v[176:179], a[132:135], a[84:87], v[176:179]
v_fmac_f32 v254, v25, v30
v_fmac_f32 v254, v22, v29
v_fmac_f32 v254, v23, v28
v_mfma_f32_16x16x32_bf16 v[184:187], a[128:131], a[88:91], v[184:187]
ds_read_b64_tr_b16 a[142:143], v9 offset:51200
v_mul_f32 v254, v254, v247
v_mfma_f32_16x16x32_bf16 v[184:187], a[132:135], a[92:95], v[184:187]
v_cvt_pk_bf16_f32 v246, v255, v254
v_accvgpr_write_b32 a184, v246
v_mfma_f32_16x16x32_bf16 v[192:195], a[128:131], a[96:99], v[192:195]
v_mul_f32 v255, v25, v253
v_and_b32 v24, s58, v230
v_mfma_f32_16x16x32_bf16 v[192:195], a[132:135], a[100:103], v[192:195]
v_and_b32 v247, s58, v239
v_fmac_f32 v255, v22, v30
v_mfma_f32_16x16x32_bf16 v[200:203], a[128:131], a[104:107], v[200:203]
ds_read_b128 a[44:47], v3 offset:10240
v_fmac_f32 v255, v23, v29
v_mfma_f32_16x16x32_bf16 v[200:203], a[132:135], a[108:111], v[200:203]
v_fmac_f32 v255, v24, v28
v_mul_f32 v255, v255, v247
v_cvt_pk_bf16_f32 v246, v254, v255
v_mfma_f32_16x16x32_bf16 v[208:211], a[128:131], a[112:115], v[208:211]
ds_read_b128 a[48:51], v2 offset:12288
v_accvgpr_write_b32 a189, v246
v_mfma_f32_16x16x32_bf16 v[208:211], a[132:135], a[116:119], v[208:211]
v_mul_f32 v254, v22, v253
v_and_b32 v25, s58, v231
v_mfma_f32_16x16x32_bf16 v[216:219], a[128:131], a[120:123], v[216:219]
v_and_b32 v247, s58, v240
v_fmac_f32 v254, v23, v30
v_mfma_f32_16x16x32_bf16 v[216:219], a[132:135], a[124:127], v[216:219]
s_waitcnt lgkmcnt(2)
v_fmac_f32 v254, v24, v29
v_fmac_f32 v254, v25, v28
v_mfma_f32_16x16x32_bf16 v[164:167], a[136:139], a[64:67], v[164:167]
ds_read_b64_tr_b16 a[128:129], v10 offset:32768
v_mul_f32 v254, v254, v247
v_cvt_pk_bf16_f32 v246, v255, v254
v_mfma_f32_16x16x32_bf16 v[164:167], a[140:143], a[68:71], v[164:167]
v_accvgpr_write_b32 a185, v246
v_mul_f32 v255, v23, v253
v_mfma_f32_16x16x32_bf16 v[172:175], a[136:139], a[72:75], v[172:175]
ds_read_b64_tr_b16 a[130:131], v10 offset:34816
v_and_b32 v22, s58, v232
v_mfma_f32_16x16x32_bf16 v[172:175], a[140:143], a[76:79], v[172:175]
v_and_b32 v247, s58, v241
v_fmac_f32 v255, v24, v30
v_mfma_f32_16x16x32_bf16 v[180:183], a[136:139], a[80:83], v[180:183]
s_lshr_b32 s22, s3, 1
ds_read_b64_tr_b16 a[132:133], v10 offset:49152
v_fmac_f32 v255, v25, v29
v_mfma_f32_16x16x32_bf16 v[180:183], a[140:143], a[84:87], v[180:183]
s_mul_i32 s22, s22, 2097152
v_fmac_f32 v255, v22, v28
v_mul_f32 v255, v255, v247
v_cvt_pk_bf16_f32 v246, v254, v255
v_mfma_f32_16x16x32_bf16 v[188:191], a[136:139], a[88:91], v[188:191]
s_and_b32 s23, s3, 1
ds_read_b64_tr_b16 a[134:135], v10 offset:51200
v_accvgpr_write_b32 a190, v246
v_mfma_f32_16x16x32_bf16 v[188:191], a[140:143], a[92:95], v[188:191]
s_lshl_b32 s23, s23, 5
v_mul_f32 v254, v24, v253
v_and_b32 v23, s58, v233
v_mfma_f32_16x16x32_bf16 v[196:199], a[136:139], a[96:99], v[196:199]
s_lshl_b32 s56, s39, 6
ds_read_b128 a[52:55], v3 offset:12288
v_and_b32 v247, s58, v242
v_mfma_f32_16x16x32_bf16 v[196:199], a[140:143], a[100:103], v[196:199]
s_add_u32 s23, s23, s56
v_fmac_f32 v254, v25, v30
v_fmac_f32 v254, v22, v29
v_mfma_f32_16x16x32_bf16 v[204:207], a[136:139], a[104:107], v[204:207]
s_mul_i32 s23, s23, 4224
ds_read_b128 a[56:59], v2 offset:14336
v_fmac_f32 v254, v23, v28
v_mfma_f32_16x16x32_bf16 v[204:207], a[140:143], a[108:111], v[204:207]
s_add_u32 s22, s22, s23
v_mul_f32 v254, v254, v247
v_cvt_pk_bf16_f32 v246, v255, v254
v_accvgpr_write_b32 a186, v246
v_mfma_f32_16x16x32_bf16 v[212:215], a[136:139], a[112:115], v[212:215]
s_add_u32 s57, s22, 83886200
v_mul_f32 v255, v25, v253
v_and_b32 v24, s58, v234
v_mfma_f32_16x16x32_bf16 v[212:215], a[140:143], a[116:119], v[212:215]
s_lshl_b32 s23, s38, 7
v_and_b32 v247, s58, v243
v_fmac_f32 v255, v22, v30
v_mfma_f32_16x16x32_bf16 v[220:223], a[136:139], a[120:123], v[220:223]
s_add_u32 s22, s22, s23
ds_read_b128 a[60:63], v3 offset:14336
v_fmac_f32 v255, v23, v29
v_mfma_f32_16x16x32_bf16 v[220:223], a[140:143], a[124:127], v[220:223]
s_waitcnt lgkmcnt(3)
s_add_u32 s56, s22, 83886208
v_fmac_f32 v255, v24, v28
v_mul_f32 v255, v255, v247
v_mfma_f32_16x16x32_bf16 a[192:195], a[128:131], a[64:67], a[192:195]
s_cmp_lt_u32 s2, 224
ds_read_b64_tr_b16 a[136:137], v11 offset:32768
v_cvt_pk_bf16_f32 v246, v254, v255
v_accvgpr_write_b32 a191, v246
v_mfma_f32_16x16x32_bf16 a[192:195], a[132:135], a[68:71], a[192:195]
s_cselect_b32 s56, s56, 3221225472
v_mul_f32 v254, v22, v253
v_and_b32 v25, s58, v235
v_mfma_f32_16x16x32_bf16 a[200:203], a[128:131], a[72:75], a[200:203]
s_cmp_eq_u32 s38, 0
ds_read_b64_tr_b16 a[138:139], v11 offset:34816
v_and_b32 v247, s58, v244
v_mfma_f32_16x16x32_bf16 a[200:203], a[132:135], a[76:79], a[200:203]
s_cselect_b32 s57, s57, 3221225472
v_fmac_f32 v254, v23, v30
v_fmac_f32 v254, v24, v29
v_mfma_f32_16x16x32_bf16 a[208:211], a[128:131], a[80:83], a[208:211]
ds_read_b64_tr_b16 a[140:141], v11 offset:49152
v_fmac_f32 v254, v25, v28
v_mfma_f32_16x16x32_bf16 a[208:211], a[132:135], a[84:87], a[208:211]
v_mul_f32 v254, v254, v247
v_cvt_pk_bf16_f32 v246, v255, v254
v_accvgpr_write_b32 a187, v246
v_mfma_f32_16x16x32_bf16 a[216:219], a[128:131], a[88:91], a[216:219]
ds_read_b64_tr_b16 a[142:143], v11 offset:51200
v_mfma_f32_16x16x32_bf16 a[216:219], a[132:135], a[92:95], a[216:219]
ds_write_b128 v252, a[176:179] offset:0
v_mfma_f32_16x16x32_bf16 a[224:227], a[128:131], a[96:99], a[224:227]
v_mfma_f32_16x16x32_bf16 a[224:227], a[132:135], a[100:103], a[224:227]
ds_write_b128 v252, a[180:183] offset:8192
v_mfma_f32_16x16x32_bf16 a[232:235], a[128:131], a[104:107], a[232:235]
v_mfma_f32_16x16x32_bf16 a[232:235], a[132:135], a[108:111], a[232:235]
ds_write_b128 v252, a[184:187] offset:128
v_mfma_f32_16x16x32_bf16 a[240:243], a[128:131], a[112:115], a[240:243]
v_mfma_f32_16x16x32_bf16 a[240:243], a[132:135], a[116:119], a[240:243]
ds_write_b128 v252, a[188:191] offset:8320
v_mfma_f32_16x16x32_bf16 a[248:251], a[128:131], a[120:123], a[248:251]
s_waitcnt vmcnt(2) lgkmcnt(0)
v_mfma_f32_16x16x32_bf16 a[248:251], a[132:135], a[124:127], a[248:251]
s_barrier
v_mfma_f32_16x16x32_bf16 a[196:199], a[136:139], a[64:67], a[196:199]
s_add_u32 m0, s29, 98304
ds_read_b64_tr_b16 a[128:129], v4 offset:0
v_lshrrev_b32 v22, 8, v1
v_mfma_f32_16x16x32_bf16 a[196:199], a[140:143], a[68:71], a[196:199]
buffer_load_dwordx4 v16, s[12:15], s26 offen offset:0 lds
v_mfma_f32_16x16x32_bf16 a[204:207], a[136:139], a[72:75], a[204:207]
ds_read_b64_tr_b16 a[130:131], v4 offset:2048
v_lshlrev_b32 v22, 4, v22
v_mfma_f32_16x16x32_bf16 a[204:207], a[140:143], a[76:79], a[204:207]
v_xor_b32 v22, v22, v1
v_add_u32 v22, s29, v22
v_mfma_f32_16x16x32_bf16 a[212:215], a[136:139], a[80:83], a[212:215]
ds_read_b64_tr_b16 a[132:133], v4 offset:16384
v_add_u32 v22, 147456, v22
v_mfma_f32_16x16x32_bf16 a[212:215], a[140:143], a[84:87], a[212:215]
buffer_load_dwordx4 v17, s[12:15], s26 offen offset:1024 lds
v_mfma_f32_16x16x32_bf16 a[220:223], a[136:139], a[88:91], a[220:223]
ds_read_b64_tr_b16 a[134:135], v4 offset:18432
v_xor_b32 v23, 64, v22
v_mfma_f32_16x16x32_bf16 a[220:223], a[140:143], a[92:95], a[220:223]
v_lshrrev_b32 v224, 7, v1
v_mul_u32_u24 v224, 4224, v224
v_mfma_f32_16x16x32_bf16 a[228:231], a[136:139], a[96:99], a[228:231]
v_and_b32 v225, 0x70, v1
v_add_u32 v224, v224, v225
v_mfma_f32_16x16x32_bf16 a[228:231], a[140:143], a[100:103], a[228:231]
buffer_load_dwordx4 v18, s[12:15], s26 offen offset:2048 lds
v_mfma_f32_16x16x32_bf16 a[236:239], a[136:139], a[104:107], a[236:239]
v_bfe_u32 v225, v1, 4, 5
v_mul_u32_u24 v225, 4224, v225
v_mfma_f32_16x16x32_bf16 a[236:239], a[140:143], a[108:111], a[236:239]
v_mov_b32 v226, 0
v_mov_b32 v227, 0
v_mfma_f32_16x16x32_bf16 a[244:247], a[136:139], a[112:115], a[244:247]
v_mfma_f32_16x16x32_bf16 a[244:247], a[140:143], a[116:119], a[244:247]
buffer_load_dwordx4 v19, s[12:15], s26 offen offset:3072 lds
v_mfma_f32_16x16x32_bf16 a[252:255], a[136:139], a[120:123], a[252:255]
s_add_u32 s26, s26, 524288
v_mfma_f32_16x16x32_bf16 a[252:255], a[140:143], a[124:127], a[252:255]
s_waitcnt lgkmcnt(0)
v_mfma_f32_16x16x32_bf16 v[32:35], a[128:131], a[0:3], v[32:35]
s_add_u32 m0, s29, 114688
ds_read_b64_tr_b16 a[136:137], v5 offset:0
v_mfma_f32_16x16x32_bf16 v[32:35], a[132:135], a[4:7], v[32:35]
buffer_load_dwordx4 v16, s[12:15], s27 offen offset:0 lds
v_mfma_f32_16x16x32_bf16 v[40:43], a[128:131], a[8:11], v[40:43]
s_mul_i32 s52, s20, 7
ds_read_b64_tr_b16 a[138:139], v5 offset:2048
v_mfma_f32_16x16x32_bf16 v[40:43], a[132:135], a[12:15], v[40:43]
s_add_u32 s52, s52, s21
buffer_store_dwordx2 v[226:227], v225, s[4:7], s57 offen sc1
v_mfma_f32_16x16x32_bf16 v[48:51], a[128:131], a[16:19], v[48:51]
s_lshl_b32 s53, s52, 2
ds_read_b64_tr_b16 a[140:141], v5 offset:16384
v_mfma_f32_16x16x32_bf16 v[48:51], a[132:135], a[20:23], v[48:51]
s_add_u32 s53, s53, s3
buffer_load_dwordx4 v17, s[12:15], s27 offen offset:1024 lds
v_mfma_f32_16x16x32_bf16 v[56:59], a[128:131], a[24:27], v[56:59]
s_lshl_b32 s49, s53, 12
ds_read_b64_tr_b16 a[142:143], v5 offset:18432
v_mfma_f32_16x16x32_bf16 v[56:59], a[132:135], a[28:31], v[56:59]
s_mul_i32 s53, s53, 4224
v_mfma_f32_16x16x32_bf16 v[64:67], a[128:131], a[32:35], v[64:67]
s_add_u32 s53, s53, 83886080
ds_read_b128 a[64:67], v2 offset:32768
v_mfma_f32_16x16x32_bf16 v[64:67], a[132:135], a[36:39], v[64:67]
s_lshr_b32 s52, s52, 4
buffer_load_dwordx4 v18, s[12:15], s27 offen offset:2048 lds
v_mfma_f32_16x16x32_bf16 v[72:75], a[128:131], a[40:43], v[72:75]
s_min_u32 s52, s52, 6
ds_read_b128 a[68:71], v3 offset:32768
v_mfma_f32_16x16x32_bf16 v[72:75], a[132:135], a[44:47], v[72:75]
s_lshl_b32 s52, s52, 7
ds_read_b128 a[176:179], v22 offset:0
v_mfma_f32_16x16x32_bf16 v[80:83], a[128:131], a[48:51], v[80:83]
s_add_u32 s52, s52, 94392320
ds_read_b128 a[180:183], v23 offset:1024
v_mfma_f32_16x16x32_bf16 v[80:83], a[132:135], a[52:55], v[80:83]
buffer_load_dwordx4 v19, s[12:15], s27 offen offset:3072 lds
v_mfma_f32_16x16x32_bf16 v[88:91], a[128:131], a[56:59], v[88:91]
s_add_u32 s27, s27, 524288
ds_read_b128 a[72:75], v2 offset:34816
v_mfma_f32_16x16x32_bf16 v[88:91], a[132:135], a[60:63], v[88:91]
s_waitcnt lgkmcnt(5)
ds_read_b128 a[184:187], v22 offset:2048
v_mfma_f32_16x16x32_bf16 v[36:39], a[136:139], a[0:3], v[36:39]
s_add_u32 m0, s28, 0
ds_read_b64_tr_b16 a[128:129], v6 offset:0
v_mfma_f32_16x16x32_bf16 v[36:39], a[140:143], a[4:7], v[36:39]
buffer_load_dwordx4 v12, s[8:11], s24 offen offset:0 lds
v_mfma_f32_16x16x32_bf16 v[44:47], a[136:139], a[8:11], v[44:47]
PAD_3:
s_cbranch_execz M_tret
ds_read_b64_tr_b16 a[130:131], v6 offset:2048
v_mfma_f32_16x16x32_bf16 v[44:47], a[140:143], a[12:15], v[44:47]
ds_read_b128 a[188:191], v23 offset:3072
v_mfma_f32_16x16x32_bf16 v[52:55], a[136:139], a[16:19], v[52:55]
ds_read_b64_tr_b16 a[132:133], v6 offset:16384
v_bfe_u32 v231, v1, 4, 5
v_mfma_f32_16x16x32_bf16 v[52:55], a[140:143], a[20:23], v[52:55]
buffer_load_dwordx4 v13, s[8:11], s24 offen offset:1024 lds
v_mfma_f32_16x16x32_bf16 v[60:63], a[136:139], a[24:27], v[60:63]
ds_read_b64_tr_b16 a[134:135], v6 offset:18432
v_lshlrev_b32 v231, 2, v231
v_mfma_f32_16x16x32_bf16 v[60:63], a[140:143], a[28:31], v[60:63]
v_lshlrev_b32 v229, 3, v1
v_min_u32 v229, 4096, v229
v_mfma_f32_16x16x32_bf16 v[68:71], a[136:139], a[32:35], v[68:71]
ds_read_b128 a[76:79], v3 offset:34816
v_mfma_f32_16x16x32_bf16 v[68:71], a[140:143], a[36:39], v[68:71]
buffer_load_dwordx4 v14, s[8:11], s24 offen offset:2048 lds
v_mfma_f32_16x16x32_bf16 v[76:79], a[136:139], a[40:43], v[76:79]
v_mfma_f32_16x16x32_bf16 v[76:79], a[140:143], a[44:47], v[76:79]
v_mfma_f32_16x16x32_bf16 v[84:87], a[136:139], a[48:51], v[84:87]
ds_read_b128 a[80:83], v2 offset:36864
v_mfma_f32_16x16x32_bf16 v[84:87], a[140:143], a[52:55], v[84:87]
buffer_load_dwordx4 v15, s[8:11], s24 offen offset:3072 lds
v_mfma_f32_16x16x32_bf16 v[92:95], a[136:139], a[56:59], v[92:95]
s_add_u32 s24, s24, 128
ds_read_b128 a[84:87], v3 offset:36864
v_mfma_f32_16x16x32_bf16 v[92:95], a[140:143], a[60:63], v[92:95]
s_waitcnt lgkmcnt(3)
v_mfma_f32_16x16x32_bf16 v[96:99], a[128:131], a[0:3], v[96:99]
s_add_u32 m0, s28, 4096
ds_read_b64_tr_b16 a[136:137], v7 offset:0
v_mfma_f32_16x16x32_bf16 v[96:99], a[132:135], a[4:7], v[96:99]
buffer_load_dwordx4 v12, s[8:11], s25 offen offset:0 lds
v_mfma_f32_16x16x32_bf16 v[104:107], a[128:131], a[8:11], v[104:107]
ds_read_b64_tr_b16 a[138:139], v7 offset:2048
v_mfma_f32_16x16x32_bf16 v[104:107], a[132:135], a[12:15], v[104:107]
v_mfma_f32_16x16x32_bf16 v[112:115], a[128:131], a[16:19], v[112:115]
ds_read_b64_tr_b16 a[140:141], v7 offset:16384
v_mfma_f32_16x16x32_bf16 v[112:115], a[132:135], a[20:23], v[112:115]
buffer_load_dwordx4 v13, s[8:11], s25 offen offset:1024 lds
v_mfma_f32_16x16x32_bf16 v[120:123], a[128:131], a[24:27], v[120:123]
ds_read_b64_tr_b16 a[142:143], v7 offset:18432
v_mfma_f32_16x16x32_bf16 v[120:123], a[132:135], a[28:31], v[120:123]
v_mfma_f32_16x16x32_bf16 v[128:131], a[128:131], a[32:35], v[128:131]
v_mfma_f32_16x16x32_bf16 v[128:131], a[132:135], a[36:39], v[128:131]
buffer_load_dwordx4 v14, s[8:11], s25 offen offset:2048 lds
v_mfma_f32_16x16x32_bf16 v[136:139], a[128:131], a[40:43], v[136:139]
ds_read_b128 a[88:91], v2 offset:38912
v_mfma_f32_16x16x32_bf16 v[136:139], a[132:135], a[44:47], v[136:139]
v_mfma_f32_16x16x32_bf16 v[144:147], a[128:131], a[48:51], v[144:147]
ds_read_b128 a[92:95], v3 offset:38912
v_mfma_f32_16x16x32_bf16 v[144:147], a[132:135], a[52:55], v[144:147]
buffer_load_dwordx4 v15, s[8:11], s25 offen offset:3072 lds
v_mfma_f32_16x16x32_bf16 v[152:155], a[128:131], a[56:59], v[152:155]
s_add_u32 s25, s25, 128
v_mfma_f32_16x16x32_bf16 v[152:155], a[132:135], a[60:63], v[152:155]
s_waitcnt lgkmcnt(2)
v_mfma_f32_16x16x32_bf16 v[100:103], a[136:139], a[0:3], v[100:103]
ds_read_b64_tr_b16 a[128:129], v8 offset:0
v_mfma_f32_16x16x32_bf16 v[100:103], a[140:143], a[4:7], v[100:103]
buffer_store_dwordx4 a[176:179], v224, s[4:7], s56 offen sc1
v_mfma_f32_16x16x32_bf16 v[108:111], a[136:139], a[8:11], v[108:111]
s_add_u32 s56, s56, 33792
ds_read_b64_tr_b16 a[130:131], v8 offset:2048
v_mfma_f32_16x16x32_bf16 v[108:111], a[140:143], a[12:15], v[108:111]
v_mfma_f32_16x16x32_bf16 v[116:119], a[136:139], a[16:19], v[116:119]
ds_read_b64_tr_b16 a[132:133], v8 offset:16384
v_mfma_f32_16x16x32_bf16 v[116:119], a[140:143], a[20:23], v[116:119]
v_mfma_f32_16x16x32_bf16 v[124:127], a[136:139], a[24:27], v[124:127]
s_cmp_lt_u32 s21, 0
ds_read_b64_tr_b16 a[134:135], v8 offset:18432
v_mfma_f32_16x16x32_bf16 v[124:127], a[140:143], a[28:31], v[124:127]
s_cselect_b32 s53, s53, 3221225472
v_mfma_f32_16x16x32_bf16 v[132:135], a[136:139], a[32:35], v[132:135]
s_cselect_b32 s49, s49, 3221225472
ds_read_b128 a[96:99], v2 offset:40960
v_mfma_f32_16x16x32_bf16 v[132:135], a[140:143], a[36:39], v[132:135]
s_add_u32 s48, s53, 2097152
v_mfma_f32_16x16x32_bf16 v[140:143], a[136:139], a[40:43], v[140:143]
v_mfma_f32_16x16x32_bf16 v[140:143], a[140:143], a[44:47], v[140:143]
v_mfma_f32_16x16x32_bf16 v[148:151], a[136:139], a[48:51], v[148:151]
ds_read_b128 a[100:103], v3 offset:40960
v_mfma_f32_16x16x32_bf16 v[148:151], a[140:143], a[52:55], v[148:151]
v_mfma_f32_16x16x32_bf16 v[156:159], a[136:139], a[56:59], v[156:159]
ds_read_b128 a[104:107], v2 offset:43008
v_mfma_f32_16x16x32_bf16 v[156:159], a[140:143], a[60:63], v[156:159]
s_waitcnt lgkmcnt(3)
v_mfma_f32_16x16x32_bf16 v[160:163], a[128:131], a[0:3], v[160:163]
ds_read_b64_tr_b16 a[136:137], v9 offset:0
v_mfma_f32_16x16x32_bf16 v[160:163], a[132:135], a[4:7], v[160:163]
v_mfma_f32_16x16x32_bf16 v[168:171], a[128:131], a[8:11], v[168:171]
ds_read_b64_tr_b16 a[138:139], v9 offset:2048
v_mfma_f32_16x16x32_bf16 v[168:171], a[132:135], a[12:15], v[168:171]
buffer_store_dwordx4 a[180:183], v224, s[4:7], s56 offen sc1
v_mfma_f32_16x16x32_bf16 v[176:179], a[128:131], a[16:19], v[176:179]
s_add_u32 s56, s56, 33792
ds_read_b64_tr_b16 a[140:141], v9 offset:16384
v_mfma_f32_16x16x32_bf16 v[176:179], a[132:135], a[20:23], v[176:179]
v_mfma_f32_16x16x32_bf16 v[184:187], a[128:131], a[24:27], v[184:187]
ds_read_b64_tr_b16 a[142:143], v9 offset:18432
v_mfma_f32_16x16x32_bf16 v[184:187], a[132:135], a[28:31], v[184:187]
v_mfma_f32_16x16x32_bf16 v[192:195], a[128:131], a[32:35], v[192:195]
v_mfma_f32_16x16x32_bf16 v[192:195], a[132:135], a[36:39], v[192:195]
v_mfma_f32_16x16x32_bf16 v[200:203], a[128:131], a[40:43], v[200:203]
ds_read_b128 a[108:111], v3 offset:43008
v_mfma_f32_16x16x32_bf16 v[200:203], a[132:135], a[44:47], v[200:203]
v_mfma_f32_16x16x32_bf16 v[208:211], a[128:131], a[48:51], v[208:211]
ds_read_b128 a[112:115], v2 offset:45056
v_mfma_f32_16x16x32_bf16 v[208:211], a[132:135], a[52:55], v[208:211]
v_mfma_f32_16x16x32_bf16 v[216:219], a[128:131], a[56:59], v[216:219]
v_mfma_f32_16x16x32_bf16 v[216:219], a[132:135], a[60:63], v[216:219]
s_waitcnt lgkmcnt(2)
v_mfma_f32_16x16x32_bf16 v[164:167], a[136:139], a[0:3], v[164:167]
ds_read_b64_tr_b16 a[128:129], v10 offset:0
v_mfma_f32_16x16x32_bf16 v[164:167], a[140:143], a[4:7], v[164:167]
v_mfma_f32_16x16x32_bf16 v[172:175], a[136:139], a[8:11], v[172:175]
ds_read_b64_tr_b16 a[130:131], v10 offset:2048
v_mfma_f32_16x16x32_bf16 v[172:175], a[140:143], a[12:15], v[172:175]
v_mfma_f32_16x16x32_bf16 v[180:183], a[136:139], a[16:19], v[180:183]
ds_read_b64_tr_b16 a[132:133], v10 offset:16384
v_mfma_f32_16x16x32_bf16 v[180:183], a[140:143], a[20:23], v[180:183]
buffer_store_dwordx4 a[184:187], v224, s[4:7], s56 offen sc1
v_mfma_f32_16x16x32_bf16 v[188:191], a[136:139], a[24:27], v[188:191]
s_add_u32 s56, s56, 33792
ds_read_b64_tr_b16 a[134:135], v10 offset:18432
v_mfma_f32_16x16x32_bf16 v[188:191], a[140:143], a[28:31], v[188:191]
v_mfma_f32_16x16x32_bf16 v[196:199], a[136:139], a[32:35], v[196:199]
ds_read_b128 a[116:119], v3 offset:45056
v_mfma_f32_16x16x32_bf16 v[196:199], a[140:143], a[36:39], v[196:199]
v_mfma_f32_16x16x32_bf16 v[204:207], a[136:139], a[40:43], v[204:207]
ds_read_b128 a[120:123], v2 offset:47104
v_mfma_f32_16x16x32_bf16 v[204:207], a[140:143], a[44:47], v[204:207]
v_mfma_f32_16x16x32_bf16 v[212:215], a[136:139], a[48:51], v[212:215]
v_mfma_f32_16x16x32_bf16 v[212:215], a[140:143], a[52:55], v[212:215]
v_mfma_f32_16x16x32_bf16 v[220:223], a[136:139], a[56:59], v[220:223]
ds_read_b128 a[124:127], v3 offset:47104
v_mfma_f32_16x16x32_bf16 v[220:223], a[140:143], a[60:63], v[220:223]
s_waitcnt lgkmcnt(3)
v_mfma_f32_16x16x32_bf16 a[192:195], a[128:131], a[0:3], a[192:195]
ds_read_b64_tr_b16 a[136:137], v11 offset:0
v_mfma_f32_16x16x32_bf16 a[192:195], a[132:135], a[4:7], a[192:195]
v_mfma_f32_16x16x32_bf16 a[200:203], a[128:131], a[8:11], a[200:203]
ds_read_b64_tr_b16 a[138:139], v11 offset:2048
v_mfma_f32_16x16x32_bf16 a[200:203], a[132:135], a[12:15], a[200:203]
v_mfma_f32_16x16x32_bf16 a[208:211], a[128:131], a[16:19], a[208:211]
ds_read_b64_tr_b16 a[140:141], v11 offset:16384
v_mfma_f32_16x16x32_bf16 a[208:211], a[132:135], a[20:23], a[208:211]
v_mfma_f32_16x16x32_bf16 a[216:219], a[128:131], a[24:27], a[216:219]
ds_read_b64_tr_b16 a[142:143], v11 offset:18432
v_mfma_f32_16x16x32_bf16 a[216:219], a[132:135], a[28:31], a[216:219]
buffer_store_dwordx4 a[188:191], v224, s[4:7], s56 offen sc1
v_mfma_f32_16x16x32_bf16 a[224:227], a[128:131], a[32:35], a[224:227]
s_add_u32 s56, s56, 33792
v_mfma_f32_16x16x32_bf16 a[224:227], a[132:135], a[36:39], a[224:227]
v_mfma_f32_16x16x32_bf16 a[232:235], a[128:131], a[40:43], a[232:235]
v_mfma_f32_16x16x32_bf16 a[232:235], a[132:135], a[44:47], a[232:235]
v_mfma_f32_16x16x32_bf16 a[240:243], a[128:131], a[48:51], a[240:243]
v_mfma_f32_16x16x32_bf16 a[240:243], a[132:135], a[52:55], a[240:243]
v_mfma_f32_16x16x32_bf16 a[248:251], a[128:131], a[56:59], a[248:251]
s_waitcnt vmcnt(4) lgkmcnt(0)
v_mfma_f32_16x16x32_bf16 a[248:251], a[132:135], a[60:63], a[248:251]
s_barrier
v_mfma_f32_16x16x32_bf16 a[196:199], a[136:139], a[0:3], a[196:199]
s_add_u32 m0, s29, 65536
ds_read_b64_tr_b16 a[128:129], v4 offset:32768
v_mfma_f32_16x16x32_bf16 a[196:199], a[140:143], a[4:7], a[196:199]
buffer_load_dwordx4 v16, s[12:15], s26 offen offset:0 lds
v_mfma_f32_16x16x32_bf16 a[204:207], a[136:139], a[8:11], a[204:207]
ds_read_b64_tr_b16 a[130:131], v4 offset:34816
v_cmp_gt_u32 vcc, 0x100, v245
v_mfma_f32_16x16x32_bf16 a[204:207], a[140:143], a[12:15], a[204:207]
v_mfma_f32_16x16x32_bf16 a[212:215], a[136:139], a[16:19], a[212:215]
ds_read_b64_tr_b16 a[132:133], v4 offset:49152
v_mfma_f32_16x16x32_bf16 a[212:215], a[140:143], a[20:23], a[212:215]
buffer_load_dwordx4 v17, s[12:15], s26 offen offset:1024 lds
v_mfma_f32_16x16x32_bf16 a[220:223], a[136:139], a[24:27], a[220:223]
ds_read_b64_tr_b16 a[134:135], v4 offset:51200
v_mfma_f32_16x16x32_bf16 a[220:223], a[140:143], a[28:31], a[220:223]
v_mfma_f32_16x16x32_bf16 a[228:231], a[136:139], a[32:35], a[228:231]
v_mfma_f32_16x16x32_bf16 a[228:231], a[140:143], a[36:39], a[228:231]
buffer_load_dwordx4 v18, s[12:15], s26 offen offset:2048 lds
v_mfma_f32_16x16x32_bf16 a[236:239], a[136:139], a[40:43], a[236:239]
v_mfma_f32_16x16x32_bf16 a[236:239], a[140:143], a[44:47], a[236:239]
v_mfma_f32_16x16x32_bf16 a[244:247], a[136:139], a[48:51], a[244:247]
v_mfma_f32_16x16x32_bf16 a[244:247], a[140:143], a[52:55], a[244:247]
buffer_load_dwordx4 v19, s[12:15], s26 offen offset:3072 lds
v_mfma_f32_16x16x32_bf16 a[252:255], a[136:139], a[56:59], a[252:255]
s_add_u32 s26, s26, 524288
v_mfma_f32_16x16x32_bf16 a[252:255], a[140:143], a[60:63], a[252:255]
s_waitcnt lgkmcnt(0)
s_mov_b32 s82, s59
s_cbranch_vccnz M_cntspinK
s_branch Lg_1
Lg_1t:
PAD_4:
s_cbranch_execz M_tret
buffer_load_dword v230, v231, s[4:7], s52 offen sc1
v_mfma_f32_16x16x32_bf16 v[32:35], a[128:131], a[64:67], v[32:35]
s_add_u32 m0, s29, 81920
ds_read_b64_tr_b16 a[136:137], v5 offset:32768
v_mfma_f32_16x16x32_bf16 v[32:35], a[132:135], a[68:71], v[32:35]
buffer_load_dwordx4 v16, s[12:15], s27 offen offset:0 lds
v_mfma_f32_16x16x32_bf16 v[40:43], a[128:131], a[72:75], v[40:43]
s_and_b32 s44, s3, 1
ds_read_b64_tr_b16 a[138:139], v5 offset:34816
v_mfma_f32_16x16x32_bf16 v[40:43], a[132:135], a[76:79], v[40:43]
s_lshl_b32 s44, s44, 8
v_mfma_f32_16x16x32_bf16 v[48:51], a[128:131], a[80:83], v[48:51]
s_lshl_b32 s45, s3, 7
ds_read_b64_tr_b16 a[140:141], v5 offset:49152
v_mfma_f32_16x16x32_bf16 v[48:51], a[132:135], a[84:87], v[48:51]
s_xor_b32 s44, s44, s45
buffer_load_dwordx4 v17, s[12:15], s27 offen offset:1024 lds
v_mfma_f32_16x16x32_bf16 v[56:59], a[128:131], a[88:91], v[56:59]
s_xor_b32 s44, s44, 196608
ds_read_b64_tr_b16 a[142:143], v5 offset:51200
v_mfma_f32_16x16x32_bf16 v[56:59], a[132:135], a[92:95], v[56:59]
v_mfma_f32_16x16x32_bf16 v[64:67], a[128:131], a[96:99], v[64:67]
ds_read_b128 a[0:3], v2 offset:0
v_mfma_f32_16x16x32_bf16 v[64:67], a[132:135], a[100:103], v[64:67]
buffer_load_dwordx4 v18, s[12:15], s27 offen offset:2048 lds
v_mfma_f32_16x16x32_bf16 v[72:75], a[128:131], a[104:107], v[72:75]
ds_read_b128 a[4:7], v3 offset:0
v_mfma_f32_16x16x32_bf16 v[72:75], a[132:135], a[108:111], v[72:75]
v_mfma_f32_16x16x32_bf16 v[80:83], a[128:131], a[112:115], v[80:83]
v_mfma_f32_16x16x32_bf16 v[80:83], a[132:135], a[116:119], v[80:83]
buffer_load_dwordx4 v19, s[12:15], s27 offen offset:3072 lds
v_mfma_f32_16x16x32_bf16 v[88:91], a[128:131], a[120:123], v[88:91]
s_add_u32 s27, s27, 524288
ds_read_b128 a[8:11], v2 offset:2048
v_mfma_f32_16x16x32_bf16 v[88:91], a[132:135], a[124:127], v[88:91]
s_waitcnt lgkmcnt(3)
v_mfma_f32_16x16x32_bf16 v[36:39], a[136:139], a[64:67], v[36:39]
s_add_u32 m0, s28, 32768
ds_read_b64_tr_b16 a[128:129], v6 offset:32768
v_mfma_f32_16x16x32_bf16 v[36:39], a[140:143], a[68:71], v[36:39]
buffer_load_dwordx4 v12, s[8:11], s24 offen offset:0 lds
v_mfma_f32_16x16x32_bf16 v[44:47], a[136:139], a[72:75], v[44:47]
ds_read_b64_tr_b16 a[130:131], v6 offset:34816
v_mfma_f32_16x16x32_bf16 v[44:47], a[140:143], a[76:79], v[44:47]
v_mfma_f32_16x16x32_bf16 v[52:55], a[136:139], a[80:83], v[52:55]
s_mov_b64 s[56:57], s[72:73]
ds_read_b64_tr_b16 a[132:133], v6 offset:49152
v_mfma_f32_16x16x32_bf16 v[52:55], a[140:143], a[84:87], v[52:55]
s_mov_b32 s58, 1835008
buffer_load_dwordx4 v13, s[8:11], s24 offen offset:1024 lds
v_mfma_f32_16x16x32_bf16 v[60:63], a[136:139], a[88:91], v[60:63]
s_mov_b32 s59, 0x20000
ds_read_b64_tr_b16 a[134:135], v6 offset:51200
v_mfma_f32_16x16x32_bf16 v[60:63], a[140:143], a[92:95], v[60:63]
v_mfma_f32_16x16x32_bf16 v[68:71], a[136:139], a[96:99], v[68:71]
ds_read_b128 a[12:15], v3 offset:2048
v_mfma_f32_16x16x32_bf16 v[68:71], a[140:143], a[100:103], v[68:71]
buffer_load_dwordx4 v14, s[8:11], s24 offen offset:2048 lds
v_mfma_f32_16x16x32_bf16 v[76:79], a[136:139], a[104:107], v[76:79]
v_mfma_f32_16x16x32_bf16 v[76:79], a[140:143], a[108:111], v[76:79]
v_mfma_f32_16x16x32_bf16 v[84:87], a[136:139], a[112:115], v[84:87]
ds_read_b128 a[16:19], v2 offset:4096
v_mfma_f32_16x16x32_bf16 v[84:87], a[140:143], a[116:119], v[84:87]
buffer_load_dwordx4 v15, s[8:11], s24 offen offset:3072 lds
v_mfma_f32_16x16x32_bf16 v[92:95], a[136:139], a[120:123], v[92:95]
s_add_u32 s24, s24, 128
ds_read_b128 a[20:23], v3 offset:4096
v_mfma_f32_16x16x32_bf16 v[92:95], a[140:143], a[124:127], v[92:95]
s_waitcnt lgkmcnt(3)
v_mfma_f32_16x16x32_bf16 v[96:99], a[128:131], a[64:67], v[96:99]
s_add_u32 m0, s28, 36864
ds_read_b64_tr_b16 a[136:137], v7 offset:32768
v_mfma_f32_16x16x32_bf16 v[96:99], a[132:135], a[68:71], v[96:99]
buffer_load_dwordx4 v12, s[8:11], s25 offen offset:0 lds
v_mfma_f32_16x16x32_bf16 v[104:107], a[128:131], a[72:75], v[104:107]
ds_read_b64_tr_b16 a[138:139], v7 offset:34816
v_mfma_f32_16x16x32_bf16 v[104:107], a[132:135], a[76:79], v[104:107]
v_mfma_f32_16x16x32_bf16 v[112:115], a[128:131], a[80:83], v[112:115]
ds_read_b64_tr_b16 a[140:141], v7 offset:49152
v_mfma_f32_16x16x32_bf16 v[112:115], a[132:135], a[84:87], v[112:115]
buffer_load_dwordx4 v13, s[8:11], s25 offen offset:1024 lds
v_mfma_f32_16x16x32_bf16 v[120:123], a[128:131], a[88:91], v[120:123]
ds_read_b64_tr_b16 a[142:143], v7 offset:51200
v_mfma_f32_16x16x32_bf16 v[120:123], a[132:135], a[92:95], v[120:123]
v_mfma_f32_16x16x32_bf16 v[128:131], a[128:131], a[96:99], v[128:131]
v_mfma_f32_16x16x32_bf16 v[128:131], a[132:135], a[100:103], v[128:131]
buffer_load_dwordx4 v14, s[8:11], s25 offen offset:2048 lds
v_mfma_f32_16x16x32_bf16 v[136:139], a[128:131], a[104:107], v[136:139]
ds_read_b128 a[24:27], v2 offset:6144
v_mfma_f32_16x16x32_bf16 v[136:139], a[132:135], a[108:111], v[136:139]
v_mfma_f32_16x16x32_bf16 v[144:147], a[128:131], a[112:115], v[144:147]
ds_read_b128 a[28:31], v3 offset:6144
v_mfma_f32_16x16x32_bf16 v[144:147], a[132:135], a[116:119], v[144:147]
buffer_load_dwordx4 v15, s[8:11], s25 offen offset:3072 lds
v_mfma_f32_16x16x32_bf16 v[152:155], a[128:131], a[120:123], v[152:155]
s_add_u32 s25, s25, 128
s_waitcnt vmcnt(12)
v_mfma_f32_16x16x32_bf16 v[152:155], a[132:135], a[124:127], v[152:155]
s_waitcnt lgkmcnt(2)
v_cmp_gt_u32 vcc, 1, v230
v_mfma_f32_16x16x32_bf16 v[100:103], a[136:139], a[64:67], v[100:103]
s_cbranch_vccnz M_ppspinK
M_ppokK:
ds_read_b64_tr_b16 a[128:129], v8 offset:32768
v_mfma_f32_16x16x32_bf16 v[100:103], a[140:143], a[68:71], v[100:103]
buffer_load_dword v230, v229, s[4:7], s53 offen sc1
v_mfma_f32_16x16x32_bf16 v[108:111], a[136:139], a[72:75], v[108:111]
s_mov_b64 s[8:9], s[76:77]
ds_read_b64_tr_b16 a[130:131], v8 offset:34816
v_mfma_f32_16x16x32_bf16 v[108:111], a[140:143], a[76:79], v[108:111]
s_mov_b32 s10, 1835008
buffer_load_dword v230, v229, s[4:7], s48 offen sc1
v_mfma_f32_16x16x32_bf16 v[116:119], a[136:139], a[80:83], v[116:119]
s_lshl_b32 s24, s37, 2
ds_read_b64_tr_b16 a[132:133], v8 offset:49152
v_mfma_f32_16x16x32_bf16 v[116:119], a[140:143], a[84:87], v[116:119]
s_add_u32 s24, s24, s3
buffer_load_dword v230, v229, s[56:59], s49 offen
v_mfma_f32_16x16x32_bf16 v[124:127], a[136:139], a[88:91], v[124:127]
s_mul_i32 s24, s24, 28672
ds_read_b64_tr_b16 a[134:135], v8 offset:51200
v_mfma_f32_16x16x32_bf16 v[124:127], a[140:143], a[92:95], v[124:127]
s_mov_b32 s28, s29
buffer_load_dword v21, v20, s[16:19], s43 offen
v_mfma_f32_16x16x32_bf16 v[132:135], a[136:139], a[96:99], v[132:135]
ds_read_b128 a[32:35], v2 offset:8192
v_mfma_f32_16x16x32_bf16 v[132:135], a[140:143], a[100:103], v[132:135]
v_mfma_f32_16x16x32_bf16 v[140:143], a[136:139], a[104:107], v[140:143]
v_mfma_f32_16x16x32_bf16 v[140:143], a[140:143], a[108:111], v[140:143]
v_mfma_f32_16x16x32_bf16 v[148:151], a[136:139], a[112:115], v[148:151]
ds_read_b128 a[36:39], v3 offset:8192
v_lshrrev_b32 v28, 7, v1
v_mfma_f32_16x16x32_bf16 v[148:151], a[140:143], a[116:119], v[148:151]
v_lshrrev_b32 v29, 1, v28
v_lshlrev_b32 v29, 4, v29
v_mfma_f32_16x16x32_bf16 v[156:159], a[136:139], a[120:123], v[156:159]
ds_read_b128 a[40:43], v2 offset:10240
v_and_b32 v30, 0x70, v1
v_mfma_f32_16x16x32_bf16 v[156:159], a[140:143], a[124:127], v[156:159]
s_waitcnt lgkmcnt(3)
v_xor_b32 v29, v29, v30
v_mul_u32_u24 v28, 896, v28
v_mfma_f32_16x16x32_bf16 v[160:163], a[128:131], a[64:67], v[160:163]
ds_read_b64_tr_b16 a[136:137], v9 offset:32768
v_add_u32 v12, v28, v29
v_mfma_f32_16x16x32_bf16 v[160:163], a[132:135], a[68:71], v[160:163]
v_xor_b32 v29, 64, v29
v_add_u32 v28, v28, v29
v_mfma_f32_16x16x32_bf16 v[168:171], a[128:131], a[72:75], v[168:171]
ds_read_b64_tr_b16 a[138:139], v9 offset:34816
v_add_u32 v13, 6144, v28
v_mfma_f32_16x16x32_bf16 v[168:171], a[132:135], a[76:79], v[168:171]
v_add_u32 v14, 12288, v12
v_add_u32 v15, 18432, v28
v_mfma_f32_16x16x32_bf16 v[176:179], a[128:131], a[80:83], v[176:179]
ds_read_b64_tr_b16 a[140:141], v9 offset:49152
v_xor_b32 v22, s44, v4
v_mfma_f32_16x16x32_bf16 v[176:179], a[132:135], a[84:87], v[176:179]
v_xor_b32 v23, 32, v22
v_xor_b32 v24, 64, v22
v_mfma_f32_16x16x32_bf16 v[184:187], a[128:131], a[88:91], v[184:187]
ds_read_b64_tr_b16 a[142:143], v9 offset:51200
v_xor_b32 v25, 96, v22
v_mfma_f32_16x16x32_bf16 v[184:187], a[132:135], a[92:95], v[184:187]
v_mfma_f32_16x16x32_bf16 v[192:195], a[128:131], a[96:99], v[192:195]
v_mfma_f32_16x16x32_bf16 v[192:195], a[132:135], a[100:103], v[192:195]
v_mfma_f32_16x16x32_bf16 v[200:203], a[128:131], a[104:107], v[200:203]
ds_read_b128 a[44:47], v3 offset:10240
v_mfma_f32_16x16x32_bf16 v[200:203], a[132:135], a[108:111], v[200:203]
v_mfma_f32_16x16x32_bf16 v[208:211], a[128:131], a[112:115], v[208:211]
ds_read_b128 a[48:51], v2 offset:12288
v_mfma_f32_16x16x32_bf16 v[208:211], a[132:135], a[116:119], v[208:211]
v_mfma_f32_16x16x32_bf16 v[216:219], a[128:131], a[120:123], v[216:219]
v_mfma_f32_16x16x32_bf16 v[216:219], a[132:135], a[124:127], v[216:219]
s_waitcnt lgkmcnt(2)
v_mfma_f32_16x16x32_bf16 v[164:167], a[136:139], a[64:67], v[164:167]
ds_read_b64_tr_b16 a[128:129], v10 offset:32768
v_mfma_f32_16x16x32_bf16 v[164:167], a[140:143], a[68:71], v[164:167]
v_mfma_f32_16x16x32_bf16 v[172:175], a[136:139], a[72:75], v[172:175]
ds_read_b64_tr_b16 a[130:131], v10 offset:34816
v_mfma_f32_16x16x32_bf16 v[172:175], a[140:143], a[76:79], v[172:175]
v_mfma_f32_16x16x32_bf16 v[180:183], a[136:139], a[80:83], v[180:183]
ds_read_b64_tr_b16 a[132:133], v10 offset:49152
v_mfma_f32_16x16x32_bf16 v[180:183], a[140:143], a[84:87], v[180:183]
v_mfma_f32_16x16x32_bf16 v[188:191], a[136:139], a[88:91], v[188:191]
ds_read_b64_tr_b16 a[134:135], v10 offset:51200
v_mfma_f32_16x16x32_bf16 v[188:191], a[140:143], a[92:95], v[188:191]
v_mfma_f32_16x16x32_bf16 v[196:199], a[136:139], a[96:99], v[196:199]
ds_read_b128 a[52:55], v3 offset:12288
v_mfma_f32_16x16x32_bf16 v[196:199], a[140:143], a[100:103], v[196:199]
v_mfma_f32_16x16x32_bf16 v[204:207], a[136:139], a[104:107], v[204:207]
ds_read_b128 a[56:59], v2 offset:14336
v_mfma_f32_16x16x32_bf16 v[204:207], a[140:143], a[108:111], v[204:207]
v_mfma_f32_16x16x32_bf16 v[212:215], a[136:139], a[112:115], v[212:215]
v_mfma_f32_16x16x32_bf16 v[212:215], a[140:143], a[116:119], v[212:215]
v_mfma_f32_16x16x32_bf16 v[220:223], a[136:139], a[120:123], v[220:223]
ds_read_b128 a[60:63], v3 offset:14336
v_mfma_f32_16x16x32_bf16 v[220:223], a[140:143], a[124:127], v[220:223]
s_waitcnt lgkmcnt(3)
v_mfma_f32_16x16x32_bf16 a[192:195], a[128:131], a[64:67], a[192:195]
ds_read_b64_tr_b16 a[136:137], v11 offset:32768
v_mfma_f32_16x16x32_bf16 a[192:195], a[132:135], a[68:71], a[192:195]
v_mfma_f32_16x16x32_bf16 a[200:203], a[128:131], a[72:75], a[200:203]
ds_read_b64_tr_b16 a[138:139], v11 offset:34816
v_mfma_f32_16x16x32_bf16 a[200:203], a[132:135], a[76:79], a[200:203]
v_mfma_f32_16x16x32_bf16 a[208:211], a[128:131], a[80:83], a[208:211]
ds_read_b64_tr_b16 a[140:141], v11 offset:49152
v_mfma_f32_16x16x32_bf16 a[208:211], a[132:135], a[84:87], a[208:211]
v_mfma_f32_16x16x32_bf16 a[216:219], a[128:131], a[88:91], a[216:219]
ds_read_b64_tr_b16 a[142:143], v11 offset:51200
v_mfma_f32_16x16x32_bf16 a[216:219], a[132:135], a[92:95], a[216:219]
v_mfma_f32_16x16x32_bf16 a[224:227], a[128:131], a[96:99], a[224:227]
v_mfma_f32_16x16x32_bf16 a[224:227], a[132:135], a[100:103], a[224:227]
v_mfma_f32_16x16x32_bf16 a[232:235], a[128:131], a[104:107], a[232:235]
v_mfma_f32_16x16x32_bf16 a[232:235], a[132:135], a[108:111], a[232:235]
v_mfma_f32_16x16x32_bf16 a[240:243], a[128:131], a[112:115], a[240:243]
v_mfma_f32_16x16x32_bf16 a[240:243], a[132:135], a[116:119], a[240:243]
v_mfma_f32_16x16x32_bf16 a[248:251], a[128:131], a[120:123], a[248:251]
s_waitcnt vmcnt(4) lgkmcnt(0)
v_mfma_f32_16x16x32_bf16 a[248:251], a[132:135], a[124:127], a[248:251]
s_barrier
v_mfma_f32_16x16x32_bf16 a[196:199], a[136:139], a[64:67], a[196:199]
s_add_u32 m0, s29, 98304
ds_read_b64_tr_b16 a[128:129], v4 offset:0
v_mfma_f32_16x16x32_bf16 a[196:199], a[140:143], a[68:71], a[196:199]
buffer_load_dwordx4 v16, s[12:15], s26 offen offset:0 lds
v_mfma_f32_16x16x32_bf16 a[204:207], a[136:139], a[72:75], a[204:207]
ds_read_b64_tr_b16 a[130:131], v4 offset:2048
v_mfma_f32_16x16x32_bf16 a[204:207], a[140:143], a[76:79], a[204:207]
v_mfma_f32_16x16x32_bf16 a[212:215], a[136:139], a[80:83], a[212:215]
ds_read_b64_tr_b16 a[132:133], v4 offset:16384
v_mfma_f32_16x16x32_bf16 a[212:215], a[140:143], a[84:87], a[212:215]
buffer_load_dwordx4 v17, s[12:15], s26 offen offset:1024 lds
v_mfma_f32_16x16x32_bf16 a[220:223], a[136:139], a[88:91], a[220:223]
ds_read_b64_tr_b16 a[134:135], v4 offset:18432
v_mfma_f32_16x16x32_bf16 a[220:223], a[140:143], a[92:95], a[220:223]
v_mfma_f32_16x16x32_bf16 a[228:231], a[136:139], a[96:99], a[228:231]
v_mfma_f32_16x16x32_bf16 a[228:231], a[140:143], a[100:103], a[228:231]
buffer_load_dwordx4 v18, s[12:15], s26 offen offset:2048 lds
v_mfma_f32_16x16x32_bf16 a[236:239], a[136:139], a[104:107], a[236:239]
v_mfma_f32_16x16x32_bf16 a[236:239], a[140:143], a[108:111], a[236:239]
v_mfma_f32_16x16x32_bf16 a[244:247], a[136:139], a[112:115], a[244:247]
v_mfma_f32_16x16x32_bf16 a[244:247], a[140:143], a[116:119], a[244:247]
buffer_load_dwordx4 v19, s[12:15], s26 offen offset:3072 lds
v_mfma_f32_16x16x32_bf16 a[252:255], a[136:139], a[120:123], a[252:255]
s_add_u32 s26, s26, 524288
v_mfma_f32_16x16x32_bf16 a[252:255], a[140:143], a[124:127], a[252:255]
s_waitcnt lgkmcnt(0)
v_mfma_f32_16x16x32_bf16 v[32:35], a[128:131], a[0:3], v[32:35]
s_add_u32 m0, s29, 114688
ds_read_b64_tr_b16 a[136:137], v5 offset:0
v_mfma_f32_16x16x32_bf16 v[32:35], a[132:135], a[4:7], v[32:35]
buffer_load_dwordx4 v16, s[12:15], s27 offen offset:0 lds
v_mfma_f32_16x16x32_bf16 v[40:43], a[128:131], a[8:11], v[40:43]
ds_read_b64_tr_b16 a[138:139], v5 offset:2048
v_mfma_f32_16x16x32_bf16 v[40:43], a[132:135], a[12:15], v[40:43]
v_mfma_f32_16x16x32_bf16 v[48:51], a[128:131], a[16:19], v[48:51]
ds_read_b64_tr_b16 a[140:141], v5 offset:16384
v_mfma_f32_16x16x32_bf16 v[48:51], a[132:135], a[20:23], v[48:51]
buffer_load_dwordx4 v17, s[12:15], s27 offen offset:1024 lds
v_mfma_f32_16x16x32_bf16 v[56:59], a[128:131], a[24:27], v[56:59]
ds_read_b64_tr_b16 a[142:143], v5 offset:18432
v_mfma_f32_16x16x32_bf16 v[56:59], a[132:135], a[28:31], v[56:59]
v_mfma_f32_16x16x32_bf16 v[64:67], a[128:131], a[32:35], v[64:67]
ds_read_b128 a[64:67], v2 offset:32768
v_mfma_f32_16x16x32_bf16 v[64:67], a[132:135], a[36:39], v[64:67]
buffer_load_dwordx4 v18, s[12:15], s27 offen offset:2048 lds
v_mfma_f32_16x16x32_bf16 v[72:75], a[128:131], a[40:43], v[72:75]
ds_read_b128 a[68:71], v3 offset:32768
v_mfma_f32_16x16x32_bf16 v[72:75], a[132:135], a[44:47], v[72:75]
v_mfma_f32_16x16x32_bf16 v[80:83], a[128:131], a[48:51], v[80:83]
v_mfma_f32_16x16x32_bf16 v[80:83], a[132:135], a[52:55], v[80:83]
buffer_load_dwordx4 v19, s[12:15], s27 offen offset:3072 lds
v_mfma_f32_16x16x32_bf16 v[88:91], a[128:131], a[56:59], v[88:91]
s_add_u32 s27, s27, 524288
ds_read_b128 a[72:75], v2 offset:34816
v_mfma_f32_16x16x32_bf16 v[88:91], a[132:135], a[60:63], v[88:91]
s_waitcnt lgkmcnt(3)
v_mfma_f32_16x16x32_bf16 v[36:39], a[136:139], a[0:3], v[36:39]
s_add_u32 m0, s28, 0
ds_read_b64_tr_b16 a[128:129], v6 offset:0
v_mfma_f32_16x16x32_bf16 v[36:39], a[140:143], a[4:7], v[36:39]
buffer_load_dwordx4 v12, s[8:11], s24 offen offset:0 lds
v_mfma_f32_16x16x32_bf16 v[44:47], a[136:139], a[8:11], v[44:47]
ds_read_b64_tr_b16 a[130:131], v6 offset:2048
v_mfma_f32_16x16x32_bf16 v[44:47], a[140:143], a[12:15], v[44:47]
v_mfma_f32_16x16x32_bf16 v[52:55], a[136:139], a[16:19], v[52:55]
ds_read_b64_tr_b16 a[132:133], v6 offset:16384
v_mfma_f32_16x16x32_bf16 v[52:55], a[140:143], a[20:23], v[52:55]
buffer_load_dwordx4 v13, s[8:11], s24 offen offset:1024 lds
v_mfma_f32_16x16x32_bf16 v[60:63], a[136:139], a[24:27], v[60:63]
ds_read_b64_tr_b16 a[134:135], v6 offset:18432
v_mfma_f32_16x16x32_bf16 v[60:63], a[140:143], a[28:31], v[60:63]
v_mfma_f32_16x16x32_bf16 v[68:71], a[136:139], a[32:35], v[68:71]
ds_read_b128 a[76:79], v3 offset:34816
v_mfma_f32_16x16x32_bf16 v[68:71], a[140:143], a[36:39], v[68:71]
buffer_load_dwordx4 v14, s[8:11], s24 offen offset:2048 lds
v_mfma_f32_16x16x32_bf16 v[76:79], a[136:139], a[40:43], v[76:79]
v_mfma_f32_16x16x32_bf16 v[76:79], a[140:143], a[44:47], v[76:79]
v_mfma_f32_16x16x32_bf16 v[84:87], a[136:139], a[48:51], v[84:87]
ds_read_b128 a[80:83], v2 offset:36864
v_mfma_f32_16x16x32_bf16 v[84:87], a[140:143], a[52:55], v[84:87]
buffer_load_dwordx4 v15, s[8:11], s24 offen offset:3072 lds
v_mfma_f32_16x16x32_bf16 v[92:95], a[136:139], a[56:59], v[92:95]
s_add_u32 s24, s24, 128
ds_read_b128 a[84:87], v3 offset:36864
v_mfma_f32_16x16x32_bf16 v[92:95], a[140:143], a[60:63], v[92:95]
s_waitcnt lgkmcnt(3)
s_mov_b64 s[12:13], s[80:81]
v_mfma_f32_16x16x32_bf16 v[96:99], a[128:131], a[0:3], v[96:99]
s_mov_b32 s14, 3670016
s_add_u32 m0, s28, 16384
ds_read_b64_tr_b16 a[136:137], v7 offset:0
v_mfma_f32_16x16x32_bf16 v[96:99], a[132:135], a[4:7], v[96:99]
buffer_load_dwordx4 v12, s[8:11], s24 offen offset:0 lds
v_mfma_f32_16x16x32_bf16 v[104:107], a[128:131], a[8:11], v[104:107]
ds_read_b64_tr_b16 a[138:139], v7 offset:2048
v_mfma_f32_16x16x32_bf16 v[104:107], a[132:135], a[12:15], v[104:107]
v_mfma_f32_16x16x32_bf16 v[112:115], a[128:131], a[16:19], v[112:115]
ds_read_b64_tr_b16 a[140:141], v7 offset:16384
v_mfma_f32_16x16x32_bf16 v[112:115], a[132:135], a[20:23], v[112:115]
buffer_load_dwordx4 v13, s[8:11], s24 offen offset:1024 lds
v_mfma_f32_16x16x32_bf16 v[120:123], a[128:131], a[24:27], v[120:123]
ds_read_b64_tr_b16 a[142:143], v7 offset:18432
v_mfma_f32_16x16x32_bf16 v[120:123], a[132:135], a[28:31], v[120:123]
v_mfma_f32_16x16x32_bf16 v[128:131], a[128:131], a[32:35], v[128:131]
v_mfma_f32_16x16x32_bf16 v[128:131], a[132:135], a[36:39], v[128:131]
buffer_load_dwordx4 v14, s[8:11], s24 offen offset:2048 lds
v_mfma_f32_16x16x32_bf16 v[136:139], a[128:131], a[40:43], v[136:139]
ds_read_b128 a[88:91], v2 offset:38912
v_mfma_f32_16x16x32_bf16 v[136:139], a[132:135], a[44:47], v[136:139]
v_mfma_f32_16x16x32_bf16 v[144:147], a[128:131], a[48:51], v[144:147]
ds_read_b128 a[92:95], v3 offset:38912
v_mfma_f32_16x16x32_bf16 v[144:147], a[132:135], a[52:55], v[144:147]
buffer_load_dwordx4 v15, s[8:11], s24 offen offset:3072 lds
v_mfma_f32_16x16x32_bf16 v[152:155], a[128:131], a[56:59], v[152:155]
s_add_u32 s24, s24, 128
v_mfma_f32_16x16x32_bf16 v[152:155], a[132:135], a[60:63], v[152:155]
s_waitcnt lgkmcnt(2)
s_sub_u32 s26, s26, 8388608
v_mfma_f32_16x16x32_bf16 v[100:103], a[136:139], a[0:3], v[100:103]
s_sub_u32 s27, s27, 8388608
s_add_u32 m0, s29, 131072
ds_read_b64_tr_b16 a[128:129], v8 offset:0
v_mfma_f32_16x16x32_bf16 v[100:103], a[140:143], a[4:7], v[100:103]
PAD_5:
s_cbranch_execz M_tret
buffer_load_dwordx4 v16, s[12:15], s26 offen offset:0 lds
v_mfma_f32_16x16x32_bf16 v[108:111], a[136:139], a[8:11], v[108:111]
ds_read_b64_tr_b16 a[130:131], v8 offset:2048
v_mfma_f32_16x16x32_bf16 v[108:111], a[140:143], a[12:15], v[108:111]
v_mfma_f32_16x16x32_bf16 v[116:119], a[136:139], a[16:19], v[116:119]
ds_read_b64_tr_b16 a[132:133], v8 offset:16384
v_mfma_f32_16x16x32_bf16 v[116:119], a[140:143], a[20:23], v[116:119]
buffer_load_dwordx4 v17, s[12:15], s26 offen offset:1024 lds
v_mfma_f32_16x16x32_bf16 v[124:127], a[136:139], a[24:27], v[124:127]
ds_read_b64_tr_b16 a[134:135], v8 offset:18432
v_mfma_f32_16x16x32_bf16 v[124:127], a[140:143], a[28:31], v[124:127]
v_mfma_f32_16x16x32_bf16 v[132:135], a[136:139], a[32:35], v[132:135]
ds_read_b128 a[96:99], v2 offset:40960
v_mfma_f32_16x16x32_bf16 v[132:135], a[140:143], a[36:39], v[132:135]
buffer_load_dwordx4 v18, s[12:15], s26 offen offset:2048 lds
v_mfma_f32_16x16x32_bf16 v[140:143], a[136:139], a[40:43], v[140:143]
v_mfma_f32_16x16x32_bf16 v[140:143], a[140:143], a[44:47], v[140:143]
v_mfma_f32_16x16x32_bf16 v[148:151], a[136:139], a[48:51], v[148:151]
ds_read_b128 a[100:103], v3 offset:40960
v_mfma_f32_16x16x32_bf16 v[148:151], a[140:143], a[52:55], v[148:151]
buffer_load_dwordx4 v19, s[12:15], s26 offen offset:3072 lds
v_mfma_f32_16x16x32_bf16 v[156:159], a[136:139], a[56:59], v[156:159]
s_add_u32 s26, s26, 524288
ds_read_b128 a[104:107], v2 offset:43008
v_mfma_f32_16x16x32_bf16 v[156:159], a[140:143], a[60:63], v[156:159]
s_waitcnt lgkmcnt(3)
v_mfma_f32_16x16x32_bf16 v[160:163], a[128:131], a[0:3], v[160:163]
s_add_u32 m0, s29, 147456
ds_read_b64_tr_b16 a[136:137], v9 offset:0
v_mfma_f32_16x16x32_bf16 v[160:163], a[132:135], a[4:7], v[160:163]
buffer_load_dwordx4 v16, s[12:15], s27 offen offset:0 lds
v_mfma_f32_16x16x32_bf16 v[168:171], a[128:131], a[8:11], v[168:171]
ds_read_b64_tr_b16 a[138:139], v9 offset:2048
v_mfma_f32_16x16x32_bf16 v[168:171], a[132:135], a[12:15], v[168:171]
v_mfma_f32_16x16x32_bf16 v[176:179], a[128:131], a[16:19], v[176:179]
ds_read_b64_tr_b16 a[140:141], v9 offset:16384
v_mfma_f32_16x16x32_bf16 v[176:179], a[132:135], a[20:23], v[176:179]
buffer_load_dwordx4 v17, s[12:15], s27 offen offset:1024 lds
v_mfma_f32_16x16x32_bf16 v[184:187], a[128:131], a[24:27], v[184:187]
ds_read_b64_tr_b16 a[142:143], v9 offset:18432
v_mfma_f32_16x16x32_bf16 v[184:187], a[132:135], a[28:31], v[184:187]
v_mfma_f32_16x16x32_bf16 v[192:195], a[128:131], a[32:35], v[192:195]
v_mfma_f32_16x16x32_bf16 v[192:195], a[132:135], a[36:39], v[192:195]
buffer_load_dwordx4 v18, s[12:15], s27 offen offset:2048 lds
v_mfma_f32_16x16x32_bf16 v[200:203], a[128:131], a[40:43], v[200:203]
ds_read_b128 a[108:111], v3 offset:43008
v_mfma_f32_16x16x32_bf16 v[200:203], a[132:135], a[44:47], v[200:203]
v_mfma_f32_16x16x32_bf16 v[208:211], a[128:131], a[48:51], v[208:211]
ds_read_b128 a[112:115], v2 offset:45056
v_mfma_f32_16x16x32_bf16 v[208:211], a[132:135], a[52:55], v[208:211]
buffer_load_dwordx4 v19, s[12:15], s27 offen offset:3072 lds
v_mfma_f32_16x16x32_bf16 v[216:219], a[128:131], a[56:59], v[216:219]
s_add_u32 s27, s27, 524288
v_mfma_f32_16x16x32_bf16 v[216:219], a[132:135], a[60:63], v[216:219]
s_waitcnt lgkmcnt(2)
v_mfma_f32_16x16x32_bf16 v[164:167], a[136:139], a[0:3], v[164:167]
ds_read_b64_tr_b16 a[128:129], v10 offset:0
v_mfma_f32_16x16x32_bf16 v[164:167], a[140:143], a[4:7], v[164:167]
v_mfma_f32_16x16x32_bf16 v[172:175], a[136:139], a[8:11], v[172:175]
ds_read_b64_tr_b16 a[130:131], v10 offset:2048
v_mfma_f32_16x16x32_bf16 v[172:175], a[140:143], a[12:15], v[172:175]
v_mfma_f32_16x16x32_bf16 v[180:183], a[136:139], a[16:19], v[180:183]
ds_read_b64_tr_b16 a[132:133], v10 offset:16384
v_mfma_f32_16x16x32_bf16 v[180:183], a[140:143], a[20:23], v[180:183]
v_mfma_f32_16x16x32_bf16 v[188:191], a[136:139], a[24:27], v[188:191]
ds_read_b64_tr_b16 a[134:135], v10 offset:18432
v_mfma_f32_16x16x32_bf16 v[188:191], a[140:143], a[28:31], v[188:191]
v_mfma_f32_16x16x32_bf16 v[196:199], a[136:139], a[32:35], v[196:199]
ds_read_b128 a[116:119], v3 offset:45056
v_mfma_f32_16x16x32_bf16 v[196:199], a[140:143], a[36:39], v[196:199]
v_mfma_f32_16x16x32_bf16 v[204:207], a[136:139], a[40:43], v[204:207]
ds_read_b128 a[120:123], v2 offset:47104
v_mfma_f32_16x16x32_bf16 v[204:207], a[140:143], a[44:47], v[204:207]
v_mfma_f32_16x16x32_bf16 v[212:215], a[136:139], a[48:51], v[212:215]
v_mfma_f32_16x16x32_bf16 v[212:215], a[140:143], a[52:55], v[212:215]
v_mfma_f32_16x16x32_bf16 v[220:223], a[136:139], a[56:59], v[220:223]
ds_read_b128 a[124:127], v3 offset:47104
v_mfma_f32_16x16x32_bf16 v[220:223], a[140:143], a[60:63], v[220:223]
s_waitcnt lgkmcnt(3)
v_mfma_f32_16x16x32_bf16 a[192:195], a[128:131], a[0:3], a[192:195]
ds_read_b64_tr_b16 a[136:137], v11 offset:0
v_mfma_f32_16x16x32_bf16 a[192:195], a[132:135], a[4:7], a[192:195]
v_mfma_f32_16x16x32_bf16 a[200:203], a[128:131], a[8:11], a[200:203]
ds_read_b64_tr_b16 a[138:139], v11 offset:2048
v_mfma_f32_16x16x32_bf16 a[200:203], a[132:135], a[12:15], a[200:203]
v_mfma_f32_16x16x32_bf16 a[208:211], a[128:131], a[16:19], a[208:211]
ds_read_b64_tr_b16 a[140:141], v11 offset:16384
v_mfma_f32_16x16x32_bf16 a[208:211], a[132:135], a[20:23], a[208:211]
v_mfma_f32_16x16x32_bf16 a[216:219], a[128:131], a[24:27], a[216:219]
ds_read_b64_tr_b16 a[142:143], v11 offset:18432
v_mfma_f32_16x16x32_bf16 a[216:219], a[132:135], a[28:31], a[216:219]
v_mfma_f32_16x16x32_bf16 a[224:227], a[128:131], a[32:35], a[224:227]
v_mfma_f32_16x16x32_bf16 a[224:227], a[132:135], a[36:39], a[224:227]
v_mfma_f32_16x16x32_bf16 a[232:235], a[128:131], a[40:43], a[232:235]
v_mfma_f32_16x16x32_bf16 a[232:235], a[132:135], a[44:47], a[232:235]
v_mfma_f32_16x16x32_bf16 a[240:243], a[128:131], a[48:51], a[240:243]
v_mfma_f32_16x16x32_bf16 a[240:243], a[132:135], a[52:55], a[240:243]
v_mfma_f32_16x16x32_bf16 a[248:251], a[128:131], a[56:59], a[248:251]
s_waitcnt vmcnt(12) lgkmcnt(0)
v_mfma_f32_16x16x32_bf16 a[248:251], a[132:135], a[60:63], a[248:251]
s_barrier
v_mfma_f32_16x16x32_bf16 a[196:199], a[136:139], a[0:3], a[196:199]
s_add_u32 m0, s28, 32768
ds_read_b64_tr_b16 a[128:129], v4 offset:32768
v_mfma_f32_16x16x32_bf16 a[196:199], a[140:143], a[4:7], a[196:199]
s_lshr_b32 s22, s3, 1
buffer_load_dwordx4 v12, s[8:11], s24 offen offset:0 lds
v_mfma_f32_16x16x32_bf16 a[204:207], a[136:139], a[8:11], a[204:207]
s_lshl_b32 s22, s22, 14
ds_read_b64_tr_b16 a[130:131], v4 offset:34816
v_subrev_u32 v2, s22, v2
v_mfma_f32_16x16x32_bf16 a[204:207], a[140:143], a[12:15], a[204:207]
v_subrev_u32 v3, s22, v3
v_mfma_f32_16x16x32_bf16 a[212:215], a[136:139], a[16:19], a[212:215]
ds_read_b64_tr_b16 a[132:133], v4 offset:49152
v_mfma_f32_16x16x32_bf16 a[212:215], a[140:143], a[20:23], a[212:215]
buffer_load_dwordx4 v13, s[8:11], s24 offen offset:1024 lds
v_mfma_f32_16x16x32_bf16 a[220:223], a[136:139], a[24:27], a[220:223]
ds_read_b64_tr_b16 a[134:135], v4 offset:51200
v_mfma_f32_16x16x32_bf16 a[220:223], a[140:143], a[28:31], a[220:223]
v_mfma_f32_16x16x32_bf16 a[228:231], a[136:139], a[32:35], a[228:231]
v_mfma_f32_16x16x32_bf16 a[228:231], a[140:143], a[36:39], a[228:231]
buffer_load_dwordx4 v14, s[8:11], s24 offen offset:2048 lds
v_mfma_f32_16x16x32_bf16 a[236:239], a[136:139], a[40:43], a[236:239]
v_mfma_f32_16x16x32_bf16 a[236:239], a[140:143], a[44:47], a[236:239]
v_mfma_f32_16x16x32_bf16 a[244:247], a[136:139], a[48:51], a[244:247]
v_mfma_f32_16x16x32_bf16 a[244:247], a[140:143], a[52:55], a[244:247]
buffer_load_dwordx4 v15, s[8:11], s24 offen offset:3072 lds
v_mfma_f32_16x16x32_bf16 a[252:255], a[136:139], a[56:59], a[252:255]
s_add_u32 s24, s24, 128
v_mfma_f32_16x16x32_bf16 a[252:255], a[140:143], a[60:63], a[252:255]
s_waitcnt lgkmcnt(0)
v_mfma_f32_16x16x32_bf16 v[32:35], a[128:131], a[64:67], v[32:35]
s_add_u32 m0, s29, 65536
ds_read_b64_tr_b16 a[136:137], v5 offset:32768
v_mfma_f32_16x16x32_bf16 v[32:35], a[132:135], a[68:71], v[32:35]
buffer_load_dwordx4 v16, s[12:15], s26 offen offset:0 lds
v_mfma_f32_16x16x32_bf16 v[40:43], a[128:131], a[72:75], v[40:43]
ds_read_b64_tr_b16 a[138:139], v5 offset:34816
v_mfma_f32_16x16x32_bf16 v[40:43], a[132:135], a[76:79], v[40:43]
v_mfma_f32_16x16x32_bf16 v[48:51], a[128:131], a[80:83], v[48:51]
ds_read_b64_tr_b16 a[140:141], v5 offset:49152
v_mfma_f32_16x16x32_bf16 v[48:51], a[132:135], a[84:87], v[48:51]
buffer_load_dwordx4 v17, s[12:15], s26 offen offset:1024 lds
v_mfma_f32_16x16x32_bf16 v[56:59], a[128:131], a[88:91], v[56:59]
ds_read_b64_tr_b16 a[142:143], v5 offset:51200
v_mfma_f32_16x16x32_bf16 v[56:59], a[132:135], a[92:95], v[56:59]
v_mfma_f32_16x16x32_bf16 v[64:67], a[128:131], a[96:99], v[64:67]
ds_read_b128 a[0:3], v2 offset:0
v_mfma_f32_16x16x32_bf16 v[64:67], a[132:135], a[100:103], v[64:67]
buffer_load_dwordx4 v18, s[12:15], s26 offen offset:2048 lds
v_mfma_f32_16x16x32_bf16 v[72:75], a[128:131], a[104:107], v[72:75]
ds_read_b128 a[4:7], v3 offset:0
v_mfma_f32_16x16x32_bf16 v[72:75], a[132:135], a[108:111], v[72:75]
v_mfma_f32_16x16x32_bf16 v[80:83], a[128:131], a[112:115], v[80:83]
v_mfma_f32_16x16x32_bf16 v[80:83], a[132:135], a[116:119], v[80:83]
buffer_load_dwordx4 v19, s[12:15], s26 offen offset:3072 lds
v_mfma_f32_16x16x32_bf16 v[88:91], a[128:131], a[120:123], v[88:91]
s_add_u32 s26, s26, 524288
ds_read_b128 a[8:11], v2 offset:2048
v_mfma_f32_16x16x32_bf16 v[88:91], a[132:135], a[124:127], v[88:91]
s_waitcnt lgkmcnt(3)
v_mfma_f32_16x16x32_bf16 v[36:39], a[136:139], a[64:67], v[36:39]
s_add_u32 m0, s29, 81920
ds_read_b64_tr_b16 a[128:129], v6 offset:32768
v_mfma_f32_16x16x32_bf16 v[36:39], a[140:143], a[68:71], v[36:39]
buffer_load_dwordx4 v16, s[12:15], s27 offen offset:0 lds
v_mfma_f32_16x16x32_bf16 v[44:47], a[136:139], a[72:75], v[44:47]
ds_read_b64_tr_b16 a[130:131], v6 offset:34816
v_mfma_f32_16x16x32_bf16 v[44:47], a[140:143], a[76:79], v[44:47]
v_mfma_f32_16x16x32_bf16 v[52:55], a[136:139], a[80:83], v[52:55]
ds_read_b64_tr_b16 a[132:133], v6 offset:49152
v_mfma_f32_16x16x32_bf16 v[52:55], a[140:143], a[84:87], v[52:55]
buffer_load_dwordx4 v17, s[12:15], s27 offen offset:1024 lds
v_mfma_f32_16x16x32_bf16 v[60:63], a[136:139], a[88:91], v[60:63]
ds_read_b64_tr_b16 a[134:135], v6 offset:51200
v_cvt_pk_bf16_f32 v32, v32, v33
v_mfma_f32_16x16x32_bf16 v[60:63], a[140:143], a[92:95], v[60:63]
v_cvt_pk_bf16_f32 v33, v34, v35
v_cvt_pk_bf16_f32 v34, v36, v37
v_mfma_f32_16x16x32_bf16 v[68:71], a[136:139], a[96:99], v[68:71]
ds_read_b128 a[12:15], v3 offset:2048
v_cvt_pk_bf16_f32 v35, v38, v39
v_mfma_f32_16x16x32_bf16 v[68:71], a[140:143], a[100:103], v[68:71]
buffer_load_dwordx4 v18, s[12:15], s27 offen offset:2048 lds
v_mfma_f32_16x16x32_bf16 v[76:79], a[136:139], a[104:107], v[76:79]
v_cvt_pk_bf16_f32 v40, v40, v41
v_cvt_pk_bf16_f32 v41, v42, v43
v_mfma_f32_16x16x32_bf16 v[76:79], a[140:143], a[108:111], v[76:79]
v_cvt_pk_bf16_f32 v42, v44, v45
v_cvt_pk_bf16_f32 v43, v46, v47
v_mfma_f32_16x16x32_bf16 v[84:87], a[136:139], a[112:115], v[84:87]
ds_read_b128 a[16:19], v2 offset:4096
v_cvt_pk_bf16_f32 v48, v48, v49
v_mfma_f32_16x16x32_bf16 v[84:87], a[140:143], a[116:119], v[84:87]
buffer_load_dwordx4 v19, s[12:15], s27 offen offset:3072 lds
v_mfma_f32_16x16x32_bf16 v[92:95], a[136:139], a[120:123], v[92:95]
s_add_u32 s27, s27, 524288
ds_read_b128 a[20:23], v3 offset:4096
v_cvt_pk_bf16_f32 v49, v50, v51
v_mfma_f32_16x16x32_bf16 v[92:95], a[140:143], a[124:127], v[92:95]
s_waitcnt lgkmcnt(3)
v_cvt_pk_bf16_f32 v50, v52, v53
v_cvt_pk_bf16_f32 v51, v54, v55
v_mfma_f32_16x16x32_bf16 v[96:99], a[128:131], a[64:67], v[96:99]
s_add_u32 m0, s28, 49152
ds_read_b64_tr_b16 a[136:137], v7 offset:32768
v_cvt_pk_bf16_f32 v56, v56, v57
v_mfma_f32_16x16x32_bf16 v[96:99], a[132:135], a[68:71], v[96:99]
buffer_load_dwordx4 v12, s[8:11], s24 offen offset:0 lds
v_mfma_f32_16x16x32_bf16 v[104:107], a[128:131], a[72:75], v[104:107]
ds_read_b64_tr_b16 a[138:139], v7 offset:34816
v_cvt_pk_bf16_f32 v57, v58, v59
v_mfma_f32_16x16x32_bf16 v[104:107], a[132:135], a[76:79], v[104:107]
v_cvt_pk_bf16_f32 v58, v60, v61
v_cvt_pk_bf16_f32 v59, v62, v63
v_mfma_f32_16x16x32_bf16 v[112:115], a[128:131], a[80:83], v[112:115]
ds_read_b64_tr_b16 a[140:141], v7 offset:49152
v_cvt_pk_bf16_f32 v64, v64, v65
v_mfma_f32_16x16x32_bf16 v[112:115], a[132:135], a[84:87], v[112:115]
buffer_load_dwordx4 v13, s[8:11], s24 offen offset:1024 lds
v_mfma_f32_16x16x32_bf16 v[120:123], a[128:131], a[88:91], v[120:123]
ds_read_b64_tr_b16 a[142:143], v7 offset:51200
v_cvt_pk_bf16_f32 v65, v66, v67
v_mfma_f32_16x16x32_bf16 v[120:123], a[132:135], a[92:95], v[120:123]
v_cvt_pk_bf16_f32 v66, v68, v69
v_cvt_pk_bf16_f32 v67, v70, v71
v_mfma_f32_16x16x32_bf16 v[128:131], a[128:131], a[96:99], v[128:131]
v_cvt_pk_bf16_f32 v72, v72, v73
v_cvt_pk_bf16_f32 v73, v74, v75
v_mfma_f32_16x16x32_bf16 v[128:131], a[132:135], a[100:103], v[128:131]
buffer_load_dwordx4 v14, s[8:11], s24 offen offset:2048 lds
v_mfma_f32_16x16x32_bf16 v[136:139], a[128:131], a[104:107], v[136:139]
ds_read_b128 a[24:27], v2 offset:6144
v_cvt_pk_bf16_f32 v74, v76, v77
v_mfma_f32_16x16x32_bf16 v[136:139], a[132:135], a[108:111], v[136:139]
buffer_store_dwordx4 v[32:35], v1, s[4:7], s31 offen sc1
v_mfma_f32_16x16x32_bf16 v[144:147], a[128:131], a[112:115], v[144:147]
s_add_u32 s31, s31, s32
ds_read_b128 a[28:31], v3 offset:6144
v_cvt_pk_bf16_f32 v75, v78, v79
v_mfma_f32_16x16x32_bf16 v[144:147], a[132:135], a[116:119], v[144:147]
buffer_load_dwordx4 v15, s[8:11], s24 offen offset:3072 lds
v_mfma_f32_16x16x32_bf16 v[152:155], a[128:131], a[120:123], v[152:155]
s_add_u32 s24, s24, 128
v_cvt_pk_bf16_f32 v80, v80, v81
v_cvt_pk_bf16_f32 v81, v82, v83
v_mfma_f32_16x16x32_bf16 v[152:155], a[132:135], a[124:127], v[152:155]
s_waitcnt lgkmcnt(2)
v_cvt_pk_bf16_f32 v82, v84, v85
v_cvt_pk_bf16_f32 v83, v86, v87
v_mfma_f32_16x16x32_bf16 v[100:103], a[136:139], a[64:67], v[100:103]
ds_read_b64_tr_b16 a[128:129], v8 offset:32768
v_cvt_pk_bf16_f32 v88, v88, v89
v_mfma_f32_16x16x32_bf16 v[100:103], a[140:143], a[68:71], v[100:103]
v_cvt_pk_bf16_f32 v89, v90, v91
v_cvt_pk_bf16_f32 v90, v92, v93
v_mfma_f32_16x16x32_bf16 v[108:111], a[136:139], a[72:75], v[108:111]
ds_read_b64_tr_b16 a[130:131], v8 offset:34816
v_cvt_pk_bf16_f32 v91, v94, v95
v_mfma_f32_16x16x32_bf16 v[108:111], a[140:143], a[76:79], v[108:111]
buffer_store_dwordx4 v[40:43], v1, s[4:7], s31 offen sc1
v_mfma_f32_16x16x32_bf16 v[116:119], a[136:139], a[80:83], v[116:119]
s_add_u32 s31, s31, s33
ds_read_b64_tr_b16 a[132:133], v8 offset:49152
v_mfma_f32_16x16x32_bf16 v[116:119], a[140:143], a[84:87], v[116:119]
v_mfma_f32_16x16x32_bf16 v[124:127], a[136:139], a[88:91], v[124:127]
ds_read_b64_tr_b16 a[134:135], v8 offset:51200
v_cvt_pk_bf16_f32 v96, v96, v97
v_mfma_f32_16x16x32_bf16 v[124:127], a[140:143], a[92:95], v[124:127]
v_cvt_pk_bf16_f32 v97, v98, v99
v_cvt_pk_bf16_f32 v98, v100, v101
v_mfma_f32_16x16x32_bf16 v[132:135], a[136:139], a[96:99], v[132:135]
ds_read_b128 a[32:35], v2 offset:8192
v_cvt_pk_bf16_f32 v99, v102, v103
v_mfma_f32_16x16x32_bf16 v[132:135], a[140:143], a[100:103], v[132:135]
v_cvt_pk_bf16_f32 v104, v104, v105
v_cvt_pk_bf16_f32 v105, v106, v107
v_mfma_f32_16x16x32_bf16 v[140:143], a[136:139], a[104:107], v[140:143]
v_cvt_pk_bf16_f32 v106, v108, v109
v_cvt_pk_bf16_f32 v107, v110, v111
v_mfma_f32_16x16x32_bf16 v[140:143], a[140:143], a[108:111], v[140:143]
v_cvt_pk_bf16_f32 v112, v112, v113
v_cvt_pk_bf16_f32 v113, v114, v115
v_mfma_f32_16x16x32_bf16 v[148:151], a[136:139], a[112:115], v[148:151]
ds_read_b128 a[36:39], v3 offset:8192
v_cvt_pk_bf16_f32 v114, v116, v117
v_mfma_f32_16x16x32_bf16 v[148:151], a[140:143], a[116:119], v[148:151]
v_cvt_pk_bf16_f32 v115, v118, v119
v_cvt_pk_bf16_f32 v120, v120, v121
v_mfma_f32_16x16x32_bf16 v[156:159], a[136:139], a[120:123], v[156:159]
ds_read_b128 a[40:43], v2 offset:10240
v_cvt_pk_bf16_f32 v121, v122, v123
v_mfma_f32_16x16x32_bf16 v[156:159], a[140:143], a[124:127], v[156:159]
s_waitcnt lgkmcnt(3)
buffer_store_dwordx4 v[48:51], v1, s[4:7], s31 offen sc1
v_mfma_f32_16x16x32_bf16 v[160:163], a[128:131], a[64:67], v[160:163]
s_add_u32 s31, s31, s32
ds_read_b64_tr_b16 a[136:137], v9 offset:32768
v_cvt_pk_bf16_f32 v122, v124, v125
v_mfma_f32_16x16x32_bf16 v[160:163], a[132:135], a[68:71], v[160:163]
v_cvt_pk_bf16_f32 v123, v126, v127
v_cvt_pk_bf16_f32 v128, v128, v129
v_mfma_f32_16x16x32_bf16 v[168:171], a[128:131], a[72:75], v[168:171]
ds_read_b64_tr_b16 a[138:139], v9 offset:34816
v_cvt_pk_bf16_f32 v129, v130, v131
v_mfma_f32_16x16x32_bf16 v[168:171], a[132:135], a[76:79], v[168:171]
v_cvt_pk_bf16_f32 v130, v132, v133
v_cvt_pk_bf16_f32 v131, v134, v135
v_mfma_f32_16x16x32_bf16 v[176:179], a[128:131], a[80:83], v[176:179]
ds_read_b64_tr_b16 a[140:141], v9 offset:49152
v_cvt_pk_bf16_f32 v136, v136, v137
v_mfma_f32_16x16x32_bf16 v[176:179], a[132:135], a[84:87], v[176:179]
v_cvt_pk_bf16_f32 v137, v138, v139
v_cvt_pk_bf16_f32 v138, v140, v141
v_mfma_f32_16x16x32_bf16 v[184:187], a[128:131], a[88:91], v[184:187]
ds_read_b64_tr_b16 a[142:143], v9 offset:51200
v_cvt_pk_bf16_f32 v139, v142, v143
v_mfma_f32_16x16x32_bf16 v[184:187], a[132:135], a[92:95], v[184:187]
v_cvt_pk_bf16_f32 v144, v144, v145
v_cvt_pk_bf16_f32 v145, v146, v147
v_mfma_f32_16x16x32_bf16 v[192:195], a[128:131], a[96:99], v[192:195]
buffer_store_dwordx4 v[56:59], v1, s[4:7], s31 offen sc1
v_mfma_f32_16x16x32_bf16 v[192:195], a[132:135], a[100:103], v[192:195]
s_add_u32 s31, s31, s34
v_cvt_pk_bf16_f32 v146, v148, v149
v_cvt_pk_bf16_f32 v147, v150, v151
v_mfma_f32_16x16x32_bf16 v[200:203], a[128:131], a[104:107], v[200:203]
ds_read_b128 a[44:47], v3 offset:10240
v_cvt_pk_bf16_f32 v152, v152, v153
v_mfma_f32_16x16x32_bf16 v[200:203], a[132:135], a[108:111], v[200:203]
v_cvt_pk_bf16_f32 v153, v154, v155
v_cvt_pk_bf16_f32 v154, v156, v157
v_mfma_f32_16x16x32_bf16 v[208:211], a[128:131], a[112:115], v[208:211]
ds_read_b128 a[48:51], v2 offset:12288
v_cvt_pk_bf16_f32 v155, v158, v159
v_mfma_f32_16x16x32_bf16 v[208:211], a[132:135], a[116:119], v[208:211]
v_mfma_f32_16x16x32_bf16 v[216:219], a[128:131], a[120:123], v[216:219]
v_mfma_f32_16x16x32_bf16 v[216:219], a[132:135], a[124:127], v[216:219]
s_waitcnt lgkmcnt(2)
v_mfma_f32_16x16x32_bf16 v[164:167], a[136:139], a[64:67], v[164:167]
ds_read_b64_tr_b16 a[128:129], v10 offset:32768
v_mfma_f32_16x16x32_bf16 v[164:167], a[140:143], a[68:71], v[164:167]
v_mfma_f32_16x16x32_bf16 v[172:175], a[136:139], a[72:75], v[172:175]
ds_read_b64_tr_b16 a[130:131], v10 offset:34816
v_mfma_f32_16x16x32_bf16 v[172:175], a[140:143], a[76:79], v[172:175]
buffer_store_dwordx4 v[64:67], v1, s[4:7], s31 offen sc1
v_mfma_f32_16x16x32_bf16 v[180:183], a[136:139], a[80:83], v[180:183]
s_add_u32 s31, s31, s32
ds_read_b64_tr_b16 a[132:133], v10 offset:49152
v_mfma_f32_16x16x32_bf16 v[180:183], a[140:143], a[84:87], v[180:183]
v_mfma_f32_16x16x32_bf16 v[188:191], a[136:139], a[88:91], v[188:191]
ds_read_b64_tr_b16 a[134:135], v10 offset:51200
v_cvt_pk_bf16_f32 v160, v160, v161
v_mfma_f32_16x16x32_bf16 v[188:191], a[140:143], a[92:95], v[188:191]
v_cvt_pk_bf16_f32 v161, v162, v163
v_cvt_pk_bf16_f32 v162, v164, v165
v_mfma_f32_16x16x32_bf16 v[196:199], a[136:139], a[96:99], v[196:199]
ds_read_b128 a[52:55], v3 offset:12288
v_cvt_pk_bf16_f32 v163, v166, v167
v_mfma_f32_16x16x32_bf16 v[196:199], a[140:143], a[100:103], v[196:199]
v_cvt_pk_bf16_f32 v168, v168, v169
v_cvt_pk_bf16_f32 v169, v170, v171
v_mfma_f32_16x16x32_bf16 v[204:207], a[136:139], a[104:107], v[204:207]
ds_read_b128 a[56:59], v2 offset:14336
v_cvt_pk_bf16_f32 v170, v172, v173
v_mfma_f32_16x16x32_bf16 v[204:207], a[140:143], a[108:111], v[204:207]
v_cvt_pk_bf16_f32 v171, v174, v175
v_cvt_pk_bf16_f32 v176, v176, v177
v_mfma_f32_16x16x32_bf16 v[212:215], a[136:139], a[112:115], v[212:215]
v_cvt_pk_bf16_f32 v177, v178, v179
v_cvt_pk_bf16_f32 v178, v180, v181
v_mfma_f32_16x16x32_bf16 v[212:215], a[140:143], a[116:119], v[212:215]
buffer_store_dwordx4 v[72:75], v1, s[4:7], s31 offen sc1
v_mfma_f32_16x16x32_bf16 v[220:223], a[136:139], a[120:123], v[220:223]
s_add_u32 s31, s31, s33
ds_read_b128 a[60:63], v3 offset:14336
v_cvt_pk_bf16_f32 v179, v182, v183
v_mfma_f32_16x16x32_bf16 v[220:223], a[140:143], a[124:127], v[220:223]
s_waitcnt lgkmcnt(3)
v_cvt_pk_bf16_f32 v184, v184, v185
v_cvt_pk_bf16_f32 v185, v186, v187
v_mfma_f32_16x16x32_bf16 a[192:195], a[128:131], a[64:67], a[192:195]
ds_read_b64_tr_b16 a[136:137], v11 offset:32768
v_cvt_pk_bf16_f32 v186, v188, v189
v_mfma_f32_16x16x32_bf16 a[192:195], a[132:135], a[68:71], a[192:195]
v_cvt_pk_bf16_f32 v187, v190, v191
v_cvt_pk_bf16_f32 v192, v192, v193
v_mfma_f32_16x16x32_bf16 a[200:203], a[128:131], a[72:75], a[200:203]
ds_read_b64_tr_b16 a[138:139], v11 offset:34816
v_cvt_pk_bf16_f32 v193, v194, v195
v_mfma_f32_16x16x32_bf16 a[200:203], a[132:135], a[76:79], a[200:203]
v_cvt_pk_bf16_f32 v194, v196, v197
v_cvt_pk_bf16_f32 v195, v198, v199
v_mfma_f32_16x16x32_bf16 a[208:211], a[128:131], a[80:83], a[208:211]
ds_read_b64_tr_b16 a[140:141], v11 offset:49152
v_cvt_pk_bf16_f32 v200, v200, v201
v_mfma_f32_16x16x32_bf16 a[208:211], a[132:135], a[84:87], a[208:211]
v_cvt_pk_bf16_f32 v201, v202, v203
v_cvt_pk_bf16_f32 v202, v204, v205
v_mfma_f32_16x16x32_bf16 a[216:219], a[128:131], a[88:91], a[216:219]
ds_read_b64_tr_b16 a[142:143], v11 offset:51200
v_cvt_pk_bf16_f32 v203, v206, v207
v_mfma_f32_16x16x32_bf16 a[216:219], a[132:135], a[92:95], a[216:219]
v_cvt_pk_bf16_f32 v208, v208, v209
v_cvt_pk_bf16_f32 v209, v210, v211
v_mfma_f32_16x16x32_bf16 a[224:227], a[128:131], a[96:99], a[224:227]
buffer_store_dwordx4 v[80:83], v1, s[4:7], s31 offen sc1
v_mfma_f32_16x16x32_bf16 a[224:227], a[132:135], a[100:103], a[224:227]
s_add_u32 s31, s31, s32
v_cvt_pk_bf16_f32 v210, v212, v213
v_cvt_pk_bf16_f32 v211, v214, v215
v_mfma_f32_16x16x32_bf16 a[232:235], a[128:131], a[104:107], a[232:235]
v_cvt_pk_bf16_f32 v216, v216, v217
v_cvt_pk_bf16_f32 v217, v218, v219
v_mfma_f32_16x16x32_bf16 a[232:235], a[132:135], a[108:111], a[232:235]
v_cvt_pk_bf16_f32 v218, v220, v221
v_cvt_pk_bf16_f32 v219, v222, v223
v_mfma_f32_16x16x32_bf16 a[240:243], a[128:131], a[112:115], a[240:243]
v_mfma_f32_16x16x32_bf16 a[240:243], a[132:135], a[116:119], a[240:243]
v_mfma_f32_16x16x32_bf16 a[248:251], a[128:131], a[120:123], a[248:251]
s_waitcnt vmcnt(23) lgkmcnt(0)
v_mfma_f32_16x16x32_bf16 a[248:251], a[132:135], a[124:127], a[248:251]
s_barrier
v_mfma_f32_16x16x32_bf16 a[196:199], a[136:139], a[64:67], a[196:199]
s_add_u32 m0, s29, 98304
ds_read_b64_tr_b16 a[128:129], v22 offset:0
v_mfma_f32_16x16x32_bf16 a[196:199], a[140:143], a[68:71], a[196:199]
buffer_load_dwordx4 v16, s[12:15], s26 offen offset:0 lds
v_mfma_f32_16x16x32_bf16 a[204:207], a[136:139], a[72:75], a[204:207]
ds_read_b64_tr_b16 a[130:131], v22 offset:2048
v_mfma_f32_16x16x32_bf16 a[204:207], a[140:143], a[76:79], a[204:207]
buffer_store_dwordx4 v[88:91], v1, s[4:7], s31 offen sc1
v_mfma_f32_16x16x32_bf16 a[212:215], a[136:139], a[80:83], a[212:215]
s_add_u32 s31, s31, s35
ds_read_b64_tr_b16 a[132:133], v22 offset:16384
v_mfma_f32_16x16x32_bf16 a[212:215], a[140:143], a[84:87], a[212:215]
buffer_load_dwordx4 v17, s[12:15], s26 offen offset:1024 lds
v_mfma_f32_16x16x32_bf16 a[220:223], a[136:139], a[88:91], a[220:223]
ds_read_b64_tr_b16 a[134:135], v22 offset:18432
v_add_u32 v22, 4294901760, v22
v_mfma_f32_16x16x32_bf16 a[220:223], a[140:143], a[92:95], a[220:223]
v_mfma_f32_16x16x32_bf16 a[228:231], a[136:139], a[96:99], a[228:231]
v_mfma_f32_16x16x32_bf16 a[228:231], a[140:143], a[100:103], a[228:231]
buffer_load_dwordx4 v18, s[12:15], s26 offen offset:2048 lds
v_mfma_f32_16x16x32_bf16 a[236:239], a[136:139], a[104:107], a[236:239]
v_mfma_f32_16x16x32_bf16 a[236:239], a[140:143], a[108:111], a[236:239]
v_mfma_f32_16x16x32_bf16 a[244:247], a[136:139], a[112:115], a[244:247]
v_mfma_f32_16x16x32_bf16 a[244:247], a[140:143], a[116:119], a[244:247]
buffer_load_dwordx4 v19, s[12:15], s26 offen offset:3072 lds
v_mfma_f32_16x16x32_bf16 a[252:255], a[136:139], a[120:123], a[252:255]
s_add_u32 s26, s26, 524288
v_mfma_f32_16x16x32_bf16 a[252:255], a[140:143], a[124:127], a[252:255]
s_waitcnt lgkmcnt(0)
M_Q:
v_mfma_f32_16x16x32_bf16 v[36:39], a[128:131], a[0:3], 0
s_add_u32 m0, s29, 114688
ds_read_b64_tr_b16 a[136:137], v23 offset:0
v_mfma_f32_16x16x32_bf16 v[36:39], a[132:135], a[4:7], v[36:39]
buffer_load_dwordx4 v16, s[12:15], s27 offen offset:0 lds
v_mfma_f32_16x16x32_bf16 v[44:47], a[128:131], a[8:11], 0
ds_read_b64_tr_b16 a[138:139], v23 offset:2048
v_mfma_f32_16x16x32_bf16 v[44:47], a[132:135], a[12:15], v[44:47]
ds_read_b128 a[64:67], v2 offset:16384
ds_read_b128 a[68:71], v3 offset:16384
v_mfma_f32_16x16x32_bf16 v[52:55], a[128:131], a[16:19], 0
ds_read_b64_tr_b16 a[140:141], v23 offset:16384
v_mfma_f32_16x16x32_bf16 v[52:55], a[132:135], a[20:23], v[52:55]
buffer_load_dwordx4 v17, s[12:15], s27 offen offset:1024 lds
v_mfma_f32_16x16x32_bf16 v[60:63], a[128:131], a[24:27], 0
ds_read_b64_tr_b16 a[142:143], v23 offset:18432
v_add_u32 v23, 4294901760, v23
v_mfma_f32_16x16x32_bf16 v[60:63], a[132:135], a[28:31], v[60:63]
buffer_store_dwordx4 v[96:99], v1, s[4:7], s31 offen sc1
v_mfma_f32_16x16x32_bf16 v[68:71], a[128:131], a[32:35], 0
s_add_u32 s31, s31, s32
ds_read_b128 a[72:75], v2 offset:18432
v_mfma_f32_16x16x32_bf16 v[68:71], a[132:135], a[36:39], v[68:71]
buffer_load_dwordx4 v18, s[12:15], s27 offen offset:2048 lds
v_mfma_f32_16x16x32_bf16 v[76:79], a[128:131], a[40:43], 0
ds_read_b128 a[76:79], v3 offset:18432
v_mfma_f32_16x16x32_bf16 v[76:79], a[132:135], a[44:47], v[76:79]
ds_read_b128 a[80:83], v2 offset:20480
v_mfma_f32_16x16x32_bf16 v[84:87], a[128:131], a[48:51], 0
ds_read_b128 a[84:87], v3 offset:20480
v_mfma_f32_16x16x32_bf16 v[84:87], a[132:135], a[52:55], v[84:87]
buffer_load_dwordx4 v19, s[12:15], s27 offen offset:3072 lds
v_mfma_f32_16x16x32_bf16 v[92:95], a[128:131], a[56:59], 0
s_add_u32 s27, s27, 524288
ds_read_b128 a[88:91], v2 offset:22528
v_mfma_f32_16x16x32_bf16 v[92:95], a[132:135], a[60:63], v[92:95]
s_waitcnt lgkmcnt(5)
buffer_store_dwordx4 v[104:107], v1, s[4:7], s31 offen sc1
v_mfma_f32_16x16x32_bf16 v[100:103], a[136:139], a[0:3], 0
s_add_u32 m0, s28, 0
ds_read_b64_tr_b16 a[128:129], v24 offset:0
v_mfma_f32_16x16x32_bf16 v[100:103], a[140:143], a[4:7], v[100:103]
s_add_u32 s31, s31, s33
buffer_load_dwordx4 v12, s[8:11], s24 offen offset:0 lds
v_mfma_f32_16x16x32_bf16 v[108:111], a[136:139], a[8:11], 0
ds_read_b64_tr_b16 a[130:131], v24 offset:2048
v_mfma_f32_16x16x32_bf16 v[108:111], a[140:143], a[12:15], v[108:111]
ds_read_b128 a[92:95], v3 offset:22528
v_mfma_f32_16x16x32_bf16 v[116:119], a[136:139], a[16:19], 0
ds_read_b64_tr_b16 a[132:133], v24 offset:16384
v_mfma_f32_16x16x32_bf16 v[116:119], a[140:143], a[20:23], v[116:119]
buffer_load_dwordx4 v13, s[8:11], s24 offen offset:1024 lds
v_mfma_f32_16x16x32_bf16 v[124:127], a[136:139], a[24:27], 0
ds_read_b64_tr_b16 a[134:135], v24 offset:18432
v_add_u32 v24, 4294901760, v24
v_mfma_f32_16x16x32_bf16 v[124:127], a[140:143], a[28:31], v[124:127]
v_mfma_f32_16x16x32_bf16 v[132:135], a[136:139], a[32:35], 0
ds_read_b128 a[96:99], v2 offset:24576
v_mfma_f32_16x16x32_bf16 v[132:135], a[140:143], a[36:39], v[132:135]
buffer_load_dwordx4 v14, s[8:11], s24 offen offset:2048 lds
v_mfma_f32_16x16x32_bf16 v[140:143], a[136:139], a[40:43], 0
ds_read_b128 a[100:103], v3 offset:24576
v_mfma_f32_16x16x32_bf16 v[140:143], a[140:143], a[44:47], v[140:143]
ds_read_b128 a[104:107], v2 offset:26624
v_mfma_f32_16x16x32_bf16 v[148:151], a[136:139], a[48:51], 0
ds_read_b128 a[108:111], v3 offset:26624
v_mfma_f32_16x16x32_bf16 v[148:151], a[140:143], a[52:55], v[148:151]
PAD_6:
s_cbranch_execz M_tret
buffer_load_dwordx4 v15, s[8:11], s24 offen offset:3072 lds
v_mfma_f32_16x16x32_bf16 v[156:159], a[136:139], a[56:59], 0
s_add_u32 s24, s24, 128
ds_read_b128 a[112:115], v2 offset:28672
v_mfma_f32_16x16x32_bf16 v[156:159], a[140:143], a[60:63], v[156:159]
s_waitcnt lgkmcnt(5)
buffer_store_dwordx4 v[112:115], v1, s[4:7], s31 offen sc1
v_mfma_f32_16x16x32_bf16 v[164:167], a[128:131], a[0:3], 0
s_add_u32 s31, s31, s32
ds_read_b64_tr_b16 a[136:137], v25 offset:0
v_mfma_f32_16x16x32_bf16 v[164:167], a[132:135], a[4:7], v[164:167]
v_mfma_f32_16x16x32_bf16 v[172:175], a[128:131], a[8:11], 0
ds_read_b64_tr_b16 a[138:139], v25 offset:2048
v_mfma_f32_16x16x32_bf16 v[172:175], a[132:135], a[12:15], v[172:175]
ds_read_b128 a[116:119], v3 offset:28672
v_mfma_f32_16x16x32_bf16 v[180:183], a[128:131], a[16:19], 0
ds_read_b64_tr_b16 a[140:141], v25 offset:16384
v_mfma_f32_16x16x32_bf16 v[180:183], a[132:135], a[20:23], v[180:183]
v_mfma_f32_16x16x32_bf16 v[188:191], a[128:131], a[24:27], 0
ds_read_b64_tr_b16 a[142:143], v25 offset:18432
v_add_u32 v25, 4294901760, v25
v_mfma_f32_16x16x32_bf16 v[188:191], a[132:135], a[28:31], v[188:191]
v_mfma_f32_16x16x32_bf16 v[196:199], a[128:131], a[32:35], 0
ds_read_b128 a[120:123], v2 offset:30720
v_mfma_f32_16x16x32_bf16 v[196:199], a[132:135], a[36:39], v[196:199]
v_mfma_f32_16x16x32_bf16 v[204:207], a[128:131], a[40:43], 0
ds_read_b128 a[124:127], v3 offset:30720
v_mfma_f32_16x16x32_bf16 v[204:207], a[132:135], a[44:47], v[204:207]
v_mfma_f32_16x16x32_bf16 v[212:215], a[128:131], a[48:51], 0
v_mfma_f32_16x16x32_bf16 v[212:215], a[132:135], a[52:55], v[212:215]
buffer_store_dwordx4 v[120:123], v1, s[4:7], s31 offen sc1
v_mfma_f32_16x16x32_bf16 v[220:223], a[128:131], a[56:59], 0
s_add_u32 s31, s31, s34
v_mfma_f32_16x16x32_bf16 v[220:223], a[132:135], a[60:63], v[220:223]
s_waitcnt vmcnt(28) lgkmcnt(0)
s_barrier
v_mfma_f32_16x16x32_bf16 v[224:227], a[136:139], a[0:3], 0
s_add_u32 m0, s29, 131072
ds_read_b64_tr_b16 a[128:129], v22 offset:0
v_mfma_f32_16x16x32_bf16 v[224:227], a[140:143], a[4:7], v[224:227]
buffer_load_dwordx4 v16, s[12:15], s26 offen offset:0 lds
v_mfma_f32_16x16x32_bf16 v[228:231], a[136:139], a[8:11], 0
ds_read_b64_tr_b16 a[130:131], v22 offset:2048
v_mfma_f32_16x16x32_bf16 v[228:231], a[140:143], a[12:15], v[228:231]
v_mfma_f32_16x16x32_bf16 v[232:235], a[136:139], a[16:19], 0
ds_read_b64_tr_b16 a[132:133], v22 offset:16384
v_mfma_f32_16x16x32_bf16 v[232:235], a[140:143], a[20:23], v[232:235]
buffer_load_dwordx4 v17, s[12:15], s26 offen offset:1024 lds
v_mfma_f32_16x16x32_bf16 v[236:239], a[136:139], a[24:27], 0
ds_read_b64_tr_b16 a[134:135], v22 offset:18432
v_add_u32 v22, 32768, v22
v_mfma_f32_16x16x32_bf16 v[236:239], a[140:143], a[28:31], v[236:239]
v_mfma_f32_16x16x32_bf16 v[240:243], a[136:139], a[32:35], 0
v_mfma_f32_16x16x32_bf16 v[240:243], a[140:143], a[36:39], v[240:243]
buffer_load_dwordx4 v18, s[12:15], s26 offen offset:2048 lds
v_mfma_f32_16x16x32_bf16 v[244:247], a[136:139], a[40:43], 0
v_mfma_f32_16x16x32_bf16 v[244:247], a[140:143], a[44:47], v[244:247]
v_mfma_f32_16x16x32_bf16 v[248:251], a[136:139], a[48:51], 0
v_mfma_f32_16x16x32_bf16 v[248:251], a[140:143], a[52:55], v[248:251]
buffer_load_dwordx4 v19, s[12:15], s26 offen offset:3072 lds
v_mfma_f32_16x16x32_bf16 v[252:255], a[136:139], a[56:59], 0
s_add_u32 s26, s26, 524288
v_mfma_f32_16x16x32_bf16 v[252:255], a[140:143], a[60:63], v[252:255]
s_waitcnt lgkmcnt(0)
v_mfma_f32_16x16x32_bf16 v[36:39], a[128:131], a[64:67], v[36:39]
s_add_u32 m0, s29, 147456
ds_read_b64_tr_b16 a[136:137], v23 offset:0
v_accvgpr_read_b32 v32, a192
v_mfma_f32_16x16x32_bf16 v[36:39], a[132:135], a[68:71], v[36:39]
buffer_load_dwordx4 v16, s[12:15], s27 offen offset:0 lds
v_mfma_f32_16x16x32_bf16 v[44:47], a[128:131], a[72:75], v[44:47]
ds_read_b64_tr_b16 a[138:139], v23 offset:2048
v_accvgpr_read_b32 v33, a193
v_mfma_f32_16x16x32_bf16 v[44:47], a[132:135], a[76:79], v[44:47]
ds_read_b128 a[0:3], v2 offset:32768
ds_read_b128 a[4:7], v3 offset:32768
v_mfma_f32_16x16x32_bf16 v[52:55], a[128:131], a[80:83], v[52:55]
ds_read_b64_tr_b16 a[140:141], v23 offset:16384
v_accvgpr_read_b32 v34, a194
v_mfma_f32_16x16x32_bf16 v[52:55], a[132:135], a[84:87], v[52:55]
buffer_load_dwordx4 v17, s[12:15], s27 offen offset:1024 lds
v_mfma_f32_16x16x32_bf16 v[60:63], a[128:131], a[88:91], v[60:63]
ds_read_b64_tr_b16 a[142:143], v23 offset:18432
v_add_u32 v23, 32768, v23
v_mfma_f32_16x16x32_bf16 v[60:63], a[132:135], a[92:95], v[60:63]
buffer_store_dwordx4 v[128:131], v1, s[4:7], s31 offen sc1
v_mfma_f32_16x16x32_bf16 v[68:71], a[128:131], a[96:99], v[68:71]
s_add_u32 s31, s31, s32
ds_read_b128 a[8:11], v2 offset:34816
v_accvgpr_read_b32 v35, a195
v_mfma_f32_16x16x32_bf16 v[68:71], a[132:135], a[100:103], v[68:71]
buffer_load_dwordx4 v18, s[12:15], s27 offen offset:2048 lds
v_mfma_f32_16x16x32_bf16 v[76:79], a[128:131], a[104:107], v[76:79]
ds_read_b128 a[12:15], v3 offset:34816
v_accvgpr_read_b32 v96, a196
v_mfma_f32_16x16x32_bf16 v[76:79], a[132:135], a[108:111], v[76:79]
ds_read_b128 a[16:19], v2 offset:36864
v_accvgpr_read_b32 v97, a197
v_mfma_f32_16x16x32_bf16 v[84:87], a[128:131], a[112:115], v[84:87]
ds_read_b128 a[20:23], v3 offset:36864
v_accvgpr_read_b32 v98, a198
v_mfma_f32_16x16x32_bf16 v[84:87], a[132:135], a[116:119], v[84:87]
buffer_load_dwordx4 v19, s[12:15], s27 offen offset:3072 lds
v_mfma_f32_16x16x32_bf16 v[92:95], a[128:131], a[120:123], v[92:95]
s_add_u32 s27, s27, 524288
ds_read_b128 a[24:27], v2 offset:38912
v_accvgpr_read_b32 v99, a199
v_mfma_f32_16x16x32_bf16 v[92:95], a[132:135], a[124:127], v[92:95]
s_waitcnt lgkmcnt(5)
buffer_store_dwordx4 v[136:139], v1, s[4:7], s31 offen sc1
v_mfma_f32_16x16x32_bf16 v[100:103], a[136:139], a[64:67], v[100:103]
s_add_u32 m0, s28, 16384
ds_read_b64_tr_b16 a[128:129], v24 offset:0
v_cvt_pk_bf16_f32 v32, v32, v33
v_mfma_f32_16x16x32_bf16 v[100:103], a[140:143], a[68:71], v[100:103]
s_add_u32 s31, s31, s33
buffer_load_dwordx4 v12, s[8:11], s24 offen offset:0 lds
v_mfma_f32_16x16x32_bf16 v[108:111], a[136:139], a[72:75], v[108:111]
ds_read_b64_tr_b16 a[130:131], v24 offset:2048
v_cvt_pk_bf16_f32 v33, v34, v35
v_mfma_f32_16x16x32_bf16 v[108:111], a[140:143], a[76:79], v[108:111]
ds_read_b128 a[28:31], v3 offset:38912
v_cvt_pk_bf16_f32 v34, v96, v97
v_mfma_f32_16x16x32_bf16 v[116:119], a[136:139], a[80:83], v[116:119]
ds_read_b64_tr_b16 a[132:133], v24 offset:16384
v_cvt_pk_bf16_f32 v35, v98, v99
v_mfma_f32_16x16x32_bf16 v[116:119], a[140:143], a[84:87], v[116:119]
buffer_load_dwordx4 v13, s[8:11], s24 offen offset:1024 lds
v_mfma_f32_16x16x32_bf16 v[124:127], a[136:139], a[88:91], v[124:127]
ds_read_b64_tr_b16 a[134:135], v24 offset:18432
v_add_u32 v24, 32768, v24
v_mfma_f32_16x16x32_bf16 v[124:127], a[140:143], a[92:95], v[124:127]
v_accvgpr_read_b32 v40, a200
v_accvgpr_read_b32 v41, a201
v_mfma_f32_16x16x32_bf16 v[132:135], a[136:139], a[96:99], v[132:135]
ds_read_b128 a[32:35], v2 offset:40960
v_accvgpr_read_b32 v42, a202
v_mfma_f32_16x16x32_bf16 v[132:135], a[140:143], a[100:103], v[132:135]
buffer_load_dwordx4 v14, s[8:11], s24 offen offset:2048 lds
v_mfma_f32_16x16x32_bf16 v[140:143], a[136:139], a[104:107], v[140:143]
ds_read_b128 a[36:39], v3 offset:40960
v_accvgpr_read_b32 v43, a203
v_mfma_f32_16x16x32_bf16 v[140:143], a[140:143], a[108:111], v[140:143]
ds_read_b128 a[40:43], v2 offset:43008
v_accvgpr_read_b32 v96, a204
v_mfma_f32_16x16x32_bf16 v[148:151], a[136:139], a[112:115], v[148:151]
ds_read_b128 a[44:47], v3 offset:43008
v_accvgpr_read_b32 v97, a205
v_mfma_f32_16x16x32_bf16 v[148:151], a[140:143], a[116:119], v[148:151]
buffer_load_dwordx4 v15, s[8:11], s24 offen offset:3072 lds
v_mfma_f32_16x16x32_bf16 v[156:159], a[136:139], a[120:123], v[156:159]
s_add_u32 s24, s24, 128
ds_read_b128 a[48:51], v2 offset:45056
v_accvgpr_read_b32 v98, a206
v_mfma_f32_16x16x32_bf16 v[156:159], a[140:143], a[124:127], v[156:159]
s_waitcnt lgkmcnt(5)
buffer_store_dwordx4 v[144:147], v1, s[4:7], s31 offen sc1
v_mfma_f32_16x16x32_bf16 v[164:167], a[128:131], a[64:67], v[164:167]
s_add_u32 s31, s31, s32
ds_read_b64_tr_b16 a[136:137], v25 offset:0
v_accvgpr_read_b32 v99, a207
v_mfma_f32_16x16x32_bf16 v[164:167], a[132:135], a[68:71], v[164:167]
v_cvt_pk_bf16_f32 v40, v40, v41
v_cvt_pk_bf16_f32 v41, v42, v43
v_mfma_f32_16x16x32_bf16 v[172:175], a[128:131], a[72:75], v[172:175]
ds_read_b64_tr_b16 a[138:139], v25 offset:2048
v_cvt_pk_bf16_f32 v42, v96, v97
v_mfma_f32_16x16x32_bf16 v[172:175], a[132:135], a[76:79], v[172:175]
ds_read_b128 a[52:55], v3 offset:45056
v_cvt_pk_bf16_f32 v43, v98, v99
v_mfma_f32_16x16x32_bf16 v[180:183], a[128:131], a[80:83], v[180:183]
ds_read_b64_tr_b16 a[140:141], v25 offset:16384
v_accvgpr_read_b32 v48, a208
v_mfma_f32_16x16x32_bf16 v[180:183], a[132:135], a[84:87], v[180:183]
v_accvgpr_read_b32 v49, a209
v_accvgpr_read_b32 v50, a210
v_mfma_f32_16x16x32_bf16 v[188:191], a[128:131], a[88:91], v[188:191]
ds_read_b64_tr_b16 a[142:143], v25 offset:18432
v_add_u32 v25, 32768, v25
v_mfma_f32_16x16x32_bf16 v[188:191], a[132:135], a[92:95], v[188:191]
v_accvgpr_read_b32 v51, a211
v_accvgpr_read_b32 v96, a212
v_mfma_f32_16x16x32_bf16 v[196:199], a[128:131], a[96:99], v[196:199]
ds_read_b128 a[56:59], v2 offset:47104
v_accvgpr_read_b32 v97, a213
v_mfma_f32_16x16x32_bf16 v[196:199], a[132:135], a[100:103], v[196:199]
v_accvgpr_read_b32 v98, a214
v_accvgpr_read_b32 v99, a215
v_mfma_f32_16x16x32_bf16 v[204:207], a[128:131], a[104:107], v[204:207]
ds_read_b128 a[60:63], v3 offset:47104
v_cvt_pk_bf16_f32 v48, v48, v49
v_mfma_f32_16x16x32_bf16 v[204:207], a[132:135], a[108:111], v[204:207]
v_cvt_pk_bf16_f32 v49, v50, v51
v_cvt_pk_bf16_f32 v50, v96, v97
v_mfma_f32_16x16x32_bf16 v[212:215], a[128:131], a[112:115], v[212:215]
v_cvt_pk_bf16_f32 v51, v98, v99
v_accvgpr_read_b32 v56, a216
v_mfma_f32_16x16x32_bf16 v[212:215], a[132:135], a[116:119], v[212:215]
buffer_store_dwordx4 v[152:155], v1, s[4:7], s31 offen sc1
v_mfma_f32_16x16x32_bf16 v[220:223], a[128:131], a[120:123], v[220:223]
s_add_u32 s31, s31, s36
v_accvgpr_read_b32 v57, a217
v_accvgpr_read_b32 v58, a218
v_mfma_f32_16x16x32_bf16 v[220:223], a[132:135], a[124:127], v[220:223]
s_waitcnt vmcnt(23) lgkmcnt(0)
s_barrier
v_accvgpr_read_b32 v59, a219
v_mfma_f32_16x16x32_bf16 v[224:227], a[136:139], a[64:67], v[224:227]
s_add_u32 m0, s29, 65536
ds_read_b64_tr_b16 a[128:129], v22 offset:0
v_accvgpr_read_b32 v96, a220
v_mfma_f32_16x16x32_bf16 v[224:227], a[140:143], a[68:71], v[224:227]
buffer_load_dwordx4 v16, s[12:15], s26 offen offset:0 lds
v_mfma_f32_16x16x32_bf16 v[228:231], a[136:139], a[72:75], v[228:231]
ds_read_b64_tr_b16 a[130:131], v22 offset:2048
v_accvgpr_read_b32 v97, a221
v_mfma_f32_16x16x32_bf16 v[228:231], a[140:143], a[76:79], v[228:231]
v_accvgpr_read_b32 v98, a222
v_accvgpr_read_b32 v99, a223
v_mfma_f32_16x16x32_bf16 v[232:235], a[136:139], a[80:83], v[232:235]
ds_read_b64_tr_b16 a[132:133], v22 offset:16384
v_cvt_pk_bf16_f32 v56, v56, v57
v_mfma_f32_16x16x32_bf16 v[232:235], a[140:143], a[84:87], v[232:235]
buffer_load_dwordx4 v17, s[12:15], s26 offen offset:1024 lds
v_mfma_f32_16x16x32_bf16 v[236:239], a[136:139], a[88:91], v[236:239]
ds_read_b64_tr_b16 a[134:135], v22 offset:18432
v_add_u32 v22, 32768, v22
v_mfma_f32_16x16x32_bf16 v[236:239], a[140:143], a[92:95], v[236:239]
v_cvt_pk_bf16_f32 v57, v58, v59
v_cvt_pk_bf16_f32 v58, v96, v97
v_mfma_f32_16x16x32_bf16 v[240:243], a[136:139], a[96:99], v[240:243]
v_cvt_pk_bf16_f32 v59, v98, v99
v_accvgpr_read_b32 v64, a224
v_mfma_f32_16x16x32_bf16 v[240:243], a[140:143], a[100:103], v[240:243]
buffer_load_dwordx4 v18, s[12:15], s26 offen offset:2048 lds
v_mfma_f32_16x16x32_bf16 v[244:247], a[136:139], a[104:107], v[244:247]
v_accvgpr_read_b32 v65, a225
v_accvgpr_read_b32 v66, a226
v_mfma_f32_16x16x32_bf16 v[244:247], a[140:143], a[108:111], v[244:247]
v_accvgpr_read_b32 v67, a227
v_accvgpr_read_b32 v96, a228
v_mfma_f32_16x16x32_bf16 v[248:251], a[136:139], a[112:115], v[248:251]
v_accvgpr_read_b32 v97, a229
v_accvgpr_read_b32 v98, a230
v_mfma_f32_16x16x32_bf16 v[248:251], a[140:143], a[116:119], v[248:251]
buffer_load_dwordx4 v19, s[12:15], s26 offen offset:3072 lds
v_mfma_f32_16x16x32_bf16 v[252:255], a[136:139], a[120:123], v[252:255]
s_add_u32 s26, s26, 524288
v_accvgpr_read_b32 v99, a231
v_cvt_pk_bf16_f32 v64, v64, v65
v_mfma_f32_16x16x32_bf16 v[252:255], a[140:143], a[124:127], v[252:255]
s_waitcnt lgkmcnt(0)
v_cvt_pk_bf16_f32 v65, v66, v67
v_cvt_pk_bf16_f32 v66, v96, v97
v_mfma_f32_16x16x32_bf16 v[36:39], a[128:131], a[0:3], v[36:39]
s_add_u32 m0, s29, 81920
ds_read_b64_tr_b16 a[136:137], v23 offset:0
v_cvt_pk_bf16_f32 v67, v98, v99
v_mfma_f32_16x16x32_bf16 v[36:39], a[132:135], a[4:7], v[36:39]
buffer_load_dwordx4 v16, s[12:15], s27 offen offset:0 lds
v_mfma_f32_16x16x32_bf16 v[44:47], a[128:131], a[8:11], v[44:47]
ds_read_b64_tr_b16 a[138:139], v23 offset:2048
v_accvgpr_read_b32 v72, a232
v_mfma_f32_16x16x32_bf16 v[44:47], a[132:135], a[12:15], v[44:47]
ds_read_b128 a[64:67], v2 offset:49152
ds_read_b128 a[68:71], v3 offset:49152
v_mfma_f32_16x16x32_bf16 v[52:55], a[128:131], a[16:19], v[52:55]
ds_read_b64_tr_b16 a[140:141], v23 offset:16384
v_accvgpr_read_b32 v73, a233
v_mfma_f32_16x16x32_bf16 v[52:55], a[132:135], a[20:23], v[52:55]
buffer_load_dwordx4 v17, s[12:15], s27 offen offset:1024 lds
v_mfma_f32_16x16x32_bf16 v[60:63], a[128:131], a[24:27], v[60:63]
ds_read_b64_tr_b16 a[142:143], v23 offset:18432
v_add_u32 v23, 32768, v23
v_mfma_f32_16x16x32_bf16 v[60:63], a[132:135], a[28:31], v[60:63]
buffer_store_dwordx4 v[160:163], v1, s[4:7], s31 offen sc1
v_mfma_f32_16x16x32_bf16 v[68:71], a[128:131], a[32:35], v[68:71]
s_add_u32 s31, s31, s32
ds_read_b128 a[72:75], v2 offset:51200
v_accvgpr_read_b32 v74, a234
v_mfma_f32_16x16x32_bf16 v[68:71], a[132:135], a[36:39], v[68:71]
buffer_load_dwordx4 v18, s[12:15], s27 offen offset:2048 lds
v_mfma_f32_16x16x32_bf16 v[76:79], a[128:131], a[40:43], v[76:79]
ds_read_b128 a[76:79], v3 offset:51200
v_accvgpr_read_b32 v75, a235
v_mfma_f32_16x16x32_bf16 v[76:79], a[132:135], a[44:47], v[76:79]
ds_read_b128 a[80:83], v2 offset:53248
v_accvgpr_read_b32 v96, a236
v_mfma_f32_16x16x32_bf16 v[84:87], a[128:131], a[48:51], v[84:87]
ds_read_b128 a[84:87], v3 offset:53248
v_accvgpr_read_b32 v97, a237
v_mfma_f32_16x16x32_bf16 v[84:87], a[132:135], a[52:55], v[84:87]
buffer_load_dwordx4 v19, s[12:15], s27 offen offset:3072 lds
v_mfma_f32_16x16x32_bf16 v[92:95], a[128:131], a[56:59], v[92:95]
s_add_u32 s27, s27, 524288
ds_read_b128 a[88:91], v2 offset:55296
v_accvgpr_read_b32 v98, a238
v_mfma_f32_16x16x32_bf16 v[92:95], a[132:135], a[60:63], v[92:95]
s_waitcnt lgkmcnt(5)
buffer_store_dwordx4 v[168:171], v1, s[4:7], s31 offen sc1
v_mfma_f32_16x16x32_bf16 v[100:103], a[136:139], a[0:3], v[100:103]
s_add_u32 m0, s28, 32768
ds_read_b64_tr_b16 a[128:129], v24 offset:0
v_accvgpr_read_b32 v99, a239
v_mfma_f32_16x16x32_bf16 v[100:103], a[140:143], a[4:7], v[100:103]
s_add_u32 s31, s31, s33
buffer_load_dwordx4 v12, s[8:11], s24 offen offset:0 lds
v_mfma_f32_16x16x32_bf16 v[108:111], a[136:139], a[8:11], v[108:111]
ds_read_b64_tr_b16 a[130:131], v24 offset:2048
v_cvt_pk_bf16_f32 v72, v72, v73
v_mfma_f32_16x16x32_bf16 v[108:111], a[140:143], a[12:15], v[108:111]
ds_read_b128 a[92:95], v3 offset:55296
v_cvt_pk_bf16_f32 v73, v74, v75
v_mfma_f32_16x16x32_bf16 v[116:119], a[136:139], a[16:19], v[116:119]
ds_read_b64_tr_b16 a[132:133], v24 offset:16384
v_cvt_pk_bf16_f32 v74, v96, v97
v_mfma_f32_16x16x32_bf16 v[116:119], a[140:143], a[20:23], v[116:119]
buffer_load_dwordx4 v13, s[8:11], s24 offen offset:1024 lds
v_mfma_f32_16x16x32_bf16 v[124:127], a[136:139], a[24:27], v[124:127]
ds_read_b64_tr_b16 a[134:135], v24 offset:18432
v_add_u32 v24, 32768, v24
v_mfma_f32_16x16x32_bf16 v[124:127], a[140:143], a[28:31], v[124:127]
v_cvt_pk_bf16_f32 v75, v98, v99
v_accvgpr_read_b32 v80, a240
v_mfma_f32_16x16x32_bf16 v[132:135], a[136:139], a[32:35], v[132:135]
ds_read_b128 a[96:99], v2 offset:57344
v_accvgpr_read_b32 v81, a241
v_mfma_f32_16x16x32_bf16 v[132:135], a[140:143], a[36:39], v[132:135]
buffer_load_dwordx4 v14, s[8:11], s24 offen offset:2048 lds
v_mfma_f32_16x16x32_bf16 v[140:143], a[136:139], a[40:43], v[140:143]
ds_read_b128 a[100:103], v3 offset:57344
v_accvgpr_read_b32 v82, a242
v_mfma_f32_16x16x32_bf16 v[140:143], a[140:143], a[44:47], v[140:143]
ds_read_b128 a[104:107], v2 offset:59392
v_accvgpr_read_b32 v83, a243
v_mfma_f32_16x16x32_bf16 v[148:151], a[136:139], a[48:51], v[148:151]
ds_read_b128 a[108:111], v3 offset:59392
v_accvgpr_read_b32 v96, a244
v_mfma_f32_16x16x32_bf16 v[148:151], a[140:143], a[52:55], v[148:151]
buffer_load_dwordx4 v15, s[8:11], s24 offen offset:3072 lds
v_mfma_f32_16x16x32_bf16 v[156:159], a[136:139], a[56:59], v[156:159]
s_add_u32 s24, s24, 128
ds_read_b128 a[112:115], v2 offset:61440
v_accvgpr_read_b32 v97, a245
v_mfma_f32_16x16x32_bf16 v[156:159], a[140:143], a[60:63], v[156:159]
s_waitcnt lgkmcnt(5)
buffer_store_dwordx4 v[176:179], v1, s[4:7], s31 offen sc1
v_mfma_f32_16x16x32_bf16 v[164:167], a[128:131], a[0:3], v[164:167]
s_add_u32 s31, s31, s32
ds_read_b64_tr_b16 a[136:137], v25 offset:0
v_accvgpr_read_b32 v98, a246
v_mfma_f32_16x16x32_bf16 v[164:167], a[132:135], a[4:7], v[164:167]
v_accvgpr_read_b32 v99, a247
v_cvt_pk_bf16_f32 v80, v80, v81
v_mfma_f32_16x16x32_bf16 v[172:175], a[128:131], a[8:11], v[172:175]
ds_read_b64_tr_b16 a[138:139], v25 offset:2048
v_cvt_pk_bf16_f32 v81, v82, v83
v_mfma_f32_16x16x32_bf16 v[172:175], a[132:135], a[12:15], v[172:175]
ds_read_b128 a[116:119], v3 offset:61440
v_cvt_pk_bf16_f32 v82, v96, v97
v_mfma_f32_16x16x32_bf16 v[180:183], a[128:131], a[16:19], v[180:183]
ds_read_b64_tr_b16 a[140:141], v25 offset:16384
v_cvt_pk_bf16_f32 v83, v98, v99
v_mfma_f32_16x16x32_bf16 v[180:183], a[132:135], a[20:23], v[180:183]
buffer_store_dwordx4 v[184:187], v1, s[4:7], s31 offen sc1
v_mfma_f32_16x16x32_bf16 v[188:191], a[128:131], a[24:27], v[188:191]
s_add_u32 s31, s31, s34
ds_read_b64_tr_b16 a[142:143], v25 offset:18432
v_add_u32 v25, 32768, v25
v_mfma_f32_16x16x32_bf16 v[188:191], a[132:135], a[28:31], v[188:191]
v_accvgpr_read_b32 v88, a248
v_accvgpr_read_b32 v89, a249
v_mfma_f32_16x16x32_bf16 v[196:199], a[128:131], a[32:35], v[196:199]
ds_read_b128 a[120:123], v2 offset:63488
v_accvgpr_read_b32 v90, a250
v_mfma_f32_16x16x32_bf16 v[196:199], a[132:135], a[36:39], v[196:199]
v_accvgpr_read_b32 v91, a251
v_accvgpr_read_b32 v96, a252
v_mfma_f32_16x16x32_bf16 v[204:207], a[128:131], a[40:43], v[204:207]
ds_read_b128 a[124:127], v3 offset:63488
v_accvgpr_read_b32 v97, a253
v_mfma_f32_16x16x32_bf16 v[204:207], a[132:135], a[44:47], v[204:207]
v_accvgpr_read_b32 v98, a254
v_accvgpr_read_b32 v99, a255
v_mfma_f32_16x16x32_bf16 v[212:215], a[128:131], a[48:51], v[212:215]
v_cvt_pk_bf16_f32 v88, v88, v89
v_cvt_pk_bf16_f32 v89, v90, v91
v_mfma_f32_16x16x32_bf16 v[212:215], a[132:135], a[52:55], v[212:215]
v_cvt_pk_bf16_f32 v90, v96, v97
v_cvt_pk_bf16_f32 v91, v98, v99
v_mfma_f32_16x16x32_bf16 v[220:223], a[128:131], a[56:59], v[220:223]
v_mfma_f32_16x16x32_bf16 v[220:223], a[132:135], a[60:63], v[220:223]
s_waitcnt vmcnt(23) lgkmcnt(0)
s_barrier
v_mfma_f32_16x16x32_bf16 v[224:227], a[136:139], a[0:3], v[224:227]
s_add_u32 m0, s29, 98304
ds_read_b64_tr_b16 a[128:129], v22 offset:0
v_mfma_f32_16x16x32_bf16 v[224:227], a[140:143], a[4:7], v[224:227]
buffer_load_dwordx4 v16, s[12:15], s26 offen offset:0 lds
v_mfma_f32_16x16x32_bf16 v[228:231], a[136:139], a[8:11], v[228:231]
ds_read_b64_tr_b16 a[130:131], v22 offset:2048
v_mfma_f32_16x16x32_bf16 v[228:231], a[140:143], a[12:15], v[228:231]
buffer_store_dwordx4 v[192:195], v1, s[4:7], s31 offen sc1
v_mfma_f32_16x16x32_bf16 v[232:235], a[136:139], a[16:19], v[232:235]
s_add_u32 s31, s31, s32
ds_read_b64_tr_b16 a[132:133], v22 offset:16384
v_mfma_f32_16x16x32_bf16 v[232:235], a[140:143], a[20:23], v[232:235]
buffer_load_dwordx4 v17, s[12:15], s26 offen offset:1024 lds
v_mfma_f32_16x16x32_bf16 v[236:239], a[136:139], a[24:27], v[236:239]
ds_read_b64_tr_b16 a[134:135], v22 offset:18432
v_add_u32 v22, 4294901760, v22
v_mfma_f32_16x16x32_bf16 v[236:239], a[140:143], a[28:31], v[236:239]
v_mfma_f32_16x16x32_bf16 v[240:243], a[136:139], a[32:35], v[240:243]
v_mfma_f32_16x16x32_bf16 v[240:243], a[140:143], a[36:39], v[240:243]
buffer_load_dwordx4 v18, s[12:15], s26 offen offset:2048 lds
v_mfma_f32_16x16x32_bf16 v[244:247], a[136:139], a[40:43], v[244:247]
v_mfma_f32_16x16x32_bf16 v[244:247], a[140:143], a[44:47], v[244:247]
v_mfma_f32_16x16x32_bf16 v[248:251], a[136:139], a[48:51], v[248:251]
v_mfma_f32_16x16x32_bf16 v[248:251], a[140:143], a[52:55], v[248:251]
buffer_load_dwordx4 v19, s[12:15], s26 offen offset:3072 lds
v_mfma_f32_16x16x32_bf16 v[252:255], a[136:139], a[56:59], v[252:255]
s_add_u32 s26, s26, 524288
v_mfma_f32_16x16x32_bf16 v[252:255], a[140:143], a[60:63], v[252:255]
s_waitcnt lgkmcnt(0)
v_mfma_f32_16x16x32_bf16 v[36:39], a[128:131], a[64:67], v[36:39]
s_add_u32 m0, s29, 114688
ds_read_b64_tr_b16 a[136:137], v23 offset:0
v_mfma_f32_16x16x32_bf16 v[36:39], a[132:135], a[68:71], v[36:39]
buffer_load_dwordx4 v16, s[12:15], s27 offen offset:0 lds
v_mfma_f32_16x16x32_bf16 v[44:47], a[128:131], a[72:75], v[44:47]
ds_read_b64_tr_b16 a[138:139], v23 offset:2048
v_mfma_f32_16x16x32_bf16 v[44:47], a[132:135], a[76:79], v[44:47]
ds_read_b128 a[0:3], v2 offset:0
ds_read_b128 a[4:7], v3 offset:0
v_mfma_f32_16x16x32_bf16 v[52:55], a[128:131], a[80:83], v[52:55]
ds_read_b64_tr_b16 a[140:141], v23 offset:16384
v_mfma_f32_16x16x32_bf16 v[52:55], a[132:135], a[84:87], v[52:55]
buffer_load_dwordx4 v17, s[12:15], s27 offen offset:1024 lds
v_mfma_f32_16x16x32_bf16 v[60:63], a[128:131], a[88:91], v[60:63]
ds_read_b64_tr_b16 a[142:143], v23 offset:18432
v_add_u32 v23, 4294901760, v23
v_mfma_f32_16x16x32_bf16 v[60:63], a[132:135], a[92:95], v[60:63]
buffer_store_dwordx4 v[200:203], v1, s[4:7], s31 offen sc1
v_mfma_f32_16x16x32_bf16 v[68:71], a[128:131], a[96:99], v[68:71]
s_add_u32 s31, s31, s33
ds_read_b128 a[8:11], v2 offset:2048
v_mfma_f32_16x16x32_bf16 v[68:71], a[132:135], a[100:103], v[68:71]
buffer_load_dwordx4 v18, s[12:15], s27 offen offset:2048 lds
v_mfma_f32_16x16x32_bf16 v[76:79], a[128:131], a[104:107], v[76:79]
ds_read_b128 a[12:15], v3 offset:2048
v_mfma_f32_16x16x32_bf16 v[76:79], a[132:135], a[108:111], v[76:79]
ds_read_b128 a[16:19], v2 offset:4096
v_mfma_f32_16x16x32_bf16 v[84:87], a[128:131], a[112:115], v[84:87]
ds_read_b128 a[20:23], v3 offset:4096
v_mfma_f32_16x16x32_bf16 v[84:87], a[132:135], a[116:119], v[84:87]
buffer_load_dwordx4 v19, s[12:15], s27 offen offset:3072 lds
v_mfma_f32_16x16x32_bf16 v[92:95], a[128:131], a[120:123], v[92:95]
s_add_u32 s27, s27, 524288
ds_read_b128 a[24:27], v2 offset:6144
v_mfma_f32_16x16x32_bf16 v[92:95], a[132:135], a[124:127], v[92:95]
s_waitcnt lgkmcnt(5)
buffer_store_dwordx4 v[208:211], v1, s[4:7], s31 offen sc1
v_mfma_f32_16x16x32_bf16 v[100:103], a[136:139], a[64:67], v[100:103]
s_add_u32 s31, s31, s32
ds_read_b64_tr_b16 a[128:129], v24 offset:0
v_mfma_f32_16x16x32_bf16 v[100:103], a[140:143], a[68:71], v[100:103]
v_mfma_f32_16x16x32_bf16 v[108:111], a[136:139], a[72:75], v[108:111]
ds_read_b64_tr_b16 a[130:131], v24 offset:2048
v_mfma_f32_16x16x32_bf16 v[108:111], a[140:143], a[76:79], v[108:111]
ds_read_b128 a[28:31], v3 offset:6144
v_mfma_f32_16x16x32_bf16 v[116:119], a[136:139], a[80:83], v[116:119]
ds_read_b64_tr_b16 a[132:133], v24 offset:16384
v_mfma_f32_16x16x32_bf16 v[116:119], a[140:143], a[84:87], v[116:119]
v_mfma_f32_16x16x32_bf16 v[124:127], a[136:139], a[88:91], v[124:127]
ds_read_b64_tr_b16 a[134:135], v24 offset:18432
v_add_u32 v24, 4294901760, v24
v_mfma_f32_16x16x32_bf16 v[124:127], a[140:143], a[92:95], v[124:127]
v_mfma_f32_16x16x32_bf16 v[132:135], a[136:139], a[96:99], v[132:135]
ds_read_b128 a[32:35], v2 offset:8192
v_mfma_f32_16x16x32_bf16 v[132:135], a[140:143], a[100:103], v[132:135]
buffer_store_dwordx4 v[216:219], v1, s[4:7], s31 offen sc1
v_mfma_f32_16x16x32_bf16 v[140:143], a[136:139], a[104:107], v[140:143]
s_add_u32 s31, s31, s35
ds_read_b128 a[36:39], v3 offset:8192
v_mfma_f32_16x16x32_bf16 v[140:143], a[140:143], a[108:111], v[140:143]
ds_read_b128 a[40:43], v2 offset:10240
v_mfma_f32_16x16x32_bf16 v[148:151], a[136:139], a[112:115], v[148:151]
ds_read_b128 a[44:47], v3 offset:10240
v_mfma_f32_16x16x32_bf16 v[148:151], a[140:143], a[116:119], v[148:151]
v_mfma_f32_16x16x32_bf16 v[156:159], a[136:139], a[120:123], v[156:159]
ds_read_b128 a[48:51], v2 offset:12288
v_mfma_f32_16x16x32_bf16 v[156:159], a[140:143], a[124:127], v[156:159]
s_waitcnt lgkmcnt(5)
v_mfma_f32_16x16x32_bf16 v[164:167], a[128:131], a[64:67], v[164:167]
ds_read_b64_tr_b16 a[136:137], v25 offset:0
v_mfma_f32_16x16x32_bf16 v[164:167], a[132:135], a[68:71], v[164:167]
v_mfma_f32_16x16x32_bf16 v[172:175], a[128:131], a[72:75], v[172:175]
ds_read_b64_tr_b16 a[138:139], v25 offset:2048
v_mfma_f32_16x16x32_bf16 v[172:175], a[132:135], a[76:79], v[172:175]
ds_read_b128 a[52:55], v3 offset:12288
v_mfma_f32_16x16x32_bf16 v[180:183], a[128:131], a[80:83], v[180:183]
ds_read_b64_tr_b16 a[140:141], v25 offset:16384
v_mfma_f32_16x16x32_bf16 v[180:183], a[132:135], a[84:87], v[180:183]
buffer_store_dwordx4 v[32:35], v1, s[4:7], s31 offen sc1
v_mfma_f32_16x16x32_bf16 v[188:191], a[128:131], a[88:91], v[188:191]
s_add_u32 s31, s31, s32
ds_read_b64_tr_b16 a[142:143], v25 offset:18432
v_add_u32 v25, 4294901760, v25
v_mfma_f32_16x16x32_bf16 v[188:191], a[132:135], a[92:95], v[188:191]
v_mfma_f32_16x16x32_bf16 v[196:199], a[128:131], a[96:99], v[196:199]
ds_read_b128 a[56:59], v2 offset:14336
v_mfma_f32_16x16x32_bf16 v[196:199], a[132:135], a[100:103], v[196:199]
v_mfma_f32_16x16x32_bf16 v[204:207], a[128:131], a[104:107], v[204:207]
ds_read_b128 a[60:63], v3 offset:14336
v_mfma_f32_16x16x32_bf16 v[204:207], a[132:135], a[108:111], v[204:207]
v_mfma_f32_16x16x32_bf16 v[212:215], a[128:131], a[112:115], v[212:215]
v_mfma_f32_16x16x32_bf16 v[212:215], a[132:135], a[116:119], v[212:215]
v_mfma_f32_16x16x32_bf16 v[220:223], a[128:131], a[120:123], v[220:223]
v_mfma_f32_16x16x32_bf16 v[220:223], a[132:135], a[124:127], v[220:223]
s_waitcnt vmcnt(20) lgkmcnt(0)
s_barrier
v_mfma_f32_16x16x32_bf16 v[224:227], a[136:139], a[64:67], v[224:227]
s_add_u32 m0, s29, 131072
ds_read_b64_tr_b16 a[128:129], v22 offset:0
v_mfma_f32_16x16x32_bf16 v[224:227], a[140:143], a[68:71], v[224:227]
buffer_load_dwordx4 v16, s[12:15], s26 offen offset:0 lds
v_mfma_f32_16x16x32_bf16 v[228:231], a[136:139], a[72:75], v[228:231]
ds_read_b64_tr_b16 a[130:131], v22 offset:2048
v_mfma_f32_16x16x32_bf16 v[228:231], a[140:143], a[76:79], v[228:231]
PAD_7:
s_cbranch_execz M_tret
buffer_store_dwordx4 v[40:43], v1, s[4:7], s31 offen sc1
v_mfma_f32_16x16x32_bf16 v[232:235], a[136:139], a[80:83], v[232:235]
s_add_u32 s31, s31, s33
ds_read_b64_tr_b16 a[132:133], v22 offset:16384
v_mfma_f32_16x16x32_bf16 v[232:235], a[140:143], a[84:87], v[232:235]
buffer_load_dwordx4 v17, s[12:15], s26 offen offset:1024 lds
v_mfma_f32_16x16x32_bf16 v[236:239], a[136:139], a[88:91], v[236:239]
ds_read_b64_tr_b16 a[134:135], v22 offset:18432
v_add_u32 v22, 32768, v22
v_mfma_f32_16x16x32_bf16 v[236:239], a[140:143], a[92:95], v[236:239]
v_mfma_f32_16x16x32_bf16 v[240:243], a[136:139], a[96:99], v[240:243]
v_mfma_f32_16x16x32_bf16 v[240:243], a[140:143], a[100:103], v[240:243]
buffer_load_dwordx4 v18, s[12:15], s26 offen offset:2048 lds
v_mfma_f32_16x16x32_bf16 v[244:247], a[136:139], a[104:107], v[244:247]
v_mfma_f32_16x16x32_bf16 v[244:247], a[140:143], a[108:111], v[244:247]
v_mfma_f32_16x16x32_bf16 v[248:251], a[136:139], a[112:115], v[248:251]
v_mfma_f32_16x16x32_bf16 v[248:251], a[140:143], a[116:119], v[248:251]
buffer_load_dwordx4 v19, s[12:15], s26 offen offset:3072 lds
v_mfma_f32_16x16x32_bf16 v[252:255], a[136:139], a[120:123], v[252:255]
s_add_u32 s26, s26, 524288
v_mfma_f32_16x16x32_bf16 v[252:255], a[140:143], a[124:127], v[252:255]
s_waitcnt lgkmcnt(0)
v_mfma_f32_16x16x32_bf16 v[36:39], a[128:131], a[0:3], v[36:39]
s_add_u32 m0, s29, 147456
ds_read_b64_tr_b16 a[136:137], v23 offset:0
v_mfma_f32_16x16x32_bf16 v[36:39], a[132:135], a[4:7], v[36:39]
buffer_load_dwordx4 v16, s[12:15], s27 offen offset:0 lds
v_mfma_f32_16x16x32_bf16 v[44:47], a[128:131], a[8:11], v[44:47]
s_lshl_b32 s22, s20, 7
ds_read_b64_tr_b16 a[138:139], v23 offset:2048
v_bfe_u32 v20, v1, 4, 3
v_mfma_f32_16x16x32_bf16 v[44:47], a[132:135], a[12:15], v[44:47]
s_add_u32 s70, s22, 94371840
ds_read_b128 a[64:67], v2 offset:16384
ds_read_b128 a[68:71], v3 offset:16384
v_mfma_f32_16x16x32_bf16 v[52:55], a[128:131], a[16:19], v[52:55]
s_lshr_b32 s22, s2, 4
ds_read_b64_tr_b16 a[140:141], v23 offset:16384
v_lshlrev_b32 v20, 3, v20
v_mfma_f32_16x16x32_bf16 v[52:55], a[132:135], a[20:23], v[52:55]
s_lshl_b32 s22, s22, 2
buffer_load_dwordx4 v17, s[12:15], s27 offen offset:1024 lds
v_mfma_f32_16x16x32_bf16 v[60:63], a[128:131], a[24:27], v[60:63]
s_add_u32 s66, s70, s22
ds_read_b64_tr_b16 a[142:143], v23 offset:18432
v_add_u32 v23, 32768, v23
v_mfma_f32_16x16x32_bf16 v[60:63], a[132:135], a[28:31], v[60:63]
s_and_b32 s22, s2, 16
buffer_store_dwordx4 v[48:51], v1, s[4:7], s31 offen sc1
v_mfma_f32_16x16x32_bf16 v[68:71], a[128:131], a[32:35], v[68:71]
s_add_u32 s31, s31, s32
ds_read_b128 a[72:75], v2 offset:18432
v_add_u32 v15, 2052, v20
v_mfma_f32_16x16x32_bf16 v[68:71], a[132:135], a[36:39], v[68:71]
s_lshl_b32 s22, s22, 7
buffer_load_dwordx4 v18, s[12:15], s27 offen offset:2048 lds
v_mfma_f32_16x16x32_bf16 v[76:79], a[128:131], a[40:43], v[76:79]
s_add_u32 s66, s66, s22
ds_read_b128 a[76:79], v3 offset:18432
v_mfma_f32_16x16x32_bf16 v[76:79], a[132:135], a[44:47], v[76:79]
s_lshl_b32 s67, s20, 20
ds_read_b128 a[80:83], v2 offset:20480
v_mfma_f32_16x16x32_bf16 v[84:87], a[128:131], a[48:51], v[84:87]
s_lshl_b32 s22, s37, 16
ds_read_b128 a[84:87], v3 offset:20480
v_mfma_f32_16x16x32_bf16 v[84:87], a[132:135], a[52:55], v[84:87]
s_add_u32 s67, s67, s22
buffer_load_dwordx4 v19, s[12:15], s27 offen offset:3072 lds
v_mfma_f32_16x16x32_bf16 v[92:95], a[128:131], a[56:59], v[92:95]
s_waitcnt lgkmcnt(5)
s_add_u32 s27, s27, 524288
ds_read_b128 a[88:91], v2 offset:22528
v_mfma_f32_16x16x32_bf16 v[92:95], a[132:135], a[60:63], v[92:95]
s_lshl_b32 s22, s3, 11
buffer_store_dwordx4 v[56:59], v1, s[4:7], s31 offen sc1
v_mfma_f32_16x16x32_bf16 v[100:103], a[136:139], a[0:3], v[100:103]
s_waitcnt lgkmcnt(5)
s_add_u32 s31, s31, s34
ds_read_b64_tr_b16 a[128:129], v24 offset:0
v_mfma_f32_16x16x32_bf16 v[100:103], a[140:143], a[4:7], v[100:103]
s_add_u32 s67, s67, s22
v_mfma_f32_16x16x32_bf16 v[108:111], a[136:139], a[8:11], v[108:111]
s_add_u32 s67, s67, 33554432
ds_read_b64_tr_b16 a[130:131], v24 offset:2048
v_mfma_f32_16x16x32_bf16 v[108:111], a[140:143], a[12:15], v[108:111]
s_mov_b32 s68, 1035512379
ds_read_b128 a[92:95], v3 offset:22528
v_mfma_f32_16x16x32_bf16 v[116:119], a[136:139], a[16:19], v[116:119]
s_mov_b32 s69, 1035512379
ds_read_b64_tr_b16 a[132:133], v24 offset:16384
v_mfma_f32_16x16x32_bf16 v[116:119], a[140:143], a[20:23], v[116:119]
buffer_store_dwordx4 v[64:67], v1, s[4:7], s31 offen sc1
v_mfma_f32_16x16x32_bf16 v[124:127], a[136:139], a[24:27], v[124:127]
s_add_u32 s31, s31, s32
ds_read_b64_tr_b16 a[134:135], v24 offset:18432
v_add_u32 v24, 32768, v24
v_mfma_f32_16x16x32_bf16 v[124:127], a[140:143], a[28:31], v[124:127]
v_mfma_f32_16x16x32_bf16 v[132:135], a[136:139], a[32:35], v[132:135]
ds_read_b128 a[96:99], v2 offset:24576
v_mfma_f32_16x16x32_bf16 v[132:135], a[140:143], a[36:39], v[132:135]
v_mfma_f32_16x16x32_bf16 v[140:143], a[136:139], a[40:43], v[140:143]
ds_read_b128 a[100:103], v3 offset:24576
v_mfma_f32_16x16x32_bf16 v[140:143], a[140:143], a[44:47], v[140:143]
ds_read_b128 a[104:107], v2 offset:26624
v_mfma_f32_16x16x32_bf16 v[148:151], a[136:139], a[48:51], v[148:151]
ds_read_b128 a[108:111], v3 offset:26624
v_mfma_f32_16x16x32_bf16 v[148:151], a[140:143], a[52:55], v[148:151]
v_mfma_f32_16x16x32_bf16 v[156:159], a[136:139], a[56:59], v[156:159]
ds_read_b128 a[112:115], v2 offset:28672
v_mfma_f32_16x16x32_bf16 v[156:159], a[140:143], a[60:63], v[156:159]
s_waitcnt lgkmcnt(5)
buffer_store_dwordx4 v[72:75], v1, s[4:7], s31 offen sc1
v_mfma_f32_16x16x32_bf16 v[164:167], a[128:131], a[0:3], v[164:167]
s_add_u32 s31, s31, s33
ds_read_b64_tr_b16 a[136:137], v25 offset:0
v_mfma_f32_16x16x32_bf16 v[164:167], a[132:135], a[4:7], v[164:167]
v_mfma_f32_16x16x32_bf16 v[172:175], a[128:131], a[8:11], v[172:175]
ds_read_b64_tr_b16 a[138:139], v25 offset:2048
v_mfma_f32_16x16x32_bf16 v[172:175], a[132:135], a[12:15], v[172:175]
ds_read_b128 a[116:119], v3 offset:28672
v_mfma_f32_16x16x32_bf16 v[180:183], a[128:131], a[16:19], v[180:183]
ds_read_b64_tr_b16 a[140:141], v25 offset:16384
v_mfma_f32_16x16x32_bf16 v[180:183], a[132:135], a[20:23], v[180:183]
v_mfma_f32_16x16x32_bf16 v[188:191], a[128:131], a[24:27], v[188:191]
ds_read_b64_tr_b16 a[142:143], v25 offset:18432
v_add_u32 v25, 32768, v25
v_mfma_f32_16x16x32_bf16 v[188:191], a[132:135], a[28:31], v[188:191]
v_mfma_f32_16x16x32_bf16 v[196:199], a[128:131], a[32:35], v[196:199]
ds_read_b128 a[120:123], v2 offset:30720
v_mfma_f32_16x16x32_bf16 v[196:199], a[132:135], a[36:39], v[196:199]
buffer_store_dwordx4 v[80:83], v1, s[4:7], s31 offen sc1
v_mfma_f32_16x16x32_bf16 v[204:207], a[128:131], a[40:43], v[204:207]
s_add_u32 s31, s31, s32
ds_read_b128 a[124:127], v3 offset:30720
v_mfma_f32_16x16x32_bf16 v[204:207], a[132:135], a[44:47], v[204:207]
v_mfma_f32_16x16x32_bf16 v[212:215], a[128:131], a[48:51], v[212:215]
v_mfma_f32_16x16x32_bf16 v[212:215], a[132:135], a[52:55], v[212:215]
v_mfma_f32_16x16x32_bf16 v[220:223], a[128:131], a[56:59], v[220:223]
v_mfma_f32_16x16x32_bf16 v[220:223], a[132:135], a[60:63], v[220:223]
s_waitcnt vmcnt(17) lgkmcnt(0)
s_barrier
v_mfma_f32_16x16x32_bf16 v[224:227], a[136:139], a[0:3], v[224:227]
ds_read_b64_tr_b16 a[128:129], v22 offset:0
v_mfma_f32_16x16x32_bf16 v[224:227], a[140:143], a[4:7], v[224:227]
v_mfma_f32_16x16x32_bf16 v[228:231], a[136:139], a[8:11], v[228:231]
ds_read_b64_tr_b16 a[130:131], v22 offset:2048
v_mfma_f32_16x16x32_bf16 v[228:231], a[140:143], a[12:15], v[228:231]
buffer_store_dwordx4 v[88:91], v1, s[4:7], s31 offen sc1
v_mfma_f32_16x16x32_bf16 v[232:235], a[136:139], a[16:19], v[232:235]
ds_read_b64_tr_b16 a[132:133], v22 offset:16384
v_mfma_f32_16x16x32_bf16 v[232:235], a[140:143], a[20:23], v[232:235]
v_mfma_f32_16x16x32_bf16 v[236:239], a[136:139], a[24:27], v[236:239]
ds_read_b64_tr_b16 a[134:135], v22 offset:18432
v_add_u32 v22, 32768, v22
v_mfma_f32_16x16x32_bf16 v[236:239], a[140:143], a[28:31], v[236:239]
v_mfma_f32_16x16x32_bf16 v[240:243], a[136:139], a[32:35], v[240:243]
v_mfma_f32_16x16x32_bf16 v[240:243], a[140:143], a[36:39], v[240:243]
v_mfma_f32_16x16x32_bf16 v[244:247], a[136:139], a[40:43], v[244:247]
v_mfma_f32_16x16x32_bf16 v[244:247], a[140:143], a[44:47], v[244:247]
v_mfma_f32_16x16x32_bf16 v[248:251], a[136:139], a[48:51], v[248:251]
v_mfma_f32_16x16x32_bf16 v[248:251], a[140:143], a[52:55], v[248:251]
v_mfma_f32_16x16x32_bf16 v[252:255], a[136:139], a[56:59], v[252:255]
v_mfma_f32_16x16x32_bf16 v[252:255], a[140:143], a[60:63], v[252:255]
s_waitcnt lgkmcnt(0)
v_mfma_f32_16x16x32_bf16 v[36:39], a[128:131], a[64:67], v[36:39]
ds_read_b64_tr_b16 a[136:137], v23 offset:0
v_mfma_f32_16x16x32_bf16 v[36:39], a[132:135], a[68:71], v[36:39]
v_mfma_f32_16x16x32_bf16 v[44:47], a[128:131], a[72:75], v[44:47]
ds_read_b64_tr_b16 a[138:139], v23 offset:2048
v_mfma_f32_16x16x32_bf16 v[44:47], a[132:135], a[76:79], v[44:47]
ds_read_b128 a[0:3], v2 offset:32768
ds_read_b128 a[4:7], v3 offset:32768
v_mfma_f32_16x16x32_bf16 v[52:55], a[128:131], a[80:83], v[52:55]
ds_read_b64_tr_b16 a[140:141], v23 offset:16384
v_mfma_f32_16x16x32_bf16 v[52:55], a[132:135], a[84:87], v[52:55]
v_mfma_f32_16x16x32_bf16 v[60:63], a[128:131], a[88:91], v[60:63]
ds_read_b64_tr_b16 a[142:143], v23 offset:18432
v_add_u32 v23, 32768, v23
v_mfma_f32_16x16x32_bf16 v[60:63], a[132:135], a[92:95], v[60:63]
v_mfma_f32_16x16x32_bf16 v[68:71], a[128:131], a[96:99], v[68:71]
ds_read_b128 a[8:11], v2 offset:34816
v_mfma_f32_16x16x32_bf16 v[68:71], a[132:135], a[100:103], v[68:71]
v_mfma_f32_16x16x32_bf16 v[76:79], a[128:131], a[104:107], v[76:79]
ds_read_b128 a[12:15], v3 offset:34816
v_mfma_f32_16x16x32_bf16 v[76:79], a[132:135], a[108:111], v[76:79]
ds_read_b128 a[16:19], v2 offset:36864
v_mfma_f32_16x16x32_bf16 v[84:87], a[128:131], a[112:115], v[84:87]
ds_read_b128 a[20:23], v3 offset:36864
v_mfma_f32_16x16x32_bf16 v[84:87], a[132:135], a[116:119], v[84:87]
v_mfma_f32_16x16x32_bf16 v[92:95], a[128:131], a[120:123], v[92:95]
ds_read_b128 a[24:27], v2 offset:38912
v_mfma_f32_16x16x32_bf16 v[92:95], a[132:135], a[124:127], v[92:95]
s_waitcnt lgkmcnt(5)
v_mfma_f32_16x16x32_bf16 v[100:103], a[136:139], a[64:67], v[100:103]
ds_read_b64_tr_b16 a[128:129], v24 offset:0
v_mfma_f32_16x16x32_bf16 v[100:103], a[140:143], a[68:71], v[100:103]
v_mfma_f32_16x16x32_bf16 v[108:111], a[136:139], a[72:75], v[108:111]
ds_read_b64_tr_b16 a[130:131], v24 offset:2048
v_mfma_f32_16x16x32_bf16 v[108:111], a[140:143], a[76:79], v[108:111]
ds_read_b128 a[28:31], v3 offset:38912
v_mfma_f32_16x16x32_bf16 v[116:119], a[136:139], a[80:83], v[116:119]
ds_read_b64_tr_b16 a[132:133], v24 offset:16384
v_mfma_f32_16x16x32_bf16 v[116:119], a[140:143], a[84:87], v[116:119]
v_mfma_f32_16x16x32_bf16 v[124:127], a[136:139], a[88:91], v[124:127]
ds_read_b64_tr_b16 a[134:135], v24 offset:18432
v_add_u32 v24, 32768, v24
v_mfma_f32_16x16x32_bf16 v[124:127], a[140:143], a[92:95], v[124:127]
v_mfma_f32_16x16x32_bf16 v[132:135], a[136:139], a[96:99], v[132:135]
ds_read_b128 a[32:35], v2 offset:40960
v_mfma_f32_16x16x32_bf16 v[132:135], a[140:143], a[100:103], v[132:135]
v_mfma_f32_16x16x32_bf16 v[140:143], a[136:139], a[104:107], v[140:143]
ds_read_b128 a[36:39], v3 offset:40960
v_mfma_f32_16x16x32_bf16 v[140:143], a[140:143], a[108:111], v[140:143]
ds_read_b128 a[40:43], v2 offset:43008
v_mfma_f32_16x16x32_bf16 v[148:151], a[136:139], a[112:115], v[148:151]
ds_read_b128 a[44:47], v3 offset:43008
v_mfma_f32_16x16x32_bf16 v[148:151], a[140:143], a[116:119], v[148:151]
v_mfma_f32_16x16x32_bf16 v[156:159], a[136:139], a[120:123], v[156:159]
ds_read_b128 a[48:51], v2 offset:45056
v_mfma_f32_16x16x32_bf16 v[156:159], a[140:143], a[124:127], v[156:159]
s_waitcnt lgkmcnt(5)
v_mfma_f32_16x16x32_bf16 v[164:167], a[128:131], a[64:67], v[164:167]
ds_read_b64_tr_b16 a[136:137], v25 offset:0
v_mfma_f32_16x16x32_bf16 v[164:167], a[132:135], a[68:71], v[164:167]
v_mfma_f32_16x16x32_bf16 v[172:175], a[128:131], a[72:75], v[172:175]
ds_read_b64_tr_b16 a[138:139], v25 offset:2048
v_mfma_f32_16x16x32_bf16 v[172:175], a[132:135], a[76:79], v[172:175]
ds_read_b128 a[52:55], v3 offset:45056
v_mfma_f32_16x16x32_bf16 v[180:183], a[128:131], a[80:83], v[180:183]
ds_read_b64_tr_b16 a[140:141], v25 offset:16384
v_mfma_f32_16x16x32_bf16 v[180:183], a[132:135], a[84:87], v[180:183]
v_mfma_f32_16x16x32_bf16 v[188:191], a[128:131], a[88:91], v[188:191]
ds_read_b64_tr_b16 a[142:143], v25 offset:18432
v_add_u32 v25, 32768, v25
v_mfma_f32_16x16x32_bf16 v[188:191], a[132:135], a[92:95], v[188:191]
v_mfma_f32_16x16x32_bf16 v[196:199], a[128:131], a[96:99], v[196:199]
ds_read_b128 a[56:59], v2 offset:47104
v_mfma_f32_16x16x32_bf16 v[196:199], a[132:135], a[100:103], v[196:199]
v_mfma_f32_16x16x32_bf16 v[204:207], a[128:131], a[104:107], v[204:207]
ds_read_b128 a[60:63], v3 offset:47104
v_mfma_f32_16x16x32_bf16 v[204:207], a[132:135], a[108:111], v[204:207]
v_mfma_f32_16x16x32_bf16 v[212:215], a[128:131], a[112:115], v[212:215]
v_mfma_f32_16x16x32_bf16 v[212:215], a[132:135], a[116:119], v[212:215]
v_mfma_f32_16x16x32_bf16 v[220:223], a[128:131], a[120:123], v[220:223]
v_mfma_f32_16x16x32_bf16 v[220:223], a[132:135], a[124:127], v[220:223]
s_waitcnt vmcnt(0) lgkmcnt(0)
s_barrier
v_mfma_f32_16x16x32_bf16 v[224:227], a[136:139], a[64:67], v[224:227]
ds_read_b64_tr_b16 a[128:129], v22 offset:0
v_mfma_f32_16x16x32_bf16 v[224:227], a[140:143], a[68:71], v[224:227]
buffer_store_dword v27, v26, s[4:7], s66 offen sc1
v_mfma_f32_16x16x32_bf16 v[228:231], a[136:139], a[72:75], v[228:231]
ds_read_b64_tr_b16 a[130:131], v22 offset:2048
v_mfma_f32_16x16x32_bf16 v[228:231], a[140:143], a[76:79], v[228:231]
v_mfma_f32_16x16x32_bf16 v[232:235], a[136:139], a[80:83], v[232:235]
ds_read_b64_tr_b16 a[132:133], v22 offset:16384
v_mfma_f32_16x16x32_bf16 v[232:235], a[140:143], a[84:87], v[232:235]
v_mfma_f32_16x16x32_bf16 v[236:239], a[136:139], a[88:91], v[236:239]
ds_read_b64_tr_b16 a[134:135], v22 offset:18432
v_mfma_f32_16x16x32_bf16 v[236:239], a[140:143], a[92:95], v[236:239]
v_mfma_f32_16x16x32_bf16 v[240:243], a[136:139], a[96:99], v[240:243]
v_mfma_f32_16x16x32_bf16 v[240:243], a[140:143], a[100:103], v[240:243]
v_mfma_f32_16x16x32_bf16 v[244:247], a[136:139], a[104:107], v[244:247]
v_mfma_f32_16x16x32_bf16 v[244:247], a[140:143], a[108:111], v[244:247]
v_mfma_f32_16x16x32_bf16 v[248:251], a[136:139], a[112:115], v[248:251]
v_mfma_f32_16x16x32_bf16 v[248:251], a[140:143], a[116:119], v[248:251]
v_mfma_f32_16x16x32_bf16 v[252:255], a[136:139], a[120:123], v[252:255]
v_mfma_f32_16x16x32_bf16 v[252:255], a[140:143], a[124:127], v[252:255]
s_waitcnt lgkmcnt(0)
v_mfma_f32_16x16x32_bf16 v[36:39], a[128:131], a[0:3], v[36:39]
s_lshl_b32 s18, s3, 13
ds_read_b64_tr_b16 a[136:137], v23 offset:0
v_lshrrev_b32 v28, 6, v0
v_mfma_f32_16x16x32_bf16 v[36:39], a[132:135], a[4:7], v[36:39]
s_lshl_b32 s30, s20, 20
v_lshl_add_u32 v28, v28, 11, v1
v_add_u32 v28, 65536, v28
v_mfma_f32_16x16x32_bf16 v[44:47], a[128:131], a[8:11], v[44:47]
s_add_u32 s30, s30, s18
ds_read_b64_tr_b16 a[138:139], v23 offset:2048
v_lshrrev_b32 v3, 6, v0
v_mfma_f32_16x16x32_bf16 v[44:47], a[132:135], a[12:15], v[44:47]
s_lshl_b32 s22, s21, 1
v_and_b32 v4, 63, v0
v_add_u32 v2, 0x10000, v1
v_mfma_f32_16x16x32_bf16 v[52:55], a[128:131], a[16:19], v[52:55]
s_lshl_b32 s85, s21, 2
ds_read_b64_tr_b16 a[140:141], v23 offset:16384
v_and_b32 v5, 15, v4
v_mfma_f32_16x16x32_bf16 v[52:55], a[132:135], a[20:23], v[52:55]
s_lshr_b32 s85, 2386092, s85
v_lshrrev_b32 v6, 4, v4
v_lshlrev_b32 v6, 2, v6
v_mfma_f32_16x16x32_bf16 v[60:63], a[128:131], a[24:27], v[60:63]
s_and_b32 s9, s85, 15
ds_read_b64_tr_b16 a[142:143], v23 offset:18432
v_sub_u32 v5, v5, v6
v_mfma_f32_16x16x32_bf16 v[60:63], a[132:135], a[28:31], v[60:63]
s_and_b32 s84, s85, 1
v_lshl_add_u32 v5, v3, 4, v5
v_cmp_gt_i32 s[32:33], 0, v5
v_mfma_f32_16x16x32_bf16 v[68:71], a[128:131], a[32:35], v[68:71]
s_lshl_b32 s84, s84, 17
v_cmp_gt_i32 s[34:35], 1, v5
v_cmp_gt_i32 s[36:37], 2, v5
v_mfma_f32_16x16x32_bf16 v[68:71], a[132:135], a[36:39], v[68:71]
s_add_u32 s84, s84, s18
v_cmp_gt_i32 s[38:39], 3, v5
v_cmp_gt_i32 s[40:41], 16, v5
v_mfma_f32_16x16x32_bf16 v[76:79], a[128:131], a[40:43], v[76:79]
s_xor_b32 s85, s84, 0x20000
v_cmp_gt_i32 s[42:43], 17, v5
v_cmp_gt_i32 s[44:45], 18, v5
v_mfma_f32_16x16x32_bf16 v[76:79], a[132:135], a[44:47], v[76:79]
s_sub_u32 s29, 15, s21
v_cmp_gt_i32 s[46:47], 19, v5
v_cmp_gt_i32 s[48:49], 32, v5
v_mfma_f32_16x16x32_bf16 v[84:87], a[128:131], a[48:51], v[84:87]
s_cmp_lg_u32 s9, 0
v_cmp_gt_i32 s[50:51], 33, v5
v_cmp_gt_i32 s[52:53], 34, v5
v_mfma_f32_16x16x32_bf16 v[84:87], a[132:135], a[52:55], v[84:87]
s_cselect_b32 s24, 1, 0
v_cmp_gt_i32 s[54:55], 35, v5
v_cmp_gt_i32 s[56:57], 48, v5
v_mfma_f32_16x16x32_bf16 v[92:95], a[128:131], a[56:59], v[92:95]
s_cselect_b32 s67, s67, 3221225472
v_cmp_gt_i32 s[58:59], 49, v5
v_cmp_gt_i32 s[60:61], 50, v5
v_mfma_f32_16x16x32_bf16 v[92:95], a[132:135], a[60:63], v[92:95]
s_waitcnt lgkmcnt(0)
v_cmp_gt_i32 s[62:63], 51, v5
v_mov_b32 v7, 0xff800000
v_mfma_f32_16x16x32_bf16 v[100:103], a[136:139], a[0:3], v[100:103]
s_lshl_b32 s8, s9, 15
ds_read_b64_tr_b16 a[128:129], v24 offset:0
v_mov_b32 v6, 1
v_mfma_f32_16x16x32_bf16 v[100:103], a[140:143], a[4:7], v[100:103]
s_add_u32 s8, s8, s30
v_mov_b32 v5, v26
v_add_u32 v4, 0x20000, v1
v_mfma_f32_16x16x32_bf16 v[108:111], a[136:139], a[8:11], v[108:111]
s_add_u32 s9, s9, s22
ds_read_b64_tr_b16 a[130:131], v24 offset:2048
v_mfma_f32_16x16x32_bf16 v[108:111], a[140:143], a[12:15], v[108:111]
s_sub_u32 s9, 32, s9
v_mfma_f32_16x16x32_bf16 v[116:119], a[136:139], a[16:19], v[116:119]
s_bitcmp1_b32 s2, 4
ds_read_b64_tr_b16 a[132:133], v24 offset:16384
v_mfma_f32_16x16x32_bf16 v[116:119], a[140:143], a[20:23], v[116:119]
s_cselect_b32 s9, 16, s9
v_mfma_f32_16x16x32_bf16 v[124:127], a[136:139], a[24:27], v[124:127]
s_cselect_b32 s29, 7, s29
ds_read_b64_tr_b16 a[134:135], v24 offset:18432
v_mul_f32 v36, s68, v36
v_mfma_f32_16x16x32_bf16 v[124:127], a[140:143], a[28:31], v[124:127]
s_mov_b32 s10, 3221225472
v_mul_f32 v37, s68, v37
v_mul_f32 v38, s68, v38
v_mfma_f32_16x16x32_bf16 v[132:135], a[136:139], a[32:35], v[132:135]
s_mov_b32 s14, 3221225472
v_mul_f32 v39, s68, v39
v_mul_f32 v100, s68, v100
v_mfma_f32_16x16x32_bf16 v[132:135], a[140:143], a[36:39], v[132:135]
s_mov_b32 s11, 0
v_mul_f32 v101, s68, v101
v_mul_f32 v102, s68, v102
v_mfma_f32_16x16x32_bf16 v[140:143], a[136:139], a[40:43], v[140:143]
s_lshr_b32 s19, s9, 1
v_mul_f32 v103, s68, v103
v_cvt_pk_bf16_f32 v36, v36, v37
v_mfma_f32_16x16x32_bf16 v[140:143], a[140:143], a[44:47], v[140:143]
s_sub_u32 s19, s19, 1
v_cvt_pk_bf16_f32 v37, v38, v39
v_cvt_pk_bf16_f32 v38, v100, v101
v_mfma_f32_16x16x32_bf16 v[148:151], a[136:139], a[48:51], v[148:151]
s_add_u32 s12, s8, 16777216
v_cvt_pk_bf16_f32 v39, v102, v103
v_mul_f32 v44, s68, v44
v_mfma_f32_16x16x32_bf16 v[148:151], a[140:143], a[52:55], v[148:151]
s_mov_b32 s13, s9
ds_write_b128 v28, v[36:39] offset:0
v_mul_f32 v45, s68, v45
v_mfma_f32_16x16x32_bf16 v[156:159], a[136:139], a[56:59], v[156:159]
s_mov_b32 s15, s11
s_add_u32 s23, s67, 0
buffer_store_dwordx4 v[36:39], v1, s[4:7], s23 offen offset:0 sc1
v_mfma_f32_16x16x32_bf16 v[156:159], a[140:143], a[60:63], v[156:159]
s_waitcnt lgkmcnt(1)
v_mul_f32 v46, s68, v46
v_mul_f32 v47, s68, v47
v_mfma_f32_16x16x32_bf16 v[164:167], a[128:131], a[0:3], v[164:167]
ds_read_b64_tr_b16 a[136:137], v25 offset:0
v_mul_f32 v108, s68, v108
v_mfma_f32_16x16x32_bf16 v[164:167], a[132:135], a[4:7], v[164:167]
v_mul_f32 v109, s68, v109
v_mul_f32 v110, s68, v110
v_mfma_f32_16x16x32_bf16 v[172:175], a[128:131], a[8:11], v[172:175]
ds_read_b64_tr_b16 a[138:139], v25 offset:2048
v_mul_f32 v111, s68, v111
v_mfma_f32_16x16x32_bf16 v[172:175], a[132:135], a[12:15], v[172:175]
v_cvt_pk_bf16_f32 v44, v44, v45
v_cvt_pk_bf16_f32 v45, v46, v47
v_mfma_f32_16x16x32_bf16 v[180:183], a[128:131], a[16:19], v[180:183]
ds_read_b64_tr_b16 a[140:141], v25 offset:16384
v_cvt_pk_bf16_f32 v46, v108, v109
v_mfma_f32_16x16x32_bf16 v[180:183], a[132:135], a[20:23], v[180:183]
v_cvt_pk_bf16_f32 v47, v110, v111
v_mul_f32 v52, s68, v52
v_mfma_f32_16x16x32_bf16 v[188:191], a[128:131], a[24:27], v[188:191]
ds_read_b64_tr_b16 a[142:143], v25 offset:18432
v_mul_f32 v53, s68, v53
v_mfma_f32_16x16x32_bf16 v[188:191], a[132:135], a[28:31], v[188:191]
ds_write_b128 v28, v[44:47] offset:8192
v_mul_f32 v54, s68, v54
v_mfma_f32_16x16x32_bf16 v[196:199], a[128:131], a[32:35], v[196:199]
s_add_u32 s23, s67, 8192
buffer_store_dwordx4 v[44:47], v1, s[4:7], s23 offen offset:0 sc1
v_mfma_f32_16x16x32_bf16 v[196:199], a[132:135], a[36:39], v[196:199]
v_mul_f32 v55, s68, v55
v_mul_f32 v116, s68, v116
v_mfma_f32_16x16x32_bf16 v[204:207], a[128:131], a[40:43], v[204:207]
v_mul_f32 v117, s68, v117
v_mul_f32 v118, s68, v118
v_mfma_f32_16x16x32_bf16 v[204:207], a[132:135], a[44:47], v[204:207]
v_mul_f32 v119, s68, v119
v_cvt_pk_bf16_f32 v52, v52, v53
v_mfma_f32_16x16x32_bf16 v[212:215], a[128:131], a[48:51], v[212:215]
v_cvt_pk_bf16_f32 v53, v54, v55
v_cvt_pk_bf16_f32 v54, v116, v117
v_mfma_f32_16x16x32_bf16 v[212:215], a[132:135], a[52:55], v[212:215]
v_cvt_pk_bf16_f32 v55, v118, v119
v_mul_f32 v60, s68, v60
v_mfma_f32_16x16x32_bf16 v[220:223], a[128:131], a[56:59], v[220:223]
ds_write_b128 v28, v[52:55] offset:16384
v_mul_f32 v61, s68, v61
v_mfma_f32_16x16x32_bf16 v[220:223], a[132:135], a[60:63], v[220:223]
s_waitcnt lgkmcnt(0)
s_waitcnt lgkmcnt(0)
s_barrier
v_mfma_f32_16x16x32_bf16 v[224:227], a[136:139], a[0:3], v[224:227]
s_add_u32 s23, s67, 16384
buffer_store_dwordx4 v[52:55], v1, s[4:7], s23 offen offset:0 sc1
v_mfma_f32_16x16x32_bf16 v[224:227], a[140:143], a[4:7], v[224:227]
v_mul_f32 v62, s68, v62
v_mul_f32 v63, s68, v63
v_mfma_f32_16x16x32_bf16 v[228:231], a[136:139], a[8:11], v[228:231]
v_mul_f32 v124, s68, v124
v_mul_f32 v125, s68, v125
v_mfma_f32_16x16x32_bf16 v[228:231], a[140:143], a[12:15], v[228:231]
v_mul_f32 v126, s68, v126
v_mul_f32 v127, s68, v127
v_mfma_f32_16x16x32_bf16 v[232:235], a[136:139], a[16:19], v[232:235]
v_cvt_pk_bf16_f32 v60, v60, v61
v_cvt_pk_bf16_f32 v61, v62, v63
v_mfma_f32_16x16x32_bf16 v[232:235], a[140:143], a[20:23], v[232:235]
v_cvt_pk_bf16_f32 v62, v124, v125
v_cvt_pk_bf16_f32 v63, v126, v127
v_mfma_f32_16x16x32_bf16 v[236:239], a[136:139], a[24:27], v[236:239]
ds_write_b128 v28, v[60:63] offset:24576
v_mul_f32 v68, s68, v68
v_mfma_f32_16x16x32_bf16 v[236:239], a[140:143], a[28:31], v[236:239]
s_add_u32 s23, s67, 24576
buffer_store_dwordx4 v[60:63], v1, s[4:7], s23 offen offset:0 sc1
v_mfma_f32_16x16x32_bf16 v[240:243], a[136:139], a[32:35], v[240:243]
v_mul_f32 v69, s68, v69
v_mul_f32 v70, s68, v70
v_mfma_f32_16x16x32_bf16 v[240:243], a[140:143], a[36:39], v[240:243]
v_mul_f32 v71, s68, v71
v_mul_f32 v132, s68, v132
v_mfma_f32_16x16x32_bf16 v[244:247], a[136:139], a[40:43], v[244:247]
v_mul_f32 v133, s68, v133
v_mul_f32 v134, s68, v134
v_mfma_f32_16x16x32_bf16 v[244:247], a[140:143], a[44:47], v[244:247]
v_mul_f32 v135, s68, v135
v_cvt_pk_bf16_f32 v68, v68, v69
v_mfma_f32_16x16x32_bf16 v[248:251], a[136:139], a[48:51], v[248:251]
v_cvt_pk_bf16_f32 v69, v70, v71
v_cvt_pk_bf16_f32 v70, v132, v133
v_mfma_f32_16x16x32_bf16 v[248:251], a[140:143], a[52:55], v[248:251]
v_cvt_pk_bf16_f32 v71, v134, v135
v_mfma_f32_16x16x32_bf16 v[252:255], a[136:139], a[56:59], v[252:255]
ds_write_b128 v28, v[68:71] offset:32768
v_mfma_f32_16x16x32_bf16 v[252:255], a[140:143], a[60:63], v[252:255]
s_add_u32 s23, s67, 32768
buffer_store_dwordx4 v[68:71], v1, s[4:7], s23 offen offset:0 sc1
buffer_load_dword v21, v20, s[4:7], s70 offen sc1
v_pk_mul_f32 v[76:77], v[76:77], s[68:69]
v_pk_mul_f32 v[78:79], v[78:79], s[68:69]
v_pk_mul_f32 v[140:141], v[140:141], s[68:69]
v_pk_mul_f32 v[142:143], v[142:143], s[68:69]
v_cvt_pk_bf16_f32 v76, v76, v77
v_cvt_pk_bf16_f32 v77, v78, v79
v_cvt_pk_bf16_f32 v78, v140, v141
v_cvt_pk_bf16_f32 v79, v142, v143
ds_write_b128 v28, v[76:79] offset:40960
s_add_u32 s23, s67, 40960
buffer_store_dwordx4 v[76:79], v1, s[4:7], s23 offen offset:0 sc1
v_pk_mul_f32 v[84:85], v[84:85], s[68:69]
v_pk_mul_f32 v[86:87], v[86:87], s[68:69]
v_pk_mul_f32 v[148:149], v[148:149], s[68:69]
v_pk_mul_f32 v[150:151], v[150:151], s[68:69]
v_cvt_pk_bf16_f32 v84, v84, v85
v_cvt_pk_bf16_f32 v85, v86, v87
v_cvt_pk_bf16_f32 v86, v148, v149
v_cvt_pk_bf16_f32 v87, v150, v151
ds_write_b128 v28, v[84:87] offset:49152
s_add_u32 s23, s67, 49152
buffer_store_dwordx4 v[84:87], v1, s[4:7], s23 offen offset:0 sc1
v_pk_mul_f32 v[92:93], v[92:93], s[68:69]
v_pk_mul_f32 v[94:95], v[94:95], s[68:69]
v_pk_mul_f32 v[156:157], v[156:157], s[68:69]
v_pk_mul_f32 v[158:159], v[158:159], s[68:69]
v_cvt_pk_bf16_f32 v92, v92, v93
v_cvt_pk_bf16_f32 v93, v94, v95
v_cvt_pk_bf16_f32 v94, v156, v157
v_cvt_pk_bf16_f32 v95, v158, v159
ds_write_b128 v28, v[92:95] offset:57344
s_add_u32 s23, s67, 57344
buffer_store_dwordx4 v[92:95], v1, s[4:7], s23 offen offset:0 sc1
v_pk_mul_f32 v[164:165], v[164:165], s[68:69]
v_pk_mul_f32 v[166:167], v[166:167], s[68:69]
v_pk_mul_f32 v[224:225], v[224:225], s[68:69]
v_pk_mul_f32 v[226:227], v[226:227], s[68:69]
v_cvt_pk_bf16_f32 v164, v164, v165
v_cvt_pk_bf16_f32 v165, v166, v167
v_cvt_pk_bf16_f32 v166, v224, v225
v_cvt_pk_bf16_f32 v167, v226, v227
ds_write_b128 v28, v[164:167] offset:1024
s_add_u32 s23, s67, 0
buffer_store_dwordx4 v[164:167], v1, s[4:7], s23 offen offset:1024 sc1
v_pk_mul_f32 v[172:173], v[172:173], s[68:69]
v_pk_mul_f32 v[174:175], v[174:175], s[68:69]
v_pk_mul_f32 v[228:229], v[228:229], s[68:69]
v_pk_mul_f32 v[230:231], v[230:231], s[68:69]
v_cvt_pk_bf16_f32 v172, v172, v173
v_cvt_pk_bf16_f32 v173, v174, v175
v_cvt_pk_bf16_f32 v174, v228, v229
v_cvt_pk_bf16_f32 v175, v230, v231
ds_write_b128 v28, v[172:175] offset:9216
s_add_u32 s23, s67, 8192
buffer_store_dwordx4 v[172:175], v1, s[4:7], s23 offen offset:1024 sc1
v_pk_mul_f32 v[180:181], v[180:181], s[68:69]
v_pk_mul_f32 v[182:183], v[182:183], s[68:69]
v_pk_mul_f32 v[232:233], v[232:233], s[68:69]
v_pk_mul_f32 v[234:235], v[234:235], s[68:69]
v_cvt_pk_bf16_f32 v180, v180, v181
v_cvt_pk_bf16_f32 v181, v182, v183
v_cvt_pk_bf16_f32 v182, v232, v233
v_cvt_pk_bf16_f32 v183, v234, v235
ds_write_b128 v28, v[180:183] offset:17408
s_add_u32 s23, s67, 16384
buffer_store_dwordx4 v[180:183], v1, s[4:7], s23 offen offset:1024 sc1
v_pk_mul_f32 v[188:189], v[188:189], s[68:69]
v_pk_mul_f32 v[190:191], v[190:191], s[68:69]
v_pk_mul_f32 v[236:237], v[236:237], s[68:69]
v_pk_mul_f32 v[238:239], v[238:239], s[68:69]
v_cvt_pk_bf16_f32 v188, v188, v189
v_cvt_pk_bf16_f32 v189, v190, v191
v_cvt_pk_bf16_f32 v190, v236, v237
v_cvt_pk_bf16_f32 v191, v238, v239
ds_write_b128 v28, v[188:191] offset:25600
s_add_u32 s23, s67, 24576
buffer_store_dwordx4 v[188:191], v1, s[4:7], s23 offen offset:1024 sc1
v_pk_mul_f32 v[196:197], v[196:197], s[68:69]
v_pk_mul_f32 v[198:199], v[198:199], s[68:69]
v_pk_mul_f32 v[240:241], v[240:241], s[68:69]
v_pk_mul_f32 v[242:243], v[242:243], s[68:69]
PAD_8:
s_cbranch_execz M_tret
v_cvt_pk_bf16_f32 v196, v196, v197
v_cvt_pk_bf16_f32 v197, v198, v199
v_cvt_pk_bf16_f32 v198, v240, v241
v_cvt_pk_bf16_f32 v199, v242, v243
ds_write_b128 v28, v[196:199] offset:33792
s_add_u32 s23, s67, 32768
buffer_store_dwordx4 v[196:199], v1, s[4:7], s23 offen offset:1024 sc1
v_pk_mul_f32 v[204:205], v[204:205], s[68:69]
v_pk_mul_f32 v[206:207], v[206:207], s[68:69]
v_pk_mul_f32 v[244:245], v[244:245], s[68:69]
v_pk_mul_f32 v[246:247], v[246:247], s[68:69]
v_cvt_pk_bf16_f32 v204, v204, v205
v_cvt_pk_bf16_f32 v205, v206, v207
v_cvt_pk_bf16_f32 v206, v244, v245
v_cvt_pk_bf16_f32 v207, v246, v247
ds_write_b128 v28, v[204:207] offset:41984
s_add_u32 s23, s67, 40960
buffer_store_dwordx4 v[204:207], v1, s[4:7], s23 offen offset:1024 sc1
v_pk_mul_f32 v[212:213], v[212:213], s[68:69]
v_pk_mul_f32 v[214:215], v[214:215], s[68:69]
v_pk_mul_f32 v[248:249], v[248:249], s[68:69]
v_pk_mul_f32 v[250:251], v[250:251], s[68:69]
v_cvt_pk_bf16_f32 v212, v212, v213
v_cvt_pk_bf16_f32 v213, v214, v215
v_cvt_pk_bf16_f32 v214, v248, v249
v_cvt_pk_bf16_f32 v215, v250, v251
ds_write_b128 v28, v[212:215] offset:50176
s_add_u32 s23, s67, 49152
buffer_store_dwordx4 v[212:215], v1, s[4:7], s23 offen offset:1024 sc1
v_pk_mul_f32 v[220:221], v[220:221], s[68:69]
v_pk_mul_f32 v[222:223], v[222:223], s[68:69]
v_pk_mul_f32 v[252:253], v[252:253], s[68:69]
v_pk_mul_f32 v[254:255], v[254:255], s[68:69]
v_cvt_pk_bf16_f32 v220, v220, v221
v_cvt_pk_bf16_f32 v221, v222, v223
v_cvt_pk_bf16_f32 v222, v252, v253
v_cvt_pk_bf16_f32 v223, v254, v255
ds_write_b128 v28, v[220:223] offset:58368
s_add_u32 s23, s67, 57344
buffer_store_dwordx4 v[220:223], v1, s[4:7], s23 offen offset:1024 sc1
s_waitcnt vmcnt(11)
v_cmp_gt_u32 vcc, 1, v21
s_cbranch_vccnz M_kspin
M_kok:
buffer_load_dword v21, v15, s[4:7], s70 offen sc1
s_mov_b32 m0, s84
s_nop 0
buffer_load_dwordx4 v1, s[4:7], s8 offen offset:0 sc1 lds
buffer_load_dwordx4 v1, s[4:7], s8 offen offset:1024 sc1 lds
buffer_load_dwordx4 v1, s[4:7], s8 offen offset:2048 sc1 lds
buffer_load_dwordx4 v1, s[4:7], s8 offen offset:3072 sc1 lds
s_add_u32 s8, s8, 4096
s_add_u32 m0, s84, 4096
s_nop 0
buffer_load_dwordx4 v1, s[4:7], s8 offen offset:0 sc1 lds
buffer_load_dwordx4 v1, s[4:7], s8 offen offset:1024 sc1 lds
buffer_load_dwordx4 v1, s[4:7], s8 offen offset:2048 sc1 lds
buffer_load_dwordx4 v1, s[4:7], s8 offen offset:3072 sc1 lds
s_add_u32 s8, s8, 28672
s_sub_u32 s9, s9, 1
s_cmp_eq_u32 s9, 0
s_cselect_b32 s8, s10, s8
s_cselect_b32 s9, s11, s9
s_cselect_b32 s10, 3221225472, s10
v_add_u32 v28, s18, v2
s_waitcnt lgkmcnt(0)
s_barrier
ds_read_b128 a[0:3], v28 offset:0
ds_read_b128 a[4:7], v28 offset:1024
ds_read_b128 a[8:11], v28 offset:2048
ds_read_b128 a[12:15], v28 offset:3072
ds_read_b128 a[16:19], v28 offset:4096
ds_read_b128 a[20:23], v28 offset:5120
ds_read_b128 a[24:27], v28 offset:6144
ds_read_b128 a[28:31], v28 offset:7168
ds_read_b128 a[32:35], v28 offset:32768
ds_read_b128 a[36:39], v28 offset:33792
ds_read_b128 a[40:43], v28 offset:34816
ds_read_b128 a[44:47], v28 offset:35840
ds_read_b128 a[48:51], v28 offset:36864
ds_read_b128 a[52:55], v28 offset:37888
ds_read_b128 a[56:59], v28 offset:38912
ds_read_b128 a[60:63], v28 offset:39936
s_mov_b32 m0, s85
s_nop 0
buffer_load_dwordx4 v1, s[4:7], s8 offen offset:0 sc1 lds
buffer_load_dwordx4 v1, s[4:7], s8 offen offset:1024 sc1 lds
buffer_load_dwordx4 v1, s[4:7], s8 offen offset:2048 sc1 lds
buffer_load_dwordx4 v1, s[4:7], s8 offen offset:3072 sc1 lds
s_add_u32 s8, s8, 4096
s_add_u32 m0, s85, 4096
s_nop 0
buffer_load_dwordx4 v1, s[4:7], s8 offen offset:0 sc1 lds
buffer_load_dwordx4 v1, s[4:7], s8 offen offset:1024 sc1 lds
buffer_load_dwordx4 v1, s[4:7], s8 offen offset:2048 sc1 lds
buffer_load_dwordx4 v1, s[4:7], s8 offen offset:3072 sc1 lds
s_add_u32 s8, s8, 28672
s_sub_u32 s9, s9, 1
s_cmp_eq_u32 s9, 0
s_cselect_b32 s8, s10, s8
s_cselect_b32 s9, s11, s9
s_cselect_b32 s10, 3221225472, s10
s_mov_b32 s25, 1266679808
s_lshl_b32 s22, s21, 3
s_add_u32 s28, s70, s22
s_add_u32 s28, s28, 6148
s_lshl_b32 s26, s21, 16
s_add_u32 s26, s26, s30
s_add_u32 s26, s26, 33554432
s_lshl_b32 s76, s20, 3
s_add_u32 s76, s76, s21
s_lshl_b32 s76, s76, 2
s_add_u32 s76, s76, s3
s_lshl_b32 s27, s76, 10
s_add_u32 s27, s27, 75497472
s_lshl_b32 s76, s76, 14
s_add_u32 s76, s76, 67108864
s_lshl_b32 s81, s20, 2
s_add_u32 s81, s81, s3
s_mul_i32 s81, s81, 57344
s_cmp_eq_u32 s24, 1
s_cselect_b32 s80, s28, s70
s_add_u32 s77, s76, 8192
v_lshrrev_b32 v8, 7, v1
v_and_b32 v9, 6, v8
v_lshlrev_b32 v9, 4, v9
v_and_b32 v10, 0x70, v1
v_xor_b32 v9, v9, v10
v_mul_u32_u24 v8, 896, v8
v_add_u32 v8, v8, v9
v_accvgpr_write_b32 a184, v8
v_add_u32 v8, 6144, v8
v_accvgpr_write_b32 a185, v8
v_add_u32 v8, 6144, v8
v_accvgpr_write_b32 a186, v8
v_add_u32 v8, 6144, v8
v_accvgpr_write_b32 a187, v8
v_lshrrev_b32 v8, 6, v1
v_bfe_u32 v9, v1, 7, 2
v_lshlrev_b32 v9, 5, v9
v_lshl_add_u32 v8, v8, 7, v9
v_bfe_u32 v9, v1, 4, 2
v_lshl_add_u32 v8, v9, 3, v8
v_add_u32 v8, 32768, v8
v_accvgpr_write_b32 a188, v8
v_xor_b32 v9, 32, v8
v_accvgpr_write_b32 a189, v9
v_xor_b32 v9, 64, v8
v_accvgpr_write_b32 a190, v9
v_xor_b32 v9, 96, v8
v_accvgpr_write_b32 a191, v9
s_add_u32 s22, s66, 16384
s_mov_b32 s71, 3221225472
s_waitcnt vmcnt(17)
s_barrier
buffer_store_dword v6, v5, s[4:7], s22 offen sc1
v_mov_b64 v[128:129], 0
v_mov_b64 v[130:131], 0
v_mov_b64 v[132:133], 0
v_mov_b64 v[134:135], 0
v_mov_b64 v[136:137], 0
v_mov_b64 v[138:139], 0
v_mov_b64 v[140:141], 0
v_mov_b64 v[142:143], 0
v_mov_b64 v[144:145], 0
v_mov_b64 v[146:147], 0
v_mov_b64 v[148:149], 0
v_mov_b64 v[150:151], 0
v_mov_b64 v[152:153], 0
v_mov_b64 v[154:155], 0
v_mov_b64 v[156:157], 0
v_mov_b64 v[158:159], 0
v_mov_b64 v[160:161], 0
v_mov_b64 v[162:163], 0
v_mov_b64 v[164:165], 0
v_mov_b64 v[166:167], 0
v_mov_b64 v[168:169], 0
v_mov_b64 v[170:171], 0
v_mov_b64 v[172:173], 0
v_mov_b64 v[174:175], 0
v_mov_b64 v[176:177], 0
v_mov_b64 v[178:179], 0
v_mov_b64 v[180:181], 0
v_mov_b64 v[182:183], 0
v_mov_b64 v[184:185], 0
v_mov_b64 v[186:187], 0
v_mov_b64 v[188:189], 0
v_mov_b64 v[190:191], 0
v_mov_b64 v[192:193], 0
v_mov_b64 v[194:195], 0
v_mov_b64 v[196:197], 0
v_mov_b64 v[198:199], 0
v_mov_b64 v[200:201], 0
v_mov_b64 v[202:203], 0
v_mov_b64 v[204:205], 0
v_mov_b64 v[206:207], 0
v_mov_b64 v[208:209], 0
v_mov_b64 v[210:211], 0
v_mov_b64 v[212:213], 0
v_mov_b64 v[214:215], 0
v_mov_b64 v[216:217], 0
v_mov_b64 v[218:219], 0
v_mov_b64 v[220:221], 0
v_mov_b64 v[222:223], 0
v_mov_b64 v[224:225], 0
v_mov_b64 v[226:227], 0
v_mov_b64 v[228:229], 0
v_mov_b64 v[230:231], 0
v_mov_b64 v[232:233], 0
v_mov_b64 v[234:235], 0
v_mov_b64 v[236:237], 0
v_mov_b64 v[238:239], 0
v_mov_b64 v[240:241], 0
v_mov_b64 v[242:243], 0
v_mov_b64 v[244:245], 0
v_mov_b64 v[246:247], 0
v_mov_b64 v[248:249], 0
v_mov_b64 v[250:251], 0
v_mov_b64 v[252:253], 0
v_mov_b64 v[254:255], 0
v_mov_b64 v[24:25], 0
s_cmp_eq_u32 s24, 9
s_cbranch_scc1 M_t2A
M_t2Ar:
s_waitcnt vmcnt(9) lgkmcnt(0)
v_cmp_gt_u32 vcc, 1, v21
s_cbranch_vccnz M_vspin
M_vok:
s_barrier
K2_item:
PAD_9:
s_cbranch_execz M_tret
s_cmp_eq_u32 s19, 0
s_cbranch_scc1 K2_p0d
ds_read_b128 a[64:67], v1 offset:0
ds_read_b128 a[68:71], v1 offset:1024
ds_read_b128 a[72:75], v1 offset:2048
ds_read_b128 a[76:79], v1 offset:3072
ds_read_b128 a[80:83], v1 offset:4096
ds_read_b128 a[84:87], v1 offset:5120
ds_read_b128 a[88:91], v1 offset:6144
ds_read_b128 a[92:95], v1 offset:7168
s_waitcnt lgkmcnt(7)
v_mfma_f32_16x16x32_bf16 v[32:35], a[64:67], a[0:3], 0
s_waitcnt lgkmcnt(6)
s_add_u32 m0, s18, 65536
ds_read_b128 a[96:99], v1 offset:8192
v_mfma_f32_16x16x32_bf16 v[32:35], a[68:71], a[4:7], v[32:35]
s_waitcnt lgkmcnt(6)
buffer_load_dwordx4 v1, s[4:7], s12 offen offset:0 sc1 lds
v_mfma_f32_16x16x32_bf16 v[32:35], a[72:75], a[8:11], v[32:35]
s_waitcnt lgkmcnt(5)
ds_read_b128 a[100:103], v1 offset:9216
v_mfma_f32_16x16x32_bf16 v[32:35], a[76:79], a[12:15], v[32:35]
s_waitcnt lgkmcnt(5)
buffer_load_dwordx4 v1, s[4:7], s12 offen offset:1024 sc1 lds
v_mfma_f32_16x16x32_bf16 v[32:35], a[80:83], a[16:19], v[32:35]
s_waitcnt lgkmcnt(4)
ds_read_b128 a[104:107], v1 offset:10240
v_mfma_f32_16x16x32_bf16 v[32:35], a[84:87], a[20:23], v[32:35]
s_waitcnt lgkmcnt(4)
buffer_load_dwordx4 v1, s[4:7], s12 offen offset:2048 sc1 lds
v_mfma_f32_16x16x32_bf16 v[32:35], a[88:91], a[24:27], v[32:35]
s_waitcnt lgkmcnt(3)
ds_read_b128 a[108:111], v1 offset:11264
v_mfma_f32_16x16x32_bf16 v[32:35], a[92:95], a[28:31], v[32:35]
buffer_load_dwordx4 v1, s[4:7], s12 offen offset:3072 sc1 lds
v_mfma_f32_16x16x32_bf16 v[36:39], a[64:67], a[32:35], 0
s_add_u32 s12, s12, 4096
s_add_u32 m0, s18, 69632
ds_read_b128 a[112:115], v1 offset:12288
v_mfma_f32_16x16x32_bf16 v[36:39], a[68:71], a[36:39], v[36:39]
buffer_load_dwordx4 v1, s[4:7], s12 offen offset:0 sc1 lds
v_mfma_f32_16x16x32_bf16 v[36:39], a[72:75], a[40:43], v[36:39]
ds_read_b128 a[116:119], v1 offset:13312
v_mfma_f32_16x16x32_bf16 v[36:39], a[76:79], a[44:47], v[36:39]
buffer_load_dwordx4 v1, s[4:7], s12 offen offset:1024 sc1 lds
v_mfma_f32_16x16x32_bf16 v[36:39], a[80:83], a[48:51], v[36:39]
ds_read_b128 a[120:123], v1 offset:14336
v_max3_f32 v28, v32, v33, v34
v_mfma_f32_16x16x32_bf16 v[36:39], a[84:87], a[52:55], v[36:39]
buffer_load_dwordx4 v1, s[4:7], s12 offen offset:2048 sc1 lds
v_mfma_f32_16x16x32_bf16 v[36:39], a[88:91], a[56:59], v[36:39]
ds_read_b128 a[124:127], v1 offset:15360
v_max_f32 v28, v28, v35
v_mfma_f32_16x16x32_bf16 v[36:39], a[92:95], a[60:63], v[36:39]
s_waitcnt lgkmcnt(4)
buffer_load_dwordx4 v1, s[4:7], s12 offen offset:3072 sc1 lds
v_mfma_f32_16x16x32_bf16 v[40:43], a[96:99], a[0:3], 0
s_add_u32 s12, s12, 28672
ds_read_b128 a[64:67], v1 offset:16384
v_mov_b32 v30, v28
v_mfma_f32_16x16x32_bf16 v[40:43], a[100:103], a[4:7], v[40:43]
s_waitcnt lgkmcnt(2)
s_sub_u32 s13, s13, 1
v_mfma_f32_16x16x32_bf16 v[40:43], a[104:107], a[8:11], v[40:43]
s_cmp_eq_u32 s13, 0
ds_read_b128 a[68:71], v1 offset:17408
v_permlane16_swap_b32 v28, v30
v_mfma_f32_16x16x32_bf16 v[40:43], a[108:111], a[12:15], v[40:43]
s_cselect_b32 s12, s14, s12
v_max_f32 v28, v28, v30
v_mov_b32 v30, v28
v_mfma_f32_16x16x32_bf16 v[40:43], a[112:115], a[16:19], v[40:43]
s_cselect_b32 s13, s15, s13
ds_read_b128 a[72:75], v1 offset:18432
v_max3_f32 v29, v36, v37, v38
v_mfma_f32_16x16x32_bf16 v[40:43], a[116:119], a[20:23], v[40:43]
s_cselect_b32 s14, 3221225472, s14
v_permlane32_swap_b32 v28, v30
v_max_f32 v28, v28, v30
v_mfma_f32_16x16x32_bf16 v[40:43], a[120:123], a[24:27], v[40:43]
s_waitcnt lgkmcnt(3)
ds_read_b128 a[76:79], v1 offset:19456
v_sub_f32 v16, 0, v28
v_mfma_f32_16x16x32_bf16 v[40:43], a[124:127], a[28:31], v[40:43]
v_sub_f32 v17, 0, v28
v_sub_f32 v18, 0, v28
v_mfma_f32_16x16x32_bf16 v[44:47], a[96:99], a[32:35], 0
ds_read_b128 a[80:83], v1 offset:20480
v_sub_f32 v19, 0, v28
v_mfma_f32_16x16x32_bf16 v[44:47], a[100:103], a[36:39], v[44:47]
v_max_f32 v29, v29, v39
v_mov_b32 v31, v29
v_mfma_f32_16x16x32_bf16 v[44:47], a[104:107], a[40:43], v[44:47]
ds_read_b128 a[84:87], v1 offset:21504
v_mfma_f32_16x16x32_bf16 v[44:47], a[108:111], a[44:47], v[44:47]
v_permlane16_swap_b32 v29, v31
v_max_f32 v29, v29, v31
v_mfma_f32_16x16x32_bf16 v[44:47], a[112:115], a[48:51], v[44:47]
ds_read_b128 a[88:91], v1 offset:22528
v_mov_b32 v31, v29
v_mfma_f32_16x16x32_bf16 v[44:47], a[116:119], a[52:55], v[44:47]
v_mfma_f32_16x16x32_bf16 v[44:47], a[120:123], a[56:59], v[44:47]
ds_read_b128 a[92:95], v1 offset:23552
v_permlane32_swap_b32 v29, v31
v_mfma_f32_16x16x32_bf16 v[44:47], a[124:127], a[60:63], v[44:47]
s_waitcnt lgkmcnt(4)
v_max_f32 v29, v29, v31
v_sub_f32 v20, 0, v29
v_mfma_f32_16x16x32_bf16 v[48:51], a[64:67], a[0:3], v[16:19]
ds_read_b128 a[96:99], v1 offset:24576
v_sub_f32 v21, 0, v29
v_mfma_f32_16x16x32_bf16 v[48:51], a[68:71], a[4:7], v[48:51]
v_sub_f32 v22, 0, v29
v_sub_f32 v23, 0, v29
v_mfma_f32_16x16x32_bf16 v[48:51], a[72:75], a[8:11], v[48:51]
ds_read_b128 a[100:103], v1 offset:25600
v_mfma_f32_16x16x32_bf16 v[48:51], a[76:79], a[12:15], v[48:51]
s_waitcnt lgkmcnt(4)
v_mfma_f32_16x16x32_bf16 v[48:51], a[80:83], a[16:19], v[48:51]
ds_read_b128 a[104:107], v1 offset:26624
v_mfma_f32_16x16x32_bf16 v[48:51], a[84:87], a[20:23], v[48:51]
s_waitcnt lgkmcnt(4)
v_add_f32 v32, v32, v16
v_add_f32 v33, v33, v16
v_add_f32 v34, v34, v16
v_add_f32 v35, v35, v16
v_mfma_f32_16x16x32_bf16 v[48:51], a[88:91], a[24:27], v[48:51]
s_waitcnt lgkmcnt(3)
ds_read_b128 a[108:111], v1 offset:27648
v_add_f32 v36, v36, v20
v_add_f32 v37, v37, v20
v_add_f32 v38, v38, v20
v_add_f32 v39, v39, v20
v_mfma_f32_16x16x32_bf16 v[48:51], a[92:95], a[28:31], v[48:51]
v_add_f32 v40, v40, v16
v_add_f32 v41, v41, v16
v_add_f32 v42, v42, v16
v_add_f32 v43, v43, v16
v_mfma_f32_16x16x32_bf16 v[52:55], a[64:67], a[32:35], v[20:23]
ds_read_b128 a[112:115], v1 offset:28672
v_add_f32 v44, v44, v20
v_add_f32 v45, v45, v20
v_add_f32 v46, v46, v20
v_add_f32 v47, v47, v20
v_mfma_f32_16x16x32_bf16 v[52:55], a[68:71], a[36:39], v[52:55]
v_exp_f32 v8, v32
v_mfma_f32_16x16x32_bf16 v[52:55], a[72:75], a[40:43], v[52:55]
ds_read_b128 a[116:119], v1 offset:29696
v_exp_f32 v9, v33
v_mfma_f32_16x16x32_bf16 v[52:55], a[76:79], a[44:47], v[52:55]
v_exp_f32 v10, v34
v_add_f32 v26, v8, v9
v_cvt_pk_bf16_f32 v96, v8, v9
v_mfma_f32_16x16x32_bf16 v[52:55], a[80:83], a[48:51], v[52:55]
ds_read_b128 a[120:123], v1 offset:30720
v_exp_f32 v11, v35
v_add_f32 v26, v26, v10
v_mfma_f32_16x16x32_bf16 v[52:55], a[84:87], a[52:55], v[52:55]
v_exp_f32 v12, v36
v_add_f32 v26, v26, v11
v_cvt_pk_bf16_f32 v97, v10, v11
v_mfma_f32_16x16x32_bf16 v[52:55], a[88:91], a[56:59], v[52:55]
s_waitcnt vmcnt(8) lgkmcnt(4)
ds_read_b128 a[124:127], v1 offset:31744
v_exp_f32 v13, v37
v_mfma_f32_16x16x32_bf16 v[52:55], a[92:95], a[60:63], v[52:55]
s_barrier
v_mfma_f32_16x16x32_bf16 v[56:59], a[96:99], a[0:3], v[16:19]
ds_read_b128 a[64:67], v4 offset:0
v_exp_f32 v14, v38
v_mfma_f32_16x16x32_bf16 v[56:59], a[100:103], a[4:7], v[56:59]
buffer_store_dword v6, v5, s[4:7], s71 offen sc1
v_mfma_f32_16x16x32_bf16 v[56:59], a[104:107], a[8:11], v[56:59]
s_waitcnt lgkmcnt(4)
ds_read_b128 a[68:71], v4 offset:1024
v_add_f32 v27, v12, v13
v_cvt_pk_bf16_f32 v104, v12, v13
v_add_f32 v27, v27, v14
v_mfma_f32_16x16x32_bf16 v[56:59], a[108:111], a[12:15], v[56:59]
v_exp_f32 v15, v39
v_mfma_f32_16x16x32_bf16 v[56:59], a[112:115], a[16:19], v[56:59]
s_waitcnt lgkmcnt(4)
ds_read_b128 a[72:75], v4 offset:2048
v_exp_f32 v8, v40
v_add_f32 v27, v27, v15
v_cvt_pk_bf16_f32 v105, v14, v15
v_mfma_f32_16x16x32_bf16 v[56:59], a[116:119], a[20:23], v[56:59]
s_waitcnt lgkmcnt(4)
v_exp_f32 v9, v41
v_add_f32 v26, v26, v8
v_mfma_f32_16x16x32_bf16 v[56:59], a[120:123], a[24:27], v[56:59]
s_waitcnt lgkmcnt(3)
ds_read_b128 a[76:79], v4 offset:3072
v_exp_f32 v10, v42
v_add_f32 v26, v26, v9
v_cvt_pk_bf16_f32 v98, v8, v9
v_mfma_f32_16x16x32_bf16 v[56:59], a[124:127], a[28:31], v[56:59]
v_exp_f32 v11, v43
v_add_f32 v26, v26, v10
v_mfma_f32_16x16x32_bf16 v[60:63], a[96:99], a[32:35], v[20:23]
ds_read_b128 a[80:83], v4 offset:4096
v_exp_f32 v12, v44
v_mfma_f32_16x16x32_bf16 v[60:63], a[100:103], a[36:39], v[60:63]
v_exp_f32 v13, v45
v_mfma_f32_16x16x32_bf16 v[60:63], a[104:107], a[40:43], v[60:63]
ds_read_b128 a[84:87], v4 offset:5120
v_exp_f32 v14, v46
v_mfma_f32_16x16x32_bf16 v[60:63], a[108:111], a[44:47], v[60:63]
v_exp_f32 v15, v47
v_mfma_f32_16x16x32_bf16 v[60:63], a[112:115], a[48:51], v[60:63]
ds_read_b128 a[88:91], v4 offset:6144
v_add_f32 v26, v26, v11
v_cvt_pk_bf16_f32 v99, v10, v11
v_mfma_f32_16x16x32_bf16 v[60:63], a[116:119], a[52:55], v[60:63]
v_add_f32 v27, v27, v12
v_add_f32 v27, v27, v13
v_cvt_pk_bf16_f32 v106, v12, v13
v_mfma_f32_16x16x32_bf16 v[60:63], a[120:123], a[56:59], v[60:63]
s_waitcnt lgkmcnt(7)
s_barrier
ds_read_b128 a[92:95], v4 offset:7168
v_mfma_f32_16x16x32_bf16 v[60:63], a[124:127], a[60:63], v[60:63]
s_waitcnt lgkmcnt(4)
v_add_f32 v27, v27, v14
v_add_f32 v27, v27, v15
v_cvt_pk_bf16_f32 v107, v14, v15
K2_x1:
v_mfma_f32_16x16x32_bf16 v[64:67], a[64:67], a[0:3], v[16:19]
s_add_u32 m0, s18, 0
ds_read_b128 a[96:99], v4 offset:8192
v_mfma_f32_16x16x32_bf16 v[64:67], a[68:71], a[4:7], v[64:67]
s_waitcnt lgkmcnt(4)
buffer_load_dwordx4 v1, s[4:7], s8 offen offset:0 sc1 lds
v_mfma_f32_16x16x32_bf16 v[64:67], a[72:75], a[8:11], v[64:67]
ds_read_b128 a[100:103], v4 offset:9216
v_mfma_f32_16x16x32_bf16 v[64:67], a[76:79], a[12:15], v[64:67]
s_waitcnt lgkmcnt(4)
v_exp_f32 v8, v48
v_mfma_f32_16x16x32_bf16 v[64:67], a[80:83], a[16:19], v[64:67]
ds_read_b128 a[104:107], v4 offset:10240
v_add_f32 v26, v26, v8
v_mfma_f32_16x16x32_bf16 v[64:67], a[84:87], a[20:23], v[64:67]
s_waitcnt lgkmcnt(4)
buffer_load_dwordx4 v1, s[4:7], s8 offen offset:1024 sc1 lds
v_mfma_f32_16x16x32_bf16 v[64:67], a[88:91], a[24:27], v[64:67]
s_waitcnt lgkmcnt(3)
ds_read_b128 a[108:111], v4 offset:11264
v_mfma_f32_16x16x32_bf16 v[64:67], a[92:95], a[28:31], v[64:67]
v_exp_f32 v9, v49
v_mfma_f32_16x16x32_bf16 v[68:71], a[64:67], a[32:35], v[20:23]
ds_read_b128 a[112:115], v4 offset:12288
v_add_f32 v26, v26, v9
v_mfma_f32_16x16x32_bf16 v[68:71], a[68:71], a[36:39], v[68:71]
buffer_load_dwordx4 v1, s[4:7], s8 offen offset:2048 sc1 lds
v_mfma_f32_16x16x32_bf16 v[68:71], a[72:75], a[40:43], v[68:71]
ds_read_b128 a[116:119], v4 offset:13312
v_cvt_pk_bf16_f32 v100, v8, v9
v_mfma_f32_16x16x32_bf16 v[68:71], a[76:79], a[44:47], v[68:71]
v_exp_f32 v10, v50
v_mfma_f32_16x16x32_bf16 v[68:71], a[80:83], a[48:51], v[68:71]
ds_read_b128 a[120:123], v4 offset:14336
v_add_f32 v26, v26, v10
v_mfma_f32_16x16x32_bf16 v[68:71], a[84:87], a[52:55], v[68:71]
buffer_load_dwordx4 v1, s[4:7], s8 offen offset:3072 sc1 lds
v_mfma_f32_16x16x32_bf16 v[68:71], a[88:91], a[56:59], v[68:71]
s_add_u32 s8, s8, 4096
ds_read_b128 a[124:127], v4 offset:15360
v_mfma_f32_16x16x32_bf16 v[68:71], a[92:95], a[60:63], v[68:71]
s_waitcnt lgkmcnt(4)
v_exp_f32 v11, v51
v_mfma_f32_16x16x32_bf16 v[72:75], a[96:99], a[0:3], v[16:19]
s_add_u32 m0, s18, 4096
ds_read_b128 a[64:67], v4 offset:16384
v_add_f32 v26, v26, v11
v_mfma_f32_16x16x32_bf16 v[72:75], a[100:103], a[4:7], v[72:75]
buffer_load_dwordx4 v1, s[4:7], s8 offen offset:0 sc1 lds
v_mfma_f32_16x16x32_bf16 v[72:75], a[104:107], a[8:11], v[72:75]
ds_read_b128 a[68:71], v4 offset:17408
v_cvt_pk_bf16_f32 v101, v10, v11
v_mfma_f32_16x16x32_bf16 v[72:75], a[108:111], a[12:15], v[72:75]
s_waitcnt lgkmcnt(4)
v_mfma_f32_16x16x32_bf16 v[72:75], a[112:115], a[16:19], v[72:75]
ds_read_b128 a[72:75], v4 offset:18432
v_mfma_f32_16x16x32_bf16 v[72:75], a[116:119], a[20:23], v[72:75]
s_waitcnt lgkmcnt(4)
buffer_load_dwordx4 v1, s[4:7], s8 offen offset:1024 sc1 lds
v_mfma_f32_16x16x32_bf16 v[72:75], a[120:123], a[24:27], v[72:75]
s_waitcnt lgkmcnt(3)
ds_read_b128 a[76:79], v4 offset:19456
v_mfma_f32_16x16x32_bf16 v[72:75], a[124:127], a[28:31], v[72:75]
v_exp_f32 v12, v52
v_mfma_f32_16x16x32_bf16 v[76:79], a[96:99], a[32:35], v[20:23]
ds_read_b128 a[80:83], v4 offset:20480
v_add_f32 v27, v27, v12
v_mfma_f32_16x16x32_bf16 v[76:79], a[100:103], a[36:39], v[76:79]
buffer_load_dwordx4 v1, s[4:7], s8 offen offset:2048 sc1 lds
v_mfma_f32_16x16x32_bf16 v[76:79], a[104:107], a[40:43], v[76:79]
ds_read_b128 a[84:87], v4 offset:21504
v_mfma_f32_16x16x32_bf16 v[76:79], a[108:111], a[44:47], v[76:79]
v_exp_f32 v13, v53
v_mfma_f32_16x16x32_bf16 v[76:79], a[112:115], a[48:51], v[76:79]
ds_read_b128 a[88:91], v4 offset:22528
v_add_f32 v27, v27, v13
v_mfma_f32_16x16x32_bf16 v[76:79], a[116:119], a[52:55], v[76:79]
s_waitcnt lgkmcnt(3)
buffer_load_dwordx4 v1, s[4:7], s8 offen offset:3072 sc1 lds
v_mfma_f32_16x16x32_bf16 v[76:79], a[120:123], a[56:59], v[76:79]
s_add_u32 s8, s8, 28672
ds_read_b128 a[92:95], v4 offset:23552
v_cvt_pk_bf16_f32 v108, v12, v13
v_mfma_f32_16x16x32_bf16 v[76:79], a[124:127], a[60:63], v[76:79]
s_sub_u32 s9, s9, 1
v_exp_f32 v14, v54
v_mfma_f32_16x16x32_bf16 v[80:83], a[64:67], a[0:3], v[16:19]
s_cmp_eq_u32 s9, 0
ds_read_b128 a[96:99], v4 offset:24576
v_add_f32 v27, v27, v14
v_mfma_f32_16x16x32_bf16 v[80:83], a[68:71], a[4:7], v[80:83]
s_cselect_b32 s8, s10, s8
v_exp_f32 v15, v55
v_mfma_f32_16x16x32_bf16 v[80:83], a[72:75], a[8:11], v[80:83]
s_cselect_b32 s9, s11, s9
ds_read_b128 a[100:103], v4 offset:25600
v_add_f32 v27, v27, v15
v_mfma_f32_16x16x32_bf16 v[80:83], a[76:79], a[12:15], v[80:83]
s_waitcnt lgkmcnt(4)
s_cselect_b32 s10, 3221225472, s10
v_cvt_pk_bf16_f32 v109, v14, v15
v_mfma_f32_16x16x32_bf16 v[80:83], a[80:83], a[16:19], v[80:83]
ds_read_b128 a[104:107], v4 offset:26624
v_mfma_f32_16x16x32_bf16 v[80:83], a[84:87], a[20:23], v[80:83]
s_waitcnt lgkmcnt(4)
v_exp_f32 v8, v56
v_mfma_f32_16x16x32_bf16 v[80:83], a[88:91], a[24:27], v[80:83]
s_waitcnt lgkmcnt(3)
ds_read_b128 a[108:111], v4 offset:27648
v_add_f32 v26, v26, v8
v_mfma_f32_16x16x32_bf16 v[80:83], a[92:95], a[28:31], v[80:83]
v_exp_f32 v9, v57
v_mfma_f32_16x16x32_bf16 v[84:87], a[64:67], a[32:35], v[20:23]
ds_read_b128 a[112:115], v4 offset:28672
v_add_f32 v26, v26, v9
v_mfma_f32_16x16x32_bf16 v[84:87], a[68:71], a[36:39], v[84:87]
v_exp_f32 v10, v58
v_mfma_f32_16x16x32_bf16 v[84:87], a[72:75], a[40:43], v[84:87]
ds_read_b128 a[116:119], v4 offset:29696
v_cvt_pk_bf16_f32 v102, v8, v9
v_mfma_f32_16x16x32_bf16 v[84:87], a[76:79], a[44:47], v[84:87]
v_exp_f32 v11, v59
v_mfma_f32_16x16x32_bf16 v[84:87], a[80:83], a[48:51], v[84:87]
ds_read_b128 a[120:123], v4 offset:30720
v_add_f32 v26, v26, v10
v_mfma_f32_16x16x32_bf16 v[84:87], a[84:87], a[52:55], v[84:87]
v_add_f32 v26, v26, v11
v_cvt_pk_bf16_f32 v103, v10, v11
v_mfma_f32_16x16x32_bf16 v[84:87], a[88:91], a[56:59], v[84:87]
s_waitcnt vmcnt(8) lgkmcnt(4)
ds_read_b128 a[124:127], v4 offset:31744
v_mfma_f32_16x16x32_bf16 v[84:87], a[92:95], a[60:63], v[84:87]
s_barrier
v_mfma_f32_16x16x32_bf16 v[88:91], a[96:99], a[0:3], v[16:19]
ds_read_b128 a[64:67], v2 offset:0
v_mfma_f32_16x16x32_bf16 v[88:91], a[100:103], a[4:7], v[88:91]
v_exp_f32 v12, v60
v_mfma_f32_16x16x32_bf16 v[88:91], a[104:107], a[8:11], v[88:91]
s_waitcnt lgkmcnt(4)
ds_read_b128 a[68:71], v2 offset:1024
v_add_f32 v27, v27, v12
v_mfma_f32_16x16x32_bf16 v[88:91], a[108:111], a[12:15], v[88:91]
v_exp_f32 v13, v61
v_mfma_f32_16x16x32_bf16 v[88:91], a[112:115], a[16:19], v[88:91]
s_waitcnt lgkmcnt(4)
ds_read_b128 a[72:75], v2 offset:2048
v_add_f32 v27, v27, v13
v_mfma_f32_16x16x32_bf16 v[88:91], a[116:119], a[20:23], v[88:91]
s_waitcnt lgkmcnt(4)
v_exp_f32 v14, v62
v_mfma_f32_16x16x32_bf16 v[88:91], a[120:123], a[24:27], v[88:91]
s_waitcnt lgkmcnt(3)
ds_read_b128 a[76:79], v2 offset:3072
v_cvt_pk_bf16_f32 v110, v12, v13
v_mfma_f32_16x16x32_bf16 v[88:91], a[124:127], a[28:31], v[88:91]
v_exp_f32 v15, v63
v_mfma_f32_16x16x32_bf16 v[92:95], a[96:99], a[32:35], v[20:23]
s_sub_u32 s19, s19, 1
ds_read_b128 a[80:83], v2 offset:4096
v_add_f32 v27, v27, v14
v_mfma_f32_16x16x32_bf16 v[92:95], a[100:103], a[36:39], v[92:95]
v_add_f32 v27, v27, v15
v_cvt_pk_bf16_f32 v111, v14, v15
v_mfma_f32_16x16x32_bf16 v[92:95], a[104:107], a[40:43], v[92:95]
ds_read_b128 a[84:87], v2 offset:5120
v_add_f32 v28, v26, v27
v_mfma_f32_16x16x32_bf16 v[92:95], a[108:111], a[44:47], v[92:95]
v_cmp_nge_f32 vcc, s25, v28
v_mfma_f32_16x16x32_bf16 v[92:95], a[112:115], a[48:51], v[92:95]
s_cmp_eq_u64 vcc, 0
ds_read_b128 a[88:91], v2 offset:6144
v_mfma_f32_16x16x32_bf16 v[92:95], a[116:119], a[52:55], v[92:95]
s_cselect_b32 s22, s19, 0
v_mfma_f32_16x16x32_bf16 v[92:95], a[120:123], a[56:59], v[92:95]
s_cmp_eq_u32 s22, 0
ds_read_b128 a[92:95], v2 offset:7168
v_mfma_f32_16x16x32_bf16 v[92:95], a[124:127], a[60:63], v[92:95]
s_waitcnt lgkmcnt(4)
s_cbranch_scc1 K2_xexit
K2_loop:
v_mfma_f32_16x16x32_bf16 v[128:131], a[64:67], v[96:99], v[128:131]
s_add_u32 m0, s18, 98304
ds_read_b128 a[96:99], v2 offset:8192
v_add_f32 v24, v24, v26
v_mfma_f32_16x16x32_bf16 v[128:131], a[68:71], v[100:103], v[128:131]
buffer_load_dwordx4 v1, s[4:7], s12 offen offset:0 sc1 lds
v_mfma_f32_16x16x32_bf16 v[132:135], a[68:71], v[108:111], v[132:135]
ds_read_b128 a[100:103], v2 offset:9216
v_add_f32 v25, v25, v27
v_mfma_f32_16x16x32_bf16 v[132:135], a[64:67], v[104:107], v[132:135]
v_exp_f32 v8, v64
v_mfma_f32_16x16x32_bf16 v[136:139], a[72:75], v[96:99], v[136:139]
ds_read_b128 a[104:107], v2 offset:10240
v_mfma_f32_16x16x32_bf16 v[136:139], a[76:79], v[100:103], v[136:139]
buffer_load_dwordx4 v1, s[4:7], s12 offen offset:1024 sc1 lds
v_mfma_f32_16x16x32_bf16 v[140:143], a[76:79], v[108:111], v[140:143]
ds_read_b128 a[108:111], v2 offset:11264
v_mfma_f32_16x16x32_bf16 v[140:143], a[72:75], v[104:107], v[140:143]
s_waitcnt lgkmcnt(4)
v_exp_f32 v9, v65
v_mfma_f32_16x16x32_bf16 v[144:147], a[80:83], v[96:99], v[144:147]
ds_read_b128 a[112:115], v2 offset:12288
v_add_f32 v26, v8, v9
v_mfma_f32_16x16x32_bf16 v[144:147], a[84:87], v[100:103], v[144:147]
PAD_10:
s_cbranch_execz M_tret
buffer_load_dwordx4 v1, s[4:7], s12 offen offset:2048 sc1 lds
v_mfma_f32_16x16x32_bf16 v[148:151], a[84:87], v[108:111], v[148:151]
ds_read_b128 a[116:119], v2 offset:13312
v_cvt_pk_bf16_f32 v112, v8, v9
v_mfma_f32_16x16x32_bf16 v[148:151], a[80:83], v[104:107], v[148:151]
v_exp_f32 v10, v66
v_mfma_f32_16x16x32_bf16 v[152:155], a[88:91], v[96:99], v[152:155]
ds_read_b128 a[120:123], v2 offset:14336
v_add_f32 v26, v26, v10
v_mfma_f32_16x16x32_bf16 v[152:155], a[92:95], v[100:103], v[152:155]
buffer_load_dwordx4 v1, s[4:7], s12 offen offset:3072 sc1 lds
v_mfma_f32_16x16x32_bf16 v[156:159], a[92:95], v[108:111], v[156:159]
s_add_u32 s12, s12, 4096
ds_read_b128 a[124:127], v2 offset:15360
v_mfma_f32_16x16x32_bf16 v[156:159], a[88:91], v[104:107], v[156:159]
s_waitcnt lgkmcnt(4)
v_exp_f32 v11, v67
v_mfma_f32_16x16x32_bf16 v[160:163], a[96:99], v[96:99], v[160:163]
s_add_u32 m0, s18, 102400
ds_read_b128 a[64:67], v2 offset:16384
v_add_f32 v26, v26, v11
v_mfma_f32_16x16x32_bf16 v[160:163], a[100:103], v[100:103], v[160:163]
buffer_load_dwordx4 v1, s[4:7], s12 offen offset:0 sc1 lds
v_mfma_f32_16x16x32_bf16 v[164:167], a[100:103], v[108:111], v[164:167]
ds_read_b128 a[68:71], v2 offset:17408
v_cvt_pk_bf16_f32 v113, v10, v11
v_mfma_f32_16x16x32_bf16 v[164:167], a[96:99], v[104:107], v[164:167]
v_mfma_f32_16x16x32_bf16 v[168:171], a[104:107], v[96:99], v[168:171]
ds_read_b128 a[72:75], v2 offset:18432
v_mfma_f32_16x16x32_bf16 v[168:171], a[108:111], v[100:103], v[168:171]
buffer_load_dwordx4 v1, s[4:7], s12 offen offset:1024 sc1 lds
v_mfma_f32_16x16x32_bf16 v[172:175], a[108:111], v[108:111], v[172:175]
ds_read_b128 a[76:79], v2 offset:19456
v_mfma_f32_16x16x32_bf16 v[172:175], a[104:107], v[104:107], v[172:175]
s_waitcnt lgkmcnt(4)
v_exp_f32 v12, v68
v_mfma_f32_16x16x32_bf16 v[176:179], a[112:115], v[96:99], v[176:179]
ds_read_b128 a[80:83], v2 offset:20480
v_mfma_f32_16x16x32_bf16 v[176:179], a[116:119], v[100:103], v[176:179]
buffer_load_dwordx4 v1, s[4:7], s12 offen offset:2048 sc1 lds
v_mfma_f32_16x16x32_bf16 v[180:183], a[116:119], v[108:111], v[180:183]
ds_read_b128 a[84:87], v2 offset:21504
v_mfma_f32_16x16x32_bf16 v[180:183], a[112:115], v[104:107], v[180:183]
v_exp_f32 v13, v69
v_mfma_f32_16x16x32_bf16 v[184:187], a[120:123], v[96:99], v[184:187]
ds_read_b128 a[88:91], v2 offset:22528
v_add_f32 v27, v12, v13
v_mfma_f32_16x16x32_bf16 v[184:187], a[124:127], v[100:103], v[184:187]
s_waitcnt lgkmcnt(4)
buffer_load_dwordx4 v1, s[4:7], s12 offen offset:3072 sc1 lds
v_mfma_f32_16x16x32_bf16 v[188:191], a[124:127], v[108:111], v[188:191]
s_add_u32 s12, s12, 28672
ds_read_b128 a[92:95], v2 offset:23552
v_cvt_pk_bf16_f32 v120, v12, v13
v_mfma_f32_16x16x32_bf16 v[188:191], a[120:123], v[104:107], v[188:191]
s_sub_u32 s13, s13, 1
v_exp_f32 v14, v70
v_mfma_f32_16x16x32_bf16 v[192:195], a[64:67], v[96:99], v[192:195]
s_cmp_eq_u32 s13, 0
ds_read_b128 a[96:99], v2 offset:24576
v_add_f32 v27, v27, v14
v_mfma_f32_16x16x32_bf16 v[192:195], a[68:71], v[100:103], v[192:195]
s_cselect_b32 s12, s14, s12
v_mfma_f32_16x16x32_bf16 v[196:199], a[68:71], v[108:111], v[196:199]
s_cselect_b32 s13, s15, s13
ds_read_b128 a[100:103], v2 offset:25600
v_mfma_f32_16x16x32_bf16 v[196:199], a[64:67], v[104:107], v[196:199]
s_cselect_b32 s14, 3221225472, s14
v_exp_f32 v15, v71
v_mfma_f32_16x16x32_bf16 v[200:203], a[72:75], v[96:99], v[200:203]
s_waitcnt lgkmcnt(4)
ds_read_b128 a[104:107], v2 offset:26624
v_add_f32 v27, v27, v15
v_mfma_f32_16x16x32_bf16 v[200:203], a[76:79], v[100:103], v[200:203]
v_exp_f32 v8, v72
v_mfma_f32_16x16x32_bf16 v[204:207], a[76:79], v[108:111], v[204:207]
ds_read_b128 a[108:111], v2 offset:27648
v_cvt_pk_bf16_f32 v121, v14, v15
v_mfma_f32_16x16x32_bf16 v[204:207], a[72:75], v[104:107], v[204:207]
v_exp_f32 v9, v73
v_mfma_f32_16x16x32_bf16 v[208:211], a[80:83], v[96:99], v[208:211]
ds_read_b128 a[112:115], v2 offset:28672
v_add_f32 v26, v26, v8
v_mfma_f32_16x16x32_bf16 v[208:211], a[84:87], v[100:103], v[208:211]
v_add_f32 v26, v26, v9
v_cvt_pk_bf16_f32 v114, v8, v9
v_mfma_f32_16x16x32_bf16 v[212:215], a[84:87], v[108:111], v[212:215]
ds_read_b128 a[116:119], v2 offset:29696
v_mfma_f32_16x16x32_bf16 v[212:215], a[80:83], v[104:107], v[212:215]
s_waitcnt lgkmcnt(4)
v_exp_f32 v10, v74
v_mfma_f32_16x16x32_bf16 v[216:219], a[88:91], v[96:99], v[216:219]
ds_read_b128 a[120:123], v2 offset:30720
v_add_f32 v26, v26, v10
v_mfma_f32_16x16x32_bf16 v[216:219], a[92:95], v[100:103], v[216:219]
v_exp_f32 v11, v75
v_mfma_f32_16x16x32_bf16 v[220:223], a[92:95], v[108:111], v[220:223]
s_waitcnt vmcnt(8)
ds_read_b128 a[124:127], v2 offset:31744
v_add_f32 v26, v26, v11
v_mfma_f32_16x16x32_bf16 v[220:223], a[88:91], v[104:107], v[220:223]
s_barrier
v_mfma_f32_16x16x32_bf16 v[224:227], a[96:99], v[96:99], v[224:227]
ds_read_b128 a[64:67], v1 offset:0
v_cvt_pk_bf16_f32 v115, v10, v11
v_mfma_f32_16x16x32_bf16 v[224:227], a[100:103], v[100:103], v[224:227]
v_exp_f32 v12, v76
v_mfma_f32_16x16x32_bf16 v[228:231], a[100:103], v[108:111], v[228:231]
ds_read_b128 a[68:71], v1 offset:1024
v_add_f32 v27, v27, v12
v_mfma_f32_16x16x32_bf16 v[228:231], a[96:99], v[104:107], v[228:231]
s_waitcnt lgkmcnt(4)
v_mfma_f32_16x16x32_bf16 v[232:235], a[104:107], v[96:99], v[232:235]
ds_read_b128 a[72:75], v1 offset:2048
v_mfma_f32_16x16x32_bf16 v[232:235], a[108:111], v[100:103], v[232:235]
v_exp_f32 v13, v77
v_mfma_f32_16x16x32_bf16 v[236:239], a[108:111], v[108:111], v[236:239]
ds_read_b128 a[76:79], v1 offset:3072
v_add_f32 v27, v27, v13
v_mfma_f32_16x16x32_bf16 v[236:239], a[104:107], v[104:107], v[236:239]
v_exp_f32 v14, v78
v_mfma_f32_16x16x32_bf16 v[240:243], a[112:115], v[96:99], v[240:243]
ds_read_b128 a[80:83], v1 offset:4096
v_cvt_pk_bf16_f32 v122, v12, v13
v_mfma_f32_16x16x32_bf16 v[240:243], a[116:119], v[100:103], v[240:243]
v_exp_f32 v15, v79
v_mfma_f32_16x16x32_bf16 v[244:247], a[116:119], v[108:111], v[244:247]
ds_read_b128 a[84:87], v1 offset:5120
v_add_f32 v27, v27, v14
v_mfma_f32_16x16x32_bf16 v[244:247], a[112:115], v[104:107], v[244:247]
s_waitcnt lgkmcnt(4)
v_add_f32 v27, v27, v15
v_cvt_pk_bf16_f32 v123, v14, v15
v_mfma_f32_16x16x32_bf16 v[248:251], a[120:123], v[96:99], v[248:251]
ds_read_b128 a[88:91], v1 offset:6144
v_mfma_f32_16x16x32_bf16 v[248:251], a[124:127], v[100:103], v[248:251]
v_mfma_f32_16x16x32_bf16 v[252:255], a[124:127], v[108:111], v[252:255]
ds_read_b128 a[92:95], v1 offset:7168
v_mfma_f32_16x16x32_bf16 v[252:255], a[120:123], v[104:107], v[252:255]
K2_x0:
v_mfma_f32_16x16x32_bf16 v[32:35], a[64:67], a[0:3], v[16:19]
s_add_u32 m0, s18, 131072
ds_read_b128 a[96:99], v1 offset:8192
v_mfma_f32_16x16x32_bf16 v[32:35], a[68:71], a[4:7], v[32:35]
s_waitcnt lgkmcnt(4)
buffer_load_dwordx4 v1, s[4:7], s8 offen offset:0 sc1 lds
v_mfma_f32_16x16x32_bf16 v[32:35], a[72:75], a[8:11], v[32:35]
ds_read_b128 a[100:103], v1 offset:9216
v_mfma_f32_16x16x32_bf16 v[32:35], a[76:79], a[12:15], v[32:35]
v_exp_f32 v8, v80
v_mfma_f32_16x16x32_bf16 v[32:35], a[80:83], a[16:19], v[32:35]
s_waitcnt lgkmcnt(4)
ds_read_b128 a[104:107], v1 offset:10240
v_add_f32 v26, v26, v8
v_mfma_f32_16x16x32_bf16 v[32:35], a[84:87], a[20:23], v[32:35]
s_waitcnt lgkmcnt(4)
buffer_load_dwordx4 v1, s[4:7], s8 offen offset:1024 sc1 lds
v_mfma_f32_16x16x32_bf16 v[32:35], a[88:91], a[24:27], v[32:35]
s_waitcnt lgkmcnt(3)
ds_read_b128 a[108:111], v1 offset:11264
v_mfma_f32_16x16x32_bf16 v[32:35], a[92:95], a[28:31], v[32:35]
v_exp_f32 v9, v81
v_mfma_f32_16x16x32_bf16 v[36:39], a[64:67], a[32:35], v[20:23]
ds_read_b128 a[112:115], v1 offset:12288
v_add_f32 v26, v26, v9
v_mfma_f32_16x16x32_bf16 v[36:39], a[68:71], a[36:39], v[36:39]
buffer_load_dwordx4 v1, s[4:7], s8 offen offset:2048 sc1 lds
v_mfma_f32_16x16x32_bf16 v[36:39], a[72:75], a[40:43], v[36:39]
ds_read_b128 a[116:119], v1 offset:13312
v_cvt_pk_bf16_f32 v116, v8, v9
v_mfma_f32_16x16x32_bf16 v[36:39], a[76:79], a[44:47], v[36:39]
v_exp_f32 v10, v82
v_mfma_f32_16x16x32_bf16 v[36:39], a[80:83], a[48:51], v[36:39]
ds_read_b128 a[120:123], v1 offset:14336
v_add_f32 v26, v26, v10
v_mfma_f32_16x16x32_bf16 v[36:39], a[84:87], a[52:55], v[36:39]
buffer_load_dwordx4 v1, s[4:7], s8 offen offset:3072 sc1 lds
v_mfma_f32_16x16x32_bf16 v[36:39], a[88:91], a[56:59], v[36:39]
s_add_u32 s8, s8, 4096
ds_read_b128 a[124:127], v1 offset:15360
v_mfma_f32_16x16x32_bf16 v[36:39], a[92:95], a[60:63], v[36:39]
s_waitcnt lgkmcnt(4)
v_exp_f32 v11, v83
v_mfma_f32_16x16x32_bf16 v[40:43], a[96:99], a[0:3], v[16:19]
s_add_u32 m0, s18, 135168
ds_read_b128 a[64:67], v1 offset:16384
v_add_f32 v26, v26, v11
v_mfma_f32_16x16x32_bf16 v[40:43], a[100:103], a[4:7], v[40:43]
buffer_load_dwordx4 v1, s[4:7], s8 offen offset:0 sc1 lds
v_mfma_f32_16x16x32_bf16 v[40:43], a[104:107], a[8:11], v[40:43]
ds_read_b128 a[68:71], v1 offset:17408
v_cvt_pk_bf16_f32 v117, v10, v11
v_mfma_f32_16x16x32_bf16 v[40:43], a[108:111], a[12:15], v[40:43]
s_waitcnt lgkmcnt(4)
v_mfma_f32_16x16x32_bf16 v[40:43], a[112:115], a[16:19], v[40:43]
ds_read_b128 a[72:75], v1 offset:18432
v_mfma_f32_16x16x32_bf16 v[40:43], a[116:119], a[20:23], v[40:43]
s_waitcnt lgkmcnt(4)
buffer_load_dwordx4 v1, s[4:7], s8 offen offset:1024 sc1 lds
v_mfma_f32_16x16x32_bf16 v[40:43], a[120:123], a[24:27], v[40:43]
s_waitcnt lgkmcnt(3)
ds_read_b128 a[76:79], v1 offset:19456
v_mfma_f32_16x16x32_bf16 v[40:43], a[124:127], a[28:31], v[40:43]
v_exp_f32 v12, v84
v_mfma_f32_16x16x32_bf16 v[44:47], a[96:99], a[32:35], v[20:23]
ds_read_b128 a[80:83], v1 offset:20480
v_add_f32 v27, v27, v12
v_mfma_f32_16x16x32_bf16 v[44:47], a[100:103], a[36:39], v[44:47]
buffer_load_dwordx4 v1, s[4:7], s8 offen offset:2048 sc1 lds
v_mfma_f32_16x16x32_bf16 v[44:47], a[104:107], a[40:43], v[44:47]
ds_read_b128 a[84:87], v1 offset:21504
v_mfma_f32_16x16x32_bf16 v[44:47], a[108:111], a[44:47], v[44:47]
v_exp_f32 v13, v85
v_mfma_f32_16x16x32_bf16 v[44:47], a[112:115], a[48:51], v[44:47]
ds_read_b128 a[88:91], v1 offset:22528
v_add_f32 v27, v27, v13
v_mfma_f32_16x16x32_bf16 v[44:47], a[116:119], a[52:55], v[44:47]
s_waitcnt lgkmcnt(3)
buffer_load_dwordx4 v1, s[4:7], s8 offen offset:3072 sc1 lds
v_mfma_f32_16x16x32_bf16 v[44:47], a[120:123], a[56:59], v[44:47]
s_add_u32 s8, s8, 28672
ds_read_b128 a[92:95], v1 offset:23552
v_cvt_pk_bf16_f32 v124, v12, v13
v_mfma_f32_16x16x32_bf16 v[44:47], a[124:127], a[60:63], v[44:47]
s_sub_u32 s9, s9, 1
v_exp_f32 v14, v86
v_mfma_f32_16x16x32_bf16 v[48:51], a[64:67], a[0:3], v[16:19]
s_cmp_eq_u32 s9, 0
ds_read_b128 a[96:99], v1 offset:24576
v_add_f32 v27, v27, v14
v_mfma_f32_16x16x32_bf16 v[48:51], a[68:71], a[4:7], v[48:51]
s_cselect_b32 s8, s10, s8
v_exp_f32 v15, v87
v_mfma_f32_16x16x32_bf16 v[48:51], a[72:75], a[8:11], v[48:51]
s_cselect_b32 s9, s11, s9
ds_read_b128 a[100:103], v1 offset:25600
v_add_f32 v27, v27, v15
v_mfma_f32_16x16x32_bf16 v[48:51], a[76:79], a[12:15], v[48:51]
s_waitcnt lgkmcnt(4)
s_cselect_b32 s10, 3221225472, s10
v_cvt_pk_bf16_f32 v125, v14, v15
v_mfma_f32_16x16x32_bf16 v[48:51], a[80:83], a[16:19], v[48:51]
ds_read_b128 a[104:107], v1 offset:26624
v_mfma_f32_16x16x32_bf16 v[48:51], a[84:87], a[20:23], v[48:51]
s_waitcnt lgkmcnt(4)
v_exp_f32 v8, v88
v_mfma_f32_16x16x32_bf16 v[48:51], a[88:91], a[24:27], v[48:51]
s_waitcnt lgkmcnt(3)
ds_read_b128 a[108:111], v1 offset:27648
v_add_f32 v26, v26, v8
v_mfma_f32_16x16x32_bf16 v[48:51], a[92:95], a[28:31], v[48:51]
v_exp_f32 v9, v89
v_mfma_f32_16x16x32_bf16 v[52:55], a[64:67], a[32:35], v[20:23]
ds_read_b128 a[112:115], v1 offset:28672
v_add_f32 v26, v26, v9
v_mfma_f32_16x16x32_bf16 v[52:55], a[68:71], a[36:39], v[52:55]
v_exp_f32 v10, v90
v_mfma_f32_16x16x32_bf16 v[52:55], a[72:75], a[40:43], v[52:55]
ds_read_b128 a[116:119], v1 offset:29696
v_cvt_pk_bf16_f32 v118, v8, v9
v_mfma_f32_16x16x32_bf16 v[52:55], a[76:79], a[44:47], v[52:55]
v_exp_f32 v11, v91
v_mfma_f32_16x16x32_bf16 v[52:55], a[80:83], a[48:51], v[52:55]
ds_read_b128 a[120:123], v1 offset:30720
v_add_f32 v26, v26, v10
v_mfma_f32_16x16x32_bf16 v[52:55], a[84:87], a[52:55], v[52:55]
v_add_f32 v26, v26, v11
v_cvt_pk_bf16_f32 v119, v10, v11
v_mfma_f32_16x16x32_bf16 v[52:55], a[88:91], a[56:59], v[52:55]
s_waitcnt vmcnt(8) lgkmcnt(4)
ds_read_b128 a[124:127], v1 offset:31744
v_mfma_f32_16x16x32_bf16 v[52:55], a[92:95], a[60:63], v[52:55]
s_barrier
v_mfma_f32_16x16x32_bf16 v[56:59], a[96:99], a[0:3], v[16:19]
ds_read_b128 a[64:67], v2 offset:32768
v_mfma_f32_16x16x32_bf16 v[56:59], a[100:103], a[4:7], v[56:59]
v_exp_f32 v12, v92
v_mfma_f32_16x16x32_bf16 v[56:59], a[104:107], a[8:11], v[56:59]
s_waitcnt lgkmcnt(4)
ds_read_b128 a[68:71], v2 offset:33792
v_add_f32 v27, v27, v12
v_mfma_f32_16x16x32_bf16 v[56:59], a[108:111], a[12:15], v[56:59]
v_exp_f32 v13, v93
v_mfma_f32_16x16x32_bf16 v[56:59], a[112:115], a[16:19], v[56:59]
s_waitcnt lgkmcnt(4)
ds_read_b128 a[72:75], v2 offset:34816
v_add_f32 v27, v27, v13
v_mfma_f32_16x16x32_bf16 v[56:59], a[116:119], a[20:23], v[56:59]
s_waitcnt lgkmcnt(4)
v_exp_f32 v14, v94
v_mfma_f32_16x16x32_bf16 v[56:59], a[120:123], a[24:27], v[56:59]
s_waitcnt lgkmcnt(3)
ds_read_b128 a[76:79], v2 offset:35840
v_cvt_pk_bf16_f32 v126, v12, v13
v_mfma_f32_16x16x32_bf16 v[56:59], a[124:127], a[28:31], v[56:59]
v_exp_f32 v15, v95
v_mfma_f32_16x16x32_bf16 v[60:63], a[96:99], a[32:35], v[20:23]
ds_read_b128 a[80:83], v2 offset:36864
v_add_f32 v27, v27, v14
v_mfma_f32_16x16x32_bf16 v[60:63], a[100:103], a[36:39], v[60:63]
v_add_f32 v27, v27, v15
v_cvt_pk_bf16_f32 v127, v14, v15
v_mfma_f32_16x16x32_bf16 v[60:63], a[104:107], a[40:43], v[60:63]
ds_read_b128 a[84:87], v2 offset:37888
v_add_f32 v28, v26, v27
v_mfma_f32_16x16x32_bf16 v[60:63], a[108:111], a[44:47], v[60:63]
v_cmp_nge_f32 vcc, s25, v28
v_mfma_f32_16x16x32_bf16 v[60:63], a[112:115], a[48:51], v[60:63]
ds_read_b128 a[88:91], v2 offset:38912
v_mfma_f32_16x16x32_bf16 v[60:63], a[116:119], a[52:55], v[60:63]
v_mfma_f32_16x16x32_bf16 v[60:63], a[120:123], a[56:59], v[60:63]
ds_read_b128 a[92:95], v2 offset:39936
v_mfma_f32_16x16x32_bf16 v[60:63], a[124:127], a[60:63], v[60:63]
s_waitcnt lgkmcnt(4)
s_cbranch_vccnz Lstub_2
Lback_3:
v_mfma_f32_16x16x32_bf16 v[128:131], a[64:67], v[112:115], v[128:131]
s_add_u32 m0, s18, 65536
ds_read_b128 a[96:99], v2 offset:40960
v_add_f32 v24, v24, v26
v_mfma_f32_16x16x32_bf16 v[128:131], a[68:71], v[116:119], v[128:131]
buffer_load_dwordx4 v1, s[4:7], s12 offen offset:0 sc1 lds
v_mfma_f32_16x16x32_bf16 v[132:135], a[68:71], v[124:127], v[132:135]
ds_read_b128 a[100:103], v2 offset:41984
v_add_f32 v25, v25, v27
v_mfma_f32_16x16x32_bf16 v[132:135], a[64:67], v[120:123], v[132:135]
v_exp_f32 v8, v32
v_mfma_f32_16x16x32_bf16 v[136:139], a[72:75], v[112:115], v[136:139]
ds_read_b128 a[104:107], v2 offset:43008
v_mfma_f32_16x16x32_bf16 v[136:139], a[76:79], v[116:119], v[136:139]
buffer_load_dwordx4 v1, s[4:7], s12 offen offset:1024 sc1 lds
v_mfma_f32_16x16x32_bf16 v[140:143], a[76:79], v[124:127], v[140:143]
ds_read_b128 a[108:111], v2 offset:44032
v_mfma_f32_16x16x32_bf16 v[140:143], a[72:75], v[120:123], v[140:143]
s_waitcnt lgkmcnt(4)
v_exp_f32 v9, v33
v_mfma_f32_16x16x32_bf16 v[144:147], a[80:83], v[112:115], v[144:147]
ds_read_b128 a[112:115], v2 offset:45056
v_add_f32 v26, v8, v9
v_mfma_f32_16x16x32_bf16 v[144:147], a[84:87], v[116:119], v[144:147]
buffer_load_dwordx4 v1, s[4:7], s12 offen offset:2048 sc1 lds
v_mfma_f32_16x16x32_bf16 v[148:151], a[84:87], v[124:127], v[148:151]
ds_read_b128 a[116:119], v2 offset:46080
v_cvt_pk_bf16_f32 v96, v8, v9
v_mfma_f32_16x16x32_bf16 v[148:151], a[80:83], v[120:123], v[148:151]
v_exp_f32 v10, v34
v_mfma_f32_16x16x32_bf16 v[152:155], a[88:91], v[112:115], v[152:155]
ds_read_b128 a[120:123], v2 offset:47104
v_add_f32 v26, v26, v10
v_mfma_f32_16x16x32_bf16 v[152:155], a[92:95], v[116:119], v[152:155]
buffer_load_dwordx4 v1, s[4:7], s12 offen offset:3072 sc1 lds
v_mfma_f32_16x16x32_bf16 v[156:159], a[92:95], v[124:127], v[156:159]
s_add_u32 s12, s12, 4096
ds_read_b128 a[124:127], v2 offset:48128
v_mfma_f32_16x16x32_bf16 v[156:159], a[88:91], v[120:123], v[156:159]
s_waitcnt lgkmcnt(4)
v_exp_f32 v11, v35
v_mfma_f32_16x16x32_bf16 v[160:163], a[96:99], v[112:115], v[160:163]
s_add_u32 m0, s18, 69632
ds_read_b128 a[64:67], v2 offset:49152
v_add_f32 v26, v26, v11
v_mfma_f32_16x16x32_bf16 v[160:163], a[100:103], v[116:119], v[160:163]
buffer_load_dwordx4 v1, s[4:7], s12 offen offset:0 sc1 lds
v_mfma_f32_16x16x32_bf16 v[164:167], a[100:103], v[124:127], v[164:167]
ds_read_b128 a[68:71], v2 offset:50176
v_cvt_pk_bf16_f32 v97, v10, v11
v_mfma_f32_16x16x32_bf16 v[164:167], a[96:99], v[120:123], v[164:167]
v_mfma_f32_16x16x32_bf16 v[168:171], a[104:107], v[112:115], v[168:171]
ds_read_b128 a[72:75], v2 offset:51200
v_mfma_f32_16x16x32_bf16 v[168:171], a[108:111], v[116:119], v[168:171]
buffer_load_dwordx4 v1, s[4:7], s12 offen offset:1024 sc1 lds
v_mfma_f32_16x16x32_bf16 v[172:175], a[108:111], v[124:127], v[172:175]
ds_read_b128 a[76:79], v2 offset:52224
v_mfma_f32_16x16x32_bf16 v[172:175], a[104:107], v[120:123], v[172:175]
s_waitcnt lgkmcnt(4)
v_exp_f32 v12, v36
v_mfma_f32_16x16x32_bf16 v[176:179], a[112:115], v[112:115], v[176:179]
ds_read_b128 a[80:83], v2 offset:53248
v_mfma_f32_16x16x32_bf16 v[176:179], a[116:119], v[116:119], v[176:179]
buffer_load_dwordx4 v1, s[4:7], s12 offen offset:2048 sc1 lds
v_mfma_f32_16x16x32_bf16 v[180:183], a[116:119], v[124:127], v[180:183]
ds_read_b128 a[84:87], v2 offset:54272
v_mfma_f32_16x16x32_bf16 v[180:183], a[112:115], v[120:123], v[180:183]
v_exp_f32 v13, v37
v_mfma_f32_16x16x32_bf16 v[184:187], a[120:123], v[112:115], v[184:187]
ds_read_b128 a[88:91], v2 offset:55296
v_add_f32 v27, v12, v13
v_mfma_f32_16x16x32_bf16 v[184:187], a[124:127], v[116:119], v[184:187]
s_waitcnt lgkmcnt(4)
buffer_load_dwordx4 v1, s[4:7], s12 offen offset:3072 sc1 lds
v_mfma_f32_16x16x32_bf16 v[188:191], a[124:127], v[124:127], v[188:191]
s_add_u32 s12, s12, 28672
ds_read_b128 a[92:95], v2 offset:56320
v_cvt_pk_bf16_f32 v104, v12, v13
v_mfma_f32_16x16x32_bf16 v[188:191], a[120:123], v[120:123], v[188:191]
s_sub_u32 s13, s13, 1
v_exp_f32 v14, v38
v_mfma_f32_16x16x32_bf16 v[192:195], a[64:67], v[112:115], v[192:195]
s_cmp_eq_u32 s13, 0
ds_read_b128 a[96:99], v2 offset:57344
v_add_f32 v27, v27, v14
v_mfma_f32_16x16x32_bf16 v[192:195], a[68:71], v[116:119], v[192:195]
s_cselect_b32 s12, s14, s12
v_mfma_f32_16x16x32_bf16 v[196:199], a[68:71], v[124:127], v[196:199]
s_cselect_b32 s13, s15, s13
ds_read_b128 a[100:103], v2 offset:58368
v_mfma_f32_16x16x32_bf16 v[196:199], a[64:67], v[120:123], v[196:199]
s_cselect_b32 s14, 3221225472, s14
v_exp_f32 v15, v39
v_mfma_f32_16x16x32_bf16 v[200:203], a[72:75], v[112:115], v[200:203]
s_waitcnt lgkmcnt(4)
ds_read_b128 a[104:107], v2 offset:59392
v_add_f32 v27, v27, v15
v_mfma_f32_16x16x32_bf16 v[200:203], a[76:79], v[116:119], v[200:203]
v_exp_f32 v8, v40
v_mfma_f32_16x16x32_bf16 v[204:207], a[76:79], v[124:127], v[204:207]
ds_read_b128 a[108:111], v2 offset:60416
v_cvt_pk_bf16_f32 v105, v14, v15
v_mfma_f32_16x16x32_bf16 v[204:207], a[72:75], v[120:123], v[204:207]
v_exp_f32 v9, v41
v_mfma_f32_16x16x32_bf16 v[208:211], a[80:83], v[112:115], v[208:211]
ds_read_b128 a[112:115], v2 offset:61440
v_add_f32 v26, v26, v8
v_mfma_f32_16x16x32_bf16 v[208:211], a[84:87], v[116:119], v[208:211]
v_add_f32 v26, v26, v9
v_cvt_pk_bf16_f32 v98, v8, v9
v_mfma_f32_16x16x32_bf16 v[212:215], a[84:87], v[124:127], v[212:215]
ds_read_b128 a[116:119], v2 offset:62464
v_mfma_f32_16x16x32_bf16 v[212:215], a[80:83], v[120:123], v[212:215]
s_waitcnt lgkmcnt(4)
v_exp_f32 v10, v42
v_mfma_f32_16x16x32_bf16 v[216:219], a[88:91], v[112:115], v[216:219]
ds_read_b128 a[120:123], v2 offset:63488
v_add_f32 v26, v26, v10
v_mfma_f32_16x16x32_bf16 v[216:219], a[92:95], v[116:119], v[216:219]
v_exp_f32 v11, v43
v_mfma_f32_16x16x32_bf16 v[220:223], a[92:95], v[124:127], v[220:223]
s_waitcnt vmcnt(8)
ds_read_b128 a[124:127], v2 offset:64512
v_add_f32 v26, v26, v11
v_mfma_f32_16x16x32_bf16 v[220:223], a[88:91], v[120:123], v[220:223]
s_barrier
v_mfma_f32_16x16x32_bf16 v[224:227], a[96:99], v[112:115], v[224:227]
ds_read_b128 a[64:67], v4 offset:0
v_cvt_pk_bf16_f32 v99, v10, v11
v_mfma_f32_16x16x32_bf16 v[224:227], a[100:103], v[116:119], v[224:227]
v_exp_f32 v12, v44
v_mfma_f32_16x16x32_bf16 v[228:231], a[100:103], v[124:127], v[228:231]
ds_read_b128 a[68:71], v4 offset:1024
v_add_f32 v27, v27, v12
v_mfma_f32_16x16x32_bf16 v[228:231], a[96:99], v[120:123], v[228:231]
s_waitcnt lgkmcnt(4)
v_mfma_f32_16x16x32_bf16 v[232:235], a[104:107], v[112:115], v[232:235]
ds_read_b128 a[72:75], v4 offset:2048
v_mfma_f32_16x16x32_bf16 v[232:235], a[108:111], v[116:119], v[232:235]
v_exp_f32 v13, v45
v_mfma_f32_16x16x32_bf16 v[236:239], a[108:111], v[124:127], v[236:239]
ds_read_b128 a[76:79], v4 offset:3072
v_add_f32 v27, v27, v13
v_mfma_f32_16x16x32_bf16 v[236:239], a[104:107], v[120:123], v[236:239]
v_exp_f32 v14, v46
v_mfma_f32_16x16x32_bf16 v[240:243], a[112:115], v[112:115], v[240:243]
ds_read_b128 a[80:83], v4 offset:4096
v_cvt_pk_bf16_f32 v106, v12, v13
v_mfma_f32_16x16x32_bf16 v[240:243], a[116:119], v[116:119], v[240:243]
v_exp_f32 v15, v47
v_mfma_f32_16x16x32_bf16 v[244:247], a[116:119], v[124:127], v[244:247]
ds_read_b128 a[84:87], v4 offset:5120
v_add_f32 v27, v27, v14
v_mfma_f32_16x16x32_bf16 v[244:247], a[112:115], v[120:123], v[244:247]
s_waitcnt lgkmcnt(4)
v_add_f32 v27, v27, v15
v_cvt_pk_bf16_f32 v107, v14, v15
v_mfma_f32_16x16x32_bf16 v[248:251], a[120:123], v[112:115], v[248:251]
ds_read_b128 a[88:91], v4 offset:6144
v_mfma_f32_16x16x32_bf16 v[248:251], a[124:127], v[116:119], v[248:251]
v_mfma_f32_16x16x32_bf16 v[252:255], a[124:127], v[124:127], v[252:255]
s_waitcnt lgkmcnt(5)
ds_read_b128 a[92:95], v4 offset:7168
v_mfma_f32_16x16x32_bf16 v[252:255], a[120:123], v[120:123], v[252:255]
s_branch K2_x1
K2_xexit:
s_cbranch_vccnz Lstub_4
Lback_5:
s_cmp_lg_u32 s19, 0
s_cbranch_scc1 K2_loop
s_cmp_eq_u32 s24, 2
s_cbranch_scc1 K2_ntail
v_mfma_f32_16x16x32_bf16 v[128:131], a[64:67], v[96:99], v[128:131]
s_add_u32 m0, s18, 98304
ds_read_b128 a[96:99], v2 offset:8192
v_add_f32 v24, v24, v26
v_mfma_f32_16x16x32_bf16 v[128:131], a[68:71], v[100:103], v[128:131]
buffer_load_dwordx4 v1, s[4:7], s12 offen offset:0 sc1 lds
v_mfma_f32_16x16x32_bf16 v[132:135], a[68:71], v[108:111], v[132:135]
ds_read_b128 a[100:103], v2 offset:9216
v_add_f32 v25, v25, v27
v_mfma_f32_16x16x32_bf16 v[132:135], a[64:67], v[104:107], v[132:135]
v_exp_f32 v8, v64
v_mfma_f32_16x16x32_bf16 v[136:139], a[72:75], v[96:99], v[136:139]
ds_read_b128 a[104:107], v2 offset:10240
v_mfma_f32_16x16x32_bf16 v[136:139], a[76:79], v[100:103], v[136:139]
buffer_load_dwordx4 v1, s[4:7], s12 offen offset:1024 sc1 lds
v_mfma_f32_16x16x32_bf16 v[140:143], a[76:79], v[108:111], v[140:143]
ds_read_b128 a[108:111], v2 offset:11264
v_mfma_f32_16x16x32_bf16 v[140:143], a[72:75], v[104:107], v[140:143]
s_waitcnt lgkmcnt(4)
v_exp_f32 v9, v65
v_mfma_f32_16x16x32_bf16 v[144:147], a[80:83], v[96:99], v[144:147]
ds_read_b128 a[112:115], v2 offset:12288
v_add_f32 v26, v8, v9
v_mfma_f32_16x16x32_bf16 v[144:147], a[84:87], v[100:103], v[144:147]
buffer_load_dwordx4 v1, s[4:7], s12 offen offset:2048 sc1 lds
v_mfma_f32_16x16x32_bf16 v[148:151], a[84:87], v[108:111], v[148:151]
ds_read_b128 a[116:119], v2 offset:13312
v_cvt_pk_bf16_f32 v112, v8, v9
v_mfma_f32_16x16x32_bf16 v[148:151], a[80:83], v[104:107], v[148:151]
v_exp_f32 v10, v66
v_mfma_f32_16x16x32_bf16 v[152:155], a[88:91], v[96:99], v[152:155]
ds_read_b128 a[120:123], v2 offset:14336
v_add_f32 v26, v26, v10
v_mfma_f32_16x16x32_bf16 v[152:155], a[92:95], v[100:103], v[152:155]
buffer_load_dwordx4 v1, s[4:7], s12 offen offset:3072 sc1 lds
v_mfma_f32_16x16x32_bf16 v[156:159], a[92:95], v[108:111], v[156:159]
s_add_u32 s12, s12, 4096
ds_read_b128 a[124:127], v2 offset:15360
v_mfma_f32_16x16x32_bf16 v[156:159], a[88:91], v[104:107], v[156:159]
s_waitcnt lgkmcnt(4)
v_exp_f32 v11, v67
v_mfma_f32_16x16x32_bf16 v[160:163], a[96:99], v[96:99], v[160:163]
s_add_u32 m0, s18, 102400
ds_read_b128 a[64:67], v2 offset:16384
v_add_f32 v26, v26, v11
v_mfma_f32_16x16x32_bf16 v[160:163], a[100:103], v[100:103], v[160:163]
buffer_load_dwordx4 v1, s[4:7], s12 offen offset:0 sc1 lds
v_mfma_f32_16x16x32_bf16 v[164:167], a[100:103], v[108:111], v[164:167]
ds_read_b128 a[68:71], v2 offset:17408
v_cvt_pk_bf16_f32 v113, v10, v11
v_mfma_f32_16x16x32_bf16 v[164:167], a[96:99], v[104:107], v[164:167]
v_mfma_f32_16x16x32_bf16 v[168:171], a[104:107], v[96:99], v[168:171]
ds_read_b128 a[72:75], v2 offset:18432
v_mfma_f32_16x16x32_bf16 v[168:171], a[108:111], v[100:103], v[168:171]
buffer_load_dwordx4 v1, s[4:7], s12 offen offset:1024 sc1 lds
v_mfma_f32_16x16x32_bf16 v[172:175], a[108:111], v[108:111], v[172:175]
ds_read_b128 a[76:79], v2 offset:19456
v_mfma_f32_16x16x32_bf16 v[172:175], a[104:107], v[104:107], v[172:175]
s_waitcnt lgkmcnt(4)
v_exp_f32 v12, v68
v_mfma_f32_16x16x32_bf16 v[176:179], a[112:115], v[96:99], v[176:179]
ds_read_b128 a[80:83], v2 offset:20480
v_mfma_f32_16x16x32_bf16 v[176:179], a[116:119], v[100:103], v[176:179]
buffer_load_dwordx4 v1, s[4:7], s12 offen offset:2048 sc1 lds
v_mfma_f32_16x16x32_bf16 v[180:183], a[116:119], v[108:111], v[180:183]
ds_read_b128 a[84:87], v2 offset:21504
v_mfma_f32_16x16x32_bf16 v[180:183], a[112:115], v[104:107], v[180:183]
v_exp_f32 v13, v69
v_mfma_f32_16x16x32_bf16 v[184:187], a[120:123], v[96:99], v[184:187]
ds_read_b128 a[88:91], v2 offset:22528
v_add_f32 v27, v12, v13
v_mfma_f32_16x16x32_bf16 v[184:187], a[124:127], v[100:103], v[184:187]
s_waitcnt lgkmcnt(4)
buffer_load_dwordx4 v1, s[4:7], s12 offen offset:3072 sc1 lds
v_mfma_f32_16x16x32_bf16 v[188:191], a[124:127], v[108:111], v[188:191]
s_add_u32 s12, s12, 28672
ds_read_b128 a[92:95], v2 offset:23552
v_cvt_pk_bf16_f32 v120, v12, v13
v_mfma_f32_16x16x32_bf16 v[188:191], a[120:123], v[104:107], v[188:191]
s_sub_u32 s13, s13, 1
v_exp_f32 v14, v70
v_mfma_f32_16x16x32_bf16 v[192:195], a[64:67], v[96:99], v[192:195]
s_cmp_eq_u32 s13, 0
ds_read_b128 a[96:99], v2 offset:24576
v_add_f32 v27, v27, v14
v_mfma_f32_16x16x32_bf16 v[192:195], a[68:71], v[100:103], v[192:195]
s_cselect_b32 s12, s14, s12
v_mfma_f32_16x16x32_bf16 v[196:199], a[68:71], v[108:111], v[196:199]
s_cselect_b32 s13, s15, s13
ds_read_b128 a[100:103], v2 offset:25600
v_mfma_f32_16x16x32_bf16 v[196:199], a[64:67], v[104:107], v[196:199]
s_cselect_b32 s14, 3221225472, s14
v_exp_f32 v15, v71
v_mfma_f32_16x16x32_bf16 v[200:203], a[72:75], v[96:99], v[200:203]
s_waitcnt lgkmcnt(4)
ds_read_b128 a[104:107], v2 offset:26624
v_add_f32 v27, v27, v15
v_mfma_f32_16x16x32_bf16 v[200:203], a[76:79], v[100:103], v[200:203]
v_exp_f32 v8, v72
v_mfma_f32_16x16x32_bf16 v[204:207], a[76:79], v[108:111], v[204:207]
ds_read_b128 a[108:111], v2 offset:27648
v_cvt_pk_bf16_f32 v121, v14, v15
v_mfma_f32_16x16x32_bf16 v[204:207], a[72:75], v[104:107], v[204:207]
v_exp_f32 v9, v73
v_mfma_f32_16x16x32_bf16 v[208:211], a[80:83], v[96:99], v[208:211]
ds_read_b128 a[112:115], v2 offset:28672
v_add_f32 v26, v26, v8
v_mfma_f32_16x16x32_bf16 v[208:211], a[84:87], v[100:103], v[208:211]
v_add_f32 v26, v26, v9
v_cvt_pk_bf16_f32 v114, v8, v9
v_mfma_f32_16x16x32_bf16 v[212:215], a[84:87], v[108:111], v[212:215]
ds_read_b128 a[116:119], v2 offset:29696
v_mfma_f32_16x16x32_bf16 v[212:215], a[80:83], v[104:107], v[212:215]
s_waitcnt lgkmcnt(4)
v_exp_f32 v10, v74
v_mfma_f32_16x16x32_bf16 v[216:219], a[88:91], v[96:99], v[216:219]
ds_read_b128 a[120:123], v2 offset:30720
v_add_f32 v26, v26, v10
v_mfma_f32_16x16x32_bf16 v[216:219], a[92:95], v[100:103], v[216:219]
v_exp_f32 v11, v75
v_mfma_f32_16x16x32_bf16 v[220:223], a[92:95], v[108:111], v[220:223]
s_waitcnt vmcnt(8)
ds_read_b128 a[124:127], v2 offset:31744
v_add_f32 v26, v26, v11
v_mfma_f32_16x16x32_bf16 v[220:223], a[88:91], v[104:107], v[220:223]
PAD_11:
s_cbranch_execz M_tret
s_barrier
v_mfma_f32_16x16x32_bf16 v[224:227], a[96:99], v[96:99], v[224:227]
ds_read_b128 a[64:67], v1 offset:0
v_cvt_pk_bf16_f32 v115, v10, v11
v_mfma_f32_16x16x32_bf16 v[224:227], a[100:103], v[100:103], v[224:227]
v_exp_f32 v12, v76
v_mfma_f32_16x16x32_bf16 v[228:231], a[100:103], v[108:111], v[228:231]
ds_read_b128 a[68:71], v1 offset:1024
v_add_f32 v27, v27, v12
v_mfma_f32_16x16x32_bf16 v[228:231], a[96:99], v[104:107], v[228:231]
s_waitcnt lgkmcnt(4)
v_mfma_f32_16x16x32_bf16 v[232:235], a[104:107], v[96:99], v[232:235]
ds_read_b128 a[72:75], v1 offset:2048
v_mfma_f32_16x16x32_bf16 v[232:235], a[108:111], v[100:103], v[232:235]
v_exp_f32 v13, v77
v_mfma_f32_16x16x32_bf16 v[236:239], a[108:111], v[108:111], v[236:239]
ds_read_b128 a[76:79], v1 offset:3072
v_add_f32 v27, v27, v13
v_mfma_f32_16x16x32_bf16 v[236:239], a[104:107], v[104:107], v[236:239]
v_exp_f32 v14, v78
v_mfma_f32_16x16x32_bf16 v[240:243], a[112:115], v[96:99], v[240:243]
ds_read_b128 a[80:83], v1 offset:4096
v_cvt_pk_bf16_f32 v122, v12, v13
v_mfma_f32_16x16x32_bf16 v[240:243], a[116:119], v[100:103], v[240:243]
v_exp_f32 v15, v79
v_mfma_f32_16x16x32_bf16 v[244:247], a[116:119], v[108:111], v[244:247]
ds_read_b128 a[84:87], v1 offset:5120
v_add_f32 v27, v27, v14
v_mfma_f32_16x16x32_bf16 v[244:247], a[112:115], v[104:107], v[244:247]
s_waitcnt lgkmcnt(4)
v_add_f32 v27, v27, v15
v_cvt_pk_bf16_f32 v123, v14, v15
v_mfma_f32_16x16x32_bf16 v[248:251], a[120:123], v[96:99], v[248:251]
ds_read_b128 a[88:91], v1 offset:6144
v_mfma_f32_16x16x32_bf16 v[248:251], a[124:127], v[100:103], v[248:251]
v_mfma_f32_16x16x32_bf16 v[252:255], a[124:127], v[108:111], v[252:255]
ds_read_b128 a[92:95], v1 offset:7168
v_mfma_f32_16x16x32_bf16 v[252:255], a[120:123], v[104:107], v[252:255]
v_cndmask_b32 v32, v16, v7, s[32:33]
v_cndmask_b32 v33, v16, v7, s[34:35]
v_cndmask_b32 v34, v16, v7, s[36:37]
v_cndmask_b32 v35, v16, v7, s[38:39]
s_nop 1
v_mfma_f32_16x16x32_bf16 v[32:35], a[64:67], a[0:3], v[32:35]
s_add_u32 m0, s18, 131072
ds_read_b128 a[96:99], v1 offset:8192
v_cndmask_b32 v40, v16, v7, s[40:41]
v_mfma_f32_16x16x32_bf16 v[32:35], a[68:71], a[4:7], v[32:35]
s_waitcnt lgkmcnt(4)
buffer_load_dwordx4 v1, s[4:7], s8 offen offset:0 sc1 lds
v_mfma_f32_16x16x32_bf16 v[32:35], a[72:75], a[8:11], v[32:35]
ds_read_b128 a[100:103], v1 offset:9216
v_cndmask_b32 v41, v16, v7, s[42:43]
v_mfma_f32_16x16x32_bf16 v[32:35], a[76:79], a[12:15], v[32:35]
v_cndmask_b32 v42, v16, v7, s[44:45]
v_cndmask_b32 v43, v16, v7, s[46:47]
v_mfma_f32_16x16x32_bf16 v[32:35], a[80:83], a[16:19], v[32:35]
s_waitcnt lgkmcnt(4)
ds_read_b128 a[104:107], v1 offset:10240
v_mfma_f32_16x16x32_bf16 v[32:35], a[84:87], a[20:23], v[32:35]
s_waitcnt lgkmcnt(4)
buffer_load_dwordx4 v1, s[4:7], s8 offen offset:1024 sc1 lds
v_mfma_f32_16x16x32_bf16 v[32:35], a[88:91], a[24:27], v[32:35]
s_waitcnt lgkmcnt(3)
ds_read_b128 a[108:111], v1 offset:11264
v_mfma_f32_16x16x32_bf16 v[32:35], a[92:95], a[28:31], v[32:35]
v_exp_f32 v8, v80
v_mfma_f32_16x16x32_bf16 v[36:39], a[64:67], a[32:35], v[20:23]
ds_read_b128 a[112:115], v1 offset:12288
v_add_f32 v26, v26, v8
v_mfma_f32_16x16x32_bf16 v[36:39], a[68:71], a[36:39], v[36:39]
buffer_load_dwordx4 v1, s[4:7], s8 offen offset:2048 sc1 lds
v_mfma_f32_16x16x32_bf16 v[36:39], a[72:75], a[40:43], v[36:39]
ds_read_b128 a[116:119], v1 offset:13312
v_mfma_f32_16x16x32_bf16 v[36:39], a[76:79], a[44:47], v[36:39]
v_exp_f32 v9, v81
v_mfma_f32_16x16x32_bf16 v[36:39], a[80:83], a[48:51], v[36:39]
ds_read_b128 a[120:123], v1 offset:14336
v_add_f32 v26, v26, v9
v_mfma_f32_16x16x32_bf16 v[36:39], a[84:87], a[52:55], v[36:39]
buffer_load_dwordx4 v1, s[4:7], s8 offen offset:3072 sc1 lds
v_mfma_f32_16x16x32_bf16 v[36:39], a[88:91], a[56:59], v[36:39]
s_add_u32 s8, s8, 4096
ds_read_b128 a[124:127], v1 offset:15360
v_cvt_pk_bf16_f32 v116, v8, v9
v_mfma_f32_16x16x32_bf16 v[36:39], a[92:95], a[60:63], v[36:39]
s_waitcnt lgkmcnt(4)
v_exp_f32 v10, v82
v_mfma_f32_16x16x32_bf16 v[40:43], a[96:99], a[0:3], v[40:43]
s_add_u32 m0, s18, 135168
ds_read_b128 a[64:67], v1 offset:16384
v_cndmask_b32 v48, v16, v7, s[48:49]
v_mfma_f32_16x16x32_bf16 v[40:43], a[100:103], a[4:7], v[40:43]
buffer_load_dwordx4 v1, s[4:7], s8 offen offset:0 sc1 lds
v_mfma_f32_16x16x32_bf16 v[40:43], a[104:107], a[8:11], v[40:43]
ds_read_b128 a[68:71], v1 offset:17408
v_cndmask_b32 v49, v16, v7, s[50:51]
v_mfma_f32_16x16x32_bf16 v[40:43], a[108:111], a[12:15], v[40:43]
s_waitcnt lgkmcnt(4)
v_cndmask_b32 v50, v16, v7, s[52:53]
v_cndmask_b32 v51, v16, v7, s[54:55]
v_mfma_f32_16x16x32_bf16 v[40:43], a[112:115], a[16:19], v[40:43]
ds_read_b128 a[72:75], v1 offset:18432
v_add_f32 v26, v26, v10
v_mfma_f32_16x16x32_bf16 v[40:43], a[116:119], a[20:23], v[40:43]
s_waitcnt lgkmcnt(4)
buffer_load_dwordx4 v1, s[4:7], s8 offen offset:1024 sc1 lds
v_mfma_f32_16x16x32_bf16 v[40:43], a[120:123], a[24:27], v[40:43]
s_waitcnt lgkmcnt(3)
ds_read_b128 a[76:79], v1 offset:19456
v_mfma_f32_16x16x32_bf16 v[40:43], a[124:127], a[28:31], v[40:43]
v_exp_f32 v11, v83
v_mfma_f32_16x16x32_bf16 v[44:47], a[96:99], a[32:35], v[20:23]
ds_read_b128 a[80:83], v1 offset:20480
v_add_f32 v26, v26, v11
v_mfma_f32_16x16x32_bf16 v[44:47], a[100:103], a[36:39], v[44:47]
buffer_load_dwordx4 v1, s[4:7], s8 offen offset:2048 sc1 lds
v_mfma_f32_16x16x32_bf16 v[44:47], a[104:107], a[40:43], v[44:47]
ds_read_b128 a[84:87], v1 offset:21504
v_cvt_pk_bf16_f32 v117, v10, v11
v_mfma_f32_16x16x32_bf16 v[44:47], a[108:111], a[44:47], v[44:47]
v_exp_f32 v12, v84
v_mfma_f32_16x16x32_bf16 v[44:47], a[112:115], a[48:51], v[44:47]
ds_read_b128 a[88:91], v1 offset:22528
v_add_f32 v27, v27, v12
v_mfma_f32_16x16x32_bf16 v[44:47], a[116:119], a[52:55], v[44:47]
buffer_load_dwordx4 v1, s[4:7], s8 offen offset:3072 sc1 lds
v_mfma_f32_16x16x32_bf16 v[44:47], a[120:123], a[56:59], v[44:47]
s_waitcnt lgkmcnt(2)
s_add_u32 s8, s8, 28672
ds_read_b128 a[92:95], v1 offset:23552
v_mfma_f32_16x16x32_bf16 v[44:47], a[124:127], a[60:63], v[44:47]
s_sub_u32 s9, s9, 1
v_exp_f32 v13, v85
v_mfma_f32_16x16x32_bf16 v[48:51], a[64:67], a[0:3], v[48:51]
s_cmp_eq_u32 s9, 0
ds_read_b128 a[96:99], v1 offset:24576
v_cndmask_b32 v56, v16, v7, s[56:57]
v_mfma_f32_16x16x32_bf16 v[48:51], a[68:71], a[4:7], v[48:51]
s_cselect_b32 s8, s10, s8
v_cndmask_b32 v57, v16, v7, s[58:59]
v_cndmask_b32 v58, v16, v7, s[60:61]
v_mfma_f32_16x16x32_bf16 v[48:51], a[72:75], a[8:11], v[48:51]
s_cselect_b32 s9, s11, s9
ds_read_b128 a[100:103], v1 offset:25600
v_cndmask_b32 v59, v16, v7, s[62:63]
v_mfma_f32_16x16x32_bf16 v[48:51], a[76:79], a[12:15], v[48:51]
s_cselect_b32 s10, 3221225472, s10
v_exp_f32 v14, v86
v_mfma_f32_16x16x32_bf16 v[48:51], a[80:83], a[16:19], v[48:51]
s_waitcnt lgkmcnt(4)
ds_read_b128 a[104:107], v1 offset:26624
v_add_f32 v27, v27, v13
v_cvt_pk_bf16_f32 v124, v12, v13
v_mfma_f32_16x16x32_bf16 v[48:51], a[84:87], a[20:23], v[48:51]
s_waitcnt lgkmcnt(4)
v_exp_f32 v15, v87
v_mfma_f32_16x16x32_bf16 v[48:51], a[88:91], a[24:27], v[48:51]
s_waitcnt lgkmcnt(3)
ds_read_b128 a[108:111], v1 offset:27648
v_add_f32 v27, v27, v14
v_mfma_f32_16x16x32_bf16 v[48:51], a[92:95], a[28:31], v[48:51]
v_exp_f32 v8, v88
v_mfma_f32_16x16x32_bf16 v[52:55], a[64:67], a[32:35], v[20:23]
ds_read_b128 a[112:115], v1 offset:28672
v_add_f32 v27, v27, v15
v_mfma_f32_16x16x32_bf16 v[52:55], a[68:71], a[36:39], v[52:55]
v_exp_f32 v9, v89
v_mfma_f32_16x16x32_bf16 v[52:55], a[72:75], a[40:43], v[52:55]
ds_read_b128 a[116:119], v1 offset:29696
v_cvt_pk_bf16_f32 v125, v14, v15
v_mfma_f32_16x16x32_bf16 v[52:55], a[76:79], a[44:47], v[52:55]
v_exp_f32 v10, v90
v_mfma_f32_16x16x32_bf16 v[52:55], a[80:83], a[48:51], v[52:55]
ds_read_b128 a[120:123], v1 offset:30720
v_add_f32 v26, v26, v8
v_mfma_f32_16x16x32_bf16 v[52:55], a[84:87], a[52:55], v[52:55]
v_exp_f32 v11, v91
v_mfma_f32_16x16x32_bf16 v[52:55], a[88:91], a[56:59], v[52:55]
s_waitcnt vmcnt(8) lgkmcnt(4)
ds_read_b128 a[124:127], v1 offset:31744
v_add_f32 v26, v26, v9
v_cvt_pk_bf16_f32 v118, v8, v9
v_mfma_f32_16x16x32_bf16 v[52:55], a[92:95], a[60:63], v[52:55]
s_barrier
v_mfma_f32_16x16x32_bf16 v[56:59], a[96:99], a[0:3], v[56:59]
ds_read_b128 a[64:67], v2 offset:32768
v_add_f32 v26, v26, v10
v_mfma_f32_16x16x32_bf16 v[56:59], a[100:103], a[4:7], v[56:59]
v_exp_f32 v12, v92
v_mfma_f32_16x16x32_bf16 v[56:59], a[104:107], a[8:11], v[56:59]
s_waitcnt lgkmcnt(4)
ds_read_b128 a[68:71], v2 offset:33792
v_add_f32 v26, v26, v11
v_cvt_pk_bf16_f32 v119, v10, v11
v_mfma_f32_16x16x32_bf16 v[56:59], a[108:111], a[12:15], v[56:59]
v_exp_f32 v13, v93
v_mfma_f32_16x16x32_bf16 v[56:59], a[112:115], a[16:19], v[56:59]
s_waitcnt lgkmcnt(4)
ds_read_b128 a[72:75], v2 offset:34816
v_add_f32 v27, v27, v12
v_mfma_f32_16x16x32_bf16 v[56:59], a[116:119], a[20:23], v[56:59]
s_waitcnt lgkmcnt(4)
v_exp_f32 v14, v94
v_mfma_f32_16x16x32_bf16 v[56:59], a[120:123], a[24:27], v[56:59]
s_waitcnt lgkmcnt(3)
ds_read_b128 a[76:79], v2 offset:35840
v_add_f32 v27, v27, v13
v_mfma_f32_16x16x32_bf16 v[56:59], a[124:127], a[28:31], v[56:59]
v_exp_f32 v15, v95
v_mfma_f32_16x16x32_bf16 v[60:63], a[96:99], a[32:35], v[20:23]
ds_read_b128 a[80:83], v2 offset:36864
v_cvt_pk_bf16_f32 v126, v12, v13
v_mfma_f32_16x16x32_bf16 v[60:63], a[100:103], a[36:39], v[60:63]
v_add_f32 v27, v27, v14
v_add_f32 v27, v27, v15
v_mfma_f32_16x16x32_bf16 v[60:63], a[104:107], a[40:43], v[60:63]
ds_read_b128 a[84:87], v2 offset:37888
v_cvt_pk_bf16_f32 v127, v14, v15
v_mfma_f32_16x16x32_bf16 v[60:63], a[108:111], a[44:47], v[60:63]
v_add_f32 v28, v26, v27
v_cmp_nge_f32 vcc, s25, v28
v_mfma_f32_16x16x32_bf16 v[60:63], a[112:115], a[48:51], v[60:63]
ds_read_b128 a[88:91], v2 offset:38912
v_mfma_f32_16x16x32_bf16 v[60:63], a[116:119], a[52:55], v[60:63]
v_mfma_f32_16x16x32_bf16 v[60:63], a[120:123], a[56:59], v[60:63]
ds_read_b128 a[92:95], v2 offset:39936
v_mfma_f32_16x16x32_bf16 v[60:63], a[124:127], a[60:63], v[60:63]
s_waitcnt lgkmcnt(4)
s_cbranch_vccnz Lstub_6
Lback_7:
v_mfma_f32_16x16x32_bf16 v[128:131], a[64:67], v[112:115], v[128:131]
s_add_u32 m0, s18, 65536
ds_read_b128 a[96:99], v2 offset:40960
v_add_f32 v24, v24, v26
v_mfma_f32_16x16x32_bf16 v[128:131], a[68:71], v[116:119], v[128:131]
buffer_load_dwordx4 v1, s[4:7], s12 offen offset:0 sc1 lds
v_mfma_f32_16x16x32_bf16 v[132:135], a[68:71], v[124:127], v[132:135]
ds_read_b128 a[100:103], v2 offset:41984
v_add_f32 v25, v25, v27
v_mfma_f32_16x16x32_bf16 v[132:135], a[64:67], v[120:123], v[132:135]
v_exp_f32 v8, v32
v_mfma_f32_16x16x32_bf16 v[136:139], a[72:75], v[112:115], v[136:139]
ds_read_b128 a[104:107], v2 offset:43008
v_mfma_f32_16x16x32_bf16 v[136:139], a[76:79], v[116:119], v[136:139]
buffer_load_dwordx4 v1, s[4:7], s12 offen offset:1024 sc1 lds
v_mfma_f32_16x16x32_bf16 v[140:143], a[76:79], v[124:127], v[140:143]
ds_read_b128 a[108:111], v2 offset:44032
v_mfma_f32_16x16x32_bf16 v[140:143], a[72:75], v[120:123], v[140:143]
s_waitcnt lgkmcnt(4)
v_exp_f32 v9, v33
v_mfma_f32_16x16x32_bf16 v[144:147], a[80:83], v[112:115], v[144:147]
ds_read_b128 a[112:115], v2 offset:45056
v_add_f32 v26, v8, v9
v_mfma_f32_16x16x32_bf16 v[144:147], a[84:87], v[116:119], v[144:147]
buffer_load_dwordx4 v1, s[4:7], s12 offen offset:2048 sc1 lds
v_mfma_f32_16x16x32_bf16 v[148:151], a[84:87], v[124:127], v[148:151]
ds_read_b128 a[116:119], v2 offset:46080
v_cvt_pk_bf16_f32 v96, v8, v9
v_mfma_f32_16x16x32_bf16 v[148:151], a[80:83], v[120:123], v[148:151]
v_exp_f32 v10, v34
v_mfma_f32_16x16x32_bf16 v[152:155], a[88:91], v[112:115], v[152:155]
ds_read_b128 a[120:123], v2 offset:47104
v_add_f32 v26, v26, v10
v_mfma_f32_16x16x32_bf16 v[152:155], a[92:95], v[116:119], v[152:155]
buffer_load_dwordx4 v1, s[4:7], s12 offen offset:3072 sc1 lds
v_mfma_f32_16x16x32_bf16 v[156:159], a[92:95], v[124:127], v[156:159]
s_add_u32 s12, s12, 4096
ds_read_b128 a[124:127], v2 offset:48128
v_mfma_f32_16x16x32_bf16 v[156:159], a[88:91], v[120:123], v[156:159]
s_waitcnt lgkmcnt(4)
v_exp_f32 v11, v35
v_mfma_f32_16x16x32_bf16 v[160:163], a[96:99], v[112:115], v[160:163]
s_add_u32 m0, s18, 69632
ds_read_b128 a[64:67], v2 offset:49152
v_add_f32 v26, v26, v11
v_mfma_f32_16x16x32_bf16 v[160:163], a[100:103], v[116:119], v[160:163]
buffer_load_dwordx4 v1, s[4:7], s12 offen offset:0 sc1 lds
v_mfma_f32_16x16x32_bf16 v[164:167], a[100:103], v[124:127], v[164:167]
ds_read_b128 a[68:71], v2 offset:50176
v_cvt_pk_bf16_f32 v97, v10, v11
v_mfma_f32_16x16x32_bf16 v[164:167], a[96:99], v[120:123], v[164:167]
v_mfma_f32_16x16x32_bf16 v[168:171], a[104:107], v[112:115], v[168:171]
ds_read_b128 a[72:75], v2 offset:51200
v_mfma_f32_16x16x32_bf16 v[168:171], a[108:111], v[116:119], v[168:171]
buffer_load_dwordx4 v1, s[4:7], s12 offen offset:1024 sc1 lds
v_mfma_f32_16x16x32_bf16 v[172:175], a[108:111], v[124:127], v[172:175]
ds_read_b128 a[76:79], v2 offset:52224
v_mfma_f32_16x16x32_bf16 v[172:175], a[104:107], v[120:123], v[172:175]
s_waitcnt lgkmcnt(4)
v_exp_f32 v12, v36
v_mfma_f32_16x16x32_bf16 v[176:179], a[112:115], v[112:115], v[176:179]
ds_read_b128 a[80:83], v2 offset:53248
v_mfma_f32_16x16x32_bf16 v[176:179], a[116:119], v[116:119], v[176:179]
buffer_load_dwordx4 v1, s[4:7], s12 offen offset:2048 sc1 lds
v_mfma_f32_16x16x32_bf16 v[180:183], a[116:119], v[124:127], v[180:183]
ds_read_b128 a[84:87], v2 offset:54272
v_mfma_f32_16x16x32_bf16 v[180:183], a[112:115], v[120:123], v[180:183]
v_exp_f32 v13, v37
v_mfma_f32_16x16x32_bf16 v[184:187], a[120:123], v[112:115], v[184:187]
ds_read_b128 a[88:91], v2 offset:55296
v_add_f32 v27, v12, v13
v_mfma_f32_16x16x32_bf16 v[184:187], a[124:127], v[116:119], v[184:187]
s_waitcnt lgkmcnt(4)
buffer_load_dwordx4 v1, s[4:7], s12 offen offset:3072 sc1 lds
v_mfma_f32_16x16x32_bf16 v[188:191], a[124:127], v[124:127], v[188:191]
s_add_u32 s12, s12, 28672
ds_read_b128 a[92:95], v2 offset:56320
v_cvt_pk_bf16_f32 v104, v12, v13
v_mfma_f32_16x16x32_bf16 v[188:191], a[120:123], v[120:123], v[188:191]
s_sub_u32 s13, s13, 1
v_exp_f32 v14, v38
v_mfma_f32_16x16x32_bf16 v[192:195], a[64:67], v[112:115], v[192:195]
s_cmp_eq_u32 s13, 0
ds_read_b128 a[96:99], v2 offset:57344
v_add_f32 v27, v27, v14
v_mfma_f32_16x16x32_bf16 v[192:195], a[68:71], v[116:119], v[192:195]
s_cselect_b32 s12, s14, s12
v_exp_f32 v15, v39
v_mfma_f32_16x16x32_bf16 v[196:199], a[68:71], v[124:127], v[196:199]
s_cselect_b32 s13, s15, s13
ds_read_b128 a[100:103], v2 offset:58368
v_add_f32 v27, v27, v15
v_mfma_f32_16x16x32_bf16 v[196:199], a[64:67], v[120:123], v[196:199]
s_cselect_b32 s14, 3221225472, s14
v_cvt_pk_bf16_f32 v105, v14, v15
v_mfma_f32_16x16x32_bf16 v[200:203], a[72:75], v[112:115], v[200:203]
s_waitcnt lgkmcnt(4)
ds_read_b128 a[104:107], v2 offset:59392
v_mfma_f32_16x16x32_bf16 v[200:203], a[76:79], v[116:119], v[200:203]
buffer_load_dword v3, off, s[4:7], s80 sc1
v_mfma_f32_16x16x32_bf16 v[204:207], a[76:79], v[124:127], v[204:207]
ds_read_b128 a[108:111], v2 offset:60416
v_mfma_f32_16x16x32_bf16 v[204:207], a[72:75], v[120:123], v[204:207]
v_exp_f32 v8, v40
v_mfma_f32_16x16x32_bf16 v[208:211], a[80:83], v[112:115], v[208:211]
ds_read_b128 a[112:115], v2 offset:61440
v_add_f32 v26, v26, v8
v_mfma_f32_16x16x32_bf16 v[208:211], a[84:87], v[116:119], v[208:211]
v_exp_f32 v9, v41
v_mfma_f32_16x16x32_bf16 v[212:215], a[84:87], v[124:127], v[212:215]
ds_read_b128 a[116:119], v2 offset:62464
v_add_f32 v26, v26, v9
v_mfma_f32_16x16x32_bf16 v[212:215], a[80:83], v[120:123], v[212:215]
s_waitcnt lgkmcnt(4)
v_exp_f32 v10, v42
v_mfma_f32_16x16x32_bf16 v[216:219], a[88:91], v[112:115], v[216:219]
ds_read_b128 a[120:123], v2 offset:63488
v_cvt_pk_bf16_f32 v98, v8, v9
v_mfma_f32_16x16x32_bf16 v[216:219], a[92:95], v[116:119], v[216:219]
v_exp_f32 v11, v43
v_mfma_f32_16x16x32_bf16 v[220:223], a[92:95], v[124:127], v[220:223]
s_waitcnt vmcnt(9)
ds_read_b128 a[124:127], v2 offset:64512
v_add_f32 v26, v26, v10
v_mfma_f32_16x16x32_bf16 v[220:223], a[88:91], v[120:123], v[220:223]
s_barrier
v_mfma_f32_16x16x32_bf16 v[224:227], a[96:99], v[112:115], v[224:227]
ds_read_b128 a[64:67], v4 offset:0
v_add_f32 v26, v26, v11
v_mfma_f32_16x16x32_bf16 v[224:227], a[100:103], v[116:119], v[224:227]
v_cvt_pk_bf16_f32 v99, v10, v11
v_mfma_f32_16x16x32_bf16 v[228:231], a[100:103], v[124:127], v[228:231]
ds_read_b128 a[68:71], v4 offset:1024
v_mfma_f32_16x16x32_bf16 v[228:231], a[96:99], v[120:123], v[228:231]
s_waitcnt lgkmcnt(4)
v_exp_f32 v12, v44
v_mfma_f32_16x16x32_bf16 v[232:235], a[104:107], v[112:115], v[232:235]
ds_read_b128 a[72:75], v4 offset:2048
v_add_f32 v27, v27, v12
v_mfma_f32_16x16x32_bf16 v[232:235], a[108:111], v[116:119], v[232:235]
v_exp_f32 v13, v45
v_mfma_f32_16x16x32_bf16 v[236:239], a[108:111], v[124:127], v[236:239]
ds_read_b128 a[76:79], v4 offset:3072
v_add_f32 v27, v27, v13
v_mfma_f32_16x16x32_bf16 v[236:239], a[104:107], v[120:123], v[236:239]
v_exp_f32 v14, v46
v_mfma_f32_16x16x32_bf16 v[240:243], a[112:115], v[112:115], v[240:243]
ds_read_b128 a[80:83], v4 offset:4096
v_cvt_pk_bf16_f32 v106, v12, v13
v_mfma_f32_16x16x32_bf16 v[240:243], a[116:119], v[116:119], v[240:243]
v_exp_f32 v15, v47
v_mfma_f32_16x16x32_bf16 v[244:247], a[116:119], v[124:127], v[244:247]
ds_read_b128 a[84:87], v4 offset:5120
v_add_f32 v27, v27, v14
v_mfma_f32_16x16x32_bf16 v[244:247], a[112:115], v[120:123], v[244:247]
s_waitcnt lgkmcnt(4)
v_add_f32 v27, v27, v15
v_cvt_pk_bf16_f32 v107, v14, v15
v_mfma_f32_16x16x32_bf16 v[248:251], a[120:123], v[112:115], v[248:251]
ds_read_b128 a[88:91], v4 offset:6144
v_mfma_f32_16x16x32_bf16 v[248:251], a[124:127], v[116:119], v[248:251]
v_mfma_f32_16x16x32_bf16 v[252:255], a[124:127], v[124:127], v[252:255]
ds_read_b128 a[92:95], v4 offset:7168
v_mfma_f32_16x16x32_bf16 v[252:255], a[120:123], v[120:123], v[252:255]
K2_dx1:
v_cndmask_b32 v68, v20, v7, s[32:33]
v_cndmask_b32 v69, v20, v7, s[34:35]
v_cndmask_b32 v70, v20, v7, s[36:37]
v_cndmask_b32 v71, v20, v7, s[38:39]
s_nop 1
v_mfma_f32_16x16x32_bf16 v[68:71], a[64:67], a[32:35], v[68:71]
s_add_u32 m0, s18, 0
ds_read_b128 a[96:99], v4 offset:8192
v_cndmask_b32 v76, v20, v7, s[40:41]
v_cndmask_b32 v79, v20, v7, s[46:47]
v_mfma_f32_16x16x32_bf16 v[68:71], a[68:71], a[36:39], v[68:71]
s_waitcnt lgkmcnt(4)
ds_read_b128 a[100:103], v4 offset:9216
buffer_load_dwordx4 v1, s[4:7], s12 offen offset:0 sc1 lds
v_mfma_f32_16x16x32_bf16 v[68:71], a[72:75], a[40:43], v[68:71]
ds_read_b128 a[104:107], v4 offset:10240
v_cndmask_b32 v77, v20, v7, s[42:43]
v_mfma_f32_16x16x32_bf16 v[68:71], a[76:79], a[44:47], v[68:71]
ds_read_b128 a[108:111], v4 offset:11264
buffer_load_dwordx4 v1, s[4:7], s12 offen offset:1024 sc1 lds
v_mfma_f32_16x16x32_bf16 v[68:71], a[80:83], a[48:51], v[68:71]
s_waitcnt lgkmcnt(6)
ds_read_b128 a[112:115], v4 offset:12288
v_cndmask_b32 v78, v20, v7, s[44:45]
v_mfma_f32_16x16x32_bf16 v[68:71], a[84:87], a[52:55], v[68:71]
s_waitcnt lgkmcnt(6)
ds_read_b128 a[116:119], v4 offset:13312
buffer_load_dwordx4 v1, s[4:7], s12 offen offset:2048 sc1 lds
v_mfma_f32_16x16x32_bf16 v[68:71], a[88:91], a[56:59], v[68:71]
s_waitcnt lgkmcnt(6)
ds_read_b128 a[120:123], v4 offset:14336
v_exp_f32 v8, v48
v_exp_f32 v9, v49
v_exp_f32 v10, v50
v_mfma_f32_16x16x32_bf16 v[68:71], a[92:95], a[60:63], v[68:71]
s_waitcnt lgkmcnt(5)
ds_read_b128 a[124:127], v4 offset:15360
buffer_load_dwordx4 v1, s[4:7], s12 offen offset:3072 sc1 lds
v_add_f32 v26, v26, v8
v_add_f32 v26, v26, v9
v_cvt_pk_bf16_f32 v100, v8, v9
v_add_f32 v26, v26, v10
v_mfma_f32_16x16x32_bf16 v[76:79], a[96:99], a[32:35], v[76:79]
s_add_u32 s12, s12, 4096
s_add_u32 m0, s18, 4096
ds_read_b128 a[64:67], v4 offset:16384
v_cndmask_b32 v86, v20, v7, s[52:53]
v_cndmask_b32 v87, v20, v7, s[54:55]
v_mfma_f32_16x16x32_bf16 v[76:79], a[100:103], a[36:39], v[76:79]
s_waitcnt lgkmcnt(6)
ds_read_b128 a[68:71], v4 offset:17408
buffer_load_dwordx4 v1, s[4:7], s12 offen offset:0 sc1 lds
v_mfma_f32_16x16x32_bf16 v[76:79], a[104:107], a[40:43], v[76:79]
s_waitcnt lgkmcnt(6)
ds_read_b128 a[72:75], v4 offset:18432
v_cndmask_b32 v84, v20, v7, s[48:49]
v_mfma_f32_16x16x32_bf16 v[76:79], a[108:111], a[44:47], v[76:79]
s_waitcnt lgkmcnt(6)
ds_read_b128 a[76:79], v4 offset:19456
buffer_load_dwordx4 v1, s[4:7], s12 offen offset:1024 sc1 lds
v_mfma_f32_16x16x32_bf16 v[76:79], a[112:115], a[48:51], v[76:79]
s_waitcnt lgkmcnt(6)
ds_read_b128 a[80:83], v4 offset:20480
v_cndmask_b32 v85, v20, v7, s[50:51]
v_mfma_f32_16x16x32_bf16 v[76:79], a[116:119], a[52:55], v[76:79]
s_waitcnt lgkmcnt(6)
ds_read_b128 a[84:87], v4 offset:21504
buffer_load_dwordx4 v1, s[4:7], s12 offen offset:2048 sc1 lds
v_mfma_f32_16x16x32_bf16 v[76:79], a[120:123], a[56:59], v[76:79]
s_waitcnt lgkmcnt(6)
ds_read_b128 a[88:91], v4 offset:22528
v_exp_f32 v11, v51
v_exp_f32 v12, v52
v_mfma_f32_16x16x32_bf16 v[76:79], a[124:127], a[60:63], v[76:79]
s_waitcnt lgkmcnt(1)
ds_read_b128 a[92:95], v4 offset:23552
buffer_load_dwordx4 v1, s[4:7], s12 offen offset:3072 sc1 lds
v_add_f32 v26, v26, v11
v_cvt_pk_bf16_f32 v101, v10, v11
v_add_f32 v27, v27, v12
v_mfma_f32_16x16x32_bf16 v[84:87], a[64:67], a[32:35], v[84:87]
s_add_u32 s12, s12, 28672
ds_read_b128 a[96:99], v4 offset:24576
v_cndmask_b32 v92, v20, v7, s[56:57]
v_mfma_f32_16x16x32_bf16 v[84:87], a[68:71], a[36:39], v[84:87]
s_sub_u32 s13, s13, 1
ds_read_b128 a[100:103], v4 offset:25600
v_cndmask_b32 v93, v20, v7, s[58:59]
v_mfma_f32_16x16x32_bf16 v[84:87], a[72:75], a[40:43], v[84:87]
s_cmp_eq_u32 s13, 0
ds_read_b128 a[104:107], v4 offset:26624
v_cndmask_b32 v94, v20, v7, s[60:61]
v_mfma_f32_16x16x32_bf16 v[84:87], a[76:79], a[44:47], v[84:87]
s_cselect_b32 s12, s14, s12
ds_read_b128 a[108:111], v4 offset:27648
v_cndmask_b32 v95, v20, v7, s[62:63]
v_mfma_f32_16x16x32_bf16 v[84:87], a[80:83], a[48:51], v[84:87]
s_cselect_b32 s13, s15, s13
ds_read_b128 a[112:115], v4 offset:28672
v_exp_f32 v13, v53
v_exp_f32 v14, v54
v_mfma_f32_16x16x32_bf16 v[84:87], a[84:87], a[52:55], v[84:87]
s_waitcnt lgkmcnt(6)
s_cselect_b32 s14, 3221225472, s14
ds_read_b128 a[116:119], v4 offset:29696
v_exp_f32 v15, v55
v_exp_f32 v8, v56
v_exp_f32 v9, v57
v_add_f32 v27, v27, v13
v_cvt_pk_bf16_f32 v108, v12, v13
v_add_f32 v27, v27, v14
v_mfma_f32_16x16x32_bf16 v[84:87], a[88:91], a[56:59], v[84:87]
s_waitcnt lgkmcnt(6)
ds_read_b128 a[120:123], v4 offset:30720
v_exp_f32 v10, v58
v_exp_f32 v11, v59
v_add_f32 v27, v27, v15
v_cvt_pk_bf16_f32 v109, v14, v15
v_mfma_f32_16x16x32_bf16 v[84:87], a[92:95], a[60:63], v[84:87]
s_waitcnt vmcnt(8) lgkmcnt(6)
s_barrier
ds_read_b128 a[124:127], v4 offset:31744
v_mfma_f32_16x16x32_bf16 v[92:95], a[96:99], a[32:35], v[92:95]
s_waitcnt lgkmcnt(6)
ds_read_b128 a[64:67], v2 offset:0
v_exp_f32 v12, v60
v_exp_f32 v13, v61
v_mfma_f32_16x16x32_bf16 v[92:95], a[100:103], a[36:39], v[92:95]
s_waitcnt lgkmcnt(6)
ds_read_b128 a[68:71], v2 offset:1024
v_exp_f32 v14, v62
v_exp_f32 v15, v63
v_mfma_f32_16x16x32_bf16 v[92:95], a[104:107], a[40:43], v[92:95]
s_waitcnt lgkmcnt(6)
ds_read_b128 a[72:75], v2 offset:2048
v_add_f32 v26, v26, v8
v_add_f32 v26, v26, v9
v_cvt_pk_bf16_f32 v102, v8, v9
v_mfma_f32_16x16x32_bf16 v[92:95], a[108:111], a[44:47], v[92:95]
s_waitcnt lgkmcnt(6)
ds_read_b128 a[76:79], v2 offset:3072
v_add_f32 v26, v26, v10
v_add_f32 v26, v26, v11
v_cvt_pk_bf16_f32 v103, v10, v11
v_mfma_f32_16x16x32_bf16 v[92:95], a[112:115], a[48:51], v[92:95]
s_waitcnt lgkmcnt(6)
ds_read_b128 a[80:83], v2 offset:4096
v_add_f32 v27, v27, v12
v_mfma_f32_16x16x32_bf16 v[92:95], a[116:119], a[52:55], v[92:95]
s_waitcnt lgkmcnt(6)
ds_read_b128 a[84:87], v2 offset:5120
v_add_f32 v27, v27, v13
v_cvt_pk_bf16_f32 v110, v12, v13
v_mfma_f32_16x16x32_bf16 v[92:95], a[120:123], a[56:59], v[92:95]
s_waitcnt lgkmcnt(6)
ds_read_b128 a[88:91], v2 offset:6144
v_add_f32 v27, v27, v14
v_add_f32 v27, v27, v15
v_cvt_pk_bf16_f32 v111, v14, v15
v_mfma_f32_16x16x32_bf16 v[92:95], a[124:127], a[60:63], v[92:95]
s_waitcnt lgkmcnt(6)
ds_read_b128 a[92:95], v2 offset:7168
v_add_f32 v28, v26, v27
v_cmp_nge_f32 vcc, s25, v28
s_cbranch_vccnz Lstub_8
Lback_9:
s_cmp_lg_u32 s24, 1
s_cbranch_scc1 K2_plain
v_cmp_gt_u32 vcc, 1, v3
s_cbranch_vccnz K2_tspin
K2_tok:
v_mfma_f32_16x16x32_bf16 v[128:131], a[64:67], v[96:99], v[128:131]
s_waitcnt lgkmcnt(6)
ds_read_b128 a[96:99], v2 offset:8192
v_add_f32 v24, v24, v26
v_mfma_f32_16x16x32_bf16 v[128:131], a[68:71], v[100:103], v[128:131]
buffer_load_dwordx4 v[28:31], v1, s[4:7], s27 offen sc1
v_mfma_f32_16x16x32_bf16 v[132:135], a[68:71], v[108:111], v[132:135]
ds_read_b128 a[100:103], v2 offset:9216
v_add_f32 v25, v25, v27
v_mfma_f32_16x16x32_bf16 v[132:135], a[64:67], v[104:107], v[132:135]
s_waitcnt lgkmcnt(6)
v_exp_f32 v8, v68
v_mfma_f32_16x16x32_bf16 v[136:139], a[72:75], v[96:99], v[136:139]
s_add_u32 s22, s76, 0
ds_read_b128 a[104:107], v2 offset:10240
v_exp_f32 v9, v69
v_mfma_f32_16x16x32_bf16 v[136:139], a[76:79], v[100:103], v[136:139]
buffer_load_dwordx4 v[32:35], v1, s[4:7], s22 offen offset:0 sc1
v_mfma_f32_16x16x32_bf16 v[140:143], a[76:79], v[108:111], v[140:143]
ds_read_b128 a[108:111], v2 offset:11264
v_add_f32 v27, v8, v9
v_mfma_f32_16x16x32_bf16 v[140:143], a[72:75], v[104:107], v[140:143]
s_waitcnt lgkmcnt(5)
v_exp_f32 v10, v70
v_mfma_f32_16x16x32_bf16 v[144:147], a[80:83], v[96:99], v[144:147]
ds_read_b128 a[112:115], v2 offset:12288
v_cvt_pk_bf16_f32 v120, v8, v9
v_mfma_f32_16x16x32_bf16 v[144:147], a[84:87], v[100:103], v[144:147]
buffer_load_dwordx4 v[36:39], v1, s[4:7], s22 offen offset:1024 sc1
v_mfma_f32_16x16x32_bf16 v[148:151], a[84:87], v[108:111], v[148:151]
ds_read_b128 a[116:119], v2 offset:13312
v_add_f32 v27, v27, v10
v_mfma_f32_16x16x32_bf16 v[148:151], a[80:83], v[104:107], v[148:151]
v_exp_f32 v11, v71
v_mfma_f32_16x16x32_bf16 v[152:155], a[88:91], v[96:99], v[152:155]
s_waitcnt lgkmcnt(4)
ds_read_b128 a[120:123], v2 offset:14336
v_add_f32 v27, v27, v11
v_mfma_f32_16x16x32_bf16 v[152:155], a[92:95], v[100:103], v[152:155]
buffer_load_dwordx4 v[40:43], v1, s[4:7], s22 offen offset:2048 sc1
v_mfma_f32_16x16x32_bf16 v[156:159], a[92:95], v[108:111], v[156:159]
ds_read_b128 a[124:127], v2 offset:15360
v_cvt_pk_bf16_f32 v121, v10, v11
v_mfma_f32_16x16x32_bf16 v[156:159], a[88:91], v[104:107], v[156:159]
v_exp_f32 v12, v76
v_mfma_f32_16x16x32_bf16 v[160:163], a[96:99], v[96:99], v[160:163]
ds_read_b128 a[64:67], v2 offset:16384
v_add_f32 v27, v27, v12
v_mfma_f32_16x16x32_bf16 v[160:163], a[100:103], v[100:103], v[160:163]
buffer_load_dwordx4 v[44:47], v1, s[4:7], s22 offen offset:3072 sc1
v_mfma_f32_16x16x32_bf16 v[164:167], a[100:103], v[108:111], v[164:167]
PAD_12:
s_cbranch_execz M_tret
ds_read_b128 a[68:71], v2 offset:17408
v_mfma_f32_16x16x32_bf16 v[164:167], a[96:99], v[104:107], v[164:167]
s_waitcnt lgkmcnt(4)
v_exp_f32 v13, v77
v_mfma_f32_16x16x32_bf16 v[168:171], a[104:107], v[96:99], v[168:171]
s_add_u32 s22, s76, 4096
ds_read_b128 a[72:75], v2 offset:18432
v_add_f32 v27, v27, v13
v_mfma_f32_16x16x32_bf16 v[168:171], a[108:111], v[100:103], v[168:171]
buffer_load_dwordx4 v[48:51], v1, s[4:7], s22 offen offset:0 sc1
v_mfma_f32_16x16x32_bf16 v[172:175], a[108:111], v[108:111], v[172:175]
ds_read_b128 a[76:79], v2 offset:19456
v_exp_f32 v14, v78
v_mfma_f32_16x16x32_bf16 v[172:175], a[104:107], v[104:107], v[172:175]
v_exp_f32 v15, v79
v_mfma_f32_16x16x32_bf16 v[176:179], a[112:115], v[96:99], v[176:179]
ds_read_b128 a[80:83], v2 offset:20480
v_cvt_pk_bf16_f32 v122, v12, v13
v_mfma_f32_16x16x32_bf16 v[176:179], a[116:119], v[100:103], v[176:179]
buffer_load_dwordx4 v[52:55], v1, s[4:7], s22 offen offset:1024 sc1
v_mfma_f32_16x16x32_bf16 v[180:183], a[116:119], v[108:111], v[180:183]
ds_read_b128 a[84:87], v2 offset:21504
v_add_f32 v27, v27, v14
v_mfma_f32_16x16x32_bf16 v[180:183], a[112:115], v[104:107], v[180:183]
s_waitcnt lgkmcnt(4)
v_exp_f32 v8, v84
v_mfma_f32_16x16x32_bf16 v[184:187], a[120:123], v[96:99], v[184:187]
ds_read_b128 a[88:91], v2 offset:22528
v_add_f32 v27, v27, v15
v_cvt_pk_bf16_f32 v123, v14, v15
v_mfma_f32_16x16x32_bf16 v[184:187], a[124:127], v[100:103], v[184:187]
buffer_load_dwordx4 v[56:59], v1, s[4:7], s22 offen offset:2048 sc1
v_mfma_f32_16x16x32_bf16 v[188:191], a[124:127], v[108:111], v[188:191]
ds_read_b128 a[92:95], v2 offset:23552
v_add_f32 v27, v27, v8
v_mfma_f32_16x16x32_bf16 v[188:191], a[120:123], v[104:107], v[188:191]
v_exp_f32 v9, v85
v_mfma_f32_16x16x32_bf16 v[192:195], a[64:67], v[96:99], v[192:195]
ds_read_b128 a[96:99], v2 offset:24576
v_add_f32 v27, v27, v9
v_mfma_f32_16x16x32_bf16 v[192:195], a[68:71], v[100:103], v[192:195]
buffer_load_dwordx4 v[60:63], v1, s[4:7], s22 offen offset:3072 sc1
v_mfma_f32_16x16x32_bf16 v[196:199], a[68:71], v[108:111], v[196:199]
ds_read_b128 a[100:103], v2 offset:25600
v_cvt_pk_bf16_f32 v124, v8, v9
v_mfma_f32_16x16x32_bf16 v[196:199], a[64:67], v[104:107], v[196:199]
s_waitcnt lgkmcnt(4)
v_exp_f32 v10, v86
v_mfma_f32_16x16x32_bf16 v[200:203], a[72:75], v[96:99], v[200:203]
s_add_u32 s22, s76, 8192
ds_read_b128 a[104:107], v2 offset:26624
v_add_f32 v27, v27, v10
v_mfma_f32_16x16x32_bf16 v[200:203], a[76:79], v[100:103], v[200:203]
buffer_load_dwordx4 a[32:35], v1, s[4:7], s22 offen offset:0 sc1
v_mfma_f32_16x16x32_bf16 v[204:207], a[76:79], v[108:111], v[204:207]
ds_read_b128 a[108:111], v2 offset:27648
v_mfma_f32_16x16x32_bf16 v[204:207], a[72:75], v[104:107], v[204:207]
v_exp_f32 v11, v87
v_mfma_f32_16x16x32_bf16 v[208:211], a[80:83], v[96:99], v[208:211]
ds_read_b128 a[112:115], v2 offset:28672
v_exp_f32 v12, v92
v_mfma_f32_16x16x32_bf16 v[208:211], a[84:87], v[100:103], v[208:211]
buffer_load_dwordx4 a[36:39], v1, s[4:7], s22 offen offset:1024 sc1
v_mfma_f32_16x16x32_bf16 v[212:215], a[84:87], v[108:111], v[212:215]
ds_read_b128 a[116:119], v2 offset:29696
v_add_f32 v27, v27, v11
v_mfma_f32_16x16x32_bf16 v[212:215], a[80:83], v[104:107], v[212:215]
s_waitcnt lgkmcnt(4)
v_exp_f32 v13, v93
v_mfma_f32_16x16x32_bf16 v[216:219], a[88:91], v[96:99], v[216:219]
ds_read_b128 a[120:123], v2 offset:30720
v_cvt_pk_bf16_f32 v125, v10, v11
v_add_f32 v27, v27, v12
v_mfma_f32_16x16x32_bf16 v[216:219], a[92:95], v[100:103], v[216:219]
buffer_load_dwordx4 a[40:43], v1, s[4:7], s22 offen offset:2048 sc1
v_mfma_f32_16x16x32_bf16 v[220:223], a[92:95], v[108:111], v[220:223]
s_waitcnt vmcnt(12)
ds_read_b128 a[124:127], v2 offset:31744
v_add_f32 v27, v27, v13
v_mfma_f32_16x16x32_bf16 v[220:223], a[88:91], v[104:107], v[220:223]
s_barrier
v_mfma_f32_16x16x32_bf16 v[224:227], a[96:99], v[96:99], v[224:227]
ds_read_b128 a[64:67], v1 offset:0
v_cvt_pk_bf16_f32 v126, v12, v13
v_mfma_f32_16x16x32_bf16 v[224:227], a[100:103], v[100:103], v[224:227]
buffer_load_dwordx4 a[44:47], v1, s[4:7], s22 offen offset:3072 sc1
v_mfma_f32_16x16x32_bf16 v[228:231], a[100:103], v[108:111], v[228:231]
ds_read_b128 a[68:71], v1 offset:1024
v_mfma_f32_16x16x32_bf16 v[228:231], a[96:99], v[104:107], v[228:231]
s_waitcnt lgkmcnt(4)
v_exp_f32 v14, v94
v_mfma_f32_16x16x32_bf16 v[232:235], a[104:107], v[96:99], v[232:235]
s_add_u32 s22, s76, 12288
ds_read_b128 a[72:75], v1 offset:2048
v_add_f32 v27, v27, v14
v_mfma_f32_16x16x32_bf16 v[232:235], a[108:111], v[100:103], v[232:235]
buffer_load_dwordx4 a[48:51], v1, s[4:7], s22 offen offset:0 sc1
v_mfma_f32_16x16x32_bf16 v[236:239], a[108:111], v[108:111], v[236:239]
ds_read_b128 a[76:79], v1 offset:3072
v_mfma_f32_16x16x32_bf16 v[236:239], a[104:107], v[104:107], v[236:239]
v_exp_f32 v15, v95
v_mfma_f32_16x16x32_bf16 v[240:243], a[112:115], v[96:99], v[240:243]
ds_read_b128 a[80:83], v1 offset:4096
v_add_f32 v27, v27, v15
v_mfma_f32_16x16x32_bf16 v[240:243], a[116:119], v[100:103], v[240:243]
buffer_load_dwordx4 a[52:55], v1, s[4:7], s22 offen offset:1024 sc1
v_mfma_f32_16x16x32_bf16 v[244:247], a[116:119], v[108:111], v[244:247]
ds_read_b128 a[84:87], v1 offset:5120
v_cvt_pk_bf16_f32 v127, v14, v15
v_mfma_f32_16x16x32_bf16 v[244:247], a[112:115], v[104:107], v[244:247]
s_waitcnt lgkmcnt(4)
v_cmp_nge_f32 vcc, s25, v27
v_mfma_f32_16x16x32_bf16 v[248:251], a[120:123], v[96:99], v[248:251]
ds_read_b128 a[88:91], v1 offset:6144
v_mfma_f32_16x16x32_bf16 v[248:251], a[124:127], v[100:103], v[248:251]
buffer_load_dwordx4 a[56:59], v1, s[4:7], s22 offen offset:2048 sc1
v_mfma_f32_16x16x32_bf16 v[252:255], a[124:127], v[108:111], v[252:255]
ds_read_b128 a[92:95], v1 offset:7168
v_mfma_f32_16x16x32_bf16 v[252:255], a[120:123], v[104:107], v[252:255]
s_waitcnt lgkmcnt(2)
buffer_load_dwordx4 a[60:63], v1, s[4:7], s22 offen offset:3072 sc1
s_cbranch_vccnz Lstub_10
Lback_11:
v_mfma_f32_16x16x32_bf16 v[132:135], a[64:67], v[120:123], v[132:135]
s_mov_b64 s[36:37], s[86:87]
ds_read_b128 a[96:99], v1 offset:8192
v_add_f32 v25, v25, v27
v_mfma_f32_16x16x32_bf16 v[132:135], a[68:71], v[124:127], v[132:135]
s_mov_b32 s38, 3670016
ds_read_b128 a[100:103], v1 offset:9216
v_accvgpr_read_b32 v112, a184
v_mfma_f32_16x16x32_bf16 v[140:143], a[72:75], v[120:123], v[140:143]
s_mov_b32 s39, 0x20000
ds_read_b128 a[104:107], v1 offset:10240
v_accvgpr_read_b32 v113, a185
v_mfma_f32_16x16x32_bf16 v[140:143], a[76:79], v[124:127], v[140:143]
s_lshl_b32 s8, s29, 3
ds_read_b128 a[108:111], v1 offset:11264
v_accvgpr_read_b32 v114, a186
v_mfma_f32_16x16x32_bf16 v[148:151], a[80:83], v[120:123], v[148:151]
s_add_u32 s8, s8, s3
ds_read_b128 a[112:115], v1 offset:12288
v_accvgpr_read_b32 v115, a187
v_mfma_f32_16x16x32_bf16 v[148:151], a[84:87], v[124:127], v[148:151]
s_waitcnt lgkmcnt(3)
s_lshl_b32 s8, s8, 4
ds_read_b128 a[116:119], v1 offset:13312
v_accvgpr_read_b32 v116, a188
v_mfma_f32_16x16x32_bf16 v[156:159], a[88:91], v[120:123], v[156:159]
s_add_u32 s8, s8, s20
ds_read_b128 a[120:123], v1 offset:14336
v_accvgpr_read_b32 v117, a189
v_mfma_f32_16x16x32_bf16 v[156:159], a[92:95], v[124:127], v[156:159]
s_mul_i32 s8, s8, 14336
ds_read_b128 a[124:127], v1 offset:15360
v_accvgpr_read_b32 v118, a190
v_mfma_f32_16x16x32_bf16 v[164:167], a[96:99], v[120:123], v[164:167]
s_add_u32 s8, s8, 104857600
ds_read_b128 a[64:67], v1 offset:16384
v_accvgpr_read_b32 v119, a191
v_mfma_f32_16x16x32_bf16 v[164:167], a[100:103], v[124:127], v[164:167]
s_waitcnt lgkmcnt(6)
s_add_u32 s12, s8, 917504
ds_read_b128 a[68:71], v1 offset:17408
v_mfma_f32_16x16x32_bf16 v[172:175], a[104:107], v[120:123], v[172:175]
s_waitcnt lgkmcnt(6)
ds_read_b128 a[72:75], v1 offset:18432
v_mfma_f32_16x16x32_bf16 v[172:175], a[108:111], v[124:127], v[172:175]
s_waitcnt lgkmcnt(6)
ds_read_b128 a[76:79], v1 offset:19456
v_mfma_f32_16x16x32_bf16 v[180:183], a[112:115], v[120:123], v[180:183]
s_waitcnt lgkmcnt(6)
ds_read_b128 a[80:83], v1 offset:20480
v_mfma_f32_16x16x32_bf16 v[180:183], a[116:119], v[124:127], v[180:183]
s_waitcnt lgkmcnt(6)
ds_read_b128 a[84:87], v1 offset:21504
v_mfma_f32_16x16x32_bf16 v[188:191], a[120:123], v[120:123], v[188:191]
s_waitcnt lgkmcnt(6)
ds_read_b128 a[88:91], v1 offset:22528
v_mfma_f32_16x16x32_bf16 v[188:191], a[124:127], v[124:127], v[188:191]
s_waitcnt lgkmcnt(6)
ds_read_b128 a[92:95], v1 offset:23552
v_mfma_f32_16x16x32_bf16 v[196:199], a[64:67], v[120:123], v[196:199]
s_waitcnt lgkmcnt(6)
ds_read_b128 a[96:99], v1 offset:24576
v_mfma_f32_16x16x32_bf16 v[196:199], a[68:71], v[124:127], v[196:199]
s_waitcnt lgkmcnt(6)
ds_read_b128 a[100:103], v1 offset:25600
v_mfma_f32_16x16x32_bf16 v[204:207], a[72:75], v[120:123], v[204:207]
s_waitcnt lgkmcnt(6)
ds_read_b128 a[104:107], v1 offset:26624
v_mfma_f32_16x16x32_bf16 v[204:207], a[76:79], v[124:127], v[204:207]
s_waitcnt lgkmcnt(6)
ds_read_b128 a[108:111], v1 offset:27648
v_mfma_f32_16x16x32_bf16 v[212:215], a[80:83], v[120:123], v[212:215]
s_waitcnt lgkmcnt(6)
ds_read_b128 a[112:115], v1 offset:28672
v_mfma_f32_16x16x32_bf16 v[212:215], a[84:87], v[124:127], v[212:215]
s_waitcnt lgkmcnt(6)
ds_read_b128 a[116:119], v1 offset:29696
v_mfma_f32_16x16x32_bf16 v[220:223], a[88:91], v[120:123], v[220:223]
s_waitcnt lgkmcnt(6)
s_add_u32 m0, s18, 32768
ds_read_b128 a[120:123], v1 offset:30720
v_mfma_f32_16x16x32_bf16 v[220:223], a[92:95], v[124:127], v[220:223]
s_waitcnt lgkmcnt(6)
ds_read_b128 a[124:127], v1 offset:31744
v_mfma_f32_16x16x32_bf16 v[228:231], a[96:99], v[120:123], v[228:231]
s_waitcnt lgkmcnt(6)
buffer_load_dwordx4 v112, s[36:39], s81 offen offset:0 lds
v_mfma_f32_16x16x32_bf16 v[228:231], a[100:103], v[124:127], v[228:231]
s_waitcnt lgkmcnt(5)
buffer_load_dwordx4 v113, s[36:39], s81 offen offset:1024 lds
v_mfma_f32_16x16x32_bf16 v[236:239], a[104:107], v[120:123], v[236:239]
s_waitcnt lgkmcnt(4)
buffer_load_dwordx4 v114, s[36:39], s81 offen offset:2048 lds
v_mfma_f32_16x16x32_bf16 v[236:239], a[108:111], v[124:127], v[236:239]
s_waitcnt lgkmcnt(3)
buffer_load_dwordx4 v115, s[36:39], s81 offen offset:3072 lds
v_mfma_f32_16x16x32_bf16 v[244:247], a[112:115], v[120:123], v[244:247]
s_waitcnt lgkmcnt(2)
s_add_u32 s81, s81, 28672
v_mfma_f32_16x16x32_bf16 v[244:247], a[116:119], v[124:127], v[244:247]
s_waitcnt lgkmcnt(1)
s_add_u32 m0, s18, 36864
v_mfma_f32_16x16x32_bf16 v[252:255], a[120:123], v[120:123], v[252:255]
s_waitcnt lgkmcnt(0)
buffer_load_dwordx4 v112, s[36:39], s81 offen offset:0 lds
v_mfma_f32_16x16x32_bf16 v[252:255], a[124:127], v[124:127], v[252:255]
buffer_load_dwordx4 v113, s[36:39], s81 offen offset:1024 lds
buffer_load_dwordx4 v114, s[36:39], s81 offen offset:2048 lds
buffer_load_dwordx4 v115, s[36:39], s81 offen offset:3072 lds
s_sub_u32 s81, s81, 28544
s_waitcnt vmcnt(8)
v_sub_f32 v8, v16, v28
v_sub_f32 v10, v20, v30
v_max_f32 v9, v8, v10
v_cmp_lt_f32 vcc, 1114636288, v9
s_cbranch_vccnz K2_cfix
K2_cok:
v_exp_f32 v8, v8
v_exp_f32 v10, v10
s_nop 0
v_mov_b32 v9, v8
v_mov_b32 v11, v10
v_fmac_f32 v24, v8, v29
v_fmac_f32 v25, v10, v31
s_mov_b32 s23, 0xffff0000
v_lshlrev_b32 v64, 16, v32
v_and_b32 v65, s23, v32
v_lshlrev_b32 v66, 16, v33
v_and_b32 v67, s23, v33
v_lshlrev_b32 v68, 16, v34
v_and_b32 v69, s23, v34
v_lshlrev_b32 v70, 16, v35
v_and_b32 v71, s23, v35
v_pk_fma_f32 v[128:129], v[64:65], v[8:9], v[128:129]
v_pk_fma_f32 v[130:131], v[66:67], v[8:9], v[130:131]
v_pk_fma_f32 v[136:137], v[68:69], v[8:9], v[136:137]
v_pk_fma_f32 v[138:139], v[70:71], v[8:9], v[138:139]
v_cvt_pk_bf16_f32 v128, v128, v129
v_cvt_pk_bf16_f32 v129, v130, v131
v_cvt_pk_bf16_f32 v130, v136, v137
v_cvt_pk_bf16_f32 v131, v138, v139
s_add_u32 m0, s18, 98304
s_nop 0
buffer_load_dwordx4 v112, s[36:39], s81 offen offset:0 lds
v_lshlrev_b32 v64, 16, v36
v_and_b32 v65, s23, v36
v_lshlrev_b32 v66, 16, v37
v_and_b32 v67, s23, v37
v_lshlrev_b32 v68, 16, v38
v_and_b32 v69, s23, v38
v_lshlrev_b32 v70, 16, v39
v_and_b32 v71, s23, v39
v_pk_fma_f32 v[144:145], v[64:65], v[8:9], v[144:145]
v_pk_fma_f32 v[146:147], v[66:67], v[8:9], v[146:147]
v_pk_fma_f32 v[152:153], v[68:69], v[8:9], v[152:153]
v_pk_fma_f32 v[154:155], v[70:71], v[8:9], v[154:155]
v_cvt_pk_bf16_f32 v144, v144, v145
v_cvt_pk_bf16_f32 v145, v146, v147
v_cvt_pk_bf16_f32 v146, v152, v153
v_cvt_pk_bf16_f32 v147, v154, v155
buffer_load_dwordx4 v113, s[36:39], s81 offen offset:1024 lds
v_lshlrev_b32 v64, 16, v40
v_and_b32 v65, s23, v40
v_lshlrev_b32 v66, 16, v41
v_and_b32 v67, s23, v41
v_lshlrev_b32 v68, 16, v42
v_and_b32 v69, s23, v42
v_lshlrev_b32 v70, 16, v43
v_and_b32 v71, s23, v43
v_pk_fma_f32 v[160:161], v[64:65], v[8:9], v[160:161]
v_pk_fma_f32 v[162:163], v[66:67], v[8:9], v[162:163]
v_pk_fma_f32 v[168:169], v[68:69], v[8:9], v[168:169]
v_pk_fma_f32 v[170:171], v[70:71], v[8:9], v[170:171]
v_cvt_pk_bf16_f32 v160, v160, v161
v_cvt_pk_bf16_f32 v161, v162, v163
v_cvt_pk_bf16_f32 v162, v168, v169
v_cvt_pk_bf16_f32 v163, v170, v171
buffer_load_dwordx4 v114, s[36:39], s81 offen offset:2048 lds
v_lshlrev_b32 v64, 16, v44
v_and_b32 v65, s23, v44
v_lshlrev_b32 v66, 16, v45
v_and_b32 v67, s23, v45
v_lshlrev_b32 v68, 16, v46
v_and_b32 v69, s23, v46
v_lshlrev_b32 v70, 16, v47
v_and_b32 v71, s23, v47
v_pk_fma_f32 v[176:177], v[64:65], v[8:9], v[176:177]
v_pk_fma_f32 v[178:179], v[66:67], v[8:9], v[178:179]
v_pk_fma_f32 v[184:185], v[68:69], v[8:9], v[184:185]
v_pk_fma_f32 v[186:187], v[70:71], v[8:9], v[186:187]
v_cvt_pk_bf16_f32 v176, v176, v177
v_cvt_pk_bf16_f32 v177, v178, v179
v_cvt_pk_bf16_f32 v178, v184, v185
v_cvt_pk_bf16_f32 v179, v186, v187
buffer_load_dwordx4 v115, s[36:39], s81 offen offset:3072 lds
v_lshlrev_b32 v64, 16, v48
v_and_b32 v65, s23, v48
v_lshlrev_b32 v66, 16, v49
v_and_b32 v67, s23, v49
v_lshlrev_b32 v68, 16, v50
v_and_b32 v69, s23, v50
v_lshlrev_b32 v70, 16, v51
v_and_b32 v71, s23, v51
v_pk_fma_f32 v[192:193], v[64:65], v[8:9], v[192:193]
v_pk_fma_f32 v[194:195], v[66:67], v[8:9], v[194:195]
v_pk_fma_f32 v[200:201], v[68:69], v[8:9], v[200:201]
v_pk_fma_f32 v[202:203], v[70:71], v[8:9], v[202:203]
v_cvt_pk_bf16_f32 v192, v192, v193
v_cvt_pk_bf16_f32 v193, v194, v195
v_cvt_pk_bf16_f32 v194, v200, v201
v_cvt_pk_bf16_f32 v195, v202, v203
s_add_u32 s81, s81, 28672
s_add_u32 m0, s18, 102400
s_nop 0
buffer_load_dwordx4 v112, s[36:39], s81 offen offset:0 lds
v_lshlrev_b32 v64, 16, v52
v_and_b32 v65, s23, v52
v_lshlrev_b32 v66, 16, v53
v_and_b32 v67, s23, v53
v_lshlrev_b32 v68, 16, v54
v_and_b32 v69, s23, v54
v_lshlrev_b32 v70, 16, v55
v_and_b32 v71, s23, v55
v_pk_fma_f32 v[208:209], v[64:65], v[8:9], v[208:209]
v_pk_fma_f32 v[210:211], v[66:67], v[8:9], v[210:211]
v_pk_fma_f32 v[216:217], v[68:69], v[8:9], v[216:217]
v_pk_fma_f32 v[218:219], v[70:71], v[8:9], v[218:219]
v_cvt_pk_bf16_f32 v208, v208, v209
v_cvt_pk_bf16_f32 v209, v210, v211
v_cvt_pk_bf16_f32 v210, v216, v217
v_cvt_pk_bf16_f32 v211, v218, v219
buffer_load_dwordx4 v113, s[36:39], s81 offen offset:1024 lds
v_lshlrev_b32 v64, 16, v56
v_and_b32 v65, s23, v56
v_lshlrev_b32 v66, 16, v57
v_and_b32 v67, s23, v57
v_lshlrev_b32 v68, 16, v58
v_and_b32 v69, s23, v58
v_lshlrev_b32 v70, 16, v59
v_and_b32 v71, s23, v59
v_pk_fma_f32 v[224:225], v[64:65], v[8:9], v[224:225]
v_pk_fma_f32 v[226:227], v[66:67], v[8:9], v[226:227]
v_pk_fma_f32 v[232:233], v[68:69], v[8:9], v[232:233]
v_pk_fma_f32 v[234:235], v[70:71], v[8:9], v[234:235]
v_cvt_pk_bf16_f32 v224, v224, v225
v_cvt_pk_bf16_f32 v225, v226, v227
v_cvt_pk_bf16_f32 v226, v232, v233
v_cvt_pk_bf16_f32 v227, v234, v235
buffer_load_dwordx4 v114, s[36:39], s81 offen offset:2048 lds
v_lshlrev_b32 v64, 16, v60
v_and_b32 v65, s23, v60
v_lshlrev_b32 v66, 16, v61
v_and_b32 v67, s23, v61
v_lshlrev_b32 v68, 16, v62
v_and_b32 v69, s23, v62
v_lshlrev_b32 v70, 16, v63
v_and_b32 v71, s23, v63
v_pk_fma_f32 v[240:241], v[64:65], v[8:9], v[240:241]
v_pk_fma_f32 v[242:243], v[66:67], v[8:9], v[242:243]
v_pk_fma_f32 v[248:249], v[68:69], v[8:9], v[248:249]
v_pk_fma_f32 v[250:251], v[70:71], v[8:9], v[250:251]
v_cvt_pk_bf16_f32 v240, v240, v241
v_cvt_pk_bf16_f32 v241, v242, v243
v_cvt_pk_bf16_f32 v242, v248, v249
v_cvt_pk_bf16_f32 v243, v250, v251
buffer_load_dwordx4 v115, s[36:39], s81 offen offset:3072 lds
v_accvgpr_read_b32 v32, a32
v_accvgpr_read_b32 v33, a33
v_accvgpr_read_b32 v34, a34
v_accvgpr_read_b32 v35, a35
v_lshlrev_b32 v64, 16, v32
v_and_b32 v65, s23, v32
v_lshlrev_b32 v66, 16, v33
v_and_b32 v67, s23, v33
v_lshlrev_b32 v68, 16, v34
v_and_b32 v69, s23, v34
v_lshlrev_b32 v70, 16, v35
v_and_b32 v71, s23, v35
v_pk_fma_f32 v[132:133], v[64:65], v[10:11], v[132:133]
v_pk_fma_f32 v[134:135], v[66:67], v[10:11], v[134:135]
v_pk_fma_f32 v[140:141], v[68:69], v[10:11], v[140:141]
v_pk_fma_f32 v[142:143], v[70:71], v[10:11], v[142:143]
v_cvt_pk_bf16_f32 v132, v132, v133
v_cvt_pk_bf16_f32 v133, v134, v135
v_cvt_pk_bf16_f32 v134, v140, v141
v_cvt_pk_bf16_f32 v135, v142, v143
s_sub_u32 s81, s81, 28544
s_add_u32 m0, s18, 131072
s_nop 0
buffer_load_dwordx4 v112, s[36:39], s81 offen offset:0 lds
v_accvgpr_read_b32 v36, a36
v_accvgpr_read_b32 v37, a37
v_accvgpr_read_b32 v38, a38
v_accvgpr_read_b32 v39, a39
v_lshlrev_b32 v64, 16, v36
v_and_b32 v65, s23, v36
v_lshlrev_b32 v66, 16, v37
v_and_b32 v67, s23, v37
v_lshlrev_b32 v68, 16, v38
v_and_b32 v69, s23, v38
v_lshlrev_b32 v70, 16, v39
v_and_b32 v71, s23, v39
v_pk_fma_f32 v[148:149], v[64:65], v[10:11], v[148:149]
v_pk_fma_f32 v[150:151], v[66:67], v[10:11], v[150:151]
v_pk_fma_f32 v[156:157], v[68:69], v[10:11], v[156:157]
v_pk_fma_f32 v[158:159], v[70:71], v[10:11], v[158:159]
v_cvt_pk_bf16_f32 v148, v148, v149
v_cvt_pk_bf16_f32 v149, v150, v151
v_cvt_pk_bf16_f32 v150, v156, v157
v_cvt_pk_bf16_f32 v151, v158, v159
buffer_load_dwordx4 v113, s[36:39], s81 offen offset:1024 lds
v_accvgpr_read_b32 v40, a40
v_accvgpr_read_b32 v41, a41
v_accvgpr_read_b32 v42, a42
v_accvgpr_read_b32 v43, a43
v_lshlrev_b32 v64, 16, v40
v_and_b32 v65, s23, v40
v_lshlrev_b32 v66, 16, v41
v_and_b32 v67, s23, v41
v_lshlrev_b32 v68, 16, v42
v_and_b32 v69, s23, v42
v_lshlrev_b32 v70, 16, v43
v_and_b32 v71, s23, v43
v_pk_fma_f32 v[164:165], v[64:65], v[10:11], v[164:165]
v_pk_fma_f32 v[166:167], v[66:67], v[10:11], v[166:167]
v_pk_fma_f32 v[172:173], v[68:69], v[10:11], v[172:173]
v_pk_fma_f32 v[174:175], v[70:71], v[10:11], v[174:175]
v_cvt_pk_bf16_f32 v164, v164, v165
v_cvt_pk_bf16_f32 v165, v166, v167
v_cvt_pk_bf16_f32 v166, v172, v173
v_cvt_pk_bf16_f32 v167, v174, v175
buffer_load_dwordx4 v114, s[36:39], s81 offen offset:2048 lds
v_accvgpr_read_b32 v44, a44
v_accvgpr_read_b32 v45, a45
v_accvgpr_read_b32 v46, a46
v_accvgpr_read_b32 v47, a47
v_lshlrev_b32 v64, 16, v44
v_and_b32 v65, s23, v44
v_lshlrev_b32 v66, 16, v45
v_and_b32 v67, s23, v45
v_lshlrev_b32 v68, 16, v46
v_and_b32 v69, s23, v46
v_lshlrev_b32 v70, 16, v47
v_and_b32 v71, s23, v47
v_pk_fma_f32 v[180:181], v[64:65], v[10:11], v[180:181]
v_pk_fma_f32 v[182:183], v[66:67], v[10:11], v[182:183]
v_pk_fma_f32 v[188:189], v[68:69], v[10:11], v[188:189]
v_pk_fma_f32 v[190:191], v[70:71], v[10:11], v[190:191]
v_cvt_pk_bf16_f32 v180, v180, v181
v_cvt_pk_bf16_f32 v181, v182, v183
v_cvt_pk_bf16_f32 v182, v188, v189
v_cvt_pk_bf16_f32 v183, v190, v191
buffer_load_dwordx4 v115, s[36:39], s81 offen offset:3072 lds
v_accvgpr_read_b32 v48, a48
v_accvgpr_read_b32 v49, a49
v_accvgpr_read_b32 v50, a50
v_accvgpr_read_b32 v51, a51
v_lshlrev_b32 v64, 16, v48
v_and_b32 v65, s23, v48
v_lshlrev_b32 v66, 16, v49
v_and_b32 v67, s23, v49
v_lshlrev_b32 v68, 16, v50
v_and_b32 v69, s23, v50
v_lshlrev_b32 v70, 16, v51
v_and_b32 v71, s23, v51
v_pk_fma_f32 v[196:197], v[64:65], v[10:11], v[196:197]
v_pk_fma_f32 v[198:199], v[66:67], v[10:11], v[198:199]
v_pk_fma_f32 v[204:205], v[68:69], v[10:11], v[204:205]
v_pk_fma_f32 v[206:207], v[70:71], v[10:11], v[206:207]
v_cvt_pk_bf16_f32 v196, v196, v197
v_cvt_pk_bf16_f32 v197, v198, v199
v_cvt_pk_bf16_f32 v198, v204, v205
v_cvt_pk_bf16_f32 v199, v206, v207
s_add_u32 s81, s81, 28672
s_add_u32 m0, s18, 135168
s_nop 0
buffer_load_dwordx4 v112, s[36:39], s81 offen offset:0 lds
v_accvgpr_read_b32 v52, a52
v_accvgpr_read_b32 v53, a53
v_accvgpr_read_b32 v54, a54
v_accvgpr_read_b32 v55, a55
v_lshlrev_b32 v64, 16, v52
v_and_b32 v65, s23, v52
v_lshlrev_b32 v66, 16, v53
v_and_b32 v67, s23, v53
v_lshlrev_b32 v68, 16, v54
v_and_b32 v69, s23, v54
v_lshlrev_b32 v70, 16, v55
v_and_b32 v71, s23, v55
v_pk_fma_f32 v[212:213], v[64:65], v[10:11], v[212:213]
v_pk_fma_f32 v[214:215], v[66:67], v[10:11], v[214:215]
v_pk_fma_f32 v[220:221], v[68:69], v[10:11], v[220:221]
v_pk_fma_f32 v[222:223], v[70:71], v[10:11], v[222:223]
v_cvt_pk_bf16_f32 v212, v212, v213
v_cvt_pk_bf16_f32 v213, v214, v215
v_cvt_pk_bf16_f32 v214, v220, v221
v_cvt_pk_bf16_f32 v215, v222, v223
buffer_load_dwordx4 v113, s[36:39], s81 offen offset:1024 lds
v_accvgpr_read_b32 v56, a56
v_accvgpr_read_b32 v57, a57
v_accvgpr_read_b32 v58, a58
v_accvgpr_read_b32 v59, a59
v_lshlrev_b32 v64, 16, v56
v_and_b32 v65, s23, v56
v_lshlrev_b32 v66, 16, v57
v_and_b32 v67, s23, v57
v_lshlrev_b32 v68, 16, v58
v_and_b32 v69, s23, v58
v_lshlrev_b32 v70, 16, v59
v_and_b32 v71, s23, v59
v_pk_fma_f32 v[228:229], v[64:65], v[10:11], v[228:229]
v_pk_fma_f32 v[230:231], v[66:67], v[10:11], v[230:231]
v_pk_fma_f32 v[236:237], v[68:69], v[10:11], v[236:237]
v_pk_fma_f32 v[238:239], v[70:71], v[10:11], v[238:239]
v_cvt_pk_bf16_f32 v228, v228, v229
v_cvt_pk_bf16_f32 v229, v230, v231
v_cvt_pk_bf16_f32 v230, v236, v237
v_cvt_pk_bf16_f32 v231, v238, v239
buffer_load_dwordx4 v114, s[36:39], s81 offen offset:2048 lds
v_accvgpr_read_b32 v60, a60
v_accvgpr_read_b32 v61, a61
v_accvgpr_read_b32 v62, a62
v_accvgpr_read_b32 v63, a63
v_lshlrev_b32 v64, 16, v60
v_and_b32 v65, s23, v60
v_lshlrev_b32 v66, 16, v61
v_and_b32 v67, s23, v61
v_lshlrev_b32 v68, 16, v62
v_and_b32 v69, s23, v62
v_lshlrev_b32 v70, 16, v63
v_and_b32 v71, s23, v63
v_pk_fma_f32 v[244:245], v[64:65], v[10:11], v[244:245]
v_pk_fma_f32 v[246:247], v[66:67], v[10:11], v[246:247]
v_pk_fma_f32 v[252:253], v[68:69], v[10:11], v[252:253]
v_pk_fma_f32 v[254:255], v[70:71], v[10:11], v[254:255]
v_cvt_pk_bf16_f32 v244, v244, v245
v_cvt_pk_bf16_f32 v245, v246, v247
v_cvt_pk_bf16_f32 v246, v252, v253
v_cvt_pk_bf16_f32 v247, v254, v255
buffer_load_dwordx4 v115, s[36:39], s81 offen offset:3072 lds
s_sub_u32 s81, s81, 28544
K2_done:
PAD_13:
s_cbranch_execz PAD_17
s_waitcnt vmcnt(16)
s_barrier
ds_read_b64_tr_b16 a[64:65], v116 offset:0
ds_read_b64_tr_b16 a[66:67], v116 offset:2048
ds_read_b64_tr_b16 a[68:69], v116 offset:4096
ds_read_b64_tr_b16 a[70:71], v116 offset:6144
ds_read_b64_tr_b16 a[72:73], v116 offset:8192
ds_read_b64_tr_b16 a[74:75], v116 offset:10240
ds_read_b64_tr_b16 a[76:77], v116 offset:12288
ds_read_b64_tr_b16 a[78:79], v116 offset:14336
ds_read_b64_tr_b16 a[80:81], v116 offset:16384
ds_read_b64_tr_b16 a[82:83], v116 offset:18432
ds_read_b64_tr_b16 a[84:85], v116 offset:20480
ds_read_b64_tr_b16 a[86:87], v116 offset:22528
ds_read_b64_tr_b16 a[88:89], v116 offset:24576
ds_read_b64_tr_b16 a[90:91], v116 offset:26624
ds_read_b64_tr_b16 a[92:93], v116 offset:28672
ds_read_b64_tr_b16 a[94:95], v116 offset:30720
v_add_u32 v116, 65536, v116
s_waitcnt lgkmcnt(14)
v_mfma_f32_16x16x32_bf16 v[32:35], a[64:67], v[128:131], 0
s_waitcnt lgkmcnt(12)
s_add_u32 m0, s18, 65536
ds_read_b64_tr_b16 a[96:97], v117 offset:0
v_mov_b32 v28, v24
v_mfma_f32_16x16x32_bf16 v[32:35], a[68:71], v[144:147], v[32:35]
s_waitcnt lgkmcnt(11)
ds_read_b64_tr_b16 a[98:99], v117 offset:2048
buffer_load_dwordx4 v112, s[36:39], s81 offen offset:0 lds
v_mfma_f32_16x16x32_bf16 v[32:35], a[72:75], v[160:163], v[32:35]
s_waitcnt lgkmcnt(10)
ds_read_b64_tr_b16 a[100:101], v117 offset:4096
v_permlane16_swap_b32 v24, v28
v_mfma_f32_16x16x32_bf16 v[32:35], a[76:79], v[176:179], v[32:35]
s_waitcnt lgkmcnt(9)
ds_read_b64_tr_b16 a[102:103], v117 offset:6144
v_add_f32 v24, v24, v28
v_mfma_f32_16x16x32_bf16 v[32:35], a[80:83], v[192:195], v[32:35]
s_waitcnt lgkmcnt(8)
ds_read_b64_tr_b16 a[104:105], v117 offset:8192
buffer_load_dwordx4 v113, s[36:39], s81 offen offset:1024 lds
v_mfma_f32_16x16x32_bf16 v[32:35], a[84:87], v[208:211], v[32:35]
s_waitcnt lgkmcnt(7)
ds_read_b64_tr_b16 a[106:107], v117 offset:10240
v_mov_b32 v28, v24
v_mfma_f32_16x16x32_bf16 v[32:35], a[88:91], v[224:227], v[32:35]
s_waitcnt lgkmcnt(6)
ds_read_b64_tr_b16 a[108:109], v117 offset:12288
v_lshrrev_b32 v20, 4, v1
v_mfma_f32_16x16x32_bf16 v[32:35], a[92:95], v[240:243], v[32:35]
ds_read_b64_tr_b16 a[110:111], v117 offset:14336
buffer_load_dwordx4 v114, s[36:39], s81 offen offset:2048 lds
v_mfma_f32_16x16x32_bf16 v[36:39], a[64:67], v[132:135], 0
ds_read_b64_tr_b16 a[112:113], v117 offset:16384
v_permlane32_swap_b32 v24, v28
v_mfma_f32_16x16x32_bf16 v[36:39], a[68:71], v[148:151], v[36:39]
ds_read_b64_tr_b16 a[114:115], v117 offset:18432
v_add_f32 v24, v24, v28
v_mfma_f32_16x16x32_bf16 v[36:39], a[72:75], v[164:167], v[36:39]
ds_read_b64_tr_b16 a[116:117], v117 offset:20480
buffer_load_dwordx4 v115, s[36:39], s81 offen offset:3072 lds
v_mfma_f32_16x16x32_bf16 v[36:39], a[76:79], v[180:183], v[36:39]
PAD_14:
s_cbranch_execz PAD_18
ds_read_b64_tr_b16 a[118:119], v117 offset:22528
v_mov_b32 v29, v25
v_mfma_f32_16x16x32_bf16 v[36:39], a[80:83], v[196:199], v[36:39]
s_add_u32 s81, s81, 28672
s_add_u32 m0, s18, 69632
ds_read_b64_tr_b16 a[120:121], v117 offset:24576
v_mfma_f32_16x16x32_bf16 v[36:39], a[84:87], v[212:215], v[36:39]
ds_read_b64_tr_b16 a[122:123], v117 offset:26624
buffer_load_dwordx4 v112, s[36:39], s81 offen offset:0 lds
v_mfma_f32_16x16x32_bf16 v[36:39], a[88:91], v[228:231], v[36:39]
ds_read_b64_tr_b16 a[124:125], v117 offset:28672
v_permlane16_swap_b32 v25, v29
v_mfma_f32_16x16x32_bf16 v[36:39], a[92:95], v[244:247], v[36:39]
s_waitcnt lgkmcnt(8)
ds_read_b64_tr_b16 a[126:127], v117 offset:30720
v_add_u32 v117, 65536, v117
v_mfma_f32_16x16x32_bf16 v[40:43], a[96:99], v[128:131], 0
ds_read_b64_tr_b16 a[64:65], v118 offset:0
buffer_load_dwordx4 v113, s[36:39], s81 offen offset:1024 lds
v_mfma_f32_16x16x32_bf16 v[40:43], a[100:103], v[144:147], v[40:43]
ds_read_b64_tr_b16 a[66:67], v118 offset:2048
v_add_f32 v25, v25, v29
v_mfma_f32_16x16x32_bf16 v[40:43], a[104:107], v[160:163], v[40:43]
s_waitcnt lgkmcnt(8)
ds_read_b64_tr_b16 a[68:69], v118 offset:4096
v_mov_b32 v29, v25
v_mfma_f32_16x16x32_bf16 v[40:43], a[108:111], v[176:179], v[40:43]
ds_read_b64_tr_b16 a[70:71], v118 offset:6144
buffer_load_dwordx4 v114, s[36:39], s81 offen offset:2048 lds
v_mfma_f32_16x16x32_bf16 v[40:43], a[112:115], v[192:195], v[40:43]
s_waitcnt lgkmcnt(8)
ds_read_b64_tr_b16 a[72:73], v118 offset:8192
v_permlane32_swap_b32 v25, v29
v_mfma_f32_16x16x32_bf16 v[40:43], a[116:119], v[208:211], v[40:43]
s_waitcnt lgkmcnt(7)
ds_read_b64_tr_b16 a[74:75], v118 offset:10240
v_add_f32 v25, v25, v29
v_mfma_f32_16x16x32_bf16 v[40:43], a[120:123], v[224:227], v[40:43]
s_waitcnt lgkmcnt(6)
ds_read_b64_tr_b16 a[76:77], v118 offset:12288
buffer_load_dwordx4 v115, s[36:39], s81 offen offset:3072 lds
v_mfma_f32_16x16x32_bf16 v[40:43], a[124:127], v[240:243], v[40:43]
ds_read_b64_tr_b16 a[78:79], v118 offset:14336
v_rcp_f32 v24, v24
v_mfma_f32_16x16x32_bf16 v[44:47], a[96:99], v[132:135], 0
s_sub_u32 s81, s81, 28544
s_add_u32 m0, s18, 0
ds_read_b64_tr_b16 a[80:81], v118 offset:16384
v_mfma_f32_16x16x32_bf16 v[44:47], a[100:103], v[148:151], v[44:47]
ds_read_b64_tr_b16 a[82:83], v118 offset:18432
buffer_load_dwordx4 v112, s[36:39], s81 offen offset:0 lds
v_mfma_f32_16x16x32_bf16 v[44:47], a[104:107], v[164:167], v[44:47]
ds_read_b64_tr_b16 a[84:85], v118 offset:20480
v_rcp_f32 v25, v25
v_mfma_f32_16x16x32_bf16 v[44:47], a[108:111], v[180:183], v[44:47]
ds_read_b64_tr_b16 a[86:87], v118 offset:22528
v_and_b32 v19, 15, v20
v_mfma_f32_16x16x32_bf16 v[44:47], a[112:115], v[196:199], v[44:47]
ds_read_b64_tr_b16 a[88:89], v118 offset:24576
buffer_load_dwordx4 v113, s[36:39], s81 offen offset:1024 lds
v_mfma_f32_16x16x32_bf16 v[44:47], a[116:119], v[212:215], v[44:47]
ds_read_b64_tr_b16 a[90:91], v118 offset:26624
v_mul_f32 v32, v32, v24
v_mfma_f32_16x16x32_bf16 v[44:47], a[120:123], v[228:231], v[44:47]
ds_read_b64_tr_b16 a[92:93], v118 offset:28672
v_mul_f32 v33, v33, v24
v_mfma_f32_16x16x32_bf16 v[44:47], a[124:127], v[244:247], v[44:47]
s_waitcnt lgkmcnt(8)
ds_read_b64_tr_b16 a[94:95], v118 offset:30720
v_add_u32 v118, 65536, v118
v_mfma_f32_16x16x32_bf16 v[48:51], a[64:67], v[128:131], 0
ds_read_b64_tr_b16 a[96:97], v119 offset:0
buffer_load_dwordx4 v114, s[36:39], s81 offen offset:2048 lds
v_mfma_f32_16x16x32_bf16 v[48:51], a[68:71], v[144:147], v[48:51]
ds_read_b64_tr_b16 a[98:99], v119 offset:2048
v_mul_f32 v34, v34, v24
v_mfma_f32_16x16x32_bf16 v[48:51], a[72:75], v[160:163], v[48:51]
s_waitcnt lgkmcnt(8)
ds_read_b64_tr_b16 a[100:101], v119 offset:4096
v_mul_f32 v35, v35, v24
v_mfma_f32_16x16x32_bf16 v[48:51], a[76:79], v[176:179], v[48:51]
ds_read_b64_tr_b16 a[102:103], v119 offset:6144
buffer_load_dwordx4 v115, s[36:39], s81 offen offset:3072 lds
v_mfma_f32_16x16x32_bf16 v[48:51], a[80:83], v[192:195], v[48:51]
s_waitcnt lgkmcnt(6)
ds_read_b64_tr_b16 a[104:105], v119 offset:8192
v_mul_f32 v40, v40, v24
v_mfma_f32_16x16x32_bf16 v[48:51], a[84:87], v[208:211], v[48:51]
s_add_u32 s81, s81, 28672
s_add_u32 m0, s18, 4096
ds_read_b64_tr_b16 a[106:107], v119 offset:10240
v_mfma_f32_16x16x32_bf16 v[48:51], a[88:91], v[224:227], v[48:51]
s_waitcnt lgkmcnt(6)
ds_read_b64_tr_b16 a[108:109], v119 offset:12288
buffer_load_dwordx4 v112, s[36:39], s81 offen offset:0 lds
v_mfma_f32_16x16x32_bf16 v[48:51], a[92:95], v[240:243], v[48:51]
ds_read_b64_tr_b16 a[110:111], v119 offset:14336
v_mul_f32 v41, v41, v24
v_mfma_f32_16x16x32_bf16 v[52:55], a[64:67], v[132:135], 0
ds_read_b64_tr_b16 a[112:113], v119 offset:16384
v_mul_f32 v42, v42, v24
v_mfma_f32_16x16x32_bf16 v[52:55], a[68:71], v[148:151], v[52:55]
ds_read_b64_tr_b16 a[114:115], v119 offset:18432
buffer_load_dwordx4 v113, s[36:39], s81 offen offset:1024 lds
v_mfma_f32_16x16x32_bf16 v[52:55], a[72:75], v[164:167], v[52:55]
ds_read_b64_tr_b16 a[116:117], v119 offset:20480
v_mul_f32 v43, v43, v24
v_mfma_f32_16x16x32_bf16 v[52:55], a[76:79], v[180:183], v[52:55]
ds_read_b64_tr_b16 a[118:119], v119 offset:22528
v_cvt_pk_bf16_f32 v32, v32, v33
v_mfma_f32_16x16x32_bf16 v[52:55], a[80:83], v[196:199], v[52:55]
ds_read_b64_tr_b16 a[120:121], v119 offset:24576
buffer_load_dwordx4 v114, s[36:39], s81 offen offset:2048 lds
v_mfma_f32_16x16x32_bf16 v[52:55], a[84:87], v[212:215], v[52:55]
ds_read_b64_tr_b16 a[122:123], v119 offset:26624
v_cvt_pk_bf16_f32 v33, v34, v35
v_mfma_f32_16x16x32_bf16 v[52:55], a[88:91], v[228:231], v[52:55]
ds_read_b64_tr_b16 a[124:125], v119 offset:28672
ds_read_b64_tr_b16 a[126:127], v119 offset:30720
v_mfma_f32_16x16x32_bf16 v[52:55], a[92:95], v[244:247], v[52:55]
s_waitcnt vmcnt(23) lgkmcnt(9)
s_barrier
v_add_u32 v119, 65536, v119
v_mfma_f32_16x16x32_bf16 v[56:59], a[96:99], v[128:131], 0
ds_read_b64_tr_b16 a[64:65], v116 offset:0
buffer_load_dwordx4 v115, s[36:39], s81 offen offset:3072 lds
v_mfma_f32_16x16x32_bf16 v[56:59], a[100:103], v[144:147], v[56:59]
s_waitcnt lgkmcnt(8)
ds_read_b64_tr_b16 a[66:67], v116 offset:2048
v_cvt_pk_bf16_f32 v34, v40, v41
v_mfma_f32_16x16x32_bf16 v[56:59], a[104:107], v[160:163], v[56:59]
s_sub_u32 s81, s81, 28544
ds_read_b64_tr_b16 a[68:69], v116 offset:4096
v_cvt_pk_bf16_f32 v35, v42, v43
v_mfma_f32_16x16x32_bf16 v[56:59], a[108:111], v[176:179], v[56:59]
s_waitcnt lgkmcnt(8)
ds_read_b64_tr_b16 a[70:71], v116 offset:6144
buffer_store_dwordx4 v[32:35], v1, s[4:7], s8 offen offset:0 sc1
v_mfma_f32_16x16x32_bf16 v[56:59], a[112:115], v[192:195], v[56:59]
s_waitcnt lgkmcnt(8)
ds_read_b64_tr_b16 a[72:73], v116 offset:8192
v_mul_f32 v36, v36, v25
v_mfma_f32_16x16x32_bf16 v[56:59], a[116:119], v[208:211], v[56:59]
s_waitcnt lgkmcnt(7)
ds_read_b64_tr_b16 a[74:75], v116 offset:10240
v_mul_f32 v37, v37, v25
v_mfma_f32_16x16x32_bf16 v[56:59], a[120:123], v[224:227], v[56:59]
s_waitcnt lgkmcnt(6)
ds_read_b64_tr_b16 a[76:77], v116 offset:12288
v_mul_f32 v38, v38, v25
v_mfma_f32_16x16x32_bf16 v[56:59], a[124:127], v[240:243], v[56:59]
ds_read_b64_tr_b16 a[78:79], v116 offset:14336
v_mul_f32 v39, v39, v25
v_mfma_f32_16x16x32_bf16 v[60:63], a[96:99], v[132:135], 0
ds_read_b64_tr_b16 a[80:81], v116 offset:16384
v_mul_f32 v44, v44, v25
v_mfma_f32_16x16x32_bf16 v[60:63], a[100:103], v[148:151], v[60:63]
ds_read_b64_tr_b16 a[82:83], v116 offset:18432
v_mul_f32 v45, v45, v25
v_mfma_f32_16x16x32_bf16 v[60:63], a[104:107], v[164:167], v[60:63]
ds_read_b64_tr_b16 a[84:85], v116 offset:20480
v_mul_f32 v46, v46, v25
v_mfma_f32_16x16x32_bf16 v[60:63], a[108:111], v[180:183], v[60:63]
ds_read_b64_tr_b16 a[86:87], v116 offset:22528
v_mul_f32 v47, v47, v25
v_mfma_f32_16x16x32_bf16 v[60:63], a[112:115], v[196:199], v[60:63]
ds_read_b64_tr_b16 a[88:89], v116 offset:24576
v_cvt_pk_bf16_f32 v36, v36, v37
v_mfma_f32_16x16x32_bf16 v[60:63], a[116:119], v[212:215], v[60:63]
ds_read_b64_tr_b16 a[90:91], v116 offset:26624
v_cvt_pk_bf16_f32 v37, v38, v39
v_mfma_f32_16x16x32_bf16 v[60:63], a[120:123], v[228:231], v[60:63]
ds_read_b64_tr_b16 a[92:93], v116 offset:28672
v_cvt_pk_bf16_f32 v38, v44, v45
v_mfma_f32_16x16x32_bf16 v[60:63], a[124:127], v[244:247], v[60:63]
s_waitcnt lgkmcnt(3)
ds_read_b64_tr_b16 a[94:95], v116 offset:30720
v_add_u32 v116, 32768, v116
v_mfma_f32_16x16x32_bf16 v[64:67], a[64:67], v[128:131], 0
s_lshl_b32 s34, s29, 5
ds_read_b64_tr_b16 a[96:97], v117 offset:0
v_cvt_pk_bf16_f32 v39, v46, v47
v_mfma_f32_16x16x32_bf16 v[64:67], a[68:71], v[144:147], v[64:67]
s_add_u32 s34, s34, s20
ds_read_b64_tr_b16 a[98:99], v117 offset:2048
buffer_store_dwordx4 v[36:39], v1, s[4:7], s12 offen offset:0 sc1
v_mfma_f32_16x16x32_bf16 v[64:67], a[72:75], v[160:163], v[64:67]
s_lshl_b32 s34, s34, 2
ds_read_b64_tr_b16 a[100:101], v117 offset:4096
v_mul_f32 v48, v48, v24
v_mfma_f32_16x16x32_bf16 v[64:67], a[76:79], v[176:179], v[64:67]
s_add_u32 s34, s34, 94380032
ds_read_b64_tr_b16 a[102:103], v117 offset:6144
v_mul_f32 v49, v49, v24
v_mfma_f32_16x16x32_bf16 v[64:67], a[80:83], v[192:195], v[64:67]
s_add_u32 s35, s34, 2048
ds_read_b64_tr_b16 a[104:105], v117 offset:8192
v_mul_f32 v50, v50, v24
v_mfma_f32_16x16x32_bf16 v[64:67], a[84:87], v[208:211], v[64:67]
s_waitcnt lgkmcnt(5)
s_mov_b32 s80, s21
ds_read_b64_tr_b16 a[106:107], v117 offset:10240
v_mul_f32 v51, v51, v24
v_mfma_f32_16x16x32_bf16 v[64:67], a[88:91], v[224:227], v[64:67]
s_and_b32 s79, s2, 16
ds_read_b64_tr_b16 a[108:109], v117 offset:12288
v_mul_f32 v56, v56, v24
v_mfma_f32_16x16x32_bf16 v[64:67], a[92:95], v[240:243], v[64:67]
s_xor_b32 s79, s79, 16
ds_read_b64_tr_b16 a[110:111], v117 offset:14336
v_mul_f32 v57, v57, v24
v_mfma_f32_16x16x32_bf16 v[68:71], a[64:67], v[132:135], 0
s_add_u32 s79, s79, s20
ds_read_b64_tr_b16 a[112:113], v117 offset:16384
v_mul_f32 v58, v58, v24
v_mfma_f32_16x16x32_bf16 v[68:71], a[68:71], v[148:151], v[68:71]
s_lshl_b32 s22, s79, 2
ds_read_b64_tr_b16 a[114:115], v117 offset:18432
v_mul_f32 v59, v59, v24
v_mfma_f32_16x16x32_bf16 v[68:71], a[72:75], v[164:167], v[68:71]
s_add_u32 s22, s22, s3
ds_read_b64_tr_b16 a[116:117], v117 offset:20480
v_cvt_pk_bf16_f32 v48, v48, v49
v_mfma_f32_16x16x32_bf16 v[68:71], a[76:79], v[180:183], v[68:71]
s_mul_i32 s25, s22, 28672
ds_read_b64_tr_b16 a[118:119], v117 offset:22528
v_cvt_pk_bf16_f32 v49, v50, v51
v_mfma_f32_16x16x32_bf16 v[68:71], a[80:83], v[196:199], v[68:71]
s_lshl_b32 s23, s80, 6
ds_read_b64_tr_b16 a[120:121], v117 offset:24576
v_cvt_pk_bf16_f32 v50, v56, v57
v_mfma_f32_16x16x32_bf16 v[68:71], a[84:87], v[212:215], v[68:71]
s_add_u32 s25, s25, s23
ds_read_b64_tr_b16 a[122:123], v117 offset:26624
v_cvt_pk_bf16_f32 v51, v58, v59
v_mfma_f32_16x16x32_bf16 v[68:71], a[88:91], v[228:231], v[68:71]
s_mul_i32 s26, s22, 229376
ds_read_b64_tr_b16 a[124:125], v117 offset:28672
buffer_store_dwordx4 v[48:51], v1, s[4:7], s8 offen offset:1024 sc1
v_mfma_f32_16x16x32_bf16 v[68:71], a[92:95], v[244:247], v[68:71]
s_waitcnt lgkmcnt(3)
s_lshl_b32 s23, s80, 10
ds_read_b64_tr_b16 a[126:127], v117 offset:30720
v_add_u32 v117, 32768, v117
v_mfma_f32_16x16x32_bf16 v[72:75], a[96:99], v[128:131], 0
s_add_u32 s26, s26, s23
ds_read_b64_tr_b16 a[64:65], v118 offset:0
v_mul_f32 v52, v52, v25
v_mfma_f32_16x16x32_bf16 v[72:75], a[100:103], v[144:147], v[72:75]
s_add_u32 s26, s26, 104857600
ds_read_b64_tr_b16 a[66:67], v118 offset:2048
v_mul_f32 v53, v53, v25
v_mfma_f32_16x16x32_bf16 v[72:75], a[104:107], v[160:163], v[72:75]
s_lshr_b32 s22, s79, 1
ds_read_b64_tr_b16 a[68:69], v118 offset:4096
v_mul_f32 v54, v54, v25
v_mfma_f32_16x16x32_bf16 v[72:75], a[108:111], v[176:179], v[72:75]
s_lshl_b32 s22, s22, 7
ds_read_b64_tr_b16 a[70:71], v118 offset:6144
v_mul_f32 v55, v55, v25
v_mfma_f32_16x16x32_bf16 v[72:75], a[112:115], v[192:195], v[72:75]
s_add_u32 s33, s22, 94380032
ds_read_b64_tr_b16 a[72:73], v118 offset:8192
v_mul_f32 v60, v60, v25
v_mfma_f32_16x16x32_bf16 v[72:75], a[116:119], v[208:211], v[72:75]
s_waitcnt lgkmcnt(5)
s_mov_b64 s[40:41], s[88:89]
ds_read_b64_tr_b16 a[74:75], v118 offset:10240
v_mul_f32 v61, v61, v25
v_mfma_f32_16x16x32_bf16 v[72:75], a[120:123], v[224:227], v[72:75]
s_mov_b32 s42, 3670016
ds_read_b64_tr_b16 a[76:77], v118 offset:12288
v_mul_f32 v62, v62, v25
v_mfma_f32_16x16x32_bf16 v[72:75], a[124:127], v[240:243], v[72:75]
s_mov_b32 s43, 0x20000
ds_read_b64_tr_b16 a[78:79], v118 offset:14336
v_mul_f32 v63, v63, v25
v_mfma_f32_16x16x32_bf16 v[76:79], a[96:99], v[132:135], 0
ds_read_b64_tr_b16 a[80:81], v118 offset:16384
v_cvt_pk_bf16_f32 v52, v52, v53
v_mfma_f32_16x16x32_bf16 v[76:79], a[100:103], v[148:151], v[76:79]
ds_read_b64_tr_b16 a[82:83], v118 offset:18432
v_cvt_pk_bf16_f32 v53, v54, v55
v_mfma_f32_16x16x32_bf16 v[76:79], a[104:107], v[164:167], v[76:79]
ds_read_b64_tr_b16 a[84:85], v118 offset:20480
v_cvt_pk_bf16_f32 v54, v60, v61
v_mfma_f32_16x16x32_bf16 v[76:79], a[108:111], v[180:183], v[76:79]
ds_read_b64_tr_b16 a[86:87], v118 offset:22528
v_cvt_pk_bf16_f32 v55, v62, v63
v_mfma_f32_16x16x32_bf16 v[76:79], a[112:115], v[196:199], v[76:79]
ds_read_b64_tr_b16 a[88:89], v118 offset:24576
buffer_store_dwordx4 v[52:55], v1, s[4:7], s12 offen offset:1024 sc1
v_mfma_f32_16x16x32_bf16 v[76:79], a[116:119], v[212:215], v[76:79]
ds_read_b64_tr_b16 a[90:91], v118 offset:26624
v_mfma_f32_16x16x32_bf16 v[76:79], a[120:123], v[228:231], v[76:79]
ds_read_b64_tr_b16 a[92:93], v118 offset:28672
v_mul_f32 v64, v64, v24
v_mfma_f32_16x16x32_bf16 v[76:79], a[124:127], v[244:247], v[76:79]
s_waitcnt lgkmcnt(8)
ds_read_b64_tr_b16 a[94:95], v118 offset:30720
v_add_u32 v118, 32768, v118
v_mfma_f32_16x16x32_bf16 v[80:83], a[64:67], v[128:131], 0
ds_read_b64_tr_b16 a[96:97], v119 offset:0
v_mul_f32 v65, v65, v24
v_mfma_f32_16x16x32_bf16 v[80:83], a[68:71], v[144:147], v[80:83]
ds_read_b64_tr_b16 a[98:99], v119 offset:2048
v_mul_f32 v66, v66, v24
v_mfma_f32_16x16x32_bf16 v[80:83], a[72:75], v[160:163], v[80:83]
s_waitcnt lgkmcnt(8)
ds_read_b64_tr_b16 a[100:101], v119 offset:4096
v_mul_f32 v67, v67, v24
v_mfma_f32_16x16x32_bf16 v[80:83], a[76:79], v[176:179], v[80:83]
ds_read_b64_tr_b16 a[102:103], v119 offset:6144
v_mul_f32 v72, v72, v24
v_mfma_f32_16x16x32_bf16 v[80:83], a[80:83], v[192:195], v[80:83]
s_waitcnt lgkmcnt(8)
ds_read_b64_tr_b16 a[104:105], v119 offset:8192
v_mul_f32 v73, v73, v24
v_mfma_f32_16x16x32_bf16 v[80:83], a[84:87], v[208:211], v[80:83]
s_waitcnt lgkmcnt(7)
ds_read_b64_tr_b16 a[106:107], v119 offset:10240
v_mul_f32 v74, v74, v24
v_mfma_f32_16x16x32_bf16 v[80:83], a[88:91], v[224:227], v[80:83]
s_waitcnt lgkmcnt(6)
ds_read_b64_tr_b16 a[108:109], v119 offset:12288
v_mul_f32 v75, v75, v24
v_mfma_f32_16x16x32_bf16 v[80:83], a[92:95], v[240:243], v[80:83]
ds_read_b64_tr_b16 a[110:111], v119 offset:14336
v_cvt_pk_bf16_f32 v64, v64, v65
v_mfma_f32_16x16x32_bf16 v[84:87], a[64:67], v[132:135], 0
ds_read_b64_tr_b16 a[112:113], v119 offset:16384
v_cvt_pk_bf16_f32 v65, v66, v67
v_mfma_f32_16x16x32_bf16 v[84:87], a[68:71], v[148:151], v[84:87]
ds_read_b64_tr_b16 a[114:115], v119 offset:18432
v_cvt_pk_bf16_f32 v66, v72, v73
v_mfma_f32_16x16x32_bf16 v[84:87], a[72:75], v[164:167], v[84:87]
ds_read_b64_tr_b16 a[116:117], v119 offset:20480
v_cvt_pk_bf16_f32 v67, v74, v75
v_mfma_f32_16x16x32_bf16 v[84:87], a[76:79], v[180:183], v[84:87]
ds_read_b64_tr_b16 a[118:119], v119 offset:22528
buffer_store_dwordx4 v[64:67], v1, s[4:7], s8 offen offset:2048 sc1
v_mfma_f32_16x16x32_bf16 v[84:87], a[80:83], v[196:199], v[84:87]
ds_read_b64_tr_b16 a[120:121], v119 offset:24576
v_mul_f32 v68, v68, v25
v_mfma_f32_16x16x32_bf16 v[84:87], a[84:87], v[212:215], v[84:87]
ds_read_b64_tr_b16 a[122:123], v119 offset:26624
v_mul_f32 v69, v69, v25
v_mfma_f32_16x16x32_bf16 v[84:87], a[88:91], v[228:231], v[84:87]
ds_read_b64_tr_b16 a[124:125], v119 offset:28672
ds_read_b64_tr_b16 a[126:127], v119 offset:30720
v_mfma_f32_16x16x32_bf16 v[84:87], a[92:95], v[244:247], v[84:87]
s_waitcnt vmcnt(21) lgkmcnt(9)
s_barrier
v_add_u32 v119, 32768, v119
v_mfma_f32_16x16x32_bf16 v[88:91], a[96:99], v[128:131], 0
ds_read_b64_tr_b16 a[64:65], v116 offset:0
v_mul_f32 v70, v70, v25
v_mfma_f32_16x16x32_bf16 v[88:91], a[100:103], v[144:147], v[88:91]
ds_read_b64_tr_b16 a[66:67], v116 offset:2048
v_mul_f32 v71, v71, v25
v_mfma_f32_16x16x32_bf16 v[88:91], a[104:107], v[160:163], v[88:91]
s_waitcnt lgkmcnt(8)
ds_read_b64_tr_b16 a[68:69], v116 offset:4096
v_mul_f32 v76, v76, v25
v_mfma_f32_16x16x32_bf16 v[88:91], a[108:111], v[176:179], v[88:91]
ds_read_b64_tr_b16 a[70:71], v116 offset:6144
v_mul_f32 v77, v77, v25
v_mfma_f32_16x16x32_bf16 v[88:91], a[112:115], v[192:195], v[88:91]
s_waitcnt lgkmcnt(8)
ds_read_b64_tr_b16 a[72:73], v116 offset:8192
v_mul_f32 v78, v78, v25
v_mfma_f32_16x16x32_bf16 v[88:91], a[116:119], v[208:211], v[88:91]
s_waitcnt lgkmcnt(7)
ds_read_b64_tr_b16 a[74:75], v116 offset:10240
v_mul_f32 v79, v79, v25
v_mfma_f32_16x16x32_bf16 v[88:91], a[120:123], v[224:227], v[88:91]
s_waitcnt lgkmcnt(6)
ds_read_b64_tr_b16 a[76:77], v116 offset:12288
v_cvt_pk_bf16_f32 v68, v68, v69
v_mfma_f32_16x16x32_bf16 v[88:91], a[124:127], v[240:243], v[88:91]
ds_read_b64_tr_b16 a[78:79], v116 offset:14336
v_cvt_pk_bf16_f32 v69, v70, v71
v_mfma_f32_16x16x32_bf16 v[92:95], a[96:99], v[132:135], 0
ds_read_b64_tr_b16 a[80:81], v116 offset:16384
v_cvt_pk_bf16_f32 v70, v76, v77
v_mfma_f32_16x16x32_bf16 v[92:95], a[100:103], v[148:151], v[92:95]
ds_read_b64_tr_b16 a[82:83], v116 offset:18432
v_cvt_pk_bf16_f32 v71, v78, v79
v_mfma_f32_16x16x32_bf16 v[92:95], a[104:107], v[164:167], v[92:95]
ds_read_b64_tr_b16 a[84:85], v116 offset:20480
buffer_store_dwordx4 v[68:71], v1, s[4:7], s12 offen offset:2048 sc1
v_mfma_f32_16x16x32_bf16 v[92:95], a[108:111], v[180:183], v[92:95]
ds_read_b64_tr_b16 a[86:87], v116 offset:22528
v_mfma_f32_16x16x32_bf16 v[92:95], a[112:115], v[196:199], v[92:95]
ds_read_b64_tr_b16 a[88:89], v116 offset:24576
v_mfma_f32_16x16x32_bf16 v[92:95], a[116:119], v[212:215], v[92:95]
ds_read_b64_tr_b16 a[90:91], v116 offset:26624
v_mfma_f32_16x16x32_bf16 v[92:95], a[120:123], v[228:231], v[92:95]
ds_read_b64_tr_b16 a[92:93], v116 offset:28672
v_mfma_f32_16x16x32_bf16 v[92:95], a[124:127], v[244:247], v[92:95]
s_waitcnt lgkmcnt(8)
ds_read_b64_tr_b16 a[94:95], v116 offset:30720
v_add_u32 v116, 4294901760, v116
v_mfma_f32_16x16x32_bf16 v[32:35], a[64:67], v[128:131], 0
s_add_u32 m0, s18, 32768
ds_read_b64_tr_b16 a[96:97], v117 offset:0
v_mul_f32 v80, v80, v24
v_mfma_f32_16x16x32_bf16 v[32:35], a[68:71], v[144:147], v[32:35]
ds_read_b64_tr_b16 a[98:99], v117 offset:2048
buffer_load_dwordx4 v112, s[36:39], s81 offen offset:0 lds
v_mfma_f32_16x16x32_bf16 v[32:35], a[72:75], v[160:163], v[32:35]
s_waitcnt lgkmcnt(8)
ds_read_b64_tr_b16 a[100:101], v117 offset:4096
v_mul_f32 v81, v81, v24
v_mfma_f32_16x16x32_bf16 v[32:35], a[76:79], v[176:179], v[32:35]
ds_read_b64_tr_b16 a[102:103], v117 offset:6144
v_mul_f32 v82, v82, v24
v_mfma_f32_16x16x32_bf16 v[32:35], a[80:83], v[192:195], v[32:35]
s_waitcnt lgkmcnt(8)
ds_read_b64_tr_b16 a[104:105], v117 offset:8192
v_mul_f32 v83, v83, v24
v_mfma_f32_16x16x32_bf16 v[32:35], a[84:87], v[208:211], v[32:35]
s_waitcnt lgkmcnt(7)
ds_read_b64_tr_b16 a[106:107], v117 offset:10240
v_mul_f32 v88, v88, v24
v_mfma_f32_16x16x32_bf16 v[32:35], a[88:91], v[224:227], v[32:35]
s_waitcnt lgkmcnt(6)
ds_read_b64_tr_b16 a[108:109], v117 offset:12288
v_mul_f32 v89, v89, v24
v_mfma_f32_16x16x32_bf16 v[32:35], a[92:95], v[240:243], v[32:35]
ds_read_b64_tr_b16 a[110:111], v117 offset:14336
v_mul_f32 v90, v90, v24
v_mfma_f32_16x16x32_bf16 v[36:39], a[64:67], v[132:135], 0
ds_read_b64_tr_b16 a[112:113], v117 offset:16384
buffer_load_dwordx4 v113, s[36:39], s81 offen offset:1024 lds
v_mfma_f32_16x16x32_bf16 v[36:39], a[68:71], v[148:151], v[36:39]
ds_read_b64_tr_b16 a[114:115], v117 offset:18432
v_mul_f32 v91, v91, v24
v_mfma_f32_16x16x32_bf16 v[36:39], a[72:75], v[164:167], v[36:39]
ds_read_b64_tr_b16 a[116:117], v117 offset:20480
v_cvt_pk_bf16_f32 v80, v80, v81
v_mfma_f32_16x16x32_bf16 v[36:39], a[76:79], v[180:183], v[36:39]
ds_read_b64_tr_b16 a[118:119], v117 offset:22528
v_cvt_pk_bf16_f32 v81, v82, v83
v_mfma_f32_16x16x32_bf16 v[36:39], a[80:83], v[196:199], v[36:39]
ds_read_b64_tr_b16 a[120:121], v117 offset:24576
v_cvt_pk_bf16_f32 v82, v88, v89
v_mfma_f32_16x16x32_bf16 v[36:39], a[84:87], v[212:215], v[36:39]
ds_read_b64_tr_b16 a[122:123], v117 offset:26624
v_cvt_pk_bf16_f32 v83, v90, v91
v_mfma_f32_16x16x32_bf16 v[36:39], a[88:91], v[228:231], v[36:39]
ds_read_b64_tr_b16 a[124:125], v117 offset:28672
buffer_store_dwordx4 v[80:83], v1, s[4:7], s8 offen offset:3072 sc1
v_mfma_f32_16x16x32_bf16 v[36:39], a[92:95], v[244:247], v[36:39]
s_waitcnt lgkmcnt(8)
ds_read_b64_tr_b16 a[126:127], v117 offset:30720
v_add_u32 v117, 4294901760, v117
v_mfma_f32_16x16x32_bf16 v[40:43], a[96:99], v[128:131], 0
ds_read_b64_tr_b16 a[64:65], v118 offset:0
buffer_load_dwordx4 v114, s[36:39], s81 offen offset:2048 lds
v_mfma_f32_16x16x32_bf16 v[40:43], a[100:103], v[144:147], v[40:43]
ds_read_b64_tr_b16 a[66:67], v118 offset:2048
v_mul_f32 v84, v84, v25
v_mfma_f32_16x16x32_bf16 v[40:43], a[104:107], v[160:163], v[40:43]
s_waitcnt lgkmcnt(8)
ds_read_b64_tr_b16 a[68:69], v118 offset:4096
v_mul_f32 v85, v85, v25
v_mfma_f32_16x16x32_bf16 v[40:43], a[108:111], v[176:179], v[40:43]
ds_read_b64_tr_b16 a[70:71], v118 offset:6144
v_mul_f32 v86, v86, v25
v_mfma_f32_16x16x32_bf16 v[40:43], a[112:115], v[192:195], v[40:43]
s_waitcnt lgkmcnt(8)
ds_read_b64_tr_b16 a[72:73], v118 offset:8192
v_mul_f32 v87, v87, v25
v_mfma_f32_16x16x32_bf16 v[40:43], a[116:119], v[208:211], v[40:43]
s_waitcnt lgkmcnt(7)
ds_read_b64_tr_b16 a[74:75], v118 offset:10240
v_mul_f32 v92, v92, v25
v_mfma_f32_16x16x32_bf16 v[40:43], a[120:123], v[224:227], v[40:43]
s_waitcnt lgkmcnt(6)
ds_read_b64_tr_b16 a[76:77], v118 offset:12288
v_mul_f32 v93, v93, v25
v_mfma_f32_16x16x32_bf16 v[40:43], a[124:127], v[240:243], v[40:43]
ds_read_b64_tr_b16 a[78:79], v118 offset:14336
buffer_load_dwordx4 v115, s[36:39], s81 offen offset:3072 lds
v_mfma_f32_16x16x32_bf16 v[44:47], a[96:99], v[132:135], 0
ds_read_b64_tr_b16 a[80:81], v118 offset:16384
v_mul_f32 v94, v94, v25
v_mfma_f32_16x16x32_bf16 v[44:47], a[100:103], v[148:151], v[44:47]
ds_read_b64_tr_b16 a[82:83], v118 offset:18432
v_mul_f32 v95, v95, v25
v_mfma_f32_16x16x32_bf16 v[44:47], a[104:107], v[164:167], v[44:47]
ds_read_b64_tr_b16 a[84:85], v118 offset:20480
v_cvt_pk_bf16_f32 v84, v84, v85
v_mfma_f32_16x16x32_bf16 v[44:47], a[108:111], v[180:183], v[44:47]
ds_read_b64_tr_b16 a[86:87], v118 offset:22528
v_cvt_pk_bf16_f32 v85, v86, v87
v_mfma_f32_16x16x32_bf16 v[44:47], a[112:115], v[196:199], v[44:47]
ds_read_b64_tr_b16 a[88:89], v118 offset:24576
v_cvt_pk_bf16_f32 v86, v92, v93
v_mfma_f32_16x16x32_bf16 v[44:47], a[116:119], v[212:215], v[44:47]
s_add_u32 s81, s81, 28672
s_add_u32 m0, s18, 36864
ds_read_b64_tr_b16 a[90:91], v118 offset:26624
v_mfma_f32_16x16x32_bf16 v[44:47], a[120:123], v[228:231], v[44:47]
ds_read_b64_tr_b16 a[92:93], v118 offset:28672
buffer_load_dwordx4 v112, s[36:39], s81 offen offset:0 lds
v_mfma_f32_16x16x32_bf16 v[44:47], a[124:127], v[244:247], v[44:47]
s_waitcnt lgkmcnt(8)
ds_read_b64_tr_b16 a[94:95], v118 offset:30720
v_add_u32 v118, 4294901760, v118
v_mfma_f32_16x16x32_bf16 v[48:51], a[64:67], v[128:131], 0
ds_read_b64_tr_b16 a[96:97], v119 offset:0
v_cvt_pk_bf16_f32 v87, v94, v95
v_mfma_f32_16x16x32_bf16 v[48:51], a[68:71], v[144:147], v[48:51]
s_waitcnt lgkmcnt(8)
ds_read_b64_tr_b16 a[98:99], v119 offset:2048
buffer_store_dwordx4 v[84:87], v1, s[4:7], s12 offen offset:3072 sc1
v_mfma_f32_16x16x32_bf16 v[48:51], a[72:75], v[160:163], v[48:51]
s_add_u32 s8, s8, 4096
s_add_u32 s12, s12, 4096
ds_read_b64_tr_b16 a[100:101], v119 offset:4096
v_mfma_f32_16x16x32_bf16 v[48:51], a[76:79], v[176:179], v[48:51]
s_waitcnt lgkmcnt(8)
ds_read_b64_tr_b16 a[102:103], v119 offset:6144
v_mul_f32 v32, v32, v24
v_mfma_f32_16x16x32_bf16 v[48:51], a[80:83], v[192:195], v[48:51]
s_waitcnt lgkmcnt(8)
ds_read_b64_tr_b16 a[104:105], v119 offset:8192
v_mul_f32 v33, v33, v24
v_mfma_f32_16x16x32_bf16 v[48:51], a[84:87], v[208:211], v[48:51]
s_waitcnt lgkmcnt(7)
ds_read_b64_tr_b16 a[106:107], v119 offset:10240
buffer_load_dwordx4 v113, s[36:39], s81 offen offset:1024 lds
v_mfma_f32_16x16x32_bf16 v[48:51], a[88:91], v[224:227], v[48:51]
s_waitcnt lgkmcnt(6)
ds_read_b64_tr_b16 a[108:109], v119 offset:12288
v_mul_f32 v34, v34, v24
v_mfma_f32_16x16x32_bf16 v[48:51], a[92:95], v[240:243], v[48:51]
ds_read_b64_tr_b16 a[110:111], v119 offset:14336
v_mul_f32 v35, v35, v24
v_mfma_f32_16x16x32_bf16 v[52:55], a[64:67], v[132:135], 0
ds_read_b64_tr_b16 a[112:113], v119 offset:16384
v_mul_f32 v40, v40, v24
v_mfma_f32_16x16x32_bf16 v[52:55], a[68:71], v[148:151], v[52:55]
ds_read_b64_tr_b16 a[114:115], v119 offset:18432
v_mul_f32 v41, v41, v24
v_mfma_f32_16x16x32_bf16 v[52:55], a[72:75], v[164:167], v[52:55]
ds_read_b64_tr_b16 a[116:117], v119 offset:20480
v_mul_f32 v42, v42, v24
v_mfma_f32_16x16x32_bf16 v[52:55], a[76:79], v[180:183], v[52:55]
ds_read_b64_tr_b16 a[118:119], v119 offset:22528
v_mul_f32 v43, v43, v24
v_mfma_f32_16x16x32_bf16 v[52:55], a[80:83], v[196:199], v[52:55]
ds_read_b64_tr_b16 a[120:121], v119 offset:24576
buffer_load_dwordx4 v114, s[36:39], s81 offen offset:2048 lds
v_mfma_f32_16x16x32_bf16 v[52:55], a[84:87], v[212:215], v[52:55]
ds_read_b64_tr_b16 a[122:123], v119 offset:26624
v_cvt_pk_bf16_f32 v32, v32, v33
v_mfma_f32_16x16x32_bf16 v[52:55], a[88:91], v[228:231], v[52:55]
ds_read_b64_tr_b16 a[124:125], v119 offset:28672
ds_read_b64_tr_b16 a[126:127], v119 offset:30720
v_mfma_f32_16x16x32_bf16 v[52:55], a[92:95], v[244:247], v[52:55]
s_waitcnt vmcnt(23) lgkmcnt(9)
s_barrier
v_add_u32 v119, 4294901760, v119
v_mfma_f32_16x16x32_bf16 v[56:59], a[96:99], v[128:131], 0
ds_read_b64_tr_b16 a[64:65], v116 offset:0
v_cvt_pk_bf16_f32 v33, v34, v35
v_mfma_f32_16x16x32_bf16 v[56:59], a[100:103], v[144:147], v[56:59]
ds_read_b64_tr_b16 a[66:67], v116 offset:2048
v_cvt_pk_bf16_f32 v34, v40, v41
v_mfma_f32_16x16x32_bf16 v[56:59], a[104:107], v[160:163], v[56:59]
s_waitcnt lgkmcnt(8)
ds_read_b64_tr_b16 a[68:69], v116 offset:4096
v_cvt_pk_bf16_f32 v35, v42, v43
v_mfma_f32_16x16x32_bf16 v[56:59], a[108:111], v[176:179], v[56:59]
ds_read_b64_tr_b16 a[70:71], v116 offset:6144
buffer_load_dwordx4 v115, s[36:39], s81 offen offset:3072 lds
v_mfma_f32_16x16x32_bf16 v[56:59], a[112:115], v[192:195], v[56:59]
s_waitcnt lgkmcnt(8)
ds_read_b64_tr_b16 a[72:73], v116 offset:8192
buffer_store_dwordx4 v[32:35], v1, s[4:7], s8 offen offset:0 sc1
v_mfma_f32_16x16x32_bf16 v[56:59], a[116:119], v[208:211], v[56:59]
PAD_15:
s_cbranch_execz M_tret
s_waitcnt lgkmcnt(7)
ds_read_b64_tr_b16 a[74:75], v116 offset:10240
v_mul_f32 v36, v36, v25
v_mfma_f32_16x16x32_bf16 v[56:59], a[120:123], v[224:227], v[56:59]
s_waitcnt lgkmcnt(6)
ds_read_b64_tr_b16 a[76:77], v116 offset:12288
v_mul_f32 v37, v37, v25
v_mfma_f32_16x16x32_bf16 v[56:59], a[124:127], v[240:243], v[56:59]
ds_read_b64_tr_b16 a[78:79], v116 offset:14336
v_mul_f32 v38, v38, v25
v_mfma_f32_16x16x32_bf16 v[60:63], a[96:99], v[132:135], 0
ds_read_b64_tr_b16 a[80:81], v116 offset:16384
v_mul_f32 v39, v39, v25
v_mfma_f32_16x16x32_bf16 v[60:63], a[100:103], v[148:151], v[60:63]
s_sub_u32 s81, s81, 28544
ds_read_b64_tr_b16 a[82:83], v116 offset:18432
v_mul_f32 v44, v44, v25
v_mfma_f32_16x16x32_bf16 v[60:63], a[104:107], v[164:167], v[60:63]
ds_read_b64_tr_b16 a[84:85], v116 offset:20480
v_mul_f32 v45, v45, v25
v_mfma_f32_16x16x32_bf16 v[60:63], a[108:111], v[180:183], v[60:63]
ds_read_b64_tr_b16 a[86:87], v116 offset:22528
v_mul_f32 v46, v46, v25
v_mfma_f32_16x16x32_bf16 v[60:63], a[112:115], v[196:199], v[60:63]
ds_read_b64_tr_b16 a[88:89], v116 offset:24576
v_mul_f32 v47, v47, v25
v_mfma_f32_16x16x32_bf16 v[60:63], a[116:119], v[212:215], v[60:63]
ds_read_b64_tr_b16 a[90:91], v116 offset:26624
v_cvt_pk_bf16_f32 v36, v36, v37
v_mfma_f32_16x16x32_bf16 v[60:63], a[120:123], v[228:231], v[60:63]
ds_read_b64_tr_b16 a[92:93], v116 offset:28672
v_cvt_pk_bf16_f32 v37, v38, v39
v_mfma_f32_16x16x32_bf16 v[60:63], a[124:127], v[244:247], v[60:63]
s_waitcnt lgkmcnt(8)
ds_read_b64_tr_b16 a[94:95], v116 offset:30720
v_add_u32 v116, 4294901760, v116
v_mfma_f32_16x16x32_bf16 v[64:67], a[64:67], v[128:131], 0
s_add_u32 m0, s18, 98304
ds_read_b64_tr_b16 a[96:97], v117 offset:0
v_cvt_pk_bf16_f32 v38, v44, v45
v_mfma_f32_16x16x32_bf16 v[64:67], a[68:71], v[144:147], v[64:67]
ds_read_b64_tr_b16 a[98:99], v117 offset:2048
buffer_load_dwordx4 v112, s[36:39], s81 offen offset:0 lds
v_mfma_f32_16x16x32_bf16 v[64:67], a[72:75], v[160:163], v[64:67]
s_waitcnt lgkmcnt(8)
ds_read_b64_tr_b16 a[100:101], v117 offset:4096
v_cvt_pk_bf16_f32 v39, v46, v47
v_mfma_f32_16x16x32_bf16 v[64:67], a[76:79], v[176:179], v[64:67]
ds_read_b64_tr_b16 a[102:103], v117 offset:6144
buffer_store_dwordx4 v[36:39], v1, s[4:7], s12 offen offset:0 sc1
v_mfma_f32_16x16x32_bf16 v[64:67], a[80:83], v[192:195], v[64:67]
s_waitcnt lgkmcnt(8)
ds_read_b64_tr_b16 a[104:105], v117 offset:8192
v_mul_f32 v48, v48, v24
v_mfma_f32_16x16x32_bf16 v[64:67], a[84:87], v[208:211], v[64:67]
s_waitcnt lgkmcnt(7)
ds_read_b64_tr_b16 a[106:107], v117 offset:10240
v_mul_f32 v49, v49, v24
v_mfma_f32_16x16x32_bf16 v[64:67], a[88:91], v[224:227], v[64:67]
s_waitcnt lgkmcnt(6)
ds_read_b64_tr_b16 a[108:109], v117 offset:12288
v_mul_f32 v50, v50, v24
v_mfma_f32_16x16x32_bf16 v[64:67], a[92:95], v[240:243], v[64:67]
ds_read_b64_tr_b16 a[110:111], v117 offset:14336
v_mul_f32 v51, v51, v24
v_mfma_f32_16x16x32_bf16 v[68:71], a[64:67], v[132:135], 0
ds_read_b64_tr_b16 a[112:113], v117 offset:16384
buffer_load_dwordx4 v113, s[36:39], s81 offen offset:1024 lds
v_mfma_f32_16x16x32_bf16 v[68:71], a[68:71], v[148:151], v[68:71]
ds_read_b64_tr_b16 a[114:115], v117 offset:18432
v_mul_f32 v56, v56, v24
v_mfma_f32_16x16x32_bf16 v[68:71], a[72:75], v[164:167], v[68:71]
ds_read_b64_tr_b16 a[116:117], v117 offset:20480
v_mul_f32 v57, v57, v24
v_mfma_f32_16x16x32_bf16 v[68:71], a[76:79], v[180:183], v[68:71]
ds_read_b64_tr_b16 a[118:119], v117 offset:22528
v_mul_f32 v58, v58, v24
v_mfma_f32_16x16x32_bf16 v[68:71], a[80:83], v[196:199], v[68:71]
ds_read_b64_tr_b16 a[120:121], v117 offset:24576
v_mul_f32 v59, v59, v24
v_mfma_f32_16x16x32_bf16 v[68:71], a[84:87], v[212:215], v[68:71]
ds_read_b64_tr_b16 a[122:123], v117 offset:26624
v_cvt_pk_bf16_f32 v48, v48, v49
v_mfma_f32_16x16x32_bf16 v[68:71], a[88:91], v[228:231], v[68:71]
ds_read_b64_tr_b16 a[124:125], v117 offset:28672
v_cvt_pk_bf16_f32 v49, v50, v51
v_mfma_f32_16x16x32_bf16 v[68:71], a[92:95], v[244:247], v[68:71]
s_waitcnt lgkmcnt(8)
ds_read_b64_tr_b16 a[126:127], v117 offset:30720
v_add_u32 v117, 4294901760, v117
v_mfma_f32_16x16x32_bf16 v[72:75], a[96:99], v[128:131], 0
ds_read_b64_tr_b16 a[64:65], v118 offset:0
buffer_load_dwordx4 v114, s[36:39], s81 offen offset:2048 lds
v_mfma_f32_16x16x32_bf16 v[72:75], a[100:103], v[144:147], v[72:75]
ds_read_b64_tr_b16 a[66:67], v118 offset:2048
v_cvt_pk_bf16_f32 v50, v56, v57
v_mfma_f32_16x16x32_bf16 v[72:75], a[104:107], v[160:163], v[72:75]
s_waitcnt lgkmcnt(8)
ds_read_b64_tr_b16 a[68:69], v118 offset:4096
v_cvt_pk_bf16_f32 v51, v58, v59
v_mfma_f32_16x16x32_bf16 v[72:75], a[108:111], v[176:179], v[72:75]
ds_read_b64_tr_b16 a[70:71], v118 offset:6144
buffer_store_dwordx4 v[48:51], v1, s[4:7], s8 offen offset:1024 sc1
v_mfma_f32_16x16x32_bf16 v[72:75], a[112:115], v[192:195], v[72:75]
s_waitcnt lgkmcnt(8)
ds_read_b64_tr_b16 a[72:73], v118 offset:8192
v_mul_f32 v52, v52, v25
v_mfma_f32_16x16x32_bf16 v[72:75], a[116:119], v[208:211], v[72:75]
s_waitcnt lgkmcnt(7)
ds_read_b64_tr_b16 a[74:75], v118 offset:10240
v_mul_f32 v53, v53, v25
v_mfma_f32_16x16x32_bf16 v[72:75], a[120:123], v[224:227], v[72:75]
s_waitcnt lgkmcnt(6)
ds_read_b64_tr_b16 a[76:77], v118 offset:12288
v_mul_f32 v54, v54, v25
v_mfma_f32_16x16x32_bf16 v[72:75], a[124:127], v[240:243], v[72:75]
ds_read_b64_tr_b16 a[78:79], v118 offset:14336
buffer_load_dwordx4 v115, s[36:39], s81 offen offset:3072 lds
v_mfma_f32_16x16x32_bf16 v[76:79], a[96:99], v[132:135], 0
ds_read_b64_tr_b16 a[80:81], v118 offset:16384
v_mul_f32 v55, v55, v25
v_mfma_f32_16x16x32_bf16 v[76:79], a[100:103], v[148:151], v[76:79]
ds_read_b64_tr_b16 a[82:83], v118 offset:18432
v_mul_f32 v60, v60, v25
v_mfma_f32_16x16x32_bf16 v[76:79], a[104:107], v[164:167], v[76:79]
ds_read_b64_tr_b16 a[84:85], v118 offset:20480
v_mul_f32 v61, v61, v25
v_mfma_f32_16x16x32_bf16 v[76:79], a[108:111], v[180:183], v[76:79]
ds_read_b64_tr_b16 a[86:87], v118 offset:22528
v_mul_f32 v62, v62, v25
v_mfma_f32_16x16x32_bf16 v[76:79], a[112:115], v[196:199], v[76:79]
ds_read_b64_tr_b16 a[88:89], v118 offset:24576
v_mul_f32 v63, v63, v25
v_mfma_f32_16x16x32_bf16 v[76:79], a[116:119], v[212:215], v[76:79]
s_add_u32 s81, s81, 28672
s_add_u32 m0, s18, 102400
ds_read_b64_tr_b16 a[90:91], v118 offset:26624
v_mfma_f32_16x16x32_bf16 v[76:79], a[120:123], v[228:231], v[76:79]
ds_read_b64_tr_b16 a[92:93], v118 offset:28672
buffer_load_dwordx4 v112, s[36:39], s81 offen offset:0 lds
v_mfma_f32_16x16x32_bf16 v[76:79], a[124:127], v[244:247], v[76:79]
s_waitcnt lgkmcnt(8)
ds_read_b64_tr_b16 a[94:95], v118 offset:30720
v_add_u32 v118, 4294901760, v118
v_mfma_f32_16x16x32_bf16 v[80:83], a[64:67], v[128:131], 0
ds_read_b64_tr_b16 a[96:97], v119 offset:0
v_cvt_pk_bf16_f32 v52, v52, v53
v_mfma_f32_16x16x32_bf16 v[80:83], a[68:71], v[144:147], v[80:83]
ds_read_b64_tr_b16 a[98:99], v119 offset:2048
v_cvt_pk_bf16_f32 v53, v54, v55
v_mfma_f32_16x16x32_bf16 v[80:83], a[72:75], v[160:163], v[80:83]
s_waitcnt lgkmcnt(8)
ds_read_b64_tr_b16 a[100:101], v119 offset:4096
v_cvt_pk_bf16_f32 v54, v60, v61
v_mfma_f32_16x16x32_bf16 v[80:83], a[76:79], v[176:179], v[80:83]
ds_read_b64_tr_b16 a[102:103], v119 offset:6144
v_cvt_pk_bf16_f32 v55, v62, v63
v_mfma_f32_16x16x32_bf16 v[80:83], a[80:83], v[192:195], v[80:83]
s_waitcnt lgkmcnt(8)
ds_read_b64_tr_b16 a[104:105], v119 offset:8192
buffer_store_dwordx4 v[52:55], v1, s[4:7], s12 offen offset:1024 sc1
v_mfma_f32_16x16x32_bf16 v[80:83], a[84:87], v[208:211], v[80:83]
s_waitcnt lgkmcnt(7)
ds_read_b64_tr_b16 a[106:107], v119 offset:10240
buffer_load_dwordx4 v113, s[36:39], s81 offen offset:1024 lds
v_mfma_f32_16x16x32_bf16 v[80:83], a[88:91], v[224:227], v[80:83]
s_waitcnt lgkmcnt(6)
ds_read_b64_tr_b16 a[108:109], v119 offset:12288
v_mul_f32 v64, v64, v24
v_mfma_f32_16x16x32_bf16 v[80:83], a[92:95], v[240:243], v[80:83]
ds_read_b64_tr_b16 a[110:111], v119 offset:14336
v_mul_f32 v65, v65, v24
v_mfma_f32_16x16x32_bf16 v[84:87], a[64:67], v[132:135], 0
ds_read_b64_tr_b16 a[112:113], v119 offset:16384
v_mul_f32 v66, v66, v24
v_mfma_f32_16x16x32_bf16 v[84:87], a[68:71], v[148:151], v[84:87]
ds_read_b64_tr_b16 a[114:115], v119 offset:18432
v_mul_f32 v67, v67, v24
v_mfma_f32_16x16x32_bf16 v[84:87], a[72:75], v[164:167], v[84:87]
ds_read_b64_tr_b16 a[116:117], v119 offset:20480
v_mul_f32 v72, v72, v24
v_mfma_f32_16x16x32_bf16 v[84:87], a[76:79], v[180:183], v[84:87]
ds_read_b64_tr_b16 a[118:119], v119 offset:22528
v_mul_f32 v73, v73, v24
v_mfma_f32_16x16x32_bf16 v[84:87], a[80:83], v[196:199], v[84:87]
ds_read_b64_tr_b16 a[120:121], v119 offset:24576
buffer_load_dwordx4 v114, s[36:39], s81 offen offset:2048 lds
v_mfma_f32_16x16x32_bf16 v[84:87], a[84:87], v[212:215], v[84:87]
ds_read_b64_tr_b16 a[122:123], v119 offset:26624
v_mul_f32 v74, v74, v24
v_mfma_f32_16x16x32_bf16 v[84:87], a[88:91], v[228:231], v[84:87]
ds_read_b64_tr_b16 a[124:125], v119 offset:28672
ds_read_b64_tr_b16 a[126:127], v119 offset:30720
v_mfma_f32_16x16x32_bf16 v[84:87], a[92:95], v[244:247], v[84:87]
s_waitcnt vmcnt(27) lgkmcnt(9)
s_barrier
v_add_u32 v119, 4294901760, v119
v_mfma_f32_16x16x32_bf16 v[88:91], a[96:99], v[128:131], 0
ds_read_b64_tr_b16 a[64:65], v116 offset:0
v_mul_f32 v75, v75, v24
v_mfma_f32_16x16x32_bf16 v[88:91], a[100:103], v[144:147], v[88:91]
ds_read_b64_tr_b16 a[66:67], v116 offset:2048
v_cvt_pk_bf16_f32 v64, v64, v65
v_mfma_f32_16x16x32_bf16 v[88:91], a[104:107], v[160:163], v[88:91]
s_waitcnt lgkmcnt(8)
ds_read_b64_tr_b16 a[68:69], v116 offset:4096
v_cvt_pk_bf16_f32 v65, v66, v67
v_mfma_f32_16x16x32_bf16 v[88:91], a[108:111], v[176:179], v[88:91]
ds_read_b64_tr_b16 a[70:71], v116 offset:6144
buffer_load_dwordx4 v115, s[36:39], s81 offen offset:3072 lds
v_mfma_f32_16x16x32_bf16 v[88:91], a[112:115], v[192:195], v[88:91]
s_waitcnt lgkmcnt(8)
ds_read_b64_tr_b16 a[72:73], v116 offset:8192
v_cvt_pk_bf16_f32 v66, v72, v73
v_mfma_f32_16x16x32_bf16 v[88:91], a[116:119], v[208:211], v[88:91]
s_waitcnt lgkmcnt(7)
ds_read_b64_tr_b16 a[74:75], v116 offset:10240
v_cvt_pk_bf16_f32 v67, v74, v75
v_mfma_f32_16x16x32_bf16 v[88:91], a[120:123], v[224:227], v[88:91]
s_waitcnt lgkmcnt(6)
ds_read_b64_tr_b16 a[76:77], v116 offset:12288
buffer_store_dwordx4 v[64:67], v1, s[4:7], s8 offen offset:2048 sc1
v_mfma_f32_16x16x32_bf16 v[88:91], a[124:127], v[240:243], v[88:91]
ds_read_b64_tr_b16 a[78:79], v116 offset:14336
v_mul_f32 v68, v68, v25
v_mfma_f32_16x16x32_bf16 v[92:95], a[96:99], v[132:135], 0
ds_read_b64_tr_b16 a[80:81], v116 offset:16384
v_mul_f32 v69, v69, v25
v_mfma_f32_16x16x32_bf16 v[92:95], a[100:103], v[148:151], v[92:95]
s_sub_u32 s81, s81, 28544
ds_read_b64_tr_b16 a[82:83], v116 offset:18432
v_mul_f32 v70, v70, v25
v_mfma_f32_16x16x32_bf16 v[92:95], a[104:107], v[164:167], v[92:95]
ds_read_b64_tr_b16 a[84:85], v116 offset:20480
v_mul_f32 v71, v71, v25
v_mfma_f32_16x16x32_bf16 v[92:95], a[108:111], v[180:183], v[92:95]
ds_read_b64_tr_b16 a[86:87], v116 offset:22528
v_mul_f32 v76, v76, v25
v_mfma_f32_16x16x32_bf16 v[92:95], a[112:115], v[196:199], v[92:95]
ds_read_b64_tr_b16 a[88:89], v116 offset:24576
v_mul_f32 v77, v77, v25
v_mfma_f32_16x16x32_bf16 v[92:95], a[116:119], v[212:215], v[92:95]
ds_read_b64_tr_b16 a[90:91], v116 offset:26624
v_mul_f32 v78, v78, v25
v_mfma_f32_16x16x32_bf16 v[92:95], a[120:123], v[228:231], v[92:95]
ds_read_b64_tr_b16 a[92:93], v116 offset:28672
v_mul_f32 v79, v79, v25
v_mfma_f32_16x16x32_bf16 v[92:95], a[124:127], v[244:247], v[92:95]
s_waitcnt lgkmcnt(8)
ds_read_b64_tr_b16 a[94:95], v116 offset:30720
v_add_u32 v116, 32768, v116
v_mfma_f32_16x16x32_bf16 v[32:35], a[64:67], v[128:131], 0
ds_read_b64_tr_b16 a[96:97], v117 offset:0
v_cvt_pk_bf16_f32 v68, v68, v69
v_mfma_f32_16x16x32_bf16 v[32:35], a[68:71], v[144:147], v[32:35]
ds_read_b64_tr_b16 a[98:99], v117 offset:2048
v_cvt_pk_bf16_f32 v69, v70, v71
v_mfma_f32_16x16x32_bf16 v[32:35], a[72:75], v[160:163], v[32:35]
s_waitcnt lgkmcnt(8)
ds_read_b64_tr_b16 a[100:101], v117 offset:4096
v_cvt_pk_bf16_f32 v70, v76, v77
v_mfma_f32_16x16x32_bf16 v[32:35], a[76:79], v[176:179], v[32:35]
ds_read_b64_tr_b16 a[102:103], v117 offset:6144
v_cvt_pk_bf16_f32 v71, v78, v79
v_mfma_f32_16x16x32_bf16 v[32:35], a[80:83], v[192:195], v[32:35]
s_waitcnt lgkmcnt(8)
ds_read_b64_tr_b16 a[104:105], v117 offset:8192
buffer_store_dwordx4 v[68:71], v1, s[4:7], s12 offen offset:2048 sc1
v_mfma_f32_16x16x32_bf16 v[32:35], a[84:87], v[208:211], v[32:35]
s_waitcnt lgkmcnt(7)
ds_read_b64_tr_b16 a[106:107], v117 offset:10240
v_mul_f32 v80, v80, v24
v_mfma_f32_16x16x32_bf16 v[32:35], a[88:91], v[224:227], v[32:35]
s_waitcnt lgkmcnt(6)
ds_read_b64_tr_b16 a[108:109], v117 offset:12288
v_mul_f32 v81, v81, v24
v_mfma_f32_16x16x32_bf16 v[32:35], a[92:95], v[240:243], v[32:35]
ds_read_b64_tr_b16 a[110:111], v117 offset:14336
v_mul_f32 v82, v82, v24
v_mfma_f32_16x16x32_bf16 v[36:39], a[64:67], v[132:135], 0
ds_read_b64_tr_b16 a[112:113], v117 offset:16384
v_mul_f32 v83, v83, v24
v_mfma_f32_16x16x32_bf16 v[36:39], a[68:71], v[148:151], v[36:39]
ds_read_b64_tr_b16 a[114:115], v117 offset:18432
v_mul_f32 v88, v88, v24
v_mfma_f32_16x16x32_bf16 v[36:39], a[72:75], v[164:167], v[36:39]
ds_read_b64_tr_b16 a[116:117], v117 offset:20480
v_mul_f32 v89, v89, v24
v_mfma_f32_16x16x32_bf16 v[36:39], a[76:79], v[180:183], v[36:39]
ds_read_b64_tr_b16 a[118:119], v117 offset:22528
v_mul_f32 v90, v90, v24
v_mfma_f32_16x16x32_bf16 v[36:39], a[80:83], v[196:199], v[36:39]
ds_read_b64_tr_b16 a[120:121], v117 offset:24576
v_mul_f32 v91, v91, v24
v_mfma_f32_16x16x32_bf16 v[36:39], a[84:87], v[212:215], v[36:39]
ds_read_b64_tr_b16 a[122:123], v117 offset:26624
v_cvt_pk_bf16_f32 v80, v80, v81
v_mfma_f32_16x16x32_bf16 v[36:39], a[88:91], v[228:231], v[36:39]
ds_read_b64_tr_b16 a[124:125], v117 offset:28672
v_cvt_pk_bf16_f32 v81, v82, v83
v_mfma_f32_16x16x32_bf16 v[36:39], a[92:95], v[244:247], v[36:39]
s_waitcnt lgkmcnt(8)
ds_read_b64_tr_b16 a[126:127], v117 offset:30720
v_add_u32 v117, 32768, v117
v_mfma_f32_16x16x32_bf16 v[40:43], a[96:99], v[128:131], 0
ds_read_b64_tr_b16 a[64:65], v118 offset:0
v_cvt_pk_bf16_f32 v82, v88, v89
v_mfma_f32_16x16x32_bf16 v[40:43], a[100:103], v[144:147], v[40:43]
ds_read_b64_tr_b16 a[66:67], v118 offset:2048
v_cvt_pk_bf16_f32 v83, v90, v91
v_mfma_f32_16x16x32_bf16 v[40:43], a[104:107], v[160:163], v[40:43]
s_waitcnt lgkmcnt(8)
ds_read_b64_tr_b16 a[68:69], v118 offset:4096
buffer_store_dwordx4 v[80:83], v1, s[4:7], s8 offen offset:3072 sc1
v_mfma_f32_16x16x32_bf16 v[40:43], a[108:111], v[176:179], v[40:43]
ds_read_b64_tr_b16 a[70:71], v118 offset:6144
v_mul_f32 v84, v84, v25
v_mfma_f32_16x16x32_bf16 v[40:43], a[112:115], v[192:195], v[40:43]
s_waitcnt lgkmcnt(8)
ds_read_b64_tr_b16 a[72:73], v118 offset:8192
v_mul_f32 v85, v85, v25
v_mfma_f32_16x16x32_bf16 v[40:43], a[116:119], v[208:211], v[40:43]
s_waitcnt lgkmcnt(7)
ds_read_b64_tr_b16 a[74:75], v118 offset:10240
v_mul_f32 v86, v86, v25
v_mfma_f32_16x16x32_bf16 v[40:43], a[120:123], v[224:227], v[40:43]
s_waitcnt lgkmcnt(6)
ds_read_b64_tr_b16 a[76:77], v118 offset:12288
v_mul_f32 v87, v87, v25
v_mfma_f32_16x16x32_bf16 v[40:43], a[124:127], v[240:243], v[40:43]
ds_read_b64_tr_b16 a[78:79], v118 offset:14336
v_mul_f32 v92, v92, v25
v_mfma_f32_16x16x32_bf16 v[44:47], a[96:99], v[132:135], 0
ds_read_b64_tr_b16 a[80:81], v118 offset:16384
v_mul_f32 v93, v93, v25
v_mfma_f32_16x16x32_bf16 v[44:47], a[100:103], v[148:151], v[44:47]
ds_read_b64_tr_b16 a[82:83], v118 offset:18432
v_mul_f32 v94, v94, v25
v_mfma_f32_16x16x32_bf16 v[44:47], a[104:107], v[164:167], v[44:47]
ds_read_b64_tr_b16 a[84:85], v118 offset:20480
v_mul_f32 v95, v95, v25
v_mfma_f32_16x16x32_bf16 v[44:47], a[108:111], v[180:183], v[44:47]
ds_read_b64_tr_b16 a[86:87], v118 offset:22528
v_cvt_pk_bf16_f32 v84, v84, v85
v_mfma_f32_16x16x32_bf16 v[44:47], a[112:115], v[196:199], v[44:47]
ds_read_b64_tr_b16 a[88:89], v118 offset:24576
v_cvt_pk_bf16_f32 v85, v86, v87
v_mfma_f32_16x16x32_bf16 v[44:47], a[116:119], v[212:215], v[44:47]
ds_read_b64_tr_b16 a[90:91], v118 offset:26624
v_cvt_pk_bf16_f32 v86, v92, v93
v_mfma_f32_16x16x32_bf16 v[44:47], a[120:123], v[228:231], v[44:47]
ds_read_b64_tr_b16 a[92:93], v118 offset:28672
v_cvt_pk_bf16_f32 v87, v94, v95
v_mfma_f32_16x16x32_bf16 v[44:47], a[124:127], v[244:247], v[44:47]
s_waitcnt lgkmcnt(8)
ds_read_b64_tr_b16 a[94:95], v118 offset:30720
v_add_u32 v118, 32768, v118
v_mfma_f32_16x16x32_bf16 v[48:51], a[64:67], v[128:131], 0
ds_read_b64_tr_b16 a[96:97], v119 offset:0
buffer_store_dwordx4 v[84:87], v1, s[4:7], s12 offen offset:3072 sc1
v_mfma_f32_16x16x32_bf16 v[48:51], a[68:71], v[144:147], v[48:51]
s_add_u32 s8, s8, 4096
s_add_u32 s12, s12, 4096
ds_read_b64_tr_b16 a[98:99], v119 offset:2048
v_mfma_f32_16x16x32_bf16 v[48:51], a[72:75], v[160:163], v[48:51]
s_waitcnt lgkmcnt(8)
ds_read_b64_tr_b16 a[100:101], v119 offset:4096
v_mul_f32 v32, v32, v24
v_mfma_f32_16x16x32_bf16 v[48:51], a[76:79], v[176:179], v[48:51]
ds_read_b64_tr_b16 a[102:103], v119 offset:6144
v_mul_f32 v33, v33, v24
v_mfma_f32_16x16x32_bf16 v[48:51], a[80:83], v[192:195], v[48:51]
s_waitcnt lgkmcnt(8)
ds_read_b64_tr_b16 a[104:105], v119 offset:8192
v_mul_f32 v34, v34, v24
v_mfma_f32_16x16x32_bf16 v[48:51], a[84:87], v[208:211], v[48:51]
s_waitcnt lgkmcnt(7)
ds_read_b64_tr_b16 a[106:107], v119 offset:10240
v_mul_f32 v35, v35, v24
v_mfma_f32_16x16x32_bf16 v[48:51], a[88:91], v[224:227], v[48:51]
s_waitcnt lgkmcnt(6)
ds_read_b64_tr_b16 a[108:109], v119 offset:12288
v_mul_f32 v40, v40, v24
v_mfma_f32_16x16x32_bf16 v[48:51], a[92:95], v[240:243], v[48:51]
ds_read_b64_tr_b16 a[110:111], v119 offset:14336
v_mul_f32 v41, v41, v24
v_mfma_f32_16x16x32_bf16 v[52:55], a[64:67], v[132:135], 0
ds_read_b64_tr_b16 a[112:113], v119 offset:16384
v_mul_f32 v42, v42, v24
v_mfma_f32_16x16x32_bf16 v[52:55], a[68:71], v[148:151], v[52:55]
ds_read_b64_tr_b16 a[114:115], v119 offset:18432
v_mul_f32 v43, v43, v24
v_mfma_f32_16x16x32_bf16 v[52:55], a[72:75], v[164:167], v[52:55]
ds_read_b64_tr_b16 a[116:117], v119 offset:20480
v_cvt_pk_bf16_f32 v32, v32, v33
v_mfma_f32_16x16x32_bf16 v[52:55], a[76:79], v[180:183], v[52:55]
ds_read_b64_tr_b16 a[118:119], v119 offset:22528
v_cvt_pk_bf16_f32 v33, v34, v35
v_mfma_f32_16x16x32_bf16 v[52:55], a[80:83], v[196:199], v[52:55]
ds_read_b64_tr_b16 a[120:121], v119 offset:24576
v_cvt_pk_bf16_f32 v34, v40, v41
v_mfma_f32_16x16x32_bf16 v[52:55], a[84:87], v[212:215], v[52:55]
ds_read_b64_tr_b16 a[122:123], v119 offset:26624
v_cvt_pk_bf16_f32 v35, v42, v43
v_mfma_f32_16x16x32_bf16 v[52:55], a[88:91], v[228:231], v[52:55]
ds_read_b64_tr_b16 a[124:125], v119 offset:28672
ds_read_b64_tr_b16 a[126:127], v119 offset:30720
v_mfma_f32_16x16x32_bf16 v[52:55], a[92:95], v[244:247], v[52:55]
s_waitcnt vmcnt(16) lgkmcnt(9)
s_barrier
v_add_u32 v119, 32768, v119
v_mfma_f32_16x16x32_bf16 v[56:59], a[96:99], v[128:131], 0
ds_read_b64_tr_b16 a[64:65], v116 offset:0
buffer_store_dwordx4 v[32:35], v1, s[4:7], s8 offen offset:0 sc1
v_mfma_f32_16x16x32_bf16 v[56:59], a[100:103], v[144:147], v[56:59]
ds_read_b64_tr_b16 a[66:67], v116 offset:2048
v_mul_f32 v36, v36, v25
v_mfma_f32_16x16x32_bf16 v[56:59], a[104:107], v[160:163], v[56:59]
s_waitcnt lgkmcnt(8)
ds_read_b64_tr_b16 a[68:69], v116 offset:4096
v_mul_f32 v37, v37, v25
v_mfma_f32_16x16x32_bf16 v[56:59], a[108:111], v[176:179], v[56:59]
ds_read_b64_tr_b16 a[70:71], v116 offset:6144
v_mul_f32 v38, v38, v25
v_mfma_f32_16x16x32_bf16 v[56:59], a[112:115], v[192:195], v[56:59]
s_waitcnt lgkmcnt(8)
ds_read_b64_tr_b16 a[72:73], v116 offset:8192
v_mul_f32 v39, v39, v25
v_mfma_f32_16x16x32_bf16 v[56:59], a[116:119], v[208:211], v[56:59]
s_waitcnt lgkmcnt(7)
ds_read_b64_tr_b16 a[74:75], v116 offset:10240
v_mul_f32 v44, v44, v25
v_mfma_f32_16x16x32_bf16 v[56:59], a[120:123], v[224:227], v[56:59]
s_waitcnt lgkmcnt(6)
ds_read_b64_tr_b16 a[76:77], v116 offset:12288
v_mul_f32 v45, v45, v25
v_mfma_f32_16x16x32_bf16 v[56:59], a[124:127], v[240:243], v[56:59]
ds_read_b64_tr_b16 a[78:79], v116 offset:14336
v_mul_f32 v46, v46, v25
v_mfma_f32_16x16x32_bf16 v[60:63], a[96:99], v[132:135], 0
ds_read_b64_tr_b16 a[80:81], v116 offset:16384
v_mul_f32 v47, v47, v25
v_mfma_f32_16x16x32_bf16 v[60:63], a[100:103], v[148:151], v[60:63]
ds_read_b64_tr_b16 a[82:83], v116 offset:18432
v_cvt_pk_bf16_f32 v36, v36, v37
v_mfma_f32_16x16x32_bf16 v[60:63], a[104:107], v[164:167], v[60:63]
ds_read_b64_tr_b16 a[84:85], v116 offset:20480
v_cvt_pk_bf16_f32 v37, v38, v39
v_mfma_f32_16x16x32_bf16 v[60:63], a[108:111], v[180:183], v[60:63]
ds_read_b64_tr_b16 a[86:87], v116 offset:22528
v_cvt_pk_bf16_f32 v38, v44, v45
v_mfma_f32_16x16x32_bf16 v[60:63], a[112:115], v[196:199], v[60:63]
ds_read_b64_tr_b16 a[88:89], v116 offset:24576
v_cvt_pk_bf16_f32 v39, v46, v47
v_mfma_f32_16x16x32_bf16 v[60:63], a[116:119], v[212:215], v[60:63]
ds_read_b64_tr_b16 a[90:91], v116 offset:26624
buffer_store_dwordx4 v[36:39], v1, s[4:7], s12 offen offset:0 sc1
v_mfma_f32_16x16x32_bf16 v[60:63], a[120:123], v[228:231], v[60:63]
ds_read_b64_tr_b16 a[92:93], v116 offset:28672
v_mfma_f32_16x16x32_bf16 v[60:63], a[124:127], v[244:247], v[60:63]
s_waitcnt lgkmcnt(8)
ds_read_b64_tr_b16 a[94:95], v116 offset:30720
v_add_u32 v116, 65536, v116
v_mfma_f32_16x16x32_bf16 v[64:67], a[64:67], v[128:131], 0
ds_read_b64_tr_b16 a[96:97], v117 offset:0
v_mul_f32 v48, v48, v24
v_mfma_f32_16x16x32_bf16 v[64:67], a[68:71], v[144:147], v[64:67]
ds_read_b64_tr_b16 a[98:99], v117 offset:2048
v_mul_f32 v49, v49, v24
v_mfma_f32_16x16x32_bf16 v[64:67], a[72:75], v[160:163], v[64:67]
s_waitcnt lgkmcnt(8)
ds_read_b64_tr_b16 a[100:101], v117 offset:4096
v_mul_f32 v50, v50, v24
v_mfma_f32_16x16x32_bf16 v[64:67], a[76:79], v[176:179], v[64:67]
ds_read_b64_tr_b16 a[102:103], v117 offset:6144
v_mul_f32 v51, v51, v24
v_mfma_f32_16x16x32_bf16 v[64:67], a[80:83], v[192:195], v[64:67]
s_waitcnt lgkmcnt(8)
ds_read_b64_tr_b16 a[104:105], v117 offset:8192
v_mul_f32 v56, v56, v24
v_mfma_f32_16x16x32_bf16 v[64:67], a[84:87], v[208:211], v[64:67]
s_waitcnt lgkmcnt(7)
ds_read_b64_tr_b16 a[106:107], v117 offset:10240
v_mul_f32 v57, v57, v24
v_mfma_f32_16x16x32_bf16 v[64:67], a[88:91], v[224:227], v[64:67]
s_waitcnt lgkmcnt(6)
ds_read_b64_tr_b16 a[108:109], v117 offset:12288
v_mul_f32 v58, v58, v24
v_mfma_f32_16x16x32_bf16 v[64:67], a[92:95], v[240:243], v[64:67]
ds_read_b64_tr_b16 a[110:111], v117 offset:14336
v_mul_f32 v59, v59, v24
v_mfma_f32_16x16x32_bf16 v[68:71], a[64:67], v[132:135], 0
ds_read_b64_tr_b16 a[112:113], v117 offset:16384
v_cvt_pk_bf16_f32 v48, v48, v49
v_mfma_f32_16x16x32_bf16 v[68:71], a[68:71], v[148:151], v[68:71]
ds_read_b64_tr_b16 a[114:115], v117 offset:18432
v_cvt_pk_bf16_f32 v49, v50, v51
v_mfma_f32_16x16x32_bf16 v[68:71], a[72:75], v[164:167], v[68:71]
ds_read_b64_tr_b16 a[116:117], v117 offset:20480
v_cvt_pk_bf16_f32 v50, v56, v57
v_mfma_f32_16x16x32_bf16 v[68:71], a[76:79], v[180:183], v[68:71]
ds_read_b64_tr_b16 a[118:119], v117 offset:22528
v_cvt_pk_bf16_f32 v51, v58, v59
v_mfma_f32_16x16x32_bf16 v[68:71], a[80:83], v[196:199], v[68:71]
ds_read_b64_tr_b16 a[120:121], v117 offset:24576
buffer_store_dwordx4 v[48:51], v1, s[4:7], s8 offen offset:1024 sc1
v_mfma_f32_16x16x32_bf16 v[68:71], a[84:87], v[212:215], v[68:71]
ds_read_b64_tr_b16 a[122:123], v117 offset:26624
v_mul_f32 v52, v52, v25
v_mfma_f32_16x16x32_bf16 v[68:71], a[88:91], v[228:231], v[68:71]
ds_read_b64_tr_b16 a[124:125], v117 offset:28672
v_mul_f32 v53, v53, v25
v_mfma_f32_16x16x32_bf16 v[68:71], a[92:95], v[244:247], v[68:71]
s_waitcnt lgkmcnt(8)
ds_read_b64_tr_b16 a[126:127], v117 offset:30720
v_add_u32 v117, 65536, v117
v_mfma_f32_16x16x32_bf16 v[72:75], a[96:99], v[128:131], 0
ds_read_b64_tr_b16 a[64:65], v118 offset:0
v_mul_f32 v54, v54, v25
v_mfma_f32_16x16x32_bf16 v[72:75], a[100:103], v[144:147], v[72:75]
ds_read_b64_tr_b16 a[66:67], v118 offset:2048
v_mul_f32 v55, v55, v25
v_mfma_f32_16x16x32_bf16 v[72:75], a[104:107], v[160:163], v[72:75]
s_waitcnt lgkmcnt(8)
ds_read_b64_tr_b16 a[68:69], v118 offset:4096
v_mul_f32 v60, v60, v25
v_mfma_f32_16x16x32_bf16 v[72:75], a[108:111], v[176:179], v[72:75]
ds_read_b64_tr_b16 a[70:71], v118 offset:6144
v_mul_f32 v61, v61, v25
v_mfma_f32_16x16x32_bf16 v[72:75], a[112:115], v[192:195], v[72:75]
s_waitcnt lgkmcnt(8)
ds_read_b64_tr_b16 a[72:73], v118 offset:8192
v_mul_f32 v62, v62, v25
v_mfma_f32_16x16x32_bf16 v[72:75], a[116:119], v[208:211], v[72:75]
s_waitcnt lgkmcnt(7)
ds_read_b64_tr_b16 a[74:75], v118 offset:10240
v_mul_f32 v63, v63, v25
v_mfma_f32_16x16x32_bf16 v[72:75], a[120:123], v[224:227], v[72:75]
s_waitcnt lgkmcnt(6)
ds_read_b64_tr_b16 a[76:77], v118 offset:12288
v_cvt_pk_bf16_f32 v52, v52, v53
v_mfma_f32_16x16x32_bf16 v[72:75], a[124:127], v[240:243], v[72:75]
ds_read_b64_tr_b16 a[78:79], v118 offset:14336
v_cvt_pk_bf16_f32 v53, v54, v55
v_mfma_f32_16x16x32_bf16 v[76:79], a[96:99], v[132:135], 0
ds_read_b64_tr_b16 a[80:81], v118 offset:16384
v_cvt_pk_bf16_f32 v54, v60, v61
v_mfma_f32_16x16x32_bf16 v[76:79], a[100:103], v[148:151], v[76:79]
ds_read_b64_tr_b16 a[82:83], v118 offset:18432
v_cvt_pk_bf16_f32 v55, v62, v63
v_mfma_f32_16x16x32_bf16 v[76:79], a[104:107], v[164:167], v[76:79]
ds_read_b64_tr_b16 a[84:85], v118 offset:20480
buffer_store_dwordx4 v[52:55], v1, s[4:7], s12 offen offset:1024 sc1
v_mfma_f32_16x16x32_bf16 v[76:79], a[108:111], v[180:183], v[76:79]
ds_read_b64_tr_b16 a[86:87], v118 offset:22528
v_mul_u32_u24 v21, 1792, v19
v_mfma_f32_16x16x32_bf16 v[76:79], a[112:115], v[196:199], v[76:79]
ds_read_b64_tr_b16 a[88:89], v118 offset:24576
v_mul_f32 v64, v64, v24
v_mfma_f32_16x16x32_bf16 v[76:79], a[116:119], v[212:215], v[76:79]
ds_read_b64_tr_b16 a[90:91], v118 offset:26624
v_mul_f32 v65, v65, v24
v_mfma_f32_16x16x32_bf16 v[76:79], a[120:123], v[228:231], v[76:79]
ds_read_b64_tr_b16 a[92:93], v118 offset:28672
v_mul_f32 v66, v66, v24
v_mfma_f32_16x16x32_bf16 v[76:79], a[124:127], v[244:247], v[76:79]
s_waitcnt lgkmcnt(8)
ds_read_b64_tr_b16 a[94:95], v118 offset:30720
v_add_u32 v118, 65536, v118
v_mfma_f32_16x16x32_bf16 v[80:83], a[64:67], v[128:131], 0
ds_read_b64_tr_b16 a[96:97], v119 offset:0
v_mul_f32 v67, v67, v24
v_mfma_f32_16x16x32_bf16 v[80:83], a[68:71], v[144:147], v[80:83]
ds_read_b64_tr_b16 a[98:99], v119 offset:2048
v_mul_f32 v72, v72, v24
v_mfma_f32_16x16x32_bf16 v[80:83], a[72:75], v[160:163], v[80:83]
s_waitcnt lgkmcnt(8)
ds_read_b64_tr_b16 a[100:101], v119 offset:4096
v_mul_f32 v73, v73, v24
v_mfma_f32_16x16x32_bf16 v[80:83], a[76:79], v[176:179], v[80:83]
ds_read_b64_tr_b16 a[102:103], v119 offset:6144
v_mul_f32 v74, v74, v24
v_mfma_f32_16x16x32_bf16 v[80:83], a[80:83], v[192:195], v[80:83]
s_waitcnt lgkmcnt(8)
ds_read_b64_tr_b16 a[104:105], v119 offset:8192
v_mul_f32 v75, v75, v24
v_mfma_f32_16x16x32_bf16 v[80:83], a[84:87], v[208:211], v[80:83]
PAD_16:
s_cbranch_execz M_tret
s_waitcnt lgkmcnt(7)
ds_read_b64_tr_b16 a[106:107], v119 offset:10240
v_cvt_pk_bf16_f32 v64, v64, v65
v_mfma_f32_16x16x32_bf16 v[80:83], a[88:91], v[224:227], v[80:83]
s_waitcnt lgkmcnt(6)
ds_read_b64_tr_b16 a[108:109], v119 offset:12288
v_cvt_pk_bf16_f32 v65, v66, v67
v_mfma_f32_16x16x32_bf16 v[80:83], a[92:95], v[240:243], v[80:83]
ds_read_b64_tr_b16 a[110:111], v119 offset:14336
v_cvt_pk_bf16_f32 v66, v72, v73
v_mfma_f32_16x16x32_bf16 v[84:87], a[64:67], v[132:135], 0
ds_read_b64_tr_b16 a[112:113], v119 offset:16384
v_cvt_pk_bf16_f32 v67, v74, v75
v_mfma_f32_16x16x32_bf16 v[84:87], a[68:71], v[148:151], v[84:87]
ds_read_b64_tr_b16 a[114:115], v119 offset:18432
buffer_store_dwordx4 v[64:67], v1, s[4:7], s8 offen offset:2048 sc1
v_mfma_f32_16x16x32_bf16 v[84:87], a[72:75], v[164:167], v[84:87]
ds_read_b64_tr_b16 a[116:117], v119 offset:20480
v_mul_f32 v68, v68, v25
v_mfma_f32_16x16x32_bf16 v[84:87], a[76:79], v[180:183], v[84:87]
ds_read_b64_tr_b16 a[118:119], v119 offset:22528
v_mul_f32 v69, v69, v25
v_mfma_f32_16x16x32_bf16 v[84:87], a[80:83], v[196:199], v[84:87]
ds_read_b64_tr_b16 a[120:121], v119 offset:24576
v_mul_f32 v70, v70, v25
v_mfma_f32_16x16x32_bf16 v[84:87], a[84:87], v[212:215], v[84:87]
ds_read_b64_tr_b16 a[122:123], v119 offset:26624
v_mul_f32 v71, v71, v25
v_mfma_f32_16x16x32_bf16 v[84:87], a[88:91], v[228:231], v[84:87]
ds_read_b64_tr_b16 a[124:125], v119 offset:28672
ds_read_b64_tr_b16 a[126:127], v119 offset:30720
v_mfma_f32_16x16x32_bf16 v[84:87], a[92:95], v[244:247], v[84:87]
s_waitcnt vmcnt(7) lgkmcnt(9)
s_barrier
v_add_u32 v119, 65536, v119
v_mfma_f32_16x16x32_bf16 v[88:91], a[96:99], v[128:131], 0
ds_read_b64_tr_b16 a[64:65], v116 offset:0
v_mul_f32 v76, v76, v25
v_mfma_f32_16x16x32_bf16 v[88:91], a[100:103], v[144:147], v[88:91]
ds_read_b64_tr_b16 a[66:67], v116 offset:2048
buffer_store_dword v6, v5, s[4:7], s34 offen sc1
v_mfma_f32_16x16x32_bf16 v[88:91], a[104:107], v[160:163], v[88:91]
s_waitcnt lgkmcnt(8)
ds_read_b64_tr_b16 a[68:69], v116 offset:4096
v_mul_f32 v77, v77, v25
v_mfma_f32_16x16x32_bf16 v[88:91], a[108:111], v[176:179], v[88:91]
ds_read_b64_tr_b16 a[70:71], v116 offset:6144
v_mul_f32 v78, v78, v25
v_mfma_f32_16x16x32_bf16 v[88:91], a[112:115], v[192:195], v[88:91]
s_waitcnt lgkmcnt(8)
ds_read_b64_tr_b16 a[72:73], v116 offset:8192
v_mul_f32 v79, v79, v25
v_mfma_f32_16x16x32_bf16 v[88:91], a[116:119], v[208:211], v[88:91]
s_waitcnt lgkmcnt(7)
ds_read_b64_tr_b16 a[74:75], v116 offset:10240
v_cvt_pk_bf16_f32 v68, v68, v69
v_mfma_f32_16x16x32_bf16 v[88:91], a[120:123], v[224:227], v[88:91]
s_waitcnt lgkmcnt(6)
ds_read_b64_tr_b16 a[76:77], v116 offset:12288
v_cvt_pk_bf16_f32 v69, v70, v71
v_mfma_f32_16x16x32_bf16 v[88:91], a[124:127], v[240:243], v[88:91]
ds_read_b64_tr_b16 a[78:79], v116 offset:14336
v_cvt_pk_bf16_f32 v70, v76, v77
v_mfma_f32_16x16x32_bf16 v[92:95], a[96:99], v[132:135], 0
ds_read_b64_tr_b16 a[80:81], v116 offset:16384
v_cvt_pk_bf16_f32 v71, v78, v79
v_mfma_f32_16x16x32_bf16 v[92:95], a[100:103], v[148:151], v[92:95]
ds_read_b64_tr_b16 a[82:83], v116 offset:18432
buffer_store_dwordx4 v[68:71], v1, s[4:7], s12 offen offset:2048 sc1
v_mfma_f32_16x16x32_bf16 v[92:95], a[104:107], v[164:167], v[92:95]
ds_read_b64_tr_b16 a[84:85], v116 offset:20480
v_lshlrev_b32 v19, 2, v19
v_mfma_f32_16x16x32_bf16 v[92:95], a[108:111], v[180:183], v[92:95]
ds_read_b64_tr_b16 a[86:87], v116 offset:22528
v_mfma_f32_16x16x32_bf16 v[92:95], a[112:115], v[196:199], v[92:95]
ds_read_b64_tr_b16 a[88:89], v116 offset:24576
v_mfma_f32_16x16x32_bf16 v[92:95], a[116:119], v[212:215], v[92:95]
ds_read_b64_tr_b16 a[90:91], v116 offset:26624
v_mfma_f32_16x16x32_bf16 v[92:95], a[120:123], v[228:231], v[92:95]
ds_read_b64_tr_b16 a[92:93], v116 offset:28672
v_mfma_f32_16x16x32_bf16 v[92:95], a[124:127], v[244:247], v[92:95]
s_waitcnt lgkmcnt(8)
ds_read_b64_tr_b16 a[94:95], v116 offset:30720
v_mfma_f32_16x16x32_bf16 v[32:35], a[64:67], v[128:131], 0
ds_read_b64_tr_b16 a[96:97], v117 offset:0
v_mul_f32 v80, v80, v24
v_mfma_f32_16x16x32_bf16 v[32:35], a[68:71], v[144:147], v[32:35]
ds_read_b64_tr_b16 a[98:99], v117 offset:2048
v_mul_f32 v81, v81, v24
v_mfma_f32_16x16x32_bf16 v[32:35], a[72:75], v[160:163], v[32:35]
s_waitcnt lgkmcnt(8)
ds_read_b64_tr_b16 a[100:101], v117 offset:4096
v_mul_f32 v82, v82, v24
v_mfma_f32_16x16x32_bf16 v[32:35], a[76:79], v[176:179], v[32:35]
ds_read_b64_tr_b16 a[102:103], v117 offset:6144
v_mul_f32 v83, v83, v24
v_mfma_f32_16x16x32_bf16 v[32:35], a[80:83], v[192:195], v[32:35]
s_waitcnt lgkmcnt(8)
ds_read_b64_tr_b16 a[104:105], v117 offset:8192
v_mul_f32 v88, v88, v24
v_mfma_f32_16x16x32_bf16 v[32:35], a[84:87], v[208:211], v[32:35]
s_waitcnt lgkmcnt(7)
ds_read_b64_tr_b16 a[106:107], v117 offset:10240
v_mul_f32 v89, v89, v24
v_mfma_f32_16x16x32_bf16 v[32:35], a[88:91], v[224:227], v[32:35]
s_waitcnt lgkmcnt(6)
ds_read_b64_tr_b16 a[108:109], v117 offset:12288
v_mul_f32 v90, v90, v24
v_mfma_f32_16x16x32_bf16 v[32:35], a[92:95], v[240:243], v[32:35]
ds_read_b64_tr_b16 a[110:111], v117 offset:14336
v_mul_f32 v91, v91, v24
v_mfma_f32_16x16x32_bf16 v[36:39], a[64:67], v[132:135], 0
ds_read_b64_tr_b16 a[112:113], v117 offset:16384
v_cvt_pk_bf16_f32 v80, v80, v81
v_mfma_f32_16x16x32_bf16 v[36:39], a[68:71], v[148:151], v[36:39]
ds_read_b64_tr_b16 a[114:115], v117 offset:18432
v_cvt_pk_bf16_f32 v81, v82, v83
v_mfma_f32_16x16x32_bf16 v[36:39], a[72:75], v[164:167], v[36:39]
ds_read_b64_tr_b16 a[116:117], v117 offset:20480
v_cvt_pk_bf16_f32 v82, v88, v89
v_mfma_f32_16x16x32_bf16 v[36:39], a[76:79], v[180:183], v[36:39]
ds_read_b64_tr_b16 a[118:119], v117 offset:22528
v_cvt_pk_bf16_f32 v83, v90, v91
v_mfma_f32_16x16x32_bf16 v[36:39], a[80:83], v[196:199], v[36:39]
ds_read_b64_tr_b16 a[120:121], v117 offset:24576
buffer_store_dwordx4 v[80:83], v1, s[4:7], s8 offen offset:3072 sc1
v_mfma_f32_16x16x32_bf16 v[36:39], a[84:87], v[212:215], v[36:39]
ds_read_b64_tr_b16 a[122:123], v117 offset:26624
v_mul_f32 v84, v84, v25
v_mfma_f32_16x16x32_bf16 v[36:39], a[88:91], v[228:231], v[36:39]
ds_read_b64_tr_b16 a[124:125], v117 offset:28672
v_mul_f32 v85, v85, v25
v_mfma_f32_16x16x32_bf16 v[36:39], a[92:95], v[244:247], v[36:39]
s_waitcnt lgkmcnt(8)
ds_read_b64_tr_b16 a[126:127], v117 offset:30720
v_mul_f32 v86, v86, v25
v_mfma_f32_16x16x32_bf16 v[40:43], a[96:99], v[128:131], 0
ds_read_b64_tr_b16 a[64:65], v118 offset:0
v_mul_f32 v87, v87, v25
v_mfma_f32_16x16x32_bf16 v[40:43], a[100:103], v[144:147], v[40:43]
ds_read_b64_tr_b16 a[66:67], v118 offset:2048
v_mul_f32 v92, v92, v25
v_mfma_f32_16x16x32_bf16 v[40:43], a[104:107], v[160:163], v[40:43]
s_waitcnt lgkmcnt(8)
ds_read_b64_tr_b16 a[68:69], v118 offset:4096
v_mul_f32 v93, v93, v25
v_mfma_f32_16x16x32_bf16 v[40:43], a[108:111], v[176:179], v[40:43]
ds_read_b64_tr_b16 a[70:71], v118 offset:6144
v_mul_f32 v94, v94, v25
v_mfma_f32_16x16x32_bf16 v[40:43], a[112:115], v[192:195], v[40:43]
s_waitcnt lgkmcnt(8)
ds_read_b64_tr_b16 a[72:73], v118 offset:8192
v_mul_f32 v95, v95, v25
v_mfma_f32_16x16x32_bf16 v[40:43], a[116:119], v[208:211], v[40:43]
s_waitcnt lgkmcnt(7)
ds_read_b64_tr_b16 a[74:75], v118 offset:10240
v_cvt_pk_bf16_f32 v84, v84, v85
v_mfma_f32_16x16x32_bf16 v[40:43], a[120:123], v[224:227], v[40:43]
s_waitcnt lgkmcnt(6)
ds_read_b64_tr_b16 a[76:77], v118 offset:12288
v_cvt_pk_bf16_f32 v85, v86, v87
v_mfma_f32_16x16x32_bf16 v[40:43], a[124:127], v[240:243], v[40:43]
ds_read_b64_tr_b16 a[78:79], v118 offset:14336
v_cvt_pk_bf16_f32 v86, v92, v93
v_mfma_f32_16x16x32_bf16 v[44:47], a[96:99], v[132:135], 0
ds_read_b64_tr_b16 a[80:81], v118 offset:16384
v_cvt_pk_bf16_f32 v87, v94, v95
v_mfma_f32_16x16x32_bf16 v[44:47], a[100:103], v[148:151], v[44:47]
ds_read_b64_tr_b16 a[82:83], v118 offset:18432
buffer_store_dwordx4 v[84:87], v1, s[4:7], s12 offen offset:3072 sc1
v_mfma_f32_16x16x32_bf16 v[44:47], a[104:107], v[164:167], v[44:47]
s_add_u32 s8, s8, 4096
s_add_u32 s12, s12, 4096
ds_read_b64_tr_b16 a[84:85], v118 offset:20480
v_mfma_f32_16x16x32_bf16 v[44:47], a[108:111], v[180:183], v[44:47]
ds_read_b64_tr_b16 a[86:87], v118 offset:22528
v_lshrrev_b32 v22, 4, v20
v_mfma_f32_16x16x32_bf16 v[44:47], a[112:115], v[196:199], v[44:47]
ds_read_b64_tr_b16 a[88:89], v118 offset:24576
v_mul_f32 v32, v32, v24
v_mfma_f32_16x16x32_bf16 v[44:47], a[116:119], v[212:215], v[44:47]
ds_read_b64_tr_b16 a[90:91], v118 offset:26624
v_mul_f32 v33, v33, v24
v_mfma_f32_16x16x32_bf16 v[44:47], a[120:123], v[228:231], v[44:47]
ds_read_b64_tr_b16 a[92:93], v118 offset:28672
v_mul_f32 v34, v34, v24
v_mfma_f32_16x16x32_bf16 v[44:47], a[124:127], v[244:247], v[44:47]
s_waitcnt lgkmcnt(8)
ds_read_b64_tr_b16 a[94:95], v118 offset:30720
v_mul_f32 v35, v35, v24
v_mfma_f32_16x16x32_bf16 v[48:51], a[64:67], v[128:131], 0
ds_read_b64_tr_b16 a[96:97], v119 offset:0
v_mul_f32 v40, v40, v24
v_mfma_f32_16x16x32_bf16 v[48:51], a[68:71], v[144:147], v[48:51]
ds_read_b64_tr_b16 a[98:99], v119 offset:2048
v_mul_f32 v41, v41, v24
v_mfma_f32_16x16x32_bf16 v[48:51], a[72:75], v[160:163], v[48:51]
s_waitcnt lgkmcnt(8)
ds_read_b64_tr_b16 a[100:101], v119 offset:4096
v_mul_f32 v42, v42, v24
v_mfma_f32_16x16x32_bf16 v[48:51], a[76:79], v[176:179], v[48:51]
ds_read_b64_tr_b16 a[102:103], v119 offset:6144
v_mul_f32 v43, v43, v24
v_mfma_f32_16x16x32_bf16 v[48:51], a[80:83], v[192:195], v[48:51]
s_waitcnt lgkmcnt(8)
ds_read_b64_tr_b16 a[104:105], v119 offset:8192
v_cvt_pk_bf16_f32 v32, v32, v33
v_mfma_f32_16x16x32_bf16 v[48:51], a[84:87], v[208:211], v[48:51]
s_waitcnt lgkmcnt(7)
ds_read_b64_tr_b16 a[106:107], v119 offset:10240
v_cvt_pk_bf16_f32 v33, v34, v35
v_mfma_f32_16x16x32_bf16 v[48:51], a[88:91], v[224:227], v[48:51]
s_waitcnt lgkmcnt(6)
ds_read_b64_tr_b16 a[108:109], v119 offset:12288
v_cvt_pk_bf16_f32 v34, v40, v41
v_mfma_f32_16x16x32_bf16 v[48:51], a[92:95], v[240:243], v[48:51]
ds_read_b64_tr_b16 a[110:111], v119 offset:14336
v_cvt_pk_bf16_f32 v35, v42, v43
v_mfma_f32_16x16x32_bf16 v[52:55], a[64:67], v[132:135], 0
ds_read_b64_tr_b16 a[112:113], v119 offset:16384
buffer_store_dwordx4 v[32:35], v1, s[4:7], s8 offen offset:0 sc1
v_mfma_f32_16x16x32_bf16 v[52:55], a[68:71], v[148:151], v[52:55]
ds_read_b64_tr_b16 a[114:115], v119 offset:18432
v_mul_f32 v36, v36, v25
v_mfma_f32_16x16x32_bf16 v[52:55], a[72:75], v[164:167], v[52:55]
ds_read_b64_tr_b16 a[116:117], v119 offset:20480
v_mul_f32 v37, v37, v25
v_mfma_f32_16x16x32_bf16 v[52:55], a[76:79], v[180:183], v[52:55]
ds_read_b64_tr_b16 a[118:119], v119 offset:22528
v_mul_f32 v38, v38, v25
v_mfma_f32_16x16x32_bf16 v[52:55], a[80:83], v[196:199], v[52:55]
ds_read_b64_tr_b16 a[120:121], v119 offset:24576
v_mul_f32 v39, v39, v25
v_mfma_f32_16x16x32_bf16 v[52:55], a[84:87], v[212:215], v[52:55]
ds_read_b64_tr_b16 a[122:123], v119 offset:26624
v_mul_f32 v44, v44, v25
v_mfma_f32_16x16x32_bf16 v[52:55], a[88:91], v[228:231], v[52:55]
ds_read_b64_tr_b16 a[124:125], v119 offset:28672
ds_read_b64_tr_b16 a[126:127], v119 offset:30720
v_mfma_f32_16x16x32_bf16 v[52:55], a[92:95], v[244:247], v[52:55]
s_waitcnt lgkmcnt(9)
v_mul_f32 v45, v45, v25
v_mul_f32 v46, v46, v25
v_mfma_f32_16x16x32_bf16 v[56:59], a[96:99], v[128:131], 0
v_mul_f32 v47, v47, v25
v_cvt_pk_bf16_f32 v36, v36, v37
v_mfma_f32_16x16x32_bf16 v[56:59], a[100:103], v[144:147], v[56:59]
v_cvt_pk_bf16_f32 v37, v38, v39
v_cvt_pk_bf16_f32 v38, v44, v45
v_mfma_f32_16x16x32_bf16 v[56:59], a[104:107], v[160:163], v[56:59]
s_waitcnt lgkmcnt(6)
v_cvt_pk_bf16_f32 v39, v46, v47
v_lshl_add_u32 v21, v22, 3, v21
v_mfma_f32_16x16x32_bf16 v[56:59], a[108:111], v[176:179], v[56:59]
buffer_store_dwordx4 v[36:39], v1, s[4:7], s12 offen offset:0 sc1
v_mfma_f32_16x16x32_bf16 v[56:59], a[112:115], v[192:195], v[56:59]
s_waitcnt lgkmcnt(4)
v_mfma_f32_16x16x32_bf16 v[56:59], a[116:119], v[208:211], v[56:59]
s_waitcnt lgkmcnt(2)
v_mfma_f32_16x16x32_bf16 v[56:59], a[120:123], v[224:227], v[56:59]
s_waitcnt lgkmcnt(0)
v_mfma_f32_16x16x32_bf16 v[56:59], a[124:127], v[240:243], v[56:59]
v_mfma_f32_16x16x32_bf16 v[60:63], a[96:99], v[132:135], 0
v_mfma_f32_16x16x32_bf16 v[60:63], a[100:103], v[148:151], v[60:63]
v_mfma_f32_16x16x32_bf16 v[60:63], a[104:107], v[164:167], v[60:63]
v_mfma_f32_16x16x32_bf16 v[60:63], a[108:111], v[180:183], v[60:63]
v_mfma_f32_16x16x32_bf16 v[60:63], a[112:115], v[196:199], v[60:63]
buffer_load_dword v18, v19, s[4:7], s33 offen offset:0 sc1
v_mfma_f32_16x16x32_bf16 v[60:63], a[116:119], v[212:215], v[60:63]
v_mfma_f32_16x16x32_bf16 v[60:63], a[120:123], v[228:231], v[60:63]
v_mfma_f32_16x16x32_bf16 v[60:63], a[124:127], v[244:247], v[60:63]
v_mul_f32 v48, v48, v24
v_mul_f32 v49, v49, v24
v_mul_f32 v50, v50, v24
v_mul_f32 v51, v51, v24
v_mul_f32 v56, v56, v24
v_mul_f32 v57, v57, v24
v_mul_f32 v58, v58, v24
v_mul_f32 v59, v59, v24
v_cvt_pk_bf16_f32 v48, v48, v49
v_cvt_pk_bf16_f32 v49, v50, v51
v_cvt_pk_bf16_f32 v50, v56, v57
v_cvt_pk_bf16_f32 v51, v58, v59
buffer_store_dwordx4 v[48:51], v1, s[4:7], s8 offen offset:1024 sc1
v_mul_f32 v52, v52, v25
v_mul_f32 v53, v53, v25
v_mul_f32 v54, v54, v25
v_mul_f32 v55, v55, v25
v_mul_f32 v60, v60, v25
v_mul_f32 v61, v61, v25
v_mul_f32 v62, v62, v25
v_mul_f32 v63, v63, v25
v_cvt_pk_bf16_f32 v52, v52, v53
v_cvt_pk_bf16_f32 v53, v54, v55
v_cvt_pk_bf16_f32 v54, v60, v61
v_cvt_pk_bf16_f32 v55, v62, v63
buffer_store_dwordx4 v[52:55], v1, s[4:7], s12 offen offset:1024 sc1
s_and_b32 s22, s2, 224
s_cmp_eq_u32 s22, 224
s_cbranch_scc1 M_final
s_waitcnt vmcnt(0)
s_barrier
buffer_store_dword v6, v5, s[4:7], s35 offen sc1
s_bitcmp0_b32 s2, 4
s_cbranch_scc1 M_rA
v_cmp_gt_u32 vcc, 1, v18
s_cbranch_vccnz M_rslow
M_rjoin:
buffer_load_dwordx4 v[128:131], v1, s[4:7], s26 offen sc1
s_add_u32 s26, s26, 14336
buffer_load_dwordx4 v[132:135], v1, s[4:7], s26 offen sc1
s_add_u32 s26, s26, 14336
buffer_load_dwordx4 v[136:139], v1, s[4:7], s26 offen sc1
s_add_u32 s26, s26, 14336
buffer_load_dwordx4 v[140:143], v1, s[4:7], s26 offen sc1
s_add_u32 s26, s26, 14336
buffer_load_dwordx4 v[144:147], v1, s[4:7], s26 offen sc1
s_add_u32 s26, s26, 14336
buffer_load_dwordx4 v[148:151], v1, s[4:7], s26 offen sc1
s_add_u32 s26, s26, 14336
buffer_load_dwordx4 v[152:155], v1, s[4:7], s26 offen sc1
s_add_u32 s26, s26, 14336
buffer_load_dwordx4 v[156:159], v1, s[4:7], s26 offen sc1
s_add_u32 s26, s26, 14336
buffer_load_dwordx4 v[160:163], v1, s[4:7], s26 offen sc1
s_add_u32 s26, s26, 14336
buffer_load_dwordx4 v[164:167], v1, s[4:7], s26 offen sc1
s_add_u32 s26, s26, 14336
buffer_load_dwordx4 v[168:171], v1, s[4:7], s26 offen sc1
s_add_u32 s26, s26, 14336
buffer_load_dwordx4 v[172:175], v1, s[4:7], s26 offen sc1
s_add_u32 s26, s26, 14336
buffer_load_dwordx4 v[176:179], v1, s[4:7], s26 offen sc1
s_add_u32 s26, s26, 14336
buffer_load_dwordx4 v[180:183], v1, s[4:7], s26 offen sc1
s_add_u32 s26, s26, 14336
buffer_load_dwordx4 v[184:187], v1, s[4:7], s26 offen sc1
s_add_u32 s26, s26, 14336
buffer_load_dwordx4 v[188:191], v1, s[4:7], s26 offen sc1
Lp_9201:
buffer_load_dword v18, v19, s[4:7], s33 offen offset:2048 sc1
s_waitcnt vmcnt(0)
v_cmp_gt_u32 vcc, 1, v18
s_cbranch_vccz Lpd_9202
s_sleep 8
s_sub_u32 s101, s101, 1
s_cbranch_scc0 Lp_9201
s_mov_b32 s101, 0
Lpd_9202:
s_sub_u32 s26, s26, 207872
buffer_load_dwordx4 v[192:195], v1, s[4:7], s26 offen sc1
s_add_u32 s26, s26, 14336
buffer_load_dwordx4 v[196:199], v1, s[4:7], s26 offen sc1
s_add_u32 s26, s26, 14336
buffer_load_dwordx4 v[200:203], v1, s[4:7], s26 offen sc1
s_add_u32 s26, s26, 14336
buffer_load_dwordx4 v[204:207], v1, s[4:7], s26 offen sc1
s_add_u32 s26, s26, 14336
buffer_load_dwordx4 v[208:211], v1, s[4:7], s26 offen sc1
s_add_u32 s26, s26, 14336
buffer_load_dwordx4 v[212:215], v1, s[4:7], s26 offen sc1
s_add_u32 s26, s26, 14336
buffer_load_dwordx4 v[216:219], v1, s[4:7], s26 offen sc1
s_add_u32 s26, s26, 14336
buffer_load_dwordx4 v[220:223], v1, s[4:7], s26 offen sc1
s_add_u32 s26, s26, 14336
buffer_load_dwordx4 v[224:227], v1, s[4:7], s26 offen sc1
s_add_u32 s26, s26, 14336
buffer_load_dwordx4 v[228:231], v1, s[4:7], s26 offen sc1
s_add_u32 s26, s26, 14336
buffer_load_dwordx4 v[232:235], v1, s[4:7], s26 offen sc1
s_add_u32 s26, s26, 14336
buffer_load_dwordx4 v[236:239], v1, s[4:7], s26 offen sc1
s_add_u32 s26, s26, 14336
buffer_load_dwordx4 v[240:243], v1, s[4:7], s26 offen sc1
s_add_u32 s26, s26, 14336
buffer_load_dwordx4 v[244:247], v1, s[4:7], s26 offen sc1
s_add_u32 s26, s26, 14336
buffer_load_dwordx4 v[248:251], v1, s[4:7], s26 offen sc1
s_add_u32 s26, s26, 14336
buffer_load_dwordx4 v[252:255], v1, s[4:7], s26 offen sc1
v_lshlrev_b32 v96, 16, v128
v_and_b32 v97, 0xffff0000, v128
v_lshlrev_b32 v98, 16, v129
v_and_b32 v99, 0xffff0000, v129
v_lshlrev_b32 v100, 16, v130
v_and_b32 v101, 0xffff0000, v130
v_lshlrev_b32 v102, 16, v131
v_and_b32 v103, 0xffff0000, v131
v_lshlrev_b32 v10, 16, v132
v_and_b32 v11, 0xffff0000, v132
v_lshlrev_b32 v12, 16, v133
v_and_b32 v13, 0xffff0000, v133
v_lshlrev_b32 v14, 16, v134
v_and_b32 v15, 0xffff0000, v134
v_lshlrev_b32 v16, 16, v135
v_and_b32 v17, 0xffff0000, v135
v_pk_add_f32 v[96:97], v[96:97], v[10:11]
v_pk_add_f32 v[98:99], v[98:99], v[12:13]
v_pk_add_f32 v[100:101], v[100:101], v[14:15]
v_pk_add_f32 v[102:103], v[102:103], v[16:17]
v_lshlrev_b32 v10, 16, v136
v_and_b32 v11, 0xffff0000, v136
v_lshlrev_b32 v12, 16, v137
v_and_b32 v13, 0xffff0000, v137
v_lshlrev_b32 v14, 16, v138
v_and_b32 v15, 0xffff0000, v138
v_lshlrev_b32 v16, 16, v139
v_and_b32 v17, 0xffff0000, v139
v_pk_add_f32 v[96:97], v[96:97], v[10:11]
v_pk_add_f32 v[98:99], v[98:99], v[12:13]
v_pk_add_f32 v[100:101], v[100:101], v[14:15]
v_pk_add_f32 v[102:103], v[102:103], v[16:17]
v_lshlrev_b32 v10, 16, v140
v_and_b32 v11, 0xffff0000, v140
v_lshlrev_b32 v12, 16, v141
v_and_b32 v13, 0xffff0000, v141
v_lshlrev_b32 v14, 16, v142
v_and_b32 v15, 0xffff0000, v142
v_lshlrev_b32 v16, 16, v143
v_and_b32 v17, 0xffff0000, v143
v_pk_add_f32 v[96:97], v[96:97], v[10:11]
v_pk_add_f32 v[98:99], v[98:99], v[12:13]
v_pk_add_f32 v[100:101], v[100:101], v[14:15]
v_pk_add_f32 v[102:103], v[102:103], v[16:17]
v_lshlrev_b32 v10, 16, v144
v_and_b32 v11, 0xffff0000, v144
v_lshlrev_b32 v12, 16, v145
v_and_b32 v13, 0xffff0000, v145
v_lshlrev_b32 v14, 16, v146
v_and_b32 v15, 0xffff0000, v146
v_lshlrev_b32 v16, 16, v147
v_and_b32 v17, 0xffff0000, v147
v_pk_add_f32 v[96:97], v[96:97], v[10:11]
v_pk_add_f32 v[98:99], v[98:99], v[12:13]
v_pk_add_f32 v[100:101], v[100:101], v[14:15]
v_pk_add_f32 v[102:103], v[102:103], v[16:17]
v_lshlrev_b32 v10, 16, v148
v_and_b32 v11, 0xffff0000, v148
v_lshlrev_b32 v12, 16, v149
v_and_b32 v13, 0xffff0000, v149
v_lshlrev_b32 v14, 16, v150
v_and_b32 v15, 0xffff0000, v150
v_lshlrev_b32 v16, 16, v151
v_and_b32 v17, 0xffff0000, v151
v_pk_add_f32 v[96:97], v[96:97], v[10:11]
v_pk_add_f32 v[98:99], v[98:99], v[12:13]
v_pk_add_f32 v[100:101], v[100:101], v[14:15]
v_pk_add_f32 v[102:103], v[102:103], v[16:17]
v_lshlrev_b32 v10, 16, v152
v_and_b32 v11, 0xffff0000, v152
v_lshlrev_b32 v12, 16, v153
v_and_b32 v13, 0xffff0000, v153
v_lshlrev_b32 v14, 16, v154
v_and_b32 v15, 0xffff0000, v154
v_lshlrev_b32 v16, 16, v155
v_and_b32 v17, 0xffff0000, v155
v_pk_add_f32 v[96:97], v[96:97], v[10:11]
v_pk_add_f32 v[98:99], v[98:99], v[12:13]
v_pk_add_f32 v[100:101], v[100:101], v[14:15]
v_pk_add_f32 v[102:103], v[102:103], v[16:17]
v_lshlrev_b32 v10, 16, v156
v_and_b32 v11, 0xffff0000, v156
v_lshlrev_b32 v12, 16, v157
v_and_b32 v13, 0xffff0000, v157
v_lshlrev_b32 v14, 16, v158
v_and_b32 v15, 0xffff0000, v158
v_lshlrev_b32 v16, 16, v159
v_and_b32 v17, 0xffff0000, v159
v_pk_add_f32 v[96:97], v[96:97], v[10:11]
v_pk_add_f32 v[98:99], v[98:99], v[12:13]
v_pk_add_f32 v[100:101], v[100:101], v[14:15]
v_pk_add_f32 v[102:103], v[102:103], v[16:17]
v_lshlrev_b32 v10, 16, v160
v_and_b32 v11, 0xffff0000, v160
v_lshlrev_b32 v12, 16, v161
v_and_b32 v13, 0xffff0000, v161
v_lshlrev_b32 v14, 16, v162
v_and_b32 v15, 0xffff0000, v162
v_lshlrev_b32 v16, 16, v163
v_and_b32 v17, 0xffff0000, v163
v_pk_add_f32 v[96:97], v[96:97], v[10:11]
v_pk_add_f32 v[98:99], v[98:99], v[12:13]
v_pk_add_f32 v[100:101], v[100:101], v[14:15]
v_pk_add_f32 v[102:103], v[102:103], v[16:17]
v_lshlrev_b32 v10, 16, v164
v_and_b32 v11, 0xffff0000, v164
v_lshlrev_b32 v12, 16, v165
v_and_b32 v13, 0xffff0000, v165
v_lshlrev_b32 v14, 16, v166
v_and_b32 v15, 0xffff0000, v166
v_lshlrev_b32 v16, 16, v167
v_and_b32 v17, 0xffff0000, v167
v_pk_add_f32 v[96:97], v[96:97], v[10:11]
v_pk_add_f32 v[98:99], v[98:99], v[12:13]
v_pk_add_f32 v[100:101], v[100:101], v[14:15]
v_pk_add_f32 v[102:103], v[102:103], v[16:17]
v_lshlrev_b32 v10, 16, v168
v_and_b32 v11, 0xffff0000, v168
v_lshlrev_b32 v12, 16, v169
v_and_b32 v13, 0xffff0000, v169
v_lshlrev_b32 v14, 16, v170
v_and_b32 v15, 0xffff0000, v170
v_lshlrev_b32 v16, 16, v171
v_and_b32 v17, 0xffff0000, v171
v_pk_add_f32 v[96:97], v[96:97], v[10:11]
v_pk_add_f32 v[98:99], v[98:99], v[12:13]
v_pk_add_f32 v[100:101], v[100:101], v[14:15]
v_pk_add_f32 v[102:103], v[102:103], v[16:17]
v_lshlrev_b32 v10, 16, v172
v_and_b32 v11, 0xffff0000, v172
v_lshlrev_b32 v12, 16, v173
v_and_b32 v13, 0xffff0000, v173
v_lshlrev_b32 v14, 16, v174
v_and_b32 v15, 0xffff0000, v174
v_lshlrev_b32 v16, 16, v175
v_and_b32 v17, 0xffff0000, v175
v_pk_add_f32 v[96:97], v[96:97], v[10:11]
v_pk_add_f32 v[98:99], v[98:99], v[12:13]
v_pk_add_f32 v[100:101], v[100:101], v[14:15]
v_pk_add_f32 v[102:103], v[102:103], v[16:17]
v_lshlrev_b32 v10, 16, v176
v_and_b32 v11, 0xffff0000, v176
v_lshlrev_b32 v12, 16, v177
v_and_b32 v13, 0xffff0000, v177
v_lshlrev_b32 v14, 16, v178
v_and_b32 v15, 0xffff0000, v178
v_lshlrev_b32 v16, 16, v179
v_and_b32 v17, 0xffff0000, v179
v_pk_add_f32 v[96:97], v[96:97], v[10:11]
v_pk_add_f32 v[98:99], v[98:99], v[12:13]
v_pk_add_f32 v[100:101], v[100:101], v[14:15]
v_pk_add_f32 v[102:103], v[102:103], v[16:17]
v_lshlrev_b32 v10, 16, v180
v_and_b32 v11, 0xffff0000, v180
v_lshlrev_b32 v12, 16, v181
v_and_b32 v13, 0xffff0000, v181
v_lshlrev_b32 v14, 16, v182
v_and_b32 v15, 0xffff0000, v182
v_lshlrev_b32 v16, 16, v183
v_and_b32 v17, 0xffff0000, v183
v_pk_add_f32 v[96:97], v[96:97], v[10:11]
v_pk_add_f32 v[98:99], v[98:99], v[12:13]
v_pk_add_f32 v[100:101], v[100:101], v[14:15]
v_pk_add_f32 v[102:103], v[102:103], v[16:17]
v_lshlrev_b32 v10, 16, v184
v_and_b32 v11, 0xffff0000, v184
v_lshlrev_b32 v12, 16, v185
v_and_b32 v13, 0xffff0000, v185
v_lshlrev_b32 v14, 16, v186
v_and_b32 v15, 0xffff0000, v186
v_lshlrev_b32 v16, 16, v187
v_and_b32 v17, 0xffff0000, v187
v_pk_add_f32 v[96:97], v[96:97], v[10:11]
v_pk_add_f32 v[98:99], v[98:99], v[12:13]
v_pk_add_f32 v[100:101], v[100:101], v[14:15]
v_pk_add_f32 v[102:103], v[102:103], v[16:17]
v_lshlrev_b32 v10, 16, v188
v_and_b32 v11, 0xffff0000, v188
v_lshlrev_b32 v12, 16, v189
v_and_b32 v13, 0xffff0000, v189
v_lshlrev_b32 v14, 16, v190
v_and_b32 v15, 0xffff0000, v190
v_lshlrev_b32 v16, 16, v191
v_and_b32 v17, 0xffff0000, v191
v_pk_add_f32 v[96:97], v[96:97], v[10:11]
v_pk_add_f32 v[98:99], v[98:99], v[12:13]
v_pk_add_f32 v[100:101], v[100:101], v[14:15]
v_pk_add_f32 v[102:103], v[102:103], v[16:17]
v_cvt_pk_bf16_f32 v96, v96, v97
v_cvt_pk_bf16_f32 v97, v98, v99
v_cvt_pk_bf16_f32 v98, v100, v101
v_cvt_pk_bf16_f32 v99, v102, v103
buffer_store_dwordx2 v[96:97], v21, s[40:43], s25 offen offset:896
buffer_store_dwordx2 v[98:99], v21, s[40:43], s25 offen offset:928
s_waitcnt vmcnt(17)
v_lshlrev_b32 v104, 16, v192
v_and_b32 v105, 0xffff0000, v192
v_lshlrev_b32 v106, 16, v193
v_and_b32 v107, 0xffff0000, v193
v_lshlrev_b32 v108, 16, v194
v_and_b32 v109, 0xffff0000, v194
v_lshlrev_b32 v110, 16, v195
v_and_b32 v111, 0xffff0000, v195
s_waitcnt vmcnt(16)
v_lshlrev_b32 v10, 16, v196
v_and_b32 v11, 0xffff0000, v196
v_lshlrev_b32 v12, 16, v197
v_and_b32 v13, 0xffff0000, v197
v_lshlrev_b32 v14, 16, v198
v_and_b32 v15, 0xffff0000, v198
v_lshlrev_b32 v16, 16, v199
v_and_b32 v17, 0xffff0000, v199
v_pk_add_f32 v[104:105], v[104:105], v[10:11]
v_pk_add_f32 v[106:107], v[106:107], v[12:13]
v_pk_add_f32 v[108:109], v[108:109], v[14:15]
v_pk_add_f32 v[110:111], v[110:111], v[16:17]
s_waitcnt vmcnt(15)
v_lshlrev_b32 v10, 16, v200
v_and_b32 v11, 0xffff0000, v200
v_lshlrev_b32 v12, 16, v201
PAD_17:
s_cbranch_execz M_tret
v_and_b32 v13, 0xffff0000, v201
v_lshlrev_b32 v14, 16, v202
v_and_b32 v15, 0xffff0000, v202
v_lshlrev_b32 v16, 16, v203
v_and_b32 v17, 0xffff0000, v203
v_pk_add_f32 v[104:105], v[104:105], v[10:11]
v_pk_add_f32 v[106:107], v[106:107], v[12:13]
v_pk_add_f32 v[108:109], v[108:109], v[14:15]
v_pk_add_f32 v[110:111], v[110:111], v[16:17]
s_waitcnt vmcnt(14)
v_lshlrev_b32 v10, 16, v204
v_and_b32 v11, 0xffff0000, v204
v_lshlrev_b32 v12, 16, v205
v_and_b32 v13, 0xffff0000, v205
v_lshlrev_b32 v14, 16, v206
v_and_b32 v15, 0xffff0000, v206
v_lshlrev_b32 v16, 16, v207
v_and_b32 v17, 0xffff0000, v207
v_pk_add_f32 v[104:105], v[104:105], v[10:11]
v_pk_add_f32 v[106:107], v[106:107], v[12:13]
v_pk_add_f32 v[108:109], v[108:109], v[14:15]
v_pk_add_f32 v[110:111], v[110:111], v[16:17]
s_waitcnt vmcnt(13)
v_lshlrev_b32 v10, 16, v208
v_and_b32 v11, 0xffff0000, v208
v_lshlrev_b32 v12, 16, v209
v_and_b32 v13, 0xffff0000, v209
v_lshlrev_b32 v14, 16, v210
v_and_b32 v15, 0xffff0000, v210
v_lshlrev_b32 v16, 16, v211
v_and_b32 v17, 0xffff0000, v211
v_pk_add_f32 v[104:105], v[104:105], v[10:11]
v_pk_add_f32 v[106:107], v[106:107], v[12:13]
v_pk_add_f32 v[108:109], v[108:109], v[14:15]
v_pk_add_f32 v[110:111], v[110:111], v[16:17]
s_waitcnt vmcnt(12)
v_lshlrev_b32 v10, 16, v212
v_and_b32 v11, 0xffff0000, v212
v_lshlrev_b32 v12, 16, v213
v_and_b32 v13, 0xffff0000, v213
v_lshlrev_b32 v14, 16, v214
v_and_b32 v15, 0xffff0000, v214
v_lshlrev_b32 v16, 16, v215
v_and_b32 v17, 0xffff0000, v215
v_pk_add_f32 v[104:105], v[104:105], v[10:11]
v_pk_add_f32 v[106:107], v[106:107], v[12:13]
v_pk_add_f32 v[108:109], v[108:109], v[14:15]
v_pk_add_f32 v[110:111], v[110:111], v[16:17]
s_waitcnt vmcnt(11)
v_lshlrev_b32 v10, 16, v216
v_and_b32 v11, 0xffff0000, v216
v_lshlrev_b32 v12, 16, v217
v_and_b32 v13, 0xffff0000, v217
v_lshlrev_b32 v14, 16, v218
v_and_b32 v15, 0xffff0000, v218
v_lshlrev_b32 v16, 16, v219
v_and_b32 v17, 0xffff0000, v219
v_pk_add_f32 v[104:105], v[104:105], v[10:11]
v_pk_add_f32 v[106:107], v[106:107], v[12:13]
v_pk_add_f32 v[108:109], v[108:109], v[14:15]
v_pk_add_f32 v[110:111], v[110:111], v[16:17]
s_waitcnt vmcnt(10)
v_lshlrev_b32 v10, 16, v220
v_and_b32 v11, 0xffff0000, v220
v_lshlrev_b32 v12, 16, v221
v_and_b32 v13, 0xffff0000, v221
v_lshlrev_b32 v14, 16, v222
v_and_b32 v15, 0xffff0000, v222
v_lshlrev_b32 v16, 16, v223
v_and_b32 v17, 0xffff0000, v223
v_pk_add_f32 v[104:105], v[104:105], v[10:11]
v_pk_add_f32 v[106:107], v[106:107], v[12:13]
v_pk_add_f32 v[108:109], v[108:109], v[14:15]
v_pk_add_f32 v[110:111], v[110:111], v[16:17]
s_waitcnt vmcnt(9)
v_lshlrev_b32 v10, 16, v224
v_and_b32 v11, 0xffff0000, v224
v_lshlrev_b32 v12, 16, v225
v_and_b32 v13, 0xffff0000, v225
v_lshlrev_b32 v14, 16, v226
v_and_b32 v15, 0xffff0000, v226
v_lshlrev_b32 v16, 16, v227
v_and_b32 v17, 0xffff0000, v227
v_pk_add_f32 v[104:105], v[104:105], v[10:11]
v_pk_add_f32 v[106:107], v[106:107], v[12:13]
v_pk_add_f32 v[108:109], v[108:109], v[14:15]
v_pk_add_f32 v[110:111], v[110:111], v[16:17]
s_waitcnt vmcnt(8)
v_lshlrev_b32 v10, 16, v228
v_and_b32 v11, 0xffff0000, v228
v_lshlrev_b32 v12, 16, v229
v_and_b32 v13, 0xffff0000, v229
v_lshlrev_b32 v14, 16, v230
v_and_b32 v15, 0xffff0000, v230
v_lshlrev_b32 v16, 16, v231
v_and_b32 v17, 0xffff0000, v231
v_pk_add_f32 v[104:105], v[104:105], v[10:11]
v_pk_add_f32 v[106:107], v[106:107], v[12:13]
v_pk_add_f32 v[108:109], v[108:109], v[14:15]
v_pk_add_f32 v[110:111], v[110:111], v[16:17]
s_waitcnt vmcnt(7)
v_lshlrev_b32 v10, 16, v232
v_and_b32 v11, 0xffff0000, v232
v_lshlrev_b32 v12, 16, v233
v_and_b32 v13, 0xffff0000, v233
v_lshlrev_b32 v14, 16, v234
v_and_b32 v15, 0xffff0000, v234
v_lshlrev_b32 v16, 16, v235
v_and_b32 v17, 0xffff0000, v235
v_pk_add_f32 v[104:105], v[104:105], v[10:11]
v_pk_add_f32 v[106:107], v[106:107], v[12:13]
v_pk_add_f32 v[108:109], v[108:109], v[14:15]
v_pk_add_f32 v[110:111], v[110:111], v[16:17]
s_waitcnt vmcnt(6)
v_lshlrev_b32 v10, 16, v236
v_and_b32 v11, 0xffff0000, v236
v_lshlrev_b32 v12, 16, v237
v_and_b32 v13, 0xffff0000, v237
v_lshlrev_b32 v14, 16, v238
v_and_b32 v15, 0xffff0000, v238
v_lshlrev_b32 v16, 16, v239
v_and_b32 v17, 0xffff0000, v239
v_pk_add_f32 v[104:105], v[104:105], v[10:11]
v_pk_add_f32 v[106:107], v[106:107], v[12:13]
v_pk_add_f32 v[108:109], v[108:109], v[14:15]
v_pk_add_f32 v[110:111], v[110:111], v[16:17]
s_waitcnt vmcnt(5)
v_lshlrev_b32 v10, 16, v240
v_and_b32 v11, 0xffff0000, v240
v_lshlrev_b32 v12, 16, v241
v_and_b32 v13, 0xffff0000, v241
v_lshlrev_b32 v14, 16, v242
v_and_b32 v15, 0xffff0000, v242
v_lshlrev_b32 v16, 16, v243
v_and_b32 v17, 0xffff0000, v243
v_pk_add_f32 v[104:105], v[104:105], v[10:11]
v_pk_add_f32 v[106:107], v[106:107], v[12:13]
v_pk_add_f32 v[108:109], v[108:109], v[14:15]
v_pk_add_f32 v[110:111], v[110:111], v[16:17]
s_waitcnt vmcnt(4)
v_lshlrev_b32 v10, 16, v244
v_and_b32 v11, 0xffff0000, v244
v_lshlrev_b32 v12, 16, v245
v_and_b32 v13, 0xffff0000, v245
v_lshlrev_b32 v14, 16, v246
v_and_b32 v15, 0xffff0000, v246
v_lshlrev_b32 v16, 16, v247
v_and_b32 v17, 0xffff0000, v247
v_pk_add_f32 v[104:105], v[104:105], v[10:11]
v_pk_add_f32 v[106:107], v[106:107], v[12:13]
v_pk_add_f32 v[108:109], v[108:109], v[14:15]
v_pk_add_f32 v[110:111], v[110:111], v[16:17]
s_waitcnt vmcnt(3)
v_lshlrev_b32 v10, 16, v248
v_and_b32 v11, 0xffff0000, v248
v_lshlrev_b32 v12, 16, v249
v_and_b32 v13, 0xffff0000, v249
v_lshlrev_b32 v14, 16, v250
v_and_b32 v15, 0xffff0000, v250
v_lshlrev_b32 v16, 16, v251
v_and_b32 v17, 0xffff0000, v251
v_pk_add_f32 v[104:105], v[104:105], v[10:11]
v_pk_add_f32 v[106:107], v[106:107], v[12:13]
v_pk_add_f32 v[108:109], v[108:109], v[14:15]
v_pk_add_f32 v[110:111], v[110:111], v[16:17]
s_waitcnt vmcnt(2)
v_lshlrev_b32 v10, 16, v252
v_and_b32 v11, 0xffff0000, v252
v_lshlrev_b32 v12, 16, v253
v_and_b32 v13, 0xffff0000, v253
v_lshlrev_b32 v14, 16, v254
v_and_b32 v15, 0xffff0000, v254
v_lshlrev_b32 v16, 16, v255
v_and_b32 v17, 0xffff0000, v255
v_pk_add_f32 v[104:105], v[104:105], v[10:11]
v_pk_add_f32 v[106:107], v[106:107], v[12:13]
v_pk_add_f32 v[108:109], v[108:109], v[14:15]
v_pk_add_f32 v[110:111], v[110:111], v[16:17]
v_cvt_pk_bf16_f32 v104, v104, v105
v_cvt_pk_bf16_f32 v105, v106, v107
v_cvt_pk_bf16_f32 v106, v108, v109
v_cvt_pk_bf16_f32 v107, v110, v111
buffer_store_dwordx2 v[104:105], v21, s[40:43], s25 offen offset:1344
buffer_store_dwordx2 v[106:107], v21, s[40:43], s25 offen offset:1376
s_add_u32 s25, s25, 1835008
s_add_u32 s26, s26, 14457856
s_add_u32 s33, s33, 1024
s_branch M_r1
PAD_18:
s_cbranch_execz M_tret
M_rA:
s_add_u32 s25, s25, 448
s_add_u32 s26, s26, 7168
s_add_u32 s33, s33, 2048
M_r1:
Lp_9203:
buffer_load_dword v18, v19, s[4:7], s33 offen offset:0 sc1
s_waitcnt vmcnt(0)
v_cmp_gt_u32 vcc, 1, v18
s_cbranch_vccz Lpd_9204
s_sleep 8
s_sub_u32 s101, s101, 1
s_cbranch_scc0 Lp_9203
s_mov_b32 s101, 0
Lpd_9204:
buffer_load_dwordx4 v[128:131], v1, s[4:7], s26 offen sc1
s_add_u32 s26, s26, 14336
buffer_load_dwordx4 v[132:135], v1, s[4:7], s26 offen sc1
s_add_u32 s26, s26, 14336
buffer_load_dwordx4 v[136:139], v1, s[4:7], s26 offen sc1
s_add_u32 s26, s26, 14336
buffer_load_dwordx4 v[140:143], v1, s[4:7], s26 offen sc1
s_add_u32 s26, s26, 14336
buffer_load_dwordx4 v[144:147], v1, s[4:7], s26 offen sc1
s_add_u32 s26, s26, 14336
buffer_load_dwordx4 v[148:151], v1, s[4:7], s26 offen sc1
s_add_u32 s26, s26, 14336
buffer_load_dwordx4 v[152:155], v1, s[4:7], s26 offen sc1
s_add_u32 s26, s26, 14336
buffer_load_dwordx4 v[156:159], v1, s[4:7], s26 offen sc1
s_add_u32 s26, s26, 14336
buffer_load_dwordx4 v[160:163], v1, s[4:7], s26 offen sc1
s_add_u32 s26, s26, 14336
buffer_load_dwordx4 v[164:167], v1, s[4:7], s26 offen sc1
s_add_u32 s26, s26, 14336
buffer_load_dwordx4 v[168:171], v1, s[4:7], s26 offen sc1
s_add_u32 s26, s26, 14336
buffer_load_dwordx4 v[172:175], v1, s[4:7], s26 offen sc1
s_add_u32 s26, s26, 14336
buffer_load_dwordx4 v[176:179], v1, s[4:7], s26 offen sc1
s_add_u32 s26, s26, 14336
buffer_load_dwordx4 v[180:183], v1, s[4:7], s26 offen sc1
s_add_u32 s26, s26, 14336
buffer_load_dwordx4 v[184:187], v1, s[4:7], s26 offen sc1
s_add_u32 s26, s26, 14336
buffer_load_dwordx4 v[188:191], v1, s[4:7], s26 offen sc1
s_waitcnt vmcnt(15)
v_lshlrev_b32 v96, 16, v128
v_and_b32 v97, 0xffff0000, v128
v_lshlrev_b32 v98, 16, v129
v_and_b32 v99, 0xffff0000, v129
v_lshlrev_b32 v100, 16, v130
v_and_b32 v101, 0xffff0000, v130
v_lshlrev_b32 v102, 16, v131
v_and_b32 v103, 0xffff0000, v131
s_waitcnt vmcnt(14)
v_lshlrev_b32 v10, 16, v132
v_and_b32 v11, 0xffff0000, v132
v_lshlrev_b32 v12, 16, v133
v_and_b32 v13, 0xffff0000, v133
v_lshlrev_b32 v14, 16, v134
v_and_b32 v15, 0xffff0000, v134
v_lshlrev_b32 v16, 16, v135
v_and_b32 v17, 0xffff0000, v135
v_pk_add_f32 v[96:97], v[96:97], v[10:11]
v_pk_add_f32 v[98:99], v[98:99], v[12:13]
v_pk_add_f32 v[100:101], v[100:101], v[14:15]
v_pk_add_f32 v[102:103], v[102:103], v[16:17]
s_waitcnt vmcnt(13)
v_lshlrev_b32 v10, 16, v136
v_and_b32 v11, 0xffff0000, v136
v_lshlrev_b32 v12, 16, v137
v_and_b32 v13, 0xffff0000, v137
v_lshlrev_b32 v14, 16, v138
v_and_b32 v15, 0xffff0000, v138
v_lshlrev_b32 v16, 16, v139
v_and_b32 v17, 0xffff0000, v139
v_pk_add_f32 v[96:97], v[96:97], v[10:11]
v_pk_add_f32 v[98:99], v[98:99], v[12:13]
v_pk_add_f32 v[100:101], v[100:101], v[14:15]
v_pk_add_f32 v[102:103], v[102:103], v[16:17]
s_waitcnt vmcnt(12)
v_lshlrev_b32 v10, 16, v140
v_and_b32 v11, 0xffff0000, v140
v_lshlrev_b32 v12, 16, v141
v_and_b32 v13, 0xffff0000, v141
v_lshlrev_b32 v14, 16, v142
v_and_b32 v15, 0xffff0000, v142
v_lshlrev_b32 v16, 16, v143
v_and_b32 v17, 0xffff0000, v143
v_pk_add_f32 v[96:97], v[96:97], v[10:11]
v_pk_add_f32 v[98:99], v[98:99], v[12:13]
v_pk_add_f32 v[100:101], v[100:101], v[14:15]
v_pk_add_f32 v[102:103], v[102:103], v[16:17]
s_waitcnt vmcnt(11)
v_lshlrev_b32 v10, 16, v144
v_and_b32 v11, 0xffff0000, v144
v_lshlrev_b32 v12, 16, v145
v_and_b32 v13, 0xffff0000, v145
v_lshlrev_b32 v14, 16, v146
v_and_b32 v15, 0xffff0000, v146
v_lshlrev_b32 v16, 16, v147
v_and_b32 v17, 0xffff0000, v147
v_pk_add_f32 v[96:97], v[96:97], v[10:11]
v_pk_add_f32 v[98:99], v[98:99], v[12:13]
v_pk_add_f32 v[100:101], v[100:101], v[14:15]
v_pk_add_f32 v[102:103], v[102:103], v[16:17]
s_waitcnt vmcnt(10)
v_lshlrev_b32 v10, 16, v148
v_and_b32 v11, 0xffff0000, v148
v_lshlrev_b32 v12, 16, v149
v_and_b32 v13, 0xffff0000, v149
v_lshlrev_b32 v14, 16, v150
v_and_b32 v15, 0xffff0000, v150
v_lshlrev_b32 v16, 16, v151
v_and_b32 v17, 0xffff0000, v151
v_pk_add_f32 v[96:97], v[96:97], v[10:11]
v_pk_add_f32 v[98:99], v[98:99], v[12:13]
v_pk_add_f32 v[100:101], v[100:101], v[14:15]
v_pk_add_f32 v[102:103], v[102:103], v[16:17]
s_waitcnt vmcnt(9)
v_lshlrev_b32 v10, 16, v152
v_and_b32 v11, 0xffff0000, v152
v_lshlrev_b32 v12, 16, v153
v_and_b32 v13, 0xffff0000, v153
v_lshlrev_b32 v14, 16, v154
v_and_b32 v15, 0xffff0000, v154
v_lshlrev_b32 v16, 16, v155
v_and_b32 v17, 0xffff0000, v155
v_pk_add_f32 v[96:97], v[96:97], v[10:11]
v_pk_add_f32 v[98:99], v[98:99], v[12:13]
v_pk_add_f32 v[100:101], v[100:101], v[14:15]
v_pk_add_f32 v[102:103], v[102:103], v[16:17]
s_waitcnt vmcnt(8)
v_lshlrev_b32 v10, 16, v156
v_and_b32 v11, 0xffff0000, v156
v_lshlrev_b32 v12, 16, v157
v_and_b32 v13, 0xffff0000, v157
v_lshlrev_b32 v14, 16, v158
v_and_b32 v15, 0xffff0000, v158
v_lshlrev_b32 v16, 16, v159
v_and_b32 v17, 0xffff0000, v159
v_pk_add_f32 v[96:97], v[96:97], v[10:11]
v_pk_add_f32 v[98:99], v[98:99], v[12:13]
v_pk_add_f32 v[100:101], v[100:101], v[14:15]
v_pk_add_f32 v[102:103], v[102:103], v[16:17]
s_waitcnt vmcnt(7)
v_lshlrev_b32 v10, 16, v160
v_and_b32 v11, 0xffff0000, v160
v_lshlrev_b32 v12, 16, v161
v_and_b32 v13, 0xffff0000, v161
v_lshlrev_b32 v14, 16, v162
v_and_b32 v15, 0xffff0000, v162
v_lshlrev_b32 v16, 16, v163
v_and_b32 v17, 0xffff0000, v163
v_pk_add_f32 v[96:97], v[96:97], v[10:11]
v_pk_add_f32 v[98:99], v[98:99], v[12:13]
v_pk_add_f32 v[100:101], v[100:101], v[14:15]
v_pk_add_f32 v[102:103], v[102:103], v[16:17]
s_waitcnt vmcnt(6)
v_lshlrev_b32 v10, 16, v164
v_and_b32 v11, 0xffff0000, v164
v_lshlrev_b32 v12, 16, v165
v_and_b32 v13, 0xffff0000, v165
v_lshlrev_b32 v14, 16, v166
v_and_b32 v15, 0xffff0000, v166
v_lshlrev_b32 v16, 16, v167
v_and_b32 v17, 0xffff0000, v167
v_pk_add_f32 v[96:97], v[96:97], v[10:11]
v_pk_add_f32 v[98:99], v[98:99], v[12:13]
v_pk_add_f32 v[100:101], v[100:101], v[14:15]
v_pk_add_f32 v[102:103], v[102:103], v[16:17]
s_waitcnt vmcnt(5)
v_lshlrev_b32 v10, 16, v168
v_and_b32 v11, 0xffff0000, v168
v_lshlrev_b32 v12, 16, v169
v_and_b32 v13, 0xffff0000, v169
v_lshlrev_b32 v14, 16, v170
v_and_b32 v15, 0xffff0000, v170
v_lshlrev_b32 v16, 16, v171
v_and_b32 v17, 0xffff0000, v171
v_pk_add_f32 v[96:97], v[96:97], v[10:11]
v_pk_add_f32 v[98:99], v[98:99], v[12:13]
v_pk_add_f32 v[100:101], v[100:101], v[14:15]
v_pk_add_f32 v[102:103], v[102:103], v[16:17]
s_waitcnt vmcnt(4)
v_lshlrev_b32 v10, 16, v172
v_and_b32 v11, 0xffff0000, v172
v_lshlrev_b32 v12, 16, v173
v_and_b32 v13, 0xffff0000, v173
v_lshlrev_b32 v14, 16, v174
v_and_b32 v15, 0xffff0000, v174
v_lshlrev_b32 v16, 16, v175
v_and_b32 v17, 0xffff0000, v175
v_pk_add_f32 v[96:97], v[96:97], v[10:11]
v_pk_add_f32 v[98:99], v[98:99], v[12:13]
v_pk_add_f32 v[100:101], v[100:101], v[14:15]
v_pk_add_f32 v[102:103], v[102:103], v[16:17]
s_waitcnt vmcnt(3)
v_lshlrev_b32 v10, 16, v176
v_and_b32 v11, 0xffff0000, v176
v_lshlrev_b32 v12, 16, v177
v_and_b32 v13, 0xffff0000, v177
v_lshlrev_b32 v14, 16, v178
v_and_b32 v15, 0xffff0000, v178
v_lshlrev_b32 v16, 16, v179
v_and_b32 v17, 0xffff0000, v179
v_pk_add_f32 v[96:97], v[96:97], v[10:11]
v_pk_add_f32 v[98:99], v[98:99], v[12:13]
v_pk_add_f32 v[100:101], v[100:101], v[14:15]
v_pk_add_f32 v[102:103], v[102:103], v[16:17]
s_waitcnt vmcnt(2)
v_lshlrev_b32 v10, 16, v180
v_and_b32 v11, 0xffff0000, v180
v_lshlrev_b32 v12, 16, v181
v_and_b32 v13, 0xffff0000, v181
v_lshlrev_b32 v14, 16, v182
v_and_b32 v15, 0xffff0000, v182
v_lshlrev_b32 v16, 16, v183
v_and_b32 v17, 0xffff0000, v183
v_pk_add_f32 v[96:97], v[96:97], v[10:11]
v_pk_add_f32 v[98:99], v[98:99], v[12:13]
v_pk_add_f32 v[100:101], v[100:101], v[14:15]
v_pk_add_f32 v[102:103], v[102:103], v[16:17]
s_waitcnt vmcnt(1)
v_lshlrev_b32 v10, 16, v184
v_and_b32 v11, 0xffff0000, v184
v_lshlrev_b32 v12, 16, v185
v_and_b32 v13, 0xffff0000, v185
v_lshlrev_b32 v14, 16, v186
v_and_b32 v15, 0xffff0000, v186
v_lshlrev_b32 v16, 16, v187
v_and_b32 v17, 0xffff0000, v187
v_pk_add_f32 v[96:97], v[96:97], v[10:11]
v_pk_add_f32 v[98:99], v[98:99], v[12:13]
v_pk_add_f32 v[100:101], v[100:101], v[14:15]
v_pk_add_f32 v[102:103], v[102:103], v[16:17]
s_waitcnt vmcnt(0)
v_lshlrev_b32 v10, 16, v188
v_and_b32 v11, 0xffff0000, v188
v_lshlrev_b32 v12, 16, v189
v_and_b32 v13, 0xffff0000, v189
v_lshlrev_b32 v14, 16, v190
v_and_b32 v15, 0xffff0000, v190
v_lshlrev_b32 v16, 16, v191
v_and_b32 v17, 0xffff0000, v191
v_pk_add_f32 v[96:97], v[96:97], v[10:11]
v_pk_add_f32 v[98:99], v[98:99], v[12:13]
v_pk_add_f32 v[100:101], v[100:101], v[14:15]
v_pk_add_f32 v[102:103], v[102:103], v[16:17]
v_cvt_pk_bf16_f32 v96, v96, v97
v_cvt_pk_bf16_f32 v97, v98, v99
v_cvt_pk_bf16_f32 v98, v100, v101
v_cvt_pk_bf16_f32 v99, v102, v103
buffer_store_dwordx2 v[96:97], v21, s[40:43], s25 offen offset:896
buffer_store_dwordx2 v[98:99], v21, s[40:43], s25 offen offset:928
M_fin:
s_endpgm
PAD_19:
s_cbranch_execz M_tret
M_final:
s_mov_b32 s8, s64
s_mov_b32 s9, s65
s_mov_b32 s10, 1835008
s_mov_b32 s11, 0x20000
s_mov_b32 s12, s88
s_mov_b32 s13, s89
s_mov_b32 s14, 3670016
s_mov_b32 s15, 0x20000
s_and_b32 s24, s2, 16
s_add_u32 s24, s24, s20
v_lshrrev_b32 v20, 4, v1
v_and_b32 v21, 15, v20
v_lshrrev_b32 v22, 4, v20
v_mul_u32_u24 v2, 896, v21
v_lshlrev_b32 v9, 1, v2
v_lshl_add_u32 v2, v22, 4, v2
v_lshl_add_u32 v9, v22, 4, v9
s_lshl_b32 s22, s24, 2
s_add_u32 s22, s22, s3
s_mul_i32 s25, s22, 14336
s_lshl_b32 s26, s25, 1
v_lshlrev_b32 v10, 5, v22
v_add3_u32 v10, v10, v21, 16
v_lshlrev_b32 v10, 2, v10
v_min_u32 v11, 380, v10
v_add_u32 v11, 512, v11
s_mov_b32 s27, 94384128
Lfp:
buffer_load_dword v3, v10, s[4:7], s27 offen sc1
buffer_load_dword v4, v11, s[4:7], s27 offen sc1
s_waitcnt vmcnt(0)
v_and_b32 v3, v3, v4
v_cmp_gt_u32 vcc, 1, v3
s_cbranch_vccz Lfpd
s_sleep 2
s_sub_u32 s101, s101, 1
s_cbranch_scc0 Lfp
s_mov_b32 s101, 0
Lfpd:
s_barrier
buffer_store_dword v6, v5, s[4:7], s35 offen sc1
Lfg:
v_lshrrev_b32 v3, 3, v20
v_and_b32 v4, 7, v20
v_lshlrev_b32 v4, 4, v4
v_lshl_add_u32 v3, v3, 12, v4
s_mul_i32 s27, s3, 458752
s_lshl_b32 s22, s24, 7
s_add_u32 s27, s27, s22
s_add_u32 s27, s27, 88080384
s_mul_i32 s28, s3, 14336
s_add_u32 m0, s28, 0
s_nop 0
buffer_load_dwordx4 v3, s[4:7], s27 offen sc1 lds
s_add_u32 s27, s27, 32768
s_add_u32 m0, s28, 1024
s_nop 0
buffer_load_dwordx4 v3, s[4:7], s27 offen sc1 lds
s_add_u32 s27, s27, 32768
s_add_u32 m0, s28, 2048
s_nop 0
buffer_load_dwordx4 v3, s[4:7], s27 offen sc1 lds
s_add_u32 s27, s27, 32768
s_add_u32 m0, s28, 3072
s_nop 0
buffer_load_dwordx4 v3, s[4:7], s27 offen sc1 lds
s_add_u32 s27, s27, 32768
s_add_u32 m0, s28, 4096
s_nop 0
buffer_load_dwordx4 v3, s[4:7], s27 offen sc1 lds
s_add_u32 s27, s27, 32768
s_add_u32 m0, s28, 5120
s_nop 0
buffer_load_dwordx4 v3, s[4:7], s27 offen sc1 lds
s_add_u32 s27, s27, 32768
s_add_u32 m0, s28, 6144
s_nop 0
buffer_load_dwordx4 v3, s[4:7], s27 offen sc1 lds
s_add_u32 s27, s27, 32768
s_add_u32 m0, s28, 7168
s_nop 0
buffer_load_dwordx4 v3, s[4:7], s27 offen sc1 lds
s_add_u32 s27, s27, 32768
s_add_u32 m0, s28, 8192
s_nop 0
buffer_load_dwordx4 v3, s[4:7], s27 offen sc1 lds
s_add_u32 s27, s27, 32768
s_add_u32 m0, s28, 9216
s_nop 0
buffer_load_dwordx4 v3, s[4:7], s27 offen sc1 lds
s_add_u32 s27, s27, 32768
s_add_u32 m0, s28, 10240
s_nop 0
buffer_load_dwordx4 v3, s[4:7], s27 offen sc1 lds
s_add_u32 s27, s27, 32768
s_add_u32 m0, s28, 11264
s_nop 0
buffer_load_dwordx4 v3, s[4:7], s27 offen sc1 lds
s_add_u32 s27, s27, 32768
s_add_u32 m0, s28, 12288
s_nop 0
buffer_load_dwordx4 v3, s[4:7], s27 offen sc1 lds
s_add_u32 s27, s27, 32768
s_add_u32 m0, s28, 13312
s_nop 0
buffer_load_dwordx4 v3, s[4:7], s27 offen sc1 lds
s_add_u32 s27, s27, 32768
buffer_load_dwordx4 v[160:163], v2, s[8:11], s25 offen offset:0
buffer_load_dwordx4 v[164:167], v2, s[8:11], s25 offen offset:64
buffer_load_dwordx4 v[168:171], v2, s[8:11], s25 offen offset:128
buffer_load_dwordx4 v[172:175], v2, s[8:11], s25 offen offset:192
buffer_load_dwordx4 v[176:179], v2, s[8:11], s25 offen offset:256
buffer_load_dwordx4 v[180:183], v2, s[8:11], s25 offen offset:320
buffer_load_dwordx4 v[184:187], v2, s[8:11], s25 offen offset:384
buffer_load_dwordx4 v[188:191], v2, s[8:11], s25 offen offset:448
buffer_load_dwordx4 v[192:195], v2, s[8:11], s25 offen offset:512
buffer_load_dwordx4 v[196:199], v2, s[8:11], s25 offen offset:576
buffer_load_dwordx4 v[200:203], v2, s[8:11], s25 offen offset:640
buffer_load_dwordx4 v[204:207], v2, s[8:11], s25 offen offset:704
buffer_load_dwordx4 v[208:211], v2, s[8:11], s25 offen offset:768
buffer_load_dwordx4 v[212:215], v2, s[8:11], s25 offen offset:832
v_lshrrev_b32 v3, 2, v21
v_lshl_add_u32 v3, v22, 3, v3
v_lshlrev_b32 v3, 7, v3
v_and_b32 v4, 3, v20
v_lshl_add_u32 v3, v4, 3, v3
s_lshl_b32 s22, s3, 5
v_add_u32 v3, s22, v3
s_waitcnt vmcnt(14)
s_barrier
ds_read_b64_tr_b16 v[96:97], v3 offset:0
ds_read_b64_tr_b16 v[98:99], v3 offset:512
ds_read_b64_tr_b16 v[100:101], v3 offset:4096
ds_read_b64_tr_b16 v[102:103], v3 offset:4608
ds_read_b64_tr_b16 v[104:105], v3 offset:8192
ds_read_b64_tr_b16 v[106:107], v3 offset:8704
ds_read_b64_tr_b16 v[108:109], v3 offset:12288
ds_read_b64_tr_b16 v[110:111], v3 offset:12800
ds_read_b64_tr_b16 v[112:113], v3 offset:16384
ds_read_b64_tr_b16 v[114:115], v3 offset:16896
ds_read_b64_tr_b16 v[116:117], v3 offset:20480
ds_read_b64_tr_b16 v[118:119], v3 offset:20992
ds_read_b64_tr_b16 v[120:121], v3 offset:24576
ds_read_b64_tr_b16 v[122:123], v3 offset:25088
s_waitcnt lgkmcnt(0)
ds_read_b64_tr_b16 v[124:125], v3 offset:28672
ds_read_b64_tr_b16 v[126:127], v3 offset:29184
ds_read_b64_tr_b16 v[128:129], v3 offset:32768
ds_read_b64_tr_b16 v[130:131], v3 offset:33280
ds_read_b64_tr_b16 v[132:133], v3 offset:36864
ds_read_b64_tr_b16 v[134:135], v3 offset:37376
ds_read_b64_tr_b16 v[136:137], v3 offset:40960
ds_read_b64_tr_b16 v[138:139], v3 offset:41472
ds_read_b64_tr_b16 v[140:141], v3 offset:45056
ds_read_b64_tr_b16 v[142:143], v3 offset:45568
ds_read_b64_tr_b16 v[144:145], v3 offset:49152
ds_read_b64_tr_b16 v[146:147], v3 offset:49664
ds_read_b64_tr_b16 v[148:149], v3 offset:53248
ds_read_b64_tr_b16 v[150:151], v3 offset:53760
s_waitcnt vmcnt(13)
v_lshlrev_b32 v10, 16, v160
v_and_b32 v11, 0xffff0000, v160
v_lshlrev_b32 v12, 16, v96
v_and_b32 v13, 0xffff0000, v96
v_pk_mul_f32 v[10:11], v[10:11], v[12:13]
v_cvt_pk_bf16_f32 v160, v10, v11
v_lshlrev_b32 v10, 16, v161
v_and_b32 v11, 0xffff0000, v161
v_lshlrev_b32 v12, 16, v97
v_and_b32 v13, 0xffff0000, v97
v_pk_mul_f32 v[10:11], v[10:11], v[12:13]
v_cvt_pk_bf16_f32 v161, v10, v11
v_lshlrev_b32 v10, 16, v162
v_and_b32 v11, 0xffff0000, v162
v_lshlrev_b32 v12, 16, v98
v_and_b32 v13, 0xffff0000, v98
v_pk_mul_f32 v[10:11], v[10:11], v[12:13]
v_cvt_pk_bf16_f32 v162, v10, v11
v_lshlrev_b32 v10, 16, v163
v_and_b32 v11, 0xffff0000, v163
v_lshlrev_b32 v12, 16, v99
PAD_20:
s_cbranch_execz M_tret
v_and_b32 v13, 0xffff0000, v99
v_pk_mul_f32 v[10:11], v[10:11], v[12:13]
v_cvt_pk_bf16_f32 v163, v10, v11
buffer_store_dwordx4 v[160:163], v9, s[12:15], s26 offen offset:0
s_waitcnt vmcnt(13)
v_lshlrev_b32 v10, 16, v164
v_and_b32 v11, 0xffff0000, v164
v_lshlrev_b32 v12, 16, v100
v_and_b32 v13, 0xffff0000, v100
v_pk_mul_f32 v[10:11], v[10:11], v[12:13]
v_cvt_pk_bf16_f32 v164, v10, v11
v_lshlrev_b32 v10, 16, v165
v_and_b32 v11, 0xffff0000, v165
v_lshlrev_b32 v12, 16, v101
v_and_b32 v13, 0xffff0000, v101
v_pk_mul_f32 v[10:11], v[10:11], v[12:13]
v_cvt_pk_bf16_f32 v165, v10, v11
v_lshlrev_b32 v10, 16, v166
v_and_b32 v11, 0xffff0000, v166
v_lshlrev_b32 v12, 16, v102
v_and_b32 v13, 0xffff0000, v102
v_pk_mul_f32 v[10:11], v[10:11], v[12:13]
v_cvt_pk_bf16_f32 v166, v10, v11
v_lshlrev_b32 v10, 16, v167
v_and_b32 v11, 0xffff0000, v167
v_lshlrev_b32 v12, 16, v103
v_and_b32 v13, 0xffff0000, v103
v_pk_mul_f32 v[10:11], v[10:11], v[12:13]
v_cvt_pk_bf16_f32 v167, v10, v11
buffer_store_dwordx4 v[164:167], v9, s[12:15], s26 offen offset:64
s_waitcnt vmcnt(13)
v_lshlrev_b32 v10, 16, v168
v_and_b32 v11, 0xffff0000, v168
v_lshlrev_b32 v12, 16, v104
v_and_b32 v13, 0xffff0000, v104
v_pk_mul_f32 v[10:11], v[10:11], v[12:13]
v_cvt_pk_bf16_f32 v168, v10, v11
v_lshlrev_b32 v10, 16, v169
v_and_b32 v11, 0xffff0000, v169
v_lshlrev_b32 v12, 16, v105
v_and_b32 v13, 0xffff0000, v105
v_pk_mul_f32 v[10:11], v[10:11], v[12:13]
v_cvt_pk_bf16_f32 v169, v10, v11
v_lshlrev_b32 v10, 16, v170
v_and_b32 v11, 0xffff0000, v170
v_lshlrev_b32 v12, 16, v106
v_and_b32 v13, 0xffff0000, v106
v_pk_mul_f32 v[10:11], v[10:11], v[12:13]
v_cvt_pk_bf16_f32 v170, v10, v11
v_lshlrev_b32 v10, 16, v171
v_and_b32 v11, 0xffff0000, v171
v_lshlrev_b32 v12, 16, v107
v_and_b32 v13, 0xffff0000, v107
v_pk_mul_f32 v[10:11], v[10:11], v[12:13]
v_cvt_pk_bf16_f32 v171, v10, v11
buffer_store_dwordx4 v[168:171], v9, s[12:15], s26 offen offset:128
s_waitcnt vmcnt(13)
v_lshlrev_b32 v10, 16, v172
v_and_b32 v11, 0xffff0000, v172
v_lshlrev_b32 v12, 16, v108
v_and_b32 v13, 0xffff0000, v108
v_pk_mul_f32 v[10:11], v[10:11], v[12:13]
v_cvt_pk_bf16_f32 v172, v10, v11
v_lshlrev_b32 v10, 16, v173
v_and_b32 v11, 0xffff0000, v173
v_lshlrev_b32 v12, 16, v109
v_and_b32 v13, 0xffff0000, v109
v_pk_mul_f32 v[10:11], v[10:11], v[12:13]
v_cvt_pk_bf16_f32 v173, v10, v11
v_lshlrev_b32 v10, 16, v174
v_and_b32 v11, 0xffff0000, v174
v_lshlrev_b32 v12, 16, v110
v_and_b32 v13, 0xffff0000, v110
v_pk_mul_f32 v[10:11], v[10:11], v[12:13]
v_cvt_pk_bf16_f32 v174, v10, v11
v_lshlrev_b32 v10, 16, v175
v_and_b32 v11, 0xffff0000, v175
v_lshlrev_b32 v12, 16, v111
v_and_b32 v13, 0xffff0000, v111
v_pk_mul_f32 v[10:11], v[10:11], v[12:13]
v_cvt_pk_bf16_f32 v175, v10, v11
buffer_store_dwordx4 v[172:175], v9, s[12:15], s26 offen offset:192
s_waitcnt vmcnt(13)
v_lshlrev_b32 v10, 16, v176
v_and_b32 v11, 0xffff0000, v176
v_lshlrev_b32 v12, 16, v112
v_and_b32 v13, 0xffff0000, v112
v_pk_mul_f32 v[10:11], v[10:11], v[12:13]
v_cvt_pk_bf16_f32 v176, v10, v11
v_lshlrev_b32 v10, 16, v177
v_and_b32 v11, 0xffff0000, v177
v_lshlrev_b32 v12, 16, v113
v_and_b32 v13, 0xffff0000, v113
v_pk_mul_f32 v[10:11], v[10:11], v[12:13]
v_cvt_pk_bf16_f32 v177, v10, v11
v_lshlrev_b32 v10, 16, v178
v_and_b32 v11, 0xffff0000, v178
v_lshlrev_b32 v12, 16, v114
v_and_b32 v13, 0xffff0000, v114
v_pk_mul_f32 v[10:11], v[10:11], v[12:13]
v_cvt_pk_bf16_f32 v178, v10, v11
v_lshlrev_b32 v10, 16, v179
v_and_b32 v11, 0xffff0000, v179
v_lshlrev_b32 v12, 16, v115
v_and_b32 v13, 0xffff0000, v115
v_pk_mul_f32 v[10:11], v[10:11], v[12:13]
v_cvt_pk_bf16_f32 v179, v10, v11
buffer_store_dwordx4 v[176:179], v9, s[12:15], s26 offen offset:256
s_waitcnt vmcnt(13)
v_lshlrev_b32 v10, 16, v180
v_and_b32 v11, 0xffff0000, v180
v_lshlrev_b32 v12, 16, v116
v_and_b32 v13, 0xffff0000, v116
v_pk_mul_f32 v[10:11], v[10:11], v[12:13]
v_cvt_pk_bf16_f32 v180, v10, v11
v_lshlrev_b32 v10, 16, v181
v_and_b32 v11, 0xffff0000, v181
v_lshlrev_b32 v12, 16, v117
v_and_b32 v13, 0xffff0000, v117
v_pk_mul_f32 v[10:11], v[10:11], v[12:13]
v_cvt_pk_bf16_f32 v181, v10, v11
v_lshlrev_b32 v10, 16, v182
v_and_b32 v11, 0xffff0000, v182
v_lshlrev_b32 v12, 16, v118
v_and_b32 v13, 0xffff0000, v118
v_pk_mul_f32 v[10:11], v[10:11], v[12:13]
v_cvt_pk_bf16_f32 v182, v10, v11
v_lshlrev_b32 v10, 16, v183
v_and_b32 v11, 0xffff0000, v183
v_lshlrev_b32 v12, 16, v119
v_and_b32 v13, 0xffff0000, v119
v_pk_mul_f32 v[10:11], v[10:11], v[12:13]
v_cvt_pk_bf16_f32 v183, v10, v11
buffer_store_dwordx4 v[180:183], v9, s[12:15], s26 offen offset:320
s_waitcnt vmcnt(13)
v_lshlrev_b32 v10, 16, v184
v_and_b32 v11, 0xffff0000, v184
v_lshlrev_b32 v12, 16, v120
v_and_b32 v13, 0xffff0000, v120
v_pk_mul_f32 v[10:11], v[10:11], v[12:13]
v_cvt_pk_bf16_f32 v184, v10, v11
v_lshlrev_b32 v10, 16, v185
v_and_b32 v11, 0xffff0000, v185
v_lshlrev_b32 v12, 16, v121
v_and_b32 v13, 0xffff0000, v121
v_pk_mul_f32 v[10:11], v[10:11], v[12:13]
v_cvt_pk_bf16_f32 v185, v10, v11
v_lshlrev_b32 v10, 16, v186
v_and_b32 v11, 0xffff0000, v186
v_lshlrev_b32 v12, 16, v122
v_and_b32 v13, 0xffff0000, v122
v_pk_mul_f32 v[10:11], v[10:11], v[12:13]
v_cvt_pk_bf16_f32 v186, v10, v11
v_lshlrev_b32 v10, 16, v187
v_and_b32 v11, 0xffff0000, v187
v_lshlrev_b32 v12, 16, v123
v_and_b32 v13, 0xffff0000, v123
v_pk_mul_f32 v[10:11], v[10:11], v[12:13]
v_cvt_pk_bf16_f32 v187, v10, v11
buffer_store_dwordx4 v[184:187], v9, s[12:15], s26 offen offset:384
s_waitcnt lgkmcnt(0)
s_waitcnt vmcnt(13)
v_lshlrev_b32 v10, 16, v188
v_and_b32 v11, 0xffff0000, v188
v_lshlrev_b32 v12, 16, v124
v_and_b32 v13, 0xffff0000, v124
v_pk_mul_f32 v[10:11], v[10:11], v[12:13]
v_cvt_pk_bf16_f32 v188, v10, v11
v_lshlrev_b32 v10, 16, v189
v_and_b32 v11, 0xffff0000, v189
v_lshlrev_b32 v12, 16, v125
v_and_b32 v13, 0xffff0000, v125
v_pk_mul_f32 v[10:11], v[10:11], v[12:13]
v_cvt_pk_bf16_f32 v189, v10, v11
v_lshlrev_b32 v10, 16, v190
v_and_b32 v11, 0xffff0000, v190
v_lshlrev_b32 v12, 16, v126
v_and_b32 v13, 0xffff0000, v126
v_pk_mul_f32 v[10:11], v[10:11], v[12:13]
v_cvt_pk_bf16_f32 v190, v10, v11
v_lshlrev_b32 v10, 16, v191
v_and_b32 v11, 0xffff0000, v191
v_lshlrev_b32 v12, 16, v127
v_and_b32 v13, 0xffff0000, v127
v_pk_mul_f32 v[10:11], v[10:11], v[12:13]
v_cvt_pk_bf16_f32 v191, v10, v11
buffer_store_dwordx4 v[188:191], v9, s[12:15], s26 offen offset:448
s_waitcnt vmcnt(13)
v_lshlrev_b32 v10, 16, v192
v_and_b32 v11, 0xffff0000, v192
v_lshlrev_b32 v12, 16, v128
v_and_b32 v13, 0xffff0000, v128
v_pk_mul_f32 v[10:11], v[10:11], v[12:13]
v_cvt_pk_bf16_f32 v192, v10, v11
v_lshlrev_b32 v10, 16, v193
v_and_b32 v11, 0xffff0000, v193
v_lshlrev_b32 v12, 16, v129
v_and_b32 v13, 0xffff0000, v129
v_pk_mul_f32 v[10:11], v[10:11], v[12:13]
v_cvt_pk_bf16_f32 v193, v10, v11
v_lshlrev_b32 v10, 16, v194
v_and_b32 v11, 0xffff0000, v194
v_lshlrev_b32 v12, 16, v130
v_and_b32 v13, 0xffff0000, v130
v_pk_mul_f32 v[10:11], v[10:11], v[12:13]
v_cvt_pk_bf16_f32 v194, v10, v11
v_lshlrev_b32 v10, 16, v195
v_and_b32 v11, 0xffff0000, v195
v_lshlrev_b32 v12, 16, v131
v_and_b32 v13, 0xffff0000, v131
v_pk_mul_f32 v[10:11], v[10:11], v[12:13]
v_cvt_pk_bf16_f32 v195, v10, v11
buffer_store_dwordx4 v[192:195], v9, s[12:15], s26 offen offset:512
s_waitcnt vmcnt(13)
v_lshlrev_b32 v10, 16, v196
v_and_b32 v11, 0xffff0000, v196
v_lshlrev_b32 v12, 16, v132
v_and_b32 v13, 0xffff0000, v132
v_pk_mul_f32 v[10:11], v[10:11], v[12:13]
v_cvt_pk_bf16_f32 v196, v10, v11
v_lshlrev_b32 v10, 16, v197
v_and_b32 v11, 0xffff0000, v197
v_lshlrev_b32 v12, 16, v133
v_and_b32 v13, 0xffff0000, v133
v_pk_mul_f32 v[10:11], v[10:11], v[12:13]
v_cvt_pk_bf16_f32 v197, v10, v11
v_lshlrev_b32 v10, 16, v198
v_and_b32 v11, 0xffff0000, v198
v_lshlrev_b32 v12, 16, v134
v_and_b32 v13, 0xffff0000, v134
v_pk_mul_f32 v[10:11], v[10:11], v[12:13]
v_cvt_pk_bf16_f32 v198, v10, v11
v_lshlrev_b32 v10, 16, v199
v_and_b32 v11, 0xffff0000, v199
v_lshlrev_b32 v12, 16, v135
v_and_b32 v13, 0xffff0000, v135
v_pk_mul_f32 v[10:11], v[10:11], v[12:13]
v_cvt_pk_bf16_f32 v199, v10, v11
buffer_store_dwordx4 v[196:199], v9, s[12:15], s26 offen offset:576
s_waitcnt vmcnt(13)
v_lshlrev_b32 v10, 16, v200
v_and_b32 v11, 0xffff0000, v200
v_lshlrev_b32 v12, 16, v136
v_and_b32 v13, 0xffff0000, v136
v_pk_mul_f32 v[10:11], v[10:11], v[12:13]
v_cvt_pk_bf16_f32 v200, v10, v11
v_lshlrev_b32 v10, 16, v201
v_and_b32 v11, 0xffff0000, v201
v_lshlrev_b32 v12, 16, v137
v_and_b32 v13, 0xffff0000, v137
v_pk_mul_f32 v[10:11], v[10:11], v[12:13]
v_cvt_pk_bf16_f32 v201, v10, v11
v_lshlrev_b32 v10, 16, v202
v_and_b32 v11, 0xffff0000, v202
v_lshlrev_b32 v12, 16, v138
v_and_b32 v13, 0xffff0000, v138
v_pk_mul_f32 v[10:11], v[10:11], v[12:13]
v_cvt_pk_bf16_f32 v202, v10, v11
v_lshlrev_b32 v10, 16, v203
v_and_b32 v11, 0xffff0000, v203
v_lshlrev_b32 v12, 16, v139
v_and_b32 v13, 0xffff0000, v139
v_pk_mul_f32 v[10:11], v[10:11], v[12:13]
v_cvt_pk_bf16_f32 v203, v10, v11
buffer_store_dwordx4 v[200:203], v9, s[12:15], s26 offen offset:640
s_waitcnt vmcnt(13)
v_lshlrev_b32 v10, 16, v204
v_and_b32 v11, 0xffff0000, v204
v_lshlrev_b32 v12, 16, v140
v_and_b32 v13, 0xffff0000, v140
v_pk_mul_f32 v[10:11], v[10:11], v[12:13]
v_cvt_pk_bf16_f32 v204, v10, v11
v_lshlrev_b32 v10, 16, v205
v_and_b32 v11, 0xffff0000, v205
v_lshlrev_b32 v12, 16, v141
v_and_b32 v13, 0xffff0000, v141
v_pk_mul_f32 v[10:11], v[10:11], v[12:13]
v_cvt_pk_bf16_f32 v205, v10, v11
v_lshlrev_b32 v10, 16, v206
v_and_b32 v11, 0xffff0000, v206
v_lshlrev_b32 v12, 16, v142
v_and_b32 v13, 0xffff0000, v142
v_pk_mul_f32 v[10:11], v[10:11], v[12:13]
v_cvt_pk_bf16_f32 v206, v10, v11
v_lshlrev_b32 v10, 16, v207
v_and_b32 v11, 0xffff0000, v207
v_lshlrev_b32 v12, 16, v143
v_and_b32 v13, 0xffff0000, v143
v_pk_mul_f32 v[10:11], v[10:11], v[12:13]
v_cvt_pk_bf16_f32 v207, v10, v11
buffer_store_dwordx4 v[204:207], v9, s[12:15], s26 offen offset:704
s_waitcnt vmcnt(13)
v_lshlrev_b32 v10, 16, v208
v_and_b32 v11, 0xffff0000, v208
v_lshlrev_b32 v12, 16, v144
v_and_b32 v13, 0xffff0000, v144
v_pk_mul_f32 v[10:11], v[10:11], v[12:13]
v_cvt_pk_bf16_f32 v208, v10, v11
v_lshlrev_b32 v10, 16, v209
v_and_b32 v11, 0xffff0000, v209
v_lshlrev_b32 v12, 16, v145
v_and_b32 v13, 0xffff0000, v145
v_pk_mul_f32 v[10:11], v[10:11], v[12:13]
v_cvt_pk_bf16_f32 v209, v10, v11
v_lshlrev_b32 v10, 16, v210
v_and_b32 v11, 0xffff0000, v210
v_lshlrev_b32 v12, 16, v146
v_and_b32 v13, 0xffff0000, v146
v_pk_mul_f32 v[10:11], v[10:11], v[12:13]
v_cvt_pk_bf16_f32 v210, v10, v11
v_lshlrev_b32 v10, 16, v211
v_and_b32 v11, 0xffff0000, v211
v_lshlrev_b32 v12, 16, v147
v_and_b32 v13, 0xffff0000, v147
v_pk_mul_f32 v[10:11], v[10:11], v[12:13]
v_cvt_pk_bf16_f32 v211, v10, v11
buffer_store_dwordx4 v[208:211], v9, s[12:15], s26 offen offset:768
s_waitcnt vmcnt(13)
v_lshlrev_b32 v10, 16, v212
v_and_b32 v11, 0xffff0000, v212
v_lshlrev_b32 v12, 16, v148
v_and_b32 v13, 0xffff0000, v148
v_pk_mul_f32 v[10:11], v[10:11], v[12:13]
v_cvt_pk_bf16_f32 v212, v10, v11
v_lshlrev_b32 v10, 16, v213
v_and_b32 v11, 0xffff0000, v213
v_lshlrev_b32 v12, 16, v149
v_and_b32 v13, 0xffff0000, v149
v_pk_mul_f32 v[10:11], v[10:11], v[12:13]
v_cvt_pk_bf16_f32 v213, v10, v11
v_lshlrev_b32 v10, 16, v214
v_and_b32 v11, 0xffff0000, v214
v_lshlrev_b32 v12, 16, v150
v_and_b32 v13, 0xffff0000, v150
v_pk_mul_f32 v[10:11], v[10:11], v[12:13]
v_cvt_pk_bf16_f32 v214, v10, v11
v_lshlrev_b32 v10, 16, v215
v_and_b32 v11, 0xffff0000, v215
v_lshlrev_b32 v12, 16, v151
v_and_b32 v13, 0xffff0000, v151
v_pk_mul_f32 v[10:11], v[10:11], v[12:13]
v_cvt_pk_bf16_f32 v215, v10, v11
buffer_store_dwordx4 v[212:215], v9, s[12:15], s26 offen offset:832
s_branch M_fin
M_rslow:
Lp_9251:
buffer_load_dword v18, v19, s[4:7], s33 offen offset:0 sc1
s_waitcnt vmcnt(0)
v_cmp_gt_u32 vcc, 1, v18
s_cbranch_vccz Lpd_9252
s_sleep 8
s_sub_u32 s101, s101, 1
s_cbranch_scc0 Lp_9251
s_mov_b32 s101, 0
Lpd_9252:
s_branch M_rjoin
PAD_21:
s_cbranch_execz PAD_25
M_V:
v_mfma_f32_16x16x32_bf16 v[32:35], a[0:3], a[128:131], 0
s_add_u32 m0, s29, 114688
ds_read_b64_tr_b16 a[136:137], v5 offset:0
v_mfma_f32_16x16x32_bf16 v[32:35], a[4:7], a[132:135], v[32:35]
s_mov_b32 s32, 1024
buffer_load_dwordx4 v16, s[12:15], s27 offen offset:0 lds
v_mfma_f32_16x16x32_bf16 v[36:39], a[8:11], a[128:131], 0
s_mov_b32 s33, 31744
ds_read_b64_tr_b16 a[138:139], v5 offset:2048
v_mfma_f32_16x16x32_bf16 v[36:39], a[12:15], a[132:135], v[36:39]
s_mov_b32 s34, 4294935552
v_mfma_f32_16x16x32_bf16 v[40:43], a[16:19], a[128:131], 0
s_mov_b32 s35, 4294935552
ds_read_b64_tr_b16 a[140:141], v5 offset:16384
v_mfma_f32_16x16x32_bf16 v[40:43], a[20:23], a[132:135], v[40:43]
s_mov_b32 s36, 4294935552
buffer_load_dwordx4 v17, s[12:15], s27 offen offset:1024 lds
v_mfma_f32_16x16x32_bf16 v[44:47], a[24:27], a[128:131], 0
s_mov_b32 s30, 8
ds_read_b64_tr_b16 a[142:143], v5 offset:18432
v_mfma_f32_16x16x32_bf16 v[44:47], a[28:31], a[132:135], v[44:47]
s_mov_b32 s82, 3221225472
v_mfma_f32_16x16x32_bf16 v[48:51], a[32:35], a[128:131], 0
s_mul_hi_u32 s38, s2, 613566757
v_mfma_f32_16x16x32_bf16 v[48:51], a[36:39], a[132:135], v[48:51]
s_mul_i32 s39, s38, 7
buffer_load_dwordx4 v18, s[12:15], s27 offen offset:2048 lds
v_mfma_f32_16x16x32_bf16 v[52:55], a[40:43], a[128:131], 0
s_sub_u32 s39, s2, s39
v_mov_b32 v246, 0
v_mov_b32 v229, 0
v_mfma_f32_16x16x32_bf16 v[52:55], a[44:47], a[132:135], v[52:55]
v_mov_b32 v231, 0
v_mfma_f32_16x16x32_bf16 v[56:59], a[48:51], a[128:131], 0
s_mov_b32 s60, s90
v_mfma_f32_16x16x32_bf16 v[56:59], a[52:55], a[132:135], v[56:59]
s_mov_b32 s61, s91
buffer_load_dwordx4 v19, s[12:15], s27 offen offset:3072 lds
v_mfma_f32_16x16x32_bf16 v[60:63], a[56:59], a[128:131], 0
s_add_u32 s27, s27, 524288
v_mfma_f32_16x16x32_bf16 v[60:63], a[60:63], a[132:135], v[60:63]
s_waitcnt lgkmcnt(0)
s_mov_b32 s62, 256
v_mfma_f32_16x16x32_bf16 v[64:67], a[0:3], a[136:139], 0
s_add_u32 m0, s28, 0
ds_read_b64_tr_b16 a[128:129], v6 offset:0
v_mfma_f32_16x16x32_bf16 v[64:67], a[4:7], a[140:143], v[64:67]
s_mov_b32 s63, 0x20000
buffer_load_dwordx4 v12, s[8:11], s24 offen offset:0 lds
v_mfma_f32_16x16x32_bf16 v[68:71], a[8:11], a[136:139], 0
s_mul_hi_u32 s55, s2, 1431655766
ds_read_b64_tr_b16 a[130:131], v6 offset:2048
v_mfma_f32_16x16x32_bf16 v[68:71], a[12:15], a[140:143], v[68:71]
s_mul_i32 s55, s55, 3
v_mfma_f32_16x16x32_bf16 v[72:75], a[16:19], a[136:139], 0
s_sub_u32 s55, s2, s55
ds_read_b64_tr_b16 a[132:133], v6 offset:16384
v_mfma_f32_16x16x32_bf16 v[72:75], a[20:23], a[140:143], v[72:75]
s_add_u32 s55, s55, 5
buffer_load_dwordx4 v13, s[8:11], s24 offen offset:1024 lds
v_mfma_f32_16x16x32_bf16 v[76:79], a[24:27], a[136:139], 0
s_lshr_b32 s22, s2, 4
ds_read_b64_tr_b16 a[134:135], v6 offset:18432
v_mfma_f32_16x16x32_bf16 v[76:79], a[28:31], a[140:143], v[76:79]
s_lshl_b32 s23, s20, 5
v_mfma_f32_16x16x32_bf16 v[80:83], a[32:35], a[136:139], 0
s_add_u32 s23, s23, s22
v_mfma_f32_16x16x32_bf16 v[80:83], a[36:39], a[140:143], v[80:83]
s_lshl_b32 s23, s23, 2
buffer_load_dwordx4 v14, s[8:11], s24 offen offset:2048 lds
v_mfma_f32_16x16x32_bf16 v[84:87], a[40:43], a[136:139], 0
s_and_b32 s22, s2, 16
v_mfma_f32_16x16x32_bf16 v[84:87], a[44:47], a[140:143], v[84:87]
s_lshl_b32 s22, s22, 7
v_mfma_f32_16x16x32_bf16 v[88:91], a[48:51], a[136:139], 0
s_add_u32 s23, s23, s22
v_mov_b32 v28, 3221225472
v_writelane_b32 v28, s23, 0
v_mfma_f32_16x16x32_bf16 v[88:91], a[52:55], a[140:143], v[88:91]
s_add_u32 s56, s23, 16384
buffer_load_dwordx4 v15, s[8:11], s24 offen offset:3072 lds
v_mfma_f32_16x16x32_bf16 v[92:95], a[56:59], a[136:139], 0
s_add_u32 s24, s24, 128
v_writelane_b32 v28, s56, 1
v_mfma_f32_16x16x32_bf16 v[92:95], a[60:63], a[140:143], v[92:95]
s_waitcnt lgkmcnt(0)
s_add_u32 s56, s23, 4096
v_writelane_b32 v28, s56, 2
v_mfma_f32_16x16x32_bf16 v[96:99], a[0:3], a[128:131], 0
s_add_u32 m0, s28, 4096
ds_read_b64_tr_b16 a[136:137], v7 offset:0
v_mfma_f32_16x16x32_bf16 v[96:99], a[4:7], a[132:135], v[96:99]
s_sub_u32 s37, 15, s21
buffer_load_dwordx4 v12, s[8:11], s25 offen offset:0 lds
v_mfma_f32_16x16x32_bf16 v[100:103], a[8:11], a[128:131], 0
ds_read_b64_tr_b16 a[138:139], v7 offset:2048
v_mfma_f32_16x16x32_bf16 v[100:103], a[12:15], a[132:135], v[100:103]
v_mfma_f32_16x16x32_bf16 v[104:107], a[16:19], a[128:131], 0
ds_read_b64_tr_b16 a[140:141], v7 offset:16384
v_mfma_f32_16x16x32_bf16 v[104:107], a[20:23], a[132:135], v[104:107]
buffer_load_dwordx4 v13, s[8:11], s25 offen offset:1024 lds
v_mfma_f32_16x16x32_bf16 v[108:111], a[24:27], a[128:131], 0
ds_read_b64_tr_b16 a[142:143], v7 offset:18432
v_mfma_f32_16x16x32_bf16 v[108:111], a[28:31], a[132:135], v[108:111]
v_mfma_f32_16x16x32_bf16 v[112:115], a[32:35], a[128:131], 0
v_mfma_f32_16x16x32_bf16 v[112:115], a[36:39], a[132:135], v[112:115]
buffer_load_dwordx4 v14, s[8:11], s25 offen offset:2048 lds
v_mfma_f32_16x16x32_bf16 v[116:119], a[40:43], a[128:131], 0
v_mfma_f32_16x16x32_bf16 v[116:119], a[44:47], a[132:135], v[116:119]
v_mfma_f32_16x16x32_bf16 v[120:123], a[48:51], a[128:131], 0
v_mfma_f32_16x16x32_bf16 v[120:123], a[52:55], a[132:135], v[120:123]
buffer_load_dwordx4 v15, s[8:11], s25 offen offset:3072 lds
v_mfma_f32_16x16x32_bf16 v[124:127], a[56:59], a[128:131], 0
s_add_u32 s25, s25, 128
v_mfma_f32_16x16x32_bf16 v[124:127], a[60:63], a[132:135], v[124:127]
s_waitcnt vmcnt(17) lgkmcnt(0)
s_barrier
v_mfma_f32_16x16x32_bf16 v[128:131], a[0:3], a[136:139], 0
ds_read_b64_tr_b16 a[128:129], v8 offset:0
v_mfma_f32_16x16x32_bf16 v[128:131], a[4:7], a[140:143], v[128:131]
buffer_load_dword v21, v20, s[16:19], s43 offen
v_mfma_f32_16x16x32_bf16 v[132:135], a[8:11], a[136:139], 0
s_add_u32 s43, s43, s47
ds_read_b64_tr_b16 a[130:131], v8 offset:2048
v_mfma_f32_16x16x32_bf16 v[132:135], a[12:15], a[140:143], v[132:135]
s_cmp_ge_u32 s43, s51
v_mfma_f32_16x16x32_bf16 v[136:139], a[16:19], a[136:139], 0
s_cselect_b32 s43, 0, s43
ds_read_b64_tr_b16 a[132:133], v8 offset:16384
v_mfma_f32_16x16x32_bf16 v[136:139], a[20:23], a[140:143], v[136:139]
s_cselect_b32 s51, s42, s51
v_mfma_f32_16x16x32_bf16 v[140:143], a[24:27], a[136:139], 0
s_cselect_b64 s[16:17], s[40:41], s[16:17]
ds_read_b64_tr_b16 a[134:135], v8 offset:18432
v_mfma_f32_16x16x32_bf16 v[140:143], a[28:31], a[140:143], v[140:143]
s_cselect_b32 s18, s42, s18
v_mfma_f32_16x16x32_bf16 v[144:147], a[32:35], a[136:139], 0
s_cselect_b64 s[40:41], s[44:45], s[40:41]
ds_read_b128 a[64:67], v2 offset:32768
v_mfma_f32_16x16x32_bf16 v[144:147], a[36:39], a[140:143], v[144:147]
s_cselect_b32 s42, s46, s42
v_mfma_f32_16x16x32_bf16 v[148:151], a[40:43], a[136:139], 0
s_cselect_b32 s46, 0, s46
ds_read_b128 a[68:71], v3 offset:32768
v_mfma_f32_16x16x32_bf16 v[148:151], a[44:47], a[140:143], v[148:151]
ds_read_b128 a[72:75], v2 offset:34816
v_mfma_f32_16x16x32_bf16 v[152:155], a[48:51], a[136:139], 0
ds_read_b128 a[76:79], v3 offset:34816
v_mfma_f32_16x16x32_bf16 v[152:155], a[52:55], a[140:143], v[152:155]
buffer_load_dword v21, v20, s[16:19], s43 offen
v_mfma_f32_16x16x32_bf16 v[156:159], a[56:59], a[136:139], 0
s_add_u32 s43, s43, s47
ds_read_b128 a[80:83], v2 offset:36864
v_mfma_f32_16x16x32_bf16 v[156:159], a[60:63], a[140:143], v[156:159]
s_waitcnt lgkmcnt(5)
s_cmp_ge_u32 s43, s51
ds_read_b128 a[84:87], v3 offset:36864
v_mfma_f32_16x16x32_bf16 v[160:163], a[0:3], a[128:131], 0
s_cselect_b32 s43, 0, s43
ds_read_b64_tr_b16 a[136:137], v9 offset:0
v_mfma_f32_16x16x32_bf16 v[160:163], a[4:7], a[132:135], v[160:163]
s_cselect_b32 s51, s42, s51
v_mfma_f32_16x16x32_bf16 v[164:167], a[8:11], a[128:131], 0
s_cselect_b64 s[16:17], s[40:41], s[16:17]
ds_read_b64_tr_b16 a[138:139], v9 offset:2048
v_mfma_f32_16x16x32_bf16 v[164:167], a[12:15], a[132:135], v[164:167]
s_cselect_b32 s18, s42, s18
v_mfma_f32_16x16x32_bf16 v[168:171], a[16:19], a[128:131], 0
s_cselect_b64 s[40:41], s[44:45], s[40:41]
ds_read_b64_tr_b16 a[140:141], v9 offset:16384
v_mfma_f32_16x16x32_bf16 v[168:171], a[20:23], a[132:135], v[168:171]
s_cselect_b32 s42, s46, s42
v_mfma_f32_16x16x32_bf16 v[172:175], a[24:27], a[128:131], 0
s_cselect_b32 s46, 0, s46
ds_read_b64_tr_b16 a[142:143], v9 offset:18432
v_mfma_f32_16x16x32_bf16 v[172:175], a[28:31], a[132:135], v[172:175]
s_bitcmp1_b32 s2, 4
s_cselect_b32 s37, s21, s37
s_lshl_b32 s56, s37, 5
v_mfma_f32_16x16x32_bf16 v[176:179], a[32:35], a[128:131], 0
s_add_u32 s56, s56, s20
s_lshl_b32 s56, s56, 2
s_add_u32 s56, s56, 8192
v_mfma_f32_16x16x32_bf16 v[176:179], a[36:39], a[132:135], v[176:179]
v_writelane_b32 v28, s56, 3
v_mfma_f32_16x16x32_bf16 v[180:183], a[40:43], a[128:131], 0
s_add_u32 s56, s56, 2048
ds_read_b128 a[88:91], v2 offset:38912
v_writelane_b32 v28, s56, 6
v_mfma_f32_16x16x32_bf16 v[180:183], a[44:47], a[132:135], v[180:183]
s_lshl_b32 s56, s2, 2
s_add_u32 s56, s56, 12288
ds_read_b128 a[92:95], v3 offset:38912
v_mfma_f32_16x16x32_bf16 v[184:187], a[48:51], a[128:131], 0
s_waitcnt lgkmcnt(2)
ds_read_b128 a[96:99], v2 offset:40960
v_writelane_b32 v28, s56, 4
v_mfma_f32_16x16x32_bf16 v[184:187], a[52:55], a[132:135], v[184:187]
s_lshl_b32 s56, s39, 5
s_add_u32 s56, s56, s38
s_lshl_b32 s56, s56, 2
v_mfma_f32_16x16x32_bf16 v[188:191], a[56:59], a[128:131], 0
s_add_u32 s56, s56, 20480
s_cmp_lt_u32 s2, 224
ds_read_b128 a[100:103], v3 offset:40960
v_mfma_f32_16x16x32_bf16 v[188:191], a[60:63], a[132:135], v[188:191]
s_cselect_b32 s56, s56, 3221225472
ds_read_b128 a[104:107], v2 offset:43008
v_writelane_b32 v28, s56, 7
v_mfma_f32_16x16x32_bf16 v[192:195], a[0:3], a[136:139], 0
s_cmp_eq_u32 s3, 0
s_cselect_b32 s56, 94371840, 3221225472
ds_read_b64_tr_b16 a[128:129], v10 offset:0
v_mfma_f32_16x16x32_bf16 v[192:195], a[4:7], a[140:143], v[192:195]
buffer_store_dword v246, v28, s[4:7], s56 offen sc1
v_mfma_f32_16x16x32_bf16 v[196:199], a[8:11], a[136:139], 0
ds_read_b64_tr_b16 a[130:131], v10 offset:2048
v_mov_b32 v27, 1
v_mfma_f32_16x16x32_bf16 v[196:199], a[12:15], a[140:143], v[196:199]
v_cmp_eq_u32 vcc, 0, v0
v_mov_b32 v26, 3221225472
v_mfma_f32_16x16x32_bf16 v[200:203], a[16:19], a[136:139], 0
s_lshl_b32 s31, s20, 20
s_lshl_b32 s22, s21, 17
ds_read_b64_tr_b16 a[132:133], v10 offset:16384
v_mfma_f32_16x16x32_bf16 v[200:203], a[20:23], a[140:143], v[200:203]
v_cndmask_b32 v26, v26, v246, vcc
v_mfma_f32_16x16x32_bf16 v[204:207], a[24:27], a[136:139], 0
s_add_u32 s31, s31, s22
s_lshr_b32 s22, s3, 1
ds_read_b64_tr_b16 a[134:135], v10 offset:18432
v_mfma_f32_16x16x32_bf16 v[204:207], a[28:31], a[140:143], v[204:207]
s_lshl_b32 s22, s22, 16
s_add_u32 s31, s31, s22
s_and_b32 s22, s3, 1
v_mfma_f32_16x16x32_bf16 v[208:211], a[32:35], a[136:139], 0
s_lshl_b32 s22, s22, 14
s_add_u32 s31, s31, s22
s_add_u32 s31, s31, 16777216
v_mfma_f32_16x16x32_bf16 v[208:211], a[36:39], a[140:143], v[208:211]
v_mfma_f32_16x16x32_bf16 v[212:215], a[40:43], a[136:139], 0
ds_read_b128 a[108:111], v3 offset:43008
v_mfma_f32_16x16x32_bf16 v[212:215], a[44:47], a[140:143], v[212:215]
ds_read_b128 a[112:115], v2 offset:45056
v_mfma_f32_16x16x32_bf16 v[216:219], a[48:51], a[136:139], 0
ds_read_b128 a[116:119], v3 offset:45056
v_mfma_f32_16x16x32_bf16 v[216:219], a[52:55], a[140:143], v[216:219]
v_mfma_f32_16x16x32_bf16 v[220:223], a[56:59], a[136:139], 0
ds_read_b128 a[120:123], v2 offset:47104
v_mfma_f32_16x16x32_bf16 v[220:223], a[60:63], a[140:143], v[220:223]
s_waitcnt lgkmcnt(4)
ds_read_b128 a[124:127], v3 offset:47104
v_mfma_f32_16x16x32_bf16 a[192:195], a[0:3], a[128:131], 0
ds_read_b64_tr_b16 a[136:137], v11 offset:0
v_mfma_f32_16x16x32_bf16 a[192:195], a[4:7], a[132:135], a[192:195]
v_mfma_f32_16x16x32_bf16 a[196:199], a[8:11], a[128:131], 0
ds_read_b64_tr_b16 a[138:139], v11 offset:2048
v_mfma_f32_16x16x32_bf16 a[196:199], a[12:15], a[132:135], a[196:199]
PAD_22:
s_cbranch_execz PAD_26
v_mfma_f32_16x16x32_bf16 a[200:203], a[16:19], a[128:131], 0
ds_read_b64_tr_b16 a[140:141], v11 offset:16384
v_mfma_f32_16x16x32_bf16 a[200:203], a[20:23], a[132:135], a[200:203]
v_mfma_f32_16x16x32_bf16 a[204:207], a[24:27], a[128:131], 0
ds_read_b64_tr_b16 a[142:143], v11 offset:18432
v_mfma_f32_16x16x32_bf16 a[204:207], a[28:31], a[132:135], a[204:207]
v_mfma_f32_16x16x32_bf16 a[208:211], a[32:35], a[128:131], 0
v_mfma_f32_16x16x32_bf16 a[208:211], a[36:39], a[132:135], a[208:211]
v_mfma_f32_16x16x32_bf16 a[212:215], a[40:43], a[128:131], 0
v_mfma_f32_16x16x32_bf16 a[212:215], a[44:47], a[132:135], a[212:215]
v_mfma_f32_16x16x32_bf16 a[216:219], a[48:51], a[128:131], 0
v_mfma_f32_16x16x32_bf16 a[216:219], a[52:55], a[132:135], a[216:219]
v_mfma_f32_16x16x32_bf16 a[220:223], a[56:59], a[128:131], 0
s_waitcnt vmcnt(3) lgkmcnt(0)
v_mfma_f32_16x16x32_bf16 a[220:223], a[60:63], a[132:135], a[220:223]
s_barrier
v_mfma_f32_16x16x32_bf16 a[224:227], a[0:3], a[136:139], 0
s_add_u32 m0, s29, 65536
ds_read_b64_tr_b16 a[128:129], v4 offset:32768
v_mfma_f32_16x16x32_bf16 a[224:227], a[4:7], a[140:143], a[224:227]
buffer_load_dwordx4 v16, s[12:15], s26 offen offset:0 lds
v_mfma_f32_16x16x32_bf16 a[228:231], a[8:11], a[136:139], 0
ds_read_b64_tr_b16 a[130:131], v4 offset:34816
v_mfma_f32_16x16x32_bf16 a[228:231], a[12:15], a[140:143], a[228:231]
v_mfma_f32_16x16x32_bf16 a[232:235], a[16:19], a[136:139], 0
ds_read_b64_tr_b16 a[132:133], v4 offset:49152
v_mfma_f32_16x16x32_bf16 a[232:235], a[20:23], a[140:143], a[232:235]
buffer_load_dwordx4 v17, s[12:15], s26 offen offset:1024 lds
v_mfma_f32_16x16x32_bf16 a[236:239], a[24:27], a[136:139], 0
ds_read_b64_tr_b16 a[134:135], v4 offset:51200
v_mfma_f32_16x16x32_bf16 a[236:239], a[28:31], a[140:143], a[236:239]
v_mfma_f32_16x16x32_bf16 a[240:243], a[32:35], a[136:139], 0
v_mfma_f32_16x16x32_bf16 a[240:243], a[36:39], a[140:143], a[240:243]
buffer_load_dwordx4 v18, s[12:15], s26 offen offset:2048 lds
v_mfma_f32_16x16x32_bf16 a[244:247], a[40:43], a[136:139], 0
v_mfma_f32_16x16x32_bf16 a[244:247], a[44:47], a[140:143], a[244:247]
v_mfma_f32_16x16x32_bf16 a[248:251], a[48:51], a[136:139], 0
v_mfma_f32_16x16x32_bf16 a[248:251], a[52:55], a[140:143], a[248:251]
buffer_load_dwordx4 v19, s[12:15], s26 offen offset:3072 lds
v_mfma_f32_16x16x32_bf16 a[252:255], a[56:59], a[136:139], 0
s_add_u32 s26, s26, 524288
v_mfma_f32_16x16x32_bf16 a[252:255], a[60:63], a[140:143], a[252:255]
s_waitcnt lgkmcnt(0)
Lg_501:
v_mfma_f32_16x16x32_bf16 v[32:35], a[64:67], a[128:131], v[32:35]
s_add_u32 m0, s29, 81920
ds_read_b64_tr_b16 a[136:137], v5 offset:32768
v_mfma_f32_16x16x32_bf16 v[32:35], a[68:71], a[132:135], v[32:35]
buffer_load_dwordx4 v16, s[12:15], s27 offen offset:0 lds
v_mfma_f32_16x16x32_bf16 v[36:39], a[72:75], a[128:131], v[36:39]
ds_read_b64_tr_b16 a[138:139], v5 offset:34816
v_mfma_f32_16x16x32_bf16 v[36:39], a[76:79], a[132:135], v[36:39]
v_mfma_f32_16x16x32_bf16 v[40:43], a[80:83], a[128:131], v[40:43]
ds_read_b64_tr_b16 a[140:141], v5 offset:49152
v_mfma_f32_16x16x32_bf16 v[40:43], a[84:87], a[132:135], v[40:43]
buffer_load_dwordx4 v17, s[12:15], s27 offen offset:1024 lds
v_mfma_f32_16x16x32_bf16 v[44:47], a[88:91], a[128:131], v[44:47]
ds_read_b64_tr_b16 a[142:143], v5 offset:51200
v_mfma_f32_16x16x32_bf16 v[44:47], a[92:95], a[132:135], v[44:47]
v_mfma_f32_16x16x32_bf16 v[48:51], a[96:99], a[128:131], v[48:51]
ds_read_b128 a[0:3], v2 offset:0
v_mfma_f32_16x16x32_bf16 v[48:51], a[100:103], a[132:135], v[48:51]
buffer_load_dwordx4 v18, s[12:15], s27 offen offset:2048 lds
v_mfma_f32_16x16x32_bf16 v[52:55], a[104:107], a[128:131], v[52:55]
ds_read_b128 a[4:7], v3 offset:0
v_mfma_f32_16x16x32_bf16 v[52:55], a[108:111], a[132:135], v[52:55]
v_mfma_f32_16x16x32_bf16 v[56:59], a[112:115], a[128:131], v[56:59]
v_mfma_f32_16x16x32_bf16 v[56:59], a[116:119], a[132:135], v[56:59]
buffer_load_dwordx4 v19, s[12:15], s27 offen offset:3072 lds
v_mfma_f32_16x16x32_bf16 v[60:63], a[120:123], a[128:131], v[60:63]
s_add_u32 s27, s27, 524288
ds_read_b128 a[8:11], v2 offset:2048
v_mfma_f32_16x16x32_bf16 v[60:63], a[124:127], a[132:135], v[60:63]
s_waitcnt lgkmcnt(3)
v_mfma_f32_16x16x32_bf16 v[64:67], a[64:67], a[136:139], v[64:67]
s_add_u32 m0, s28, 32768
ds_read_b64_tr_b16 a[128:129], v6 offset:32768
v_mfma_f32_16x16x32_bf16 v[64:67], a[68:71], a[140:143], v[64:67]
buffer_load_dwordx4 v12, s[8:11], s24 offen offset:0 lds
v_mfma_f32_16x16x32_bf16 v[68:71], a[72:75], a[136:139], v[68:71]
ds_read_b64_tr_b16 a[130:131], v6 offset:34816
v_mfma_f32_16x16x32_bf16 v[68:71], a[76:79], a[140:143], v[68:71]
v_mfma_f32_16x16x32_bf16 v[72:75], a[80:83], a[136:139], v[72:75]
ds_read_b64_tr_b16 a[132:133], v6 offset:49152
v_mfma_f32_16x16x32_bf16 v[72:75], a[84:87], a[140:143], v[72:75]
buffer_load_dwordx4 v13, s[8:11], s24 offen offset:1024 lds
v_mfma_f32_16x16x32_bf16 v[76:79], a[88:91], a[136:139], v[76:79]
ds_read_b64_tr_b16 a[134:135], v6 offset:51200
v_mfma_f32_16x16x32_bf16 v[76:79], a[92:95], a[140:143], v[76:79]
v_mfma_f32_16x16x32_bf16 v[80:83], a[96:99], a[136:139], v[80:83]
ds_read_b128 a[12:15], v3 offset:2048
v_mfma_f32_16x16x32_bf16 v[80:83], a[100:103], a[140:143], v[80:83]
buffer_load_dwordx4 v14, s[8:11], s24 offen offset:2048 lds
v_mfma_f32_16x16x32_bf16 v[84:87], a[104:107], a[136:139], v[84:87]
v_mfma_f32_16x16x32_bf16 v[84:87], a[108:111], a[140:143], v[84:87]
v_mfma_f32_16x16x32_bf16 v[88:91], a[112:115], a[136:139], v[88:91]
ds_read_b128 a[16:19], v2 offset:4096
v_mfma_f32_16x16x32_bf16 v[88:91], a[116:119], a[140:143], v[88:91]
buffer_load_dwordx4 v15, s[8:11], s24 offen offset:3072 lds
v_mfma_f32_16x16x32_bf16 v[92:95], a[120:123], a[136:139], v[92:95]
s_add_u32 s24, s24, 128
ds_read_b128 a[20:23], v3 offset:4096
v_mfma_f32_16x16x32_bf16 v[92:95], a[124:127], a[140:143], v[92:95]
s_waitcnt lgkmcnt(3)
v_mfma_f32_16x16x32_bf16 v[96:99], a[64:67], a[128:131], v[96:99]
s_add_u32 m0, s28, 36864
ds_read_b64_tr_b16 a[136:137], v7 offset:32768
v_mfma_f32_16x16x32_bf16 v[96:99], a[68:71], a[132:135], v[96:99]
buffer_load_dwordx4 v12, s[8:11], s25 offen offset:0 lds
v_mfma_f32_16x16x32_bf16 v[100:103], a[72:75], a[128:131], v[100:103]
ds_read_b64_tr_b16 a[138:139], v7 offset:34816
v_mfma_f32_16x16x32_bf16 v[100:103], a[76:79], a[132:135], v[100:103]
v_mfma_f32_16x16x32_bf16 v[104:107], a[80:83], a[128:131], v[104:107]
ds_read_b64_tr_b16 a[140:141], v7 offset:49152
v_mfma_f32_16x16x32_bf16 v[104:107], a[84:87], a[132:135], v[104:107]
buffer_load_dwordx4 v13, s[8:11], s25 offen offset:1024 lds
v_mfma_f32_16x16x32_bf16 v[108:111], a[88:91], a[128:131], v[108:111]
ds_read_b64_tr_b16 a[142:143], v7 offset:51200
v_mfma_f32_16x16x32_bf16 v[108:111], a[92:95], a[132:135], v[108:111]
v_mfma_f32_16x16x32_bf16 v[112:115], a[96:99], a[128:131], v[112:115]
v_mfma_f32_16x16x32_bf16 v[112:115], a[100:103], a[132:135], v[112:115]
buffer_load_dwordx4 v14, s[8:11], s25 offen offset:2048 lds
v_mfma_f32_16x16x32_bf16 v[116:119], a[104:107], a[128:131], v[116:119]
ds_read_b128 a[24:27], v2 offset:6144
v_mfma_f32_16x16x32_bf16 v[116:119], a[108:111], a[132:135], v[116:119]
v_mfma_f32_16x16x32_bf16 v[120:123], a[112:115], a[128:131], v[120:123]
ds_read_b128 a[28:31], v3 offset:6144
v_mfma_f32_16x16x32_bf16 v[120:123], a[116:119], a[132:135], v[120:123]
buffer_load_dwordx4 v15, s[8:11], s25 offen offset:3072 lds
v_mfma_f32_16x16x32_bf16 v[124:127], a[120:123], a[128:131], v[124:127]
s_add_u32 s25, s25, 128
v_mfma_f32_16x16x32_bf16 v[124:127], a[124:127], a[132:135], v[124:127]
s_waitcnt lgkmcnt(2)
v_mfma_f32_16x16x32_bf16 v[128:131], a[64:67], a[136:139], v[128:131]
ds_read_b64_tr_b16 a[128:129], v8 offset:32768
v_mfma_f32_16x16x32_bf16 v[128:131], a[68:71], a[140:143], v[128:131]
buffer_load_dword v21, v20, s[16:19], s43 offen
v_mfma_f32_16x16x32_bf16 v[132:135], a[72:75], a[136:139], v[132:135]
s_add_u32 s43, s43, s47
ds_read_b64_tr_b16 a[130:131], v8 offset:34816
v_mfma_f32_16x16x32_bf16 v[132:135], a[76:79], a[140:143], v[132:135]
s_cmp_ge_u32 s43, s51
v_mfma_f32_16x16x32_bf16 v[136:139], a[80:83], a[136:139], v[136:139]
s_cselect_b32 s43, 0, s43
ds_read_b64_tr_b16 a[132:133], v8 offset:49152
v_mfma_f32_16x16x32_bf16 v[136:139], a[84:87], a[140:143], v[136:139]
s_cselect_b32 s51, s42, s51
v_mfma_f32_16x16x32_bf16 v[140:143], a[88:91], a[136:139], v[140:143]
s_cselect_b64 s[16:17], s[40:41], s[16:17]
ds_read_b64_tr_b16 a[134:135], v8 offset:51200
v_mfma_f32_16x16x32_bf16 v[140:143], a[92:95], a[140:143], v[140:143]
s_cselect_b32 s18, s42, s18
v_mfma_f32_16x16x32_bf16 v[144:147], a[96:99], a[136:139], v[144:147]
s_cselect_b64 s[40:41], s[44:45], s[40:41]
ds_read_b128 a[32:35], v2 offset:8192
v_mfma_f32_16x16x32_bf16 v[144:147], a[100:103], a[140:143], v[144:147]
s_cselect_b32 s42, s46, s42
v_mfma_f32_16x16x32_bf16 v[148:151], a[104:107], a[136:139], v[148:151]
s_cselect_b32 s46, 0, s46
v_mfma_f32_16x16x32_bf16 v[148:151], a[108:111], a[140:143], v[148:151]
s_cmp_eq_u32 s30, s55
v_mfma_f32_16x16x32_bf16 v[152:155], a[112:115], a[136:139], v[152:155]
s_cselect_b32 s22, 0, 3221225472
ds_read_b128 a[36:39], v3 offset:8192
v_mfma_f32_16x16x32_bf16 v[152:155], a[116:119], a[140:143], v[152:155]
s_sub_u32 s30, s30, 1
buffer_atomic_add v27, v26, s[60:63], s22 offen sc1
v_mfma_f32_16x16x32_bf16 v[156:159], a[120:123], a[136:139], v[156:159]
ds_read_b128 a[40:43], v2 offset:10240
v_mfma_f32_16x16x32_bf16 v[156:159], a[124:127], a[140:143], v[156:159]
s_waitcnt lgkmcnt(3)
v_mfma_f32_16x16x32_bf16 v[160:163], a[64:67], a[128:131], v[160:163]
ds_read_b64_tr_b16 a[136:137], v9 offset:32768
v_mfma_f32_16x16x32_bf16 v[160:163], a[68:71], a[132:135], v[160:163]
v_mfma_f32_16x16x32_bf16 v[164:167], a[72:75], a[128:131], v[164:167]
ds_read_b64_tr_b16 a[138:139], v9 offset:34816
v_mfma_f32_16x16x32_bf16 v[164:167], a[76:79], a[132:135], v[164:167]
v_mfma_f32_16x16x32_bf16 v[168:171], a[80:83], a[128:131], v[168:171]
ds_read_b64_tr_b16 a[140:141], v9 offset:49152
v_mfma_f32_16x16x32_bf16 v[168:171], a[84:87], a[132:135], v[168:171]
v_mfma_f32_16x16x32_bf16 v[172:175], a[88:91], a[128:131], v[172:175]
ds_read_b64_tr_b16 a[142:143], v9 offset:51200
v_mfma_f32_16x16x32_bf16 v[172:175], a[92:95], a[132:135], v[172:175]
v_mfma_f32_16x16x32_bf16 v[176:179], a[96:99], a[128:131], v[176:179]
v_mfma_f32_16x16x32_bf16 v[176:179], a[100:103], a[132:135], v[176:179]
v_mfma_f32_16x16x32_bf16 v[180:183], a[104:107], a[128:131], v[180:183]
ds_read_b128 a[44:47], v3 offset:10240
v_mfma_f32_16x16x32_bf16 v[180:183], a[108:111], a[132:135], v[180:183]
v_mfma_f32_16x16x32_bf16 v[184:187], a[112:115], a[128:131], v[184:187]
ds_read_b128 a[48:51], v2 offset:12288
v_mfma_f32_16x16x32_bf16 v[184:187], a[116:119], a[132:135], v[184:187]
v_mfma_f32_16x16x32_bf16 v[188:191], a[120:123], a[128:131], v[188:191]
v_mfma_f32_16x16x32_bf16 v[188:191], a[124:127], a[132:135], v[188:191]
s_waitcnt lgkmcnt(2)
v_mfma_f32_16x16x32_bf16 v[192:195], a[64:67], a[136:139], v[192:195]
ds_read_b64_tr_b16 a[128:129], v10 offset:32768
v_mfma_f32_16x16x32_bf16 v[192:195], a[68:71], a[140:143], v[192:195]
v_mfma_f32_16x16x32_bf16 v[196:199], a[72:75], a[136:139], v[196:199]
ds_read_b64_tr_b16 a[130:131], v10 offset:34816
v_mfma_f32_16x16x32_bf16 v[196:199], a[76:79], a[140:143], v[196:199]
v_mfma_f32_16x16x32_bf16 v[200:203], a[80:83], a[136:139], v[200:203]
ds_read_b64_tr_b16 a[132:133], v10 offset:49152
v_mfma_f32_16x16x32_bf16 v[200:203], a[84:87], a[140:143], v[200:203]
v_mfma_f32_16x16x32_bf16 v[204:207], a[88:91], a[136:139], v[204:207]
ds_read_b64_tr_b16 a[134:135], v10 offset:51200
v_mfma_f32_16x16x32_bf16 v[204:207], a[92:95], a[140:143], v[204:207]
v_mfma_f32_16x16x32_bf16 v[208:211], a[96:99], a[136:139], v[208:211]
ds_read_b128 a[52:55], v3 offset:12288
v_mfma_f32_16x16x32_bf16 v[208:211], a[100:103], a[140:143], v[208:211]
v_mfma_f32_16x16x32_bf16 v[212:215], a[104:107], a[136:139], v[212:215]
ds_read_b128 a[56:59], v2 offset:14336
v_mfma_f32_16x16x32_bf16 v[212:215], a[108:111], a[140:143], v[212:215]
v_mfma_f32_16x16x32_bf16 v[216:219], a[112:115], a[136:139], v[216:219]
v_mfma_f32_16x16x32_bf16 v[216:219], a[116:119], a[140:143], v[216:219]
v_mfma_f32_16x16x32_bf16 v[220:223], a[120:123], a[136:139], v[220:223]
ds_read_b128 a[60:63], v3 offset:14336
v_mfma_f32_16x16x32_bf16 v[220:223], a[124:127], a[140:143], v[220:223]
s_waitcnt lgkmcnt(3)
v_mfma_f32_16x16x32_bf16 a[192:195], a[64:67], a[128:131], a[192:195]
ds_read_b64_tr_b16 a[136:137], v11 offset:32768
v_mfma_f32_16x16x32_bf16 a[192:195], a[68:71], a[132:135], a[192:195]
v_mfma_f32_16x16x32_bf16 a[196:199], a[72:75], a[128:131], a[196:199]
ds_read_b64_tr_b16 a[138:139], v11 offset:34816
v_mfma_f32_16x16x32_bf16 a[196:199], a[76:79], a[132:135], a[196:199]
v_mfma_f32_16x16x32_bf16 a[200:203], a[80:83], a[128:131], a[200:203]
ds_read_b64_tr_b16 a[140:141], v11 offset:49152
v_mfma_f32_16x16x32_bf16 a[200:203], a[84:87], a[132:135], a[200:203]
v_mfma_f32_16x16x32_bf16 a[204:207], a[88:91], a[128:131], a[204:207]
ds_read_b64_tr_b16 a[142:143], v11 offset:51200
v_mfma_f32_16x16x32_bf16 a[204:207], a[92:95], a[132:135], a[204:207]
v_mfma_f32_16x16x32_bf16 a[208:211], a[96:99], a[128:131], a[208:211]
v_mfma_f32_16x16x32_bf16 a[208:211], a[100:103], a[132:135], a[208:211]
v_mfma_f32_16x16x32_bf16 a[212:215], a[104:107], a[128:131], a[212:215]
v_mfma_f32_16x16x32_bf16 a[212:215], a[108:111], a[132:135], a[212:215]
v_mfma_f32_16x16x32_bf16 a[216:219], a[112:115], a[128:131], a[216:219]
v_mfma_f32_16x16x32_bf16 a[216:219], a[116:119], a[132:135], a[216:219]
v_mfma_f32_16x16x32_bf16 a[220:223], a[120:123], a[128:131], a[220:223]
s_waitcnt vmcnt(2) lgkmcnt(0)
v_mfma_f32_16x16x32_bf16 a[220:223], a[124:127], a[132:135], a[220:223]
s_barrier
v_mfma_f32_16x16x32_bf16 a[224:227], a[64:67], a[136:139], a[224:227]
s_add_u32 m0, s29, 98304
ds_read_b64_tr_b16 a[128:129], v4 offset:0
v_mfma_f32_16x16x32_bf16 a[224:227], a[68:71], a[140:143], a[224:227]
buffer_load_dwordx4 v16, s[12:15], s26 offen offset:0 lds
v_mfma_f32_16x16x32_bf16 a[228:231], a[72:75], a[136:139], a[228:231]
ds_read_b64_tr_b16 a[130:131], v4 offset:2048
v_mfma_f32_16x16x32_bf16 a[228:231], a[76:79], a[140:143], a[228:231]
v_mfma_f32_16x16x32_bf16 a[232:235], a[80:83], a[136:139], a[232:235]
ds_read_b64_tr_b16 a[132:133], v4 offset:16384
v_mfma_f32_16x16x32_bf16 a[232:235], a[84:87], a[140:143], a[232:235]
buffer_load_dwordx4 v17, s[12:15], s26 offen offset:1024 lds
v_mfma_f32_16x16x32_bf16 a[236:239], a[88:91], a[136:139], a[236:239]
ds_read_b64_tr_b16 a[134:135], v4 offset:18432
v_mfma_f32_16x16x32_bf16 a[236:239], a[92:95], a[140:143], a[236:239]
v_mfma_f32_16x16x32_bf16 a[240:243], a[96:99], a[136:139], a[240:243]
v_mfma_f32_16x16x32_bf16 a[240:243], a[100:103], a[140:143], a[240:243]
buffer_load_dwordx4 v18, s[12:15], s26 offen offset:2048 lds
v_mfma_f32_16x16x32_bf16 a[244:247], a[104:107], a[136:139], a[244:247]
v_mfma_f32_16x16x32_bf16 a[244:247], a[108:111], a[140:143], a[244:247]
v_mfma_f32_16x16x32_bf16 a[248:251], a[112:115], a[136:139], a[248:251]
v_mfma_f32_16x16x32_bf16 a[248:251], a[116:119], a[140:143], a[248:251]
buffer_load_dwordx4 v19, s[12:15], s26 offen offset:3072 lds
v_mfma_f32_16x16x32_bf16 a[252:255], a[120:123], a[136:139], a[252:255]
s_add_u32 s26, s26, 524288
v_mfma_f32_16x16x32_bf16 a[252:255], a[124:127], a[140:143], a[252:255]
s_waitcnt lgkmcnt(0)
buffer_store_dword v27, v26, s[4:7], s82 offen sc1
v_mfma_f32_16x16x32_bf16 v[32:35], a[0:3], a[128:131], v[32:35]
s_add_u32 m0, s29, 114688
ds_read_b64_tr_b16 a[136:137], v5 offset:0
v_mfma_f32_16x16x32_bf16 v[32:35], a[4:7], a[132:135], v[32:35]
buffer_load_dwordx4 v16, s[12:15], s27 offen offset:0 lds
v_mfma_f32_16x16x32_bf16 v[36:39], a[8:11], a[128:131], v[36:39]
ds_read_b64_tr_b16 a[138:139], v5 offset:2048
v_mfma_f32_16x16x32_bf16 v[36:39], a[12:15], a[132:135], v[36:39]
v_mfma_f32_16x16x32_bf16 v[40:43], a[16:19], a[128:131], v[40:43]
ds_read_b64_tr_b16 a[140:141], v5 offset:16384
v_mfma_f32_16x16x32_bf16 v[40:43], a[20:23], a[132:135], v[40:43]
buffer_load_dwordx4 v17, s[12:15], s27 offen offset:1024 lds
v_mfma_f32_16x16x32_bf16 v[44:47], a[24:27], a[128:131], v[44:47]
ds_read_b64_tr_b16 a[142:143], v5 offset:18432
v_mfma_f32_16x16x32_bf16 v[44:47], a[28:31], a[132:135], v[44:47]
v_mfma_f32_16x16x32_bf16 v[48:51], a[32:35], a[128:131], v[48:51]
ds_read_b128 a[64:67], v2 offset:32768
v_mfma_f32_16x16x32_bf16 v[48:51], a[36:39], a[132:135], v[48:51]
buffer_load_dwordx4 v18, s[12:15], s27 offen offset:2048 lds
v_mfma_f32_16x16x32_bf16 v[52:55], a[40:43], a[128:131], v[52:55]
ds_read_b128 a[68:71], v3 offset:32768
v_mfma_f32_16x16x32_bf16 v[52:55], a[44:47], a[132:135], v[52:55]
v_mfma_f32_16x16x32_bf16 v[56:59], a[48:51], a[128:131], v[56:59]
v_mfma_f32_16x16x32_bf16 v[56:59], a[52:55], a[132:135], v[56:59]
buffer_load_dwordx4 v19, s[12:15], s27 offen offset:3072 lds
v_mfma_f32_16x16x32_bf16 v[60:63], a[56:59], a[128:131], v[60:63]
s_add_u32 s27, s27, 524288
ds_read_b128 a[72:75], v2 offset:34816
v_mfma_f32_16x16x32_bf16 v[60:63], a[60:63], a[132:135], v[60:63]
s_waitcnt lgkmcnt(3)
v_mfma_f32_16x16x32_bf16 v[64:67], a[0:3], a[136:139], v[64:67]
s_add_u32 m0, s28, 0
ds_read_b64_tr_b16 a[128:129], v6 offset:0
v_mfma_f32_16x16x32_bf16 v[64:67], a[4:7], a[140:143], v[64:67]
buffer_load_dwordx4 v12, s[8:11], s24 offen offset:0 lds
v_mfma_f32_16x16x32_bf16 v[68:71], a[8:11], a[136:139], v[68:71]
ds_read_b64_tr_b16 a[130:131], v6 offset:2048
v_mfma_f32_16x16x32_bf16 v[68:71], a[12:15], a[140:143], v[68:71]
v_mfma_f32_16x16x32_bf16 v[72:75], a[16:19], a[136:139], v[72:75]
ds_read_b64_tr_b16 a[132:133], v6 offset:16384
v_mfma_f32_16x16x32_bf16 v[72:75], a[20:23], a[140:143], v[72:75]
buffer_load_dwordx4 v13, s[8:11], s24 offen offset:1024 lds
v_mfma_f32_16x16x32_bf16 v[76:79], a[24:27], a[136:139], v[76:79]
ds_read_b64_tr_b16 a[134:135], v6 offset:18432
v_mfma_f32_16x16x32_bf16 v[76:79], a[28:31], a[140:143], v[76:79]
v_mfma_f32_16x16x32_bf16 v[80:83], a[32:35], a[136:139], v[80:83]
ds_read_b128 a[76:79], v3 offset:34816
v_mfma_f32_16x16x32_bf16 v[80:83], a[36:39], a[140:143], v[80:83]
buffer_load_dwordx4 v14, s[8:11], s24 offen offset:2048 lds
v_mfma_f32_16x16x32_bf16 v[84:87], a[40:43], a[136:139], v[84:87]
v_mfma_f32_16x16x32_bf16 v[84:87], a[44:47], a[140:143], v[84:87]
v_mfma_f32_16x16x32_bf16 v[88:91], a[48:51], a[136:139], v[88:91]
ds_read_b128 a[80:83], v2 offset:36864
v_mfma_f32_16x16x32_bf16 v[88:91], a[52:55], a[140:143], v[88:91]
buffer_load_dwordx4 v15, s[8:11], s24 offen offset:3072 lds
v_mfma_f32_16x16x32_bf16 v[92:95], a[56:59], a[136:139], v[92:95]
s_add_u32 s24, s24, 128
ds_read_b128 a[84:87], v3 offset:36864
v_mfma_f32_16x16x32_bf16 v[92:95], a[60:63], a[140:143], v[92:95]
s_waitcnt lgkmcnt(3)
v_mfma_f32_16x16x32_bf16 v[96:99], a[0:3], a[128:131], v[96:99]
s_add_u32 m0, s28, 4096
ds_read_b64_tr_b16 a[136:137], v7 offset:0
v_mfma_f32_16x16x32_bf16 v[96:99], a[4:7], a[132:135], v[96:99]
buffer_load_dwordx4 v12, s[8:11], s25 offen offset:0 lds
v_mfma_f32_16x16x32_bf16 v[100:103], a[8:11], a[128:131], v[100:103]
ds_read_b64_tr_b16 a[138:139], v7 offset:2048
v_mfma_f32_16x16x32_bf16 v[100:103], a[12:15], a[132:135], v[100:103]
v_mfma_f32_16x16x32_bf16 v[104:107], a[16:19], a[128:131], v[104:107]
ds_read_b64_tr_b16 a[140:141], v7 offset:16384
v_mfma_f32_16x16x32_bf16 v[104:107], a[20:23], a[132:135], v[104:107]
buffer_load_dwordx4 v13, s[8:11], s25 offen offset:1024 lds
v_mfma_f32_16x16x32_bf16 v[108:111], a[24:27], a[128:131], v[108:111]
ds_read_b64_tr_b16 a[142:143], v7 offset:18432
v_mfma_f32_16x16x32_bf16 v[108:111], a[28:31], a[132:135], v[108:111]
v_mfma_f32_16x16x32_bf16 v[112:115], a[32:35], a[128:131], v[112:115]
v_mfma_f32_16x16x32_bf16 v[112:115], a[36:39], a[132:135], v[112:115]
buffer_load_dwordx4 v14, s[8:11], s25 offen offset:2048 lds
v_mfma_f32_16x16x32_bf16 v[116:119], a[40:43], a[128:131], v[116:119]
ds_read_b128 a[88:91], v2 offset:38912
v_mfma_f32_16x16x32_bf16 v[116:119], a[44:47], a[132:135], v[116:119]
v_mfma_f32_16x16x32_bf16 v[120:123], a[48:51], a[128:131], v[120:123]
ds_read_b128 a[92:95], v3 offset:38912
v_mfma_f32_16x16x32_bf16 v[120:123], a[52:55], a[132:135], v[120:123]
buffer_load_dwordx4 v15, s[8:11], s25 offen offset:3072 lds
v_mfma_f32_16x16x32_bf16 v[124:127], a[56:59], a[128:131], v[124:127]
s_add_u32 s25, s25, 128
v_mfma_f32_16x16x32_bf16 v[124:127], a[60:63], a[132:135], v[124:127]
s_waitcnt lgkmcnt(2)
v_mfma_f32_16x16x32_bf16 v[128:131], a[0:3], a[136:139], v[128:131]
ds_read_b64_tr_b16 a[128:129], v8 offset:0
v_mfma_f32_16x16x32_bf16 v[128:131], a[4:7], a[140:143], v[128:131]
buffer_load_dword v21, v20, s[16:19], s43 offen
v_mfma_f32_16x16x32_bf16 v[132:135], a[8:11], a[136:139], v[132:135]
s_add_u32 s43, s43, s47
ds_read_b64_tr_b16 a[130:131], v8 offset:2048
v_mfma_f32_16x16x32_bf16 v[132:135], a[12:15], a[140:143], v[132:135]
s_cmp_ge_u32 s43, s51
v_mfma_f32_16x16x32_bf16 v[136:139], a[16:19], a[136:139], v[136:139]
s_cselect_b32 s43, 0, s43
ds_read_b64_tr_b16 a[132:133], v8 offset:16384
v_mfma_f32_16x16x32_bf16 v[136:139], a[20:23], a[140:143], v[136:139]
s_cselect_b32 s51, s42, s51
v_mfma_f32_16x16x32_bf16 v[140:143], a[24:27], a[136:139], v[140:143]
s_cselect_b64 s[16:17], s[40:41], s[16:17]
ds_read_b64_tr_b16 a[134:135], v8 offset:18432
v_mfma_f32_16x16x32_bf16 v[140:143], a[28:31], a[140:143], v[140:143]
s_cselect_b32 s18, s42, s18
v_mfma_f32_16x16x32_bf16 v[144:147], a[32:35], a[136:139], v[144:147]
s_cselect_b64 s[40:41], s[44:45], s[40:41]
ds_read_b128 a[96:99], v2 offset:40960
v_mfma_f32_16x16x32_bf16 v[144:147], a[36:39], a[140:143], v[144:147]
s_cselect_b32 s42, s46, s42
v_mfma_f32_16x16x32_bf16 v[148:151], a[40:43], a[136:139], v[148:151]
s_cselect_b32 s46, 0, s46
v_mfma_f32_16x16x32_bf16 v[148:151], a[44:47], a[140:143], v[148:151]
s_cmp_eq_u32 s30, s55
v_mfma_f32_16x16x32_bf16 v[152:155], a[48:51], a[136:139], v[152:155]
s_cselect_b32 s22, 0, 3221225472
ds_read_b128 a[100:103], v3 offset:40960
v_mfma_f32_16x16x32_bf16 v[152:155], a[52:55], a[140:143], v[152:155]
s_sub_u32 s30, s30, 1
buffer_atomic_add v27, v26, s[60:63], s22 offen sc1
v_mfma_f32_16x16x32_bf16 v[156:159], a[56:59], a[136:139], v[156:159]
ds_read_b128 a[104:107], v2 offset:43008
v_mfma_f32_16x16x32_bf16 v[156:159], a[60:63], a[140:143], v[156:159]
s_waitcnt lgkmcnt(3)
v_mfma_f32_16x16x32_bf16 v[160:163], a[0:3], a[128:131], v[160:163]
ds_read_b64_tr_b16 a[136:137], v9 offset:0
v_mfma_f32_16x16x32_bf16 v[160:163], a[4:7], a[132:135], v[160:163]
v_mfma_f32_16x16x32_bf16 v[164:167], a[8:11], a[128:131], v[164:167]
ds_read_b64_tr_b16 a[138:139], v9 offset:2048
v_mfma_f32_16x16x32_bf16 v[164:167], a[12:15], a[132:135], v[164:167]
v_mfma_f32_16x16x32_bf16 v[168:171], a[16:19], a[128:131], v[168:171]
ds_read_b64_tr_b16 a[140:141], v9 offset:16384
v_mfma_f32_16x16x32_bf16 v[168:171], a[20:23], a[132:135], v[168:171]
v_mfma_f32_16x16x32_bf16 v[172:175], a[24:27], a[128:131], v[172:175]
ds_read_b64_tr_b16 a[142:143], v9 offset:18432
v_mfma_f32_16x16x32_bf16 v[172:175], a[28:31], a[132:135], v[172:175]
v_mfma_f32_16x16x32_bf16 v[176:179], a[32:35], a[128:131], v[176:179]
v_mfma_f32_16x16x32_bf16 v[176:179], a[36:39], a[132:135], v[176:179]
v_mfma_f32_16x16x32_bf16 v[180:183], a[40:43], a[128:131], v[180:183]
ds_read_b128 a[108:111], v3 offset:43008
v_mfma_f32_16x16x32_bf16 v[180:183], a[44:47], a[132:135], v[180:183]
v_mfma_f32_16x16x32_bf16 v[184:187], a[48:51], a[128:131], v[184:187]
ds_read_b128 a[112:115], v2 offset:45056
v_mfma_f32_16x16x32_bf16 v[184:187], a[52:55], a[132:135], v[184:187]
v_mfma_f32_16x16x32_bf16 v[188:191], a[56:59], a[128:131], v[188:191]
v_mfma_f32_16x16x32_bf16 v[188:191], a[60:63], a[132:135], v[188:191]
s_waitcnt lgkmcnt(2)
v_mfma_f32_16x16x32_bf16 v[192:195], a[0:3], a[136:139], v[192:195]
ds_read_b64_tr_b16 a[128:129], v10 offset:0
v_mfma_f32_16x16x32_bf16 v[192:195], a[4:7], a[140:143], v[192:195]
v_mfma_f32_16x16x32_bf16 v[196:199], a[8:11], a[136:139], v[196:199]
ds_read_b64_tr_b16 a[130:131], v10 offset:2048
v_mfma_f32_16x16x32_bf16 v[196:199], a[12:15], a[140:143], v[196:199]
v_mfma_f32_16x16x32_bf16 v[200:203], a[16:19], a[136:139], v[200:203]
ds_read_b64_tr_b16 a[132:133], v10 offset:16384
v_mfma_f32_16x16x32_bf16 v[200:203], a[20:23], a[140:143], v[200:203]
v_mfma_f32_16x16x32_bf16 v[204:207], a[24:27], a[136:139], v[204:207]
ds_read_b64_tr_b16 a[134:135], v10 offset:18432
v_mfma_f32_16x16x32_bf16 v[204:207], a[28:31], a[140:143], v[204:207]
v_mfma_f32_16x16x32_bf16 v[208:211], a[32:35], a[136:139], v[208:211]
ds_read_b128 a[116:119], v3 offset:45056
v_mfma_f32_16x16x32_bf16 v[208:211], a[36:39], a[140:143], v[208:211]
v_mfma_f32_16x16x32_bf16 v[212:215], a[40:43], a[136:139], v[212:215]
ds_read_b128 a[120:123], v2 offset:47104
v_mfma_f32_16x16x32_bf16 v[212:215], a[44:47], a[140:143], v[212:215]
v_mfma_f32_16x16x32_bf16 v[216:219], a[48:51], a[136:139], v[216:219]
v_mfma_f32_16x16x32_bf16 v[216:219], a[52:55], a[140:143], v[216:219]
v_mfma_f32_16x16x32_bf16 v[220:223], a[56:59], a[136:139], v[220:223]
ds_read_b128 a[124:127], v3 offset:47104
v_mfma_f32_16x16x32_bf16 v[220:223], a[60:63], a[140:143], v[220:223]
s_waitcnt lgkmcnt(3)
v_mfma_f32_16x16x32_bf16 a[192:195], a[0:3], a[128:131], a[192:195]
ds_read_b64_tr_b16 a[136:137], v11 offset:0
v_mfma_f32_16x16x32_bf16 a[192:195], a[4:7], a[132:135], a[192:195]
v_mfma_f32_16x16x32_bf16 a[196:199], a[8:11], a[128:131], a[196:199]
ds_read_b64_tr_b16 a[138:139], v11 offset:2048
v_mfma_f32_16x16x32_bf16 a[196:199], a[12:15], a[132:135], a[196:199]
v_mfma_f32_16x16x32_bf16 a[200:203], a[16:19], a[128:131], a[200:203]
ds_read_b64_tr_b16 a[140:141], v11 offset:16384
v_mfma_f32_16x16x32_bf16 a[200:203], a[20:23], a[132:135], a[200:203]
v_mfma_f32_16x16x32_bf16 a[204:207], a[24:27], a[128:131], a[204:207]
ds_read_b64_tr_b16 a[142:143], v11 offset:18432
v_mfma_f32_16x16x32_bf16 a[204:207], a[28:31], a[132:135], a[204:207]
v_mfma_f32_16x16x32_bf16 a[208:211], a[32:35], a[128:131], a[208:211]
v_mfma_f32_16x16x32_bf16 a[208:211], a[36:39], a[132:135], a[208:211]
v_mfma_f32_16x16x32_bf16 a[212:215], a[40:43], a[128:131], a[212:215]
v_mfma_f32_16x16x32_bf16 a[212:215], a[44:47], a[132:135], a[212:215]
v_mfma_f32_16x16x32_bf16 a[216:219], a[48:51], a[128:131], a[216:219]
v_mfma_f32_16x16x32_bf16 a[216:219], a[52:55], a[132:135], a[216:219]
v_mfma_f32_16x16x32_bf16 a[220:223], a[56:59], a[128:131], a[220:223]
s_waitcnt vmcnt(2) lgkmcnt(0)
v_mfma_f32_16x16x32_bf16 a[220:223], a[60:63], a[132:135], a[220:223]
s_barrier
v_mfma_f32_16x16x32_bf16 a[224:227], a[0:3], a[136:139], a[224:227]
s_add_u32 m0, s29, 65536
ds_read_b64_tr_b16 a[128:129], v4 offset:32768
v_mfma_f32_16x16x32_bf16 a[224:227], a[4:7], a[140:143], a[224:227]
buffer_load_dwordx4 v16, s[12:15], s26 offen offset:0 lds
v_mfma_f32_16x16x32_bf16 a[228:231], a[8:11], a[136:139], a[228:231]
ds_read_b64_tr_b16 a[130:131], v4 offset:34816
v_mfma_f32_16x16x32_bf16 a[228:231], a[12:15], a[140:143], a[228:231]
v_mfma_f32_16x16x32_bf16 a[232:235], a[16:19], a[136:139], a[232:235]
ds_read_b64_tr_b16 a[132:133], v4 offset:49152
v_mfma_f32_16x16x32_bf16 a[232:235], a[20:23], a[140:143], a[232:235]
buffer_load_dwordx4 v17, s[12:15], s26 offen offset:1024 lds
v_mfma_f32_16x16x32_bf16 a[236:239], a[24:27], a[136:139], a[236:239]
ds_read_b64_tr_b16 a[134:135], v4 offset:51200
v_mfma_f32_16x16x32_bf16 a[236:239], a[28:31], a[140:143], a[236:239]
v_mfma_f32_16x16x32_bf16 a[240:243], a[32:35], a[136:139], a[240:243]
v_mfma_f32_16x16x32_bf16 a[240:243], a[36:39], a[140:143], a[240:243]
buffer_load_dwordx4 v18, s[12:15], s26 offen offset:2048 lds
v_mfma_f32_16x16x32_bf16 a[244:247], a[40:43], a[136:139], a[244:247]
v_mfma_f32_16x16x32_bf16 a[244:247], a[44:47], a[140:143], a[244:247]
v_mfma_f32_16x16x32_bf16 a[248:251], a[48:51], a[136:139], a[248:251]
v_mfma_f32_16x16x32_bf16 a[248:251], a[52:55], a[140:143], a[248:251]
s_waitcnt lgkmcnt(0)
buffer_load_dwordx4 v19, s[12:15], s26 offen offset:3072 lds
v_mfma_f32_16x16x32_bf16 a[252:255], a[56:59], a[136:139], a[252:255]
s_add_u32 s26, s26, 524288
s_bitcmp1_b32 s30, 1
v_mfma_f32_16x16x32_bf16 a[252:255], a[60:63], a[140:143], a[252:255]
s_cbranch_scc1 Lg_501
s_cmp_eq_u32 s30, 0
s_cbranch_scc1 Lg_501t
v_mfma_f32_16x16x32_bf16 v[32:35], a[64:67], a[128:131], v[32:35]
s_add_u32 m0, s29, 81920
ds_read_b64_tr_b16 a[136:137], v5 offset:32768
v_mfma_f32_16x16x32_bf16 v[32:35], a[68:71], a[132:135], v[32:35]
buffer_load_dwordx4 v16, s[12:15], s27 offen offset:0 lds
v_mfma_f32_16x16x32_bf16 v[36:39], a[72:75], a[128:131], v[36:39]
s_lshl_b32 s22, s38, 3
ds_read_b64_tr_b16 a[138:139], v5 offset:34816
v_mfma_f32_16x16x32_bf16 v[36:39], a[76:79], a[132:135], v[36:39]
s_lshl_b32 s23, s39, 5
v_and_b32 v252, 31, v0
v_lshrrev_b32 v253, 5, v0
v_mfma_f32_16x16x32_bf16 v[40:43], a[80:83], a[128:131], v[40:43]
ds_read_b64_tr_b16 a[140:141], v5 offset:49152
v_add_u32 v253, s22, v253
v_mfma_f32_16x16x32_bf16 v[40:43], a[84:87], a[132:135], v[40:43]
buffer_load_dwordx4 v17, s[12:15], s27 offen offset:1024 lds
v_mfma_f32_16x16x32_bf16 v[44:47], a[88:91], a[128:131], v[44:47]
ds_read_b64_tr_b16 a[142:143], v5 offset:51200
v_add_u32 v252, s23, v252
v_mfma_f32_16x16x32_bf16 v[44:47], a[92:95], a[132:135], v[44:47]
v_mul_u32_u24 v254, 7168, v253
v_lshl_add_u32 v254, v252, 2, v254
v_mfma_f32_16x16x32_bf16 v[48:51], a[96:99], a[128:131], v[48:51]
ds_read_b128 a[0:3], v2 offset:0
v_lshlrev_b32 v252, 4, v252
v_mfma_f32_16x16x32_bf16 v[48:51], a[100:103], a[132:135], v[48:51]
buffer_load_dwordx4 v18, s[12:15], s27 offen offset:2048 lds
v_mfma_f32_16x16x32_bf16 v[52:55], a[104:107], a[128:131], v[52:55]
ds_read_b128 a[4:7], v3 offset:0
v_add_u32 v255, 3584, v254
v_mfma_f32_16x16x32_bf16 v[52:55], a[108:111], a[132:135], v[52:55]
v_subrev_u32 v22, 3584, v254
v_subrev_u32 v23, 2688, v254
v_mfma_f32_16x16x32_bf16 v[56:59], a[112:115], a[128:131], v[56:59]
v_subrev_u32 v24, 1792, v254
v_subrev_u32 v25, 896, v254
v_mfma_f32_16x16x32_bf16 v[56:59], a[116:119], a[132:135], v[56:59]
buffer_load_dwordx4 v19, s[12:15], s27 offen offset:3072 lds
v_mfma_f32_16x16x32_bf16 v[60:63], a[120:123], a[128:131], v[60:63]
s_add_u32 s27, s27, 524288
ds_read_b128 a[8:11], v2 offset:2048
v_mfma_f32_16x16x32_bf16 v[60:63], a[124:127], a[132:135], v[60:63]
s_waitcnt lgkmcnt(3)
v_mfma_f32_16x16x32_bf16 v[64:67], a[64:67], a[136:139], v[64:67]
s_add_u32 m0, s28, 32768
ds_read_b64_tr_b16 a[128:129], v6 offset:32768
v_mfma_f32_16x16x32_bf16 v[64:67], a[68:71], a[140:143], v[64:67]
buffer_load_dwordx4 v12, s[8:11], s24 offen offset:0 lds
v_mfma_f32_16x16x32_bf16 v[68:71], a[72:75], a[136:139], v[68:71]
ds_read_b64_tr_b16 a[130:131], v6 offset:34816
v_mfma_f32_16x16x32_bf16 v[68:71], a[76:79], a[140:143], v[68:71]
PAD_23:
s_cbranch_execz PAD_27
v_mfma_f32_16x16x32_bf16 v[72:75], a[80:83], a[136:139], v[72:75]
ds_read_b64_tr_b16 a[132:133], v6 offset:49152
v_mfma_f32_16x16x32_bf16 v[72:75], a[84:87], a[140:143], v[72:75]
buffer_load_dwordx4 v13, s[8:11], s24 offen offset:1024 lds
v_mfma_f32_16x16x32_bf16 v[76:79], a[88:91], a[136:139], v[76:79]
ds_read_b64_tr_b16 a[134:135], v6 offset:51200
v_mfma_f32_16x16x32_bf16 v[76:79], a[92:95], a[140:143], v[76:79]
v_mfma_f32_16x16x32_bf16 v[80:83], a[96:99], a[136:139], v[80:83]
ds_read_b128 a[12:15], v3 offset:2048
v_mfma_f32_16x16x32_bf16 v[80:83], a[100:103], a[140:143], v[80:83]
buffer_load_dwordx4 v14, s[8:11], s24 offen offset:2048 lds
v_mfma_f32_16x16x32_bf16 v[84:87], a[104:107], a[136:139], v[84:87]
v_mfma_f32_16x16x32_bf16 v[84:87], a[108:111], a[140:143], v[84:87]
v_mfma_f32_16x16x32_bf16 v[88:91], a[112:115], a[136:139], v[88:91]
ds_read_b128 a[16:19], v2 offset:4096
v_mfma_f32_16x16x32_bf16 v[88:91], a[116:119], a[140:143], v[88:91]
buffer_load_dwordx4 v15, s[8:11], s24 offen offset:3072 lds
v_mfma_f32_16x16x32_bf16 v[92:95], a[120:123], a[136:139], v[92:95]
s_add_u32 s24, s24, 128
ds_read_b128 a[20:23], v3 offset:4096
v_mfma_f32_16x16x32_bf16 v[92:95], a[124:127], a[140:143], v[92:95]
s_waitcnt lgkmcnt(3)
v_mfma_f32_16x16x32_bf16 v[96:99], a[64:67], a[128:131], v[96:99]
s_add_u32 m0, s28, 36864
ds_read_b64_tr_b16 a[136:137], v7 offset:32768
v_mfma_f32_16x16x32_bf16 v[96:99], a[68:71], a[132:135], v[96:99]
buffer_load_dwordx4 v12, s[8:11], s25 offen offset:0 lds
v_mfma_f32_16x16x32_bf16 v[100:103], a[72:75], a[128:131], v[100:103]
ds_read_b64_tr_b16 a[138:139], v7 offset:34816
v_mfma_f32_16x16x32_bf16 v[100:103], a[76:79], a[132:135], v[100:103]
v_mfma_f32_16x16x32_bf16 v[104:107], a[80:83], a[128:131], v[104:107]
ds_read_b64_tr_b16 a[140:141], v7 offset:49152
v_mfma_f32_16x16x32_bf16 v[104:107], a[84:87], a[132:135], v[104:107]
buffer_load_dwordx4 v13, s[8:11], s25 offen offset:1024 lds
v_mfma_f32_16x16x32_bf16 v[108:111], a[88:91], a[128:131], v[108:111]
ds_read_b64_tr_b16 a[142:143], v7 offset:51200
v_mfma_f32_16x16x32_bf16 v[108:111], a[92:95], a[132:135], v[108:111]
v_mfma_f32_16x16x32_bf16 v[112:115], a[96:99], a[128:131], v[112:115]
v_mfma_f32_16x16x32_bf16 v[112:115], a[100:103], a[132:135], v[112:115]
buffer_load_dwordx4 v14, s[8:11], s25 offen offset:2048 lds
v_mfma_f32_16x16x32_bf16 v[116:119], a[104:107], a[128:131], v[116:119]
ds_read_b128 a[24:27], v2 offset:6144
v_mfma_f32_16x16x32_bf16 v[116:119], a[108:111], a[132:135], v[116:119]
v_mfma_f32_16x16x32_bf16 v[120:123], a[112:115], a[128:131], v[120:123]
ds_read_b128 a[28:31], v3 offset:6144
v_mfma_f32_16x16x32_bf16 v[120:123], a[116:119], a[132:135], v[120:123]
buffer_load_dwordx4 v15, s[8:11], s25 offen offset:3072 lds
v_mfma_f32_16x16x32_bf16 v[124:127], a[120:123], a[128:131], v[124:127]
s_add_u32 s25, s25, 128
v_mfma_f32_16x16x32_bf16 v[124:127], a[124:127], a[132:135], v[124:127]
s_waitcnt lgkmcnt(2)
v_mfma_f32_16x16x32_bf16 v[128:131], a[64:67], a[136:139], v[128:131]
s_mov_b64 s[56:57], s[70:71]
s_mov_b32 s58, 3584
s_mov_b32 s59, 0x20000
ds_read_b64_tr_b16 a[128:129], v8 offset:32768
buffer_load_dwordx4 v[248:251], v252, s[56:59], 0 offen
v_mfma_f32_16x16x32_bf16 v[128:131], a[68:71], a[140:143], v[128:131]
s_mov_b64 s[56:57], s[66:67]
s_mov_b32 s58, 1835008
buffer_load_dword v224, v22, s[56:59], 0 offen nt
v_mfma_f32_16x16x32_bf16 v[132:135], a[72:75], a[136:139], v[132:135]
ds_read_b64_tr_b16 a[130:131], v8 offset:34816
buffer_load_dword v225, v23, s[56:59], 0 offen nt
v_mfma_f32_16x16x32_bf16 v[132:135], a[76:79], a[140:143], v[132:135]
buffer_load_dword v226, v24, s[56:59], 0 offen nt
v_mfma_f32_16x16x32_bf16 v[136:139], a[80:83], a[136:139], v[136:139]
ds_read_b64_tr_b16 a[132:133], v8 offset:49152
buffer_load_dword v227, v25, s[56:59], 0 offen nt
v_mfma_f32_16x16x32_bf16 v[136:139], a[84:87], a[140:143], v[136:139]
buffer_load_dword v228, v254, s[56:59], 0 offen offset:0 nt
v_mfma_f32_16x16x32_bf16 v[140:143], a[88:91], a[136:139], v[140:143]
ds_read_b64_tr_b16 a[134:135], v8 offset:51200
buffer_load_dword v229, v254, s[56:59], 0 offen offset:896 nt
v_mfma_f32_16x16x32_bf16 v[140:143], a[92:95], a[140:143], v[140:143]
buffer_load_dword v230, v254, s[56:59], 0 offen offset:1792 nt
v_mfma_f32_16x16x32_bf16 v[144:147], a[96:99], a[136:139], v[144:147]
ds_read_b128 a[32:35], v2 offset:8192
buffer_load_dword v231, v254, s[56:59], 0 offen offset:2688 nt
v_mfma_f32_16x16x32_bf16 v[144:147], a[100:103], a[140:143], v[144:147]
buffer_load_dword v232, v255, s[56:59], 0 offen offset:0 nt
v_mfma_f32_16x16x32_bf16 v[148:151], a[104:107], a[136:139], v[148:151]
buffer_load_dword v233, v255, s[56:59], 0 offen offset:896 nt
v_mfma_f32_16x16x32_bf16 v[148:151], a[108:111], a[140:143], v[148:151]
buffer_load_dword v234, v255, s[56:59], 0 offen offset:1792 nt
v_mfma_f32_16x16x32_bf16 v[152:155], a[112:115], a[136:139], v[152:155]
ds_read_b128 a[36:39], v3 offset:8192
buffer_load_dword v235, v255, s[56:59], 0 offen offset:2688 nt
v_mfma_f32_16x16x32_bf16 v[152:155], a[116:119], a[140:143], v[152:155]
s_mov_b64 s[56:57], s[68:69]
buffer_load_dword v236, v25, s[56:59], 0 offen nt
v_mfma_f32_16x16x32_bf16 v[156:159], a[120:123], a[136:139], v[156:159]
ds_read_b128 a[40:43], v2 offset:10240
buffer_load_dword v237, v254, s[56:59], 0 offen offset:0 nt
v_mfma_f32_16x16x32_bf16 v[156:159], a[124:127], a[140:143], v[156:159]
s_waitcnt lgkmcnt(3)
buffer_load_dword v238, v254, s[56:59], 0 offen offset:896 nt
v_mfma_f32_16x16x32_bf16 v[160:163], a[64:67], a[128:131], v[160:163]
ds_read_b64_tr_b16 a[136:137], v9 offset:32768
buffer_load_dword v239, v254, s[56:59], 0 offen offset:1792 nt
v_mfma_f32_16x16x32_bf16 v[160:163], a[68:71], a[132:135], v[160:163]
buffer_load_dword v240, v254, s[56:59], 0 offen offset:2688 nt
v_mfma_f32_16x16x32_bf16 v[164:167], a[72:75], a[128:131], v[164:167]
ds_read_b64_tr_b16 a[138:139], v9 offset:34816
buffer_load_dword v241, v255, s[56:59], 0 offen offset:0 nt
v_mfma_f32_16x16x32_bf16 v[164:167], a[76:79], a[132:135], v[164:167]
buffer_load_dword v242, v255, s[56:59], 0 offen offset:896 nt
v_mfma_f32_16x16x32_bf16 v[168:171], a[80:83], a[128:131], v[168:171]
ds_read_b64_tr_b16 a[140:141], v9 offset:49152
buffer_load_dword v243, v255, s[56:59], 0 offen offset:1792 nt
v_mfma_f32_16x16x32_bf16 v[168:171], a[84:87], a[132:135], v[168:171]
buffer_load_dword v244, v255, s[56:59], 0 offen offset:2688 nt
v_mfma_f32_16x16x32_bf16 v[172:175], a[88:91], a[128:131], v[172:175]
ds_read_b64_tr_b16 a[142:143], v9 offset:51200
v_mfma_f32_16x16x32_bf16 v[172:175], a[92:95], a[132:135], v[172:175]
v_mfma_f32_16x16x32_bf16 v[176:179], a[96:99], a[128:131], v[176:179]
v_mfma_f32_16x16x32_bf16 v[176:179], a[100:103], a[132:135], v[176:179]
v_mfma_f32_16x16x32_bf16 v[180:183], a[104:107], a[128:131], v[180:183]
ds_read_b128 a[44:47], v3 offset:10240
v_mfma_f32_16x16x32_bf16 v[180:183], a[108:111], a[132:135], v[180:183]
v_mfma_f32_16x16x32_bf16 v[184:187], a[112:115], a[128:131], v[184:187]
ds_read_b128 a[48:51], v2 offset:12288
v_mfma_f32_16x16x32_bf16 v[184:187], a[116:119], a[132:135], v[184:187]
v_mfma_f32_16x16x32_bf16 v[188:191], a[120:123], a[128:131], v[188:191]
v_mfma_f32_16x16x32_bf16 v[188:191], a[124:127], a[132:135], v[188:191]
s_waitcnt lgkmcnt(2)
v_mfma_f32_16x16x32_bf16 v[192:195], a[64:67], a[136:139], v[192:195]
ds_read_b64_tr_b16 a[128:129], v10 offset:32768
v_mfma_f32_16x16x32_bf16 v[192:195], a[68:71], a[140:143], v[192:195]
v_mfma_f32_16x16x32_bf16 v[196:199], a[72:75], a[136:139], v[196:199]
ds_read_b64_tr_b16 a[130:131], v10 offset:34816
v_mfma_f32_16x16x32_bf16 v[196:199], a[76:79], a[140:143], v[196:199]
v_mfma_f32_16x16x32_bf16 v[200:203], a[80:83], a[136:139], v[200:203]
ds_read_b64_tr_b16 a[132:133], v10 offset:49152
v_mfma_f32_16x16x32_bf16 v[200:203], a[84:87], a[140:143], v[200:203]
v_mfma_f32_16x16x32_bf16 v[204:207], a[88:91], a[136:139], v[204:207]
ds_read_b64_tr_b16 a[134:135], v10 offset:51200
v_mfma_f32_16x16x32_bf16 v[204:207], a[92:95], a[140:143], v[204:207]
v_mfma_f32_16x16x32_bf16 v[208:211], a[96:99], a[136:139], v[208:211]
ds_read_b128 a[52:55], v3 offset:12288
v_mfma_f32_16x16x32_bf16 v[208:211], a[100:103], a[140:143], v[208:211]
v_mfma_f32_16x16x32_bf16 v[212:215], a[104:107], a[136:139], v[212:215]
ds_read_b128 a[56:59], v2 offset:14336
v_mfma_f32_16x16x32_bf16 v[212:215], a[108:111], a[140:143], v[212:215]
v_mfma_f32_16x16x32_bf16 v[216:219], a[112:115], a[136:139], v[216:219]
v_mfma_f32_16x16x32_bf16 v[216:219], a[116:119], a[140:143], v[216:219]
v_mfma_f32_16x16x32_bf16 v[220:223], a[120:123], a[136:139], v[220:223]
ds_read_b128 a[60:63], v3 offset:14336
v_mfma_f32_16x16x32_bf16 v[220:223], a[124:127], a[140:143], v[220:223]
s_waitcnt lgkmcnt(3)
v_mfma_f32_16x16x32_bf16 a[192:195], a[64:67], a[128:131], a[192:195]
ds_read_b64_tr_b16 a[136:137], v11 offset:32768
v_mfma_f32_16x16x32_bf16 a[192:195], a[68:71], a[132:135], a[192:195]
v_mfma_f32_16x16x32_bf16 a[196:199], a[72:75], a[128:131], a[196:199]
ds_read_b64_tr_b16 a[138:139], v11 offset:34816
v_mfma_f32_16x16x32_bf16 a[196:199], a[76:79], a[132:135], a[196:199]
v_mfma_f32_16x16x32_bf16 a[200:203], a[80:83], a[128:131], a[200:203]
ds_read_b64_tr_b16 a[140:141], v11 offset:49152
v_mfma_f32_16x16x32_bf16 a[200:203], a[84:87], a[132:135], a[200:203]
v_mfma_f32_16x16x32_bf16 a[204:207], a[88:91], a[128:131], a[204:207]
ds_read_b64_tr_b16 a[142:143], v11 offset:51200
v_mfma_f32_16x16x32_bf16 a[204:207], a[92:95], a[132:135], a[204:207]
v_mfma_f32_16x16x32_bf16 a[208:211], a[96:99], a[128:131], a[208:211]
v_mfma_f32_16x16x32_bf16 a[208:211], a[100:103], a[132:135], a[208:211]
v_mfma_f32_16x16x32_bf16 a[212:215], a[104:107], a[128:131], a[212:215]
v_mfma_f32_16x16x32_bf16 a[212:215], a[108:111], a[132:135], a[212:215]
v_mfma_f32_16x16x32_bf16 a[216:219], a[112:115], a[128:131], a[216:219]
v_mfma_f32_16x16x32_bf16 a[216:219], a[116:119], a[132:135], a[216:219]
v_mfma_f32_16x16x32_bf16 a[220:223], a[120:123], a[128:131], a[220:223]
s_waitcnt vmcnt(22) lgkmcnt(0)
v_mfma_f32_16x16x32_bf16 a[220:223], a[124:127], a[132:135], a[220:223]
s_barrier
v_mfma_f32_16x16x32_bf16 a[224:227], a[64:67], a[136:139], a[224:227]
s_add_u32 m0, s29, 98304
ds_read_b64_tr_b16 a[128:129], v4 offset:0
v_mfma_f32_16x16x32_bf16 a[224:227], a[68:71], a[140:143], a[224:227]
buffer_load_dwordx4 v16, s[12:15], s26 offen offset:0 lds
v_mfma_f32_16x16x32_bf16 a[228:231], a[72:75], a[136:139], a[228:231]
ds_read_b64_tr_b16 a[130:131], v4 offset:2048
v_mfma_f32_16x16x32_bf16 a[228:231], a[76:79], a[140:143], a[228:231]
v_mfma_f32_16x16x32_bf16 a[232:235], a[80:83], a[136:139], a[232:235]
ds_read_b64_tr_b16 a[132:133], v4 offset:16384
v_mfma_f32_16x16x32_bf16 a[232:235], a[84:87], a[140:143], a[232:235]
buffer_load_dwordx4 v17, s[12:15], s26 offen offset:1024 lds
v_mfma_f32_16x16x32_bf16 a[236:239], a[88:91], a[136:139], a[236:239]
ds_read_b64_tr_b16 a[134:135], v4 offset:18432
v_mfma_f32_16x16x32_bf16 a[236:239], a[92:95], a[140:143], a[236:239]
v_mfma_f32_16x16x32_bf16 a[240:243], a[96:99], a[136:139], a[240:243]
v_mfma_f32_16x16x32_bf16 a[240:243], a[100:103], a[140:143], a[240:243]
buffer_load_dwordx4 v18, s[12:15], s26 offen offset:2048 lds
v_mfma_f32_16x16x32_bf16 a[244:247], a[104:107], a[136:139], a[244:247]
v_mfma_f32_16x16x32_bf16 a[244:247], a[108:111], a[140:143], a[244:247]
v_mfma_f32_16x16x32_bf16 a[248:251], a[112:115], a[136:139], a[248:251]
v_mfma_f32_16x16x32_bf16 a[248:251], a[116:119], a[140:143], a[248:251]
buffer_load_dwordx4 v19, s[12:15], s26 offen offset:3072 lds
v_mfma_f32_16x16x32_bf16 a[252:255], a[120:123], a[136:139], a[252:255]
s_add_u32 s26, s26, 524288
v_mfma_f32_16x16x32_bf16 a[252:255], a[124:127], a[140:143], a[252:255]
s_waitcnt lgkmcnt(0)
v_mfma_f32_16x16x32_bf16 v[32:35], a[0:3], a[128:131], v[32:35]
s_add_u32 m0, s29, 114688
ds_read_b64_tr_b16 a[136:137], v5 offset:0
v_mfma_f32_16x16x32_bf16 v[32:35], a[4:7], a[132:135], v[32:35]
buffer_load_dwordx4 v16, s[12:15], s27 offen offset:0 lds
v_mfma_f32_16x16x32_bf16 v[36:39], a[8:11], a[128:131], v[36:39]
ds_read_b64_tr_b16 a[138:139], v5 offset:2048
v_mfma_f32_16x16x32_bf16 v[36:39], a[12:15], a[132:135], v[36:39]
v_mfma_f32_16x16x32_bf16 v[40:43], a[16:19], a[128:131], v[40:43]
ds_read_b64_tr_b16 a[140:141], v5 offset:16384
v_mfma_f32_16x16x32_bf16 v[40:43], a[20:23], a[132:135], v[40:43]
buffer_load_dwordx4 v17, s[12:15], s27 offen offset:1024 lds
v_mfma_f32_16x16x32_bf16 v[44:47], a[24:27], a[128:131], v[44:47]
ds_read_b64_tr_b16 a[142:143], v5 offset:18432
v_mfma_f32_16x16x32_bf16 v[44:47], a[28:31], a[132:135], v[44:47]
v_mfma_f32_16x16x32_bf16 v[48:51], a[32:35], a[128:131], v[48:51]
ds_read_b128 a[64:67], v2 offset:32768
v_mfma_f32_16x16x32_bf16 v[48:51], a[36:39], a[132:135], v[48:51]
buffer_load_dwordx4 v18, s[12:15], s27 offen offset:2048 lds
v_mfma_f32_16x16x32_bf16 v[52:55], a[40:43], a[128:131], v[52:55]
ds_read_b128 a[68:71], v3 offset:32768
v_mfma_f32_16x16x32_bf16 v[52:55], a[44:47], a[132:135], v[52:55]
v_mfma_f32_16x16x32_bf16 v[56:59], a[48:51], a[128:131], v[56:59]
v_mfma_f32_16x16x32_bf16 v[56:59], a[52:55], a[132:135], v[56:59]
buffer_load_dwordx4 v19, s[12:15], s27 offen offset:3072 lds
v_mfma_f32_16x16x32_bf16 v[60:63], a[56:59], a[128:131], v[60:63]
s_add_u32 s27, s27, 524288
ds_read_b128 a[72:75], v2 offset:34816
v_mfma_f32_16x16x32_bf16 v[60:63], a[60:63], a[132:135], v[60:63]
s_waitcnt lgkmcnt(3)
v_mfma_f32_16x16x32_bf16 v[64:67], a[0:3], a[136:139], v[64:67]
s_add_u32 m0, s28, 0
ds_read_b64_tr_b16 a[128:129], v6 offset:0
v_mfma_f32_16x16x32_bf16 v[64:67], a[4:7], a[140:143], v[64:67]
buffer_load_dwordx4 v12, s[8:11], s24 offen offset:0 lds
v_mfma_f32_16x16x32_bf16 v[68:71], a[8:11], a[136:139], v[68:71]
ds_read_b64_tr_b16 a[130:131], v6 offset:2048
v_mfma_f32_16x16x32_bf16 v[68:71], a[12:15], a[140:143], v[68:71]
v_mfma_f32_16x16x32_bf16 v[72:75], a[16:19], a[136:139], v[72:75]
ds_read_b64_tr_b16 a[132:133], v6 offset:16384
v_mfma_f32_16x16x32_bf16 v[72:75], a[20:23], a[140:143], v[72:75]
buffer_load_dwordx4 v13, s[8:11], s24 offen offset:1024 lds
v_mfma_f32_16x16x32_bf16 v[76:79], a[24:27], a[136:139], v[76:79]
ds_read_b64_tr_b16 a[134:135], v6 offset:18432
v_mfma_f32_16x16x32_bf16 v[76:79], a[28:31], a[140:143], v[76:79]
v_mfma_f32_16x16x32_bf16 v[80:83], a[32:35], a[136:139], v[80:83]
ds_read_b128 a[76:79], v3 offset:34816
v_mfma_f32_16x16x32_bf16 v[80:83], a[36:39], a[140:143], v[80:83]
buffer_load_dwordx4 v14, s[8:11], s24 offen offset:2048 lds
v_mfma_f32_16x16x32_bf16 v[84:87], a[40:43], a[136:139], v[84:87]
v_mfma_f32_16x16x32_bf16 v[84:87], a[44:47], a[140:143], v[84:87]
v_mfma_f32_16x16x32_bf16 v[88:91], a[48:51], a[136:139], v[88:91]
ds_read_b128 a[80:83], v2 offset:36864
v_mfma_f32_16x16x32_bf16 v[88:91], a[52:55], a[140:143], v[88:91]
buffer_load_dwordx4 v15, s[8:11], s24 offen offset:3072 lds
v_mfma_f32_16x16x32_bf16 v[92:95], a[56:59], a[136:139], v[92:95]
s_add_u32 s24, s24, 128
ds_read_b128 a[84:87], v3 offset:36864
v_mfma_f32_16x16x32_bf16 v[92:95], a[60:63], a[140:143], v[92:95]
s_waitcnt lgkmcnt(3)
v_mfma_f32_16x16x32_bf16 v[96:99], a[0:3], a[128:131], v[96:99]
s_add_u32 m0, s28, 4096
ds_read_b64_tr_b16 a[136:137], v7 offset:0
v_mfma_f32_16x16x32_bf16 v[96:99], a[4:7], a[132:135], v[96:99]
buffer_load_dwordx4 v12, s[8:11], s25 offen offset:0 lds
v_mfma_f32_16x16x32_bf16 v[100:103], a[8:11], a[128:131], v[100:103]
ds_read_b64_tr_b16 a[138:139], v7 offset:2048
v_mfma_f32_16x16x32_bf16 v[100:103], a[12:15], a[132:135], v[100:103]
v_mfma_f32_16x16x32_bf16 v[104:107], a[16:19], a[128:131], v[104:107]
ds_read_b64_tr_b16 a[140:141], v7 offset:16384
v_mfma_f32_16x16x32_bf16 v[104:107], a[20:23], a[132:135], v[104:107]
buffer_load_dwordx4 v13, s[8:11], s25 offen offset:1024 lds
v_mfma_f32_16x16x32_bf16 v[108:111], a[24:27], a[128:131], v[108:111]
ds_read_b64_tr_b16 a[142:143], v7 offset:18432
v_mfma_f32_16x16x32_bf16 v[108:111], a[28:31], a[132:135], v[108:111]
v_mfma_f32_16x16x32_bf16 v[112:115], a[32:35], a[128:131], v[112:115]
v_mfma_f32_16x16x32_bf16 v[112:115], a[36:39], a[132:135], v[112:115]
buffer_load_dwordx4 v14, s[8:11], s25 offen offset:2048 lds
v_mfma_f32_16x16x32_bf16 v[116:119], a[40:43], a[128:131], v[116:119]
ds_read_b128 a[88:91], v2 offset:38912
v_mfma_f32_16x16x32_bf16 v[116:119], a[44:47], a[132:135], v[116:119]
v_mfma_f32_16x16x32_bf16 v[120:123], a[48:51], a[128:131], v[120:123]
ds_read_b128 a[92:95], v3 offset:38912
v_mfma_f32_16x16x32_bf16 v[120:123], a[52:55], a[132:135], v[120:123]
buffer_load_dwordx4 v15, s[8:11], s25 offen offset:3072 lds
v_mfma_f32_16x16x32_bf16 v[124:127], a[56:59], a[128:131], v[124:127]
s_add_u32 s25, s25, 128
v_mfma_f32_16x16x32_bf16 v[124:127], a[60:63], a[132:135], v[124:127]
s_waitcnt lgkmcnt(2)
v_mfma_f32_16x16x32_bf16 v[128:131], a[0:3], a[136:139], v[128:131]
ds_read_b64_tr_b16 a[128:129], v8 offset:0
v_mfma_f32_16x16x32_bf16 v[128:131], a[4:7], a[140:143], v[128:131]
buffer_load_dword v21, v20, s[16:19], s43 offen
v_mfma_f32_16x16x32_bf16 v[132:135], a[8:11], a[136:139], v[132:135]
s_add_u32 s43, s43, s47
ds_read_b64_tr_b16 a[130:131], v8 offset:2048
v_mfma_f32_16x16x32_bf16 v[132:135], a[12:15], a[140:143], v[132:135]
s_cmp_ge_u32 s43, s51
v_mfma_f32_16x16x32_bf16 v[136:139], a[16:19], a[136:139], v[136:139]
s_cselect_b32 s43, 0, s43
ds_read_b64_tr_b16 a[132:133], v8 offset:16384
v_mfma_f32_16x16x32_bf16 v[136:139], a[20:23], a[140:143], v[136:139]
s_cselect_b32 s51, s42, s51
v_mfma_f32_16x16x32_bf16 v[140:143], a[24:27], a[136:139], v[140:143]
s_cselect_b64 s[16:17], s[40:41], s[16:17]
ds_read_b64_tr_b16 a[134:135], v8 offset:18432
v_mfma_f32_16x16x32_bf16 v[140:143], a[28:31], a[140:143], v[140:143]
s_cselect_b32 s18, s42, s18
v_mfma_f32_16x16x32_bf16 v[144:147], a[32:35], a[136:139], v[144:147]
s_cselect_b64 s[40:41], s[44:45], s[40:41]
ds_read_b128 a[96:99], v2 offset:40960
v_mfma_f32_16x16x32_bf16 v[144:147], a[36:39], a[140:143], v[144:147]
s_cselect_b32 s42, s46, s42
v_mfma_f32_16x16x32_bf16 v[148:151], a[40:43], a[136:139], v[148:151]
s_cselect_b32 s46, 0, s46
v_mfma_f32_16x16x32_bf16 v[148:151], a[44:47], a[140:143], v[148:151]
s_lshl_b32 s59, s39, 5
v_mfma_f32_16x16x32_bf16 v[152:155], a[48:51], a[136:139], v[152:155]
s_add_u32 s59, s59, s38
ds_read_b128 a[100:103], v3 offset:40960
v_mfma_f32_16x16x32_bf16 v[152:155], a[52:55], a[140:143], v[152:155]
s_lshl_b32 s59, s59, 2
v_mfma_f32_16x16x32_bf16 v[156:159], a[56:59], a[136:139], v[156:159]
s_add_u32 s59, s59, 94392320
ds_read_b128 a[104:107], v2 offset:43008
v_mfma_f32_16x16x32_bf16 v[156:159], a[60:63], a[140:143], v[156:159]
s_waitcnt lgkmcnt(3)
s_cmp_lt_u32 s2, 224
v_mfma_f32_16x16x32_bf16 v[160:163], a[0:3], a[128:131], v[160:163]
s_cselect_b32 s59, s59, 3221225472
ds_read_b64_tr_b16 a[136:137], v9 offset:0
v_mfma_f32_16x16x32_bf16 v[160:163], a[4:7], a[132:135], v[160:163]
s_mov_b32 s58, 0xffff0000
v_mfma_f32_16x16x32_bf16 v[164:167], a[8:11], a[128:131], v[164:167]
ds_read_b64_tr_b16 a[138:139], v9 offset:2048
v_mfma_f32_16x16x32_bf16 v[164:167], a[12:15], a[132:135], v[164:167]
buffer_load_dword v21, v20, s[16:19], s43 offen
v_mfma_f32_16x16x32_bf16 v[168:171], a[16:19], a[128:131], v[168:171]
s_add_u32 s43, s43, s47
ds_read_b64_tr_b16 a[140:141], v9 offset:16384
v_mfma_f32_16x16x32_bf16 v[168:171], a[20:23], a[132:135], v[168:171]
s_cmp_ge_u32 s43, s51
v_mfma_f32_16x16x32_bf16 v[172:175], a[24:27], a[128:131], v[172:175]
s_cselect_b32 s43, 0, s43
ds_read_b64_tr_b16 a[142:143], v9 offset:18432
v_mfma_f32_16x16x32_bf16 v[172:175], a[28:31], a[132:135], v[172:175]
s_cselect_b32 s51, s42, s51
v_mfma_f32_16x16x32_bf16 v[176:179], a[32:35], a[128:131], v[176:179]
s_cselect_b64 s[16:17], s[40:41], s[16:17]
v_mfma_f32_16x16x32_bf16 v[176:179], a[36:39], a[132:135], v[176:179]
s_cselect_b32 s18, s42, s18
v_mfma_f32_16x16x32_bf16 v[180:183], a[40:43], a[128:131], v[180:183]
s_cselect_b64 s[40:41], s[44:45], s[40:41]
ds_read_b128 a[108:111], v3 offset:43008
v_mfma_f32_16x16x32_bf16 v[180:183], a[44:47], a[132:135], v[180:183]
s_cselect_b32 s42, s46, s42
v_mfma_f32_16x16x32_bf16 v[184:187], a[48:51], a[128:131], v[184:187]
s_cselect_b32 s46, 0, s46
ds_read_b128 a[112:115], v2 offset:45056
v_mfma_f32_16x16x32_bf16 v[184:187], a[52:55], a[132:135], v[184:187]
v_mfma_f32_16x16x32_bf16 v[188:191], a[56:59], a[128:131], v[188:191]
v_mfma_f32_16x16x32_bf16 v[188:191], a[60:63], a[132:135], v[188:191]
s_waitcnt lgkmcnt(2)
v_mfma_f32_16x16x32_bf16 v[192:195], a[0:3], a[136:139], v[192:195]
ds_read_b64_tr_b16 a[128:129], v10 offset:0
v_mfma_f32_16x16x32_bf16 v[192:195], a[4:7], a[140:143], v[192:195]
v_mfma_f32_16x16x32_bf16 v[196:199], a[8:11], a[136:139], v[196:199]
ds_read_b64_tr_b16 a[130:131], v10 offset:2048
v_mfma_f32_16x16x32_bf16 v[196:199], a[12:15], a[140:143], v[196:199]
v_mfma_f32_16x16x32_bf16 v[200:203], a[16:19], a[136:139], v[200:203]
ds_read_b64_tr_b16 a[132:133], v10 offset:16384
v_mfma_f32_16x16x32_bf16 v[200:203], a[20:23], a[140:143], v[200:203]
v_mfma_f32_16x16x32_bf16 v[204:207], a[24:27], a[136:139], v[204:207]
ds_read_b64_tr_b16 a[134:135], v10 offset:18432
v_mfma_f32_16x16x32_bf16 v[204:207], a[28:31], a[140:143], v[204:207]
v_mfma_f32_16x16x32_bf16 v[208:211], a[32:35], a[136:139], v[208:211]
ds_read_b128 a[116:119], v3 offset:45056
v_mfma_f32_16x16x32_bf16 v[208:211], a[36:39], a[140:143], v[208:211]
v_mfma_f32_16x16x32_bf16 v[212:215], a[40:43], a[136:139], v[212:215]
ds_read_b128 a[120:123], v2 offset:47104
v_and_b32 v252, 31, v0
v_mfma_f32_16x16x32_bf16 v[212:215], a[44:47], a[140:143], v[212:215]
v_lshrrev_b32 v253, 5, v0
v_xor_b32 v253, v253, v252
v_mfma_f32_16x16x32_bf16 v[216:219], a[48:51], a[136:139], v[216:219]
v_and_b32 v253, 7, v253
v_lshlrev_b32 v252, 8, v252
v_mfma_f32_16x16x32_bf16 v[216:219], a[52:55], a[140:143], v[216:219]
v_lshl_add_u32 v252, v253, 4, v252
v_add_u32 v252, 147456, v252
v_mfma_f32_16x16x32_bf16 v[220:223], a[56:59], a[136:139], v[220:223]
ds_read_b128 a[124:127], v3 offset:47104
v_mfma_f32_16x16x32_bf16 v[220:223], a[60:63], a[140:143], v[220:223]
s_waitcnt lgkmcnt(3)
v_mfma_f32_16x16x32_bf16 a[192:195], a[0:3], a[128:131], a[192:195]
ds_read_b64_tr_b16 a[136:137], v11 offset:0
v_mfma_f32_16x16x32_bf16 a[192:195], a[4:7], a[132:135], a[192:195]
v_mfma_f32_16x16x32_bf16 a[196:199], a[8:11], a[128:131], a[196:199]
ds_read_b64_tr_b16 a[138:139], v11 offset:2048
v_mfma_f32_16x16x32_bf16 a[196:199], a[12:15], a[132:135], a[196:199]
v_mfma_f32_16x16x32_bf16 a[200:203], a[16:19], a[128:131], a[200:203]
ds_read_b64_tr_b16 a[140:141], v11 offset:16384
v_mfma_f32_16x16x32_bf16 a[200:203], a[20:23], a[132:135], a[200:203]
v_mfma_f32_16x16x32_bf16 a[204:207], a[24:27], a[128:131], a[204:207]
ds_read_b64_tr_b16 a[142:143], v11 offset:18432
v_mfma_f32_16x16x32_bf16 a[204:207], a[28:31], a[132:135], a[204:207]
v_mfma_f32_16x16x32_bf16 a[208:211], a[32:35], a[128:131], a[208:211]
v_mfma_f32_16x16x32_bf16 a[208:211], a[36:39], a[132:135], a[208:211]
v_mfma_f32_16x16x32_bf16 a[212:215], a[40:43], a[128:131], a[212:215]
v_mfma_f32_16x16x32_bf16 a[212:215], a[44:47], a[132:135], a[212:215]
v_mfma_f32_16x16x32_bf16 a[216:219], a[48:51], a[128:131], a[216:219]
v_mfma_f32_16x16x32_bf16 a[216:219], a[52:55], a[132:135], a[216:219]
v_mfma_f32_16x16x32_bf16 a[220:223], a[56:59], a[128:131], a[220:223]
s_waitcnt vmcnt(2) lgkmcnt(0)
v_mfma_f32_16x16x32_bf16 a[220:223], a[60:63], a[132:135], a[220:223]
s_barrier
v_mfma_f32_16x16x32_bf16 a[224:227], a[0:3], a[136:139], a[224:227]
s_add_u32 m0, s29, 65536
ds_read_b64_tr_b16 a[128:129], v4 offset:32768
v_lshlrev_b32 v28, 16, v248
v_mfma_f32_16x16x32_bf16 a[224:227], a[4:7], a[140:143], a[224:227]
buffer_load_dwordx4 v16, s[12:15], s26 offen offset:0 lds
v_mfma_f32_16x16x32_bf16 a[228:231], a[8:11], a[136:139], a[228:231]
ds_read_b64_tr_b16 a[130:131], v4 offset:34816
v_and_b32 v29, s58, v248
v_mfma_f32_16x16x32_bf16 a[228:231], a[12:15], a[140:143], a[228:231]
v_lshlrev_b32 v30, 16, v249
v_and_b32 v253, s58, v249
v_mfma_f32_16x16x32_bf16 a[232:235], a[16:19], a[136:139], a[232:235]
ds_read_b64_tr_b16 a[132:133], v4 offset:49152
v_lshlrev_b32 v22, 16, v224
v_mfma_f32_16x16x32_bf16 a[232:235], a[20:23], a[140:143], a[232:235]
buffer_load_dwordx4 v17, s[12:15], s26 offen offset:1024 lds
v_mfma_f32_16x16x32_bf16 a[236:239], a[24:27], a[136:139], a[236:239]
ds_read_b64_tr_b16 a[134:135], v4 offset:51200
v_lshlrev_b32 v23, 16, v225
v_mfma_f32_16x16x32_bf16 a[236:239], a[28:31], a[140:143], a[236:239]
v_lshlrev_b32 v24, 16, v226
v_mul_f32 v254, v22, v253
v_mfma_f32_16x16x32_bf16 a[240:243], a[32:35], a[136:139], a[240:243]
v_lshlrev_b32 v25, 16, v227
v_lshlrev_b32 v247, 16, v236
v_mfma_f32_16x16x32_bf16 a[240:243], a[36:39], a[140:143], a[240:243]
buffer_load_dwordx4 v18, s[12:15], s26 offen offset:2048 lds
v_mfma_f32_16x16x32_bf16 a[244:247], a[40:43], a[136:139], a[244:247]
v_fmac_f32 v254, v23, v30
v_fmac_f32 v254, v24, v29
v_mfma_f32_16x16x32_bf16 a[244:247], a[44:47], a[140:143], a[244:247]
v_fmac_f32 v254, v25, v28
v_mul_f32 v254, v254, v247
v_mfma_f32_16x16x32_bf16 a[248:251], a[48:51], a[136:139], a[248:251]
v_mul_f32 v255, v23, v253
v_lshlrev_b32 v22, 16, v228
v_mfma_f32_16x16x32_bf16 a[248:251], a[52:55], a[140:143], a[248:251]
buffer_load_dwordx4 v19, s[12:15], s26 offen offset:3072 lds
v_mfma_f32_16x16x32_bf16 a[252:255], a[56:59], a[136:139], a[252:255]
s_add_u32 s26, s26, 524288
v_lshlrev_b32 v247, 16, v237
v_fmac_f32 v255, v24, v30
v_mfma_f32_16x16x32_bf16 a[252:255], a[60:63], a[140:143], a[252:255]
s_waitcnt lgkmcnt(0)
v_fmac_f32 v255, v25, v29
v_fmac_f32 v255, v22, v28
v_mfma_f32_16x16x32_bf16 v[32:35], a[64:67], a[128:131], v[32:35]
s_add_u32 m0, s29, 81920
ds_read_b64_tr_b16 a[136:137], v5 offset:32768
v_mul_f32 v255, v255, v247
v_mfma_f32_16x16x32_bf16 v[32:35], a[68:71], a[132:135], v[32:35]
buffer_load_dwordx4 v16, s[12:15], s27 offen offset:0 lds
v_mfma_f32_16x16x32_bf16 v[36:39], a[72:75], a[128:131], v[36:39]
ds_read_b64_tr_b16 a[138:139], v5 offset:34816
v_cvt_pk_bf16_f32 v246, v254, v255
v_mfma_f32_16x16x32_bf16 v[36:39], a[76:79], a[132:135], v[36:39]
v_accvgpr_write_b32 a180, v246
v_mul_f32 v254, v24, v253
v_mfma_f32_16x16x32_bf16 v[40:43], a[80:83], a[128:131], v[40:43]
ds_read_b64_tr_b16 a[140:141], v5 offset:49152
v_lshlrev_b32 v23, 16, v229
v_mfma_f32_16x16x32_bf16 v[40:43], a[84:87], a[132:135], v[40:43]
buffer_load_dwordx4 v17, s[12:15], s27 offen offset:1024 lds
v_lshlrev_b32 v247, 16, v238
v_mfma_f32_16x16x32_bf16 v[44:47], a[88:91], a[128:131], v[44:47]
ds_read_b64_tr_b16 a[142:143], v5 offset:51200
v_fmac_f32 v254, v25, v30
v_mfma_f32_16x16x32_bf16 v[44:47], a[92:95], a[132:135], v[44:47]
v_fmac_f32 v254, v22, v29
v_fmac_f32 v254, v23, v28
v_mfma_f32_16x16x32_bf16 v[48:51], a[96:99], a[128:131], v[48:51]
ds_read_b128 a[0:3], v2 offset:0
v_mul_f32 v254, v254, v247
v_mfma_f32_16x16x32_bf16 v[48:51], a[100:103], a[132:135], v[48:51]
buffer_load_dwordx4 v18, s[12:15], s27 offen offset:2048 lds
v_mfma_f32_16x16x32_bf16 v[52:55], a[104:107], a[128:131], v[52:55]
ds_read_b128 a[4:7], v3 offset:0
v_cvt_pk_bf16_f32 v246, v255, v254
v_accvgpr_write_b32 a176, v246
v_mfma_f32_16x16x32_bf16 v[52:55], a[108:111], a[132:135], v[52:55]
v_mul_f32 v255, v25, v253
v_lshlrev_b32 v24, 16, v230
v_mfma_f32_16x16x32_bf16 v[56:59], a[112:115], a[128:131], v[56:59]
v_lshlrev_b32 v247, 16, v239
v_fmac_f32 v255, v22, v30
v_mfma_f32_16x16x32_bf16 v[56:59], a[116:119], a[132:135], v[56:59]
buffer_load_dwordx4 v19, s[12:15], s27 offen offset:3072 lds
v_mfma_f32_16x16x32_bf16 v[60:63], a[120:123], a[128:131], v[60:63]
s_add_u32 s27, s27, 524288
ds_read_b128 a[8:11], v2 offset:2048
v_fmac_f32 v255, v23, v29
v_mfma_f32_16x16x32_bf16 v[60:63], a[124:127], a[132:135], v[60:63]
s_waitcnt lgkmcnt(3)
v_fmac_f32 v255, v24, v28
v_mul_f32 v255, v255, v247
v_mfma_f32_16x16x32_bf16 v[64:67], a[64:67], a[136:139], v[64:67]
s_add_u32 m0, s28, 32768
ds_read_b64_tr_b16 a[128:129], v6 offset:32768
v_cvt_pk_bf16_f32 v246, v254, v255
v_accvgpr_write_b32 a181, v246
v_mfma_f32_16x16x32_bf16 v[64:67], a[68:71], a[140:143], v[64:67]
buffer_load_dwordx4 v12, s[8:11], s24 offen offset:0 lds
v_mfma_f32_16x16x32_bf16 v[68:71], a[72:75], a[136:139], v[68:71]
ds_read_b64_tr_b16 a[130:131], v6 offset:34816
v_mul_f32 v254, v22, v253
v_mfma_f32_16x16x32_bf16 v[68:71], a[76:79], a[140:143], v[68:71]
v_lshlrev_b32 v25, 16, v231
v_lshlrev_b32 v247, 16, v240
v_mfma_f32_16x16x32_bf16 v[72:75], a[80:83], a[136:139], v[72:75]
ds_read_b64_tr_b16 a[132:133], v6 offset:49152
v_fmac_f32 v254, v23, v30
v_mfma_f32_16x16x32_bf16 v[72:75], a[84:87], a[140:143], v[72:75]
buffer_load_dwordx4 v13, s[8:11], s24 offen offset:1024 lds
v_fmac_f32 v254, v24, v29
v_mfma_f32_16x16x32_bf16 v[76:79], a[88:91], a[136:139], v[76:79]
ds_read_b64_tr_b16 a[134:135], v6 offset:51200
v_fmac_f32 v254, v25, v28
v_mfma_f32_16x16x32_bf16 v[76:79], a[92:95], a[140:143], v[76:79]
v_mul_f32 v254, v254, v247
v_cvt_pk_bf16_f32 v246, v255, v254
v_mfma_f32_16x16x32_bf16 v[80:83], a[96:99], a[136:139], v[80:83]
ds_read_b128 a[12:15], v3 offset:2048
v_accvgpr_write_b32 a177, v246
v_mfma_f32_16x16x32_bf16 v[80:83], a[100:103], a[140:143], v[80:83]
buffer_load_dwordx4 v14, s[8:11], s24 offen offset:2048 lds
v_mfma_f32_16x16x32_bf16 v[84:87], a[104:107], a[136:139], v[84:87]
v_mul_f32 v255, v23, v253
v_lshlrev_b32 v22, 16, v232
v_lshlrev_b32 v247, 16, v241
v_mfma_f32_16x16x32_bf16 v[84:87], a[108:111], a[140:143], v[84:87]
v_fmac_f32 v255, v24, v30
v_fmac_f32 v255, v25, v29
v_mfma_f32_16x16x32_bf16 v[88:91], a[112:115], a[136:139], v[88:91]
ds_read_b128 a[16:19], v2 offset:4096
v_fmac_f32 v255, v22, v28
v_mfma_f32_16x16x32_bf16 v[88:91], a[116:119], a[140:143], v[88:91]
buffer_load_dwordx4 v15, s[8:11], s24 offen offset:3072 lds
v_mfma_f32_16x16x32_bf16 v[92:95], a[120:123], a[136:139], v[92:95]
PAD_24:
s_cbranch_execz PAD_28
s_add_u32 s24, s24, 128
ds_read_b128 a[20:23], v3 offset:4096
v_mul_f32 v255, v255, v247
v_mfma_f32_16x16x32_bf16 v[92:95], a[124:127], a[140:143], v[92:95]
s_waitcnt lgkmcnt(3)
v_cvt_pk_bf16_f32 v246, v254, v255
v_accvgpr_write_b32 a182, v246
v_mfma_f32_16x16x32_bf16 v[96:99], a[64:67], a[128:131], v[96:99]
s_add_u32 m0, s28, 36864
ds_read_b64_tr_b16 a[136:137], v7 offset:32768
v_mul_f32 v254, v24, v253
v_lshlrev_b32 v23, 16, v233
v_mfma_f32_16x16x32_bf16 v[96:99], a[68:71], a[132:135], v[96:99]
buffer_load_dwordx4 v12, s[8:11], s25 offen offset:0 lds
v_mfma_f32_16x16x32_bf16 v[100:103], a[72:75], a[128:131], v[100:103]
ds_read_b64_tr_b16 a[138:139], v7 offset:34816
v_lshlrev_b32 v247, 16, v242
v_mfma_f32_16x16x32_bf16 v[100:103], a[76:79], a[132:135], v[100:103]
v_fmac_f32 v254, v25, v30
v_fmac_f32 v254, v22, v29
v_mfma_f32_16x16x32_bf16 v[104:107], a[80:83], a[128:131], v[104:107]
ds_read_b64_tr_b16 a[140:141], v7 offset:49152
v_fmac_f32 v254, v23, v28
v_mfma_f32_16x16x32_bf16 v[104:107], a[84:87], a[132:135], v[104:107]
buffer_load_dwordx4 v13, s[8:11], s25 offen offset:1024 lds
v_mul_f32 v254, v254, v247
v_mfma_f32_16x16x32_bf16 v[108:111], a[88:91], a[128:131], v[108:111]
ds_read_b64_tr_b16 a[142:143], v7 offset:51200
v_cvt_pk_bf16_f32 v246, v255, v254
v_mfma_f32_16x16x32_bf16 v[108:111], a[92:95], a[132:135], v[108:111]
v_accvgpr_write_b32 a178, v246
v_mul_f32 v255, v25, v253
v_mfma_f32_16x16x32_bf16 v[112:115], a[96:99], a[128:131], v[112:115]
v_lshlrev_b32 v24, 16, v234
v_lshlrev_b32 v247, 16, v243
v_mfma_f32_16x16x32_bf16 v[112:115], a[100:103], a[132:135], v[112:115]
buffer_load_dwordx4 v14, s[8:11], s25 offen offset:2048 lds
v_mfma_f32_16x16x32_bf16 v[116:119], a[104:107], a[128:131], v[116:119]
ds_read_b128 a[24:27], v2 offset:6144
v_fmac_f32 v255, v22, v30
v_fmac_f32 v255, v23, v29
v_mfma_f32_16x16x32_bf16 v[116:119], a[108:111], a[132:135], v[116:119]
v_fmac_f32 v255, v24, v28
v_mul_f32 v255, v255, v247
v_mfma_f32_16x16x32_bf16 v[120:123], a[112:115], a[128:131], v[120:123]
ds_read_b128 a[28:31], v3 offset:6144
v_cvt_pk_bf16_f32 v246, v254, v255
v_mfma_f32_16x16x32_bf16 v[120:123], a[116:119], a[132:135], v[120:123]
buffer_load_dwordx4 v15, s[8:11], s25 offen offset:3072 lds
v_mfma_f32_16x16x32_bf16 v[124:127], a[120:123], a[128:131], v[124:127]
s_add_u32 s25, s25, 128
v_accvgpr_write_b32 a183, v246
v_mul_f32 v254, v22, v253
v_mfma_f32_16x16x32_bf16 v[124:127], a[124:127], a[132:135], v[124:127]
s_waitcnt lgkmcnt(2)
v_lshlrev_b32 v25, 16, v235
v_lshlrev_b32 v247, 16, v244
v_mfma_f32_16x16x32_bf16 v[128:131], a[64:67], a[136:139], v[128:131]
ds_read_b64_tr_b16 a[128:129], v8 offset:32768
v_fmac_f32 v254, v23, v30
v_fmac_f32 v254, v24, v29
v_mfma_f32_16x16x32_bf16 v[128:131], a[68:71], a[140:143], v[128:131]
buffer_load_dword v21, v20, s[16:19], s43 offen
v_mfma_f32_16x16x32_bf16 v[132:135], a[72:75], a[136:139], v[132:135]
s_add_u32 s43, s43, s47
ds_read_b64_tr_b16 a[130:131], v8 offset:34816
v_fmac_f32 v254, v25, v28
v_mfma_f32_16x16x32_bf16 v[132:135], a[76:79], a[140:143], v[132:135]
s_cmp_ge_u32 s43, s51
v_mul_f32 v254, v254, v247
v_cvt_pk_bf16_f32 v246, v255, v254
v_mfma_f32_16x16x32_bf16 v[136:139], a[80:83], a[136:139], v[136:139]
s_cselect_b32 s43, 0, s43
ds_read_b64_tr_b16 a[132:133], v8 offset:49152
v_accvgpr_write_b32 a179, v246
v_mfma_f32_16x16x32_bf16 v[136:139], a[84:87], a[140:143], v[136:139]
s_cselect_b32 s51, s42, s51
v_lshlrev_b32 v28, 16, v250
v_and_b32 v29, s58, v250
v_lshlrev_b32 v30, 16, v251
v_mfma_f32_16x16x32_bf16 v[140:143], a[88:91], a[136:139], v[140:143]
s_cselect_b64 s[16:17], s[40:41], s[16:17]
ds_read_b64_tr_b16 a[134:135], v8 offset:51200
v_and_b32 v253, s58, v251
v_mfma_f32_16x16x32_bf16 v[140:143], a[92:95], a[140:143], v[140:143]
s_cselect_b32 s18, s42, s18
v_and_b32 v22, s58, v224
v_and_b32 v23, s58, v225
v_mfma_f32_16x16x32_bf16 v[144:147], a[96:99], a[136:139], v[144:147]
s_cselect_b64 s[40:41], s[44:45], s[40:41]
ds_read_b128 a[32:35], v2 offset:8192
v_and_b32 v24, s58, v226
v_mfma_f32_16x16x32_bf16 v[144:147], a[100:103], a[140:143], v[144:147]
s_cselect_b32 s42, s46, s42
v_mul_f32 v254, v22, v253
v_and_b32 v25, s58, v227
v_mfma_f32_16x16x32_bf16 v[148:151], a[104:107], a[136:139], v[148:151]
s_cselect_b32 s46, 0, s46
v_and_b32 v247, s58, v236
v_fmac_f32 v254, v23, v30
v_mfma_f32_16x16x32_bf16 v[148:151], a[108:111], a[140:143], v[148:151]
buffer_load_dword v245, off, s[60:63], 0 sc1
v_fmac_f32 v254, v24, v29
v_mfma_f32_16x16x32_bf16 v[152:155], a[112:115], a[136:139], v[152:155]
ds_read_b128 a[36:39], v3 offset:8192
v_fmac_f32 v254, v25, v28
v_mfma_f32_16x16x32_bf16 v[152:155], a[116:119], a[140:143], v[152:155]
v_mul_f32 v254, v254, v247
v_mul_f32 v255, v23, v253
v_mfma_f32_16x16x32_bf16 v[156:159], a[120:123], a[136:139], v[156:159]
ds_read_b128 a[40:43], v2 offset:10240
v_and_b32 v22, s58, v228
v_mfma_f32_16x16x32_bf16 v[156:159], a[124:127], a[140:143], v[156:159]
s_waitcnt lgkmcnt(3)
v_and_b32 v247, s58, v237
v_fmac_f32 v255, v24, v30
v_mfma_f32_16x16x32_bf16 v[160:163], a[64:67], a[128:131], v[160:163]
ds_read_b64_tr_b16 a[136:137], v9 offset:32768
v_fmac_f32 v255, v25, v29
v_fmac_f32 v255, v22, v28
v_mfma_f32_16x16x32_bf16 v[160:163], a[68:71], a[132:135], v[160:163]
v_mul_f32 v255, v255, v247
v_cvt_pk_bf16_f32 v246, v254, v255
v_mfma_f32_16x16x32_bf16 v[164:167], a[72:75], a[128:131], v[164:167]
ds_read_b64_tr_b16 a[138:139], v9 offset:34816
v_accvgpr_write_b32 a188, v246
v_mfma_f32_16x16x32_bf16 v[164:167], a[76:79], a[132:135], v[164:167]
v_mul_f32 v254, v24, v253
v_and_b32 v23, s58, v229
v_mfma_f32_16x16x32_bf16 v[168:171], a[80:83], a[128:131], v[168:171]
ds_read_b64_tr_b16 a[140:141], v9 offset:49152
v_and_b32 v247, s58, v238
v_mfma_f32_16x16x32_bf16 v[168:171], a[84:87], a[132:135], v[168:171]
v_fmac_f32 v254, v25, v30
v_fmac_f32 v254, v22, v29
v_fmac_f32 v254, v23, v28
v_mfma_f32_16x16x32_bf16 v[172:175], a[88:91], a[128:131], v[172:175]
ds_read_b64_tr_b16 a[142:143], v9 offset:51200
v_mul_f32 v254, v254, v247
v_mfma_f32_16x16x32_bf16 v[172:175], a[92:95], a[132:135], v[172:175]
v_cvt_pk_bf16_f32 v246, v255, v254
v_accvgpr_write_b32 a184, v246
v_mfma_f32_16x16x32_bf16 v[176:179], a[96:99], a[128:131], v[176:179]
v_mul_f32 v255, v25, v253
v_and_b32 v24, s58, v230
v_mfma_f32_16x16x32_bf16 v[176:179], a[100:103], a[132:135], v[176:179]
v_and_b32 v247, s58, v239
v_fmac_f32 v255, v22, v30
v_mfma_f32_16x16x32_bf16 v[180:183], a[104:107], a[128:131], v[180:183]
ds_read_b128 a[44:47], v3 offset:10240
v_fmac_f32 v255, v23, v29
v_mfma_f32_16x16x32_bf16 v[180:183], a[108:111], a[132:135], v[180:183]
v_fmac_f32 v255, v24, v28
v_mul_f32 v255, v255, v247
v_cvt_pk_bf16_f32 v246, v254, v255
v_mfma_f32_16x16x32_bf16 v[184:187], a[112:115], a[128:131], v[184:187]
ds_read_b128 a[48:51], v2 offset:12288
v_accvgpr_write_b32 a189, v246
v_mfma_f32_16x16x32_bf16 v[184:187], a[116:119], a[132:135], v[184:187]
v_mul_f32 v254, v22, v253
v_and_b32 v25, s58, v231
v_mfma_f32_16x16x32_bf16 v[188:191], a[120:123], a[128:131], v[188:191]
v_and_b32 v247, s58, v240
v_fmac_f32 v254, v23, v30
v_mfma_f32_16x16x32_bf16 v[188:191], a[124:127], a[132:135], v[188:191]
s_waitcnt lgkmcnt(2)
v_fmac_f32 v254, v24, v29
v_fmac_f32 v254, v25, v28
v_mfma_f32_16x16x32_bf16 v[192:195], a[64:67], a[136:139], v[192:195]
ds_read_b64_tr_b16 a[128:129], v10 offset:32768
v_mul_f32 v254, v254, v247
v_cvt_pk_bf16_f32 v246, v255, v254
v_mfma_f32_16x16x32_bf16 v[192:195], a[68:71], a[140:143], v[192:195]
v_accvgpr_write_b32 a185, v246
v_mul_f32 v255, v23, v253
v_mfma_f32_16x16x32_bf16 v[196:199], a[72:75], a[136:139], v[196:199]
ds_read_b64_tr_b16 a[130:131], v10 offset:34816
v_and_b32 v22, s58, v232
v_mfma_f32_16x16x32_bf16 v[196:199], a[76:79], a[140:143], v[196:199]
v_and_b32 v247, s58, v241
v_fmac_f32 v255, v24, v30
v_mfma_f32_16x16x32_bf16 v[200:203], a[80:83], a[136:139], v[200:203]
s_lshr_b32 s22, s3, 1
ds_read_b64_tr_b16 a[132:133], v10 offset:49152
v_fmac_f32 v255, v25, v29
v_mfma_f32_16x16x32_bf16 v[200:203], a[84:87], a[140:143], v[200:203]
s_mul_i32 s22, s22, 2097152
v_fmac_f32 v255, v22, v28
v_mul_f32 v255, v255, v247
v_cvt_pk_bf16_f32 v246, v254, v255
v_mfma_f32_16x16x32_bf16 v[204:207], a[88:91], a[136:139], v[204:207]
s_and_b32 s23, s3, 1
ds_read_b64_tr_b16 a[134:135], v10 offset:51200
v_accvgpr_write_b32 a190, v246
v_mfma_f32_16x16x32_bf16 v[204:207], a[92:95], a[140:143], v[204:207]
s_lshl_b32 s23, s23, 5
v_mul_f32 v254, v24, v253
v_and_b32 v23, s58, v233
v_mfma_f32_16x16x32_bf16 v[208:211], a[96:99], a[136:139], v[208:211]
s_lshl_b32 s56, s39, 6
ds_read_b128 a[52:55], v3 offset:12288
v_and_b32 v247, s58, v242
v_mfma_f32_16x16x32_bf16 v[208:211], a[100:103], a[140:143], v[208:211]
s_add_u32 s23, s23, s56
v_fmac_f32 v254, v25, v30
v_fmac_f32 v254, v22, v29
v_mfma_f32_16x16x32_bf16 v[212:215], a[104:107], a[136:139], v[212:215]
s_mul_i32 s23, s23, 4224
ds_read_b128 a[56:59], v2 offset:14336
v_fmac_f32 v254, v23, v28
v_mfma_f32_16x16x32_bf16 v[212:215], a[108:111], a[140:143], v[212:215]
s_add_u32 s22, s22, s23
v_mul_f32 v254, v254, v247
v_cvt_pk_bf16_f32 v246, v255, v254
v_accvgpr_write_b32 a186, v246
v_mfma_f32_16x16x32_bf16 v[216:219], a[112:115], a[136:139], v[216:219]
s_add_u32 s57, s22, 83886200
v_mul_f32 v255, v25, v253
v_and_b32 v24, s58, v234
v_mfma_f32_16x16x32_bf16 v[216:219], a[116:119], a[140:143], v[216:219]
s_lshl_b32 s23, s38, 7
v_and_b32 v247, s58, v243
v_fmac_f32 v255, v22, v30
v_mfma_f32_16x16x32_bf16 v[220:223], a[120:123], a[136:139], v[220:223]
s_add_u32 s22, s22, s23
ds_read_b128 a[60:63], v3 offset:14336
v_fmac_f32 v255, v23, v29
v_mfma_f32_16x16x32_bf16 v[220:223], a[124:127], a[140:143], v[220:223]
s_waitcnt lgkmcnt(3)
s_add_u32 s56, s22, 83886208
v_fmac_f32 v255, v24, v28
v_mul_f32 v255, v255, v247
v_mfma_f32_16x16x32_bf16 a[192:195], a[64:67], a[128:131], a[192:195]
s_cmp_lt_u32 s2, 224
ds_read_b64_tr_b16 a[136:137], v11 offset:32768
v_cvt_pk_bf16_f32 v246, v254, v255
v_accvgpr_write_b32 a191, v246
v_mfma_f32_16x16x32_bf16 a[192:195], a[68:71], a[132:135], a[192:195]
s_cselect_b32 s56, s56, 3221225472
v_mul_f32 v254, v22, v253
v_and_b32 v25, s58, v235
v_mfma_f32_16x16x32_bf16 a[196:199], a[72:75], a[128:131], a[196:199]
s_cmp_eq_u32 s38, 0
ds_read_b64_tr_b16 a[138:139], v11 offset:34816
v_and_b32 v247, s58, v244
v_mfma_f32_16x16x32_bf16 a[196:199], a[76:79], a[132:135], a[196:199]
s_cselect_b32 s57, s57, 3221225472
v_fmac_f32 v254, v23, v30
v_fmac_f32 v254, v24, v29
v_mfma_f32_16x16x32_bf16 a[200:203], a[80:83], a[128:131], a[200:203]
ds_read_b64_tr_b16 a[140:141], v11 offset:49152
v_fmac_f32 v254, v25, v28
v_mfma_f32_16x16x32_bf16 a[200:203], a[84:87], a[132:135], a[200:203]
v_mul_f32 v254, v254, v247
v_cvt_pk_bf16_f32 v246, v255, v254
v_accvgpr_write_b32 a187, v246
v_mfma_f32_16x16x32_bf16 a[204:207], a[88:91], a[128:131], a[204:207]
ds_read_b64_tr_b16 a[142:143], v11 offset:51200
v_mfma_f32_16x16x32_bf16 a[204:207], a[92:95], a[132:135], a[204:207]
ds_write_b128 v252, a[176:179] offset:0
v_mfma_f32_16x16x32_bf16 a[208:211], a[96:99], a[128:131], a[208:211]
v_mfma_f32_16x16x32_bf16 a[208:211], a[100:103], a[132:135], a[208:211]
ds_write_b128 v252, a[180:183] offset:8192
v_mfma_f32_16x16x32_bf16 a[212:215], a[104:107], a[128:131], a[212:215]
v_mfma_f32_16x16x32_bf16 a[212:215], a[108:111], a[132:135], a[212:215]
ds_write_b128 v252, a[184:187] offset:128
v_mfma_f32_16x16x32_bf16 a[216:219], a[112:115], a[128:131], a[216:219]
v_mfma_f32_16x16x32_bf16 a[216:219], a[116:119], a[132:135], a[216:219]
ds_write_b128 v252, a[188:191] offset:8320
v_mfma_f32_16x16x32_bf16 a[220:223], a[120:123], a[128:131], a[220:223]
s_waitcnt vmcnt(2) lgkmcnt(0)
v_mfma_f32_16x16x32_bf16 a[220:223], a[124:127], a[132:135], a[220:223]
s_barrier
v_mfma_f32_16x16x32_bf16 a[224:227], a[64:67], a[136:139], a[224:227]
s_add_u32 m0, s29, 98304
ds_read_b64_tr_b16 a[128:129], v4 offset:0
v_lshrrev_b32 v22, 8, v1
v_mfma_f32_16x16x32_bf16 a[224:227], a[68:71], a[140:143], a[224:227]
buffer_load_dwordx4 v16, s[12:15], s26 offen offset:0 lds
v_mfma_f32_16x16x32_bf16 a[228:231], a[72:75], a[136:139], a[228:231]
ds_read_b64_tr_b16 a[130:131], v4 offset:2048
v_lshlrev_b32 v22, 4, v22
v_mfma_f32_16x16x32_bf16 a[228:231], a[76:79], a[140:143], a[228:231]
v_xor_b32 v22, v22, v1
v_add_u32 v22, s29, v22
v_mfma_f32_16x16x32_bf16 a[232:235], a[80:83], a[136:139], a[232:235]
ds_read_b64_tr_b16 a[132:133], v4 offset:16384
v_add_u32 v22, 147456, v22
v_mfma_f32_16x16x32_bf16 a[232:235], a[84:87], a[140:143], a[232:235]
buffer_load_dwordx4 v17, s[12:15], s26 offen offset:1024 lds
v_mfma_f32_16x16x32_bf16 a[236:239], a[88:91], a[136:139], a[236:239]
ds_read_b64_tr_b16 a[134:135], v4 offset:18432
v_xor_b32 v23, 64, v22
v_mfma_f32_16x16x32_bf16 a[236:239], a[92:95], a[140:143], a[236:239]
v_lshrrev_b32 v224, 7, v1
v_mul_u32_u24 v224, 4224, v224
v_mfma_f32_16x16x32_bf16 a[240:243], a[96:99], a[136:139], a[240:243]
v_and_b32 v225, 0x70, v1
v_add_u32 v224, v224, v225
v_mfma_f32_16x16x32_bf16 a[240:243], a[100:103], a[140:143], a[240:243]
buffer_load_dwordx4 v18, s[12:15], s26 offen offset:2048 lds
v_mfma_f32_16x16x32_bf16 a[244:247], a[104:107], a[136:139], a[244:247]
v_bfe_u32 v225, v1, 4, 5
v_mul_u32_u24 v225, 4224, v225
v_mfma_f32_16x16x32_bf16 a[244:247], a[108:111], a[140:143], a[244:247]
v_mov_b32 v226, 0
v_mov_b32 v227, 0
v_mfma_f32_16x16x32_bf16 a[248:251], a[112:115], a[136:139], a[248:251]
v_mfma_f32_16x16x32_bf16 a[248:251], a[116:119], a[140:143], a[248:251]
buffer_load_dwordx4 v19, s[12:15], s26 offen offset:3072 lds
v_mfma_f32_16x16x32_bf16 a[252:255], a[120:123], a[136:139], a[252:255]
s_add_u32 s26, s26, 524288
v_mfma_f32_16x16x32_bf16 a[252:255], a[124:127], a[140:143], a[252:255]
s_waitcnt lgkmcnt(0)
v_mfma_f32_16x16x32_bf16 v[32:35], a[0:3], a[128:131], v[32:35]
s_add_u32 m0, s29, 114688
ds_read_b64_tr_b16 a[136:137], v5 offset:0
v_mfma_f32_16x16x32_bf16 v[32:35], a[4:7], a[132:135], v[32:35]
buffer_load_dwordx4 v16, s[12:15], s27 offen offset:0 lds
v_mfma_f32_16x16x32_bf16 v[36:39], a[8:11], a[128:131], v[36:39]
s_mul_i32 s52, s20, 7
ds_read_b64_tr_b16 a[138:139], v5 offset:2048
v_mfma_f32_16x16x32_bf16 v[36:39], a[12:15], a[132:135], v[36:39]
s_add_u32 s52, s52, s21
buffer_store_dwordx2 v[226:227], v225, s[4:7], s57 offen sc1
v_mfma_f32_16x16x32_bf16 v[40:43], a[16:19], a[128:131], v[40:43]
s_lshl_b32 s53, s52, 2
ds_read_b64_tr_b16 a[140:141], v5 offset:16384
v_mfma_f32_16x16x32_bf16 v[40:43], a[20:23], a[132:135], v[40:43]
s_add_u32 s53, s53, s3
buffer_load_dwordx4 v17, s[12:15], s27 offen offset:1024 lds
v_mfma_f32_16x16x32_bf16 v[44:47], a[24:27], a[128:131], v[44:47]
s_lshl_b32 s49, s53, 12
ds_read_b64_tr_b16 a[142:143], v5 offset:18432
v_mfma_f32_16x16x32_bf16 v[44:47], a[28:31], a[132:135], v[44:47]
s_mul_i32 s53, s53, 4224
v_mfma_f32_16x16x32_bf16 v[48:51], a[32:35], a[128:131], v[48:51]
s_add_u32 s53, s53, 83886080
ds_read_b128 a[64:67], v2 offset:32768
v_mfma_f32_16x16x32_bf16 v[48:51], a[36:39], a[132:135], v[48:51]
s_lshr_b32 s52, s52, 4
buffer_load_dwordx4 v18, s[12:15], s27 offen offset:2048 lds
v_mfma_f32_16x16x32_bf16 v[52:55], a[40:43], a[128:131], v[52:55]
s_min_u32 s52, s52, 6
ds_read_b128 a[68:71], v3 offset:32768
v_mfma_f32_16x16x32_bf16 v[52:55], a[44:47], a[132:135], v[52:55]
s_lshl_b32 s52, s52, 7
ds_read_b128 a[176:179], v22 offset:0
v_mfma_f32_16x16x32_bf16 v[56:59], a[48:51], a[128:131], v[56:59]
s_add_u32 s52, s52, 94392320
ds_read_b128 a[180:183], v23 offset:1024
v_mfma_f32_16x16x32_bf16 v[56:59], a[52:55], a[132:135], v[56:59]
buffer_load_dwordx4 v19, s[12:15], s27 offen offset:3072 lds
v_mfma_f32_16x16x32_bf16 v[60:63], a[56:59], a[128:131], v[60:63]
s_add_u32 s27, s27, 524288
ds_read_b128 a[72:75], v2 offset:34816
v_mfma_f32_16x16x32_bf16 v[60:63], a[60:63], a[132:135], v[60:63]
s_waitcnt lgkmcnt(5)
ds_read_b128 a[184:187], v22 offset:2048
v_mfma_f32_16x16x32_bf16 v[64:67], a[0:3], a[136:139], v[64:67]
s_add_u32 m0, s28, 0
ds_read_b64_tr_b16 a[128:129], v6 offset:0
v_mfma_f32_16x16x32_bf16 v[64:67], a[4:7], a[140:143], v[64:67]
buffer_load_dwordx4 v12, s[8:11], s24 offen offset:0 lds
v_mfma_f32_16x16x32_bf16 v[68:71], a[8:11], a[136:139], v[68:71]
ds_read_b64_tr_b16 a[130:131], v6 offset:2048
v_mfma_f32_16x16x32_bf16 v[68:71], a[12:15], a[140:143], v[68:71]
ds_read_b128 a[188:191], v23 offset:3072
v_mfma_f32_16x16x32_bf16 v[72:75], a[16:19], a[136:139], v[72:75]
ds_read_b64_tr_b16 a[132:133], v6 offset:16384
v_bfe_u32 v231, v1, 4, 5
v_mfma_f32_16x16x32_bf16 v[72:75], a[20:23], a[140:143], v[72:75]
buffer_load_dwordx4 v13, s[8:11], s24 offen offset:1024 lds
v_mfma_f32_16x16x32_bf16 v[76:79], a[24:27], a[136:139], v[76:79]
ds_read_b64_tr_b16 a[134:135], v6 offset:18432
v_lshlrev_b32 v231, 2, v231
v_mfma_f32_16x16x32_bf16 v[76:79], a[28:31], a[140:143], v[76:79]
v_lshlrev_b32 v229, 3, v1
v_min_u32 v229, 4096, v229
v_mfma_f32_16x16x32_bf16 v[80:83], a[32:35], a[136:139], v[80:83]
ds_read_b128 a[76:79], v3 offset:34816
v_mfma_f32_16x16x32_bf16 v[80:83], a[36:39], a[140:143], v[80:83]
buffer_load_dwordx4 v14, s[8:11], s24 offen offset:2048 lds
v_mfma_f32_16x16x32_bf16 v[84:87], a[40:43], a[136:139], v[84:87]
v_mfma_f32_16x16x32_bf16 v[84:87], a[44:47], a[140:143], v[84:87]
v_mfma_f32_16x16x32_bf16 v[88:91], a[48:51], a[136:139], v[88:91]
ds_read_b128 a[80:83], v2 offset:36864
v_mfma_f32_16x16x32_bf16 v[88:91], a[52:55], a[140:143], v[88:91]
buffer_load_dwordx4 v15, s[8:11], s24 offen offset:3072 lds
v_mfma_f32_16x16x32_bf16 v[92:95], a[56:59], a[136:139], v[92:95]
s_add_u32 s24, s24, 128
ds_read_b128 a[84:87], v3 offset:36864
v_mfma_f32_16x16x32_bf16 v[92:95], a[60:63], a[140:143], v[92:95]
s_waitcnt lgkmcnt(3)
v_mfma_f32_16x16x32_bf16 v[96:99], a[0:3], a[128:131], v[96:99]
s_add_u32 m0, s28, 4096
ds_read_b64_tr_b16 a[136:137], v7 offset:0
v_mfma_f32_16x16x32_bf16 v[96:99], a[4:7], a[132:135], v[96:99]
buffer_load_dwordx4 v12, s[8:11], s25 offen offset:0 lds
v_mfma_f32_16x16x32_bf16 v[100:103], a[8:11], a[128:131], v[100:103]
ds_read_b64_tr_b16 a[138:139], v7 offset:2048
v_mfma_f32_16x16x32_bf16 v[100:103], a[12:15], a[132:135], v[100:103]
v_mfma_f32_16x16x32_bf16 v[104:107], a[16:19], a[128:131], v[104:107]
ds_read_b64_tr_b16 a[140:141], v7 offset:16384
v_mfma_f32_16x16x32_bf16 v[104:107], a[20:23], a[132:135], v[104:107]
buffer_load_dwordx4 v13, s[8:11], s25 offen offset:1024 lds
v_mfma_f32_16x16x32_bf16 v[108:111], a[24:27], a[128:131], v[108:111]
ds_read_b64_tr_b16 a[142:143], v7 offset:18432
v_mfma_f32_16x16x32_bf16 v[108:111], a[28:31], a[132:135], v[108:111]
v_mfma_f32_16x16x32_bf16 v[112:115], a[32:35], a[128:131], v[112:115]
v_mfma_f32_16x16x32_bf16 v[112:115], a[36:39], a[132:135], v[112:115]
buffer_load_dwordx4 v14, s[8:11], s25 offen offset:2048 lds
v_mfma_f32_16x16x32_bf16 v[116:119], a[40:43], a[128:131], v[116:119]
ds_read_b128 a[88:91], v2 offset:38912
v_mfma_f32_16x16x32_bf16 v[116:119], a[44:47], a[132:135], v[116:119]
v_mfma_f32_16x16x32_bf16 v[120:123], a[48:51], a[128:131], v[120:123]
ds_read_b128 a[92:95], v3 offset:38912
v_mfma_f32_16x16x32_bf16 v[120:123], a[52:55], a[132:135], v[120:123]
buffer_load_dwordx4 v15, s[8:11], s25 offen offset:3072 lds
v_mfma_f32_16x16x32_bf16 v[124:127], a[56:59], a[128:131], v[124:127]
s_add_u32 s25, s25, 128
v_mfma_f32_16x16x32_bf16 v[124:127], a[60:63], a[132:135], v[124:127]
s_waitcnt lgkmcnt(2)
v_mfma_f32_16x16x32_bf16 v[128:131], a[0:3], a[136:139], v[128:131]
ds_read_b64_tr_b16 a[128:129], v8 offset:0
v_mfma_f32_16x16x32_bf16 v[128:131], a[4:7], a[140:143], v[128:131]
buffer_store_dwordx4 a[176:179], v224, s[4:7], s56 offen sc1
v_mfma_f32_16x16x32_bf16 v[132:135], a[8:11], a[136:139], v[132:135]
s_add_u32 s56, s56, 33792
ds_read_b64_tr_b16 a[130:131], v8 offset:2048
v_mfma_f32_16x16x32_bf16 v[132:135], a[12:15], a[140:143], v[132:135]
v_mfma_f32_16x16x32_bf16 v[136:139], a[16:19], a[136:139], v[136:139]
ds_read_b64_tr_b16 a[132:133], v8 offset:16384
v_mfma_f32_16x16x32_bf16 v[136:139], a[20:23], a[140:143], v[136:139]
v_mfma_f32_16x16x32_bf16 v[140:143], a[24:27], a[136:139], v[140:143]
s_cmp_lt_u32 s21, 7
ds_read_b64_tr_b16 a[134:135], v8 offset:18432
v_mfma_f32_16x16x32_bf16 v[140:143], a[28:31], a[140:143], v[140:143]
s_cselect_b32 s53, s53, 3221225472
v_mfma_f32_16x16x32_bf16 v[144:147], a[32:35], a[136:139], v[144:147]
s_cselect_b32 s49, s49, 3221225472
ds_read_b128 a[96:99], v2 offset:40960
v_mfma_f32_16x16x32_bf16 v[144:147], a[36:39], a[140:143], v[144:147]
s_add_u32 s48, s53, 2097152
v_mfma_f32_16x16x32_bf16 v[148:151], a[40:43], a[136:139], v[148:151]
v_mfma_f32_16x16x32_bf16 v[148:151], a[44:47], a[140:143], v[148:151]
v_mfma_f32_16x16x32_bf16 v[152:155], a[48:51], a[136:139], v[152:155]
ds_read_b128 a[100:103], v3 offset:40960
v_mfma_f32_16x16x32_bf16 v[152:155], a[52:55], a[140:143], v[152:155]
v_mfma_f32_16x16x32_bf16 v[156:159], a[56:59], a[136:139], v[156:159]
ds_read_b128 a[104:107], v2 offset:43008
v_mfma_f32_16x16x32_bf16 v[156:159], a[60:63], a[140:143], v[156:159]
s_waitcnt lgkmcnt(3)
v_mfma_f32_16x16x32_bf16 v[160:163], a[0:3], a[128:131], v[160:163]
ds_read_b64_tr_b16 a[136:137], v9 offset:0
v_mfma_f32_16x16x32_bf16 v[160:163], a[4:7], a[132:135], v[160:163]
v_mfma_f32_16x16x32_bf16 v[164:167], a[8:11], a[128:131], v[164:167]
ds_read_b64_tr_b16 a[138:139], v9 offset:2048
v_mfma_f32_16x16x32_bf16 v[164:167], a[12:15], a[132:135], v[164:167]
buffer_store_dwordx4 a[180:183], v224, s[4:7], s56 offen sc1
v_mfma_f32_16x16x32_bf16 v[168:171], a[16:19], a[128:131], v[168:171]
s_add_u32 s56, s56, 33792
ds_read_b64_tr_b16 a[140:141], v9 offset:16384
v_mfma_f32_16x16x32_bf16 v[168:171], a[20:23], a[132:135], v[168:171]
v_mfma_f32_16x16x32_bf16 v[172:175], a[24:27], a[128:131], v[172:175]
ds_read_b64_tr_b16 a[142:143], v9 offset:18432
v_mfma_f32_16x16x32_bf16 v[172:175], a[28:31], a[132:135], v[172:175]
v_mfma_f32_16x16x32_bf16 v[176:179], a[32:35], a[128:131], v[176:179]
v_mfma_f32_16x16x32_bf16 v[176:179], a[36:39], a[132:135], v[176:179]
v_mfma_f32_16x16x32_bf16 v[180:183], a[40:43], a[128:131], v[180:183]
ds_read_b128 a[108:111], v3 offset:43008
v_mfma_f32_16x16x32_bf16 v[180:183], a[44:47], a[132:135], v[180:183]
v_mfma_f32_16x16x32_bf16 v[184:187], a[48:51], a[128:131], v[184:187]
ds_read_b128 a[112:115], v2 offset:45056
v_mfma_f32_16x16x32_bf16 v[184:187], a[52:55], a[132:135], v[184:187]
v_mfma_f32_16x16x32_bf16 v[188:191], a[56:59], a[128:131], v[188:191]
v_mfma_f32_16x16x32_bf16 v[188:191], a[60:63], a[132:135], v[188:191]
s_waitcnt lgkmcnt(2)
v_mfma_f32_16x16x32_bf16 v[192:195], a[0:3], a[136:139], v[192:195]
ds_read_b64_tr_b16 a[128:129], v10 offset:0
v_mfma_f32_16x16x32_bf16 v[192:195], a[4:7], a[140:143], v[192:195]
v_mfma_f32_16x16x32_bf16 v[196:199], a[8:11], a[136:139], v[196:199]
ds_read_b64_tr_b16 a[130:131], v10 offset:2048
v_mfma_f32_16x16x32_bf16 v[196:199], a[12:15], a[140:143], v[196:199]
v_mfma_f32_16x16x32_bf16 v[200:203], a[16:19], a[136:139], v[200:203]
ds_read_b64_tr_b16 a[132:133], v10 offset:16384
v_mfma_f32_16x16x32_bf16 v[200:203], a[20:23], a[140:143], v[200:203]
buffer_store_dwordx4 a[184:187], v224, s[4:7], s56 offen sc1
v_mfma_f32_16x16x32_bf16 v[204:207], a[24:27], a[136:139], v[204:207]
s_add_u32 s56, s56, 33792
ds_read_b64_tr_b16 a[134:135], v10 offset:18432
v_mfma_f32_16x16x32_bf16 v[204:207], a[28:31], a[140:143], v[204:207]
v_mfma_f32_16x16x32_bf16 v[208:211], a[32:35], a[136:139], v[208:211]
ds_read_b128 a[116:119], v3 offset:45056
v_mfma_f32_16x16x32_bf16 v[208:211], a[36:39], a[140:143], v[208:211]
v_mfma_f32_16x16x32_bf16 v[212:215], a[40:43], a[136:139], v[212:215]
ds_read_b128 a[120:123], v2 offset:47104
v_mfma_f32_16x16x32_bf16 v[212:215], a[44:47], a[140:143], v[212:215]
v_mfma_f32_16x16x32_bf16 v[216:219], a[48:51], a[136:139], v[216:219]
v_mfma_f32_16x16x32_bf16 v[216:219], a[52:55], a[140:143], v[216:219]
v_mfma_f32_16x16x32_bf16 v[220:223], a[56:59], a[136:139], v[220:223]
ds_read_b128 a[124:127], v3 offset:47104
v_mfma_f32_16x16x32_bf16 v[220:223], a[60:63], a[140:143], v[220:223]
s_waitcnt lgkmcnt(3)
v_mfma_f32_16x16x32_bf16 a[192:195], a[0:3], a[128:131], a[192:195]
ds_read_b64_tr_b16 a[136:137], v11 offset:0
v_mfma_f32_16x16x32_bf16 a[192:195], a[4:7], a[132:135], a[192:195]
v_mfma_f32_16x16x32_bf16 a[196:199], a[8:11], a[128:131], a[196:199]
ds_read_b64_tr_b16 a[138:139], v11 offset:2048
v_mfma_f32_16x16x32_bf16 a[196:199], a[12:15], a[132:135], a[196:199]
v_mfma_f32_16x16x32_bf16 a[200:203], a[16:19], a[128:131], a[200:203]
ds_read_b64_tr_b16 a[140:141], v11 offset:16384
v_mfma_f32_16x16x32_bf16 a[200:203], a[20:23], a[132:135], a[200:203]
v_mfma_f32_16x16x32_bf16 a[204:207], a[24:27], a[128:131], a[204:207]
ds_read_b64_tr_b16 a[142:143], v11 offset:18432
v_mfma_f32_16x16x32_bf16 a[204:207], a[28:31], a[132:135], a[204:207]
buffer_store_dwordx4 a[188:191], v224, s[4:7], s56 offen sc1
v_mfma_f32_16x16x32_bf16 a[208:211], a[32:35], a[128:131], a[208:211]
s_add_u32 s56, s56, 33792
v_mfma_f32_16x16x32_bf16 a[208:211], a[36:39], a[132:135], a[208:211]
v_mfma_f32_16x16x32_bf16 a[212:215], a[40:43], a[128:131], a[212:215]
v_mfma_f32_16x16x32_bf16 a[212:215], a[44:47], a[132:135], a[212:215]
v_mfma_f32_16x16x32_bf16 a[216:219], a[48:51], a[128:131], a[216:219]
v_mfma_f32_16x16x32_bf16 a[216:219], a[52:55], a[132:135], a[216:219]
v_mfma_f32_16x16x32_bf16 a[220:223], a[56:59], a[128:131], a[220:223]
s_waitcnt vmcnt(4) lgkmcnt(0)
v_mfma_f32_16x16x32_bf16 a[220:223], a[60:63], a[132:135], a[220:223]
s_barrier
v_mfma_f32_16x16x32_bf16 a[224:227], a[0:3], a[136:139], a[224:227]
s_add_u32 m0, s29, 65536
ds_read_b64_tr_b16 a[128:129], v4 offset:32768
v_mfma_f32_16x16x32_bf16 a[224:227], a[4:7], a[140:143], a[224:227]
buffer_load_dwordx4 v16, s[12:15], s26 offen offset:0 lds
v_mfma_f32_16x16x32_bf16 a[228:231], a[8:11], a[136:139], a[228:231]
ds_read_b64_tr_b16 a[130:131], v4 offset:34816
v_cmp_gt_u32 vcc, 0x100, v245
v_mfma_f32_16x16x32_bf16 a[228:231], a[12:15], a[140:143], a[228:231]
v_mfma_f32_16x16x32_bf16 a[232:235], a[16:19], a[136:139], a[232:235]
ds_read_b64_tr_b16 a[132:133], v4 offset:49152
v_mfma_f32_16x16x32_bf16 a[232:235], a[20:23], a[140:143], a[232:235]
buffer_load_dwordx4 v17, s[12:15], s26 offen offset:1024 lds
v_mfma_f32_16x16x32_bf16 a[236:239], a[24:27], a[136:139], a[236:239]
ds_read_b64_tr_b16 a[134:135], v4 offset:51200
v_mfma_f32_16x16x32_bf16 a[236:239], a[28:31], a[140:143], a[236:239]
v_mfma_f32_16x16x32_bf16 a[240:243], a[32:35], a[136:139], a[240:243]
v_mfma_f32_16x16x32_bf16 a[240:243], a[36:39], a[140:143], a[240:243]
buffer_load_dwordx4 v18, s[12:15], s26 offen offset:2048 lds
v_mfma_f32_16x16x32_bf16 a[244:247], a[40:43], a[136:139], a[244:247]
v_mfma_f32_16x16x32_bf16 a[244:247], a[44:47], a[140:143], a[244:247]
v_mfma_f32_16x16x32_bf16 a[248:251], a[48:51], a[136:139], a[248:251]
v_mfma_f32_16x16x32_bf16 a[248:251], a[52:55], a[140:143], a[248:251]
buffer_load_dwordx4 v19, s[12:15], s26 offen offset:3072 lds
v_mfma_f32_16x16x32_bf16 a[252:255], a[56:59], a[136:139], a[252:255]
s_add_u32 s26, s26, 524288
v_mfma_f32_16x16x32_bf16 a[252:255], a[60:63], a[140:143], a[252:255]
s_waitcnt lgkmcnt(0)
s_mov_b32 s82, s59
s_cbranch_vccnz M_cntspinV
s_branch Lg_501
PAD_25:
s_cbranch_execz PAD_29
Lg_501t:
buffer_load_dword v230, v231, s[4:7], s52 offen sc1
v_mfma_f32_16x16x32_bf16 v[32:35], a[64:67], a[128:131], v[32:35]
s_add_u32 m0, s29, 81920
ds_read_b64_tr_b16 a[136:137], v5 offset:32768
v_mfma_f32_16x16x32_bf16 v[32:35], a[68:71], a[132:135], v[32:35]
buffer_load_dwordx4 v16, s[12:15], s27 offen offset:0 lds
v_mfma_f32_16x16x32_bf16 v[36:39], a[72:75], a[128:131], v[36:39]
s_and_b32 s44, s3, 1
ds_read_b64_tr_b16 a[138:139], v5 offset:34816
v_mfma_f32_16x16x32_bf16 v[36:39], a[76:79], a[132:135], v[36:39]
s_lshl_b32 s44, s44, 8
v_mfma_f32_16x16x32_bf16 v[40:43], a[80:83], a[128:131], v[40:43]
s_lshl_b32 s45, s3, 7
ds_read_b64_tr_b16 a[140:141], v5 offset:49152
v_mfma_f32_16x16x32_bf16 v[40:43], a[84:87], a[132:135], v[40:43]
s_xor_b32 s44, s44, s45
buffer_load_dwordx4 v17, s[12:15], s27 offen offset:1024 lds
v_mfma_f32_16x16x32_bf16 v[44:47], a[88:91], a[128:131], v[44:47]
s_xor_b32 s44, s44, 196608
ds_read_b64_tr_b16 a[142:143], v5 offset:51200
v_mfma_f32_16x16x32_bf16 v[44:47], a[92:95], a[132:135], v[44:47]
v_mfma_f32_16x16x32_bf16 v[48:51], a[96:99], a[128:131], v[48:51]
ds_read_b128 a[0:3], v2 offset:0
v_mfma_f32_16x16x32_bf16 v[48:51], a[100:103], a[132:135], v[48:51]
buffer_load_dwordx4 v18, s[12:15], s27 offen offset:2048 lds
v_mfma_f32_16x16x32_bf16 v[52:55], a[104:107], a[128:131], v[52:55]
ds_read_b128 a[4:7], v3 offset:0
v_mfma_f32_16x16x32_bf16 v[52:55], a[108:111], a[132:135], v[52:55]
v_mfma_f32_16x16x32_bf16 v[56:59], a[112:115], a[128:131], v[56:59]
v_mfma_f32_16x16x32_bf16 v[56:59], a[116:119], a[132:135], v[56:59]
buffer_load_dwordx4 v19, s[12:15], s27 offen offset:3072 lds
v_mfma_f32_16x16x32_bf16 v[60:63], a[120:123], a[128:131], v[60:63]
s_add_u32 s27, s27, 524288
ds_read_b128 a[8:11], v2 offset:2048
v_mfma_f32_16x16x32_bf16 v[60:63], a[124:127], a[132:135], v[60:63]
PAD_26:
s_cbranch_execz PAD_30
s_waitcnt lgkmcnt(3)
v_mfma_f32_16x16x32_bf16 v[64:67], a[64:67], a[136:139], v[64:67]
s_add_u32 m0, s28, 32768
ds_read_b64_tr_b16 a[128:129], v6 offset:32768
v_mfma_f32_16x16x32_bf16 v[64:67], a[68:71], a[140:143], v[64:67]
buffer_load_dwordx4 v12, s[8:11], s24 offen offset:0 lds
v_mfma_f32_16x16x32_bf16 v[68:71], a[72:75], a[136:139], v[68:71]
ds_read_b64_tr_b16 a[130:131], v6 offset:34816
v_mfma_f32_16x16x32_bf16 v[68:71], a[76:79], a[140:143], v[68:71]
v_mfma_f32_16x16x32_bf16 v[72:75], a[80:83], a[136:139], v[72:75]
s_mov_b64 s[56:57], s[72:73]
ds_read_b64_tr_b16 a[132:133], v6 offset:49152
v_mfma_f32_16x16x32_bf16 v[72:75], a[84:87], a[140:143], v[72:75]
s_mov_b32 s58, 1835008
buffer_load_dwordx4 v13, s[8:11], s24 offen offset:1024 lds
v_mfma_f32_16x16x32_bf16 v[76:79], a[88:91], a[136:139], v[76:79]
s_mov_b32 s59, 0x20000
ds_read_b64_tr_b16 a[134:135], v6 offset:51200
v_mfma_f32_16x16x32_bf16 v[76:79], a[92:95], a[140:143], v[76:79]
v_mfma_f32_16x16x32_bf16 v[80:83], a[96:99], a[136:139], v[80:83]
ds_read_b128 a[12:15], v3 offset:2048
v_mfma_f32_16x16x32_bf16 v[80:83], a[100:103], a[140:143], v[80:83]
buffer_load_dwordx4 v14, s[8:11], s24 offen offset:2048 lds
v_mfma_f32_16x16x32_bf16 v[84:87], a[104:107], a[136:139], v[84:87]
v_mfma_f32_16x16x32_bf16 v[84:87], a[108:111], a[140:143], v[84:87]
v_mfma_f32_16x16x32_bf16 v[88:91], a[112:115], a[136:139], v[88:91]
ds_read_b128 a[16:19], v2 offset:4096
v_mfma_f32_16x16x32_bf16 v[88:91], a[116:119], a[140:143], v[88:91]
buffer_load_dwordx4 v15, s[8:11], s24 offen offset:3072 lds
v_mfma_f32_16x16x32_bf16 v[92:95], a[120:123], a[136:139], v[92:95]
s_add_u32 s24, s24, 128
ds_read_b128 a[20:23], v3 offset:4096
v_mfma_f32_16x16x32_bf16 v[92:95], a[124:127], a[140:143], v[92:95]
s_waitcnt lgkmcnt(3)
v_mfma_f32_16x16x32_bf16 v[96:99], a[64:67], a[128:131], v[96:99]
s_add_u32 m0, s28, 36864
ds_read_b64_tr_b16 a[136:137], v7 offset:32768
v_mfma_f32_16x16x32_bf16 v[96:99], a[68:71], a[132:135], v[96:99]
buffer_load_dwordx4 v12, s[8:11], s25 offen offset:0 lds
v_mfma_f32_16x16x32_bf16 v[100:103], a[72:75], a[128:131], v[100:103]
ds_read_b64_tr_b16 a[138:139], v7 offset:34816
v_mfma_f32_16x16x32_bf16 v[100:103], a[76:79], a[132:135], v[100:103]
v_mfma_f32_16x16x32_bf16 v[104:107], a[80:83], a[128:131], v[104:107]
ds_read_b64_tr_b16 a[140:141], v7 offset:49152
v_mfma_f32_16x16x32_bf16 v[104:107], a[84:87], a[132:135], v[104:107]
buffer_load_dwordx4 v13, s[8:11], s25 offen offset:1024 lds
v_mfma_f32_16x16x32_bf16 v[108:111], a[88:91], a[128:131], v[108:111]
ds_read_b64_tr_b16 a[142:143], v7 offset:51200
v_mfma_f32_16x16x32_bf16 v[108:111], a[92:95], a[132:135], v[108:111]
v_mfma_f32_16x16x32_bf16 v[112:115], a[96:99], a[128:131], v[112:115]
v_mfma_f32_16x16x32_bf16 v[112:115], a[100:103], a[132:135], v[112:115]
buffer_load_dwordx4 v14, s[8:11], s25 offen offset:2048 lds
v_mfma_f32_16x16x32_bf16 v[116:119], a[104:107], a[128:131], v[116:119]
ds_read_b128 a[24:27], v2 offset:6144
v_mfma_f32_16x16x32_bf16 v[116:119], a[108:111], a[132:135], v[116:119]
v_mfma_f32_16x16x32_bf16 v[120:123], a[112:115], a[128:131], v[120:123]
ds_read_b128 a[28:31], v3 offset:6144
v_mfma_f32_16x16x32_bf16 v[120:123], a[116:119], a[132:135], v[120:123]
buffer_load_dwordx4 v15, s[8:11], s25 offen offset:3072 lds
v_mfma_f32_16x16x32_bf16 v[124:127], a[120:123], a[128:131], v[124:127]
s_add_u32 s25, s25, 128
s_waitcnt vmcnt(12)
v_mfma_f32_16x16x32_bf16 v[124:127], a[124:127], a[132:135], v[124:127]
s_waitcnt lgkmcnt(2)
v_cmp_gt_u32 vcc, 1, v230
v_mfma_f32_16x16x32_bf16 v[128:131], a[64:67], a[136:139], v[128:131]
s_cbranch_vccnz M_ppspinV
M_ppokV:
ds_read_b64_tr_b16 a[128:129], v8 offset:32768
v_mfma_f32_16x16x32_bf16 v[128:131], a[68:71], a[140:143], v[128:131]
buffer_load_dword v230, v229, s[4:7], s53 offen sc1
v_mfma_f32_16x16x32_bf16 v[132:135], a[72:75], a[136:139], v[132:135]
s_mov_b64 s[8:9], s[76:77]
ds_read_b64_tr_b16 a[130:131], v8 offset:34816
v_mfma_f32_16x16x32_bf16 v[132:135], a[76:79], a[140:143], v[132:135]
s_mov_b32 s10, 1835008
buffer_load_dword v230, v229, s[4:7], s48 offen sc1
v_mfma_f32_16x16x32_bf16 v[136:139], a[80:83], a[136:139], v[136:139]
s_lshl_b32 s24, s37, 2
ds_read_b64_tr_b16 a[132:133], v8 offset:49152
v_mfma_f32_16x16x32_bf16 v[136:139], a[84:87], a[140:143], v[136:139]
s_add_u32 s24, s24, s3
buffer_load_dword v230, v229, s[56:59], s49 offen
v_mfma_f32_16x16x32_bf16 v[140:143], a[88:91], a[136:139], v[140:143]
s_mul_i32 s24, s24, 28672
ds_read_b64_tr_b16 a[134:135], v8 offset:51200
v_mfma_f32_16x16x32_bf16 v[140:143], a[92:95], a[140:143], v[140:143]
s_mov_b32 s28, s29
buffer_load_dword v21, v20, s[16:19], s43 offen
v_mfma_f32_16x16x32_bf16 v[144:147], a[96:99], a[136:139], v[144:147]
ds_read_b128 a[32:35], v2 offset:8192
v_mfma_f32_16x16x32_bf16 v[144:147], a[100:103], a[140:143], v[144:147]
v_mfma_f32_16x16x32_bf16 v[148:151], a[104:107], a[136:139], v[148:151]
v_mfma_f32_16x16x32_bf16 v[148:151], a[108:111], a[140:143], v[148:151]
v_mfma_f32_16x16x32_bf16 v[152:155], a[112:115], a[136:139], v[152:155]
ds_read_b128 a[36:39], v3 offset:8192
v_lshrrev_b32 v28, 7, v1
v_mfma_f32_16x16x32_bf16 v[152:155], a[116:119], a[140:143], v[152:155]
v_lshrrev_b32 v29, 1, v28
v_lshlrev_b32 v29, 4, v29
v_mfma_f32_16x16x32_bf16 v[156:159], a[120:123], a[136:139], v[156:159]
ds_read_b128 a[40:43], v2 offset:10240
v_and_b32 v30, 0x70, v1
v_mfma_f32_16x16x32_bf16 v[156:159], a[124:127], a[140:143], v[156:159]
s_waitcnt lgkmcnt(3)
v_xor_b32 v29, v29, v30
v_mul_u32_u24 v28, 896, v28
v_mfma_f32_16x16x32_bf16 v[160:163], a[64:67], a[128:131], v[160:163]
ds_read_b64_tr_b16 a[136:137], v9 offset:32768
v_add_u32 v12, v28, v29
v_mfma_f32_16x16x32_bf16 v[160:163], a[68:71], a[132:135], v[160:163]
v_xor_b32 v29, 64, v29
v_add_u32 v28, v28, v29
v_mfma_f32_16x16x32_bf16 v[164:167], a[72:75], a[128:131], v[164:167]
ds_read_b64_tr_b16 a[138:139], v9 offset:34816
v_add_u32 v13, 6144, v28
v_mfma_f32_16x16x32_bf16 v[164:167], a[76:79], a[132:135], v[164:167]
v_add_u32 v14, 12288, v12
v_add_u32 v15, 18432, v28
v_mfma_f32_16x16x32_bf16 v[168:171], a[80:83], a[128:131], v[168:171]
ds_read_b64_tr_b16 a[140:141], v9 offset:49152
v_xor_b32 v22, s44, v4
v_mfma_f32_16x16x32_bf16 v[168:171], a[84:87], a[132:135], v[168:171]
v_xor_b32 v23, 32, v22
v_xor_b32 v24, 64, v22
v_mfma_f32_16x16x32_bf16 v[172:175], a[88:91], a[128:131], v[172:175]
ds_read_b64_tr_b16 a[142:143], v9 offset:51200
v_xor_b32 v25, 96, v22
v_mfma_f32_16x16x32_bf16 v[172:175], a[92:95], a[132:135], v[172:175]
v_mfma_f32_16x16x32_bf16 v[176:179], a[96:99], a[128:131], v[176:179]
v_mfma_f32_16x16x32_bf16 v[176:179], a[100:103], a[132:135], v[176:179]
v_mfma_f32_16x16x32_bf16 v[180:183], a[104:107], a[128:131], v[180:183]
ds_read_b128 a[44:47], v3 offset:10240
v_mfma_f32_16x16x32_bf16 v[180:183], a[108:111], a[132:135], v[180:183]
v_mfma_f32_16x16x32_bf16 v[184:187], a[112:115], a[128:131], v[184:187]
ds_read_b128 a[48:51], v2 offset:12288
v_mfma_f32_16x16x32_bf16 v[184:187], a[116:119], a[132:135], v[184:187]
v_mfma_f32_16x16x32_bf16 v[188:191], a[120:123], a[128:131], v[188:191]
v_mfma_f32_16x16x32_bf16 v[188:191], a[124:127], a[132:135], v[188:191]
s_waitcnt lgkmcnt(2)
v_mfma_f32_16x16x32_bf16 v[192:195], a[64:67], a[136:139], v[192:195]
ds_read_b64_tr_b16 a[128:129], v10 offset:32768
v_mfma_f32_16x16x32_bf16 v[192:195], a[68:71], a[140:143], v[192:195]
v_mfma_f32_16x16x32_bf16 v[196:199], a[72:75], a[136:139], v[196:199]
ds_read_b64_tr_b16 a[130:131], v10 offset:34816
v_mfma_f32_16x16x32_bf16 v[196:199], a[76:79], a[140:143], v[196:199]
v_mfma_f32_16x16x32_bf16 v[200:203], a[80:83], a[136:139], v[200:203]
ds_read_b64_tr_b16 a[132:133], v10 offset:49152
v_mfma_f32_16x16x32_bf16 v[200:203], a[84:87], a[140:143], v[200:203]
v_mfma_f32_16x16x32_bf16 v[204:207], a[88:91], a[136:139], v[204:207]
ds_read_b64_tr_b16 a[134:135], v10 offset:51200
v_mfma_f32_16x16x32_bf16 v[204:207], a[92:95], a[140:143], v[204:207]
v_mfma_f32_16x16x32_bf16 v[208:211], a[96:99], a[136:139], v[208:211]
ds_read_b128 a[52:55], v3 offset:12288
v_mfma_f32_16x16x32_bf16 v[208:211], a[100:103], a[140:143], v[208:211]
v_mfma_f32_16x16x32_bf16 v[212:215], a[104:107], a[136:139], v[212:215]
ds_read_b128 a[56:59], v2 offset:14336
v_mfma_f32_16x16x32_bf16 v[212:215], a[108:111], a[140:143], v[212:215]
v_mfma_f32_16x16x32_bf16 v[216:219], a[112:115], a[136:139], v[216:219]
v_mfma_f32_16x16x32_bf16 v[216:219], a[116:119], a[140:143], v[216:219]
v_mfma_f32_16x16x32_bf16 v[220:223], a[120:123], a[136:139], v[220:223]
ds_read_b128 a[60:63], v3 offset:14336
v_mfma_f32_16x16x32_bf16 v[220:223], a[124:127], a[140:143], v[220:223]
s_waitcnt lgkmcnt(3)
v_mfma_f32_16x16x32_bf16 a[192:195], a[64:67], a[128:131], a[192:195]
ds_read_b64_tr_b16 a[136:137], v11 offset:32768
v_mfma_f32_16x16x32_bf16 a[192:195], a[68:71], a[132:135], a[192:195]
v_mfma_f32_16x16x32_bf16 a[196:199], a[72:75], a[128:131], a[196:199]
ds_read_b64_tr_b16 a[138:139], v11 offset:34816
v_mfma_f32_16x16x32_bf16 a[196:199], a[76:79], a[132:135], a[196:199]
v_mfma_f32_16x16x32_bf16 a[200:203], a[80:83], a[128:131], a[200:203]
ds_read_b64_tr_b16 a[140:141], v11 offset:49152
v_mfma_f32_16x16x32_bf16 a[200:203], a[84:87], a[132:135], a[200:203]
v_mfma_f32_16x16x32_bf16 a[204:207], a[88:91], a[128:131], a[204:207]
ds_read_b64_tr_b16 a[142:143], v11 offset:51200
v_mfma_f32_16x16x32_bf16 a[204:207], a[92:95], a[132:135], a[204:207]
v_mfma_f32_16x16x32_bf16 a[208:211], a[96:99], a[128:131], a[208:211]
v_mfma_f32_16x16x32_bf16 a[208:211], a[100:103], a[132:135], a[208:211]
v_mfma_f32_16x16x32_bf16 a[212:215], a[104:107], a[128:131], a[212:215]
v_mfma_f32_16x16x32_bf16 a[212:215], a[108:111], a[132:135], a[212:215]
v_mfma_f32_16x16x32_bf16 a[216:219], a[112:115], a[128:131], a[216:219]
v_mfma_f32_16x16x32_bf16 a[216:219], a[116:119], a[132:135], a[216:219]
v_mfma_f32_16x16x32_bf16 a[220:223], a[120:123], a[128:131], a[220:223]
s_waitcnt vmcnt(4) lgkmcnt(0)
v_mfma_f32_16x16x32_bf16 a[220:223], a[124:127], a[132:135], a[220:223]
s_barrier
v_mfma_f32_16x16x32_bf16 a[224:227], a[64:67], a[136:139], a[224:227]
s_add_u32 m0, s29, 98304
ds_read_b64_tr_b16 a[128:129], v4 offset:0
v_mfma_f32_16x16x32_bf16 a[224:227], a[68:71], a[140:143], a[224:227]
buffer_load_dwordx4 v16, s[12:15], s26 offen offset:0 lds
v_mfma_f32_16x16x32_bf16 a[228:231], a[72:75], a[136:139], a[228:231]
ds_read_b64_tr_b16 a[130:131], v4 offset:2048
v_mfma_f32_16x16x32_bf16 a[228:231], a[76:79], a[140:143], a[228:231]
v_mfma_f32_16x16x32_bf16 a[232:235], a[80:83], a[136:139], a[232:235]
ds_read_b64_tr_b16 a[132:133], v4 offset:16384
v_mfma_f32_16x16x32_bf16 a[232:235], a[84:87], a[140:143], a[232:235]
buffer_load_dwordx4 v17, s[12:15], s26 offen offset:1024 lds
v_mfma_f32_16x16x32_bf16 a[236:239], a[88:91], a[136:139], a[236:239]
ds_read_b64_tr_b16 a[134:135], v4 offset:18432
v_mfma_f32_16x16x32_bf16 a[236:239], a[92:95], a[140:143], a[236:239]
v_mfma_f32_16x16x32_bf16 a[240:243], a[96:99], a[136:139], a[240:243]
v_mfma_f32_16x16x32_bf16 a[240:243], a[100:103], a[140:143], a[240:243]
buffer_load_dwordx4 v18, s[12:15], s26 offen offset:2048 lds
v_mfma_f32_16x16x32_bf16 a[244:247], a[104:107], a[136:139], a[244:247]
v_mfma_f32_16x16x32_bf16 a[244:247], a[108:111], a[140:143], a[244:247]
v_mfma_f32_16x16x32_bf16 a[248:251], a[112:115], a[136:139], a[248:251]
v_mfma_f32_16x16x32_bf16 a[248:251], a[116:119], a[140:143], a[248:251]
buffer_load_dwordx4 v19, s[12:15], s26 offen offset:3072 lds
v_mfma_f32_16x16x32_bf16 a[252:255], a[120:123], a[136:139], a[252:255]
s_add_u32 s26, s26, 524288
v_mfma_f32_16x16x32_bf16 a[252:255], a[124:127], a[140:143], a[252:255]
s_waitcnt lgkmcnt(0)
v_mfma_f32_16x16x32_bf16 v[32:35], a[0:3], a[128:131], v[32:35]
s_add_u32 m0, s29, 114688
ds_read_b64_tr_b16 a[136:137], v5 offset:0
v_mfma_f32_16x16x32_bf16 v[32:35], a[4:7], a[132:135], v[32:35]
buffer_load_dwordx4 v16, s[12:15], s27 offen offset:0 lds
v_mfma_f32_16x16x32_bf16 v[36:39], a[8:11], a[128:131], v[36:39]
ds_read_b64_tr_b16 a[138:139], v5 offset:2048
v_mfma_f32_16x16x32_bf16 v[36:39], a[12:15], a[132:135], v[36:39]
v_mfma_f32_16x16x32_bf16 v[40:43], a[16:19], a[128:131], v[40:43]
ds_read_b64_tr_b16 a[140:141], v5 offset:16384
v_mfma_f32_16x16x32_bf16 v[40:43], a[20:23], a[132:135], v[40:43]
buffer_load_dwordx4 v17, s[12:15], s27 offen offset:1024 lds
v_mfma_f32_16x16x32_bf16 v[44:47], a[24:27], a[128:131], v[44:47]
ds_read_b64_tr_b16 a[142:143], v5 offset:18432
v_mfma_f32_16x16x32_bf16 v[44:47], a[28:31], a[132:135], v[44:47]
v_mfma_f32_16x16x32_bf16 v[48:51], a[32:35], a[128:131], v[48:51]
ds_read_b128 a[64:67], v2 offset:32768
v_mfma_f32_16x16x32_bf16 v[48:51], a[36:39], a[132:135], v[48:51]
buffer_load_dwordx4 v18, s[12:15], s27 offen offset:2048 lds
v_mfma_f32_16x16x32_bf16 v[52:55], a[40:43], a[128:131], v[52:55]
ds_read_b128 a[68:71], v3 offset:32768
v_mfma_f32_16x16x32_bf16 v[52:55], a[44:47], a[132:135], v[52:55]
v_mfma_f32_16x16x32_bf16 v[56:59], a[48:51], a[128:131], v[56:59]
v_mfma_f32_16x16x32_bf16 v[56:59], a[52:55], a[132:135], v[56:59]
buffer_load_dwordx4 v19, s[12:15], s27 offen offset:3072 lds
v_mfma_f32_16x16x32_bf16 v[60:63], a[56:59], a[128:131], v[60:63]
s_add_u32 s27, s27, 524288
ds_read_b128 a[72:75], v2 offset:34816
v_mfma_f32_16x16x32_bf16 v[60:63], a[60:63], a[132:135], v[60:63]
s_waitcnt lgkmcnt(3)
v_mfma_f32_16x16x32_bf16 v[64:67], a[0:3], a[136:139], v[64:67]
s_add_u32 m0, s28, 0
ds_read_b64_tr_b16 a[128:129], v6 offset:0
v_mfma_f32_16x16x32_bf16 v[64:67], a[4:7], a[140:143], v[64:67]
buffer_load_dwordx4 v12, s[8:11], s24 offen offset:0 lds
v_mfma_f32_16x16x32_bf16 v[68:71], a[8:11], a[136:139], v[68:71]
ds_read_b64_tr_b16 a[130:131], v6 offset:2048
v_mfma_f32_16x16x32_bf16 v[68:71], a[12:15], a[140:143], v[68:71]
v_mfma_f32_16x16x32_bf16 v[72:75], a[16:19], a[136:139], v[72:75]
ds_read_b64_tr_b16 a[132:133], v6 offset:16384
v_mfma_f32_16x16x32_bf16 v[72:75], a[20:23], a[140:143], v[72:75]
buffer_load_dwordx4 v13, s[8:11], s24 offen offset:1024 lds
v_mfma_f32_16x16x32_bf16 v[76:79], a[24:27], a[136:139], v[76:79]
ds_read_b64_tr_b16 a[134:135], v6 offset:18432
v_mfma_f32_16x16x32_bf16 v[76:79], a[28:31], a[140:143], v[76:79]
v_mfma_f32_16x16x32_bf16 v[80:83], a[32:35], a[136:139], v[80:83]
ds_read_b128 a[76:79], v3 offset:34816
v_mfma_f32_16x16x32_bf16 v[80:83], a[36:39], a[140:143], v[80:83]
buffer_load_dwordx4 v14, s[8:11], s24 offen offset:2048 lds
v_mfma_f32_16x16x32_bf16 v[84:87], a[40:43], a[136:139], v[84:87]
v_mfma_f32_16x16x32_bf16 v[84:87], a[44:47], a[140:143], v[84:87]
v_mfma_f32_16x16x32_bf16 v[88:91], a[48:51], a[136:139], v[88:91]
ds_read_b128 a[80:83], v2 offset:36864
v_mfma_f32_16x16x32_bf16 v[88:91], a[52:55], a[140:143], v[88:91]
buffer_load_dwordx4 v15, s[8:11], s24 offen offset:3072 lds
v_mfma_f32_16x16x32_bf16 v[92:95], a[56:59], a[136:139], v[92:95]
s_add_u32 s24, s24, 128
ds_read_b128 a[84:87], v3 offset:36864
v_mfma_f32_16x16x32_bf16 v[92:95], a[60:63], a[140:143], v[92:95]
s_waitcnt lgkmcnt(3)
s_mov_b64 s[12:13], s[80:81]
v_mfma_f32_16x16x32_bf16 v[96:99], a[0:3], a[128:131], v[96:99]
s_mov_b32 s14, 3670016
s_add_u32 m0, s28, 16384
ds_read_b64_tr_b16 a[136:137], v7 offset:0
v_mfma_f32_16x16x32_bf16 v[96:99], a[4:7], a[132:135], v[96:99]
buffer_load_dwordx4 v12, s[8:11], s24 offen offset:0 lds
v_mfma_f32_16x16x32_bf16 v[100:103], a[8:11], a[128:131], v[100:103]
ds_read_b64_tr_b16 a[138:139], v7 offset:2048
v_mfma_f32_16x16x32_bf16 v[100:103], a[12:15], a[132:135], v[100:103]
v_mfma_f32_16x16x32_bf16 v[104:107], a[16:19], a[128:131], v[104:107]
ds_read_b64_tr_b16 a[140:141], v7 offset:16384
v_mfma_f32_16x16x32_bf16 v[104:107], a[20:23], a[132:135], v[104:107]
buffer_load_dwordx4 v13, s[8:11], s24 offen offset:1024 lds
v_mfma_f32_16x16x32_bf16 v[108:111], a[24:27], a[128:131], v[108:111]
ds_read_b64_tr_b16 a[142:143], v7 offset:18432
v_mfma_f32_16x16x32_bf16 v[108:111], a[28:31], a[132:135], v[108:111]
v_mfma_f32_16x16x32_bf16 v[112:115], a[32:35], a[128:131], v[112:115]
v_mfma_f32_16x16x32_bf16 v[112:115], a[36:39], a[132:135], v[112:115]
buffer_load_dwordx4 v14, s[8:11], s24 offen offset:2048 lds
v_mfma_f32_16x16x32_bf16 v[116:119], a[40:43], a[128:131], v[116:119]
ds_read_b128 a[88:91], v2 offset:38912
v_mfma_f32_16x16x32_bf16 v[116:119], a[44:47], a[132:135], v[116:119]
v_mfma_f32_16x16x32_bf16 v[120:123], a[48:51], a[128:131], v[120:123]
ds_read_b128 a[92:95], v3 offset:38912
v_mfma_f32_16x16x32_bf16 v[120:123], a[52:55], a[132:135], v[120:123]
buffer_load_dwordx4 v15, s[8:11], s24 offen offset:3072 lds
v_mfma_f32_16x16x32_bf16 v[124:127], a[56:59], a[128:131], v[124:127]
s_add_u32 s24, s24, 128
v_mfma_f32_16x16x32_bf16 v[124:127], a[60:63], a[132:135], v[124:127]
s_waitcnt lgkmcnt(2)
s_sub_u32 s26, s26, 8388608
v_mfma_f32_16x16x32_bf16 v[128:131], a[0:3], a[136:139], v[128:131]
s_sub_u32 s27, s27, 8388608
s_add_u32 m0, s29, 131072
ds_read_b64_tr_b16 a[128:129], v8 offset:0
v_mfma_f32_16x16x32_bf16 v[128:131], a[4:7], a[140:143], v[128:131]
buffer_load_dwordx4 v16, s[12:15], s26 offen offset:0 lds
v_mfma_f32_16x16x32_bf16 v[132:135], a[8:11], a[136:139], v[132:135]
ds_read_b64_tr_b16 a[130:131], v8 offset:2048
v_mfma_f32_16x16x32_bf16 v[132:135], a[12:15], a[140:143], v[132:135]
v_mfma_f32_16x16x32_bf16 v[136:139], a[16:19], a[136:139], v[136:139]
ds_read_b64_tr_b16 a[132:133], v8 offset:16384
v_mfma_f32_16x16x32_bf16 v[136:139], a[20:23], a[140:143], v[136:139]
buffer_load_dwordx4 v17, s[12:15], s26 offen offset:1024 lds
v_mfma_f32_16x16x32_bf16 v[140:143], a[24:27], a[136:139], v[140:143]
ds_read_b64_tr_b16 a[134:135], v8 offset:18432
v_mfma_f32_16x16x32_bf16 v[140:143], a[28:31], a[140:143], v[140:143]
v_mfma_f32_16x16x32_bf16 v[144:147], a[32:35], a[136:139], v[144:147]
ds_read_b128 a[96:99], v2 offset:40960
v_mfma_f32_16x16x32_bf16 v[144:147], a[36:39], a[140:143], v[144:147]
buffer_load_dwordx4 v18, s[12:15], s26 offen offset:2048 lds
v_mfma_f32_16x16x32_bf16 v[148:151], a[40:43], a[136:139], v[148:151]
v_mfma_f32_16x16x32_bf16 v[148:151], a[44:47], a[140:143], v[148:151]
v_mfma_f32_16x16x32_bf16 v[152:155], a[48:51], a[136:139], v[152:155]
ds_read_b128 a[100:103], v3 offset:40960
v_mfma_f32_16x16x32_bf16 v[152:155], a[52:55], a[140:143], v[152:155]
buffer_load_dwordx4 v19, s[12:15], s26 offen offset:3072 lds
v_mfma_f32_16x16x32_bf16 v[156:159], a[56:59], a[136:139], v[156:159]
s_add_u32 s26, s26, 524288
ds_read_b128 a[104:107], v2 offset:43008
v_mfma_f32_16x16x32_bf16 v[156:159], a[60:63], a[140:143], v[156:159]
s_waitcnt lgkmcnt(3)
v_mfma_f32_16x16x32_bf16 v[160:163], a[0:3], a[128:131], v[160:163]
s_add_u32 m0, s29, 147456
ds_read_b64_tr_b16 a[136:137], v9 offset:0
v_mfma_f32_16x16x32_bf16 v[160:163], a[4:7], a[132:135], v[160:163]
buffer_load_dwordx4 v16, s[12:15], s27 offen offset:0 lds
v_mfma_f32_16x16x32_bf16 v[164:167], a[8:11], a[128:131], v[164:167]
ds_read_b64_tr_b16 a[138:139], v9 offset:2048
v_mfma_f32_16x16x32_bf16 v[164:167], a[12:15], a[132:135], v[164:167]
v_mfma_f32_16x16x32_bf16 v[168:171], a[16:19], a[128:131], v[168:171]
ds_read_b64_tr_b16 a[140:141], v9 offset:16384
v_mfma_f32_16x16x32_bf16 v[168:171], a[20:23], a[132:135], v[168:171]
buffer_load_dwordx4 v17, s[12:15], s27 offen offset:1024 lds
v_mfma_f32_16x16x32_bf16 v[172:175], a[24:27], a[128:131], v[172:175]
ds_read_b64_tr_b16 a[142:143], v9 offset:18432
v_mfma_f32_16x16x32_bf16 v[172:175], a[28:31], a[132:135], v[172:175]
v_mfma_f32_16x16x32_bf16 v[176:179], a[32:35], a[128:131], v[176:179]
v_mfma_f32_16x16x32_bf16 v[176:179], a[36:39], a[132:135], v[176:179]
buffer_load_dwordx4 v18, s[12:15], s27 offen offset:2048 lds
v_mfma_f32_16x16x32_bf16 v[180:183], a[40:43], a[128:131], v[180:183]
ds_read_b128 a[108:111], v3 offset:43008
v_mfma_f32_16x16x32_bf16 v[180:183], a[44:47], a[132:135], v[180:183]
v_mfma_f32_16x16x32_bf16 v[184:187], a[48:51], a[128:131], v[184:187]
ds_read_b128 a[112:115], v2 offset:45056
v_mfma_f32_16x16x32_bf16 v[184:187], a[52:55], a[132:135], v[184:187]
buffer_load_dwordx4 v19, s[12:15], s27 offen offset:3072 lds
v_mfma_f32_16x16x32_bf16 v[188:191], a[56:59], a[128:131], v[188:191]
s_add_u32 s27, s27, 524288
v_mfma_f32_16x16x32_bf16 v[188:191], a[60:63], a[132:135], v[188:191]
s_waitcnt lgkmcnt(2)
v_mfma_f32_16x16x32_bf16 v[192:195], a[0:3], a[136:139], v[192:195]
ds_read_b64_tr_b16 a[128:129], v10 offset:0
v_mfma_f32_16x16x32_bf16 v[192:195], a[4:7], a[140:143], v[192:195]
v_mfma_f32_16x16x32_bf16 v[196:199], a[8:11], a[136:139], v[196:199]
ds_read_b64_tr_b16 a[130:131], v10 offset:2048
v_mfma_f32_16x16x32_bf16 v[196:199], a[12:15], a[140:143], v[196:199]
v_mfma_f32_16x16x32_bf16 v[200:203], a[16:19], a[136:139], v[200:203]
ds_read_b64_tr_b16 a[132:133], v10 offset:16384
v_mfma_f32_16x16x32_bf16 v[200:203], a[20:23], a[140:143], v[200:203]
v_mfma_f32_16x16x32_bf16 v[204:207], a[24:27], a[136:139], v[204:207]
ds_read_b64_tr_b16 a[134:135], v10 offset:18432
v_mfma_f32_16x16x32_bf16 v[204:207], a[28:31], a[140:143], v[204:207]
v_mfma_f32_16x16x32_bf16 v[208:211], a[32:35], a[136:139], v[208:211]
ds_read_b128 a[116:119], v3 offset:45056
v_mfma_f32_16x16x32_bf16 v[208:211], a[36:39], a[140:143], v[208:211]
v_mfma_f32_16x16x32_bf16 v[212:215], a[40:43], a[136:139], v[212:215]
ds_read_b128 a[120:123], v2 offset:47104
v_mfma_f32_16x16x32_bf16 v[212:215], a[44:47], a[140:143], v[212:215]
v_mfma_f32_16x16x32_bf16 v[216:219], a[48:51], a[136:139], v[216:219]
v_mfma_f32_16x16x32_bf16 v[216:219], a[52:55], a[140:143], v[216:219]
v_mfma_f32_16x16x32_bf16 v[220:223], a[56:59], a[136:139], v[220:223]
ds_read_b128 a[124:127], v3 offset:47104
v_mfma_f32_16x16x32_bf16 v[220:223], a[60:63], a[140:143], v[220:223]
s_waitcnt lgkmcnt(3)
v_mfma_f32_16x16x32_bf16 a[192:195], a[0:3], a[128:131], a[192:195]
ds_read_b64_tr_b16 a[136:137], v11 offset:0
v_mfma_f32_16x16x32_bf16 a[192:195], a[4:7], a[132:135], a[192:195]
v_mfma_f32_16x16x32_bf16 a[196:199], a[8:11], a[128:131], a[196:199]
ds_read_b64_tr_b16 a[138:139], v11 offset:2048
v_mfma_f32_16x16x32_bf16 a[196:199], a[12:15], a[132:135], a[196:199]
v_mfma_f32_16x16x32_bf16 a[200:203], a[16:19], a[128:131], a[200:203]
ds_read_b64_tr_b16 a[140:141], v11 offset:16384
v_mfma_f32_16x16x32_bf16 a[200:203], a[20:23], a[132:135], a[200:203]
v_mfma_f32_16x16x32_bf16 a[204:207], a[24:27], a[128:131], a[204:207]
ds_read_b64_tr_b16 a[142:143], v11 offset:18432
v_mfma_f32_16x16x32_bf16 a[204:207], a[28:31], a[132:135], a[204:207]
v_mfma_f32_16x16x32_bf16 a[208:211], a[32:35], a[128:131], a[208:211]
v_mfma_f32_16x16x32_bf16 a[208:211], a[36:39], a[132:135], a[208:211]
v_mfma_f32_16x16x32_bf16 a[212:215], a[40:43], a[128:131], a[212:215]
v_mfma_f32_16x16x32_bf16 a[212:215], a[44:47], a[132:135], a[212:215]
v_mfma_f32_16x16x32_bf16 a[216:219], a[48:51], a[128:131], a[216:219]
v_mfma_f32_16x16x32_bf16 a[216:219], a[52:55], a[132:135], a[216:219]
v_mfma_f32_16x16x32_bf16 a[220:223], a[56:59], a[128:131], a[220:223]
s_waitcnt vmcnt(12) lgkmcnt(0)
v_mfma_f32_16x16x32_bf16 a[220:223], a[60:63], a[132:135], a[220:223]
s_barrier
v_mfma_f32_16x16x32_bf16 a[224:227], a[0:3], a[136:139], a[224:227]
s_add_u32 m0, s28, 32768
ds_read_b64_tr_b16 a[128:129], v4 offset:32768
v_mfma_f32_16x16x32_bf16 a[224:227], a[4:7], a[140:143], a[224:227]
s_lshr_b32 s22, s3, 1
buffer_load_dwordx4 v12, s[8:11], s24 offen offset:0 lds
v_mfma_f32_16x16x32_bf16 a[228:231], a[8:11], a[136:139], a[228:231]
s_lshl_b32 s22, s22, 14
ds_read_b64_tr_b16 a[130:131], v4 offset:34816
v_subrev_u32 v2, s22, v2
v_mfma_f32_16x16x32_bf16 a[228:231], a[12:15], a[140:143], a[228:231]
v_subrev_u32 v3, s22, v3
v_mfma_f32_16x16x32_bf16 a[232:235], a[16:19], a[136:139], a[232:235]
ds_read_b64_tr_b16 a[132:133], v4 offset:49152
v_mfma_f32_16x16x32_bf16 a[232:235], a[20:23], a[140:143], a[232:235]
buffer_load_dwordx4 v13, s[8:11], s24 offen offset:1024 lds
v_mfma_f32_16x16x32_bf16 a[236:239], a[24:27], a[136:139], a[236:239]
ds_read_b64_tr_b16 a[134:135], v4 offset:51200
v_mfma_f32_16x16x32_bf16 a[236:239], a[28:31], a[140:143], a[236:239]
v_mfma_f32_16x16x32_bf16 a[240:243], a[32:35], a[136:139], a[240:243]
v_mfma_f32_16x16x32_bf16 a[240:243], a[36:39], a[140:143], a[240:243]
buffer_load_dwordx4 v14, s[8:11], s24 offen offset:2048 lds
v_mfma_f32_16x16x32_bf16 a[244:247], a[40:43], a[136:139], a[244:247]
v_mfma_f32_16x16x32_bf16 a[244:247], a[44:47], a[140:143], a[244:247]
v_mfma_f32_16x16x32_bf16 a[248:251], a[48:51], a[136:139], a[248:251]
v_mfma_f32_16x16x32_bf16 a[248:251], a[52:55], a[140:143], a[248:251]
buffer_load_dwordx4 v15, s[8:11], s24 offen offset:3072 lds
v_mfma_f32_16x16x32_bf16 a[252:255], a[56:59], a[136:139], a[252:255]
s_add_u32 s24, s24, 128
v_mfma_f32_16x16x32_bf16 a[252:255], a[60:63], a[140:143], a[252:255]
s_waitcnt lgkmcnt(0)
v_mfma_f32_16x16x32_bf16 v[32:35], a[64:67], a[128:131], v[32:35]
s_add_u32 m0, s29, 65536
ds_read_b64_tr_b16 a[136:137], v5 offset:32768
v_mfma_f32_16x16x32_bf16 v[32:35], a[68:71], a[132:135], v[32:35]
buffer_load_dwordx4 v16, s[12:15], s26 offen offset:0 lds
v_mfma_f32_16x16x32_bf16 v[36:39], a[72:75], a[128:131], v[36:39]
ds_read_b64_tr_b16 a[138:139], v5 offset:34816
v_mfma_f32_16x16x32_bf16 v[36:39], a[76:79], a[132:135], v[36:39]
v_mfma_f32_16x16x32_bf16 v[40:43], a[80:83], a[128:131], v[40:43]
ds_read_b64_tr_b16 a[140:141], v5 offset:49152
v_mfma_f32_16x16x32_bf16 v[40:43], a[84:87], a[132:135], v[40:43]
buffer_load_dwordx4 v17, s[12:15], s26 offen offset:1024 lds
v_mfma_f32_16x16x32_bf16 v[44:47], a[88:91], a[128:131], v[44:47]
ds_read_b64_tr_b16 a[142:143], v5 offset:51200
v_mfma_f32_16x16x32_bf16 v[44:47], a[92:95], a[132:135], v[44:47]
v_mfma_f32_16x16x32_bf16 v[48:51], a[96:99], a[128:131], v[48:51]
ds_read_b128 a[0:3], v2 offset:0
v_cvt_pk_bf16_f32 v32, v32, v33
v_mfma_f32_16x16x32_bf16 v[48:51], a[100:103], a[132:135], v[48:51]
buffer_load_dwordx4 v18, s[12:15], s26 offen offset:2048 lds
v_mfma_f32_16x16x32_bf16 v[52:55], a[104:107], a[128:131], v[52:55]
ds_read_b128 a[4:7], v3 offset:0
v_cvt_pk_bf16_f32 v33, v34, v35
v_mfma_f32_16x16x32_bf16 v[52:55], a[108:111], a[132:135], v[52:55]
v_cvt_pk_bf16_f32 v34, v36, v37
v_cvt_pk_bf16_f32 v35, v38, v39
v_mfma_f32_16x16x32_bf16 v[56:59], a[112:115], a[128:131], v[56:59]
v_cvt_pk_bf16_f32 v40, v40, v41
v_cvt_pk_bf16_f32 v41, v42, v43
v_mfma_f32_16x16x32_bf16 v[56:59], a[116:119], a[132:135], v[56:59]
buffer_load_dwordx4 v19, s[12:15], s26 offen offset:3072 lds
v_mfma_f32_16x16x32_bf16 v[60:63], a[120:123], a[128:131], v[60:63]
s_add_u32 s26, s26, 524288
ds_read_b128 a[8:11], v2 offset:2048
v_cvt_pk_bf16_f32 v42, v44, v45
v_mfma_f32_16x16x32_bf16 v[60:63], a[124:127], a[132:135], v[60:63]
s_waitcnt lgkmcnt(3)
v_cvt_pk_bf16_f32 v43, v46, v47
v_mfma_f32_16x16x32_bf16 v[64:67], a[64:67], a[136:139], v[64:67]
s_add_u32 m0, s29, 81920
ds_read_b64_tr_b16 a[128:129], v6 offset:32768
v_cvt_pk_bf16_f32 v48, v48, v49
v_mfma_f32_16x16x32_bf16 v[64:67], a[68:71], a[140:143], v[64:67]
buffer_load_dwordx4 v16, s[12:15], s27 offen offset:0 lds
v_mfma_f32_16x16x32_bf16 v[68:71], a[72:75], a[136:139], v[68:71]
ds_read_b64_tr_b16 a[130:131], v6 offset:34816
v_cvt_pk_bf16_f32 v49, v50, v51
v_mfma_f32_16x16x32_bf16 v[68:71], a[76:79], a[140:143], v[68:71]
v_cvt_pk_bf16_f32 v50, v52, v53
v_cvt_pk_bf16_f32 v51, v54, v55
v_mfma_f32_16x16x32_bf16 v[72:75], a[80:83], a[136:139], v[72:75]
ds_read_b64_tr_b16 a[132:133], v6 offset:49152
v_cvt_pk_bf16_f32 v56, v56, v57
v_mfma_f32_16x16x32_bf16 v[72:75], a[84:87], a[140:143], v[72:75]
buffer_load_dwordx4 v17, s[12:15], s27 offen offset:1024 lds
v_mfma_f32_16x16x32_bf16 v[76:79], a[88:91], a[136:139], v[76:79]
ds_read_b64_tr_b16 a[134:135], v6 offset:51200
v_cvt_pk_bf16_f32 v57, v58, v59
v_mfma_f32_16x16x32_bf16 v[76:79], a[92:95], a[140:143], v[76:79]
v_cvt_pk_bf16_f32 v58, v60, v61
v_cvt_pk_bf16_f32 v59, v62, v63
v_mfma_f32_16x16x32_bf16 v[80:83], a[96:99], a[136:139], v[80:83]
ds_read_b128 a[12:15], v3 offset:2048
v_cvt_pk_bf16_f32 v64, v64, v65
v_mfma_f32_16x16x32_bf16 v[80:83], a[100:103], a[140:143], v[80:83]
buffer_load_dwordx4 v18, s[12:15], s27 offen offset:2048 lds
v_mfma_f32_16x16x32_bf16 v[84:87], a[104:107], a[136:139], v[84:87]
v_cvt_pk_bf16_f32 v65, v66, v67
v_cvt_pk_bf16_f32 v66, v68, v69
v_mfma_f32_16x16x32_bf16 v[84:87], a[108:111], a[140:143], v[84:87]
v_cvt_pk_bf16_f32 v67, v70, v71
v_mfma_f32_16x16x32_bf16 v[88:91], a[112:115], a[136:139], v[88:91]
ds_read_b128 a[16:19], v2 offset:4096
v_cvt_pk_bf16_f32 v72, v72, v73
v_mfma_f32_16x16x32_bf16 v[88:91], a[116:119], a[140:143], v[88:91]
buffer_load_dwordx4 v19, s[12:15], s27 offen offset:3072 lds
v_mfma_f32_16x16x32_bf16 v[92:95], a[120:123], a[136:139], v[92:95]
s_add_u32 s27, s27, 524288
ds_read_b128 a[20:23], v3 offset:4096
v_cvt_pk_bf16_f32 v73, v74, v75
v_mfma_f32_16x16x32_bf16 v[92:95], a[124:127], a[140:143], v[92:95]
s_waitcnt lgkmcnt(3)
v_cvt_pk_bf16_f32 v74, v76, v77
v_cvt_pk_bf16_f32 v75, v78, v79
v_mfma_f32_16x16x32_bf16 v[96:99], a[64:67], a[128:131], v[96:99]
s_add_u32 m0, s28, 49152
ds_read_b64_tr_b16 a[136:137], v7 offset:32768
v_cvt_pk_bf16_f32 v80, v80, v81
v_mfma_f32_16x16x32_bf16 v[96:99], a[68:71], a[132:135], v[96:99]
PAD_27:
s_cbranch_execz PAD_31
buffer_load_dwordx4 v12, s[8:11], s24 offen offset:0 lds
v_mfma_f32_16x16x32_bf16 v[100:103], a[72:75], a[128:131], v[100:103]
ds_read_b64_tr_b16 a[138:139], v7 offset:34816
v_cvt_pk_bf16_f32 v81, v82, v83
v_mfma_f32_16x16x32_bf16 v[100:103], a[76:79], a[132:135], v[100:103]
v_cvt_pk_bf16_f32 v82, v84, v85
v_cvt_pk_bf16_f32 v83, v86, v87
v_mfma_f32_16x16x32_bf16 v[104:107], a[80:83], a[128:131], v[104:107]
ds_read_b64_tr_b16 a[140:141], v7 offset:49152
v_cvt_pk_bf16_f32 v88, v88, v89
v_mfma_f32_16x16x32_bf16 v[104:107], a[84:87], a[132:135], v[104:107]
buffer_load_dwordx4 v13, s[8:11], s24 offen offset:1024 lds
v_mfma_f32_16x16x32_bf16 v[108:111], a[88:91], a[128:131], v[108:111]
ds_read_b64_tr_b16 a[142:143], v7 offset:51200
v_cvt_pk_bf16_f32 v89, v90, v91
v_mfma_f32_16x16x32_bf16 v[108:111], a[92:95], a[132:135], v[108:111]
v_cvt_pk_bf16_f32 v90, v92, v93
v_cvt_pk_bf16_f32 v91, v94, v95
v_mfma_f32_16x16x32_bf16 v[112:115], a[96:99], a[128:131], v[112:115]
v_cvt_pk_bf16_f32 v96, v96, v97
v_cvt_pk_bf16_f32 v97, v98, v99
v_mfma_f32_16x16x32_bf16 v[112:115], a[100:103], a[132:135], v[112:115]
buffer_load_dwordx4 v14, s[8:11], s24 offen offset:2048 lds
v_mfma_f32_16x16x32_bf16 v[116:119], a[104:107], a[128:131], v[116:119]
ds_read_b128 a[24:27], v2 offset:6144
v_cvt_pk_bf16_f32 v98, v100, v101
v_mfma_f32_16x16x32_bf16 v[116:119], a[108:111], a[132:135], v[116:119]
buffer_store_dwordx4 v[32:35], v1, s[4:7], s31 offen sc1
v_mfma_f32_16x16x32_bf16 v[120:123], a[112:115], a[128:131], v[120:123]
s_add_u32 s31, s31, s32
ds_read_b128 a[28:31], v3 offset:6144
v_cvt_pk_bf16_f32 v99, v102, v103
v_mfma_f32_16x16x32_bf16 v[120:123], a[116:119], a[132:135], v[120:123]
buffer_load_dwordx4 v15, s[8:11], s24 offen offset:3072 lds
v_mfma_f32_16x16x32_bf16 v[124:127], a[120:123], a[128:131], v[124:127]
s_add_u32 s24, s24, 128
v_cvt_pk_bf16_f32 v104, v104, v105
v_cvt_pk_bf16_f32 v105, v106, v107
v_mfma_f32_16x16x32_bf16 v[124:127], a[124:127], a[132:135], v[124:127]
s_waitcnt lgkmcnt(2)
v_cvt_pk_bf16_f32 v106, v108, v109
v_cvt_pk_bf16_f32 v107, v110, v111
v_mfma_f32_16x16x32_bf16 v[128:131], a[64:67], a[136:139], v[128:131]
ds_read_b64_tr_b16 a[128:129], v8 offset:32768
v_cvt_pk_bf16_f32 v112, v112, v113
v_mfma_f32_16x16x32_bf16 v[128:131], a[68:71], a[140:143], v[128:131]
v_cvt_pk_bf16_f32 v113, v114, v115
v_cvt_pk_bf16_f32 v114, v116, v117
v_mfma_f32_16x16x32_bf16 v[132:135], a[72:75], a[136:139], v[132:135]
ds_read_b64_tr_b16 a[130:131], v8 offset:34816
v_cvt_pk_bf16_f32 v115, v118, v119
v_mfma_f32_16x16x32_bf16 v[132:135], a[76:79], a[140:143], v[132:135]
buffer_store_dwordx4 v[40:43], v1, s[4:7], s31 offen sc1
v_mfma_f32_16x16x32_bf16 v[136:139], a[80:83], a[136:139], v[136:139]
s_add_u32 s31, s31, s33
ds_read_b64_tr_b16 a[132:133], v8 offset:49152
v_cvt_pk_bf16_f32 v120, v120, v121
v_mfma_f32_16x16x32_bf16 v[136:139], a[84:87], a[140:143], v[136:139]
v_cvt_pk_bf16_f32 v121, v122, v123
v_cvt_pk_bf16_f32 v122, v124, v125
v_mfma_f32_16x16x32_bf16 v[140:143], a[88:91], a[136:139], v[140:143]
ds_read_b64_tr_b16 a[134:135], v8 offset:51200
v_cvt_pk_bf16_f32 v123, v126, v127
v_mfma_f32_16x16x32_bf16 v[140:143], a[92:95], a[140:143], v[140:143]
v_mfma_f32_16x16x32_bf16 v[144:147], a[96:99], a[136:139], v[144:147]
ds_read_b128 a[32:35], v2 offset:8192
v_cvt_pk_bf16_f32 v128, v128, v129
v_mfma_f32_16x16x32_bf16 v[144:147], a[100:103], a[140:143], v[144:147]
v_cvt_pk_bf16_f32 v129, v130, v131
v_cvt_pk_bf16_f32 v130, v132, v133
v_mfma_f32_16x16x32_bf16 v[148:151], a[104:107], a[136:139], v[148:151]
v_cvt_pk_bf16_f32 v131, v134, v135
v_mfma_f32_16x16x32_bf16 v[148:151], a[108:111], a[140:143], v[148:151]
v_mfma_f32_16x16x32_bf16 v[152:155], a[112:115], a[136:139], v[152:155]
ds_read_b128 a[36:39], v3 offset:8192
v_cvt_pk_bf16_f32 v136, v136, v137
v_mfma_f32_16x16x32_bf16 v[152:155], a[116:119], a[140:143], v[152:155]
v_cvt_pk_bf16_f32 v137, v138, v139
v_cvt_pk_bf16_f32 v138, v140, v141
v_mfma_f32_16x16x32_bf16 v[156:159], a[120:123], a[136:139], v[156:159]
ds_read_b128 a[40:43], v2 offset:10240
v_cvt_pk_bf16_f32 v139, v142, v143
v_mfma_f32_16x16x32_bf16 v[156:159], a[124:127], a[140:143], v[156:159]
s_waitcnt lgkmcnt(3)
buffer_store_dwordx4 v[48:51], v1, s[4:7], s31 offen sc1
v_mfma_f32_16x16x32_bf16 v[160:163], a[64:67], a[128:131], v[160:163]
s_add_u32 s31, s31, s32
ds_read_b64_tr_b16 a[136:137], v9 offset:32768
v_cvt_pk_bf16_f32 v144, v144, v145
v_mfma_f32_16x16x32_bf16 v[160:163], a[68:71], a[132:135], v[160:163]
v_cvt_pk_bf16_f32 v145, v146, v147
v_cvt_pk_bf16_f32 v146, v148, v149
v_mfma_f32_16x16x32_bf16 v[164:167], a[72:75], a[128:131], v[164:167]
ds_read_b64_tr_b16 a[138:139], v9 offset:34816
v_cvt_pk_bf16_f32 v147, v150, v151
v_mfma_f32_16x16x32_bf16 v[164:167], a[76:79], a[132:135], v[164:167]
v_mfma_f32_16x16x32_bf16 v[168:171], a[80:83], a[128:131], v[168:171]
ds_read_b64_tr_b16 a[140:141], v9 offset:49152
v_cvt_pk_bf16_f32 v152, v152, v153
v_mfma_f32_16x16x32_bf16 v[168:171], a[84:87], a[132:135], v[168:171]
v_cvt_pk_bf16_f32 v153, v154, v155
v_cvt_pk_bf16_f32 v154, v156, v157
v_mfma_f32_16x16x32_bf16 v[172:175], a[88:91], a[128:131], v[172:175]
ds_read_b64_tr_b16 a[142:143], v9 offset:51200
v_cvt_pk_bf16_f32 v155, v158, v159
v_mfma_f32_16x16x32_bf16 v[172:175], a[92:95], a[132:135], v[172:175]
v_mfma_f32_16x16x32_bf16 v[176:179], a[96:99], a[128:131], v[176:179]
buffer_store_dwordx4 v[56:59], v1, s[4:7], s31 offen sc1
v_mfma_f32_16x16x32_bf16 v[176:179], a[100:103], a[132:135], v[176:179]
s_add_u32 s31, s31, s34
v_cvt_pk_bf16_f32 v160, v160, v161
v_cvt_pk_bf16_f32 v161, v162, v163
v_mfma_f32_16x16x32_bf16 v[180:183], a[104:107], a[128:131], v[180:183]
ds_read_b128 a[44:47], v3 offset:10240
v_cvt_pk_bf16_f32 v162, v164, v165
v_mfma_f32_16x16x32_bf16 v[180:183], a[108:111], a[132:135], v[180:183]
v_cvt_pk_bf16_f32 v163, v166, v167
v_mfma_f32_16x16x32_bf16 v[184:187], a[112:115], a[128:131], v[184:187]
ds_read_b128 a[48:51], v2 offset:12288
v_cvt_pk_bf16_f32 v168, v168, v169
v_mfma_f32_16x16x32_bf16 v[184:187], a[116:119], a[132:135], v[184:187]
v_cvt_pk_bf16_f32 v169, v170, v171
v_cvt_pk_bf16_f32 v170, v172, v173
v_mfma_f32_16x16x32_bf16 v[188:191], a[120:123], a[128:131], v[188:191]
v_cvt_pk_bf16_f32 v171, v174, v175
v_mfma_f32_16x16x32_bf16 v[188:191], a[124:127], a[132:135], v[188:191]
s_waitcnt lgkmcnt(2)
v_mfma_f32_16x16x32_bf16 v[192:195], a[64:67], a[136:139], v[192:195]
ds_read_b64_tr_b16 a[128:129], v10 offset:32768
v_cvt_pk_bf16_f32 v176, v176, v177
v_mfma_f32_16x16x32_bf16 v[192:195], a[68:71], a[140:143], v[192:195]
v_cvt_pk_bf16_f32 v177, v178, v179
v_cvt_pk_bf16_f32 v178, v180, v181
v_mfma_f32_16x16x32_bf16 v[196:199], a[72:75], a[136:139], v[196:199]
ds_read_b64_tr_b16 a[130:131], v10 offset:34816
v_cvt_pk_bf16_f32 v179, v182, v183
v_mfma_f32_16x16x32_bf16 v[196:199], a[76:79], a[140:143], v[196:199]
buffer_store_dwordx4 v[64:67], v1, s[4:7], s31 offen sc1
v_mfma_f32_16x16x32_bf16 v[200:203], a[80:83], a[136:139], v[200:203]
s_add_u32 s31, s31, s32
ds_read_b64_tr_b16 a[132:133], v10 offset:49152
v_cvt_pk_bf16_f32 v184, v184, v185
v_mfma_f32_16x16x32_bf16 v[200:203], a[84:87], a[140:143], v[200:203]
v_cvt_pk_bf16_f32 v185, v186, v187
v_cvt_pk_bf16_f32 v186, v188, v189
v_mfma_f32_16x16x32_bf16 v[204:207], a[88:91], a[136:139], v[204:207]
ds_read_b64_tr_b16 a[134:135], v10 offset:51200
v_cvt_pk_bf16_f32 v187, v190, v191
v_mfma_f32_16x16x32_bf16 v[204:207], a[92:95], a[140:143], v[204:207]
v_mfma_f32_16x16x32_bf16 v[208:211], a[96:99], a[136:139], v[208:211]
ds_read_b128 a[52:55], v3 offset:12288
v_cvt_pk_bf16_f32 v192, v192, v193
v_mfma_f32_16x16x32_bf16 v[208:211], a[100:103], a[140:143], v[208:211]
v_cvt_pk_bf16_f32 v193, v194, v195
v_cvt_pk_bf16_f32 v194, v196, v197
v_mfma_f32_16x16x32_bf16 v[212:215], a[104:107], a[136:139], v[212:215]
ds_read_b128 a[56:59], v2 offset:14336
v_cvt_pk_bf16_f32 v195, v198, v199
v_mfma_f32_16x16x32_bf16 v[212:215], a[108:111], a[140:143], v[212:215]
v_mfma_f32_16x16x32_bf16 v[216:219], a[112:115], a[136:139], v[216:219]
v_cvt_pk_bf16_f32 v200, v200, v201
v_cvt_pk_bf16_f32 v201, v202, v203
v_mfma_f32_16x16x32_bf16 v[216:219], a[116:119], a[140:143], v[216:219]
buffer_store_dwordx4 v[72:75], v1, s[4:7], s31 offen sc1
v_mfma_f32_16x16x32_bf16 v[220:223], a[120:123], a[136:139], v[220:223]
s_add_u32 s31, s31, s33
ds_read_b128 a[60:63], v3 offset:14336
v_cvt_pk_bf16_f32 v202, v204, v205
v_mfma_f32_16x16x32_bf16 v[220:223], a[124:127], a[140:143], v[220:223]
s_waitcnt lgkmcnt(3)
v_cvt_pk_bf16_f32 v203, v206, v207
v_mfma_f32_16x16x32_bf16 a[192:195], a[64:67], a[128:131], a[192:195]
ds_read_b64_tr_b16 a[136:137], v11 offset:32768
v_cvt_pk_bf16_f32 v208, v208, v209
v_mfma_f32_16x16x32_bf16 a[192:195], a[68:71], a[132:135], a[192:195]
v_cvt_pk_bf16_f32 v209, v210, v211
v_cvt_pk_bf16_f32 v210, v212, v213
v_mfma_f32_16x16x32_bf16 a[196:199], a[72:75], a[128:131], a[196:199]
ds_read_b64_tr_b16 a[138:139], v11 offset:34816
v_cvt_pk_bf16_f32 v211, v214, v215
v_mfma_f32_16x16x32_bf16 a[196:199], a[76:79], a[132:135], a[196:199]
v_mfma_f32_16x16x32_bf16 a[200:203], a[80:83], a[128:131], a[200:203]
ds_read_b64_tr_b16 a[140:141], v11 offset:49152
v_cvt_pk_bf16_f32 v216, v216, v217
v_mfma_f32_16x16x32_bf16 a[200:203], a[84:87], a[132:135], a[200:203]
v_cvt_pk_bf16_f32 v217, v218, v219
v_cvt_pk_bf16_f32 v218, v220, v221
v_mfma_f32_16x16x32_bf16 a[204:207], a[88:91], a[128:131], a[204:207]
ds_read_b64_tr_b16 a[142:143], v11 offset:51200
v_cvt_pk_bf16_f32 v219, v222, v223
v_mfma_f32_16x16x32_bf16 a[204:207], a[92:95], a[132:135], a[204:207]
v_mfma_f32_16x16x32_bf16 a[208:211], a[96:99], a[128:131], a[208:211]
buffer_store_dwordx4 v[80:83], v1, s[4:7], s31 offen sc1
v_mfma_f32_16x16x32_bf16 a[208:211], a[100:103], a[132:135], a[208:211]
s_add_u32 s31, s31, s32
v_mfma_f32_16x16x32_bf16 a[212:215], a[104:107], a[128:131], a[212:215]
v_mfma_f32_16x16x32_bf16 a[212:215], a[108:111], a[132:135], a[212:215]
v_mfma_f32_16x16x32_bf16 a[216:219], a[112:115], a[128:131], a[216:219]
v_mfma_f32_16x16x32_bf16 a[216:219], a[116:119], a[132:135], a[216:219]
v_mfma_f32_16x16x32_bf16 a[220:223], a[120:123], a[128:131], a[220:223]
s_waitcnt vmcnt(23) lgkmcnt(0)
v_mfma_f32_16x16x32_bf16 a[220:223], a[124:127], a[132:135], a[220:223]
s_barrier
v_mfma_f32_16x16x32_bf16 a[224:227], a[64:67], a[136:139], a[224:227]
s_add_u32 m0, s29, 98304
ds_read_b64_tr_b16 a[128:129], v22 offset:0
v_mfma_f32_16x16x32_bf16 a[224:227], a[68:71], a[140:143], a[224:227]
buffer_load_dwordx4 v16, s[12:15], s26 offen offset:0 lds
v_mfma_f32_16x16x32_bf16 a[228:231], a[72:75], a[136:139], a[228:231]
ds_read_b64_tr_b16 a[130:131], v22 offset:2048
v_mfma_f32_16x16x32_bf16 a[228:231], a[76:79], a[140:143], a[228:231]
buffer_store_dwordx4 v[88:91], v1, s[4:7], s31 offen sc1
v_mfma_f32_16x16x32_bf16 a[232:235], a[80:83], a[136:139], a[232:235]
s_add_u32 s31, s31, s35
ds_read_b64_tr_b16 a[132:133], v22 offset:16384
v_mfma_f32_16x16x32_bf16 a[232:235], a[84:87], a[140:143], a[232:235]
buffer_load_dwordx4 v17, s[12:15], s26 offen offset:1024 lds
v_mfma_f32_16x16x32_bf16 a[236:239], a[88:91], a[136:139], a[236:239]
ds_read_b64_tr_b16 a[134:135], v22 offset:18432
v_add_u32 v22, 4294901760, v22
v_mfma_f32_16x16x32_bf16 a[236:239], a[92:95], a[140:143], a[236:239]
v_mfma_f32_16x16x32_bf16 a[240:243], a[96:99], a[136:139], a[240:243]
v_mfma_f32_16x16x32_bf16 a[240:243], a[100:103], a[140:143], a[240:243]
buffer_load_dwordx4 v18, s[12:15], s26 offen offset:2048 lds
v_mfma_f32_16x16x32_bf16 a[244:247], a[104:107], a[136:139], a[244:247]
v_mfma_f32_16x16x32_bf16 a[244:247], a[108:111], a[140:143], a[244:247]
v_mfma_f32_16x16x32_bf16 a[248:251], a[112:115], a[136:139], a[248:251]
v_mfma_f32_16x16x32_bf16 a[248:251], a[116:119], a[140:143], a[248:251]
buffer_load_dwordx4 v19, s[12:15], s26 offen offset:3072 lds
v_mfma_f32_16x16x32_bf16 a[252:255], a[120:123], a[136:139], a[252:255]
s_add_u32 s26, s26, 524288
v_mfma_f32_16x16x32_bf16 a[252:255], a[124:127], a[140:143], a[252:255]
s_waitcnt lgkmcnt(0)
s_cmp_ge_u32 s21, 7
s_cbranch_scc1 M_Q
M_conv:
v_mfma_f32_16x16x32_bf16 v[36:39], a[128:131], a[0:3], 0
s_add_u32 m0, s29, 114688
ds_read_b64_tr_b16 a[136:137], v23 offset:0
v_mfma_f32_16x16x32_bf16 v[36:39], a[132:135], a[4:7], v[36:39]
buffer_load_dwordx4 v16, s[12:15], s27 offen offset:0 lds
v_mfma_f32_16x16x32_bf16 v[44:47], a[128:131], a[8:11], 0
ds_read_b64_tr_b16 a[138:139], v23 offset:2048
v_mfma_f32_16x16x32_bf16 v[44:47], a[132:135], a[12:15], v[44:47]
ds_read_b128 a[64:67], v2 offset:16384
ds_read_b128 a[68:71], v3 offset:16384
v_mfma_f32_16x16x32_bf16 v[52:55], a[128:131], a[16:19], 0
ds_read_b64_tr_b16 a[140:141], v23 offset:16384
v_mfma_f32_16x16x32_bf16 v[52:55], a[132:135], a[20:23], v[52:55]
buffer_load_dwordx4 v17, s[12:15], s27 offen offset:1024 lds
v_mfma_f32_16x16x32_bf16 v[60:63], a[128:131], a[24:27], 0
ds_read_b64_tr_b16 a[142:143], v23 offset:18432
v_add_u32 v23, 4294901760, v23
v_mfma_f32_16x16x32_bf16 v[60:63], a[132:135], a[28:31], v[60:63]
buffer_store_dwordx4 v[96:99], v1, s[4:7], s31 offen sc1
v_mfma_f32_16x16x32_bf16 v[68:71], a[128:131], a[32:35], 0
s_add_u32 s31, s31, s32
ds_read_b128 a[72:75], v2 offset:18432
v_mfma_f32_16x16x32_bf16 v[68:71], a[132:135], a[36:39], v[68:71]
buffer_load_dwordx4 v18, s[12:15], s27 offen offset:2048 lds
v_mfma_f32_16x16x32_bf16 v[76:79], a[128:131], a[40:43], 0
ds_read_b128 a[76:79], v3 offset:18432
v_mfma_f32_16x16x32_bf16 v[76:79], a[132:135], a[44:47], v[76:79]
ds_read_b128 a[80:83], v2 offset:20480
v_mfma_f32_16x16x32_bf16 v[84:87], a[128:131], a[48:51], 0
ds_read_b128 a[84:87], v3 offset:20480
v_mfma_f32_16x16x32_bf16 v[84:87], a[132:135], a[52:55], v[84:87]
buffer_load_dwordx4 v19, s[12:15], s27 offen offset:3072 lds
v_mfma_f32_16x16x32_bf16 v[92:95], a[128:131], a[56:59], 0
s_add_u32 s27, s27, 524288
ds_read_b128 a[88:91], v2 offset:22528
v_mfma_f32_16x16x32_bf16 v[92:95], a[132:135], a[60:63], v[92:95]
s_waitcnt lgkmcnt(5)
buffer_store_dwordx4 v[104:107], v1, s[4:7], s31 offen sc1
v_mfma_f32_16x16x32_bf16 v[100:103], a[136:139], a[0:3], 0
s_add_u32 m0, s28, 0
ds_read_b64_tr_b16 a[128:129], v24 offset:0
v_mfma_f32_16x16x32_bf16 v[100:103], a[140:143], a[4:7], v[100:103]
s_add_u32 s31, s31, s33
buffer_load_dwordx4 v12, s[8:11], s24 offen offset:0 lds
v_mfma_f32_16x16x32_bf16 v[108:111], a[136:139], a[8:11], 0
ds_read_b64_tr_b16 a[130:131], v24 offset:2048
v_mfma_f32_16x16x32_bf16 v[108:111], a[140:143], a[12:15], v[108:111]
ds_read_b128 a[92:95], v3 offset:22528
v_mfma_f32_16x16x32_bf16 v[116:119], a[136:139], a[16:19], 0
ds_read_b64_tr_b16 a[132:133], v24 offset:16384
v_mfma_f32_16x16x32_bf16 v[116:119], a[140:143], a[20:23], v[116:119]
buffer_load_dwordx4 v13, s[8:11], s24 offen offset:1024 lds
v_mfma_f32_16x16x32_bf16 v[124:127], a[136:139], a[24:27], 0
ds_read_b64_tr_b16 a[134:135], v24 offset:18432
v_add_u32 v24, 4294901760, v24
v_mfma_f32_16x16x32_bf16 v[124:127], a[140:143], a[28:31], v[124:127]
v_mfma_f32_16x16x32_bf16 v[132:135], a[136:139], a[32:35], 0
ds_read_b128 a[96:99], v2 offset:24576
v_mfma_f32_16x16x32_bf16 v[132:135], a[140:143], a[36:39], v[132:135]
buffer_load_dwordx4 v14, s[8:11], s24 offen offset:2048 lds
v_mfma_f32_16x16x32_bf16 v[140:143], a[136:139], a[40:43], 0
ds_read_b128 a[100:103], v3 offset:24576
v_mfma_f32_16x16x32_bf16 v[140:143], a[140:143], a[44:47], v[140:143]
ds_read_b128 a[104:107], v2 offset:26624
v_mfma_f32_16x16x32_bf16 v[148:151], a[136:139], a[48:51], 0
ds_read_b128 a[108:111], v3 offset:26624
v_mfma_f32_16x16x32_bf16 v[148:151], a[140:143], a[52:55], v[148:151]
buffer_load_dwordx4 v15, s[8:11], s24 offen offset:3072 lds
v_mfma_f32_16x16x32_bf16 v[156:159], a[136:139], a[56:59], 0
s_add_u32 s24, s24, 128
ds_read_b128 a[112:115], v2 offset:28672
v_mfma_f32_16x16x32_bf16 v[156:159], a[140:143], a[60:63], v[156:159]
s_waitcnt lgkmcnt(5)
buffer_store_dwordx4 v[112:115], v1, s[4:7], s31 offen sc1
v_mfma_f32_16x16x32_bf16 v[164:167], a[128:131], a[0:3], 0
s_add_u32 s31, s31, s32
ds_read_b64_tr_b16 a[136:137], v25 offset:0
v_mfma_f32_16x16x32_bf16 v[164:167], a[132:135], a[4:7], v[164:167]
v_mfma_f32_16x16x32_bf16 v[172:175], a[128:131], a[8:11], 0
ds_read_b64_tr_b16 a[138:139], v25 offset:2048
v_mfma_f32_16x16x32_bf16 v[172:175], a[132:135], a[12:15], v[172:175]
ds_read_b128 a[116:119], v3 offset:28672
v_mfma_f32_16x16x32_bf16 v[180:183], a[128:131], a[16:19], 0
ds_read_b64_tr_b16 a[140:141], v25 offset:16384
v_mfma_f32_16x16x32_bf16 v[180:183], a[132:135], a[20:23], v[180:183]
v_mfma_f32_16x16x32_bf16 v[188:191], a[128:131], a[24:27], 0
ds_read_b64_tr_b16 a[142:143], v25 offset:18432
v_add_u32 v25, 4294901760, v25
v_mfma_f32_16x16x32_bf16 v[188:191], a[132:135], a[28:31], v[188:191]
v_mfma_f32_16x16x32_bf16 v[196:199], a[128:131], a[32:35], 0
ds_read_b128 a[120:123], v2 offset:30720
v_mfma_f32_16x16x32_bf16 v[196:199], a[132:135], a[36:39], v[196:199]
v_mfma_f32_16x16x32_bf16 v[204:207], a[128:131], a[40:43], 0
ds_read_b128 a[124:127], v3 offset:30720
v_mfma_f32_16x16x32_bf16 v[204:207], a[132:135], a[44:47], v[204:207]
v_mfma_f32_16x16x32_bf16 v[212:215], a[128:131], a[48:51], 0
v_mfma_f32_16x16x32_bf16 v[212:215], a[132:135], a[52:55], v[212:215]
buffer_store_dwordx4 v[120:123], v1, s[4:7], s31 offen sc1
v_mfma_f32_16x16x32_bf16 v[220:223], a[128:131], a[56:59], 0
s_add_u32 s31, s31, s34
v_mfma_f32_16x16x32_bf16 v[220:223], a[132:135], a[60:63], v[220:223]
s_waitcnt vmcnt(28) lgkmcnt(0)
s_barrier
v_mfma_f32_16x16x32_bf16 v[224:227], a[136:139], a[0:3], 0
s_add_u32 m0, s29, 131072
ds_read_b64_tr_b16 a[128:129], v22 offset:0
v_mfma_f32_16x16x32_bf16 v[224:227], a[140:143], a[4:7], v[224:227]
buffer_load_dwordx4 v16, s[12:15], s26 offen offset:0 lds
v_mfma_f32_16x16x32_bf16 v[228:231], a[136:139], a[8:11], 0
ds_read_b64_tr_b16 a[130:131], v22 offset:2048
v_mfma_f32_16x16x32_bf16 v[228:231], a[140:143], a[12:15], v[228:231]
v_mfma_f32_16x16x32_bf16 v[232:235], a[136:139], a[16:19], 0
ds_read_b64_tr_b16 a[132:133], v22 offset:16384
v_mfma_f32_16x16x32_bf16 v[232:235], a[140:143], a[20:23], v[232:235]
buffer_load_dwordx4 v17, s[12:15], s26 offen offset:1024 lds
v_mfma_f32_16x16x32_bf16 v[236:239], a[136:139], a[24:27], 0
ds_read_b64_tr_b16 a[134:135], v22 offset:18432
v_add_u32 v22, 32768, v22
v_mfma_f32_16x16x32_bf16 v[236:239], a[140:143], a[28:31], v[236:239]
v_mfma_f32_16x16x32_bf16 v[240:243], a[136:139], a[32:35], 0
v_mfma_f32_16x16x32_bf16 v[240:243], a[140:143], a[36:39], v[240:243]
buffer_load_dwordx4 v18, s[12:15], s26 offen offset:2048 lds
v_mfma_f32_16x16x32_bf16 v[244:247], a[136:139], a[40:43], 0
v_mfma_f32_16x16x32_bf16 v[244:247], a[140:143], a[44:47], v[244:247]
v_mfma_f32_16x16x32_bf16 v[248:251], a[136:139], a[48:51], 0
v_mfma_f32_16x16x32_bf16 v[248:251], a[140:143], a[52:55], v[248:251]
buffer_load_dwordx4 v19, s[12:15], s26 offen offset:3072 lds
v_mfma_f32_16x16x32_bf16 v[252:255], a[136:139], a[56:59], 0
s_add_u32 s26, s26, 524288
v_mfma_f32_16x16x32_bf16 v[252:255], a[140:143], a[60:63], v[252:255]
s_waitcnt lgkmcnt(0)
v_mfma_f32_16x16x32_bf16 v[36:39], a[128:131], a[64:67], v[36:39]
s_add_u32 m0, s29, 147456
ds_read_b64_tr_b16 a[136:137], v23 offset:0
v_accvgpr_read_b32 v32, a192
v_mfma_f32_16x16x32_bf16 v[36:39], a[132:135], a[68:71], v[36:39]
buffer_load_dwordx4 v16, s[12:15], s27 offen offset:0 lds
v_mfma_f32_16x16x32_bf16 v[44:47], a[128:131], a[72:75], v[44:47]
ds_read_b64_tr_b16 a[138:139], v23 offset:2048
v_accvgpr_read_b32 v33, a193
v_mfma_f32_16x16x32_bf16 v[44:47], a[132:135], a[76:79], v[44:47]
ds_read_b128 a[0:3], v2 offset:32768
ds_read_b128 a[4:7], v3 offset:32768
v_mfma_f32_16x16x32_bf16 v[52:55], a[128:131], a[80:83], v[52:55]
ds_read_b64_tr_b16 a[140:141], v23 offset:16384
v_accvgpr_read_b32 v34, a194
v_mfma_f32_16x16x32_bf16 v[52:55], a[132:135], a[84:87], v[52:55]
buffer_load_dwordx4 v17, s[12:15], s27 offen offset:1024 lds
v_mfma_f32_16x16x32_bf16 v[60:63], a[128:131], a[88:91], v[60:63]
ds_read_b64_tr_b16 a[142:143], v23 offset:18432
v_add_u32 v23, 32768, v23
v_mfma_f32_16x16x32_bf16 v[60:63], a[132:135], a[92:95], v[60:63]
buffer_store_dwordx4 v[128:131], v1, s[4:7], s31 offen sc1
v_mfma_f32_16x16x32_bf16 v[68:71], a[128:131], a[96:99], v[68:71]
s_add_u32 s31, s31, s32
ds_read_b128 a[8:11], v2 offset:34816
v_accvgpr_read_b32 v35, a195
v_mfma_f32_16x16x32_bf16 v[68:71], a[132:135], a[100:103], v[68:71]
buffer_load_dwordx4 v18, s[12:15], s27 offen offset:2048 lds
v_mfma_f32_16x16x32_bf16 v[76:79], a[128:131], a[104:107], v[76:79]
ds_read_b128 a[12:15], v3 offset:34816
v_accvgpr_read_b32 v96, a196
v_mfma_f32_16x16x32_bf16 v[76:79], a[132:135], a[108:111], v[76:79]
ds_read_b128 a[16:19], v2 offset:36864
v_accvgpr_read_b32 v97, a197
v_mfma_f32_16x16x32_bf16 v[84:87], a[128:131], a[112:115], v[84:87]
ds_read_b128 a[20:23], v3 offset:36864
v_accvgpr_read_b32 v98, a198
v_mfma_f32_16x16x32_bf16 v[84:87], a[132:135], a[116:119], v[84:87]
buffer_load_dwordx4 v19, s[12:15], s27 offen offset:3072 lds
v_mfma_f32_16x16x32_bf16 v[92:95], a[128:131], a[120:123], v[92:95]
s_add_u32 s27, s27, 524288
ds_read_b128 a[24:27], v2 offset:38912
v_accvgpr_read_b32 v99, a199
v_mfma_f32_16x16x32_bf16 v[92:95], a[132:135], a[124:127], v[92:95]
s_waitcnt lgkmcnt(5)
buffer_store_dwordx4 v[136:139], v1, s[4:7], s31 offen sc1
v_mfma_f32_16x16x32_bf16 v[100:103], a[136:139], a[64:67], v[100:103]
s_add_u32 m0, s28, 16384
ds_read_b64_tr_b16 a[128:129], v24 offset:0
v_cvt_pk_bf16_f32 v32, v32, v33
v_mfma_f32_16x16x32_bf16 v[100:103], a[140:143], a[68:71], v[100:103]
s_add_u32 s31, s31, s33
buffer_load_dwordx4 v12, s[8:11], s24 offen offset:0 lds
v_mfma_f32_16x16x32_bf16 v[108:111], a[136:139], a[72:75], v[108:111]
ds_read_b64_tr_b16 a[130:131], v24 offset:2048
v_cvt_pk_bf16_f32 v33, v34, v35
v_mfma_f32_16x16x32_bf16 v[108:111], a[140:143], a[76:79], v[108:111]
ds_read_b128 a[28:31], v3 offset:38912
v_cvt_pk_bf16_f32 v34, v96, v97
v_mfma_f32_16x16x32_bf16 v[116:119], a[136:139], a[80:83], v[116:119]
ds_read_b64_tr_b16 a[132:133], v24 offset:16384
v_cvt_pk_bf16_f32 v35, v98, v99
v_mfma_f32_16x16x32_bf16 v[116:119], a[140:143], a[84:87], v[116:119]
buffer_load_dwordx4 v13, s[8:11], s24 offen offset:1024 lds
v_mfma_f32_16x16x32_bf16 v[124:127], a[136:139], a[88:91], v[124:127]
ds_read_b64_tr_b16 a[134:135], v24 offset:18432
v_add_u32 v24, 32768, v24
v_mfma_f32_16x16x32_bf16 v[124:127], a[140:143], a[92:95], v[124:127]
v_accvgpr_read_b32 v40, a200
v_accvgpr_read_b32 v41, a201
v_mfma_f32_16x16x32_bf16 v[132:135], a[136:139], a[96:99], v[132:135]
ds_read_b128 a[32:35], v2 offset:40960
v_accvgpr_read_b32 v42, a202
v_mfma_f32_16x16x32_bf16 v[132:135], a[140:143], a[100:103], v[132:135]
buffer_load_dwordx4 v14, s[8:11], s24 offen offset:2048 lds
v_mfma_f32_16x16x32_bf16 v[140:143], a[136:139], a[104:107], v[140:143]
ds_read_b128 a[36:39], v3 offset:40960
v_accvgpr_read_b32 v43, a203
v_mfma_f32_16x16x32_bf16 v[140:143], a[140:143], a[108:111], v[140:143]
ds_read_b128 a[40:43], v2 offset:43008
v_accvgpr_read_b32 v96, a204
v_mfma_f32_16x16x32_bf16 v[148:151], a[136:139], a[112:115], v[148:151]
ds_read_b128 a[44:47], v3 offset:43008
v_accvgpr_read_b32 v97, a205
v_mfma_f32_16x16x32_bf16 v[148:151], a[140:143], a[116:119], v[148:151]
buffer_load_dwordx4 v15, s[8:11], s24 offen offset:3072 lds
v_mfma_f32_16x16x32_bf16 v[156:159], a[136:139], a[120:123], v[156:159]
s_add_u32 s24, s24, 128
ds_read_b128 a[48:51], v2 offset:45056
v_accvgpr_read_b32 v98, a206
v_mfma_f32_16x16x32_bf16 v[156:159], a[140:143], a[124:127], v[156:159]
s_waitcnt lgkmcnt(5)
buffer_store_dwordx4 v[144:147], v1, s[4:7], s31 offen sc1
v_mfma_f32_16x16x32_bf16 v[164:167], a[128:131], a[64:67], v[164:167]
s_add_u32 s31, s31, s32
ds_read_b64_tr_b16 a[136:137], v25 offset:0
v_accvgpr_read_b32 v99, a207
v_mfma_f32_16x16x32_bf16 v[164:167], a[132:135], a[68:71], v[164:167]
v_cvt_pk_bf16_f32 v40, v40, v41
v_cvt_pk_bf16_f32 v41, v42, v43
v_mfma_f32_16x16x32_bf16 v[172:175], a[128:131], a[72:75], v[172:175]
ds_read_b64_tr_b16 a[138:139], v25 offset:2048
v_cvt_pk_bf16_f32 v42, v96, v97
v_mfma_f32_16x16x32_bf16 v[172:175], a[132:135], a[76:79], v[172:175]
ds_read_b128 a[52:55], v3 offset:45056
v_cvt_pk_bf16_f32 v43, v98, v99
v_mfma_f32_16x16x32_bf16 v[180:183], a[128:131], a[80:83], v[180:183]
ds_read_b64_tr_b16 a[140:141], v25 offset:16384
v_accvgpr_read_b32 v48, a208
v_mfma_f32_16x16x32_bf16 v[180:183], a[132:135], a[84:87], v[180:183]
v_accvgpr_read_b32 v49, a209
v_accvgpr_read_b32 v50, a210
v_mfma_f32_16x16x32_bf16 v[188:191], a[128:131], a[88:91], v[188:191]
ds_read_b64_tr_b16 a[142:143], v25 offset:18432
v_add_u32 v25, 32768, v25
v_mfma_f32_16x16x32_bf16 v[188:191], a[132:135], a[92:95], v[188:191]
v_accvgpr_read_b32 v51, a211
v_accvgpr_read_b32 v96, a212
v_mfma_f32_16x16x32_bf16 v[196:199], a[128:131], a[96:99], v[196:199]
ds_read_b128 a[56:59], v2 offset:47104
v_accvgpr_read_b32 v97, a213
v_mfma_f32_16x16x32_bf16 v[196:199], a[132:135], a[100:103], v[196:199]
v_accvgpr_read_b32 v98, a214
v_accvgpr_read_b32 v99, a215
v_mfma_f32_16x16x32_bf16 v[204:207], a[128:131], a[104:107], v[204:207]
ds_read_b128 a[60:63], v3 offset:47104
v_cvt_pk_bf16_f32 v48, v48, v49
v_mfma_f32_16x16x32_bf16 v[204:207], a[132:135], a[108:111], v[204:207]
v_cvt_pk_bf16_f32 v49, v50, v51
v_cvt_pk_bf16_f32 v50, v96, v97
v_mfma_f32_16x16x32_bf16 v[212:215], a[128:131], a[112:115], v[212:215]
v_cvt_pk_bf16_f32 v51, v98, v99
v_accvgpr_read_b32 v56, a216
v_mfma_f32_16x16x32_bf16 v[212:215], a[132:135], a[116:119], v[212:215]
buffer_store_dwordx4 v[152:155], v1, s[4:7], s31 offen sc1
v_mfma_f32_16x16x32_bf16 v[220:223], a[128:131], a[120:123], v[220:223]
s_add_u32 s31, s31, s36
v_accvgpr_read_b32 v57, a217
v_accvgpr_read_b32 v58, a218
v_mfma_f32_16x16x32_bf16 v[220:223], a[132:135], a[124:127], v[220:223]
s_waitcnt vmcnt(23) lgkmcnt(0)
s_barrier
v_accvgpr_read_b32 v59, a219
v_mfma_f32_16x16x32_bf16 v[224:227], a[136:139], a[64:67], v[224:227]
s_add_u32 m0, s29, 65536
ds_read_b64_tr_b16 a[128:129], v22 offset:0
v_accvgpr_read_b32 v96, a220
v_mfma_f32_16x16x32_bf16 v[224:227], a[140:143], a[68:71], v[224:227]
buffer_load_dwordx4 v16, s[12:15], s26 offen offset:0 lds
v_mfma_f32_16x16x32_bf16 v[228:231], a[136:139], a[72:75], v[228:231]
ds_read_b64_tr_b16 a[130:131], v22 offset:2048
v_accvgpr_read_b32 v97, a221
v_mfma_f32_16x16x32_bf16 v[228:231], a[140:143], a[76:79], v[228:231]
v_accvgpr_read_b32 v98, a222
v_accvgpr_read_b32 v99, a223
v_mfma_f32_16x16x32_bf16 v[232:235], a[136:139], a[80:83], v[232:235]
ds_read_b64_tr_b16 a[132:133], v22 offset:16384
v_cvt_pk_bf16_f32 v56, v56, v57
v_mfma_f32_16x16x32_bf16 v[232:235], a[140:143], a[84:87], v[232:235]
buffer_load_dwordx4 v17, s[12:15], s26 offen offset:1024 lds
v_mfma_f32_16x16x32_bf16 v[236:239], a[136:139], a[88:91], v[236:239]
ds_read_b64_tr_b16 a[134:135], v22 offset:18432
v_add_u32 v22, 32768, v22
v_mfma_f32_16x16x32_bf16 v[236:239], a[140:143], a[92:95], v[236:239]
PAD_28:
s_cbranch_execz M_tret
v_cvt_pk_bf16_f32 v57, v58, v59
v_cvt_pk_bf16_f32 v58, v96, v97
v_mfma_f32_16x16x32_bf16 v[240:243], a[136:139], a[96:99], v[240:243]
v_cvt_pk_bf16_f32 v59, v98, v99
v_accvgpr_read_b32 v64, a224
v_mfma_f32_16x16x32_bf16 v[240:243], a[140:143], a[100:103], v[240:243]
buffer_load_dwordx4 v18, s[12:15], s26 offen offset:2048 lds
v_mfma_f32_16x16x32_bf16 v[244:247], a[136:139], a[104:107], v[244:247]
v_accvgpr_read_b32 v65, a225
v_accvgpr_read_b32 v66, a226
v_mfma_f32_16x16x32_bf16 v[244:247], a[140:143], a[108:111], v[244:247]
v_accvgpr_read_b32 v67, a227
v_accvgpr_read_b32 v96, a228
v_mfma_f32_16x16x32_bf16 v[248:251], a[136:139], a[112:115], v[248:251]
v_accvgpr_read_b32 v97, a229
v_accvgpr_read_b32 v98, a230
v_mfma_f32_16x16x32_bf16 v[248:251], a[140:143], a[116:119], v[248:251]
buffer_load_dwordx4 v19, s[12:15], s26 offen offset:3072 lds
v_mfma_f32_16x16x32_bf16 v[252:255], a[136:139], a[120:123], v[252:255]
s_add_u32 s26, s26, 524288
v_accvgpr_read_b32 v99, a231
v_cvt_pk_bf16_f32 v64, v64, v65
v_mfma_f32_16x16x32_bf16 v[252:255], a[140:143], a[124:127], v[252:255]
s_waitcnt lgkmcnt(0)
v_cvt_pk_bf16_f32 v65, v66, v67
v_cvt_pk_bf16_f32 v66, v96, v97
v_mfma_f32_16x16x32_bf16 v[36:39], a[128:131], a[0:3], v[36:39]
s_add_u32 m0, s29, 81920
ds_read_b64_tr_b16 a[136:137], v23 offset:0
v_cvt_pk_bf16_f32 v67, v98, v99
v_mfma_f32_16x16x32_bf16 v[36:39], a[132:135], a[4:7], v[36:39]
buffer_load_dwordx4 v16, s[12:15], s27 offen offset:0 lds
v_mfma_f32_16x16x32_bf16 v[44:47], a[128:131], a[8:11], v[44:47]
ds_read_b64_tr_b16 a[138:139], v23 offset:2048
v_accvgpr_read_b32 v72, a232
v_mfma_f32_16x16x32_bf16 v[44:47], a[132:135], a[12:15], v[44:47]
ds_read_b128 a[64:67], v2 offset:49152
ds_read_b128 a[68:71], v3 offset:49152
v_mfma_f32_16x16x32_bf16 v[52:55], a[128:131], a[16:19], v[52:55]
ds_read_b64_tr_b16 a[140:141], v23 offset:16384
v_accvgpr_read_b32 v73, a233
v_mfma_f32_16x16x32_bf16 v[52:55], a[132:135], a[20:23], v[52:55]
buffer_load_dwordx4 v17, s[12:15], s27 offen offset:1024 lds
v_mfma_f32_16x16x32_bf16 v[60:63], a[128:131], a[24:27], v[60:63]
ds_read_b64_tr_b16 a[142:143], v23 offset:18432
v_add_u32 v23, 32768, v23
v_mfma_f32_16x16x32_bf16 v[60:63], a[132:135], a[28:31], v[60:63]
buffer_store_dwordx4 v[160:163], v1, s[4:7], s31 offen sc1
v_mfma_f32_16x16x32_bf16 v[68:71], a[128:131], a[32:35], v[68:71]
s_add_u32 s31, s31, s32
ds_read_b128 a[72:75], v2 offset:51200
v_accvgpr_read_b32 v74, a234
v_mfma_f32_16x16x32_bf16 v[68:71], a[132:135], a[36:39], v[68:71]
buffer_load_dwordx4 v18, s[12:15], s27 offen offset:2048 lds
v_mfma_f32_16x16x32_bf16 v[76:79], a[128:131], a[40:43], v[76:79]
ds_read_b128 a[76:79], v3 offset:51200
v_accvgpr_read_b32 v75, a235
v_mfma_f32_16x16x32_bf16 v[76:79], a[132:135], a[44:47], v[76:79]
ds_read_b128 a[80:83], v2 offset:53248
v_accvgpr_read_b32 v96, a236
v_mfma_f32_16x16x32_bf16 v[84:87], a[128:131], a[48:51], v[84:87]
ds_read_b128 a[84:87], v3 offset:53248
v_accvgpr_read_b32 v97, a237
v_mfma_f32_16x16x32_bf16 v[84:87], a[132:135], a[52:55], v[84:87]
buffer_load_dwordx4 v19, s[12:15], s27 offen offset:3072 lds
v_mfma_f32_16x16x32_bf16 v[92:95], a[128:131], a[56:59], v[92:95]
s_add_u32 s27, s27, 524288
ds_read_b128 a[88:91], v2 offset:55296
v_accvgpr_read_b32 v98, a238
v_mfma_f32_16x16x32_bf16 v[92:95], a[132:135], a[60:63], v[92:95]
s_waitcnt lgkmcnt(5)
buffer_store_dwordx4 v[168:171], v1, s[4:7], s31 offen sc1
v_mfma_f32_16x16x32_bf16 v[100:103], a[136:139], a[0:3], v[100:103]
s_add_u32 m0, s28, 32768
ds_read_b64_tr_b16 a[128:129], v24 offset:0
v_accvgpr_read_b32 v99, a239
v_mfma_f32_16x16x32_bf16 v[100:103], a[140:143], a[4:7], v[100:103]
s_add_u32 s31, s31, s33
buffer_load_dwordx4 v12, s[8:11], s24 offen offset:0 lds
v_mfma_f32_16x16x32_bf16 v[108:111], a[136:139], a[8:11], v[108:111]
ds_read_b64_tr_b16 a[130:131], v24 offset:2048
v_cvt_pk_bf16_f32 v72, v72, v73
v_mfma_f32_16x16x32_bf16 v[108:111], a[140:143], a[12:15], v[108:111]
ds_read_b128 a[92:95], v3 offset:55296
v_cvt_pk_bf16_f32 v73, v74, v75
v_mfma_f32_16x16x32_bf16 v[116:119], a[136:139], a[16:19], v[116:119]
ds_read_b64_tr_b16 a[132:133], v24 offset:16384
v_cvt_pk_bf16_f32 v74, v96, v97
v_mfma_f32_16x16x32_bf16 v[116:119], a[140:143], a[20:23], v[116:119]
buffer_load_dwordx4 v13, s[8:11], s24 offen offset:1024 lds
v_mfma_f32_16x16x32_bf16 v[124:127], a[136:139], a[24:27], v[124:127]
ds_read_b64_tr_b16 a[134:135], v24 offset:18432
v_add_u32 v24, 32768, v24
v_mfma_f32_16x16x32_bf16 v[124:127], a[140:143], a[28:31], v[124:127]
v_cvt_pk_bf16_f32 v75, v98, v99
v_accvgpr_read_b32 v80, a240
v_mfma_f32_16x16x32_bf16 v[132:135], a[136:139], a[32:35], v[132:135]
ds_read_b128 a[96:99], v2 offset:57344
v_accvgpr_read_b32 v81, a241
v_mfma_f32_16x16x32_bf16 v[132:135], a[140:143], a[36:39], v[132:135]
buffer_load_dwordx4 v14, s[8:11], s24 offen offset:2048 lds
v_mfma_f32_16x16x32_bf16 v[140:143], a[136:139], a[40:43], v[140:143]
ds_read_b128 a[100:103], v3 offset:57344
v_accvgpr_read_b32 v82, a242
v_mfma_f32_16x16x32_bf16 v[140:143], a[140:143], a[44:47], v[140:143]
ds_read_b128 a[104:107], v2 offset:59392
v_accvgpr_read_b32 v83, a243
v_mfma_f32_16x16x32_bf16 v[148:151], a[136:139], a[48:51], v[148:151]
ds_read_b128 a[108:111], v3 offset:59392
v_accvgpr_read_b32 v96, a244
v_mfma_f32_16x16x32_bf16 v[148:151], a[140:143], a[52:55], v[148:151]
buffer_load_dwordx4 v15, s[8:11], s24 offen offset:3072 lds
v_mfma_f32_16x16x32_bf16 v[156:159], a[136:139], a[56:59], v[156:159]
s_add_u32 s24, s24, 128
ds_read_b128 a[112:115], v2 offset:61440
v_accvgpr_read_b32 v97, a245
v_mfma_f32_16x16x32_bf16 v[156:159], a[140:143], a[60:63], v[156:159]
s_waitcnt lgkmcnt(5)
buffer_store_dwordx4 v[176:179], v1, s[4:7], s31 offen sc1
v_mfma_f32_16x16x32_bf16 v[164:167], a[128:131], a[0:3], v[164:167]
s_add_u32 s31, s31, s32
ds_read_b64_tr_b16 a[136:137], v25 offset:0
v_accvgpr_read_b32 v98, a246
v_mfma_f32_16x16x32_bf16 v[164:167], a[132:135], a[4:7], v[164:167]
v_accvgpr_read_b32 v99, a247
v_cvt_pk_bf16_f32 v80, v80, v81
v_mfma_f32_16x16x32_bf16 v[172:175], a[128:131], a[8:11], v[172:175]
ds_read_b64_tr_b16 a[138:139], v25 offset:2048
v_cvt_pk_bf16_f32 v81, v82, v83
v_mfma_f32_16x16x32_bf16 v[172:175], a[132:135], a[12:15], v[172:175]
ds_read_b128 a[116:119], v3 offset:61440
v_cvt_pk_bf16_f32 v82, v96, v97
v_mfma_f32_16x16x32_bf16 v[180:183], a[128:131], a[16:19], v[180:183]
ds_read_b64_tr_b16 a[140:141], v25 offset:16384
v_cvt_pk_bf16_f32 v83, v98, v99
v_mfma_f32_16x16x32_bf16 v[180:183], a[132:135], a[20:23], v[180:183]
buffer_store_dwordx4 v[184:187], v1, s[4:7], s31 offen sc1
v_mfma_f32_16x16x32_bf16 v[188:191], a[128:131], a[24:27], v[188:191]
s_add_u32 s31, s31, s34
ds_read_b64_tr_b16 a[142:143], v25 offset:18432
v_add_u32 v25, 32768, v25
v_mfma_f32_16x16x32_bf16 v[188:191], a[132:135], a[28:31], v[188:191]
v_accvgpr_read_b32 v88, a248
v_accvgpr_read_b32 v89, a249
v_mfma_f32_16x16x32_bf16 v[196:199], a[128:131], a[32:35], v[196:199]
ds_read_b128 a[120:123], v2 offset:63488
v_accvgpr_read_b32 v90, a250
v_mfma_f32_16x16x32_bf16 v[196:199], a[132:135], a[36:39], v[196:199]
v_accvgpr_read_b32 v91, a251
v_accvgpr_read_b32 v96, a252
v_mfma_f32_16x16x32_bf16 v[204:207], a[128:131], a[40:43], v[204:207]
ds_read_b128 a[124:127], v3 offset:63488
v_accvgpr_read_b32 v97, a253
v_mfma_f32_16x16x32_bf16 v[204:207], a[132:135], a[44:47], v[204:207]
v_accvgpr_read_b32 v98, a254
v_accvgpr_read_b32 v99, a255
v_mfma_f32_16x16x32_bf16 v[212:215], a[128:131], a[48:51], v[212:215]
v_cvt_pk_bf16_f32 v88, v88, v89
v_cvt_pk_bf16_f32 v89, v90, v91
v_mfma_f32_16x16x32_bf16 v[212:215], a[132:135], a[52:55], v[212:215]
v_cvt_pk_bf16_f32 v90, v96, v97
v_cvt_pk_bf16_f32 v91, v98, v99
v_mfma_f32_16x16x32_bf16 v[220:223], a[128:131], a[56:59], v[220:223]
v_mfma_f32_16x16x32_bf16 v[220:223], a[132:135], a[60:63], v[220:223]
s_waitcnt vmcnt(23) lgkmcnt(0)
s_barrier
v_mfma_f32_16x16x32_bf16 v[224:227], a[136:139], a[0:3], v[224:227]
s_add_u32 m0, s29, 98304
ds_read_b64_tr_b16 a[128:129], v22 offset:0
v_mfma_f32_16x16x32_bf16 v[224:227], a[140:143], a[4:7], v[224:227]
buffer_load_dwordx4 v16, s[12:15], s26 offen offset:0 lds
v_mfma_f32_16x16x32_bf16 v[228:231], a[136:139], a[8:11], v[228:231]
ds_read_b64_tr_b16 a[130:131], v22 offset:2048
v_mfma_f32_16x16x32_bf16 v[228:231], a[140:143], a[12:15], v[228:231]
buffer_store_dwordx4 v[192:195], v1, s[4:7], s31 offen sc1
v_mfma_f32_16x16x32_bf16 v[232:235], a[136:139], a[16:19], v[232:235]
s_add_u32 s31, s31, s32
ds_read_b64_tr_b16 a[132:133], v22 offset:16384
v_mfma_f32_16x16x32_bf16 v[232:235], a[140:143], a[20:23], v[232:235]
buffer_load_dwordx4 v17, s[12:15], s26 offen offset:1024 lds
v_mfma_f32_16x16x32_bf16 v[236:239], a[136:139], a[24:27], v[236:239]
ds_read_b64_tr_b16 a[134:135], v22 offset:18432
v_add_u32 v22, 4294901760, v22
v_mfma_f32_16x16x32_bf16 v[236:239], a[140:143], a[28:31], v[236:239]
v_mfma_f32_16x16x32_bf16 v[240:243], a[136:139], a[32:35], v[240:243]
v_mfma_f32_16x16x32_bf16 v[240:243], a[140:143], a[36:39], v[240:243]
buffer_load_dwordx4 v18, s[12:15], s26 offen offset:2048 lds
v_mfma_f32_16x16x32_bf16 v[244:247], a[136:139], a[40:43], v[244:247]
v_mfma_f32_16x16x32_bf16 v[244:247], a[140:143], a[44:47], v[244:247]
v_mfma_f32_16x16x32_bf16 v[248:251], a[136:139], a[48:51], v[248:251]
v_mfma_f32_16x16x32_bf16 v[248:251], a[140:143], a[52:55], v[248:251]
buffer_load_dwordx4 v19, s[12:15], s26 offen offset:3072 lds
v_mfma_f32_16x16x32_bf16 v[252:255], a[136:139], a[56:59], v[252:255]
s_add_u32 s26, s26, 524288
v_mfma_f32_16x16x32_bf16 v[252:255], a[140:143], a[60:63], v[252:255]
s_waitcnt lgkmcnt(0)
v_mfma_f32_16x16x32_bf16 v[36:39], a[128:131], a[64:67], v[36:39]
s_add_u32 m0, s29, 114688
ds_read_b64_tr_b16 a[136:137], v23 offset:0
v_mfma_f32_16x16x32_bf16 v[36:39], a[132:135], a[68:71], v[36:39]
buffer_load_dwordx4 v16, s[12:15], s27 offen offset:0 lds
v_mfma_f32_16x16x32_bf16 v[44:47], a[128:131], a[72:75], v[44:47]
ds_read_b64_tr_b16 a[138:139], v23 offset:2048
v_mfma_f32_16x16x32_bf16 v[44:47], a[132:135], a[76:79], v[44:47]
ds_read_b128 a[0:3], v2 offset:0
ds_read_b128 a[4:7], v3 offset:0
v_mfma_f32_16x16x32_bf16 v[52:55], a[128:131], a[80:83], v[52:55]
ds_read_b64_tr_b16 a[140:141], v23 offset:16384
v_mfma_f32_16x16x32_bf16 v[52:55], a[132:135], a[84:87], v[52:55]
buffer_load_dwordx4 v17, s[12:15], s27 offen offset:1024 lds
v_mfma_f32_16x16x32_bf16 v[60:63], a[128:131], a[88:91], v[60:63]
ds_read_b64_tr_b16 a[142:143], v23 offset:18432
v_add_u32 v23, 4294901760, v23
v_mfma_f32_16x16x32_bf16 v[60:63], a[132:135], a[92:95], v[60:63]
buffer_store_dwordx4 v[200:203], v1, s[4:7], s31 offen sc1
v_mfma_f32_16x16x32_bf16 v[68:71], a[128:131], a[96:99], v[68:71]
s_add_u32 s31, s31, s33
ds_read_b128 a[8:11], v2 offset:2048
v_mfma_f32_16x16x32_bf16 v[68:71], a[132:135], a[100:103], v[68:71]
buffer_load_dwordx4 v18, s[12:15], s27 offen offset:2048 lds
v_mfma_f32_16x16x32_bf16 v[76:79], a[128:131], a[104:107], v[76:79]
ds_read_b128 a[12:15], v3 offset:2048
v_mfma_f32_16x16x32_bf16 v[76:79], a[132:135], a[108:111], v[76:79]
ds_read_b128 a[16:19], v2 offset:4096
v_mfma_f32_16x16x32_bf16 v[84:87], a[128:131], a[112:115], v[84:87]
ds_read_b128 a[20:23], v3 offset:4096
v_mfma_f32_16x16x32_bf16 v[84:87], a[132:135], a[116:119], v[84:87]
buffer_load_dwordx4 v19, s[12:15], s27 offen offset:3072 lds
v_mfma_f32_16x16x32_bf16 v[92:95], a[128:131], a[120:123], v[92:95]
s_add_u32 s27, s27, 524288
ds_read_b128 a[24:27], v2 offset:6144
v_mfma_f32_16x16x32_bf16 v[92:95], a[132:135], a[124:127], v[92:95]
s_waitcnt lgkmcnt(5)
buffer_store_dwordx4 v[208:211], v1, s[4:7], s31 offen sc1
v_mfma_f32_16x16x32_bf16 v[100:103], a[136:139], a[64:67], v[100:103]
s_add_u32 s31, s31, s32
ds_read_b64_tr_b16 a[128:129], v24 offset:0
v_mfma_f32_16x16x32_bf16 v[100:103], a[140:143], a[68:71], v[100:103]
v_mfma_f32_16x16x32_bf16 v[108:111], a[136:139], a[72:75], v[108:111]
ds_read_b64_tr_b16 a[130:131], v24 offset:2048
v_mfma_f32_16x16x32_bf16 v[108:111], a[140:143], a[76:79], v[108:111]
ds_read_b128 a[28:31], v3 offset:6144
v_mfma_f32_16x16x32_bf16 v[116:119], a[136:139], a[80:83], v[116:119]
ds_read_b64_tr_b16 a[132:133], v24 offset:16384
v_mfma_f32_16x16x32_bf16 v[116:119], a[140:143], a[84:87], v[116:119]
v_mfma_f32_16x16x32_bf16 v[124:127], a[136:139], a[88:91], v[124:127]
ds_read_b64_tr_b16 a[134:135], v24 offset:18432
v_add_u32 v24, 4294901760, v24
v_mfma_f32_16x16x32_bf16 v[124:127], a[140:143], a[92:95], v[124:127]
v_mfma_f32_16x16x32_bf16 v[132:135], a[136:139], a[96:99], v[132:135]
ds_read_b128 a[32:35], v2 offset:8192
v_mfma_f32_16x16x32_bf16 v[132:135], a[140:143], a[100:103], v[132:135]
buffer_store_dwordx4 v[216:219], v1, s[4:7], s31 offen sc1
v_mfma_f32_16x16x32_bf16 v[140:143], a[136:139], a[104:107], v[140:143]
s_add_u32 s31, s31, s35
ds_read_b128 a[36:39], v3 offset:8192
v_mfma_f32_16x16x32_bf16 v[140:143], a[140:143], a[108:111], v[140:143]
ds_read_b128 a[40:43], v2 offset:10240
v_mfma_f32_16x16x32_bf16 v[148:151], a[136:139], a[112:115], v[148:151]
ds_read_b128 a[44:47], v3 offset:10240
v_mfma_f32_16x16x32_bf16 v[148:151], a[140:143], a[116:119], v[148:151]
v_mfma_f32_16x16x32_bf16 v[156:159], a[136:139], a[120:123], v[156:159]
ds_read_b128 a[48:51], v2 offset:12288
v_mfma_f32_16x16x32_bf16 v[156:159], a[140:143], a[124:127], v[156:159]
s_waitcnt lgkmcnt(5)
v_mfma_f32_16x16x32_bf16 v[164:167], a[128:131], a[64:67], v[164:167]
ds_read_b64_tr_b16 a[136:137], v25 offset:0
v_mfma_f32_16x16x32_bf16 v[164:167], a[132:135], a[68:71], v[164:167]
v_mfma_f32_16x16x32_bf16 v[172:175], a[128:131], a[72:75], v[172:175]
ds_read_b64_tr_b16 a[138:139], v25 offset:2048
v_mfma_f32_16x16x32_bf16 v[172:175], a[132:135], a[76:79], v[172:175]
ds_read_b128 a[52:55], v3 offset:12288
v_mfma_f32_16x16x32_bf16 v[180:183], a[128:131], a[80:83], v[180:183]
ds_read_b64_tr_b16 a[140:141], v25 offset:16384
v_mfma_f32_16x16x32_bf16 v[180:183], a[132:135], a[84:87], v[180:183]
buffer_store_dwordx4 v[32:35], v1, s[4:7], s31 offen sc1
v_mfma_f32_16x16x32_bf16 v[188:191], a[128:131], a[88:91], v[188:191]
s_add_u32 s31, s31, s32
ds_read_b64_tr_b16 a[142:143], v25 offset:18432
v_add_u32 v25, 4294901760, v25
v_mfma_f32_16x16x32_bf16 v[188:191], a[132:135], a[92:95], v[188:191]
v_mfma_f32_16x16x32_bf16 v[196:199], a[128:131], a[96:99], v[196:199]
ds_read_b128 a[56:59], v2 offset:14336
v_mfma_f32_16x16x32_bf16 v[196:199], a[132:135], a[100:103], v[196:199]
v_mfma_f32_16x16x32_bf16 v[204:207], a[128:131], a[104:107], v[204:207]
ds_read_b128 a[60:63], v3 offset:14336
v_mfma_f32_16x16x32_bf16 v[204:207], a[132:135], a[108:111], v[204:207]
v_mfma_f32_16x16x32_bf16 v[212:215], a[128:131], a[112:115], v[212:215]
v_mfma_f32_16x16x32_bf16 v[212:215], a[132:135], a[116:119], v[212:215]
v_mfma_f32_16x16x32_bf16 v[220:223], a[128:131], a[120:123], v[220:223]
v_mfma_f32_16x16x32_bf16 v[220:223], a[132:135], a[124:127], v[220:223]
s_waitcnt vmcnt(20) lgkmcnt(0)
s_barrier
v_mfma_f32_16x16x32_bf16 v[224:227], a[136:139], a[64:67], v[224:227]
s_add_u32 m0, s29, 131072
ds_read_b64_tr_b16 a[128:129], v22 offset:0
v_mfma_f32_16x16x32_bf16 v[224:227], a[140:143], a[68:71], v[224:227]
buffer_load_dwordx4 v16, s[12:15], s26 offen offset:0 lds
v_mfma_f32_16x16x32_bf16 v[228:231], a[136:139], a[72:75], v[228:231]
ds_read_b64_tr_b16 a[130:131], v22 offset:2048
v_mfma_f32_16x16x32_bf16 v[228:231], a[140:143], a[76:79], v[228:231]
buffer_store_dwordx4 v[40:43], v1, s[4:7], s31 offen sc1
v_mfma_f32_16x16x32_bf16 v[232:235], a[136:139], a[80:83], v[232:235]
s_add_u32 s31, s31, s33
ds_read_b64_tr_b16 a[132:133], v22 offset:16384
v_mfma_f32_16x16x32_bf16 v[232:235], a[140:143], a[84:87], v[232:235]
buffer_load_dwordx4 v17, s[12:15], s26 offen offset:1024 lds
v_mfma_f32_16x16x32_bf16 v[236:239], a[136:139], a[88:91], v[236:239]
ds_read_b64_tr_b16 a[134:135], v22 offset:18432
v_add_u32 v22, 32768, v22
v_mfma_f32_16x16x32_bf16 v[236:239], a[140:143], a[92:95], v[236:239]
v_mfma_f32_16x16x32_bf16 v[240:243], a[136:139], a[96:99], v[240:243]
v_mfma_f32_16x16x32_bf16 v[240:243], a[140:143], a[100:103], v[240:243]
buffer_load_dwordx4 v18, s[12:15], s26 offen offset:2048 lds
v_mfma_f32_16x16x32_bf16 v[244:247], a[136:139], a[104:107], v[244:247]
v_mfma_f32_16x16x32_bf16 v[244:247], a[140:143], a[108:111], v[244:247]
v_mfma_f32_16x16x32_bf16 v[248:251], a[136:139], a[112:115], v[248:251]
v_mfma_f32_16x16x32_bf16 v[248:251], a[140:143], a[116:119], v[248:251]
buffer_load_dwordx4 v19, s[12:15], s26 offen offset:3072 lds
v_mfma_f32_16x16x32_bf16 v[252:255], a[136:139], a[120:123], v[252:255]
s_add_u32 s26, s26, 524288
v_mfma_f32_16x16x32_bf16 v[252:255], a[140:143], a[124:127], v[252:255]
s_waitcnt lgkmcnt(0)
v_mfma_f32_16x16x32_bf16 v[36:39], a[128:131], a[0:3], v[36:39]
s_add_u32 m0, s29, 147456
ds_read_b64_tr_b16 a[136:137], v23 offset:0
v_mfma_f32_16x16x32_bf16 v[36:39], a[132:135], a[4:7], v[36:39]
buffer_load_dwordx4 v16, s[12:15], s27 offen offset:0 lds
v_mfma_f32_16x16x32_bf16 v[44:47], a[128:131], a[8:11], v[44:47]
s_lshl_b32 s22, s20, 7
ds_read_b64_tr_b16 a[138:139], v23 offset:2048
v_bfe_u32 v20, v1, 4, 3
v_mfma_f32_16x16x32_bf16 v[44:47], a[132:135], a[12:15], v[44:47]
s_add_u32 s70, s22, 94371840
ds_read_b128 a[64:67], v2 offset:16384
ds_read_b128 a[68:71], v3 offset:16384
v_mfma_f32_16x16x32_bf16 v[52:55], a[128:131], a[16:19], v[52:55]
s_lshr_b32 s22, s2, 4
ds_read_b64_tr_b16 a[140:141], v23 offset:16384
v_lshlrev_b32 v20, 3, v20
v_mfma_f32_16x16x32_bf16 v[52:55], a[132:135], a[20:23], v[52:55]
s_lshl_b32 s22, s22, 2
buffer_load_dwordx4 v17, s[12:15], s27 offen offset:1024 lds
v_mfma_f32_16x16x32_bf16 v[60:63], a[128:131], a[24:27], v[60:63]
s_add_u32 s66, s70, s22
ds_read_b64_tr_b16 a[142:143], v23 offset:18432
v_add_u32 v23, 32768, v23
v_mfma_f32_16x16x32_bf16 v[60:63], a[132:135], a[28:31], v[60:63]
s_and_b32 s22, s2, 16
buffer_store_dwordx4 v[48:51], v1, s[4:7], s31 offen sc1
v_mfma_f32_16x16x32_bf16 v[68:71], a[128:131], a[32:35], v[68:71]
s_add_u32 s31, s31, s32
ds_read_b128 a[72:75], v2 offset:18432
v_add_u32 v15, 2052, v20
v_mfma_f32_16x16x32_bf16 v[68:71], a[132:135], a[36:39], v[68:71]
s_lshl_b32 s22, s22, 7
buffer_load_dwordx4 v18, s[12:15], s27 offen offset:2048 lds
v_mfma_f32_16x16x32_bf16 v[76:79], a[128:131], a[40:43], v[76:79]
s_add_u32 s66, s66, s22
ds_read_b128 a[76:79], v3 offset:18432
v_mfma_f32_16x16x32_bf16 v[76:79], a[132:135], a[44:47], v[76:79]
s_lshl_b32 s67, s20, 20
ds_read_b128 a[80:83], v2 offset:20480
v_mfma_f32_16x16x32_bf16 v[84:87], a[128:131], a[48:51], v[84:87]
s_lshl_b32 s22, s37, 16
ds_read_b128 a[84:87], v3 offset:20480
v_mfma_f32_16x16x32_bf16 v[84:87], a[132:135], a[52:55], v[84:87]
s_add_u32 s67, s67, s22
buffer_load_dwordx4 v19, s[12:15], s27 offen offset:3072 lds
v_mfma_f32_16x16x32_bf16 v[92:95], a[128:131], a[56:59], v[92:95]
s_waitcnt lgkmcnt(5)
s_add_u32 s27, s27, 524288
ds_read_b128 a[88:91], v2 offset:22528
v_mfma_f32_16x16x32_bf16 v[92:95], a[132:135], a[60:63], v[92:95]
s_lshl_b32 s22, s3, 11
buffer_store_dwordx4 v[56:59], v1, s[4:7], s31 offen sc1
v_mfma_f32_16x16x32_bf16 v[100:103], a[136:139], a[0:3], v[100:103]
s_waitcnt lgkmcnt(5)
s_add_u32 s31, s31, s34
ds_read_b64_tr_b16 a[128:129], v24 offset:0
v_mfma_f32_16x16x32_bf16 v[100:103], a[140:143], a[4:7], v[100:103]
s_add_u32 s67, s67, s22
v_mfma_f32_16x16x32_bf16 v[108:111], a[136:139], a[8:11], v[108:111]
s_add_u32 s67, s67, 33554432
ds_read_b64_tr_b16 a[130:131], v24 offset:2048
v_mfma_f32_16x16x32_bf16 v[108:111], a[140:143], a[12:15], v[108:111]
s_mov_b32 s68, 1035512379
ds_read_b128 a[92:95], v3 offset:22528
v_mfma_f32_16x16x32_bf16 v[116:119], a[136:139], a[16:19], v[116:119]
s_mov_b32 s69, 1035512379
ds_read_b64_tr_b16 a[132:133], v24 offset:16384
v_mfma_f32_16x16x32_bf16 v[116:119], a[140:143], a[20:23], v[116:119]
buffer_store_dwordx4 v[64:67], v1, s[4:7], s31 offen sc1
v_mfma_f32_16x16x32_bf16 v[124:127], a[136:139], a[24:27], v[124:127]
s_add_u32 s31, s31, s32
ds_read_b64_tr_b16 a[134:135], v24 offset:18432
v_add_u32 v24, 32768, v24
v_mfma_f32_16x16x32_bf16 v[124:127], a[140:143], a[28:31], v[124:127]
v_mfma_f32_16x16x32_bf16 v[132:135], a[136:139], a[32:35], v[132:135]
ds_read_b128 a[96:99], v2 offset:24576
v_mfma_f32_16x16x32_bf16 v[132:135], a[140:143], a[36:39], v[132:135]
v_mfma_f32_16x16x32_bf16 v[140:143], a[136:139], a[40:43], v[140:143]
ds_read_b128 a[100:103], v3 offset:24576
v_mfma_f32_16x16x32_bf16 v[140:143], a[140:143], a[44:47], v[140:143]
ds_read_b128 a[104:107], v2 offset:26624
v_mfma_f32_16x16x32_bf16 v[148:151], a[136:139], a[48:51], v[148:151]
ds_read_b128 a[108:111], v3 offset:26624
v_mfma_f32_16x16x32_bf16 v[148:151], a[140:143], a[52:55], v[148:151]
v_mfma_f32_16x16x32_bf16 v[156:159], a[136:139], a[56:59], v[156:159]
ds_read_b128 a[112:115], v2 offset:28672
v_mfma_f32_16x16x32_bf16 v[156:159], a[140:143], a[60:63], v[156:159]
s_waitcnt lgkmcnt(5)
buffer_store_dwordx4 v[72:75], v1, s[4:7], s31 offen sc1
v_mfma_f32_16x16x32_bf16 v[164:167], a[128:131], a[0:3], v[164:167]
s_add_u32 s31, s31, s33
ds_read_b64_tr_b16 a[136:137], v25 offset:0
v_mfma_f32_16x16x32_bf16 v[164:167], a[132:135], a[4:7], v[164:167]
v_mfma_f32_16x16x32_bf16 v[172:175], a[128:131], a[8:11], v[172:175]
ds_read_b64_tr_b16 a[138:139], v25 offset:2048
v_mfma_f32_16x16x32_bf16 v[172:175], a[132:135], a[12:15], v[172:175]
ds_read_b128 a[116:119], v3 offset:28672
v_mfma_f32_16x16x32_bf16 v[180:183], a[128:131], a[16:19], v[180:183]
ds_read_b64_tr_b16 a[140:141], v25 offset:16384
v_mfma_f32_16x16x32_bf16 v[180:183], a[132:135], a[20:23], v[180:183]
v_mfma_f32_16x16x32_bf16 v[188:191], a[128:131], a[24:27], v[188:191]
ds_read_b64_tr_b16 a[142:143], v25 offset:18432
v_add_u32 v25, 32768, v25
v_mfma_f32_16x16x32_bf16 v[188:191], a[132:135], a[28:31], v[188:191]
v_mfma_f32_16x16x32_bf16 v[196:199], a[128:131], a[32:35], v[196:199]
ds_read_b128 a[120:123], v2 offset:30720
v_mfma_f32_16x16x32_bf16 v[196:199], a[132:135], a[36:39], v[196:199]
buffer_store_dwordx4 v[80:83], v1, s[4:7], s31 offen sc1
v_mfma_f32_16x16x32_bf16 v[204:207], a[128:131], a[40:43], v[204:207]
s_add_u32 s31, s31, s32
ds_read_b128 a[124:127], v3 offset:30720
v_mfma_f32_16x16x32_bf16 v[204:207], a[132:135], a[44:47], v[204:207]
v_mfma_f32_16x16x32_bf16 v[212:215], a[128:131], a[48:51], v[212:215]
v_mfma_f32_16x16x32_bf16 v[212:215], a[132:135], a[52:55], v[212:215]
v_mfma_f32_16x16x32_bf16 v[220:223], a[128:131], a[56:59], v[220:223]
v_mfma_f32_16x16x32_bf16 v[220:223], a[132:135], a[60:63], v[220:223]
s_waitcnt vmcnt(17) lgkmcnt(0)
s_barrier
v_mfma_f32_16x16x32_bf16 v[224:227], a[136:139], a[0:3], v[224:227]
ds_read_b64_tr_b16 a[128:129], v22 offset:0
v_mfma_f32_16x16x32_bf16 v[224:227], a[140:143], a[4:7], v[224:227]
v_mfma_f32_16x16x32_bf16 v[228:231], a[136:139], a[8:11], v[228:231]
ds_read_b64_tr_b16 a[130:131], v22 offset:2048
v_mfma_f32_16x16x32_bf16 v[228:231], a[140:143], a[12:15], v[228:231]
buffer_store_dwordx4 v[88:91], v1, s[4:7], s31 offen sc1
v_mfma_f32_16x16x32_bf16 v[232:235], a[136:139], a[16:19], v[232:235]
ds_read_b64_tr_b16 a[132:133], v22 offset:16384
v_mfma_f32_16x16x32_bf16 v[232:235], a[140:143], a[20:23], v[232:235]
v_mfma_f32_16x16x32_bf16 v[236:239], a[136:139], a[24:27], v[236:239]
ds_read_b64_tr_b16 a[134:135], v22 offset:18432
v_add_u32 v22, 32768, v22
v_mfma_f32_16x16x32_bf16 v[236:239], a[140:143], a[28:31], v[236:239]
v_mfma_f32_16x16x32_bf16 v[240:243], a[136:139], a[32:35], v[240:243]
v_mfma_f32_16x16x32_bf16 v[240:243], a[140:143], a[36:39], v[240:243]
v_mfma_f32_16x16x32_bf16 v[244:247], a[136:139], a[40:43], v[244:247]
v_mfma_f32_16x16x32_bf16 v[244:247], a[140:143], a[44:47], v[244:247]
v_mfma_f32_16x16x32_bf16 v[248:251], a[136:139], a[48:51], v[248:251]
v_mfma_f32_16x16x32_bf16 v[248:251], a[140:143], a[52:55], v[248:251]
v_mfma_f32_16x16x32_bf16 v[252:255], a[136:139], a[56:59], v[252:255]
v_mfma_f32_16x16x32_bf16 v[252:255], a[140:143], a[60:63], v[252:255]
s_waitcnt lgkmcnt(0)
v_mfma_f32_16x16x32_bf16 v[36:39], a[128:131], a[64:67], v[36:39]
ds_read_b64_tr_b16 a[136:137], v23 offset:0
v_mfma_f32_16x16x32_bf16 v[36:39], a[132:135], a[68:71], v[36:39]
v_mfma_f32_16x16x32_bf16 v[44:47], a[128:131], a[72:75], v[44:47]
s_mul_i32 s85, s20, 7
ds_read_b64_tr_b16 a[138:139], v23 offset:2048
v_mfma_f32_16x16x32_bf16 v[44:47], a[132:135], a[76:79], v[44:47]
s_add_u32 s85, s85, s21
ds_read_b128 a[0:3], v2 offset:32768
ds_read_b128 a[4:7], v3 offset:32768
v_mfma_f32_16x16x32_bf16 v[52:55], a[128:131], a[80:83], v[52:55]
s_lshl_b32 s85, s85, 2
ds_read_b64_tr_b16 a[140:141], v23 offset:16384
v_mfma_f32_16x16x32_bf16 v[52:55], a[132:135], a[84:87], v[52:55]
s_add_u32 s85, s85, s3
v_mfma_f32_16x16x32_bf16 v[60:63], a[128:131], a[88:91], v[60:63]
s_mul_i32 s82, s85, 4224
ds_read_b64_tr_b16 a[142:143], v23 offset:18432
v_add_u32 v23, 32768, v23
v_mfma_f32_16x16x32_bf16 v[60:63], a[132:135], a[92:95], v[60:63]
s_add_u32 s82, s82, 83886208
v_mfma_f32_16x16x32_bf16 v[68:71], a[128:131], a[96:99], v[68:71]
s_lshl_b32 s83, s85, 12
ds_read_b128 a[8:11], v2 offset:34816
v_mfma_f32_16x16x32_bf16 v[68:71], a[132:135], a[100:103], v[68:71]
s_mul_i32 s84, s3, 21248
v_mfma_f32_16x16x32_bf16 v[76:79], a[128:131], a[104:107], v[76:79]
s_add_u32 s84, s84, 46080
ds_read_b128 a[12:15], v3 offset:34816
v_mfma_f32_16x16x32_bf16 v[76:79], a[132:135], a[108:111], v[76:79]
s_mov_b64 s[60:61], s[72:73]
ds_read_b128 a[16:19], v2 offset:36864
v_mfma_f32_16x16x32_bf16 v[84:87], a[128:131], a[112:115], v[84:87]
s_mov_b32 s62, 1835008
ds_read_b128 a[20:23], v3 offset:36864
v_mfma_f32_16x16x32_bf16 v[84:87], a[132:135], a[116:119], v[84:87]
v_mfma_f32_16x16x32_bf16 v[92:95], a[128:131], a[120:123], v[92:95]
ds_read_b128 a[24:27], v2 offset:38912
v_mfma_f32_16x16x32_bf16 v[92:95], a[132:135], a[124:127], v[92:95]
s_waitcnt lgkmcnt(5)
v_mfma_f32_16x16x32_bf16 v[100:103], a[136:139], a[64:67], v[100:103]
ds_read_b64_tr_b16 a[128:129], v24 offset:0
v_mfma_f32_16x16x32_bf16 v[100:103], a[140:143], a[68:71], v[100:103]
v_mfma_f32_16x16x32_bf16 v[108:111], a[136:139], a[72:75], v[108:111]
ds_read_b64_tr_b16 a[130:131], v24 offset:2048
v_mfma_f32_16x16x32_bf16 v[108:111], a[140:143], a[76:79], v[108:111]
ds_read_b128 a[28:31], v3 offset:38912
v_mfma_f32_16x16x32_bf16 v[116:119], a[136:139], a[80:83], v[116:119]
ds_read_b64_tr_b16 a[132:133], v24 offset:16384
v_mfma_f32_16x16x32_bf16 v[116:119], a[140:143], a[84:87], v[116:119]
v_mfma_f32_16x16x32_bf16 v[124:127], a[136:139], a[88:91], v[124:127]
ds_read_b64_tr_b16 a[134:135], v24 offset:18432
v_add_u32 v24, 32768, v24
v_mfma_f32_16x16x32_bf16 v[124:127], a[140:143], a[92:95], v[124:127]
v_mfma_f32_16x16x32_bf16 v[132:135], a[136:139], a[96:99], v[132:135]
ds_read_b128 a[32:35], v2 offset:40960
v_mfma_f32_16x16x32_bf16 v[132:135], a[140:143], a[100:103], v[132:135]
v_mfma_f32_16x16x32_bf16 v[140:143], a[136:139], a[104:107], v[140:143]
ds_read_b128 a[36:39], v3 offset:40960
v_mfma_f32_16x16x32_bf16 v[140:143], a[140:143], a[108:111], v[140:143]
ds_read_b128 a[40:43], v2 offset:43008
v_mfma_f32_16x16x32_bf16 v[148:151], a[136:139], a[112:115], v[148:151]
ds_read_b128 a[44:47], v3 offset:43008
v_mfma_f32_16x16x32_bf16 v[148:151], a[140:143], a[116:119], v[148:151]
v_mfma_f32_16x16x32_bf16 v[156:159], a[136:139], a[120:123], v[156:159]
ds_read_b128 a[48:51], v2 offset:45056
v_mfma_f32_16x16x32_bf16 v[156:159], a[140:143], a[124:127], v[156:159]
s_waitcnt lgkmcnt(5)
v_mfma_f32_16x16x32_bf16 v[164:167], a[128:131], a[64:67], v[164:167]
ds_read_b64_tr_b16 a[136:137], v25 offset:0
v_mfma_f32_16x16x32_bf16 v[164:167], a[132:135], a[68:71], v[164:167]
v_mfma_f32_16x16x32_bf16 v[172:175], a[128:131], a[72:75], v[172:175]
ds_read_b64_tr_b16 a[138:139], v25 offset:2048
v_mfma_f32_16x16x32_bf16 v[172:175], a[132:135], a[76:79], v[172:175]
ds_read_b128 a[52:55], v3 offset:45056
v_mfma_f32_16x16x32_bf16 v[180:183], a[128:131], a[80:83], v[180:183]
ds_read_b64_tr_b16 a[140:141], v25 offset:16384
v_mfma_f32_16x16x32_bf16 v[180:183], a[132:135], a[84:87], v[180:183]
PAD_29:
s_cbranch_execz M_tret
v_mfma_f32_16x16x32_bf16 v[188:191], a[128:131], a[88:91], v[188:191]
ds_read_b64_tr_b16 a[142:143], v25 offset:18432
v_add_u32 v25, 32768, v25
v_mfma_f32_16x16x32_bf16 v[188:191], a[132:135], a[92:95], v[188:191]
v_mfma_f32_16x16x32_bf16 v[196:199], a[128:131], a[96:99], v[196:199]
ds_read_b128 a[56:59], v2 offset:47104
v_mfma_f32_16x16x32_bf16 v[196:199], a[132:135], a[100:103], v[196:199]
v_mfma_f32_16x16x32_bf16 v[204:207], a[128:131], a[104:107], v[204:207]
ds_read_b128 a[60:63], v3 offset:47104
v_mfma_f32_16x16x32_bf16 v[204:207], a[132:135], a[108:111], v[204:207]
v_mfma_f32_16x16x32_bf16 v[212:215], a[128:131], a[112:115], v[212:215]
v_mfma_f32_16x16x32_bf16 v[212:215], a[132:135], a[116:119], v[212:215]
v_mfma_f32_16x16x32_bf16 v[220:223], a[128:131], a[120:123], v[220:223]
v_mfma_f32_16x16x32_bf16 v[220:223], a[132:135], a[124:127], v[220:223]
s_waitcnt vmcnt(0) lgkmcnt(0)
s_barrier
v_mfma_f32_16x16x32_bf16 v[224:227], a[136:139], a[64:67], v[224:227]
ds_read_b64_tr_b16 a[128:129], v22 offset:0
v_mfma_f32_16x16x32_bf16 v[224:227], a[140:143], a[68:71], v[224:227]
buffer_store_dword v27, v26, s[4:7], s66 offen sc1
v_mfma_f32_16x16x32_bf16 v[228:231], a[136:139], a[72:75], v[228:231]
ds_read_b64_tr_b16 a[130:131], v22 offset:2048
v_mfma_f32_16x16x32_bf16 v[228:231], a[140:143], a[76:79], v[228:231]
v_mfma_f32_16x16x32_bf16 v[232:235], a[136:139], a[80:83], v[232:235]
ds_read_b64_tr_b16 a[132:133], v22 offset:16384
v_mfma_f32_16x16x32_bf16 v[232:235], a[140:143], a[84:87], v[232:235]
v_mfma_f32_16x16x32_bf16 v[236:239], a[136:139], a[88:91], v[236:239]
ds_read_b64_tr_b16 a[134:135], v22 offset:18432
v_mfma_f32_16x16x32_bf16 v[236:239], a[140:143], a[92:95], v[236:239]
v_mfma_f32_16x16x32_bf16 v[240:243], a[136:139], a[96:99], v[240:243]
v_mfma_f32_16x16x32_bf16 v[240:243], a[140:143], a[100:103], v[240:243]
v_mfma_f32_16x16x32_bf16 v[244:247], a[136:139], a[104:107], v[244:247]
v_mfma_f32_16x16x32_bf16 v[244:247], a[140:143], a[108:111], v[244:247]
v_mfma_f32_16x16x32_bf16 v[248:251], a[136:139], a[112:115], v[248:251]
v_mfma_f32_16x16x32_bf16 v[248:251], a[140:143], a[116:119], v[248:251]
v_mfma_f32_16x16x32_bf16 v[252:255], a[136:139], a[120:123], v[252:255]
v_mfma_f32_16x16x32_bf16 v[252:255], a[140:143], a[124:127], v[252:255]
s_waitcnt lgkmcnt(0)
v_mfma_f32_16x16x32_bf16 v[36:39], a[128:131], a[0:3], v[36:39]
s_add_u32 m0, s84, 17152
ds_read_b64_tr_b16 a[136:137], v23 offset:0
v_lshrrev_b32 v9, 4, v1
v_mfma_f32_16x16x32_bf16 v[36:39], a[132:135], a[4:7], v[36:39]
buffer_load_dwordx4 v1, s[60:63], s83 offen offset:0 lds
v_mfma_f32_16x16x32_bf16 v[44:47], a[128:131], a[8:11], v[44:47]
ds_read_b64_tr_b16 a[138:139], v23 offset:2048
v_and_b32 v10, 15, v9
v_mfma_f32_16x16x32_bf16 v[44:47], a[132:135], a[12:15], v[44:47]
buffer_load_dwordx4 v1, s[60:63], s83 offen offset:1024 lds
v_mfma_f32_16x16x32_bf16 v[52:55], a[128:131], a[16:19], v[52:55]
ds_read_b64_tr_b16 a[140:141], v23 offset:16384
v_lshrrev_b32 v11, 4, v9
v_mfma_f32_16x16x32_bf16 v[52:55], a[132:135], a[20:23], v[52:55]
buffer_load_dwordx4 v1, s[60:63], s83 offen offset:2048 lds
v_mfma_f32_16x16x32_bf16 v[60:63], a[128:131], a[24:27], v[60:63]
ds_read_b64_tr_b16 a[142:143], v23 offset:18432
v_lshrrev_b32 v12, 2, v10
v_mfma_f32_16x16x32_bf16 v[60:63], a[132:135], a[28:31], v[60:63]
buffer_load_dwordx4 v1, s[60:63], s83 offen offset:3072 lds
v_mfma_f32_16x16x32_bf16 v[68:71], a[128:131], a[32:35], v[68:71]
s_add_u32 m0, s84, 64
v_mul_u32_u24 v12, 4160, v12
v_and_b32 v13, 3, v9
v_mfma_f32_16x16x32_bf16 v[68:71], a[132:135], a[36:39], v[68:71]
buffer_load_dwordx4 v1, s[4:7], s82 offen offset:0 sc1 lds
v_mfma_f32_16x16x32_bf16 v[76:79], a[128:131], a[40:43], v[76:79]
buffer_load_dwordx4 v1, s[4:7], s82 offen offset:1024 sc1 lds
v_mfma_f32_16x16x32_bf16 v[76:79], a[132:135], a[44:47], v[76:79]
buffer_load_dwordx4 v1, s[4:7], s82 offen offset:2048 sc1 lds
v_mfma_f32_16x16x32_bf16 v[84:87], a[128:131], a[48:51], v[84:87]
buffer_load_dwordx4 v1, s[4:7], s82 offen offset:3072 sc1 lds
v_mfma_f32_16x16x32_bf16 v[84:87], a[132:135], a[52:55], v[84:87]
s_add_u32 s82, s82, 2097152
v_lshl_add_u32 v12, v13, 3, v12
v_lshlrev_b32 v13, 4, v11
v_mfma_f32_16x16x32_bf16 v[92:95], a[128:131], a[56:59], v[92:95]
s_add_u32 m0, s84, 4224
v_sub_u32 v12, v12, v13
v_add_u32 v12, 88, v12
v_mfma_f32_16x16x32_bf16 v[92:95], a[132:135], a[60:63], v[92:95]
s_waitcnt lgkmcnt(0)
buffer_load_dwordx4 v1, s[4:7], s82 offen offset:0 sc1 lds
v_mfma_f32_16x16x32_bf16 v[100:103], a[136:139], a[0:3], v[100:103]
ds_read_b64_tr_b16 a[128:129], v24 offset:0
v_add_u32 v16, s84, v12
v_mfma_f32_16x16x32_bf16 v[100:103], a[140:143], a[4:7], v[100:103]
buffer_load_dwordx4 v1, s[4:7], s82 offen offset:1024 sc1 lds
v_mfma_f32_16x16x32_bf16 v[108:111], a[136:139], a[8:11], v[108:111]
ds_read_b64_tr_b16 a[130:131], v24 offset:2048
v_lshl_add_u32 v12, v10, 5, v13
v_mfma_f32_16x16x32_bf16 v[108:111], a[140:143], a[12:15], v[108:111]
buffer_load_dwordx4 v1, s[4:7], s82 offen offset:2048 sc1 lds
v_mfma_f32_16x16x32_bf16 v[116:119], a[136:139], a[16:19], v[116:119]
ds_read_b64_tr_b16 a[132:133], v24 offset:16384
v_add_u32 v12, 16672, v12
v_mfma_f32_16x16x32_bf16 v[116:119], a[140:143], a[20:23], v[116:119]
buffer_load_dwordx4 v1, s[4:7], s82 offen offset:3072 sc1 lds
v_mfma_f32_16x16x32_bf16 v[124:127], a[136:139], a[24:27], v[124:127]
s_add_u32 s82, s82, 4292870140
ds_read_b64_tr_b16 a[134:135], v24 offset:18432
v_add_u32 v17, s84, v12
v_mfma_f32_16x16x32_bf16 v[124:127], a[140:143], a[28:31], v[124:127]
s_add_u32 m0, s84, 8384
v_lshlrev_b32 v12, 5, v10
v_lshl_add_u32 v8, v11, 3, v12
v_mfma_f32_16x16x32_bf16 v[132:135], a[136:139], a[32:35], v[132:135]
buffer_load_dwordx4 v1, s[4:7], s82 offen offset:0 sc1 lds
v_mfma_f32_16x16x32_bf16 v[132:135], a[140:143], a[36:39], v[132:135]
buffer_load_dwordx4 v1, s[4:7], s82 offen offset:1024 sc1 lds
v_mfma_f32_16x16x32_bf16 v[140:143], a[136:139], a[40:43], v[140:143]
buffer_load_dwordx4 v1, s[4:7], s82 offen offset:2048 sc1 lds
v_mfma_f32_16x16x32_bf16 v[140:143], a[140:143], a[44:47], v[140:143]
buffer_load_dwordx4 v1, s[4:7], s82 offen offset:3072 sc1 lds
v_mfma_f32_16x16x32_bf16 v[148:151], a[136:139], a[48:51], v[148:151]
s_add_u32 s82, s82, 2097152
v_add3_u32 v18, s84, 64, v8
v_mov_b32 v19, 0
v_mfma_f32_16x16x32_bf16 v[148:151], a[140:143], a[52:55], v[148:151]
s_add_u32 m0, s84, 12544
v_mov_b32 v12, 0
v_mov_b32 v13, 0
v_mfma_f32_16x16x32_bf16 v[156:159], a[136:139], a[56:59], v[156:159]
buffer_load_dwordx4 v1, s[4:7], s82 offen offset:0 sc1 lds
v_mfma_f32_16x16x32_bf16 v[156:159], a[140:143], a[60:63], v[156:159]
s_waitcnt lgkmcnt(0)
buffer_load_dwordx4 v1, s[4:7], s82 offen offset:1024 sc1 lds
v_mfma_f32_16x16x32_bf16 v[164:167], a[128:131], a[0:3], v[164:167]
ds_read_b64_tr_b16 a[136:137], v25 offset:0
v_lshl_add_u32 v14, v9, 3, s84
v_mfma_f32_16x16x32_bf16 v[164:167], a[132:135], a[4:7], v[164:167]
buffer_load_dwordx4 v1, s[4:7], s82 offen offset:2048 sc1 lds
v_mfma_f32_16x16x32_bf16 v[172:175], a[128:131], a[8:11], v[172:175]
ds_read_b64_tr_b16 a[138:139], v25 offset:2048
v_mfma_f32_16x16x32_bf16 v[172:175], a[132:135], a[12:15], v[172:175]
buffer_load_dwordx4 v1, s[4:7], s82 offen offset:3072 sc1 lds
v_mfma_f32_16x16x32_bf16 v[180:183], a[128:131], a[16:19], v[180:183]
ds_read_b64_tr_b16 a[140:141], v25 offset:16384
v_mfma_f32_16x16x32_bf16 v[180:183], a[132:135], a[20:23], v[180:183]
ds_write_b64 v14, v[12:13] offset:16640
v_mul_u32_u24 v14, 4160, v11
v_mfma_f32_16x16x32_bf16 v[188:191], a[128:131], a[24:27], v[188:191]
ds_read_b64_tr_b16 a[142:143], v25 offset:18432
v_lshl_add_u32 v14, v10, 2, v14
v_mfma_f32_16x16x32_bf16 v[188:191], a[132:135], a[28:31], v[188:191]
v_add_u32 v14, s84, v14
v_mfma_f32_16x16x32_bf16 v[196:199], a[128:131], a[32:35], v[196:199]
ds_write_b32 v14, v12
v_lshrrev_b32 v30, 6, v0
v_mfma_f32_16x16x32_bf16 v[196:199], a[132:135], a[36:39], v[196:199]
v_lshl_add_u32 v28, v30, 11, v1
v_add_u32 v29, 0x20000, v28
v_mfma_f32_16x16x32_bf16 v[204:207], a[128:131], a[40:43], v[204:207]
v_lshl_add_u32 v30, v30, 13, v1
v_add_u32 v31, 0x20000, v30
v_mfma_f32_16x16x32_bf16 v[204:207], a[132:135], a[44:47], v[204:207]
v_mul_f32 v36, s68, v36
v_mul_f32 v37, s68, v37
v_mfma_f32_16x16x32_bf16 v[212:215], a[128:131], a[48:51], v[212:215]
v_mul_f32 v38, s68, v38
v_mul_f32 v39, s68, v39
v_mfma_f32_16x16x32_bf16 v[212:215], a[132:135], a[52:55], v[212:215]
v_mul_f32 v100, s68, v100
v_mul_f32 v101, s68, v101
v_mfma_f32_16x16x32_bf16 v[220:223], a[128:131], a[56:59], v[220:223]
v_mul_f32 v102, s68, v102
v_mul_f32 v103, s68, v103
v_mfma_f32_16x16x32_bf16 v[220:223], a[132:135], a[60:63], v[220:223]
s_waitcnt lgkmcnt(0)
s_waitcnt lgkmcnt(0)
s_barrier
v_mfma_f32_16x16x32_bf16 v[224:227], a[136:139], a[0:3], v[224:227]
v_cvt_pk_bf16_f32 v36, v36, v37
v_cvt_pk_bf16_f32 v37, v38, v39
v_mfma_f32_16x16x32_bf16 v[224:227], a[140:143], a[4:7], v[224:227]
v_cvt_pk_bf16_f32 v38, v100, v101
v_cvt_pk_bf16_f32 v39, v102, v103
v_mfma_f32_16x16x32_bf16 v[228:231], a[136:139], a[8:11], v[228:231]
v_mul_f32 v44, s68, v44
v_mul_f32 v45, s68, v45
v_mfma_f32_16x16x32_bf16 v[228:231], a[140:143], a[12:15], v[228:231]
v_mul_f32 v46, s68, v46
v_mul_f32 v47, s68, v47
v_mfma_f32_16x16x32_bf16 v[232:235], a[136:139], a[16:19], v[232:235]
v_mul_f32 v108, s68, v108
v_mul_f32 v109, s68, v109
v_mfma_f32_16x16x32_bf16 v[232:235], a[140:143], a[20:23], v[232:235]
v_mul_f32 v110, s68, v110
v_mul_f32 v111, s68, v111
v_mfma_f32_16x16x32_bf16 v[236:239], a[136:139], a[24:27], v[236:239]
v_cvt_pk_bf16_f32 v44, v44, v45
v_cvt_pk_bf16_f32 v45, v46, v47
v_mfma_f32_16x16x32_bf16 v[236:239], a[140:143], a[28:31], v[236:239]
v_cvt_pk_bf16_f32 v46, v108, v109
v_cvt_pk_bf16_f32 v47, v110, v111
v_mfma_f32_16x16x32_bf16 v[240:243], a[136:139], a[32:35], v[240:243]
v_mul_f32 v52, s68, v52
v_mul_f32 v53, s68, v53
v_mfma_f32_16x16x32_bf16 v[240:243], a[140:143], a[36:39], v[240:243]
v_mul_f32 v54, s68, v54
v_mul_f32 v55, s68, v55
v_mfma_f32_16x16x32_bf16 v[244:247], a[136:139], a[40:43], v[244:247]
v_mul_f32 v116, s68, v116
v_mul_f32 v117, s68, v117
v_mfma_f32_16x16x32_bf16 v[244:247], a[140:143], a[44:47], v[244:247]
v_mul_f32 v118, s68, v118
v_mul_f32 v119, s68, v119
v_mfma_f32_16x16x32_bf16 v[248:251], a[136:139], a[48:51], v[248:251]
v_cvt_pk_bf16_f32 v52, v52, v53
v_cvt_pk_bf16_f32 v53, v54, v55
v_mfma_f32_16x16x32_bf16 v[248:251], a[140:143], a[52:55], v[248:251]
v_cvt_pk_bf16_f32 v54, v116, v117
v_cvt_pk_bf16_f32 v55, v118, v119
v_mfma_f32_16x16x32_bf16 v[252:255], a[136:139], a[56:59], v[252:255]
v_mfma_f32_16x16x32_bf16 v[252:255], a[140:143], a[60:63], v[252:255]
s_mov_b64 s[60:61], s[74:75]
s_mov_b32 s62, 896
s_lshl_b32 s79, s85, 1
buffer_load_short_d16_hi v19, off, s[60:63], s79
s_lshl_b32 s83, s85, 12
s_add_u32 s83, s83, 88080384
ds_write_b128 v28, v[36:39] offset:0
ds_write_b128 v28, v[44:47] offset:8192
ds_write_b128 v28, v[52:55] offset:16384
v_pk_mul_f32 v[60:61], v[60:61], s[68:69]
v_pk_mul_f32 v[62:63], v[62:63], s[68:69]
v_pk_mul_f32 v[124:125], v[124:125], s[68:69]
v_pk_mul_f32 v[126:127], v[126:127], s[68:69]
v_cvt_pk_bf16_f32 v60, v60, v61
v_cvt_pk_bf16_f32 v61, v62, v63
v_cvt_pk_bf16_f32 v62, v124, v125
v_cvt_pk_bf16_f32 v63, v126, v127
ds_write_b128 v28, v[60:63] offset:24576
v_pk_mul_f32 v[68:69], v[68:69], s[68:69]
v_pk_mul_f32 v[70:71], v[70:71], s[68:69]
v_pk_mul_f32 v[132:133], v[132:133], s[68:69]
v_pk_mul_f32 v[134:135], v[134:135], s[68:69]
v_cvt_pk_bf16_f32 v68, v68, v69
v_cvt_pk_bf16_f32 v69, v70, v71
v_cvt_pk_bf16_f32 v70, v132, v133
v_cvt_pk_bf16_f32 v71, v134, v135
ds_write_b128 v29, v[68:71] offset:0
v_pk_mul_f32 v[76:77], v[76:77], s[68:69]
v_pk_mul_f32 v[78:79], v[78:79], s[68:69]
v_pk_mul_f32 v[140:141], v[140:141], s[68:69]
v_pk_mul_f32 v[142:143], v[142:143], s[68:69]
v_cvt_pk_bf16_f32 v76, v76, v77
v_cvt_pk_bf16_f32 v77, v78, v79
v_cvt_pk_bf16_f32 v78, v140, v141
v_cvt_pk_bf16_f32 v79, v142, v143
ds_write_b128 v29, v[76:79] offset:8192
v_pk_mul_f32 v[84:85], v[84:85], s[68:69]
v_pk_mul_f32 v[86:87], v[86:87], s[68:69]
v_pk_mul_f32 v[148:149], v[148:149], s[68:69]
v_pk_mul_f32 v[150:151], v[150:151], s[68:69]
v_cvt_pk_bf16_f32 v84, v84, v85
v_cvt_pk_bf16_f32 v85, v86, v87
v_cvt_pk_bf16_f32 v86, v148, v149
v_cvt_pk_bf16_f32 v87, v150, v151
ds_write_b128 v29, v[84:87] offset:16384
v_pk_mul_f32 v[92:93], v[92:93], s[68:69]
v_pk_mul_f32 v[94:95], v[94:95], s[68:69]
v_pk_mul_f32 v[156:157], v[156:157], s[68:69]
v_pk_mul_f32 v[158:159], v[158:159], s[68:69]
v_cvt_pk_bf16_f32 v92, v92, v93
v_cvt_pk_bf16_f32 v93, v94, v95
v_cvt_pk_bf16_f32 v94, v156, v157
v_cvt_pk_bf16_f32 v95, v158, v159
ds_write_b128 v29, v[92:95] offset:24576
v_pk_mul_f32 v[164:165], v[164:165], s[68:69]
v_pk_mul_f32 v[166:167], v[166:167], s[68:69]
v_pk_mul_f32 v[224:225], v[224:225], s[68:69]
v_pk_mul_f32 v[226:227], v[226:227], s[68:69]
v_cvt_pk_bf16_f32 v164, v164, v165
v_cvt_pk_bf16_f32 v165, v166, v167
v_cvt_pk_bf16_f32 v166, v224, v225
v_cvt_pk_bf16_f32 v167, v226, v227
ds_write_b128 v28, v[164:167] offset:1024
v_pk_mul_f32 v[172:173], v[172:173], s[68:69]
v_pk_mul_f32 v[174:175], v[174:175], s[68:69]
v_pk_mul_f32 v[228:229], v[228:229], s[68:69]
v_pk_mul_f32 v[230:231], v[230:231], s[68:69]
v_cvt_pk_bf16_f32 v172, v172, v173
v_cvt_pk_bf16_f32 v173, v174, v175
v_cvt_pk_bf16_f32 v174, v228, v229
v_cvt_pk_bf16_f32 v175, v230, v231
ds_write_b128 v28, v[172:175] offset:9216
v_pk_mul_f32 v[180:181], v[180:181], s[68:69]
v_pk_mul_f32 v[182:183], v[182:183], s[68:69]
v_pk_mul_f32 v[232:233], v[232:233], s[68:69]
v_pk_mul_f32 v[234:235], v[234:235], s[68:69]
v_cvt_pk_bf16_f32 v180, v180, v181
v_cvt_pk_bf16_f32 v181, v182, v183
v_cvt_pk_bf16_f32 v182, v232, v233
v_cvt_pk_bf16_f32 v183, v234, v235
ds_write_b128 v28, v[180:183] offset:17408
v_pk_mul_f32 v[188:189], v[188:189], s[68:69]
v_pk_mul_f32 v[190:191], v[190:191], s[68:69]
v_pk_mul_f32 v[236:237], v[236:237], s[68:69]
v_pk_mul_f32 v[238:239], v[238:239], s[68:69]
v_cvt_pk_bf16_f32 v188, v188, v189
v_cvt_pk_bf16_f32 v189, v190, v191
v_cvt_pk_bf16_f32 v190, v236, v237
v_cvt_pk_bf16_f32 v191, v238, v239
ds_write_b128 v28, v[188:191] offset:25600
v_pk_mul_f32 v[196:197], v[196:197], s[68:69]
v_pk_mul_f32 v[198:199], v[198:199], s[68:69]
v_pk_mul_f32 v[240:241], v[240:241], s[68:69]
v_pk_mul_f32 v[242:243], v[242:243], s[68:69]
v_cvt_pk_bf16_f32 v196, v196, v197
v_cvt_pk_bf16_f32 v197, v198, v199
v_cvt_pk_bf16_f32 v198, v240, v241
v_cvt_pk_bf16_f32 v199, v242, v243
ds_write_b128 v29, v[196:199] offset:1024
v_pk_mul_f32 v[204:205], v[204:205], s[68:69]
v_pk_mul_f32 v[206:207], v[206:207], s[68:69]
v_pk_mul_f32 v[244:245], v[244:245], s[68:69]
v_pk_mul_f32 v[246:247], v[246:247], s[68:69]
v_cvt_pk_bf16_f32 v204, v204, v205
v_cvt_pk_bf16_f32 v205, v206, v207
v_cvt_pk_bf16_f32 v206, v244, v245
v_cvt_pk_bf16_f32 v207, v246, v247
ds_write_b128 v29, v[204:207] offset:9216
v_pk_mul_f32 v[212:213], v[212:213], s[68:69]
v_pk_mul_f32 v[214:215], v[214:215], s[68:69]
v_pk_mul_f32 v[248:249], v[248:249], s[68:69]
v_pk_mul_f32 v[250:251], v[250:251], s[68:69]
v_cvt_pk_bf16_f32 v212, v212, v213
v_cvt_pk_bf16_f32 v213, v214, v215
v_cvt_pk_bf16_f32 v214, v248, v249
v_cvt_pk_bf16_f32 v215, v250, v251
ds_write_b128 v29, v[212:215] offset:17408
v_pk_mul_f32 v[220:221], v[220:221], s[68:69]
v_pk_mul_f32 v[222:223], v[222:223], s[68:69]
v_pk_mul_f32 v[252:253], v[252:253], s[68:69]
v_pk_mul_f32 v[254:255], v[254:255], s[68:69]
v_cvt_pk_bf16_f32 v220, v220, v221
v_cvt_pk_bf16_f32 v221, v222, v223
v_cvt_pk_bf16_f32 v222, v252, v253
v_cvt_pk_bf16_f32 v223, v254, v255
ds_write_b128 v29, v[220:223] offset:25600
s_waitcnt vmcnt(1) lgkmcnt(0)
s_barrier
buffer_load_dword v21, v20, s[4:7], s70 offen sc1
ds_read_b64_tr_b16 a[64:65], v16 offset:8
ds_read_b64_tr_b16 a[66:67], v16 offset:0
ds_read_b128 a[96:99], v17 offset:448
ds_read_b64_tr_b16 a[68:69], v16 offset:520
ds_read_b64_tr_b16 a[70:71], v16 offset:512
ds_read_b128 a[100:103], v17 offset:960
ds_read_b64_tr_b16 a[72:73], v16 offset:1032
ds_read_b64_tr_b16 a[74:75], v16 offset:1024
ds_read_b128 a[104:107], v17 offset:1472
ds_read_b64_tr_b16 a[76:77], v16 offset:1544
ds_read_b64_tr_b16 a[78:79], v16 offset:1536
ds_read_b128 a[108:111], v17 offset:1984
ds_read_b64_tr_b16 a[80:81], v16 offset:2056
ds_read_b64_tr_b16 a[82:83], v16 offset:2048
ds_read_b128 a[112:115], v17 offset:2496
ds_read_b64_tr_b16 a[84:85], v16 offset:2568
ds_read_b64_tr_b16 a[86:87], v16 offset:2560
ds_read_b128 a[116:119], v17 offset:3008
ds_read_b64_tr_b16 a[88:89], v16 offset:3080
ds_read_b64_tr_b16 a[90:91], v16 offset:3072
ds_read_b128 a[120:123], v17 offset:3520
ds_read_b64_tr_b16 a[92:93], v16 offset:3592
ds_read_b64_tr_b16 a[94:95], v16 offset:3584
ds_read_b128 a[124:127], v17 offset:4032
s_waitcnt lgkmcnt(15)
v_mfma_f32_16x16x32_bf16 v[96:99], a[64:67], a[96:99], 0
s_waitcnt lgkmcnt(12)
s_lshl_b32 s18, s3, 13
ds_read_b64_tr_b16 a[128:129], v16 offset:72
v_mov_b32 v24, 0
v_mfma_f32_16x16x32_bf16 v[100:103], a[64:67], a[100:103], 0
s_lshl_b32 s30, s20, 20
ds_read_b64_tr_b16 a[130:131], v16 offset:64
v_lshrrev_b32 v3, 6, v0
v_mfma_f32_16x16x32_bf16 v[100:103], a[68:71], a[96:99], v[100:103]
s_add_u32 s30, s30, s18
ds_read_b128 a[160:163], v17 offset:384
v_and_b32 v4, 63, v0
v_mfma_f32_16x16x32_bf16 v[104:107], a[64:67], a[104:107], 0
s_lshl_b32 s22, s21, 1
ds_read_b128 a[192:195], v30 offset:0
v_add_u32 v2, 0x10000, v1
v_mfma_f32_16x16x32_bf16 v[104:107], a[68:71], a[100:103], v[104:107]
s_lshl_b32 s85, s21, 2
ds_read_b64_tr_b16 a[132:133], v16 offset:584
v_and_b32 v5, 15, v4
v_mfma_f32_16x16x32_bf16 v[104:107], a[72:75], a[96:99], v[104:107]
s_lshr_b32 s85, 2386092, s85
ds_read_b64_tr_b16 a[134:135], v16 offset:576
v_lshrrev_b32 v6, 4, v4
v_mfma_f32_16x16x32_bf16 v[108:111], a[64:67], a[108:111], 0
s_and_b32 s9, s85, 15
ds_read_b128 a[164:167], v17 offset:896
v_lshlrev_b32 v6, 2, v6
v_mfma_f32_16x16x32_bf16 v[108:111], a[68:71], a[104:107], v[108:111]
s_and_b32 s84, s85, 1
ds_read_b128 a[196:199], v30 offset:1024
v_sub_u32 v5, v5, v6
v_mfma_f32_16x16x32_bf16 v[108:111], a[72:75], a[100:103], v[108:111]
s_lshl_b32 s84, s84, 17
ds_read_b64_tr_b16 a[136:137], v16 offset:1096
v_lshl_add_u32 v5, v3, 4, v5
v_mfma_f32_16x16x32_bf16 v[108:111], a[76:79], a[96:99], v[108:111]
s_waitcnt lgkmcnt(8)
s_add_u32 s84, s84, s18
ds_read_b64_tr_b16 a[138:139], v16 offset:1088
v_cmp_gt_i32 s[32:33], 0, v5
v_mfma_f32_16x16x32_bf16 v[112:115], a[64:67], a[112:115], 0
s_xor_b32 s85, s84, 0x20000
ds_read_b128 a[168:171], v17 offset:1408
v_cmp_gt_i32 s[34:35], 1, v5
v_mfma_f32_16x16x32_bf16 v[112:115], a[68:71], a[108:111], v[112:115]
s_sub_u32 s29, 15, s21
ds_read_b128 a[200:203], v30 offset:2048
v_cmp_gt_i32 s[36:37], 2, v5
v_mfma_f32_16x16x32_bf16 v[112:115], a[72:75], a[104:107], v[112:115]
s_mov_b32 s8, s30
ds_read_b64_tr_b16 a[140:141], v16 offset:1608
v_cmp_gt_i32 s[38:39], 3, v5
v_mfma_f32_16x16x32_bf16 v[112:115], a[76:79], a[100:103], v[112:115]
s_add_u32 s11, s22, 2
ds_read_b64_tr_b16 a[142:143], v16 offset:1600
v_cmp_gt_i32 s[40:41], 16, v5
v_mfma_f32_16x16x32_bf16 v[112:115], a[80:83], a[96:99], v[112:115]
s_add_u32 s14, s30, 16777216
ds_read_b128 a[172:175], v17 offset:1920
v_cmp_gt_i32 s[42:43], 17, v5
v_mfma_f32_16x16x32_bf16 v[116:119], a[64:67], a[116:119], 0
s_lshr_b32 s19, s9, 1
ds_read_b128 a[204:207], v30 offset:3072
v_cmp_gt_i32 s[44:45], 18, v5
v_mfma_f32_16x16x32_bf16 v[116:119], a[68:71], a[112:115], v[116:119]
s_cmp_lg_u32 s9, 0
ds_read_b64_tr_b16 a[144:145], v16 offset:2120
v_cmp_gt_i32 s[46:47], 19, v5
v_mfma_f32_16x16x32_bf16 v[116:119], a[72:75], a[108:111], v[116:119]
s_cselect_b32 s10, s30, 3221225472
ds_read_b64_tr_b16 a[146:147], v16 offset:2112
v_cmp_gt_i32 s[48:49], 32, v5
v_mfma_f32_16x16x32_bf16 v[116:119], a[76:79], a[104:107], v[116:119]
s_cselect_b32 s14, s14, 3221225472
ds_read_b128 a[176:179], v17 offset:2432
v_cmp_gt_i32 s[50:51], 33, v5
v_mfma_f32_16x16x32_bf16 v[116:119], a[80:83], a[100:103], v[116:119]
s_cselect_b32 s9, s9, s11
ds_read_b128 a[208:211], v30 offset:4096
v_cmp_gt_i32 s[52:53], 34, v5
v_mfma_f32_16x16x32_bf16 v[116:119], a[84:87], a[96:99], v[116:119]
s_cselect_b32 s19, s19, s21
ds_read_b64_tr_b16 a[148:149], v16 offset:2632
v_cmp_gt_i32 s[54:55], 35, v5
v_mfma_f32_16x16x32_bf16 v[120:123], a[64:67], a[120:123], 0
s_cselect_b32 s29, s29, s21
ds_read_b64_tr_b16 a[150:151], v16 offset:2624
v_cmp_gt_i32 s[56:57], 48, v5
v_mfma_f32_16x16x32_bf16 v[120:123], a[68:71], a[116:119], v[120:123]
s_cselect_b32 s24, 2, 0
ds_read_b128 a[180:183], v17 offset:2944
v_cmp_gt_i32 s[58:59], 49, v5
v_mfma_f32_16x16x32_bf16 v[120:123], a[72:75], a[112:115], v[120:123]
s_add_u32 s12, s8, 16777216
ds_read_b128 a[212:215], v30 offset:5120
v_cmp_gt_i32 s[60:61], 50, v5
v_mfma_f32_16x16x32_bf16 v[120:123], a[76:79], a[108:111], v[120:123]
s_mov_b32 s13, s9
ds_read_b64_tr_b16 a[152:153], v16 offset:3144
v_cmp_gt_i32 s[62:63], 51, v5
v_mfma_f32_16x16x32_bf16 v[120:123], a[80:83], a[104:107], v[120:123]
s_mov_b32 s15, s11
ds_read_b64_tr_b16 a[154:155], v16 offset:3136
v_mov_b32 v7, 0xff800000
v_mfma_f32_16x16x32_bf16 v[120:123], a[84:87], a[100:103], v[120:123]
s_mov_b32 s25, 1266679808
ds_read_b128 a[184:187], v17 offset:3456
v_mov_b32 v6, 1
v_mfma_f32_16x16x32_bf16 v[120:123], a[88:91], a[96:99], v[120:123]
s_lshl_b32 s22, s21, 3
ds_read_b128 a[216:219], v30 offset:6144
v_mov_b32 v5, v26
v_mfma_f32_16x16x32_bf16 v[124:127], a[64:67], a[124:127], 0
s_add_u32 s28, s70, s22
ds_read_b64_tr_b16 a[156:157], v16 offset:3656
v_add_u32 v4, 0x20000, v1
v_mfma_f32_16x16x32_bf16 v[124:127], a[68:71], a[120:123], v[124:127]
s_add_u32 s28, s28, 6148
ds_read_b64_tr_b16 a[158:159], v16 offset:3648
v_mfma_f32_16x16x32_bf16 v[124:127], a[72:75], a[116:119], v[124:127]
s_lshl_b32 s26, s21, 16
ds_read_b128 a[188:191], v17 offset:3968
v_mfma_f32_16x16x32_bf16 v[124:127], a[76:79], a[112:115], v[124:127]
s_add_u32 s26, s26, s30
ds_read_b128 a[220:223], v30 offset:7168
v_mfma_f32_16x16x32_bf16 v[124:127], a[80:83], a[108:111], v[124:127]
s_add_u32 s26, s26, 33554432
ds_read_b128 a[224:227], v31 offset:0
v_mfma_f32_16x16x32_bf16 v[124:127], a[84:87], a[104:107], v[124:127]
s_lshl_b32 s76, s20, 3
ds_read_b128 a[228:231], v31 offset:1024
v_mfma_f32_16x16x32_bf16 v[124:127], a[88:91], a[100:103], v[124:127]
s_add_u32 s76, s76, s21
ds_read_b128 a[232:235], v31 offset:2048
v_mfma_f32_16x16x32_bf16 v[124:127], a[92:95], a[96:99], v[124:127]
s_waitcnt lgkmcnt(8)
s_lshl_b32 s76, s76, 2
ds_read_b128 a[236:239], v31 offset:3072
v_mfma_f32_16x16x32_bf16 v[96:99], a[128:131], a[160:163], v[96:99]
s_add_u32 s76, s76, s3
ds_read_b64_tr_b16 a[64:65], v16 offset:136
v_mfma_f32_16x16x32_bf16 v[100:103], a[128:131], a[164:167], v[100:103]
s_lshl_b32 s27, s76, 10
ds_read_b64_tr_b16 a[66:67], v16 offset:128
v_mfma_f32_16x16x32_bf16 v[100:103], a[132:135], a[160:163], v[100:103]
s_add_u32 s27, s27, 75497472
ds_read_b128 a[96:99], v17 offset:320
v_mfma_f32_16x16x32_bf16 v[104:107], a[128:131], a[168:171], v[104:107]
s_lshl_b32 s76, s76, 14
ds_read_b128 a[240:243], v31 offset:4096
v_mfma_f32_16x16x32_bf16 v[104:107], a[132:135], a[164:167], v[104:107]
s_add_u32 s76, s76, 67108864
ds_read_b64_tr_b16 a[68:69], v16 offset:648
v_mfma_f32_16x16x32_bf16 v[104:107], a[136:139], a[160:163], v[104:107]
s_lshl_b32 s81, s20, 2
ds_read_b64_tr_b16 a[70:71], v16 offset:640
v_mfma_f32_16x16x32_bf16 v[108:111], a[128:131], a[172:175], v[108:111]
s_add_u32 s81, s81, s3
ds_read_b128 a[100:103], v17 offset:832
v_mfma_f32_16x16x32_bf16 v[108:111], a[132:135], a[168:171], v[108:111]
s_mul_i32 s81, s81, 57344
ds_read_b128 a[244:247], v31 offset:5120
v_mfma_f32_16x16x32_bf16 v[108:111], a[136:139], a[164:167], v[108:111]
s_cmp_eq_u32 s24, 1
ds_read_b64_tr_b16 a[72:73], v16 offset:1160
v_mfma_f32_16x16x32_bf16 v[108:111], a[140:143], a[160:163], v[108:111]
s_cselect_b32 s80, s28, s70
ds_read_b64_tr_b16 a[74:75], v16 offset:1152
v_mfma_f32_16x16x32_bf16 v[112:115], a[128:131], a[176:179], v[112:115]
s_add_u32 s77, s76, 8192
ds_read_b128 a[104:107], v17 offset:1344
v_mfma_f32_16x16x32_bf16 v[112:115], a[132:135], a[172:175], v[112:115]
s_lshl_b32 s71, s2, 2
ds_read_b128 a[248:251], v31 offset:6144
v_mfma_f32_16x16x32_bf16 v[112:115], a[136:139], a[168:171], v[112:115]
s_add_u32 s71, s71, 94384128
ds_read_b64_tr_b16 a[76:77], v16 offset:1672
v_mfma_f32_16x16x32_bf16 v[112:115], a[140:143], a[164:167], v[112:115]
s_lshl_b32 s78, s29, 16
ds_read_b64_tr_b16 a[78:79], v16 offset:1664
v_mfma_f32_16x16x32_bf16 v[112:115], a[144:147], a[160:163], v[112:115]
s_add_u32 s78, s78, s30
ds_read_b128 a[108:111], v17 offset:1856
v_mfma_f32_16x16x32_bf16 v[116:119], a[128:131], a[180:183], v[116:119]
s_add_u32 s78, s78, 33554432
ds_read_b128 a[252:255], v31 offset:7168
v_mfma_f32_16x16x32_bf16 v[116:119], a[132:135], a[176:179], v[116:119]
s_cmp_eq_u32 s24, 0
ds_read_b64_tr_b16 a[80:81], v16 offset:2184
v_mfma_f32_16x16x32_bf16 v[116:119], a[136:139], a[172:175], v[116:119]
s_cselect_b32 s78, 3221225472, s78
ds_read_b64_tr_b16 a[82:83], v16 offset:2176
v_mfma_f32_16x16x32_bf16 v[116:119], a[140:143], a[168:171], v[116:119]
s_lshl_b32 s22, s21, 3
ds_read_b128 a[112:115], v17 offset:2368
v_mfma_f32_16x16x32_bf16 v[116:119], a[144:147], a[164:167], v[116:119]
PAD_30:
s_cbranch_execz M_tret
s_add_u32 s22, s22, 16384
v_mfma_f32_16x16x32_bf16 v[116:119], a[148:151], a[160:163], v[116:119]
ds_read_b64_tr_b16 a[84:85], v16 offset:2696
v_writelane_b32 v15, s22, 63
v_mfma_f32_16x16x32_bf16 v[120:123], a[128:131], a[184:187], v[120:123]
ds_read_b64_tr_b16 a[86:87], v16 offset:2688
v_mov_b32 v25, 0
v_mfma_f32_16x16x32_bf16 v[120:123], a[132:135], a[180:183], v[120:123]
s_waitcnt vmcnt(0) lgkmcnt(5)
s_barrier
ds_read_b128 a[116:119], v17 offset:2880
v_cmp_gt_u32 vcc, 1, v21
v_mfma_f32_16x16x32_bf16 v[120:123], a[136:139], a[176:179], v[120:123]
s_cbranch_vccnz M_kspin2
M_kok2:
v_mov_b32 v128, 0
v_mov_b32 v129, 0
v_mfma_f32_16x16x32_bf16 v[120:123], a[140:143], a[172:175], v[120:123]
s_mov_b32 m0, s84
ds_read_b64_tr_b16 a[88:89], v16 offset:3208
v_mov_b32 v130, 0
v_mfma_f32_16x16x32_bf16 v[120:123], a[144:147], a[168:171], v[120:123]
ds_read_b64_tr_b16 a[90:91], v16 offset:3200
v_mov_b32 v131, 0
v_mfma_f32_16x16x32_bf16 v[120:123], a[148:151], a[164:167], v[120:123]
ds_read_b128 a[120:123], v17 offset:3392
v_mov_b32 v132, 0
v_mfma_f32_16x16x32_bf16 v[120:123], a[152:155], a[160:163], v[120:123]
buffer_load_dwordx4 v1, s[4:7], s8 offen offset:0 sc1 lds
v_mfma_f32_16x16x32_bf16 v[124:127], a[128:131], a[188:191], v[124:127]
ds_read_b64_tr_b16 a[92:93], v16 offset:3720
v_mov_b32 v133, 0
v_mfma_f32_16x16x32_bf16 v[124:127], a[132:135], a[184:187], v[124:127]
ds_read_b64_tr_b16 a[94:95], v16 offset:3712
v_mov_b32 v134, 0
v_mfma_f32_16x16x32_bf16 v[124:127], a[136:139], a[180:183], v[124:127]
ds_read_b128 a[124:127], v17 offset:3904
v_mov_b32 v135, 0
v_mfma_f32_16x16x32_bf16 v[124:127], a[140:143], a[176:179], v[124:127]
buffer_load_dwordx4 v1, s[4:7], s8 offen offset:1024 sc1 lds
v_mfma_f32_16x16x32_bf16 v[124:127], a[144:147], a[172:175], v[124:127]
buffer_load_dwordx4 v1, s[4:7], s8 offen offset:2048 sc1 lds
v_mfma_f32_16x16x32_bf16 v[124:127], a[148:151], a[168:171], v[124:127]
buffer_load_dwordx4 v1, s[4:7], s8 offen offset:3072 sc1 lds
v_mfma_f32_16x16x32_bf16 v[124:127], a[152:155], a[164:167], v[124:127]
s_add_u32 s8, s8, 4096
v_mov_b32 v136, 0
v_mov_b32 v137, 0
v_mfma_f32_16x16x32_bf16 v[124:127], a[156:159], a[160:163], v[124:127]
s_add_u32 m0, s84, 4096
v_mov_b32 v138, 0
v_mov_b32 v139, 0
v_mfma_f32_16x16x32_bf16 v[96:99], a[64:67], a[96:99], v[96:99]
ds_read_b64_tr_b16 a[128:129], v16 offset:200
v_mov_b32 v140, 0
v_mfma_f32_16x16x32_bf16 v[100:103], a[64:67], a[100:103], v[100:103]
ds_read_b64_tr_b16 a[130:131], v16 offset:192
v_mov_b32 v141, 0
v_mfma_f32_16x16x32_bf16 v[100:103], a[68:71], a[96:99], v[100:103]
ds_read_b128 a[160:163], v17 offset:256
v_mov_b32 v142, 0
v_mfma_f32_16x16x32_bf16 v[104:107], a[64:67], a[104:107], v[104:107]
buffer_load_dwordx4 v1, s[4:7], s8 offen offset:0 sc1 lds
v_mfma_f32_16x16x32_bf16 v[104:107], a[68:71], a[100:103], v[104:107]
ds_read_b64_tr_b16 a[132:133], v16 offset:712
v_mov_b32 v143, 0
v_mfma_f32_16x16x32_bf16 v[104:107], a[72:75], a[96:99], v[104:107]
ds_read_b64_tr_b16 a[134:135], v16 offset:704
v_mov_b32 v144, 0
v_mfma_f32_16x16x32_bf16 v[108:111], a[64:67], a[108:111], v[108:111]
ds_read_b128 a[164:167], v17 offset:768
v_mov_b32 v145, 0
v_mfma_f32_16x16x32_bf16 v[108:111], a[68:71], a[104:107], v[108:111]
buffer_load_dwordx4 v1, s[4:7], s8 offen offset:1024 sc1 lds
v_mfma_f32_16x16x32_bf16 v[108:111], a[72:75], a[100:103], v[108:111]
ds_read_b64_tr_b16 a[136:137], v16 offset:1224
v_mov_b32 v146, 0
v_mfma_f32_16x16x32_bf16 v[108:111], a[76:79], a[96:99], v[108:111]
s_waitcnt lgkmcnt(6)
ds_read_b64_tr_b16 a[138:139], v16 offset:1216
v_mov_b32 v147, 0
v_mfma_f32_16x16x32_bf16 v[112:115], a[64:67], a[112:115], v[112:115]
ds_read_b128 a[168:171], v17 offset:1280
v_mov_b32 v148, 0
v_mfma_f32_16x16x32_bf16 v[112:115], a[68:71], a[108:111], v[112:115]
buffer_load_dwordx4 v1, s[4:7], s8 offen offset:2048 sc1 lds
v_mfma_f32_16x16x32_bf16 v[112:115], a[72:75], a[104:107], v[112:115]
ds_read_b64_tr_b16 a[140:141], v16 offset:1736
v_mov_b32 v149, 0
v_mfma_f32_16x16x32_bf16 v[112:115], a[76:79], a[100:103], v[112:115]
ds_read_b64_tr_b16 a[142:143], v16 offset:1728
v_mov_b32 v150, 0
v_mfma_f32_16x16x32_bf16 v[112:115], a[80:83], a[96:99], v[112:115]
ds_read_b128 a[172:175], v17 offset:1792
v_mov_b32 v151, 0
v_mfma_f32_16x16x32_bf16 v[116:119], a[64:67], a[116:119], v[116:119]
buffer_load_dwordx4 v1, s[4:7], s8 offen offset:3072 sc1 lds
v_mfma_f32_16x16x32_bf16 v[116:119], a[68:71], a[112:115], v[116:119]
s_add_u32 s8, s8, 28672
ds_read_b64_tr_b16 a[144:145], v16 offset:2248
v_mov_b32 v152, 0
v_mfma_f32_16x16x32_bf16 v[116:119], a[72:75], a[108:111], v[116:119]
s_sub_u32 s9, s9, 1
ds_read_b64_tr_b16 a[146:147], v16 offset:2240
v_mov_b32 v153, 0
v_mfma_f32_16x16x32_bf16 v[116:119], a[76:79], a[104:107], v[116:119]
s_cmp_eq_u32 s9, 0
ds_read_b128 a[176:179], v17 offset:2304
v_mov_b32 v154, 0
v_mfma_f32_16x16x32_bf16 v[116:119], a[80:83], a[100:103], v[116:119]
s_cselect_b32 s8, s10, s8
v_mov_b32 v155, 0
v_mov_b32 v156, 0
v_mfma_f32_16x16x32_bf16 v[116:119], a[84:87], a[96:99], v[116:119]
s_cselect_b32 s9, s11, s9
ds_read_b64_tr_b16 a[148:149], v16 offset:2760
v_mov_b32 v157, 0
v_mfma_f32_16x16x32_bf16 v[120:123], a[64:67], a[120:123], v[120:123]
s_cselect_b32 s10, 3221225472, s10
ds_read_b64_tr_b16 a[150:151], v16 offset:2752
v_mov_b32 v158, 0
v_mfma_f32_16x16x32_bf16 v[120:123], a[68:71], a[116:119], v[120:123]
s_mov_b32 m0, s85
ds_read_b128 a[180:183], v17 offset:2816
v_mov_b32 v159, 0
v_mfma_f32_16x16x32_bf16 v[120:123], a[72:75], a[112:115], v[120:123]
buffer_load_dwordx4 v1, s[4:7], s8 offen offset:0 sc1 lds
v_mfma_f32_16x16x32_bf16 v[120:123], a[76:79], a[108:111], v[120:123]
ds_read_b64_tr_b16 a[152:153], v16 offset:3272
v_mov_b32 v160, 0
v_mfma_f32_16x16x32_bf16 v[120:123], a[80:83], a[104:107], v[120:123]
ds_read_b64_tr_b16 a[154:155], v16 offset:3264
v_mov_b32 v161, 0
v_mfma_f32_16x16x32_bf16 v[120:123], a[84:87], a[100:103], v[120:123]
ds_read_b128 a[184:187], v17 offset:3328
v_mov_b32 v162, 0
v_mfma_f32_16x16x32_bf16 v[120:123], a[88:91], a[96:99], v[120:123]
buffer_load_dwordx4 v1, s[4:7], s8 offen offset:1024 sc1 lds
v_mfma_f32_16x16x32_bf16 v[124:127], a[64:67], a[124:127], v[124:127]
ds_read_b64_tr_b16 a[156:157], v16 offset:3784
v_mov_b32 v163, 0
v_mfma_f32_16x16x32_bf16 v[124:127], a[68:71], a[120:123], v[124:127]
ds_read_b64_tr_b16 a[158:159], v16 offset:3776
v_mov_b32 v164, 0
v_mfma_f32_16x16x32_bf16 v[124:127], a[72:75], a[116:119], v[124:127]
ds_read_b128 a[188:191], v17 offset:3840
v_mov_b32 v165, 0
v_mfma_f32_16x16x32_bf16 v[124:127], a[76:79], a[112:115], v[124:127]
buffer_load_dwordx4 v1, s[4:7], s8 offen offset:2048 sc1 lds
v_mfma_f32_16x16x32_bf16 v[124:127], a[80:83], a[108:111], v[124:127]
buffer_load_dwordx4 v1, s[4:7], s8 offen offset:3072 sc1 lds
v_mfma_f32_16x16x32_bf16 v[124:127], a[84:87], a[104:107], v[124:127]
s_add_u32 s8, s8, 4096
v_mov_b32 v166, 0
v_mov_b32 v167, 0
v_mfma_f32_16x16x32_bf16 v[124:127], a[88:91], a[100:103], v[124:127]
s_add_u32 m0, s85, 4096
v_mov_b32 v168, 0
v_mov_b32 v169, 0
v_mfma_f32_16x16x32_bf16 v[124:127], a[92:95], a[96:99], v[124:127]
s_waitcnt lgkmcnt(3)
buffer_load_dwordx4 v1, s[4:7], s8 offen offset:0 sc1 lds
v_mfma_f32_16x16x32_bf16 v[96:99], a[128:131], a[160:163], v[96:99]
ds_read_b64_tr_b16 a[64:65], v16 offset:264
v_mov_b32 v170, 0
v_mfma_f32_16x16x32_bf16 v[100:103], a[128:131], a[164:167], v[100:103]
ds_read_b64_tr_b16 a[66:67], v16 offset:256
v_mov_b32 v171, 0
v_mfma_f32_16x16x32_bf16 v[100:103], a[132:135], a[160:163], v[100:103]
ds_read_b128 a[96:99], v17 offset:192
v_mov_b32 v172, 0
v_mfma_f32_16x16x32_bf16 v[104:107], a[128:131], a[168:171], v[104:107]
buffer_load_dwordx4 v1, s[4:7], s8 offen offset:1024 sc1 lds
v_mfma_f32_16x16x32_bf16 v[104:107], a[132:135], a[164:167], v[104:107]
ds_read_b64_tr_b16 a[68:69], v16 offset:776
v_mov_b32 v173, 0
v_mfma_f32_16x16x32_bf16 v[104:107], a[136:139], a[160:163], v[104:107]
ds_read_b64_tr_b16 a[70:71], v16 offset:768
v_mov_b32 v174, 0
v_mfma_f32_16x16x32_bf16 v[108:111], a[128:131], a[172:175], v[108:111]
ds_read_b128 a[100:103], v17 offset:704
v_mov_b32 v175, 0
v_mfma_f32_16x16x32_bf16 v[108:111], a[132:135], a[168:171], v[108:111]
buffer_load_dwordx4 v1, s[4:7], s8 offen offset:2048 sc1 lds
v_mfma_f32_16x16x32_bf16 v[108:111], a[136:139], a[164:167], v[108:111]
ds_read_b64_tr_b16 a[72:73], v16 offset:1288
v_mov_b32 v176, 0
v_mfma_f32_16x16x32_bf16 v[108:111], a[140:143], a[160:163], v[108:111]
ds_read_b64_tr_b16 a[74:75], v16 offset:1280
v_mov_b32 v177, 0
v_mfma_f32_16x16x32_bf16 v[112:115], a[128:131], a[176:179], v[112:115]
ds_read_b128 a[104:107], v17 offset:1216
v_mov_b32 v178, 0
v_mfma_f32_16x16x32_bf16 v[112:115], a[132:135], a[172:175], v[112:115]
buffer_load_dwordx4 v1, s[4:7], s8 offen offset:3072 sc1 lds
v_mfma_f32_16x16x32_bf16 v[112:115], a[136:139], a[168:171], v[112:115]
s_add_u32 s8, s8, 28672
ds_read_b64_tr_b16 a[76:77], v16 offset:1800
v_mov_b32 v179, 0
v_mfma_f32_16x16x32_bf16 v[112:115], a[140:143], a[164:167], v[112:115]
s_sub_u32 s9, s9, 1
ds_read_b64_tr_b16 a[78:79], v16 offset:1792
v_mov_b32 v180, 0
v_mfma_f32_16x16x32_bf16 v[112:115], a[144:147], a[160:163], v[112:115]
s_cmp_eq_u32 s9, 0
ds_read_b128 a[108:111], v17 offset:1728
v_mov_b32 v181, 0
v_mfma_f32_16x16x32_bf16 v[116:119], a[128:131], a[180:183], v[116:119]
s_cselect_b32 s8, s10, s8
buffer_load_dword v14, v15, s[4:7], s70 offen sc1
v_mfma_f32_16x16x32_bf16 v[116:119], a[132:135], a[176:179], v[116:119]
s_cselect_b32 s9, s11, s9
ds_read_b64_tr_b16 a[80:81], v16 offset:2312
v_mov_b32 v182, 0
v_mfma_f32_16x16x32_bf16 v[116:119], a[136:139], a[172:175], v[116:119]
s_cselect_b32 s10, 3221225472, s10
ds_read_b64_tr_b16 a[82:83], v16 offset:2304
v_mov_b32 v183, 0
v_mfma_f32_16x16x32_bf16 v[116:119], a[140:143], a[168:171], v[116:119]
ds_read_b128 a[112:115], v17 offset:2240
v_mov_b32 v184, 0
v_mfma_f32_16x16x32_bf16 v[116:119], a[144:147], a[164:167], v[116:119]
v_mov_b32 v185, 0
v_mov_b32 v186, 0
v_mfma_f32_16x16x32_bf16 v[116:119], a[148:151], a[160:163], v[116:119]
ds_read_b64_tr_b16 a[84:85], v16 offset:2824
v_mov_b32 v187, 0
v_mfma_f32_16x16x32_bf16 v[120:123], a[128:131], a[184:187], v[120:123]
ds_read_b64_tr_b16 a[86:87], v16 offset:2816
v_mov_b32 v188, 0
v_mfma_f32_16x16x32_bf16 v[120:123], a[132:135], a[180:183], v[120:123]
ds_read_b128 a[116:119], v17 offset:2752
v_mov_b32 v189, 0
v_mfma_f32_16x16x32_bf16 v[120:123], a[136:139], a[176:179], v[120:123]
v_mov_b32 v190, 0
v_mov_b32 v191, 0
v_mfma_f32_16x16x32_bf16 v[120:123], a[140:143], a[172:175], v[120:123]
ds_read_b64_tr_b16 a[88:89], v16 offset:3336
v_mov_b32 v192, 0
v_mfma_f32_16x16x32_bf16 v[120:123], a[144:147], a[168:171], v[120:123]
ds_read_b64_tr_b16 a[90:91], v16 offset:3328
v_mov_b32 v193, 0
v_mfma_f32_16x16x32_bf16 v[120:123], a[148:151], a[164:167], v[120:123]
ds_read_b128 a[120:123], v17 offset:3264
v_mov_b32 v194, 0
v_mfma_f32_16x16x32_bf16 v[120:123], a[152:155], a[160:163], v[120:123]
s_waitcnt lgkmcnt(6)
v_mov_b32 v195, 0
v_mov_b32 v196, 0
v_mfma_f32_16x16x32_bf16 v[124:127], a[128:131], a[188:191], v[124:127]
ds_read_b64_tr_b16 a[92:93], v16 offset:3848
v_mov_b32 v197, 0
v_mfma_f32_16x16x32_bf16 v[124:127], a[132:135], a[184:187], v[124:127]
ds_read_b64_tr_b16 a[94:95], v16 offset:3840
v_mov_b32 v198, 0
v_mfma_f32_16x16x32_bf16 v[124:127], a[136:139], a[180:183], v[124:127]
ds_read_b128 a[124:127], v17 offset:3776
v_mov_b32 v199, 0
v_mfma_f32_16x16x32_bf16 v[124:127], a[140:143], a[176:179], v[124:127]
v_mov_b32 v200, 0
v_mov_b32 v201, 0
v_mfma_f32_16x16x32_bf16 v[124:127], a[144:147], a[172:175], v[124:127]
v_mov_b32 v202, 0
v_mov_b32 v203, 0
v_mfma_f32_16x16x32_bf16 v[124:127], a[148:151], a[168:171], v[124:127]
v_mov_b32 v204, 0
v_mov_b32 v205, 0
v_mfma_f32_16x16x32_bf16 v[124:127], a[152:155], a[164:167], v[124:127]
v_mov_b32 v206, 0
v_mov_b32 v207, 0
v_mfma_f32_16x16x32_bf16 v[124:127], a[156:159], a[160:163], v[124:127]
v_mov_b32 v208, 0
v_mov_b32 v209, 0
s_waitcnt vmcnt(0)
v_cmp_gt_u32 vcc, 1, v14
s_cbranch_vccnz M_cspin
M_cok:
v_mfma_f32_16x16x32_bf16 v[96:99], a[64:67], a[96:99], v[96:99]
s_add_u32 s22, s78, 0
ds_read_b64_tr_b16 a[128:129], v16 offset:328
v_mov_b32 v210, 0
v_mfma_f32_16x16x32_bf16 v[100:103], a[64:67], a[100:103], v[100:103]
ds_read_b64_tr_b16 a[130:131], v16 offset:320
v_mov_b32 v211, 0
v_mfma_f32_16x16x32_bf16 v[100:103], a[68:71], a[96:99], v[100:103]
ds_read_b128 a[160:163], v17 offset:128
v_mov_b32 v212, 0
v_mfma_f32_16x16x32_bf16 v[104:107], a[64:67], a[104:107], v[104:107]
buffer_load_dwordx4 a[0:3], v1, s[4:7], s22 offen offset:0 sc1
v_mfma_f32_16x16x32_bf16 v[104:107], a[68:71], a[100:103], v[104:107]
ds_read_b64_tr_b16 a[132:133], v16 offset:840
v_mov_b32 v213, 0
v_mfma_f32_16x16x32_bf16 v[104:107], a[72:75], a[96:99], v[104:107]
ds_read_b64_tr_b16 a[134:135], v16 offset:832
v_mov_b32 v214, 0
v_mfma_f32_16x16x32_bf16 v[108:111], a[64:67], a[108:111], v[108:111]
ds_read_b128 a[164:167], v17 offset:640
v_mov_b32 v215, 0
v_mfma_f32_16x16x32_bf16 v[108:111], a[68:71], a[104:107], v[108:111]
buffer_load_dwordx4 a[4:7], v1, s[4:7], s22 offen offset:1024 sc1
v_mfma_f32_16x16x32_bf16 v[108:111], a[72:75], a[100:103], v[108:111]
ds_read_b64_tr_b16 a[136:137], v16 offset:1352
v_mov_b32 v216, 0
v_mfma_f32_16x16x32_bf16 v[108:111], a[76:79], a[96:99], v[108:111]
ds_read_b64_tr_b16 a[138:139], v16 offset:1344
v_mov_b32 v217, 0
v_mfma_f32_16x16x32_bf16 v[112:115], a[64:67], a[112:115], v[112:115]
ds_read_b128 a[168:171], v17 offset:1152
v_mov_b32 v218, 0
v_mfma_f32_16x16x32_bf16 v[112:115], a[68:71], a[108:111], v[112:115]
buffer_load_dwordx4 a[8:11], v1, s[4:7], s22 offen offset:2048 sc1
v_mfma_f32_16x16x32_bf16 v[112:115], a[72:75], a[104:107], v[112:115]
ds_read_b64_tr_b16 a[140:141], v16 offset:1864
v_mov_b32 v219, 0
v_mfma_f32_16x16x32_bf16 v[112:115], a[76:79], a[100:103], v[112:115]
ds_read_b64_tr_b16 a[142:143], v16 offset:1856
v_mov_b32 v220, 0
v_mfma_f32_16x16x32_bf16 v[112:115], a[80:83], a[96:99], v[112:115]
s_waitcnt lgkmcnt(6)
ds_read_b128 a[172:175], v17 offset:1664
v_mov_b32 v221, 0
v_mfma_f32_16x16x32_bf16 v[116:119], a[64:67], a[116:119], v[116:119]
buffer_load_dwordx4 a[12:15], v1, s[4:7], s22 offen offset:3072 sc1
v_mfma_f32_16x16x32_bf16 v[116:119], a[68:71], a[112:115], v[116:119]
s_add_u32 s22, s78, 4096
ds_read_b64_tr_b16 a[144:145], v16 offset:2376
v_mov_b32 v222, 0
v_mfma_f32_16x16x32_bf16 v[116:119], a[72:75], a[108:111], v[116:119]
ds_read_b64_tr_b16 a[146:147], v16 offset:2368
v_mov_b32 v223, 0
v_mfma_f32_16x16x32_bf16 v[116:119], a[76:79], a[104:107], v[116:119]
ds_read_b128 a[176:179], v17 offset:2176
v_mov_b32 v224, 0
v_mfma_f32_16x16x32_bf16 v[116:119], a[80:83], a[100:103], v[116:119]
buffer_load_dwordx4 a[16:19], v1, s[4:7], s22 offen offset:0 sc1
v_mfma_f32_16x16x32_bf16 v[116:119], a[84:87], a[96:99], v[116:119]
ds_read_b64_tr_b16 a[148:149], v16 offset:2888
v_mov_b32 v225, 0
v_mfma_f32_16x16x32_bf16 v[120:123], a[64:67], a[120:123], v[120:123]
ds_read_b64_tr_b16 a[150:151], v16 offset:2880
v_mov_b32 v226, 0
v_mfma_f32_16x16x32_bf16 v[120:123], a[68:71], a[116:119], v[120:123]
ds_read_b128 a[180:183], v17 offset:2688
v_mov_b32 v227, 0
v_mfma_f32_16x16x32_bf16 v[120:123], a[72:75], a[112:115], v[120:123]
buffer_load_dwordx4 a[20:23], v1, s[4:7], s22 offen offset:1024 sc1
v_mfma_f32_16x16x32_bf16 v[120:123], a[76:79], a[108:111], v[120:123]
ds_read_b64_tr_b16 a[152:153], v16 offset:3400
v_mov_b32 v228, 0
v_mfma_f32_16x16x32_bf16 v[120:123], a[80:83], a[104:107], v[120:123]
ds_read_b64_tr_b16 a[154:155], v16 offset:3392
v_mov_b32 v229, 0
v_mfma_f32_16x16x32_bf16 v[120:123], a[84:87], a[100:103], v[120:123]
ds_read_b128 a[184:187], v17 offset:3200
v_mov_b32 v230, 0
v_mfma_f32_16x16x32_bf16 v[120:123], a[88:91], a[96:99], v[120:123]
buffer_load_dwordx4 a[24:27], v1, s[4:7], s22 offen offset:2048 sc1
v_mfma_f32_16x16x32_bf16 v[124:127], a[64:67], a[124:127], v[124:127]
ds_read_b64_tr_b16 a[156:157], v16 offset:3912
v_mov_b32 v231, 0
v_mfma_f32_16x16x32_bf16 v[124:127], a[68:71], a[120:123], v[124:127]
ds_read_b64_tr_b16 a[158:159], v16 offset:3904
v_mov_b32 v232, 0
v_mfma_f32_16x16x32_bf16 v[124:127], a[72:75], a[116:119], v[124:127]
ds_read_b128 a[188:191], v17 offset:3712
v_mov_b32 v233, 0
v_mfma_f32_16x16x32_bf16 v[124:127], a[76:79], a[112:115], v[124:127]
buffer_load_dwordx4 a[28:31], v1, s[4:7], s22 offen offset:3072 sc1
v_mfma_f32_16x16x32_bf16 v[124:127], a[80:83], a[108:111], v[124:127]
s_add_u32 s22, s78, 32768
buffer_load_dwordx4 a[32:35], v1, s[4:7], s22 offen offset:0 sc1
v_mfma_f32_16x16x32_bf16 v[124:127], a[84:87], a[104:107], v[124:127]
buffer_load_dwordx4 a[36:39], v1, s[4:7], s22 offen offset:1024 sc1
v_mfma_f32_16x16x32_bf16 v[124:127], a[88:91], a[100:103], v[124:127]
buffer_load_dwordx4 a[40:43], v1, s[4:7], s22 offen offset:2048 sc1
v_mfma_f32_16x16x32_bf16 v[124:127], a[92:95], a[96:99], v[124:127]
s_waitcnt lgkmcnt(3)
buffer_load_dwordx4 a[44:47], v1, s[4:7], s22 offen offset:3072 sc1
v_mfma_f32_16x16x32_bf16 v[96:99], a[128:131], a[160:163], v[96:99]
s_add_u32 s22, s78, 36864
ds_read_b64_tr_b16 a[64:65], v16 offset:392
v_mov_b32 v234, 0
v_mfma_f32_16x16x32_bf16 v[100:103], a[128:131], a[164:167], v[100:103]
ds_read_b64_tr_b16 a[66:67], v16 offset:384
v_mov_b32 v235, 0
v_mfma_f32_16x16x32_bf16 v[100:103], a[132:135], a[160:163], v[100:103]
ds_read_b128 a[96:99], v17 offset:64
v_mov_b32 v236, 0
v_mfma_f32_16x16x32_bf16 v[104:107], a[128:131], a[168:171], v[104:107]
ds_read_b64 v[36:37], v18 offset:0
v_mov_b32 v237, 0
v_mfma_f32_16x16x32_bf16 v[104:107], a[132:135], a[164:167], v[104:107]
ds_read_b64_tr_b16 a[68:69], v16 offset:904
v_mov_b32 v238, 0
v_mfma_f32_16x16x32_bf16 v[104:107], a[136:139], a[160:163], v[104:107]
ds_read_b64_tr_b16 a[70:71], v16 offset:896
v_mov_b32 v239, 0
v_mfma_f32_16x16x32_bf16 v[108:111], a[128:131], a[172:175], v[108:111]
ds_read_b128 a[100:103], v17 offset:576
v_mov_b32 v240, 0
v_mfma_f32_16x16x32_bf16 v[108:111], a[132:135], a[168:171], v[108:111]
ds_read_b64 v[38:39], v18 offset:512
v_mov_b32 v241, 0
v_mfma_f32_16x16x32_bf16 v[108:111], a[136:139], a[164:167], v[108:111]
ds_read_b64_tr_b16 a[72:73], v16 offset:1416
v_mov_b32 v242, 0
v_mfma_f32_16x16x32_bf16 v[108:111], a[140:143], a[160:163], v[108:111]
ds_read_b64_tr_b16 a[74:75], v16 offset:1408
v_mov_b32 v243, 0
v_mfma_f32_16x16x32_bf16 v[112:115], a[128:131], a[176:179], v[112:115]
ds_read_b128 a[104:107], v17 offset:1088
v_mov_b32 v244, 0
v_mfma_f32_16x16x32_bf16 v[112:115], a[132:135], a[172:175], v[112:115]
ds_read_b64 v[44:45], v18 offset:1024
v_mov_b32 v245, 0
v_mfma_f32_16x16x32_bf16 v[112:115], a[136:139], a[168:171], v[112:115]
ds_read_b64_tr_b16 a[76:77], v16 offset:1928
v_mov_b32 v246, 0
v_mfma_f32_16x16x32_bf16 v[112:115], a[140:143], a[164:167], v[112:115]
ds_read_b64_tr_b16 a[78:79], v16 offset:1920
v_mov_b32 v247, 0
v_mfma_f32_16x16x32_bf16 v[112:115], a[144:147], a[160:163], v[112:115]
ds_read_b128 a[108:111], v17 offset:1600
v_mov_b32 v248, 0
v_mfma_f32_16x16x32_bf16 v[116:119], a[128:131], a[180:183], v[116:119]
ds_read_b64 v[46:47], v18 offset:1536
v_mov_b32 v249, 0
v_mfma_f32_16x16x32_bf16 v[116:119], a[132:135], a[176:179], v[116:119]
ds_read_b64_tr_b16 a[80:81], v16 offset:2440
v_mov_b32 v250, 0
v_mfma_f32_16x16x32_bf16 v[116:119], a[136:139], a[172:175], v[116:119]
ds_read_b64_tr_b16 a[82:83], v16 offset:2432
v_mov_b32 v251, 0
v_mfma_f32_16x16x32_bf16 v[116:119], a[140:143], a[168:171], v[116:119]
ds_read_b128 a[112:115], v17 offset:2112
v_mov_b32 v252, 0
v_mfma_f32_16x16x32_bf16 v[116:119], a[144:147], a[164:167], v[116:119]
ds_read_b64 v[52:53], v18 offset:2048
v_mov_b32 v253, 0
v_mfma_f32_16x16x32_bf16 v[116:119], a[148:151], a[160:163], v[116:119]
ds_read_b64_tr_b16 a[84:85], v16 offset:2952
v_mov_b32 v254, 0
v_mfma_f32_16x16x32_bf16 v[120:123], a[128:131], a[184:187], v[120:123]
ds_read_b64_tr_b16 a[86:87], v16 offset:2944
v_mov_b32 v255, 0
v_mfma_f32_16x16x32_bf16 v[120:123], a[132:135], a[180:183], v[120:123]
ds_read_b128 a[116:119], v17 offset:2624
v_mfma_f32_16x16x32_bf16 v[120:123], a[136:139], a[176:179], v[120:123]
ds_read_b64 v[54:55], v18 offset:2560
v_mfma_f32_16x16x32_bf16 v[120:123], a[140:143], a[172:175], v[120:123]
ds_read_b64_tr_b16 a[88:89], v16 offset:3464
v_mfma_f32_16x16x32_bf16 v[120:123], a[144:147], a[168:171], v[120:123]
ds_read_b64_tr_b16 a[90:91], v16 offset:3456
v_mfma_f32_16x16x32_bf16 v[120:123], a[148:151], a[164:167], v[120:123]
ds_read_b128 a[120:123], v17 offset:3136
v_mfma_f32_16x16x32_bf16 v[120:123], a[152:155], a[160:163], v[120:123]
s_waitcnt lgkmcnt(8)
ds_read_b64 v[60:61], v18 offset:3072
v_mfma_f32_16x16x32_bf16 v[124:127], a[128:131], a[188:191], v[124:127]
ds_read_b64_tr_b16 a[92:93], v16 offset:3976
v_mfma_f32_16x16x32_bf16 v[124:127], a[132:135], a[184:187], v[124:127]
ds_read_b64_tr_b16 a[94:95], v16 offset:3968
v_mfma_f32_16x16x32_bf16 v[124:127], a[136:139], a[180:183], v[124:127]
ds_read_b128 a[124:127], v17 offset:3648
v_mfma_f32_16x16x32_bf16 v[124:127], a[140:143], a[176:179], v[124:127]
ds_read_b64 v[62:63], v18 offset:3584
v_mfma_f32_16x16x32_bf16 v[124:127], a[144:147], a[172:175], v[124:127]
buffer_load_dwordx4 a[48:51], v1, s[4:7], s22 offen offset:0 sc1
v_mfma_f32_16x16x32_bf16 v[124:127], a[148:151], a[168:171], v[124:127]
buffer_load_dwordx4 a[52:55], v1, s[4:7], s22 offen offset:1024 sc1
v_mfma_f32_16x16x32_bf16 v[124:127], a[152:155], a[164:167], v[124:127]
buffer_load_dwordx4 a[56:59], v1, s[4:7], s22 offen offset:2048 sc1
v_mfma_f32_16x16x32_bf16 v[124:127], a[156:159], a[160:163], v[124:127]
buffer_load_dwordx4 a[60:63], v1, s[4:7], s22 offen offset:3072 sc1
v_mfma_f32_16x16x32_bf16 v[96:99], a[64:67], a[96:99], v[96:99]
ds_read_b64_tr_b16 a[128:129], v16 offset:456
v_mfma_f32_16x16x32_bf16 v[100:103], a[64:67], a[100:103], v[100:103]
ds_read_b64_tr_b16 a[130:131], v16 offset:448
v_mfma_f32_16x16x32_bf16 v[100:103], a[68:71], a[96:99], v[100:103]
ds_read_b128 a[160:163], v17 offset:0
v_mfma_f32_16x16x32_bf16 v[104:107], a[64:67], a[104:107], v[104:107]
v_mfma_f32_16x16x32_bf16 v[104:107], a[68:71], a[100:103], v[104:107]
ds_read_b64_tr_b16 a[132:133], v16 offset:968
v_mfma_f32_16x16x32_bf16 v[104:107], a[72:75], a[96:99], v[104:107]
ds_read_b64_tr_b16 a[134:135], v16 offset:960
v_mfma_f32_16x16x32_bf16 v[108:111], a[64:67], a[108:111], v[108:111]
ds_read_b128 a[164:167], v17 offset:512
v_mfma_f32_16x16x32_bf16 v[108:111], a[68:71], a[104:107], v[108:111]
v_mfma_f32_16x16x32_bf16 v[108:111], a[72:75], a[100:103], v[108:111]
ds_read_b64_tr_b16 a[136:137], v16 offset:1480
v_mfma_f32_16x16x32_bf16 v[108:111], a[76:79], a[96:99], v[108:111]
ds_read_b64_tr_b16 a[138:139], v16 offset:1472
v_mfma_f32_16x16x32_bf16 v[112:115], a[64:67], a[112:115], v[112:115]
ds_read_b128 a[168:171], v17 offset:1024
v_mfma_f32_16x16x32_bf16 v[112:115], a[68:71], a[108:111], v[112:115]
v_mfma_f32_16x16x32_bf16 v[112:115], a[72:75], a[104:107], v[112:115]
ds_read_b64_tr_b16 a[140:141], v16 offset:1992
v_mfma_f32_16x16x32_bf16 v[112:115], a[76:79], a[100:103], v[112:115]
ds_read_b64_tr_b16 a[142:143], v16 offset:1984
v_mfma_f32_16x16x32_bf16 v[112:115], a[80:83], a[96:99], v[112:115]
s_waitcnt lgkmcnt(6)
ds_read_b128 a[172:175], v17 offset:1536
v_mfma_f32_16x16x32_bf16 v[116:119], a[64:67], a[116:119], v[116:119]
v_mfma_f32_16x16x32_bf16 v[116:119], a[68:71], a[112:115], v[116:119]
ds_read_b64_tr_b16 a[144:145], v16 offset:2504
v_mfma_f32_16x16x32_bf16 v[116:119], a[72:75], a[108:111], v[116:119]
ds_read_b64_tr_b16 a[146:147], v16 offset:2496
v_mfma_f32_16x16x32_bf16 v[116:119], a[76:79], a[104:107], v[116:119]
ds_read_b128 a[176:179], v17 offset:2048
v_mfma_f32_16x16x32_bf16 v[116:119], a[80:83], a[100:103], v[116:119]
v_mfma_f32_16x16x32_bf16 v[116:119], a[84:87], a[96:99], v[116:119]
ds_read_b64_tr_b16 a[148:149], v16 offset:3016
v_mfma_f32_16x16x32_bf16 v[120:123], a[64:67], a[120:123], v[120:123]
ds_read_b64_tr_b16 a[150:151], v16 offset:3008
v_mfma_f32_16x16x32_bf16 v[120:123], a[68:71], a[116:119], v[120:123]
ds_read_b128 a[180:183], v17 offset:2560
v_mfma_f32_16x16x32_bf16 v[120:123], a[72:75], a[112:115], v[120:123]
v_mfma_f32_16x16x32_bf16 v[120:123], a[76:79], a[108:111], v[120:123]
ds_read_b64_tr_b16 a[152:153], v16 offset:3528
v_mfma_f32_16x16x32_bf16 v[120:123], a[80:83], a[104:107], v[120:123]
ds_read_b64_tr_b16 a[154:155], v16 offset:3520
v_mfma_f32_16x16x32_bf16 v[120:123], a[84:87], a[100:103], v[120:123]
ds_read_b128 a[184:187], v17 offset:3072
v_mfma_f32_16x16x32_bf16 v[120:123], a[88:91], a[96:99], v[120:123]
v_mfma_f32_16x16x32_bf16 v[124:127], a[64:67], a[124:127], v[124:127]
ds_read_b64_tr_b16 a[156:157], v16 offset:4040
v_mfma_f32_16x16x32_bf16 v[124:127], a[68:71], a[120:123], v[124:127]
ds_read_b64_tr_b16 a[158:159], v16 offset:4032
v_mfma_f32_16x16x32_bf16 v[124:127], a[72:75], a[116:119], v[124:127]
ds_read_b128 a[188:191], v17 offset:3584
v_mfma_f32_16x16x32_bf16 v[124:127], a[76:79], a[112:115], v[124:127]
v_mfma_f32_16x16x32_bf16 v[124:127], a[80:83], a[108:111], v[124:127]
v_mfma_f32_16x16x32_bf16 v[124:127], a[84:87], a[104:107], v[124:127]
v_mfma_f32_16x16x32_bf16 v[124:127], a[88:91], a[100:103], v[124:127]
v_mfma_f32_16x16x32_bf16 v[124:127], a[92:95], a[96:99], v[124:127]
v_mfma_f32_16x16x32_bf16 v[96:99], a[128:131], a[160:163], v[96:99]
s_waitcnt lgkmcnt(3)
v_mfma_f32_16x16x32_bf16 v[100:103], a[128:131], a[164:167], v[100:103]
v_mfma_f32_16x16x32_bf16 v[100:103], a[132:135], a[160:163], v[100:103]
v_mfma_f32_16x16x32_bf16 v[104:107], a[128:131], a[168:171], v[104:107]
v_mfma_f32_16x16x32_bf16 v[104:107], a[132:135], a[164:167], v[104:107]
v_mfma_f32_16x16x32_bf16 v[104:107], a[136:139], a[160:163], v[104:107]
v_mfma_f32_16x16x32_bf16 v[108:111], a[128:131], a[172:175], v[108:111]
v_mfma_f32_16x16x32_bf16 v[108:111], a[132:135], a[168:171], v[108:111]
v_mfma_f32_16x16x32_bf16 v[108:111], a[136:139], a[164:167], v[108:111]
v_lshlrev_b32 v10, 16, v36
v_fmac_f32 v96, v19, v10
v_mfma_f32_16x16x32_bf16 v[108:111], a[140:143], a[160:163], v[108:111]
v_and_b32 v11, 0xffff0000, v36
v_fmac_f32 v97, v19, v11
v_mfma_f32_16x16x32_bf16 v[112:115], a[128:131], a[176:179], v[112:115]
v_lshlrev_b32 v12, 16, v37
v_fmac_f32 v98, v19, v12
v_mfma_f32_16x16x32_bf16 v[112:115], a[132:135], a[172:175], v[112:115]
v_and_b32 v13, 0xffff0000, v37
v_fmac_f32 v99, v19, v13
v_mfma_f32_16x16x32_bf16 v[112:115], a[136:139], a[168:171], v[112:115]
v_cvt_pk_bf16_f32 v96, v96, v97
v_cvt_pk_bf16_f32 v97, v98, v99
v_mfma_f32_16x16x32_bf16 v[112:115], a[140:143], a[164:167], v[112:115]
buffer_store_dwordx2 v[96:97], v8, s[4:7], s83 offen offset:0 sc1
v_mfma_f32_16x16x32_bf16 v[112:115], a[144:147], a[160:163], v[112:115]
v_lshlrev_b32 v10, 16, v38
v_fmac_f32 v100, v19, v10
v_mfma_f32_16x16x32_bf16 v[116:119], a[128:131], a[180:183], v[116:119]
v_and_b32 v11, 0xffff0000, v38
v_fmac_f32 v101, v19, v11
v_mfma_f32_16x16x32_bf16 v[116:119], a[132:135], a[176:179], v[116:119]
v_lshlrev_b32 v12, 16, v39
v_fmac_f32 v102, v19, v12
v_mfma_f32_16x16x32_bf16 v[116:119], a[136:139], a[172:175], v[116:119]
v_and_b32 v13, 0xffff0000, v39
v_fmac_f32 v103, v19, v13
v_mfma_f32_16x16x32_bf16 v[116:119], a[140:143], a[168:171], v[116:119]
v_cvt_pk_bf16_f32 v100, v100, v101
v_cvt_pk_bf16_f32 v101, v102, v103
v_mfma_f32_16x16x32_bf16 v[116:119], a[144:147], a[164:167], v[116:119]
buffer_store_dwordx2 v[100:101], v8, s[4:7], s83 offen offset:512 sc1
v_mfma_f32_16x16x32_bf16 v[116:119], a[148:151], a[160:163], v[116:119]
v_lshlrev_b32 v10, 16, v44
v_fmac_f32 v104, v19, v10
v_mfma_f32_16x16x32_bf16 v[120:123], a[128:131], a[184:187], v[120:123]
v_and_b32 v11, 0xffff0000, v44
v_fmac_f32 v105, v19, v11
v_mfma_f32_16x16x32_bf16 v[120:123], a[132:135], a[180:183], v[120:123]
v_lshlrev_b32 v12, 16, v45
v_fmac_f32 v106, v19, v12
v_mfma_f32_16x16x32_bf16 v[120:123], a[136:139], a[176:179], v[120:123]
v_and_b32 v13, 0xffff0000, v45
v_fmac_f32 v107, v19, v13
v_mfma_f32_16x16x32_bf16 v[120:123], a[140:143], a[172:175], v[120:123]
v_cvt_pk_bf16_f32 v104, v104, v105
v_cvt_pk_bf16_f32 v105, v106, v107
v_mfma_f32_16x16x32_bf16 v[120:123], a[144:147], a[168:171], v[120:123]
PAD_31:
s_cbranch_execz M_tret
buffer_store_dwordx2 v[104:105], v8, s[4:7], s83 offen offset:1024 sc1
v_mfma_f32_16x16x32_bf16 v[120:123], a[148:151], a[164:167], v[120:123]
v_lshlrev_b32 v10, 16, v46
v_fmac_f32 v108, v19, v10
v_mfma_f32_16x16x32_bf16 v[120:123], a[152:155], a[160:163], v[120:123]
s_waitcnt lgkmcnt(0)
v_and_b32 v11, 0xffff0000, v46
v_fmac_f32 v109, v19, v11
v_mfma_f32_16x16x32_bf16 v[124:127], a[128:131], a[188:191], v[124:127]
v_lshlrev_b32 v12, 16, v47
v_fmac_f32 v110, v19, v12
v_mfma_f32_16x16x32_bf16 v[124:127], a[132:135], a[184:187], v[124:127]
v_and_b32 v13, 0xffff0000, v47
v_fmac_f32 v111, v19, v13
v_mfma_f32_16x16x32_bf16 v[124:127], a[136:139], a[180:183], v[124:127]
v_cvt_pk_bf16_f32 v108, v108, v109
v_cvt_pk_bf16_f32 v109, v110, v111
v_mfma_f32_16x16x32_bf16 v[124:127], a[140:143], a[176:179], v[124:127]
buffer_store_dwordx2 v[108:109], v8, s[4:7], s83 offen offset:1536 sc1
v_mfma_f32_16x16x32_bf16 v[124:127], a[144:147], a[172:175], v[124:127]
v_lshlrev_b32 v10, 16, v52
v_fmac_f32 v112, v19, v10
v_mfma_f32_16x16x32_bf16 v[124:127], a[148:151], a[168:171], v[124:127]
v_and_b32 v11, 0xffff0000, v52
v_fmac_f32 v113, v19, v11
v_mfma_f32_16x16x32_bf16 v[124:127], a[152:155], a[164:167], v[124:127]
v_lshlrev_b32 v12, 16, v53
v_fmac_f32 v114, v19, v12
v_mfma_f32_16x16x32_bf16 v[124:127], a[156:159], a[160:163], v[124:127]
v_and_b32 v13, 0xffff0000, v53
v_fmac_f32 v115, v19, v13
v_cvt_pk_bf16_f32 v112, v112, v113
v_cvt_pk_bf16_f32 v113, v114, v115
buffer_store_dwordx2 v[112:113], v8, s[4:7], s83 offen offset:2048 sc1
v_lshlrev_b32 v10, 16, v54
v_fmac_f32 v116, v19, v10
v_and_b32 v11, 0xffff0000, v54
v_fmac_f32 v117, v19, v11
v_lshlrev_b32 v12, 16, v55
v_fmac_f32 v118, v19, v12
v_and_b32 v13, 0xffff0000, v55
v_fmac_f32 v119, v19, v13
v_cvt_pk_bf16_f32 v116, v116, v117
v_cvt_pk_bf16_f32 v117, v118, v119
buffer_store_dwordx2 v[116:117], v8, s[4:7], s83 offen offset:2560 sc1
v_lshlrev_b32 v10, 16, v60
v_fmac_f32 v120, v19, v10
v_and_b32 v11, 0xffff0000, v60
v_fmac_f32 v121, v19, v11
v_lshlrev_b32 v12, 16, v61
v_fmac_f32 v122, v19, v12
v_and_b32 v13, 0xffff0000, v61
v_fmac_f32 v123, v19, v13
v_cvt_pk_bf16_f32 v120, v120, v121
v_cvt_pk_bf16_f32 v121, v122, v123
buffer_store_dwordx2 v[120:121], v8, s[4:7], s83 offen offset:3072 sc1
v_lshlrev_b32 v10, 16, v62
v_fmac_f32 v124, v19, v10
v_and_b32 v11, 0xffff0000, v62
v_fmac_f32 v125, v19, v11
v_lshlrev_b32 v12, 16, v63
v_fmac_f32 v126, v19, v12
v_and_b32 v13, 0xffff0000, v63
v_fmac_f32 v127, v19, v13
v_cvt_pk_bf16_f32 v124, v124, v125
v_cvt_pk_bf16_f32 v125, v126, v127
buffer_store_dwordx2 v[124:125], v8, s[4:7], s83 offen offset:3584 sc1
v_lshrrev_b32 v8, 7, v1
v_and_b32 v9, 6, v8
v_lshlrev_b32 v9, 4, v9
v_and_b32 v10, 0x70, v1
v_xor_b32 v9, v9, v10
v_mul_u32_u24 v8, 896, v8
v_add_u32 v8, v8, v9
v_accvgpr_write_b32 a184, v8
v_add_u32 v8, 6144, v8
v_accvgpr_write_b32 a185, v8
v_add_u32 v8, 6144, v8
v_accvgpr_write_b32 a186, v8
v_add_u32 v8, 6144, v8
v_accvgpr_write_b32 a187, v8
v_lshrrev_b32 v8, 6, v1
v_bfe_u32 v9, v1, 7, 2
v_lshlrev_b32 v9, 5, v9
v_lshl_add_u32 v8, v8, 7, v9
v_bfe_u32 v9, v1, 4, 2
v_lshl_add_u32 v8, v9, 3, v8
v_add_u32 v8, 32768, v8
v_accvgpr_write_b32 a188, v8
v_xor_b32 v9, 32, v8
v_accvgpr_write_b32 a189, v9
v_xor_b32 v9, 64, v8
v_accvgpr_write_b32 a190, v9
v_xor_b32 v9, 96, v8
v_accvgpr_write_b32 a191, v9
s_branch M_t2B
M_t2Br:
s_waitcnt vmcnt(8)
s_barrier
s_cmp_lg_u32 s24, 0
s_cbranch_scc1 K2_item
v_accvgpr_mov_b32 a0, a192
v_accvgpr_mov_b32 a1, a193
v_accvgpr_mov_b32 a2, a194
v_accvgpr_mov_b32 a3, a195
v_accvgpr_mov_b32 a4, a196
v_accvgpr_mov_b32 a5, a197
v_accvgpr_mov_b32 a6, a198
v_accvgpr_mov_b32 a7, a199
v_accvgpr_mov_b32 a8, a200
v_accvgpr_mov_b32 a9, a201
v_accvgpr_mov_b32 a10, a202
v_accvgpr_mov_b32 a11, a203
v_accvgpr_mov_b32 a12, a204
v_accvgpr_mov_b32 a13, a205
v_accvgpr_mov_b32 a14, a206
v_accvgpr_mov_b32 a15, a207
v_accvgpr_mov_b32 a16, a208
v_accvgpr_mov_b32 a17, a209
v_accvgpr_mov_b32 a18, a210
v_accvgpr_mov_b32 a19, a211
v_accvgpr_mov_b32 a20, a212
v_accvgpr_mov_b32 a21, a213
v_accvgpr_mov_b32 a22, a214
v_accvgpr_mov_b32 a23, a215
v_accvgpr_mov_b32 a24, a216
v_accvgpr_mov_b32 a25, a217
v_accvgpr_mov_b32 a26, a218
v_accvgpr_mov_b32 a27, a219
v_accvgpr_mov_b32 a28, a220
v_accvgpr_mov_b32 a29, a221
v_accvgpr_mov_b32 a30, a222
v_accvgpr_mov_b32 a31, a223
v_accvgpr_mov_b32 a32, a224
v_accvgpr_mov_b32 a33, a225
v_accvgpr_mov_b32 a34, a226
v_accvgpr_mov_b32 a35, a227
v_accvgpr_mov_b32 a36, a228
v_accvgpr_mov_b32 a37, a229
v_accvgpr_mov_b32 a38, a230
v_accvgpr_mov_b32 a39, a231
v_accvgpr_mov_b32 a40, a232
v_accvgpr_mov_b32 a41, a233
v_accvgpr_mov_b32 a42, a234
v_accvgpr_mov_b32 a43, a235
v_accvgpr_mov_b32 a44, a236
v_accvgpr_mov_b32 a45, a237
v_accvgpr_mov_b32 a46, a238
v_accvgpr_mov_b32 a47, a239
v_accvgpr_mov_b32 a48, a240
v_accvgpr_mov_b32 a49, a241
v_accvgpr_mov_b32 a50, a242
v_accvgpr_mov_b32 a51, a243
v_accvgpr_mov_b32 a52, a244
v_accvgpr_mov_b32 a53, a245
v_accvgpr_mov_b32 a54, a246
v_accvgpr_mov_b32 a55, a247
v_accvgpr_mov_b32 a56, a248
v_accvgpr_mov_b32 a57, a249
v_accvgpr_mov_b32 a58, a250
v_accvgpr_mov_b32 a59, a251
v_accvgpr_mov_b32 a60, a252
v_accvgpr_mov_b32 a61, a253
v_accvgpr_mov_b32 a62, a254
v_accvgpr_mov_b32 a63, a255
s_branch K2_item
M_cend:
M_cspin:
Lp_16:
buffer_load_dword v14, v15, s[4:7], s70 offen sc1
s_waitcnt vmcnt(0)
v_cmp_gt_u32 vcc, 1, v14
s_cbranch_vccz Lpd_17
s_sleep 8
s_sub_u32 s101, s101, 1
s_cbranch_scc0 Lp_16
s_mov_b32 s101, 0
Lpd_17:
s_branch M_cok
M_kspin:
Lp_18:
buffer_load_dword v21, v20, s[4:7], s70 offen sc1
s_waitcnt vmcnt(0)
v_cmp_gt_u32 vcc, 1, v21
s_cbranch_vccz Lpd_19
s_sleep 8
s_sub_u32 s101, s101, 1
s_cbranch_scc0 Lp_18
s_mov_b32 s101, 0
Lpd_19:
s_branch M_kok
M_kspin2:
Lp_20:
buffer_load_dword v21, v20, s[4:7], s70 offen sc1
s_waitcnt vmcnt(0)
v_cmp_gt_u32 vcc, 1, v21
s_cbranch_vccz Lpd_21
s_sleep 8
s_sub_u32 s101, s101, 1
s_cbranch_scc0 Lp_20
s_mov_b32 s101, 0
Lpd_21:
s_branch M_kok2
M_vspin:
Lp_22:
buffer_load_dword v21, v15, s[4:7], s70 offen sc1
s_waitcnt vmcnt(0)
v_cmp_gt_u32 vcc, 1, v21
s_cbranch_vccz Lpd_23
s_sleep 8
s_sub_u32 s101, s101, 1
s_cbranch_scc0 Lp_22
s_mov_b32 s101, 0
Lpd_23:
s_branch M_vok
PAD_32:
s_cbranch_execz M_tret
K2_plain:
v_mfma_f32_16x16x32_bf16 v[128:131], a[64:67], v[96:99], v[128:131]
s_waitcnt lgkmcnt(6)
ds_read_b128 a[96:99], v2 offset:8192
v_add_f32 v24, v24, v26
v_mfma_f32_16x16x32_bf16 v[128:131], a[68:71], v[100:103], v[128:131]
s_waitcnt lgkmcnt(5)
v_mfma_f32_16x16x32_bf16 v[132:135], a[68:71], v[108:111], v[132:135]
s_mov_b64 s[36:37], s[86:87]
ds_read_b128 a[100:103], v2 offset:9216
v_add_f32 v25, v25, v27
v_mfma_f32_16x16x32_bf16 v[132:135], a[64:67], v[104:107], v[132:135]
s_mov_b32 s38, 3670016
v_exp_f32 v8, v68
v_mfma_f32_16x16x32_bf16 v[136:139], a[72:75], v[96:99], v[136:139]
s_mov_b32 s39, 0x20000
ds_read_b128 a[104:107], v2 offset:10240
v_accvgpr_read_b32 v112, a184
v_mfma_f32_16x16x32_bf16 v[136:139], a[76:79], v[100:103], v[136:139]
v_accvgpr_read_b32 v113, a185
v_accvgpr_read_b32 v114, a186
v_mfma_f32_16x16x32_bf16 v[140:143], a[76:79], v[108:111], v[140:143]
ds_read_b128 a[108:111], v2 offset:11264
v_accvgpr_read_b32 v115, a187
v_mfma_f32_16x16x32_bf16 v[140:143], a[72:75], v[104:107], v[140:143]
s_waitcnt lgkmcnt(5)
v_accvgpr_read_b32 v116, a188
v_accvgpr_read_b32 v117, a189
v_mfma_f32_16x16x32_bf16 v[144:147], a[80:83], v[96:99], v[144:147]
ds_read_b128 a[112:115], v2 offset:12288
v_accvgpr_read_b32 v118, a190
v_mfma_f32_16x16x32_bf16 v[144:147], a[84:87], v[100:103], v[144:147]
v_accvgpr_read_b32 v119, a191
v_mfma_f32_16x16x32_bf16 v[148:151], a[84:87], v[108:111], v[148:151]
s_add_u32 m0, s18, 32768
ds_read_b128 a[116:119], v2 offset:13312
v_cvt_pk_bf16_f32 v128, v128, v129
v_mfma_f32_16x16x32_bf16 v[148:151], a[80:83], v[104:107], v[148:151]
buffer_load_dwordx4 v112, s[36:39], s81 offen offset:0 lds
v_mfma_f32_16x16x32_bf16 v[152:155], a[88:91], v[96:99], v[152:155]
s_waitcnt lgkmcnt(4)
ds_read_b128 a[120:123], v2 offset:14336
v_cvt_pk_bf16_f32 v129, v130, v131
v_mfma_f32_16x16x32_bf16 v[152:155], a[92:95], v[100:103], v[152:155]
v_exp_f32 v9, v69
v_mfma_f32_16x16x32_bf16 v[156:159], a[92:95], v[108:111], v[156:159]
ds_read_b128 a[124:127], v2 offset:15360
v_add_f32 v27, v8, v9
v_mfma_f32_16x16x32_bf16 v[156:159], a[88:91], v[104:107], v[156:159]
buffer_load_dwordx4 v113, s[36:39], s81 offen offset:1024 lds
v_mfma_f32_16x16x32_bf16 v[160:163], a[96:99], v[96:99], v[160:163]
ds_read_b128 a[64:67], v2 offset:16384
v_cvt_pk_bf16_f32 v120, v8, v9
v_mfma_f32_16x16x32_bf16 v[160:163], a[100:103], v[100:103], v[160:163]
v_exp_f32 v10, v70
v_mfma_f32_16x16x32_bf16 v[164:167], a[100:103], v[108:111], v[164:167]
ds_read_b128 a[68:71], v2 offset:17408
v_add_f32 v27, v27, v10
v_mfma_f32_16x16x32_bf16 v[164:167], a[96:99], v[104:107], v[164:167]
s_waitcnt lgkmcnt(4)
buffer_load_dwordx4 v114, s[36:39], s81 offen offset:2048 lds
v_mfma_f32_16x16x32_bf16 v[168:171], a[104:107], v[96:99], v[168:171]
ds_read_b128 a[72:75], v2 offset:18432
v_cvt_pk_bf16_f32 v130, v136, v137
v_mfma_f32_16x16x32_bf16 v[168:171], a[108:111], v[100:103], v[168:171]
v_exp_f32 v11, v71
v_mfma_f32_16x16x32_bf16 v[172:175], a[108:111], v[108:111], v[172:175]
ds_read_b128 a[76:79], v2 offset:19456
v_add_f32 v27, v27, v11
v_mfma_f32_16x16x32_bf16 v[172:175], a[104:107], v[104:107], v[172:175]
buffer_load_dwordx4 v115, s[36:39], s81 offen offset:3072 lds
v_mfma_f32_16x16x32_bf16 v[176:179], a[112:115], v[96:99], v[176:179]
ds_read_b128 a[80:83], v2 offset:20480
v_cvt_pk_bf16_f32 v121, v10, v11
v_mfma_f32_16x16x32_bf16 v[176:179], a[116:119], v[100:103], v[176:179]
s_waitcnt lgkmcnt(4)
v_exp_f32 v12, v76
v_mfma_f32_16x16x32_bf16 v[180:183], a[116:119], v[108:111], v[180:183]
s_add_u32 s81, s81, 28672
ds_read_b128 a[84:87], v2 offset:21504
v_add_f32 v27, v27, v12
v_mfma_f32_16x16x32_bf16 v[180:183], a[112:115], v[104:107], v[180:183]
s_add_u32 m0, s18, 36864
v_exp_f32 v13, v77
v_mfma_f32_16x16x32_bf16 v[184:187], a[120:123], v[96:99], v[184:187]
ds_read_b128 a[88:91], v2 offset:22528
v_add_f32 v27, v27, v13
v_mfma_f32_16x16x32_bf16 v[184:187], a[124:127], v[100:103], v[184:187]
buffer_load_dwordx4 v112, s[36:39], s81 offen offset:0 lds
v_mfma_f32_16x16x32_bf16 v[188:191], a[124:127], v[108:111], v[188:191]
ds_read_b128 a[92:95], v2 offset:23552
v_cvt_pk_bf16_f32 v122, v12, v13
v_mfma_f32_16x16x32_bf16 v[188:191], a[120:123], v[104:107], v[188:191]
v_exp_f32 v14, v78
v_mfma_f32_16x16x32_bf16 v[192:195], a[64:67], v[96:99], v[192:195]
s_waitcnt lgkmcnt(4)
ds_read_b128 a[96:99], v2 offset:24576
v_add_f32 v27, v27, v14
v_mfma_f32_16x16x32_bf16 v[192:195], a[68:71], v[100:103], v[192:195]
buffer_load_dwordx4 v113, s[36:39], s81 offen offset:1024 lds
v_mfma_f32_16x16x32_bf16 v[196:199], a[68:71], v[108:111], v[196:199]
ds_read_b128 a[100:103], v2 offset:25600
v_cvt_pk_bf16_f32 v131, v138, v139
v_mfma_f32_16x16x32_bf16 v[196:199], a[64:67], v[104:107], v[196:199]
v_exp_f32 v15, v79
v_mfma_f32_16x16x32_bf16 v[200:203], a[72:75], v[96:99], v[200:203]
ds_read_b128 a[104:107], v2 offset:26624
v_add_f32 v27, v27, v15
v_mfma_f32_16x16x32_bf16 v[200:203], a[76:79], v[100:103], v[200:203]
buffer_load_dwordx4 v114, s[36:39], s81 offen offset:2048 lds
v_mfma_f32_16x16x32_bf16 v[204:207], a[76:79], v[108:111], v[204:207]
ds_read_b128 a[108:111], v2 offset:27648
v_cvt_pk_bf16_f32 v123, v14, v15
v_mfma_f32_16x16x32_bf16 v[204:207], a[72:75], v[104:107], v[204:207]
s_waitcnt lgkmcnt(4)
v_exp_f32 v8, v84
v_mfma_f32_16x16x32_bf16 v[208:211], a[80:83], v[96:99], v[208:211]
ds_read_b128 a[112:115], v2 offset:28672
v_add_f32 v27, v27, v8
v_mfma_f32_16x16x32_bf16 v[208:211], a[84:87], v[100:103], v[208:211]
buffer_load_dwordx4 v115, s[36:39], s81 offen offset:3072 lds
v_mfma_f32_16x16x32_bf16 v[212:215], a[84:87], v[108:111], v[212:215]
ds_read_b128 a[116:119], v2 offset:29696
v_cvt_pk_bf16_f32 v144, v144, v145
v_mfma_f32_16x16x32_bf16 v[212:215], a[80:83], v[104:107], v[212:215]
v_exp_f32 v9, v85
v_mfma_f32_16x16x32_bf16 v[216:219], a[88:91], v[96:99], v[216:219]
s_sub_u32 s81, s81, 28544
ds_read_b128 a[120:123], v2 offset:30720
v_add_f32 v27, v27, v9
v_mfma_f32_16x16x32_bf16 v[216:219], a[92:95], v[100:103], v[216:219]
v_exp_f32 v10, v86
v_mfma_f32_16x16x32_bf16 v[220:223], a[92:95], v[108:111], v[220:223]
s_waitcnt vmcnt(8) lgkmcnt(4)
ds_read_b128 a[124:127], v2 offset:31744
v_cvt_pk_bf16_f32 v124, v8, v9
v_mfma_f32_16x16x32_bf16 v[220:223], a[88:91], v[104:107], v[220:223]
s_barrier
v_mfma_f32_16x16x32_bf16 v[224:227], a[96:99], v[96:99], v[224:227]
ds_read_b128 a[64:67], v1 offset:0
v_add_f32 v27, v27, v10
v_mfma_f32_16x16x32_bf16 v[224:227], a[100:103], v[100:103], v[224:227]
v_exp_f32 v11, v87
v_mfma_f32_16x16x32_bf16 v[228:231], a[100:103], v[108:111], v[228:231]
ds_read_b128 a[68:71], v1 offset:1024
v_add_f32 v27, v27, v11
v_mfma_f32_16x16x32_bf16 v[228:231], a[96:99], v[104:107], v[228:231]
v_exp_f32 v12, v92
v_mfma_f32_16x16x32_bf16 v[232:235], a[104:107], v[96:99], v[232:235]
s_waitcnt lgkmcnt(4)
ds_read_b128 a[72:75], v1 offset:2048
v_cvt_pk_bf16_f32 v125, v10, v11
v_mfma_f32_16x16x32_bf16 v[232:235], a[108:111], v[100:103], v[232:235]
v_exp_f32 v13, v93
v_mfma_f32_16x16x32_bf16 v[236:239], a[108:111], v[108:111], v[236:239]
ds_read_b128 a[76:79], v1 offset:3072
v_add_f32 v27, v27, v12
v_mfma_f32_16x16x32_bf16 v[236:239], a[104:107], v[104:107], v[236:239]
v_exp_f32 v14, v94
v_mfma_f32_16x16x32_bf16 v[240:243], a[112:115], v[96:99], v[240:243]
ds_read_b128 a[80:83], v1 offset:4096
v_add_f32 v27, v27, v13
v_mfma_f32_16x16x32_bf16 v[240:243], a[116:119], v[100:103], v[240:243]
v_exp_f32 v15, v95
v_mfma_f32_16x16x32_bf16 v[244:247], a[116:119], v[108:111], v[244:247]
ds_read_b128 a[84:87], v1 offset:5120
v_cvt_pk_bf16_f32 v126, v12, v13
v_mfma_f32_16x16x32_bf16 v[244:247], a[112:115], v[104:107], v[244:247]
s_waitcnt lgkmcnt(4)
v_add_f32 v27, v27, v14
v_add_f32 v27, v27, v15
v_mfma_f32_16x16x32_bf16 v[248:251], a[120:123], v[96:99], v[248:251]
ds_read_b128 a[88:91], v1 offset:6144
v_cvt_pk_bf16_f32 v127, v14, v15
v_mfma_f32_16x16x32_bf16 v[248:251], a[124:127], v[100:103], v[248:251]
v_cmp_nge_f32 vcc, s25, v27
v_cvt_pk_bf16_f32 v145, v146, v147
v_mfma_f32_16x16x32_bf16 v[252:255], a[124:127], v[108:111], v[252:255]
ds_read_b128 a[92:95], v1 offset:7168
v_cvt_pk_bf16_f32 v146, v152, v153
v_mfma_f32_16x16x32_bf16 v[252:255], a[120:123], v[104:107], v[252:255]
s_waitcnt lgkmcnt(2)
v_cvt_pk_bf16_f32 v147, v154, v155
v_cvt_pk_bf16_f32 v160, v160, v161
s_cbranch_vccnz Lstub_12
Lback_13:
v_mfma_f32_16x16x32_bf16 v[132:135], a[64:67], v[120:123], v[132:135]
s_lshl_b32 s8, s29, 3
ds_read_b128 a[96:99], v1 offset:8192
v_add_f32 v25, v25, v27
v_mfma_f32_16x16x32_bf16 v[132:135], a[68:71], v[124:127], v[132:135]
s_add_u32 s8, s8, s3
ds_read_b128 a[100:103], v1 offset:9216
v_cvt_pk_bf16_f32 v161, v162, v163
v_mfma_f32_16x16x32_bf16 v[140:143], a[72:75], v[120:123], v[140:143]
s_lshl_b32 s8, s8, 4
ds_read_b128 a[104:107], v1 offset:10240
v_cvt_pk_bf16_f32 v162, v168, v169
v_mfma_f32_16x16x32_bf16 v[140:143], a[76:79], v[124:127], v[140:143]
s_add_u32 s8, s8, s20
ds_read_b128 a[108:111], v1 offset:11264
v_cvt_pk_bf16_f32 v163, v170, v171
v_mfma_f32_16x16x32_bf16 v[148:151], a[80:83], v[120:123], v[148:151]
s_mul_i32 s8, s8, 14336
ds_read_b128 a[112:115], v1 offset:12288
v_cvt_pk_bf16_f32 v176, v176, v177
v_mfma_f32_16x16x32_bf16 v[148:151], a[84:87], v[124:127], v[148:151]
s_waitcnt lgkmcnt(5)
s_add_u32 s8, s8, 104857600
ds_read_b128 a[116:119], v1 offset:13312
v_cvt_pk_bf16_f32 v177, v178, v179
v_mfma_f32_16x16x32_bf16 v[156:159], a[88:91], v[120:123], v[156:159]
s_add_u32 s12, s8, 917504
ds_read_b128 a[120:123], v1 offset:14336
v_cvt_pk_bf16_f32 v178, v184, v185
v_mfma_f32_16x16x32_bf16 v[156:159], a[92:95], v[124:127], v[156:159]
s_waitcnt lgkmcnt(6)
ds_read_b128 a[124:127], v1 offset:15360
v_cvt_pk_bf16_f32 v179, v186, v187
v_mfma_f32_16x16x32_bf16 v[164:167], a[96:99], v[120:123], v[164:167]
s_waitcnt lgkmcnt(6)
ds_read_b128 a[64:67], v1 offset:16384
v_cvt_pk_bf16_f32 v192, v192, v193
v_mfma_f32_16x16x32_bf16 v[164:167], a[100:103], v[124:127], v[164:167]
s_waitcnt lgkmcnt(6)
ds_read_b128 a[68:71], v1 offset:17408
v_cvt_pk_bf16_f32 v193, v194, v195
v_mfma_f32_16x16x32_bf16 v[172:175], a[104:107], v[120:123], v[172:175]
s_waitcnt lgkmcnt(6)
ds_read_b128 a[72:75], v1 offset:18432
v_cvt_pk_bf16_f32 v194, v200, v201
v_mfma_f32_16x16x32_bf16 v[172:175], a[108:111], v[124:127], v[172:175]
s_waitcnt lgkmcnt(6)
ds_read_b128 a[76:79], v1 offset:19456
v_cvt_pk_bf16_f32 v195, v202, v203
v_mfma_f32_16x16x32_bf16 v[180:183], a[112:115], v[120:123], v[180:183]
s_waitcnt lgkmcnt(6)
ds_read_b128 a[80:83], v1 offset:20480
v_cvt_pk_bf16_f32 v208, v208, v209
v_mfma_f32_16x16x32_bf16 v[180:183], a[116:119], v[124:127], v[180:183]
s_waitcnt lgkmcnt(6)
ds_read_b128 a[84:87], v1 offset:21504
v_cvt_pk_bf16_f32 v209, v210, v211
v_mfma_f32_16x16x32_bf16 v[188:191], a[120:123], v[120:123], v[188:191]
s_waitcnt lgkmcnt(6)
ds_read_b128 a[88:91], v1 offset:22528
v_cvt_pk_bf16_f32 v210, v216, v217
v_mfma_f32_16x16x32_bf16 v[188:191], a[124:127], v[124:127], v[188:191]
s_waitcnt lgkmcnt(6)
ds_read_b128 a[92:95], v1 offset:23552
v_cvt_pk_bf16_f32 v211, v218, v219
v_mfma_f32_16x16x32_bf16 v[196:199], a[64:67], v[120:123], v[196:199]
s_waitcnt lgkmcnt(6)
ds_read_b128 a[96:99], v1 offset:24576
v_cvt_pk_bf16_f32 v224, v224, v225
v_mfma_f32_16x16x32_bf16 v[196:199], a[68:71], v[124:127], v[196:199]
s_waitcnt lgkmcnt(6)
ds_read_b128 a[100:103], v1 offset:25600
v_cvt_pk_bf16_f32 v225, v226, v227
v_mfma_f32_16x16x32_bf16 v[204:207], a[72:75], v[120:123], v[204:207]
s_waitcnt lgkmcnt(6)
ds_read_b128 a[104:107], v1 offset:26624
v_cvt_pk_bf16_f32 v226, v232, v233
v_mfma_f32_16x16x32_bf16 v[204:207], a[76:79], v[124:127], v[204:207]
s_waitcnt lgkmcnt(6)
ds_read_b128 a[108:111], v1 offset:27648
v_cvt_pk_bf16_f32 v227, v234, v235
v_mfma_f32_16x16x32_bf16 v[212:215], a[80:83], v[120:123], v[212:215]
s_waitcnt lgkmcnt(6)
ds_read_b128 a[112:115], v1 offset:28672
v_cvt_pk_bf16_f32 v240, v240, v241
v_mfma_f32_16x16x32_bf16 v[212:215], a[84:87], v[124:127], v[212:215]
s_waitcnt lgkmcnt(5)
ds_read_b128 a[116:119], v1 offset:29696
v_cvt_pk_bf16_f32 v241, v242, v243
v_mfma_f32_16x16x32_bf16 v[220:223], a[88:91], v[120:123], v[220:223]
s_add_u32 m0, s18, 98304
ds_read_b128 a[120:123], v1 offset:30720
v_cvt_pk_bf16_f32 v242, v248, v249
v_mfma_f32_16x16x32_bf16 v[220:223], a[92:95], v[124:127], v[220:223]
s_waitcnt lgkmcnt(6)
ds_read_b128 a[124:127], v1 offset:31744
v_cvt_pk_bf16_f32 v243, v250, v251
v_mfma_f32_16x16x32_bf16 v[228:231], a[96:99], v[120:123], v[228:231]
s_waitcnt lgkmcnt(6)
buffer_load_dwordx4 v112, s[36:39], s81 offen offset:0 lds
v_mfma_f32_16x16x32_bf16 v[228:231], a[100:103], v[124:127], v[228:231]
s_waitcnt lgkmcnt(5)
buffer_load_dwordx4 v113, s[36:39], s81 offen offset:1024 lds
v_mfma_f32_16x16x32_bf16 v[236:239], a[104:107], v[120:123], v[236:239]
s_waitcnt lgkmcnt(4)
buffer_load_dwordx4 v114, s[36:39], s81 offen offset:2048 lds
v_mfma_f32_16x16x32_bf16 v[236:239], a[108:111], v[124:127], v[236:239]
s_waitcnt lgkmcnt(1)
buffer_load_dwordx4 v115, s[36:39], s81 offen offset:3072 lds
v_mfma_f32_16x16x32_bf16 v[244:247], a[112:115], v[120:123], v[244:247]
s_add_u32 s81, s81, 28672
v_cvt_pk_bf16_f32 v132, v132, v133
v_cvt_pk_bf16_f32 v133, v134, v135
v_mfma_f32_16x16x32_bf16 v[244:247], a[116:119], v[124:127], v[244:247]
s_add_u32 m0, s18, 102400
v_cvt_pk_bf16_f32 v134, v140, v141
v_cvt_pk_bf16_f32 v135, v142, v143
v_mfma_f32_16x16x32_bf16 v[252:255], a[120:123], v[120:123], v[252:255]
s_waitcnt lgkmcnt(0)
buffer_load_dwordx4 v112, s[36:39], s81 offen offset:0 lds
v_mfma_f32_16x16x32_bf16 v[252:255], a[124:127], v[124:127], v[252:255]
buffer_load_dwordx4 v113, s[36:39], s81 offen offset:1024 lds
buffer_load_dwordx4 v114, s[36:39], s81 offen offset:2048 lds
buffer_load_dwordx4 v115, s[36:39], s81 offen offset:3072 lds
s_sub_u32 s81, s81, 28544
s_add_u32 m0, s18, 131072
s_nop 0
buffer_load_dwordx4 v112, s[36:39], s81 offen offset:0 lds
v_cvt_pk_bf16_f32 v148, v148, v149
v_cvt_pk_bf16_f32 v149, v150, v151
v_cvt_pk_bf16_f32 v150, v156, v157
v_cvt_pk_bf16_f32 v151, v158, v159
buffer_load_dwordx4 v113, s[36:39], s81 offen offset:1024 lds
v_cvt_pk_bf16_f32 v164, v164, v165
v_cvt_pk_bf16_f32 v165, v166, v167
v_cvt_pk_bf16_f32 v166, v172, v173
v_cvt_pk_bf16_f32 v167, v174, v175
buffer_load_dwordx4 v114, s[36:39], s81 offen offset:2048 lds
v_cvt_pk_bf16_f32 v180, v180, v181
v_cvt_pk_bf16_f32 v181, v182, v183
v_cvt_pk_bf16_f32 v182, v188, v189
v_cvt_pk_bf16_f32 v183, v190, v191
buffer_load_dwordx4 v115, s[36:39], s81 offen offset:3072 lds
v_cvt_pk_bf16_f32 v196, v196, v197
v_cvt_pk_bf16_f32 v197, v198, v199
v_cvt_pk_bf16_f32 v198, v204, v205
v_cvt_pk_bf16_f32 v199, v206, v207
s_add_u32 s81, s81, 28672
s_add_u32 m0, s18, 135168
s_nop 0
buffer_load_dwordx4 v112, s[36:39], s81 offen offset:0 lds
v_cvt_pk_bf16_f32 v212, v212, v213
v_cvt_pk_bf16_f32 v213, v214, v215
v_cvt_pk_bf16_f32 v214, v220, v221
v_cvt_pk_bf16_f32 v215, v222, v223
buffer_load_dwordx4 v113, s[36:39], s81 offen offset:1024 lds
v_cvt_pk_bf16_f32 v228, v228, v229
v_cvt_pk_bf16_f32 v229, v230, v231
v_cvt_pk_bf16_f32 v230, v236, v237
v_cvt_pk_bf16_f32 v231, v238, v239
buffer_load_dwordx4 v114, s[36:39], s81 offen offset:2048 lds
v_cvt_pk_bf16_f32 v244, v244, v245
v_cvt_pk_bf16_f32 v245, v246, v247
v_cvt_pk_bf16_f32 v246, v252, v253
v_cvt_pk_bf16_f32 v247, v254, v255
buffer_load_dwordx4 v115, s[36:39], s81 offen offset:3072 lds
s_sub_u32 s81, s81, 28544
s_branch K2_done
K2_cfix:
s_nop 7
v_max_f32 v12, 0, v8
v_exp_f32 v13, -v12
v_sub_f32 v8, v8, v12
v_mul_f32 v24, v24, v13
v_mul_f32 v128, v128, v13
v_mul_f32 v129, v129, v13
v_mul_f32 v130, v130, v13
v_mul_f32 v131, v131, v13
v_mul_f32 v136, v136, v13
v_mul_f32 v137, v137, v13
v_mul_f32 v138, v138, v13
v_mul_f32 v139, v139, v13
v_mul_f32 v144, v144, v13
v_mul_f32 v145, v145, v13
v_mul_f32 v146, v146, v13
v_mul_f32 v147, v147, v13
v_mul_f32 v152, v152, v13
v_mul_f32 v153, v153, v13
v_mul_f32 v154, v154, v13
v_mul_f32 v155, v155, v13
v_mul_f32 v160, v160, v13
v_mul_f32 v161, v161, v13
v_mul_f32 v162, v162, v13
v_mul_f32 v163, v163, v13
v_mul_f32 v168, v168, v13
v_mul_f32 v169, v169, v13
v_mul_f32 v170, v170, v13
v_mul_f32 v171, v171, v13
v_mul_f32 v176, v176, v13
v_mul_f32 v177, v177, v13
v_mul_f32 v178, v178, v13
v_mul_f32 v179, v179, v13
v_mul_f32 v184, v184, v13
v_mul_f32 v185, v185, v13
v_mul_f32 v186, v186, v13
v_mul_f32 v187, v187, v13
v_mul_f32 v192, v192, v13
v_mul_f32 v193, v193, v13
v_mul_f32 v194, v194, v13
v_mul_f32 v195, v195, v13
v_mul_f32 v200, v200, v13
v_mul_f32 v201, v201, v13
v_mul_f32 v202, v202, v13
v_mul_f32 v203, v203, v13
v_mul_f32 v208, v208, v13
v_mul_f32 v209, v209, v13
v_mul_f32 v210, v210, v13
v_mul_f32 v211, v211, v13
v_mul_f32 v216, v216, v13
v_mul_f32 v217, v217, v13
v_mul_f32 v218, v218, v13
v_mul_f32 v219, v219, v13
v_mul_f32 v224, v224, v13
v_mul_f32 v225, v225, v13
v_mul_f32 v226, v226, v13
v_mul_f32 v227, v227, v13
v_mul_f32 v232, v232, v13
v_mul_f32 v233, v233, v13
v_mul_f32 v234, v234, v13
v_mul_f32 v235, v235, v13
v_mul_f32 v240, v240, v13
v_mul_f32 v241, v241, v13
v_mul_f32 v242, v242, v13
v_mul_f32 v243, v243, v13
v_mul_f32 v248, v248, v13
v_mul_f32 v249, v249, v13
v_mul_f32 v250, v250, v13
v_mul_f32 v251, v251, v13
v_max_f32 v12, 0, v10
v_exp_f32 v13, -v12
v_sub_f32 v10, v10, v12
v_mul_f32 v25, v25, v13
v_mul_f32 v132, v132, v13
v_mul_f32 v133, v133, v13
v_mul_f32 v134, v134, v13
v_mul_f32 v135, v135, v13
v_mul_f32 v140, v140, v13
v_mul_f32 v141, v141, v13
v_mul_f32 v142, v142, v13
v_mul_f32 v143, v143, v13
v_mul_f32 v148, v148, v13
v_mul_f32 v149, v149, v13
v_mul_f32 v150, v150, v13
v_mul_f32 v151, v151, v13
v_mul_f32 v156, v156, v13
v_mul_f32 v157, v157, v13
v_mul_f32 v158, v158, v13
v_mul_f32 v159, v159, v13
v_mul_f32 v164, v164, v13
v_mul_f32 v165, v165, v13
v_mul_f32 v166, v166, v13
v_mul_f32 v167, v167, v13
v_mul_f32 v172, v172, v13
v_mul_f32 v173, v173, v13
v_mul_f32 v174, v174, v13
v_mul_f32 v175, v175, v13
v_mul_f32 v180, v180, v13
v_mul_f32 v181, v181, v13
v_mul_f32 v182, v182, v13
v_mul_f32 v183, v183, v13
v_mul_f32 v188, v188, v13
v_mul_f32 v189, v189, v13
v_mul_f32 v190, v190, v13
v_mul_f32 v191, v191, v13
v_mul_f32 v196, v196, v13
v_mul_f32 v197, v197, v13
v_mul_f32 v198, v198, v13
v_mul_f32 v199, v199, v13
v_mul_f32 v204, v204, v13
v_mul_f32 v205, v205, v13
v_mul_f32 v206, v206, v13
v_mul_f32 v207, v207, v13
v_mul_f32 v212, v212, v13
v_mul_f32 v213, v213, v13
v_mul_f32 v214, v214, v13
v_mul_f32 v215, v215, v13
v_mul_f32 v220, v220, v13
v_mul_f32 v221, v221, v13
v_mul_f32 v222, v222, v13
v_mul_f32 v223, v223, v13
v_mul_f32 v228, v228, v13
v_mul_f32 v229, v229, v13
v_mul_f32 v230, v230, v13
v_mul_f32 v231, v231, v13
v_mul_f32 v236, v236, v13
v_mul_f32 v237, v237, v13
v_mul_f32 v238, v238, v13
v_mul_f32 v239, v239, v13
v_mul_f32 v244, v244, v13
v_mul_f32 v245, v245, v13
v_mul_f32 v246, v246, v13
v_mul_f32 v247, v247, v13
v_mul_f32 v252, v252, v13
v_mul_f32 v253, v253, v13
v_mul_f32 v254, v254, v13
v_mul_f32 v255, v255, v13
s_branch K2_cok
K2_tspin:
Lp_9101:
buffer_load_dword v3, off, s[4:7], s80 sc1
s_waitcnt vmcnt(0)
v_cmp_gt_u32 vcc, 1, v3
s_cbranch_vccz Lpd_9102
s_sleep 8
s_sub_u32 s101, s101, 1
s_cbranch_scc0 Lp_9101
s_mov_b32 s101, 0
Lpd_9102:
s_branch K2_tok
K2_p0d:
ds_read_b128 a[64:67], v1 offset:0
ds_read_b128 a[68:71], v1 offset:1024
ds_read_b128 a[72:75], v1 offset:2048
ds_read_b128 a[76:79], v1 offset:3072
ds_read_b128 a[80:83], v1 offset:4096
ds_read_b128 a[84:87], v1 offset:5120
ds_read_b128 a[88:91], v1 offset:6144
ds_read_b128 a[92:95], v1 offset:7168
v_cndmask_b32 v32, 0, v7, s[32:33]
v_cndmask_b32 v33, 0, v7, s[34:35]
v_cndmask_b32 v34, 0, v7, s[36:37]
v_cndmask_b32 v35, 0, v7, s[38:39]
v_cndmask_b32 v40, 0, v7, s[40:41]
v_cndmask_b32 v41, 0, v7, s[42:43]
v_cndmask_b32 v42, 0, v7, s[44:45]
v_cndmask_b32 v43, 0, v7, s[46:47]
s_waitcnt lgkmcnt(7)
v_mfma_f32_16x16x32_bf16 v[32:35], a[64:67], a[0:3], v[32:35]
s_waitcnt lgkmcnt(6)
s_add_u32 m0, s18, 65536
ds_read_b128 a[96:99], v1 offset:8192
v_mfma_f32_16x16x32_bf16 v[32:35], a[68:71], a[4:7], v[32:35]
s_waitcnt lgkmcnt(6)
buffer_load_dwordx4 v1, s[4:7], s12 offen offset:0 sc1 lds
v_mfma_f32_16x16x32_bf16 v[32:35], a[72:75], a[8:11], v[32:35]
s_waitcnt lgkmcnt(5)
ds_read_b128 a[100:103], v1 offset:9216
v_mfma_f32_16x16x32_bf16 v[32:35], a[76:79], a[12:15], v[32:35]
s_waitcnt lgkmcnt(5)
buffer_load_dwordx4 v1, s[4:7], s12 offen offset:1024 sc1 lds
v_mfma_f32_16x16x32_bf16 v[32:35], a[80:83], a[16:19], v[32:35]
s_waitcnt lgkmcnt(4)
ds_read_b128 a[104:107], v1 offset:10240
v_mfma_f32_16x16x32_bf16 v[32:35], a[84:87], a[20:23], v[32:35]
s_waitcnt lgkmcnt(4)
buffer_load_dwordx4 v1, s[4:7], s12 offen offset:2048 sc1 lds
v_mfma_f32_16x16x32_bf16 v[32:35], a[88:91], a[24:27], v[32:35]
s_waitcnt lgkmcnt(3)
ds_read_b128 a[108:111], v1 offset:11264
v_mfma_f32_16x16x32_bf16 v[32:35], a[92:95], a[28:31], v[32:35]
buffer_load_dwordx4 v1, s[4:7], s12 offen offset:3072 sc1 lds
v_mfma_f32_16x16x32_bf16 v[36:39], a[64:67], a[32:35], 0
s_add_u32 s12, s12, 4096
s_add_u32 m0, s18, 69632
ds_read_b128 a[112:115], v1 offset:12288
v_mfma_f32_16x16x32_bf16 v[36:39], a[68:71], a[36:39], v[36:39]
buffer_load_dwordx4 v1, s[4:7], s12 offen offset:0 sc1 lds
v_mfma_f32_16x16x32_bf16 v[36:39], a[72:75], a[40:43], v[36:39]
ds_read_b128 a[116:119], v1 offset:13312
v_mfma_f32_16x16x32_bf16 v[36:39], a[76:79], a[44:47], v[36:39]
buffer_load_dwordx4 v1, s[4:7], s12 offen offset:1024 sc1 lds
v_mfma_f32_16x16x32_bf16 v[36:39], a[80:83], a[48:51], v[36:39]
ds_read_b128 a[120:123], v1 offset:14336
v_max3_f32 v28, v32, v33, v34
v_mfma_f32_16x16x32_bf16 v[36:39], a[84:87], a[52:55], v[36:39]
buffer_load_dwordx4 v1, s[4:7], s12 offen offset:2048 sc1 lds
v_mfma_f32_16x16x32_bf16 v[36:39], a[88:91], a[56:59], v[36:39]
ds_read_b128 a[124:127], v1 offset:15360
v_max_f32 v28, v28, v35
v_mfma_f32_16x16x32_bf16 v[36:39], a[92:95], a[60:63], v[36:39]
s_waitcnt lgkmcnt(4)
buffer_load_dwordx4 v1, s[4:7], s12 offen offset:3072 sc1 lds
v_mfma_f32_16x16x32_bf16 v[40:43], a[96:99], a[0:3], v[40:43]
s_add_u32 s12, s12, 28672
ds_read_b128 a[64:67], v1 offset:16384
v_mov_b32 v30, v28
v_mfma_f32_16x16x32_bf16 v[40:43], a[100:103], a[4:7], v[40:43]
s_waitcnt lgkmcnt(2)
s_sub_u32 s13, s13, 1
v_mfma_f32_16x16x32_bf16 v[40:43], a[104:107], a[8:11], v[40:43]
s_cmp_eq_u32 s13, 0
ds_read_b128 a[68:71], v1 offset:17408
v_permlane16_swap_b32 v28, v30
v_mfma_f32_16x16x32_bf16 v[40:43], a[108:111], a[12:15], v[40:43]
s_cselect_b32 s12, s14, s12
v_max_f32 v28, v28, v30
v_mov_b32 v30, v28
v_mfma_f32_16x16x32_bf16 v[40:43], a[112:115], a[16:19], v[40:43]
s_cselect_b32 s13, s15, s13
ds_read_b128 a[72:75], v1 offset:18432
v_max3_f32 v29, v36, v37, v38
v_mfma_f32_16x16x32_bf16 v[40:43], a[116:119], a[20:23], v[40:43]
s_cselect_b32 s14, 3221225472, s14
v_permlane32_swap_b32 v28, v30
v_max_f32 v28, v28, v30
v_mfma_f32_16x16x32_bf16 v[40:43], a[120:123], a[24:27], v[40:43]
s_waitcnt lgkmcnt(3)
ds_read_b128 a[76:79], v1 offset:19456
v_sub_f32 v16, 0, v28
v_mfma_f32_16x16x32_bf16 v[40:43], a[124:127], a[28:31], v[40:43]
v_sub_f32 v17, 0, v28
v_sub_f32 v18, 0, v28
v_mfma_f32_16x16x32_bf16 v[44:47], a[96:99], a[32:35], 0
ds_read_b128 a[80:83], v1 offset:20480
v_sub_f32 v19, 0, v28
v_mfma_f32_16x16x32_bf16 v[44:47], a[100:103], a[36:39], v[44:47]
v_max_f32 v29, v29, v39
v_mov_b32 v31, v29
v_cndmask_b32 v48, v16, v7, s[48:49]
v_mfma_f32_16x16x32_bf16 v[44:47], a[104:107], a[40:43], v[44:47]
ds_read_b128 a[84:87], v1 offset:21504
v_cndmask_b32 v49, v16, v7, s[50:51]
v_mfma_f32_16x16x32_bf16 v[44:47], a[108:111], a[44:47], v[44:47]
v_permlane16_swap_b32 v29, v31
v_max_f32 v29, v29, v31
v_cndmask_b32 v50, v16, v7, s[52:53]
v_mfma_f32_16x16x32_bf16 v[44:47], a[112:115], a[48:51], v[44:47]
ds_read_b128 a[88:91], v1 offset:22528
v_mov_b32 v31, v29
v_cndmask_b32 v51, v16, v7, s[54:55]
v_mfma_f32_16x16x32_bf16 v[44:47], a[116:119], a[52:55], v[44:47]
v_cndmask_b32 v56, v16, v7, s[56:57]
v_cndmask_b32 v57, v16, v7, s[58:59]
v_mfma_f32_16x16x32_bf16 v[44:47], a[120:123], a[56:59], v[44:47]
ds_read_b128 a[92:95], v1 offset:23552
v_permlane32_swap_b32 v29, v31
v_mfma_f32_16x16x32_bf16 v[44:47], a[124:127], a[60:63], v[44:47]
s_waitcnt lgkmcnt(4)
v_max_f32 v29, v29, v31
v_sub_f32 v20, 0, v29
v_mfma_f32_16x16x32_bf16 v[48:51], a[64:67], a[0:3], v[48:51]
ds_read_b128 a[96:99], v1 offset:24576
v_sub_f32 v21, 0, v29
v_mfma_f32_16x16x32_bf16 v[48:51], a[68:71], a[4:7], v[48:51]
v_sub_f32 v22, 0, v29
v_sub_f32 v23, 0, v29
v_mfma_f32_16x16x32_bf16 v[48:51], a[72:75], a[8:11], v[48:51]
ds_read_b128 a[100:103], v1 offset:25600
v_cndmask_b32 v58, v16, v7, s[60:61]
v_mfma_f32_16x16x32_bf16 v[48:51], a[76:79], a[12:15], v[48:51]
s_waitcnt lgkmcnt(4)
v_cndmask_b32 v59, v16, v7, s[62:63]
v_mfma_f32_16x16x32_bf16 v[48:51], a[80:83], a[16:19], v[48:51]
ds_read_b128 a[104:107], v1 offset:26624
v_mfma_f32_16x16x32_bf16 v[48:51], a[84:87], a[20:23], v[48:51]
s_waitcnt lgkmcnt(4)
v_add_f32 v32, v32, v16
v_add_f32 v33, v33, v16
v_add_f32 v34, v34, v16
v_add_f32 v35, v35, v16
v_mfma_f32_16x16x32_bf16 v[48:51], a[88:91], a[24:27], v[48:51]
s_waitcnt lgkmcnt(3)
ds_read_b128 a[108:111], v1 offset:27648
v_add_f32 v36, v36, v20
v_add_f32 v37, v37, v20
v_add_f32 v38, v38, v20
v_add_f32 v39, v39, v20
v_mfma_f32_16x16x32_bf16 v[48:51], a[92:95], a[28:31], v[48:51]
v_add_f32 v40, v40, v16
v_add_f32 v41, v41, v16
v_add_f32 v42, v42, v16
v_add_f32 v43, v43, v16
v_mfma_f32_16x16x32_bf16 v[52:55], a[64:67], a[32:35], v[20:23]
ds_read_b128 a[112:115], v1 offset:28672
v_add_f32 v44, v44, v20
v_add_f32 v45, v45, v20
v_add_f32 v46, v46, v20
v_add_f32 v47, v47, v20
v_mfma_f32_16x16x32_bf16 v[52:55], a[68:71], a[36:39], v[52:55]
v_exp_f32 v8, v32
v_mfma_f32_16x16x32_bf16 v[52:55], a[72:75], a[40:43], v[52:55]
ds_read_b128 a[116:119], v1 offset:29696
v_exp_f32 v9, v33
v_mfma_f32_16x16x32_bf16 v[52:55], a[76:79], a[44:47], v[52:55]
v_exp_f32 v10, v34
v_add_f32 v26, v8, v9
v_cvt_pk_bf16_f32 v96, v8, v9
v_mfma_f32_16x16x32_bf16 v[52:55], a[80:83], a[48:51], v[52:55]
ds_read_b128 a[120:123], v1 offset:30720
v_exp_f32 v11, v35
v_add_f32 v26, v26, v10
v_mfma_f32_16x16x32_bf16 v[52:55], a[84:87], a[52:55], v[52:55]
v_exp_f32 v12, v36
v_add_f32 v26, v26, v11
v_cvt_pk_bf16_f32 v97, v10, v11
v_mfma_f32_16x16x32_bf16 v[52:55], a[88:91], a[56:59], v[52:55]
s_waitcnt vmcnt(8) lgkmcnt(4)
ds_read_b128 a[124:127], v1 offset:31744
v_exp_f32 v13, v37
v_mfma_f32_16x16x32_bf16 v[52:55], a[92:95], a[60:63], v[52:55]
s_barrier
v_mfma_f32_16x16x32_bf16 v[56:59], a[96:99], a[0:3], v[56:59]
ds_read_b128 a[64:67], v4 offset:0
v_exp_f32 v14, v38
v_mfma_f32_16x16x32_bf16 v[56:59], a[100:103], a[4:7], v[56:59]
buffer_store_dword v6, v5, s[4:7], s71 offen sc1
v_mfma_f32_16x16x32_bf16 v[56:59], a[104:107], a[8:11], v[56:59]
s_waitcnt lgkmcnt(4)
ds_read_b128 a[68:71], v4 offset:1024
v_add_f32 v27, v12, v13
v_cvt_pk_bf16_f32 v104, v12, v13
v_add_f32 v27, v27, v14
v_mfma_f32_16x16x32_bf16 v[56:59], a[108:111], a[12:15], v[56:59]
v_exp_f32 v15, v39
v_mfma_f32_16x16x32_bf16 v[56:59], a[112:115], a[16:19], v[56:59]
s_waitcnt lgkmcnt(4)
ds_read_b128 a[72:75], v4 offset:2048
v_exp_f32 v8, v40
v_add_f32 v27, v27, v15
v_cvt_pk_bf16_f32 v105, v14, v15
v_mfma_f32_16x16x32_bf16 v[56:59], a[116:119], a[20:23], v[56:59]
s_waitcnt lgkmcnt(4)
v_exp_f32 v9, v41
v_add_f32 v26, v26, v8
v_mfma_f32_16x16x32_bf16 v[56:59], a[120:123], a[24:27], v[56:59]
s_waitcnt lgkmcnt(3)
ds_read_b128 a[76:79], v4 offset:3072
v_exp_f32 v10, v42
v_add_f32 v26, v26, v9
v_cvt_pk_bf16_f32 v98, v8, v9
v_mfma_f32_16x16x32_bf16 v[56:59], a[124:127], a[28:31], v[56:59]
v_exp_f32 v11, v43
v_add_f32 v26, v26, v10
v_mfma_f32_16x16x32_bf16 v[60:63], a[96:99], a[32:35], v[20:23]
ds_read_b128 a[80:83], v4 offset:4096
v_exp_f32 v12, v44
v_mfma_f32_16x16x32_bf16 v[60:63], a[100:103], a[36:39], v[60:63]
v_exp_f32 v13, v45
v_mfma_f32_16x16x32_bf16 v[60:63], a[104:107], a[40:43], v[60:63]
ds_read_b128 a[84:87], v4 offset:5120
v_exp_f32 v14, v46
v_mfma_f32_16x16x32_bf16 v[60:63], a[108:111], a[44:47], v[60:63]
v_exp_f32 v15, v47
v_mfma_f32_16x16x32_bf16 v[60:63], a[112:115], a[48:51], v[60:63]
ds_read_b128 a[88:91], v4 offset:6144
v_add_f32 v26, v26, v11
v_cvt_pk_bf16_f32 v99, v10, v11
v_mfma_f32_16x16x32_bf16 v[60:63], a[116:119], a[52:55], v[60:63]
v_add_f32 v27, v27, v12
v_add_f32 v27, v27, v13
v_cvt_pk_bf16_f32 v106, v12, v13
v_mfma_f32_16x16x32_bf16 v[60:63], a[120:123], a[56:59], v[60:63]
s_waitcnt lgkmcnt(7)
s_barrier
ds_read_b128 a[92:95], v4 offset:7168
v_mfma_f32_16x16x32_bf16 v[60:63], a[124:127], a[60:63], v[60:63]
s_waitcnt lgkmcnt(4)
v_add_f32 v27, v27, v14
v_add_f32 v27, v27, v15
v_cvt_pk_bf16_f32 v107, v14, v15
s_branch K2_dx1
PAD_33:
s_cbranch_execz M_tret
K2_ntail:
v_mfma_f32_16x16x32_bf16 v[128:131], a[64:67], v[96:99], v[128:131]
s_add_u32 m0, s18, 98304
ds_read_b128 a[96:99], v2 offset:8192
v_add_f32 v24, v24, v26
v_mfma_f32_16x16x32_bf16 v[128:131], a[68:71], v[100:103], v[128:131]
buffer_load_dwordx4 v1, s[4:7], s12 offen offset:0 sc1 lds
v_mfma_f32_16x16x32_bf16 v[132:135], a[68:71], v[108:111], v[132:135]
ds_read_b128 a[100:103], v2 offset:9216
v_add_f32 v25, v25, v27
v_mfma_f32_16x16x32_bf16 v[132:135], a[64:67], v[104:107], v[132:135]
buffer_load_dwordx4 v1, s[4:7], s12 offen offset:1024 sc1 lds
v_mfma_f32_16x16x32_bf16 v[136:139], a[72:75], v[96:99], v[136:139]
ds_read_b128 a[104:107], v2 offset:10240
v_exp_f32 v8, v64
v_mfma_f32_16x16x32_bf16 v[136:139], a[76:79], v[100:103], v[136:139]
buffer_load_dwordx4 v1, s[4:7], s12 offen offset:2048 sc1 lds
v_mfma_f32_16x16x32_bf16 v[140:143], a[76:79], v[108:111], v[140:143]
ds_read_b128 a[108:111], v2 offset:11264
v_mfma_f32_16x16x32_bf16 v[140:143], a[72:75], v[104:107], v[140:143]
s_waitcnt lgkmcnt(4)
buffer_load_dwordx4 v1, s[4:7], s12 offen offset:3072 sc1 lds
v_mfma_f32_16x16x32_bf16 v[144:147], a[80:83], v[96:99], v[144:147]
s_add_u32 s12, s12, 4096
s_add_u32 m0, s18, 102400
ds_read_b128 a[112:115], v2 offset:12288
v_mfma_f32_16x16x32_bf16 v[144:147], a[84:87], v[100:103], v[144:147]
buffer_load_dwordx4 v1, s[4:7], s12 offen offset:0 sc1 lds
v_mfma_f32_16x16x32_bf16 v[148:151], a[84:87], v[108:111], v[148:151]
ds_read_b128 a[116:119], v2 offset:13312
v_exp_f32 v9, v65
v_mfma_f32_16x16x32_bf16 v[148:151], a[80:83], v[104:107], v[148:151]
buffer_load_dwordx4 v1, s[4:7], s12 offen offset:1024 sc1 lds
v_mfma_f32_16x16x32_bf16 v[152:155], a[88:91], v[96:99], v[152:155]
ds_read_b128 a[120:123], v2 offset:14336
v_add_f32 v26, v8, v9
v_cvt_pk_bf16_f32 v112, v8, v9
v_mfma_f32_16x16x32_bf16 v[152:155], a[92:95], v[100:103], v[152:155]
buffer_load_dwordx4 v1, s[4:7], s12 offen offset:2048 sc1 lds
v_mfma_f32_16x16x32_bf16 v[156:159], a[92:95], v[108:111], v[156:159]
ds_read_b128 a[124:127], v2 offset:15360
v_exp_f32 v10, v66
v_mfma_f32_16x16x32_bf16 v[156:159], a[88:91], v[104:107], v[156:159]
s_waitcnt lgkmcnt(4)
buffer_load_dwordx4 v1, s[4:7], s12 offen offset:3072 sc1 lds
v_mfma_f32_16x16x32_bf16 v[160:163], a[96:99], v[96:99], v[160:163]
s_add_u32 s12, s12, 28672
ds_read_b128 a[64:67], v2 offset:16384
v_add_f32 v26, v26, v10
v_mfma_f32_16x16x32_bf16 v[160:163], a[100:103], v[100:103], v[160:163]
s_sub_u32 s13, s13, 1
v_exp_f32 v11, v67
v_mfma_f32_16x16x32_bf16 v[164:167], a[100:103], v[108:111], v[164:167]
s_cmp_eq_u32 s13, 0
ds_read_b128 a[68:71], v2 offset:17408
v_exp_f32 v12, v68
v_mfma_f32_16x16x32_bf16 v[164:167], a[96:99], v[104:107], v[164:167]
s_cselect_b32 s12, s14, s12
v_exp_f32 v13, v69
v_mfma_f32_16x16x32_bf16 v[168:171], a[104:107], v[96:99], v[168:171]
s_cselect_b32 s13, s15, s13
ds_read_b128 a[72:75], v2 offset:18432
v_add_f32 v26, v26, v11
v_cvt_pk_bf16_f32 v113, v10, v11
v_mfma_f32_16x16x32_bf16 v[168:171], a[108:111], v[100:103], v[168:171]
s_cselect_b32 s14, 3221225472, s14
v_exp_f32 v14, v70
v_mfma_f32_16x16x32_bf16 v[172:175], a[108:111], v[108:111], v[172:175]
ds_read_b128 a[76:79], v2 offset:19456
v_exp_f32 v15, v71
v_mfma_f32_16x16x32_bf16 v[172:175], a[104:107], v[104:107], v[172:175]
s_waitcnt lgkmcnt(4)
v_exp_f32 v8, v72
v_mfma_f32_16x16x32_bf16 v[176:179], a[112:115], v[96:99], v[176:179]
ds_read_b128 a[80:83], v2 offset:20480
v_add_f32 v27, v12, v13
v_cvt_pk_bf16_f32 v120, v12, v13
v_add_f32 v27, v27, v14
v_add_f32 v27, v27, v15
v_cvt_pk_bf16_f32 v121, v14, v15
v_mfma_f32_16x16x32_bf16 v[176:179], a[116:119], v[100:103], v[176:179]
v_exp_f32 v9, v73
v_mfma_f32_16x16x32_bf16 v[180:183], a[116:119], v[108:111], v[180:183]
ds_read_b128 a[84:87], v2 offset:21504
v_exp_f32 v10, v74
v_mfma_f32_16x16x32_bf16 v[180:183], a[112:115], v[104:107], v[180:183]
v_exp_f32 v11, v75
v_mfma_f32_16x16x32_bf16 v[184:187], a[120:123], v[96:99], v[184:187]
ds_read_b128 a[88:91], v2 offset:22528
v_add_f32 v26, v26, v8
v_mfma_f32_16x16x32_bf16 v[184:187], a[124:127], v[100:103], v[184:187]
v_exp_f32 v12, v76
v_mfma_f32_16x16x32_bf16 v[188:191], a[124:127], v[108:111], v[188:191]
ds_read_b128 a[92:95], v2 offset:23552
v_add_f32 v26, v26, v9
v_cvt_pk_bf16_f32 v114, v8, v9
v_add_f32 v26, v26, v10
v_add_f32 v26, v26, v11
v_cvt_pk_bf16_f32 v115, v10, v11
v_mfma_f32_16x16x32_bf16 v[188:191], a[120:123], v[104:107], v[188:191]
s_waitcnt lgkmcnt(4)
v_exp_f32 v13, v77
v_mfma_f32_16x16x32_bf16 v[192:195], a[64:67], v[96:99], v[192:195]
ds_read_b128 a[96:99], v2 offset:24576
v_exp_f32 v14, v78
v_mfma_f32_16x16x32_bf16 v[192:195], a[68:71], v[100:103], v[192:195]
v_exp_f32 v15, v79
v_mfma_f32_16x16x32_bf16 v[196:199], a[68:71], v[108:111], v[196:199]
ds_read_b128 a[100:103], v2 offset:25600
v_add_f32 v27, v27, v12
v_add_f32 v27, v27, v13
v_cvt_pk_bf16_f32 v122, v12, v13
v_add_f32 v27, v27, v14
v_mfma_f32_16x16x32_bf16 v[196:199], a[64:67], v[104:107], v[196:199]
v_exp_f32 v8, v80
v_mfma_f32_16x16x32_bf16 v[200:203], a[72:75], v[96:99], v[200:203]
ds_read_b128 a[104:107], v2 offset:26624
v_exp_f32 v9, v81
v_mfma_f32_16x16x32_bf16 v[200:203], a[76:79], v[100:103], v[200:203]
v_exp_f32 v10, v82
v_mfma_f32_16x16x32_bf16 v[204:207], a[76:79], v[108:111], v[204:207]
ds_read_b128 a[108:111], v2 offset:27648
v_add_f32 v27, v27, v15
v_cvt_pk_bf16_f32 v123, v14, v15
v_add_f32 v26, v26, v8
v_add_f32 v26, v26, v9
v_cvt_pk_bf16_f32 v116, v8, v9
v_mfma_f32_16x16x32_bf16 v[204:207], a[72:75], v[104:107], v[204:207]
s_waitcnt lgkmcnt(4)
v_exp_f32 v11, v83
v_mfma_f32_16x16x32_bf16 v[208:211], a[80:83], v[96:99], v[208:211]
ds_read_b128 a[112:115], v2 offset:28672
v_exp_f32 v12, v84
v_mfma_f32_16x16x32_bf16 v[208:211], a[84:87], v[100:103], v[208:211]
v_exp_f32 v13, v85
v_mfma_f32_16x16x32_bf16 v[212:215], a[84:87], v[108:111], v[212:215]
ds_read_b128 a[116:119], v2 offset:29696
v_add_f32 v26, v26, v10
v_add_f32 v26, v26, v11
v_cvt_pk_bf16_f32 v117, v10, v11
v_add_f32 v27, v27, v12
v_mfma_f32_16x16x32_bf16 v[212:215], a[80:83], v[104:107], v[212:215]
v_exp_f32 v14, v86
v_mfma_f32_16x16x32_bf16 v[216:219], a[88:91], v[96:99], v[216:219]
ds_read_b128 a[120:123], v2 offset:30720
v_exp_f32 v15, v87
v_mfma_f32_16x16x32_bf16 v[216:219], a[92:95], v[100:103], v[216:219]
v_exp_f32 v8, v88
v_mfma_f32_16x16x32_bf16 v[220:223], a[92:95], v[108:111], v[220:223]
s_waitcnt vmcnt(0) lgkmcnt(4)
ds_read_b128 a[124:127], v2 offset:31744
v_add_f32 v27, v27, v13
v_cvt_pk_bf16_f32 v124, v12, v13
v_add_f32 v27, v27, v14
v_add_f32 v27, v27, v15
v_cvt_pk_bf16_f32 v125, v14, v15
v_mfma_f32_16x16x32_bf16 v[220:223], a[88:91], v[104:107], v[220:223]
s_barrier
v_mfma_f32_16x16x32_bf16 v[224:227], a[96:99], v[96:99], v[224:227]
ds_read_b128 a[64:67], v2 offset:32768
v_exp_f32 v9, v89
v_mfma_f32_16x16x32_bf16 v[224:227], a[100:103], v[100:103], v[224:227]
v_exp_f32 v10, v90
v_mfma_f32_16x16x32_bf16 v[228:231], a[100:103], v[108:111], v[228:231]
ds_read_b128 a[68:71], v2 offset:33792
v_add_f32 v26, v26, v8
v_add_f32 v26, v26, v9
v_cvt_pk_bf16_f32 v118, v8, v9
v_mfma_f32_16x16x32_bf16 v[228:231], a[96:99], v[104:107], v[228:231]
v_exp_f32 v11, v91
v_mfma_f32_16x16x32_bf16 v[232:235], a[104:107], v[96:99], v[232:235]
s_waitcnt lgkmcnt(4)
ds_read_b128 a[72:75], v2 offset:34816
v_exp_f32 v12, v92
v_mfma_f32_16x16x32_bf16 v[232:235], a[108:111], v[100:103], v[232:235]
v_exp_f32 v13, v93
v_mfma_f32_16x16x32_bf16 v[236:239], a[108:111], v[108:111], v[236:239]
ds_read_b128 a[76:79], v2 offset:35840
v_add_f32 v26, v26, v10
v_mfma_f32_16x16x32_bf16 v[236:239], a[104:107], v[104:107], v[236:239]
v_exp_f32 v14, v94
v_mfma_f32_16x16x32_bf16 v[240:243], a[112:115], v[96:99], v[240:243]
ds_read_b128 a[80:83], v2 offset:36864
v_add_f32 v26, v26, v11
v_cvt_pk_bf16_f32 v119, v10, v11
v_add_f32 v27, v27, v12
v_mfma_f32_16x16x32_bf16 v[240:243], a[116:119], v[100:103], v[240:243]
v_exp_f32 v15, v95
v_mfma_f32_16x16x32_bf16 v[244:247], a[116:119], v[108:111], v[244:247]
ds_read_b128 a[84:87], v2 offset:37888
v_add_f32 v27, v27, v13
v_cvt_pk_bf16_f32 v126, v12, v13
v_mfma_f32_16x16x32_bf16 v[244:247], a[112:115], v[104:107], v[244:247]
s_waitcnt lgkmcnt(4)
v_add_f32 v27, v27, v14
v_add_f32 v27, v27, v15
v_mfma_f32_16x16x32_bf16 v[248:251], a[120:123], v[96:99], v[248:251]
ds_read_b128 a[88:91], v2 offset:38912
v_cvt_pk_bf16_f32 v127, v14, v15
v_mfma_f32_16x16x32_bf16 v[248:251], a[124:127], v[100:103], v[248:251]
v_add_f32 v28, v26, v27
v_cmp_nge_f32 vcc, s25, v28
v_mfma_f32_16x16x32_bf16 v[252:255], a[124:127], v[108:111], v[252:255]
ds_read_b128 a[92:95], v2 offset:39936
v_mfma_f32_16x16x32_bf16 v[252:255], a[120:123], v[104:107], v[252:255]
s_cbranch_vccnz Lstub_14
Lback_15:
v_mfma_f32_16x16x32_bf16 v[128:131], a[64:67], v[112:115], v[128:131]
s_add_u32 m0, s18, 131072
ds_read_b128 a[96:99], v2 offset:40960
v_add_f32 v24, v24, v26
v_mfma_f32_16x16x32_bf16 v[128:131], a[68:71], v[116:119], v[128:131]
buffer_load_dwordx4 v1, s[4:7], s8 offen offset:0 sc1 lds
v_mfma_f32_16x16x32_bf16 v[132:135], a[68:71], v[124:127], v[132:135]
ds_read_b128 a[100:103], v2 offset:41984
v_add_f32 v25, v25, v27
v_mfma_f32_16x16x32_bf16 v[132:135], a[64:67], v[120:123], v[132:135]
s_waitcnt lgkmcnt(4)
buffer_load_dwordx4 v1, s[4:7], s8 offen offset:1024 sc1 lds
v_mfma_f32_16x16x32_bf16 v[136:139], a[72:75], v[112:115], v[136:139]
ds_read_b128 a[104:107], v2 offset:43008
v_mov_b32 v8, v16
v_mfma_f32_16x16x32_bf16 v[136:139], a[76:79], v[116:119], v[136:139]
buffer_load_dwordx4 v1, s[4:7], s8 offen offset:2048 sc1 lds
v_mfma_f32_16x16x32_bf16 v[140:143], a[76:79], v[124:127], v[140:143]
ds_read_b128 a[108:111], v2 offset:44032
v_mov_b32 v9, v24
v_mfma_f32_16x16x32_bf16 v[140:143], a[72:75], v[120:123], v[140:143]
buffer_load_dwordx4 v1, s[4:7], s8 offen offset:3072 sc1 lds
v_mfma_f32_16x16x32_bf16 v[144:147], a[80:83], v[112:115], v[144:147]
s_add_u32 s8, s8, 4096
s_add_u32 m0, s18, 135168
ds_read_b128 a[112:115], v2 offset:45056
v_mfma_f32_16x16x32_bf16 v[144:147], a[84:87], v[116:119], v[144:147]
buffer_load_dwordx4 v1, s[4:7], s8 offen offset:0 sc1 lds
v_mfma_f32_16x16x32_bf16 v[148:151], a[84:87], v[124:127], v[148:151]
ds_read_b128 a[116:119], v2 offset:46080
v_mov_b32 v10, v20
v_mfma_f32_16x16x32_bf16 v[148:151], a[80:83], v[120:123], v[148:151]
s_waitcnt lgkmcnt(4)
buffer_load_dwordx4 v1, s[4:7], s8 offen offset:1024 sc1 lds
v_mfma_f32_16x16x32_bf16 v[152:155], a[88:91], v[112:115], v[152:155]
ds_read_b128 a[120:123], v2 offset:47104
v_mov_b32 v11, v25
v_mfma_f32_16x16x32_bf16 v[152:155], a[92:95], v[116:119], v[152:155]
buffer_load_dwordx4 v1, s[4:7], s8 offen offset:2048 sc1 lds
v_mfma_f32_16x16x32_bf16 v[156:159], a[92:95], v[124:127], v[156:159]
ds_read_b128 a[124:127], v2 offset:48128
v_cvt_pk_bf16_f32 v128, v128, v129
v_mfma_f32_16x16x32_bf16 v[156:159], a[88:91], v[120:123], v[156:159]
s_waitcnt lgkmcnt(4)
buffer_load_dwordx4 v1, s[4:7], s8 offen offset:3072 sc1 lds
v_mfma_f32_16x16x32_bf16 v[160:163], a[96:99], v[112:115], v[160:163]
s_add_u32 s8, s8, 28672
ds_read_b128 a[64:67], v2 offset:49152
v_cvt_pk_bf16_f32 v129, v130, v131
v_mfma_f32_16x16x32_bf16 v[160:163], a[100:103], v[116:119], v[160:163]
s_sub_u32 s9, s9, 1
buffer_store_dwordx4 v[8:11], v1, s[4:7], s27 offen sc1
v_mfma_f32_16x16x32_bf16 v[164:167], a[100:103], v[124:127], v[164:167]
s_cmp_eq_u32 s9, 0
ds_read_b128 a[68:71], v2 offset:50176
v_cvt_pk_bf16_f32 v130, v136, v137
v_mfma_f32_16x16x32_bf16 v[164:167], a[96:99], v[120:123], v[164:167]
s_cselect_b32 s8, s10, s8
v_cvt_pk_bf16_f32 v131, v138, v139
v_accvgpr_mov_b32 a0, a192
v_mfma_f32_16x16x32_bf16 v[168:171], a[104:107], v[112:115], v[168:171]
s_cselect_b32 s9, s11, s9
ds_read_b128 a[72:75], v2 offset:51200
v_accvgpr_mov_b32 a1, a193
v_mfma_f32_16x16x32_bf16 v[168:171], a[108:111], v[116:119], v[168:171]
s_cselect_b32 s10, 3221225472, s10
buffer_store_dwordx4 v[128:131], v1, s[4:7], s76 offen offset:0 sc1
v_mfma_f32_16x16x32_bf16 v[172:175], a[108:111], v[124:127], v[172:175]
ds_read_b128 a[76:79], v2 offset:52224
v_cvt_pk_bf16_f32 v132, v132, v133
v_mfma_f32_16x16x32_bf16 v[172:175], a[104:107], v[120:123], v[172:175]
s_waitcnt lgkmcnt(4)
v_cvt_pk_bf16_f32 v133, v134, v135
v_cvt_pk_bf16_f32 v134, v140, v141
v_mfma_f32_16x16x32_bf16 v[176:179], a[112:115], v[112:115], v[176:179]
ds_read_b128 a[80:83], v2 offset:53248
v_cvt_pk_bf16_f32 v135, v142, v143
v_mfma_f32_16x16x32_bf16 v[176:179], a[116:119], v[116:119], v[176:179]
buffer_store_dwordx4 v[132:135], v1, s[4:7], s77 offen offset:0 sc1
v_mfma_f32_16x16x32_bf16 v[180:183], a[116:119], v[124:127], v[180:183]
ds_read_b128 a[84:87], v2 offset:54272
v_cvt_pk_bf16_f32 v144, v144, v145
v_mfma_f32_16x16x32_bf16 v[180:183], a[112:115], v[120:123], v[180:183]
v_cvt_pk_bf16_f32 v145, v146, v147
v_cvt_pk_bf16_f32 v146, v152, v153
v_mfma_f32_16x16x32_bf16 v[184:187], a[120:123], v[112:115], v[184:187]
ds_read_b128 a[88:91], v2 offset:55296
v_cvt_pk_bf16_f32 v147, v154, v155
v_mfma_f32_16x16x32_bf16 v[184:187], a[124:127], v[116:119], v[184:187]
buffer_store_dwordx4 v[144:147], v1, s[4:7], s76 offen offset:1024 sc1
v_mfma_f32_16x16x32_bf16 v[188:191], a[124:127], v[124:127], v[188:191]
ds_read_b128 a[92:95], v2 offset:56320
v_cvt_pk_bf16_f32 v148, v148, v149
v_mfma_f32_16x16x32_bf16 v[188:191], a[120:123], v[120:123], v[188:191]
s_waitcnt lgkmcnt(4)
v_cvt_pk_bf16_f32 v149, v150, v151
v_cvt_pk_bf16_f32 v150, v156, v157
v_mfma_f32_16x16x32_bf16 v[192:195], a[64:67], v[112:115], v[192:195]
ds_read_b128 a[96:99], v2 offset:57344
v_cvt_pk_bf16_f32 v151, v158, v159
v_mfma_f32_16x16x32_bf16 v[192:195], a[68:71], v[116:119], v[192:195]
buffer_store_dwordx4 v[148:151], v1, s[4:7], s77 offen offset:1024 sc1
v_mfma_f32_16x16x32_bf16 v[196:199], a[68:71], v[124:127], v[196:199]
ds_read_b128 a[100:103], v2 offset:58368
v_cvt_pk_bf16_f32 v160, v160, v161
v_mfma_f32_16x16x32_bf16 v[196:199], a[64:67], v[120:123], v[196:199]
v_cvt_pk_bf16_f32 v161, v162, v163
v_cvt_pk_bf16_f32 v162, v168, v169
v_mfma_f32_16x16x32_bf16 v[200:203], a[72:75], v[112:115], v[200:203]
ds_read_b128 a[104:107], v2 offset:59392
v_cvt_pk_bf16_f32 v163, v170, v171
v_mfma_f32_16x16x32_bf16 v[200:203], a[76:79], v[116:119], v[200:203]
buffer_store_dwordx4 v[160:163], v1, s[4:7], s76 offen offset:2048 sc1
v_mfma_f32_16x16x32_bf16 v[204:207], a[76:79], v[124:127], v[204:207]
ds_read_b128 a[108:111], v2 offset:60416
v_cvt_pk_bf16_f32 v164, v164, v165
v_mfma_f32_16x16x32_bf16 v[204:207], a[72:75], v[120:123], v[204:207]
s_waitcnt lgkmcnt(4)
v_cvt_pk_bf16_f32 v165, v166, v167
v_cvt_pk_bf16_f32 v166, v172, v173
v_mfma_f32_16x16x32_bf16 v[208:211], a[80:83], v[112:115], v[208:211]
ds_read_b128 a[112:115], v2 offset:61440
v_cvt_pk_bf16_f32 v167, v174, v175
v_mfma_f32_16x16x32_bf16 v[208:211], a[84:87], v[116:119], v[208:211]
buffer_store_dwordx4 v[164:167], v1, s[4:7], s77 offen offset:2048 sc1
v_mfma_f32_16x16x32_bf16 v[212:215], a[84:87], v[124:127], v[212:215]
ds_read_b128 a[116:119], v2 offset:62464
v_cvt_pk_bf16_f32 v176, v176, v177
v_mfma_f32_16x16x32_bf16 v[212:215], a[80:83], v[120:123], v[212:215]
v_cvt_pk_bf16_f32 v177, v178, v179
v_cvt_pk_bf16_f32 v178, v184, v185
v_mfma_f32_16x16x32_bf16 v[216:219], a[88:91], v[112:115], v[216:219]
ds_read_b128 a[120:123], v2 offset:63488
v_cvt_pk_bf16_f32 v179, v186, v187
v_mfma_f32_16x16x32_bf16 v[216:219], a[92:95], v[116:119], v[216:219]
buffer_store_dwordx4 v[176:179], v1, s[4:7], s76 offen offset:3072 sc1
v_mfma_f32_16x16x32_bf16 v[220:223], a[92:95], v[124:127], v[220:223]
ds_read_b128 a[124:127], v2 offset:64512
v_cvt_pk_bf16_f32 v180, v180, v181
v_mfma_f32_16x16x32_bf16 v[220:223], a[88:91], v[120:123], v[220:223]
s_waitcnt lgkmcnt(4)
v_cvt_pk_bf16_f32 v181, v182, v183
v_cvt_pk_bf16_f32 v182, v188, v189
v_mfma_f32_16x16x32_bf16 v[224:227], a[96:99], v[112:115], v[224:227]
v_cvt_pk_bf16_f32 v183, v190, v191
v_accvgpr_mov_b32 a2, a194
v_mfma_f32_16x16x32_bf16 v[224:227], a[100:103], v[116:119], v[224:227]
buffer_store_dwordx4 v[180:183], v1, s[4:7], s77 offen offset:3072 sc1
v_mfma_f32_16x16x32_bf16 v[228:231], a[100:103], v[124:127], v[228:231]
s_add_u32 s76, s76, 4096
v_accvgpr_mov_b32 a3, a195
v_accvgpr_mov_b32 a4, a196
v_mfma_f32_16x16x32_bf16 v[228:231], a[96:99], v[120:123], v[228:231]
s_add_u32 s77, s77, 4096
v_cvt_pk_bf16_f32 v192, v192, v193
v_cvt_pk_bf16_f32 v193, v194, v195
v_mfma_f32_16x16x32_bf16 v[232:235], a[104:107], v[112:115], v[232:235]
v_cvt_pk_bf16_f32 v194, v200, v201
v_cvt_pk_bf16_f32 v195, v202, v203
v_mfma_f32_16x16x32_bf16 v[232:235], a[108:111], v[116:119], v[232:235]
PAD_34:
s_cbranch_execz M_tret
buffer_store_dwordx4 v[192:195], v1, s[4:7], s76 offen offset:0 sc1
v_mfma_f32_16x16x32_bf16 v[236:239], a[108:111], v[124:127], v[236:239]
v_cvt_pk_bf16_f32 v196, v196, v197
v_cvt_pk_bf16_f32 v197, v198, v199
v_mfma_f32_16x16x32_bf16 v[236:239], a[104:107], v[120:123], v[236:239]
s_waitcnt lgkmcnt(0)
v_cvt_pk_bf16_f32 v198, v204, v205
v_cvt_pk_bf16_f32 v199, v206, v207
v_mfma_f32_16x16x32_bf16 v[240:243], a[112:115], v[112:115], v[240:243]
buffer_store_dwordx4 v[196:199], v1, s[4:7], s77 offen offset:0 sc1
v_mfma_f32_16x16x32_bf16 v[240:243], a[116:119], v[116:119], v[240:243]
v_cvt_pk_bf16_f32 v208, v208, v209
v_cvt_pk_bf16_f32 v209, v210, v211
v_mfma_f32_16x16x32_bf16 v[244:247], a[116:119], v[124:127], v[244:247]
v_cvt_pk_bf16_f32 v210, v216, v217
v_cvt_pk_bf16_f32 v211, v218, v219
v_mfma_f32_16x16x32_bf16 v[244:247], a[112:115], v[120:123], v[244:247]
buffer_store_dwordx4 v[208:211], v1, s[4:7], s76 offen offset:1024 sc1
v_mfma_f32_16x16x32_bf16 v[248:251], a[120:123], v[112:115], v[248:251]
v_cvt_pk_bf16_f32 v212, v212, v213
v_cvt_pk_bf16_f32 v213, v214, v215
v_mfma_f32_16x16x32_bf16 v[248:251], a[124:127], v[116:119], v[248:251]
v_cvt_pk_bf16_f32 v214, v220, v221
v_cvt_pk_bf16_f32 v215, v222, v223
v_mfma_f32_16x16x32_bf16 v[252:255], a[124:127], v[124:127], v[252:255]
buffer_store_dwordx4 v[212:215], v1, s[4:7], s77 offen offset:1024 sc1
v_mfma_f32_16x16x32_bf16 v[252:255], a[120:123], v[120:123], v[252:255]
v_cvt_pk_bf16_f32 v224, v224, v225
v_cvt_pk_bf16_f32 v225, v226, v227
v_accvgpr_mov_b32 a5, a197
v_accvgpr_mov_b32 a6, a198
v_accvgpr_mov_b32 a7, a199
v_accvgpr_mov_b32 a8, a200
v_accvgpr_mov_b32 a9, a201
v_accvgpr_mov_b32 a10, a202
v_accvgpr_mov_b32 a11, a203
v_accvgpr_mov_b32 a12, a204
v_cvt_pk_bf16_f32 v226, v232, v233
v_cvt_pk_bf16_f32 v227, v234, v235
buffer_store_dwordx4 v[224:227], v1, s[4:7], s76 offen offset:2048 sc1
v_cvt_pk_bf16_f32 v228, v228, v229
v_cvt_pk_bf16_f32 v229, v230, v231
v_cvt_pk_bf16_f32 v230, v236, v237
v_cvt_pk_bf16_f32 v231, v238, v239
buffer_store_dwordx4 v[228:231], v1, s[4:7], s77 offen offset:2048 sc1
v_cvt_pk_bf16_f32 v240, v240, v241
v_cvt_pk_bf16_f32 v241, v242, v243
v_cvt_pk_bf16_f32 v242, v248, v249
v_cvt_pk_bf16_f32 v243, v250, v251
buffer_store_dwordx4 v[240:243], v1, s[4:7], s76 offen offset:3072 sc1
v_cvt_pk_bf16_f32 v244, v244, v245
v_cvt_pk_bf16_f32 v245, v246, v247
v_cvt_pk_bf16_f32 v246, v252, v253
v_cvt_pk_bf16_f32 v247, v254, v255
buffer_store_dwordx4 v[244:247], v1, s[4:7], s77 offen offset:3072 sc1
v_accvgpr_mov_b32 a13, a205
v_accvgpr_mov_b32 a14, a206
v_accvgpr_mov_b32 a15, a207
v_accvgpr_mov_b32 a16, a208
v_accvgpr_mov_b32 a17, a209
v_accvgpr_mov_b32 a18, a210
v_accvgpr_mov_b32 a19, a211
v_accvgpr_mov_b32 a20, a212
v_accvgpr_mov_b32 a21, a213
v_accvgpr_mov_b32 a22, a214
v_accvgpr_mov_b32 a23, a215
v_accvgpr_mov_b32 a24, a216
v_accvgpr_mov_b32 a25, a217
v_accvgpr_mov_b32 a26, a218
v_accvgpr_mov_b32 a27, a219
v_accvgpr_mov_b32 a28, a220
v_accvgpr_mov_b32 a29, a221
v_accvgpr_mov_b32 a30, a222
v_accvgpr_mov_b32 a31, a223
v_accvgpr_mov_b32 a32, a224
v_accvgpr_mov_b32 a33, a225
v_accvgpr_mov_b32 a34, a226
v_accvgpr_mov_b32 a35, a227
v_accvgpr_mov_b32 a36, a228
v_accvgpr_mov_b32 a37, a229
v_accvgpr_mov_b32 a38, a230
v_accvgpr_mov_b32 a39, a231
v_accvgpr_mov_b32 a40, a232
v_accvgpr_mov_b32 a41, a233
v_accvgpr_mov_b32 a42, a234
v_accvgpr_mov_b32 a43, a235
v_accvgpr_mov_b32 a44, a236
v_accvgpr_mov_b32 a45, a237
v_accvgpr_mov_b32 a46, a238
v_accvgpr_mov_b32 a47, a239
v_accvgpr_mov_b32 a48, a240
v_accvgpr_mov_b32 a49, a241
v_accvgpr_mov_b32 a50, a242
v_accvgpr_mov_b32 a51, a243
v_accvgpr_mov_b32 a52, a244
v_accvgpr_mov_b32 a53, a245
v_accvgpr_mov_b32 a54, a246
v_accvgpr_mov_b32 a55, a247
v_accvgpr_mov_b32 a56, a248
v_accvgpr_mov_b32 a57, a249
v_accvgpr_mov_b32 a58, a250
v_accvgpr_mov_b32 a59, a251
v_accvgpr_mov_b32 a60, a252
v_accvgpr_mov_b32 a61, a253
v_accvgpr_mov_b32 a62, a254
v_accvgpr_mov_b32 a63, a255
s_mov_b32 s24, 0
s_mov_b32 s29, s21
s_mov_b32 s19, s21
v_mov_b64 v[128:129], 0
v_mov_b64 v[130:131], 0
v_mov_b64 v[132:133], 0
v_mov_b64 v[134:135], 0
v_mov_b64 v[136:137], 0
v_mov_b64 v[138:139], 0
v_mov_b64 v[140:141], 0
v_mov_b64 v[142:143], 0
v_mov_b64 v[144:145], 0
v_mov_b64 v[146:147], 0
v_mov_b64 v[148:149], 0
v_mov_b64 v[150:151], 0
v_mov_b64 v[152:153], 0
v_mov_b64 v[154:155], 0
v_mov_b64 v[156:157], 0
v_mov_b64 v[158:159], 0
v_mov_b64 v[160:161], 0
v_mov_b64 v[162:163], 0
v_mov_b64 v[164:165], 0
v_mov_b64 v[166:167], 0
v_mov_b64 v[168:169], 0
v_mov_b64 v[170:171], 0
v_mov_b64 v[172:173], 0
v_mov_b64 v[174:175], 0
v_mov_b64 v[176:177], 0
v_mov_b64 v[178:179], 0
v_mov_b64 v[180:181], 0
v_mov_b64 v[182:183], 0
v_mov_b64 v[184:185], 0
v_mov_b64 v[186:187], 0
v_mov_b64 v[188:189], 0
v_mov_b64 v[190:191], 0
v_mov_b64 v[192:193], 0
v_mov_b64 v[194:195], 0
v_mov_b64 v[196:197], 0
v_mov_b64 v[198:199], 0
v_mov_b64 v[200:201], 0
v_mov_b64 v[202:203], 0
v_mov_b64 v[204:205], 0
v_mov_b64 v[206:207], 0
v_mov_b64 v[208:209], 0
v_mov_b64 v[210:211], 0
v_mov_b64 v[212:213], 0
v_mov_b64 v[214:215], 0
v_mov_b64 v[216:217], 0
v_mov_b64 v[218:219], 0
v_mov_b64 v[220:221], 0
v_mov_b64 v[222:223], 0
v_mov_b64 v[224:225], 0
v_mov_b64 v[226:227], 0
v_mov_b64 v[228:229], 0
v_mov_b64 v[230:231], 0
v_mov_b64 v[232:233], 0
v_mov_b64 v[234:235], 0
v_mov_b64 v[236:237], 0
v_mov_b64 v[238:239], 0
v_mov_b64 v[240:241], 0
v_mov_b64 v[242:243], 0
v_mov_b64 v[244:245], 0
v_mov_b64 v[246:247], 0
v_mov_b64 v[248:249], 0
v_mov_b64 v[250:251], 0
v_mov_b64 v[252:253], 0
v_mov_b64 v[254:255], 0
v_mov_b64 v[24:25], 0
s_mov_b32 s71, s28
s_mov_b32 s84, 0
s_barrier
s_branch K2_item
K2_nend:
Lstub_2:
s_call_b64 s[16:17], K2_slow1
s_branch Lback_3
Lstub_4:
s_call_b64 s[16:17], K2_slow0
s_branch Lback_5
Lstub_6:
s_call_b64 s[16:17], K2_slow1
s_branch Lback_7
Lstub_8:
s_call_b64 s[16:17], K2_slow0
s_branch Lback_9
Lstub_10:
s_call_b64 s[16:17], K2_slow2
s_branch Lback_11
Lstub_12:
s_call_b64 s[16:17], K2_slow2
s_branch Lback_13
Lstub_14:
s_call_b64 s[16:17], K2_slow1
s_branch Lback_15
K2_slow0:
s_nop 7
s_nop 7
v_max3_f32 v8, v32, v33, 0
v_max3_f32 v8, v34, v35, v8
v_max3_f32 v8, v40, v41, v8
v_max3_f32 v8, v42, v43, v8
v_max3_f32 v8, v48, v49, v8
v_max3_f32 v8, v50, v51, v8
v_max3_f32 v8, v56, v57, v8
v_max3_f32 v8, v58, v59, v8
v_mov_b32 v9, v8
s_nop 1
v_permlane16_swap_b32 v8, v9
v_max_f32 v8, v8, v9
v_mov_b32 v9, v8
s_nop 1
v_permlane32_swap_b32 v8, v9
v_max_f32 v8, v8, v9
v_exp_f32 v9, -v8
v_sub_f32 v16, v16, v8
v_sub_f32 v17, v17, v8
v_sub_f32 v18, v18, v8
v_sub_f32 v19, v19, v8
v_mul_f32 v24, v24, v9
v_mul_f32 v128, v128, v9
v_mul_f32 v129, v129, v9
v_mul_f32 v130, v130, v9
v_mul_f32 v131, v131, v9
v_mul_f32 v136, v136, v9
v_mul_f32 v137, v137, v9
v_mul_f32 v138, v138, v9
v_mul_f32 v139, v139, v9
v_mul_f32 v144, v144, v9
v_mul_f32 v145, v145, v9
v_mul_f32 v146, v146, v9
v_mul_f32 v147, v147, v9
v_mul_f32 v152, v152, v9
v_mul_f32 v153, v153, v9
v_mul_f32 v154, v154, v9
v_mul_f32 v155, v155, v9
v_mul_f32 v160, v160, v9
v_mul_f32 v161, v161, v9
v_mul_f32 v162, v162, v9
v_mul_f32 v163, v163, v9
v_mul_f32 v168, v168, v9
v_mul_f32 v169, v169, v9
v_mul_f32 v170, v170, v9
v_mul_f32 v171, v171, v9
v_mul_f32 v176, v176, v9
v_mul_f32 v177, v177, v9
v_mul_f32 v178, v178, v9
v_mul_f32 v179, v179, v9
v_mul_f32 v184, v184, v9
v_mul_f32 v185, v185, v9
v_mul_f32 v186, v186, v9
v_mul_f32 v187, v187, v9
v_mul_f32 v192, v192, v9
v_mul_f32 v193, v193, v9
v_mul_f32 v194, v194, v9
v_mul_f32 v195, v195, v9
v_mul_f32 v200, v200, v9
v_mul_f32 v201, v201, v9
v_mul_f32 v202, v202, v9
v_mul_f32 v203, v203, v9
v_mul_f32 v208, v208, v9
v_mul_f32 v209, v209, v9
v_mul_f32 v210, v210, v9
v_mul_f32 v211, v211, v9
v_mul_f32 v216, v216, v9
v_mul_f32 v217, v217, v9
v_mul_f32 v218, v218, v9
v_mul_f32 v219, v219, v9
v_mul_f32 v224, v224, v9
v_mul_f32 v225, v225, v9
v_mul_f32 v226, v226, v9
v_mul_f32 v227, v227, v9
v_mul_f32 v232, v232, v9
v_mul_f32 v233, v233, v9
v_mul_f32 v234, v234, v9
v_mul_f32 v235, v235, v9
v_mul_f32 v240, v240, v9
v_mul_f32 v241, v241, v9
v_mul_f32 v242, v242, v9
v_mul_f32 v243, v243, v9
v_mul_f32 v248, v248, v9
v_mul_f32 v249, v249, v9
v_mul_f32 v250, v250, v9
v_mul_f32 v251, v251, v9
v_sub_f32 v32, v32, v8
v_sub_f32 v33, v33, v8
v_sub_f32 v34, v34, v8
v_sub_f32 v35, v35, v8
v_sub_f32 v40, v40, v8
v_sub_f32 v41, v41, v8
v_sub_f32 v42, v42, v8
v_sub_f32 v43, v43, v8
v_sub_f32 v48, v48, v8
v_sub_f32 v49, v49, v8
v_sub_f32 v50, v50, v8
v_sub_f32 v51, v51, v8
v_sub_f32 v56, v56, v8
v_sub_f32 v57, v57, v8
v_sub_f32 v58, v58, v8
v_sub_f32 v59, v59, v8
v_sub_f32 v64, v64, v8
v_sub_f32 v65, v65, v8
v_sub_f32 v66, v66, v8
v_sub_f32 v67, v67, v8
v_sub_f32 v72, v72, v8
v_sub_f32 v73, v73, v8
v_sub_f32 v74, v74, v8
v_sub_f32 v75, v75, v8
v_sub_f32 v80, v80, v8
v_sub_f32 v81, v81, v8
v_sub_f32 v82, v82, v8
v_sub_f32 v83, v83, v8
v_sub_f32 v88, v88, v8
v_sub_f32 v89, v89, v8
v_sub_f32 v90, v90, v8
v_sub_f32 v91, v91, v8
v_max3_f32 v8, v36, v37, 0
v_max3_f32 v8, v38, v39, v8
v_max3_f32 v8, v44, v45, v8
v_max3_f32 v8, v46, v47, v8
v_max3_f32 v8, v52, v53, v8
v_max3_f32 v8, v54, v55, v8
v_max3_f32 v8, v60, v61, v8
v_max3_f32 v8, v62, v63, v8
v_mov_b32 v9, v8
s_nop 1
v_permlane16_swap_b32 v8, v9
v_max_f32 v8, v8, v9
v_mov_b32 v9, v8
s_nop 1
v_permlane32_swap_b32 v8, v9
v_max_f32 v8, v8, v9
v_exp_f32 v9, -v8
v_sub_f32 v20, v20, v8
v_sub_f32 v21, v21, v8
v_sub_f32 v22, v22, v8
v_sub_f32 v23, v23, v8
v_mul_f32 v25, v25, v9
v_mul_f32 v132, v132, v9
v_mul_f32 v133, v133, v9
v_mul_f32 v134, v134, v9
v_mul_f32 v135, v135, v9
v_mul_f32 v140, v140, v9
v_mul_f32 v141, v141, v9
v_mul_f32 v142, v142, v9
v_mul_f32 v143, v143, v9
v_mul_f32 v148, v148, v9
v_mul_f32 v149, v149, v9
v_mul_f32 v150, v150, v9
v_mul_f32 v151, v151, v9
v_mul_f32 v156, v156, v9
v_mul_f32 v157, v157, v9
v_mul_f32 v158, v158, v9
v_mul_f32 v159, v159, v9
v_mul_f32 v164, v164, v9
v_mul_f32 v165, v165, v9
v_mul_f32 v166, v166, v9
v_mul_f32 v167, v167, v9
v_mul_f32 v172, v172, v9
v_mul_f32 v173, v173, v9
v_mul_f32 v174, v174, v9
v_mul_f32 v175, v175, v9
v_mul_f32 v180, v180, v9
v_mul_f32 v181, v181, v9
v_mul_f32 v182, v182, v9
v_mul_f32 v183, v183, v9
v_mul_f32 v188, v188, v9
v_mul_f32 v189, v189, v9
v_mul_f32 v190, v190, v9
v_mul_f32 v191, v191, v9
v_mul_f32 v196, v196, v9
v_mul_f32 v197, v197, v9
v_mul_f32 v198, v198, v9
v_mul_f32 v199, v199, v9
v_mul_f32 v204, v204, v9
v_mul_f32 v205, v205, v9
v_mul_f32 v206, v206, v9
v_mul_f32 v207, v207, v9
v_mul_f32 v212, v212, v9
v_mul_f32 v213, v213, v9
v_mul_f32 v214, v214, v9
v_mul_f32 v215, v215, v9
v_mul_f32 v220, v220, v9
v_mul_f32 v221, v221, v9
v_mul_f32 v222, v222, v9
v_mul_f32 v223, v223, v9
v_mul_f32 v228, v228, v9
v_mul_f32 v229, v229, v9
v_mul_f32 v230, v230, v9
v_mul_f32 v231, v231, v9
v_mul_f32 v236, v236, v9
v_mul_f32 v237, v237, v9
v_mul_f32 v238, v238, v9
v_mul_f32 v239, v239, v9
v_mul_f32 v244, v244, v9
v_mul_f32 v245, v245, v9
v_mul_f32 v246, v246, v9
v_mul_f32 v247, v247, v9
v_mul_f32 v252, v252, v9
v_mul_f32 v253, v253, v9
v_mul_f32 v254, v254, v9
v_mul_f32 v255, v255, v9
v_sub_f32 v36, v36, v8
v_sub_f32 v37, v37, v8
v_sub_f32 v38, v38, v8
v_sub_f32 v39, v39, v8
v_sub_f32 v44, v44, v8
v_sub_f32 v45, v45, v8
v_sub_f32 v46, v46, v8
v_sub_f32 v47, v47, v8
v_sub_f32 v52, v52, v8
v_sub_f32 v53, v53, v8
v_sub_f32 v54, v54, v8
v_sub_f32 v55, v55, v8
v_sub_f32 v60, v60, v8
v_sub_f32 v61, v61, v8
v_sub_f32 v62, v62, v8
v_sub_f32 v63, v63, v8
v_sub_f32 v68, v68, v8
v_sub_f32 v69, v69, v8
v_sub_f32 v70, v70, v8
v_sub_f32 v71, v71, v8
v_sub_f32 v76, v76, v8
v_sub_f32 v77, v77, v8
v_sub_f32 v78, v78, v8
v_sub_f32 v79, v79, v8
v_sub_f32 v84, v84, v8
v_sub_f32 v85, v85, v8
v_sub_f32 v86, v86, v8
v_sub_f32 v87, v87, v8
v_sub_f32 v92, v92, v8
v_sub_f32 v93, v93, v8
v_sub_f32 v94, v94, v8
v_sub_f32 v95, v95, v8
v_exp_f32 v8, v32
v_exp_f32 v9, v33
v_exp_f32 v10, v34
v_exp_f32 v11, v35
s_nop 0
v_add_f32 v26, v8, v9
v_cvt_pk_bf16_f32 v96, v8, v9
v_add_f32 v26, v26, v10
v_add_f32 v26, v26, v11
v_cvt_pk_bf16_f32 v97, v10, v11
v_exp_f32 v12, v36
v_exp_f32 v13, v37
v_exp_f32 v14, v38
v_exp_f32 v15, v39
s_nop 0
v_add_f32 v27, v12, v13
v_cvt_pk_bf16_f32 v104, v12, v13
v_add_f32 v27, v27, v14
v_add_f32 v27, v27, v15
v_cvt_pk_bf16_f32 v105, v14, v15
v_exp_f32 v8, v40
v_exp_f32 v9, v41
v_exp_f32 v10, v42
v_exp_f32 v11, v43
s_nop 0
v_add_f32 v26, v26, v8
v_add_f32 v26, v26, v9
v_cvt_pk_bf16_f32 v98, v8, v9
v_add_f32 v26, v26, v10
v_add_f32 v26, v26, v11
v_cvt_pk_bf16_f32 v99, v10, v11
v_exp_f32 v12, v44
v_exp_f32 v13, v45
v_exp_f32 v14, v46
v_exp_f32 v15, v47
s_nop 0
v_add_f32 v27, v27, v12
v_add_f32 v27, v27, v13
v_cvt_pk_bf16_f32 v106, v12, v13
v_add_f32 v27, v27, v14
v_add_f32 v27, v27, v15
v_cvt_pk_bf16_f32 v107, v14, v15
v_exp_f32 v8, v48
v_exp_f32 v9, v49
v_exp_f32 v10, v50
v_exp_f32 v11, v51
s_nop 0
v_add_f32 v26, v26, v8
v_add_f32 v26, v26, v9
v_cvt_pk_bf16_f32 v100, v8, v9
v_add_f32 v26, v26, v10
v_add_f32 v26, v26, v11
v_cvt_pk_bf16_f32 v101, v10, v11
v_exp_f32 v12, v52
v_exp_f32 v13, v53
v_exp_f32 v14, v54
v_exp_f32 v15, v55
s_nop 0
v_add_f32 v27, v27, v12
v_add_f32 v27, v27, v13
v_cvt_pk_bf16_f32 v108, v12, v13
v_add_f32 v27, v27, v14
v_add_f32 v27, v27, v15
v_cvt_pk_bf16_f32 v109, v14, v15
v_exp_f32 v8, v56
v_exp_f32 v9, v57
v_exp_f32 v10, v58
v_exp_f32 v11, v59
s_nop 0
v_add_f32 v26, v26, v8
v_add_f32 v26, v26, v9
v_cvt_pk_bf16_f32 v102, v8, v9
v_add_f32 v26, v26, v10
v_add_f32 v26, v26, v11
v_cvt_pk_bf16_f32 v103, v10, v11
v_exp_f32 v12, v60
v_exp_f32 v13, v61
v_exp_f32 v14, v62
v_exp_f32 v15, v63
s_nop 0
v_add_f32 v27, v27, v12
v_add_f32 v27, v27, v13
v_cvt_pk_bf16_f32 v110, v12, v13
v_add_f32 v27, v27, v14
v_add_f32 v27, v27, v15
v_cvt_pk_bf16_f32 v111, v14, v15
s_nop 1
s_setpc_b64 s[16:17]
K2_slow1:
s_nop 7
s_nop 7
v_max3_f32 v8, v64, v65, 0
v_max3_f32 v8, v66, v67, v8
v_max3_f32 v8, v72, v73, v8
v_max3_f32 v8, v74, v75, v8
v_max3_f32 v8, v80, v81, v8
v_max3_f32 v8, v82, v83, v8
v_max3_f32 v8, v88, v89, v8
v_max3_f32 v8, v90, v91, v8
v_mov_b32 v9, v8
s_nop 1
v_permlane16_swap_b32 v8, v9
v_max_f32 v8, v8, v9
v_mov_b32 v9, v8
s_nop 1
v_permlane32_swap_b32 v8, v9
v_max_f32 v8, v8, v9
v_exp_f32 v9, -v8
v_sub_f32 v16, v16, v8
v_sub_f32 v17, v17, v8
v_sub_f32 v18, v18, v8
v_sub_f32 v19, v19, v8
v_mul_f32 v24, v24, v9
v_mul_f32 v128, v128, v9
v_mul_f32 v129, v129, v9
v_mul_f32 v130, v130, v9
v_mul_f32 v131, v131, v9
v_mul_f32 v136, v136, v9
v_mul_f32 v137, v137, v9
v_mul_f32 v138, v138, v9
v_mul_f32 v139, v139, v9
v_mul_f32 v144, v144, v9
v_mul_f32 v145, v145, v9
v_mul_f32 v146, v146, v9
v_mul_f32 v147, v147, v9
v_mul_f32 v152, v152, v9
v_mul_f32 v153, v153, v9
v_mul_f32 v154, v154, v9
v_mul_f32 v155, v155, v9
v_mul_f32 v160, v160, v9
v_mul_f32 v161, v161, v9
v_mul_f32 v162, v162, v9
v_mul_f32 v163, v163, v9
v_mul_f32 v168, v168, v9
v_mul_f32 v169, v169, v9
v_mul_f32 v170, v170, v9
v_mul_f32 v171, v171, v9
v_mul_f32 v176, v176, v9
v_mul_f32 v177, v177, v9
v_mul_f32 v178, v178, v9
v_mul_f32 v179, v179, v9
v_mul_f32 v184, v184, v9
v_mul_f32 v185, v185, v9
v_mul_f32 v186, v186, v9
v_mul_f32 v187, v187, v9
v_mul_f32 v192, v192, v9
v_mul_f32 v193, v193, v9
v_mul_f32 v194, v194, v9
v_mul_f32 v195, v195, v9
v_mul_f32 v200, v200, v9
v_mul_f32 v201, v201, v9
v_mul_f32 v202, v202, v9
v_mul_f32 v203, v203, v9
v_mul_f32 v208, v208, v9
v_mul_f32 v209, v209, v9
v_mul_f32 v210, v210, v9
v_mul_f32 v211, v211, v9
v_mul_f32 v216, v216, v9
v_mul_f32 v217, v217, v9
v_mul_f32 v218, v218, v9
v_mul_f32 v219, v219, v9
v_mul_f32 v224, v224, v9
v_mul_f32 v225, v225, v9
v_mul_f32 v226, v226, v9
v_mul_f32 v227, v227, v9
v_mul_f32 v232, v232, v9
v_mul_f32 v233, v233, v9
v_mul_f32 v234, v234, v9
v_mul_f32 v235, v235, v9
v_mul_f32 v240, v240, v9
v_mul_f32 v241, v241, v9
v_mul_f32 v242, v242, v9
v_mul_f32 v243, v243, v9
v_mul_f32 v248, v248, v9
v_mul_f32 v249, v249, v9
v_mul_f32 v250, v250, v9
v_mul_f32 v251, v251, v9
v_sub_f32 v32, v32, v8
v_sub_f32 v33, v33, v8
v_sub_f32 v34, v34, v8
v_sub_f32 v35, v35, v8
v_sub_f32 v40, v40, v8
v_sub_f32 v41, v41, v8
v_sub_f32 v42, v42, v8
v_sub_f32 v43, v43, v8
v_sub_f32 v48, v48, v8
v_sub_f32 v49, v49, v8
v_sub_f32 v50, v50, v8
v_sub_f32 v51, v51, v8
v_sub_f32 v56, v56, v8
v_sub_f32 v57, v57, v8
v_sub_f32 v58, v58, v8
v_sub_f32 v59, v59, v8
v_sub_f32 v64, v64, v8
v_sub_f32 v65, v65, v8
v_sub_f32 v66, v66, v8
v_sub_f32 v67, v67, v8
v_sub_f32 v72, v72, v8
v_sub_f32 v73, v73, v8
v_sub_f32 v74, v74, v8
v_sub_f32 v75, v75, v8
v_sub_f32 v80, v80, v8
v_sub_f32 v81, v81, v8
v_sub_f32 v82, v82, v8
v_sub_f32 v83, v83, v8
v_sub_f32 v88, v88, v8
v_sub_f32 v89, v89, v8
v_sub_f32 v90, v90, v8
v_sub_f32 v91, v91, v8
v_max3_f32 v8, v68, v69, 0
v_max3_f32 v8, v70, v71, v8
v_max3_f32 v8, v76, v77, v8
v_max3_f32 v8, v78, v79, v8
v_max3_f32 v8, v84, v85, v8
v_max3_f32 v8, v86, v87, v8
v_max3_f32 v8, v92, v93, v8
v_max3_f32 v8, v94, v95, v8
v_mov_b32 v9, v8
s_nop 1
v_permlane16_swap_b32 v8, v9
v_max_f32 v8, v8, v9
v_mov_b32 v9, v8
s_nop 1
v_permlane32_swap_b32 v8, v9
v_max_f32 v8, v8, v9
v_exp_f32 v9, -v8
v_sub_f32 v20, v20, v8
v_sub_f32 v21, v21, v8
v_sub_f32 v22, v22, v8
v_sub_f32 v23, v23, v8
v_mul_f32 v25, v25, v9
v_mul_f32 v132, v132, v9
v_mul_f32 v133, v133, v9
v_mul_f32 v134, v134, v9
v_mul_f32 v135, v135, v9
v_mul_f32 v140, v140, v9
v_mul_f32 v141, v141, v9
v_mul_f32 v142, v142, v9
v_mul_f32 v143, v143, v9
v_mul_f32 v148, v148, v9
v_mul_f32 v149, v149, v9
v_mul_f32 v150, v150, v9
v_mul_f32 v151, v151, v9
v_mul_f32 v156, v156, v9
v_mul_f32 v157, v157, v9
v_mul_f32 v158, v158, v9
v_mul_f32 v159, v159, v9
v_mul_f32 v164, v164, v9
v_mul_f32 v165, v165, v9
v_mul_f32 v166, v166, v9
v_mul_f32 v167, v167, v9
v_mul_f32 v172, v172, v9
v_mul_f32 v173, v173, v9
v_mul_f32 v174, v174, v9
v_mul_f32 v175, v175, v9
v_mul_f32 v180, v180, v9
v_mul_f32 v181, v181, v9
v_mul_f32 v182, v182, v9
v_mul_f32 v183, v183, v9
v_mul_f32 v188, v188, v9
v_mul_f32 v189, v189, v9
v_mul_f32 v190, v190, v9
v_mul_f32 v191, v191, v9
v_mul_f32 v196, v196, v9
v_mul_f32 v197, v197, v9
v_mul_f32 v198, v198, v9
v_mul_f32 v199, v199, v9
v_mul_f32 v204, v204, v9
v_mul_f32 v205, v205, v9
v_mul_f32 v206, v206, v9
v_mul_f32 v207, v207, v9
v_mul_f32 v212, v212, v9
v_mul_f32 v213, v213, v9
v_mul_f32 v214, v214, v9
v_mul_f32 v215, v215, v9
v_mul_f32 v220, v220, v9
v_mul_f32 v221, v221, v9
v_mul_f32 v222, v222, v9
v_mul_f32 v223, v223, v9
v_mul_f32 v228, v228, v9
v_mul_f32 v229, v229, v9
v_mul_f32 v230, v230, v9
v_mul_f32 v231, v231, v9
v_mul_f32 v236, v236, v9
v_mul_f32 v237, v237, v9
v_mul_f32 v238, v238, v9
v_mul_f32 v239, v239, v9
v_mul_f32 v244, v244, v9
v_mul_f32 v245, v245, v9
v_mul_f32 v246, v246, v9
v_mul_f32 v247, v247, v9
v_mul_f32 v252, v252, v9
v_mul_f32 v253, v253, v9
v_mul_f32 v254, v254, v9
v_mul_f32 v255, v255, v9
v_sub_f32 v36, v36, v8
v_sub_f32 v37, v37, v8
v_sub_f32 v38, v38, v8
v_sub_f32 v39, v39, v8
v_sub_f32 v44, v44, v8
v_sub_f32 v45, v45, v8
v_sub_f32 v46, v46, v8
v_sub_f32 v47, v47, v8
v_sub_f32 v52, v52, v8
v_sub_f32 v53, v53, v8
v_sub_f32 v54, v54, v8
v_sub_f32 v55, v55, v8
v_sub_f32 v60, v60, v8
v_sub_f32 v61, v61, v8
v_sub_f32 v62, v62, v8
v_sub_f32 v63, v63, v8
v_sub_f32 v68, v68, v8
v_sub_f32 v69, v69, v8
v_sub_f32 v70, v70, v8
v_sub_f32 v71, v71, v8
v_sub_f32 v76, v76, v8
v_sub_f32 v77, v77, v8
v_sub_f32 v78, v78, v8
v_sub_f32 v79, v79, v8
v_sub_f32 v84, v84, v8
v_sub_f32 v85, v85, v8
v_sub_f32 v86, v86, v8
v_sub_f32 v87, v87, v8
v_sub_f32 v92, v92, v8
v_sub_f32 v93, v93, v8
v_sub_f32 v94, v94, v8
v_sub_f32 v95, v95, v8
v_exp_f32 v8, v64
v_exp_f32 v9, v65
v_exp_f32 v10, v66
v_exp_f32 v11, v67
s_nop 0
v_add_f32 v26, v8, v9
v_cvt_pk_bf16_f32 v112, v8, v9
v_add_f32 v26, v26, v10
v_add_f32 v26, v26, v11
v_cvt_pk_bf16_f32 v113, v10, v11
v_exp_f32 v12, v68
v_exp_f32 v13, v69
v_exp_f32 v14, v70
v_exp_f32 v15, v71
s_nop 0
v_add_f32 v27, v12, v13
v_cvt_pk_bf16_f32 v120, v12, v13
v_add_f32 v27, v27, v14
v_add_f32 v27, v27, v15
v_cvt_pk_bf16_f32 v121, v14, v15
v_exp_f32 v8, v72
v_exp_f32 v9, v73
v_exp_f32 v10, v74
v_exp_f32 v11, v75
s_nop 0
v_add_f32 v26, v26, v8
v_add_f32 v26, v26, v9
v_cvt_pk_bf16_f32 v114, v8, v9
v_add_f32 v26, v26, v10
v_add_f32 v26, v26, v11
v_cvt_pk_bf16_f32 v115, v10, v11
v_exp_f32 v12, v76
v_exp_f32 v13, v77
v_exp_f32 v14, v78
v_exp_f32 v15, v79
s_nop 0
v_add_f32 v27, v27, v12
v_add_f32 v27, v27, v13
v_cvt_pk_bf16_f32 v122, v12, v13
v_add_f32 v27, v27, v14
v_add_f32 v27, v27, v15
v_cvt_pk_bf16_f32 v123, v14, v15
v_exp_f32 v8, v80
v_exp_f32 v9, v81
v_exp_f32 v10, v82
v_exp_f32 v11, v83
s_nop 0
v_add_f32 v26, v26, v8
v_add_f32 v26, v26, v9
v_cvt_pk_bf16_f32 v116, v8, v9
v_add_f32 v26, v26, v10
v_add_f32 v26, v26, v11
v_cvt_pk_bf16_f32 v117, v10, v11
v_exp_f32 v12, v84
v_exp_f32 v13, v85
v_exp_f32 v14, v86
v_exp_f32 v15, v87
s_nop 0
v_add_f32 v27, v27, v12
v_add_f32 v27, v27, v13
v_cvt_pk_bf16_f32 v124, v12, v13
v_add_f32 v27, v27, v14
v_add_f32 v27, v27, v15
v_cvt_pk_bf16_f32 v125, v14, v15
v_exp_f32 v8, v88
v_exp_f32 v9, v89
v_exp_f32 v10, v90
v_exp_f32 v11, v91
s_nop 0
v_add_f32 v26, v26, v8
v_add_f32 v26, v26, v9
v_cvt_pk_bf16_f32 v118, v8, v9
v_add_f32 v26, v26, v10
v_add_f32 v26, v26, v11
v_cvt_pk_bf16_f32 v119, v10, v11
v_exp_f32 v12, v92
v_exp_f32 v13, v93
v_exp_f32 v14, v94
v_exp_f32 v15, v95
s_nop 0
v_add_f32 v27, v27, v12
v_add_f32 v27, v27, v13
v_cvt_pk_bf16_f32 v126, v12, v13
v_add_f32 v27, v27, v14
v_add_f32 v27, v27, v15
v_cvt_pk_bf16_f32 v127, v14, v15
s_nop 1
s_setpc_b64 s[16:17]
K2_slow2:
s_nop 7
s_nop 7
v_max3_f32 v8, v68, v69, 0
v_max3_f32 v8, v70, v71, v8
v_max3_f32 v8, v76, v77, v8
v_max3_f32 v8, v78, v79, v8
v_max3_f32 v8, v84, v85, v8
v_max3_f32 v8, v86, v87, v8
v_max3_f32 v8, v92, v93, v8
v_max3_f32 v8, v94, v95, v8
v_mov_b32 v9, v8
s_nop 1
v_permlane16_swap_b32 v8, v9
v_max_f32 v8, v8, v9
v_mov_b32 v9, v8
s_nop 1
v_permlane32_swap_b32 v8, v9
v_max_f32 v8, v8, v9
v_exp_f32 v9, -v8
v_sub_f32 v20, v20, v8
v_sub_f32 v21, v21, v8
v_sub_f32 v22, v22, v8
v_sub_f32 v23, v23, v8
v_mul_f32 v25, v25, v9
v_mul_f32 v132, v132, v9
v_mul_f32 v133, v133, v9
v_mul_f32 v134, v134, v9
v_mul_f32 v135, v135, v9
v_mul_f32 v140, v140, v9
v_mul_f32 v141, v141, v9
v_mul_f32 v142, v142, v9
v_mul_f32 v143, v143, v9
v_mul_f32 v148, v148, v9
v_mul_f32 v149, v149, v9
v_mul_f32 v150, v150, v9
v_mul_f32 v151, v151, v9
v_mul_f32 v156, v156, v9
v_mul_f32 v157, v157, v9
v_mul_f32 v158, v158, v9
v_mul_f32 v159, v159, v9
v_mul_f32 v164, v164, v9
v_mul_f32 v165, v165, v9
v_mul_f32 v166, v166, v9
v_mul_f32 v167, v167, v9
v_mul_f32 v172, v172, v9
v_mul_f32 v173, v173, v9
v_mul_f32 v174, v174, v9
v_mul_f32 v175, v175, v9
v_mul_f32 v180, v180, v9
v_mul_f32 v181, v181, v9
v_mul_f32 v182, v182, v9
v_mul_f32 v183, v183, v9
v_mul_f32 v188, v188, v9
v_mul_f32 v189, v189, v9
v_mul_f32 v190, v190, v9
v_mul_f32 v191, v191, v9
v_mul_f32 v196, v196, v9
v_mul_f32 v197, v197, v9
v_mul_f32 v198, v198, v9
v_mul_f32 v199, v199, v9
v_mul_f32 v204, v204, v9
v_mul_f32 v205, v205, v9
v_mul_f32 v206, v206, v9
v_mul_f32 v207, v207, v9
v_mul_f32 v212, v212, v9
v_mul_f32 v213, v213, v9
v_mul_f32 v214, v214, v9
v_mul_f32 v215, v215, v9
v_mul_f32 v220, v220, v9
v_mul_f32 v221, v221, v9
v_mul_f32 v222, v222, v9
v_mul_f32 v223, v223, v9
v_mul_f32 v228, v228, v9
v_mul_f32 v229, v229, v9
v_mul_f32 v230, v230, v9
v_mul_f32 v231, v231, v9
v_mul_f32 v236, v236, v9
v_mul_f32 v237, v237, v9
v_mul_f32 v238, v238, v9
v_mul_f32 v239, v239, v9
v_mul_f32 v244, v244, v9
v_mul_f32 v245, v245, v9
v_mul_f32 v246, v246, v9
v_mul_f32 v247, v247, v9
v_mul_f32 v252, v252, v9
v_mul_f32 v253, v253, v9
v_mul_f32 v254, v254, v9
v_mul_f32 v255, v255, v9
v_sub_f32 v68, v68, v8
v_sub_f32 v69, v69, v8
v_sub_f32 v70, v70, v8
v_sub_f32 v71, v71, v8
v_sub_f32 v76, v76, v8
v_sub_f32 v77, v77, v8
v_sub_f32 v78, v78, v8
v_sub_f32 v79, v79, v8
v_sub_f32 v84, v84, v8
v_sub_f32 v85, v85, v8
v_sub_f32 v86, v86, v8
v_sub_f32 v87, v87, v8
v_sub_f32 v92, v92, v8
v_sub_f32 v93, v93, v8
v_sub_f32 v94, v94, v8
v_sub_f32 v95, v95, v8
v_exp_f32 v8, v68
v_exp_f32 v9, v69
v_exp_f32 v10, v70
v_exp_f32 v11, v71
s_nop 0
v_add_f32 v27, v8, v9
v_cvt_pk_bf16_f32 v120, v8, v9
v_add_f32 v27, v27, v10
v_add_f32 v27, v27, v11
v_cvt_pk_bf16_f32 v121, v10, v11
v_exp_f32 v12, v76
v_exp_f32 v13, v77
v_exp_f32 v14, v78
v_exp_f32 v15, v79
s_nop 0
v_add_f32 v27, v27, v12
v_add_f32 v27, v27, v13
v_cvt_pk_bf16_f32 v122, v12, v13
v_add_f32 v27, v27, v14
v_add_f32 v27, v27, v15
v_cvt_pk_bf16_f32 v123, v14, v15
v_exp_f32 v8, v84
v_exp_f32 v9, v85
v_exp_f32 v10, v86
v_exp_f32 v11, v87
s_nop 0
v_add_f32 v27, v27, v8
v_add_f32 v27, v27, v9
v_cvt_pk_bf16_f32 v124, v8, v9
v_add_f32 v27, v27, v10
v_add_f32 v27, v27, v11
v_cvt_pk_bf16_f32 v125, v10, v11
v_exp_f32 v12, v92
v_exp_f32 v13, v93
v_exp_f32 v14, v94
v_exp_f32 v15, v95
s_nop 0
v_add_f32 v27, v27, v12
v_add_f32 v27, v27, v13
v_cvt_pk_bf16_f32 v126, v12, v13
v_add_f32 v27, v27, v14
v_add_f32 v27, v27, v15
v_cvt_pk_bf16_f32 v127, v14, v15
s_nop 1
s_setpc_b64 s[16:17]
M_cntspinK:
Lp_9801:
buffer_load_dword v245, off, s[60:63], 0 sc1
s_waitcnt vmcnt(0)
v_cmp_gt_u32 vcc, 0x100, v245
s_cbranch_vccz Lpd_9802
s_sleep 8
s_sub_u32 s101, s101, 1
s_cbranch_scc0 Lp_9801
s_mov_b32 s101, 0
Lpd_9802:
s_branch Lg_1
M_ppspinK:
Lp_9803:
buffer_load_dword v230, v231, s[4:7], s52 offen sc1
s_waitcnt vmcnt(0)
v_cmp_gt_u32 vcc, 1, v230
s_cbranch_vccz Lpd_9804
s_sleep 8
s_sub_u32 s101, s101, 1
s_cbranch_scc0 Lp_9803
s_mov_b32 s101, 0
Lpd_9804:
s_branch M_ppokK
M_cntspinV:
Lp_9805:
buffer_load_dword v245, off, s[60:63], 0 sc1
s_waitcnt vmcnt(0)
v_cmp_gt_u32 vcc, 0x100, v245
s_cbranch_vccz Lpd_9806
s_sleep 8
s_sub_u32 s101, s101, 1
s_cbranch_scc0 Lp_9805
s_mov_b32 s101, 0
Lpd_9806:
s_branch Lg_501
M_ppspinV:
Lp_9807:
buffer_load_dword v230, v231, s[4:7], s52 offen sc1
s_waitcnt vmcnt(0)
v_cmp_gt_u32 vcc, 1, v230
s_cbranch_vccz Lpd_9808
s_sleep 8
s_sub_u32 s101, s101, 1
s_cbranch_scc0 Lp_9807
s_mov_b32 s101, 0
Lpd_9808:
s_branch M_ppokV
M_t2B:
s_mov_b64 exec, 0
s_cmp_lg_u32 s3, 0
s_cbranch_scc1 M_uw1
s_call_b64 s[98:99], PAD_32
s_call_b64 s[98:99], PAD_16
s_branch M_ud
M_uw1:
s_cmp_lg_u32 s3, 1
s_cbranch_scc1 M_uw2
s_call_b64 s[98:99], PAD_33
s_call_b64 s[98:99], PAD_13
s_branch M_ud
M_uw2:
s_cmp_lg_u32 s3, 2
s_cbranch_scc1 M_uw3
s_call_b64 s[98:99], PAD_34
s_call_b64 s[98:99], PAD_14
s_branch M_ud
M_uw3:
s_call_b64 s[98:99], PAD_15
M_ud:
s_mov_b64 exec, -1
s_branch M_t2Br
M_t2A:
s_mov_b64 exec, 0
s_cmp_lg_u32 s3, 0
s_cbranch_scc1 M_vw1
s_call_b64 s[98:99], PAD_32
s_call_b64 s[98:99], PAD_16
s_branch M_vd
M_vw1:
s_cmp_lg_u32 s3, 1
s_cbranch_scc1 M_vw2
s_call_b64 s[98:99], PAD_13
s_branch M_vd
M_vw2:
s_cmp_lg_u32 s3, 2
s_cbranch_scc1 M_vw3
s_call_b64 s[98:99], PAD_14
s_call_b64 s[98:99], PAD_19
s_branch M_vd
M_vw3:
s_call_b64 s[98:99], PAD_15
s_call_b64 s[98:99], PAD_20
M_vd:
s_mov_b64 exec, -1
s_branch M_t2Ar
M_end:
s_endpgm
.section .rodata,"a"
.p2align 6
.amdhsa_kernel concat_heads__ssm_conv_h3__compressed_kv_cla__prompt_kernel
  .amdhsa_next_free_vgpr 512
  .amdhsa_next_free_sgpr 102
  .amdhsa_accum_offset 256
  .amdhsa_group_segment_fixed_size 0
  .amdhsa_kernarg_size 120
  .amdhsa_user_sgpr_count 2
  .amdhsa_user_sgpr_kernarg_segment_ptr 1
  .amdhsa_system_sgpr_workgroup_id_x 1
  .amdhsa_float_denorm_mode_32 3
  .amdhsa_float_denorm_mode_16_64 3
  .amdhsa_ieee_mode 0
  .amdhsa_dx10_clamp 0
.end_amdhsa_kernel
```

```asm
; @launch grid=(256,1,1) block=(256,1,1) lds=163840
.amdgcn_target "amdgcn-amd-amdhsa--gfx950"
.text
.globl concat_heads__ssm_conv_h3__compressed_kv_cla__prompt_kernel
.p2align 8
.type concat_heads__ssm_conv_h3__compressed_kv_cla__prompt_kernel,@function
concat_heads__ssm_conv_h3__compressed_kv_cla__prompt_kernel:
s_cmp_ge_u32 s2, 256
s_cbranch_scc1 M_end
s_load_dwordx16 s[64:79], s[0:1], 0
s_load_dwordx8 s[80:87], s[0:1], 64
s_load_dwordx4 s[88:91], s[0:1], 96
s_load_dwordx2 s[92:93], s[0:1], 112
s_getpc_b64 s[58:59]
M_pc:
s_lshr_b32 s22, s2, 3
s_lshl_b32 s22, s22, 5
v_and_b32 v26, 31, v0
v_add_u32 v26, s22, v26
v_lshlrev_b32 v26, 7, v26
v_min_u32 v26, M_end-M_pc, v26
v_mov_b32 v27, s59
v_add_co_u32 v26, vcc, s58, v26
s_nop 1
v_addc_co_u32 v27, vcc, 0, v27, vcc
global_load_dword v21, v[26:27], off
v_lshrrev_b32 v28, 6, v0
v_and_b32 v29, 63, v0
v_lshlrev_b32 v1, 4, v29
v_readfirstlane_b32 s3, v28
s_and_b32 s20, s2, 7
s_lshl_b32 s20, s20, 1
s_bfe_u32 s22, s2, 0x10003
s_add_u32 s20, s20, s22
s_lshr_b32 s21, s2, 5
s_mov_b32 s101, 0x40000
v_lshrrev_b32 v26, 7, v1
v_lshrrev_b32 v27, 1, v26
v_lshlrev_b32 v27, 4, v27
v_and_b32 v28, 0x70, v1
v_xor_b32 v27, v27, v28
v_mul_u32_u24 v26, 2048, v26
v_add_u32 v12, v26, v27
v_xor_b32 v27, 64, v27
v_add_u32 v26, v26, v27
v_add_u32 v13, 15360, v26
v_add_u32 v14, 30720, v12
v_add_u32 v15, 46080, v26
v_lshrrev_b32 v26, 5, v29
v_and_b32 v27, 31, v29
s_and_b32 s22, s3, 1
s_lshl_b32 s22, s22, 2
v_or_b32 v28, s22, v26
v_lshlrev_b32 v28, 1, v28
v_xor_b32 v27, v27, v28
v_lshlrev_b32 v27, 4, v27
v_lshl_add_u32 v16, v26, 13, v27
v_xor_b32 v26, 64, v16
v_add_u32 v17, 15360, v26
v_add_u32 v18, 30720, v16
v_add_u32 v19, 46080, v26
s_lshl_b32 s28, s3, 13
s_lshl_b32 s29, s3, 12
s_lshl_b32 s24, s21, 19
s_lshl_b32 s22, s3, 17
s_add_u32 s24, s24, s22
s_add_u32 s25, s24, 65536
s_lshl_b32 s26, s3, 16
s_lshl_b32 s22, s20, 9
s_add_u32 s26, s26, s22
s_add_u32 s27, s26, 262144
s_mov_b32 s10, 4194304
s_mov_b32 s11, 0x20000
s_mov_b32 s14, 8388608
s_mov_b32 s15, 0x20000
v_and_b32 v30, 15, v29
v_lshrrev_b32 v31, 4, v29
v_lshrrev_b32 v26, 1, v30
v_xor_b32 v26, v31, v26
v_lshlrev_b32 v26, 4, v26
v_lshl_add_u32 v2, v30, 7, v26
s_lshr_b32 s22, s3, 1
s_lshl_b32 s22, s22, 14
v_add_u32 v2, s22, v2
v_xor_b32 v3, 64, v2
v_lshrrev_b32 v26, 2, v30
v_and_b32 v27, 1, v31
v_lshl_or_b32 v27, v27, 2, v26
v_lshl_add_u32 v26, v31, 3, v26
v_lshlrev_b32 v26, 9, v26
v_lshl_add_u32 v26, v27, 5, v26
v_and_b32 v27, 3, v29
v_lshl_add_u32 v26, v27, 3, v26
s_and_b32 s22, s3, 1
s_lshl_b32 s22, s22, 8
s_add_u32 s22, s22, 0x10000
v_xor_b32 v4, s22, v26
v_xor_b32 v5, 32, v4
v_xor_b32 v6, 64, v4
v_xor_b32 v7, 96, v4
v_xor_b32 v8, 128, v4
v_xor_b32 v9, 160, v4
v_xor_b32 v10, 192, v4
v_xor_b32 v11, 224, v4
s_mov_b32 s19, 0x20000
s_cmp_eq_u32 s3, 2
s_cbranch_scc1 M_pf2
s_cmp_lg_u32 s3, 0
s_cbranch_scc1 M_pf3
s_mov_b32 s18, 8388608
s_mov_b32 s51, 8388608
s_mov_b32 s47, 524288
s_mov_b32 s43, 524288
s_lshl_b32 s22, s21, 16
s_lshl_b32 s23, s20, 9
s_add_u32 s22, s22, s23
v_bfe_u32 v26, v29, 2, 3
v_lshl_add_u32 v26, v26, 13, s22
v_and_b32 v27, 3, v29
v_lshl_add_u32 v20, v27, 7, v26
v_lshrrev_b32 v27, 5, v29
v_lshl_add_u32 v22, v27, 19, v20
v_cmp_gt_u32 vcc, 32, v29
s_branch M_pfd
M_pf2:
s_mov_b32 s18, 4194304
s_mov_b32 s51, 2048
s_mov_b32 s47, 256
s_mov_b32 s43, 0
s_lshl_b32 s22, s2, 14
v_bfe_u32 v26, v29, 1, 3
v_lshl_add_u32 v26, v26, 11, s22
v_and_b32 v27, 1, v29
v_lshl_add_u32 v20, v27, 7, v26
v_bfe_u32 v27, v29, 4, 1
v_lshl_add_u32 v22, v27, 8, v20
v_cmp_gt_u32 vcc, 16, v29
s_branch M_pfd
M_pf3:
s_mov_b32 s18, 0
s_mov_b32 s51, 3112960
s_mov_b32 s47, 622592
s_mov_b32 s43, 0
s_mul_i32 s22, s2, 2432
v_lshl_add_u32 v20, v29, 7, s22
v_mov_b32 v22, v20
v_cmp_gt_u32 vcc, 19, v29
M_pfd:
v_mov_b32 v26, 3221225472
s_nop 0
v_cndmask_b32 v20, v26, v20, vcc
s_bitcmp1_b32 s2, 4
s_waitcnt lgkmcnt(0)
s_mov_b64 s[8:9], s[78:79]
s_cselect_b64 s[12:13], s[84:85], s[82:83]
s_add_u32 m0, s28, 0
s_nop 0
buffer_load_dwordx4 v12, s[8:11], s24 offen offset:0 lds
buffer_load_dwordx4 v13, s[8:11], s24 offen offset:1024 lds
buffer_load_dwordx4 v14, s[8:11], s24 offen offset:2048 lds
buffer_load_dwordx4 v15, s[8:11], s24 offen offset:3072 lds
s_add_u32 s24, s24, 128
s_add_u32 m0, s28, 4096
s_nop 0
buffer_load_dwordx4 v12, s[8:11], s25 offen offset:0 lds
buffer_load_dwordx4 v13, s[8:11], s25 offen offset:1024 lds
buffer_load_dwordx4 v14, s[8:11], s25 offen offset:2048 lds
buffer_load_dwordx4 v15, s[8:11], s25 offen offset:3072 lds
s_add_u32 s25, s25, 128
s_add_u32 m0, s29, 65536
s_nop 0
buffer_load_dwordx4 v16, s[12:15], s26 offen offset:0 lds
buffer_load_dwordx4 v17, s[12:15], s26 offen offset:1024 lds
buffer_load_dwordx4 v18, s[12:15], s26 offen offset:2048 lds
buffer_load_dwordx4 v19, s[12:15], s26 offen offset:3072 lds
s_add_u32 s26, s26, 524288
s_add_u32 m0, s29, 81920
s_nop 0
buffer_load_dwordx4 v16, s[12:15], s27 offen offset:0 lds
buffer_load_dwordx4 v17, s[12:15], s27 offen offset:1024 lds
buffer_load_dwordx4 v18, s[12:15], s27 offen offset:2048 lds
buffer_load_dwordx4 v19, s[12:15], s27 offen offset:3072 lds
s_add_u32 s27, s27, 524288
s_mov_b64 exec, 0
s_bfe_u32 s22, s2, 0x10004
s_lshl_b32 s22, s22, 2
s_add_u32 s22, s22, s3
s_cmp_lg_u32 s22, 0
s_cbranch_scc1 M_tw1
s_call_b64 s[98:99], PAD_0
s_call_b64 s[98:99], PAD_8
s_call_b64 s[98:99], PAD_12
s_call_b64 s[98:99], PAD_16
s_branch M_td
M_tw1:
s_cmp_lg_u32 s22, 1
s_cbranch_scc1 M_tw2
s_call_b64 s[98:99], PAD_1
s_call_b64 s[98:99], PAD_9
s_call_b64 s[98:99], PAD_13
s_branch M_td
M_tw2:
s_cmp_lg_u32 s22, 2
s_cbranch_scc1 M_tw3
s_call_b64 s[98:99], PAD_2
s_call_b64 s[98:99], PAD_6
s_call_b64 s[98:99], PAD_10
s_call_b64 s[98:99], PAD_14
s_branch M_td
M_tw3:
s_cmp_lg_u32 s22, 3
s_cbranch_scc1 M_tw4
s_call_b64 s[98:99], PAD_3
s_call_b64 s[98:99], PAD_7
s_call_b64 s[98:99], PAD_11
s_call_b64 s[98:99], PAD_15
s_branch M_td
M_tw4:
s_cmp_lg_u32 s22, 4
s_cbranch_scc1 M_tw5
s_call_b64 s[98:99], PAD_22
s_branch M_td
M_tw5:
s_cmp_lg_u32 s22, 5
s_cbranch_scc1 M_tw6
s_call_b64 s[98:99], PAD_23
s_call_b64 s[98:99], PAD_9
s_branch M_td
M_tw6:
s_cmp_lg_u32 s22, 6
s_cbranch_scc1 M_tw7
s_call_b64 s[98:99], PAD_24
s_call_b64 s[98:99], PAD_10
s_branch M_td
M_tw7:
s_call_b64 s[98:99], PAD_21
s_call_b64 s[98:99], PAD_11
M_td:
s_mov_b64 exec, -1
s_add_u32 m0, s28, 32768
s_nop 0
buffer_load_dwordx4 v12, s[8:11], s24 offen offset:0 lds
buffer_load_dwordx4 v13, s[8:11], s24 offen offset:1024 lds
buffer_load_dwordx4 v14, s[8:11], s24 offen offset:2048 lds
buffer_load_dwordx4 v15, s[8:11], s24 offen offset:3072 lds
s_add_u32 s24, s24, 128
s_add_u32 m0, s28, 36864
s_nop 0
buffer_load_dwordx4 v12, s[8:11], s25 offen offset:0 lds
buffer_load_dwordx4 v13, s[8:11], s25 offen offset:1024 lds
buffer_load_dwordx4 v14, s[8:11], s25 offen offset:2048 lds
buffer_load_dwordx4 v15, s[8:11], s25 offen offset:3072 lds
s_add_u32 s25, s25, 128
s_cmp_eq_u32 s3, 0
s_cselect_b64 s[16:17], s[12:13], s[8:9]
buffer_load_dword v21, v22, s[16:19], s43 offen
s_add_u32 s43, s43, s47
s_add_u32 s43, s43, s47
s_mov_b32 s4, s92
s_mov_b32 s5, s93
s_mov_b32 s6, 268435456
s_mov_b32 s7, 0x20000
s_cmp_eq_u32 s3, 3
s_cselect_b64 s[40:41], s[76:77], s[80:81]
s_cselect_b32 s42, 1835008, 0
s_cmp_eq_u32 s3, 1
s_cselect_b32 s42, 3670016, s42
s_cmp_eq_u32 s3, 3
s_cselect_b64 s[44:45], s[86:87], s[72:73]
s_cselect_b32 s46, 3670016, 0
s_cmp_eq_u32 s3, 1
s_cselect_b32 s46, 1835008, s46
s_cmp_eq_u32 s3, 2
s_cselect_b64 s[40:41], s[64:65], s[40:41]
s_cselect_b32 s42, 1835008, s42
s_waitcnt vmcnt(9)
s_barrier
ds_read_b64_tr_b16 a[128:129], v4 offset:0
ds_read_b64_tr_b16 a[130:131], v4 offset:2048
ds_read_b64_tr_b16 a[132:133], v4 offset:16384
ds_read_b64_tr_b16 a[134:135], v4 offset:18432
ds_read_b128 a[0:3], v2 offset:0
ds_read_b128 a[4:7], v3 offset:0
ds_read_b128 a[8:11], v2 offset:2048
ds_read_b128 a[12:15], v3 offset:2048
ds_read_b128 a[16:19], v2 offset:4096
ds_read_b128 a[20:23], v3 offset:4096
ds_read_b128 a[24:27], v2 offset:6144
ds_read_b128 a[28:31], v3 offset:6144
ds_read_b128 a[32:35], v2 offset:8192
ds_read_b128 a[36:39], v3 offset:8192
ds_read_b128 a[40:43], v2 offset:10240
ds_read_b128 a[44:47], v3 offset:10240
ds_read_b128 a[48:51], v2 offset:12288
ds_read_b128 a[52:55], v3 offset:12288
ds_read_b128 a[56:59], v2 offset:14336
ds_read_b128 a[60:63], v3 offset:14336
s_add_u32 m0, s29, 98304
s_nop 0
buffer_load_dwordx4 v16, s[12:15], s26 offen offset:0 lds
buffer_load_dwordx4 v17, s[12:15], s26 offen offset:1024 lds
buffer_load_dwordx4 v18, s[12:15], s26 offen offset:2048 lds
buffer_load_dwordx4 v19, s[12:15], s26 offen offset:3072 lds
s_add_u32 s26, s26, 524288
s_waitcnt lgkmcnt(0)
s_barrier
s_bitcmp1_b32 s2, 4
s_cbranch_scc1 M_V
s_branch M_K
M_tret:
s_setpc_b64 s[98:99]
.p2align 12
PAD_0:
s_cbranch_execz PAD_4
M_K:
v_mfma_f32_16x16x32_bf16 v[32:35], a[128:131], a[0:3], 0
s_add_u32 m0, s29, 114688
ds_read_b64_tr_b16 a[136:137], v5 offset:0
v_mfma_f32_16x16x32_bf16 v[32:35], a[132:135], a[4:7], v[32:35]
s_mov_b32 s32, 8192
buffer_load_dwordx4 v16, s[12:15], s27 offen offset:0 lds
v_mfma_f32_16x16x32_bf16 v[40:43], a[128:131], a[8:11], 0
s_mov_b32 s33, 8192
ds_read_b64_tr_b16 a[138:139], v5 offset:2048
v_mfma_f32_16x16x32_bf16 v[40:43], a[132:135], a[12:15], v[40:43]
s_mov_b32 s34, 8192
v_mfma_f32_16x16x32_bf16 v[48:51], a[128:131], a[16:19], 0
s_mov_b32 s35, 4294910976
ds_read_b64_tr_b16 a[140:141], v5 offset:16384
v_mfma_f32_16x16x32_bf16 v[48:51], a[132:135], a[20:23], v[48:51]
s_mov_b32 s36, 4294910976
buffer_load_dwordx4 v17, s[12:15], s27 offen offset:1024 lds
v_mfma_f32_16x16x32_bf16 v[56:59], a[128:131], a[24:27], 0
s_mov_b32 s30, 8
ds_read_b64_tr_b16 a[142:143], v5 offset:18432
v_mfma_f32_16x16x32_bf16 v[56:59], a[132:135], a[28:31], v[56:59]
s_mov_b32 s82, 3221225472
v_mfma_f32_16x16x32_bf16 v[64:67], a[128:131], a[32:35], 0
s_mul_hi_u32 s38, s2, 613566757
v_mfma_f32_16x16x32_bf16 v[64:67], a[132:135], a[36:39], v[64:67]
s_mul_i32 s39, s38, 7
buffer_load_dwordx4 v18, s[12:15], s27 offen offset:2048 lds
v_mfma_f32_16x16x32_bf16 v[72:75], a[128:131], a[40:43], 0
s_sub_u32 s39, s2, s39
v_mov_b32 v246, 0
v_mov_b32 v229, 0
v_mfma_f32_16x16x32_bf16 v[72:75], a[132:135], a[44:47], v[72:75]
v_mov_b32 v231, 0
v_mfma_f32_16x16x32_bf16 v[80:83], a[128:131], a[48:51], 0
s_mov_b32 s60, s90
v_mfma_f32_16x16x32_bf16 v[80:83], a[132:135], a[52:55], v[80:83]
s_mov_b32 s61, s91
buffer_load_dwordx4 v19, s[12:15], s27 offen offset:3072 lds
v_mfma_f32_16x16x32_bf16 v[88:91], a[128:131], a[56:59], 0
s_add_u32 s27, s27, 524288
v_mfma_f32_16x16x32_bf16 v[88:91], a[132:135], a[60:63], v[88:91]
s_waitcnt lgkmcnt(0)
s_mov_b32 s62, 256
v_mfma_f32_16x16x32_bf16 v[36:39], a[136:139], a[0:3], 0
s_add_u32 m0, s28, 0
ds_read_b64_tr_b16 a[128:129], v6 offset:0
v_mfma_f32_16x16x32_bf16 v[36:39], a[140:143], a[4:7], v[36:39]
s_mov_b32 s63, 0x20000
buffer_load_dwordx4 v12, s[8:11], s24 offen offset:0 lds
v_mfma_f32_16x16x32_bf16 v[44:47], a[136:139], a[8:11], 0
s_mul_hi_u32 s55, s2, 1431655766
ds_read_b64_tr_b16 a[130:131], v6 offset:2048
v_mfma_f32_16x16x32_bf16 v[44:47], a[140:143], a[12:15], v[44:47]
s_mul_i32 s55, s55, 3
v_mfma_f32_16x16x32_bf16 v[52:55], a[136:139], a[16:19], 0
s_sub_u32 s55, s2, s55
ds_read_b64_tr_b16 a[132:133], v6 offset:16384
v_mfma_f32_16x16x32_bf16 v[52:55], a[140:143], a[20:23], v[52:55]
s_add_u32 s55, s55, 5
buffer_load_dwordx4 v13, s[8:11], s24 offen offset:1024 lds
v_mfma_f32_16x16x32_bf16 v[60:63], a[136:139], a[24:27], 0
s_lshr_b32 s22, s2, 4
ds_read_b64_tr_b16 a[134:135], v6 offset:18432
v_mfma_f32_16x16x32_bf16 v[60:63], a[140:143], a[28:31], v[60:63]
s_lshl_b32 s23, s20, 5
v_mfma_f32_16x16x32_bf16 v[68:71], a[136:139], a[32:35], 0
s_add_u32 s23, s23, s22
v_mfma_f32_16x16x32_bf16 v[68:71], a[140:143], a[36:39], v[68:71]
s_lshl_b32 s23, s23, 2
buffer_load_dwordx4 v14, s[8:11], s24 offen offset:2048 lds
v_mfma_f32_16x16x32_bf16 v[76:79], a[136:139], a[40:43], 0
s_and_b32 s22, s2, 16
v_mfma_f32_16x16x32_bf16 v[76:79], a[140:143], a[44:47], v[76:79]
s_lshl_b32 s22, s22, 7
v_mfma_f32_16x16x32_bf16 v[84:87], a[136:139], a[48:51], 0
s_add_u32 s23, s23, s22
v_mov_b32 v28, 3221225472
v_writelane_b32 v28, s23, 0
v_mfma_f32_16x16x32_bf16 v[84:87], a[140:143], a[52:55], v[84:87]
s_add_u32 s56, s23, 16384
buffer_load_dwordx4 v15, s[8:11], s24 offen offset:3072 lds
v_mfma_f32_16x16x32_bf16 v[92:95], a[136:139], a[56:59], 0
s_add_u32 s24, s24, 128
v_writelane_b32 v28, s56, 1
v_mfma_f32_16x16x32_bf16 v[92:95], a[140:143], a[60:63], v[92:95]
s_waitcnt lgkmcnt(0)
s_add_u32 s56, s23, 4096
v_writelane_b32 v28, s56, 2
v_mfma_f32_16x16x32_bf16 v[96:99], a[128:131], a[0:3], 0
s_add_u32 m0, s28, 4096
ds_read_b64_tr_b16 a[136:137], v7 offset:0
v_mfma_f32_16x16x32_bf16 v[96:99], a[132:135], a[4:7], v[96:99]
s_sub_u32 s37, 15, s21
buffer_load_dwordx4 v12, s[8:11], s25 offen offset:0 lds
v_mfma_f32_16x16x32_bf16 v[104:107], a[128:131], a[8:11], 0
ds_read_b64_tr_b16 a[138:139], v7 offset:2048
v_mfma_f32_16x16x32_bf16 v[104:107], a[132:135], a[12:15], v[104:107]
v_mfma_f32_16x16x32_bf16 v[112:115], a[128:131], a[16:19], 0
ds_read_b64_tr_b16 a[140:141], v7 offset:16384
v_mfma_f32_16x16x32_bf16 v[112:115], a[132:135], a[20:23], v[112:115]
buffer_load_dwordx4 v13, s[8:11], s25 offen offset:1024 lds
v_mfma_f32_16x16x32_bf16 v[120:123], a[128:131], a[24:27], 0
ds_read_b64_tr_b16 a[142:143], v7 offset:18432
v_mfma_f32_16x16x32_bf16 v[120:123], a[132:135], a[28:31], v[120:123]
v_mfma_f32_16x16x32_bf16 v[128:131], a[128:131], a[32:35], 0
v_mfma_f32_16x16x32_bf16 v[128:131], a[132:135], a[36:39], v[128:131]
buffer_load_dwordx4 v14, s[8:11], s25 offen offset:2048 lds
v_mfma_f32_16x16x32_bf16 v[136:139], a[128:131], a[40:43], 0
v_mfma_f32_16x16x32_bf16 v[136:139], a[132:135], a[44:47], v[136:139]
v_mfma_f32_16x16x32_bf16 v[144:147], a[128:131], a[48:51], 0
v_mfma_f32_16x16x32_bf16 v[144:147], a[132:135], a[52:55], v[144:147]
buffer_load_dwordx4 v15, s[8:11], s25 offen offset:3072 lds
v_mfma_f32_16x16x32_bf16 v[152:155], a[128:131], a[56:59], 0
s_add_u32 s25, s25, 128
v_mfma_f32_16x16x32_bf16 v[152:155], a[132:135], a[60:63], v[152:155]
s_waitcnt vmcnt(17) lgkmcnt(0)
s_barrier
v_mfma_f32_16x16x32_bf16 v[100:103], a[136:139], a[0:3], 0
ds_read_b64_tr_b16 a[128:129], v8 offset:0
v_mfma_f32_16x16x32_bf16 v[100:103], a[140:143], a[4:7], v[100:103]
buffer_load_dword v21, v20, s[16:19], s43 offen
v_mfma_f32_16x16x32_bf16 v[108:111], a[136:139], a[8:11], 0
s_add_u32 s43, s43, s47
ds_read_b64_tr_b16 a[130:131], v8 offset:2048
v_mfma_f32_16x16x32_bf16 v[108:111], a[140:143], a[12:15], v[108:111]
s_cmp_ge_u32 s43, s51
v_mfma_f32_16x16x32_bf16 v[116:119], a[136:139], a[16:19], 0
s_cselect_b32 s43, 0, s43
ds_read_b64_tr_b16 a[132:133], v8 offset:16384
v_mfma_f32_16x16x32_bf16 v[116:119], a[140:143], a[20:23], v[116:119]
s_cselect_b32 s51, s42, s51
v_mfma_f32_16x16x32_bf16 v[124:127], a[136:139], a[24:27], 0
s_cselect_b64 s[16:17], s[40:41], s[16:17]
ds_read_b64_tr_b16 a[134:135], v8 offset:18432
v_mfma_f32_16x16x32_bf16 v[124:127], a[140:143], a[28:31], v[124:127]
s_cselect_b32 s18, s42, s18
v_mfma_f32_16x16x32_bf16 v[132:135], a[136:139], a[32:35], 0
s_cselect_b64 s[40:41], s[44:45], s[40:41]
ds_read_b128 a[64:67], v2 offset:32768
v_mfma_f32_16x16x32_bf16 v[132:135], a[140:143], a[36:39], v[132:135]
s_cselect_b32 s42, s46, s42
v_mfma_f32_16x16x32_bf16 v[140:143], a[136:139], a[40:43], 0
s_cselect_b32 s46, 0, s46
ds_read_b128 a[68:71], v3 offset:32768
v_mfma_f32_16x16x32_bf16 v[140:143], a[140:143], a[44:47], v[140:143]
ds_read_b128 a[72:75], v2 offset:34816
v_mfma_f32_16x16x32_bf16 v[148:151], a[136:139], a[48:51], 0
ds_read_b128 a[76:79], v3 offset:34816
v_mfma_f32_16x16x32_bf16 v[148:151], a[140:143], a[52:55], v[148:151]
buffer_load_dword v21, v20, s[16:19], s43 offen
v_mfma_f32_16x16x32_bf16 v[156:159], a[136:139], a[56:59], 0
s_add_u32 s43, s43, s47
ds_read_b128 a[80:83], v2 offset:36864
v_mfma_f32_16x16x32_bf16 v[156:159], a[140:143], a[60:63], v[156:159]
s_waitcnt lgkmcnt(5)
s_cmp_ge_u32 s43, s51
ds_read_b128 a[84:87], v3 offset:36864
v_mfma_f32_16x16x32_bf16 v[160:163], a[128:131], a[0:3], 0
s_cselect_b32 s43, 0, s43
ds_read_b64_tr_b16 a[136:137], v9 offset:0
v_mfma_f32_16x16x32_bf16 v[160:163], a[132:135], a[4:7], v[160:163]
s_cselect_b32 s51, s42, s51
v_mfma_f32_16x16x32_bf16 v[168:171], a[128:131], a[8:11], 0
s_cselect_b64 s[16:17], s[40:41], s[16:17]
ds_read_b64_tr_b16 a[138:139], v9 offset:2048
v_mfma_f32_16x16x32_bf16 v[168:171], a[132:135], a[12:15], v[168:171]
s_cselect_b32 s18, s42, s18
v_mfma_f32_16x16x32_bf16 v[176:179], a[128:131], a[16:19], 0
s_cselect_b64 s[40:41], s[44:45], s[40:41]
ds_read_b64_tr_b16 a[140:141], v9 offset:16384
v_mfma_f32_16x16x32_bf16 v[176:179], a[132:135], a[20:23], v[176:179]
s_cselect_b32 s42, s46, s42
v_mfma_f32_16x16x32_bf16 v[184:187], a[128:131], a[24:27], 0
s_cselect_b32 s46, 0, s46
ds_read_b64_tr_b16 a[142:143], v9 offset:18432
v_mfma_f32_16x16x32_bf16 v[184:187], a[132:135], a[28:31], v[184:187]
s_bitcmp1_b32 s2, 4
s_cselect_b32 s37, s21, s37
s_lshl_b32 s56, s37, 5
v_mfma_f32_16x16x32_bf16 v[192:195], a[128:131], a[32:35], 0
s_add_u32 s56, s56, s20
s_lshl_b32 s56, s56, 2
s_add_u32 s56, s56, 8192
v_mfma_f32_16x16x32_bf16 v[192:195], a[132:135], a[36:39], v[192:195]
v_writelane_b32 v28, s56, 3
v_mfma_f32_16x16x32_bf16 v[200:203], a[128:131], a[40:43], 0
s_add_u32 s56, s56, 2048
ds_read_b128 a[88:91], v2 offset:38912
v_writelane_b32 v28, s56, 6
v_mfma_f32_16x16x32_bf16 v[200:203], a[132:135], a[44:47], v[200:203]
s_lshl_b32 s56, s2, 2
s_add_u32 s56, s56, 12288
ds_read_b128 a[92:95], v3 offset:38912
v_mfma_f32_16x16x32_bf16 v[208:211], a[128:131], a[48:51], 0
s_waitcnt lgkmcnt(2)
ds_read_b128 a[96:99], v2 offset:40960
v_writelane_b32 v28, s56, 4
v_mfma_f32_16x16x32_bf16 v[208:211], a[132:135], a[52:55], v[208:211]
s_lshl_b32 s56, s39, 5
s_add_u32 s56, s56, s38
s_lshl_b32 s56, s56, 2
v_mfma_f32_16x16x32_bf16 v[216:219], a[128:131], a[56:59], 0
s_add_u32 s56, s56, 20480
s_cmp_lt_u32 s2, 224
ds_read_b128 a[100:103], v3 offset:40960
v_mfma_f32_16x16x32_bf16 v[216:219], a[132:135], a[60:63], v[216:219]
s_cselect_b32 s56, s56, 3221225472
ds_read_b128 a[104:107], v2 offset:43008
v_writelane_b32 v28, s56, 7
v_mfma_f32_16x16x32_bf16 v[164:167], a[136:139], a[0:3], 0
s_cmp_eq_u32 s3, 0
s_cselect_b32 s56, 94371840, 3221225472
ds_read_b64_tr_b16 a[128:129], v10 offset:0
v_mfma_f32_16x16x32_bf16 v[164:167], a[140:143], a[4:7], v[164:167]
buffer_store_dword v246, v28, s[4:7], s56 offen sc1
v_mfma_f32_16x16x32_bf16 v[172:175], a[136:139], a[8:11], 0
ds_read_b64_tr_b16 a[130:131], v10 offset:2048
v_mov_b32 v27, 1
v_mfma_f32_16x16x32_bf16 v[172:175], a[140:143], a[12:15], v[172:175]
v_cmp_eq_u32 vcc, 0, v0
v_mov_b32 v26, 3221225472
v_mfma_f32_16x16x32_bf16 v[180:183], a[136:139], a[16:19], 0
s_lshl_b32 s31, s20, 20
s_lshl_b32 s22, s21, 17
ds_read_b64_tr_b16 a[132:133], v10 offset:16384
v_mfma_f32_16x16x32_bf16 v[180:183], a[140:143], a[20:23], v[180:183]
v_cndmask_b32 v26, v26, v246, vcc
v_mfma_f32_16x16x32_bf16 v[188:191], a[136:139], a[24:27], 0
s_add_u32 s31, s31, s22
s_lshr_b32 s22, s3, 1
ds_read_b64_tr_b16 a[134:135], v10 offset:18432
v_mfma_f32_16x16x32_bf16 v[188:191], a[140:143], a[28:31], v[188:191]
s_lshl_b32 s22, s22, 16
s_add_u32 s31, s31, s22
s_and_b32 s22, s3, 1
v_mfma_f32_16x16x32_bf16 v[196:199], a[136:139], a[32:35], 0
s_lshl_b32 s22, s22, 12
s_add_u32 s31, s31, s22
v_mfma_f32_16x16x32_bf16 v[196:199], a[140:143], a[36:39], v[196:199]
v_mfma_f32_16x16x32_bf16 v[204:207], a[136:139], a[40:43], 0
ds_read_b128 a[108:111], v3 offset:43008
v_mfma_f32_16x16x32_bf16 v[204:207], a[140:143], a[44:47], v[204:207]
ds_read_b128 a[112:115], v2 offset:45056
v_mfma_f32_16x16x32_bf16 v[212:215], a[136:139], a[48:51], 0
ds_read_b128 a[116:119], v3 offset:45056
v_mfma_f32_16x16x32_bf16 v[212:215], a[140:143], a[52:55], v[212:215]
v_mfma_f32_16x16x32_bf16 v[220:223], a[136:139], a[56:59], 0
ds_read_b128 a[120:123], v2 offset:47104
v_mfma_f32_16x16x32_bf16 v[220:223], a[140:143], a[60:63], v[220:223]
s_waitcnt lgkmcnt(4)
ds_read_b128 a[124:127], v3 offset:47104
v_mfma_f32_16x16x32_bf16 a[192:195], a[128:131], a[0:3], 0
ds_read_b64_tr_b16 a[136:137], v11 offset:0
v_mfma_f32_16x16x32_bf16 a[192:195], a[132:135], a[4:7], a[192:195]
v_mfma_f32_16x16x32_bf16 a[200:203], a[128:131], a[8:11], 0
ds_read_b64_tr_b16 a[138:139], v11 offset:2048
v_mfma_f32_16x16x32_bf16 a[200:203], a[132:135], a[12:15], a[200:203]
v_mfma_f32_16x16x32_bf16 a[208:211], a[128:131], a[16:19], 0
ds_read_b64_tr_b16 a[140:141], v11 offset:16384
v_mfma_f32_16x16x32_bf16 a[208:211], a[132:135], a[20:23], a[208:211]
v_mfma_f32_16x16x32_bf16 a[216:219], a[128:131], a[24:27], 0
ds_read_b64_tr_b16 a[142:143], v11 offset:18432
v_mfma_f32_16x16x32_bf16 a[216:219], a[132:135], a[28:31], a[216:219]
v_mfma_f32_16x16x32_bf16 a[224:227], a[128:131], a[32:35], 0
v_mfma_f32_16x16x32_bf16 a[224:227], a[132:135], a[36:39], a[224:227]
v_mfma_f32_16x16x32_bf16 a[232:235], a[128:131], a[40:43], 0
v_mfma_f32_16x16x32_bf16 a[232:235], a[132:135], a[44:47], a[232:235]
v_mfma_f32_16x16x32_bf16 a[240:243], a[128:131], a[48:51], 0
v_mfma_f32_16x16x32_bf16 a[240:243], a[132:135], a[52:55], a[240:243]
v_mfma_f32_16x16x32_bf16 a[248:251], a[128:131], a[56:59], 0
s_waitcnt vmcnt(3) lgkmcnt(0)
v_mfma_f32_16x16x32_bf16 a[248:251], a[132:135], a[60:63], a[248:251]
s_barrier
v_mfma_f32_16x16x32_bf16 a[196:199], a[136:139], a[0:3], 0
s_add_u32 m0, s29, 65536
ds_read_b64_tr_b16 a[128:129], v4 offset:32768
v_mfma_f32_16x16x32_bf16 a[196:199], a[140:143], a[4:7], a[196:199]
buffer_load_dwordx4 v16, s[12:15], s26 offen offset:0 lds
v_mfma_f32_16x16x32_bf16 a[204:207], a[136:139], a[8:11], 0
ds_read_b64_tr_b16 a[130:131], v4 offset:34816
v_mfma_f32_16x16x32_bf16 a[204:207], a[140:143], a[12:15], a[204:207]
v_mfma_f32_16x16x32_bf16 a[212:215], a[136:139], a[16:19], 0
ds_read_b64_tr_b16 a[132:133], v4 offset:49152
v_mfma_f32_16x16x32_bf16 a[212:215], a[140:143], a[20:23], a[212:215]
buffer_load_dwordx4 v17, s[12:15], s26 offen offset:1024 lds
v_mfma_f32_16x16x32_bf16 a[220:223], a[136:139], a[24:27], 0
ds_read_b64_tr_b16 a[134:135], v4 offset:51200
v_mfma_f32_16x16x32_bf16 a[220:223], a[140:143], a[28:31], a[220:223]
v_mfma_f32_16x16x32_bf16 a[228:231], a[136:139], a[32:35], 0
v_mfma_f32_16x16x32_bf16 a[228:231], a[140:143], a[36:39], a[228:231]
buffer_load_dwordx4 v18, s[12:15], s26 offen offset:2048 lds
v_mfma_f32_16x16x32_bf16 a[236:239], a[136:139], a[40:43], 0
v_mfma_f32_16x16x32_bf16 a[236:239], a[140:143], a[44:47], a[236:239]
v_mfma_f32_16x16x32_bf16 a[244:247], a[136:139], a[48:51], 0
v_mfma_f32_16x16x32_bf16 a[244:247], a[140:143], a[52:55], a[244:247]
buffer_load_dwordx4 v19, s[12:15], s26 offen offset:3072 lds
v_mfma_f32_16x16x32_bf16 a[252:255], a[136:139], a[56:59], 0
s_add_u32 s26, s26, 524288
v_mfma_f32_16x16x32_bf16 a[252:255], a[140:143], a[60:63], a[252:255]
s_waitcnt lgkmcnt(0)
Lg_1:
v_mfma_f32_16x16x32_bf16 v[32:35], a[128:131], a[64:67], v[32:35]
s_add_u32 m0, s29, 81920
ds_read_b64_tr_b16 a[136:137], v5 offset:32768
v_mfma_f32_16x16x32_bf16 v[32:35], a[132:135], a[68:71], v[32:35]
buffer_load_dwordx4 v16, s[12:15], s27 offen offset:0 lds
v_mfma_f32_16x16x32_bf16 v[40:43], a[128:131], a[72:75], v[40:43]
ds_read_b64_tr_b16 a[138:139], v5 offset:34816
v_mfma_f32_16x16x32_bf16 v[40:43], a[132:135], a[76:79], v[40:43]
v_mfma_f32_16x16x32_bf16 v[48:51], a[128:131], a[80:83], v[48:51]
ds_read_b64_tr_b16 a[140:141], v5 offset:49152
v_mfma_f32_16x16x32_bf16 v[48:51], a[132:135], a[84:87], v[48:51]
buffer_load_dwordx4 v17, s[12:15], s27 offen offset:1024 lds
v_mfma_f32_16x16x32_bf16 v[56:59], a[128:131], a[88:91], v[56:59]
ds_read_b64_tr_b16 a[142:143], v5 offset:51200
v_mfma_f32_16x16x32_bf16 v[56:59], a[132:135], a[92:95], v[56:59]
v_mfma_f32_16x16x32_bf16 v[64:67], a[128:131], a[96:99], v[64:67]
ds_read_b128 a[0:3], v2 offset:0
v_mfma_f32_16x16x32_bf16 v[64:67], a[132:135], a[100:103], v[64:67]
buffer_load_dwordx4 v18, s[12:15], s27 offen offset:2048 lds
v_mfma_f32_16x16x32_bf16 v[72:75], a[128:131], a[104:107], v[72:75]
ds_read_b128 a[4:7], v3 offset:0
v_mfma_f32_16x16x32_bf16 v[72:75], a[132:135], a[108:111], v[72:75]
v_mfma_f32_16x16x32_bf16 v[80:83], a[128:131], a[112:115], v[80:83]
v_mfma_f32_16x16x32_bf16 v[80:83], a[132:135], a[116:119], v[80:83]
buffer_load_dwordx4 v19, s[12:15], s27 offen offset:3072 lds
v_mfma_f32_16x16x32_bf16 v[88:91], a[128:131], a[120:123], v[88:91]
s_add_u32 s27, s27, 524288
ds_read_b128 a[8:11], v2 offset:2048
v_mfma_f32_16x16x32_bf16 v[88:91], a[132:135], a[124:127], v[88:91]
s_waitcnt lgkmcnt(3)
v_mfma_f32_16x16x32_bf16 v[36:39], a[136:139], a[64:67], v[36:39]
s_add_u32 m0, s28, 32768
ds_read_b64_tr_b16 a[128:129], v6 offset:32768
v_mfma_f32_16x16x32_bf16 v[36:39], a[140:143], a[68:71], v[36:39]
buffer_load_dwordx4 v12, s[8:11], s24 offen offset:0 lds
v_mfma_f32_16x16x32_bf16 v[44:47], a[136:139], a[72:75], v[44:47]
ds_read_b64_tr_b16 a[130:131], v6 offset:34816
v_mfma_f32_16x16x32_bf16 v[44:47], a[140:143], a[76:79], v[44:47]
v_mfma_f32_16x16x32_bf16 v[52:55], a[136:139], a[80:83], v[52:55]
ds_read_b64_tr_b16 a[132:133], v6 offset:49152
v_mfma_f32_16x16x32_bf16 v[52:55], a[140:143], a[84:87], v[52:55]
buffer_load_dwordx4 v13, s[8:11], s24 offen offset:1024 lds
v_mfma_f32_16x16x32_bf16 v[60:63], a[136:139], a[88:91], v[60:63]
ds_read_b64_tr_b16 a[134:135], v6 offset:51200
v_mfma_f32_16x16x32_bf16 v[60:63], a[140:143], a[92:95], v[60:63]
v_mfma_f32_16x16x32_bf16 v[68:71], a[136:139], a[96:99], v[68:71]
ds_read_b128 a[12:15], v3 offset:2048
v_mfma_f32_16x16x32_bf16 v[68:71], a[140:143], a[100:103], v[68:71]
buffer_load_dwordx4 v14, s[8:11], s24 offen offset:2048 lds
v_mfma_f32_16x16x32_bf16 v[76:79], a[136:139], a[104:107], v[76:79]
v_mfma_f32_16x16x32_bf16 v[76:79], a[140:143], a[108:111], v[76:79]
v_mfma_f32_16x16x32_bf16 v[84:87], a[136:139], a[112:115], v[84:87]
ds_read_b128 a[16:19], v2 offset:4096
v_mfma_f32_16x16x32_bf16 v[84:87], a[140:143], a[116:119], v[84:87]
buffer_load_dwordx4 v15, s[8:11], s24 offen offset:3072 lds
v_mfma_f32_16x16x32_bf16 v[92:95], a[136:139], a[120:123], v[92:95]
s_add_u32 s24, s24, 128
ds_read_b128 a[20:23], v3 offset:4096
v_mfma_f32_16x16x32_bf16 v[92:95], a[140:143], a[124:127], v[92:95]
s_waitcnt lgkmcnt(3)
v_mfma_f32_16x16x32_bf16 v[96:99], a[128:131], a[64:67], v[96:99]
s_add_u32 m0, s28, 36864
ds_read_b64_tr_b16 a[136:137], v7 offset:32768
v_mfma_f32_16x16x32_bf16 v[96:99], a[132:135], a[68:71], v[96:99]
buffer_load_dwordx4 v12, s[8:11], s25 offen offset:0 lds
v_mfma_f32_16x16x32_bf16 v[104:107], a[128:131], a[72:75], v[104:107]
ds_read_b64_tr_b16 a[138:139], v7 offset:34816
v_mfma_f32_16x16x32_bf16 v[104:107], a[132:135], a[76:79], v[104:107]
v_mfma_f32_16x16x32_bf16 v[112:115], a[128:131], a[80:83], v[112:115]
ds_read_b64_tr_b16 a[140:141], v7 offset:49152
v_mfma_f32_16x16x32_bf16 v[112:115], a[132:135], a[84:87], v[112:115]
buffer_load_dwordx4 v13, s[8:11], s25 offen offset:1024 lds
v_mfma_f32_16x16x32_bf16 v[120:123], a[128:131], a[88:91], v[120:123]
ds_read_b64_tr_b16 a[142:143], v7 offset:51200
v_mfma_f32_16x16x32_bf16 v[120:123], a[132:135], a[92:95], v[120:123]
v_mfma_f32_16x16x32_bf16 v[128:131], a[128:131], a[96:99], v[128:131]
v_mfma_f32_16x16x32_bf16 v[128:131], a[132:135], a[100:103], v[128:131]
buffer_load_dwordx4 v14, s[8:11], s25 offen offset:2048 lds
v_mfma_f32_16x16x32_bf16 v[136:139], a[128:131], a[104:107], v[136:139]
ds_read_b128 a[24:27], v2 offset:6144
v_mfma_f32_16x16x32_bf16 v[136:139], a[132:135], a[108:111], v[136:139]
v_mfma_f32_16x16x32_bf16 v[144:147], a[128:131], a[112:115], v[144:147]
ds_read_b128 a[28:31], v3 offset:6144
v_mfma_f32_16x16x32_bf16 v[144:147], a[132:135], a[116:119], v[144:147]
buffer_load_dwordx4 v15, s[8:11], s25 offen offset:3072 lds
v_mfma_f32_16x16x32_bf16 v[152:155], a[128:131], a[120:123], v[152:155]
s_add_u32 s25, s25, 128
v_mfma_f32_16x16x32_bf16 v[152:155], a[132:135], a[124:127], v[152:155]
s_waitcnt lgkmcnt(2)
v_mfma_f32_16x16x32_bf16 v[100:103], a[136:139], a[64:67], v[100:103]
ds_read_b64_tr_b16 a[128:129], v8 offset:32768
v_mfma_f32_16x16x32_bf16 v[100:103], a[140:143], a[68:71], v[100:103]
buffer_load_dword v21, v20, s[16:19], s43 offen
v_mfma_f32_16x16x32_bf16 v[108:111], a[136:139], a[72:75], v[108:111]
s_add_u32 s43, s43, s47
ds_read_b64_tr_b16 a[130:131], v8 offset:34816
v_mfma_f32_16x16x32_bf16 v[108:111], a[140:143], a[76:79], v[108:111]
s_cmp_ge_u32 s43, s51
v_mfma_f32_16x16x32_bf16 v[116:119], a[136:139], a[80:83], v[116:119]
s_cselect_b32 s43, 0, s43
ds_read_b64_tr_b16 a[132:133], v8 offset:49152
v_mfma_f32_16x16x32_bf16 v[116:119], a[140:143], a[84:87], v[116:119]
s_cselect_b32 s51, s42, s51
v_mfma_f32_16x16x32_bf16 v[124:127], a[136:139], a[88:91], v[124:127]
s_cselect_b64 s[16:17], s[40:41], s[16:17]
ds_read_b64_tr_b16 a[134:135], v8 offset:51200
v_mfma_f32_16x16x32_bf16 v[124:127], a[140:143], a[92:95], v[124:127]
s_cselect_b32 s18, s42, s18
v_mfma_f32_16x16x32_bf16 v[132:135], a[136:139], a[96:99], v[132:135]
s_cselect_b64 s[40:41], s[44:45], s[40:41]
ds_read_b128 a[32:35], v2 offset:8192
v_mfma_f32_16x16x32_bf16 v[132:135], a[140:143], a[100:103], v[132:135]
s_cselect_b32 s42, s46, s42
v_mfma_f32_16x16x32_bf16 v[140:143], a[136:139], a[104:107], v[140:143]
s_cselect_b32 s46, 0, s46
v_mfma_f32_16x16x32_bf16 v[140:143], a[140:143], a[108:111], v[140:143]
s_cmp_eq_u32 s30, s55
v_mfma_f32_16x16x32_bf16 v[148:151], a[136:139], a[112:115], v[148:151]
s_cselect_b32 s22, 0, 3221225472
ds_read_b128 a[36:39], v3 offset:8192
v_mfma_f32_16x16x32_bf16 v[148:151], a[140:143], a[116:119], v[148:151]
s_sub_u32 s30, s30, 1
buffer_atomic_add v27, v26, s[60:63], s22 offen sc1
v_mfma_f32_16x16x32_bf16 v[156:159], a[136:139], a[120:123], v[156:159]
ds_read_b128 a[40:43], v2 offset:10240
v_mfma_f32_16x16x32_bf16 v[156:159], a[140:143], a[124:127], v[156:159]
s_waitcnt lgkmcnt(3)
v_mfma_f32_16x16x32_bf16 v[160:163], a[128:131], a[64:67], v[160:163]
ds_read_b64_tr_b16 a[136:137], v9 offset:32768
v_mfma_f32_16x16x32_bf16 v[160:163], a[132:135], a[68:71], v[160:163]
v_mfma_f32_16x16x32_bf16 v[168:171], a[128:131], a[72:75], v[168:171]
ds_read_b64_tr_b16 a[138:139], v9 offset:34816
v_mfma_f32_16x16x32_bf16 v[168:171], a[132:135], a[76:79], v[168:171]
v_mfma_f32_16x16x32_bf16 v[176:179], a[128:131], a[80:83], v[176:179]
ds_read_b64_tr_b16 a[140:141], v9 offset:49152
v_mfma_f32_16x16x32_bf16 v[176:179], a[132:135], a[84:87], v[176:179]
v_mfma_f32_16x16x32_bf16 v[184:187], a[128:131], a[88:91], v[184:187]
ds_read_b64_tr_b16 a[142:143], v9 offset:51200
v_mfma_f32_16x16x32_bf16 v[184:187], a[132:135], a[92:95], v[184:187]
v_mfma_f32_16x16x32_bf16 v[192:195], a[128:131], a[96:99], v[192:195]
v_mfma_f32_16x16x32_bf16 v[192:195], a[132:135], a[100:103], v[192:195]
v_mfma_f32_16x16x32_bf16 v[200:203], a[128:131], a[104:107], v[200:203]
ds_read_b128 a[44:47], v3 offset:10240
v_mfma_f32_16x16x32_bf16 v[200:203], a[132:135], a[108:111], v[200:203]
v_mfma_f32_16x16x32_bf16 v[208:211], a[128:131], a[112:115], v[208:211]
ds_read_b128 a[48:51], v2 offset:12288
v_mfma_f32_16x16x32_bf16 v[208:211], a[132:135], a[116:119], v[208:211]
v_mfma_f32_16x16x32_bf16 v[216:219], a[128:131], a[120:123], v[216:219]
v_mfma_f32_16x16x32_bf16 v[216:219], a[132:135], a[124:127], v[216:219]
s_waitcnt lgkmcnt(2)
v_mfma_f32_16x16x32_bf16 v[164:167], a[136:139], a[64:67], v[164:167]
ds_read_b64_tr_b16 a[128:129], v10 offset:32768
v_mfma_f32_16x16x32_bf16 v[164:167], a[140:143], a[68:71], v[164:167]
v_mfma_f32_16x16x32_bf16 v[172:175], a[136:139], a[72:75], v[172:175]
ds_read_b64_tr_b16 a[130:131], v10 offset:34816
v_mfma_f32_16x16x32_bf16 v[172:175], a[140:143], a[76:79], v[172:175]
v_mfma_f32_16x16x32_bf16 v[180:183], a[136:139], a[80:83], v[180:183]
ds_read_b64_tr_b16 a[132:133], v10 offset:49152
v_mfma_f32_16x16x32_bf16 v[180:183], a[140:143], a[84:87], v[180:183]
v_mfma_f32_16x16x32_bf16 v[188:191], a[136:139], a[88:91], v[188:191]
ds_read_b64_tr_b16 a[134:135], v10 offset:51200
v_mfma_f32_16x16x32_bf16 v[188:191], a[140:143], a[92:95], v[188:191]
v_mfma_f32_16x16x32_bf16 v[196:199], a[136:139], a[96:99], v[196:199]
ds_read_b128 a[52:55], v3 offset:12288
v_mfma_f32_16x16x32_bf16 v[196:199], a[140:143], a[100:103], v[196:199]
v_mfma_f32_16x16x32_bf16 v[204:207], a[136:139], a[104:107], v[204:207]
ds_read_b128 a[56:59], v2 offset:14336
v_mfma_f32_16x16x32_bf16 v[204:207], a[140:143], a[108:111], v[204:207]
v_mfma_f32_16x16x32_bf16 v[212:215], a[136:139], a[112:115], v[212:215]
v_mfma_f32_16x16x32_bf16 v[212:215], a[140:143], a[116:119], v[212:215]
v_mfma_f32_16x16x32_bf16 v[220:223], a[136:139], a[120:123], v[220:223]
ds_read_b128 a[60:63], v3 offset:14336
v_mfma_f32_16x16x32_bf16 v[220:223], a[140:143], a[124:127], v[220:223]
s_waitcnt lgkmcnt(3)
v_mfma_f32_16x16x32_bf16 a[192:195], a[128:131], a[64:67], a[192:195]
ds_read_b64_tr_b16 a[136:137], v11 offset:32768
v_mfma_f32_16x16x32_bf16 a[192:195], a[132:135], a[68:71], a[192:195]
v_mfma_f32_16x16x32_bf16 a[200:203], a[128:131], a[72:75], a[200:203]
ds_read_b64_tr_b16 a[138:139], v11 offset:34816
v_mfma_f32_16x16x32_bf16 a[200:203], a[132:135], a[76:79], a[200:203]
v_mfma_f32_16x16x32_bf16 a[208:211], a[128:131], a[80:83], a[208:211]
ds_read_b64_tr_b16 a[140:141], v11 offset:49152
v_mfma_f32_16x16x32_bf16 a[208:211], a[132:135], a[84:87], a[208:211]
v_mfma_f32_16x16x32_bf16 a[216:219], a[128:131], a[88:91], a[216:219]
ds_read_b64_tr_b16 a[142:143], v11 offset:51200
v_mfma_f32_16x16x32_bf16 a[216:219], a[132:135], a[92:95], a[216:219]
v_mfma_f32_16x16x32_bf16 a[224:227], a[128:131], a[96:99], a[224:227]
v_mfma_f32_16x16x32_bf16 a[224:227], a[132:135], a[100:103], a[224:227]
v_mfma_f32_16x16x32_bf16 a[232:235], a[128:131], a[104:107], a[232:235]
v_mfma_f32_16x16x32_bf16 a[232:235], a[132:135], a[108:111], a[232:235]
v_mfma_f32_16x16x32_bf16 a[240:243], a[128:131], a[112:115], a[240:243]
v_mfma_f32_16x16x32_bf16 a[240:243], a[132:135], a[116:119], a[240:243]
v_mfma_f32_16x16x32_bf16 a[248:251], a[128:131], a[120:123], a[248:251]
s_waitcnt vmcnt(2) lgkmcnt(0)
v_mfma_f32_16x16x32_bf16 a[248:251], a[132:135], a[124:127], a[248:251]
s_barrier
v_mfma_f32_16x16x32_bf16 a[196:199], a[136:139], a[64:67], a[196:199]
s_add_u32 m0, s29, 98304
ds_read_b64_tr_b16 a[128:129], v4 offset:0
v_mfma_f32_16x16x32_bf16 a[196:199], a[140:143], a[68:71], a[196:199]
buffer_load_dwordx4 v16, s[12:15], s26 offen offset:0 lds
v_mfma_f32_16x16x32_bf16 a[204:207], a[136:139], a[72:75], a[204:207]
ds_read_b64_tr_b16 a[130:131], v4 offset:2048
v_mfma_f32_16x16x32_bf16 a[204:207], a[140:143], a[76:79], a[204:207]
v_mfma_f32_16x16x32_bf16 a[212:215], a[136:139], a[80:83], a[212:215]
ds_read_b64_tr_b16 a[132:133], v4 offset:16384
v_mfma_f32_16x16x32_bf16 a[212:215], a[140:143], a[84:87], a[212:215]
buffer_load_dwordx4 v17, s[12:15], s26 offen offset:1024 lds
v_mfma_f32_16x16x32_bf16 a[220:223], a[136:139], a[88:91], a[220:223]
ds_read_b64_tr_b16 a[134:135], v4 offset:18432
v_mfma_f32_16x16x32_bf16 a[220:223], a[140:143], a[92:95], a[220:223]
v_mfma_f32_16x16x32_bf16 a[228:231], a[136:139], a[96:99], a[228:231]
v_mfma_f32_16x16x32_bf16 a[228:231], a[140:143], a[100:103], a[228:231]
buffer_load_dwordx4 v18, s[12:15], s26 offen offset:2048 lds
v_mfma_f32_16x16x32_bf16 a[236:239], a[136:139], a[104:107], a[236:239]
v_mfma_f32_16x16x32_bf16 a[236:239], a[140:143], a[108:111], a[236:239]
v_mfma_f32_16x16x32_bf16 a[244:247], a[136:139], a[112:115], a[244:247]
v_mfma_f32_16x16x32_bf16 a[244:247], a[140:143], a[116:119], a[244:247]
buffer_load_dwordx4 v19, s[12:15], s26 offen offset:3072 lds
v_mfma_f32_16x16x32_bf16 a[252:255], a[136:139], a[120:123], a[252:255]
s_add_u32 s26, s26, 524288
v_mfma_f32_16x16x32_bf16 a[252:255], a[140:143], a[124:127], a[252:255]
s_waitcnt lgkmcnt(0)
buffer_store_dword v27, v26, s[4:7], s82 offen sc1
v_mfma_f32_16x16x32_bf16 v[32:35], a[128:131], a[0:3], v[32:35]
s_add_u32 m0, s29, 114688
ds_read_b64_tr_b16 a[136:137], v5 offset:0
v_mfma_f32_16x16x32_bf16 v[32:35], a[132:135], a[4:7], v[32:35]
buffer_load_dwordx4 v16, s[12:15], s27 offen offset:0 lds
v_mfma_f32_16x16x32_bf16 v[40:43], a[128:131], a[8:11], v[40:43]
ds_read_b64_tr_b16 a[138:139], v5 offset:2048
v_mfma_f32_16x16x32_bf16 v[40:43], a[132:135], a[12:15], v[40:43]
v_mfma_f32_16x16x32_bf16 v[48:51], a[128:131], a[16:19], v[48:51]
ds_read_b64_tr_b16 a[140:141], v5 offset:16384
v_mfma_f32_16x16x32_bf16 v[48:51], a[132:135], a[20:23], v[48:51]
buffer_load_dwordx4 v17, s[12:15], s27 offen offset:1024 lds
v_mfma_f32_16x16x32_bf16 v[56:59], a[128:131], a[24:27], v[56:59]
ds_read_b64_tr_b16 a[142:143], v5 offset:18432
v_mfma_f32_16x16x32_bf16 v[56:59], a[132:135], a[28:31], v[56:59]
v_mfma_f32_16x16x32_bf16 v[64:67], a[128:131], a[32:35], v[64:67]
ds_read_b128 a[64:67], v2 offset:32768
v_mfma_f32_16x16x32_bf16 v[64:67], a[132:135], a[36:39], v[64:67]
buffer_load_dwordx4 v18, s[12:15], s27 offen offset:2048 lds
v_mfma_f32_16x16x32_bf16 v[72:75], a[128:131], a[40:43], v[72:75]
ds_read_b128 a[68:71], v3 offset:32768
v_mfma_f32_16x16x32_bf16 v[72:75], a[132:135], a[44:47], v[72:75]
v_mfma_f32_16x16x32_bf16 v[80:83], a[128:131], a[48:51], v[80:83]
v_mfma_f32_16x16x32_bf16 v[80:83], a[132:135], a[52:55], v[80:83]
buffer_load_dwordx4 v19, s[12:15], s27 offen offset:3072 lds
v_mfma_f32_16x16x32_bf16 v[88:91], a[128:131], a[56:59], v[88:91]
s_add_u32 s27, s27, 524288
ds_read_b128 a[72:75], v2 offset:34816
v_mfma_f32_16x16x32_bf16 v[88:91], a[132:135], a[60:63], v[88:91]
s_waitcnt lgkmcnt(3)
v_mfma_f32_16x16x32_bf16 v[36:39], a[136:139], a[0:3], v[36:39]
s_add_u32 m0, s28, 0
ds_read_b64_tr_b16 a[128:129], v6 offset:0
v_mfma_f32_16x16x32_bf16 v[36:39], a[140:143], a[4:7], v[36:39]
buffer_load_dwordx4 v12, s[8:11], s24 offen offset:0 lds
v_mfma_f32_16x16x32_bf16 v[44:47], a[136:139], a[8:11], v[44:47]
ds_read_b64_tr_b16 a[130:131], v6 offset:2048
v_mfma_f32_16x16x32_bf16 v[44:47], a[140:143], a[12:15], v[44:47]
PAD_1:
s_cbranch_execz PAD_5
v_mfma_f32_16x16x32_bf16 v[52:55], a[136:139], a[16:19], v[52:55]
ds_read_b64_tr_b16 a[132:133], v6 offset:16384
v_mfma_f32_16x16x32_bf16 v[52:55], a[140:143], a[20:23], v[52:55]
buffer_load_dwordx4 v13, s[8:11], s24 offen offset:1024 lds
v_mfma_f32_16x16x32_bf16 v[60:63], a[136:139], a[24:27], v[60:63]
ds_read_b64_tr_b16 a[134:135], v6 offset:18432
v_mfma_f32_16x16x32_bf16 v[60:63], a[140:143], a[28:31], v[60:63]
v_mfma_f32_16x16x32_bf16 v[68:71], a[136:139], a[32:35], v[68:71]
ds_read_b128 a[76:79], v3 offset:34816
v_mfma_f32_16x16x32_bf16 v[68:71], a[140:143], a[36:39], v[68:71]
buffer_load_dwordx4 v14, s[8:11], s24 offen offset:2048 lds
v_mfma_f32_16x16x32_bf16 v[76:79], a[136:139], a[40:43], v[76:79]
v_mfma_f32_16x16x32_bf16 v[76:79], a[140:143], a[44:47], v[76:79]
v_mfma_f32_16x16x32_bf16 v[84:87], a[136:139], a[48:51], v[84:87]
ds_read_b128 a[80:83], v2 offset:36864
v_mfma_f32_16x16x32_bf16 v[84:87], a[140:143], a[52:55], v[84:87]
buffer_load_dwordx4 v15, s[8:11], s24 offen offset:3072 lds
v_mfma_f32_16x16x32_bf16 v[92:95], a[136:139], a[56:59], v[92:95]
s_add_u32 s24, s24, 128
ds_read_b128 a[84:87], v3 offset:36864
v_mfma_f32_16x16x32_bf16 v[92:95], a[140:143], a[60:63], v[92:95]
s_waitcnt lgkmcnt(3)
v_mfma_f32_16x16x32_bf16 v[96:99], a[128:131], a[0:3], v[96:99]
s_add_u32 m0, s28, 4096
ds_read_b64_tr_b16 a[136:137], v7 offset:0
v_mfma_f32_16x16x32_bf16 v[96:99], a[132:135], a[4:7], v[96:99]
buffer_load_dwordx4 v12, s[8:11], s25 offen offset:0 lds
v_mfma_f32_16x16x32_bf16 v[104:107], a[128:131], a[8:11], v[104:107]
ds_read_b64_tr_b16 a[138:139], v7 offset:2048
v_mfma_f32_16x16x32_bf16 v[104:107], a[132:135], a[12:15], v[104:107]
v_mfma_f32_16x16x32_bf16 v[112:115], a[128:131], a[16:19], v[112:115]
ds_read_b64_tr_b16 a[140:141], v7 offset:16384
v_mfma_f32_16x16x32_bf16 v[112:115], a[132:135], a[20:23], v[112:115]
buffer_load_dwordx4 v13, s[8:11], s25 offen offset:1024 lds
v_mfma_f32_16x16x32_bf16 v[120:123], a[128:131], a[24:27], v[120:123]
ds_read_b64_tr_b16 a[142:143], v7 offset:18432
v_mfma_f32_16x16x32_bf16 v[120:123], a[132:135], a[28:31], v[120:123]
v_mfma_f32_16x16x32_bf16 v[128:131], a[128:131], a[32:35], v[128:131]
v_mfma_f32_16x16x32_bf16 v[128:131], a[132:135], a[36:39], v[128:131]
buffer_load_dwordx4 v14, s[8:11], s25 offen offset:2048 lds
v_mfma_f32_16x16x32_bf16 v[136:139], a[128:131], a[40:43], v[136:139]
ds_read_b128 a[88:91], v2 offset:38912
v_mfma_f32_16x16x32_bf16 v[136:139], a[132:135], a[44:47], v[136:139]
v_mfma_f32_16x16x32_bf16 v[144:147], a[128:131], a[48:51], v[144:147]
ds_read_b128 a[92:95], v3 offset:38912
v_mfma_f32_16x16x32_bf16 v[144:147], a[132:135], a[52:55], v[144:147]
buffer_load_dwordx4 v15, s[8:11], s25 offen offset:3072 lds
v_mfma_f32_16x16x32_bf16 v[152:155], a[128:131], a[56:59], v[152:155]
s_add_u32 s25, s25, 128
v_mfma_f32_16x16x32_bf16 v[152:155], a[132:135], a[60:63], v[152:155]
s_waitcnt lgkmcnt(2)
v_mfma_f32_16x16x32_bf16 v[100:103], a[136:139], a[0:3], v[100:103]
ds_read_b64_tr_b16 a[128:129], v8 offset:0
v_mfma_f32_16x16x32_bf16 v[100:103], a[140:143], a[4:7], v[100:103]
buffer_load_dword v21, v20, s[16:19], s43 offen
v_mfma_f32_16x16x32_bf16 v[108:111], a[136:139], a[8:11], v[108:111]
s_add_u32 s43, s43, s47
ds_read_b64_tr_b16 a[130:131], v8 offset:2048
v_mfma_f32_16x16x32_bf16 v[108:111], a[140:143], a[12:15], v[108:111]
s_cmp_ge_u32 s43, s51
v_mfma_f32_16x16x32_bf16 v[116:119], a[136:139], a[16:19], v[116:119]
s_cselect_b32 s43, 0, s43
ds_read_b64_tr_b16 a[132:133], v8 offset:16384
v_mfma_f32_16x16x32_bf16 v[116:119], a[140:143], a[20:23], v[116:119]
s_cselect_b32 s51, s42, s51
v_mfma_f32_16x16x32_bf16 v[124:127], a[136:139], a[24:27], v[124:127]
s_cselect_b64 s[16:17], s[40:41], s[16:17]
ds_read_b64_tr_b16 a[134:135], v8 offset:18432
v_mfma_f32_16x16x32_bf16 v[124:127], a[140:143], a[28:31], v[124:127]
s_cselect_b32 s18, s42, s18
v_mfma_f32_16x16x32_bf16 v[132:135], a[136:139], a[32:35], v[132:135]
s_cselect_b64 s[40:41], s[44:45], s[40:41]
ds_read_b128 a[96:99], v2 offset:40960
v_mfma_f32_16x16x32_bf16 v[132:135], a[140:143], a[36:39], v[132:135]
s_cselect_b32 s42, s46, s42
v_mfma_f32_16x16x32_bf16 v[140:143], a[136:139], a[40:43], v[140:143]
s_cselect_b32 s46, 0, s46
v_mfma_f32_16x16x32_bf16 v[140:143], a[140:143], a[44:47], v[140:143]
s_cmp_eq_u32 s30, s55
v_mfma_f32_16x16x32_bf16 v[148:151], a[136:139], a[48:51], v[148:151]
s_cselect_b32 s22, 0, 3221225472
ds_read_b128 a[100:103], v3 offset:40960
v_mfma_f32_16x16x32_bf16 v[148:151], a[140:143], a[52:55], v[148:151]
s_sub_u32 s30, s30, 1
buffer_atomic_add v27, v26, s[60:63], s22 offen sc1
v_mfma_f32_16x16x32_bf16 v[156:159], a[136:139], a[56:59], v[156:159]
ds_read_b128 a[104:107], v2 offset:43008
v_mfma_f32_16x16x32_bf16 v[156:159], a[140:143], a[60:63], v[156:159]
s_waitcnt lgkmcnt(3)
v_mfma_f32_16x16x32_bf16 v[160:163], a[128:131], a[0:3], v[160:163]
ds_read_b64_tr_b16 a[136:137], v9 offset:0
v_mfma_f32_16x16x32_bf16 v[160:163], a[132:135], a[4:7], v[160:163]
v_mfma_f32_16x16x32_bf16 v[168:171], a[128:131], a[8:11], v[168:171]
ds_read_b64_tr_b16 a[138:139], v9 offset:2048
v_mfma_f32_16x16x32_bf16 v[168:171], a[132:135], a[12:15], v[168:171]
v_mfma_f32_16x16x32_bf16 v[176:179], a[128:131], a[16:19], v[176:179]
ds_read_b64_tr_b16 a[140:141], v9 offset:16384
v_mfma_f32_16x16x32_bf16 v[176:179], a[132:135], a[20:23], v[176:179]
v_mfma_f32_16x16x32_bf16 v[184:187], a[128:131], a[24:27], v[184:187]
ds_read_b64_tr_b16 a[142:143], v9 offset:18432
v_mfma_f32_16x16x32_bf16 v[184:187], a[132:135], a[28:31], v[184:187]
v_mfma_f32_16x16x32_bf16 v[192:195], a[128:131], a[32:35], v[192:195]
v_mfma_f32_16x16x32_bf16 v[192:195], a[132:135], a[36:39], v[192:195]
v_mfma_f32_16x16x32_bf16 v[200:203], a[128:131], a[40:43], v[200:203]
ds_read_b128 a[108:111], v3 offset:43008
v_mfma_f32_16x16x32_bf16 v[200:203], a[132:135], a[44:47], v[200:203]
v_mfma_f32_16x16x32_bf16 v[208:211], a[128:131], a[48:51], v[208:211]
ds_read_b128 a[112:115], v2 offset:45056
v_mfma_f32_16x16x32_bf16 v[208:211], a[132:135], a[52:55], v[208:211]
v_mfma_f32_16x16x32_bf16 v[216:219], a[128:131], a[56:59], v[216:219]
v_mfma_f32_16x16x32_bf16 v[216:219], a[132:135], a[60:63], v[216:219]
s_waitcnt lgkmcnt(2)
v_mfma_f32_16x16x32_bf16 v[164:167], a[136:139], a[0:3], v[164:167]
ds_read_b64_tr_b16 a[128:129], v10 offset:0
v_mfma_f32_16x16x32_bf16 v[164:167], a[140:143], a[4:7], v[164:167]
v_mfma_f32_16x16x32_bf16 v[172:175], a[136:139], a[8:11], v[172:175]
ds_read_b64_tr_b16 a[130:131], v10 offset:2048
v_mfma_f32_16x16x32_bf16 v[172:175], a[140:143], a[12:15], v[172:175]
v_mfma_f32_16x16x32_bf16 v[180:183], a[136:139], a[16:19], v[180:183]
ds_read_b64_tr_b16 a[132:133], v10 offset:16384
v_mfma_f32_16x16x32_bf16 v[180:183], a[140:143], a[20:23], v[180:183]
v_mfma_f32_16x16x32_bf16 v[188:191], a[136:139], a[24:27], v[188:191]
ds_read_b64_tr_b16 a[134:135], v10 offset:18432
v_mfma_f32_16x16x32_bf16 v[188:191], a[140:143], a[28:31], v[188:191]
v_mfma_f32_16x16x32_bf16 v[196:199], a[136:139], a[32:35], v[196:199]
ds_read_b128 a[116:119], v3 offset:45056
v_mfma_f32_16x16x32_bf16 v[196:199], a[140:143], a[36:39], v[196:199]
v_mfma_f32_16x16x32_bf16 v[204:207], a[136:139], a[40:43], v[204:207]
ds_read_b128 a[120:123], v2 offset:47104
v_mfma_f32_16x16x32_bf16 v[204:207], a[140:143], a[44:47], v[204:207]
v_mfma_f32_16x16x32_bf16 v[212:215], a[136:139], a[48:51], v[212:215]
v_mfma_f32_16x16x32_bf16 v[212:215], a[140:143], a[52:55], v[212:215]
v_mfma_f32_16x16x32_bf16 v[220:223], a[136:139], a[56:59], v[220:223]
ds_read_b128 a[124:127], v3 offset:47104
v_mfma_f32_16x16x32_bf16 v[220:223], a[140:143], a[60:63], v[220:223]
s_waitcnt lgkmcnt(3)
v_mfma_f32_16x16x32_bf16 a[192:195], a[128:131], a[0:3], a[192:195]
ds_read_b64_tr_b16 a[136:137], v11 offset:0
v_mfma_f32_16x16x32_bf16 a[192:195], a[132:135], a[4:7], a[192:195]
v_mfma_f32_16x16x32_bf16 a[200:203], a[128:131], a[8:11], a[200:203]
ds_read_b64_tr_b16 a[138:139], v11 offset:2048
v_mfma_f32_16x16x32_bf16 a[200:203], a[132:135], a[12:15], a[200:203]
v_mfma_f32_16x16x32_bf16 a[208:211], a[128:131], a[16:19], a[208:211]
ds_read_b64_tr_b16 a[140:141], v11 offset:16384
v_mfma_f32_16x16x32_bf16 a[208:211], a[132:135], a[20:23], a[208:211]
v_mfma_f32_16x16x32_bf16 a[216:219], a[128:131], a[24:27], a[216:219]
ds_read_b64_tr_b16 a[142:143], v11 offset:18432
v_mfma_f32_16x16x32_bf16 a[216:219], a[132:135], a[28:31], a[216:219]
v_mfma_f32_16x16x32_bf16 a[224:227], a[128:131], a[32:35], a[224:227]
v_mfma_f32_16x16x32_bf16 a[224:227], a[132:135], a[36:39], a[224:227]
v_mfma_f32_16x16x32_bf16 a[232:235], a[128:131], a[40:43], a[232:235]
v_mfma_f32_16x16x32_bf16 a[232:235], a[132:135], a[44:47], a[232:235]
v_mfma_f32_16x16x32_bf16 a[240:243], a[128:131], a[48:51], a[240:243]
v_mfma_f32_16x16x32_bf16 a[240:243], a[132:135], a[52:55], a[240:243]
v_mfma_f32_16x16x32_bf16 a[248:251], a[128:131], a[56:59], a[248:251]
s_waitcnt vmcnt(2) lgkmcnt(0)
v_mfma_f32_16x16x32_bf16 a[248:251], a[132:135], a[60:63], a[248:251]
s_barrier
v_mfma_f32_16x16x32_bf16 a[196:199], a[136:139], a[0:3], a[196:199]
s_add_u32 m0, s29, 65536
ds_read_b64_tr_b16 a[128:129], v4 offset:32768
v_mfma_f32_16x16x32_bf16 a[196:199], a[140:143], a[4:7], a[196:199]
buffer_load_dwordx4 v16, s[12:15], s26 offen offset:0 lds
v_mfma_f32_16x16x32_bf16 a[204:207], a[136:139], a[8:11], a[204:207]
ds_read_b64_tr_b16 a[130:131], v4 offset:34816
v_mfma_f32_16x16x32_bf16 a[204:207], a[140:143], a[12:15], a[204:207]
v_mfma_f32_16x16x32_bf16 a[212:215], a[136:139], a[16:19], a[212:215]
ds_read_b64_tr_b16 a[132:133], v4 offset:49152
v_mfma_f32_16x16x32_bf16 a[212:215], a[140:143], a[20:23], a[212:215]
buffer_load_dwordx4 v17, s[12:15], s26 offen offset:1024 lds
v_mfma_f32_16x16x32_bf16 a[220:223], a[136:139], a[24:27], a[220:223]
ds_read_b64_tr_b16 a[134:135], v4 offset:51200
v_mfma_f32_16x16x32_bf16 a[220:223], a[140:143], a[28:31], a[220:223]
v_mfma_f32_16x16x32_bf16 a[228:231], a[136:139], a[32:35], a[228:231]
v_mfma_f32_16x16x32_bf16 a[228:231], a[140:143], a[36:39], a[228:231]
buffer_load_dwordx4 v18, s[12:15], s26 offen offset:2048 lds
v_mfma_f32_16x16x32_bf16 a[236:239], a[136:139], a[40:43], a[236:239]
v_mfma_f32_16x16x32_bf16 a[236:239], a[140:143], a[44:47], a[236:239]
v_mfma_f32_16x16x32_bf16 a[244:247], a[136:139], a[48:51], a[244:247]
v_mfma_f32_16x16x32_bf16 a[244:247], a[140:143], a[52:55], a[244:247]
s_waitcnt lgkmcnt(0)
buffer_load_dwordx4 v19, s[12:15], s26 offen offset:3072 lds
v_mfma_f32_16x16x32_bf16 a[252:255], a[136:139], a[56:59], a[252:255]
s_add_u32 s26, s26, 524288
s_bitcmp1_b32 s30, 1
v_mfma_f32_16x16x32_bf16 a[252:255], a[140:143], a[60:63], a[252:255]
s_cbranch_scc1 Lg_1
s_cmp_eq_u32 s30, 0
s_cbranch_scc1 Lg_1t
v_mfma_f32_16x16x32_bf16 v[32:35], a[128:131], a[64:67], v[32:35]
s_add_u32 m0, s29, 81920
ds_read_b64_tr_b16 a[136:137], v5 offset:32768
v_mfma_f32_16x16x32_bf16 v[32:35], a[132:135], a[68:71], v[32:35]
buffer_load_dwordx4 v16, s[12:15], s27 offen offset:0 lds
v_mfma_f32_16x16x32_bf16 v[40:43], a[128:131], a[72:75], v[40:43]
s_lshl_b32 s22, s38, 3
ds_read_b64_tr_b16 a[138:139], v5 offset:34816
v_mfma_f32_16x16x32_bf16 v[40:43], a[132:135], a[76:79], v[40:43]
s_lshl_b32 s23, s39, 5
v_and_b32 v252, 31, v0
v_lshrrev_b32 v253, 5, v0
v_mfma_f32_16x16x32_bf16 v[48:51], a[128:131], a[80:83], v[48:51]
ds_read_b64_tr_b16 a[140:141], v5 offset:49152
v_add_u32 v253, s22, v253
v_mfma_f32_16x16x32_bf16 v[48:51], a[132:135], a[84:87], v[48:51]
buffer_load_dwordx4 v17, s[12:15], s27 offen offset:1024 lds
v_mfma_f32_16x16x32_bf16 v[56:59], a[128:131], a[88:91], v[56:59]
ds_read_b64_tr_b16 a[142:143], v5 offset:51200
v_add_u32 v252, s23, v252
v_mfma_f32_16x16x32_bf16 v[56:59], a[132:135], a[92:95], v[56:59]
v_mul_u32_u24 v254, 7168, v253
v_lshl_add_u32 v254, v252, 2, v254
v_mfma_f32_16x16x32_bf16 v[64:67], a[128:131], a[96:99], v[64:67]
ds_read_b128 a[0:3], v2 offset:0
v_lshlrev_b32 v252, 4, v252
v_mfma_f32_16x16x32_bf16 v[64:67], a[132:135], a[100:103], v[64:67]
buffer_load_dwordx4 v18, s[12:15], s27 offen offset:2048 lds
v_mfma_f32_16x16x32_bf16 v[72:75], a[128:131], a[104:107], v[72:75]
ds_read_b128 a[4:7], v3 offset:0
v_add_u32 v255, 3584, v254
v_mfma_f32_16x16x32_bf16 v[72:75], a[132:135], a[108:111], v[72:75]
v_subrev_u32 v22, 3584, v254
v_subrev_u32 v23, 2688, v254
v_mfma_f32_16x16x32_bf16 v[80:83], a[128:131], a[112:115], v[80:83]
v_subrev_u32 v24, 1792, v254
v_subrev_u32 v25, 896, v254
v_mfma_f32_16x16x32_bf16 v[80:83], a[132:135], a[116:119], v[80:83]
buffer_load_dwordx4 v19, s[12:15], s27 offen offset:3072 lds
v_mfma_f32_16x16x32_bf16 v[88:91], a[128:131], a[120:123], v[88:91]
s_add_u32 s27, s27, 524288
ds_read_b128 a[8:11], v2 offset:2048
v_mfma_f32_16x16x32_bf16 v[88:91], a[132:135], a[124:127], v[88:91]
s_waitcnt lgkmcnt(3)
v_mfma_f32_16x16x32_bf16 v[36:39], a[136:139], a[64:67], v[36:39]
s_add_u32 m0, s28, 32768
ds_read_b64_tr_b16 a[128:129], v6 offset:32768
v_mfma_f32_16x16x32_bf16 v[36:39], a[140:143], a[68:71], v[36:39]
buffer_load_dwordx4 v12, s[8:11], s24 offen offset:0 lds
v_mfma_f32_16x16x32_bf16 v[44:47], a[136:139], a[72:75], v[44:47]
ds_read_b64_tr_b16 a[130:131], v6 offset:34816
v_mfma_f32_16x16x32_bf16 v[44:47], a[140:143], a[76:79], v[44:47]
v_mfma_f32_16x16x32_bf16 v[52:55], a[136:139], a[80:83], v[52:55]
ds_read_b64_tr_b16 a[132:133], v6 offset:49152
v_mfma_f32_16x16x32_bf16 v[52:55], a[140:143], a[84:87], v[52:55]
buffer_load_dwordx4 v13, s[8:11], s24 offen offset:1024 lds
v_mfma_f32_16x16x32_bf16 v[60:63], a[136:139], a[88:91], v[60:63]
ds_read_b64_tr_b16 a[134:135], v6 offset:51200
v_mfma_f32_16x16x32_bf16 v[60:63], a[140:143], a[92:95], v[60:63]
v_mfma_f32_16x16x32_bf16 v[68:71], a[136:139], a[96:99], v[68:71]
ds_read_b128 a[12:15], v3 offset:2048
v_mfma_f32_16x16x32_bf16 v[68:71], a[140:143], a[100:103], v[68:71]
buffer_load_dwordx4 v14, s[8:11], s24 offen offset:2048 lds
v_mfma_f32_16x16x32_bf16 v[76:79], a[136:139], a[104:107], v[76:79]
v_mfma_f32_16x16x32_bf16 v[76:79], a[140:143], a[108:111], v[76:79]
v_mfma_f32_16x16x32_bf16 v[84:87], a[136:139], a[112:115], v[84:87]
ds_read_b128 a[16:19], v2 offset:4096
v_mfma_f32_16x16x32_bf16 v[84:87], a[140:143], a[116:119], v[84:87]
buffer_load_dwordx4 v15, s[8:11], s24 offen offset:3072 lds
v_mfma_f32_16x16x32_bf16 v[92:95], a[136:139], a[120:123], v[92:95]
s_add_u32 s24, s24, 128
ds_read_b128 a[20:23], v3 offset:4096
v_mfma_f32_16x16x32_bf16 v[92:95], a[140:143], a[124:127], v[92:95]
s_waitcnt lgkmcnt(3)
v_mfma_f32_16x16x32_bf16 v[96:99], a[128:131], a[64:67], v[96:99]
s_add_u32 m0, s28, 36864
ds_read_b64_tr_b16 a[136:137], v7 offset:32768
v_mfma_f32_16x16x32_bf16 v[96:99], a[132:135], a[68:71], v[96:99]
buffer_load_dwordx4 v12, s[8:11], s25 offen offset:0 lds
v_mfma_f32_16x16x32_bf16 v[104:107], a[128:131], a[72:75], v[104:107]
ds_read_b64_tr_b16 a[138:139], v7 offset:34816
v_mfma_f32_16x16x32_bf16 v[104:107], a[132:135], a[76:79], v[104:107]
v_mfma_f32_16x16x32_bf16 v[112:115], a[128:131], a[80:83], v[112:115]
ds_read_b64_tr_b16 a[140:141], v7 offset:49152
v_mfma_f32_16x16x32_bf16 v[112:115], a[132:135], a[84:87], v[112:115]
buffer_load_dwordx4 v13, s[8:11], s25 offen offset:1024 lds
v_mfma_f32_16x16x32_bf16 v[120:123], a[128:131], a[88:91], v[120:123]
ds_read_b64_tr_b16 a[142:143], v7 offset:51200
v_mfma_f32_16x16x32_bf16 v[120:123], a[132:135], a[92:95], v[120:123]
v_mfma_f32_16x16x32_bf16 v[128:131], a[128:131], a[96:99], v[128:131]
v_mfma_f32_16x16x32_bf16 v[128:131], a[132:135], a[100:103], v[128:131]
buffer_load_dwordx4 v14, s[8:11], s25 offen offset:2048 lds
v_mfma_f32_16x16x32_bf16 v[136:139], a[128:131], a[104:107], v[136:139]
ds_read_b128 a[24:27], v2 offset:6144
v_mfma_f32_16x16x32_bf16 v[136:139], a[132:135], a[108:111], v[136:139]
v_mfma_f32_16x16x32_bf16 v[144:147], a[128:131], a[112:115], v[144:147]
ds_read_b128 a[28:31], v3 offset:6144
v_mfma_f32_16x16x32_bf16 v[144:147], a[132:135], a[116:119], v[144:147]
buffer_load_dwordx4 v15, s[8:11], s25 offen offset:3072 lds
v_mfma_f32_16x16x32_bf16 v[152:155], a[128:131], a[120:123], v[152:155]
s_add_u32 s25, s25, 128
v_mfma_f32_16x16x32_bf16 v[152:155], a[132:135], a[124:127], v[152:155]
s_waitcnt lgkmcnt(2)
v_mfma_f32_16x16x32_bf16 v[100:103], a[136:139], a[64:67], v[100:103]
s_mov_b64 s[56:57], s[70:71]
s_mov_b32 s58, 3584
s_mov_b32 s59, 0x20000
ds_read_b64_tr_b16 a[128:129], v8 offset:32768
buffer_load_dwordx4 v[248:251], v252, s[56:59], 0 offen
v_mfma_f32_16x16x32_bf16 v[100:103], a[140:143], a[68:71], v[100:103]
s_mov_b64 s[56:57], s[66:67]
s_mov_b32 s58, 1835008
buffer_load_dword v224, v22, s[56:59], 0 offen nt
v_mfma_f32_16x16x32_bf16 v[108:111], a[136:139], a[72:75], v[108:111]
ds_read_b64_tr_b16 a[130:131], v8 offset:34816
buffer_load_dword v225, v23, s[56:59], 0 offen nt
v_mfma_f32_16x16x32_bf16 v[108:111], a[140:143], a[76:79], v[108:111]
buffer_load_dword v226, v24, s[56:59], 0 offen nt
v_mfma_f32_16x16x32_bf16 v[116:119], a[136:139], a[80:83], v[116:119]
ds_read_b64_tr_b16 a[132:133], v8 offset:49152
buffer_load_dword v227, v25, s[56:59], 0 offen nt
v_mfma_f32_16x16x32_bf16 v[116:119], a[140:143], a[84:87], v[116:119]
buffer_load_dword v228, v254, s[56:59], 0 offen offset:0 nt
v_mfma_f32_16x16x32_bf16 v[124:127], a[136:139], a[88:91], v[124:127]
ds_read_b64_tr_b16 a[134:135], v8 offset:51200
buffer_load_dword v229, v254, s[56:59], 0 offen offset:896 nt
v_mfma_f32_16x16x32_bf16 v[124:127], a[140:143], a[92:95], v[124:127]
buffer_load_dword v230, v254, s[56:59], 0 offen offset:1792 nt
v_mfma_f32_16x16x32_bf16 v[132:135], a[136:139], a[96:99], v[132:135]
ds_read_b128 a[32:35], v2 offset:8192
buffer_load_dword v231, v254, s[56:59], 0 offen offset:2688 nt
v_mfma_f32_16x16x32_bf16 v[132:135], a[140:143], a[100:103], v[132:135]
buffer_load_dword v232, v255, s[56:59], 0 offen offset:0 nt
v_mfma_f32_16x16x32_bf16 v[140:143], a[136:139], a[104:107], v[140:143]
buffer_load_dword v233, v255, s[56:59], 0 offen offset:896 nt
v_mfma_f32_16x16x32_bf16 v[140:143], a[140:143], a[108:111], v[140:143]
buffer_load_dword v234, v255, s[56:59], 0 offen offset:1792 nt
v_mfma_f32_16x16x32_bf16 v[148:151], a[136:139], a[112:115], v[148:151]
ds_read_b128 a[36:39], v3 offset:8192
buffer_load_dword v235, v255, s[56:59], 0 offen offset:2688 nt
v_mfma_f32_16x16x32_bf16 v[148:151], a[140:143], a[116:119], v[148:151]
s_mov_b64 s[56:57], s[68:69]
buffer_load_dword v236, v25, s[56:59], 0 offen nt
v_mfma_f32_16x16x32_bf16 v[156:159], a[136:139], a[120:123], v[156:159]
ds_read_b128 a[40:43], v2 offset:10240
buffer_load_dword v237, v254, s[56:59], 0 offen offset:0 nt
v_mfma_f32_16x16x32_bf16 v[156:159], a[140:143], a[124:127], v[156:159]
s_waitcnt lgkmcnt(3)
buffer_load_dword v238, v254, s[56:59], 0 offen offset:896 nt
v_mfma_f32_16x16x32_bf16 v[160:163], a[128:131], a[64:67], v[160:163]
ds_read_b64_tr_b16 a[136:137], v9 offset:32768
buffer_load_dword v239, v254, s[56:59], 0 offen offset:1792 nt
v_mfma_f32_16x16x32_bf16 v[160:163], a[132:135], a[68:71], v[160:163]
buffer_load_dword v240, v254, s[56:59], 0 offen offset:2688 nt
v_mfma_f32_16x16x32_bf16 v[168:171], a[128:131], a[72:75], v[168:171]
ds_read_b64_tr_b16 a[138:139], v9 offset:34816
buffer_load_dword v241, v255, s[56:59], 0 offen offset:0 nt
v_mfma_f32_16x16x32_bf16 v[168:171], a[132:135], a[76:79], v[168:171]
buffer_load_dword v242, v255, s[56:59], 0 offen offset:896 nt
v_mfma_f32_16x16x32_bf16 v[176:179], a[128:131], a[80:83], v[176:179]
ds_read_b64_tr_b16 a[140:141], v9 offset:49152
buffer_load_dword v243, v255, s[56:59], 0 offen offset:1792 nt
v_mfma_f32_16x16x32_bf16 v[176:179], a[132:135], a[84:87], v[176:179]
buffer_load_dword v244, v255, s[56:59], 0 offen offset:2688 nt
v_mfma_f32_16x16x32_bf16 v[184:187], a[128:131], a[88:91], v[184:187]
ds_read_b64_tr_b16 a[142:143], v9 offset:51200
v_mfma_f32_16x16x32_bf16 v[184:187], a[132:135], a[92:95], v[184:187]
v_mfma_f32_16x16x32_bf16 v[192:195], a[128:131], a[96:99], v[192:195]
v_mfma_f32_16x16x32_bf16 v[192:195], a[132:135], a[100:103], v[192:195]
v_mfma_f32_16x16x32_bf16 v[200:203], a[128:131], a[104:107], v[200:203]
ds_read_b128 a[44:47], v3 offset:10240
v_mfma_f32_16x16x32_bf16 v[200:203], a[132:135], a[108:111], v[200:203]
v_mfma_f32_16x16x32_bf16 v[208:211], a[128:131], a[112:115], v[208:211]
ds_read_b128 a[48:51], v2 offset:12288
v_mfma_f32_16x16x32_bf16 v[208:211], a[132:135], a[116:119], v[208:211]
v_mfma_f32_16x16x32_bf16 v[216:219], a[128:131], a[120:123], v[216:219]
v_mfma_f32_16x16x32_bf16 v[216:219], a[132:135], a[124:127], v[216:219]
s_waitcnt lgkmcnt(2)
v_mfma_f32_16x16x32_bf16 v[164:167], a[136:139], a[64:67], v[164:167]
ds_read_b64_tr_b16 a[128:129], v10 offset:32768
v_mfma_f32_16x16x32_bf16 v[164:167], a[140:143], a[68:71], v[164:167]
v_mfma_f32_16x16x32_bf16 v[172:175], a[136:139], a[72:75], v[172:175]
ds_read_b64_tr_b16 a[130:131], v10 offset:34816
v_mfma_f32_16x16x32_bf16 v[172:175], a[140:143], a[76:79], v[172:175]
v_mfma_f32_16x16x32_bf16 v[180:183], a[136:139], a[80:83], v[180:183]
ds_read_b64_tr_b16 a[132:133], v10 offset:49152
v_mfma_f32_16x16x32_bf16 v[180:183], a[140:143], a[84:87], v[180:183]
v_mfma_f32_16x16x32_bf16 v[188:191], a[136:139], a[88:91], v[188:191]
ds_read_b64_tr_b16 a[134:135], v10 offset:51200
v_mfma_f32_16x16x32_bf16 v[188:191], a[140:143], a[92:95], v[188:191]
v_mfma_f32_16x16x32_bf16 v[196:199], a[136:139], a[96:99], v[196:199]
ds_read_b128 a[52:55], v3 offset:12288
v_mfma_f32_16x16x32_bf16 v[196:199], a[140:143], a[100:103], v[196:199]
v_mfma_f32_16x16x32_bf16 v[204:207], a[136:139], a[104:107], v[204:207]
ds_read_b128 a[56:59], v2 offset:14336
v_mfma_f32_16x16x32_bf16 v[204:207], a[140:143], a[108:111], v[204:207]
v_mfma_f32_16x16x32_bf16 v[212:215], a[136:139], a[112:115], v[212:215]
v_mfma_f32_16x16x32_bf16 v[212:215], a[140:143], a[116:119], v[212:215]
v_mfma_f32_16x16x32_bf16 v[220:223], a[136:139], a[120:123], v[220:223]
ds_read_b128 a[60:63], v3 offset:14336
v_mfma_f32_16x16x32_bf16 v[220:223], a[140:143], a[124:127], v[220:223]
s_waitcnt lgkmcnt(3)
v_mfma_f32_16x16x32_bf16 a[192:195], a[128:131], a[64:67], a[192:195]
ds_read_b64_tr_b16 a[136:137], v11 offset:32768
v_mfma_f32_16x16x32_bf16 a[192:195], a[132:135], a[68:71], a[192:195]
v_mfma_f32_16x16x32_bf16 a[200:203], a[128:131], a[72:75], a[200:203]
ds_read_b64_tr_b16 a[138:139], v11 offset:34816
v_mfma_f32_16x16x32_bf16 a[200:203], a[132:135], a[76:79], a[200:203]
v_mfma_f32_16x16x32_bf16 a[208:211], a[128:131], a[80:83], a[208:211]
ds_read_b64_tr_b16 a[140:141], v11 offset:49152
v_mfma_f32_16x16x32_bf16 a[208:211], a[132:135], a[84:87], a[208:211]
v_mfma_f32_16x16x32_bf16 a[216:219], a[128:131], a[88:91], a[216:219]
ds_read_b64_tr_b16 a[142:143], v11 offset:51200
v_mfma_f32_16x16x32_bf16 a[216:219], a[132:135], a[92:95], a[216:219]
v_mfma_f32_16x16x32_bf16 a[224:227], a[128:131], a[96:99], a[224:227]
v_mfma_f32_16x16x32_bf16 a[224:227], a[132:135], a[100:103], a[224:227]
v_mfma_f32_16x16x32_bf16 a[232:235], a[128:131], a[104:107], a[232:235]
v_mfma_f32_16x16x32_bf16 a[232:235], a[132:135], a[108:111], a[232:235]
v_mfma_f32_16x16x32_bf16 a[240:243], a[128:131], a[112:115], a[240:243]
v_mfma_f32_16x16x32_bf16 a[240:243], a[132:135], a[116:119], a[240:243]
v_mfma_f32_16x16x32_bf16 a[248:251], a[128:131], a[120:123], a[248:251]
s_waitcnt vmcnt(22) lgkmcnt(0)
v_mfma_f32_16x16x32_bf16 a[248:251], a[132:135], a[124:127], a[248:251]
s_barrier
v_mfma_f32_16x16x32_bf16 a[196:199], a[136:139], a[64:67], a[196:199]
s_add_u32 m0, s29, 98304
ds_read_b64_tr_b16 a[128:129], v4 offset:0
v_mfma_f32_16x16x32_bf16 a[196:199], a[140:143], a[68:71], a[196:199]
buffer_load_dwordx4 v16, s[12:15], s26 offen offset:0 lds
v_mfma_f32_16x16x32_bf16 a[204:207], a[136:139], a[72:75], a[204:207]
ds_read_b64_tr_b16 a[130:131], v4 offset:2048
v_mfma_f32_16x16x32_bf16 a[204:207], a[140:143], a[76:79], a[204:207]
v_mfma_f32_16x16x32_bf16 a[212:215], a[136:139], a[80:83], a[212:215]
ds_read_b64_tr_b16 a[132:133], v4 offset:16384
v_mfma_f32_16x16x32_bf16 a[212:215], a[140:143], a[84:87], a[212:215]
buffer_load_dwordx4 v17, s[12:15], s26 offen offset:1024 lds
v_mfma_f32_16x16x32_bf16 a[220:223], a[136:139], a[88:91], a[220:223]
ds_read_b64_tr_b16 a[134:135], v4 offset:18432
v_mfma_f32_16x16x32_bf16 a[220:223], a[140:143], a[92:95], a[220:223]
v_mfma_f32_16x16x32_bf16 a[228:231], a[136:139], a[96:99], a[228:231]
v_mfma_f32_16x16x32_bf16 a[228:231], a[140:143], a[100:103], a[228:231]
buffer_load_dwordx4 v18, s[12:15], s26 offen offset:2048 lds
v_mfma_f32_16x16x32_bf16 a[236:239], a[136:139], a[104:107], a[236:239]
v_mfma_f32_16x16x32_bf16 a[236:239], a[140:143], a[108:111], a[236:239]
v_mfma_f32_16x16x32_bf16 a[244:247], a[136:139], a[112:115], a[244:247]
v_mfma_f32_16x16x32_bf16 a[244:247], a[140:143], a[116:119], a[244:247]
buffer_load_dwordx4 v19, s[12:15], s26 offen offset:3072 lds
v_mfma_f32_16x16x32_bf16 a[252:255], a[136:139], a[120:123], a[252:255]
s_add_u32 s26, s26, 524288
v_mfma_f32_16x16x32_bf16 a[252:255], a[140:143], a[124:127], a[252:255]
s_waitcnt lgkmcnt(0)
v_mfma_f32_16x16x32_bf16 v[32:35], a[128:131], a[0:3], v[32:35]
s_add_u32 m0, s29, 114688
ds_read_b64_tr_b16 a[136:137], v5 offset:0
v_mfma_f32_16x16x32_bf16 v[32:35], a[132:135], a[4:7], v[32:35]
buffer_load_dwordx4 v16, s[12:15], s27 offen offset:0 lds
v_mfma_f32_16x16x32_bf16 v[40:43], a[128:131], a[8:11], v[40:43]
ds_read_b64_tr_b16 a[138:139], v5 offset:2048
v_mfma_f32_16x16x32_bf16 v[40:43], a[132:135], a[12:15], v[40:43]
v_mfma_f32_16x16x32_bf16 v[48:51], a[128:131], a[16:19], v[48:51]
ds_read_b64_tr_b16 a[140:141], v5 offset:16384
v_mfma_f32_16x16x32_bf16 v[48:51], a[132:135], a[20:23], v[48:51]
buffer_load_dwordx4 v17, s[12:15], s27 offen offset:1024 lds
v_mfma_f32_16x16x32_bf16 v[56:59], a[128:131], a[24:27], v[56:59]
ds_read_b64_tr_b16 a[142:143], v5 offset:18432
v_mfma_f32_16x16x32_bf16 v[56:59], a[132:135], a[28:31], v[56:59]
v_mfma_f32_16x16x32_bf16 v[64:67], a[128:131], a[32:35], v[64:67]
ds_read_b128 a[64:67], v2 offset:32768
v_mfma_f32_16x16x32_bf16 v[64:67], a[132:135], a[36:39], v[64:67]
buffer_load_dwordx4 v18, s[12:15], s27 offen offset:2048 lds
v_mfma_f32_16x16x32_bf16 v[72:75], a[128:131], a[40:43], v[72:75]
ds_read_b128 a[68:71], v3 offset:32768
v_mfma_f32_16x16x32_bf16 v[72:75], a[132:135], a[44:47], v[72:75]
v_mfma_f32_16x16x32_bf16 v[80:83], a[128:131], a[48:51], v[80:83]
v_mfma_f32_16x16x32_bf16 v[80:83], a[132:135], a[52:55], v[80:83]
buffer_load_dwordx4 v19, s[12:15], s27 offen offset:3072 lds
v_mfma_f32_16x16x32_bf16 v[88:91], a[128:131], a[56:59], v[88:91]
s_add_u32 s27, s27, 524288
ds_read_b128 a[72:75], v2 offset:34816
v_mfma_f32_16x16x32_bf16 v[88:91], a[132:135], a[60:63], v[88:91]
s_waitcnt lgkmcnt(3)
v_mfma_f32_16x16x32_bf16 v[36:39], a[136:139], a[0:3], v[36:39]
s_add_u32 m0, s28, 0
ds_read_b64_tr_b16 a[128:129], v6 offset:0
v_mfma_f32_16x16x32_bf16 v[36:39], a[140:143], a[4:7], v[36:39]
buffer_load_dwordx4 v12, s[8:11], s24 offen offset:0 lds
v_mfma_f32_16x16x32_bf16 v[44:47], a[136:139], a[8:11], v[44:47]
ds_read_b64_tr_b16 a[130:131], v6 offset:2048
v_mfma_f32_16x16x32_bf16 v[44:47], a[140:143], a[12:15], v[44:47]
v_mfma_f32_16x16x32_bf16 v[52:55], a[136:139], a[16:19], v[52:55]
ds_read_b64_tr_b16 a[132:133], v6 offset:16384
v_mfma_f32_16x16x32_bf16 v[52:55], a[140:143], a[20:23], v[52:55]
buffer_load_dwordx4 v13, s[8:11], s24 offen offset:1024 lds
v_mfma_f32_16x16x32_bf16 v[60:63], a[136:139], a[24:27], v[60:63]
ds_read_b64_tr_b16 a[134:135], v6 offset:18432
v_mfma_f32_16x16x32_bf16 v[60:63], a[140:143], a[28:31], v[60:63]
v_mfma_f32_16x16x32_bf16 v[68:71], a[136:139], a[32:35], v[68:71]
ds_read_b128 a[76:79], v3 offset:34816
v_mfma_f32_16x16x32_bf16 v[68:71], a[140:143], a[36:39], v[68:71]
buffer_load_dwordx4 v14, s[8:11], s24 offen offset:2048 lds
v_mfma_f32_16x16x32_bf16 v[76:79], a[136:139], a[40:43], v[76:79]
v_mfma_f32_16x16x32_bf16 v[76:79], a[140:143], a[44:47], v[76:79]
v_mfma_f32_16x16x32_bf16 v[84:87], a[136:139], a[48:51], v[84:87]
ds_read_b128 a[80:83], v2 offset:36864
v_mfma_f32_16x16x32_bf16 v[84:87], a[140:143], a[52:55], v[84:87]
buffer_load_dwordx4 v15, s[8:11], s24 offen offset:3072 lds
v_mfma_f32_16x16x32_bf16 v[92:95], a[136:139], a[56:59], v[92:95]
s_add_u32 s24, s24, 128
ds_read_b128 a[84:87], v3 offset:36864
v_mfma_f32_16x16x32_bf16 v[92:95], a[140:143], a[60:63], v[92:95]
s_waitcnt lgkmcnt(3)
v_mfma_f32_16x16x32_bf16 v[96:99], a[128:131], a[0:3], v[96:99]
s_add_u32 m0, s28, 4096
ds_read_b64_tr_b16 a[136:137], v7 offset:0
v_mfma_f32_16x16x32_bf16 v[96:99], a[132:135], a[4:7], v[96:99]
buffer_load_dwordx4 v12, s[8:11], s25 offen offset:0 lds
v_mfma_f32_16x16x32_bf16 v[104:107], a[128:131], a[8:11], v[104:107]
ds_read_b64_tr_b16 a[138:139], v7 offset:2048
v_mfma_f32_16x16x32_bf16 v[104:107], a[132:135], a[12:15], v[104:107]
v_mfma_f32_16x16x32_bf16 v[112:115], a[128:131], a[16:19], v[112:115]
ds_read_b64_tr_b16 a[140:141], v7 offset:16384
v_mfma_f32_16x16x32_bf16 v[112:115], a[132:135], a[20:23], v[112:115]
buffer_load_dwordx4 v13, s[8:11], s25 offen offset:1024 lds
v_mfma_f32_16x16x32_bf16 v[120:123], a[128:131], a[24:27], v[120:123]
ds_read_b64_tr_b16 a[142:143], v7 offset:18432
v_mfma_f32_16x16x32_bf16 v[120:123], a[132:135], a[28:31], v[120:123]
v_mfma_f32_16x16x32_bf16 v[128:131], a[128:131], a[32:35], v[128:131]
v_mfma_f32_16x16x32_bf16 v[128:131], a[132:135], a[36:39], v[128:131]
buffer_load_dwordx4 v14, s[8:11], s25 offen offset:2048 lds
v_mfma_f32_16x16x32_bf16 v[136:139], a[128:131], a[40:43], v[136:139]
ds_read_b128 a[88:91], v2 offset:38912
v_mfma_f32_16x16x32_bf16 v[136:139], a[132:135], a[44:47], v[136:139]
v_mfma_f32_16x16x32_bf16 v[144:147], a[128:131], a[48:51], v[144:147]
ds_read_b128 a[92:95], v3 offset:38912
v_mfma_f32_16x16x32_bf16 v[144:147], a[132:135], a[52:55], v[144:147]
buffer_load_dwordx4 v15, s[8:11], s25 offen offset:3072 lds
v_mfma_f32_16x16x32_bf16 v[152:155], a[128:131], a[56:59], v[152:155]
s_add_u32 s25, s25, 128
v_mfma_f32_16x16x32_bf16 v[152:155], a[132:135], a[60:63], v[152:155]
s_waitcnt lgkmcnt(2)
v_mfma_f32_16x16x32_bf16 v[100:103], a[136:139], a[0:3], v[100:103]
ds_read_b64_tr_b16 a[128:129], v8 offset:0
v_mfma_f32_16x16x32_bf16 v[100:103], a[140:143], a[4:7], v[100:103]
buffer_load_dword v21, v20, s[16:19], s43 offen
v_mfma_f32_16x16x32_bf16 v[108:111], a[136:139], a[8:11], v[108:111]
s_add_u32 s43, s43, s47
ds_read_b64_tr_b16 a[130:131], v8 offset:2048
v_mfma_f32_16x16x32_bf16 v[108:111], a[140:143], a[12:15], v[108:111]
PAD_2:
s_cbranch_execz M_tret
s_cmp_ge_u32 s43, s51
v_mfma_f32_16x16x32_bf16 v[116:119], a[136:139], a[16:19], v[116:119]
s_cselect_b32 s43, 0, s43
ds_read_b64_tr_b16 a[132:133], v8 offset:16384
v_mfma_f32_16x16x32_bf16 v[116:119], a[140:143], a[20:23], v[116:119]
s_cselect_b32 s51, s42, s51
v_mfma_f32_16x16x32_bf16 v[124:127], a[136:139], a[24:27], v[124:127]
s_cselect_b64 s[16:17], s[40:41], s[16:17]
ds_read_b64_tr_b16 a[134:135], v8 offset:18432
v_mfma_f32_16x16x32_bf16 v[124:127], a[140:143], a[28:31], v[124:127]
s_cselect_b32 s18, s42, s18
v_mfma_f32_16x16x32_bf16 v[132:135], a[136:139], a[32:35], v[132:135]
s_cselect_b64 s[40:41], s[44:45], s[40:41]
ds_read_b128 a[96:99], v2 offset:40960
v_mfma_f32_16x16x32_bf16 v[132:135], a[140:143], a[36:39], v[132:135]
s_cselect_b32 s42, s46, s42
v_mfma_f32_16x16x32_bf16 v[140:143], a[136:139], a[40:43], v[140:143]
s_cselect_b32 s46, 0, s46
v_mfma_f32_16x16x32_bf16 v[140:143], a[140:143], a[44:47], v[140:143]
s_lshl_b32 s59, s39, 5
v_mfma_f32_16x16x32_bf16 v[148:151], a[136:139], a[48:51], v[148:151]
s_add_u32 s59, s59, s38
ds_read_b128 a[100:103], v3 offset:40960
v_mfma_f32_16x16x32_bf16 v[148:151], a[140:143], a[52:55], v[148:151]
s_lshl_b32 s59, s59, 2
v_mfma_f32_16x16x32_bf16 v[156:159], a[136:139], a[56:59], v[156:159]
s_add_u32 s59, s59, 94392320
ds_read_b128 a[104:107], v2 offset:43008
v_mfma_f32_16x16x32_bf16 v[156:159], a[140:143], a[60:63], v[156:159]
s_waitcnt lgkmcnt(3)
s_cmp_lt_u32 s2, 224
v_mfma_f32_16x16x32_bf16 v[160:163], a[128:131], a[0:3], v[160:163]
s_cselect_b32 s59, s59, 3221225472
ds_read_b64_tr_b16 a[136:137], v9 offset:0
v_mfma_f32_16x16x32_bf16 v[160:163], a[132:135], a[4:7], v[160:163]
s_mov_b32 s58, 0xffff0000
v_mfma_f32_16x16x32_bf16 v[168:171], a[128:131], a[8:11], v[168:171]
ds_read_b64_tr_b16 a[138:139], v9 offset:2048
v_mfma_f32_16x16x32_bf16 v[168:171], a[132:135], a[12:15], v[168:171]
buffer_load_dword v21, v20, s[16:19], s43 offen
v_mfma_f32_16x16x32_bf16 v[176:179], a[128:131], a[16:19], v[176:179]
s_add_u32 s43, s43, s47
ds_read_b64_tr_b16 a[140:141], v9 offset:16384
v_mfma_f32_16x16x32_bf16 v[176:179], a[132:135], a[20:23], v[176:179]
s_cmp_ge_u32 s43, s51
v_mfma_f32_16x16x32_bf16 v[184:187], a[128:131], a[24:27], v[184:187]
s_cselect_b32 s43, 0, s43
ds_read_b64_tr_b16 a[142:143], v9 offset:18432
v_mfma_f32_16x16x32_bf16 v[184:187], a[132:135], a[28:31], v[184:187]
s_cselect_b32 s51, s42, s51
v_mfma_f32_16x16x32_bf16 v[192:195], a[128:131], a[32:35], v[192:195]
s_cselect_b64 s[16:17], s[40:41], s[16:17]
v_mfma_f32_16x16x32_bf16 v[192:195], a[132:135], a[36:39], v[192:195]
s_cselect_b32 s18, s42, s18
v_mfma_f32_16x16x32_bf16 v[200:203], a[128:131], a[40:43], v[200:203]
s_cselect_b64 s[40:41], s[44:45], s[40:41]
ds_read_b128 a[108:111], v3 offset:43008
v_mfma_f32_16x16x32_bf16 v[200:203], a[132:135], a[44:47], v[200:203]
s_cselect_b32 s42, s46, s42
v_mfma_f32_16x16x32_bf16 v[208:211], a[128:131], a[48:51], v[208:211]
s_cselect_b32 s46, 0, s46
ds_read_b128 a[112:115], v2 offset:45056
v_mfma_f32_16x16x32_bf16 v[208:211], a[132:135], a[52:55], v[208:211]
v_mfma_f32_16x16x32_bf16 v[216:219], a[128:131], a[56:59], v[216:219]
v_mfma_f32_16x16x32_bf16 v[216:219], a[132:135], a[60:63], v[216:219]
s_waitcnt lgkmcnt(2)
v_mfma_f32_16x16x32_bf16 v[164:167], a[136:139], a[0:3], v[164:167]
ds_read_b64_tr_b16 a[128:129], v10 offset:0
v_mfma_f32_16x16x32_bf16 v[164:167], a[140:143], a[4:7], v[164:167]
v_mfma_f32_16x16x32_bf16 v[172:175], a[136:139], a[8:11], v[172:175]
ds_read_b64_tr_b16 a[130:131], v10 offset:2048
v_mfma_f32_16x16x32_bf16 v[172:175], a[140:143], a[12:15], v[172:175]
v_mfma_f32_16x16x32_bf16 v[180:183], a[136:139], a[16:19], v[180:183]
ds_read_b64_tr_b16 a[132:133], v10 offset:16384
v_mfma_f32_16x16x32_bf16 v[180:183], a[140:143], a[20:23], v[180:183]
v_mfma_f32_16x16x32_bf16 v[188:191], a[136:139], a[24:27], v[188:191]
ds_read_b64_tr_b16 a[134:135], v10 offset:18432
v_mfma_f32_16x16x32_bf16 v[188:191], a[140:143], a[28:31], v[188:191]
v_mfma_f32_16x16x32_bf16 v[196:199], a[136:139], a[32:35], v[196:199]
ds_read_b128 a[116:119], v3 offset:45056
v_mfma_f32_16x16x32_bf16 v[196:199], a[140:143], a[36:39], v[196:199]
v_mfma_f32_16x16x32_bf16 v[204:207], a[136:139], a[40:43], v[204:207]
ds_read_b128 a[120:123], v2 offset:47104
v_and_b32 v252, 31, v0
v_mfma_f32_16x16x32_bf16 v[204:207], a[140:143], a[44:47], v[204:207]
v_lshrrev_b32 v253, 5, v0
v_xor_b32 v253, v253, v252
v_mfma_f32_16x16x32_bf16 v[212:215], a[136:139], a[48:51], v[212:215]
v_and_b32 v253, 7, v253
v_lshlrev_b32 v252, 8, v252
v_mfma_f32_16x16x32_bf16 v[212:215], a[140:143], a[52:55], v[212:215]
v_lshl_add_u32 v252, v253, 4, v252
v_add_u32 v252, 147456, v252
v_mfma_f32_16x16x32_bf16 v[220:223], a[136:139], a[56:59], v[220:223]
ds_read_b128 a[124:127], v3 offset:47104
v_mfma_f32_16x16x32_bf16 v[220:223], a[140:143], a[60:63], v[220:223]
s_waitcnt lgkmcnt(3)
v_mfma_f32_16x16x32_bf16 a[192:195], a[128:131], a[0:3], a[192:195]
ds_read_b64_tr_b16 a[136:137], v11 offset:0
v_mfma_f32_16x16x32_bf16 a[192:195], a[132:135], a[4:7], a[192:195]
v_mfma_f32_16x16x32_bf16 a[200:203], a[128:131], a[8:11], a[200:203]
ds_read_b64_tr_b16 a[138:139], v11 offset:2048
v_mfma_f32_16x16x32_bf16 a[200:203], a[132:135], a[12:15], a[200:203]
v_mfma_f32_16x16x32_bf16 a[208:211], a[128:131], a[16:19], a[208:211]
ds_read_b64_tr_b16 a[140:141], v11 offset:16384
v_mfma_f32_16x16x32_bf16 a[208:211], a[132:135], a[20:23], a[208:211]
v_mfma_f32_16x16x32_bf16 a[216:219], a[128:131], a[24:27], a[216:219]
ds_read_b64_tr_b16 a[142:143], v11 offset:18432
v_mfma_f32_16x16x32_bf16 a[216:219], a[132:135], a[28:31], a[216:219]
v_mfma_f32_16x16x32_bf16 a[224:227], a[128:131], a[32:35], a[224:227]
v_mfma_f32_16x16x32_bf16 a[224:227], a[132:135], a[36:39], a[224:227]
v_mfma_f32_16x16x32_bf16 a[232:235], a[128:131], a[40:43], a[232:235]
v_mfma_f32_16x16x32_bf16 a[232:235], a[132:135], a[44:47], a[232:235]
v_mfma_f32_16x16x32_bf16 a[240:243], a[128:131], a[48:51], a[240:243]
v_mfma_f32_16x16x32_bf16 a[240:243], a[132:135], a[52:55], a[240:243]
v_mfma_f32_16x16x32_bf16 a[248:251], a[128:131], a[56:59], a[248:251]
s_waitcnt vmcnt(2) lgkmcnt(0)
v_mfma_f32_16x16x32_bf16 a[248:251], a[132:135], a[60:63], a[248:251]
s_barrier
v_mfma_f32_16x16x32_bf16 a[196:199], a[136:139], a[0:3], a[196:199]
s_add_u32 m0, s29, 65536
ds_read_b64_tr_b16 a[128:129], v4 offset:32768
v_lshlrev_b32 v28, 16, v248
v_mfma_f32_16x16x32_bf16 a[196:199], a[140:143], a[4:7], a[196:199]
buffer_load_dwordx4 v16, s[12:15], s26 offen offset:0 lds
v_mfma_f32_16x16x32_bf16 a[204:207], a[136:139], a[8:11], a[204:207]
ds_read_b64_tr_b16 a[130:131], v4 offset:34816
v_and_b32 v29, s58, v248
v_mfma_f32_16x16x32_bf16 a[204:207], a[140:143], a[12:15], a[204:207]
v_lshlrev_b32 v30, 16, v249
v_and_b32 v253, s58, v249
v_mfma_f32_16x16x32_bf16 a[212:215], a[136:139], a[16:19], a[212:215]
ds_read_b64_tr_b16 a[132:133], v4 offset:49152
v_lshlrev_b32 v22, 16, v224
v_mfma_f32_16x16x32_bf16 a[212:215], a[140:143], a[20:23], a[212:215]
buffer_load_dwordx4 v17, s[12:15], s26 offen offset:1024 lds
v_mfma_f32_16x16x32_bf16 a[220:223], a[136:139], a[24:27], a[220:223]
ds_read_b64_tr_b16 a[134:135], v4 offset:51200
v_lshlrev_b32 v23, 16, v225
v_mfma_f32_16x16x32_bf16 a[220:223], a[140:143], a[28:31], a[220:223]
v_lshlrev_b32 v24, 16, v226
v_mul_f32 v254, v22, v253
v_mfma_f32_16x16x32_bf16 a[228:231], a[136:139], a[32:35], a[228:231]
v_lshlrev_b32 v25, 16, v227
v_lshlrev_b32 v247, 16, v236
v_mfma_f32_16x16x32_bf16 a[228:231], a[140:143], a[36:39], a[228:231]
buffer_load_dwordx4 v18, s[12:15], s26 offen offset:2048 lds
v_mfma_f32_16x16x32_bf16 a[236:239], a[136:139], a[40:43], a[236:239]
v_fmac_f32 v254, v23, v30
v_fmac_f32 v254, v24, v29
v_mfma_f32_16x16x32_bf16 a[236:239], a[140:143], a[44:47], a[236:239]
v_fmac_f32 v254, v25, v28
v_mul_f32 v254, v254, v247
v_mfma_f32_16x16x32_bf16 a[244:247], a[136:139], a[48:51], a[244:247]
v_mul_f32 v255, v23, v253
v_lshlrev_b32 v22, 16, v228
v_mfma_f32_16x16x32_bf16 a[244:247], a[140:143], a[52:55], a[244:247]
buffer_load_dwordx4 v19, s[12:15], s26 offen offset:3072 lds
v_mfma_f32_16x16x32_bf16 a[252:255], a[136:139], a[56:59], a[252:255]
s_add_u32 s26, s26, 524288
v_lshlrev_b32 v247, 16, v237
v_fmac_f32 v255, v24, v30
v_mfma_f32_16x16x32_bf16 a[252:255], a[140:143], a[60:63], a[252:255]
s_waitcnt lgkmcnt(0)
v_fmac_f32 v255, v25, v29
v_fmac_f32 v255, v22, v28
v_mfma_f32_16x16x32_bf16 v[32:35], a[128:131], a[64:67], v[32:35]
s_add_u32 m0, s29, 81920
ds_read_b64_tr_b16 a[136:137], v5 offset:32768
v_mul_f32 v255, v255, v247
v_mfma_f32_16x16x32_bf16 v[32:35], a[132:135], a[68:71], v[32:35]
buffer_load_dwordx4 v16, s[12:15], s27 offen offset:0 lds
v_mfma_f32_16x16x32_bf16 v[40:43], a[128:131], a[72:75], v[40:43]
ds_read_b64_tr_b16 a[138:139], v5 offset:34816
v_cvt_pk_bf16_f32 v246, v254, v255
v_mfma_f32_16x16x32_bf16 v[40:43], a[132:135], a[76:79], v[40:43]
v_accvgpr_write_b32 a180, v246
v_mul_f32 v254, v24, v253
v_mfma_f32_16x16x32_bf16 v[48:51], a[128:131], a[80:83], v[48:51]
ds_read_b64_tr_b16 a[140:141], v5 offset:49152
v_lshlrev_b32 v23, 16, v229
v_mfma_f32_16x16x32_bf16 v[48:51], a[132:135], a[84:87], v[48:51]
buffer_load_dwordx4 v17, s[12:15], s27 offen offset:1024 lds
v_lshlrev_b32 v247, 16, v238
v_mfma_f32_16x16x32_bf16 v[56:59], a[128:131], a[88:91], v[56:59]
ds_read_b64_tr_b16 a[142:143], v5 offset:51200
v_fmac_f32 v254, v25, v30
v_mfma_f32_16x16x32_bf16 v[56:59], a[132:135], a[92:95], v[56:59]
v_fmac_f32 v254, v22, v29
v_fmac_f32 v254, v23, v28
v_mfma_f32_16x16x32_bf16 v[64:67], a[128:131], a[96:99], v[64:67]
ds_read_b128 a[0:3], v2 offset:0
v_mul_f32 v254, v254, v247
v_mfma_f32_16x16x32_bf16 v[64:67], a[132:135], a[100:103], v[64:67]
buffer_load_dwordx4 v18, s[12:15], s27 offen offset:2048 lds
v_mfma_f32_16x16x32_bf16 v[72:75], a[128:131], a[104:107], v[72:75]
ds_read_b128 a[4:7], v3 offset:0
v_cvt_pk_bf16_f32 v246, v255, v254
v_accvgpr_write_b32 a176, v246
v_mfma_f32_16x16x32_bf16 v[72:75], a[132:135], a[108:111], v[72:75]
v_mul_f32 v255, v25, v253
v_lshlrev_b32 v24, 16, v230
v_mfma_f32_16x16x32_bf16 v[80:83], a[128:131], a[112:115], v[80:83]
v_lshlrev_b32 v247, 16, v239
v_fmac_f32 v255, v22, v30
v_mfma_f32_16x16x32_bf16 v[80:83], a[132:135], a[116:119], v[80:83]
buffer_load_dwordx4 v19, s[12:15], s27 offen offset:3072 lds
v_mfma_f32_16x16x32_bf16 v[88:91], a[128:131], a[120:123], v[88:91]
s_add_u32 s27, s27, 524288
ds_read_b128 a[8:11], v2 offset:2048
v_fmac_f32 v255, v23, v29
v_mfma_f32_16x16x32_bf16 v[88:91], a[132:135], a[124:127], v[88:91]
s_waitcnt lgkmcnt(3)
v_fmac_f32 v255, v24, v28
v_mul_f32 v255, v255, v247
v_mfma_f32_16x16x32_bf16 v[36:39], a[136:139], a[64:67], v[36:39]
s_add_u32 m0, s28, 32768
ds_read_b64_tr_b16 a[128:129], v6 offset:32768
v_cvt_pk_bf16_f32 v246, v254, v255
v_accvgpr_write_b32 a181, v246
v_mfma_f32_16x16x32_bf16 v[36:39], a[140:143], a[68:71], v[36:39]
buffer_load_dwordx4 v12, s[8:11], s24 offen offset:0 lds
v_mfma_f32_16x16x32_bf16 v[44:47], a[136:139], a[72:75], v[44:47]
ds_read_b64_tr_b16 a[130:131], v6 offset:34816
v_mul_f32 v254, v22, v253
v_mfma_f32_16x16x32_bf16 v[44:47], a[140:143], a[76:79], v[44:47]
v_lshlrev_b32 v25, 16, v231
v_lshlrev_b32 v247, 16, v240
v_mfma_f32_16x16x32_bf16 v[52:55], a[136:139], a[80:83], v[52:55]
ds_read_b64_tr_b16 a[132:133], v6 offset:49152
v_fmac_f32 v254, v23, v30
v_mfma_f32_16x16x32_bf16 v[52:55], a[140:143], a[84:87], v[52:55]
buffer_load_dwordx4 v13, s[8:11], s24 offen offset:1024 lds
v_fmac_f32 v254, v24, v29
v_mfma_f32_16x16x32_bf16 v[60:63], a[136:139], a[88:91], v[60:63]
ds_read_b64_tr_b16 a[134:135], v6 offset:51200
v_fmac_f32 v254, v25, v28
v_mfma_f32_16x16x32_bf16 v[60:63], a[140:143], a[92:95], v[60:63]
v_mul_f32 v254, v254, v247
v_cvt_pk_bf16_f32 v246, v255, v254
v_mfma_f32_16x16x32_bf16 v[68:71], a[136:139], a[96:99], v[68:71]
ds_read_b128 a[12:15], v3 offset:2048
v_accvgpr_write_b32 a177, v246
v_mfma_f32_16x16x32_bf16 v[68:71], a[140:143], a[100:103], v[68:71]
buffer_load_dwordx4 v14, s[8:11], s24 offen offset:2048 lds
v_mfma_f32_16x16x32_bf16 v[76:79], a[136:139], a[104:107], v[76:79]
v_mul_f32 v255, v23, v253
v_lshlrev_b32 v22, 16, v232
v_lshlrev_b32 v247, 16, v241
v_mfma_f32_16x16x32_bf16 v[76:79], a[140:143], a[108:111], v[76:79]
v_fmac_f32 v255, v24, v30
v_fmac_f32 v255, v25, v29
v_mfma_f32_16x16x32_bf16 v[84:87], a[136:139], a[112:115], v[84:87]
ds_read_b128 a[16:19], v2 offset:4096
v_fmac_f32 v255, v22, v28
v_mfma_f32_16x16x32_bf16 v[84:87], a[140:143], a[116:119], v[84:87]
buffer_load_dwordx4 v15, s[8:11], s24 offen offset:3072 lds
v_mfma_f32_16x16x32_bf16 v[92:95], a[136:139], a[120:123], v[92:95]
s_add_u32 s24, s24, 128
ds_read_b128 a[20:23], v3 offset:4096
v_mul_f32 v255, v255, v247
v_mfma_f32_16x16x32_bf16 v[92:95], a[140:143], a[124:127], v[92:95]
s_waitcnt lgkmcnt(3)
v_cvt_pk_bf16_f32 v246, v254, v255
v_accvgpr_write_b32 a182, v246
v_mfma_f32_16x16x32_bf16 v[96:99], a[128:131], a[64:67], v[96:99]
s_add_u32 m0, s28, 36864
ds_read_b64_tr_b16 a[136:137], v7 offset:32768
v_mul_f32 v254, v24, v253
v_lshlrev_b32 v23, 16, v233
v_mfma_f32_16x16x32_bf16 v[96:99], a[132:135], a[68:71], v[96:99]
buffer_load_dwordx4 v12, s[8:11], s25 offen offset:0 lds
v_mfma_f32_16x16x32_bf16 v[104:107], a[128:131], a[72:75], v[104:107]
ds_read_b64_tr_b16 a[138:139], v7 offset:34816
v_lshlrev_b32 v247, 16, v242
v_mfma_f32_16x16x32_bf16 v[104:107], a[132:135], a[76:79], v[104:107]
v_fmac_f32 v254, v25, v30
v_fmac_f32 v254, v22, v29
v_mfma_f32_16x16x32_bf16 v[112:115], a[128:131], a[80:83], v[112:115]
ds_read_b64_tr_b16 a[140:141], v7 offset:49152
v_fmac_f32 v254, v23, v28
v_mfma_f32_16x16x32_bf16 v[112:115], a[132:135], a[84:87], v[112:115]
buffer_load_dwordx4 v13, s[8:11], s25 offen offset:1024 lds
v_mul_f32 v254, v254, v247
v_mfma_f32_16x16x32_bf16 v[120:123], a[128:131], a[88:91], v[120:123]
ds_read_b64_tr_b16 a[142:143], v7 offset:51200
v_cvt_pk_bf16_f32 v246, v255, v254
v_mfma_f32_16x16x32_bf16 v[120:123], a[132:135], a[92:95], v[120:123]
v_accvgpr_write_b32 a178, v246
v_mul_f32 v255, v25, v253
v_mfma_f32_16x16x32_bf16 v[128:131], a[128:131], a[96:99], v[128:131]
v_lshlrev_b32 v24, 16, v234
v_lshlrev_b32 v247, 16, v243
v_mfma_f32_16x16x32_bf16 v[128:131], a[132:135], a[100:103], v[128:131]
buffer_load_dwordx4 v14, s[8:11], s25 offen offset:2048 lds
v_mfma_f32_16x16x32_bf16 v[136:139], a[128:131], a[104:107], v[136:139]
ds_read_b128 a[24:27], v2 offset:6144
v_fmac_f32 v255, v22, v30
v_fmac_f32 v255, v23, v29
v_mfma_f32_16x16x32_bf16 v[136:139], a[132:135], a[108:111], v[136:139]
v_fmac_f32 v255, v24, v28
v_mul_f32 v255, v255, v247
v_mfma_f32_16x16x32_bf16 v[144:147], a[128:131], a[112:115], v[144:147]
ds_read_b128 a[28:31], v3 offset:6144
v_cvt_pk_bf16_f32 v246, v254, v255
v_mfma_f32_16x16x32_bf16 v[144:147], a[132:135], a[116:119], v[144:147]
buffer_load_dwordx4 v15, s[8:11], s25 offen offset:3072 lds
v_mfma_f32_16x16x32_bf16 v[152:155], a[128:131], a[120:123], v[152:155]
s_add_u32 s25, s25, 128
v_accvgpr_write_b32 a183, v246
v_mul_f32 v254, v22, v253
v_mfma_f32_16x16x32_bf16 v[152:155], a[132:135], a[124:127], v[152:155]
s_waitcnt lgkmcnt(2)
v_lshlrev_b32 v25, 16, v235
v_lshlrev_b32 v247, 16, v244
v_mfma_f32_16x16x32_bf16 v[100:103], a[136:139], a[64:67], v[100:103]
ds_read_b64_tr_b16 a[128:129], v8 offset:32768
v_fmac_f32 v254, v23, v30
v_fmac_f32 v254, v24, v29
v_mfma_f32_16x16x32_bf16 v[100:103], a[140:143], a[68:71], v[100:103]
buffer_load_dword v21, v20, s[16:19], s43 offen
v_mfma_f32_16x16x32_bf16 v[108:111], a[136:139], a[72:75], v[108:111]
s_add_u32 s43, s43, s47
ds_read_b64_tr_b16 a[130:131], v8 offset:34816
v_fmac_f32 v254, v25, v28
v_mfma_f32_16x16x32_bf16 v[108:111], a[140:143], a[76:79], v[108:111]
s_cmp_ge_u32 s43, s51
v_mul_f32 v254, v254, v247
v_cvt_pk_bf16_f32 v246, v255, v254
v_mfma_f32_16x16x32_bf16 v[116:119], a[136:139], a[80:83], v[116:119]
s_cselect_b32 s43, 0, s43
ds_read_b64_tr_b16 a[132:133], v8 offset:49152
v_accvgpr_write_b32 a179, v246
v_mfma_f32_16x16x32_bf16 v[116:119], a[140:143], a[84:87], v[116:119]
s_cselect_b32 s51, s42, s51
v_lshlrev_b32 v28, 16, v250
v_and_b32 v29, s58, v250
v_lshlrev_b32 v30, 16, v251
v_mfma_f32_16x16x32_bf16 v[124:127], a[136:139], a[88:91], v[124:127]
s_cselect_b64 s[16:17], s[40:41], s[16:17]
ds_read_b64_tr_b16 a[134:135], v8 offset:51200
v_and_b32 v253, s58, v251
v_mfma_f32_16x16x32_bf16 v[124:127], a[140:143], a[92:95], v[124:127]
s_cselect_b32 s18, s42, s18
v_and_b32 v22, s58, v224
v_and_b32 v23, s58, v225
v_mfma_f32_16x16x32_bf16 v[132:135], a[136:139], a[96:99], v[132:135]
s_cselect_b64 s[40:41], s[44:45], s[40:41]
ds_read_b128 a[32:35], v2 offset:8192
v_and_b32 v24, s58, v226
v_mfma_f32_16x16x32_bf16 v[132:135], a[140:143], a[100:103], v[132:135]
s_cselect_b32 s42, s46, s42
v_mul_f32 v254, v22, v253
v_and_b32 v25, s58, v227
v_mfma_f32_16x16x32_bf16 v[140:143], a[136:139], a[104:107], v[140:143]
s_cselect_b32 s46, 0, s46
v_and_b32 v247, s58, v236
v_fmac_f32 v254, v23, v30
v_mfma_f32_16x16x32_bf16 v[140:143], a[140:143], a[108:111], v[140:143]
buffer_load_dword v245, off, s[60:63], 0 sc1
v_fmac_f32 v254, v24, v29
v_mfma_f32_16x16x32_bf16 v[148:151], a[136:139], a[112:115], v[148:151]
ds_read_b128 a[36:39], v3 offset:8192
v_fmac_f32 v254, v25, v28
v_mfma_f32_16x16x32_bf16 v[148:151], a[140:143], a[116:119], v[148:151]
v_mul_f32 v254, v254, v247
v_mul_f32 v255, v23, v253
v_mfma_f32_16x16x32_bf16 v[156:159], a[136:139], a[120:123], v[156:159]
ds_read_b128 a[40:43], v2 offset:10240
v_and_b32 v22, s58, v228
v_mfma_f32_16x16x32_bf16 v[156:159], a[140:143], a[124:127], v[156:159]
s_waitcnt lgkmcnt(3)
v_and_b32 v247, s58, v237
v_fmac_f32 v255, v24, v30
v_mfma_f32_16x16x32_bf16 v[160:163], a[128:131], a[64:67], v[160:163]
ds_read_b64_tr_b16 a[136:137], v9 offset:32768
v_fmac_f32 v255, v25, v29
v_fmac_f32 v255, v22, v28
v_mfma_f32_16x16x32_bf16 v[160:163], a[132:135], a[68:71], v[160:163]
v_mul_f32 v255, v255, v247
v_cvt_pk_bf16_f32 v246, v254, v255
v_mfma_f32_16x16x32_bf16 v[168:171], a[128:131], a[72:75], v[168:171]
ds_read_b64_tr_b16 a[138:139], v9 offset:34816
v_accvgpr_write_b32 a188, v246
v_mfma_f32_16x16x32_bf16 v[168:171], a[132:135], a[76:79], v[168:171]
v_mul_f32 v254, v24, v253
v_and_b32 v23, s58, v229
v_mfma_f32_16x16x32_bf16 v[176:179], a[128:131], a[80:83], v[176:179]
ds_read_b64_tr_b16 a[140:141], v9 offset:49152
v_and_b32 v247, s58, v238
v_mfma_f32_16x16x32_bf16 v[176:179], a[132:135], a[84:87], v[176:179]
v_fmac_f32 v254, v25, v30
v_fmac_f32 v254, v22, v29
v_fmac_f32 v254, v23, v28
v_mfma_f32_16x16x32_bf16 v[184:187], a[128:131], a[88:91], v[184:187]
ds_read_b64_tr_b16 a[142:143], v9 offset:51200
v_mul_f32 v254, v254, v247
v_mfma_f32_16x16x32_bf16 v[184:187], a[132:135], a[92:95], v[184:187]
v_cvt_pk_bf16_f32 v246, v255, v254
v_accvgpr_write_b32 a184, v246
v_mfma_f32_16x16x32_bf16 v[192:195], a[128:131], a[96:99], v[192:195]
v_mul_f32 v255, v25, v253
v_and_b32 v24, s58, v230
v_mfma_f32_16x16x32_bf16 v[192:195], a[132:135], a[100:103], v[192:195]
v_and_b32 v247, s58, v239
v_fmac_f32 v255, v22, v30
v_mfma_f32_16x16x32_bf16 v[200:203], a[128:131], a[104:107], v[200:203]
ds_read_b128 a[44:47], v3 offset:10240
v_fmac_f32 v255, v23, v29
v_mfma_f32_16x16x32_bf16 v[200:203], a[132:135], a[108:111], v[200:203]
v_fmac_f32 v255, v24, v28
v_mul_f32 v255, v255, v247
v_cvt_pk_bf16_f32 v246, v254, v255
v_mfma_f32_16x16x32_bf16 v[208:211], a[128:131], a[112:115], v[208:211]
ds_read_b128 a[48:51], v2 offset:12288
v_accvgpr_write_b32 a189, v246
v_mfma_f32_16x16x32_bf16 v[208:211], a[132:135], a[116:119], v[208:211]
v_mul_f32 v254, v22, v253
v_and_b32 v25, s58, v231
v_mfma_f32_16x16x32_bf16 v[216:219], a[128:131], a[120:123], v[216:219]
v_and_b32 v247, s58, v240
v_fmac_f32 v254, v23, v30
v_mfma_f32_16x16x32_bf16 v[216:219], a[132:135], a[124:127], v[216:219]
s_waitcnt lgkmcnt(2)
v_fmac_f32 v254, v24, v29
v_fmac_f32 v254, v25, v28
v_mfma_f32_16x16x32_bf16 v[164:167], a[136:139], a[64:67], v[164:167]
ds_read_b64_tr_b16 a[128:129], v10 offset:32768
v_mul_f32 v254, v254, v247
v_cvt_pk_bf16_f32 v246, v255, v254
v_mfma_f32_16x16x32_bf16 v[164:167], a[140:143], a[68:71], v[164:167]
v_accvgpr_write_b32 a185, v246
v_mul_f32 v255, v23, v253
v_mfma_f32_16x16x32_bf16 v[172:175], a[136:139], a[72:75], v[172:175]
ds_read_b64_tr_b16 a[130:131], v10 offset:34816
v_and_b32 v22, s58, v232
v_mfma_f32_16x16x32_bf16 v[172:175], a[140:143], a[76:79], v[172:175]
v_and_b32 v247, s58, v241
v_fmac_f32 v255, v24, v30
v_mfma_f32_16x16x32_bf16 v[180:183], a[136:139], a[80:83], v[180:183]
s_lshr_b32 s22, s3, 1
ds_read_b64_tr_b16 a[132:133], v10 offset:49152
v_fmac_f32 v255, v25, v29
v_mfma_f32_16x16x32_bf16 v[180:183], a[140:143], a[84:87], v[180:183]
s_mul_i32 s22, s22, 2097152
v_fmac_f32 v255, v22, v28
v_mul_f32 v255, v255, v247
v_cvt_pk_bf16_f32 v246, v254, v255
v_mfma_f32_16x16x32_bf16 v[188:191], a[136:139], a[88:91], v[188:191]
s_and_b32 s23, s3, 1
ds_read_b64_tr_b16 a[134:135], v10 offset:51200
v_accvgpr_write_b32 a190, v246
v_mfma_f32_16x16x32_bf16 v[188:191], a[140:143], a[92:95], v[188:191]
s_lshl_b32 s23, s23, 5
v_mul_f32 v254, v24, v253
v_and_b32 v23, s58, v233
v_mfma_f32_16x16x32_bf16 v[196:199], a[136:139], a[96:99], v[196:199]
s_lshl_b32 s56, s39, 6
ds_read_b128 a[52:55], v3 offset:12288
v_and_b32 v247, s58, v242
v_mfma_f32_16x16x32_bf16 v[196:199], a[140:143], a[100:103], v[196:199]
s_add_u32 s23, s23, s56
v_fmac_f32 v254, v25, v30
v_fmac_f32 v254, v22, v29
v_mfma_f32_16x16x32_bf16 v[204:207], a[136:139], a[104:107], v[204:207]
s_mul_i32 s23, s23, 4224
ds_read_b128 a[56:59], v2 offset:14336
v_fmac_f32 v254, v23, v28
v_mfma_f32_16x16x32_bf16 v[204:207], a[140:143], a[108:111], v[204:207]
s_add_u32 s22, s22, s23
v_mul_f32 v254, v254, v247
v_cvt_pk_bf16_f32 v246, v255, v254
v_accvgpr_write_b32 a186, v246
v_mfma_f32_16x16x32_bf16 v[212:215], a[136:139], a[112:115], v[212:215]
s_add_u32 s57, s22, 83886200
v_mul_f32 v255, v25, v253
v_and_b32 v24, s58, v234
v_mfma_f32_16x16x32_bf16 v[212:215], a[140:143], a[116:119], v[212:215]
s_lshl_b32 s23, s38, 7
v_and_b32 v247, s58, v243
v_fmac_f32 v255, v22, v30
v_mfma_f32_16x16x32_bf16 v[220:223], a[136:139], a[120:123], v[220:223]
s_add_u32 s22, s22, s23
ds_read_b128 a[60:63], v3 offset:14336
v_fmac_f32 v255, v23, v29
v_mfma_f32_16x16x32_bf16 v[220:223], a[140:143], a[124:127], v[220:223]
s_waitcnt lgkmcnt(3)
s_add_u32 s56, s22, 83886208
v_fmac_f32 v255, v24, v28
v_mul_f32 v255, v255, v247
v_mfma_f32_16x16x32_bf16 a[192:195], a[128:131], a[64:67], a[192:195]
s_cmp_lt_u32 s2, 224
ds_read_b64_tr_b16 a[136:137], v11 offset:32768
v_cvt_pk_bf16_f32 v246, v254, v255
v_accvgpr_write_b32 a191, v246
v_mfma_f32_16x16x32_bf16 a[192:195], a[132:135], a[68:71], a[192:195]
s_cselect_b32 s56, s56, 3221225472
v_mul_f32 v254, v22, v253
v_and_b32 v25, s58, v235
v_mfma_f32_16x16x32_bf16 a[200:203], a[128:131], a[72:75], a[200:203]
s_cmp_eq_u32 s38, 0
ds_read_b64_tr_b16 a[138:139], v11 offset:34816
v_and_b32 v247, s58, v244
v_mfma_f32_16x16x32_bf16 a[200:203], a[132:135], a[76:79], a[200:203]
s_cselect_b32 s57, s57, 3221225472
v_fmac_f32 v254, v23, v30
v_fmac_f32 v254, v24, v29
v_mfma_f32_16x16x32_bf16 a[208:211], a[128:131], a[80:83], a[208:211]
ds_read_b64_tr_b16 a[140:141], v11 offset:49152
v_fmac_f32 v254, v25, v28
v_mfma_f32_16x16x32_bf16 a[208:211], a[132:135], a[84:87], a[208:211]
v_mul_f32 v254, v254, v247
v_cvt_pk_bf16_f32 v246, v255, v254
v_accvgpr_write_b32 a187, v246
v_mfma_f32_16x16x32_bf16 a[216:219], a[128:131], a[88:91], a[216:219]
ds_read_b64_tr_b16 a[142:143], v11 offset:51200
v_mfma_f32_16x16x32_bf16 a[216:219], a[132:135], a[92:95], a[216:219]
ds_write_b128 v252, a[176:179] offset:0
v_mfma_f32_16x16x32_bf16 a[224:227], a[128:131], a[96:99], a[224:227]
v_mfma_f32_16x16x32_bf16 a[224:227], a[132:135], a[100:103], a[224:227]
ds_write_b128 v252, a[180:183] offset:8192
v_mfma_f32_16x16x32_bf16 a[232:235], a[128:131], a[104:107], a[232:235]
v_mfma_f32_16x16x32_bf16 a[232:235], a[132:135], a[108:111], a[232:235]
ds_write_b128 v252, a[184:187] offset:128
v_mfma_f32_16x16x32_bf16 a[240:243], a[128:131], a[112:115], a[240:243]
v_mfma_f32_16x16x32_bf16 a[240:243], a[132:135], a[116:119], a[240:243]
ds_write_b128 v252, a[188:191] offset:8320
v_mfma_f32_16x16x32_bf16 a[248:251], a[128:131], a[120:123], a[248:251]
s_waitcnt vmcnt(2) lgkmcnt(0)
v_mfma_f32_16x16x32_bf16 a[248:251], a[132:135], a[124:127], a[248:251]
s_barrier
v_mfma_f32_16x16x32_bf16 a[196:199], a[136:139], a[64:67], a[196:199]
s_add_u32 m0, s29, 98304
ds_read_b64_tr_b16 a[128:129], v4 offset:0
v_lshrrev_b32 v22, 8, v1
v_mfma_f32_16x16x32_bf16 a[196:199], a[140:143], a[68:71], a[196:199]
buffer_load_dwordx4 v16, s[12:15], s26 offen offset:0 lds
v_mfma_f32_16x16x32_bf16 a[204:207], a[136:139], a[72:75], a[204:207]
ds_read_b64_tr_b16 a[130:131], v4 offset:2048
v_lshlrev_b32 v22, 4, v22
v_mfma_f32_16x16x32_bf16 a[204:207], a[140:143], a[76:79], a[204:207]
v_xor_b32 v22, v22, v1
v_add_u32 v22, s29, v22
v_mfma_f32_16x16x32_bf16 a[212:215], a[136:139], a[80:83], a[212:215]
ds_read_b64_tr_b16 a[132:133], v4 offset:16384
v_add_u32 v22, 147456, v22
v_mfma_f32_16x16x32_bf16 a[212:215], a[140:143], a[84:87], a[212:215]
buffer_load_dwordx4 v17, s[12:15], s26 offen offset:1024 lds
v_mfma_f32_16x16x32_bf16 a[220:223], a[136:139], a[88:91], a[220:223]
ds_read_b64_tr_b16 a[134:135], v4 offset:18432
v_xor_b32 v23, 64, v22
v_mfma_f32_16x16x32_bf16 a[220:223], a[140:143], a[92:95], a[220:223]
v_lshrrev_b32 v224, 7, v1
v_mul_u32_u24 v224, 4224, v224
v_mfma_f32_16x16x32_bf16 a[228:231], a[136:139], a[96:99], a[228:231]
v_and_b32 v225, 0x70, v1
v_add_u32 v224, v224, v225
v_mfma_f32_16x16x32_bf16 a[228:231], a[140:143], a[100:103], a[228:231]
buffer_load_dwordx4 v18, s[12:15], s26 offen offset:2048 lds
v_mfma_f32_16x16x32_bf16 a[236:239], a[136:139], a[104:107], a[236:239]
v_bfe_u32 v225, v1, 4, 5
v_mul_u32_u24 v225, 4224, v225
v_mfma_f32_16x16x32_bf16 a[236:239], a[140:143], a[108:111], a[236:239]
v_mov_b32 v226, 0
v_mov_b32 v227, 0
v_mfma_f32_16x16x32_bf16 a[244:247], a[136:139], a[112:115], a[244:247]
v_mfma_f32_16x16x32_bf16 a[244:247], a[140:143], a[116:119], a[244:247]
buffer_load_dwordx4 v19, s[12:15], s26 offen offset:3072 lds
v_mfma_f32_16x16x32_bf16 a[252:255], a[136:139], a[120:123], a[252:255]
s_add_u32 s26, s26, 524288
v_mfma_f32_16x16x32_bf16 a[252:255], a[140:143], a[124:127], a[252:255]
s_waitcnt lgkmcnt(0)
v_mfma_f32_16x16x32_bf16 v[32:35], a[128:131], a[0:3], v[32:35]
s_add_u32 m0, s29, 114688
ds_read_b64_tr_b16 a[136:137], v5 offset:0
v_mfma_f32_16x16x32_bf16 v[32:35], a[132:135], a[4:7], v[32:35]
buffer_load_dwordx4 v16, s[12:15], s27 offen offset:0 lds
v_mfma_f32_16x16x32_bf16 v[40:43], a[128:131], a[8:11], v[40:43]
s_mul_i32 s52, s20, 7
ds_read_b64_tr_b16 a[138:139], v5 offset:2048
v_mfma_f32_16x16x32_bf16 v[40:43], a[132:135], a[12:15], v[40:43]
s_add_u32 s52, s52, s21
buffer_store_dwordx2 v[226:227], v225, s[4:7], s57 offen sc1
v_mfma_f32_16x16x32_bf16 v[48:51], a[128:131], a[16:19], v[48:51]
s_lshl_b32 s53, s52, 2
ds_read_b64_tr_b16 a[140:141], v5 offset:16384
v_mfma_f32_16x16x32_bf16 v[48:51], a[132:135], a[20:23], v[48:51]
s_add_u32 s53, s53, s3
buffer_load_dwordx4 v17, s[12:15], s27 offen offset:1024 lds
v_mfma_f32_16x16x32_bf16 v[56:59], a[128:131], a[24:27], v[56:59]
s_lshl_b32 s49, s53, 12
ds_read_b64_tr_b16 a[142:143], v5 offset:18432
v_mfma_f32_16x16x32_bf16 v[56:59], a[132:135], a[28:31], v[56:59]
s_mul_i32 s53, s53, 4224
v_mfma_f32_16x16x32_bf16 v[64:67], a[128:131], a[32:35], v[64:67]
s_add_u32 s53, s53, 83886080
ds_read_b128 a[64:67], v2 offset:32768
v_mfma_f32_16x16x32_bf16 v[64:67], a[132:135], a[36:39], v[64:67]
s_lshr_b32 s52, s52, 4
buffer_load_dwordx4 v18, s[12:15], s27 offen offset:2048 lds
v_mfma_f32_16x16x32_bf16 v[72:75], a[128:131], a[40:43], v[72:75]
s_min_u32 s52, s52, 6
ds_read_b128 a[68:71], v3 offset:32768
v_mfma_f32_16x16x32_bf16 v[72:75], a[132:135], a[44:47], v[72:75]
s_lshl_b32 s52, s52, 7
ds_read_b128 a[176:179], v22 offset:0
v_mfma_f32_16x16x32_bf16 v[80:83], a[128:131], a[48:51], v[80:83]
s_add_u32 s52, s52, 94392320
ds_read_b128 a[180:183], v23 offset:1024
v_mfma_f32_16x16x32_bf16 v[80:83], a[132:135], a[52:55], v[80:83]
buffer_load_dwordx4 v19, s[12:15], s27 offen offset:3072 lds
v_mfma_f32_16x16x32_bf16 v[88:91], a[128:131], a[56:59], v[88:91]
s_add_u32 s27, s27, 524288
ds_read_b128 a[72:75], v2 offset:34816
v_mfma_f32_16x16x32_bf16 v[88:91], a[132:135], a[60:63], v[88:91]
s_waitcnt lgkmcnt(5)
ds_read_b128 a[184:187], v22 offset:2048
v_mfma_f32_16x16x32_bf16 v[36:39], a[136:139], a[0:3], v[36:39]
s_add_u32 m0, s28, 0
ds_read_b64_tr_b16 a[128:129], v6 offset:0
v_mfma_f32_16x16x32_bf16 v[36:39], a[140:143], a[4:7], v[36:39]
buffer_load_dwordx4 v12, s[8:11], s24 offen offset:0 lds
v_mfma_f32_16x16x32_bf16 v[44:47], a[136:139], a[8:11], v[44:47]
PAD_3:
s_cbranch_execz M_tret
ds_read_b64_tr_b16 a[130:131], v6 offset:2048
v_mfma_f32_16x16x32_bf16 v[44:47], a[140:143], a[12:15], v[44:47]
ds_read_b128 a[188:191], v23 offset:3072
v_mfma_f32_16x16x32_bf16 v[52:55], a[136:139], a[16:19], v[52:55]
ds_read_b64_tr_b16 a[132:133], v6 offset:16384
v_bfe_u32 v231, v1, 4, 5
v_mfma_f32_16x16x32_bf16 v[52:55], a[140:143], a[20:23], v[52:55]
buffer_load_dwordx4 v13, s[8:11], s24 offen offset:1024 lds
v_mfma_f32_16x16x32_bf16 v[60:63], a[136:139], a[24:27], v[60:63]
ds_read_b64_tr_b16 a[134:135], v6 offset:18432
v_lshlrev_b32 v231, 2, v231
v_mfma_f32_16x16x32_bf16 v[60:63], a[140:143], a[28:31], v[60:63]
v_lshlrev_b32 v229, 3, v1
v_min_u32 v229, 4096, v229
v_mfma_f32_16x16x32_bf16 v[68:71], a[136:139], a[32:35], v[68:71]
ds_read_b128 a[76:79], v3 offset:34816
v_mfma_f32_16x16x32_bf16 v[68:71], a[140:143], a[36:39], v[68:71]
buffer_load_dwordx4 v14, s[8:11], s24 offen offset:2048 lds
v_mfma_f32_16x16x32_bf16 v[76:79], a[136:139], a[40:43], v[76:79]
v_mfma_f32_16x16x32_bf16 v[76:79], a[140:143], a[44:47], v[76:79]
v_mfma_f32_16x16x32_bf16 v[84:87], a[136:139], a[48:51], v[84:87]
ds_read_b128 a[80:83], v2 offset:36864
v_mfma_f32_16x16x32_bf16 v[84:87], a[140:143], a[52:55], v[84:87]
buffer_load_dwordx4 v15, s[8:11], s24 offen offset:3072 lds
v_mfma_f32_16x16x32_bf16 v[92:95], a[136:139], a[56:59], v[92:95]
s_add_u32 s24, s24, 128
ds_read_b128 a[84:87], v3 offset:36864
v_mfma_f32_16x16x32_bf16 v[92:95], a[140:143], a[60:63], v[92:95]
s_waitcnt lgkmcnt(3)
v_mfma_f32_16x16x32_bf16 v[96:99], a[128:131], a[0:3], v[96:99]
s_add_u32 m0, s28, 4096
ds_read_b64_tr_b16 a[136:137], v7 offset:0
v_mfma_f32_16x16x32_bf16 v[96:99], a[132:135], a[4:7], v[96:99]
buffer_load_dwordx4 v12, s[8:11], s25 offen offset:0 lds
v_mfma_f32_16x16x32_bf16 v[104:107], a[128:131], a[8:11], v[104:107]
ds_read_b64_tr_b16 a[138:139], v7 offset:2048
v_mfma_f32_16x16x32_bf16 v[104:107], a[132:135], a[12:15], v[104:107]
v_mfma_f32_16x16x32_bf16 v[112:115], a[128:131], a[16:19], v[112:115]
ds_read_b64_tr_b16 a[140:141], v7 offset:16384
v_mfma_f32_16x16x32_bf16 v[112:115], a[132:135], a[20:23], v[112:115]
buffer_load_dwordx4 v13, s[8:11], s25 offen offset:1024 lds
v_mfma_f32_16x16x32_bf16 v[120:123], a[128:131], a[24:27], v[120:123]
ds_read_b64_tr_b16 a[142:143], v7 offset:18432
v_mfma_f32_16x16x32_bf16 v[120:123], a[132:135], a[28:31], v[120:123]
v_mfma_f32_16x16x32_bf16 v[128:131], a[128:131], a[32:35], v[128:131]
v_mfma_f32_16x16x32_bf16 v[128:131], a[132:135], a[36:39], v[128:131]
buffer_load_dwordx4 v14, s[8:11], s25 offen offset:2048 lds
v_mfma_f32_16x16x32_bf16 v[136:139], a[128:131], a[40:43], v[136:139]
ds_read_b128 a[88:91], v2 offset:38912
v_mfma_f32_16x16x32_bf16 v[136:139], a[132:135], a[44:47], v[136:139]
v_mfma_f32_16x16x32_bf16 v[144:147], a[128:131], a[48:51], v[144:147]
ds_read_b128 a[92:95], v3 offset:38912
v_mfma_f32_16x16x32_bf16 v[144:147], a[132:135], a[52:55], v[144:147]
buffer_load_dwordx4 v15, s[8:11], s25 offen offset:3072 lds
v_mfma_f32_16x16x32_bf16 v[152:155], a[128:131], a[56:59], v[152:155]
s_add_u32 s25, s25, 128
v_mfma_f32_16x16x32_bf16 v[152:155], a[132:135], a[60:63], v[152:155]
s_waitcnt lgkmcnt(2)
v_mfma_f32_16x16x32_bf16 v[100:103], a[136:139], a[0:3], v[100:103]
ds_read_b64_tr_b16 a[128:129], v8 offset:0
v_mfma_f32_16x16x32_bf16 v[100:103], a[140:143], a[4:7], v[100:103]
buffer_store_dwordx4 a[176:179], v224, s[4:7], s56 offen sc1
v_mfma_f32_16x16x32_bf16 v[108:111], a[136:139], a[8:11], v[108:111]
s_add_u32 s56, s56, 33792
ds_read_b64_tr_b16 a[130:131], v8 offset:2048
v_mfma_f32_16x16x32_bf16 v[108:111], a[140:143], a[12:15], v[108:111]
v_mfma_f32_16x16x32_bf16 v[116:119], a[136:139], a[16:19], v[116:119]
ds_read_b64_tr_b16 a[132:133], v8 offset:16384
v_mfma_f32_16x16x32_bf16 v[116:119], a[140:143], a[20:23], v[116:119]
v_mfma_f32_16x16x32_bf16 v[124:127], a[136:139], a[24:27], v[124:127]
s_cmp_lt_u32 s21, 0
ds_read_b64_tr_b16 a[134:135], v8 offset:18432
v_mfma_f32_16x16x32_bf16 v[124:127], a[140:143], a[28:31], v[124:127]
s_cselect_b32 s53, s53, 3221225472
v_mfma_f32_16x16x32_bf16 v[132:135], a[136:139], a[32:35], v[132:135]
s_cselect_b32 s49, s49, 3221225472
ds_read_b128 a[96:99], v2 offset:40960
v_mfma_f32_16x16x32_bf16 v[132:135], a[140:143], a[36:39], v[132:135]
s_add_u32 s48, s53, 2097152
v_mfma_f32_16x16x32_bf16 v[140:143], a[136:139], a[40:43], v[140:143]
v_mfma_f32_16x16x32_bf16 v[140:143], a[140:143], a[44:47], v[140:143]
v_mfma_f32_16x16x32_bf16 v[148:151], a[136:139], a[48:51], v[148:151]
ds_read_b128 a[100:103], v3 offset:40960
v_mfma_f32_16x16x32_bf16 v[148:151], a[140:143], a[52:55], v[148:151]
v_mfma_f32_16x16x32_bf16 v[156:159], a[136:139], a[56:59], v[156:159]
ds_read_b128 a[104:107], v2 offset:43008
v_mfma_f32_16x16x32_bf16 v[156:159], a[140:143], a[60:63], v[156:159]
s_waitcnt lgkmcnt(3)
v_mfma_f32_16x16x32_bf16 v[160:163], a[128:131], a[0:3], v[160:163]
ds_read_b64_tr_b16 a[136:137], v9 offset:0
v_mfma_f32_16x16x32_bf16 v[160:163], a[132:135], a[4:7], v[160:163]
v_mfma_f32_16x16x32_bf16 v[168:171], a[128:131], a[8:11], v[168:171]
ds_read_b64_tr_b16 a[138:139], v9 offset:2048
v_mfma_f32_16x16x32_bf16 v[168:171], a[132:135], a[12:15], v[168:171]
buffer_store_dwordx4 a[180:183], v224, s[4:7], s56 offen sc1
v_mfma_f32_16x16x32_bf16 v[176:179], a[128:131], a[16:19], v[176:179]
s_add_u32 s56, s56, 33792
ds_read_b64_tr_b16 a[140:141], v9 offset:16384
v_mfma_f32_16x16x32_bf16 v[176:179], a[132:135], a[20:23], v[176:179]
v_mfma_f32_16x16x32_bf16 v[184:187], a[128:131], a[24:27], v[184:187]
ds_read_b64_tr_b16 a[142:143], v9 offset:18432
v_mfma_f32_16x16x32_bf16 v[184:187], a[132:135], a[28:31], v[184:187]
v_mfma_f32_16x16x32_bf16 v[192:195], a[128:131], a[32:35], v[192:195]
v_mfma_f32_16x16x32_bf16 v[192:195], a[132:135], a[36:39], v[192:195]
v_mfma_f32_16x16x32_bf16 v[200:203], a[128:131], a[40:43], v[200:203]
ds_read_b128 a[108:111], v3 offset:43008
v_mfma_f32_16x16x32_bf16 v[200:203], a[132:135], a[44:47], v[200:203]
v_mfma_f32_16x16x32_bf16 v[208:211], a[128:131], a[48:51], v[208:211]
ds_read_b128 a[112:115], v2 offset:45056
v_mfma_f32_16x16x32_bf16 v[208:211], a[132:135], a[52:55], v[208:211]
v_mfma_f32_16x16x32_bf16 v[216:219], a[128:131], a[56:59], v[216:219]
v_mfma_f32_16x16x32_bf16 v[216:219], a[132:135], a[60:63], v[216:219]
s_waitcnt lgkmcnt(2)
v_mfma_f32_16x16x32_bf16 v[164:167], a[136:139], a[0:3], v[164:167]
ds_read_b64_tr_b16 a[128:129], v10 offset:0
v_mfma_f32_16x16x32_bf16 v[164:167], a[140:143], a[4:7], v[164:167]
v_mfma_f32_16x16x32_bf16 v[172:175], a[136:139], a[8:11], v[172:175]
ds_read_b64_tr_b16 a[130:131], v10 offset:2048
v_mfma_f32_16x16x32_bf16 v[172:175], a[140:143], a[12:15], v[172:175]
v_mfma_f32_16x16x32_bf16 v[180:183], a[136:139], a[16:19], v[180:183]
ds_read_b64_tr_b16 a[132:133], v10 offset:16384
v_mfma_f32_16x16x32_bf16 v[180:183], a[140:143], a[20:23], v[180:183]
buffer_store_dwordx4 a[184:187], v224, s[4:7], s56 offen sc1
v_mfma_f32_16x16x32_bf16 v[188:191], a[136:139], a[24:27], v[188:191]
s_add_u32 s56, s56, 33792
ds_read_b64_tr_b16 a[134:135], v10 offset:18432
v_mfma_f32_16x16x32_bf16 v[188:191], a[140:143], a[28:31], v[188:191]
v_mfma_f32_16x16x32_bf16 v[196:199], a[136:139], a[32:35], v[196:199]
ds_read_b128 a[116:119], v3 offset:45056
v_mfma_f32_16x16x32_bf16 v[196:199], a[140:143], a[36:39], v[196:199]
v_mfma_f32_16x16x32_bf16 v[204:207], a[136:139], a[40:43], v[204:207]
ds_read_b128 a[120:123], v2 offset:47104
v_mfma_f32_16x16x32_bf16 v[204:207], a[140:143], a[44:47], v[204:207]
v_mfma_f32_16x16x32_bf16 v[212:215], a[136:139], a[48:51], v[212:215]
v_mfma_f32_16x16x32_bf16 v[212:215], a[140:143], a[52:55], v[212:215]
v_mfma_f32_16x16x32_bf16 v[220:223], a[136:139], a[56:59], v[220:223]
ds_read_b128 a[124:127], v3 offset:47104
v_mfma_f32_16x16x32_bf16 v[220:223], a[140:143], a[60:63], v[220:223]
s_waitcnt lgkmcnt(3)
v_mfma_f32_16x16x32_bf16 a[192:195], a[128:131], a[0:3], a[192:195]
ds_read_b64_tr_b16 a[136:137], v11 offset:0
v_mfma_f32_16x16x32_bf16 a[192:195], a[132:135], a[4:7], a[192:195]
v_mfma_f32_16x16x32_bf16 a[200:203], a[128:131], a[8:11], a[200:203]
ds_read_b64_tr_b16 a[138:139], v11 offset:2048
v_mfma_f32_16x16x32_bf16 a[200:203], a[132:135], a[12:15], a[200:203]
v_mfma_f32_16x16x32_bf16 a[208:211], a[128:131], a[16:19], a[208:211]
ds_read_b64_tr_b16 a[140:141], v11 offset:16384
v_mfma_f32_16x16x32_bf16 a[208:211], a[132:135], a[20:23], a[208:211]
v_mfma_f32_16x16x32_bf16 a[216:219], a[128:131], a[24:27], a[216:219]
ds_read_b64_tr_b16 a[142:143], v11 offset:18432
v_mfma_f32_16x16x32_bf16 a[216:219], a[132:135], a[28:31], a[216:219]
buffer_store_dwordx4 a[188:191], v224, s[4:7], s56 offen sc1
v_mfma_f32_16x16x32_bf16 a[224:227], a[128:131], a[32:35], a[224:227]
s_add_u32 s56, s56, 33792
v_mfma_f32_16x16x32_bf16 a[224:227], a[132:135], a[36:39], a[224:227]
v_mfma_f32_16x16x32_bf16 a[232:235], a[128:131], a[40:43], a[232:235]
v_mfma_f32_16x16x32_bf16 a[232:235], a[132:135], a[44:47], a[232:235]
v_mfma_f32_16x16x32_bf16 a[240:243], a[128:131], a[48:51], a[240:243]
v_mfma_f32_16x16x32_bf16 a[240:243], a[132:135], a[52:55], a[240:243]
v_mfma_f32_16x16x32_bf16 a[248:251], a[128:131], a[56:59], a[248:251]
s_waitcnt vmcnt(4) lgkmcnt(0)
v_mfma_f32_16x16x32_bf16 a[248:251], a[132:135], a[60:63], a[248:251]
s_barrier
v_mfma_f32_16x16x32_bf16 a[196:199], a[136:139], a[0:3], a[196:199]
s_add_u32 m0, s29, 65536
ds_read_b64_tr_b16 a[128:129], v4 offset:32768
v_mfma_f32_16x16x32_bf16 a[196:199], a[140:143], a[4:7], a[196:199]
buffer_load_dwordx4 v16, s[12:15], s26 offen offset:0 lds
v_mfma_f32_16x16x32_bf16 a[204:207], a[136:139], a[8:11], a[204:207]
ds_read_b64_tr_b16 a[130:131], v4 offset:34816
v_cmp_gt_u32 vcc, 0x100, v245
v_mfma_f32_16x16x32_bf16 a[204:207], a[140:143], a[12:15], a[204:207]
v_mfma_f32_16x16x32_bf16 a[212:215], a[136:139], a[16:19], a[212:215]
ds_read_b64_tr_b16 a[132:133], v4 offset:49152
v_mfma_f32_16x16x32_bf16 a[212:215], a[140:143], a[20:23], a[212:215]
buffer_load_dwordx4 v17, s[12:15], s26 offen offset:1024 lds
v_mfma_f32_16x16x32_bf16 a[220:223], a[136:139], a[24:27], a[220:223]
ds_read_b64_tr_b16 a[134:135], v4 offset:51200
v_mfma_f32_16x16x32_bf16 a[220:223], a[140:143], a[28:31], a[220:223]
v_mfma_f32_16x16x32_bf16 a[228:231], a[136:139], a[32:35], a[228:231]
v_mfma_f32_16x16x32_bf16 a[228:231], a[140:143], a[36:39], a[228:231]
buffer_load_dwordx4 v18, s[12:15], s26 offen offset:2048 lds
v_mfma_f32_16x16x32_bf16 a[236:239], a[136:139], a[40:43], a[236:239]
v_mfma_f32_16x16x32_bf16 a[236:239], a[140:143], a[44:47], a[236:239]
v_mfma_f32_16x16x32_bf16 a[244:247], a[136:139], a[48:51], a[244:247]
v_mfma_f32_16x16x32_bf16 a[244:247], a[140:143], a[52:55], a[244:247]
buffer_load_dwordx4 v19, s[12:15], s26 offen offset:3072 lds
v_mfma_f32_16x16x32_bf16 a[252:255], a[136:139], a[56:59], a[252:255]
s_add_u32 s26, s26, 524288
v_mfma_f32_16x16x32_bf16 a[252:255], a[140:143], a[60:63], a[252:255]
s_waitcnt lgkmcnt(0)
s_mov_b32 s82, s59
s_cbranch_vccnz M_cntspinK
s_branch Lg_1
Lg_1t:
PAD_4:
s_cbranch_execz M_tret
buffer_load_dword v230, v231, s[4:7], s52 offen sc1
v_mfma_f32_16x16x32_bf16 v[32:35], a[128:131], a[64:67], v[32:35]
s_add_u32 m0, s29, 81920
ds_read_b64_tr_b16 a[136:137], v5 offset:32768
v_mfma_f32_16x16x32_bf16 v[32:35], a[132:135], a[68:71], v[32:35]
buffer_load_dwordx4 v16, s[12:15], s27 offen offset:0 lds
v_mfma_f32_16x16x32_bf16 v[40:43], a[128:131], a[72:75], v[40:43]
s_and_b32 s44, s3, 1
ds_read_b64_tr_b16 a[138:139], v5 offset:34816
v_mfma_f32_16x16x32_bf16 v[40:43], a[132:135], a[76:79], v[40:43]
s_lshl_b32 s44, s44, 8
v_mfma_f32_16x16x32_bf16 v[48:51], a[128:131], a[80:83], v[48:51]
s_lshl_b32 s45, s3, 7
ds_read_b64_tr_b16 a[140:141], v5 offset:49152
v_mfma_f32_16x16x32_bf16 v[48:51], a[132:135], a[84:87], v[48:51]
s_xor_b32 s44, s44, s45
buffer_load_dwordx4 v17, s[12:15], s27 offen offset:1024 lds
v_mfma_f32_16x16x32_bf16 v[56:59], a[128:131], a[88:91], v[56:59]
s_xor_b32 s44, s44, 196608
ds_read_b64_tr_b16 a[142:143], v5 offset:51200
v_mfma_f32_16x16x32_bf16 v[56:59], a[132:135], a[92:95], v[56:59]
v_mfma_f32_16x16x32_bf16 v[64:67], a[128:131], a[96:99], v[64:67]
ds_read_b128 a[0:3], v2 offset:0
v_mfma_f32_16x16x32_bf16 v[64:67], a[132:135], a[100:103], v[64:67]
buffer_load_dwordx4 v18, s[12:15], s27 offen offset:2048 lds
v_mfma_f32_16x16x32_bf16 v[72:75], a[128:131], a[104:107], v[72:75]
ds_read_b128 a[4:7], v3 offset:0
v_mfma_f32_16x16x32_bf16 v[72:75], a[132:135], a[108:111], v[72:75]
v_mfma_f32_16x16x32_bf16 v[80:83], a[128:131], a[112:115], v[80:83]
v_mfma_f32_16x16x32_bf16 v[80:83], a[132:135], a[116:119], v[80:83]
buffer_load_dwordx4 v19, s[12:15], s27 offen offset:3072 lds
v_mfma_f32_16x16x32_bf16 v[88:91], a[128:131], a[120:123], v[88:91]
s_add_u32 s27, s27, 524288
ds_read_b128 a[8:11], v2 offset:2048
v_mfma_f32_16x16x32_bf16 v[88:91], a[132:135], a[124:127], v[88:91]
s_waitcnt lgkmcnt(3)
v_mfma_f32_16x16x32_bf16 v[36:39], a[136:139], a[64:67], v[36:39]
s_add_u32 m0, s28, 32768
ds_read_b64_tr_b16 a[128:129], v6 offset:32768
v_mfma_f32_16x16x32_bf16 v[36:39], a[140:143], a[68:71], v[36:39]
buffer_load_dwordx4 v12, s[8:11], s24 offen offset:0 lds
v_mfma_f32_16x16x32_bf16 v[44:47], a[136:139], a[72:75], v[44:47]
ds_read_b64_tr_b16 a[130:131], v6 offset:34816
v_mfma_f32_16x16x32_bf16 v[44:47], a[140:143], a[76:79], v[44:47]
v_mfma_f32_16x16x32_bf16 v[52:55], a[136:139], a[80:83], v[52:55]
s_mov_b64 s[56:57], s[72:73]
ds_read_b64_tr_b16 a[132:133], v6 offset:49152
v_mfma_f32_16x16x32_bf16 v[52:55], a[140:143], a[84:87], v[52:55]
s_mov_b32 s58, 1835008
buffer_load_dwordx4 v13, s[8:11], s24 offen offset:1024 lds
v_mfma_f32_16x16x32_bf16 v[60:63], a[136:139], a[88:91], v[60:63]
s_mov_b32 s59, 0x20000
ds_read_b64_tr_b16 a[134:135], v6 offset:51200
v_mfma_f32_16x16x32_bf16 v[60:63], a[140:143], a[92:95], v[60:63]
v_mfma_f32_16x16x32_bf16 v[68:71], a[136:139], a[96:99], v[68:71]
ds_read_b128 a[12:15], v3 offset:2048
v_mfma_f32_16x16x32_bf16 v[68:71], a[140:143], a[100:103], v[68:71]
buffer_load_dwordx4 v14, s[8:11], s24 offen offset:2048 lds
v_mfma_f32_16x16x32_bf16 v[76:79], a[136:139], a[104:107], v[76:79]
v_mfma_f32_16x16x32_bf16 v[76:79], a[140:143], a[108:111], v[76:79]
v_mfma_f32_16x16x32_bf16 v[84:87], a[136:139], a[112:115], v[84:87]
ds_read_b128 a[16:19], v2 offset:4096
v_mfma_f32_16x16x32_bf16 v[84:87], a[140:143], a[116:119], v[84:87]
buffer_load_dwordx4 v15, s[8:11], s24 offen offset:3072 lds
v_mfma_f32_16x16x32_bf16 v[92:95], a[136:139], a[120:123], v[92:95]
s_add_u32 s24, s24, 128
ds_read_b128 a[20:23], v3 offset:4096
v_mfma_f32_16x16x32_bf16 v[92:95], a[140:143], a[124:127], v[92:95]
s_waitcnt lgkmcnt(3)
v_mfma_f32_16x16x32_bf16 v[96:99], a[128:131], a[64:67], v[96:99]
s_add_u32 m0, s28, 36864
ds_read_b64_tr_b16 a[136:137], v7 offset:32768
v_mfma_f32_16x16x32_bf16 v[96:99], a[132:135], a[68:71], v[96:99]
buffer_load_dwordx4 v12, s[8:11], s25 offen offset:0 lds
v_mfma_f32_16x16x32_bf16 v[104:107], a[128:131], a[72:75], v[104:107]
ds_read_b64_tr_b16 a[138:139], v7 offset:34816
v_mfma_f32_16x16x32_bf16 v[104:107], a[132:135], a[76:79], v[104:107]
v_mfma_f32_16x16x32_bf16 v[112:115], a[128:131], a[80:83], v[112:115]
ds_read_b64_tr_b16 a[140:141], v7 offset:49152
v_mfma_f32_16x16x32_bf16 v[112:115], a[132:135], a[84:87], v[112:115]
buffer_load_dwordx4 v13, s[8:11], s25 offen offset:1024 lds
v_mfma_f32_16x16x32_bf16 v[120:123], a[128:131], a[88:91], v[120:123]
ds_read_b64_tr_b16 a[142:143], v7 offset:51200
v_mfma_f32_16x16x32_bf16 v[120:123], a[132:135], a[92:95], v[120:123]
v_mfma_f32_16x16x32_bf16 v[128:131], a[128:131], a[96:99], v[128:131]
v_mfma_f32_16x16x32_bf16 v[128:131], a[132:135], a[100:103], v[128:131]
buffer_load_dwordx4 v14, s[8:11], s25 offen offset:2048 lds
v_mfma_f32_16x16x32_bf16 v[136:139], a[128:131], a[104:107], v[136:139]
ds_read_b128 a[24:27], v2 offset:6144
v_mfma_f32_16x16x32_bf16 v[136:139], a[132:135], a[108:111], v[136:139]
v_mfma_f32_16x16x32_bf16 v[144:147], a[128:131], a[112:115], v[144:147]
ds_read_b128 a[28:31], v3 offset:6144
v_mfma_f32_16x16x32_bf16 v[144:147], a[132:135], a[116:119], v[144:147]
buffer_load_dwordx4 v15, s[8:11], s25 offen offset:3072 lds
v_mfma_f32_16x16x32_bf16 v[152:155], a[128:131], a[120:123], v[152:155]
s_add_u32 s25, s25, 128
s_waitcnt vmcnt(12)
v_mfma_f32_16x16x32_bf16 v[152:155], a[132:135], a[124:127], v[152:155]
s_waitcnt lgkmcnt(2)
v_cmp_gt_u32 vcc, 1, v230
v_mfma_f32_16x16x32_bf16 v[100:103], a[136:139], a[64:67], v[100:103]
s_cbranch_vccnz M_ppspinK
M_ppokK:
ds_read_b64_tr_b16 a[128:129], v8 offset:32768
v_mfma_f32_16x16x32_bf16 v[100:103], a[140:143], a[68:71], v[100:103]
buffer_load_dword v230, v229, s[4:7], s53 offen sc1
v_mfma_f32_16x16x32_bf16 v[108:111], a[136:139], a[72:75], v[108:111]
s_mov_b64 s[8:9], s[76:77]
ds_read_b64_tr_b16 a[130:131], v8 offset:34816
v_mfma_f32_16x16x32_bf16 v[108:111], a[140:143], a[76:79], v[108:111]
s_mov_b32 s10, 1835008
buffer_load_dword v230, v229, s[4:7], s48 offen sc1
v_mfma_f32_16x16x32_bf16 v[116:119], a[136:139], a[80:83], v[116:119]
s_lshl_b32 s24, s37, 2
ds_read_b64_tr_b16 a[132:133], v8 offset:49152
v_mfma_f32_16x16x32_bf16 v[116:119], a[140:143], a[84:87], v[116:119]
s_add_u32 s24, s24, s3
buffer_load_dword v230, v229, s[56:59], s49 offen
v_mfma_f32_16x16x32_bf16 v[124:127], a[136:139], a[88:91], v[124:127]
s_mul_i32 s24, s24, 28672
ds_read_b64_tr_b16 a[134:135], v8 offset:51200
v_mfma_f32_16x16x32_bf16 v[124:127], a[140:143], a[92:95], v[124:127]
s_mov_b32 s28, s29
buffer_load_dword v21, v20, s[16:19], s43 offen
v_mfma_f32_16x16x32_bf16 v[132:135], a[136:139], a[96:99], v[132:135]
ds_read_b128 a[32:35], v2 offset:8192
v_mfma_f32_16x16x32_bf16 v[132:135], a[140:143], a[100:103], v[132:135]
v_mfma_f32_16x16x32_bf16 v[140:143], a[136:139], a[104:107], v[140:143]
v_mfma_f32_16x16x32_bf16 v[140:143], a[140:143], a[108:111], v[140:143]
v_mfma_f32_16x16x32_bf16 v[148:151], a[136:139], a[112:115], v[148:151]
ds_read_b128 a[36:39], v3 offset:8192
v_lshrrev_b32 v28, 7, v1
v_mfma_f32_16x16x32_bf16 v[148:151], a[140:143], a[116:119], v[148:151]
v_lshrrev_b32 v29, 1, v28
v_lshlrev_b32 v29, 4, v29
v_mfma_f32_16x16x32_bf16 v[156:159], a[136:139], a[120:123], v[156:159]
ds_read_b128 a[40:43], v2 offset:10240
v_and_b32 v30, 0x70, v1
v_mfma_f32_16x16x32_bf16 v[156:159], a[140:143], a[124:127], v[156:159]
s_waitcnt lgkmcnt(3)
v_xor_b32 v29, v29, v30
v_mul_u32_u24 v28, 896, v28
v_mfma_f32_16x16x32_bf16 v[160:163], a[128:131], a[64:67], v[160:163]
ds_read_b64_tr_b16 a[136:137], v9 offset:32768
v_add_u32 v12, v28, v29
v_mfma_f32_16x16x32_bf16 v[160:163], a[132:135], a[68:71], v[160:163]
v_xor_b32 v29, 64, v29
v_add_u32 v28, v28, v29
v_mfma_f32_16x16x32_bf16 v[168:171], a[128:131], a[72:75], v[168:171]
ds_read_b64_tr_b16 a[138:139], v9 offset:34816
v_add_u32 v13, 6144, v28
v_mfma_f32_16x16x32_bf16 v[168:171], a[132:135], a[76:79], v[168:171]
v_add_u32 v14, 12288, v12
v_add_u32 v15, 18432, v28
v_mfma_f32_16x16x32_bf16 v[176:179], a[128:131], a[80:83], v[176:179]
ds_read_b64_tr_b16 a[140:141], v9 offset:49152
v_xor_b32 v22, s44, v4
v_mfma_f32_16x16x32_bf16 v[176:179], a[132:135], a[84:87], v[176:179]
v_xor_b32 v23, 32, v22
v_xor_b32 v24, 64, v22
v_mfma_f32_16x16x32_bf16 v[184:187], a[128:131], a[88:91], v[184:187]
ds_read_b64_tr_b16 a[142:143], v9 offset:51200
v_xor_b32 v25, 96, v22
v_mfma_f32_16x16x32_bf16 v[184:187], a[132:135], a[92:95], v[184:187]
v_mfma_f32_16x16x32_bf16 v[192:195], a[128:131], a[96:99], v[192:195]
v_mfma_f32_16x16x32_bf16 v[192:195], a[132:135], a[100:103], v[192:195]
v_mfma_f32_16x16x32_bf16 v[200:203], a[128:131], a[104:107], v[200:203]
ds_read_b128 a[44:47], v3 offset:10240
v_mfma_f32_16x16x32_bf16 v[200:203], a[132:135], a[108:111], v[200:203]
v_mfma_f32_16x16x32_bf16 v[208:211], a[128:131], a[112:115], v[208:211]
ds_read_b128 a[48:51], v2 offset:12288
v_mfma_f32_16x16x32_bf16 v[208:211], a[132:135], a[116:119], v[208:211]
v_mfma_f32_16x16x32_bf16 v[216:219], a[128:131], a[120:123], v[216:219]
v_mfma_f32_16x16x32_bf16 v[216:219], a[132:135], a[124:127], v[216:219]
s_waitcnt lgkmcnt(2)
v_mfma_f32_16x16x32_bf16 v[164:167], a[136:139], a[64:67], v[164:167]
ds_read_b64_tr_b16 a[128:129], v10 offset:32768
v_mfma_f32_16x16x32_bf16 v[164:167], a[140:143], a[68:71], v[164:167]
v_mfma_f32_16x16x32_bf16 v[172:175], a[136:139], a[72:75], v[172:175]
ds_read_b64_tr_b16 a[130:131], v10 offset:34816
v_mfma_f32_16x16x32_bf16 v[172:175], a[140:143], a[76:79], v[172:175]
v_mfma_f32_16x16x32_bf16 v[180:183], a[136:139], a[80:83], v[180:183]
ds_read_b64_tr_b16 a[132:133], v10 offset:49152
v_mfma_f32_16x16x32_bf16 v[180:183], a[140:143], a[84:87], v[180:183]
v_mfma_f32_16x16x32_bf16 v[188:191], a[136:139], a[88:91], v[188:191]
ds_read_b64_tr_b16 a[134:135], v10 offset:51200
v_mfma_f32_16x16x32_bf16 v[188:191], a[140:143], a[92:95], v[188:191]
v_mfma_f32_16x16x32_bf16 v[196:199], a[136:139], a[96:99], v[196:199]
ds_read_b128 a[52:55], v3 offset:12288
v_mfma_f32_16x16x32_bf16 v[196:199], a[140:143], a[100:103], v[196:199]
v_mfma_f32_16x16x32_bf16 v[204:207], a[136:139], a[104:107], v[204:207]
ds_read_b128 a[56:59], v2 offset:14336
v_mfma_f32_16x16x32_bf16 v[204:207], a[140:143], a[108:111], v[204:207]
v_mfma_f32_16x16x32_bf16 v[212:215], a[136:139], a[112:115], v[212:215]
v_mfma_f32_16x16x32_bf16 v[212:215], a[140:143], a[116:119], v[212:215]
v_mfma_f32_16x16x32_bf16 v[220:223], a[136:139], a[120:123], v[220:223]
ds_read_b128 a[60:63], v3 offset:14336
v_mfma_f32_16x16x32_bf16 v[220:223], a[140:143], a[124:127], v[220:223]
s_waitcnt lgkmcnt(3)
v_mfma_f32_16x16x32_bf16 a[192:195], a[128:131], a[64:67], a[192:195]
ds_read_b64_tr_b16 a[136:137], v11 offset:32768
v_mfma_f32_16x16x32_bf16 a[192:195], a[132:135], a[68:71], a[192:195]
v_mfma_f32_16x16x32_bf16 a[200:203], a[128:131], a[72:75], a[200:203]
ds_read_b64_tr_b16 a[138:139], v11 offset:34816
v_mfma_f32_16x16x32_bf16 a[200:203], a[132:135], a[76:79], a[200:203]
v_mfma_f32_16x16x32_bf16 a[208:211], a[128:131], a[80:83], a[208:211]
ds_read_b64_tr_b16 a[140:141], v11 offset:49152
v_mfma_f32_16x16x32_bf16 a[208:211], a[132:135], a[84:87], a[208:211]
v_mfma_f32_16x16x32_bf16 a[216:219], a[128:131], a[88:91], a[216:219]
ds_read_b64_tr_b16 a[142:143], v11 offset:51200
v_mfma_f32_16x16x32_bf16 a[216:219], a[132:135], a[92:95], a[216:219]
v_mfma_f32_16x16x32_bf16 a[224:227], a[128:131], a[96:99], a[224:227]
v_mfma_f32_16x16x32_bf16 a[224:227], a[132:135], a[100:103], a[224:227]
v_mfma_f32_16x16x32_bf16 a[232:235], a[128:131], a[104:107], a[232:235]
v_mfma_f32_16x16x32_bf16 a[232:235], a[132:135], a[108:111], a[232:235]
v_mfma_f32_16x16x32_bf16 a[240:243], a[128:131], a[112:115], a[240:243]
v_mfma_f32_16x16x32_bf16 a[240:243], a[132:135], a[116:119], a[240:243]
v_mfma_f32_16x16x32_bf16 a[248:251], a[128:131], a[120:123], a[248:251]
s_waitcnt vmcnt(4) lgkmcnt(0)
v_mfma_f32_16x16x32_bf16 a[248:251], a[132:135], a[124:127], a[248:251]
s_barrier
v_mfma_f32_16x16x32_bf16 a[196:199], a[136:139], a[64:67], a[196:199]
s_add_u32 m0, s29, 98304
ds_read_b64_tr_b16 a[128:129], v4 offset:0
v_mfma_f32_16x16x32_bf16 a[196:199], a[140:143], a[68:71], a[196:199]
buffer_load_dwordx4 v16, s[12:15], s26 offen offset:0 lds
v_mfma_f32_16x16x32_bf16 a[204:207], a[136:139], a[72:75], a[204:207]
ds_read_b64_tr_b16 a[130:131], v4 offset:2048
v_mfma_f32_16x16x32_bf16 a[204:207], a[140:143], a[76:79], a[204:207]
v_mfma_f32_16x16x32_bf16 a[212:215], a[136:139], a[80:83], a[212:215]
ds_read_b64_tr_b16 a[132:133], v4 offset:16384
v_mfma_f32_16x16x32_bf16 a[212:215], a[140:143], a[84:87], a[212:215]
buffer_load_dwordx4 v17, s[12:15], s26 offen offset:1024 lds
v_mfma_f32_16x16x32_bf16 a[220:223], a[136:139], a[88:91], a[220:223]
ds_read_b64_tr_b16 a[134:135], v4 offset:18432
v_mfma_f32_16x16x32_bf16 a[220:223], a[140:143], a[92:95], a[220:223]
v_mfma_f32_16x16x32_bf16 a[228:231], a[136:139], a[96:99], a[228:231]
v_mfma_f32_16x16x32_bf16 a[228:231], a[140:143], a[100:103], a[228:231]
buffer_load_dwordx4 v18, s[12:15], s26 offen offset:2048 lds
v_mfma_f32_16x16x32_bf16 a[236:239], a[136:139], a[104:107], a[236:239]
v_mfma_f32_16x16x32_bf16 a[236:239], a[140:143], a[108:111], a[236:239]
v_mfma_f32_16x16x32_bf16 a[244:247], a[136:139], a[112:115], a[244:247]
v_mfma_f32_16x16x32_bf16 a[244:247], a[140:143], a[116:119], a[244:247]
buffer_load_dwordx4 v19, s[12:15], s26 offen offset:3072 lds
v_mfma_f32_16x16x32_bf16 a[252:255], a[136:139], a[120:123], a[252:255]
s_add_u32 s26, s26, 524288
v_mfma_f32_16x16x32_bf16 a[252:255], a[140:143], a[124:127], a[252:255]
s_waitcnt lgkmcnt(0)
v_mfma_f32_16x16x32_bf16 v[32:35], a[128:131], a[0:3], v[32:35]
s_add_u32 m0, s29, 114688
ds_read_b64_tr_b16 a[136:137], v5 offset:0
v_mfma_f32_16x16x32_bf16 v[32:35], a[132:135], a[4:7], v[32:35]
buffer_load_dwordx4 v16, s[12:15], s27 offen offset:0 lds
v_mfma_f32_16x16x32_bf16 v[40:43], a[128:131], a[8:11], v[40:43]
ds_read_b64_tr_b16 a[138:139], v5 offset:2048
v_mfma_f32_16x16x32_bf16 v[40:43], a[132:135], a[12:15], v[40:43]
v_mfma_f32_16x16x32_bf16 v[48:51], a[128:131], a[16:19], v[48:51]
ds_read_b64_tr_b16 a[140:141], v5 offset:16384
v_mfma_f32_16x16x32_bf16 v[48:51], a[132:135], a[20:23], v[48:51]
buffer_load_dwordx4 v17, s[12:15], s27 offen offset:1024 lds
v_mfma_f32_16x16x32_bf16 v[56:59], a[128:131], a[24:27], v[56:59]
ds_read_b64_tr_b16 a[142:143], v5 offset:18432
v_mfma_f32_16x16x32_bf16 v[56:59], a[132:135], a[28:31], v[56:59]
v_mfma_f32_16x16x32_bf16 v[64:67], a[128:131], a[32:35], v[64:67]
ds_read_b128 a[64:67], v2 offset:32768
v_mfma_f32_16x16x32_bf16 v[64:67], a[132:135], a[36:39], v[64:67]
buffer_load_dwordx4 v18, s[12:15], s27 offen offset:2048 lds
v_mfma_f32_16x16x32_bf16 v[72:75], a[128:131], a[40:43], v[72:75]
ds_read_b128 a[68:71], v3 offset:32768
v_mfma_f32_16x16x32_bf16 v[72:75], a[132:135], a[44:47], v[72:75]
v_mfma_f32_16x16x32_bf16 v[80:83], a[128:131], a[48:51], v[80:83]
v_mfma_f32_16x16x32_bf16 v[80:83], a[132:135], a[52:55], v[80:83]
buffer_load_dwordx4 v19, s[12:15], s27 offen offset:3072 lds
v_mfma_f32_16x16x32_bf16 v[88:91], a[128:131], a[56:59], v[88:91]
s_add_u32 s27, s27, 524288
ds_read_b128 a[72:75], v2 offset:34816
v_mfma_f32_16x16x32_bf16 v[88:91], a[132:135], a[60:63], v[88:91]
s_waitcnt lgkmcnt(3)
v_mfma_f32_16x16x32_bf16 v[36:39], a[136:139], a[0:3], v[36:39]
s_add_u32 m0, s28, 0
ds_read_b64_tr_b16 a[128:129], v6 offset:0
v_mfma_f32_16x16x32_bf16 v[36:39], a[140:143], a[4:7], v[36:39]
buffer_load_dwordx4 v12, s[8:11], s24 offen offset:0 lds
v_mfma_f32_16x16x32_bf16 v[44:47], a[136:139], a[8:11], v[44:47]
ds_read_b64_tr_b16 a[130:131], v6 offset:2048
v_mfma_f32_16x16x32_bf16 v[44:47], a[140:143], a[12:15], v[44:47]
v_mfma_f32_16x16x32_bf16 v[52:55], a[136:139], a[16:19], v[52:55]
ds_read_b64_tr_b16 a[132:133], v6 offset:16384
v_mfma_f32_16x16x32_bf16 v[52:55], a[140:143], a[20:23], v[52:55]
buffer_load_dwordx4 v13, s[8:11], s24 offen offset:1024 lds
v_mfma_f32_16x16x32_bf16 v[60:63], a[136:139], a[24:27], v[60:63]
ds_read_b64_tr_b16 a[134:135], v6 offset:18432
v_mfma_f32_16x16x32_bf16 v[60:63], a[140:143], a[28:31], v[60:63]
v_mfma_f32_16x16x32_bf16 v[68:71], a[136:139], a[32:35], v[68:71]
ds_read_b128 a[76:79], v3 offset:34816
v_mfma_f32_16x16x32_bf16 v[68:71], a[140:143], a[36:39], v[68:71]
buffer_load_dwordx4 v14, s[8:11], s24 offen offset:2048 lds
v_mfma_f32_16x16x32_bf16 v[76:79], a[136:139], a[40:43], v[76:79]
v_mfma_f32_16x16x32_bf16 v[76:79], a[140:143], a[44:47], v[76:79]
v_mfma_f32_16x16x32_bf16 v[84:87], a[136:139], a[48:51], v[84:87]
ds_read_b128 a[80:83], v2 offset:36864
v_mfma_f32_16x16x32_bf16 v[84:87], a[140:143], a[52:55], v[84:87]
buffer_load_dwordx4 v15, s[8:11], s24 offen offset:3072 lds
v_mfma_f32_16x16x32_bf16 v[92:95], a[136:139], a[56:59], v[92:95]
s_add_u32 s24, s24, 128
ds_read_b128 a[84:87], v3 offset:36864
v_mfma_f32_16x16x32_bf16 v[92:95], a[140:143], a[60:63], v[92:95]
s_waitcnt lgkmcnt(3)
s_mov_b64 s[12:13], s[80:81]
v_mfma_f32_16x16x32_bf16 v[96:99], a[128:131], a[0:3], v[96:99]
s_mov_b32 s14, 3670016
s_add_u32 m0, s28, 16384
ds_read_b64_tr_b16 a[136:137], v7 offset:0
v_mfma_f32_16x16x32_bf16 v[96:99], a[132:135], a[4:7], v[96:99]
buffer_load_dwordx4 v12, s[8:11], s24 offen offset:0 lds
v_mfma_f32_16x16x32_bf16 v[104:107], a[128:131], a[8:11], v[104:107]
ds_read_b64_tr_b16 a[138:139], v7 offset:2048
v_mfma_f32_16x16x32_bf16 v[104:107], a[132:135], a[12:15], v[104:107]
v_mfma_f32_16x16x32_bf16 v[112:115], a[128:131], a[16:19], v[112:115]
ds_read_b64_tr_b16 a[140:141], v7 offset:16384
v_mfma_f32_16x16x32_bf16 v[112:115], a[132:135], a[20:23], v[112:115]
buffer_load_dwordx4 v13, s[8:11], s24 offen offset:1024 lds
v_mfma_f32_16x16x32_bf16 v[120:123], a[128:131], a[24:27], v[120:123]
ds_read_b64_tr_b16 a[142:143], v7 offset:18432
v_mfma_f32_16x16x32_bf16 v[120:123], a[132:135], a[28:31], v[120:123]
v_mfma_f32_16x16x32_bf16 v[128:131], a[128:131], a[32:35], v[128:131]
v_mfma_f32_16x16x32_bf16 v[128:131], a[132:135], a[36:39], v[128:131]
buffer_load_dwordx4 v14, s[8:11], s24 offen offset:2048 lds
v_mfma_f32_16x16x32_bf16 v[136:139], a[128:131], a[40:43], v[136:139]
ds_read_b128 a[88:91], v2 offset:38912
v_mfma_f32_16x16x32_bf16 v[136:139], a[132:135], a[44:47], v[136:139]
v_mfma_f32_16x16x32_bf16 v[144:147], a[128:131], a[48:51], v[144:147]
ds_read_b128 a[92:95], v3 offset:38912
v_mfma_f32_16x16x32_bf16 v[144:147], a[132:135], a[52:55], v[144:147]
buffer_load_dwordx4 v15, s[8:11], s24 offen offset:3072 lds
v_mfma_f32_16x16x32_bf16 v[152:155], a[128:131], a[56:59], v[152:155]
s_add_u32 s24, s24, 128
v_mfma_f32_16x16x32_bf16 v[152:155], a[132:135], a[60:63], v[152:155]
s_waitcnt lgkmcnt(2)
s_sub_u32 s26, s26, 8388608
v_mfma_f32_16x16x32_bf16 v[100:103], a[136:139], a[0:3], v[100:103]
s_sub_u32 s27, s27, 8388608
s_add_u32 m0, s29, 131072
ds_read_b64_tr_b16 a[128:129], v8 offset:0
v_mfma_f32_16x16x32_bf16 v[100:103], a[140:143], a[4:7], v[100:103]
PAD_5:
s_cbranch_execz M_tret
buffer_load_dwordx4 v16, s[12:15], s26 offen offset:0 lds
v_mfma_f32_16x16x32_bf16 v[108:111], a[136:139], a[8:11], v[108:111]
ds_read_b64_tr_b16 a[130:131], v8 offset:2048
v_mfma_f32_16x16x32_bf16 v[108:111], a[140:143], a[12:15], v[108:111]
v_mfma_f32_16x16x32_bf16 v[116:119], a[136:139], a[16:19], v[116:119]
ds_read_b64_tr_b16 a[132:133], v8 offset:16384
v_mfma_f32_16x16x32_bf16 v[116:119], a[140:143], a[20:23], v[116:119]
buffer_load_dwordx4 v17, s[12:15], s26 offen offset:1024 lds
v_mfma_f32_16x16x32_bf16 v[124:127], a[136:139], a[24:27], v[124:127]
ds_read_b64_tr_b16 a[134:135], v8 offset:18432
v_mfma_f32_16x16x32_bf16 v[124:127], a[140:143], a[28:31], v[124:127]
v_mfma_f32_16x16x32_bf16 v[132:135], a[136:139], a[32:35], v[132:135]
ds_read_b128 a[96:99], v2 offset:40960
v_mfma_f32_16x16x32_bf16 v[132:135], a[140:143], a[36:39], v[132:135]
buffer_load_dwordx4 v18, s[12:15], s26 offen offset:2048 lds
v_mfma_f32_16x16x32_bf16 v[140:143], a[136:139], a[40:43], v[140:143]
v_mfma_f32_16x16x32_bf16 v[140:143], a[140:143], a[44:47], v[140:143]
v_mfma_f32_16x16x32_bf16 v[148:151], a[136:139], a[48:51], v[148:151]
ds_read_b128 a[100:103], v3 offset:40960
v_mfma_f32_16x16x32_bf16 v[148:151], a[140:143], a[52:55], v[148:151]
buffer_load_dwordx4 v19, s[12:15], s26 offen offset:3072 lds
v_mfma_f32_16x16x32_bf16 v[156:159], a[136:139], a[56:59], v[156:159]
s_add_u32 s26, s26, 524288
ds_read_b128 a[104:107], v2 offset:43008
v_mfma_f32_16x16x32_bf16 v[156:159], a[140:143], a[60:63], v[156:159]
s_waitcnt lgkmcnt(3)
v_mfma_f32_16x16x32_bf16 v[160:163], a[128:131], a[0:3], v[160:163]
s_add_u32 m0, s29, 147456
ds_read_b64_tr_b16 a[136:137], v9 offset:0
v_mfma_f32_16x16x32_bf16 v[160:163], a[132:135], a[4:7], v[160:163]
buffer_load_dwordx4 v16, s[12:15], s27 offen offset:0 lds
v_mfma_f32_16x16x32_bf16 v[168:171], a[128:131], a[8:11], v[168:171]
ds_read_b64_tr_b16 a[138:139], v9 offset:2048
v_mfma_f32_16x16x32_bf16 v[168:171], a[132:135], a[12:15], v[168:171]
v_mfma_f32_16x16x32_bf16 v[176:179], a[128:131], a[16:19], v[176:179]
ds_read_b64_tr_b16 a[140:141], v9 offset:16384
v_mfma_f32_16x16x32_bf16 v[176:179], a[132:135], a[20:23], v[176:179]
buffer_load_dwordx4 v17, s[12:15], s27 offen offset:1024 lds
v_mfma_f32_16x16x32_bf16 v[184:187], a[128:131], a[24:27], v[184:187]
ds_read_b64_tr_b16 a[142:143], v9 offset:18432
v_mfma_f32_16x16x32_bf16 v[184:187], a[132:135], a[28:31], v[184:187]
v_mfma_f32_16x16x32_bf16 v[192:195], a[128:131], a[32:35], v[192:195]
v_mfma_f32_16x16x32_bf16 v[192:195], a[132:135], a[36:39], v[192:195]
buffer_load_dwordx4 v18, s[12:15], s27 offen offset:2048 lds
v_mfma_f32_16x16x32_bf16 v[200:203], a[128:131], a[40:43], v[200:203]
ds_read_b128 a[108:111], v3 offset:43008
v_mfma_f32_16x16x32_bf16 v[200:203], a[132:135], a[44:47], v[200:203]
v_mfma_f32_16x16x32_bf16 v[208:211], a[128:131], a[48:51], v[208:211]
ds_read_b128 a[112:115], v2 offset:45056
v_mfma_f32_16x16x32_bf16 v[208:211], a[132:135], a[52:55], v[208:211]
buffer_load_dwordx4 v19, s[12:15], s27 offen offset:3072 lds
v_mfma_f32_16x16x32_bf16 v[216:219], a[128:131], a[56:59], v[216:219]
s_add_u32 s27, s27, 524288
v_mfma_f32_16x16x32_bf16 v[216:219], a[132:135], a[60:63], v[216:219]
s_waitcnt lgkmcnt(2)
v_mfma_f32_16x16x32_bf16 v[164:167], a[136:139], a[0:3], v[164:167]
ds_read_b64_tr_b16 a[128:129], v10 offset:0
v_mfma_f32_16x16x32_bf16 v[164:167], a[140:143], a[4:7], v[164:167]
v_mfma_f32_16x16x32_bf16 v[172:175], a[136:139], a[8:11], v[172:175]
ds_read_b64_tr_b16 a[130:131], v10 offset:2048
v_mfma_f32_16x16x32_bf16 v[172:175], a[140:143], a[12:15], v[172:175]
v_mfma_f32_16x16x32_bf16 v[180:183], a[136:139], a[16:19], v[180:183]
ds_read_b64_tr_b16 a[132:133], v10 offset:16384
v_mfma_f32_16x16x32_bf16 v[180:183], a[140:143], a[20:23], v[180:183]
v_mfma_f32_16x16x32_bf16 v[188:191], a[136:139], a[24:27], v[188:191]
ds_read_b64_tr_b16 a[134:135], v10 offset:18432
v_mfma_f32_16x16x32_bf16 v[188:191], a[140:143], a[28:31], v[188:191]
v_mfma_f32_16x16x32_bf16 v[196:199], a[136:139], a[32:35], v[196:199]
ds_read_b128 a[116:119], v3 offset:45056
v_mfma_f32_16x16x32_bf16 v[196:199], a[140:143], a[36:39], v[196:199]
v_mfma_f32_16x16x32_bf16 v[204:207], a[136:139], a[40:43], v[204:207]
ds_read_b128 a[120:123], v2 offset:47104
v_mfma_f32_16x16x32_bf16 v[204:207], a[140:143], a[44:47], v[204:207]
v_mfma_f32_16x16x32_bf16 v[212:215], a[136:139], a[48:51], v[212:215]
v_mfma_f32_16x16x32_bf16 v[212:215], a[140:143], a[52:55], v[212:215]
v_mfma_f32_16x16x32_bf16 v[220:223], a[136:139], a[56:59], v[220:223]
ds_read_b128 a[124:127], v3 offset:47104
v_mfma_f32_16x16x32_bf16 v[220:223], a[140:143], a[60:63], v[220:223]
s_waitcnt lgkmcnt(3)
v_mfma_f32_16x16x32_bf16 a[192:195], a[128:131], a[0:3], a[192:195]
ds_read_b64_tr_b16 a[136:137], v11 offset:0
v_mfma_f32_16x16x32_bf16 a[192:195], a[132:135], a[4:7], a[192:195]
v_mfma_f32_16x16x32_bf16 a[200:203], a[128:131], a[8:11], a[200:203]
ds_read_b64_tr_b16 a[138:139], v11 offset:2048
v_mfma_f32_16x16x32_bf16 a[200:203], a[132:135], a[12:15], a[200:203]
v_mfma_f32_16x16x32_bf16 a[208:211], a[128:131], a[16:19], a[208:211]
ds_read_b64_tr_b16 a[140:141], v11 offset:16384
v_mfma_f32_16x16x32_bf16 a[208:211], a[132:135], a[20:23], a[208:211]
v_mfma_f32_16x16x32_bf16 a[216:219], a[128:131], a[24:27], a[216:219]
ds_read_b64_tr_b16 a[142:143], v11 offset:18432
v_mfma_f32_16x16x32_bf16 a[216:219], a[132:135], a[28:31], a[216:219]
v_mfma_f32_16x16x32_bf16 a[224:227], a[128:131], a[32:35], a[224:227]
v_mfma_f32_16x16x32_bf16 a[224:227], a[132:135], a[36:39], a[224:227]
v_mfma_f32_16x16x32_bf16 a[232:235], a[128:131], a[40:43], a[232:235]
v_mfma_f32_16x16x32_bf16 a[232:235], a[132:135], a[44:47], a[232:235]
v_mfma_f32_16x16x32_bf16 a[240:243], a[128:131], a[48:51], a[240:243]
v_mfma_f32_16x16x32_bf16 a[240:243], a[132:135], a[52:55], a[240:243]
v_mfma_f32_16x16x32_bf16 a[248:251], a[128:131], a[56:59], a[248:251]
s_waitcnt vmcnt(12) lgkmcnt(0)
v_mfma_f32_16x16x32_bf16 a[248:251], a[132:135], a[60:63], a[248:251]
s_barrier
v_mfma_f32_16x16x32_bf16 a[196:199], a[136:139], a[0:3], a[196:199]
s_add_u32 m0, s28, 32768
ds_read_b64_tr_b16 a[128:129], v4 offset:32768
v_mfma_f32_16x16x32_bf16 a[196:199], a[140:143], a[4:7], a[196:199]
s_lshr_b32 s22, s3, 1
buffer_load_dwordx4 v12, s[8:11], s24 offen offset:0 lds
v_mfma_f32_16x16x32_bf16 a[204:207], a[136:139], a[8:11], a[204:207]
s_lshl_b32 s22, s22, 14
ds_read_b64_tr_b16 a[130:131], v4 offset:34816
v_subrev_u32 v2, s22, v2
v_mfma_f32_16x16x32_bf16 a[204:207], a[140:143], a[12:15], a[204:207]
v_subrev_u32 v3, s22, v3
v_mfma_f32_16x16x32_bf16 a[212:215], a[136:139], a[16:19], a[212:215]
ds_read_b64_tr_b16 a[132:133], v4 offset:49152
v_mfma_f32_16x16x32_bf16 a[212:215], a[140:143], a[20:23], a[212:215]
buffer_load_dwordx4 v13, s[8:11], s24 offen offset:1024 lds
v_mfma_f32_16x16x32_bf16 a[220:223], a[136:139], a[24:27], a[220:223]
ds_read_b64_tr_b16 a[134:135], v4 offset:51200
v_mfma_f32_16x16x32_bf16 a[220:223], a[140:143], a[28:31], a[220:223]
v_mfma_f32_16x16x32_bf16 a[228:231], a[136:139], a[32:35], a[228:231]
v_mfma_f32_16x16x32_bf16 a[228:231], a[140:143], a[36:39], a[228:231]
buffer_load_dwordx4 v14, s[8:11], s24 offen offset:2048 lds
v_mfma_f32_16x16x32_bf16 a[236:239], a[136:139], a[40:43], a[236:239]
v_mfma_f32_16x16x32_bf16 a[236:239], a[140:143], a[44:47], a[236:239]
v_mfma_f32_16x16x32_bf16 a[244:247], a[136:139], a[48:51], a[244:247]
v_mfma_f32_16x16x32_bf16 a[244:247], a[140:143], a[52:55], a[244:247]
buffer_load_dwordx4 v15, s[8:11], s24 offen offset:3072 lds
v_mfma_f32_16x16x32_bf16 a[252:255], a[136:139], a[56:59], a[252:255]
s_add_u32 s24, s24, 128
v_mfma_f32_16x16x32_bf16 a[252:255], a[140:143], a[60:63], a[252:255]
s_waitcnt lgkmcnt(0)
v_mfma_f32_16x16x32_bf16 v[32:35], a[128:131], a[64:67], v[32:35]
s_add_u32 m0, s29, 65536
ds_read_b64_tr_b16 a[136:137], v5 offset:32768
v_mfma_f32_16x16x32_bf16 v[32:35], a[132:135], a[68:71], v[32:35]
buffer_load_dwordx4 v16, s[12:15], s26 offen offset:0 lds
v_mfma_f32_16x16x32_bf16 v[40:43], a[128:131], a[72:75], v[40:43]
ds_read_b64_tr_b16 a[138:139], v5 offset:34816
v_mfma_f32_16x16x32_bf16 v[40:43], a[132:135], a[76:79], v[40:43]
v_mfma_f32_16x16x32_bf16 v[48:51], a[128:131], a[80:83], v[48:51]
ds_read_b64_tr_b16 a[140:141], v5 offset:49152
v_mfma_f32_16x16x32_bf16 v[48:51], a[132:135], a[84:87], v[48:51]
buffer_load_dwordx4 v17, s[12:15], s26 offen offset:1024 lds
v_mfma_f32_16x16x32_bf16 v[56:59], a[128:131], a[88:91], v[56:59]
ds_read_b64_tr_b16 a[142:143], v5 offset:51200
v_mfma_f32_16x16x32_bf16 v[56:59], a[132:135], a[92:95], v[56:59]
v_mfma_f32_16x16x32_bf16 v[64:67], a[128:131], a[96:99], v[64:67]
ds_read_b128 a[0:3], v2 offset:0
v_mfma_f32_16x16x32_bf16 v[64:67], a[132:135], a[100:103], v[64:67]
buffer_load_dwordx4 v18, s[12:15], s26 offen offset:2048 lds
v_mfma_f32_16x16x32_bf16 v[72:75], a[128:131], a[104:107], v[72:75]
ds_read_b128 a[4:7], v3 offset:0
v_mfma_f32_16x16x32_bf16 v[72:75], a[132:135], a[108:111], v[72:75]
v_mfma_f32_16x16x32_bf16 v[80:83], a[128:131], a[112:115], v[80:83]
v_mfma_f32_16x16x32_bf16 v[80:83], a[132:135], a[116:119], v[80:83]
buffer_load_dwordx4 v19, s[12:15], s26 offen offset:3072 lds
v_mfma_f32_16x16x32_bf16 v[88:91], a[128:131], a[120:123], v[88:91]
s_add_u32 s26, s26, 524288
ds_read_b128 a[8:11], v2 offset:2048
v_mfma_f32_16x16x32_bf16 v[88:91], a[132:135], a[124:127], v[88:91]
s_waitcnt lgkmcnt(3)
v_mfma_f32_16x16x32_bf16 v[36:39], a[136:139], a[64:67], v[36:39]
s_add_u32 m0, s29, 81920
ds_read_b64_tr_b16 a[128:129], v6 offset:32768
v_mfma_f32_16x16x32_bf16 v[36:39], a[140:143], a[68:71], v[36:39]
buffer_load_dwordx4 v16, s[12:15], s27 offen offset:0 lds
v_mfma_f32_16x16x32_bf16 v[44:47], a[136:139], a[72:75], v[44:47]
ds_read_b64_tr_b16 a[130:131], v6 offset:34816
v_mfma_f32_16x16x32_bf16 v[44:47], a[140:143], a[76:79], v[44:47]
v_mfma_f32_16x16x32_bf16 v[52:55], a[136:139], a[80:83], v[52:55]
ds_read_b64_tr_b16 a[132:133], v6 offset:49152
v_mfma_f32_16x16x32_bf16 v[52:55], a[140:143], a[84:87], v[52:55]
buffer_load_dwordx4 v17, s[12:15], s27 offen offset:1024 lds
v_mfma_f32_16x16x32_bf16 v[60:63], a[136:139], a[88:91], v[60:63]
ds_read_b64_tr_b16 a[134:135], v6 offset:51200
v_cvt_pk_bf16_f32 v32, v32, v33
v_mfma_f32_16x16x32_bf16 v[60:63], a[140:143], a[92:95], v[60:63]
v_cvt_pk_bf16_f32 v33, v34, v35
v_cvt_pk_bf16_f32 v34, v36, v37
v_mfma_f32_16x16x32_bf16 v[68:71], a[136:139], a[96:99], v[68:71]
ds_read_b128 a[12:15], v3 offset:2048
v_cvt_pk_bf16_f32 v35, v38, v39
v_mfma_f32_16x16x32_bf16 v[68:71], a[140:143], a[100:103], v[68:71]
buffer_load_dwordx4 v18, s[12:15], s27 offen offset:2048 lds
v_mfma_f32_16x16x32_bf16 v[76:79], a[136:139], a[104:107], v[76:79]
v_cvt_pk_bf16_f32 v40, v40, v41
v_cvt_pk_bf16_f32 v41, v42, v43
v_mfma_f32_16x16x32_bf16 v[76:79], a[140:143], a[108:111], v[76:79]
v_cvt_pk_bf16_f32 v42, v44, v45
v_cvt_pk_bf16_f32 v43, v46, v47
v_mfma_f32_16x16x32_bf16 v[84:87], a[136:139], a[112:115], v[84:87]
ds_read_b128 a[16:19], v2 offset:4096
v_cvt_pk_bf16_f32 v48, v48, v49
v_mfma_f32_16x16x32_bf16 v[84:87], a[140:143], a[116:119], v[84:87]
buffer_load_dwordx4 v19, s[12:15], s27 offen offset:3072 lds
v_mfma_f32_16x16x32_bf16 v[92:95], a[136:139], a[120:123], v[92:95]
s_add_u32 s27, s27, 524288
ds_read_b128 a[20:23], v3 offset:4096
v_cvt_pk_bf16_f32 v49, v50, v51
v_mfma_f32_16x16x32_bf16 v[92:95], a[140:143], a[124:127], v[92:95]
s_waitcnt lgkmcnt(3)
v_cvt_pk_bf16_f32 v50, v52, v53
v_cvt_pk_bf16_f32 v51, v54, v55
v_mfma_f32_16x16x32_bf16 v[96:99], a[128:131], a[64:67], v[96:99]
s_add_u32 m0, s28, 49152
ds_read_b64_tr_b16 a[136:137], v7 offset:32768
v_cvt_pk_bf16_f32 v56, v56, v57
v_mfma_f32_16x16x32_bf16 v[96:99], a[132:135], a[68:71], v[96:99]
buffer_load_dwordx4 v12, s[8:11], s24 offen offset:0 lds
v_mfma_f32_16x16x32_bf16 v[104:107], a[128:131], a[72:75], v[104:107]
ds_read_b64_tr_b16 a[138:139], v7 offset:34816
v_cvt_pk_bf16_f32 v57, v58, v59
v_mfma_f32_16x16x32_bf16 v[104:107], a[132:135], a[76:79], v[104:107]
v_cvt_pk_bf16_f32 v58, v60, v61
v_cvt_pk_bf16_f32 v59, v62, v63
v_mfma_f32_16x16x32_bf16 v[112:115], a[128:131], a[80:83], v[112:115]
ds_read_b64_tr_b16 a[140:141], v7 offset:49152
v_cvt_pk_bf16_f32 v64, v64, v65
v_mfma_f32_16x16x32_bf16 v[112:115], a[132:135], a[84:87], v[112:115]
buffer_load_dwordx4 v13, s[8:11], s24 offen offset:1024 lds
v_mfma_f32_16x16x32_bf16 v[120:123], a[128:131], a[88:91], v[120:123]
ds_read_b64_tr_b16 a[142:143], v7 offset:51200
v_cvt_pk_bf16_f32 v65, v66, v67
v_mfma_f32_16x16x32_bf16 v[120:123], a[132:135], a[92:95], v[120:123]
v_cvt_pk_bf16_f32 v66, v68, v69
v_cvt_pk_bf16_f32 v67, v70, v71
v_mfma_f32_16x16x32_bf16 v[128:131], a[128:131], a[96:99], v[128:131]
v_cvt_pk_bf16_f32 v72, v72, v73
v_cvt_pk_bf16_f32 v73, v74, v75
v_mfma_f32_16x16x32_bf16 v[128:131], a[132:135], a[100:103], v[128:131]
buffer_load_dwordx4 v14, s[8:11], s24 offen offset:2048 lds
v_mfma_f32_16x16x32_bf16 v[136:139], a[128:131], a[104:107], v[136:139]
ds_read_b128 a[24:27], v2 offset:6144
v_cvt_pk_bf16_f32 v74, v76, v77
v_mfma_f32_16x16x32_bf16 v[136:139], a[132:135], a[108:111], v[136:139]
buffer_store_dwordx4 v[32:35], v1, s[4:7], s31 offen sc1
v_mfma_f32_16x16x32_bf16 v[144:147], a[128:131], a[112:115], v[144:147]
s_add_u32 s31, s31, s32
ds_read_b128 a[28:31], v3 offset:6144
v_cvt_pk_bf16_f32 v75, v78, v79
v_mfma_f32_16x16x32_bf16 v[144:147], a[132:135], a[116:119], v[144:147]
buffer_load_dwordx4 v15, s[8:11], s24 offen offset:3072 lds
v_mfma_f32_16x16x32_bf16 v[152:155], a[128:131], a[120:123], v[152:155]
s_add_u32 s24, s24, 128
v_cvt_pk_bf16_f32 v80, v80, v81
v_cvt_pk_bf16_f32 v81, v82, v83
v_mfma_f32_16x16x32_bf16 v[152:155], a[132:135], a[124:127], v[152:155]
s_waitcnt lgkmcnt(2)
v_cvt_pk_bf16_f32 v82, v84, v85
v_cvt_pk_bf16_f32 v83, v86, v87
v_mfma_f32_16x16x32_bf16 v[100:103], a[136:139], a[64:67], v[100:103]
ds_read_b64_tr_b16 a[128:129], v8 offset:32768
v_cvt_pk_bf16_f32 v88, v88, v89
v_mfma_f32_16x16x32_bf16 v[100:103], a[140:143], a[68:71], v[100:103]
v_cvt_pk_bf16_f32 v89, v90, v91
v_cvt_pk_bf16_f32 v90, v92, v93
v_mfma_f32_16x16x32_bf16 v[108:111], a[136:139], a[72:75], v[108:111]
ds_read_b64_tr_b16 a[130:131], v8 offset:34816
v_cvt_pk_bf16_f32 v91, v94, v95
v_mfma_f32_16x16x32_bf16 v[108:111], a[140:143], a[76:79], v[108:111]
buffer_store_dwordx4 v[40:43], v1, s[4:7], s31 offen sc1
v_mfma_f32_16x16x32_bf16 v[116:119], a[136:139], a[80:83], v[116:119]
s_add_u32 s31, s31, s33
ds_read_b64_tr_b16 a[132:133], v8 offset:49152
v_mfma_f32_16x16x32_bf16 v[116:119], a[140:143], a[84:87], v[116:119]
v_mfma_f32_16x16x32_bf16 v[124:127], a[136:139], a[88:91], v[124:127]
ds_read_b64_tr_b16 a[134:135], v8 offset:51200
v_cvt_pk_bf16_f32 v96, v96, v97
v_mfma_f32_16x16x32_bf16 v[124:127], a[140:143], a[92:95], v[124:127]
v_cvt_pk_bf16_f32 v97, v98, v99
v_cvt_pk_bf16_f32 v98, v100, v101
v_mfma_f32_16x16x32_bf16 v[132:135], a[136:139], a[96:99], v[132:135]
ds_read_b128 a[32:35], v2 offset:8192
v_cvt_pk_bf16_f32 v99, v102, v103
v_mfma_f32_16x16x32_bf16 v[132:135], a[140:143], a[100:103], v[132:135]
v_cvt_pk_bf16_f32 v104, v104, v105
v_cvt_pk_bf16_f32 v105, v106, v107
v_mfma_f32_16x16x32_bf16 v[140:143], a[136:139], a[104:107], v[140:143]
v_cvt_pk_bf16_f32 v106, v108, v109
v_cvt_pk_bf16_f32 v107, v110, v111
v_mfma_f32_16x16x32_bf16 v[140:143], a[140:143], a[108:111], v[140:143]
v_cvt_pk_bf16_f32 v112, v112, v113
v_cvt_pk_bf16_f32 v113, v114, v115
v_mfma_f32_16x16x32_bf16 v[148:151], a[136:139], a[112:115], v[148:151]
ds_read_b128 a[36:39], v3 offset:8192
v_cvt_pk_bf16_f32 v114, v116, v117
v_mfma_f32_16x16x32_bf16 v[148:151], a[140:143], a[116:119], v[148:151]
v_cvt_pk_bf16_f32 v115, v118, v119
v_cvt_pk_bf16_f32 v120, v120, v121
v_mfma_f32_16x16x32_bf16 v[156:159], a[136:139], a[120:123], v[156:159]
ds_read_b128 a[40:43], v2 offset:10240
v_cvt_pk_bf16_f32 v121, v122, v123
v_mfma_f32_16x16x32_bf16 v[156:159], a[140:143], a[124:127], v[156:159]
s_waitcnt lgkmcnt(3)
buffer_store_dwordx4 v[48:51], v1, s[4:7], s31 offen sc1
v_mfma_f32_16x16x32_bf16 v[160:163], a[128:131], a[64:67], v[160:163]
s_add_u32 s31, s31, s32
ds_read_b64_tr_b16 a[136:137], v9 offset:32768
v_cvt_pk_bf16_f32 v122, v124, v125
v_mfma_f32_16x16x32_bf16 v[160:163], a[132:135], a[68:71], v[160:163]
v_cvt_pk_bf16_f32 v123, v126, v127
v_cvt_pk_bf16_f32 v128, v128, v129
v_mfma_f32_16x16x32_bf16 v[168:171], a[128:131], a[72:75], v[168:171]
ds_read_b64_tr_b16 a[138:139], v9 offset:34816
v_cvt_pk_bf16_f32 v129, v130, v131
v_mfma_f32_16x16x32_bf16 v[168:171], a[132:135], a[76:79], v[168:171]
v_cvt_pk_bf16_f32 v130, v132, v133
v_cvt_pk_bf16_f32 v131, v134, v135
v_mfma_f32_16x16x32_bf16 v[176:179], a[128:131], a[80:83], v[176:179]
ds_read_b64_tr_b16 a[140:141], v9 offset:49152
v_cvt_pk_bf16_f32 v136, v136, v137
v_mfma_f32_16x16x32_bf16 v[176:179], a[132:135], a[84:87], v[176:179]
v_cvt_pk_bf16_f32 v137, v138, v139
v_cvt_pk_bf16_f32 v138, v140, v141
v_mfma_f32_16x16x32_bf16 v[184:187], a[128:131], a[88:91], v[184:187]
ds_read_b64_tr_b16 a[142:143], v9 offset:51200
v_cvt_pk_bf16_f32 v139, v142, v143
v_mfma_f32_16x16x32_bf16 v[184:187], a[132:135], a[92:95], v[184:187]
v_cvt_pk_bf16_f32 v144, v144, v145
v_cvt_pk_bf16_f32 v145, v146, v147
v_mfma_f32_16x16x32_bf16 v[192:195], a[128:131], a[96:99], v[192:195]
buffer_store_dwordx4 v[56:59], v1, s[4:7], s31 offen sc1
v_mfma_f32_16x16x32_bf16 v[192:195], a[132:135], a[100:103], v[192:195]
s_add_u32 s31, s31, s34
v_cvt_pk_bf16_f32 v146, v148, v149
v_cvt_pk_bf16_f32 v147, v150, v151
v_mfma_f32_16x16x32_bf16 v[200:203], a[128:131], a[104:107], v[200:203]
ds_read_b128 a[44:47], v3 offset:10240
v_cvt_pk_bf16_f32 v152, v152, v153
v_mfma_f32_16x16x32_bf16 v[200:203], a[132:135], a[108:111], v[200:203]
v_cvt_pk_bf16_f32 v153, v154, v155
v_cvt_pk_bf16_f32 v154, v156, v157
v_mfma_f32_16x16x32_bf16 v[208:211], a[128:131], a[112:115], v[208:211]
ds_read_b128 a[48:51], v2 offset:12288
v_cvt_pk_bf16_f32 v155, v158, v159
v_mfma_f32_16x16x32_bf16 v[208:211], a[132:135], a[116:119], v[208:211]
v_mfma_f32_16x16x32_bf16 v[216:219], a[128:131], a[120:123], v[216:219]
v_mfma_f32_16x16x32_bf16 v[216:219], a[132:135], a[124:127], v[216:219]
s_waitcnt lgkmcnt(2)
v_mfma_f32_16x16x32_bf16 v[164:167], a[136:139], a[64:67], v[164:167]
ds_read_b64_tr_b16 a[128:129], v10 offset:32768
v_mfma_f32_16x16x32_bf16 v[164:167], a[140:143], a[68:71], v[164:167]
v_mfma_f32_16x16x32_bf16 v[172:175], a[136:139], a[72:75], v[172:175]
ds_read_b64_tr_b16 a[130:131], v10 offset:34816
v_mfma_f32_16x16x32_bf16 v[172:175], a[140:143], a[76:79], v[172:175]
buffer_store_dwordx4 v[64:67], v1, s[4:7], s31 offen sc1
v_mfma_f32_16x16x32_bf16 v[180:183], a[136:139], a[80:83], v[180:183]
s_add_u32 s31, s31, s32
ds_read_b64_tr_b16 a[132:133], v10 offset:49152
v_mfma_f32_16x16x32_bf16 v[180:183], a[140:143], a[84:87], v[180:183]
v_mfma_f32_16x16x32_bf16 v[188:191], a[136:139], a[88:91], v[188:191]
ds_read_b64_tr_b16 a[134:135], v10 offset:51200
v_cvt_pk_bf16_f32 v160, v160, v161
v_mfma_f32_16x16x32_bf16 v[188:191], a[140:143], a[92:95], v[188:191]
v_cvt_pk_bf16_f32 v161, v162, v163
v_cvt_pk_bf16_f32 v162, v164, v165
v_mfma_f32_16x16x32_bf16 v[196:199], a[136:139], a[96:99], v[196:199]
ds_read_b128 a[52:55], v3 offset:12288
v_cvt_pk_bf16_f32 v163, v166, v167
v_mfma_f32_16x16x32_bf16 v[196:199], a[140:143], a[100:103], v[196:199]
v_cvt_pk_bf16_f32 v168, v168, v169
v_cvt_pk_bf16_f32 v169, v170, v171
v_mfma_f32_16x16x32_bf16 v[204:207], a[136:139], a[104:107], v[204:207]
ds_read_b128 a[56:59], v2 offset:14336
v_cvt_pk_bf16_f32 v170, v172, v173
v_mfma_f32_16x16x32_bf16 v[204:207], a[140:143], a[108:111], v[204:207]
v_cvt_pk_bf16_f32 v171, v174, v175
v_cvt_pk_bf16_f32 v176, v176, v177
v_mfma_f32_16x16x32_bf16 v[212:215], a[136:139], a[112:115], v[212:215]
v_cvt_pk_bf16_f32 v177, v178, v179
v_cvt_pk_bf16_f32 v178, v180, v181
v_mfma_f32_16x16x32_bf16 v[212:215], a[140:143], a[116:119], v[212:215]
buffer_store_dwordx4 v[72:75], v1, s[4:7], s31 offen sc1
v_mfma_f32_16x16x32_bf16 v[220:223], a[136:139], a[120:123], v[220:223]
s_add_u32 s31, s31, s33
ds_read_b128 a[60:63], v3 offset:14336
v_cvt_pk_bf16_f32 v179, v182, v183
v_mfma_f32_16x16x32_bf16 v[220:223], a[140:143], a[124:127], v[220:223]
s_waitcnt lgkmcnt(3)
v_cvt_pk_bf16_f32 v184, v184, v185
v_cvt_pk_bf16_f32 v185, v186, v187
v_mfma_f32_16x16x32_bf16 a[192:195], a[128:131], a[64:67], a[192:195]
ds_read_b64_tr_b16 a[136:137], v11 offset:32768
v_cvt_pk_bf16_f32 v186, v188, v189
v_mfma_f32_16x16x32_bf16 a[192:195], a[132:135], a[68:71], a[192:195]
v_cvt_pk_bf16_f32 v187, v190, v191
v_cvt_pk_bf16_f32 v192, v192, v193
v_mfma_f32_16x16x32_bf16 a[200:203], a[128:131], a[72:75], a[200:203]
ds_read_b64_tr_b16 a[138:139], v11 offset:34816
v_cvt_pk_bf16_f32 v193, v194, v195
v_mfma_f32_16x16x32_bf16 a[200:203], a[132:135], a[76:79], a[200:203]
v_cvt_pk_bf16_f32 v194, v196, v197
v_cvt_pk_bf16_f32 v195, v198, v199
v_mfma_f32_16x16x32_bf16 a[208:211], a[128:131], a[80:83], a[208:211]
ds_read_b64_tr_b16 a[140:141], v11 offset:49152
v_cvt_pk_bf16_f32 v200, v200, v201
v_mfma_f32_16x16x32_bf16 a[208:211], a[132:135], a[84:87], a[208:211]
v_cvt_pk_bf16_f32 v201, v202, v203
v_cvt_pk_bf16_f32 v202, v204, v205
v_mfma_f32_16x16x32_bf16 a[216:219], a[128:131], a[88:91], a[216:219]
ds_read_b64_tr_b16 a[142:143], v11 offset:51200
v_cvt_pk_bf16_f32 v203, v206, v207
v_mfma_f32_16x16x32_bf16 a[216:219], a[132:135], a[92:95], a[216:219]
v_cvt_pk_bf16_f32 v208, v208, v209
v_cvt_pk_bf16_f32 v209, v210, v211
v_mfma_f32_16x16x32_bf16 a[224:227], a[128:131], a[96:99], a[224:227]
buffer_store_dwordx4 v[80:83], v1, s[4:7], s31 offen sc1
v_mfma_f32_16x16x32_bf16 a[224:227], a[132:135], a[100:103], a[224:227]
s_add_u32 s31, s31, s32
v_cvt_pk_bf16_f32 v210, v212, v213
v_cvt_pk_bf16_f32 v211, v214, v215
v_mfma_f32_16x16x32_bf16 a[232:235], a[128:131], a[104:107], a[232:235]
v_cvt_pk_bf16_f32 v216, v216, v217
v_cvt_pk_bf16_f32 v217, v218, v219
v_mfma_f32_16x16x32_bf16 a[232:235], a[132:135], a[108:111], a[232:235]
v_cvt_pk_bf16_f32 v218, v220, v221
v_cvt_pk_bf16_f32 v219, v222, v223
v_mfma_f32_16x16x32_bf16 a[240:243], a[128:131], a[112:115], a[240:243]
v_mfma_f32_16x16x32_bf16 a[240:243], a[132:135], a[116:119], a[240:243]
v_mfma_f32_16x16x32_bf16 a[248:251], a[128:131], a[120:123], a[248:251]
s_waitcnt vmcnt(23) lgkmcnt(0)
v_mfma_f32_16x16x32_bf16 a[248:251], a[132:135], a[124:127], a[248:251]
s_barrier
v_mfma_f32_16x16x32_bf16 a[196:199], a[136:139], a[64:67], a[196:199]
s_add_u32 m0, s29, 98304
ds_read_b64_tr_b16 a[128:129], v22 offset:0
v_mfma_f32_16x16x32_bf16 a[196:199], a[140:143], a[68:71], a[196:199]
buffer_load_dwordx4 v16, s[12:15], s26 offen offset:0 lds
v_mfma_f32_16x16x32_bf16 a[204:207], a[136:139], a[72:75], a[204:207]
ds_read_b64_tr_b16 a[130:131], v22 offset:2048
v_mfma_f32_16x16x32_bf16 a[204:207], a[140:143], a[76:79], a[204:207]
buffer_store_dwordx4 v[88:91], v1, s[4:7], s31 offen sc1
v_mfma_f32_16x16x32_bf16 a[212:215], a[136:139], a[80:83], a[212:215]
s_add_u32 s31, s31, s35
ds_read_b64_tr_b16 a[132:133], v22 offset:16384
v_mfma_f32_16x16x32_bf16 a[212:215], a[140:143], a[84:87], a[212:215]
buffer_load_dwordx4 v17, s[12:15], s26 offen offset:1024 lds
v_mfma_f32_16x16x32_bf16 a[220:223], a[136:139], a[88:91], a[220:223]
ds_read_b64_tr_b16 a[134:135], v22 offset:18432
v_add_u32 v22, 4294901760, v22
v_mfma_f32_16x16x32_bf16 a[220:223], a[140:143], a[92:95], a[220:223]
v_mfma_f32_16x16x32_bf16 a[228:231], a[136:139], a[96:99], a[228:231]
v_mfma_f32_16x16x32_bf16 a[228:231], a[140:143], a[100:103], a[228:231]
buffer_load_dwordx4 v18, s[12:15], s26 offen offset:2048 lds
v_mfma_f32_16x16x32_bf16 a[236:239], a[136:139], a[104:107], a[236:239]
v_mfma_f32_16x16x32_bf16 a[236:239], a[140:143], a[108:111], a[236:239]
v_mfma_f32_16x16x32_bf16 a[244:247], a[136:139], a[112:115], a[244:247]
v_mfma_f32_16x16x32_bf16 a[244:247], a[140:143], a[116:119], a[244:247]
buffer_load_dwordx4 v19, s[12:15], s26 offen offset:3072 lds
v_mfma_f32_16x16x32_bf16 a[252:255], a[136:139], a[120:123], a[252:255]
s_add_u32 s26, s26, 524288
v_mfma_f32_16x16x32_bf16 a[252:255], a[140:143], a[124:127], a[252:255]
s_waitcnt lgkmcnt(0)
M_Q:
v_mfma_f32_16x16x32_bf16 v[36:39], a[128:131], a[0:3], 0
s_add_u32 m0, s29, 114688
ds_read_b64_tr_b16 a[136:137], v23 offset:0
v_mfma_f32_16x16x32_bf16 v[36:39], a[132:135], a[4:7], v[36:39]
buffer_load_dwordx4 v16, s[12:15], s27 offen offset:0 lds
v_mfma_f32_16x16x32_bf16 v[44:47], a[128:131], a[8:11], 0
ds_read_b64_tr_b16 a[138:139], v23 offset:2048
v_mfma_f32_16x16x32_bf16 v[44:47], a[132:135], a[12:15], v[44:47]
ds_read_b128 a[64:67], v2 offset:16384
ds_read_b128 a[68:71], v3 offset:16384
v_mfma_f32_16x16x32_bf16 v[52:55], a[128:131], a[16:19], 0
ds_read_b64_tr_b16 a[140:141], v23 offset:16384
v_mfma_f32_16x16x32_bf16 v[52:55], a[132:135], a[20:23], v[52:55]
buffer_load_dwordx4 v17, s[12:15], s27 offen offset:1024 lds
v_mfma_f32_16x16x32_bf16 v[60:63], a[128:131], a[24:27], 0
ds_read_b64_tr_b16 a[142:143], v23 offset:18432
v_add_u32 v23, 4294901760, v23
v_mfma_f32_16x16x32_bf16 v[60:63], a[132:135], a[28:31], v[60:63]
buffer_store_dwordx4 v[96:99], v1, s[4:7], s31 offen sc1
v_mfma_f32_16x16x32_bf16 v[68:71], a[128:131], a[32:35], 0
s_add_u32 s31, s31, s32
ds_read_b128 a[72:75], v2 offset:18432
v_mfma_f32_16x16x32_bf16 v[68:71], a[132:135], a[36:39], v[68:71]
buffer_load_dwordx4 v18, s[12:15], s27 offen offset:2048 lds
v_mfma_f32_16x16x32_bf16 v[76:79], a[128:131], a[40:43], 0
ds_read_b128 a[76:79], v3 offset:18432
v_mfma_f32_16x16x32_bf16 v[76:79], a[132:135], a[44:47], v[76:79]
ds_read_b128 a[80:83], v2 offset:20480
v_mfma_f32_16x16x32_bf16 v[84:87], a[128:131], a[48:51], 0
ds_read_b128 a[84:87], v3 offset:20480
v_mfma_f32_16x16x32_bf16 v[84:87], a[132:135], a[52:55], v[84:87]
buffer_load_dwordx4 v19, s[12:15], s27 offen offset:3072 lds
v_mfma_f32_16x16x32_bf16 v[92:95], a[128:131], a[56:59], 0
s_add_u32 s27, s27, 524288
ds_read_b128 a[88:91], v2 offset:22528
v_mfma_f32_16x16x32_bf16 v[92:95], a[132:135], a[60:63], v[92:95]
s_waitcnt lgkmcnt(5)
buffer_store_dwordx4 v[104:107], v1, s[4:7], s31 offen sc1
v_mfma_f32_16x16x32_bf16 v[100:103], a[136:139], a[0:3], 0
s_add_u32 m0, s28, 0
ds_read_b64_tr_b16 a[128:129], v24 offset:0
v_mfma_f32_16x16x32_bf16 v[100:103], a[140:143], a[4:7], v[100:103]
s_add_u32 s31, s31, s33
buffer_load_dwordx4 v12, s[8:11], s24 offen offset:0 lds
v_mfma_f32_16x16x32_bf16 v[108:111], a[136:139], a[8:11], 0
ds_read_b64_tr_b16 a[130:131], v24 offset:2048
v_mfma_f32_16x16x32_bf16 v[108:111], a[140:143], a[12:15], v[108:111]
ds_read_b128 a[92:95], v3 offset:22528
v_mfma_f32_16x16x32_bf16 v[116:119], a[136:139], a[16:19], 0
ds_read_b64_tr_b16 a[132:133], v24 offset:16384
v_mfma_f32_16x16x32_bf16 v[116:119], a[140:143], a[20:23], v[116:119]
buffer_load_dwordx4 v13, s[8:11], s24 offen offset:1024 lds
v_mfma_f32_16x16x32_bf16 v[124:127], a[136:139], a[24:27], 0
ds_read_b64_tr_b16 a[134:135], v24 offset:18432
v_add_u32 v24, 4294901760, v24
v_mfma_f32_16x16x32_bf16 v[124:127], a[140:143], a[28:31], v[124:127]
v_mfma_f32_16x16x32_bf16 v[132:135], a[136:139], a[32:35], 0
ds_read_b128 a[96:99], v2 offset:24576
v_mfma_f32_16x16x32_bf16 v[132:135], a[140:143], a[36:39], v[132:135]
buffer_load_dwordx4 v14, s[8:11], s24 offen offset:2048 lds
v_mfma_f32_16x16x32_bf16 v[140:143], a[136:139], a[40:43], 0
ds_read_b128 a[100:103], v3 offset:24576
v_mfma_f32_16x16x32_bf16 v[140:143], a[140:143], a[44:47], v[140:143]
ds_read_b128 a[104:107], v2 offset:26624
v_mfma_f32_16x16x32_bf16 v[148:151], a[136:139], a[48:51], 0
ds_read_b128 a[108:111], v3 offset:26624
v_mfma_f32_16x16x32_bf16 v[148:151], a[140:143], a[52:55], v[148:151]
PAD_6:
s_cbranch_execz M_tret
buffer_load_dwordx4 v15, s[8:11], s24 offen offset:3072 lds
v_mfma_f32_16x16x32_bf16 v[156:159], a[136:139], a[56:59], 0
s_add_u32 s24, s24, 128
ds_read_b128 a[112:115], v2 offset:28672
v_mfma_f32_16x16x32_bf16 v[156:159], a[140:143], a[60:63], v[156:159]
s_waitcnt lgkmcnt(5)
buffer_store_dwordx4 v[112:115], v1, s[4:7], s31 offen sc1
v_mfma_f32_16x16x32_bf16 v[164:167], a[128:131], a[0:3], 0
s_add_u32 s31, s31, s32
ds_read_b64_tr_b16 a[136:137], v25 offset:0
v_mfma_f32_16x16x32_bf16 v[164:167], a[132:135], a[4:7], v[164:167]
v_mfma_f32_16x16x32_bf16 v[172:175], a[128:131], a[8:11], 0
ds_read_b64_tr_b16 a[138:139], v25 offset:2048
v_mfma_f32_16x16x32_bf16 v[172:175], a[132:135], a[12:15], v[172:175]
ds_read_b128 a[116:119], v3 offset:28672
v_mfma_f32_16x16x32_bf16 v[180:183], a[128:131], a[16:19], 0
ds_read_b64_tr_b16 a[140:141], v25 offset:16384
v_mfma_f32_16x16x32_bf16 v[180:183], a[132:135], a[20:23], v[180:183]
v_mfma_f32_16x16x32_bf16 v[188:191], a[128:131], a[24:27], 0
ds_read_b64_tr_b16 a[142:143], v25 offset:18432
v_add_u32 v25, 4294901760, v25
v_mfma_f32_16x16x32_bf16 v[188:191], a[132:135], a[28:31], v[188:191]
v_mfma_f32_16x16x32_bf16 v[196:199], a[128:131], a[32:35], 0
ds_read_b128 a[120:123], v2 offset:30720
v_mfma_f32_16x16x32_bf16 v[196:199], a[132:135], a[36:39], v[196:199]
v_mfma_f32_16x16x32_bf16 v[204:207], a[128:131], a[40:43], 0
ds_read_b128 a[124:127], v3 offset:30720
v_mfma_f32_16x16x32_bf16 v[204:207], a[132:135], a[44:47], v[204:207]
v_mfma_f32_16x16x32_bf16 v[212:215], a[128:131], a[48:51], 0
v_mfma_f32_16x16x32_bf16 v[212:215], a[132:135], a[52:55], v[212:215]
buffer_store_dwordx4 v[120:123], v1, s[4:7], s31 offen sc1
v_mfma_f32_16x16x32_bf16 v[220:223], a[128:131], a[56:59], 0
s_add_u32 s31, s31, s34
v_mfma_f32_16x16x32_bf16 v[220:223], a[132:135], a[60:63], v[220:223]
s_waitcnt vmcnt(28) lgkmcnt(0)
s_barrier
v_mfma_f32_16x16x32_bf16 v[224:227], a[136:139], a[0:3], 0
s_add_u32 m0, s29, 131072
ds_read_b64_tr_b16 a[128:129], v22 offset:0
v_mfma_f32_16x16x32_bf16 v[224:227], a[140:143], a[4:7], v[224:227]
buffer_load_dwordx4 v16, s[12:15], s26 offen offset:0 lds
v_mfma_f32_16x16x32_bf16 v[228:231], a[136:139], a[8:11], 0
ds_read_b64_tr_b16 a[130:131], v22 offset:2048
v_mfma_f32_16x16x32_bf16 v[228:231], a[140:143], a[12:15], v[228:231]
v_mfma_f32_16x16x32_bf16 v[232:235], a[136:139], a[16:19], 0
ds_read_b64_tr_b16 a[132:133], v22 offset:16384
v_mfma_f32_16x16x32_bf16 v[232:235], a[140:143], a[20:23], v[232:235]
buffer_load_dwordx4 v17, s[12:15], s26 offen offset:1024 lds
v_mfma_f32_16x16x32_bf16 v[236:239], a[136:139], a[24:27], 0
ds_read_b64_tr_b16 a[134:135], v22 offset:18432
v_add_u32 v22, 32768, v22
v_mfma_f32_16x16x32_bf16 v[236:239], a[140:143], a[28:31], v[236:239]
v_mfma_f32_16x16x32_bf16 v[240:243], a[136:139], a[32:35], 0
v_mfma_f32_16x16x32_bf16 v[240:243], a[140:143], a[36:39], v[240:243]
buffer_load_dwordx4 v18, s[12:15], s26 offen offset:2048 lds
v_mfma_f32_16x16x32_bf16 v[244:247], a[136:139], a[40:43], 0
v_mfma_f32_16x16x32_bf16 v[244:247], a[140:143], a[44:47], v[244:247]
v_mfma_f32_16x16x32_bf16 v[248:251], a[136:139], a[48:51], 0
v_mfma_f32_16x16x32_bf16 v[248:251], a[140:143], a[52:55], v[248:251]
buffer_load_dwordx4 v19, s[12:15], s26 offen offset:3072 lds
v_mfma_f32_16x16x32_bf16 v[252:255], a[136:139], a[56:59], 0
s_add_u32 s26, s26, 524288
v_mfma_f32_16x16x32_bf16 v[252:255], a[140:143], a[60:63], v[252:255]
s_waitcnt lgkmcnt(0)
v_mfma_f32_16x16x32_bf16 v[36:39], a[128:131], a[64:67], v[36:39]
s_add_u32 m0, s29, 147456
ds_read_b64_tr_b16 a[136:137], v23 offset:0
v_mfma_f32_16x16x32_bf16 v[36:39], a[132:135], a[68:71], v[36:39]
buffer_load_dwordx4 v16, s[12:15], s27 offen offset:0 lds
v_mfma_f32_16x16x32_bf16 v[44:47], a[128:131], a[72:75], v[44:47]
ds_read_b64_tr_b16 a[138:139], v23 offset:2048
v_mfma_f32_16x16x32_bf16 v[44:47], a[132:135], a[76:79], v[44:47]
ds_read_b128 a[0:3], v2 offset:32768
ds_read_b128 a[4:7], v3 offset:32768
v_mfma_f32_16x16x32_bf16 v[52:55], a[128:131], a[80:83], v[52:55]
ds_read_b64_tr_b16 a[140:141], v23 offset:16384
v_mfma_f32_16x16x32_bf16 v[52:55], a[132:135], a[84:87], v[52:55]
buffer_load_dwordx4 v17, s[12:15], s27 offen offset:1024 lds
v_mfma_f32_16x16x32_bf16 v[60:63], a[128:131], a[88:91], v[60:63]
ds_read_b64_tr_b16 a[142:143], v23 offset:18432
v_add_u32 v23, 32768, v23
v_mfma_f32_16x16x32_bf16 v[60:63], a[132:135], a[92:95], v[60:63]
buffer_store_dwordx4 v[128:131], v1, s[4:7], s31 offen sc1
v_mfma_f32_16x16x32_bf16 v[68:71], a[128:131], a[96:99], v[68:71]
s_add_u32 s31, s31, s32
ds_read_b128 a[8:11], v2 offset:34816
v_accvgpr_read_b32 v32, a192
v_mfma_f32_16x16x32_bf16 v[68:71], a[132:135], a[100:103], v[68:71]
buffer_load_dwordx4 v18, s[12:15], s27 offen offset:2048 lds
v_mfma_f32_16x16x32_bf16 v[76:79], a[128:131], a[104:107], v[76:79]
ds_read_b128 a[12:15], v3 offset:34816
v_accvgpr_read_b32 v33, a193
v_mfma_f32_16x16x32_bf16 v[76:79], a[132:135], a[108:111], v[76:79]
ds_read_b128 a[16:19], v2 offset:36864
v_accvgpr_read_b32 v34, a194
v_mfma_f32_16x16x32_bf16 v[84:87], a[128:131], a[112:115], v[84:87]
ds_read_b128 a[20:23], v3 offset:36864
v_accvgpr_read_b32 v35, a195
v_mfma_f32_16x16x32_bf16 v[84:87], a[132:135], a[116:119], v[84:87]
buffer_load_dwordx4 v19, s[12:15], s27 offen offset:3072 lds
v_mfma_f32_16x16x32_bf16 v[92:95], a[128:131], a[120:123], v[92:95]
s_add_u32 s27, s27, 524288
ds_read_b128 a[24:27], v2 offset:38912
v_accvgpr_read_b32 v96, a196
v_mfma_f32_16x16x32_bf16 v[92:95], a[132:135], a[124:127], v[92:95]
s_waitcnt lgkmcnt(5)
buffer_store_dwordx4 v[136:139], v1, s[4:7], s31 offen sc1
v_mfma_f32_16x16x32_bf16 v[100:103], a[136:139], a[64:67], v[100:103]
s_add_u32 m0, s28, 16384
ds_read_b64_tr_b16 a[128:129], v24 offset:0
v_accvgpr_read_b32 v97, a197
v_mfma_f32_16x16x32_bf16 v[100:103], a[140:143], a[68:71], v[100:103]
s_add_u32 s31, s31, s33
buffer_load_dwordx4 v12, s[8:11], s24 offen offset:0 lds
v_mfma_f32_16x16x32_bf16 v[108:111], a[136:139], a[72:75], v[108:111]
ds_read_b64_tr_b16 a[130:131], v24 offset:2048
v_accvgpr_read_b32 v98, a198
v_mfma_f32_16x16x32_bf16 v[108:111], a[140:143], a[76:79], v[108:111]
ds_read_b128 a[28:31], v3 offset:38912
v_accvgpr_read_b32 v99, a199
v_mfma_f32_16x16x32_bf16 v[116:119], a[136:139], a[80:83], v[116:119]
ds_read_b64_tr_b16 a[132:133], v24 offset:16384
v_cvt_pk_bf16_f32 v32, v32, v33
v_mfma_f32_16x16x32_bf16 v[116:119], a[140:143], a[84:87], v[116:119]
buffer_load_dwordx4 v13, s[8:11], s24 offen offset:1024 lds
v_mfma_f32_16x16x32_bf16 v[124:127], a[136:139], a[88:91], v[124:127]
ds_read_b64_tr_b16 a[134:135], v24 offset:18432
v_add_u32 v24, 32768, v24
v_mfma_f32_16x16x32_bf16 v[124:127], a[140:143], a[92:95], v[124:127]
v_cvt_pk_bf16_f32 v33, v34, v35
v_cvt_pk_bf16_f32 v34, v96, v97
v_mfma_f32_16x16x32_bf16 v[132:135], a[136:139], a[96:99], v[132:135]
ds_read_b128 a[32:35], v2 offset:40960
v_cvt_pk_bf16_f32 v35, v98, v99
v_mfma_f32_16x16x32_bf16 v[132:135], a[140:143], a[100:103], v[132:135]
buffer_load_dwordx4 v14, s[8:11], s24 offen offset:2048 lds
v_mfma_f32_16x16x32_bf16 v[140:143], a[136:139], a[104:107], v[140:143]
ds_read_b128 a[36:39], v3 offset:40960
v_accvgpr_read_b32 v40, a200
v_mfma_f32_16x16x32_bf16 v[140:143], a[140:143], a[108:111], v[140:143]
ds_read_b128 a[40:43], v2 offset:43008
v_accvgpr_read_b32 v41, a201
v_mfma_f32_16x16x32_bf16 v[148:151], a[136:139], a[112:115], v[148:151]
ds_read_b128 a[44:47], v3 offset:43008
v_accvgpr_read_b32 v42, a202
v_mfma_f32_16x16x32_bf16 v[148:151], a[140:143], a[116:119], v[148:151]
buffer_load_dwordx4 v15, s[8:11], s24 offen offset:3072 lds
v_mfma_f32_16x16x32_bf16 v[156:159], a[136:139], a[120:123], v[156:159]
s_add_u32 s24, s24, 128
ds_read_b128 a[48:51], v2 offset:45056
v_accvgpr_read_b32 v43, a203
v_mfma_f32_16x16x32_bf16 v[156:159], a[140:143], a[124:127], v[156:159]
s_waitcnt lgkmcnt(5)
buffer_store_dwordx4 v[144:147], v1, s[4:7], s31 offen sc1
v_mfma_f32_16x16x32_bf16 v[164:167], a[128:131], a[64:67], v[164:167]
s_add_u32 s31, s31, s32
ds_read_b64_tr_b16 a[136:137], v25 offset:0
v_accvgpr_read_b32 v96, a204
v_mfma_f32_16x16x32_bf16 v[164:167], a[132:135], a[68:71], v[164:167]
v_accvgpr_read_b32 v97, a205
v_accvgpr_read_b32 v98, a206
v_mfma_f32_16x16x32_bf16 v[172:175], a[128:131], a[72:75], v[172:175]
ds_read_b64_tr_b16 a[138:139], v25 offset:2048
v_accvgpr_read_b32 v99, a207
v_mfma_f32_16x16x32_bf16 v[172:175], a[132:135], a[76:79], v[172:175]
ds_read_b128 a[52:55], v3 offset:45056
v_cvt_pk_bf16_f32 v40, v40, v41
v_mfma_f32_16x16x32_bf16 v[180:183], a[128:131], a[80:83], v[180:183]
ds_read_b64_tr_b16 a[140:141], v25 offset:16384
v_cvt_pk_bf16_f32 v41, v42, v43
v_mfma_f32_16x16x32_bf16 v[180:183], a[132:135], a[84:87], v[180:183]
v_cvt_pk_bf16_f32 v42, v96, v97
v_cvt_pk_bf16_f32 v43, v98, v99
v_mfma_f32_16x16x32_bf16 v[188:191], a[128:131], a[88:91], v[188:191]
ds_read_b64_tr_b16 a[142:143], v25 offset:18432
v_add_u32 v25, 32768, v25
v_mfma_f32_16x16x32_bf16 v[188:191], a[132:135], a[92:95], v[188:191]
v_accvgpr_read_b32 v48, a208
v_accvgpr_read_b32 v49, a209
v_mfma_f32_16x16x32_bf16 v[196:199], a[128:131], a[96:99], v[196:199]
ds_read_b128 a[56:59], v2 offset:47104
v_accvgpr_read_b32 v50, a210
v_mfma_f32_16x16x32_bf16 v[196:199], a[132:135], a[100:103], v[196:199]
v_accvgpr_read_b32 v51, a211
v_accvgpr_read_b32 v96, a212
v_mfma_f32_16x16x32_bf16 v[204:207], a[128:131], a[104:107], v[204:207]
ds_read_b128 a[60:63], v3 offset:47104
v_accvgpr_read_b32 v97, a213
v_mfma_f32_16x16x32_bf16 v[204:207], a[132:135], a[108:111], v[204:207]
v_accvgpr_read_b32 v98, a214
v_accvgpr_read_b32 v99, a215
v_mfma_f32_16x16x32_bf16 v[212:215], a[128:131], a[112:115], v[212:215]
v_cvt_pk_bf16_f32 v48, v48, v49
v_cvt_pk_bf16_f32 v49, v50, v51
v_mfma_f32_16x16x32_bf16 v[212:215], a[132:135], a[116:119], v[212:215]
buffer_store_dwordx4 v[152:155], v1, s[4:7], s31 offen sc1
v_mfma_f32_16x16x32_bf16 v[220:223], a[128:131], a[120:123], v[220:223]
s_add_u32 s31, s31, s36
v_cvt_pk_bf16_f32 v50, v96, v97
v_cvt_pk_bf16_f32 v51, v98, v99
v_mfma_f32_16x16x32_bf16 v[220:223], a[132:135], a[124:127], v[220:223]
s_waitcnt vmcnt(23) lgkmcnt(0)
s_barrier
v_accvgpr_read_b32 v56, a216
v_mfma_f32_16x16x32_bf16 v[224:227], a[136:139], a[64:67], v[224:227]
s_add_u32 m0, s29, 65536
ds_read_b64_tr_b16 a[128:129], v22 offset:0
v_accvgpr_read_b32 v57, a217
v_mfma_f32_16x16x32_bf16 v[224:227], a[140:143], a[68:71], v[224:227]
buffer_load_dwordx4 v16, s[12:15], s26 offen offset:0 lds
v_mfma_f32_16x16x32_bf16 v[228:231], a[136:139], a[72:75], v[228:231]
ds_read_b64_tr_b16 a[130:131], v22 offset:2048
v_accvgpr_read_b32 v58, a218
v_mfma_f32_16x16x32_bf16 v[228:231], a[140:143], a[76:79], v[228:231]
v_accvgpr_read_b32 v59, a219
v_accvgpr_read_b32 v96, a220
v_mfma_f32_16x16x32_bf16 v[232:235], a[136:139], a[80:83], v[232:235]
ds_read_b64_tr_b16 a[132:133], v22 offset:16384
v_accvgpr_read_b32 v97, a221
v_mfma_f32_16x16x32_bf16 v[232:235], a[140:143], a[84:87], v[232:235]
buffer_load_dwordx4 v17, s[12:15], s26 offen offset:1024 lds
v_mfma_f32_16x16x32_bf16 v[236:239], a[136:139], a[88:91], v[236:239]
ds_read_b64_tr_b16 a[134:135], v22 offset:18432
v_add_u32 v22, 32768, v22
v_mfma_f32_16x16x32_bf16 v[236:239], a[140:143], a[92:95], v[236:239]
v_accvgpr_read_b32 v98, a222
v_accvgpr_read_b32 v99, a223
v_mfma_f32_16x16x32_bf16 v[240:243], a[136:139], a[96:99], v[240:243]
v_cvt_pk_bf16_f32 v56, v56, v57
v_cvt_pk_bf16_f32 v57, v58, v59
v_mfma_f32_16x16x32_bf16 v[240:243], a[140:143], a[100:103], v[240:243]
buffer_load_dwordx4 v18, s[12:15], s26 offen offset:2048 lds
v_mfma_f32_16x16x32_bf16 v[244:247], a[136:139], a[104:107], v[244:247]
v_cvt_pk_bf16_f32 v58, v96, v97
v_cvt_pk_bf16_f32 v59, v98, v99
v_mfma_f32_16x16x32_bf16 v[244:247], a[140:143], a[108:111], v[244:247]
v_accvgpr_read_b32 v64, a224
v_accvgpr_read_b32 v65, a225
v_mfma_f32_16x16x32_bf16 v[248:251], a[136:139], a[112:115], v[248:251]
v_accvgpr_read_b32 v66, a226
v_accvgpr_read_b32 v67, a227
v_mfma_f32_16x16x32_bf16 v[248:251], a[140:143], a[116:119], v[248:251]
buffer_load_dwordx4 v19, s[12:15], s26 offen offset:3072 lds
v_mfma_f32_16x16x32_bf16 v[252:255], a[136:139], a[120:123], v[252:255]
s_add_u32 s26, s26, 524288
v_accvgpr_read_b32 v96, a228
v_accvgpr_read_b32 v97, a229
v_mfma_f32_16x16x32_bf16 v[252:255], a[140:143], a[124:127], v[252:255]
s_waitcnt lgkmcnt(0)
v_accvgpr_read_b32 v98, a230
v_accvgpr_read_b32 v99, a231
v_mfma_f32_16x16x32_bf16 v[36:39], a[128:131], a[0:3], v[36:39]
s_add_u32 m0, s29, 81920
ds_read_b64_tr_b16 a[136:137], v23 offset:0
v_cvt_pk_bf16_f32 v64, v64, v65
v_mfma_f32_16x16x32_bf16 v[36:39], a[132:135], a[4:7], v[36:39]
buffer_load_dwordx4 v16, s[12:15], s27 offen offset:0 lds
v_mfma_f32_16x16x32_bf16 v[44:47], a[128:131], a[8:11], v[44:47]
ds_read_b64_tr_b16 a[138:139], v23 offset:2048
v_cvt_pk_bf16_f32 v65, v66, v67
v_mfma_f32_16x16x32_bf16 v[44:47], a[132:135], a[12:15], v[44:47]
ds_read_b128 a[64:67], v2 offset:49152
ds_read_b128 a[68:71], v3 offset:49152
v_mfma_f32_16x16x32_bf16 v[52:55], a[128:131], a[16:19], v[52:55]
ds_read_b64_tr_b16 a[140:141], v23 offset:16384
v_cvt_pk_bf16_f32 v66, v96, v97
v_mfma_f32_16x16x32_bf16 v[52:55], a[132:135], a[20:23], v[52:55]
buffer_load_dwordx4 v17, s[12:15], s27 offen offset:1024 lds
v_mfma_f32_16x16x32_bf16 v[60:63], a[128:131], a[24:27], v[60:63]
ds_read_b64_tr_b16 a[142:143], v23 offset:18432
v_add_u32 v23, 32768, v23
v_mfma_f32_16x16x32_bf16 v[60:63], a[132:135], a[28:31], v[60:63]
buffer_store_dwordx4 v[160:163], v1, s[4:7], s31 offen sc1
v_mfma_f32_16x16x32_bf16 v[68:71], a[128:131], a[32:35], v[68:71]
s_add_u32 s31, s31, s32
ds_read_b128 a[72:75], v2 offset:51200
v_cvt_pk_bf16_f32 v67, v98, v99
v_mfma_f32_16x16x32_bf16 v[68:71], a[132:135], a[36:39], v[68:71]
buffer_load_dwordx4 v18, s[12:15], s27 offen offset:2048 lds
v_mfma_f32_16x16x32_bf16 v[76:79], a[128:131], a[40:43], v[76:79]
ds_read_b128 a[76:79], v3 offset:51200
v_accvgpr_read_b32 v72, a232
v_mfma_f32_16x16x32_bf16 v[76:79], a[132:135], a[44:47], v[76:79]
ds_read_b128 a[80:83], v2 offset:53248
v_accvgpr_read_b32 v73, a233
v_mfma_f32_16x16x32_bf16 v[84:87], a[128:131], a[48:51], v[84:87]
ds_read_b128 a[84:87], v3 offset:53248
v_accvgpr_read_b32 v74, a234
v_mfma_f32_16x16x32_bf16 v[84:87], a[132:135], a[52:55], v[84:87]
buffer_load_dwordx4 v19, s[12:15], s27 offen offset:3072 lds
v_mfma_f32_16x16x32_bf16 v[92:95], a[128:131], a[56:59], v[92:95]
s_add_u32 s27, s27, 524288
ds_read_b128 a[88:91], v2 offset:55296
v_accvgpr_read_b32 v75, a235
v_mfma_f32_16x16x32_bf16 v[92:95], a[132:135], a[60:63], v[92:95]
s_waitcnt lgkmcnt(5)
buffer_store_dwordx4 v[168:171], v1, s[4:7], s31 offen sc1
v_mfma_f32_16x16x32_bf16 v[100:103], a[136:139], a[0:3], v[100:103]
s_add_u32 m0, s28, 32768
ds_read_b64_tr_b16 a[128:129], v24 offset:0
v_accvgpr_read_b32 v96, a236
v_mfma_f32_16x16x32_bf16 v[100:103], a[140:143], a[4:7], v[100:103]
s_add_u32 s31, s31, s33
buffer_load_dwordx4 v12, s[8:11], s24 offen offset:0 lds
v_mfma_f32_16x16x32_bf16 v[108:111], a[136:139], a[8:11], v[108:111]
ds_read_b64_tr_b16 a[130:131], v24 offset:2048
v_accvgpr_read_b32 v97, a237
v_mfma_f32_16x16x32_bf16 v[108:111], a[140:143], a[12:15], v[108:111]
ds_read_b128 a[92:95], v3 offset:55296
v_accvgpr_read_b32 v98, a238
v_mfma_f32_16x16x32_bf16 v[116:119], a[136:139], a[16:19], v[116:119]
ds_read_b64_tr_b16 a[132:133], v24 offset:16384
v_accvgpr_read_b32 v99, a239
v_mfma_f32_16x16x32_bf16 v[116:119], a[140:143], a[20:23], v[116:119]
buffer_load_dwordx4 v13, s[8:11], s24 offen offset:1024 lds
v_mfma_f32_16x16x32_bf16 v[124:127], a[136:139], a[24:27], v[124:127]
ds_read_b64_tr_b16 a[134:135], v24 offset:18432
v_add_u32 v24, 32768, v24
v_mfma_f32_16x16x32_bf16 v[124:127], a[140:143], a[28:31], v[124:127]
v_cvt_pk_bf16_f32 v72, v72, v73
v_cvt_pk_bf16_f32 v73, v74, v75
v_mfma_f32_16x16x32_bf16 v[132:135], a[136:139], a[32:35], v[132:135]
ds_read_b128 a[96:99], v2 offset:57344
v_cvt_pk_bf16_f32 v74, v96, v97
v_mfma_f32_16x16x32_bf16 v[132:135], a[140:143], a[36:39], v[132:135]
buffer_load_dwordx4 v14, s[8:11], s24 offen offset:2048 lds
v_mfma_f32_16x16x32_bf16 v[140:143], a[136:139], a[40:43], v[140:143]
ds_read_b128 a[100:103], v3 offset:57344
v_cvt_pk_bf16_f32 v75, v98, v99
v_mfma_f32_16x16x32_bf16 v[140:143], a[140:143], a[44:47], v[140:143]
ds_read_b128 a[104:107], v2 offset:59392
v_accvgpr_read_b32 v80, a240
v_mfma_f32_16x16x32_bf16 v[148:151], a[136:139], a[48:51], v[148:151]
ds_read_b128 a[108:111], v3 offset:59392
v_accvgpr_read_b32 v81, a241
v_mfma_f32_16x16x32_bf16 v[148:151], a[140:143], a[52:55], v[148:151]
buffer_load_dwordx4 v15, s[8:11], s24 offen offset:3072 lds
v_mfma_f32_16x16x32_bf16 v[156:159], a[136:139], a[56:59], v[156:159]
s_add_u32 s24, s24, 128
ds_read_b128 a[112:115], v2 offset:61440
v_accvgpr_read_b32 v82, a242
v_mfma_f32_16x16x32_bf16 v[156:159], a[140:143], a[60:63], v[156:159]
s_waitcnt lgkmcnt(5)
buffer_store_dwordx4 v[176:179], v1, s[4:7], s31 offen sc1
v_mfma_f32_16x16x32_bf16 v[164:167], a[128:131], a[0:3], v[164:167]
s_add_u32 s31, s31, s32
ds_read_b64_tr_b16 a[136:137], v25 offset:0
v_accvgpr_read_b32 v83, a243
v_mfma_f32_16x16x32_bf16 v[164:167], a[132:135], a[4:7], v[164:167]
v_accvgpr_read_b32 v96, a244
v_accvgpr_read_b32 v97, a245
v_mfma_f32_16x16x32_bf16 v[172:175], a[128:131], a[8:11], v[172:175]
ds_read_b64_tr_b16 a[138:139], v25 offset:2048
v_accvgpr_read_b32 v98, a246
v_mfma_f32_16x16x32_bf16 v[172:175], a[132:135], a[12:15], v[172:175]
ds_read_b128 a[116:119], v3 offset:61440
v_accvgpr_read_b32 v99, a247
v_mfma_f32_16x16x32_bf16 v[180:183], a[128:131], a[16:19], v[180:183]
ds_read_b64_tr_b16 a[140:141], v25 offset:16384
v_cvt_pk_bf16_f32 v80, v80, v81
v_mfma_f32_16x16x32_bf16 v[180:183], a[132:135], a[20:23], v[180:183]
buffer_store_dwordx4 v[184:187], v1, s[4:7], s31 offen sc1
v_mfma_f32_16x16x32_bf16 v[188:191], a[128:131], a[24:27], v[188:191]
s_add_u32 s31, s31, s34
ds_read_b64_tr_b16 a[142:143], v25 offset:18432
v_add_u32 v25, 32768, v25
v_mfma_f32_16x16x32_bf16 v[188:191], a[132:135], a[28:31], v[188:191]
v_cvt_pk_bf16_f32 v81, v82, v83
v_cvt_pk_bf16_f32 v82, v96, v97
v_mfma_f32_16x16x32_bf16 v[196:199], a[128:131], a[32:35], v[196:199]
ds_read_b128 a[120:123], v2 offset:63488
v_cvt_pk_bf16_f32 v83, v98, v99
v_mfma_f32_16x16x32_bf16 v[196:199], a[132:135], a[36:39], v[196:199]
v_accvgpr_read_b32 v88, a248
v_accvgpr_read_b32 v89, a249
v_mfma_f32_16x16x32_bf16 v[204:207], a[128:131], a[40:43], v[204:207]
ds_read_b128 a[124:127], v3 offset:63488
v_accvgpr_read_b32 v90, a250
v_mfma_f32_16x16x32_bf16 v[204:207], a[132:135], a[44:47], v[204:207]
v_accvgpr_read_b32 v91, a251
v_accvgpr_read_b32 v96, a252
v_mfma_f32_16x16x32_bf16 v[212:215], a[128:131], a[48:51], v[212:215]
v_accvgpr_read_b32 v97, a253
v_accvgpr_read_b32 v98, a254
v_mfma_f32_16x16x32_bf16 v[212:215], a[132:135], a[52:55], v[212:215]
v_accvgpr_read_b32 v99, a255
v_cvt_pk_bf16_f32 v88, v88, v89
v_mfma_f32_16x16x32_bf16 v[220:223], a[128:131], a[56:59], v[220:223]
v_cvt_pk_bf16_f32 v89, v90, v91
v_cvt_pk_bf16_f32 v90, v96, v97
v_mfma_f32_16x16x32_bf16 v[220:223], a[132:135], a[60:63], v[220:223]
s_waitcnt vmcnt(23) lgkmcnt(0)
s_barrier
v_cvt_pk_bf16_f32 v91, v98, v99
v_mfma_f32_16x16x32_bf16 v[224:227], a[136:139], a[0:3], v[224:227]
s_add_u32 m0, s29, 98304
ds_read_b64_tr_b16 a[128:129], v22 offset:0
v_mfma_f32_16x16x32_bf16 v[224:227], a[140:143], a[4:7], v[224:227]
buffer_load_dwordx4 v16, s[12:15], s26 offen offset:0 lds
v_mfma_f32_16x16x32_bf16 v[228:231], a[136:139], a[8:11], v[228:231]
ds_read_b64_tr_b16 a[130:131], v22 offset:2048
v_mfma_f32_16x16x32_bf16 v[228:231], a[140:143], a[12:15], v[228:231]
buffer_store_dwordx4 v[192:195], v1, s[4:7], s31 offen sc1
v_mfma_f32_16x16x32_bf16 v[232:235], a[136:139], a[16:19], v[232:235]
s_add_u32 s31, s31, s32
ds_read_b64_tr_b16 a[132:133], v22 offset:16384
v_mfma_f32_16x16x32_bf16 v[232:235], a[140:143], a[20:23], v[232:235]
buffer_load_dwordx4 v17, s[12:15], s26 offen offset:1024 lds
v_mfma_f32_16x16x32_bf16 v[236:239], a[136:139], a[24:27], v[236:239]
ds_read_b64_tr_b16 a[134:135], v22 offset:18432
v_add_u32 v22, 4294901760, v22
v_mfma_f32_16x16x32_bf16 v[236:239], a[140:143], a[28:31], v[236:239]
v_mfma_f32_16x16x32_bf16 v[240:243], a[136:139], a[32:35], v[240:243]
v_mfma_f32_16x16x32_bf16 v[240:243], a[140:143], a[36:39], v[240:243]
buffer_load_dwordx4 v18, s[12:15], s26 offen offset:2048 lds
v_mfma_f32_16x16x32_bf16 v[244:247], a[136:139], a[40:43], v[244:247]
v_mfma_f32_16x16x32_bf16 v[244:247], a[140:143], a[44:47], v[244:247]
v_mfma_f32_16x16x32_bf16 v[248:251], a[136:139], a[48:51], v[248:251]
v_mfma_f32_16x16x32_bf16 v[248:251], a[140:143], a[52:55], v[248:251]
buffer_load_dwordx4 v19, s[12:15], s26 offen offset:3072 lds
v_mfma_f32_16x16x32_bf16 v[252:255], a[136:139], a[56:59], v[252:255]
s_add_u32 s26, s26, 524288
v_mfma_f32_16x16x32_bf16 v[252:255], a[140:143], a[60:63], v[252:255]
s_waitcnt lgkmcnt(0)
v_mfma_f32_16x16x32_bf16 v[36:39], a[128:131], a[64:67], v[36:39]
s_add_u32 m0, s29, 114688
ds_read_b64_tr_b16 a[136:137], v23 offset:0
v_mfma_f32_16x16x32_bf16 v[36:39], a[132:135], a[68:71], v[36:39]
buffer_load_dwordx4 v16, s[12:15], s27 offen offset:0 lds
v_mfma_f32_16x16x32_bf16 v[44:47], a[128:131], a[72:75], v[44:47]
ds_read_b64_tr_b16 a[138:139], v23 offset:2048
v_mfma_f32_16x16x32_bf16 v[44:47], a[132:135], a[76:79], v[44:47]
ds_read_b128 a[0:3], v2 offset:0
ds_read_b128 a[4:7], v3 offset:0
v_mfma_f32_16x16x32_bf16 v[52:55], a[128:131], a[80:83], v[52:55]
ds_read_b64_tr_b16 a[140:141], v23 offset:16384
v_mfma_f32_16x16x32_bf16 v[52:55], a[132:135], a[84:87], v[52:55]
buffer_load_dwordx4 v17, s[12:15], s27 offen offset:1024 lds
v_mfma_f32_16x16x32_bf16 v[60:63], a[128:131], a[88:91], v[60:63]
ds_read_b64_tr_b16 a[142:143], v23 offset:18432
v_add_u32 v23, 4294901760, v23
v_mfma_f32_16x16x32_bf16 v[60:63], a[132:135], a[92:95], v[60:63]
buffer_store_dwordx4 v[200:203], v1, s[4:7], s31 offen sc1
v_mfma_f32_16x16x32_bf16 v[68:71], a[128:131], a[96:99], v[68:71]
s_add_u32 s31, s31, s33
ds_read_b128 a[8:11], v2 offset:2048
v_mfma_f32_16x16x32_bf16 v[68:71], a[132:135], a[100:103], v[68:71]
buffer_load_dwordx4 v18, s[12:15], s27 offen offset:2048 lds
v_mfma_f32_16x16x32_bf16 v[76:79], a[128:131], a[104:107], v[76:79]
ds_read_b128 a[12:15], v3 offset:2048
v_mfma_f32_16x16x32_bf16 v[76:79], a[132:135], a[108:111], v[76:79]
ds_read_b128 a[16:19], v2 offset:4096
v_mfma_f32_16x16x32_bf16 v[84:87], a[128:131], a[112:115], v[84:87]
ds_read_b128 a[20:23], v3 offset:4096
v_mfma_f32_16x16x32_bf16 v[84:87], a[132:135], a[116:119], v[84:87]
buffer_load_dwordx4 v19, s[12:15], s27 offen offset:3072 lds
v_mfma_f32_16x16x32_bf16 v[92:95], a[128:131], a[120:123], v[92:95]
s_add_u32 s27, s27, 524288
ds_read_b128 a[24:27], v2 offset:6144
v_mfma_f32_16x16x32_bf16 v[92:95], a[132:135], a[124:127], v[92:95]
s_waitcnt lgkmcnt(5)
buffer_store_dwordx4 v[208:211], v1, s[4:7], s31 offen sc1
v_mfma_f32_16x16x32_bf16 v[100:103], a[136:139], a[64:67], v[100:103]
s_add_u32 s31, s31, s32
ds_read_b64_tr_b16 a[128:129], v24 offset:0
v_mfma_f32_16x16x32_bf16 v[100:103], a[140:143], a[68:71], v[100:103]
v_mfma_f32_16x16x32_bf16 v[108:111], a[136:139], a[72:75], v[108:111]
ds_read_b64_tr_b16 a[130:131], v24 offset:2048
v_mfma_f32_16x16x32_bf16 v[108:111], a[140:143], a[76:79], v[108:111]
ds_read_b128 a[28:31], v3 offset:6144
v_mfma_f32_16x16x32_bf16 v[116:119], a[136:139], a[80:83], v[116:119]
ds_read_b64_tr_b16 a[132:133], v24 offset:16384
v_mfma_f32_16x16x32_bf16 v[116:119], a[140:143], a[84:87], v[116:119]
v_mfma_f32_16x16x32_bf16 v[124:127], a[136:139], a[88:91], v[124:127]
ds_read_b64_tr_b16 a[134:135], v24 offset:18432
v_add_u32 v24, 4294901760, v24
v_mfma_f32_16x16x32_bf16 v[124:127], a[140:143], a[92:95], v[124:127]
v_mfma_f32_16x16x32_bf16 v[132:135], a[136:139], a[96:99], v[132:135]
ds_read_b128 a[32:35], v2 offset:8192
v_mfma_f32_16x16x32_bf16 v[132:135], a[140:143], a[100:103], v[132:135]
buffer_store_dwordx4 v[216:219], v1, s[4:7], s31 offen sc1
v_mfma_f32_16x16x32_bf16 v[140:143], a[136:139], a[104:107], v[140:143]
s_add_u32 s31, s31, s35
ds_read_b128 a[36:39], v3 offset:8192
v_mfma_f32_16x16x32_bf16 v[140:143], a[140:143], a[108:111], v[140:143]
ds_read_b128 a[40:43], v2 offset:10240
v_mfma_f32_16x16x32_bf16 v[148:151], a[136:139], a[112:115], v[148:151]
ds_read_b128 a[44:47], v3 offset:10240
v_mfma_f32_16x16x32_bf16 v[148:151], a[140:143], a[116:119], v[148:151]
v_mfma_f32_16x16x32_bf16 v[156:159], a[136:139], a[120:123], v[156:159]
ds_read_b128 a[48:51], v2 offset:12288
v_mfma_f32_16x16x32_bf16 v[156:159], a[140:143], a[124:127], v[156:159]
s_waitcnt lgkmcnt(5)
v_mfma_f32_16x16x32_bf16 v[164:167], a[128:131], a[64:67], v[164:167]
ds_read_b64_tr_b16 a[136:137], v25 offset:0
v_mfma_f32_16x16x32_bf16 v[164:167], a[132:135], a[68:71], v[164:167]
v_mfma_f32_16x16x32_bf16 v[172:175], a[128:131], a[72:75], v[172:175]
ds_read_b64_tr_b16 a[138:139], v25 offset:2048
v_mfma_f32_16x16x32_bf16 v[172:175], a[132:135], a[76:79], v[172:175]
ds_read_b128 a[52:55], v3 offset:12288
v_mfma_f32_16x16x32_bf16 v[180:183], a[128:131], a[80:83], v[180:183]
ds_read_b64_tr_b16 a[140:141], v25 offset:16384
v_mfma_f32_16x16x32_bf16 v[180:183], a[132:135], a[84:87], v[180:183]
buffer_store_dwordx4 v[32:35], v1, s[4:7], s31 offen sc1
v_mfma_f32_16x16x32_bf16 v[188:191], a[128:131], a[88:91], v[188:191]
s_add_u32 s31, s31, s32
ds_read_b64_tr_b16 a[142:143], v25 offset:18432
v_add_u32 v25, 4294901760, v25
v_mfma_f32_16x16x32_bf16 v[188:191], a[132:135], a[92:95], v[188:191]
v_mfma_f32_16x16x32_bf16 v[196:199], a[128:131], a[96:99], v[196:199]
ds_read_b128 a[56:59], v2 offset:14336
v_mfma_f32_16x16x32_bf16 v[196:199], a[132:135], a[100:103], v[196:199]
v_mfma_f32_16x16x32_bf16 v[204:207], a[128:131], a[104:107], v[204:207]
ds_read_b128 a[60:63], v3 offset:14336
v_mfma_f32_16x16x32_bf16 v[204:207], a[132:135], a[108:111], v[204:207]
v_mfma_f32_16x16x32_bf16 v[212:215], a[128:131], a[112:115], v[212:215]
v_mfma_f32_16x16x32_bf16 v[212:215], a[132:135], a[116:119], v[212:215]
v_mfma_f32_16x16x32_bf16 v[220:223], a[128:131], a[120:123], v[220:223]
v_mfma_f32_16x16x32_bf16 v[220:223], a[132:135], a[124:127], v[220:223]
s_waitcnt vmcnt(20) lgkmcnt(0)
s_barrier
v_mfma_f32_16x16x32_bf16 v[224:227], a[136:139], a[64:67], v[224:227]
s_add_u32 m0, s29, 131072
ds_read_b64_tr_b16 a[128:129], v22 offset:0
v_mfma_f32_16x16x32_bf16 v[224:227], a[140:143], a[68:71], v[224:227]
buffer_load_dwordx4 v16, s[12:15], s26 offen offset:0 lds
v_mfma_f32_16x16x32_bf16 v[228:231], a[136:139], a[72:75], v[228:231]
ds_read_b64_tr_b16 a[130:131], v22 offset:2048
v_mfma_f32_16x16x32_bf16 v[228:231], a[140:143], a[76:79], v[228:231]
PAD_7:
s_cbranch_execz M_tret
buffer_store_dwordx4 v[40:43], v1, s[4:7], s31 offen sc1
v_mfma_f32_16x16x32_bf16 v[232:235], a[136:139], a[80:83], v[232:235]
s_add_u32 s31, s31, s33
ds_read_b64_tr_b16 a[132:133], v22 offset:16384
v_mfma_f32_16x16x32_bf16 v[232:235], a[140:143], a[84:87], v[232:235]
buffer_load_dwordx4 v17, s[12:15], s26 offen offset:1024 lds
v_mfma_f32_16x16x32_bf16 v[236:239], a[136:139], a[88:91], v[236:239]
ds_read_b64_tr_b16 a[134:135], v22 offset:18432
v_add_u32 v22, 32768, v22
v_mfma_f32_16x16x32_bf16 v[236:239], a[140:143], a[92:95], v[236:239]
v_mfma_f32_16x16x32_bf16 v[240:243], a[136:139], a[96:99], v[240:243]
v_mfma_f32_16x16x32_bf16 v[240:243], a[140:143], a[100:103], v[240:243]
buffer_load_dwordx4 v18, s[12:15], s26 offen offset:2048 lds
v_mfma_f32_16x16x32_bf16 v[244:247], a[136:139], a[104:107], v[244:247]
v_mfma_f32_16x16x32_bf16 v[244:247], a[140:143], a[108:111], v[244:247]
v_mfma_f32_16x16x32_bf16 v[248:251], a[136:139], a[112:115], v[248:251]
v_mfma_f32_16x16x32_bf16 v[248:251], a[140:143], a[116:119], v[248:251]
buffer_load_dwordx4 v19, s[12:15], s26 offen offset:3072 lds
v_mfma_f32_16x16x32_bf16 v[252:255], a[136:139], a[120:123], v[252:255]
s_add_u32 s26, s26, 524288
v_mfma_f32_16x16x32_bf16 v[252:255], a[140:143], a[124:127], v[252:255]
s_waitcnt lgkmcnt(0)
v_mfma_f32_16x16x32_bf16 v[36:39], a[128:131], a[0:3], v[36:39]
s_add_u32 m0, s29, 147456
ds_read_b64_tr_b16 a[136:137], v23 offset:0
v_mfma_f32_16x16x32_bf16 v[36:39], a[132:135], a[4:7], v[36:39]
buffer_load_dwordx4 v16, s[12:15], s27 offen offset:0 lds
v_mfma_f32_16x16x32_bf16 v[44:47], a[128:131], a[8:11], v[44:47]
s_lshl_b32 s22, s20, 7
ds_read_b64_tr_b16 a[138:139], v23 offset:2048
v_bfe_u32 v20, v1, 4, 3
v_mfma_f32_16x16x32_bf16 v[44:47], a[132:135], a[12:15], v[44:47]
s_add_u32 s70, s22, 94371840
ds_read_b128 a[64:67], v2 offset:16384
ds_read_b128 a[68:71], v3 offset:16384
v_mfma_f32_16x16x32_bf16 v[52:55], a[128:131], a[16:19], v[52:55]
s_lshr_b32 s22, s2, 4
ds_read_b64_tr_b16 a[140:141], v23 offset:16384
v_lshlrev_b32 v20, 3, v20
v_mfma_f32_16x16x32_bf16 v[52:55], a[132:135], a[20:23], v[52:55]
s_lshl_b32 s22, s22, 2
buffer_load_dwordx4 v17, s[12:15], s27 offen offset:1024 lds
v_mfma_f32_16x16x32_bf16 v[60:63], a[128:131], a[24:27], v[60:63]
s_add_u32 s66, s70, s22
ds_read_b64_tr_b16 a[142:143], v23 offset:18432
v_add_u32 v23, 32768, v23
v_mfma_f32_16x16x32_bf16 v[60:63], a[132:135], a[28:31], v[60:63]
s_and_b32 s22, s2, 16
buffer_store_dwordx4 v[48:51], v1, s[4:7], s31 offen sc1
v_mfma_f32_16x16x32_bf16 v[68:71], a[128:131], a[32:35], v[68:71]
s_add_u32 s31, s31, s32
ds_read_b128 a[72:75], v2 offset:18432
v_add_u32 v15, 2052, v20
v_mfma_f32_16x16x32_bf16 v[68:71], a[132:135], a[36:39], v[68:71]
s_lshl_b32 s22, s22, 7
buffer_load_dwordx4 v18, s[12:15], s27 offen offset:2048 lds
v_mfma_f32_16x16x32_bf16 v[76:79], a[128:131], a[40:43], v[76:79]
s_add_u32 s66, s66, s22
ds_read_b128 a[76:79], v3 offset:18432
v_mfma_f32_16x16x32_bf16 v[76:79], a[132:135], a[44:47], v[76:79]
s_lshl_b32 s67, s20, 20
ds_read_b128 a[80:83], v2 offset:20480
v_mfma_f32_16x16x32_bf16 v[84:87], a[128:131], a[48:51], v[84:87]
s_lshl_b32 s22, s37, 16
ds_read_b128 a[84:87], v3 offset:20480
v_mfma_f32_16x16x32_bf16 v[84:87], a[132:135], a[52:55], v[84:87]
s_add_u32 s67, s67, s22
buffer_load_dwordx4 v19, s[12:15], s27 offen offset:3072 lds
v_mfma_f32_16x16x32_bf16 v[92:95], a[128:131], a[56:59], v[92:95]
s_waitcnt lgkmcnt(5)
s_add_u32 s27, s27, 524288
ds_read_b128 a[88:91], v2 offset:22528
v_mfma_f32_16x16x32_bf16 v[92:95], a[132:135], a[60:63], v[92:95]
s_lshl_b32 s22, s3, 11
buffer_store_dwordx4 v[56:59], v1, s[4:7], s31 offen sc1
v_mfma_f32_16x16x32_bf16 v[100:103], a[136:139], a[0:3], v[100:103]
s_waitcnt lgkmcnt(5)
s_add_u32 s31, s31, s34
ds_read_b64_tr_b16 a[128:129], v24 offset:0
v_mfma_f32_16x16x32_bf16 v[100:103], a[140:143], a[4:7], v[100:103]
s_add_u32 s67, s67, s22
v_mfma_f32_16x16x32_bf16 v[108:111], a[136:139], a[8:11], v[108:111]
s_add_u32 s67, s67, 33554432
ds_read_b64_tr_b16 a[130:131], v24 offset:2048
v_mfma_f32_16x16x32_bf16 v[108:111], a[140:143], a[12:15], v[108:111]
s_mov_b32 s68, 1035512379
ds_read_b128 a[92:95], v3 offset:22528
v_mfma_f32_16x16x32_bf16 v[116:119], a[136:139], a[16:19], v[116:119]
s_mov_b32 s69, 1035512379
ds_read_b64_tr_b16 a[132:133], v24 offset:16384
v_mfma_f32_16x16x32_bf16 v[116:119], a[140:143], a[20:23], v[116:119]
buffer_store_dwordx4 v[64:67], v1, s[4:7], s31 offen sc1
v_mfma_f32_16x16x32_bf16 v[124:127], a[136:139], a[24:27], v[124:127]
s_add_u32 s31, s31, s32
ds_read_b64_tr_b16 a[134:135], v24 offset:18432
v_add_u32 v24, 32768, v24
v_mfma_f32_16x16x32_bf16 v[124:127], a[140:143], a[28:31], v[124:127]
v_mfma_f32_16x16x32_bf16 v[132:135], a[136:139], a[32:35], v[132:135]
ds_read_b128 a[96:99], v2 offset:24576
v_mfma_f32_16x16x32_bf16 v[132:135], a[140:143], a[36:39], v[132:135]
v_mfma_f32_16x16x32_bf16 v[140:143], a[136:139], a[40:43], v[140:143]
ds_read_b128 a[100:103], v3 offset:24576
v_mfma_f32_16x16x32_bf16 v[140:143], a[140:143], a[44:47], v[140:143]
ds_read_b128 a[104:107], v2 offset:26624
v_mfma_f32_16x16x32_bf16 v[148:151], a[136:139], a[48:51], v[148:151]
ds_read_b128 a[108:111], v3 offset:26624
v_mfma_f32_16x16x32_bf16 v[148:151], a[140:143], a[52:55], v[148:151]
v_mfma_f32_16x16x32_bf16 v[156:159], a[136:139], a[56:59], v[156:159]
ds_read_b128 a[112:115], v2 offset:28672
v_mfma_f32_16x16x32_bf16 v[156:159], a[140:143], a[60:63], v[156:159]
s_waitcnt lgkmcnt(5)
buffer_store_dwordx4 v[72:75], v1, s[4:7], s31 offen sc1
v_mfma_f32_16x16x32_bf16 v[164:167], a[128:131], a[0:3], v[164:167]
s_add_u32 s31, s31, s33
ds_read_b64_tr_b16 a[136:137], v25 offset:0
v_mfma_f32_16x16x32_bf16 v[164:167], a[132:135], a[4:7], v[164:167]
v_mfma_f32_16x16x32_bf16 v[172:175], a[128:131], a[8:11], v[172:175]
ds_read_b64_tr_b16 a[138:139], v25 offset:2048
v_mfma_f32_16x16x32_bf16 v[172:175], a[132:135], a[12:15], v[172:175]
ds_read_b128 a[116:119], v3 offset:28672
v_mfma_f32_16x16x32_bf16 v[180:183], a[128:131], a[16:19], v[180:183]
ds_read_b64_tr_b16 a[140:141], v25 offset:16384
v_mfma_f32_16x16x32_bf16 v[180:183], a[132:135], a[20:23], v[180:183]
v_mfma_f32_16x16x32_bf16 v[188:191], a[128:131], a[24:27], v[188:191]
ds_read_b64_tr_b16 a[142:143], v25 offset:18432
v_add_u32 v25, 32768, v25
v_mfma_f32_16x16x32_bf16 v[188:191], a[132:135], a[28:31], v[188:191]
v_mfma_f32_16x16x32_bf16 v[196:199], a[128:131], a[32:35], v[196:199]
ds_read_b128 a[120:123], v2 offset:30720
v_mfma_f32_16x16x32_bf16 v[196:199], a[132:135], a[36:39], v[196:199]
buffer_store_dwordx4 v[80:83], v1, s[4:7], s31 offen sc1
v_mfma_f32_16x16x32_bf16 v[204:207], a[128:131], a[40:43], v[204:207]
s_add_u32 s31, s31, s32
ds_read_b128 a[124:127], v3 offset:30720
v_mfma_f32_16x16x32_bf16 v[204:207], a[132:135], a[44:47], v[204:207]
v_mfma_f32_16x16x32_bf16 v[212:215], a[128:131], a[48:51], v[212:215]
v_mfma_f32_16x16x32_bf16 v[212:215], a[132:135], a[52:55], v[212:215]
v_mfma_f32_16x16x32_bf16 v[220:223], a[128:131], a[56:59], v[220:223]
v_mfma_f32_16x16x32_bf16 v[220:223], a[132:135], a[60:63], v[220:223]
s_waitcnt vmcnt(17) lgkmcnt(0)
s_barrier
v_mfma_f32_16x16x32_bf16 v[224:227], a[136:139], a[0:3], v[224:227]
ds_read_b64_tr_b16 a[128:129], v22 offset:0
v_mfma_f32_16x16x32_bf16 v[224:227], a[140:143], a[4:7], v[224:227]
v_mfma_f32_16x16x32_bf16 v[228:231], a[136:139], a[8:11], v[228:231]
ds_read_b64_tr_b16 a[130:131], v22 offset:2048
v_mfma_f32_16x16x32_bf16 v[228:231], a[140:143], a[12:15], v[228:231]
buffer_store_dwordx4 v[88:91], v1, s[4:7], s31 offen sc1
v_mfma_f32_16x16x32_bf16 v[232:235], a[136:139], a[16:19], v[232:235]
ds_read_b64_tr_b16 a[132:133], v22 offset:16384
v_mfma_f32_16x16x32_bf16 v[232:235], a[140:143], a[20:23], v[232:235]
v_mfma_f32_16x16x32_bf16 v[236:239], a[136:139], a[24:27], v[236:239]
ds_read_b64_tr_b16 a[134:135], v22 offset:18432
v_add_u32 v22, 32768, v22
v_mfma_f32_16x16x32_bf16 v[236:239], a[140:143], a[28:31], v[236:239]
v_mfma_f32_16x16x32_bf16 v[240:243], a[136:139], a[32:35], v[240:243]
v_mfma_f32_16x16x32_bf16 v[240:243], a[140:143], a[36:39], v[240:243]
v_mfma_f32_16x16x32_bf16 v[244:247], a[136:139], a[40:43], v[244:247]
v_mfma_f32_16x16x32_bf16 v[244:247], a[140:143], a[44:47], v[244:247]
v_mfma_f32_16x16x32_bf16 v[248:251], a[136:139], a[48:51], v[248:251]
v_mfma_f32_16x16x32_bf16 v[248:251], a[140:143], a[52:55], v[248:251]
v_mfma_f32_16x16x32_bf16 v[252:255], a[136:139], a[56:59], v[252:255]
v_mfma_f32_16x16x32_bf16 v[252:255], a[140:143], a[60:63], v[252:255]
s_waitcnt lgkmcnt(0)
v_mfma_f32_16x16x32_bf16 v[36:39], a[128:131], a[64:67], v[36:39]
ds_read_b64_tr_b16 a[136:137], v23 offset:0
v_mfma_f32_16x16x32_bf16 v[36:39], a[132:135], a[68:71], v[36:39]
v_mfma_f32_16x16x32_bf16 v[44:47], a[128:131], a[72:75], v[44:47]
ds_read_b64_tr_b16 a[138:139], v23 offset:2048
v_mfma_f32_16x16x32_bf16 v[44:47], a[132:135], a[76:79], v[44:47]
ds_read_b128 a[0:3], v2 offset:32768
ds_read_b128 a[4:7], v3 offset:32768
v_mfma_f32_16x16x32_bf16 v[52:55], a[128:131], a[80:83], v[52:55]
ds_read_b64_tr_b16 a[140:141], v23 offset:16384
v_mfma_f32_16x16x32_bf16 v[52:55], a[132:135], a[84:87], v[52:55]
v_mfma_f32_16x16x32_bf16 v[60:63], a[128:131], a[88:91], v[60:63]
ds_read_b64_tr_b16 a[142:143], v23 offset:18432
v_add_u32 v23, 32768, v23
v_mfma_f32_16x16x32_bf16 v[60:63], a[132:135], a[92:95], v[60:63]
v_mfma_f32_16x16x32_bf16 v[68:71], a[128:131], a[96:99], v[68:71]
ds_read_b128 a[8:11], v2 offset:34816
v_mfma_f32_16x16x32_bf16 v[68:71], a[132:135], a[100:103], v[68:71]
v_mfma_f32_16x16x32_bf16 v[76:79], a[128:131], a[104:107], v[76:79]
ds_read_b128 a[12:15], v3 offset:34816
v_mfma_f32_16x16x32_bf16 v[76:79], a[132:135], a[108:111], v[76:79]
ds_read_b128 a[16:19], v2 offset:36864
v_mfma_f32_16x16x32_bf16 v[84:87], a[128:131], a[112:115], v[84:87]
ds_read_b128 a[20:23], v3 offset:36864
v_mfma_f32_16x16x32_bf16 v[84:87], a[132:135], a[116:119], v[84:87]
v_mfma_f32_16x16x32_bf16 v[92:95], a[128:131], a[120:123], v[92:95]
ds_read_b128 a[24:27], v2 offset:38912
v_mfma_f32_16x16x32_bf16 v[92:95], a[132:135], a[124:127], v[92:95]
s_waitcnt lgkmcnt(5)
v_mfma_f32_16x16x32_bf16 v[100:103], a[136:139], a[64:67], v[100:103]
ds_read_b64_tr_b16 a[128:129], v24 offset:0
v_mfma_f32_16x16x32_bf16 v[100:103], a[140:143], a[68:71], v[100:103]
v_mfma_f32_16x16x32_bf16 v[108:111], a[136:139], a[72:75], v[108:111]
ds_read_b64_tr_b16 a[130:131], v24 offset:2048
v_mfma_f32_16x16x32_bf16 v[108:111], a[140:143], a[76:79], v[108:111]
ds_read_b128 a[28:31], v3 offset:38912
v_mfma_f32_16x16x32_bf16 v[116:119], a[136:139], a[80:83], v[116:119]
ds_read_b64_tr_b16 a[132:133], v24 offset:16384
v_mfma_f32_16x16x32_bf16 v[116:119], a[140:143], a[84:87], v[116:119]
v_mfma_f32_16x16x32_bf16 v[124:127], a[136:139], a[88:91], v[124:127]
ds_read_b64_tr_b16 a[134:135], v24 offset:18432
v_add_u32 v24, 32768, v24
v_mfma_f32_16x16x32_bf16 v[124:127], a[140:143], a[92:95], v[124:127]
v_mfma_f32_16x16x32_bf16 v[132:135], a[136:139], a[96:99], v[132:135]
ds_read_b128 a[32:35], v2 offset:40960
v_mfma_f32_16x16x32_bf16 v[132:135], a[140:143], a[100:103], v[132:135]
v_mfma_f32_16x16x32_bf16 v[140:143], a[136:139], a[104:107], v[140:143]
ds_read_b128 a[36:39], v3 offset:40960
v_mfma_f32_16x16x32_bf16 v[140:143], a[140:143], a[108:111], v[140:143]
ds_read_b128 a[40:43], v2 offset:43008
v_mfma_f32_16x16x32_bf16 v[148:151], a[136:139], a[112:115], v[148:151]
ds_read_b128 a[44:47], v3 offset:43008
v_mfma_f32_16x16x32_bf16 v[148:151], a[140:143], a[116:119], v[148:151]
v_mfma_f32_16x16x32_bf16 v[156:159], a[136:139], a[120:123], v[156:159]
ds_read_b128 a[48:51], v2 offset:45056
v_mfma_f32_16x16x32_bf16 v[156:159], a[140:143], a[124:127], v[156:159]
s_waitcnt lgkmcnt(5)
v_mfma_f32_16x16x32_bf16 v[164:167], a[128:131], a[64:67], v[164:167]
ds_read_b64_tr_b16 a[136:137], v25 offset:0
v_mfma_f32_16x16x32_bf16 v[164:167], a[132:135], a[68:71], v[164:167]
v_mfma_f32_16x16x32_bf16 v[172:175], a[128:131], a[72:75], v[172:175]
ds_read_b64_tr_b16 a[138:139], v25 offset:2048
v_mfma_f32_16x16x32_bf16 v[172:175], a[132:135], a[76:79], v[172:175]
ds_read_b128 a[52:55], v3 offset:45056
v_mfma_f32_16x16x32_bf16 v[180:183], a[128:131], a[80:83], v[180:183]
ds_read_b64_tr_b16 a[140:141], v25 offset:16384
v_mfma_f32_16x16x32_bf16 v[180:183], a[132:135], a[84:87], v[180:183]
v_mfma_f32_16x16x32_bf16 v[188:191], a[128:131], a[88:91], v[188:191]
ds_read_b64_tr_b16 a[142:143], v25 offset:18432
v_add_u32 v25, 32768, v25
v_mfma_f32_16x16x32_bf16 v[188:191], a[132:135], a[92:95], v[188:191]
v_mfma_f32_16x16x32_bf16 v[196:199], a[128:131], a[96:99], v[196:199]
ds_read_b128 a[56:59], v2 offset:47104
v_mfma_f32_16x16x32_bf16 v[196:199], a[132:135], a[100:103], v[196:199]
v_mfma_f32_16x16x32_bf16 v[204:207], a[128:131], a[104:107], v[204:207]
ds_read_b128 a[60:63], v3 offset:47104
v_mfma_f32_16x16x32_bf16 v[204:207], a[132:135], a[108:111], v[204:207]
v_mfma_f32_16x16x32_bf16 v[212:215], a[128:131], a[112:115], v[212:215]
v_mfma_f32_16x16x32_bf16 v[212:215], a[132:135], a[116:119], v[212:215]
v_mfma_f32_16x16x32_bf16 v[220:223], a[128:131], a[120:123], v[220:223]
v_mfma_f32_16x16x32_bf16 v[220:223], a[132:135], a[124:127], v[220:223]
s_waitcnt vmcnt(0) lgkmcnt(0)
s_barrier
v_mfma_f32_16x16x32_bf16 v[224:227], a[136:139], a[64:67], v[224:227]
ds_read_b64_tr_b16 a[128:129], v22 offset:0
v_mfma_f32_16x16x32_bf16 v[224:227], a[140:143], a[68:71], v[224:227]
buffer_store_dword v27, v26, s[4:7], s66 offen sc1
v_mfma_f32_16x16x32_bf16 v[228:231], a[136:139], a[72:75], v[228:231]
ds_read_b64_tr_b16 a[130:131], v22 offset:2048
v_mfma_f32_16x16x32_bf16 v[228:231], a[140:143], a[76:79], v[228:231]
v_mfma_f32_16x16x32_bf16 v[232:235], a[136:139], a[80:83], v[232:235]
ds_read_b64_tr_b16 a[132:133], v22 offset:16384
v_mfma_f32_16x16x32_bf16 v[232:235], a[140:143], a[84:87], v[232:235]
v_mfma_f32_16x16x32_bf16 v[236:239], a[136:139], a[88:91], v[236:239]
ds_read_b64_tr_b16 a[134:135], v22 offset:18432
v_mfma_f32_16x16x32_bf16 v[236:239], a[140:143], a[92:95], v[236:239]
v_mfma_f32_16x16x32_bf16 v[240:243], a[136:139], a[96:99], v[240:243]
v_mfma_f32_16x16x32_bf16 v[240:243], a[140:143], a[100:103], v[240:243]
v_mfma_f32_16x16x32_bf16 v[244:247], a[136:139], a[104:107], v[244:247]
v_mfma_f32_16x16x32_bf16 v[244:247], a[140:143], a[108:111], v[244:247]
v_mfma_f32_16x16x32_bf16 v[248:251], a[136:139], a[112:115], v[248:251]
v_mfma_f32_16x16x32_bf16 v[248:251], a[140:143], a[116:119], v[248:251]
v_mfma_f32_16x16x32_bf16 v[252:255], a[136:139], a[120:123], v[252:255]
v_mfma_f32_16x16x32_bf16 v[252:255], a[140:143], a[124:127], v[252:255]
s_waitcnt lgkmcnt(0)
v_mfma_f32_16x16x32_bf16 v[36:39], a[128:131], a[0:3], v[36:39]
s_lshl_b32 s18, s3, 13
ds_read_b64_tr_b16 a[136:137], v23 offset:0
v_lshrrev_b32 v28, 6, v0
v_mfma_f32_16x16x32_bf16 v[36:39], a[132:135], a[4:7], v[36:39]
s_lshl_b32 s30, s20, 20
v_lshl_add_u32 v28, v28, 11, v1
v_add_u32 v28, 65536, v28
v_mfma_f32_16x16x32_bf16 v[44:47], a[128:131], a[8:11], v[44:47]
s_add_u32 s30, s30, s18
ds_read_b64_tr_b16 a[138:139], v23 offset:2048
v_lshrrev_b32 v3, 6, v0
v_mfma_f32_16x16x32_bf16 v[44:47], a[132:135], a[12:15], v[44:47]
s_lshl_b32 s22, s21, 1
v_and_b32 v4, 63, v0
v_add_u32 v2, 0x10000, v1
v_mfma_f32_16x16x32_bf16 v[52:55], a[128:131], a[16:19], v[52:55]
s_lshl_b32 s85, s21, 2
ds_read_b64_tr_b16 a[140:141], v23 offset:16384
v_and_b32 v5, 15, v4
v_mfma_f32_16x16x32_bf16 v[52:55], a[132:135], a[20:23], v[52:55]
s_lshr_b32 s85, 2386092, s85
v_lshrrev_b32 v6, 4, v4
v_lshlrev_b32 v6, 2, v6
v_mfma_f32_16x16x32_bf16 v[60:63], a[128:131], a[24:27], v[60:63]
s_and_b32 s9, s85, 15
ds_read_b64_tr_b16 a[142:143], v23 offset:18432
v_sub_u32 v5, v5, v6
v_mfma_f32_16x16x32_bf16 v[60:63], a[132:135], a[28:31], v[60:63]
s_and_b32 s84, s85, 1
v_lshl_add_u32 v5, v3, 4, v5
v_cmp_gt_i32 s[32:33], 0, v5
v_mfma_f32_16x16x32_bf16 v[68:71], a[128:131], a[32:35], v[68:71]
s_lshl_b32 s84, s84, 17
v_cmp_gt_i32 s[34:35], 1, v5
v_cmp_gt_i32 s[36:37], 2, v5
v_mfma_f32_16x16x32_bf16 v[68:71], a[132:135], a[36:39], v[68:71]
s_add_u32 s84, s84, s18
v_cmp_gt_i32 s[38:39], 3, v5
v_cmp_gt_i32 s[40:41], 16, v5
v_mfma_f32_16x16x32_bf16 v[76:79], a[128:131], a[40:43], v[76:79]
s_xor_b32 s85, s84, 0x20000
v_cmp_gt_i32 s[42:43], 17, v5
v_cmp_gt_i32 s[44:45], 18, v5
v_mfma_f32_16x16x32_bf16 v[76:79], a[132:135], a[44:47], v[76:79]
s_sub_u32 s29, 15, s21
v_cmp_gt_i32 s[46:47], 19, v5
v_cmp_gt_i32 s[48:49], 32, v5
v_mfma_f32_16x16x32_bf16 v[84:87], a[128:131], a[48:51], v[84:87]
s_cmp_lg_u32 s9, 0
v_cmp_gt_i32 s[50:51], 33, v5
v_cmp_gt_i32 s[52:53], 34, v5
v_mfma_f32_16x16x32_bf16 v[84:87], a[132:135], a[52:55], v[84:87]
s_cselect_b32 s24, 1, 0
v_cmp_gt_i32 s[54:55], 35, v5
v_cmp_gt_i32 s[56:57], 48, v5
v_mfma_f32_16x16x32_bf16 v[92:95], a[128:131], a[56:59], v[92:95]
s_cselect_b32 s67, s67, 3221225472
v_cmp_gt_i32 s[58:59], 49, v5
v_cmp_gt_i32 s[60:61], 50, v5
v_mfma_f32_16x16x32_bf16 v[92:95], a[132:135], a[60:63], v[92:95]
s_waitcnt lgkmcnt(0)
v_cmp_gt_i32 s[62:63], 51, v5
v_mov_b32 v7, 0xff800000
v_mfma_f32_16x16x32_bf16 v[100:103], a[136:139], a[0:3], v[100:103]
s_lshl_b32 s8, s9, 15
ds_read_b64_tr_b16 a[128:129], v24 offset:0
v_mov_b32 v6, 1
v_mfma_f32_16x16x32_bf16 v[100:103], a[140:143], a[4:7], v[100:103]
s_add_u32 s8, s8, s30
v_mov_b32 v5, v26
v_add_u32 v4, 0x20000, v1
v_mfma_f32_16x16x32_bf16 v[108:111], a[136:139], a[8:11], v[108:111]
s_add_u32 s9, s9, s22
ds_read_b64_tr_b16 a[130:131], v24 offset:2048
v_mfma_f32_16x16x32_bf16 v[108:111], a[140:143], a[12:15], v[108:111]
s_sub_u32 s9, 32, s9
v_mfma_f32_16x16x32_bf16 v[116:119], a[136:139], a[16:19], v[116:119]
s_bitcmp1_b32 s2, 4
ds_read_b64_tr_b16 a[132:133], v24 offset:16384
v_mfma_f32_16x16x32_bf16 v[116:119], a[140:143], a[20:23], v[116:119]
s_cselect_b32 s9, 16, s9
v_mfma_f32_16x16x32_bf16 v[124:127], a[136:139], a[24:27], v[124:127]
s_cselect_b32 s29, 7, s29
ds_read_b64_tr_b16 a[134:135], v24 offset:18432
v_mul_f32 v36, s68, v36
v_mfma_f32_16x16x32_bf16 v[124:127], a[140:143], a[28:31], v[124:127]
s_mov_b32 s10, 3221225472
v_mul_f32 v37, s68, v37
v_mul_f32 v38, s68, v38
v_mfma_f32_16x16x32_bf16 v[132:135], a[136:139], a[32:35], v[132:135]
s_mov_b32 s14, 3221225472
v_mul_f32 v39, s68, v39
v_mul_f32 v100, s68, v100
v_mfma_f32_16x16x32_bf16 v[132:135], a[140:143], a[36:39], v[132:135]
s_mov_b32 s11, 0
v_mul_f32 v101, s68, v101
v_mul_f32 v102, s68, v102
v_mfma_f32_16x16x32_bf16 v[140:143], a[136:139], a[40:43], v[140:143]
s_lshr_b32 s19, s9, 1
v_mul_f32 v103, s68, v103
v_cvt_pk_bf16_f32 v36, v36, v37
v_mfma_f32_16x16x32_bf16 v[140:143], a[140:143], a[44:47], v[140:143]
s_sub_u32 s19, s19, 1
v_cvt_pk_bf16_f32 v37, v38, v39
v_cvt_pk_bf16_f32 v38, v100, v101
v_mfma_f32_16x16x32_bf16 v[148:151], a[136:139], a[48:51], v[148:151]
s_add_u32 s12, s8, 16777216
v_cvt_pk_bf16_f32 v39, v102, v103
v_mul_f32 v44, s68, v44
v_mfma_f32_16x16x32_bf16 v[148:151], a[140:143], a[52:55], v[148:151]
s_mov_b32 s13, s9
ds_write_b128 v28, v[36:39] offset:0
v_mul_f32 v45, s68, v45
v_mfma_f32_16x16x32_bf16 v[156:159], a[136:139], a[56:59], v[156:159]
s_mov_b32 s15, s11
s_add_u32 s23, s67, 0
buffer_store_dwordx4 v[36:39], v1, s[4:7], s23 offen offset:0 sc1
v_mfma_f32_16x16x32_bf16 v[156:159], a[140:143], a[60:63], v[156:159]
s_waitcnt lgkmcnt(1)
v_mul_f32 v46, s68, v46
v_mul_f32 v47, s68, v47
v_mfma_f32_16x16x32_bf16 v[164:167], a[128:131], a[0:3], v[164:167]
ds_read_b64_tr_b16 a[136:137], v25 offset:0
v_mul_f32 v108, s68, v108
v_mfma_f32_16x16x32_bf16 v[164:167], a[132:135], a[4:7], v[164:167]
v_mul_f32 v109, s68, v109
v_mul_f32 v110, s68, v110
v_mfma_f32_16x16x32_bf16 v[172:175], a[128:131], a[8:11], v[172:175]
ds_read_b64_tr_b16 a[138:139], v25 offset:2048
v_mul_f32 v111, s68, v111
v_mfma_f32_16x16x32_bf16 v[172:175], a[132:135], a[12:15], v[172:175]
v_cvt_pk_bf16_f32 v44, v44, v45
v_cvt_pk_bf16_f32 v45, v46, v47
v_mfma_f32_16x16x32_bf16 v[180:183], a[128:131], a[16:19], v[180:183]
ds_read_b64_tr_b16 a[140:141], v25 offset:16384
v_cvt_pk_bf16_f32 v46, v108, v109
v_mfma_f32_16x16x32_bf16 v[180:183], a[132:135], a[20:23], v[180:183]
v_cvt_pk_bf16_f32 v47, v110, v111
v_mul_f32 v52, s68, v52
v_mfma_f32_16x16x32_bf16 v[188:191], a[128:131], a[24:27], v[188:191]
ds_read_b64_tr_b16 a[142:143], v25 offset:18432
v_mul_f32 v53, s68, v53
v_mfma_f32_16x16x32_bf16 v[188:191], a[132:135], a[28:31], v[188:191]
ds_write_b128 v28, v[44:47] offset:8192
v_mul_f32 v54, s68, v54
v_mfma_f32_16x16x32_bf16 v[196:199], a[128:131], a[32:35], v[196:199]
s_add_u32 s23, s67, 8192
buffer_store_dwordx4 v[44:47], v1, s[4:7], s23 offen offset:0 sc1
v_mfma_f32_16x16x32_bf16 v[196:199], a[132:135], a[36:39], v[196:199]
v_mul_f32 v55, s68, v55
v_mul_f32 v116, s68, v116
v_mfma_f32_16x16x32_bf16 v[204:207], a[128:131], a[40:43], v[204:207]
v_mul_f32 v117, s68, v117
v_mul_f32 v118, s68, v118
v_mfma_f32_16x16x32_bf16 v[204:207], a[132:135], a[44:47], v[204:207]
v_mul_f32 v119, s68, v119
v_cvt_pk_bf16_f32 v52, v52, v53
v_mfma_f32_16x16x32_bf16 v[212:215], a[128:131], a[48:51], v[212:215]
v_cvt_pk_bf16_f32 v53, v54, v55
v_cvt_pk_bf16_f32 v54, v116, v117
v_mfma_f32_16x16x32_bf16 v[212:215], a[132:135], a[52:55], v[212:215]
v_cvt_pk_bf16_f32 v55, v118, v119
v_mul_f32 v60, s68, v60
v_mfma_f32_16x16x32_bf16 v[220:223], a[128:131], a[56:59], v[220:223]
ds_write_b128 v28, v[52:55] offset:16384
v_mul_f32 v61, s68, v61
v_mfma_f32_16x16x32_bf16 v[220:223], a[132:135], a[60:63], v[220:223]
s_waitcnt lgkmcnt(0)
s_waitcnt lgkmcnt(0)
s_barrier
v_mfma_f32_16x16x32_bf16 v[224:227], a[136:139], a[0:3], v[224:227]
s_add_u32 s23, s67, 16384
buffer_store_dwordx4 v[52:55], v1, s[4:7], s23 offen offset:0 sc1
v_mfma_f32_16x16x32_bf16 v[224:227], a[140:143], a[4:7], v[224:227]
v_mul_f32 v62, s68, v62
v_mul_f32 v63, s68, v63
v_mfma_f32_16x16x32_bf16 v[228:231], a[136:139], a[8:11], v[228:231]
v_mul_f32 v124, s68, v124
v_mul_f32 v125, s68, v125
v_mfma_f32_16x16x32_bf16 v[228:231], a[140:143], a[12:15], v[228:231]
v_mul_f32 v126, s68, v126
v_mul_f32 v127, s68, v127
v_mfma_f32_16x16x32_bf16 v[232:235], a[136:139], a[16:19], v[232:235]
v_cvt_pk_bf16_f32 v60, v60, v61
v_cvt_pk_bf16_f32 v61, v62, v63
v_mfma_f32_16x16x32_bf16 v[232:235], a[140:143], a[20:23], v[232:235]
v_cvt_pk_bf16_f32 v62, v124, v125
v_cvt_pk_bf16_f32 v63, v126, v127
v_mfma_f32_16x16x32_bf16 v[236:239], a[136:139], a[24:27], v[236:239]
ds_write_b128 v28, v[60:63] offset:24576
v_mul_f32 v68, s68, v68
v_mfma_f32_16x16x32_bf16 v[236:239], a[140:143], a[28:31], v[236:239]
s_add_u32 s23, s67, 24576
buffer_store_dwordx4 v[60:63], v1, s[4:7], s23 offen offset:0 sc1
v_mfma_f32_16x16x32_bf16 v[240:243], a[136:139], a[32:35], v[240:243]
v_mul_f32 v69, s68, v69
v_mul_f32 v70, s68, v70
v_mfma_f32_16x16x32_bf16 v[240:243], a[140:143], a[36:39], v[240:243]
v_mul_f32 v71, s68, v71
v_mul_f32 v132, s68, v132
v_mfma_f32_16x16x32_bf16 v[244:247], a[136:139], a[40:43], v[244:247]
v_mul_f32 v133, s68, v133
v_mul_f32 v134, s68, v134
v_mfma_f32_16x16x32_bf16 v[244:247], a[140:143], a[44:47], v[244:247]
v_mul_f32 v135, s68, v135
v_cvt_pk_bf16_f32 v68, v68, v69
v_mfma_f32_16x16x32_bf16 v[248:251], a[136:139], a[48:51], v[248:251]
v_cvt_pk_bf16_f32 v69, v70, v71
v_cvt_pk_bf16_f32 v70, v132, v133
v_mfma_f32_16x16x32_bf16 v[248:251], a[140:143], a[52:55], v[248:251]
v_cvt_pk_bf16_f32 v71, v134, v135
v_mfma_f32_16x16x32_bf16 v[252:255], a[136:139], a[56:59], v[252:255]
ds_write_b128 v28, v[68:71] offset:32768
v_mfma_f32_16x16x32_bf16 v[252:255], a[140:143], a[60:63], v[252:255]
s_add_u32 s23, s67, 32768
buffer_store_dwordx4 v[68:71], v1, s[4:7], s23 offen offset:0 sc1
buffer_load_dword v21, v20, s[4:7], s70 offen sc1
v_pk_mul_f32 v[76:77], v[76:77], s[68:69]
v_pk_mul_f32 v[78:79], v[78:79], s[68:69]
v_pk_mul_f32 v[140:141], v[140:141], s[68:69]
v_pk_mul_f32 v[142:143], v[142:143], s[68:69]
v_cvt_pk_bf16_f32 v76, v76, v77
v_cvt_pk_bf16_f32 v77, v78, v79
v_cvt_pk_bf16_f32 v78, v140, v141
v_cvt_pk_bf16_f32 v79, v142, v143
ds_write_b128 v28, v[76:79] offset:40960
s_add_u32 s23, s67, 40960
buffer_store_dwordx4 v[76:79], v1, s[4:7], s23 offen offset:0 sc1
v_pk_mul_f32 v[84:85], v[84:85], s[68:69]
v_pk_mul_f32 v[86:87], v[86:87], s[68:69]
v_pk_mul_f32 v[148:149], v[148:149], s[68:69]
v_pk_mul_f32 v[150:151], v[150:151], s[68:69]
v_cvt_pk_bf16_f32 v84, v84, v85
v_cvt_pk_bf16_f32 v85, v86, v87
v_cvt_pk_bf16_f32 v86, v148, v149
v_cvt_pk_bf16_f32 v87, v150, v151
ds_write_b128 v28, v[84:87] offset:49152
s_add_u32 s23, s67, 49152
buffer_store_dwordx4 v[84:87], v1, s[4:7], s23 offen offset:0 sc1
v_pk_mul_f32 v[92:93], v[92:93], s[68:69]
v_pk_mul_f32 v[94:95], v[94:95], s[68:69]
v_pk_mul_f32 v[156:157], v[156:157], s[68:69]
v_pk_mul_f32 v[158:159], v[158:159], s[68:69]
v_cvt_pk_bf16_f32 v92, v92, v93
v_cvt_pk_bf16_f32 v93, v94, v95
v_cvt_pk_bf16_f32 v94, v156, v157
v_cvt_pk_bf16_f32 v95, v158, v159
ds_write_b128 v28, v[92:95] offset:57344
s_add_u32 s23, s67, 57344
buffer_store_dwordx4 v[92:95], v1, s[4:7], s23 offen offset:0 sc1
v_pk_mul_f32 v[164:165], v[164:165], s[68:69]
v_pk_mul_f32 v[166:167], v[166:167], s[68:69]
v_pk_mul_f32 v[224:225], v[224:225], s[68:69]
v_pk_mul_f32 v[226:227], v[226:227], s[68:69]
v_cvt_pk_bf16_f32 v164, v164, v165
v_cvt_pk_bf16_f32 v165, v166, v167
v_cvt_pk_bf16_f32 v166, v224, v225
v_cvt_pk_bf16_f32 v167, v226, v227
ds_write_b128 v28, v[164:167] offset:1024
s_add_u32 s23, s67, 0
buffer_store_dwordx4 v[164:167], v1, s[4:7], s23 offen offset:1024 sc1
v_pk_mul_f32 v[172:173], v[172:173], s[68:69]
v_pk_mul_f32 v[174:175], v[174:175], s[68:69]
v_pk_mul_f32 v[228:229], v[228:229], s[68:69]
v_pk_mul_f32 v[230:231], v[230:231], s[68:69]
v_cvt_pk_bf16_f32 v172, v172, v173
v_cvt_pk_bf16_f32 v173, v174, v175
v_cvt_pk_bf16_f32 v174, v228, v229
v_cvt_pk_bf16_f32 v175, v230, v231
ds_write_b128 v28, v[172:175] offset:9216
s_add_u32 s23, s67, 8192
buffer_store_dwordx4 v[172:175], v1, s[4:7], s23 offen offset:1024 sc1
v_pk_mul_f32 v[180:181], v[180:181], s[68:69]
v_pk_mul_f32 v[182:183], v[182:183], s[68:69]
v_pk_mul_f32 v[232:233], v[232:233], s[68:69]
v_pk_mul_f32 v[234:235], v[234:235], s[68:69]
v_cvt_pk_bf16_f32 v180, v180, v181
v_cvt_pk_bf16_f32 v181, v182, v183
v_cvt_pk_bf16_f32 v182, v232, v233
v_cvt_pk_bf16_f32 v183, v234, v235
ds_write_b128 v28, v[180:183] offset:17408
s_add_u32 s23, s67, 16384
buffer_store_dwordx4 v[180:183], v1, s[4:7], s23 offen offset:1024 sc1
v_pk_mul_f32 v[188:189], v[188:189], s[68:69]
v_pk_mul_f32 v[190:191], v[190:191], s[68:69]
v_pk_mul_f32 v[236:237], v[236:237], s[68:69]
v_pk_mul_f32 v[238:239], v[238:239], s[68:69]
v_cvt_pk_bf16_f32 v188, v188, v189
v_cvt_pk_bf16_f32 v189, v190, v191
v_cvt_pk_bf16_f32 v190, v236, v237
v_cvt_pk_bf16_f32 v191, v238, v239
ds_write_b128 v28, v[188:191] offset:25600
s_add_u32 s23, s67, 24576
buffer_store_dwordx4 v[188:191], v1, s[4:7], s23 offen offset:1024 sc1
v_pk_mul_f32 v[196:197], v[196:197], s[68:69]
v_pk_mul_f32 v[198:199], v[198:199], s[68:69]
v_pk_mul_f32 v[240:241], v[240:241], s[68:69]
v_pk_mul_f32 v[242:243], v[242:243], s[68:69]
PAD_8:
s_cbranch_execz M_tret
v_cvt_pk_bf16_f32 v196, v196, v197
v_cvt_pk_bf16_f32 v197, v198, v199
v_cvt_pk_bf16_f32 v198, v240, v241
v_cvt_pk_bf16_f32 v199, v242, v243
ds_write_b128 v28, v[196:199] offset:33792
s_add_u32 s23, s67, 32768
buffer_store_dwordx4 v[196:199], v1, s[4:7], s23 offen offset:1024 sc1
v_pk_mul_f32 v[204:205], v[204:205], s[68:69]
v_pk_mul_f32 v[206:207], v[206:207], s[68:69]
v_pk_mul_f32 v[244:245], v[244:245], s[68:69]
v_pk_mul_f32 v[246:247], v[246:247], s[68:69]
v_cvt_pk_bf16_f32 v204, v204, v205
v_cvt_pk_bf16_f32 v205, v206, v207
v_cvt_pk_bf16_f32 v206, v244, v245
v_cvt_pk_bf16_f32 v207, v246, v247
ds_write_b128 v28, v[204:207] offset:41984
s_add_u32 s23, s67, 40960
buffer_store_dwordx4 v[204:207], v1, s[4:7], s23 offen offset:1024 sc1
v_pk_mul_f32 v[212:213], v[212:213], s[68:69]
v_pk_mul_f32 v[214:215], v[214:215], s[68:69]
v_pk_mul_f32 v[248:249], v[248:249], s[68:69]
v_pk_mul_f32 v[250:251], v[250:251], s[68:69]
v_cvt_pk_bf16_f32 v212, v212, v213
v_cvt_pk_bf16_f32 v213, v214, v215
v_cvt_pk_bf16_f32 v214, v248, v249
v_cvt_pk_bf16_f32 v215, v250, v251
ds_write_b128 v28, v[212:215] offset:50176
s_add_u32 s23, s67, 49152
buffer_store_dwordx4 v[212:215], v1, s[4:7], s23 offen offset:1024 sc1
v_pk_mul_f32 v[220:221], v[220:221], s[68:69]
v_pk_mul_f32 v[222:223], v[222:223], s[68:69]
v_pk_mul_f32 v[252:253], v[252:253], s[68:69]
v_pk_mul_f32 v[254:255], v[254:255], s[68:69]
v_cvt_pk_bf16_f32 v220, v220, v221
v_cvt_pk_bf16_f32 v221, v222, v223
v_cvt_pk_bf16_f32 v222, v252, v253
v_cvt_pk_bf16_f32 v223, v254, v255
ds_write_b128 v28, v[220:223] offset:58368
s_add_u32 s23, s67, 57344
buffer_store_dwordx4 v[220:223], v1, s[4:7], s23 offen offset:1024 sc1
s_waitcnt vmcnt(11)
v_cmp_gt_u32 vcc, 1, v21
s_cbranch_vccnz M_kspin
M_kok:
buffer_load_dword v21, v15, s[4:7], s70 offen sc1
s_mov_b32 m0, s84
s_nop 0
buffer_load_dwordx4 v1, s[4:7], s8 offen offset:0 sc1 lds
buffer_load_dwordx4 v1, s[4:7], s8 offen offset:1024 sc1 lds
buffer_load_dwordx4 v1, s[4:7], s8 offen offset:2048 sc1 lds
buffer_load_dwordx4 v1, s[4:7], s8 offen offset:3072 sc1 lds
s_add_u32 s8, s8, 4096
s_add_u32 m0, s84, 4096
s_nop 0
buffer_load_dwordx4 v1, s[4:7], s8 offen offset:0 sc1 lds
buffer_load_dwordx4 v1, s[4:7], s8 offen offset:1024 sc1 lds
buffer_load_dwordx4 v1, s[4:7], s8 offen offset:2048 sc1 lds
buffer_load_dwordx4 v1, s[4:7], s8 offen offset:3072 sc1 lds
s_add_u32 s8, s8, 28672
s_sub_u32 s9, s9, 1
s_cmp_eq_u32 s9, 0
s_cselect_b32 s8, s10, s8
s_cselect_b32 s9, s11, s9
s_cselect_b32 s10, 3221225472, s10
v_add_u32 v28, s18, v2
s_waitcnt lgkmcnt(0)
s_barrier
ds_read_b128 a[0:3], v28 offset:0
ds_read_b128 a[4:7], v28 offset:1024
ds_read_b128 a[8:11], v28 offset:2048
ds_read_b128 a[12:15], v28 offset:3072
ds_read_b128 a[16:19], v28 offset:4096
ds_read_b128 a[20:23], v28 offset:5120
ds_read_b128 a[24:27], v28 offset:6144
ds_read_b128 a[28:31], v28 offset:7168
ds_read_b128 a[32:35], v28 offset:32768
ds_read_b128 a[36:39], v28 offset:33792
ds_read_b128 a[40:43], v28 offset:34816
ds_read_b128 a[44:47], v28 offset:35840
ds_read_b128 a[48:51], v28 offset:36864
ds_read_b128 a[52:55], v28 offset:37888
ds_read_b128 a[56:59], v28 offset:38912
ds_read_b128 a[60:63], v28 offset:39936
s_mov_b32 m0, s85
s_nop 0
buffer_load_dwordx4 v1, s[4:7], s8 offen offset:0 sc1 lds
buffer_load_dwordx4 v1, s[4:7], s8 offen offset:1024 sc1 lds
buffer_load_dwordx4 v1, s[4:7], s8 offen offset:2048 sc1 lds
buffer_load_dwordx4 v1, s[4:7], s8 offen offset:3072 sc1 lds
s_add_u32 s8, s8, 4096
s_add_u32 m0, s85, 4096
s_nop 0
buffer_load_dwordx4 v1, s[4:7], s8 offen offset:0 sc1 lds
buffer_load_dwordx4 v1, s[4:7], s8 offen offset:1024 sc1 lds
buffer_load_dwordx4 v1, s[4:7], s8 offen offset:2048 sc1 lds
buffer_load_dwordx4 v1, s[4:7], s8 offen offset:3072 sc1 lds
s_add_u32 s8, s8, 28672
s_sub_u32 s9, s9, 1
s_cmp_eq_u32 s9, 0
s_cselect_b32 s8, s10, s8
s_cselect_b32 s9, s11, s9
s_cselect_b32 s10, 3221225472, s10
s_mov_b32 s25, 1266679808
s_lshl_b32 s22, s21, 3
s_add_u32 s28, s70, s22
s_add_u32 s28, s28, 6148
s_lshl_b32 s26, s21, 16
s_add_u32 s26, s26, s30
s_add_u32 s26, s26, 33554432
s_lshl_b32 s76, s20, 3
s_add_u32 s76, s76, s21
s_lshl_b32 s76, s76, 2
s_add_u32 s76, s76, s3
s_lshl_b32 s27, s76, 10
s_add_u32 s27, s27, 75497472
s_lshl_b32 s76, s76, 14
s_add_u32 s76, s76, 67108864
s_lshl_b32 s81, s20, 2
s_add_u32 s81, s81, s3
s_mul_i32 s81, s81, 57344
s_cmp_eq_u32 s24, 1
s_cselect_b32 s80, s28, s70
s_add_u32 s77, s76, 8192
v_lshrrev_b32 v8, 7, v1
v_and_b32 v9, 6, v8
v_lshlrev_b32 v9, 4, v9
v_and_b32 v10, 0x70, v1
v_xor_b32 v9, v9, v10
v_mul_u32_u24 v8, 896, v8
v_add_u32 v8, v8, v9
v_accvgpr_write_b32 a184, v8
v_add_u32 v8, 6144, v8
v_accvgpr_write_b32 a185, v8
v_add_u32 v8, 6144, v8
v_accvgpr_write_b32 a186, v8
v_add_u32 v8, 6144, v8
v_accvgpr_write_b32 a187, v8
v_lshrrev_b32 v8, 6, v1
v_bfe_u32 v9, v1, 7, 2
v_lshlrev_b32 v9, 5, v9
v_lshl_add_u32 v8, v8, 7, v9
v_bfe_u32 v9, v1, 4, 2
v_lshl_add_u32 v8, v9, 3, v8
v_add_u32 v8, 32768, v8
v_accvgpr_write_b32 a188, v8
v_xor_b32 v9, 32, v8
v_accvgpr_write_b32 a189, v9
v_xor_b32 v9, 64, v8
v_accvgpr_write_b32 a190, v9
v_xor_b32 v9, 96, v8
v_accvgpr_write_b32 a191, v9
s_add_u32 s22, s66, 16384
s_mov_b32 s71, 3221225472
s_waitcnt vmcnt(17)
s_barrier
buffer_store_dword v6, v5, s[4:7], s22 offen sc1
v_mov_b64 v[128:129], 0
v_mov_b64 v[130:131], 0
v_mov_b64 v[132:133], 0
v_mov_b64 v[134:135], 0
v_mov_b64 v[136:137], 0
v_mov_b64 v[138:139], 0
v_mov_b64 v[140:141], 0
v_mov_b64 v[142:143], 0
v_mov_b64 v[144:145], 0
v_mov_b64 v[146:147], 0
v_mov_b64 v[148:149], 0
v_mov_b64 v[150:151], 0
v_mov_b64 v[152:153], 0
v_mov_b64 v[154:155], 0
v_mov_b64 v[156:157], 0
v_mov_b64 v[158:159], 0
v_mov_b64 v[160:161], 0
v_mov_b64 v[162:163], 0
v_mov_b64 v[164:165], 0
v_mov_b64 v[166:167], 0
v_mov_b64 v[168:169], 0
v_mov_b64 v[170:171], 0
v_mov_b64 v[172:173], 0
v_mov_b64 v[174:175], 0
v_mov_b64 v[176:177], 0
v_mov_b64 v[178:179], 0
v_mov_b64 v[180:181], 0
v_mov_b64 v[182:183], 0
v_mov_b64 v[184:185], 0
v_mov_b64 v[186:187], 0
v_mov_b64 v[188:189], 0
v_mov_b64 v[190:191], 0
v_mov_b64 v[192:193], 0
v_mov_b64 v[194:195], 0
v_mov_b64 v[196:197], 0
v_mov_b64 v[198:199], 0
v_mov_b64 v[200:201], 0
v_mov_b64 v[202:203], 0
v_mov_b64 v[204:205], 0
v_mov_b64 v[206:207], 0
v_mov_b64 v[208:209], 0
v_mov_b64 v[210:211], 0
v_mov_b64 v[212:213], 0
v_mov_b64 v[214:215], 0
v_mov_b64 v[216:217], 0
v_mov_b64 v[218:219], 0
v_mov_b64 v[220:221], 0
v_mov_b64 v[222:223], 0
v_mov_b64 v[224:225], 0
v_mov_b64 v[226:227], 0
v_mov_b64 v[228:229], 0
v_mov_b64 v[230:231], 0
v_mov_b64 v[232:233], 0
v_mov_b64 v[234:235], 0
v_mov_b64 v[236:237], 0
v_mov_b64 v[238:239], 0
v_mov_b64 v[240:241], 0
v_mov_b64 v[242:243], 0
v_mov_b64 v[244:245], 0
v_mov_b64 v[246:247], 0
v_mov_b64 v[248:249], 0
v_mov_b64 v[250:251], 0
v_mov_b64 v[252:253], 0
v_mov_b64 v[254:255], 0
v_mov_b64 v[24:25], 0
s_cmp_eq_u32 s24, 9
s_cbranch_scc1 M_t2A
M_t2Ar:
s_waitcnt vmcnt(9) lgkmcnt(0)
v_cmp_gt_u32 vcc, 1, v21
s_cbranch_vccnz M_vspin
M_vok:
s_barrier
K2_item:
PAD_9:
s_cbranch_execz M_tret
s_cmp_eq_u32 s19, 0
s_cbranch_scc1 K2_p0d
ds_read_b128 a[64:67], v1 offset:0
ds_read_b128 a[68:71], v1 offset:1024
ds_read_b128 a[72:75], v1 offset:2048
ds_read_b128 a[76:79], v1 offset:3072
ds_read_b128 a[80:83], v1 offset:4096
ds_read_b128 a[84:87], v1 offset:5120
ds_read_b128 a[88:91], v1 offset:6144
ds_read_b128 a[92:95], v1 offset:7168
s_waitcnt lgkmcnt(7)
v_mfma_f32_16x16x32_bf16 v[32:35], a[64:67], a[0:3], 0
s_waitcnt lgkmcnt(6)
s_add_u32 m0, s18, 65536
ds_read_b128 a[96:99], v1 offset:8192
v_mfma_f32_16x16x32_bf16 v[32:35], a[68:71], a[4:7], v[32:35]
s_waitcnt lgkmcnt(6)
buffer_load_dwordx4 v1, s[4:7], s12 offen offset:0 sc1 lds
v_mfma_f32_16x16x32_bf16 v[32:35], a[72:75], a[8:11], v[32:35]
s_waitcnt lgkmcnt(5)
ds_read_b128 a[100:103], v1 offset:9216
v_mfma_f32_16x16x32_bf16 v[32:35], a[76:79], a[12:15], v[32:35]
s_waitcnt lgkmcnt(5)
buffer_load_dwordx4 v1, s[4:7], s12 offen offset:1024 sc1 lds
v_mfma_f32_16x16x32_bf16 v[32:35], a[80:83], a[16:19], v[32:35]
s_waitcnt lgkmcnt(4)
ds_read_b128 a[104:107], v1 offset:10240
v_mfma_f32_16x16x32_bf16 v[32:35], a[84:87], a[20:23], v[32:35]
s_waitcnt lgkmcnt(4)
buffer_load_dwordx4 v1, s[4:7], s12 offen offset:2048 sc1 lds
v_mfma_f32_16x16x32_bf16 v[32:35], a[88:91], a[24:27], v[32:35]
s_waitcnt lgkmcnt(3)
ds_read_b128 a[108:111], v1 offset:11264
v_mfma_f32_16x16x32_bf16 v[32:35], a[92:95], a[28:31], v[32:35]
buffer_load_dwordx4 v1, s[4:7], s12 offen offset:3072 sc1 lds
v_mfma_f32_16x16x32_bf16 v[36:39], a[64:67], a[32:35], 0
s_add_u32 s12, s12, 4096
s_add_u32 m0, s18, 69632
ds_read_b128 a[112:115], v1 offset:12288
v_mfma_f32_16x16x32_bf16 v[36:39], a[68:71], a[36:39], v[36:39]
buffer_load_dwordx4 v1, s[4:7], s12 offen offset:0 sc1 lds
v_mfma_f32_16x16x32_bf16 v[36:39], a[72:75], a[40:43], v[36:39]
ds_read_b128 a[116:119], v1 offset:13312
v_mfma_f32_16x16x32_bf16 v[36:39], a[76:79], a[44:47], v[36:39]
buffer_load_dwordx4 v1, s[4:7], s12 offen offset:1024 sc1 lds
v_mfma_f32_16x16x32_bf16 v[36:39], a[80:83], a[48:51], v[36:39]
ds_read_b128 a[120:123], v1 offset:14336
v_max3_f32 v28, v32, v33, v34
v_mfma_f32_16x16x32_bf16 v[36:39], a[84:87], a[52:55], v[36:39]
buffer_load_dwordx4 v1, s[4:7], s12 offen offset:2048 sc1 lds
v_mfma_f32_16x16x32_bf16 v[36:39], a[88:91], a[56:59], v[36:39]
ds_read_b128 a[124:127], v1 offset:15360
v_max_f32 v28, v28, v35
v_mfma_f32_16x16x32_bf16 v[36:39], a[92:95], a[60:63], v[36:39]
s_waitcnt lgkmcnt(4)
buffer_load_dwordx4 v1, s[4:7], s12 offen offset:3072 sc1 lds
v_mfma_f32_16x16x32_bf16 v[40:43], a[96:99], a[0:3], 0
s_add_u32 s12, s12, 28672
ds_read_b128 a[64:67], v1 offset:16384
v_mov_b32 v30, v28
v_mfma_f32_16x16x32_bf16 v[40:43], a[100:103], a[4:7], v[40:43]
s_waitcnt lgkmcnt(2)
s_sub_u32 s13, s13, 1
v_mfma_f32_16x16x32_bf16 v[40:43], a[104:107], a[8:11], v[40:43]
s_cmp_eq_u32 s13, 0
ds_read_b128 a[68:71], v1 offset:17408
v_permlane16_swap_b32 v28, v30
v_mfma_f32_16x16x32_bf16 v[40:43], a[108:111], a[12:15], v[40:43]
s_cselect_b32 s12, s14, s12
v_max_f32 v28, v28, v30
v_mov_b32 v30, v28
v_mfma_f32_16x16x32_bf16 v[40:43], a[112:115], a[16:19], v[40:43]
s_cselect_b32 s13, s15, s13
ds_read_b128 a[72:75], v1 offset:18432
v_max3_f32 v29, v36, v37, v38
v_mfma_f32_16x16x32_bf16 v[40:43], a[116:119], a[20:23], v[40:43]
s_cselect_b32 s14, 3221225472, s14
v_permlane32_swap_b32 v28, v30
v_max_f32 v28, v28, v30
v_mfma_f32_16x16x32_bf16 v[40:43], a[120:123], a[24:27], v[40:43]
s_waitcnt lgkmcnt(3)
ds_read_b128 a[76:79], v1 offset:19456
v_sub_f32 v16, 0, v28
v_mfma_f32_16x16x32_bf16 v[40:43], a[124:127], a[28:31], v[40:43]
v_sub_f32 v17, 0, v28
v_sub_f32 v18, 0, v28
v_mfma_f32_16x16x32_bf16 v[44:47], a[96:99], a[32:35], 0
ds_read_b128 a[80:83], v1 offset:20480
v_sub_f32 v19, 0, v28
v_mfma_f32_16x16x32_bf16 v[44:47], a[100:103], a[36:39], v[44:47]
v_max_f32 v29, v29, v39
v_mov_b32 v31, v29
v_mfma_f32_16x16x32_bf16 v[44:47], a[104:107], a[40:43], v[44:47]
ds_read_b128 a[84:87], v1 offset:21504
v_mfma_f32_16x16x32_bf16 v[44:47], a[108:111], a[44:47], v[44:47]
v_permlane16_swap_b32 v29, v31
v_max_f32 v29, v29, v31
v_mfma_f32_16x16x32_bf16 v[44:47], a[112:115], a[48:51], v[44:47]
ds_read_b128 a[88:91], v1 offset:22528
v_mov_b32 v31, v29
v_mfma_f32_16x16x32_bf16 v[44:47], a[116:119], a[52:55], v[44:47]
v_mfma_f32_16x16x32_bf16 v[44:47], a[120:123], a[56:59], v[44:47]
ds_read_b128 a[92:95], v1 offset:23552
v_permlane32_swap_b32 v29, v31
v_mfma_f32_16x16x32_bf16 v[44:47], a[124:127], a[60:63], v[44:47]
s_waitcnt lgkmcnt(4)
v_max_f32 v29, v29, v31
v_sub_f32 v20, 0, v29
v_mfma_f32_16x16x32_bf16 v[48:51], a[64:67], a[0:3], v[16:19]
ds_read_b128 a[96:99], v1 offset:24576
v_sub_f32 v21, 0, v29
v_mfma_f32_16x16x32_bf16 v[48:51], a[68:71], a[4:7], v[48:51]
v_sub_f32 v22, 0, v29
v_sub_f32 v23, 0, v29
v_mfma_f32_16x16x32_bf16 v[48:51], a[72:75], a[8:11], v[48:51]
ds_read_b128 a[100:103], v1 offset:25600
v_mfma_f32_16x16x32_bf16 v[48:51], a[76:79], a[12:15], v[48:51]
s_waitcnt lgkmcnt(4)
v_mfma_f32_16x16x32_bf16 v[48:51], a[80:83], a[16:19], v[48:51]
ds_read_b128 a[104:107], v1 offset:26624
v_mfma_f32_16x16x32_bf16 v[48:51], a[84:87], a[20:23], v[48:51]
s_waitcnt lgkmcnt(4)
v_add_f32 v32, v32, v16
v_add_f32 v33, v33, v16
v_add_f32 v34, v34, v16
v_add_f32 v35, v35, v16
v_mfma_f32_16x16x32_bf16 v[48:51], a[88:91], a[24:27], v[48:51]
s_waitcnt lgkmcnt(3)
ds_read_b128 a[108:111], v1 offset:27648
v_add_f32 v36, v36, v20
v_add_f32 v37, v37, v20
v_add_f32 v38, v38, v20
v_add_f32 v39, v39, v20
v_mfma_f32_16x16x32_bf16 v[48:51], a[92:95], a[28:31], v[48:51]
v_add_f32 v40, v40, v16
v_add_f32 v41, v41, v16
v_add_f32 v42, v42, v16
v_add_f32 v43, v43, v16
v_mfma_f32_16x16x32_bf16 v[52:55], a[64:67], a[32:35], v[20:23]
ds_read_b128 a[112:115], v1 offset:28672
v_add_f32 v44, v44, v20
v_add_f32 v45, v45, v20
v_add_f32 v46, v46, v20
v_add_f32 v47, v47, v20
v_mfma_f32_16x16x32_bf16 v[52:55], a[68:71], a[36:39], v[52:55]
v_exp_f32 v8, v32
v_mfma_f32_16x16x32_bf16 v[52:55], a[72:75], a[40:43], v[52:55]
ds_read_b128 a[116:119], v1 offset:29696
v_exp_f32 v9, v33
v_mfma_f32_16x16x32_bf16 v[52:55], a[76:79], a[44:47], v[52:55]
v_exp_f32 v10, v34
v_add_f32 v26, v8, v9
v_cvt_pk_bf16_f32 v96, v8, v9
v_mfma_f32_16x16x32_bf16 v[52:55], a[80:83], a[48:51], v[52:55]
ds_read_b128 a[120:123], v1 offset:30720
v_exp_f32 v11, v35
v_add_f32 v26, v26, v10
v_mfma_f32_16x16x32_bf16 v[52:55], a[84:87], a[52:55], v[52:55]
v_exp_f32 v12, v36
v_add_f32 v26, v26, v11
v_cvt_pk_bf16_f32 v97, v10, v11
v_mfma_f32_16x16x32_bf16 v[52:55], a[88:91], a[56:59], v[52:55]
s_waitcnt vmcnt(8) lgkmcnt(4)
ds_read_b128 a[124:127], v1 offset:31744
v_exp_f32 v13, v37
v_mfma_f32_16x16x32_bf16 v[52:55], a[92:95], a[60:63], v[52:55]
s_barrier
v_mfma_f32_16x16x32_bf16 v[56:59], a[96:99], a[0:3], v[16:19]
ds_read_b128 a[64:67], v4 offset:0
v_exp_f32 v14, v38
v_mfma_f32_16x16x32_bf16 v[56:59], a[100:103], a[4:7], v[56:59]
buffer_store_dword v6, v5, s[4:7], s71 offen sc1
v_mfma_f32_16x16x32_bf16 v[56:59], a[104:107], a[8:11], v[56:59]
s_waitcnt lgkmcnt(4)
ds_read_b128 a[68:71], v4 offset:1024
v_add_f32 v27, v12, v13
v_cvt_pk_bf16_f32 v104, v12, v13
v_add_f32 v27, v27, v14
v_mfma_f32_16x16x32_bf16 v[56:59], a[108:111], a[12:15], v[56:59]
v_exp_f32 v15, v39
v_mfma_f32_16x16x32_bf16 v[56:59], a[112:115], a[16:19], v[56:59]
s_waitcnt lgkmcnt(4)
ds_read_b128 a[72:75], v4 offset:2048
v_exp_f32 v8, v40
v_add_f32 v27, v27, v15
v_cvt_pk_bf16_f32 v105, v14, v15
v_mfma_f32_16x16x32_bf16 v[56:59], a[116:119], a[20:23], v[56:59]
s_waitcnt lgkmcnt(4)
v_exp_f32 v9, v41
v_add_f32 v26, v26, v8
v_mfma_f32_16x16x32_bf16 v[56:59], a[120:123], a[24:27], v[56:59]
s_waitcnt lgkmcnt(3)
ds_read_b128 a[76:79], v4 offset:3072
v_exp_f32 v10, v42
v_add_f32 v26, v26, v9
v_cvt_pk_bf16_f32 v98, v8, v9
v_mfma_f32_16x16x32_bf16 v[56:59], a[124:127], a[28:31], v[56:59]
v_exp_f32 v11, v43
v_add_f32 v26, v26, v10
v_mfma_f32_16x16x32_bf16 v[60:63], a[96:99], a[32:35], v[20:23]
ds_read_b128 a[80:83], v4 offset:4096
v_exp_f32 v12, v44
v_mfma_f32_16x16x32_bf16 v[60:63], a[100:103], a[36:39], v[60:63]
v_exp_f32 v13, v45
v_mfma_f32_16x16x32_bf16 v[60:63], a[104:107], a[40:43], v[60:63]
ds_read_b128 a[84:87], v4 offset:5120
v_exp_f32 v14, v46
v_mfma_f32_16x16x32_bf16 v[60:63], a[108:111], a[44:47], v[60:63]
v_exp_f32 v15, v47
v_mfma_f32_16x16x32_bf16 v[60:63], a[112:115], a[48:51], v[60:63]
ds_read_b128 a[88:91], v4 offset:6144
v_add_f32 v26, v26, v11
v_cvt_pk_bf16_f32 v99, v10, v11
v_mfma_f32_16x16x32_bf16 v[60:63], a[116:119], a[52:55], v[60:63]
v_add_f32 v27, v27, v12
v_add_f32 v27, v27, v13
v_cvt_pk_bf16_f32 v106, v12, v13
v_mfma_f32_16x16x32_bf16 v[60:63], a[120:123], a[56:59], v[60:63]
s_waitcnt lgkmcnt(7)
s_barrier
ds_read_b128 a[92:95], v4 offset:7168
v_mfma_f32_16x16x32_bf16 v[60:63], a[124:127], a[60:63], v[60:63]
s_waitcnt lgkmcnt(4)
v_add_f32 v27, v27, v14
v_add_f32 v27, v27, v15
v_cvt_pk_bf16_f32 v107, v14, v15
K2_x1:
v_mfma_f32_16x16x32_bf16 v[64:67], a[64:67], a[0:3], v[16:19]
s_add_u32 m0, s18, 0
ds_read_b128 a[96:99], v4 offset:8192
v_mfma_f32_16x16x32_bf16 v[64:67], a[68:71], a[4:7], v[64:67]
s_waitcnt lgkmcnt(4)
buffer_load_dwordx4 v1, s[4:7], s8 offen offset:0 sc1 lds
v_mfma_f32_16x16x32_bf16 v[64:67], a[72:75], a[8:11], v[64:67]
ds_read_b128 a[100:103], v4 offset:9216
v_mfma_f32_16x16x32_bf16 v[64:67], a[76:79], a[12:15], v[64:67]
s_waitcnt lgkmcnt(4)
v_exp_f32 v8, v48
v_mfma_f32_16x16x32_bf16 v[64:67], a[80:83], a[16:19], v[64:67]
ds_read_b128 a[104:107], v4 offset:10240
v_add_f32 v26, v26, v8
v_mfma_f32_16x16x32_bf16 v[64:67], a[84:87], a[20:23], v[64:67]
s_waitcnt lgkmcnt(4)
buffer_load_dwordx4 v1, s[4:7], s8 offen offset:1024 sc1 lds
v_mfma_f32_16x16x32_bf16 v[64:67], a[88:91], a[24:27], v[64:67]
s_waitcnt lgkmcnt(3)
ds_read_b128 a[108:111], v4 offset:11264
v_mfma_f32_16x16x32_bf16 v[64:67], a[92:95], a[28:31], v[64:67]
v_exp_f32 v9, v49
v_mfma_f32_16x16x32_bf16 v[68:71], a[64:67], a[32:35], v[20:23]
ds_read_b128 a[112:115], v4 offset:12288
v_add_f32 v26, v26, v9
v_mfma_f32_16x16x32_bf16 v[68:71], a[68:71], a[36:39], v[68:71]
buffer_load_dwordx4 v1, s[4:7], s8 offen offset:2048 sc1 lds
v_mfma_f32_16x16x32_bf16 v[68:71], a[72:75], a[40:43], v[68:71]
ds_read_b128 a[116:119], v4 offset:13312
v_cvt_pk_bf16_f32 v100, v8, v9
v_mfma_f32_16x16x32_bf16 v[68:71], a[76:79], a[44:47], v[68:71]
v_exp_f32 v10, v50
v_mfma_f32_16x16x32_bf16 v[68:71], a[80:83], a[48:51], v[68:71]
ds_read_b128 a[120:123], v4 offset:14336
v_add_f32 v26, v26, v10
v_mfma_f32_16x16x32_bf16 v[68:71], a[84:87], a[52:55], v[68:71]
buffer_load_dwordx4 v1, s[4:7], s8 offen offset:3072 sc1 lds
v_mfma_f32_16x16x32_bf16 v[68:71], a[88:91], a[56:59], v[68:71]
s_add_u32 s8, s8, 4096
ds_read_b128 a[124:127], v4 offset:15360
v_mfma_f32_16x16x32_bf16 v[68:71], a[92:95], a[60:63], v[68:71]
s_waitcnt lgkmcnt(4)
v_exp_f32 v11, v51
v_mfma_f32_16x16x32_bf16 v[72:75], a[96:99], a[0:3], v[16:19]
s_add_u32 m0, s18, 4096
ds_read_b128 a[64:67], v4 offset:16384
v_add_f32 v26, v26, v11
v_mfma_f32_16x16x32_bf16 v[72:75], a[100:103], a[4:7], v[72:75]
buffer_load_dwordx4 v1, s[4:7], s8 offen offset:0 sc1 lds
v_mfma_f32_16x16x32_bf16 v[72:75], a[104:107], a[8:11], v[72:75]
ds_read_b128 a[68:71], v4 offset:17408
v_cvt_pk_bf16_f32 v101, v10, v11
v_mfma_f32_16x16x32_bf16 v[72:75], a[108:111], a[12:15], v[72:75]
s_waitcnt lgkmcnt(4)
v_mfma_f32_16x16x32_bf16 v[72:75], a[112:115], a[16:19], v[72:75]
ds_read_b128 a[72:75], v4 offset:18432
v_mfma_f32_16x16x32_bf16 v[72:75], a[116:119], a[20:23], v[72:75]
s_waitcnt lgkmcnt(4)
buffer_load_dwordx4 v1, s[4:7], s8 offen offset:1024 sc1 lds
v_mfma_f32_16x16x32_bf16 v[72:75], a[120:123], a[24:27], v[72:75]
s_waitcnt lgkmcnt(3)
ds_read_b128 a[76:79], v4 offset:19456
v_mfma_f32_16x16x32_bf16 v[72:75], a[124:127], a[28:31], v[72:75]
v_exp_f32 v12, v52
v_mfma_f32_16x16x32_bf16 v[76:79], a[96:99], a[32:35], v[20:23]
ds_read_b128 a[80:83], v4 offset:20480
v_add_f32 v27, v27, v12
v_mfma_f32_16x16x32_bf16 v[76:79], a[100:103], a[36:39], v[76:79]
buffer_load_dwordx4 v1, s[4:7], s8 offen offset:2048 sc1 lds
v_mfma_f32_16x16x32_bf16 v[76:79], a[104:107], a[40:43], v[76:79]
ds_read_b128 a[84:87], v4 offset:21504
v_mfma_f32_16x16x32_bf16 v[76:79], a[108:111], a[44:47], v[76:79]
v_exp_f32 v13, v53
v_mfma_f32_16x16x32_bf16 v[76:79], a[112:115], a[48:51], v[76:79]
ds_read_b128 a[88:91], v4 offset:22528
v_add_f32 v27, v27, v13
v_mfma_f32_16x16x32_bf16 v[76:79], a[116:119], a[52:55], v[76:79]
s_waitcnt lgkmcnt(3)
buffer_load_dwordx4 v1, s[4:7], s8 offen offset:3072 sc1 lds
v_mfma_f32_16x16x32_bf16 v[76:79], a[120:123], a[56:59], v[76:79]
s_add_u32 s8, s8, 28672
ds_read_b128 a[92:95], v4 offset:23552
v_cvt_pk_bf16_f32 v108, v12, v13
v_mfma_f32_16x16x32_bf16 v[76:79], a[124:127], a[60:63], v[76:79]
s_sub_u32 s9, s9, 1
v_exp_f32 v14, v54
v_mfma_f32_16x16x32_bf16 v[80:83], a[64:67], a[0:3], v[16:19]
s_cmp_eq_u32 s9, 0
ds_read_b128 a[96:99], v4 offset:24576
v_add_f32 v27, v27, v14
v_mfma_f32_16x16x32_bf16 v[80:83], a[68:71], a[4:7], v[80:83]
s_cselect_b32 s8, s10, s8
v_exp_f32 v15, v55
v_mfma_f32_16x16x32_bf16 v[80:83], a[72:75], a[8:11], v[80:83]
s_cselect_b32 s9, s11, s9
ds_read_b128 a[100:103], v4 offset:25600
v_add_f32 v27, v27, v15
v_mfma_f32_16x16x32_bf16 v[80:83], a[76:79], a[12:15], v[80:83]
s_waitcnt lgkmcnt(4)
s_cselect_b32 s10, 3221225472, s10
v_cvt_pk_bf16_f32 v109, v14, v15
v_mfma_f32_16x16x32_bf16 v[80:83], a[80:83], a[16:19], v[80:83]
ds_read_b128 a[104:107], v4 offset:26624
v_mfma_f32_16x16x32_bf16 v[80:83], a[84:87], a[20:23], v[80:83]
s_waitcnt lgkmcnt(4)
v_exp_f32 v8, v56
v_mfma_f32_16x16x32_bf16 v[80:83], a[88:91], a[24:27], v[80:83]
s_waitcnt lgkmcnt(3)
ds_read_b128 a[108:111], v4 offset:27648
v_add_f32 v26, v26, v8
v_mfma_f32_16x16x32_bf16 v[80:83], a[92:95], a[28:31], v[80:83]
v_exp_f32 v9, v57
v_mfma_f32_16x16x32_bf16 v[84:87], a[64:67], a[32:35], v[20:23]
ds_read_b128 a[112:115], v4 offset:28672
v_add_f32 v26, v26, v9
v_mfma_f32_16x16x32_bf16 v[84:87], a[68:71], a[36:39], v[84:87]
v_exp_f32 v10, v58
v_mfma_f32_16x16x32_bf16 v[84:87], a[72:75], a[40:43], v[84:87]
ds_read_b128 a[116:119], v4 offset:29696
v_cvt_pk_bf16_f32 v102, v8, v9
v_mfma_f32_16x16x32_bf16 v[84:87], a[76:79], a[44:47], v[84:87]
v_exp_f32 v11, v59
v_mfma_f32_16x16x32_bf16 v[84:87], a[80:83], a[48:51], v[84:87]
ds_read_b128 a[120:123], v4 offset:30720
v_add_f32 v26, v26, v10
v_mfma_f32_16x16x32_bf16 v[84:87], a[84:87], a[52:55], v[84:87]
v_add_f32 v26, v26, v11
v_cvt_pk_bf16_f32 v103, v10, v11
v_mfma_f32_16x16x32_bf16 v[84:87], a[88:91], a[56:59], v[84:87]
s_waitcnt vmcnt(8) lgkmcnt(4)
ds_read_b128 a[124:127], v4 offset:31744
v_mfma_f32_16x16x32_bf16 v[84:87], a[92:95], a[60:63], v[84:87]
s_barrier
v_mfma_f32_16x16x32_bf16 v[88:91], a[96:99], a[0:3], v[16:19]
ds_read_b128 a[64:67], v2 offset:0
v_mfma_f32_16x16x32_bf16 v[88:91], a[100:103], a[4:7], v[88:91]
v_exp_f32 v12, v60
v_mfma_f32_16x16x32_bf16 v[88:91], a[104:107], a[8:11], v[88:91]
s_waitcnt lgkmcnt(4)
ds_read_b128 a[68:71], v2 offset:1024
v_add_f32 v27, v27, v12
v_mfma_f32_16x16x32_bf16 v[88:91], a[108:111], a[12:15], v[88:91]
v_exp_f32 v13, v61
v_mfma_f32_16x16x32_bf16 v[88:91], a[112:115], a[16:19], v[88:91]
s_waitcnt lgkmcnt(4)
ds_read_b128 a[72:75], v2 offset:2048
v_add_f32 v27, v27, v13
v_mfma_f32_16x16x32_bf16 v[88:91], a[116:119], a[20:23], v[88:91]
s_waitcnt lgkmcnt(4)
v_exp_f32 v14, v62
v_mfma_f32_16x16x32_bf16 v[88:91], a[120:123], a[24:27], v[88:91]
s_waitcnt lgkmcnt(3)
ds_read_b128 a[76:79], v2 offset:3072
v_cvt_pk_bf16_f32 v110, v12, v13
v_mfma_f32_16x16x32_bf16 v[88:91], a[124:127], a[28:31], v[88:91]
v_exp_f32 v15, v63
v_mfma_f32_16x16x32_bf16 v[92:95], a[96:99], a[32:35], v[20:23]
s_sub_u32 s19, s19, 1
ds_read_b128 a[80:83], v2 offset:4096
v_add_f32 v27, v27, v14
v_mfma_f32_16x16x32_bf16 v[92:95], a[100:103], a[36:39], v[92:95]
v_add_f32 v27, v27, v15
v_cvt_pk_bf16_f32 v111, v14, v15
v_mfma_f32_16x16x32_bf16 v[92:95], a[104:107], a[40:43], v[92:95]
ds_read_b128 a[84:87], v2 offset:5120
v_add_f32 v28, v26, v27
v_mfma_f32_16x16x32_bf16 v[92:95], a[108:111], a[44:47], v[92:95]
v_cmp_nge_f32 vcc, s25, v28
v_mfma_f32_16x16x32_bf16 v[92:95], a[112:115], a[48:51], v[92:95]
s_cmp_eq_u64 vcc, 0
ds_read_b128 a[88:91], v2 offset:6144
v_mfma_f32_16x16x32_bf16 v[92:95], a[116:119], a[52:55], v[92:95]
s_cselect_b32 s22, s19, 0
v_mfma_f32_16x16x32_bf16 v[92:95], a[120:123], a[56:59], v[92:95]
s_cmp_eq_u32 s22, 0
ds_read_b128 a[92:95], v2 offset:7168
v_mfma_f32_16x16x32_bf16 v[92:95], a[124:127], a[60:63], v[92:95]
s_waitcnt lgkmcnt(4)
s_cbranch_scc1 K2_xexit
K2_loop:
v_mfma_f32_16x16x32_bf16 v[128:131], a[64:67], v[96:99], v[128:131]
s_add_u32 m0, s18, 98304
ds_read_b128 a[96:99], v2 offset:8192
v_add_f32 v24, v24, v26
v_mfma_f32_16x16x32_bf16 v[128:131], a[68:71], v[100:103], v[128:131]
buffer_load_dwordx4 v1, s[4:7], s12 offen offset:0 sc1 lds
v_mfma_f32_16x16x32_bf16 v[132:135], a[68:71], v[108:111], v[132:135]
ds_read_b128 a[100:103], v2 offset:9216
v_add_f32 v25, v25, v27
v_mfma_f32_16x16x32_bf16 v[132:135], a[64:67], v[104:107], v[132:135]
v_exp_f32 v8, v64
v_mfma_f32_16x16x32_bf16 v[136:139], a[72:75], v[96:99], v[136:139]
ds_read_b128 a[104:107], v2 offset:10240
v_mfma_f32_16x16x32_bf16 v[136:139], a[76:79], v[100:103], v[136:139]
buffer_load_dwordx4 v1, s[4:7], s12 offen offset:1024 sc1 lds
v_mfma_f32_16x16x32_bf16 v[140:143], a[76:79], v[108:111], v[140:143]
ds_read_b128 a[108:111], v2 offset:11264
v_mfma_f32_16x16x32_bf16 v[140:143], a[72:75], v[104:107], v[140:143]
s_waitcnt lgkmcnt(4)
v_exp_f32 v9, v65
v_mfma_f32_16x16x32_bf16 v[144:147], a[80:83], v[96:99], v[144:147]
ds_read_b128 a[112:115], v2 offset:12288
v_add_f32 v26, v8, v9
v_mfma_f32_16x16x32_bf16 v[144:147], a[84:87], v[100:103], v[144:147]
PAD_10:
s_cbranch_execz M_tret
buffer_load_dwordx4 v1, s[4:7], s12 offen offset:2048 sc1 lds
v_mfma_f32_16x16x32_bf16 v[148:151], a[84:87], v[108:111], v[148:151]
ds_read_b128 a[116:119], v2 offset:13312
v_cvt_pk_bf16_f32 v112, v8, v9
v_mfma_f32_16x16x32_bf16 v[148:151], a[80:83], v[104:107], v[148:151]
v_exp_f32 v10, v66
v_mfma_f32_16x16x32_bf16 v[152:155], a[88:91], v[96:99], v[152:155]
ds_read_b128 a[120:123], v2 offset:14336
v_add_f32 v26, v26, v10
v_mfma_f32_16x16x32_bf16 v[152:155], a[92:95], v[100:103], v[152:155]
buffer_load_dwordx4 v1, s[4:7], s12 offen offset:3072 sc1 lds
v_mfma_f32_16x16x32_bf16 v[156:159], a[92:95], v[108:111], v[156:159]
s_add_u32 s12, s12, 4096
ds_read_b128 a[124:127], v2 offset:15360
v_mfma_f32_16x16x32_bf16 v[156:159], a[88:91], v[104:107], v[156:159]
s_waitcnt lgkmcnt(4)
v_exp_f32 v11, v67
v_mfma_f32_16x16x32_bf16 v[160:163], a[96:99], v[96:99], v[160:163]
s_add_u32 m0, s18, 102400
ds_read_b128 a[64:67], v2 offset:16384
v_add_f32 v26, v26, v11
v_mfma_f32_16x16x32_bf16 v[160:163], a[100:103], v[100:103], v[160:163]
buffer_load_dwordx4 v1, s[4:7], s12 offen offset:0 sc1 lds
v_mfma_f32_16x16x32_bf16 v[164:167], a[100:103], v[108:111], v[164:167]
ds_read_b128 a[68:71], v2 offset:17408
v_cvt_pk_bf16_f32 v113, v10, v11
v_mfma_f32_16x16x32_bf16 v[164:167], a[96:99], v[104:107], v[164:167]
v_mfma_f32_16x16x32_bf16 v[168:171], a[104:107], v[96:99], v[168:171]
ds_read_b128 a[72:75], v2 offset:18432
v_mfma_f32_16x16x32_bf16 v[168:171], a[108:111], v[100:103], v[168:171]
buffer_load_dwordx4 v1, s[4:7], s12 offen offset:1024 sc1 lds
v_mfma_f32_16x16x32_bf16 v[172:175], a[108:111], v[108:111], v[172:175]
ds_read_b128 a[76:79], v2 offset:19456
v_mfma_f32_16x16x32_bf16 v[172:175], a[104:107], v[104:107], v[172:175]
s_waitcnt lgkmcnt(4)
v_exp_f32 v12, v68
v_mfma_f32_16x16x32_bf16 v[176:179], a[112:115], v[96:99], v[176:179]
ds_read_b128 a[80:83], v2 offset:20480
v_mfma_f32_16x16x32_bf16 v[176:179], a[116:119], v[100:103], v[176:179]
buffer_load_dwordx4 v1, s[4:7], s12 offen offset:2048 sc1 lds
v_mfma_f32_16x16x32_bf16 v[180:183], a[116:119], v[108:111], v[180:183]
ds_read_b128 a[84:87], v2 offset:21504
v_mfma_f32_16x16x32_bf16 v[180:183], a[112:115], v[104:107], v[180:183]
v_exp_f32 v13, v69
v_mfma_f32_16x16x32_bf16 v[184:187], a[120:123], v[96:99], v[184:187]
ds_read_b128 a[88:91], v2 offset:22528
v_add_f32 v27, v12, v13
v_mfma_f32_16x16x32_bf16 v[184:187], a[124:127], v[100:103], v[184:187]
s_waitcnt lgkmcnt(4)
buffer_load_dwordx4 v1, s[4:7], s12 offen offset:3072 sc1 lds
v_mfma_f32_16x16x32_bf16 v[188:191], a[124:127], v[108:111], v[188:191]
s_add_u32 s12, s12, 28672
ds_read_b128 a[92:95], v2 offset:23552
v_cvt_pk_bf16_f32 v120, v12, v13
v_mfma_f32_16x16x32_bf16 v[188:191], a[120:123], v[104:107], v[188:191]
s_sub_u32 s13, s13, 1
v_exp_f32 v14, v70
v_mfma_f32_16x16x32_bf16 v[192:195], a[64:67], v[96:99], v[192:195]
s_cmp_eq_u32 s13, 0
ds_read_b128 a[96:99], v2 offset:24576
v_add_f32 v27, v27, v14
v_mfma_f32_16x16x32_bf16 v[192:195], a[68:71], v[100:103], v[192:195]
s_cselect_b32 s12, s14, s12
v_mfma_f32_16x16x32_bf16 v[196:199], a[68:71], v[108:111], v[196:199]
s_cselect_b32 s13, s15, s13
ds_read_b128 a[100:103], v2 offset:25600
v_mfma_f32_16x16x32_bf16 v[196:199], a[64:67], v[104:107], v[196:199]
s_cselect_b32 s14, 3221225472, s14
v_exp_f32 v15, v71
v_mfma_f32_16x16x32_bf16 v[200:203], a[72:75], v[96:99], v[200:203]
s_waitcnt lgkmcnt(4)
ds_read_b128 a[104:107], v2 offset:26624
v_add_f32 v27, v27, v15
v_mfma_f32_16x16x32_bf16 v[200:203], a[76:79], v[100:103], v[200:203]
v_exp_f32 v8, v72
v_mfma_f32_16x16x32_bf16 v[204:207], a[76:79], v[108:111], v[204:207]
ds_read_b128 a[108:111], v2 offset:27648
v_cvt_pk_bf16_f32 v121, v14, v15
v_mfma_f32_16x16x32_bf16 v[204:207], a[72:75], v[104:107], v[204:207]
v_exp_f32 v9, v73
v_mfma_f32_16x16x32_bf16 v[208:211], a[80:83], v[96:99], v[208:211]
ds_read_b128 a[112:115], v2 offset:28672
v_add_f32 v26, v26, v8
v_mfma_f32_16x16x32_bf16 v[208:211], a[84:87], v[100:103], v[208:211]
v_add_f32 v26, v26, v9
v_cvt_pk_bf16_f32 v114, v8, v9
v_mfma_f32_16x16x32_bf16 v[212:215], a[84:87], v[108:111], v[212:215]
ds_read_b128 a[116:119], v2 offset:29696
v_mfma_f32_16x16x32_bf16 v[212:215], a[80:83], v[104:107], v[212:215]
s_waitcnt lgkmcnt(4)
v_exp_f32 v10, v74
v_mfma_f32_16x16x32_bf16 v[216:219], a[88:91], v[96:99], v[216:219]
ds_read_b128 a[120:123], v2 offset:30720
v_add_f32 v26, v26, v10
v_mfma_f32_16x16x32_bf16 v[216:219], a[92:95], v[100:103], v[216:219]
v_exp_f32 v11, v75
v_mfma_f32_16x16x32_bf16 v[220:223], a[92:95], v[108:111], v[220:223]
s_waitcnt vmcnt(8)
ds_read_b128 a[124:127], v2 offset:31744
v_add_f32 v26, v26, v11
v_mfma_f32_16x16x32_bf16 v[220:223], a[88:91], v[104:107], v[220:223]
s_barrier
v_mfma_f32_16x16x32_bf16 v[224:227], a[96:99], v[96:99], v[224:227]
ds_read_b128 a[64:67], v1 offset:0
v_cvt_pk_bf16_f32 v115, v10, v11
v_mfma_f32_16x16x32_bf16 v[224:227], a[100:103], v[100:103], v[224:227]
v_exp_f32 v12, v76
v_mfma_f32_16x16x32_bf16 v[228:231], a[100:103], v[108:111], v[228:231]
ds_read_b128 a[68:71], v1 offset:1024
v_add_f32 v27, v27, v12
v_mfma_f32_16x16x32_bf16 v[228:231], a[96:99], v[104:107], v[228:231]
s_waitcnt lgkmcnt(4)
v_mfma_f32_16x16x32_bf16 v[232:235], a[104:107], v[96:99], v[232:235]
ds_read_b128 a[72:75], v1 offset:2048
v_mfma_f32_16x16x32_bf16 v[232:235], a[108:111], v[100:103], v[232:235]
v_exp_f32 v13, v77
v_mfma_f32_16x16x32_bf16 v[236:239], a[108:111], v[108:111], v[236:239]
ds_read_b128 a[76:79], v1 offset:3072
v_add_f32 v27, v27, v13
v_mfma_f32_16x16x32_bf16 v[236:239], a[104:107], v[104:107], v[236:239]
v_exp_f32 v14, v78
v_mfma_f32_16x16x32_bf16 v[240:243], a[112:115], v[96:99], v[240:243]
ds_read_b128 a[80:83], v1 offset:4096
v_cvt_pk_bf16_f32 v122, v12, v13
v_mfma_f32_16x16x32_bf16 v[240:243], a[116:119], v[100:103], v[240:243]
v_exp_f32 v15, v79
v_mfma_f32_16x16x32_bf16 v[244:247], a[116:119], v[108:111], v[244:247]
ds_read_b128 a[84:87], v1 offset:5120
v_add_f32 v27, v27, v14
v_mfma_f32_16x16x32_bf16 v[244:247], a[112:115], v[104:107], v[244:247]
s_waitcnt lgkmcnt(4)
v_add_f32 v27, v27, v15
v_cvt_pk_bf16_f32 v123, v14, v15
v_mfma_f32_16x16x32_bf16 v[248:251], a[120:123], v[96:99], v[248:251]
ds_read_b128 a[88:91], v1 offset:6144
v_mfma_f32_16x16x32_bf16 v[248:251], a[124:127], v[100:103], v[248:251]
v_mfma_f32_16x16x32_bf16 v[252:255], a[124:127], v[108:111], v[252:255]
ds_read_b128 a[92:95], v1 offset:7168
v_mfma_f32_16x16x32_bf16 v[252:255], a[120:123], v[104:107], v[252:255]
K2_x0:
v_mfma_f32_16x16x32_bf16 v[32:35], a[64:67], a[0:3], v[16:19]
s_add_u32 m0, s18, 131072
ds_read_b128 a[96:99], v1 offset:8192
v_mfma_f32_16x16x32_bf16 v[32:35], a[68:71], a[4:7], v[32:35]
s_waitcnt lgkmcnt(4)
buffer_load_dwordx4 v1, s[4:7], s8 offen offset:0 sc1 lds
v_mfma_f32_16x16x32_bf16 v[32:35], a[72:75], a[8:11], v[32:35]
ds_read_b128 a[100:103], v1 offset:9216
v_mfma_f32_16x16x32_bf16 v[32:35], a[76:79], a[12:15], v[32:35]
v_exp_f32 v8, v80
v_mfma_f32_16x16x32_bf16 v[32:35], a[80:83], a[16:19], v[32:35]
s_waitcnt lgkmcnt(4)
ds_read_b128 a[104:107], v1 offset:10240
v_add_f32 v26, v26, v8
v_mfma_f32_16x16x32_bf16 v[32:35], a[84:87], a[20:23], v[32:35]
s_waitcnt lgkmcnt(4)
buffer_load_dwordx4 v1, s[4:7], s8 offen offset:1024 sc1 lds
v_mfma_f32_16x16x32_bf16 v[32:35], a[88:91], a[24:27], v[32:35]
s_waitcnt lgkmcnt(3)
ds_read_b128 a[108:111], v1 offset:11264
v_mfma_f32_16x16x32_bf16 v[32:35], a[92:95], a[28:31], v[32:35]
v_exp_f32 v9, v81
v_mfma_f32_16x16x32_bf16 v[36:39], a[64:67], a[32:35], v[20:23]
ds_read_b128 a[112:115], v1 offset:12288
v_add_f32 v26, v26, v9
v_mfma_f32_16x16x32_bf16 v[36:39], a[68:71], a[36:39], v[36:39]
buffer_load_dwordx4 v1, s[4:7], s8 offen offset:2048 sc1 lds
v_mfma_f32_16x16x32_bf16 v[36:39], a[72:75], a[40:43], v[36:39]
ds_read_b128 a[116:119], v1 offset:13312
v_cvt_pk_bf16_f32 v116, v8, v9
v_mfma_f32_16x16x32_bf16 v[36:39], a[76:79], a[44:47], v[36:39]
v_exp_f32 v10, v82
v_mfma_f32_16x16x32_bf16 v[36:39], a[80:83], a[48:51], v[36:39]
ds_read_b128 a[120:123], v1 offset:14336
v_add_f32 v26, v26, v10
v_mfma_f32_16x16x32_bf16 v[36:39], a[84:87], a[52:55], v[36:39]
buffer_load_dwordx4 v1, s[4:7], s8 offen offset:3072 sc1 lds
v_mfma_f32_16x16x32_bf16 v[36:39], a[88:91], a[56:59], v[36:39]
s_add_u32 s8, s8, 4096
ds_read_b128 a[124:127], v1 offset:15360
v_mfma_f32_16x16x32_bf16 v[36:39], a[92:95], a[60:63], v[36:39]
s_waitcnt lgkmcnt(4)
v_exp_f32 v11, v83
v_mfma_f32_16x16x32_bf16 v[40:43], a[96:99], a[0:3], v[16:19]
s_add_u32 m0, s18, 135168
ds_read_b128 a[64:67], v1 offset:16384
v_add_f32 v26, v26, v11
v_mfma_f32_16x16x32_bf16 v[40:43], a[100:103], a[4:7], v[40:43]
buffer_load_dwordx4 v1, s[4:7], s8 offen offset:0 sc1 lds
v_mfma_f32_16x16x32_bf16 v[40:43], a[104:107], a[8:11], v[40:43]
ds_read_b128 a[68:71], v1 offset:17408
v_cvt_pk_bf16_f32 v117, v10, v11
v_mfma_f32_16x16x32_bf16 v[40:43], a[108:111], a[12:15], v[40:43]
s_waitcnt lgkmcnt(4)
v_mfma_f32_16x16x32_bf16 v[40:43], a[112:115], a[16:19], v[40:43]
ds_read_b128 a[72:75], v1 offset:18432
v_mfma_f32_16x16x32_bf16 v[40:43], a[116:119], a[20:23], v[40:43]
s_waitcnt lgkmcnt(4)
buffer_load_dwordx4 v1, s[4:7], s8 offen offset:1024 sc1 lds
v_mfma_f32_16x16x32_bf16 v[40:43], a[120:123], a[24:27], v[40:43]
s_waitcnt lgkmcnt(3)
ds_read_b128 a[76:79], v1 offset:19456
v_mfma_f32_16x16x32_bf16 v[40:43], a[124:127], a[28:31], v[40:43]
v_exp_f32 v12, v84
v_mfma_f32_16x16x32_bf16 v[44:47], a[96:99], a[32:35], v[20:23]
ds_read_b128 a[80:83], v1 offset:20480
v_add_f32 v27, v27, v12
v_mfma_f32_16x16x32_bf16 v[44:47], a[100:103], a[36:39], v[44:47]
buffer_load_dwordx4 v1, s[4:7], s8 offen offset:2048 sc1 lds
v_mfma_f32_16x16x32_bf16 v[44:47], a[104:107], a[40:43], v[44:47]
ds_read_b128 a[84:87], v1 offset:21504
v_mfma_f32_16x16x32_bf16 v[44:47], a[108:111], a[44:47], v[44:47]
v_exp_f32 v13, v85
v_mfma_f32_16x16x32_bf16 v[44:47], a[112:115], a[48:51], v[44:47]
ds_read_b128 a[88:91], v1 offset:22528
v_add_f32 v27, v27, v13
v_mfma_f32_16x16x32_bf16 v[44:47], a[116:119], a[52:55], v[44:47]
s_waitcnt lgkmcnt(3)
buffer_load_dwordx4 v1, s[4:7], s8 offen offset:3072 sc1 lds
v_mfma_f32_16x16x32_bf16 v[44:47], a[120:123], a[56:59], v[44:47]
s_add_u32 s8, s8, 28672
ds_read_b128 a[92:95], v1 offset:23552
v_cvt_pk_bf16_f32 v124, v12, v13
v_mfma_f32_16x16x32_bf16 v[44:47], a[124:127], a[60:63], v[44:47]
s_sub_u32 s9, s9, 1
v_exp_f32 v14, v86
v_mfma_f32_16x16x32_bf16 v[48:51], a[64:67], a[0:3], v[16:19]
s_cmp_eq_u32 s9, 0
ds_read_b128 a[96:99], v1 offset:24576
v_add_f32 v27, v27, v14
v_mfma_f32_16x16x32_bf16 v[48:51], a[68:71], a[4:7], v[48:51]
s_cselect_b32 s8, s10, s8
v_exp_f32 v15, v87
v_mfma_f32_16x16x32_bf16 v[48:51], a[72:75], a[8:11], v[48:51]
s_cselect_b32 s9, s11, s9
ds_read_b128 a[100:103], v1 offset:25600
v_add_f32 v27, v27, v15
v_mfma_f32_16x16x32_bf16 v[48:51], a[76:79], a[12:15], v[48:51]
s_waitcnt lgkmcnt(4)
s_cselect_b32 s10, 3221225472, s10
v_cvt_pk_bf16_f32 v125, v14, v15
v_mfma_f32_16x16x32_bf16 v[48:51], a[80:83], a[16:19], v[48:51]
ds_read_b128 a[104:107], v1 offset:26624
v_mfma_f32_16x16x32_bf16 v[48:51], a[84:87], a[20:23], v[48:51]
s_waitcnt lgkmcnt(4)
v_exp_f32 v8, v88
v_mfma_f32_16x16x32_bf16 v[48:51], a[88:91], a[24:27], v[48:51]
s_waitcnt lgkmcnt(3)
ds_read_b128 a[108:111], v1 offset:27648
v_add_f32 v26, v26, v8
v_mfma_f32_16x16x32_bf16 v[48:51], a[92:95], a[28:31], v[48:51]
v_exp_f32 v9, v89
v_mfma_f32_16x16x32_bf16 v[52:55], a[64:67], a[32:35], v[20:23]
ds_read_b128 a[112:115], v1 offset:28672
v_add_f32 v26, v26, v9
v_mfma_f32_16x16x32_bf16 v[52:55], a[68:71], a[36:39], v[52:55]
v_exp_f32 v10, v90
v_mfma_f32_16x16x32_bf16 v[52:55], a[72:75], a[40:43], v[52:55]
ds_read_b128 a[116:119], v1 offset:29696
v_cvt_pk_bf16_f32 v118, v8, v9
v_mfma_f32_16x16x32_bf16 v[52:55], a[76:79], a[44:47], v[52:55]
v_exp_f32 v11, v91
v_mfma_f32_16x16x32_bf16 v[52:55], a[80:83], a[48:51], v[52:55]
ds_read_b128 a[120:123], v1 offset:30720
v_add_f32 v26, v26, v10
v_mfma_f32_16x16x32_bf16 v[52:55], a[84:87], a[52:55], v[52:55]
v_add_f32 v26, v26, v11
v_cvt_pk_bf16_f32 v119, v10, v11
v_mfma_f32_16x16x32_bf16 v[52:55], a[88:91], a[56:59], v[52:55]
s_waitcnt vmcnt(8) lgkmcnt(4)
ds_read_b128 a[124:127], v1 offset:31744
v_mfma_f32_16x16x32_bf16 v[52:55], a[92:95], a[60:63], v[52:55]
s_barrier
v_mfma_f32_16x16x32_bf16 v[56:59], a[96:99], a[0:3], v[16:19]
ds_read_b128 a[64:67], v2 offset:32768
v_mfma_f32_16x16x32_bf16 v[56:59], a[100:103], a[4:7], v[56:59]
v_exp_f32 v12, v92
v_mfma_f32_16x16x32_bf16 v[56:59], a[104:107], a[8:11], v[56:59]
s_waitcnt lgkmcnt(4)
ds_read_b128 a[68:71], v2 offset:33792
v_add_f32 v27, v27, v12
v_mfma_f32_16x16x32_bf16 v[56:59], a[108:111], a[12:15], v[56:59]
v_exp_f32 v13, v93
v_mfma_f32_16x16x32_bf16 v[56:59], a[112:115], a[16:19], v[56:59]
s_waitcnt lgkmcnt(4)
ds_read_b128 a[72:75], v2 offset:34816
v_add_f32 v27, v27, v13
v_mfma_f32_16x16x32_bf16 v[56:59], a[116:119], a[20:23], v[56:59]
s_waitcnt lgkmcnt(4)
v_exp_f32 v14, v94
v_mfma_f32_16x16x32_bf16 v[56:59], a[120:123], a[24:27], v[56:59]
s_waitcnt lgkmcnt(3)
ds_read_b128 a[76:79], v2 offset:35840
v_cvt_pk_bf16_f32 v126, v12, v13
v_mfma_f32_16x16x32_bf16 v[56:59], a[124:127], a[28:31], v[56:59]
v_exp_f32 v15, v95
v_mfma_f32_16x16x32_bf16 v[60:63], a[96:99], a[32:35], v[20:23]
ds_read_b128 a[80:83], v2 offset:36864
v_add_f32 v27, v27, v14
v_mfma_f32_16x16x32_bf16 v[60:63], a[100:103], a[36:39], v[60:63]
v_add_f32 v27, v27, v15
v_cvt_pk_bf16_f32 v127, v14, v15
v_mfma_f32_16x16x32_bf16 v[60:63], a[104:107], a[40:43], v[60:63]
ds_read_b128 a[84:87], v2 offset:37888
v_add_f32 v28, v26, v27
v_mfma_f32_16x16x32_bf16 v[60:63], a[108:111], a[44:47], v[60:63]
v_cmp_nge_f32 vcc, s25, v28
v_mfma_f32_16x16x32_bf16 v[60:63], a[112:115], a[48:51], v[60:63]
ds_read_b128 a[88:91], v2 offset:38912
v_mfma_f32_16x16x32_bf16 v[60:63], a[116:119], a[52:55], v[60:63]
v_mfma_f32_16x16x32_bf16 v[60:63], a[120:123], a[56:59], v[60:63]
ds_read_b128 a[92:95], v2 offset:39936
v_mfma_f32_16x16x32_bf16 v[60:63], a[124:127], a[60:63], v[60:63]
s_waitcnt lgkmcnt(4)
s_cbranch_vccnz Lstub_2
Lback_3:
v_mfma_f32_16x16x32_bf16 v[128:131], a[64:67], v[112:115], v[128:131]
s_add_u32 m0, s18, 65536
ds_read_b128 a[96:99], v2 offset:40960
v_add_f32 v24, v24, v26
v_mfma_f32_16x16x32_bf16 v[128:131], a[68:71], v[116:119], v[128:131]
buffer_load_dwordx4 v1, s[4:7], s12 offen offset:0 sc1 lds
v_mfma_f32_16x16x32_bf16 v[132:135], a[68:71], v[124:127], v[132:135]
ds_read_b128 a[100:103], v2 offset:41984
v_add_f32 v25, v25, v27
v_mfma_f32_16x16x32_bf16 v[132:135], a[64:67], v[120:123], v[132:135]
v_exp_f32 v8, v32
v_mfma_f32_16x16x32_bf16 v[136:139], a[72:75], v[112:115], v[136:139]
ds_read_b128 a[104:107], v2 offset:43008
v_mfma_f32_16x16x32_bf16 v[136:139], a[76:79], v[116:119], v[136:139]
buffer_load_dwordx4 v1, s[4:7], s12 offen offset:1024 sc1 lds
v_mfma_f32_16x16x32_bf16 v[140:143], a[76:79], v[124:127], v[140:143]
ds_read_b128 a[108:111], v2 offset:44032
v_mfma_f32_16x16x32_bf16 v[140:143], a[72:75], v[120:123], v[140:143]
s_waitcnt lgkmcnt(4)
v_exp_f32 v9, v33
v_mfma_f32_16x16x32_bf16 v[144:147], a[80:83], v[112:115], v[144:147]
ds_read_b128 a[112:115], v2 offset:45056
v_add_f32 v26, v8, v9
v_mfma_f32_16x16x32_bf16 v[144:147], a[84:87], v[116:119], v[144:147]
buffer_load_dwordx4 v1, s[4:7], s12 offen offset:2048 sc1 lds
v_mfma_f32_16x16x32_bf16 v[148:151], a[84:87], v[124:127], v[148:151]
ds_read_b128 a[116:119], v2 offset:46080
v_cvt_pk_bf16_f32 v96, v8, v9
v_mfma_f32_16x16x32_bf16 v[148:151], a[80:83], v[120:123], v[148:151]
v_exp_f32 v10, v34
v_mfma_f32_16x16x32_bf16 v[152:155], a[88:91], v[112:115], v[152:155]
ds_read_b128 a[120:123], v2 offset:47104
v_add_f32 v26, v26, v10
v_mfma_f32_16x16x32_bf16 v[152:155], a[92:95], v[116:119], v[152:155]
buffer_load_dwordx4 v1, s[4:7], s12 offen offset:3072 sc1 lds
v_mfma_f32_16x16x32_bf16 v[156:159], a[92:95], v[124:127], v[156:159]
s_add_u32 s12, s12, 4096
ds_read_b128 a[124:127], v2 offset:48128
v_mfma_f32_16x16x32_bf16 v[156:159], a[88:91], v[120:123], v[156:159]
s_waitcnt lgkmcnt(4)
v_exp_f32 v11, v35
v_mfma_f32_16x16x32_bf16 v[160:163], a[96:99], v[112:115], v[160:163]
s_add_u32 m0, s18, 69632
ds_read_b128 a[64:67], v2 offset:49152
v_add_f32 v26, v26, v11
v_mfma_f32_16x16x32_bf16 v[160:163], a[100:103], v[116:119], v[160:163]
buffer_load_dwordx4 v1, s[4:7], s12 offen offset:0 sc1 lds
v_mfma_f32_16x16x32_bf16 v[164:167], a[100:103], v[124:127], v[164:167]
ds_read_b128 a[68:71], v2 offset:50176
v_cvt_pk_bf16_f32 v97, v10, v11
v_mfma_f32_16x16x32_bf16 v[164:167], a[96:99], v[120:123], v[164:167]
v_mfma_f32_16x16x32_bf16 v[168:171], a[104:107], v[112:115], v[168:171]
ds_read_b128 a[72:75], v2 offset:51200
v_mfma_f32_16x16x32_bf16 v[168:171], a[108:111], v[116:119], v[168:171]
buffer_load_dwordx4 v1, s[4:7], s12 offen offset:1024 sc1 lds
v_mfma_f32_16x16x32_bf16 v[172:175], a[108:111], v[124:127], v[172:175]
ds_read_b128 a[76:79], v2 offset:52224
v_mfma_f32_16x16x32_bf16 v[172:175], a[104:107], v[120:123], v[172:175]
s_waitcnt lgkmcnt(4)
v_exp_f32 v12, v36
v_mfma_f32_16x16x32_bf16 v[176:179], a[112:115], v[112:115], v[176:179]
ds_read_b128 a[80:83], v2 offset:53248
v_mfma_f32_16x16x32_bf16 v[176:179], a[116:119], v[116:119], v[176:179]
buffer_load_dwordx4 v1, s[4:7], s12 offen offset:2048 sc1 lds
v_mfma_f32_16x16x32_bf16 v[180:183], a[116:119], v[124:127], v[180:183]
ds_read_b128 a[84:87], v2 offset:54272
v_mfma_f32_16x16x32_bf16 v[180:183], a[112:115], v[120:123], v[180:183]
v_exp_f32 v13, v37
v_mfma_f32_16x16x32_bf16 v[184:187], a[120:123], v[112:115], v[184:187]
ds_read_b128 a[88:91], v2 offset:55296
v_add_f32 v27, v12, v13
v_mfma_f32_16x16x32_bf16 v[184:187], a[124:127], v[116:119], v[184:187]
s_waitcnt lgkmcnt(4)
buffer_load_dwordx4 v1, s[4:7], s12 offen offset:3072 sc1 lds
v_mfma_f32_16x16x32_bf16 v[188:191], a[124:127], v[124:127], v[188:191]
s_add_u32 s12, s12, 28672
ds_read_b128 a[92:95], v2 offset:56320
v_cvt_pk_bf16_f32 v104, v12, v13
v_mfma_f32_16x16x32_bf16 v[188:191], a[120:123], v[120:123], v[188:191]
s_sub_u32 s13, s13, 1
v_exp_f32 v14, v38
v_mfma_f32_16x16x32_bf16 v[192:195], a[64:67], v[112:115], v[192:195]
s_cmp_eq_u32 s13, 0
ds_read_b128 a[96:99], v2 offset:57344
v_add_f32 v27, v27, v14
v_mfma_f32_16x16x32_bf16 v[192:195], a[68:71], v[116:119], v[192:195]
s_cselect_b32 s12, s14, s12
v_mfma_f32_16x16x32_bf16 v[196:199], a[68:71], v[124:127], v[196:199]
s_cselect_b32 s13, s15, s13
ds_read_b128 a[100:103], v2 offset:58368
v_mfma_f32_16x16x32_bf16 v[196:199], a[64:67], v[120:123], v[196:199]
s_cselect_b32 s14, 3221225472, s14
v_exp_f32 v15, v39
v_mfma_f32_16x16x32_bf16 v[200:203], a[72:75], v[112:115], v[200:203]
s_waitcnt lgkmcnt(4)
ds_read_b128 a[104:107], v2 offset:59392
v_add_f32 v27, v27, v15
v_mfma_f32_16x16x32_bf16 v[200:203], a[76:79], v[116:119], v[200:203]
v_exp_f32 v8, v40
v_mfma_f32_16x16x32_bf16 v[204:207], a[76:79], v[124:127], v[204:207]
ds_read_b128 a[108:111], v2 offset:60416
v_cvt_pk_bf16_f32 v105, v14, v15
v_mfma_f32_16x16x32_bf16 v[204:207], a[72:75], v[120:123], v[204:207]
v_exp_f32 v9, v41
v_mfma_f32_16x16x32_bf16 v[208:211], a[80:83], v[112:115], v[208:211]
ds_read_b128 a[112:115], v2 offset:61440
v_add_f32 v26, v26, v8
v_mfma_f32_16x16x32_bf16 v[208:211], a[84:87], v[116:119], v[208:211]
v_add_f32 v26, v26, v9
v_cvt_pk_bf16_f32 v98, v8, v9
v_mfma_f32_16x16x32_bf16 v[212:215], a[84:87], v[124:127], v[212:215]
ds_read_b128 a[116:119], v2 offset:62464
v_mfma_f32_16x16x32_bf16 v[212:215], a[80:83], v[120:123], v[212:215]
s_waitcnt lgkmcnt(4)
v_exp_f32 v10, v42
v_mfma_f32_16x16x32_bf16 v[216:219], a[88:91], v[112:115], v[216:219]
ds_read_b128 a[120:123], v2 offset:63488
v_add_f32 v26, v26, v10
v_mfma_f32_16x16x32_bf16 v[216:219], a[92:95], v[116:119], v[216:219]
v_exp_f32 v11, v43
v_mfma_f32_16x16x32_bf16 v[220:223], a[92:95], v[124:127], v[220:223]
s_waitcnt vmcnt(8)
ds_read_b128 a[124:127], v2 offset:64512
v_add_f32 v26, v26, v11
v_mfma_f32_16x16x32_bf16 v[220:223], a[88:91], v[120:123], v[220:223]
s_barrier
v_mfma_f32_16x16x32_bf16 v[224:227], a[96:99], v[112:115], v[224:227]
ds_read_b128 a[64:67], v4 offset:0
v_cvt_pk_bf16_f32 v99, v10, v11
v_mfma_f32_16x16x32_bf16 v[224:227], a[100:103], v[116:119], v[224:227]
v_exp_f32 v12, v44
v_mfma_f32_16x16x32_bf16 v[228:231], a[100:103], v[124:127], v[228:231]
ds_read_b128 a[68:71], v4 offset:1024
v_add_f32 v27, v27, v12
v_mfma_f32_16x16x32_bf16 v[228:231], a[96:99], v[120:123], v[228:231]
s_waitcnt lgkmcnt(4)
v_mfma_f32_16x16x32_bf16 v[232:235], a[104:107], v[112:115], v[232:235]
ds_read_b128 a[72:75], v4 offset:2048
v_mfma_f32_16x16x32_bf16 v[232:235], a[108:111], v[116:119], v[232:235]
v_exp_f32 v13, v45
v_mfma_f32_16x16x32_bf16 v[236:239], a[108:111], v[124:127], v[236:239]
ds_read_b128 a[76:79], v4 offset:3072
v_add_f32 v27, v27, v13
v_mfma_f32_16x16x32_bf16 v[236:239], a[104:107], v[120:123], v[236:239]
v_exp_f32 v14, v46
v_mfma_f32_16x16x32_bf16 v[240:243], a[112:115], v[112:115], v[240:243]
ds_read_b128 a[80:83], v4 offset:4096
v_cvt_pk_bf16_f32 v106, v12, v13
v_mfma_f32_16x16x32_bf16 v[240:243], a[116:119], v[116:119], v[240:243]
v_exp_f32 v15, v47
v_mfma_f32_16x16x32_bf16 v[244:247], a[116:119], v[124:127], v[244:247]
ds_read_b128 a[84:87], v4 offset:5120
v_add_f32 v27, v27, v14
v_mfma_f32_16x16x32_bf16 v[244:247], a[112:115], v[120:123], v[244:247]
s_waitcnt lgkmcnt(4)
v_add_f32 v27, v27, v15
v_cvt_pk_bf16_f32 v107, v14, v15
v_mfma_f32_16x16x32_bf16 v[248:251], a[120:123], v[112:115], v[248:251]
ds_read_b128 a[88:91], v4 offset:6144
v_mfma_f32_16x16x32_bf16 v[248:251], a[124:127], v[116:119], v[248:251]
v_mfma_f32_16x16x32_bf16 v[252:255], a[124:127], v[124:127], v[252:255]
s_waitcnt lgkmcnt(5)
ds_read_b128 a[92:95], v4 offset:7168
v_mfma_f32_16x16x32_bf16 v[252:255], a[120:123], v[120:123], v[252:255]
s_branch K2_x1
K2_xexit:
s_cbranch_vccnz Lstub_4
Lback_5:
s_cmp_lg_u32 s19, 0
s_cbranch_scc1 K2_loop
s_cmp_eq_u32 s24, 2
s_cbranch_scc1 K2_ntail
v_mfma_f32_16x16x32_bf16 v[128:131], a[64:67], v[96:99], v[128:131]
s_add_u32 m0, s18, 98304
ds_read_b128 a[96:99], v2 offset:8192
v_add_f32 v24, v24, v26
v_mfma_f32_16x16x32_bf16 v[128:131], a[68:71], v[100:103], v[128:131]
buffer_load_dwordx4 v1, s[4:7], s12 offen offset:0 sc1 lds
v_mfma_f32_16x16x32_bf16 v[132:135], a[68:71], v[108:111], v[132:135]
ds_read_b128 a[100:103], v2 offset:9216
v_add_f32 v25, v25, v27
v_mfma_f32_16x16x32_bf16 v[132:135], a[64:67], v[104:107], v[132:135]
v_exp_f32 v8, v64
v_mfma_f32_16x16x32_bf16 v[136:139], a[72:75], v[96:99], v[136:139]
ds_read_b128 a[104:107], v2 offset:10240
v_mfma_f32_16x16x32_bf16 v[136:139], a[76:79], v[100:103], v[136:139]
buffer_load_dwordx4 v1, s[4:7], s12 offen offset:1024 sc1 lds
v_mfma_f32_16x16x32_bf16 v[140:143], a[76:79], v[108:111], v[140:143]
ds_read_b128 a[108:111], v2 offset:11264
v_mfma_f32_16x16x32_bf16 v[140:143], a[72:75], v[104:107], v[140:143]
s_waitcnt lgkmcnt(4)
v_exp_f32 v9, v65
v_mfma_f32_16x16x32_bf16 v[144:147], a[80:83], v[96:99], v[144:147]
ds_read_b128 a[112:115], v2 offset:12288
v_add_f32 v26, v8, v9
v_mfma_f32_16x16x32_bf16 v[144:147], a[84:87], v[100:103], v[144:147]
buffer_load_dwordx4 v1, s[4:7], s12 offen offset:2048 sc1 lds
v_mfma_f32_16x16x32_bf16 v[148:151], a[84:87], v[108:111], v[148:151]
ds_read_b128 a[116:119], v2 offset:13312
v_cvt_pk_bf16_f32 v112, v8, v9
v_mfma_f32_16x16x32_bf16 v[148:151], a[80:83], v[104:107], v[148:151]
v_exp_f32 v10, v66
v_mfma_f32_16x16x32_bf16 v[152:155], a[88:91], v[96:99], v[152:155]
ds_read_b128 a[120:123], v2 offset:14336
v_add_f32 v26, v26, v10
v_mfma_f32_16x16x32_bf16 v[152:155], a[92:95], v[100:103], v[152:155]
buffer_load_dwordx4 v1, s[4:7], s12 offen offset:3072 sc1 lds
v_mfma_f32_16x16x32_bf16 v[156:159], a[92:95], v[108:111], v[156:159]
s_add_u32 s12, s12, 4096
ds_read_b128 a[124:127], v2 offset:15360
v_mfma_f32_16x16x32_bf16 v[156:159], a[88:91], v[104:107], v[156:159]
s_waitcnt lgkmcnt(4)
v_exp_f32 v11, v67
v_mfma_f32_16x16x32_bf16 v[160:163], a[96:99], v[96:99], v[160:163]
s_add_u32 m0, s18, 102400
ds_read_b128 a[64:67], v2 offset:16384
v_add_f32 v26, v26, v11
v_mfma_f32_16x16x32_bf16 v[160:163], a[100:103], v[100:103], v[160:163]
buffer_load_dwordx4 v1, s[4:7], s12 offen offset:0 sc1 lds
v_mfma_f32_16x16x32_bf16 v[164:167], a[100:103], v[108:111], v[164:167]
ds_read_b128 a[68:71], v2 offset:17408
v_cvt_pk_bf16_f32 v113, v10, v11
v_mfma_f32_16x16x32_bf16 v[164:167], a[96:99], v[104:107], v[164:167]
v_mfma_f32_16x16x32_bf16 v[168:171], a[104:107], v[96:99], v[168:171]
ds_read_b128 a[72:75], v2 offset:18432
v_mfma_f32_16x16x32_bf16 v[168:171], a[108:111], v[100:103], v[168:171]
buffer_load_dwordx4 v1, s[4:7], s12 offen offset:1024 sc1 lds
v_mfma_f32_16x16x32_bf16 v[172:175], a[108:111], v[108:111], v[172:175]
ds_read_b128 a[76:79], v2 offset:19456
v_mfma_f32_16x16x32_bf16 v[172:175], a[104:107], v[104:107], v[172:175]
s_waitcnt lgkmcnt(4)
v_exp_f32 v12, v68
v_mfma_f32_16x16x32_bf16 v[176:179], a[112:115], v[96:99], v[176:179]
ds_read_b128 a[80:83], v2 offset:20480
v_mfma_f32_16x16x32_bf16 v[176:179], a[116:119], v[100:103], v[176:179]
buffer_load_dwordx4 v1, s[4:7], s12 offen offset:2048 sc1 lds
v_mfma_f32_16x16x32_bf16 v[180:183], a[116:119], v[108:111], v[180:183]
ds_read_b128 a[84:87], v2 offset:21504
v_mfma_f32_16x16x32_bf16 v[180:183], a[112:115], v[104:107], v[180:183]
v_exp_f32 v13, v69
v_mfma_f32_16x16x32_bf16 v[184:187], a[120:123], v[96:99], v[184:187]
ds_read_b128 a[88:91], v2 offset:22528
v_add_f32 v27, v12, v13
v_mfma_f32_16x16x32_bf16 v[184:187], a[124:127], v[100:103], v[184:187]
s_waitcnt lgkmcnt(4)
buffer_load_dwordx4 v1, s[4:7], s12 offen offset:3072 sc1 lds
v_mfma_f32_16x16x32_bf16 v[188:191], a[124:127], v[108:111], v[188:191]
s_add_u32 s12, s12, 28672
ds_read_b128 a[92:95], v2 offset:23552
v_cvt_pk_bf16_f32 v120, v12, v13
v_mfma_f32_16x16x32_bf16 v[188:191], a[120:123], v[104:107], v[188:191]
s_sub_u32 s13, s13, 1
v_exp_f32 v14, v70
v_mfma_f32_16x16x32_bf16 v[192:195], a[64:67], v[96:99], v[192:195]
s_cmp_eq_u32 s13, 0
ds_read_b128 a[96:99], v2 offset:24576
v_add_f32 v27, v27, v14
v_mfma_f32_16x16x32_bf16 v[192:195], a[68:71], v[100:103], v[192:195]
s_cselect_b32 s12, s14, s12
v_mfma_f32_16x16x32_bf16 v[196:199], a[68:71], v[108:111], v[196:199]
s_cselect_b32 s13, s15, s13
ds_read_b128 a[100:103], v2 offset:25600
v_mfma_f32_16x16x32_bf16 v[196:199], a[64:67], v[104:107], v[196:199]
s_cselect_b32 s14, 3221225472, s14
v_exp_f32 v15, v71
v_mfma_f32_16x16x32_bf16 v[200:203], a[72:75], v[96:99], v[200:203]
s_waitcnt lgkmcnt(4)
ds_read_b128 a[104:107], v2 offset:26624
v_add_f32 v27, v27, v15
v_mfma_f32_16x16x32_bf16 v[200:203], a[76:79], v[100:103], v[200:203]
v_exp_f32 v8, v72
v_mfma_f32_16x16x32_bf16 v[204:207], a[76:79], v[108:111], v[204:207]
ds_read_b128 a[108:111], v2 offset:27648
v_cvt_pk_bf16_f32 v121, v14, v15
v_mfma_f32_16x16x32_bf16 v[204:207], a[72:75], v[104:107], v[204:207]
v_exp_f32 v9, v73
v_mfma_f32_16x16x32_bf16 v[208:211], a[80:83], v[96:99], v[208:211]
ds_read_b128 a[112:115], v2 offset:28672
v_add_f32 v26, v26, v8
v_mfma_f32_16x16x32_bf16 v[208:211], a[84:87], v[100:103], v[208:211]
v_add_f32 v26, v26, v9
v_cvt_pk_bf16_f32 v114, v8, v9
v_mfma_f32_16x16x32_bf16 v[212:215], a[84:87], v[108:111], v[212:215]
ds_read_b128 a[116:119], v2 offset:29696
v_mfma_f32_16x16x32_bf16 v[212:215], a[80:83], v[104:107], v[212:215]
s_waitcnt lgkmcnt(4)
v_exp_f32 v10, v74
v_mfma_f32_16x16x32_bf16 v[216:219], a[88:91], v[96:99], v[216:219]
ds_read_b128 a[120:123], v2 offset:30720
v_add_f32 v26, v26, v10
v_mfma_f32_16x16x32_bf16 v[216:219], a[92:95], v[100:103], v[216:219]
v_exp_f32 v11, v75
v_mfma_f32_16x16x32_bf16 v[220:223], a[92:95], v[108:111], v[220:223]
s_waitcnt vmcnt(8)
ds_read_b128 a[124:127], v2 offset:31744
v_add_f32 v26, v26, v11
v_mfma_f32_16x16x32_bf16 v[220:223], a[88:91], v[104:107], v[220:223]
PAD_11:
s_cbranch_execz M_tret
s_barrier
v_mfma_f32_16x16x32_bf16 v[224:227], a[96:99], v[96:99], v[224:227]
ds_read_b128 a[64:67], v1 offset:0
v_cvt_pk_bf16_f32 v115, v10, v11
v_mfma_f32_16x16x32_bf16 v[224:227], a[100:103], v[100:103], v[224:227]
v_exp_f32 v12, v76
v_mfma_f32_16x16x32_bf16 v[228:231], a[100:103], v[108:111], v[228:231]
ds_read_b128 a[68:71], v1 offset:1024
v_add_f32 v27, v27, v12
v_mfma_f32_16x16x32_bf16 v[228:231], a[96:99], v[104:107], v[228:231]
s_waitcnt lgkmcnt(4)
v_mfma_f32_16x16x32_bf16 v[232:235], a[104:107], v[96:99], v[232:235]
ds_read_b128 a[72:75], v1 offset:2048
v_mfma_f32_16x16x32_bf16 v[232:235], a[108:111], v[100:103], v[232:235]
v_exp_f32 v13, v77
v_mfma_f32_16x16x32_bf16 v[236:239], a[108:111], v[108:111], v[236:239]
ds_read_b128 a[76:79], v1 offset:3072
v_add_f32 v27, v27, v13
v_mfma_f32_16x16x32_bf16 v[236:239], a[104:107], v[104:107], v[236:239]
v_exp_f32 v14, v78
v_mfma_f32_16x16x32_bf16 v[240:243], a[112:115], v[96:99], v[240:243]
ds_read_b128 a[80:83], v1 offset:4096
v_cvt_pk_bf16_f32 v122, v12, v13
v_mfma_f32_16x16x32_bf16 v[240:243], a[116:119], v[100:103], v[240:243]
v_exp_f32 v15, v79
v_mfma_f32_16x16x32_bf16 v[244:247], a[116:119], v[108:111], v[244:247]
ds_read_b128 a[84:87], v1 offset:5120
v_add_f32 v27, v27, v14
v_mfma_f32_16x16x32_bf16 v[244:247], a[112:115], v[104:107], v[244:247]
s_waitcnt lgkmcnt(4)
v_add_f32 v27, v27, v15
v_cvt_pk_bf16_f32 v123, v14, v15
v_mfma_f32_16x16x32_bf16 v[248:251], a[120:123], v[96:99], v[248:251]
ds_read_b128 a[88:91], v1 offset:6144
v_mfma_f32_16x16x32_bf16 v[248:251], a[124:127], v[100:103], v[248:251]
v_mfma_f32_16x16x32_bf16 v[252:255], a[124:127], v[108:111], v[252:255]
ds_read_b128 a[92:95], v1 offset:7168
v_mfma_f32_16x16x32_bf16 v[252:255], a[120:123], v[104:107], v[252:255]
v_cndmask_b32 v32, v16, v7, s[32:33]
v_cndmask_b32 v33, v16, v7, s[34:35]
v_cndmask_b32 v34, v16, v7, s[36:37]
v_cndmask_b32 v35, v16, v7, s[38:39]
s_nop 1
v_mfma_f32_16x16x32_bf16 v[32:35], a[64:67], a[0:3], v[32:35]
s_add_u32 m0, s18, 131072
ds_read_b128 a[96:99], v1 offset:8192
v_cndmask_b32 v40, v16, v7, s[40:41]
v_mfma_f32_16x16x32_bf16 v[32:35], a[68:71], a[4:7], v[32:35]
s_waitcnt lgkmcnt(4)
buffer_load_dwordx4 v1, s[4:7], s8 offen offset:0 sc1 lds
v_mfma_f32_16x16x32_bf16 v[32:35], a[72:75], a[8:11], v[32:35]
ds_read_b128 a[100:103], v1 offset:9216
v_cndmask_b32 v41, v16, v7, s[42:43]
v_mfma_f32_16x16x32_bf16 v[32:35], a[76:79], a[12:15], v[32:35]
v_cndmask_b32 v42, v16, v7, s[44:45]
v_cndmask_b32 v43, v16, v7, s[46:47]
v_mfma_f32_16x16x32_bf16 v[32:35], a[80:83], a[16:19], v[32:35]
s_waitcnt lgkmcnt(4)
ds_read_b128 a[104:107], v1 offset:10240
v_mfma_f32_16x16x32_bf16 v[32:35], a[84:87], a[20:23], v[32:35]
s_waitcnt lgkmcnt(4)
buffer_load_dwordx4 v1, s[4:7], s8 offen offset:1024 sc1 lds
v_mfma_f32_16x16x32_bf16 v[32:35], a[88:91], a[24:27], v[32:35]
s_waitcnt lgkmcnt(3)
ds_read_b128 a[108:111], v1 offset:11264
v_mfma_f32_16x16x32_bf16 v[32:35], a[92:95], a[28:31], v[32:35]
v_exp_f32 v8, v80
v_mfma_f32_16x16x32_bf16 v[36:39], a[64:67], a[32:35], v[20:23]
ds_read_b128 a[112:115], v1 offset:12288
v_add_f32 v26, v26, v8
v_mfma_f32_16x16x32_bf16 v[36:39], a[68:71], a[36:39], v[36:39]
buffer_load_dwordx4 v1, s[4:7], s8 offen offset:2048 sc1 lds
v_mfma_f32_16x16x32_bf16 v[36:39], a[72:75], a[40:43], v[36:39]
ds_read_b128 a[116:119], v1 offset:13312
v_mfma_f32_16x16x32_bf16 v[36:39], a[76:79], a[44:47], v[36:39]
v_exp_f32 v9, v81
v_mfma_f32_16x16x32_bf16 v[36:39], a[80:83], a[48:51], v[36:39]
ds_read_b128 a[120:123], v1 offset:14336
v_add_f32 v26, v26, v9
v_mfma_f32_16x16x32_bf16 v[36:39], a[84:87], a[52:55], v[36:39]
buffer_load_dwordx4 v1, s[4:7], s8 offen offset:3072 sc1 lds
v_mfma_f32_16x16x32_bf16 v[36:39], a[88:91], a[56:59], v[36:39]
s_add_u32 s8, s8, 4096
ds_read_b128 a[124:127], v1 offset:15360
v_cvt_pk_bf16_f32 v116, v8, v9
v_mfma_f32_16x16x32_bf16 v[36:39], a[92:95], a[60:63], v[36:39]
s_waitcnt lgkmcnt(4)
v_exp_f32 v10, v82
v_mfma_f32_16x16x32_bf16 v[40:43], a[96:99], a[0:3], v[40:43]
s_add_u32 m0, s18, 135168
ds_read_b128 a[64:67], v1 offset:16384
v_cndmask_b32 v48, v16, v7, s[48:49]
v_mfma_f32_16x16x32_bf16 v[40:43], a[100:103], a[4:7], v[40:43]
buffer_load_dwordx4 v1, s[4:7], s8 offen offset:0 sc1 lds
v_mfma_f32_16x16x32_bf16 v[40:43], a[104:107], a[8:11], v[40:43]
ds_read_b128 a[68:71], v1 offset:17408
v_cndmask_b32 v49, v16, v7, s[50:51]
v_mfma_f32_16x16x32_bf16 v[40:43], a[108:111], a[12:15], v[40:43]
s_waitcnt lgkmcnt(4)
v_cndmask_b32 v50, v16, v7, s[52:53]
v_cndmask_b32 v51, v16, v7, s[54:55]
v_mfma_f32_16x16x32_bf16 v[40:43], a[112:115], a[16:19], v[40:43]
ds_read_b128 a[72:75], v1 offset:18432
v_add_f32 v26, v26, v10
v_mfma_f32_16x16x32_bf16 v[40:43], a[116:119], a[20:23], v[40:43]
s_waitcnt lgkmcnt(4)
buffer_load_dwordx4 v1, s[4:7], s8 offen offset:1024 sc1 lds
v_mfma_f32_16x16x32_bf16 v[40:43], a[120:123], a[24:27], v[40:43]
s_waitcnt lgkmcnt(3)
ds_read_b128 a[76:79], v1 offset:19456
v_mfma_f32_16x16x32_bf16 v[40:43], a[124:127], a[28:31], v[40:43]
v_exp_f32 v11, v83
v_mfma_f32_16x16x32_bf16 v[44:47], a[96:99], a[32:35], v[20:23]
ds_read_b128 a[80:83], v1 offset:20480
v_add_f32 v26, v26, v11
v_mfma_f32_16x16x32_bf16 v[44:47], a[100:103], a[36:39], v[44:47]
buffer_load_dwordx4 v1, s[4:7], s8 offen offset:2048 sc1 lds
v_mfma_f32_16x16x32_bf16 v[44:47], a[104:107], a[40:43], v[44:47]
ds_read_b128 a[84:87], v1 offset:21504
v_cvt_pk_bf16_f32 v117, v10, v11
v_mfma_f32_16x16x32_bf16 v[44:47], a[108:111], a[44:47], v[44:47]
v_exp_f32 v12, v84
v_mfma_f32_16x16x32_bf16 v[44:47], a[112:115], a[48:51], v[44:47]
ds_read_b128 a[88:91], v1 offset:22528
v_add_f32 v27, v27, v12
v_mfma_f32_16x16x32_bf16 v[44:47], a[116:119], a[52:55], v[44:47]
buffer_load_dwordx4 v1, s[4:7], s8 offen offset:3072 sc1 lds
v_mfma_f32_16x16x32_bf16 v[44:47], a[120:123], a[56:59], v[44:47]
s_waitcnt lgkmcnt(2)
s_add_u32 s8, s8, 28672
ds_read_b128 a[92:95], v1 offset:23552
v_mfma_f32_16x16x32_bf16 v[44:47], a[124:127], a[60:63], v[44:47]
s_sub_u32 s9, s9, 1
v_exp_f32 v13, v85
v_mfma_f32_16x16x32_bf16 v[48:51], a[64:67], a[0:3], v[48:51]
s_cmp_eq_u32 s9, 0
ds_read_b128 a[96:99], v1 offset:24576
v_cndmask_b32 v56, v16, v7, s[56:57]
v_mfma_f32_16x16x32_bf16 v[48:51], a[68:71], a[4:7], v[48:51]
s_cselect_b32 s8, s10, s8
v_cndmask_b32 v57, v16, v7, s[58:59]
v_cndmask_b32 v58, v16, v7, s[60:61]
v_mfma_f32_16x16x32_bf16 v[48:51], a[72:75], a[8:11], v[48:51]
s_cselect_b32 s9, s11, s9
ds_read_b128 a[100:103], v1 offset:25600
v_cndmask_b32 v59, v16, v7, s[62:63]
v_mfma_f32_16x16x32_bf16 v[48:51], a[76:79], a[12:15], v[48:51]
s_cselect_b32 s10, 3221225472, s10
v_exp_f32 v14, v86
v_mfma_f32_16x16x32_bf16 v[48:51], a[80:83], a[16:19], v[48:51]
s_waitcnt lgkmcnt(4)
ds_read_b128 a[104:107], v1 offset:26624
v_add_f32 v27, v27, v13
v_cvt_pk_bf16_f32 v124, v12, v13
v_mfma_f32_16x16x32_bf16 v[48:51], a[84:87], a[20:23], v[48:51]
s_waitcnt lgkmcnt(4)
v_exp_f32 v15, v87
v_mfma_f32_16x16x32_bf16 v[48:51], a[88:91], a[24:27], v[48:51]
s_waitcnt lgkmcnt(3)
ds_read_b128 a[108:111], v1 offset:27648
v_add_f32 v27, v27, v14
v_mfma_f32_16x16x32_bf16 v[48:51], a[92:95], a[28:31], v[48:51]
v_exp_f32 v8, v88
v_mfma_f32_16x16x32_bf16 v[52:55], a[64:67], a[32:35], v[20:23]
ds_read_b128 a[112:115], v1 offset:28672
v_add_f32 v27, v27, v15
v_mfma_f32_16x16x32_bf16 v[52:55], a[68:71], a[36:39], v[52:55]
v_exp_f32 v9, v89
v_mfma_f32_16x16x32_bf16 v[52:55], a[72:75], a[40:43], v[52:55]
ds_read_b128 a[116:119], v1 offset:29696
v_cvt_pk_bf16_f32 v125, v14, v15
v_mfma_f32_16x16x32_bf16 v[52:55], a[76:79], a[44:47], v[52:55]
v_exp_f32 v10, v90
v_mfma_f32_16x16x32_bf16 v[52:55], a[80:83], a[48:51], v[52:55]
ds_read_b128 a[120:123], v1 offset:30720
v_add_f32 v26, v26, v8
v_mfma_f32_16x16x32_bf16 v[52:55], a[84:87], a[52:55], v[52:55]
v_exp_f32 v11, v91
v_mfma_f32_16x16x32_bf16 v[52:55], a[88:91], a[56:59], v[52:55]
s_waitcnt vmcnt(8) lgkmcnt(4)
ds_read_b128 a[124:127], v1 offset:31744
v_add_f32 v26, v26, v9
v_cvt_pk_bf16_f32 v118, v8, v9
v_mfma_f32_16x16x32_bf16 v[52:55], a[92:95], a[60:63], v[52:55]
s_barrier
v_mfma_f32_16x16x32_bf16 v[56:59], a[96:99], a[0:3], v[56:59]
ds_read_b128 a[64:67], v2 offset:32768
v_add_f32 v26, v26, v10
v_mfma_f32_16x16x32_bf16 v[56:59], a[100:103], a[4:7], v[56:59]
v_exp_f32 v12, v92
v_mfma_f32_16x16x32_bf16 v[56:59], a[104:107], a[8:11], v[56:59]
s_waitcnt lgkmcnt(4)
ds_read_b128 a[68:71], v2 offset:33792
v_add_f32 v26, v26, v11
v_cvt_pk_bf16_f32 v119, v10, v11
v_mfma_f32_16x16x32_bf16 v[56:59], a[108:111], a[12:15], v[56:59]
v_exp_f32 v13, v93
v_mfma_f32_16x16x32_bf16 v[56:59], a[112:115], a[16:19], v[56:59]
s_waitcnt lgkmcnt(4)
ds_read_b128 a[72:75], v2 offset:34816
v_add_f32 v27, v27, v12
v_mfma_f32_16x16x32_bf16 v[56:59], a[116:119], a[20:23], v[56:59]
s_waitcnt lgkmcnt(4)
v_exp_f32 v14, v94
v_mfma_f32_16x16x32_bf16 v[56:59], a[120:123], a[24:27], v[56:59]
s_waitcnt lgkmcnt(3)
ds_read_b128 a[76:79], v2 offset:35840
v_add_f32 v27, v27, v13
v_mfma_f32_16x16x32_bf16 v[56:59], a[124:127], a[28:31], v[56:59]
v_exp_f32 v15, v95
v_mfma_f32_16x16x32_bf16 v[60:63], a[96:99], a[32:35], v[20:23]
ds_read_b128 a[80:83], v2 offset:36864
v_cvt_pk_bf16_f32 v126, v12, v13
v_mfma_f32_16x16x32_bf16 v[60:63], a[100:103], a[36:39], v[60:63]
v_add_f32 v27, v27, v14
v_add_f32 v27, v27, v15
v_mfma_f32_16x16x32_bf16 v[60:63], a[104:107], a[40:43], v[60:63]
ds_read_b128 a[84:87], v2 offset:37888
v_cvt_pk_bf16_f32 v127, v14, v15
v_mfma_f32_16x16x32_bf16 v[60:63], a[108:111], a[44:47], v[60:63]
v_add_f32 v28, v26, v27
v_cmp_nge_f32 vcc, s25, v28
v_mfma_f32_16x16x32_bf16 v[60:63], a[112:115], a[48:51], v[60:63]
ds_read_b128 a[88:91], v2 offset:38912
v_mfma_f32_16x16x32_bf16 v[60:63], a[116:119], a[52:55], v[60:63]
v_mfma_f32_16x16x32_bf16 v[60:63], a[120:123], a[56:59], v[60:63]
ds_read_b128 a[92:95], v2 offset:39936
v_mfma_f32_16x16x32_bf16 v[60:63], a[124:127], a[60:63], v[60:63]
s_waitcnt lgkmcnt(4)
s_cbranch_vccnz Lstub_6
Lback_7:
v_mfma_f32_16x16x32_bf16 v[128:131], a[64:67], v[112:115], v[128:131]
s_add_u32 m0, s18, 65536
ds_read_b128 a[96:99], v2 offset:40960
v_add_f32 v24, v24, v26
v_mfma_f32_16x16x32_bf16 v[128:131], a[68:71], v[116:119], v[128:131]
buffer_load_dwordx4 v1, s[4:7], s12 offen offset:0 sc1 lds
v_mfma_f32_16x16x32_bf16 v[132:135], a[68:71], v[124:127], v[132:135]
ds_read_b128 a[100:103], v2 offset:41984
v_add_f32 v25, v25, v27
v_mfma_f32_16x16x32_bf16 v[132:135], a[64:67], v[120:123], v[132:135]
v_exp_f32 v8, v32
v_mfma_f32_16x16x32_bf16 v[136:139], a[72:75], v[112:115], v[136:139]
ds_read_b128 a[104:107], v2 offset:43008
v_mfma_f32_16x16x32_bf16 v[136:139], a[76:79], v[116:119], v[136:139]
buffer_load_dwordx4 v1, s[4:7], s12 offen offset:1024 sc1 lds
v_mfma_f32_16x16x32_bf16 v[140:143], a[76:79], v[124:127], v[140:143]
ds_read_b128 a[108:111], v2 offset:44032
v_mfma_f32_16x16x32_bf16 v[140:143], a[72:75], v[120:123], v[140:143]
s_waitcnt lgkmcnt(4)
v_exp_f32 v9, v33
v_mfma_f32_16x16x32_bf16 v[144:147], a[80:83], v[112:115], v[144:147]
ds_read_b128 a[112:115], v2 offset:45056
v_add_f32 v26, v8, v9
v_mfma_f32_16x16x32_bf16 v[144:147], a[84:87], v[116:119], v[144:147]
buffer_load_dwordx4 v1, s[4:7], s12 offen offset:2048 sc1 lds
v_mfma_f32_16x16x32_bf16 v[148:151], a[84:87], v[124:127], v[148:151]
ds_read_b128 a[116:119], v2 offset:46080
v_cvt_pk_bf16_f32 v96, v8, v9
v_mfma_f32_16x16x32_bf16 v[148:151], a[80:83], v[120:123], v[148:151]
v_exp_f32 v10, v34
v_mfma_f32_16x16x32_bf16 v[152:155], a[88:91], v[112:115], v[152:155]
ds_read_b128 a[120:123], v2 offset:47104
v_add_f32 v26, v26, v10
v_mfma_f32_16x16x32_bf16 v[152:155], a[92:95], v[116:119], v[152:155]
buffer_load_dwordx4 v1, s[4:7], s12 offen offset:3072 sc1 lds
v_mfma_f32_16x16x32_bf16 v[156:159], a[92:95], v[124:127], v[156:159]
s_add_u32 s12, s12, 4096
ds_read_b128 a[124:127], v2 offset:48128
v_mfma_f32_16x16x32_bf16 v[156:159], a[88:91], v[120:123], v[156:159]
s_waitcnt lgkmcnt(4)
v_exp_f32 v11, v35
v_mfma_f32_16x16x32_bf16 v[160:163], a[96:99], v[112:115], v[160:163]
s_add_u32 m0, s18, 69632
ds_read_b128 a[64:67], v2 offset:49152
v_add_f32 v26, v26, v11
v_mfma_f32_16x16x32_bf16 v[160:163], a[100:103], v[116:119], v[160:163]
buffer_load_dwordx4 v1, s[4:7], s12 offen offset:0 sc1 lds
v_mfma_f32_16x16x32_bf16 v[164:167], a[100:103], v[124:127], v[164:167]
ds_read_b128 a[68:71], v2 offset:50176
v_cvt_pk_bf16_f32 v97, v10, v11
v_mfma_f32_16x16x32_bf16 v[164:167], a[96:99], v[120:123], v[164:167]
v_mfma_f32_16x16x32_bf16 v[168:171], a[104:107], v[112:115], v[168:171]
ds_read_b128 a[72:75], v2 offset:51200
v_mfma_f32_16x16x32_bf16 v[168:171], a[108:111], v[116:119], v[168:171]
buffer_load_dwordx4 v1, s[4:7], s12 offen offset:1024 sc1 lds
v_mfma_f32_16x16x32_bf16 v[172:175], a[108:111], v[124:127], v[172:175]
ds_read_b128 a[76:79], v2 offset:52224
v_mfma_f32_16x16x32_bf16 v[172:175], a[104:107], v[120:123], v[172:175]
s_waitcnt lgkmcnt(4)
v_exp_f32 v12, v36
v_mfma_f32_16x16x32_bf16 v[176:179], a[112:115], v[112:115], v[176:179]
ds_read_b128 a[80:83], v2 offset:53248
v_mfma_f32_16x16x32_bf16 v[176:179], a[116:119], v[116:119], v[176:179]
buffer_load_dwordx4 v1, s[4:7], s12 offen offset:2048 sc1 lds
v_mfma_f32_16x16x32_bf16 v[180:183], a[116:119], v[124:127], v[180:183]
ds_read_b128 a[84:87], v2 offset:54272
v_mfma_f32_16x16x32_bf16 v[180:183], a[112:115], v[120:123], v[180:183]
v_exp_f32 v13, v37
v_mfma_f32_16x16x32_bf16 v[184:187], a[120:123], v[112:115], v[184:187]
ds_read_b128 a[88:91], v2 offset:55296
v_add_f32 v27, v12, v13
v_mfma_f32_16x16x32_bf16 v[184:187], a[124:127], v[116:119], v[184:187]
s_waitcnt lgkmcnt(4)
buffer_load_dwordx4 v1, s[4:7], s12 offen offset:3072 sc1 lds
v_mfma_f32_16x16x32_bf16 v[188:191], a[124:127], v[124:127], v[188:191]
s_add_u32 s12, s12, 28672
ds_read_b128 a[92:95], v2 offset:56320
v_cvt_pk_bf16_f32 v104, v12, v13
v_mfma_f32_16x16x32_bf16 v[188:191], a[120:123], v[120:123], v[188:191]
s_sub_u32 s13, s13, 1
v_exp_f32 v14, v38
v_mfma_f32_16x16x32_bf16 v[192:195], a[64:67], v[112:115], v[192:195]
s_cmp_eq_u32 s13, 0
ds_read_b128 a[96:99], v2 offset:57344
v_add_f32 v27, v27, v14
v_mfma_f32_16x16x32_bf16 v[192:195], a[68:71], v[116:119], v[192:195]
s_cselect_b32 s12, s14, s12
v_exp_f32 v15, v39
v_mfma_f32_16x16x32_bf16 v[196:199], a[68:71], v[124:127], v[196:199]
s_cselect_b32 s13, s15, s13
ds_read_b128 a[100:103], v2 offset:58368
v_add_f32 v27, v27, v15
v_mfma_f32_16x16x32_bf16 v[196:199], a[64:67], v[120:123], v[196:199]
s_cselect_b32 s14, 3221225472, s14
v_cvt_pk_bf16_f32 v105, v14, v15
v_mfma_f32_16x16x32_bf16 v[200:203], a[72:75], v[112:115], v[200:203]
s_waitcnt lgkmcnt(4)
ds_read_b128 a[104:107], v2 offset:59392
v_mfma_f32_16x16x32_bf16 v[200:203], a[76:79], v[116:119], v[200:203]
buffer_load_dword v3, off, s[4:7], s80 sc1
v_mfma_f32_16x16x32_bf16 v[204:207], a[76:79], v[124:127], v[204:207]
ds_read_b128 a[108:111], v2 offset:60416
v_mfma_f32_16x16x32_bf16 v[204:207], a[72:75], v[120:123], v[204:207]
v_exp_f32 v8, v40
v_mfma_f32_16x16x32_bf16 v[208:211], a[80:83], v[112:115], v[208:211]
ds_read_b128 a[112:115], v2 offset:61440
v_add_f32 v26, v26, v8
v_mfma_f32_16x16x32_bf16 v[208:211], a[84:87], v[116:119], v[208:211]
v_exp_f32 v9, v41
v_mfma_f32_16x16x32_bf16 v[212:215], a[84:87], v[124:127], v[212:215]
ds_read_b128 a[116:119], v2 offset:62464
v_add_f32 v26, v26, v9
v_mfma_f32_16x16x32_bf16 v[212:215], a[80:83], v[120:123], v[212:215]
s_waitcnt lgkmcnt(4)
v_exp_f32 v10, v42
v_mfma_f32_16x16x32_bf16 v[216:219], a[88:91], v[112:115], v[216:219]
ds_read_b128 a[120:123], v2 offset:63488
v_cvt_pk_bf16_f32 v98, v8, v9
v_mfma_f32_16x16x32_bf16 v[216:219], a[92:95], v[116:119], v[216:219]
v_exp_f32 v11, v43
v_mfma_f32_16x16x32_bf16 v[220:223], a[92:95], v[124:127], v[220:223]
s_waitcnt vmcnt(9)
ds_read_b128 a[124:127], v2 offset:64512
v_add_f32 v26, v26, v10
v_mfma_f32_16x16x32_bf16 v[220:223], a[88:91], v[120:123], v[220:223]
s_barrier
v_mfma_f32_16x16x32_bf16 v[224:227], a[96:99], v[112:115], v[224:227]
ds_read_b128 a[64:67], v4 offset:0
v_add_f32 v26, v26, v11
v_mfma_f32_16x16x32_bf16 v[224:227], a[100:103], v[116:119], v[224:227]
v_cvt_pk_bf16_f32 v99, v10, v11
v_mfma_f32_16x16x32_bf16 v[228:231], a[100:103], v[124:127], v[228:231]
ds_read_b128 a[68:71], v4 offset:1024
v_mfma_f32_16x16x32_bf16 v[228:231], a[96:99], v[120:123], v[228:231]
s_waitcnt lgkmcnt(4)
v_exp_f32 v12, v44
v_mfma_f32_16x16x32_bf16 v[232:235], a[104:107], v[112:115], v[232:235]
ds_read_b128 a[72:75], v4 offset:2048
v_add_f32 v27, v27, v12
v_mfma_f32_16x16x32_bf16 v[232:235], a[108:111], v[116:119], v[232:235]
v_exp_f32 v13, v45
v_mfma_f32_16x16x32_bf16 v[236:239], a[108:111], v[124:127], v[236:239]
ds_read_b128 a[76:79], v4 offset:3072
v_add_f32 v27, v27, v13
v_mfma_f32_16x16x32_bf16 v[236:239], a[104:107], v[120:123], v[236:239]
v_exp_f32 v14, v46
v_mfma_f32_16x16x32_bf16 v[240:243], a[112:115], v[112:115], v[240:243]
ds_read_b128 a[80:83], v4 offset:4096
v_cvt_pk_bf16_f32 v106, v12, v13
v_mfma_f32_16x16x32_bf16 v[240:243], a[116:119], v[116:119], v[240:243]
v_exp_f32 v15, v47
v_mfma_f32_16x16x32_bf16 v[244:247], a[116:119], v[124:127], v[244:247]
ds_read_b128 a[84:87], v4 offset:5120
v_add_f32 v27, v27, v14
v_mfma_f32_16x16x32_bf16 v[244:247], a[112:115], v[120:123], v[244:247]
s_waitcnt lgkmcnt(4)
v_add_f32 v27, v27, v15
v_cvt_pk_bf16_f32 v107, v14, v15
v_mfma_f32_16x16x32_bf16 v[248:251], a[120:123], v[112:115], v[248:251]
ds_read_b128 a[88:91], v4 offset:6144
v_mfma_f32_16x16x32_bf16 v[248:251], a[124:127], v[116:119], v[248:251]
v_mfma_f32_16x16x32_bf16 v[252:255], a[124:127], v[124:127], v[252:255]
ds_read_b128 a[92:95], v4 offset:7168
v_mfma_f32_16x16x32_bf16 v[252:255], a[120:123], v[120:123], v[252:255]
K2_dx1:
v_cndmask_b32 v68, v20, v7, s[32:33]
v_cndmask_b32 v69, v20, v7, s[34:35]
v_cndmask_b32 v70, v20, v7, s[36:37]
v_cndmask_b32 v71, v20, v7, s[38:39]
s_nop 1
v_mfma_f32_16x16x32_bf16 v[68:71], a[64:67], a[32:35], v[68:71]
s_add_u32 m0, s18, 0
ds_read_b128 a[96:99], v4 offset:8192
v_cndmask_b32 v76, v20, v7, s[40:41]
v_cndmask_b32 v79, v20, v7, s[46:47]
v_mfma_f32_16x16x32_bf16 v[68:71], a[68:71], a[36:39], v[68:71]
s_waitcnt lgkmcnt(4)
ds_read_b128 a[100:103], v4 offset:9216
buffer_load_dwordx4 v1, s[4:7], s12 offen offset:0 sc1 lds
v_mfma_f32_16x16x32_bf16 v[68:71], a[72:75], a[40:43], v[68:71]
ds_read_b128 a[104:107], v4 offset:10240
v_cndmask_b32 v77, v20, v7, s[42:43]
v_mfma_f32_16x16x32_bf16 v[68:71], a[76:79], a[44:47], v[68:71]
ds_read_b128 a[108:111], v4 offset:11264
buffer_load_dwordx4 v1, s[4:7], s12 offen offset:1024 sc1 lds
v_mfma_f32_16x16x32_bf16 v[68:71], a[80:83], a[48:51], v[68:71]
s_waitcnt lgkmcnt(6)
ds_read_b128 a[112:115], v4 offset:12288
v_cndmask_b32 v78, v20, v7, s[44:45]
v_mfma_f32_16x16x32_bf16 v[68:71], a[84:87], a[52:55], v[68:71]
s_waitcnt lgkmcnt(6)
ds_read_b128 a[116:119], v4 offset:13312
buffer_load_dwordx4 v1, s[4:7], s12 offen offset:2048 sc1 lds
v_mfma_f32_16x16x32_bf16 v[68:71], a[88:91], a[56:59], v[68:71]
s_waitcnt lgkmcnt(6)
ds_read_b128 a[120:123], v4 offset:14336
v_exp_f32 v8, v48
v_exp_f32 v9, v49
v_exp_f32 v10, v50
v_mfma_f32_16x16x32_bf16 v[68:71], a[92:95], a[60:63], v[68:71]
s_waitcnt lgkmcnt(5)
ds_read_b128 a[124:127], v4 offset:15360
buffer_load_dwordx4 v1, s[4:7], s12 offen offset:3072 sc1 lds
v_add_f32 v26, v26, v8
v_add_f32 v26, v26, v9
v_cvt_pk_bf16_f32 v100, v8, v9
v_add_f32 v26, v26, v10
v_mfma_f32_16x16x32_bf16 v[76:79], a[96:99], a[32:35], v[76:79]
s_add_u32 s12, s12, 4096
s_add_u32 m0, s18, 4096
ds_read_b128 a[64:67], v4 offset:16384
v_cndmask_b32 v86, v20, v7, s[52:53]
v_cndmask_b32 v87, v20, v7, s[54:55]
v_mfma_f32_16x16x32_bf16 v[76:79], a[100:103], a[36:39], v[76:79]
s_waitcnt lgkmcnt(6)
ds_read_b128 a[68:71], v4 offset:17408
buffer_load_dwordx4 v1, s[4:7], s12 offen offset:0 sc1 lds
v_mfma_f32_16x16x32_bf16 v[76:79], a[104:107], a[40:43], v[76:79]
s_waitcnt lgkmcnt(6)
ds_read_b128 a[72:75], v4 offset:18432
v_cndmask_b32 v84, v20, v7, s[48:49]
v_mfma_f32_16x16x32_bf16 v[76:79], a[108:111], a[44:47], v[76:79]
s_waitcnt lgkmcnt(6)
ds_read_b128 a[76:79], v4 offset:19456
buffer_load_dwordx4 v1, s[4:7], s12 offen offset:1024 sc1 lds
v_mfma_f32_16x16x32_bf16 v[76:79], a[112:115], a[48:51], v[76:79]
s_waitcnt lgkmcnt(6)
ds_read_b128 a[80:83], v4 offset:20480
v_cndmask_b32 v85, v20, v7, s[50:51]
v_mfma_f32_16x16x32_bf16 v[76:79], a[116:119], a[52:55], v[76:79]
s_waitcnt lgkmcnt(6)
ds_read_b128 a[84:87], v4 offset:21504
buffer_load_dwordx4 v1, s[4:7], s12 offen offset:2048 sc1 lds
v_mfma_f32_16x16x32_bf16 v[76:79], a[120:123], a[56:59], v[76:79]
s_waitcnt lgkmcnt(6)
ds_read_b128 a[88:91], v4 offset:22528
v_exp_f32 v11, v51
v_exp_f32 v12, v52
v_mfma_f32_16x16x32_bf16 v[76:79], a[124:127], a[60:63], v[76:79]
s_waitcnt lgkmcnt(1)
ds_read_b128 a[92:95], v4 offset:23552
buffer_load_dwordx4 v1, s[4:7], s12 offen offset:3072 sc1 lds
v_add_f32 v26, v26, v11
v_cvt_pk_bf16_f32 v101, v10, v11
v_add_f32 v27, v27, v12
v_mfma_f32_16x16x32_bf16 v[84:87], a[64:67], a[32:35], v[84:87]
s_add_u32 s12, s12, 28672
ds_read_b128 a[96:99], v4 offset:24576
v_cndmask_b32 v92, v20, v7, s[56:57]
v_mfma_f32_16x16x32_bf16 v[84:87], a[68:71], a[36:39], v[84:87]
s_sub_u32 s13, s13, 1
ds_read_b128 a[100:103], v4 offset:25600
v_cndmask_b32 v93, v20, v7, s[58:59]
v_mfma_f32_16x16x32_bf16 v[84:87], a[72:75], a[40:43], v[84:87]
s_cmp_eq_u32 s13, 0
ds_read_b128 a[104:107], v4 offset:26624
v_cndmask_b32 v94, v20, v7, s[60:61]
v_mfma_f32_16x16x32_bf16 v[84:87], a[76:79], a[44:47], v[84:87]
s_cselect_b32 s12, s14, s12
ds_read_b128 a[108:111], v4 offset:27648
v_cndmask_b32 v95, v20, v7, s[62:63]
v_mfma_f32_16x16x32_bf16 v[84:87], a[80:83], a[48:51], v[84:87]
s_cselect_b32 s13, s15, s13
ds_read_b128 a[112:115], v4 offset:28672
v_exp_f32 v13, v53
v_exp_f32 v14, v54
v_mfma_f32_16x16x32_bf16 v[84:87], a[84:87], a[52:55], v[84:87]
s_waitcnt lgkmcnt(6)
s_cselect_b32 s14, 3221225472, s14
ds_read_b128 a[116:119], v4 offset:29696
v_exp_f32 v15, v55
v_exp_f32 v8, v56
v_exp_f32 v9, v57
v_add_f32 v27, v27, v13
v_cvt_pk_bf16_f32 v108, v12, v13
v_add_f32 v27, v27, v14
v_mfma_f32_16x16x32_bf16 v[84:87], a[88:91], a[56:59], v[84:87]
s_waitcnt lgkmcnt(6)
ds_read_b128 a[120:123], v4 offset:30720
v_exp_f32 v10, v58
v_exp_f32 v11, v59
v_add_f32 v27, v27, v15
v_cvt_pk_bf16_f32 v109, v14, v15
v_mfma_f32_16x16x32_bf16 v[84:87], a[92:95], a[60:63], v[84:87]
s_waitcnt vmcnt(8) lgkmcnt(6)
s_barrier
ds_read_b128 a[124:127], v4 offset:31744
v_mfma_f32_16x16x32_bf16 v[92:95], a[96:99], a[32:35], v[92:95]
s_waitcnt lgkmcnt(6)
ds_read_b128 a[64:67], v2 offset:0
v_exp_f32 v12, v60
v_exp_f32 v13, v61
v_mfma_f32_16x16x32_bf16 v[92:95], a[100:103], a[36:39], v[92:95]
s_waitcnt lgkmcnt(6)
ds_read_b128 a[68:71], v2 offset:1024
v_exp_f32 v14, v62
v_exp_f32 v15, v63
v_mfma_f32_16x16x32_bf16 v[92:95], a[104:107], a[40:43], v[92:95]
s_waitcnt lgkmcnt(6)
ds_read_b128 a[72:75], v2 offset:2048
v_add_f32 v26, v26, v8
v_add_f32 v26, v26, v9
v_cvt_pk_bf16_f32 v102, v8, v9
v_mfma_f32_16x16x32_bf16 v[92:95], a[108:111], a[44:47], v[92:95]
s_waitcnt lgkmcnt(6)
ds_read_b128 a[76:79], v2 offset:3072
v_add_f32 v26, v26, v10
v_add_f32 v26, v26, v11
v_cvt_pk_bf16_f32 v103, v10, v11
v_mfma_f32_16x16x32_bf16 v[92:95], a[112:115], a[48:51], v[92:95]
s_waitcnt lgkmcnt(6)
ds_read_b128 a[80:83], v2 offset:4096
v_add_f32 v27, v27, v12
v_mfma_f32_16x16x32_bf16 v[92:95], a[116:119], a[52:55], v[92:95]
s_waitcnt lgkmcnt(6)
ds_read_b128 a[84:87], v2 offset:5120
v_add_f32 v27, v27, v13
v_cvt_pk_bf16_f32 v110, v12, v13
v_mfma_f32_16x16x32_bf16 v[92:95], a[120:123], a[56:59], v[92:95]
s_waitcnt lgkmcnt(6)
ds_read_b128 a[88:91], v2 offset:6144
v_add_f32 v27, v27, v14
v_add_f32 v27, v27, v15
v_cvt_pk_bf16_f32 v111, v14, v15
v_mfma_f32_16x16x32_bf16 v[92:95], a[124:127], a[60:63], v[92:95]
s_waitcnt lgkmcnt(6)
ds_read_b128 a[92:95], v2 offset:7168
v_add_f32 v28, v26, v27
v_cmp_nge_f32 vcc, s25, v28
s_cbranch_vccnz Lstub_8
Lback_9:
s_cmp_lg_u32 s24, 1
s_cbranch_scc1 K2_plain
v_cmp_gt_u32 vcc, 1, v3
s_cbranch_vccnz K2_tspin
K2_tok:
v_mfma_f32_16x16x32_bf16 v[128:131], a[64:67], v[96:99], v[128:131]
s_waitcnt lgkmcnt(6)
ds_read_b128 a[96:99], v2 offset:8192
v_add_f32 v24, v24, v26
v_mfma_f32_16x16x32_bf16 v[128:131], a[68:71], v[100:103], v[128:131]
buffer_load_dwordx4 v[28:31], v1, s[4:7], s27 offen sc1
v_mfma_f32_16x16x32_bf16 v[132:135], a[68:71], v[108:111], v[132:135]
ds_read_b128 a[100:103], v2 offset:9216
v_add_f32 v25, v25, v27
v_mfma_f32_16x16x32_bf16 v[132:135], a[64:67], v[104:107], v[132:135]
s_waitcnt lgkmcnt(6)
v_exp_f32 v8, v68
v_mfma_f32_16x16x32_bf16 v[136:139], a[72:75], v[96:99], v[136:139]
s_add_u32 s22, s76, 0
ds_read_b128 a[104:107], v2 offset:10240
v_exp_f32 v9, v69
v_mfma_f32_16x16x32_bf16 v[136:139], a[76:79], v[100:103], v[136:139]
buffer_load_dwordx4 v[32:35], v1, s[4:7], s22 offen offset:0 sc1
v_mfma_f32_16x16x32_bf16 v[140:143], a[76:79], v[108:111], v[140:143]
ds_read_b128 a[108:111], v2 offset:11264
v_add_f32 v27, v8, v9
v_mfma_f32_16x16x32_bf16 v[140:143], a[72:75], v[104:107], v[140:143]
s_waitcnt lgkmcnt(5)
v_exp_f32 v10, v70
v_mfma_f32_16x16x32_bf16 v[144:147], a[80:83], v[96:99], v[144:147]
ds_read_b128 a[112:115], v2 offset:12288
v_cvt_pk_bf16_f32 v120, v8, v9
v_mfma_f32_16x16x32_bf16 v[144:147], a[84:87], v[100:103], v[144:147]
buffer_load_dwordx4 v[36:39], v1, s[4:7], s22 offen offset:1024 sc1
v_mfma_f32_16x16x32_bf16 v[148:151], a[84:87], v[108:111], v[148:151]
ds_read_b128 a[116:119], v2 offset:13312
v_add_f32 v27, v27, v10
v_mfma_f32_16x16x32_bf16 v[148:151], a[80:83], v[104:107], v[148:151]
v_exp_f32 v11, v71
v_mfma_f32_16x16x32_bf16 v[152:155], a[88:91], v[96:99], v[152:155]
s_waitcnt lgkmcnt(4)
ds_read_b128 a[120:123], v2 offset:14336
v_add_f32 v27, v27, v11
v_mfma_f32_16x16x32_bf16 v[152:155], a[92:95], v[100:103], v[152:155]
buffer_load_dwordx4 v[40:43], v1, s[4:7], s22 offen offset:2048 sc1
v_mfma_f32_16x16x32_bf16 v[156:159], a[92:95], v[108:111], v[156:159]
ds_read_b128 a[124:127], v2 offset:15360
v_cvt_pk_bf16_f32 v121, v10, v11
v_mfma_f32_16x16x32_bf16 v[156:159], a[88:91], v[104:107], v[156:159]
v_exp_f32 v12, v76
v_mfma_f32_16x16x32_bf16 v[160:163], a[96:99], v[96:99], v[160:163]
ds_read_b128 a[64:67], v2 offset:16384
v_add_f32 v27, v27, v12
v_mfma_f32_16x16x32_bf16 v[160:163], a[100:103], v[100:103], v[160:163]
buffer_load_dwordx4 v[44:47], v1, s[4:7], s22 offen offset:3072 sc1
v_mfma_f32_16x16x32_bf16 v[164:167], a[100:103], v[108:111], v[164:167]
PAD_12:
s_cbranch_execz M_tret
ds_read_b128 a[68:71], v2 offset:17408
v_mfma_f32_16x16x32_bf16 v[164:167], a[96:99], v[104:107], v[164:167]
s_waitcnt lgkmcnt(4)
v_exp_f32 v13, v77
v_mfma_f32_16x16x32_bf16 v[168:171], a[104:107], v[96:99], v[168:171]
s_add_u32 s22, s76, 4096
ds_read_b128 a[72:75], v2 offset:18432
v_add_f32 v27, v27, v13
v_mfma_f32_16x16x32_bf16 v[168:171], a[108:111], v[100:103], v[168:171]
buffer_load_dwordx4 v[48:51], v1, s[4:7], s22 offen offset:0 sc1
v_mfma_f32_16x16x32_bf16 v[172:175], a[108:111], v[108:111], v[172:175]
ds_read_b128 a[76:79], v2 offset:19456
v_exp_f32 v14, v78
v_mfma_f32_16x16x32_bf16 v[172:175], a[104:107], v[104:107], v[172:175]
v_exp_f32 v15, v79
v_mfma_f32_16x16x32_bf16 v[176:179], a[112:115], v[96:99], v[176:179]
ds_read_b128 a[80:83], v2 offset:20480
v_cvt_pk_bf16_f32 v122, v12, v13
v_mfma_f32_16x16x32_bf16 v[176:179], a[116:119], v[100:103], v[176:179]
buffer_load_dwordx4 v[52:55], v1, s[4:7], s22 offen offset:1024 sc1
v_mfma_f32_16x16x32_bf16 v[180:183], a[116:119], v[108:111], v[180:183]
ds_read_b128 a[84:87], v2 offset:21504
v_add_f32 v27, v27, v14
v_mfma_f32_16x16x32_bf16 v[180:183], a[112:115], v[104:107], v[180:183]
s_waitcnt lgkmcnt(4)
v_exp_f32 v8, v84
v_mfma_f32_16x16x32_bf16 v[184:187], a[120:123], v[96:99], v[184:187]
ds_read_b128 a[88:91], v2 offset:22528
v_add_f32 v27, v27, v15
v_cvt_pk_bf16_f32 v123, v14, v15
v_mfma_f32_16x16x32_bf16 v[184:187], a[124:127], v[100:103], v[184:187]
buffer_load_dwordx4 v[56:59], v1, s[4:7], s22 offen offset:2048 sc1
v_mfma_f32_16x16x32_bf16 v[188:191], a[124:127], v[108:111], v[188:191]
ds_read_b128 a[92:95], v2 offset:23552
v_add_f32 v27, v27, v8
v_mfma_f32_16x16x32_bf16 v[188:191], a[120:123], v[104:107], v[188:191]
v_exp_f32 v9, v85
v_mfma_f32_16x16x32_bf16 v[192:195], a[64:67], v[96:99], v[192:195]
ds_read_b128 a[96:99], v2 offset:24576
v_add_f32 v27, v27, v9
v_mfma_f32_16x16x32_bf16 v[192:195], a[68:71], v[100:103], v[192:195]
buffer_load_dwordx4 v[60:63], v1, s[4:7], s22 offen offset:3072 sc1
v_mfma_f32_16x16x32_bf16 v[196:199], a[68:71], v[108:111], v[196:199]
ds_read_b128 a[100:103], v2 offset:25600
v_cvt_pk_bf16_f32 v124, v8, v9
v_mfma_f32_16x16x32_bf16 v[196:199], a[64:67], v[104:107], v[196:199]
s_waitcnt lgkmcnt(4)
v_exp_f32 v10, v86
v_mfma_f32_16x16x32_bf16 v[200:203], a[72:75], v[96:99], v[200:203]
s_add_u32 s22, s76, 8192
ds_read_b128 a[104:107], v2 offset:26624
v_add_f32 v27, v27, v10
v_mfma_f32_16x16x32_bf16 v[200:203], a[76:79], v[100:103], v[200:203]
buffer_load_dwordx4 a[32:35], v1, s[4:7], s22 offen offset:0 sc1
v_mfma_f32_16x16x32_bf16 v[204:207], a[76:79], v[108:111], v[204:207]
ds_read_b128 a[108:111], v2 offset:27648
v_mfma_f32_16x16x32_bf16 v[204:207], a[72:75], v[104:107], v[204:207]
v_exp_f32 v11, v87
v_mfma_f32_16x16x32_bf16 v[208:211], a[80:83], v[96:99], v[208:211]
ds_read_b128 a[112:115], v2 offset:28672
v_exp_f32 v12, v92
v_mfma_f32_16x16x32_bf16 v[208:211], a[84:87], v[100:103], v[208:211]
buffer_load_dwordx4 a[36:39], v1, s[4:7], s22 offen offset:1024 sc1
v_mfma_f32_16x16x32_bf16 v[212:215], a[84:87], v[108:111], v[212:215]
ds_read_b128 a[116:119], v2 offset:29696
v_add_f32 v27, v27, v11
v_mfma_f32_16x16x32_bf16 v[212:215], a[80:83], v[104:107], v[212:215]
s_waitcnt lgkmcnt(4)
v_exp_f32 v13, v93
v_mfma_f32_16x16x32_bf16 v[216:219], a[88:91], v[96:99], v[216:219]
ds_read_b128 a[120:123], v2 offset:30720
v_cvt_pk_bf16_f32 v125, v10, v11
v_add_f32 v27, v27, v12
v_mfma_f32_16x16x32_bf16 v[216:219], a[92:95], v[100:103], v[216:219]
buffer_load_dwordx4 a[40:43], v1, s[4:7], s22 offen offset:2048 sc1
v_mfma_f32_16x16x32_bf16 v[220:223], a[92:95], v[108:111], v[220:223]
s_waitcnt vmcnt(12)
ds_read_b128 a[124:127], v2 offset:31744
v_add_f32 v27, v27, v13
v_mfma_f32_16x16x32_bf16 v[220:223], a[88:91], v[104:107], v[220:223]
s_barrier
v_mfma_f32_16x16x32_bf16 v[224:227], a[96:99], v[96:99], v[224:227]
ds_read_b128 a[64:67], v1 offset:0
v_cvt_pk_bf16_f32 v126, v12, v13
v_mfma_f32_16x16x32_bf16 v[224:227], a[100:103], v[100:103], v[224:227]
buffer_load_dwordx4 a[44:47], v1, s[4:7], s22 offen offset:3072 sc1
v_mfma_f32_16x16x32_bf16 v[228:231], a[100:103], v[108:111], v[228:231]
ds_read_b128 a[68:71], v1 offset:1024
v_mfma_f32_16x16x32_bf16 v[228:231], a[96:99], v[104:107], v[228:231]
s_waitcnt lgkmcnt(4)
v_exp_f32 v14, v94
v_mfma_f32_16x16x32_bf16 v[232:235], a[104:107], v[96:99], v[232:235]
s_add_u32 s22, s76, 12288
ds_read_b128 a[72:75], v1 offset:2048
v_add_f32 v27, v27, v14
v_mfma_f32_16x16x32_bf16 v[232:235], a[108:111], v[100:103], v[232:235]
buffer_load_dwordx4 a[48:51], v1, s[4:7], s22 offen offset:0 sc1
v_mfma_f32_16x16x32_bf16 v[236:239], a[108:111], v[108:111], v[236:239]
ds_read_b128 a[76:79], v1 offset:3072
v_mfma_f32_16x16x32_bf16 v[236:239], a[104:107], v[104:107], v[236:239]
v_exp_f32 v15, v95
v_mfma_f32_16x16x32_bf16 v[240:243], a[112:115], v[96:99], v[240:243]
ds_read_b128 a[80:83], v1 offset:4096
v_add_f32 v27, v27, v15
v_mfma_f32_16x16x32_bf16 v[240:243], a[116:119], v[100:103], v[240:243]
buffer_load_dwordx4 a[52:55], v1, s[4:7], s22 offen offset:1024 sc1
v_mfma_f32_16x16x32_bf16 v[244:247], a[116:119], v[108:111], v[244:247]
ds_read_b128 a[84:87], v1 offset:5120
v_cvt_pk_bf16_f32 v127, v14, v15
v_mfma_f32_16x16x32_bf16 v[244:247], a[112:115], v[104:107], v[244:247]
s_waitcnt lgkmcnt(4)
v_cmp_nge_f32 vcc, s25, v27
v_mfma_f32_16x16x32_bf16 v[248:251], a[120:123], v[96:99], v[248:251]
ds_read_b128 a[88:91], v1 offset:6144
v_mfma_f32_16x16x32_bf16 v[248:251], a[124:127], v[100:103], v[248:251]
buffer_load_dwordx4 a[56:59], v1, s[4:7], s22 offen offset:2048 sc1
v_mfma_f32_16x16x32_bf16 v[252:255], a[124:127], v[108:111], v[252:255]
ds_read_b128 a[92:95], v1 offset:7168
v_mfma_f32_16x16x32_bf16 v[252:255], a[120:123], v[104:107], v[252:255]
s_waitcnt lgkmcnt(2)
buffer_load_dwordx4 a[60:63], v1, s[4:7], s22 offen offset:3072 sc1
s_cbranch_vccnz Lstub_10
Lback_11:
v_mfma_f32_16x16x32_bf16 v[132:135], a[64:67], v[120:123], v[132:135]
s_mov_b64 s[36:37], s[86:87]
ds_read_b128 a[96:99], v1 offset:8192
v_add_f32 v25, v25, v27
v_mfma_f32_16x16x32_bf16 v[132:135], a[68:71], v[124:127], v[132:135]
s_mov_b32 s38, 3670016
ds_read_b128 a[100:103], v1 offset:9216
v_accvgpr_read_b32 v112, a184
v_mfma_f32_16x16x32_bf16 v[140:143], a[72:75], v[120:123], v[140:143]
s_mov_b32 s39, 0x20000
ds_read_b128 a[104:107], v1 offset:10240
v_accvgpr_read_b32 v113, a185
v_mfma_f32_16x16x32_bf16 v[140:143], a[76:79], v[124:127], v[140:143]
s_lshl_b32 s8, s29, 3
ds_read_b128 a[108:111], v1 offset:11264
v_accvgpr_read_b32 v114, a186
v_mfma_f32_16x16x32_bf16 v[148:151], a[80:83], v[120:123], v[148:151]
s_add_u32 s8, s8, s3
ds_read_b128 a[112:115], v1 offset:12288
v_accvgpr_read_b32 v115, a187
v_mfma_f32_16x16x32_bf16 v[148:151], a[84:87], v[124:127], v[148:151]
s_waitcnt lgkmcnt(3)
s_lshl_b32 s8, s8, 4
ds_read_b128 a[116:119], v1 offset:13312
v_accvgpr_read_b32 v116, a188
v_mfma_f32_16x16x32_bf16 v[156:159], a[88:91], v[120:123], v[156:159]
s_add_u32 s8, s8, s20
ds_read_b128 a[120:123], v1 offset:14336
v_accvgpr_read_b32 v117, a189
v_mfma_f32_16x16x32_bf16 v[156:159], a[92:95], v[124:127], v[156:159]
s_mul_i32 s8, s8, 14336
ds_read_b128 a[124:127], v1 offset:15360
v_accvgpr_read_b32 v118, a190
v_mfma_f32_16x16x32_bf16 v[164:167], a[96:99], v[120:123], v[164:167]
s_add_u32 s8, s8, 104857600
ds_read_b128 a[64:67], v1 offset:16384
v_accvgpr_read_b32 v119, a191
v_mfma_f32_16x16x32_bf16 v[164:167], a[100:103], v[124:127], v[164:167]
s_waitcnt lgkmcnt(6)
s_add_u32 s12, s8, 917504
ds_read_b128 a[68:71], v1 offset:17408
v_mfma_f32_16x16x32_bf16 v[172:175], a[104:107], v[120:123], v[172:175]
s_waitcnt lgkmcnt(6)
ds_read_b128 a[72:75], v1 offset:18432
v_mfma_f32_16x16x32_bf16 v[172:175], a[108:111], v[124:127], v[172:175]
s_waitcnt lgkmcnt(6)
ds_read_b128 a[76:79], v1 offset:19456
v_mfma_f32_16x16x32_bf16 v[180:183], a[112:115], v[120:123], v[180:183]
s_waitcnt lgkmcnt(6)
ds_read_b128 a[80:83], v1 offset:20480
v_mfma_f32_16x16x32_bf16 v[180:183], a[116:119], v[124:127], v[180:183]
s_waitcnt lgkmcnt(6)
ds_read_b128 a[84:87], v1 offset:21504
v_mfma_f32_16x16x32_bf16 v[188:191], a[120:123], v[120:123], v[188:191]
s_waitcnt lgkmcnt(6)
ds_read_b128 a[88:91], v1 offset:22528
v_mfma_f32_16x16x32_bf16 v[188:191], a[124:127], v[124:127], v[188:191]
s_waitcnt lgkmcnt(6)
ds_read_b128 a[92:95], v1 offset:23552
v_mfma_f32_16x16x32_bf16 v[196:199], a[64:67], v[120:123], v[196:199]
s_waitcnt lgkmcnt(6)
ds_read_b128 a[96:99], v1 offset:24576
v_mfma_f32_16x16x32_bf16 v[196:199], a[68:71], v[124:127], v[196:199]
s_waitcnt lgkmcnt(6)
ds_read_b128 a[100:103], v1 offset:25600
v_mfma_f32_16x16x32_bf16 v[204:207], a[72:75], v[120:123], v[204:207]
s_waitcnt lgkmcnt(6)
ds_read_b128 a[104:107], v1 offset:26624
v_mfma_f32_16x16x32_bf16 v[204:207], a[76:79], v[124:127], v[204:207]
s_waitcnt lgkmcnt(6)
ds_read_b128 a[108:111], v1 offset:27648
v_mfma_f32_16x16x32_bf16 v[212:215], a[80:83], v[120:123], v[212:215]
s_waitcnt lgkmcnt(6)
ds_read_b128 a[112:115], v1 offset:28672
v_mfma_f32_16x16x32_bf16 v[212:215], a[84:87], v[124:127], v[212:215]
s_waitcnt lgkmcnt(6)
ds_read_b128 a[116:119], v1 offset:29696
v_mfma_f32_16x16x32_bf16 v[220:223], a[88:91], v[120:123], v[220:223]
s_waitcnt lgkmcnt(6)
s_add_u32 m0, s18, 32768
ds_read_b128 a[120:123], v1 offset:30720
v_mfma_f32_16x16x32_bf16 v[220:223], a[92:95], v[124:127], v[220:223]
s_waitcnt lgkmcnt(6)
ds_read_b128 a[124:127], v1 offset:31744
v_mfma_f32_16x16x32_bf16 v[228:231], a[96:99], v[120:123], v[228:231]
s_waitcnt lgkmcnt(6)
buffer_load_dwordx4 v112, s[36:39], s81 offen offset:0 lds
v_mfma_f32_16x16x32_bf16 v[228:231], a[100:103], v[124:127], v[228:231]
s_waitcnt lgkmcnt(5)
buffer_load_dwordx4 v113, s[36:39], s81 offen offset:1024 lds
v_mfma_f32_16x16x32_bf16 v[236:239], a[104:107], v[120:123], v[236:239]
s_waitcnt lgkmcnt(4)
buffer_load_dwordx4 v114, s[36:39], s81 offen offset:2048 lds
v_mfma_f32_16x16x32_bf16 v[236:239], a[108:111], v[124:127], v[236:239]
s_waitcnt lgkmcnt(3)
buffer_load_dwordx4 v115, s[36:39], s81 offen offset:3072 lds
v_mfma_f32_16x16x32_bf16 v[244:247], a[112:115], v[120:123], v[244:247]
s_waitcnt lgkmcnt(2)
s_add_u32 s81, s81, 28672
v_mfma_f32_16x16x32_bf16 v[244:247], a[116:119], v[124:127], v[244:247]
s_waitcnt lgkmcnt(1)
s_add_u32 m0, s18, 36864
v_mfma_f32_16x16x32_bf16 v[252:255], a[120:123], v[120:123], v[252:255]
s_waitcnt lgkmcnt(0)
buffer_load_dwordx4 v112, s[36:39], s81 offen offset:0 lds
v_mfma_f32_16x16x32_bf16 v[252:255], a[124:127], v[124:127], v[252:255]
buffer_load_dwordx4 v113, s[36:39], s81 offen offset:1024 lds
buffer_load_dwordx4 v114, s[36:39], s81 offen offset:2048 lds
buffer_load_dwordx4 v115, s[36:39], s81 offen offset:3072 lds
s_sub_u32 s81, s81, 28544
s_waitcnt vmcnt(8)
v_sub_f32 v8, v16, v28
v_sub_f32 v10, v20, v30
v_max_f32 v9, v8, v10
v_cmp_lt_f32 vcc, 1114636288, v9
s_cbranch_vccnz K2_cfix
K2_cok:
v_exp_f32 v8, v8
v_exp_f32 v10, v10
s_nop 0
v_mov_b32 v9, v8
v_mov_b32 v11, v10
v_fmac_f32 v24, v8, v29
v_fmac_f32 v25, v10, v31
s_mov_b32 s23, 0xffff0000
v_lshlrev_b32 v64, 16, v32
v_and_b32 v65, s23, v32
v_lshlrev_b32 v66, 16, v33
v_and_b32 v67, s23, v33
v_lshlrev_b32 v68, 16, v34
v_and_b32 v69, s23, v34
v_lshlrev_b32 v70, 16, v35
v_and_b32 v71, s23, v35
v_pk_fma_f32 v[128:129], v[64:65], v[8:9], v[128:129]
v_pk_fma_f32 v[130:131], v[66:67], v[8:9], v[130:131]
v_pk_fma_f32 v[136:137], v[68:69], v[8:9], v[136:137]
v_pk_fma_f32 v[138:139], v[70:71], v[8:9], v[138:139]
v_cvt_pk_bf16_f32 v128, v128, v129
v_cvt_pk_bf16_f32 v129, v130, v131
v_cvt_pk_bf16_f32 v130, v136, v137
v_cvt_pk_bf16_f32 v131, v138, v139
s_add_u32 m0, s18, 98304
s_nop 0
buffer_load_dwordx4 v112, s[36:39], s81 offen offset:0 lds
v_lshlrev_b32 v64, 16, v36
v_and_b32 v65, s23, v36
v_lshlrev_b32 v66, 16, v37
v_and_b32 v67, s23, v37
v_lshlrev_b32 v68, 16, v38
v_and_b32 v69, s23, v38
v_lshlrev_b32 v70, 16, v39
v_and_b32 v71, s23, v39
v_pk_fma_f32 v[144:145], v[64:65], v[8:9], v[144:145]
v_pk_fma_f32 v[146:147], v[66:67], v[8:9], v[146:147]
v_pk_fma_f32 v[152:153], v[68:69], v[8:9], v[152:153]
v_pk_fma_f32 v[154:155], v[70:71], v[8:9], v[154:155]
v_cvt_pk_bf16_f32 v144, v144, v145
v_cvt_pk_bf16_f32 v145, v146, v147
v_cvt_pk_bf16_f32 v146, v152, v153
v_cvt_pk_bf16_f32 v147, v154, v155
buffer_load_dwordx4 v113, s[36:39], s81 offen offset:1024 lds
v_lshlrev_b32 v64, 16, v40
v_and_b32 v65, s23, v40
v_lshlrev_b32 v66, 16, v41
v_and_b32 v67, s23, v41
v_lshlrev_b32 v68, 16, v42
v_and_b32 v69, s23, v42
v_lshlrev_b32 v70, 16, v43
v_and_b32 v71, s23, v43
v_pk_fma_f32 v[160:161], v[64:65], v[8:9], v[160:161]
v_pk_fma_f32 v[162:163], v[66:67], v[8:9], v[162:163]
v_pk_fma_f32 v[168:169], v[68:69], v[8:9], v[168:169]
v_pk_fma_f32 v[170:171], v[70:71], v[8:9], v[170:171]
v_cvt_pk_bf16_f32 v160, v160, v161
v_cvt_pk_bf16_f32 v161, v162, v163
v_cvt_pk_bf16_f32 v162, v168, v169
v_cvt_pk_bf16_f32 v163, v170, v171
buffer_load_dwordx4 v114, s[36:39], s81 offen offset:2048 lds
v_lshlrev_b32 v64, 16, v44
v_and_b32 v65, s23, v44
v_lshlrev_b32 v66, 16, v45
v_and_b32 v67, s23, v45
v_lshlrev_b32 v68, 16, v46
v_and_b32 v69, s23, v46
v_lshlrev_b32 v70, 16, v47
v_and_b32 v71, s23, v47
v_pk_fma_f32 v[176:177], v[64:65], v[8:9], v[176:177]
v_pk_fma_f32 v[178:179], v[66:67], v[8:9], v[178:179]
v_pk_fma_f32 v[184:185], v[68:69], v[8:9], v[184:185]
v_pk_fma_f32 v[186:187], v[70:71], v[8:9], v[186:187]
v_cvt_pk_bf16_f32 v176, v176, v177
v_cvt_pk_bf16_f32 v177, v178, v179
v_cvt_pk_bf16_f32 v178, v184, v185
v_cvt_pk_bf16_f32 v179, v186, v187
buffer_load_dwordx4 v115, s[36:39], s81 offen offset:3072 lds
v_lshlrev_b32 v64, 16, v48
v_and_b32 v65, s23, v48
v_lshlrev_b32 v66, 16, v49
v_and_b32 v67, s23, v49
v_lshlrev_b32 v68, 16, v50
v_and_b32 v69, s23, v50
v_lshlrev_b32 v70, 16, v51
v_and_b32 v71, s23, v51
v_pk_fma_f32 v[192:193], v[64:65], v[8:9], v[192:193]
v_pk_fma_f32 v[194:195], v[66:67], v[8:9], v[194:195]
v_pk_fma_f32 v[200:201], v[68:69], v[8:9], v[200:201]
v_pk_fma_f32 v[202:203], v[70:71], v[8:9], v[202:203]
v_cvt_pk_bf16_f32 v192, v192, v193
v_cvt_pk_bf16_f32 v193, v194, v195
v_cvt_pk_bf16_f32 v194, v200, v201
v_cvt_pk_bf16_f32 v195, v202, v203
s_add_u32 s81, s81, 28672
s_add_u32 m0, s18, 102400
s_nop 0
buffer_load_dwordx4 v112, s[36:39], s81 offen offset:0 lds
v_lshlrev_b32 v64, 16, v52
v_and_b32 v65, s23, v52
v_lshlrev_b32 v66, 16, v53
v_and_b32 v67, s23, v53
v_lshlrev_b32 v68, 16, v54
v_and_b32 v69, s23, v54
v_lshlrev_b32 v70, 16, v55
v_and_b32 v71, s23, v55
v_pk_fma_f32 v[208:209], v[64:65], v[8:9], v[208:209]
v_pk_fma_f32 v[210:211], v[66:67], v[8:9], v[210:211]
v_pk_fma_f32 v[216:217], v[68:69], v[8:9], v[216:217]
v_pk_fma_f32 v[218:219], v[70:71], v[8:9], v[218:219]
v_cvt_pk_bf16_f32 v208, v208, v209
v_cvt_pk_bf16_f32 v209, v210, v211
v_cvt_pk_bf16_f32 v210, v216, v217
v_cvt_pk_bf16_f32 v211, v218, v219
buffer_load_dwordx4 v113, s[36:39], s81 offen offset:1024 lds
v_lshlrev_b32 v64, 16, v56
v_and_b32 v65, s23, v56
v_lshlrev_b32 v66, 16, v57
v_and_b32 v67, s23, v57
v_lshlrev_b32 v68, 16, v58
v_and_b32 v69, s23, v58
v_lshlrev_b32 v70, 16, v59
v_and_b32 v71, s23, v59
v_pk_fma_f32 v[224:225], v[64:65], v[8:9], v[224:225]
v_pk_fma_f32 v[226:227], v[66:67], v[8:9], v[226:227]
v_pk_fma_f32 v[232:233], v[68:69], v[8:9], v[232:233]
v_pk_fma_f32 v[234:235], v[70:71], v[8:9], v[234:235]
v_cvt_pk_bf16_f32 v224, v224, v225
v_cvt_pk_bf16_f32 v225, v226, v227
v_cvt_pk_bf16_f32 v226, v232, v233
v_cvt_pk_bf16_f32 v227, v234, v235
buffer_load_dwordx4 v114, s[36:39], s81 offen offset:2048 lds
v_lshlrev_b32 v64, 16, v60
v_and_b32 v65, s23, v60
v_lshlrev_b32 v66, 16, v61
v_and_b32 v67, s23, v61
v_lshlrev_b32 v68, 16, v62
v_and_b32 v69, s23, v62
v_lshlrev_b32 v70, 16, v63
v_and_b32 v71, s23, v63
v_pk_fma_f32 v[240:241], v[64:65], v[8:9], v[240:241]
v_pk_fma_f32 v[242:243], v[66:67], v[8:9], v[242:243]
v_pk_fma_f32 v[248:249], v[68:69], v[8:9], v[248:249]
v_pk_fma_f32 v[250:251], v[70:71], v[8:9], v[250:251]
v_cvt_pk_bf16_f32 v240, v240, v241
v_cvt_pk_bf16_f32 v241, v242, v243
v_cvt_pk_bf16_f32 v242, v248, v249
v_cvt_pk_bf16_f32 v243, v250, v251
buffer_load_dwordx4 v115, s[36:39], s81 offen offset:3072 lds
v_accvgpr_read_b32 v32, a32
v_accvgpr_read_b32 v33, a33
v_accvgpr_read_b32 v34, a34
v_accvgpr_read_b32 v35, a35
v_lshlrev_b32 v64, 16, v32
v_and_b32 v65, s23, v32
v_lshlrev_b32 v66, 16, v33
v_and_b32 v67, s23, v33
v_lshlrev_b32 v68, 16, v34
v_and_b32 v69, s23, v34
v_lshlrev_b32 v70, 16, v35
v_and_b32 v71, s23, v35
v_pk_fma_f32 v[132:133], v[64:65], v[10:11], v[132:133]
v_pk_fma_f32 v[134:135], v[66:67], v[10:11], v[134:135]
v_pk_fma_f32 v[140:141], v[68:69], v[10:11], v[140:141]
v_pk_fma_f32 v[142:143], v[70:71], v[10:11], v[142:143]
v_cvt_pk_bf16_f32 v132, v132, v133
v_cvt_pk_bf16_f32 v133, v134, v135
v_cvt_pk_bf16_f32 v134, v140, v141
v_cvt_pk_bf16_f32 v135, v142, v143
s_sub_u32 s81, s81, 28544
s_add_u32 m0, s18, 131072
s_nop 0
buffer_load_dwordx4 v112, s[36:39], s81 offen offset:0 lds
v_accvgpr_read_b32 v36, a36
v_accvgpr_read_b32 v37, a37
v_accvgpr_read_b32 v38, a38
v_accvgpr_read_b32 v39, a39
v_lshlrev_b32 v64, 16, v36
v_and_b32 v65, s23, v36
v_lshlrev_b32 v66, 16, v37
v_and_b32 v67, s23, v37
v_lshlrev_b32 v68, 16, v38
v_and_b32 v69, s23, v38
v_lshlrev_b32 v70, 16, v39
v_and_b32 v71, s23, v39
v_pk_fma_f32 v[148:149], v[64:65], v[10:11], v[148:149]
v_pk_fma_f32 v[150:151], v[66:67], v[10:11], v[150:151]
v_pk_fma_f32 v[156:157], v[68:69], v[10:11], v[156:157]
v_pk_fma_f32 v[158:159], v[70:71], v[10:11], v[158:159]
v_cvt_pk_bf16_f32 v148, v148, v149
v_cvt_pk_bf16_f32 v149, v150, v151
v_cvt_pk_bf16_f32 v150, v156, v157
v_cvt_pk_bf16_f32 v151, v158, v159
buffer_load_dwordx4 v113, s[36:39], s81 offen offset:1024 lds
v_accvgpr_read_b32 v40, a40
v_accvgpr_read_b32 v41, a41
v_accvgpr_read_b32 v42, a42
v_accvgpr_read_b32 v43, a43
v_lshlrev_b32 v64, 16, v40
v_and_b32 v65, s23, v40
v_lshlrev_b32 v66, 16, v41
v_and_b32 v67, s23, v41
v_lshlrev_b32 v68, 16, v42
v_and_b32 v69, s23, v42
v_lshlrev_b32 v70, 16, v43
v_and_b32 v71, s23, v43
v_pk_fma_f32 v[164:165], v[64:65], v[10:11], v[164:165]
v_pk_fma_f32 v[166:167], v[66:67], v[10:11], v[166:167]
v_pk_fma_f32 v[172:173], v[68:69], v[10:11], v[172:173]
v_pk_fma_f32 v[174:175], v[70:71], v[10:11], v[174:175]
v_cvt_pk_bf16_f32 v164, v164, v165
v_cvt_pk_bf16_f32 v165, v166, v167
v_cvt_pk_bf16_f32 v166, v172, v173
v_cvt_pk_bf16_f32 v167, v174, v175
buffer_load_dwordx4 v114, s[36:39], s81 offen offset:2048 lds
v_accvgpr_read_b32 v44, a44
v_accvgpr_read_b32 v45, a45
v_accvgpr_read_b32 v46, a46
v_accvgpr_read_b32 v47, a47
v_lshlrev_b32 v64, 16, v44
v_and_b32 v65, s23, v44
v_lshlrev_b32 v66, 16, v45
v_and_b32 v67, s23, v45
v_lshlrev_b32 v68, 16, v46
v_and_b32 v69, s23, v46
v_lshlrev_b32 v70, 16, v47
v_and_b32 v71, s23, v47
v_pk_fma_f32 v[180:181], v[64:65], v[10:11], v[180:181]
v_pk_fma_f32 v[182:183], v[66:67], v[10:11], v[182:183]
v_pk_fma_f32 v[188:189], v[68:69], v[10:11], v[188:189]
v_pk_fma_f32 v[190:191], v[70:71], v[10:11], v[190:191]
v_cvt_pk_bf16_f32 v180, v180, v181
v_cvt_pk_bf16_f32 v181, v182, v183
v_cvt_pk_bf16_f32 v182, v188, v189
v_cvt_pk_bf16_f32 v183, v190, v191
buffer_load_dwordx4 v115, s[36:39], s81 offen offset:3072 lds
v_accvgpr_read_b32 v48, a48
v_accvgpr_read_b32 v49, a49
v_accvgpr_read_b32 v50, a50
v_accvgpr_read_b32 v51, a51
v_lshlrev_b32 v64, 16, v48
v_and_b32 v65, s23, v48
v_lshlrev_b32 v66, 16, v49
v_and_b32 v67, s23, v49
v_lshlrev_b32 v68, 16, v50
v_and_b32 v69, s23, v50
v_lshlrev_b32 v70, 16, v51
v_and_b32 v71, s23, v51
v_pk_fma_f32 v[196:197], v[64:65], v[10:11], v[196:197]
v_pk_fma_f32 v[198:199], v[66:67], v[10:11], v[198:199]
v_pk_fma_f32 v[204:205], v[68:69], v[10:11], v[204:205]
v_pk_fma_f32 v[206:207], v[70:71], v[10:11], v[206:207]
v_cvt_pk_bf16_f32 v196, v196, v197
v_cvt_pk_bf16_f32 v197, v198, v199
v_cvt_pk_bf16_f32 v198, v204, v205
v_cvt_pk_bf16_f32 v199, v206, v207
s_add_u32 s81, s81, 28672
s_add_u32 m0, s18, 135168
s_nop 0
buffer_load_dwordx4 v112, s[36:39], s81 offen offset:0 lds
v_accvgpr_read_b32 v52, a52
v_accvgpr_read_b32 v53, a53
v_accvgpr_read_b32 v54, a54
v_accvgpr_read_b32 v55, a55
v_lshlrev_b32 v64, 16, v52
v_and_b32 v65, s23, v52
v_lshlrev_b32 v66, 16, v53
v_and_b32 v67, s23, v53
v_lshlrev_b32 v68, 16, v54
v_and_b32 v69, s23, v54
v_lshlrev_b32 v70, 16, v55
v_and_b32 v71, s23, v55
v_pk_fma_f32 v[212:213], v[64:65], v[10:11], v[212:213]
v_pk_fma_f32 v[214:215], v[66:67], v[10:11], v[214:215]
v_pk_fma_f32 v[220:221], v[68:69], v[10:11], v[220:221]
v_pk_fma_f32 v[222:223], v[70:71], v[10:11], v[222:223]
v_cvt_pk_bf16_f32 v212, v212, v213
v_cvt_pk_bf16_f32 v213, v214, v215
v_cvt_pk_bf16_f32 v214, v220, v221
v_cvt_pk_bf16_f32 v215, v222, v223
buffer_load_dwordx4 v113, s[36:39], s81 offen offset:1024 lds
v_accvgpr_read_b32 v56, a56
v_accvgpr_read_b32 v57, a57
v_accvgpr_read_b32 v58, a58
v_accvgpr_read_b32 v59, a59
v_lshlrev_b32 v64, 16, v56
v_and_b32 v65, s23, v56
v_lshlrev_b32 v66, 16, v57
v_and_b32 v67, s23, v57
v_lshlrev_b32 v68, 16, v58
v_and_b32 v69, s23, v58
v_lshlrev_b32 v70, 16, v59
v_and_b32 v71, s23, v59
v_pk_fma_f32 v[228:229], v[64:65], v[10:11], v[228:229]
v_pk_fma_f32 v[230:231], v[66:67], v[10:11], v[230:231]
v_pk_fma_f32 v[236:237], v[68:69], v[10:11], v[236:237]
v_pk_fma_f32 v[238:239], v[70:71], v[10:11], v[238:239]
v_cvt_pk_bf16_f32 v228, v228, v229
v_cvt_pk_bf16_f32 v229, v230, v231
v_cvt_pk_bf16_f32 v230, v236, v237
v_cvt_pk_bf16_f32 v231, v238, v239
buffer_load_dwordx4 v114, s[36:39], s81 offen offset:2048 lds
v_accvgpr_read_b32 v60, a60
v_accvgpr_read_b32 v61, a61
v_accvgpr_read_b32 v62, a62
v_accvgpr_read_b32 v63, a63
v_lshlrev_b32 v64, 16, v60
v_and_b32 v65, s23, v60
v_lshlrev_b32 v66, 16, v61
v_and_b32 v67, s23, v61
v_lshlrev_b32 v68, 16, v62
v_and_b32 v69, s23, v62
v_lshlrev_b32 v70, 16, v63
v_and_b32 v71, s23, v63
v_pk_fma_f32 v[244:245], v[64:65], v[10:11], v[244:245]
v_pk_fma_f32 v[246:247], v[66:67], v[10:11], v[246:247]
v_pk_fma_f32 v[252:253], v[68:69], v[10:11], v[252:253]
v_pk_fma_f32 v[254:255], v[70:71], v[10:11], v[254:255]
v_cvt_pk_bf16_f32 v244, v244, v245
v_cvt_pk_bf16_f32 v245, v246, v247
v_cvt_pk_bf16_f32 v246, v252, v253
v_cvt_pk_bf16_f32 v247, v254, v255
buffer_load_dwordx4 v115, s[36:39], s81 offen offset:3072 lds
s_sub_u32 s81, s81, 28544
K2_done:
PAD_13:
s_cbranch_execz PAD_17
s_waitcnt vmcnt(16)
s_barrier
ds_read_b64_tr_b16 a[64:65], v116 offset:0
ds_read_b64_tr_b16 a[66:67], v116 offset:2048
ds_read_b64_tr_b16 a[68:69], v116 offset:4096
ds_read_b64_tr_b16 a[70:71], v116 offset:6144
ds_read_b64_tr_b16 a[72:73], v116 offset:8192
ds_read_b64_tr_b16 a[74:75], v116 offset:10240
ds_read_b64_tr_b16 a[76:77], v116 offset:12288
ds_read_b64_tr_b16 a[78:79], v116 offset:14336
ds_read_b64_tr_b16 a[80:81], v116 offset:16384
ds_read_b64_tr_b16 a[82:83], v116 offset:18432
ds_read_b64_tr_b16 a[84:85], v116 offset:20480
ds_read_b64_tr_b16 a[86:87], v116 offset:22528
ds_read_b64_tr_b16 a[88:89], v116 offset:24576
ds_read_b64_tr_b16 a[90:91], v116 offset:26624
ds_read_b64_tr_b16 a[92:93], v116 offset:28672
ds_read_b64_tr_b16 a[94:95], v116 offset:30720
v_add_u32 v116, 65536, v116
s_waitcnt lgkmcnt(14)
v_mfma_f32_16x16x32_bf16 v[32:35], a[64:67], v[128:131], 0
s_waitcnt lgkmcnt(12)
s_add_u32 m0, s18, 65536
ds_read_b64_tr_b16 a[96:97], v117 offset:0
v_mov_b32 v28, v24
v_mfma_f32_16x16x32_bf16 v[32:35], a[68:71], v[144:147], v[32:35]
s_waitcnt lgkmcnt(11)
ds_read_b64_tr_b16 a[98:99], v117 offset:2048
buffer_load_dwordx4 v112, s[36:39], s81 offen offset:0 lds
v_mfma_f32_16x16x32_bf16 v[32:35], a[72:75], v[160:163], v[32:35]
s_waitcnt lgkmcnt(10)
ds_read_b64_tr_b16 a[100:101], v117 offset:4096
v_permlane16_swap_b32 v24, v28
v_mfma_f32_16x16x32_bf16 v[32:35], a[76:79], v[176:179], v[32:35]
s_waitcnt lgkmcnt(9)
ds_read_b64_tr_b16 a[102:103], v117 offset:6144
v_add_f32 v24, v24, v28
v_mfma_f32_16x16x32_bf16 v[32:35], a[80:83], v[192:195], v[32:35]
s_waitcnt lgkmcnt(8)
ds_read_b64_tr_b16 a[104:105], v117 offset:8192
buffer_load_dwordx4 v113, s[36:39], s81 offen offset:1024 lds
v_mfma_f32_16x16x32_bf16 v[32:35], a[84:87], v[208:211], v[32:35]
s_waitcnt lgkmcnt(7)
ds_read_b64_tr_b16 a[106:107], v117 offset:10240
v_mov_b32 v28, v24
v_mfma_f32_16x16x32_bf16 v[32:35], a[88:91], v[224:227], v[32:35]
s_waitcnt lgkmcnt(6)
ds_read_b64_tr_b16 a[108:109], v117 offset:12288
v_lshrrev_b32 v20, 4, v1
v_mfma_f32_16x16x32_bf16 v[32:35], a[92:95], v[240:243], v[32:35]
ds_read_b64_tr_b16 a[110:111], v117 offset:14336
buffer_load_dwordx4 v114, s[36:39], s81 offen offset:2048 lds
v_mfma_f32_16x16x32_bf16 v[36:39], a[64:67], v[132:135], 0
ds_read_b64_tr_b16 a[112:113], v117 offset:16384
v_permlane32_swap_b32 v24, v28
v_mfma_f32_16x16x32_bf16 v[36:39], a[68:71], v[148:151], v[36:39]
ds_read_b64_tr_b16 a[114:115], v117 offset:18432
v_add_f32 v24, v24, v28
v_mfma_f32_16x16x32_bf16 v[36:39], a[72:75], v[164:167], v[36:39]
ds_read_b64_tr_b16 a[116:117], v117 offset:20480
buffer_load_dwordx4 v115, s[36:39], s81 offen offset:3072 lds
v_mfma_f32_16x16x32_bf16 v[36:39], a[76:79], v[180:183], v[36:39]
PAD_14:
s_cbranch_execz PAD_18
ds_read_b64_tr_b16 a[118:119], v117 offset:22528
v_mov_b32 v29, v25
v_mfma_f32_16x16x32_bf16 v[36:39], a[80:83], v[196:199], v[36:39]
s_add_u32 s81, s81, 28672
s_add_u32 m0, s18, 69632
ds_read_b64_tr_b16 a[120:121], v117 offset:24576
v_mfma_f32_16x16x32_bf16 v[36:39], a[84:87], v[212:215], v[36:39]
ds_read_b64_tr_b16 a[122:123], v117 offset:26624
buffer_load_dwordx4 v112, s[36:39], s81 offen offset:0 lds
v_mfma_f32_16x16x32_bf16 v[36:39], a[88:91], v[228:231], v[36:39]
ds_read_b64_tr_b16 a[124:125], v117 offset:28672
v_permlane16_swap_b32 v25, v29
v_mfma_f32_16x16x32_bf16 v[36:39], a[92:95], v[244:247], v[36:39]
s_waitcnt lgkmcnt(8)
ds_read_b64_tr_b16 a[126:127], v117 offset:30720
v_add_u32 v117, 65536, v117
v_mfma_f32_16x16x32_bf16 v[40:43], a[96:99], v[128:131], 0
ds_read_b64_tr_b16 a[64:65], v118 offset:0
buffer_load_dwordx4 v113, s[36:39], s81 offen offset:1024 lds
v_mfma_f32_16x16x32_bf16 v[40:43], a[100:103], v[144:147], v[40:43]
ds_read_b64_tr_b16 a[66:67], v118 offset:2048
v_add_f32 v25, v25, v29
v_mfma_f32_16x16x32_bf16 v[40:43], a[104:107], v[160:163], v[40:43]
s_waitcnt lgkmcnt(8)
ds_read_b64_tr_b16 a[68:69], v118 offset:4096
v_mov_b32 v29, v25
v_mfma_f32_16x16x32_bf16 v[40:43], a[108:111], v[176:179], v[40:43]
ds_read_b64_tr_b16 a[70:71], v118 offset:6144
buffer_load_dwordx4 v114, s[36:39], s81 offen offset:2048 lds
v_mfma_f32_16x16x32_bf16 v[40:43], a[112:115], v[192:195], v[40:43]
s_waitcnt lgkmcnt(8)
ds_read_b64_tr_b16 a[72:73], v118 offset:8192
v_permlane32_swap_b32 v25, v29
v_mfma_f32_16x16x32_bf16 v[40:43], a[116:119], v[208:211], v[40:43]
s_waitcnt lgkmcnt(7)
ds_read_b64_tr_b16 a[74:75], v118 offset:10240
v_add_f32 v25, v25, v29
v_mfma_f32_16x16x32_bf16 v[40:43], a[120:123], v[224:227], v[40:43]
s_waitcnt lgkmcnt(6)
ds_read_b64_tr_b16 a[76:77], v118 offset:12288
buffer_load_dwordx4 v115, s[36:39], s81 offen offset:3072 lds
v_mfma_f32_16x16x32_bf16 v[40:43], a[124:127], v[240:243], v[40:43]
ds_read_b64_tr_b16 a[78:79], v118 offset:14336
v_rcp_f32 v24, v24
v_mfma_f32_16x16x32_bf16 v[44:47], a[96:99], v[132:135], 0
s_sub_u32 s81, s81, 28544
s_add_u32 m0, s18, 0
ds_read_b64_tr_b16 a[80:81], v118 offset:16384
v_mfma_f32_16x16x32_bf16 v[44:47], a[100:103], v[148:151], v[44:47]
ds_read_b64_tr_b16 a[82:83], v118 offset:18432
buffer_load_dwordx4 v112, s[36:39], s81 offen offset:0 lds
v_mfma_f32_16x16x32_bf16 v[44:47], a[104:107], v[164:167], v[44:47]
ds_read_b64_tr_b16 a[84:85], v118 offset:20480
v_rcp_f32 v25, v25
v_mfma_f32_16x16x32_bf16 v[44:47], a[108:111], v[180:183], v[44:47]
ds_read_b64_tr_b16 a[86:87], v118 offset:22528
v_and_b32 v19, 15, v20
v_mfma_f32_16x16x32_bf16 v[44:47], a[112:115], v[196:199], v[44:47]
ds_read_b64_tr_b16 a[88:89], v118 offset:24576
buffer_load_dwordx4 v113, s[36:39], s81 offen offset:1024 lds
v_mfma_f32_16x16x32_bf16 v[44:47], a[116:119], v[212:215], v[44:47]
ds_read_b64_tr_b16 a[90:91], v118 offset:26624
v_mul_f32 v32, v32, v24
v_mfma_f32_16x16x32_bf16 v[44:47], a[120:123], v[228:231], v[44:47]
ds_read_b64_tr_b16 a[92:93], v118 offset:28672
v_mul_f32 v33, v33, v24
v_mfma_f32_16x16x32_bf16 v[44:47], a[124:127], v[244:247], v[44:47]
s_waitcnt lgkmcnt(8)
ds_read_b64_tr_b16 a[94:95], v118 offset:30720
v_add_u32 v118, 65536, v118
v_mfma_f32_16x16x32_bf16 v[48:51], a[64:67], v[128:131], 0
ds_read_b64_tr_b16 a[96:97], v119 offset:0
buffer_load_dwordx4 v114, s[36:39], s81 offen offset:2048 lds
v_mfma_f32_16x16x32_bf16 v[48:51], a[68:71], v[144:147], v[48:51]
ds_read_b64_tr_b16 a[98:99], v119 offset:2048
v_mul_f32 v34, v34, v24
v_mfma_f32_16x16x32_bf16 v[48:51], a[72:75], v[160:163], v[48:51]
s_waitcnt lgkmcnt(8)
ds_read_b64_tr_b16 a[100:101], v119 offset:4096
v_mul_f32 v35, v35, v24
v_mfma_f32_16x16x32_bf16 v[48:51], a[76:79], v[176:179], v[48:51]
ds_read_b64_tr_b16 a[102:103], v119 offset:6144
buffer_load_dwordx4 v115, s[36:39], s81 offen offset:3072 lds
v_mfma_f32_16x16x32_bf16 v[48:51], a[80:83], v[192:195], v[48:51]
s_waitcnt lgkmcnt(6)
ds_read_b64_tr_b16 a[104:105], v119 offset:8192
v_mul_f32 v40, v40, v24
v_mfma_f32_16x16x32_bf16 v[48:51], a[84:87], v[208:211], v[48:51]
s_add_u32 s81, s81, 28672
s_add_u32 m0, s18, 4096
ds_read_b64_tr_b16 a[106:107], v119 offset:10240
v_mfma_f32_16x16x32_bf16 v[48:51], a[88:91], v[224:227], v[48:51]
s_waitcnt lgkmcnt(6)
ds_read_b64_tr_b16 a[108:109], v119 offset:12288
buffer_load_dwordx4 v112, s[36:39], s81 offen offset:0 lds
v_mfma_f32_16x16x32_bf16 v[48:51], a[92:95], v[240:243], v[48:51]
ds_read_b64_tr_b16 a[110:111], v119 offset:14336
v_mul_f32 v41, v41, v24
v_mfma_f32_16x16x32_bf16 v[52:55], a[64:67], v[132:135], 0
ds_read_b64_tr_b16 a[112:113], v119 offset:16384
v_mul_f32 v42, v42, v24
v_mfma_f32_16x16x32_bf16 v[52:55], a[68:71], v[148:151], v[52:55]
ds_read_b64_tr_b16 a[114:115], v119 offset:18432
buffer_load_dwordx4 v113, s[36:39], s81 offen offset:1024 lds
v_mfma_f32_16x16x32_bf16 v[52:55], a[72:75], v[164:167], v[52:55]
ds_read_b64_tr_b16 a[116:117], v119 offset:20480
v_mul_f32 v43, v43, v24
v_mfma_f32_16x16x32_bf16 v[52:55], a[76:79], v[180:183], v[52:55]
ds_read_b64_tr_b16 a[118:119], v119 offset:22528
v_cvt_pk_bf16_f32 v32, v32, v33
v_mfma_f32_16x16x32_bf16 v[52:55], a[80:83], v[196:199], v[52:55]
ds_read_b64_tr_b16 a[120:121], v119 offset:24576
buffer_load_dwordx4 v114, s[36:39], s81 offen offset:2048 lds
v_mfma_f32_16x16x32_bf16 v[52:55], a[84:87], v[212:215], v[52:55]
ds_read_b64_tr_b16 a[122:123], v119 offset:26624
v_cvt_pk_bf16_f32 v33, v34, v35
v_mfma_f32_16x16x32_bf16 v[52:55], a[88:91], v[228:231], v[52:55]
ds_read_b64_tr_b16 a[124:125], v119 offset:28672
ds_read_b64_tr_b16 a[126:127], v119 offset:30720
v_mfma_f32_16x16x32_bf16 v[52:55], a[92:95], v[244:247], v[52:55]
s_waitcnt vmcnt(23) lgkmcnt(9)
s_barrier
v_add_u32 v119, 65536, v119
v_mfma_f32_16x16x32_bf16 v[56:59], a[96:99], v[128:131], 0
ds_read_b64_tr_b16 a[64:65], v116 offset:0
buffer_load_dwordx4 v115, s[36:39], s81 offen offset:3072 lds
v_mfma_f32_16x16x32_bf16 v[56:59], a[100:103], v[144:147], v[56:59]
s_waitcnt lgkmcnt(8)
ds_read_b64_tr_b16 a[66:67], v116 offset:2048
v_cvt_pk_bf16_f32 v34, v40, v41
v_mfma_f32_16x16x32_bf16 v[56:59], a[104:107], v[160:163], v[56:59]
s_sub_u32 s81, s81, 28544
ds_read_b64_tr_b16 a[68:69], v116 offset:4096
v_cvt_pk_bf16_f32 v35, v42, v43
v_mfma_f32_16x16x32_bf16 v[56:59], a[108:111], v[176:179], v[56:59]
s_waitcnt lgkmcnt(8)
ds_read_b64_tr_b16 a[70:71], v116 offset:6144
buffer_store_dwordx4 v[32:35], v1, s[4:7], s8 offen offset:0 sc1
v_mfma_f32_16x16x32_bf16 v[56:59], a[112:115], v[192:195], v[56:59]
s_waitcnt lgkmcnt(8)
ds_read_b64_tr_b16 a[72:73], v116 offset:8192
v_mul_f32 v36, v36, v25
v_mfma_f32_16x16x32_bf16 v[56:59], a[116:119], v[208:211], v[56:59]
s_waitcnt lgkmcnt(7)
ds_read_b64_tr_b16 a[74:75], v116 offset:10240
v_mul_f32 v37, v37, v25
v_mfma_f32_16x16x32_bf16 v[56:59], a[120:123], v[224:227], v[56:59]
s_waitcnt lgkmcnt(6)
ds_read_b64_tr_b16 a[76:77], v116 offset:12288
v_mul_f32 v38, v38, v25
v_mfma_f32_16x16x32_bf16 v[56:59], a[124:127], v[240:243], v[56:59]
ds_read_b64_tr_b16 a[78:79], v116 offset:14336
v_mul_f32 v39, v39, v25
v_mfma_f32_16x16x32_bf16 v[60:63], a[96:99], v[132:135], 0
ds_read_b64_tr_b16 a[80:81], v116 offset:16384
v_mul_f32 v44, v44, v25
v_mfma_f32_16x16x32_bf16 v[60:63], a[100:103], v[148:151], v[60:63]
ds_read_b64_tr_b16 a[82:83], v116 offset:18432
v_mul_f32 v45, v45, v25
v_mfma_f32_16x16x32_bf16 v[60:63], a[104:107], v[164:167], v[60:63]
ds_read_b64_tr_b16 a[84:85], v116 offset:20480
v_mul_f32 v46, v46, v25
v_mfma_f32_16x16x32_bf16 v[60:63], a[108:111], v[180:183], v[60:63]
ds_read_b64_tr_b16 a[86:87], v116 offset:22528
v_mul_f32 v47, v47, v25
v_mfma_f32_16x16x32_bf16 v[60:63], a[112:115], v[196:199], v[60:63]
ds_read_b64_tr_b16 a[88:89], v116 offset:24576
v_cvt_pk_bf16_f32 v36, v36, v37
v_mfma_f32_16x16x32_bf16 v[60:63], a[116:119], v[212:215], v[60:63]
ds_read_b64_tr_b16 a[90:91], v116 offset:26624
v_cvt_pk_bf16_f32 v37, v38, v39
v_mfma_f32_16x16x32_bf16 v[60:63], a[120:123], v[228:231], v[60:63]
ds_read_b64_tr_b16 a[92:93], v116 offset:28672
v_cvt_pk_bf16_f32 v38, v44, v45
v_mfma_f32_16x16x32_bf16 v[60:63], a[124:127], v[244:247], v[60:63]
s_waitcnt lgkmcnt(3)
ds_read_b64_tr_b16 a[94:95], v116 offset:30720
v_add_u32 v116, 32768, v116
v_mfma_f32_16x16x32_bf16 v[64:67], a[64:67], v[128:131], 0
s_lshl_b32 s34, s29, 5
ds_read_b64_tr_b16 a[96:97], v117 offset:0
v_cvt_pk_bf16_f32 v39, v46, v47
v_mfma_f32_16x16x32_bf16 v[64:67], a[68:71], v[144:147], v[64:67]
s_add_u32 s34, s34, s20
ds_read_b64_tr_b16 a[98:99], v117 offset:2048
buffer_store_dwordx4 v[36:39], v1, s[4:7], s12 offen offset:0 sc1
v_mfma_f32_16x16x32_bf16 v[64:67], a[72:75], v[160:163], v[64:67]
s_lshl_b32 s34, s34, 2
ds_read_b64_tr_b16 a[100:101], v117 offset:4096
v_mul_f32 v48, v48, v24
v_mfma_f32_16x16x32_bf16 v[64:67], a[76:79], v[176:179], v[64:67]
s_add_u32 s34, s34, 94380032
ds_read_b64_tr_b16 a[102:103], v117 offset:6144
v_mul_f32 v49, v49, v24
v_mfma_f32_16x16x32_bf16 v[64:67], a[80:83], v[192:195], v[64:67]
s_add_u32 s35, s34, 2048
ds_read_b64_tr_b16 a[104:105], v117 offset:8192
v_mul_f32 v50, v50, v24
v_mfma_f32_16x16x32_bf16 v[64:67], a[84:87], v[208:211], v[64:67]
s_waitcnt lgkmcnt(5)
s_mov_b32 s80, s21
ds_read_b64_tr_b16 a[106:107], v117 offset:10240
v_mul_f32 v51, v51, v24
v_mfma_f32_16x16x32_bf16 v[64:67], a[88:91], v[224:227], v[64:67]
s_and_b32 s79, s2, 16
ds_read_b64_tr_b16 a[108:109], v117 offset:12288
v_mul_f32 v56, v56, v24
v_mfma_f32_16x16x32_bf16 v[64:67], a[92:95], v[240:243], v[64:67]
s_xor_b32 s79, s79, 16
ds_read_b64_tr_b16 a[110:111], v117 offset:14336
v_mul_f32 v57, v57, v24
v_mfma_f32_16x16x32_bf16 v[68:71], a[64:67], v[132:135], 0
s_add_u32 s79, s79, s20
ds_read_b64_tr_b16 a[112:113], v117 offset:16384
v_mul_f32 v58, v58, v24
v_mfma_f32_16x16x32_bf16 v[68:71], a[68:71], v[148:151], v[68:71]
s_lshl_b32 s22, s79, 2
ds_read_b64_tr_b16 a[114:115], v117 offset:18432
v_mul_f32 v59, v59, v24
v_mfma_f32_16x16x32_bf16 v[68:71], a[72:75], v[164:167], v[68:71]
s_add_u32 s22, s22, s3
ds_read_b64_tr_b16 a[116:117], v117 offset:20480
v_cvt_pk_bf16_f32 v48, v48, v49
v_mfma_f32_16x16x32_bf16 v[68:71], a[76:79], v[180:183], v[68:71]
s_mul_i32 s25, s22, 28672
ds_read_b64_tr_b16 a[118:119], v117 offset:22528
v_cvt_pk_bf16_f32 v49, v50, v51
v_mfma_f32_16x16x32_bf16 v[68:71], a[80:83], v[196:199], v[68:71]
s_lshl_b32 s23, s80, 6
ds_read_b64_tr_b16 a[120:121], v117 offset:24576
v_cvt_pk_bf16_f32 v50, v56, v57
v_mfma_f32_16x16x32_bf16 v[68:71], a[84:87], v[212:215], v[68:71]
s_add_u32 s25, s25, s23
ds_read_b64_tr_b16 a[122:123], v117 offset:26624
v_cvt_pk_bf16_f32 v51, v58, v59
v_mfma_f32_16x16x32_bf16 v[68:71], a[88:91], v[228:231], v[68:71]
s_mul_i32 s26, s22, 229376
ds_read_b64_tr_b16 a[124:125], v117 offset:28672
buffer_store_dwordx4 v[48:51], v1, s[4:7], s8 offen offset:1024 sc1
v_mfma_f32_16x16x32_bf16 v[68:71], a[92:95], v[244:247], v[68:71]
s_waitcnt lgkmcnt(3)
s_lshl_b32 s23, s80, 10
ds_read_b64_tr_b16 a[126:127], v117 offset:30720
v_add_u32 v117, 32768, v117
v_mfma_f32_16x16x32_bf16 v[72:75], a[96:99], v[128:131], 0
s_add_u32 s26, s26, s23
ds_read_b64_tr_b16 a[64:65], v118 offset:0
v_mul_f32 v52, v52, v25
v_mfma_f32_16x16x32_bf16 v[72:75], a[100:103], v[144:147], v[72:75]
s_add_u32 s26, s26, 104857600
ds_read_b64_tr_b16 a[66:67], v118 offset:2048
v_mul_f32 v53, v53, v25
v_mfma_f32_16x16x32_bf16 v[72:75], a[104:107], v[160:163], v[72:75]
s_lshr_b32 s22, s79, 1
ds_read_b64_tr_b16 a[68:69], v118 offset:4096
v_mul_f32 v54, v54, v25
v_mfma_f32_16x16x32_bf16 v[72:75], a[108:111], v[176:179], v[72:75]
s_lshl_b32 s22, s22, 7
ds_read_b64_tr_b16 a[70:71], v118 offset:6144
v_mul_f32 v55, v55, v25
v_mfma_f32_16x16x32_bf16 v[72:75], a[112:115], v[192:195], v[72:75]
s_add_u32 s33, s22, 94380032
ds_read_b64_tr_b16 a[72:73], v118 offset:8192
v_mul_f32 v60, v60, v25
v_mfma_f32_16x16x32_bf16 v[72:75], a[116:119], v[208:211], v[72:75]
s_waitcnt lgkmcnt(5)
s_mov_b64 s[40:41], s[88:89]
ds_read_b64_tr_b16 a[74:75], v118 offset:10240
v_mul_f32 v61, v61, v25
v_mfma_f32_16x16x32_bf16 v[72:75], a[120:123], v[224:227], v[72:75]
s_mov_b32 s42, 3670016
ds_read_b64_tr_b16 a[76:77], v118 offset:12288
v_mul_f32 v62, v62, v25
v_mfma_f32_16x16x32_bf16 v[72:75], a[124:127], v[240:243], v[72:75]
s_mov_b32 s43, 0x20000
ds_read_b64_tr_b16 a[78:79], v118 offset:14336
v_mul_f32 v63, v63, v25
v_mfma_f32_16x16x32_bf16 v[76:79], a[96:99], v[132:135], 0
ds_read_b64_tr_b16 a[80:81], v118 offset:16384
v_cvt_pk_bf16_f32 v52, v52, v53
v_mfma_f32_16x16x32_bf16 v[76:79], a[100:103], v[148:151], v[76:79]
ds_read_b64_tr_b16 a[82:83], v118 offset:18432
v_cvt_pk_bf16_f32 v53, v54, v55
v_mfma_f32_16x16x32_bf16 v[76:79], a[104:107], v[164:167], v[76:79]
ds_read_b64_tr_b16 a[84:85], v118 offset:20480
v_cvt_pk_bf16_f32 v54, v60, v61
v_mfma_f32_16x16x32_bf16 v[76:79], a[108:111], v[180:183], v[76:79]
ds_read_b64_tr_b16 a[86:87], v118 offset:22528
v_cvt_pk_bf16_f32 v55, v62, v63
v_mfma_f32_16x16x32_bf16 v[76:79], a[112:115], v[196:199], v[76:79]
ds_read_b64_tr_b16 a[88:89], v118 offset:24576
buffer_store_dwordx4 v[52:55], v1, s[4:7], s12 offen offset:1024 sc1
v_mfma_f32_16x16x32_bf16 v[76:79], a[116:119], v[212:215], v[76:79]
ds_read_b64_tr_b16 a[90:91], v118 offset:26624
v_mfma_f32_16x16x32_bf16 v[76:79], a[120:123], v[228:231], v[76:79]
ds_read_b64_tr_b16 a[92:93], v118 offset:28672
v_mul_f32 v64, v64, v24
v_mfma_f32_16x16x32_bf16 v[76:79], a[124:127], v[244:247], v[76:79]
s_waitcnt lgkmcnt(8)
ds_read_b64_tr_b16 a[94:95], v118 offset:30720
v_add_u32 v118, 32768, v118
v_mfma_f32_16x16x32_bf16 v[80:83], a[64:67], v[128:131], 0
ds_read_b64_tr_b16 a[96:97], v119 offset:0
v_mul_f32 v65, v65, v24
v_mfma_f32_16x16x32_bf16 v[80:83], a[68:71], v[144:147], v[80:83]
ds_read_b64_tr_b16 a[98:99], v119 offset:2048
v_mul_f32 v66, v66, v24
v_mfma_f32_16x16x32_bf16 v[80:83], a[72:75], v[160:163], v[80:83]
s_waitcnt lgkmcnt(8)
ds_read_b64_tr_b16 a[100:101], v119 offset:4096
v_mul_f32 v67, v67, v24
v_mfma_f32_16x16x32_bf16 v[80:83], a[76:79], v[176:179], v[80:83]
ds_read_b64_tr_b16 a[102:103], v119 offset:6144
v_mul_f32 v72, v72, v24
v_mfma_f32_16x16x32_bf16 v[80:83], a[80:83], v[192:195], v[80:83]
s_waitcnt lgkmcnt(8)
ds_read_b64_tr_b16 a[104:105], v119 offset:8192
v_mul_f32 v73, v73, v24
v_mfma_f32_16x16x32_bf16 v[80:83], a[84:87], v[208:211], v[80:83]
s_waitcnt lgkmcnt(7)
ds_read_b64_tr_b16 a[106:107], v119 offset:10240
v_mul_f32 v74, v74, v24
v_mfma_f32_16x16x32_bf16 v[80:83], a[88:91], v[224:227], v[80:83]
s_waitcnt lgkmcnt(6)
ds_read_b64_tr_b16 a[108:109], v119 offset:12288
v_mul_f32 v75, v75, v24
v_mfma_f32_16x16x32_bf16 v[80:83], a[92:95], v[240:243], v[80:83]
ds_read_b64_tr_b16 a[110:111], v119 offset:14336
v_cvt_pk_bf16_f32 v64, v64, v65
v_mfma_f32_16x16x32_bf16 v[84:87], a[64:67], v[132:135], 0
ds_read_b64_tr_b16 a[112:113], v119 offset:16384
v_cvt_pk_bf16_f32 v65, v66, v67
v_mfma_f32_16x16x32_bf16 v[84:87], a[68:71], v[148:151], v[84:87]
ds_read_b64_tr_b16 a[114:115], v119 offset:18432
v_cvt_pk_bf16_f32 v66, v72, v73
v_mfma_f32_16x16x32_bf16 v[84:87], a[72:75], v[164:167], v[84:87]
ds_read_b64_tr_b16 a[116:117], v119 offset:20480
v_cvt_pk_bf16_f32 v67, v74, v75
v_mfma_f32_16x16x32_bf16 v[84:87], a[76:79], v[180:183], v[84:87]
ds_read_b64_tr_b16 a[118:119], v119 offset:22528
buffer_store_dwordx4 v[64:67], v1, s[4:7], s8 offen offset:2048 sc1
v_mfma_f32_16x16x32_bf16 v[84:87], a[80:83], v[196:199], v[84:87]
ds_read_b64_tr_b16 a[120:121], v119 offset:24576
v_mul_f32 v68, v68, v25
v_mfma_f32_16x16x32_bf16 v[84:87], a[84:87], v[212:215], v[84:87]
ds_read_b64_tr_b16 a[122:123], v119 offset:26624
v_mul_f32 v69, v69, v25
v_mfma_f32_16x16x32_bf16 v[84:87], a[88:91], v[228:231], v[84:87]
ds_read_b64_tr_b16 a[124:125], v119 offset:28672
ds_read_b64_tr_b16 a[126:127], v119 offset:30720
v_mfma_f32_16x16x32_bf16 v[84:87], a[92:95], v[244:247], v[84:87]
s_waitcnt vmcnt(21) lgkmcnt(9)
s_barrier
v_add_u32 v119, 32768, v119
v_mfma_f32_16x16x32_bf16 v[88:91], a[96:99], v[128:131], 0
ds_read_b64_tr_b16 a[64:65], v116 offset:0
v_mul_f32 v70, v70, v25
v_mfma_f32_16x16x32_bf16 v[88:91], a[100:103], v[144:147], v[88:91]
ds_read_b64_tr_b16 a[66:67], v116 offset:2048
v_mul_f32 v71, v71, v25
v_mfma_f32_16x16x32_bf16 v[88:91], a[104:107], v[160:163], v[88:91]
s_waitcnt lgkmcnt(8)
ds_read_b64_tr_b16 a[68:69], v116 offset:4096
v_mul_f32 v76, v76, v25
v_mfma_f32_16x16x32_bf16 v[88:91], a[108:111], v[176:179], v[88:91]
ds_read_b64_tr_b16 a[70:71], v116 offset:6144
v_mul_f32 v77, v77, v25
v_mfma_f32_16x16x32_bf16 v[88:91], a[112:115], v[192:195], v[88:91]
s_waitcnt lgkmcnt(8)
ds_read_b64_tr_b16 a[72:73], v116 offset:8192
v_mul_f32 v78, v78, v25
v_mfma_f32_16x16x32_bf16 v[88:91], a[116:119], v[208:211], v[88:91]
s_waitcnt lgkmcnt(7)
ds_read_b64_tr_b16 a[74:75], v116 offset:10240
v_mul_f32 v79, v79, v25
v_mfma_f32_16x16x32_bf16 v[88:91], a[120:123], v[224:227], v[88:91]
s_waitcnt lgkmcnt(6)
ds_read_b64_tr_b16 a[76:77], v116 offset:12288
v_cvt_pk_bf16_f32 v68, v68, v69
v_mfma_f32_16x16x32_bf16 v[88:91], a[124:127], v[240:243], v[88:91]
ds_read_b64_tr_b16 a[78:79], v116 offset:14336
v_cvt_pk_bf16_f32 v69, v70, v71
v_mfma_f32_16x16x32_bf16 v[92:95], a[96:99], v[132:135], 0
ds_read_b64_tr_b16 a[80:81], v116 offset:16384
v_cvt_pk_bf16_f32 v70, v76, v77
v_mfma_f32_16x16x32_bf16 v[92:95], a[100:103], v[148:151], v[92:95]
ds_read_b64_tr_b16 a[82:83], v116 offset:18432
v_cvt_pk_bf16_f32 v71, v78, v79
v_mfma_f32_16x16x32_bf16 v[92:95], a[104:107], v[164:167], v[92:95]
ds_read_b64_tr_b16 a[84:85], v116 offset:20480
buffer_store_dwordx4 v[68:71], v1, s[4:7], s12 offen offset:2048 sc1
v_mfma_f32_16x16x32_bf16 v[92:95], a[108:111], v[180:183], v[92:95]
ds_read_b64_tr_b16 a[86:87], v116 offset:22528
v_mfma_f32_16x16x32_bf16 v[92:95], a[112:115], v[196:199], v[92:95]
ds_read_b64_tr_b16 a[88:89], v116 offset:24576
v_mfma_f32_16x16x32_bf16 v[92:95], a[116:119], v[212:215], v[92:95]
ds_read_b64_tr_b16 a[90:91], v116 offset:26624
v_mfma_f32_16x16x32_bf16 v[92:95], a[120:123], v[228:231], v[92:95]
ds_read_b64_tr_b16 a[92:93], v116 offset:28672
v_mfma_f32_16x16x32_bf16 v[92:95], a[124:127], v[244:247], v[92:95]
s_waitcnt lgkmcnt(8)
ds_read_b64_tr_b16 a[94:95], v116 offset:30720
v_add_u32 v116, 4294901760, v116
v_mfma_f32_16x16x32_bf16 v[32:35], a[64:67], v[128:131], 0
s_add_u32 m0, s18, 32768
ds_read_b64_tr_b16 a[96:97], v117 offset:0
v_mul_f32 v80, v80, v24
v_mfma_f32_16x16x32_bf16 v[32:35], a[68:71], v[144:147], v[32:35]
ds_read_b64_tr_b16 a[98:99], v117 offset:2048
buffer_load_dwordx4 v112, s[36:39], s81 offen offset:0 lds
v_mfma_f32_16x16x32_bf16 v[32:35], a[72:75], v[160:163], v[32:35]
s_waitcnt lgkmcnt(8)
ds_read_b64_tr_b16 a[100:101], v117 offset:4096
v_mul_f32 v81, v81, v24
v_mfma_f32_16x16x32_bf16 v[32:35], a[76:79], v[176:179], v[32:35]
ds_read_b64_tr_b16 a[102:103], v117 offset:6144
v_mul_f32 v82, v82, v24
v_mfma_f32_16x16x32_bf16 v[32:35], a[80:83], v[192:195], v[32:35]
s_waitcnt lgkmcnt(8)
ds_read_b64_tr_b16 a[104:105], v117 offset:8192
v_mul_f32 v83, v83, v24
v_mfma_f32_16x16x32_bf16 v[32:35], a[84:87], v[208:211], v[32:35]
s_waitcnt lgkmcnt(7)
ds_read_b64_tr_b16 a[106:107], v117 offset:10240
v_mul_f32 v88, v88, v24
v_mfma_f32_16x16x32_bf16 v[32:35], a[88:91], v[224:227], v[32:35]
s_waitcnt lgkmcnt(6)
ds_read_b64_tr_b16 a[108:109], v117 offset:12288
v_mul_f32 v89, v89, v24
v_mfma_f32_16x16x32_bf16 v[32:35], a[92:95], v[240:243], v[32:35]
ds_read_b64_tr_b16 a[110:111], v117 offset:14336
v_mul_f32 v90, v90, v24
v_mfma_f32_16x16x32_bf16 v[36:39], a[64:67], v[132:135], 0
ds_read_b64_tr_b16 a[112:113], v117 offset:16384
buffer_load_dwordx4 v113, s[36:39], s81 offen offset:1024 lds
v_mfma_f32_16x16x32_bf16 v[36:39], a[68:71], v[148:151], v[36:39]
ds_read_b64_tr_b16 a[114:115], v117 offset:18432
v_mul_f32 v91, v91, v24
v_mfma_f32_16x16x32_bf16 v[36:39], a[72:75], v[164:167], v[36:39]
ds_read_b64_tr_b16 a[116:117], v117 offset:20480
v_cvt_pk_bf16_f32 v80, v80, v81
v_mfma_f32_16x16x32_bf16 v[36:39], a[76:79], v[180:183], v[36:39]
ds_read_b64_tr_b16 a[118:119], v117 offset:22528
v_cvt_pk_bf16_f32 v81, v82, v83
v_mfma_f32_16x16x32_bf16 v[36:39], a[80:83], v[196:199], v[36:39]
ds_read_b64_tr_b16 a[120:121], v117 offset:24576
v_cvt_pk_bf16_f32 v82, v88, v89
v_mfma_f32_16x16x32_bf16 v[36:39], a[84:87], v[212:215], v[36:39]
ds_read_b64_tr_b16 a[122:123], v117 offset:26624
v_cvt_pk_bf16_f32 v83, v90, v91
v_mfma_f32_16x16x32_bf16 v[36:39], a[88:91], v[228:231], v[36:39]
ds_read_b64_tr_b16 a[124:125], v117 offset:28672
buffer_store_dwordx4 v[80:83], v1, s[4:7], s8 offen offset:3072 sc1
v_mfma_f32_16x16x32_bf16 v[36:39], a[92:95], v[244:247], v[36:39]
s_waitcnt lgkmcnt(8)
ds_read_b64_tr_b16 a[126:127], v117 offset:30720
v_add_u32 v117, 4294901760, v117
v_mfma_f32_16x16x32_bf16 v[40:43], a[96:99], v[128:131], 0
ds_read_b64_tr_b16 a[64:65], v118 offset:0
buffer_load_dwordx4 v114, s[36:39], s81 offen offset:2048 lds
v_mfma_f32_16x16x32_bf16 v[40:43], a[100:103], v[144:147], v[40:43]
ds_read_b64_tr_b16 a[66:67], v118 offset:2048
v_mul_f32 v84, v84, v25
v_mfma_f32_16x16x32_bf16 v[40:43], a[104:107], v[160:163], v[40:43]
s_waitcnt lgkmcnt(8)
ds_read_b64_tr_b16 a[68:69], v118 offset:4096
v_mul_f32 v85, v85, v25
v_mfma_f32_16x16x32_bf16 v[40:43], a[108:111], v[176:179], v[40:43]
ds_read_b64_tr_b16 a[70:71], v118 offset:6144
v_mul_f32 v86, v86, v25
v_mfma_f32_16x16x32_bf16 v[40:43], a[112:115], v[192:195], v[40:43]
s_waitcnt lgkmcnt(8)
ds_read_b64_tr_b16 a[72:73], v118 offset:8192
v_mul_f32 v87, v87, v25
v_mfma_f32_16x16x32_bf16 v[40:43], a[116:119], v[208:211], v[40:43]
s_waitcnt lgkmcnt(7)
ds_read_b64_tr_b16 a[74:75], v118 offset:10240
v_mul_f32 v92, v92, v25
v_mfma_f32_16x16x32_bf16 v[40:43], a[120:123], v[224:227], v[40:43]
s_waitcnt lgkmcnt(6)
ds_read_b64_tr_b16 a[76:77], v118 offset:12288
v_mul_f32 v93, v93, v25
v_mfma_f32_16x16x32_bf16 v[40:43], a[124:127], v[240:243], v[40:43]
ds_read_b64_tr_b16 a[78:79], v118 offset:14336
buffer_load_dwordx4 v115, s[36:39], s81 offen offset:3072 lds
v_mfma_f32_16x16x32_bf16 v[44:47], a[96:99], v[132:135], 0
ds_read_b64_tr_b16 a[80:81], v118 offset:16384
v_mul_f32 v94, v94, v25
v_mfma_f32_16x16x32_bf16 v[44:47], a[100:103], v[148:151], v[44:47]
ds_read_b64_tr_b16 a[82:83], v118 offset:18432
v_mul_f32 v95, v95, v25
v_mfma_f32_16x16x32_bf16 v[44:47], a[104:107], v[164:167], v[44:47]
ds_read_b64_tr_b16 a[84:85], v118 offset:20480
v_cvt_pk_bf16_f32 v84, v84, v85
v_mfma_f32_16x16x32_bf16 v[44:47], a[108:111], v[180:183], v[44:47]
ds_read_b64_tr_b16 a[86:87], v118 offset:22528
v_cvt_pk_bf16_f32 v85, v86, v87
v_mfma_f32_16x16x32_bf16 v[44:47], a[112:115], v[196:199], v[44:47]
ds_read_b64_tr_b16 a[88:89], v118 offset:24576
v_cvt_pk_bf16_f32 v86, v92, v93
v_mfma_f32_16x16x32_bf16 v[44:47], a[116:119], v[212:215], v[44:47]
s_add_u32 s81, s81, 28672
s_add_u32 m0, s18, 36864
ds_read_b64_tr_b16 a[90:91], v118 offset:26624
v_mfma_f32_16x16x32_bf16 v[44:47], a[120:123], v[228:231], v[44:47]
ds_read_b64_tr_b16 a[92:93], v118 offset:28672
buffer_load_dwordx4 v112, s[36:39], s81 offen offset:0 lds
v_mfma_f32_16x16x32_bf16 v[44:47], a[124:127], v[244:247], v[44:47]
s_waitcnt lgkmcnt(8)
ds_read_b64_tr_b16 a[94:95], v118 offset:30720
v_add_u32 v118, 4294901760, v118
v_mfma_f32_16x16x32_bf16 v[48:51], a[64:67], v[128:131], 0
ds_read_b64_tr_b16 a[96:97], v119 offset:0
v_cvt_pk_bf16_f32 v87, v94, v95
v_mfma_f32_16x16x32_bf16 v[48:51], a[68:71], v[144:147], v[48:51]
s_waitcnt lgkmcnt(8)
ds_read_b64_tr_b16 a[98:99], v119 offset:2048
buffer_store_dwordx4 v[84:87], v1, s[4:7], s12 offen offset:3072 sc1
v_mfma_f32_16x16x32_bf16 v[48:51], a[72:75], v[160:163], v[48:51]
s_add_u32 s8, s8, 4096
s_add_u32 s12, s12, 4096
ds_read_b64_tr_b16 a[100:101], v119 offset:4096
v_mfma_f32_16x16x32_bf16 v[48:51], a[76:79], v[176:179], v[48:51]
s_waitcnt lgkmcnt(8)
ds_read_b64_tr_b16 a[102:103], v119 offset:6144
v_mul_f32 v32, v32, v24
v_mfma_f32_16x16x32_bf16 v[48:51], a[80:83], v[192:195], v[48:51]
s_waitcnt lgkmcnt(8)
ds_read_b64_tr_b16 a[104:105], v119 offset:8192
v_mul_f32 v33, v33, v24
v_mfma_f32_16x16x32_bf16 v[48:51], a[84:87], v[208:211], v[48:51]
s_waitcnt lgkmcnt(7)
ds_read_b64_tr_b16 a[106:107], v119 offset:10240
buffer_load_dwordx4 v113, s[36:39], s81 offen offset:1024 lds
v_mfma_f32_16x16x32_bf16 v[48:51], a[88:91], v[224:227], v[48:51]
s_waitcnt lgkmcnt(6)
ds_read_b64_tr_b16 a[108:109], v119 offset:12288
v_mul_f32 v34, v34, v24
v_mfma_f32_16x16x32_bf16 v[48:51], a[92:95], v[240:243], v[48:51]
ds_read_b64_tr_b16 a[110:111], v119 offset:14336
v_mul_f32 v35, v35, v24
v_mfma_f32_16x16x32_bf16 v[52:55], a[64:67], v[132:135], 0
ds_read_b64_tr_b16 a[112:113], v119 offset:16384
v_mul_f32 v40, v40, v24
v_mfma_f32_16x16x32_bf16 v[52:55], a[68:71], v[148:151], v[52:55]
ds_read_b64_tr_b16 a[114:115], v119 offset:18432
v_mul_f32 v41, v41, v24
v_mfma_f32_16x16x32_bf16 v[52:55], a[72:75], v[164:167], v[52:55]
ds_read_b64_tr_b16 a[116:117], v119 offset:20480
v_mul_f32 v42, v42, v24
v_mfma_f32_16x16x32_bf16 v[52:55], a[76:79], v[180:183], v[52:55]
ds_read_b64_tr_b16 a[118:119], v119 offset:22528
v_mul_f32 v43, v43, v24
v_mfma_f32_16x16x32_bf16 v[52:55], a[80:83], v[196:199], v[52:55]
ds_read_b64_tr_b16 a[120:121], v119 offset:24576
buffer_load_dwordx4 v114, s[36:39], s81 offen offset:2048 lds
v_mfma_f32_16x16x32_bf16 v[52:55], a[84:87], v[212:215], v[52:55]
ds_read_b64_tr_b16 a[122:123], v119 offset:26624
v_cvt_pk_bf16_f32 v32, v32, v33
v_mfma_f32_16x16x32_bf16 v[52:55], a[88:91], v[228:231], v[52:55]
ds_read_b64_tr_b16 a[124:125], v119 offset:28672
ds_read_b64_tr_b16 a[126:127], v119 offset:30720
v_mfma_f32_16x16x32_bf16 v[52:55], a[92:95], v[244:247], v[52:55]
s_waitcnt vmcnt(23) lgkmcnt(9)
s_barrier
v_add_u32 v119, 4294901760, v119
v_mfma_f32_16x16x32_bf16 v[56:59], a[96:99], v[128:131], 0
ds_read_b64_tr_b16 a[64:65], v116 offset:0
v_cvt_pk_bf16_f32 v33, v34, v35
v_mfma_f32_16x16x32_bf16 v[56:59], a[100:103], v[144:147], v[56:59]
ds_read_b64_tr_b16 a[66:67], v116 offset:2048
v_cvt_pk_bf16_f32 v34, v40, v41
v_mfma_f32_16x16x32_bf16 v[56:59], a[104:107], v[160:163], v[56:59]
s_waitcnt lgkmcnt(8)
ds_read_b64_tr_b16 a[68:69], v116 offset:4096
v_cvt_pk_bf16_f32 v35, v42, v43
v_mfma_f32_16x16x32_bf16 v[56:59], a[108:111], v[176:179], v[56:59]
ds_read_b64_tr_b16 a[70:71], v116 offset:6144
buffer_load_dwordx4 v115, s[36:39], s81 offen offset:3072 lds
v_mfma_f32_16x16x32_bf16 v[56:59], a[112:115], v[192:195], v[56:59]
s_waitcnt lgkmcnt(8)
ds_read_b64_tr_b16 a[72:73], v116 offset:8192
buffer_store_dwordx4 v[32:35], v1, s[4:7], s8 offen offset:0 sc1
v_mfma_f32_16x16x32_bf16 v[56:59], a[116:119], v[208:211], v[56:59]
PAD_15:
s_cbranch_execz M_tret
s_waitcnt lgkmcnt(7)
ds_read_b64_tr_b16 a[74:75], v116 offset:10240
v_mul_f32 v36, v36, v25
v_mfma_f32_16x16x32_bf16 v[56:59], a[120:123], v[224:227], v[56:59]
s_waitcnt lgkmcnt(6)
ds_read_b64_tr_b16 a[76:77], v116 offset:12288
v_mul_f32 v37, v37, v25
v_mfma_f32_16x16x32_bf16 v[56:59], a[124:127], v[240:243], v[56:59]
ds_read_b64_tr_b16 a[78:79], v116 offset:14336
v_mul_f32 v38, v38, v25
v_mfma_f32_16x16x32_bf16 v[60:63], a[96:99], v[132:135], 0
ds_read_b64_tr_b16 a[80:81], v116 offset:16384
v_mul_f32 v39, v39, v25
v_mfma_f32_16x16x32_bf16 v[60:63], a[100:103], v[148:151], v[60:63]
s_sub_u32 s81, s81, 28544
ds_read_b64_tr_b16 a[82:83], v116 offset:18432
v_mul_f32 v44, v44, v25
v_mfma_f32_16x16x32_bf16 v[60:63], a[104:107], v[164:167], v[60:63]
ds_read_b64_tr_b16 a[84:85], v116 offset:20480
v_mul_f32 v45, v45, v25
v_mfma_f32_16x16x32_bf16 v[60:63], a[108:111], v[180:183], v[60:63]
ds_read_b64_tr_b16 a[86:87], v116 offset:22528
v_mul_f32 v46, v46, v25
v_mfma_f32_16x16x32_bf16 v[60:63], a[112:115], v[196:199], v[60:63]
ds_read_b64_tr_b16 a[88:89], v116 offset:24576
v_mul_f32 v47, v47, v25
v_mfma_f32_16x16x32_bf16 v[60:63], a[116:119], v[212:215], v[60:63]
ds_read_b64_tr_b16 a[90:91], v116 offset:26624
v_cvt_pk_bf16_f32 v36, v36, v37
v_mfma_f32_16x16x32_bf16 v[60:63], a[120:123], v[228:231], v[60:63]
ds_read_b64_tr_b16 a[92:93], v116 offset:28672
v_cvt_pk_bf16_f32 v37, v38, v39
v_mfma_f32_16x16x32_bf16 v[60:63], a[124:127], v[244:247], v[60:63]
s_waitcnt lgkmcnt(8)
ds_read_b64_tr_b16 a[94:95], v116 offset:30720
v_add_u32 v116, 4294901760, v116
v_mfma_f32_16x16x32_bf16 v[64:67], a[64:67], v[128:131], 0
s_add_u32 m0, s18, 98304
ds_read_b64_tr_b16 a[96:97], v117 offset:0
v_cvt_pk_bf16_f32 v38, v44, v45
v_mfma_f32_16x16x32_bf16 v[64:67], a[68:71], v[144:147], v[64:67]
ds_read_b64_tr_b16 a[98:99], v117 offset:2048
buffer_load_dwordx4 v112, s[36:39], s81 offen offset:0 lds
v_mfma_f32_16x16x32_bf16 v[64:67], a[72:75], v[160:163], v[64:67]
s_waitcnt lgkmcnt(8)
ds_read_b64_tr_b16 a[100:101], v117 offset:4096
v_cvt_pk_bf16_f32 v39, v46, v47
v_mfma_f32_16x16x32_bf16 v[64:67], a[76:79], v[176:179], v[64:67]
ds_read_b64_tr_b16 a[102:103], v117 offset:6144
buffer_store_dwordx4 v[36:39], v1, s[4:7], s12 offen offset:0 sc1
v_mfma_f32_16x16x32_bf16 v[64:67], a[80:83], v[192:195], v[64:67]
s_waitcnt lgkmcnt(8)
ds_read_b64_tr_b16 a[104:105], v117 offset:8192
v_mul_f32 v48, v48, v24
v_mfma_f32_16x16x32_bf16 v[64:67], a[84:87], v[208:211], v[64:67]
s_waitcnt lgkmcnt(7)
ds_read_b64_tr_b16 a[106:107], v117 offset:10240
v_mul_f32 v49, v49, v24
v_mfma_f32_16x16x32_bf16 v[64:67], a[88:91], v[224:227], v[64:67]
s_waitcnt lgkmcnt(6)
ds_read_b64_tr_b16 a[108:109], v117 offset:12288
v_mul_f32 v50, v50, v24
v_mfma_f32_16x16x32_bf16 v[64:67], a[92:95], v[240:243], v[64:67]
ds_read_b64_tr_b16 a[110:111], v117 offset:14336
v_mul_f32 v51, v51, v24
v_mfma_f32_16x16x32_bf16 v[68:71], a[64:67], v[132:135], 0
ds_read_b64_tr_b16 a[112:113], v117 offset:16384
buffer_load_dwordx4 v113, s[36:39], s81 offen offset:1024 lds
v_mfma_f32_16x16x32_bf16 v[68:71], a[68:71], v[148:151], v[68:71]
ds_read_b64_tr_b16 a[114:115], v117 offset:18432
v_mul_f32 v56, v56, v24
v_mfma_f32_16x16x32_bf16 v[68:71], a[72:75], v[164:167], v[68:71]
ds_read_b64_tr_b16 a[116:117], v117 offset:20480
v_mul_f32 v57, v57, v24
v_mfma_f32_16x16x32_bf16 v[68:71], a[76:79], v[180:183], v[68:71]
ds_read_b64_tr_b16 a[118:119], v117 offset:22528
v_mul_f32 v58, v58, v24
v_mfma_f32_16x16x32_bf16 v[68:71], a[80:83], v[196:199], v[68:71]
ds_read_b64_tr_b16 a[120:121], v117 offset:24576
v_mul_f32 v59, v59, v24
v_mfma_f32_16x16x32_bf16 v[68:71], a[84:87], v[212:215], v[68:71]
ds_read_b64_tr_b16 a[122:123], v117 offset:26624
v_cvt_pk_bf16_f32 v48, v48, v49
v_mfma_f32_16x16x32_bf16 v[68:71], a[88:91], v[228:231], v[68:71]
ds_read_b64_tr_b16 a[124:125], v117 offset:28672
v_cvt_pk_bf16_f32 v49, v50, v51
v_mfma_f32_16x16x32_bf16 v[68:71], a[92:95], v[244:247], v[68:71]
s_waitcnt lgkmcnt(8)
ds_read_b64_tr_b16 a[126:127], v117 offset:30720
v_add_u32 v117, 4294901760, v117
v_mfma_f32_16x16x32_bf16 v[72:75], a[96:99], v[128:131], 0
ds_read_b64_tr_b16 a[64:65], v118 offset:0
buffer_load_dwordx4 v114, s[36:39], s81 offen offset:2048 lds
v_mfma_f32_16x16x32_bf16 v[72:75], a[100:103], v[144:147], v[72:75]
ds_read_b64_tr_b16 a[66:67], v118 offset:2048
v_cvt_pk_bf16_f32 v50, v56, v57
v_mfma_f32_16x16x32_bf16 v[72:75], a[104:107], v[160:163], v[72:75]
s_waitcnt lgkmcnt(8)
ds_read_b64_tr_b16 a[68:69], v118 offset:4096
v_cvt_pk_bf16_f32 v51, v58, v59
v_mfma_f32_16x16x32_bf16 v[72:75], a[108:111], v[176:179], v[72:75]
ds_read_b64_tr_b16 a[70:71], v118 offset:6144
buffer_store_dwordx4 v[48:51], v1, s[4:7], s8 offen offset:1024 sc1
v_mfma_f32_16x16x32_bf16 v[72:75], a[112:115], v[192:195], v[72:75]
s_waitcnt lgkmcnt(8)
ds_read_b64_tr_b16 a[72:73], v118 offset:8192
v_mul_f32 v52, v52, v25
v_mfma_f32_16x16x32_bf16 v[72:75], a[116:119], v[208:211], v[72:75]
s_waitcnt lgkmcnt(7)
ds_read_b64_tr_b16 a[74:75], v118 offset:10240
v_mul_f32 v53, v53, v25
v_mfma_f32_16x16x32_bf16 v[72:75], a[120:123], v[224:227], v[72:75]
s_waitcnt lgkmcnt(6)
ds_read_b64_tr_b16 a[76:77], v118 offset:12288
v_mul_f32 v54, v54, v25
v_mfma_f32_16x16x32_bf16 v[72:75], a[124:127], v[240:243], v[72:75]
ds_read_b64_tr_b16 a[78:79], v118 offset:14336
buffer_load_dwordx4 v115, s[36:39], s81 offen offset:3072 lds
v_mfma_f32_16x16x32_bf16 v[76:79], a[96:99], v[132:135], 0
ds_read_b64_tr_b16 a[80:81], v118 offset:16384
v_mul_f32 v55, v55, v25
v_mfma_f32_16x16x32_bf16 v[76:79], a[100:103], v[148:151], v[76:79]
ds_read_b64_tr_b16 a[82:83], v118 offset:18432
v_mul_f32 v60, v60, v25
v_mfma_f32_16x16x32_bf16 v[76:79], a[104:107], v[164:167], v[76:79]
ds_read_b64_tr_b16 a[84:85], v118 offset:20480
v_mul_f32 v61, v61, v25
v_mfma_f32_16x16x32_bf16 v[76:79], a[108:111], v[180:183], v[76:79]
ds_read_b64_tr_b16 a[86:87], v118 offset:22528
v_mul_f32 v62, v62, v25
v_mfma_f32_16x16x32_bf16 v[76:79], a[112:115], v[196:199], v[76:79]
ds_read_b64_tr_b16 a[88:89], v118 offset:24576
v_mul_f32 v63, v63, v25
v_mfma_f32_16x16x32_bf16 v[76:79], a[116:119], v[212:215], v[76:79]
s_add_u32 s81, s81, 28672
s_add_u32 m0, s18, 102400
ds_read_b64_tr_b16 a[90:91], v118 offset:26624
v_mfma_f32_16x16x32_bf16 v[76:79], a[120:123], v[228:231], v[76:79]
ds_read_b64_tr_b16 a[92:93], v118 offset:28672
buffer_load_dwordx4 v112, s[36:39], s81 offen offset:0 lds
v_mfma_f32_16x16x32_bf16 v[76:79], a[124:127], v[244:247], v[76:79]
s_waitcnt lgkmcnt(8)
ds_read_b64_tr_b16 a[94:95], v118 offset:30720
v_add_u32 v118, 4294901760, v118
v_mfma_f32_16x16x32_bf16 v[80:83], a[64:67], v[128:131], 0
ds_read_b64_tr_b16 a[96:97], v119 offset:0
v_cvt_pk_bf16_f32 v52, v52, v53
v_mfma_f32_16x16x32_bf16 v[80:83], a[68:71], v[144:147], v[80:83]
ds_read_b64_tr_b16 a[98:99], v119 offset:2048
v_cvt_pk_bf16_f32 v53, v54, v55
v_mfma_f32_16x16x32_bf16 v[80:83], a[72:75], v[160:163], v[80:83]
s_waitcnt lgkmcnt(8)
ds_read_b64_tr_b16 a[100:101], v119 offset:4096
v_cvt_pk_bf16_f32 v54, v60, v61
v_mfma_f32_16x16x32_bf16 v[80:83], a[76:79], v[176:179], v[80:83]
ds_read_b64_tr_b16 a[102:103], v119 offset:6144
v_cvt_pk_bf16_f32 v55, v62, v63
v_mfma_f32_16x16x32_bf16 v[80:83], a[80:83], v[192:195], v[80:83]
s_waitcnt lgkmcnt(8)
ds_read_b64_tr_b16 a[104:105], v119 offset:8192
buffer_store_dwordx4 v[52:55], v1, s[4:7], s12 offen offset:1024 sc1
v_mfma_f32_16x16x32_bf16 v[80:83], a[84:87], v[208:211], v[80:83]
s_waitcnt lgkmcnt(7)
ds_read_b64_tr_b16 a[106:107], v119 offset:10240
buffer_load_dwordx4 v113, s[36:39], s81 offen offset:1024 lds
v_mfma_f32_16x16x32_bf16 v[80:83], a[88:91], v[224:227], v[80:83]
s_waitcnt lgkmcnt(6)
ds_read_b64_tr_b16 a[108:109], v119 offset:12288
v_mul_f32 v64, v64, v24
v_mfma_f32_16x16x32_bf16 v[80:83], a[92:95], v[240:243], v[80:83]
ds_read_b64_tr_b16 a[110:111], v119 offset:14336
v_mul_f32 v65, v65, v24
v_mfma_f32_16x16x32_bf16 v[84:87], a[64:67], v[132:135], 0
ds_read_b64_tr_b16 a[112:113], v119 offset:16384
v_mul_f32 v66, v66, v24
v_mfma_f32_16x16x32_bf16 v[84:87], a[68:71], v[148:151], v[84:87]
ds_read_b64_tr_b16 a[114:115], v119 offset:18432
v_mul_f32 v67, v67, v24
v_mfma_f32_16x16x32_bf16 v[84:87], a[72:75], v[164:167], v[84:87]
ds_read_b64_tr_b16 a[116:117], v119 offset:20480
v_mul_f32 v72, v72, v24
v_mfma_f32_16x16x32_bf16 v[84:87], a[76:79], v[180:183], v[84:87]
ds_read_b64_tr_b16 a[118:119], v119 offset:22528
v_mul_f32 v73, v73, v24
v_mfma_f32_16x16x32_bf16 v[84:87], a[80:83], v[196:199], v[84:87]
ds_read_b64_tr_b16 a[120:121], v119 offset:24576
buffer_load_dwordx4 v114, s[36:39], s81 offen offset:2048 lds
v_mfma_f32_16x16x32_bf16 v[84:87], a[84:87], v[212:215], v[84:87]
ds_read_b64_tr_b16 a[122:123], v119 offset:26624
v_mul_f32 v74, v74, v24
v_mfma_f32_16x16x32_bf16 v[84:87], a[88:91], v[228:231], v[84:87]
ds_read_b64_tr_b16 a[124:125], v119 offset:28672
ds_read_b64_tr_b16 a[126:127], v119 offset:30720
v_mfma_f32_16x16x32_bf16 v[84:87], a[92:95], v[244:247], v[84:87]
s_waitcnt vmcnt(27) lgkmcnt(9)
s_barrier
v_add_u32 v119, 4294901760, v119
v_mfma_f32_16x16x32_bf16 v[88:91], a[96:99], v[128:131], 0
ds_read_b64_tr_b16 a[64:65], v116 offset:0
v_mul_f32 v75, v75, v24
v_mfma_f32_16x16x32_bf16 v[88:91], a[100:103], v[144:147], v[88:91]
ds_read_b64_tr_b16 a[66:67], v116 offset:2048
v_cvt_pk_bf16_f32 v64, v64, v65
v_mfma_f32_16x16x32_bf16 v[88:91], a[104:107], v[160:163], v[88:91]
s_waitcnt lgkmcnt(8)
ds_read_b64_tr_b16 a[68:69], v116 offset:4096
v_cvt_pk_bf16_f32 v65, v66, v67
v_mfma_f32_16x16x32_bf16 v[88:91], a[108:111], v[176:179], v[88:91]
ds_read_b64_tr_b16 a[70:71], v116 offset:6144
buffer_load_dwordx4 v115, s[36:39], s81 offen offset:3072 lds
v_mfma_f32_16x16x32_bf16 v[88:91], a[112:115], v[192:195], v[88:91]
s_waitcnt lgkmcnt(8)
ds_read_b64_tr_b16 a[72:73], v116 offset:8192
v_cvt_pk_bf16_f32 v66, v72, v73
v_mfma_f32_16x16x32_bf16 v[88:91], a[116:119], v[208:211], v[88:91]
s_waitcnt lgkmcnt(7)
ds_read_b64_tr_b16 a[74:75], v116 offset:10240
v_cvt_pk_bf16_f32 v67, v74, v75
v_mfma_f32_16x16x32_bf16 v[88:91], a[120:123], v[224:227], v[88:91]
s_waitcnt lgkmcnt(6)
ds_read_b64_tr_b16 a[76:77], v116 offset:12288
buffer_store_dwordx4 v[64:67], v1, s[4:7], s8 offen offset:2048 sc1
v_mfma_f32_16x16x32_bf16 v[88:91], a[124:127], v[240:243], v[88:91]
ds_read_b64_tr_b16 a[78:79], v116 offset:14336
v_mul_f32 v68, v68, v25
v_mfma_f32_16x16x32_bf16 v[92:95], a[96:99], v[132:135], 0
ds_read_b64_tr_b16 a[80:81], v116 offset:16384
v_mul_f32 v69, v69, v25
v_mfma_f32_16x16x32_bf16 v[92:95], a[100:103], v[148:151], v[92:95]
s_sub_u32 s81, s81, 28544
ds_read_b64_tr_b16 a[82:83], v116 offset:18432
v_mul_f32 v70, v70, v25
v_mfma_f32_16x16x32_bf16 v[92:95], a[104:107], v[164:167], v[92:95]
ds_read_b64_tr_b16 a[84:85], v116 offset:20480
v_mul_f32 v71, v71, v25
v_mfma_f32_16x16x32_bf16 v[92:95], a[108:111], v[180:183], v[92:95]
ds_read_b64_tr_b16 a[86:87], v116 offset:22528
v_mul_f32 v76, v76, v25
v_mfma_f32_16x16x32_bf16 v[92:95], a[112:115], v[196:199], v[92:95]
ds_read_b64_tr_b16 a[88:89], v116 offset:24576
v_mul_f32 v77, v77, v25
v_mfma_f32_16x16x32_bf16 v[92:95], a[116:119], v[212:215], v[92:95]
ds_read_b64_tr_b16 a[90:91], v116 offset:26624
v_mul_f32 v78, v78, v25
v_mfma_f32_16x16x32_bf16 v[92:95], a[120:123], v[228:231], v[92:95]
ds_read_b64_tr_b16 a[92:93], v116 offset:28672
v_mul_f32 v79, v79, v25
v_mfma_f32_16x16x32_bf16 v[92:95], a[124:127], v[244:247], v[92:95]
s_waitcnt lgkmcnt(8)
ds_read_b64_tr_b16 a[94:95], v116 offset:30720
v_add_u32 v116, 32768, v116
v_mfma_f32_16x16x32_bf16 v[32:35], a[64:67], v[128:131], 0
ds_read_b64_tr_b16 a[96:97], v117 offset:0
v_cvt_pk_bf16_f32 v68, v68, v69
v_mfma_f32_16x16x32_bf16 v[32:35], a[68:71], v[144:147], v[32:35]
ds_read_b64_tr_b16 a[98:99], v117 offset:2048
v_cvt_pk_bf16_f32 v69, v70, v71
v_mfma_f32_16x16x32_bf16 v[32:35], a[72:75], v[160:163], v[32:35]
s_waitcnt lgkmcnt(8)
ds_read_b64_tr_b16 a[100:101], v117 offset:4096
v_cvt_pk_bf16_f32 v70, v76, v77
v_mfma_f32_16x16x32_bf16 v[32:35], a[76:79], v[176:179], v[32:35]
ds_read_b64_tr_b16 a[102:103], v117 offset:6144
v_cvt_pk_bf16_f32 v71, v78, v79
v_mfma_f32_16x16x32_bf16 v[32:35], a[80:83], v[192:195], v[32:35]
s_waitcnt lgkmcnt(8)
ds_read_b64_tr_b16 a[104:105], v117 offset:8192
buffer_store_dwordx4 v[68:71], v1, s[4:7], s12 offen offset:2048 sc1
v_mfma_f32_16x16x32_bf16 v[32:35], a[84:87], v[208:211], v[32:35]
s_waitcnt lgkmcnt(7)
ds_read_b64_tr_b16 a[106:107], v117 offset:10240
v_mul_f32 v80, v80, v24
v_mfma_f32_16x16x32_bf16 v[32:35], a[88:91], v[224:227], v[32:35]
s_waitcnt lgkmcnt(6)
ds_read_b64_tr_b16 a[108:109], v117 offset:12288
v_mul_f32 v81, v81, v24
v_mfma_f32_16x16x32_bf16 v[32:35], a[92:95], v[240:243], v[32:35]
ds_read_b64_tr_b16 a[110:111], v117 offset:14336
v_mul_f32 v82, v82, v24
v_mfma_f32_16x16x32_bf16 v[36:39], a[64:67], v[132:135], 0
ds_read_b64_tr_b16 a[112:113], v117 offset:16384
v_mul_f32 v83, v83, v24
v_mfma_f32_16x16x32_bf16 v[36:39], a[68:71], v[148:151], v[36:39]
ds_read_b64_tr_b16 a[114:115], v117 offset:18432
v_mul_f32 v88, v88, v24
v_mfma_f32_16x16x32_bf16 v[36:39], a[72:75], v[164:167], v[36:39]
ds_read_b64_tr_b16 a[116:117], v117 offset:20480
v_mul_f32 v89, v89, v24
v_mfma_f32_16x16x32_bf16 v[36:39], a[76:79], v[180:183], v[36:39]
ds_read_b64_tr_b16 a[118:119], v117 offset:22528
v_mul_f32 v90, v90, v24
v_mfma_f32_16x16x32_bf16 v[36:39], a[80:83], v[196:199], v[36:39]
ds_read_b64_tr_b16 a[120:121], v117 offset:24576
v_mul_f32 v91, v91, v24
v_mfma_f32_16x16x32_bf16 v[36:39], a[84:87], v[212:215], v[36:39]
ds_read_b64_tr_b16 a[122:123], v117 offset:26624
v_cvt_pk_bf16_f32 v80, v80, v81
v_mfma_f32_16x16x32_bf16 v[36:39], a[88:91], v[228:231], v[36:39]
ds_read_b64_tr_b16 a[124:125], v117 offset:28672
v_cvt_pk_bf16_f32 v81, v82, v83
v_mfma_f32_16x16x32_bf16 v[36:39], a[92:95], v[244:247], v[36:39]
s_waitcnt lgkmcnt(8)
ds_read_b64_tr_b16 a[126:127], v117 offset:30720
v_add_u32 v117, 32768, v117
v_mfma_f32_16x16x32_bf16 v[40:43], a[96:99], v[128:131], 0
ds_read_b64_tr_b16 a[64:65], v118 offset:0
v_cvt_pk_bf16_f32 v82, v88, v89
v_mfma_f32_16x16x32_bf16 v[40:43], a[100:103], v[144:147], v[40:43]
ds_read_b64_tr_b16 a[66:67], v118 offset:2048
v_cvt_pk_bf16_f32 v83, v90, v91
v_mfma_f32_16x16x32_bf16 v[40:43], a[104:107], v[160:163], v[40:43]
s_waitcnt lgkmcnt(8)
ds_read_b64_tr_b16 a[68:69], v118 offset:4096
buffer_store_dwordx4 v[80:83], v1, s[4:7], s8 offen offset:3072 sc1
v_mfma_f32_16x16x32_bf16 v[40:43], a[108:111], v[176:179], v[40:43]
ds_read_b64_tr_b16 a[70:71], v118 offset:6144
v_mul_f32 v84, v84, v25
v_mfma_f32_16x16x32_bf16 v[40:43], a[112:115], v[192:195], v[40:43]
s_waitcnt lgkmcnt(8)
ds_read_b64_tr_b16 a[72:73], v118 offset:8192
v_mul_f32 v85, v85, v25
v_mfma_f32_16x16x32_bf16 v[40:43], a[116:119], v[208:211], v[40:43]
s_waitcnt lgkmcnt(7)
ds_read_b64_tr_b16 a[74:75], v118 offset:10240
v_mul_f32 v86, v86, v25
v_mfma_f32_16x16x32_bf16 v[40:43], a[120:123], v[224:227], v[40:43]
s_waitcnt lgkmcnt(6)
ds_read_b64_tr_b16 a[76:77], v118 offset:12288
v_mul_f32 v87, v87, v25
v_mfma_f32_16x16x32_bf16 v[40:43], a[124:127], v[240:243], v[40:43]
ds_read_b64_tr_b16 a[78:79], v118 offset:14336
v_mul_f32 v92, v92, v25
v_mfma_f32_16x16x32_bf16 v[44:47], a[96:99], v[132:135], 0
ds_read_b64_tr_b16 a[80:81], v118 offset:16384
v_mul_f32 v93, v93, v25
v_mfma_f32_16x16x32_bf16 v[44:47], a[100:103], v[148:151], v[44:47]
ds_read_b64_tr_b16 a[82:83], v118 offset:18432
v_mul_f32 v94, v94, v25
v_mfma_f32_16x16x32_bf16 v[44:47], a[104:107], v[164:167], v[44:47]
ds_read_b64_tr_b16 a[84:85], v118 offset:20480
v_mul_f32 v95, v95, v25
v_mfma_f32_16x16x32_bf16 v[44:47], a[108:111], v[180:183], v[44:47]
ds_read_b64_tr_b16 a[86:87], v118 offset:22528
v_cvt_pk_bf16_f32 v84, v84, v85
v_mfma_f32_16x16x32_bf16 v[44:47], a[112:115], v[196:199], v[44:47]
ds_read_b64_tr_b16 a[88:89], v118 offset:24576
v_cvt_pk_bf16_f32 v85, v86, v87
v_mfma_f32_16x16x32_bf16 v[44:47], a[116:119], v[212:215], v[44:47]
ds_read_b64_tr_b16 a[90:91], v118 offset:26624
v_cvt_pk_bf16_f32 v86, v92, v93
v_mfma_f32_16x16x32_bf16 v[44:47], a[120:123], v[228:231], v[44:47]
ds_read_b64_tr_b16 a[92:93], v118 offset:28672
v_cvt_pk_bf16_f32 v87, v94, v95
v_mfma_f32_16x16x32_bf16 v[44:47], a[124:127], v[244:247], v[44:47]
s_waitcnt lgkmcnt(8)
ds_read_b64_tr_b16 a[94:95], v118 offset:30720
v_add_u32 v118, 32768, v118
v_mfma_f32_16x16x32_bf16 v[48:51], a[64:67], v[128:131], 0
ds_read_b64_tr_b16 a[96:97], v119 offset:0
buffer_store_dwordx4 v[84:87], v1, s[4:7], s12 offen offset:3072 sc1
v_mfma_f32_16x16x32_bf16 v[48:51], a[68:71], v[144:147], v[48:51]
s_add_u32 s8, s8, 4096
s_add_u32 s12, s12, 4096
ds_read_b64_tr_b16 a[98:99], v119 offset:2048
v_mfma_f32_16x16x32_bf16 v[48:51], a[72:75], v[160:163], v[48:51]
s_waitcnt lgkmcnt(8)
ds_read_b64_tr_b16 a[100:101], v119 offset:4096
v_mul_f32 v32, v32, v24
v_mfma_f32_16x16x32_bf16 v[48:51], a[76:79], v[176:179], v[48:51]
ds_read_b64_tr_b16 a[102:103], v119 offset:6144
v_mul_f32 v33, v33, v24
v_mfma_f32_16x16x32_bf16 v[48:51], a[80:83], v[192:195], v[48:51]
s_waitcnt lgkmcnt(8)
ds_read_b64_tr_b16 a[104:105], v119 offset:8192
v_mul_f32 v34, v34, v24
v_mfma_f32_16x16x32_bf16 v[48:51], a[84:87], v[208:211], v[48:51]
s_waitcnt lgkmcnt(7)
ds_read_b64_tr_b16 a[106:107], v119 offset:10240
v_mul_f32 v35, v35, v24
v_mfma_f32_16x16x32_bf16 v[48:51], a[88:91], v[224:227], v[48:51]
s_waitcnt lgkmcnt(6)
ds_read_b64_tr_b16 a[108:109], v119 offset:12288
v_mul_f32 v40, v40, v24
v_mfma_f32_16x16x32_bf16 v[48:51], a[92:95], v[240:243], v[48:51]
ds_read_b64_tr_b16 a[110:111], v119 offset:14336
v_mul_f32 v41, v41, v24
v_mfma_f32_16x16x32_bf16 v[52:55], a[64:67], v[132:135], 0
ds_read_b64_tr_b16 a[112:113], v119 offset:16384
v_mul_f32 v42, v42, v24
v_mfma_f32_16x16x32_bf16 v[52:55], a[68:71], v[148:151], v[52:55]
ds_read_b64_tr_b16 a[114:115], v119 offset:18432
v_mul_f32 v43, v43, v24
v_mfma_f32_16x16x32_bf16 v[52:55], a[72:75], v[164:167], v[52:55]
ds_read_b64_tr_b16 a[116:117], v119 offset:20480
v_cvt_pk_bf16_f32 v32, v32, v33
v_mfma_f32_16x16x32_bf16 v[52:55], a[76:79], v[180:183], v[52:55]
ds_read_b64_tr_b16 a[118:119], v119 offset:22528
v_cvt_pk_bf16_f32 v33, v34, v35
v_mfma_f32_16x16x32_bf16 v[52:55], a[80:83], v[196:199], v[52:55]
ds_read_b64_tr_b16 a[120:121], v119 offset:24576
v_cvt_pk_bf16_f32 v34, v40, v41
v_mfma_f32_16x16x32_bf16 v[52:55], a[84:87], v[212:215], v[52:55]
ds_read_b64_tr_b16 a[122:123], v119 offset:26624
v_cvt_pk_bf16_f32 v35, v42, v43
v_mfma_f32_16x16x32_bf16 v[52:55], a[88:91], v[228:231], v[52:55]
ds_read_b64_tr_b16 a[124:125], v119 offset:28672
ds_read_b64_tr_b16 a[126:127], v119 offset:30720
v_mfma_f32_16x16x32_bf16 v[52:55], a[92:95], v[244:247], v[52:55]
s_waitcnt vmcnt(16) lgkmcnt(9)
s_barrier
v_add_u32 v119, 32768, v119
v_mfma_f32_16x16x32_bf16 v[56:59], a[96:99], v[128:131], 0
ds_read_b64_tr_b16 a[64:65], v116 offset:0
buffer_store_dwordx4 v[32:35], v1, s[4:7], s8 offen offset:0 sc1
v_mfma_f32_16x16x32_bf16 v[56:59], a[100:103], v[144:147], v[56:59]
ds_read_b64_tr_b16 a[66:67], v116 offset:2048
v_mul_f32 v36, v36, v25
v_mfma_f32_16x16x32_bf16 v[56:59], a[104:107], v[160:163], v[56:59]
s_waitcnt lgkmcnt(8)
ds_read_b64_tr_b16 a[68:69], v116 offset:4096
v_mul_f32 v37, v37, v25
v_mfma_f32_16x16x32_bf16 v[56:59], a[108:111], v[176:179], v[56:59]
ds_read_b64_tr_b16 a[70:71], v116 offset:6144
v_mul_f32 v38, v38, v25
v_mfma_f32_16x16x32_bf16 v[56:59], a[112:115], v[192:195], v[56:59]
s_waitcnt lgkmcnt(8)
ds_read_b64_tr_b16 a[72:73], v116 offset:8192
v_mul_f32 v39, v39, v25
v_mfma_f32_16x16x32_bf16 v[56:59], a[116:119], v[208:211], v[56:59]
s_waitcnt lgkmcnt(7)
ds_read_b64_tr_b16 a[74:75], v116 offset:10240
v_mul_f32 v44, v44, v25
v_mfma_f32_16x16x32_bf16 v[56:59], a[120:123], v[224:227], v[56:59]
s_waitcnt lgkmcnt(6)
ds_read_b64_tr_b16 a[76:77], v116 offset:12288
v_mul_f32 v45, v45, v25
v_mfma_f32_16x16x32_bf16 v[56:59], a[124:127], v[240:243], v[56:59]
ds_read_b64_tr_b16 a[78:79], v116 offset:14336
v_mul_f32 v46, v46, v25
v_mfma_f32_16x16x32_bf16 v[60:63], a[96:99], v[132:135], 0
ds_read_b64_tr_b16 a[80:81], v116 offset:16384
v_mul_f32 v47, v47, v25
v_mfma_f32_16x16x32_bf16 v[60:63], a[100:103], v[148:151], v[60:63]
ds_read_b64_tr_b16 a[82:83], v116 offset:18432
v_cvt_pk_bf16_f32 v36, v36, v37
v_mfma_f32_16x16x32_bf16 v[60:63], a[104:107], v[164:167], v[60:63]
ds_read_b64_tr_b16 a[84:85], v116 offset:20480
v_cvt_pk_bf16_f32 v37, v38, v39
v_mfma_f32_16x16x32_bf16 v[60:63], a[108:111], v[180:183], v[60:63]
ds_read_b64_tr_b16 a[86:87], v116 offset:22528
v_cvt_pk_bf16_f32 v38, v44, v45
v_mfma_f32_16x16x32_bf16 v[60:63], a[112:115], v[196:199], v[60:63]
ds_read_b64_tr_b16 a[88:89], v116 offset:24576
v_cvt_pk_bf16_f32 v39, v46, v47
v_mfma_f32_16x16x32_bf16 v[60:63], a[116:119], v[212:215], v[60:63]
ds_read_b64_tr_b16 a[90:91], v116 offset:26624
buffer_store_dwordx4 v[36:39], v1, s[4:7], s12 offen offset:0 sc1
v_mfma_f32_16x16x32_bf16 v[60:63], a[120:123], v[228:231], v[60:63]
ds_read_b64_tr_b16 a[92:93], v116 offset:28672
v_mfma_f32_16x16x32_bf16 v[60:63], a[124:127], v[244:247], v[60:63]
s_waitcnt lgkmcnt(8)
ds_read_b64_tr_b16 a[94:95], v116 offset:30720
v_add_u32 v116, 65536, v116
v_mfma_f32_16x16x32_bf16 v[64:67], a[64:67], v[128:131], 0
ds_read_b64_tr_b16 a[96:97], v117 offset:0
v_mul_f32 v48, v48, v24
v_mfma_f32_16x16x32_bf16 v[64:67], a[68:71], v[144:147], v[64:67]
ds_read_b64_tr_b16 a[98:99], v117 offset:2048
v_mul_f32 v49, v49, v24
v_mfma_f32_16x16x32_bf16 v[64:67], a[72:75], v[160:163], v[64:67]
s_waitcnt lgkmcnt(8)
ds_read_b64_tr_b16 a[100:101], v117 offset:4096
v_mul_f32 v50, v50, v24
v_mfma_f32_16x16x32_bf16 v[64:67], a[76:79], v[176:179], v[64:67]
ds_read_b64_tr_b16 a[102:103], v117 offset:6144
v_mul_f32 v51, v51, v24
v_mfma_f32_16x16x32_bf16 v[64:67], a[80:83], v[192:195], v[64:67]
s_waitcnt lgkmcnt(8)
ds_read_b64_tr_b16 a[104:105], v117 offset:8192
v_mul_f32 v56, v56, v24
v_mfma_f32_16x16x32_bf16 v[64:67], a[84:87], v[208:211], v[64:67]
s_waitcnt lgkmcnt(7)
ds_read_b64_tr_b16 a[106:107], v117 offset:10240
v_mul_f32 v57, v57, v24
v_mfma_f32_16x16x32_bf16 v[64:67], a[88:91], v[224:227], v[64:67]
s_waitcnt lgkmcnt(6)
ds_read_b64_tr_b16 a[108:109], v117 offset:12288
v_mul_f32 v58, v58, v24
v_mfma_f32_16x16x32_bf16 v[64:67], a[92:95], v[240:243], v[64:67]
ds_read_b64_tr_b16 a[110:111], v117 offset:14336
v_mul_f32 v59, v59, v24
v_mfma_f32_16x16x32_bf16 v[68:71], a[64:67], v[132:135], 0
ds_read_b64_tr_b16 a[112:113], v117 offset:16384
v_cvt_pk_bf16_f32 v48, v48, v49
v_mfma_f32_16x16x32_bf16 v[68:71], a[68:71], v[148:151], v[68:71]
ds_read_b64_tr_b16 a[114:115], v117 offset:18432
v_cvt_pk_bf16_f32 v49, v50, v51
v_mfma_f32_16x16x32_bf16 v[68:71], a[72:75], v[164:167], v[68:71]
ds_read_b64_tr_b16 a[116:117], v117 offset:20480
v_cvt_pk_bf16_f32 v50, v56, v57
v_mfma_f32_16x16x32_bf16 v[68:71], a[76:79], v[180:183], v[68:71]
ds_read_b64_tr_b16 a[118:119], v117 offset:22528
v_cvt_pk_bf16_f32 v51, v58, v59
v_mfma_f32_16x16x32_bf16 v[68:71], a[80:83], v[196:199], v[68:71]
ds_read_b64_tr_b16 a[120:121], v117 offset:24576
buffer_store_dwordx4 v[48:51], v1, s[4:7], s8 offen offset:1024 sc1
v_mfma_f32_16x16x32_bf16 v[68:71], a[84:87], v[212:215], v[68:71]
ds_read_b64_tr_b16 a[122:123], v117 offset:26624
v_mul_f32 v52, v52, v25
v_mfma_f32_16x16x32_bf16 v[68:71], a[88:91], v[228:231], v[68:71]
ds_read_b64_tr_b16 a[124:125], v117 offset:28672
v_mul_f32 v53, v53, v25
v_mfma_f32_16x16x32_bf16 v[68:71], a[92:95], v[244:247], v[68:71]
s_waitcnt lgkmcnt(8)
ds_read_b64_tr_b16 a[126:127], v117 offset:30720
v_add_u32 v117, 65536, v117
v_mfma_f32_16x16x32_bf16 v[72:75], a[96:99], v[128:131], 0
ds_read_b64_tr_b16 a[64:65], v118 offset:0
v_mul_f32 v54, v54, v25
v_mfma_f32_16x16x32_bf16 v[72:75], a[100:103], v[144:147], v[72:75]
ds_read_b64_tr_b16 a[66:67], v118 offset:2048
v_mul_f32 v55, v55, v25
v_mfma_f32_16x16x32_bf16 v[72:75], a[104:107], v[160:163], v[72:75]
s_waitcnt lgkmcnt(8)
ds_read_b64_tr_b16 a[68:69], v118 offset:4096
v_mul_f32 v60, v60, v25
v_mfma_f32_16x16x32_bf16 v[72:75], a[108:111], v[176:179], v[72:75]
ds_read_b64_tr_b16 a[70:71], v118 offset:6144
v_mul_f32 v61, v61, v25
v_mfma_f32_16x16x32_bf16 v[72:75], a[112:115], v[192:195], v[72:75]
s_waitcnt lgkmcnt(8)
ds_read_b64_tr_b16 a[72:73], v118 offset:8192
v_mul_f32 v62, v62, v25
v_mfma_f32_16x16x32_bf16 v[72:75], a[116:119], v[208:211], v[72:75]
s_waitcnt lgkmcnt(7)
ds_read_b64_tr_b16 a[74:75], v118 offset:10240
v_mul_f32 v63, v63, v25
v_mfma_f32_16x16x32_bf16 v[72:75], a[120:123], v[224:227], v[72:75]
s_waitcnt lgkmcnt(6)
ds_read_b64_tr_b16 a[76:77], v118 offset:12288
v_cvt_pk_bf16_f32 v52, v52, v53
v_mfma_f32_16x16x32_bf16 v[72:75], a[124:127], v[240:243], v[72:75]
ds_read_b64_tr_b16 a[78:79], v118 offset:14336
v_cvt_pk_bf16_f32 v53, v54, v55
v_mfma_f32_16x16x32_bf16 v[76:79], a[96:99], v[132:135], 0
ds_read_b64_tr_b16 a[80:81], v118 offset:16384
v_cvt_pk_bf16_f32 v54, v60, v61
v_mfma_f32_16x16x32_bf16 v[76:79], a[100:103], v[148:151], v[76:79]
ds_read_b64_tr_b16 a[82:83], v118 offset:18432
v_cvt_pk_bf16_f32 v55, v62, v63
v_mfma_f32_16x16x32_bf16 v[76:79], a[104:107], v[164:167], v[76:79]
ds_read_b64_tr_b16 a[84:85], v118 offset:20480
buffer_store_dwordx4 v[52:55], v1, s[4:7], s12 offen offset:1024 sc1
v_mfma_f32_16x16x32_bf16 v[76:79], a[108:111], v[180:183], v[76:79]
ds_read_b64_tr_b16 a[86:87], v118 offset:22528
v_mul_u32_u24 v21, 1792, v19
v_mfma_f32_16x16x32_bf16 v[76:79], a[112:115], v[196:199], v[76:79]
ds_read_b64_tr_b16 a[88:89], v118 offset:24576
v_mul_f32 v64, v64, v24
v_mfma_f32_16x16x32_bf16 v[76:79], a[116:119], v[212:215], v[76:79]
ds_read_b64_tr_b16 a[90:91], v118 offset:26624
v_mul_f32 v65, v65, v24
v_mfma_f32_16x16x32_bf16 v[76:79], a[120:123], v[228:231], v[76:79]
ds_read_b64_tr_b16 a[92:93], v118 offset:28672
v_mul_f32 v66, v66, v24
v_mfma_f32_16x16x32_bf16 v[76:79], a[124:127], v[244:247], v[76:79]
s_waitcnt lgkmcnt(8)
ds_read_b64_tr_b16 a[94:95], v118 offset:30720
v_add_u32 v118, 65536, v118
v_mfma_f32_16x16x32_bf16 v[80:83], a[64:67], v[128:131], 0
ds_read_b64_tr_b16 a[96:97], v119 offset:0
v_mul_f32 v67, v67, v24
v_mfma_f32_16x16x32_bf16 v[80:83], a[68:71], v[144:147], v[80:83]
ds_read_b64_tr_b16 a[98:99], v119 offset:2048
v_mul_f32 v72, v72, v24
v_mfma_f32_16x16x32_bf16 v[80:83], a[72:75], v[160:163], v[80:83]
s_waitcnt lgkmcnt(8)
ds_read_b64_tr_b16 a[100:101], v119 offset:4096
v_mul_f32 v73, v73, v24
v_mfma_f32_16x16x32_bf16 v[80:83], a[76:79], v[176:179], v[80:83]
ds_read_b64_tr_b16 a[102:103], v119 offset:6144
v_mul_f32 v74, v74, v24
v_mfma_f32_16x16x32_bf16 v[80:83], a[80:83], v[192:195], v[80:83]
s_waitcnt lgkmcnt(8)
ds_read_b64_tr_b16 a[104:105], v119 offset:8192
v_mul_f32 v75, v75, v24
v_mfma_f32_16x16x32_bf16 v[80:83], a[84:87], v[208:211], v[80:83]
PAD_16:
s_cbranch_execz M_tret
s_waitcnt lgkmcnt(7)
ds_read_b64_tr_b16 a[106:107], v119 offset:10240
v_cvt_pk_bf16_f32 v64, v64, v65
v_mfma_f32_16x16x32_bf16 v[80:83], a[88:91], v[224:227], v[80:83]
s_waitcnt lgkmcnt(6)
ds_read_b64_tr_b16 a[108:109], v119 offset:12288
v_cvt_pk_bf16_f32 v65, v66, v67
v_mfma_f32_16x16x32_bf16 v[80:83], a[92:95], v[240:243], v[80:83]
ds_read_b64_tr_b16 a[110:111], v119 offset:14336
v_cvt_pk_bf16_f32 v66, v72, v73
v_mfma_f32_16x16x32_bf16 v[84:87], a[64:67], v[132:135], 0
ds_read_b64_tr_b16 a[112:113], v119 offset:16384
v_cvt_pk_bf16_f32 v67, v74, v75
v_mfma_f32_16x16x32_bf16 v[84:87], a[68:71], v[148:151], v[84:87]
ds_read_b64_tr_b16 a[114:115], v119 offset:18432
buffer_store_dwordx4 v[64:67], v1, s[4:7], s8 offen offset:2048 sc1
v_mfma_f32_16x16x32_bf16 v[84:87], a[72:75], v[164:167], v[84:87]
ds_read_b64_tr_b16 a[116:117], v119 offset:20480
v_mul_f32 v68, v68, v25
v_mfma_f32_16x16x32_bf16 v[84:87], a[76:79], v[180:183], v[84:87]
ds_read_b64_tr_b16 a[118:119], v119 offset:22528
v_mul_f32 v69, v69, v25
v_mfma_f32_16x16x32_bf16 v[84:87], a[80:83], v[196:199], v[84:87]
ds_read_b64_tr_b16 a[120:121], v119 offset:24576
v_mul_f32 v70, v70, v25
v_mfma_f32_16x16x32_bf16 v[84:87], a[84:87], v[212:215], v[84:87]
ds_read_b64_tr_b16 a[122:123], v119 offset:26624
v_mul_f32 v71, v71, v25
v_mfma_f32_16x16x32_bf16 v[84:87], a[88:91], v[228:231], v[84:87]
ds_read_b64_tr_b16 a[124:125], v119 offset:28672
ds_read_b64_tr_b16 a[126:127], v119 offset:30720
v_mfma_f32_16x16x32_bf16 v[84:87], a[92:95], v[244:247], v[84:87]
s_waitcnt vmcnt(7) lgkmcnt(9)
s_barrier
v_add_u32 v119, 65536, v119
v_mfma_f32_16x16x32_bf16 v[88:91], a[96:99], v[128:131], 0
ds_read_b64_tr_b16 a[64:65], v116 offset:0
v_mul_f32 v76, v76, v25
v_mfma_f32_16x16x32_bf16 v[88:91], a[100:103], v[144:147], v[88:91]
ds_read_b64_tr_b16 a[66:67], v116 offset:2048
buffer_store_dword v6, v5, s[4:7], s34 offen sc1
v_mfma_f32_16x16x32_bf16 v[88:91], a[104:107], v[160:163], v[88:91]
s_waitcnt lgkmcnt(8)
ds_read_b64_tr_b16 a[68:69], v116 offset:4096
v_mul_f32 v77, v77, v25
v_mfma_f32_16x16x32_bf16 v[88:91], a[108:111], v[176:179], v[88:91]
ds_read_b64_tr_b16 a[70:71], v116 offset:6144
v_mul_f32 v78, v78, v25
v_mfma_f32_16x16x32_bf16 v[88:91], a[112:115], v[192:195], v[88:91]
s_waitcnt lgkmcnt(8)
ds_read_b64_tr_b16 a[72:73], v116 offset:8192
v_mul_f32 v79, v79, v25
v_mfma_f32_16x16x32_bf16 v[88:91], a[116:119], v[208:211], v[88:91]
s_waitcnt lgkmcnt(7)
ds_read_b64_tr_b16 a[74:75], v116 offset:10240
v_cvt_pk_bf16_f32 v68, v68, v69
v_mfma_f32_16x16x32_bf16 v[88:91], a[120:123], v[224:227], v[88:91]
s_waitcnt lgkmcnt(6)
ds_read_b64_tr_b16 a[76:77], v116 offset:12288
v_cvt_pk_bf16_f32 v69, v70, v71
v_mfma_f32_16x16x32_bf16 v[88:91], a[124:127], v[240:243], v[88:91]
ds_read_b64_tr_b16 a[78:79], v116 offset:14336
v_cvt_pk_bf16_f32 v70, v76, v77
v_mfma_f32_16x16x32_bf16 v[92:95], a[96:99], v[132:135], 0
ds_read_b64_tr_b16 a[80:81], v116 offset:16384
v_cvt_pk_bf16_f32 v71, v78, v79
v_mfma_f32_16x16x32_bf16 v[92:95], a[100:103], v[148:151], v[92:95]
ds_read_b64_tr_b16 a[82:83], v116 offset:18432
buffer_store_dwordx4 v[68:71], v1, s[4:7], s12 offen offset:2048 sc1
v_mfma_f32_16x16x32_bf16 v[92:95], a[104:107], v[164:167], v[92:95]
ds_read_b64_tr_b16 a[84:85], v116 offset:20480
v_lshlrev_b32 v19, 2, v19
v_mfma_f32_16x16x32_bf16 v[92:95], a[108:111], v[180:183], v[92:95]
ds_read_b64_tr_b16 a[86:87], v116 offset:22528
v_mfma_f32_16x16x32_bf16 v[92:95], a[112:115], v[196:199], v[92:95]
ds_read_b64_tr_b16 a[88:89], v116 offset:24576
v_mfma_f32_16x16x32_bf16 v[92:95], a[116:119], v[212:215], v[92:95]
ds_read_b64_tr_b16 a[90:91], v116 offset:26624
v_mfma_f32_16x16x32_bf16 v[92:95], a[120:123], v[228:231], v[92:95]
ds_read_b64_tr_b16 a[92:93], v116 offset:28672
v_mfma_f32_16x16x32_bf16 v[92:95], a[124:127], v[244:247], v[92:95]
s_waitcnt lgkmcnt(8)
ds_read_b64_tr_b16 a[94:95], v116 offset:30720
v_mfma_f32_16x16x32_bf16 v[32:35], a[64:67], v[128:131], 0
ds_read_b64_tr_b16 a[96:97], v117 offset:0
v_mul_f32 v80, v80, v24
v_mfma_f32_16x16x32_bf16 v[32:35], a[68:71], v[144:147], v[32:35]
ds_read_b64_tr_b16 a[98:99], v117 offset:2048
v_mul_f32 v81, v81, v24
v_mfma_f32_16x16x32_bf16 v[32:35], a[72:75], v[160:163], v[32:35]
s_waitcnt lgkmcnt(8)
ds_read_b64_tr_b16 a[100:101], v117 offset:4096
v_mul_f32 v82, v82, v24
v_mfma_f32_16x16x32_bf16 v[32:35], a[76:79], v[176:179], v[32:35]
ds_read_b64_tr_b16 a[102:103], v117 offset:6144
v_mul_f32 v83, v83, v24
v_mfma_f32_16x16x32_bf16 v[32:35], a[80:83], v[192:195], v[32:35]
s_waitcnt lgkmcnt(8)
ds_read_b64_tr_b16 a[104:105], v117 offset:8192
v_mul_f32 v88, v88, v24
v_mfma_f32_16x16x32_bf16 v[32:35], a[84:87], v[208:211], v[32:35]
s_waitcnt lgkmcnt(7)
ds_read_b64_tr_b16 a[106:107], v117 offset:10240
v_mul_f32 v89, v89, v24
v_mfma_f32_16x16x32_bf16 v[32:35], a[88:91], v[224:227], v[32:35]
s_waitcnt lgkmcnt(6)
ds_read_b64_tr_b16 a[108:109], v117 offset:12288
v_mul_f32 v90, v90, v24
v_mfma_f32_16x16x32_bf16 v[32:35], a[92:95], v[240:243], v[32:35]
ds_read_b64_tr_b16 a[110:111], v117 offset:14336
v_mul_f32 v91, v91, v24
v_mfma_f32_16x16x32_bf16 v[36:39], a[64:67], v[132:135], 0
ds_read_b64_tr_b16 a[112:113], v117 offset:16384
v_cvt_pk_bf16_f32 v80, v80, v81
v_mfma_f32_16x16x32_bf16 v[36:39], a[68:71], v[148:151], v[36:39]
ds_read_b64_tr_b16 a[114:115], v117 offset:18432
v_cvt_pk_bf16_f32 v81, v82, v83
v_mfma_f32_16x16x32_bf16 v[36:39], a[72:75], v[164:167], v[36:39]
ds_read_b64_tr_b16 a[116:117], v117 offset:20480
v_cvt_pk_bf16_f32 v82, v88, v89
v_mfma_f32_16x16x32_bf16 v[36:39], a[76:79], v[180:183], v[36:39]
ds_read_b64_tr_b16 a[118:119], v117 offset:22528
v_cvt_pk_bf16_f32 v83, v90, v91
v_mfma_f32_16x16x32_bf16 v[36:39], a[80:83], v[196:199], v[36:39]
ds_read_b64_tr_b16 a[120:121], v117 offset:24576
buffer_store_dwordx4 v[80:83], v1, s[4:7], s8 offen offset:3072 sc1
v_mfma_f32_16x16x32_bf16 v[36:39], a[84:87], v[212:215], v[36:39]
ds_read_b64_tr_b16 a[122:123], v117 offset:26624
v_mul_f32 v84, v84, v25
v_mfma_f32_16x16x32_bf16 v[36:39], a[88:91], v[228:231], v[36:39]
ds_read_b64_tr_b16 a[124:125], v117 offset:28672
v_mul_f32 v85, v85, v25
v_mfma_f32_16x16x32_bf16 v[36:39], a[92:95], v[244:247], v[36:39]
s_waitcnt lgkmcnt(8)
ds_read_b64_tr_b16 a[126:127], v117 offset:30720
v_mul_f32 v86, v86, v25
v_mfma_f32_16x16x32_bf16 v[40:43], a[96:99], v[128:131], 0
ds_read_b64_tr_b16 a[64:65], v118 offset:0
v_mul_f32 v87, v87, v25
v_mfma_f32_16x16x32_bf16 v[40:43], a[100:103], v[144:147], v[40:43]
ds_read_b64_tr_b16 a[66:67], v118 offset:2048
v_mul_f32 v92, v92, v25
v_mfma_f32_16x16x32_bf16 v[40:43], a[104:107], v[160:163], v[40:43]
s_waitcnt lgkmcnt(8)
ds_read_b64_tr_b16 a[68:69], v118 offset:4096
v_mul_f32 v93, v93, v25
v_mfma_f32_16x16x32_bf16 v[40:43], a[108:111], v[176:179], v[40:43]
ds_read_b64_tr_b16 a[70:71], v118 offset:6144
v_mul_f32 v94, v94, v25
v_mfma_f32_16x16x32_bf16 v[40:43], a[112:115], v[192:195], v[40:43]
s_waitcnt lgkmcnt(8)
ds_read_b64_tr_b16 a[72:73], v118 offset:8192
v_mul_f32 v95, v95, v25
v_mfma_f32_16x16x32_bf16 v[40:43], a[116:119], v[208:211], v[40:43]
s_waitcnt lgkmcnt(7)
ds_read_b64_tr_b16 a[74:75], v118 offset:10240
v_cvt_pk_bf16_f32 v84, v84, v85
v_mfma_f32_16x16x32_bf16 v[40:43], a[120:123], v[224:227], v[40:43]
s_waitcnt lgkmcnt(6)
ds_read_b64_tr_b16 a[76:77], v118 offset:12288
v_cvt_pk_bf16_f32 v85, v86, v87
v_mfma_f32_16x16x32_bf16 v[40:43], a[124:127], v[240:243], v[40:43]
ds_read_b64_tr_b16 a[78:79], v118 offset:14336
v_cvt_pk_bf16_f32 v86, v92, v93
v_mfma_f32_16x16x32_bf16 v[44:47], a[96:99], v[132:135], 0
ds_read_b64_tr_b16 a[80:81], v118 offset:16384
v_cvt_pk_bf16_f32 v87, v94, v95
v_mfma_f32_16x16x32_bf16 v[44:47], a[100:103], v[148:151], v[44:47]
ds_read_b64_tr_b16 a[82:83], v118 offset:18432
buffer_store_dwordx4 v[84:87], v1, s[4:7], s12 offen offset:3072 sc1
v_mfma_f32_16x16x32_bf16 v[44:47], a[104:107], v[164:167], v[44:47]
s_add_u32 s8, s8, 4096
s_add_u32 s12, s12, 4096
ds_read_b64_tr_b16 a[84:85], v118 offset:20480
v_mfma_f32_16x16x32_bf16 v[44:47], a[108:111], v[180:183], v[44:47]
ds_read_b64_tr_b16 a[86:87], v118 offset:22528
v_lshrrev_b32 v22, 4, v20
v_mfma_f32_16x16x32_bf16 v[44:47], a[112:115], v[196:199], v[44:47]
ds_read_b64_tr_b16 a[88:89], v118 offset:24576
v_mul_f32 v32, v32, v24
v_mfma_f32_16x16x32_bf16 v[44:47], a[116:119], v[212:215], v[44:47]
ds_read_b64_tr_b16 a[90:91], v118 offset:26624
v_mul_f32 v33, v33, v24
v_mfma_f32_16x16x32_bf16 v[44:47], a[120:123], v[228:231], v[44:47]
ds_read_b64_tr_b16 a[92:93], v118 offset:28672
v_mul_f32 v34, v34, v24
v_mfma_f32_16x16x32_bf16 v[44:47], a[124:127], v[244:247], v[44:47]
s_waitcnt lgkmcnt(8)
ds_read_b64_tr_b16 a[94:95], v118 offset:30720
v_mul_f32 v35, v35, v24
v_mfma_f32_16x16x32_bf16 v[48:51], a[64:67], v[128:131], 0
ds_read_b64_tr_b16 a[96:97], v119 offset:0
v_mul_f32 v40, v40, v24
v_mfma_f32_16x16x32_bf16 v[48:51], a[68:71], v[144:147], v[48:51]
ds_read_b64_tr_b16 a[98:99], v119 offset:2048
v_mul_f32 v41, v41, v24
v_mfma_f32_16x16x32_bf16 v[48:51], a[72:75], v[160:163], v[48:51]
s_waitcnt lgkmcnt(8)
ds_read_b64_tr_b16 a[100:101], v119 offset:4096
v_mul_f32 v42, v42, v24
v_mfma_f32_16x16x32_bf16 v[48:51], a[76:79], v[176:179], v[48:51]
ds_read_b64_tr_b16 a[102:103], v119 offset:6144
v_mul_f32 v43, v43, v24
v_mfma_f32_16x16x32_bf16 v[48:51], a[80:83], v[192:195], v[48:51]
s_waitcnt lgkmcnt(8)
ds_read_b64_tr_b16 a[104:105], v119 offset:8192
v_cvt_pk_bf16_f32 v32, v32, v33
v_mfma_f32_16x16x32_bf16 v[48:51], a[84:87], v[208:211], v[48:51]
s_waitcnt lgkmcnt(7)
ds_read_b64_tr_b16 a[106:107], v119 offset:10240
v_cvt_pk_bf16_f32 v33, v34, v35
v_mfma_f32_16x16x32_bf16 v[48:51], a[88:91], v[224:227], v[48:51]
s_waitcnt lgkmcnt(6)
ds_read_b64_tr_b16 a[108:109], v119 offset:12288
v_cvt_pk_bf16_f32 v34, v40, v41
v_mfma_f32_16x16x32_bf16 v[48:51], a[92:95], v[240:243], v[48:51]
ds_read_b64_tr_b16 a[110:111], v119 offset:14336
v_cvt_pk_bf16_f32 v35, v42, v43
v_mfma_f32_16x16x32_bf16 v[52:55], a[64:67], v[132:135], 0
ds_read_b64_tr_b16 a[112:113], v119 offset:16384
buffer_store_dwordx4 v[32:35], v1, s[4:7], s8 offen offset:0 sc1
v_mfma_f32_16x16x32_bf16 v[52:55], a[68:71], v[148:151], v[52:55]
ds_read_b64_tr_b16 a[114:115], v119 offset:18432
v_mul_f32 v36, v36, v25
v_mfma_f32_16x16x32_bf16 v[52:55], a[72:75], v[164:167], v[52:55]
ds_read_b64_tr_b16 a[116:117], v119 offset:20480
v_mul_f32 v37, v37, v25
v_mfma_f32_16x16x32_bf16 v[52:55], a[76:79], v[180:183], v[52:55]
ds_read_b64_tr_b16 a[118:119], v119 offset:22528
v_mul_f32 v38, v38, v25
v_mfma_f32_16x16x32_bf16 v[52:55], a[80:83], v[196:199], v[52:55]
ds_read_b64_tr_b16 a[120:121], v119 offset:24576
v_mul_f32 v39, v39, v25
v_mfma_f32_16x16x32_bf16 v[52:55], a[84:87], v[212:215], v[52:55]
ds_read_b64_tr_b16 a[122:123], v119 offset:26624
v_mul_f32 v44, v44, v25
v_mfma_f32_16x16x32_bf16 v[52:55], a[88:91], v[228:231], v[52:55]
ds_read_b64_tr_b16 a[124:125], v119 offset:28672
ds_read_b64_tr_b16 a[126:127], v119 offset:30720
v_mfma_f32_16x16x32_bf16 v[52:55], a[92:95], v[244:247], v[52:55]
s_waitcnt lgkmcnt(9)
v_mul_f32 v45, v45, v25
v_mul_f32 v46, v46, v25
v_mfma_f32_16x16x32_bf16 v[56:59], a[96:99], v[128:131], 0
v_mul_f32 v47, v47, v25
v_cvt_pk_bf16_f32 v36, v36, v37
v_mfma_f32_16x16x32_bf16 v[56:59], a[100:103], v[144:147], v[56:59]
v_cvt_pk_bf16_f32 v37, v38, v39
v_cvt_pk_bf16_f32 v38, v44, v45
v_mfma_f32_16x16x32_bf16 v[56:59], a[104:107], v[160:163], v[56:59]
s_waitcnt lgkmcnt(6)
v_cvt_pk_bf16_f32 v39, v46, v47
v_lshl_add_u32 v21, v22, 3, v21
v_mfma_f32_16x16x32_bf16 v[56:59], a[108:111], v[176:179], v[56:59]
buffer_store_dwordx4 v[36:39], v1, s[4:7], s12 offen offset:0 sc1
v_mfma_f32_16x16x32_bf16 v[56:59], a[112:115], v[192:195], v[56:59]
s_waitcnt lgkmcnt(4)
v_mfma_f32_16x16x32_bf16 v[56:59], a[116:119], v[208:211], v[56:59]
s_waitcnt lgkmcnt(2)
v_mfma_f32_16x16x32_bf16 v[56:59], a[120:123], v[224:227], v[56:59]
s_waitcnt lgkmcnt(0)
v_mfma_f32_16x16x32_bf16 v[56:59], a[124:127], v[240:243], v[56:59]
v_mfma_f32_16x16x32_bf16 v[60:63], a[96:99], v[132:135], 0
v_mfma_f32_16x16x32_bf16 v[60:63], a[100:103], v[148:151], v[60:63]
v_mfma_f32_16x16x32_bf16 v[60:63], a[104:107], v[164:167], v[60:63]
v_mfma_f32_16x16x32_bf16 v[60:63], a[108:111], v[180:183], v[60:63]
v_mfma_f32_16x16x32_bf16 v[60:63], a[112:115], v[196:199], v[60:63]
buffer_load_dword v18, v19, s[4:7], s33 offen offset:0 sc1
v_mfma_f32_16x16x32_bf16 v[60:63], a[116:119], v[212:215], v[60:63]
v_mfma_f32_16x16x32_bf16 v[60:63], a[120:123], v[228:231], v[60:63]
v_mfma_f32_16x16x32_bf16 v[60:63], a[124:127], v[244:247], v[60:63]
v_mul_f32 v48, v48, v24
v_mul_f32 v49, v49, v24
v_mul_f32 v50, v50, v24
v_mul_f32 v51, v51, v24
v_mul_f32 v56, v56, v24
v_mul_f32 v57, v57, v24
v_mul_f32 v58, v58, v24
v_mul_f32 v59, v59, v24
v_cvt_pk_bf16_f32 v48, v48, v49
v_cvt_pk_bf16_f32 v49, v50, v51
v_cvt_pk_bf16_f32 v50, v56, v57
v_cvt_pk_bf16_f32 v51, v58, v59
buffer_store_dwordx4 v[48:51], v1, s[4:7], s8 offen offset:1024 sc1
v_mul_f32 v52, v52, v25
v_mul_f32 v53, v53, v25
v_mul_f32 v54, v54, v25
v_mul_f32 v55, v55, v25
v_mul_f32 v60, v60, v25
v_mul_f32 v61, v61, v25
v_mul_f32 v62, v62, v25
v_mul_f32 v63, v63, v25
v_cvt_pk_bf16_f32 v52, v52, v53
v_cvt_pk_bf16_f32 v53, v54, v55
v_cvt_pk_bf16_f32 v54, v60, v61
v_cvt_pk_bf16_f32 v55, v62, v63
buffer_store_dwordx4 v[52:55], v1, s[4:7], s12 offen offset:1024 sc1
s_and_b32 s22, s2, 224
s_cmp_eq_u32 s22, 224
s_cbranch_scc1 M_final
s_waitcnt vmcnt(0)
s_barrier
buffer_store_dword v6, v5, s[4:7], s35 offen sc1
s_bitcmp0_b32 s2, 4
s_cbranch_scc1 M_rA
v_cmp_gt_u32 vcc, 1, v18
s_cbranch_vccnz M_rslow
M_rjoin:
buffer_load_dwordx4 v[128:131], v1, s[4:7], s26 offen sc1
s_add_u32 s26, s26, 14336
buffer_load_dwordx4 v[132:135], v1, s[4:7], s26 offen sc1
s_add_u32 s26, s26, 14336
buffer_load_dwordx4 v[136:139], v1, s[4:7], s26 offen sc1
s_add_u32 s26, s26, 14336
buffer_load_dwordx4 v[140:143], v1, s[4:7], s26 offen sc1
s_add_u32 s26, s26, 14336
buffer_load_dwordx4 v[144:147], v1, s[4:7], s26 offen sc1
s_add_u32 s26, s26, 14336
buffer_load_dwordx4 v[148:151], v1, s[4:7], s26 offen sc1
s_add_u32 s26, s26, 14336
buffer_load_dwordx4 v[152:155], v1, s[4:7], s26 offen sc1
s_add_u32 s26, s26, 14336
buffer_load_dwordx4 v[156:159], v1, s[4:7], s26 offen sc1
s_add_u32 s26, s26, 14336
buffer_load_dwordx4 v[160:163], v1, s[4:7], s26 offen sc1
s_add_u32 s26, s26, 14336
buffer_load_dwordx4 v[164:167], v1, s[4:7], s26 offen sc1
s_add_u32 s26, s26, 14336
buffer_load_dwordx4 v[168:171], v1, s[4:7], s26 offen sc1
s_add_u32 s26, s26, 14336
buffer_load_dwordx4 v[172:175], v1, s[4:7], s26 offen sc1
s_add_u32 s26, s26, 14336
buffer_load_dwordx4 v[176:179], v1, s[4:7], s26 offen sc1
s_add_u32 s26, s26, 14336
buffer_load_dwordx4 v[180:183], v1, s[4:7], s26 offen sc1
s_add_u32 s26, s26, 14336
buffer_load_dwordx4 v[184:187], v1, s[4:7], s26 offen sc1
s_add_u32 s26, s26, 14336
buffer_load_dwordx4 v[188:191], v1, s[4:7], s26 offen sc1
Lp_9201:
buffer_load_dword v18, v19, s[4:7], s33 offen offset:2048 sc1
s_waitcnt vmcnt(0)
v_cmp_gt_u32 vcc, 1, v18
s_cbranch_vccz Lpd_9202
s_sleep 8
s_sub_u32 s101, s101, 1
s_cbranch_scc0 Lp_9201
s_mov_b32 s101, 0
Lpd_9202:
s_sub_u32 s26, s26, 207872
buffer_load_dwordx4 v[192:195], v1, s[4:7], s26 offen sc1
s_add_u32 s26, s26, 14336
buffer_load_dwordx4 v[196:199], v1, s[4:7], s26 offen sc1
s_add_u32 s26, s26, 14336
buffer_load_dwordx4 v[200:203], v1, s[4:7], s26 offen sc1
s_add_u32 s26, s26, 14336
buffer_load_dwordx4 v[204:207], v1, s[4:7], s26 offen sc1
s_add_u32 s26, s26, 14336
buffer_load_dwordx4 v[208:211], v1, s[4:7], s26 offen sc1
s_add_u32 s26, s26, 14336
buffer_load_dwordx4 v[212:215], v1, s[4:7], s26 offen sc1
s_add_u32 s26, s26, 14336
buffer_load_dwordx4 v[216:219], v1, s[4:7], s26 offen sc1
s_add_u32 s26, s26, 14336
buffer_load_dwordx4 v[220:223], v1, s[4:7], s26 offen sc1
s_add_u32 s26, s26, 14336
buffer_load_dwordx4 v[224:227], v1, s[4:7], s26 offen sc1
s_add_u32 s26, s26, 14336
buffer_load_dwordx4 v[228:231], v1, s[4:7], s26 offen sc1
s_add_u32 s26, s26, 14336
buffer_load_dwordx4 v[232:235], v1, s[4:7], s26 offen sc1
s_add_u32 s26, s26, 14336
buffer_load_dwordx4 v[236:239], v1, s[4:7], s26 offen sc1
s_add_u32 s26, s26, 14336
buffer_load_dwordx4 v[240:243], v1, s[4:7], s26 offen sc1
s_add_u32 s26, s26, 14336
buffer_load_dwordx4 v[244:247], v1, s[4:7], s26 offen sc1
s_add_u32 s26, s26, 14336
buffer_load_dwordx4 v[248:251], v1, s[4:7], s26 offen sc1
s_add_u32 s26, s26, 14336
buffer_load_dwordx4 v[252:255], v1, s[4:7], s26 offen sc1
v_lshlrev_b32 v96, 16, v128
v_and_b32 v97, 0xffff0000, v128
v_lshlrev_b32 v98, 16, v129
v_and_b32 v99, 0xffff0000, v129
v_lshlrev_b32 v100, 16, v130
v_and_b32 v101, 0xffff0000, v130
v_lshlrev_b32 v102, 16, v131
v_and_b32 v103, 0xffff0000, v131
v_lshlrev_b32 v10, 16, v132
v_and_b32 v11, 0xffff0000, v132
v_lshlrev_b32 v12, 16, v133
v_and_b32 v13, 0xffff0000, v133
v_lshlrev_b32 v14, 16, v134
v_and_b32 v15, 0xffff0000, v134
v_lshlrev_b32 v16, 16, v135
v_and_b32 v17, 0xffff0000, v135
v_pk_add_f32 v[96:97], v[96:97], v[10:11]
v_pk_add_f32 v[98:99], v[98:99], v[12:13]
v_pk_add_f32 v[100:101], v[100:101], v[14:15]
v_pk_add_f32 v[102:103], v[102:103], v[16:17]
v_lshlrev_b32 v10, 16, v136
v_and_b32 v11, 0xffff0000, v136
v_lshlrev_b32 v12, 16, v137
v_and_b32 v13, 0xffff0000, v137
v_lshlrev_b32 v14, 16, v138
v_and_b32 v15, 0xffff0000, v138
v_lshlrev_b32 v16, 16, v139
v_and_b32 v17, 0xffff0000, v139
v_pk_add_f32 v[96:97], v[96:97], v[10:11]
v_pk_add_f32 v[98:99], v[98:99], v[12:13]
v_pk_add_f32 v[100:101], v[100:101], v[14:15]
v_pk_add_f32 v[102:103], v[102:103], v[16:17]
v_lshlrev_b32 v10, 16, v140
v_and_b32 v11, 0xffff0000, v140
v_lshlrev_b32 v12, 16, v141
v_and_b32 v13, 0xffff0000, v141
v_lshlrev_b32 v14, 16, v142
v_and_b32 v15, 0xffff0000, v142
v_lshlrev_b32 v16, 16, v143
v_and_b32 v17, 0xffff0000, v143
v_pk_add_f32 v[96:97], v[96:97], v[10:11]
v_pk_add_f32 v[98:99], v[98:99], v[12:13]
v_pk_add_f32 v[100:101], v[100:101], v[14:15]
v_pk_add_f32 v[102:103], v[102:103], v[16:17]
v_lshlrev_b32 v10, 16, v144
v_and_b32 v11, 0xffff0000, v144
v_lshlrev_b32 v12, 16, v145
v_and_b32 v13, 0xffff0000, v145
v_lshlrev_b32 v14, 16, v146
v_and_b32 v15, 0xffff0000, v146
v_lshlrev_b32 v16, 16, v147
v_and_b32 v17, 0xffff0000, v147
v_pk_add_f32 v[96:97], v[96:97], v[10:11]
v_pk_add_f32 v[98:99], v[98:99], v[12:13]
v_pk_add_f32 v[100:101], v[100:101], v[14:15]
v_pk_add_f32 v[102:103], v[102:103], v[16:17]
v_lshlrev_b32 v10, 16, v148
v_and_b32 v11, 0xffff0000, v148
v_lshlrev_b32 v12, 16, v149
v_and_b32 v13, 0xffff0000, v149
v_lshlrev_b32 v14, 16, v150
v_and_b32 v15, 0xffff0000, v150
v_lshlrev_b32 v16, 16, v151
v_and_b32 v17, 0xffff0000, v151
v_pk_add_f32 v[96:97], v[96:97], v[10:11]
v_pk_add_f32 v[98:99], v[98:99], v[12:13]
v_pk_add_f32 v[100:101], v[100:101], v[14:15]
v_pk_add_f32 v[102:103], v[102:103], v[16:17]
v_lshlrev_b32 v10, 16, v152
v_and_b32 v11, 0xffff0000, v152
v_lshlrev_b32 v12, 16, v153
v_and_b32 v13, 0xffff0000, v153
v_lshlrev_b32 v14, 16, v154
v_and_b32 v15, 0xffff0000, v154
v_lshlrev_b32 v16, 16, v155
v_and_b32 v17, 0xffff0000, v155
v_pk_add_f32 v[96:97], v[96:97], v[10:11]
v_pk_add_f32 v[98:99], v[98:99], v[12:13]
v_pk_add_f32 v[100:101], v[100:101], v[14:15]
v_pk_add_f32 v[102:103], v[102:103], v[16:17]
v_lshlrev_b32 v10, 16, v156
v_and_b32 v11, 0xffff0000, v156
v_lshlrev_b32 v12, 16, v157
v_and_b32 v13, 0xffff0000, v157
v_lshlrev_b32 v14, 16, v158
v_and_b32 v15, 0xffff0000, v158
v_lshlrev_b32 v16, 16, v159
v_and_b32 v17, 0xffff0000, v159
v_pk_add_f32 v[96:97], v[96:97], v[10:11]
v_pk_add_f32 v[98:99], v[98:99], v[12:13]
v_pk_add_f32 v[100:101], v[100:101], v[14:15]
v_pk_add_f32 v[102:103], v[102:103], v[16:17]
v_lshlrev_b32 v10, 16, v160
v_and_b32 v11, 0xffff0000, v160
v_lshlrev_b32 v12, 16, v161
v_and_b32 v13, 0xffff0000, v161
v_lshlrev_b32 v14, 16, v162
v_and_b32 v15, 0xffff0000, v162
v_lshlrev_b32 v16, 16, v163
v_and_b32 v17, 0xffff0000, v163
v_pk_add_f32 v[96:97], v[96:97], v[10:11]
v_pk_add_f32 v[98:99], v[98:99], v[12:13]
v_pk_add_f32 v[100:101], v[100:101], v[14:15]
v_pk_add_f32 v[102:103], v[102:103], v[16:17]
v_lshlrev_b32 v10, 16, v164
v_and_b32 v11, 0xffff0000, v164
v_lshlrev_b32 v12, 16, v165
v_and_b32 v13, 0xffff0000, v165
v_lshlrev_b32 v14, 16, v166
v_and_b32 v15, 0xffff0000, v166
v_lshlrev_b32 v16, 16, v167
v_and_b32 v17, 0xffff0000, v167
v_pk_add_f32 v[96:97], v[96:97], v[10:11]
v_pk_add_f32 v[98:99], v[98:99], v[12:13]
v_pk_add_f32 v[100:101], v[100:101], v[14:15]
v_pk_add_f32 v[102:103], v[102:103], v[16:17]
v_lshlrev_b32 v10, 16, v168
v_and_b32 v11, 0xffff0000, v168
v_lshlrev_b32 v12, 16, v169
v_and_b32 v13, 0xffff0000, v169
v_lshlrev_b32 v14, 16, v170
v_and_b32 v15, 0xffff0000, v170
v_lshlrev_b32 v16, 16, v171
v_and_b32 v17, 0xffff0000, v171
v_pk_add_f32 v[96:97], v[96:97], v[10:11]
v_pk_add_f32 v[98:99], v[98:99], v[12:13]
v_pk_add_f32 v[100:101], v[100:101], v[14:15]
v_pk_add_f32 v[102:103], v[102:103], v[16:17]
v_lshlrev_b32 v10, 16, v172
v_and_b32 v11, 0xffff0000, v172
v_lshlrev_b32 v12, 16, v173
v_and_b32 v13, 0xffff0000, v173
v_lshlrev_b32 v14, 16, v174
v_and_b32 v15, 0xffff0000, v174
v_lshlrev_b32 v16, 16, v175
v_and_b32 v17, 0xffff0000, v175
v_pk_add_f32 v[96:97], v[96:97], v[10:11]
v_pk_add_f32 v[98:99], v[98:99], v[12:13]
v_pk_add_f32 v[100:101], v[100:101], v[14:15]
v_pk_add_f32 v[102:103], v[102:103], v[16:17]
v_lshlrev_b32 v10, 16, v176
v_and_b32 v11, 0xffff0000, v176
v_lshlrev_b32 v12, 16, v177
v_and_b32 v13, 0xffff0000, v177
v_lshlrev_b32 v14, 16, v178
v_and_b32 v15, 0xffff0000, v178
v_lshlrev_b32 v16, 16, v179
v_and_b32 v17, 0xffff0000, v179
v_pk_add_f32 v[96:97], v[96:97], v[10:11]
v_pk_add_f32 v[98:99], v[98:99], v[12:13]
v_pk_add_f32 v[100:101], v[100:101], v[14:15]
v_pk_add_f32 v[102:103], v[102:103], v[16:17]
v_lshlrev_b32 v10, 16, v180
v_and_b32 v11, 0xffff0000, v180
v_lshlrev_b32 v12, 16, v181
v_and_b32 v13, 0xffff0000, v181
v_lshlrev_b32 v14, 16, v182
v_and_b32 v15, 0xffff0000, v182
v_lshlrev_b32 v16, 16, v183
v_and_b32 v17, 0xffff0000, v183
v_pk_add_f32 v[96:97], v[96:97], v[10:11]
v_pk_add_f32 v[98:99], v[98:99], v[12:13]
v_pk_add_f32 v[100:101], v[100:101], v[14:15]
v_pk_add_f32 v[102:103], v[102:103], v[16:17]
v_lshlrev_b32 v10, 16, v184
v_and_b32 v11, 0xffff0000, v184
v_lshlrev_b32 v12, 16, v185
v_and_b32 v13, 0xffff0000, v185
v_lshlrev_b32 v14, 16, v186
v_and_b32 v15, 0xffff0000, v186
v_lshlrev_b32 v16, 16, v187
v_and_b32 v17, 0xffff0000, v187
v_pk_add_f32 v[96:97], v[96:97], v[10:11]
v_pk_add_f32 v[98:99], v[98:99], v[12:13]
v_pk_add_f32 v[100:101], v[100:101], v[14:15]
v_pk_add_f32 v[102:103], v[102:103], v[16:17]
v_lshlrev_b32 v10, 16, v188
v_and_b32 v11, 0xffff0000, v188
v_lshlrev_b32 v12, 16, v189
v_and_b32 v13, 0xffff0000, v189
v_lshlrev_b32 v14, 16, v190
v_and_b32 v15, 0xffff0000, v190
v_lshlrev_b32 v16, 16, v191
v_and_b32 v17, 0xffff0000, v191
v_pk_add_f32 v[96:97], v[96:97], v[10:11]
v_pk_add_f32 v[98:99], v[98:99], v[12:13]
v_pk_add_f32 v[100:101], v[100:101], v[14:15]
v_pk_add_f32 v[102:103], v[102:103], v[16:17]
v_cvt_pk_bf16_f32 v96, v96, v97
v_cvt_pk_bf16_f32 v97, v98, v99
v_cvt_pk_bf16_f32 v98, v100, v101
v_cvt_pk_bf16_f32 v99, v102, v103
buffer_store_dwordx2 v[96:97], v21, s[40:43], s25 offen offset:896
buffer_store_dwordx2 v[98:99], v21, s[40:43], s25 offen offset:928
s_waitcnt vmcnt(17)
v_lshlrev_b32 v104, 16, v192
v_and_b32 v105, 0xffff0000, v192
v_lshlrev_b32 v106, 16, v193
v_and_b32 v107, 0xffff0000, v193
v_lshlrev_b32 v108, 16, v194
v_and_b32 v109, 0xffff0000, v194
v_lshlrev_b32 v110, 16, v195
v_and_b32 v111, 0xffff0000, v195
s_waitcnt vmcnt(16)
v_lshlrev_b32 v10, 16, v196
v_and_b32 v11, 0xffff0000, v196
v_lshlrev_b32 v12, 16, v197
v_and_b32 v13, 0xffff0000, v197
v_lshlrev_b32 v14, 16, v198
v_and_b32 v15, 0xffff0000, v198
v_lshlrev_b32 v16, 16, v199
v_and_b32 v17, 0xffff0000, v199
v_pk_add_f32 v[104:105], v[104:105], v[10:11]
v_pk_add_f32 v[106:107], v[106:107], v[12:13]
v_pk_add_f32 v[108:109], v[108:109], v[14:15]
v_pk_add_f32 v[110:111], v[110:111], v[16:17]
s_waitcnt vmcnt(15)
v_lshlrev_b32 v10, 16, v200
v_and_b32 v11, 0xffff0000, v200
v_lshlrev_b32 v12, 16, v201
PAD_17:
s_cbranch_execz M_tret
v_and_b32 v13, 0xffff0000, v201
v_lshlrev_b32 v14, 16, v202
v_and_b32 v15, 0xffff0000, v202
v_lshlrev_b32 v16, 16, v203
v_and_b32 v17, 0xffff0000, v203
v_pk_add_f32 v[104:105], v[104:105], v[10:11]
v_pk_add_f32 v[106:107], v[106:107], v[12:13]
v_pk_add_f32 v[108:109], v[108:109], v[14:15]
v_pk_add_f32 v[110:111], v[110:111], v[16:17]
s_waitcnt vmcnt(14)
v_lshlrev_b32 v10, 16, v204
v_and_b32 v11, 0xffff0000, v204
v_lshlrev_b32 v12, 16, v205
v_and_b32 v13, 0xffff0000, v205
v_lshlrev_b32 v14, 16, v206
v_and_b32 v15, 0xffff0000, v206
v_lshlrev_b32 v16, 16, v207
v_and_b32 v17, 0xffff0000, v207
v_pk_add_f32 v[104:105], v[104:105], v[10:11]
v_pk_add_f32 v[106:107], v[106:107], v[12:13]
v_pk_add_f32 v[108:109], v[108:109], v[14:15]
v_pk_add_f32 v[110:111], v[110:111], v[16:17]
s_waitcnt vmcnt(13)
v_lshlrev_b32 v10, 16, v208
v_and_b32 v11, 0xffff0000, v208
v_lshlrev_b32 v12, 16, v209
v_and_b32 v13, 0xffff0000, v209
v_lshlrev_b32 v14, 16, v210
v_and_b32 v15, 0xffff0000, v210
v_lshlrev_b32 v16, 16, v211
v_and_b32 v17, 0xffff0000, v211
v_pk_add_f32 v[104:105], v[104:105], v[10:11]
v_pk_add_f32 v[106:107], v[106:107], v[12:13]
v_pk_add_f32 v[108:109], v[108:109], v[14:15]
v_pk_add_f32 v[110:111], v[110:111], v[16:17]
s_waitcnt vmcnt(12)
v_lshlrev_b32 v10, 16, v212
v_and_b32 v11, 0xffff0000, v212
v_lshlrev_b32 v12, 16, v213
v_and_b32 v13, 0xffff0000, v213
v_lshlrev_b32 v14, 16, v214
v_and_b32 v15, 0xffff0000, v214
v_lshlrev_b32 v16, 16, v215
v_and_b32 v17, 0xffff0000, v215
v_pk_add_f32 v[104:105], v[104:105], v[10:11]
v_pk_add_f32 v[106:107], v[106:107], v[12:13]
v_pk_add_f32 v[108:109], v[108:109], v[14:15]
v_pk_add_f32 v[110:111], v[110:111], v[16:17]
s_waitcnt vmcnt(11)
v_lshlrev_b32 v10, 16, v216
v_and_b32 v11, 0xffff0000, v216
v_lshlrev_b32 v12, 16, v217
v_and_b32 v13, 0xffff0000, v217
v_lshlrev_b32 v14, 16, v218
v_and_b32 v15, 0xffff0000, v218
v_lshlrev_b32 v16, 16, v219
v_and_b32 v17, 0xffff0000, v219
v_pk_add_f32 v[104:105], v[104:105], v[10:11]
v_pk_add_f32 v[106:107], v[106:107], v[12:13]
v_pk_add_f32 v[108:109], v[108:109], v[14:15]
v_pk_add_f32 v[110:111], v[110:111], v[16:17]
s_waitcnt vmcnt(10)
v_lshlrev_b32 v10, 16, v220
v_and_b32 v11, 0xffff0000, v220
v_lshlrev_b32 v12, 16, v221
v_and_b32 v13, 0xffff0000, v221
v_lshlrev_b32 v14, 16, v222
v_and_b32 v15, 0xffff0000, v222
v_lshlrev_b32 v16, 16, v223
v_and_b32 v17, 0xffff0000, v223
v_pk_add_f32 v[104:105], v[104:105], v[10:11]
v_pk_add_f32 v[106:107], v[106:107], v[12:13]
v_pk_add_f32 v[108:109], v[108:109], v[14:15]
v_pk_add_f32 v[110:111], v[110:111], v[16:17]
s_waitcnt vmcnt(9)
v_lshlrev_b32 v10, 16, v224
v_and_b32 v11, 0xffff0000, v224
v_lshlrev_b32 v12, 16, v225
v_and_b32 v13, 0xffff0000, v225
v_lshlrev_b32 v14, 16, v226
v_and_b32 v15, 0xffff0000, v226
v_lshlrev_b32 v16, 16, v227
v_and_b32 v17, 0xffff0000, v227
v_pk_add_f32 v[104:105], v[104:105], v[10:11]
v_pk_add_f32 v[106:107], v[106:107], v[12:13]
v_pk_add_f32 v[108:109], v[108:109], v[14:15]
v_pk_add_f32 v[110:111], v[110:111], v[16:17]
s_waitcnt vmcnt(8)
v_lshlrev_b32 v10, 16, v228
v_and_b32 v11, 0xffff0000, v228
v_lshlrev_b32 v12, 16, v229
v_and_b32 v13, 0xffff0000, v229
v_lshlrev_b32 v14, 16, v230
v_and_b32 v15, 0xffff0000, v230
v_lshlrev_b32 v16, 16, v231
v_and_b32 v17, 0xffff0000, v231
v_pk_add_f32 v[104:105], v[104:105], v[10:11]
v_pk_add_f32 v[106:107], v[106:107], v[12:13]
v_pk_add_f32 v[108:109], v[108:109], v[14:15]
v_pk_add_f32 v[110:111], v[110:111], v[16:17]
s_waitcnt vmcnt(7)
v_lshlrev_b32 v10, 16, v232
v_and_b32 v11, 0xffff0000, v232
v_lshlrev_b32 v12, 16, v233
v_and_b32 v13, 0xffff0000, v233
v_lshlrev_b32 v14, 16, v234
v_and_b32 v15, 0xffff0000, v234
v_lshlrev_b32 v16, 16, v235
v_and_b32 v17, 0xffff0000, v235
v_pk_add_f32 v[104:105], v[104:105], v[10:11]
v_pk_add_f32 v[106:107], v[106:107], v[12:13]
v_pk_add_f32 v[108:109], v[108:109], v[14:15]
v_pk_add_f32 v[110:111], v[110:111], v[16:17]
s_waitcnt vmcnt(6)
v_lshlrev_b32 v10, 16, v236
v_and_b32 v11, 0xffff0000, v236
v_lshlrev_b32 v12, 16, v237
v_and_b32 v13, 0xffff0000, v237
v_lshlrev_b32 v14, 16, v238
v_and_b32 v15, 0xffff0000, v238
v_lshlrev_b32 v16, 16, v239
v_and_b32 v17, 0xffff0000, v239
v_pk_add_f32 v[104:105], v[104:105], v[10:11]
v_pk_add_f32 v[106:107], v[106:107], v[12:13]
v_pk_add_f32 v[108:109], v[108:109], v[14:15]
v_pk_add_f32 v[110:111], v[110:111], v[16:17]
s_waitcnt vmcnt(5)
v_lshlrev_b32 v10, 16, v240
v_and_b32 v11, 0xffff0000, v240
v_lshlrev_b32 v12, 16, v241
v_and_b32 v13, 0xffff0000, v241
v_lshlrev_b32 v14, 16, v242
v_and_b32 v15, 0xffff0000, v242
v_lshlrev_b32 v16, 16, v243
v_and_b32 v17, 0xffff0000, v243
v_pk_add_f32 v[104:105], v[104:105], v[10:11]
v_pk_add_f32 v[106:107], v[106:107], v[12:13]
v_pk_add_f32 v[108:109], v[108:109], v[14:15]
v_pk_add_f32 v[110:111], v[110:111], v[16:17]
s_waitcnt vmcnt(4)
v_lshlrev_b32 v10, 16, v244
v_and_b32 v11, 0xffff0000, v244
v_lshlrev_b32 v12, 16, v245
v_and_b32 v13, 0xffff0000, v245
v_lshlrev_b32 v14, 16, v246
v_and_b32 v15, 0xffff0000, v246
v_lshlrev_b32 v16, 16, v247
v_and_b32 v17, 0xffff0000, v247
v_pk_add_f32 v[104:105], v[104:105], v[10:11]
v_pk_add_f32 v[106:107], v[106:107], v[12:13]
v_pk_add_f32 v[108:109], v[108:109], v[14:15]
v_pk_add_f32 v[110:111], v[110:111], v[16:17]
s_waitcnt vmcnt(3)
v_lshlrev_b32 v10, 16, v248
v_and_b32 v11, 0xffff0000, v248
v_lshlrev_b32 v12, 16, v249
v_and_b32 v13, 0xffff0000, v249
v_lshlrev_b32 v14, 16, v250
v_and_b32 v15, 0xffff0000, v250
v_lshlrev_b32 v16, 16, v251
v_and_b32 v17, 0xffff0000, v251
v_pk_add_f32 v[104:105], v[104:105], v[10:11]
v_pk_add_f32 v[106:107], v[106:107], v[12:13]
v_pk_add_f32 v[108:109], v[108:109], v[14:15]
v_pk_add_f32 v[110:111], v[110:111], v[16:17]
s_waitcnt vmcnt(2)
v_lshlrev_b32 v10, 16, v252
v_and_b32 v11, 0xffff0000, v252
v_lshlrev_b32 v12, 16, v253
v_and_b32 v13, 0xffff0000, v253
v_lshlrev_b32 v14, 16, v254
v_and_b32 v15, 0xffff0000, v254
v_lshlrev_b32 v16, 16, v255
v_and_b32 v17, 0xffff0000, v255
v_pk_add_f32 v[104:105], v[104:105], v[10:11]
v_pk_add_f32 v[106:107], v[106:107], v[12:13]
v_pk_add_f32 v[108:109], v[108:109], v[14:15]
v_pk_add_f32 v[110:111], v[110:111], v[16:17]
v_cvt_pk_bf16_f32 v104, v104, v105
v_cvt_pk_bf16_f32 v105, v106, v107
v_cvt_pk_bf16_f32 v106, v108, v109
v_cvt_pk_bf16_f32 v107, v110, v111
buffer_store_dwordx2 v[104:105], v21, s[40:43], s25 offen offset:1344
buffer_store_dwordx2 v[106:107], v21, s[40:43], s25 offen offset:1376
s_add_u32 s25, s25, 1835008
s_add_u32 s26, s26, 14457856
s_add_u32 s33, s33, 1024
s_branch M_r1
PAD_18:
s_cbranch_execz M_tret
M_rA:
s_add_u32 s25, s25, 448
s_add_u32 s26, s26, 7168
s_add_u32 s33, s33, 2048
M_r1:
Lp_9203:
buffer_load_dword v18, v19, s[4:7], s33 offen offset:0 sc1
s_waitcnt vmcnt(0)
v_cmp_gt_u32 vcc, 1, v18
s_cbranch_vccz Lpd_9204
s_sleep 8
s_sub_u32 s101, s101, 1
s_cbranch_scc0 Lp_9203
s_mov_b32 s101, 0
Lpd_9204:
buffer_load_dwordx4 v[128:131], v1, s[4:7], s26 offen sc1
s_add_u32 s26, s26, 14336
buffer_load_dwordx4 v[132:135], v1, s[4:7], s26 offen sc1
s_add_u32 s26, s26, 14336
buffer_load_dwordx4 v[136:139], v1, s[4:7], s26 offen sc1
s_add_u32 s26, s26, 14336
buffer_load_dwordx4 v[140:143], v1, s[4:7], s26 offen sc1
s_add_u32 s26, s26, 14336
buffer_load_dwordx4 v[144:147], v1, s[4:7], s26 offen sc1
s_add_u32 s26, s26, 14336
buffer_load_dwordx4 v[148:151], v1, s[4:7], s26 offen sc1
s_add_u32 s26, s26, 14336
buffer_load_dwordx4 v[152:155], v1, s[4:7], s26 offen sc1
s_add_u32 s26, s26, 14336
buffer_load_dwordx4 v[156:159], v1, s[4:7], s26 offen sc1
s_add_u32 s26, s26, 14336
buffer_load_dwordx4 v[160:163], v1, s[4:7], s26 offen sc1
s_add_u32 s26, s26, 14336
buffer_load_dwordx4 v[164:167], v1, s[4:7], s26 offen sc1
s_add_u32 s26, s26, 14336
buffer_load_dwordx4 v[168:171], v1, s[4:7], s26 offen sc1
s_add_u32 s26, s26, 14336
buffer_load_dwordx4 v[172:175], v1, s[4:7], s26 offen sc1
s_add_u32 s26, s26, 14336
buffer_load_dwordx4 v[176:179], v1, s[4:7], s26 offen sc1
s_add_u32 s26, s26, 14336
buffer_load_dwordx4 v[180:183], v1, s[4:7], s26 offen sc1
s_add_u32 s26, s26, 14336
buffer_load_dwordx4 v[184:187], v1, s[4:7], s26 offen sc1
s_add_u32 s26, s26, 14336
buffer_load_dwordx4 v[188:191], v1, s[4:7], s26 offen sc1
s_waitcnt vmcnt(15)
v_lshlrev_b32 v96, 16, v128
v_and_b32 v97, 0xffff0000, v128
v_lshlrev_b32 v98, 16, v129
v_and_b32 v99, 0xffff0000, v129
v_lshlrev_b32 v100, 16, v130
v_and_b32 v101, 0xffff0000, v130
v_lshlrev_b32 v102, 16, v131
v_and_b32 v103, 0xffff0000, v131
s_waitcnt vmcnt(14)
v_lshlrev_b32 v10, 16, v132
v_and_b32 v11, 0xffff0000, v132
v_lshlrev_b32 v12, 16, v133
v_and_b32 v13, 0xffff0000, v133
v_lshlrev_b32 v14, 16, v134
v_and_b32 v15, 0xffff0000, v134
v_lshlrev_b32 v16, 16, v135
v_and_b32 v17, 0xffff0000, v135
v_pk_add_f32 v[96:97], v[96:97], v[10:11]
v_pk_add_f32 v[98:99], v[98:99], v[12:13]
v_pk_add_f32 v[100:101], v[100:101], v[14:15]
v_pk_add_f32 v[102:103], v[102:103], v[16:17]
s_waitcnt vmcnt(13)
v_lshlrev_b32 v10, 16, v136
v_and_b32 v11, 0xffff0000, v136
v_lshlrev_b32 v12, 16, v137
v_and_b32 v13, 0xffff0000, v137
v_lshlrev_b32 v14, 16, v138
v_and_b32 v15, 0xffff0000, v138
v_lshlrev_b32 v16, 16, v139
v_and_b32 v17, 0xffff0000, v139
v_pk_add_f32 v[96:97], v[96:97], v[10:11]
v_pk_add_f32 v[98:99], v[98:99], v[12:13]
v_pk_add_f32 v[100:101], v[100:101], v[14:15]
v_pk_add_f32 v[102:103], v[102:103], v[16:17]
s_waitcnt vmcnt(12)
v_lshlrev_b32 v10, 16, v140
v_and_b32 v11, 0xffff0000, v140
v_lshlrev_b32 v12, 16, v141
v_and_b32 v13, 0xffff0000, v141
v_lshlrev_b32 v14, 16, v142
v_and_b32 v15, 0xffff0000, v142
v_lshlrev_b32 v16, 16, v143
v_and_b32 v17, 0xffff0000, v143
v_pk_add_f32 v[96:97], v[96:97], v[10:11]
v_pk_add_f32 v[98:99], v[98:99], v[12:13]
v_pk_add_f32 v[100:101], v[100:101], v[14:15]
v_pk_add_f32 v[102:103], v[102:103], v[16:17]
s_waitcnt vmcnt(11)
v_lshlrev_b32 v10, 16, v144
v_and_b32 v11, 0xffff0000, v144
v_lshlrev_b32 v12, 16, v145
v_and_b32 v13, 0xffff0000, v145
v_lshlrev_b32 v14, 16, v146
v_and_b32 v15, 0xffff0000, v146
v_lshlrev_b32 v16, 16, v147
v_and_b32 v17, 0xffff0000, v147
v_pk_add_f32 v[96:97], v[96:97], v[10:11]
v_pk_add_f32 v[98:99], v[98:99], v[12:13]
v_pk_add_f32 v[100:101], v[100:101], v[14:15]
v_pk_add_f32 v[102:103], v[102:103], v[16:17]
s_waitcnt vmcnt(10)
v_lshlrev_b32 v10, 16, v148
v_and_b32 v11, 0xffff0000, v148
v_lshlrev_b32 v12, 16, v149
v_and_b32 v13, 0xffff0000, v149
v_lshlrev_b32 v14, 16, v150
v_and_b32 v15, 0xffff0000, v150
v_lshlrev_b32 v16, 16, v151
v_and_b32 v17, 0xffff0000, v151
v_pk_add_f32 v[96:97], v[96:97], v[10:11]
v_pk_add_f32 v[98:99], v[98:99], v[12:13]
v_pk_add_f32 v[100:101], v[100:101], v[14:15]
v_pk_add_f32 v[102:103], v[102:103], v[16:17]
s_waitcnt vmcnt(9)
v_lshlrev_b32 v10, 16, v152
v_and_b32 v11, 0xffff0000, v152
v_lshlrev_b32 v12, 16, v153
v_and_b32 v13, 0xffff0000, v153
v_lshlrev_b32 v14, 16, v154
v_and_b32 v15, 0xffff0000, v154
v_lshlrev_b32 v16, 16, v155
v_and_b32 v17, 0xffff0000, v155
v_pk_add_f32 v[96:97], v[96:97], v[10:11]
v_pk_add_f32 v[98:99], v[98:99], v[12:13]
v_pk_add_f32 v[100:101], v[100:101], v[14:15]
v_pk_add_f32 v[102:103], v[102:103], v[16:17]
s_waitcnt vmcnt(8)
v_lshlrev_b32 v10, 16, v156
v_and_b32 v11, 0xffff0000, v156
v_lshlrev_b32 v12, 16, v157
v_and_b32 v13, 0xffff0000, v157
v_lshlrev_b32 v14, 16, v158
v_and_b32 v15, 0xffff0000, v158
v_lshlrev_b32 v16, 16, v159
v_and_b32 v17, 0xffff0000, v159
v_pk_add_f32 v[96:97], v[96:97], v[10:11]
v_pk_add_f32 v[98:99], v[98:99], v[12:13]
v_pk_add_f32 v[100:101], v[100:101], v[14:15]
v_pk_add_f32 v[102:103], v[102:103], v[16:17]
s_waitcnt vmcnt(7)
v_lshlrev_b32 v10, 16, v160
v_and_b32 v11, 0xffff0000, v160
v_lshlrev_b32 v12, 16, v161
v_and_b32 v13, 0xffff0000, v161
v_lshlrev_b32 v14, 16, v162
v_and_b32 v15, 0xffff0000, v162
v_lshlrev_b32 v16, 16, v163
v_and_b32 v17, 0xffff0000, v163
v_pk_add_f32 v[96:97], v[96:97], v[10:11]
v_pk_add_f32 v[98:99], v[98:99], v[12:13]
v_pk_add_f32 v[100:101], v[100:101], v[14:15]
v_pk_add_f32 v[102:103], v[102:103], v[16:17]
s_waitcnt vmcnt(6)
v_lshlrev_b32 v10, 16, v164
v_and_b32 v11, 0xffff0000, v164
v_lshlrev_b32 v12, 16, v165
v_and_b32 v13, 0xffff0000, v165
v_lshlrev_b32 v14, 16, v166
v_and_b32 v15, 0xffff0000, v166
v_lshlrev_b32 v16, 16, v167
v_and_b32 v17, 0xffff0000, v167
v_pk_add_f32 v[96:97], v[96:97], v[10:11]
v_pk_add_f32 v[98:99], v[98:99], v[12:13]
v_pk_add_f32 v[100:101], v[100:101], v[14:15]
v_pk_add_f32 v[102:103], v[102:103], v[16:17]
s_waitcnt vmcnt(5)
v_lshlrev_b32 v10, 16, v168
v_and_b32 v11, 0xffff0000, v168
v_lshlrev_b32 v12, 16, v169
v_and_b32 v13, 0xffff0000, v169
v_lshlrev_b32 v14, 16, v170
v_and_b32 v15, 0xffff0000, v170
v_lshlrev_b32 v16, 16, v171
v_and_b32 v17, 0xffff0000, v171
v_pk_add_f32 v[96:97], v[96:97], v[10:11]
v_pk_add_f32 v[98:99], v[98:99], v[12:13]
v_pk_add_f32 v[100:101], v[100:101], v[14:15]
v_pk_add_f32 v[102:103], v[102:103], v[16:17]
s_waitcnt vmcnt(4)
v_lshlrev_b32 v10, 16, v172
v_and_b32 v11, 0xffff0000, v172
v_lshlrev_b32 v12, 16, v173
v_and_b32 v13, 0xffff0000, v173
v_lshlrev_b32 v14, 16, v174
v_and_b32 v15, 0xffff0000, v174
v_lshlrev_b32 v16, 16, v175
v_and_b32 v17, 0xffff0000, v175
v_pk_add_f32 v[96:97], v[96:97], v[10:11]
v_pk_add_f32 v[98:99], v[98:99], v[12:13]
v_pk_add_f32 v[100:101], v[100:101], v[14:15]
v_pk_add_f32 v[102:103], v[102:103], v[16:17]
s_waitcnt vmcnt(3)
v_lshlrev_b32 v10, 16, v176
v_and_b32 v11, 0xffff0000, v176
v_lshlrev_b32 v12, 16, v177
v_and_b32 v13, 0xffff0000, v177
v_lshlrev_b32 v14, 16, v178
v_and_b32 v15, 0xffff0000, v178
v_lshlrev_b32 v16, 16, v179
v_and_b32 v17, 0xffff0000, v179
v_pk_add_f32 v[96:97], v[96:97], v[10:11]
v_pk_add_f32 v[98:99], v[98:99], v[12:13]
v_pk_add_f32 v[100:101], v[100:101], v[14:15]
v_pk_add_f32 v[102:103], v[102:103], v[16:17]
s_waitcnt vmcnt(2)
v_lshlrev_b32 v10, 16, v180
v_and_b32 v11, 0xffff0000, v180
v_lshlrev_b32 v12, 16, v181
v_and_b32 v13, 0xffff0000, v181
v_lshlrev_b32 v14, 16, v182
v_and_b32 v15, 0xffff0000, v182
v_lshlrev_b32 v16, 16, v183
v_and_b32 v17, 0xffff0000, v183
v_pk_add_f32 v[96:97], v[96:97], v[10:11]
v_pk_add_f32 v[98:99], v[98:99], v[12:13]
v_pk_add_f32 v[100:101], v[100:101], v[14:15]
v_pk_add_f32 v[102:103], v[102:103], v[16:17]
s_waitcnt vmcnt(1)
v_lshlrev_b32 v10, 16, v184
v_and_b32 v11, 0xffff0000, v184
v_lshlrev_b32 v12, 16, v185
v_and_b32 v13, 0xffff0000, v185
v_lshlrev_b32 v14, 16, v186
v_and_b32 v15, 0xffff0000, v186
v_lshlrev_b32 v16, 16, v187
v_and_b32 v17, 0xffff0000, v187
v_pk_add_f32 v[96:97], v[96:97], v[10:11]
v_pk_add_f32 v[98:99], v[98:99], v[12:13]
v_pk_add_f32 v[100:101], v[100:101], v[14:15]
v_pk_add_f32 v[102:103], v[102:103], v[16:17]
s_waitcnt vmcnt(0)
v_lshlrev_b32 v10, 16, v188
v_and_b32 v11, 0xffff0000, v188
v_lshlrev_b32 v12, 16, v189
v_and_b32 v13, 0xffff0000, v189
v_lshlrev_b32 v14, 16, v190
v_and_b32 v15, 0xffff0000, v190
v_lshlrev_b32 v16, 16, v191
v_and_b32 v17, 0xffff0000, v191
v_pk_add_f32 v[96:97], v[96:97], v[10:11]
v_pk_add_f32 v[98:99], v[98:99], v[12:13]
v_pk_add_f32 v[100:101], v[100:101], v[14:15]
v_pk_add_f32 v[102:103], v[102:103], v[16:17]
v_cvt_pk_bf16_f32 v96, v96, v97
v_cvt_pk_bf16_f32 v97, v98, v99
v_cvt_pk_bf16_f32 v98, v100, v101
v_cvt_pk_bf16_f32 v99, v102, v103
buffer_store_dwordx2 v[96:97], v21, s[40:43], s25 offen offset:896
buffer_store_dwordx2 v[98:99], v21, s[40:43], s25 offen offset:928
M_fin:
s_endpgm
PAD_19:
s_cbranch_execz M_tret
M_final:
s_mov_b32 s8, s64
s_mov_b32 s9, s65
s_mov_b32 s10, 1835008
s_mov_b32 s11, 0x20000
s_mov_b32 s12, s88
s_mov_b32 s13, s89
s_mov_b32 s14, 3670016
s_mov_b32 s15, 0x20000
s_and_b32 s24, s2, 16
s_add_u32 s24, s24, s20
v_lshrrev_b32 v20, 4, v1
v_and_b32 v21, 15, v20
v_lshrrev_b32 v22, 4, v20
v_mul_u32_u24 v2, 896, v21
v_lshlrev_b32 v9, 1, v2
v_lshl_add_u32 v2, v22, 4, v2
v_lshl_add_u32 v9, v22, 4, v9
s_lshl_b32 s22, s24, 2
s_add_u32 s22, s22, s3
s_mul_i32 s25, s22, 14336
s_lshl_b32 s26, s25, 1
v_lshlrev_b32 v10, 5, v22
v_add3_u32 v10, v10, v21, 16
v_lshlrev_b32 v10, 2, v10
v_min_u32 v11, 380, v10
v_add_u32 v11, 512, v11
s_mov_b32 s27, 94384128
Lfp:
buffer_load_dword v3, v10, s[4:7], s27 offen sc1
buffer_load_dword v4, v11, s[4:7], s27 offen sc1
s_waitcnt vmcnt(0)
v_and_b32 v3, v3, v4
v_cmp_gt_u32 vcc, 1, v3
s_cbranch_vccz Lfpd
s_sleep 2
s_sub_u32 s101, s101, 1
s_cbranch_scc0 Lfp
s_mov_b32 s101, 0
Lfpd:
s_barrier
buffer_store_dword v6, v5, s[4:7], s35 offen sc1
Lfg:
v_lshrrev_b32 v3, 3, v20
v_and_b32 v4, 7, v20
v_lshlrev_b32 v4, 4, v4
v_lshl_add_u32 v3, v3, 12, v4
s_mul_i32 s27, s3, 458752
s_lshl_b32 s22, s24, 7
s_add_u32 s27, s27, s22
s_add_u32 s27, s27, 88080384
s_mul_i32 s28, s3, 14336
s_add_u32 m0, s28, 0
s_nop 0
buffer_load_dwordx4 v3, s[4:7], s27 offen sc1 lds
s_add_u32 s27, s27, 32768
s_add_u32 m0, s28, 1024
s_nop 0
buffer_load_dwordx4 v3, s[4:7], s27 offen sc1 lds
s_add_u32 s27, s27, 32768
s_add_u32 m0, s28, 2048
s_nop 0
buffer_load_dwordx4 v3, s[4:7], s27 offen sc1 lds
s_add_u32 s27, s27, 32768
s_add_u32 m0, s28, 3072
s_nop 0
buffer_load_dwordx4 v3, s[4:7], s27 offen sc1 lds
s_add_u32 s27, s27, 32768
s_add_u32 m0, s28, 4096
s_nop 0
buffer_load_dwordx4 v3, s[4:7], s27 offen sc1 lds
s_add_u32 s27, s27, 32768
s_add_u32 m0, s28, 5120
s_nop 0
buffer_load_dwordx4 v3, s[4:7], s27 offen sc1 lds
s_add_u32 s27, s27, 32768
s_add_u32 m0, s28, 6144
s_nop 0
buffer_load_dwordx4 v3, s[4:7], s27 offen sc1 lds
s_add_u32 s27, s27, 32768
s_add_u32 m0, s28, 7168
s_nop 0
buffer_load_dwordx4 v3, s[4:7], s27 offen sc1 lds
s_add_u32 s27, s27, 32768
s_add_u32 m0, s28, 8192
s_nop 0
buffer_load_dwordx4 v3, s[4:7], s27 offen sc1 lds
s_add_u32 s27, s27, 32768
s_add_u32 m0, s28, 9216
s_nop 0
buffer_load_dwordx4 v3, s[4:7], s27 offen sc1 lds
s_add_u32 s27, s27, 32768
s_add_u32 m0, s28, 10240
s_nop 0
buffer_load_dwordx4 v3, s[4:7], s27 offen sc1 lds
s_add_u32 s27, s27, 32768
s_add_u32 m0, s28, 11264
s_nop 0
buffer_load_dwordx4 v3, s[4:7], s27 offen sc1 lds
s_add_u32 s27, s27, 32768
s_add_u32 m0, s28, 12288
s_nop 0
buffer_load_dwordx4 v3, s[4:7], s27 offen sc1 lds
s_add_u32 s27, s27, 32768
s_add_u32 m0, s28, 13312
s_nop 0
buffer_load_dwordx4 v3, s[4:7], s27 offen sc1 lds
s_add_u32 s27, s27, 32768
buffer_load_dwordx4 v[160:163], v2, s[8:11], s25 offen offset:0
buffer_load_dwordx4 v[164:167], v2, s[8:11], s25 offen offset:64
buffer_load_dwordx4 v[168:171], v2, s[8:11], s25 offen offset:128
buffer_load_dwordx4 v[172:175], v2, s[8:11], s25 offen offset:192
buffer_load_dwordx4 v[176:179], v2, s[8:11], s25 offen offset:256
buffer_load_dwordx4 v[180:183], v2, s[8:11], s25 offen offset:320
buffer_load_dwordx4 v[184:187], v2, s[8:11], s25 offen offset:384
buffer_load_dwordx4 v[188:191], v2, s[8:11], s25 offen offset:448
buffer_load_dwordx4 v[192:195], v2, s[8:11], s25 offen offset:512
buffer_load_dwordx4 v[196:199], v2, s[8:11], s25 offen offset:576
buffer_load_dwordx4 v[200:203], v2, s[8:11], s25 offen offset:640
buffer_load_dwordx4 v[204:207], v2, s[8:11], s25 offen offset:704
buffer_load_dwordx4 v[208:211], v2, s[8:11], s25 offen offset:768
buffer_load_dwordx4 v[212:215], v2, s[8:11], s25 offen offset:832
v_lshrrev_b32 v3, 2, v21
v_lshl_add_u32 v3, v22, 3, v3
v_lshlrev_b32 v3, 7, v3
v_and_b32 v4, 3, v20
v_lshl_add_u32 v3, v4, 3, v3
s_lshl_b32 s22, s3, 5
v_add_u32 v3, s22, v3
s_waitcnt vmcnt(14)
s_barrier
ds_read_b64_tr_b16 v[96:97], v3 offset:0
ds_read_b64_tr_b16 v[98:99], v3 offset:512
ds_read_b64_tr_b16 v[100:101], v3 offset:4096
ds_read_b64_tr_b16 v[102:103], v3 offset:4608
ds_read_b64_tr_b16 v[104:105], v3 offset:8192
ds_read_b64_tr_b16 v[106:107], v3 offset:8704
ds_read_b64_tr_b16 v[108:109], v3 offset:12288
ds_read_b64_tr_b16 v[110:111], v3 offset:12800
ds_read_b64_tr_b16 v[112:113], v3 offset:16384
ds_read_b64_tr_b16 v[114:115], v3 offset:16896
ds_read_b64_tr_b16 v[116:117], v3 offset:20480
ds_read_b64_tr_b16 v[118:119], v3 offset:20992
ds_read_b64_tr_b16 v[120:121], v3 offset:24576
ds_read_b64_tr_b16 v[122:123], v3 offset:25088
s_waitcnt lgkmcnt(0)
ds_read_b64_tr_b16 v[124:125], v3 offset:28672
ds_read_b64_tr_b16 v[126:127], v3 offset:29184
ds_read_b64_tr_b16 v[128:129], v3 offset:32768
ds_read_b64_tr_b16 v[130:131], v3 offset:33280
ds_read_b64_tr_b16 v[132:133], v3 offset:36864
ds_read_b64_tr_b16 v[134:135], v3 offset:37376
ds_read_b64_tr_b16 v[136:137], v3 offset:40960
ds_read_b64_tr_b16 v[138:139], v3 offset:41472
ds_read_b64_tr_b16 v[140:141], v3 offset:45056
ds_read_b64_tr_b16 v[142:143], v3 offset:45568
ds_read_b64_tr_b16 v[144:145], v3 offset:49152
ds_read_b64_tr_b16 v[146:147], v3 offset:49664
ds_read_b64_tr_b16 v[148:149], v3 offset:53248
ds_read_b64_tr_b16 v[150:151], v3 offset:53760
s_waitcnt vmcnt(13)
v_lshlrev_b32 v10, 16, v160
v_and_b32 v11, 0xffff0000, v160
v_lshlrev_b32 v12, 16, v96
v_and_b32 v13, 0xffff0000, v96
v_pk_mul_f32 v[10:11], v[10:11], v[12:13]
v_cvt_pk_bf16_f32 v160, v10, v11
v_lshlrev_b32 v10, 16, v161
v_and_b32 v11, 0xffff0000, v161
v_lshlrev_b32 v12, 16, v97
v_and_b32 v13, 0xffff0000, v97
v_pk_mul_f32 v[10:11], v[10:11], v[12:13]
v_cvt_pk_bf16_f32 v161, v10, v11
v_lshlrev_b32 v10, 16, v162
v_and_b32 v11, 0xffff0000, v162
v_lshlrev_b32 v12, 16, v98
v_and_b32 v13, 0xffff0000, v98
v_pk_mul_f32 v[10:11], v[10:11], v[12:13]
v_cvt_pk_bf16_f32 v162, v10, v11
v_lshlrev_b32 v10, 16, v163
v_and_b32 v11, 0xffff0000, v163
v_lshlrev_b32 v12, 16, v99
PAD_20:
s_cbranch_execz M_tret
v_and_b32 v13, 0xffff0000, v99
v_pk_mul_f32 v[10:11], v[10:11], v[12:13]
v_cvt_pk_bf16_f32 v163, v10, v11
buffer_store_dwordx4 v[160:163], v9, s[12:15], s26 offen offset:0
s_waitcnt vmcnt(13)
v_lshlrev_b32 v10, 16, v164
v_and_b32 v11, 0xffff0000, v164
v_lshlrev_b32 v12, 16, v100
v_and_b32 v13, 0xffff0000, v100
v_pk_mul_f32 v[10:11], v[10:11], v[12:13]
v_cvt_pk_bf16_f32 v164, v10, v11
v_lshlrev_b32 v10, 16, v165
v_and_b32 v11, 0xffff0000, v165
v_lshlrev_b32 v12, 16, v101
v_and_b32 v13, 0xffff0000, v101
v_pk_mul_f32 v[10:11], v[10:11], v[12:13]
v_cvt_pk_bf16_f32 v165, v10, v11
v_lshlrev_b32 v10, 16, v166
v_and_b32 v11, 0xffff0000, v166
v_lshlrev_b32 v12, 16, v102
v_and_b32 v13, 0xffff0000, v102
v_pk_mul_f32 v[10:11], v[10:11], v[12:13]
v_cvt_pk_bf16_f32 v166, v10, v11
v_lshlrev_b32 v10, 16, v167
v_and_b32 v11, 0xffff0000, v167
v_lshlrev_b32 v12, 16, v103
v_and_b32 v13, 0xffff0000, v103
v_pk_mul_f32 v[10:11], v[10:11], v[12:13]
v_cvt_pk_bf16_f32 v167, v10, v11
buffer_store_dwordx4 v[164:167], v9, s[12:15], s26 offen offset:64
s_waitcnt vmcnt(13)
v_lshlrev_b32 v10, 16, v168
v_and_b32 v11, 0xffff0000, v168
v_lshlrev_b32 v12, 16, v104
v_and_b32 v13, 0xffff0000, v104
v_pk_mul_f32 v[10:11], v[10:11], v[12:13]
v_cvt_pk_bf16_f32 v168, v10, v11
v_lshlrev_b32 v10, 16, v169
v_and_b32 v11, 0xffff0000, v169
v_lshlrev_b32 v12, 16, v105
v_and_b32 v13, 0xffff0000, v105
v_pk_mul_f32 v[10:11], v[10:11], v[12:13]
v_cvt_pk_bf16_f32 v169, v10, v11
v_lshlrev_b32 v10, 16, v170
v_and_b32 v11, 0xffff0000, v170
v_lshlrev_b32 v12, 16, v106
v_and_b32 v13, 0xffff0000, v106
v_pk_mul_f32 v[10:11], v[10:11], v[12:13]
v_cvt_pk_bf16_f32 v170, v10, v11
v_lshlrev_b32 v10, 16, v171
v_and_b32 v11, 0xffff0000, v171
v_lshlrev_b32 v12, 16, v107
v_and_b32 v13, 0xffff0000, v107
v_pk_mul_f32 v[10:11], v[10:11], v[12:13]
v_cvt_pk_bf16_f32 v171, v10, v11
buffer_store_dwordx4 v[168:171], v9, s[12:15], s26 offen offset:128
s_waitcnt vmcnt(13)
v_lshlrev_b32 v10, 16, v172
v_and_b32 v11, 0xffff0000, v172
v_lshlrev_b32 v12, 16, v108
v_and_b32 v13, 0xffff0000, v108
v_pk_mul_f32 v[10:11], v[10:11], v[12:13]
v_cvt_pk_bf16_f32 v172, v10, v11
v_lshlrev_b32 v10, 16, v173
v_and_b32 v11, 0xffff0000, v173
v_lshlrev_b32 v12, 16, v109
v_and_b32 v13, 0xffff0000, v109
v_pk_mul_f32 v[10:11], v[10:11], v[12:13]
v_cvt_pk_bf16_f32 v173, v10, v11
v_lshlrev_b32 v10, 16, v174
v_and_b32 v11, 0xffff0000, v174
v_lshlrev_b32 v12, 16, v110
v_and_b32 v13, 0xffff0000, v110
v_pk_mul_f32 v[10:11], v[10:11], v[12:13]
v_cvt_pk_bf16_f32 v174, v10, v11
v_lshlrev_b32 v10, 16, v175
v_and_b32 v11, 0xffff0000, v175
v_lshlrev_b32 v12, 16, v111
v_and_b32 v13, 0xffff0000, v111
v_pk_mul_f32 v[10:11], v[10:11], v[12:13]
v_cvt_pk_bf16_f32 v175, v10, v11
buffer_store_dwordx4 v[172:175], v9, s[12:15], s26 offen offset:192
s_waitcnt vmcnt(13)
v_lshlrev_b32 v10, 16, v176
v_and_b32 v11, 0xffff0000, v176
v_lshlrev_b32 v12, 16, v112
v_and_b32 v13, 0xffff0000, v112
v_pk_mul_f32 v[10:11], v[10:11], v[12:13]
v_cvt_pk_bf16_f32 v176, v10, v11
v_lshlrev_b32 v10, 16, v177
v_and_b32 v11, 0xffff0000, v177
v_lshlrev_b32 v12, 16, v113
v_and_b32 v13, 0xffff0000, v113
v_pk_mul_f32 v[10:11], v[10:11], v[12:13]
v_cvt_pk_bf16_f32 v177, v10, v11
v_lshlrev_b32 v10, 16, v178
v_and_b32 v11, 0xffff0000, v178
v_lshlrev_b32 v12, 16, v114
v_and_b32 v13, 0xffff0000, v114
v_pk_mul_f32 v[10:11], v[10:11], v[12:13]
v_cvt_pk_bf16_f32 v178, v10, v11
v_lshlrev_b32 v10, 16, v179
v_and_b32 v11, 0xffff0000, v179
v_lshlrev_b32 v12, 16, v115
v_and_b32 v13, 0xffff0000, v115
v_pk_mul_f32 v[10:11], v[10:11], v[12:13]
v_cvt_pk_bf16_f32 v179, v10, v11
buffer_store_dwordx4 v[176:179], v9, s[12:15], s26 offen offset:256
s_waitcnt vmcnt(13)
v_lshlrev_b32 v10, 16, v180
v_and_b32 v11, 0xffff0000, v180
v_lshlrev_b32 v12, 16, v116
v_and_b32 v13, 0xffff0000, v116
v_pk_mul_f32 v[10:11], v[10:11], v[12:13]
v_cvt_pk_bf16_f32 v180, v10, v11
v_lshlrev_b32 v10, 16, v181
v_and_b32 v11, 0xffff0000, v181
v_lshlrev_b32 v12, 16, v117
v_and_b32 v13, 0xffff0000, v117
v_pk_mul_f32 v[10:11], v[10:11], v[12:13]
v_cvt_pk_bf16_f32 v181, v10, v11
v_lshlrev_b32 v10, 16, v182
v_and_b32 v11, 0xffff0000, v182
v_lshlrev_b32 v12, 16, v118
v_and_b32 v13, 0xffff0000, v118
v_pk_mul_f32 v[10:11], v[10:11], v[12:13]
v_cvt_pk_bf16_f32 v182, v10, v11
v_lshlrev_b32 v10, 16, v183
v_and_b32 v11, 0xffff0000, v183
v_lshlrev_b32 v12, 16, v119
v_and_b32 v13, 0xffff0000, v119
v_pk_mul_f32 v[10:11], v[10:11], v[12:13]
v_cvt_pk_bf16_f32 v183, v10, v11
buffer_store_dwordx4 v[180:183], v9, s[12:15], s26 offen offset:320
s_waitcnt vmcnt(13)
v_lshlrev_b32 v10, 16, v184
v_and_b32 v11, 0xffff0000, v184
v_lshlrev_b32 v12, 16, v120
v_and_b32 v13, 0xffff0000, v120
v_pk_mul_f32 v[10:11], v[10:11], v[12:13]
v_cvt_pk_bf16_f32 v184, v10, v11
v_lshlrev_b32 v10, 16, v185
v_and_b32 v11, 0xffff0000, v185
v_lshlrev_b32 v12, 16, v121
v_and_b32 v13, 0xffff0000, v121
v_pk_mul_f32 v[10:11], v[10:11], v[12:13]
v_cvt_pk_bf16_f32 v185, v10, v11
v_lshlrev_b32 v10, 16, v186
v_and_b32 v11, 0xffff0000, v186
v_lshlrev_b32 v12, 16, v122
v_and_b32 v13, 0xffff0000, v122
v_pk_mul_f32 v[10:11], v[10:11], v[12:13]
v_cvt_pk_bf16_f32 v186, v10, v11
v_lshlrev_b32 v10, 16, v187
v_and_b32 v11, 0xffff0000, v187
v_lshlrev_b32 v12, 16, v123
v_and_b32 v13, 0xffff0000, v123
v_pk_mul_f32 v[10:11], v[10:11], v[12:13]
v_cvt_pk_bf16_f32 v187, v10, v11
buffer_store_dwordx4 v[184:187], v9, s[12:15], s26 offen offset:384
s_waitcnt lgkmcnt(0)
s_waitcnt vmcnt(13)
v_lshlrev_b32 v10, 16, v188
v_and_b32 v11, 0xffff0000, v188
v_lshlrev_b32 v12, 16, v124
v_and_b32 v13, 0xffff0000, v124
v_pk_mul_f32 v[10:11], v[10:11], v[12:13]
v_cvt_pk_bf16_f32 v188, v10, v11
v_lshlrev_b32 v10, 16, v189
v_and_b32 v11, 0xffff0000, v189
v_lshlrev_b32 v12, 16, v125
v_and_b32 v13, 0xffff0000, v125
v_pk_mul_f32 v[10:11], v[10:11], v[12:13]
v_cvt_pk_bf16_f32 v189, v10, v11
v_lshlrev_b32 v10, 16, v190
v_and_b32 v11, 0xffff0000, v190
v_lshlrev_b32 v12, 16, v126
v_and_b32 v13, 0xffff0000, v126
v_pk_mul_f32 v[10:11], v[10:11], v[12:13]
v_cvt_pk_bf16_f32 v190, v10, v11
v_lshlrev_b32 v10, 16, v191
v_and_b32 v11, 0xffff0000, v191
v_lshlrev_b32 v12, 16, v127
v_and_b32 v13, 0xffff0000, v127
v_pk_mul_f32 v[10:11], v[10:11], v[12:13]
v_cvt_pk_bf16_f32 v191, v10, v11
buffer_store_dwordx4 v[188:191], v9, s[12:15], s26 offen offset:448
s_waitcnt vmcnt(13)
v_lshlrev_b32 v10, 16, v192
v_and_b32 v11, 0xffff0000, v192
v_lshlrev_b32 v12, 16, v128
v_and_b32 v13, 0xffff0000, v128
v_pk_mul_f32 v[10:11], v[10:11], v[12:13]
v_cvt_pk_bf16_f32 v192, v10, v11
v_lshlrev_b32 v10, 16, v193
v_and_b32 v11, 0xffff0000, v193
v_lshlrev_b32 v12, 16, v129
v_and_b32 v13, 0xffff0000, v129
v_pk_mul_f32 v[10:11], v[10:11], v[12:13]
v_cvt_pk_bf16_f32 v193, v10, v11
v_lshlrev_b32 v10, 16, v194
v_and_b32 v11, 0xffff0000, v194
v_lshlrev_b32 v12, 16, v130
v_and_b32 v13, 0xffff0000, v130
v_pk_mul_f32 v[10:11], v[10:11], v[12:13]
v_cvt_pk_bf16_f32 v194, v10, v11
v_lshlrev_b32 v10, 16, v195
v_and_b32 v11, 0xffff0000, v195
v_lshlrev_b32 v12, 16, v131
v_and_b32 v13, 0xffff0000, v131
v_pk_mul_f32 v[10:11], v[10:11], v[12:13]
v_cvt_pk_bf16_f32 v195, v10, v11
buffer_store_dwordx4 v[192:195], v9, s[12:15], s26 offen offset:512
s_waitcnt vmcnt(13)
v_lshlrev_b32 v10, 16, v196
v_and_b32 v11, 0xffff0000, v196
v_lshlrev_b32 v12, 16, v132
v_and_b32 v13, 0xffff0000, v132
v_pk_mul_f32 v[10:11], v[10:11], v[12:13]
v_cvt_pk_bf16_f32 v196, v10, v11
v_lshlrev_b32 v10, 16, v197
v_and_b32 v11, 0xffff0000, v197
v_lshlrev_b32 v12, 16, v133
v_and_b32 v13, 0xffff0000, v133
v_pk_mul_f32 v[10:11], v[10:11], v[12:13]
v_cvt_pk_bf16_f32 v197, v10, v11
v_lshlrev_b32 v10, 16, v198
v_and_b32 v11, 0xffff0000, v198
v_lshlrev_b32 v12, 16, v134
v_and_b32 v13, 0xffff0000, v134
v_pk_mul_f32 v[10:11], v[10:11], v[12:13]
v_cvt_pk_bf16_f32 v198, v10, v11
v_lshlrev_b32 v10, 16, v199
v_and_b32 v11, 0xffff0000, v199
v_lshlrev_b32 v12, 16, v135
v_and_b32 v13, 0xffff0000, v135
v_pk_mul_f32 v[10:11], v[10:11], v[12:13]
v_cvt_pk_bf16_f32 v199, v10, v11
buffer_store_dwordx4 v[196:199], v9, s[12:15], s26 offen offset:576
s_waitcnt vmcnt(13)
v_lshlrev_b32 v10, 16, v200
v_and_b32 v11, 0xffff0000, v200
v_lshlrev_b32 v12, 16, v136
v_and_b32 v13, 0xffff0000, v136
v_pk_mul_f32 v[10:11], v[10:11], v[12:13]
v_cvt_pk_bf16_f32 v200, v10, v11
v_lshlrev_b32 v10, 16, v201
v_and_b32 v11, 0xffff0000, v201
v_lshlrev_b32 v12, 16, v137
v_and_b32 v13, 0xffff0000, v137
v_pk_mul_f32 v[10:11], v[10:11], v[12:13]
v_cvt_pk_bf16_f32 v201, v10, v11
v_lshlrev_b32 v10, 16, v202
v_and_b32 v11, 0xffff0000, v202
v_lshlrev_b32 v12, 16, v138
v_and_b32 v13, 0xffff0000, v138
v_pk_mul_f32 v[10:11], v[10:11], v[12:13]
v_cvt_pk_bf16_f32 v202, v10, v11
v_lshlrev_b32 v10, 16, v203
v_and_b32 v11, 0xffff0000, v203
v_lshlrev_b32 v12, 16, v139
v_and_b32 v13, 0xffff0000, v139
v_pk_mul_f32 v[10:11], v[10:11], v[12:13]
v_cvt_pk_bf16_f32 v203, v10, v11
buffer_store_dwordx4 v[200:203], v9, s[12:15], s26 offen offset:640
s_waitcnt vmcnt(13)
v_lshlrev_b32 v10, 16, v204
v_and_b32 v11, 0xffff0000, v204
v_lshlrev_b32 v12, 16, v140
v_and_b32 v13, 0xffff0000, v140
v_pk_mul_f32 v[10:11], v[10:11], v[12:13]
v_cvt_pk_bf16_f32 v204, v10, v11
v_lshlrev_b32 v10, 16, v205
v_and_b32 v11, 0xffff0000, v205
v_lshlrev_b32 v12, 16, v141
v_and_b32 v13, 0xffff0000, v141
v_pk_mul_f32 v[10:11], v[10:11], v[12:13]
v_cvt_pk_bf16_f32 v205, v10, v11
v_lshlrev_b32 v10, 16, v206
v_and_b32 v11, 0xffff0000, v206
v_lshlrev_b32 v12, 16, v142
v_and_b32 v13, 0xffff0000, v142
v_pk_mul_f32 v[10:11], v[10:11], v[12:13]
v_cvt_pk_bf16_f32 v206, v10, v11
v_lshlrev_b32 v10, 16, v207
v_and_b32 v11, 0xffff0000, v207
v_lshlrev_b32 v12, 16, v143
v_and_b32 v13, 0xffff0000, v143
v_pk_mul_f32 v[10:11], v[10:11], v[12:13]
v_cvt_pk_bf16_f32 v207, v10, v11
buffer_store_dwordx4 v[204:207], v9, s[12:15], s26 offen offset:704
s_waitcnt vmcnt(13)
v_lshlrev_b32 v10, 16, v208
v_and_b32 v11, 0xffff0000, v208
v_lshlrev_b32 v12, 16, v144
v_and_b32 v13, 0xffff0000, v144
v_pk_mul_f32 v[10:11], v[10:11], v[12:13]
v_cvt_pk_bf16_f32 v208, v10, v11
v_lshlrev_b32 v10, 16, v209
v_and_b32 v11, 0xffff0000, v209
v_lshlrev_b32 v12, 16, v145
v_and_b32 v13, 0xffff0000, v145
v_pk_mul_f32 v[10:11], v[10:11], v[12:13]
v_cvt_pk_bf16_f32 v209, v10, v11
v_lshlrev_b32 v10, 16, v210
v_and_b32 v11, 0xffff0000, v210
v_lshlrev_b32 v12, 16, v146
v_and_b32 v13, 0xffff0000, v146
v_pk_mul_f32 v[10:11], v[10:11], v[12:13]
v_cvt_pk_bf16_f32 v210, v10, v11
v_lshlrev_b32 v10, 16, v211
v_and_b32 v11, 0xffff0000, v211
v_lshlrev_b32 v12, 16, v147
v_and_b32 v13, 0xffff0000, v147
v_pk_mul_f32 v[10:11], v[10:11], v[12:13]
v_cvt_pk_bf16_f32 v211, v10, v11
buffer_store_dwordx4 v[208:211], v9, s[12:15], s26 offen offset:768
s_waitcnt vmcnt(13)
v_lshlrev_b32 v10, 16, v212
v_and_b32 v11, 0xffff0000, v212
v_lshlrev_b32 v12, 16, v148
v_and_b32 v13, 0xffff0000, v148
v_pk_mul_f32 v[10:11], v[10:11], v[12:13]
v_cvt_pk_bf16_f32 v212, v10, v11
v_lshlrev_b32 v10, 16, v213
v_and_b32 v11, 0xffff0000, v213
v_lshlrev_b32 v12, 16, v149
v_and_b32 v13, 0xffff0000, v149
v_pk_mul_f32 v[10:11], v[10:11], v[12:13]
v_cvt_pk_bf16_f32 v213, v10, v11
v_lshlrev_b32 v10, 16, v214
v_and_b32 v11, 0xffff0000, v214
v_lshlrev_b32 v12, 16, v150
v_and_b32 v13, 0xffff0000, v150
v_pk_mul_f32 v[10:11], v[10:11], v[12:13]
v_cvt_pk_bf16_f32 v214, v10, v11
v_lshlrev_b32 v10, 16, v215
v_and_b32 v11, 0xffff0000, v215
v_lshlrev_b32 v12, 16, v151
v_and_b32 v13, 0xffff0000, v151
v_pk_mul_f32 v[10:11], v[10:11], v[12:13]
v_cvt_pk_bf16_f32 v215, v10, v11
buffer_store_dwordx4 v[212:215], v9, s[12:15], s26 offen offset:832
s_branch M_fin
M_rslow:
Lp_9251:
buffer_load_dword v18, v19, s[4:7], s33 offen offset:0 sc1
s_waitcnt vmcnt(0)
v_cmp_gt_u32 vcc, 1, v18
s_cbranch_vccz Lpd_9252
s_sleep 8
s_sub_u32 s101, s101, 1
s_cbranch_scc0 Lp_9251
s_mov_b32 s101, 0
Lpd_9252:
s_branch M_rjoin
PAD_21:
s_cbranch_execz PAD_25
M_V:
v_mfma_f32_16x16x32_bf16 v[32:35], a[0:3], a[128:131], 0
s_add_u32 m0, s29, 114688
ds_read_b64_tr_b16 a[136:137], v5 offset:0
v_mfma_f32_16x16x32_bf16 v[32:35], a[4:7], a[132:135], v[32:35]
s_mov_b32 s32, 1024
buffer_load_dwordx4 v16, s[12:15], s27 offen offset:0 lds
v_mfma_f32_16x16x32_bf16 v[36:39], a[8:11], a[128:131], 0
s_mov_b32 s33, 31744
ds_read_b64_tr_b16 a[138:139], v5 offset:2048
v_mfma_f32_16x16x32_bf16 v[36:39], a[12:15], a[132:135], v[36:39]
s_mov_b32 s34, 4294935552
v_mfma_f32_16x16x32_bf16 v[40:43], a[16:19], a[128:131], 0
s_mov_b32 s35, 4294935552
ds_read_b64_tr_b16 a[140:141], v5 offset:16384
v_mfma_f32_16x16x32_bf16 v[40:43], a[20:23], a[132:135], v[40:43]
s_mov_b32 s36, 4294935552
buffer_load_dwordx4 v17, s[12:15], s27 offen offset:1024 lds
v_mfma_f32_16x16x32_bf16 v[44:47], a[24:27], a[128:131], 0
s_mov_b32 s30, 8
ds_read_b64_tr_b16 a[142:143], v5 offset:18432
v_mfma_f32_16x16x32_bf16 v[44:47], a[28:31], a[132:135], v[44:47]
s_mov_b32 s82, 3221225472
v_mfma_f32_16x16x32_bf16 v[48:51], a[32:35], a[128:131], 0
s_mul_hi_u32 s38, s2, 613566757
v_mfma_f32_16x16x32_bf16 v[48:51], a[36:39], a[132:135], v[48:51]
s_mul_i32 s39, s38, 7
buffer_load_dwordx4 v18, s[12:15], s27 offen offset:2048 lds
v_mfma_f32_16x16x32_bf16 v[52:55], a[40:43], a[128:131], 0
s_sub_u32 s39, s2, s39
v_mov_b32 v246, 0
v_mov_b32 v229, 0
v_mfma_f32_16x16x32_bf16 v[52:55], a[44:47], a[132:135], v[52:55]
v_mov_b32 v231, 0
v_mfma_f32_16x16x32_bf16 v[56:59], a[48:51], a[128:131], 0
s_mov_b32 s60, s90
v_mfma_f32_16x16x32_bf16 v[56:59], a[52:55], a[132:135], v[56:59]
s_mov_b32 s61, s91
buffer_load_dwordx4 v19, s[12:15], s27 offen offset:3072 lds
v_mfma_f32_16x16x32_bf16 v[60:63], a[56:59], a[128:131], 0
s_add_u32 s27, s27, 524288
v_mfma_f32_16x16x32_bf16 v[60:63], a[60:63], a[132:135], v[60:63]
s_waitcnt lgkmcnt(0)
s_mov_b32 s62, 256
v_mfma_f32_16x16x32_bf16 v[64:67], a[0:3], a[136:139], 0
s_add_u32 m0, s28, 0
ds_read_b64_tr_b16 a[128:129], v6 offset:0
v_mfma_f32_16x16x32_bf16 v[64:67], a[4:7], a[140:143], v[64:67]
s_mov_b32 s63, 0x20000
buffer_load_dwordx4 v12, s[8:11], s24 offen offset:0 lds
v_mfma_f32_16x16x32_bf16 v[68:71], a[8:11], a[136:139], 0
s_mul_hi_u32 s55, s2, 1431655766
ds_read_b64_tr_b16 a[130:131], v6 offset:2048
v_mfma_f32_16x16x32_bf16 v[68:71], a[12:15], a[140:143], v[68:71]
s_mul_i32 s55, s55, 3
v_mfma_f32_16x16x32_bf16 v[72:75], a[16:19], a[136:139], 0
s_sub_u32 s55, s2, s55
ds_read_b64_tr_b16 a[132:133], v6 offset:16384
v_mfma_f32_16x16x32_bf16 v[72:75], a[20:23], a[140:143], v[72:75]
s_add_u32 s55, s55, 5
buffer_load_dwordx4 v13, s[8:11], s24 offen offset:1024 lds
v_mfma_f32_16x16x32_bf16 v[76:79], a[24:27], a[136:139], 0
s_lshr_b32 s22, s2, 4
ds_read_b64_tr_b16 a[134:135], v6 offset:18432
v_mfma_f32_16x16x32_bf16 v[76:79], a[28:31], a[140:143], v[76:79]
s_lshl_b32 s23, s20, 5
v_mfma_f32_16x16x32_bf16 v[80:83], a[32:35], a[136:139], 0
s_add_u32 s23, s23, s22
v_mfma_f32_16x16x32_bf16 v[80:83], a[36:39], a[140:143], v[80:83]
s_lshl_b32 s23, s23, 2
buffer_load_dwordx4 v14, s[8:11], s24 offen offset:2048 lds
v_mfma_f32_16x16x32_bf16 v[84:87], a[40:43], a[136:139], 0
s_and_b32 s22, s2, 16
v_mfma_f32_16x16x32_bf16 v[84:87], a[44:47], a[140:143], v[84:87]
s_lshl_b32 s22, s22, 7
v_mfma_f32_16x16x32_bf16 v[88:91], a[48:51], a[136:139], 0
s_add_u32 s23, s23, s22
v_mov_b32 v28, 3221225472
v_writelane_b32 v28, s23, 0
v_mfma_f32_16x16x32_bf16 v[88:91], a[52:55], a[140:143], v[88:91]
s_add_u32 s56, s23, 16384
buffer_load_dwordx4 v15, s[8:11], s24 offen offset:3072 lds
v_mfma_f32_16x16x32_bf16 v[92:95], a[56:59], a[136:139], 0
s_add_u32 s24, s24, 128
v_writelane_b32 v28, s56, 1
v_mfma_f32_16x16x32_bf16 v[92:95], a[60:63], a[140:143], v[92:95]
s_waitcnt lgkmcnt(0)
s_add_u32 s56, s23, 4096
v_writelane_b32 v28, s56, 2
v_mfma_f32_16x16x32_bf16 v[96:99], a[0:3], a[128:131], 0
s_add_u32 m0, s28, 4096
ds_read_b64_tr_b16 a[136:137], v7 offset:0
v_mfma_f32_16x16x32_bf16 v[96:99], a[4:7], a[132:135], v[96:99]
s_sub_u32 s37, 15, s21
buffer_load_dwordx4 v12, s[8:11], s25 offen offset:0 lds
v_mfma_f32_16x16x32_bf16 v[100:103], a[8:11], a[128:131], 0
ds_read_b64_tr_b16 a[138:139], v7 offset:2048
v_mfma_f32_16x16x32_bf16 v[100:103], a[12:15], a[132:135], v[100:103]
v_mfma_f32_16x16x32_bf16 v[104:107], a[16:19], a[128:131], 0
ds_read_b64_tr_b16 a[140:141], v7 offset:16384
v_mfma_f32_16x16x32_bf16 v[104:107], a[20:23], a[132:135], v[104:107]
buffer_load_dwordx4 v13, s[8:11], s25 offen offset:1024 lds
v_mfma_f32_16x16x32_bf16 v[108:111], a[24:27], a[128:131], 0
ds_read_b64_tr_b16 a[142:143], v7 offset:18432
v_mfma_f32_16x16x32_bf16 v[108:111], a[28:31], a[132:135], v[108:111]
v_mfma_f32_16x16x32_bf16 v[112:115], a[32:35], a[128:131], 0
v_mfma_f32_16x16x32_bf16 v[112:115], a[36:39], a[132:135], v[112:115]
buffer_load_dwordx4 v14, s[8:11], s25 offen offset:2048 lds
v_mfma_f32_16x16x32_bf16 v[116:119], a[40:43], a[128:131], 0
v_mfma_f32_16x16x32_bf16 v[116:119], a[44:47], a[132:135], v[116:119]
v_mfma_f32_16x16x32_bf16 v[120:123], a[48:51], a[128:131], 0
v_mfma_f32_16x16x32_bf16 v[120:123], a[52:55], a[132:135], v[120:123]
buffer_load_dwordx4 v15, s[8:11], s25 offen offset:3072 lds
v_mfma_f32_16x16x32_bf16 v[124:127], a[56:59], a[128:131], 0
s_add_u32 s25, s25, 128
v_mfma_f32_16x16x32_bf16 v[124:127], a[60:63], a[132:135], v[124:127]
s_waitcnt vmcnt(17) lgkmcnt(0)
s_barrier
v_mfma_f32_16x16x32_bf16 v[128:131], a[0:3], a[136:139], 0
ds_read_b64_tr_b16 a[128:129], v8 offset:0
v_mfma_f32_16x16x32_bf16 v[128:131], a[4:7], a[140:143], v[128:131]
buffer_load_dword v21, v20, s[16:19], s43 offen
v_mfma_f32_16x16x32_bf16 v[132:135], a[8:11], a[136:139], 0
s_add_u32 s43, s43, s47
ds_read_b64_tr_b16 a[130:131], v8 offset:2048
v_mfma_f32_16x16x32_bf16 v[132:135], a[12:15], a[140:143], v[132:135]
s_cmp_ge_u32 s43, s51
v_mfma_f32_16x16x32_bf16 v[136:139], a[16:19], a[136:139], 0
s_cselect_b32 s43, 0, s43
ds_read_b64_tr_b16 a[132:133], v8 offset:16384
v_mfma_f32_16x16x32_bf16 v[136:139], a[20:23], a[140:143], v[136:139]
s_cselect_b32 s51, s42, s51
v_mfma_f32_16x16x32_bf16 v[140:143], a[24:27], a[136:139], 0
s_cselect_b64 s[16:17], s[40:41], s[16:17]
ds_read_b64_tr_b16 a[134:135], v8 offset:18432
v_mfma_f32_16x16x32_bf16 v[140:143], a[28:31], a[140:143], v[140:143]
s_cselect_b32 s18, s42, s18
v_mfma_f32_16x16x32_bf16 v[144:147], a[32:35], a[136:139], 0
s_cselect_b64 s[40:41], s[44:45], s[40:41]
ds_read_b128 a[64:67], v2 offset:32768
v_mfma_f32_16x16x32_bf16 v[144:147], a[36:39], a[140:143], v[144:147]
s_cselect_b32 s42, s46, s42
v_mfma_f32_16x16x32_bf16 v[148:151], a[40:43], a[136:139], 0
s_cselect_b32 s46, 0, s46
ds_read_b128 a[68:71], v3 offset:32768
v_mfma_f32_16x16x32_bf16 v[148:151], a[44:47], a[140:143], v[148:151]
ds_read_b128 a[72:75], v2 offset:34816
v_mfma_f32_16x16x32_bf16 v[152:155], a[48:51], a[136:139], 0
ds_read_b128 a[76:79], v3 offset:34816
v_mfma_f32_16x16x32_bf16 v[152:155], a[52:55], a[140:143], v[152:155]
buffer_load_dword v21, v20, s[16:19], s43 offen
v_mfma_f32_16x16x32_bf16 v[156:159], a[56:59], a[136:139], 0
s_add_u32 s43, s43, s47
ds_read_b128 a[80:83], v2 offset:36864
v_mfma_f32_16x16x32_bf16 v[156:159], a[60:63], a[140:143], v[156:159]
s_waitcnt lgkmcnt(5)
s_cmp_ge_u32 s43, s51
ds_read_b128 a[84:87], v3 offset:36864
v_mfma_f32_16x16x32_bf16 v[160:163], a[0:3], a[128:131], 0
s_cselect_b32 s43, 0, s43
ds_read_b64_tr_b16 a[136:137], v9 offset:0
v_mfma_f32_16x16x32_bf16 v[160:163], a[4:7], a[132:135], v[160:163]
s_cselect_b32 s51, s42, s51
v_mfma_f32_16x16x32_bf16 v[164:167], a[8:11], a[128:131], 0
s_cselect_b64 s[16:17], s[40:41], s[16:17]
ds_read_b64_tr_b16 a[138:139], v9 offset:2048
v_mfma_f32_16x16x32_bf16 v[164:167], a[12:15], a[132:135], v[164:167]
s_cselect_b32 s18, s42, s18
v_mfma_f32_16x16x32_bf16 v[168:171], a[16:19], a[128:131], 0
s_cselect_b64 s[40:41], s[44:45], s[40:41]
ds_read_b64_tr_b16 a[140:141], v9 offset:16384
v_mfma_f32_16x16x32_bf16 v[168:171], a[20:23], a[132:135], v[168:171]
s_cselect_b32 s42, s46, s42
v_mfma_f32_16x16x32_bf16 v[172:175], a[24:27], a[128:131], 0
s_cselect_b32 s46, 0, s46
ds_read_b64_tr_b16 a[142:143], v9 offset:18432
v_mfma_f32_16x16x32_bf16 v[172:175], a[28:31], a[132:135], v[172:175]
s_bitcmp1_b32 s2, 4
s_cselect_b32 s37, s21, s37
s_lshl_b32 s56, s37, 5
v_mfma_f32_16x16x32_bf16 v[176:179], a[32:35], a[128:131], 0
s_add_u32 s56, s56, s20
s_lshl_b32 s56, s56, 2
s_add_u32 s56, s56, 8192
v_mfma_f32_16x16x32_bf16 v[176:179], a[36:39], a[132:135], v[176:179]
v_writelane_b32 v28, s56, 3
v_mfma_f32_16x16x32_bf16 v[180:183], a[40:43], a[128:131], 0
s_add_u32 s56, s56, 2048
ds_read_b128 a[88:91], v2 offset:38912
v_writelane_b32 v28, s56, 6
v_mfma_f32_16x16x32_bf16 v[180:183], a[44:47], a[132:135], v[180:183]
s_lshl_b32 s56, s2, 2
s_add_u32 s56, s56, 12288
ds_read_b128 a[92:95], v3 offset:38912
v_mfma_f32_16x16x32_bf16 v[184:187], a[48:51], a[128:131], 0
s_waitcnt lgkmcnt(2)
ds_read_b128 a[96:99], v2 offset:40960
v_writelane_b32 v28, s56, 4
v_mfma_f32_16x16x32_bf16 v[184:187], a[52:55], a[132:135], v[184:187]
s_lshl_b32 s56, s39, 5
s_add_u32 s56, s56, s38
s_lshl_b32 s56, s56, 2
v_mfma_f32_16x16x32_bf16 v[188:191], a[56:59], a[128:131], 0
s_add_u32 s56, s56, 20480
s_cmp_lt_u32 s2, 224
ds_read_b128 a[100:103], v3 offset:40960
v_mfma_f32_16x16x32_bf16 v[188:191], a[60:63], a[132:135], v[188:191]
s_cselect_b32 s56, s56, 3221225472
ds_read_b128 a[104:107], v2 offset:43008
v_writelane_b32 v28, s56, 7
v_mfma_f32_16x16x32_bf16 v[192:195], a[0:3], a[136:139], 0
s_cmp_eq_u32 s3, 0
s_cselect_b32 s56, 94371840, 3221225472
ds_read_b64_tr_b16 a[128:129], v10 offset:0
v_mfma_f32_16x16x32_bf16 v[192:195], a[4:7], a[140:143], v[192:195]
buffer_store_dword v246, v28, s[4:7], s56 offen sc1
v_mfma_f32_16x16x32_bf16 v[196:199], a[8:11], a[136:139], 0
ds_read_b64_tr_b16 a[130:131], v10 offset:2048
v_mov_b32 v27, 1
v_mfma_f32_16x16x32_bf16 v[196:199], a[12:15], a[140:143], v[196:199]
v_cmp_eq_u32 vcc, 0, v0
v_mov_b32 v26, 3221225472
v_mfma_f32_16x16x32_bf16 v[200:203], a[16:19], a[136:139], 0
s_lshl_b32 s31, s20, 20
s_lshl_b32 s22, s21, 17
ds_read_b64_tr_b16 a[132:133], v10 offset:16384
v_mfma_f32_16x16x32_bf16 v[200:203], a[20:23], a[140:143], v[200:203]
v_cndmask_b32 v26, v26, v246, vcc
v_mfma_f32_16x16x32_bf16 v[204:207], a[24:27], a[136:139], 0
s_add_u32 s31, s31, s22
s_lshr_b32 s22, s3, 1
ds_read_b64_tr_b16 a[134:135], v10 offset:18432
v_mfma_f32_16x16x32_bf16 v[204:207], a[28:31], a[140:143], v[204:207]
s_lshl_b32 s22, s22, 16
s_add_u32 s31, s31, s22
s_and_b32 s22, s3, 1
v_mfma_f32_16x16x32_bf16 v[208:211], a[32:35], a[136:139], 0
s_lshl_b32 s22, s22, 14
s_add_u32 s31, s31, s22
s_add_u32 s31, s31, 16777216
v_mfma_f32_16x16x32_bf16 v[208:211], a[36:39], a[140:143], v[208:211]
v_mfma_f32_16x16x32_bf16 v[212:215], a[40:43], a[136:139], 0
ds_read_b128 a[108:111], v3 offset:43008
v_mfma_f32_16x16x32_bf16 v[212:215], a[44:47], a[140:143], v[212:215]
ds_read_b128 a[112:115], v2 offset:45056
v_mfma_f32_16x16x32_bf16 v[216:219], a[48:51], a[136:139], 0
ds_read_b128 a[116:119], v3 offset:45056
v_mfma_f32_16x16x32_bf16 v[216:219], a[52:55], a[140:143], v[216:219]
v_mfma_f32_16x16x32_bf16 v[220:223], a[56:59], a[136:139], 0
ds_read_b128 a[120:123], v2 offset:47104
v_mfma_f32_16x16x32_bf16 v[220:223], a[60:63], a[140:143], v[220:223]
s_waitcnt lgkmcnt(4)
ds_read_b128 a[124:127], v3 offset:47104
v_mfma_f32_16x16x32_bf16 a[192:195], a[0:3], a[128:131], 0
ds_read_b64_tr_b16 a[136:137], v11 offset:0
v_mfma_f32_16x16x32_bf16 a[192:195], a[4:7], a[132:135], a[192:195]
v_mfma_f32_16x16x32_bf16 a[196:199], a[8:11], a[128:131], 0
ds_read_b64_tr_b16 a[138:139], v11 offset:2048
v_mfma_f32_16x16x32_bf16 a[196:199], a[12:15], a[132:135], a[196:199]
PAD_22:
s_cbranch_execz PAD_26
v_mfma_f32_16x16x32_bf16 a[200:203], a[16:19], a[128:131], 0
ds_read_b64_tr_b16 a[140:141], v11 offset:16384
v_mfma_f32_16x16x32_bf16 a[200:203], a[20:23], a[132:135], a[200:203]
v_mfma_f32_16x16x32_bf16 a[204:207], a[24:27], a[128:131], 0
ds_read_b64_tr_b16 a[142:143], v11 offset:18432
v_mfma_f32_16x16x32_bf16 a[204:207], a[28:31], a[132:135], a[204:207]
v_mfma_f32_16x16x32_bf16 a[208:211], a[32:35], a[128:131], 0
v_mfma_f32_16x16x32_bf16 a[208:211], a[36:39], a[132:135], a[208:211]
v_mfma_f32_16x16x32_bf16 a[212:215], a[40:43], a[128:131], 0
v_mfma_f32_16x16x32_bf16 a[212:215], a[44:47], a[132:135], a[212:215]
v_mfma_f32_16x16x32_bf16 a[216:219], a[48:51], a[128:131], 0
v_mfma_f32_16x16x32_bf16 a[216:219], a[52:55], a[132:135], a[216:219]
v_mfma_f32_16x16x32_bf16 a[220:223], a[56:59], a[128:131], 0
s_waitcnt vmcnt(3) lgkmcnt(0)
v_mfma_f32_16x16x32_bf16 a[220:223], a[60:63], a[132:135], a[220:223]
s_barrier
v_mfma_f32_16x16x32_bf16 a[224:227], a[0:3], a[136:139], 0
s_add_u32 m0, s29, 65536
ds_read_b64_tr_b16 a[128:129], v4 offset:32768
v_mfma_f32_16x16x32_bf16 a[224:227], a[4:7], a[140:143], a[224:227]
buffer_load_dwordx4 v16, s[12:15], s26 offen offset:0 lds
v_mfma_f32_16x16x32_bf16 a[228:231], a[8:11], a[136:139], 0
ds_read_b64_tr_b16 a[130:131], v4 offset:34816
v_mfma_f32_16x16x32_bf16 a[228:231], a[12:15], a[140:143], a[228:231]
v_mfma_f32_16x16x32_bf16 a[232:235], a[16:19], a[136:139], 0
ds_read_b64_tr_b16 a[132:133], v4 offset:49152
v_mfma_f32_16x16x32_bf16 a[232:235], a[20:23], a[140:143], a[232:235]
buffer_load_dwordx4 v17, s[12:15], s26 offen offset:1024 lds
v_mfma_f32_16x16x32_bf16 a[236:239], a[24:27], a[136:139], 0
ds_read_b64_tr_b16 a[134:135], v4 offset:51200
v_mfma_f32_16x16x32_bf16 a[236:239], a[28:31], a[140:143], a[236:239]
v_mfma_f32_16x16x32_bf16 a[240:243], a[32:35], a[136:139], 0
v_mfma_f32_16x16x32_bf16 a[240:243], a[36:39], a[140:143], a[240:243]
buffer_load_dwordx4 v18, s[12:15], s26 offen offset:2048 lds
v_mfma_f32_16x16x32_bf16 a[244:247], a[40:43], a[136:139], 0
v_mfma_f32_16x16x32_bf16 a[244:247], a[44:47], a[140:143], a[244:247]
v_mfma_f32_16x16x32_bf16 a[248:251], a[48:51], a[136:139], 0
v_mfma_f32_16x16x32_bf16 a[248:251], a[52:55], a[140:143], a[248:251]
buffer_load_dwordx4 v19, s[12:15], s26 offen offset:3072 lds
v_mfma_f32_16x16x32_bf16 a[252:255], a[56:59], a[136:139], 0
s_add_u32 s26, s26, 524288
v_mfma_f32_16x16x32_bf16 a[252:255], a[60:63], a[140:143], a[252:255]
s_waitcnt lgkmcnt(0)
Lg_501:
v_mfma_f32_16x16x32_bf16 v[32:35], a[64:67], a[128:131], v[32:35]
s_add_u32 m0, s29, 81920
ds_read_b64_tr_b16 a[136:137], v5 offset:32768
v_mfma_f32_16x16x32_bf16 v[32:35], a[68:71], a[132:135], v[32:35]
buffer_load_dwordx4 v16, s[12:15], s27 offen offset:0 lds
v_mfma_f32_16x16x32_bf16 v[36:39], a[72:75], a[128:131], v[36:39]
ds_read_b64_tr_b16 a[138:139], v5 offset:34816
v_mfma_f32_16x16x32_bf16 v[36:39], a[76:79], a[132:135], v[36:39]
v_mfma_f32_16x16x32_bf16 v[40:43], a[80:83], a[128:131], v[40:43]
ds_read_b64_tr_b16 a[140:141], v5 offset:49152
v_mfma_f32_16x16x32_bf16 v[40:43], a[84:87], a[132:135], v[40:43]
buffer_load_dwordx4 v17, s[12:15], s27 offen offset:1024 lds
v_mfma_f32_16x16x32_bf16 v[44:47], a[88:91], a[128:131], v[44:47]
ds_read_b64_tr_b16 a[142:143], v5 offset:51200
v_mfma_f32_16x16x32_bf16 v[44:47], a[92:95], a[132:135], v[44:47]
v_mfma_f32_16x16x32_bf16 v[48:51], a[96:99], a[128:131], v[48:51]
ds_read_b128 a[0:3], v2 offset:0
v_mfma_f32_16x16x32_bf16 v[48:51], a[100:103], a[132:135], v[48:51]
buffer_load_dwordx4 v18, s[12:15], s27 offen offset:2048 lds
v_mfma_f32_16x16x32_bf16 v[52:55], a[104:107], a[128:131], v[52:55]
ds_read_b128 a[4:7], v3 offset:0
v_mfma_f32_16x16x32_bf16 v[52:55], a[108:111], a[132:135], v[52:55]
v_mfma_f32_16x16x32_bf16 v[56:59], a[112:115], a[128:131], v[56:59]
v_mfma_f32_16x16x32_bf16 v[56:59], a[116:119], a[132:135], v[56:59]
buffer_load_dwordx4 v19, s[12:15], s27 offen offset:3072 lds
v_mfma_f32_16x16x32_bf16 v[60:63], a[120:123], a[128:131], v[60:63]
s_add_u32 s27, s27, 524288
ds_read_b128 a[8:11], v2 offset:2048
v_mfma_f32_16x16x32_bf16 v[60:63], a[124:127], a[132:135], v[60:63]
s_waitcnt lgkmcnt(3)
v_mfma_f32_16x16x32_bf16 v[64:67], a[64:67], a[136:139], v[64:67]
s_add_u32 m0, s28, 32768
ds_read_b64_tr_b16 a[128:129], v6 offset:32768
v_mfma_f32_16x16x32_bf16 v[64:67], a[68:71], a[140:143], v[64:67]
buffer_load_dwordx4 v12, s[8:11], s24 offen offset:0 lds
v_mfma_f32_16x16x32_bf16 v[68:71], a[72:75], a[136:139], v[68:71]
ds_read_b64_tr_b16 a[130:131], v6 offset:34816
v_mfma_f32_16x16x32_bf16 v[68:71], a[76:79], a[140:143], v[68:71]
v_mfma_f32_16x16x32_bf16 v[72:75], a[80:83], a[136:139], v[72:75]
ds_read_b64_tr_b16 a[132:133], v6 offset:49152
v_mfma_f32_16x16x32_bf16 v[72:75], a[84:87], a[140:143], v[72:75]
buffer_load_dwordx4 v13, s[8:11], s24 offen offset:1024 lds
v_mfma_f32_16x16x32_bf16 v[76:79], a[88:91], a[136:139], v[76:79]
ds_read_b64_tr_b16 a[134:135], v6 offset:51200
v_mfma_f32_16x16x32_bf16 v[76:79], a[92:95], a[140:143], v[76:79]
v_mfma_f32_16x16x32_bf16 v[80:83], a[96:99], a[136:139], v[80:83]
ds_read_b128 a[12:15], v3 offset:2048
v_mfma_f32_16x16x32_bf16 v[80:83], a[100:103], a[140:143], v[80:83]
buffer_load_dwordx4 v14, s[8:11], s24 offen offset:2048 lds
v_mfma_f32_16x16x32_bf16 v[84:87], a[104:107], a[136:139], v[84:87]
v_mfma_f32_16x16x32_bf16 v[84:87], a[108:111], a[140:143], v[84:87]
v_mfma_f32_16x16x32_bf16 v[88:91], a[112:115], a[136:139], v[88:91]
ds_read_b128 a[16:19], v2 offset:4096
v_mfma_f32_16x16x32_bf16 v[88:91], a[116:119], a[140:143], v[88:91]
buffer_load_dwordx4 v15, s[8:11], s24 offen offset:3072 lds
v_mfma_f32_16x16x32_bf16 v[92:95], a[120:123], a[136:139], v[92:95]
s_add_u32 s24, s24, 128
ds_read_b128 a[20:23], v3 offset:4096
v_mfma_f32_16x16x32_bf16 v[92:95], a[124:127], a[140:143], v[92:95]
s_waitcnt lgkmcnt(3)
v_mfma_f32_16x16x32_bf16 v[96:99], a[64:67], a[128:131], v[96:99]
s_add_u32 m0, s28, 36864
ds_read_b64_tr_b16 a[136:137], v7 offset:32768
v_mfma_f32_16x16x32_bf16 v[96:99], a[68:71], a[132:135], v[96:99]
buffer_load_dwordx4 v12, s[8:11], s25 offen offset:0 lds
v_mfma_f32_16x16x32_bf16 v[100:103], a[72:75], a[128:131], v[100:103]
ds_read_b64_tr_b16 a[138:139], v7 offset:34816
v_mfma_f32_16x16x32_bf16 v[100:103], a[76:79], a[132:135], v[100:103]
v_mfma_f32_16x16x32_bf16 v[104:107], a[80:83], a[128:131], v[104:107]
ds_read_b64_tr_b16 a[140:141], v7 offset:49152
v_mfma_f32_16x16x32_bf16 v[104:107], a[84:87], a[132:135], v[104:107]
buffer_load_dwordx4 v13, s[8:11], s25 offen offset:1024 lds
v_mfma_f32_16x16x32_bf16 v[108:111], a[88:91], a[128:131], v[108:111]
ds_read_b64_tr_b16 a[142:143], v7 offset:51200
v_mfma_f32_16x16x32_bf16 v[108:111], a[92:95], a[132:135], v[108:111]
v_mfma_f32_16x16x32_bf16 v[112:115], a[96:99], a[128:131], v[112:115]
v_mfma_f32_16x16x32_bf16 v[112:115], a[100:103], a[132:135], v[112:115]
buffer_load_dwordx4 v14, s[8:11], s25 offen offset:2048 lds
v_mfma_f32_16x16x32_bf16 v[116:119], a[104:107], a[128:131], v[116:119]
ds_read_b128 a[24:27], v2 offset:6144
v_mfma_f32_16x16x32_bf16 v[116:119], a[108:111], a[132:135], v[116:119]
v_mfma_f32_16x16x32_bf16 v[120:123], a[112:115], a[128:131], v[120:123]
ds_read_b128 a[28:31], v3 offset:6144
v_mfma_f32_16x16x32_bf16 v[120:123], a[116:119], a[132:135], v[120:123]
buffer_load_dwordx4 v15, s[8:11], s25 offen offset:3072 lds
v_mfma_f32_16x16x32_bf16 v[124:127], a[120:123], a[128:131], v[124:127]
s_add_u32 s25, s25, 128
v_mfma_f32_16x16x32_bf16 v[124:127], a[124:127], a[132:135], v[124:127]
s_waitcnt lgkmcnt(2)
v_mfma_f32_16x16x32_bf16 v[128:131], a[64:67], a[136:139], v[128:131]
ds_read_b64_tr_b16 a[128:129], v8 offset:32768
v_mfma_f32_16x16x32_bf16 v[128:131], a[68:71], a[140:143], v[128:131]
buffer_load_dword v21, v20, s[16:19], s43 offen
v_mfma_f32_16x16x32_bf16 v[132:135], a[72:75], a[136:139], v[132:135]
s_add_u32 s43, s43, s47
ds_read_b64_tr_b16 a[130:131], v8 offset:34816
v_mfma_f32_16x16x32_bf16 v[132:135], a[76:79], a[140:143], v[132:135]
s_cmp_ge_u32 s43, s51
v_mfma_f32_16x16x32_bf16 v[136:139], a[80:83], a[136:139], v[136:139]
s_cselect_b32 s43, 0, s43
ds_read_b64_tr_b16 a[132:133], v8 offset:49152
v_mfma_f32_16x16x32_bf16 v[136:139], a[84:87], a[140:143], v[136:139]
s_cselect_b32 s51, s42, s51
v_mfma_f32_16x16x32_bf16 v[140:143], a[88:91], a[136:139], v[140:143]
s_cselect_b64 s[16:17], s[40:41], s[16:17]
ds_read_b64_tr_b16 a[134:135], v8 offset:51200
v_mfma_f32_16x16x32_bf16 v[140:143], a[92:95], a[140:143], v[140:143]
s_cselect_b32 s18, s42, s18
v_mfma_f32_16x16x32_bf16 v[144:147], a[96:99], a[136:139], v[144:147]
s_cselect_b64 s[40:41], s[44:45], s[40:41]
ds_read_b128 a[32:35], v2 offset:8192
v_mfma_f32_16x16x32_bf16 v[144:147], a[100:103], a[140:143], v[144:147]
s_cselect_b32 s42, s46, s42
v_mfma_f32_16x16x32_bf16 v[148:151], a[104:107], a[136:139], v[148:151]
s_cselect_b32 s46, 0, s46
v_mfma_f32_16x16x32_bf16 v[148:151], a[108:111], a[140:143], v[148:151]
s_cmp_eq_u32 s30, s55
v_mfma_f32_16x16x32_bf16 v[152:155], a[112:115], a[136:139], v[152:155]
s_cselect_b32 s22, 0, 3221225472
ds_read_b128 a[36:39], v3 offset:8192
v_mfma_f32_16x16x32_bf16 v[152:155], a[116:119], a[140:143], v[152:155]
s_sub_u32 s30, s30, 1
buffer_atomic_add v27, v26, s[60:63], s22 offen sc1
v_mfma_f32_16x16x32_bf16 v[156:159], a[120:123], a[136:139], v[156:159]
ds_read_b128 a[40:43], v2 offset:10240
v_mfma_f32_16x16x32_bf16 v[156:159], a[124:127], a[140:143], v[156:159]
s_waitcnt lgkmcnt(3)
v_mfma_f32_16x16x32_bf16 v[160:163], a[64:67], a[128:131], v[160:163]
ds_read_b64_tr_b16 a[136:137], v9 offset:32768
v_mfma_f32_16x16x32_bf16 v[160:163], a[68:71], a[132:135], v[160:163]
v_mfma_f32_16x16x32_bf16 v[164:167], a[72:75], a[128:131], v[164:167]
ds_read_b64_tr_b16 a[138:139], v9 offset:34816
v_mfma_f32_16x16x32_bf16 v[164:167], a[76:79], a[132:135], v[164:167]
v_mfma_f32_16x16x32_bf16 v[168:171], a[80:83], a[128:131], v[168:171]
ds_read_b64_tr_b16 a[140:141], v9 offset:49152
v_mfma_f32_16x16x32_bf16 v[168:171], a[84:87], a[132:135], v[168:171]
v_mfma_f32_16x16x32_bf16 v[172:175], a[88:91], a[128:131], v[172:175]
ds_read_b64_tr_b16 a[142:143], v9 offset:51200
v_mfma_f32_16x16x32_bf16 v[172:175], a[92:95], a[132:135], v[172:175]
v_mfma_f32_16x16x32_bf16 v[176:179], a[96:99], a[128:131], v[176:179]
v_mfma_f32_16x16x32_bf16 v[176:179], a[100:103], a[132:135], v[176:179]
v_mfma_f32_16x16x32_bf16 v[180:183], a[104:107], a[128:131], v[180:183]
ds_read_b128 a[44:47], v3 offset:10240
v_mfma_f32_16x16x32_bf16 v[180:183], a[108:111], a[132:135], v[180:183]
v_mfma_f32_16x16x32_bf16 v[184:187], a[112:115], a[128:131], v[184:187]
ds_read_b128 a[48:51], v2 offset:12288
v_mfma_f32_16x16x32_bf16 v[184:187], a[116:119], a[132:135], v[184:187]
v_mfma_f32_16x16x32_bf16 v[188:191], a[120:123], a[128:131], v[188:191]
v_mfma_f32_16x16x32_bf16 v[188:191], a[124:127], a[132:135], v[188:191]
s_waitcnt lgkmcnt(2)
v_mfma_f32_16x16x32_bf16 v[192:195], a[64:67], a[136:139], v[192:195]
ds_read_b64_tr_b16 a[128:129], v10 offset:32768
v_mfma_f32_16x16x32_bf16 v[192:195], a[68:71], a[140:143], v[192:195]
v_mfma_f32_16x16x32_bf16 v[196:199], a[72:75], a[136:139], v[196:199]
ds_read_b64_tr_b16 a[130:131], v10 offset:34816
v_mfma_f32_16x16x32_bf16 v[196:199], a[76:79], a[140:143], v[196:199]
v_mfma_f32_16x16x32_bf16 v[200:203], a[80:83], a[136:139], v[200:203]
ds_read_b64_tr_b16 a[132:133], v10 offset:49152
v_mfma_f32_16x16x32_bf16 v[200:203], a[84:87], a[140:143], v[200:203]
v_mfma_f32_16x16x32_bf16 v[204:207], a[88:91], a[136:139], v[204:207]
ds_read_b64_tr_b16 a[134:135], v10 offset:51200
v_mfma_f32_16x16x32_bf16 v[204:207], a[92:95], a[140:143], v[204:207]
v_mfma_f32_16x16x32_bf16 v[208:211], a[96:99], a[136:139], v[208:211]
ds_read_b128 a[52:55], v3 offset:12288
v_mfma_f32_16x16x32_bf16 v[208:211], a[100:103], a[140:143], v[208:211]
v_mfma_f32_16x16x32_bf16 v[212:215], a[104:107], a[136:139], v[212:215]
ds_read_b128 a[56:59], v2 offset:14336
v_mfma_f32_16x16x32_bf16 v[212:215], a[108:111], a[140:143], v[212:215]
v_mfma_f32_16x16x32_bf16 v[216:219], a[112:115], a[136:139], v[216:219]
v_mfma_f32_16x16x32_bf16 v[216:219], a[116:119], a[140:143], v[216:219]
v_mfma_f32_16x16x32_bf16 v[220:223], a[120:123], a[136:139], v[220:223]
ds_read_b128 a[60:63], v3 offset:14336
v_mfma_f32_16x16x32_bf16 v[220:223], a[124:127], a[140:143], v[220:223]
s_waitcnt lgkmcnt(3)
v_mfma_f32_16x16x32_bf16 a[192:195], a[64:67], a[128:131], a[192:195]
ds_read_b64_tr_b16 a[136:137], v11 offset:32768
v_mfma_f32_16x16x32_bf16 a[192:195], a[68:71], a[132:135], a[192:195]
v_mfma_f32_16x16x32_bf16 a[196:199], a[72:75], a[128:131], a[196:199]
ds_read_b64_tr_b16 a[138:139], v11 offset:34816
v_mfma_f32_16x16x32_bf16 a[196:199], a[76:79], a[132:135], a[196:199]
v_mfma_f32_16x16x32_bf16 a[200:203], a[80:83], a[128:131], a[200:203]
ds_read_b64_tr_b16 a[140:141], v11 offset:49152
v_mfma_f32_16x16x32_bf16 a[200:203], a[84:87], a[132:135], a[200:203]
v_mfma_f32_16x16x32_bf16 a[204:207], a[88:91], a[128:131], a[204:207]
ds_read_b64_tr_b16 a[142:143], v11 offset:51200
v_mfma_f32_16x16x32_bf16 a[204:207], a[92:95], a[132:135], a[204:207]
v_mfma_f32_16x16x32_bf16 a[208:211], a[96:99], a[128:131], a[208:211]
v_mfma_f32_16x16x32_bf16 a[208:211], a[100:103], a[132:135], a[208:211]
v_mfma_f32_16x16x32_bf16 a[212:215], a[104:107], a[128:131], a[212:215]
v_mfma_f32_16x16x32_bf16 a[212:215], a[108:111], a[132:135], a[212:215]
v_mfma_f32_16x16x32_bf16 a[216:219], a[112:115], a[128:131], a[216:219]
v_mfma_f32_16x16x32_bf16 a[216:219], a[116:119], a[132:135], a[216:219]
v_mfma_f32_16x16x32_bf16 a[220:223], a[120:123], a[128:131], a[220:223]
s_waitcnt vmcnt(2) lgkmcnt(0)
v_mfma_f32_16x16x32_bf16 a[220:223], a[124:127], a[132:135], a[220:223]
s_barrier
v_mfma_f32_16x16x32_bf16 a[224:227], a[64:67], a[136:139], a[224:227]
s_add_u32 m0, s29, 98304
ds_read_b64_tr_b16 a[128:129], v4 offset:0
v_mfma_f32_16x16x32_bf16 a[224:227], a[68:71], a[140:143], a[224:227]
buffer_load_dwordx4 v16, s[12:15], s26 offen offset:0 lds
v_mfma_f32_16x16x32_bf16 a[228:231], a[72:75], a[136:139], a[228:231]
ds_read_b64_tr_b16 a[130:131], v4 offset:2048
v_mfma_f32_16x16x32_bf16 a[228:231], a[76:79], a[140:143], a[228:231]
v_mfma_f32_16x16x32_bf16 a[232:235], a[80:83], a[136:139], a[232:235]
ds_read_b64_tr_b16 a[132:133], v4 offset:16384
v_mfma_f32_16x16x32_bf16 a[232:235], a[84:87], a[140:143], a[232:235]
buffer_load_dwordx4 v17, s[12:15], s26 offen offset:1024 lds
v_mfma_f32_16x16x32_bf16 a[236:239], a[88:91], a[136:139], a[236:239]
ds_read_b64_tr_b16 a[134:135], v4 offset:18432
v_mfma_f32_16x16x32_bf16 a[236:239], a[92:95], a[140:143], a[236:239]
v_mfma_f32_16x16x32_bf16 a[240:243], a[96:99], a[136:139], a[240:243]
v_mfma_f32_16x16x32_bf16 a[240:243], a[100:103], a[140:143], a[240:243]
buffer_load_dwordx4 v18, s[12:15], s26 offen offset:2048 lds
v_mfma_f32_16x16x32_bf16 a[244:247], a[104:107], a[136:139], a[244:247]
v_mfma_f32_16x16x32_bf16 a[244:247], a[108:111], a[140:143], a[244:247]
v_mfma_f32_16x16x32_bf16 a[248:251], a[112:115], a[136:139], a[248:251]
v_mfma_f32_16x16x32_bf16 a[248:251], a[116:119], a[140:143], a[248:251]
buffer_load_dwordx4 v19, s[12:15], s26 offen offset:3072 lds
v_mfma_f32_16x16x32_bf16 a[252:255], a[120:123], a[136:139], a[252:255]
s_add_u32 s26, s26, 524288
v_mfma_f32_16x16x32_bf16 a[252:255], a[124:127], a[140:143], a[252:255]
s_waitcnt lgkmcnt(0)
buffer_store_dword v27, v26, s[4:7], s82 offen sc1
v_mfma_f32_16x16x32_bf16 v[32:35], a[0:3], a[128:131], v[32:35]
s_add_u32 m0, s29, 114688
ds_read_b64_tr_b16 a[136:137], v5 offset:0
v_mfma_f32_16x16x32_bf16 v[32:35], a[4:7], a[132:135], v[32:35]
buffer_load_dwordx4 v16, s[12:15], s27 offen offset:0 lds
v_mfma_f32_16x16x32_bf16 v[36:39], a[8:11], a[128:131], v[36:39]
ds_read_b64_tr_b16 a[138:139], v5 offset:2048
v_mfma_f32_16x16x32_bf16 v[36:39], a[12:15], a[132:135], v[36:39]
v_mfma_f32_16x16x32_bf16 v[40:43], a[16:19], a[128:131], v[40:43]
ds_read_b64_tr_b16 a[140:141], v5 offset:16384
v_mfma_f32_16x16x32_bf16 v[40:43], a[20:23], a[132:135], v[40:43]
buffer_load_dwordx4 v17, s[12:15], s27 offen offset:1024 lds
v_mfma_f32_16x16x32_bf16 v[44:47], a[24:27], a[128:131], v[44:47]
ds_read_b64_tr_b16 a[142:143], v5 offset:18432
v_mfma_f32_16x16x32_bf16 v[44:47], a[28:31], a[132:135], v[44:47]
v_mfma_f32_16x16x32_bf16 v[48:51], a[32:35], a[128:131], v[48:51]
ds_read_b128 a[64:67], v2 offset:32768
v_mfma_f32_16x16x32_bf16 v[48:51], a[36:39], a[132:135], v[48:51]
buffer_load_dwordx4 v18, s[12:15], s27 offen offset:2048 lds
v_mfma_f32_16x16x32_bf16 v[52:55], a[40:43], a[128:131], v[52:55]
ds_read_b128 a[68:71], v3 offset:32768
v_mfma_f32_16x16x32_bf16 v[52:55], a[44:47], a[132:135], v[52:55]
v_mfma_f32_16x16x32_bf16 v[56:59], a[48:51], a[128:131], v[56:59]
v_mfma_f32_16x16x32_bf16 v[56:59], a[52:55], a[132:135], v[56:59]
buffer_load_dwordx4 v19, s[12:15], s27 offen offset:3072 lds
v_mfma_f32_16x16x32_bf16 v[60:63], a[56:59], a[128:131], v[60:63]
s_add_u32 s27, s27, 524288
ds_read_b128 a[72:75], v2 offset:34816
v_mfma_f32_16x16x32_bf16 v[60:63], a[60:63], a[132:135], v[60:63]
s_waitcnt lgkmcnt(3)
v_mfma_f32_16x16x32_bf16 v[64:67], a[0:3], a[136:139], v[64:67]
s_add_u32 m0, s28, 0
ds_read_b64_tr_b16 a[128:129], v6 offset:0
v_mfma_f32_16x16x32_bf16 v[64:67], a[4:7], a[140:143], v[64:67]
buffer_load_dwordx4 v12, s[8:11], s24 offen offset:0 lds
v_mfma_f32_16x16x32_bf16 v[68:71], a[8:11], a[136:139], v[68:71]
ds_read_b64_tr_b16 a[130:131], v6 offset:2048
v_mfma_f32_16x16x32_bf16 v[68:71], a[12:15], a[140:143], v[68:71]
v_mfma_f32_16x16x32_bf16 v[72:75], a[16:19], a[136:139], v[72:75]
ds_read_b64_tr_b16 a[132:133], v6 offset:16384
v_mfma_f32_16x16x32_bf16 v[72:75], a[20:23], a[140:143], v[72:75]
buffer_load_dwordx4 v13, s[8:11], s24 offen offset:1024 lds
v_mfma_f32_16x16x32_bf16 v[76:79], a[24:27], a[136:139], v[76:79]
ds_read_b64_tr_b16 a[134:135], v6 offset:18432
v_mfma_f32_16x16x32_bf16 v[76:79], a[28:31], a[140:143], v[76:79]
v_mfma_f32_16x16x32_bf16 v[80:83], a[32:35], a[136:139], v[80:83]
ds_read_b128 a[76:79], v3 offset:34816
v_mfma_f32_16x16x32_bf16 v[80:83], a[36:39], a[140:143], v[80:83]
buffer_load_dwordx4 v14, s[8:11], s24 offen offset:2048 lds
v_mfma_f32_16x16x32_bf16 v[84:87], a[40:43], a[136:139], v[84:87]
v_mfma_f32_16x16x32_bf16 v[84:87], a[44:47], a[140:143], v[84:87]
v_mfma_f32_16x16x32_bf16 v[88:91], a[48:51], a[136:139], v[88:91]
ds_read_b128 a[80:83], v2 offset:36864
v_mfma_f32_16x16x32_bf16 v[88:91], a[52:55], a[140:143], v[88:91]
buffer_load_dwordx4 v15, s[8:11], s24 offen offset:3072 lds
v_mfma_f32_16x16x32_bf16 v[92:95], a[56:59], a[136:139], v[92:95]
s_add_u32 s24, s24, 128
ds_read_b128 a[84:87], v3 offset:36864
v_mfma_f32_16x16x32_bf16 v[92:95], a[60:63], a[140:143], v[92:95]
s_waitcnt lgkmcnt(3)
v_mfma_f32_16x16x32_bf16 v[96:99], a[0:3], a[128:131], v[96:99]
s_add_u32 m0, s28, 4096
ds_read_b64_tr_b16 a[136:137], v7 offset:0
v_mfma_f32_16x16x32_bf16 v[96:99], a[4:7], a[132:135], v[96:99]
buffer_load_dwordx4 v12, s[8:11], s25 offen offset:0 lds
v_mfma_f32_16x16x32_bf16 v[100:103], a[8:11], a[128:131], v[100:103]
ds_read_b64_tr_b16 a[138:139], v7 offset:2048
v_mfma_f32_16x16x32_bf16 v[100:103], a[12:15], a[132:135], v[100:103]
v_mfma_f32_16x16x32_bf16 v[104:107], a[16:19], a[128:131], v[104:107]
ds_read_b64_tr_b16 a[140:141], v7 offset:16384
v_mfma_f32_16x16x32_bf16 v[104:107], a[20:23], a[132:135], v[104:107]
buffer_load_dwordx4 v13, s[8:11], s25 offen offset:1024 lds
v_mfma_f32_16x16x32_bf16 v[108:111], a[24:27], a[128:131], v[108:111]
ds_read_b64_tr_b16 a[142:143], v7 offset:18432
v_mfma_f32_16x16x32_bf16 v[108:111], a[28:31], a[132:135], v[108:111]
v_mfma_f32_16x16x32_bf16 v[112:115], a[32:35], a[128:131], v[112:115]
v_mfma_f32_16x16x32_bf16 v[112:115], a[36:39], a[132:135], v[112:115]
buffer_load_dwordx4 v14, s[8:11], s25 offen offset:2048 lds
v_mfma_f32_16x16x32_bf16 v[116:119], a[40:43], a[128:131], v[116:119]
ds_read_b128 a[88:91], v2 offset:38912
v_mfma_f32_16x16x32_bf16 v[116:119], a[44:47], a[132:135], v[116:119]
v_mfma_f32_16x16x32_bf16 v[120:123], a[48:51], a[128:131], v[120:123]
ds_read_b128 a[92:95], v3 offset:38912
v_mfma_f32_16x16x32_bf16 v[120:123], a[52:55], a[132:135], v[120:123]
buffer_load_dwordx4 v15, s[8:11], s25 offen offset:3072 lds
v_mfma_f32_16x16x32_bf16 v[124:127], a[56:59], a[128:131], v[124:127]
s_add_u32 s25, s25, 128
v_mfma_f32_16x16x32_bf16 v[124:127], a[60:63], a[132:135], v[124:127]
s_waitcnt lgkmcnt(2)
v_mfma_f32_16x16x32_bf16 v[128:131], a[0:3], a[136:139], v[128:131]
ds_read_b64_tr_b16 a[128:129], v8 offset:0
v_mfma_f32_16x16x32_bf16 v[128:131], a[4:7], a[140:143], v[128:131]
buffer_load_dword v21, v20, s[16:19], s43 offen
v_mfma_f32_16x16x32_bf16 v[132:135], a[8:11], a[136:139], v[132:135]
s_add_u32 s43, s43, s47
ds_read_b64_tr_b16 a[130:131], v8 offset:2048
v_mfma_f32_16x16x32_bf16 v[132:135], a[12:15], a[140:143], v[132:135]
s_cmp_ge_u32 s43, s51
v_mfma_f32_16x16x32_bf16 v[136:139], a[16:19], a[136:139], v[136:139]
s_cselect_b32 s43, 0, s43
ds_read_b64_tr_b16 a[132:133], v8 offset:16384
v_mfma_f32_16x16x32_bf16 v[136:139], a[20:23], a[140:143], v[136:139]
s_cselect_b32 s51, s42, s51
v_mfma_f32_16x16x32_bf16 v[140:143], a[24:27], a[136:139], v[140:143]
s_cselect_b64 s[16:17], s[40:41], s[16:17]
ds_read_b64_tr_b16 a[134:135], v8 offset:18432
v_mfma_f32_16x16x32_bf16 v[140:143], a[28:31], a[140:143], v[140:143]
s_cselect_b32 s18, s42, s18
v_mfma_f32_16x16x32_bf16 v[144:147], a[32:35], a[136:139], v[144:147]
s_cselect_b64 s[40:41], s[44:45], s[40:41]
ds_read_b128 a[96:99], v2 offset:40960
v_mfma_f32_16x16x32_bf16 v[144:147], a[36:39], a[140:143], v[144:147]
s_cselect_b32 s42, s46, s42
v_mfma_f32_16x16x32_bf16 v[148:151], a[40:43], a[136:139], v[148:151]
s_cselect_b32 s46, 0, s46
v_mfma_f32_16x16x32_bf16 v[148:151], a[44:47], a[140:143], v[148:151]
s_cmp_eq_u32 s30, s55
v_mfma_f32_16x16x32_bf16 v[152:155], a[48:51], a[136:139], v[152:155]
s_cselect_b32 s22, 0, 3221225472
ds_read_b128 a[100:103], v3 offset:40960
v_mfma_f32_16x16x32_bf16 v[152:155], a[52:55], a[140:143], v[152:155]
s_sub_u32 s30, s30, 1
buffer_atomic_add v27, v26, s[60:63], s22 offen sc1
v_mfma_f32_16x16x32_bf16 v[156:159], a[56:59], a[136:139], v[156:159]
ds_read_b128 a[104:107], v2 offset:43008
v_mfma_f32_16x16x32_bf16 v[156:159], a[60:63], a[140:143], v[156:159]
s_waitcnt lgkmcnt(3)
v_mfma_f32_16x16x32_bf16 v[160:163], a[0:3], a[128:131], v[160:163]
ds_read_b64_tr_b16 a[136:137], v9 offset:0
v_mfma_f32_16x16x32_bf16 v[160:163], a[4:7], a[132:135], v[160:163]
v_mfma_f32_16x16x32_bf16 v[164:167], a[8:11], a[128:131], v[164:167]
ds_read_b64_tr_b16 a[138:139], v9 offset:2048
v_mfma_f32_16x16x32_bf16 v[164:167], a[12:15], a[132:135], v[164:167]
v_mfma_f32_16x16x32_bf16 v[168:171], a[16:19], a[128:131], v[168:171]
ds_read_b64_tr_b16 a[140:141], v9 offset:16384
v_mfma_f32_16x16x32_bf16 v[168:171], a[20:23], a[132:135], v[168:171]
v_mfma_f32_16x16x32_bf16 v[172:175], a[24:27], a[128:131], v[172:175]
ds_read_b64_tr_b16 a[142:143], v9 offset:18432
v_mfma_f32_16x16x32_bf16 v[172:175], a[28:31], a[132:135], v[172:175]
v_mfma_f32_16x16x32_bf16 v[176:179], a[32:35], a[128:131], v[176:179]
v_mfma_f32_16x16x32_bf16 v[176:179], a[36:39], a[132:135], v[176:179]
v_mfma_f32_16x16x32_bf16 v[180:183], a[40:43], a[128:131], v[180:183]
ds_read_b128 a[108:111], v3 offset:43008
v_mfma_f32_16x16x32_bf16 v[180:183], a[44:47], a[132:135], v[180:183]
v_mfma_f32_16x16x32_bf16 v[184:187], a[48:51], a[128:131], v[184:187]
ds_read_b128 a[112:115], v2 offset:45056
v_mfma_f32_16x16x32_bf16 v[184:187], a[52:55], a[132:135], v[184:187]
v_mfma_f32_16x16x32_bf16 v[188:191], a[56:59], a[128:131], v[188:191]
v_mfma_f32_16x16x32_bf16 v[188:191], a[60:63], a[132:135], v[188:191]
s_waitcnt lgkmcnt(2)
v_mfma_f32_16x16x32_bf16 v[192:195], a[0:3], a[136:139], v[192:195]
ds_read_b64_tr_b16 a[128:129], v10 offset:0
v_mfma_f32_16x16x32_bf16 v[192:195], a[4:7], a[140:143], v[192:195]
v_mfma_f32_16x16x32_bf16 v[196:199], a[8:11], a[136:139], v[196:199]
ds_read_b64_tr_b16 a[130:131], v10 offset:2048
v_mfma_f32_16x16x32_bf16 v[196:199], a[12:15], a[140:143], v[196:199]
v_mfma_f32_16x16x32_bf16 v[200:203], a[16:19], a[136:139], v[200:203]
ds_read_b64_tr_b16 a[132:133], v10 offset:16384
v_mfma_f32_16x16x32_bf16 v[200:203], a[20:23], a[140:143], v[200:203]
v_mfma_f32_16x16x32_bf16 v[204:207], a[24:27], a[136:139], v[204:207]
ds_read_b64_tr_b16 a[134:135], v10 offset:18432
v_mfma_f32_16x16x32_bf16 v[204:207], a[28:31], a[140:143], v[204:207]
v_mfma_f32_16x16x32_bf16 v[208:211], a[32:35], a[136:139], v[208:211]
ds_read_b128 a[116:119], v3 offset:45056
v_mfma_f32_16x16x32_bf16 v[208:211], a[36:39], a[140:143], v[208:211]
v_mfma_f32_16x16x32_bf16 v[212:215], a[40:43], a[136:139], v[212:215]
ds_read_b128 a[120:123], v2 offset:47104
v_mfma_f32_16x16x32_bf16 v[212:215], a[44:47], a[140:143], v[212:215]
v_mfma_f32_16x16x32_bf16 v[216:219], a[48:51], a[136:139], v[216:219]
v_mfma_f32_16x16x32_bf16 v[216:219], a[52:55], a[140:143], v[216:219]
v_mfma_f32_16x16x32_bf16 v[220:223], a[56:59], a[136:139], v[220:223]
ds_read_b128 a[124:127], v3 offset:47104
v_mfma_f32_16x16x32_bf16 v[220:223], a[60:63], a[140:143], v[220:223]
s_waitcnt lgkmcnt(3)
v_mfma_f32_16x16x32_bf16 a[192:195], a[0:3], a[128:131], a[192:195]
ds_read_b64_tr_b16 a[136:137], v11 offset:0
v_mfma_f32_16x16x32_bf16 a[192:195], a[4:7], a[132:135], a[192:195]
v_mfma_f32_16x16x32_bf16 a[196:199], a[8:11], a[128:131], a[196:199]
ds_read_b64_tr_b16 a[138:139], v11 offset:2048
v_mfma_f32_16x16x32_bf16 a[196:199], a[12:15], a[132:135], a[196:199]
v_mfma_f32_16x16x32_bf16 a[200:203], a[16:19], a[128:131], a[200:203]
ds_read_b64_tr_b16 a[140:141], v11 offset:16384
v_mfma_f32_16x16x32_bf16 a[200:203], a[20:23], a[132:135], a[200:203]
v_mfma_f32_16x16x32_bf16 a[204:207], a[24:27], a[128:131], a[204:207]
ds_read_b64_tr_b16 a[142:143], v11 offset:18432
v_mfma_f32_16x16x32_bf16 a[204:207], a[28:31], a[132:135], a[204:207]
v_mfma_f32_16x16x32_bf16 a[208:211], a[32:35], a[128:131], a[208:211]
v_mfma_f32_16x16x32_bf16 a[208:211], a[36:39], a[132:135], a[208:211]
v_mfma_f32_16x16x32_bf16 a[212:215], a[40:43], a[128:131], a[212:215]
v_mfma_f32_16x16x32_bf16 a[212:215], a[44:47], a[132:135], a[212:215]
v_mfma_f32_16x16x32_bf16 a[216:219], a[48:51], a[128:131], a[216:219]
v_mfma_f32_16x16x32_bf16 a[216:219], a[52:55], a[132:135], a[216:219]
v_mfma_f32_16x16x32_bf16 a[220:223], a[56:59], a[128:131], a[220:223]
s_waitcnt vmcnt(2) lgkmcnt(0)
v_mfma_f32_16x16x32_bf16 a[220:223], a[60:63], a[132:135], a[220:223]
s_barrier
v_mfma_f32_16x16x32_bf16 a[224:227], a[0:3], a[136:139], a[224:227]
s_add_u32 m0, s29, 65536
ds_read_b64_tr_b16 a[128:129], v4 offset:32768
v_mfma_f32_16x16x32_bf16 a[224:227], a[4:7], a[140:143], a[224:227]
buffer_load_dwordx4 v16, s[12:15], s26 offen offset:0 lds
v_mfma_f32_16x16x32_bf16 a[228:231], a[8:11], a[136:139], a[228:231]
ds_read_b64_tr_b16 a[130:131], v4 offset:34816
v_mfma_f32_16x16x32_bf16 a[228:231], a[12:15], a[140:143], a[228:231]
v_mfma_f32_16x16x32_bf16 a[232:235], a[16:19], a[136:139], a[232:235]
ds_read_b64_tr_b16 a[132:133], v4 offset:49152
v_mfma_f32_16x16x32_bf16 a[232:235], a[20:23], a[140:143], a[232:235]
buffer_load_dwordx4 v17, s[12:15], s26 offen offset:1024 lds
v_mfma_f32_16x16x32_bf16 a[236:239], a[24:27], a[136:139], a[236:239]
ds_read_b64_tr_b16 a[134:135], v4 offset:51200
v_mfma_f32_16x16x32_bf16 a[236:239], a[28:31], a[140:143], a[236:239]
v_mfma_f32_16x16x32_bf16 a[240:243], a[32:35], a[136:139], a[240:243]
v_mfma_f32_16x16x32_bf16 a[240:243], a[36:39], a[140:143], a[240:243]
buffer_load_dwordx4 v18, s[12:15], s26 offen offset:2048 lds
v_mfma_f32_16x16x32_bf16 a[244:247], a[40:43], a[136:139], a[244:247]
v_mfma_f32_16x16x32_bf16 a[244:247], a[44:47], a[140:143], a[244:247]
v_mfma_f32_16x16x32_bf16 a[248:251], a[48:51], a[136:139], a[248:251]
v_mfma_f32_16x16x32_bf16 a[248:251], a[52:55], a[140:143], a[248:251]
s_waitcnt lgkmcnt(0)
buffer_load_dwordx4 v19, s[12:15], s26 offen offset:3072 lds
v_mfma_f32_16x16x32_bf16 a[252:255], a[56:59], a[136:139], a[252:255]
s_add_u32 s26, s26, 524288
s_bitcmp1_b32 s30, 1
v_mfma_f32_16x16x32_bf16 a[252:255], a[60:63], a[140:143], a[252:255]
s_cbranch_scc1 Lg_501
s_cmp_eq_u32 s30, 0
s_cbranch_scc1 Lg_501t
v_mfma_f32_16x16x32_bf16 v[32:35], a[64:67], a[128:131], v[32:35]
s_add_u32 m0, s29, 81920
ds_read_b64_tr_b16 a[136:137], v5 offset:32768
v_mfma_f32_16x16x32_bf16 v[32:35], a[68:71], a[132:135], v[32:35]
buffer_load_dwordx4 v16, s[12:15], s27 offen offset:0 lds
v_mfma_f32_16x16x32_bf16 v[36:39], a[72:75], a[128:131], v[36:39]
s_lshl_b32 s22, s38, 3
ds_read_b64_tr_b16 a[138:139], v5 offset:34816
v_mfma_f32_16x16x32_bf16 v[36:39], a[76:79], a[132:135], v[36:39]
s_lshl_b32 s23, s39, 5
v_and_b32 v252, 31, v0
v_lshrrev_b32 v253, 5, v0
v_mfma_f32_16x16x32_bf16 v[40:43], a[80:83], a[128:131], v[40:43]
ds_read_b64_tr_b16 a[140:141], v5 offset:49152
v_add_u32 v253, s22, v253
v_mfma_f32_16x16x32_bf16 v[40:43], a[84:87], a[132:135], v[40:43]
buffer_load_dwordx4 v17, s[12:15], s27 offen offset:1024 lds
v_mfma_f32_16x16x32_bf16 v[44:47], a[88:91], a[128:131], v[44:47]
ds_read_b64_tr_b16 a[142:143], v5 offset:51200
v_add_u32 v252, s23, v252
v_mfma_f32_16x16x32_bf16 v[44:47], a[92:95], a[132:135], v[44:47]
v_mul_u32_u24 v254, 7168, v253
v_lshl_add_u32 v254, v252, 2, v254
v_mfma_f32_16x16x32_bf16 v[48:51], a[96:99], a[128:131], v[48:51]
ds_read_b128 a[0:3], v2 offset:0
v_lshlrev_b32 v252, 4, v252
v_mfma_f32_16x16x32_bf16 v[48:51], a[100:103], a[132:135], v[48:51]
buffer_load_dwordx4 v18, s[12:15], s27 offen offset:2048 lds
v_mfma_f32_16x16x32_bf16 v[52:55], a[104:107], a[128:131], v[52:55]
ds_read_b128 a[4:7], v3 offset:0
v_add_u32 v255, 3584, v254
v_mfma_f32_16x16x32_bf16 v[52:55], a[108:111], a[132:135], v[52:55]
v_subrev_u32 v22, 3584, v254
v_subrev_u32 v23, 2688, v254
v_mfma_f32_16x16x32_bf16 v[56:59], a[112:115], a[128:131], v[56:59]
v_subrev_u32 v24, 1792, v254
v_subrev_u32 v25, 896, v254
v_mfma_f32_16x16x32_bf16 v[56:59], a[116:119], a[132:135], v[56:59]
buffer_load_dwordx4 v19, s[12:15], s27 offen offset:3072 lds
v_mfma_f32_16x16x32_bf16 v[60:63], a[120:123], a[128:131], v[60:63]
s_add_u32 s27, s27, 524288
ds_read_b128 a[8:11], v2 offset:2048
v_mfma_f32_16x16x32_bf16 v[60:63], a[124:127], a[132:135], v[60:63]
s_waitcnt lgkmcnt(3)
v_mfma_f32_16x16x32_bf16 v[64:67], a[64:67], a[136:139], v[64:67]
s_add_u32 m0, s28, 32768
ds_read_b64_tr_b16 a[128:129], v6 offset:32768
v_mfma_f32_16x16x32_bf16 v[64:67], a[68:71], a[140:143], v[64:67]
buffer_load_dwordx4 v12, s[8:11], s24 offen offset:0 lds
v_mfma_f32_16x16x32_bf16 v[68:71], a[72:75], a[136:139], v[68:71]
ds_read_b64_tr_b16 a[130:131], v6 offset:34816
v_mfma_f32_16x16x32_bf16 v[68:71], a[76:79], a[140:143], v[68:71]
PAD_23:
s_cbranch_execz PAD_27
v_mfma_f32_16x16x32_bf16 v[72:75], a[80:83], a[136:139], v[72:75]
ds_read_b64_tr_b16 a[132:133], v6 offset:49152
v_mfma_f32_16x16x32_bf16 v[72:75], a[84:87], a[140:143], v[72:75]
buffer_load_dwordx4 v13, s[8:11], s24 offen offset:1024 lds
v_mfma_f32_16x16x32_bf16 v[76:79], a[88:91], a[136:139], v[76:79]
ds_read_b64_tr_b16 a[134:135], v6 offset:51200
v_mfma_f32_16x16x32_bf16 v[76:79], a[92:95], a[140:143], v[76:79]
v_mfma_f32_16x16x32_bf16 v[80:83], a[96:99], a[136:139], v[80:83]
ds_read_b128 a[12:15], v3 offset:2048
v_mfma_f32_16x16x32_bf16 v[80:83], a[100:103], a[140:143], v[80:83]
buffer_load_dwordx4 v14, s[8:11], s24 offen offset:2048 lds
v_mfma_f32_16x16x32_bf16 v[84:87], a[104:107], a[136:139], v[84:87]
v_mfma_f32_16x16x32_bf16 v[84:87], a[108:111], a[140:143], v[84:87]
v_mfma_f32_16x16x32_bf16 v[88:91], a[112:115], a[136:139], v[88:91]
ds_read_b128 a[16:19], v2 offset:4096
v_mfma_f32_16x16x32_bf16 v[88:91], a[116:119], a[140:143], v[88:91]
buffer_load_dwordx4 v15, s[8:11], s24 offen offset:3072 lds
v_mfma_f32_16x16x32_bf16 v[92:95], a[120:123], a[136:139], v[92:95]
s_add_u32 s24, s24, 128
ds_read_b128 a[20:23], v3 offset:4096
v_mfma_f32_16x16x32_bf16 v[92:95], a[124:127], a[140:143], v[92:95]
s_waitcnt lgkmcnt(3)
v_mfma_f32_16x16x32_bf16 v[96:99], a[64:67], a[128:131], v[96:99]
s_add_u32 m0, s28, 36864
ds_read_b64_tr_b16 a[136:137], v7 offset:32768
v_mfma_f32_16x16x32_bf16 v[96:99], a[68:71], a[132:135], v[96:99]
buffer_load_dwordx4 v12, s[8:11], s25 offen offset:0 lds
v_mfma_f32_16x16x32_bf16 v[100:103], a[72:75], a[128:131], v[100:103]
ds_read_b64_tr_b16 a[138:139], v7 offset:34816
v_mfma_f32_16x16x32_bf16 v[100:103], a[76:79], a[132:135], v[100:103]
v_mfma_f32_16x16x32_bf16 v[104:107], a[80:83], a[128:131], v[104:107]
ds_read_b64_tr_b16 a[140:141], v7 offset:49152
v_mfma_f32_16x16x32_bf16 v[104:107], a[84:87], a[132:135], v[104:107]
buffer_load_dwordx4 v13, s[8:11], s25 offen offset:1024 lds
v_mfma_f32_16x16x32_bf16 v[108:111], a[88:91], a[128:131], v[108:111]
ds_read_b64_tr_b16 a[142:143], v7 offset:51200
v_mfma_f32_16x16x32_bf16 v[108:111], a[92:95], a[132:135], v[108:111]
v_mfma_f32_16x16x32_bf16 v[112:115], a[96:99], a[128:131], v[112:115]
v_mfma_f32_16x16x32_bf16 v[112:115], a[100:103], a[132:135], v[112:115]
buffer_load_dwordx4 v14, s[8:11], s25 offen offset:2048 lds
v_mfma_f32_16x16x32_bf16 v[116:119], a[104:107], a[128:131], v[116:119]
ds_read_b128 a[24:27], v2 offset:6144
v_mfma_f32_16x16x32_bf16 v[116:119], a[108:111], a[132:135], v[116:119]
v_mfma_f32_16x16x32_bf16 v[120:123], a[112:115], a[128:131], v[120:123]
ds_read_b128 a[28:31], v3 offset:6144
v_mfma_f32_16x16x32_bf16 v[120:123], a[116:119], a[132:135], v[120:123]
buffer_load_dwordx4 v15, s[8:11], s25 offen offset:3072 lds
v_mfma_f32_16x16x32_bf16 v[124:127], a[120:123], a[128:131], v[124:127]
s_add_u32 s25, s25, 128
v_mfma_f32_16x16x32_bf16 v[124:127], a[124:127], a[132:135], v[124:127]
s_waitcnt lgkmcnt(2)
v_mfma_f32_16x16x32_bf16 v[128:131], a[64:67], a[136:139], v[128:131]
s_mov_b64 s[56:57], s[70:71]
s_mov_b32 s58, 3584
s_mov_b32 s59, 0x20000
ds_read_b64_tr_b16 a[128:129], v8 offset:32768
buffer_load_dwordx4 v[248:251], v252, s[56:59], 0 offen
v_mfma_f32_16x16x32_bf16 v[128:131], a[68:71], a[140:143], v[128:131]
s_mov_b64 s[56:57], s[66:67]
s_mov_b32 s58, 1835008
buffer_load_dword v224, v22, s[56:59], 0 offen nt
v_mfma_f32_16x16x32_bf16 v[132:135], a[72:75], a[136:139], v[132:135]
ds_read_b64_tr_b16 a[130:131], v8 offset:34816
buffer_load_dword v225, v23, s[56:59], 0 offen nt
v_mfma_f32_16x16x32_bf16 v[132:135], a[76:79], a[140:143], v[132:135]
buffer_load_dword v226, v24, s[56:59], 0 offen nt
v_mfma_f32_16x16x32_bf16 v[136:139], a[80:83], a[136:139], v[136:139]
ds_read_b64_tr_b16 a[132:133], v8 offset:49152
buffer_load_dword v227, v25, s[56:59], 0 offen nt
v_mfma_f32_16x16x32_bf16 v[136:139], a[84:87], a[140:143], v[136:139]
buffer_load_dword v228, v254, s[56:59], 0 offen offset:0 nt
v_mfma_f32_16x16x32_bf16 v[140:143], a[88:91], a[136:139], v[140:143]
ds_read_b64_tr_b16 a[134:135], v8 offset:51200
buffer_load_dword v229, v254, s[56:59], 0 offen offset:896 nt
v_mfma_f32_16x16x32_bf16 v[140:143], a[92:95], a[140:143], v[140:143]
buffer_load_dword v230, v254, s[56:59], 0 offen offset:1792 nt
v_mfma_f32_16x16x32_bf16 v[144:147], a[96:99], a[136:139], v[144:147]
ds_read_b128 a[32:35], v2 offset:8192
buffer_load_dword v231, v254, s[56:59], 0 offen offset:2688 nt
v_mfma_f32_16x16x32_bf16 v[144:147], a[100:103], a[140:143], v[144:147]
buffer_load_dword v232, v255, s[56:59], 0 offen offset:0 nt
v_mfma_f32_16x16x32_bf16 v[148:151], a[104:107], a[136:139], v[148:151]
buffer_load_dword v233, v255, s[56:59], 0 offen offset:896 nt
v_mfma_f32_16x16x32_bf16 v[148:151], a[108:111], a[140:143], v[148:151]
buffer_load_dword v234, v255, s[56:59], 0 offen offset:1792 nt
v_mfma_f32_16x16x32_bf16 v[152:155], a[112:115], a[136:139], v[152:155]
ds_read_b128 a[36:39], v3 offset:8192
buffer_load_dword v235, v255, s[56:59], 0 offen offset:2688 nt
v_mfma_f32_16x16x32_bf16 v[152:155], a[116:119], a[140:143], v[152:155]
s_mov_b64 s[56:57], s[68:69]
buffer_load_dword v236, v25, s[56:59], 0 offen nt
v_mfma_f32_16x16x32_bf16 v[156:159], a[120:123], a[136:139], v[156:159]
ds_read_b128 a[40:43], v2 offset:10240
buffer_load_dword v237, v254, s[56:59], 0 offen offset:0 nt
v_mfma_f32_16x16x32_bf16 v[156:159], a[124:127], a[140:143], v[156:159]
s_waitcnt lgkmcnt(3)
buffer_load_dword v238, v254, s[56:59], 0 offen offset:896 nt
v_mfma_f32_16x16x32_bf16 v[160:163], a[64:67], a[128:131], v[160:163]
ds_read_b64_tr_b16 a[136:137], v9 offset:32768
buffer_load_dword v239, v254, s[56:59], 0 offen offset:1792 nt
v_mfma_f32_16x16x32_bf16 v[160:163], a[68:71], a[132:135], v[160:163]
buffer_load_dword v240, v254, s[56:59], 0 offen offset:2688 nt
v_mfma_f32_16x16x32_bf16 v[164:167], a[72:75], a[128:131], v[164:167]
ds_read_b64_tr_b16 a[138:139], v9 offset:34816
buffer_load_dword v241, v255, s[56:59], 0 offen offset:0 nt
v_mfma_f32_16x16x32_bf16 v[164:167], a[76:79], a[132:135], v[164:167]
buffer_load_dword v242, v255, s[56:59], 0 offen offset:896 nt
v_mfma_f32_16x16x32_bf16 v[168:171], a[80:83], a[128:131], v[168:171]
ds_read_b64_tr_b16 a[140:141], v9 offset:49152
buffer_load_dword v243, v255, s[56:59], 0 offen offset:1792 nt
v_mfma_f32_16x16x32_bf16 v[168:171], a[84:87], a[132:135], v[168:171]
buffer_load_dword v244, v255, s[56:59], 0 offen offset:2688 nt
v_mfma_f32_16x16x32_bf16 v[172:175], a[88:91], a[128:131], v[172:175]
ds_read_b64_tr_b16 a[142:143], v9 offset:51200
v_mfma_f32_16x16x32_bf16 v[172:175], a[92:95], a[132:135], v[172:175]
v_mfma_f32_16x16x32_bf16 v[176:179], a[96:99], a[128:131], v[176:179]
v_mfma_f32_16x16x32_bf16 v[176:179], a[100:103], a[132:135], v[176:179]
v_mfma_f32_16x16x32_bf16 v[180:183], a[104:107], a[128:131], v[180:183]
ds_read_b128 a[44:47], v3 offset:10240
v_mfma_f32_16x16x32_bf16 v[180:183], a[108:111], a[132:135], v[180:183]
v_mfma_f32_16x16x32_bf16 v[184:187], a[112:115], a[128:131], v[184:187]
ds_read_b128 a[48:51], v2 offset:12288
v_mfma_f32_16x16x32_bf16 v[184:187], a[116:119], a[132:135], v[184:187]
v_mfma_f32_16x16x32_bf16 v[188:191], a[120:123], a[128:131], v[188:191]
v_mfma_f32_16x16x32_bf16 v[188:191], a[124:127], a[132:135], v[188:191]
s_waitcnt lgkmcnt(2)
v_mfma_f32_16x16x32_bf16 v[192:195], a[64:67], a[136:139], v[192:195]
ds_read_b64_tr_b16 a[128:129], v10 offset:32768
v_mfma_f32_16x16x32_bf16 v[192:195], a[68:71], a[140:143], v[192:195]
v_mfma_f32_16x16x32_bf16 v[196:199], a[72:75], a[136:139], v[196:199]
ds_read_b64_tr_b16 a[130:131], v10 offset:34816
v_mfma_f32_16x16x32_bf16 v[196:199], a[76:79], a[140:143], v[196:199]
v_mfma_f32_16x16x32_bf16 v[200:203], a[80:83], a[136:139], v[200:203]
ds_read_b64_tr_b16 a[132:133], v10 offset:49152
v_mfma_f32_16x16x32_bf16 v[200:203], a[84:87], a[140:143], v[200:203]
v_mfma_f32_16x16x32_bf16 v[204:207], a[88:91], a[136:139], v[204:207]
ds_read_b64_tr_b16 a[134:135], v10 offset:51200
v_mfma_f32_16x16x32_bf16 v[204:207], a[92:95], a[140:143], v[204:207]
v_mfma_f32_16x16x32_bf16 v[208:211], a[96:99], a[136:139], v[208:211]
ds_read_b128 a[52:55], v3 offset:12288
v_mfma_f32_16x16x32_bf16 v[208:211], a[100:103], a[140:143], v[208:211]
v_mfma_f32_16x16x32_bf16 v[212:215], a[104:107], a[136:139], v[212:215]
ds_read_b128 a[56:59], v2 offset:14336
v_mfma_f32_16x16x32_bf16 v[212:215], a[108:111], a[140:143], v[212:215]
v_mfma_f32_16x16x32_bf16 v[216:219], a[112:115], a[136:139], v[216:219]
v_mfma_f32_16x16x32_bf16 v[216:219], a[116:119], a[140:143], v[216:219]
v_mfma_f32_16x16x32_bf16 v[220:223], a[120:123], a[136:139], v[220:223]
ds_read_b128 a[60:63], v3 offset:14336
v_mfma_f32_16x16x32_bf16 v[220:223], a[124:127], a[140:143], v[220:223]
s_waitcnt lgkmcnt(3)
v_mfma_f32_16x16x32_bf16 a[192:195], a[64:67], a[128:131], a[192:195]
ds_read_b64_tr_b16 a[136:137], v11 offset:32768
v_mfma_f32_16x16x32_bf16 a[192:195], a[68:71], a[132:135], a[192:195]
v_mfma_f32_16x16x32_bf16 a[196:199], a[72:75], a[128:131], a[196:199]
ds_read_b64_tr_b16 a[138:139], v11 offset:34816
v_mfma_f32_16x16x32_bf16 a[196:199], a[76:79], a[132:135], a[196:199]
v_mfma_f32_16x16x32_bf16 a[200:203], a[80:83], a[128:131], a[200:203]
ds_read_b64_tr_b16 a[140:141], v11 offset:49152
v_mfma_f32_16x16x32_bf16 a[200:203], a[84:87], a[132:135], a[200:203]
v_mfma_f32_16x16x32_bf16 a[204:207], a[88:91], a[128:131], a[204:207]
ds_read_b64_tr_b16 a[142:143], v11 offset:51200
v_mfma_f32_16x16x32_bf16 a[204:207], a[92:95], a[132:135], a[204:207]
v_mfma_f32_16x16x32_bf16 a[208:211], a[96:99], a[128:131], a[208:211]
v_mfma_f32_16x16x32_bf16 a[208:211], a[100:103], a[132:135], a[208:211]
v_mfma_f32_16x16x32_bf16 a[212:215], a[104:107], a[128:131], a[212:215]
v_mfma_f32_16x16x32_bf16 a[212:215], a[108:111], a[132:135], a[212:215]
v_mfma_f32_16x16x32_bf16 a[216:219], a[112:115], a[128:131], a[216:219]
v_mfma_f32_16x16x32_bf16 a[216:219], a[116:119], a[132:135], a[216:219]
v_mfma_f32_16x16x32_bf16 a[220:223], a[120:123], a[128:131], a[220:223]
s_waitcnt vmcnt(22) lgkmcnt(0)
v_mfma_f32_16x16x32_bf16 a[220:223], a[124:127], a[132:135], a[220:223]
s_barrier
v_mfma_f32_16x16x32_bf16 a[224:227], a[64:67], a[136:139], a[224:227]
s_add_u32 m0, s29, 98304
ds_read_b64_tr_b16 a[128:129], v4 offset:0
v_mfma_f32_16x16x32_bf16 a[224:227], a[68:71], a[140:143], a[224:227]
buffer_load_dwordx4 v16, s[12:15], s26 offen offset:0 lds
v_mfma_f32_16x16x32_bf16 a[228:231], a[72:75], a[136:139], a[228:231]
ds_read_b64_tr_b16 a[130:131], v4 offset:2048
v_mfma_f32_16x16x32_bf16 a[228:231], a[76:79], a[140:143], a[228:231]
v_mfma_f32_16x16x32_bf16 a[232:235], a[80:83], a[136:139], a[232:235]
ds_read_b64_tr_b16 a[132:133], v4 offset:16384
v_mfma_f32_16x16x32_bf16 a[232:235], a[84:87], a[140:143], a[232:235]
buffer_load_dwordx4 v17, s[12:15], s26 offen offset:1024 lds
v_mfma_f32_16x16x32_bf16 a[236:239], a[88:91], a[136:139], a[236:239]
ds_read_b64_tr_b16 a[134:135], v4 offset:18432
v_mfma_f32_16x16x32_bf16 a[236:239], a[92:95], a[140:143], a[236:239]
v_mfma_f32_16x16x32_bf16 a[240:243], a[96:99], a[136:139], a[240:243]
v_mfma_f32_16x16x32_bf16 a[240:243], a[100:103], a[140:143], a[240:243]
buffer_load_dwordx4 v18, s[12:15], s26 offen offset:2048 lds
v_mfma_f32_16x16x32_bf16 a[244:247], a[104:107], a[136:139], a[244:247]
v_mfma_f32_16x16x32_bf16 a[244:247], a[108:111], a[140:143], a[244:247]
v_mfma_f32_16x16x32_bf16 a[248:251], a[112:115], a[136:139], a[248:251]
v_mfma_f32_16x16x32_bf16 a[248:251], a[116:119], a[140:143], a[248:251]
buffer_load_dwordx4 v19, s[12:15], s26 offen offset:3072 lds
v_mfma_f32_16x16x32_bf16 a[252:255], a[120:123], a[136:139], a[252:255]
s_add_u32 s26, s26, 524288
v_mfma_f32_16x16x32_bf16 a[252:255], a[124:127], a[140:143], a[252:255]
s_waitcnt lgkmcnt(0)
v_mfma_f32_16x16x32_bf16 v[32:35], a[0:3], a[128:131], v[32:35]
s_add_u32 m0, s29, 114688
ds_read_b64_tr_b16 a[136:137], v5 offset:0
v_mfma_f32_16x16x32_bf16 v[32:35], a[4:7], a[132:135], v[32:35]
buffer_load_dwordx4 v16, s[12:15], s27 offen offset:0 lds
v_mfma_f32_16x16x32_bf16 v[36:39], a[8:11], a[128:131], v[36:39]
ds_read_b64_tr_b16 a[138:139], v5 offset:2048
v_mfma_f32_16x16x32_bf16 v[36:39], a[12:15], a[132:135], v[36:39]
v_mfma_f32_16x16x32_bf16 v[40:43], a[16:19], a[128:131], v[40:43]
ds_read_b64_tr_b16 a[140:141], v5 offset:16384
v_mfma_f32_16x16x32_bf16 v[40:43], a[20:23], a[132:135], v[40:43]
buffer_load_dwordx4 v17, s[12:15], s27 offen offset:1024 lds
v_mfma_f32_16x16x32_bf16 v[44:47], a[24:27], a[128:131], v[44:47]
ds_read_b64_tr_b16 a[142:143], v5 offset:18432
v_mfma_f32_16x16x32_bf16 v[44:47], a[28:31], a[132:135], v[44:47]
v_mfma_f32_16x16x32_bf16 v[48:51], a[32:35], a[128:131], v[48:51]
ds_read_b128 a[64:67], v2 offset:32768
v_mfma_f32_16x16x32_bf16 v[48:51], a[36:39], a[132:135], v[48:51]
buffer_load_dwordx4 v18, s[12:15], s27 offen offset:2048 lds
v_mfma_f32_16x16x32_bf16 v[52:55], a[40:43], a[128:131], v[52:55]
ds_read_b128 a[68:71], v3 offset:32768
v_mfma_f32_16x16x32_bf16 v[52:55], a[44:47], a[132:135], v[52:55]
v_mfma_f32_16x16x32_bf16 v[56:59], a[48:51], a[128:131], v[56:59]
v_mfma_f32_16x16x32_bf16 v[56:59], a[52:55], a[132:135], v[56:59]
buffer_load_dwordx4 v19, s[12:15], s27 offen offset:3072 lds
v_mfma_f32_16x16x32_bf16 v[60:63], a[56:59], a[128:131], v[60:63]
s_add_u32 s27, s27, 524288
ds_read_b128 a[72:75], v2 offset:34816
v_mfma_f32_16x16x32_bf16 v[60:63], a[60:63], a[132:135], v[60:63]
s_waitcnt lgkmcnt(3)
v_mfma_f32_16x16x32_bf16 v[64:67], a[0:3], a[136:139], v[64:67]
s_add_u32 m0, s28, 0
ds_read_b64_tr_b16 a[128:129], v6 offset:0
v_mfma_f32_16x16x32_bf16 v[64:67], a[4:7], a[140:143], v[64:67]
buffer_load_dwordx4 v12, s[8:11], s24 offen offset:0 lds
v_mfma_f32_16x16x32_bf16 v[68:71], a[8:11], a[136:139], v[68:71]
ds_read_b64_tr_b16 a[130:131], v6 offset:2048
v_mfma_f32_16x16x32_bf16 v[68:71], a[12:15], a[140:143], v[68:71]
v_mfma_f32_16x16x32_bf16 v[72:75], a[16:19], a[136:139], v[72:75]
ds_read_b64_tr_b16 a[132:133], v6 offset:16384
v_mfma_f32_16x16x32_bf16 v[72:75], a[20:23], a[140:143], v[72:75]
buffer_load_dwordx4 v13, s[8:11], s24 offen offset:1024 lds
v_mfma_f32_16x16x32_bf16 v[76:79], a[24:27], a[136:139], v[76:79]
ds_read_b64_tr_b16 a[134:135], v6 offset:18432
v_mfma_f32_16x16x32_bf16 v[76:79], a[28:31], a[140:143], v[76:79]
v_mfma_f32_16x16x32_bf16 v[80:83], a[32:35], a[136:139], v[80:83]
ds_read_b128 a[76:79], v3 offset:34816
v_mfma_f32_16x16x32_bf16 v[80:83], a[36:39], a[140:143], v[80:83]
buffer_load_dwordx4 v14, s[8:11], s24 offen offset:2048 lds
v_mfma_f32_16x16x32_bf16 v[84:87], a[40:43], a[136:139], v[84:87]
v_mfma_f32_16x16x32_bf16 v[84:87], a[44:47], a[140:143], v[84:87]
v_mfma_f32_16x16x32_bf16 v[88:91], a[48:51], a[136:139], v[88:91]
ds_read_b128 a[80:83], v2 offset:36864
v_mfma_f32_16x16x32_bf16 v[88:91], a[52:55], a[140:143], v[88:91]
buffer_load_dwordx4 v15, s[8:11], s24 offen offset:3072 lds
v_mfma_f32_16x16x32_bf16 v[92:95], a[56:59], a[136:139], v[92:95]
s_add_u32 s24, s24, 128
ds_read_b128 a[84:87], v3 offset:36864
v_mfma_f32_16x16x32_bf16 v[92:95], a[60:63], a[140:143], v[92:95]
s_waitcnt lgkmcnt(3)
v_mfma_f32_16x16x32_bf16 v[96:99], a[0:3], a[128:131], v[96:99]
s_add_u32 m0, s28, 4096
ds_read_b64_tr_b16 a[136:137], v7 offset:0
v_mfma_f32_16x16x32_bf16 v[96:99], a[4:7], a[132:135], v[96:99]
buffer_load_dwordx4 v12, s[8:11], s25 offen offset:0 lds
v_mfma_f32_16x16x32_bf16 v[100:103], a[8:11], a[128:131], v[100:103]
ds_read_b64_tr_b16 a[138:139], v7 offset:2048
v_mfma_f32_16x16x32_bf16 v[100:103], a[12:15], a[132:135], v[100:103]
v_mfma_f32_16x16x32_bf16 v[104:107], a[16:19], a[128:131], v[104:107]
ds_read_b64_tr_b16 a[140:141], v7 offset:16384
v_mfma_f32_16x16x32_bf16 v[104:107], a[20:23], a[132:135], v[104:107]
buffer_load_dwordx4 v13, s[8:11], s25 offen offset:1024 lds
v_mfma_f32_16x16x32_bf16 v[108:111], a[24:27], a[128:131], v[108:111]
ds_read_b64_tr_b16 a[142:143], v7 offset:18432
v_mfma_f32_16x16x32_bf16 v[108:111], a[28:31], a[132:135], v[108:111]
v_mfma_f32_16x16x32_bf16 v[112:115], a[32:35], a[128:131], v[112:115]
v_mfma_f32_16x16x32_bf16 v[112:115], a[36:39], a[132:135], v[112:115]
buffer_load_dwordx4 v14, s[8:11], s25 offen offset:2048 lds
v_mfma_f32_16x16x32_bf16 v[116:119], a[40:43], a[128:131], v[116:119]
ds_read_b128 a[88:91], v2 offset:38912
v_mfma_f32_16x16x32_bf16 v[116:119], a[44:47], a[132:135], v[116:119]
v_mfma_f32_16x16x32_bf16 v[120:123], a[48:51], a[128:131], v[120:123]
ds_read_b128 a[92:95], v3 offset:38912
v_mfma_f32_16x16x32_bf16 v[120:123], a[52:55], a[132:135], v[120:123]
buffer_load_dwordx4 v15, s[8:11], s25 offen offset:3072 lds
v_mfma_f32_16x16x32_bf16 v[124:127], a[56:59], a[128:131], v[124:127]
s_add_u32 s25, s25, 128
v_mfma_f32_16x16x32_bf16 v[124:127], a[60:63], a[132:135], v[124:127]
s_waitcnt lgkmcnt(2)
v_mfma_f32_16x16x32_bf16 v[128:131], a[0:3], a[136:139], v[128:131]
ds_read_b64_tr_b16 a[128:129], v8 offset:0
v_mfma_f32_16x16x32_bf16 v[128:131], a[4:7], a[140:143], v[128:131]
buffer_load_dword v21, v20, s[16:19], s43 offen
v_mfma_f32_16x16x32_bf16 v[132:135], a[8:11], a[136:139], v[132:135]
s_add_u32 s43, s43, s47
ds_read_b64_tr_b16 a[130:131], v8 offset:2048
v_mfma_f32_16x16x32_bf16 v[132:135], a[12:15], a[140:143], v[132:135]
s_cmp_ge_u32 s43, s51
v_mfma_f32_16x16x32_bf16 v[136:139], a[16:19], a[136:139], v[136:139]
s_cselect_b32 s43, 0, s43
ds_read_b64_tr_b16 a[132:133], v8 offset:16384
v_mfma_f32_16x16x32_bf16 v[136:139], a[20:23], a[140:143], v[136:139]
s_cselect_b32 s51, s42, s51
v_mfma_f32_16x16x32_bf16 v[140:143], a[24:27], a[136:139], v[140:143]
s_cselect_b64 s[16:17], s[40:41], s[16:17]
ds_read_b64_tr_b16 a[134:135], v8 offset:18432
v_mfma_f32_16x16x32_bf16 v[140:143], a[28:31], a[140:143], v[140:143]
s_cselect_b32 s18, s42, s18
v_mfma_f32_16x16x32_bf16 v[144:147], a[32:35], a[136:139], v[144:147]
s_cselect_b64 s[40:41], s[44:45], s[40:41]
ds_read_b128 a[96:99], v2 offset:40960
v_mfma_f32_16x16x32_bf16 v[144:147], a[36:39], a[140:143], v[144:147]
s_cselect_b32 s42, s46, s42
v_mfma_f32_16x16x32_bf16 v[148:151], a[40:43], a[136:139], v[148:151]
s_cselect_b32 s46, 0, s46
v_mfma_f32_16x16x32_bf16 v[148:151], a[44:47], a[140:143], v[148:151]
s_lshl_b32 s59, s39, 5
v_mfma_f32_16x16x32_bf16 v[152:155], a[48:51], a[136:139], v[152:155]
s_add_u32 s59, s59, s38
ds_read_b128 a[100:103], v3 offset:40960
v_mfma_f32_16x16x32_bf16 v[152:155], a[52:55], a[140:143], v[152:155]
s_lshl_b32 s59, s59, 2
v_mfma_f32_16x16x32_bf16 v[156:159], a[56:59], a[136:139], v[156:159]
s_add_u32 s59, s59, 94392320
ds_read_b128 a[104:107], v2 offset:43008
v_mfma_f32_16x16x32_bf16 v[156:159], a[60:63], a[140:143], v[156:159]
s_waitcnt lgkmcnt(3)
s_cmp_lt_u32 s2, 224
v_mfma_f32_16x16x32_bf16 v[160:163], a[0:3], a[128:131], v[160:163]
s_cselect_b32 s59, s59, 3221225472
ds_read_b64_tr_b16 a[136:137], v9 offset:0
v_mfma_f32_16x16x32_bf16 v[160:163], a[4:7], a[132:135], v[160:163]
s_mov_b32 s58, 0xffff0000
v_mfma_f32_16x16x32_bf16 v[164:167], a[8:11], a[128:131], v[164:167]
ds_read_b64_tr_b16 a[138:139], v9 offset:2048
v_mfma_f32_16x16x32_bf16 v[164:167], a[12:15], a[132:135], v[164:167]
buffer_load_dword v21, v20, s[16:19], s43 offen
v_mfma_f32_16x16x32_bf16 v[168:171], a[16:19], a[128:131], v[168:171]
s_add_u32 s43, s43, s47
ds_read_b64_tr_b16 a[140:141], v9 offset:16384
v_mfma_f32_16x16x32_bf16 v[168:171], a[20:23], a[132:135], v[168:171]
s_cmp_ge_u32 s43, s51
v_mfma_f32_16x16x32_bf16 v[172:175], a[24:27], a[128:131], v[172:175]
s_cselect_b32 s43, 0, s43
ds_read_b64_tr_b16 a[142:143], v9 offset:18432
v_mfma_f32_16x16x32_bf16 v[172:175], a[28:31], a[132:135], v[172:175]
s_cselect_b32 s51, s42, s51
v_mfma_f32_16x16x32_bf16 v[176:179], a[32:35], a[128:131], v[176:179]
s_cselect_b64 s[16:17], s[40:41], s[16:17]
v_mfma_f32_16x16x32_bf16 v[176:179], a[36:39], a[132:135], v[176:179]
s_cselect_b32 s18, s42, s18
v_mfma_f32_16x16x32_bf16 v[180:183], a[40:43], a[128:131], v[180:183]
s_cselect_b64 s[40:41], s[44:45], s[40:41]
ds_read_b128 a[108:111], v3 offset:43008
v_mfma_f32_16x16x32_bf16 v[180:183], a[44:47], a[132:135], v[180:183]
s_cselect_b32 s42, s46, s42
v_mfma_f32_16x16x32_bf16 v[184:187], a[48:51], a[128:131], v[184:187]
s_cselect_b32 s46, 0, s46
ds_read_b128 a[112:115], v2 offset:45056
v_mfma_f32_16x16x32_bf16 v[184:187], a[52:55], a[132:135], v[184:187]
v_mfma_f32_16x16x32_bf16 v[188:191], a[56:59], a[128:131], v[188:191]
v_mfma_f32_16x16x32_bf16 v[188:191], a[60:63], a[132:135], v[188:191]
s_waitcnt lgkmcnt(2)
v_mfma_f32_16x16x32_bf16 v[192:195], a[0:3], a[136:139], v[192:195]
ds_read_b64_tr_b16 a[128:129], v10 offset:0
v_mfma_f32_16x16x32_bf16 v[192:195], a[4:7], a[140:143], v[192:195]
v_mfma_f32_16x16x32_bf16 v[196:199], a[8:11], a[136:139], v[196:199]
ds_read_b64_tr_b16 a[130:131], v10 offset:2048
v_mfma_f32_16x16x32_bf16 v[196:199], a[12:15], a[140:143], v[196:199]
v_mfma_f32_16x16x32_bf16 v[200:203], a[16:19], a[136:139], v[200:203]
ds_read_b64_tr_b16 a[132:133], v10 offset:16384
v_mfma_f32_16x16x32_bf16 v[200:203], a[20:23], a[140:143], v[200:203]
v_mfma_f32_16x16x32_bf16 v[204:207], a[24:27], a[136:139], v[204:207]
ds_read_b64_tr_b16 a[134:135], v10 offset:18432
v_mfma_f32_16x16x32_bf16 v[204:207], a[28:31], a[140:143], v[204:207]
v_mfma_f32_16x16x32_bf16 v[208:211], a[32:35], a[136:139], v[208:211]
ds_read_b128 a[116:119], v3 offset:45056
v_mfma_f32_16x16x32_bf16 v[208:211], a[36:39], a[140:143], v[208:211]
v_mfma_f32_16x16x32_bf16 v[212:215], a[40:43], a[136:139], v[212:215]
ds_read_b128 a[120:123], v2 offset:47104
v_and_b32 v252, 31, v0
v_mfma_f32_16x16x32_bf16 v[212:215], a[44:47], a[140:143], v[212:215]
v_lshrrev_b32 v253, 5, v0
v_xor_b32 v253, v253, v252
v_mfma_f32_16x16x32_bf16 v[216:219], a[48:51], a[136:139], v[216:219]
v_and_b32 v253, 7, v253
v_lshlrev_b32 v252, 8, v252
v_mfma_f32_16x16x32_bf16 v[216:219], a[52:55], a[140:143], v[216:219]
v_lshl_add_u32 v252, v253, 4, v252
v_add_u32 v252, 147456, v252
v_mfma_f32_16x16x32_bf16 v[220:223], a[56:59], a[136:139], v[220:223]
ds_read_b128 a[124:127], v3 offset:47104
v_mfma_f32_16x16x32_bf16 v[220:223], a[60:63], a[140:143], v[220:223]
s_waitcnt lgkmcnt(3)
v_mfma_f32_16x16x32_bf16 a[192:195], a[0:3], a[128:131], a[192:195]
ds_read_b64_tr_b16 a[136:137], v11 offset:0
v_mfma_f32_16x16x32_bf16 a[192:195], a[4:7], a[132:135], a[192:195]
v_mfma_f32_16x16x32_bf16 a[196:199], a[8:11], a[128:131], a[196:199]
ds_read_b64_tr_b16 a[138:139], v11 offset:2048
v_mfma_f32_16x16x32_bf16 a[196:199], a[12:15], a[132:135], a[196:199]
v_mfma_f32_16x16x32_bf16 a[200:203], a[16:19], a[128:131], a[200:203]
ds_read_b64_tr_b16 a[140:141], v11 offset:16384
v_mfma_f32_16x16x32_bf16 a[200:203], a[20:23], a[132:135], a[200:203]
v_mfma_f32_16x16x32_bf16 a[204:207], a[24:27], a[128:131], a[204:207]
ds_read_b64_tr_b16 a[142:143], v11 offset:18432
v_mfma_f32_16x16x32_bf16 a[204:207], a[28:31], a[132:135], a[204:207]
v_mfma_f32_16x16x32_bf16 a[208:211], a[32:35], a[128:131], a[208:211]
v_mfma_f32_16x16x32_bf16 a[208:211], a[36:39], a[132:135], a[208:211]
v_mfma_f32_16x16x32_bf16 a[212:215], a[40:43], a[128:131], a[212:215]
v_mfma_f32_16x16x32_bf16 a[212:215], a[44:47], a[132:135], a[212:215]
v_mfma_f32_16x16x32_bf16 a[216:219], a[48:51], a[128:131], a[216:219]
v_mfma_f32_16x16x32_bf16 a[216:219], a[52:55], a[132:135], a[216:219]
v_mfma_f32_16x16x32_bf16 a[220:223], a[56:59], a[128:131], a[220:223]
s_waitcnt vmcnt(2) lgkmcnt(0)
v_mfma_f32_16x16x32_bf16 a[220:223], a[60:63], a[132:135], a[220:223]
s_barrier
v_mfma_f32_16x16x32_bf16 a[224:227], a[0:3], a[136:139], a[224:227]
s_add_u32 m0, s29, 65536
ds_read_b64_tr_b16 a[128:129], v4 offset:32768
v_lshlrev_b32 v28, 16, v248
v_mfma_f32_16x16x32_bf16 a[224:227], a[4:7], a[140:143], a[224:227]
buffer_load_dwordx4 v16, s[12:15], s26 offen offset:0 lds
v_mfma_f32_16x16x32_bf16 a[228:231], a[8:11], a[136:139], a[228:231]
ds_read_b64_tr_b16 a[130:131], v4 offset:34816
v_and_b32 v29, s58, v248
v_mfma_f32_16x16x32_bf16 a[228:231], a[12:15], a[140:143], a[228:231]
v_lshlrev_b32 v30, 16, v249
v_and_b32 v253, s58, v249
v_mfma_f32_16x16x32_bf16 a[232:235], a[16:19], a[136:139], a[232:235]
ds_read_b64_tr_b16 a[132:133], v4 offset:49152
v_lshlrev_b32 v22, 16, v224
v_mfma_f32_16x16x32_bf16 a[232:235], a[20:23], a[140:143], a[232:235]
buffer_load_dwordx4 v17, s[12:15], s26 offen offset:1024 lds
v_mfma_f32_16x16x32_bf16 a[236:239], a[24:27], a[136:139], a[236:239]
ds_read_b64_tr_b16 a[134:135], v4 offset:51200
v_lshlrev_b32 v23, 16, v225
v_mfma_f32_16x16x32_bf16 a[236:239], a[28:31], a[140:143], a[236:239]
v_lshlrev_b32 v24, 16, v226
v_mul_f32 v254, v22, v253
v_mfma_f32_16x16x32_bf16 a[240:243], a[32:35], a[136:139], a[240:243]
v_lshlrev_b32 v25, 16, v227
v_lshlrev_b32 v247, 16, v236
v_mfma_f32_16x16x32_bf16 a[240:243], a[36:39], a[140:143], a[240:243]
buffer_load_dwordx4 v18, s[12:15], s26 offen offset:2048 lds
v_mfma_f32_16x16x32_bf16 a[244:247], a[40:43], a[136:139], a[244:247]
v_fmac_f32 v254, v23, v30
v_fmac_f32 v254, v24, v29
v_mfma_f32_16x16x32_bf16 a[244:247], a[44:47], a[140:143], a[244:247]
v_fmac_f32 v254, v25, v28
v_mul_f32 v254, v254, v247
v_mfma_f32_16x16x32_bf16 a[248:251], a[48:51], a[136:139], a[248:251]
v_mul_f32 v255, v23, v253
v_lshlrev_b32 v22, 16, v228
v_mfma_f32_16x16x32_bf16 a[248:251], a[52:55], a[140:143], a[248:251]
buffer_load_dwordx4 v19, s[12:15], s26 offen offset:3072 lds
v_mfma_f32_16x16x32_bf16 a[252:255], a[56:59], a[136:139], a[252:255]
s_add_u32 s26, s26, 524288
v_lshlrev_b32 v247, 16, v237
v_fmac_f32 v255, v24, v30
v_mfma_f32_16x16x32_bf16 a[252:255], a[60:63], a[140:143], a[252:255]
s_waitcnt lgkmcnt(0)
v_fmac_f32 v255, v25, v29
v_fmac_f32 v255, v22, v28
v_mfma_f32_16x16x32_bf16 v[32:35], a[64:67], a[128:131], v[32:35]
s_add_u32 m0, s29, 81920
ds_read_b64_tr_b16 a[136:137], v5 offset:32768
v_mul_f32 v255, v255, v247
v_mfma_f32_16x16x32_bf16 v[32:35], a[68:71], a[132:135], v[32:35]
buffer_load_dwordx4 v16, s[12:15], s27 offen offset:0 lds
v_mfma_f32_16x16x32_bf16 v[36:39], a[72:75], a[128:131], v[36:39]
ds_read_b64_tr_b16 a[138:139], v5 offset:34816
v_cvt_pk_bf16_f32 v246, v254, v255
v_mfma_f32_16x16x32_bf16 v[36:39], a[76:79], a[132:135], v[36:39]
v_accvgpr_write_b32 a180, v246
v_mul_f32 v254, v24, v253
v_mfma_f32_16x16x32_bf16 v[40:43], a[80:83], a[128:131], v[40:43]
ds_read_b64_tr_b16 a[140:141], v5 offset:49152
v_lshlrev_b32 v23, 16, v229
v_mfma_f32_16x16x32_bf16 v[40:43], a[84:87], a[132:135], v[40:43]
buffer_load_dwordx4 v17, s[12:15], s27 offen offset:1024 lds
v_lshlrev_b32 v247, 16, v238
v_mfma_f32_16x16x32_bf16 v[44:47], a[88:91], a[128:131], v[44:47]
ds_read_b64_tr_b16 a[142:143], v5 offset:51200
v_fmac_f32 v254, v25, v30
v_mfma_f32_16x16x32_bf16 v[44:47], a[92:95], a[132:135], v[44:47]
v_fmac_f32 v254, v22, v29
v_fmac_f32 v254, v23, v28
v_mfma_f32_16x16x32_bf16 v[48:51], a[96:99], a[128:131], v[48:51]
ds_read_b128 a[0:3], v2 offset:0
v_mul_f32 v254, v254, v247
v_mfma_f32_16x16x32_bf16 v[48:51], a[100:103], a[132:135], v[48:51]
buffer_load_dwordx4 v18, s[12:15], s27 offen offset:2048 lds
v_mfma_f32_16x16x32_bf16 v[52:55], a[104:107], a[128:131], v[52:55]
ds_read_b128 a[4:7], v3 offset:0
v_cvt_pk_bf16_f32 v246, v255, v254
v_accvgpr_write_b32 a176, v246
v_mfma_f32_16x16x32_bf16 v[52:55], a[108:111], a[132:135], v[52:55]
v_mul_f32 v255, v25, v253
v_lshlrev_b32 v24, 16, v230
v_mfma_f32_16x16x32_bf16 v[56:59], a[112:115], a[128:131], v[56:59]
v_lshlrev_b32 v247, 16, v239
v_fmac_f32 v255, v22, v30
v_mfma_f32_16x16x32_bf16 v[56:59], a[116:119], a[132:135], v[56:59]
buffer_load_dwordx4 v19, s[12:15], s27 offen offset:3072 lds
v_mfma_f32_16x16x32_bf16 v[60:63], a[120:123], a[128:131], v[60:63]
s_add_u32 s27, s27, 524288
ds_read_b128 a[8:11], v2 offset:2048
v_fmac_f32 v255, v23, v29
v_mfma_f32_16x16x32_bf16 v[60:63], a[124:127], a[132:135], v[60:63]
s_waitcnt lgkmcnt(3)
v_fmac_f32 v255, v24, v28
v_mul_f32 v255, v255, v247
v_mfma_f32_16x16x32_bf16 v[64:67], a[64:67], a[136:139], v[64:67]
s_add_u32 m0, s28, 32768
ds_read_b64_tr_b16 a[128:129], v6 offset:32768
v_cvt_pk_bf16_f32 v246, v254, v255
v_accvgpr_write_b32 a181, v246
v_mfma_f32_16x16x32_bf16 v[64:67], a[68:71], a[140:143], v[64:67]
buffer_load_dwordx4 v12, s[8:11], s24 offen offset:0 lds
v_mfma_f32_16x16x32_bf16 v[68:71], a[72:75], a[136:139], v[68:71]
ds_read_b64_tr_b16 a[130:131], v6 offset:34816
v_mul_f32 v254, v22, v253
v_mfma_f32_16x16x32_bf16 v[68:71], a[76:79], a[140:143], v[68:71]
v_lshlrev_b32 v25, 16, v231
v_lshlrev_b32 v247, 16, v240
v_mfma_f32_16x16x32_bf16 v[72:75], a[80:83], a[136:139], v[72:75]
ds_read_b64_tr_b16 a[132:133], v6 offset:49152
v_fmac_f32 v254, v23, v30
v_mfma_f32_16x16x32_bf16 v[72:75], a[84:87], a[140:143], v[72:75]
buffer_load_dwordx4 v13, s[8:11], s24 offen offset:1024 lds
v_fmac_f32 v254, v24, v29
v_mfma_f32_16x16x32_bf16 v[76:79], a[88:91], a[136:139], v[76:79]
ds_read_b64_tr_b16 a[134:135], v6 offset:51200
v_fmac_f32 v254, v25, v28
v_mfma_f32_16x16x32_bf16 v[76:79], a[92:95], a[140:143], v[76:79]
v_mul_f32 v254, v254, v247
v_cvt_pk_bf16_f32 v246, v255, v254
v_mfma_f32_16x16x32_bf16 v[80:83], a[96:99], a[136:139], v[80:83]
ds_read_b128 a[12:15], v3 offset:2048
v_accvgpr_write_b32 a177, v246
v_mfma_f32_16x16x32_bf16 v[80:83], a[100:103], a[140:143], v[80:83]
buffer_load_dwordx4 v14, s[8:11], s24 offen offset:2048 lds
v_mfma_f32_16x16x32_bf16 v[84:87], a[104:107], a[136:139], v[84:87]
v_mul_f32 v255, v23, v253
v_lshlrev_b32 v22, 16, v232
v_lshlrev_b32 v247, 16, v241
v_mfma_f32_16x16x32_bf16 v[84:87], a[108:111], a[140:143], v[84:87]
v_fmac_f32 v255, v24, v30
v_fmac_f32 v255, v25, v29
v_mfma_f32_16x16x32_bf16 v[88:91], a[112:115], a[136:139], v[88:91]
ds_read_b128 a[16:19], v2 offset:4096
v_fmac_f32 v255, v22, v28
v_mfma_f32_16x16x32_bf16 v[88:91], a[116:119], a[140:143], v[88:91]
buffer_load_dwordx4 v15, s[8:11], s24 offen offset:3072 lds
v_mfma_f32_16x16x32_bf16 v[92:95], a[120:123], a[136:139], v[92:95]
PAD_24:
s_cbranch_execz PAD_28
s_add_u32 s24, s24, 128
ds_read_b128 a[20:23], v3 offset:4096
v_mul_f32 v255, v255, v247
v_mfma_f32_16x16x32_bf16 v[92:95], a[124:127], a[140:143], v[92:95]
s_waitcnt lgkmcnt(3)
v_cvt_pk_bf16_f32 v246, v254, v255
v_accvgpr_write_b32 a182, v246
v_mfma_f32_16x16x32_bf16 v[96:99], a[64:67], a[128:131], v[96:99]
s_add_u32 m0, s28, 36864
ds_read_b64_tr_b16 a[136:137], v7 offset:32768
v_mul_f32 v254, v24, v253
v_lshlrev_b32 v23, 16, v233
v_mfma_f32_16x16x32_bf16 v[96:99], a[68:71], a[132:135], v[96:99]
buffer_load_dwordx4 v12, s[8:11], s25 offen offset:0 lds
v_mfma_f32_16x16x32_bf16 v[100:103], a[72:75], a[128:131], v[100:103]
ds_read_b64_tr_b16 a[138:139], v7 offset:34816
v_lshlrev_b32 v247, 16, v242
v_mfma_f32_16x16x32_bf16 v[100:103], a[76:79], a[132:135], v[100:103]
v_fmac_f32 v254, v25, v30
v_fmac_f32 v254, v22, v29
v_mfma_f32_16x16x32_bf16 v[104:107], a[80:83], a[128:131], v[104:107]
ds_read_b64_tr_b16 a[140:141], v7 offset:49152
v_fmac_f32 v254, v23, v28
v_mfma_f32_16x16x32_bf16 v[104:107], a[84:87], a[132:135], v[104:107]
buffer_load_dwordx4 v13, s[8:11], s25 offen offset:1024 lds
v_mul_f32 v254, v254, v247
v_mfma_f32_16x16x32_bf16 v[108:111], a[88:91], a[128:131], v[108:111]
ds_read_b64_tr_b16 a[142:143], v7 offset:51200
v_cvt_pk_bf16_f32 v246, v255, v254
v_mfma_f32_16x16x32_bf16 v[108:111], a[92:95], a[132:135], v[108:111]
v_accvgpr_write_b32 a178, v246
v_mul_f32 v255, v25, v253
v_mfma_f32_16x16x32_bf16 v[112:115], a[96:99], a[128:131], v[112:115]
v_lshlrev_b32 v24, 16, v234
v_lshlrev_b32 v247, 16, v243
v_mfma_f32_16x16x32_bf16 v[112:115], a[100:103], a[132:135], v[112:115]
buffer_load_dwordx4 v14, s[8:11], s25 offen offset:2048 lds
v_mfma_f32_16x16x32_bf16 v[116:119], a[104:107], a[128:131], v[116:119]
ds_read_b128 a[24:27], v2 offset:6144
v_fmac_f32 v255, v22, v30
v_fmac_f32 v255, v23, v29
v_mfma_f32_16x16x32_bf16 v[116:119], a[108:111], a[132:135], v[116:119]
v_fmac_f32 v255, v24, v28
v_mul_f32 v255, v255, v247
v_mfma_f32_16x16x32_bf16 v[120:123], a[112:115], a[128:131], v[120:123]
ds_read_b128 a[28:31], v3 offset:6144
v_cvt_pk_bf16_f32 v246, v254, v255
v_mfma_f32_16x16x32_bf16 v[120:123], a[116:119], a[132:135], v[120:123]
buffer_load_dwordx4 v15, s[8:11], s25 offen offset:3072 lds
v_mfma_f32_16x16x32_bf16 v[124:127], a[120:123], a[128:131], v[124:127]
s_add_u32 s25, s25, 128
v_accvgpr_write_b32 a183, v246
v_mul_f32 v254, v22, v253
v_mfma_f32_16x16x32_bf16 v[124:127], a[124:127], a[132:135], v[124:127]
s_waitcnt lgkmcnt(2)
v_lshlrev_b32 v25, 16, v235
v_lshlrev_b32 v247, 16, v244
v_mfma_f32_16x16x32_bf16 v[128:131], a[64:67], a[136:139], v[128:131]
ds_read_b64_tr_b16 a[128:129], v8 offset:32768
v_fmac_f32 v254, v23, v30
v_fmac_f32 v254, v24, v29
v_mfma_f32_16x16x32_bf16 v[128:131], a[68:71], a[140:143], v[128:131]
buffer_load_dword v21, v20, s[16:19], s43 offen
v_mfma_f32_16x16x32_bf16 v[132:135], a[72:75], a[136:139], v[132:135]
s_add_u32 s43, s43, s47
ds_read_b64_tr_b16 a[130:131], v8 offset:34816
v_fmac_f32 v254, v25, v28
v_mfma_f32_16x16x32_bf16 v[132:135], a[76:79], a[140:143], v[132:135]
s_cmp_ge_u32 s43, s51
v_mul_f32 v254, v254, v247
v_cvt_pk_bf16_f32 v246, v255, v254
v_mfma_f32_16x16x32_bf16 v[136:139], a[80:83], a[136:139], v[136:139]
s_cselect_b32 s43, 0, s43
ds_read_b64_tr_b16 a[132:133], v8 offset:49152
v_accvgpr_write_b32 a179, v246
v_mfma_f32_16x16x32_bf16 v[136:139], a[84:87], a[140:143], v[136:139]
s_cselect_b32 s51, s42, s51
v_lshlrev_b32 v28, 16, v250
v_and_b32 v29, s58, v250
v_lshlrev_b32 v30, 16, v251
v_mfma_f32_16x16x32_bf16 v[140:143], a[88:91], a[136:139], v[140:143]
s_cselect_b64 s[16:17], s[40:41], s[16:17]
ds_read_b64_tr_b16 a[134:135], v8 offset:51200
v_and_b32 v253, s58, v251
v_mfma_f32_16x16x32_bf16 v[140:143], a[92:95], a[140:143], v[140:143]
s_cselect_b32 s18, s42, s18
v_and_b32 v22, s58, v224
v_and_b32 v23, s58, v225
v_mfma_f32_16x16x32_bf16 v[144:147], a[96:99], a[136:139], v[144:147]
s_cselect_b64 s[40:41], s[44:45], s[40:41]
ds_read_b128 a[32:35], v2 offset:8192
v_and_b32 v24, s58, v226
v_mfma_f32_16x16x32_bf16 v[144:147], a[100:103], a[140:143], v[144:147]
s_cselect_b32 s42, s46, s42
v_mul_f32 v254, v22, v253
v_and_b32 v25, s58, v227
v_mfma_f32_16x16x32_bf16 v[148:151], a[104:107], a[136:139], v[148:151]
s_cselect_b32 s46, 0, s46
v_and_b32 v247, s58, v236
v_fmac_f32 v254, v23, v30
v_mfma_f32_16x16x32_bf16 v[148:151], a[108:111], a[140:143], v[148:151]
buffer_load_dword v245, off, s[60:63], 0 sc1
v_fmac_f32 v254, v24, v29
v_mfma_f32_16x16x32_bf16 v[152:155], a[112:115], a[136:139], v[152:155]
ds_read_b128 a[36:39], v3 offset:8192
v_fmac_f32 v254, v25, v28
v_mfma_f32_16x16x32_bf16 v[152:155], a[116:119], a[140:143], v[152:155]
v_mul_f32 v254, v254, v247
v_mul_f32 v255, v23, v253
v_mfma_f32_16x16x32_bf16 v[156:159], a[120:123], a[136:139], v[156:159]
ds_read_b128 a[40:43], v2 offset:10240
v_and_b32 v22, s58, v228
v_mfma_f32_16x16x32_bf16 v[156:159], a[124:127], a[140:143], v[156:159]
s_waitcnt lgkmcnt(3)
v_and_b32 v247, s58, v237
v_fmac_f32 v255, v24, v30
v_mfma_f32_16x16x32_bf16 v[160:163], a[64:67], a[128:131], v[160:163]
ds_read_b64_tr_b16 a[136:137], v9 offset:32768
v_fmac_f32 v255, v25, v29
v_fmac_f32 v255, v22, v28
v_mfma_f32_16x16x32_bf16 v[160:163], a[68:71], a[132:135], v[160:163]
v_mul_f32 v255, v255, v247
v_cvt_pk_bf16_f32 v246, v254, v255
v_mfma_f32_16x16x32_bf16 v[164:167], a[72:75], a[128:131], v[164:167]
ds_read_b64_tr_b16 a[138:139], v9 offset:34816
v_accvgpr_write_b32 a188, v246
v_mfma_f32_16x16x32_bf16 v[164:167], a[76:79], a[132:135], v[164:167]
v_mul_f32 v254, v24, v253
v_and_b32 v23, s58, v229
v_mfma_f32_16x16x32_bf16 v[168:171], a[80:83], a[128:131], v[168:171]
ds_read_b64_tr_b16 a[140:141], v9 offset:49152
v_and_b32 v247, s58, v238
v_mfma_f32_16x16x32_bf16 v[168:171], a[84:87], a[132:135], v[168:171]
v_fmac_f32 v254, v25, v30
v_fmac_f32 v254, v22, v29
v_fmac_f32 v254, v23, v28
v_mfma_f32_16x16x32_bf16 v[172:175], a[88:91], a[128:131], v[172:175]
ds_read_b64_tr_b16 a[142:143], v9 offset:51200
v_mul_f32 v254, v254, v247
v_mfma_f32_16x16x32_bf16 v[172:175], a[92:95], a[132:135], v[172:175]
v_cvt_pk_bf16_f32 v246, v255, v254
v_accvgpr_write_b32 a184, v246
v_mfma_f32_16x16x32_bf16 v[176:179], a[96:99], a[128:131], v[176:179]
v_mul_f32 v255, v25, v253
v_and_b32 v24, s58, v230
v_mfma_f32_16x16x32_bf16 v[176:179], a[100:103], a[132:135], v[176:179]
v_and_b32 v247, s58, v239
v_fmac_f32 v255, v22, v30
v_mfma_f32_16x16x32_bf16 v[180:183], a[104:107], a[128:131], v[180:183]
ds_read_b128 a[44:47], v3 offset:10240
v_fmac_f32 v255, v23, v29
v_mfma_f32_16x16x32_bf16 v[180:183], a[108:111], a[132:135], v[180:183]
v_fmac_f32 v255, v24, v28
v_mul_f32 v255, v255, v247
v_cvt_pk_bf16_f32 v246, v254, v255
v_mfma_f32_16x16x32_bf16 v[184:187], a[112:115], a[128:131], v[184:187]
ds_read_b128 a[48:51], v2 offset:12288
v_accvgpr_write_b32 a189, v246
v_mfma_f32_16x16x32_bf16 v[184:187], a[116:119], a[132:135], v[184:187]
v_mul_f32 v254, v22, v253
v_and_b32 v25, s58, v231
v_mfma_f32_16x16x32_bf16 v[188:191], a[120:123], a[128:131], v[188:191]
v_and_b32 v247, s58, v240
v_fmac_f32 v254, v23, v30
v_mfma_f32_16x16x32_bf16 v[188:191], a[124:127], a[132:135], v[188:191]
s_waitcnt lgkmcnt(2)
v_fmac_f32 v254, v24, v29
v_fmac_f32 v254, v25, v28
v_mfma_f32_16x16x32_bf16 v[192:195], a[64:67], a[136:139], v[192:195]
ds_read_b64_tr_b16 a[128:129], v10 offset:32768
v_mul_f32 v254, v254, v247
v_cvt_pk_bf16_f32 v246, v255, v254
v_mfma_f32_16x16x32_bf16 v[192:195], a[68:71], a[140:143], v[192:195]
v_accvgpr_write_b32 a185, v246
v_mul_f32 v255, v23, v253
v_mfma_f32_16x16x32_bf16 v[196:199], a[72:75], a[136:139], v[196:199]
ds_read_b64_tr_b16 a[130:131], v10 offset:34816
v_and_b32 v22, s58, v232
v_mfma_f32_16x16x32_bf16 v[196:199], a[76:79], a[140:143], v[196:199]
v_and_b32 v247, s58, v241
v_fmac_f32 v255, v24, v30
v_mfma_f32_16x16x32_bf16 v[200:203], a[80:83], a[136:139], v[200:203]
s_lshr_b32 s22, s3, 1
ds_read_b64_tr_b16 a[132:133], v10 offset:49152
v_fmac_f32 v255, v25, v29
v_mfma_f32_16x16x32_bf16 v[200:203], a[84:87], a[140:143], v[200:203]
s_mul_i32 s22, s22, 2097152
v_fmac_f32 v255, v22, v28
v_mul_f32 v255, v255, v247
v_cvt_pk_bf16_f32 v246, v254, v255
v_mfma_f32_16x16x32_bf16 v[204:207], a[88:91], a[136:139], v[204:207]
s_and_b32 s23, s3, 1
ds_read_b64_tr_b16 a[134:135], v10 offset:51200
v_accvgpr_write_b32 a190, v246
v_mfma_f32_16x16x32_bf16 v[204:207], a[92:95], a[140:143], v[204:207]
s_lshl_b32 s23, s23, 5
v_mul_f32 v254, v24, v253
v_and_b32 v23, s58, v233
v_mfma_f32_16x16x32_bf16 v[208:211], a[96:99], a[136:139], v[208:211]
s_lshl_b32 s56, s39, 6
ds_read_b128 a[52:55], v3 offset:12288
v_and_b32 v247, s58, v242
v_mfma_f32_16x16x32_bf16 v[208:211], a[100:103], a[140:143], v[208:211]
s_add_u32 s23, s23, s56
v_fmac_f32 v254, v25, v30
v_fmac_f32 v254, v22, v29
v_mfma_f32_16x16x32_bf16 v[212:215], a[104:107], a[136:139], v[212:215]
s_mul_i32 s23, s23, 4224
ds_read_b128 a[56:59], v2 offset:14336
v_fmac_f32 v254, v23, v28
v_mfma_f32_16x16x32_bf16 v[212:215], a[108:111], a[140:143], v[212:215]
s_add_u32 s22, s22, s23
v_mul_f32 v254, v254, v247
v_cvt_pk_bf16_f32 v246, v255, v254
v_accvgpr_write_b32 a186, v246
v_mfma_f32_16x16x32_bf16 v[216:219], a[112:115], a[136:139], v[216:219]
s_add_u32 s57, s22, 83886200
v_mul_f32 v255, v25, v253
v_and_b32 v24, s58, v234
v_mfma_f32_16x16x32_bf16 v[216:219], a[116:119], a[140:143], v[216:219]
s_lshl_b32 s23, s38, 7
v_and_b32 v247, s58, v243
v_fmac_f32 v255, v22, v30
v_mfma_f32_16x16x32_bf16 v[220:223], a[120:123], a[136:139], v[220:223]
s_add_u32 s22, s22, s23
ds_read_b128 a[60:63], v3 offset:14336
v_fmac_f32 v255, v23, v29
v_mfma_f32_16x16x32_bf16 v[220:223], a[124:127], a[140:143], v[220:223]
s_waitcnt lgkmcnt(3)
s_add_u32 s56, s22, 83886208
v_fmac_f32 v255, v24, v28
v_mul_f32 v255, v255, v247
v_mfma_f32_16x16x32_bf16 a[192:195], a[64:67], a[128:131], a[192:195]
s_cmp_lt_u32 s2, 224
ds_read_b64_tr_b16 a[136:137], v11 offset:32768
v_cvt_pk_bf16_f32 v246, v254, v255
v_accvgpr_write_b32 a191, v246
v_mfma_f32_16x16x32_bf16 a[192:195], a[68:71], a[132:135], a[192:195]
s_cselect_b32 s56, s56, 3221225472
v_mul_f32 v254, v22, v253
v_and_b32 v25, s58, v235
v_mfma_f32_16x16x32_bf16 a[196:199], a[72:75], a[128:131], a[196:199]
s_cmp_eq_u32 s38, 0
ds_read_b64_tr_b16 a[138:139], v11 offset:34816
v_and_b32 v247, s58, v244
v_mfma_f32_16x16x32_bf16 a[196:199], a[76:79], a[132:135], a[196:199]
s_cselect_b32 s57, s57, 3221225472
v_fmac_f32 v254, v23, v30
v_fmac_f32 v254, v24, v29
v_mfma_f32_16x16x32_bf16 a[200:203], a[80:83], a[128:131], a[200:203]
ds_read_b64_tr_b16 a[140:141], v11 offset:49152
v_fmac_f32 v254, v25, v28
v_mfma_f32_16x16x32_bf16 a[200:203], a[84:87], a[132:135], a[200:203]
v_mul_f32 v254, v254, v247
v_cvt_pk_bf16_f32 v246, v255, v254
v_accvgpr_write_b32 a187, v246
v_mfma_f32_16x16x32_bf16 a[204:207], a[88:91], a[128:131], a[204:207]
ds_read_b64_tr_b16 a[142:143], v11 offset:51200
v_mfma_f32_16x16x32_bf16 a[204:207], a[92:95], a[132:135], a[204:207]
ds_write_b128 v252, a[176:179] offset:0
v_mfma_f32_16x16x32_bf16 a[208:211], a[96:99], a[128:131], a[208:211]
v_mfma_f32_16x16x32_bf16 a[208:211], a[100:103], a[132:135], a[208:211]
ds_write_b128 v252, a[180:183] offset:8192
v_mfma_f32_16x16x32_bf16 a[212:215], a[104:107], a[128:131], a[212:215]
v_mfma_f32_16x16x32_bf16 a[212:215], a[108:111], a[132:135], a[212:215]
ds_write_b128 v252, a[184:187] offset:128
v_mfma_f32_16x16x32_bf16 a[216:219], a[112:115], a[128:131], a[216:219]
v_mfma_f32_16x16x32_bf16 a[216:219], a[116:119], a[132:135], a[216:219]
ds_write_b128 v252, a[188:191] offset:8320
v_mfma_f32_16x16x32_bf16 a[220:223], a[120:123], a[128:131], a[220:223]
s_waitcnt vmcnt(2) lgkmcnt(0)
v_mfma_f32_16x16x32_bf16 a[220:223], a[124:127], a[132:135], a[220:223]
s_barrier
v_mfma_f32_16x16x32_bf16 a[224:227], a[64:67], a[136:139], a[224:227]
s_add_u32 m0, s29, 98304
ds_read_b64_tr_b16 a[128:129], v4 offset:0
v_lshrrev_b32 v22, 8, v1
v_mfma_f32_16x16x32_bf16 a[224:227], a[68:71], a[140:143], a[224:227]
buffer_load_dwordx4 v16, s[12:15], s26 offen offset:0 lds
v_mfma_f32_16x16x32_bf16 a[228:231], a[72:75], a[136:139], a[228:231]
ds_read_b64_tr_b16 a[130:131], v4 offset:2048
v_lshlrev_b32 v22, 4, v22
v_mfma_f32_16x16x32_bf16 a[228:231], a[76:79], a[140:143], a[228:231]
v_xor_b32 v22, v22, v1
v_add_u32 v22, s29, v22
v_mfma_f32_16x16x32_bf16 a[232:235], a[80:83], a[136:139], a[232:235]
ds_read_b64_tr_b16 a[132:133], v4 offset:16384
v_add_u32 v22, 147456, v22
v_mfma_f32_16x16x32_bf16 a[232:235], a[84:87], a[140:143], a[232:235]
buffer_load_dwordx4 v17, s[12:15], s26 offen offset:1024 lds
v_mfma_f32_16x16x32_bf16 a[236:239], a[88:91], a[136:139], a[236:239]
ds_read_b64_tr_b16 a[134:135], v4 offset:18432
v_xor_b32 v23, 64, v22
v_mfma_f32_16x16x32_bf16 a[236:239], a[92:95], a[140:143], a[236:239]
v_lshrrev_b32 v224, 7, v1
v_mul_u32_u24 v224, 4224, v224
v_mfma_f32_16x16x32_bf16 a[240:243], a[96:99], a[136:139], a[240:243]
v_and_b32 v225, 0x70, v1
v_add_u32 v224, v224, v225
v_mfma_f32_16x16x32_bf16 a[240:243], a[100:103], a[140:143], a[240:243]
buffer_load_dwordx4 v18, s[12:15], s26 offen offset:2048 lds
v_mfma_f32_16x16x32_bf16 a[244:247], a[104:107], a[136:139], a[244:247]
v_bfe_u32 v225, v1, 4, 5
v_mul_u32_u24 v225, 4224, v225
v_mfma_f32_16x16x32_bf16 a[244:247], a[108:111], a[140:143], a[244:247]
v_mov_b32 v226, 0
v_mov_b32 v227, 0
v_mfma_f32_16x16x32_bf16 a[248:251], a[112:115], a[136:139], a[248:251]
v_mfma_f32_16x16x32_bf16 a[248:251], a[116:119], a[140:143], a[248:251]
buffer_load_dwordx4 v19, s[12:15], s26 offen offset:3072 lds
v_mfma_f32_16x16x32_bf16 a[252:255], a[120:123], a[136:139], a[252:255]
s_add_u32 s26, s26, 524288
v_mfma_f32_16x16x32_bf16 a[252:255], a[124:127], a[140:143], a[252:255]
s_waitcnt lgkmcnt(0)
v_mfma_f32_16x16x32_bf16 v[32:35], a[0:3], a[128:131], v[32:35]
s_add_u32 m0, s29, 114688
ds_read_b64_tr_b16 a[136:137], v5 offset:0
v_mfma_f32_16x16x32_bf16 v[32:35], a[4:7], a[132:135], v[32:35]
buffer_load_dwordx4 v16, s[12:15], s27 offen offset:0 lds
v_mfma_f32_16x16x32_bf16 v[36:39], a[8:11], a[128:131], v[36:39]
s_mul_i32 s52, s20, 7
ds_read_b64_tr_b16 a[138:139], v5 offset:2048
v_mfma_f32_16x16x32_bf16 v[36:39], a[12:15], a[132:135], v[36:39]
s_add_u32 s52, s52, s21
buffer_store_dwordx2 v[226:227], v225, s[4:7], s57 offen sc1
v_mfma_f32_16x16x32_bf16 v[40:43], a[16:19], a[128:131], v[40:43]
s_lshl_b32 s53, s52, 2
ds_read_b64_tr_b16 a[140:141], v5 offset:16384
v_mfma_f32_16x16x32_bf16 v[40:43], a[20:23], a[132:135], v[40:43]
s_add_u32 s53, s53, s3
buffer_load_dwordx4 v17, s[12:15], s27 offen offset:1024 lds
v_mfma_f32_16x16x32_bf16 v[44:47], a[24:27], a[128:131], v[44:47]
s_lshl_b32 s49, s53, 12
ds_read_b64_tr_b16 a[142:143], v5 offset:18432
v_mfma_f32_16x16x32_bf16 v[44:47], a[28:31], a[132:135], v[44:47]
s_mul_i32 s53, s53, 4224
v_mfma_f32_16x16x32_bf16 v[48:51], a[32:35], a[128:131], v[48:51]
s_add_u32 s53, s53, 83886080
ds_read_b128 a[64:67], v2 offset:32768
v_mfma_f32_16x16x32_bf16 v[48:51], a[36:39], a[132:135], v[48:51]
s_lshr_b32 s52, s52, 4
buffer_load_dwordx4 v18, s[12:15], s27 offen offset:2048 lds
v_mfma_f32_16x16x32_bf16 v[52:55], a[40:43], a[128:131], v[52:55]
s_min_u32 s52, s52, 6
ds_read_b128 a[68:71], v3 offset:32768
v_mfma_f32_16x16x32_bf16 v[52:55], a[44:47], a[132:135], v[52:55]
s_lshl_b32 s52, s52, 7
ds_read_b128 a[176:179], v22 offset:0
v_mfma_f32_16x16x32_bf16 v[56:59], a[48:51], a[128:131], v[56:59]
s_add_u32 s52, s52, 94392320
ds_read_b128 a[180:183], v23 offset:1024
v_mfma_f32_16x16x32_bf16 v[56:59], a[52:55], a[132:135], v[56:59]
buffer_load_dwordx4 v19, s[12:15], s27 offen offset:3072 lds
v_mfma_f32_16x16x32_bf16 v[60:63], a[56:59], a[128:131], v[60:63]
s_add_u32 s27, s27, 524288
ds_read_b128 a[72:75], v2 offset:34816
v_mfma_f32_16x16x32_bf16 v[60:63], a[60:63], a[132:135], v[60:63]
s_waitcnt lgkmcnt(5)
ds_read_b128 a[184:187], v22 offset:2048
v_mfma_f32_16x16x32_bf16 v[64:67], a[0:3], a[136:139], v[64:67]
s_add_u32 m0, s28, 0
ds_read_b64_tr_b16 a[128:129], v6 offset:0
v_mfma_f32_16x16x32_bf16 v[64:67], a[4:7], a[140:143], v[64:67]
buffer_load_dwordx4 v12, s[8:11], s24 offen offset:0 lds
v_mfma_f32_16x16x32_bf16 v[68:71], a[8:11], a[136:139], v[68:71]
ds_read_b64_tr_b16 a[130:131], v6 offset:2048
v_mfma_f32_16x16x32_bf16 v[68:71], a[12:15], a[140:143], v[68:71]
ds_read_b128 a[188:191], v23 offset:3072
v_mfma_f32_16x16x32_bf16 v[72:75], a[16:19], a[136:139], v[72:75]
ds_read_b64_tr_b16 a[132:133], v6 offset:16384
v_bfe_u32 v231, v1, 4, 5
v_mfma_f32_16x16x32_bf16 v[72:75], a[20:23], a[140:143], v[72:75]
buffer_load_dwordx4 v13, s[8:11], s24 offen offset:1024 lds
v_mfma_f32_16x16x32_bf16 v[76:79], a[24:27], a[136:139], v[76:79]
ds_read_b64_tr_b16 a[134:135], v6 offset:18432
v_lshlrev_b32 v231, 2, v231
v_mfma_f32_16x16x32_bf16 v[76:79], a[28:31], a[140:143], v[76:79]
v_lshlrev_b32 v229, 3, v1
v_min_u32 v229, 4096, v229
v_mfma_f32_16x16x32_bf16 v[80:83], a[32:35], a[136:139], v[80:83]
ds_read_b128 a[76:79], v3 offset:34816
v_mfma_f32_16x16x32_bf16 v[80:83], a[36:39], a[140:143], v[80:83]
buffer_load_dwordx4 v14, s[8:11], s24 offen offset:2048 lds
v_mfma_f32_16x16x32_bf16 v[84:87], a[40:43], a[136:139], v[84:87]
v_mfma_f32_16x16x32_bf16 v[84:87], a[44:47], a[140:143], v[84:87]
v_mfma_f32_16x16x32_bf16 v[88:91], a[48:51], a[136:139], v[88:91]
ds_read_b128 a[80:83], v2 offset:36864
v_mfma_f32_16x16x32_bf16 v[88:91], a[52:55], a[140:143], v[88:91]
buffer_load_dwordx4 v15, s[8:11], s24 offen offset:3072 lds
v_mfma_f32_16x16x32_bf16 v[92:95], a[56:59], a[136:139], v[92:95]
s_add_u32 s24, s24, 128
ds_read_b128 a[84:87], v3 offset:36864
v_mfma_f32_16x16x32_bf16 v[92:95], a[60:63], a[140:143], v[92:95]
s_waitcnt lgkmcnt(3)
v_mfma_f32_16x16x32_bf16 v[96:99], a[0:3], a[128:131], v[96:99]
s_add_u32 m0, s28, 4096
ds_read_b64_tr_b16 a[136:137], v7 offset:0
v_mfma_f32_16x16x32_bf16 v[96:99], a[4:7], a[132:135], v[96:99]
buffer_load_dwordx4 v12, s[8:11], s25 offen offset:0 lds
v_mfma_f32_16x16x32_bf16 v[100:103], a[8:11], a[128:131], v[100:103]
ds_read_b64_tr_b16 a[138:139], v7 offset:2048
v_mfma_f32_16x16x32_bf16 v[100:103], a[12:15], a[132:135], v[100:103]
v_mfma_f32_16x16x32_bf16 v[104:107], a[16:19], a[128:131], v[104:107]
ds_read_b64_tr_b16 a[140:141], v7 offset:16384
v_mfma_f32_16x16x32_bf16 v[104:107], a[20:23], a[132:135], v[104:107]
buffer_load_dwordx4 v13, s[8:11], s25 offen offset:1024 lds
v_mfma_f32_16x16x32_bf16 v[108:111], a[24:27], a[128:131], v[108:111]
ds_read_b64_tr_b16 a[142:143], v7 offset:18432
v_mfma_f32_16x16x32_bf16 v[108:111], a[28:31], a[132:135], v[108:111]
v_mfma_f32_16x16x32_bf16 v[112:115], a[32:35], a[128:131], v[112:115]
v_mfma_f32_16x16x32_bf16 v[112:115], a[36:39], a[132:135], v[112:115]
buffer_load_dwordx4 v14, s[8:11], s25 offen offset:2048 lds
v_mfma_f32_16x16x32_bf16 v[116:119], a[40:43], a[128:131], v[116:119]
ds_read_b128 a[88:91], v2 offset:38912
v_mfma_f32_16x16x32_bf16 v[116:119], a[44:47], a[132:135], v[116:119]
v_mfma_f32_16x16x32_bf16 v[120:123], a[48:51], a[128:131], v[120:123]
ds_read_b128 a[92:95], v3 offset:38912
v_mfma_f32_16x16x32_bf16 v[120:123], a[52:55], a[132:135], v[120:123]
buffer_load_dwordx4 v15, s[8:11], s25 offen offset:3072 lds
v_mfma_f32_16x16x32_bf16 v[124:127], a[56:59], a[128:131], v[124:127]
s_add_u32 s25, s25, 128
v_mfma_f32_16x16x32_bf16 v[124:127], a[60:63], a[132:135], v[124:127]
s_waitcnt lgkmcnt(2)
v_mfma_f32_16x16x32_bf16 v[128:131], a[0:3], a[136:139], v[128:131]
ds_read_b64_tr_b16 a[128:129], v8 offset:0
v_mfma_f32_16x16x32_bf16 v[128:131], a[4:7], a[140:143], v[128:131]
buffer_store_dwordx4 a[176:179], v224, s[4:7], s56 offen sc1
v_mfma_f32_16x16x32_bf16 v[132:135], a[8:11], a[136:139], v[132:135]
s_add_u32 s56, s56, 33792
ds_read_b64_tr_b16 a[130:131], v8 offset:2048
v_mfma_f32_16x16x32_bf16 v[132:135], a[12:15], a[140:143], v[132:135]
v_mfma_f32_16x16x32_bf16 v[136:139], a[16:19], a[136:139], v[136:139]
ds_read_b64_tr_b16 a[132:133], v8 offset:16384
v_mfma_f32_16x16x32_bf16 v[136:139], a[20:23], a[140:143], v[136:139]
v_mfma_f32_16x16x32_bf16 v[140:143], a[24:27], a[136:139], v[140:143]
s_cmp_lt_u32 s21, 7
ds_read_b64_tr_b16 a[134:135], v8 offset:18432
v_mfma_f32_16x16x32_bf16 v[140:143], a[28:31], a[140:143], v[140:143]
s_cselect_b32 s53, s53, 3221225472
v_mfma_f32_16x16x32_bf16 v[144:147], a[32:35], a[136:139], v[144:147]
s_cselect_b32 s49, s49, 3221225472
ds_read_b128 a[96:99], v2 offset:40960
v_mfma_f32_16x16x32_bf16 v[144:147], a[36:39], a[140:143], v[144:147]
s_add_u32 s48, s53, 2097152
v_mfma_f32_16x16x32_bf16 v[148:151], a[40:43], a[136:139], v[148:151]
v_mfma_f32_16x16x32_bf16 v[148:151], a[44:47], a[140:143], v[148:151]
v_mfma_f32_16x16x32_bf16 v[152:155], a[48:51], a[136:139], v[152:155]
ds_read_b128 a[100:103], v3 offset:40960
v_mfma_f32_16x16x32_bf16 v[152:155], a[52:55], a[140:143], v[152:155]
v_mfma_f32_16x16x32_bf16 v[156:159], a[56:59], a[136:139], v[156:159]
ds_read_b128 a[104:107], v2 offset:43008
v_mfma_f32_16x16x32_bf16 v[156:159], a[60:63], a[140:143], v[156:159]
s_waitcnt lgkmcnt(3)
v_mfma_f32_16x16x32_bf16 v[160:163], a[0:3], a[128:131], v[160:163]
ds_read_b64_tr_b16 a[136:137], v9 offset:0
v_mfma_f32_16x16x32_bf16 v[160:163], a[4:7], a[132:135], v[160:163]
v_mfma_f32_16x16x32_bf16 v[164:167], a[8:11], a[128:131], v[164:167]
ds_read_b64_tr_b16 a[138:139], v9 offset:2048
v_mfma_f32_16x16x32_bf16 v[164:167], a[12:15], a[132:135], v[164:167]
buffer_store_dwordx4 a[180:183], v224, s[4:7], s56 offen sc1
v_mfma_f32_16x16x32_bf16 v[168:171], a[16:19], a[128:131], v[168:171]
s_add_u32 s56, s56, 33792
ds_read_b64_tr_b16 a[140:141], v9 offset:16384
v_mfma_f32_16x16x32_bf16 v[168:171], a[20:23], a[132:135], v[168:171]
v_mfma_f32_16x16x32_bf16 v[172:175], a[24:27], a[128:131], v[172:175]
ds_read_b64_tr_b16 a[142:143], v9 offset:18432
v_mfma_f32_16x16x32_bf16 v[172:175], a[28:31], a[132:135], v[172:175]
v_mfma_f32_16x16x32_bf16 v[176:179], a[32:35], a[128:131], v[176:179]
v_mfma_f32_16x16x32_bf16 v[176:179], a[36:39], a[132:135], v[176:179]
v_mfma_f32_16x16x32_bf16 v[180:183], a[40:43], a[128:131], v[180:183]
ds_read_b128 a[108:111], v3 offset:43008
v_mfma_f32_16x16x32_bf16 v[180:183], a[44:47], a[132:135], v[180:183]
v_mfma_f32_16x16x32_bf16 v[184:187], a[48:51], a[128:131], v[184:187]
ds_read_b128 a[112:115], v2 offset:45056
v_mfma_f32_16x16x32_bf16 v[184:187], a[52:55], a[132:135], v[184:187]
v_mfma_f32_16x16x32_bf16 v[188:191], a[56:59], a[128:131], v[188:191]
v_mfma_f32_16x16x32_bf16 v[188:191], a[60:63], a[132:135], v[188:191]
s_waitcnt lgkmcnt(2)
v_mfma_f32_16x16x32_bf16 v[192:195], a[0:3], a[136:139], v[192:195]
ds_read_b64_tr_b16 a[128:129], v10 offset:0
v_mfma_f32_16x16x32_bf16 v[192:195], a[4:7], a[140:143], v[192:195]
v_mfma_f32_16x16x32_bf16 v[196:199], a[8:11], a[136:139], v[196:199]
ds_read_b64_tr_b16 a[130:131], v10 offset:2048
v_mfma_f32_16x16x32_bf16 v[196:199], a[12:15], a[140:143], v[196:199]
v_mfma_f32_16x16x32_bf16 v[200:203], a[16:19], a[136:139], v[200:203]
ds_read_b64_tr_b16 a[132:133], v10 offset:16384
v_mfma_f32_16x16x32_bf16 v[200:203], a[20:23], a[140:143], v[200:203]
buffer_store_dwordx4 a[184:187], v224, s[4:7], s56 offen sc1
v_mfma_f32_16x16x32_bf16 v[204:207], a[24:27], a[136:139], v[204:207]
s_add_u32 s56, s56, 33792
ds_read_b64_tr_b16 a[134:135], v10 offset:18432
v_mfma_f32_16x16x32_bf16 v[204:207], a[28:31], a[140:143], v[204:207]
v_mfma_f32_16x16x32_bf16 v[208:211], a[32:35], a[136:139], v[208:211]
ds_read_b128 a[116:119], v3 offset:45056
v_mfma_f32_16x16x32_bf16 v[208:211], a[36:39], a[140:143], v[208:211]
v_mfma_f32_16x16x32_bf16 v[212:215], a[40:43], a[136:139], v[212:215]
ds_read_b128 a[120:123], v2 offset:47104
v_mfma_f32_16x16x32_bf16 v[212:215], a[44:47], a[140:143], v[212:215]
v_mfma_f32_16x16x32_bf16 v[216:219], a[48:51], a[136:139], v[216:219]
v_mfma_f32_16x16x32_bf16 v[216:219], a[52:55], a[140:143], v[216:219]
v_mfma_f32_16x16x32_bf16 v[220:223], a[56:59], a[136:139], v[220:223]
ds_read_b128 a[124:127], v3 offset:47104
v_mfma_f32_16x16x32_bf16 v[220:223], a[60:63], a[140:143], v[220:223]
s_waitcnt lgkmcnt(3)
v_mfma_f32_16x16x32_bf16 a[192:195], a[0:3], a[128:131], a[192:195]
ds_read_b64_tr_b16 a[136:137], v11 offset:0
v_mfma_f32_16x16x32_bf16 a[192:195], a[4:7], a[132:135], a[192:195]
v_mfma_f32_16x16x32_bf16 a[196:199], a[8:11], a[128:131], a[196:199]
ds_read_b64_tr_b16 a[138:139], v11 offset:2048
v_mfma_f32_16x16x32_bf16 a[196:199], a[12:15], a[132:135], a[196:199]
v_mfma_f32_16x16x32_bf16 a[200:203], a[16:19], a[128:131], a[200:203]
ds_read_b64_tr_b16 a[140:141], v11 offset:16384
v_mfma_f32_16x16x32_bf16 a[200:203], a[20:23], a[132:135], a[200:203]
v_mfma_f32_16x16x32_bf16 a[204:207], a[24:27], a[128:131], a[204:207]
ds_read_b64_tr_b16 a[142:143], v11 offset:18432
v_mfma_f32_16x16x32_bf16 a[204:207], a[28:31], a[132:135], a[204:207]
buffer_store_dwordx4 a[188:191], v224, s[4:7], s56 offen sc1
v_mfma_f32_16x16x32_bf16 a[208:211], a[32:35], a[128:131], a[208:211]
s_add_u32 s56, s56, 33792
v_mfma_f32_16x16x32_bf16 a[208:211], a[36:39], a[132:135], a[208:211]
v_mfma_f32_16x16x32_bf16 a[212:215], a[40:43], a[128:131], a[212:215]
v_mfma_f32_16x16x32_bf16 a[212:215], a[44:47], a[132:135], a[212:215]
v_mfma_f32_16x16x32_bf16 a[216:219], a[48:51], a[128:131], a[216:219]
v_mfma_f32_16x16x32_bf16 a[216:219], a[52:55], a[132:135], a[216:219]
v_mfma_f32_16x16x32_bf16 a[220:223], a[56:59], a[128:131], a[220:223]
s_waitcnt vmcnt(4) lgkmcnt(0)
v_mfma_f32_16x16x32_bf16 a[220:223], a[60:63], a[132:135], a[220:223]
s_barrier
v_mfma_f32_16x16x32_bf16 a[224:227], a[0:3], a[136:139], a[224:227]
s_add_u32 m0, s29, 65536
ds_read_b64_tr_b16 a[128:129], v4 offset:32768
v_mfma_f32_16x16x32_bf16 a[224:227], a[4:7], a[140:143], a[224:227]
buffer_load_dwordx4 v16, s[12:15], s26 offen offset:0 lds
v_mfma_f32_16x16x32_bf16 a[228:231], a[8:11], a[136:139], a[228:231]
ds_read_b64_tr_b16 a[130:131], v4 offset:34816
v_cmp_gt_u32 vcc, 0x100, v245
v_mfma_f32_16x16x32_bf16 a[228:231], a[12:15], a[140:143], a[228:231]
v_mfma_f32_16x16x32_bf16 a[232:235], a[16:19], a[136:139], a[232:235]
ds_read_b64_tr_b16 a[132:133], v4 offset:49152
v_mfma_f32_16x16x32_bf16 a[232:235], a[20:23], a[140:143], a[232:235]
buffer_load_dwordx4 v17, s[12:15], s26 offen offset:1024 lds
v_mfma_f32_16x16x32_bf16 a[236:239], a[24:27], a[136:139], a[236:239]
ds_read_b64_tr_b16 a[134:135], v4 offset:51200
v_mfma_f32_16x16x32_bf16 a[236:239], a[28:31], a[140:143], a[236:239]
v_mfma_f32_16x16x32_bf16 a[240:243], a[32:35], a[136:139], a[240:243]
v_mfma_f32_16x16x32_bf16 a[240:243], a[36:39], a[140:143], a[240:243]
buffer_load_dwordx4 v18, s[12:15], s26 offen offset:2048 lds
v_mfma_f32_16x16x32_bf16 a[244:247], a[40:43], a[136:139], a[244:247]
v_mfma_f32_16x16x32_bf16 a[244:247], a[44:47], a[140:143], a[244:247]
v_mfma_f32_16x16x32_bf16 a[248:251], a[48:51], a[136:139], a[248:251]
v_mfma_f32_16x16x32_bf16 a[248:251], a[52:55], a[140:143], a[248:251]
buffer_load_dwordx4 v19, s[12:15], s26 offen offset:3072 lds
v_mfma_f32_16x16x32_bf16 a[252:255], a[56:59], a[136:139], a[252:255]
s_add_u32 s26, s26, 524288
v_mfma_f32_16x16x32_bf16 a[252:255], a[60:63], a[140:143], a[252:255]
s_waitcnt lgkmcnt(0)
s_mov_b32 s82, s59
s_cbranch_vccnz M_cntspinV
s_branch Lg_501
PAD_25:
s_cbranch_execz PAD_29
Lg_501t:
buffer_load_dword v230, v231, s[4:7], s52 offen sc1
v_mfma_f32_16x16x32_bf16 v[32:35], a[64:67], a[128:131], v[32:35]
s_add_u32 m0, s29, 81920
ds_read_b64_tr_b16 a[136:137], v5 offset:32768
v_mfma_f32_16x16x32_bf16 v[32:35], a[68:71], a[132:135], v[32:35]
buffer_load_dwordx4 v16, s[12:15], s27 offen offset:0 lds
v_mfma_f32_16x16x32_bf16 v[36:39], a[72:75], a[128:131], v[36:39]
s_and_b32 s44, s3, 1
ds_read_b64_tr_b16 a[138:139], v5 offset:34816
v_mfma_f32_16x16x32_bf16 v[36:39], a[76:79], a[132:135], v[36:39]
s_lshl_b32 s44, s44, 8
v_mfma_f32_16x16x32_bf16 v[40:43], a[80:83], a[128:131], v[40:43]
s_lshl_b32 s45, s3, 7
ds_read_b64_tr_b16 a[140:141], v5 offset:49152
v_mfma_f32_16x16x32_bf16 v[40:43], a[84:87], a[132:135], v[40:43]
s_xor_b32 s44, s44, s45
buffer_load_dwordx4 v17, s[12:15], s27 offen offset:1024 lds
v_mfma_f32_16x16x32_bf16 v[44:47], a[88:91], a[128:131], v[44:47]
s_xor_b32 s44, s44, 196608
ds_read_b64_tr_b16 a[142:143], v5 offset:51200
v_mfma_f32_16x16x32_bf16 v[44:47], a[92:95], a[132:135], v[44:47]
v_mfma_f32_16x16x32_bf16 v[48:51], a[96:99], a[128:131], v[48:51]
ds_read_b128 a[0:3], v2 offset:0
v_mfma_f32_16x16x32_bf16 v[48:51], a[100:103], a[132:135], v[48:51]
buffer_load_dwordx4 v18, s[12:15], s27 offen offset:2048 lds
v_mfma_f32_16x16x32_bf16 v[52:55], a[104:107], a[128:131], v[52:55]
ds_read_b128 a[4:7], v3 offset:0
v_mfma_f32_16x16x32_bf16 v[52:55], a[108:111], a[132:135], v[52:55]
v_mfma_f32_16x16x32_bf16 v[56:59], a[112:115], a[128:131], v[56:59]
v_mfma_f32_16x16x32_bf16 v[56:59], a[116:119], a[132:135], v[56:59]
buffer_load_dwordx4 v19, s[12:15], s27 offen offset:3072 lds
v_mfma_f32_16x16x32_bf16 v[60:63], a[120:123], a[128:131], v[60:63]
s_add_u32 s27, s27, 524288
ds_read_b128 a[8:11], v2 offset:2048
v_mfma_f32_16x16x32_bf16 v[60:63], a[124:127], a[132:135], v[60:63]
PAD_26:
s_cbranch_execz PAD_30
s_waitcnt lgkmcnt(3)
v_mfma_f32_16x16x32_bf16 v[64:67], a[64:67], a[136:139], v[64:67]
s_add_u32 m0, s28, 32768
ds_read_b64_tr_b16 a[128:129], v6 offset:32768
v_mfma_f32_16x16x32_bf16 v[64:67], a[68:71], a[140:143], v[64:67]
buffer_load_dwordx4 v12, s[8:11], s24 offen offset:0 lds
v_mfma_f32_16x16x32_bf16 v[68:71], a[72:75], a[136:139], v[68:71]
ds_read_b64_tr_b16 a[130:131], v6 offset:34816
v_mfma_f32_16x16x32_bf16 v[68:71], a[76:79], a[140:143], v[68:71]
v_mfma_f32_16x16x32_bf16 v[72:75], a[80:83], a[136:139], v[72:75]
s_mov_b64 s[56:57], s[72:73]
ds_read_b64_tr_b16 a[132:133], v6 offset:49152
v_mfma_f32_16x16x32_bf16 v[72:75], a[84:87], a[140:143], v[72:75]
s_mov_b32 s58, 1835008
buffer_load_dwordx4 v13, s[8:11], s24 offen offset:1024 lds
v_mfma_f32_16x16x32_bf16 v[76:79], a[88:91], a[136:139], v[76:79]
s_mov_b32 s59, 0x20000
ds_read_b64_tr_b16 a[134:135], v6 offset:51200
v_mfma_f32_16x16x32_bf16 v[76:79], a[92:95], a[140:143], v[76:79]
v_mfma_f32_16x16x32_bf16 v[80:83], a[96:99], a[136:139], v[80:83]
ds_read_b128 a[12:15], v3 offset:2048
v_mfma_f32_16x16x32_bf16 v[80:83], a[100:103], a[140:143], v[80:83]
buffer_load_dwordx4 v14, s[8:11], s24 offen offset:2048 lds
v_mfma_f32_16x16x32_bf16 v[84:87], a[104:107], a[136:139], v[84:87]
v_mfma_f32_16x16x32_bf16 v[84:87], a[108:111], a[140:143], v[84:87]
v_mfma_f32_16x16x32_bf16 v[88:91], a[112:115], a[136:139], v[88:91]
ds_read_b128 a[16:19], v2 offset:4096
v_mfma_f32_16x16x32_bf16 v[88:91], a[116:119], a[140:143], v[88:91]
buffer_load_dwordx4 v15, s[8:11], s24 offen offset:3072 lds
v_mfma_f32_16x16x32_bf16 v[92:95], a[120:123], a[136:139], v[92:95]
s_add_u32 s24, s24, 128
ds_read_b128 a[20:23], v3 offset:4096
v_mfma_f32_16x16x32_bf16 v[92:95], a[124:127], a[140:143], v[92:95]
s_waitcnt lgkmcnt(3)
v_mfma_f32_16x16x32_bf16 v[96:99], a[64:67], a[128:131], v[96:99]
s_add_u32 m0, s28, 36864
ds_read_b64_tr_b16 a[136:137], v7 offset:32768
v_mfma_f32_16x16x32_bf16 v[96:99], a[68:71], a[132:135], v[96:99]
buffer_load_dwordx4 v12, s[8:11], s25 offen offset:0 lds
v_mfma_f32_16x16x32_bf16 v[100:103], a[72:75], a[128:131], v[100:103]
ds_read_b64_tr_b16 a[138:139], v7 offset:34816
v_mfma_f32_16x16x32_bf16 v[100:103], a[76:79], a[132:135], v[100:103]
v_mfma_f32_16x16x32_bf16 v[104:107], a[80:83], a[128:131], v[104:107]
ds_read_b64_tr_b16 a[140:141], v7 offset:49152
v_mfma_f32_16x16x32_bf16 v[104:107], a[84:87], a[132:135], v[104:107]
buffer_load_dwordx4 v13, s[8:11], s25 offen offset:1024 lds
v_mfma_f32_16x16x32_bf16 v[108:111], a[88:91], a[128:131], v[108:111]
ds_read_b64_tr_b16 a[142:143], v7 offset:51200
v_mfma_f32_16x16x32_bf16 v[108:111], a[92:95], a[132:135], v[108:111]
v_mfma_f32_16x16x32_bf16 v[112:115], a[96:99], a[128:131], v[112:115]
v_mfma_f32_16x16x32_bf16 v[112:115], a[100:103], a[132:135], v[112:115]
buffer_load_dwordx4 v14, s[8:11], s25 offen offset:2048 lds
v_mfma_f32_16x16x32_bf16 v[116:119], a[104:107], a[128:131], v[116:119]
ds_read_b128 a[24:27], v2 offset:6144
v_mfma_f32_16x16x32_bf16 v[116:119], a[108:111], a[132:135], v[116:119]
v_mfma_f32_16x16x32_bf16 v[120:123], a[112:115], a[128:131], v[120:123]
ds_read_b128 a[28:31], v3 offset:6144
v_mfma_f32_16x16x32_bf16 v[120:123], a[116:119], a[132:135], v[120:123]
buffer_load_dwordx4 v15, s[8:11], s25 offen offset:3072 lds
v_mfma_f32_16x16x32_bf16 v[124:127], a[120:123], a[128:131], v[124:127]
s_add_u32 s25, s25, 128
s_waitcnt vmcnt(12)
v_mfma_f32_16x16x32_bf16 v[124:127], a[124:127], a[132:135], v[124:127]
s_waitcnt lgkmcnt(2)
v_cmp_gt_u32 vcc, 1, v230
v_mfma_f32_16x16x32_bf16 v[128:131], a[64:67], a[136:139], v[128:131]
s_cbranch_vccnz M_ppspinV
M_ppokV:
ds_read_b64_tr_b16 a[128:129], v8 offset:32768
v_mfma_f32_16x16x32_bf16 v[128:131], a[68:71], a[140:143], v[128:131]
buffer_load_dword v230, v229, s[4:7], s53 offen sc1
v_mfma_f32_16x16x32_bf16 v[132:135], a[72:75], a[136:139], v[132:135]
s_mov_b64 s[8:9], s[76:77]
ds_read_b64_tr_b16 a[130:131], v8 offset:34816
v_mfma_f32_16x16x32_bf16 v[132:135], a[76:79], a[140:143], v[132:135]
s_mov_b32 s10, 1835008
buffer_load_dword v230, v229, s[4:7], s48 offen sc1
v_mfma_f32_16x16x32_bf16 v[136:139], a[80:83], a[136:139], v[136:139]
s_lshl_b32 s24, s37, 2
ds_read_b64_tr_b16 a[132:133], v8 offset:49152
v_mfma_f32_16x16x32_bf16 v[136:139], a[84:87], a[140:143], v[136:139]
s_add_u32 s24, s24, s3
buffer_load_dword v230, v229, s[56:59], s49 offen
v_mfma_f32_16x16x32_bf16 v[140:143], a[88:91], a[136:139], v[140:143]
s_mul_i32 s24, s24, 28672
ds_read_b64_tr_b16 a[134:135], v8 offset:51200
v_mfma_f32_16x16x32_bf16 v[140:143], a[92:95], a[140:143], v[140:143]
s_mov_b32 s28, s29
buffer_load_dword v21, v20, s[16:19], s43 offen
v_mfma_f32_16x16x32_bf16 v[144:147], a[96:99], a[136:139], v[144:147]
ds_read_b128 a[32:35], v2 offset:8192
v_mfma_f32_16x16x32_bf16 v[144:147], a[100:103], a[140:143], v[144:147]
v_mfma_f32_16x16x32_bf16 v[148:151], a[104:107], a[136:139], v[148:151]
v_mfma_f32_16x16x32_bf16 v[148:151], a[108:111], a[140:143], v[148:151]
v_mfma_f32_16x16x32_bf16 v[152:155], a[112:115], a[136:139], v[152:155]
ds_read_b128 a[36:39], v3 offset:8192
v_lshrrev_b32 v28, 7, v1
v_mfma_f32_16x16x32_bf16 v[152:155], a[116:119], a[140:143], v[152:155]
v_lshrrev_b32 v29, 1, v28
v_lshlrev_b32 v29, 4, v29
v_mfma_f32_16x16x32_bf16 v[156:159], a[120:123], a[136:139], v[156:159]
ds_read_b128 a[40:43], v2 offset:10240
v_and_b32 v30, 0x70, v1
v_mfma_f32_16x16x32_bf16 v[156:159], a[124:127], a[140:143], v[156:159]
s_waitcnt lgkmcnt(3)
v_xor_b32 v29, v29, v30
v_mul_u32_u24 v28, 896, v28
v_mfma_f32_16x16x32_bf16 v[160:163], a[64:67], a[128:131], v[160:163]
ds_read_b64_tr_b16 a[136:137], v9 offset:32768
v_add_u32 v12, v28, v29
v_mfma_f32_16x16x32_bf16 v[160:163], a[68:71], a[132:135], v[160:163]
v_xor_b32 v29, 64, v29
v_add_u32 v28, v28, v29
v_mfma_f32_16x16x32_bf16 v[164:167], a[72:75], a[128:131], v[164:167]
ds_read_b64_tr_b16 a[138:139], v9 offset:34816
v_add_u32 v13, 6144, v28
v_mfma_f32_16x16x32_bf16 v[164:167], a[76:79], a[132:135], v[164:167]
v_add_u32 v14, 12288, v12
v_add_u32 v15, 18432, v28
v_mfma_f32_16x16x32_bf16 v[168:171], a[80:83], a[128:131], v[168:171]
ds_read_b64_tr_b16 a[140:141], v9 offset:49152
v_xor_b32 v22, s44, v4
v_mfma_f32_16x16x32_bf16 v[168:171], a[84:87], a[132:135], v[168:171]
v_xor_b32 v23, 32, v22
v_xor_b32 v24, 64, v22
v_mfma_f32_16x16x32_bf16 v[172:175], a[88:91], a[128:131], v[172:175]
ds_read_b64_tr_b16 a[142:143], v9 offset:51200
v_xor_b32 v25, 96, v22
v_mfma_f32_16x16x32_bf16 v[172:175], a[92:95], a[132:135], v[172:175]
v_mfma_f32_16x16x32_bf16 v[176:179], a[96:99], a[128:131], v[176:179]
v_mfma_f32_16x16x32_bf16 v[176:179], a[100:103], a[132:135], v[176:179]
v_mfma_f32_16x16x32_bf16 v[180:183], a[104:107], a[128:131], v[180:183]
ds_read_b128 a[44:47], v3 offset:10240
v_mfma_f32_16x16x32_bf16 v[180:183], a[108:111], a[132:135], v[180:183]
v_mfma_f32_16x16x32_bf16 v[184:187], a[112:115], a[128:131], v[184:187]
ds_read_b128 a[48:51], v2 offset:12288
v_mfma_f32_16x16x32_bf16 v[184:187], a[116:119], a[132:135], v[184:187]
v_mfma_f32_16x16x32_bf16 v[188:191], a[120:123], a[128:131], v[188:191]
v_mfma_f32_16x16x32_bf16 v[188:191], a[124:127], a[132:135], v[188:191]
s_waitcnt lgkmcnt(2)
v_mfma_f32_16x16x32_bf16 v[192:195], a[64:67], a[136:139], v[192:195]
ds_read_b64_tr_b16 a[128:129], v10 offset:32768
v_mfma_f32_16x16x32_bf16 v[192:195], a[68:71], a[140:143], v[192:195]
v_mfma_f32_16x16x32_bf16 v[196:199], a[72:75], a[136:139], v[196:199]
ds_read_b64_tr_b16 a[130:131], v10 offset:34816
v_mfma_f32_16x16x32_bf16 v[196:199], a[76:79], a[140:143], v[196:199]
v_mfma_f32_16x16x32_bf16 v[200:203], a[80:83], a[136:139], v[200:203]
ds_read_b64_tr_b16 a[132:133], v10 offset:49152
v_mfma_f32_16x16x32_bf16 v[200:203], a[84:87], a[140:143], v[200:203]
v_mfma_f32_16x16x32_bf16 v[204:207], a[88:91], a[136:139], v[204:207]
ds_read_b64_tr_b16 a[134:135], v10 offset:51200
v_mfma_f32_16x16x32_bf16 v[204:207], a[92:95], a[140:143], v[204:207]
v_mfma_f32_16x16x32_bf16 v[208:211], a[96:99], a[136:139], v[208:211]
ds_read_b128 a[52:55], v3 offset:12288
v_mfma_f32_16x16x32_bf16 v[208:211], a[100:103], a[140:143], v[208:211]
v_mfma_f32_16x16x32_bf16 v[212:215], a[104:107], a[136:139], v[212:215]
ds_read_b128 a[56:59], v2 offset:14336
v_mfma_f32_16x16x32_bf16 v[212:215], a[108:111], a[140:143], v[212:215]
v_mfma_f32_16x16x32_bf16 v[216:219], a[112:115], a[136:139], v[216:219]
v_mfma_f32_16x16x32_bf16 v[216:219], a[116:119], a[140:143], v[216:219]
v_mfma_f32_16x16x32_bf16 v[220:223], a[120:123], a[136:139], v[220:223]
ds_read_b128 a[60:63], v3 offset:14336
v_mfma_f32_16x16x32_bf16 v[220:223], a[124:127], a[140:143], v[220:223]
s_waitcnt lgkmcnt(3)
v_mfma_f32_16x16x32_bf16 a[192:195], a[64:67], a[128:131], a[192:195]
ds_read_b64_tr_b16 a[136:137], v11 offset:32768
v_mfma_f32_16x16x32_bf16 a[192:195], a[68:71], a[132:135], a[192:195]
v_mfma_f32_16x16x32_bf16 a[196:199], a[72:75], a[128:131], a[196:199]
ds_read_b64_tr_b16 a[138:139], v11 offset:34816
v_mfma_f32_16x16x32_bf16 a[196:199], a[76:79], a[132:135], a[196:199]
v_mfma_f32_16x16x32_bf16 a[200:203], a[80:83], a[128:131], a[200:203]
ds_read_b64_tr_b16 a[140:141], v11 offset:49152
v_mfma_f32_16x16x32_bf16 a[200:203], a[84:87], a[132:135], a[200:203]
v_mfma_f32_16x16x32_bf16 a[204:207], a[88:91], a[128:131], a[204:207]
ds_read_b64_tr_b16 a[142:143], v11 offset:51200
v_mfma_f32_16x16x32_bf16 a[204:207], a[92:95], a[132:135], a[204:207]
v_mfma_f32_16x16x32_bf16 a[208:211], a[96:99], a[128:131], a[208:211]
v_mfma_f32_16x16x32_bf16 a[208:211], a[100:103], a[132:135], a[208:211]
v_mfma_f32_16x16x32_bf16 a[212:215], a[104:107], a[128:131], a[212:215]
v_mfma_f32_16x16x32_bf16 a[212:215], a[108:111], a[132:135], a[212:215]
v_mfma_f32_16x16x32_bf16 a[216:219], a[112:115], a[128:131], a[216:219]
v_mfma_f32_16x16x32_bf16 a[216:219], a[116:119], a[132:135], a[216:219]
v_mfma_f32_16x16x32_bf16 a[220:223], a[120:123], a[128:131], a[220:223]
s_waitcnt vmcnt(4) lgkmcnt(0)
v_mfma_f32_16x16x32_bf16 a[220:223], a[124:127], a[132:135], a[220:223]
s_barrier
v_mfma_f32_16x16x32_bf16 a[224:227], a[64:67], a[136:139], a[224:227]
s_add_u32 m0, s29, 98304
ds_read_b64_tr_b16 a[128:129], v4 offset:0
v_mfma_f32_16x16x32_bf16 a[224:227], a[68:71], a[140:143], a[224:227]
buffer_load_dwordx4 v16, s[12:15], s26 offen offset:0 lds
v_mfma_f32_16x16x32_bf16 a[228:231], a[72:75], a[136:139], a[228:231]
ds_read_b64_tr_b16 a[130:131], v4 offset:2048
v_mfma_f32_16x16x32_bf16 a[228:231], a[76:79], a[140:143], a[228:231]
v_mfma_f32_16x16x32_bf16 a[232:235], a[80:83], a[136:139], a[232:235]
ds_read_b64_tr_b16 a[132:133], v4 offset:16384
v_mfma_f32_16x16x32_bf16 a[232:235], a[84:87], a[140:143], a[232:235]
buffer_load_dwordx4 v17, s[12:15], s26 offen offset:1024 lds
v_mfma_f32_16x16x32_bf16 a[236:239], a[88:91], a[136:139], a[236:239]
ds_read_b64_tr_b16 a[134:135], v4 offset:18432
v_mfma_f32_16x16x32_bf16 a[236:239], a[92:95], a[140:143], a[236:239]
v_mfma_f32_16x16x32_bf16 a[240:243], a[96:99], a[136:139], a[240:243]
v_mfma_f32_16x16x32_bf16 a[240:243], a[100:103], a[140:143], a[240:243]
buffer_load_dwordx4 v18, s[12:15], s26 offen offset:2048 lds
v_mfma_f32_16x16x32_bf16 a[244:247], a[104:107], a[136:139], a[244:247]
v_mfma_f32_16x16x32_bf16 a[244:247], a[108:111], a[140:143], a[244:247]
v_mfma_f32_16x16x32_bf16 a[248:251], a[112:115], a[136:139], a[248:251]
v_mfma_f32_16x16x32_bf16 a[248:251], a[116:119], a[140:143], a[248:251]
buffer_load_dwordx4 v19, s[12:15], s26 offen offset:3072 lds
v_mfma_f32_16x16x32_bf16 a[252:255], a[120:123], a[136:139], a[252:255]
s_add_u32 s26, s26, 524288
v_mfma_f32_16x16x32_bf16 a[252:255], a[124:127], a[140:143], a[252:255]
s_waitcnt lgkmcnt(0)
v_mfma_f32_16x16x32_bf16 v[32:35], a[0:3], a[128:131], v[32:35]
s_add_u32 m0, s29, 114688
ds_read_b64_tr_b16 a[136:137], v5 offset:0
v_mfma_f32_16x16x32_bf16 v[32:35], a[4:7], a[132:135], v[32:35]
buffer_load_dwordx4 v16, s[12:15], s27 offen offset:0 lds
v_mfma_f32_16x16x32_bf16 v[36:39], a[8:11], a[128:131], v[36:39]
ds_read_b64_tr_b16 a[138:139], v5 offset:2048
v_mfma_f32_16x16x32_bf16 v[36:39], a[12:15], a[132:135], v[36:39]
v_mfma_f32_16x16x32_bf16 v[40:43], a[16:19], a[128:131], v[40:43]
ds_read_b64_tr_b16 a[140:141], v5 offset:16384
v_mfma_f32_16x16x32_bf16 v[40:43], a[20:23], a[132:135], v[40:43]
buffer_load_dwordx4 v17, s[12:15], s27 offen offset:1024 lds
v_mfma_f32_16x16x32_bf16 v[44:47], a[24:27], a[128:131], v[44:47]
ds_read_b64_tr_b16 a[142:143], v5 offset:18432
v_mfma_f32_16x16x32_bf16 v[44:47], a[28:31], a[132:135], v[44:47]
v_mfma_f32_16x16x32_bf16 v[48:51], a[32:35], a[128:131], v[48:51]
ds_read_b128 a[64:67], v2 offset:32768
v_mfma_f32_16x16x32_bf16 v[48:51], a[36:39], a[132:135], v[48:51]
buffer_load_dwordx4 v18, s[12:15], s27 offen offset:2048 lds
v_mfma_f32_16x16x32_bf16 v[52:55], a[40:43], a[128:131], v[52:55]
ds_read_b128 a[68:71], v3 offset:32768
v_mfma_f32_16x16x32_bf16 v[52:55], a[44:47], a[132:135], v[52:55]
v_mfma_f32_16x16x32_bf16 v[56:59], a[48:51], a[128:131], v[56:59]
v_mfma_f32_16x16x32_bf16 v[56:59], a[52:55], a[132:135], v[56:59]
buffer_load_dwordx4 v19, s[12:15], s27 offen offset:3072 lds
v_mfma_f32_16x16x32_bf16 v[60:63], a[56:59], a[128:131], v[60:63]
s_add_u32 s27, s27, 524288
ds_read_b128 a[72:75], v2 offset:34816
v_mfma_f32_16x16x32_bf16 v[60:63], a[60:63], a[132:135], v[60:63]
s_waitcnt lgkmcnt(3)
v_mfma_f32_16x16x32_bf16 v[64:67], a[0:3], a[136:139], v[64:67]
s_add_u32 m0, s28, 0
ds_read_b64_tr_b16 a[128:129], v6 offset:0
v_mfma_f32_16x16x32_bf16 v[64:67], a[4:7], a[140:143], v[64:67]
buffer_load_dwordx4 v12, s[8:11], s24 offen offset:0 lds
v_mfma_f32_16x16x32_bf16 v[68:71], a[8:11], a[136:139], v[68:71]
ds_read_b64_tr_b16 a[130:131], v6 offset:2048
v_mfma_f32_16x16x32_bf16 v[68:71], a[12:15], a[140:143], v[68:71]
v_mfma_f32_16x16x32_bf16 v[72:75], a[16:19], a[136:139], v[72:75]
ds_read_b64_tr_b16 a[132:133], v6 offset:16384
v_mfma_f32_16x16x32_bf16 v[72:75], a[20:23], a[140:143], v[72:75]
buffer_load_dwordx4 v13, s[8:11], s24 offen offset:1024 lds
v_mfma_f32_16x16x32_bf16 v[76:79], a[24:27], a[136:139], v[76:79]
ds_read_b64_tr_b16 a[134:135], v6 offset:18432
v_mfma_f32_16x16x32_bf16 v[76:79], a[28:31], a[140:143], v[76:79]
v_mfma_f32_16x16x32_bf16 v[80:83], a[32:35], a[136:139], v[80:83]
ds_read_b128 a[76:79], v3 offset:34816
v_mfma_f32_16x16x32_bf16 v[80:83], a[36:39], a[140:143], v[80:83]
buffer_load_dwordx4 v14, s[8:11], s24 offen offset:2048 lds
v_mfma_f32_16x16x32_bf16 v[84:87], a[40:43], a[136:139], v[84:87]
v_mfma_f32_16x16x32_bf16 v[84:87], a[44:47], a[140:143], v[84:87]
v_mfma_f32_16x16x32_bf16 v[88:91], a[48:51], a[136:139], v[88:91]
ds_read_b128 a[80:83], v2 offset:36864
v_mfma_f32_16x16x32_bf16 v[88:91], a[52:55], a[140:143], v[88:91]
buffer_load_dwordx4 v15, s[8:11], s24 offen offset:3072 lds
v_mfma_f32_16x16x32_bf16 v[92:95], a[56:59], a[136:139], v[92:95]
s_add_u32 s24, s24, 128
ds_read_b128 a[84:87], v3 offset:36864
v_mfma_f32_16x16x32_bf16 v[92:95], a[60:63], a[140:143], v[92:95]
s_waitcnt lgkmcnt(3)
s_mov_b64 s[12:13], s[80:81]
v_mfma_f32_16x16x32_bf16 v[96:99], a[0:3], a[128:131], v[96:99]
s_mov_b32 s14, 3670016
s_add_u32 m0, s28, 16384
ds_read_b64_tr_b16 a[136:137], v7 offset:0
v_mfma_f32_16x16x32_bf16 v[96:99], a[4:7], a[132:135], v[96:99]
buffer_load_dwordx4 v12, s[8:11], s24 offen offset:0 lds
v_mfma_f32_16x16x32_bf16 v[100:103], a[8:11], a[128:131], v[100:103]
ds_read_b64_tr_b16 a[138:139], v7 offset:2048
v_mfma_f32_16x16x32_bf16 v[100:103], a[12:15], a[132:135], v[100:103]
v_mfma_f32_16x16x32_bf16 v[104:107], a[16:19], a[128:131], v[104:107]
ds_read_b64_tr_b16 a[140:141], v7 offset:16384
v_mfma_f32_16x16x32_bf16 v[104:107], a[20:23], a[132:135], v[104:107]
buffer_load_dwordx4 v13, s[8:11], s24 offen offset:1024 lds
v_mfma_f32_16x16x32_bf16 v[108:111], a[24:27], a[128:131], v[108:111]
ds_read_b64_tr_b16 a[142:143], v7 offset:18432
v_mfma_f32_16x16x32_bf16 v[108:111], a[28:31], a[132:135], v[108:111]
v_mfma_f32_16x16x32_bf16 v[112:115], a[32:35], a[128:131], v[112:115]
v_mfma_f32_16x16x32_bf16 v[112:115], a[36:39], a[132:135], v[112:115]
buffer_load_dwordx4 v14, s[8:11], s24 offen offset:2048 lds
v_mfma_f32_16x16x32_bf16 v[116:119], a[40:43], a[128:131], v[116:119]
ds_read_b128 a[88:91], v2 offset:38912
v_mfma_f32_16x16x32_bf16 v[116:119], a[44:47], a[132:135], v[116:119]
v_mfma_f32_16x16x32_bf16 v[120:123], a[48:51], a[128:131], v[120:123]
ds_read_b128 a[92:95], v3 offset:38912
v_mfma_f32_16x16x32_bf16 v[120:123], a[52:55], a[132:135], v[120:123]
buffer_load_dwordx4 v15, s[8:11], s24 offen offset:3072 lds
v_mfma_f32_16x16x32_bf16 v[124:127], a[56:59], a[128:131], v[124:127]
s_add_u32 s24, s24, 128
v_mfma_f32_16x16x32_bf16 v[124:127], a[60:63], a[132:135], v[124:127]
s_waitcnt lgkmcnt(2)
s_sub_u32 s26, s26, 8388608
v_mfma_f32_16x16x32_bf16 v[128:131], a[0:3], a[136:139], v[128:131]
s_sub_u32 s27, s27, 8388608
s_add_u32 m0, s29, 131072
ds_read_b64_tr_b16 a[128:129], v8 offset:0
v_mfma_f32_16x16x32_bf16 v[128:131], a[4:7], a[140:143], v[128:131]
buffer_load_dwordx4 v16, s[12:15], s26 offen offset:0 lds
v_mfma_f32_16x16x32_bf16 v[132:135], a[8:11], a[136:139], v[132:135]
ds_read_b64_tr_b16 a[130:131], v8 offset:2048
v_mfma_f32_16x16x32_bf16 v[132:135], a[12:15], a[140:143], v[132:135]
v_mfma_f32_16x16x32_bf16 v[136:139], a[16:19], a[136:139], v[136:139]
ds_read_b64_tr_b16 a[132:133], v8 offset:16384
v_mfma_f32_16x16x32_bf16 v[136:139], a[20:23], a[140:143], v[136:139]
buffer_load_dwordx4 v17, s[12:15], s26 offen offset:1024 lds
v_mfma_f32_16x16x32_bf16 v[140:143], a[24:27], a[136:139], v[140:143]
ds_read_b64_tr_b16 a[134:135], v8 offset:18432
v_mfma_f32_16x16x32_bf16 v[140:143], a[28:31], a[140:143], v[140:143]
v_mfma_f32_16x16x32_bf16 v[144:147], a[32:35], a[136:139], v[144:147]
ds_read_b128 a[96:99], v2 offset:40960
v_mfma_f32_16x16x32_bf16 v[144:147], a[36:39], a[140:143], v[144:147]
buffer_load_dwordx4 v18, s[12:15], s26 offen offset:2048 lds
v_mfma_f32_16x16x32_bf16 v[148:151], a[40:43], a[136:139], v[148:151]
v_mfma_f32_16x16x32_bf16 v[148:151], a[44:47], a[140:143], v[148:151]
v_mfma_f32_16x16x32_bf16 v[152:155], a[48:51], a[136:139], v[152:155]
ds_read_b128 a[100:103], v3 offset:40960
v_mfma_f32_16x16x32_bf16 v[152:155], a[52:55], a[140:143], v[152:155]
buffer_load_dwordx4 v19, s[12:15], s26 offen offset:3072 lds
v_mfma_f32_16x16x32_bf16 v[156:159], a[56:59], a[136:139], v[156:159]
s_add_u32 s26, s26, 524288
ds_read_b128 a[104:107], v2 offset:43008
v_mfma_f32_16x16x32_bf16 v[156:159], a[60:63], a[140:143], v[156:159]
s_waitcnt lgkmcnt(3)
v_mfma_f32_16x16x32_bf16 v[160:163], a[0:3], a[128:131], v[160:163]
s_add_u32 m0, s29, 147456
ds_read_b64_tr_b16 a[136:137], v9 offset:0
v_mfma_f32_16x16x32_bf16 v[160:163], a[4:7], a[132:135], v[160:163]
buffer_load_dwordx4 v16, s[12:15], s27 offen offset:0 lds
v_mfma_f32_16x16x32_bf16 v[164:167], a[8:11], a[128:131], v[164:167]
ds_read_b64_tr_b16 a[138:139], v9 offset:2048
v_mfma_f32_16x16x32_bf16 v[164:167], a[12:15], a[132:135], v[164:167]
v_mfma_f32_16x16x32_bf16 v[168:171], a[16:19], a[128:131], v[168:171]
ds_read_b64_tr_b16 a[140:141], v9 offset:16384
v_mfma_f32_16x16x32_bf16 v[168:171], a[20:23], a[132:135], v[168:171]
buffer_load_dwordx4 v17, s[12:15], s27 offen offset:1024 lds
v_mfma_f32_16x16x32_bf16 v[172:175], a[24:27], a[128:131], v[172:175]
ds_read_b64_tr_b16 a[142:143], v9 offset:18432
v_mfma_f32_16x16x32_bf16 v[172:175], a[28:31], a[132:135], v[172:175]
v_mfma_f32_16x16x32_bf16 v[176:179], a[32:35], a[128:131], v[176:179]
v_mfma_f32_16x16x32_bf16 v[176:179], a[36:39], a[132:135], v[176:179]
buffer_load_dwordx4 v18, s[12:15], s27 offen offset:2048 lds
v_mfma_f32_16x16x32_bf16 v[180:183], a[40:43], a[128:131], v[180:183]
ds_read_b128 a[108:111], v3 offset:43008
v_mfma_f32_16x16x32_bf16 v[180:183], a[44:47], a[132:135], v[180:183]
v_mfma_f32_16x16x32_bf16 v[184:187], a[48:51], a[128:131], v[184:187]
ds_read_b128 a[112:115], v2 offset:45056
v_mfma_f32_16x16x32_bf16 v[184:187], a[52:55], a[132:135], v[184:187]
buffer_load_dwordx4 v19, s[12:15], s27 offen offset:3072 lds
v_mfma_f32_16x16x32_bf16 v[188:191], a[56:59], a[128:131], v[188:191]
s_add_u32 s27, s27, 524288
v_mfma_f32_16x16x32_bf16 v[188:191], a[60:63], a[132:135], v[188:191]
s_waitcnt lgkmcnt(2)
v_mfma_f32_16x16x32_bf16 v[192:195], a[0:3], a[136:139], v[192:195]
ds_read_b64_tr_b16 a[128:129], v10 offset:0
v_mfma_f32_16x16x32_bf16 v[192:195], a[4:7], a[140:143], v[192:195]
v_mfma_f32_16x16x32_bf16 v[196:199], a[8:11], a[136:139], v[196:199]
ds_read_b64_tr_b16 a[130:131], v10 offset:2048
v_mfma_f32_16x16x32_bf16 v[196:199], a[12:15], a[140:143], v[196:199]
v_mfma_f32_16x16x32_bf16 v[200:203], a[16:19], a[136:139], v[200:203]
ds_read_b64_tr_b16 a[132:133], v10 offset:16384
v_mfma_f32_16x16x32_bf16 v[200:203], a[20:23], a[140:143], v[200:203]
v_mfma_f32_16x16x32_bf16 v[204:207], a[24:27], a[136:139], v[204:207]
ds_read_b64_tr_b16 a[134:135], v10 offset:18432
v_mfma_f32_16x16x32_bf16 v[204:207], a[28:31], a[140:143], v[204:207]
v_mfma_f32_16x16x32_bf16 v[208:211], a[32:35], a[136:139], v[208:211]
ds_read_b128 a[116:119], v3 offset:45056
v_mfma_f32_16x16x32_bf16 v[208:211], a[36:39], a[140:143], v[208:211]
v_mfma_f32_16x16x32_bf16 v[212:215], a[40:43], a[136:139], v[212:215]
ds_read_b128 a[120:123], v2 offset:47104
v_mfma_f32_16x16x32_bf16 v[212:215], a[44:47], a[140:143], v[212:215]
v_mfma_f32_16x16x32_bf16 v[216:219], a[48:51], a[136:139], v[216:219]
v_mfma_f32_16x16x32_bf16 v[216:219], a[52:55], a[140:143], v[216:219]
v_mfma_f32_16x16x32_bf16 v[220:223], a[56:59], a[136:139], v[220:223]
ds_read_b128 a[124:127], v3 offset:47104
v_mfma_f32_16x16x32_bf16 v[220:223], a[60:63], a[140:143], v[220:223]
s_waitcnt lgkmcnt(3)
v_mfma_f32_16x16x32_bf16 a[192:195], a[0:3], a[128:131], a[192:195]
ds_read_b64_tr_b16 a[136:137], v11 offset:0
v_mfma_f32_16x16x32_bf16 a[192:195], a[4:7], a[132:135], a[192:195]
v_mfma_f32_16x16x32_bf16 a[196:199], a[8:11], a[128:131], a[196:199]
ds_read_b64_tr_b16 a[138:139], v11 offset:2048
v_mfma_f32_16x16x32_bf16 a[196:199], a[12:15], a[132:135], a[196:199]
v_mfma_f32_16x16x32_bf16 a[200:203], a[16:19], a[128:131], a[200:203]
ds_read_b64_tr_b16 a[140:141], v11 offset:16384
v_mfma_f32_16x16x32_bf16 a[200:203], a[20:23], a[132:135], a[200:203]
v_mfma_f32_16x16x32_bf16 a[204:207], a[24:27], a[128:131], a[204:207]
ds_read_b64_tr_b16 a[142:143], v11 offset:18432
v_mfma_f32_16x16x32_bf16 a[204:207], a[28:31], a[132:135], a[204:207]
v_mfma_f32_16x16x32_bf16 a[208:211], a[32:35], a[128:131], a[208:211]
v_mfma_f32_16x16x32_bf16 a[208:211], a[36:39], a[132:135], a[208:211]
v_mfma_f32_16x16x32_bf16 a[212:215], a[40:43], a[128:131], a[212:215]
v_mfma_f32_16x16x32_bf16 a[212:215], a[44:47], a[132:135], a[212:215]
v_mfma_f32_16x16x32_bf16 a[216:219], a[48:51], a[128:131], a[216:219]
v_mfma_f32_16x16x32_bf16 a[216:219], a[52:55], a[132:135], a[216:219]
v_mfma_f32_16x16x32_bf16 a[220:223], a[56:59], a[128:131], a[220:223]
s_waitcnt vmcnt(12) lgkmcnt(0)
v_mfma_f32_16x16x32_bf16 a[220:223], a[60:63], a[132:135], a[220:223]
s_barrier
v_mfma_f32_16x16x32_bf16 a[224:227], a[0:3], a[136:139], a[224:227]
s_add_u32 m0, s28, 32768
ds_read_b64_tr_b16 a[128:129], v4 offset:32768
v_mfma_f32_16x16x32_bf16 a[224:227], a[4:7], a[140:143], a[224:227]
s_lshr_b32 s22, s3, 1
buffer_load_dwordx4 v12, s[8:11], s24 offen offset:0 lds
v_mfma_f32_16x16x32_bf16 a[228:231], a[8:11], a[136:139], a[228:231]
s_lshl_b32 s22, s22, 14
ds_read_b64_tr_b16 a[130:131], v4 offset:34816
v_subrev_u32 v2, s22, v2
v_mfma_f32_16x16x32_bf16 a[228:231], a[12:15], a[140:143], a[228:231]
v_subrev_u32 v3, s22, v3
v_mfma_f32_16x16x32_bf16 a[232:235], a[16:19], a[136:139], a[232:235]
ds_read_b64_tr_b16 a[132:133], v4 offset:49152
v_mfma_f32_16x16x32_bf16 a[232:235], a[20:23], a[140:143], a[232:235]
buffer_load_dwordx4 v13, s[8:11], s24 offen offset:1024 lds
v_mfma_f32_16x16x32_bf16 a[236:239], a[24:27], a[136:139], a[236:239]
ds_read_b64_tr_b16 a[134:135], v4 offset:51200
v_mfma_f32_16x16x32_bf16 a[236:239], a[28:31], a[140:143], a[236:239]
v_mfma_f32_16x16x32_bf16 a[240:243], a[32:35], a[136:139], a[240:243]
v_mfma_f32_16x16x32_bf16 a[240:243], a[36:39], a[140:143], a[240:243]
buffer_load_dwordx4 v14, s[8:11], s24 offen offset:2048 lds
v_mfma_f32_16x16x32_bf16 a[244:247], a[40:43], a[136:139], a[244:247]
v_mfma_f32_16x16x32_bf16 a[244:247], a[44:47], a[140:143], a[244:247]
v_mfma_f32_16x16x32_bf16 a[248:251], a[48:51], a[136:139], a[248:251]
v_mfma_f32_16x16x32_bf16 a[248:251], a[52:55], a[140:143], a[248:251]
buffer_load_dwordx4 v15, s[8:11], s24 offen offset:3072 lds
v_mfma_f32_16x16x32_bf16 a[252:255], a[56:59], a[136:139], a[252:255]
s_add_u32 s24, s24, 128
v_mfma_f32_16x16x32_bf16 a[252:255], a[60:63], a[140:143], a[252:255]
s_waitcnt lgkmcnt(0)
v_mfma_f32_16x16x32_bf16 v[32:35], a[64:67], a[128:131], v[32:35]
s_add_u32 m0, s29, 65536
ds_read_b64_tr_b16 a[136:137], v5 offset:32768
v_mfma_f32_16x16x32_bf16 v[32:35], a[68:71], a[132:135], v[32:35]
buffer_load_dwordx4 v16, s[12:15], s26 offen offset:0 lds
v_mfma_f32_16x16x32_bf16 v[36:39], a[72:75], a[128:131], v[36:39]
ds_read_b64_tr_b16 a[138:139], v5 offset:34816
v_mfma_f32_16x16x32_bf16 v[36:39], a[76:79], a[132:135], v[36:39]
v_mfma_f32_16x16x32_bf16 v[40:43], a[80:83], a[128:131], v[40:43]
ds_read_b64_tr_b16 a[140:141], v5 offset:49152
v_mfma_f32_16x16x32_bf16 v[40:43], a[84:87], a[132:135], v[40:43]
buffer_load_dwordx4 v17, s[12:15], s26 offen offset:1024 lds
v_mfma_f32_16x16x32_bf16 v[44:47], a[88:91], a[128:131], v[44:47]
ds_read_b64_tr_b16 a[142:143], v5 offset:51200
v_mfma_f32_16x16x32_bf16 v[44:47], a[92:95], a[132:135], v[44:47]
v_mfma_f32_16x16x32_bf16 v[48:51], a[96:99], a[128:131], v[48:51]
ds_read_b128 a[0:3], v2 offset:0
v_cvt_pk_bf16_f32 v32, v32, v33
v_mfma_f32_16x16x32_bf16 v[48:51], a[100:103], a[132:135], v[48:51]
buffer_load_dwordx4 v18, s[12:15], s26 offen offset:2048 lds
v_mfma_f32_16x16x32_bf16 v[52:55], a[104:107], a[128:131], v[52:55]
ds_read_b128 a[4:7], v3 offset:0
v_cvt_pk_bf16_f32 v33, v34, v35
v_mfma_f32_16x16x32_bf16 v[52:55], a[108:111], a[132:135], v[52:55]
v_cvt_pk_bf16_f32 v34, v36, v37
v_cvt_pk_bf16_f32 v35, v38, v39
v_mfma_f32_16x16x32_bf16 v[56:59], a[112:115], a[128:131], v[56:59]
v_cvt_pk_bf16_f32 v40, v40, v41
v_cvt_pk_bf16_f32 v41, v42, v43
v_mfma_f32_16x16x32_bf16 v[56:59], a[116:119], a[132:135], v[56:59]
buffer_load_dwordx4 v19, s[12:15], s26 offen offset:3072 lds
v_mfma_f32_16x16x32_bf16 v[60:63], a[120:123], a[128:131], v[60:63]
s_add_u32 s26, s26, 524288
ds_read_b128 a[8:11], v2 offset:2048
v_cvt_pk_bf16_f32 v42, v44, v45
v_mfma_f32_16x16x32_bf16 v[60:63], a[124:127], a[132:135], v[60:63]
s_waitcnt lgkmcnt(3)
v_cvt_pk_bf16_f32 v43, v46, v47
v_mfma_f32_16x16x32_bf16 v[64:67], a[64:67], a[136:139], v[64:67]
s_add_u32 m0, s29, 81920
ds_read_b64_tr_b16 a[128:129], v6 offset:32768
v_cvt_pk_bf16_f32 v48, v48, v49
v_mfma_f32_16x16x32_bf16 v[64:67], a[68:71], a[140:143], v[64:67]
buffer_load_dwordx4 v16, s[12:15], s27 offen offset:0 lds
v_mfma_f32_16x16x32_bf16 v[68:71], a[72:75], a[136:139], v[68:71]
ds_read_b64_tr_b16 a[130:131], v6 offset:34816
v_cvt_pk_bf16_f32 v49, v50, v51
v_mfma_f32_16x16x32_bf16 v[68:71], a[76:79], a[140:143], v[68:71]
v_cvt_pk_bf16_f32 v50, v52, v53
v_cvt_pk_bf16_f32 v51, v54, v55
v_mfma_f32_16x16x32_bf16 v[72:75], a[80:83], a[136:139], v[72:75]
ds_read_b64_tr_b16 a[132:133], v6 offset:49152
v_cvt_pk_bf16_f32 v56, v56, v57
v_mfma_f32_16x16x32_bf16 v[72:75], a[84:87], a[140:143], v[72:75]
buffer_load_dwordx4 v17, s[12:15], s27 offen offset:1024 lds
v_mfma_f32_16x16x32_bf16 v[76:79], a[88:91], a[136:139], v[76:79]
ds_read_b64_tr_b16 a[134:135], v6 offset:51200
v_cvt_pk_bf16_f32 v57, v58, v59
v_mfma_f32_16x16x32_bf16 v[76:79], a[92:95], a[140:143], v[76:79]
v_cvt_pk_bf16_f32 v58, v60, v61
v_cvt_pk_bf16_f32 v59, v62, v63
v_mfma_f32_16x16x32_bf16 v[80:83], a[96:99], a[136:139], v[80:83]
ds_read_b128 a[12:15], v3 offset:2048
v_cvt_pk_bf16_f32 v64, v64, v65
v_mfma_f32_16x16x32_bf16 v[80:83], a[100:103], a[140:143], v[80:83]
buffer_load_dwordx4 v18, s[12:15], s27 offen offset:2048 lds
v_mfma_f32_16x16x32_bf16 v[84:87], a[104:107], a[136:139], v[84:87]
v_cvt_pk_bf16_f32 v65, v66, v67
v_cvt_pk_bf16_f32 v66, v68, v69
v_mfma_f32_16x16x32_bf16 v[84:87], a[108:111], a[140:143], v[84:87]
v_cvt_pk_bf16_f32 v67, v70, v71
v_mfma_f32_16x16x32_bf16 v[88:91], a[112:115], a[136:139], v[88:91]
ds_read_b128 a[16:19], v2 offset:4096
v_cvt_pk_bf16_f32 v72, v72, v73
v_mfma_f32_16x16x32_bf16 v[88:91], a[116:119], a[140:143], v[88:91]
buffer_load_dwordx4 v19, s[12:15], s27 offen offset:3072 lds
v_mfma_f32_16x16x32_bf16 v[92:95], a[120:123], a[136:139], v[92:95]
s_add_u32 s27, s27, 524288
ds_read_b128 a[20:23], v3 offset:4096
v_cvt_pk_bf16_f32 v73, v74, v75
v_mfma_f32_16x16x32_bf16 v[92:95], a[124:127], a[140:143], v[92:95]
s_waitcnt lgkmcnt(3)
v_cvt_pk_bf16_f32 v74, v76, v77
v_cvt_pk_bf16_f32 v75, v78, v79
v_mfma_f32_16x16x32_bf16 v[96:99], a[64:67], a[128:131], v[96:99]
s_add_u32 m0, s28, 49152
ds_read_b64_tr_b16 a[136:137], v7 offset:32768
v_cvt_pk_bf16_f32 v80, v80, v81
v_mfma_f32_16x16x32_bf16 v[96:99], a[68:71], a[132:135], v[96:99]
PAD_27:
s_cbranch_execz PAD_31
buffer_load_dwordx4 v12, s[8:11], s24 offen offset:0 lds
v_mfma_f32_16x16x32_bf16 v[100:103], a[72:75], a[128:131], v[100:103]
ds_read_b64_tr_b16 a[138:139], v7 offset:34816
v_cvt_pk_bf16_f32 v81, v82, v83
v_mfma_f32_16x16x32_bf16 v[100:103], a[76:79], a[132:135], v[100:103]
v_cvt_pk_bf16_f32 v82, v84, v85
v_cvt_pk_bf16_f32 v83, v86, v87
v_mfma_f32_16x16x32_bf16 v[104:107], a[80:83], a[128:131], v[104:107]
ds_read_b64_tr_b16 a[140:141], v7 offset:49152
v_cvt_pk_bf16_f32 v88, v88, v89
v_mfma_f32_16x16x32_bf16 v[104:107], a[84:87], a[132:135], v[104:107]
buffer_load_dwordx4 v13, s[8:11], s24 offen offset:1024 lds
v_mfma_f32_16x16x32_bf16 v[108:111], a[88:91], a[128:131], v[108:111]
ds_read_b64_tr_b16 a[142:143], v7 offset:51200
v_cvt_pk_bf16_f32 v89, v90, v91
v_mfma_f32_16x16x32_bf16 v[108:111], a[92:95], a[132:135], v[108:111]
v_cvt_pk_bf16_f32 v90, v92, v93
v_cvt_pk_bf16_f32 v91, v94, v95
v_mfma_f32_16x16x32_bf16 v[112:115], a[96:99], a[128:131], v[112:115]
v_cvt_pk_bf16_f32 v96, v96, v97
v_cvt_pk_bf16_f32 v97, v98, v99
v_mfma_f32_16x16x32_bf16 v[112:115], a[100:103], a[132:135], v[112:115]
buffer_load_dwordx4 v14, s[8:11], s24 offen offset:2048 lds
v_mfma_f32_16x16x32_bf16 v[116:119], a[104:107], a[128:131], v[116:119]
ds_read_b128 a[24:27], v2 offset:6144
v_cvt_pk_bf16_f32 v98, v100, v101
v_mfma_f32_16x16x32_bf16 v[116:119], a[108:111], a[132:135], v[116:119]
buffer_store_dwordx4 v[32:35], v1, s[4:7], s31 offen sc1
v_mfma_f32_16x16x32_bf16 v[120:123], a[112:115], a[128:131], v[120:123]
s_add_u32 s31, s31, s32
ds_read_b128 a[28:31], v3 offset:6144
v_cvt_pk_bf16_f32 v99, v102, v103
v_mfma_f32_16x16x32_bf16 v[120:123], a[116:119], a[132:135], v[120:123]
buffer_load_dwordx4 v15, s[8:11], s24 offen offset:3072 lds
v_mfma_f32_16x16x32_bf16 v[124:127], a[120:123], a[128:131], v[124:127]
s_add_u32 s24, s24, 128
v_cvt_pk_bf16_f32 v104, v104, v105
v_cvt_pk_bf16_f32 v105, v106, v107
v_mfma_f32_16x16x32_bf16 v[124:127], a[124:127], a[132:135], v[124:127]
s_waitcnt lgkmcnt(2)
v_cvt_pk_bf16_f32 v106, v108, v109
v_cvt_pk_bf16_f32 v107, v110, v111
v_mfma_f32_16x16x32_bf16 v[128:131], a[64:67], a[136:139], v[128:131]
ds_read_b64_tr_b16 a[128:129], v8 offset:32768
v_cvt_pk_bf16_f32 v112, v112, v113
v_mfma_f32_16x16x32_bf16 v[128:131], a[68:71], a[140:143], v[128:131]
v_cvt_pk_bf16_f32 v113, v114, v115
v_cvt_pk_bf16_f32 v114, v116, v117
v_mfma_f32_16x16x32_bf16 v[132:135], a[72:75], a[136:139], v[132:135]
ds_read_b64_tr_b16 a[130:131], v8 offset:34816
v_cvt_pk_bf16_f32 v115, v118, v119
v_mfma_f32_16x16x32_bf16 v[132:135], a[76:79], a[140:143], v[132:135]
buffer_store_dwordx4 v[40:43], v1, s[4:7], s31 offen sc1
v_mfma_f32_16x16x32_bf16 v[136:139], a[80:83], a[136:139], v[136:139]
s_add_u32 s31, s31, s33
ds_read_b64_tr_b16 a[132:133], v8 offset:49152
v_cvt_pk_bf16_f32 v120, v120, v121
v_mfma_f32_16x16x32_bf16 v[136:139], a[84:87], a[140:143], v[136:139]
v_cvt_pk_bf16_f32 v121, v122, v123
v_cvt_pk_bf16_f32 v122, v124, v125
v_mfma_f32_16x16x32_bf16 v[140:143], a[88:91], a[136:139], v[140:143]
ds_read_b64_tr_b16 a[134:135], v8 offset:51200
v_cvt_pk_bf16_f32 v123, v126, v127
v_mfma_f32_16x16x32_bf16 v[140:143], a[92:95], a[140:143], v[140:143]
v_mfma_f32_16x16x32_bf16 v[144:147], a[96:99], a[136:139], v[144:147]
ds_read_b128 a[32:35], v2 offset:8192
v_cvt_pk_bf16_f32 v128, v128, v129
v_mfma_f32_16x16x32_bf16 v[144:147], a[100:103], a[140:143], v[144:147]
v_cvt_pk_bf16_f32 v129, v130, v131
v_cvt_pk_bf16_f32 v130, v132, v133
v_mfma_f32_16x16x32_bf16 v[148:151], a[104:107], a[136:139], v[148:151]
v_cvt_pk_bf16_f32 v131, v134, v135
v_mfma_f32_16x16x32_bf16 v[148:151], a[108:111], a[140:143], v[148:151]
v_mfma_f32_16x16x32_bf16 v[152:155], a[112:115], a[136:139], v[152:155]
ds_read_b128 a[36:39], v3 offset:8192
v_cvt_pk_bf16_f32 v136, v136, v137
v_mfma_f32_16x16x32_bf16 v[152:155], a[116:119], a[140:143], v[152:155]
v_cvt_pk_bf16_f32 v137, v138, v139
v_cvt_pk_bf16_f32 v138, v140, v141
v_mfma_f32_16x16x32_bf16 v[156:159], a[120:123], a[136:139], v[156:159]
ds_read_b128 a[40:43], v2 offset:10240
v_cvt_pk_bf16_f32 v139, v142, v143
v_mfma_f32_16x16x32_bf16 v[156:159], a[124:127], a[140:143], v[156:159]
s_waitcnt lgkmcnt(3)
buffer_store_dwordx4 v[48:51], v1, s[4:7], s31 offen sc1
v_mfma_f32_16x16x32_bf16 v[160:163], a[64:67], a[128:131], v[160:163]
s_add_u32 s31, s31, s32
ds_read_b64_tr_b16 a[136:137], v9 offset:32768
v_cvt_pk_bf16_f32 v144, v144, v145
v_mfma_f32_16x16x32_bf16 v[160:163], a[68:71], a[132:135], v[160:163]
v_cvt_pk_bf16_f32 v145, v146, v147
v_cvt_pk_bf16_f32 v146, v148, v149
v_mfma_f32_16x16x32_bf16 v[164:167], a[72:75], a[128:131], v[164:167]
ds_read_b64_tr_b16 a[138:139], v9 offset:34816
v_cvt_pk_bf16_f32 v147, v150, v151
v_mfma_f32_16x16x32_bf16 v[164:167], a[76:79], a[132:135], v[164:167]
v_mfma_f32_16x16x32_bf16 v[168:171], a[80:83], a[128:131], v[168:171]
ds_read_b64_tr_b16 a[140:141], v9 offset:49152
v_cvt_pk_bf16_f32 v152, v152, v153
v_mfma_f32_16x16x32_bf16 v[168:171], a[84:87], a[132:135], v[168:171]
v_cvt_pk_bf16_f32 v153, v154, v155
v_cvt_pk_bf16_f32 v154, v156, v157
v_mfma_f32_16x16x32_bf16 v[172:175], a[88:91], a[128:131], v[172:175]
ds_read_b64_tr_b16 a[142:143], v9 offset:51200
v_cvt_pk_bf16_f32 v155, v158, v159
v_mfma_f32_16x16x32_bf16 v[172:175], a[92:95], a[132:135], v[172:175]
v_mfma_f32_16x16x32_bf16 v[176:179], a[96:99], a[128:131], v[176:179]
buffer_store_dwordx4 v[56:59], v1, s[4:7], s31 offen sc1
v_mfma_f32_16x16x32_bf16 v[176:179], a[100:103], a[132:135], v[176:179]
s_add_u32 s31, s31, s34
v_cvt_pk_bf16_f32 v160, v160, v161
v_cvt_pk_bf16_f32 v161, v162, v163
v_mfma_f32_16x16x32_bf16 v[180:183], a[104:107], a[128:131], v[180:183]
ds_read_b128 a[44:47], v3 offset:10240
v_cvt_pk_bf16_f32 v162, v164, v165
v_mfma_f32_16x16x32_bf16 v[180:183], a[108:111], a[132:135], v[180:183]
v_cvt_pk_bf16_f32 v163, v166, v167
v_mfma_f32_16x16x32_bf16 v[184:187], a[112:115], a[128:131], v[184:187]
ds_read_b128 a[48:51], v2 offset:12288
v_cvt_pk_bf16_f32 v168, v168, v169
v_mfma_f32_16x16x32_bf16 v[184:187], a[116:119], a[132:135], v[184:187]
v_cvt_pk_bf16_f32 v169, v170, v171
v_cvt_pk_bf16_f32 v170, v172, v173
v_mfma_f32_16x16x32_bf16 v[188:191], a[120:123], a[128:131], v[188:191]
v_cvt_pk_bf16_f32 v171, v174, v175
v_mfma_f32_16x16x32_bf16 v[188:191], a[124:127], a[132:135], v[188:191]
s_waitcnt lgkmcnt(2)
v_mfma_f32_16x16x32_bf16 v[192:195], a[64:67], a[136:139], v[192:195]
ds_read_b64_tr_b16 a[128:129], v10 offset:32768
v_cvt_pk_bf16_f32 v176, v176, v177
v_mfma_f32_16x16x32_bf16 v[192:195], a[68:71], a[140:143], v[192:195]
v_cvt_pk_bf16_f32 v177, v178, v179
v_cvt_pk_bf16_f32 v178, v180, v181
v_mfma_f32_16x16x32_bf16 v[196:199], a[72:75], a[136:139], v[196:199]
ds_read_b64_tr_b16 a[130:131], v10 offset:34816
v_cvt_pk_bf16_f32 v179, v182, v183
v_mfma_f32_16x16x32_bf16 v[196:199], a[76:79], a[140:143], v[196:199]
buffer_store_dwordx4 v[64:67], v1, s[4:7], s31 offen sc1
v_mfma_f32_16x16x32_bf16 v[200:203], a[80:83], a[136:139], v[200:203]
s_add_u32 s31, s31, s32
ds_read_b64_tr_b16 a[132:133], v10 offset:49152
v_cvt_pk_bf16_f32 v184, v184, v185
v_mfma_f32_16x16x32_bf16 v[200:203], a[84:87], a[140:143], v[200:203]
v_cvt_pk_bf16_f32 v185, v186, v187
v_cvt_pk_bf16_f32 v186, v188, v189
v_mfma_f32_16x16x32_bf16 v[204:207], a[88:91], a[136:139], v[204:207]
ds_read_b64_tr_b16 a[134:135], v10 offset:51200
v_cvt_pk_bf16_f32 v187, v190, v191
v_mfma_f32_16x16x32_bf16 v[204:207], a[92:95], a[140:143], v[204:207]
v_mfma_f32_16x16x32_bf16 v[208:211], a[96:99], a[136:139], v[208:211]
ds_read_b128 a[52:55], v3 offset:12288
v_cvt_pk_bf16_f32 v192, v192, v193
v_mfma_f32_16x16x32_bf16 v[208:211], a[100:103], a[140:143], v[208:211]
v_cvt_pk_bf16_f32 v193, v194, v195
v_cvt_pk_bf16_f32 v194, v196, v197
v_mfma_f32_16x16x32_bf16 v[212:215], a[104:107], a[136:139], v[212:215]
ds_read_b128 a[56:59], v2 offset:14336
v_cvt_pk_bf16_f32 v195, v198, v199
v_mfma_f32_16x16x32_bf16 v[212:215], a[108:111], a[140:143], v[212:215]
v_mfma_f32_16x16x32_bf16 v[216:219], a[112:115], a[136:139], v[216:219]
v_cvt_pk_bf16_f32 v200, v200, v201
v_cvt_pk_bf16_f32 v201, v202, v203
v_mfma_f32_16x16x32_bf16 v[216:219], a[116:119], a[140:143], v[216:219]
buffer_store_dwordx4 v[72:75], v1, s[4:7], s31 offen sc1
v_mfma_f32_16x16x32_bf16 v[220:223], a[120:123], a[136:139], v[220:223]
s_add_u32 s31, s31, s33
ds_read_b128 a[60:63], v3 offset:14336
v_cvt_pk_bf16_f32 v202, v204, v205
v_mfma_f32_16x16x32_bf16 v[220:223], a[124:127], a[140:143], v[220:223]
s_waitcnt lgkmcnt(3)
v_cvt_pk_bf16_f32 v203, v206, v207
v_mfma_f32_16x16x32_bf16 a[192:195], a[64:67], a[128:131], a[192:195]
ds_read_b64_tr_b16 a[136:137], v11 offset:32768
v_cvt_pk_bf16_f32 v208, v208, v209
v_mfma_f32_16x16x32_bf16 a[192:195], a[68:71], a[132:135], a[192:195]
v_cvt_pk_bf16_f32 v209, v210, v211
v_cvt_pk_bf16_f32 v210, v212, v213
v_mfma_f32_16x16x32_bf16 a[196:199], a[72:75], a[128:131], a[196:199]
ds_read_b64_tr_b16 a[138:139], v11 offset:34816
v_cvt_pk_bf16_f32 v211, v214, v215
v_mfma_f32_16x16x32_bf16 a[196:199], a[76:79], a[132:135], a[196:199]
v_mfma_f32_16x16x32_bf16 a[200:203], a[80:83], a[128:131], a[200:203]
ds_read_b64_tr_b16 a[140:141], v11 offset:49152
v_cvt_pk_bf16_f32 v216, v216, v217
v_mfma_f32_16x16x32_bf16 a[200:203], a[84:87], a[132:135], a[200:203]
v_cvt_pk_bf16_f32 v217, v218, v219
v_cvt_pk_bf16_f32 v218, v220, v221
v_mfma_f32_16x16x32_bf16 a[204:207], a[88:91], a[128:131], a[204:207]
ds_read_b64_tr_b16 a[142:143], v11 offset:51200
v_cvt_pk_bf16_f32 v219, v222, v223
v_mfma_f32_16x16x32_bf16 a[204:207], a[92:95], a[132:135], a[204:207]
v_mfma_f32_16x16x32_bf16 a[208:211], a[96:99], a[128:131], a[208:211]
buffer_store_dwordx4 v[80:83], v1, s[4:7], s31 offen sc1
v_mfma_f32_16x16x32_bf16 a[208:211], a[100:103], a[132:135], a[208:211]
s_add_u32 s31, s31, s32
v_mfma_f32_16x16x32_bf16 a[212:215], a[104:107], a[128:131], a[212:215]
v_mfma_f32_16x16x32_bf16 a[212:215], a[108:111], a[132:135], a[212:215]
v_mfma_f32_16x16x32_bf16 a[216:219], a[112:115], a[128:131], a[216:219]
v_mfma_f32_16x16x32_bf16 a[216:219], a[116:119], a[132:135], a[216:219]
v_mfma_f32_16x16x32_bf16 a[220:223], a[120:123], a[128:131], a[220:223]
s_waitcnt vmcnt(23) lgkmcnt(0)
v_mfma_f32_16x16x32_bf16 a[220:223], a[124:127], a[132:135], a[220:223]
s_barrier
v_mfma_f32_16x16x32_bf16 a[224:227], a[64:67], a[136:139], a[224:227]
s_add_u32 m0, s29, 98304
ds_read_b64_tr_b16 a[128:129], v22 offset:0
v_mfma_f32_16x16x32_bf16 a[224:227], a[68:71], a[140:143], a[224:227]
buffer_load_dwordx4 v16, s[12:15], s26 offen offset:0 lds
v_mfma_f32_16x16x32_bf16 a[228:231], a[72:75], a[136:139], a[228:231]
ds_read_b64_tr_b16 a[130:131], v22 offset:2048
v_mfma_f32_16x16x32_bf16 a[228:231], a[76:79], a[140:143], a[228:231]
buffer_store_dwordx4 v[88:91], v1, s[4:7], s31 offen sc1
v_mfma_f32_16x16x32_bf16 a[232:235], a[80:83], a[136:139], a[232:235]
s_add_u32 s31, s31, s35
ds_read_b64_tr_b16 a[132:133], v22 offset:16384
v_mfma_f32_16x16x32_bf16 a[232:235], a[84:87], a[140:143], a[232:235]
buffer_load_dwordx4 v17, s[12:15], s26 offen offset:1024 lds
v_mfma_f32_16x16x32_bf16 a[236:239], a[88:91], a[136:139], a[236:239]
ds_read_b64_tr_b16 a[134:135], v22 offset:18432
v_add_u32 v22, 4294901760, v22
v_mfma_f32_16x16x32_bf16 a[236:239], a[92:95], a[140:143], a[236:239]
v_mfma_f32_16x16x32_bf16 a[240:243], a[96:99], a[136:139], a[240:243]
v_mfma_f32_16x16x32_bf16 a[240:243], a[100:103], a[140:143], a[240:243]
buffer_load_dwordx4 v18, s[12:15], s26 offen offset:2048 lds
v_mfma_f32_16x16x32_bf16 a[244:247], a[104:107], a[136:139], a[244:247]
v_mfma_f32_16x16x32_bf16 a[244:247], a[108:111], a[140:143], a[244:247]
v_mfma_f32_16x16x32_bf16 a[248:251], a[112:115], a[136:139], a[248:251]
v_mfma_f32_16x16x32_bf16 a[248:251], a[116:119], a[140:143], a[248:251]
buffer_load_dwordx4 v19, s[12:15], s26 offen offset:3072 lds
v_mfma_f32_16x16x32_bf16 a[252:255], a[120:123], a[136:139], a[252:255]
s_add_u32 s26, s26, 524288
v_mfma_f32_16x16x32_bf16 a[252:255], a[124:127], a[140:143], a[252:255]
s_waitcnt lgkmcnt(0)
s_cmp_ge_u32 s21, 7
s_cbranch_scc1 M_Q
M_conv:
v_mfma_f32_16x16x32_bf16 v[36:39], a[128:131], a[0:3], 0
s_add_u32 m0, s29, 114688
ds_read_b64_tr_b16 a[136:137], v23 offset:0
v_mfma_f32_16x16x32_bf16 v[36:39], a[132:135], a[4:7], v[36:39]
buffer_load_dwordx4 v16, s[12:15], s27 offen offset:0 lds
v_mfma_f32_16x16x32_bf16 v[44:47], a[128:131], a[8:11], 0
ds_read_b64_tr_b16 a[138:139], v23 offset:2048
v_mfma_f32_16x16x32_bf16 v[44:47], a[132:135], a[12:15], v[44:47]
ds_read_b128 a[64:67], v2 offset:16384
ds_read_b128 a[68:71], v3 offset:16384
v_mfma_f32_16x16x32_bf16 v[52:55], a[128:131], a[16:19], 0
ds_read_b64_tr_b16 a[140:141], v23 offset:16384
v_mfma_f32_16x16x32_bf16 v[52:55], a[132:135], a[20:23], v[52:55]
buffer_load_dwordx4 v17, s[12:15], s27 offen offset:1024 lds
v_mfma_f32_16x16x32_bf16 v[60:63], a[128:131], a[24:27], 0
ds_read_b64_tr_b16 a[142:143], v23 offset:18432
v_add_u32 v23, 4294901760, v23
v_mfma_f32_16x16x32_bf16 v[60:63], a[132:135], a[28:31], v[60:63]
buffer_store_dwordx4 v[96:99], v1, s[4:7], s31 offen sc1
v_mfma_f32_16x16x32_bf16 v[68:71], a[128:131], a[32:35], 0
s_add_u32 s31, s31, s32
ds_read_b128 a[72:75], v2 offset:18432
v_mfma_f32_16x16x32_bf16 v[68:71], a[132:135], a[36:39], v[68:71]
buffer_load_dwordx4 v18, s[12:15], s27 offen offset:2048 lds
v_mfma_f32_16x16x32_bf16 v[76:79], a[128:131], a[40:43], 0
ds_read_b128 a[76:79], v3 offset:18432
v_mfma_f32_16x16x32_bf16 v[76:79], a[132:135], a[44:47], v[76:79]
ds_read_b128 a[80:83], v2 offset:20480
v_mfma_f32_16x16x32_bf16 v[84:87], a[128:131], a[48:51], 0
ds_read_b128 a[84:87], v3 offset:20480
v_mfma_f32_16x16x32_bf16 v[84:87], a[132:135], a[52:55], v[84:87]
buffer_load_dwordx4 v19, s[12:15], s27 offen offset:3072 lds
v_mfma_f32_16x16x32_bf16 v[92:95], a[128:131], a[56:59], 0
s_add_u32 s27, s27, 524288
ds_read_b128 a[88:91], v2 offset:22528
v_mfma_f32_16x16x32_bf16 v[92:95], a[132:135], a[60:63], v[92:95]
s_waitcnt lgkmcnt(5)
buffer_store_dwordx4 v[104:107], v1, s[4:7], s31 offen sc1
v_mfma_f32_16x16x32_bf16 v[100:103], a[136:139], a[0:3], 0
s_add_u32 m0, s28, 0
ds_read_b64_tr_b16 a[128:129], v24 offset:0
v_mfma_f32_16x16x32_bf16 v[100:103], a[140:143], a[4:7], v[100:103]
s_add_u32 s31, s31, s33
buffer_load_dwordx4 v12, s[8:11], s24 offen offset:0 lds
v_mfma_f32_16x16x32_bf16 v[108:111], a[136:139], a[8:11], 0
ds_read_b64_tr_b16 a[130:131], v24 offset:2048
v_mfma_f32_16x16x32_bf16 v[108:111], a[140:143], a[12:15], v[108:111]
ds_read_b128 a[92:95], v3 offset:22528
v_mfma_f32_16x16x32_bf16 v[116:119], a[136:139], a[16:19], 0
ds_read_b64_tr_b16 a[132:133], v24 offset:16384
v_mfma_f32_16x16x32_bf16 v[116:119], a[140:143], a[20:23], v[116:119]
buffer_load_dwordx4 v13, s[8:11], s24 offen offset:1024 lds
v_mfma_f32_16x16x32_bf16 v[124:127], a[136:139], a[24:27], 0
ds_read_b64_tr_b16 a[134:135], v24 offset:18432
v_add_u32 v24, 4294901760, v24
v_mfma_f32_16x16x32_bf16 v[124:127], a[140:143], a[28:31], v[124:127]
v_mfma_f32_16x16x32_bf16 v[132:135], a[136:139], a[32:35], 0
ds_read_b128 a[96:99], v2 offset:24576
v_mfma_f32_16x16x32_bf16 v[132:135], a[140:143], a[36:39], v[132:135]
buffer_load_dwordx4 v14, s[8:11], s24 offen offset:2048 lds
v_mfma_f32_16x16x32_bf16 v[140:143], a[136:139], a[40:43], 0
ds_read_b128 a[100:103], v3 offset:24576
v_mfma_f32_16x16x32_bf16 v[140:143], a[140:143], a[44:47], v[140:143]
ds_read_b128 a[104:107], v2 offset:26624
v_mfma_f32_16x16x32_bf16 v[148:151], a[136:139], a[48:51], 0
ds_read_b128 a[108:111], v3 offset:26624
v_mfma_f32_16x16x32_bf16 v[148:151], a[140:143], a[52:55], v[148:151]
buffer_load_dwordx4 v15, s[8:11], s24 offen offset:3072 lds
v_mfma_f32_16x16x32_bf16 v[156:159], a[136:139], a[56:59], 0
s_add_u32 s24, s24, 128
ds_read_b128 a[112:115], v2 offset:28672
v_mfma_f32_16x16x32_bf16 v[156:159], a[140:143], a[60:63], v[156:159]
s_waitcnt lgkmcnt(5)
buffer_store_dwordx4 v[112:115], v1, s[4:7], s31 offen sc1
v_mfma_f32_16x16x32_bf16 v[164:167], a[128:131], a[0:3], 0
s_add_u32 s31, s31, s32
ds_read_b64_tr_b16 a[136:137], v25 offset:0
v_mfma_f32_16x16x32_bf16 v[164:167], a[132:135], a[4:7], v[164:167]
v_mfma_f32_16x16x32_bf16 v[172:175], a[128:131], a[8:11], 0
ds_read_b64_tr_b16 a[138:139], v25 offset:2048
v_mfma_f32_16x16x32_bf16 v[172:175], a[132:135], a[12:15], v[172:175]
ds_read_b128 a[116:119], v3 offset:28672
v_mfma_f32_16x16x32_bf16 v[180:183], a[128:131], a[16:19], 0
ds_read_b64_tr_b16 a[140:141], v25 offset:16384
v_mfma_f32_16x16x32_bf16 v[180:183], a[132:135], a[20:23], v[180:183]
v_mfma_f32_16x16x32_bf16 v[188:191], a[128:131], a[24:27], 0
ds_read_b64_tr_b16 a[142:143], v25 offset:18432
v_add_u32 v25, 4294901760, v25
v_mfma_f32_16x16x32_bf16 v[188:191], a[132:135], a[28:31], v[188:191]
v_mfma_f32_16x16x32_bf16 v[196:199], a[128:131], a[32:35], 0
ds_read_b128 a[120:123], v2 offset:30720
v_mfma_f32_16x16x32_bf16 v[196:199], a[132:135], a[36:39], v[196:199]
v_mfma_f32_16x16x32_bf16 v[204:207], a[128:131], a[40:43], 0
ds_read_b128 a[124:127], v3 offset:30720
v_mfma_f32_16x16x32_bf16 v[204:207], a[132:135], a[44:47], v[204:207]
v_mfma_f32_16x16x32_bf16 v[212:215], a[128:131], a[48:51], 0
v_mfma_f32_16x16x32_bf16 v[212:215], a[132:135], a[52:55], v[212:215]
buffer_store_dwordx4 v[120:123], v1, s[4:7], s31 offen sc1
v_mfma_f32_16x16x32_bf16 v[220:223], a[128:131], a[56:59], 0
s_add_u32 s31, s31, s34
v_mfma_f32_16x16x32_bf16 v[220:223], a[132:135], a[60:63], v[220:223]
s_waitcnt vmcnt(28) lgkmcnt(0)
s_barrier
v_mfma_f32_16x16x32_bf16 v[224:227], a[136:139], a[0:3], 0
s_add_u32 m0, s29, 131072
ds_read_b64_tr_b16 a[128:129], v22 offset:0
v_mfma_f32_16x16x32_bf16 v[224:227], a[140:143], a[4:7], v[224:227]
buffer_load_dwordx4 v16, s[12:15], s26 offen offset:0 lds
v_mfma_f32_16x16x32_bf16 v[228:231], a[136:139], a[8:11], 0
ds_read_b64_tr_b16 a[130:131], v22 offset:2048
v_mfma_f32_16x16x32_bf16 v[228:231], a[140:143], a[12:15], v[228:231]
v_mfma_f32_16x16x32_bf16 v[232:235], a[136:139], a[16:19], 0
ds_read_b64_tr_b16 a[132:133], v22 offset:16384
v_mfma_f32_16x16x32_bf16 v[232:235], a[140:143], a[20:23], v[232:235]
buffer_load_dwordx4 v17, s[12:15], s26 offen offset:1024 lds
v_mfma_f32_16x16x32_bf16 v[236:239], a[136:139], a[24:27], 0
ds_read_b64_tr_b16 a[134:135], v22 offset:18432
v_add_u32 v22, 32768, v22
v_mfma_f32_16x16x32_bf16 v[236:239], a[140:143], a[28:31], v[236:239]
v_mfma_f32_16x16x32_bf16 v[240:243], a[136:139], a[32:35], 0
v_mfma_f32_16x16x32_bf16 v[240:243], a[140:143], a[36:39], v[240:243]
buffer_load_dwordx4 v18, s[12:15], s26 offen offset:2048 lds
v_mfma_f32_16x16x32_bf16 v[244:247], a[136:139], a[40:43], 0
v_mfma_f32_16x16x32_bf16 v[244:247], a[140:143], a[44:47], v[244:247]
v_mfma_f32_16x16x32_bf16 v[248:251], a[136:139], a[48:51], 0
v_mfma_f32_16x16x32_bf16 v[248:251], a[140:143], a[52:55], v[248:251]
buffer_load_dwordx4 v19, s[12:15], s26 offen offset:3072 lds
v_mfma_f32_16x16x32_bf16 v[252:255], a[136:139], a[56:59], 0
s_add_u32 s26, s26, 524288
v_mfma_f32_16x16x32_bf16 v[252:255], a[140:143], a[60:63], v[252:255]
s_waitcnt lgkmcnt(0)
v_mfma_f32_16x16x32_bf16 v[36:39], a[128:131], a[64:67], v[36:39]
s_add_u32 m0, s29, 147456
ds_read_b64_tr_b16 a[136:137], v23 offset:0
v_mfma_f32_16x16x32_bf16 v[36:39], a[132:135], a[68:71], v[36:39]
buffer_load_dwordx4 v16, s[12:15], s27 offen offset:0 lds
v_mfma_f32_16x16x32_bf16 v[44:47], a[128:131], a[72:75], v[44:47]
ds_read_b64_tr_b16 a[138:139], v23 offset:2048
v_mfma_f32_16x16x32_bf16 v[44:47], a[132:135], a[76:79], v[44:47]
ds_read_b128 a[0:3], v2 offset:32768
ds_read_b128 a[4:7], v3 offset:32768
v_mfma_f32_16x16x32_bf16 v[52:55], a[128:131], a[80:83], v[52:55]
ds_read_b64_tr_b16 a[140:141], v23 offset:16384
v_mfma_f32_16x16x32_bf16 v[52:55], a[132:135], a[84:87], v[52:55]
buffer_load_dwordx4 v17, s[12:15], s27 offen offset:1024 lds
v_mfma_f32_16x16x32_bf16 v[60:63], a[128:131], a[88:91], v[60:63]
ds_read_b64_tr_b16 a[142:143], v23 offset:18432
v_add_u32 v23, 32768, v23
v_mfma_f32_16x16x32_bf16 v[60:63], a[132:135], a[92:95], v[60:63]
buffer_store_dwordx4 v[128:131], v1, s[4:7], s31 offen sc1
v_mfma_f32_16x16x32_bf16 v[68:71], a[128:131], a[96:99], v[68:71]
s_add_u32 s31, s31, s32
ds_read_b128 a[8:11], v2 offset:34816
v_accvgpr_read_b32 v32, a192
v_mfma_f32_16x16x32_bf16 v[68:71], a[132:135], a[100:103], v[68:71]
buffer_load_dwordx4 v18, s[12:15], s27 offen offset:2048 lds
v_mfma_f32_16x16x32_bf16 v[76:79], a[128:131], a[104:107], v[76:79]
ds_read_b128 a[12:15], v3 offset:34816
v_accvgpr_read_b32 v33, a193
v_mfma_f32_16x16x32_bf16 v[76:79], a[132:135], a[108:111], v[76:79]
ds_read_b128 a[16:19], v2 offset:36864
v_accvgpr_read_b32 v34, a194
v_mfma_f32_16x16x32_bf16 v[84:87], a[128:131], a[112:115], v[84:87]
ds_read_b128 a[20:23], v3 offset:36864
v_accvgpr_read_b32 v35, a195
v_mfma_f32_16x16x32_bf16 v[84:87], a[132:135], a[116:119], v[84:87]
buffer_load_dwordx4 v19, s[12:15], s27 offen offset:3072 lds
v_mfma_f32_16x16x32_bf16 v[92:95], a[128:131], a[120:123], v[92:95]
s_add_u32 s27, s27, 524288
ds_read_b128 a[24:27], v2 offset:38912
v_accvgpr_read_b32 v96, a196
v_mfma_f32_16x16x32_bf16 v[92:95], a[132:135], a[124:127], v[92:95]
s_waitcnt lgkmcnt(5)
buffer_store_dwordx4 v[136:139], v1, s[4:7], s31 offen sc1
v_mfma_f32_16x16x32_bf16 v[100:103], a[136:139], a[64:67], v[100:103]
s_add_u32 m0, s28, 16384
ds_read_b64_tr_b16 a[128:129], v24 offset:0
v_accvgpr_read_b32 v97, a197
v_mfma_f32_16x16x32_bf16 v[100:103], a[140:143], a[68:71], v[100:103]
s_add_u32 s31, s31, s33
buffer_load_dwordx4 v12, s[8:11], s24 offen offset:0 lds
v_mfma_f32_16x16x32_bf16 v[108:111], a[136:139], a[72:75], v[108:111]
ds_read_b64_tr_b16 a[130:131], v24 offset:2048
v_accvgpr_read_b32 v98, a198
v_mfma_f32_16x16x32_bf16 v[108:111], a[140:143], a[76:79], v[108:111]
ds_read_b128 a[28:31], v3 offset:38912
v_accvgpr_read_b32 v99, a199
v_mfma_f32_16x16x32_bf16 v[116:119], a[136:139], a[80:83], v[116:119]
ds_read_b64_tr_b16 a[132:133], v24 offset:16384
v_cvt_pk_bf16_f32 v32, v32, v33
v_mfma_f32_16x16x32_bf16 v[116:119], a[140:143], a[84:87], v[116:119]
buffer_load_dwordx4 v13, s[8:11], s24 offen offset:1024 lds
v_mfma_f32_16x16x32_bf16 v[124:127], a[136:139], a[88:91], v[124:127]
ds_read_b64_tr_b16 a[134:135], v24 offset:18432
v_add_u32 v24, 32768, v24
v_mfma_f32_16x16x32_bf16 v[124:127], a[140:143], a[92:95], v[124:127]
v_cvt_pk_bf16_f32 v33, v34, v35
v_cvt_pk_bf16_f32 v34, v96, v97
v_mfma_f32_16x16x32_bf16 v[132:135], a[136:139], a[96:99], v[132:135]
ds_read_b128 a[32:35], v2 offset:40960
v_cvt_pk_bf16_f32 v35, v98, v99
v_mfma_f32_16x16x32_bf16 v[132:135], a[140:143], a[100:103], v[132:135]
buffer_load_dwordx4 v14, s[8:11], s24 offen offset:2048 lds
v_mfma_f32_16x16x32_bf16 v[140:143], a[136:139], a[104:107], v[140:143]
ds_read_b128 a[36:39], v3 offset:40960
v_accvgpr_read_b32 v40, a200
v_mfma_f32_16x16x32_bf16 v[140:143], a[140:143], a[108:111], v[140:143]
ds_read_b128 a[40:43], v2 offset:43008
v_accvgpr_read_b32 v41, a201
v_mfma_f32_16x16x32_bf16 v[148:151], a[136:139], a[112:115], v[148:151]
ds_read_b128 a[44:47], v3 offset:43008
v_accvgpr_read_b32 v42, a202
v_mfma_f32_16x16x32_bf16 v[148:151], a[140:143], a[116:119], v[148:151]
buffer_load_dwordx4 v15, s[8:11], s24 offen offset:3072 lds
v_mfma_f32_16x16x32_bf16 v[156:159], a[136:139], a[120:123], v[156:159]
s_add_u32 s24, s24, 128
ds_read_b128 a[48:51], v2 offset:45056
v_accvgpr_read_b32 v43, a203
v_mfma_f32_16x16x32_bf16 v[156:159], a[140:143], a[124:127], v[156:159]
s_waitcnt lgkmcnt(5)
buffer_store_dwordx4 v[144:147], v1, s[4:7], s31 offen sc1
v_mfma_f32_16x16x32_bf16 v[164:167], a[128:131], a[64:67], v[164:167]
s_add_u32 s31, s31, s32
ds_read_b64_tr_b16 a[136:137], v25 offset:0
v_accvgpr_read_b32 v96, a204
v_mfma_f32_16x16x32_bf16 v[164:167], a[132:135], a[68:71], v[164:167]
v_accvgpr_read_b32 v97, a205
v_accvgpr_read_b32 v98, a206
v_mfma_f32_16x16x32_bf16 v[172:175], a[128:131], a[72:75], v[172:175]
ds_read_b64_tr_b16 a[138:139], v25 offset:2048
v_accvgpr_read_b32 v99, a207
v_mfma_f32_16x16x32_bf16 v[172:175], a[132:135], a[76:79], v[172:175]
ds_read_b128 a[52:55], v3 offset:45056
v_cvt_pk_bf16_f32 v40, v40, v41
v_mfma_f32_16x16x32_bf16 v[180:183], a[128:131], a[80:83], v[180:183]
ds_read_b64_tr_b16 a[140:141], v25 offset:16384
v_cvt_pk_bf16_f32 v41, v42, v43
v_mfma_f32_16x16x32_bf16 v[180:183], a[132:135], a[84:87], v[180:183]
v_cvt_pk_bf16_f32 v42, v96, v97
v_cvt_pk_bf16_f32 v43, v98, v99
v_mfma_f32_16x16x32_bf16 v[188:191], a[128:131], a[88:91], v[188:191]
ds_read_b64_tr_b16 a[142:143], v25 offset:18432
v_add_u32 v25, 32768, v25
v_mfma_f32_16x16x32_bf16 v[188:191], a[132:135], a[92:95], v[188:191]
v_accvgpr_read_b32 v48, a208
v_accvgpr_read_b32 v49, a209
v_mfma_f32_16x16x32_bf16 v[196:199], a[128:131], a[96:99], v[196:199]
ds_read_b128 a[56:59], v2 offset:47104
v_accvgpr_read_b32 v50, a210
v_mfma_f32_16x16x32_bf16 v[196:199], a[132:135], a[100:103], v[196:199]
v_accvgpr_read_b32 v51, a211
v_accvgpr_read_b32 v96, a212
v_mfma_f32_16x16x32_bf16 v[204:207], a[128:131], a[104:107], v[204:207]
ds_read_b128 a[60:63], v3 offset:47104
v_accvgpr_read_b32 v97, a213
v_mfma_f32_16x16x32_bf16 v[204:207], a[132:135], a[108:111], v[204:207]
v_accvgpr_read_b32 v98, a214
v_accvgpr_read_b32 v99, a215
v_mfma_f32_16x16x32_bf16 v[212:215], a[128:131], a[112:115], v[212:215]
v_cvt_pk_bf16_f32 v48, v48, v49
v_cvt_pk_bf16_f32 v49, v50, v51
v_mfma_f32_16x16x32_bf16 v[212:215], a[132:135], a[116:119], v[212:215]
buffer_store_dwordx4 v[152:155], v1, s[4:7], s31 offen sc1
v_mfma_f32_16x16x32_bf16 v[220:223], a[128:131], a[120:123], v[220:223]
s_add_u32 s31, s31, s36
v_cvt_pk_bf16_f32 v50, v96, v97
v_cvt_pk_bf16_f32 v51, v98, v99
v_mfma_f32_16x16x32_bf16 v[220:223], a[132:135], a[124:127], v[220:223]
s_waitcnt vmcnt(23) lgkmcnt(0)
s_barrier
v_accvgpr_read_b32 v56, a216
v_mfma_f32_16x16x32_bf16 v[224:227], a[136:139], a[64:67], v[224:227]
s_add_u32 m0, s29, 65536
ds_read_b64_tr_b16 a[128:129], v22 offset:0
v_accvgpr_read_b32 v57, a217
v_mfma_f32_16x16x32_bf16 v[224:227], a[140:143], a[68:71], v[224:227]
buffer_load_dwordx4 v16, s[12:15], s26 offen offset:0 lds
v_mfma_f32_16x16x32_bf16 v[228:231], a[136:139], a[72:75], v[228:231]
ds_read_b64_tr_b16 a[130:131], v22 offset:2048
v_accvgpr_read_b32 v58, a218
v_mfma_f32_16x16x32_bf16 v[228:231], a[140:143], a[76:79], v[228:231]
v_accvgpr_read_b32 v59, a219
v_accvgpr_read_b32 v96, a220
v_mfma_f32_16x16x32_bf16 v[232:235], a[136:139], a[80:83], v[232:235]
ds_read_b64_tr_b16 a[132:133], v22 offset:16384
v_accvgpr_read_b32 v97, a221
v_mfma_f32_16x16x32_bf16 v[232:235], a[140:143], a[84:87], v[232:235]
buffer_load_dwordx4 v17, s[12:15], s26 offen offset:1024 lds
v_mfma_f32_16x16x32_bf16 v[236:239], a[136:139], a[88:91], v[236:239]
ds_read_b64_tr_b16 a[134:135], v22 offset:18432
v_add_u32 v22, 32768, v22
v_mfma_f32_16x16x32_bf16 v[236:239], a[140:143], a[92:95], v[236:239]
v_accvgpr_read_b32 v98, a222
v_accvgpr_read_b32 v99, a223
v_mfma_f32_16x16x32_bf16 v[240:243], a[136:139], a[96:99], v[240:243]
PAD_28:
s_cbranch_execz M_tret
v_cvt_pk_bf16_f32 v56, v56, v57
v_cvt_pk_bf16_f32 v57, v58, v59
v_mfma_f32_16x16x32_bf16 v[240:243], a[140:143], a[100:103], v[240:243]
buffer_load_dwordx4 v18, s[12:15], s26 offen offset:2048 lds
v_mfma_f32_16x16x32_bf16 v[244:247], a[136:139], a[104:107], v[244:247]
v_cvt_pk_bf16_f32 v58, v96, v97
v_cvt_pk_bf16_f32 v59, v98, v99
v_mfma_f32_16x16x32_bf16 v[244:247], a[140:143], a[108:111], v[244:247]
v_accvgpr_read_b32 v64, a224
v_accvgpr_read_b32 v65, a225
v_mfma_f32_16x16x32_bf16 v[248:251], a[136:139], a[112:115], v[248:251]
v_accvgpr_read_b32 v66, a226
v_accvgpr_read_b32 v67, a227
v_mfma_f32_16x16x32_bf16 v[248:251], a[140:143], a[116:119], v[248:251]
buffer_load_dwordx4 v19, s[12:15], s26 offen offset:3072 lds
v_mfma_f32_16x16x32_bf16 v[252:255], a[136:139], a[120:123], v[252:255]
s_add_u32 s26, s26, 524288
v_accvgpr_read_b32 v96, a228
v_accvgpr_read_b32 v97, a229
v_mfma_f32_16x16x32_bf16 v[252:255], a[140:143], a[124:127], v[252:255]
s_waitcnt lgkmcnt(0)
v_accvgpr_read_b32 v98, a230
v_accvgpr_read_b32 v99, a231
v_mfma_f32_16x16x32_bf16 v[36:39], a[128:131], a[0:3], v[36:39]
s_add_u32 m0, s29, 81920
ds_read_b64_tr_b16 a[136:137], v23 offset:0
v_cvt_pk_bf16_f32 v64, v64, v65
v_mfma_f32_16x16x32_bf16 v[36:39], a[132:135], a[4:7], v[36:39]
buffer_load_dwordx4 v16, s[12:15], s27 offen offset:0 lds
v_mfma_f32_16x16x32_bf16 v[44:47], a[128:131], a[8:11], v[44:47]
ds_read_b64_tr_b16 a[138:139], v23 offset:2048
v_cvt_pk_bf16_f32 v65, v66, v67
v_mfma_f32_16x16x32_bf16 v[44:47], a[132:135], a[12:15], v[44:47]
ds_read_b128 a[64:67], v2 offset:49152
ds_read_b128 a[68:71], v3 offset:49152
v_mfma_f32_16x16x32_bf16 v[52:55], a[128:131], a[16:19], v[52:55]
ds_read_b64_tr_b16 a[140:141], v23 offset:16384
v_cvt_pk_bf16_f32 v66, v96, v97
v_mfma_f32_16x16x32_bf16 v[52:55], a[132:135], a[20:23], v[52:55]
buffer_load_dwordx4 v17, s[12:15], s27 offen offset:1024 lds
v_mfma_f32_16x16x32_bf16 v[60:63], a[128:131], a[24:27], v[60:63]
ds_read_b64_tr_b16 a[142:143], v23 offset:18432
v_add_u32 v23, 32768, v23
v_mfma_f32_16x16x32_bf16 v[60:63], a[132:135], a[28:31], v[60:63]
buffer_store_dwordx4 v[160:163], v1, s[4:7], s31 offen sc1
v_mfma_f32_16x16x32_bf16 v[68:71], a[128:131], a[32:35], v[68:71]
s_add_u32 s31, s31, s32
ds_read_b128 a[72:75], v2 offset:51200
v_cvt_pk_bf16_f32 v67, v98, v99
v_mfma_f32_16x16x32_bf16 v[68:71], a[132:135], a[36:39], v[68:71]
buffer_load_dwordx4 v18, s[12:15], s27 offen offset:2048 lds
v_mfma_f32_16x16x32_bf16 v[76:79], a[128:131], a[40:43], v[76:79]
ds_read_b128 a[76:79], v3 offset:51200
v_accvgpr_read_b32 v72, a232
v_mfma_f32_16x16x32_bf16 v[76:79], a[132:135], a[44:47], v[76:79]
ds_read_b128 a[80:83], v2 offset:53248
v_accvgpr_read_b32 v73, a233
v_mfma_f32_16x16x32_bf16 v[84:87], a[128:131], a[48:51], v[84:87]
ds_read_b128 a[84:87], v3 offset:53248
v_accvgpr_read_b32 v74, a234
v_mfma_f32_16x16x32_bf16 v[84:87], a[132:135], a[52:55], v[84:87]
buffer_load_dwordx4 v19, s[12:15], s27 offen offset:3072 lds
v_mfma_f32_16x16x32_bf16 v[92:95], a[128:131], a[56:59], v[92:95]
s_add_u32 s27, s27, 524288
ds_read_b128 a[88:91], v2 offset:55296
v_accvgpr_read_b32 v75, a235
v_mfma_f32_16x16x32_bf16 v[92:95], a[132:135], a[60:63], v[92:95]
s_waitcnt lgkmcnt(5)
buffer_store_dwordx4 v[168:171], v1, s[4:7], s31 offen sc1
v_mfma_f32_16x16x32_bf16 v[100:103], a[136:139], a[0:3], v[100:103]
s_add_u32 m0, s28, 32768
ds_read_b64_tr_b16 a[128:129], v24 offset:0
v_accvgpr_read_b32 v96, a236
v_mfma_f32_16x16x32_bf16 v[100:103], a[140:143], a[4:7], v[100:103]
s_add_u32 s31, s31, s33
buffer_load_dwordx4 v12, s[8:11], s24 offen offset:0 lds
v_mfma_f32_16x16x32_bf16 v[108:111], a[136:139], a[8:11], v[108:111]
ds_read_b64_tr_b16 a[130:131], v24 offset:2048
v_accvgpr_read_b32 v97, a237
v_mfma_f32_16x16x32_bf16 v[108:111], a[140:143], a[12:15], v[108:111]
ds_read_b128 a[92:95], v3 offset:55296
v_accvgpr_read_b32 v98, a238
v_mfma_f32_16x16x32_bf16 v[116:119], a[136:139], a[16:19], v[116:119]
ds_read_b64_tr_b16 a[132:133], v24 offset:16384
v_accvgpr_read_b32 v99, a239
v_mfma_f32_16x16x32_bf16 v[116:119], a[140:143], a[20:23], v[116:119]
buffer_load_dwordx4 v13, s[8:11], s24 offen offset:1024 lds
v_mfma_f32_16x16x32_bf16 v[124:127], a[136:139], a[24:27], v[124:127]
ds_read_b64_tr_b16 a[134:135], v24 offset:18432
v_add_u32 v24, 32768, v24
v_mfma_f32_16x16x32_bf16 v[124:127], a[140:143], a[28:31], v[124:127]
v_cvt_pk_bf16_f32 v72, v72, v73
v_cvt_pk_bf16_f32 v73, v74, v75
v_mfma_f32_16x16x32_bf16 v[132:135], a[136:139], a[32:35], v[132:135]
ds_read_b128 a[96:99], v2 offset:57344
v_cvt_pk_bf16_f32 v74, v96, v97
v_mfma_f32_16x16x32_bf16 v[132:135], a[140:143], a[36:39], v[132:135]
buffer_load_dwordx4 v14, s[8:11], s24 offen offset:2048 lds
v_mfma_f32_16x16x32_bf16 v[140:143], a[136:139], a[40:43], v[140:143]
ds_read_b128 a[100:103], v3 offset:57344
v_cvt_pk_bf16_f32 v75, v98, v99
v_mfma_f32_16x16x32_bf16 v[140:143], a[140:143], a[44:47], v[140:143]
ds_read_b128 a[104:107], v2 offset:59392
v_accvgpr_read_b32 v80, a240
v_mfma_f32_16x16x32_bf16 v[148:151], a[136:139], a[48:51], v[148:151]
ds_read_b128 a[108:111], v3 offset:59392
v_accvgpr_read_b32 v81, a241
v_mfma_f32_16x16x32_bf16 v[148:151], a[140:143], a[52:55], v[148:151]
buffer_load_dwordx4 v15, s[8:11], s24 offen offset:3072 lds
v_mfma_f32_16x16x32_bf16 v[156:159], a[136:139], a[56:59], v[156:159]
s_add_u32 s24, s24, 128
ds_read_b128 a[112:115], v2 offset:61440
v_accvgpr_read_b32 v82, a242
v_mfma_f32_16x16x32_bf16 v[156:159], a[140:143], a[60:63], v[156:159]
s_waitcnt lgkmcnt(5)
buffer_store_dwordx4 v[176:179], v1, s[4:7], s31 offen sc1
v_mfma_f32_16x16x32_bf16 v[164:167], a[128:131], a[0:3], v[164:167]
s_add_u32 s31, s31, s32
ds_read_b64_tr_b16 a[136:137], v25 offset:0
v_accvgpr_read_b32 v83, a243
v_mfma_f32_16x16x32_bf16 v[164:167], a[132:135], a[4:7], v[164:167]
v_accvgpr_read_b32 v96, a244
v_accvgpr_read_b32 v97, a245
v_mfma_f32_16x16x32_bf16 v[172:175], a[128:131], a[8:11], v[172:175]
ds_read_b64_tr_b16 a[138:139], v25 offset:2048
v_accvgpr_read_b32 v98, a246
v_mfma_f32_16x16x32_bf16 v[172:175], a[132:135], a[12:15], v[172:175]
ds_read_b128 a[116:119], v3 offset:61440
v_accvgpr_read_b32 v99, a247
v_mfma_f32_16x16x32_bf16 v[180:183], a[128:131], a[16:19], v[180:183]
ds_read_b64_tr_b16 a[140:141], v25 offset:16384
v_cvt_pk_bf16_f32 v80, v80, v81
v_mfma_f32_16x16x32_bf16 v[180:183], a[132:135], a[20:23], v[180:183]
buffer_store_dwordx4 v[184:187], v1, s[4:7], s31 offen sc1
v_mfma_f32_16x16x32_bf16 v[188:191], a[128:131], a[24:27], v[188:191]
s_add_u32 s31, s31, s34
ds_read_b64_tr_b16 a[142:143], v25 offset:18432
v_add_u32 v25, 32768, v25
v_mfma_f32_16x16x32_bf16 v[188:191], a[132:135], a[28:31], v[188:191]
v_cvt_pk_bf16_f32 v81, v82, v83
v_cvt_pk_bf16_f32 v82, v96, v97
v_mfma_f32_16x16x32_bf16 v[196:199], a[128:131], a[32:35], v[196:199]
ds_read_b128 a[120:123], v2 offset:63488
v_cvt_pk_bf16_f32 v83, v98, v99
v_mfma_f32_16x16x32_bf16 v[196:199], a[132:135], a[36:39], v[196:199]
v_accvgpr_read_b32 v88, a248
v_accvgpr_read_b32 v89, a249
v_mfma_f32_16x16x32_bf16 v[204:207], a[128:131], a[40:43], v[204:207]
ds_read_b128 a[124:127], v3 offset:63488
v_accvgpr_read_b32 v90, a250
v_mfma_f32_16x16x32_bf16 v[204:207], a[132:135], a[44:47], v[204:207]
v_accvgpr_read_b32 v91, a251
v_accvgpr_read_b32 v96, a252
v_mfma_f32_16x16x32_bf16 v[212:215], a[128:131], a[48:51], v[212:215]
v_accvgpr_read_b32 v97, a253
v_accvgpr_read_b32 v98, a254
v_mfma_f32_16x16x32_bf16 v[212:215], a[132:135], a[52:55], v[212:215]
v_accvgpr_read_b32 v99, a255
v_cvt_pk_bf16_f32 v88, v88, v89
v_mfma_f32_16x16x32_bf16 v[220:223], a[128:131], a[56:59], v[220:223]
v_cvt_pk_bf16_f32 v89, v90, v91
v_cvt_pk_bf16_f32 v90, v96, v97
v_mfma_f32_16x16x32_bf16 v[220:223], a[132:135], a[60:63], v[220:223]
s_waitcnt vmcnt(23) lgkmcnt(0)
s_barrier
v_cvt_pk_bf16_f32 v91, v98, v99
v_mfma_f32_16x16x32_bf16 v[224:227], a[136:139], a[0:3], v[224:227]
s_add_u32 m0, s29, 98304
ds_read_b64_tr_b16 a[128:129], v22 offset:0
v_mfma_f32_16x16x32_bf16 v[224:227], a[140:143], a[4:7], v[224:227]
buffer_load_dwordx4 v16, s[12:15], s26 offen offset:0 lds
v_mfma_f32_16x16x32_bf16 v[228:231], a[136:139], a[8:11], v[228:231]
ds_read_b64_tr_b16 a[130:131], v22 offset:2048
v_mfma_f32_16x16x32_bf16 v[228:231], a[140:143], a[12:15], v[228:231]
buffer_store_dwordx4 v[192:195], v1, s[4:7], s31 offen sc1
v_mfma_f32_16x16x32_bf16 v[232:235], a[136:139], a[16:19], v[232:235]
s_add_u32 s31, s31, s32
ds_read_b64_tr_b16 a[132:133], v22 offset:16384
v_mfma_f32_16x16x32_bf16 v[232:235], a[140:143], a[20:23], v[232:235]
buffer_load_dwordx4 v17, s[12:15], s26 offen offset:1024 lds
v_mfma_f32_16x16x32_bf16 v[236:239], a[136:139], a[24:27], v[236:239]
ds_read_b64_tr_b16 a[134:135], v22 offset:18432
v_add_u32 v22, 4294901760, v22
v_mfma_f32_16x16x32_bf16 v[236:239], a[140:143], a[28:31], v[236:239]
v_mfma_f32_16x16x32_bf16 v[240:243], a[136:139], a[32:35], v[240:243]
v_mfma_f32_16x16x32_bf16 v[240:243], a[140:143], a[36:39], v[240:243]
buffer_load_dwordx4 v18, s[12:15], s26 offen offset:2048 lds
v_mfma_f32_16x16x32_bf16 v[244:247], a[136:139], a[40:43], v[244:247]
v_mfma_f32_16x16x32_bf16 v[244:247], a[140:143], a[44:47], v[244:247]
v_mfma_f32_16x16x32_bf16 v[248:251], a[136:139], a[48:51], v[248:251]
v_mfma_f32_16x16x32_bf16 v[248:251], a[140:143], a[52:55], v[248:251]
buffer_load_dwordx4 v19, s[12:15], s26 offen offset:3072 lds
v_mfma_f32_16x16x32_bf16 v[252:255], a[136:139], a[56:59], v[252:255]
s_add_u32 s26, s26, 524288
v_mfma_f32_16x16x32_bf16 v[252:255], a[140:143], a[60:63], v[252:255]
s_waitcnt lgkmcnt(0)
v_mfma_f32_16x16x32_bf16 v[36:39], a[128:131], a[64:67], v[36:39]
s_add_u32 m0, s29, 114688
ds_read_b64_tr_b16 a[136:137], v23 offset:0
v_mfma_f32_16x16x32_bf16 v[36:39], a[132:135], a[68:71], v[36:39]
buffer_load_dwordx4 v16, s[12:15], s27 offen offset:0 lds
v_mfma_f32_16x16x32_bf16 v[44:47], a[128:131], a[72:75], v[44:47]
ds_read_b64_tr_b16 a[138:139], v23 offset:2048
v_mfma_f32_16x16x32_bf16 v[44:47], a[132:135], a[76:79], v[44:47]
ds_read_b128 a[0:3], v2 offset:0
ds_read_b128 a[4:7], v3 offset:0
v_mfma_f32_16x16x32_bf16 v[52:55], a[128:131], a[80:83], v[52:55]
ds_read_b64_tr_b16 a[140:141], v23 offset:16384
v_mfma_f32_16x16x32_bf16 v[52:55], a[132:135], a[84:87], v[52:55]
buffer_load_dwordx4 v17, s[12:15], s27 offen offset:1024 lds
v_mfma_f32_16x16x32_bf16 v[60:63], a[128:131], a[88:91], v[60:63]
ds_read_b64_tr_b16 a[142:143], v23 offset:18432
v_add_u32 v23, 4294901760, v23
v_mfma_f32_16x16x32_bf16 v[60:63], a[132:135], a[92:95], v[60:63]
buffer_store_dwordx4 v[200:203], v1, s[4:7], s31 offen sc1
v_mfma_f32_16x16x32_bf16 v[68:71], a[128:131], a[96:99], v[68:71]
s_add_u32 s31, s31, s33
ds_read_b128 a[8:11], v2 offset:2048
v_mfma_f32_16x16x32_bf16 v[68:71], a[132:135], a[100:103], v[68:71]
buffer_load_dwordx4 v18, s[12:15], s27 offen offset:2048 lds
v_mfma_f32_16x16x32_bf16 v[76:79], a[128:131], a[104:107], v[76:79]
ds_read_b128 a[12:15], v3 offset:2048
v_mfma_f32_16x16x32_bf16 v[76:79], a[132:135], a[108:111], v[76:79]
ds_read_b128 a[16:19], v2 offset:4096
v_mfma_f32_16x16x32_bf16 v[84:87], a[128:131], a[112:115], v[84:87]
ds_read_b128 a[20:23], v3 offset:4096
v_mfma_f32_16x16x32_bf16 v[84:87], a[132:135], a[116:119], v[84:87]
buffer_load_dwordx4 v19, s[12:15], s27 offen offset:3072 lds
v_mfma_f32_16x16x32_bf16 v[92:95], a[128:131], a[120:123], v[92:95]
s_add_u32 s27, s27, 524288
ds_read_b128 a[24:27], v2 offset:6144
v_mfma_f32_16x16x32_bf16 v[92:95], a[132:135], a[124:127], v[92:95]
s_waitcnt lgkmcnt(5)
buffer_store_dwordx4 v[208:211], v1, s[4:7], s31 offen sc1
v_mfma_f32_16x16x32_bf16 v[100:103], a[136:139], a[64:67], v[100:103]
s_add_u32 s31, s31, s32
ds_read_b64_tr_b16 a[128:129], v24 offset:0
v_mfma_f32_16x16x32_bf16 v[100:103], a[140:143], a[68:71], v[100:103]
v_mfma_f32_16x16x32_bf16 v[108:111], a[136:139], a[72:75], v[108:111]
ds_read_b64_tr_b16 a[130:131], v24 offset:2048
v_mfma_f32_16x16x32_bf16 v[108:111], a[140:143], a[76:79], v[108:111]
ds_read_b128 a[28:31], v3 offset:6144
v_mfma_f32_16x16x32_bf16 v[116:119], a[136:139], a[80:83], v[116:119]
ds_read_b64_tr_b16 a[132:133], v24 offset:16384
v_mfma_f32_16x16x32_bf16 v[116:119], a[140:143], a[84:87], v[116:119]
v_mfma_f32_16x16x32_bf16 v[124:127], a[136:139], a[88:91], v[124:127]
ds_read_b64_tr_b16 a[134:135], v24 offset:18432
v_add_u32 v24, 4294901760, v24
v_mfma_f32_16x16x32_bf16 v[124:127], a[140:143], a[92:95], v[124:127]
v_mfma_f32_16x16x32_bf16 v[132:135], a[136:139], a[96:99], v[132:135]
ds_read_b128 a[32:35], v2 offset:8192
v_mfma_f32_16x16x32_bf16 v[132:135], a[140:143], a[100:103], v[132:135]
buffer_store_dwordx4 v[216:219], v1, s[4:7], s31 offen sc1
v_mfma_f32_16x16x32_bf16 v[140:143], a[136:139], a[104:107], v[140:143]
s_add_u32 s31, s31, s35
ds_read_b128 a[36:39], v3 offset:8192
v_mfma_f32_16x16x32_bf16 v[140:143], a[140:143], a[108:111], v[140:143]
ds_read_b128 a[40:43], v2 offset:10240
v_mfma_f32_16x16x32_bf16 v[148:151], a[136:139], a[112:115], v[148:151]
ds_read_b128 a[44:47], v3 offset:10240
v_mfma_f32_16x16x32_bf16 v[148:151], a[140:143], a[116:119], v[148:151]
v_mfma_f32_16x16x32_bf16 v[156:159], a[136:139], a[120:123], v[156:159]
ds_read_b128 a[48:51], v2 offset:12288
v_mfma_f32_16x16x32_bf16 v[156:159], a[140:143], a[124:127], v[156:159]
s_waitcnt lgkmcnt(5)
v_mfma_f32_16x16x32_bf16 v[164:167], a[128:131], a[64:67], v[164:167]
ds_read_b64_tr_b16 a[136:137], v25 offset:0
v_mfma_f32_16x16x32_bf16 v[164:167], a[132:135], a[68:71], v[164:167]
v_mfma_f32_16x16x32_bf16 v[172:175], a[128:131], a[72:75], v[172:175]
ds_read_b64_tr_b16 a[138:139], v25 offset:2048
v_mfma_f32_16x16x32_bf16 v[172:175], a[132:135], a[76:79], v[172:175]
ds_read_b128 a[52:55], v3 offset:12288
v_mfma_f32_16x16x32_bf16 v[180:183], a[128:131], a[80:83], v[180:183]
ds_read_b64_tr_b16 a[140:141], v25 offset:16384
v_mfma_f32_16x16x32_bf16 v[180:183], a[132:135], a[84:87], v[180:183]
buffer_store_dwordx4 v[32:35], v1, s[4:7], s31 offen sc1
v_mfma_f32_16x16x32_bf16 v[188:191], a[128:131], a[88:91], v[188:191]
s_add_u32 s31, s31, s32
ds_read_b64_tr_b16 a[142:143], v25 offset:18432
v_add_u32 v25, 4294901760, v25
v_mfma_f32_16x16x32_bf16 v[188:191], a[132:135], a[92:95], v[188:191]
v_mfma_f32_16x16x32_bf16 v[196:199], a[128:131], a[96:99], v[196:199]
ds_read_b128 a[56:59], v2 offset:14336
v_mfma_f32_16x16x32_bf16 v[196:199], a[132:135], a[100:103], v[196:199]
v_mfma_f32_16x16x32_bf16 v[204:207], a[128:131], a[104:107], v[204:207]
ds_read_b128 a[60:63], v3 offset:14336
v_mfma_f32_16x16x32_bf16 v[204:207], a[132:135], a[108:111], v[204:207]
v_mfma_f32_16x16x32_bf16 v[212:215], a[128:131], a[112:115], v[212:215]
v_mfma_f32_16x16x32_bf16 v[212:215], a[132:135], a[116:119], v[212:215]
v_mfma_f32_16x16x32_bf16 v[220:223], a[128:131], a[120:123], v[220:223]
v_mfma_f32_16x16x32_bf16 v[220:223], a[132:135], a[124:127], v[220:223]
s_waitcnt vmcnt(20) lgkmcnt(0)
s_barrier
v_mfma_f32_16x16x32_bf16 v[224:227], a[136:139], a[64:67], v[224:227]
s_add_u32 m0, s29, 131072
ds_read_b64_tr_b16 a[128:129], v22 offset:0
v_mfma_f32_16x16x32_bf16 v[224:227], a[140:143], a[68:71], v[224:227]
buffer_load_dwordx4 v16, s[12:15], s26 offen offset:0 lds
v_mfma_f32_16x16x32_bf16 v[228:231], a[136:139], a[72:75], v[228:231]
ds_read_b64_tr_b16 a[130:131], v22 offset:2048
v_mfma_f32_16x16x32_bf16 v[228:231], a[140:143], a[76:79], v[228:231]
buffer_store_dwordx4 v[40:43], v1, s[4:7], s31 offen sc1
v_mfma_f32_16x16x32_bf16 v[232:235], a[136:139], a[80:83], v[232:235]
s_add_u32 s31, s31, s33
ds_read_b64_tr_b16 a[132:133], v22 offset:16384
v_mfma_f32_16x16x32_bf16 v[232:235], a[140:143], a[84:87], v[232:235]
buffer_load_dwordx4 v17, s[12:15], s26 offen offset:1024 lds
v_mfma_f32_16x16x32_bf16 v[236:239], a[136:139], a[88:91], v[236:239]
ds_read_b64_tr_b16 a[134:135], v22 offset:18432
v_add_u32 v22, 32768, v22
v_mfma_f32_16x16x32_bf16 v[236:239], a[140:143], a[92:95], v[236:239]
v_mfma_f32_16x16x32_bf16 v[240:243], a[136:139], a[96:99], v[240:243]
v_mfma_f32_16x16x32_bf16 v[240:243], a[140:143], a[100:103], v[240:243]
buffer_load_dwordx4 v18, s[12:15], s26 offen offset:2048 lds
v_mfma_f32_16x16x32_bf16 v[244:247], a[136:139], a[104:107], v[244:247]
v_mfma_f32_16x16x32_bf16 v[244:247], a[140:143], a[108:111], v[244:247]
v_mfma_f32_16x16x32_bf16 v[248:251], a[136:139], a[112:115], v[248:251]
v_mfma_f32_16x16x32_bf16 v[248:251], a[140:143], a[116:119], v[248:251]
buffer_load_dwordx4 v19, s[12:15], s26 offen offset:3072 lds
v_mfma_f32_16x16x32_bf16 v[252:255], a[136:139], a[120:123], v[252:255]
s_add_u32 s26, s26, 524288
v_mfma_f32_16x16x32_bf16 v[252:255], a[140:143], a[124:127], v[252:255]
s_waitcnt lgkmcnt(0)
v_mfma_f32_16x16x32_bf16 v[36:39], a[128:131], a[0:3], v[36:39]
s_add_u32 m0, s29, 147456
ds_read_b64_tr_b16 a[136:137], v23 offset:0
v_mfma_f32_16x16x32_bf16 v[36:39], a[132:135], a[4:7], v[36:39]
buffer_load_dwordx4 v16, s[12:15], s27 offen offset:0 lds
v_mfma_f32_16x16x32_bf16 v[44:47], a[128:131], a[8:11], v[44:47]
s_lshl_b32 s22, s20, 7
ds_read_b64_tr_b16 a[138:139], v23 offset:2048
v_bfe_u32 v20, v1, 4, 3
v_mfma_f32_16x16x32_bf16 v[44:47], a[132:135], a[12:15], v[44:47]
s_add_u32 s70, s22, 94371840
ds_read_b128 a[64:67], v2 offset:16384
ds_read_b128 a[68:71], v3 offset:16384
v_mfma_f32_16x16x32_bf16 v[52:55], a[128:131], a[16:19], v[52:55]
s_lshr_b32 s22, s2, 4
ds_read_b64_tr_b16 a[140:141], v23 offset:16384
v_lshlrev_b32 v20, 3, v20
v_mfma_f32_16x16x32_bf16 v[52:55], a[132:135], a[20:23], v[52:55]
s_lshl_b32 s22, s22, 2
buffer_load_dwordx4 v17, s[12:15], s27 offen offset:1024 lds
v_mfma_f32_16x16x32_bf16 v[60:63], a[128:131], a[24:27], v[60:63]
s_add_u32 s66, s70, s22
ds_read_b64_tr_b16 a[142:143], v23 offset:18432
v_add_u32 v23, 32768, v23
v_mfma_f32_16x16x32_bf16 v[60:63], a[132:135], a[28:31], v[60:63]
s_and_b32 s22, s2, 16
buffer_store_dwordx4 v[48:51], v1, s[4:7], s31 offen sc1
v_mfma_f32_16x16x32_bf16 v[68:71], a[128:131], a[32:35], v[68:71]
s_add_u32 s31, s31, s32
ds_read_b128 a[72:75], v2 offset:18432
v_add_u32 v15, 2052, v20
v_mfma_f32_16x16x32_bf16 v[68:71], a[132:135], a[36:39], v[68:71]
s_lshl_b32 s22, s22, 7
buffer_load_dwordx4 v18, s[12:15], s27 offen offset:2048 lds
v_mfma_f32_16x16x32_bf16 v[76:79], a[128:131], a[40:43], v[76:79]
s_add_u32 s66, s66, s22
ds_read_b128 a[76:79], v3 offset:18432
v_mfma_f32_16x16x32_bf16 v[76:79], a[132:135], a[44:47], v[76:79]
s_lshl_b32 s67, s20, 20
ds_read_b128 a[80:83], v2 offset:20480
v_mfma_f32_16x16x32_bf16 v[84:87], a[128:131], a[48:51], v[84:87]
s_lshl_b32 s22, s37, 16
ds_read_b128 a[84:87], v3 offset:20480
v_mfma_f32_16x16x32_bf16 v[84:87], a[132:135], a[52:55], v[84:87]
s_add_u32 s67, s67, s22
buffer_load_dwordx4 v19, s[12:15], s27 offen offset:3072 lds
v_mfma_f32_16x16x32_bf16 v[92:95], a[128:131], a[56:59], v[92:95]
s_waitcnt lgkmcnt(5)
s_add_u32 s27, s27, 524288
ds_read_b128 a[88:91], v2 offset:22528
v_mfma_f32_16x16x32_bf16 v[92:95], a[132:135], a[60:63], v[92:95]
s_lshl_b32 s22, s3, 11
buffer_store_dwordx4 v[56:59], v1, s[4:7], s31 offen sc1
v_mfma_f32_16x16x32_bf16 v[100:103], a[136:139], a[0:3], v[100:103]
s_waitcnt lgkmcnt(5)
s_add_u32 s31, s31, s34
ds_read_b64_tr_b16 a[128:129], v24 offset:0
v_mfma_f32_16x16x32_bf16 v[100:103], a[140:143], a[4:7], v[100:103]
s_add_u32 s67, s67, s22
v_mfma_f32_16x16x32_bf16 v[108:111], a[136:139], a[8:11], v[108:111]
s_add_u32 s67, s67, 33554432
ds_read_b64_tr_b16 a[130:131], v24 offset:2048
v_mfma_f32_16x16x32_bf16 v[108:111], a[140:143], a[12:15], v[108:111]
s_mov_b32 s68, 1035512379
ds_read_b128 a[92:95], v3 offset:22528
v_mfma_f32_16x16x32_bf16 v[116:119], a[136:139], a[16:19], v[116:119]
s_mov_b32 s69, 1035512379
ds_read_b64_tr_b16 a[132:133], v24 offset:16384
v_mfma_f32_16x16x32_bf16 v[116:119], a[140:143], a[20:23], v[116:119]
buffer_store_dwordx4 v[64:67], v1, s[4:7], s31 offen sc1
v_mfma_f32_16x16x32_bf16 v[124:127], a[136:139], a[24:27], v[124:127]
s_add_u32 s31, s31, s32
ds_read_b64_tr_b16 a[134:135], v24 offset:18432
v_add_u32 v24, 32768, v24
v_mfma_f32_16x16x32_bf16 v[124:127], a[140:143], a[28:31], v[124:127]
v_mfma_f32_16x16x32_bf16 v[132:135], a[136:139], a[32:35], v[132:135]
ds_read_b128 a[96:99], v2 offset:24576
v_mfma_f32_16x16x32_bf16 v[132:135], a[140:143], a[36:39], v[132:135]
v_mfma_f32_16x16x32_bf16 v[140:143], a[136:139], a[40:43], v[140:143]
ds_read_b128 a[100:103], v3 offset:24576
v_mfma_f32_16x16x32_bf16 v[140:143], a[140:143], a[44:47], v[140:143]
ds_read_b128 a[104:107], v2 offset:26624
v_mfma_f32_16x16x32_bf16 v[148:151], a[136:139], a[48:51], v[148:151]
ds_read_b128 a[108:111], v3 offset:26624
v_mfma_f32_16x16x32_bf16 v[148:151], a[140:143], a[52:55], v[148:151]
v_mfma_f32_16x16x32_bf16 v[156:159], a[136:139], a[56:59], v[156:159]
ds_read_b128 a[112:115], v2 offset:28672
v_mfma_f32_16x16x32_bf16 v[156:159], a[140:143], a[60:63], v[156:159]
s_waitcnt lgkmcnt(5)
buffer_store_dwordx4 v[72:75], v1, s[4:7], s31 offen sc1
v_mfma_f32_16x16x32_bf16 v[164:167], a[128:131], a[0:3], v[164:167]
s_add_u32 s31, s31, s33
ds_read_b64_tr_b16 a[136:137], v25 offset:0
v_mfma_f32_16x16x32_bf16 v[164:167], a[132:135], a[4:7], v[164:167]
v_mfma_f32_16x16x32_bf16 v[172:175], a[128:131], a[8:11], v[172:175]
ds_read_b64_tr_b16 a[138:139], v25 offset:2048
v_mfma_f32_16x16x32_bf16 v[172:175], a[132:135], a[12:15], v[172:175]
ds_read_b128 a[116:119], v3 offset:28672
v_mfma_f32_16x16x32_bf16 v[180:183], a[128:131], a[16:19], v[180:183]
ds_read_b64_tr_b16 a[140:141], v25 offset:16384
v_mfma_f32_16x16x32_bf16 v[180:183], a[132:135], a[20:23], v[180:183]
v_mfma_f32_16x16x32_bf16 v[188:191], a[128:131], a[24:27], v[188:191]
ds_read_b64_tr_b16 a[142:143], v25 offset:18432
v_add_u32 v25, 32768, v25
v_mfma_f32_16x16x32_bf16 v[188:191], a[132:135], a[28:31], v[188:191]
v_mfma_f32_16x16x32_bf16 v[196:199], a[128:131], a[32:35], v[196:199]
ds_read_b128 a[120:123], v2 offset:30720
v_mfma_f32_16x16x32_bf16 v[196:199], a[132:135], a[36:39], v[196:199]
buffer_store_dwordx4 v[80:83], v1, s[4:7], s31 offen sc1
v_mfma_f32_16x16x32_bf16 v[204:207], a[128:131], a[40:43], v[204:207]
s_add_u32 s31, s31, s32
ds_read_b128 a[124:127], v3 offset:30720
v_mfma_f32_16x16x32_bf16 v[204:207], a[132:135], a[44:47], v[204:207]
v_mfma_f32_16x16x32_bf16 v[212:215], a[128:131], a[48:51], v[212:215]
v_mfma_f32_16x16x32_bf16 v[212:215], a[132:135], a[52:55], v[212:215]
v_mfma_f32_16x16x32_bf16 v[220:223], a[128:131], a[56:59], v[220:223]
v_mfma_f32_16x16x32_bf16 v[220:223], a[132:135], a[60:63], v[220:223]
s_waitcnt vmcnt(17) lgkmcnt(0)
s_barrier
v_mfma_f32_16x16x32_bf16 v[224:227], a[136:139], a[0:3], v[224:227]
ds_read_b64_tr_b16 a[128:129], v22 offset:0
v_mfma_f32_16x16x32_bf16 v[224:227], a[140:143], a[4:7], v[224:227]
v_mfma_f32_16x16x32_bf16 v[228:231], a[136:139], a[8:11], v[228:231]
ds_read_b64_tr_b16 a[130:131], v22 offset:2048
v_mfma_f32_16x16x32_bf16 v[228:231], a[140:143], a[12:15], v[228:231]
buffer_store_dwordx4 v[88:91], v1, s[4:7], s31 offen sc1
v_mfma_f32_16x16x32_bf16 v[232:235], a[136:139], a[16:19], v[232:235]
ds_read_b64_tr_b16 a[132:133], v22 offset:16384
v_mfma_f32_16x16x32_bf16 v[232:235], a[140:143], a[20:23], v[232:235]
v_mfma_f32_16x16x32_bf16 v[236:239], a[136:139], a[24:27], v[236:239]
ds_read_b64_tr_b16 a[134:135], v22 offset:18432
v_add_u32 v22, 32768, v22
v_mfma_f32_16x16x32_bf16 v[236:239], a[140:143], a[28:31], v[236:239]
v_mfma_f32_16x16x32_bf16 v[240:243], a[136:139], a[32:35], v[240:243]
v_mfma_f32_16x16x32_bf16 v[240:243], a[140:143], a[36:39], v[240:243]
v_mfma_f32_16x16x32_bf16 v[244:247], a[136:139], a[40:43], v[244:247]
v_mfma_f32_16x16x32_bf16 v[244:247], a[140:143], a[44:47], v[244:247]
v_mfma_f32_16x16x32_bf16 v[248:251], a[136:139], a[48:51], v[248:251]
v_mfma_f32_16x16x32_bf16 v[248:251], a[140:143], a[52:55], v[248:251]
v_mfma_f32_16x16x32_bf16 v[252:255], a[136:139], a[56:59], v[252:255]
v_mfma_f32_16x16x32_bf16 v[252:255], a[140:143], a[60:63], v[252:255]
s_waitcnt lgkmcnt(0)
v_mfma_f32_16x16x32_bf16 v[36:39], a[128:131], a[64:67], v[36:39]
ds_read_b64_tr_b16 a[136:137], v23 offset:0
v_mfma_f32_16x16x32_bf16 v[36:39], a[132:135], a[68:71], v[36:39]
v_mfma_f32_16x16x32_bf16 v[44:47], a[128:131], a[72:75], v[44:47]
s_mul_i32 s85, s20, 7
ds_read_b64_tr_b16 a[138:139], v23 offset:2048
v_mfma_f32_16x16x32_bf16 v[44:47], a[132:135], a[76:79], v[44:47]
s_add_u32 s85, s85, s21
ds_read_b128 a[0:3], v2 offset:32768
ds_read_b128 a[4:7], v3 offset:32768
v_mfma_f32_16x16x32_bf16 v[52:55], a[128:131], a[80:83], v[52:55]
s_lshl_b32 s85, s85, 2
ds_read_b64_tr_b16 a[140:141], v23 offset:16384
v_mfma_f32_16x16x32_bf16 v[52:55], a[132:135], a[84:87], v[52:55]
s_add_u32 s85, s85, s3
v_mfma_f32_16x16x32_bf16 v[60:63], a[128:131], a[88:91], v[60:63]
s_mul_i32 s82, s85, 4224
ds_read_b64_tr_b16 a[142:143], v23 offset:18432
v_add_u32 v23, 32768, v23
v_mfma_f32_16x16x32_bf16 v[60:63], a[132:135], a[92:95], v[60:63]
s_add_u32 s82, s82, 83886208
v_mfma_f32_16x16x32_bf16 v[68:71], a[128:131], a[96:99], v[68:71]
s_lshl_b32 s83, s85, 12
ds_read_b128 a[8:11], v2 offset:34816
v_mfma_f32_16x16x32_bf16 v[68:71], a[132:135], a[100:103], v[68:71]
s_mul_i32 s84, s3, 21248
v_mfma_f32_16x16x32_bf16 v[76:79], a[128:131], a[104:107], v[76:79]
s_add_u32 s84, s84, 46080
ds_read_b128 a[12:15], v3 offset:34816
v_mfma_f32_16x16x32_bf16 v[76:79], a[132:135], a[108:111], v[76:79]
s_mov_b64 s[60:61], s[72:73]
ds_read_b128 a[16:19], v2 offset:36864
v_mfma_f32_16x16x32_bf16 v[84:87], a[128:131], a[112:115], v[84:87]
s_mov_b32 s62, 1835008
ds_read_b128 a[20:23], v3 offset:36864
v_mfma_f32_16x16x32_bf16 v[84:87], a[132:135], a[116:119], v[84:87]
v_mfma_f32_16x16x32_bf16 v[92:95], a[128:131], a[120:123], v[92:95]
ds_read_b128 a[24:27], v2 offset:38912
v_mfma_f32_16x16x32_bf16 v[92:95], a[132:135], a[124:127], v[92:95]
s_waitcnt lgkmcnt(5)
v_mfma_f32_16x16x32_bf16 v[100:103], a[136:139], a[64:67], v[100:103]
ds_read_b64_tr_b16 a[128:129], v24 offset:0
v_mfma_f32_16x16x32_bf16 v[100:103], a[140:143], a[68:71], v[100:103]
v_mfma_f32_16x16x32_bf16 v[108:111], a[136:139], a[72:75], v[108:111]
ds_read_b64_tr_b16 a[130:131], v24 offset:2048
v_mfma_f32_16x16x32_bf16 v[108:111], a[140:143], a[76:79], v[108:111]
ds_read_b128 a[28:31], v3 offset:38912
v_mfma_f32_16x16x32_bf16 v[116:119], a[136:139], a[80:83], v[116:119]
ds_read_b64_tr_b16 a[132:133], v24 offset:16384
v_mfma_f32_16x16x32_bf16 v[116:119], a[140:143], a[84:87], v[116:119]
v_mfma_f32_16x16x32_bf16 v[124:127], a[136:139], a[88:91], v[124:127]
ds_read_b64_tr_b16 a[134:135], v24 offset:18432
v_add_u32 v24, 32768, v24
v_mfma_f32_16x16x32_bf16 v[124:127], a[140:143], a[92:95], v[124:127]
v_mfma_f32_16x16x32_bf16 v[132:135], a[136:139], a[96:99], v[132:135]
ds_read_b128 a[32:35], v2 offset:40960
v_mfma_f32_16x16x32_bf16 v[132:135], a[140:143], a[100:103], v[132:135]
v_mfma_f32_16x16x32_bf16 v[140:143], a[136:139], a[104:107], v[140:143]
ds_read_b128 a[36:39], v3 offset:40960
v_mfma_f32_16x16x32_bf16 v[140:143], a[140:143], a[108:111], v[140:143]
ds_read_b128 a[40:43], v2 offset:43008
v_mfma_f32_16x16x32_bf16 v[148:151], a[136:139], a[112:115], v[148:151]
ds_read_b128 a[44:47], v3 offset:43008
v_mfma_f32_16x16x32_bf16 v[148:151], a[140:143], a[116:119], v[148:151]
v_mfma_f32_16x16x32_bf16 v[156:159], a[136:139], a[120:123], v[156:159]
ds_read_b128 a[48:51], v2 offset:45056
v_mfma_f32_16x16x32_bf16 v[156:159], a[140:143], a[124:127], v[156:159]
s_waitcnt lgkmcnt(5)
v_mfma_f32_16x16x32_bf16 v[164:167], a[128:131], a[64:67], v[164:167]
ds_read_b64_tr_b16 a[136:137], v25 offset:0
v_mfma_f32_16x16x32_bf16 v[164:167], a[132:135], a[68:71], v[164:167]
v_mfma_f32_16x16x32_bf16 v[172:175], a[128:131], a[72:75], v[172:175]
ds_read_b64_tr_b16 a[138:139], v25 offset:2048
v_mfma_f32_16x16x32_bf16 v[172:175], a[132:135], a[76:79], v[172:175]
ds_read_b128 a[52:55], v3 offset:45056
v_mfma_f32_16x16x32_bf16 v[180:183], a[128:131], a[80:83], v[180:183]
ds_read_b64_tr_b16 a[140:141], v25 offset:16384
v_mfma_f32_16x16x32_bf16 v[180:183], a[132:135], a[84:87], v[180:183]
PAD_29:
s_cbranch_execz M_tret
v_mfma_f32_16x16x32_bf16 v[188:191], a[128:131], a[88:91], v[188:191]
ds_read_b64_tr_b16 a[142:143], v25 offset:18432
v_add_u32 v25, 32768, v25
v_mfma_f32_16x16x32_bf16 v[188:191], a[132:135], a[92:95], v[188:191]
v_mfma_f32_16x16x32_bf16 v[196:199], a[128:131], a[96:99], v[196:199]
ds_read_b128 a[56:59], v2 offset:47104
v_mfma_f32_16x16x32_bf16 v[196:199], a[132:135], a[100:103], v[196:199]
v_mfma_f32_16x16x32_bf16 v[204:207], a[128:131], a[104:107], v[204:207]
ds_read_b128 a[60:63], v3 offset:47104
v_mfma_f32_16x16x32_bf16 v[204:207], a[132:135], a[108:111], v[204:207]
v_mfma_f32_16x16x32_bf16 v[212:215], a[128:131], a[112:115], v[212:215]
v_mfma_f32_16x16x32_bf16 v[212:215], a[132:135], a[116:119], v[212:215]
v_mfma_f32_16x16x32_bf16 v[220:223], a[128:131], a[120:123], v[220:223]
v_mfma_f32_16x16x32_bf16 v[220:223], a[132:135], a[124:127], v[220:223]
s_waitcnt vmcnt(0) lgkmcnt(0)
s_barrier
v_mfma_f32_16x16x32_bf16 v[224:227], a[136:139], a[64:67], v[224:227]
ds_read_b64_tr_b16 a[128:129], v22 offset:0
v_mfma_f32_16x16x32_bf16 v[224:227], a[140:143], a[68:71], v[224:227]
buffer_store_dword v27, v26, s[4:7], s66 offen sc1
v_mfma_f32_16x16x32_bf16 v[228:231], a[136:139], a[72:75], v[228:231]
ds_read_b64_tr_b16 a[130:131], v22 offset:2048
v_mfma_f32_16x16x32_bf16 v[228:231], a[140:143], a[76:79], v[228:231]
v_mfma_f32_16x16x32_bf16 v[232:235], a[136:139], a[80:83], v[232:235]
ds_read_b64_tr_b16 a[132:133], v22 offset:16384
v_mfma_f32_16x16x32_bf16 v[232:235], a[140:143], a[84:87], v[232:235]
v_mfma_f32_16x16x32_bf16 v[236:239], a[136:139], a[88:91], v[236:239]
ds_read_b64_tr_b16 a[134:135], v22 offset:18432
v_mfma_f32_16x16x32_bf16 v[236:239], a[140:143], a[92:95], v[236:239]
v_mfma_f32_16x16x32_bf16 v[240:243], a[136:139], a[96:99], v[240:243]
v_mfma_f32_16x16x32_bf16 v[240:243], a[140:143], a[100:103], v[240:243]
v_mfma_f32_16x16x32_bf16 v[244:247], a[136:139], a[104:107], v[244:247]
v_mfma_f32_16x16x32_bf16 v[244:247], a[140:143], a[108:111], v[244:247]
v_mfma_f32_16x16x32_bf16 v[248:251], a[136:139], a[112:115], v[248:251]
v_mfma_f32_16x16x32_bf16 v[248:251], a[140:143], a[116:119], v[248:251]
v_mfma_f32_16x16x32_bf16 v[252:255], a[136:139], a[120:123], v[252:255]
v_mfma_f32_16x16x32_bf16 v[252:255], a[140:143], a[124:127], v[252:255]
s_waitcnt lgkmcnt(0)
v_mfma_f32_16x16x32_bf16 v[36:39], a[128:131], a[0:3], v[36:39]
s_add_u32 m0, s84, 17152
ds_read_b64_tr_b16 a[136:137], v23 offset:0
v_lshrrev_b32 v9, 4, v1
v_mfma_f32_16x16x32_bf16 v[36:39], a[132:135], a[4:7], v[36:39]
buffer_load_dwordx4 v1, s[60:63], s83 offen offset:0 lds
v_mfma_f32_16x16x32_bf16 v[44:47], a[128:131], a[8:11], v[44:47]
ds_read_b64_tr_b16 a[138:139], v23 offset:2048
v_and_b32 v10, 15, v9
v_mfma_f32_16x16x32_bf16 v[44:47], a[132:135], a[12:15], v[44:47]
buffer_load_dwordx4 v1, s[60:63], s83 offen offset:1024 lds
v_mfma_f32_16x16x32_bf16 v[52:55], a[128:131], a[16:19], v[52:55]
ds_read_b64_tr_b16 a[140:141], v23 offset:16384
v_lshrrev_b32 v11, 4, v9
v_mfma_f32_16x16x32_bf16 v[52:55], a[132:135], a[20:23], v[52:55]
buffer_load_dwordx4 v1, s[60:63], s83 offen offset:2048 lds
v_mfma_f32_16x16x32_bf16 v[60:63], a[128:131], a[24:27], v[60:63]
ds_read_b64_tr_b16 a[142:143], v23 offset:18432
v_lshrrev_b32 v12, 2, v10
v_mfma_f32_16x16x32_bf16 v[60:63], a[132:135], a[28:31], v[60:63]
buffer_load_dwordx4 v1, s[60:63], s83 offen offset:3072 lds
v_mfma_f32_16x16x32_bf16 v[68:71], a[128:131], a[32:35], v[68:71]
s_add_u32 m0, s84, 64
v_mul_u32_u24 v12, 4160, v12
v_and_b32 v13, 3, v9
v_mfma_f32_16x16x32_bf16 v[68:71], a[132:135], a[36:39], v[68:71]
buffer_load_dwordx4 v1, s[4:7], s82 offen offset:0 sc1 lds
v_mfma_f32_16x16x32_bf16 v[76:79], a[128:131], a[40:43], v[76:79]
buffer_load_dwordx4 v1, s[4:7], s82 offen offset:1024 sc1 lds
v_mfma_f32_16x16x32_bf16 v[76:79], a[132:135], a[44:47], v[76:79]
buffer_load_dwordx4 v1, s[4:7], s82 offen offset:2048 sc1 lds
v_mfma_f32_16x16x32_bf16 v[84:87], a[128:131], a[48:51], v[84:87]
buffer_load_dwordx4 v1, s[4:7], s82 offen offset:3072 sc1 lds
v_mfma_f32_16x16x32_bf16 v[84:87], a[132:135], a[52:55], v[84:87]
s_add_u32 s82, s82, 2097152
v_lshl_add_u32 v12, v13, 3, v12
v_lshlrev_b32 v13, 4, v11
v_mfma_f32_16x16x32_bf16 v[92:95], a[128:131], a[56:59], v[92:95]
s_add_u32 m0, s84, 4224
v_sub_u32 v12, v12, v13
v_add_u32 v12, 88, v12
v_mfma_f32_16x16x32_bf16 v[92:95], a[132:135], a[60:63], v[92:95]
s_waitcnt lgkmcnt(0)
buffer_load_dwordx4 v1, s[4:7], s82 offen offset:0 sc1 lds
v_mfma_f32_16x16x32_bf16 v[100:103], a[136:139], a[0:3], v[100:103]
ds_read_b64_tr_b16 a[128:129], v24 offset:0
v_add_u32 v16, s84, v12
v_mfma_f32_16x16x32_bf16 v[100:103], a[140:143], a[4:7], v[100:103]
buffer_load_dwordx4 v1, s[4:7], s82 offen offset:1024 sc1 lds
v_mfma_f32_16x16x32_bf16 v[108:111], a[136:139], a[8:11], v[108:111]
ds_read_b64_tr_b16 a[130:131], v24 offset:2048
v_lshl_add_u32 v12, v10, 5, v13
v_mfma_f32_16x16x32_bf16 v[108:111], a[140:143], a[12:15], v[108:111]
buffer_load_dwordx4 v1, s[4:7], s82 offen offset:2048 sc1 lds
v_mfma_f32_16x16x32_bf16 v[116:119], a[136:139], a[16:19], v[116:119]
ds_read_b64_tr_b16 a[132:133], v24 offset:16384
v_add_u32 v12, 16672, v12
v_mfma_f32_16x16x32_bf16 v[116:119], a[140:143], a[20:23], v[116:119]
buffer_load_dwordx4 v1, s[4:7], s82 offen offset:3072 sc1 lds
v_mfma_f32_16x16x32_bf16 v[124:127], a[136:139], a[24:27], v[124:127]
s_add_u32 s82, s82, 4292870140
ds_read_b64_tr_b16 a[134:135], v24 offset:18432
v_add_u32 v17, s84, v12
v_mfma_f32_16x16x32_bf16 v[124:127], a[140:143], a[28:31], v[124:127]
s_add_u32 m0, s84, 8384
v_lshlrev_b32 v12, 5, v10
v_lshl_add_u32 v8, v11, 3, v12
v_mfma_f32_16x16x32_bf16 v[132:135], a[136:139], a[32:35], v[132:135]
buffer_load_dwordx4 v1, s[4:7], s82 offen offset:0 sc1 lds
v_mfma_f32_16x16x32_bf16 v[132:135], a[140:143], a[36:39], v[132:135]
buffer_load_dwordx4 v1, s[4:7], s82 offen offset:1024 sc1 lds
v_mfma_f32_16x16x32_bf16 v[140:143], a[136:139], a[40:43], v[140:143]
buffer_load_dwordx4 v1, s[4:7], s82 offen offset:2048 sc1 lds
v_mfma_f32_16x16x32_bf16 v[140:143], a[140:143], a[44:47], v[140:143]
buffer_load_dwordx4 v1, s[4:7], s82 offen offset:3072 sc1 lds
v_mfma_f32_16x16x32_bf16 v[148:151], a[136:139], a[48:51], v[148:151]
s_add_u32 s82, s82, 2097152
v_add3_u32 v18, s84, 64, v8
v_mov_b32 v19, 0
v_mfma_f32_16x16x32_bf16 v[148:151], a[140:143], a[52:55], v[148:151]
s_add_u32 m0, s84, 12544
v_mov_b32 v12, 0
v_mov_b32 v13, 0
v_mfma_f32_16x16x32_bf16 v[156:159], a[136:139], a[56:59], v[156:159]
buffer_load_dwordx4 v1, s[4:7], s82 offen offset:0 sc1 lds
v_mfma_f32_16x16x32_bf16 v[156:159], a[140:143], a[60:63], v[156:159]
s_waitcnt lgkmcnt(0)
buffer_load_dwordx4 v1, s[4:7], s82 offen offset:1024 sc1 lds
v_mfma_f32_16x16x32_bf16 v[164:167], a[128:131], a[0:3], v[164:167]
ds_read_b64_tr_b16 a[136:137], v25 offset:0
v_lshl_add_u32 v14, v9, 3, s84
v_mfma_f32_16x16x32_bf16 v[164:167], a[132:135], a[4:7], v[164:167]
buffer_load_dwordx4 v1, s[4:7], s82 offen offset:2048 sc1 lds
v_mfma_f32_16x16x32_bf16 v[172:175], a[128:131], a[8:11], v[172:175]
ds_read_b64_tr_b16 a[138:139], v25 offset:2048
v_mfma_f32_16x16x32_bf16 v[172:175], a[132:135], a[12:15], v[172:175]
buffer_load_dwordx4 v1, s[4:7], s82 offen offset:3072 sc1 lds
v_mfma_f32_16x16x32_bf16 v[180:183], a[128:131], a[16:19], v[180:183]
ds_read_b64_tr_b16 a[140:141], v25 offset:16384
v_mfma_f32_16x16x32_bf16 v[180:183], a[132:135], a[20:23], v[180:183]
ds_write_b64 v14, v[12:13] offset:16640
v_mul_u32_u24 v14, 4160, v11
v_mfma_f32_16x16x32_bf16 v[188:191], a[128:131], a[24:27], v[188:191]
ds_read_b64_tr_b16 a[142:143], v25 offset:18432
v_lshl_add_u32 v14, v10, 2, v14
v_mfma_f32_16x16x32_bf16 v[188:191], a[132:135], a[28:31], v[188:191]
v_add_u32 v14, s84, v14
v_mfma_f32_16x16x32_bf16 v[196:199], a[128:131], a[32:35], v[196:199]
ds_write_b32 v14, v12
v_lshrrev_b32 v30, 6, v0
v_mfma_f32_16x16x32_bf16 v[196:199], a[132:135], a[36:39], v[196:199]
v_lshl_add_u32 v28, v30, 11, v1
v_add_u32 v29, 0x20000, v28
v_mfma_f32_16x16x32_bf16 v[204:207], a[128:131], a[40:43], v[204:207]
v_lshl_add_u32 v30, v30, 13, v1
v_add_u32 v31, 0x20000, v30
v_mfma_f32_16x16x32_bf16 v[204:207], a[132:135], a[44:47], v[204:207]
v_mul_f32 v36, s68, v36
v_mul_f32 v37, s68, v37
v_mfma_f32_16x16x32_bf16 v[212:215], a[128:131], a[48:51], v[212:215]
v_mul_f32 v38, s68, v38
v_mul_f32 v39, s68, v39
v_mfma_f32_16x16x32_bf16 v[212:215], a[132:135], a[52:55], v[212:215]
v_mul_f32 v100, s68, v100
v_mul_f32 v101, s68, v101
v_mfma_f32_16x16x32_bf16 v[220:223], a[128:131], a[56:59], v[220:223]
v_mul_f32 v102, s68, v102
v_mul_f32 v103, s68, v103
v_mfma_f32_16x16x32_bf16 v[220:223], a[132:135], a[60:63], v[220:223]
s_waitcnt lgkmcnt(0)
s_waitcnt lgkmcnt(0)
s_barrier
v_mfma_f32_16x16x32_bf16 v[224:227], a[136:139], a[0:3], v[224:227]
v_cvt_pk_bf16_f32 v36, v36, v37
v_cvt_pk_bf16_f32 v37, v38, v39
v_mfma_f32_16x16x32_bf16 v[224:227], a[140:143], a[4:7], v[224:227]
v_cvt_pk_bf16_f32 v38, v100, v101
v_cvt_pk_bf16_f32 v39, v102, v103
v_mfma_f32_16x16x32_bf16 v[228:231], a[136:139], a[8:11], v[228:231]
v_mul_f32 v44, s68, v44
v_mul_f32 v45, s68, v45
v_mfma_f32_16x16x32_bf16 v[228:231], a[140:143], a[12:15], v[228:231]
v_mul_f32 v46, s68, v46
v_mul_f32 v47, s68, v47
v_mfma_f32_16x16x32_bf16 v[232:235], a[136:139], a[16:19], v[232:235]
v_mul_f32 v108, s68, v108
v_mul_f32 v109, s68, v109
v_mfma_f32_16x16x32_bf16 v[232:235], a[140:143], a[20:23], v[232:235]
v_mul_f32 v110, s68, v110
v_mul_f32 v111, s68, v111
v_mfma_f32_16x16x32_bf16 v[236:239], a[136:139], a[24:27], v[236:239]
v_cvt_pk_bf16_f32 v44, v44, v45
v_cvt_pk_bf16_f32 v45, v46, v47
v_mfma_f32_16x16x32_bf16 v[236:239], a[140:143], a[28:31], v[236:239]
v_cvt_pk_bf16_f32 v46, v108, v109
v_cvt_pk_bf16_f32 v47, v110, v111
v_mfma_f32_16x16x32_bf16 v[240:243], a[136:139], a[32:35], v[240:243]
v_mul_f32 v52, s68, v52
v_mul_f32 v53, s68, v53
v_mfma_f32_16x16x32_bf16 v[240:243], a[140:143], a[36:39], v[240:243]
v_mul_f32 v54, s68, v54
v_mul_f32 v55, s68, v55
v_mfma_f32_16x16x32_bf16 v[244:247], a[136:139], a[40:43], v[244:247]
v_mul_f32 v116, s68, v116
v_mul_f32 v117, s68, v117
v_mfma_f32_16x16x32_bf16 v[244:247], a[140:143], a[44:47], v[244:247]
v_mul_f32 v118, s68, v118
v_mul_f32 v119, s68, v119
v_mfma_f32_16x16x32_bf16 v[248:251], a[136:139], a[48:51], v[248:251]
v_cvt_pk_bf16_f32 v52, v52, v53
v_cvt_pk_bf16_f32 v53, v54, v55
v_mfma_f32_16x16x32_bf16 v[248:251], a[140:143], a[52:55], v[248:251]
v_cvt_pk_bf16_f32 v54, v116, v117
v_cvt_pk_bf16_f32 v55, v118, v119
v_mfma_f32_16x16x32_bf16 v[252:255], a[136:139], a[56:59], v[252:255]
v_mfma_f32_16x16x32_bf16 v[252:255], a[140:143], a[60:63], v[252:255]
s_mov_b64 s[60:61], s[74:75]
s_mov_b32 s62, 896
s_lshl_b32 s79, s85, 1
buffer_load_short_d16_hi v19, off, s[60:63], s79
s_lshl_b32 s83, s85, 12
s_add_u32 s83, s83, 88080384
ds_write_b128 v28, v[36:39] offset:0
ds_write_b128 v28, v[44:47] offset:8192
ds_write_b128 v28, v[52:55] offset:16384
v_pk_mul_f32 v[60:61], v[60:61], s[68:69]
v_pk_mul_f32 v[62:63], v[62:63], s[68:69]
v_pk_mul_f32 v[124:125], v[124:125], s[68:69]
v_pk_mul_f32 v[126:127], v[126:127], s[68:69]
v_cvt_pk_bf16_f32 v60, v60, v61
v_cvt_pk_bf16_f32 v61, v62, v63
v_cvt_pk_bf16_f32 v62, v124, v125
v_cvt_pk_bf16_f32 v63, v126, v127
ds_write_b128 v28, v[60:63] offset:24576
v_pk_mul_f32 v[68:69], v[68:69], s[68:69]
v_pk_mul_f32 v[70:71], v[70:71], s[68:69]
v_pk_mul_f32 v[132:133], v[132:133], s[68:69]
v_pk_mul_f32 v[134:135], v[134:135], s[68:69]
v_cvt_pk_bf16_f32 v68, v68, v69
v_cvt_pk_bf16_f32 v69, v70, v71
v_cvt_pk_bf16_f32 v70, v132, v133
v_cvt_pk_bf16_f32 v71, v134, v135
ds_write_b128 v29, v[68:71] offset:0
v_pk_mul_f32 v[76:77], v[76:77], s[68:69]
v_pk_mul_f32 v[78:79], v[78:79], s[68:69]
v_pk_mul_f32 v[140:141], v[140:141], s[68:69]
v_pk_mul_f32 v[142:143], v[142:143], s[68:69]
v_cvt_pk_bf16_f32 v76, v76, v77
v_cvt_pk_bf16_f32 v77, v78, v79
v_cvt_pk_bf16_f32 v78, v140, v141
v_cvt_pk_bf16_f32 v79, v142, v143
ds_write_b128 v29, v[76:79] offset:8192
v_pk_mul_f32 v[84:85], v[84:85], s[68:69]
v_pk_mul_f32 v[86:87], v[86:87], s[68:69]
v_pk_mul_f32 v[148:149], v[148:149], s[68:69]
v_pk_mul_f32 v[150:151], v[150:151], s[68:69]
v_cvt_pk_bf16_f32 v84, v84, v85
v_cvt_pk_bf16_f32 v85, v86, v87
v_cvt_pk_bf16_f32 v86, v148, v149
v_cvt_pk_bf16_f32 v87, v150, v151
ds_write_b128 v29, v[84:87] offset:16384
v_pk_mul_f32 v[92:93], v[92:93], s[68:69]
v_pk_mul_f32 v[94:95], v[94:95], s[68:69]
v_pk_mul_f32 v[156:157], v[156:157], s[68:69]
v_pk_mul_f32 v[158:159], v[158:159], s[68:69]
v_cvt_pk_bf16_f32 v92, v92, v93
v_cvt_pk_bf16_f32 v93, v94, v95
v_cvt_pk_bf16_f32 v94, v156, v157
v_cvt_pk_bf16_f32 v95, v158, v159
ds_write_b128 v29, v[92:95] offset:24576
v_pk_mul_f32 v[164:165], v[164:165], s[68:69]
v_pk_mul_f32 v[166:167], v[166:167], s[68:69]
v_pk_mul_f32 v[224:225], v[224:225], s[68:69]
v_pk_mul_f32 v[226:227], v[226:227], s[68:69]
v_cvt_pk_bf16_f32 v164, v164, v165
v_cvt_pk_bf16_f32 v165, v166, v167
v_cvt_pk_bf16_f32 v166, v224, v225
v_cvt_pk_bf16_f32 v167, v226, v227
ds_write_b128 v28, v[164:167] offset:1024
v_pk_mul_f32 v[172:173], v[172:173], s[68:69]
v_pk_mul_f32 v[174:175], v[174:175], s[68:69]
v_pk_mul_f32 v[228:229], v[228:229], s[68:69]
v_pk_mul_f32 v[230:231], v[230:231], s[68:69]
v_cvt_pk_bf16_f32 v172, v172, v173
v_cvt_pk_bf16_f32 v173, v174, v175
v_cvt_pk_bf16_f32 v174, v228, v229
v_cvt_pk_bf16_f32 v175, v230, v231
ds_write_b128 v28, v[172:175] offset:9216
v_pk_mul_f32 v[180:181], v[180:181], s[68:69]
v_pk_mul_f32 v[182:183], v[182:183], s[68:69]
v_pk_mul_f32 v[232:233], v[232:233], s[68:69]
v_pk_mul_f32 v[234:235], v[234:235], s[68:69]
v_cvt_pk_bf16_f32 v180, v180, v181
v_cvt_pk_bf16_f32 v181, v182, v183
v_cvt_pk_bf16_f32 v182, v232, v233
v_cvt_pk_bf16_f32 v183, v234, v235
ds_write_b128 v28, v[180:183] offset:17408
v_pk_mul_f32 v[188:189], v[188:189], s[68:69]
v_pk_mul_f32 v[190:191], v[190:191], s[68:69]
v_pk_mul_f32 v[236:237], v[236:237], s[68:69]
v_pk_mul_f32 v[238:239], v[238:239], s[68:69]
v_cvt_pk_bf16_f32 v188, v188, v189
v_cvt_pk_bf16_f32 v189, v190, v191
v_cvt_pk_bf16_f32 v190, v236, v237
v_cvt_pk_bf16_f32 v191, v238, v239
ds_write_b128 v28, v[188:191] offset:25600
v_pk_mul_f32 v[196:197], v[196:197], s[68:69]
v_pk_mul_f32 v[198:199], v[198:199], s[68:69]
v_pk_mul_f32 v[240:241], v[240:241], s[68:69]
v_pk_mul_f32 v[242:243], v[242:243], s[68:69]
v_cvt_pk_bf16_f32 v196, v196, v197
v_cvt_pk_bf16_f32 v197, v198, v199
v_cvt_pk_bf16_f32 v198, v240, v241
v_cvt_pk_bf16_f32 v199, v242, v243
ds_write_b128 v29, v[196:199] offset:1024
v_pk_mul_f32 v[204:205], v[204:205], s[68:69]
v_pk_mul_f32 v[206:207], v[206:207], s[68:69]
v_pk_mul_f32 v[244:245], v[244:245], s[68:69]
v_pk_mul_f32 v[246:247], v[246:247], s[68:69]
v_cvt_pk_bf16_f32 v204, v204, v205
v_cvt_pk_bf16_f32 v205, v206, v207
v_cvt_pk_bf16_f32 v206, v244, v245
v_cvt_pk_bf16_f32 v207, v246, v247
ds_write_b128 v29, v[204:207] offset:9216
v_pk_mul_f32 v[212:213], v[212:213], s[68:69]
v_pk_mul_f32 v[214:215], v[214:215], s[68:69]
v_pk_mul_f32 v[248:249], v[248:249], s[68:69]
v_pk_mul_f32 v[250:251], v[250:251], s[68:69]
v_cvt_pk_bf16_f32 v212, v212, v213
v_cvt_pk_bf16_f32 v213, v214, v215
v_cvt_pk_bf16_f32 v214, v248, v249
v_cvt_pk_bf16_f32 v215, v250, v251
ds_write_b128 v29, v[212:215] offset:17408
v_pk_mul_f32 v[220:221], v[220:221], s[68:69]
v_pk_mul_f32 v[222:223], v[222:223], s[68:69]
v_pk_mul_f32 v[252:253], v[252:253], s[68:69]
v_pk_mul_f32 v[254:255], v[254:255], s[68:69]
v_cvt_pk_bf16_f32 v220, v220, v221
v_cvt_pk_bf16_f32 v221, v222, v223
v_cvt_pk_bf16_f32 v222, v252, v253
v_cvt_pk_bf16_f32 v223, v254, v255
ds_write_b128 v29, v[220:223] offset:25600
s_waitcnt vmcnt(1) lgkmcnt(0)
s_barrier
buffer_load_dword v21, v20, s[4:7], s70 offen sc1
ds_read_b64_tr_b16 a[64:65], v16 offset:8
ds_read_b64_tr_b16 a[66:67], v16 offset:0
ds_read_b128 a[96:99], v17 offset:448
ds_read_b64_tr_b16 a[68:69], v16 offset:520
ds_read_b64_tr_b16 a[70:71], v16 offset:512
ds_read_b128 a[100:103], v17 offset:960
ds_read_b64_tr_b16 a[72:73], v16 offset:1032
ds_read_b64_tr_b16 a[74:75], v16 offset:1024
ds_read_b128 a[104:107], v17 offset:1472
ds_read_b64_tr_b16 a[76:77], v16 offset:1544
ds_read_b64_tr_b16 a[78:79], v16 offset:1536
ds_read_b128 a[108:111], v17 offset:1984
ds_read_b64_tr_b16 a[80:81], v16 offset:2056
ds_read_b64_tr_b16 a[82:83], v16 offset:2048
ds_read_b128 a[112:115], v17 offset:2496
ds_read_b64_tr_b16 a[84:85], v16 offset:2568
ds_read_b64_tr_b16 a[86:87], v16 offset:2560
ds_read_b128 a[116:119], v17 offset:3008
ds_read_b64_tr_b16 a[88:89], v16 offset:3080
ds_read_b64_tr_b16 a[90:91], v16 offset:3072
ds_read_b128 a[120:123], v17 offset:3520
ds_read_b64_tr_b16 a[92:93], v16 offset:3592
ds_read_b64_tr_b16 a[94:95], v16 offset:3584
ds_read_b128 a[124:127], v17 offset:4032
s_waitcnt lgkmcnt(15)
v_mfma_f32_16x16x32_bf16 v[96:99], a[64:67], a[96:99], 0
s_waitcnt lgkmcnt(12)
s_lshl_b32 s18, s3, 13
ds_read_b64_tr_b16 a[128:129], v16 offset:72
v_mov_b32 v24, 0
v_mfma_f32_16x16x32_bf16 v[100:103], a[64:67], a[100:103], 0
s_lshl_b32 s30, s20, 20
ds_read_b64_tr_b16 a[130:131], v16 offset:64
v_lshrrev_b32 v3, 6, v0
v_mfma_f32_16x16x32_bf16 v[100:103], a[68:71], a[96:99], v[100:103]
s_add_u32 s30, s30, s18
ds_read_b128 a[160:163], v17 offset:384
v_and_b32 v4, 63, v0
v_mfma_f32_16x16x32_bf16 v[104:107], a[64:67], a[104:107], 0
s_lshl_b32 s22, s21, 1
ds_read_b128 a[192:195], v30 offset:0
v_add_u32 v2, 0x10000, v1
v_mfma_f32_16x16x32_bf16 v[104:107], a[68:71], a[100:103], v[104:107]
s_lshl_b32 s85, s21, 2
ds_read_b64_tr_b16 a[132:133], v16 offset:584
v_and_b32 v5, 15, v4
v_mfma_f32_16x16x32_bf16 v[104:107], a[72:75], a[96:99], v[104:107]
s_lshr_b32 s85, 2386092, s85
ds_read_b64_tr_b16 a[134:135], v16 offset:576
v_lshrrev_b32 v6, 4, v4
v_mfma_f32_16x16x32_bf16 v[108:111], a[64:67], a[108:111], 0
s_and_b32 s9, s85, 15
ds_read_b128 a[164:167], v17 offset:896
v_lshlrev_b32 v6, 2, v6
v_mfma_f32_16x16x32_bf16 v[108:111], a[68:71], a[104:107], v[108:111]
s_and_b32 s84, s85, 1
ds_read_b128 a[196:199], v30 offset:1024
v_sub_u32 v5, v5, v6
v_mfma_f32_16x16x32_bf16 v[108:111], a[72:75], a[100:103], v[108:111]
s_lshl_b32 s84, s84, 17
ds_read_b64_tr_b16 a[136:137], v16 offset:1096
v_lshl_add_u32 v5, v3, 4, v5
v_mfma_f32_16x16x32_bf16 v[108:111], a[76:79], a[96:99], v[108:111]
s_waitcnt lgkmcnt(8)
s_add_u32 s84, s84, s18
ds_read_b64_tr_b16 a[138:139], v16 offset:1088
v_cmp_gt_i32 s[32:33], 0, v5
v_mfma_f32_16x16x32_bf16 v[112:115], a[64:67], a[112:115], 0
s_xor_b32 s85, s84, 0x20000
ds_read_b128 a[168:171], v17 offset:1408
v_cmp_gt_i32 s[34:35], 1, v5
v_mfma_f32_16x16x32_bf16 v[112:115], a[68:71], a[108:111], v[112:115]
s_sub_u32 s29, 15, s21
ds_read_b128 a[200:203], v30 offset:2048
v_cmp_gt_i32 s[36:37], 2, v5
v_mfma_f32_16x16x32_bf16 v[112:115], a[72:75], a[104:107], v[112:115]
s_mov_b32 s8, s30
ds_read_b64_tr_b16 a[140:141], v16 offset:1608
v_cmp_gt_i32 s[38:39], 3, v5
v_mfma_f32_16x16x32_bf16 v[112:115], a[76:79], a[100:103], v[112:115]
s_add_u32 s11, s22, 2
ds_read_b64_tr_b16 a[142:143], v16 offset:1600
v_cmp_gt_i32 s[40:41], 16, v5
v_mfma_f32_16x16x32_bf16 v[112:115], a[80:83], a[96:99], v[112:115]
s_add_u32 s14, s30, 16777216
ds_read_b128 a[172:175], v17 offset:1920
v_cmp_gt_i32 s[42:43], 17, v5
v_mfma_f32_16x16x32_bf16 v[116:119], a[64:67], a[116:119], 0
s_lshr_b32 s19, s9, 1
ds_read_b128 a[204:207], v30 offset:3072
v_cmp_gt_i32 s[44:45], 18, v5
v_mfma_f32_16x16x32_bf16 v[116:119], a[68:71], a[112:115], v[116:119]
s_cmp_lg_u32 s9, 0
ds_read_b64_tr_b16 a[144:145], v16 offset:2120
v_cmp_gt_i32 s[46:47], 19, v5
v_mfma_f32_16x16x32_bf16 v[116:119], a[72:75], a[108:111], v[116:119]
s_cselect_b32 s10, s30, 3221225472
ds_read_b64_tr_b16 a[146:147], v16 offset:2112
v_cmp_gt_i32 s[48:49], 32, v5
v_mfma_f32_16x16x32_bf16 v[116:119], a[76:79], a[104:107], v[116:119]
s_cselect_b32 s14, s14, 3221225472
ds_read_b128 a[176:179], v17 offset:2432
v_cmp_gt_i32 s[50:51], 33, v5
v_mfma_f32_16x16x32_bf16 v[116:119], a[80:83], a[100:103], v[116:119]
s_cselect_b32 s9, s9, s11
ds_read_b128 a[208:211], v30 offset:4096
v_cmp_gt_i32 s[52:53], 34, v5
v_mfma_f32_16x16x32_bf16 v[116:119], a[84:87], a[96:99], v[116:119]
s_cselect_b32 s19, s19, s21
ds_read_b64_tr_b16 a[148:149], v16 offset:2632
v_cmp_gt_i32 s[54:55], 35, v5
v_mfma_f32_16x16x32_bf16 v[120:123], a[64:67], a[120:123], 0
s_cselect_b32 s29, s29, s21
ds_read_b64_tr_b16 a[150:151], v16 offset:2624
v_cmp_gt_i32 s[56:57], 48, v5
v_mfma_f32_16x16x32_bf16 v[120:123], a[68:71], a[116:119], v[120:123]
s_cselect_b32 s24, 2, 0
ds_read_b128 a[180:183], v17 offset:2944
v_cmp_gt_i32 s[58:59], 49, v5
v_mfma_f32_16x16x32_bf16 v[120:123], a[72:75], a[112:115], v[120:123]
s_add_u32 s12, s8, 16777216
ds_read_b128 a[212:215], v30 offset:5120
v_cmp_gt_i32 s[60:61], 50, v5
v_mfma_f32_16x16x32_bf16 v[120:123], a[76:79], a[108:111], v[120:123]
s_mov_b32 s13, s9
ds_read_b64_tr_b16 a[152:153], v16 offset:3144
v_cmp_gt_i32 s[62:63], 51, v5
v_mfma_f32_16x16x32_bf16 v[120:123], a[80:83], a[104:107], v[120:123]
s_mov_b32 s15, s11
ds_read_b64_tr_b16 a[154:155], v16 offset:3136
v_mov_b32 v7, 0xff800000
v_mfma_f32_16x16x32_bf16 v[120:123], a[84:87], a[100:103], v[120:123]
s_mov_b32 s25, 1266679808
ds_read_b128 a[184:187], v17 offset:3456
v_mov_b32 v6, 1
v_mfma_f32_16x16x32_bf16 v[120:123], a[88:91], a[96:99], v[120:123]
s_lshl_b32 s22, s21, 3
ds_read_b128 a[216:219], v30 offset:6144
v_mov_b32 v5, v26
v_mfma_f32_16x16x32_bf16 v[124:127], a[64:67], a[124:127], 0
s_add_u32 s28, s70, s22
ds_read_b64_tr_b16 a[156:157], v16 offset:3656
v_add_u32 v4, 0x20000, v1
v_mfma_f32_16x16x32_bf16 v[124:127], a[68:71], a[120:123], v[124:127]
s_add_u32 s28, s28, 6148
ds_read_b64_tr_b16 a[158:159], v16 offset:3648
v_mfma_f32_16x16x32_bf16 v[124:127], a[72:75], a[116:119], v[124:127]
s_lshl_b32 s26, s21, 16
ds_read_b128 a[188:191], v17 offset:3968
v_mfma_f32_16x16x32_bf16 v[124:127], a[76:79], a[112:115], v[124:127]
s_add_u32 s26, s26, s30
ds_read_b128 a[220:223], v30 offset:7168
v_mfma_f32_16x16x32_bf16 v[124:127], a[80:83], a[108:111], v[124:127]
s_add_u32 s26, s26, 33554432
ds_read_b128 a[224:227], v31 offset:0
v_mfma_f32_16x16x32_bf16 v[124:127], a[84:87], a[104:107], v[124:127]
s_lshl_b32 s76, s20, 3
ds_read_b128 a[228:231], v31 offset:1024
v_mfma_f32_16x16x32_bf16 v[124:127], a[88:91], a[100:103], v[124:127]
s_add_u32 s76, s76, s21
ds_read_b128 a[232:235], v31 offset:2048
v_mfma_f32_16x16x32_bf16 v[124:127], a[92:95], a[96:99], v[124:127]
s_waitcnt lgkmcnt(8)
s_lshl_b32 s76, s76, 2
ds_read_b128 a[236:239], v31 offset:3072
v_mfma_f32_16x16x32_bf16 v[96:99], a[128:131], a[160:163], v[96:99]
s_add_u32 s76, s76, s3
ds_read_b64_tr_b16 a[64:65], v16 offset:136
v_mfma_f32_16x16x32_bf16 v[100:103], a[128:131], a[164:167], v[100:103]
s_lshl_b32 s27, s76, 10
ds_read_b64_tr_b16 a[66:67], v16 offset:128
v_mfma_f32_16x16x32_bf16 v[100:103], a[132:135], a[160:163], v[100:103]
s_add_u32 s27, s27, 75497472
ds_read_b128 a[96:99], v17 offset:320
v_mfma_f32_16x16x32_bf16 v[104:107], a[128:131], a[168:171], v[104:107]
s_lshl_b32 s76, s76, 14
ds_read_b128 a[240:243], v31 offset:4096
v_mfma_f32_16x16x32_bf16 v[104:107], a[132:135], a[164:167], v[104:107]
s_add_u32 s76, s76, 67108864
ds_read_b64_tr_b16 a[68:69], v16 offset:648
v_mfma_f32_16x16x32_bf16 v[104:107], a[136:139], a[160:163], v[104:107]
s_lshl_b32 s81, s20, 2
ds_read_b64_tr_b16 a[70:71], v16 offset:640
v_mfma_f32_16x16x32_bf16 v[108:111], a[128:131], a[172:175], v[108:111]
s_add_u32 s81, s81, s3
ds_read_b128 a[100:103], v17 offset:832
v_mfma_f32_16x16x32_bf16 v[108:111], a[132:135], a[168:171], v[108:111]
s_mul_i32 s81, s81, 57344
ds_read_b128 a[244:247], v31 offset:5120
v_mfma_f32_16x16x32_bf16 v[108:111], a[136:139], a[164:167], v[108:111]
s_cmp_eq_u32 s24, 1
ds_read_b64_tr_b16 a[72:73], v16 offset:1160
v_mfma_f32_16x16x32_bf16 v[108:111], a[140:143], a[160:163], v[108:111]
s_cselect_b32 s80, s28, s70
ds_read_b64_tr_b16 a[74:75], v16 offset:1152
v_mfma_f32_16x16x32_bf16 v[112:115], a[128:131], a[176:179], v[112:115]
s_add_u32 s77, s76, 8192
ds_read_b128 a[104:107], v17 offset:1344
v_mfma_f32_16x16x32_bf16 v[112:115], a[132:135], a[172:175], v[112:115]
s_lshl_b32 s71, s2, 2
ds_read_b128 a[248:251], v31 offset:6144
v_mfma_f32_16x16x32_bf16 v[112:115], a[136:139], a[168:171], v[112:115]
s_add_u32 s71, s71, 94384128
ds_read_b64_tr_b16 a[76:77], v16 offset:1672
v_mfma_f32_16x16x32_bf16 v[112:115], a[140:143], a[164:167], v[112:115]
s_lshl_b32 s78, s29, 16
ds_read_b64_tr_b16 a[78:79], v16 offset:1664
v_mfma_f32_16x16x32_bf16 v[112:115], a[144:147], a[160:163], v[112:115]
s_add_u32 s78, s78, s30
ds_read_b128 a[108:111], v17 offset:1856
v_mfma_f32_16x16x32_bf16 v[116:119], a[128:131], a[180:183], v[116:119]
s_add_u32 s78, s78, 33554432
ds_read_b128 a[252:255], v31 offset:7168
v_mfma_f32_16x16x32_bf16 v[116:119], a[132:135], a[176:179], v[116:119]
s_cmp_eq_u32 s24, 0
ds_read_b64_tr_b16 a[80:81], v16 offset:2184
v_mfma_f32_16x16x32_bf16 v[116:119], a[136:139], a[172:175], v[116:119]
s_cselect_b32 s78, 3221225472, s78
ds_read_b64_tr_b16 a[82:83], v16 offset:2176
v_mfma_f32_16x16x32_bf16 v[116:119], a[140:143], a[168:171], v[116:119]
s_lshl_b32 s22, s21, 3
ds_read_b128 a[112:115], v17 offset:2368
v_mfma_f32_16x16x32_bf16 v[116:119], a[144:147], a[164:167], v[116:119]
PAD_30:
s_cbranch_execz M_tret
s_add_u32 s22, s22, 16384
v_mfma_f32_16x16x32_bf16 v[116:119], a[148:151], a[160:163], v[116:119]
ds_read_b64_tr_b16 a[84:85], v16 offset:2696
v_writelane_b32 v15, s22, 63
v_mfma_f32_16x16x32_bf16 v[120:123], a[128:131], a[184:187], v[120:123]
ds_read_b64_tr_b16 a[86:87], v16 offset:2688
v_mov_b32 v25, 0
v_mfma_f32_16x16x32_bf16 v[120:123], a[132:135], a[180:183], v[120:123]
s_waitcnt vmcnt(0) lgkmcnt(5)
s_barrier
ds_read_b128 a[116:119], v17 offset:2880
v_cmp_gt_u32 vcc, 1, v21
v_mfma_f32_16x16x32_bf16 v[120:123], a[136:139], a[176:179], v[120:123]
s_cbranch_vccnz M_kspin2
M_kok2:
v_mov_b32 v128, 0
v_mov_b32 v129, 0
v_mfma_f32_16x16x32_bf16 v[120:123], a[140:143], a[172:175], v[120:123]
s_mov_b32 m0, s84
ds_read_b64_tr_b16 a[88:89], v16 offset:3208
v_mov_b32 v130, 0
v_mfma_f32_16x16x32_bf16 v[120:123], a[144:147], a[168:171], v[120:123]
ds_read_b64_tr_b16 a[90:91], v16 offset:3200
v_mov_b32 v131, 0
v_mfma_f32_16x16x32_bf16 v[120:123], a[148:151], a[164:167], v[120:123]
ds_read_b128 a[120:123], v17 offset:3392
v_mov_b32 v132, 0
v_mfma_f32_16x16x32_bf16 v[120:123], a[152:155], a[160:163], v[120:123]
buffer_load_dwordx4 v1, s[4:7], s8 offen offset:0 sc1 lds
v_mfma_f32_16x16x32_bf16 v[124:127], a[128:131], a[188:191], v[124:127]
ds_read_b64_tr_b16 a[92:93], v16 offset:3720
v_mov_b32 v133, 0
v_mfma_f32_16x16x32_bf16 v[124:127], a[132:135], a[184:187], v[124:127]
ds_read_b64_tr_b16 a[94:95], v16 offset:3712
v_mov_b32 v134, 0
v_mfma_f32_16x16x32_bf16 v[124:127], a[136:139], a[180:183], v[124:127]
ds_read_b128 a[124:127], v17 offset:3904
v_mov_b32 v135, 0
v_mfma_f32_16x16x32_bf16 v[124:127], a[140:143], a[176:179], v[124:127]
buffer_load_dwordx4 v1, s[4:7], s8 offen offset:1024 sc1 lds
v_mfma_f32_16x16x32_bf16 v[124:127], a[144:147], a[172:175], v[124:127]
buffer_load_dwordx4 v1, s[4:7], s8 offen offset:2048 sc1 lds
v_mfma_f32_16x16x32_bf16 v[124:127], a[148:151], a[168:171], v[124:127]
buffer_load_dwordx4 v1, s[4:7], s8 offen offset:3072 sc1 lds
v_mfma_f32_16x16x32_bf16 v[124:127], a[152:155], a[164:167], v[124:127]
s_add_u32 s8, s8, 4096
v_mov_b32 v136, 0
v_mov_b32 v137, 0
v_mfma_f32_16x16x32_bf16 v[124:127], a[156:159], a[160:163], v[124:127]
s_add_u32 m0, s84, 4096
v_mov_b32 v138, 0
v_mov_b32 v139, 0
v_mfma_f32_16x16x32_bf16 v[96:99], a[64:67], a[96:99], v[96:99]
ds_read_b64_tr_b16 a[128:129], v16 offset:200
v_mov_b32 v140, 0
v_mfma_f32_16x16x32_bf16 v[100:103], a[64:67], a[100:103], v[100:103]
ds_read_b64_tr_b16 a[130:131], v16 offset:192
v_mov_b32 v141, 0
v_mfma_f32_16x16x32_bf16 v[100:103], a[68:71], a[96:99], v[100:103]
ds_read_b128 a[160:163], v17 offset:256
v_mov_b32 v142, 0
v_mfma_f32_16x16x32_bf16 v[104:107], a[64:67], a[104:107], v[104:107]
buffer_load_dwordx4 v1, s[4:7], s8 offen offset:0 sc1 lds
v_mfma_f32_16x16x32_bf16 v[104:107], a[68:71], a[100:103], v[104:107]
ds_read_b64_tr_b16 a[132:133], v16 offset:712
v_mov_b32 v143, 0
v_mfma_f32_16x16x32_bf16 v[104:107], a[72:75], a[96:99], v[104:107]
ds_read_b64_tr_b16 a[134:135], v16 offset:704
v_mov_b32 v144, 0
v_mfma_f32_16x16x32_bf16 v[108:111], a[64:67], a[108:111], v[108:111]
ds_read_b128 a[164:167], v17 offset:768
v_mov_b32 v145, 0
v_mfma_f32_16x16x32_bf16 v[108:111], a[68:71], a[104:107], v[108:111]
buffer_load_dwordx4 v1, s[4:7], s8 offen offset:1024 sc1 lds
v_mfma_f32_16x16x32_bf16 v[108:111], a[72:75], a[100:103], v[108:111]
ds_read_b64_tr_b16 a[136:137], v16 offset:1224
v_mov_b32 v146, 0
v_mfma_f32_16x16x32_bf16 v[108:111], a[76:79], a[96:99], v[108:111]
s_waitcnt lgkmcnt(6)
ds_read_b64_tr_b16 a[138:139], v16 offset:1216
v_mov_b32 v147, 0
v_mfma_f32_16x16x32_bf16 v[112:115], a[64:67], a[112:115], v[112:115]
ds_read_b128 a[168:171], v17 offset:1280
v_mov_b32 v148, 0
v_mfma_f32_16x16x32_bf16 v[112:115], a[68:71], a[108:111], v[112:115]
buffer_load_dwordx4 v1, s[4:7], s8 offen offset:2048 sc1 lds
v_mfma_f32_16x16x32_bf16 v[112:115], a[72:75], a[104:107], v[112:115]
ds_read_b64_tr_b16 a[140:141], v16 offset:1736
v_mov_b32 v149, 0
v_mfma_f32_16x16x32_bf16 v[112:115], a[76:79], a[100:103], v[112:115]
ds_read_b64_tr_b16 a[142:143], v16 offset:1728
v_mov_b32 v150, 0
v_mfma_f32_16x16x32_bf16 v[112:115], a[80:83], a[96:99], v[112:115]
ds_read_b128 a[172:175], v17 offset:1792
v_mov_b32 v151, 0
v_mfma_f32_16x16x32_bf16 v[116:119], a[64:67], a[116:119], v[116:119]
buffer_load_dwordx4 v1, s[4:7], s8 offen offset:3072 sc1 lds
v_mfma_f32_16x16x32_bf16 v[116:119], a[68:71], a[112:115], v[116:119]
s_add_u32 s8, s8, 28672
ds_read_b64_tr_b16 a[144:145], v16 offset:2248
v_mov_b32 v152, 0
v_mfma_f32_16x16x32_bf16 v[116:119], a[72:75], a[108:111], v[116:119]
s_sub_u32 s9, s9, 1
ds_read_b64_tr_b16 a[146:147], v16 offset:2240
v_mov_b32 v153, 0
v_mfma_f32_16x16x32_bf16 v[116:119], a[76:79], a[104:107], v[116:119]
s_cmp_eq_u32 s9, 0
ds_read_b128 a[176:179], v17 offset:2304
v_mov_b32 v154, 0
v_mfma_f32_16x16x32_bf16 v[116:119], a[80:83], a[100:103], v[116:119]
s_cselect_b32 s8, s10, s8
v_mov_b32 v155, 0
v_mov_b32 v156, 0
v_mfma_f32_16x16x32_bf16 v[116:119], a[84:87], a[96:99], v[116:119]
s_cselect_b32 s9, s11, s9
ds_read_b64_tr_b16 a[148:149], v16 offset:2760
v_mov_b32 v157, 0
v_mfma_f32_16x16x32_bf16 v[120:123], a[64:67], a[120:123], v[120:123]
s_cselect_b32 s10, 3221225472, s10
ds_read_b64_tr_b16 a[150:151], v16 offset:2752
v_mov_b32 v158, 0
v_mfma_f32_16x16x32_bf16 v[120:123], a[68:71], a[116:119], v[120:123]
s_mov_b32 m0, s85
ds_read_b128 a[180:183], v17 offset:2816
v_mov_b32 v159, 0
v_mfma_f32_16x16x32_bf16 v[120:123], a[72:75], a[112:115], v[120:123]
buffer_load_dwordx4 v1, s[4:7], s8 offen offset:0 sc1 lds
v_mfma_f32_16x16x32_bf16 v[120:123], a[76:79], a[108:111], v[120:123]
ds_read_b64_tr_b16 a[152:153], v16 offset:3272
v_mov_b32 v160, 0
v_mfma_f32_16x16x32_bf16 v[120:123], a[80:83], a[104:107], v[120:123]
ds_read_b64_tr_b16 a[154:155], v16 offset:3264
v_mov_b32 v161, 0
v_mfma_f32_16x16x32_bf16 v[120:123], a[84:87], a[100:103], v[120:123]
ds_read_b128 a[184:187], v17 offset:3328
v_mov_b32 v162, 0
v_mfma_f32_16x16x32_bf16 v[120:123], a[88:91], a[96:99], v[120:123]
buffer_load_dwordx4 v1, s[4:7], s8 offen offset:1024 sc1 lds
v_mfma_f32_16x16x32_bf16 v[124:127], a[64:67], a[124:127], v[124:127]
ds_read_b64_tr_b16 a[156:157], v16 offset:3784
v_mov_b32 v163, 0
v_mfma_f32_16x16x32_bf16 v[124:127], a[68:71], a[120:123], v[124:127]
ds_read_b64_tr_b16 a[158:159], v16 offset:3776
v_mov_b32 v164, 0
v_mfma_f32_16x16x32_bf16 v[124:127], a[72:75], a[116:119], v[124:127]
ds_read_b128 a[188:191], v17 offset:3840
v_mov_b32 v165, 0
v_mfma_f32_16x16x32_bf16 v[124:127], a[76:79], a[112:115], v[124:127]
buffer_load_dwordx4 v1, s[4:7], s8 offen offset:2048 sc1 lds
v_mfma_f32_16x16x32_bf16 v[124:127], a[80:83], a[108:111], v[124:127]
buffer_load_dwordx4 v1, s[4:7], s8 offen offset:3072 sc1 lds
v_mfma_f32_16x16x32_bf16 v[124:127], a[84:87], a[104:107], v[124:127]
s_add_u32 s8, s8, 4096
v_mov_b32 v166, 0
v_mov_b32 v167, 0
v_mfma_f32_16x16x32_bf16 v[124:127], a[88:91], a[100:103], v[124:127]
s_add_u32 m0, s85, 4096
v_mov_b32 v168, 0
v_mov_b32 v169, 0
v_mfma_f32_16x16x32_bf16 v[124:127], a[92:95], a[96:99], v[124:127]
s_waitcnt lgkmcnt(3)
buffer_load_dwordx4 v1, s[4:7], s8 offen offset:0 sc1 lds
v_mfma_f32_16x16x32_bf16 v[96:99], a[128:131], a[160:163], v[96:99]
ds_read_b64_tr_b16 a[64:65], v16 offset:264
v_mov_b32 v170, 0
v_mfma_f32_16x16x32_bf16 v[100:103], a[128:131], a[164:167], v[100:103]
ds_read_b64_tr_b16 a[66:67], v16 offset:256
v_mov_b32 v171, 0
v_mfma_f32_16x16x32_bf16 v[100:103], a[132:135], a[160:163], v[100:103]
ds_read_b128 a[96:99], v17 offset:192
v_mov_b32 v172, 0
v_mfma_f32_16x16x32_bf16 v[104:107], a[128:131], a[168:171], v[104:107]
buffer_load_dwordx4 v1, s[4:7], s8 offen offset:1024 sc1 lds
v_mfma_f32_16x16x32_bf16 v[104:107], a[132:135], a[164:167], v[104:107]
ds_read_b64_tr_b16 a[68:69], v16 offset:776
v_mov_b32 v173, 0
v_mfma_f32_16x16x32_bf16 v[104:107], a[136:139], a[160:163], v[104:107]
ds_read_b64_tr_b16 a[70:71], v16 offset:768
v_mov_b32 v174, 0
v_mfma_f32_16x16x32_bf16 v[108:111], a[128:131], a[172:175], v[108:111]
ds_read_b128 a[100:103], v17 offset:704
v_mov_b32 v175, 0
v_mfma_f32_16x16x32_bf16 v[108:111], a[132:135], a[168:171], v[108:111]
buffer_load_dwordx4 v1, s[4:7], s8 offen offset:2048 sc1 lds
v_mfma_f32_16x16x32_bf16 v[108:111], a[136:139], a[164:167], v[108:111]
ds_read_b64_tr_b16 a[72:73], v16 offset:1288
v_mov_b32 v176, 0
v_mfma_f32_16x16x32_bf16 v[108:111], a[140:143], a[160:163], v[108:111]
ds_read_b64_tr_b16 a[74:75], v16 offset:1280
v_mov_b32 v177, 0
v_mfma_f32_16x16x32_bf16 v[112:115], a[128:131], a[176:179], v[112:115]
ds_read_b128 a[104:107], v17 offset:1216
v_mov_b32 v178, 0
v_mfma_f32_16x16x32_bf16 v[112:115], a[132:135], a[172:175], v[112:115]
buffer_load_dwordx4 v1, s[4:7], s8 offen offset:3072 sc1 lds
v_mfma_f32_16x16x32_bf16 v[112:115], a[136:139], a[168:171], v[112:115]
s_add_u32 s8, s8, 28672
ds_read_b64_tr_b16 a[76:77], v16 offset:1800
v_mov_b32 v179, 0
v_mfma_f32_16x16x32_bf16 v[112:115], a[140:143], a[164:167], v[112:115]
s_sub_u32 s9, s9, 1
ds_read_b64_tr_b16 a[78:79], v16 offset:1792
v_mov_b32 v180, 0
v_mfma_f32_16x16x32_bf16 v[112:115], a[144:147], a[160:163], v[112:115]
s_cmp_eq_u32 s9, 0
ds_read_b128 a[108:111], v17 offset:1728
v_mov_b32 v181, 0
v_mfma_f32_16x16x32_bf16 v[116:119], a[128:131], a[180:183], v[116:119]
s_cselect_b32 s8, s10, s8
buffer_load_dword v14, v15, s[4:7], s70 offen sc1
v_mfma_f32_16x16x32_bf16 v[116:119], a[132:135], a[176:179], v[116:119]
s_cselect_b32 s9, s11, s9
ds_read_b64_tr_b16 a[80:81], v16 offset:2312
v_mov_b32 v182, 0
v_mfma_f32_16x16x32_bf16 v[116:119], a[136:139], a[172:175], v[116:119]
s_cselect_b32 s10, 3221225472, s10
ds_read_b64_tr_b16 a[82:83], v16 offset:2304
v_mov_b32 v183, 0
v_mfma_f32_16x16x32_bf16 v[116:119], a[140:143], a[168:171], v[116:119]
ds_read_b128 a[112:115], v17 offset:2240
v_mov_b32 v184, 0
v_mfma_f32_16x16x32_bf16 v[116:119], a[144:147], a[164:167], v[116:119]
v_mov_b32 v185, 0
v_mov_b32 v186, 0
v_mfma_f32_16x16x32_bf16 v[116:119], a[148:151], a[160:163], v[116:119]
ds_read_b64_tr_b16 a[84:85], v16 offset:2824
v_mov_b32 v187, 0
v_mfma_f32_16x16x32_bf16 v[120:123], a[128:131], a[184:187], v[120:123]
ds_read_b64_tr_b16 a[86:87], v16 offset:2816
v_mov_b32 v188, 0
v_mfma_f32_16x16x32_bf16 v[120:123], a[132:135], a[180:183], v[120:123]
ds_read_b128 a[116:119], v17 offset:2752
v_mov_b32 v189, 0
v_mfma_f32_16x16x32_bf16 v[120:123], a[136:139], a[176:179], v[120:123]
v_mov_b32 v190, 0
v_mov_b32 v191, 0
v_mfma_f32_16x16x32_bf16 v[120:123], a[140:143], a[172:175], v[120:123]
ds_read_b64_tr_b16 a[88:89], v16 offset:3336
v_mov_b32 v192, 0
v_mfma_f32_16x16x32_bf16 v[120:123], a[144:147], a[168:171], v[120:123]
ds_read_b64_tr_b16 a[90:91], v16 offset:3328
v_mov_b32 v193, 0
v_mfma_f32_16x16x32_bf16 v[120:123], a[148:151], a[164:167], v[120:123]
ds_read_b128 a[120:123], v17 offset:3264
v_mov_b32 v194, 0
v_mfma_f32_16x16x32_bf16 v[120:123], a[152:155], a[160:163], v[120:123]
s_waitcnt lgkmcnt(6)
v_mov_b32 v195, 0
v_mov_b32 v196, 0
v_mfma_f32_16x16x32_bf16 v[124:127], a[128:131], a[188:191], v[124:127]
ds_read_b64_tr_b16 a[92:93], v16 offset:3848
v_mov_b32 v197, 0
v_mfma_f32_16x16x32_bf16 v[124:127], a[132:135], a[184:187], v[124:127]
ds_read_b64_tr_b16 a[94:95], v16 offset:3840
v_mov_b32 v198, 0
v_mfma_f32_16x16x32_bf16 v[124:127], a[136:139], a[180:183], v[124:127]
ds_read_b128 a[124:127], v17 offset:3776
v_mov_b32 v199, 0
v_mfma_f32_16x16x32_bf16 v[124:127], a[140:143], a[176:179], v[124:127]
v_mov_b32 v200, 0
v_mov_b32 v201, 0
v_mfma_f32_16x16x32_bf16 v[124:127], a[144:147], a[172:175], v[124:127]
v_mov_b32 v202, 0
v_mov_b32 v203, 0
v_mfma_f32_16x16x32_bf16 v[124:127], a[148:151], a[168:171], v[124:127]
v_mov_b32 v204, 0
v_mov_b32 v205, 0
v_mfma_f32_16x16x32_bf16 v[124:127], a[152:155], a[164:167], v[124:127]
v_mov_b32 v206, 0
v_mov_b32 v207, 0
v_mfma_f32_16x16x32_bf16 v[124:127], a[156:159], a[160:163], v[124:127]
v_mov_b32 v208, 0
v_mov_b32 v209, 0
s_waitcnt vmcnt(0)
v_cmp_gt_u32 vcc, 1, v14
s_cbranch_vccnz M_cspin
M_cok:
v_mfma_f32_16x16x32_bf16 v[96:99], a[64:67], a[96:99], v[96:99]
s_add_u32 s22, s78, 0
ds_read_b64_tr_b16 a[128:129], v16 offset:328
v_mov_b32 v210, 0
v_mfma_f32_16x16x32_bf16 v[100:103], a[64:67], a[100:103], v[100:103]
ds_read_b64_tr_b16 a[130:131], v16 offset:320
v_mov_b32 v211, 0
v_mfma_f32_16x16x32_bf16 v[100:103], a[68:71], a[96:99], v[100:103]
ds_read_b128 a[160:163], v17 offset:128
v_mov_b32 v212, 0
v_mfma_f32_16x16x32_bf16 v[104:107], a[64:67], a[104:107], v[104:107]
buffer_load_dwordx4 a[0:3], v1, s[4:7], s22 offen offset:0 sc1
v_mfma_f32_16x16x32_bf16 v[104:107], a[68:71], a[100:103], v[104:107]
ds_read_b64_tr_b16 a[132:133], v16 offset:840
v_mov_b32 v213, 0
v_mfma_f32_16x16x32_bf16 v[104:107], a[72:75], a[96:99], v[104:107]
ds_read_b64_tr_b16 a[134:135], v16 offset:832
v_mov_b32 v214, 0
v_mfma_f32_16x16x32_bf16 v[108:111], a[64:67], a[108:111], v[108:111]
ds_read_b128 a[164:167], v17 offset:640
v_mov_b32 v215, 0
v_mfma_f32_16x16x32_bf16 v[108:111], a[68:71], a[104:107], v[108:111]
buffer_load_dwordx4 a[4:7], v1, s[4:7], s22 offen offset:1024 sc1
v_mfma_f32_16x16x32_bf16 v[108:111], a[72:75], a[100:103], v[108:111]
ds_read_b64_tr_b16 a[136:137], v16 offset:1352
v_mov_b32 v216, 0
v_mfma_f32_16x16x32_bf16 v[108:111], a[76:79], a[96:99], v[108:111]
ds_read_b64_tr_b16 a[138:139], v16 offset:1344
v_mov_b32 v217, 0
v_mfma_f32_16x16x32_bf16 v[112:115], a[64:67], a[112:115], v[112:115]
ds_read_b128 a[168:171], v17 offset:1152
v_mov_b32 v218, 0
v_mfma_f32_16x16x32_bf16 v[112:115], a[68:71], a[108:111], v[112:115]
buffer_load_dwordx4 a[8:11], v1, s[4:7], s22 offen offset:2048 sc1
v_mfma_f32_16x16x32_bf16 v[112:115], a[72:75], a[104:107], v[112:115]
ds_read_b64_tr_b16 a[140:141], v16 offset:1864
v_mov_b32 v219, 0
v_mfma_f32_16x16x32_bf16 v[112:115], a[76:79], a[100:103], v[112:115]
ds_read_b64_tr_b16 a[142:143], v16 offset:1856
v_mov_b32 v220, 0
v_mfma_f32_16x16x32_bf16 v[112:115], a[80:83], a[96:99], v[112:115]
s_waitcnt lgkmcnt(6)
ds_read_b128 a[172:175], v17 offset:1664
v_mov_b32 v221, 0
v_mfma_f32_16x16x32_bf16 v[116:119], a[64:67], a[116:119], v[116:119]
buffer_load_dwordx4 a[12:15], v1, s[4:7], s22 offen offset:3072 sc1
v_mfma_f32_16x16x32_bf16 v[116:119], a[68:71], a[112:115], v[116:119]
s_add_u32 s22, s78, 4096
ds_read_b64_tr_b16 a[144:145], v16 offset:2376
v_mov_b32 v222, 0
v_mfma_f32_16x16x32_bf16 v[116:119], a[72:75], a[108:111], v[116:119]
ds_read_b64_tr_b16 a[146:147], v16 offset:2368
v_mov_b32 v223, 0
v_mfma_f32_16x16x32_bf16 v[116:119], a[76:79], a[104:107], v[116:119]
ds_read_b128 a[176:179], v17 offset:2176
v_mov_b32 v224, 0
v_mfma_f32_16x16x32_bf16 v[116:119], a[80:83], a[100:103], v[116:119]
buffer_load_dwordx4 a[16:19], v1, s[4:7], s22 offen offset:0 sc1
v_mfma_f32_16x16x32_bf16 v[116:119], a[84:87], a[96:99], v[116:119]
ds_read_b64_tr_b16 a[148:149], v16 offset:2888
v_mov_b32 v225, 0
v_mfma_f32_16x16x32_bf16 v[120:123], a[64:67], a[120:123], v[120:123]
ds_read_b64_tr_b16 a[150:151], v16 offset:2880
v_mov_b32 v226, 0
v_mfma_f32_16x16x32_bf16 v[120:123], a[68:71], a[116:119], v[120:123]
ds_read_b128 a[180:183], v17 offset:2688
v_mov_b32 v227, 0
v_mfma_f32_16x16x32_bf16 v[120:123], a[72:75], a[112:115], v[120:123]
buffer_load_dwordx4 a[20:23], v1, s[4:7], s22 offen offset:1024 sc1
v_mfma_f32_16x16x32_bf16 v[120:123], a[76:79], a[108:111], v[120:123]
ds_read_b64_tr_b16 a[152:153], v16 offset:3400
v_mov_b32 v228, 0
v_mfma_f32_16x16x32_bf16 v[120:123], a[80:83], a[104:107], v[120:123]
ds_read_b64_tr_b16 a[154:155], v16 offset:3392
v_mov_b32 v229, 0
v_mfma_f32_16x16x32_bf16 v[120:123], a[84:87], a[100:103], v[120:123]
ds_read_b128 a[184:187], v17 offset:3200
v_mov_b32 v230, 0
v_mfma_f32_16x16x32_bf16 v[120:123], a[88:91], a[96:99], v[120:123]
buffer_load_dwordx4 a[24:27], v1, s[4:7], s22 offen offset:2048 sc1
v_mfma_f32_16x16x32_bf16 v[124:127], a[64:67], a[124:127], v[124:127]
ds_read_b64_tr_b16 a[156:157], v16 offset:3912
v_mov_b32 v231, 0
v_mfma_f32_16x16x32_bf16 v[124:127], a[68:71], a[120:123], v[124:127]
ds_read_b64_tr_b16 a[158:159], v16 offset:3904
v_mov_b32 v232, 0
v_mfma_f32_16x16x32_bf16 v[124:127], a[72:75], a[116:119], v[124:127]
ds_read_b128 a[188:191], v17 offset:3712
v_mov_b32 v233, 0
v_mfma_f32_16x16x32_bf16 v[124:127], a[76:79], a[112:115], v[124:127]
buffer_load_dwordx4 a[28:31], v1, s[4:7], s22 offen offset:3072 sc1
v_mfma_f32_16x16x32_bf16 v[124:127], a[80:83], a[108:111], v[124:127]
s_add_u32 s22, s78, 32768
buffer_load_dwordx4 a[32:35], v1, s[4:7], s22 offen offset:0 sc1
v_mfma_f32_16x16x32_bf16 v[124:127], a[84:87], a[104:107], v[124:127]
buffer_load_dwordx4 a[36:39], v1, s[4:7], s22 offen offset:1024 sc1
v_mfma_f32_16x16x32_bf16 v[124:127], a[88:91], a[100:103], v[124:127]
buffer_load_dwordx4 a[40:43], v1, s[4:7], s22 offen offset:2048 sc1
v_mfma_f32_16x16x32_bf16 v[124:127], a[92:95], a[96:99], v[124:127]
s_waitcnt lgkmcnt(3)
buffer_load_dwordx4 a[44:47], v1, s[4:7], s22 offen offset:3072 sc1
v_mfma_f32_16x16x32_bf16 v[96:99], a[128:131], a[160:163], v[96:99]
s_add_u32 s22, s78, 36864
ds_read_b64_tr_b16 a[64:65], v16 offset:392
v_mov_b32 v234, 0
v_mfma_f32_16x16x32_bf16 v[100:103], a[128:131], a[164:167], v[100:103]
ds_read_b64_tr_b16 a[66:67], v16 offset:384
v_mov_b32 v235, 0
v_mfma_f32_16x16x32_bf16 v[100:103], a[132:135], a[160:163], v[100:103]
ds_read_b128 a[96:99], v17 offset:64
v_mov_b32 v236, 0
v_mfma_f32_16x16x32_bf16 v[104:107], a[128:131], a[168:171], v[104:107]
ds_read_b64 v[36:37], v18 offset:0
v_mov_b32 v237, 0
v_mfma_f32_16x16x32_bf16 v[104:107], a[132:135], a[164:167], v[104:107]
ds_read_b64_tr_b16 a[68:69], v16 offset:904
v_mov_b32 v238, 0
v_mfma_f32_16x16x32_bf16 v[104:107], a[136:139], a[160:163], v[104:107]
ds_read_b64_tr_b16 a[70:71], v16 offset:896
v_mov_b32 v239, 0
v_mfma_f32_16x16x32_bf16 v[108:111], a[128:131], a[172:175], v[108:111]
ds_read_b128 a[100:103], v17 offset:576
v_mov_b32 v240, 0
v_mfma_f32_16x16x32_bf16 v[108:111], a[132:135], a[168:171], v[108:111]
ds_read_b64 v[38:39], v18 offset:512
v_mov_b32 v241, 0
v_mfma_f32_16x16x32_bf16 v[108:111], a[136:139], a[164:167], v[108:111]
ds_read_b64_tr_b16 a[72:73], v16 offset:1416
v_mov_b32 v242, 0
v_mfma_f32_16x16x32_bf16 v[108:111], a[140:143], a[160:163], v[108:111]
ds_read_b64_tr_b16 a[74:75], v16 offset:1408
v_mov_b32 v243, 0
v_mfma_f32_16x16x32_bf16 v[112:115], a[128:131], a[176:179], v[112:115]
ds_read_b128 a[104:107], v17 offset:1088
v_mov_b32 v244, 0
v_mfma_f32_16x16x32_bf16 v[112:115], a[132:135], a[172:175], v[112:115]
ds_read_b64 v[44:45], v18 offset:1024
v_mov_b32 v245, 0
v_mfma_f32_16x16x32_bf16 v[112:115], a[136:139], a[168:171], v[112:115]
ds_read_b64_tr_b16 a[76:77], v16 offset:1928
v_mov_b32 v246, 0
v_mfma_f32_16x16x32_bf16 v[112:115], a[140:143], a[164:167], v[112:115]
ds_read_b64_tr_b16 a[78:79], v16 offset:1920
v_mov_b32 v247, 0
v_mfma_f32_16x16x32_bf16 v[112:115], a[144:147], a[160:163], v[112:115]
ds_read_b128 a[108:111], v17 offset:1600
v_mov_b32 v248, 0
v_mfma_f32_16x16x32_bf16 v[116:119], a[128:131], a[180:183], v[116:119]
ds_read_b64 v[46:47], v18 offset:1536
v_mov_b32 v249, 0
v_mfma_f32_16x16x32_bf16 v[116:119], a[132:135], a[176:179], v[116:119]
ds_read_b64_tr_b16 a[80:81], v16 offset:2440
v_mov_b32 v250, 0
v_mfma_f32_16x16x32_bf16 v[116:119], a[136:139], a[172:175], v[116:119]
ds_read_b64_tr_b16 a[82:83], v16 offset:2432
v_mov_b32 v251, 0
v_mfma_f32_16x16x32_bf16 v[116:119], a[140:143], a[168:171], v[116:119]
ds_read_b128 a[112:115], v17 offset:2112
v_mov_b32 v252, 0
v_mfma_f32_16x16x32_bf16 v[116:119], a[144:147], a[164:167], v[116:119]
ds_read_b64 v[52:53], v18 offset:2048
v_mov_b32 v253, 0
v_mfma_f32_16x16x32_bf16 v[116:119], a[148:151], a[160:163], v[116:119]
ds_read_b64_tr_b16 a[84:85], v16 offset:2952
v_mov_b32 v254, 0
v_mfma_f32_16x16x32_bf16 v[120:123], a[128:131], a[184:187], v[120:123]
ds_read_b64_tr_b16 a[86:87], v16 offset:2944
v_mov_b32 v255, 0
v_mfma_f32_16x16x32_bf16 v[120:123], a[132:135], a[180:183], v[120:123]
ds_read_b128 a[116:119], v17 offset:2624
v_mfma_f32_16x16x32_bf16 v[120:123], a[136:139], a[176:179], v[120:123]
ds_read_b64 v[54:55], v18 offset:2560
v_mfma_f32_16x16x32_bf16 v[120:123], a[140:143], a[172:175], v[120:123]
ds_read_b64_tr_b16 a[88:89], v16 offset:3464
v_mfma_f32_16x16x32_bf16 v[120:123], a[144:147], a[168:171], v[120:123]
ds_read_b64_tr_b16 a[90:91], v16 offset:3456
v_mfma_f32_16x16x32_bf16 v[120:123], a[148:151], a[164:167], v[120:123]
ds_read_b128 a[120:123], v17 offset:3136
v_mfma_f32_16x16x32_bf16 v[120:123], a[152:155], a[160:163], v[120:123]
s_waitcnt lgkmcnt(8)
ds_read_b64 v[60:61], v18 offset:3072
v_mfma_f32_16x16x32_bf16 v[124:127], a[128:131], a[188:191], v[124:127]
ds_read_b64_tr_b16 a[92:93], v16 offset:3976
v_mfma_f32_16x16x32_bf16 v[124:127], a[132:135], a[184:187], v[124:127]
ds_read_b64_tr_b16 a[94:95], v16 offset:3968
v_mfma_f32_16x16x32_bf16 v[124:127], a[136:139], a[180:183], v[124:127]
ds_read_b128 a[124:127], v17 offset:3648
v_mfma_f32_16x16x32_bf16 v[124:127], a[140:143], a[176:179], v[124:127]
ds_read_b64 v[62:63], v18 offset:3584
v_mfma_f32_16x16x32_bf16 v[124:127], a[144:147], a[172:175], v[124:127]
buffer_load_dwordx4 a[48:51], v1, s[4:7], s22 offen offset:0 sc1
v_mfma_f32_16x16x32_bf16 v[124:127], a[148:151], a[168:171], v[124:127]
buffer_load_dwordx4 a[52:55], v1, s[4:7], s22 offen offset:1024 sc1
v_mfma_f32_16x16x32_bf16 v[124:127], a[152:155], a[164:167], v[124:127]
buffer_load_dwordx4 a[56:59], v1, s[4:7], s22 offen offset:2048 sc1
v_mfma_f32_16x16x32_bf16 v[124:127], a[156:159], a[160:163], v[124:127]
buffer_load_dwordx4 a[60:63], v1, s[4:7], s22 offen offset:3072 sc1
v_mfma_f32_16x16x32_bf16 v[96:99], a[64:67], a[96:99], v[96:99]
ds_read_b64_tr_b16 a[128:129], v16 offset:456
v_mfma_f32_16x16x32_bf16 v[100:103], a[64:67], a[100:103], v[100:103]
ds_read_b64_tr_b16 a[130:131], v16 offset:448
v_mfma_f32_16x16x32_bf16 v[100:103], a[68:71], a[96:99], v[100:103]
ds_read_b128 a[160:163], v17 offset:0
v_mfma_f32_16x16x32_bf16 v[104:107], a[64:67], a[104:107], v[104:107]
v_mfma_f32_16x16x32_bf16 v[104:107], a[68:71], a[100:103], v[104:107]
ds_read_b64_tr_b16 a[132:133], v16 offset:968
v_mfma_f32_16x16x32_bf16 v[104:107], a[72:75], a[96:99], v[104:107]
ds_read_b64_tr_b16 a[134:135], v16 offset:960
v_mfma_f32_16x16x32_bf16 v[108:111], a[64:67], a[108:111], v[108:111]
ds_read_b128 a[164:167], v17 offset:512
v_mfma_f32_16x16x32_bf16 v[108:111], a[68:71], a[104:107], v[108:111]
v_mfma_f32_16x16x32_bf16 v[108:111], a[72:75], a[100:103], v[108:111]
ds_read_b64_tr_b16 a[136:137], v16 offset:1480
v_mfma_f32_16x16x32_bf16 v[108:111], a[76:79], a[96:99], v[108:111]
ds_read_b64_tr_b16 a[138:139], v16 offset:1472
v_mfma_f32_16x16x32_bf16 v[112:115], a[64:67], a[112:115], v[112:115]
ds_read_b128 a[168:171], v17 offset:1024
v_mfma_f32_16x16x32_bf16 v[112:115], a[68:71], a[108:111], v[112:115]
v_mfma_f32_16x16x32_bf16 v[112:115], a[72:75], a[104:107], v[112:115]
ds_read_b64_tr_b16 a[140:141], v16 offset:1992
v_mfma_f32_16x16x32_bf16 v[112:115], a[76:79], a[100:103], v[112:115]
ds_read_b64_tr_b16 a[142:143], v16 offset:1984
v_mfma_f32_16x16x32_bf16 v[112:115], a[80:83], a[96:99], v[112:115]
s_waitcnt lgkmcnt(6)
ds_read_b128 a[172:175], v17 offset:1536
v_mfma_f32_16x16x32_bf16 v[116:119], a[64:67], a[116:119], v[116:119]
v_mfma_f32_16x16x32_bf16 v[116:119], a[68:71], a[112:115], v[116:119]
ds_read_b64_tr_b16 a[144:145], v16 offset:2504
v_mfma_f32_16x16x32_bf16 v[116:119], a[72:75], a[108:111], v[116:119]
ds_read_b64_tr_b16 a[146:147], v16 offset:2496
v_mfma_f32_16x16x32_bf16 v[116:119], a[76:79], a[104:107], v[116:119]
ds_read_b128 a[176:179], v17 offset:2048
v_mfma_f32_16x16x32_bf16 v[116:119], a[80:83], a[100:103], v[116:119]
v_mfma_f32_16x16x32_bf16 v[116:119], a[84:87], a[96:99], v[116:119]
ds_read_b64_tr_b16 a[148:149], v16 offset:3016
v_mfma_f32_16x16x32_bf16 v[120:123], a[64:67], a[120:123], v[120:123]
ds_read_b64_tr_b16 a[150:151], v16 offset:3008
v_mfma_f32_16x16x32_bf16 v[120:123], a[68:71], a[116:119], v[120:123]
ds_read_b128 a[180:183], v17 offset:2560
v_mfma_f32_16x16x32_bf16 v[120:123], a[72:75], a[112:115], v[120:123]
v_mfma_f32_16x16x32_bf16 v[120:123], a[76:79], a[108:111], v[120:123]
ds_read_b64_tr_b16 a[152:153], v16 offset:3528
v_mfma_f32_16x16x32_bf16 v[120:123], a[80:83], a[104:107], v[120:123]
ds_read_b64_tr_b16 a[154:155], v16 offset:3520
v_mfma_f32_16x16x32_bf16 v[120:123], a[84:87], a[100:103], v[120:123]
ds_read_b128 a[184:187], v17 offset:3072
v_mfma_f32_16x16x32_bf16 v[120:123], a[88:91], a[96:99], v[120:123]
v_mfma_f32_16x16x32_bf16 v[124:127], a[64:67], a[124:127], v[124:127]
ds_read_b64_tr_b16 a[156:157], v16 offset:4040
v_mfma_f32_16x16x32_bf16 v[124:127], a[68:71], a[120:123], v[124:127]
ds_read_b64_tr_b16 a[158:159], v16 offset:4032
v_mfma_f32_16x16x32_bf16 v[124:127], a[72:75], a[116:119], v[124:127]
ds_read_b128 a[188:191], v17 offset:3584
v_mfma_f32_16x16x32_bf16 v[124:127], a[76:79], a[112:115], v[124:127]
v_mfma_f32_16x16x32_bf16 v[124:127], a[80:83], a[108:111], v[124:127]
v_mfma_f32_16x16x32_bf16 v[124:127], a[84:87], a[104:107], v[124:127]
v_mfma_f32_16x16x32_bf16 v[124:127], a[88:91], a[100:103], v[124:127]
v_mfma_f32_16x16x32_bf16 v[124:127], a[92:95], a[96:99], v[124:127]
v_mfma_f32_16x16x32_bf16 v[96:99], a[128:131], a[160:163], v[96:99]
s_waitcnt lgkmcnt(3)
v_mfma_f32_16x16x32_bf16 v[100:103], a[128:131], a[164:167], v[100:103]
v_mfma_f32_16x16x32_bf16 v[100:103], a[132:135], a[160:163], v[100:103]
v_mfma_f32_16x16x32_bf16 v[104:107], a[128:131], a[168:171], v[104:107]
v_mfma_f32_16x16x32_bf16 v[104:107], a[132:135], a[164:167], v[104:107]
v_mfma_f32_16x16x32_bf16 v[104:107], a[136:139], a[160:163], v[104:107]
v_mfma_f32_16x16x32_bf16 v[108:111], a[128:131], a[172:175], v[108:111]
v_mfma_f32_16x16x32_bf16 v[108:111], a[132:135], a[168:171], v[108:111]
v_mfma_f32_16x16x32_bf16 v[108:111], a[136:139], a[164:167], v[108:111]
v_lshlrev_b32 v10, 16, v36
v_fmac_f32 v96, v19, v10
v_mfma_f32_16x16x32_bf16 v[108:111], a[140:143], a[160:163], v[108:111]
v_and_b32 v11, 0xffff0000, v36
v_fmac_f32 v97, v19, v11
v_mfma_f32_16x16x32_bf16 v[112:115], a[128:131], a[176:179], v[112:115]
v_lshlrev_b32 v12, 16, v37
v_fmac_f32 v98, v19, v12
v_mfma_f32_16x16x32_bf16 v[112:115], a[132:135], a[172:175], v[112:115]
v_and_b32 v13, 0xffff0000, v37
v_fmac_f32 v99, v19, v13
v_mfma_f32_16x16x32_bf16 v[112:115], a[136:139], a[168:171], v[112:115]
v_cvt_pk_bf16_f32 v96, v96, v97
v_cvt_pk_bf16_f32 v97, v98, v99
v_mfma_f32_16x16x32_bf16 v[112:115], a[140:143], a[164:167], v[112:115]
buffer_store_dwordx2 v[96:97], v8, s[4:7], s83 offen offset:0 sc1
v_mfma_f32_16x16x32_bf16 v[112:115], a[144:147], a[160:163], v[112:115]
v_lshlrev_b32 v10, 16, v38
v_fmac_f32 v100, v19, v10
v_mfma_f32_16x16x32_bf16 v[116:119], a[128:131], a[180:183], v[116:119]
v_and_b32 v11, 0xffff0000, v38
v_fmac_f32 v101, v19, v11
v_mfma_f32_16x16x32_bf16 v[116:119], a[132:135], a[176:179], v[116:119]
v_lshlrev_b32 v12, 16, v39
v_fmac_f32 v102, v19, v12
v_mfma_f32_16x16x32_bf16 v[116:119], a[136:139], a[172:175], v[116:119]
v_and_b32 v13, 0xffff0000, v39
v_fmac_f32 v103, v19, v13
v_mfma_f32_16x16x32_bf16 v[116:119], a[140:143], a[168:171], v[116:119]
v_cvt_pk_bf16_f32 v100, v100, v101
v_cvt_pk_bf16_f32 v101, v102, v103
v_mfma_f32_16x16x32_bf16 v[116:119], a[144:147], a[164:167], v[116:119]
buffer_store_dwordx2 v[100:101], v8, s[4:7], s83 offen offset:512 sc1
v_mfma_f32_16x16x32_bf16 v[116:119], a[148:151], a[160:163], v[116:119]
v_lshlrev_b32 v10, 16, v44
v_fmac_f32 v104, v19, v10
v_mfma_f32_16x16x32_bf16 v[120:123], a[128:131], a[184:187], v[120:123]
v_and_b32 v11, 0xffff0000, v44
v_fmac_f32 v105, v19, v11
v_mfma_f32_16x16x32_bf16 v[120:123], a[132:135], a[180:183], v[120:123]
v_lshlrev_b32 v12, 16, v45
v_fmac_f32 v106, v19, v12
v_mfma_f32_16x16x32_bf16 v[120:123], a[136:139], a[176:179], v[120:123]
v_and_b32 v13, 0xffff0000, v45
v_fmac_f32 v107, v19, v13
v_mfma_f32_16x16x32_bf16 v[120:123], a[140:143], a[172:175], v[120:123]
v_cvt_pk_bf16_f32 v104, v104, v105
v_cvt_pk_bf16_f32 v105, v106, v107
v_mfma_f32_16x16x32_bf16 v[120:123], a[144:147], a[168:171], v[120:123]
PAD_31:
s_cbranch_execz M_tret
buffer_store_dwordx2 v[104:105], v8, s[4:7], s83 offen offset:1024 sc1
v_mfma_f32_16x16x32_bf16 v[120:123], a[148:151], a[164:167], v[120:123]
v_lshlrev_b32 v10, 16, v46
v_fmac_f32 v108, v19, v10
v_mfma_f32_16x16x32_bf16 v[120:123], a[152:155], a[160:163], v[120:123]
s_waitcnt lgkmcnt(0)
v_and_b32 v11, 0xffff0000, v46
v_fmac_f32 v109, v19, v11
v_mfma_f32_16x16x32_bf16 v[124:127], a[128:131], a[188:191], v[124:127]
v_lshlrev_b32 v12, 16, v47
v_fmac_f32 v110, v19, v12
v_mfma_f32_16x16x32_bf16 v[124:127], a[132:135], a[184:187], v[124:127]
v_and_b32 v13, 0xffff0000, v47
v_fmac_f32 v111, v19, v13
v_mfma_f32_16x16x32_bf16 v[124:127], a[136:139], a[180:183], v[124:127]
v_cvt_pk_bf16_f32 v108, v108, v109
v_cvt_pk_bf16_f32 v109, v110, v111
v_mfma_f32_16x16x32_bf16 v[124:127], a[140:143], a[176:179], v[124:127]
buffer_store_dwordx2 v[108:109], v8, s[4:7], s83 offen offset:1536 sc1
v_mfma_f32_16x16x32_bf16 v[124:127], a[144:147], a[172:175], v[124:127]
v_lshlrev_b32 v10, 16, v52
v_fmac_f32 v112, v19, v10
v_mfma_f32_16x16x32_bf16 v[124:127], a[148:151], a[168:171], v[124:127]
v_and_b32 v11, 0xffff0000, v52
v_fmac_f32 v113, v19, v11
v_mfma_f32_16x16x32_bf16 v[124:127], a[152:155], a[164:167], v[124:127]
v_lshlrev_b32 v12, 16, v53
v_fmac_f32 v114, v19, v12
v_mfma_f32_16x16x32_bf16 v[124:127], a[156:159], a[160:163], v[124:127]
v_and_b32 v13, 0xffff0000, v53
v_fmac_f32 v115, v19, v13
v_cvt_pk_bf16_f32 v112, v112, v113
v_cvt_pk_bf16_f32 v113, v114, v115
buffer_store_dwordx2 v[112:113], v8, s[4:7], s83 offen offset:2048 sc1
v_lshlrev_b32 v10, 16, v54
v_fmac_f32 v116, v19, v10
v_and_b32 v11, 0xffff0000, v54
v_fmac_f32 v117, v19, v11
v_lshlrev_b32 v12, 16, v55
v_fmac_f32 v118, v19, v12
v_and_b32 v13, 0xffff0000, v55
v_fmac_f32 v119, v19, v13
v_cvt_pk_bf16_f32 v116, v116, v117
v_cvt_pk_bf16_f32 v117, v118, v119
buffer_store_dwordx2 v[116:117], v8, s[4:7], s83 offen offset:2560 sc1
v_lshlrev_b32 v10, 16, v60
v_fmac_f32 v120, v19, v10
v_and_b32 v11, 0xffff0000, v60
v_fmac_f32 v121, v19, v11
v_lshlrev_b32 v12, 16, v61
v_fmac_f32 v122, v19, v12
v_and_b32 v13, 0xffff0000, v61
v_fmac_f32 v123, v19, v13
v_cvt_pk_bf16_f32 v120, v120, v121
v_cvt_pk_bf16_f32 v121, v122, v123
buffer_store_dwordx2 v[120:121], v8, s[4:7], s83 offen offset:3072 sc1
v_lshlrev_b32 v10, 16, v62
v_fmac_f32 v124, v19, v10
v_and_b32 v11, 0xffff0000, v62
v_fmac_f32 v125, v19, v11
v_lshlrev_b32 v12, 16, v63
v_fmac_f32 v126, v19, v12
v_and_b32 v13, 0xffff0000, v63
v_fmac_f32 v127, v19, v13
v_cvt_pk_bf16_f32 v124, v124, v125
v_cvt_pk_bf16_f32 v125, v126, v127
buffer_store_dwordx2 v[124:125], v8, s[4:7], s83 offen offset:3584 sc1
v_lshrrev_b32 v8, 7, v1
v_and_b32 v9, 6, v8
v_lshlrev_b32 v9, 4, v9
v_and_b32 v10, 0x70, v1
v_xor_b32 v9, v9, v10
v_mul_u32_u24 v8, 896, v8
v_add_u32 v8, v8, v9
v_accvgpr_write_b32 a184, v8
v_add_u32 v8, 6144, v8
v_accvgpr_write_b32 a185, v8
v_add_u32 v8, 6144, v8
v_accvgpr_write_b32 a186, v8
v_add_u32 v8, 6144, v8
v_accvgpr_write_b32 a187, v8
v_lshrrev_b32 v8, 6, v1
v_bfe_u32 v9, v1, 7, 2
v_lshlrev_b32 v9, 5, v9
v_lshl_add_u32 v8, v8, 7, v9
v_bfe_u32 v9, v1, 4, 2
v_lshl_add_u32 v8, v9, 3, v8
v_add_u32 v8, 32768, v8
v_accvgpr_write_b32 a188, v8
v_xor_b32 v9, 32, v8
v_accvgpr_write_b32 a189, v9
v_xor_b32 v9, 64, v8
v_accvgpr_write_b32 a190, v9
v_xor_b32 v9, 96, v8
v_accvgpr_write_b32 a191, v9
s_branch M_t2B
M_t2Br:
s_waitcnt vmcnt(8)
s_barrier
s_cmp_lg_u32 s24, 0
s_cbranch_scc1 K2_item
v_accvgpr_mov_b32 a0, a192
v_accvgpr_mov_b32 a1, a193
v_accvgpr_mov_b32 a2, a194
v_accvgpr_mov_b32 a3, a195
v_accvgpr_mov_b32 a4, a196
v_accvgpr_mov_b32 a5, a197
v_accvgpr_mov_b32 a6, a198
v_accvgpr_mov_b32 a7, a199
v_accvgpr_mov_b32 a8, a200
v_accvgpr_mov_b32 a9, a201
v_accvgpr_mov_b32 a10, a202
v_accvgpr_mov_b32 a11, a203
v_accvgpr_mov_b32 a12, a204
v_accvgpr_mov_b32 a13, a205
v_accvgpr_mov_b32 a14, a206
v_accvgpr_mov_b32 a15, a207
v_accvgpr_mov_b32 a16, a208
v_accvgpr_mov_b32 a17, a209
v_accvgpr_mov_b32 a18, a210
v_accvgpr_mov_b32 a19, a211
v_accvgpr_mov_b32 a20, a212
v_accvgpr_mov_b32 a21, a213
v_accvgpr_mov_b32 a22, a214
v_accvgpr_mov_b32 a23, a215
v_accvgpr_mov_b32 a24, a216
v_accvgpr_mov_b32 a25, a217
v_accvgpr_mov_b32 a26, a218
v_accvgpr_mov_b32 a27, a219
v_accvgpr_mov_b32 a28, a220
v_accvgpr_mov_b32 a29, a221
v_accvgpr_mov_b32 a30, a222
v_accvgpr_mov_b32 a31, a223
v_accvgpr_mov_b32 a32, a224
v_accvgpr_mov_b32 a33, a225
v_accvgpr_mov_b32 a34, a226
v_accvgpr_mov_b32 a35, a227
v_accvgpr_mov_b32 a36, a228
v_accvgpr_mov_b32 a37, a229
v_accvgpr_mov_b32 a38, a230
v_accvgpr_mov_b32 a39, a231
v_accvgpr_mov_b32 a40, a232
v_accvgpr_mov_b32 a41, a233
v_accvgpr_mov_b32 a42, a234
v_accvgpr_mov_b32 a43, a235
v_accvgpr_mov_b32 a44, a236
v_accvgpr_mov_b32 a45, a237
v_accvgpr_mov_b32 a46, a238
v_accvgpr_mov_b32 a47, a239
v_accvgpr_mov_b32 a48, a240
v_accvgpr_mov_b32 a49, a241
v_accvgpr_mov_b32 a50, a242
v_accvgpr_mov_b32 a51, a243
v_accvgpr_mov_b32 a52, a244
v_accvgpr_mov_b32 a53, a245
v_accvgpr_mov_b32 a54, a246
v_accvgpr_mov_b32 a55, a247
v_accvgpr_mov_b32 a56, a248
v_accvgpr_mov_b32 a57, a249
v_accvgpr_mov_b32 a58, a250
v_accvgpr_mov_b32 a59, a251
v_accvgpr_mov_b32 a60, a252
v_accvgpr_mov_b32 a61, a253
v_accvgpr_mov_b32 a62, a254
v_accvgpr_mov_b32 a63, a255
s_branch K2_item
M_cend:
M_cspin:
Lp_16:
buffer_load_dword v14, v15, s[4:7], s70 offen sc1
s_waitcnt vmcnt(0)
v_cmp_gt_u32 vcc, 1, v14
s_cbranch_vccz Lpd_17
s_sleep 8
s_sub_u32 s101, s101, 1
s_cbranch_scc0 Lp_16
s_mov_b32 s101, 0
Lpd_17:
s_branch M_cok
M_kspin:
Lp_18:
buffer_load_dword v21, v20, s[4:7], s70 offen sc1
s_waitcnt vmcnt(0)
v_cmp_gt_u32 vcc, 1, v21
s_cbranch_vccz Lpd_19
s_sleep 8
s_sub_u32 s101, s101, 1
s_cbranch_scc0 Lp_18
s_mov_b32 s101, 0
Lpd_19:
s_branch M_kok
M_kspin2:
Lp_20:
buffer_load_dword v21, v20, s[4:7], s70 offen sc1
s_waitcnt vmcnt(0)
v_cmp_gt_u32 vcc, 1, v21
s_cbranch_vccz Lpd_21
s_sleep 8
s_sub_u32 s101, s101, 1
s_cbranch_scc0 Lp_20
s_mov_b32 s101, 0
Lpd_21:
s_branch M_kok2
M_vspin:
Lp_22:
buffer_load_dword v21, v15, s[4:7], s70 offen sc1
s_waitcnt vmcnt(0)
v_cmp_gt_u32 vcc, 1, v21
s_cbranch_vccz Lpd_23
s_sleep 8
s_sub_u32 s101, s101, 1
s_cbranch_scc0 Lp_22
s_mov_b32 s101, 0
Lpd_23:
s_branch M_vok
PAD_32:
s_cbranch_execz M_tret
K2_plain:
v_mfma_f32_16x16x32_bf16 v[128:131], a[64:67], v[96:99], v[128:131]
s_waitcnt lgkmcnt(6)
ds_read_b128 a[96:99], v2 offset:8192
v_add_f32 v24, v24, v26
v_mfma_f32_16x16x32_bf16 v[128:131], a[68:71], v[100:103], v[128:131]
s_waitcnt lgkmcnt(5)
v_mfma_f32_16x16x32_bf16 v[132:135], a[68:71], v[108:111], v[132:135]
s_mov_b64 s[36:37], s[86:87]
ds_read_b128 a[100:103], v2 offset:9216
v_add_f32 v25, v25, v27
v_mfma_f32_16x16x32_bf16 v[132:135], a[64:67], v[104:107], v[132:135]
s_mov_b32 s38, 3670016
v_exp_f32 v8, v68
v_mfma_f32_16x16x32_bf16 v[136:139], a[72:75], v[96:99], v[136:139]
s_mov_b32 s39, 0x20000
ds_read_b128 a[104:107], v2 offset:10240
v_accvgpr_read_b32 v112, a184
v_mfma_f32_16x16x32_bf16 v[136:139], a[76:79], v[100:103], v[136:139]
v_accvgpr_read_b32 v113, a185
v_accvgpr_read_b32 v114, a186
v_mfma_f32_16x16x32_bf16 v[140:143], a[76:79], v[108:111], v[140:143]
ds_read_b128 a[108:111], v2 offset:11264
v_accvgpr_read_b32 v115, a187
v_mfma_f32_16x16x32_bf16 v[140:143], a[72:75], v[104:107], v[140:143]
s_waitcnt lgkmcnt(5)
v_accvgpr_read_b32 v116, a188
v_accvgpr_read_b32 v117, a189
v_mfma_f32_16x16x32_bf16 v[144:147], a[80:83], v[96:99], v[144:147]
ds_read_b128 a[112:115], v2 offset:12288
v_accvgpr_read_b32 v118, a190
v_mfma_f32_16x16x32_bf16 v[144:147], a[84:87], v[100:103], v[144:147]
v_accvgpr_read_b32 v119, a191
v_mfma_f32_16x16x32_bf16 v[148:151], a[84:87], v[108:111], v[148:151]
s_add_u32 m0, s18, 32768
ds_read_b128 a[116:119], v2 offset:13312
v_cvt_pk_bf16_f32 v128, v128, v129
v_mfma_f32_16x16x32_bf16 v[148:151], a[80:83], v[104:107], v[148:151]
buffer_load_dwordx4 v112, s[36:39], s81 offen offset:0 lds
v_mfma_f32_16x16x32_bf16 v[152:155], a[88:91], v[96:99], v[152:155]
s_waitcnt lgkmcnt(4)
ds_read_b128 a[120:123], v2 offset:14336
v_cvt_pk_bf16_f32 v129, v130, v131
v_mfma_f32_16x16x32_bf16 v[152:155], a[92:95], v[100:103], v[152:155]
v_exp_f32 v9, v69
v_mfma_f32_16x16x32_bf16 v[156:159], a[92:95], v[108:111], v[156:159]
ds_read_b128 a[124:127], v2 offset:15360
v_add_f32 v27, v8, v9
v_mfma_f32_16x16x32_bf16 v[156:159], a[88:91], v[104:107], v[156:159]
buffer_load_dwordx4 v113, s[36:39], s81 offen offset:1024 lds
v_mfma_f32_16x16x32_bf16 v[160:163], a[96:99], v[96:99], v[160:163]
ds_read_b128 a[64:67], v2 offset:16384
v_cvt_pk_bf16_f32 v120, v8, v9
v_mfma_f32_16x16x32_bf16 v[160:163], a[100:103], v[100:103], v[160:163]
v_exp_f32 v10, v70
v_mfma_f32_16x16x32_bf16 v[164:167], a[100:103], v[108:111], v[164:167]
ds_read_b128 a[68:71], v2 offset:17408
v_add_f32 v27, v27, v10
v_mfma_f32_16x16x32_bf16 v[164:167], a[96:99], v[104:107], v[164:167]
s_waitcnt lgkmcnt(4)
buffer_load_dwordx4 v114, s[36:39], s81 offen offset:2048 lds
v_mfma_f32_16x16x32_bf16 v[168:171], a[104:107], v[96:99], v[168:171]
ds_read_b128 a[72:75], v2 offset:18432
v_cvt_pk_bf16_f32 v130, v136, v137
v_mfma_f32_16x16x32_bf16 v[168:171], a[108:111], v[100:103], v[168:171]
v_exp_f32 v11, v71
v_mfma_f32_16x16x32_bf16 v[172:175], a[108:111], v[108:111], v[172:175]
ds_read_b128 a[76:79], v2 offset:19456
v_add_f32 v27, v27, v11
v_mfma_f32_16x16x32_bf16 v[172:175], a[104:107], v[104:107], v[172:175]
buffer_load_dwordx4 v115, s[36:39], s81 offen offset:3072 lds
v_mfma_f32_16x16x32_bf16 v[176:179], a[112:115], v[96:99], v[176:179]
ds_read_b128 a[80:83], v2 offset:20480
v_cvt_pk_bf16_f32 v121, v10, v11
v_mfma_f32_16x16x32_bf16 v[176:179], a[116:119], v[100:103], v[176:179]
s_waitcnt lgkmcnt(4)
v_exp_f32 v12, v76
v_mfma_f32_16x16x32_bf16 v[180:183], a[116:119], v[108:111], v[180:183]
s_add_u32 s81, s81, 28672
ds_read_b128 a[84:87], v2 offset:21504
v_add_f32 v27, v27, v12
v_mfma_f32_16x16x32_bf16 v[180:183], a[112:115], v[104:107], v[180:183]
s_add_u32 m0, s18, 36864
v_exp_f32 v13, v77
v_mfma_f32_16x16x32_bf16 v[184:187], a[120:123], v[96:99], v[184:187]
ds_read_b128 a[88:91], v2 offset:22528
v_add_f32 v27, v27, v13
v_mfma_f32_16x16x32_bf16 v[184:187], a[124:127], v[100:103], v[184:187]
buffer_load_dwordx4 v112, s[36:39], s81 offen offset:0 lds
v_mfma_f32_16x16x32_bf16 v[188:191], a[124:127], v[108:111], v[188:191]
ds_read_b128 a[92:95], v2 offset:23552
v_cvt_pk_bf16_f32 v122, v12, v13
v_mfma_f32_16x16x32_bf16 v[188:191], a[120:123], v[104:107], v[188:191]
v_exp_f32 v14, v78
v_mfma_f32_16x16x32_bf16 v[192:195], a[64:67], v[96:99], v[192:195]
s_waitcnt lgkmcnt(4)
ds_read_b128 a[96:99], v2 offset:24576
v_add_f32 v27, v27, v14
v_mfma_f32_16x16x32_bf16 v[192:195], a[68:71], v[100:103], v[192:195]
buffer_load_dwordx4 v113, s[36:39], s81 offen offset:1024 lds
v_mfma_f32_16x16x32_bf16 v[196:199], a[68:71], v[108:111], v[196:199]
ds_read_b128 a[100:103], v2 offset:25600
v_cvt_pk_bf16_f32 v131, v138, v139
v_mfma_f32_16x16x32_bf16 v[196:199], a[64:67], v[104:107], v[196:199]
v_exp_f32 v15, v79
v_mfma_f32_16x16x32_bf16 v[200:203], a[72:75], v[96:99], v[200:203]
ds_read_b128 a[104:107], v2 offset:26624
v_add_f32 v27, v27, v15
v_mfma_f32_16x16x32_bf16 v[200:203], a[76:79], v[100:103], v[200:203]
buffer_load_dwordx4 v114, s[36:39], s81 offen offset:2048 lds
v_mfma_f32_16x16x32_bf16 v[204:207], a[76:79], v[108:111], v[204:207]
ds_read_b128 a[108:111], v2 offset:27648
v_cvt_pk_bf16_f32 v123, v14, v15
v_mfma_f32_16x16x32_bf16 v[204:207], a[72:75], v[104:107], v[204:207]
s_waitcnt lgkmcnt(4)
v_exp_f32 v8, v84
v_mfma_f32_16x16x32_bf16 v[208:211], a[80:83], v[96:99], v[208:211]
ds_read_b128 a[112:115], v2 offset:28672
v_add_f32 v27, v27, v8
v_mfma_f32_16x16x32_bf16 v[208:211], a[84:87], v[100:103], v[208:211]
buffer_load_dwordx4 v115, s[36:39], s81 offen offset:3072 lds
v_mfma_f32_16x16x32_bf16 v[212:215], a[84:87], v[108:111], v[212:215]
ds_read_b128 a[116:119], v2 offset:29696
v_cvt_pk_bf16_f32 v144, v144, v145
v_mfma_f32_16x16x32_bf16 v[212:215], a[80:83], v[104:107], v[212:215]
v_exp_f32 v9, v85
v_mfma_f32_16x16x32_bf16 v[216:219], a[88:91], v[96:99], v[216:219]
s_sub_u32 s81, s81, 28544
ds_read_b128 a[120:123], v2 offset:30720
v_add_f32 v27, v27, v9
v_mfma_f32_16x16x32_bf16 v[216:219], a[92:95], v[100:103], v[216:219]
v_exp_f32 v10, v86
v_mfma_f32_16x16x32_bf16 v[220:223], a[92:95], v[108:111], v[220:223]
s_waitcnt vmcnt(8) lgkmcnt(4)
ds_read_b128 a[124:127], v2 offset:31744
v_cvt_pk_bf16_f32 v124, v8, v9
v_mfma_f32_16x16x32_bf16 v[220:223], a[88:91], v[104:107], v[220:223]
s_barrier
v_mfma_f32_16x16x32_bf16 v[224:227], a[96:99], v[96:99], v[224:227]
ds_read_b128 a[64:67], v1 offset:0
v_add_f32 v27, v27, v10
v_mfma_f32_16x16x32_bf16 v[224:227], a[100:103], v[100:103], v[224:227]
v_exp_f32 v11, v87
v_mfma_f32_16x16x32_bf16 v[228:231], a[100:103], v[108:111], v[228:231]
ds_read_b128 a[68:71], v1 offset:1024
v_add_f32 v27, v27, v11
v_mfma_f32_16x16x32_bf16 v[228:231], a[96:99], v[104:107], v[228:231]
v_exp_f32 v12, v92
v_mfma_f32_16x16x32_bf16 v[232:235], a[104:107], v[96:99], v[232:235]
s_waitcnt lgkmcnt(4)
ds_read_b128 a[72:75], v1 offset:2048
v_cvt_pk_bf16_f32 v125, v10, v11
v_mfma_f32_16x16x32_bf16 v[232:235], a[108:111], v[100:103], v[232:235]
v_exp_f32 v13, v93
v_mfma_f32_16x16x32_bf16 v[236:239], a[108:111], v[108:111], v[236:239]
ds_read_b128 a[76:79], v1 offset:3072
v_add_f32 v27, v27, v12
v_mfma_f32_16x16x32_bf16 v[236:239], a[104:107], v[104:107], v[236:239]
v_exp_f32 v14, v94
v_mfma_f32_16x16x32_bf16 v[240:243], a[112:115], v[96:99], v[240:243]
ds_read_b128 a[80:83], v1 offset:4096
v_add_f32 v27, v27, v13
v_mfma_f32_16x16x32_bf16 v[240:243], a[116:119], v[100:103], v[240:243]
v_exp_f32 v15, v95
v_mfma_f32_16x16x32_bf16 v[244:247], a[116:119], v[108:111], v[244:247]
ds_read_b128 a[84:87], v1 offset:5120
v_cvt_pk_bf16_f32 v126, v12, v13
v_mfma_f32_16x16x32_bf16 v[244:247], a[112:115], v[104:107], v[244:247]
s_waitcnt lgkmcnt(4)
v_add_f32 v27, v27, v14
v_add_f32 v27, v27, v15
v_mfma_f32_16x16x32_bf16 v[248:251], a[120:123], v[96:99], v[248:251]
ds_read_b128 a[88:91], v1 offset:6144
v_cvt_pk_bf16_f32 v127, v14, v15
v_mfma_f32_16x16x32_bf16 v[248:251], a[124:127], v[100:103], v[248:251]
v_cmp_nge_f32 vcc, s25, v27
v_cvt_pk_bf16_f32 v145, v146, v147
v_mfma_f32_16x16x32_bf16 v[252:255], a[124:127], v[108:111], v[252:255]
ds_read_b128 a[92:95], v1 offset:7168
v_cvt_pk_bf16_f32 v146, v152, v153
v_mfma_f32_16x16x32_bf16 v[252:255], a[120:123], v[104:107], v[252:255]
s_waitcnt lgkmcnt(2)
v_cvt_pk_bf16_f32 v147, v154, v155
v_cvt_pk_bf16_f32 v160, v160, v161
s_cbranch_vccnz Lstub_12
Lback_13:
v_mfma_f32_16x16x32_bf16 v[132:135], a[64:67], v[120:123], v[132:135]
s_lshl_b32 s8, s29, 3
ds_read_b128 a[96:99], v1 offset:8192
v_add_f32 v25, v25, v27
v_mfma_f32_16x16x32_bf16 v[132:135], a[68:71], v[124:127], v[132:135]
s_add_u32 s8, s8, s3
ds_read_b128 a[100:103], v1 offset:9216
v_cvt_pk_bf16_f32 v161, v162, v163
v_mfma_f32_16x16x32_bf16 v[140:143], a[72:75], v[120:123], v[140:143]
s_lshl_b32 s8, s8, 4
ds_read_b128 a[104:107], v1 offset:10240
v_cvt_pk_bf16_f32 v162, v168, v169
v_mfma_f32_16x16x32_bf16 v[140:143], a[76:79], v[124:127], v[140:143]
s_add_u32 s8, s8, s20
ds_read_b128 a[108:111], v1 offset:11264
v_cvt_pk_bf16_f32 v163, v170, v171
v_mfma_f32_16x16x32_bf16 v[148:151], a[80:83], v[120:123], v[148:151]
s_mul_i32 s8, s8, 14336
ds_read_b128 a[112:115], v1 offset:12288
v_cvt_pk_bf16_f32 v176, v176, v177
v_mfma_f32_16x16x32_bf16 v[148:151], a[84:87], v[124:127], v[148:151]
s_waitcnt lgkmcnt(5)
s_add_u32 s8, s8, 104857600
ds_read_b128 a[116:119], v1 offset:13312
v_cvt_pk_bf16_f32 v177, v178, v179
v_mfma_f32_16x16x32_bf16 v[156:159], a[88:91], v[120:123], v[156:159]
s_add_u32 s12, s8, 917504
ds_read_b128 a[120:123], v1 offset:14336
v_cvt_pk_bf16_f32 v178, v184, v185
v_mfma_f32_16x16x32_bf16 v[156:159], a[92:95], v[124:127], v[156:159]
s_waitcnt lgkmcnt(6)
ds_read_b128 a[124:127], v1 offset:15360
v_cvt_pk_bf16_f32 v179, v186, v187
v_mfma_f32_16x16x32_bf16 v[164:167], a[96:99], v[120:123], v[164:167]
s_waitcnt lgkmcnt(6)
ds_read_b128 a[64:67], v1 offset:16384
v_cvt_pk_bf16_f32 v192, v192, v193
v_mfma_f32_16x16x32_bf16 v[164:167], a[100:103], v[124:127], v[164:167]
s_waitcnt lgkmcnt(6)
ds_read_b128 a[68:71], v1 offset:17408
v_cvt_pk_bf16_f32 v193, v194, v195
v_mfma_f32_16x16x32_bf16 v[172:175], a[104:107], v[120:123], v[172:175]
s_waitcnt lgkmcnt(6)
ds_read_b128 a[72:75], v1 offset:18432
v_cvt_pk_bf16_f32 v194, v200, v201
v_mfma_f32_16x16x32_bf16 v[172:175], a[108:111], v[124:127], v[172:175]
s_waitcnt lgkmcnt(6)
ds_read_b128 a[76:79], v1 offset:19456
v_cvt_pk_bf16_f32 v195, v202, v203
v_mfma_f32_16x16x32_bf16 v[180:183], a[112:115], v[120:123], v[180:183]
s_waitcnt lgkmcnt(6)
ds_read_b128 a[80:83], v1 offset:20480
v_cvt_pk_bf16_f32 v208, v208, v209
v_mfma_f32_16x16x32_bf16 v[180:183], a[116:119], v[124:127], v[180:183]
s_waitcnt lgkmcnt(6)
ds_read_b128 a[84:87], v1 offset:21504
v_cvt_pk_bf16_f32 v209, v210, v211
v_mfma_f32_16x16x32_bf16 v[188:191], a[120:123], v[120:123], v[188:191]
s_waitcnt lgkmcnt(6)
ds_read_b128 a[88:91], v1 offset:22528
v_cvt_pk_bf16_f32 v210, v216, v217
v_mfma_f32_16x16x32_bf16 v[188:191], a[124:127], v[124:127], v[188:191]
s_waitcnt lgkmcnt(6)
ds_read_b128 a[92:95], v1 offset:23552
v_cvt_pk_bf16_f32 v211, v218, v219
v_mfma_f32_16x16x32_bf16 v[196:199], a[64:67], v[120:123], v[196:199]
s_waitcnt lgkmcnt(6)
ds_read_b128 a[96:99], v1 offset:24576
v_cvt_pk_bf16_f32 v224, v224, v225
v_mfma_f32_16x16x32_bf16 v[196:199], a[68:71], v[124:127], v[196:199]
s_waitcnt lgkmcnt(6)
ds_read_b128 a[100:103], v1 offset:25600
v_cvt_pk_bf16_f32 v225, v226, v227
v_mfma_f32_16x16x32_bf16 v[204:207], a[72:75], v[120:123], v[204:207]
s_waitcnt lgkmcnt(6)
ds_read_b128 a[104:107], v1 offset:26624
v_cvt_pk_bf16_f32 v226, v232, v233
v_mfma_f32_16x16x32_bf16 v[204:207], a[76:79], v[124:127], v[204:207]
s_waitcnt lgkmcnt(6)
ds_read_b128 a[108:111], v1 offset:27648
v_cvt_pk_bf16_f32 v227, v234, v235
v_mfma_f32_16x16x32_bf16 v[212:215], a[80:83], v[120:123], v[212:215]
s_waitcnt lgkmcnt(6)
ds_read_b128 a[112:115], v1 offset:28672
v_cvt_pk_bf16_f32 v240, v240, v241
v_mfma_f32_16x16x32_bf16 v[212:215], a[84:87], v[124:127], v[212:215]
s_waitcnt lgkmcnt(5)
ds_read_b128 a[116:119], v1 offset:29696
v_cvt_pk_bf16_f32 v241, v242, v243
v_mfma_f32_16x16x32_bf16 v[220:223], a[88:91], v[120:123], v[220:223]
s_add_u32 m0, s18, 98304
ds_read_b128 a[120:123], v1 offset:30720
v_cvt_pk_bf16_f32 v242, v248, v249
v_mfma_f32_16x16x32_bf16 v[220:223], a[92:95], v[124:127], v[220:223]
s_waitcnt lgkmcnt(6)
ds_read_b128 a[124:127], v1 offset:31744
v_cvt_pk_bf16_f32 v243, v250, v251
v_mfma_f32_16x16x32_bf16 v[228:231], a[96:99], v[120:123], v[228:231]
s_waitcnt lgkmcnt(6)
buffer_load_dwordx4 v112, s[36:39], s81 offen offset:0 lds
v_mfma_f32_16x16x32_bf16 v[228:231], a[100:103], v[124:127], v[228:231]
s_waitcnt lgkmcnt(5)
buffer_load_dwordx4 v113, s[36:39], s81 offen offset:1024 lds
v_mfma_f32_16x16x32_bf16 v[236:239], a[104:107], v[120:123], v[236:239]
s_waitcnt lgkmcnt(4)
buffer_load_dwordx4 v114, s[36:39], s81 offen offset:2048 lds
v_mfma_f32_16x16x32_bf16 v[236:239], a[108:111], v[124:127], v[236:239]
s_waitcnt lgkmcnt(1)
buffer_load_dwordx4 v115, s[36:39], s81 offen offset:3072 lds
v_mfma_f32_16x16x32_bf16 v[244:247], a[112:115], v[120:123], v[244:247]
s_add_u32 s81, s81, 28672
v_cvt_pk_bf16_f32 v132, v132, v133
v_cvt_pk_bf16_f32 v133, v134, v135
v_mfma_f32_16x16x32_bf16 v[244:247], a[116:119], v[124:127], v[244:247]
s_add_u32 m0, s18, 102400
v_cvt_pk_bf16_f32 v134, v140, v141
v_cvt_pk_bf16_f32 v135, v142, v143
v_mfma_f32_16x16x32_bf16 v[252:255], a[120:123], v[120:123], v[252:255]
s_waitcnt lgkmcnt(0)
buffer_load_dwordx4 v112, s[36:39], s81 offen offset:0 lds
v_mfma_f32_16x16x32_bf16 v[252:255], a[124:127], v[124:127], v[252:255]
buffer_load_dwordx4 v113, s[36:39], s81 offen offset:1024 lds
buffer_load_dwordx4 v114, s[36:39], s81 offen offset:2048 lds
buffer_load_dwordx4 v115, s[36:39], s81 offen offset:3072 lds
s_sub_u32 s81, s81, 28544
s_add_u32 m0, s18, 131072
s_nop 0
buffer_load_dwordx4 v112, s[36:39], s81 offen offset:0 lds
v_cvt_pk_bf16_f32 v148, v148, v149
v_cvt_pk_bf16_f32 v149, v150, v151
v_cvt_pk_bf16_f32 v150, v156, v157
v_cvt_pk_bf16_f32 v151, v158, v159
buffer_load_dwordx4 v113, s[36:39], s81 offen offset:1024 lds
v_cvt_pk_bf16_f32 v164, v164, v165
v_cvt_pk_bf16_f32 v165, v166, v167
v_cvt_pk_bf16_f32 v166, v172, v173
v_cvt_pk_bf16_f32 v167, v174, v175
buffer_load_dwordx4 v114, s[36:39], s81 offen offset:2048 lds
v_cvt_pk_bf16_f32 v180, v180, v181
v_cvt_pk_bf16_f32 v181, v182, v183
v_cvt_pk_bf16_f32 v182, v188, v189
v_cvt_pk_bf16_f32 v183, v190, v191
buffer_load_dwordx4 v115, s[36:39], s81 offen offset:3072 lds
v_cvt_pk_bf16_f32 v196, v196, v197
v_cvt_pk_bf16_f32 v197, v198, v199
v_cvt_pk_bf16_f32 v198, v204, v205
v_cvt_pk_bf16_f32 v199, v206, v207
s_add_u32 s81, s81, 28672
s_add_u32 m0, s18, 135168
s_nop 0
buffer_load_dwordx4 v112, s[36:39], s81 offen offset:0 lds
v_cvt_pk_bf16_f32 v212, v212, v213
v_cvt_pk_bf16_f32 v213, v214, v215
v_cvt_pk_bf16_f32 v214, v220, v221
v_cvt_pk_bf16_f32 v215, v222, v223
buffer_load_dwordx4 v113, s[36:39], s81 offen offset:1024 lds
v_cvt_pk_bf16_f32 v228, v228, v229
v_cvt_pk_bf16_f32 v229, v230, v231
v_cvt_pk_bf16_f32 v230, v236, v237
v_cvt_pk_bf16_f32 v231, v238, v239
buffer_load_dwordx4 v114, s[36:39], s81 offen offset:2048 lds
v_cvt_pk_bf16_f32 v244, v244, v245
v_cvt_pk_bf16_f32 v245, v246, v247
v_cvt_pk_bf16_f32 v246, v252, v253
v_cvt_pk_bf16_f32 v247, v254, v255
buffer_load_dwordx4 v115, s[36:39], s81 offen offset:3072 lds
s_sub_u32 s81, s81, 28544
s_branch K2_done
K2_cfix:
s_nop 7
v_max_f32 v12, 0, v8
v_exp_f32 v13, -v12
v_sub_f32 v8, v8, v12
v_mul_f32 v24, v24, v13
v_mul_f32 v128, v128, v13
v_mul_f32 v129, v129, v13
v_mul_f32 v130, v130, v13
v_mul_f32 v131, v131, v13
v_mul_f32 v136, v136, v13
v_mul_f32 v137, v137, v13
v_mul_f32 v138, v138, v13
v_mul_f32 v139, v139, v13
v_mul_f32 v144, v144, v13
v_mul_f32 v145, v145, v13
v_mul_f32 v146, v146, v13
v_mul_f32 v147, v147, v13
v_mul_f32 v152, v152, v13
v_mul_f32 v153, v153, v13
v_mul_f32 v154, v154, v13
v_mul_f32 v155, v155, v13
v_mul_f32 v160, v160, v13
v_mul_f32 v161, v161, v13
v_mul_f32 v162, v162, v13
v_mul_f32 v163, v163, v13
v_mul_f32 v168, v168, v13
v_mul_f32 v169, v169, v13
v_mul_f32 v170, v170, v13
v_mul_f32 v171, v171, v13
v_mul_f32 v176, v176, v13
v_mul_f32 v177, v177, v13
v_mul_f32 v178, v178, v13
v_mul_f32 v179, v179, v13
v_mul_f32 v184, v184, v13
v_mul_f32 v185, v185, v13
v_mul_f32 v186, v186, v13
v_mul_f32 v187, v187, v13
v_mul_f32 v192, v192, v13
v_mul_f32 v193, v193, v13
v_mul_f32 v194, v194, v13
v_mul_f32 v195, v195, v13
v_mul_f32 v200, v200, v13
v_mul_f32 v201, v201, v13
v_mul_f32 v202, v202, v13
v_mul_f32 v203, v203, v13
v_mul_f32 v208, v208, v13
v_mul_f32 v209, v209, v13
v_mul_f32 v210, v210, v13
v_mul_f32 v211, v211, v13
v_mul_f32 v216, v216, v13
v_mul_f32 v217, v217, v13
v_mul_f32 v218, v218, v13
v_mul_f32 v219, v219, v13
v_mul_f32 v224, v224, v13
v_mul_f32 v225, v225, v13
v_mul_f32 v226, v226, v13
v_mul_f32 v227, v227, v13
v_mul_f32 v232, v232, v13
v_mul_f32 v233, v233, v13
v_mul_f32 v234, v234, v13
v_mul_f32 v235, v235, v13
v_mul_f32 v240, v240, v13
v_mul_f32 v241, v241, v13
v_mul_f32 v242, v242, v13
v_mul_f32 v243, v243, v13
v_mul_f32 v248, v248, v13
v_mul_f32 v249, v249, v13
v_mul_f32 v250, v250, v13
v_mul_f32 v251, v251, v13
v_max_f32 v12, 0, v10
v_exp_f32 v13, -v12
v_sub_f32 v10, v10, v12
v_mul_f32 v25, v25, v13
v_mul_f32 v132, v132, v13
v_mul_f32 v133, v133, v13
v_mul_f32 v134, v134, v13
v_mul_f32 v135, v135, v13
v_mul_f32 v140, v140, v13
v_mul_f32 v141, v141, v13
v_mul_f32 v142, v142, v13
v_mul_f32 v143, v143, v13
v_mul_f32 v148, v148, v13
v_mul_f32 v149, v149, v13
v_mul_f32 v150, v150, v13
v_mul_f32 v151, v151, v13
v_mul_f32 v156, v156, v13
v_mul_f32 v157, v157, v13
v_mul_f32 v158, v158, v13
v_mul_f32 v159, v159, v13
v_mul_f32 v164, v164, v13
v_mul_f32 v165, v165, v13
v_mul_f32 v166, v166, v13
v_mul_f32 v167, v167, v13
v_mul_f32 v172, v172, v13
v_mul_f32 v173, v173, v13
v_mul_f32 v174, v174, v13
v_mul_f32 v175, v175, v13
v_mul_f32 v180, v180, v13
v_mul_f32 v181, v181, v13
v_mul_f32 v182, v182, v13
v_mul_f32 v183, v183, v13
v_mul_f32 v188, v188, v13
v_mul_f32 v189, v189, v13
v_mul_f32 v190, v190, v13
v_mul_f32 v191, v191, v13
v_mul_f32 v196, v196, v13
v_mul_f32 v197, v197, v13
v_mul_f32 v198, v198, v13
v_mul_f32 v199, v199, v13
v_mul_f32 v204, v204, v13
v_mul_f32 v205, v205, v13
v_mul_f32 v206, v206, v13
v_mul_f32 v207, v207, v13
v_mul_f32 v212, v212, v13
v_mul_f32 v213, v213, v13
v_mul_f32 v214, v214, v13
v_mul_f32 v215, v215, v13
v_mul_f32 v220, v220, v13
v_mul_f32 v221, v221, v13
v_mul_f32 v222, v222, v13
v_mul_f32 v223, v223, v13
v_mul_f32 v228, v228, v13
v_mul_f32 v229, v229, v13
v_mul_f32 v230, v230, v13
v_mul_f32 v231, v231, v13
v_mul_f32 v236, v236, v13
v_mul_f32 v237, v237, v13
v_mul_f32 v238, v238, v13
v_mul_f32 v239, v239, v13
v_mul_f32 v244, v244, v13
v_mul_f32 v245, v245, v13
v_mul_f32 v246, v246, v13
v_mul_f32 v247, v247, v13
v_mul_f32 v252, v252, v13
v_mul_f32 v253, v253, v13
v_mul_f32 v254, v254, v13
v_mul_f32 v255, v255, v13
s_branch K2_cok
K2_tspin:
Lp_9101:
buffer_load_dword v3, off, s[4:7], s80 sc1
s_waitcnt vmcnt(0)
v_cmp_gt_u32 vcc, 1, v3
s_cbranch_vccz Lpd_9102
s_sleep 8
s_sub_u32 s101, s101, 1
s_cbranch_scc0 Lp_9101
s_mov_b32 s101, 0
Lpd_9102:
s_branch K2_tok
K2_p0d:
ds_read_b128 a[64:67], v1 offset:0
ds_read_b128 a[68:71], v1 offset:1024
ds_read_b128 a[72:75], v1 offset:2048
ds_read_b128 a[76:79], v1 offset:3072
ds_read_b128 a[80:83], v1 offset:4096
ds_read_b128 a[84:87], v1 offset:5120
ds_read_b128 a[88:91], v1 offset:6144
ds_read_b128 a[92:95], v1 offset:7168
v_cndmask_b32 v32, 0, v7, s[32:33]
v_cndmask_b32 v33, 0, v7, s[34:35]
v_cndmask_b32 v34, 0, v7, s[36:37]
v_cndmask_b32 v35, 0, v7, s[38:39]
v_cndmask_b32 v40, 0, v7, s[40:41]
v_cndmask_b32 v41, 0, v7, s[42:43]
v_cndmask_b32 v42, 0, v7, s[44:45]
v_cndmask_b32 v43, 0, v7, s[46:47]
s_waitcnt lgkmcnt(7)
v_mfma_f32_16x16x32_bf16 v[32:35], a[64:67], a[0:3], v[32:35]
s_waitcnt lgkmcnt(6)
s_add_u32 m0, s18, 65536
ds_read_b128 a[96:99], v1 offset:8192
v_mfma_f32_16x16x32_bf16 v[32:35], a[68:71], a[4:7], v[32:35]
s_waitcnt lgkmcnt(6)
buffer_load_dwordx4 v1, s[4:7], s12 offen offset:0 sc1 lds
v_mfma_f32_16x16x32_bf16 v[32:35], a[72:75], a[8:11], v[32:35]
s_waitcnt lgkmcnt(5)
ds_read_b128 a[100:103], v1 offset:9216
v_mfma_f32_16x16x32_bf16 v[32:35], a[76:79], a[12:15], v[32:35]
s_waitcnt lgkmcnt(5)
buffer_load_dwordx4 v1, s[4:7], s12 offen offset:1024 sc1 lds
v_mfma_f32_16x16x32_bf16 v[32:35], a[80:83], a[16:19], v[32:35]
s_waitcnt lgkmcnt(4)
ds_read_b128 a[104:107], v1 offset:10240
v_mfma_f32_16x16x32_bf16 v[32:35], a[84:87], a[20:23], v[32:35]
s_waitcnt lgkmcnt(4)
buffer_load_dwordx4 v1, s[4:7], s12 offen offset:2048 sc1 lds
v_mfma_f32_16x16x32_bf16 v[32:35], a[88:91], a[24:27], v[32:35]
s_waitcnt lgkmcnt(3)
ds_read_b128 a[108:111], v1 offset:11264
v_mfma_f32_16x16x32_bf16 v[32:35], a[92:95], a[28:31], v[32:35]
buffer_load_dwordx4 v1, s[4:7], s12 offen offset:3072 sc1 lds
v_mfma_f32_16x16x32_bf16 v[36:39], a[64:67], a[32:35], 0
s_add_u32 s12, s12, 4096
s_add_u32 m0, s18, 69632
ds_read_b128 a[112:115], v1 offset:12288
v_mfma_f32_16x16x32_bf16 v[36:39], a[68:71], a[36:39], v[36:39]
buffer_load_dwordx4 v1, s[4:7], s12 offen offset:0 sc1 lds
v_mfma_f32_16x16x32_bf16 v[36:39], a[72:75], a[40:43], v[36:39]
ds_read_b128 a[116:119], v1 offset:13312
v_mfma_f32_16x16x32_bf16 v[36:39], a[76:79], a[44:47], v[36:39]
buffer_load_dwordx4 v1, s[4:7], s12 offen offset:1024 sc1 lds
v_mfma_f32_16x16x32_bf16 v[36:39], a[80:83], a[48:51], v[36:39]
ds_read_b128 a[120:123], v1 offset:14336
v_max3_f32 v28, v32, v33, v34
v_mfma_f32_16x16x32_bf16 v[36:39], a[84:87], a[52:55], v[36:39]
buffer_load_dwordx4 v1, s[4:7], s12 offen offset:2048 sc1 lds
v_mfma_f32_16x16x32_bf16 v[36:39], a[88:91], a[56:59], v[36:39]
ds_read_b128 a[124:127], v1 offset:15360
v_max_f32 v28, v28, v35
v_mfma_f32_16x16x32_bf16 v[36:39], a[92:95], a[60:63], v[36:39]
s_waitcnt lgkmcnt(4)
buffer_load_dwordx4 v1, s[4:7], s12 offen offset:3072 sc1 lds
v_mfma_f32_16x16x32_bf16 v[40:43], a[96:99], a[0:3], v[40:43]
s_add_u32 s12, s12, 28672
ds_read_b128 a[64:67], v1 offset:16384
v_mov_b32 v30, v28
v_mfma_f32_16x16x32_bf16 v[40:43], a[100:103], a[4:7], v[40:43]
s_waitcnt lgkmcnt(2)
s_sub_u32 s13, s13, 1
v_mfma_f32_16x16x32_bf16 v[40:43], a[104:107], a[8:11], v[40:43]
s_cmp_eq_u32 s13, 0
ds_read_b128 a[68:71], v1 offset:17408
v_permlane16_swap_b32 v28, v30
v_mfma_f32_16x16x32_bf16 v[40:43], a[108:111], a[12:15], v[40:43]
s_cselect_b32 s12, s14, s12
v_max_f32 v28, v28, v30
v_mov_b32 v30, v28
v_mfma_f32_16x16x32_bf16 v[40:43], a[112:115], a[16:19], v[40:43]
s_cselect_b32 s13, s15, s13
ds_read_b128 a[72:75], v1 offset:18432
v_max3_f32 v29, v36, v37, v38
v_mfma_f32_16x16x32_bf16 v[40:43], a[116:119], a[20:23], v[40:43]
s_cselect_b32 s14, 3221225472, s14
v_permlane32_swap_b32 v28, v30
v_max_f32 v28, v28, v30
v_mfma_f32_16x16x32_bf16 v[40:43], a[120:123], a[24:27], v[40:43]
s_waitcnt lgkmcnt(3)
ds_read_b128 a[76:79], v1 offset:19456
v_sub_f32 v16, 0, v28
v_mfma_f32_16x16x32_bf16 v[40:43], a[124:127], a[28:31], v[40:43]
v_sub_f32 v17, 0, v28
v_sub_f32 v18, 0, v28
v_mfma_f32_16x16x32_bf16 v[44:47], a[96:99], a[32:35], 0
ds_read_b128 a[80:83], v1 offset:20480
v_sub_f32 v19, 0, v28
v_mfma_f32_16x16x32_bf16 v[44:47], a[100:103], a[36:39], v[44:47]
v_max_f32 v29, v29, v39
v_mov_b32 v31, v29
v_cndmask_b32 v48, v16, v7, s[48:49]
v_mfma_f32_16x16x32_bf16 v[44:47], a[104:107], a[40:43], v[44:47]
ds_read_b128 a[84:87], v1 offset:21504
v_cndmask_b32 v49, v16, v7, s[50:51]
v_mfma_f32_16x16x32_bf16 v[44:47], a[108:111], a[44:47], v[44:47]
v_permlane16_swap_b32 v29, v31
v_max_f32 v29, v29, v31
v_cndmask_b32 v50, v16, v7, s[52:53]
v_mfma_f32_16x16x32_bf16 v[44:47], a[112:115], a[48:51], v[44:47]
ds_read_b128 a[88:91], v1 offset:22528
v_mov_b32 v31, v29
v_cndmask_b32 v51, v16, v7, s[54:55]
v_mfma_f32_16x16x32_bf16 v[44:47], a[116:119], a[52:55], v[44:47]
v_cndmask_b32 v56, v16, v7, s[56:57]
v_cndmask_b32 v57, v16, v7, s[58:59]
v_mfma_f32_16x16x32_bf16 v[44:47], a[120:123], a[56:59], v[44:47]
ds_read_b128 a[92:95], v1 offset:23552
v_permlane32_swap_b32 v29, v31
v_mfma_f32_16x16x32_bf16 v[44:47], a[124:127], a[60:63], v[44:47]
s_waitcnt lgkmcnt(4)
v_max_f32 v29, v29, v31
v_sub_f32 v20, 0, v29
v_mfma_f32_16x16x32_bf16 v[48:51], a[64:67], a[0:3], v[48:51]
ds_read_b128 a[96:99], v1 offset:24576
v_sub_f32 v21, 0, v29
v_mfma_f32_16x16x32_bf16 v[48:51], a[68:71], a[4:7], v[48:51]
v_sub_f32 v22, 0, v29
v_sub_f32 v23, 0, v29
v_mfma_f32_16x16x32_bf16 v[48:51], a[72:75], a[8:11], v[48:51]
ds_read_b128 a[100:103], v1 offset:25600
v_cndmask_b32 v58, v16, v7, s[60:61]
v_mfma_f32_16x16x32_bf16 v[48:51], a[76:79], a[12:15], v[48:51]
s_waitcnt lgkmcnt(4)
v_cndmask_b32 v59, v16, v7, s[62:63]
v_mfma_f32_16x16x32_bf16 v[48:51], a[80:83], a[16:19], v[48:51]
ds_read_b128 a[104:107], v1 offset:26624
v_mfma_f32_16x16x32_bf16 v[48:51], a[84:87], a[20:23], v[48:51]
s_waitcnt lgkmcnt(4)
v_add_f32 v32, v32, v16
v_add_f32 v33, v33, v16
v_add_f32 v34, v34, v16
v_add_f32 v35, v35, v16
v_mfma_f32_16x16x32_bf16 v[48:51], a[88:91], a[24:27], v[48:51]
s_waitcnt lgkmcnt(3)
ds_read_b128 a[108:111], v1 offset:27648
v_add_f32 v36, v36, v20
v_add_f32 v37, v37, v20
v_add_f32 v38, v38, v20
v_add_f32 v39, v39, v20
v_mfma_f32_16x16x32_bf16 v[48:51], a[92:95], a[28:31], v[48:51]
v_add_f32 v40, v40, v16
v_add_f32 v41, v41, v16
v_add_f32 v42, v42, v16
v_add_f32 v43, v43, v16
v_mfma_f32_16x16x32_bf16 v[52:55], a[64:67], a[32:35], v[20:23]
ds_read_b128 a[112:115], v1 offset:28672
v_add_f32 v44, v44, v20
v_add_f32 v45, v45, v20
v_add_f32 v46, v46, v20
v_add_f32 v47, v47, v20
v_mfma_f32_16x16x32_bf16 v[52:55], a[68:71], a[36:39], v[52:55]
v_exp_f32 v8, v32
v_mfma_f32_16x16x32_bf16 v[52:55], a[72:75], a[40:43], v[52:55]
ds_read_b128 a[116:119], v1 offset:29696
v_exp_f32 v9, v33
v_mfma_f32_16x16x32_bf16 v[52:55], a[76:79], a[44:47], v[52:55]
v_exp_f32 v10, v34
v_add_f32 v26, v8, v9
v_cvt_pk_bf16_f32 v96, v8, v9
v_mfma_f32_16x16x32_bf16 v[52:55], a[80:83], a[48:51], v[52:55]
ds_read_b128 a[120:123], v1 offset:30720
v_exp_f32 v11, v35
v_add_f32 v26, v26, v10
v_mfma_f32_16x16x32_bf16 v[52:55], a[84:87], a[52:55], v[52:55]
v_exp_f32 v12, v36
v_add_f32 v26, v26, v11
v_cvt_pk_bf16_f32 v97, v10, v11
v_mfma_f32_16x16x32_bf16 v[52:55], a[88:91], a[56:59], v[52:55]
s_waitcnt vmcnt(8) lgkmcnt(4)
ds_read_b128 a[124:127], v1 offset:31744
v_exp_f32 v13, v37
v_mfma_f32_16x16x32_bf16 v[52:55], a[92:95], a[60:63], v[52:55]
s_barrier
v_mfma_f32_16x16x32_bf16 v[56:59], a[96:99], a[0:3], v[56:59]
ds_read_b128 a[64:67], v4 offset:0
v_exp_f32 v14, v38
v_mfma_f32_16x16x32_bf16 v[56:59], a[100:103], a[4:7], v[56:59]
buffer_store_dword v6, v5, s[4:7], s71 offen sc1
v_mfma_f32_16x16x32_bf16 v[56:59], a[104:107], a[8:11], v[56:59]
s_waitcnt lgkmcnt(4)
ds_read_b128 a[68:71], v4 offset:1024
v_add_f32 v27, v12, v13
v_cvt_pk_bf16_f32 v104, v12, v13
v_add_f32 v27, v27, v14
v_mfma_f32_16x16x32_bf16 v[56:59], a[108:111], a[12:15], v[56:59]
v_exp_f32 v15, v39
v_mfma_f32_16x16x32_bf16 v[56:59], a[112:115], a[16:19], v[56:59]
s_waitcnt lgkmcnt(4)
ds_read_b128 a[72:75], v4 offset:2048
v_exp_f32 v8, v40
v_add_f32 v27, v27, v15
v_cvt_pk_bf16_f32 v105, v14, v15
v_mfma_f32_16x16x32_bf16 v[56:59], a[116:119], a[20:23], v[56:59]
s_waitcnt lgkmcnt(4)
v_exp_f32 v9, v41
v_add_f32 v26, v26, v8
v_mfma_f32_16x16x32_bf16 v[56:59], a[120:123], a[24:27], v[56:59]
s_waitcnt lgkmcnt(3)
ds_read_b128 a[76:79], v4 offset:3072
v_exp_f32 v10, v42
v_add_f32 v26, v26, v9
v_cvt_pk_bf16_f32 v98, v8, v9
v_mfma_f32_16x16x32_bf16 v[56:59], a[124:127], a[28:31], v[56:59]
v_exp_f32 v11, v43
v_add_f32 v26, v26, v10
v_mfma_f32_16x16x32_bf16 v[60:63], a[96:99], a[32:35], v[20:23]
ds_read_b128 a[80:83], v4 offset:4096
v_exp_f32 v12, v44
v_mfma_f32_16x16x32_bf16 v[60:63], a[100:103], a[36:39], v[60:63]
v_exp_f32 v13, v45
v_mfma_f32_16x16x32_bf16 v[60:63], a[104:107], a[40:43], v[60:63]
ds_read_b128 a[84:87], v4 offset:5120
v_exp_f32 v14, v46
v_mfma_f32_16x16x32_bf16 v[60:63], a[108:111], a[44:47], v[60:63]
v_exp_f32 v15, v47
v_mfma_f32_16x16x32_bf16 v[60:63], a[112:115], a[48:51], v[60:63]
ds_read_b128 a[88:91], v4 offset:6144
v_add_f32 v26, v26, v11
v_cvt_pk_bf16_f32 v99, v10, v11
v_mfma_f32_16x16x32_bf16 v[60:63], a[116:119], a[52:55], v[60:63]
v_add_f32 v27, v27, v12
v_add_f32 v27, v27, v13
v_cvt_pk_bf16_f32 v106, v12, v13
v_mfma_f32_16x16x32_bf16 v[60:63], a[120:123], a[56:59], v[60:63]
s_waitcnt lgkmcnt(7)
s_barrier
ds_read_b128 a[92:95], v4 offset:7168
v_mfma_f32_16x16x32_bf16 v[60:63], a[124:127], a[60:63], v[60:63]
s_waitcnt lgkmcnt(4)
v_add_f32 v27, v27, v14
v_add_f32 v27, v27, v15
v_cvt_pk_bf16_f32 v107, v14, v15
s_branch K2_dx1
PAD_33:
s_cbranch_execz M_tret
K2_ntail:
v_mfma_f32_16x16x32_bf16 v[128:131], a[64:67], v[96:99], v[128:131]
s_add_u32 m0, s18, 98304
ds_read_b128 a[96:99], v2 offset:8192
v_add_f32 v24, v24, v26
v_mfma_f32_16x16x32_bf16 v[128:131], a[68:71], v[100:103], v[128:131]
buffer_load_dwordx4 v1, s[4:7], s12 offen offset:0 sc1 lds
v_mfma_f32_16x16x32_bf16 v[132:135], a[68:71], v[108:111], v[132:135]
ds_read_b128 a[100:103], v2 offset:9216
v_add_f32 v25, v25, v27
v_mfma_f32_16x16x32_bf16 v[132:135], a[64:67], v[104:107], v[132:135]
buffer_load_dwordx4 v1, s[4:7], s12 offen offset:1024 sc1 lds
v_mfma_f32_16x16x32_bf16 v[136:139], a[72:75], v[96:99], v[136:139]
ds_read_b128 a[104:107], v2 offset:10240
v_exp_f32 v8, v64
v_mfma_f32_16x16x32_bf16 v[136:139], a[76:79], v[100:103], v[136:139]
buffer_load_dwordx4 v1, s[4:7], s12 offen offset:2048 sc1 lds
v_mfma_f32_16x16x32_bf16 v[140:143], a[76:79], v[108:111], v[140:143]
ds_read_b128 a[108:111], v2 offset:11264
v_mfma_f32_16x16x32_bf16 v[140:143], a[72:75], v[104:107], v[140:143]
s_waitcnt lgkmcnt(4)
buffer_load_dwordx4 v1, s[4:7], s12 offen offset:3072 sc1 lds
v_mfma_f32_16x16x32_bf16 v[144:147], a[80:83], v[96:99], v[144:147]
s_add_u32 s12, s12, 4096
s_add_u32 m0, s18, 102400
ds_read_b128 a[112:115], v2 offset:12288
v_mfma_f32_16x16x32_bf16 v[144:147], a[84:87], v[100:103], v[144:147]
buffer_load_dwordx4 v1, s[4:7], s12 offen offset:0 sc1 lds
v_mfma_f32_16x16x32_bf16 v[148:151], a[84:87], v[108:111], v[148:151]
ds_read_b128 a[116:119], v2 offset:13312
v_exp_f32 v9, v65
v_mfma_f32_16x16x32_bf16 v[148:151], a[80:83], v[104:107], v[148:151]
buffer_load_dwordx4 v1, s[4:7], s12 offen offset:1024 sc1 lds
v_mfma_f32_16x16x32_bf16 v[152:155], a[88:91], v[96:99], v[152:155]
ds_read_b128 a[120:123], v2 offset:14336
v_add_f32 v26, v8, v9
v_cvt_pk_bf16_f32 v112, v8, v9
v_mfma_f32_16x16x32_bf16 v[152:155], a[92:95], v[100:103], v[152:155]
buffer_load_dwordx4 v1, s[4:7], s12 offen offset:2048 sc1 lds
v_mfma_f32_16x16x32_bf16 v[156:159], a[92:95], v[108:111], v[156:159]
ds_read_b128 a[124:127], v2 offset:15360
v_exp_f32 v10, v66
v_mfma_f32_16x16x32_bf16 v[156:159], a[88:91], v[104:107], v[156:159]
s_waitcnt lgkmcnt(4)
buffer_load_dwordx4 v1, s[4:7], s12 offen offset:3072 sc1 lds
v_mfma_f32_16x16x32_bf16 v[160:163], a[96:99], v[96:99], v[160:163]
s_add_u32 s12, s12, 28672
ds_read_b128 a[64:67], v2 offset:16384
v_add_f32 v26, v26, v10
v_mfma_f32_16x16x32_bf16 v[160:163], a[100:103], v[100:103], v[160:163]
s_sub_u32 s13, s13, 1
v_exp_f32 v11, v67
v_mfma_f32_16x16x32_bf16 v[164:167], a[100:103], v[108:111], v[164:167]
s_cmp_eq_u32 s13, 0
ds_read_b128 a[68:71], v2 offset:17408
v_exp_f32 v12, v68
v_mfma_f32_16x16x32_bf16 v[164:167], a[96:99], v[104:107], v[164:167]
s_cselect_b32 s12, s14, s12
v_exp_f32 v13, v69
v_mfma_f32_16x16x32_bf16 v[168:171], a[104:107], v[96:99], v[168:171]
s_cselect_b32 s13, s15, s13
ds_read_b128 a[72:75], v2 offset:18432
v_add_f32 v26, v26, v11
v_cvt_pk_bf16_f32 v113, v10, v11
v_mfma_f32_16x16x32_bf16 v[168:171], a[108:111], v[100:103], v[168:171]
s_cselect_b32 s14, 3221225472, s14
v_exp_f32 v14, v70
v_mfma_f32_16x16x32_bf16 v[172:175], a[108:111], v[108:111], v[172:175]
ds_read_b128 a[76:79], v2 offset:19456
v_exp_f32 v15, v71
v_mfma_f32_16x16x32_bf16 v[172:175], a[104:107], v[104:107], v[172:175]
s_waitcnt lgkmcnt(4)
v_exp_f32 v8, v72
v_mfma_f32_16x16x32_bf16 v[176:179], a[112:115], v[96:99], v[176:179]
ds_read_b128 a[80:83], v2 offset:20480
v_add_f32 v27, v12, v13
v_cvt_pk_bf16_f32 v120, v12, v13
v_add_f32 v27, v27, v14
v_add_f32 v27, v27, v15
v_cvt_pk_bf16_f32 v121, v14, v15
v_mfma_f32_16x16x32_bf16 v[176:179], a[116:119], v[100:103], v[176:179]
v_exp_f32 v9, v73
v_mfma_f32_16x16x32_bf16 v[180:183], a[116:119], v[108:111], v[180:183]
ds_read_b128 a[84:87], v2 offset:21504
v_exp_f32 v10, v74
v_mfma_f32_16x16x32_bf16 v[180:183], a[112:115], v[104:107], v[180:183]
v_exp_f32 v11, v75
v_mfma_f32_16x16x32_bf16 v[184:187], a[120:123], v[96:99], v[184:187]
ds_read_b128 a[88:91], v2 offset:22528
v_add_f32 v26, v26, v8
v_mfma_f32_16x16x32_bf16 v[184:187], a[124:127], v[100:103], v[184:187]
v_exp_f32 v12, v76
v_mfma_f32_16x16x32_bf16 v[188:191], a[124:127], v[108:111], v[188:191]
ds_read_b128 a[92:95], v2 offset:23552
v_add_f32 v26, v26, v9
v_cvt_pk_bf16_f32 v114, v8, v9
v_add_f32 v26, v26, v10
v_add_f32 v26, v26, v11
v_cvt_pk_bf16_f32 v115, v10, v11
v_mfma_f32_16x16x32_bf16 v[188:191], a[120:123], v[104:107], v[188:191]
s_waitcnt lgkmcnt(4)
v_exp_f32 v13, v77
v_mfma_f32_16x16x32_bf16 v[192:195], a[64:67], v[96:99], v[192:195]
ds_read_b128 a[96:99], v2 offset:24576
v_exp_f32 v14, v78
v_mfma_f32_16x16x32_bf16 v[192:195], a[68:71], v[100:103], v[192:195]
v_exp_f32 v15, v79
v_mfma_f32_16x16x32_bf16 v[196:199], a[68:71], v[108:111], v[196:199]
ds_read_b128 a[100:103], v2 offset:25600
v_add_f32 v27, v27, v12
v_add_f32 v27, v27, v13
v_cvt_pk_bf16_f32 v122, v12, v13
v_add_f32 v27, v27, v14
v_mfma_f32_16x16x32_bf16 v[196:199], a[64:67], v[104:107], v[196:199]
v_exp_f32 v8, v80
v_mfma_f32_16x16x32_bf16 v[200:203], a[72:75], v[96:99], v[200:203]
ds_read_b128 a[104:107], v2 offset:26624
v_exp_f32 v9, v81
v_mfma_f32_16x16x32_bf16 v[200:203], a[76:79], v[100:103], v[200:203]
v_exp_f32 v10, v82
v_mfma_f32_16x16x32_bf16 v[204:207], a[76:79], v[108:111], v[204:207]
ds_read_b128 a[108:111], v2 offset:27648
v_add_f32 v27, v27, v15
v_cvt_pk_bf16_f32 v123, v14, v15
v_add_f32 v26, v26, v8
v_add_f32 v26, v26, v9
v_cvt_pk_bf16_f32 v116, v8, v9
v_mfma_f32_16x16x32_bf16 v[204:207], a[72:75], v[104:107], v[204:207]
s_waitcnt lgkmcnt(4)
v_exp_f32 v11, v83
v_mfma_f32_16x16x32_bf16 v[208:211], a[80:83], v[96:99], v[208:211]
ds_read_b128 a[112:115], v2 offset:28672
v_exp_f32 v12, v84
v_mfma_f32_16x16x32_bf16 v[208:211], a[84:87], v[100:103], v[208:211]
v_exp_f32 v13, v85
v_mfma_f32_16x16x32_bf16 v[212:215], a[84:87], v[108:111], v[212:215]
ds_read_b128 a[116:119], v2 offset:29696
v_add_f32 v26, v26, v10
v_add_f32 v26, v26, v11
v_cvt_pk_bf16_f32 v117, v10, v11
v_add_f32 v27, v27, v12
v_mfma_f32_16x16x32_bf16 v[212:215], a[80:83], v[104:107], v[212:215]
v_exp_f32 v14, v86
v_mfma_f32_16x16x32_bf16 v[216:219], a[88:91], v[96:99], v[216:219]
ds_read_b128 a[120:123], v2 offset:30720
v_exp_f32 v15, v87
v_mfma_f32_16x16x32_bf16 v[216:219], a[92:95], v[100:103], v[216:219]
v_exp_f32 v8, v88
v_mfma_f32_16x16x32_bf16 v[220:223], a[92:95], v[108:111], v[220:223]
s_waitcnt vmcnt(0) lgkmcnt(4)
ds_read_b128 a[124:127], v2 offset:31744
v_add_f32 v27, v27, v13
v_cvt_pk_bf16_f32 v124, v12, v13
v_add_f32 v27, v27, v14
v_add_f32 v27, v27, v15
v_cvt_pk_bf16_f32 v125, v14, v15
v_mfma_f32_16x16x32_bf16 v[220:223], a[88:91], v[104:107], v[220:223]
s_barrier
v_mfma_f32_16x16x32_bf16 v[224:227], a[96:99], v[96:99], v[224:227]
ds_read_b128 a[64:67], v2 offset:32768
v_exp_f32 v9, v89
v_mfma_f32_16x16x32_bf16 v[224:227], a[100:103], v[100:103], v[224:227]
v_exp_f32 v10, v90
v_mfma_f32_16x16x32_bf16 v[228:231], a[100:103], v[108:111], v[228:231]
ds_read_b128 a[68:71], v2 offset:33792
v_add_f32 v26, v26, v8
v_add_f32 v26, v26, v9
v_cvt_pk_bf16_f32 v118, v8, v9
v_mfma_f32_16x16x32_bf16 v[228:231], a[96:99], v[104:107], v[228:231]
v_exp_f32 v11, v91
v_mfma_f32_16x16x32_bf16 v[232:235], a[104:107], v[96:99], v[232:235]
s_waitcnt lgkmcnt(4)
ds_read_b128 a[72:75], v2 offset:34816
v_exp_f32 v12, v92
v_mfma_f32_16x16x32_bf16 v[232:235], a[108:111], v[100:103], v[232:235]
v_exp_f32 v13, v93
v_mfma_f32_16x16x32_bf16 v[236:239], a[108:111], v[108:111], v[236:239]
ds_read_b128 a[76:79], v2 offset:35840
v_add_f32 v26, v26, v10
v_mfma_f32_16x16x32_bf16 v[236:239], a[104:107], v[104:107], v[236:239]
v_exp_f32 v14, v94
v_mfma_f32_16x16x32_bf16 v[240:243], a[112:115], v[96:99], v[240:243]
ds_read_b128 a[80:83], v2 offset:36864
v_add_f32 v26, v26, v11
v_cvt_pk_bf16_f32 v119, v10, v11
v_add_f32 v27, v27, v12
v_mfma_f32_16x16x32_bf16 v[240:243], a[116:119], v[100:103], v[240:243]
v_exp_f32 v15, v95
v_mfma_f32_16x16x32_bf16 v[244:247], a[116:119], v[108:111], v[244:247]
ds_read_b128 a[84:87], v2 offset:37888
v_add_f32 v27, v27, v13
v_cvt_pk_bf16_f32 v126, v12, v13
v_mfma_f32_16x16x32_bf16 v[244:247], a[112:115], v[104:107], v[244:247]
s_waitcnt lgkmcnt(4)
v_add_f32 v27, v27, v14
v_add_f32 v27, v27, v15
v_mfma_f32_16x16x32_bf16 v[248:251], a[120:123], v[96:99], v[248:251]
ds_read_b128 a[88:91], v2 offset:38912
v_cvt_pk_bf16_f32 v127, v14, v15
v_mfma_f32_16x16x32_bf16 v[248:251], a[124:127], v[100:103], v[248:251]
v_add_f32 v28, v26, v27
v_cmp_nge_f32 vcc, s25, v28
v_mfma_f32_16x16x32_bf16 v[252:255], a[124:127], v[108:111], v[252:255]
ds_read_b128 a[92:95], v2 offset:39936
v_mfma_f32_16x16x32_bf16 v[252:255], a[120:123], v[104:107], v[252:255]
s_cbranch_vccnz Lstub_14
Lback_15:
v_mfma_f32_16x16x32_bf16 v[128:131], a[64:67], v[112:115], v[128:131]
s_add_u32 m0, s18, 131072
ds_read_b128 a[96:99], v2 offset:40960
v_add_f32 v24, v24, v26
v_mfma_f32_16x16x32_bf16 v[128:131], a[68:71], v[116:119], v[128:131]
buffer_load_dwordx4 v1, s[4:7], s8 offen offset:0 sc1 lds
v_mfma_f32_16x16x32_bf16 v[132:135], a[68:71], v[124:127], v[132:135]
ds_read_b128 a[100:103], v2 offset:41984
v_add_f32 v25, v25, v27
v_mfma_f32_16x16x32_bf16 v[132:135], a[64:67], v[120:123], v[132:135]
s_waitcnt lgkmcnt(4)
buffer_load_dwordx4 v1, s[4:7], s8 offen offset:1024 sc1 lds
v_mfma_f32_16x16x32_bf16 v[136:139], a[72:75], v[112:115], v[136:139]
ds_read_b128 a[104:107], v2 offset:43008
v_mov_b32 v8, v16
v_mfma_f32_16x16x32_bf16 v[136:139], a[76:79], v[116:119], v[136:139]
buffer_load_dwordx4 v1, s[4:7], s8 offen offset:2048 sc1 lds
v_mfma_f32_16x16x32_bf16 v[140:143], a[76:79], v[124:127], v[140:143]
ds_read_b128 a[108:111], v2 offset:44032
v_mov_b32 v9, v24
v_mfma_f32_16x16x32_bf16 v[140:143], a[72:75], v[120:123], v[140:143]
buffer_load_dwordx4 v1, s[4:7], s8 offen offset:3072 sc1 lds
v_mfma_f32_16x16x32_bf16 v[144:147], a[80:83], v[112:115], v[144:147]
s_add_u32 s8, s8, 4096
s_add_u32 m0, s18, 135168
ds_read_b128 a[112:115], v2 offset:45056
v_mfma_f32_16x16x32_bf16 v[144:147], a[84:87], v[116:119], v[144:147]
buffer_load_dwordx4 v1, s[4:7], s8 offen offset:0 sc1 lds
v_mfma_f32_16x16x32_bf16 v[148:151], a[84:87], v[124:127], v[148:151]
ds_read_b128 a[116:119], v2 offset:46080
v_mov_b32 v10, v20
v_mfma_f32_16x16x32_bf16 v[148:151], a[80:83], v[120:123], v[148:151]
s_waitcnt lgkmcnt(4)
buffer_load_dwordx4 v1, s[4:7], s8 offen offset:1024 sc1 lds
v_mfma_f32_16x16x32_bf16 v[152:155], a[88:91], v[112:115], v[152:155]
ds_read_b128 a[120:123], v2 offset:47104
v_mov_b32 v11, v25
v_mfma_f32_16x16x32_bf16 v[152:155], a[92:95], v[116:119], v[152:155]
buffer_load_dwordx4 v1, s[4:7], s8 offen offset:2048 sc1 lds
v_mfma_f32_16x16x32_bf16 v[156:159], a[92:95], v[124:127], v[156:159]
ds_read_b128 a[124:127], v2 offset:48128
v_cvt_pk_bf16_f32 v128, v128, v129
v_mfma_f32_16x16x32_bf16 v[156:159], a[88:91], v[120:123], v[156:159]
s_waitcnt lgkmcnt(4)
buffer_load_dwordx4 v1, s[4:7], s8 offen offset:3072 sc1 lds
v_mfma_f32_16x16x32_bf16 v[160:163], a[96:99], v[112:115], v[160:163]
s_add_u32 s8, s8, 28672
ds_read_b128 a[64:67], v2 offset:49152
v_cvt_pk_bf16_f32 v129, v130, v131
v_mfma_f32_16x16x32_bf16 v[160:163], a[100:103], v[116:119], v[160:163]
s_sub_u32 s9, s9, 1
buffer_store_dwordx4 v[8:11], v1, s[4:7], s27 offen sc1
v_mfma_f32_16x16x32_bf16 v[164:167], a[100:103], v[124:127], v[164:167]
s_cmp_eq_u32 s9, 0
ds_read_b128 a[68:71], v2 offset:50176
v_cvt_pk_bf16_f32 v130, v136, v137
v_mfma_f32_16x16x32_bf16 v[164:167], a[96:99], v[120:123], v[164:167]
s_cselect_b32 s8, s10, s8
v_cvt_pk_bf16_f32 v131, v138, v139
v_accvgpr_mov_b32 a0, a192
v_mfma_f32_16x16x32_bf16 v[168:171], a[104:107], v[112:115], v[168:171]
s_cselect_b32 s9, s11, s9
ds_read_b128 a[72:75], v2 offset:51200
v_accvgpr_mov_b32 a1, a193
v_mfma_f32_16x16x32_bf16 v[168:171], a[108:111], v[116:119], v[168:171]
s_cselect_b32 s10, 3221225472, s10
buffer_store_dwordx4 v[128:131], v1, s[4:7], s76 offen offset:0 sc1
v_mfma_f32_16x16x32_bf16 v[172:175], a[108:111], v[124:127], v[172:175]
ds_read_b128 a[76:79], v2 offset:52224
v_cvt_pk_bf16_f32 v132, v132, v133
v_mfma_f32_16x16x32_bf16 v[172:175], a[104:107], v[120:123], v[172:175]
s_waitcnt lgkmcnt(4)
v_cvt_pk_bf16_f32 v133, v134, v135
v_cvt_pk_bf16_f32 v134, v140, v141
v_mfma_f32_16x16x32_bf16 v[176:179], a[112:115], v[112:115], v[176:179]
ds_read_b128 a[80:83], v2 offset:53248
v_cvt_pk_bf16_f32 v135, v142, v143
v_mfma_f32_16x16x32_bf16 v[176:179], a[116:119], v[116:119], v[176:179]
buffer_store_dwordx4 v[132:135], v1, s[4:7], s77 offen offset:0 sc1
v_mfma_f32_16x16x32_bf16 v[180:183], a[116:119], v[124:127], v[180:183]
ds_read_b128 a[84:87], v2 offset:54272
v_cvt_pk_bf16_f32 v144, v144, v145
v_mfma_f32_16x16x32_bf16 v[180:183], a[112:115], v[120:123], v[180:183]
v_cvt_pk_bf16_f32 v145, v146, v147
v_cvt_pk_bf16_f32 v146, v152, v153
v_mfma_f32_16x16x32_bf16 v[184:187], a[120:123], v[112:115], v[184:187]
ds_read_b128 a[88:91], v2 offset:55296
v_cvt_pk_bf16_f32 v147, v154, v155
v_mfma_f32_16x16x32_bf16 v[184:187], a[124:127], v[116:119], v[184:187]
buffer_store_dwordx4 v[144:147], v1, s[4:7], s76 offen offset:1024 sc1
v_mfma_f32_16x16x32_bf16 v[188:191], a[124:127], v[124:127], v[188:191]
ds_read_b128 a[92:95], v2 offset:56320
v_cvt_pk_bf16_f32 v148, v148, v149
v_mfma_f32_16x16x32_bf16 v[188:191], a[120:123], v[120:123], v[188:191]
s_waitcnt lgkmcnt(4)
v_cvt_pk_bf16_f32 v149, v150, v151
v_cvt_pk_bf16_f32 v150, v156, v157
v_mfma_f32_16x16x32_bf16 v[192:195], a[64:67], v[112:115], v[192:195]
ds_read_b128 a[96:99], v2 offset:57344
v_cvt_pk_bf16_f32 v151, v158, v159
v_mfma_f32_16x16x32_bf16 v[192:195], a[68:71], v[116:119], v[192:195]
buffer_store_dwordx4 v[148:151], v1, s[4:7], s77 offen offset:1024 sc1
v_mfma_f32_16x16x32_bf16 v[196:199], a[68:71], v[124:127], v[196:199]
ds_read_b128 a[100:103], v2 offset:58368
v_cvt_pk_bf16_f32 v160, v160, v161
v_mfma_f32_16x16x32_bf16 v[196:199], a[64:67], v[120:123], v[196:199]
v_cvt_pk_bf16_f32 v161, v162, v163
v_cvt_pk_bf16_f32 v162, v168, v169
v_mfma_f32_16x16x32_bf16 v[200:203], a[72:75], v[112:115], v[200:203]
ds_read_b128 a[104:107], v2 offset:59392
v_cvt_pk_bf16_f32 v163, v170, v171
v_mfma_f32_16x16x32_bf16 v[200:203], a[76:79], v[116:119], v[200:203]
buffer_store_dwordx4 v[160:163], v1, s[4:7], s76 offen offset:2048 sc1
v_mfma_f32_16x16x32_bf16 v[204:207], a[76:79], v[124:127], v[204:207]
ds_read_b128 a[108:111], v2 offset:60416
v_cvt_pk_bf16_f32 v164, v164, v165
v_mfma_f32_16x16x32_bf16 v[204:207], a[72:75], v[120:123], v[204:207]
s_waitcnt lgkmcnt(4)
v_cvt_pk_bf16_f32 v165, v166, v167
v_cvt_pk_bf16_f32 v166, v172, v173
v_mfma_f32_16x16x32_bf16 v[208:211], a[80:83], v[112:115], v[208:211]
ds_read_b128 a[112:115], v2 offset:61440
v_cvt_pk_bf16_f32 v167, v174, v175
v_mfma_f32_16x16x32_bf16 v[208:211], a[84:87], v[116:119], v[208:211]
buffer_store_dwordx4 v[164:167], v1, s[4:7], s77 offen offset:2048 sc1
v_mfma_f32_16x16x32_bf16 v[212:215], a[84:87], v[124:127], v[212:215]
ds_read_b128 a[116:119], v2 offset:62464
v_cvt_pk_bf16_f32 v176, v176, v177
v_mfma_f32_16x16x32_bf16 v[212:215], a[80:83], v[120:123], v[212:215]
v_cvt_pk_bf16_f32 v177, v178, v179
v_cvt_pk_bf16_f32 v178, v184, v185
v_mfma_f32_16x16x32_bf16 v[216:219], a[88:91], v[112:115], v[216:219]
ds_read_b128 a[120:123], v2 offset:63488
v_cvt_pk_bf16_f32 v179, v186, v187
v_mfma_f32_16x16x32_bf16 v[216:219], a[92:95], v[116:119], v[216:219]
buffer_store_dwordx4 v[176:179], v1, s[4:7], s76 offen offset:3072 sc1
v_mfma_f32_16x16x32_bf16 v[220:223], a[92:95], v[124:127], v[220:223]
ds_read_b128 a[124:127], v2 offset:64512
v_cvt_pk_bf16_f32 v180, v180, v181
v_mfma_f32_16x16x32_bf16 v[220:223], a[88:91], v[120:123], v[220:223]
s_waitcnt lgkmcnt(4)
v_cvt_pk_bf16_f32 v181, v182, v183
v_cvt_pk_bf16_f32 v182, v188, v189
v_mfma_f32_16x16x32_bf16 v[224:227], a[96:99], v[112:115], v[224:227]
v_cvt_pk_bf16_f32 v183, v190, v191
v_accvgpr_mov_b32 a2, a194
v_mfma_f32_16x16x32_bf16 v[224:227], a[100:103], v[116:119], v[224:227]
buffer_store_dwordx4 v[180:183], v1, s[4:7], s77 offen offset:3072 sc1
v_mfma_f32_16x16x32_bf16 v[228:231], a[100:103], v[124:127], v[228:231]
s_add_u32 s76, s76, 4096
v_accvgpr_mov_b32 a3, a195
v_accvgpr_mov_b32 a4, a196
v_mfma_f32_16x16x32_bf16 v[228:231], a[96:99], v[120:123], v[228:231]
s_add_u32 s77, s77, 4096
v_cvt_pk_bf16_f32 v192, v192, v193
v_cvt_pk_bf16_f32 v193, v194, v195
v_mfma_f32_16x16x32_bf16 v[232:235], a[104:107], v[112:115], v[232:235]
v_cvt_pk_bf16_f32 v194, v200, v201
v_cvt_pk_bf16_f32 v195, v202, v203
v_mfma_f32_16x16x32_bf16 v[232:235], a[108:111], v[116:119], v[232:235]
PAD_34:
s_cbranch_execz M_tret
buffer_store_dwordx4 v[192:195], v1, s[4:7], s76 offen offset:0 sc1
v_mfma_f32_16x16x32_bf16 v[236:239], a[108:111], v[124:127], v[236:239]
v_cvt_pk_bf16_f32 v196, v196, v197
v_cvt_pk_bf16_f32 v197, v198, v199
v_mfma_f32_16x16x32_bf16 v[236:239], a[104:107], v[120:123], v[236:239]
s_waitcnt lgkmcnt(0)
v_cvt_pk_bf16_f32 v198, v204, v205
v_cvt_pk_bf16_f32 v199, v206, v207
v_mfma_f32_16x16x32_bf16 v[240:243], a[112:115], v[112:115], v[240:243]
buffer_store_dwordx4 v[196:199], v1, s[4:7], s77 offen offset:0 sc1
v_mfma_f32_16x16x32_bf16 v[240:243], a[116:119], v[116:119], v[240:243]
v_cvt_pk_bf16_f32 v208, v208, v209
v_cvt_pk_bf16_f32 v209, v210, v211
v_mfma_f32_16x16x32_bf16 v[244:247], a[116:119], v[124:127], v[244:247]
v_cvt_pk_bf16_f32 v210, v216, v217
v_cvt_pk_bf16_f32 v211, v218, v219
v_mfma_f32_16x16x32_bf16 v[244:247], a[112:115], v[120:123], v[244:247]
buffer_store_dwordx4 v[208:211], v1, s[4:7], s76 offen offset:1024 sc1
v_mfma_f32_16x16x32_bf16 v[248:251], a[120:123], v[112:115], v[248:251]
v_cvt_pk_bf16_f32 v212, v212, v213
v_cvt_pk_bf16_f32 v213, v214, v215
v_mfma_f32_16x16x32_bf16 v[248:251], a[124:127], v[116:119], v[248:251]
v_cvt_pk_bf16_f32 v214, v220, v221
v_cvt_pk_bf16_f32 v215, v222, v223
v_mfma_f32_16x16x32_bf16 v[252:255], a[124:127], v[124:127], v[252:255]
buffer_store_dwordx4 v[212:215], v1, s[4:7], s77 offen offset:1024 sc1
v_mfma_f32_16x16x32_bf16 v[252:255], a[120:123], v[120:123], v[252:255]
v_cvt_pk_bf16_f32 v224, v224, v225
v_cvt_pk_bf16_f32 v225, v226, v227
v_accvgpr_mov_b32 a5, a197
v_accvgpr_mov_b32 a6, a198
v_accvgpr_mov_b32 a7, a199
v_accvgpr_mov_b32 a8, a200
v_accvgpr_mov_b32 a9, a201
v_accvgpr_mov_b32 a10, a202
v_accvgpr_mov_b32 a11, a203
v_accvgpr_mov_b32 a12, a204
v_cvt_pk_bf16_f32 v226, v232, v233
v_cvt_pk_bf16_f32 v227, v234, v235
buffer_store_dwordx4 v[224:227], v1, s[4:7], s76 offen offset:2048 sc1
v_cvt_pk_bf16_f32 v228, v228, v229
v_cvt_pk_bf16_f32 v229, v230, v231
v_cvt_pk_bf16_f32 v230, v236, v237
v_cvt_pk_bf16_f32 v231, v238, v239
buffer_store_dwordx4 v[228:231], v1, s[4:7], s77 offen offset:2048 sc1
v_cvt_pk_bf16_f32 v240, v240, v241
v_cvt_pk_bf16_f32 v241, v242, v243
v_cvt_pk_bf16_f32 v242, v248, v249
v_cvt_pk_bf16_f32 v243, v250, v251
buffer_store_dwordx4 v[240:243], v1, s[4:7], s76 offen offset:3072 sc1
v_cvt_pk_bf16_f32 v244, v244, v245
v_cvt_pk_bf16_f32 v245, v246, v247
v_cvt_pk_bf16_f32 v246, v252, v253
v_cvt_pk_bf16_f32 v247, v254, v255
buffer_store_dwordx4 v[244:247], v1, s[4:7], s77 offen offset:3072 sc1
v_accvgpr_mov_b32 a13, a205
v_accvgpr_mov_b32 a14, a206
v_accvgpr_mov_b32 a15, a207
v_accvgpr_mov_b32 a16, a208
v_accvgpr_mov_b32 a17, a209
v_accvgpr_mov_b32 a18, a210
v_accvgpr_mov_b32 a19, a211
v_accvgpr_mov_b32 a20, a212
v_accvgpr_mov_b32 a21, a213
v_accvgpr_mov_b32 a22, a214
v_accvgpr_mov_b32 a23, a215
v_accvgpr_mov_b32 a24, a216
v_accvgpr_mov_b32 a25, a217
v_accvgpr_mov_b32 a26, a218
v_accvgpr_mov_b32 a27, a219
v_accvgpr_mov_b32 a28, a220
v_accvgpr_mov_b32 a29, a221
v_accvgpr_mov_b32 a30, a222
v_accvgpr_mov_b32 a31, a223
v_accvgpr_mov_b32 a32, a224
v_accvgpr_mov_b32 a33, a225
v_accvgpr_mov_b32 a34, a226
v_accvgpr_mov_b32 a35, a227
v_accvgpr_mov_b32 a36, a228
v_accvgpr_mov_b32 a37, a229
v_accvgpr_mov_b32 a38, a230
v_accvgpr_mov_b32 a39, a231
v_accvgpr_mov_b32 a40, a232
v_accvgpr_mov_b32 a41, a233
v_accvgpr_mov_b32 a42, a234
v_accvgpr_mov_b32 a43, a235
v_accvgpr_mov_b32 a44, a236
v_accvgpr_mov_b32 a45, a237
v_accvgpr_mov_b32 a46, a238
v_accvgpr_mov_b32 a47, a239
v_accvgpr_mov_b32 a48, a240
v_accvgpr_mov_b32 a49, a241
v_accvgpr_mov_b32 a50, a242
v_accvgpr_mov_b32 a51, a243
v_accvgpr_mov_b32 a52, a244
v_accvgpr_mov_b32 a53, a245
v_accvgpr_mov_b32 a54, a246
v_accvgpr_mov_b32 a55, a247
v_accvgpr_mov_b32 a56, a248
v_accvgpr_mov_b32 a57, a249
v_accvgpr_mov_b32 a58, a250
v_accvgpr_mov_b32 a59, a251
v_accvgpr_mov_b32 a60, a252
v_accvgpr_mov_b32 a61, a253
v_accvgpr_mov_b32 a62, a254
v_accvgpr_mov_b32 a63, a255
s_mov_b32 s24, 0
s_mov_b32 s29, s21
s_mov_b32 s19, s21
v_mov_b64 v[128:129], 0
v_mov_b64 v[130:131], 0
v_mov_b64 v[132:133], 0
v_mov_b64 v[134:135], 0
v_mov_b64 v[136:137], 0
v_mov_b64 v[138:139], 0
v_mov_b64 v[140:141], 0
v_mov_b64 v[142:143], 0
v_mov_b64 v[144:145], 0
v_mov_b64 v[146:147], 0
v_mov_b64 v[148:149], 0
v_mov_b64 v[150:151], 0
v_mov_b64 v[152:153], 0
v_mov_b64 v[154:155], 0
v_mov_b64 v[156:157], 0
v_mov_b64 v[158:159], 0
v_mov_b64 v[160:161], 0
v_mov_b64 v[162:163], 0
v_mov_b64 v[164:165], 0
v_mov_b64 v[166:167], 0
v_mov_b64 v[168:169], 0
v_mov_b64 v[170:171], 0
v_mov_b64 v[172:173], 0
v_mov_b64 v[174:175], 0
v_mov_b64 v[176:177], 0
v_mov_b64 v[178:179], 0
v_mov_b64 v[180:181], 0
v_mov_b64 v[182:183], 0
v_mov_b64 v[184:185], 0
v_mov_b64 v[186:187], 0
v_mov_b64 v[188:189], 0
v_mov_b64 v[190:191], 0
v_mov_b64 v[192:193], 0
v_mov_b64 v[194:195], 0
v_mov_b64 v[196:197], 0
v_mov_b64 v[198:199], 0
v_mov_b64 v[200:201], 0
v_mov_b64 v[202:203], 0
v_mov_b64 v[204:205], 0
v_mov_b64 v[206:207], 0
v_mov_b64 v[208:209], 0
v_mov_b64 v[210:211], 0
v_mov_b64 v[212:213], 0
v_mov_b64 v[214:215], 0
v_mov_b64 v[216:217], 0
v_mov_b64 v[218:219], 0
v_mov_b64 v[220:221], 0
v_mov_b64 v[222:223], 0
v_mov_b64 v[224:225], 0
v_mov_b64 v[226:227], 0
v_mov_b64 v[228:229], 0
v_mov_b64 v[230:231], 0
v_mov_b64 v[232:233], 0
v_mov_b64 v[234:235], 0
v_mov_b64 v[236:237], 0
v_mov_b64 v[238:239], 0
v_mov_b64 v[240:241], 0
v_mov_b64 v[242:243], 0
v_mov_b64 v[244:245], 0
v_mov_b64 v[246:247], 0
v_mov_b64 v[248:249], 0
v_mov_b64 v[250:251], 0
v_mov_b64 v[252:253], 0
v_mov_b64 v[254:255], 0
v_mov_b64 v[24:25], 0
s_mov_b32 s71, s28
s_mov_b32 s84, 0
s_barrier
s_branch K2_item
K2_nend:
Lstub_2:
s_call_b64 s[16:17], K2_slow1
s_branch Lback_3
Lstub_4:
s_call_b64 s[16:17], K2_slow0
s_branch Lback_5
Lstub_6:
s_call_b64 s[16:17], K2_slow1
s_branch Lback_7
Lstub_8:
s_call_b64 s[16:17], K2_slow0
s_branch Lback_9
Lstub_10:
s_call_b64 s[16:17], K2_slow2
s_branch Lback_11
Lstub_12:
s_call_b64 s[16:17], K2_slow2
s_branch Lback_13
Lstub_14:
s_call_b64 s[16:17], K2_slow1
s_branch Lback_15
K2_slow0:
s_nop 7
s_nop 7
v_max3_f32 v8, v32, v33, 0
v_max3_f32 v8, v34, v35, v8
v_max3_f32 v8, v40, v41, v8
v_max3_f32 v8, v42, v43, v8
v_max3_f32 v8, v48, v49, v8
v_max3_f32 v8, v50, v51, v8
v_max3_f32 v8, v56, v57, v8
v_max3_f32 v8, v58, v59, v8
v_mov_b32 v9, v8
s_nop 1
v_permlane16_swap_b32 v8, v9
v_max_f32 v8, v8, v9
v_mov_b32 v9, v8
s_nop 1
v_permlane32_swap_b32 v8, v9
v_max_f32 v8, v8, v9
v_exp_f32 v9, -v8
v_sub_f32 v16, v16, v8
v_sub_f32 v17, v17, v8
v_sub_f32 v18, v18, v8
v_sub_f32 v19, v19, v8
v_mul_f32 v24, v24, v9
v_mul_f32 v128, v128, v9
v_mul_f32 v129, v129, v9
v_mul_f32 v130, v130, v9
v_mul_f32 v131, v131, v9
v_mul_f32 v136, v136, v9
v_mul_f32 v137, v137, v9
v_mul_f32 v138, v138, v9
v_mul_f32 v139, v139, v9
v_mul_f32 v144, v144, v9
v_mul_f32 v145, v145, v9
v_mul_f32 v146, v146, v9
v_mul_f32 v147, v147, v9
v_mul_f32 v152, v152, v9
v_mul_f32 v153, v153, v9
v_mul_f32 v154, v154, v9
v_mul_f32 v155, v155, v9
v_mul_f32 v160, v160, v9
v_mul_f32 v161, v161, v9
v_mul_f32 v162, v162, v9
v_mul_f32 v163, v163, v9
v_mul_f32 v168, v168, v9
v_mul_f32 v169, v169, v9
v_mul_f32 v170, v170, v9
v_mul_f32 v171, v171, v9
v_mul_f32 v176, v176, v9
v_mul_f32 v177, v177, v9
v_mul_f32 v178, v178, v9
v_mul_f32 v179, v179, v9
v_mul_f32 v184, v184, v9
v_mul_f32 v185, v185, v9
v_mul_f32 v186, v186, v9
v_mul_f32 v187, v187, v9
v_mul_f32 v192, v192, v9
v_mul_f32 v193, v193, v9
v_mul_f32 v194, v194, v9
v_mul_f32 v195, v195, v9
v_mul_f32 v200, v200, v9
v_mul_f32 v201, v201, v9
v_mul_f32 v202, v202, v9
v_mul_f32 v203, v203, v9
v_mul_f32 v208, v208, v9
v_mul_f32 v209, v209, v9
v_mul_f32 v210, v210, v9
v_mul_f32 v211, v211, v9
v_mul_f32 v216, v216, v9
v_mul_f32 v217, v217, v9
v_mul_f32 v218, v218, v9
v_mul_f32 v219, v219, v9
v_mul_f32 v224, v224, v9
v_mul_f32 v225, v225, v9
v_mul_f32 v226, v226, v9
v_mul_f32 v227, v227, v9
v_mul_f32 v232, v232, v9
v_mul_f32 v233, v233, v9
v_mul_f32 v234, v234, v9
v_mul_f32 v235, v235, v9
v_mul_f32 v240, v240, v9
v_mul_f32 v241, v241, v9
v_mul_f32 v242, v242, v9
v_mul_f32 v243, v243, v9
v_mul_f32 v248, v248, v9
v_mul_f32 v249, v249, v9
v_mul_f32 v250, v250, v9
v_mul_f32 v251, v251, v9
v_sub_f32 v32, v32, v8
v_sub_f32 v33, v33, v8
v_sub_f32 v34, v34, v8
v_sub_f32 v35, v35, v8
v_sub_f32 v40, v40, v8
v_sub_f32 v41, v41, v8
v_sub_f32 v42, v42, v8
v_sub_f32 v43, v43, v8
v_sub_f32 v48, v48, v8
v_sub_f32 v49, v49, v8
v_sub_f32 v50, v50, v8
v_sub_f32 v51, v51, v8
v_sub_f32 v56, v56, v8
v_sub_f32 v57, v57, v8
v_sub_f32 v58, v58, v8
v_sub_f32 v59, v59, v8
v_sub_f32 v64, v64, v8
v_sub_f32 v65, v65, v8
v_sub_f32 v66, v66, v8
v_sub_f32 v67, v67, v8
v_sub_f32 v72, v72, v8
v_sub_f32 v73, v73, v8
v_sub_f32 v74, v74, v8
v_sub_f32 v75, v75, v8
v_sub_f32 v80, v80, v8
v_sub_f32 v81, v81, v8
v_sub_f32 v82, v82, v8
v_sub_f32 v83, v83, v8
v_sub_f32 v88, v88, v8
v_sub_f32 v89, v89, v8
v_sub_f32 v90, v90, v8
v_sub_f32 v91, v91, v8
v_max3_f32 v8, v36, v37, 0
v_max3_f32 v8, v38, v39, v8
v_max3_f32 v8, v44, v45, v8
v_max3_f32 v8, v46, v47, v8
v_max3_f32 v8, v52, v53, v8
v_max3_f32 v8, v54, v55, v8
v_max3_f32 v8, v60, v61, v8
v_max3_f32 v8, v62, v63, v8
v_mov_b32 v9, v8
s_nop 1
v_permlane16_swap_b32 v8, v9
v_max_f32 v8, v8, v9
v_mov_b32 v9, v8
s_nop 1
v_permlane32_swap_b32 v8, v9
v_max_f32 v8, v8, v9
v_exp_f32 v9, -v8
v_sub_f32 v20, v20, v8
v_sub_f32 v21, v21, v8
v_sub_f32 v22, v22, v8
v_sub_f32 v23, v23, v8
v_mul_f32 v25, v25, v9
v_mul_f32 v132, v132, v9
v_mul_f32 v133, v133, v9
v_mul_f32 v134, v134, v9
v_mul_f32 v135, v135, v9
v_mul_f32 v140, v140, v9
v_mul_f32 v141, v141, v9
v_mul_f32 v142, v142, v9
v_mul_f32 v143, v143, v9
v_mul_f32 v148, v148, v9
v_mul_f32 v149, v149, v9
v_mul_f32 v150, v150, v9
v_mul_f32 v151, v151, v9
v_mul_f32 v156, v156, v9
v_mul_f32 v157, v157, v9
v_mul_f32 v158, v158, v9
v_mul_f32 v159, v159, v9
v_mul_f32 v164, v164, v9
v_mul_f32 v165, v165, v9
v_mul_f32 v166, v166, v9
v_mul_f32 v167, v167, v9
v_mul_f32 v172, v172, v9
v_mul_f32 v173, v173, v9
v_mul_f32 v174, v174, v9
v_mul_f32 v175, v175, v9
v_mul_f32 v180, v180, v9
v_mul_f32 v181, v181, v9
v_mul_f32 v182, v182, v9
v_mul_f32 v183, v183, v9
v_mul_f32 v188, v188, v9
v_mul_f32 v189, v189, v9
v_mul_f32 v190, v190, v9
v_mul_f32 v191, v191, v9
v_mul_f32 v196, v196, v9
v_mul_f32 v197, v197, v9
v_mul_f32 v198, v198, v9
v_mul_f32 v199, v199, v9
v_mul_f32 v204, v204, v9
v_mul_f32 v205, v205, v9
v_mul_f32 v206, v206, v9
v_mul_f32 v207, v207, v9
v_mul_f32 v212, v212, v9
v_mul_f32 v213, v213, v9
v_mul_f32 v214, v214, v9
v_mul_f32 v215, v215, v9
v_mul_f32 v220, v220, v9
v_mul_f32 v221, v221, v9
v_mul_f32 v222, v222, v9
v_mul_f32 v223, v223, v9
v_mul_f32 v228, v228, v9
v_mul_f32 v229, v229, v9
v_mul_f32 v230, v230, v9
v_mul_f32 v231, v231, v9
v_mul_f32 v236, v236, v9
v_mul_f32 v237, v237, v9
v_mul_f32 v238, v238, v9
v_mul_f32 v239, v239, v9
v_mul_f32 v244, v244, v9
v_mul_f32 v245, v245, v9
v_mul_f32 v246, v246, v9
v_mul_f32 v247, v247, v9
v_mul_f32 v252, v252, v9
v_mul_f32 v253, v253, v9
v_mul_f32 v254, v254, v9
v_mul_f32 v255, v255, v9
v_sub_f32 v36, v36, v8
v_sub_f32 v37, v37, v8
v_sub_f32 v38, v38, v8
v_sub_f32 v39, v39, v8
v_sub_f32 v44, v44, v8
v_sub_f32 v45, v45, v8
v_sub_f32 v46, v46, v8
v_sub_f32 v47, v47, v8
v_sub_f32 v52, v52, v8
v_sub_f32 v53, v53, v8
v_sub_f32 v54, v54, v8
v_sub_f32 v55, v55, v8
v_sub_f32 v60, v60, v8
v_sub_f32 v61, v61, v8
v_sub_f32 v62, v62, v8
v_sub_f32 v63, v63, v8
v_sub_f32 v68, v68, v8
v_sub_f32 v69, v69, v8
v_sub_f32 v70, v70, v8
v_sub_f32 v71, v71, v8
v_sub_f32 v76, v76, v8
v_sub_f32 v77, v77, v8
v_sub_f32 v78, v78, v8
v_sub_f32 v79, v79, v8
v_sub_f32 v84, v84, v8
v_sub_f32 v85, v85, v8
v_sub_f32 v86, v86, v8
v_sub_f32 v87, v87, v8
v_sub_f32 v92, v92, v8
v_sub_f32 v93, v93, v8
v_sub_f32 v94, v94, v8
v_sub_f32 v95, v95, v8
v_exp_f32 v8, v32
v_exp_f32 v9, v33
v_exp_f32 v10, v34
v_exp_f32 v11, v35
s_nop 0
v_add_f32 v26, v8, v9
v_cvt_pk_bf16_f32 v96, v8, v9
v_add_f32 v26, v26, v10
v_add_f32 v26, v26, v11
v_cvt_pk_bf16_f32 v97, v10, v11
v_exp_f32 v12, v36
v_exp_f32 v13, v37
v_exp_f32 v14, v38
v_exp_f32 v15, v39
s_nop 0
v_add_f32 v27, v12, v13
v_cvt_pk_bf16_f32 v104, v12, v13
v_add_f32 v27, v27, v14
v_add_f32 v27, v27, v15
v_cvt_pk_bf16_f32 v105, v14, v15
v_exp_f32 v8, v40
v_exp_f32 v9, v41
v_exp_f32 v10, v42
v_exp_f32 v11, v43
s_nop 0
v_add_f32 v26, v26, v8
v_add_f32 v26, v26, v9
v_cvt_pk_bf16_f32 v98, v8, v9
v_add_f32 v26, v26, v10
v_add_f32 v26, v26, v11
v_cvt_pk_bf16_f32 v99, v10, v11
v_exp_f32 v12, v44
v_exp_f32 v13, v45
v_exp_f32 v14, v46
v_exp_f32 v15, v47
s_nop 0
v_add_f32 v27, v27, v12
v_add_f32 v27, v27, v13
v_cvt_pk_bf16_f32 v106, v12, v13
v_add_f32 v27, v27, v14
v_add_f32 v27, v27, v15
v_cvt_pk_bf16_f32 v107, v14, v15
v_exp_f32 v8, v48
v_exp_f32 v9, v49
v_exp_f32 v10, v50
v_exp_f32 v11, v51
s_nop 0
v_add_f32 v26, v26, v8
v_add_f32 v26, v26, v9
v_cvt_pk_bf16_f32 v100, v8, v9
v_add_f32 v26, v26, v10
v_add_f32 v26, v26, v11
v_cvt_pk_bf16_f32 v101, v10, v11
v_exp_f32 v12, v52
v_exp_f32 v13, v53
v_exp_f32 v14, v54
v_exp_f32 v15, v55
s_nop 0
v_add_f32 v27, v27, v12
v_add_f32 v27, v27, v13
v_cvt_pk_bf16_f32 v108, v12, v13
v_add_f32 v27, v27, v14
v_add_f32 v27, v27, v15
v_cvt_pk_bf16_f32 v109, v14, v15
v_exp_f32 v8, v56
v_exp_f32 v9, v57
v_exp_f32 v10, v58
v_exp_f32 v11, v59
s_nop 0
v_add_f32 v26, v26, v8
v_add_f32 v26, v26, v9
v_cvt_pk_bf16_f32 v102, v8, v9
v_add_f32 v26, v26, v10
v_add_f32 v26, v26, v11
v_cvt_pk_bf16_f32 v103, v10, v11
v_exp_f32 v12, v60
v_exp_f32 v13, v61
v_exp_f32 v14, v62
v_exp_f32 v15, v63
s_nop 0
v_add_f32 v27, v27, v12
v_add_f32 v27, v27, v13
v_cvt_pk_bf16_f32 v110, v12, v13
v_add_f32 v27, v27, v14
v_add_f32 v27, v27, v15
v_cvt_pk_bf16_f32 v111, v14, v15
s_nop 1
s_setpc_b64 s[16:17]
K2_slow1:
s_nop 7
s_nop 7
v_max3_f32 v8, v64, v65, 0
v_max3_f32 v8, v66, v67, v8
v_max3_f32 v8, v72, v73, v8
v_max3_f32 v8, v74, v75, v8
v_max3_f32 v8, v80, v81, v8
v_max3_f32 v8, v82, v83, v8
v_max3_f32 v8, v88, v89, v8
v_max3_f32 v8, v90, v91, v8
v_mov_b32 v9, v8
s_nop 1
v_permlane16_swap_b32 v8, v9
v_max_f32 v8, v8, v9
v_mov_b32 v9, v8
s_nop 1
v_permlane32_swap_b32 v8, v9
v_max_f32 v8, v8, v9
v_exp_f32 v9, -v8
v_sub_f32 v16, v16, v8
v_sub_f32 v17, v17, v8
v_sub_f32 v18, v18, v8
v_sub_f32 v19, v19, v8
v_mul_f32 v24, v24, v9
v_mul_f32 v128, v128, v9
v_mul_f32 v129, v129, v9
v_mul_f32 v130, v130, v9
v_mul_f32 v131, v131, v9
v_mul_f32 v136, v136, v9
v_mul_f32 v137, v137, v9
v_mul_f32 v138, v138, v9
v_mul_f32 v139, v139, v9
v_mul_f32 v144, v144, v9
v_mul_f32 v145, v145, v9
v_mul_f32 v146, v146, v9
v_mul_f32 v147, v147, v9
v_mul_f32 v152, v152, v9
v_mul_f32 v153, v153, v9
v_mul_f32 v154, v154, v9
v_mul_f32 v155, v155, v9
v_mul_f32 v160, v160, v9
v_mul_f32 v161, v161, v9
v_mul_f32 v162, v162, v9
v_mul_f32 v163, v163, v9
v_mul_f32 v168, v168, v9
v_mul_f32 v169, v169, v9
v_mul_f32 v170, v170, v9
v_mul_f32 v171, v171, v9
v_mul_f32 v176, v176, v9
v_mul_f32 v177, v177, v9
v_mul_f32 v178, v178, v9
v_mul_f32 v179, v179, v9
v_mul_f32 v184, v184, v9
v_mul_f32 v185, v185, v9
v_mul_f32 v186, v186, v9
v_mul_f32 v187, v187, v9
v_mul_f32 v192, v192, v9
v_mul_f32 v193, v193, v9
v_mul_f32 v194, v194, v9
v_mul_f32 v195, v195, v9
v_mul_f32 v200, v200, v9
v_mul_f32 v201, v201, v9
v_mul_f32 v202, v202, v9
v_mul_f32 v203, v203, v9
v_mul_f32 v208, v208, v9
v_mul_f32 v209, v209, v9
v_mul_f32 v210, v210, v9
v_mul_f32 v211, v211, v9
v_mul_f32 v216, v216, v9
v_mul_f32 v217, v217, v9
v_mul_f32 v218, v218, v9
v_mul_f32 v219, v219, v9
v_mul_f32 v224, v224, v9
v_mul_f32 v225, v225, v9
v_mul_f32 v226, v226, v9
v_mul_f32 v227, v227, v9
v_mul_f32 v232, v232, v9
v_mul_f32 v233, v233, v9
v_mul_f32 v234, v234, v9
v_mul_f32 v235, v235, v9
v_mul_f32 v240, v240, v9
v_mul_f32 v241, v241, v9
v_mul_f32 v242, v242, v9
v_mul_f32 v243, v243, v9
v_mul_f32 v248, v248, v9
v_mul_f32 v249, v249, v9
v_mul_f32 v250, v250, v9
v_mul_f32 v251, v251, v9
v_sub_f32 v32, v32, v8
v_sub_f32 v33, v33, v8
v_sub_f32 v34, v34, v8
v_sub_f32 v35, v35, v8
v_sub_f32 v40, v40, v8
v_sub_f32 v41, v41, v8
v_sub_f32 v42, v42, v8
v_sub_f32 v43, v43, v8
v_sub_f32 v48, v48, v8
v_sub_f32 v49, v49, v8
v_sub_f32 v50, v50, v8
v_sub_f32 v51, v51, v8
v_sub_f32 v56, v56, v8
v_sub_f32 v57, v57, v8
v_sub_f32 v58, v58, v8
v_sub_f32 v59, v59, v8
v_sub_f32 v64, v64, v8
v_sub_f32 v65, v65, v8
v_sub_f32 v66, v66, v8
v_sub_f32 v67, v67, v8
v_sub_f32 v72, v72, v8
v_sub_f32 v73, v73, v8
v_sub_f32 v74, v74, v8
v_sub_f32 v75, v75, v8
v_sub_f32 v80, v80, v8
v_sub_f32 v81, v81, v8
v_sub_f32 v82, v82, v8
v_sub_f32 v83, v83, v8
v_sub_f32 v88, v88, v8
v_sub_f32 v89, v89, v8
v_sub_f32 v90, v90, v8
v_sub_f32 v91, v91, v8
v_max3_f32 v8, v68, v69, 0
v_max3_f32 v8, v70, v71, v8
v_max3_f32 v8, v76, v77, v8
v_max3_f32 v8, v78, v79, v8
v_max3_f32 v8, v84, v85, v8
v_max3_f32 v8, v86, v87, v8
v_max3_f32 v8, v92, v93, v8
v_max3_f32 v8, v94, v95, v8
v_mov_b32 v9, v8
s_nop 1
v_permlane16_swap_b32 v8, v9
v_max_f32 v8, v8, v9
v_mov_b32 v9, v8
s_nop 1
v_permlane32_swap_b32 v8, v9
v_max_f32 v8, v8, v9
v_exp_f32 v9, -v8
v_sub_f32 v20, v20, v8
v_sub_f32 v21, v21, v8
v_sub_f32 v22, v22, v8
v_sub_f32 v23, v23, v8
v_mul_f32 v25, v25, v9
v_mul_f32 v132, v132, v9
v_mul_f32 v133, v133, v9
v_mul_f32 v134, v134, v9
v_mul_f32 v135, v135, v9
v_mul_f32 v140, v140, v9
v_mul_f32 v141, v141, v9
v_mul_f32 v142, v142, v9
v_mul_f32 v143, v143, v9
v_mul_f32 v148, v148, v9
v_mul_f32 v149, v149, v9
v_mul_f32 v150, v150, v9
v_mul_f32 v151, v151, v9
v_mul_f32 v156, v156, v9
v_mul_f32 v157, v157, v9
v_mul_f32 v158, v158, v9
v_mul_f32 v159, v159, v9
v_mul_f32 v164, v164, v9
v_mul_f32 v165, v165, v9
v_mul_f32 v166, v166, v9
v_mul_f32 v167, v167, v9
v_mul_f32 v172, v172, v9
v_mul_f32 v173, v173, v9
v_mul_f32 v174, v174, v9
v_mul_f32 v175, v175, v9
v_mul_f32 v180, v180, v9
v_mul_f32 v181, v181, v9
v_mul_f32 v182, v182, v9
v_mul_f32 v183, v183, v9
v_mul_f32 v188, v188, v9
v_mul_f32 v189, v189, v9
v_mul_f32 v190, v190, v9
v_mul_f32 v191, v191, v9
v_mul_f32 v196, v196, v9
v_mul_f32 v197, v197, v9
v_mul_f32 v198, v198, v9
v_mul_f32 v199, v199, v9
v_mul_f32 v204, v204, v9
v_mul_f32 v205, v205, v9
v_mul_f32 v206, v206, v9
v_mul_f32 v207, v207, v9
v_mul_f32 v212, v212, v9
v_mul_f32 v213, v213, v9
v_mul_f32 v214, v214, v9
v_mul_f32 v215, v215, v9
v_mul_f32 v220, v220, v9
v_mul_f32 v221, v221, v9
v_mul_f32 v222, v222, v9
v_mul_f32 v223, v223, v9
v_mul_f32 v228, v228, v9
v_mul_f32 v229, v229, v9
v_mul_f32 v230, v230, v9
v_mul_f32 v231, v231, v9
v_mul_f32 v236, v236, v9
v_mul_f32 v237, v237, v9
v_mul_f32 v238, v238, v9
v_mul_f32 v239, v239, v9
v_mul_f32 v244, v244, v9
v_mul_f32 v245, v245, v9
v_mul_f32 v246, v246, v9
v_mul_f32 v247, v247, v9
v_mul_f32 v252, v252, v9
v_mul_f32 v253, v253, v9
v_mul_f32 v254, v254, v9
v_mul_f32 v255, v255, v9
v_sub_f32 v36, v36, v8
v_sub_f32 v37, v37, v8
v_sub_f32 v38, v38, v8
v_sub_f32 v39, v39, v8
v_sub_f32 v44, v44, v8
v_sub_f32 v45, v45, v8
v_sub_f32 v46, v46, v8
v_sub_f32 v47, v47, v8
v_sub_f32 v52, v52, v8
v_sub_f32 v53, v53, v8
v_sub_f32 v54, v54, v8
v_sub_f32 v55, v55, v8
v_sub_f32 v60, v60, v8
v_sub_f32 v61, v61, v8
v_sub_f32 v62, v62, v8
v_sub_f32 v63, v63, v8
v_sub_f32 v68, v68, v8
v_sub_f32 v69, v69, v8
v_sub_f32 v70, v70, v8
v_sub_f32 v71, v71, v8
v_sub_f32 v76, v76, v8
v_sub_f32 v77, v77, v8
v_sub_f32 v78, v78, v8
v_sub_f32 v79, v79, v8
v_sub_f32 v84, v84, v8
v_sub_f32 v85, v85, v8
v_sub_f32 v86, v86, v8
v_sub_f32 v87, v87, v8
v_sub_f32 v92, v92, v8
v_sub_f32 v93, v93, v8
v_sub_f32 v94, v94, v8
v_sub_f32 v95, v95, v8
v_exp_f32 v8, v64
v_exp_f32 v9, v65
v_exp_f32 v10, v66
v_exp_f32 v11, v67
s_nop 0
v_add_f32 v26, v8, v9
v_cvt_pk_bf16_f32 v112, v8, v9
v_add_f32 v26, v26, v10
v_add_f32 v26, v26, v11
v_cvt_pk_bf16_f32 v113, v10, v11
v_exp_f32 v12, v68
v_exp_f32 v13, v69
v_exp_f32 v14, v70
v_exp_f32 v15, v71
s_nop 0
v_add_f32 v27, v12, v13
v_cvt_pk_bf16_f32 v120, v12, v13
v_add_f32 v27, v27, v14
v_add_f32 v27, v27, v15
v_cvt_pk_bf16_f32 v121, v14, v15
v_exp_f32 v8, v72
v_exp_f32 v9, v73
v_exp_f32 v10, v74
v_exp_f32 v11, v75
s_nop 0
v_add_f32 v26, v26, v8
v_add_f32 v26, v26, v9
v_cvt_pk_bf16_f32 v114, v8, v9
v_add_f32 v26, v26, v10
v_add_f32 v26, v26, v11
v_cvt_pk_bf16_f32 v115, v10, v11
v_exp_f32 v12, v76
v_exp_f32 v13, v77
v_exp_f32 v14, v78
v_exp_f32 v15, v79
s_nop 0
v_add_f32 v27, v27, v12
v_add_f32 v27, v27, v13
v_cvt_pk_bf16_f32 v122, v12, v13
v_add_f32 v27, v27, v14
v_add_f32 v27, v27, v15
v_cvt_pk_bf16_f32 v123, v14, v15
v_exp_f32 v8, v80
v_exp_f32 v9, v81
v_exp_f32 v10, v82
v_exp_f32 v11, v83
s_nop 0
v_add_f32 v26, v26, v8
v_add_f32 v26, v26, v9
v_cvt_pk_bf16_f32 v116, v8, v9
v_add_f32 v26, v26, v10
v_add_f32 v26, v26, v11
v_cvt_pk_bf16_f32 v117, v10, v11
v_exp_f32 v12, v84
v_exp_f32 v13, v85
v_exp_f32 v14, v86
v_exp_f32 v15, v87
s_nop 0
v_add_f32 v27, v27, v12
v_add_f32 v27, v27, v13
v_cvt_pk_bf16_f32 v124, v12, v13
v_add_f32 v27, v27, v14
v_add_f32 v27, v27, v15
v_cvt_pk_bf16_f32 v125, v14, v15
v_exp_f32 v8, v88
v_exp_f32 v9, v89
v_exp_f32 v10, v90
v_exp_f32 v11, v91
s_nop 0
v_add_f32 v26, v26, v8
v_add_f32 v26, v26, v9
v_cvt_pk_bf16_f32 v118, v8, v9
v_add_f32 v26, v26, v10
v_add_f32 v26, v26, v11
v_cvt_pk_bf16_f32 v119, v10, v11
v_exp_f32 v12, v92
v_exp_f32 v13, v93
v_exp_f32 v14, v94
v_exp_f32 v15, v95
s_nop 0
v_add_f32 v27, v27, v12
v_add_f32 v27, v27, v13
v_cvt_pk_bf16_f32 v126, v12, v13
v_add_f32 v27, v27, v14
v_add_f32 v27, v27, v15
v_cvt_pk_bf16_f32 v127, v14, v15
s_nop 1
s_setpc_b64 s[16:17]
K2_slow2:
s_nop 7
s_nop 7
v_max3_f32 v8, v68, v69, 0
v_max3_f32 v8, v70, v71, v8
v_max3_f32 v8, v76, v77, v8
v_max3_f32 v8, v78, v79, v8
v_max3_f32 v8, v84, v85, v8
v_max3_f32 v8, v86, v87, v8
v_max3_f32 v8, v92, v93, v8
v_max3_f32 v8, v94, v95, v8
v_mov_b32 v9, v8
s_nop 1
v_permlane16_swap_b32 v8, v9
v_max_f32 v8, v8, v9
v_mov_b32 v9, v8
s_nop 1
v_permlane32_swap_b32 v8, v9
v_max_f32 v8, v8, v9
v_exp_f32 v9, -v8
v_sub_f32 v20, v20, v8
v_sub_f32 v21, v21, v8
v_sub_f32 v22, v22, v8
v_sub_f32 v23, v23, v8
v_mul_f32 v25, v25, v9
v_mul_f32 v132, v132, v9
v_mul_f32 v133, v133, v9
v_mul_f32 v134, v134, v9
v_mul_f32 v135, v135, v9
v_mul_f32 v140, v140, v9
v_mul_f32 v141, v141, v9
v_mul_f32 v142, v142, v9
v_mul_f32 v143, v143, v9
v_mul_f32 v148, v148, v9
v_mul_f32 v149, v149, v9
v_mul_f32 v150, v150, v9
v_mul_f32 v151, v151, v9
v_mul_f32 v156, v156, v9
v_mul_f32 v157, v157, v9
v_mul_f32 v158, v158, v9
v_mul_f32 v159, v159, v9
v_mul_f32 v164, v164, v9
v_mul_f32 v165, v165, v9
v_mul_f32 v166, v166, v9
v_mul_f32 v167, v167, v9
v_mul_f32 v172, v172, v9
v_mul_f32 v173, v173, v9
v_mul_f32 v174, v174, v9
v_mul_f32 v175, v175, v9
v_mul_f32 v180, v180, v9
v_mul_f32 v181, v181, v9
v_mul_f32 v182, v182, v9
v_mul_f32 v183, v183, v9
v_mul_f32 v188, v188, v9
v_mul_f32 v189, v189, v9
v_mul_f32 v190, v190, v9
v_mul_f32 v191, v191, v9
v_mul_f32 v196, v196, v9
v_mul_f32 v197, v197, v9
v_mul_f32 v198, v198, v9
v_mul_f32 v199, v199, v9
v_mul_f32 v204, v204, v9
v_mul_f32 v205, v205, v9
v_mul_f32 v206, v206, v9
v_mul_f32 v207, v207, v9
v_mul_f32 v212, v212, v9
v_mul_f32 v213, v213, v9
v_mul_f32 v214, v214, v9
v_mul_f32 v215, v215, v9
v_mul_f32 v220, v220, v9
v_mul_f32 v221, v221, v9
v_mul_f32 v222, v222, v9
v_mul_f32 v223, v223, v9
v_mul_f32 v228, v228, v9
v_mul_f32 v229, v229, v9
v_mul_f32 v230, v230, v9
v_mul_f32 v231, v231, v9
v_mul_f32 v236, v236, v9
v_mul_f32 v237, v237, v9
v_mul_f32 v238, v238, v9
v_mul_f32 v239, v239, v9
v_mul_f32 v244, v244, v9
v_mul_f32 v245, v245, v9
v_mul_f32 v246, v246, v9
v_mul_f32 v247, v247, v9
v_mul_f32 v252, v252, v9
v_mul_f32 v253, v253, v9
v_mul_f32 v254, v254, v9
v_mul_f32 v255, v255, v9
v_sub_f32 v68, v68, v8
v_sub_f32 v69, v69, v8
v_sub_f32 v70, v70, v8
v_sub_f32 v71, v71, v8
v_sub_f32 v76, v76, v8
v_sub_f32 v77, v77, v8
v_sub_f32 v78, v78, v8
v_sub_f32 v79, v79, v8
v_sub_f32 v84, v84, v8
v_sub_f32 v85, v85, v8
v_sub_f32 v86, v86, v8
v_sub_f32 v87, v87, v8
v_sub_f32 v92, v92, v8
v_sub_f32 v93, v93, v8
v_sub_f32 v94, v94, v8
v_sub_f32 v95, v95, v8
v_exp_f32 v8, v68
v_exp_f32 v9, v69
v_exp_f32 v10, v70
v_exp_f32 v11, v71
s_nop 0
v_add_f32 v27, v8, v9
v_cvt_pk_bf16_f32 v120, v8, v9
v_add_f32 v27, v27, v10
v_add_f32 v27, v27, v11
v_cvt_pk_bf16_f32 v121, v10, v11
v_exp_f32 v12, v76
v_exp_f32 v13, v77
v_exp_f32 v14, v78
v_exp_f32 v15, v79
s_nop 0
v_add_f32 v27, v27, v12
v_add_f32 v27, v27, v13
v_cvt_pk_bf16_f32 v122, v12, v13
v_add_f32 v27, v27, v14
v_add_f32 v27, v27, v15
v_cvt_pk_bf16_f32 v123, v14, v15
v_exp_f32 v8, v84
v_exp_f32 v9, v85
v_exp_f32 v10, v86
v_exp_f32 v11, v87
s_nop 0
v_add_f32 v27, v27, v8
v_add_f32 v27, v27, v9
v_cvt_pk_bf16_f32 v124, v8, v9
v_add_f32 v27, v27, v10
v_add_f32 v27, v27, v11
v_cvt_pk_bf16_f32 v125, v10, v11
v_exp_f32 v12, v92
v_exp_f32 v13, v93
v_exp_f32 v14, v94
v_exp_f32 v15, v95
s_nop 0
v_add_f32 v27, v27, v12
v_add_f32 v27, v27, v13
v_cvt_pk_bf16_f32 v126, v12, v13
v_add_f32 v27, v27, v14
v_add_f32 v27, v27, v15
v_cvt_pk_bf16_f32 v127, v14, v15
s_nop 1
s_setpc_b64 s[16:17]
M_cntspinK:
Lp_9801:
buffer_load_dword v245, off, s[60:63], 0 sc1
s_waitcnt vmcnt(0)
v_cmp_gt_u32 vcc, 0x100, v245
s_cbranch_vccz Lpd_9802
s_sleep 8
s_sub_u32 s101, s101, 1
s_cbranch_scc0 Lp_9801
s_mov_b32 s101, 0
Lpd_9802:
s_branch Lg_1
M_ppspinK:
Lp_9803:
buffer_load_dword v230, v231, s[4:7], s52 offen sc1
s_waitcnt vmcnt(0)
v_cmp_gt_u32 vcc, 1, v230
s_cbranch_vccz Lpd_9804
s_sleep 8
s_sub_u32 s101, s101, 1
s_cbranch_scc0 Lp_9803
s_mov_b32 s101, 0
Lpd_9804:
s_branch M_ppokK
M_cntspinV:
Lp_9805:
buffer_load_dword v245, off, s[60:63], 0 sc1
s_waitcnt vmcnt(0)
v_cmp_gt_u32 vcc, 0x100, v245
s_cbranch_vccz Lpd_9806
s_sleep 8
s_sub_u32 s101, s101, 1
s_cbranch_scc0 Lp_9805
s_mov_b32 s101, 0
Lpd_9806:
s_branch Lg_501
M_ppspinV:
Lp_9807:
buffer_load_dword v230, v231, s[4:7], s52 offen sc1
s_waitcnt vmcnt(0)
v_cmp_gt_u32 vcc, 1, v230
s_cbranch_vccz Lpd_9808
s_sleep 8
s_sub_u32 s101, s101, 1
s_cbranch_scc0 Lp_9807
s_mov_b32 s101, 0
Lpd_9808:
s_branch M_ppokV
M_t2B:
s_mov_b64 exec, 0
s_cmp_lg_u32 s3, 0
s_cbranch_scc1 M_uw1
s_call_b64 s[98:99], PAD_32
s_call_b64 s[98:99], PAD_16
s_branch M_ud
M_uw1:
s_cmp_lg_u32 s3, 1
s_cbranch_scc1 M_uw2
s_call_b64 s[98:99], PAD_33
s_call_b64 s[98:99], PAD_13
s_branch M_ud
M_uw2:
s_cmp_lg_u32 s3, 2
s_cbranch_scc1 M_uw3
s_call_b64 s[98:99], PAD_34
s_call_b64 s[98:99], PAD_14
s_branch M_ud
M_uw3:
s_call_b64 s[98:99], PAD_15
M_ud:
s_mov_b64 exec, -1
s_branch M_t2Br
M_t2A:
s_mov_b64 exec, 0
s_cmp_lg_u32 s3, 0
s_cbranch_scc1 M_vw1
s_call_b64 s[98:99], PAD_32
s_call_b64 s[98:99], PAD_16
s_branch M_vd
M_vw1:
s_cmp_lg_u32 s3, 1
s_cbranch_scc1 M_vw2
s_call_b64 s[98:99], PAD_13
s_branch M_vd
M_vw2:
s_cmp_lg_u32 s3, 2
s_cbranch_scc1 M_vw3
s_call_b64 s[98:99], PAD_14
s_call_b64 s[98:99], PAD_19
s_branch M_vd
M_vw3:
s_call_b64 s[98:99], PAD_15
s_call_b64 s[98:99], PAD_20
M_vd:
s_mov_b64 exec, -1
s_branch M_t2Ar
M_end:
s_endpgm
.section .rodata,"a"
.p2align 6
.amdhsa_kernel concat_heads__ssm_conv_h3__compressed_kv_cla__prompt_kernel
  .amdhsa_next_free_vgpr 512
  .amdhsa_next_free_sgpr 102
  .amdhsa_accum_offset 256
  .amdhsa_group_segment_fixed_size 0
  .amdhsa_kernarg_size 120
  .amdhsa_user_sgpr_count 2
  .amdhsa_user_sgpr_kernarg_segment_ptr 1
  .amdhsa_system_sgpr_workgroup_id_x 1
  .amdhsa_float_denorm_mode_32 3
  .amdhsa_float_denorm_mode_16_64 3
  .amdhsa_ieee_mode 0
  .amdhsa_dx10_clamp 0
.end_amdhsa_kernel
```

```asm
; @launch grid=(256,1,1) block=(256,1,1) lds=163840
.amdgcn_target "amdgcn-amd-amdhsa--gfx950"
.text
.globl concat_heads__ssm_conv_h3__compressed_kv_cla__prompt_kernel
.p2align 8
.type concat_heads__ssm_conv_h3__compressed_kv_cla__prompt_kernel,@function
concat_heads__ssm_conv_h3__compressed_kv_cla__prompt_kernel:
s_cmp_ge_u32 s2, 256
s_cbranch_scc1 M_end
s_load_dwordx16 s[64:79], s[0:1], 0
s_load_dwordx8 s[80:87], s[0:1], 64
s_load_dwordx4 s[88:91], s[0:1], 96
s_load_dwordx2 s[92:93], s[0:1], 112
s_getpc_b64 s[58:59]
M_pc:
s_lshr_b32 s22, s2, 3
s_lshl_b32 s22, s22, 5
v_and_b32 v26, 31, v0
v_add_u32 v26, s22, v26
v_lshlrev_b32 v26, 7, v26
v_min_u32 v26, M_end-M_pc, v26
v_mov_b32 v27, s59
v_add_co_u32 v26, vcc, s58, v26
s_nop 1
v_addc_co_u32 v27, vcc, 0, v27, vcc
global_load_dword v21, v[26:27], off
v_lshrrev_b32 v28, 6, v0
v_and_b32 v29, 63, v0
v_lshlrev_b32 v1, 4, v29
v_readfirstlane_b32 s3, v28
s_lshr_b32 s21, s2, 5
v_lshrrev_b32 v26, 7, v1
v_lshrrev_b32 v27, 1, v26
v_lshlrev_b32 v27, 4, v27
v_and_b32 v28, 0x70, v1
v_xor_b32 v27, v27, v28
v_mul_u32_u24 v26, 2048, v26
v_add_u32 v12, v26, v27
v_xor_b32 v27, 64, v27
v_add_u32 v26, v26, v27
v_add_u32 v13, 15360, v26
v_add_u32 v14, 30720, v12
v_add_u32 v15, 46080, v26
s_lshl_b32 s28, s3, 13
s_lshl_b32 s24, s21, 19
s_lshl_b32 s22, s3, 17
s_add_u32 s24, s24, s22
s_add_u32 s25, s24, 65536
s_mov_b32 s10, 4194304
s_mov_b32 s11, 0x20000
s_and_b32 s20, s2, 7
s_lshl_b32 s20, s20, 1
s_bfe_u32 s22, s2, 0x10003
s_add_u32 s20, s20, s22
v_lshrrev_b32 v26, 5, v29
v_and_b32 v27, 31, v29
s_and_b32 s22, s3, 1
s_lshl_b32 s22, s22, 2
v_or_b32 v28, s22, v26
v_lshlrev_b32 v28, 1, v28
v_xor_b32 v27, v27, v28
v_lshlrev_b32 v27, 4, v27
v_lshl_add_u32 v16, v26, 13, v27
v_xor_b32 v26, 64, v16
v_add_u32 v17, 15360, v26
v_add_u32 v18, 30720, v16
v_add_u32 v19, 46080, v26
s_lshl_b32 s29, s3, 12
s_lshl_b32 s26, s3, 16
s_lshl_b32 s22, s20, 9
s_add_u32 s26, s26, s22
s_add_u32 s27, s26, 262144
s_mov_b32 s14, 8388608
s_mov_b32 s15, 0x20000
s_mov_b32 s101, 0x40000
v_and_b32 v30, 15, v29
v_lshrrev_b32 v31, 4, v29
v_lshrrev_b32 v26, 1, v30
v_xor_b32 v26, v31, v26
v_lshlrev_b32 v26, 4, v26
v_lshl_add_u32 v2, v30, 7, v26
s_lshr_b32 s22, s3, 1
s_lshl_b32 s22, s22, 14
v_add_u32 v2, s22, v2
v_xor_b32 v3, 64, v2
v_lshrrev_b32 v26, 2, v30
v_and_b32 v27, 1, v31
v_lshl_or_b32 v27, v27, 2, v26
v_lshl_add_u32 v26, v31, 3, v26
v_lshlrev_b32 v26, 9, v26
v_lshl_add_u32 v26, v27, 5, v26
v_and_b32 v27, 3, v29
v_lshl_add_u32 v26, v27, 3, v26
s_and_b32 s22, s3, 1
s_lshl_b32 s22, s22, 8
s_add_u32 s22, s22, 0x10000
v_xor_b32 v4, s22, v26
v_xor_b32 v5, 32, v4
v_xor_b32 v6, 64, v4
v_xor_b32 v7, 96, v4
v_xor_b32 v8, 128, v4
v_xor_b32 v9, 160, v4
v_xor_b32 v10, 192, v4
v_xor_b32 v11, 224, v4
s_mov_b32 s19, 0x20000
s_cmp_eq_u32 s3, 2
s_cbranch_scc1 M_pf2
s_cmp_lg_u32 s3, 0
s_cbranch_scc1 M_pf3
s_mov_b32 s18, 8388608
s_mov_b32 s51, 8388608
s_mov_b32 s47, 524288
s_mov_b32 s43, 524288
s_lshl_b32 s22, s21, 16
s_lshl_b32 s23, s20, 9
s_add_u32 s22, s22, s23
v_bfe_u32 v26, v29, 2, 3
v_lshl_add_u32 v26, v26, 13, s22
v_and_b32 v27, 3, v29
v_lshl_add_u32 v20, v27, 7, v26
v_lshrrev_b32 v27, 5, v29
v_lshl_add_u32 v22, v27, 19, v20
v_cmp_gt_u32 vcc, 32, v29
s_branch M_pfd
M_pf2:
s_mov_b32 s18, 4194304
s_mov_b32 s51, 2048
s_mov_b32 s47, 256
s_mov_b32 s43, 0
s_lshl_b32 s22, s2, 14
v_bfe_u32 v26, v29, 1, 3
v_lshl_add_u32 v26, v26, 11, s22
v_and_b32 v27, 1, v29
v_lshl_add_u32 v20, v27, 7, v26
v_bfe_u32 v27, v29, 4, 1
v_lshl_add_u32 v22, v27, 8, v20
v_cmp_gt_u32 vcc, 16, v29
s_branch M_pfd
M_pf3:
s_mov_b32 s18, 0
s_mov_b32 s51, 3112960
s_mov_b32 s47, 622592
s_mov_b32 s43, 0
s_mul_i32 s22, s2, 2432
v_lshl_add_u32 v20, v29, 7, s22
v_mov_b32 v22, v20
v_cmp_gt_u32 vcc, 19, v29
M_pfd:
v_mov_b32 v26, 3221225472
s_nop 0
v_cndmask_b32 v20, v26, v20, vcc
s_bitcmp1_b32 s2, 4
s_waitcnt lgkmcnt(0)
s_mov_b64 s[8:9], s[78:79]
s_cselect_b64 s[12:13], s[84:85], s[82:83]
s_add_u32 m0, s28, 0
s_nop 0
buffer_load_dwordx4 v12, s[8:11], s24 offen offset:0 lds
buffer_load_dwordx4 v13, s[8:11], s24 offen offset:1024 lds
buffer_load_dwordx4 v14, s[8:11], s24 offen offset:2048 lds
buffer_load_dwordx4 v15, s[8:11], s24 offen offset:3072 lds
s_add_u32 s24, s24, 128
s_add_u32 m0, s28, 4096
s_nop 0
buffer_load_dwordx4 v12, s[8:11], s25 offen offset:0 lds
buffer_load_dwordx4 v13, s[8:11], s25 offen offset:1024 lds
buffer_load_dwordx4 v14, s[8:11], s25 offen offset:2048 lds
buffer_load_dwordx4 v15, s[8:11], s25 offen offset:3072 lds
s_add_u32 s25, s25, 128
s_add_u32 m0, s29, 65536
s_nop 0
buffer_load_dwordx4 v16, s[12:15], s26 offen offset:0 lds
buffer_load_dwordx4 v17, s[12:15], s26 offen offset:1024 lds
buffer_load_dwordx4 v18, s[12:15], s26 offen offset:2048 lds
buffer_load_dwordx4 v19, s[12:15], s26 offen offset:3072 lds
s_add_u32 s26, s26, 524288
s_add_u32 m0, s29, 81920
s_nop 0
buffer_load_dwordx4 v16, s[12:15], s27 offen offset:0 lds
buffer_load_dwordx4 v17, s[12:15], s27 offen offset:1024 lds
buffer_load_dwordx4 v18, s[12:15], s27 offen offset:2048 lds
buffer_load_dwordx4 v19, s[12:15], s27 offen offset:3072 lds
s_add_u32 s27, s27, 524288
s_mov_b64 exec, 0
s_bfe_u32 s22, s2, 0x10004
s_lshl_b32 s22, s22, 2
s_add_u32 s22, s22, s3
s_cmp_lg_u32 s22, 0
s_cbranch_scc1 M_tw1
s_call_b64 s[98:99], PAD_0
s_call_b64 s[98:99], PAD_8
s_branch M_td
M_tw1:
s_cmp_lg_u32 s22, 1
s_cbranch_scc1 M_tw2
s_call_b64 s[98:99], PAD_1
s_call_b64 s[98:99], PAD_9
s_branch M_td
M_tw2:
s_cmp_lg_u32 s22, 2
s_cbranch_scc1 M_tw3
s_call_b64 s[98:99], PAD_2
s_call_b64 s[98:99], PAD_6
s_call_b64 s[98:99], PAD_10
s_branch M_td
M_tw3:
s_cmp_lg_u32 s22, 3
s_cbranch_scc1 M_tw4
s_call_b64 s[98:99], PAD_3
s_call_b64 s[98:99], PAD_7
s_call_b64 s[98:99], PAD_11
s_branch M_td
M_tw4:
s_cmp_lg_u32 s22, 4
s_cbranch_scc1 M_tw5
s_call_b64 s[98:99], PAD_22
s_branch M_td
M_tw5:
s_cmp_lg_u32 s22, 5
s_cbranch_scc1 M_tw6
s_call_b64 s[98:99], PAD_23
s_branch M_td
M_tw6:
s_cmp_lg_u32 s22, 6
s_cbranch_scc1 M_tw7
s_call_b64 s[98:99], PAD_24
s_branch M_td
M_tw7:
s_call_b64 s[98:99], PAD_21
M_td:
s_mov_b64 exec, -1
s_add_u32 m0, s28, 32768
s_nop 0
buffer_load_dwordx4 v12, s[8:11], s24 offen offset:0 lds
buffer_load_dwordx4 v13, s[8:11], s24 offen offset:1024 lds
buffer_load_dwordx4 v14, s[8:11], s24 offen offset:2048 lds
buffer_load_dwordx4 v15, s[8:11], s24 offen offset:3072 lds
s_add_u32 s24, s24, 128
s_add_u32 m0, s28, 36864
s_nop 0
buffer_load_dwordx4 v12, s[8:11], s25 offen offset:0 lds
buffer_load_dwordx4 v13, s[8:11], s25 offen offset:1024 lds
buffer_load_dwordx4 v14, s[8:11], s25 offen offset:2048 lds
buffer_load_dwordx4 v15, s[8:11], s25 offen offset:3072 lds
s_add_u32 s25, s25, 128
s_cmp_eq_u32 s3, 0
s_cselect_b64 s[16:17], s[12:13], s[8:9]
buffer_load_dword v21, v22, s[16:19], s43 offen
s_add_u32 s43, s43, s47
s_add_u32 s43, s43, s47
s_mov_b32 s4, s92
s_mov_b32 s5, s93
s_mov_b32 s6, 268435456
s_mov_b32 s7, 0x20000
s_cmp_eq_u32 s3, 3
s_cselect_b64 s[40:41], s[76:77], s[80:81]
s_cselect_b32 s42, 1835008, 0
s_cmp_eq_u32 s3, 1
s_cselect_b32 s42, 3670016, s42
s_cmp_eq_u32 s3, 3
s_cselect_b64 s[44:45], s[86:87], s[72:73]
s_cselect_b32 s46, 3670016, 0
s_cmp_eq_u32 s3, 1
s_cselect_b32 s46, 1835008, s46
s_cmp_eq_u32 s3, 2
s_cselect_b64 s[40:41], s[64:65], s[40:41]
s_cselect_b32 s42, 1835008, s42
s_waitcnt vmcnt(9)
s_barrier
ds_read_b64_tr_b16 a[128:129], v4 offset:0
ds_read_b64_tr_b16 a[130:131], v4 offset:2048
ds_read_b64_tr_b16 a[132:133], v4 offset:16384
ds_read_b64_tr_b16 a[134:135], v4 offset:18432
ds_read_b128 a[0:3], v2 offset:0
ds_read_b128 a[4:7], v3 offset:0
ds_read_b128 a[8:11], v2 offset:2048
ds_read_b128 a[12:15], v3 offset:2048
ds_read_b128 a[16:19], v2 offset:4096
ds_read_b128 a[20:23], v3 offset:4096
ds_read_b128 a[24:27], v2 offset:6144
ds_read_b128 a[28:31], v3 offset:6144
ds_read_b128 a[32:35], v2 offset:8192
ds_read_b128 a[36:39], v3 offset:8192
ds_read_b128 a[40:43], v2 offset:10240
ds_read_b128 a[44:47], v3 offset:10240
ds_read_b128 a[48:51], v2 offset:12288
ds_read_b128 a[52:55], v3 offset:12288
ds_read_b128 a[56:59], v2 offset:14336
ds_read_b128 a[60:63], v3 offset:14336
s_add_u32 m0, s29, 98304
s_nop 0
buffer_load_dwordx4 v16, s[12:15], s26 offen offset:0 lds
buffer_load_dwordx4 v17, s[12:15], s26 offen offset:1024 lds
buffer_load_dwordx4 v18, s[12:15], s26 offen offset:2048 lds
buffer_load_dwordx4 v19, s[12:15], s26 offen offset:3072 lds
s_add_u32 s26, s26, 524288
s_waitcnt lgkmcnt(0)
s_barrier
s_bitcmp1_b32 s2, 4
s_cbranch_scc1 M_V
s_branch M_K
M_t2B:
s_mov_b64 exec, 0
s_cmp_lg_u32 s3, 0
s_cbranch_scc1 M_uw1
s_call_b64 s[98:99], PAD_32
s_call_b64 s[98:99], PAD_16
s_branch M_ud
M_uw1:
s_cmp_lg_u32 s3, 1
s_cbranch_scc1 M_uw2
s_call_b64 s[98:99], PAD_9
s_call_b64 s[98:99], PAD_33
s_call_b64 s[98:99], PAD_13
s_branch M_ud
M_uw2:
s_cmp_lg_u32 s3, 2
s_cbranch_scc1 M_uw3
s_call_b64 s[98:99], PAD_10
s_call_b64 s[98:99], PAD_34
s_call_b64 s[98:99], PAD_14
s_branch M_ud
M_uw3:
s_call_b64 s[98:99], PAD_11
s_call_b64 s[98:99], PAD_15
M_ud:
s_mov_b64 exec, -1
s_branch M_t2Br
M_t2A:
s_mov_b64 exec, 0
s_lshl_b32 s22, s24, 2
s_add_u32 s22, s22, s3
s_cmp_lg_u32 s22, 0
s_cbranch_scc1 M_vw1
s_call_b64 s[98:99], PAD_32
s_call_b64 s[98:99], PAD_16
s_branch M_vd
M_vw1:
s_cmp_lg_u32 s22, 1
s_cbranch_scc1 M_vw2
s_call_b64 s[98:99], PAD_13
s_branch M_vd
M_vw2:
s_cmp_lg_u32 s22, 2
s_cbranch_scc1 M_vw3
s_call_b64 s[98:99], PAD_14
s_call_b64 s[98:99], PAD_19
s_branch M_vd
M_vw3:
s_cmp_lg_u32 s22, 3
s_cbranch_scc1 M_vw4
s_call_b64 s[98:99], PAD_15
s_call_b64 s[98:99], PAD_20
s_branch M_vd
M_vw4:
s_cmp_lg_u32 s22, 4
s_cbranch_scc1 M_vw5
s_call_b64 s[98:99], PAD_12
s_call_b64 s[98:99], PAD_16
s_branch M_vd
M_vw5:
s_cmp_lg_u32 s22, 5
s_cbranch_scc1 M_vw6
s_call_b64 s[98:99], PAD_13
s_branch M_vd
M_vw6:
s_cmp_lg_u32 s22, 6
s_cbranch_scc1 M_vw7
s_call_b64 s[98:99], PAD_14
s_branch M_vd
M_vw7:
s_call_b64 s[98:99], PAD_15
M_vd:
s_mov_b64 exec, -1
s_branch M_t2Ar
M_tret:
s_setpc_b64 s[98:99]
.p2align 12
PAD_0:
s_cbranch_execz PAD_4
M_K:
v_mfma_f32_16x16x32_bf16 v[32:35], a[128:131], a[0:3], 0
s_add_u32 m0, s29, 114688
ds_read_b64_tr_b16 a[136:137], v5 offset:0
v_mfma_f32_16x16x32_bf16 v[32:35], a[132:135], a[4:7], v[32:35]
s_mov_b32 s32, 8192
buffer_load_dwordx4 v16, s[12:15], s27 offen offset:0 lds
v_mfma_f32_16x16x32_bf16 v[40:43], a[128:131], a[8:11], 0
s_mov_b32 s33, 8192
ds_read_b64_tr_b16 a[138:139], v5 offset:2048
v_mfma_f32_16x16x32_bf16 v[40:43], a[132:135], a[12:15], v[40:43]
s_mov_b32 s34, 8192
v_mfma_f32_16x16x32_bf16 v[48:51], a[128:131], a[16:19], 0
s_mov_b32 s35, 4294910976
ds_read_b64_tr_b16 a[140:141], v5 offset:16384
v_mfma_f32_16x16x32_bf16 v[48:51], a[132:135], a[20:23], v[48:51]
s_mov_b32 s36, 4294910976
buffer_load_dwordx4 v17, s[12:15], s27 offen offset:1024 lds
v_mfma_f32_16x16x32_bf16 v[56:59], a[128:131], a[24:27], 0
s_mov_b32 s30, 8
ds_read_b64_tr_b16 a[142:143], v5 offset:18432
v_mfma_f32_16x16x32_bf16 v[56:59], a[132:135], a[28:31], v[56:59]
s_mov_b32 s82, 3221225472
v_mfma_f32_16x16x32_bf16 v[64:67], a[128:131], a[32:35], 0
s_mul_hi_u32 s38, s2, 613566757
v_mfma_f32_16x16x32_bf16 v[64:67], a[132:135], a[36:39], v[64:67]
s_mul_i32 s39, s38, 7
buffer_load_dwordx4 v18, s[12:15], s27 offen offset:2048 lds
v_mfma_f32_16x16x32_bf16 v[72:75], a[128:131], a[40:43], 0
s_sub_u32 s39, s2, s39
v_mov_b32 v246, 0
v_mov_b32 v229, 0
v_mfma_f32_16x16x32_bf16 v[72:75], a[132:135], a[44:47], v[72:75]
v_mov_b32 v231, 0
v_mfma_f32_16x16x32_bf16 v[80:83], a[128:131], a[48:51], 0
s_mov_b32 s60, s90
v_mfma_f32_16x16x32_bf16 v[80:83], a[132:135], a[52:55], v[80:83]
s_mov_b32 s61, s91
buffer_load_dwordx4 v19, s[12:15], s27 offen offset:3072 lds
v_mfma_f32_16x16x32_bf16 v[88:91], a[128:131], a[56:59], 0
s_add_u32 s27, s27, 524288
v_mfma_f32_16x16x32_bf16 v[88:91], a[132:135], a[60:63], v[88:91]
s_waitcnt lgkmcnt(0)
s_mov_b32 s62, 256
v_mfma_f32_16x16x32_bf16 v[36:39], a[136:139], a[0:3], 0
s_add_u32 m0, s28, 0
ds_read_b64_tr_b16 a[128:129], v6 offset:0
v_mfma_f32_16x16x32_bf16 v[36:39], a[140:143], a[4:7], v[36:39]
s_mov_b32 s63, 0x20000
buffer_load_dwordx4 v12, s[8:11], s24 offen offset:0 lds
v_mfma_f32_16x16x32_bf16 v[44:47], a[136:139], a[8:11], 0
s_mul_hi_u32 s55, s2, 1431655766
ds_read_b64_tr_b16 a[130:131], v6 offset:2048
v_mfma_f32_16x16x32_bf16 v[44:47], a[140:143], a[12:15], v[44:47]
s_mul_i32 s55, s55, 3
v_mfma_f32_16x16x32_bf16 v[52:55], a[136:139], a[16:19], 0
s_sub_u32 s55, s2, s55
ds_read_b64_tr_b16 a[132:133], v6 offset:16384
v_mfma_f32_16x16x32_bf16 v[52:55], a[140:143], a[20:23], v[52:55]
s_add_u32 s55, s55, 5
buffer_load_dwordx4 v13, s[8:11], s24 offen offset:1024 lds
v_mfma_f32_16x16x32_bf16 v[60:63], a[136:139], a[24:27], 0
s_lshr_b32 s22, s2, 4
ds_read_b64_tr_b16 a[134:135], v6 offset:18432
v_mfma_f32_16x16x32_bf16 v[60:63], a[140:143], a[28:31], v[60:63]
s_lshl_b32 s23, s20, 5
v_mfma_f32_16x16x32_bf16 v[68:71], a[136:139], a[32:35], 0
s_add_u32 s23, s23, s22
v_mfma_f32_16x16x32_bf16 v[68:71], a[140:143], a[36:39], v[68:71]
s_lshl_b32 s23, s23, 2
buffer_load_dwordx4 v14, s[8:11], s24 offen offset:2048 lds
v_mfma_f32_16x16x32_bf16 v[76:79], a[136:139], a[40:43], 0
s_and_b32 s22, s2, 16
v_mfma_f32_16x16x32_bf16 v[76:79], a[140:143], a[44:47], v[76:79]
s_lshl_b32 s22, s22, 7
v_mfma_f32_16x16x32_bf16 v[84:87], a[136:139], a[48:51], 0
s_add_u32 s23, s23, s22
v_mov_b32 v28, 3221225472
v_writelane_b32 v28, s23, 0
v_mfma_f32_16x16x32_bf16 v[84:87], a[140:143], a[52:55], v[84:87]
s_add_u32 s56, s23, 16384
buffer_load_dwordx4 v15, s[8:11], s24 offen offset:3072 lds
v_mfma_f32_16x16x32_bf16 v[92:95], a[136:139], a[56:59], 0
s_add_u32 s24, s24, 128
v_writelane_b32 v28, s56, 1
v_mfma_f32_16x16x32_bf16 v[92:95], a[140:143], a[60:63], v[92:95]
s_waitcnt lgkmcnt(0)
s_add_u32 s56, s23, 4096
v_writelane_b32 v28, s56, 2
v_mfma_f32_16x16x32_bf16 v[96:99], a[128:131], a[0:3], 0
s_add_u32 m0, s28, 4096
ds_read_b64_tr_b16 a[136:137], v7 offset:0
v_mfma_f32_16x16x32_bf16 v[96:99], a[132:135], a[4:7], v[96:99]
s_sub_u32 s37, 15, s21
buffer_load_dwordx4 v12, s[8:11], s25 offen offset:0 lds
v_mfma_f32_16x16x32_bf16 v[104:107], a[128:131], a[8:11], 0
ds_read_b64_tr_b16 a[138:139], v7 offset:2048
v_mfma_f32_16x16x32_bf16 v[104:107], a[132:135], a[12:15], v[104:107]
v_mfma_f32_16x16x32_bf16 v[112:115], a[128:131], a[16:19], 0
ds_read_b64_tr_b16 a[140:141], v7 offset:16384
v_mfma_f32_16x16x32_bf16 v[112:115], a[132:135], a[20:23], v[112:115]
buffer_load_dwordx4 v13, s[8:11], s25 offen offset:1024 lds
v_mfma_f32_16x16x32_bf16 v[120:123], a[128:131], a[24:27], 0
ds_read_b64_tr_b16 a[142:143], v7 offset:18432
v_mfma_f32_16x16x32_bf16 v[120:123], a[132:135], a[28:31], v[120:123]
v_mfma_f32_16x16x32_bf16 v[128:131], a[128:131], a[32:35], 0
v_mfma_f32_16x16x32_bf16 v[128:131], a[132:135], a[36:39], v[128:131]
buffer_load_dwordx4 v14, s[8:11], s25 offen offset:2048 lds
v_mfma_f32_16x16x32_bf16 v[136:139], a[128:131], a[40:43], 0
v_mfma_f32_16x16x32_bf16 v[136:139], a[132:135], a[44:47], v[136:139]
v_mfma_f32_16x16x32_bf16 v[144:147], a[128:131], a[48:51], 0
v_mfma_f32_16x16x32_bf16 v[144:147], a[132:135], a[52:55], v[144:147]
buffer_load_dwordx4 v15, s[8:11], s25 offen offset:3072 lds
v_mfma_f32_16x16x32_bf16 v[152:155], a[128:131], a[56:59], 0
s_add_u32 s25, s25, 128
v_mfma_f32_16x16x32_bf16 v[152:155], a[132:135], a[60:63], v[152:155]
s_waitcnt vmcnt(17) lgkmcnt(0)
s_barrier
v_mfma_f32_16x16x32_bf16 v[100:103], a[136:139], a[0:3], 0
ds_read_b64_tr_b16 a[128:129], v8 offset:0
v_mfma_f32_16x16x32_bf16 v[100:103], a[140:143], a[4:7], v[100:103]
buffer_load_dword v21, v20, s[16:19], s43 offen
v_mfma_f32_16x16x32_bf16 v[108:111], a[136:139], a[8:11], 0
s_add_u32 s43, s43, s47
ds_read_b64_tr_b16 a[130:131], v8 offset:2048
v_mfma_f32_16x16x32_bf16 v[108:111], a[140:143], a[12:15], v[108:111]
s_cmp_ge_u32 s43, s51
v_mfma_f32_16x16x32_bf16 v[116:119], a[136:139], a[16:19], 0
s_cselect_b32 s43, 0, s43
ds_read_b64_tr_b16 a[132:133], v8 offset:16384
v_mfma_f32_16x16x32_bf16 v[116:119], a[140:143], a[20:23], v[116:119]
s_cselect_b32 s51, s42, s51
v_mfma_f32_16x16x32_bf16 v[124:127], a[136:139], a[24:27], 0
s_cselect_b64 s[16:17], s[40:41], s[16:17]
ds_read_b64_tr_b16 a[134:135], v8 offset:18432
v_mfma_f32_16x16x32_bf16 v[124:127], a[140:143], a[28:31], v[124:127]
s_cselect_b32 s18, s42, s18
v_mfma_f32_16x16x32_bf16 v[132:135], a[136:139], a[32:35], 0
s_cselect_b64 s[40:41], s[44:45], s[40:41]
ds_read_b128 a[64:67], v2 offset:32768
v_mfma_f32_16x16x32_bf16 v[132:135], a[140:143], a[36:39], v[132:135]
s_cselect_b32 s42, s46, s42
v_mfma_f32_16x16x32_bf16 v[140:143], a[136:139], a[40:43], 0
s_cselect_b32 s46, 0, s46
ds_read_b128 a[68:71], v3 offset:32768
v_mfma_f32_16x16x32_bf16 v[140:143], a[140:143], a[44:47], v[140:143]
ds_read_b128 a[72:75], v2 offset:34816
v_mfma_f32_16x16x32_bf16 v[148:151], a[136:139], a[48:51], 0
ds_read_b128 a[76:79], v3 offset:34816
v_mfma_f32_16x16x32_bf16 v[148:151], a[140:143], a[52:55], v[148:151]
buffer_load_dword v21, v20, s[16:19], s43 offen
v_mfma_f32_16x16x32_bf16 v[156:159], a[136:139], a[56:59], 0
s_add_u32 s43, s43, s47
ds_read_b128 a[80:83], v2 offset:36864
v_mfma_f32_16x16x32_bf16 v[156:159], a[140:143], a[60:63], v[156:159]
s_waitcnt lgkmcnt(5)
s_cmp_ge_u32 s43, s51
ds_read_b128 a[84:87], v3 offset:36864
v_mfma_f32_16x16x32_bf16 v[160:163], a[128:131], a[0:3], 0
s_cselect_b32 s43, 0, s43
ds_read_b64_tr_b16 a[136:137], v9 offset:0
v_mfma_f32_16x16x32_bf16 v[160:163], a[132:135], a[4:7], v[160:163]
s_cselect_b32 s51, s42, s51
v_mfma_f32_16x16x32_bf16 v[168:171], a[128:131], a[8:11], 0
s_cselect_b64 s[16:17], s[40:41], s[16:17]
ds_read_b64_tr_b16 a[138:139], v9 offset:2048
v_mfma_f32_16x16x32_bf16 v[168:171], a[132:135], a[12:15], v[168:171]
s_cselect_b32 s18, s42, s18
v_mfma_f32_16x16x32_bf16 v[176:179], a[128:131], a[16:19], 0
s_cselect_b64 s[40:41], s[44:45], s[40:41]
ds_read_b64_tr_b16 a[140:141], v9 offset:16384
v_mfma_f32_16x16x32_bf16 v[176:179], a[132:135], a[20:23], v[176:179]
s_cselect_b32 s42, s46, s42
v_mfma_f32_16x16x32_bf16 v[184:187], a[128:131], a[24:27], 0
s_cselect_b32 s46, 0, s46
ds_read_b64_tr_b16 a[142:143], v9 offset:18432
v_mfma_f32_16x16x32_bf16 v[184:187], a[132:135], a[28:31], v[184:187]
s_bitcmp1_b32 s2, 4
s_cselect_b32 s37, s21, s37
s_lshl_b32 s56, s37, 5
v_mfma_f32_16x16x32_bf16 v[192:195], a[128:131], a[32:35], 0
s_add_u32 s56, s56, s20
s_lshl_b32 s56, s56, 2
s_add_u32 s56, s56, 8192
v_mfma_f32_16x16x32_bf16 v[192:195], a[132:135], a[36:39], v[192:195]
v_writelane_b32 v28, s56, 3
v_mfma_f32_16x16x32_bf16 v[200:203], a[128:131], a[40:43], 0
s_add_u32 s56, s56, 2048
ds_read_b128 a[88:91], v2 offset:38912
v_writelane_b32 v28, s56, 6
v_mfma_f32_16x16x32_bf16 v[200:203], a[132:135], a[44:47], v[200:203]
s_lshl_b32 s56, s2, 2
s_add_u32 s56, s56, 12288
ds_read_b128 a[92:95], v3 offset:38912
v_mfma_f32_16x16x32_bf16 v[208:211], a[128:131], a[48:51], 0
s_waitcnt lgkmcnt(2)
ds_read_b128 a[96:99], v2 offset:40960
v_writelane_b32 v28, s56, 4
v_mfma_f32_16x16x32_bf16 v[208:211], a[132:135], a[52:55], v[208:211]
s_lshl_b32 s56, s39, 5
s_add_u32 s56, s56, s38
s_lshl_b32 s56, s56, 2
v_mfma_f32_16x16x32_bf16 v[216:219], a[128:131], a[56:59], 0
s_add_u32 s56, s56, 20480
s_cmp_lt_u32 s2, 224
ds_read_b128 a[100:103], v3 offset:40960
v_mfma_f32_16x16x32_bf16 v[216:219], a[132:135], a[60:63], v[216:219]
s_cselect_b32 s56, s56, 3221225472
ds_read_b128 a[104:107], v2 offset:43008
v_writelane_b32 v28, s56, 7
v_mfma_f32_16x16x32_bf16 v[164:167], a[136:139], a[0:3], 0
s_cmp_eq_u32 s3, 0
s_cselect_b32 s56, 94371840, 3221225472
ds_read_b64_tr_b16 a[128:129], v10 offset:0
v_mfma_f32_16x16x32_bf16 v[164:167], a[140:143], a[4:7], v[164:167]
buffer_store_dword v246, v28, s[4:7], s56 offen sc1
v_mfma_f32_16x16x32_bf16 v[172:175], a[136:139], a[8:11], 0
ds_read_b64_tr_b16 a[130:131], v10 offset:2048
v_mov_b32 v27, 1
v_mfma_f32_16x16x32_bf16 v[172:175], a[140:143], a[12:15], v[172:175]
v_cmp_eq_u32 vcc, 0, v0
v_mov_b32 v26, 3221225472
v_mfma_f32_16x16x32_bf16 v[180:183], a[136:139], a[16:19], 0
s_lshl_b32 s31, s20, 20
s_lshl_b32 s22, s21, 17
ds_read_b64_tr_b16 a[132:133], v10 offset:16384
v_mfma_f32_16x16x32_bf16 v[180:183], a[140:143], a[20:23], v[180:183]
v_cndmask_b32 v26, v26, v246, vcc
v_mfma_f32_16x16x32_bf16 v[188:191], a[136:139], a[24:27], 0
s_add_u32 s31, s31, s22
s_lshr_b32 s22, s3, 1
ds_read_b64_tr_b16 a[134:135], v10 offset:18432
v_mfma_f32_16x16x32_bf16 v[188:191], a[140:143], a[28:31], v[188:191]
s_lshl_b32 s22, s22, 16
s_add_u32 s31, s31, s22
s_and_b32 s22, s3, 1
v_mfma_f32_16x16x32_bf16 v[196:199], a[136:139], a[32:35], 0
s_lshl_b32 s22, s22, 12
s_add_u32 s31, s31, s22
v_mfma_f32_16x16x32_bf16 v[196:199], a[140:143], a[36:39], v[196:199]
v_mfma_f32_16x16x32_bf16 v[204:207], a[136:139], a[40:43], 0
ds_read_b128 a[108:111], v3 offset:43008
v_mfma_f32_16x16x32_bf16 v[204:207], a[140:143], a[44:47], v[204:207]
ds_read_b128 a[112:115], v2 offset:45056
v_mfma_f32_16x16x32_bf16 v[212:215], a[136:139], a[48:51], 0
ds_read_b128 a[116:119], v3 offset:45056
v_mfma_f32_16x16x32_bf16 v[212:215], a[140:143], a[52:55], v[212:215]
v_mfma_f32_16x16x32_bf16 v[220:223], a[136:139], a[56:59], 0
ds_read_b128 a[120:123], v2 offset:47104
v_mfma_f32_16x16x32_bf16 v[220:223], a[140:143], a[60:63], v[220:223]
s_waitcnt lgkmcnt(4)
ds_read_b128 a[124:127], v3 offset:47104
v_mfma_f32_16x16x32_bf16 a[192:195], a[128:131], a[0:3], 0
ds_read_b64_tr_b16 a[136:137], v11 offset:0
v_mfma_f32_16x16x32_bf16 a[192:195], a[132:135], a[4:7], a[192:195]
v_mfma_f32_16x16x32_bf16 a[200:203], a[128:131], a[8:11], 0
ds_read_b64_tr_b16 a[138:139], v11 offset:2048
v_mfma_f32_16x16x32_bf16 a[200:203], a[132:135], a[12:15], a[200:203]
v_mfma_f32_16x16x32_bf16 a[208:211], a[128:131], a[16:19], 0
ds_read_b64_tr_b16 a[140:141], v11 offset:16384
v_mfma_f32_16x16x32_bf16 a[208:211], a[132:135], a[20:23], a[208:211]
v_mfma_f32_16x16x32_bf16 a[216:219], a[128:131], a[24:27], 0
ds_read_b64_tr_b16 a[142:143], v11 offset:18432
v_mfma_f32_16x16x32_bf16 a[216:219], a[132:135], a[28:31], a[216:219]
v_mfma_f32_16x16x32_bf16 a[224:227], a[128:131], a[32:35], 0
v_mfma_f32_16x16x32_bf16 a[224:227], a[132:135], a[36:39], a[224:227]
v_mfma_f32_16x16x32_bf16 a[232:235], a[128:131], a[40:43], 0
v_mfma_f32_16x16x32_bf16 a[232:235], a[132:135], a[44:47], a[232:235]
v_mfma_f32_16x16x32_bf16 a[240:243], a[128:131], a[48:51], 0
v_mfma_f32_16x16x32_bf16 a[240:243], a[132:135], a[52:55], a[240:243]
v_mfma_f32_16x16x32_bf16 a[248:251], a[128:131], a[56:59], 0
s_waitcnt vmcnt(3) lgkmcnt(0)
v_mfma_f32_16x16x32_bf16 a[248:251], a[132:135], a[60:63], a[248:251]
s_barrier
v_mfma_f32_16x16x32_bf16 a[196:199], a[136:139], a[0:3], 0
s_add_u32 m0, s29, 65536
ds_read_b64_tr_b16 a[128:129], v4 offset:32768
v_mfma_f32_16x16x32_bf16 a[196:199], a[140:143], a[4:7], a[196:199]
buffer_load_dwordx4 v16, s[12:15], s26 offen offset:0 lds
v_mfma_f32_16x16x32_bf16 a[204:207], a[136:139], a[8:11], 0
ds_read_b64_tr_b16 a[130:131], v4 offset:34816
v_mfma_f32_16x16x32_bf16 a[204:207], a[140:143], a[12:15], a[204:207]
v_mfma_f32_16x16x32_bf16 a[212:215], a[136:139], a[16:19], 0
ds_read_b64_tr_b16 a[132:133], v4 offset:49152
v_mfma_f32_16x16x32_bf16 a[212:215], a[140:143], a[20:23], a[212:215]
buffer_load_dwordx4 v17, s[12:15], s26 offen offset:1024 lds
v_mfma_f32_16x16x32_bf16 a[220:223], a[136:139], a[24:27], 0
ds_read_b64_tr_b16 a[134:135], v4 offset:51200
v_mfma_f32_16x16x32_bf16 a[220:223], a[140:143], a[28:31], a[220:223]
v_mfma_f32_16x16x32_bf16 a[228:231], a[136:139], a[32:35], 0
v_mfma_f32_16x16x32_bf16 a[228:231], a[140:143], a[36:39], a[228:231]
buffer_load_dwordx4 v18, s[12:15], s26 offen offset:2048 lds
v_mfma_f32_16x16x32_bf16 a[236:239], a[136:139], a[40:43], 0
v_mfma_f32_16x16x32_bf16 a[236:239], a[140:143], a[44:47], a[236:239]
v_mfma_f32_16x16x32_bf16 a[244:247], a[136:139], a[48:51], 0
v_mfma_f32_16x16x32_bf16 a[244:247], a[140:143], a[52:55], a[244:247]
buffer_load_dwordx4 v19, s[12:15], s26 offen offset:3072 lds
v_mfma_f32_16x16x32_bf16 a[252:255], a[136:139], a[56:59], 0
s_add_u32 s26, s26, 524288
v_mfma_f32_16x16x32_bf16 a[252:255], a[140:143], a[60:63], a[252:255]
s_waitcnt lgkmcnt(0)
Lg_1:
v_mfma_f32_16x16x32_bf16 v[32:35], a[128:131], a[64:67], v[32:35]
s_add_u32 m0, s29, 81920
ds_read_b64_tr_b16 a[136:137], v5 offset:32768
v_mfma_f32_16x16x32_bf16 v[32:35], a[132:135], a[68:71], v[32:35]
buffer_load_dwordx4 v16, s[12:15], s27 offen offset:0 lds
v_mfma_f32_16x16x32_bf16 v[40:43], a[128:131], a[72:75], v[40:43]
ds_read_b64_tr_b16 a[138:139], v5 offset:34816
v_mfma_f32_16x16x32_bf16 v[40:43], a[132:135], a[76:79], v[40:43]
v_mfma_f32_16x16x32_bf16 v[48:51], a[128:131], a[80:83], v[48:51]
ds_read_b64_tr_b16 a[140:141], v5 offset:49152
v_mfma_f32_16x16x32_bf16 v[48:51], a[132:135], a[84:87], v[48:51]
buffer_load_dwordx4 v17, s[12:15], s27 offen offset:1024 lds
v_mfma_f32_16x16x32_bf16 v[56:59], a[128:131], a[88:91], v[56:59]
ds_read_b64_tr_b16 a[142:143], v5 offset:51200
v_mfma_f32_16x16x32_bf16 v[56:59], a[132:135], a[92:95], v[56:59]
v_mfma_f32_16x16x32_bf16 v[64:67], a[128:131], a[96:99], v[64:67]
ds_read_b128 a[0:3], v2 offset:0
v_mfma_f32_16x16x32_bf16 v[64:67], a[132:135], a[100:103], v[64:67]
buffer_load_dwordx4 v18, s[12:15], s27 offen offset:2048 lds
v_mfma_f32_16x16x32_bf16 v[72:75], a[128:131], a[104:107], v[72:75]
ds_read_b128 a[4:7], v3 offset:0
v_mfma_f32_16x16x32_bf16 v[72:75], a[132:135], a[108:111], v[72:75]
v_mfma_f32_16x16x32_bf16 v[80:83], a[128:131], a[112:115], v[80:83]
v_mfma_f32_16x16x32_bf16 v[80:83], a[132:135], a[116:119], v[80:83]
buffer_load_dwordx4 v19, s[12:15], s27 offen offset:3072 lds
v_mfma_f32_16x16x32_bf16 v[88:91], a[128:131], a[120:123], v[88:91]
s_add_u32 s27, s27, 524288
ds_read_b128 a[8:11], v2 offset:2048
v_mfma_f32_16x16x32_bf16 v[88:91], a[132:135], a[124:127], v[88:91]
s_waitcnt lgkmcnt(3)
v_mfma_f32_16x16x32_bf16 v[36:39], a[136:139], a[64:67], v[36:39]
s_add_u32 m0, s28, 32768
ds_read_b64_tr_b16 a[128:129], v6 offset:32768
v_mfma_f32_16x16x32_bf16 v[36:39], a[140:143], a[68:71], v[36:39]
buffer_load_dwordx4 v12, s[8:11], s24 offen offset:0 lds
v_mfma_f32_16x16x32_bf16 v[44:47], a[136:139], a[72:75], v[44:47]
ds_read_b64_tr_b16 a[130:131], v6 offset:34816
v_mfma_f32_16x16x32_bf16 v[44:47], a[140:143], a[76:79], v[44:47]
v_mfma_f32_16x16x32_bf16 v[52:55], a[136:139], a[80:83], v[52:55]
ds_read_b64_tr_b16 a[132:133], v6 offset:49152
v_mfma_f32_16x16x32_bf16 v[52:55], a[140:143], a[84:87], v[52:55]
buffer_load_dwordx4 v13, s[8:11], s24 offen offset:1024 lds
v_mfma_f32_16x16x32_bf16 v[60:63], a[136:139], a[88:91], v[60:63]
ds_read_b64_tr_b16 a[134:135], v6 offset:51200
v_mfma_f32_16x16x32_bf16 v[60:63], a[140:143], a[92:95], v[60:63]
v_mfma_f32_16x16x32_bf16 v[68:71], a[136:139], a[96:99], v[68:71]
ds_read_b128 a[12:15], v3 offset:2048
v_mfma_f32_16x16x32_bf16 v[68:71], a[140:143], a[100:103], v[68:71]
buffer_load_dwordx4 v14, s[8:11], s24 offen offset:2048 lds
v_mfma_f32_16x16x32_bf16 v[76:79], a[136:139], a[104:107], v[76:79]
v_mfma_f32_16x16x32_bf16 v[76:79], a[140:143], a[108:111], v[76:79]
v_mfma_f32_16x16x32_bf16 v[84:87], a[136:139], a[112:115], v[84:87]
ds_read_b128 a[16:19], v2 offset:4096
v_mfma_f32_16x16x32_bf16 v[84:87], a[140:143], a[116:119], v[84:87]
buffer_load_dwordx4 v15, s[8:11], s24 offen offset:3072 lds
v_mfma_f32_16x16x32_bf16 v[92:95], a[136:139], a[120:123], v[92:95]
s_add_u32 s24, s24, 128
ds_read_b128 a[20:23], v3 offset:4096
v_mfma_f32_16x16x32_bf16 v[92:95], a[140:143], a[124:127], v[92:95]
s_waitcnt lgkmcnt(3)
v_mfma_f32_16x16x32_bf16 v[96:99], a[128:131], a[64:67], v[96:99]
s_add_u32 m0, s28, 36864
ds_read_b64_tr_b16 a[136:137], v7 offset:32768
v_mfma_f32_16x16x32_bf16 v[96:99], a[132:135], a[68:71], v[96:99]
buffer_load_dwordx4 v12, s[8:11], s25 offen offset:0 lds
v_mfma_f32_16x16x32_bf16 v[104:107], a[128:131], a[72:75], v[104:107]
ds_read_b64_tr_b16 a[138:139], v7 offset:34816
v_mfma_f32_16x16x32_bf16 v[104:107], a[132:135], a[76:79], v[104:107]
v_mfma_f32_16x16x32_bf16 v[112:115], a[128:131], a[80:83], v[112:115]
ds_read_b64_tr_b16 a[140:141], v7 offset:49152
v_mfma_f32_16x16x32_bf16 v[112:115], a[132:135], a[84:87], v[112:115]
buffer_load_dwordx4 v13, s[8:11], s25 offen offset:1024 lds
v_mfma_f32_16x16x32_bf16 v[120:123], a[128:131], a[88:91], v[120:123]
ds_read_b64_tr_b16 a[142:143], v7 offset:51200
v_mfma_f32_16x16x32_bf16 v[120:123], a[132:135], a[92:95], v[120:123]
v_mfma_f32_16x16x32_bf16 v[128:131], a[128:131], a[96:99], v[128:131]
v_mfma_f32_16x16x32_bf16 v[128:131], a[132:135], a[100:103], v[128:131]
buffer_load_dwordx4 v14, s[8:11], s25 offen offset:2048 lds
v_mfma_f32_16x16x32_bf16 v[136:139], a[128:131], a[104:107], v[136:139]
ds_read_b128 a[24:27], v2 offset:6144
v_mfma_f32_16x16x32_bf16 v[136:139], a[132:135], a[108:111], v[136:139]
v_mfma_f32_16x16x32_bf16 v[144:147], a[128:131], a[112:115], v[144:147]
ds_read_b128 a[28:31], v3 offset:6144
v_mfma_f32_16x16x32_bf16 v[144:147], a[132:135], a[116:119], v[144:147]
buffer_load_dwordx4 v15, s[8:11], s25 offen offset:3072 lds
v_mfma_f32_16x16x32_bf16 v[152:155], a[128:131], a[120:123], v[152:155]
s_add_u32 s25, s25, 128
v_mfma_f32_16x16x32_bf16 v[152:155], a[132:135], a[124:127], v[152:155]
s_waitcnt lgkmcnt(2)
v_mfma_f32_16x16x32_bf16 v[100:103], a[136:139], a[64:67], v[100:103]
ds_read_b64_tr_b16 a[128:129], v8 offset:32768
v_mfma_f32_16x16x32_bf16 v[100:103], a[140:143], a[68:71], v[100:103]
buffer_load_dword v21, v20, s[16:19], s43 offen
v_mfma_f32_16x16x32_bf16 v[108:111], a[136:139], a[72:75], v[108:111]
s_add_u32 s43, s43, s47
ds_read_b64_tr_b16 a[130:131], v8 offset:34816
v_mfma_f32_16x16x32_bf16 v[108:111], a[140:143], a[76:79], v[108:111]
s_cmp_ge_u32 s43, s51
v_mfma_f32_16x16x32_bf16 v[116:119], a[136:139], a[80:83], v[116:119]
s_cselect_b32 s43, 0, s43
ds_read_b64_tr_b16 a[132:133], v8 offset:49152
v_mfma_f32_16x16x32_bf16 v[116:119], a[140:143], a[84:87], v[116:119]
s_cselect_b32 s51, s42, s51
v_mfma_f32_16x16x32_bf16 v[124:127], a[136:139], a[88:91], v[124:127]
s_cselect_b64 s[16:17], s[40:41], s[16:17]
ds_read_b64_tr_b16 a[134:135], v8 offset:51200
v_mfma_f32_16x16x32_bf16 v[124:127], a[140:143], a[92:95], v[124:127]
s_cselect_b32 s18, s42, s18
v_mfma_f32_16x16x32_bf16 v[132:135], a[136:139], a[96:99], v[132:135]
s_cselect_b64 s[40:41], s[44:45], s[40:41]
ds_read_b128 a[32:35], v2 offset:8192
v_mfma_f32_16x16x32_bf16 v[132:135], a[140:143], a[100:103], v[132:135]
s_cselect_b32 s42, s46, s42
v_mfma_f32_16x16x32_bf16 v[140:143], a[136:139], a[104:107], v[140:143]
s_cselect_b32 s46, 0, s46
v_mfma_f32_16x16x32_bf16 v[140:143], a[140:143], a[108:111], v[140:143]
s_cmp_eq_u32 s30, s55
v_mfma_f32_16x16x32_bf16 v[148:151], a[136:139], a[112:115], v[148:151]
s_cselect_b32 s22, 0, 3221225472
ds_read_b128 a[36:39], v3 offset:8192
v_mfma_f32_16x16x32_bf16 v[148:151], a[140:143], a[116:119], v[148:151]
s_sub_u32 s30, s30, 1
buffer_atomic_add v27, v26, s[60:63], s22 offen sc1
v_mfma_f32_16x16x32_bf16 v[156:159], a[136:139], a[120:123], v[156:159]
ds_read_b128 a[40:43], v2 offset:10240
v_mfma_f32_16x16x32_bf16 v[156:159], a[140:143], a[124:127], v[156:159]
s_waitcnt lgkmcnt(3)
v_mfma_f32_16x16x32_bf16 v[160:163], a[128:131], a[64:67], v[160:163]
ds_read_b64_tr_b16 a[136:137], v9 offset:32768
v_mfma_f32_16x16x32_bf16 v[160:163], a[132:135], a[68:71], v[160:163]
v_mfma_f32_16x16x32_bf16 v[168:171], a[128:131], a[72:75], v[168:171]
ds_read_b64_tr_b16 a[138:139], v9 offset:34816
v_mfma_f32_16x16x32_bf16 v[168:171], a[132:135], a[76:79], v[168:171]
v_mfma_f32_16x16x32_bf16 v[176:179], a[128:131], a[80:83], v[176:179]
ds_read_b64_tr_b16 a[140:141], v9 offset:49152
v_mfma_f32_16x16x32_bf16 v[176:179], a[132:135], a[84:87], v[176:179]
v_mfma_f32_16x16x32_bf16 v[184:187], a[128:131], a[88:91], v[184:187]
ds_read_b64_tr_b16 a[142:143], v9 offset:51200
v_mfma_f32_16x16x32_bf16 v[184:187], a[132:135], a[92:95], v[184:187]
v_mfma_f32_16x16x32_bf16 v[192:195], a[128:131], a[96:99], v[192:195]
v_mfma_f32_16x16x32_bf16 v[192:195], a[132:135], a[100:103], v[192:195]
v_mfma_f32_16x16x32_bf16 v[200:203], a[128:131], a[104:107], v[200:203]
ds_read_b128 a[44:47], v3 offset:10240
v_mfma_f32_16x16x32_bf16 v[200:203], a[132:135], a[108:111], v[200:203]
v_mfma_f32_16x16x32_bf16 v[208:211], a[128:131], a[112:115], v[208:211]
ds_read_b128 a[48:51], v2 offset:12288
v_mfma_f32_16x16x32_bf16 v[208:211], a[132:135], a[116:119], v[208:211]
v_mfma_f32_16x16x32_bf16 v[216:219], a[128:131], a[120:123], v[216:219]
v_mfma_f32_16x16x32_bf16 v[216:219], a[132:135], a[124:127], v[216:219]
s_waitcnt lgkmcnt(2)
v_mfma_f32_16x16x32_bf16 v[164:167], a[136:139], a[64:67], v[164:167]
ds_read_b64_tr_b16 a[128:129], v10 offset:32768
v_mfma_f32_16x16x32_bf16 v[164:167], a[140:143], a[68:71], v[164:167]
v_mfma_f32_16x16x32_bf16 v[172:175], a[136:139], a[72:75], v[172:175]
ds_read_b64_tr_b16 a[130:131], v10 offset:34816
v_mfma_f32_16x16x32_bf16 v[172:175], a[140:143], a[76:79], v[172:175]
v_mfma_f32_16x16x32_bf16 v[180:183], a[136:139], a[80:83], v[180:183]
ds_read_b64_tr_b16 a[132:133], v10 offset:49152
v_mfma_f32_16x16x32_bf16 v[180:183], a[140:143], a[84:87], v[180:183]
v_mfma_f32_16x16x32_bf16 v[188:191], a[136:139], a[88:91], v[188:191]
ds_read_b64_tr_b16 a[134:135], v10 offset:51200
v_mfma_f32_16x16x32_bf16 v[188:191], a[140:143], a[92:95], v[188:191]
v_mfma_f32_16x16x32_bf16 v[196:199], a[136:139], a[96:99], v[196:199]
ds_read_b128 a[52:55], v3 offset:12288
v_mfma_f32_16x16x32_bf16 v[196:199], a[140:143], a[100:103], v[196:199]
v_mfma_f32_16x16x32_bf16 v[204:207], a[136:139], a[104:107], v[204:207]
ds_read_b128 a[56:59], v2 offset:14336
v_mfma_f32_16x16x32_bf16 v[204:207], a[140:143], a[108:111], v[204:207]
v_mfma_f32_16x16x32_bf16 v[212:215], a[136:139], a[112:115], v[212:215]
v_mfma_f32_16x16x32_bf16 v[212:215], a[140:143], a[116:119], v[212:215]
v_mfma_f32_16x16x32_bf16 v[220:223], a[136:139], a[120:123], v[220:223]
ds_read_b128 a[60:63], v3 offset:14336
v_mfma_f32_16x16x32_bf16 v[220:223], a[140:143], a[124:127], v[220:223]
s_waitcnt lgkmcnt(3)
v_mfma_f32_16x16x32_bf16 a[192:195], a[128:131], a[64:67], a[192:195]
ds_read_b64_tr_b16 a[136:137], v11 offset:32768
v_mfma_f32_16x16x32_bf16 a[192:195], a[132:135], a[68:71], a[192:195]
v_mfma_f32_16x16x32_bf16 a[200:203], a[128:131], a[72:75], a[200:203]
ds_read_b64_tr_b16 a[138:139], v11 offset:34816
v_mfma_f32_16x16x32_bf16 a[200:203], a[132:135], a[76:79], a[200:203]
v_mfma_f32_16x16x32_bf16 a[208:211], a[128:131], a[80:83], a[208:211]
ds_read_b64_tr_b16 a[140:141], v11 offset:49152
v_mfma_f32_16x16x32_bf16 a[208:211], a[132:135], a[84:87], a[208:211]
v_mfma_f32_16x16x32_bf16 a[216:219], a[128:131], a[88:91], a[216:219]
ds_read_b64_tr_b16 a[142:143], v11 offset:51200
v_mfma_f32_16x16x32_bf16 a[216:219], a[132:135], a[92:95], a[216:219]
v_mfma_f32_16x16x32_bf16 a[224:227], a[128:131], a[96:99], a[224:227]
v_mfma_f32_16x16x32_bf16 a[224:227], a[132:135], a[100:103], a[224:227]
v_mfma_f32_16x16x32_bf16 a[232:235], a[128:131], a[104:107], a[232:235]
v_mfma_f32_16x16x32_bf16 a[232:235], a[132:135], a[108:111], a[232:235]
v_mfma_f32_16x16x32_bf16 a[240:243], a[128:131], a[112:115], a[240:243]
v_mfma_f32_16x16x32_bf16 a[240:243], a[132:135], a[116:119], a[240:243]
v_mfma_f32_16x16x32_bf16 a[248:251], a[128:131], a[120:123], a[248:251]
s_waitcnt vmcnt(2) lgkmcnt(0)
v_mfma_f32_16x16x32_bf16 a[248:251], a[132:135], a[124:127], a[248:251]
s_barrier
v_mfma_f32_16x16x32_bf16 a[196:199], a[136:139], a[64:67], a[196:199]
s_add_u32 m0, s29, 98304
ds_read_b64_tr_b16 a[128:129], v4 offset:0
v_mfma_f32_16x16x32_bf16 a[196:199], a[140:143], a[68:71], a[196:199]
buffer_load_dwordx4 v16, s[12:15], s26 offen offset:0 lds
v_mfma_f32_16x16x32_bf16 a[204:207], a[136:139], a[72:75], a[204:207]
ds_read_b64_tr_b16 a[130:131], v4 offset:2048
v_mfma_f32_16x16x32_bf16 a[204:207], a[140:143], a[76:79], a[204:207]
v_mfma_f32_16x16x32_bf16 a[212:215], a[136:139], a[80:83], a[212:215]
ds_read_b64_tr_b16 a[132:133], v4 offset:16384
v_mfma_f32_16x16x32_bf16 a[212:215], a[140:143], a[84:87], a[212:215]
buffer_load_dwordx4 v17, s[12:15], s26 offen offset:1024 lds
v_mfma_f32_16x16x32_bf16 a[220:223], a[136:139], a[88:91], a[220:223]
ds_read_b64_tr_b16 a[134:135], v4 offset:18432
v_mfma_f32_16x16x32_bf16 a[220:223], a[140:143], a[92:95], a[220:223]
v_mfma_f32_16x16x32_bf16 a[228:231], a[136:139], a[96:99], a[228:231]
v_mfma_f32_16x16x32_bf16 a[228:231], a[140:143], a[100:103], a[228:231]
buffer_load_dwordx4 v18, s[12:15], s26 offen offset:2048 lds
v_mfma_f32_16x16x32_bf16 a[236:239], a[136:139], a[104:107], a[236:239]
v_mfma_f32_16x16x32_bf16 a[236:239], a[140:143], a[108:111], a[236:239]
v_mfma_f32_16x16x32_bf16 a[244:247], a[136:139], a[112:115], a[244:247]
v_mfma_f32_16x16x32_bf16 a[244:247], a[140:143], a[116:119], a[244:247]
buffer_load_dwordx4 v19, s[12:15], s26 offen offset:3072 lds
v_mfma_f32_16x16x32_bf16 a[252:255], a[136:139], a[120:123], a[252:255]
s_add_u32 s26, s26, 524288
v_mfma_f32_16x16x32_bf16 a[252:255], a[140:143], a[124:127], a[252:255]
s_waitcnt lgkmcnt(0)
buffer_store_dword v27, v26, s[4:7], s82 offen sc1
v_mfma_f32_16x16x32_bf16 v[32:35], a[128:131], a[0:3], v[32:35]
s_add_u32 m0, s29, 114688
ds_read_b64_tr_b16 a[136:137], v5 offset:0
v_mfma_f32_16x16x32_bf16 v[32:35], a[132:135], a[4:7], v[32:35]
buffer_load_dwordx4 v16, s[12:15], s27 offen offset:0 lds
v_mfma_f32_16x16x32_bf16 v[40:43], a[128:131], a[8:11], v[40:43]
ds_read_b64_tr_b16 a[138:139], v5 offset:2048
v_mfma_f32_16x16x32_bf16 v[40:43], a[132:135], a[12:15], v[40:43]
v_mfma_f32_16x16x32_bf16 v[48:51], a[128:131], a[16:19], v[48:51]
ds_read_b64_tr_b16 a[140:141], v5 offset:16384
v_mfma_f32_16x16x32_bf16 v[48:51], a[132:135], a[20:23], v[48:51]
buffer_load_dwordx4 v17, s[12:15], s27 offen offset:1024 lds
v_mfma_f32_16x16x32_bf16 v[56:59], a[128:131], a[24:27], v[56:59]
ds_read_b64_tr_b16 a[142:143], v5 offset:18432
v_mfma_f32_16x16x32_bf16 v[56:59], a[132:135], a[28:31], v[56:59]
v_mfma_f32_16x16x32_bf16 v[64:67], a[128:131], a[32:35], v[64:67]
ds_read_b128 a[64:67], v2 offset:32768
v_mfma_f32_16x16x32_bf16 v[64:67], a[132:135], a[36:39], v[64:67]
buffer_load_dwordx4 v18, s[12:15], s27 offen offset:2048 lds
v_mfma_f32_16x16x32_bf16 v[72:75], a[128:131], a[40:43], v[72:75]
ds_read_b128 a[68:71], v3 offset:32768
v_mfma_f32_16x16x32_bf16 v[72:75], a[132:135], a[44:47], v[72:75]
v_mfma_f32_16x16x32_bf16 v[80:83], a[128:131], a[48:51], v[80:83]
v_mfma_f32_16x16x32_bf16 v[80:83], a[132:135], a[52:55], v[80:83]
buffer_load_dwordx4 v19, s[12:15], s27 offen offset:3072 lds
v_mfma_f32_16x16x32_bf16 v[88:91], a[128:131], a[56:59], v[88:91]
s_add_u32 s27, s27, 524288
ds_read_b128 a[72:75], v2 offset:34816
v_mfma_f32_16x16x32_bf16 v[88:91], a[132:135], a[60:63], v[88:91]
s_waitcnt lgkmcnt(3)
v_mfma_f32_16x16x32_bf16 v[36:39], a[136:139], a[0:3], v[36:39]
s_add_u32 m0, s28, 0
ds_read_b64_tr_b16 a[128:129], v6 offset:0
v_mfma_f32_16x16x32_bf16 v[36:39], a[140:143], a[4:7], v[36:39]
buffer_load_dwordx4 v12, s[8:11], s24 offen offset:0 lds
v_mfma_f32_16x16x32_bf16 v[44:47], a[136:139], a[8:11], v[44:47]
ds_read_b64_tr_b16 a[130:131], v6 offset:2048
v_mfma_f32_16x16x32_bf16 v[44:47], a[140:143], a[12:15], v[44:47]
PAD_1:
s_cbranch_execz PAD_5
v_mfma_f32_16x16x32_bf16 v[52:55], a[136:139], a[16:19], v[52:55]
ds_read_b64_tr_b16 a[132:133], v6 offset:16384
v_mfma_f32_16x16x32_bf16 v[52:55], a[140:143], a[20:23], v[52:55]
buffer_load_dwordx4 v13, s[8:11], s24 offen offset:1024 lds
v_mfma_f32_16x16x32_bf16 v[60:63], a[136:139], a[24:27], v[60:63]
ds_read_b64_tr_b16 a[134:135], v6 offset:18432
v_mfma_f32_16x16x32_bf16 v[60:63], a[140:143], a[28:31], v[60:63]
v_mfma_f32_16x16x32_bf16 v[68:71], a[136:139], a[32:35], v[68:71]
ds_read_b128 a[76:79], v3 offset:34816
v_mfma_f32_16x16x32_bf16 v[68:71], a[140:143], a[36:39], v[68:71]
buffer_load_dwordx4 v14, s[8:11], s24 offen offset:2048 lds
v_mfma_f32_16x16x32_bf16 v[76:79], a[136:139], a[40:43], v[76:79]
v_mfma_f32_16x16x32_bf16 v[76:79], a[140:143], a[44:47], v[76:79]
v_mfma_f32_16x16x32_bf16 v[84:87], a[136:139], a[48:51], v[84:87]
ds_read_b128 a[80:83], v2 offset:36864
v_mfma_f32_16x16x32_bf16 v[84:87], a[140:143], a[52:55], v[84:87]
buffer_load_dwordx4 v15, s[8:11], s24 offen offset:3072 lds
v_mfma_f32_16x16x32_bf16 v[92:95], a[136:139], a[56:59], v[92:95]
s_add_u32 s24, s24, 128
ds_read_b128 a[84:87], v3 offset:36864
v_mfma_f32_16x16x32_bf16 v[92:95], a[140:143], a[60:63], v[92:95]
s_waitcnt lgkmcnt(3)
v_mfma_f32_16x16x32_bf16 v[96:99], a[128:131], a[0:3], v[96:99]
s_add_u32 m0, s28, 4096
ds_read_b64_tr_b16 a[136:137], v7 offset:0
v_mfma_f32_16x16x32_bf16 v[96:99], a[132:135], a[4:7], v[96:99]
buffer_load_dwordx4 v12, s[8:11], s25 offen offset:0 lds
v_mfma_f32_16x16x32_bf16 v[104:107], a[128:131], a[8:11], v[104:107]
ds_read_b64_tr_b16 a[138:139], v7 offset:2048
v_mfma_f32_16x16x32_bf16 v[104:107], a[132:135], a[12:15], v[104:107]
v_mfma_f32_16x16x32_bf16 v[112:115], a[128:131], a[16:19], v[112:115]
ds_read_b64_tr_b16 a[140:141], v7 offset:16384
v_mfma_f32_16x16x32_bf16 v[112:115], a[132:135], a[20:23], v[112:115]
buffer_load_dwordx4 v13, s[8:11], s25 offen offset:1024 lds
v_mfma_f32_16x16x32_bf16 v[120:123], a[128:131], a[24:27], v[120:123]
ds_read_b64_tr_b16 a[142:143], v7 offset:18432
v_mfma_f32_16x16x32_bf16 v[120:123], a[132:135], a[28:31], v[120:123]
v_mfma_f32_16x16x32_bf16 v[128:131], a[128:131], a[32:35], v[128:131]
v_mfma_f32_16x16x32_bf16 v[128:131], a[132:135], a[36:39], v[128:131]
buffer_load_dwordx4 v14, s[8:11], s25 offen offset:2048 lds
v_mfma_f32_16x16x32_bf16 v[136:139], a[128:131], a[40:43], v[136:139]
ds_read_b128 a[88:91], v2 offset:38912
v_mfma_f32_16x16x32_bf16 v[136:139], a[132:135], a[44:47], v[136:139]
v_mfma_f32_16x16x32_bf16 v[144:147], a[128:131], a[48:51], v[144:147]
ds_read_b128 a[92:95], v3 offset:38912
v_mfma_f32_16x16x32_bf16 v[144:147], a[132:135], a[52:55], v[144:147]
buffer_load_dwordx4 v15, s[8:11], s25 offen offset:3072 lds
v_mfma_f32_16x16x32_bf16 v[152:155], a[128:131], a[56:59], v[152:155]
s_add_u32 s25, s25, 128
v_mfma_f32_16x16x32_bf16 v[152:155], a[132:135], a[60:63], v[152:155]
s_waitcnt lgkmcnt(2)
v_mfma_f32_16x16x32_bf16 v[100:103], a[136:139], a[0:3], v[100:103]
ds_read_b64_tr_b16 a[128:129], v8 offset:0
v_mfma_f32_16x16x32_bf16 v[100:103], a[140:143], a[4:7], v[100:103]
buffer_load_dword v21, v20, s[16:19], s43 offen
v_mfma_f32_16x16x32_bf16 v[108:111], a[136:139], a[8:11], v[108:111]
s_add_u32 s43, s43, s47
ds_read_b64_tr_b16 a[130:131], v8 offset:2048
v_mfma_f32_16x16x32_bf16 v[108:111], a[140:143], a[12:15], v[108:111]
s_cmp_ge_u32 s43, s51
v_mfma_f32_16x16x32_bf16 v[116:119], a[136:139], a[16:19], v[116:119]
s_cselect_b32 s43, 0, s43
ds_read_b64_tr_b16 a[132:133], v8 offset:16384
v_mfma_f32_16x16x32_bf16 v[116:119], a[140:143], a[20:23], v[116:119]
s_cselect_b32 s51, s42, s51
v_mfma_f32_16x16x32_bf16 v[124:127], a[136:139], a[24:27], v[124:127]
s_cselect_b64 s[16:17], s[40:41], s[16:17]
ds_read_b64_tr_b16 a[134:135], v8 offset:18432
v_mfma_f32_16x16x32_bf16 v[124:127], a[140:143], a[28:31], v[124:127]
s_cselect_b32 s18, s42, s18
v_mfma_f32_16x16x32_bf16 v[132:135], a[136:139], a[32:35], v[132:135]
s_cselect_b64 s[40:41], s[44:45], s[40:41]
ds_read_b128 a[96:99], v2 offset:40960
v_mfma_f32_16x16x32_bf16 v[132:135], a[140:143], a[36:39], v[132:135]
s_cselect_b32 s42, s46, s42
v_mfma_f32_16x16x32_bf16 v[140:143], a[136:139], a[40:43], v[140:143]
s_cselect_b32 s46, 0, s46
v_mfma_f32_16x16x32_bf16 v[140:143], a[140:143], a[44:47], v[140:143]
s_cmp_eq_u32 s30, s55
v_mfma_f32_16x16x32_bf16 v[148:151], a[136:139], a[48:51], v[148:151]
s_cselect_b32 s22, 0, 3221225472
ds_read_b128 a[100:103], v3 offset:40960
v_mfma_f32_16x16x32_bf16 v[148:151], a[140:143], a[52:55], v[148:151]
s_sub_u32 s30, s30, 1
buffer_atomic_add v27, v26, s[60:63], s22 offen sc1
v_mfma_f32_16x16x32_bf16 v[156:159], a[136:139], a[56:59], v[156:159]
ds_read_b128 a[104:107], v2 offset:43008
v_mfma_f32_16x16x32_bf16 v[156:159], a[140:143], a[60:63], v[156:159]
s_waitcnt lgkmcnt(3)
v_mfma_f32_16x16x32_bf16 v[160:163], a[128:131], a[0:3], v[160:163]
ds_read_b64_tr_b16 a[136:137], v9 offset:0
v_mfma_f32_16x16x32_bf16 v[160:163], a[132:135], a[4:7], v[160:163]
v_mfma_f32_16x16x32_bf16 v[168:171], a[128:131], a[8:11], v[168:171]
ds_read_b64_tr_b16 a[138:139], v9 offset:2048
v_mfma_f32_16x16x32_bf16 v[168:171], a[132:135], a[12:15], v[168:171]
v_mfma_f32_16x16x32_bf16 v[176:179], a[128:131], a[16:19], v[176:179]
ds_read_b64_tr_b16 a[140:141], v9 offset:16384
v_mfma_f32_16x16x32_bf16 v[176:179], a[132:135], a[20:23], v[176:179]
v_mfma_f32_16x16x32_bf16 v[184:187], a[128:131], a[24:27], v[184:187]
ds_read_b64_tr_b16 a[142:143], v9 offset:18432
v_mfma_f32_16x16x32_bf16 v[184:187], a[132:135], a[28:31], v[184:187]
v_mfma_f32_16x16x32_bf16 v[192:195], a[128:131], a[32:35], v[192:195]
v_mfma_f32_16x16x32_bf16 v[192:195], a[132:135], a[36:39], v[192:195]
v_mfma_f32_16x16x32_bf16 v[200:203], a[128:131], a[40:43], v[200:203]
ds_read_b128 a[108:111], v3 offset:43008
v_mfma_f32_16x16x32_bf16 v[200:203], a[132:135], a[44:47], v[200:203]
v_mfma_f32_16x16x32_bf16 v[208:211], a[128:131], a[48:51], v[208:211]
ds_read_b128 a[112:115], v2 offset:45056
v_mfma_f32_16x16x32_bf16 v[208:211], a[132:135], a[52:55], v[208:211]
v_mfma_f32_16x16x32_bf16 v[216:219], a[128:131], a[56:59], v[216:219]
v_mfma_f32_16x16x32_bf16 v[216:219], a[132:135], a[60:63], v[216:219]
s_waitcnt lgkmcnt(2)
v_mfma_f32_16x16x32_bf16 v[164:167], a[136:139], a[0:3], v[164:167]
ds_read_b64_tr_b16 a[128:129], v10 offset:0
v_mfma_f32_16x16x32_bf16 v[164:167], a[140:143], a[4:7], v[164:167]
v_mfma_f32_16x16x32_bf16 v[172:175], a[136:139], a[8:11], v[172:175]
ds_read_b64_tr_b16 a[130:131], v10 offset:2048
v_mfma_f32_16x16x32_bf16 v[172:175], a[140:143], a[12:15], v[172:175]
v_mfma_f32_16x16x32_bf16 v[180:183], a[136:139], a[16:19], v[180:183]
ds_read_b64_tr_b16 a[132:133], v10 offset:16384
v_mfma_f32_16x16x32_bf16 v[180:183], a[140:143], a[20:23], v[180:183]
v_mfma_f32_16x16x32_bf16 v[188:191], a[136:139], a[24:27], v[188:191]
ds_read_b64_tr_b16 a[134:135], v10 offset:18432
v_mfma_f32_16x16x32_bf16 v[188:191], a[140:143], a[28:31], v[188:191]
v_mfma_f32_16x16x32_bf16 v[196:199], a[136:139], a[32:35], v[196:199]
ds_read_b128 a[116:119], v3 offset:45056
v_mfma_f32_16x16x32_bf16 v[196:199], a[140:143], a[36:39], v[196:199]
v_mfma_f32_16x16x32_bf16 v[204:207], a[136:139], a[40:43], v[204:207]
ds_read_b128 a[120:123], v2 offset:47104
v_mfma_f32_16x16x32_bf16 v[204:207], a[140:143], a[44:47], v[204:207]
v_mfma_f32_16x16x32_bf16 v[212:215], a[136:139], a[48:51], v[212:215]
v_mfma_f32_16x16x32_bf16 v[212:215], a[140:143], a[52:55], v[212:215]
v_mfma_f32_16x16x32_bf16 v[220:223], a[136:139], a[56:59], v[220:223]
ds_read_b128 a[124:127], v3 offset:47104
v_mfma_f32_16x16x32_bf16 v[220:223], a[140:143], a[60:63], v[220:223]
s_waitcnt lgkmcnt(3)
v_mfma_f32_16x16x32_bf16 a[192:195], a[128:131], a[0:3], a[192:195]
ds_read_b64_tr_b16 a[136:137], v11 offset:0
v_mfma_f32_16x16x32_bf16 a[192:195], a[132:135], a[4:7], a[192:195]
v_mfma_f32_16x16x32_bf16 a[200:203], a[128:131], a[8:11], a[200:203]
ds_read_b64_tr_b16 a[138:139], v11 offset:2048
v_mfma_f32_16x16x32_bf16 a[200:203], a[132:135], a[12:15], a[200:203]
v_mfma_f32_16x16x32_bf16 a[208:211], a[128:131], a[16:19], a[208:211]
ds_read_b64_tr_b16 a[140:141], v11 offset:16384
v_mfma_f32_16x16x32_bf16 a[208:211], a[132:135], a[20:23], a[208:211]
v_mfma_f32_16x16x32_bf16 a[216:219], a[128:131], a[24:27], a[216:219]
ds_read_b64_tr_b16 a[142:143], v11 offset:18432
v_mfma_f32_16x16x32_bf16 a[216:219], a[132:135], a[28:31], a[216:219]
v_mfma_f32_16x16x32_bf16 a[224:227], a[128:131], a[32:35], a[224:227]
v_mfma_f32_16x16x32_bf16 a[224:227], a[132:135], a[36:39], a[224:227]
v_mfma_f32_16x16x32_bf16 a[232:235], a[128:131], a[40:43], a[232:235]
v_mfma_f32_16x16x32_bf16 a[232:235], a[132:135], a[44:47], a[232:235]
v_mfma_f32_16x16x32_bf16 a[240:243], a[128:131], a[48:51], a[240:243]
v_mfma_f32_16x16x32_bf16 a[240:243], a[132:135], a[52:55], a[240:243]
v_mfma_f32_16x16x32_bf16 a[248:251], a[128:131], a[56:59], a[248:251]
s_waitcnt vmcnt(2) lgkmcnt(0)
v_mfma_f32_16x16x32_bf16 a[248:251], a[132:135], a[60:63], a[248:251]
s_barrier
v_mfma_f32_16x16x32_bf16 a[196:199], a[136:139], a[0:3], a[196:199]
s_add_u32 m0, s29, 65536
ds_read_b64_tr_b16 a[128:129], v4 offset:32768
v_mfma_f32_16x16x32_bf16 a[196:199], a[140:143], a[4:7], a[196:199]
buffer_load_dwordx4 v16, s[12:15], s26 offen offset:0 lds
v_mfma_f32_16x16x32_bf16 a[204:207], a[136:139], a[8:11], a[204:207]
ds_read_b64_tr_b16 a[130:131], v4 offset:34816
v_mfma_f32_16x16x32_bf16 a[204:207], a[140:143], a[12:15], a[204:207]
v_mfma_f32_16x16x32_bf16 a[212:215], a[136:139], a[16:19], a[212:215]
ds_read_b64_tr_b16 a[132:133], v4 offset:49152
v_mfma_f32_16x16x32_bf16 a[212:215], a[140:143], a[20:23], a[212:215]
buffer_load_dwordx4 v17, s[12:15], s26 offen offset:1024 lds
v_mfma_f32_16x16x32_bf16 a[220:223], a[136:139], a[24:27], a[220:223]
ds_read_b64_tr_b16 a[134:135], v4 offset:51200
v_mfma_f32_16x16x32_bf16 a[220:223], a[140:143], a[28:31], a[220:223]
v_mfma_f32_16x16x32_bf16 a[228:231], a[136:139], a[32:35], a[228:231]
v_mfma_f32_16x16x32_bf16 a[228:231], a[140:143], a[36:39], a[228:231]
buffer_load_dwordx4 v18, s[12:15], s26 offen offset:2048 lds
v_mfma_f32_16x16x32_bf16 a[236:239], a[136:139], a[40:43], a[236:239]
v_mfma_f32_16x16x32_bf16 a[236:239], a[140:143], a[44:47], a[236:239]
v_mfma_f32_16x16x32_bf16 a[244:247], a[136:139], a[48:51], a[244:247]
v_mfma_f32_16x16x32_bf16 a[244:247], a[140:143], a[52:55], a[244:247]
s_waitcnt lgkmcnt(0)
buffer_load_dwordx4 v19, s[12:15], s26 offen offset:3072 lds
v_mfma_f32_16x16x32_bf16 a[252:255], a[136:139], a[56:59], a[252:255]
s_add_u32 s26, s26, 524288
s_bitcmp1_b32 s30, 1
v_mfma_f32_16x16x32_bf16 a[252:255], a[140:143], a[60:63], a[252:255]
s_cbranch_scc1 Lg_1
s_cmp_eq_u32 s30, 0
s_cbranch_scc1 Lg_1t
v_mfma_f32_16x16x32_bf16 v[32:35], a[128:131], a[64:67], v[32:35]
s_add_u32 m0, s29, 81920
ds_read_b64_tr_b16 a[136:137], v5 offset:32768
v_mfma_f32_16x16x32_bf16 v[32:35], a[132:135], a[68:71], v[32:35]
buffer_load_dwordx4 v16, s[12:15], s27 offen offset:0 lds
v_mfma_f32_16x16x32_bf16 v[40:43], a[128:131], a[72:75], v[40:43]
s_lshl_b32 s22, s38, 3
ds_read_b64_tr_b16 a[138:139], v5 offset:34816
v_mfma_f32_16x16x32_bf16 v[40:43], a[132:135], a[76:79], v[40:43]
s_lshl_b32 s23, s39, 5
v_and_b32 v252, 31, v0
v_lshrrev_b32 v253, 5, v0
v_mfma_f32_16x16x32_bf16 v[48:51], a[128:131], a[80:83], v[48:51]
ds_read_b64_tr_b16 a[140:141], v5 offset:49152
v_add_u32 v253, s22, v253
v_mfma_f32_16x16x32_bf16 v[48:51], a[132:135], a[84:87], v[48:51]
buffer_load_dwordx4 v17, s[12:15], s27 offen offset:1024 lds
v_mfma_f32_16x16x32_bf16 v[56:59], a[128:131], a[88:91], v[56:59]
ds_read_b64_tr_b16 a[142:143], v5 offset:51200
v_add_u32 v252, s23, v252
v_mfma_f32_16x16x32_bf16 v[56:59], a[132:135], a[92:95], v[56:59]
v_mul_u32_u24 v254, 7168, v253
v_lshl_add_u32 v254, v252, 2, v254
v_mfma_f32_16x16x32_bf16 v[64:67], a[128:131], a[96:99], v[64:67]
ds_read_b128 a[0:3], v2 offset:0
v_lshlrev_b32 v252, 4, v252
v_mfma_f32_16x16x32_bf16 v[64:67], a[132:135], a[100:103], v[64:67]
buffer_load_dwordx4 v18, s[12:15], s27 offen offset:2048 lds
v_mfma_f32_16x16x32_bf16 v[72:75], a[128:131], a[104:107], v[72:75]
ds_read_b128 a[4:7], v3 offset:0
v_add_u32 v255, 3584, v254
v_mfma_f32_16x16x32_bf16 v[72:75], a[132:135], a[108:111], v[72:75]
v_subrev_u32 v22, 3584, v254
v_subrev_u32 v23, 2688, v254
v_mfma_f32_16x16x32_bf16 v[80:83], a[128:131], a[112:115], v[80:83]
v_subrev_u32 v24, 1792, v254
v_subrev_u32 v25, 896, v254
v_mfma_f32_16x16x32_bf16 v[80:83], a[132:135], a[116:119], v[80:83]
buffer_load_dwordx4 v19, s[12:15], s27 offen offset:3072 lds
v_mfma_f32_16x16x32_bf16 v[88:91], a[128:131], a[120:123], v[88:91]
s_add_u32 s27, s27, 524288
ds_read_b128 a[8:11], v2 offset:2048
v_mfma_f32_16x16x32_bf16 v[88:91], a[132:135], a[124:127], v[88:91]
s_waitcnt lgkmcnt(3)
v_mfma_f32_16x16x32_bf16 v[36:39], a[136:139], a[64:67], v[36:39]
s_add_u32 m0, s28, 32768
ds_read_b64_tr_b16 a[128:129], v6 offset:32768
v_mfma_f32_16x16x32_bf16 v[36:39], a[140:143], a[68:71], v[36:39]
buffer_load_dwordx4 v12, s[8:11], s24 offen offset:0 lds
v_mfma_f32_16x16x32_bf16 v[44:47], a[136:139], a[72:75], v[44:47]
ds_read_b64_tr_b16 a[130:131], v6 offset:34816
v_mfma_f32_16x16x32_bf16 v[44:47], a[140:143], a[76:79], v[44:47]
v_mfma_f32_16x16x32_bf16 v[52:55], a[136:139], a[80:83], v[52:55]
ds_read_b64_tr_b16 a[132:133], v6 offset:49152
v_mfma_f32_16x16x32_bf16 v[52:55], a[140:143], a[84:87], v[52:55]
buffer_load_dwordx4 v13, s[8:11], s24 offen offset:1024 lds
v_mfma_f32_16x16x32_bf16 v[60:63], a[136:139], a[88:91], v[60:63]
ds_read_b64_tr_b16 a[134:135], v6 offset:51200
v_mfma_f32_16x16x32_bf16 v[60:63], a[140:143], a[92:95], v[60:63]
v_mfma_f32_16x16x32_bf16 v[68:71], a[136:139], a[96:99], v[68:71]
ds_read_b128 a[12:15], v3 offset:2048
v_mfma_f32_16x16x32_bf16 v[68:71], a[140:143], a[100:103], v[68:71]
buffer_load_dwordx4 v14, s[8:11], s24 offen offset:2048 lds
v_mfma_f32_16x16x32_bf16 v[76:79], a[136:139], a[104:107], v[76:79]
v_mfma_f32_16x16x32_bf16 v[76:79], a[140:143], a[108:111], v[76:79]
v_mfma_f32_16x16x32_bf16 v[84:87], a[136:139], a[112:115], v[84:87]
ds_read_b128 a[16:19], v2 offset:4096
v_mfma_f32_16x16x32_bf16 v[84:87], a[140:143], a[116:119], v[84:87]
buffer_load_dwordx4 v15, s[8:11], s24 offen offset:3072 lds
v_mfma_f32_16x16x32_bf16 v[92:95], a[136:139], a[120:123], v[92:95]
s_add_u32 s24, s24, 128
ds_read_b128 a[20:23], v3 offset:4096
v_mfma_f32_16x16x32_bf16 v[92:95], a[140:143], a[124:127], v[92:95]
s_waitcnt lgkmcnt(3)
v_mfma_f32_16x16x32_bf16 v[96:99], a[128:131], a[64:67], v[96:99]
s_add_u32 m0, s28, 36864
ds_read_b64_tr_b16 a[136:137], v7 offset:32768
v_mfma_f32_16x16x32_bf16 v[96:99], a[132:135], a[68:71], v[96:99]
buffer_load_dwordx4 v12, s[8:11], s25 offen offset:0 lds
v_mfma_f32_16x16x32_bf16 v[104:107], a[128:131], a[72:75], v[104:107]
ds_read_b64_tr_b16 a[138:139], v7 offset:34816
v_mfma_f32_16x16x32_bf16 v[104:107], a[132:135], a[76:79], v[104:107]
v_mfma_f32_16x16x32_bf16 v[112:115], a[128:131], a[80:83], v[112:115]
ds_read_b64_tr_b16 a[140:141], v7 offset:49152
v_mfma_f32_16x16x32_bf16 v[112:115], a[132:135], a[84:87], v[112:115]
buffer_load_dwordx4 v13, s[8:11], s25 offen offset:1024 lds
v_mfma_f32_16x16x32_bf16 v[120:123], a[128:131], a[88:91], v[120:123]
ds_read_b64_tr_b16 a[142:143], v7 offset:51200
v_mfma_f32_16x16x32_bf16 v[120:123], a[132:135], a[92:95], v[120:123]
v_mfma_f32_16x16x32_bf16 v[128:131], a[128:131], a[96:99], v[128:131]
v_mfma_f32_16x16x32_bf16 v[128:131], a[132:135], a[100:103], v[128:131]
buffer_load_dwordx4 v14, s[8:11], s25 offen offset:2048 lds
v_mfma_f32_16x16x32_bf16 v[136:139], a[128:131], a[104:107], v[136:139]
ds_read_b128 a[24:27], v2 offset:6144
v_mfma_f32_16x16x32_bf16 v[136:139], a[132:135], a[108:111], v[136:139]
v_mfma_f32_16x16x32_bf16 v[144:147], a[128:131], a[112:115], v[144:147]
ds_read_b128 a[28:31], v3 offset:6144
v_mfma_f32_16x16x32_bf16 v[144:147], a[132:135], a[116:119], v[144:147]
buffer_load_dwordx4 v15, s[8:11], s25 offen offset:3072 lds
v_mfma_f32_16x16x32_bf16 v[152:155], a[128:131], a[120:123], v[152:155]
s_add_u32 s25, s25, 128
v_mfma_f32_16x16x32_bf16 v[152:155], a[132:135], a[124:127], v[152:155]
s_waitcnt lgkmcnt(2)
v_mfma_f32_16x16x32_bf16 v[100:103], a[136:139], a[64:67], v[100:103]
s_mov_b64 s[56:57], s[70:71]
s_mov_b32 s58, 3584
s_mov_b32 s59, 0x20000
ds_read_b64_tr_b16 a[128:129], v8 offset:32768
buffer_load_dwordx4 v[248:251], v252, s[56:59], 0 offen
v_mfma_f32_16x16x32_bf16 v[100:103], a[140:143], a[68:71], v[100:103]
s_mov_b64 s[56:57], s[66:67]
s_mov_b32 s58, 1835008
buffer_load_dword v224, v22, s[56:59], 0 offen nt
v_mfma_f32_16x16x32_bf16 v[108:111], a[136:139], a[72:75], v[108:111]
ds_read_b64_tr_b16 a[130:131], v8 offset:34816
buffer_load_dword v225, v23, s[56:59], 0 offen nt
v_mfma_f32_16x16x32_bf16 v[108:111], a[140:143], a[76:79], v[108:111]
buffer_load_dword v226, v24, s[56:59], 0 offen nt
v_mfma_f32_16x16x32_bf16 v[116:119], a[136:139], a[80:83], v[116:119]
ds_read_b64_tr_b16 a[132:133], v8 offset:49152
buffer_load_dword v227, v25, s[56:59], 0 offen nt
v_mfma_f32_16x16x32_bf16 v[116:119], a[140:143], a[84:87], v[116:119]
buffer_load_dword v228, v254, s[56:59], 0 offen offset:0 nt
v_mfma_f32_16x16x32_bf16 v[124:127], a[136:139], a[88:91], v[124:127]
ds_read_b64_tr_b16 a[134:135], v8 offset:51200
buffer_load_dword v229, v254, s[56:59], 0 offen offset:896 nt
v_mfma_f32_16x16x32_bf16 v[124:127], a[140:143], a[92:95], v[124:127]
buffer_load_dword v230, v254, s[56:59], 0 offen offset:1792 nt
v_mfma_f32_16x16x32_bf16 v[132:135], a[136:139], a[96:99], v[132:135]
ds_read_b128 a[32:35], v2 offset:8192
buffer_load_dword v231, v254, s[56:59], 0 offen offset:2688 nt
v_mfma_f32_16x16x32_bf16 v[132:135], a[140:143], a[100:103], v[132:135]
buffer_load_dword v232, v255, s[56:59], 0 offen offset:0 nt
v_mfma_f32_16x16x32_bf16 v[140:143], a[136:139], a[104:107], v[140:143]
buffer_load_dword v233, v255, s[56:59], 0 offen offset:896 nt
v_mfma_f32_16x16x32_bf16 v[140:143], a[140:143], a[108:111], v[140:143]
buffer_load_dword v234, v255, s[56:59], 0 offen offset:1792 nt
v_mfma_f32_16x16x32_bf16 v[148:151], a[136:139], a[112:115], v[148:151]
ds_read_b128 a[36:39], v3 offset:8192
buffer_load_dword v235, v255, s[56:59], 0 offen offset:2688 nt
v_mfma_f32_16x16x32_bf16 v[148:151], a[140:143], a[116:119], v[148:151]
s_mov_b64 s[56:57], s[68:69]
buffer_load_dword v236, v25, s[56:59], 0 offen nt
v_mfma_f32_16x16x32_bf16 v[156:159], a[136:139], a[120:123], v[156:159]
ds_read_b128 a[40:43], v2 offset:10240
buffer_load_dword v237, v254, s[56:59], 0 offen offset:0 nt
v_mfma_f32_16x16x32_bf16 v[156:159], a[140:143], a[124:127], v[156:159]
s_waitcnt lgkmcnt(3)
buffer_load_dword v238, v254, s[56:59], 0 offen offset:896 nt
v_mfma_f32_16x16x32_bf16 v[160:163], a[128:131], a[64:67], v[160:163]
ds_read_b64_tr_b16 a[136:137], v9 offset:32768
buffer_load_dword v239, v254, s[56:59], 0 offen offset:1792 nt
v_mfma_f32_16x16x32_bf16 v[160:163], a[132:135], a[68:71], v[160:163]
buffer_load_dword v240, v254, s[56:59], 0 offen offset:2688 nt
v_mfma_f32_16x16x32_bf16 v[168:171], a[128:131], a[72:75], v[168:171]
ds_read_b64_tr_b16 a[138:139], v9 offset:34816
buffer_load_dword v241, v255, s[56:59], 0 offen offset:0 nt
v_mfma_f32_16x16x32_bf16 v[168:171], a[132:135], a[76:79], v[168:171]
buffer_load_dword v242, v255, s[56:59], 0 offen offset:896 nt
v_mfma_f32_16x16x32_bf16 v[176:179], a[128:131], a[80:83], v[176:179]
ds_read_b64_tr_b16 a[140:141], v9 offset:49152
buffer_load_dword v243, v255, s[56:59], 0 offen offset:1792 nt
v_mfma_f32_16x16x32_bf16 v[176:179], a[132:135], a[84:87], v[176:179]
buffer_load_dword v244, v255, s[56:59], 0 offen offset:2688 nt
v_mfma_f32_16x16x32_bf16 v[184:187], a[128:131], a[88:91], v[184:187]
ds_read_b64_tr_b16 a[142:143], v9 offset:51200
v_mfma_f32_16x16x32_bf16 v[184:187], a[132:135], a[92:95], v[184:187]
v_mfma_f32_16x16x32_bf16 v[192:195], a[128:131], a[96:99], v[192:195]
v_mfma_f32_16x16x32_bf16 v[192:195], a[132:135], a[100:103], v[192:195]
v_mfma_f32_16x16x32_bf16 v[200:203], a[128:131], a[104:107], v[200:203]
ds_read_b128 a[44:47], v3 offset:10240
v_mfma_f32_16x16x32_bf16 v[200:203], a[132:135], a[108:111], v[200:203]
v_mfma_f32_16x16x32_bf16 v[208:211], a[128:131], a[112:115], v[208:211]
ds_read_b128 a[48:51], v2 offset:12288
v_mfma_f32_16x16x32_bf16 v[208:211], a[132:135], a[116:119], v[208:211]
v_mfma_f32_16x16x32_bf16 v[216:219], a[128:131], a[120:123], v[216:219]
v_mfma_f32_16x16x32_bf16 v[216:219], a[132:135], a[124:127], v[216:219]
s_waitcnt lgkmcnt(2)
v_mfma_f32_16x16x32_bf16 v[164:167], a[136:139], a[64:67], v[164:167]
ds_read_b64_tr_b16 a[128:129], v10 offset:32768
v_mfma_f32_16x16x32_bf16 v[164:167], a[140:143], a[68:71], v[164:167]
v_mfma_f32_16x16x32_bf16 v[172:175], a[136:139], a[72:75], v[172:175]
ds_read_b64_tr_b16 a[130:131], v10 offset:34816
v_mfma_f32_16x16x32_bf16 v[172:175], a[140:143], a[76:79], v[172:175]
v_mfma_f32_16x16x32_bf16 v[180:183], a[136:139], a[80:83], v[180:183]
ds_read_b64_tr_b16 a[132:133], v10 offset:49152
v_mfma_f32_16x16x32_bf16 v[180:183], a[140:143], a[84:87], v[180:183]
v_mfma_f32_16x16x32_bf16 v[188:191], a[136:139], a[88:91], v[188:191]
ds_read_b64_tr_b16 a[134:135], v10 offset:51200
v_mfma_f32_16x16x32_bf16 v[188:191], a[140:143], a[92:95], v[188:191]
v_mfma_f32_16x16x32_bf16 v[196:199], a[136:139], a[96:99], v[196:199]
ds_read_b128 a[52:55], v3 offset:12288
v_mfma_f32_16x16x32_bf16 v[196:199], a[140:143], a[100:103], v[196:199]
v_mfma_f32_16x16x32_bf16 v[204:207], a[136:139], a[104:107], v[204:207]
ds_read_b128 a[56:59], v2 offset:14336
v_mfma_f32_16x16x32_bf16 v[204:207], a[140:143], a[108:111], v[204:207]
v_mfma_f32_16x16x32_bf16 v[212:215], a[136:139], a[112:115], v[212:215]
v_mfma_f32_16x16x32_bf16 v[212:215], a[140:143], a[116:119], v[212:215]
v_mfma_f32_16x16x32_bf16 v[220:223], a[136:139], a[120:123], v[220:223]
ds_read_b128 a[60:63], v3 offset:14336
v_mfma_f32_16x16x32_bf16 v[220:223], a[140:143], a[124:127], v[220:223]
s_waitcnt lgkmcnt(3)
v_mfma_f32_16x16x32_bf16 a[192:195], a[128:131], a[64:67], a[192:195]
ds_read_b64_tr_b16 a[136:137], v11 offset:32768
v_mfma_f32_16x16x32_bf16 a[192:195], a[132:135], a[68:71], a[192:195]
v_mfma_f32_16x16x32_bf16 a[200:203], a[128:131], a[72:75], a[200:203]
ds_read_b64_tr_b16 a[138:139], v11 offset:34816
v_mfma_f32_16x16x32_bf16 a[200:203], a[132:135], a[76:79], a[200:203]
v_mfma_f32_16x16x32_bf16 a[208:211], a[128:131], a[80:83], a[208:211]
ds_read_b64_tr_b16 a[140:141], v11 offset:49152
v_mfma_f32_16x16x32_bf16 a[208:211], a[132:135], a[84:87], a[208:211]
v_mfma_f32_16x16x32_bf16 a[216:219], a[128:131], a[88:91], a[216:219]
ds_read_b64_tr_b16 a[142:143], v11 offset:51200
v_mfma_f32_16x16x32_bf16 a[216:219], a[132:135], a[92:95], a[216:219]
v_mfma_f32_16x16x32_bf16 a[224:227], a[128:131], a[96:99], a[224:227]
v_mfma_f32_16x16x32_bf16 a[224:227], a[132:135], a[100:103], a[224:227]
v_mfma_f32_16x16x32_bf16 a[232:235], a[128:131], a[104:107], a[232:235]
v_mfma_f32_16x16x32_bf16 a[232:235], a[132:135], a[108:111], a[232:235]
v_mfma_f32_16x16x32_bf16 a[240:243], a[128:131], a[112:115], a[240:243]
v_mfma_f32_16x16x32_bf16 a[240:243], a[132:135], a[116:119], a[240:243]
v_mfma_f32_16x16x32_bf16 a[248:251], a[128:131], a[120:123], a[248:251]
s_waitcnt vmcnt(22) lgkmcnt(0)
v_mfma_f32_16x16x32_bf16 a[248:251], a[132:135], a[124:127], a[248:251]
s_barrier
v_mfma_f32_16x16x32_bf16 a[196:199], a[136:139], a[64:67], a[196:199]
s_add_u32 m0, s29, 98304
ds_read_b64_tr_b16 a[128:129], v4 offset:0
v_mfma_f32_16x16x32_bf16 a[196:199], a[140:143], a[68:71], a[196:199]
buffer_load_dwordx4 v16, s[12:15], s26 offen offset:0 lds
v_mfma_f32_16x16x32_bf16 a[204:207], a[136:139], a[72:75], a[204:207]
ds_read_b64_tr_b16 a[130:131], v4 offset:2048
v_mfma_f32_16x16x32_bf16 a[204:207], a[140:143], a[76:79], a[204:207]
v_mfma_f32_16x16x32_bf16 a[212:215], a[136:139], a[80:83], a[212:215]
ds_read_b64_tr_b16 a[132:133], v4 offset:16384
v_mfma_f32_16x16x32_bf16 a[212:215], a[140:143], a[84:87], a[212:215]
buffer_load_dwordx4 v17, s[12:15], s26 offen offset:1024 lds
v_mfma_f32_16x16x32_bf16 a[220:223], a[136:139], a[88:91], a[220:223]
ds_read_b64_tr_b16 a[134:135], v4 offset:18432
v_mfma_f32_16x16x32_bf16 a[220:223], a[140:143], a[92:95], a[220:223]
v_mfma_f32_16x16x32_bf16 a[228:231], a[136:139], a[96:99], a[228:231]
v_mfma_f32_16x16x32_bf16 a[228:231], a[140:143], a[100:103], a[228:231]
buffer_load_dwordx4 v18, s[12:15], s26 offen offset:2048 lds
v_mfma_f32_16x16x32_bf16 a[236:239], a[136:139], a[104:107], a[236:239]
v_mfma_f32_16x16x32_bf16 a[236:239], a[140:143], a[108:111], a[236:239]
v_mfma_f32_16x16x32_bf16 a[244:247], a[136:139], a[112:115], a[244:247]
v_mfma_f32_16x16x32_bf16 a[244:247], a[140:143], a[116:119], a[244:247]
buffer_load_dwordx4 v19, s[12:15], s26 offen offset:3072 lds
v_mfma_f32_16x16x32_bf16 a[252:255], a[136:139], a[120:123], a[252:255]
s_add_u32 s26, s26, 524288
v_mfma_f32_16x16x32_bf16 a[252:255], a[140:143], a[124:127], a[252:255]
s_waitcnt lgkmcnt(0)
v_mfma_f32_16x16x32_bf16 v[32:35], a[128:131], a[0:3], v[32:35]
s_add_u32 m0, s29, 114688
ds_read_b64_tr_b16 a[136:137], v5 offset:0
v_mfma_f32_16x16x32_bf16 v[32:35], a[132:135], a[4:7], v[32:35]
buffer_load_dwordx4 v16, s[12:15], s27 offen offset:0 lds
v_mfma_f32_16x16x32_bf16 v[40:43], a[128:131], a[8:11], v[40:43]
ds_read_b64_tr_b16 a[138:139], v5 offset:2048
v_mfma_f32_16x16x32_bf16 v[40:43], a[132:135], a[12:15], v[40:43]
v_mfma_f32_16x16x32_bf16 v[48:51], a[128:131], a[16:19], v[48:51]
ds_read_b64_tr_b16 a[140:141], v5 offset:16384
v_mfma_f32_16x16x32_bf16 v[48:51], a[132:135], a[20:23], v[48:51]
buffer_load_dwordx4 v17, s[12:15], s27 offen offset:1024 lds
v_mfma_f32_16x16x32_bf16 v[56:59], a[128:131], a[24:27], v[56:59]
ds_read_b64_tr_b16 a[142:143], v5 offset:18432
v_mfma_f32_16x16x32_bf16 v[56:59], a[132:135], a[28:31], v[56:59]
v_mfma_f32_16x16x32_bf16 v[64:67], a[128:131], a[32:35], v[64:67]
ds_read_b128 a[64:67], v2 offset:32768
v_mfma_f32_16x16x32_bf16 v[64:67], a[132:135], a[36:39], v[64:67]
buffer_load_dwordx4 v18, s[12:15], s27 offen offset:2048 lds
v_mfma_f32_16x16x32_bf16 v[72:75], a[128:131], a[40:43], v[72:75]
ds_read_b128 a[68:71], v3 offset:32768
v_mfma_f32_16x16x32_bf16 v[72:75], a[132:135], a[44:47], v[72:75]
v_mfma_f32_16x16x32_bf16 v[80:83], a[128:131], a[48:51], v[80:83]
v_mfma_f32_16x16x32_bf16 v[80:83], a[132:135], a[52:55], v[80:83]
buffer_load_dwordx4 v19, s[12:15], s27 offen offset:3072 lds
v_mfma_f32_16x16x32_bf16 v[88:91], a[128:131], a[56:59], v[88:91]
s_add_u32 s27, s27, 524288
ds_read_b128 a[72:75], v2 offset:34816
v_mfma_f32_16x16x32_bf16 v[88:91], a[132:135], a[60:63], v[88:91]
s_waitcnt lgkmcnt(3)
v_mfma_f32_16x16x32_bf16 v[36:39], a[136:139], a[0:3], v[36:39]
s_add_u32 m0, s28, 0
ds_read_b64_tr_b16 a[128:129], v6 offset:0
v_mfma_f32_16x16x32_bf16 v[36:39], a[140:143], a[4:7], v[36:39]
buffer_load_dwordx4 v12, s[8:11], s24 offen offset:0 lds
v_mfma_f32_16x16x32_bf16 v[44:47], a[136:139], a[8:11], v[44:47]
ds_read_b64_tr_b16 a[130:131], v6 offset:2048
v_mfma_f32_16x16x32_bf16 v[44:47], a[140:143], a[12:15], v[44:47]
v_mfma_f32_16x16x32_bf16 v[52:55], a[136:139], a[16:19], v[52:55]
ds_read_b64_tr_b16 a[132:133], v6 offset:16384
v_mfma_f32_16x16x32_bf16 v[52:55], a[140:143], a[20:23], v[52:55]
buffer_load_dwordx4 v13, s[8:11], s24 offen offset:1024 lds
v_mfma_f32_16x16x32_bf16 v[60:63], a[136:139], a[24:27], v[60:63]
ds_read_b64_tr_b16 a[134:135], v6 offset:18432
v_mfma_f32_16x16x32_bf16 v[60:63], a[140:143], a[28:31], v[60:63]
v_mfma_f32_16x16x32_bf16 v[68:71], a[136:139], a[32:35], v[68:71]
ds_read_b128 a[76:79], v3 offset:34816
v_mfma_f32_16x16x32_bf16 v[68:71], a[140:143], a[36:39], v[68:71]
buffer_load_dwordx4 v14, s[8:11], s24 offen offset:2048 lds
v_mfma_f32_16x16x32_bf16 v[76:79], a[136:139], a[40:43], v[76:79]
v_mfma_f32_16x16x32_bf16 v[76:79], a[140:143], a[44:47], v[76:79]
v_mfma_f32_16x16x32_bf16 v[84:87], a[136:139], a[48:51], v[84:87]
ds_read_b128 a[80:83], v2 offset:36864
v_mfma_f32_16x16x32_bf16 v[84:87], a[140:143], a[52:55], v[84:87]
buffer_load_dwordx4 v15, s[8:11], s24 offen offset:3072 lds
v_mfma_f32_16x16x32_bf16 v[92:95], a[136:139], a[56:59], v[92:95]
s_add_u32 s24, s24, 128
ds_read_b128 a[84:87], v3 offset:36864
v_mfma_f32_16x16x32_bf16 v[92:95], a[140:143], a[60:63], v[92:95]
s_waitcnt lgkmcnt(3)
v_mfma_f32_16x16x32_bf16 v[96:99], a[128:131], a[0:3], v[96:99]
s_add_u32 m0, s28, 4096
ds_read_b64_tr_b16 a[136:137], v7 offset:0
v_mfma_f32_16x16x32_bf16 v[96:99], a[132:135], a[4:7], v[96:99]
buffer_load_dwordx4 v12, s[8:11], s25 offen offset:0 lds
v_mfma_f32_16x16x32_bf16 v[104:107], a[128:131], a[8:11], v[104:107]
ds_read_b64_tr_b16 a[138:139], v7 offset:2048
v_mfma_f32_16x16x32_bf16 v[104:107], a[132:135], a[12:15], v[104:107]
v_mfma_f32_16x16x32_bf16 v[112:115], a[128:131], a[16:19], v[112:115]
ds_read_b64_tr_b16 a[140:141], v7 offset:16384
v_mfma_f32_16x16x32_bf16 v[112:115], a[132:135], a[20:23], v[112:115]
buffer_load_dwordx4 v13, s[8:11], s25 offen offset:1024 lds
v_mfma_f32_16x16x32_bf16 v[120:123], a[128:131], a[24:27], v[120:123]
ds_read_b64_tr_b16 a[142:143], v7 offset:18432
v_mfma_f32_16x16x32_bf16 v[120:123], a[132:135], a[28:31], v[120:123]
v_mfma_f32_16x16x32_bf16 v[128:131], a[128:131], a[32:35], v[128:131]
v_mfma_f32_16x16x32_bf16 v[128:131], a[132:135], a[36:39], v[128:131]
buffer_load_dwordx4 v14, s[8:11], s25 offen offset:2048 lds
v_mfma_f32_16x16x32_bf16 v[136:139], a[128:131], a[40:43], v[136:139]
ds_read_b128 a[88:91], v2 offset:38912
v_mfma_f32_16x16x32_bf16 v[136:139], a[132:135], a[44:47], v[136:139]
v_mfma_f32_16x16x32_bf16 v[144:147], a[128:131], a[48:51], v[144:147]
ds_read_b128 a[92:95], v3 offset:38912
v_mfma_f32_16x16x32_bf16 v[144:147], a[132:135], a[52:55], v[144:147]
buffer_load_dwordx4 v15, s[8:11], s25 offen offset:3072 lds
v_mfma_f32_16x16x32_bf16 v[152:155], a[128:131], a[56:59], v[152:155]
s_add_u32 s25, s25, 128
v_mfma_f32_16x16x32_bf16 v[152:155], a[132:135], a[60:63], v[152:155]
s_waitcnt lgkmcnt(2)
v_mfma_f32_16x16x32_bf16 v[100:103], a[136:139], a[0:3], v[100:103]
ds_read_b64_tr_b16 a[128:129], v8 offset:0
v_mfma_f32_16x16x32_bf16 v[100:103], a[140:143], a[4:7], v[100:103]
buffer_load_dword v21, v20, s[16:19], s43 offen
v_mfma_f32_16x16x32_bf16 v[108:111], a[136:139], a[8:11], v[108:111]
s_add_u32 s43, s43, s47
ds_read_b64_tr_b16 a[130:131], v8 offset:2048
v_mfma_f32_16x16x32_bf16 v[108:111], a[140:143], a[12:15], v[108:111]
PAD_2:
s_cbranch_execz M_tret
s_cmp_ge_u32 s43, s51
v_mfma_f32_16x16x32_bf16 v[116:119], a[136:139], a[16:19], v[116:119]
s_cselect_b32 s43, 0, s43
ds_read_b64_tr_b16 a[132:133], v8 offset:16384
v_mfma_f32_16x16x32_bf16 v[116:119], a[140:143], a[20:23], v[116:119]
s_cselect_b32 s51, s42, s51
v_mfma_f32_16x16x32_bf16 v[124:127], a[136:139], a[24:27], v[124:127]
s_cselect_b64 s[16:17], s[40:41], s[16:17]
ds_read_b64_tr_b16 a[134:135], v8 offset:18432
v_mfma_f32_16x16x32_bf16 v[124:127], a[140:143], a[28:31], v[124:127]
s_cselect_b32 s18, s42, s18
v_mfma_f32_16x16x32_bf16 v[132:135], a[136:139], a[32:35], v[132:135]
s_cselect_b64 s[40:41], s[44:45], s[40:41]
ds_read_b128 a[96:99], v2 offset:40960
v_mfma_f32_16x16x32_bf16 v[132:135], a[140:143], a[36:39], v[132:135]
s_cselect_b32 s42, s46, s42
v_mfma_f32_16x16x32_bf16 v[140:143], a[136:139], a[40:43], v[140:143]
s_cselect_b32 s46, 0, s46
v_mfma_f32_16x16x32_bf16 v[140:143], a[140:143], a[44:47], v[140:143]
s_lshl_b32 s59, s39, 5
v_mfma_f32_16x16x32_bf16 v[148:151], a[136:139], a[48:51], v[148:151]
s_add_u32 s59, s59, s38
ds_read_b128 a[100:103], v3 offset:40960
v_mfma_f32_16x16x32_bf16 v[148:151], a[140:143], a[52:55], v[148:151]
s_lshl_b32 s59, s59, 2
v_mfma_f32_16x16x32_bf16 v[156:159], a[136:139], a[56:59], v[156:159]
s_add_u32 s59, s59, 94392320
ds_read_b128 a[104:107], v2 offset:43008
v_mfma_f32_16x16x32_bf16 v[156:159], a[140:143], a[60:63], v[156:159]
s_waitcnt lgkmcnt(3)
s_cmp_lt_u32 s2, 224
v_mfma_f32_16x16x32_bf16 v[160:163], a[128:131], a[0:3], v[160:163]
s_cselect_b32 s59, s59, 3221225472
ds_read_b64_tr_b16 a[136:137], v9 offset:0
v_mfma_f32_16x16x32_bf16 v[160:163], a[132:135], a[4:7], v[160:163]
s_mov_b32 s58, 0xffff0000
v_mfma_f32_16x16x32_bf16 v[168:171], a[128:131], a[8:11], v[168:171]
ds_read_b64_tr_b16 a[138:139], v9 offset:2048
v_mfma_f32_16x16x32_bf16 v[168:171], a[132:135], a[12:15], v[168:171]
buffer_load_dword v21, v20, s[16:19], s43 offen
v_mfma_f32_16x16x32_bf16 v[176:179], a[128:131], a[16:19], v[176:179]
s_add_u32 s43, s43, s47
ds_read_b64_tr_b16 a[140:141], v9 offset:16384
v_mfma_f32_16x16x32_bf16 v[176:179], a[132:135], a[20:23], v[176:179]
s_cmp_ge_u32 s43, s51
v_mfma_f32_16x16x32_bf16 v[184:187], a[128:131], a[24:27], v[184:187]
s_cselect_b32 s43, 0, s43
ds_read_b64_tr_b16 a[142:143], v9 offset:18432
v_mfma_f32_16x16x32_bf16 v[184:187], a[132:135], a[28:31], v[184:187]
s_cselect_b32 s51, s42, s51
v_mfma_f32_16x16x32_bf16 v[192:195], a[128:131], a[32:35], v[192:195]
s_cselect_b64 s[16:17], s[40:41], s[16:17]
v_mfma_f32_16x16x32_bf16 v[192:195], a[132:135], a[36:39], v[192:195]
s_cselect_b32 s18, s42, s18
v_mfma_f32_16x16x32_bf16 v[200:203], a[128:131], a[40:43], v[200:203]
s_cselect_b64 s[40:41], s[44:45], s[40:41]
ds_read_b128 a[108:111], v3 offset:43008
v_mfma_f32_16x16x32_bf16 v[200:203], a[132:135], a[44:47], v[200:203]
s_cselect_b32 s42, s46, s42
v_mfma_f32_16x16x32_bf16 v[208:211], a[128:131], a[48:51], v[208:211]
s_cselect_b32 s46, 0, s46
ds_read_b128 a[112:115], v2 offset:45056
v_mfma_f32_16x16x32_bf16 v[208:211], a[132:135], a[52:55], v[208:211]
v_mfma_f32_16x16x32_bf16 v[216:219], a[128:131], a[56:59], v[216:219]
v_mfma_f32_16x16x32_bf16 v[216:219], a[132:135], a[60:63], v[216:219]
s_waitcnt lgkmcnt(2)
v_mfma_f32_16x16x32_bf16 v[164:167], a[136:139], a[0:3], v[164:167]
ds_read_b64_tr_b16 a[128:129], v10 offset:0
v_mfma_f32_16x16x32_bf16 v[164:167], a[140:143], a[4:7], v[164:167]
v_mfma_f32_16x16x32_bf16 v[172:175], a[136:139], a[8:11], v[172:175]
ds_read_b64_tr_b16 a[130:131], v10 offset:2048
v_mfma_f32_16x16x32_bf16 v[172:175], a[140:143], a[12:15], v[172:175]
v_mfma_f32_16x16x32_bf16 v[180:183], a[136:139], a[16:19], v[180:183]
ds_read_b64_tr_b16 a[132:133], v10 offset:16384
v_mfma_f32_16x16x32_bf16 v[180:183], a[140:143], a[20:23], v[180:183]
v_mfma_f32_16x16x32_bf16 v[188:191], a[136:139], a[24:27], v[188:191]
ds_read_b64_tr_b16 a[134:135], v10 offset:18432
v_mfma_f32_16x16x32_bf16 v[188:191], a[140:143], a[28:31], v[188:191]
v_mfma_f32_16x16x32_bf16 v[196:199], a[136:139], a[32:35], v[196:199]
ds_read_b128 a[116:119], v3 offset:45056
v_mfma_f32_16x16x32_bf16 v[196:199], a[140:143], a[36:39], v[196:199]
v_mfma_f32_16x16x32_bf16 v[204:207], a[136:139], a[40:43], v[204:207]
ds_read_b128 a[120:123], v2 offset:47104
v_and_b32 v252, 31, v0
v_mfma_f32_16x16x32_bf16 v[204:207], a[140:143], a[44:47], v[204:207]
v_lshrrev_b32 v253, 5, v0
v_xor_b32 v253, v253, v252
v_mfma_f32_16x16x32_bf16 v[212:215], a[136:139], a[48:51], v[212:215]
v_and_b32 v253, 7, v253
v_lshlrev_b32 v252, 8, v252
v_mfma_f32_16x16x32_bf16 v[212:215], a[140:143], a[52:55], v[212:215]
v_lshl_add_u32 v252, v253, 4, v252
v_add_u32 v252, 147456, v252
v_mfma_f32_16x16x32_bf16 v[220:223], a[136:139], a[56:59], v[220:223]
ds_read_b128 a[124:127], v3 offset:47104
v_mfma_f32_16x16x32_bf16 v[220:223], a[140:143], a[60:63], v[220:223]
s_waitcnt lgkmcnt(3)
v_mfma_f32_16x16x32_bf16 a[192:195], a[128:131], a[0:3], a[192:195]
ds_read_b64_tr_b16 a[136:137], v11 offset:0
v_mfma_f32_16x16x32_bf16 a[192:195], a[132:135], a[4:7], a[192:195]
v_mfma_f32_16x16x32_bf16 a[200:203], a[128:131], a[8:11], a[200:203]
ds_read_b64_tr_b16 a[138:139], v11 offset:2048
v_mfma_f32_16x16x32_bf16 a[200:203], a[132:135], a[12:15], a[200:203]
v_mfma_f32_16x16x32_bf16 a[208:211], a[128:131], a[16:19], a[208:211]
ds_read_b64_tr_b16 a[140:141], v11 offset:16384
v_mfma_f32_16x16x32_bf16 a[208:211], a[132:135], a[20:23], a[208:211]
v_mfma_f32_16x16x32_bf16 a[216:219], a[128:131], a[24:27], a[216:219]
ds_read_b64_tr_b16 a[142:143], v11 offset:18432
v_mfma_f32_16x16x32_bf16 a[216:219], a[132:135], a[28:31], a[216:219]
v_mfma_f32_16x16x32_bf16 a[224:227], a[128:131], a[32:35], a[224:227]
v_mfma_f32_16x16x32_bf16 a[224:227], a[132:135], a[36:39], a[224:227]
v_mfma_f32_16x16x32_bf16 a[232:235], a[128:131], a[40:43], a[232:235]
v_mfma_f32_16x16x32_bf16 a[232:235], a[132:135], a[44:47], a[232:235]
v_mfma_f32_16x16x32_bf16 a[240:243], a[128:131], a[48:51], a[240:243]
v_mfma_f32_16x16x32_bf16 a[240:243], a[132:135], a[52:55], a[240:243]
v_mfma_f32_16x16x32_bf16 a[248:251], a[128:131], a[56:59], a[248:251]
s_waitcnt vmcnt(2) lgkmcnt(0)
v_mfma_f32_16x16x32_bf16 a[248:251], a[132:135], a[60:63], a[248:251]
s_barrier
v_mfma_f32_16x16x32_bf16 a[196:199], a[136:139], a[0:3], a[196:199]
s_add_u32 m0, s29, 65536
ds_read_b64_tr_b16 a[128:129], v4 offset:32768
v_lshlrev_b32 v28, 16, v248
v_mfma_f32_16x16x32_bf16 a[196:199], a[140:143], a[4:7], a[196:199]
buffer_load_dwordx4 v16, s[12:15], s26 offen offset:0 lds
v_mfma_f32_16x16x32_bf16 a[204:207], a[136:139], a[8:11], a[204:207]
ds_read_b64_tr_b16 a[130:131], v4 offset:34816
v_and_b32 v29, s58, v248
v_mfma_f32_16x16x32_bf16 a[204:207], a[140:143], a[12:15], a[204:207]
v_lshlrev_b32 v30, 16, v249
v_and_b32 v253, s58, v249
v_mfma_f32_16x16x32_bf16 a[212:215], a[136:139], a[16:19], a[212:215]
ds_read_b64_tr_b16 a[132:133], v4 offset:49152
v_lshlrev_b32 v22, 16, v224
v_mfma_f32_16x16x32_bf16 a[212:215], a[140:143], a[20:23], a[212:215]
buffer_load_dwordx4 v17, s[12:15], s26 offen offset:1024 lds
v_mfma_f32_16x16x32_bf16 a[220:223], a[136:139], a[24:27], a[220:223]
ds_read_b64_tr_b16 a[134:135], v4 offset:51200
v_lshlrev_b32 v23, 16, v225
v_mfma_f32_16x16x32_bf16 a[220:223], a[140:143], a[28:31], a[220:223]
v_lshlrev_b32 v24, 16, v226
v_mul_f32 v254, v22, v253
v_mfma_f32_16x16x32_bf16 a[228:231], a[136:139], a[32:35], a[228:231]
v_lshlrev_b32 v25, 16, v227
v_lshlrev_b32 v247, 16, v236
v_mfma_f32_16x16x32_bf16 a[228:231], a[140:143], a[36:39], a[228:231]
buffer_load_dwordx4 v18, s[12:15], s26 offen offset:2048 lds
v_mfma_f32_16x16x32_bf16 a[236:239], a[136:139], a[40:43], a[236:239]
v_fmac_f32 v254, v23, v30
v_fmac_f32 v254, v24, v29
v_mfma_f32_16x16x32_bf16 a[236:239], a[140:143], a[44:47], a[236:239]
v_fmac_f32 v254, v25, v28
v_mul_f32 v254, v254, v247
v_mfma_f32_16x16x32_bf16 a[244:247], a[136:139], a[48:51], a[244:247]
v_mul_f32 v255, v23, v253
v_lshlrev_b32 v22, 16, v228
v_mfma_f32_16x16x32_bf16 a[244:247], a[140:143], a[52:55], a[244:247]
buffer_load_dwordx4 v19, s[12:15], s26 offen offset:3072 lds
v_mfma_f32_16x16x32_bf16 a[252:255], a[136:139], a[56:59], a[252:255]
s_add_u32 s26, s26, 524288
v_lshlrev_b32 v247, 16, v237
v_fmac_f32 v255, v24, v30
v_mfma_f32_16x16x32_bf16 a[252:255], a[140:143], a[60:63], a[252:255]
s_waitcnt lgkmcnt(0)
v_fmac_f32 v255, v25, v29
v_fmac_f32 v255, v22, v28
v_mfma_f32_16x16x32_bf16 v[32:35], a[128:131], a[64:67], v[32:35]
s_add_u32 m0, s29, 81920
ds_read_b64_tr_b16 a[136:137], v5 offset:32768
v_mul_f32 v255, v255, v247
v_mfma_f32_16x16x32_bf16 v[32:35], a[132:135], a[68:71], v[32:35]
buffer_load_dwordx4 v16, s[12:15], s27 offen offset:0 lds
v_mfma_f32_16x16x32_bf16 v[40:43], a[128:131], a[72:75], v[40:43]
ds_read_b64_tr_b16 a[138:139], v5 offset:34816
v_cvt_pk_bf16_f32 v246, v254, v255
v_mfma_f32_16x16x32_bf16 v[40:43], a[132:135], a[76:79], v[40:43]
v_accvgpr_write_b32 a180, v246
v_mul_f32 v254, v24, v253
v_mfma_f32_16x16x32_bf16 v[48:51], a[128:131], a[80:83], v[48:51]
ds_read_b64_tr_b16 a[140:141], v5 offset:49152
v_lshlrev_b32 v23, 16, v229
v_mfma_f32_16x16x32_bf16 v[48:51], a[132:135], a[84:87], v[48:51]
buffer_load_dwordx4 v17, s[12:15], s27 offen offset:1024 lds
v_lshlrev_b32 v247, 16, v238
v_mfma_f32_16x16x32_bf16 v[56:59], a[128:131], a[88:91], v[56:59]
ds_read_b64_tr_b16 a[142:143], v5 offset:51200
v_fmac_f32 v254, v25, v30
v_mfma_f32_16x16x32_bf16 v[56:59], a[132:135], a[92:95], v[56:59]
v_fmac_f32 v254, v22, v29
v_fmac_f32 v254, v23, v28
v_mfma_f32_16x16x32_bf16 v[64:67], a[128:131], a[96:99], v[64:67]
ds_read_b128 a[0:3], v2 offset:0
v_mul_f32 v254, v254, v247
v_mfma_f32_16x16x32_bf16 v[64:67], a[132:135], a[100:103], v[64:67]
buffer_load_dwordx4 v18, s[12:15], s27 offen offset:2048 lds
v_mfma_f32_16x16x32_bf16 v[72:75], a[128:131], a[104:107], v[72:75]
ds_read_b128 a[4:7], v3 offset:0
v_cvt_pk_bf16_f32 v246, v255, v254
v_accvgpr_write_b32 a176, v246
v_mfma_f32_16x16x32_bf16 v[72:75], a[132:135], a[108:111], v[72:75]
v_mul_f32 v255, v25, v253
v_lshlrev_b32 v24, 16, v230
v_mfma_f32_16x16x32_bf16 v[80:83], a[128:131], a[112:115], v[80:83]
v_lshlrev_b32 v247, 16, v239
v_fmac_f32 v255, v22, v30
v_mfma_f32_16x16x32_bf16 v[80:83], a[132:135], a[116:119], v[80:83]
buffer_load_dwordx4 v19, s[12:15], s27 offen offset:3072 lds
v_mfma_f32_16x16x32_bf16 v[88:91], a[128:131], a[120:123], v[88:91]
s_add_u32 s27, s27, 524288
ds_read_b128 a[8:11], v2 offset:2048
v_fmac_f32 v255, v23, v29
v_mfma_f32_16x16x32_bf16 v[88:91], a[132:135], a[124:127], v[88:91]
s_waitcnt lgkmcnt(3)
v_fmac_f32 v255, v24, v28
v_mul_f32 v255, v255, v247
v_mfma_f32_16x16x32_bf16 v[36:39], a[136:139], a[64:67], v[36:39]
s_add_u32 m0, s28, 32768
ds_read_b64_tr_b16 a[128:129], v6 offset:32768
v_cvt_pk_bf16_f32 v246, v254, v255
v_accvgpr_write_b32 a181, v246
v_mfma_f32_16x16x32_bf16 v[36:39], a[140:143], a[68:71], v[36:39]
buffer_load_dwordx4 v12, s[8:11], s24 offen offset:0 lds
v_mfma_f32_16x16x32_bf16 v[44:47], a[136:139], a[72:75], v[44:47]
ds_read_b64_tr_b16 a[130:131], v6 offset:34816
v_mul_f32 v254, v22, v253
v_mfma_f32_16x16x32_bf16 v[44:47], a[140:143], a[76:79], v[44:47]
v_lshlrev_b32 v25, 16, v231
v_lshlrev_b32 v247, 16, v240
v_mfma_f32_16x16x32_bf16 v[52:55], a[136:139], a[80:83], v[52:55]
ds_read_b64_tr_b16 a[132:133], v6 offset:49152
v_fmac_f32 v254, v23, v30
v_mfma_f32_16x16x32_bf16 v[52:55], a[140:143], a[84:87], v[52:55]
buffer_load_dwordx4 v13, s[8:11], s24 offen offset:1024 lds
v_fmac_f32 v254, v24, v29
v_mfma_f32_16x16x32_bf16 v[60:63], a[136:139], a[88:91], v[60:63]
ds_read_b64_tr_b16 a[134:135], v6 offset:51200
v_fmac_f32 v254, v25, v28
v_mfma_f32_16x16x32_bf16 v[60:63], a[140:143], a[92:95], v[60:63]
v_mul_f32 v254, v254, v247
v_cvt_pk_bf16_f32 v246, v255, v254
v_mfma_f32_16x16x32_bf16 v[68:71], a[136:139], a[96:99], v[68:71]
ds_read_b128 a[12:15], v3 offset:2048
v_accvgpr_write_b32 a177, v246
v_mfma_f32_16x16x32_bf16 v[68:71], a[140:143], a[100:103], v[68:71]
buffer_load_dwordx4 v14, s[8:11], s24 offen offset:2048 lds
v_mfma_f32_16x16x32_bf16 v[76:79], a[136:139], a[104:107], v[76:79]
v_mul_f32 v255, v23, v253
v_lshlrev_b32 v22, 16, v232
v_lshlrev_b32 v247, 16, v241
v_mfma_f32_16x16x32_bf16 v[76:79], a[140:143], a[108:111], v[76:79]
v_fmac_f32 v255, v24, v30
v_fmac_f32 v255, v25, v29
v_mfma_f32_16x16x32_bf16 v[84:87], a[136:139], a[112:115], v[84:87]
ds_read_b128 a[16:19], v2 offset:4096
v_fmac_f32 v255, v22, v28
v_mfma_f32_16x16x32_bf16 v[84:87], a[140:143], a[116:119], v[84:87]
buffer_load_dwordx4 v15, s[8:11], s24 offen offset:3072 lds
v_mfma_f32_16x16x32_bf16 v[92:95], a[136:139], a[120:123], v[92:95]
s_add_u32 s24, s24, 128
ds_read_b128 a[20:23], v3 offset:4096
v_mul_f32 v255, v255, v247
v_mfma_f32_16x16x32_bf16 v[92:95], a[140:143], a[124:127], v[92:95]
s_waitcnt lgkmcnt(3)
v_cvt_pk_bf16_f32 v246, v254, v255
v_accvgpr_write_b32 a182, v246
v_mfma_f32_16x16x32_bf16 v[96:99], a[128:131], a[64:67], v[96:99]
s_add_u32 m0, s28, 36864
ds_read_b64_tr_b16 a[136:137], v7 offset:32768
v_mul_f32 v254, v24, v253
v_lshlrev_b32 v23, 16, v233
v_mfma_f32_16x16x32_bf16 v[96:99], a[132:135], a[68:71], v[96:99]
buffer_load_dwordx4 v12, s[8:11], s25 offen offset:0 lds
v_mfma_f32_16x16x32_bf16 v[104:107], a[128:131], a[72:75], v[104:107]
ds_read_b64_tr_b16 a[138:139], v7 offset:34816
v_lshlrev_b32 v247, 16, v242
v_mfma_f32_16x16x32_bf16 v[104:107], a[132:135], a[76:79], v[104:107]
v_fmac_f32 v254, v25, v30
v_fmac_f32 v254, v22, v29
v_mfma_f32_16x16x32_bf16 v[112:115], a[128:131], a[80:83], v[112:115]
ds_read_b64_tr_b16 a[140:141], v7 offset:49152
v_fmac_f32 v254, v23, v28
v_mfma_f32_16x16x32_bf16 v[112:115], a[132:135], a[84:87], v[112:115]
buffer_load_dwordx4 v13, s[8:11], s25 offen offset:1024 lds
v_mul_f32 v254, v254, v247
v_mfma_f32_16x16x32_bf16 v[120:123], a[128:131], a[88:91], v[120:123]
ds_read_b64_tr_b16 a[142:143], v7 offset:51200
v_cvt_pk_bf16_f32 v246, v255, v254
v_mfma_f32_16x16x32_bf16 v[120:123], a[132:135], a[92:95], v[120:123]
v_accvgpr_write_b32 a178, v246
v_mul_f32 v255, v25, v253
v_mfma_f32_16x16x32_bf16 v[128:131], a[128:131], a[96:99], v[128:131]
v_lshlrev_b32 v24, 16, v234
v_lshlrev_b32 v247, 16, v243
v_mfma_f32_16x16x32_bf16 v[128:131], a[132:135], a[100:103], v[128:131]
buffer_load_dwordx4 v14, s[8:11], s25 offen offset:2048 lds
v_mfma_f32_16x16x32_bf16 v[136:139], a[128:131], a[104:107], v[136:139]
ds_read_b128 a[24:27], v2 offset:6144
v_fmac_f32 v255, v22, v30
v_fmac_f32 v255, v23, v29
v_mfma_f32_16x16x32_bf16 v[136:139], a[132:135], a[108:111], v[136:139]
v_fmac_f32 v255, v24, v28
v_mul_f32 v255, v255, v247
v_mfma_f32_16x16x32_bf16 v[144:147], a[128:131], a[112:115], v[144:147]
ds_read_b128 a[28:31], v3 offset:6144
v_cvt_pk_bf16_f32 v246, v254, v255
v_mfma_f32_16x16x32_bf16 v[144:147], a[132:135], a[116:119], v[144:147]
buffer_load_dwordx4 v15, s[8:11], s25 offen offset:3072 lds
v_mfma_f32_16x16x32_bf16 v[152:155], a[128:131], a[120:123], v[152:155]
s_add_u32 s25, s25, 128
v_accvgpr_write_b32 a183, v246
v_mul_f32 v254, v22, v253
v_mfma_f32_16x16x32_bf16 v[152:155], a[132:135], a[124:127], v[152:155]
s_waitcnt lgkmcnt(2)
v_lshlrev_b32 v25, 16, v235
v_lshlrev_b32 v247, 16, v244
v_mfma_f32_16x16x32_bf16 v[100:103], a[136:139], a[64:67], v[100:103]
ds_read_b64_tr_b16 a[128:129], v8 offset:32768
v_fmac_f32 v254, v23, v30
v_fmac_f32 v254, v24, v29
v_mfma_f32_16x16x32_bf16 v[100:103], a[140:143], a[68:71], v[100:103]
buffer_load_dword v21, v20, s[16:19], s43 offen
v_mfma_f32_16x16x32_bf16 v[108:111], a[136:139], a[72:75], v[108:111]
s_add_u32 s43, s43, s47
ds_read_b64_tr_b16 a[130:131], v8 offset:34816
v_fmac_f32 v254, v25, v28
v_mfma_f32_16x16x32_bf16 v[108:111], a[140:143], a[76:79], v[108:111]
s_cmp_ge_u32 s43, s51
v_mul_f32 v254, v254, v247
v_cvt_pk_bf16_f32 v246, v255, v254
v_mfma_f32_16x16x32_bf16 v[116:119], a[136:139], a[80:83], v[116:119]
s_cselect_b32 s43, 0, s43
ds_read_b64_tr_b16 a[132:133], v8 offset:49152
v_accvgpr_write_b32 a179, v246
v_mfma_f32_16x16x32_bf16 v[116:119], a[140:143], a[84:87], v[116:119]
s_cselect_b32 s51, s42, s51
v_lshlrev_b32 v28, 16, v250
v_and_b32 v29, s58, v250
v_lshlrev_b32 v30, 16, v251
v_mfma_f32_16x16x32_bf16 v[124:127], a[136:139], a[88:91], v[124:127]
s_cselect_b64 s[16:17], s[40:41], s[16:17]
ds_read_b64_tr_b16 a[134:135], v8 offset:51200
v_and_b32 v253, s58, v251
v_mfma_f32_16x16x32_bf16 v[124:127], a[140:143], a[92:95], v[124:127]
s_cselect_b32 s18, s42, s18
v_and_b32 v22, s58, v224
v_and_b32 v23, s58, v225
v_mfma_f32_16x16x32_bf16 v[132:135], a[136:139], a[96:99], v[132:135]
s_cselect_b64 s[40:41], s[44:45], s[40:41]
ds_read_b128 a[32:35], v2 offset:8192
v_and_b32 v24, s58, v226
v_mfma_f32_16x16x32_bf16 v[132:135], a[140:143], a[100:103], v[132:135]
s_cselect_b32 s42, s46, s42
v_mul_f32 v254, v22, v253
v_and_b32 v25, s58, v227
v_mfma_f32_16x16x32_bf16 v[140:143], a[136:139], a[104:107], v[140:143]
s_cselect_b32 s46, 0, s46
v_and_b32 v247, s58, v236
v_fmac_f32 v254, v23, v30
v_mfma_f32_16x16x32_bf16 v[140:143], a[140:143], a[108:111], v[140:143]
buffer_load_dword v245, off, s[60:63], 0 sc1
v_fmac_f32 v254, v24, v29
v_mfma_f32_16x16x32_bf16 v[148:151], a[136:139], a[112:115], v[148:151]
ds_read_b128 a[36:39], v3 offset:8192
v_fmac_f32 v254, v25, v28
v_mfma_f32_16x16x32_bf16 v[148:151], a[140:143], a[116:119], v[148:151]
v_mul_f32 v254, v254, v247
v_mul_f32 v255, v23, v253
v_mfma_f32_16x16x32_bf16 v[156:159], a[136:139], a[120:123], v[156:159]
ds_read_b128 a[40:43], v2 offset:10240
v_and_b32 v22, s58, v228
v_mfma_f32_16x16x32_bf16 v[156:159], a[140:143], a[124:127], v[156:159]
s_waitcnt lgkmcnt(3)
v_and_b32 v247, s58, v237
v_fmac_f32 v255, v24, v30
v_mfma_f32_16x16x32_bf16 v[160:163], a[128:131], a[64:67], v[160:163]
ds_read_b64_tr_b16 a[136:137], v9 offset:32768
v_fmac_f32 v255, v25, v29
v_fmac_f32 v255, v22, v28
v_mfma_f32_16x16x32_bf16 v[160:163], a[132:135], a[68:71], v[160:163]
v_mul_f32 v255, v255, v247
v_cvt_pk_bf16_f32 v246, v254, v255
v_mfma_f32_16x16x32_bf16 v[168:171], a[128:131], a[72:75], v[168:171]
ds_read_b64_tr_b16 a[138:139], v9 offset:34816
v_accvgpr_write_b32 a188, v246
v_mfma_f32_16x16x32_bf16 v[168:171], a[132:135], a[76:79], v[168:171]
v_mul_f32 v254, v24, v253
v_and_b32 v23, s58, v229
v_mfma_f32_16x16x32_bf16 v[176:179], a[128:131], a[80:83], v[176:179]
ds_read_b64_tr_b16 a[140:141], v9 offset:49152
v_and_b32 v247, s58, v238
v_mfma_f32_16x16x32_bf16 v[176:179], a[132:135], a[84:87], v[176:179]
v_fmac_f32 v254, v25, v30
v_fmac_f32 v254, v22, v29
v_fmac_f32 v254, v23, v28
v_mfma_f32_16x16x32_bf16 v[184:187], a[128:131], a[88:91], v[184:187]
ds_read_b64_tr_b16 a[142:143], v9 offset:51200
v_mul_f32 v254, v254, v247
v_mfma_f32_16x16x32_bf16 v[184:187], a[132:135], a[92:95], v[184:187]
v_cvt_pk_bf16_f32 v246, v255, v254
v_accvgpr_write_b32 a184, v246
v_mfma_f32_16x16x32_bf16 v[192:195], a[128:131], a[96:99], v[192:195]
v_mul_f32 v255, v25, v253
v_and_b32 v24, s58, v230
v_mfma_f32_16x16x32_bf16 v[192:195], a[132:135], a[100:103], v[192:195]
v_and_b32 v247, s58, v239
v_fmac_f32 v255, v22, v30
v_mfma_f32_16x16x32_bf16 v[200:203], a[128:131], a[104:107], v[200:203]
ds_read_b128 a[44:47], v3 offset:10240
v_fmac_f32 v255, v23, v29
v_mfma_f32_16x16x32_bf16 v[200:203], a[132:135], a[108:111], v[200:203]
v_fmac_f32 v255, v24, v28
v_mul_f32 v255, v255, v247
v_cvt_pk_bf16_f32 v246, v254, v255
v_mfma_f32_16x16x32_bf16 v[208:211], a[128:131], a[112:115], v[208:211]
ds_read_b128 a[48:51], v2 offset:12288
v_accvgpr_write_b32 a189, v246
v_mfma_f32_16x16x32_bf16 v[208:211], a[132:135], a[116:119], v[208:211]
v_mul_f32 v254, v22, v253
v_and_b32 v25, s58, v231
v_mfma_f32_16x16x32_bf16 v[216:219], a[128:131], a[120:123], v[216:219]
v_and_b32 v247, s58, v240
v_fmac_f32 v254, v23, v30
v_mfma_f32_16x16x32_bf16 v[216:219], a[132:135], a[124:127], v[216:219]
s_waitcnt lgkmcnt(2)
v_fmac_f32 v254, v24, v29
v_fmac_f32 v254, v25, v28
v_mfma_f32_16x16x32_bf16 v[164:167], a[136:139], a[64:67], v[164:167]
ds_read_b64_tr_b16 a[128:129], v10 offset:32768
v_mul_f32 v254, v254, v247
v_cvt_pk_bf16_f32 v246, v255, v254
v_mfma_f32_16x16x32_bf16 v[164:167], a[140:143], a[68:71], v[164:167]
v_accvgpr_write_b32 a185, v246
v_mul_f32 v255, v23, v253
v_mfma_f32_16x16x32_bf16 v[172:175], a[136:139], a[72:75], v[172:175]
ds_read_b64_tr_b16 a[130:131], v10 offset:34816
v_and_b32 v22, s58, v232
v_mfma_f32_16x16x32_bf16 v[172:175], a[140:143], a[76:79], v[172:175]
v_and_b32 v247, s58, v241
v_fmac_f32 v255, v24, v30
v_mfma_f32_16x16x32_bf16 v[180:183], a[136:139], a[80:83], v[180:183]
s_lshr_b32 s22, s3, 1
ds_read_b64_tr_b16 a[132:133], v10 offset:49152
v_fmac_f32 v255, v25, v29
v_mfma_f32_16x16x32_bf16 v[180:183], a[140:143], a[84:87], v[180:183]
s_mul_i32 s22, s22, 2097152
v_fmac_f32 v255, v22, v28
v_mul_f32 v255, v255, v247
v_cvt_pk_bf16_f32 v246, v254, v255
v_mfma_f32_16x16x32_bf16 v[188:191], a[136:139], a[88:91], v[188:191]
s_and_b32 s23, s3, 1
ds_read_b64_tr_b16 a[134:135], v10 offset:51200
v_accvgpr_write_b32 a190, v246
v_mfma_f32_16x16x32_bf16 v[188:191], a[140:143], a[92:95], v[188:191]
s_lshl_b32 s23, s23, 5
v_mul_f32 v254, v24, v253
v_and_b32 v23, s58, v233
v_mfma_f32_16x16x32_bf16 v[196:199], a[136:139], a[96:99], v[196:199]
s_lshl_b32 s56, s39, 6
ds_read_b128 a[52:55], v3 offset:12288
v_and_b32 v247, s58, v242
v_mfma_f32_16x16x32_bf16 v[196:199], a[140:143], a[100:103], v[196:199]
s_add_u32 s23, s23, s56
v_fmac_f32 v254, v25, v30
v_fmac_f32 v254, v22, v29
v_mfma_f32_16x16x32_bf16 v[204:207], a[136:139], a[104:107], v[204:207]
s_mul_i32 s23, s23, 4224
ds_read_b128 a[56:59], v2 offset:14336
v_fmac_f32 v254, v23, v28
v_mfma_f32_16x16x32_bf16 v[204:207], a[140:143], a[108:111], v[204:207]
s_add_u32 s22, s22, s23
v_mul_f32 v254, v254, v247
v_cvt_pk_bf16_f32 v246, v255, v254
v_accvgpr_write_b32 a186, v246
v_mfma_f32_16x16x32_bf16 v[212:215], a[136:139], a[112:115], v[212:215]
s_add_u32 s57, s22, 83886200
v_mul_f32 v255, v25, v253
v_and_b32 v24, s58, v234
v_mfma_f32_16x16x32_bf16 v[212:215], a[140:143], a[116:119], v[212:215]
s_lshl_b32 s23, s38, 7
v_and_b32 v247, s58, v243
v_fmac_f32 v255, v22, v30
v_mfma_f32_16x16x32_bf16 v[220:223], a[136:139], a[120:123], v[220:223]
s_add_u32 s22, s22, s23
ds_read_b128 a[60:63], v3 offset:14336
v_fmac_f32 v255, v23, v29
v_mfma_f32_16x16x32_bf16 v[220:223], a[140:143], a[124:127], v[220:223]
s_waitcnt lgkmcnt(3)
s_add_u32 s56, s22, 83886208
v_fmac_f32 v255, v24, v28
v_mul_f32 v255, v255, v247
v_mfma_f32_16x16x32_bf16 a[192:195], a[128:131], a[64:67], a[192:195]
s_cmp_lt_u32 s2, 224
ds_read_b64_tr_b16 a[136:137], v11 offset:32768
v_cvt_pk_bf16_f32 v246, v254, v255
v_accvgpr_write_b32 a191, v246
v_mfma_f32_16x16x32_bf16 a[192:195], a[132:135], a[68:71], a[192:195]
s_cselect_b32 s56, s56, 3221225472
v_mul_f32 v254, v22, v253
v_and_b32 v25, s58, v235
v_mfma_f32_16x16x32_bf16 a[200:203], a[128:131], a[72:75], a[200:203]
s_cmp_eq_u32 s38, 0
ds_read_b64_tr_b16 a[138:139], v11 offset:34816
v_and_b32 v247, s58, v244
v_mfma_f32_16x16x32_bf16 a[200:203], a[132:135], a[76:79], a[200:203]
s_cselect_b32 s57, s57, 3221225472
v_fmac_f32 v254, v23, v30
v_fmac_f32 v254, v24, v29
v_mfma_f32_16x16x32_bf16 a[208:211], a[128:131], a[80:83], a[208:211]
ds_read_b64_tr_b16 a[140:141], v11 offset:49152
v_fmac_f32 v254, v25, v28
v_mfma_f32_16x16x32_bf16 a[208:211], a[132:135], a[84:87], a[208:211]
v_mul_f32 v254, v254, v247
v_cvt_pk_bf16_f32 v246, v255, v254
v_accvgpr_write_b32 a187, v246
v_mfma_f32_16x16x32_bf16 a[216:219], a[128:131], a[88:91], a[216:219]
ds_read_b64_tr_b16 a[142:143], v11 offset:51200
v_mfma_f32_16x16x32_bf16 a[216:219], a[132:135], a[92:95], a[216:219]
ds_write_b128 v252, a[176:179] offset:0
v_mfma_f32_16x16x32_bf16 a[224:227], a[128:131], a[96:99], a[224:227]
v_mfma_f32_16x16x32_bf16 a[224:227], a[132:135], a[100:103], a[224:227]
ds_write_b128 v252, a[180:183] offset:8192
v_mfma_f32_16x16x32_bf16 a[232:235], a[128:131], a[104:107], a[232:235]
v_mfma_f32_16x16x32_bf16 a[232:235], a[132:135], a[108:111], a[232:235]
ds_write_b128 v252, a[184:187] offset:128
v_mfma_f32_16x16x32_bf16 a[240:243], a[128:131], a[112:115], a[240:243]
v_mfma_f32_16x16x32_bf16 a[240:243], a[132:135], a[116:119], a[240:243]
ds_write_b128 v252, a[188:191] offset:8320
v_mfma_f32_16x16x32_bf16 a[248:251], a[128:131], a[120:123], a[248:251]
s_waitcnt vmcnt(2) lgkmcnt(0)
v_mfma_f32_16x16x32_bf16 a[248:251], a[132:135], a[124:127], a[248:251]
s_barrier
v_mfma_f32_16x16x32_bf16 a[196:199], a[136:139], a[64:67], a[196:199]
s_add_u32 m0, s29, 98304
ds_read_b64_tr_b16 a[128:129], v4 offset:0
v_lshrrev_b32 v22, 8, v1
v_mfma_f32_16x16x32_bf16 a[196:199], a[140:143], a[68:71], a[196:199]
buffer_load_dwordx4 v16, s[12:15], s26 offen offset:0 lds
v_mfma_f32_16x16x32_bf16 a[204:207], a[136:139], a[72:75], a[204:207]
ds_read_b64_tr_b16 a[130:131], v4 offset:2048
v_lshlrev_b32 v22, 4, v22
v_mfma_f32_16x16x32_bf16 a[204:207], a[140:143], a[76:79], a[204:207]
v_xor_b32 v22, v22, v1
v_add_u32 v22, s29, v22
v_mfma_f32_16x16x32_bf16 a[212:215], a[136:139], a[80:83], a[212:215]
ds_read_b64_tr_b16 a[132:133], v4 offset:16384
v_add_u32 v22, 147456, v22
v_mfma_f32_16x16x32_bf16 a[212:215], a[140:143], a[84:87], a[212:215]
buffer_load_dwordx4 v17, s[12:15], s26 offen offset:1024 lds
v_mfma_f32_16x16x32_bf16 a[220:223], a[136:139], a[88:91], a[220:223]
ds_read_b64_tr_b16 a[134:135], v4 offset:18432
v_xor_b32 v23, 64, v22
v_mfma_f32_16x16x32_bf16 a[220:223], a[140:143], a[92:95], a[220:223]
v_lshrrev_b32 v224, 7, v1
v_mul_u32_u24 v224, 4224, v224
v_mfma_f32_16x16x32_bf16 a[228:231], a[136:139], a[96:99], a[228:231]
v_and_b32 v225, 0x70, v1
v_add_u32 v224, v224, v225
v_mfma_f32_16x16x32_bf16 a[228:231], a[140:143], a[100:103], a[228:231]
buffer_load_dwordx4 v18, s[12:15], s26 offen offset:2048 lds
v_mfma_f32_16x16x32_bf16 a[236:239], a[136:139], a[104:107], a[236:239]
v_bfe_u32 v225, v1, 4, 5
v_mul_u32_u24 v225, 4224, v225
v_mfma_f32_16x16x32_bf16 a[236:239], a[140:143], a[108:111], a[236:239]
v_mov_b32 v226, 0
v_mov_b32 v227, 0
v_mfma_f32_16x16x32_bf16 a[244:247], a[136:139], a[112:115], a[244:247]
v_mfma_f32_16x16x32_bf16 a[244:247], a[140:143], a[116:119], a[244:247]
buffer_load_dwordx4 v19, s[12:15], s26 offen offset:3072 lds
v_mfma_f32_16x16x32_bf16 a[252:255], a[136:139], a[120:123], a[252:255]
s_add_u32 s26, s26, 524288
v_mfma_f32_16x16x32_bf16 a[252:255], a[140:143], a[124:127], a[252:255]
s_waitcnt lgkmcnt(0)
v_mfma_f32_16x16x32_bf16 v[32:35], a[128:131], a[0:3], v[32:35]
s_add_u32 m0, s29, 114688
ds_read_b64_tr_b16 a[136:137], v5 offset:0
v_mfma_f32_16x16x32_bf16 v[32:35], a[132:135], a[4:7], v[32:35]
buffer_load_dwordx4 v16, s[12:15], s27 offen offset:0 lds
v_mfma_f32_16x16x32_bf16 v[40:43], a[128:131], a[8:11], v[40:43]
s_mul_i32 s52, s20, 7
ds_read_b64_tr_b16 a[138:139], v5 offset:2048
v_mfma_f32_16x16x32_bf16 v[40:43], a[132:135], a[12:15], v[40:43]
s_add_u32 s52, s52, s21
buffer_store_dwordx2 v[226:227], v225, s[4:7], s57 offen sc1
v_mfma_f32_16x16x32_bf16 v[48:51], a[128:131], a[16:19], v[48:51]
s_lshl_b32 s53, s52, 2
ds_read_b64_tr_b16 a[140:141], v5 offset:16384
v_mfma_f32_16x16x32_bf16 v[48:51], a[132:135], a[20:23], v[48:51]
s_add_u32 s53, s53, s3
buffer_load_dwordx4 v17, s[12:15], s27 offen offset:1024 lds
v_mfma_f32_16x16x32_bf16 v[56:59], a[128:131], a[24:27], v[56:59]
s_lshl_b32 s49, s53, 12
ds_read_b64_tr_b16 a[142:143], v5 offset:18432
v_mfma_f32_16x16x32_bf16 v[56:59], a[132:135], a[28:31], v[56:59]
s_mul_i32 s53, s53, 4224
v_mfma_f32_16x16x32_bf16 v[64:67], a[128:131], a[32:35], v[64:67]
s_add_u32 s53, s53, 83886080
ds_read_b128 a[64:67], v2 offset:32768
v_mfma_f32_16x16x32_bf16 v[64:67], a[132:135], a[36:39], v[64:67]
s_lshr_b32 s52, s52, 4
buffer_load_dwordx4 v18, s[12:15], s27 offen offset:2048 lds
v_mfma_f32_16x16x32_bf16 v[72:75], a[128:131], a[40:43], v[72:75]
s_min_u32 s52, s52, 6
ds_read_b128 a[68:71], v3 offset:32768
v_mfma_f32_16x16x32_bf16 v[72:75], a[132:135], a[44:47], v[72:75]
s_lshl_b32 s52, s52, 7
ds_read_b128 a[176:179], v22 offset:0
v_mfma_f32_16x16x32_bf16 v[80:83], a[128:131], a[48:51], v[80:83]
s_add_u32 s52, s52, 94392320
ds_read_b128 a[180:183], v23 offset:1024
v_mfma_f32_16x16x32_bf16 v[80:83], a[132:135], a[52:55], v[80:83]
buffer_load_dwordx4 v19, s[12:15], s27 offen offset:3072 lds
v_mfma_f32_16x16x32_bf16 v[88:91], a[128:131], a[56:59], v[88:91]
s_add_u32 s27, s27, 524288
ds_read_b128 a[72:75], v2 offset:34816
v_mfma_f32_16x16x32_bf16 v[88:91], a[132:135], a[60:63], v[88:91]
s_waitcnt lgkmcnt(5)
ds_read_b128 a[184:187], v22 offset:2048
v_mfma_f32_16x16x32_bf16 v[36:39], a[136:139], a[0:3], v[36:39]
s_add_u32 m0, s28, 0
ds_read_b64_tr_b16 a[128:129], v6 offset:0
v_mfma_f32_16x16x32_bf16 v[36:39], a[140:143], a[4:7], v[36:39]
buffer_load_dwordx4 v12, s[8:11], s24 offen offset:0 lds
v_mfma_f32_16x16x32_bf16 v[44:47], a[136:139], a[8:11], v[44:47]
PAD_3:
s_cbranch_execz M_tret
ds_read_b64_tr_b16 a[130:131], v6 offset:2048
v_mfma_f32_16x16x32_bf16 v[44:47], a[140:143], a[12:15], v[44:47]
ds_read_b128 a[188:191], v23 offset:3072
v_mfma_f32_16x16x32_bf16 v[52:55], a[136:139], a[16:19], v[52:55]
ds_read_b64_tr_b16 a[132:133], v6 offset:16384
v_bfe_u32 v231, v1, 4, 5
v_mfma_f32_16x16x32_bf16 v[52:55], a[140:143], a[20:23], v[52:55]
buffer_load_dwordx4 v13, s[8:11], s24 offen offset:1024 lds
v_mfma_f32_16x16x32_bf16 v[60:63], a[136:139], a[24:27], v[60:63]
ds_read_b64_tr_b16 a[134:135], v6 offset:18432
v_lshlrev_b32 v231, 2, v231
v_mfma_f32_16x16x32_bf16 v[60:63], a[140:143], a[28:31], v[60:63]
v_lshlrev_b32 v229, 3, v1
v_min_u32 v229, 4096, v229
v_mfma_f32_16x16x32_bf16 v[68:71], a[136:139], a[32:35], v[68:71]
ds_read_b128 a[76:79], v3 offset:34816
v_mfma_f32_16x16x32_bf16 v[68:71], a[140:143], a[36:39], v[68:71]
buffer_load_dwordx4 v14, s[8:11], s24 offen offset:2048 lds
v_mfma_f32_16x16x32_bf16 v[76:79], a[136:139], a[40:43], v[76:79]
v_mfma_f32_16x16x32_bf16 v[76:79], a[140:143], a[44:47], v[76:79]
v_mfma_f32_16x16x32_bf16 v[84:87], a[136:139], a[48:51], v[84:87]
ds_read_b128 a[80:83], v2 offset:36864
v_mfma_f32_16x16x32_bf16 v[84:87], a[140:143], a[52:55], v[84:87]
buffer_load_dwordx4 v15, s[8:11], s24 offen offset:3072 lds
v_mfma_f32_16x16x32_bf16 v[92:95], a[136:139], a[56:59], v[92:95]
s_add_u32 s24, s24, 128
ds_read_b128 a[84:87], v3 offset:36864
v_mfma_f32_16x16x32_bf16 v[92:95], a[140:143], a[60:63], v[92:95]
s_waitcnt lgkmcnt(3)
v_mfma_f32_16x16x32_bf16 v[96:99], a[128:131], a[0:3], v[96:99]
s_add_u32 m0, s28, 4096
ds_read_b64_tr_b16 a[136:137], v7 offset:0
v_mfma_f32_16x16x32_bf16 v[96:99], a[132:135], a[4:7], v[96:99]
buffer_load_dwordx4 v12, s[8:11], s25 offen offset:0 lds
v_mfma_f32_16x16x32_bf16 v[104:107], a[128:131], a[8:11], v[104:107]
ds_read_b64_tr_b16 a[138:139], v7 offset:2048
v_mfma_f32_16x16x32_bf16 v[104:107], a[132:135], a[12:15], v[104:107]
v_mfma_f32_16x16x32_bf16 v[112:115], a[128:131], a[16:19], v[112:115]
ds_read_b64_tr_b16 a[140:141], v7 offset:16384
v_mfma_f32_16x16x32_bf16 v[112:115], a[132:135], a[20:23], v[112:115]
buffer_load_dwordx4 v13, s[8:11], s25 offen offset:1024 lds
v_mfma_f32_16x16x32_bf16 v[120:123], a[128:131], a[24:27], v[120:123]
ds_read_b64_tr_b16 a[142:143], v7 offset:18432
v_mfma_f32_16x16x32_bf16 v[120:123], a[132:135], a[28:31], v[120:123]
v_mfma_f32_16x16x32_bf16 v[128:131], a[128:131], a[32:35], v[128:131]
v_mfma_f32_16x16x32_bf16 v[128:131], a[132:135], a[36:39], v[128:131]
buffer_load_dwordx4 v14, s[8:11], s25 offen offset:2048 lds
v_mfma_f32_16x16x32_bf16 v[136:139], a[128:131], a[40:43], v[136:139]
ds_read_b128 a[88:91], v2 offset:38912
v_mfma_f32_16x16x32_bf16 v[136:139], a[132:135], a[44:47], v[136:139]
v_mfma_f32_16x16x32_bf16 v[144:147], a[128:131], a[48:51], v[144:147]
ds_read_b128 a[92:95], v3 offset:38912
v_mfma_f32_16x16x32_bf16 v[144:147], a[132:135], a[52:55], v[144:147]
buffer_load_dwordx4 v15, s[8:11], s25 offen offset:3072 lds
v_mfma_f32_16x16x32_bf16 v[152:155], a[128:131], a[56:59], v[152:155]
s_add_u32 s25, s25, 128
v_mfma_f32_16x16x32_bf16 v[152:155], a[132:135], a[60:63], v[152:155]
s_waitcnt lgkmcnt(2)
v_mfma_f32_16x16x32_bf16 v[100:103], a[136:139], a[0:3], v[100:103]
ds_read_b64_tr_b16 a[128:129], v8 offset:0
v_mfma_f32_16x16x32_bf16 v[100:103], a[140:143], a[4:7], v[100:103]
buffer_store_dwordx4 a[176:179], v224, s[4:7], s56 offen sc1
v_mfma_f32_16x16x32_bf16 v[108:111], a[136:139], a[8:11], v[108:111]
s_add_u32 s56, s56, 33792
ds_read_b64_tr_b16 a[130:131], v8 offset:2048
v_mfma_f32_16x16x32_bf16 v[108:111], a[140:143], a[12:15], v[108:111]
v_mfma_f32_16x16x32_bf16 v[116:119], a[136:139], a[16:19], v[116:119]
ds_read_b64_tr_b16 a[132:133], v8 offset:16384
v_mfma_f32_16x16x32_bf16 v[116:119], a[140:143], a[20:23], v[116:119]
v_mfma_f32_16x16x32_bf16 v[124:127], a[136:139], a[24:27], v[124:127]
s_cmp_lt_u32 s21, 0
ds_read_b64_tr_b16 a[134:135], v8 offset:18432
v_mfma_f32_16x16x32_bf16 v[124:127], a[140:143], a[28:31], v[124:127]
s_cselect_b32 s53, s53, 3221225472
v_mfma_f32_16x16x32_bf16 v[132:135], a[136:139], a[32:35], v[132:135]
s_cselect_b32 s49, s49, 3221225472
ds_read_b128 a[96:99], v2 offset:40960
v_mfma_f32_16x16x32_bf16 v[132:135], a[140:143], a[36:39], v[132:135]
s_add_u32 s48, s53, 2097152
v_mfma_f32_16x16x32_bf16 v[140:143], a[136:139], a[40:43], v[140:143]
v_mfma_f32_16x16x32_bf16 v[140:143], a[140:143], a[44:47], v[140:143]
v_mfma_f32_16x16x32_bf16 v[148:151], a[136:139], a[48:51], v[148:151]
ds_read_b128 a[100:103], v3 offset:40960
v_mfma_f32_16x16x32_bf16 v[148:151], a[140:143], a[52:55], v[148:151]
v_mfma_f32_16x16x32_bf16 v[156:159], a[136:139], a[56:59], v[156:159]
ds_read_b128 a[104:107], v2 offset:43008
v_mfma_f32_16x16x32_bf16 v[156:159], a[140:143], a[60:63], v[156:159]
s_waitcnt lgkmcnt(3)
v_mfma_f32_16x16x32_bf16 v[160:163], a[128:131], a[0:3], v[160:163]
ds_read_b64_tr_b16 a[136:137], v9 offset:0
v_mfma_f32_16x16x32_bf16 v[160:163], a[132:135], a[4:7], v[160:163]
v_mfma_f32_16x16x32_bf16 v[168:171], a[128:131], a[8:11], v[168:171]
ds_read_b64_tr_b16 a[138:139], v9 offset:2048
v_mfma_f32_16x16x32_bf16 v[168:171], a[132:135], a[12:15], v[168:171]
buffer_store_dwordx4 a[180:183], v224, s[4:7], s56 offen sc1
v_mfma_f32_16x16x32_bf16 v[176:179], a[128:131], a[16:19], v[176:179]
s_add_u32 s56, s56, 33792
ds_read_b64_tr_b16 a[140:141], v9 offset:16384
v_mfma_f32_16x16x32_bf16 v[176:179], a[132:135], a[20:23], v[176:179]
v_mfma_f32_16x16x32_bf16 v[184:187], a[128:131], a[24:27], v[184:187]
ds_read_b64_tr_b16 a[142:143], v9 offset:18432
v_mfma_f32_16x16x32_bf16 v[184:187], a[132:135], a[28:31], v[184:187]
v_mfma_f32_16x16x32_bf16 v[192:195], a[128:131], a[32:35], v[192:195]
v_mfma_f32_16x16x32_bf16 v[192:195], a[132:135], a[36:39], v[192:195]
v_mfma_f32_16x16x32_bf16 v[200:203], a[128:131], a[40:43], v[200:203]
ds_read_b128 a[108:111], v3 offset:43008
v_mfma_f32_16x16x32_bf16 v[200:203], a[132:135], a[44:47], v[200:203]
v_mfma_f32_16x16x32_bf16 v[208:211], a[128:131], a[48:51], v[208:211]
ds_read_b128 a[112:115], v2 offset:45056
v_mfma_f32_16x16x32_bf16 v[208:211], a[132:135], a[52:55], v[208:211]
v_mfma_f32_16x16x32_bf16 v[216:219], a[128:131], a[56:59], v[216:219]
v_mfma_f32_16x16x32_bf16 v[216:219], a[132:135], a[60:63], v[216:219]
s_waitcnt lgkmcnt(2)
v_mfma_f32_16x16x32_bf16 v[164:167], a[136:139], a[0:3], v[164:167]
ds_read_b64_tr_b16 a[128:129], v10 offset:0
v_mfma_f32_16x16x32_bf16 v[164:167], a[140:143], a[4:7], v[164:167]
v_mfma_f32_16x16x32_bf16 v[172:175], a[136:139], a[8:11], v[172:175]
ds_read_b64_tr_b16 a[130:131], v10 offset:2048
v_mfma_f32_16x16x32_bf16 v[172:175], a[140:143], a[12:15], v[172:175]
v_mfma_f32_16x16x32_bf16 v[180:183], a[136:139], a[16:19], v[180:183]
ds_read_b64_tr_b16 a[132:133], v10 offset:16384
v_mfma_f32_16x16x32_bf16 v[180:183], a[140:143], a[20:23], v[180:183]
buffer_store_dwordx4 a[184:187], v224, s[4:7], s56 offen sc1
v_mfma_f32_16x16x32_bf16 v[188:191], a[136:139], a[24:27], v[188:191]
s_add_u32 s56, s56, 33792
ds_read_b64_tr_b16 a[134:135], v10 offset:18432
v_mfma_f32_16x16x32_bf16 v[188:191], a[140:143], a[28:31], v[188:191]
v_mfma_f32_16x16x32_bf16 v[196:199], a[136:139], a[32:35], v[196:199]
ds_read_b128 a[116:119], v3 offset:45056
v_mfma_f32_16x16x32_bf16 v[196:199], a[140:143], a[36:39], v[196:199]
v_mfma_f32_16x16x32_bf16 v[204:207], a[136:139], a[40:43], v[204:207]
ds_read_b128 a[120:123], v2 offset:47104
v_mfma_f32_16x16x32_bf16 v[204:207], a[140:143], a[44:47], v[204:207]
v_mfma_f32_16x16x32_bf16 v[212:215], a[136:139], a[48:51], v[212:215]
v_mfma_f32_16x16x32_bf16 v[212:215], a[140:143], a[52:55], v[212:215]
v_mfma_f32_16x16x32_bf16 v[220:223], a[136:139], a[56:59], v[220:223]
ds_read_b128 a[124:127], v3 offset:47104
v_mfma_f32_16x16x32_bf16 v[220:223], a[140:143], a[60:63], v[220:223]
s_waitcnt lgkmcnt(3)
v_mfma_f32_16x16x32_bf16 a[192:195], a[128:131], a[0:3], a[192:195]
ds_read_b64_tr_b16 a[136:137], v11 offset:0
v_mfma_f32_16x16x32_bf16 a[192:195], a[132:135], a[4:7], a[192:195]
v_mfma_f32_16x16x32_bf16 a[200:203], a[128:131], a[8:11], a[200:203]
ds_read_b64_tr_b16 a[138:139], v11 offset:2048
v_mfma_f32_16x16x32_bf16 a[200:203], a[132:135], a[12:15], a[200:203]
v_mfma_f32_16x16x32_bf16 a[208:211], a[128:131], a[16:19], a[208:211]
ds_read_b64_tr_b16 a[140:141], v11 offset:16384
v_mfma_f32_16x16x32_bf16 a[208:211], a[132:135], a[20:23], a[208:211]
v_mfma_f32_16x16x32_bf16 a[216:219], a[128:131], a[24:27], a[216:219]
ds_read_b64_tr_b16 a[142:143], v11 offset:18432
v_mfma_f32_16x16x32_bf16 a[216:219], a[132:135], a[28:31], a[216:219]
buffer_store_dwordx4 a[188:191], v224, s[4:7], s56 offen sc1
v_mfma_f32_16x16x32_bf16 a[224:227], a[128:131], a[32:35], a[224:227]
s_add_u32 s56, s56, 33792
v_mfma_f32_16x16x32_bf16 a[224:227], a[132:135], a[36:39], a[224:227]
v_mfma_f32_16x16x32_bf16 a[232:235], a[128:131], a[40:43], a[232:235]
v_mfma_f32_16x16x32_bf16 a[232:235], a[132:135], a[44:47], a[232:235]
v_mfma_f32_16x16x32_bf16 a[240:243], a[128:131], a[48:51], a[240:243]
v_mfma_f32_16x16x32_bf16 a[240:243], a[132:135], a[52:55], a[240:243]
v_mfma_f32_16x16x32_bf16 a[248:251], a[128:131], a[56:59], a[248:251]
s_waitcnt vmcnt(4) lgkmcnt(0)
v_mfma_f32_16x16x32_bf16 a[248:251], a[132:135], a[60:63], a[248:251]
s_barrier
v_mfma_f32_16x16x32_bf16 a[196:199], a[136:139], a[0:3], a[196:199]
s_add_u32 m0, s29, 65536
ds_read_b64_tr_b16 a[128:129], v4 offset:32768
v_mfma_f32_16x16x32_bf16 a[196:199], a[140:143], a[4:7], a[196:199]
buffer_load_dwordx4 v16, s[12:15], s26 offen offset:0 lds
v_mfma_f32_16x16x32_bf16 a[204:207], a[136:139], a[8:11], a[204:207]
ds_read_b64_tr_b16 a[130:131], v4 offset:34816
v_cmp_gt_u32 vcc, 0x100, v245
v_mfma_f32_16x16x32_bf16 a[204:207], a[140:143], a[12:15], a[204:207]
v_mfma_f32_16x16x32_bf16 a[212:215], a[136:139], a[16:19], a[212:215]
ds_read_b64_tr_b16 a[132:133], v4 offset:49152
v_mfma_f32_16x16x32_bf16 a[212:215], a[140:143], a[20:23], a[212:215]
buffer_load_dwordx4 v17, s[12:15], s26 offen offset:1024 lds
v_mfma_f32_16x16x32_bf16 a[220:223], a[136:139], a[24:27], a[220:223]
ds_read_b64_tr_b16 a[134:135], v4 offset:51200
v_mfma_f32_16x16x32_bf16 a[220:223], a[140:143], a[28:31], a[220:223]
v_mfma_f32_16x16x32_bf16 a[228:231], a[136:139], a[32:35], a[228:231]
v_mfma_f32_16x16x32_bf16 a[228:231], a[140:143], a[36:39], a[228:231]
buffer_load_dwordx4 v18, s[12:15], s26 offen offset:2048 lds
v_mfma_f32_16x16x32_bf16 a[236:239], a[136:139], a[40:43], a[236:239]
v_mfma_f32_16x16x32_bf16 a[236:239], a[140:143], a[44:47], a[236:239]
v_mfma_f32_16x16x32_bf16 a[244:247], a[136:139], a[48:51], a[244:247]
v_mfma_f32_16x16x32_bf16 a[244:247], a[140:143], a[52:55], a[244:247]
buffer_load_dwordx4 v19, s[12:15], s26 offen offset:3072 lds
v_mfma_f32_16x16x32_bf16 a[252:255], a[136:139], a[56:59], a[252:255]
s_add_u32 s26, s26, 524288
v_mfma_f32_16x16x32_bf16 a[252:255], a[140:143], a[60:63], a[252:255]
s_waitcnt lgkmcnt(0)
s_mov_b32 s82, s59
s_cbranch_vccnz M_cntspinK
s_branch Lg_1
Lg_1t:
PAD_4:
s_cbranch_execz M_tret
buffer_load_dword v230, v231, s[4:7], s52 offen sc1
v_mfma_f32_16x16x32_bf16 v[32:35], a[128:131], a[64:67], v[32:35]
s_add_u32 m0, s29, 81920
ds_read_b64_tr_b16 a[136:137], v5 offset:32768
v_mfma_f32_16x16x32_bf16 v[32:35], a[132:135], a[68:71], v[32:35]
buffer_load_dwordx4 v16, s[12:15], s27 offen offset:0 lds
v_mfma_f32_16x16x32_bf16 v[40:43], a[128:131], a[72:75], v[40:43]
s_and_b32 s44, s3, 1
ds_read_b64_tr_b16 a[138:139], v5 offset:34816
v_mfma_f32_16x16x32_bf16 v[40:43], a[132:135], a[76:79], v[40:43]
s_lshl_b32 s44, s44, 8
v_mfma_f32_16x16x32_bf16 v[48:51], a[128:131], a[80:83], v[48:51]
s_lshl_b32 s45, s3, 7
ds_read_b64_tr_b16 a[140:141], v5 offset:49152
v_mfma_f32_16x16x32_bf16 v[48:51], a[132:135], a[84:87], v[48:51]
s_xor_b32 s44, s44, s45
buffer_load_dwordx4 v17, s[12:15], s27 offen offset:1024 lds
v_mfma_f32_16x16x32_bf16 v[56:59], a[128:131], a[88:91], v[56:59]
s_xor_b32 s44, s44, 196608
ds_read_b64_tr_b16 a[142:143], v5 offset:51200
v_mfma_f32_16x16x32_bf16 v[56:59], a[132:135], a[92:95], v[56:59]
v_mfma_f32_16x16x32_bf16 v[64:67], a[128:131], a[96:99], v[64:67]
ds_read_b128 a[0:3], v2 offset:0
v_mfma_f32_16x16x32_bf16 v[64:67], a[132:135], a[100:103], v[64:67]
buffer_load_dwordx4 v18, s[12:15], s27 offen offset:2048 lds
v_mfma_f32_16x16x32_bf16 v[72:75], a[128:131], a[104:107], v[72:75]
ds_read_b128 a[4:7], v3 offset:0
v_mfma_f32_16x16x32_bf16 v[72:75], a[132:135], a[108:111], v[72:75]
v_mfma_f32_16x16x32_bf16 v[80:83], a[128:131], a[112:115], v[80:83]
v_mfma_f32_16x16x32_bf16 v[80:83], a[132:135], a[116:119], v[80:83]
buffer_load_dwordx4 v19, s[12:15], s27 offen offset:3072 lds
v_mfma_f32_16x16x32_bf16 v[88:91], a[128:131], a[120:123], v[88:91]
s_add_u32 s27, s27, 524288
ds_read_b128 a[8:11], v2 offset:2048
v_mfma_f32_16x16x32_bf16 v[88:91], a[132:135], a[124:127], v[88:91]
s_waitcnt lgkmcnt(3)
v_mfma_f32_16x16x32_bf16 v[36:39], a[136:139], a[64:67], v[36:39]
s_add_u32 m0, s28, 32768
ds_read_b64_tr_b16 a[128:129], v6 offset:32768
v_mfma_f32_16x16x32_bf16 v[36:39], a[140:143], a[68:71], v[36:39]
buffer_load_dwordx4 v12, s[8:11], s24 offen offset:0 lds
v_mfma_f32_16x16x32_bf16 v[44:47], a[136:139], a[72:75], v[44:47]
ds_read_b64_tr_b16 a[130:131], v6 offset:34816
v_mfma_f32_16x16x32_bf16 v[44:47], a[140:143], a[76:79], v[44:47]
v_mfma_f32_16x16x32_bf16 v[52:55], a[136:139], a[80:83], v[52:55]
s_mov_b64 s[56:57], s[72:73]
ds_read_b64_tr_b16 a[132:133], v6 offset:49152
v_mfma_f32_16x16x32_bf16 v[52:55], a[140:143], a[84:87], v[52:55]
s_mov_b32 s58, 1835008
buffer_load_dwordx4 v13, s[8:11], s24 offen offset:1024 lds
v_mfma_f32_16x16x32_bf16 v[60:63], a[136:139], a[88:91], v[60:63]
s_mov_b32 s59, 0x20000
ds_read_b64_tr_b16 a[134:135], v6 offset:51200
v_mfma_f32_16x16x32_bf16 v[60:63], a[140:143], a[92:95], v[60:63]
v_mfma_f32_16x16x32_bf16 v[68:71], a[136:139], a[96:99], v[68:71]
ds_read_b128 a[12:15], v3 offset:2048
v_mfma_f32_16x16x32_bf16 v[68:71], a[140:143], a[100:103], v[68:71]
buffer_load_dwordx4 v14, s[8:11], s24 offen offset:2048 lds
v_mfma_f32_16x16x32_bf16 v[76:79], a[136:139], a[104:107], v[76:79]
v_mfma_f32_16x16x32_bf16 v[76:79], a[140:143], a[108:111], v[76:79]
v_mfma_f32_16x16x32_bf16 v[84:87], a[136:139], a[112:115], v[84:87]
ds_read_b128 a[16:19], v2 offset:4096
v_mfma_f32_16x16x32_bf16 v[84:87], a[140:143], a[116:119], v[84:87]
buffer_load_dwordx4 v15, s[8:11], s24 offen offset:3072 lds
v_mfma_f32_16x16x32_bf16 v[92:95], a[136:139], a[120:123], v[92:95]
s_add_u32 s24, s24, 128
ds_read_b128 a[20:23], v3 offset:4096
v_mfma_f32_16x16x32_bf16 v[92:95], a[140:143], a[124:127], v[92:95]
s_waitcnt lgkmcnt(3)
v_mfma_f32_16x16x32_bf16 v[96:99], a[128:131], a[64:67], v[96:99]
s_add_u32 m0, s28, 36864
ds_read_b64_tr_b16 a[136:137], v7 offset:32768
v_mfma_f32_16x16x32_bf16 v[96:99], a[132:135], a[68:71], v[96:99]
buffer_load_dwordx4 v12, s[8:11], s25 offen offset:0 lds
v_mfma_f32_16x16x32_bf16 v[104:107], a[128:131], a[72:75], v[104:107]
ds_read_b64_tr_b16 a[138:139], v7 offset:34816
v_mfma_f32_16x16x32_bf16 v[104:107], a[132:135], a[76:79], v[104:107]
v_mfma_f32_16x16x32_bf16 v[112:115], a[128:131], a[80:83], v[112:115]
ds_read_b64_tr_b16 a[140:141], v7 offset:49152
v_mfma_f32_16x16x32_bf16 v[112:115], a[132:135], a[84:87], v[112:115]
buffer_load_dwordx4 v13, s[8:11], s25 offen offset:1024 lds
v_mfma_f32_16x16x32_bf16 v[120:123], a[128:131], a[88:91], v[120:123]
ds_read_b64_tr_b16 a[142:143], v7 offset:51200
v_mfma_f32_16x16x32_bf16 v[120:123], a[132:135], a[92:95], v[120:123]
v_mfma_f32_16x16x32_bf16 v[128:131], a[128:131], a[96:99], v[128:131]
v_mfma_f32_16x16x32_bf16 v[128:131], a[132:135], a[100:103], v[128:131]
buffer_load_dwordx4 v14, s[8:11], s25 offen offset:2048 lds
v_mfma_f32_16x16x32_bf16 v[136:139], a[128:131], a[104:107], v[136:139]
ds_read_b128 a[24:27], v2 offset:6144
v_mfma_f32_16x16x32_bf16 v[136:139], a[132:135], a[108:111], v[136:139]
v_mfma_f32_16x16x32_bf16 v[144:147], a[128:131], a[112:115], v[144:147]
ds_read_b128 a[28:31], v3 offset:6144
v_mfma_f32_16x16x32_bf16 v[144:147], a[132:135], a[116:119], v[144:147]
buffer_load_dwordx4 v15, s[8:11], s25 offen offset:3072 lds
v_mfma_f32_16x16x32_bf16 v[152:155], a[128:131], a[120:123], v[152:155]
s_add_u32 s25, s25, 128
s_waitcnt vmcnt(12)
v_mfma_f32_16x16x32_bf16 v[152:155], a[132:135], a[124:127], v[152:155]
s_waitcnt lgkmcnt(2)
v_cmp_gt_u32 vcc, 1, v230
v_mfma_f32_16x16x32_bf16 v[100:103], a[136:139], a[64:67], v[100:103]
s_cbranch_vccnz M_ppspinK
M_ppokK:
ds_read_b64_tr_b16 a[128:129], v8 offset:32768
v_mfma_f32_16x16x32_bf16 v[100:103], a[140:143], a[68:71], v[100:103]
buffer_load_dword v230, v229, s[4:7], s53 offen sc1
v_mfma_f32_16x16x32_bf16 v[108:111], a[136:139], a[72:75], v[108:111]
s_mov_b64 s[8:9], s[76:77]
ds_read_b64_tr_b16 a[130:131], v8 offset:34816
v_mfma_f32_16x16x32_bf16 v[108:111], a[140:143], a[76:79], v[108:111]
s_mov_b32 s10, 1835008
buffer_load_dword v230, v229, s[4:7], s48 offen sc1
v_mfma_f32_16x16x32_bf16 v[116:119], a[136:139], a[80:83], v[116:119]
s_lshl_b32 s24, s37, 2
ds_read_b64_tr_b16 a[132:133], v8 offset:49152
v_mfma_f32_16x16x32_bf16 v[116:119], a[140:143], a[84:87], v[116:119]
s_add_u32 s24, s24, s3
buffer_load_dword v230, v229, s[56:59], s49 offen
v_mfma_f32_16x16x32_bf16 v[124:127], a[136:139], a[88:91], v[124:127]
s_mul_i32 s24, s24, 28672
ds_read_b64_tr_b16 a[134:135], v8 offset:51200
v_mfma_f32_16x16x32_bf16 v[124:127], a[140:143], a[92:95], v[124:127]
s_mov_b32 s28, s29
buffer_load_dword v21, v20, s[16:19], s43 offen
v_mfma_f32_16x16x32_bf16 v[132:135], a[136:139], a[96:99], v[132:135]
ds_read_b128 a[32:35], v2 offset:8192
v_mfma_f32_16x16x32_bf16 v[132:135], a[140:143], a[100:103], v[132:135]
v_mfma_f32_16x16x32_bf16 v[140:143], a[136:139], a[104:107], v[140:143]
v_mfma_f32_16x16x32_bf16 v[140:143], a[140:143], a[108:111], v[140:143]
v_mfma_f32_16x16x32_bf16 v[148:151], a[136:139], a[112:115], v[148:151]
ds_read_b128 a[36:39], v3 offset:8192
v_lshrrev_b32 v28, 7, v1
v_mfma_f32_16x16x32_bf16 v[148:151], a[140:143], a[116:119], v[148:151]
v_lshrrev_b32 v29, 1, v28
v_lshlrev_b32 v29, 4, v29
v_mfma_f32_16x16x32_bf16 v[156:159], a[136:139], a[120:123], v[156:159]
ds_read_b128 a[40:43], v2 offset:10240
v_and_b32 v30, 0x70, v1
v_mfma_f32_16x16x32_bf16 v[156:159], a[140:143], a[124:127], v[156:159]
s_waitcnt lgkmcnt(3)
v_xor_b32 v29, v29, v30
v_mul_u32_u24 v28, 896, v28
v_mfma_f32_16x16x32_bf16 v[160:163], a[128:131], a[64:67], v[160:163]
ds_read_b64_tr_b16 a[136:137], v9 offset:32768
v_add_u32 v12, v28, v29
v_mfma_f32_16x16x32_bf16 v[160:163], a[132:135], a[68:71], v[160:163]
v_xor_b32 v29, 64, v29
v_add_u32 v28, v28, v29
v_mfma_f32_16x16x32_bf16 v[168:171], a[128:131], a[72:75], v[168:171]
ds_read_b64_tr_b16 a[138:139], v9 offset:34816
v_add_u32 v13, 6144, v28
v_mfma_f32_16x16x32_bf16 v[168:171], a[132:135], a[76:79], v[168:171]
v_add_u32 v14, 12288, v12
v_add_u32 v15, 18432, v28
v_mfma_f32_16x16x32_bf16 v[176:179], a[128:131], a[80:83], v[176:179]
ds_read_b64_tr_b16 a[140:141], v9 offset:49152
v_xor_b32 v22, s44, v4
v_mfma_f32_16x16x32_bf16 v[176:179], a[132:135], a[84:87], v[176:179]
v_xor_b32 v23, 32, v22
v_xor_b32 v24, 64, v22
v_mfma_f32_16x16x32_bf16 v[184:187], a[128:131], a[88:91], v[184:187]
ds_read_b64_tr_b16 a[142:143], v9 offset:51200
v_xor_b32 v25, 96, v22
v_mfma_f32_16x16x32_bf16 v[184:187], a[132:135], a[92:95], v[184:187]
v_mfma_f32_16x16x32_bf16 v[192:195], a[128:131], a[96:99], v[192:195]
v_mfma_f32_16x16x32_bf16 v[192:195], a[132:135], a[100:103], v[192:195]
v_mfma_f32_16x16x32_bf16 v[200:203], a[128:131], a[104:107], v[200:203]
ds_read_b128 a[44:47], v3 offset:10240
v_mfma_f32_16x16x32_bf16 v[200:203], a[132:135], a[108:111], v[200:203]
v_mfma_f32_16x16x32_bf16 v[208:211], a[128:131], a[112:115], v[208:211]
ds_read_b128 a[48:51], v2 offset:12288
v_mfma_f32_16x16x32_bf16 v[208:211], a[132:135], a[116:119], v[208:211]
v_mfma_f32_16x16x32_bf16 v[216:219], a[128:131], a[120:123], v[216:219]
v_mfma_f32_16x16x32_bf16 v[216:219], a[132:135], a[124:127], v[216:219]
s_waitcnt lgkmcnt(2)
v_mfma_f32_16x16x32_bf16 v[164:167], a[136:139], a[64:67], v[164:167]
ds_read_b64_tr_b16 a[128:129], v10 offset:32768
v_mfma_f32_16x16x32_bf16 v[164:167], a[140:143], a[68:71], v[164:167]
v_mfma_f32_16x16x32_bf16 v[172:175], a[136:139], a[72:75], v[172:175]
ds_read_b64_tr_b16 a[130:131], v10 offset:34816
v_mfma_f32_16x16x32_bf16 v[172:175], a[140:143], a[76:79], v[172:175]
v_mfma_f32_16x16x32_bf16 v[180:183], a[136:139], a[80:83], v[180:183]
ds_read_b64_tr_b16 a[132:133], v10 offset:49152
v_mfma_f32_16x16x32_bf16 v[180:183], a[140:143], a[84:87], v[180:183]
v_mfma_f32_16x16x32_bf16 v[188:191], a[136:139], a[88:91], v[188:191]
ds_read_b64_tr_b16 a[134:135], v10 offset:51200
v_mfma_f32_16x16x32_bf16 v[188:191], a[140:143], a[92:95], v[188:191]
v_mfma_f32_16x16x32_bf16 v[196:199], a[136:139], a[96:99], v[196:199]
ds_read_b128 a[52:55], v3 offset:12288
v_mfma_f32_16x16x32_bf16 v[196:199], a[140:143], a[100:103], v[196:199]
v_mfma_f32_16x16x32_bf16 v[204:207], a[136:139], a[104:107], v[204:207]
ds_read_b128 a[56:59], v2 offset:14336
v_mfma_f32_16x16x32_bf16 v[204:207], a[140:143], a[108:111], v[204:207]
v_mfma_f32_16x16x32_bf16 v[212:215], a[136:139], a[112:115], v[212:215]
v_mfma_f32_16x16x32_bf16 v[212:215], a[140:143], a[116:119], v[212:215]
v_mfma_f32_16x16x32_bf16 v[220:223], a[136:139], a[120:123], v[220:223]
ds_read_b128 a[60:63], v3 offset:14336
v_mfma_f32_16x16x32_bf16 v[220:223], a[140:143], a[124:127], v[220:223]
s_waitcnt lgkmcnt(3)
v_mfma_f32_16x16x32_bf16 a[192:195], a[128:131], a[64:67], a[192:195]
ds_read_b64_tr_b16 a[136:137], v11 offset:32768
v_mfma_f32_16x16x32_bf16 a[192:195], a[132:135], a[68:71], a[192:195]
v_mfma_f32_16x16x32_bf16 a[200:203], a[128:131], a[72:75], a[200:203]
ds_read_b64_tr_b16 a[138:139], v11 offset:34816
v_mfma_f32_16x16x32_bf16 a[200:203], a[132:135], a[76:79], a[200:203]
v_mfma_f32_16x16x32_bf16 a[208:211], a[128:131], a[80:83], a[208:211]
ds_read_b64_tr_b16 a[140:141], v11 offset:49152
v_mfma_f32_16x16x32_bf16 a[208:211], a[132:135], a[84:87], a[208:211]
v_mfma_f32_16x16x32_bf16 a[216:219], a[128:131], a[88:91], a[216:219]
ds_read_b64_tr_b16 a[142:143], v11 offset:51200
v_mfma_f32_16x16x32_bf16 a[216:219], a[132:135], a[92:95], a[216:219]
v_mfma_f32_16x16x32_bf16 a[224:227], a[128:131], a[96:99], a[224:227]
v_mfma_f32_16x16x32_bf16 a[224:227], a[132:135], a[100:103], a[224:227]
v_mfma_f32_16x16x32_bf16 a[232:235], a[128:131], a[104:107], a[232:235]
v_mfma_f32_16x16x32_bf16 a[232:235], a[132:135], a[108:111], a[232:235]
v_mfma_f32_16x16x32_bf16 a[240:243], a[128:131], a[112:115], a[240:243]
v_mfma_f32_16x16x32_bf16 a[240:243], a[132:135], a[116:119], a[240:243]
v_mfma_f32_16x16x32_bf16 a[248:251], a[128:131], a[120:123], a[248:251]
s_waitcnt vmcnt(4) lgkmcnt(0)
v_mfma_f32_16x16x32_bf16 a[248:251], a[132:135], a[124:127], a[248:251]
s_barrier
v_mfma_f32_16x16x32_bf16 a[196:199], a[136:139], a[64:67], a[196:199]
s_add_u32 m0, s29, 98304
ds_read_b64_tr_b16 a[128:129], v4 offset:0
v_mfma_f32_16x16x32_bf16 a[196:199], a[140:143], a[68:71], a[196:199]
buffer_load_dwordx4 v16, s[12:15], s26 offen offset:0 lds
v_mfma_f32_16x16x32_bf16 a[204:207], a[136:139], a[72:75], a[204:207]
ds_read_b64_tr_b16 a[130:131], v4 offset:2048
v_mfma_f32_16x16x32_bf16 a[204:207], a[140:143], a[76:79], a[204:207]
v_mfma_f32_16x16x32_bf16 a[212:215], a[136:139], a[80:83], a[212:215]
ds_read_b64_tr_b16 a[132:133], v4 offset:16384
v_mfma_f32_16x16x32_bf16 a[212:215], a[140:143], a[84:87], a[212:215]
buffer_load_dwordx4 v17, s[12:15], s26 offen offset:1024 lds
v_mfma_f32_16x16x32_bf16 a[220:223], a[136:139], a[88:91], a[220:223]
ds_read_b64_tr_b16 a[134:135], v4 offset:18432
v_mfma_f32_16x16x32_bf16 a[220:223], a[140:143], a[92:95], a[220:223]
v_mfma_f32_16x16x32_bf16 a[228:231], a[136:139], a[96:99], a[228:231]
v_mfma_f32_16x16x32_bf16 a[228:231], a[140:143], a[100:103], a[228:231]
buffer_load_dwordx4 v18, s[12:15], s26 offen offset:2048 lds
v_mfma_f32_16x16x32_bf16 a[236:239], a[136:139], a[104:107], a[236:239]
v_mfma_f32_16x16x32_bf16 a[236:239], a[140:143], a[108:111], a[236:239]
v_mfma_f32_16x16x32_bf16 a[244:247], a[136:139], a[112:115], a[244:247]
v_mfma_f32_16x16x32_bf16 a[244:247], a[140:143], a[116:119], a[244:247]
buffer_load_dwordx4 v19, s[12:15], s26 offen offset:3072 lds
v_mfma_f32_16x16x32_bf16 a[252:255], a[136:139], a[120:123], a[252:255]
s_add_u32 s26, s26, 524288
v_mfma_f32_16x16x32_bf16 a[252:255], a[140:143], a[124:127], a[252:255]
s_waitcnt lgkmcnt(0)
v_mfma_f32_16x16x32_bf16 v[32:35], a[128:131], a[0:3], v[32:35]
s_add_u32 m0, s29, 114688
ds_read_b64_tr_b16 a[136:137], v5 offset:0
v_mfma_f32_16x16x32_bf16 v[32:35], a[132:135], a[4:7], v[32:35]
buffer_load_dwordx4 v16, s[12:15], s27 offen offset:0 lds
v_mfma_f32_16x16x32_bf16 v[40:43], a[128:131], a[8:11], v[40:43]
ds_read_b64_tr_b16 a[138:139], v5 offset:2048
v_mfma_f32_16x16x32_bf16 v[40:43], a[132:135], a[12:15], v[40:43]
v_mfma_f32_16x16x32_bf16 v[48:51], a[128:131], a[16:19], v[48:51]
ds_read_b64_tr_b16 a[140:141], v5 offset:16384
v_mfma_f32_16x16x32_bf16 v[48:51], a[132:135], a[20:23], v[48:51]
buffer_load_dwordx4 v17, s[12:15], s27 offen offset:1024 lds
v_mfma_f32_16x16x32_bf16 v[56:59], a[128:131], a[24:27], v[56:59]
ds_read_b64_tr_b16 a[142:143], v5 offset:18432
v_mfma_f32_16x16x32_bf16 v[56:59], a[132:135], a[28:31], v[56:59]
v_mfma_f32_16x16x32_bf16 v[64:67], a[128:131], a[32:35], v[64:67]
ds_read_b128 a[64:67], v2 offset:32768
v_mfma_f32_16x16x32_bf16 v[64:67], a[132:135], a[36:39], v[64:67]
buffer_load_dwordx4 v18, s[12:15], s27 offen offset:2048 lds
v_mfma_f32_16x16x32_bf16 v[72:75], a[128:131], a[40:43], v[72:75]
ds_read_b128 a[68:71], v3 offset:32768
v_mfma_f32_16x16x32_bf16 v[72:75], a[132:135], a[44:47], v[72:75]
v_mfma_f32_16x16x32_bf16 v[80:83], a[128:131], a[48:51], v[80:83]
v_mfma_f32_16x16x32_bf16 v[80:83], a[132:135], a[52:55], v[80:83]
buffer_load_dwordx4 v19, s[12:15], s27 offen offset:3072 lds
v_mfma_f32_16x16x32_bf16 v[88:91], a[128:131], a[56:59], v[88:91]
s_add_u32 s27, s27, 524288
ds_read_b128 a[72:75], v2 offset:34816
v_mfma_f32_16x16x32_bf16 v[88:91], a[132:135], a[60:63], v[88:91]
s_waitcnt lgkmcnt(3)
v_mfma_f32_16x16x32_bf16 v[36:39], a[136:139], a[0:3], v[36:39]
s_add_u32 m0, s28, 0
ds_read_b64_tr_b16 a[128:129], v6 offset:0
v_mfma_f32_16x16x32_bf16 v[36:39], a[140:143], a[4:7], v[36:39]
buffer_load_dwordx4 v12, s[8:11], s24 offen offset:0 lds
v_mfma_f32_16x16x32_bf16 v[44:47], a[136:139], a[8:11], v[44:47]
ds_read_b64_tr_b16 a[130:131], v6 offset:2048
v_mfma_f32_16x16x32_bf16 v[44:47], a[140:143], a[12:15], v[44:47]
v_mfma_f32_16x16x32_bf16 v[52:55], a[136:139], a[16:19], v[52:55]
ds_read_b64_tr_b16 a[132:133], v6 offset:16384
v_mfma_f32_16x16x32_bf16 v[52:55], a[140:143], a[20:23], v[52:55]
buffer_load_dwordx4 v13, s[8:11], s24 offen offset:1024 lds
v_mfma_f32_16x16x32_bf16 v[60:63], a[136:139], a[24:27], v[60:63]
ds_read_b64_tr_b16 a[134:135], v6 offset:18432
v_mfma_f32_16x16x32_bf16 v[60:63], a[140:143], a[28:31], v[60:63]
v_mfma_f32_16x16x32_bf16 v[68:71], a[136:139], a[32:35], v[68:71]
ds_read_b128 a[76:79], v3 offset:34816
v_mfma_f32_16x16x32_bf16 v[68:71], a[140:143], a[36:39], v[68:71]
buffer_load_dwordx4 v14, s[8:11], s24 offen offset:2048 lds
v_mfma_f32_16x16x32_bf16 v[76:79], a[136:139], a[40:43], v[76:79]
v_mfma_f32_16x16x32_bf16 v[76:79], a[140:143], a[44:47], v[76:79]
v_mfma_f32_16x16x32_bf16 v[84:87], a[136:139], a[48:51], v[84:87]
ds_read_b128 a[80:83], v2 offset:36864
v_mfma_f32_16x16x32_bf16 v[84:87], a[140:143], a[52:55], v[84:87]
buffer_load_dwordx4 v15, s[8:11], s24 offen offset:3072 lds
v_mfma_f32_16x16x32_bf16 v[92:95], a[136:139], a[56:59], v[92:95]
s_add_u32 s24, s24, 128
ds_read_b128 a[84:87], v3 offset:36864
v_mfma_f32_16x16x32_bf16 v[92:95], a[140:143], a[60:63], v[92:95]
s_waitcnt lgkmcnt(3)
s_mov_b64 s[12:13], s[80:81]
v_mfma_f32_16x16x32_bf16 v[96:99], a[128:131], a[0:3], v[96:99]
s_mov_b32 s14, 3670016
s_add_u32 m0, s28, 16384
ds_read_b64_tr_b16 a[136:137], v7 offset:0
v_mfma_f32_16x16x32_bf16 v[96:99], a[132:135], a[4:7], v[96:99]
buffer_load_dwordx4 v12, s[8:11], s24 offen offset:0 lds
v_mfma_f32_16x16x32_bf16 v[104:107], a[128:131], a[8:11], v[104:107]
ds_read_b64_tr_b16 a[138:139], v7 offset:2048
v_mfma_f32_16x16x32_bf16 v[104:107], a[132:135], a[12:15], v[104:107]
v_mfma_f32_16x16x32_bf16 v[112:115], a[128:131], a[16:19], v[112:115]
ds_read_b64_tr_b16 a[140:141], v7 offset:16384
v_mfma_f32_16x16x32_bf16 v[112:115], a[132:135], a[20:23], v[112:115]
buffer_load_dwordx4 v13, s[8:11], s24 offen offset:1024 lds
v_mfma_f32_16x16x32_bf16 v[120:123], a[128:131], a[24:27], v[120:123]
ds_read_b64_tr_b16 a[142:143], v7 offset:18432
v_mfma_f32_16x16x32_bf16 v[120:123], a[132:135], a[28:31], v[120:123]
v_mfma_f32_16x16x32_bf16 v[128:131], a[128:131], a[32:35], v[128:131]
v_mfma_f32_16x16x32_bf16 v[128:131], a[132:135], a[36:39], v[128:131]
buffer_load_dwordx4 v14, s[8:11], s24 offen offset:2048 lds
v_mfma_f32_16x16x32_bf16 v[136:139], a[128:131], a[40:43], v[136:139]
ds_read_b128 a[88:91], v2 offset:38912
v_mfma_f32_16x16x32_bf16 v[136:139], a[132:135], a[44:47], v[136:139]
v_mfma_f32_16x16x32_bf16 v[144:147], a[128:131], a[48:51], v[144:147]
ds_read_b128 a[92:95], v3 offset:38912
v_mfma_f32_16x16x32_bf16 v[144:147], a[132:135], a[52:55], v[144:147]
buffer_load_dwordx4 v15, s[8:11], s24 offen offset:3072 lds
v_mfma_f32_16x16x32_bf16 v[152:155], a[128:131], a[56:59], v[152:155]
s_add_u32 s24, s24, 128
v_mfma_f32_16x16x32_bf16 v[152:155], a[132:135], a[60:63], v[152:155]
s_waitcnt lgkmcnt(2)
s_sub_u32 s26, s26, 8388608
v_mfma_f32_16x16x32_bf16 v[100:103], a[136:139], a[0:3], v[100:103]
s_sub_u32 s27, s27, 8388608
s_add_u32 m0, s29, 131072
ds_read_b64_tr_b16 a[128:129], v8 offset:0
v_mfma_f32_16x16x32_bf16 v[100:103], a[140:143], a[4:7], v[100:103]
PAD_5:
s_cbranch_execz M_tret
buffer_load_dwordx4 v16, s[12:15], s26 offen offset:0 lds
v_mfma_f32_16x16x32_bf16 v[108:111], a[136:139], a[8:11], v[108:111]
ds_read_b64_tr_b16 a[130:131], v8 offset:2048
v_mfma_f32_16x16x32_bf16 v[108:111], a[140:143], a[12:15], v[108:111]
v_mfma_f32_16x16x32_bf16 v[116:119], a[136:139], a[16:19], v[116:119]
ds_read_b64_tr_b16 a[132:133], v8 offset:16384
v_mfma_f32_16x16x32_bf16 v[116:119], a[140:143], a[20:23], v[116:119]
buffer_load_dwordx4 v17, s[12:15], s26 offen offset:1024 lds
v_mfma_f32_16x16x32_bf16 v[124:127], a[136:139], a[24:27], v[124:127]
ds_read_b64_tr_b16 a[134:135], v8 offset:18432
v_mfma_f32_16x16x32_bf16 v[124:127], a[140:143], a[28:31], v[124:127]
v_mfma_f32_16x16x32_bf16 v[132:135], a[136:139], a[32:35], v[132:135]
ds_read_b128 a[96:99], v2 offset:40960
v_mfma_f32_16x16x32_bf16 v[132:135], a[140:143], a[36:39], v[132:135]
buffer_load_dwordx4 v18, s[12:15], s26 offen offset:2048 lds
v_mfma_f32_16x16x32_bf16 v[140:143], a[136:139], a[40:43], v[140:143]
v_mfma_f32_16x16x32_bf16 v[140:143], a[140:143], a[44:47], v[140:143]
v_mfma_f32_16x16x32_bf16 v[148:151], a[136:139], a[48:51], v[148:151]
ds_read_b128 a[100:103], v3 offset:40960
v_mfma_f32_16x16x32_bf16 v[148:151], a[140:143], a[52:55], v[148:151]
buffer_load_dwordx4 v19, s[12:15], s26 offen offset:3072 lds
v_mfma_f32_16x16x32_bf16 v[156:159], a[136:139], a[56:59], v[156:159]
s_add_u32 s26, s26, 524288
ds_read_b128 a[104:107], v2 offset:43008
v_mfma_f32_16x16x32_bf16 v[156:159], a[140:143], a[60:63], v[156:159]
s_waitcnt lgkmcnt(3)
v_mfma_f32_16x16x32_bf16 v[160:163], a[128:131], a[0:3], v[160:163]
s_add_u32 m0, s29, 147456
ds_read_b64_tr_b16 a[136:137], v9 offset:0
v_mfma_f32_16x16x32_bf16 v[160:163], a[132:135], a[4:7], v[160:163]
buffer_load_dwordx4 v16, s[12:15], s27 offen offset:0 lds
v_mfma_f32_16x16x32_bf16 v[168:171], a[128:131], a[8:11], v[168:171]
ds_read_b64_tr_b16 a[138:139], v9 offset:2048
v_mfma_f32_16x16x32_bf16 v[168:171], a[132:135], a[12:15], v[168:171]
v_mfma_f32_16x16x32_bf16 v[176:179], a[128:131], a[16:19], v[176:179]
ds_read_b64_tr_b16 a[140:141], v9 offset:16384
v_mfma_f32_16x16x32_bf16 v[176:179], a[132:135], a[20:23], v[176:179]
buffer_load_dwordx4 v17, s[12:15], s27 offen offset:1024 lds
v_mfma_f32_16x16x32_bf16 v[184:187], a[128:131], a[24:27], v[184:187]
ds_read_b64_tr_b16 a[142:143], v9 offset:18432
v_mfma_f32_16x16x32_bf16 v[184:187], a[132:135], a[28:31], v[184:187]
v_mfma_f32_16x16x32_bf16 v[192:195], a[128:131], a[32:35], v[192:195]
v_mfma_f32_16x16x32_bf16 v[192:195], a[132:135], a[36:39], v[192:195]
buffer_load_dwordx4 v18, s[12:15], s27 offen offset:2048 lds
v_mfma_f32_16x16x32_bf16 v[200:203], a[128:131], a[40:43], v[200:203]
ds_read_b128 a[108:111], v3 offset:43008
v_mfma_f32_16x16x32_bf16 v[200:203], a[132:135], a[44:47], v[200:203]
v_mfma_f32_16x16x32_bf16 v[208:211], a[128:131], a[48:51], v[208:211]
ds_read_b128 a[112:115], v2 offset:45056
v_mfma_f32_16x16x32_bf16 v[208:211], a[132:135], a[52:55], v[208:211]
buffer_load_dwordx4 v19, s[12:15], s27 offen offset:3072 lds
v_mfma_f32_16x16x32_bf16 v[216:219], a[128:131], a[56:59], v[216:219]
s_add_u32 s27, s27, 524288
v_mfma_f32_16x16x32_bf16 v[216:219], a[132:135], a[60:63], v[216:219]
s_waitcnt lgkmcnt(2)
v_mfma_f32_16x16x32_bf16 v[164:167], a[136:139], a[0:3], v[164:167]
ds_read_b64_tr_b16 a[128:129], v10 offset:0
v_mfma_f32_16x16x32_bf16 v[164:167], a[140:143], a[4:7], v[164:167]
v_mfma_f32_16x16x32_bf16 v[172:175], a[136:139], a[8:11], v[172:175]
ds_read_b64_tr_b16 a[130:131], v10 offset:2048
v_mfma_f32_16x16x32_bf16 v[172:175], a[140:143], a[12:15], v[172:175]
v_mfma_f32_16x16x32_bf16 v[180:183], a[136:139], a[16:19], v[180:183]
ds_read_b64_tr_b16 a[132:133], v10 offset:16384
v_mfma_f32_16x16x32_bf16 v[180:183], a[140:143], a[20:23], v[180:183]
v_mfma_f32_16x16x32_bf16 v[188:191], a[136:139], a[24:27], v[188:191]
ds_read_b64_tr_b16 a[134:135], v10 offset:18432
v_mfma_f32_16x16x32_bf16 v[188:191], a[140:143], a[28:31], v[188:191]
v_mfma_f32_16x16x32_bf16 v[196:199], a[136:139], a[32:35], v[196:199]
ds_read_b128 a[116:119], v3 offset:45056
v_mfma_f32_16x16x32_bf16 v[196:199], a[140:143], a[36:39], v[196:199]
v_mfma_f32_16x16x32_bf16 v[204:207], a[136:139], a[40:43], v[204:207]
ds_read_b128 a[120:123], v2 offset:47104
v_mfma_f32_16x16x32_bf16 v[204:207], a[140:143], a[44:47], v[204:207]
v_mfma_f32_16x16x32_bf16 v[212:215], a[136:139], a[48:51], v[212:215]
v_mfma_f32_16x16x32_bf16 v[212:215], a[140:143], a[52:55], v[212:215]
v_mfma_f32_16x16x32_bf16 v[220:223], a[136:139], a[56:59], v[220:223]
ds_read_b128 a[124:127], v3 offset:47104
v_mfma_f32_16x16x32_bf16 v[220:223], a[140:143], a[60:63], v[220:223]
s_waitcnt lgkmcnt(3)
v_mfma_f32_16x16x32_bf16 a[192:195], a[128:131], a[0:3], a[192:195]
ds_read_b64_tr_b16 a[136:137], v11 offset:0
v_mfma_f32_16x16x32_bf16 a[192:195], a[132:135], a[4:7], a[192:195]
v_mfma_f32_16x16x32_bf16 a[200:203], a[128:131], a[8:11], a[200:203]
ds_read_b64_tr_b16 a[138:139], v11 offset:2048
v_mfma_f32_16x16x32_bf16 a[200:203], a[132:135], a[12:15], a[200:203]
v_mfma_f32_16x16x32_bf16 a[208:211], a[128:131], a[16:19], a[208:211]
ds_read_b64_tr_b16 a[140:141], v11 offset:16384
v_mfma_f32_16x16x32_bf16 a[208:211], a[132:135], a[20:23], a[208:211]
v_mfma_f32_16x16x32_bf16 a[216:219], a[128:131], a[24:27], a[216:219]
ds_read_b64_tr_b16 a[142:143], v11 offset:18432
v_mfma_f32_16x16x32_bf16 a[216:219], a[132:135], a[28:31], a[216:219]
v_mfma_f32_16x16x32_bf16 a[224:227], a[128:131], a[32:35], a[224:227]
v_mfma_f32_16x16x32_bf16 a[224:227], a[132:135], a[36:39], a[224:227]
v_mfma_f32_16x16x32_bf16 a[232:235], a[128:131], a[40:43], a[232:235]
v_mfma_f32_16x16x32_bf16 a[232:235], a[132:135], a[44:47], a[232:235]
v_mfma_f32_16x16x32_bf16 a[240:243], a[128:131], a[48:51], a[240:243]
v_mfma_f32_16x16x32_bf16 a[240:243], a[132:135], a[52:55], a[240:243]
v_mfma_f32_16x16x32_bf16 a[248:251], a[128:131], a[56:59], a[248:251]
s_waitcnt vmcnt(12) lgkmcnt(0)
v_mfma_f32_16x16x32_bf16 a[248:251], a[132:135], a[60:63], a[248:251]
s_barrier
v_mfma_f32_16x16x32_bf16 a[196:199], a[136:139], a[0:3], a[196:199]
s_add_u32 m0, s28, 32768
ds_read_b64_tr_b16 a[128:129], v4 offset:32768
v_mfma_f32_16x16x32_bf16 a[196:199], a[140:143], a[4:7], a[196:199]
s_lshr_b32 s22, s3, 1
buffer_load_dwordx4 v12, s[8:11], s24 offen offset:0 lds
v_mfma_f32_16x16x32_bf16 a[204:207], a[136:139], a[8:11], a[204:207]
s_lshl_b32 s22, s22, 14
ds_read_b64_tr_b16 a[130:131], v4 offset:34816
v_subrev_u32 v2, s22, v2
v_mfma_f32_16x16x32_bf16 a[204:207], a[140:143], a[12:15], a[204:207]
v_subrev_u32 v3, s22, v3
v_mfma_f32_16x16x32_bf16 a[212:215], a[136:139], a[16:19], a[212:215]
ds_read_b64_tr_b16 a[132:133], v4 offset:49152
v_mfma_f32_16x16x32_bf16 a[212:215], a[140:143], a[20:23], a[212:215]
buffer_load_dwordx4 v13, s[8:11], s24 offen offset:1024 lds
v_mfma_f32_16x16x32_bf16 a[220:223], a[136:139], a[24:27], a[220:223]
ds_read_b64_tr_b16 a[134:135], v4 offset:51200
v_mfma_f32_16x16x32_bf16 a[220:223], a[140:143], a[28:31], a[220:223]
v_mfma_f32_16x16x32_bf16 a[228:231], a[136:139], a[32:35], a[228:231]
v_mfma_f32_16x16x32_bf16 a[228:231], a[140:143], a[36:39], a[228:231]
buffer_load_dwordx4 v14, s[8:11], s24 offen offset:2048 lds
v_mfma_f32_16x16x32_bf16 a[236:239], a[136:139], a[40:43], a[236:239]
v_mfma_f32_16x16x32_bf16 a[236:239], a[140:143], a[44:47], a[236:239]
v_mfma_f32_16x16x32_bf16 a[244:247], a[136:139], a[48:51], a[244:247]
v_mfma_f32_16x16x32_bf16 a[244:247], a[140:143], a[52:55], a[244:247]
buffer_load_dwordx4 v15, s[8:11], s24 offen offset:3072 lds
v_mfma_f32_16x16x32_bf16 a[252:255], a[136:139], a[56:59], a[252:255]
s_add_u32 s24, s24, 128
v_mfma_f32_16x16x32_bf16 a[252:255], a[140:143], a[60:63], a[252:255]
s_waitcnt lgkmcnt(0)
v_mfma_f32_16x16x32_bf16 v[32:35], a[128:131], a[64:67], v[32:35]
s_add_u32 m0, s29, 65536
ds_read_b64_tr_b16 a[136:137], v5 offset:32768
v_mfma_f32_16x16x32_bf16 v[32:35], a[132:135], a[68:71], v[32:35]
buffer_load_dwordx4 v16, s[12:15], s26 offen offset:0 lds
v_mfma_f32_16x16x32_bf16 v[40:43], a[128:131], a[72:75], v[40:43]
ds_read_b64_tr_b16 a[138:139], v5 offset:34816
v_mfma_f32_16x16x32_bf16 v[40:43], a[132:135], a[76:79], v[40:43]
v_mfma_f32_16x16x32_bf16 v[48:51], a[128:131], a[80:83], v[48:51]
ds_read_b64_tr_b16 a[140:141], v5 offset:49152
v_mfma_f32_16x16x32_bf16 v[48:51], a[132:135], a[84:87], v[48:51]
buffer_load_dwordx4 v17, s[12:15], s26 offen offset:1024 lds
v_mfma_f32_16x16x32_bf16 v[56:59], a[128:131], a[88:91], v[56:59]
ds_read_b64_tr_b16 a[142:143], v5 offset:51200
v_mfma_f32_16x16x32_bf16 v[56:59], a[132:135], a[92:95], v[56:59]
v_mfma_f32_16x16x32_bf16 v[64:67], a[128:131], a[96:99], v[64:67]
ds_read_b128 a[0:3], v2 offset:0
v_mfma_f32_16x16x32_bf16 v[64:67], a[132:135], a[100:103], v[64:67]
buffer_load_dwordx4 v18, s[12:15], s26 offen offset:2048 lds
v_mfma_f32_16x16x32_bf16 v[72:75], a[128:131], a[104:107], v[72:75]
ds_read_b128 a[4:7], v3 offset:0
v_mfma_f32_16x16x32_bf16 v[72:75], a[132:135], a[108:111], v[72:75]
v_mfma_f32_16x16x32_bf16 v[80:83], a[128:131], a[112:115], v[80:83]
v_mfma_f32_16x16x32_bf16 v[80:83], a[132:135], a[116:119], v[80:83]
buffer_load_dwordx4 v19, s[12:15], s26 offen offset:3072 lds
v_mfma_f32_16x16x32_bf16 v[88:91], a[128:131], a[120:123], v[88:91]
s_add_u32 s26, s26, 524288
ds_read_b128 a[8:11], v2 offset:2048
v_mfma_f32_16x16x32_bf16 v[88:91], a[132:135], a[124:127], v[88:91]
s_waitcnt lgkmcnt(3)
v_mfma_f32_16x16x32_bf16 v[36:39], a[136:139], a[64:67], v[36:39]
s_add_u32 m0, s29, 81920
ds_read_b64_tr_b16 a[128:129], v6 offset:32768
v_mfma_f32_16x16x32_bf16 v[36:39], a[140:143], a[68:71], v[36:39]
buffer_load_dwordx4 v16, s[12:15], s27 offen offset:0 lds
v_mfma_f32_16x16x32_bf16 v[44:47], a[136:139], a[72:75], v[44:47]
ds_read_b64_tr_b16 a[130:131], v6 offset:34816
v_mfma_f32_16x16x32_bf16 v[44:47], a[140:143], a[76:79], v[44:47]
v_mfma_f32_16x16x32_bf16 v[52:55], a[136:139], a[80:83], v[52:55]
ds_read_b64_tr_b16 a[132:133], v6 offset:49152
v_mfma_f32_16x16x32_bf16 v[52:55], a[140:143], a[84:87], v[52:55]
buffer_load_dwordx4 v17, s[12:15], s27 offen offset:1024 lds
v_mfma_f32_16x16x32_bf16 v[60:63], a[136:139], a[88:91], v[60:63]
ds_read_b64_tr_b16 a[134:135], v6 offset:51200
v_cvt_pk_bf16_f32 v32, v32, v33
v_mfma_f32_16x16x32_bf16 v[60:63], a[140:143], a[92:95], v[60:63]
v_cvt_pk_bf16_f32 v33, v34, v35
v_cvt_pk_bf16_f32 v34, v36, v37
v_mfma_f32_16x16x32_bf16 v[68:71], a[136:139], a[96:99], v[68:71]
ds_read_b128 a[12:15], v3 offset:2048
v_cvt_pk_bf16_f32 v35, v38, v39
v_mfma_f32_16x16x32_bf16 v[68:71], a[140:143], a[100:103], v[68:71]
buffer_load_dwordx4 v18, s[12:15], s27 offen offset:2048 lds
v_mfma_f32_16x16x32_bf16 v[76:79], a[136:139], a[104:107], v[76:79]
v_cvt_pk_bf16_f32 v40, v40, v41
v_cvt_pk_bf16_f32 v41, v42, v43
v_mfma_f32_16x16x32_bf16 v[76:79], a[140:143], a[108:111], v[76:79]
v_cvt_pk_bf16_f32 v42, v44, v45
v_cvt_pk_bf16_f32 v43, v46, v47
v_mfma_f32_16x16x32_bf16 v[84:87], a[136:139], a[112:115], v[84:87]
ds_read_b128 a[16:19], v2 offset:4096
v_cvt_pk_bf16_f32 v48, v48, v49
v_mfma_f32_16x16x32_bf16 v[84:87], a[140:143], a[116:119], v[84:87]
buffer_load_dwordx4 v19, s[12:15], s27 offen offset:3072 lds
v_mfma_f32_16x16x32_bf16 v[92:95], a[136:139], a[120:123], v[92:95]
s_add_u32 s27, s27, 524288
ds_read_b128 a[20:23], v3 offset:4096
v_cvt_pk_bf16_f32 v49, v50, v51
v_mfma_f32_16x16x32_bf16 v[92:95], a[140:143], a[124:127], v[92:95]
s_waitcnt lgkmcnt(3)
v_cvt_pk_bf16_f32 v50, v52, v53
v_cvt_pk_bf16_f32 v51, v54, v55
v_mfma_f32_16x16x32_bf16 v[96:99], a[128:131], a[64:67], v[96:99]
s_add_u32 m0, s28, 49152
ds_read_b64_tr_b16 a[136:137], v7 offset:32768
v_cvt_pk_bf16_f32 v56, v56, v57
v_mfma_f32_16x16x32_bf16 v[96:99], a[132:135], a[68:71], v[96:99]
buffer_load_dwordx4 v12, s[8:11], s24 offen offset:0 lds
v_mfma_f32_16x16x32_bf16 v[104:107], a[128:131], a[72:75], v[104:107]
ds_read_b64_tr_b16 a[138:139], v7 offset:34816
v_cvt_pk_bf16_f32 v57, v58, v59
v_mfma_f32_16x16x32_bf16 v[104:107], a[132:135], a[76:79], v[104:107]
v_cvt_pk_bf16_f32 v58, v60, v61
v_cvt_pk_bf16_f32 v59, v62, v63
v_mfma_f32_16x16x32_bf16 v[112:115], a[128:131], a[80:83], v[112:115]
ds_read_b64_tr_b16 a[140:141], v7 offset:49152
v_cvt_pk_bf16_f32 v64, v64, v65
v_mfma_f32_16x16x32_bf16 v[112:115], a[132:135], a[84:87], v[112:115]
buffer_load_dwordx4 v13, s[8:11], s24 offen offset:1024 lds
v_mfma_f32_16x16x32_bf16 v[120:123], a[128:131], a[88:91], v[120:123]
ds_read_b64_tr_b16 a[142:143], v7 offset:51200
v_cvt_pk_bf16_f32 v65, v66, v67
v_mfma_f32_16x16x32_bf16 v[120:123], a[132:135], a[92:95], v[120:123]
v_cvt_pk_bf16_f32 v66, v68, v69
v_cvt_pk_bf16_f32 v67, v70, v71
v_mfma_f32_16x16x32_bf16 v[128:131], a[128:131], a[96:99], v[128:131]
v_cvt_pk_bf16_f32 v72, v72, v73
v_cvt_pk_bf16_f32 v73, v74, v75
v_mfma_f32_16x16x32_bf16 v[128:131], a[132:135], a[100:103], v[128:131]
buffer_load_dwordx4 v14, s[8:11], s24 offen offset:2048 lds
v_mfma_f32_16x16x32_bf16 v[136:139], a[128:131], a[104:107], v[136:139]
ds_read_b128 a[24:27], v2 offset:6144
v_cvt_pk_bf16_f32 v74, v76, v77
v_mfma_f32_16x16x32_bf16 v[136:139], a[132:135], a[108:111], v[136:139]
buffer_store_dwordx4 v[32:35], v1, s[4:7], s31 offen sc1
v_mfma_f32_16x16x32_bf16 v[144:147], a[128:131], a[112:115], v[144:147]
s_add_u32 s31, s31, s32
ds_read_b128 a[28:31], v3 offset:6144
v_cvt_pk_bf16_f32 v75, v78, v79
v_mfma_f32_16x16x32_bf16 v[144:147], a[132:135], a[116:119], v[144:147]
buffer_load_dwordx4 v15, s[8:11], s24 offen offset:3072 lds
v_mfma_f32_16x16x32_bf16 v[152:155], a[128:131], a[120:123], v[152:155]
s_add_u32 s24, s24, 128
v_cvt_pk_bf16_f32 v80, v80, v81
v_cvt_pk_bf16_f32 v81, v82, v83
v_mfma_f32_16x16x32_bf16 v[152:155], a[132:135], a[124:127], v[152:155]
s_waitcnt lgkmcnt(2)
v_cvt_pk_bf16_f32 v82, v84, v85
v_cvt_pk_bf16_f32 v83, v86, v87
v_mfma_f32_16x16x32_bf16 v[100:103], a[136:139], a[64:67], v[100:103]
ds_read_b64_tr_b16 a[128:129], v8 offset:32768
v_cvt_pk_bf16_f32 v88, v88, v89
v_mfma_f32_16x16x32_bf16 v[100:103], a[140:143], a[68:71], v[100:103]
v_cvt_pk_bf16_f32 v89, v90, v91
v_cvt_pk_bf16_f32 v90, v92, v93
v_mfma_f32_16x16x32_bf16 v[108:111], a[136:139], a[72:75], v[108:111]
ds_read_b64_tr_b16 a[130:131], v8 offset:34816
v_cvt_pk_bf16_f32 v91, v94, v95
v_mfma_f32_16x16x32_bf16 v[108:111], a[140:143], a[76:79], v[108:111]
buffer_store_dwordx4 v[40:43], v1, s[4:7], s31 offen sc1
v_mfma_f32_16x16x32_bf16 v[116:119], a[136:139], a[80:83], v[116:119]
s_add_u32 s31, s31, s33
ds_read_b64_tr_b16 a[132:133], v8 offset:49152
v_mfma_f32_16x16x32_bf16 v[116:119], a[140:143], a[84:87], v[116:119]
v_mfma_f32_16x16x32_bf16 v[124:127], a[136:139], a[88:91], v[124:127]
ds_read_b64_tr_b16 a[134:135], v8 offset:51200
v_cvt_pk_bf16_f32 v96, v96, v97
v_mfma_f32_16x16x32_bf16 v[124:127], a[140:143], a[92:95], v[124:127]
v_cvt_pk_bf16_f32 v97, v98, v99
v_cvt_pk_bf16_f32 v98, v100, v101
v_mfma_f32_16x16x32_bf16 v[132:135], a[136:139], a[96:99], v[132:135]
ds_read_b128 a[32:35], v2 offset:8192
v_cvt_pk_bf16_f32 v99, v102, v103
v_mfma_f32_16x16x32_bf16 v[132:135], a[140:143], a[100:103], v[132:135]
v_cvt_pk_bf16_f32 v104, v104, v105
v_cvt_pk_bf16_f32 v105, v106, v107
v_mfma_f32_16x16x32_bf16 v[140:143], a[136:139], a[104:107], v[140:143]
v_cvt_pk_bf16_f32 v106, v108, v109
v_cvt_pk_bf16_f32 v107, v110, v111
v_mfma_f32_16x16x32_bf16 v[140:143], a[140:143], a[108:111], v[140:143]
v_cvt_pk_bf16_f32 v112, v112, v113
v_cvt_pk_bf16_f32 v113, v114, v115
v_mfma_f32_16x16x32_bf16 v[148:151], a[136:139], a[112:115], v[148:151]
ds_read_b128 a[36:39], v3 offset:8192
v_cvt_pk_bf16_f32 v114, v116, v117
v_mfma_f32_16x16x32_bf16 v[148:151], a[140:143], a[116:119], v[148:151]
v_cvt_pk_bf16_f32 v115, v118, v119
v_cvt_pk_bf16_f32 v120, v120, v121
v_mfma_f32_16x16x32_bf16 v[156:159], a[136:139], a[120:123], v[156:159]
ds_read_b128 a[40:43], v2 offset:10240
v_cvt_pk_bf16_f32 v121, v122, v123
v_mfma_f32_16x16x32_bf16 v[156:159], a[140:143], a[124:127], v[156:159]
s_waitcnt lgkmcnt(3)
buffer_store_dwordx4 v[48:51], v1, s[4:7], s31 offen sc1
v_mfma_f32_16x16x32_bf16 v[160:163], a[128:131], a[64:67], v[160:163]
s_add_u32 s31, s31, s32
ds_read_b64_tr_b16 a[136:137], v9 offset:32768
v_cvt_pk_bf16_f32 v122, v124, v125
v_mfma_f32_16x16x32_bf16 v[160:163], a[132:135], a[68:71], v[160:163]
v_cvt_pk_bf16_f32 v123, v126, v127
v_cvt_pk_bf16_f32 v128, v128, v129
v_mfma_f32_16x16x32_bf16 v[168:171], a[128:131], a[72:75], v[168:171]
ds_read_b64_tr_b16 a[138:139], v9 offset:34816
v_cvt_pk_bf16_f32 v129, v130, v131
v_mfma_f32_16x16x32_bf16 v[168:171], a[132:135], a[76:79], v[168:171]
v_cvt_pk_bf16_f32 v130, v132, v133
v_cvt_pk_bf16_f32 v131, v134, v135
v_mfma_f32_16x16x32_bf16 v[176:179], a[128:131], a[80:83], v[176:179]
ds_read_b64_tr_b16 a[140:141], v9 offset:49152
v_cvt_pk_bf16_f32 v136, v136, v137
v_mfma_f32_16x16x32_bf16 v[176:179], a[132:135], a[84:87], v[176:179]
v_cvt_pk_bf16_f32 v137, v138, v139
v_cvt_pk_bf16_f32 v138, v140, v141
v_mfma_f32_16x16x32_bf16 v[184:187], a[128:131], a[88:91], v[184:187]
ds_read_b64_tr_b16 a[142:143], v9 offset:51200
v_cvt_pk_bf16_f32 v139, v142, v143
v_mfma_f32_16x16x32_bf16 v[184:187], a[132:135], a[92:95], v[184:187]
v_cvt_pk_bf16_f32 v144, v144, v145
v_cvt_pk_bf16_f32 v145, v146, v147
v_mfma_f32_16x16x32_bf16 v[192:195], a[128:131], a[96:99], v[192:195]
buffer_store_dwordx4 v[56:59], v1, s[4:7], s31 offen sc1
v_mfma_f32_16x16x32_bf16 v[192:195], a[132:135], a[100:103], v[192:195]
s_add_u32 s31, s31, s34
v_cvt_pk_bf16_f32 v146, v148, v149
v_cvt_pk_bf16_f32 v147, v150, v151
v_mfma_f32_16x16x32_bf16 v[200:203], a[128:131], a[104:107], v[200:203]
ds_read_b128 a[44:47], v3 offset:10240
v_cvt_pk_bf16_f32 v152, v152, v153
v_mfma_f32_16x16x32_bf16 v[200:203], a[132:135], a[108:111], v[200:203]
v_cvt_pk_bf16_f32 v153, v154, v155
v_cvt_pk_bf16_f32 v154, v156, v157
v_mfma_f32_16x16x32_bf16 v[208:211], a[128:131], a[112:115], v[208:211]
ds_read_b128 a[48:51], v2 offset:12288
v_cvt_pk_bf16_f32 v155, v158, v159
v_mfma_f32_16x16x32_bf16 v[208:211], a[132:135], a[116:119], v[208:211]
v_mfma_f32_16x16x32_bf16 v[216:219], a[128:131], a[120:123], v[216:219]
v_mfma_f32_16x16x32_bf16 v[216:219], a[132:135], a[124:127], v[216:219]
s_waitcnt lgkmcnt(2)
v_mfma_f32_16x16x32_bf16 v[164:167], a[136:139], a[64:67], v[164:167]
ds_read_b64_tr_b16 a[128:129], v10 offset:32768
v_mfma_f32_16x16x32_bf16 v[164:167], a[140:143], a[68:71], v[164:167]
v_mfma_f32_16x16x32_bf16 v[172:175], a[136:139], a[72:75], v[172:175]
ds_read_b64_tr_b16 a[130:131], v10 offset:34816
v_mfma_f32_16x16x32_bf16 v[172:175], a[140:143], a[76:79], v[172:175]
buffer_store_dwordx4 v[64:67], v1, s[4:7], s31 offen sc1
v_mfma_f32_16x16x32_bf16 v[180:183], a[136:139], a[80:83], v[180:183]
s_add_u32 s31, s31, s32
ds_read_b64_tr_b16 a[132:133], v10 offset:49152
v_mfma_f32_16x16x32_bf16 v[180:183], a[140:143], a[84:87], v[180:183]
v_mfma_f32_16x16x32_bf16 v[188:191], a[136:139], a[88:91], v[188:191]
ds_read_b64_tr_b16 a[134:135], v10 offset:51200
v_cvt_pk_bf16_f32 v160, v160, v161
v_mfma_f32_16x16x32_bf16 v[188:191], a[140:143], a[92:95], v[188:191]
v_cvt_pk_bf16_f32 v161, v162, v163
v_cvt_pk_bf16_f32 v162, v164, v165
v_mfma_f32_16x16x32_bf16 v[196:199], a[136:139], a[96:99], v[196:199]
ds_read_b128 a[52:55], v3 offset:12288
v_cvt_pk_bf16_f32 v163, v166, v167
v_mfma_f32_16x16x32_bf16 v[196:199], a[140:143], a[100:103], v[196:199]
v_cvt_pk_bf16_f32 v168, v168, v169
v_cvt_pk_bf16_f32 v169, v170, v171
v_mfma_f32_16x16x32_bf16 v[204:207], a[136:139], a[104:107], v[204:207]
ds_read_b128 a[56:59], v2 offset:14336
v_cvt_pk_bf16_f32 v170, v172, v173
v_mfma_f32_16x16x32_bf16 v[204:207], a[140:143], a[108:111], v[204:207]
v_cvt_pk_bf16_f32 v171, v174, v175
v_cvt_pk_bf16_f32 v176, v176, v177
v_mfma_f32_16x16x32_bf16 v[212:215], a[136:139], a[112:115], v[212:215]
v_cvt_pk_bf16_f32 v177, v178, v179
v_cvt_pk_bf16_f32 v178, v180, v181
v_mfma_f32_16x16x32_bf16 v[212:215], a[140:143], a[116:119], v[212:215]
buffer_store_dwordx4 v[72:75], v1, s[4:7], s31 offen sc1
v_mfma_f32_16x16x32_bf16 v[220:223], a[136:139], a[120:123], v[220:223]
s_add_u32 s31, s31, s33
ds_read_b128 a[60:63], v3 offset:14336
v_cvt_pk_bf16_f32 v179, v182, v183
v_mfma_f32_16x16x32_bf16 v[220:223], a[140:143], a[124:127], v[220:223]
s_waitcnt lgkmcnt(3)
v_cvt_pk_bf16_f32 v184, v184, v185
v_cvt_pk_bf16_f32 v185, v186, v187
v_mfma_f32_16x16x32_bf16 a[192:195], a[128:131], a[64:67], a[192:195]
ds_read_b64_tr_b16 a[136:137], v11 offset:32768
v_cvt_pk_bf16_f32 v186, v188, v189
v_mfma_f32_16x16x32_bf16 a[192:195], a[132:135], a[68:71], a[192:195]
v_cvt_pk_bf16_f32 v187, v190, v191
v_cvt_pk_bf16_f32 v192, v192, v193
v_mfma_f32_16x16x32_bf16 a[200:203], a[128:131], a[72:75], a[200:203]
ds_read_b64_tr_b16 a[138:139], v11 offset:34816
v_cvt_pk_bf16_f32 v193, v194, v195
v_mfma_f32_16x16x32_bf16 a[200:203], a[132:135], a[76:79], a[200:203]
v_cvt_pk_bf16_f32 v194, v196, v197
v_cvt_pk_bf16_f32 v195, v198, v199
v_mfma_f32_16x16x32_bf16 a[208:211], a[128:131], a[80:83], a[208:211]
ds_read_b64_tr_b16 a[140:141], v11 offset:49152
v_cvt_pk_bf16_f32 v200, v200, v201
v_mfma_f32_16x16x32_bf16 a[208:211], a[132:135], a[84:87], a[208:211]
v_cvt_pk_bf16_f32 v201, v202, v203
v_cvt_pk_bf16_f32 v202, v204, v205
v_mfma_f32_16x16x32_bf16 a[216:219], a[128:131], a[88:91], a[216:219]
ds_read_b64_tr_b16 a[142:143], v11 offset:51200
v_cvt_pk_bf16_f32 v203, v206, v207
v_mfma_f32_16x16x32_bf16 a[216:219], a[132:135], a[92:95], a[216:219]
v_cvt_pk_bf16_f32 v208, v208, v209
v_cvt_pk_bf16_f32 v209, v210, v211
v_mfma_f32_16x16x32_bf16 a[224:227], a[128:131], a[96:99], a[224:227]
buffer_store_dwordx4 v[80:83], v1, s[4:7], s31 offen sc1
v_mfma_f32_16x16x32_bf16 a[224:227], a[132:135], a[100:103], a[224:227]
s_add_u32 s31, s31, s32
v_cvt_pk_bf16_f32 v210, v212, v213
v_cvt_pk_bf16_f32 v211, v214, v215
v_mfma_f32_16x16x32_bf16 a[232:235], a[128:131], a[104:107], a[232:235]
v_cvt_pk_bf16_f32 v216, v216, v217
v_cvt_pk_bf16_f32 v217, v218, v219
v_mfma_f32_16x16x32_bf16 a[232:235], a[132:135], a[108:111], a[232:235]
v_cvt_pk_bf16_f32 v218, v220, v221
v_cvt_pk_bf16_f32 v219, v222, v223
v_mfma_f32_16x16x32_bf16 a[240:243], a[128:131], a[112:115], a[240:243]
v_mfma_f32_16x16x32_bf16 a[240:243], a[132:135], a[116:119], a[240:243]
v_mfma_f32_16x16x32_bf16 a[248:251], a[128:131], a[120:123], a[248:251]
s_waitcnt vmcnt(23) lgkmcnt(0)
v_mfma_f32_16x16x32_bf16 a[248:251], a[132:135], a[124:127], a[248:251]
s_barrier
v_mfma_f32_16x16x32_bf16 a[196:199], a[136:139], a[64:67], a[196:199]
s_add_u32 m0, s29, 98304
ds_read_b64_tr_b16 a[128:129], v22 offset:0
v_mfma_f32_16x16x32_bf16 a[196:199], a[140:143], a[68:71], a[196:199]
buffer_load_dwordx4 v16, s[12:15], s26 offen offset:0 lds
v_mfma_f32_16x16x32_bf16 a[204:207], a[136:139], a[72:75], a[204:207]
ds_read_b64_tr_b16 a[130:131], v22 offset:2048
v_mfma_f32_16x16x32_bf16 a[204:207], a[140:143], a[76:79], a[204:207]
buffer_store_dwordx4 v[88:91], v1, s[4:7], s31 offen sc1
v_mfma_f32_16x16x32_bf16 a[212:215], a[136:139], a[80:83], a[212:215]
s_add_u32 s31, s31, s35
ds_read_b64_tr_b16 a[132:133], v22 offset:16384
v_mfma_f32_16x16x32_bf16 a[212:215], a[140:143], a[84:87], a[212:215]
buffer_load_dwordx4 v17, s[12:15], s26 offen offset:1024 lds
v_mfma_f32_16x16x32_bf16 a[220:223], a[136:139], a[88:91], a[220:223]
ds_read_b64_tr_b16 a[134:135], v22 offset:18432
v_add_u32 v22, 4294901760, v22
v_mfma_f32_16x16x32_bf16 a[220:223], a[140:143], a[92:95], a[220:223]
v_mfma_f32_16x16x32_bf16 a[228:231], a[136:139], a[96:99], a[228:231]
v_mfma_f32_16x16x32_bf16 a[228:231], a[140:143], a[100:103], a[228:231]
buffer_load_dwordx4 v18, s[12:15], s26 offen offset:2048 lds
v_mfma_f32_16x16x32_bf16 a[236:239], a[136:139], a[104:107], a[236:239]
v_mfma_f32_16x16x32_bf16 a[236:239], a[140:143], a[108:111], a[236:239]
v_mfma_f32_16x16x32_bf16 a[244:247], a[136:139], a[112:115], a[244:247]
v_mfma_f32_16x16x32_bf16 a[244:247], a[140:143], a[116:119], a[244:247]
buffer_load_dwordx4 v19, s[12:15], s26 offen offset:3072 lds
v_mfma_f32_16x16x32_bf16 a[252:255], a[136:139], a[120:123], a[252:255]
s_add_u32 s26, s26, 524288
v_mfma_f32_16x16x32_bf16 a[252:255], a[140:143], a[124:127], a[252:255]
s_waitcnt lgkmcnt(0)
M_Q:
v_mfma_f32_16x16x32_bf16 v[36:39], a[128:131], a[0:3], 0
s_add_u32 m0, s29, 114688
ds_read_b64_tr_b16 a[136:137], v23 offset:0
v_mfma_f32_16x16x32_bf16 v[36:39], a[132:135], a[4:7], v[36:39]
buffer_load_dwordx4 v16, s[12:15], s27 offen offset:0 lds
v_mfma_f32_16x16x32_bf16 v[44:47], a[128:131], a[8:11], 0
ds_read_b64_tr_b16 a[138:139], v23 offset:2048
v_mfma_f32_16x16x32_bf16 v[44:47], a[132:135], a[12:15], v[44:47]
ds_read_b128 a[64:67], v2 offset:16384
ds_read_b128 a[68:71], v3 offset:16384
v_mfma_f32_16x16x32_bf16 v[52:55], a[128:131], a[16:19], 0
ds_read_b64_tr_b16 a[140:141], v23 offset:16384
v_mfma_f32_16x16x32_bf16 v[52:55], a[132:135], a[20:23], v[52:55]
buffer_load_dwordx4 v17, s[12:15], s27 offen offset:1024 lds
v_mfma_f32_16x16x32_bf16 v[60:63], a[128:131], a[24:27], 0
ds_read_b64_tr_b16 a[142:143], v23 offset:18432
v_add_u32 v23, 4294901760, v23
v_mfma_f32_16x16x32_bf16 v[60:63], a[132:135], a[28:31], v[60:63]
buffer_store_dwordx4 v[96:99], v1, s[4:7], s31 offen sc1
v_mfma_f32_16x16x32_bf16 v[68:71], a[128:131], a[32:35], 0
s_add_u32 s31, s31, s32
ds_read_b128 a[72:75], v2 offset:18432
v_mfma_f32_16x16x32_bf16 v[68:71], a[132:135], a[36:39], v[68:71]
buffer_load_dwordx4 v18, s[12:15], s27 offen offset:2048 lds
v_mfma_f32_16x16x32_bf16 v[76:79], a[128:131], a[40:43], 0
ds_read_b128 a[76:79], v3 offset:18432
v_mfma_f32_16x16x32_bf16 v[76:79], a[132:135], a[44:47], v[76:79]
ds_read_b128 a[80:83], v2 offset:20480
v_mfma_f32_16x16x32_bf16 v[84:87], a[128:131], a[48:51], 0
ds_read_b128 a[84:87], v3 offset:20480
v_mfma_f32_16x16x32_bf16 v[84:87], a[132:135], a[52:55], v[84:87]
buffer_load_dwordx4 v19, s[12:15], s27 offen offset:3072 lds
v_mfma_f32_16x16x32_bf16 v[92:95], a[128:131], a[56:59], 0
s_add_u32 s27, s27, 524288
ds_read_b128 a[88:91], v2 offset:22528
v_mfma_f32_16x16x32_bf16 v[92:95], a[132:135], a[60:63], v[92:95]
s_waitcnt lgkmcnt(5)
buffer_store_dwordx4 v[104:107], v1, s[4:7], s31 offen sc1
v_mfma_f32_16x16x32_bf16 v[100:103], a[136:139], a[0:3], 0
s_add_u32 m0, s28, 0
ds_read_b64_tr_b16 a[128:129], v24 offset:0
v_mfma_f32_16x16x32_bf16 v[100:103], a[140:143], a[4:7], v[100:103]
s_add_u32 s31, s31, s33
buffer_load_dwordx4 v12, s[8:11], s24 offen offset:0 lds
v_mfma_f32_16x16x32_bf16 v[108:111], a[136:139], a[8:11], 0
ds_read_b64_tr_b16 a[130:131], v24 offset:2048
v_mfma_f32_16x16x32_bf16 v[108:111], a[140:143], a[12:15], v[108:111]
ds_read_b128 a[92:95], v3 offset:22528
v_mfma_f32_16x16x32_bf16 v[116:119], a[136:139], a[16:19], 0
ds_read_b64_tr_b16 a[132:133], v24 offset:16384
v_mfma_f32_16x16x32_bf16 v[116:119], a[140:143], a[20:23], v[116:119]
buffer_load_dwordx4 v13, s[8:11], s24 offen offset:1024 lds
v_mfma_f32_16x16x32_bf16 v[124:127], a[136:139], a[24:27], 0
ds_read_b64_tr_b16 a[134:135], v24 offset:18432
v_add_u32 v24, 4294901760, v24
v_mfma_f32_16x16x32_bf16 v[124:127], a[140:143], a[28:31], v[124:127]
v_mfma_f32_16x16x32_bf16 v[132:135], a[136:139], a[32:35], 0
ds_read_b128 a[96:99], v2 offset:24576
v_mfma_f32_16x16x32_bf16 v[132:135], a[140:143], a[36:39], v[132:135]
buffer_load_dwordx4 v14, s[8:11], s24 offen offset:2048 lds
v_mfma_f32_16x16x32_bf16 v[140:143], a[136:139], a[40:43], 0
ds_read_b128 a[100:103], v3 offset:24576
v_mfma_f32_16x16x32_bf16 v[140:143], a[140:143], a[44:47], v[140:143]
ds_read_b128 a[104:107], v2 offset:26624
v_mfma_f32_16x16x32_bf16 v[148:151], a[136:139], a[48:51], 0
ds_read_b128 a[108:111], v3 offset:26624
v_mfma_f32_16x16x32_bf16 v[148:151], a[140:143], a[52:55], v[148:151]
PAD_6:
s_cbranch_execz M_tret
buffer_load_dwordx4 v15, s[8:11], s24 offen offset:3072 lds
v_mfma_f32_16x16x32_bf16 v[156:159], a[136:139], a[56:59], 0
s_add_u32 s24, s24, 128
ds_read_b128 a[112:115], v2 offset:28672
v_mfma_f32_16x16x32_bf16 v[156:159], a[140:143], a[60:63], v[156:159]
s_waitcnt lgkmcnt(5)
buffer_store_dwordx4 v[112:115], v1, s[4:7], s31 offen sc1
v_mfma_f32_16x16x32_bf16 v[164:167], a[128:131], a[0:3], 0
s_add_u32 s31, s31, s32
ds_read_b64_tr_b16 a[136:137], v25 offset:0
v_mfma_f32_16x16x32_bf16 v[164:167], a[132:135], a[4:7], v[164:167]
v_mfma_f32_16x16x32_bf16 v[172:175], a[128:131], a[8:11], 0
ds_read_b64_tr_b16 a[138:139], v25 offset:2048
v_mfma_f32_16x16x32_bf16 v[172:175], a[132:135], a[12:15], v[172:175]
ds_read_b128 a[116:119], v3 offset:28672
v_mfma_f32_16x16x32_bf16 v[180:183], a[128:131], a[16:19], 0
ds_read_b64_tr_b16 a[140:141], v25 offset:16384
v_mfma_f32_16x16x32_bf16 v[180:183], a[132:135], a[20:23], v[180:183]
v_mfma_f32_16x16x32_bf16 v[188:191], a[128:131], a[24:27], 0
ds_read_b64_tr_b16 a[142:143], v25 offset:18432
v_add_u32 v25, 4294901760, v25
v_mfma_f32_16x16x32_bf16 v[188:191], a[132:135], a[28:31], v[188:191]
v_mfma_f32_16x16x32_bf16 v[196:199], a[128:131], a[32:35], 0
ds_read_b128 a[120:123], v2 offset:30720
v_mfma_f32_16x16x32_bf16 v[196:199], a[132:135], a[36:39], v[196:199]
v_mfma_f32_16x16x32_bf16 v[204:207], a[128:131], a[40:43], 0
ds_read_b128 a[124:127], v3 offset:30720
v_mfma_f32_16x16x32_bf16 v[204:207], a[132:135], a[44:47], v[204:207]
v_mfma_f32_16x16x32_bf16 v[212:215], a[128:131], a[48:51], 0
v_mfma_f32_16x16x32_bf16 v[212:215], a[132:135], a[52:55], v[212:215]
buffer_store_dwordx4 v[120:123], v1, s[4:7], s31 offen sc1
v_mfma_f32_16x16x32_bf16 v[220:223], a[128:131], a[56:59], 0
s_add_u32 s31, s31, s34
v_mfma_f32_16x16x32_bf16 v[220:223], a[132:135], a[60:63], v[220:223]
s_waitcnt vmcnt(28) lgkmcnt(0)
s_barrier
v_mfma_f32_16x16x32_bf16 v[224:227], a[136:139], a[0:3], 0
s_add_u32 m0, s29, 131072
ds_read_b64_tr_b16 a[128:129], v22 offset:0
v_mfma_f32_16x16x32_bf16 v[224:227], a[140:143], a[4:7], v[224:227]
buffer_load_dwordx4 v16, s[12:15], s26 offen offset:0 lds
v_mfma_f32_16x16x32_bf16 v[228:231], a[136:139], a[8:11], 0
ds_read_b64_tr_b16 a[130:131], v22 offset:2048
v_mfma_f32_16x16x32_bf16 v[228:231], a[140:143], a[12:15], v[228:231]
v_mfma_f32_16x16x32_bf16 v[232:235], a[136:139], a[16:19], 0
ds_read_b64_tr_b16 a[132:133], v22 offset:16384
v_mfma_f32_16x16x32_bf16 v[232:235], a[140:143], a[20:23], v[232:235]
buffer_load_dwordx4 v17, s[12:15], s26 offen offset:1024 lds
v_mfma_f32_16x16x32_bf16 v[236:239], a[136:139], a[24:27], 0
ds_read_b64_tr_b16 a[134:135], v22 offset:18432
v_add_u32 v22, 32768, v22
v_mfma_f32_16x16x32_bf16 v[236:239], a[140:143], a[28:31], v[236:239]
v_mfma_f32_16x16x32_bf16 v[240:243], a[136:139], a[32:35], 0
v_mfma_f32_16x16x32_bf16 v[240:243], a[140:143], a[36:39], v[240:243]
buffer_load_dwordx4 v18, s[12:15], s26 offen offset:2048 lds
v_mfma_f32_16x16x32_bf16 v[244:247], a[136:139], a[40:43], 0
v_mfma_f32_16x16x32_bf16 v[244:247], a[140:143], a[44:47], v[244:247]
v_mfma_f32_16x16x32_bf16 v[248:251], a[136:139], a[48:51], 0
v_mfma_f32_16x16x32_bf16 v[248:251], a[140:143], a[52:55], v[248:251]
buffer_load_dwordx4 v19, s[12:15], s26 offen offset:3072 lds
v_mfma_f32_16x16x32_bf16 v[252:255], a[136:139], a[56:59], 0
s_add_u32 s26, s26, 524288
v_mfma_f32_16x16x32_bf16 v[252:255], a[140:143], a[60:63], v[252:255]
s_waitcnt lgkmcnt(0)
v_mfma_f32_16x16x32_bf16 v[36:39], a[128:131], a[64:67], v[36:39]
s_add_u32 m0, s29, 147456
ds_read_b64_tr_b16 a[136:137], v23 offset:0
v_mfma_f32_16x16x32_bf16 v[36:39], a[132:135], a[68:71], v[36:39]
buffer_load_dwordx4 v16, s[12:15], s27 offen offset:0 lds
v_mfma_f32_16x16x32_bf16 v[44:47], a[128:131], a[72:75], v[44:47]
ds_read_b64_tr_b16 a[138:139], v23 offset:2048
v_mfma_f32_16x16x32_bf16 v[44:47], a[132:135], a[76:79], v[44:47]
ds_read_b128 a[0:3], v2 offset:32768
ds_read_b128 a[4:7], v3 offset:32768
v_mfma_f32_16x16x32_bf16 v[52:55], a[128:131], a[80:83], v[52:55]
ds_read_b64_tr_b16 a[140:141], v23 offset:16384
v_mfma_f32_16x16x32_bf16 v[52:55], a[132:135], a[84:87], v[52:55]
buffer_load_dwordx4 v17, s[12:15], s27 offen offset:1024 lds
v_mfma_f32_16x16x32_bf16 v[60:63], a[128:131], a[88:91], v[60:63]
ds_read_b64_tr_b16 a[142:143], v23 offset:18432
v_add_u32 v23, 32768, v23
v_mfma_f32_16x16x32_bf16 v[60:63], a[132:135], a[92:95], v[60:63]
buffer_store_dwordx4 v[128:131], v1, s[4:7], s31 offen sc1
v_mfma_f32_16x16x32_bf16 v[68:71], a[128:131], a[96:99], v[68:71]
s_add_u32 s31, s31, s32
ds_read_b128 a[8:11], v2 offset:34816
v_accvgpr_read_b32 v32, a192
v_mfma_f32_16x16x32_bf16 v[68:71], a[132:135], a[100:103], v[68:71]
buffer_load_dwordx4 v18, s[12:15], s27 offen offset:2048 lds
v_mfma_f32_16x16x32_bf16 v[76:79], a[128:131], a[104:107], v[76:79]
ds_read_b128 a[12:15], v3 offset:34816
v_accvgpr_read_b32 v33, a193
v_mfma_f32_16x16x32_bf16 v[76:79], a[132:135], a[108:111], v[76:79]
ds_read_b128 a[16:19], v2 offset:36864
v_accvgpr_read_b32 v34, a194
v_mfma_f32_16x16x32_bf16 v[84:87], a[128:131], a[112:115], v[84:87]
ds_read_b128 a[20:23], v3 offset:36864
v_accvgpr_read_b32 v35, a195
v_mfma_f32_16x16x32_bf16 v[84:87], a[132:135], a[116:119], v[84:87]
buffer_load_dwordx4 v19, s[12:15], s27 offen offset:3072 lds
v_mfma_f32_16x16x32_bf16 v[92:95], a[128:131], a[120:123], v[92:95]
s_add_u32 s27, s27, 524288
ds_read_b128 a[24:27], v2 offset:38912
v_accvgpr_read_b32 v96, a196
v_mfma_f32_16x16x32_bf16 v[92:95], a[132:135], a[124:127], v[92:95]
s_waitcnt lgkmcnt(5)
buffer_store_dwordx4 v[136:139], v1, s[4:7], s31 offen sc1
v_mfma_f32_16x16x32_bf16 v[100:103], a[136:139], a[64:67], v[100:103]
s_add_u32 m0, s28, 16384
ds_read_b64_tr_b16 a[128:129], v24 offset:0
v_accvgpr_read_b32 v97, a197
v_mfma_f32_16x16x32_bf16 v[100:103], a[140:143], a[68:71], v[100:103]
s_add_u32 s31, s31, s33
buffer_load_dwordx4 v12, s[8:11], s24 offen offset:0 lds
v_mfma_f32_16x16x32_bf16 v[108:111], a[136:139], a[72:75], v[108:111]
ds_read_b64_tr_b16 a[130:131], v24 offset:2048
v_accvgpr_read_b32 v98, a198
v_mfma_f32_16x16x32_bf16 v[108:111], a[140:143], a[76:79], v[108:111]
ds_read_b128 a[28:31], v3 offset:38912
v_accvgpr_read_b32 v99, a199
v_mfma_f32_16x16x32_bf16 v[116:119], a[136:139], a[80:83], v[116:119]
ds_read_b64_tr_b16 a[132:133], v24 offset:16384
v_cvt_pk_bf16_f32 v32, v32, v33
v_mfma_f32_16x16x32_bf16 v[116:119], a[140:143], a[84:87], v[116:119]
buffer_load_dwordx4 v13, s[8:11], s24 offen offset:1024 lds
v_mfma_f32_16x16x32_bf16 v[124:127], a[136:139], a[88:91], v[124:127]
ds_read_b64_tr_b16 a[134:135], v24 offset:18432
v_add_u32 v24, 32768, v24
v_mfma_f32_16x16x32_bf16 v[124:127], a[140:143], a[92:95], v[124:127]
v_cvt_pk_bf16_f32 v33, v34, v35
v_cvt_pk_bf16_f32 v34, v96, v97
v_mfma_f32_16x16x32_bf16 v[132:135], a[136:139], a[96:99], v[132:135]
ds_read_b128 a[32:35], v2 offset:40960
v_cvt_pk_bf16_f32 v35, v98, v99
v_mfma_f32_16x16x32_bf16 v[132:135], a[140:143], a[100:103], v[132:135]
buffer_load_dwordx4 v14, s[8:11], s24 offen offset:2048 lds
v_mfma_f32_16x16x32_bf16 v[140:143], a[136:139], a[104:107], v[140:143]
ds_read_b128 a[36:39], v3 offset:40960
v_accvgpr_read_b32 v40, a200
v_mfma_f32_16x16x32_bf16 v[140:143], a[140:143], a[108:111], v[140:143]
ds_read_b128 a[40:43], v2 offset:43008
v_accvgpr_read_b32 v41, a201
v_mfma_f32_16x16x32_bf16 v[148:151], a[136:139], a[112:115], v[148:151]
ds_read_b128 a[44:47], v3 offset:43008
v_accvgpr_read_b32 v42, a202
v_mfma_f32_16x16x32_bf16 v[148:151], a[140:143], a[116:119], v[148:151]
buffer_load_dwordx4 v15, s[8:11], s24 offen offset:3072 lds
v_mfma_f32_16x16x32_bf16 v[156:159], a[136:139], a[120:123], v[156:159]
s_add_u32 s24, s24, 128
ds_read_b128 a[48:51], v2 offset:45056
v_accvgpr_read_b32 v43, a203
v_mfma_f32_16x16x32_bf16 v[156:159], a[140:143], a[124:127], v[156:159]
s_waitcnt lgkmcnt(5)
buffer_store_dwordx4 v[144:147], v1, s[4:7], s31 offen sc1
v_mfma_f32_16x16x32_bf16 v[164:167], a[128:131], a[64:67], v[164:167]
s_add_u32 s31, s31, s32
ds_read_b64_tr_b16 a[136:137], v25 offset:0
v_accvgpr_read_b32 v96, a204
v_mfma_f32_16x16x32_bf16 v[164:167], a[132:135], a[68:71], v[164:167]
v_accvgpr_read_b32 v97, a205
v_accvgpr_read_b32 v98, a206
v_mfma_f32_16x16x32_bf16 v[172:175], a[128:131], a[72:75], v[172:175]
ds_read_b64_tr_b16 a[138:139], v25 offset:2048
v_accvgpr_read_b32 v99, a207
v_mfma_f32_16x16x32_bf16 v[172:175], a[132:135], a[76:79], v[172:175]
ds_read_b128 a[52:55], v3 offset:45056
v_cvt_pk_bf16_f32 v40, v40, v41
v_mfma_f32_16x16x32_bf16 v[180:183], a[128:131], a[80:83], v[180:183]
ds_read_b64_tr_b16 a[140:141], v25 offset:16384
v_cvt_pk_bf16_f32 v41, v42, v43
v_mfma_f32_16x16x32_bf16 v[180:183], a[132:135], a[84:87], v[180:183]
v_cvt_pk_bf16_f32 v42, v96, v97
v_cvt_pk_bf16_f32 v43, v98, v99
v_mfma_f32_16x16x32_bf16 v[188:191], a[128:131], a[88:91], v[188:191]
ds_read_b64_tr_b16 a[142:143], v25 offset:18432
v_add_u32 v25, 32768, v25
v_mfma_f32_16x16x32_bf16 v[188:191], a[132:135], a[92:95], v[188:191]
v_accvgpr_read_b32 v48, a208
v_accvgpr_read_b32 v49, a209
v_mfma_f32_16x16x32_bf16 v[196:199], a[128:131], a[96:99], v[196:199]
ds_read_b128 a[56:59], v2 offset:47104
v_accvgpr_read_b32 v50, a210
v_mfma_f32_16x16x32_bf16 v[196:199], a[132:135], a[100:103], v[196:199]
v_accvgpr_read_b32 v51, a211
v_accvgpr_read_b32 v96, a212
v_mfma_f32_16x16x32_bf16 v[204:207], a[128:131], a[104:107], v[204:207]
ds_read_b128 a[60:63], v3 offset:47104
v_accvgpr_read_b32 v97, a213
v_mfma_f32_16x16x32_bf16 v[204:207], a[132:135], a[108:111], v[204:207]
v_accvgpr_read_b32 v98, a214
v_accvgpr_read_b32 v99, a215
v_mfma_f32_16x16x32_bf16 v[212:215], a[128:131], a[112:115], v[212:215]
v_cvt_pk_bf16_f32 v48, v48, v49
v_cvt_pk_bf16_f32 v49, v50, v51
v_mfma_f32_16x16x32_bf16 v[212:215], a[132:135], a[116:119], v[212:215]
buffer_store_dwordx4 v[152:155], v1, s[4:7], s31 offen sc1
v_mfma_f32_16x16x32_bf16 v[220:223], a[128:131], a[120:123], v[220:223]
s_add_u32 s31, s31, s36
v_cvt_pk_bf16_f32 v50, v96, v97
v_cvt_pk_bf16_f32 v51, v98, v99
v_mfma_f32_16x16x32_bf16 v[220:223], a[132:135], a[124:127], v[220:223]
s_waitcnt vmcnt(23) lgkmcnt(0)
s_barrier
v_accvgpr_read_b32 v56, a216
v_mfma_f32_16x16x32_bf16 v[224:227], a[136:139], a[64:67], v[224:227]
s_add_u32 m0, s29, 65536
ds_read_b64_tr_b16 a[128:129], v22 offset:0
v_accvgpr_read_b32 v57, a217
v_mfma_f32_16x16x32_bf16 v[224:227], a[140:143], a[68:71], v[224:227]
buffer_load_dwordx4 v16, s[12:15], s26 offen offset:0 lds
v_mfma_f32_16x16x32_bf16 v[228:231], a[136:139], a[72:75], v[228:231]
ds_read_b64_tr_b16 a[130:131], v22 offset:2048
v_accvgpr_read_b32 v58, a218
v_mfma_f32_16x16x32_bf16 v[228:231], a[140:143], a[76:79], v[228:231]
v_accvgpr_read_b32 v59, a219
v_accvgpr_read_b32 v96, a220
v_mfma_f32_16x16x32_bf16 v[232:235], a[136:139], a[80:83], v[232:235]
ds_read_b64_tr_b16 a[132:133], v22 offset:16384
v_accvgpr_read_b32 v97, a221
v_mfma_f32_16x16x32_bf16 v[232:235], a[140:143], a[84:87], v[232:235]
buffer_load_dwordx4 v17, s[12:15], s26 offen offset:1024 lds
v_mfma_f32_16x16x32_bf16 v[236:239], a[136:139], a[88:91], v[236:239]
ds_read_b64_tr_b16 a[134:135], v22 offset:18432
v_add_u32 v22, 32768, v22
v_mfma_f32_16x16x32_bf16 v[236:239], a[140:143], a[92:95], v[236:239]
v_accvgpr_read_b32 v98, a222
v_accvgpr_read_b32 v99, a223
v_mfma_f32_16x16x32_bf16 v[240:243], a[136:139], a[96:99], v[240:243]
v_cvt_pk_bf16_f32 v56, v56, v57
v_cvt_pk_bf16_f32 v57, v58, v59
v_mfma_f32_16x16x32_bf16 v[240:243], a[140:143], a[100:103], v[240:243]
buffer_load_dwordx4 v18, s[12:15], s26 offen offset:2048 lds
v_mfma_f32_16x16x32_bf16 v[244:247], a[136:139], a[104:107], v[244:247]
v_cvt_pk_bf16_f32 v58, v96, v97
v_cvt_pk_bf16_f32 v59, v98, v99
v_mfma_f32_16x16x32_bf16 v[244:247], a[140:143], a[108:111], v[244:247]
v_accvgpr_read_b32 v64, a224
v_accvgpr_read_b32 v65, a225
v_mfma_f32_16x16x32_bf16 v[248:251], a[136:139], a[112:115], v[248:251]
v_accvgpr_read_b32 v66, a226
v_accvgpr_read_b32 v67, a227
v_mfma_f32_16x16x32_bf16 v[248:251], a[140:143], a[116:119], v[248:251]
buffer_load_dwordx4 v19, s[12:15], s26 offen offset:3072 lds
v_mfma_f32_16x16x32_bf16 v[252:255], a[136:139], a[120:123], v[252:255]
s_add_u32 s26, s26, 524288
v_accvgpr_read_b32 v96, a228
v_accvgpr_read_b32 v97, a229
v_mfma_f32_16x16x32_bf16 v[252:255], a[140:143], a[124:127], v[252:255]
s_waitcnt lgkmcnt(0)
v_accvgpr_read_b32 v98, a230
v_accvgpr_read_b32 v99, a231
v_mfma_f32_16x16x32_bf16 v[36:39], a[128:131], a[0:3], v[36:39]
s_add_u32 m0, s29, 81920
ds_read_b64_tr_b16 a[136:137], v23 offset:0
v_cvt_pk_bf16_f32 v64, v64, v65
v_mfma_f32_16x16x32_bf16 v[36:39], a[132:135], a[4:7], v[36:39]
buffer_load_dwordx4 v16, s[12:15], s27 offen offset:0 lds
v_mfma_f32_16x16x32_bf16 v[44:47], a[128:131], a[8:11], v[44:47]
ds_read_b64_tr_b16 a[138:139], v23 offset:2048
v_cvt_pk_bf16_f32 v65, v66, v67
v_mfma_f32_16x16x32_bf16 v[44:47], a[132:135], a[12:15], v[44:47]
ds_read_b128 a[64:67], v2 offset:49152
ds_read_b128 a[68:71], v3 offset:49152
v_mfma_f32_16x16x32_bf16 v[52:55], a[128:131], a[16:19], v[52:55]
ds_read_b64_tr_b16 a[140:141], v23 offset:16384
v_cvt_pk_bf16_f32 v66, v96, v97
v_mfma_f32_16x16x32_bf16 v[52:55], a[132:135], a[20:23], v[52:55]
buffer_load_dwordx4 v17, s[12:15], s27 offen offset:1024 lds
v_mfma_f32_16x16x32_bf16 v[60:63], a[128:131], a[24:27], v[60:63]
ds_read_b64_tr_b16 a[142:143], v23 offset:18432
v_add_u32 v23, 32768, v23
v_mfma_f32_16x16x32_bf16 v[60:63], a[132:135], a[28:31], v[60:63]
buffer_store_dwordx4 v[160:163], v1, s[4:7], s31 offen sc1
v_mfma_f32_16x16x32_bf16 v[68:71], a[128:131], a[32:35], v[68:71]
s_add_u32 s31, s31, s32
ds_read_b128 a[72:75], v2 offset:51200
v_cvt_pk_bf16_f32 v67, v98, v99
v_mfma_f32_16x16x32_bf16 v[68:71], a[132:135], a[36:39], v[68:71]
buffer_load_dwordx4 v18, s[12:15], s27 offen offset:2048 lds
v_mfma_f32_16x16x32_bf16 v[76:79], a[128:131], a[40:43], v[76:79]
ds_read_b128 a[76:79], v3 offset:51200
v_accvgpr_read_b32 v72, a232
v_mfma_f32_16x16x32_bf16 v[76:79], a[132:135], a[44:47], v[76:79]
ds_read_b128 a[80:83], v2 offset:53248
v_accvgpr_read_b32 v73, a233
v_mfma_f32_16x16x32_bf16 v[84:87], a[128:131], a[48:51], v[84:87]
ds_read_b128 a[84:87], v3 offset:53248
v_accvgpr_read_b32 v74, a234
v_mfma_f32_16x16x32_bf16 v[84:87], a[132:135], a[52:55], v[84:87]
buffer_load_dwordx4 v19, s[12:15], s27 offen offset:3072 lds
v_mfma_f32_16x16x32_bf16 v[92:95], a[128:131], a[56:59], v[92:95]
s_add_u32 s27, s27, 524288
ds_read_b128 a[88:91], v2 offset:55296
v_accvgpr_read_b32 v75, a235
v_mfma_f32_16x16x32_bf16 v[92:95], a[132:135], a[60:63], v[92:95]
s_waitcnt lgkmcnt(5)
buffer_store_dwordx4 v[168:171], v1, s[4:7], s31 offen sc1
v_mfma_f32_16x16x32_bf16 v[100:103], a[136:139], a[0:3], v[100:103]
s_add_u32 m0, s28, 32768
ds_read_b64_tr_b16 a[128:129], v24 offset:0
v_accvgpr_read_b32 v96, a236
v_mfma_f32_16x16x32_bf16 v[100:103], a[140:143], a[4:7], v[100:103]
s_add_u32 s31, s31, s33
buffer_load_dwordx4 v12, s[8:11], s24 offen offset:0 lds
v_mfma_f32_16x16x32_bf16 v[108:111], a[136:139], a[8:11], v[108:111]
ds_read_b64_tr_b16 a[130:131], v24 offset:2048
v_accvgpr_read_b32 v97, a237
v_mfma_f32_16x16x32_bf16 v[108:111], a[140:143], a[12:15], v[108:111]
ds_read_b128 a[92:95], v3 offset:55296
v_accvgpr_read_b32 v98, a238
v_mfma_f32_16x16x32_bf16 v[116:119], a[136:139], a[16:19], v[116:119]
ds_read_b64_tr_b16 a[132:133], v24 offset:16384
v_accvgpr_read_b32 v99, a239
v_mfma_f32_16x16x32_bf16 v[116:119], a[140:143], a[20:23], v[116:119]
buffer_load_dwordx4 v13, s[8:11], s24 offen offset:1024 lds
v_mfma_f32_16x16x32_bf16 v[124:127], a[136:139], a[24:27], v[124:127]
ds_read_b64_tr_b16 a[134:135], v24 offset:18432
v_add_u32 v24, 32768, v24
v_mfma_f32_16x16x32_bf16 v[124:127], a[140:143], a[28:31], v[124:127]
v_cvt_pk_bf16_f32 v72, v72, v73
v_cvt_pk_bf16_f32 v73, v74, v75
v_mfma_f32_16x16x32_bf16 v[132:135], a[136:139], a[32:35], v[132:135]
ds_read_b128 a[96:99], v2 offset:57344
v_cvt_pk_bf16_f32 v74, v96, v97
v_mfma_f32_16x16x32_bf16 v[132:135], a[140:143], a[36:39], v[132:135]
buffer_load_dwordx4 v14, s[8:11], s24 offen offset:2048 lds
v_mfma_f32_16x16x32_bf16 v[140:143], a[136:139], a[40:43], v[140:143]
ds_read_b128 a[100:103], v3 offset:57344
v_cvt_pk_bf16_f32 v75, v98, v99
v_mfma_f32_16x16x32_bf16 v[140:143], a[140:143], a[44:47], v[140:143]
ds_read_b128 a[104:107], v2 offset:59392
v_accvgpr_read_b32 v80, a240
v_mfma_f32_16x16x32_bf16 v[148:151], a[136:139], a[48:51], v[148:151]
ds_read_b128 a[108:111], v3 offset:59392
v_accvgpr_read_b32 v81, a241
v_mfma_f32_16x16x32_bf16 v[148:151], a[140:143], a[52:55], v[148:151]
buffer_load_dwordx4 v15, s[8:11], s24 offen offset:3072 lds
v_mfma_f32_16x16x32_bf16 v[156:159], a[136:139], a[56:59], v[156:159]
s_add_u32 s24, s24, 128
ds_read_b128 a[112:115], v2 offset:61440
v_accvgpr_read_b32 v82, a242
v_mfma_f32_16x16x32_bf16 v[156:159], a[140:143], a[60:63], v[156:159]
s_waitcnt lgkmcnt(5)
buffer_store_dwordx4 v[176:179], v1, s[4:7], s31 offen sc1
v_mfma_f32_16x16x32_bf16 v[164:167], a[128:131], a[0:3], v[164:167]
s_add_u32 s31, s31, s32
ds_read_b64_tr_b16 a[136:137], v25 offset:0
v_accvgpr_read_b32 v83, a243
v_mfma_f32_16x16x32_bf16 v[164:167], a[132:135], a[4:7], v[164:167]
v_accvgpr_read_b32 v96, a244
v_accvgpr_read_b32 v97, a245
v_mfma_f32_16x16x32_bf16 v[172:175], a[128:131], a[8:11], v[172:175]
ds_read_b64_tr_b16 a[138:139], v25 offset:2048
v_accvgpr_read_b32 v98, a246
v_mfma_f32_16x16x32_bf16 v[172:175], a[132:135], a[12:15], v[172:175]
ds_read_b128 a[116:119], v3 offset:61440
v_accvgpr_read_b32 v99, a247
v_mfma_f32_16x16x32_bf16 v[180:183], a[128:131], a[16:19], v[180:183]
ds_read_b64_tr_b16 a[140:141], v25 offset:16384
v_cvt_pk_bf16_f32 v80, v80, v81
v_mfma_f32_16x16x32_bf16 v[180:183], a[132:135], a[20:23], v[180:183]
buffer_store_dwordx4 v[184:187], v1, s[4:7], s31 offen sc1
v_mfma_f32_16x16x32_bf16 v[188:191], a[128:131], a[24:27], v[188:191]
s_add_u32 s31, s31, s34
ds_read_b64_tr_b16 a[142:143], v25 offset:18432
v_add_u32 v25, 32768, v25
v_mfma_f32_16x16x32_bf16 v[188:191], a[132:135], a[28:31], v[188:191]
v_cvt_pk_bf16_f32 v81, v82, v83
v_cvt_pk_bf16_f32 v82, v96, v97
v_mfma_f32_16x16x32_bf16 v[196:199], a[128:131], a[32:35], v[196:199]
ds_read_b128 a[120:123], v2 offset:63488
v_cvt_pk_bf16_f32 v83, v98, v99
v_mfma_f32_16x16x32_bf16 v[196:199], a[132:135], a[36:39], v[196:199]
v_accvgpr_read_b32 v88, a248
v_accvgpr_read_b32 v89, a249
v_mfma_f32_16x16x32_bf16 v[204:207], a[128:131], a[40:43], v[204:207]
ds_read_b128 a[124:127], v3 offset:63488
v_accvgpr_read_b32 v90, a250
v_mfma_f32_16x16x32_bf16 v[204:207], a[132:135], a[44:47], v[204:207]
v_accvgpr_read_b32 v91, a251
v_accvgpr_read_b32 v96, a252
v_mfma_f32_16x16x32_bf16 v[212:215], a[128:131], a[48:51], v[212:215]
v_accvgpr_read_b32 v97, a253
v_accvgpr_read_b32 v98, a254
v_mfma_f32_16x16x32_bf16 v[212:215], a[132:135], a[52:55], v[212:215]
v_accvgpr_read_b32 v99, a255
v_cvt_pk_bf16_f32 v88, v88, v89
v_mfma_f32_16x16x32_bf16 v[220:223], a[128:131], a[56:59], v[220:223]
v_cvt_pk_bf16_f32 v89, v90, v91
v_cvt_pk_bf16_f32 v90, v96, v97
v_mfma_f32_16x16x32_bf16 v[220:223], a[132:135], a[60:63], v[220:223]
s_waitcnt vmcnt(23) lgkmcnt(0)
s_barrier
v_cvt_pk_bf16_f32 v91, v98, v99
v_mfma_f32_16x16x32_bf16 v[224:227], a[136:139], a[0:3], v[224:227]
s_add_u32 m0, s29, 98304
ds_read_b64_tr_b16 a[128:129], v22 offset:0
v_mfma_f32_16x16x32_bf16 v[224:227], a[140:143], a[4:7], v[224:227]
buffer_load_dwordx4 v16, s[12:15], s26 offen offset:0 lds
v_mfma_f32_16x16x32_bf16 v[228:231], a[136:139], a[8:11], v[228:231]
ds_read_b64_tr_b16 a[130:131], v22 offset:2048
v_mfma_f32_16x16x32_bf16 v[228:231], a[140:143], a[12:15], v[228:231]
buffer_store_dwordx4 v[192:195], v1, s[4:7], s31 offen sc1
v_mfma_f32_16x16x32_bf16 v[232:235], a[136:139], a[16:19], v[232:235]
s_add_u32 s31, s31, s32
ds_read_b64_tr_b16 a[132:133], v22 offset:16384
v_mfma_f32_16x16x32_bf16 v[232:235], a[140:143], a[20:23], v[232:235]
buffer_load_dwordx4 v17, s[12:15], s26 offen offset:1024 lds
v_mfma_f32_16x16x32_bf16 v[236:239], a[136:139], a[24:27], v[236:239]
ds_read_b64_tr_b16 a[134:135], v22 offset:18432
v_add_u32 v22, 4294901760, v22
v_mfma_f32_16x16x32_bf16 v[236:239], a[140:143], a[28:31], v[236:239]
v_mfma_f32_16x16x32_bf16 v[240:243], a[136:139], a[32:35], v[240:243]
v_mfma_f32_16x16x32_bf16 v[240:243], a[140:143], a[36:39], v[240:243]
buffer_load_dwordx4 v18, s[12:15], s26 offen offset:2048 lds
v_mfma_f32_16x16x32_bf16 v[244:247], a[136:139], a[40:43], v[244:247]
v_mfma_f32_16x16x32_bf16 v[244:247], a[140:143], a[44:47], v[244:247]
v_mfma_f32_16x16x32_bf16 v[248:251], a[136:139], a[48:51], v[248:251]
v_mfma_f32_16x16x32_bf16 v[248:251], a[140:143], a[52:55], v[248:251]
buffer_load_dwordx4 v19, s[12:15], s26 offen offset:3072 lds
v_mfma_f32_16x16x32_bf16 v[252:255], a[136:139], a[56:59], v[252:255]
s_add_u32 s26, s26, 524288
v_mfma_f32_16x16x32_bf16 v[252:255], a[140:143], a[60:63], v[252:255]
s_waitcnt lgkmcnt(0)
v_mfma_f32_16x16x32_bf16 v[36:39], a[128:131], a[64:67], v[36:39]
s_add_u32 m0, s29, 114688
ds_read_b64_tr_b16 a[136:137], v23 offset:0
v_mfma_f32_16x16x32_bf16 v[36:39], a[132:135], a[68:71], v[36:39]
buffer_load_dwordx4 v16, s[12:15], s27 offen offset:0 lds
v_mfma_f32_16x16x32_bf16 v[44:47], a[128:131], a[72:75], v[44:47]
ds_read_b64_tr_b16 a[138:139], v23 offset:2048
v_mfma_f32_16x16x32_bf16 v[44:47], a[132:135], a[76:79], v[44:47]
ds_read_b128 a[0:3], v2 offset:0
ds_read_b128 a[4:7], v3 offset:0
v_mfma_f32_16x16x32_bf16 v[52:55], a[128:131], a[80:83], v[52:55]
ds_read_b64_tr_b16 a[140:141], v23 offset:16384
v_mfma_f32_16x16x32_bf16 v[52:55], a[132:135], a[84:87], v[52:55]
buffer_load_dwordx4 v17, s[12:15], s27 offen offset:1024 lds
v_mfma_f32_16x16x32_bf16 v[60:63], a[128:131], a[88:91], v[60:63]
ds_read_b64_tr_b16 a[142:143], v23 offset:18432
v_add_u32 v23, 4294901760, v23
v_mfma_f32_16x16x32_bf16 v[60:63], a[132:135], a[92:95], v[60:63]
buffer_store_dwordx4 v[200:203], v1, s[4:7], s31 offen sc1
v_mfma_f32_16x16x32_bf16 v[68:71], a[128:131], a[96:99], v[68:71]
s_add_u32 s31, s31, s33
ds_read_b128 a[8:11], v2 offset:2048
v_mfma_f32_16x16x32_bf16 v[68:71], a[132:135], a[100:103], v[68:71]
buffer_load_dwordx4 v18, s[12:15], s27 offen offset:2048 lds
v_mfma_f32_16x16x32_bf16 v[76:79], a[128:131], a[104:107], v[76:79]
ds_read_b128 a[12:15], v3 offset:2048
v_mfma_f32_16x16x32_bf16 v[76:79], a[132:135], a[108:111], v[76:79]
ds_read_b128 a[16:19], v2 offset:4096
v_mfma_f32_16x16x32_bf16 v[84:87], a[128:131], a[112:115], v[84:87]
ds_read_b128 a[20:23], v3 offset:4096
v_mfma_f32_16x16x32_bf16 v[84:87], a[132:135], a[116:119], v[84:87]
buffer_load_dwordx4 v19, s[12:15], s27 offen offset:3072 lds
v_mfma_f32_16x16x32_bf16 v[92:95], a[128:131], a[120:123], v[92:95]
s_add_u32 s27, s27, 524288
ds_read_b128 a[24:27], v2 offset:6144
v_mfma_f32_16x16x32_bf16 v[92:95], a[132:135], a[124:127], v[92:95]
s_waitcnt lgkmcnt(5)
buffer_store_dwordx4 v[208:211], v1, s[4:7], s31 offen sc1
v_mfma_f32_16x16x32_bf16 v[100:103], a[136:139], a[64:67], v[100:103]
s_add_u32 s31, s31, s32
ds_read_b64_tr_b16 a[128:129], v24 offset:0
v_mfma_f32_16x16x32_bf16 v[100:103], a[140:143], a[68:71], v[100:103]
v_mfma_f32_16x16x32_bf16 v[108:111], a[136:139], a[72:75], v[108:111]
ds_read_b64_tr_b16 a[130:131], v24 offset:2048
v_mfma_f32_16x16x32_bf16 v[108:111], a[140:143], a[76:79], v[108:111]
ds_read_b128 a[28:31], v3 offset:6144
v_mfma_f32_16x16x32_bf16 v[116:119], a[136:139], a[80:83], v[116:119]
ds_read_b64_tr_b16 a[132:133], v24 offset:16384
v_mfma_f32_16x16x32_bf16 v[116:119], a[140:143], a[84:87], v[116:119]
v_mfma_f32_16x16x32_bf16 v[124:127], a[136:139], a[88:91], v[124:127]
ds_read_b64_tr_b16 a[134:135], v24 offset:18432
v_add_u32 v24, 4294901760, v24
v_mfma_f32_16x16x32_bf16 v[124:127], a[140:143], a[92:95], v[124:127]
v_mfma_f32_16x16x32_bf16 v[132:135], a[136:139], a[96:99], v[132:135]
ds_read_b128 a[32:35], v2 offset:8192
v_mfma_f32_16x16x32_bf16 v[132:135], a[140:143], a[100:103], v[132:135]
buffer_store_dwordx4 v[216:219], v1, s[4:7], s31 offen sc1
v_mfma_f32_16x16x32_bf16 v[140:143], a[136:139], a[104:107], v[140:143]
s_add_u32 s31, s31, s35
ds_read_b128 a[36:39], v3 offset:8192
v_mfma_f32_16x16x32_bf16 v[140:143], a[140:143], a[108:111], v[140:143]
ds_read_b128 a[40:43], v2 offset:10240
v_mfma_f32_16x16x32_bf16 v[148:151], a[136:139], a[112:115], v[148:151]
ds_read_b128 a[44:47], v3 offset:10240
v_mfma_f32_16x16x32_bf16 v[148:151], a[140:143], a[116:119], v[148:151]
v_mfma_f32_16x16x32_bf16 v[156:159], a[136:139], a[120:123], v[156:159]
ds_read_b128 a[48:51], v2 offset:12288
v_mfma_f32_16x16x32_bf16 v[156:159], a[140:143], a[124:127], v[156:159]
s_waitcnt lgkmcnt(5)
v_mfma_f32_16x16x32_bf16 v[164:167], a[128:131], a[64:67], v[164:167]
ds_read_b64_tr_b16 a[136:137], v25 offset:0
v_mfma_f32_16x16x32_bf16 v[164:167], a[132:135], a[68:71], v[164:167]
v_mfma_f32_16x16x32_bf16 v[172:175], a[128:131], a[72:75], v[172:175]
ds_read_b64_tr_b16 a[138:139], v25 offset:2048
v_mfma_f32_16x16x32_bf16 v[172:175], a[132:135], a[76:79], v[172:175]
ds_read_b128 a[52:55], v3 offset:12288
v_mfma_f32_16x16x32_bf16 v[180:183], a[128:131], a[80:83], v[180:183]
ds_read_b64_tr_b16 a[140:141], v25 offset:16384
v_mfma_f32_16x16x32_bf16 v[180:183], a[132:135], a[84:87], v[180:183]
buffer_store_dwordx4 v[32:35], v1, s[4:7], s31 offen sc1
v_mfma_f32_16x16x32_bf16 v[188:191], a[128:131], a[88:91], v[188:191]
s_add_u32 s31, s31, s32
ds_read_b64_tr_b16 a[142:143], v25 offset:18432
v_add_u32 v25, 4294901760, v25
v_mfma_f32_16x16x32_bf16 v[188:191], a[132:135], a[92:95], v[188:191]
v_mfma_f32_16x16x32_bf16 v[196:199], a[128:131], a[96:99], v[196:199]
ds_read_b128 a[56:59], v2 offset:14336
v_mfma_f32_16x16x32_bf16 v[196:199], a[132:135], a[100:103], v[196:199]
v_mfma_f32_16x16x32_bf16 v[204:207], a[128:131], a[104:107], v[204:207]
ds_read_b128 a[60:63], v3 offset:14336
v_mfma_f32_16x16x32_bf16 v[204:207], a[132:135], a[108:111], v[204:207]
v_mfma_f32_16x16x32_bf16 v[212:215], a[128:131], a[112:115], v[212:215]
v_mfma_f32_16x16x32_bf16 v[212:215], a[132:135], a[116:119], v[212:215]
v_mfma_f32_16x16x32_bf16 v[220:223], a[128:131], a[120:123], v[220:223]
v_mfma_f32_16x16x32_bf16 v[220:223], a[132:135], a[124:127], v[220:223]
s_waitcnt vmcnt(20) lgkmcnt(0)
s_barrier
v_mfma_f32_16x16x32_bf16 v[224:227], a[136:139], a[64:67], v[224:227]
s_add_u32 m0, s29, 131072
ds_read_b64_tr_b16 a[128:129], v22 offset:0
v_mfma_f32_16x16x32_bf16 v[224:227], a[140:143], a[68:71], v[224:227]
buffer_load_dwordx4 v16, s[12:15], s26 offen offset:0 lds
v_mfma_f32_16x16x32_bf16 v[228:231], a[136:139], a[72:75], v[228:231]
ds_read_b64_tr_b16 a[130:131], v22 offset:2048
v_mfma_f32_16x16x32_bf16 v[228:231], a[140:143], a[76:79], v[228:231]
PAD_7:
s_cbranch_execz M_tret
buffer_store_dwordx4 v[40:43], v1, s[4:7], s31 offen sc1
v_mfma_f32_16x16x32_bf16 v[232:235], a[136:139], a[80:83], v[232:235]
s_add_u32 s31, s31, s33
ds_read_b64_tr_b16 a[132:133], v22 offset:16384
v_mfma_f32_16x16x32_bf16 v[232:235], a[140:143], a[84:87], v[232:235]
buffer_load_dwordx4 v17, s[12:15], s26 offen offset:1024 lds
v_mfma_f32_16x16x32_bf16 v[236:239], a[136:139], a[88:91], v[236:239]
ds_read_b64_tr_b16 a[134:135], v22 offset:18432
v_add_u32 v22, 32768, v22
v_mfma_f32_16x16x32_bf16 v[236:239], a[140:143], a[92:95], v[236:239]
v_mfma_f32_16x16x32_bf16 v[240:243], a[136:139], a[96:99], v[240:243]
v_mfma_f32_16x16x32_bf16 v[240:243], a[140:143], a[100:103], v[240:243]
buffer_load_dwordx4 v18, s[12:15], s26 offen offset:2048 lds
v_mfma_f32_16x16x32_bf16 v[244:247], a[136:139], a[104:107], v[244:247]
v_mfma_f32_16x16x32_bf16 v[244:247], a[140:143], a[108:111], v[244:247]
v_mfma_f32_16x16x32_bf16 v[248:251], a[136:139], a[112:115], v[248:251]
v_mfma_f32_16x16x32_bf16 v[248:251], a[140:143], a[116:119], v[248:251]
buffer_load_dwordx4 v19, s[12:15], s26 offen offset:3072 lds
v_mfma_f32_16x16x32_bf16 v[252:255], a[136:139], a[120:123], v[252:255]
s_add_u32 s26, s26, 524288
v_mfma_f32_16x16x32_bf16 v[252:255], a[140:143], a[124:127], v[252:255]
s_waitcnt lgkmcnt(0)
v_mfma_f32_16x16x32_bf16 v[36:39], a[128:131], a[0:3], v[36:39]
s_add_u32 m0, s29, 147456
ds_read_b64_tr_b16 a[136:137], v23 offset:0
v_mfma_f32_16x16x32_bf16 v[36:39], a[132:135], a[4:7], v[36:39]
buffer_load_dwordx4 v16, s[12:15], s27 offen offset:0 lds
v_mfma_f32_16x16x32_bf16 v[44:47], a[128:131], a[8:11], v[44:47]
s_lshl_b32 s22, s20, 7
ds_read_b64_tr_b16 a[138:139], v23 offset:2048
v_bfe_u32 v20, v1, 4, 3
v_mfma_f32_16x16x32_bf16 v[44:47], a[132:135], a[12:15], v[44:47]
s_add_u32 s70, s22, 94371840
ds_read_b128 a[64:67], v2 offset:16384
ds_read_b128 a[68:71], v3 offset:16384
v_mfma_f32_16x16x32_bf16 v[52:55], a[128:131], a[16:19], v[52:55]
s_lshr_b32 s22, s2, 4
ds_read_b64_tr_b16 a[140:141], v23 offset:16384
v_lshlrev_b32 v20, 3, v20
v_mfma_f32_16x16x32_bf16 v[52:55], a[132:135], a[20:23], v[52:55]
s_lshl_b32 s22, s22, 2
buffer_load_dwordx4 v17, s[12:15], s27 offen offset:1024 lds
v_mfma_f32_16x16x32_bf16 v[60:63], a[128:131], a[24:27], v[60:63]
s_add_u32 s66, s70, s22
ds_read_b64_tr_b16 a[142:143], v23 offset:18432
v_add_u32 v23, 32768, v23
v_mfma_f32_16x16x32_bf16 v[60:63], a[132:135], a[28:31], v[60:63]
s_and_b32 s22, s2, 16
buffer_store_dwordx4 v[48:51], v1, s[4:7], s31 offen sc1
v_mfma_f32_16x16x32_bf16 v[68:71], a[128:131], a[32:35], v[68:71]
s_add_u32 s31, s31, s32
ds_read_b128 a[72:75], v2 offset:18432
v_add_u32 v15, 2052, v20
v_mfma_f32_16x16x32_bf16 v[68:71], a[132:135], a[36:39], v[68:71]
s_lshl_b32 s22, s22, 7
buffer_load_dwordx4 v18, s[12:15], s27 offen offset:2048 lds
v_mfma_f32_16x16x32_bf16 v[76:79], a[128:131], a[40:43], v[76:79]
s_add_u32 s66, s66, s22
ds_read_b128 a[76:79], v3 offset:18432
v_mfma_f32_16x16x32_bf16 v[76:79], a[132:135], a[44:47], v[76:79]
s_lshl_b32 s67, s20, 20
ds_read_b128 a[80:83], v2 offset:20480
v_mfma_f32_16x16x32_bf16 v[84:87], a[128:131], a[48:51], v[84:87]
s_lshl_b32 s22, s37, 16
ds_read_b128 a[84:87], v3 offset:20480
v_mfma_f32_16x16x32_bf16 v[84:87], a[132:135], a[52:55], v[84:87]
s_add_u32 s67, s67, s22
buffer_load_dwordx4 v19, s[12:15], s27 offen offset:3072 lds
v_mfma_f32_16x16x32_bf16 v[92:95], a[128:131], a[56:59], v[92:95]
s_waitcnt lgkmcnt(5)
s_add_u32 s27, s27, 524288
ds_read_b128 a[88:91], v2 offset:22528
v_mfma_f32_16x16x32_bf16 v[92:95], a[132:135], a[60:63], v[92:95]
s_lshl_b32 s22, s3, 11
buffer_store_dwordx4 v[56:59], v1, s[4:7], s31 offen sc1
v_mfma_f32_16x16x32_bf16 v[100:103], a[136:139], a[0:3], v[100:103]
s_waitcnt lgkmcnt(5)
s_add_u32 s31, s31, s34
ds_read_b64_tr_b16 a[128:129], v24 offset:0
v_mfma_f32_16x16x32_bf16 v[100:103], a[140:143], a[4:7], v[100:103]
s_add_u32 s67, s67, s22
v_mfma_f32_16x16x32_bf16 v[108:111], a[136:139], a[8:11], v[108:111]
s_add_u32 s67, s67, 33554432
ds_read_b64_tr_b16 a[130:131], v24 offset:2048
v_mfma_f32_16x16x32_bf16 v[108:111], a[140:143], a[12:15], v[108:111]
s_mov_b32 s68, 1035512379
ds_read_b128 a[92:95], v3 offset:22528
v_mfma_f32_16x16x32_bf16 v[116:119], a[136:139], a[16:19], v[116:119]
s_mov_b32 s69, 1035512379
ds_read_b64_tr_b16 a[132:133], v24 offset:16384
v_mfma_f32_16x16x32_bf16 v[116:119], a[140:143], a[20:23], v[116:119]
buffer_store_dwordx4 v[64:67], v1, s[4:7], s31 offen sc1
v_mfma_f32_16x16x32_bf16 v[124:127], a[136:139], a[24:27], v[124:127]
s_add_u32 s31, s31, s32
ds_read_b64_tr_b16 a[134:135], v24 offset:18432
v_add_u32 v24, 32768, v24
v_mfma_f32_16x16x32_bf16 v[124:127], a[140:143], a[28:31], v[124:127]
v_mfma_f32_16x16x32_bf16 v[132:135], a[136:139], a[32:35], v[132:135]
ds_read_b128 a[96:99], v2 offset:24576
v_mfma_f32_16x16x32_bf16 v[132:135], a[140:143], a[36:39], v[132:135]
v_mfma_f32_16x16x32_bf16 v[140:143], a[136:139], a[40:43], v[140:143]
ds_read_b128 a[100:103], v3 offset:24576
v_mfma_f32_16x16x32_bf16 v[140:143], a[140:143], a[44:47], v[140:143]
ds_read_b128 a[104:107], v2 offset:26624
v_mfma_f32_16x16x32_bf16 v[148:151], a[136:139], a[48:51], v[148:151]
ds_read_b128 a[108:111], v3 offset:26624
v_mfma_f32_16x16x32_bf16 v[148:151], a[140:143], a[52:55], v[148:151]
v_mfma_f32_16x16x32_bf16 v[156:159], a[136:139], a[56:59], v[156:159]
ds_read_b128 a[112:115], v2 offset:28672
v_mfma_f32_16x16x32_bf16 v[156:159], a[140:143], a[60:63], v[156:159]
s_waitcnt lgkmcnt(5)
buffer_store_dwordx4 v[72:75], v1, s[4:7], s31 offen sc1
v_mfma_f32_16x16x32_bf16 v[164:167], a[128:131], a[0:3], v[164:167]
s_add_u32 s31, s31, s33
ds_read_b64_tr_b16 a[136:137], v25 offset:0
v_mfma_f32_16x16x32_bf16 v[164:167], a[132:135], a[4:7], v[164:167]
v_mfma_f32_16x16x32_bf16 v[172:175], a[128:131], a[8:11], v[172:175]
ds_read_b64_tr_b16 a[138:139], v25 offset:2048
v_mfma_f32_16x16x32_bf16 v[172:175], a[132:135], a[12:15], v[172:175]
ds_read_b128 a[116:119], v3 offset:28672
v_mfma_f32_16x16x32_bf16 v[180:183], a[128:131], a[16:19], v[180:183]
ds_read_b64_tr_b16 a[140:141], v25 offset:16384
v_mfma_f32_16x16x32_bf16 v[180:183], a[132:135], a[20:23], v[180:183]
v_mfma_f32_16x16x32_bf16 v[188:191], a[128:131], a[24:27], v[188:191]
ds_read_b64_tr_b16 a[142:143], v25 offset:18432
v_add_u32 v25, 32768, v25
v_mfma_f32_16x16x32_bf16 v[188:191], a[132:135], a[28:31], v[188:191]
v_mfma_f32_16x16x32_bf16 v[196:199], a[128:131], a[32:35], v[196:199]
ds_read_b128 a[120:123], v2 offset:30720
v_mfma_f32_16x16x32_bf16 v[196:199], a[132:135], a[36:39], v[196:199]
buffer_store_dwordx4 v[80:83], v1, s[4:7], s31 offen sc1
v_mfma_f32_16x16x32_bf16 v[204:207], a[128:131], a[40:43], v[204:207]
s_add_u32 s31, s31, s32
ds_read_b128 a[124:127], v3 offset:30720
v_mfma_f32_16x16x32_bf16 v[204:207], a[132:135], a[44:47], v[204:207]
v_mfma_f32_16x16x32_bf16 v[212:215], a[128:131], a[48:51], v[212:215]
v_mfma_f32_16x16x32_bf16 v[212:215], a[132:135], a[52:55], v[212:215]
v_mfma_f32_16x16x32_bf16 v[220:223], a[128:131], a[56:59], v[220:223]
v_mfma_f32_16x16x32_bf16 v[220:223], a[132:135], a[60:63], v[220:223]
s_waitcnt vmcnt(17) lgkmcnt(0)
s_barrier
v_mfma_f32_16x16x32_bf16 v[224:227], a[136:139], a[0:3], v[224:227]
ds_read_b64_tr_b16 a[128:129], v22 offset:0
v_mfma_f32_16x16x32_bf16 v[224:227], a[140:143], a[4:7], v[224:227]
v_mfma_f32_16x16x32_bf16 v[228:231], a[136:139], a[8:11], v[228:231]
ds_read_b64_tr_b16 a[130:131], v22 offset:2048
v_mfma_f32_16x16x32_bf16 v[228:231], a[140:143], a[12:15], v[228:231]
buffer_store_dwordx4 v[88:91], v1, s[4:7], s31 offen sc1
v_mfma_f32_16x16x32_bf16 v[232:235], a[136:139], a[16:19], v[232:235]
ds_read_b64_tr_b16 a[132:133], v22 offset:16384
v_mfma_f32_16x16x32_bf16 v[232:235], a[140:143], a[20:23], v[232:235]
v_mfma_f32_16x16x32_bf16 v[236:239], a[136:139], a[24:27], v[236:239]
ds_read_b64_tr_b16 a[134:135], v22 offset:18432
v_add_u32 v22, 32768, v22
v_mfma_f32_16x16x32_bf16 v[236:239], a[140:143], a[28:31], v[236:239]
v_mfma_f32_16x16x32_bf16 v[240:243], a[136:139], a[32:35], v[240:243]
v_mfma_f32_16x16x32_bf16 v[240:243], a[140:143], a[36:39], v[240:243]
v_mfma_f32_16x16x32_bf16 v[244:247], a[136:139], a[40:43], v[244:247]
v_mfma_f32_16x16x32_bf16 v[244:247], a[140:143], a[44:47], v[244:247]
v_mfma_f32_16x16x32_bf16 v[248:251], a[136:139], a[48:51], v[248:251]
v_mfma_f32_16x16x32_bf16 v[248:251], a[140:143], a[52:55], v[248:251]
v_mfma_f32_16x16x32_bf16 v[252:255], a[136:139], a[56:59], v[252:255]
v_mfma_f32_16x16x32_bf16 v[252:255], a[140:143], a[60:63], v[252:255]
s_waitcnt lgkmcnt(0)
v_mfma_f32_16x16x32_bf16 v[36:39], a[128:131], a[64:67], v[36:39]
ds_read_b64_tr_b16 a[136:137], v23 offset:0
v_mfma_f32_16x16x32_bf16 v[36:39], a[132:135], a[68:71], v[36:39]
v_mfma_f32_16x16x32_bf16 v[44:47], a[128:131], a[72:75], v[44:47]
ds_read_b64_tr_b16 a[138:139], v23 offset:2048
v_mfma_f32_16x16x32_bf16 v[44:47], a[132:135], a[76:79], v[44:47]
ds_read_b128 a[0:3], v2 offset:32768
ds_read_b128 a[4:7], v3 offset:32768
v_mfma_f32_16x16x32_bf16 v[52:55], a[128:131], a[80:83], v[52:55]
ds_read_b64_tr_b16 a[140:141], v23 offset:16384
v_mfma_f32_16x16x32_bf16 v[52:55], a[132:135], a[84:87], v[52:55]
v_mfma_f32_16x16x32_bf16 v[60:63], a[128:131], a[88:91], v[60:63]
ds_read_b64_tr_b16 a[142:143], v23 offset:18432
v_add_u32 v23, 32768, v23
v_mfma_f32_16x16x32_bf16 v[60:63], a[132:135], a[92:95], v[60:63]
v_mfma_f32_16x16x32_bf16 v[68:71], a[128:131], a[96:99], v[68:71]
ds_read_b128 a[8:11], v2 offset:34816
v_mfma_f32_16x16x32_bf16 v[68:71], a[132:135], a[100:103], v[68:71]
v_mfma_f32_16x16x32_bf16 v[76:79], a[128:131], a[104:107], v[76:79]
ds_read_b128 a[12:15], v3 offset:34816
v_mfma_f32_16x16x32_bf16 v[76:79], a[132:135], a[108:111], v[76:79]
ds_read_b128 a[16:19], v2 offset:36864
v_mfma_f32_16x16x32_bf16 v[84:87], a[128:131], a[112:115], v[84:87]
ds_read_b128 a[20:23], v3 offset:36864
v_mfma_f32_16x16x32_bf16 v[84:87], a[132:135], a[116:119], v[84:87]
v_mfma_f32_16x16x32_bf16 v[92:95], a[128:131], a[120:123], v[92:95]
ds_read_b128 a[24:27], v2 offset:38912
v_mfma_f32_16x16x32_bf16 v[92:95], a[132:135], a[124:127], v[92:95]
s_waitcnt lgkmcnt(5)
v_mfma_f32_16x16x32_bf16 v[100:103], a[136:139], a[64:67], v[100:103]
ds_read_b64_tr_b16 a[128:129], v24 offset:0
v_mfma_f32_16x16x32_bf16 v[100:103], a[140:143], a[68:71], v[100:103]
v_mfma_f32_16x16x32_bf16 v[108:111], a[136:139], a[72:75], v[108:111]
ds_read_b64_tr_b16 a[130:131], v24 offset:2048
v_mfma_f32_16x16x32_bf16 v[108:111], a[140:143], a[76:79], v[108:111]
ds_read_b128 a[28:31], v3 offset:38912
v_mfma_f32_16x16x32_bf16 v[116:119], a[136:139], a[80:83], v[116:119]
ds_read_b64_tr_b16 a[132:133], v24 offset:16384
v_mfma_f32_16x16x32_bf16 v[116:119], a[140:143], a[84:87], v[116:119]
v_mfma_f32_16x16x32_bf16 v[124:127], a[136:139], a[88:91], v[124:127]
ds_read_b64_tr_b16 a[134:135], v24 offset:18432
v_add_u32 v24, 32768, v24
v_mfma_f32_16x16x32_bf16 v[124:127], a[140:143], a[92:95], v[124:127]
v_mfma_f32_16x16x32_bf16 v[132:135], a[136:139], a[96:99], v[132:135]
ds_read_b128 a[32:35], v2 offset:40960
v_mfma_f32_16x16x32_bf16 v[132:135], a[140:143], a[100:103], v[132:135]
v_mfma_f32_16x16x32_bf16 v[140:143], a[136:139], a[104:107], v[140:143]
ds_read_b128 a[36:39], v3 offset:40960
v_mfma_f32_16x16x32_bf16 v[140:143], a[140:143], a[108:111], v[140:143]
ds_read_b128 a[40:43], v2 offset:43008
v_mfma_f32_16x16x32_bf16 v[148:151], a[136:139], a[112:115], v[148:151]
ds_read_b128 a[44:47], v3 offset:43008
v_mfma_f32_16x16x32_bf16 v[148:151], a[140:143], a[116:119], v[148:151]
v_mfma_f32_16x16x32_bf16 v[156:159], a[136:139], a[120:123], v[156:159]
ds_read_b128 a[48:51], v2 offset:45056
v_mfma_f32_16x16x32_bf16 v[156:159], a[140:143], a[124:127], v[156:159]
s_waitcnt lgkmcnt(5)
v_mfma_f32_16x16x32_bf16 v[164:167], a[128:131], a[64:67], v[164:167]
ds_read_b64_tr_b16 a[136:137], v25 offset:0
v_mfma_f32_16x16x32_bf16 v[164:167], a[132:135], a[68:71], v[164:167]
v_mfma_f32_16x16x32_bf16 v[172:175], a[128:131], a[72:75], v[172:175]
ds_read_b64_tr_b16 a[138:139], v25 offset:2048
v_mfma_f32_16x16x32_bf16 v[172:175], a[132:135], a[76:79], v[172:175]
ds_read_b128 a[52:55], v3 offset:45056
v_mfma_f32_16x16x32_bf16 v[180:183], a[128:131], a[80:83], v[180:183]
ds_read_b64_tr_b16 a[140:141], v25 offset:16384
v_mfma_f32_16x16x32_bf16 v[180:183], a[132:135], a[84:87], v[180:183]
v_mfma_f32_16x16x32_bf16 v[188:191], a[128:131], a[88:91], v[188:191]
ds_read_b64_tr_b16 a[142:143], v25 offset:18432
v_add_u32 v25, 32768, v25
v_mfma_f32_16x16x32_bf16 v[188:191], a[132:135], a[92:95], v[188:191]
v_mfma_f32_16x16x32_bf16 v[196:199], a[128:131], a[96:99], v[196:199]
ds_read_b128 a[56:59], v2 offset:47104
v_mfma_f32_16x16x32_bf16 v[196:199], a[132:135], a[100:103], v[196:199]
v_mfma_f32_16x16x32_bf16 v[204:207], a[128:131], a[104:107], v[204:207]
ds_read_b128 a[60:63], v3 offset:47104
v_mfma_f32_16x16x32_bf16 v[204:207], a[132:135], a[108:111], v[204:207]
v_mfma_f32_16x16x32_bf16 v[212:215], a[128:131], a[112:115], v[212:215]
v_mfma_f32_16x16x32_bf16 v[212:215], a[132:135], a[116:119], v[212:215]
v_mfma_f32_16x16x32_bf16 v[220:223], a[128:131], a[120:123], v[220:223]
v_mfma_f32_16x16x32_bf16 v[220:223], a[132:135], a[124:127], v[220:223]
s_waitcnt vmcnt(0) lgkmcnt(0)
s_barrier
v_mfma_f32_16x16x32_bf16 v[224:227], a[136:139], a[64:67], v[224:227]
ds_read_b64_tr_b16 a[128:129], v22 offset:0
v_mfma_f32_16x16x32_bf16 v[224:227], a[140:143], a[68:71], v[224:227]
buffer_store_dword v27, v26, s[4:7], s66 offen sc1
v_mfma_f32_16x16x32_bf16 v[228:231], a[136:139], a[72:75], v[228:231]
ds_read_b64_tr_b16 a[130:131], v22 offset:2048
v_mfma_f32_16x16x32_bf16 v[228:231], a[140:143], a[76:79], v[228:231]
v_mfma_f32_16x16x32_bf16 v[232:235], a[136:139], a[80:83], v[232:235]
ds_read_b64_tr_b16 a[132:133], v22 offset:16384
v_mfma_f32_16x16x32_bf16 v[232:235], a[140:143], a[84:87], v[232:235]
v_mfma_f32_16x16x32_bf16 v[236:239], a[136:139], a[88:91], v[236:239]
ds_read_b64_tr_b16 a[134:135], v22 offset:18432
v_mfma_f32_16x16x32_bf16 v[236:239], a[140:143], a[92:95], v[236:239]
v_mfma_f32_16x16x32_bf16 v[240:243], a[136:139], a[96:99], v[240:243]
v_mfma_f32_16x16x32_bf16 v[240:243], a[140:143], a[100:103], v[240:243]
v_mfma_f32_16x16x32_bf16 v[244:247], a[136:139], a[104:107], v[244:247]
v_mfma_f32_16x16x32_bf16 v[244:247], a[140:143], a[108:111], v[244:247]
v_mfma_f32_16x16x32_bf16 v[248:251], a[136:139], a[112:115], v[248:251]
v_mfma_f32_16x16x32_bf16 v[248:251], a[140:143], a[116:119], v[248:251]
v_mfma_f32_16x16x32_bf16 v[252:255], a[136:139], a[120:123], v[252:255]
v_mfma_f32_16x16x32_bf16 v[252:255], a[140:143], a[124:127], v[252:255]
s_waitcnt lgkmcnt(0)
v_mfma_f32_16x16x32_bf16 v[36:39], a[128:131], a[0:3], v[36:39]
s_lshl_b32 s18, s3, 13
ds_read_b64_tr_b16 a[136:137], v23 offset:0
v_lshrrev_b32 v28, 6, v0
v_mfma_f32_16x16x32_bf16 v[36:39], a[132:135], a[4:7], v[36:39]
s_lshl_b32 s30, s20, 20
v_lshl_add_u32 v28, v28, 11, v1
v_add_u32 v28, 65536, v28
v_mfma_f32_16x16x32_bf16 v[44:47], a[128:131], a[8:11], v[44:47]
s_add_u32 s30, s30, s18
ds_read_b64_tr_b16 a[138:139], v23 offset:2048
v_lshrrev_b32 v3, 6, v0
v_mfma_f32_16x16x32_bf16 v[44:47], a[132:135], a[12:15], v[44:47]
s_lshl_b32 s22, s21, 1
v_and_b32 v4, 63, v0
v_add_u32 v2, 0x10000, v1
v_mfma_f32_16x16x32_bf16 v[52:55], a[128:131], a[16:19], v[52:55]
s_lshl_b32 s85, s21, 2
ds_read_b64_tr_b16 a[140:141], v23 offset:16384
v_and_b32 v5, 15, v4
v_mfma_f32_16x16x32_bf16 v[52:55], a[132:135], a[20:23], v[52:55]
s_lshr_b32 s85, 2386092, s85
v_lshrrev_b32 v6, 4, v4
v_lshlrev_b32 v6, 2, v6
v_mfma_f32_16x16x32_bf16 v[60:63], a[128:131], a[24:27], v[60:63]
s_and_b32 s9, s85, 15
ds_read_b64_tr_b16 a[142:143], v23 offset:18432
v_sub_u32 v5, v5, v6
v_mfma_f32_16x16x32_bf16 v[60:63], a[132:135], a[28:31], v[60:63]
s_and_b32 s84, s85, 1
v_lshl_add_u32 v5, v3, 4, v5
v_cmp_gt_i32 s[32:33], 0, v5
v_mfma_f32_16x16x32_bf16 v[68:71], a[128:131], a[32:35], v[68:71]
s_lshl_b32 s84, s84, 17
v_cmp_gt_i32 s[34:35], 1, v5
v_cmp_gt_i32 s[36:37], 2, v5
v_mfma_f32_16x16x32_bf16 v[68:71], a[132:135], a[36:39], v[68:71]
s_add_u32 s84, s84, s18
v_cmp_gt_i32 s[38:39], 3, v5
v_cmp_gt_i32 s[40:41], 16, v5
v_mfma_f32_16x16x32_bf16 v[76:79], a[128:131], a[40:43], v[76:79]
s_xor_b32 s85, s84, 0x20000
v_cmp_gt_i32 s[42:43], 17, v5
v_cmp_gt_i32 s[44:45], 18, v5
v_mfma_f32_16x16x32_bf16 v[76:79], a[132:135], a[44:47], v[76:79]
s_sub_u32 s29, 15, s21
v_cmp_gt_i32 s[46:47], 19, v5
v_cmp_gt_i32 s[48:49], 32, v5
v_mfma_f32_16x16x32_bf16 v[84:87], a[128:131], a[48:51], v[84:87]
s_cmp_lg_u32 s9, 0
v_cmp_gt_i32 s[50:51], 33, v5
v_cmp_gt_i32 s[52:53], 34, v5
v_mfma_f32_16x16x32_bf16 v[84:87], a[132:135], a[52:55], v[84:87]
s_cselect_b32 s24, 1, 0
v_cmp_gt_i32 s[54:55], 35, v5
v_cmp_gt_i32 s[56:57], 48, v5
v_mfma_f32_16x16x32_bf16 v[92:95], a[128:131], a[56:59], v[92:95]
s_cselect_b32 s67, s67, 3221225472
v_cmp_gt_i32 s[58:59], 49, v5
v_cmp_gt_i32 s[60:61], 50, v5
v_mfma_f32_16x16x32_bf16 v[92:95], a[132:135], a[60:63], v[92:95]
s_waitcnt lgkmcnt(0)
v_cmp_gt_i32 s[62:63], 51, v5
v_mov_b32 v7, 0xff800000
v_mfma_f32_16x16x32_bf16 v[100:103], a[136:139], a[0:3], v[100:103]
s_lshl_b32 s8, s9, 15
ds_read_b64_tr_b16 a[128:129], v24 offset:0
v_mov_b32 v6, 1
v_mfma_f32_16x16x32_bf16 v[100:103], a[140:143], a[4:7], v[100:103]
s_add_u32 s8, s8, s30
v_mov_b32 v5, v26
v_add_u32 v4, 0x20000, v1
v_mfma_f32_16x16x32_bf16 v[108:111], a[136:139], a[8:11], v[108:111]
s_add_u32 s9, s9, s22
ds_read_b64_tr_b16 a[130:131], v24 offset:2048
v_mfma_f32_16x16x32_bf16 v[108:111], a[140:143], a[12:15], v[108:111]
s_sub_u32 s9, 32, s9
v_mfma_f32_16x16x32_bf16 v[116:119], a[136:139], a[16:19], v[116:119]
s_bitcmp1_b32 s2, 4
ds_read_b64_tr_b16 a[132:133], v24 offset:16384
v_mfma_f32_16x16x32_bf16 v[116:119], a[140:143], a[20:23], v[116:119]
s_cselect_b32 s9, 16, s9
v_mfma_f32_16x16x32_bf16 v[124:127], a[136:139], a[24:27], v[124:127]
s_cselect_b32 s29, 7, s29
ds_read_b64_tr_b16 a[134:135], v24 offset:18432
v_mul_f32 v36, s68, v36
v_mfma_f32_16x16x32_bf16 v[124:127], a[140:143], a[28:31], v[124:127]
s_mov_b32 s10, 3221225472
v_mul_f32 v37, s68, v37
v_mul_f32 v38, s68, v38
v_mfma_f32_16x16x32_bf16 v[132:135], a[136:139], a[32:35], v[132:135]
s_mov_b32 s14, 3221225472
v_mul_f32 v39, s68, v39
v_mul_f32 v100, s68, v100
v_mfma_f32_16x16x32_bf16 v[132:135], a[140:143], a[36:39], v[132:135]
s_mov_b32 s11, 0
v_mul_f32 v101, s68, v101
v_mul_f32 v102, s68, v102
v_mfma_f32_16x16x32_bf16 v[140:143], a[136:139], a[40:43], v[140:143]
s_lshr_b32 s19, s9, 1
v_mul_f32 v103, s68, v103
v_cvt_pk_bf16_f32 v36, v36, v37
v_mfma_f32_16x16x32_bf16 v[140:143], a[140:143], a[44:47], v[140:143]
s_sub_u32 s19, s19, 1
v_cvt_pk_bf16_f32 v37, v38, v39
v_cvt_pk_bf16_f32 v38, v100, v101
v_mfma_f32_16x16x32_bf16 v[148:151], a[136:139], a[48:51], v[148:151]
s_add_u32 s12, s8, 16777216
v_cvt_pk_bf16_f32 v39, v102, v103
v_mul_f32 v44, s68, v44
v_mfma_f32_16x16x32_bf16 v[148:151], a[140:143], a[52:55], v[148:151]
s_mov_b32 s13, s9
ds_write_b128 v28, v[36:39] offset:0
v_mul_f32 v45, s68, v45
v_mfma_f32_16x16x32_bf16 v[156:159], a[136:139], a[56:59], v[156:159]
s_mov_b32 s15, s11
s_add_u32 s23, s67, 0
buffer_store_dwordx4 v[36:39], v1, s[4:7], s23 offen offset:0 sc1
v_mfma_f32_16x16x32_bf16 v[156:159], a[140:143], a[60:63], v[156:159]
s_waitcnt lgkmcnt(1)
v_mul_f32 v46, s68, v46
v_mul_f32 v47, s68, v47
v_mfma_f32_16x16x32_bf16 v[164:167], a[128:131], a[0:3], v[164:167]
ds_read_b64_tr_b16 a[136:137], v25 offset:0
v_mul_f32 v108, s68, v108
v_mfma_f32_16x16x32_bf16 v[164:167], a[132:135], a[4:7], v[164:167]
v_mul_f32 v109, s68, v109
v_mul_f32 v110, s68, v110
v_mfma_f32_16x16x32_bf16 v[172:175], a[128:131], a[8:11], v[172:175]
ds_read_b64_tr_b16 a[138:139], v25 offset:2048
v_mul_f32 v111, s68, v111
v_mfma_f32_16x16x32_bf16 v[172:175], a[132:135], a[12:15], v[172:175]
v_cvt_pk_bf16_f32 v44, v44, v45
v_cvt_pk_bf16_f32 v45, v46, v47
v_mfma_f32_16x16x32_bf16 v[180:183], a[128:131], a[16:19], v[180:183]
ds_read_b64_tr_b16 a[140:141], v25 offset:16384
v_cvt_pk_bf16_f32 v46, v108, v109
v_mfma_f32_16x16x32_bf16 v[180:183], a[132:135], a[20:23], v[180:183]
v_cvt_pk_bf16_f32 v47, v110, v111
v_mul_f32 v52, s68, v52
v_mfma_f32_16x16x32_bf16 v[188:191], a[128:131], a[24:27], v[188:191]
ds_read_b64_tr_b16 a[142:143], v25 offset:18432
v_mul_f32 v53, s68, v53
v_mfma_f32_16x16x32_bf16 v[188:191], a[132:135], a[28:31], v[188:191]
ds_write_b128 v28, v[44:47] offset:8192
v_mul_f32 v54, s68, v54
v_mfma_f32_16x16x32_bf16 v[196:199], a[128:131], a[32:35], v[196:199]
s_add_u32 s23, s67, 8192
buffer_store_dwordx4 v[44:47], v1, s[4:7], s23 offen offset:0 sc1
v_mfma_f32_16x16x32_bf16 v[196:199], a[132:135], a[36:39], v[196:199]
v_mul_f32 v55, s68, v55
v_mul_f32 v116, s68, v116
v_mfma_f32_16x16x32_bf16 v[204:207], a[128:131], a[40:43], v[204:207]
v_mul_f32 v117, s68, v117
v_mul_f32 v118, s68, v118
v_mfma_f32_16x16x32_bf16 v[204:207], a[132:135], a[44:47], v[204:207]
v_mul_f32 v119, s68, v119
v_cvt_pk_bf16_f32 v52, v52, v53
v_mfma_f32_16x16x32_bf16 v[212:215], a[128:131], a[48:51], v[212:215]
v_cvt_pk_bf16_f32 v53, v54, v55
v_cvt_pk_bf16_f32 v54, v116, v117
v_mfma_f32_16x16x32_bf16 v[212:215], a[132:135], a[52:55], v[212:215]
v_cvt_pk_bf16_f32 v55, v118, v119
v_mul_f32 v60, s68, v60
v_mfma_f32_16x16x32_bf16 v[220:223], a[128:131], a[56:59], v[220:223]
ds_write_b128 v28, v[52:55] offset:16384
v_mul_f32 v61, s68, v61
v_mfma_f32_16x16x32_bf16 v[220:223], a[132:135], a[60:63], v[220:223]
s_waitcnt lgkmcnt(0)
s_waitcnt lgkmcnt(0)
s_barrier
v_mfma_f32_16x16x32_bf16 v[224:227], a[136:139], a[0:3], v[224:227]
s_add_u32 s23, s67, 16384
buffer_store_dwordx4 v[52:55], v1, s[4:7], s23 offen offset:0 sc1
v_mfma_f32_16x16x32_bf16 v[224:227], a[140:143], a[4:7], v[224:227]
v_mul_f32 v62, s68, v62
v_mul_f32 v63, s68, v63
v_mfma_f32_16x16x32_bf16 v[228:231], a[136:139], a[8:11], v[228:231]
v_mul_f32 v124, s68, v124
v_mul_f32 v125, s68, v125
v_mfma_f32_16x16x32_bf16 v[228:231], a[140:143], a[12:15], v[228:231]
v_mul_f32 v126, s68, v126
v_mul_f32 v127, s68, v127
v_mfma_f32_16x16x32_bf16 v[232:235], a[136:139], a[16:19], v[232:235]
v_cvt_pk_bf16_f32 v60, v60, v61
v_cvt_pk_bf16_f32 v61, v62, v63
v_mfma_f32_16x16x32_bf16 v[232:235], a[140:143], a[20:23], v[232:235]
v_cvt_pk_bf16_f32 v62, v124, v125
v_cvt_pk_bf16_f32 v63, v126, v127
v_mfma_f32_16x16x32_bf16 v[236:239], a[136:139], a[24:27], v[236:239]
ds_write_b128 v28, v[60:63] offset:24576
v_mul_f32 v68, s68, v68
v_mfma_f32_16x16x32_bf16 v[236:239], a[140:143], a[28:31], v[236:239]
s_add_u32 s23, s67, 24576
buffer_store_dwordx4 v[60:63], v1, s[4:7], s23 offen offset:0 sc1
v_mfma_f32_16x16x32_bf16 v[240:243], a[136:139], a[32:35], v[240:243]
v_mul_f32 v69, s68, v69
v_mul_f32 v70, s68, v70
v_mfma_f32_16x16x32_bf16 v[240:243], a[140:143], a[36:39], v[240:243]
v_mul_f32 v71, s68, v71
v_mul_f32 v132, s68, v132
v_mfma_f32_16x16x32_bf16 v[244:247], a[136:139], a[40:43], v[244:247]
v_mul_f32 v133, s68, v133
v_mul_f32 v134, s68, v134
v_mfma_f32_16x16x32_bf16 v[244:247], a[140:143], a[44:47], v[244:247]
v_mul_f32 v135, s68, v135
v_cvt_pk_bf16_f32 v68, v68, v69
v_mfma_f32_16x16x32_bf16 v[248:251], a[136:139], a[48:51], v[248:251]
v_cvt_pk_bf16_f32 v69, v70, v71
v_cvt_pk_bf16_f32 v70, v132, v133
v_mfma_f32_16x16x32_bf16 v[248:251], a[140:143], a[52:55], v[248:251]
v_cvt_pk_bf16_f32 v71, v134, v135
v_mfma_f32_16x16x32_bf16 v[252:255], a[136:139], a[56:59], v[252:255]
ds_write_b128 v28, v[68:71] offset:32768
v_mfma_f32_16x16x32_bf16 v[252:255], a[140:143], a[60:63], v[252:255]
s_add_u32 s23, s67, 32768
buffer_store_dwordx4 v[68:71], v1, s[4:7], s23 offen offset:0 sc1
buffer_load_dword v21, v20, s[4:7], s70 offen sc1
v_pk_mul_f32 v[76:77], v[76:77], s[68:69]
v_pk_mul_f32 v[78:79], v[78:79], s[68:69]
v_pk_mul_f32 v[140:141], v[140:141], s[68:69]
v_pk_mul_f32 v[142:143], v[142:143], s[68:69]
v_cvt_pk_bf16_f32 v76, v76, v77
v_cvt_pk_bf16_f32 v77, v78, v79
v_cvt_pk_bf16_f32 v78, v140, v141
v_cvt_pk_bf16_f32 v79, v142, v143
ds_write_b128 v28, v[76:79] offset:40960
s_add_u32 s23, s67, 40960
buffer_store_dwordx4 v[76:79], v1, s[4:7], s23 offen offset:0 sc1
v_pk_mul_f32 v[84:85], v[84:85], s[68:69]
v_pk_mul_f32 v[86:87], v[86:87], s[68:69]
v_pk_mul_f32 v[148:149], v[148:149], s[68:69]
v_pk_mul_f32 v[150:151], v[150:151], s[68:69]
v_cvt_pk_bf16_f32 v84, v84, v85
v_cvt_pk_bf16_f32 v85, v86, v87
v_cvt_pk_bf16_f32 v86, v148, v149
v_cvt_pk_bf16_f32 v87, v150, v151
ds_write_b128 v28, v[84:87] offset:49152
s_add_u32 s23, s67, 49152
buffer_store_dwordx4 v[84:87], v1, s[4:7], s23 offen offset:0 sc1
v_pk_mul_f32 v[92:93], v[92:93], s[68:69]
v_pk_mul_f32 v[94:95], v[94:95], s[68:69]
v_pk_mul_f32 v[156:157], v[156:157], s[68:69]
v_pk_mul_f32 v[158:159], v[158:159], s[68:69]
v_cvt_pk_bf16_f32 v92, v92, v93
v_cvt_pk_bf16_f32 v93, v94, v95
v_cvt_pk_bf16_f32 v94, v156, v157
v_cvt_pk_bf16_f32 v95, v158, v159
ds_write_b128 v28, v[92:95] offset:57344
s_add_u32 s23, s67, 57344
buffer_store_dwordx4 v[92:95], v1, s[4:7], s23 offen offset:0 sc1
v_pk_mul_f32 v[164:165], v[164:165], s[68:69]
v_pk_mul_f32 v[166:167], v[166:167], s[68:69]
v_pk_mul_f32 v[224:225], v[224:225], s[68:69]
v_pk_mul_f32 v[226:227], v[226:227], s[68:69]
v_cvt_pk_bf16_f32 v164, v164, v165
v_cvt_pk_bf16_f32 v165, v166, v167
v_cvt_pk_bf16_f32 v166, v224, v225
v_cvt_pk_bf16_f32 v167, v226, v227
ds_write_b128 v28, v[164:167] offset:1024
s_add_u32 s23, s67, 0
buffer_store_dwordx4 v[164:167], v1, s[4:7], s23 offen offset:1024 sc1
v_pk_mul_f32 v[172:173], v[172:173], s[68:69]
v_pk_mul_f32 v[174:175], v[174:175], s[68:69]
v_pk_mul_f32 v[228:229], v[228:229], s[68:69]
v_pk_mul_f32 v[230:231], v[230:231], s[68:69]
v_cvt_pk_bf16_f32 v172, v172, v173
v_cvt_pk_bf16_f32 v173, v174, v175
v_cvt_pk_bf16_f32 v174, v228, v229
v_cvt_pk_bf16_f32 v175, v230, v231
ds_write_b128 v28, v[172:175] offset:9216
s_add_u32 s23, s67, 8192
buffer_store_dwordx4 v[172:175], v1, s[4:7], s23 offen offset:1024 sc1
v_pk_mul_f32 v[180:181], v[180:181], s[68:69]
v_pk_mul_f32 v[182:183], v[182:183], s[68:69]
v_pk_mul_f32 v[232:233], v[232:233], s[68:69]
v_pk_mul_f32 v[234:235], v[234:235], s[68:69]
v_cvt_pk_bf16_f32 v180, v180, v181
v_cvt_pk_bf16_f32 v181, v182, v183
v_cvt_pk_bf16_f32 v182, v232, v233
v_cvt_pk_bf16_f32 v183, v234, v235
ds_write_b128 v28, v[180:183] offset:17408
s_add_u32 s23, s67, 16384
buffer_store_dwordx4 v[180:183], v1, s[4:7], s23 offen offset:1024 sc1
v_pk_mul_f32 v[188:189], v[188:189], s[68:69]
v_pk_mul_f32 v[190:191], v[190:191], s[68:69]
v_pk_mul_f32 v[236:237], v[236:237], s[68:69]
v_pk_mul_f32 v[238:239], v[238:239], s[68:69]
v_cvt_pk_bf16_f32 v188, v188, v189
v_cvt_pk_bf16_f32 v189, v190, v191
v_cvt_pk_bf16_f32 v190, v236, v237
v_cvt_pk_bf16_f32 v191, v238, v239
ds_write_b128 v28, v[188:191] offset:25600
s_add_u32 s23, s67, 24576
buffer_store_dwordx4 v[188:191], v1, s[4:7], s23 offen offset:1024 sc1
v_pk_mul_f32 v[196:197], v[196:197], s[68:69]
v_pk_mul_f32 v[198:199], v[198:199], s[68:69]
v_pk_mul_f32 v[240:241], v[240:241], s[68:69]
v_pk_mul_f32 v[242:243], v[242:243], s[68:69]
PAD_8:
s_cbranch_execz M_tret
v_cvt_pk_bf16_f32 v196, v196, v197
v_cvt_pk_bf16_f32 v197, v198, v199
v_cvt_pk_bf16_f32 v198, v240, v241
v_cvt_pk_bf16_f32 v199, v242, v243
ds_write_b128 v28, v[196:199] offset:33792
s_add_u32 s23, s67, 32768
buffer_store_dwordx4 v[196:199], v1, s[4:7], s23 offen offset:1024 sc1
v_pk_mul_f32 v[204:205], v[204:205], s[68:69]
v_pk_mul_f32 v[206:207], v[206:207], s[68:69]
v_pk_mul_f32 v[244:245], v[244:245], s[68:69]
v_pk_mul_f32 v[246:247], v[246:247], s[68:69]
v_cvt_pk_bf16_f32 v204, v204, v205
v_cvt_pk_bf16_f32 v205, v206, v207
v_cvt_pk_bf16_f32 v206, v244, v245
v_cvt_pk_bf16_f32 v207, v246, v247
ds_write_b128 v28, v[204:207] offset:41984
s_add_u32 s23, s67, 40960
buffer_store_dwordx4 v[204:207], v1, s[4:7], s23 offen offset:1024 sc1
v_pk_mul_f32 v[212:213], v[212:213], s[68:69]
v_pk_mul_f32 v[214:215], v[214:215], s[68:69]
v_pk_mul_f32 v[248:249], v[248:249], s[68:69]
v_pk_mul_f32 v[250:251], v[250:251], s[68:69]
v_cvt_pk_bf16_f32 v212, v212, v213
v_cvt_pk_bf16_f32 v213, v214, v215
v_cvt_pk_bf16_f32 v214, v248, v249
v_cvt_pk_bf16_f32 v215, v250, v251
ds_write_b128 v28, v[212:215] offset:50176
s_add_u32 s23, s67, 49152
buffer_store_dwordx4 v[212:215], v1, s[4:7], s23 offen offset:1024 sc1
v_pk_mul_f32 v[220:221], v[220:221], s[68:69]
v_pk_mul_f32 v[222:223], v[222:223], s[68:69]
v_pk_mul_f32 v[252:253], v[252:253], s[68:69]
v_pk_mul_f32 v[254:255], v[254:255], s[68:69]
v_cvt_pk_bf16_f32 v220, v220, v221
v_cvt_pk_bf16_f32 v221, v222, v223
v_cvt_pk_bf16_f32 v222, v252, v253
v_cvt_pk_bf16_f32 v223, v254, v255
ds_write_b128 v28, v[220:223] offset:58368
s_add_u32 s23, s67, 57344
buffer_store_dwordx4 v[220:223], v1, s[4:7], s23 offen offset:1024 sc1
s_waitcnt vmcnt(11)
v_cmp_gt_u32 vcc, 1, v21
s_cbranch_vccnz M_kspin
M_kok:
buffer_load_dword v21, v15, s[4:7], s70 offen sc1
s_mov_b32 m0, s84
s_nop 0
buffer_load_dwordx4 v1, s[4:7], s8 offen offset:0 sc1 lds
buffer_load_dwordx4 v1, s[4:7], s8 offen offset:1024 sc1 lds
buffer_load_dwordx4 v1, s[4:7], s8 offen offset:2048 sc1 lds
buffer_load_dwordx4 v1, s[4:7], s8 offen offset:3072 sc1 lds
s_add_u32 s8, s8, 4096
s_add_u32 m0, s84, 4096
s_nop 0
buffer_load_dwordx4 v1, s[4:7], s8 offen offset:0 sc1 lds
buffer_load_dwordx4 v1, s[4:7], s8 offen offset:1024 sc1 lds
buffer_load_dwordx4 v1, s[4:7], s8 offen offset:2048 sc1 lds
buffer_load_dwordx4 v1, s[4:7], s8 offen offset:3072 sc1 lds
s_add_u32 s8, s8, 28672
s_sub_u32 s9, s9, 1
s_cmp_eq_u32 s9, 0
s_cselect_b32 s8, s10, s8
s_cselect_b32 s9, s11, s9
s_cselect_b32 s10, 3221225472, s10
v_add_u32 v28, s18, v2
s_waitcnt lgkmcnt(0)
s_barrier
ds_read_b128 a[0:3], v28 offset:0
ds_read_b128 a[4:7], v28 offset:1024
ds_read_b128 a[8:11], v28 offset:2048
ds_read_b128 a[12:15], v28 offset:3072
ds_read_b128 a[16:19], v28 offset:4096
ds_read_b128 a[20:23], v28 offset:5120
ds_read_b128 a[24:27], v28 offset:6144
ds_read_b128 a[28:31], v28 offset:7168
ds_read_b128 a[32:35], v28 offset:32768
ds_read_b128 a[36:39], v28 offset:33792
ds_read_b128 a[40:43], v28 offset:34816
ds_read_b128 a[44:47], v28 offset:35840
ds_read_b128 a[48:51], v28 offset:36864
ds_read_b128 a[52:55], v28 offset:37888
ds_read_b128 a[56:59], v28 offset:38912
ds_read_b128 a[60:63], v28 offset:39936
s_mov_b32 m0, s85
s_nop 0
buffer_load_dwordx4 v1, s[4:7], s8 offen offset:0 sc1 lds
buffer_load_dwordx4 v1, s[4:7], s8 offen offset:1024 sc1 lds
buffer_load_dwordx4 v1, s[4:7], s8 offen offset:2048 sc1 lds
buffer_load_dwordx4 v1, s[4:7], s8 offen offset:3072 sc1 lds
s_add_u32 s8, s8, 4096
s_add_u32 m0, s85, 4096
s_nop 0
buffer_load_dwordx4 v1, s[4:7], s8 offen offset:0 sc1 lds
buffer_load_dwordx4 v1, s[4:7], s8 offen offset:1024 sc1 lds
buffer_load_dwordx4 v1, s[4:7], s8 offen offset:2048 sc1 lds
buffer_load_dwordx4 v1, s[4:7], s8 offen offset:3072 sc1 lds
s_add_u32 s8, s8, 28672
s_sub_u32 s9, s9, 1
s_cmp_eq_u32 s9, 0
s_cselect_b32 s8, s10, s8
s_cselect_b32 s9, s11, s9
s_cselect_b32 s10, 3221225472, s10
s_mov_b32 s25, 1266679808
s_lshl_b32 s22, s21, 3
s_add_u32 s28, s70, s22
s_add_u32 s28, s28, 6148
s_lshl_b32 s26, s21, 16
s_add_u32 s26, s26, s30
s_add_u32 s26, s26, 33554432
s_lshl_b32 s76, s20, 3
s_add_u32 s76, s76, s21
s_lshl_b32 s76, s76, 2
s_add_u32 s76, s76, s3
s_lshl_b32 s27, s76, 10
s_add_u32 s27, s27, 75497472
s_lshl_b32 s76, s76, 14
s_add_u32 s76, s76, 67108864
s_lshl_b32 s81, s20, 2
s_add_u32 s81, s81, s3
s_mul_i32 s81, s81, 57344
s_cmp_eq_u32 s24, 1
s_cselect_b32 s80, s28, s70
s_add_u32 s77, s76, 8192
v_lshrrev_b32 v8, 7, v1
v_and_b32 v9, 6, v8
v_lshlrev_b32 v9, 4, v9
v_and_b32 v10, 0x70, v1
v_xor_b32 v9, v9, v10
v_mul_u32_u24 v8, 896, v8
v_add_u32 v8, v8, v9
v_accvgpr_write_b32 a184, v8
v_add_u32 v8, 6144, v8
v_accvgpr_write_b32 a185, v8
v_add_u32 v8, 6144, v8
v_accvgpr_write_b32 a186, v8
v_add_u32 v8, 6144, v8
v_accvgpr_write_b32 a187, v8
v_lshrrev_b32 v8, 6, v1
v_bfe_u32 v9, v1, 7, 2
v_lshlrev_b32 v9, 5, v9
v_lshl_add_u32 v8, v8, 7, v9
v_bfe_u32 v9, v1, 4, 2
v_lshl_add_u32 v8, v9, 3, v8
v_add_u32 v8, 32768, v8
v_accvgpr_write_b32 a188, v8
v_xor_b32 v9, 32, v8
v_accvgpr_write_b32 a189, v9
v_xor_b32 v9, 64, v8
v_accvgpr_write_b32 a190, v9
v_xor_b32 v9, 96, v8
v_accvgpr_write_b32 a191, v9
s_add_u32 s22, s66, 16384
s_mov_b32 s71, 3221225472
s_waitcnt vmcnt(17)
s_barrier
buffer_store_dword v6, v5, s[4:7], s22 offen sc1
v_mov_b64 v[128:129], 0
v_mov_b64 v[130:131], 0
v_mov_b64 v[132:133], 0
v_mov_b64 v[134:135], 0
v_mov_b64 v[136:137], 0
v_mov_b64 v[138:139], 0
v_mov_b64 v[140:141], 0
v_mov_b64 v[142:143], 0
v_mov_b64 v[144:145], 0
v_mov_b64 v[146:147], 0
v_mov_b64 v[148:149], 0
v_mov_b64 v[150:151], 0
v_mov_b64 v[152:153], 0
v_mov_b64 v[154:155], 0
v_mov_b64 v[156:157], 0
v_mov_b64 v[158:159], 0
v_mov_b64 v[160:161], 0
v_mov_b64 v[162:163], 0
v_mov_b64 v[164:165], 0
v_mov_b64 v[166:167], 0
v_mov_b64 v[168:169], 0
v_mov_b64 v[170:171], 0
v_mov_b64 v[172:173], 0
v_mov_b64 v[174:175], 0
v_mov_b64 v[176:177], 0
v_mov_b64 v[178:179], 0
v_mov_b64 v[180:181], 0
v_mov_b64 v[182:183], 0
v_mov_b64 v[184:185], 0
v_mov_b64 v[186:187], 0
v_mov_b64 v[188:189], 0
v_mov_b64 v[190:191], 0
v_mov_b64 v[192:193], 0
v_mov_b64 v[194:195], 0
v_mov_b64 v[196:197], 0
v_mov_b64 v[198:199], 0
v_mov_b64 v[200:201], 0
v_mov_b64 v[202:203], 0
v_mov_b64 v[204:205], 0
v_mov_b64 v[206:207], 0
v_mov_b64 v[208:209], 0
v_mov_b64 v[210:211], 0
v_mov_b64 v[212:213], 0
v_mov_b64 v[214:215], 0
v_mov_b64 v[216:217], 0
v_mov_b64 v[218:219], 0
v_mov_b64 v[220:221], 0
v_mov_b64 v[222:223], 0
v_mov_b64 v[224:225], 0
v_mov_b64 v[226:227], 0
v_mov_b64 v[228:229], 0
v_mov_b64 v[230:231], 0
v_mov_b64 v[232:233], 0
v_mov_b64 v[234:235], 0
v_mov_b64 v[236:237], 0
v_mov_b64 v[238:239], 0
v_mov_b64 v[240:241], 0
v_mov_b64 v[242:243], 0
v_mov_b64 v[244:245], 0
v_mov_b64 v[246:247], 0
v_mov_b64 v[248:249], 0
v_mov_b64 v[250:251], 0
v_mov_b64 v[252:253], 0
v_mov_b64 v[254:255], 0
v_mov_b64 v[24:25], 0
s_cmp_eq_u32 s24, 9
s_cbranch_scc1 M_t2A
M_t2Ar:
s_waitcnt vmcnt(9) lgkmcnt(0)
v_cmp_gt_u32 vcc, 1, v21
s_cbranch_vccnz M_vspin
M_vok:
s_barrier
K2_item:
PAD_9:
s_cbranch_execz M_tret
s_cmp_eq_u32 s19, 0
s_cbranch_scc1 K2_p0d
ds_read_b128 a[64:67], v1 offset:0
ds_read_b128 a[68:71], v1 offset:1024
ds_read_b128 a[72:75], v1 offset:2048
ds_read_b128 a[76:79], v1 offset:3072
ds_read_b128 a[80:83], v1 offset:4096
ds_read_b128 a[84:87], v1 offset:5120
ds_read_b128 a[88:91], v1 offset:6144
ds_read_b128 a[92:95], v1 offset:7168
s_waitcnt lgkmcnt(7)
v_mfma_f32_16x16x32_bf16 v[32:35], a[64:67], a[0:3], 0
s_waitcnt lgkmcnt(6)
s_add_u32 m0, s18, 65536
ds_read_b128 a[96:99], v1 offset:8192
v_mfma_f32_16x16x32_bf16 v[32:35], a[68:71], a[4:7], v[32:35]
s_waitcnt lgkmcnt(6)
buffer_load_dwordx4 v1, s[4:7], s12 offen offset:0 sc1 lds
v_mfma_f32_16x16x32_bf16 v[32:35], a[72:75], a[8:11], v[32:35]
s_waitcnt lgkmcnt(5)
ds_read_b128 a[100:103], v1 offset:9216
v_mfma_f32_16x16x32_bf16 v[32:35], a[76:79], a[12:15], v[32:35]
s_waitcnt lgkmcnt(5)
buffer_load_dwordx4 v1, s[4:7], s12 offen offset:1024 sc1 lds
v_mfma_f32_16x16x32_bf16 v[32:35], a[80:83], a[16:19], v[32:35]
s_waitcnt lgkmcnt(4)
ds_read_b128 a[104:107], v1 offset:10240
v_mfma_f32_16x16x32_bf16 v[32:35], a[84:87], a[20:23], v[32:35]
s_waitcnt lgkmcnt(4)
buffer_load_dwordx4 v1, s[4:7], s12 offen offset:2048 sc1 lds
v_mfma_f32_16x16x32_bf16 v[32:35], a[88:91], a[24:27], v[32:35]
s_waitcnt lgkmcnt(3)
ds_read_b128 a[108:111], v1 offset:11264
v_mfma_f32_16x16x32_bf16 v[32:35], a[92:95], a[28:31], v[32:35]
buffer_load_dwordx4 v1, s[4:7], s12 offen offset:3072 sc1 lds
v_mfma_f32_16x16x32_bf16 v[36:39], a[64:67], a[32:35], 0
s_add_u32 s12, s12, 4096
s_add_u32 m0, s18, 69632
ds_read_b128 a[112:115], v1 offset:12288
v_mfma_f32_16x16x32_bf16 v[36:39], a[68:71], a[36:39], v[36:39]
buffer_load_dwordx4 v1, s[4:7], s12 offen offset:0 sc1 lds
v_mfma_f32_16x16x32_bf16 v[36:39], a[72:75], a[40:43], v[36:39]
ds_read_b128 a[116:119], v1 offset:13312
v_mfma_f32_16x16x32_bf16 v[36:39], a[76:79], a[44:47], v[36:39]
buffer_load_dwordx4 v1, s[4:7], s12 offen offset:1024 sc1 lds
v_mfma_f32_16x16x32_bf16 v[36:39], a[80:83], a[48:51], v[36:39]
ds_read_b128 a[120:123], v1 offset:14336
v_max3_f32 v28, v32, v33, v34
v_mfma_f32_16x16x32_bf16 v[36:39], a[84:87], a[52:55], v[36:39]
buffer_load_dwordx4 v1, s[4:7], s12 offen offset:2048 sc1 lds
v_mfma_f32_16x16x32_bf16 v[36:39], a[88:91], a[56:59], v[36:39]
ds_read_b128 a[124:127], v1 offset:15360
v_max_f32 v28, v28, v35
v_mfma_f32_16x16x32_bf16 v[36:39], a[92:95], a[60:63], v[36:39]
s_waitcnt lgkmcnt(4)
buffer_load_dwordx4 v1, s[4:7], s12 offen offset:3072 sc1 lds
v_mfma_f32_16x16x32_bf16 v[40:43], a[96:99], a[0:3], 0
s_add_u32 s12, s12, 28672
ds_read_b128 a[64:67], v1 offset:16384
v_mov_b32 v30, v28
v_mfma_f32_16x16x32_bf16 v[40:43], a[100:103], a[4:7], v[40:43]
s_waitcnt lgkmcnt(2)
s_sub_u32 s13, s13, 1
v_mfma_f32_16x16x32_bf16 v[40:43], a[104:107], a[8:11], v[40:43]
s_cmp_eq_u32 s13, 0
ds_read_b128 a[68:71], v1 offset:17408
v_permlane16_swap_b32 v28, v30
v_mfma_f32_16x16x32_bf16 v[40:43], a[108:111], a[12:15], v[40:43]
s_cselect_b32 s12, s14, s12
v_max_f32 v28, v28, v30
v_mov_b32 v30, v28
v_mfma_f32_16x16x32_bf16 v[40:43], a[112:115], a[16:19], v[40:43]
s_cselect_b32 s13, s15, s13
ds_read_b128 a[72:75], v1 offset:18432
v_max3_f32 v29, v36, v37, v38
v_mfma_f32_16x16x32_bf16 v[40:43], a[116:119], a[20:23], v[40:43]
s_cselect_b32 s14, 3221225472, s14
v_permlane32_swap_b32 v28, v30
v_max_f32 v28, v28, v30
v_mfma_f32_16x16x32_bf16 v[40:43], a[120:123], a[24:27], v[40:43]
s_waitcnt lgkmcnt(3)
ds_read_b128 a[76:79], v1 offset:19456
v_sub_f32 v16, 0, v28
v_mfma_f32_16x16x32_bf16 v[40:43], a[124:127], a[28:31], v[40:43]
v_sub_f32 v17, 0, v28
v_sub_f32 v18, 0, v28
v_mfma_f32_16x16x32_bf16 v[44:47], a[96:99], a[32:35], 0
ds_read_b128 a[80:83], v1 offset:20480
v_sub_f32 v19, 0, v28
v_mfma_f32_16x16x32_bf16 v[44:47], a[100:103], a[36:39], v[44:47]
v_max_f32 v29, v29, v39
v_mov_b32 v31, v29
v_mfma_f32_16x16x32_bf16 v[44:47], a[104:107], a[40:43], v[44:47]
ds_read_b128 a[84:87], v1 offset:21504
v_mfma_f32_16x16x32_bf16 v[44:47], a[108:111], a[44:47], v[44:47]
v_permlane16_swap_b32 v29, v31
v_max_f32 v29, v29, v31
v_mfma_f32_16x16x32_bf16 v[44:47], a[112:115], a[48:51], v[44:47]
ds_read_b128 a[88:91], v1 offset:22528
v_mov_b32 v31, v29
v_mfma_f32_16x16x32_bf16 v[44:47], a[116:119], a[52:55], v[44:47]
v_mfma_f32_16x16x32_bf16 v[44:47], a[120:123], a[56:59], v[44:47]
ds_read_b128 a[92:95], v1 offset:23552
v_permlane32_swap_b32 v29, v31
v_mfma_f32_16x16x32_bf16 v[44:47], a[124:127], a[60:63], v[44:47]
s_waitcnt lgkmcnt(4)
v_max_f32 v29, v29, v31
v_sub_f32 v20, 0, v29
v_mfma_f32_16x16x32_bf16 v[48:51], a[64:67], a[0:3], v[16:19]
ds_read_b128 a[96:99], v1 offset:24576
v_sub_f32 v21, 0, v29
v_mfma_f32_16x16x32_bf16 v[48:51], a[68:71], a[4:7], v[48:51]
v_sub_f32 v22, 0, v29
v_sub_f32 v23, 0, v29
v_mfma_f32_16x16x32_bf16 v[48:51], a[72:75], a[8:11], v[48:51]
ds_read_b128 a[100:103], v1 offset:25600
v_mfma_f32_16x16x32_bf16 v[48:51], a[76:79], a[12:15], v[48:51]
s_waitcnt lgkmcnt(4)
v_mfma_f32_16x16x32_bf16 v[48:51], a[80:83], a[16:19], v[48:51]
ds_read_b128 a[104:107], v1 offset:26624
v_mfma_f32_16x16x32_bf16 v[48:51], a[84:87], a[20:23], v[48:51]
s_waitcnt lgkmcnt(4)
v_add_f32 v32, v32, v16
v_add_f32 v33, v33, v16
v_add_f32 v34, v34, v16
v_add_f32 v35, v35, v16
v_mfma_f32_16x16x32_bf16 v[48:51], a[88:91], a[24:27], v[48:51]
s_waitcnt lgkmcnt(3)
ds_read_b128 a[108:111], v1 offset:27648
v_add_f32 v36, v36, v20
v_add_f32 v37, v37, v20
v_add_f32 v38, v38, v20
v_add_f32 v39, v39, v20
v_mfma_f32_16x16x32_bf16 v[48:51], a[92:95], a[28:31], v[48:51]
v_add_f32 v40, v40, v16
v_add_f32 v41, v41, v16
v_add_f32 v42, v42, v16
v_add_f32 v43, v43, v16
v_mfma_f32_16x16x32_bf16 v[52:55], a[64:67], a[32:35], v[20:23]
ds_read_b128 a[112:115], v1 offset:28672
v_add_f32 v44, v44, v20
v_add_f32 v45, v45, v20
v_add_f32 v46, v46, v20
v_add_f32 v47, v47, v20
v_mfma_f32_16x16x32_bf16 v[52:55], a[68:71], a[36:39], v[52:55]
v_exp_f32 v8, v32
v_mfma_f32_16x16x32_bf16 v[52:55], a[72:75], a[40:43], v[52:55]
ds_read_b128 a[116:119], v1 offset:29696
v_exp_f32 v9, v33
v_mfma_f32_16x16x32_bf16 v[52:55], a[76:79], a[44:47], v[52:55]
v_exp_f32 v10, v34
v_add_f32 v26, v8, v9
v_cvt_pk_bf16_f32 v96, v8, v9
v_mfma_f32_16x16x32_bf16 v[52:55], a[80:83], a[48:51], v[52:55]
ds_read_b128 a[120:123], v1 offset:30720
v_exp_f32 v11, v35
v_add_f32 v26, v26, v10
v_mfma_f32_16x16x32_bf16 v[52:55], a[84:87], a[52:55], v[52:55]
v_exp_f32 v12, v36
v_add_f32 v26, v26, v11
v_cvt_pk_bf16_f32 v97, v10, v11
v_mfma_f32_16x16x32_bf16 v[52:55], a[88:91], a[56:59], v[52:55]
s_waitcnt vmcnt(8) lgkmcnt(4)
ds_read_b128 a[124:127], v1 offset:31744
v_exp_f32 v13, v37
v_mfma_f32_16x16x32_bf16 v[52:55], a[92:95], a[60:63], v[52:55]
s_barrier
v_mfma_f32_16x16x32_bf16 v[56:59], a[96:99], a[0:3], v[16:19]
ds_read_b128 a[64:67], v4 offset:0
v_exp_f32 v14, v38
v_mfma_f32_16x16x32_bf16 v[56:59], a[100:103], a[4:7], v[56:59]
buffer_store_dword v6, v5, s[4:7], s71 offen sc1
v_mfma_f32_16x16x32_bf16 v[56:59], a[104:107], a[8:11], v[56:59]
s_waitcnt lgkmcnt(4)
ds_read_b128 a[68:71], v4 offset:1024
v_add_f32 v27, v12, v13
v_cvt_pk_bf16_f32 v104, v12, v13
v_add_f32 v27, v27, v14
v_mfma_f32_16x16x32_bf16 v[56:59], a[108:111], a[12:15], v[56:59]
v_exp_f32 v15, v39
v_mfma_f32_16x16x32_bf16 v[56:59], a[112:115], a[16:19], v[56:59]
s_waitcnt lgkmcnt(4)
ds_read_b128 a[72:75], v4 offset:2048
v_exp_f32 v8, v40
v_add_f32 v27, v27, v15
v_cvt_pk_bf16_f32 v105, v14, v15
v_mfma_f32_16x16x32_bf16 v[56:59], a[116:119], a[20:23], v[56:59]
s_waitcnt lgkmcnt(4)
v_exp_f32 v9, v41
v_add_f32 v26, v26, v8
v_mfma_f32_16x16x32_bf16 v[56:59], a[120:123], a[24:27], v[56:59]
s_waitcnt lgkmcnt(3)
ds_read_b128 a[76:79], v4 offset:3072
v_exp_f32 v10, v42
v_add_f32 v26, v26, v9
v_cvt_pk_bf16_f32 v98, v8, v9
v_mfma_f32_16x16x32_bf16 v[56:59], a[124:127], a[28:31], v[56:59]
v_exp_f32 v11, v43
v_add_f32 v26, v26, v10
v_mfma_f32_16x16x32_bf16 v[60:63], a[96:99], a[32:35], v[20:23]
ds_read_b128 a[80:83], v4 offset:4096
v_exp_f32 v12, v44
v_mfma_f32_16x16x32_bf16 v[60:63], a[100:103], a[36:39], v[60:63]
v_exp_f32 v13, v45
v_mfma_f32_16x16x32_bf16 v[60:63], a[104:107], a[40:43], v[60:63]
ds_read_b128 a[84:87], v4 offset:5120
v_exp_f32 v14, v46
v_mfma_f32_16x16x32_bf16 v[60:63], a[108:111], a[44:47], v[60:63]
v_exp_f32 v15, v47
v_mfma_f32_16x16x32_bf16 v[60:63], a[112:115], a[48:51], v[60:63]
ds_read_b128 a[88:91], v4 offset:6144
v_add_f32 v26, v26, v11
v_cvt_pk_bf16_f32 v99, v10, v11
v_mfma_f32_16x16x32_bf16 v[60:63], a[116:119], a[52:55], v[60:63]
v_add_f32 v27, v27, v12
v_add_f32 v27, v27, v13
v_cvt_pk_bf16_f32 v106, v12, v13
v_mfma_f32_16x16x32_bf16 v[60:63], a[120:123], a[56:59], v[60:63]
s_waitcnt lgkmcnt(7)
s_barrier
ds_read_b128 a[92:95], v4 offset:7168
v_mfma_f32_16x16x32_bf16 v[60:63], a[124:127], a[60:63], v[60:63]
s_waitcnt lgkmcnt(4)
v_add_f32 v27, v27, v14
v_add_f32 v27, v27, v15
v_cvt_pk_bf16_f32 v107, v14, v15
K2_x1:
v_mfma_f32_16x16x32_bf16 v[64:67], a[64:67], a[0:3], v[16:19]
s_add_u32 m0, s18, 0
ds_read_b128 a[96:99], v4 offset:8192
v_mfma_f32_16x16x32_bf16 v[64:67], a[68:71], a[4:7], v[64:67]
s_waitcnt lgkmcnt(4)
buffer_load_dwordx4 v1, s[4:7], s8 offen offset:0 sc1 lds
v_mfma_f32_16x16x32_bf16 v[64:67], a[72:75], a[8:11], v[64:67]
ds_read_b128 a[100:103], v4 offset:9216
v_mfma_f32_16x16x32_bf16 v[64:67], a[76:79], a[12:15], v[64:67]
s_waitcnt lgkmcnt(4)
v_exp_f32 v8, v48
v_mfma_f32_16x16x32_bf16 v[64:67], a[80:83], a[16:19], v[64:67]
ds_read_b128 a[104:107], v4 offset:10240
v_add_f32 v26, v26, v8
v_mfma_f32_16x16x32_bf16 v[64:67], a[84:87], a[20:23], v[64:67]
s_waitcnt lgkmcnt(4)
buffer_load_dwordx4 v1, s[4:7], s8 offen offset:1024 sc1 lds
v_mfma_f32_16x16x32_bf16 v[64:67], a[88:91], a[24:27], v[64:67]
s_waitcnt lgkmcnt(3)
ds_read_b128 a[108:111], v4 offset:11264
v_mfma_f32_16x16x32_bf16 v[64:67], a[92:95], a[28:31], v[64:67]
v_exp_f32 v9, v49
v_mfma_f32_16x16x32_bf16 v[68:71], a[64:67], a[32:35], v[20:23]
ds_read_b128 a[112:115], v4 offset:12288
v_add_f32 v26, v26, v9
v_mfma_f32_16x16x32_bf16 v[68:71], a[68:71], a[36:39], v[68:71]
buffer_load_dwordx4 v1, s[4:7], s8 offen offset:2048 sc1 lds
v_mfma_f32_16x16x32_bf16 v[68:71], a[72:75], a[40:43], v[68:71]
ds_read_b128 a[116:119], v4 offset:13312
v_cvt_pk_bf16_f32 v100, v8, v9
v_mfma_f32_16x16x32_bf16 v[68:71], a[76:79], a[44:47], v[68:71]
v_exp_f32 v10, v50
v_mfma_f32_16x16x32_bf16 v[68:71], a[80:83], a[48:51], v[68:71]
ds_read_b128 a[120:123], v4 offset:14336
v_add_f32 v26, v26, v10
v_mfma_f32_16x16x32_bf16 v[68:71], a[84:87], a[52:55], v[68:71]
buffer_load_dwordx4 v1, s[4:7], s8 offen offset:3072 sc1 lds
v_mfma_f32_16x16x32_bf16 v[68:71], a[88:91], a[56:59], v[68:71]
s_add_u32 s8, s8, 4096
ds_read_b128 a[124:127], v4 offset:15360
v_mfma_f32_16x16x32_bf16 v[68:71], a[92:95], a[60:63], v[68:71]
s_waitcnt lgkmcnt(4)
v_exp_f32 v11, v51
v_mfma_f32_16x16x32_bf16 v[72:75], a[96:99], a[0:3], v[16:19]
s_add_u32 m0, s18, 4096
ds_read_b128 a[64:67], v4 offset:16384
v_add_f32 v26, v26, v11
v_mfma_f32_16x16x32_bf16 v[72:75], a[100:103], a[4:7], v[72:75]
buffer_load_dwordx4 v1, s[4:7], s8 offen offset:0 sc1 lds
v_mfma_f32_16x16x32_bf16 v[72:75], a[104:107], a[8:11], v[72:75]
ds_read_b128 a[68:71], v4 offset:17408
v_cvt_pk_bf16_f32 v101, v10, v11
v_mfma_f32_16x16x32_bf16 v[72:75], a[108:111], a[12:15], v[72:75]
s_waitcnt lgkmcnt(4)
v_mfma_f32_16x16x32_bf16 v[72:75], a[112:115], a[16:19], v[72:75]
ds_read_b128 a[72:75], v4 offset:18432
v_mfma_f32_16x16x32_bf16 v[72:75], a[116:119], a[20:23], v[72:75]
s_waitcnt lgkmcnt(4)
buffer_load_dwordx4 v1, s[4:7], s8 offen offset:1024 sc1 lds
v_mfma_f32_16x16x32_bf16 v[72:75], a[120:123], a[24:27], v[72:75]
s_waitcnt lgkmcnt(3)
ds_read_b128 a[76:79], v4 offset:19456
v_mfma_f32_16x16x32_bf16 v[72:75], a[124:127], a[28:31], v[72:75]
v_exp_f32 v12, v52
v_mfma_f32_16x16x32_bf16 v[76:79], a[96:99], a[32:35], v[20:23]
ds_read_b128 a[80:83], v4 offset:20480
v_add_f32 v27, v27, v12
v_mfma_f32_16x16x32_bf16 v[76:79], a[100:103], a[36:39], v[76:79]
buffer_load_dwordx4 v1, s[4:7], s8 offen offset:2048 sc1 lds
v_mfma_f32_16x16x32_bf16 v[76:79], a[104:107], a[40:43], v[76:79]
ds_read_b128 a[84:87], v4 offset:21504
v_mfma_f32_16x16x32_bf16 v[76:79], a[108:111], a[44:47], v[76:79]
v_exp_f32 v13, v53
v_mfma_f32_16x16x32_bf16 v[76:79], a[112:115], a[48:51], v[76:79]
ds_read_b128 a[88:91], v4 offset:22528
v_add_f32 v27, v27, v13
v_mfma_f32_16x16x32_bf16 v[76:79], a[116:119], a[52:55], v[76:79]
s_waitcnt lgkmcnt(3)
buffer_load_dwordx4 v1, s[4:7], s8 offen offset:3072 sc1 lds
v_mfma_f32_16x16x32_bf16 v[76:79], a[120:123], a[56:59], v[76:79]
s_add_u32 s8, s8, 28672
ds_read_b128 a[92:95], v4 offset:23552
v_cvt_pk_bf16_f32 v108, v12, v13
v_mfma_f32_16x16x32_bf16 v[76:79], a[124:127], a[60:63], v[76:79]
s_sub_u32 s9, s9, 1
v_exp_f32 v14, v54
v_mfma_f32_16x16x32_bf16 v[80:83], a[64:67], a[0:3], v[16:19]
s_cmp_eq_u32 s9, 0
ds_read_b128 a[96:99], v4 offset:24576
v_add_f32 v27, v27, v14
v_mfma_f32_16x16x32_bf16 v[80:83], a[68:71], a[4:7], v[80:83]
s_cselect_b32 s8, s10, s8
v_exp_f32 v15, v55
v_mfma_f32_16x16x32_bf16 v[80:83], a[72:75], a[8:11], v[80:83]
s_cselect_b32 s9, s11, s9
ds_read_b128 a[100:103], v4 offset:25600
v_add_f32 v27, v27, v15
v_mfma_f32_16x16x32_bf16 v[80:83], a[76:79], a[12:15], v[80:83]
s_waitcnt lgkmcnt(4)
s_cselect_b32 s10, 3221225472, s10
v_cvt_pk_bf16_f32 v109, v14, v15
v_mfma_f32_16x16x32_bf16 v[80:83], a[80:83], a[16:19], v[80:83]
ds_read_b128 a[104:107], v4 offset:26624
v_mfma_f32_16x16x32_bf16 v[80:83], a[84:87], a[20:23], v[80:83]
s_waitcnt lgkmcnt(4)
v_exp_f32 v8, v56
v_mfma_f32_16x16x32_bf16 v[80:83], a[88:91], a[24:27], v[80:83]
s_waitcnt lgkmcnt(3)
ds_read_b128 a[108:111], v4 offset:27648
v_add_f32 v26, v26, v8
v_mfma_f32_16x16x32_bf16 v[80:83], a[92:95], a[28:31], v[80:83]
v_exp_f32 v9, v57
v_mfma_f32_16x16x32_bf16 v[84:87], a[64:67], a[32:35], v[20:23]
ds_read_b128 a[112:115], v4 offset:28672
v_add_f32 v26, v26, v9
v_mfma_f32_16x16x32_bf16 v[84:87], a[68:71], a[36:39], v[84:87]
v_exp_f32 v10, v58
v_mfma_f32_16x16x32_bf16 v[84:87], a[72:75], a[40:43], v[84:87]
ds_read_b128 a[116:119], v4 offset:29696
v_cvt_pk_bf16_f32 v102, v8, v9
v_mfma_f32_16x16x32_bf16 v[84:87], a[76:79], a[44:47], v[84:87]
v_exp_f32 v11, v59
v_mfma_f32_16x16x32_bf16 v[84:87], a[80:83], a[48:51], v[84:87]
ds_read_b128 a[120:123], v4 offset:30720
v_add_f32 v26, v26, v10
v_mfma_f32_16x16x32_bf16 v[84:87], a[84:87], a[52:55], v[84:87]
v_add_f32 v26, v26, v11
v_cvt_pk_bf16_f32 v103, v10, v11
v_mfma_f32_16x16x32_bf16 v[84:87], a[88:91], a[56:59], v[84:87]
s_waitcnt vmcnt(8) lgkmcnt(4)
ds_read_b128 a[124:127], v4 offset:31744
v_mfma_f32_16x16x32_bf16 v[84:87], a[92:95], a[60:63], v[84:87]
s_barrier
v_mfma_f32_16x16x32_bf16 v[88:91], a[96:99], a[0:3], v[16:19]
ds_read_b128 a[64:67], v2 offset:0
v_mfma_f32_16x16x32_bf16 v[88:91], a[100:103], a[4:7], v[88:91]
v_exp_f32 v12, v60
v_mfma_f32_16x16x32_bf16 v[88:91], a[104:107], a[8:11], v[88:91]
s_waitcnt lgkmcnt(4)
ds_read_b128 a[68:71], v2 offset:1024
v_add_f32 v27, v27, v12
v_mfma_f32_16x16x32_bf16 v[88:91], a[108:111], a[12:15], v[88:91]
v_exp_f32 v13, v61
v_mfma_f32_16x16x32_bf16 v[88:91], a[112:115], a[16:19], v[88:91]
s_waitcnt lgkmcnt(4)
ds_read_b128 a[72:75], v2 offset:2048
v_add_f32 v27, v27, v13
v_mfma_f32_16x16x32_bf16 v[88:91], a[116:119], a[20:23], v[88:91]
s_waitcnt lgkmcnt(4)
v_exp_f32 v14, v62
v_mfma_f32_16x16x32_bf16 v[88:91], a[120:123], a[24:27], v[88:91]
s_waitcnt lgkmcnt(3)
ds_read_b128 a[76:79], v2 offset:3072
v_cvt_pk_bf16_f32 v110, v12, v13
v_mfma_f32_16x16x32_bf16 v[88:91], a[124:127], a[28:31], v[88:91]
v_exp_f32 v15, v63
v_mfma_f32_16x16x32_bf16 v[92:95], a[96:99], a[32:35], v[20:23]
s_sub_u32 s19, s19, 1
ds_read_b128 a[80:83], v2 offset:4096
v_add_f32 v27, v27, v14
v_mfma_f32_16x16x32_bf16 v[92:95], a[100:103], a[36:39], v[92:95]
v_add_f32 v27, v27, v15
v_cvt_pk_bf16_f32 v111, v14, v15
v_mfma_f32_16x16x32_bf16 v[92:95], a[104:107], a[40:43], v[92:95]
ds_read_b128 a[84:87], v2 offset:5120
v_add_f32 v28, v26, v27
v_mfma_f32_16x16x32_bf16 v[92:95], a[108:111], a[44:47], v[92:95]
v_cmp_nge_f32 vcc, s25, v28
v_mfma_f32_16x16x32_bf16 v[92:95], a[112:115], a[48:51], v[92:95]
s_cmp_eq_u64 vcc, 0
ds_read_b128 a[88:91], v2 offset:6144
v_mfma_f32_16x16x32_bf16 v[92:95], a[116:119], a[52:55], v[92:95]
s_cselect_b32 s22, s19, 0
v_mfma_f32_16x16x32_bf16 v[92:95], a[120:123], a[56:59], v[92:95]
s_cmp_eq_u32 s22, 0
ds_read_b128 a[92:95], v2 offset:7168
v_mfma_f32_16x16x32_bf16 v[92:95], a[124:127], a[60:63], v[92:95]
s_waitcnt lgkmcnt(4)
s_cbranch_scc1 K2_xexit
K2_loop:
v_mfma_f32_16x16x32_bf16 v[128:131], a[64:67], v[96:99], v[128:131]
s_add_u32 m0, s18, 98304
ds_read_b128 a[96:99], v2 offset:8192
v_add_f32 v24, v24, v26
v_mfma_f32_16x16x32_bf16 v[128:131], a[68:71], v[100:103], v[128:131]
buffer_load_dwordx4 v1, s[4:7], s12 offen offset:0 sc1 lds
v_mfma_f32_16x16x32_bf16 v[132:135], a[68:71], v[108:111], v[132:135]
ds_read_b128 a[100:103], v2 offset:9216
v_add_f32 v25, v25, v27
v_mfma_f32_16x16x32_bf16 v[132:135], a[64:67], v[104:107], v[132:135]
v_exp_f32 v8, v64
v_mfma_f32_16x16x32_bf16 v[136:139], a[72:75], v[96:99], v[136:139]
ds_read_b128 a[104:107], v2 offset:10240
v_mfma_f32_16x16x32_bf16 v[136:139], a[76:79], v[100:103], v[136:139]
buffer_load_dwordx4 v1, s[4:7], s12 offen offset:1024 sc1 lds
v_mfma_f32_16x16x32_bf16 v[140:143], a[76:79], v[108:111], v[140:143]
ds_read_b128 a[108:111], v2 offset:11264
v_mfma_f32_16x16x32_bf16 v[140:143], a[72:75], v[104:107], v[140:143]
s_waitcnt lgkmcnt(4)
v_exp_f32 v9, v65
v_mfma_f32_16x16x32_bf16 v[144:147], a[80:83], v[96:99], v[144:147]
ds_read_b128 a[112:115], v2 offset:12288
v_add_f32 v26, v8, v9
v_mfma_f32_16x16x32_bf16 v[144:147], a[84:87], v[100:103], v[144:147]
PAD_10:
s_cbranch_execz M_tret
buffer_load_dwordx4 v1, s[4:7], s12 offen offset:2048 sc1 lds
v_mfma_f32_16x16x32_bf16 v[148:151], a[84:87], v[108:111], v[148:151]
ds_read_b128 a[116:119], v2 offset:13312
v_cvt_pk_bf16_f32 v112, v8, v9
v_mfma_f32_16x16x32_bf16 v[148:151], a[80:83], v[104:107], v[148:151]
v_exp_f32 v10, v66
v_mfma_f32_16x16x32_bf16 v[152:155], a[88:91], v[96:99], v[152:155]
ds_read_b128 a[120:123], v2 offset:14336
v_add_f32 v26, v26, v10
v_mfma_f32_16x16x32_bf16 v[152:155], a[92:95], v[100:103], v[152:155]
buffer_load_dwordx4 v1, s[4:7], s12 offen offset:3072 sc1 lds
v_mfma_f32_16x16x32_bf16 v[156:159], a[92:95], v[108:111], v[156:159]
s_add_u32 s12, s12, 4096
ds_read_b128 a[124:127], v2 offset:15360
v_mfma_f32_16x16x32_bf16 v[156:159], a[88:91], v[104:107], v[156:159]
s_waitcnt lgkmcnt(4)
v_exp_f32 v11, v67
v_mfma_f32_16x16x32_bf16 v[160:163], a[96:99], v[96:99], v[160:163]
s_add_u32 m0, s18, 102400
ds_read_b128 a[64:67], v2 offset:16384
v_add_f32 v26, v26, v11
v_mfma_f32_16x16x32_bf16 v[160:163], a[100:103], v[100:103], v[160:163]
buffer_load_dwordx4 v1, s[4:7], s12 offen offset:0 sc1 lds
v_mfma_f32_16x16x32_bf16 v[164:167], a[100:103], v[108:111], v[164:167]
ds_read_b128 a[68:71], v2 offset:17408
v_cvt_pk_bf16_f32 v113, v10, v11
v_mfma_f32_16x16x32_bf16 v[164:167], a[96:99], v[104:107], v[164:167]
v_mfma_f32_16x16x32_bf16 v[168:171], a[104:107], v[96:99], v[168:171]
ds_read_b128 a[72:75], v2 offset:18432
v_mfma_f32_16x16x32_bf16 v[168:171], a[108:111], v[100:103], v[168:171]
buffer_load_dwordx4 v1, s[4:7], s12 offen offset:1024 sc1 lds
v_mfma_f32_16x16x32_bf16 v[172:175], a[108:111], v[108:111], v[172:175]
ds_read_b128 a[76:79], v2 offset:19456
v_mfma_f32_16x16x32_bf16 v[172:175], a[104:107], v[104:107], v[172:175]
s_waitcnt lgkmcnt(4)
v_exp_f32 v12, v68
v_mfma_f32_16x16x32_bf16 v[176:179], a[112:115], v[96:99], v[176:179]
ds_read_b128 a[80:83], v2 offset:20480
v_mfma_f32_16x16x32_bf16 v[176:179], a[116:119], v[100:103], v[176:179]
buffer_load_dwordx4 v1, s[4:7], s12 offen offset:2048 sc1 lds
v_mfma_f32_16x16x32_bf16 v[180:183], a[116:119], v[108:111], v[180:183]
ds_read_b128 a[84:87], v2 offset:21504
v_mfma_f32_16x16x32_bf16 v[180:183], a[112:115], v[104:107], v[180:183]
v_exp_f32 v13, v69
v_mfma_f32_16x16x32_bf16 v[184:187], a[120:123], v[96:99], v[184:187]
ds_read_b128 a[88:91], v2 offset:22528
v_add_f32 v27, v12, v13
v_mfma_f32_16x16x32_bf16 v[184:187], a[124:127], v[100:103], v[184:187]
s_waitcnt lgkmcnt(4)
buffer_load_dwordx4 v1, s[4:7], s12 offen offset:3072 sc1 lds
v_mfma_f32_16x16x32_bf16 v[188:191], a[124:127], v[108:111], v[188:191]
s_add_u32 s12, s12, 28672
ds_read_b128 a[92:95], v2 offset:23552
v_cvt_pk_bf16_f32 v120, v12, v13
v_mfma_f32_16x16x32_bf16 v[188:191], a[120:123], v[104:107], v[188:191]
s_sub_u32 s13, s13, 1
v_exp_f32 v14, v70
v_mfma_f32_16x16x32_bf16 v[192:195], a[64:67], v[96:99], v[192:195]
s_cmp_eq_u32 s13, 0
ds_read_b128 a[96:99], v2 offset:24576
v_add_f32 v27, v27, v14
v_mfma_f32_16x16x32_bf16 v[192:195], a[68:71], v[100:103], v[192:195]
s_cselect_b32 s12, s14, s12
v_mfma_f32_16x16x32_bf16 v[196:199], a[68:71], v[108:111], v[196:199]
s_cselect_b32 s13, s15, s13
ds_read_b128 a[100:103], v2 offset:25600
v_mfma_f32_16x16x32_bf16 v[196:199], a[64:67], v[104:107], v[196:199]
s_cselect_b32 s14, 3221225472, s14
v_exp_f32 v15, v71
v_mfma_f32_16x16x32_bf16 v[200:203], a[72:75], v[96:99], v[200:203]
s_waitcnt lgkmcnt(4)
ds_read_b128 a[104:107], v2 offset:26624
v_add_f32 v27, v27, v15
v_mfma_f32_16x16x32_bf16 v[200:203], a[76:79], v[100:103], v[200:203]
v_exp_f32 v8, v72
v_mfma_f32_16x16x32_bf16 v[204:207], a[76:79], v[108:111], v[204:207]
ds_read_b128 a[108:111], v2 offset:27648
v_cvt_pk_bf16_f32 v121, v14, v15
v_mfma_f32_16x16x32_bf16 v[204:207], a[72:75], v[104:107], v[204:207]
v_exp_f32 v9, v73
v_mfma_f32_16x16x32_bf16 v[208:211], a[80:83], v[96:99], v[208:211]
ds_read_b128 a[112:115], v2 offset:28672
v_add_f32 v26, v26, v8
v_mfma_f32_16x16x32_bf16 v[208:211], a[84:87], v[100:103], v[208:211]
v_add_f32 v26, v26, v9
v_cvt_pk_bf16_f32 v114, v8, v9
v_mfma_f32_16x16x32_bf16 v[212:215], a[84:87], v[108:111], v[212:215]
ds_read_b128 a[116:119], v2 offset:29696
v_mfma_f32_16x16x32_bf16 v[212:215], a[80:83], v[104:107], v[212:215]
s_waitcnt lgkmcnt(4)
v_exp_f32 v10, v74
v_mfma_f32_16x16x32_bf16 v[216:219], a[88:91], v[96:99], v[216:219]
ds_read_b128 a[120:123], v2 offset:30720
v_add_f32 v26, v26, v10
v_mfma_f32_16x16x32_bf16 v[216:219], a[92:95], v[100:103], v[216:219]
v_exp_f32 v11, v75
v_mfma_f32_16x16x32_bf16 v[220:223], a[92:95], v[108:111], v[220:223]
s_waitcnt vmcnt(8)
ds_read_b128 a[124:127], v2 offset:31744
v_add_f32 v26, v26, v11
v_mfma_f32_16x16x32_bf16 v[220:223], a[88:91], v[104:107], v[220:223]
s_barrier
v_mfma_f32_16x16x32_bf16 v[224:227], a[96:99], v[96:99], v[224:227]
ds_read_b128 a[64:67], v1 offset:0
v_cvt_pk_bf16_f32 v115, v10, v11
v_mfma_f32_16x16x32_bf16 v[224:227], a[100:103], v[100:103], v[224:227]
v_exp_f32 v12, v76
v_mfma_f32_16x16x32_bf16 v[228:231], a[100:103], v[108:111], v[228:231]
ds_read_b128 a[68:71], v1 offset:1024
v_add_f32 v27, v27, v12
v_mfma_f32_16x16x32_bf16 v[228:231], a[96:99], v[104:107], v[228:231]
s_waitcnt lgkmcnt(4)
v_mfma_f32_16x16x32_bf16 v[232:235], a[104:107], v[96:99], v[232:235]
ds_read_b128 a[72:75], v1 offset:2048
v_mfma_f32_16x16x32_bf16 v[232:235], a[108:111], v[100:103], v[232:235]
v_exp_f32 v13, v77
v_mfma_f32_16x16x32_bf16 v[236:239], a[108:111], v[108:111], v[236:239]
ds_read_b128 a[76:79], v1 offset:3072
v_add_f32 v27, v27, v13
v_mfma_f32_16x16x32_bf16 v[236:239], a[104:107], v[104:107], v[236:239]
v_exp_f32 v14, v78
v_mfma_f32_16x16x32_bf16 v[240:243], a[112:115], v[96:99], v[240:243]
ds_read_b128 a[80:83], v1 offset:4096
v_cvt_pk_bf16_f32 v122, v12, v13
v_mfma_f32_16x16x32_bf16 v[240:243], a[116:119], v[100:103], v[240:243]
v_exp_f32 v15, v79
v_mfma_f32_16x16x32_bf16 v[244:247], a[116:119], v[108:111], v[244:247]
ds_read_b128 a[84:87], v1 offset:5120
v_add_f32 v27, v27, v14
v_mfma_f32_16x16x32_bf16 v[244:247], a[112:115], v[104:107], v[244:247]
s_waitcnt lgkmcnt(4)
v_add_f32 v27, v27, v15
v_cvt_pk_bf16_f32 v123, v14, v15
v_mfma_f32_16x16x32_bf16 v[248:251], a[120:123], v[96:99], v[248:251]
ds_read_b128 a[88:91], v1 offset:6144
v_mfma_f32_16x16x32_bf16 v[248:251], a[124:127], v[100:103], v[248:251]
v_mfma_f32_16x16x32_bf16 v[252:255], a[124:127], v[108:111], v[252:255]
ds_read_b128 a[92:95], v1 offset:7168
v_mfma_f32_16x16x32_bf16 v[252:255], a[120:123], v[104:107], v[252:255]
K2_x0:
v_mfma_f32_16x16x32_bf16 v[32:35], a[64:67], a[0:3], v[16:19]
s_add_u32 m0, s18, 131072
ds_read_b128 a[96:99], v1 offset:8192
v_mfma_f32_16x16x32_bf16 v[32:35], a[68:71], a[4:7], v[32:35]
s_waitcnt lgkmcnt(4)
buffer_load_dwordx4 v1, s[4:7], s8 offen offset:0 sc1 lds
v_mfma_f32_16x16x32_bf16 v[32:35], a[72:75], a[8:11], v[32:35]
ds_read_b128 a[100:103], v1 offset:9216
v_mfma_f32_16x16x32_bf16 v[32:35], a[76:79], a[12:15], v[32:35]
v_exp_f32 v8, v80
v_mfma_f32_16x16x32_bf16 v[32:35], a[80:83], a[16:19], v[32:35]
s_waitcnt lgkmcnt(4)
ds_read_b128 a[104:107], v1 offset:10240
v_add_f32 v26, v26, v8
v_mfma_f32_16x16x32_bf16 v[32:35], a[84:87], a[20:23], v[32:35]
s_waitcnt lgkmcnt(4)
buffer_load_dwordx4 v1, s[4:7], s8 offen offset:1024 sc1 lds
v_mfma_f32_16x16x32_bf16 v[32:35], a[88:91], a[24:27], v[32:35]
s_waitcnt lgkmcnt(3)
ds_read_b128 a[108:111], v1 offset:11264
v_mfma_f32_16x16x32_bf16 v[32:35], a[92:95], a[28:31], v[32:35]
v_exp_f32 v9, v81
v_mfma_f32_16x16x32_bf16 v[36:39], a[64:67], a[32:35], v[20:23]
ds_read_b128 a[112:115], v1 offset:12288
v_add_f32 v26, v26, v9
v_mfma_f32_16x16x32_bf16 v[36:39], a[68:71], a[36:39], v[36:39]
buffer_load_dwordx4 v1, s[4:7], s8 offen offset:2048 sc1 lds
v_mfma_f32_16x16x32_bf16 v[36:39], a[72:75], a[40:43], v[36:39]
ds_read_b128 a[116:119], v1 offset:13312
v_cvt_pk_bf16_f32 v116, v8, v9
v_mfma_f32_16x16x32_bf16 v[36:39], a[76:79], a[44:47], v[36:39]
v_exp_f32 v10, v82
v_mfma_f32_16x16x32_bf16 v[36:39], a[80:83], a[48:51], v[36:39]
ds_read_b128 a[120:123], v1 offset:14336
v_add_f32 v26, v26, v10
v_mfma_f32_16x16x32_bf16 v[36:39], a[84:87], a[52:55], v[36:39]
buffer_load_dwordx4 v1, s[4:7], s8 offen offset:3072 sc1 lds
v_mfma_f32_16x16x32_bf16 v[36:39], a[88:91], a[56:59], v[36:39]
s_add_u32 s8, s8, 4096
ds_read_b128 a[124:127], v1 offset:15360
v_mfma_f32_16x16x32_bf16 v[36:39], a[92:95], a[60:63], v[36:39]
s_waitcnt lgkmcnt(4)
v_exp_f32 v11, v83
v_mfma_f32_16x16x32_bf16 v[40:43], a[96:99], a[0:3], v[16:19]
s_add_u32 m0, s18, 135168
ds_read_b128 a[64:67], v1 offset:16384
v_add_f32 v26, v26, v11
v_mfma_f32_16x16x32_bf16 v[40:43], a[100:103], a[4:7], v[40:43]
buffer_load_dwordx4 v1, s[4:7], s8 offen offset:0 sc1 lds
v_mfma_f32_16x16x32_bf16 v[40:43], a[104:107], a[8:11], v[40:43]
ds_read_b128 a[68:71], v1 offset:17408
v_cvt_pk_bf16_f32 v117, v10, v11
v_mfma_f32_16x16x32_bf16 v[40:43], a[108:111], a[12:15], v[40:43]
s_waitcnt lgkmcnt(4)
v_mfma_f32_16x16x32_bf16 v[40:43], a[112:115], a[16:19], v[40:43]
ds_read_b128 a[72:75], v1 offset:18432
v_mfma_f32_16x16x32_bf16 v[40:43], a[116:119], a[20:23], v[40:43]
s_waitcnt lgkmcnt(4)
buffer_load_dwordx4 v1, s[4:7], s8 offen offset:1024 sc1 lds
v_mfma_f32_16x16x32_bf16 v[40:43], a[120:123], a[24:27], v[40:43]
s_waitcnt lgkmcnt(3)
ds_read_b128 a[76:79], v1 offset:19456
v_mfma_f32_16x16x32_bf16 v[40:43], a[124:127], a[28:31], v[40:43]
v_exp_f32 v12, v84
v_mfma_f32_16x16x32_bf16 v[44:47], a[96:99], a[32:35], v[20:23]
ds_read_b128 a[80:83], v1 offset:20480
v_add_f32 v27, v27, v12
v_mfma_f32_16x16x32_bf16 v[44:47], a[100:103], a[36:39], v[44:47]
buffer_load_dwordx4 v1, s[4:7], s8 offen offset:2048 sc1 lds
v_mfma_f32_16x16x32_bf16 v[44:47], a[104:107], a[40:43], v[44:47]
ds_read_b128 a[84:87], v1 offset:21504
v_mfma_f32_16x16x32_bf16 v[44:47], a[108:111], a[44:47], v[44:47]
v_exp_f32 v13, v85
v_mfma_f32_16x16x32_bf16 v[44:47], a[112:115], a[48:51], v[44:47]
ds_read_b128 a[88:91], v1 offset:22528
v_add_f32 v27, v27, v13
v_mfma_f32_16x16x32_bf16 v[44:47], a[116:119], a[52:55], v[44:47]
s_waitcnt lgkmcnt(3)
buffer_load_dwordx4 v1, s[4:7], s8 offen offset:3072 sc1 lds
v_mfma_f32_16x16x32_bf16 v[44:47], a[120:123], a[56:59], v[44:47]
s_add_u32 s8, s8, 28672
ds_read_b128 a[92:95], v1 offset:23552
v_cvt_pk_bf16_f32 v124, v12, v13
v_mfma_f32_16x16x32_bf16 v[44:47], a[124:127], a[60:63], v[44:47]
s_sub_u32 s9, s9, 1
v_exp_f32 v14, v86
v_mfma_f32_16x16x32_bf16 v[48:51], a[64:67], a[0:3], v[16:19]
s_cmp_eq_u32 s9, 0
ds_read_b128 a[96:99], v1 offset:24576
v_add_f32 v27, v27, v14
v_mfma_f32_16x16x32_bf16 v[48:51], a[68:71], a[4:7], v[48:51]
s_cselect_b32 s8, s10, s8
v_exp_f32 v15, v87
v_mfma_f32_16x16x32_bf16 v[48:51], a[72:75], a[8:11], v[48:51]
s_cselect_b32 s9, s11, s9
ds_read_b128 a[100:103], v1 offset:25600
v_add_f32 v27, v27, v15
v_mfma_f32_16x16x32_bf16 v[48:51], a[76:79], a[12:15], v[48:51]
s_waitcnt lgkmcnt(4)
s_cselect_b32 s10, 3221225472, s10
v_cvt_pk_bf16_f32 v125, v14, v15
v_mfma_f32_16x16x32_bf16 v[48:51], a[80:83], a[16:19], v[48:51]
ds_read_b128 a[104:107], v1 offset:26624
v_mfma_f32_16x16x32_bf16 v[48:51], a[84:87], a[20:23], v[48:51]
s_waitcnt lgkmcnt(4)
v_exp_f32 v8, v88
v_mfma_f32_16x16x32_bf16 v[48:51], a[88:91], a[24:27], v[48:51]
s_waitcnt lgkmcnt(3)
ds_read_b128 a[108:111], v1 offset:27648
v_add_f32 v26, v26, v8
v_mfma_f32_16x16x32_bf16 v[48:51], a[92:95], a[28:31], v[48:51]
v_exp_f32 v9, v89
v_mfma_f32_16x16x32_bf16 v[52:55], a[64:67], a[32:35], v[20:23]
ds_read_b128 a[112:115], v1 offset:28672
v_add_f32 v26, v26, v9
v_mfma_f32_16x16x32_bf16 v[52:55], a[68:71], a[36:39], v[52:55]
v_exp_f32 v10, v90
v_mfma_f32_16x16x32_bf16 v[52:55], a[72:75], a[40:43], v[52:55]
ds_read_b128 a[116:119], v1 offset:29696
v_cvt_pk_bf16_f32 v118, v8, v9
v_mfma_f32_16x16x32_bf16 v[52:55], a[76:79], a[44:47], v[52:55]
v_exp_f32 v11, v91
v_mfma_f32_16x16x32_bf16 v[52:55], a[80:83], a[48:51], v[52:55]
ds_read_b128 a[120:123], v1 offset:30720
v_add_f32 v26, v26, v10
v_mfma_f32_16x16x32_bf16 v[52:55], a[84:87], a[52:55], v[52:55]
v_add_f32 v26, v26, v11
v_cvt_pk_bf16_f32 v119, v10, v11
v_mfma_f32_16x16x32_bf16 v[52:55], a[88:91], a[56:59], v[52:55]
s_waitcnt vmcnt(8) lgkmcnt(4)
ds_read_b128 a[124:127], v1 offset:31744
v_mfma_f32_16x16x32_bf16 v[52:55], a[92:95], a[60:63], v[52:55]
s_barrier
v_mfma_f32_16x16x32_bf16 v[56:59], a[96:99], a[0:3], v[16:19]
ds_read_b128 a[64:67], v2 offset:32768
v_mfma_f32_16x16x32_bf16 v[56:59], a[100:103], a[4:7], v[56:59]
v_exp_f32 v12, v92
v_mfma_f32_16x16x32_bf16 v[56:59], a[104:107], a[8:11], v[56:59]
s_waitcnt lgkmcnt(4)
ds_read_b128 a[68:71], v2 offset:33792
v_add_f32 v27, v27, v12
v_mfma_f32_16x16x32_bf16 v[56:59], a[108:111], a[12:15], v[56:59]
v_exp_f32 v13, v93
v_mfma_f32_16x16x32_bf16 v[56:59], a[112:115], a[16:19], v[56:59]
s_waitcnt lgkmcnt(4)
ds_read_b128 a[72:75], v2 offset:34816
v_add_f32 v27, v27, v13
v_mfma_f32_16x16x32_bf16 v[56:59], a[116:119], a[20:23], v[56:59]
s_waitcnt lgkmcnt(4)
v_exp_f32 v14, v94
v_mfma_f32_16x16x32_bf16 v[56:59], a[120:123], a[24:27], v[56:59]
s_waitcnt lgkmcnt(3)
ds_read_b128 a[76:79], v2 offset:35840
v_cvt_pk_bf16_f32 v126, v12, v13
v_mfma_f32_16x16x32_bf16 v[56:59], a[124:127], a[28:31], v[56:59]
v_exp_f32 v15, v95
v_mfma_f32_16x16x32_bf16 v[60:63], a[96:99], a[32:35], v[20:23]
ds_read_b128 a[80:83], v2 offset:36864
v_add_f32 v27, v27, v14
v_mfma_f32_16x16x32_bf16 v[60:63], a[100:103], a[36:39], v[60:63]
v_add_f32 v27, v27, v15
v_cvt_pk_bf16_f32 v127, v14, v15
v_mfma_f32_16x16x32_bf16 v[60:63], a[104:107], a[40:43], v[60:63]
ds_read_b128 a[84:87], v2 offset:37888
v_add_f32 v28, v26, v27
v_mfma_f32_16x16x32_bf16 v[60:63], a[108:111], a[44:47], v[60:63]
v_cmp_nge_f32 vcc, s25, v28
v_mfma_f32_16x16x32_bf16 v[60:63], a[112:115], a[48:51], v[60:63]
ds_read_b128 a[88:91], v2 offset:38912
v_mfma_f32_16x16x32_bf16 v[60:63], a[116:119], a[52:55], v[60:63]
v_mfma_f32_16x16x32_bf16 v[60:63], a[120:123], a[56:59], v[60:63]
ds_read_b128 a[92:95], v2 offset:39936
v_mfma_f32_16x16x32_bf16 v[60:63], a[124:127], a[60:63], v[60:63]
s_waitcnt lgkmcnt(4)
s_cbranch_vccnz Lstub_2
Lback_3:
v_mfma_f32_16x16x32_bf16 v[128:131], a[64:67], v[112:115], v[128:131]
s_add_u32 m0, s18, 65536
ds_read_b128 a[96:99], v2 offset:40960
v_add_f32 v24, v24, v26
v_mfma_f32_16x16x32_bf16 v[128:131], a[68:71], v[116:119], v[128:131]
buffer_load_dwordx4 v1, s[4:7], s12 offen offset:0 sc1 lds
v_mfma_f32_16x16x32_bf16 v[132:135], a[68:71], v[124:127], v[132:135]
ds_read_b128 a[100:103], v2 offset:41984
v_add_f32 v25, v25, v27
v_mfma_f32_16x16x32_bf16 v[132:135], a[64:67], v[120:123], v[132:135]
v_exp_f32 v8, v32
v_mfma_f32_16x16x32_bf16 v[136:139], a[72:75], v[112:115], v[136:139]
ds_read_b128 a[104:107], v2 offset:43008
v_mfma_f32_16x16x32_bf16 v[136:139], a[76:79], v[116:119], v[136:139]
buffer_load_dwordx4 v1, s[4:7], s12 offen offset:1024 sc1 lds
v_mfma_f32_16x16x32_bf16 v[140:143], a[76:79], v[124:127], v[140:143]
ds_read_b128 a[108:111], v2 offset:44032
v_mfma_f32_16x16x32_bf16 v[140:143], a[72:75], v[120:123], v[140:143]
s_waitcnt lgkmcnt(4)
v_exp_f32 v9, v33
v_mfma_f32_16x16x32_bf16 v[144:147], a[80:83], v[112:115], v[144:147]
ds_read_b128 a[112:115], v2 offset:45056
v_add_f32 v26, v8, v9
v_mfma_f32_16x16x32_bf16 v[144:147], a[84:87], v[116:119], v[144:147]
buffer_load_dwordx4 v1, s[4:7], s12 offen offset:2048 sc1 lds
v_mfma_f32_16x16x32_bf16 v[148:151], a[84:87], v[124:127], v[148:151]
ds_read_b128 a[116:119], v2 offset:46080
v_cvt_pk_bf16_f32 v96, v8, v9
v_mfma_f32_16x16x32_bf16 v[148:151], a[80:83], v[120:123], v[148:151]
v_exp_f32 v10, v34
v_mfma_f32_16x16x32_bf16 v[152:155], a[88:91], v[112:115], v[152:155]
ds_read_b128 a[120:123], v2 offset:47104
v_add_f32 v26, v26, v10
v_mfma_f32_16x16x32_bf16 v[152:155], a[92:95], v[116:119], v[152:155]
buffer_load_dwordx4 v1, s[4:7], s12 offen offset:3072 sc1 lds
v_mfma_f32_16x16x32_bf16 v[156:159], a[92:95], v[124:127], v[156:159]
s_add_u32 s12, s12, 4096
ds_read_b128 a[124:127], v2 offset:48128
v_mfma_f32_16x16x32_bf16 v[156:159], a[88:91], v[120:123], v[156:159]
s_waitcnt lgkmcnt(4)
v_exp_f32 v11, v35
v_mfma_f32_16x16x32_bf16 v[160:163], a[96:99], v[112:115], v[160:163]
s_add_u32 m0, s18, 69632
ds_read_b128 a[64:67], v2 offset:49152
v_add_f32 v26, v26, v11
v_mfma_f32_16x16x32_bf16 v[160:163], a[100:103], v[116:119], v[160:163]
buffer_load_dwordx4 v1, s[4:7], s12 offen offset:0 sc1 lds
v_mfma_f32_16x16x32_bf16 v[164:167], a[100:103], v[124:127], v[164:167]
ds_read_b128 a[68:71], v2 offset:50176
v_cvt_pk_bf16_f32 v97, v10, v11
v_mfma_f32_16x16x32_bf16 v[164:167], a[96:99], v[120:123], v[164:167]
v_mfma_f32_16x16x32_bf16 v[168:171], a[104:107], v[112:115], v[168:171]
ds_read_b128 a[72:75], v2 offset:51200
v_mfma_f32_16x16x32_bf16 v[168:171], a[108:111], v[116:119], v[168:171]
buffer_load_dwordx4 v1, s[4:7], s12 offen offset:1024 sc1 lds
v_mfma_f32_16x16x32_bf16 v[172:175], a[108:111], v[124:127], v[172:175]
ds_read_b128 a[76:79], v2 offset:52224
v_mfma_f32_16x16x32_bf16 v[172:175], a[104:107], v[120:123], v[172:175]
s_waitcnt lgkmcnt(4)
v_exp_f32 v12, v36
v_mfma_f32_16x16x32_bf16 v[176:179], a[112:115], v[112:115], v[176:179]
ds_read_b128 a[80:83], v2 offset:53248
v_mfma_f32_16x16x32_bf16 v[176:179], a[116:119], v[116:119], v[176:179]
buffer_load_dwordx4 v1, s[4:7], s12 offen offset:2048 sc1 lds
v_mfma_f32_16x16x32_bf16 v[180:183], a[116:119], v[124:127], v[180:183]
ds_read_b128 a[84:87], v2 offset:54272
v_mfma_f32_16x16x32_bf16 v[180:183], a[112:115], v[120:123], v[180:183]
v_exp_f32 v13, v37
v_mfma_f32_16x16x32_bf16 v[184:187], a[120:123], v[112:115], v[184:187]
ds_read_b128 a[88:91], v2 offset:55296
v_add_f32 v27, v12, v13
v_mfma_f32_16x16x32_bf16 v[184:187], a[124:127], v[116:119], v[184:187]
s_waitcnt lgkmcnt(4)
buffer_load_dwordx4 v1, s[4:7], s12 offen offset:3072 sc1 lds
v_mfma_f32_16x16x32_bf16 v[188:191], a[124:127], v[124:127], v[188:191]
s_add_u32 s12, s12, 28672
ds_read_b128 a[92:95], v2 offset:56320
v_cvt_pk_bf16_f32 v104, v12, v13
v_mfma_f32_16x16x32_bf16 v[188:191], a[120:123], v[120:123], v[188:191]
s_sub_u32 s13, s13, 1
v_exp_f32 v14, v38
v_mfma_f32_16x16x32_bf16 v[192:195], a[64:67], v[112:115], v[192:195]
s_cmp_eq_u32 s13, 0
ds_read_b128 a[96:99], v2 offset:57344
v_add_f32 v27, v27, v14
v_mfma_f32_16x16x32_bf16 v[192:195], a[68:71], v[116:119], v[192:195]
s_cselect_b32 s12, s14, s12
v_mfma_f32_16x16x32_bf16 v[196:199], a[68:71], v[124:127], v[196:199]
s_cselect_b32 s13, s15, s13
ds_read_b128 a[100:103], v2 offset:58368
v_mfma_f32_16x16x32_bf16 v[196:199], a[64:67], v[120:123], v[196:199]
s_cselect_b32 s14, 3221225472, s14
v_exp_f32 v15, v39
v_mfma_f32_16x16x32_bf16 v[200:203], a[72:75], v[112:115], v[200:203]
s_waitcnt lgkmcnt(4)
ds_read_b128 a[104:107], v2 offset:59392
v_add_f32 v27, v27, v15
v_mfma_f32_16x16x32_bf16 v[200:203], a[76:79], v[116:119], v[200:203]
v_exp_f32 v8, v40
v_mfma_f32_16x16x32_bf16 v[204:207], a[76:79], v[124:127], v[204:207]
ds_read_b128 a[108:111], v2 offset:60416
v_cvt_pk_bf16_f32 v105, v14, v15
v_mfma_f32_16x16x32_bf16 v[204:207], a[72:75], v[120:123], v[204:207]
v_exp_f32 v9, v41
v_mfma_f32_16x16x32_bf16 v[208:211], a[80:83], v[112:115], v[208:211]
ds_read_b128 a[112:115], v2 offset:61440
v_add_f32 v26, v26, v8
v_mfma_f32_16x16x32_bf16 v[208:211], a[84:87], v[116:119], v[208:211]
v_add_f32 v26, v26, v9
v_cvt_pk_bf16_f32 v98, v8, v9
v_mfma_f32_16x16x32_bf16 v[212:215], a[84:87], v[124:127], v[212:215]
ds_read_b128 a[116:119], v2 offset:62464
v_mfma_f32_16x16x32_bf16 v[212:215], a[80:83], v[120:123], v[212:215]
s_waitcnt lgkmcnt(4)
v_exp_f32 v10, v42
v_mfma_f32_16x16x32_bf16 v[216:219], a[88:91], v[112:115], v[216:219]
ds_read_b128 a[120:123], v2 offset:63488
v_add_f32 v26, v26, v10
v_mfma_f32_16x16x32_bf16 v[216:219], a[92:95], v[116:119], v[216:219]
v_exp_f32 v11, v43
v_mfma_f32_16x16x32_bf16 v[220:223], a[92:95], v[124:127], v[220:223]
s_waitcnt vmcnt(8)
ds_read_b128 a[124:127], v2 offset:64512
v_add_f32 v26, v26, v11
v_mfma_f32_16x16x32_bf16 v[220:223], a[88:91], v[120:123], v[220:223]
s_barrier
v_mfma_f32_16x16x32_bf16 v[224:227], a[96:99], v[112:115], v[224:227]
ds_read_b128 a[64:67], v4 offset:0
v_cvt_pk_bf16_f32 v99, v10, v11
v_mfma_f32_16x16x32_bf16 v[224:227], a[100:103], v[116:119], v[224:227]
v_exp_f32 v12, v44
v_mfma_f32_16x16x32_bf16 v[228:231], a[100:103], v[124:127], v[228:231]
ds_read_b128 a[68:71], v4 offset:1024
v_add_f32 v27, v27, v12
v_mfma_f32_16x16x32_bf16 v[228:231], a[96:99], v[120:123], v[228:231]
s_waitcnt lgkmcnt(4)
v_mfma_f32_16x16x32_bf16 v[232:235], a[104:107], v[112:115], v[232:235]
ds_read_b128 a[72:75], v4 offset:2048
v_mfma_f32_16x16x32_bf16 v[232:235], a[108:111], v[116:119], v[232:235]
v_exp_f32 v13, v45
v_mfma_f32_16x16x32_bf16 v[236:239], a[108:111], v[124:127], v[236:239]
ds_read_b128 a[76:79], v4 offset:3072
v_add_f32 v27, v27, v13
v_mfma_f32_16x16x32_bf16 v[236:239], a[104:107], v[120:123], v[236:239]
v_exp_f32 v14, v46
v_mfma_f32_16x16x32_bf16 v[240:243], a[112:115], v[112:115], v[240:243]
ds_read_b128 a[80:83], v4 offset:4096
v_cvt_pk_bf16_f32 v106, v12, v13
v_mfma_f32_16x16x32_bf16 v[240:243], a[116:119], v[116:119], v[240:243]
v_exp_f32 v15, v47
v_mfma_f32_16x16x32_bf16 v[244:247], a[116:119], v[124:127], v[244:247]
ds_read_b128 a[84:87], v4 offset:5120
v_add_f32 v27, v27, v14
v_mfma_f32_16x16x32_bf16 v[244:247], a[112:115], v[120:123], v[244:247]
s_waitcnt lgkmcnt(4)
v_add_f32 v27, v27, v15
v_cvt_pk_bf16_f32 v107, v14, v15
v_mfma_f32_16x16x32_bf16 v[248:251], a[120:123], v[112:115], v[248:251]
ds_read_b128 a[88:91], v4 offset:6144
v_mfma_f32_16x16x32_bf16 v[248:251], a[124:127], v[116:119], v[248:251]
v_mfma_f32_16x16x32_bf16 v[252:255], a[124:127], v[124:127], v[252:255]
s_waitcnt lgkmcnt(5)
ds_read_b128 a[92:95], v4 offset:7168
v_mfma_f32_16x16x32_bf16 v[252:255], a[120:123], v[120:123], v[252:255]
s_branch K2_x1
K2_xexit:
s_cbranch_vccnz Lstub_4
Lback_5:
s_cmp_lg_u32 s19, 0
s_cbranch_scc1 K2_loop
s_cmp_eq_u32 s24, 2
s_cbranch_scc1 K2_ntail
v_mfma_f32_16x16x32_bf16 v[128:131], a[64:67], v[96:99], v[128:131]
s_add_u32 m0, s18, 98304
ds_read_b128 a[96:99], v2 offset:8192
v_add_f32 v24, v24, v26
v_mfma_f32_16x16x32_bf16 v[128:131], a[68:71], v[100:103], v[128:131]
buffer_load_dwordx4 v1, s[4:7], s12 offen offset:0 sc1 lds
v_mfma_f32_16x16x32_bf16 v[132:135], a[68:71], v[108:111], v[132:135]
ds_read_b128 a[100:103], v2 offset:9216
v_add_f32 v25, v25, v27
v_mfma_f32_16x16x32_bf16 v[132:135], a[64:67], v[104:107], v[132:135]
v_exp_f32 v8, v64
v_mfma_f32_16x16x32_bf16 v[136:139], a[72:75], v[96:99], v[136:139]
ds_read_b128 a[104:107], v2 offset:10240
v_mfma_f32_16x16x32_bf16 v[136:139], a[76:79], v[100:103], v[136:139]
buffer_load_dwordx4 v1, s[4:7], s12 offen offset:1024 sc1 lds
v_mfma_f32_16x16x32_bf16 v[140:143], a[76:79], v[108:111], v[140:143]
ds_read_b128 a[108:111], v2 offset:11264
v_mfma_f32_16x16x32_bf16 v[140:143], a[72:75], v[104:107], v[140:143]
s_waitcnt lgkmcnt(4)
v_exp_f32 v9, v65
v_mfma_f32_16x16x32_bf16 v[144:147], a[80:83], v[96:99], v[144:147]
ds_read_b128 a[112:115], v2 offset:12288
v_add_f32 v26, v8, v9
v_mfma_f32_16x16x32_bf16 v[144:147], a[84:87], v[100:103], v[144:147]
buffer_load_dwordx4 v1, s[4:7], s12 offen offset:2048 sc1 lds
v_mfma_f32_16x16x32_bf16 v[148:151], a[84:87], v[108:111], v[148:151]
ds_read_b128 a[116:119], v2 offset:13312
v_cvt_pk_bf16_f32 v112, v8, v9
v_mfma_f32_16x16x32_bf16 v[148:151], a[80:83], v[104:107], v[148:151]
v_exp_f32 v10, v66
v_mfma_f32_16x16x32_bf16 v[152:155], a[88:91], v[96:99], v[152:155]
ds_read_b128 a[120:123], v2 offset:14336
v_add_f32 v26, v26, v10
v_mfma_f32_16x16x32_bf16 v[152:155], a[92:95], v[100:103], v[152:155]
buffer_load_dwordx4 v1, s[4:7], s12 offen offset:3072 sc1 lds
v_mfma_f32_16x16x32_bf16 v[156:159], a[92:95], v[108:111], v[156:159]
s_add_u32 s12, s12, 4096
ds_read_b128 a[124:127], v2 offset:15360
v_mfma_f32_16x16x32_bf16 v[156:159], a[88:91], v[104:107], v[156:159]
s_waitcnt lgkmcnt(4)
v_exp_f32 v11, v67
v_mfma_f32_16x16x32_bf16 v[160:163], a[96:99], v[96:99], v[160:163]
s_add_u32 m0, s18, 102400
ds_read_b128 a[64:67], v2 offset:16384
v_add_f32 v26, v26, v11
v_mfma_f32_16x16x32_bf16 v[160:163], a[100:103], v[100:103], v[160:163]
buffer_load_dwordx4 v1, s[4:7], s12 offen offset:0 sc1 lds
v_mfma_f32_16x16x32_bf16 v[164:167], a[100:103], v[108:111], v[164:167]
ds_read_b128 a[68:71], v2 offset:17408
v_cvt_pk_bf16_f32 v113, v10, v11
v_mfma_f32_16x16x32_bf16 v[164:167], a[96:99], v[104:107], v[164:167]
v_mfma_f32_16x16x32_bf16 v[168:171], a[104:107], v[96:99], v[168:171]
ds_read_b128 a[72:75], v2 offset:18432
v_mfma_f32_16x16x32_bf16 v[168:171], a[108:111], v[100:103], v[168:171]
buffer_load_dwordx4 v1, s[4:7], s12 offen offset:1024 sc1 lds
v_mfma_f32_16x16x32_bf16 v[172:175], a[108:111], v[108:111], v[172:175]
ds_read_b128 a[76:79], v2 offset:19456
v_mfma_f32_16x16x32_bf16 v[172:175], a[104:107], v[104:107], v[172:175]
s_waitcnt lgkmcnt(4)
v_exp_f32 v12, v68
v_mfma_f32_16x16x32_bf16 v[176:179], a[112:115], v[96:99], v[176:179]
ds_read_b128 a[80:83], v2 offset:20480
v_mfma_f32_16x16x32_bf16 v[176:179], a[116:119], v[100:103], v[176:179]
buffer_load_dwordx4 v1, s[4:7], s12 offen offset:2048 sc1 lds
v_mfma_f32_16x16x32_bf16 v[180:183], a[116:119], v[108:111], v[180:183]
ds_read_b128 a[84:87], v2 offset:21504
v_mfma_f32_16x16x32_bf16 v[180:183], a[112:115], v[104:107], v[180:183]
v_exp_f32 v13, v69
v_mfma_f32_16x16x32_bf16 v[184:187], a[120:123], v[96:99], v[184:187]
ds_read_b128 a[88:91], v2 offset:22528
v_add_f32 v27, v12, v13
v_mfma_f32_16x16x32_bf16 v[184:187], a[124:127], v[100:103], v[184:187]
s_waitcnt lgkmcnt(4)
buffer_load_dwordx4 v1, s[4:7], s12 offen offset:3072 sc1 lds
v_mfma_f32_16x16x32_bf16 v[188:191], a[124:127], v[108:111], v[188:191]
s_add_u32 s12, s12, 28672
ds_read_b128 a[92:95], v2 offset:23552
v_cvt_pk_bf16_f32 v120, v12, v13
v_mfma_f32_16x16x32_bf16 v[188:191], a[120:123], v[104:107], v[188:191]
s_sub_u32 s13, s13, 1
v_exp_f32 v14, v70
v_mfma_f32_16x16x32_bf16 v[192:195], a[64:67], v[96:99], v[192:195]
s_cmp_eq_u32 s13, 0
ds_read_b128 a[96:99], v2 offset:24576
v_add_f32 v27, v27, v14
v_mfma_f32_16x16x32_bf16 v[192:195], a[68:71], v[100:103], v[192:195]
s_cselect_b32 s12, s14, s12
v_mfma_f32_16x16x32_bf16 v[196:199], a[68:71], v[108:111], v[196:199]
s_cselect_b32 s13, s15, s13
ds_read_b128 a[100:103], v2 offset:25600
v_mfma_f32_16x16x32_bf16 v[196:199], a[64:67], v[104:107], v[196:199]
s_cselect_b32 s14, 3221225472, s14
v_exp_f32 v15, v71
v_mfma_f32_16x16x32_bf16 v[200:203], a[72:75], v[96:99], v[200:203]
s_waitcnt lgkmcnt(4)
ds_read_b128 a[104:107], v2 offset:26624
v_add_f32 v27, v27, v15
v_mfma_f32_16x16x32_bf16 v[200:203], a[76:79], v[100:103], v[200:203]
v_exp_f32 v8, v72
v_mfma_f32_16x16x32_bf16 v[204:207], a[76:79], v[108:111], v[204:207]
ds_read_b128 a[108:111], v2 offset:27648
v_cvt_pk_bf16_f32 v121, v14, v15
v_mfma_f32_16x16x32_bf16 v[204:207], a[72:75], v[104:107], v[204:207]
v_exp_f32 v9, v73
v_mfma_f32_16x16x32_bf16 v[208:211], a[80:83], v[96:99], v[208:211]
ds_read_b128 a[112:115], v2 offset:28672
v_add_f32 v26, v26, v8
v_mfma_f32_16x16x32_bf16 v[208:211], a[84:87], v[100:103], v[208:211]
v_add_f32 v26, v26, v9
v_cvt_pk_bf16_f32 v114, v8, v9
v_mfma_f32_16x16x32_bf16 v[212:215], a[84:87], v[108:111], v[212:215]
ds_read_b128 a[116:119], v2 offset:29696
v_mfma_f32_16x16x32_bf16 v[212:215], a[80:83], v[104:107], v[212:215]
s_waitcnt lgkmcnt(4)
v_exp_f32 v10, v74
v_mfma_f32_16x16x32_bf16 v[216:219], a[88:91], v[96:99], v[216:219]
ds_read_b128 a[120:123], v2 offset:30720
v_add_f32 v26, v26, v10
v_mfma_f32_16x16x32_bf16 v[216:219], a[92:95], v[100:103], v[216:219]
v_exp_f32 v11, v75
v_mfma_f32_16x16x32_bf16 v[220:223], a[92:95], v[108:111], v[220:223]
s_waitcnt vmcnt(8)
ds_read_b128 a[124:127], v2 offset:31744
v_add_f32 v26, v26, v11
v_mfma_f32_16x16x32_bf16 v[220:223], a[88:91], v[104:107], v[220:223]
PAD_11:
s_cbranch_execz M_tret
s_barrier
v_mfma_f32_16x16x32_bf16 v[224:227], a[96:99], v[96:99], v[224:227]
ds_read_b128 a[64:67], v1 offset:0
v_cvt_pk_bf16_f32 v115, v10, v11
v_mfma_f32_16x16x32_bf16 v[224:227], a[100:103], v[100:103], v[224:227]
v_exp_f32 v12, v76
v_mfma_f32_16x16x32_bf16 v[228:231], a[100:103], v[108:111], v[228:231]
ds_read_b128 a[68:71], v1 offset:1024
v_add_f32 v27, v27, v12
v_mfma_f32_16x16x32_bf16 v[228:231], a[96:99], v[104:107], v[228:231]
s_waitcnt lgkmcnt(4)
v_mfma_f32_16x16x32_bf16 v[232:235], a[104:107], v[96:99], v[232:235]
ds_read_b128 a[72:75], v1 offset:2048
v_mfma_f32_16x16x32_bf16 v[232:235], a[108:111], v[100:103], v[232:235]
v_exp_f32 v13, v77
v_mfma_f32_16x16x32_bf16 v[236:239], a[108:111], v[108:111], v[236:239]
ds_read_b128 a[76:79], v1 offset:3072
v_add_f32 v27, v27, v13
v_mfma_f32_16x16x32_bf16 v[236:239], a[104:107], v[104:107], v[236:239]
v_exp_f32 v14, v78
v_mfma_f32_16x16x32_bf16 v[240:243], a[112:115], v[96:99], v[240:243]
ds_read_b128 a[80:83], v1 offset:4096
v_cvt_pk_bf16_f32 v122, v12, v13
v_mfma_f32_16x16x32_bf16 v[240:243], a[116:119], v[100:103], v[240:243]
v_exp_f32 v15, v79
v_mfma_f32_16x16x32_bf16 v[244:247], a[116:119], v[108:111], v[244:247]
ds_read_b128 a[84:87], v1 offset:5120
v_add_f32 v27, v27, v14
v_mfma_f32_16x16x32_bf16 v[244:247], a[112:115], v[104:107], v[244:247]
s_waitcnt lgkmcnt(4)
v_add_f32 v27, v27, v15
v_cvt_pk_bf16_f32 v123, v14, v15
v_mfma_f32_16x16x32_bf16 v[248:251], a[120:123], v[96:99], v[248:251]
ds_read_b128 a[88:91], v1 offset:6144
v_mfma_f32_16x16x32_bf16 v[248:251], a[124:127], v[100:103], v[248:251]
v_mfma_f32_16x16x32_bf16 v[252:255], a[124:127], v[108:111], v[252:255]
ds_read_b128 a[92:95], v1 offset:7168
v_mfma_f32_16x16x32_bf16 v[252:255], a[120:123], v[104:107], v[252:255]
v_cndmask_b32 v32, v16, v7, s[32:33]
v_cndmask_b32 v33, v16, v7, s[34:35]
v_cndmask_b32 v34, v16, v7, s[36:37]
v_cndmask_b32 v35, v16, v7, s[38:39]
s_nop 1
v_mfma_f32_16x16x32_bf16 v[32:35], a[64:67], a[0:3], v[32:35]
s_add_u32 m0, s18, 131072
ds_read_b128 a[96:99], v1 offset:8192
v_cndmask_b32 v40, v16, v7, s[40:41]
v_mfma_f32_16x16x32_bf16 v[32:35], a[68:71], a[4:7], v[32:35]
s_waitcnt lgkmcnt(4)
buffer_load_dwordx4 v1, s[4:7], s8 offen offset:0 sc1 lds
v_mfma_f32_16x16x32_bf16 v[32:35], a[72:75], a[8:11], v[32:35]
ds_read_b128 a[100:103], v1 offset:9216
v_cndmask_b32 v41, v16, v7, s[42:43]
v_mfma_f32_16x16x32_bf16 v[32:35], a[76:79], a[12:15], v[32:35]
v_cndmask_b32 v42, v16, v7, s[44:45]
v_cndmask_b32 v43, v16, v7, s[46:47]
v_mfma_f32_16x16x32_bf16 v[32:35], a[80:83], a[16:19], v[32:35]
s_waitcnt lgkmcnt(4)
ds_read_b128 a[104:107], v1 offset:10240
v_mfma_f32_16x16x32_bf16 v[32:35], a[84:87], a[20:23], v[32:35]
s_waitcnt lgkmcnt(4)
buffer_load_dwordx4 v1, s[4:7], s8 offen offset:1024 sc1 lds
v_mfma_f32_16x16x32_bf16 v[32:35], a[88:91], a[24:27], v[32:35]
s_waitcnt lgkmcnt(3)
ds_read_b128 a[108:111], v1 offset:11264
v_mfma_f32_16x16x32_bf16 v[32:35], a[92:95], a[28:31], v[32:35]
v_exp_f32 v8, v80
v_mfma_f32_16x16x32_bf16 v[36:39], a[64:67], a[32:35], v[20:23]
ds_read_b128 a[112:115], v1 offset:12288
v_add_f32 v26, v26, v8
v_mfma_f32_16x16x32_bf16 v[36:39], a[68:71], a[36:39], v[36:39]
buffer_load_dwordx4 v1, s[4:7], s8 offen offset:2048 sc1 lds
v_mfma_f32_16x16x32_bf16 v[36:39], a[72:75], a[40:43], v[36:39]
ds_read_b128 a[116:119], v1 offset:13312
v_mfma_f32_16x16x32_bf16 v[36:39], a[76:79], a[44:47], v[36:39]
v_exp_f32 v9, v81
v_mfma_f32_16x16x32_bf16 v[36:39], a[80:83], a[48:51], v[36:39]
ds_read_b128 a[120:123], v1 offset:14336
v_add_f32 v26, v26, v9
v_mfma_f32_16x16x32_bf16 v[36:39], a[84:87], a[52:55], v[36:39]
buffer_load_dwordx4 v1, s[4:7], s8 offen offset:3072 sc1 lds
v_mfma_f32_16x16x32_bf16 v[36:39], a[88:91], a[56:59], v[36:39]
s_add_u32 s8, s8, 4096
ds_read_b128 a[124:127], v1 offset:15360
v_cvt_pk_bf16_f32 v116, v8, v9
v_mfma_f32_16x16x32_bf16 v[36:39], a[92:95], a[60:63], v[36:39]
s_waitcnt lgkmcnt(4)
v_exp_f32 v10, v82
v_mfma_f32_16x16x32_bf16 v[40:43], a[96:99], a[0:3], v[40:43]
s_add_u32 m0, s18, 135168
ds_read_b128 a[64:67], v1 offset:16384
v_cndmask_b32 v48, v16, v7, s[48:49]
v_mfma_f32_16x16x32_bf16 v[40:43], a[100:103], a[4:7], v[40:43]
buffer_load_dwordx4 v1, s[4:7], s8 offen offset:0 sc1 lds
v_mfma_f32_16x16x32_bf16 v[40:43], a[104:107], a[8:11], v[40:43]
ds_read_b128 a[68:71], v1 offset:17408
v_cndmask_b32 v49, v16, v7, s[50:51]
v_mfma_f32_16x16x32_bf16 v[40:43], a[108:111], a[12:15], v[40:43]
s_waitcnt lgkmcnt(4)
v_cndmask_b32 v50, v16, v7, s[52:53]
v_cndmask_b32 v51, v16, v7, s[54:55]
v_mfma_f32_16x16x32_bf16 v[40:43], a[112:115], a[16:19], v[40:43]
ds_read_b128 a[72:75], v1 offset:18432
v_add_f32 v26, v26, v10
v_mfma_f32_16x16x32_bf16 v[40:43], a[116:119], a[20:23], v[40:43]
s_waitcnt lgkmcnt(4)
buffer_load_dwordx4 v1, s[4:7], s8 offen offset:1024 sc1 lds
v_mfma_f32_16x16x32_bf16 v[40:43], a[120:123], a[24:27], v[40:43]
s_waitcnt lgkmcnt(3)
ds_read_b128 a[76:79], v1 offset:19456
v_mfma_f32_16x16x32_bf16 v[40:43], a[124:127], a[28:31], v[40:43]
v_exp_f32 v11, v83
v_mfma_f32_16x16x32_bf16 v[44:47], a[96:99], a[32:35], v[20:23]
ds_read_b128 a[80:83], v1 offset:20480
v_add_f32 v26, v26, v11
v_mfma_f32_16x16x32_bf16 v[44:47], a[100:103], a[36:39], v[44:47]
buffer_load_dwordx4 v1, s[4:7], s8 offen offset:2048 sc1 lds
v_mfma_f32_16x16x32_bf16 v[44:47], a[104:107], a[40:43], v[44:47]
ds_read_b128 a[84:87], v1 offset:21504
v_cvt_pk_bf16_f32 v117, v10, v11
v_mfma_f32_16x16x32_bf16 v[44:47], a[108:111], a[44:47], v[44:47]
v_exp_f32 v12, v84
v_mfma_f32_16x16x32_bf16 v[44:47], a[112:115], a[48:51], v[44:47]
ds_read_b128 a[88:91], v1 offset:22528
v_add_f32 v27, v27, v12
v_mfma_f32_16x16x32_bf16 v[44:47], a[116:119], a[52:55], v[44:47]
buffer_load_dwordx4 v1, s[4:7], s8 offen offset:3072 sc1 lds
v_mfma_f32_16x16x32_bf16 v[44:47], a[120:123], a[56:59], v[44:47]
s_waitcnt lgkmcnt(2)
s_add_u32 s8, s8, 28672
ds_read_b128 a[92:95], v1 offset:23552
v_mfma_f32_16x16x32_bf16 v[44:47], a[124:127], a[60:63], v[44:47]
s_sub_u32 s9, s9, 1
v_exp_f32 v13, v85
v_mfma_f32_16x16x32_bf16 v[48:51], a[64:67], a[0:3], v[48:51]
s_cmp_eq_u32 s9, 0
ds_read_b128 a[96:99], v1 offset:24576
v_cndmask_b32 v56, v16, v7, s[56:57]
v_mfma_f32_16x16x32_bf16 v[48:51], a[68:71], a[4:7], v[48:51]
s_cselect_b32 s8, s10, s8
v_cndmask_b32 v57, v16, v7, s[58:59]
v_cndmask_b32 v58, v16, v7, s[60:61]
v_mfma_f32_16x16x32_bf16 v[48:51], a[72:75], a[8:11], v[48:51]
s_cselect_b32 s9, s11, s9
ds_read_b128 a[100:103], v1 offset:25600
v_cndmask_b32 v59, v16, v7, s[62:63]
v_mfma_f32_16x16x32_bf16 v[48:51], a[76:79], a[12:15], v[48:51]
s_cselect_b32 s10, 3221225472, s10
v_exp_f32 v14, v86
v_mfma_f32_16x16x32_bf16 v[48:51], a[80:83], a[16:19], v[48:51]
s_waitcnt lgkmcnt(4)
ds_read_b128 a[104:107], v1 offset:26624
v_add_f32 v27, v27, v13
v_cvt_pk_bf16_f32 v124, v12, v13
v_mfma_f32_16x16x32_bf16 v[48:51], a[84:87], a[20:23], v[48:51]
s_waitcnt lgkmcnt(4)
v_exp_f32 v15, v87
v_mfma_f32_16x16x32_bf16 v[48:51], a[88:91], a[24:27], v[48:51]
s_waitcnt lgkmcnt(3)
ds_read_b128 a[108:111], v1 offset:27648
v_add_f32 v27, v27, v14
v_mfma_f32_16x16x32_bf16 v[48:51], a[92:95], a[28:31], v[48:51]
v_exp_f32 v8, v88
v_mfma_f32_16x16x32_bf16 v[52:55], a[64:67], a[32:35], v[20:23]
ds_read_b128 a[112:115], v1 offset:28672
v_add_f32 v27, v27, v15
v_mfma_f32_16x16x32_bf16 v[52:55], a[68:71], a[36:39], v[52:55]
v_exp_f32 v9, v89
v_mfma_f32_16x16x32_bf16 v[52:55], a[72:75], a[40:43], v[52:55]
ds_read_b128 a[116:119], v1 offset:29696
v_cvt_pk_bf16_f32 v125, v14, v15
v_mfma_f32_16x16x32_bf16 v[52:55], a[76:79], a[44:47], v[52:55]
v_exp_f32 v10, v90
v_mfma_f32_16x16x32_bf16 v[52:55], a[80:83], a[48:51], v[52:55]
ds_read_b128 a[120:123], v1 offset:30720
v_add_f32 v26, v26, v8
v_mfma_f32_16x16x32_bf16 v[52:55], a[84:87], a[52:55], v[52:55]
v_exp_f32 v11, v91
v_mfma_f32_16x16x32_bf16 v[52:55], a[88:91], a[56:59], v[52:55]
s_waitcnt vmcnt(8) lgkmcnt(4)
ds_read_b128 a[124:127], v1 offset:31744
v_add_f32 v26, v26, v9
v_cvt_pk_bf16_f32 v118, v8, v9
v_mfma_f32_16x16x32_bf16 v[52:55], a[92:95], a[60:63], v[52:55]
s_barrier
v_mfma_f32_16x16x32_bf16 v[56:59], a[96:99], a[0:3], v[56:59]
ds_read_b128 a[64:67], v2 offset:32768
v_add_f32 v26, v26, v10
v_mfma_f32_16x16x32_bf16 v[56:59], a[100:103], a[4:7], v[56:59]
v_exp_f32 v12, v92
v_mfma_f32_16x16x32_bf16 v[56:59], a[104:107], a[8:11], v[56:59]
s_waitcnt lgkmcnt(4)
ds_read_b128 a[68:71], v2 offset:33792
v_add_f32 v26, v26, v11
v_cvt_pk_bf16_f32 v119, v10, v11
v_mfma_f32_16x16x32_bf16 v[56:59], a[108:111], a[12:15], v[56:59]
v_exp_f32 v13, v93
v_mfma_f32_16x16x32_bf16 v[56:59], a[112:115], a[16:19], v[56:59]
s_waitcnt lgkmcnt(4)
ds_read_b128 a[72:75], v2 offset:34816
v_add_f32 v27, v27, v12
v_mfma_f32_16x16x32_bf16 v[56:59], a[116:119], a[20:23], v[56:59]
s_waitcnt lgkmcnt(4)
v_exp_f32 v14, v94
v_mfma_f32_16x16x32_bf16 v[56:59], a[120:123], a[24:27], v[56:59]
s_waitcnt lgkmcnt(3)
ds_read_b128 a[76:79], v2 offset:35840
v_add_f32 v27, v27, v13
v_mfma_f32_16x16x32_bf16 v[56:59], a[124:127], a[28:31], v[56:59]
v_exp_f32 v15, v95
v_mfma_f32_16x16x32_bf16 v[60:63], a[96:99], a[32:35], v[20:23]
ds_read_b128 a[80:83], v2 offset:36864
v_cvt_pk_bf16_f32 v126, v12, v13
v_mfma_f32_16x16x32_bf16 v[60:63], a[100:103], a[36:39], v[60:63]
v_add_f32 v27, v27, v14
v_add_f32 v27, v27, v15
v_mfma_f32_16x16x32_bf16 v[60:63], a[104:107], a[40:43], v[60:63]
ds_read_b128 a[84:87], v2 offset:37888
v_cvt_pk_bf16_f32 v127, v14, v15
v_mfma_f32_16x16x32_bf16 v[60:63], a[108:111], a[44:47], v[60:63]
v_add_f32 v28, v26, v27
v_cmp_nge_f32 vcc, s25, v28
v_mfma_f32_16x16x32_bf16 v[60:63], a[112:115], a[48:51], v[60:63]
ds_read_b128 a[88:91], v2 offset:38912
v_mfma_f32_16x16x32_bf16 v[60:63], a[116:119], a[52:55], v[60:63]
v_mfma_f32_16x16x32_bf16 v[60:63], a[120:123], a[56:59], v[60:63]
ds_read_b128 a[92:95], v2 offset:39936
v_mfma_f32_16x16x32_bf16 v[60:63], a[124:127], a[60:63], v[60:63]
s_waitcnt lgkmcnt(4)
s_cbranch_vccnz Lstub_6
Lback_7:
v_mfma_f32_16x16x32_bf16 v[128:131], a[64:67], v[112:115], v[128:131]
s_add_u32 m0, s18, 65536
ds_read_b128 a[96:99], v2 offset:40960
v_add_f32 v24, v24, v26
v_mfma_f32_16x16x32_bf16 v[128:131], a[68:71], v[116:119], v[128:131]
buffer_load_dwordx4 v1, s[4:7], s12 offen offset:0 sc1 lds
v_mfma_f32_16x16x32_bf16 v[132:135], a[68:71], v[124:127], v[132:135]
ds_read_b128 a[100:103], v2 offset:41984
v_add_f32 v25, v25, v27
v_mfma_f32_16x16x32_bf16 v[132:135], a[64:67], v[120:123], v[132:135]
v_exp_f32 v8, v32
v_mfma_f32_16x16x32_bf16 v[136:139], a[72:75], v[112:115], v[136:139]
ds_read_b128 a[104:107], v2 offset:43008
v_mfma_f32_16x16x32_bf16 v[136:139], a[76:79], v[116:119], v[136:139]
buffer_load_dwordx4 v1, s[4:7], s12 offen offset:1024 sc1 lds
v_mfma_f32_16x16x32_bf16 v[140:143], a[76:79], v[124:127], v[140:143]
ds_read_b128 a[108:111], v2 offset:44032
v_mfma_f32_16x16x32_bf16 v[140:143], a[72:75], v[120:123], v[140:143]
s_waitcnt lgkmcnt(4)
v_exp_f32 v9, v33
v_mfma_f32_16x16x32_bf16 v[144:147], a[80:83], v[112:115], v[144:147]
ds_read_b128 a[112:115], v2 offset:45056
v_add_f32 v26, v8, v9
v_mfma_f32_16x16x32_bf16 v[144:147], a[84:87], v[116:119], v[144:147]
buffer_load_dwordx4 v1, s[4:7], s12 offen offset:2048 sc1 lds
v_mfma_f32_16x16x32_bf16 v[148:151], a[84:87], v[124:127], v[148:151]
ds_read_b128 a[116:119], v2 offset:46080
v_cvt_pk_bf16_f32 v96, v8, v9
v_mfma_f32_16x16x32_bf16 v[148:151], a[80:83], v[120:123], v[148:151]
v_exp_f32 v10, v34
v_mfma_f32_16x16x32_bf16 v[152:155], a[88:91], v[112:115], v[152:155]
ds_read_b128 a[120:123], v2 offset:47104
v_add_f32 v26, v26, v10
v_mfma_f32_16x16x32_bf16 v[152:155], a[92:95], v[116:119], v[152:155]
buffer_load_dwordx4 v1, s[4:7], s12 offen offset:3072 sc1 lds
v_mfma_f32_16x16x32_bf16 v[156:159], a[92:95], v[124:127], v[156:159]
s_add_u32 s12, s12, 4096
ds_read_b128 a[124:127], v2 offset:48128
v_mfma_f32_16x16x32_bf16 v[156:159], a[88:91], v[120:123], v[156:159]
s_waitcnt lgkmcnt(4)
v_exp_f32 v11, v35
v_mfma_f32_16x16x32_bf16 v[160:163], a[96:99], v[112:115], v[160:163]
s_add_u32 m0, s18, 69632
ds_read_b128 a[64:67], v2 offset:49152
v_add_f32 v26, v26, v11
v_mfma_f32_16x16x32_bf16 v[160:163], a[100:103], v[116:119], v[160:163]
buffer_load_dwordx4 v1, s[4:7], s12 offen offset:0 sc1 lds
v_mfma_f32_16x16x32_bf16 v[164:167], a[100:103], v[124:127], v[164:167]
ds_read_b128 a[68:71], v2 offset:50176
v_cvt_pk_bf16_f32 v97, v10, v11
v_mfma_f32_16x16x32_bf16 v[164:167], a[96:99], v[120:123], v[164:167]
v_mfma_f32_16x16x32_bf16 v[168:171], a[104:107], v[112:115], v[168:171]
ds_read_b128 a[72:75], v2 offset:51200
v_mfma_f32_16x16x32_bf16 v[168:171], a[108:111], v[116:119], v[168:171]
buffer_load_dwordx4 v1, s[4:7], s12 offen offset:1024 sc1 lds
v_mfma_f32_16x16x32_bf16 v[172:175], a[108:111], v[124:127], v[172:175]
ds_read_b128 a[76:79], v2 offset:52224
v_mfma_f32_16x16x32_bf16 v[172:175], a[104:107], v[120:123], v[172:175]
s_waitcnt lgkmcnt(4)
v_exp_f32 v12, v36
v_mfma_f32_16x16x32_bf16 v[176:179], a[112:115], v[112:115], v[176:179]
ds_read_b128 a[80:83], v2 offset:53248
v_mfma_f32_16x16x32_bf16 v[176:179], a[116:119], v[116:119], v[176:179]
buffer_load_dwordx4 v1, s[4:7], s12 offen offset:2048 sc1 lds
v_mfma_f32_16x16x32_bf16 v[180:183], a[116:119], v[124:127], v[180:183]
ds_read_b128 a[84:87], v2 offset:54272
v_mfma_f32_16x16x32_bf16 v[180:183], a[112:115], v[120:123], v[180:183]
v_exp_f32 v13, v37
v_mfma_f32_16x16x32_bf16 v[184:187], a[120:123], v[112:115], v[184:187]
ds_read_b128 a[88:91], v2 offset:55296
v_add_f32 v27, v12, v13
v_mfma_f32_16x16x32_bf16 v[184:187], a[124:127], v[116:119], v[184:187]
s_waitcnt lgkmcnt(4)
buffer_load_dwordx4 v1, s[4:7], s12 offen offset:3072 sc1 lds
v_mfma_f32_16x16x32_bf16 v[188:191], a[124:127], v[124:127], v[188:191]
s_add_u32 s12, s12, 28672
ds_read_b128 a[92:95], v2 offset:56320
v_cvt_pk_bf16_f32 v104, v12, v13
v_mfma_f32_16x16x32_bf16 v[188:191], a[120:123], v[120:123], v[188:191]
s_sub_u32 s13, s13, 1
v_exp_f32 v14, v38
v_mfma_f32_16x16x32_bf16 v[192:195], a[64:67], v[112:115], v[192:195]
s_cmp_eq_u32 s13, 0
ds_read_b128 a[96:99], v2 offset:57344
v_add_f32 v27, v27, v14
v_mfma_f32_16x16x32_bf16 v[192:195], a[68:71], v[116:119], v[192:195]
s_cselect_b32 s12, s14, s12
v_exp_f32 v15, v39
v_mfma_f32_16x16x32_bf16 v[196:199], a[68:71], v[124:127], v[196:199]
s_cselect_b32 s13, s15, s13
ds_read_b128 a[100:103], v2 offset:58368
v_add_f32 v27, v27, v15
v_mfma_f32_16x16x32_bf16 v[196:199], a[64:67], v[120:123], v[196:199]
s_cselect_b32 s14, 3221225472, s14
v_cvt_pk_bf16_f32 v105, v14, v15
v_mfma_f32_16x16x32_bf16 v[200:203], a[72:75], v[112:115], v[200:203]
s_waitcnt lgkmcnt(4)
ds_read_b128 a[104:107], v2 offset:59392
v_mfma_f32_16x16x32_bf16 v[200:203], a[76:79], v[116:119], v[200:203]
buffer_load_dword v3, off, s[4:7], s80 sc1
v_mfma_f32_16x16x32_bf16 v[204:207], a[76:79], v[124:127], v[204:207]
ds_read_b128 a[108:111], v2 offset:60416
v_mfma_f32_16x16x32_bf16 v[204:207], a[72:75], v[120:123], v[204:207]
v_exp_f32 v8, v40
v_mfma_f32_16x16x32_bf16 v[208:211], a[80:83], v[112:115], v[208:211]
ds_read_b128 a[112:115], v2 offset:61440
v_add_f32 v26, v26, v8
v_mfma_f32_16x16x32_bf16 v[208:211], a[84:87], v[116:119], v[208:211]
v_exp_f32 v9, v41
v_mfma_f32_16x16x32_bf16 v[212:215], a[84:87], v[124:127], v[212:215]
ds_read_b128 a[116:119], v2 offset:62464
v_add_f32 v26, v26, v9
v_mfma_f32_16x16x32_bf16 v[212:215], a[80:83], v[120:123], v[212:215]
s_waitcnt lgkmcnt(4)
v_exp_f32 v10, v42
v_mfma_f32_16x16x32_bf16 v[216:219], a[88:91], v[112:115], v[216:219]
ds_read_b128 a[120:123], v2 offset:63488
v_cvt_pk_bf16_f32 v98, v8, v9
v_mfma_f32_16x16x32_bf16 v[216:219], a[92:95], v[116:119], v[216:219]
v_exp_f32 v11, v43
v_mfma_f32_16x16x32_bf16 v[220:223], a[92:95], v[124:127], v[220:223]
s_waitcnt vmcnt(9)
ds_read_b128 a[124:127], v2 offset:64512
v_add_f32 v26, v26, v10
v_mfma_f32_16x16x32_bf16 v[220:223], a[88:91], v[120:123], v[220:223]
s_barrier
v_mfma_f32_16x16x32_bf16 v[224:227], a[96:99], v[112:115], v[224:227]
ds_read_b128 a[64:67], v4 offset:0
v_add_f32 v26, v26, v11
v_mfma_f32_16x16x32_bf16 v[224:227], a[100:103], v[116:119], v[224:227]
v_cvt_pk_bf16_f32 v99, v10, v11
v_mfma_f32_16x16x32_bf16 v[228:231], a[100:103], v[124:127], v[228:231]
ds_read_b128 a[68:71], v4 offset:1024
v_mfma_f32_16x16x32_bf16 v[228:231], a[96:99], v[120:123], v[228:231]
s_waitcnt lgkmcnt(4)
v_exp_f32 v12, v44
v_mfma_f32_16x16x32_bf16 v[232:235], a[104:107], v[112:115], v[232:235]
ds_read_b128 a[72:75], v4 offset:2048
v_add_f32 v27, v27, v12
v_mfma_f32_16x16x32_bf16 v[232:235], a[108:111], v[116:119], v[232:235]
v_exp_f32 v13, v45
v_mfma_f32_16x16x32_bf16 v[236:239], a[108:111], v[124:127], v[236:239]
ds_read_b128 a[76:79], v4 offset:3072
v_add_f32 v27, v27, v13
v_mfma_f32_16x16x32_bf16 v[236:239], a[104:107], v[120:123], v[236:239]
v_exp_f32 v14, v46
v_mfma_f32_16x16x32_bf16 v[240:243], a[112:115], v[112:115], v[240:243]
ds_read_b128 a[80:83], v4 offset:4096
v_cvt_pk_bf16_f32 v106, v12, v13
v_mfma_f32_16x16x32_bf16 v[240:243], a[116:119], v[116:119], v[240:243]
v_exp_f32 v15, v47
v_mfma_f32_16x16x32_bf16 v[244:247], a[116:119], v[124:127], v[244:247]
ds_read_b128 a[84:87], v4 offset:5120
v_add_f32 v27, v27, v14
v_mfma_f32_16x16x32_bf16 v[244:247], a[112:115], v[120:123], v[244:247]
s_waitcnt lgkmcnt(4)
v_add_f32 v27, v27, v15
v_cvt_pk_bf16_f32 v107, v14, v15
v_mfma_f32_16x16x32_bf16 v[248:251], a[120:123], v[112:115], v[248:251]
ds_read_b128 a[88:91], v4 offset:6144
v_mfma_f32_16x16x32_bf16 v[248:251], a[124:127], v[116:119], v[248:251]
v_mfma_f32_16x16x32_bf16 v[252:255], a[124:127], v[124:127], v[252:255]
ds_read_b128 a[92:95], v4 offset:7168
v_mfma_f32_16x16x32_bf16 v[252:255], a[120:123], v[120:123], v[252:255]
K2_dx1:
v_cndmask_b32 v68, v20, v7, s[32:33]
v_cndmask_b32 v69, v20, v7, s[34:35]
v_cndmask_b32 v70, v20, v7, s[36:37]
v_cndmask_b32 v71, v20, v7, s[38:39]
s_nop 1
v_mfma_f32_16x16x32_bf16 v[68:71], a[64:67], a[32:35], v[68:71]
s_add_u32 m0, s18, 0
ds_read_b128 a[96:99], v4 offset:8192
v_cndmask_b32 v76, v20, v7, s[40:41]
v_cndmask_b32 v79, v20, v7, s[46:47]
v_mfma_f32_16x16x32_bf16 v[68:71], a[68:71], a[36:39], v[68:71]
s_waitcnt lgkmcnt(4)
ds_read_b128 a[100:103], v4 offset:9216
buffer_load_dwordx4 v1, s[4:7], s12 offen offset:0 sc1 lds
v_mfma_f32_16x16x32_bf16 v[68:71], a[72:75], a[40:43], v[68:71]
ds_read_b128 a[104:107], v4 offset:10240
v_cndmask_b32 v77, v20, v7, s[42:43]
v_mfma_f32_16x16x32_bf16 v[68:71], a[76:79], a[44:47], v[68:71]
ds_read_b128 a[108:111], v4 offset:11264
buffer_load_dwordx4 v1, s[4:7], s12 offen offset:1024 sc1 lds
v_mfma_f32_16x16x32_bf16 v[68:71], a[80:83], a[48:51], v[68:71]
s_waitcnt lgkmcnt(6)
ds_read_b128 a[112:115], v4 offset:12288
v_cndmask_b32 v78, v20, v7, s[44:45]
v_mfma_f32_16x16x32_bf16 v[68:71], a[84:87], a[52:55], v[68:71]
s_waitcnt lgkmcnt(6)
ds_read_b128 a[116:119], v4 offset:13312
buffer_load_dwordx4 v1, s[4:7], s12 offen offset:2048 sc1 lds
v_mfma_f32_16x16x32_bf16 v[68:71], a[88:91], a[56:59], v[68:71]
s_waitcnt lgkmcnt(6)
ds_read_b128 a[120:123], v4 offset:14336
v_exp_f32 v8, v48
v_exp_f32 v9, v49
v_exp_f32 v10, v50
v_mfma_f32_16x16x32_bf16 v[68:71], a[92:95], a[60:63], v[68:71]
s_waitcnt lgkmcnt(5)
ds_read_b128 a[124:127], v4 offset:15360
buffer_load_dwordx4 v1, s[4:7], s12 offen offset:3072 sc1 lds
v_add_f32 v26, v26, v8
v_add_f32 v26, v26, v9
v_cvt_pk_bf16_f32 v100, v8, v9
v_add_f32 v26, v26, v10
v_mfma_f32_16x16x32_bf16 v[76:79], a[96:99], a[32:35], v[76:79]
s_add_u32 s12, s12, 4096
s_add_u32 m0, s18, 4096
ds_read_b128 a[64:67], v4 offset:16384
v_cndmask_b32 v86, v20, v7, s[52:53]
v_cndmask_b32 v87, v20, v7, s[54:55]
v_mfma_f32_16x16x32_bf16 v[76:79], a[100:103], a[36:39], v[76:79]
s_waitcnt lgkmcnt(6)
ds_read_b128 a[68:71], v4 offset:17408
buffer_load_dwordx4 v1, s[4:7], s12 offen offset:0 sc1 lds
v_mfma_f32_16x16x32_bf16 v[76:79], a[104:107], a[40:43], v[76:79]
s_waitcnt lgkmcnt(6)
ds_read_b128 a[72:75], v4 offset:18432
v_cndmask_b32 v84, v20, v7, s[48:49]
v_mfma_f32_16x16x32_bf16 v[76:79], a[108:111], a[44:47], v[76:79]
s_waitcnt lgkmcnt(6)
ds_read_b128 a[76:79], v4 offset:19456
buffer_load_dwordx4 v1, s[4:7], s12 offen offset:1024 sc1 lds
v_mfma_f32_16x16x32_bf16 v[76:79], a[112:115], a[48:51], v[76:79]
s_waitcnt lgkmcnt(6)
ds_read_b128 a[80:83], v4 offset:20480
v_cndmask_b32 v85, v20, v7, s[50:51]
v_mfma_f32_16x16x32_bf16 v[76:79], a[116:119], a[52:55], v[76:79]
s_waitcnt lgkmcnt(6)
ds_read_b128 a[84:87], v4 offset:21504
buffer_load_dwordx4 v1, s[4:7], s12 offen offset:2048 sc1 lds
v_mfma_f32_16x16x32_bf16 v[76:79], a[120:123], a[56:59], v[76:79]
s_waitcnt lgkmcnt(6)
ds_read_b128 a[88:91], v4 offset:22528
v_exp_f32 v11, v51
v_exp_f32 v12, v52
v_mfma_f32_16x16x32_bf16 v[76:79], a[124:127], a[60:63], v[76:79]
s_waitcnt lgkmcnt(1)
ds_read_b128 a[92:95], v4 offset:23552
buffer_load_dwordx4 v1, s[4:7], s12 offen offset:3072 sc1 lds
v_add_f32 v26, v26, v11
v_cvt_pk_bf16_f32 v101, v10, v11
v_add_f32 v27, v27, v12
v_mfma_f32_16x16x32_bf16 v[84:87], a[64:67], a[32:35], v[84:87]
s_add_u32 s12, s12, 28672
ds_read_b128 a[96:99], v4 offset:24576
v_cndmask_b32 v92, v20, v7, s[56:57]
v_mfma_f32_16x16x32_bf16 v[84:87], a[68:71], a[36:39], v[84:87]
s_sub_u32 s13, s13, 1
ds_read_b128 a[100:103], v4 offset:25600
v_cndmask_b32 v93, v20, v7, s[58:59]
v_mfma_f32_16x16x32_bf16 v[84:87], a[72:75], a[40:43], v[84:87]
s_cmp_eq_u32 s13, 0
ds_read_b128 a[104:107], v4 offset:26624
v_cndmask_b32 v94, v20, v7, s[60:61]
v_mfma_f32_16x16x32_bf16 v[84:87], a[76:79], a[44:47], v[84:87]
s_cselect_b32 s12, s14, s12
ds_read_b128 a[108:111], v4 offset:27648
v_cndmask_b32 v95, v20, v7, s[62:63]
v_mfma_f32_16x16x32_bf16 v[84:87], a[80:83], a[48:51], v[84:87]
s_cselect_b32 s13, s15, s13
ds_read_b128 a[112:115], v4 offset:28672
v_exp_f32 v13, v53
v_exp_f32 v14, v54
v_mfma_f32_16x16x32_bf16 v[84:87], a[84:87], a[52:55], v[84:87]
s_waitcnt lgkmcnt(6)
s_cselect_b32 s14, 3221225472, s14
ds_read_b128 a[116:119], v4 offset:29696
v_exp_f32 v15, v55
v_exp_f32 v8, v56
v_exp_f32 v9, v57
v_add_f32 v27, v27, v13
v_cvt_pk_bf16_f32 v108, v12, v13
v_add_f32 v27, v27, v14
v_mfma_f32_16x16x32_bf16 v[84:87], a[88:91], a[56:59], v[84:87]
s_waitcnt lgkmcnt(6)
ds_read_b128 a[120:123], v4 offset:30720
v_exp_f32 v10, v58
v_exp_f32 v11, v59
v_add_f32 v27, v27, v15
v_cvt_pk_bf16_f32 v109, v14, v15
v_mfma_f32_16x16x32_bf16 v[84:87], a[92:95], a[60:63], v[84:87]
s_waitcnt vmcnt(8) lgkmcnt(6)
s_barrier
ds_read_b128 a[124:127], v4 offset:31744
v_mfma_f32_16x16x32_bf16 v[92:95], a[96:99], a[32:35], v[92:95]
s_waitcnt lgkmcnt(6)
ds_read_b128 a[64:67], v2 offset:0
v_exp_f32 v12, v60
v_exp_f32 v13, v61
v_mfma_f32_16x16x32_bf16 v[92:95], a[100:103], a[36:39], v[92:95]
s_waitcnt lgkmcnt(6)
ds_read_b128 a[68:71], v2 offset:1024
v_exp_f32 v14, v62
v_exp_f32 v15, v63
v_mfma_f32_16x16x32_bf16 v[92:95], a[104:107], a[40:43], v[92:95]
s_waitcnt lgkmcnt(6)
ds_read_b128 a[72:75], v2 offset:2048
v_add_f32 v26, v26, v8
v_add_f32 v26, v26, v9
v_cvt_pk_bf16_f32 v102, v8, v9
v_mfma_f32_16x16x32_bf16 v[92:95], a[108:111], a[44:47], v[92:95]
s_waitcnt lgkmcnt(6)
ds_read_b128 a[76:79], v2 offset:3072
v_add_f32 v26, v26, v10
v_add_f32 v26, v26, v11
v_cvt_pk_bf16_f32 v103, v10, v11
v_mfma_f32_16x16x32_bf16 v[92:95], a[112:115], a[48:51], v[92:95]
s_waitcnt lgkmcnt(6)
ds_read_b128 a[80:83], v2 offset:4096
v_add_f32 v27, v27, v12
v_mfma_f32_16x16x32_bf16 v[92:95], a[116:119], a[52:55], v[92:95]
s_waitcnt lgkmcnt(6)
ds_read_b128 a[84:87], v2 offset:5120
v_add_f32 v27, v27, v13
v_cvt_pk_bf16_f32 v110, v12, v13
v_mfma_f32_16x16x32_bf16 v[92:95], a[120:123], a[56:59], v[92:95]
s_waitcnt lgkmcnt(6)
ds_read_b128 a[88:91], v2 offset:6144
v_add_f32 v27, v27, v14
v_add_f32 v27, v27, v15
v_cvt_pk_bf16_f32 v111, v14, v15
v_mfma_f32_16x16x32_bf16 v[92:95], a[124:127], a[60:63], v[92:95]
s_waitcnt lgkmcnt(6)
ds_read_b128 a[92:95], v2 offset:7168
v_add_f32 v28, v26, v27
v_cmp_nge_f32 vcc, s25, v28
s_cbranch_vccnz Lstub_8
Lback_9:
s_cmp_lg_u32 s24, 1
s_cbranch_scc1 K2_plain
v_cmp_gt_u32 vcc, 1, v3
s_cbranch_vccnz K2_tspin
K2_tok:
v_mfma_f32_16x16x32_bf16 v[128:131], a[64:67], v[96:99], v[128:131]
s_waitcnt lgkmcnt(6)
ds_read_b128 a[96:99], v2 offset:8192
v_add_f32 v24, v24, v26
v_mfma_f32_16x16x32_bf16 v[128:131], a[68:71], v[100:103], v[128:131]
buffer_load_dwordx4 v[28:31], v1, s[4:7], s27 offen sc1
v_mfma_f32_16x16x32_bf16 v[132:135], a[68:71], v[108:111], v[132:135]
ds_read_b128 a[100:103], v2 offset:9216
v_add_f32 v25, v25, v27
v_mfma_f32_16x16x32_bf16 v[132:135], a[64:67], v[104:107], v[132:135]
s_waitcnt lgkmcnt(6)
v_exp_f32 v8, v68
v_mfma_f32_16x16x32_bf16 v[136:139], a[72:75], v[96:99], v[136:139]
s_add_u32 s22, s76, 0
ds_read_b128 a[104:107], v2 offset:10240
v_exp_f32 v9, v69
v_mfma_f32_16x16x32_bf16 v[136:139], a[76:79], v[100:103], v[136:139]
buffer_load_dwordx4 v[32:35], v1, s[4:7], s22 offen offset:0 sc1
v_mfma_f32_16x16x32_bf16 v[140:143], a[76:79], v[108:111], v[140:143]
ds_read_b128 a[108:111], v2 offset:11264
v_add_f32 v27, v8, v9
v_mfma_f32_16x16x32_bf16 v[140:143], a[72:75], v[104:107], v[140:143]
s_waitcnt lgkmcnt(5)
v_exp_f32 v10, v70
v_mfma_f32_16x16x32_bf16 v[144:147], a[80:83], v[96:99], v[144:147]
ds_read_b128 a[112:115], v2 offset:12288
v_cvt_pk_bf16_f32 v120, v8, v9
v_mfma_f32_16x16x32_bf16 v[144:147], a[84:87], v[100:103], v[144:147]
buffer_load_dwordx4 v[36:39], v1, s[4:7], s22 offen offset:1024 sc1
v_mfma_f32_16x16x32_bf16 v[148:151], a[84:87], v[108:111], v[148:151]
ds_read_b128 a[116:119], v2 offset:13312
v_add_f32 v27, v27, v10
v_mfma_f32_16x16x32_bf16 v[148:151], a[80:83], v[104:107], v[148:151]
v_exp_f32 v11, v71
v_mfma_f32_16x16x32_bf16 v[152:155], a[88:91], v[96:99], v[152:155]
s_waitcnt lgkmcnt(4)
ds_read_b128 a[120:123], v2 offset:14336
v_add_f32 v27, v27, v11
v_mfma_f32_16x16x32_bf16 v[152:155], a[92:95], v[100:103], v[152:155]
buffer_load_dwordx4 v[40:43], v1, s[4:7], s22 offen offset:2048 sc1
v_mfma_f32_16x16x32_bf16 v[156:159], a[92:95], v[108:111], v[156:159]
ds_read_b128 a[124:127], v2 offset:15360
v_cvt_pk_bf16_f32 v121, v10, v11
v_mfma_f32_16x16x32_bf16 v[156:159], a[88:91], v[104:107], v[156:159]
v_exp_f32 v12, v76
v_mfma_f32_16x16x32_bf16 v[160:163], a[96:99], v[96:99], v[160:163]
ds_read_b128 a[64:67], v2 offset:16384
v_add_f32 v27, v27, v12
v_mfma_f32_16x16x32_bf16 v[160:163], a[100:103], v[100:103], v[160:163]
buffer_load_dwordx4 v[44:47], v1, s[4:7], s22 offen offset:3072 sc1
v_mfma_f32_16x16x32_bf16 v[164:167], a[100:103], v[108:111], v[164:167]
PAD_12:
s_cbranch_execz M_tret
ds_read_b128 a[68:71], v2 offset:17408
v_mfma_f32_16x16x32_bf16 v[164:167], a[96:99], v[104:107], v[164:167]
s_waitcnt lgkmcnt(4)
v_exp_f32 v13, v77
v_mfma_f32_16x16x32_bf16 v[168:171], a[104:107], v[96:99], v[168:171]
s_add_u32 s22, s76, 4096
ds_read_b128 a[72:75], v2 offset:18432
v_add_f32 v27, v27, v13
v_mfma_f32_16x16x32_bf16 v[168:171], a[108:111], v[100:103], v[168:171]
buffer_load_dwordx4 v[48:51], v1, s[4:7], s22 offen offset:0 sc1
v_mfma_f32_16x16x32_bf16 v[172:175], a[108:111], v[108:111], v[172:175]
ds_read_b128 a[76:79], v2 offset:19456
v_exp_f32 v14, v78
v_mfma_f32_16x16x32_bf16 v[172:175], a[104:107], v[104:107], v[172:175]
v_exp_f32 v15, v79
v_mfma_f32_16x16x32_bf16 v[176:179], a[112:115], v[96:99], v[176:179]
ds_read_b128 a[80:83], v2 offset:20480
v_cvt_pk_bf16_f32 v122, v12, v13
v_mfma_f32_16x16x32_bf16 v[176:179], a[116:119], v[100:103], v[176:179]
buffer_load_dwordx4 v[52:55], v1, s[4:7], s22 offen offset:1024 sc1
v_mfma_f32_16x16x32_bf16 v[180:183], a[116:119], v[108:111], v[180:183]
ds_read_b128 a[84:87], v2 offset:21504
v_add_f32 v27, v27, v14
v_mfma_f32_16x16x32_bf16 v[180:183], a[112:115], v[104:107], v[180:183]
s_waitcnt lgkmcnt(4)
v_exp_f32 v8, v84
v_mfma_f32_16x16x32_bf16 v[184:187], a[120:123], v[96:99], v[184:187]
ds_read_b128 a[88:91], v2 offset:22528
v_add_f32 v27, v27, v15
v_cvt_pk_bf16_f32 v123, v14, v15
v_mfma_f32_16x16x32_bf16 v[184:187], a[124:127], v[100:103], v[184:187]
buffer_load_dwordx4 v[56:59], v1, s[4:7], s22 offen offset:2048 sc1
v_mfma_f32_16x16x32_bf16 v[188:191], a[124:127], v[108:111], v[188:191]
ds_read_b128 a[92:95], v2 offset:23552
v_add_f32 v27, v27, v8
v_mfma_f32_16x16x32_bf16 v[188:191], a[120:123], v[104:107], v[188:191]
v_exp_f32 v9, v85
v_mfma_f32_16x16x32_bf16 v[192:195], a[64:67], v[96:99], v[192:195]
ds_read_b128 a[96:99], v2 offset:24576
v_add_f32 v27, v27, v9
v_mfma_f32_16x16x32_bf16 v[192:195], a[68:71], v[100:103], v[192:195]
buffer_load_dwordx4 v[60:63], v1, s[4:7], s22 offen offset:3072 sc1
v_mfma_f32_16x16x32_bf16 v[196:199], a[68:71], v[108:111], v[196:199]
ds_read_b128 a[100:103], v2 offset:25600
v_cvt_pk_bf16_f32 v124, v8, v9
v_mfma_f32_16x16x32_bf16 v[196:199], a[64:67], v[104:107], v[196:199]
s_waitcnt lgkmcnt(4)
v_exp_f32 v10, v86
v_mfma_f32_16x16x32_bf16 v[200:203], a[72:75], v[96:99], v[200:203]
s_add_u32 s22, s76, 8192
ds_read_b128 a[104:107], v2 offset:26624
v_add_f32 v27, v27, v10
v_mfma_f32_16x16x32_bf16 v[200:203], a[76:79], v[100:103], v[200:203]
buffer_load_dwordx4 a[32:35], v1, s[4:7], s22 offen offset:0 sc1
v_mfma_f32_16x16x32_bf16 v[204:207], a[76:79], v[108:111], v[204:207]
ds_read_b128 a[108:111], v2 offset:27648
v_mfma_f32_16x16x32_bf16 v[204:207], a[72:75], v[104:107], v[204:207]
v_exp_f32 v11, v87
v_mfma_f32_16x16x32_bf16 v[208:211], a[80:83], v[96:99], v[208:211]
ds_read_b128 a[112:115], v2 offset:28672
v_exp_f32 v12, v92
v_mfma_f32_16x16x32_bf16 v[208:211], a[84:87], v[100:103], v[208:211]
buffer_load_dwordx4 a[36:39], v1, s[4:7], s22 offen offset:1024 sc1
v_mfma_f32_16x16x32_bf16 v[212:215], a[84:87], v[108:111], v[212:215]
ds_read_b128 a[116:119], v2 offset:29696
v_add_f32 v27, v27, v11
v_mfma_f32_16x16x32_bf16 v[212:215], a[80:83], v[104:107], v[212:215]
s_waitcnt lgkmcnt(4)
v_exp_f32 v13, v93
v_mfma_f32_16x16x32_bf16 v[216:219], a[88:91], v[96:99], v[216:219]
ds_read_b128 a[120:123], v2 offset:30720
v_cvt_pk_bf16_f32 v125, v10, v11
v_add_f32 v27, v27, v12
v_mfma_f32_16x16x32_bf16 v[216:219], a[92:95], v[100:103], v[216:219]
buffer_load_dwordx4 a[40:43], v1, s[4:7], s22 offen offset:2048 sc1
v_mfma_f32_16x16x32_bf16 v[220:223], a[92:95], v[108:111], v[220:223]
s_waitcnt vmcnt(12)
ds_read_b128 a[124:127], v2 offset:31744
v_add_f32 v27, v27, v13
v_mfma_f32_16x16x32_bf16 v[220:223], a[88:91], v[104:107], v[220:223]
s_barrier
v_mfma_f32_16x16x32_bf16 v[224:227], a[96:99], v[96:99], v[224:227]
ds_read_b128 a[64:67], v1 offset:0
v_cvt_pk_bf16_f32 v126, v12, v13
v_mfma_f32_16x16x32_bf16 v[224:227], a[100:103], v[100:103], v[224:227]
buffer_load_dwordx4 a[44:47], v1, s[4:7], s22 offen offset:3072 sc1
v_mfma_f32_16x16x32_bf16 v[228:231], a[100:103], v[108:111], v[228:231]
ds_read_b128 a[68:71], v1 offset:1024
v_mfma_f32_16x16x32_bf16 v[228:231], a[96:99], v[104:107], v[228:231]
s_waitcnt lgkmcnt(4)
v_exp_f32 v14, v94
v_mfma_f32_16x16x32_bf16 v[232:235], a[104:107], v[96:99], v[232:235]
s_add_u32 s22, s76, 12288
ds_read_b128 a[72:75], v1 offset:2048
v_add_f32 v27, v27, v14
v_mfma_f32_16x16x32_bf16 v[232:235], a[108:111], v[100:103], v[232:235]
buffer_load_dwordx4 a[48:51], v1, s[4:7], s22 offen offset:0 sc1
v_mfma_f32_16x16x32_bf16 v[236:239], a[108:111], v[108:111], v[236:239]
ds_read_b128 a[76:79], v1 offset:3072
v_mfma_f32_16x16x32_bf16 v[236:239], a[104:107], v[104:107], v[236:239]
v_exp_f32 v15, v95
v_mfma_f32_16x16x32_bf16 v[240:243], a[112:115], v[96:99], v[240:243]
ds_read_b128 a[80:83], v1 offset:4096
v_add_f32 v27, v27, v15
v_mfma_f32_16x16x32_bf16 v[240:243], a[116:119], v[100:103], v[240:243]
buffer_load_dwordx4 a[52:55], v1, s[4:7], s22 offen offset:1024 sc1
v_mfma_f32_16x16x32_bf16 v[244:247], a[116:119], v[108:111], v[244:247]
ds_read_b128 a[84:87], v1 offset:5120
v_cvt_pk_bf16_f32 v127, v14, v15
v_mfma_f32_16x16x32_bf16 v[244:247], a[112:115], v[104:107], v[244:247]
s_waitcnt lgkmcnt(4)
v_cmp_nge_f32 vcc, s25, v27
v_mfma_f32_16x16x32_bf16 v[248:251], a[120:123], v[96:99], v[248:251]
ds_read_b128 a[88:91], v1 offset:6144
v_mfma_f32_16x16x32_bf16 v[248:251], a[124:127], v[100:103], v[248:251]
buffer_load_dwordx4 a[56:59], v1, s[4:7], s22 offen offset:2048 sc1
v_mfma_f32_16x16x32_bf16 v[252:255], a[124:127], v[108:111], v[252:255]
ds_read_b128 a[92:95], v1 offset:7168
v_mfma_f32_16x16x32_bf16 v[252:255], a[120:123], v[104:107], v[252:255]
s_waitcnt lgkmcnt(2)
buffer_load_dwordx4 a[60:63], v1, s[4:7], s22 offen offset:3072 sc1
s_cbranch_vccnz Lstub_10
Lback_11:
v_mfma_f32_16x16x32_bf16 v[132:135], a[64:67], v[120:123], v[132:135]
s_mov_b64 s[36:37], s[86:87]
ds_read_b128 a[96:99], v1 offset:8192
v_add_f32 v25, v25, v27
v_mfma_f32_16x16x32_bf16 v[132:135], a[68:71], v[124:127], v[132:135]
s_mov_b32 s38, 3670016
ds_read_b128 a[100:103], v1 offset:9216
v_accvgpr_read_b32 v112, a184
v_mfma_f32_16x16x32_bf16 v[140:143], a[72:75], v[120:123], v[140:143]
s_mov_b32 s39, 0x20000
ds_read_b128 a[104:107], v1 offset:10240
v_accvgpr_read_b32 v113, a185
v_mfma_f32_16x16x32_bf16 v[140:143], a[76:79], v[124:127], v[140:143]
s_lshl_b32 s8, s29, 3
ds_read_b128 a[108:111], v1 offset:11264
v_accvgpr_read_b32 v114, a186
v_mfma_f32_16x16x32_bf16 v[148:151], a[80:83], v[120:123], v[148:151]
s_add_u32 s8, s8, s3
ds_read_b128 a[112:115], v1 offset:12288
v_accvgpr_read_b32 v115, a187
v_mfma_f32_16x16x32_bf16 v[148:151], a[84:87], v[124:127], v[148:151]
s_waitcnt lgkmcnt(3)
s_lshl_b32 s8, s8, 4
ds_read_b128 a[116:119], v1 offset:13312
v_accvgpr_read_b32 v116, a188
v_mfma_f32_16x16x32_bf16 v[156:159], a[88:91], v[120:123], v[156:159]
s_add_u32 s8, s8, s20
ds_read_b128 a[120:123], v1 offset:14336
v_accvgpr_read_b32 v117, a189
v_mfma_f32_16x16x32_bf16 v[156:159], a[92:95], v[124:127], v[156:159]
s_mul_i32 s8, s8, 14336
ds_read_b128 a[124:127], v1 offset:15360
v_accvgpr_read_b32 v118, a190
v_mfma_f32_16x16x32_bf16 v[164:167], a[96:99], v[120:123], v[164:167]
s_add_u32 s8, s8, 104857600
ds_read_b128 a[64:67], v1 offset:16384
v_accvgpr_read_b32 v119, a191
v_mfma_f32_16x16x32_bf16 v[164:167], a[100:103], v[124:127], v[164:167]
s_waitcnt lgkmcnt(6)
s_add_u32 s12, s8, 917504
ds_read_b128 a[68:71], v1 offset:17408
v_mfma_f32_16x16x32_bf16 v[172:175], a[104:107], v[120:123], v[172:175]
s_waitcnt lgkmcnt(6)
ds_read_b128 a[72:75], v1 offset:18432
v_mfma_f32_16x16x32_bf16 v[172:175], a[108:111], v[124:127], v[172:175]
s_waitcnt lgkmcnt(6)
ds_read_b128 a[76:79], v1 offset:19456
v_mfma_f32_16x16x32_bf16 v[180:183], a[112:115], v[120:123], v[180:183]
s_waitcnt lgkmcnt(6)
ds_read_b128 a[80:83], v1 offset:20480
v_mfma_f32_16x16x32_bf16 v[180:183], a[116:119], v[124:127], v[180:183]
s_waitcnt lgkmcnt(6)
ds_read_b128 a[84:87], v1 offset:21504
v_mfma_f32_16x16x32_bf16 v[188:191], a[120:123], v[120:123], v[188:191]
s_waitcnt lgkmcnt(6)
ds_read_b128 a[88:91], v1 offset:22528
v_mfma_f32_16x16x32_bf16 v[188:191], a[124:127], v[124:127], v[188:191]
s_waitcnt lgkmcnt(6)
ds_read_b128 a[92:95], v1 offset:23552
v_mfma_f32_16x16x32_bf16 v[196:199], a[64:67], v[120:123], v[196:199]
s_waitcnt lgkmcnt(6)
ds_read_b128 a[96:99], v1 offset:24576
v_mfma_f32_16x16x32_bf16 v[196:199], a[68:71], v[124:127], v[196:199]
s_waitcnt lgkmcnt(6)
ds_read_b128 a[100:103], v1 offset:25600
v_mfma_f32_16x16x32_bf16 v[204:207], a[72:75], v[120:123], v[204:207]
s_waitcnt lgkmcnt(6)
ds_read_b128 a[104:107], v1 offset:26624
v_mfma_f32_16x16x32_bf16 v[204:207], a[76:79], v[124:127], v[204:207]
s_waitcnt lgkmcnt(6)
ds_read_b128 a[108:111], v1 offset:27648
v_mfma_f32_16x16x32_bf16 v[212:215], a[80:83], v[120:123], v[212:215]
s_waitcnt lgkmcnt(6)
ds_read_b128 a[112:115], v1 offset:28672
v_mfma_f32_16x16x32_bf16 v[212:215], a[84:87], v[124:127], v[212:215]
s_waitcnt lgkmcnt(6)
ds_read_b128 a[116:119], v1 offset:29696
v_mfma_f32_16x16x32_bf16 v[220:223], a[88:91], v[120:123], v[220:223]
s_waitcnt lgkmcnt(6)
s_add_u32 m0, s18, 32768
ds_read_b128 a[120:123], v1 offset:30720
v_mfma_f32_16x16x32_bf16 v[220:223], a[92:95], v[124:127], v[220:223]
s_waitcnt lgkmcnt(6)
ds_read_b128 a[124:127], v1 offset:31744
v_mfma_f32_16x16x32_bf16 v[228:231], a[96:99], v[120:123], v[228:231]
s_waitcnt lgkmcnt(6)
buffer_load_dwordx4 v112, s[36:39], s81 offen offset:0 lds
v_mfma_f32_16x16x32_bf16 v[228:231], a[100:103], v[124:127], v[228:231]
s_waitcnt lgkmcnt(5)
buffer_load_dwordx4 v113, s[36:39], s81 offen offset:1024 lds
v_mfma_f32_16x16x32_bf16 v[236:239], a[104:107], v[120:123], v[236:239]
s_waitcnt lgkmcnt(4)
buffer_load_dwordx4 v114, s[36:39], s81 offen offset:2048 lds
v_mfma_f32_16x16x32_bf16 v[236:239], a[108:111], v[124:127], v[236:239]
s_waitcnt lgkmcnt(3)
buffer_load_dwordx4 v115, s[36:39], s81 offen offset:3072 lds
v_mfma_f32_16x16x32_bf16 v[244:247], a[112:115], v[120:123], v[244:247]
s_waitcnt lgkmcnt(2)
s_add_u32 s81, s81, 28672
v_mfma_f32_16x16x32_bf16 v[244:247], a[116:119], v[124:127], v[244:247]
s_waitcnt lgkmcnt(1)
s_add_u32 m0, s18, 36864
v_mfma_f32_16x16x32_bf16 v[252:255], a[120:123], v[120:123], v[252:255]
s_waitcnt lgkmcnt(0)
buffer_load_dwordx4 v112, s[36:39], s81 offen offset:0 lds
v_mfma_f32_16x16x32_bf16 v[252:255], a[124:127], v[124:127], v[252:255]
buffer_load_dwordx4 v113, s[36:39], s81 offen offset:1024 lds
buffer_load_dwordx4 v114, s[36:39], s81 offen offset:2048 lds
buffer_load_dwordx4 v115, s[36:39], s81 offen offset:3072 lds
s_sub_u32 s81, s81, 28544
s_waitcnt vmcnt(8)
v_sub_f32 v8, v16, v28
v_sub_f32 v10, v20, v30
v_max_f32 v9, v8, v10
v_cmp_lt_f32 vcc, 1114636288, v9
s_cbranch_vccnz K2_cfix
K2_cok:
v_exp_f32 v8, v8
v_exp_f32 v10, v10
s_nop 0
v_mov_b32 v9, v8
v_mov_b32 v11, v10
v_fmac_f32 v24, v8, v29
v_fmac_f32 v25, v10, v31
s_mov_b32 s23, 0xffff0000
v_lshlrev_b32 v64, 16, v32
v_and_b32 v65, s23, v32
v_lshlrev_b32 v66, 16, v33
v_and_b32 v67, s23, v33
v_lshlrev_b32 v68, 16, v34
v_and_b32 v69, s23, v34
v_lshlrev_b32 v70, 16, v35
v_and_b32 v71, s23, v35
v_pk_fma_f32 v[128:129], v[64:65], v[8:9], v[128:129]
v_pk_fma_f32 v[130:131], v[66:67], v[8:9], v[130:131]
v_pk_fma_f32 v[136:137], v[68:69], v[8:9], v[136:137]
v_pk_fma_f32 v[138:139], v[70:71], v[8:9], v[138:139]
v_cvt_pk_bf16_f32 v128, v128, v129
v_cvt_pk_bf16_f32 v129, v130, v131
v_cvt_pk_bf16_f32 v130, v136, v137
v_cvt_pk_bf16_f32 v131, v138, v139
s_add_u32 m0, s18, 98304
s_nop 0
buffer_load_dwordx4 v112, s[36:39], s81 offen offset:0 lds
v_lshlrev_b32 v64, 16, v36
v_and_b32 v65, s23, v36
v_lshlrev_b32 v66, 16, v37
v_and_b32 v67, s23, v37
v_lshlrev_b32 v68, 16, v38
v_and_b32 v69, s23, v38
v_lshlrev_b32 v70, 16, v39
v_and_b32 v71, s23, v39
v_pk_fma_f32 v[144:145], v[64:65], v[8:9], v[144:145]
v_pk_fma_f32 v[146:147], v[66:67], v[8:9], v[146:147]
v_pk_fma_f32 v[152:153], v[68:69], v[8:9], v[152:153]
v_pk_fma_f32 v[154:155], v[70:71], v[8:9], v[154:155]
v_cvt_pk_bf16_f32 v144, v144, v145
v_cvt_pk_bf16_f32 v145, v146, v147
v_cvt_pk_bf16_f32 v146, v152, v153
v_cvt_pk_bf16_f32 v147, v154, v155
buffer_load_dwordx4 v113, s[36:39], s81 offen offset:1024 lds
v_lshlrev_b32 v64, 16, v40
v_and_b32 v65, s23, v40
v_lshlrev_b32 v66, 16, v41
v_and_b32 v67, s23, v41
v_lshlrev_b32 v68, 16, v42
v_and_b32 v69, s23, v42
v_lshlrev_b32 v70, 16, v43
v_and_b32 v71, s23, v43
v_pk_fma_f32 v[160:161], v[64:65], v[8:9], v[160:161]
v_pk_fma_f32 v[162:163], v[66:67], v[8:9], v[162:163]
v_pk_fma_f32 v[168:169], v[68:69], v[8:9], v[168:169]
v_pk_fma_f32 v[170:171], v[70:71], v[8:9], v[170:171]
v_cvt_pk_bf16_f32 v160, v160, v161
v_cvt_pk_bf16_f32 v161, v162, v163
v_cvt_pk_bf16_f32 v162, v168, v169
v_cvt_pk_bf16_f32 v163, v170, v171
buffer_load_dwordx4 v114, s[36:39], s81 offen offset:2048 lds
v_lshlrev_b32 v64, 16, v44
v_and_b32 v65, s23, v44
v_lshlrev_b32 v66, 16, v45
v_and_b32 v67, s23, v45
v_lshlrev_b32 v68, 16, v46
v_and_b32 v69, s23, v46
v_lshlrev_b32 v70, 16, v47
v_and_b32 v71, s23, v47
v_pk_fma_f32 v[176:177], v[64:65], v[8:9], v[176:177]
v_pk_fma_f32 v[178:179], v[66:67], v[8:9], v[178:179]
v_pk_fma_f32 v[184:185], v[68:69], v[8:9], v[184:185]
v_pk_fma_f32 v[186:187], v[70:71], v[8:9], v[186:187]
v_cvt_pk_bf16_f32 v176, v176, v177
v_cvt_pk_bf16_f32 v177, v178, v179
v_cvt_pk_bf16_f32 v178, v184, v185
v_cvt_pk_bf16_f32 v179, v186, v187
buffer_load_dwordx4 v115, s[36:39], s81 offen offset:3072 lds
v_lshlrev_b32 v64, 16, v48
v_and_b32 v65, s23, v48
v_lshlrev_b32 v66, 16, v49
v_and_b32 v67, s23, v49
v_lshlrev_b32 v68, 16, v50
v_and_b32 v69, s23, v50
v_lshlrev_b32 v70, 16, v51
v_and_b32 v71, s23, v51
v_pk_fma_f32 v[192:193], v[64:65], v[8:9], v[192:193]
v_pk_fma_f32 v[194:195], v[66:67], v[8:9], v[194:195]
v_pk_fma_f32 v[200:201], v[68:69], v[8:9], v[200:201]
v_pk_fma_f32 v[202:203], v[70:71], v[8:9], v[202:203]
v_cvt_pk_bf16_f32 v192, v192, v193
v_cvt_pk_bf16_f32 v193, v194, v195
v_cvt_pk_bf16_f32 v194, v200, v201
v_cvt_pk_bf16_f32 v195, v202, v203
s_add_u32 s81, s81, 28672
s_add_u32 m0, s18, 102400
s_nop 0
buffer_load_dwordx4 v112, s[36:39], s81 offen offset:0 lds
v_lshlrev_b32 v64, 16, v52
v_and_b32 v65, s23, v52
v_lshlrev_b32 v66, 16, v53
v_and_b32 v67, s23, v53
v_lshlrev_b32 v68, 16, v54
v_and_b32 v69, s23, v54
v_lshlrev_b32 v70, 16, v55
v_and_b32 v71, s23, v55
v_pk_fma_f32 v[208:209], v[64:65], v[8:9], v[208:209]
v_pk_fma_f32 v[210:211], v[66:67], v[8:9], v[210:211]
v_pk_fma_f32 v[216:217], v[68:69], v[8:9], v[216:217]
v_pk_fma_f32 v[218:219], v[70:71], v[8:9], v[218:219]
v_cvt_pk_bf16_f32 v208, v208, v209
v_cvt_pk_bf16_f32 v209, v210, v211
v_cvt_pk_bf16_f32 v210, v216, v217
v_cvt_pk_bf16_f32 v211, v218, v219
buffer_load_dwordx4 v113, s[36:39], s81 offen offset:1024 lds
v_lshlrev_b32 v64, 16, v56
v_and_b32 v65, s23, v56
v_lshlrev_b32 v66, 16, v57
v_and_b32 v67, s23, v57
v_lshlrev_b32 v68, 16, v58
v_and_b32 v69, s23, v58
v_lshlrev_b32 v70, 16, v59
v_and_b32 v71, s23, v59
v_pk_fma_f32 v[224:225], v[64:65], v[8:9], v[224:225]
v_pk_fma_f32 v[226:227], v[66:67], v[8:9], v[226:227]
v_pk_fma_f32 v[232:233], v[68:69], v[8:9], v[232:233]
v_pk_fma_f32 v[234:235], v[70:71], v[8:9], v[234:235]
v_cvt_pk_bf16_f32 v224, v224, v225
v_cvt_pk_bf16_f32 v225, v226, v227
v_cvt_pk_bf16_f32 v226, v232, v233
v_cvt_pk_bf16_f32 v227, v234, v235
buffer_load_dwordx4 v114, s[36:39], s81 offen offset:2048 lds
v_lshlrev_b32 v64, 16, v60
v_and_b32 v65, s23, v60
v_lshlrev_b32 v66, 16, v61
v_and_b32 v67, s23, v61
v_lshlrev_b32 v68, 16, v62
v_and_b32 v69, s23, v62
v_lshlrev_b32 v70, 16, v63
v_and_b32 v71, s23, v63
v_pk_fma_f32 v[240:241], v[64:65], v[8:9], v[240:241]
v_pk_fma_f32 v[242:243], v[66:67], v[8:9], v[242:243]
v_pk_fma_f32 v[248:249], v[68:69], v[8:9], v[248:249]
v_pk_fma_f32 v[250:251], v[70:71], v[8:9], v[250:251]
v_cvt_pk_bf16_f32 v240, v240, v241
v_cvt_pk_bf16_f32 v241, v242, v243
v_cvt_pk_bf16_f32 v242, v248, v249
v_cvt_pk_bf16_f32 v243, v250, v251
buffer_load_dwordx4 v115, s[36:39], s81 offen offset:3072 lds
v_accvgpr_read_b32 v32, a32
v_accvgpr_read_b32 v33, a33
v_accvgpr_read_b32 v34, a34
v_accvgpr_read_b32 v35, a35
v_lshlrev_b32 v64, 16, v32
v_and_b32 v65, s23, v32
v_lshlrev_b32 v66, 16, v33
v_and_b32 v67, s23, v33
v_lshlrev_b32 v68, 16, v34
v_and_b32 v69, s23, v34
v_lshlrev_b32 v70, 16, v35
v_and_b32 v71, s23, v35
v_pk_fma_f32 v[132:133], v[64:65], v[10:11], v[132:133]
v_pk_fma_f32 v[134:135], v[66:67], v[10:11], v[134:135]
v_pk_fma_f32 v[140:141], v[68:69], v[10:11], v[140:141]
v_pk_fma_f32 v[142:143], v[70:71], v[10:11], v[142:143]
v_cvt_pk_bf16_f32 v132, v132, v133
v_cvt_pk_bf16_f32 v133, v134, v135
v_cvt_pk_bf16_f32 v134, v140, v141
v_cvt_pk_bf16_f32 v135, v142, v143
s_sub_u32 s81, s81, 28544
s_add_u32 m0, s18, 131072
s_nop 0
buffer_load_dwordx4 v112, s[36:39], s81 offen offset:0 lds
v_accvgpr_read_b32 v36, a36
v_accvgpr_read_b32 v37, a37
v_accvgpr_read_b32 v38, a38
v_accvgpr_read_b32 v39, a39
v_lshlrev_b32 v64, 16, v36
v_and_b32 v65, s23, v36
v_lshlrev_b32 v66, 16, v37
v_and_b32 v67, s23, v37
v_lshlrev_b32 v68, 16, v38
v_and_b32 v69, s23, v38
v_lshlrev_b32 v70, 16, v39
v_and_b32 v71, s23, v39
v_pk_fma_f32 v[148:149], v[64:65], v[10:11], v[148:149]
v_pk_fma_f32 v[150:151], v[66:67], v[10:11], v[150:151]
v_pk_fma_f32 v[156:157], v[68:69], v[10:11], v[156:157]
v_pk_fma_f32 v[158:159], v[70:71], v[10:11], v[158:159]
v_cvt_pk_bf16_f32 v148, v148, v149
v_cvt_pk_bf16_f32 v149, v150, v151
v_cvt_pk_bf16_f32 v150, v156, v157
v_cvt_pk_bf16_f32 v151, v158, v159
buffer_load_dwordx4 v113, s[36:39], s81 offen offset:1024 lds
v_accvgpr_read_b32 v40, a40
v_accvgpr_read_b32 v41, a41
v_accvgpr_read_b32 v42, a42
v_accvgpr_read_b32 v43, a43
v_lshlrev_b32 v64, 16, v40
v_and_b32 v65, s23, v40
v_lshlrev_b32 v66, 16, v41
v_and_b32 v67, s23, v41
v_lshlrev_b32 v68, 16, v42
v_and_b32 v69, s23, v42
v_lshlrev_b32 v70, 16, v43
v_and_b32 v71, s23, v43
v_pk_fma_f32 v[164:165], v[64:65], v[10:11], v[164:165]
v_pk_fma_f32 v[166:167], v[66:67], v[10:11], v[166:167]
v_pk_fma_f32 v[172:173], v[68:69], v[10:11], v[172:173]
v_pk_fma_f32 v[174:175], v[70:71], v[10:11], v[174:175]
v_cvt_pk_bf16_f32 v164, v164, v165
v_cvt_pk_bf16_f32 v165, v166, v167
v_cvt_pk_bf16_f32 v166, v172, v173
v_cvt_pk_bf16_f32 v167, v174, v175
buffer_load_dwordx4 v114, s[36:39], s81 offen offset:2048 lds
v_accvgpr_read_b32 v44, a44
v_accvgpr_read_b32 v45, a45
v_accvgpr_read_b32 v46, a46
v_accvgpr_read_b32 v47, a47
v_lshlrev_b32 v64, 16, v44
v_and_b32 v65, s23, v44
v_lshlrev_b32 v66, 16, v45
v_and_b32 v67, s23, v45
v_lshlrev_b32 v68, 16, v46
v_and_b32 v69, s23, v46
v_lshlrev_b32 v70, 16, v47
v_and_b32 v71, s23, v47
v_pk_fma_f32 v[180:181], v[64:65], v[10:11], v[180:181]
v_pk_fma_f32 v[182:183], v[66:67], v[10:11], v[182:183]
v_pk_fma_f32 v[188:189], v[68:69], v[10:11], v[188:189]
v_pk_fma_f32 v[190:191], v[70:71], v[10:11], v[190:191]
v_cvt_pk_bf16_f32 v180, v180, v181
v_cvt_pk_bf16_f32 v181, v182, v183
v_cvt_pk_bf16_f32 v182, v188, v189
v_cvt_pk_bf16_f32 v183, v190, v191
buffer_load_dwordx4 v115, s[36:39], s81 offen offset:3072 lds
v_accvgpr_read_b32 v48, a48
v_accvgpr_read_b32 v49, a49
v_accvgpr_read_b32 v50, a50
v_accvgpr_read_b32 v51, a51
v_lshlrev_b32 v64, 16, v48
v_and_b32 v65, s23, v48
v_lshlrev_b32 v66, 16, v49
v_and_b32 v67, s23, v49
v_lshlrev_b32 v68, 16, v50
v_and_b32 v69, s23, v50
v_lshlrev_b32 v70, 16, v51
v_and_b32 v71, s23, v51
v_pk_fma_f32 v[196:197], v[64:65], v[10:11], v[196:197]
v_pk_fma_f32 v[198:199], v[66:67], v[10:11], v[198:199]
v_pk_fma_f32 v[204:205], v[68:69], v[10:11], v[204:205]
v_pk_fma_f32 v[206:207], v[70:71], v[10:11], v[206:207]
v_cvt_pk_bf16_f32 v196, v196, v197
v_cvt_pk_bf16_f32 v197, v198, v199
v_cvt_pk_bf16_f32 v198, v204, v205
v_cvt_pk_bf16_f32 v199, v206, v207
s_add_u32 s81, s81, 28672
s_add_u32 m0, s18, 135168
s_nop 0
buffer_load_dwordx4 v112, s[36:39], s81 offen offset:0 lds
v_accvgpr_read_b32 v52, a52
v_accvgpr_read_b32 v53, a53
v_accvgpr_read_b32 v54, a54
v_accvgpr_read_b32 v55, a55
v_lshlrev_b32 v64, 16, v52
v_and_b32 v65, s23, v52
v_lshlrev_b32 v66, 16, v53
v_and_b32 v67, s23, v53
v_lshlrev_b32 v68, 16, v54
v_and_b32 v69, s23, v54
v_lshlrev_b32 v70, 16, v55
v_and_b32 v71, s23, v55
v_pk_fma_f32 v[212:213], v[64:65], v[10:11], v[212:213]
v_pk_fma_f32 v[214:215], v[66:67], v[10:11], v[214:215]
v_pk_fma_f32 v[220:221], v[68:69], v[10:11], v[220:221]
v_pk_fma_f32 v[222:223], v[70:71], v[10:11], v[222:223]
v_cvt_pk_bf16_f32 v212, v212, v213
v_cvt_pk_bf16_f32 v213, v214, v215
v_cvt_pk_bf16_f32 v214, v220, v221
v_cvt_pk_bf16_f32 v215, v222, v223
buffer_load_dwordx4 v113, s[36:39], s81 offen offset:1024 lds
v_accvgpr_read_b32 v56, a56
v_accvgpr_read_b32 v57, a57
v_accvgpr_read_b32 v58, a58
v_accvgpr_read_b32 v59, a59
v_lshlrev_b32 v64, 16, v56
v_and_b32 v65, s23, v56
v_lshlrev_b32 v66, 16, v57
v_and_b32 v67, s23, v57
v_lshlrev_b32 v68, 16, v58
v_and_b32 v69, s23, v58
v_lshlrev_b32 v70, 16, v59
v_and_b32 v71, s23, v59
v_pk_fma_f32 v[228:229], v[64:65], v[10:11], v[228:229]
v_pk_fma_f32 v[230:231], v[66:67], v[10:11], v[230:231]
v_pk_fma_f32 v[236:237], v[68:69], v[10:11], v[236:237]
v_pk_fma_f32 v[238:239], v[70:71], v[10:11], v[238:239]
v_cvt_pk_bf16_f32 v228, v228, v229
v_cvt_pk_bf16_f32 v229, v230, v231
v_cvt_pk_bf16_f32 v230, v236, v237
v_cvt_pk_bf16_f32 v231, v238, v239
buffer_load_dwordx4 v114, s[36:39], s81 offen offset:2048 lds
v_accvgpr_read_b32 v60, a60
v_accvgpr_read_b32 v61, a61
v_accvgpr_read_b32 v62, a62
v_accvgpr_read_b32 v63, a63
v_lshlrev_b32 v64, 16, v60
v_and_b32 v65, s23, v60
v_lshlrev_b32 v66, 16, v61
v_and_b32 v67, s23, v61
v_lshlrev_b32 v68, 16, v62
v_and_b32 v69, s23, v62
v_lshlrev_b32 v70, 16, v63
v_and_b32 v71, s23, v63
v_pk_fma_f32 v[244:245], v[64:65], v[10:11], v[244:245]
v_pk_fma_f32 v[246:247], v[66:67], v[10:11], v[246:247]
v_pk_fma_f32 v[252:253], v[68:69], v[10:11], v[252:253]
v_pk_fma_f32 v[254:255], v[70:71], v[10:11], v[254:255]
v_cvt_pk_bf16_f32 v244, v244, v245
v_cvt_pk_bf16_f32 v245, v246, v247
v_cvt_pk_bf16_f32 v246, v252, v253
v_cvt_pk_bf16_f32 v247, v254, v255
buffer_load_dwordx4 v115, s[36:39], s81 offen offset:3072 lds
s_sub_u32 s81, s81, 28544
K2_done:
PAD_13:
s_cbranch_execz PAD_17
s_waitcnt vmcnt(16)
s_barrier
ds_read_b64_tr_b16 a[64:65], v116 offset:0
ds_read_b64_tr_b16 a[66:67], v116 offset:2048
ds_read_b64_tr_b16 a[68:69], v116 offset:4096
ds_read_b64_tr_b16 a[70:71], v116 offset:6144
ds_read_b64_tr_b16 a[72:73], v116 offset:8192
ds_read_b64_tr_b16 a[74:75], v116 offset:10240
ds_read_b64_tr_b16 a[76:77], v116 offset:12288
ds_read_b64_tr_b16 a[78:79], v116 offset:14336
ds_read_b64_tr_b16 a[80:81], v116 offset:16384
ds_read_b64_tr_b16 a[82:83], v116 offset:18432
ds_read_b64_tr_b16 a[84:85], v116 offset:20480
ds_read_b64_tr_b16 a[86:87], v116 offset:22528
ds_read_b64_tr_b16 a[88:89], v116 offset:24576
ds_read_b64_tr_b16 a[90:91], v116 offset:26624
ds_read_b64_tr_b16 a[92:93], v116 offset:28672
ds_read_b64_tr_b16 a[94:95], v116 offset:30720
v_add_u32 v116, 65536, v116
s_waitcnt lgkmcnt(14)
v_mfma_f32_16x16x32_bf16 v[32:35], a[64:67], v[128:131], 0
s_waitcnt lgkmcnt(12)
s_add_u32 m0, s18, 65536
ds_read_b64_tr_b16 a[96:97], v117 offset:0
v_mov_b32 v28, v24
v_mfma_f32_16x16x32_bf16 v[32:35], a[68:71], v[144:147], v[32:35]
s_waitcnt lgkmcnt(11)
ds_read_b64_tr_b16 a[98:99], v117 offset:2048
buffer_load_dwordx4 v112, s[36:39], s81 offen offset:0 lds
v_mfma_f32_16x16x32_bf16 v[32:35], a[72:75], v[160:163], v[32:35]
s_waitcnt lgkmcnt(10)
ds_read_b64_tr_b16 a[100:101], v117 offset:4096
v_permlane16_swap_b32 v24, v28
v_mfma_f32_16x16x32_bf16 v[32:35], a[76:79], v[176:179], v[32:35]
s_waitcnt lgkmcnt(9)
ds_read_b64_tr_b16 a[102:103], v117 offset:6144
v_add_f32 v24, v24, v28
v_mfma_f32_16x16x32_bf16 v[32:35], a[80:83], v[192:195], v[32:35]
s_waitcnt lgkmcnt(8)
ds_read_b64_tr_b16 a[104:105], v117 offset:8192
buffer_load_dwordx4 v113, s[36:39], s81 offen offset:1024 lds
v_mfma_f32_16x16x32_bf16 v[32:35], a[84:87], v[208:211], v[32:35]
s_waitcnt lgkmcnt(7)
ds_read_b64_tr_b16 a[106:107], v117 offset:10240
v_mov_b32 v28, v24
v_mfma_f32_16x16x32_bf16 v[32:35], a[88:91], v[224:227], v[32:35]
s_waitcnt lgkmcnt(6)
ds_read_b64_tr_b16 a[108:109], v117 offset:12288
v_lshrrev_b32 v20, 4, v1
v_mfma_f32_16x16x32_bf16 v[32:35], a[92:95], v[240:243], v[32:35]
ds_read_b64_tr_b16 a[110:111], v117 offset:14336
buffer_load_dwordx4 v114, s[36:39], s81 offen offset:2048 lds
v_mfma_f32_16x16x32_bf16 v[36:39], a[64:67], v[132:135], 0
ds_read_b64_tr_b16 a[112:113], v117 offset:16384
v_permlane32_swap_b32 v24, v28
v_mfma_f32_16x16x32_bf16 v[36:39], a[68:71], v[148:151], v[36:39]
ds_read_b64_tr_b16 a[114:115], v117 offset:18432
v_add_f32 v24, v24, v28
v_mfma_f32_16x16x32_bf16 v[36:39], a[72:75], v[164:167], v[36:39]
ds_read_b64_tr_b16 a[116:117], v117 offset:20480
buffer_load_dwordx4 v115, s[36:39], s81 offen offset:3072 lds
v_mfma_f32_16x16x32_bf16 v[36:39], a[76:79], v[180:183], v[36:39]
PAD_14:
s_cbranch_execz PAD_18
ds_read_b64_tr_b16 a[118:119], v117 offset:22528
v_mov_b32 v29, v25
v_mfma_f32_16x16x32_bf16 v[36:39], a[80:83], v[196:199], v[36:39]
s_add_u32 s81, s81, 28672
s_add_u32 m0, s18, 69632
ds_read_b64_tr_b16 a[120:121], v117 offset:24576
v_mfma_f32_16x16x32_bf16 v[36:39], a[84:87], v[212:215], v[36:39]
ds_read_b64_tr_b16 a[122:123], v117 offset:26624
buffer_load_dwordx4 v112, s[36:39], s81 offen offset:0 lds
v_mfma_f32_16x16x32_bf16 v[36:39], a[88:91], v[228:231], v[36:39]
ds_read_b64_tr_b16 a[124:125], v117 offset:28672
v_permlane16_swap_b32 v25, v29
v_mfma_f32_16x16x32_bf16 v[36:39], a[92:95], v[244:247], v[36:39]
s_waitcnt lgkmcnt(8)
ds_read_b64_tr_b16 a[126:127], v117 offset:30720
v_add_u32 v117, 65536, v117
v_mfma_f32_16x16x32_bf16 v[40:43], a[96:99], v[128:131], 0
ds_read_b64_tr_b16 a[64:65], v118 offset:0
buffer_load_dwordx4 v113, s[36:39], s81 offen offset:1024 lds
v_mfma_f32_16x16x32_bf16 v[40:43], a[100:103], v[144:147], v[40:43]
ds_read_b64_tr_b16 a[66:67], v118 offset:2048
v_add_f32 v25, v25, v29
v_mfma_f32_16x16x32_bf16 v[40:43], a[104:107], v[160:163], v[40:43]
s_waitcnt lgkmcnt(8)
ds_read_b64_tr_b16 a[68:69], v118 offset:4096
v_mov_b32 v29, v25
v_mfma_f32_16x16x32_bf16 v[40:43], a[108:111], v[176:179], v[40:43]
ds_read_b64_tr_b16 a[70:71], v118 offset:6144
buffer_load_dwordx4 v114, s[36:39], s81 offen offset:2048 lds
v_mfma_f32_16x16x32_bf16 v[40:43], a[112:115], v[192:195], v[40:43]
s_waitcnt lgkmcnt(8)
ds_read_b64_tr_b16 a[72:73], v118 offset:8192
v_permlane32_swap_b32 v25, v29
v_mfma_f32_16x16x32_bf16 v[40:43], a[116:119], v[208:211], v[40:43]
s_waitcnt lgkmcnt(7)
ds_read_b64_tr_b16 a[74:75], v118 offset:10240
v_add_f32 v25, v25, v29
v_mfma_f32_16x16x32_bf16 v[40:43], a[120:123], v[224:227], v[40:43]
s_waitcnt lgkmcnt(6)
ds_read_b64_tr_b16 a[76:77], v118 offset:12288
buffer_load_dwordx4 v115, s[36:39], s81 offen offset:3072 lds
v_mfma_f32_16x16x32_bf16 v[40:43], a[124:127], v[240:243], v[40:43]
ds_read_b64_tr_b16 a[78:79], v118 offset:14336
v_rcp_f32 v24, v24
v_mfma_f32_16x16x32_bf16 v[44:47], a[96:99], v[132:135], 0
s_sub_u32 s81, s81, 28544
s_add_u32 m0, s18, 0
ds_read_b64_tr_b16 a[80:81], v118 offset:16384
v_mfma_f32_16x16x32_bf16 v[44:47], a[100:103], v[148:151], v[44:47]
ds_read_b64_tr_b16 a[82:83], v118 offset:18432
buffer_load_dwordx4 v112, s[36:39], s81 offen offset:0 lds
v_mfma_f32_16x16x32_bf16 v[44:47], a[104:107], v[164:167], v[44:47]
ds_read_b64_tr_b16 a[84:85], v118 offset:20480
v_rcp_f32 v25, v25
v_mfma_f32_16x16x32_bf16 v[44:47], a[108:111], v[180:183], v[44:47]
ds_read_b64_tr_b16 a[86:87], v118 offset:22528
v_and_b32 v19, 15, v20
v_mfma_f32_16x16x32_bf16 v[44:47], a[112:115], v[196:199], v[44:47]
ds_read_b64_tr_b16 a[88:89], v118 offset:24576
buffer_load_dwordx4 v113, s[36:39], s81 offen offset:1024 lds
v_mfma_f32_16x16x32_bf16 v[44:47], a[116:119], v[212:215], v[44:47]
ds_read_b64_tr_b16 a[90:91], v118 offset:26624
v_mul_f32 v32, v32, v24
v_mfma_f32_16x16x32_bf16 v[44:47], a[120:123], v[228:231], v[44:47]
ds_read_b64_tr_b16 a[92:93], v118 offset:28672
v_mul_f32 v33, v33, v24
v_mfma_f32_16x16x32_bf16 v[44:47], a[124:127], v[244:247], v[44:47]
s_waitcnt lgkmcnt(8)
ds_read_b64_tr_b16 a[94:95], v118 offset:30720
v_add_u32 v118, 65536, v118
v_mfma_f32_16x16x32_bf16 v[48:51], a[64:67], v[128:131], 0
ds_read_b64_tr_b16 a[96:97], v119 offset:0
buffer_load_dwordx4 v114, s[36:39], s81 offen offset:2048 lds
v_mfma_f32_16x16x32_bf16 v[48:51], a[68:71], v[144:147], v[48:51]
ds_read_b64_tr_b16 a[98:99], v119 offset:2048
v_mul_f32 v34, v34, v24
v_mfma_f32_16x16x32_bf16 v[48:51], a[72:75], v[160:163], v[48:51]
s_waitcnt lgkmcnt(8)
ds_read_b64_tr_b16 a[100:101], v119 offset:4096
v_mul_f32 v35, v35, v24
v_mfma_f32_16x16x32_bf16 v[48:51], a[76:79], v[176:179], v[48:51]
ds_read_b64_tr_b16 a[102:103], v119 offset:6144
buffer_load_dwordx4 v115, s[36:39], s81 offen offset:3072 lds
v_mfma_f32_16x16x32_bf16 v[48:51], a[80:83], v[192:195], v[48:51]
s_waitcnt lgkmcnt(6)
ds_read_b64_tr_b16 a[104:105], v119 offset:8192
v_mul_f32 v40, v40, v24
v_mfma_f32_16x16x32_bf16 v[48:51], a[84:87], v[208:211], v[48:51]
s_add_u32 s81, s81, 28672
s_add_u32 m0, s18, 4096
ds_read_b64_tr_b16 a[106:107], v119 offset:10240
v_mfma_f32_16x16x32_bf16 v[48:51], a[88:91], v[224:227], v[48:51]
s_waitcnt lgkmcnt(6)
ds_read_b64_tr_b16 a[108:109], v119 offset:12288
buffer_load_dwordx4 v112, s[36:39], s81 offen offset:0 lds
v_mfma_f32_16x16x32_bf16 v[48:51], a[92:95], v[240:243], v[48:51]
ds_read_b64_tr_b16 a[110:111], v119 offset:14336
v_mul_f32 v41, v41, v24
v_mfma_f32_16x16x32_bf16 v[52:55], a[64:67], v[132:135], 0
ds_read_b64_tr_b16 a[112:113], v119 offset:16384
v_mul_f32 v42, v42, v24
v_mfma_f32_16x16x32_bf16 v[52:55], a[68:71], v[148:151], v[52:55]
ds_read_b64_tr_b16 a[114:115], v119 offset:18432
buffer_load_dwordx4 v113, s[36:39], s81 offen offset:1024 lds
v_mfma_f32_16x16x32_bf16 v[52:55], a[72:75], v[164:167], v[52:55]
ds_read_b64_tr_b16 a[116:117], v119 offset:20480
v_mul_f32 v43, v43, v24
v_mfma_f32_16x16x32_bf16 v[52:55], a[76:79], v[180:183], v[52:55]
ds_read_b64_tr_b16 a[118:119], v119 offset:22528
v_cvt_pk_bf16_f32 v32, v32, v33
v_mfma_f32_16x16x32_bf16 v[52:55], a[80:83], v[196:199], v[52:55]
ds_read_b64_tr_b16 a[120:121], v119 offset:24576
buffer_load_dwordx4 v114, s[36:39], s81 offen offset:2048 lds
v_mfma_f32_16x16x32_bf16 v[52:55], a[84:87], v[212:215], v[52:55]
ds_read_b64_tr_b16 a[122:123], v119 offset:26624
v_cvt_pk_bf16_f32 v33, v34, v35
v_mfma_f32_16x16x32_bf16 v[52:55], a[88:91], v[228:231], v[52:55]
ds_read_b64_tr_b16 a[124:125], v119 offset:28672
ds_read_b64_tr_b16 a[126:127], v119 offset:30720
v_mfma_f32_16x16x32_bf16 v[52:55], a[92:95], v[244:247], v[52:55]
s_waitcnt vmcnt(23) lgkmcnt(9)
s_barrier
v_add_u32 v119, 65536, v119
v_mfma_f32_16x16x32_bf16 v[56:59], a[96:99], v[128:131], 0
ds_read_b64_tr_b16 a[64:65], v116 offset:0
buffer_load_dwordx4 v115, s[36:39], s81 offen offset:3072 lds
v_mfma_f32_16x16x32_bf16 v[56:59], a[100:103], v[144:147], v[56:59]
s_waitcnt lgkmcnt(8)
ds_read_b64_tr_b16 a[66:67], v116 offset:2048
v_cvt_pk_bf16_f32 v34, v40, v41
v_mfma_f32_16x16x32_bf16 v[56:59], a[104:107], v[160:163], v[56:59]
s_sub_u32 s81, s81, 28544
ds_read_b64_tr_b16 a[68:69], v116 offset:4096
v_cvt_pk_bf16_f32 v35, v42, v43
v_mfma_f32_16x16x32_bf16 v[56:59], a[108:111], v[176:179], v[56:59]
s_waitcnt lgkmcnt(8)
ds_read_b64_tr_b16 a[70:71], v116 offset:6144
buffer_store_dwordx4 v[32:35], v1, s[4:7], s8 offen offset:0 sc1
v_mfma_f32_16x16x32_bf16 v[56:59], a[112:115], v[192:195], v[56:59]
s_waitcnt lgkmcnt(8)
ds_read_b64_tr_b16 a[72:73], v116 offset:8192
v_mul_f32 v36, v36, v25
v_mfma_f32_16x16x32_bf16 v[56:59], a[116:119], v[208:211], v[56:59]
s_waitcnt lgkmcnt(7)
ds_read_b64_tr_b16 a[74:75], v116 offset:10240
v_mul_f32 v37, v37, v25
v_mfma_f32_16x16x32_bf16 v[56:59], a[120:123], v[224:227], v[56:59]
s_waitcnt lgkmcnt(6)
ds_read_b64_tr_b16 a[76:77], v116 offset:12288
v_mul_f32 v38, v38, v25
v_mfma_f32_16x16x32_bf16 v[56:59], a[124:127], v[240:243], v[56:59]
ds_read_b64_tr_b16 a[78:79], v116 offset:14336
v_mul_f32 v39, v39, v25
v_mfma_f32_16x16x32_bf16 v[60:63], a[96:99], v[132:135], 0
ds_read_b64_tr_b16 a[80:81], v116 offset:16384
v_mul_f32 v44, v44, v25
v_mfma_f32_16x16x32_bf16 v[60:63], a[100:103], v[148:151], v[60:63]
ds_read_b64_tr_b16 a[82:83], v116 offset:18432
v_mul_f32 v45, v45, v25
v_mfma_f32_16x16x32_bf16 v[60:63], a[104:107], v[164:167], v[60:63]
ds_read_b64_tr_b16 a[84:85], v116 offset:20480
v_mul_f32 v46, v46, v25
v_mfma_f32_16x16x32_bf16 v[60:63], a[108:111], v[180:183], v[60:63]
ds_read_b64_tr_b16 a[86:87], v116 offset:22528
v_mul_f32 v47, v47, v25
v_mfma_f32_16x16x32_bf16 v[60:63], a[112:115], v[196:199], v[60:63]
ds_read_b64_tr_b16 a[88:89], v116 offset:24576
v_cvt_pk_bf16_f32 v36, v36, v37
v_mfma_f32_16x16x32_bf16 v[60:63], a[116:119], v[212:215], v[60:63]
ds_read_b64_tr_b16 a[90:91], v116 offset:26624
v_cvt_pk_bf16_f32 v37, v38, v39
v_mfma_f32_16x16x32_bf16 v[60:63], a[120:123], v[228:231], v[60:63]
ds_read_b64_tr_b16 a[92:93], v116 offset:28672
v_cvt_pk_bf16_f32 v38, v44, v45
v_mfma_f32_16x16x32_bf16 v[60:63], a[124:127], v[244:247], v[60:63]
s_waitcnt lgkmcnt(3)
ds_read_b64_tr_b16 a[94:95], v116 offset:30720
v_add_u32 v116, 32768, v116
v_mfma_f32_16x16x32_bf16 v[64:67], a[64:67], v[128:131], 0
s_lshl_b32 s34, s29, 5
ds_read_b64_tr_b16 a[96:97], v117 offset:0
v_cvt_pk_bf16_f32 v39, v46, v47
v_mfma_f32_16x16x32_bf16 v[64:67], a[68:71], v[144:147], v[64:67]
s_add_u32 s34, s34, s20
ds_read_b64_tr_b16 a[98:99], v117 offset:2048
buffer_store_dwordx4 v[36:39], v1, s[4:7], s12 offen offset:0 sc1
v_mfma_f32_16x16x32_bf16 v[64:67], a[72:75], v[160:163], v[64:67]
s_lshl_b32 s34, s34, 2
ds_read_b64_tr_b16 a[100:101], v117 offset:4096
v_mul_f32 v48, v48, v24
v_mfma_f32_16x16x32_bf16 v[64:67], a[76:79], v[176:179], v[64:67]
s_add_u32 s34, s34, 94380032
ds_read_b64_tr_b16 a[102:103], v117 offset:6144
v_mul_f32 v49, v49, v24
v_mfma_f32_16x16x32_bf16 v[64:67], a[80:83], v[192:195], v[64:67]
s_add_u32 s35, s34, 2048
ds_read_b64_tr_b16 a[104:105], v117 offset:8192
v_mul_f32 v50, v50, v24
v_mfma_f32_16x16x32_bf16 v[64:67], a[84:87], v[208:211], v[64:67]
s_waitcnt lgkmcnt(5)
s_mov_b32 s80, s21
ds_read_b64_tr_b16 a[106:107], v117 offset:10240
v_mul_f32 v51, v51, v24
v_mfma_f32_16x16x32_bf16 v[64:67], a[88:91], v[224:227], v[64:67]
s_and_b32 s79, s2, 16
ds_read_b64_tr_b16 a[108:109], v117 offset:12288
v_mul_f32 v56, v56, v24
v_mfma_f32_16x16x32_bf16 v[64:67], a[92:95], v[240:243], v[64:67]
s_xor_b32 s79, s79, 16
ds_read_b64_tr_b16 a[110:111], v117 offset:14336
v_mul_f32 v57, v57, v24
v_mfma_f32_16x16x32_bf16 v[68:71], a[64:67], v[132:135], 0
s_add_u32 s79, s79, s20
ds_read_b64_tr_b16 a[112:113], v117 offset:16384
v_mul_f32 v58, v58, v24
v_mfma_f32_16x16x32_bf16 v[68:71], a[68:71], v[148:151], v[68:71]
s_lshl_b32 s22, s79, 2
ds_read_b64_tr_b16 a[114:115], v117 offset:18432
v_mul_f32 v59, v59, v24
v_mfma_f32_16x16x32_bf16 v[68:71], a[72:75], v[164:167], v[68:71]
s_add_u32 s22, s22, s3
ds_read_b64_tr_b16 a[116:117], v117 offset:20480
v_cvt_pk_bf16_f32 v48, v48, v49
v_mfma_f32_16x16x32_bf16 v[68:71], a[76:79], v[180:183], v[68:71]
s_mul_i32 s25, s22, 28672
ds_read_b64_tr_b16 a[118:119], v117 offset:22528
v_cvt_pk_bf16_f32 v49, v50, v51
v_mfma_f32_16x16x32_bf16 v[68:71], a[80:83], v[196:199], v[68:71]
s_lshl_b32 s23, s80, 6
ds_read_b64_tr_b16 a[120:121], v117 offset:24576
v_cvt_pk_bf16_f32 v50, v56, v57
v_mfma_f32_16x16x32_bf16 v[68:71], a[84:87], v[212:215], v[68:71]
s_add_u32 s25, s25, s23
ds_read_b64_tr_b16 a[122:123], v117 offset:26624
v_cvt_pk_bf16_f32 v51, v58, v59
v_mfma_f32_16x16x32_bf16 v[68:71], a[88:91], v[228:231], v[68:71]
s_mul_i32 s26, s22, 229376
ds_read_b64_tr_b16 a[124:125], v117 offset:28672
buffer_store_dwordx4 v[48:51], v1, s[4:7], s8 offen offset:1024 sc1
v_mfma_f32_16x16x32_bf16 v[68:71], a[92:95], v[244:247], v[68:71]
s_waitcnt lgkmcnt(3)
s_lshl_b32 s23, s80, 10
ds_read_b64_tr_b16 a[126:127], v117 offset:30720
v_add_u32 v117, 32768, v117
v_mfma_f32_16x16x32_bf16 v[72:75], a[96:99], v[128:131], 0
s_add_u32 s26, s26, s23
ds_read_b64_tr_b16 a[64:65], v118 offset:0
v_mul_f32 v52, v52, v25
v_mfma_f32_16x16x32_bf16 v[72:75], a[100:103], v[144:147], v[72:75]
s_add_u32 s26, s26, 104857600
ds_read_b64_tr_b16 a[66:67], v118 offset:2048
v_mul_f32 v53, v53, v25
v_mfma_f32_16x16x32_bf16 v[72:75], a[104:107], v[160:163], v[72:75]
s_lshr_b32 s22, s79, 1
ds_read_b64_tr_b16 a[68:69], v118 offset:4096
v_mul_f32 v54, v54, v25
v_mfma_f32_16x16x32_bf16 v[72:75], a[108:111], v[176:179], v[72:75]
s_lshl_b32 s22, s22, 7
ds_read_b64_tr_b16 a[70:71], v118 offset:6144
v_mul_f32 v55, v55, v25
v_mfma_f32_16x16x32_bf16 v[72:75], a[112:115], v[192:195], v[72:75]
s_add_u32 s33, s22, 94380032
ds_read_b64_tr_b16 a[72:73], v118 offset:8192
v_mul_f32 v60, v60, v25
v_mfma_f32_16x16x32_bf16 v[72:75], a[116:119], v[208:211], v[72:75]
s_waitcnt lgkmcnt(5)
s_mov_b64 s[40:41], s[88:89]
ds_read_b64_tr_b16 a[74:75], v118 offset:10240
v_mul_f32 v61, v61, v25
v_mfma_f32_16x16x32_bf16 v[72:75], a[120:123], v[224:227], v[72:75]
s_mov_b32 s42, 3670016
ds_read_b64_tr_b16 a[76:77], v118 offset:12288
v_mul_f32 v62, v62, v25
v_mfma_f32_16x16x32_bf16 v[72:75], a[124:127], v[240:243], v[72:75]
s_mov_b32 s43, 0x20000
ds_read_b64_tr_b16 a[78:79], v118 offset:14336
v_mul_f32 v63, v63, v25
v_mfma_f32_16x16x32_bf16 v[76:79], a[96:99], v[132:135], 0
ds_read_b64_tr_b16 a[80:81], v118 offset:16384
v_cvt_pk_bf16_f32 v52, v52, v53
v_mfma_f32_16x16x32_bf16 v[76:79], a[100:103], v[148:151], v[76:79]
ds_read_b64_tr_b16 a[82:83], v118 offset:18432
v_cvt_pk_bf16_f32 v53, v54, v55
v_mfma_f32_16x16x32_bf16 v[76:79], a[104:107], v[164:167], v[76:79]
ds_read_b64_tr_b16 a[84:85], v118 offset:20480
v_cvt_pk_bf16_f32 v54, v60, v61
v_mfma_f32_16x16x32_bf16 v[76:79], a[108:111], v[180:183], v[76:79]
ds_read_b64_tr_b16 a[86:87], v118 offset:22528
v_cvt_pk_bf16_f32 v55, v62, v63
v_mfma_f32_16x16x32_bf16 v[76:79], a[112:115], v[196:199], v[76:79]
ds_read_b64_tr_b16 a[88:89], v118 offset:24576
buffer_store_dwordx4 v[52:55], v1, s[4:7], s12 offen offset:1024 sc1
v_mfma_f32_16x16x32_bf16 v[76:79], a[116:119], v[212:215], v[76:79]
ds_read_b64_tr_b16 a[90:91], v118 offset:26624
v_mfma_f32_16x16x32_bf16 v[76:79], a[120:123], v[228:231], v[76:79]
ds_read_b64_tr_b16 a[92:93], v118 offset:28672
v_mul_f32 v64, v64, v24
v_mfma_f32_16x16x32_bf16 v[76:79], a[124:127], v[244:247], v[76:79]
s_waitcnt lgkmcnt(8)
ds_read_b64_tr_b16 a[94:95], v118 offset:30720
v_add_u32 v118, 32768, v118
v_mfma_f32_16x16x32_bf16 v[80:83], a[64:67], v[128:131], 0
ds_read_b64_tr_b16 a[96:97], v119 offset:0
v_mul_f32 v65, v65, v24
v_mfma_f32_16x16x32_bf16 v[80:83], a[68:71], v[144:147], v[80:83]
ds_read_b64_tr_b16 a[98:99], v119 offset:2048
v_mul_f32 v66, v66, v24
v_mfma_f32_16x16x32_bf16 v[80:83], a[72:75], v[160:163], v[80:83]
s_waitcnt lgkmcnt(8)
ds_read_b64_tr_b16 a[100:101], v119 offset:4096
v_mul_f32 v67, v67, v24
v_mfma_f32_16x16x32_bf16 v[80:83], a[76:79], v[176:179], v[80:83]
ds_read_b64_tr_b16 a[102:103], v119 offset:6144
v_mul_f32 v72, v72, v24
v_mfma_f32_16x16x32_bf16 v[80:83], a[80:83], v[192:195], v[80:83]
s_waitcnt lgkmcnt(8)
ds_read_b64_tr_b16 a[104:105], v119 offset:8192
v_mul_f32 v73, v73, v24
v_mfma_f32_16x16x32_bf16 v[80:83], a[84:87], v[208:211], v[80:83]
s_waitcnt lgkmcnt(7)
ds_read_b64_tr_b16 a[106:107], v119 offset:10240
v_mul_f32 v74, v74, v24
v_mfma_f32_16x16x32_bf16 v[80:83], a[88:91], v[224:227], v[80:83]
s_waitcnt lgkmcnt(6)
ds_read_b64_tr_b16 a[108:109], v119 offset:12288
v_mul_f32 v75, v75, v24
v_mfma_f32_16x16x32_bf16 v[80:83], a[92:95], v[240:243], v[80:83]
ds_read_b64_tr_b16 a[110:111], v119 offset:14336
v_cvt_pk_bf16_f32 v64, v64, v65
v_mfma_f32_16x16x32_bf16 v[84:87], a[64:67], v[132:135], 0
ds_read_b64_tr_b16 a[112:113], v119 offset:16384
v_cvt_pk_bf16_f32 v65, v66, v67
v_mfma_f32_16x16x32_bf16 v[84:87], a[68:71], v[148:151], v[84:87]
ds_read_b64_tr_b16 a[114:115], v119 offset:18432
v_cvt_pk_bf16_f32 v66, v72, v73
v_mfma_f32_16x16x32_bf16 v[84:87], a[72:75], v[164:167], v[84:87]
ds_read_b64_tr_b16 a[116:117], v119 offset:20480
v_cvt_pk_bf16_f32 v67, v74, v75
v_mfma_f32_16x16x32_bf16 v[84:87], a[76:79], v[180:183], v[84:87]
ds_read_b64_tr_b16 a[118:119], v119 offset:22528
buffer_store_dwordx4 v[64:67], v1, s[4:7], s8 offen offset:2048 sc1
v_mfma_f32_16x16x32_bf16 v[84:87], a[80:83], v[196:199], v[84:87]
ds_read_b64_tr_b16 a[120:121], v119 offset:24576
v_mul_f32 v68, v68, v25
v_mfma_f32_16x16x32_bf16 v[84:87], a[84:87], v[212:215], v[84:87]
ds_read_b64_tr_b16 a[122:123], v119 offset:26624
v_mul_f32 v69, v69, v25
v_mfma_f32_16x16x32_bf16 v[84:87], a[88:91], v[228:231], v[84:87]
ds_read_b64_tr_b16 a[124:125], v119 offset:28672
ds_read_b64_tr_b16 a[126:127], v119 offset:30720
v_mfma_f32_16x16x32_bf16 v[84:87], a[92:95], v[244:247], v[84:87]
s_waitcnt vmcnt(21) lgkmcnt(9)
s_barrier
v_add_u32 v119, 32768, v119
v_mfma_f32_16x16x32_bf16 v[88:91], a[96:99], v[128:131], 0
ds_read_b64_tr_b16 a[64:65], v116 offset:0
v_mul_f32 v70, v70, v25
v_mfma_f32_16x16x32_bf16 v[88:91], a[100:103], v[144:147], v[88:91]
ds_read_b64_tr_b16 a[66:67], v116 offset:2048
v_mul_f32 v71, v71, v25
v_mfma_f32_16x16x32_bf16 v[88:91], a[104:107], v[160:163], v[88:91]
s_waitcnt lgkmcnt(8)
ds_read_b64_tr_b16 a[68:69], v116 offset:4096
v_mul_f32 v76, v76, v25
v_mfma_f32_16x16x32_bf16 v[88:91], a[108:111], v[176:179], v[88:91]
ds_read_b64_tr_b16 a[70:71], v116 offset:6144
v_mul_f32 v77, v77, v25
v_mfma_f32_16x16x32_bf16 v[88:91], a[112:115], v[192:195], v[88:91]
s_waitcnt lgkmcnt(8)
ds_read_b64_tr_b16 a[72:73], v116 offset:8192
v_mul_f32 v78, v78, v25
v_mfma_f32_16x16x32_bf16 v[88:91], a[116:119], v[208:211], v[88:91]
s_waitcnt lgkmcnt(7)
ds_read_b64_tr_b16 a[74:75], v116 offset:10240
v_mul_f32 v79, v79, v25
v_mfma_f32_16x16x32_bf16 v[88:91], a[120:123], v[224:227], v[88:91]
s_waitcnt lgkmcnt(6)
ds_read_b64_tr_b16 a[76:77], v116 offset:12288
v_cvt_pk_bf16_f32 v68, v68, v69
v_mfma_f32_16x16x32_bf16 v[88:91], a[124:127], v[240:243], v[88:91]
ds_read_b64_tr_b16 a[78:79], v116 offset:14336
v_cvt_pk_bf16_f32 v69, v70, v71
v_mfma_f32_16x16x32_bf16 v[92:95], a[96:99], v[132:135], 0
ds_read_b64_tr_b16 a[80:81], v116 offset:16384
v_cvt_pk_bf16_f32 v70, v76, v77
v_mfma_f32_16x16x32_bf16 v[92:95], a[100:103], v[148:151], v[92:95]
ds_read_b64_tr_b16 a[82:83], v116 offset:18432
v_cvt_pk_bf16_f32 v71, v78, v79
v_mfma_f32_16x16x32_bf16 v[92:95], a[104:107], v[164:167], v[92:95]
ds_read_b64_tr_b16 a[84:85], v116 offset:20480
buffer_store_dwordx4 v[68:71], v1, s[4:7], s12 offen offset:2048 sc1
v_mfma_f32_16x16x32_bf16 v[92:95], a[108:111], v[180:183], v[92:95]
ds_read_b64_tr_b16 a[86:87], v116 offset:22528
v_mfma_f32_16x16x32_bf16 v[92:95], a[112:115], v[196:199], v[92:95]
ds_read_b64_tr_b16 a[88:89], v116 offset:24576
v_mfma_f32_16x16x32_bf16 v[92:95], a[116:119], v[212:215], v[92:95]
ds_read_b64_tr_b16 a[90:91], v116 offset:26624
v_mfma_f32_16x16x32_bf16 v[92:95], a[120:123], v[228:231], v[92:95]
ds_read_b64_tr_b16 a[92:93], v116 offset:28672
v_mfma_f32_16x16x32_bf16 v[92:95], a[124:127], v[244:247], v[92:95]
s_waitcnt lgkmcnt(8)
ds_read_b64_tr_b16 a[94:95], v116 offset:30720
v_add_u32 v116, 4294901760, v116
v_mfma_f32_16x16x32_bf16 v[32:35], a[64:67], v[128:131], 0
s_add_u32 m0, s18, 32768
ds_read_b64_tr_b16 a[96:97], v117 offset:0
v_mul_f32 v80, v80, v24
v_mfma_f32_16x16x32_bf16 v[32:35], a[68:71], v[144:147], v[32:35]
ds_read_b64_tr_b16 a[98:99], v117 offset:2048
buffer_load_dwordx4 v112, s[36:39], s81 offen offset:0 lds
v_mfma_f32_16x16x32_bf16 v[32:35], a[72:75], v[160:163], v[32:35]
s_waitcnt lgkmcnt(8)
ds_read_b64_tr_b16 a[100:101], v117 offset:4096
v_mul_f32 v81, v81, v24
v_mfma_f32_16x16x32_bf16 v[32:35], a[76:79], v[176:179], v[32:35]
ds_read_b64_tr_b16 a[102:103], v117 offset:6144
v_mul_f32 v82, v82, v24
v_mfma_f32_16x16x32_bf16 v[32:35], a[80:83], v[192:195], v[32:35]
s_waitcnt lgkmcnt(8)
ds_read_b64_tr_b16 a[104:105], v117 offset:8192
v_mul_f32 v83, v83, v24
v_mfma_f32_16x16x32_bf16 v[32:35], a[84:87], v[208:211], v[32:35]
s_waitcnt lgkmcnt(7)
ds_read_b64_tr_b16 a[106:107], v117 offset:10240
v_mul_f32 v88, v88, v24
v_mfma_f32_16x16x32_bf16 v[32:35], a[88:91], v[224:227], v[32:35]
s_waitcnt lgkmcnt(6)
ds_read_b64_tr_b16 a[108:109], v117 offset:12288
v_mul_f32 v89, v89, v24
v_mfma_f32_16x16x32_bf16 v[32:35], a[92:95], v[240:243], v[32:35]
ds_read_b64_tr_b16 a[110:111], v117 offset:14336
v_mul_f32 v90, v90, v24
v_mfma_f32_16x16x32_bf16 v[36:39], a[64:67], v[132:135], 0
ds_read_b64_tr_b16 a[112:113], v117 offset:16384
buffer_load_dwordx4 v113, s[36:39], s81 offen offset:1024 lds
v_mfma_f32_16x16x32_bf16 v[36:39], a[68:71], v[148:151], v[36:39]
ds_read_b64_tr_b16 a[114:115], v117 offset:18432
v_mul_f32 v91, v91, v24
v_mfma_f32_16x16x32_bf16 v[36:39], a[72:75], v[164:167], v[36:39]
ds_read_b64_tr_b16 a[116:117], v117 offset:20480
v_cvt_pk_bf16_f32 v80, v80, v81
v_mfma_f32_16x16x32_bf16 v[36:39], a[76:79], v[180:183], v[36:39]
ds_read_b64_tr_b16 a[118:119], v117 offset:22528
v_cvt_pk_bf16_f32 v81, v82, v83
v_mfma_f32_16x16x32_bf16 v[36:39], a[80:83], v[196:199], v[36:39]
ds_read_b64_tr_b16 a[120:121], v117 offset:24576
v_cvt_pk_bf16_f32 v82, v88, v89
v_mfma_f32_16x16x32_bf16 v[36:39], a[84:87], v[212:215], v[36:39]
ds_read_b64_tr_b16 a[122:123], v117 offset:26624
v_cvt_pk_bf16_f32 v83, v90, v91
v_mfma_f32_16x16x32_bf16 v[36:39], a[88:91], v[228:231], v[36:39]
ds_read_b64_tr_b16 a[124:125], v117 offset:28672
buffer_store_dwordx4 v[80:83], v1, s[4:7], s8 offen offset:3072 sc1
v_mfma_f32_16x16x32_bf16 v[36:39], a[92:95], v[244:247], v[36:39]
s_waitcnt lgkmcnt(8)
ds_read_b64_tr_b16 a[126:127], v117 offset:30720
v_add_u32 v117, 4294901760, v117
v_mfma_f32_16x16x32_bf16 v[40:43], a[96:99], v[128:131], 0
ds_read_b64_tr_b16 a[64:65], v118 offset:0
buffer_load_dwordx4 v114, s[36:39], s81 offen offset:2048 lds
v_mfma_f32_16x16x32_bf16 v[40:43], a[100:103], v[144:147], v[40:43]
ds_read_b64_tr_b16 a[66:67], v118 offset:2048
v_mul_f32 v84, v84, v25
v_mfma_f32_16x16x32_bf16 v[40:43], a[104:107], v[160:163], v[40:43]
s_waitcnt lgkmcnt(8)
ds_read_b64_tr_b16 a[68:69], v118 offset:4096
v_mul_f32 v85, v85, v25
v_mfma_f32_16x16x32_bf16 v[40:43], a[108:111], v[176:179], v[40:43]
ds_read_b64_tr_b16 a[70:71], v118 offset:6144
v_mul_f32 v86, v86, v25
v_mfma_f32_16x16x32_bf16 v[40:43], a[112:115], v[192:195], v[40:43]
s_waitcnt lgkmcnt(8)
ds_read_b64_tr_b16 a[72:73], v118 offset:8192
v_mul_f32 v87, v87, v25
v_mfma_f32_16x16x32_bf16 v[40:43], a[116:119], v[208:211], v[40:43]
s_waitcnt lgkmcnt(7)
ds_read_b64_tr_b16 a[74:75], v118 offset:10240
v_mul_f32 v92, v92, v25
v_mfma_f32_16x16x32_bf16 v[40:43], a[120:123], v[224:227], v[40:43]
s_waitcnt lgkmcnt(6)
ds_read_b64_tr_b16 a[76:77], v118 offset:12288
v_mul_f32 v93, v93, v25
v_mfma_f32_16x16x32_bf16 v[40:43], a[124:127], v[240:243], v[40:43]
ds_read_b64_tr_b16 a[78:79], v118 offset:14336
buffer_load_dwordx4 v115, s[36:39], s81 offen offset:3072 lds
v_mfma_f32_16x16x32_bf16 v[44:47], a[96:99], v[132:135], 0
ds_read_b64_tr_b16 a[80:81], v118 offset:16384
v_mul_f32 v94, v94, v25
v_mfma_f32_16x16x32_bf16 v[44:47], a[100:103], v[148:151], v[44:47]
ds_read_b64_tr_b16 a[82:83], v118 offset:18432
v_mul_f32 v95, v95, v25
v_mfma_f32_16x16x32_bf16 v[44:47], a[104:107], v[164:167], v[44:47]
ds_read_b64_tr_b16 a[84:85], v118 offset:20480
v_cvt_pk_bf16_f32 v84, v84, v85
v_mfma_f32_16x16x32_bf16 v[44:47], a[108:111], v[180:183], v[44:47]
ds_read_b64_tr_b16 a[86:87], v118 offset:22528
v_cvt_pk_bf16_f32 v85, v86, v87
v_mfma_f32_16x16x32_bf16 v[44:47], a[112:115], v[196:199], v[44:47]
ds_read_b64_tr_b16 a[88:89], v118 offset:24576
v_cvt_pk_bf16_f32 v86, v92, v93
v_mfma_f32_16x16x32_bf16 v[44:47], a[116:119], v[212:215], v[44:47]
s_add_u32 s81, s81, 28672
s_add_u32 m0, s18, 36864
ds_read_b64_tr_b16 a[90:91], v118 offset:26624
v_mfma_f32_16x16x32_bf16 v[44:47], a[120:123], v[228:231], v[44:47]
ds_read_b64_tr_b16 a[92:93], v118 offset:28672
buffer_load_dwordx4 v112, s[36:39], s81 offen offset:0 lds
v_mfma_f32_16x16x32_bf16 v[44:47], a[124:127], v[244:247], v[44:47]
s_waitcnt lgkmcnt(8)
ds_read_b64_tr_b16 a[94:95], v118 offset:30720
v_add_u32 v118, 4294901760, v118
v_mfma_f32_16x16x32_bf16 v[48:51], a[64:67], v[128:131], 0
ds_read_b64_tr_b16 a[96:97], v119 offset:0
v_cvt_pk_bf16_f32 v87, v94, v95
v_mfma_f32_16x16x32_bf16 v[48:51], a[68:71], v[144:147], v[48:51]
s_waitcnt lgkmcnt(8)
ds_read_b64_tr_b16 a[98:99], v119 offset:2048
buffer_store_dwordx4 v[84:87], v1, s[4:7], s12 offen offset:3072 sc1
v_mfma_f32_16x16x32_bf16 v[48:51], a[72:75], v[160:163], v[48:51]
s_add_u32 s8, s8, 4096
s_add_u32 s12, s12, 4096
ds_read_b64_tr_b16 a[100:101], v119 offset:4096
v_mfma_f32_16x16x32_bf16 v[48:51], a[76:79], v[176:179], v[48:51]
s_waitcnt lgkmcnt(8)
ds_read_b64_tr_b16 a[102:103], v119 offset:6144
v_mul_f32 v32, v32, v24
v_mfma_f32_16x16x32_bf16 v[48:51], a[80:83], v[192:195], v[48:51]
s_waitcnt lgkmcnt(8)
ds_read_b64_tr_b16 a[104:105], v119 offset:8192
v_mul_f32 v33, v33, v24
v_mfma_f32_16x16x32_bf16 v[48:51], a[84:87], v[208:211], v[48:51]
s_waitcnt lgkmcnt(7)
ds_read_b64_tr_b16 a[106:107], v119 offset:10240
buffer_load_dwordx4 v113, s[36:39], s81 offen offset:1024 lds
v_mfma_f32_16x16x32_bf16 v[48:51], a[88:91], v[224:227], v[48:51]
s_waitcnt lgkmcnt(6)
ds_read_b64_tr_b16 a[108:109], v119 offset:12288
v_mul_f32 v34, v34, v24
v_mfma_f32_16x16x32_bf16 v[48:51], a[92:95], v[240:243], v[48:51]
ds_read_b64_tr_b16 a[110:111], v119 offset:14336
v_mul_f32 v35, v35, v24
v_mfma_f32_16x16x32_bf16 v[52:55], a[64:67], v[132:135], 0
ds_read_b64_tr_b16 a[112:113], v119 offset:16384
v_mul_f32 v40, v40, v24
v_mfma_f32_16x16x32_bf16 v[52:55], a[68:71], v[148:151], v[52:55]
ds_read_b64_tr_b16 a[114:115], v119 offset:18432
v_mul_f32 v41, v41, v24
v_mfma_f32_16x16x32_bf16 v[52:55], a[72:75], v[164:167], v[52:55]
ds_read_b64_tr_b16 a[116:117], v119 offset:20480
v_mul_f32 v42, v42, v24
v_mfma_f32_16x16x32_bf16 v[52:55], a[76:79], v[180:183], v[52:55]
ds_read_b64_tr_b16 a[118:119], v119 offset:22528
v_mul_f32 v43, v43, v24
v_mfma_f32_16x16x32_bf16 v[52:55], a[80:83], v[196:199], v[52:55]
ds_read_b64_tr_b16 a[120:121], v119 offset:24576
buffer_load_dwordx4 v114, s[36:39], s81 offen offset:2048 lds
v_mfma_f32_16x16x32_bf16 v[52:55], a[84:87], v[212:215], v[52:55]
ds_read_b64_tr_b16 a[122:123], v119 offset:26624
v_cvt_pk_bf16_f32 v32, v32, v33
v_mfma_f32_16x16x32_bf16 v[52:55], a[88:91], v[228:231], v[52:55]
ds_read_b64_tr_b16 a[124:125], v119 offset:28672
ds_read_b64_tr_b16 a[126:127], v119 offset:30720
v_mfma_f32_16x16x32_bf16 v[52:55], a[92:95], v[244:247], v[52:55]
s_waitcnt vmcnt(23) lgkmcnt(9)
s_barrier
v_add_u32 v119, 4294901760, v119
v_mfma_f32_16x16x32_bf16 v[56:59], a[96:99], v[128:131], 0
ds_read_b64_tr_b16 a[64:65], v116 offset:0
v_cvt_pk_bf16_f32 v33, v34, v35
v_mfma_f32_16x16x32_bf16 v[56:59], a[100:103], v[144:147], v[56:59]
ds_read_b64_tr_b16 a[66:67], v116 offset:2048
v_cvt_pk_bf16_f32 v34, v40, v41
v_mfma_f32_16x16x32_bf16 v[56:59], a[104:107], v[160:163], v[56:59]
s_waitcnt lgkmcnt(8)
ds_read_b64_tr_b16 a[68:69], v116 offset:4096
v_cvt_pk_bf16_f32 v35, v42, v43
v_mfma_f32_16x16x32_bf16 v[56:59], a[108:111], v[176:179], v[56:59]
ds_read_b64_tr_b16 a[70:71], v116 offset:6144
buffer_load_dwordx4 v115, s[36:39], s81 offen offset:3072 lds
v_mfma_f32_16x16x32_bf16 v[56:59], a[112:115], v[192:195], v[56:59]
s_waitcnt lgkmcnt(8)
ds_read_b64_tr_b16 a[72:73], v116 offset:8192
buffer_store_dwordx4 v[32:35], v1, s[4:7], s8 offen offset:0 sc1
v_mfma_f32_16x16x32_bf16 v[56:59], a[116:119], v[208:211], v[56:59]
PAD_15:
s_cbranch_execz M_tret
s_waitcnt lgkmcnt(7)
ds_read_b64_tr_b16 a[74:75], v116 offset:10240
v_mul_f32 v36, v36, v25
v_mfma_f32_16x16x32_bf16 v[56:59], a[120:123], v[224:227], v[56:59]
s_waitcnt lgkmcnt(6)
ds_read_b64_tr_b16 a[76:77], v116 offset:12288
v_mul_f32 v37, v37, v25
v_mfma_f32_16x16x32_bf16 v[56:59], a[124:127], v[240:243], v[56:59]
ds_read_b64_tr_b16 a[78:79], v116 offset:14336
v_mul_f32 v38, v38, v25
v_mfma_f32_16x16x32_bf16 v[60:63], a[96:99], v[132:135], 0
ds_read_b64_tr_b16 a[80:81], v116 offset:16384
v_mul_f32 v39, v39, v25
v_mfma_f32_16x16x32_bf16 v[60:63], a[100:103], v[148:151], v[60:63]
s_sub_u32 s81, s81, 28544
ds_read_b64_tr_b16 a[82:83], v116 offset:18432
v_mul_f32 v44, v44, v25
v_mfma_f32_16x16x32_bf16 v[60:63], a[104:107], v[164:167], v[60:63]
ds_read_b64_tr_b16 a[84:85], v116 offset:20480
v_mul_f32 v45, v45, v25
v_mfma_f32_16x16x32_bf16 v[60:63], a[108:111], v[180:183], v[60:63]
ds_read_b64_tr_b16 a[86:87], v116 offset:22528
v_mul_f32 v46, v46, v25
v_mfma_f32_16x16x32_bf16 v[60:63], a[112:115], v[196:199], v[60:63]
ds_read_b64_tr_b16 a[88:89], v116 offset:24576
v_mul_f32 v47, v47, v25
v_mfma_f32_16x16x32_bf16 v[60:63], a[116:119], v[212:215], v[60:63]
ds_read_b64_tr_b16 a[90:91], v116 offset:26624
v_cvt_pk_bf16_f32 v36, v36, v37
v_mfma_f32_16x16x32_bf16 v[60:63], a[120:123], v[228:231], v[60:63]
ds_read_b64_tr_b16 a[92:93], v116 offset:28672
v_cvt_pk_bf16_f32 v37, v38, v39
v_mfma_f32_16x16x32_bf16 v[60:63], a[124:127], v[244:247], v[60:63]
s_waitcnt lgkmcnt(8)
ds_read_b64_tr_b16 a[94:95], v116 offset:30720
v_add_u32 v116, 4294901760, v116
v_mfma_f32_16x16x32_bf16 v[64:67], a[64:67], v[128:131], 0
s_add_u32 m0, s18, 98304
ds_read_b64_tr_b16 a[96:97], v117 offset:0
v_cvt_pk_bf16_f32 v38, v44, v45
v_mfma_f32_16x16x32_bf16 v[64:67], a[68:71], v[144:147], v[64:67]
ds_read_b64_tr_b16 a[98:99], v117 offset:2048
buffer_load_dwordx4 v112, s[36:39], s81 offen offset:0 lds
v_mfma_f32_16x16x32_bf16 v[64:67], a[72:75], v[160:163], v[64:67]
s_waitcnt lgkmcnt(8)
ds_read_b64_tr_b16 a[100:101], v117 offset:4096
v_cvt_pk_bf16_f32 v39, v46, v47
v_mfma_f32_16x16x32_bf16 v[64:67], a[76:79], v[176:179], v[64:67]
ds_read_b64_tr_b16 a[102:103], v117 offset:6144
buffer_store_dwordx4 v[36:39], v1, s[4:7], s12 offen offset:0 sc1
v_mfma_f32_16x16x32_bf16 v[64:67], a[80:83], v[192:195], v[64:67]
s_waitcnt lgkmcnt(8)
ds_read_b64_tr_b16 a[104:105], v117 offset:8192
v_mul_f32 v48, v48, v24
v_mfma_f32_16x16x32_bf16 v[64:67], a[84:87], v[208:211], v[64:67]
s_waitcnt lgkmcnt(7)
ds_read_b64_tr_b16 a[106:107], v117 offset:10240
v_mul_f32 v49, v49, v24
v_mfma_f32_16x16x32_bf16 v[64:67], a[88:91], v[224:227], v[64:67]
s_waitcnt lgkmcnt(6)
ds_read_b64_tr_b16 a[108:109], v117 offset:12288
v_mul_f32 v50, v50, v24
v_mfma_f32_16x16x32_bf16 v[64:67], a[92:95], v[240:243], v[64:67]
ds_read_b64_tr_b16 a[110:111], v117 offset:14336
v_mul_f32 v51, v51, v24
v_mfma_f32_16x16x32_bf16 v[68:71], a[64:67], v[132:135], 0
ds_read_b64_tr_b16 a[112:113], v117 offset:16384
buffer_load_dwordx4 v113, s[36:39], s81 offen offset:1024 lds
v_mfma_f32_16x16x32_bf16 v[68:71], a[68:71], v[148:151], v[68:71]
ds_read_b64_tr_b16 a[114:115], v117 offset:18432
v_mul_f32 v56, v56, v24
v_mfma_f32_16x16x32_bf16 v[68:71], a[72:75], v[164:167], v[68:71]
ds_read_b64_tr_b16 a[116:117], v117 offset:20480
v_mul_f32 v57, v57, v24
v_mfma_f32_16x16x32_bf16 v[68:71], a[76:79], v[180:183], v[68:71]
ds_read_b64_tr_b16 a[118:119], v117 offset:22528
v_mul_f32 v58, v58, v24
v_mfma_f32_16x16x32_bf16 v[68:71], a[80:83], v[196:199], v[68:71]
ds_read_b64_tr_b16 a[120:121], v117 offset:24576
v_mul_f32 v59, v59, v24
v_mfma_f32_16x16x32_bf16 v[68:71], a[84:87], v[212:215], v[68:71]
ds_read_b64_tr_b16 a[122:123], v117 offset:26624
v_cvt_pk_bf16_f32 v48, v48, v49
v_mfma_f32_16x16x32_bf16 v[68:71], a[88:91], v[228:231], v[68:71]
ds_read_b64_tr_b16 a[124:125], v117 offset:28672
v_cvt_pk_bf16_f32 v49, v50, v51
v_mfma_f32_16x16x32_bf16 v[68:71], a[92:95], v[244:247], v[68:71]
s_waitcnt lgkmcnt(8)
ds_read_b64_tr_b16 a[126:127], v117 offset:30720
v_add_u32 v117, 4294901760, v117
v_mfma_f32_16x16x32_bf16 v[72:75], a[96:99], v[128:131], 0
ds_read_b64_tr_b16 a[64:65], v118 offset:0
buffer_load_dwordx4 v114, s[36:39], s81 offen offset:2048 lds
v_mfma_f32_16x16x32_bf16 v[72:75], a[100:103], v[144:147], v[72:75]
ds_read_b64_tr_b16 a[66:67], v118 offset:2048
v_cvt_pk_bf16_f32 v50, v56, v57
v_mfma_f32_16x16x32_bf16 v[72:75], a[104:107], v[160:163], v[72:75]
s_waitcnt lgkmcnt(8)
ds_read_b64_tr_b16 a[68:69], v118 offset:4096
v_cvt_pk_bf16_f32 v51, v58, v59
v_mfma_f32_16x16x32_bf16 v[72:75], a[108:111], v[176:179], v[72:75]
ds_read_b64_tr_b16 a[70:71], v118 offset:6144
buffer_store_dwordx4 v[48:51], v1, s[4:7], s8 offen offset:1024 sc1
v_mfma_f32_16x16x32_bf16 v[72:75], a[112:115], v[192:195], v[72:75]
s_waitcnt lgkmcnt(8)
ds_read_b64_tr_b16 a[72:73], v118 offset:8192
v_mul_f32 v52, v52, v25
v_mfma_f32_16x16x32_bf16 v[72:75], a[116:119], v[208:211], v[72:75]
s_waitcnt lgkmcnt(7)
ds_read_b64_tr_b16 a[74:75], v118 offset:10240
v_mul_f32 v53, v53, v25
v_mfma_f32_16x16x32_bf16 v[72:75], a[120:123], v[224:227], v[72:75]
s_waitcnt lgkmcnt(6)
ds_read_b64_tr_b16 a[76:77], v118 offset:12288
v_mul_f32 v54, v54, v25
v_mfma_f32_16x16x32_bf16 v[72:75], a[124:127], v[240:243], v[72:75]
ds_read_b64_tr_b16 a[78:79], v118 offset:14336
buffer_load_dwordx4 v115, s[36:39], s81 offen offset:3072 lds
v_mfma_f32_16x16x32_bf16 v[76:79], a[96:99], v[132:135], 0
ds_read_b64_tr_b16 a[80:81], v118 offset:16384
v_mul_f32 v55, v55, v25
v_mfma_f32_16x16x32_bf16 v[76:79], a[100:103], v[148:151], v[76:79]
ds_read_b64_tr_b16 a[82:83], v118 offset:18432
v_mul_f32 v60, v60, v25
v_mfma_f32_16x16x32_bf16 v[76:79], a[104:107], v[164:167], v[76:79]
ds_read_b64_tr_b16 a[84:85], v118 offset:20480
v_mul_f32 v61, v61, v25
v_mfma_f32_16x16x32_bf16 v[76:79], a[108:111], v[180:183], v[76:79]
ds_read_b64_tr_b16 a[86:87], v118 offset:22528
v_mul_f32 v62, v62, v25
v_mfma_f32_16x16x32_bf16 v[76:79], a[112:115], v[196:199], v[76:79]
ds_read_b64_tr_b16 a[88:89], v118 offset:24576
v_mul_f32 v63, v63, v25
v_mfma_f32_16x16x32_bf16 v[76:79], a[116:119], v[212:215], v[76:79]
s_add_u32 s81, s81, 28672
s_add_u32 m0, s18, 102400
ds_read_b64_tr_b16 a[90:91], v118 offset:26624
v_mfma_f32_16x16x32_bf16 v[76:79], a[120:123], v[228:231], v[76:79]
ds_read_b64_tr_b16 a[92:93], v118 offset:28672
buffer_load_dwordx4 v112, s[36:39], s81 offen offset:0 lds
v_mfma_f32_16x16x32_bf16 v[76:79], a[124:127], v[244:247], v[76:79]
s_waitcnt lgkmcnt(8)
ds_read_b64_tr_b16 a[94:95], v118 offset:30720
v_add_u32 v118, 4294901760, v118
v_mfma_f32_16x16x32_bf16 v[80:83], a[64:67], v[128:131], 0
ds_read_b64_tr_b16 a[96:97], v119 offset:0
v_cvt_pk_bf16_f32 v52, v52, v53
v_mfma_f32_16x16x32_bf16 v[80:83], a[68:71], v[144:147], v[80:83]
ds_read_b64_tr_b16 a[98:99], v119 offset:2048
v_cvt_pk_bf16_f32 v53, v54, v55
v_mfma_f32_16x16x32_bf16 v[80:83], a[72:75], v[160:163], v[80:83]
s_waitcnt lgkmcnt(8)
ds_read_b64_tr_b16 a[100:101], v119 offset:4096
v_cvt_pk_bf16_f32 v54, v60, v61
v_mfma_f32_16x16x32_bf16 v[80:83], a[76:79], v[176:179], v[80:83]
ds_read_b64_tr_b16 a[102:103], v119 offset:6144
v_cvt_pk_bf16_f32 v55, v62, v63
v_mfma_f32_16x16x32_bf16 v[80:83], a[80:83], v[192:195], v[80:83]
s_waitcnt lgkmcnt(8)
ds_read_b64_tr_b16 a[104:105], v119 offset:8192
buffer_store_dwordx4 v[52:55], v1, s[4:7], s12 offen offset:1024 sc1
v_mfma_f32_16x16x32_bf16 v[80:83], a[84:87], v[208:211], v[80:83]
s_waitcnt lgkmcnt(7)
ds_read_b64_tr_b16 a[106:107], v119 offset:10240
buffer_load_dwordx4 v113, s[36:39], s81 offen offset:1024 lds
v_mfma_f32_16x16x32_bf16 v[80:83], a[88:91], v[224:227], v[80:83]
s_waitcnt lgkmcnt(6)
ds_read_b64_tr_b16 a[108:109], v119 offset:12288
v_mul_f32 v64, v64, v24
v_mfma_f32_16x16x32_bf16 v[80:83], a[92:95], v[240:243], v[80:83]
ds_read_b64_tr_b16 a[110:111], v119 offset:14336
v_mul_f32 v65, v65, v24
v_mfma_f32_16x16x32_bf16 v[84:87], a[64:67], v[132:135], 0
ds_read_b64_tr_b16 a[112:113], v119 offset:16384
v_mul_f32 v66, v66, v24
v_mfma_f32_16x16x32_bf16 v[84:87], a[68:71], v[148:151], v[84:87]
ds_read_b64_tr_b16 a[114:115], v119 offset:18432
v_mul_f32 v67, v67, v24
v_mfma_f32_16x16x32_bf16 v[84:87], a[72:75], v[164:167], v[84:87]
ds_read_b64_tr_b16 a[116:117], v119 offset:20480
v_mul_f32 v72, v72, v24
v_mfma_f32_16x16x32_bf16 v[84:87], a[76:79], v[180:183], v[84:87]
ds_read_b64_tr_b16 a[118:119], v119 offset:22528
v_mul_f32 v73, v73, v24
v_mfma_f32_16x16x32_bf16 v[84:87], a[80:83], v[196:199], v[84:87]
ds_read_b64_tr_b16 a[120:121], v119 offset:24576
buffer_load_dwordx4 v114, s[36:39], s81 offen offset:2048 lds
v_mfma_f32_16x16x32_bf16 v[84:87], a[84:87], v[212:215], v[84:87]
ds_read_b64_tr_b16 a[122:123], v119 offset:26624
v_mul_f32 v74, v74, v24
v_mfma_f32_16x16x32_bf16 v[84:87], a[88:91], v[228:231], v[84:87]
ds_read_b64_tr_b16 a[124:125], v119 offset:28672
ds_read_b64_tr_b16 a[126:127], v119 offset:30720
v_mfma_f32_16x16x32_bf16 v[84:87], a[92:95], v[244:247], v[84:87]
s_waitcnt vmcnt(27) lgkmcnt(9)
s_barrier
v_add_u32 v119, 4294901760, v119
v_mfma_f32_16x16x32_bf16 v[88:91], a[96:99], v[128:131], 0
ds_read_b64_tr_b16 a[64:65], v116 offset:0
v_mul_f32 v75, v75, v24
v_mfma_f32_16x16x32_bf16 v[88:91], a[100:103], v[144:147], v[88:91]
ds_read_b64_tr_b16 a[66:67], v116 offset:2048
v_cvt_pk_bf16_f32 v64, v64, v65
v_mfma_f32_16x16x32_bf16 v[88:91], a[104:107], v[160:163], v[88:91]
s_waitcnt lgkmcnt(8)
ds_read_b64_tr_b16 a[68:69], v116 offset:4096
v_cvt_pk_bf16_f32 v65, v66, v67
v_mfma_f32_16x16x32_bf16 v[88:91], a[108:111], v[176:179], v[88:91]
ds_read_b64_tr_b16 a[70:71], v116 offset:6144
buffer_load_dwordx4 v115, s[36:39], s81 offen offset:3072 lds
v_mfma_f32_16x16x32_bf16 v[88:91], a[112:115], v[192:195], v[88:91]
s_waitcnt lgkmcnt(8)
ds_read_b64_tr_b16 a[72:73], v116 offset:8192
v_cvt_pk_bf16_f32 v66, v72, v73
v_mfma_f32_16x16x32_bf16 v[88:91], a[116:119], v[208:211], v[88:91]
s_waitcnt lgkmcnt(7)
ds_read_b64_tr_b16 a[74:75], v116 offset:10240
v_cvt_pk_bf16_f32 v67, v74, v75
v_mfma_f32_16x16x32_bf16 v[88:91], a[120:123], v[224:227], v[88:91]
s_waitcnt lgkmcnt(6)
ds_read_b64_tr_b16 a[76:77], v116 offset:12288
buffer_store_dwordx4 v[64:67], v1, s[4:7], s8 offen offset:2048 sc1
v_mfma_f32_16x16x32_bf16 v[88:91], a[124:127], v[240:243], v[88:91]
ds_read_b64_tr_b16 a[78:79], v116 offset:14336
v_mul_f32 v68, v68, v25
v_mfma_f32_16x16x32_bf16 v[92:95], a[96:99], v[132:135], 0
ds_read_b64_tr_b16 a[80:81], v116 offset:16384
v_mul_f32 v69, v69, v25
v_mfma_f32_16x16x32_bf16 v[92:95], a[100:103], v[148:151], v[92:95]
s_sub_u32 s81, s81, 28544
ds_read_b64_tr_b16 a[82:83], v116 offset:18432
v_mul_f32 v70, v70, v25
v_mfma_f32_16x16x32_bf16 v[92:95], a[104:107], v[164:167], v[92:95]
ds_read_b64_tr_b16 a[84:85], v116 offset:20480
v_mul_f32 v71, v71, v25
v_mfma_f32_16x16x32_bf16 v[92:95], a[108:111], v[180:183], v[92:95]
ds_read_b64_tr_b16 a[86:87], v116 offset:22528
v_mul_f32 v76, v76, v25
v_mfma_f32_16x16x32_bf16 v[92:95], a[112:115], v[196:199], v[92:95]
ds_read_b64_tr_b16 a[88:89], v116 offset:24576
v_mul_f32 v77, v77, v25
v_mfma_f32_16x16x32_bf16 v[92:95], a[116:119], v[212:215], v[92:95]
ds_read_b64_tr_b16 a[90:91], v116 offset:26624
v_mul_f32 v78, v78, v25
v_mfma_f32_16x16x32_bf16 v[92:95], a[120:123], v[228:231], v[92:95]
ds_read_b64_tr_b16 a[92:93], v116 offset:28672
v_mul_f32 v79, v79, v25
v_mfma_f32_16x16x32_bf16 v[92:95], a[124:127], v[244:247], v[92:95]
s_waitcnt lgkmcnt(8)
ds_read_b64_tr_b16 a[94:95], v116 offset:30720
v_add_u32 v116, 32768, v116
v_mfma_f32_16x16x32_bf16 v[32:35], a[64:67], v[128:131], 0
ds_read_b64_tr_b16 a[96:97], v117 offset:0
v_cvt_pk_bf16_f32 v68, v68, v69
v_mfma_f32_16x16x32_bf16 v[32:35], a[68:71], v[144:147], v[32:35]
ds_read_b64_tr_b16 a[98:99], v117 offset:2048
v_cvt_pk_bf16_f32 v69, v70, v71
v_mfma_f32_16x16x32_bf16 v[32:35], a[72:75], v[160:163], v[32:35]
s_waitcnt lgkmcnt(8)
ds_read_b64_tr_b16 a[100:101], v117 offset:4096
v_cvt_pk_bf16_f32 v70, v76, v77
v_mfma_f32_16x16x32_bf16 v[32:35], a[76:79], v[176:179], v[32:35]
ds_read_b64_tr_b16 a[102:103], v117 offset:6144
v_cvt_pk_bf16_f32 v71, v78, v79
v_mfma_f32_16x16x32_bf16 v[32:35], a[80:83], v[192:195], v[32:35]
s_waitcnt lgkmcnt(8)
ds_read_b64_tr_b16 a[104:105], v117 offset:8192
buffer_store_dwordx4 v[68:71], v1, s[4:7], s12 offen offset:2048 sc1
v_mfma_f32_16x16x32_bf16 v[32:35], a[84:87], v[208:211], v[32:35]
s_waitcnt lgkmcnt(7)
ds_read_b64_tr_b16 a[106:107], v117 offset:10240
v_mul_f32 v80, v80, v24
v_mfma_f32_16x16x32_bf16 v[32:35], a[88:91], v[224:227], v[32:35]
s_waitcnt lgkmcnt(6)
ds_read_b64_tr_b16 a[108:109], v117 offset:12288
v_mul_f32 v81, v81, v24
v_mfma_f32_16x16x32_bf16 v[32:35], a[92:95], v[240:243], v[32:35]
ds_read_b64_tr_b16 a[110:111], v117 offset:14336
v_mul_f32 v82, v82, v24
v_mfma_f32_16x16x32_bf16 v[36:39], a[64:67], v[132:135], 0
ds_read_b64_tr_b16 a[112:113], v117 offset:16384
v_mul_f32 v83, v83, v24
v_mfma_f32_16x16x32_bf16 v[36:39], a[68:71], v[148:151], v[36:39]
ds_read_b64_tr_b16 a[114:115], v117 offset:18432
v_mul_f32 v88, v88, v24
v_mfma_f32_16x16x32_bf16 v[36:39], a[72:75], v[164:167], v[36:39]
ds_read_b64_tr_b16 a[116:117], v117 offset:20480
v_mul_f32 v89, v89, v24
v_mfma_f32_16x16x32_bf16 v[36:39], a[76:79], v[180:183], v[36:39]
ds_read_b64_tr_b16 a[118:119], v117 offset:22528
v_mul_f32 v90, v90, v24
v_mfma_f32_16x16x32_bf16 v[36:39], a[80:83], v[196:199], v[36:39]
ds_read_b64_tr_b16 a[120:121], v117 offset:24576
v_mul_f32 v91, v91, v24
v_mfma_f32_16x16x32_bf16 v[36:39], a[84:87], v[212:215], v[36:39]
ds_read_b64_tr_b16 a[122:123], v117 offset:26624
v_cvt_pk_bf16_f32 v80, v80, v81
v_mfma_f32_16x16x32_bf16 v[36:39], a[88:91], v[228:231], v[36:39]
ds_read_b64_tr_b16 a[124:125], v117 offset:28672
v_cvt_pk_bf16_f32 v81, v82, v83
v_mfma_f32_16x16x32_bf16 v[36:39], a[92:95], v[244:247], v[36:39]
s_waitcnt lgkmcnt(8)
ds_read_b64_tr_b16 a[126:127], v117 offset:30720
v_add_u32 v117, 32768, v117
v_mfma_f32_16x16x32_bf16 v[40:43], a[96:99], v[128:131], 0
ds_read_b64_tr_b16 a[64:65], v118 offset:0
v_cvt_pk_bf16_f32 v82, v88, v89
v_mfma_f32_16x16x32_bf16 v[40:43], a[100:103], v[144:147], v[40:43]
ds_read_b64_tr_b16 a[66:67], v118 offset:2048
v_cvt_pk_bf16_f32 v83, v90, v91
v_mfma_f32_16x16x32_bf16 v[40:43], a[104:107], v[160:163], v[40:43]
s_waitcnt lgkmcnt(8)
ds_read_b64_tr_b16 a[68:69], v118 offset:4096
buffer_store_dwordx4 v[80:83], v1, s[4:7], s8 offen offset:3072 sc1
v_mfma_f32_16x16x32_bf16 v[40:43], a[108:111], v[176:179], v[40:43]
ds_read_b64_tr_b16 a[70:71], v118 offset:6144
v_mul_f32 v84, v84, v25
v_mfma_f32_16x16x32_bf16 v[40:43], a[112:115], v[192:195], v[40:43]
s_waitcnt lgkmcnt(8)
ds_read_b64_tr_b16 a[72:73], v118 offset:8192
v_mul_f32 v85, v85, v25
v_mfma_f32_16x16x32_bf16 v[40:43], a[116:119], v[208:211], v[40:43]
s_waitcnt lgkmcnt(7)
ds_read_b64_tr_b16 a[74:75], v118 offset:10240
v_mul_f32 v86, v86, v25
v_mfma_f32_16x16x32_bf16 v[40:43], a[120:123], v[224:227], v[40:43]
s_waitcnt lgkmcnt(6)
ds_read_b64_tr_b16 a[76:77], v118 offset:12288
v_mul_f32 v87, v87, v25
v_mfma_f32_16x16x32_bf16 v[40:43], a[124:127], v[240:243], v[40:43]
ds_read_b64_tr_b16 a[78:79], v118 offset:14336
v_mul_f32 v92, v92, v25
v_mfma_f32_16x16x32_bf16 v[44:47], a[96:99], v[132:135], 0
ds_read_b64_tr_b16 a[80:81], v118 offset:16384
v_mul_f32 v93, v93, v25
v_mfma_f32_16x16x32_bf16 v[44:47], a[100:103], v[148:151], v[44:47]
ds_read_b64_tr_b16 a[82:83], v118 offset:18432
v_mul_f32 v94, v94, v25
v_mfma_f32_16x16x32_bf16 v[44:47], a[104:107], v[164:167], v[44:47]
ds_read_b64_tr_b16 a[84:85], v118 offset:20480
v_mul_f32 v95, v95, v25
v_mfma_f32_16x16x32_bf16 v[44:47], a[108:111], v[180:183], v[44:47]
ds_read_b64_tr_b16 a[86:87], v118 offset:22528
v_cvt_pk_bf16_f32 v84, v84, v85
v_mfma_f32_16x16x32_bf16 v[44:47], a[112:115], v[196:199], v[44:47]
ds_read_b64_tr_b16 a[88:89], v118 offset:24576
v_cvt_pk_bf16_f32 v85, v86, v87
v_mfma_f32_16x16x32_bf16 v[44:47], a[116:119], v[212:215], v[44:47]
ds_read_b64_tr_b16 a[90:91], v118 offset:26624
v_cvt_pk_bf16_f32 v86, v92, v93
v_mfma_f32_16x16x32_bf16 v[44:47], a[120:123], v[228:231], v[44:47]
ds_read_b64_tr_b16 a[92:93], v118 offset:28672
v_cvt_pk_bf16_f32 v87, v94, v95
v_mfma_f32_16x16x32_bf16 v[44:47], a[124:127], v[244:247], v[44:47]
s_waitcnt lgkmcnt(8)
ds_read_b64_tr_b16 a[94:95], v118 offset:30720
v_add_u32 v118, 32768, v118
v_mfma_f32_16x16x32_bf16 v[48:51], a[64:67], v[128:131], 0
ds_read_b64_tr_b16 a[96:97], v119 offset:0
buffer_store_dwordx4 v[84:87], v1, s[4:7], s12 offen offset:3072 sc1
v_mfma_f32_16x16x32_bf16 v[48:51], a[68:71], v[144:147], v[48:51]
s_add_u32 s8, s8, 4096
s_add_u32 s12, s12, 4096
ds_read_b64_tr_b16 a[98:99], v119 offset:2048
v_mfma_f32_16x16x32_bf16 v[48:51], a[72:75], v[160:163], v[48:51]
s_waitcnt lgkmcnt(8)
ds_read_b64_tr_b16 a[100:101], v119 offset:4096
v_mul_f32 v32, v32, v24
v_mfma_f32_16x16x32_bf16 v[48:51], a[76:79], v[176:179], v[48:51]
ds_read_b64_tr_b16 a[102:103], v119 offset:6144
v_mul_f32 v33, v33, v24
v_mfma_f32_16x16x32_bf16 v[48:51], a[80:83], v[192:195], v[48:51]
s_waitcnt lgkmcnt(8)
ds_read_b64_tr_b16 a[104:105], v119 offset:8192
v_mul_f32 v34, v34, v24
v_mfma_f32_16x16x32_bf16 v[48:51], a[84:87], v[208:211], v[48:51]
s_waitcnt lgkmcnt(7)
ds_read_b64_tr_b16 a[106:107], v119 offset:10240
v_mul_f32 v35, v35, v24
v_mfma_f32_16x16x32_bf16 v[48:51], a[88:91], v[224:227], v[48:51]
s_waitcnt lgkmcnt(6)
ds_read_b64_tr_b16 a[108:109], v119 offset:12288
v_mul_f32 v40, v40, v24
v_mfma_f32_16x16x32_bf16 v[48:51], a[92:95], v[240:243], v[48:51]
ds_read_b64_tr_b16 a[110:111], v119 offset:14336
v_mul_f32 v41, v41, v24
v_mfma_f32_16x16x32_bf16 v[52:55], a[64:67], v[132:135], 0
ds_read_b64_tr_b16 a[112:113], v119 offset:16384
v_mul_f32 v42, v42, v24
v_mfma_f32_16x16x32_bf16 v[52:55], a[68:71], v[148:151], v[52:55]
ds_read_b64_tr_b16 a[114:115], v119 offset:18432
v_mul_f32 v43, v43, v24
v_mfma_f32_16x16x32_bf16 v[52:55], a[72:75], v[164:167], v[52:55]
ds_read_b64_tr_b16 a[116:117], v119 offset:20480
v_cvt_pk_bf16_f32 v32, v32, v33
v_mfma_f32_16x16x32_bf16 v[52:55], a[76:79], v[180:183], v[52:55]
ds_read_b64_tr_b16 a[118:119], v119 offset:22528
v_cvt_pk_bf16_f32 v33, v34, v35
v_mfma_f32_16x16x32_bf16 v[52:55], a[80:83], v[196:199], v[52:55]
ds_read_b64_tr_b16 a[120:121], v119 offset:24576
v_cvt_pk_bf16_f32 v34, v40, v41
v_mfma_f32_16x16x32_bf16 v[52:55], a[84:87], v[212:215], v[52:55]
ds_read_b64_tr_b16 a[122:123], v119 offset:26624
v_cvt_pk_bf16_f32 v35, v42, v43
v_mfma_f32_16x16x32_bf16 v[52:55], a[88:91], v[228:231], v[52:55]
ds_read_b64_tr_b16 a[124:125], v119 offset:28672
ds_read_b64_tr_b16 a[126:127], v119 offset:30720
v_mfma_f32_16x16x32_bf16 v[52:55], a[92:95], v[244:247], v[52:55]
s_waitcnt vmcnt(16) lgkmcnt(9)
s_barrier
v_add_u32 v119, 32768, v119
v_mfma_f32_16x16x32_bf16 v[56:59], a[96:99], v[128:131], 0
ds_read_b64_tr_b16 a[64:65], v116 offset:0
buffer_store_dwordx4 v[32:35], v1, s[4:7], s8 offen offset:0 sc1
v_mfma_f32_16x16x32_bf16 v[56:59], a[100:103], v[144:147], v[56:59]
ds_read_b64_tr_b16 a[66:67], v116 offset:2048
v_mul_f32 v36, v36, v25
v_mfma_f32_16x16x32_bf16 v[56:59], a[104:107], v[160:163], v[56:59]
s_waitcnt lgkmcnt(8)
ds_read_b64_tr_b16 a[68:69], v116 offset:4096
v_mul_f32 v37, v37, v25
v_mfma_f32_16x16x32_bf16 v[56:59], a[108:111], v[176:179], v[56:59]
ds_read_b64_tr_b16 a[70:71], v116 offset:6144
v_mul_f32 v38, v38, v25
v_mfma_f32_16x16x32_bf16 v[56:59], a[112:115], v[192:195], v[56:59]
s_waitcnt lgkmcnt(8)
ds_read_b64_tr_b16 a[72:73], v116 offset:8192
v_mul_f32 v39, v39, v25
v_mfma_f32_16x16x32_bf16 v[56:59], a[116:119], v[208:211], v[56:59]
s_waitcnt lgkmcnt(7)
ds_read_b64_tr_b16 a[74:75], v116 offset:10240
v_mul_f32 v44, v44, v25
v_mfma_f32_16x16x32_bf16 v[56:59], a[120:123], v[224:227], v[56:59]
s_waitcnt lgkmcnt(6)
ds_read_b64_tr_b16 a[76:77], v116 offset:12288
v_mul_f32 v45, v45, v25
v_mfma_f32_16x16x32_bf16 v[56:59], a[124:127], v[240:243], v[56:59]
ds_read_b64_tr_b16 a[78:79], v116 offset:14336
v_mul_f32 v46, v46, v25
v_mfma_f32_16x16x32_bf16 v[60:63], a[96:99], v[132:135], 0
ds_read_b64_tr_b16 a[80:81], v116 offset:16384
v_mul_f32 v47, v47, v25
v_mfma_f32_16x16x32_bf16 v[60:63], a[100:103], v[148:151], v[60:63]
ds_read_b64_tr_b16 a[82:83], v116 offset:18432
v_cvt_pk_bf16_f32 v36, v36, v37
v_mfma_f32_16x16x32_bf16 v[60:63], a[104:107], v[164:167], v[60:63]
ds_read_b64_tr_b16 a[84:85], v116 offset:20480
v_cvt_pk_bf16_f32 v37, v38, v39
v_mfma_f32_16x16x32_bf16 v[60:63], a[108:111], v[180:183], v[60:63]
ds_read_b64_tr_b16 a[86:87], v116 offset:22528
v_cvt_pk_bf16_f32 v38, v44, v45
v_mfma_f32_16x16x32_bf16 v[60:63], a[112:115], v[196:199], v[60:63]
ds_read_b64_tr_b16 a[88:89], v116 offset:24576
v_cvt_pk_bf16_f32 v39, v46, v47
v_mfma_f32_16x16x32_bf16 v[60:63], a[116:119], v[212:215], v[60:63]
ds_read_b64_tr_b16 a[90:91], v116 offset:26624
buffer_store_dwordx4 v[36:39], v1, s[4:7], s12 offen offset:0 sc1
v_mfma_f32_16x16x32_bf16 v[60:63], a[120:123], v[228:231], v[60:63]
ds_read_b64_tr_b16 a[92:93], v116 offset:28672
v_mfma_f32_16x16x32_bf16 v[60:63], a[124:127], v[244:247], v[60:63]
s_waitcnt lgkmcnt(8)
ds_read_b64_tr_b16 a[94:95], v116 offset:30720
v_add_u32 v116, 65536, v116
v_mfma_f32_16x16x32_bf16 v[64:67], a[64:67], v[128:131], 0
ds_read_b64_tr_b16 a[96:97], v117 offset:0
v_mul_f32 v48, v48, v24
v_mfma_f32_16x16x32_bf16 v[64:67], a[68:71], v[144:147], v[64:67]
ds_read_b64_tr_b16 a[98:99], v117 offset:2048
v_mul_f32 v49, v49, v24
v_mfma_f32_16x16x32_bf16 v[64:67], a[72:75], v[160:163], v[64:67]
s_waitcnt lgkmcnt(8)
ds_read_b64_tr_b16 a[100:101], v117 offset:4096
v_mul_f32 v50, v50, v24
v_mfma_f32_16x16x32_bf16 v[64:67], a[76:79], v[176:179], v[64:67]
ds_read_b64_tr_b16 a[102:103], v117 offset:6144
v_mul_f32 v51, v51, v24
v_mfma_f32_16x16x32_bf16 v[64:67], a[80:83], v[192:195], v[64:67]
s_waitcnt lgkmcnt(8)
ds_read_b64_tr_b16 a[104:105], v117 offset:8192
v_mul_f32 v56, v56, v24
v_mfma_f32_16x16x32_bf16 v[64:67], a[84:87], v[208:211], v[64:67]
s_waitcnt lgkmcnt(7)
ds_read_b64_tr_b16 a[106:107], v117 offset:10240
v_mul_f32 v57, v57, v24
v_mfma_f32_16x16x32_bf16 v[64:67], a[88:91], v[224:227], v[64:67]
s_waitcnt lgkmcnt(6)
ds_read_b64_tr_b16 a[108:109], v117 offset:12288
v_mul_f32 v58, v58, v24
v_mfma_f32_16x16x32_bf16 v[64:67], a[92:95], v[240:243], v[64:67]
ds_read_b64_tr_b16 a[110:111], v117 offset:14336
v_mul_f32 v59, v59, v24
v_mfma_f32_16x16x32_bf16 v[68:71], a[64:67], v[132:135], 0
ds_read_b64_tr_b16 a[112:113], v117 offset:16384
v_cvt_pk_bf16_f32 v48, v48, v49
v_mfma_f32_16x16x32_bf16 v[68:71], a[68:71], v[148:151], v[68:71]
ds_read_b64_tr_b16 a[114:115], v117 offset:18432
v_cvt_pk_bf16_f32 v49, v50, v51
v_mfma_f32_16x16x32_bf16 v[68:71], a[72:75], v[164:167], v[68:71]
ds_read_b64_tr_b16 a[116:117], v117 offset:20480
v_cvt_pk_bf16_f32 v50, v56, v57
v_mfma_f32_16x16x32_bf16 v[68:71], a[76:79], v[180:183], v[68:71]
ds_read_b64_tr_b16 a[118:119], v117 offset:22528
v_cvt_pk_bf16_f32 v51, v58, v59
v_mfma_f32_16x16x32_bf16 v[68:71], a[80:83], v[196:199], v[68:71]
ds_read_b64_tr_b16 a[120:121], v117 offset:24576
buffer_store_dwordx4 v[48:51], v1, s[4:7], s8 offen offset:1024 sc1
v_mfma_f32_16x16x32_bf16 v[68:71], a[84:87], v[212:215], v[68:71]
ds_read_b64_tr_b16 a[122:123], v117 offset:26624
v_mul_f32 v52, v52, v25
v_mfma_f32_16x16x32_bf16 v[68:71], a[88:91], v[228:231], v[68:71]
ds_read_b64_tr_b16 a[124:125], v117 offset:28672
v_mul_f32 v53, v53, v25
v_mfma_f32_16x16x32_bf16 v[68:71], a[92:95], v[244:247], v[68:71]
s_waitcnt lgkmcnt(8)
ds_read_b64_tr_b16 a[126:127], v117 offset:30720
v_add_u32 v117, 65536, v117
v_mfma_f32_16x16x32_bf16 v[72:75], a[96:99], v[128:131], 0
ds_read_b64_tr_b16 a[64:65], v118 offset:0
v_mul_f32 v54, v54, v25
v_mfma_f32_16x16x32_bf16 v[72:75], a[100:103], v[144:147], v[72:75]
ds_read_b64_tr_b16 a[66:67], v118 offset:2048
v_mul_f32 v55, v55, v25
v_mfma_f32_16x16x32_bf16 v[72:75], a[104:107], v[160:163], v[72:75]
s_waitcnt lgkmcnt(8)
ds_read_b64_tr_b16 a[68:69], v118 offset:4096
v_mul_f32 v60, v60, v25
v_mfma_f32_16x16x32_bf16 v[72:75], a[108:111], v[176:179], v[72:75]
ds_read_b64_tr_b16 a[70:71], v118 offset:6144
v_mul_f32 v61, v61, v25
v_mfma_f32_16x16x32_bf16 v[72:75], a[112:115], v[192:195], v[72:75]
s_waitcnt lgkmcnt(8)
ds_read_b64_tr_b16 a[72:73], v118 offset:8192
v_mul_f32 v62, v62, v25
v_mfma_f32_16x16x32_bf16 v[72:75], a[116:119], v[208:211], v[72:75]
s_waitcnt lgkmcnt(7)
ds_read_b64_tr_b16 a[74:75], v118 offset:10240
v_mul_f32 v63, v63, v25
v_mfma_f32_16x16x32_bf16 v[72:75], a[120:123], v[224:227], v[72:75]
s_waitcnt lgkmcnt(6)
ds_read_b64_tr_b16 a[76:77], v118 offset:12288
v_cvt_pk_bf16_f32 v52, v52, v53
v_mfma_f32_16x16x32_bf16 v[72:75], a[124:127], v[240:243], v[72:75]
ds_read_b64_tr_b16 a[78:79], v118 offset:14336
v_cvt_pk_bf16_f32 v53, v54, v55
v_mfma_f32_16x16x32_bf16 v[76:79], a[96:99], v[132:135], 0
ds_read_b64_tr_b16 a[80:81], v118 offset:16384
v_cvt_pk_bf16_f32 v54, v60, v61
v_mfma_f32_16x16x32_bf16 v[76:79], a[100:103], v[148:151], v[76:79]
ds_read_b64_tr_b16 a[82:83], v118 offset:18432
v_cvt_pk_bf16_f32 v55, v62, v63
v_mfma_f32_16x16x32_bf16 v[76:79], a[104:107], v[164:167], v[76:79]
ds_read_b64_tr_b16 a[84:85], v118 offset:20480
buffer_store_dwordx4 v[52:55], v1, s[4:7], s12 offen offset:1024 sc1
v_mfma_f32_16x16x32_bf16 v[76:79], a[108:111], v[180:183], v[76:79]
ds_read_b64_tr_b16 a[86:87], v118 offset:22528
v_mul_u32_u24 v21, 1792, v19
v_mfma_f32_16x16x32_bf16 v[76:79], a[112:115], v[196:199], v[76:79]
ds_read_b64_tr_b16 a[88:89], v118 offset:24576
v_mul_f32 v64, v64, v24
v_mfma_f32_16x16x32_bf16 v[76:79], a[116:119], v[212:215], v[76:79]
ds_read_b64_tr_b16 a[90:91], v118 offset:26624
v_mul_f32 v65, v65, v24
v_mfma_f32_16x16x32_bf16 v[76:79], a[120:123], v[228:231], v[76:79]
ds_read_b64_tr_b16 a[92:93], v118 offset:28672
v_mul_f32 v66, v66, v24
v_mfma_f32_16x16x32_bf16 v[76:79], a[124:127], v[244:247], v[76:79]
s_waitcnt lgkmcnt(8)
ds_read_b64_tr_b16 a[94:95], v118 offset:30720
v_add_u32 v118, 65536, v118
v_mfma_f32_16x16x32_bf16 v[80:83], a[64:67], v[128:131], 0
ds_read_b64_tr_b16 a[96:97], v119 offset:0
v_mul_f32 v67, v67, v24
v_mfma_f32_16x16x32_bf16 v[80:83], a[68:71], v[144:147], v[80:83]
ds_read_b64_tr_b16 a[98:99], v119 offset:2048
v_mul_f32 v72, v72, v24
v_mfma_f32_16x16x32_bf16 v[80:83], a[72:75], v[160:163], v[80:83]
s_waitcnt lgkmcnt(8)
ds_read_b64_tr_b16 a[100:101], v119 offset:4096
v_mul_f32 v73, v73, v24
v_mfma_f32_16x16x32_bf16 v[80:83], a[76:79], v[176:179], v[80:83]
ds_read_b64_tr_b16 a[102:103], v119 offset:6144
v_mul_f32 v74, v74, v24
v_mfma_f32_16x16x32_bf16 v[80:83], a[80:83], v[192:195], v[80:83]
s_waitcnt lgkmcnt(8)
ds_read_b64_tr_b16 a[104:105], v119 offset:8192
v_mul_f32 v75, v75, v24
v_mfma_f32_16x16x32_bf16 v[80:83], a[84:87], v[208:211], v[80:83]
PAD_16:
s_cbranch_execz M_tret
s_waitcnt lgkmcnt(7)
ds_read_b64_tr_b16 a[106:107], v119 offset:10240
v_cvt_pk_bf16_f32 v64, v64, v65
v_mfma_f32_16x16x32_bf16 v[80:83], a[88:91], v[224:227], v[80:83]
s_waitcnt lgkmcnt(6)
ds_read_b64_tr_b16 a[108:109], v119 offset:12288
v_cvt_pk_bf16_f32 v65, v66, v67
v_mfma_f32_16x16x32_bf16 v[80:83], a[92:95], v[240:243], v[80:83]
ds_read_b64_tr_b16 a[110:111], v119 offset:14336
v_cvt_pk_bf16_f32 v66, v72, v73
v_mfma_f32_16x16x32_bf16 v[84:87], a[64:67], v[132:135], 0
ds_read_b64_tr_b16 a[112:113], v119 offset:16384
v_cvt_pk_bf16_f32 v67, v74, v75
v_mfma_f32_16x16x32_bf16 v[84:87], a[68:71], v[148:151], v[84:87]
ds_read_b64_tr_b16 a[114:115], v119 offset:18432
buffer_store_dwordx4 v[64:67], v1, s[4:7], s8 offen offset:2048 sc1
v_mfma_f32_16x16x32_bf16 v[84:87], a[72:75], v[164:167], v[84:87]
ds_read_b64_tr_b16 a[116:117], v119 offset:20480
v_mul_f32 v68, v68, v25
v_mfma_f32_16x16x32_bf16 v[84:87], a[76:79], v[180:183], v[84:87]
ds_read_b64_tr_b16 a[118:119], v119 offset:22528
v_mul_f32 v69, v69, v25
v_mfma_f32_16x16x32_bf16 v[84:87], a[80:83], v[196:199], v[84:87]
ds_read_b64_tr_b16 a[120:121], v119 offset:24576
v_mul_f32 v70, v70, v25
v_mfma_f32_16x16x32_bf16 v[84:87], a[84:87], v[212:215], v[84:87]
ds_read_b64_tr_b16 a[122:123], v119 offset:26624
v_mul_f32 v71, v71, v25
v_mfma_f32_16x16x32_bf16 v[84:87], a[88:91], v[228:231], v[84:87]
ds_read_b64_tr_b16 a[124:125], v119 offset:28672
ds_read_b64_tr_b16 a[126:127], v119 offset:30720
v_mfma_f32_16x16x32_bf16 v[84:87], a[92:95], v[244:247], v[84:87]
s_waitcnt vmcnt(7) lgkmcnt(9)
s_barrier
v_add_u32 v119, 65536, v119
v_mfma_f32_16x16x32_bf16 v[88:91], a[96:99], v[128:131], 0
ds_read_b64_tr_b16 a[64:65], v116 offset:0
v_mul_f32 v76, v76, v25
v_mfma_f32_16x16x32_bf16 v[88:91], a[100:103], v[144:147], v[88:91]
ds_read_b64_tr_b16 a[66:67], v116 offset:2048
buffer_store_dword v6, v5, s[4:7], s34 offen sc1
v_mfma_f32_16x16x32_bf16 v[88:91], a[104:107], v[160:163], v[88:91]
s_waitcnt lgkmcnt(8)
ds_read_b64_tr_b16 a[68:69], v116 offset:4096
v_mul_f32 v77, v77, v25
v_mfma_f32_16x16x32_bf16 v[88:91], a[108:111], v[176:179], v[88:91]
ds_read_b64_tr_b16 a[70:71], v116 offset:6144
v_mul_f32 v78, v78, v25
v_mfma_f32_16x16x32_bf16 v[88:91], a[112:115], v[192:195], v[88:91]
s_waitcnt lgkmcnt(8)
ds_read_b64_tr_b16 a[72:73], v116 offset:8192
v_mul_f32 v79, v79, v25
v_mfma_f32_16x16x32_bf16 v[88:91], a[116:119], v[208:211], v[88:91]
s_waitcnt lgkmcnt(7)
ds_read_b64_tr_b16 a[74:75], v116 offset:10240
v_cvt_pk_bf16_f32 v68, v68, v69
v_mfma_f32_16x16x32_bf16 v[88:91], a[120:123], v[224:227], v[88:91]
s_waitcnt lgkmcnt(6)
ds_read_b64_tr_b16 a[76:77], v116 offset:12288
v_cvt_pk_bf16_f32 v69, v70, v71
v_mfma_f32_16x16x32_bf16 v[88:91], a[124:127], v[240:243], v[88:91]
ds_read_b64_tr_b16 a[78:79], v116 offset:14336
v_cvt_pk_bf16_f32 v70, v76, v77
v_mfma_f32_16x16x32_bf16 v[92:95], a[96:99], v[132:135], 0
ds_read_b64_tr_b16 a[80:81], v116 offset:16384
v_cvt_pk_bf16_f32 v71, v78, v79
v_mfma_f32_16x16x32_bf16 v[92:95], a[100:103], v[148:151], v[92:95]
ds_read_b64_tr_b16 a[82:83], v116 offset:18432
buffer_store_dwordx4 v[68:71], v1, s[4:7], s12 offen offset:2048 sc1
v_mfma_f32_16x16x32_bf16 v[92:95], a[104:107], v[164:167], v[92:95]
ds_read_b64_tr_b16 a[84:85], v116 offset:20480
v_lshlrev_b32 v19, 2, v19
v_mfma_f32_16x16x32_bf16 v[92:95], a[108:111], v[180:183], v[92:95]
ds_read_b64_tr_b16 a[86:87], v116 offset:22528
v_mfma_f32_16x16x32_bf16 v[92:95], a[112:115], v[196:199], v[92:95]
ds_read_b64_tr_b16 a[88:89], v116 offset:24576
v_mfma_f32_16x16x32_bf16 v[92:95], a[116:119], v[212:215], v[92:95]
ds_read_b64_tr_b16 a[90:91], v116 offset:26624
v_mfma_f32_16x16x32_bf16 v[92:95], a[120:123], v[228:231], v[92:95]
ds_read_b64_tr_b16 a[92:93], v116 offset:28672
v_mfma_f32_16x16x32_bf16 v[92:95], a[124:127], v[244:247], v[92:95]
s_waitcnt lgkmcnt(8)
ds_read_b64_tr_b16 a[94:95], v116 offset:30720
v_mfma_f32_16x16x32_bf16 v[32:35], a[64:67], v[128:131], 0
ds_read_b64_tr_b16 a[96:97], v117 offset:0
v_mul_f32 v80, v80, v24
v_mfma_f32_16x16x32_bf16 v[32:35], a[68:71], v[144:147], v[32:35]
ds_read_b64_tr_b16 a[98:99], v117 offset:2048
v_mul_f32 v81, v81, v24
v_mfma_f32_16x16x32_bf16 v[32:35], a[72:75], v[160:163], v[32:35]
s_waitcnt lgkmcnt(8)
ds_read_b64_tr_b16 a[100:101], v117 offset:4096
v_mul_f32 v82, v82, v24
v_mfma_f32_16x16x32_bf16 v[32:35], a[76:79], v[176:179], v[32:35]
ds_read_b64_tr_b16 a[102:103], v117 offset:6144
v_mul_f32 v83, v83, v24
v_mfma_f32_16x16x32_bf16 v[32:35], a[80:83], v[192:195], v[32:35]
s_waitcnt lgkmcnt(8)
ds_read_b64_tr_b16 a[104:105], v117 offset:8192
v_mul_f32 v88, v88, v24
v_mfma_f32_16x16x32_bf16 v[32:35], a[84:87], v[208:211], v[32:35]
s_waitcnt lgkmcnt(7)
ds_read_b64_tr_b16 a[106:107], v117 offset:10240
v_mul_f32 v89, v89, v24
v_mfma_f32_16x16x32_bf16 v[32:35], a[88:91], v[224:227], v[32:35]
s_waitcnt lgkmcnt(6)
ds_read_b64_tr_b16 a[108:109], v117 offset:12288
v_mul_f32 v90, v90, v24
v_mfma_f32_16x16x32_bf16 v[32:35], a[92:95], v[240:243], v[32:35]
ds_read_b64_tr_b16 a[110:111], v117 offset:14336
v_mul_f32 v91, v91, v24
v_mfma_f32_16x16x32_bf16 v[36:39], a[64:67], v[132:135], 0
ds_read_b64_tr_b16 a[112:113], v117 offset:16384
v_cvt_pk_bf16_f32 v80, v80, v81
v_mfma_f32_16x16x32_bf16 v[36:39], a[68:71], v[148:151], v[36:39]
ds_read_b64_tr_b16 a[114:115], v117 offset:18432
v_cvt_pk_bf16_f32 v81, v82, v83
v_mfma_f32_16x16x32_bf16 v[36:39], a[72:75], v[164:167], v[36:39]
ds_read_b64_tr_b16 a[116:117], v117 offset:20480
v_cvt_pk_bf16_f32 v82, v88, v89
v_mfma_f32_16x16x32_bf16 v[36:39], a[76:79], v[180:183], v[36:39]
ds_read_b64_tr_b16 a[118:119], v117 offset:22528
v_cvt_pk_bf16_f32 v83, v90, v91
v_mfma_f32_16x16x32_bf16 v[36:39], a[80:83], v[196:199], v[36:39]
ds_read_b64_tr_b16 a[120:121], v117 offset:24576
buffer_store_dwordx4 v[80:83], v1, s[4:7], s8 offen offset:3072 sc1
v_mfma_f32_16x16x32_bf16 v[36:39], a[84:87], v[212:215], v[36:39]
ds_read_b64_tr_b16 a[122:123], v117 offset:26624
v_mul_f32 v84, v84, v25
v_mfma_f32_16x16x32_bf16 v[36:39], a[88:91], v[228:231], v[36:39]
ds_read_b64_tr_b16 a[124:125], v117 offset:28672
v_mul_f32 v85, v85, v25
v_mfma_f32_16x16x32_bf16 v[36:39], a[92:95], v[244:247], v[36:39]
s_waitcnt lgkmcnt(8)
ds_read_b64_tr_b16 a[126:127], v117 offset:30720
v_mul_f32 v86, v86, v25
v_mfma_f32_16x16x32_bf16 v[40:43], a[96:99], v[128:131], 0
ds_read_b64_tr_b16 a[64:65], v118 offset:0
v_mul_f32 v87, v87, v25
v_mfma_f32_16x16x32_bf16 v[40:43], a[100:103], v[144:147], v[40:43]
ds_read_b64_tr_b16 a[66:67], v118 offset:2048
v_mul_f32 v92, v92, v25
v_mfma_f32_16x16x32_bf16 v[40:43], a[104:107], v[160:163], v[40:43]
s_waitcnt lgkmcnt(8)
ds_read_b64_tr_b16 a[68:69], v118 offset:4096
v_mul_f32 v93, v93, v25
v_mfma_f32_16x16x32_bf16 v[40:43], a[108:111], v[176:179], v[40:43]
ds_read_b64_tr_b16 a[70:71], v118 offset:6144
v_mul_f32 v94, v94, v25
v_mfma_f32_16x16x32_bf16 v[40:43], a[112:115], v[192:195], v[40:43]
s_waitcnt lgkmcnt(8)
ds_read_b64_tr_b16 a[72:73], v118 offset:8192
v_mul_f32 v95, v95, v25
v_mfma_f32_16x16x32_bf16 v[40:43], a[116:119], v[208:211], v[40:43]
s_waitcnt lgkmcnt(7)
ds_read_b64_tr_b16 a[74:75], v118 offset:10240
v_cvt_pk_bf16_f32 v84, v84, v85
v_mfma_f32_16x16x32_bf16 v[40:43], a[120:123], v[224:227], v[40:43]
s_waitcnt lgkmcnt(6)
ds_read_b64_tr_b16 a[76:77], v118 offset:12288
v_cvt_pk_bf16_f32 v85, v86, v87
v_mfma_f32_16x16x32_bf16 v[40:43], a[124:127], v[240:243], v[40:43]
ds_read_b64_tr_b16 a[78:79], v118 offset:14336
v_cvt_pk_bf16_f32 v86, v92, v93
v_mfma_f32_16x16x32_bf16 v[44:47], a[96:99], v[132:135], 0
ds_read_b64_tr_b16 a[80:81], v118 offset:16384
v_cvt_pk_bf16_f32 v87, v94, v95
v_mfma_f32_16x16x32_bf16 v[44:47], a[100:103], v[148:151], v[44:47]
ds_read_b64_tr_b16 a[82:83], v118 offset:18432
buffer_store_dwordx4 v[84:87], v1, s[4:7], s12 offen offset:3072 sc1
v_mfma_f32_16x16x32_bf16 v[44:47], a[104:107], v[164:167], v[44:47]
s_add_u32 s8, s8, 4096
s_add_u32 s12, s12, 4096
ds_read_b64_tr_b16 a[84:85], v118 offset:20480
v_mfma_f32_16x16x32_bf16 v[44:47], a[108:111], v[180:183], v[44:47]
ds_read_b64_tr_b16 a[86:87], v118 offset:22528
v_lshrrev_b32 v22, 4, v20
v_mfma_f32_16x16x32_bf16 v[44:47], a[112:115], v[196:199], v[44:47]
ds_read_b64_tr_b16 a[88:89], v118 offset:24576
v_mul_f32 v32, v32, v24
v_mfma_f32_16x16x32_bf16 v[44:47], a[116:119], v[212:215], v[44:47]
ds_read_b64_tr_b16 a[90:91], v118 offset:26624
v_mul_f32 v33, v33, v24
v_mfma_f32_16x16x32_bf16 v[44:47], a[120:123], v[228:231], v[44:47]
ds_read_b64_tr_b16 a[92:93], v118 offset:28672
v_mul_f32 v34, v34, v24
v_mfma_f32_16x16x32_bf16 v[44:47], a[124:127], v[244:247], v[44:47]
s_waitcnt lgkmcnt(8)
ds_read_b64_tr_b16 a[94:95], v118 offset:30720
v_mul_f32 v35, v35, v24
v_mfma_f32_16x16x32_bf16 v[48:51], a[64:67], v[128:131], 0
ds_read_b64_tr_b16 a[96:97], v119 offset:0
v_mul_f32 v40, v40, v24
v_mfma_f32_16x16x32_bf16 v[48:51], a[68:71], v[144:147], v[48:51]
ds_read_b64_tr_b16 a[98:99], v119 offset:2048
v_mul_f32 v41, v41, v24
v_mfma_f32_16x16x32_bf16 v[48:51], a[72:75], v[160:163], v[48:51]
s_waitcnt lgkmcnt(8)
ds_read_b64_tr_b16 a[100:101], v119 offset:4096
v_mul_f32 v42, v42, v24
v_mfma_f32_16x16x32_bf16 v[48:51], a[76:79], v[176:179], v[48:51]
ds_read_b64_tr_b16 a[102:103], v119 offset:6144
v_mul_f32 v43, v43, v24
v_mfma_f32_16x16x32_bf16 v[48:51], a[80:83], v[192:195], v[48:51]
s_waitcnt lgkmcnt(8)
ds_read_b64_tr_b16 a[104:105], v119 offset:8192
v_cvt_pk_bf16_f32 v32, v32, v33
v_mfma_f32_16x16x32_bf16 v[48:51], a[84:87], v[208:211], v[48:51]
s_waitcnt lgkmcnt(7)
ds_read_b64_tr_b16 a[106:107], v119 offset:10240
v_cvt_pk_bf16_f32 v33, v34, v35
v_mfma_f32_16x16x32_bf16 v[48:51], a[88:91], v[224:227], v[48:51]
s_waitcnt lgkmcnt(6)
ds_read_b64_tr_b16 a[108:109], v119 offset:12288
v_cvt_pk_bf16_f32 v34, v40, v41
v_mfma_f32_16x16x32_bf16 v[48:51], a[92:95], v[240:243], v[48:51]
ds_read_b64_tr_b16 a[110:111], v119 offset:14336
v_cvt_pk_bf16_f32 v35, v42, v43
v_mfma_f32_16x16x32_bf16 v[52:55], a[64:67], v[132:135], 0
ds_read_b64_tr_b16 a[112:113], v119 offset:16384
buffer_store_dwordx4 v[32:35], v1, s[4:7], s8 offen offset:0 sc1
v_mfma_f32_16x16x32_bf16 v[52:55], a[68:71], v[148:151], v[52:55]
ds_read_b64_tr_b16 a[114:115], v119 offset:18432
v_mul_f32 v36, v36, v25
v_mfma_f32_16x16x32_bf16 v[52:55], a[72:75], v[164:167], v[52:55]
ds_read_b64_tr_b16 a[116:117], v119 offset:20480
v_mul_f32 v37, v37, v25
v_mfma_f32_16x16x32_bf16 v[52:55], a[76:79], v[180:183], v[52:55]
ds_read_b64_tr_b16 a[118:119], v119 offset:22528
v_mul_f32 v38, v38, v25
v_mfma_f32_16x16x32_bf16 v[52:55], a[80:83], v[196:199], v[52:55]
ds_read_b64_tr_b16 a[120:121], v119 offset:24576
v_mul_f32 v39, v39, v25
v_mfma_f32_16x16x32_bf16 v[52:55], a[84:87], v[212:215], v[52:55]
ds_read_b64_tr_b16 a[122:123], v119 offset:26624
v_mul_f32 v44, v44, v25
v_mfma_f32_16x16x32_bf16 v[52:55], a[88:91], v[228:231], v[52:55]
ds_read_b64_tr_b16 a[124:125], v119 offset:28672
ds_read_b64_tr_b16 a[126:127], v119 offset:30720
v_mfma_f32_16x16x32_bf16 v[52:55], a[92:95], v[244:247], v[52:55]
s_waitcnt lgkmcnt(9)
v_mul_f32 v45, v45, v25
v_mul_f32 v46, v46, v25
v_mfma_f32_16x16x32_bf16 v[56:59], a[96:99], v[128:131], 0
v_mul_f32 v47, v47, v25
v_cvt_pk_bf16_f32 v36, v36, v37
v_mfma_f32_16x16x32_bf16 v[56:59], a[100:103], v[144:147], v[56:59]
v_cvt_pk_bf16_f32 v37, v38, v39
v_cvt_pk_bf16_f32 v38, v44, v45
v_mfma_f32_16x16x32_bf16 v[56:59], a[104:107], v[160:163], v[56:59]
s_waitcnt lgkmcnt(6)
v_cvt_pk_bf16_f32 v39, v46, v47
v_lshl_add_u32 v21, v22, 3, v21
v_mfma_f32_16x16x32_bf16 v[56:59], a[108:111], v[176:179], v[56:59]
buffer_store_dwordx4 v[36:39], v1, s[4:7], s12 offen offset:0 sc1
v_mfma_f32_16x16x32_bf16 v[56:59], a[112:115], v[192:195], v[56:59]
s_waitcnt lgkmcnt(4)
v_mfma_f32_16x16x32_bf16 v[56:59], a[116:119], v[208:211], v[56:59]
s_waitcnt lgkmcnt(2)
v_mfma_f32_16x16x32_bf16 v[56:59], a[120:123], v[224:227], v[56:59]
s_waitcnt lgkmcnt(0)
v_mfma_f32_16x16x32_bf16 v[56:59], a[124:127], v[240:243], v[56:59]
v_mfma_f32_16x16x32_bf16 v[60:63], a[96:99], v[132:135], 0
v_mfma_f32_16x16x32_bf16 v[60:63], a[100:103], v[148:151], v[60:63]
v_mfma_f32_16x16x32_bf16 v[60:63], a[104:107], v[164:167], v[60:63]
v_mfma_f32_16x16x32_bf16 v[60:63], a[108:111], v[180:183], v[60:63]
v_mfma_f32_16x16x32_bf16 v[60:63], a[112:115], v[196:199], v[60:63]
buffer_load_dword v18, v19, s[4:7], s33 offen offset:0 sc1
v_mfma_f32_16x16x32_bf16 v[60:63], a[116:119], v[212:215], v[60:63]
v_mfma_f32_16x16x32_bf16 v[60:63], a[120:123], v[228:231], v[60:63]
v_mfma_f32_16x16x32_bf16 v[60:63], a[124:127], v[244:247], v[60:63]
v_mul_f32 v48, v48, v24
v_mul_f32 v49, v49, v24
v_mul_f32 v50, v50, v24
v_mul_f32 v51, v51, v24
v_mul_f32 v56, v56, v24
v_mul_f32 v57, v57, v24
v_mul_f32 v58, v58, v24
v_mul_f32 v59, v59, v24
v_cvt_pk_bf16_f32 v48, v48, v49
v_cvt_pk_bf16_f32 v49, v50, v51
v_cvt_pk_bf16_f32 v50, v56, v57
v_cvt_pk_bf16_f32 v51, v58, v59
buffer_store_dwordx4 v[48:51], v1, s[4:7], s8 offen offset:1024 sc1
v_mul_f32 v52, v52, v25
v_mul_f32 v53, v53, v25
v_mul_f32 v54, v54, v25
v_mul_f32 v55, v55, v25
v_mul_f32 v60, v60, v25
v_mul_f32 v61, v61, v25
v_mul_f32 v62, v62, v25
v_mul_f32 v63, v63, v25
v_cvt_pk_bf16_f32 v52, v52, v53
v_cvt_pk_bf16_f32 v53, v54, v55
v_cvt_pk_bf16_f32 v54, v60, v61
v_cvt_pk_bf16_f32 v55, v62, v63
buffer_store_dwordx4 v[52:55], v1, s[4:7], s12 offen offset:1024 sc1
s_and_b32 s22, s2, 224
s_cmp_eq_u32 s22, 224
s_cbranch_scc1 M_final
s_waitcnt vmcnt(0)
s_barrier
buffer_store_dword v6, v5, s[4:7], s35 offen sc1
s_bitcmp0_b32 s2, 4
s_cbranch_scc1 M_rA
v_cmp_gt_u32 vcc, 1, v18
s_cbranch_vccnz M_rslow
M_rjoin:
buffer_load_dwordx4 v[128:131], v1, s[4:7], s26 offen sc1
s_add_u32 s26, s26, 14336
buffer_load_dwordx4 v[132:135], v1, s[4:7], s26 offen sc1
s_add_u32 s26, s26, 14336
buffer_load_dwordx4 v[136:139], v1, s[4:7], s26 offen sc1
s_add_u32 s26, s26, 14336
buffer_load_dwordx4 v[140:143], v1, s[4:7], s26 offen sc1
s_add_u32 s26, s26, 14336
buffer_load_dwordx4 v[144:147], v1, s[4:7], s26 offen sc1
s_add_u32 s26, s26, 14336
buffer_load_dwordx4 v[148:151], v1, s[4:7], s26 offen sc1
s_add_u32 s26, s26, 14336
buffer_load_dwordx4 v[152:155], v1, s[4:7], s26 offen sc1
s_add_u32 s26, s26, 14336
buffer_load_dwordx4 v[156:159], v1, s[4:7], s26 offen sc1
s_add_u32 s26, s26, 14336
buffer_load_dwordx4 v[160:163], v1, s[4:7], s26 offen sc1
s_add_u32 s26, s26, 14336
buffer_load_dwordx4 v[164:167], v1, s[4:7], s26 offen sc1
s_add_u32 s26, s26, 14336
buffer_load_dwordx4 v[168:171], v1, s[4:7], s26 offen sc1
s_add_u32 s26, s26, 14336
buffer_load_dwordx4 v[172:175], v1, s[4:7], s26 offen sc1
s_add_u32 s26, s26, 14336
buffer_load_dwordx4 v[176:179], v1, s[4:7], s26 offen sc1
s_add_u32 s26, s26, 14336
buffer_load_dwordx4 v[180:183], v1, s[4:7], s26 offen sc1
s_add_u32 s26, s26, 14336
buffer_load_dwordx4 v[184:187], v1, s[4:7], s26 offen sc1
s_add_u32 s26, s26, 14336
buffer_load_dwordx4 v[188:191], v1, s[4:7], s26 offen sc1
Lp_9201:
buffer_load_dword v18, v19, s[4:7], s33 offen offset:2048 sc1
s_waitcnt vmcnt(0)
v_cmp_gt_u32 vcc, 1, v18
s_cbranch_vccz Lpd_9202
s_sleep 8
s_sub_u32 s101, s101, 1
s_cbranch_scc0 Lp_9201
s_mov_b32 s101, 0
Lpd_9202:
s_sub_u32 s26, s26, 207872
buffer_load_dwordx4 v[192:195], v1, s[4:7], s26 offen sc1
s_add_u32 s26, s26, 14336
buffer_load_dwordx4 v[196:199], v1, s[4:7], s26 offen sc1
s_add_u32 s26, s26, 14336
buffer_load_dwordx4 v[200:203], v1, s[4:7], s26 offen sc1
s_add_u32 s26, s26, 14336
buffer_load_dwordx4 v[204:207], v1, s[4:7], s26 offen sc1
s_add_u32 s26, s26, 14336
buffer_load_dwordx4 v[208:211], v1, s[4:7], s26 offen sc1
s_add_u32 s26, s26, 14336
buffer_load_dwordx4 v[212:215], v1, s[4:7], s26 offen sc1
s_add_u32 s26, s26, 14336
buffer_load_dwordx4 v[216:219], v1, s[4:7], s26 offen sc1
s_add_u32 s26, s26, 14336
buffer_load_dwordx4 v[220:223], v1, s[4:7], s26 offen sc1
s_add_u32 s26, s26, 14336
buffer_load_dwordx4 v[224:227], v1, s[4:7], s26 offen sc1
s_add_u32 s26, s26, 14336
buffer_load_dwordx4 v[228:231], v1, s[4:7], s26 offen sc1
s_add_u32 s26, s26, 14336
buffer_load_dwordx4 v[232:235], v1, s[4:7], s26 offen sc1
s_add_u32 s26, s26, 14336
buffer_load_dwordx4 v[236:239], v1, s[4:7], s26 offen sc1
s_add_u32 s26, s26, 14336
buffer_load_dwordx4 v[240:243], v1, s[4:7], s26 offen sc1
s_add_u32 s26, s26, 14336
buffer_load_dwordx4 v[244:247], v1, s[4:7], s26 offen sc1
s_add_u32 s26, s26, 14336
buffer_load_dwordx4 v[248:251], v1, s[4:7], s26 offen sc1
s_add_u32 s26, s26, 14336
buffer_load_dwordx4 v[252:255], v1, s[4:7], s26 offen sc1
v_lshlrev_b32 v96, 16, v128
v_and_b32 v97, 0xffff0000, v128
v_lshlrev_b32 v98, 16, v129
v_and_b32 v99, 0xffff0000, v129
v_lshlrev_b32 v100, 16, v130
v_and_b32 v101, 0xffff0000, v130
v_lshlrev_b32 v102, 16, v131
v_and_b32 v103, 0xffff0000, v131
v_lshlrev_b32 v10, 16, v132
v_and_b32 v11, 0xffff0000, v132
v_lshlrev_b32 v12, 16, v133
v_and_b32 v13, 0xffff0000, v133
v_lshlrev_b32 v14, 16, v134
v_and_b32 v15, 0xffff0000, v134
v_lshlrev_b32 v16, 16, v135
v_and_b32 v17, 0xffff0000, v135
v_pk_add_f32 v[96:97], v[96:97], v[10:11]
v_pk_add_f32 v[98:99], v[98:99], v[12:13]
v_pk_add_f32 v[100:101], v[100:101], v[14:15]
v_pk_add_f32 v[102:103], v[102:103], v[16:17]
v_lshlrev_b32 v10, 16, v136
v_and_b32 v11, 0xffff0000, v136
v_lshlrev_b32 v12, 16, v137
v_and_b32 v13, 0xffff0000, v137
v_lshlrev_b32 v14, 16, v138
v_and_b32 v15, 0xffff0000, v138
v_lshlrev_b32 v16, 16, v139
v_and_b32 v17, 0xffff0000, v139
v_pk_add_f32 v[96:97], v[96:97], v[10:11]
v_pk_add_f32 v[98:99], v[98:99], v[12:13]
v_pk_add_f32 v[100:101], v[100:101], v[14:15]
v_pk_add_f32 v[102:103], v[102:103], v[16:17]
v_lshlrev_b32 v10, 16, v140
v_and_b32 v11, 0xffff0000, v140
v_lshlrev_b32 v12, 16, v141
v_and_b32 v13, 0xffff0000, v141
v_lshlrev_b32 v14, 16, v142
v_and_b32 v15, 0xffff0000, v142
v_lshlrev_b32 v16, 16, v143
v_and_b32 v17, 0xffff0000, v143
v_pk_add_f32 v[96:97], v[96:97], v[10:11]
v_pk_add_f32 v[98:99], v[98:99], v[12:13]
v_pk_add_f32 v[100:101], v[100:101], v[14:15]
v_pk_add_f32 v[102:103], v[102:103], v[16:17]
v_lshlrev_b32 v10, 16, v144
v_and_b32 v11, 0xffff0000, v144
v_lshlrev_b32 v12, 16, v145
v_and_b32 v13, 0xffff0000, v145
v_lshlrev_b32 v14, 16, v146
v_and_b32 v15, 0xffff0000, v146
v_lshlrev_b32 v16, 16, v147
v_and_b32 v17, 0xffff0000, v147
v_pk_add_f32 v[96:97], v[96:97], v[10:11]
v_pk_add_f32 v[98:99], v[98:99], v[12:13]
v_pk_add_f32 v[100:101], v[100:101], v[14:15]
v_pk_add_f32 v[102:103], v[102:103], v[16:17]
v_lshlrev_b32 v10, 16, v148
v_and_b32 v11, 0xffff0000, v148
v_lshlrev_b32 v12, 16, v149
v_and_b32 v13, 0xffff0000, v149
v_lshlrev_b32 v14, 16, v150
v_and_b32 v15, 0xffff0000, v150
v_lshlrev_b32 v16, 16, v151
v_and_b32 v17, 0xffff0000, v151
v_pk_add_f32 v[96:97], v[96:97], v[10:11]
v_pk_add_f32 v[98:99], v[98:99], v[12:13]
v_pk_add_f32 v[100:101], v[100:101], v[14:15]
v_pk_add_f32 v[102:103], v[102:103], v[16:17]
v_lshlrev_b32 v10, 16, v152
v_and_b32 v11, 0xffff0000, v152
v_lshlrev_b32 v12, 16, v153
v_and_b32 v13, 0xffff0000, v153
v_lshlrev_b32 v14, 16, v154
v_and_b32 v15, 0xffff0000, v154
v_lshlrev_b32 v16, 16, v155
v_and_b32 v17, 0xffff0000, v155
v_pk_add_f32 v[96:97], v[96:97], v[10:11]
v_pk_add_f32 v[98:99], v[98:99], v[12:13]
v_pk_add_f32 v[100:101], v[100:101], v[14:15]
v_pk_add_f32 v[102:103], v[102:103], v[16:17]
v_lshlrev_b32 v10, 16, v156
v_and_b32 v11, 0xffff0000, v156
v_lshlrev_b32 v12, 16, v157
v_and_b32 v13, 0xffff0000, v157
v_lshlrev_b32 v14, 16, v158
v_and_b32 v15, 0xffff0000, v158
v_lshlrev_b32 v16, 16, v159
v_and_b32 v17, 0xffff0000, v159
v_pk_add_f32 v[96:97], v[96:97], v[10:11]
v_pk_add_f32 v[98:99], v[98:99], v[12:13]
v_pk_add_f32 v[100:101], v[100:101], v[14:15]
v_pk_add_f32 v[102:103], v[102:103], v[16:17]
v_lshlrev_b32 v10, 16, v160
v_and_b32 v11, 0xffff0000, v160
v_lshlrev_b32 v12, 16, v161
v_and_b32 v13, 0xffff0000, v161
v_lshlrev_b32 v14, 16, v162
v_and_b32 v15, 0xffff0000, v162
v_lshlrev_b32 v16, 16, v163
v_and_b32 v17, 0xffff0000, v163
v_pk_add_f32 v[96:97], v[96:97], v[10:11]
v_pk_add_f32 v[98:99], v[98:99], v[12:13]
v_pk_add_f32 v[100:101], v[100:101], v[14:15]
v_pk_add_f32 v[102:103], v[102:103], v[16:17]
v_lshlrev_b32 v10, 16, v164
v_and_b32 v11, 0xffff0000, v164
v_lshlrev_b32 v12, 16, v165
v_and_b32 v13, 0xffff0000, v165
v_lshlrev_b32 v14, 16, v166
v_and_b32 v15, 0xffff0000, v166
v_lshlrev_b32 v16, 16, v167
v_and_b32 v17, 0xffff0000, v167
v_pk_add_f32 v[96:97], v[96:97], v[10:11]
v_pk_add_f32 v[98:99], v[98:99], v[12:13]
v_pk_add_f32 v[100:101], v[100:101], v[14:15]
v_pk_add_f32 v[102:103], v[102:103], v[16:17]
v_lshlrev_b32 v10, 16, v168
v_and_b32 v11, 0xffff0000, v168
v_lshlrev_b32 v12, 16, v169
v_and_b32 v13, 0xffff0000, v169
v_lshlrev_b32 v14, 16, v170
v_and_b32 v15, 0xffff0000, v170
v_lshlrev_b32 v16, 16, v171
v_and_b32 v17, 0xffff0000, v171
v_pk_add_f32 v[96:97], v[96:97], v[10:11]
v_pk_add_f32 v[98:99], v[98:99], v[12:13]
v_pk_add_f32 v[100:101], v[100:101], v[14:15]
v_pk_add_f32 v[102:103], v[102:103], v[16:17]
v_lshlrev_b32 v10, 16, v172
v_and_b32 v11, 0xffff0000, v172
v_lshlrev_b32 v12, 16, v173
v_and_b32 v13, 0xffff0000, v173
v_lshlrev_b32 v14, 16, v174
v_and_b32 v15, 0xffff0000, v174
v_lshlrev_b32 v16, 16, v175
v_and_b32 v17, 0xffff0000, v175
v_pk_add_f32 v[96:97], v[96:97], v[10:11]
v_pk_add_f32 v[98:99], v[98:99], v[12:13]
v_pk_add_f32 v[100:101], v[100:101], v[14:15]
v_pk_add_f32 v[102:103], v[102:103], v[16:17]
v_lshlrev_b32 v10, 16, v176
v_and_b32 v11, 0xffff0000, v176
v_lshlrev_b32 v12, 16, v177
v_and_b32 v13, 0xffff0000, v177
v_lshlrev_b32 v14, 16, v178
v_and_b32 v15, 0xffff0000, v178
v_lshlrev_b32 v16, 16, v179
v_and_b32 v17, 0xffff0000, v179
v_pk_add_f32 v[96:97], v[96:97], v[10:11]
v_pk_add_f32 v[98:99], v[98:99], v[12:13]
v_pk_add_f32 v[100:101], v[100:101], v[14:15]
v_pk_add_f32 v[102:103], v[102:103], v[16:17]
v_lshlrev_b32 v10, 16, v180
v_and_b32 v11, 0xffff0000, v180
v_lshlrev_b32 v12, 16, v181
v_and_b32 v13, 0xffff0000, v181
v_lshlrev_b32 v14, 16, v182
v_and_b32 v15, 0xffff0000, v182
v_lshlrev_b32 v16, 16, v183
v_and_b32 v17, 0xffff0000, v183
v_pk_add_f32 v[96:97], v[96:97], v[10:11]
v_pk_add_f32 v[98:99], v[98:99], v[12:13]
v_pk_add_f32 v[100:101], v[100:101], v[14:15]
v_pk_add_f32 v[102:103], v[102:103], v[16:17]
v_lshlrev_b32 v10, 16, v184
v_and_b32 v11, 0xffff0000, v184
v_lshlrev_b32 v12, 16, v185
v_and_b32 v13, 0xffff0000, v185
v_lshlrev_b32 v14, 16, v186
v_and_b32 v15, 0xffff0000, v186
v_lshlrev_b32 v16, 16, v187
v_and_b32 v17, 0xffff0000, v187
v_pk_add_f32 v[96:97], v[96:97], v[10:11]
v_pk_add_f32 v[98:99], v[98:99], v[12:13]
v_pk_add_f32 v[100:101], v[100:101], v[14:15]
v_pk_add_f32 v[102:103], v[102:103], v[16:17]
v_lshlrev_b32 v10, 16, v188
v_and_b32 v11, 0xffff0000, v188
v_lshlrev_b32 v12, 16, v189
v_and_b32 v13, 0xffff0000, v189
v_lshlrev_b32 v14, 16, v190
v_and_b32 v15, 0xffff0000, v190
v_lshlrev_b32 v16, 16, v191
v_and_b32 v17, 0xffff0000, v191
v_pk_add_f32 v[96:97], v[96:97], v[10:11]
v_pk_add_f32 v[98:99], v[98:99], v[12:13]
v_pk_add_f32 v[100:101], v[100:101], v[14:15]
v_pk_add_f32 v[102:103], v[102:103], v[16:17]
v_cvt_pk_bf16_f32 v96, v96, v97
v_cvt_pk_bf16_f32 v97, v98, v99
v_cvt_pk_bf16_f32 v98, v100, v101
v_cvt_pk_bf16_f32 v99, v102, v103
buffer_store_dwordx2 v[96:97], v21, s[40:43], s25 offen offset:896
buffer_store_dwordx2 v[98:99], v21, s[40:43], s25 offen offset:928
s_waitcnt vmcnt(17)
v_lshlrev_b32 v104, 16, v192
v_and_b32 v105, 0xffff0000, v192
v_lshlrev_b32 v106, 16, v193
v_and_b32 v107, 0xffff0000, v193
v_lshlrev_b32 v108, 16, v194
v_and_b32 v109, 0xffff0000, v194
v_lshlrev_b32 v110, 16, v195
v_and_b32 v111, 0xffff0000, v195
s_waitcnt vmcnt(16)
v_lshlrev_b32 v10, 16, v196
v_and_b32 v11, 0xffff0000, v196
v_lshlrev_b32 v12, 16, v197
v_and_b32 v13, 0xffff0000, v197
v_lshlrev_b32 v14, 16, v198
v_and_b32 v15, 0xffff0000, v198
v_lshlrev_b32 v16, 16, v199
v_and_b32 v17, 0xffff0000, v199
v_pk_add_f32 v[104:105], v[104:105], v[10:11]
v_pk_add_f32 v[106:107], v[106:107], v[12:13]
v_pk_add_f32 v[108:109], v[108:109], v[14:15]
v_pk_add_f32 v[110:111], v[110:111], v[16:17]
s_waitcnt vmcnt(15)
v_lshlrev_b32 v10, 16, v200
v_and_b32 v11, 0xffff0000, v200
v_lshlrev_b32 v12, 16, v201
PAD_17:
s_cbranch_execz M_tret
v_and_b32 v13, 0xffff0000, v201
v_lshlrev_b32 v14, 16, v202
v_and_b32 v15, 0xffff0000, v202
v_lshlrev_b32 v16, 16, v203
v_and_b32 v17, 0xffff0000, v203
v_pk_add_f32 v[104:105], v[104:105], v[10:11]
v_pk_add_f32 v[106:107], v[106:107], v[12:13]
v_pk_add_f32 v[108:109], v[108:109], v[14:15]
v_pk_add_f32 v[110:111], v[110:111], v[16:17]
s_waitcnt vmcnt(14)
v_lshlrev_b32 v10, 16, v204
v_and_b32 v11, 0xffff0000, v204
v_lshlrev_b32 v12, 16, v205
v_and_b32 v13, 0xffff0000, v205
v_lshlrev_b32 v14, 16, v206
v_and_b32 v15, 0xffff0000, v206
v_lshlrev_b32 v16, 16, v207
v_and_b32 v17, 0xffff0000, v207
v_pk_add_f32 v[104:105], v[104:105], v[10:11]
v_pk_add_f32 v[106:107], v[106:107], v[12:13]
v_pk_add_f32 v[108:109], v[108:109], v[14:15]
v_pk_add_f32 v[110:111], v[110:111], v[16:17]
s_waitcnt vmcnt(13)
v_lshlrev_b32 v10, 16, v208
v_and_b32 v11, 0xffff0000, v208
v_lshlrev_b32 v12, 16, v209
v_and_b32 v13, 0xffff0000, v209
v_lshlrev_b32 v14, 16, v210
v_and_b32 v15, 0xffff0000, v210
v_lshlrev_b32 v16, 16, v211
v_and_b32 v17, 0xffff0000, v211
v_pk_add_f32 v[104:105], v[104:105], v[10:11]
v_pk_add_f32 v[106:107], v[106:107], v[12:13]
v_pk_add_f32 v[108:109], v[108:109], v[14:15]
v_pk_add_f32 v[110:111], v[110:111], v[16:17]
s_waitcnt vmcnt(12)
v_lshlrev_b32 v10, 16, v212
v_and_b32 v11, 0xffff0000, v212
v_lshlrev_b32 v12, 16, v213
v_and_b32 v13, 0xffff0000, v213
v_lshlrev_b32 v14, 16, v214
v_and_b32 v15, 0xffff0000, v214
v_lshlrev_b32 v16, 16, v215
v_and_b32 v17, 0xffff0000, v215
v_pk_add_f32 v[104:105], v[104:105], v[10:11]
v_pk_add_f32 v[106:107], v[106:107], v[12:13]
v_pk_add_f32 v[108:109], v[108:109], v[14:15]
v_pk_add_f32 v[110:111], v[110:111], v[16:17]
s_waitcnt vmcnt(11)
v_lshlrev_b32 v10, 16, v216
v_and_b32 v11, 0xffff0000, v216
v_lshlrev_b32 v12, 16, v217
v_and_b32 v13, 0xffff0000, v217
v_lshlrev_b32 v14, 16, v218
v_and_b32 v15, 0xffff0000, v218
v_lshlrev_b32 v16, 16, v219
v_and_b32 v17, 0xffff0000, v219
v_pk_add_f32 v[104:105], v[104:105], v[10:11]
v_pk_add_f32 v[106:107], v[106:107], v[12:13]
v_pk_add_f32 v[108:109], v[108:109], v[14:15]
v_pk_add_f32 v[110:111], v[110:111], v[16:17]
s_waitcnt vmcnt(10)
v_lshlrev_b32 v10, 16, v220
v_and_b32 v11, 0xffff0000, v220
v_lshlrev_b32 v12, 16, v221
v_and_b32 v13, 0xffff0000, v221
v_lshlrev_b32 v14, 16, v222
v_and_b32 v15, 0xffff0000, v222
v_lshlrev_b32 v16, 16, v223
v_and_b32 v17, 0xffff0000, v223
v_pk_add_f32 v[104:105], v[104:105], v[10:11]
v_pk_add_f32 v[106:107], v[106:107], v[12:13]
v_pk_add_f32 v[108:109], v[108:109], v[14:15]
v_pk_add_f32 v[110:111], v[110:111], v[16:17]
s_waitcnt vmcnt(9)
v_lshlrev_b32 v10, 16, v224
v_and_b32 v11, 0xffff0000, v224
v_lshlrev_b32 v12, 16, v225
v_and_b32 v13, 0xffff0000, v225
v_lshlrev_b32 v14, 16, v226
v_and_b32 v15, 0xffff0000, v226
v_lshlrev_b32 v16, 16, v227
v_and_b32 v17, 0xffff0000, v227
v_pk_add_f32 v[104:105], v[104:105], v[10:11]
v_pk_add_f32 v[106:107], v[106:107], v[12:13]
v_pk_add_f32 v[108:109], v[108:109], v[14:15]
v_pk_add_f32 v[110:111], v[110:111], v[16:17]
s_waitcnt vmcnt(8)
v_lshlrev_b32 v10, 16, v228
v_and_b32 v11, 0xffff0000, v228
v_lshlrev_b32 v12, 16, v229
v_and_b32 v13, 0xffff0000, v229
v_lshlrev_b32 v14, 16, v230
v_and_b32 v15, 0xffff0000, v230
v_lshlrev_b32 v16, 16, v231
v_and_b32 v17, 0xffff0000, v231
v_pk_add_f32 v[104:105], v[104:105], v[10:11]
v_pk_add_f32 v[106:107], v[106:107], v[12:13]
v_pk_add_f32 v[108:109], v[108:109], v[14:15]
v_pk_add_f32 v[110:111], v[110:111], v[16:17]
s_waitcnt vmcnt(7)
v_lshlrev_b32 v10, 16, v232
v_and_b32 v11, 0xffff0000, v232
v_lshlrev_b32 v12, 16, v233
v_and_b32 v13, 0xffff0000, v233
v_lshlrev_b32 v14, 16, v234
v_and_b32 v15, 0xffff0000, v234
v_lshlrev_b32 v16, 16, v235
v_and_b32 v17, 0xffff0000, v235
v_pk_add_f32 v[104:105], v[104:105], v[10:11]
v_pk_add_f32 v[106:107], v[106:107], v[12:13]
v_pk_add_f32 v[108:109], v[108:109], v[14:15]
v_pk_add_f32 v[110:111], v[110:111], v[16:17]
s_waitcnt vmcnt(6)
v_lshlrev_b32 v10, 16, v236
v_and_b32 v11, 0xffff0000, v236
v_lshlrev_b32 v12, 16, v237
v_and_b32 v13, 0xffff0000, v237
v_lshlrev_b32 v14, 16, v238
v_and_b32 v15, 0xffff0000, v238
v_lshlrev_b32 v16, 16, v239
v_and_b32 v17, 0xffff0000, v239
v_pk_add_f32 v[104:105], v[104:105], v[10:11]
v_pk_add_f32 v[106:107], v[106:107], v[12:13]
v_pk_add_f32 v[108:109], v[108:109], v[14:15]
v_pk_add_f32 v[110:111], v[110:111], v[16:17]
s_waitcnt vmcnt(5)
v_lshlrev_b32 v10, 16, v240
v_and_b32 v11, 0xffff0000, v240
v_lshlrev_b32 v12, 16, v241
v_and_b32 v13, 0xffff0000, v241
v_lshlrev_b32 v14, 16, v242
v_and_b32 v15, 0xffff0000, v242
v_lshlrev_b32 v16, 16, v243
v_and_b32 v17, 0xffff0000, v243
v_pk_add_f32 v[104:105], v[104:105], v[10:11]
v_pk_add_f32 v[106:107], v[106:107], v[12:13]
v_pk_add_f32 v[108:109], v[108:109], v[14:15]
v_pk_add_f32 v[110:111], v[110:111], v[16:17]
s_waitcnt vmcnt(4)
v_lshlrev_b32 v10, 16, v244
v_and_b32 v11, 0xffff0000, v244
v_lshlrev_b32 v12, 16, v245
v_and_b32 v13, 0xffff0000, v245
v_lshlrev_b32 v14, 16, v246
v_and_b32 v15, 0xffff0000, v246
v_lshlrev_b32 v16, 16, v247
v_and_b32 v17, 0xffff0000, v247
v_pk_add_f32 v[104:105], v[104:105], v[10:11]
v_pk_add_f32 v[106:107], v[106:107], v[12:13]
v_pk_add_f32 v[108:109], v[108:109], v[14:15]
v_pk_add_f32 v[110:111], v[110:111], v[16:17]
s_waitcnt vmcnt(3)
v_lshlrev_b32 v10, 16, v248
v_and_b32 v11, 0xffff0000, v248
v_lshlrev_b32 v12, 16, v249
v_and_b32 v13, 0xffff0000, v249
v_lshlrev_b32 v14, 16, v250
v_and_b32 v15, 0xffff0000, v250
v_lshlrev_b32 v16, 16, v251
v_and_b32 v17, 0xffff0000, v251
v_pk_add_f32 v[104:105], v[104:105], v[10:11]
v_pk_add_f32 v[106:107], v[106:107], v[12:13]
v_pk_add_f32 v[108:109], v[108:109], v[14:15]
v_pk_add_f32 v[110:111], v[110:111], v[16:17]
s_waitcnt vmcnt(2)
v_lshlrev_b32 v10, 16, v252
v_and_b32 v11, 0xffff0000, v252
v_lshlrev_b32 v12, 16, v253
v_and_b32 v13, 0xffff0000, v253
v_lshlrev_b32 v14, 16, v254
v_and_b32 v15, 0xffff0000, v254
v_lshlrev_b32 v16, 16, v255
v_and_b32 v17, 0xffff0000, v255
v_pk_add_f32 v[104:105], v[104:105], v[10:11]
v_pk_add_f32 v[106:107], v[106:107], v[12:13]
v_pk_add_f32 v[108:109], v[108:109], v[14:15]
v_pk_add_f32 v[110:111], v[110:111], v[16:17]
v_cvt_pk_bf16_f32 v104, v104, v105
v_cvt_pk_bf16_f32 v105, v106, v107
v_cvt_pk_bf16_f32 v106, v108, v109
v_cvt_pk_bf16_f32 v107, v110, v111
buffer_store_dwordx2 v[104:105], v21, s[40:43], s25 offen offset:1344
buffer_store_dwordx2 v[106:107], v21, s[40:43], s25 offen offset:1376
s_add_u32 s25, s25, 1835008
s_add_u32 s26, s26, 14457856
s_add_u32 s33, s33, 1024
s_branch M_r1
PAD_18:
s_cbranch_execz M_tret
M_rA:
s_add_u32 s25, s25, 448
s_add_u32 s26, s26, 7168
s_add_u32 s33, s33, 2048
M_r1:
Lp_9203:
buffer_load_dword v18, v19, s[4:7], s33 offen offset:0 sc1
s_waitcnt vmcnt(0)
v_cmp_gt_u32 vcc, 1, v18
s_cbranch_vccz Lpd_9204
s_sleep 8
s_sub_u32 s101, s101, 1
s_cbranch_scc0 Lp_9203
s_mov_b32 s101, 0
Lpd_9204:
buffer_load_dwordx4 v[128:131], v1, s[4:7], s26 offen sc1
s_add_u32 s26, s26, 14336
buffer_load_dwordx4 v[132:135], v1, s[4:7], s26 offen sc1
s_add_u32 s26, s26, 14336
buffer_load_dwordx4 v[136:139], v1, s[4:7], s26 offen sc1
s_add_u32 s26, s26, 14336
buffer_load_dwordx4 v[140:143], v1, s[4:7], s26 offen sc1
s_add_u32 s26, s26, 14336
buffer_load_dwordx4 v[144:147], v1, s[4:7], s26 offen sc1
s_add_u32 s26, s26, 14336
buffer_load_dwordx4 v[148:151], v1, s[4:7], s26 offen sc1
s_add_u32 s26, s26, 14336
buffer_load_dwordx4 v[152:155], v1, s[4:7], s26 offen sc1
s_add_u32 s26, s26, 14336
buffer_load_dwordx4 v[156:159], v1, s[4:7], s26 offen sc1
s_add_u32 s26, s26, 14336
buffer_load_dwordx4 v[160:163], v1, s[4:7], s26 offen sc1
s_add_u32 s26, s26, 14336
buffer_load_dwordx4 v[164:167], v1, s[4:7], s26 offen sc1
s_add_u32 s26, s26, 14336
buffer_load_dwordx4 v[168:171], v1, s[4:7], s26 offen sc1
s_add_u32 s26, s26, 14336
buffer_load_dwordx4 v[172:175], v1, s[4:7], s26 offen sc1
s_add_u32 s26, s26, 14336
buffer_load_dwordx4 v[176:179], v1, s[4:7], s26 offen sc1
s_add_u32 s26, s26, 14336
buffer_load_dwordx4 v[180:183], v1, s[4:7], s26 offen sc1
s_add_u32 s26, s26, 14336
buffer_load_dwordx4 v[184:187], v1, s[4:7], s26 offen sc1
s_add_u32 s26, s26, 14336
buffer_load_dwordx4 v[188:191], v1, s[4:7], s26 offen sc1
s_waitcnt vmcnt(15)
v_lshlrev_b32 v96, 16, v128
v_and_b32 v97, 0xffff0000, v128
v_lshlrev_b32 v98, 16, v129
v_and_b32 v99, 0xffff0000, v129
v_lshlrev_b32 v100, 16, v130
v_and_b32 v101, 0xffff0000, v130
v_lshlrev_b32 v102, 16, v131
v_and_b32 v103, 0xffff0000, v131
s_waitcnt vmcnt(14)
v_lshlrev_b32 v10, 16, v132
v_and_b32 v11, 0xffff0000, v132
v_lshlrev_b32 v12, 16, v133
v_and_b32 v13, 0xffff0000, v133
v_lshlrev_b32 v14, 16, v134
v_and_b32 v15, 0xffff0000, v134
v_lshlrev_b32 v16, 16, v135
v_and_b32 v17, 0xffff0000, v135
v_pk_add_f32 v[96:97], v[96:97], v[10:11]
v_pk_add_f32 v[98:99], v[98:99], v[12:13]
v_pk_add_f32 v[100:101], v[100:101], v[14:15]
v_pk_add_f32 v[102:103], v[102:103], v[16:17]
s_waitcnt vmcnt(13)
v_lshlrev_b32 v10, 16, v136
v_and_b32 v11, 0xffff0000, v136
v_lshlrev_b32 v12, 16, v137
v_and_b32 v13, 0xffff0000, v137
v_lshlrev_b32 v14, 16, v138
v_and_b32 v15, 0xffff0000, v138
v_lshlrev_b32 v16, 16, v139
v_and_b32 v17, 0xffff0000, v139
v_pk_add_f32 v[96:97], v[96:97], v[10:11]
v_pk_add_f32 v[98:99], v[98:99], v[12:13]
v_pk_add_f32 v[100:101], v[100:101], v[14:15]
v_pk_add_f32 v[102:103], v[102:103], v[16:17]
s_waitcnt vmcnt(12)
v_lshlrev_b32 v10, 16, v140
v_and_b32 v11, 0xffff0000, v140
v_lshlrev_b32 v12, 16, v141
v_and_b32 v13, 0xffff0000, v141
v_lshlrev_b32 v14, 16, v142
v_and_b32 v15, 0xffff0000, v142
v_lshlrev_b32 v16, 16, v143
v_and_b32 v17, 0xffff0000, v143
v_pk_add_f32 v[96:97], v[96:97], v[10:11]
v_pk_add_f32 v[98:99], v[98:99], v[12:13]
v_pk_add_f32 v[100:101], v[100:101], v[14:15]
v_pk_add_f32 v[102:103], v[102:103], v[16:17]
s_waitcnt vmcnt(11)
v_lshlrev_b32 v10, 16, v144
v_and_b32 v11, 0xffff0000, v144
v_lshlrev_b32 v12, 16, v145
v_and_b32 v13, 0xffff0000, v145
v_lshlrev_b32 v14, 16, v146
v_and_b32 v15, 0xffff0000, v146
v_lshlrev_b32 v16, 16, v147
v_and_b32 v17, 0xffff0000, v147
v_pk_add_f32 v[96:97], v[96:97], v[10:11]
v_pk_add_f32 v[98:99], v[98:99], v[12:13]
v_pk_add_f32 v[100:101], v[100:101], v[14:15]
v_pk_add_f32 v[102:103], v[102:103], v[16:17]
s_waitcnt vmcnt(10)
v_lshlrev_b32 v10, 16, v148
v_and_b32 v11, 0xffff0000, v148
v_lshlrev_b32 v12, 16, v149
v_and_b32 v13, 0xffff0000, v149
v_lshlrev_b32 v14, 16, v150
v_and_b32 v15, 0xffff0000, v150
v_lshlrev_b32 v16, 16, v151
v_and_b32 v17, 0xffff0000, v151
v_pk_add_f32 v[96:97], v[96:97], v[10:11]
v_pk_add_f32 v[98:99], v[98:99], v[12:13]
v_pk_add_f32 v[100:101], v[100:101], v[14:15]
v_pk_add_f32 v[102:103], v[102:103], v[16:17]
s_waitcnt vmcnt(9)
v_lshlrev_b32 v10, 16, v152
v_and_b32 v11, 0xffff0000, v152
v_lshlrev_b32 v12, 16, v153
v_and_b32 v13, 0xffff0000, v153
v_lshlrev_b32 v14, 16, v154
v_and_b32 v15, 0xffff0000, v154
v_lshlrev_b32 v16, 16, v155
v_and_b32 v17, 0xffff0000, v155
v_pk_add_f32 v[96:97], v[96:97], v[10:11]
v_pk_add_f32 v[98:99], v[98:99], v[12:13]
v_pk_add_f32 v[100:101], v[100:101], v[14:15]
v_pk_add_f32 v[102:103], v[102:103], v[16:17]
s_waitcnt vmcnt(8)
v_lshlrev_b32 v10, 16, v156
v_and_b32 v11, 0xffff0000, v156
v_lshlrev_b32 v12, 16, v157
v_and_b32 v13, 0xffff0000, v157
v_lshlrev_b32 v14, 16, v158
v_and_b32 v15, 0xffff0000, v158
v_lshlrev_b32 v16, 16, v159
v_and_b32 v17, 0xffff0000, v159
v_pk_add_f32 v[96:97], v[96:97], v[10:11]
v_pk_add_f32 v[98:99], v[98:99], v[12:13]
v_pk_add_f32 v[100:101], v[100:101], v[14:15]
v_pk_add_f32 v[102:103], v[102:103], v[16:17]
s_waitcnt vmcnt(7)
v_lshlrev_b32 v10, 16, v160
v_and_b32 v11, 0xffff0000, v160
v_lshlrev_b32 v12, 16, v161
v_and_b32 v13, 0xffff0000, v161
v_lshlrev_b32 v14, 16, v162
v_and_b32 v15, 0xffff0000, v162
v_lshlrev_b32 v16, 16, v163
v_and_b32 v17, 0xffff0000, v163
v_pk_add_f32 v[96:97], v[96:97], v[10:11]
v_pk_add_f32 v[98:99], v[98:99], v[12:13]
v_pk_add_f32 v[100:101], v[100:101], v[14:15]
v_pk_add_f32 v[102:103], v[102:103], v[16:17]
s_waitcnt vmcnt(6)
v_lshlrev_b32 v10, 16, v164
v_and_b32 v11, 0xffff0000, v164
v_lshlrev_b32 v12, 16, v165
v_and_b32 v13, 0xffff0000, v165
v_lshlrev_b32 v14, 16, v166
v_and_b32 v15, 0xffff0000, v166
v_lshlrev_b32 v16, 16, v167
v_and_b32 v17, 0xffff0000, v167
v_pk_add_f32 v[96:97], v[96:97], v[10:11]
v_pk_add_f32 v[98:99], v[98:99], v[12:13]
v_pk_add_f32 v[100:101], v[100:101], v[14:15]
v_pk_add_f32 v[102:103], v[102:103], v[16:17]
s_waitcnt vmcnt(5)
v_lshlrev_b32 v10, 16, v168
v_and_b32 v11, 0xffff0000, v168
v_lshlrev_b32 v12, 16, v169
v_and_b32 v13, 0xffff0000, v169
v_lshlrev_b32 v14, 16, v170
v_and_b32 v15, 0xffff0000, v170
v_lshlrev_b32 v16, 16, v171
v_and_b32 v17, 0xffff0000, v171
v_pk_add_f32 v[96:97], v[96:97], v[10:11]
v_pk_add_f32 v[98:99], v[98:99], v[12:13]
v_pk_add_f32 v[100:101], v[100:101], v[14:15]
v_pk_add_f32 v[102:103], v[102:103], v[16:17]
s_waitcnt vmcnt(4)
v_lshlrev_b32 v10, 16, v172
v_and_b32 v11, 0xffff0000, v172
v_lshlrev_b32 v12, 16, v173
v_and_b32 v13, 0xffff0000, v173
v_lshlrev_b32 v14, 16, v174
v_and_b32 v15, 0xffff0000, v174
v_lshlrev_b32 v16, 16, v175
v_and_b32 v17, 0xffff0000, v175
v_pk_add_f32 v[96:97], v[96:97], v[10:11]
v_pk_add_f32 v[98:99], v[98:99], v[12:13]
v_pk_add_f32 v[100:101], v[100:101], v[14:15]
v_pk_add_f32 v[102:103], v[102:103], v[16:17]
s_waitcnt vmcnt(3)
v_lshlrev_b32 v10, 16, v176
v_and_b32 v11, 0xffff0000, v176
v_lshlrev_b32 v12, 16, v177
v_and_b32 v13, 0xffff0000, v177
v_lshlrev_b32 v14, 16, v178
v_and_b32 v15, 0xffff0000, v178
v_lshlrev_b32 v16, 16, v179
v_and_b32 v17, 0xffff0000, v179
v_pk_add_f32 v[96:97], v[96:97], v[10:11]
v_pk_add_f32 v[98:99], v[98:99], v[12:13]
v_pk_add_f32 v[100:101], v[100:101], v[14:15]
v_pk_add_f32 v[102:103], v[102:103], v[16:17]
s_waitcnt vmcnt(2)
v_lshlrev_b32 v10, 16, v180
v_and_b32 v11, 0xffff0000, v180
v_lshlrev_b32 v12, 16, v181
v_and_b32 v13, 0xffff0000, v181
v_lshlrev_b32 v14, 16, v182
v_and_b32 v15, 0xffff0000, v182
v_lshlrev_b32 v16, 16, v183
v_and_b32 v17, 0xffff0000, v183
v_pk_add_f32 v[96:97], v[96:97], v[10:11]
v_pk_add_f32 v[98:99], v[98:99], v[12:13]
v_pk_add_f32 v[100:101], v[100:101], v[14:15]
v_pk_add_f32 v[102:103], v[102:103], v[16:17]
s_waitcnt vmcnt(1)
v_lshlrev_b32 v10, 16, v184
v_and_b32 v11, 0xffff0000, v184
v_lshlrev_b32 v12, 16, v185
v_and_b32 v13, 0xffff0000, v185
v_lshlrev_b32 v14, 16, v186
v_and_b32 v15, 0xffff0000, v186
v_lshlrev_b32 v16, 16, v187
v_and_b32 v17, 0xffff0000, v187
v_pk_add_f32 v[96:97], v[96:97], v[10:11]
v_pk_add_f32 v[98:99], v[98:99], v[12:13]
v_pk_add_f32 v[100:101], v[100:101], v[14:15]
v_pk_add_f32 v[102:103], v[102:103], v[16:17]
s_waitcnt vmcnt(0)
v_lshlrev_b32 v10, 16, v188
v_and_b32 v11, 0xffff0000, v188
v_lshlrev_b32 v12, 16, v189
v_and_b32 v13, 0xffff0000, v189
v_lshlrev_b32 v14, 16, v190
v_and_b32 v15, 0xffff0000, v190
v_lshlrev_b32 v16, 16, v191
v_and_b32 v17, 0xffff0000, v191
v_pk_add_f32 v[96:97], v[96:97], v[10:11]
v_pk_add_f32 v[98:99], v[98:99], v[12:13]
v_pk_add_f32 v[100:101], v[100:101], v[14:15]
v_pk_add_f32 v[102:103], v[102:103], v[16:17]
v_cvt_pk_bf16_f32 v96, v96, v97
v_cvt_pk_bf16_f32 v97, v98, v99
v_cvt_pk_bf16_f32 v98, v100, v101
v_cvt_pk_bf16_f32 v99, v102, v103
buffer_store_dwordx2 v[96:97], v21, s[40:43], s25 offen offset:896
buffer_store_dwordx2 v[98:99], v21, s[40:43], s25 offen offset:928
M_fin:
s_endpgm
PAD_19:
s_cbranch_execz M_tret
M_final:
s_mov_b32 s8, s64
s_mov_b32 s9, s65
s_mov_b32 s10, 1835008
s_mov_b32 s11, 0x20000
s_mov_b32 s12, s88
s_mov_b32 s13, s89
s_mov_b32 s14, 3670016
s_mov_b32 s15, 0x20000
s_and_b32 s24, s2, 16
s_add_u32 s24, s24, s20
v_lshrrev_b32 v20, 4, v1
v_and_b32 v21, 15, v20
v_lshrrev_b32 v22, 4, v20
v_mul_u32_u24 v2, 896, v21
v_lshlrev_b32 v9, 1, v2
v_lshl_add_u32 v2, v22, 4, v2
v_lshl_add_u32 v9, v22, 4, v9
s_lshl_b32 s22, s24, 2
s_add_u32 s22, s22, s3
s_mul_i32 s25, s22, 14336
s_lshl_b32 s26, s25, 1
v_lshlrev_b32 v10, 5, v22
v_add3_u32 v10, v10, v21, 16
v_lshlrev_b32 v10, 2, v10
v_min_u32 v11, 380, v10
v_add_u32 v11, 512, v11
s_mov_b32 s27, 94384128
Lfp:
buffer_load_dword v3, v10, s[4:7], s27 offen sc1
buffer_load_dword v4, v11, s[4:7], s27 offen sc1
s_waitcnt vmcnt(0)
v_and_b32 v3, v3, v4
v_cmp_gt_u32 vcc, 1, v3
s_cbranch_vccz Lfpd
s_sleep 2
s_sub_u32 s101, s101, 1
s_cbranch_scc0 Lfp
s_mov_b32 s101, 0
Lfpd:
s_barrier
buffer_store_dword v6, v5, s[4:7], s35 offen sc1
Lfg:
v_lshrrev_b32 v3, 3, v20
v_and_b32 v4, 7, v20
v_lshlrev_b32 v4, 4, v4
v_lshl_add_u32 v3, v3, 12, v4
s_mul_i32 s27, s3, 458752
s_lshl_b32 s22, s24, 7
s_add_u32 s27, s27, s22
s_add_u32 s27, s27, 88080384
s_mul_i32 s28, s3, 14336
s_add_u32 m0, s28, 0
s_nop 0
buffer_load_dwordx4 v3, s[4:7], s27 offen sc1 lds
s_add_u32 s27, s27, 32768
s_add_u32 m0, s28, 1024
s_nop 0
buffer_load_dwordx4 v3, s[4:7], s27 offen sc1 lds
s_add_u32 s27, s27, 32768
s_add_u32 m0, s28, 2048
s_nop 0
buffer_load_dwordx4 v3, s[4:7], s27 offen sc1 lds
s_add_u32 s27, s27, 32768
s_add_u32 m0, s28, 3072
s_nop 0
buffer_load_dwordx4 v3, s[4:7], s27 offen sc1 lds
s_add_u32 s27, s27, 32768
s_add_u32 m0, s28, 4096
s_nop 0
buffer_load_dwordx4 v3, s[4:7], s27 offen sc1 lds
s_add_u32 s27, s27, 32768
s_add_u32 m0, s28, 5120
s_nop 0
buffer_load_dwordx4 v3, s[4:7], s27 offen sc1 lds
s_add_u32 s27, s27, 32768
s_add_u32 m0, s28, 6144
s_nop 0
buffer_load_dwordx4 v3, s[4:7], s27 offen sc1 lds
s_add_u32 s27, s27, 32768
s_add_u32 m0, s28, 7168
s_nop 0
buffer_load_dwordx4 v3, s[4:7], s27 offen sc1 lds
s_add_u32 s27, s27, 32768
s_add_u32 m0, s28, 8192
s_nop 0
buffer_load_dwordx4 v3, s[4:7], s27 offen sc1 lds
s_add_u32 s27, s27, 32768
s_add_u32 m0, s28, 9216
s_nop 0
buffer_load_dwordx4 v3, s[4:7], s27 offen sc1 lds
s_add_u32 s27, s27, 32768
s_add_u32 m0, s28, 10240
s_nop 0
buffer_load_dwordx4 v3, s[4:7], s27 offen sc1 lds
s_add_u32 s27, s27, 32768
s_add_u32 m0, s28, 11264
s_nop 0
buffer_load_dwordx4 v3, s[4:7], s27 offen sc1 lds
s_add_u32 s27, s27, 32768
s_add_u32 m0, s28, 12288
s_nop 0
buffer_load_dwordx4 v3, s[4:7], s27 offen sc1 lds
s_add_u32 s27, s27, 32768
s_add_u32 m0, s28, 13312
s_nop 0
buffer_load_dwordx4 v3, s[4:7], s27 offen sc1 lds
s_add_u32 s27, s27, 32768
buffer_load_dwordx4 v[160:163], v2, s[8:11], s25 offen offset:0
buffer_load_dwordx4 v[164:167], v2, s[8:11], s25 offen offset:64
buffer_load_dwordx4 v[168:171], v2, s[8:11], s25 offen offset:128
buffer_load_dwordx4 v[172:175], v2, s[8:11], s25 offen offset:192
buffer_load_dwordx4 v[176:179], v2, s[8:11], s25 offen offset:256
buffer_load_dwordx4 v[180:183], v2, s[8:11], s25 offen offset:320
buffer_load_dwordx4 v[184:187], v2, s[8:11], s25 offen offset:384
buffer_load_dwordx4 v[188:191], v2, s[8:11], s25 offen offset:448
buffer_load_dwordx4 v[192:195], v2, s[8:11], s25 offen offset:512
buffer_load_dwordx4 v[196:199], v2, s[8:11], s25 offen offset:576
buffer_load_dwordx4 v[200:203], v2, s[8:11], s25 offen offset:640
buffer_load_dwordx4 v[204:207], v2, s[8:11], s25 offen offset:704
buffer_load_dwordx4 v[208:211], v2, s[8:11], s25 offen offset:768
buffer_load_dwordx4 v[212:215], v2, s[8:11], s25 offen offset:832
v_lshrrev_b32 v3, 2, v21
v_lshl_add_u32 v3, v22, 3, v3
v_lshlrev_b32 v3, 7, v3
v_and_b32 v4, 3, v20
v_lshl_add_u32 v3, v4, 3, v3
s_lshl_b32 s22, s3, 5
v_add_u32 v3, s22, v3
s_waitcnt vmcnt(14)
s_barrier
ds_read_b64_tr_b16 v[96:97], v3 offset:0
ds_read_b64_tr_b16 v[98:99], v3 offset:512
ds_read_b64_tr_b16 v[100:101], v3 offset:4096
ds_read_b64_tr_b16 v[102:103], v3 offset:4608
ds_read_b64_tr_b16 v[104:105], v3 offset:8192
ds_read_b64_tr_b16 v[106:107], v3 offset:8704
ds_read_b64_tr_b16 v[108:109], v3 offset:12288
ds_read_b64_tr_b16 v[110:111], v3 offset:12800
ds_read_b64_tr_b16 v[112:113], v3 offset:16384
ds_read_b64_tr_b16 v[114:115], v3 offset:16896
ds_read_b64_tr_b16 v[116:117], v3 offset:20480
ds_read_b64_tr_b16 v[118:119], v3 offset:20992
ds_read_b64_tr_b16 v[120:121], v3 offset:24576
ds_read_b64_tr_b16 v[122:123], v3 offset:25088
s_waitcnt lgkmcnt(0)
ds_read_b64_tr_b16 v[124:125], v3 offset:28672
ds_read_b64_tr_b16 v[126:127], v3 offset:29184
ds_read_b64_tr_b16 v[128:129], v3 offset:32768
ds_read_b64_tr_b16 v[130:131], v3 offset:33280
ds_read_b64_tr_b16 v[132:133], v3 offset:36864
ds_read_b64_tr_b16 v[134:135], v3 offset:37376
ds_read_b64_tr_b16 v[136:137], v3 offset:40960
ds_read_b64_tr_b16 v[138:139], v3 offset:41472
ds_read_b64_tr_b16 v[140:141], v3 offset:45056
ds_read_b64_tr_b16 v[142:143], v3 offset:45568
ds_read_b64_tr_b16 v[144:145], v3 offset:49152
ds_read_b64_tr_b16 v[146:147], v3 offset:49664
ds_read_b64_tr_b16 v[148:149], v3 offset:53248
ds_read_b64_tr_b16 v[150:151], v3 offset:53760
s_waitcnt vmcnt(13)
v_lshlrev_b32 v10, 16, v160
v_and_b32 v11, 0xffff0000, v160
v_lshlrev_b32 v12, 16, v96
v_and_b32 v13, 0xffff0000, v96
v_pk_mul_f32 v[10:11], v[10:11], v[12:13]
v_cvt_pk_bf16_f32 v160, v10, v11
v_lshlrev_b32 v10, 16, v161
v_and_b32 v11, 0xffff0000, v161
v_lshlrev_b32 v12, 16, v97
v_and_b32 v13, 0xffff0000, v97
v_pk_mul_f32 v[10:11], v[10:11], v[12:13]
v_cvt_pk_bf16_f32 v161, v10, v11
v_lshlrev_b32 v10, 16, v162
v_and_b32 v11, 0xffff0000, v162
v_lshlrev_b32 v12, 16, v98
v_and_b32 v13, 0xffff0000, v98
v_pk_mul_f32 v[10:11], v[10:11], v[12:13]
v_cvt_pk_bf16_f32 v162, v10, v11
v_lshlrev_b32 v10, 16, v163
v_and_b32 v11, 0xffff0000, v163
v_lshlrev_b32 v12, 16, v99
PAD_20:
s_cbranch_execz M_tret
v_and_b32 v13, 0xffff0000, v99
v_pk_mul_f32 v[10:11], v[10:11], v[12:13]
v_cvt_pk_bf16_f32 v163, v10, v11
buffer_store_dwordx4 v[160:163], v9, s[12:15], s26 offen offset:0
s_waitcnt vmcnt(13)
v_lshlrev_b32 v10, 16, v164
v_and_b32 v11, 0xffff0000, v164
v_lshlrev_b32 v12, 16, v100
v_and_b32 v13, 0xffff0000, v100
v_pk_mul_f32 v[10:11], v[10:11], v[12:13]
v_cvt_pk_bf16_f32 v164, v10, v11
v_lshlrev_b32 v10, 16, v165
v_and_b32 v11, 0xffff0000, v165
v_lshlrev_b32 v12, 16, v101
v_and_b32 v13, 0xffff0000, v101
v_pk_mul_f32 v[10:11], v[10:11], v[12:13]
v_cvt_pk_bf16_f32 v165, v10, v11
v_lshlrev_b32 v10, 16, v166
v_and_b32 v11, 0xffff0000, v166
v_lshlrev_b32 v12, 16, v102
v_and_b32 v13, 0xffff0000, v102
v_pk_mul_f32 v[10:11], v[10:11], v[12:13]
v_cvt_pk_bf16_f32 v166, v10, v11
v_lshlrev_b32 v10, 16, v167
v_and_b32 v11, 0xffff0000, v167
v_lshlrev_b32 v12, 16, v103
v_and_b32 v13, 0xffff0000, v103
v_pk_mul_f32 v[10:11], v[10:11], v[12:13]
v_cvt_pk_bf16_f32 v167, v10, v11
buffer_store_dwordx4 v[164:167], v9, s[12:15], s26 offen offset:64
s_waitcnt vmcnt(13)
v_lshlrev_b32 v10, 16, v168
v_and_b32 v11, 0xffff0000, v168
v_lshlrev_b32 v12, 16, v104
v_and_b32 v13, 0xffff0000, v104
v_pk_mul_f32 v[10:11], v[10:11], v[12:13]
v_cvt_pk_bf16_f32 v168, v10, v11
v_lshlrev_b32 v10, 16, v169
v_and_b32 v11, 0xffff0000, v169
v_lshlrev_b32 v12, 16, v105
v_and_b32 v13, 0xffff0000, v105
v_pk_mul_f32 v[10:11], v[10:11], v[12:13]
v_cvt_pk_bf16_f32 v169, v10, v11
v_lshlrev_b32 v10, 16, v170
v_and_b32 v11, 0xffff0000, v170
v_lshlrev_b32 v12, 16, v106
v_and_b32 v13, 0xffff0000, v106
v_pk_mul_f32 v[10:11], v[10:11], v[12:13]
v_cvt_pk_bf16_f32 v170, v10, v11
v_lshlrev_b32 v10, 16, v171
v_and_b32 v11, 0xffff0000, v171
v_lshlrev_b32 v12, 16, v107
v_and_b32 v13, 0xffff0000, v107
v_pk_mul_f32 v[10:11], v[10:11], v[12:13]
v_cvt_pk_bf16_f32 v171, v10, v11
buffer_store_dwordx4 v[168:171], v9, s[12:15], s26 offen offset:128
s_waitcnt vmcnt(13)
v_lshlrev_b32 v10, 16, v172
v_and_b32 v11, 0xffff0000, v172
v_lshlrev_b32 v12, 16, v108
v_and_b32 v13, 0xffff0000, v108
v_pk_mul_f32 v[10:11], v[10:11], v[12:13]
v_cvt_pk_bf16_f32 v172, v10, v11
v_lshlrev_b32 v10, 16, v173
v_and_b32 v11, 0xffff0000, v173
v_lshlrev_b32 v12, 16, v109
v_and_b32 v13, 0xffff0000, v109
v_pk_mul_f32 v[10:11], v[10:11], v[12:13]
v_cvt_pk_bf16_f32 v173, v10, v11
v_lshlrev_b32 v10, 16, v174
v_and_b32 v11, 0xffff0000, v174
v_lshlrev_b32 v12, 16, v110
v_and_b32 v13, 0xffff0000, v110
v_pk_mul_f32 v[10:11], v[10:11], v[12:13]
v_cvt_pk_bf16_f32 v174, v10, v11
v_lshlrev_b32 v10, 16, v175
v_and_b32 v11, 0xffff0000, v175
v_lshlrev_b32 v12, 16, v111
v_and_b32 v13, 0xffff0000, v111
v_pk_mul_f32 v[10:11], v[10:11], v[12:13]
v_cvt_pk_bf16_f32 v175, v10, v11
buffer_store_dwordx4 v[172:175], v9, s[12:15], s26 offen offset:192
s_waitcnt vmcnt(13)
v_lshlrev_b32 v10, 16, v176
v_and_b32 v11, 0xffff0000, v176
v_lshlrev_b32 v12, 16, v112
v_and_b32 v13, 0xffff0000, v112
v_pk_mul_f32 v[10:11], v[10:11], v[12:13]
v_cvt_pk_bf16_f32 v176, v10, v11
v_lshlrev_b32 v10, 16, v177
v_and_b32 v11, 0xffff0000, v177
v_lshlrev_b32 v12, 16, v113
v_and_b32 v13, 0xffff0000, v113
v_pk_mul_f32 v[10:11], v[10:11], v[12:13]
v_cvt_pk_bf16_f32 v177, v10, v11
v_lshlrev_b32 v10, 16, v178
v_and_b32 v11, 0xffff0000, v178
v_lshlrev_b32 v12, 16, v114
v_and_b32 v13, 0xffff0000, v114
v_pk_mul_f32 v[10:11], v[10:11], v[12:13]
v_cvt_pk_bf16_f32 v178, v10, v11
v_lshlrev_b32 v10, 16, v179
v_and_b32 v11, 0xffff0000, v179
v_lshlrev_b32 v12, 16, v115
v_and_b32 v13, 0xffff0000, v115
v_pk_mul_f32 v[10:11], v[10:11], v[12:13]
v_cvt_pk_bf16_f32 v179, v10, v11
buffer_store_dwordx4 v[176:179], v9, s[12:15], s26 offen offset:256
s_waitcnt vmcnt(13)
v_lshlrev_b32 v10, 16, v180
v_and_b32 v11, 0xffff0000, v180
v_lshlrev_b32 v12, 16, v116
v_and_b32 v13, 0xffff0000, v116
v_pk_mul_f32 v[10:11], v[10:11], v[12:13]
v_cvt_pk_bf16_f32 v180, v10, v11
v_lshlrev_b32 v10, 16, v181
v_and_b32 v11, 0xffff0000, v181
v_lshlrev_b32 v12, 16, v117
v_and_b32 v13, 0xffff0000, v117
v_pk_mul_f32 v[10:11], v[10:11], v[12:13]
v_cvt_pk_bf16_f32 v181, v10, v11
v_lshlrev_b32 v10, 16, v182
v_and_b32 v11, 0xffff0000, v182
v_lshlrev_b32 v12, 16, v118
v_and_b32 v13, 0xffff0000, v118
v_pk_mul_f32 v[10:11], v[10:11], v[12:13]
v_cvt_pk_bf16_f32 v182, v10, v11
v_lshlrev_b32 v10, 16, v183
v_and_b32 v11, 0xffff0000, v183
v_lshlrev_b32 v12, 16, v119
v_and_b32 v13, 0xffff0000, v119
v_pk_mul_f32 v[10:11], v[10:11], v[12:13]
v_cvt_pk_bf16_f32 v183, v10, v11
buffer_store_dwordx4 v[180:183], v9, s[12:15], s26 offen offset:320
s_waitcnt vmcnt(13)
v_lshlrev_b32 v10, 16, v184
v_and_b32 v11, 0xffff0000, v184
v_lshlrev_b32 v12, 16, v120
v_and_b32 v13, 0xffff0000, v120
v_pk_mul_f32 v[10:11], v[10:11], v[12:13]
v_cvt_pk_bf16_f32 v184, v10, v11
v_lshlrev_b32 v10, 16, v185
v_and_b32 v11, 0xffff0000, v185
v_lshlrev_b32 v12, 16, v121
v_and_b32 v13, 0xffff0000, v121
v_pk_mul_f32 v[10:11], v[10:11], v[12:13]
v_cvt_pk_bf16_f32 v185, v10, v11
v_lshlrev_b32 v10, 16, v186
v_and_b32 v11, 0xffff0000, v186
v_lshlrev_b32 v12, 16, v122
v_and_b32 v13, 0xffff0000, v122
v_pk_mul_f32 v[10:11], v[10:11], v[12:13]
v_cvt_pk_bf16_f32 v186, v10, v11
v_lshlrev_b32 v10, 16, v187
v_and_b32 v11, 0xffff0000, v187
v_lshlrev_b32 v12, 16, v123
v_and_b32 v13, 0xffff0000, v123
v_pk_mul_f32 v[10:11], v[10:11], v[12:13]
v_cvt_pk_bf16_f32 v187, v10, v11
buffer_store_dwordx4 v[184:187], v9, s[12:15], s26 offen offset:384
s_waitcnt lgkmcnt(0)
s_waitcnt vmcnt(13)
v_lshlrev_b32 v10, 16, v188
v_and_b32 v11, 0xffff0000, v188
v_lshlrev_b32 v12, 16, v124
v_and_b32 v13, 0xffff0000, v124
v_pk_mul_f32 v[10:11], v[10:11], v[12:13]
v_cvt_pk_bf16_f32 v188, v10, v11
v_lshlrev_b32 v10, 16, v189
v_and_b32 v11, 0xffff0000, v189
v_lshlrev_b32 v12, 16, v125
v_and_b32 v13, 0xffff0000, v125
v_pk_mul_f32 v[10:11], v[10:11], v[12:13]
v_cvt_pk_bf16_f32 v189, v10, v11
v_lshlrev_b32 v10, 16, v190
v_and_b32 v11, 0xffff0000, v190
v_lshlrev_b32 v12, 16, v126
v_and_b32 v13, 0xffff0000, v126
v_pk_mul_f32 v[10:11], v[10:11], v[12:13]
v_cvt_pk_bf16_f32 v190, v10, v11
v_lshlrev_b32 v10, 16, v191
v_and_b32 v11, 0xffff0000, v191
v_lshlrev_b32 v12, 16, v127
v_and_b32 v13, 0xffff0000, v127
v_pk_mul_f32 v[10:11], v[10:11], v[12:13]
v_cvt_pk_bf16_f32 v191, v10, v11
buffer_store_dwordx4 v[188:191], v9, s[12:15], s26 offen offset:448
s_waitcnt vmcnt(13)
v_lshlrev_b32 v10, 16, v192
v_and_b32 v11, 0xffff0000, v192
v_lshlrev_b32 v12, 16, v128
v_and_b32 v13, 0xffff0000, v128
v_pk_mul_f32 v[10:11], v[10:11], v[12:13]
v_cvt_pk_bf16_f32 v192, v10, v11
v_lshlrev_b32 v10, 16, v193
v_and_b32 v11, 0xffff0000, v193
v_lshlrev_b32 v12, 16, v129
v_and_b32 v13, 0xffff0000, v129
v_pk_mul_f32 v[10:11], v[10:11], v[12:13]
v_cvt_pk_bf16_f32 v193, v10, v11
v_lshlrev_b32 v10, 16, v194
v_and_b32 v11, 0xffff0000, v194
v_lshlrev_b32 v12, 16, v130
v_and_b32 v13, 0xffff0000, v130
v_pk_mul_f32 v[10:11], v[10:11], v[12:13]
v_cvt_pk_bf16_f32 v194, v10, v11
v_lshlrev_b32 v10, 16, v195
v_and_b32 v11, 0xffff0000, v195
v_lshlrev_b32 v12, 16, v131
v_and_b32 v13, 0xffff0000, v131
v_pk_mul_f32 v[10:11], v[10:11], v[12:13]
v_cvt_pk_bf16_f32 v195, v10, v11
buffer_store_dwordx4 v[192:195], v9, s[12:15], s26 offen offset:512
s_waitcnt vmcnt(13)
v_lshlrev_b32 v10, 16, v196
v_and_b32 v11, 0xffff0000, v196
v_lshlrev_b32 v12, 16, v132
v_and_b32 v13, 0xffff0000, v132
v_pk_mul_f32 v[10:11], v[10:11], v[12:13]
v_cvt_pk_bf16_f32 v196, v10, v11
v_lshlrev_b32 v10, 16, v197
v_and_b32 v11, 0xffff0000, v197
v_lshlrev_b32 v12, 16, v133
v_and_b32 v13, 0xffff0000, v133
v_pk_mul_f32 v[10:11], v[10:11], v[12:13]
v_cvt_pk_bf16_f32 v197, v10, v11
v_lshlrev_b32 v10, 16, v198
v_and_b32 v11, 0xffff0000, v198
v_lshlrev_b32 v12, 16, v134
v_and_b32 v13, 0xffff0000, v134
v_pk_mul_f32 v[10:11], v[10:11], v[12:13]
v_cvt_pk_bf16_f32 v198, v10, v11
v_lshlrev_b32 v10, 16, v199
v_and_b32 v11, 0xffff0000, v199
v_lshlrev_b32 v12, 16, v135
v_and_b32 v13, 0xffff0000, v135
v_pk_mul_f32 v[10:11], v[10:11], v[12:13]
v_cvt_pk_bf16_f32 v199, v10, v11
buffer_store_dwordx4 v[196:199], v9, s[12:15], s26 offen offset:576
s_waitcnt vmcnt(13)
v_lshlrev_b32 v10, 16, v200
v_and_b32 v11, 0xffff0000, v200
v_lshlrev_b32 v12, 16, v136
v_and_b32 v13, 0xffff0000, v136
v_pk_mul_f32 v[10:11], v[10:11], v[12:13]
v_cvt_pk_bf16_f32 v200, v10, v11
v_lshlrev_b32 v10, 16, v201
v_and_b32 v11, 0xffff0000, v201
v_lshlrev_b32 v12, 16, v137
v_and_b32 v13, 0xffff0000, v137
v_pk_mul_f32 v[10:11], v[10:11], v[12:13]
v_cvt_pk_bf16_f32 v201, v10, v11
v_lshlrev_b32 v10, 16, v202
v_and_b32 v11, 0xffff0000, v202
v_lshlrev_b32 v12, 16, v138
v_and_b32 v13, 0xffff0000, v138
v_pk_mul_f32 v[10:11], v[10:11], v[12:13]
v_cvt_pk_bf16_f32 v202, v10, v11
v_lshlrev_b32 v10, 16, v203
v_and_b32 v11, 0xffff0000, v203
v_lshlrev_b32 v12, 16, v139
v_and_b32 v13, 0xffff0000, v139
v_pk_mul_f32 v[10:11], v[10:11], v[12:13]
v_cvt_pk_bf16_f32 v203, v10, v11
buffer_store_dwordx4 v[200:203], v9, s[12:15], s26 offen offset:640
s_waitcnt vmcnt(13)
v_lshlrev_b32 v10, 16, v204
v_and_b32 v11, 0xffff0000, v204
v_lshlrev_b32 v12, 16, v140
v_and_b32 v13, 0xffff0000, v140
v_pk_mul_f32 v[10:11], v[10:11], v[12:13]
v_cvt_pk_bf16_f32 v204, v10, v11
v_lshlrev_b32 v10, 16, v205
v_and_b32 v11, 0xffff0000, v205
v_lshlrev_b32 v12, 16, v141
v_and_b32 v13, 0xffff0000, v141
v_pk_mul_f32 v[10:11], v[10:11], v[12:13]
v_cvt_pk_bf16_f32 v205, v10, v11
v_lshlrev_b32 v10, 16, v206
v_and_b32 v11, 0xffff0000, v206
v_lshlrev_b32 v12, 16, v142
v_and_b32 v13, 0xffff0000, v142
v_pk_mul_f32 v[10:11], v[10:11], v[12:13]
v_cvt_pk_bf16_f32 v206, v10, v11
v_lshlrev_b32 v10, 16, v207
v_and_b32 v11, 0xffff0000, v207
v_lshlrev_b32 v12, 16, v143
v_and_b32 v13, 0xffff0000, v143
v_pk_mul_f32 v[10:11], v[10:11], v[12:13]
v_cvt_pk_bf16_f32 v207, v10, v11
buffer_store_dwordx4 v[204:207], v9, s[12:15], s26 offen offset:704
s_waitcnt vmcnt(13)
v_lshlrev_b32 v10, 16, v208
v_and_b32 v11, 0xffff0000, v208
v_lshlrev_b32 v12, 16, v144
v_and_b32 v13, 0xffff0000, v144
v_pk_mul_f32 v[10:11], v[10:11], v[12:13]
v_cvt_pk_bf16_f32 v208, v10, v11
v_lshlrev_b32 v10, 16, v209
v_and_b32 v11, 0xffff0000, v209
v_lshlrev_b32 v12, 16, v145
v_and_b32 v13, 0xffff0000, v145
v_pk_mul_f32 v[10:11], v[10:11], v[12:13]
v_cvt_pk_bf16_f32 v209, v10, v11
v_lshlrev_b32 v10, 16, v210
v_and_b32 v11, 0xffff0000, v210
v_lshlrev_b32 v12, 16, v146
v_and_b32 v13, 0xffff0000, v146
v_pk_mul_f32 v[10:11], v[10:11], v[12:13]
v_cvt_pk_bf16_f32 v210, v10, v11
v_lshlrev_b32 v10, 16, v211
v_and_b32 v11, 0xffff0000, v211
v_lshlrev_b32 v12, 16, v147
v_and_b32 v13, 0xffff0000, v147
v_pk_mul_f32 v[10:11], v[10:11], v[12:13]
v_cvt_pk_bf16_f32 v211, v10, v11
buffer_store_dwordx4 v[208:211], v9, s[12:15], s26 offen offset:768
s_waitcnt vmcnt(13)
v_lshlrev_b32 v10, 16, v212
v_and_b32 v11, 0xffff0000, v212
v_lshlrev_b32 v12, 16, v148
v_and_b32 v13, 0xffff0000, v148
v_pk_mul_f32 v[10:11], v[10:11], v[12:13]
v_cvt_pk_bf16_f32 v212, v10, v11
v_lshlrev_b32 v10, 16, v213
v_and_b32 v11, 0xffff0000, v213
v_lshlrev_b32 v12, 16, v149
v_and_b32 v13, 0xffff0000, v149
v_pk_mul_f32 v[10:11], v[10:11], v[12:13]
v_cvt_pk_bf16_f32 v213, v10, v11
v_lshlrev_b32 v10, 16, v214
v_and_b32 v11, 0xffff0000, v214
v_lshlrev_b32 v12, 16, v150
v_and_b32 v13, 0xffff0000, v150
v_pk_mul_f32 v[10:11], v[10:11], v[12:13]
v_cvt_pk_bf16_f32 v214, v10, v11
v_lshlrev_b32 v10, 16, v215
v_and_b32 v11, 0xffff0000, v215
v_lshlrev_b32 v12, 16, v151
v_and_b32 v13, 0xffff0000, v151
v_pk_mul_f32 v[10:11], v[10:11], v[12:13]
v_cvt_pk_bf16_f32 v215, v10, v11
buffer_store_dwordx4 v[212:215], v9, s[12:15], s26 offen offset:832
s_branch M_fin
M_rslow:
Lp_9251:
buffer_load_dword v18, v19, s[4:7], s33 offen offset:0 sc1
s_waitcnt vmcnt(0)
v_cmp_gt_u32 vcc, 1, v18
s_cbranch_vccz Lpd_9252
s_sleep 8
s_sub_u32 s101, s101, 1
s_cbranch_scc0 Lp_9251
s_mov_b32 s101, 0
Lpd_9252:
s_branch M_rjoin
PAD_21:
s_cbranch_execz PAD_25
M_V:
v_mfma_f32_16x16x32_bf16 v[32:35], a[0:3], a[128:131], 0
s_add_u32 m0, s29, 114688
ds_read_b64_tr_b16 a[136:137], v5 offset:0
v_mfma_f32_16x16x32_bf16 v[32:35], a[4:7], a[132:135], v[32:35]
s_mov_b32 s32, 1024
buffer_load_dwordx4 v16, s[12:15], s27 offen offset:0 lds
v_mfma_f32_16x16x32_bf16 v[36:39], a[8:11], a[128:131], 0
s_mov_b32 s33, 31744
ds_read_b64_tr_b16 a[138:139], v5 offset:2048
v_mfma_f32_16x16x32_bf16 v[36:39], a[12:15], a[132:135], v[36:39]
s_mov_b32 s34, 4294935552
v_mfma_f32_16x16x32_bf16 v[40:43], a[16:19], a[128:131], 0
s_mov_b32 s35, 4294935552
ds_read_b64_tr_b16 a[140:141], v5 offset:16384
v_mfma_f32_16x16x32_bf16 v[40:43], a[20:23], a[132:135], v[40:43]
s_mov_b32 s36, 4294935552
buffer_load_dwordx4 v17, s[12:15], s27 offen offset:1024 lds
v_mfma_f32_16x16x32_bf16 v[44:47], a[24:27], a[128:131], 0
s_mov_b32 s30, 8
ds_read_b64_tr_b16 a[142:143], v5 offset:18432
v_mfma_f32_16x16x32_bf16 v[44:47], a[28:31], a[132:135], v[44:47]
s_mov_b32 s82, 3221225472
v_mfma_f32_16x16x32_bf16 v[48:51], a[32:35], a[128:131], 0
s_mul_hi_u32 s38, s2, 613566757
v_mfma_f32_16x16x32_bf16 v[48:51], a[36:39], a[132:135], v[48:51]
s_mul_i32 s39, s38, 7
buffer_load_dwordx4 v18, s[12:15], s27 offen offset:2048 lds
v_mfma_f32_16x16x32_bf16 v[52:55], a[40:43], a[128:131], 0
s_sub_u32 s39, s2, s39
v_mov_b32 v246, 0
v_mov_b32 v229, 0
v_mfma_f32_16x16x32_bf16 v[52:55], a[44:47], a[132:135], v[52:55]
v_mov_b32 v231, 0
v_mfma_f32_16x16x32_bf16 v[56:59], a[48:51], a[128:131], 0
s_mov_b32 s60, s90
v_mfma_f32_16x16x32_bf16 v[56:59], a[52:55], a[132:135], v[56:59]
s_mov_b32 s61, s91
buffer_load_dwordx4 v19, s[12:15], s27 offen offset:3072 lds
v_mfma_f32_16x16x32_bf16 v[60:63], a[56:59], a[128:131], 0
s_add_u32 s27, s27, 524288
v_mfma_f32_16x16x32_bf16 v[60:63], a[60:63], a[132:135], v[60:63]
s_waitcnt lgkmcnt(0)
s_mov_b32 s62, 256
v_mfma_f32_16x16x32_bf16 v[64:67], a[0:3], a[136:139], 0
s_add_u32 m0, s28, 0
ds_read_b64_tr_b16 a[128:129], v6 offset:0
v_mfma_f32_16x16x32_bf16 v[64:67], a[4:7], a[140:143], v[64:67]
s_mov_b32 s63, 0x20000
buffer_load_dwordx4 v12, s[8:11], s24 offen offset:0 lds
v_mfma_f32_16x16x32_bf16 v[68:71], a[8:11], a[136:139], 0
s_mul_hi_u32 s55, s2, 1431655766
ds_read_b64_tr_b16 a[130:131], v6 offset:2048
v_mfma_f32_16x16x32_bf16 v[68:71], a[12:15], a[140:143], v[68:71]
s_mul_i32 s55, s55, 3
v_mfma_f32_16x16x32_bf16 v[72:75], a[16:19], a[136:139], 0
s_sub_u32 s55, s2, s55
ds_read_b64_tr_b16 a[132:133], v6 offset:16384
v_mfma_f32_16x16x32_bf16 v[72:75], a[20:23], a[140:143], v[72:75]
s_add_u32 s55, s55, 5
buffer_load_dwordx4 v13, s[8:11], s24 offen offset:1024 lds
v_mfma_f32_16x16x32_bf16 v[76:79], a[24:27], a[136:139], 0
s_lshr_b32 s22, s2, 4
ds_read_b64_tr_b16 a[134:135], v6 offset:18432
v_mfma_f32_16x16x32_bf16 v[76:79], a[28:31], a[140:143], v[76:79]
s_lshl_b32 s23, s20, 5
v_mfma_f32_16x16x32_bf16 v[80:83], a[32:35], a[136:139], 0
s_add_u32 s23, s23, s22
v_mfma_f32_16x16x32_bf16 v[80:83], a[36:39], a[140:143], v[80:83]
s_lshl_b32 s23, s23, 2
buffer_load_dwordx4 v14, s[8:11], s24 offen offset:2048 lds
v_mfma_f32_16x16x32_bf16 v[84:87], a[40:43], a[136:139], 0
s_and_b32 s22, s2, 16
v_mfma_f32_16x16x32_bf16 v[84:87], a[44:47], a[140:143], v[84:87]
s_lshl_b32 s22, s22, 7
v_mfma_f32_16x16x32_bf16 v[88:91], a[48:51], a[136:139], 0
s_add_u32 s23, s23, s22
v_mov_b32 v28, 3221225472
v_writelane_b32 v28, s23, 0
v_mfma_f32_16x16x32_bf16 v[88:91], a[52:55], a[140:143], v[88:91]
s_add_u32 s56, s23, 16384
buffer_load_dwordx4 v15, s[8:11], s24 offen offset:3072 lds
v_mfma_f32_16x16x32_bf16 v[92:95], a[56:59], a[136:139], 0
s_add_u32 s24, s24, 128
v_writelane_b32 v28, s56, 1
v_mfma_f32_16x16x32_bf16 v[92:95], a[60:63], a[140:143], v[92:95]
s_waitcnt lgkmcnt(0)
s_add_u32 s56, s23, 4096
v_writelane_b32 v28, s56, 2
v_mfma_f32_16x16x32_bf16 v[96:99], a[0:3], a[128:131], 0
s_add_u32 m0, s28, 4096
ds_read_b64_tr_b16 a[136:137], v7 offset:0
v_mfma_f32_16x16x32_bf16 v[96:99], a[4:7], a[132:135], v[96:99]
s_sub_u32 s37, 15, s21
buffer_load_dwordx4 v12, s[8:11], s25 offen offset:0 lds
v_mfma_f32_16x16x32_bf16 v[100:103], a[8:11], a[128:131], 0
ds_read_b64_tr_b16 a[138:139], v7 offset:2048
v_mfma_f32_16x16x32_bf16 v[100:103], a[12:15], a[132:135], v[100:103]
v_mfma_f32_16x16x32_bf16 v[104:107], a[16:19], a[128:131], 0
ds_read_b64_tr_b16 a[140:141], v7 offset:16384
v_mfma_f32_16x16x32_bf16 v[104:107], a[20:23], a[132:135], v[104:107]
buffer_load_dwordx4 v13, s[8:11], s25 offen offset:1024 lds
v_mfma_f32_16x16x32_bf16 v[108:111], a[24:27], a[128:131], 0
ds_read_b64_tr_b16 a[142:143], v7 offset:18432
v_mfma_f32_16x16x32_bf16 v[108:111], a[28:31], a[132:135], v[108:111]
v_mfma_f32_16x16x32_bf16 v[112:115], a[32:35], a[128:131], 0
v_mfma_f32_16x16x32_bf16 v[112:115], a[36:39], a[132:135], v[112:115]
buffer_load_dwordx4 v14, s[8:11], s25 offen offset:2048 lds
v_mfma_f32_16x16x32_bf16 v[116:119], a[40:43], a[128:131], 0
v_mfma_f32_16x16x32_bf16 v[116:119], a[44:47], a[132:135], v[116:119]
v_mfma_f32_16x16x32_bf16 v[120:123], a[48:51], a[128:131], 0
v_mfma_f32_16x16x32_bf16 v[120:123], a[52:55], a[132:135], v[120:123]
buffer_load_dwordx4 v15, s[8:11], s25 offen offset:3072 lds
v_mfma_f32_16x16x32_bf16 v[124:127], a[56:59], a[128:131], 0
s_add_u32 s25, s25, 128
v_mfma_f32_16x16x32_bf16 v[124:127], a[60:63], a[132:135], v[124:127]
s_waitcnt vmcnt(17) lgkmcnt(0)
s_barrier
v_mfma_f32_16x16x32_bf16 v[128:131], a[0:3], a[136:139], 0
ds_read_b64_tr_b16 a[128:129], v8 offset:0
v_mfma_f32_16x16x32_bf16 v[128:131], a[4:7], a[140:143], v[128:131]
buffer_load_dword v21, v20, s[16:19], s43 offen
v_mfma_f32_16x16x32_bf16 v[132:135], a[8:11], a[136:139], 0
s_add_u32 s43, s43, s47
ds_read_b64_tr_b16 a[130:131], v8 offset:2048
v_mfma_f32_16x16x32_bf16 v[132:135], a[12:15], a[140:143], v[132:135]
s_cmp_ge_u32 s43, s51
v_mfma_f32_16x16x32_bf16 v[136:139], a[16:19], a[136:139], 0
s_cselect_b32 s43, 0, s43
ds_read_b64_tr_b16 a[132:133], v8 offset:16384
v_mfma_f32_16x16x32_bf16 v[136:139], a[20:23], a[140:143], v[136:139]
s_cselect_b32 s51, s42, s51
v_mfma_f32_16x16x32_bf16 v[140:143], a[24:27], a[136:139], 0
s_cselect_b64 s[16:17], s[40:41], s[16:17]
ds_read_b64_tr_b16 a[134:135], v8 offset:18432
v_mfma_f32_16x16x32_bf16 v[140:143], a[28:31], a[140:143], v[140:143]
s_cselect_b32 s18, s42, s18
v_mfma_f32_16x16x32_bf16 v[144:147], a[32:35], a[136:139], 0
s_cselect_b64 s[40:41], s[44:45], s[40:41]
ds_read_b128 a[64:67], v2 offset:32768
v_mfma_f32_16x16x32_bf16 v[144:147], a[36:39], a[140:143], v[144:147]
s_cselect_b32 s42, s46, s42
v_mfma_f32_16x16x32_bf16 v[148:151], a[40:43], a[136:139], 0
s_cselect_b32 s46, 0, s46
ds_read_b128 a[68:71], v3 offset:32768
v_mfma_f32_16x16x32_bf16 v[148:151], a[44:47], a[140:143], v[148:151]
ds_read_b128 a[72:75], v2 offset:34816
v_mfma_f32_16x16x32_bf16 v[152:155], a[48:51], a[136:139], 0
ds_read_b128 a[76:79], v3 offset:34816
v_mfma_f32_16x16x32_bf16 v[152:155], a[52:55], a[140:143], v[152:155]
buffer_load_dword v21, v20, s[16:19], s43 offen
v_mfma_f32_16x16x32_bf16 v[156:159], a[56:59], a[136:139], 0
s_add_u32 s43, s43, s47
ds_read_b128 a[80:83], v2 offset:36864
v_mfma_f32_16x16x32_bf16 v[156:159], a[60:63], a[140:143], v[156:159]
s_waitcnt lgkmcnt(5)
s_cmp_ge_u32 s43, s51
ds_read_b128 a[84:87], v3 offset:36864
v_mfma_f32_16x16x32_bf16 v[160:163], a[0:3], a[128:131], 0
s_cselect_b32 s43, 0, s43
ds_read_b64_tr_b16 a[136:137], v9 offset:0
v_mfma_f32_16x16x32_bf16 v[160:163], a[4:7], a[132:135], v[160:163]
s_cselect_b32 s51, s42, s51
v_mfma_f32_16x16x32_bf16 v[164:167], a[8:11], a[128:131], 0
s_cselect_b64 s[16:17], s[40:41], s[16:17]
ds_read_b64_tr_b16 a[138:139], v9 offset:2048
v_mfma_f32_16x16x32_bf16 v[164:167], a[12:15], a[132:135], v[164:167]
s_cselect_b32 s18, s42, s18
v_mfma_f32_16x16x32_bf16 v[168:171], a[16:19], a[128:131], 0
s_cselect_b64 s[40:41], s[44:45], s[40:41]
ds_read_b64_tr_b16 a[140:141], v9 offset:16384
v_mfma_f32_16x16x32_bf16 v[168:171], a[20:23], a[132:135], v[168:171]
s_cselect_b32 s42, s46, s42
v_mfma_f32_16x16x32_bf16 v[172:175], a[24:27], a[128:131], 0
s_cselect_b32 s46, 0, s46
ds_read_b64_tr_b16 a[142:143], v9 offset:18432
v_mfma_f32_16x16x32_bf16 v[172:175], a[28:31], a[132:135], v[172:175]
s_bitcmp1_b32 s2, 4
s_cselect_b32 s37, s21, s37
s_lshl_b32 s56, s37, 5
v_mfma_f32_16x16x32_bf16 v[176:179], a[32:35], a[128:131], 0
s_add_u32 s56, s56, s20
s_lshl_b32 s56, s56, 2
s_add_u32 s56, s56, 8192
v_mfma_f32_16x16x32_bf16 v[176:179], a[36:39], a[132:135], v[176:179]
v_writelane_b32 v28, s56, 3
v_mfma_f32_16x16x32_bf16 v[180:183], a[40:43], a[128:131], 0
s_add_u32 s56, s56, 2048
ds_read_b128 a[88:91], v2 offset:38912
v_writelane_b32 v28, s56, 6
v_mfma_f32_16x16x32_bf16 v[180:183], a[44:47], a[132:135], v[180:183]
s_lshl_b32 s56, s2, 2
s_add_u32 s56, s56, 12288
ds_read_b128 a[92:95], v3 offset:38912
v_mfma_f32_16x16x32_bf16 v[184:187], a[48:51], a[128:131], 0
s_waitcnt lgkmcnt(2)
ds_read_b128 a[96:99], v2 offset:40960
v_writelane_b32 v28, s56, 4
v_mfma_f32_16x16x32_bf16 v[184:187], a[52:55], a[132:135], v[184:187]
s_lshl_b32 s56, s39, 5
s_add_u32 s56, s56, s38
s_lshl_b32 s56, s56, 2
v_mfma_f32_16x16x32_bf16 v[188:191], a[56:59], a[128:131], 0
s_add_u32 s56, s56, 20480
s_cmp_lt_u32 s2, 224
ds_read_b128 a[100:103], v3 offset:40960
v_mfma_f32_16x16x32_bf16 v[188:191], a[60:63], a[132:135], v[188:191]
s_cselect_b32 s56, s56, 3221225472
ds_read_b128 a[104:107], v2 offset:43008
v_writelane_b32 v28, s56, 7
v_mfma_f32_16x16x32_bf16 v[192:195], a[0:3], a[136:139], 0
s_cmp_eq_u32 s3, 0
s_cselect_b32 s56, 94371840, 3221225472
ds_read_b64_tr_b16 a[128:129], v10 offset:0
v_mfma_f32_16x16x32_bf16 v[192:195], a[4:7], a[140:143], v[192:195]
buffer_store_dword v246, v28, s[4:7], s56 offen sc1
v_mfma_f32_16x16x32_bf16 v[196:199], a[8:11], a[136:139], 0
ds_read_b64_tr_b16 a[130:131], v10 offset:2048
v_mov_b32 v27, 1
v_mfma_f32_16x16x32_bf16 v[196:199], a[12:15], a[140:143], v[196:199]
v_cmp_eq_u32 vcc, 0, v0
v_mov_b32 v26, 3221225472
v_mfma_f32_16x16x32_bf16 v[200:203], a[16:19], a[136:139], 0
s_lshl_b32 s31, s20, 20
s_lshl_b32 s22, s21, 17
ds_read_b64_tr_b16 a[132:133], v10 offset:16384
v_mfma_f32_16x16x32_bf16 v[200:203], a[20:23], a[140:143], v[200:203]
v_cndmask_b32 v26, v26, v246, vcc
v_mfma_f32_16x16x32_bf16 v[204:207], a[24:27], a[136:139], 0
s_add_u32 s31, s31, s22
s_lshr_b32 s22, s3, 1
ds_read_b64_tr_b16 a[134:135], v10 offset:18432
v_mfma_f32_16x16x32_bf16 v[204:207], a[28:31], a[140:143], v[204:207]
s_lshl_b32 s22, s22, 16
s_add_u32 s31, s31, s22
s_and_b32 s22, s3, 1
v_mfma_f32_16x16x32_bf16 v[208:211], a[32:35], a[136:139], 0
s_lshl_b32 s22, s22, 14
s_add_u32 s31, s31, s22
s_add_u32 s31, s31, 16777216
v_mfma_f32_16x16x32_bf16 v[208:211], a[36:39], a[140:143], v[208:211]
v_mfma_f32_16x16x32_bf16 v[212:215], a[40:43], a[136:139], 0
ds_read_b128 a[108:111], v3 offset:43008
v_mfma_f32_16x16x32_bf16 v[212:215], a[44:47], a[140:143], v[212:215]
ds_read_b128 a[112:115], v2 offset:45056
v_mfma_f32_16x16x32_bf16 v[216:219], a[48:51], a[136:139], 0
ds_read_b128 a[116:119], v3 offset:45056
v_mfma_f32_16x16x32_bf16 v[216:219], a[52:55], a[140:143], v[216:219]
v_mfma_f32_16x16x32_bf16 v[220:223], a[56:59], a[136:139], 0
ds_read_b128 a[120:123], v2 offset:47104
v_mfma_f32_16x16x32_bf16 v[220:223], a[60:63], a[140:143], v[220:223]
s_waitcnt lgkmcnt(4)
ds_read_b128 a[124:127], v3 offset:47104
v_mfma_f32_16x16x32_bf16 a[192:195], a[0:3], a[128:131], 0
ds_read_b64_tr_b16 a[136:137], v11 offset:0
v_mfma_f32_16x16x32_bf16 a[192:195], a[4:7], a[132:135], a[192:195]
v_mfma_f32_16x16x32_bf16 a[196:199], a[8:11], a[128:131], 0
ds_read_b64_tr_b16 a[138:139], v11 offset:2048
v_mfma_f32_16x16x32_bf16 a[196:199], a[12:15], a[132:135], a[196:199]
PAD_22:
s_cbranch_execz PAD_26
v_mfma_f32_16x16x32_bf16 a[200:203], a[16:19], a[128:131], 0
ds_read_b64_tr_b16 a[140:141], v11 offset:16384
v_mfma_f32_16x16x32_bf16 a[200:203], a[20:23], a[132:135], a[200:203]
v_mfma_f32_16x16x32_bf16 a[204:207], a[24:27], a[128:131], 0
ds_read_b64_tr_b16 a[142:143], v11 offset:18432
v_mfma_f32_16x16x32_bf16 a[204:207], a[28:31], a[132:135], a[204:207]
v_mfma_f32_16x16x32_bf16 a[208:211], a[32:35], a[128:131], 0
v_mfma_f32_16x16x32_bf16 a[208:211], a[36:39], a[132:135], a[208:211]
v_mfma_f32_16x16x32_bf16 a[212:215], a[40:43], a[128:131], 0
v_mfma_f32_16x16x32_bf16 a[212:215], a[44:47], a[132:135], a[212:215]
v_mfma_f32_16x16x32_bf16 a[216:219], a[48:51], a[128:131], 0
v_mfma_f32_16x16x32_bf16 a[216:219], a[52:55], a[132:135], a[216:219]
v_mfma_f32_16x16x32_bf16 a[220:223], a[56:59], a[128:131], 0
s_waitcnt vmcnt(3) lgkmcnt(0)
v_mfma_f32_16x16x32_bf16 a[220:223], a[60:63], a[132:135], a[220:223]
s_barrier
v_mfma_f32_16x16x32_bf16 a[224:227], a[0:3], a[136:139], 0
s_add_u32 m0, s29, 65536
ds_read_b64_tr_b16 a[128:129], v4 offset:32768
v_mfma_f32_16x16x32_bf16 a[224:227], a[4:7], a[140:143], a[224:227]
buffer_load_dwordx4 v16, s[12:15], s26 offen offset:0 lds
v_mfma_f32_16x16x32_bf16 a[228:231], a[8:11], a[136:139], 0
ds_read_b64_tr_b16 a[130:131], v4 offset:34816
v_mfma_f32_16x16x32_bf16 a[228:231], a[12:15], a[140:143], a[228:231]
v_mfma_f32_16x16x32_bf16 a[232:235], a[16:19], a[136:139], 0
ds_read_b64_tr_b16 a[132:133], v4 offset:49152
v_mfma_f32_16x16x32_bf16 a[232:235], a[20:23], a[140:143], a[232:235]
buffer_load_dwordx4 v17, s[12:15], s26 offen offset:1024 lds
v_mfma_f32_16x16x32_bf16 a[236:239], a[24:27], a[136:139], 0
ds_read_b64_tr_b16 a[134:135], v4 offset:51200
v_mfma_f32_16x16x32_bf16 a[236:239], a[28:31], a[140:143], a[236:239]
v_mfma_f32_16x16x32_bf16 a[240:243], a[32:35], a[136:139], 0
v_mfma_f32_16x16x32_bf16 a[240:243], a[36:39], a[140:143], a[240:243]
buffer_load_dwordx4 v18, s[12:15], s26 offen offset:2048 lds
v_mfma_f32_16x16x32_bf16 a[244:247], a[40:43], a[136:139], 0
v_mfma_f32_16x16x32_bf16 a[244:247], a[44:47], a[140:143], a[244:247]
v_mfma_f32_16x16x32_bf16 a[248:251], a[48:51], a[136:139], 0
v_mfma_f32_16x16x32_bf16 a[248:251], a[52:55], a[140:143], a[248:251]
buffer_load_dwordx4 v19, s[12:15], s26 offen offset:3072 lds
v_mfma_f32_16x16x32_bf16 a[252:255], a[56:59], a[136:139], 0
s_add_u32 s26, s26, 524288
v_mfma_f32_16x16x32_bf16 a[252:255], a[60:63], a[140:143], a[252:255]
s_waitcnt lgkmcnt(0)
Lg_501:
v_mfma_f32_16x16x32_bf16 v[32:35], a[64:67], a[128:131], v[32:35]
s_add_u32 m0, s29, 81920
ds_read_b64_tr_b16 a[136:137], v5 offset:32768
v_mfma_f32_16x16x32_bf16 v[32:35], a[68:71], a[132:135], v[32:35]
buffer_load_dwordx4 v16, s[12:15], s27 offen offset:0 lds
v_mfma_f32_16x16x32_bf16 v[36:39], a[72:75], a[128:131], v[36:39]
ds_read_b64_tr_b16 a[138:139], v5 offset:34816
v_mfma_f32_16x16x32_bf16 v[36:39], a[76:79], a[132:135], v[36:39]
v_mfma_f32_16x16x32_bf16 v[40:43], a[80:83], a[128:131], v[40:43]
ds_read_b64_tr_b16 a[140:141], v5 offset:49152
v_mfma_f32_16x16x32_bf16 v[40:43], a[84:87], a[132:135], v[40:43]
buffer_load_dwordx4 v17, s[12:15], s27 offen offset:1024 lds
v_mfma_f32_16x16x32_bf16 v[44:47], a[88:91], a[128:131], v[44:47]
ds_read_b64_tr_b16 a[142:143], v5 offset:51200
v_mfma_f32_16x16x32_bf16 v[44:47], a[92:95], a[132:135], v[44:47]
v_mfma_f32_16x16x32_bf16 v[48:51], a[96:99], a[128:131], v[48:51]
ds_read_b128 a[0:3], v2 offset:0
v_mfma_f32_16x16x32_bf16 v[48:51], a[100:103], a[132:135], v[48:51]
buffer_load_dwordx4 v18, s[12:15], s27 offen offset:2048 lds
v_mfma_f32_16x16x32_bf16 v[52:55], a[104:107], a[128:131], v[52:55]
ds_read_b128 a[4:7], v3 offset:0
v_mfma_f32_16x16x32_bf16 v[52:55], a[108:111], a[132:135], v[52:55]
v_mfma_f32_16x16x32_bf16 v[56:59], a[112:115], a[128:131], v[56:59]
v_mfma_f32_16x16x32_bf16 v[56:59], a[116:119], a[132:135], v[56:59]
buffer_load_dwordx4 v19, s[12:15], s27 offen offset:3072 lds
v_mfma_f32_16x16x32_bf16 v[60:63], a[120:123], a[128:131], v[60:63]
s_add_u32 s27, s27, 524288
ds_read_b128 a[8:11], v2 offset:2048
v_mfma_f32_16x16x32_bf16 v[60:63], a[124:127], a[132:135], v[60:63]
s_waitcnt lgkmcnt(3)
v_mfma_f32_16x16x32_bf16 v[64:67], a[64:67], a[136:139], v[64:67]
s_add_u32 m0, s28, 32768
ds_read_b64_tr_b16 a[128:129], v6 offset:32768
v_mfma_f32_16x16x32_bf16 v[64:67], a[68:71], a[140:143], v[64:67]
buffer_load_dwordx4 v12, s[8:11], s24 offen offset:0 lds
v_mfma_f32_16x16x32_bf16 v[68:71], a[72:75], a[136:139], v[68:71]
ds_read_b64_tr_b16 a[130:131], v6 offset:34816
v_mfma_f32_16x16x32_bf16 v[68:71], a[76:79], a[140:143], v[68:71]
v_mfma_f32_16x16x32_bf16 v[72:75], a[80:83], a[136:139], v[72:75]
ds_read_b64_tr_b16 a[132:133], v6 offset:49152
v_mfma_f32_16x16x32_bf16 v[72:75], a[84:87], a[140:143], v[72:75]
buffer_load_dwordx4 v13, s[8:11], s24 offen offset:1024 lds
v_mfma_f32_16x16x32_bf16 v[76:79], a[88:91], a[136:139], v[76:79]
ds_read_b64_tr_b16 a[134:135], v6 offset:51200
v_mfma_f32_16x16x32_bf16 v[76:79], a[92:95], a[140:143], v[76:79]
v_mfma_f32_16x16x32_bf16 v[80:83], a[96:99], a[136:139], v[80:83]
ds_read_b128 a[12:15], v3 offset:2048
v_mfma_f32_16x16x32_bf16 v[80:83], a[100:103], a[140:143], v[80:83]
buffer_load_dwordx4 v14, s[8:11], s24 offen offset:2048 lds
v_mfma_f32_16x16x32_bf16 v[84:87], a[104:107], a[136:139], v[84:87]
v_mfma_f32_16x16x32_bf16 v[84:87], a[108:111], a[140:143], v[84:87]
v_mfma_f32_16x16x32_bf16 v[88:91], a[112:115], a[136:139], v[88:91]
ds_read_b128 a[16:19], v2 offset:4096
v_mfma_f32_16x16x32_bf16 v[88:91], a[116:119], a[140:143], v[88:91]
buffer_load_dwordx4 v15, s[8:11], s24 offen offset:3072 lds
v_mfma_f32_16x16x32_bf16 v[92:95], a[120:123], a[136:139], v[92:95]
s_add_u32 s24, s24, 128
ds_read_b128 a[20:23], v3 offset:4096
v_mfma_f32_16x16x32_bf16 v[92:95], a[124:127], a[140:143], v[92:95]
s_waitcnt lgkmcnt(3)
v_mfma_f32_16x16x32_bf16 v[96:99], a[64:67], a[128:131], v[96:99]
s_add_u32 m0, s28, 36864
ds_read_b64_tr_b16 a[136:137], v7 offset:32768
v_mfma_f32_16x16x32_bf16 v[96:99], a[68:71], a[132:135], v[96:99]
buffer_load_dwordx4 v12, s[8:11], s25 offen offset:0 lds
v_mfma_f32_16x16x32_bf16 v[100:103], a[72:75], a[128:131], v[100:103]
ds_read_b64_tr_b16 a[138:139], v7 offset:34816
v_mfma_f32_16x16x32_bf16 v[100:103], a[76:79], a[132:135], v[100:103]
v_mfma_f32_16x16x32_bf16 v[104:107], a[80:83], a[128:131], v[104:107]
ds_read_b64_tr_b16 a[140:141], v7 offset:49152
v_mfma_f32_16x16x32_bf16 v[104:107], a[84:87], a[132:135], v[104:107]
buffer_load_dwordx4 v13, s[8:11], s25 offen offset:1024 lds
v_mfma_f32_16x16x32_bf16 v[108:111], a[88:91], a[128:131], v[108:111]
ds_read_b64_tr_b16 a[142:143], v7 offset:51200
v_mfma_f32_16x16x32_bf16 v[108:111], a[92:95], a[132:135], v[108:111]
v_mfma_f32_16x16x32_bf16 v[112:115], a[96:99], a[128:131], v[112:115]
v_mfma_f32_16x16x32_bf16 v[112:115], a[100:103], a[132:135], v[112:115]
buffer_load_dwordx4 v14, s[8:11], s25 offen offset:2048 lds
v_mfma_f32_16x16x32_bf16 v[116:119], a[104:107], a[128:131], v[116:119]
ds_read_b128 a[24:27], v2 offset:6144
v_mfma_f32_16x16x32_bf16 v[116:119], a[108:111], a[132:135], v[116:119]
v_mfma_f32_16x16x32_bf16 v[120:123], a[112:115], a[128:131], v[120:123]
ds_read_b128 a[28:31], v3 offset:6144
v_mfma_f32_16x16x32_bf16 v[120:123], a[116:119], a[132:135], v[120:123]
buffer_load_dwordx4 v15, s[8:11], s25 offen offset:3072 lds
v_mfma_f32_16x16x32_bf16 v[124:127], a[120:123], a[128:131], v[124:127]
s_add_u32 s25, s25, 128
v_mfma_f32_16x16x32_bf16 v[124:127], a[124:127], a[132:135], v[124:127]
s_waitcnt lgkmcnt(2)
v_mfma_f32_16x16x32_bf16 v[128:131], a[64:67], a[136:139], v[128:131]
ds_read_b64_tr_b16 a[128:129], v8 offset:32768
v_mfma_f32_16x16x32_bf16 v[128:131], a[68:71], a[140:143], v[128:131]
buffer_load_dword v21, v20, s[16:19], s43 offen
v_mfma_f32_16x16x32_bf16 v[132:135], a[72:75], a[136:139], v[132:135]
s_add_u32 s43, s43, s47
ds_read_b64_tr_b16 a[130:131], v8 offset:34816
v_mfma_f32_16x16x32_bf16 v[132:135], a[76:79], a[140:143], v[132:135]
s_cmp_ge_u32 s43, s51
v_mfma_f32_16x16x32_bf16 v[136:139], a[80:83], a[136:139], v[136:139]
s_cselect_b32 s43, 0, s43
ds_read_b64_tr_b16 a[132:133], v8 offset:49152
v_mfma_f32_16x16x32_bf16 v[136:139], a[84:87], a[140:143], v[136:139]
s_cselect_b32 s51, s42, s51
v_mfma_f32_16x16x32_bf16 v[140:143], a[88:91], a[136:139], v[140:143]
s_cselect_b64 s[16:17], s[40:41], s[16:17]
ds_read_b64_tr_b16 a[134:135], v8 offset:51200
v_mfma_f32_16x16x32_bf16 v[140:143], a[92:95], a[140:143], v[140:143]
s_cselect_b32 s18, s42, s18
v_mfma_f32_16x16x32_bf16 v[144:147], a[96:99], a[136:139], v[144:147]
s_cselect_b64 s[40:41], s[44:45], s[40:41]
ds_read_b128 a[32:35], v2 offset:8192
v_mfma_f32_16x16x32_bf16 v[144:147], a[100:103], a[140:143], v[144:147]
s_cselect_b32 s42, s46, s42
v_mfma_f32_16x16x32_bf16 v[148:151], a[104:107], a[136:139], v[148:151]
s_cselect_b32 s46, 0, s46
v_mfma_f32_16x16x32_bf16 v[148:151], a[108:111], a[140:143], v[148:151]
s_cmp_eq_u32 s30, s55
v_mfma_f32_16x16x32_bf16 v[152:155], a[112:115], a[136:139], v[152:155]
s_cselect_b32 s22, 0, 3221225472
ds_read_b128 a[36:39], v3 offset:8192
v_mfma_f32_16x16x32_bf16 v[152:155], a[116:119], a[140:143], v[152:155]
s_sub_u32 s30, s30, 1
buffer_atomic_add v27, v26, s[60:63], s22 offen sc1
v_mfma_f32_16x16x32_bf16 v[156:159], a[120:123], a[136:139], v[156:159]
ds_read_b128 a[40:43], v2 offset:10240
v_mfma_f32_16x16x32_bf16 v[156:159], a[124:127], a[140:143], v[156:159]
s_waitcnt lgkmcnt(3)
v_mfma_f32_16x16x32_bf16 v[160:163], a[64:67], a[128:131], v[160:163]
ds_read_b64_tr_b16 a[136:137], v9 offset:32768
v_mfma_f32_16x16x32_bf16 v[160:163], a[68:71], a[132:135], v[160:163]
v_mfma_f32_16x16x32_bf16 v[164:167], a[72:75], a[128:131], v[164:167]
ds_read_b64_tr_b16 a[138:139], v9 offset:34816
v_mfma_f32_16x16x32_bf16 v[164:167], a[76:79], a[132:135], v[164:167]
v_mfma_f32_16x16x32_bf16 v[168:171], a[80:83], a[128:131], v[168:171]
ds_read_b64_tr_b16 a[140:141], v9 offset:49152
v_mfma_f32_16x16x32_bf16 v[168:171], a[84:87], a[132:135], v[168:171]
v_mfma_f32_16x16x32_bf16 v[172:175], a[88:91], a[128:131], v[172:175]
ds_read_b64_tr_b16 a[142:143], v9 offset:51200
v_mfma_f32_16x16x32_bf16 v[172:175], a[92:95], a[132:135], v[172:175]
v_mfma_f32_16x16x32_bf16 v[176:179], a[96:99], a[128:131], v[176:179]
v_mfma_f32_16x16x32_bf16 v[176:179], a[100:103], a[132:135], v[176:179]
v_mfma_f32_16x16x32_bf16 v[180:183], a[104:107], a[128:131], v[180:183]
ds_read_b128 a[44:47], v3 offset:10240
v_mfma_f32_16x16x32_bf16 v[180:183], a[108:111], a[132:135], v[180:183]
v_mfma_f32_16x16x32_bf16 v[184:187], a[112:115], a[128:131], v[184:187]
ds_read_b128 a[48:51], v2 offset:12288
v_mfma_f32_16x16x32_bf16 v[184:187], a[116:119], a[132:135], v[184:187]
v_mfma_f32_16x16x32_bf16 v[188:191], a[120:123], a[128:131], v[188:191]
v_mfma_f32_16x16x32_bf16 v[188:191], a[124:127], a[132:135], v[188:191]
s_waitcnt lgkmcnt(2)
v_mfma_f32_16x16x32_bf16 v[192:195], a[64:67], a[136:139], v[192:195]
ds_read_b64_tr_b16 a[128:129], v10 offset:32768
v_mfma_f32_16x16x32_bf16 v[192:195], a[68:71], a[140:143], v[192:195]
v_mfma_f32_16x16x32_bf16 v[196:199], a[72:75], a[136:139], v[196:199]
ds_read_b64_tr_b16 a[130:131], v10 offset:34816
v_mfma_f32_16x16x32_bf16 v[196:199], a[76:79], a[140:143], v[196:199]
v_mfma_f32_16x16x32_bf16 v[200:203], a[80:83], a[136:139], v[200:203]
ds_read_b64_tr_b16 a[132:133], v10 offset:49152
v_mfma_f32_16x16x32_bf16 v[200:203], a[84:87], a[140:143], v[200:203]
v_mfma_f32_16x16x32_bf16 v[204:207], a[88:91], a[136:139], v[204:207]
ds_read_b64_tr_b16 a[134:135], v10 offset:51200
v_mfma_f32_16x16x32_bf16 v[204:207], a[92:95], a[140:143], v[204:207]
v_mfma_f32_16x16x32_bf16 v[208:211], a[96:99], a[136:139], v[208:211]
ds_read_b128 a[52:55], v3 offset:12288
v_mfma_f32_16x16x32_bf16 v[208:211], a[100:103], a[140:143], v[208:211]
v_mfma_f32_16x16x32_bf16 v[212:215], a[104:107], a[136:139], v[212:215]
ds_read_b128 a[56:59], v2 offset:14336
v_mfma_f32_16x16x32_bf16 v[212:215], a[108:111], a[140:143], v[212:215]
v_mfma_f32_16x16x32_bf16 v[216:219], a[112:115], a[136:139], v[216:219]
v_mfma_f32_16x16x32_bf16 v[216:219], a[116:119], a[140:143], v[216:219]
v_mfma_f32_16x16x32_bf16 v[220:223], a[120:123], a[136:139], v[220:223]
ds_read_b128 a[60:63], v3 offset:14336
v_mfma_f32_16x16x32_bf16 v[220:223], a[124:127], a[140:143], v[220:223]
s_waitcnt lgkmcnt(3)
v_mfma_f32_16x16x32_bf16 a[192:195], a[64:67], a[128:131], a[192:195]
ds_read_b64_tr_b16 a[136:137], v11 offset:32768
v_mfma_f32_16x16x32_bf16 a[192:195], a[68:71], a[132:135], a[192:195]
v_mfma_f32_16x16x32_bf16 a[196:199], a[72:75], a[128:131], a[196:199]
ds_read_b64_tr_b16 a[138:139], v11 offset:34816
v_mfma_f32_16x16x32_bf16 a[196:199], a[76:79], a[132:135], a[196:199]
v_mfma_f32_16x16x32_bf16 a[200:203], a[80:83], a[128:131], a[200:203]
ds_read_b64_tr_b16 a[140:141], v11 offset:49152
v_mfma_f32_16x16x32_bf16 a[200:203], a[84:87], a[132:135], a[200:203]
v_mfma_f32_16x16x32_bf16 a[204:207], a[88:91], a[128:131], a[204:207]
ds_read_b64_tr_b16 a[142:143], v11 offset:51200
v_mfma_f32_16x16x32_bf16 a[204:207], a[92:95], a[132:135], a[204:207]
v_mfma_f32_16x16x32_bf16 a[208:211], a[96:99], a[128:131], a[208:211]
v_mfma_f32_16x16x32_bf16 a[208:211], a[100:103], a[132:135], a[208:211]
v_mfma_f32_16x16x32_bf16 a[212:215], a[104:107], a[128:131], a[212:215]
v_mfma_f32_16x16x32_bf16 a[212:215], a[108:111], a[132:135], a[212:215]
v_mfma_f32_16x16x32_bf16 a[216:219], a[112:115], a[128:131], a[216:219]
v_mfma_f32_16x16x32_bf16 a[216:219], a[116:119], a[132:135], a[216:219]
v_mfma_f32_16x16x32_bf16 a[220:223], a[120:123], a[128:131], a[220:223]
s_waitcnt vmcnt(2) lgkmcnt(0)
v_mfma_f32_16x16x32_bf16 a[220:223], a[124:127], a[132:135], a[220:223]
s_barrier
v_mfma_f32_16x16x32_bf16 a[224:227], a[64:67], a[136:139], a[224:227]
s_add_u32 m0, s29, 98304
ds_read_b64_tr_b16 a[128:129], v4 offset:0
v_mfma_f32_16x16x32_bf16 a[224:227], a[68:71], a[140:143], a[224:227]
buffer_load_dwordx4 v16, s[12:15], s26 offen offset:0 lds
v_mfma_f32_16x16x32_bf16 a[228:231], a[72:75], a[136:139], a[228:231]
ds_read_b64_tr_b16 a[130:131], v4 offset:2048
v_mfma_f32_16x16x32_bf16 a[228:231], a[76:79], a[140:143], a[228:231]
v_mfma_f32_16x16x32_bf16 a[232:235], a[80:83], a[136:139], a[232:235]
ds_read_b64_tr_b16 a[132:133], v4 offset:16384
v_mfma_f32_16x16x32_bf16 a[232:235], a[84:87], a[140:143], a[232:235]
buffer_load_dwordx4 v17, s[12:15], s26 offen offset:1024 lds
v_mfma_f32_16x16x32_bf16 a[236:239], a[88:91], a[136:139], a[236:239]
ds_read_b64_tr_b16 a[134:135], v4 offset:18432
v_mfma_f32_16x16x32_bf16 a[236:239], a[92:95], a[140:143], a[236:239]
v_mfma_f32_16x16x32_bf16 a[240:243], a[96:99], a[136:139], a[240:243]
v_mfma_f32_16x16x32_bf16 a[240:243], a[100:103], a[140:143], a[240:243]
buffer_load_dwordx4 v18, s[12:15], s26 offen offset:2048 lds
v_mfma_f32_16x16x32_bf16 a[244:247], a[104:107], a[136:139], a[244:247]
v_mfma_f32_16x16x32_bf16 a[244:247], a[108:111], a[140:143], a[244:247]
v_mfma_f32_16x16x32_bf16 a[248:251], a[112:115], a[136:139], a[248:251]
v_mfma_f32_16x16x32_bf16 a[248:251], a[116:119], a[140:143], a[248:251]
buffer_load_dwordx4 v19, s[12:15], s26 offen offset:3072 lds
v_mfma_f32_16x16x32_bf16 a[252:255], a[120:123], a[136:139], a[252:255]
s_add_u32 s26, s26, 524288
v_mfma_f32_16x16x32_bf16 a[252:255], a[124:127], a[140:143], a[252:255]
s_waitcnt lgkmcnt(0)
buffer_store_dword v27, v26, s[4:7], s82 offen sc1
v_mfma_f32_16x16x32_bf16 v[32:35], a[0:3], a[128:131], v[32:35]
s_add_u32 m0, s29, 114688
ds_read_b64_tr_b16 a[136:137], v5 offset:0
v_mfma_f32_16x16x32_bf16 v[32:35], a[4:7], a[132:135], v[32:35]
buffer_load_dwordx4 v16, s[12:15], s27 offen offset:0 lds
v_mfma_f32_16x16x32_bf16 v[36:39], a[8:11], a[128:131], v[36:39]
ds_read_b64_tr_b16 a[138:139], v5 offset:2048
v_mfma_f32_16x16x32_bf16 v[36:39], a[12:15], a[132:135], v[36:39]
v_mfma_f32_16x16x32_bf16 v[40:43], a[16:19], a[128:131], v[40:43]
ds_read_b64_tr_b16 a[140:141], v5 offset:16384
v_mfma_f32_16x16x32_bf16 v[40:43], a[20:23], a[132:135], v[40:43]
buffer_load_dwordx4 v17, s[12:15], s27 offen offset:1024 lds
v_mfma_f32_16x16x32_bf16 v[44:47], a[24:27], a[128:131], v[44:47]
ds_read_b64_tr_b16 a[142:143], v5 offset:18432
v_mfma_f32_16x16x32_bf16 v[44:47], a[28:31], a[132:135], v[44:47]
v_mfma_f32_16x16x32_bf16 v[48:51], a[32:35], a[128:131], v[48:51]
ds_read_b128 a[64:67], v2 offset:32768
v_mfma_f32_16x16x32_bf16 v[48:51], a[36:39], a[132:135], v[48:51]
buffer_load_dwordx4 v18, s[12:15], s27 offen offset:2048 lds
v_mfma_f32_16x16x32_bf16 v[52:55], a[40:43], a[128:131], v[52:55]
ds_read_b128 a[68:71], v3 offset:32768
v_mfma_f32_16x16x32_bf16 v[52:55], a[44:47], a[132:135], v[52:55]
v_mfma_f32_16x16x32_bf16 v[56:59], a[48:51], a[128:131], v[56:59]
v_mfma_f32_16x16x32_bf16 v[56:59], a[52:55], a[132:135], v[56:59]
buffer_load_dwordx4 v19, s[12:15], s27 offen offset:3072 lds
v_mfma_f32_16x16x32_bf16 v[60:63], a[56:59], a[128:131], v[60:63]
s_add_u32 s27, s27, 524288
ds_read_b128 a[72:75], v2 offset:34816
v_mfma_f32_16x16x32_bf16 v[60:63], a[60:63], a[132:135], v[60:63]
s_waitcnt lgkmcnt(3)
v_mfma_f32_16x16x32_bf16 v[64:67], a[0:3], a[136:139], v[64:67]
s_add_u32 m0, s28, 0
ds_read_b64_tr_b16 a[128:129], v6 offset:0
v_mfma_f32_16x16x32_bf16 v[64:67], a[4:7], a[140:143], v[64:67]
buffer_load_dwordx4 v12, s[8:11], s24 offen offset:0 lds
v_mfma_f32_16x16x32_bf16 v[68:71], a[8:11], a[136:139], v[68:71]
ds_read_b64_tr_b16 a[130:131], v6 offset:2048
v_mfma_f32_16x16x32_bf16 v[68:71], a[12:15], a[140:143], v[68:71]
v_mfma_f32_16x16x32_bf16 v[72:75], a[16:19], a[136:139], v[72:75]
ds_read_b64_tr_b16 a[132:133], v6 offset:16384
v_mfma_f32_16x16x32_bf16 v[72:75], a[20:23], a[140:143], v[72:75]
buffer_load_dwordx4 v13, s[8:11], s24 offen offset:1024 lds
v_mfma_f32_16x16x32_bf16 v[76:79], a[24:27], a[136:139], v[76:79]
ds_read_b64_tr_b16 a[134:135], v6 offset:18432
v_mfma_f32_16x16x32_bf16 v[76:79], a[28:31], a[140:143], v[76:79]
v_mfma_f32_16x16x32_bf16 v[80:83], a[32:35], a[136:139], v[80:83]
ds_read_b128 a[76:79], v3 offset:34816
v_mfma_f32_16x16x32_bf16 v[80:83], a[36:39], a[140:143], v[80:83]
buffer_load_dwordx4 v14, s[8:11], s24 offen offset:2048 lds
v_mfma_f32_16x16x32_bf16 v[84:87], a[40:43], a[136:139], v[84:87]
v_mfma_f32_16x16x32_bf16 v[84:87], a[44:47], a[140:143], v[84:87]
v_mfma_f32_16x16x32_bf16 v[88:91], a[48:51], a[136:139], v[88:91]
ds_read_b128 a[80:83], v2 offset:36864
v_mfma_f32_16x16x32_bf16 v[88:91], a[52:55], a[140:143], v[88:91]
buffer_load_dwordx4 v15, s[8:11], s24 offen offset:3072 lds
v_mfma_f32_16x16x32_bf16 v[92:95], a[56:59], a[136:139], v[92:95]
s_add_u32 s24, s24, 128
ds_read_b128 a[84:87], v3 offset:36864
v_mfma_f32_16x16x32_bf16 v[92:95], a[60:63], a[140:143], v[92:95]
s_waitcnt lgkmcnt(3)
v_mfma_f32_16x16x32_bf16 v[96:99], a[0:3], a[128:131], v[96:99]
s_add_u32 m0, s28, 4096
ds_read_b64_tr_b16 a[136:137], v7 offset:0
v_mfma_f32_16x16x32_bf16 v[96:99], a[4:7], a[132:135], v[96:99]
buffer_load_dwordx4 v12, s[8:11], s25 offen offset:0 lds
v_mfma_f32_16x16x32_bf16 v[100:103], a[8:11], a[128:131], v[100:103]
ds_read_b64_tr_b16 a[138:139], v7 offset:2048
v_mfma_f32_16x16x32_bf16 v[100:103], a[12:15], a[132:135], v[100:103]
v_mfma_f32_16x16x32_bf16 v[104:107], a[16:19], a[128:131], v[104:107]
ds_read_b64_tr_b16 a[140:141], v7 offset:16384
v_mfma_f32_16x16x32_bf16 v[104:107], a[20:23], a[132:135], v[104:107]
buffer_load_dwordx4 v13, s[8:11], s25 offen offset:1024 lds
v_mfma_f32_16x16x32_bf16 v[108:111], a[24:27], a[128:131], v[108:111]
ds_read_b64_tr_b16 a[142:143], v7 offset:18432
v_mfma_f32_16x16x32_bf16 v[108:111], a[28:31], a[132:135], v[108:111]
v_mfma_f32_16x16x32_bf16 v[112:115], a[32:35], a[128:131], v[112:115]
v_mfma_f32_16x16x32_bf16 v[112:115], a[36:39], a[132:135], v[112:115]
buffer_load_dwordx4 v14, s[8:11], s25 offen offset:2048 lds
v_mfma_f32_16x16x32_bf16 v[116:119], a[40:43], a[128:131], v[116:119]
ds_read_b128 a[88:91], v2 offset:38912
v_mfma_f32_16x16x32_bf16 v[116:119], a[44:47], a[132:135], v[116:119]
v_mfma_f32_16x16x32_bf16 v[120:123], a[48:51], a[128:131], v[120:123]
ds_read_b128 a[92:95], v3 offset:38912
v_mfma_f32_16x16x32_bf16 v[120:123], a[52:55], a[132:135], v[120:123]
buffer_load_dwordx4 v15, s[8:11], s25 offen offset:3072 lds
v_mfma_f32_16x16x32_bf16 v[124:127], a[56:59], a[128:131], v[124:127]
s_add_u32 s25, s25, 128
v_mfma_f32_16x16x32_bf16 v[124:127], a[60:63], a[132:135], v[124:127]
s_waitcnt lgkmcnt(2)
v_mfma_f32_16x16x32_bf16 v[128:131], a[0:3], a[136:139], v[128:131]
ds_read_b64_tr_b16 a[128:129], v8 offset:0
v_mfma_f32_16x16x32_bf16 v[128:131], a[4:7], a[140:143], v[128:131]
buffer_load_dword v21, v20, s[16:19], s43 offen
v_mfma_f32_16x16x32_bf16 v[132:135], a[8:11], a[136:139], v[132:135]
s_add_u32 s43, s43, s47
ds_read_b64_tr_b16 a[130:131], v8 offset:2048
v_mfma_f32_16x16x32_bf16 v[132:135], a[12:15], a[140:143], v[132:135]
s_cmp_ge_u32 s43, s51
v_mfma_f32_16x16x32_bf16 v[136:139], a[16:19], a[136:139], v[136:139]
s_cselect_b32 s43, 0, s43
ds_read_b64_tr_b16 a[132:133], v8 offset:16384
v_mfma_f32_16x16x32_bf16 v[136:139], a[20:23], a[140:143], v[136:139]
s_cselect_b32 s51, s42, s51
v_mfma_f32_16x16x32_bf16 v[140:143], a[24:27], a[136:139], v[140:143]
s_cselect_b64 s[16:17], s[40:41], s[16:17]
ds_read_b64_tr_b16 a[134:135], v8 offset:18432
v_mfma_f32_16x16x32_bf16 v[140:143], a[28:31], a[140:143], v[140:143]
s_cselect_b32 s18, s42, s18
v_mfma_f32_16x16x32_bf16 v[144:147], a[32:35], a[136:139], v[144:147]
s_cselect_b64 s[40:41], s[44:45], s[40:41]
ds_read_b128 a[96:99], v2 offset:40960
v_mfma_f32_16x16x32_bf16 v[144:147], a[36:39], a[140:143], v[144:147]
s_cselect_b32 s42, s46, s42
v_mfma_f32_16x16x32_bf16 v[148:151], a[40:43], a[136:139], v[148:151]
s_cselect_b32 s46, 0, s46
v_mfma_f32_16x16x32_bf16 v[148:151], a[44:47], a[140:143], v[148:151]
s_cmp_eq_u32 s30, s55
v_mfma_f32_16x16x32_bf16 v[152:155], a[48:51], a[136:139], v[152:155]
s_cselect_b32 s22, 0, 3221225472
ds_read_b128 a[100:103], v3 offset:40960
v_mfma_f32_16x16x32_bf16 v[152:155], a[52:55], a[140:143], v[152:155]
s_sub_u32 s30, s30, 1
buffer_atomic_add v27, v26, s[60:63], s22 offen sc1
v_mfma_f32_16x16x32_bf16 v[156:159], a[56:59], a[136:139], v[156:159]
ds_read_b128 a[104:107], v2 offset:43008
v_mfma_f32_16x16x32_bf16 v[156:159], a[60:63], a[140:143], v[156:159]
s_waitcnt lgkmcnt(3)
v_mfma_f32_16x16x32_bf16 v[160:163], a[0:3], a[128:131], v[160:163]
ds_read_b64_tr_b16 a[136:137], v9 offset:0
v_mfma_f32_16x16x32_bf16 v[160:163], a[4:7], a[132:135], v[160:163]
v_mfma_f32_16x16x32_bf16 v[164:167], a[8:11], a[128:131], v[164:167]
ds_read_b64_tr_b16 a[138:139], v9 offset:2048
v_mfma_f32_16x16x32_bf16 v[164:167], a[12:15], a[132:135], v[164:167]
v_mfma_f32_16x16x32_bf16 v[168:171], a[16:19], a[128:131], v[168:171]
ds_read_b64_tr_b16 a[140:141], v9 offset:16384
v_mfma_f32_16x16x32_bf16 v[168:171], a[20:23], a[132:135], v[168:171]
v_mfma_f32_16x16x32_bf16 v[172:175], a[24:27], a[128:131], v[172:175]
ds_read_b64_tr_b16 a[142:143], v9 offset:18432
v_mfma_f32_16x16x32_bf16 v[172:175], a[28:31], a[132:135], v[172:175]
v_mfma_f32_16x16x32_bf16 v[176:179], a[32:35], a[128:131], v[176:179]
v_mfma_f32_16x16x32_bf16 v[176:179], a[36:39], a[132:135], v[176:179]
v_mfma_f32_16x16x32_bf16 v[180:183], a[40:43], a[128:131], v[180:183]
ds_read_b128 a[108:111], v3 offset:43008
v_mfma_f32_16x16x32_bf16 v[180:183], a[44:47], a[132:135], v[180:183]
v_mfma_f32_16x16x32_bf16 v[184:187], a[48:51], a[128:131], v[184:187]
ds_read_b128 a[112:115], v2 offset:45056
v_mfma_f32_16x16x32_bf16 v[184:187], a[52:55], a[132:135], v[184:187]
v_mfma_f32_16x16x32_bf16 v[188:191], a[56:59], a[128:131], v[188:191]
v_mfma_f32_16x16x32_bf16 v[188:191], a[60:63], a[132:135], v[188:191]
s_waitcnt lgkmcnt(2)
v_mfma_f32_16x16x32_bf16 v[192:195], a[0:3], a[136:139], v[192:195]
ds_read_b64_tr_b16 a[128:129], v10 offset:0
v_mfma_f32_16x16x32_bf16 v[192:195], a[4:7], a[140:143], v[192:195]
v_mfma_f32_16x16x32_bf16 v[196:199], a[8:11], a[136:139], v[196:199]
ds_read_b64_tr_b16 a[130:131], v10 offset:2048
v_mfma_f32_16x16x32_bf16 v[196:199], a[12:15], a[140:143], v[196:199]
v_mfma_f32_16x16x32_bf16 v[200:203], a[16:19], a[136:139], v[200:203]
ds_read_b64_tr_b16 a[132:133], v10 offset:16384
v_mfma_f32_16x16x32_bf16 v[200:203], a[20:23], a[140:143], v[200:203]
v_mfma_f32_16x16x32_bf16 v[204:207], a[24:27], a[136:139], v[204:207]
ds_read_b64_tr_b16 a[134:135], v10 offset:18432
v_mfma_f32_16x16x32_bf16 v[204:207], a[28:31], a[140:143], v[204:207]
v_mfma_f32_16x16x32_bf16 v[208:211], a[32:35], a[136:139], v[208:211]
ds_read_b128 a[116:119], v3 offset:45056
v_mfma_f32_16x16x32_bf16 v[208:211], a[36:39], a[140:143], v[208:211]
v_mfma_f32_16x16x32_bf16 v[212:215], a[40:43], a[136:139], v[212:215]
ds_read_b128 a[120:123], v2 offset:47104
v_mfma_f32_16x16x32_bf16 v[212:215], a[44:47], a[140:143], v[212:215]
v_mfma_f32_16x16x32_bf16 v[216:219], a[48:51], a[136:139], v[216:219]
v_mfma_f32_16x16x32_bf16 v[216:219], a[52:55], a[140:143], v[216:219]
v_mfma_f32_16x16x32_bf16 v[220:223], a[56:59], a[136:139], v[220:223]
ds_read_b128 a[124:127], v3 offset:47104
v_mfma_f32_16x16x32_bf16 v[220:223], a[60:63], a[140:143], v[220:223]
s_waitcnt lgkmcnt(3)
v_mfma_f32_16x16x32_bf16 a[192:195], a[0:3], a[128:131], a[192:195]
ds_read_b64_tr_b16 a[136:137], v11 offset:0
v_mfma_f32_16x16x32_bf16 a[192:195], a[4:7], a[132:135], a[192:195]
v_mfma_f32_16x16x32_bf16 a[196:199], a[8:11], a[128:131], a[196:199]
ds_read_b64_tr_b16 a[138:139], v11 offset:2048
v_mfma_f32_16x16x32_bf16 a[196:199], a[12:15], a[132:135], a[196:199]
v_mfma_f32_16x16x32_bf16 a[200:203], a[16:19], a[128:131], a[200:203]
ds_read_b64_tr_b16 a[140:141], v11 offset:16384
v_mfma_f32_16x16x32_bf16 a[200:203], a[20:23], a[132:135], a[200:203]
v_mfma_f32_16x16x32_bf16 a[204:207], a[24:27], a[128:131], a[204:207]
ds_read_b64_tr_b16 a[142:143], v11 offset:18432
v_mfma_f32_16x16x32_bf16 a[204:207], a[28:31], a[132:135], a[204:207]
v_mfma_f32_16x16x32_bf16 a[208:211], a[32:35], a[128:131], a[208:211]
v_mfma_f32_16x16x32_bf16 a[208:211], a[36:39], a[132:135], a[208:211]
v_mfma_f32_16x16x32_bf16 a[212:215], a[40:43], a[128:131], a[212:215]
v_mfma_f32_16x16x32_bf16 a[212:215], a[44:47], a[132:135], a[212:215]
v_mfma_f32_16x16x32_bf16 a[216:219], a[48:51], a[128:131], a[216:219]
v_mfma_f32_16x16x32_bf16 a[216:219], a[52:55], a[132:135], a[216:219]
v_mfma_f32_16x16x32_bf16 a[220:223], a[56:59], a[128:131], a[220:223]
s_waitcnt vmcnt(2) lgkmcnt(0)
v_mfma_f32_16x16x32_bf16 a[220:223], a[60:63], a[132:135], a[220:223]
s_barrier
v_mfma_f32_16x16x32_bf16 a[224:227], a[0:3], a[136:139], a[224:227]
s_add_u32 m0, s29, 65536
ds_read_b64_tr_b16 a[128:129], v4 offset:32768
v_mfma_f32_16x16x32_bf16 a[224:227], a[4:7], a[140:143], a[224:227]
buffer_load_dwordx4 v16, s[12:15], s26 offen offset:0 lds
v_mfma_f32_16x16x32_bf16 a[228:231], a[8:11], a[136:139], a[228:231]
ds_read_b64_tr_b16 a[130:131], v4 offset:34816
v_mfma_f32_16x16x32_bf16 a[228:231], a[12:15], a[140:143], a[228:231]
v_mfma_f32_16x16x32_bf16 a[232:235], a[16:19], a[136:139], a[232:235]
ds_read_b64_tr_b16 a[132:133], v4 offset:49152
v_mfma_f32_16x16x32_bf16 a[232:235], a[20:23], a[140:143], a[232:235]
buffer_load_dwordx4 v17, s[12:15], s26 offen offset:1024 lds
v_mfma_f32_16x16x32_bf16 a[236:239], a[24:27], a[136:139], a[236:239]
ds_read_b64_tr_b16 a[134:135], v4 offset:51200
v_mfma_f32_16x16x32_bf16 a[236:239], a[28:31], a[140:143], a[236:239]
v_mfma_f32_16x16x32_bf16 a[240:243], a[32:35], a[136:139], a[240:243]
v_mfma_f32_16x16x32_bf16 a[240:243], a[36:39], a[140:143], a[240:243]
buffer_load_dwordx4 v18, s[12:15], s26 offen offset:2048 lds
v_mfma_f32_16x16x32_bf16 a[244:247], a[40:43], a[136:139], a[244:247]
v_mfma_f32_16x16x32_bf16 a[244:247], a[44:47], a[140:143], a[244:247]
v_mfma_f32_16x16x32_bf16 a[248:251], a[48:51], a[136:139], a[248:251]
v_mfma_f32_16x16x32_bf16 a[248:251], a[52:55], a[140:143], a[248:251]
s_waitcnt lgkmcnt(0)
buffer_load_dwordx4 v19, s[12:15], s26 offen offset:3072 lds
v_mfma_f32_16x16x32_bf16 a[252:255], a[56:59], a[136:139], a[252:255]
s_add_u32 s26, s26, 524288
s_bitcmp1_b32 s30, 1
v_mfma_f32_16x16x32_bf16 a[252:255], a[60:63], a[140:143], a[252:255]
s_cbranch_scc1 Lg_501
s_cmp_eq_u32 s30, 0
s_cbranch_scc1 Lg_501t
v_mfma_f32_16x16x32_bf16 v[32:35], a[64:67], a[128:131], v[32:35]
s_add_u32 m0, s29, 81920
ds_read_b64_tr_b16 a[136:137], v5 offset:32768
v_mfma_f32_16x16x32_bf16 v[32:35], a[68:71], a[132:135], v[32:35]
buffer_load_dwordx4 v16, s[12:15], s27 offen offset:0 lds
v_mfma_f32_16x16x32_bf16 v[36:39], a[72:75], a[128:131], v[36:39]
s_lshl_b32 s22, s38, 3
ds_read_b64_tr_b16 a[138:139], v5 offset:34816
v_mfma_f32_16x16x32_bf16 v[36:39], a[76:79], a[132:135], v[36:39]
s_lshl_b32 s23, s39, 5
v_and_b32 v252, 31, v0
v_lshrrev_b32 v253, 5, v0
v_mfma_f32_16x16x32_bf16 v[40:43], a[80:83], a[128:131], v[40:43]
ds_read_b64_tr_b16 a[140:141], v5 offset:49152
v_add_u32 v253, s22, v253
v_mfma_f32_16x16x32_bf16 v[40:43], a[84:87], a[132:135], v[40:43]
buffer_load_dwordx4 v17, s[12:15], s27 offen offset:1024 lds
v_mfma_f32_16x16x32_bf16 v[44:47], a[88:91], a[128:131], v[44:47]
ds_read_b64_tr_b16 a[142:143], v5 offset:51200
v_add_u32 v252, s23, v252
v_mfma_f32_16x16x32_bf16 v[44:47], a[92:95], a[132:135], v[44:47]
v_mul_u32_u24 v254, 7168, v253
v_lshl_add_u32 v254, v252, 2, v254
v_mfma_f32_16x16x32_bf16 v[48:51], a[96:99], a[128:131], v[48:51]
ds_read_b128 a[0:3], v2 offset:0
v_lshlrev_b32 v252, 4, v252
v_mfma_f32_16x16x32_bf16 v[48:51], a[100:103], a[132:135], v[48:51]
buffer_load_dwordx4 v18, s[12:15], s27 offen offset:2048 lds
v_mfma_f32_16x16x32_bf16 v[52:55], a[104:107], a[128:131], v[52:55]
ds_read_b128 a[4:7], v3 offset:0
v_add_u32 v255, 3584, v254
v_mfma_f32_16x16x32_bf16 v[52:55], a[108:111], a[132:135], v[52:55]
v_subrev_u32 v22, 3584, v254
v_subrev_u32 v23, 2688, v254
v_mfma_f32_16x16x32_bf16 v[56:59], a[112:115], a[128:131], v[56:59]
v_subrev_u32 v24, 1792, v254
v_subrev_u32 v25, 896, v254
v_mfma_f32_16x16x32_bf16 v[56:59], a[116:119], a[132:135], v[56:59]
buffer_load_dwordx4 v19, s[12:15], s27 offen offset:3072 lds
v_mfma_f32_16x16x32_bf16 v[60:63], a[120:123], a[128:131], v[60:63]
s_add_u32 s27, s27, 524288
ds_read_b128 a[8:11], v2 offset:2048
v_mfma_f32_16x16x32_bf16 v[60:63], a[124:127], a[132:135], v[60:63]
s_waitcnt lgkmcnt(3)
v_mfma_f32_16x16x32_bf16 v[64:67], a[64:67], a[136:139], v[64:67]
s_add_u32 m0, s28, 32768
ds_read_b64_tr_b16 a[128:129], v6 offset:32768
v_mfma_f32_16x16x32_bf16 v[64:67], a[68:71], a[140:143], v[64:67]
buffer_load_dwordx4 v12, s[8:11], s24 offen offset:0 lds
v_mfma_f32_16x16x32_bf16 v[68:71], a[72:75], a[136:139], v[68:71]
ds_read_b64_tr_b16 a[130:131], v6 offset:34816
v_mfma_f32_16x16x32_bf16 v[68:71], a[76:79], a[140:143], v[68:71]
PAD_23:
s_cbranch_execz PAD_27
v_mfma_f32_16x16x32_bf16 v[72:75], a[80:83], a[136:139], v[72:75]
ds_read_b64_tr_b16 a[132:133], v6 offset:49152
v_mfma_f32_16x16x32_bf16 v[72:75], a[84:87], a[140:143], v[72:75]
buffer_load_dwordx4 v13, s[8:11], s24 offen offset:1024 lds
v_mfma_f32_16x16x32_bf16 v[76:79], a[88:91], a[136:139], v[76:79]
ds_read_b64_tr_b16 a[134:135], v6 offset:51200
v_mfma_f32_16x16x32_bf16 v[76:79], a[92:95], a[140:143], v[76:79]
v_mfma_f32_16x16x32_bf16 v[80:83], a[96:99], a[136:139], v[80:83]
ds_read_b128 a[12:15], v3 offset:2048
v_mfma_f32_16x16x32_bf16 v[80:83], a[100:103], a[140:143], v[80:83]
buffer_load_dwordx4 v14, s[8:11], s24 offen offset:2048 lds
v_mfma_f32_16x16x32_bf16 v[84:87], a[104:107], a[136:139], v[84:87]
v_mfma_f32_16x16x32_bf16 v[84:87], a[108:111], a[140:143], v[84:87]
v_mfma_f32_16x16x32_bf16 v[88:91], a[112:115], a[136:139], v[88:91]
ds_read_b128 a[16:19], v2 offset:4096
v_mfma_f32_16x16x32_bf16 v[88:91], a[116:119], a[140:143], v[88:91]
buffer_load_dwordx4 v15, s[8:11], s24 offen offset:3072 lds
v_mfma_f32_16x16x32_bf16 v[92:95], a[120:123], a[136:139], v[92:95]
s_add_u32 s24, s24, 128
ds_read_b128 a[20:23], v3 offset:4096
v_mfma_f32_16x16x32_bf16 v[92:95], a[124:127], a[140:143], v[92:95]
s_waitcnt lgkmcnt(3)
v_mfma_f32_16x16x32_bf16 v[96:99], a[64:67], a[128:131], v[96:99]
s_add_u32 m0, s28, 36864
ds_read_b64_tr_b16 a[136:137], v7 offset:32768
v_mfma_f32_16x16x32_bf16 v[96:99], a[68:71], a[132:135], v[96:99]
buffer_load_dwordx4 v12, s[8:11], s25 offen offset:0 lds
v_mfma_f32_16x16x32_bf16 v[100:103], a[72:75], a[128:131], v[100:103]
ds_read_b64_tr_b16 a[138:139], v7 offset:34816
v_mfma_f32_16x16x32_bf16 v[100:103], a[76:79], a[132:135], v[100:103]
v_mfma_f32_16x16x32_bf16 v[104:107], a[80:83], a[128:131], v[104:107]
ds_read_b64_tr_b16 a[140:141], v7 offset:49152
v_mfma_f32_16x16x32_bf16 v[104:107], a[84:87], a[132:135], v[104:107]
buffer_load_dwordx4 v13, s[8:11], s25 offen offset:1024 lds
v_mfma_f32_16x16x32_bf16 v[108:111], a[88:91], a[128:131], v[108:111]
ds_read_b64_tr_b16 a[142:143], v7 offset:51200
v_mfma_f32_16x16x32_bf16 v[108:111], a[92:95], a[132:135], v[108:111]
v_mfma_f32_16x16x32_bf16 v[112:115], a[96:99], a[128:131], v[112:115]
v_mfma_f32_16x16x32_bf16 v[112:115], a[100:103], a[132:135], v[112:115]
buffer_load_dwordx4 v14, s[8:11], s25 offen offset:2048 lds
v_mfma_f32_16x16x32_bf16 v[116:119], a[104:107], a[128:131], v[116:119]
ds_read_b128 a[24:27], v2 offset:6144
v_mfma_f32_16x16x32_bf16 v[116:119], a[108:111], a[132:135], v[116:119]
v_mfma_f32_16x16x32_bf16 v[120:123], a[112:115], a[128:131], v[120:123]
ds_read_b128 a[28:31], v3 offset:6144
v_mfma_f32_16x16x32_bf16 v[120:123], a[116:119], a[132:135], v[120:123]
buffer_load_dwordx4 v15, s[8:11], s25 offen offset:3072 lds
v_mfma_f32_16x16x32_bf16 v[124:127], a[120:123], a[128:131], v[124:127]
s_add_u32 s25, s25, 128
v_mfma_f32_16x16x32_bf16 v[124:127], a[124:127], a[132:135], v[124:127]
s_waitcnt lgkmcnt(2)
v_mfma_f32_16x16x32_bf16 v[128:131], a[64:67], a[136:139], v[128:131]
s_mov_b64 s[56:57], s[70:71]
s_mov_b32 s58, 3584
s_mov_b32 s59, 0x20000
ds_read_b64_tr_b16 a[128:129], v8 offset:32768
buffer_load_dwordx4 v[248:251], v252, s[56:59], 0 offen
v_mfma_f32_16x16x32_bf16 v[128:131], a[68:71], a[140:143], v[128:131]
s_mov_b64 s[56:57], s[66:67]
s_mov_b32 s58, 1835008
buffer_load_dword v224, v22, s[56:59], 0 offen nt
v_mfma_f32_16x16x32_bf16 v[132:135], a[72:75], a[136:139], v[132:135]
ds_read_b64_tr_b16 a[130:131], v8 offset:34816
buffer_load_dword v225, v23, s[56:59], 0 offen nt
v_mfma_f32_16x16x32_bf16 v[132:135], a[76:79], a[140:143], v[132:135]
buffer_load_dword v226, v24, s[56:59], 0 offen nt
v_mfma_f32_16x16x32_bf16 v[136:139], a[80:83], a[136:139], v[136:139]
ds_read_b64_tr_b16 a[132:133], v8 offset:49152
buffer_load_dword v227, v25, s[56:59], 0 offen nt
v_mfma_f32_16x16x32_bf16 v[136:139], a[84:87], a[140:143], v[136:139]
buffer_load_dword v228, v254, s[56:59], 0 offen offset:0 nt
v_mfma_f32_16x16x32_bf16 v[140:143], a[88:91], a[136:139], v[140:143]
ds_read_b64_tr_b16 a[134:135], v8 offset:51200
buffer_load_dword v229, v254, s[56:59], 0 offen offset:896 nt
v_mfma_f32_16x16x32_bf16 v[140:143], a[92:95], a[140:143], v[140:143]
buffer_load_dword v230, v254, s[56:59], 0 offen offset:1792 nt
v_mfma_f32_16x16x32_bf16 v[144:147], a[96:99], a[136:139], v[144:147]
ds_read_b128 a[32:35], v2 offset:8192
buffer_load_dword v231, v254, s[56:59], 0 offen offset:2688 nt
v_mfma_f32_16x16x32_bf16 v[144:147], a[100:103], a[140:143], v[144:147]
buffer_load_dword v232, v255, s[56:59], 0 offen offset:0 nt
v_mfma_f32_16x16x32_bf16 v[148:151], a[104:107], a[136:139], v[148:151]
buffer_load_dword v233, v255, s[56:59], 0 offen offset:896 nt
v_mfma_f32_16x16x32_bf16 v[148:151], a[108:111], a[140:143], v[148:151]
buffer_load_dword v234, v255, s[56:59], 0 offen offset:1792 nt
v_mfma_f32_16x16x32_bf16 v[152:155], a[112:115], a[136:139], v[152:155]
ds_read_b128 a[36:39], v3 offset:8192
buffer_load_dword v235, v255, s[56:59], 0 offen offset:2688 nt
v_mfma_f32_16x16x32_bf16 v[152:155], a[116:119], a[140:143], v[152:155]
s_mov_b64 s[56:57], s[68:69]
buffer_load_dword v236, v25, s[56:59], 0 offen nt
v_mfma_f32_16x16x32_bf16 v[156:159], a[120:123], a[136:139], v[156:159]
ds_read_b128 a[40:43], v2 offset:10240
buffer_load_dword v237, v254, s[56:59], 0 offen offset:0 nt
v_mfma_f32_16x16x32_bf16 v[156:159], a[124:127], a[140:143], v[156:159]
s_waitcnt lgkmcnt(3)
buffer_load_dword v238, v254, s[56:59], 0 offen offset:896 nt
v_mfma_f32_16x16x32_bf16 v[160:163], a[64:67], a[128:131], v[160:163]
ds_read_b64_tr_b16 a[136:137], v9 offset:32768
buffer_load_dword v239, v254, s[56:59], 0 offen offset:1792 nt
v_mfma_f32_16x16x32_bf16 v[160:163], a[68:71], a[132:135], v[160:163]
buffer_load_dword v240, v254, s[56:59], 0 offen offset:2688 nt
v_mfma_f32_16x16x32_bf16 v[164:167], a[72:75], a[128:131], v[164:167]
ds_read_b64_tr_b16 a[138:139], v9 offset:34816
buffer_load_dword v241, v255, s[56:59], 0 offen offset:0 nt
v_mfma_f32_16x16x32_bf16 v[164:167], a[76:79], a[132:135], v[164:167]
buffer_load_dword v242, v255, s[56:59], 0 offen offset:896 nt
v_mfma_f32_16x16x32_bf16 v[168:171], a[80:83], a[128:131], v[168:171]
ds_read_b64_tr_b16 a[140:141], v9 offset:49152
buffer_load_dword v243, v255, s[56:59], 0 offen offset:1792 nt
v_mfma_f32_16x16x32_bf16 v[168:171], a[84:87], a[132:135], v[168:171]
buffer_load_dword v244, v255, s[56:59], 0 offen offset:2688 nt
v_mfma_f32_16x16x32_bf16 v[172:175], a[88:91], a[128:131], v[172:175]
ds_read_b64_tr_b16 a[142:143], v9 offset:51200
v_mfma_f32_16x16x32_bf16 v[172:175], a[92:95], a[132:135], v[172:175]
v_mfma_f32_16x16x32_bf16 v[176:179], a[96:99], a[128:131], v[176:179]
v_mfma_f32_16x16x32_bf16 v[176:179], a[100:103], a[132:135], v[176:179]
v_mfma_f32_16x16x32_bf16 v[180:183], a[104:107], a[128:131], v[180:183]
ds_read_b128 a[44:47], v3 offset:10240
v_mfma_f32_16x16x32_bf16 v[180:183], a[108:111], a[132:135], v[180:183]
v_mfma_f32_16x16x32_bf16 v[184:187], a[112:115], a[128:131], v[184:187]
ds_read_b128 a[48:51], v2 offset:12288
v_mfma_f32_16x16x32_bf16 v[184:187], a[116:119], a[132:135], v[184:187]
v_mfma_f32_16x16x32_bf16 v[188:191], a[120:123], a[128:131], v[188:191]
v_mfma_f32_16x16x32_bf16 v[188:191], a[124:127], a[132:135], v[188:191]
s_waitcnt lgkmcnt(2)
v_mfma_f32_16x16x32_bf16 v[192:195], a[64:67], a[136:139], v[192:195]
ds_read_b64_tr_b16 a[128:129], v10 offset:32768
v_mfma_f32_16x16x32_bf16 v[192:195], a[68:71], a[140:143], v[192:195]
v_mfma_f32_16x16x32_bf16 v[196:199], a[72:75], a[136:139], v[196:199]
ds_read_b64_tr_b16 a[130:131], v10 offset:34816
v_mfma_f32_16x16x32_bf16 v[196:199], a[76:79], a[140:143], v[196:199]
v_mfma_f32_16x16x32_bf16 v[200:203], a[80:83], a[136:139], v[200:203]
ds_read_b64_tr_b16 a[132:133], v10 offset:49152
v_mfma_f32_16x16x32_bf16 v[200:203], a[84:87], a[140:143], v[200:203]
v_mfma_f32_16x16x32_bf16 v[204:207], a[88:91], a[136:139], v[204:207]
ds_read_b64_tr_b16 a[134:135], v10 offset:51200
v_mfma_f32_16x16x32_bf16 v[204:207], a[92:95], a[140:143], v[204:207]
v_mfma_f32_16x16x32_bf16 v[208:211], a[96:99], a[136:139], v[208:211]
ds_read_b128 a[52:55], v3 offset:12288
v_mfma_f32_16x16x32_bf16 v[208:211], a[100:103], a[140:143], v[208:211]
v_mfma_f32_16x16x32_bf16 v[212:215], a[104:107], a[136:139], v[212:215]
ds_read_b128 a[56:59], v2 offset:14336
v_mfma_f32_16x16x32_bf16 v[212:215], a[108:111], a[140:143], v[212:215]
v_mfma_f32_16x16x32_bf16 v[216:219], a[112:115], a[136:139], v[216:219]
v_mfma_f32_16x16x32_bf16 v[216:219], a[116:119], a[140:143], v[216:219]
v_mfma_f32_16x16x32_bf16 v[220:223], a[120:123], a[136:139], v[220:223]
ds_read_b128 a[60:63], v3 offset:14336
v_mfma_f32_16x16x32_bf16 v[220:223], a[124:127], a[140:143], v[220:223]
s_waitcnt lgkmcnt(3)
v_mfma_f32_16x16x32_bf16 a[192:195], a[64:67], a[128:131], a[192:195]
ds_read_b64_tr_b16 a[136:137], v11 offset:32768
v_mfma_f32_16x16x32_bf16 a[192:195], a[68:71], a[132:135], a[192:195]
v_mfma_f32_16x16x32_bf16 a[196:199], a[72:75], a[128:131], a[196:199]
ds_read_b64_tr_b16 a[138:139], v11 offset:34816
v_mfma_f32_16x16x32_bf16 a[196:199], a[76:79], a[132:135], a[196:199]
v_mfma_f32_16x16x32_bf16 a[200:203], a[80:83], a[128:131], a[200:203]
ds_read_b64_tr_b16 a[140:141], v11 offset:49152
v_mfma_f32_16x16x32_bf16 a[200:203], a[84:87], a[132:135], a[200:203]
v_mfma_f32_16x16x32_bf16 a[204:207], a[88:91], a[128:131], a[204:207]
ds_read_b64_tr_b16 a[142:143], v11 offset:51200
v_mfma_f32_16x16x32_bf16 a[204:207], a[92:95], a[132:135], a[204:207]
v_mfma_f32_16x16x32_bf16 a[208:211], a[96:99], a[128:131], a[208:211]
v_mfma_f32_16x16x32_bf16 a[208:211], a[100:103], a[132:135], a[208:211]
v_mfma_f32_16x16x32_bf16 a[212:215], a[104:107], a[128:131], a[212:215]
v_mfma_f32_16x16x32_bf16 a[212:215], a[108:111], a[132:135], a[212:215]
v_mfma_f32_16x16x32_bf16 a[216:219], a[112:115], a[128:131], a[216:219]
v_mfma_f32_16x16x32_bf16 a[216:219], a[116:119], a[132:135], a[216:219]
v_mfma_f32_16x16x32_bf16 a[220:223], a[120:123], a[128:131], a[220:223]
s_waitcnt vmcnt(22) lgkmcnt(0)
v_mfma_f32_16x16x32_bf16 a[220:223], a[124:127], a[132:135], a[220:223]
s_barrier
v_mfma_f32_16x16x32_bf16 a[224:227], a[64:67], a[136:139], a[224:227]
s_add_u32 m0, s29, 98304
ds_read_b64_tr_b16 a[128:129], v4 offset:0
v_mfma_f32_16x16x32_bf16 a[224:227], a[68:71], a[140:143], a[224:227]
buffer_load_dwordx4 v16, s[12:15], s26 offen offset:0 lds
v_mfma_f32_16x16x32_bf16 a[228:231], a[72:75], a[136:139], a[228:231]
ds_read_b64_tr_b16 a[130:131], v4 offset:2048
v_mfma_f32_16x16x32_bf16 a[228:231], a[76:79], a[140:143], a[228:231]
v_mfma_f32_16x16x32_bf16 a[232:235], a[80:83], a[136:139], a[232:235]
ds_read_b64_tr_b16 a[132:133], v4 offset:16384
v_mfma_f32_16x16x32_bf16 a[232:235], a[84:87], a[140:143], a[232:235]
buffer_load_dwordx4 v17, s[12:15], s26 offen offset:1024 lds
v_mfma_f32_16x16x32_bf16 a[236:239], a[88:91], a[136:139], a[236:239]
ds_read_b64_tr_b16 a[134:135], v4 offset:18432
v_mfma_f32_16x16x32_bf16 a[236:239], a[92:95], a[140:143], a[236:239]
v_mfma_f32_16x16x32_bf16 a[240:243], a[96:99], a[136:139], a[240:243]
v_mfma_f32_16x16x32_bf16 a[240:243], a[100:103], a[140:143], a[240:243]
buffer_load_dwordx4 v18, s[12:15], s26 offen offset:2048 lds
v_mfma_f32_16x16x32_bf16 a[244:247], a[104:107], a[136:139], a[244:247]
v_mfma_f32_16x16x32_bf16 a[244:247], a[108:111], a[140:143], a[244:247]
v_mfma_f32_16x16x32_bf16 a[248:251], a[112:115], a[136:139], a[248:251]
v_mfma_f32_16x16x32_bf16 a[248:251], a[116:119], a[140:143], a[248:251]
buffer_load_dwordx4 v19, s[12:15], s26 offen offset:3072 lds
v_mfma_f32_16x16x32_bf16 a[252:255], a[120:123], a[136:139], a[252:255]
s_add_u32 s26, s26, 524288
v_mfma_f32_16x16x32_bf16 a[252:255], a[124:127], a[140:143], a[252:255]
s_waitcnt lgkmcnt(0)
v_mfma_f32_16x16x32_bf16 v[32:35], a[0:3], a[128:131], v[32:35]
s_add_u32 m0, s29, 114688
ds_read_b64_tr_b16 a[136:137], v5 offset:0
v_mfma_f32_16x16x32_bf16 v[32:35], a[4:7], a[132:135], v[32:35]
buffer_load_dwordx4 v16, s[12:15], s27 offen offset:0 lds
v_mfma_f32_16x16x32_bf16 v[36:39], a[8:11], a[128:131], v[36:39]
ds_read_b64_tr_b16 a[138:139], v5 offset:2048
v_mfma_f32_16x16x32_bf16 v[36:39], a[12:15], a[132:135], v[36:39]
v_mfma_f32_16x16x32_bf16 v[40:43], a[16:19], a[128:131], v[40:43]
ds_read_b64_tr_b16 a[140:141], v5 offset:16384
v_mfma_f32_16x16x32_bf16 v[40:43], a[20:23], a[132:135], v[40:43]
buffer_load_dwordx4 v17, s[12:15], s27 offen offset:1024 lds
v_mfma_f32_16x16x32_bf16 v[44:47], a[24:27], a[128:131], v[44:47]
ds_read_b64_tr_b16 a[142:143], v5 offset:18432
v_mfma_f32_16x16x32_bf16 v[44:47], a[28:31], a[132:135], v[44:47]
v_mfma_f32_16x16x32_bf16 v[48:51], a[32:35], a[128:131], v[48:51]
ds_read_b128 a[64:67], v2 offset:32768
v_mfma_f32_16x16x32_bf16 v[48:51], a[36:39], a[132:135], v[48:51]
buffer_load_dwordx4 v18, s[12:15], s27 offen offset:2048 lds
v_mfma_f32_16x16x32_bf16 v[52:55], a[40:43], a[128:131], v[52:55]
ds_read_b128 a[68:71], v3 offset:32768
v_mfma_f32_16x16x32_bf16 v[52:55], a[44:47], a[132:135], v[52:55]
v_mfma_f32_16x16x32_bf16 v[56:59], a[48:51], a[128:131], v[56:59]
v_mfma_f32_16x16x32_bf16 v[56:59], a[52:55], a[132:135], v[56:59]
buffer_load_dwordx4 v19, s[12:15], s27 offen offset:3072 lds
v_mfma_f32_16x16x32_bf16 v[60:63], a[56:59], a[128:131], v[60:63]
s_add_u32 s27, s27, 524288
ds_read_b128 a[72:75], v2 offset:34816
v_mfma_f32_16x16x32_bf16 v[60:63], a[60:63], a[132:135], v[60:63]
s_waitcnt lgkmcnt(3)
v_mfma_f32_16x16x32_bf16 v[64:67], a[0:3], a[136:139], v[64:67]
s_add_u32 m0, s28, 0
ds_read_b64_tr_b16 a[128:129], v6 offset:0
v_mfma_f32_16x16x32_bf16 v[64:67], a[4:7], a[140:143], v[64:67]
buffer_load_dwordx4 v12, s[8:11], s24 offen offset:0 lds
v_mfma_f32_16x16x32_bf16 v[68:71], a[8:11], a[136:139], v[68:71]
ds_read_b64_tr_b16 a[130:131], v6 offset:2048
v_mfma_f32_16x16x32_bf16 v[68:71], a[12:15], a[140:143], v[68:71]
v_mfma_f32_16x16x32_bf16 v[72:75], a[16:19], a[136:139], v[72:75]
ds_read_b64_tr_b16 a[132:133], v6 offset:16384
v_mfma_f32_16x16x32_bf16 v[72:75], a[20:23], a[140:143], v[72:75]
buffer_load_dwordx4 v13, s[8:11], s24 offen offset:1024 lds
v_mfma_f32_16x16x32_bf16 v[76:79], a[24:27], a[136:139], v[76:79]
ds_read_b64_tr_b16 a[134:135], v6 offset:18432
v_mfma_f32_16x16x32_bf16 v[76:79], a[28:31], a[140:143], v[76:79]
v_mfma_f32_16x16x32_bf16 v[80:83], a[32:35], a[136:139], v[80:83]
ds_read_b128 a[76:79], v3 offset:34816
v_mfma_f32_16x16x32_bf16 v[80:83], a[36:39], a[140:143], v[80:83]
buffer_load_dwordx4 v14, s[8:11], s24 offen offset:2048 lds
v_mfma_f32_16x16x32_bf16 v[84:87], a[40:43], a[136:139], v[84:87]
v_mfma_f32_16x16x32_bf16 v[84:87], a[44:47], a[140:143], v[84:87]
v_mfma_f32_16x16x32_bf16 v[88:91], a[48:51], a[136:139], v[88:91]
ds_read_b128 a[80:83], v2 offset:36864
v_mfma_f32_16x16x32_bf16 v[88:91], a[52:55], a[140:143], v[88:91]
buffer_load_dwordx4 v15, s[8:11], s24 offen offset:3072 lds
v_mfma_f32_16x16x32_bf16 v[92:95], a[56:59], a[136:139], v[92:95]
s_add_u32 s24, s24, 128
ds_read_b128 a[84:87], v3 offset:36864
v_mfma_f32_16x16x32_bf16 v[92:95], a[60:63], a[140:143], v[92:95]
s_waitcnt lgkmcnt(3)
v_mfma_f32_16x16x32_bf16 v[96:99], a[0:3], a[128:131], v[96:99]
s_add_u32 m0, s28, 4096
ds_read_b64_tr_b16 a[136:137], v7 offset:0
v_mfma_f32_16x16x32_bf16 v[96:99], a[4:7], a[132:135], v[96:99]
buffer_load_dwordx4 v12, s[8:11], s25 offen offset:0 lds
v_mfma_f32_16x16x32_bf16 v[100:103], a[8:11], a[128:131], v[100:103]
ds_read_b64_tr_b16 a[138:139], v7 offset:2048
v_mfma_f32_16x16x32_bf16 v[100:103], a[12:15], a[132:135], v[100:103]
v_mfma_f32_16x16x32_bf16 v[104:107], a[16:19], a[128:131], v[104:107]
ds_read_b64_tr_b16 a[140:141], v7 offset:16384
v_mfma_f32_16x16x32_bf16 v[104:107], a[20:23], a[132:135], v[104:107]
buffer_load_dwordx4 v13, s[8:11], s25 offen offset:1024 lds
v_mfma_f32_16x16x32_bf16 v[108:111], a[24:27], a[128:131], v[108:111]
ds_read_b64_tr_b16 a[142:143], v7 offset:18432
v_mfma_f32_16x16x32_bf16 v[108:111], a[28:31], a[132:135], v[108:111]
v_mfma_f32_16x16x32_bf16 v[112:115], a[32:35], a[128:131], v[112:115]
v_mfma_f32_16x16x32_bf16 v[112:115], a[36:39], a[132:135], v[112:115]
buffer_load_dwordx4 v14, s[8:11], s25 offen offset:2048 lds
v_mfma_f32_16x16x32_bf16 v[116:119], a[40:43], a[128:131], v[116:119]
ds_read_b128 a[88:91], v2 offset:38912
v_mfma_f32_16x16x32_bf16 v[116:119], a[44:47], a[132:135], v[116:119]
v_mfma_f32_16x16x32_bf16 v[120:123], a[48:51], a[128:131], v[120:123]
ds_read_b128 a[92:95], v3 offset:38912
v_mfma_f32_16x16x32_bf16 v[120:123], a[52:55], a[132:135], v[120:123]
buffer_load_dwordx4 v15, s[8:11], s25 offen offset:3072 lds
v_mfma_f32_16x16x32_bf16 v[124:127], a[56:59], a[128:131], v[124:127]
s_add_u32 s25, s25, 128
v_mfma_f32_16x16x32_bf16 v[124:127], a[60:63], a[132:135], v[124:127]
s_waitcnt lgkmcnt(2)
v_mfma_f32_16x16x32_bf16 v[128:131], a[0:3], a[136:139], v[128:131]
ds_read_b64_tr_b16 a[128:129], v8 offset:0
v_mfma_f32_16x16x32_bf16 v[128:131], a[4:7], a[140:143], v[128:131]
buffer_load_dword v21, v20, s[16:19], s43 offen
v_mfma_f32_16x16x32_bf16 v[132:135], a[8:11], a[136:139], v[132:135]
s_add_u32 s43, s43, s47
ds_read_b64_tr_b16 a[130:131], v8 offset:2048
v_mfma_f32_16x16x32_bf16 v[132:135], a[12:15], a[140:143], v[132:135]
s_cmp_ge_u32 s43, s51
v_mfma_f32_16x16x32_bf16 v[136:139], a[16:19], a[136:139], v[136:139]
s_cselect_b32 s43, 0, s43
ds_read_b64_tr_b16 a[132:133], v8 offset:16384
v_mfma_f32_16x16x32_bf16 v[136:139], a[20:23], a[140:143], v[136:139]
s_cselect_b32 s51, s42, s51
v_mfma_f32_16x16x32_bf16 v[140:143], a[24:27], a[136:139], v[140:143]
s_cselect_b64 s[16:17], s[40:41], s[16:17]
ds_read_b64_tr_b16 a[134:135], v8 offset:18432
v_mfma_f32_16x16x32_bf16 v[140:143], a[28:31], a[140:143], v[140:143]
s_cselect_b32 s18, s42, s18
v_mfma_f32_16x16x32_bf16 v[144:147], a[32:35], a[136:139], v[144:147]
s_cselect_b64 s[40:41], s[44:45], s[40:41]
ds_read_b128 a[96:99], v2 offset:40960
v_mfma_f32_16x16x32_bf16 v[144:147], a[36:39], a[140:143], v[144:147]
s_cselect_b32 s42, s46, s42
v_mfma_f32_16x16x32_bf16 v[148:151], a[40:43], a[136:139], v[148:151]
s_cselect_b32 s46, 0, s46
v_mfma_f32_16x16x32_bf16 v[148:151], a[44:47], a[140:143], v[148:151]
s_lshl_b32 s59, s39, 5
v_mfma_f32_16x16x32_bf16 v[152:155], a[48:51], a[136:139], v[152:155]
s_add_u32 s59, s59, s38
ds_read_b128 a[100:103], v3 offset:40960
v_mfma_f32_16x16x32_bf16 v[152:155], a[52:55], a[140:143], v[152:155]
s_lshl_b32 s59, s59, 2
v_mfma_f32_16x16x32_bf16 v[156:159], a[56:59], a[136:139], v[156:159]
s_add_u32 s59, s59, 94392320
ds_read_b128 a[104:107], v2 offset:43008
v_mfma_f32_16x16x32_bf16 v[156:159], a[60:63], a[140:143], v[156:159]
s_waitcnt lgkmcnt(3)
s_cmp_lt_u32 s2, 224
v_mfma_f32_16x16x32_bf16 v[160:163], a[0:3], a[128:131], v[160:163]
s_cselect_b32 s59, s59, 3221225472
ds_read_b64_tr_b16 a[136:137], v9 offset:0
v_mfma_f32_16x16x32_bf16 v[160:163], a[4:7], a[132:135], v[160:163]
s_mov_b32 s58, 0xffff0000
v_mfma_f32_16x16x32_bf16 v[164:167], a[8:11], a[128:131], v[164:167]
ds_read_b64_tr_b16 a[138:139], v9 offset:2048
v_mfma_f32_16x16x32_bf16 v[164:167], a[12:15], a[132:135], v[164:167]
buffer_load_dword v21, v20, s[16:19], s43 offen
v_mfma_f32_16x16x32_bf16 v[168:171], a[16:19], a[128:131], v[168:171]
s_add_u32 s43, s43, s47
ds_read_b64_tr_b16 a[140:141], v9 offset:16384
v_mfma_f32_16x16x32_bf16 v[168:171], a[20:23], a[132:135], v[168:171]
s_cmp_ge_u32 s43, s51
v_mfma_f32_16x16x32_bf16 v[172:175], a[24:27], a[128:131], v[172:175]
s_cselect_b32 s43, 0, s43
ds_read_b64_tr_b16 a[142:143], v9 offset:18432
v_mfma_f32_16x16x32_bf16 v[172:175], a[28:31], a[132:135], v[172:175]
s_cselect_b32 s51, s42, s51
v_mfma_f32_16x16x32_bf16 v[176:179], a[32:35], a[128:131], v[176:179]
s_cselect_b64 s[16:17], s[40:41], s[16:17]
v_mfma_f32_16x16x32_bf16 v[176:179], a[36:39], a[132:135], v[176:179]
s_cselect_b32 s18, s42, s18
v_mfma_f32_16x16x32_bf16 v[180:183], a[40:43], a[128:131], v[180:183]
s_cselect_b64 s[40:41], s[44:45], s[40:41]
ds_read_b128 a[108:111], v3 offset:43008
v_mfma_f32_16x16x32_bf16 v[180:183], a[44:47], a[132:135], v[180:183]
s_cselect_b32 s42, s46, s42
v_mfma_f32_16x16x32_bf16 v[184:187], a[48:51], a[128:131], v[184:187]
s_cselect_b32 s46, 0, s46
ds_read_b128 a[112:115], v2 offset:45056
v_mfma_f32_16x16x32_bf16 v[184:187], a[52:55], a[132:135], v[184:187]
v_mfma_f32_16x16x32_bf16 v[188:191], a[56:59], a[128:131], v[188:191]
v_mfma_f32_16x16x32_bf16 v[188:191], a[60:63], a[132:135], v[188:191]
s_waitcnt lgkmcnt(2)
v_mfma_f32_16x16x32_bf16 v[192:195], a[0:3], a[136:139], v[192:195]
ds_read_b64_tr_b16 a[128:129], v10 offset:0
v_mfma_f32_16x16x32_bf16 v[192:195], a[4:7], a[140:143], v[192:195]
v_mfma_f32_16x16x32_bf16 v[196:199], a[8:11], a[136:139], v[196:199]
ds_read_b64_tr_b16 a[130:131], v10 offset:2048
v_mfma_f32_16x16x32_bf16 v[196:199], a[12:15], a[140:143], v[196:199]
v_mfma_f32_16x16x32_bf16 v[200:203], a[16:19], a[136:139], v[200:203]
ds_read_b64_tr_b16 a[132:133], v10 offset:16384
v_mfma_f32_16x16x32_bf16 v[200:203], a[20:23], a[140:143], v[200:203]
v_mfma_f32_16x16x32_bf16 v[204:207], a[24:27], a[136:139], v[204:207]
ds_read_b64_tr_b16 a[134:135], v10 offset:18432
v_mfma_f32_16x16x32_bf16 v[204:207], a[28:31], a[140:143], v[204:207]
v_mfma_f32_16x16x32_bf16 v[208:211], a[32:35], a[136:139], v[208:211]
ds_read_b128 a[116:119], v3 offset:45056
v_mfma_f32_16x16x32_bf16 v[208:211], a[36:39], a[140:143], v[208:211]
v_mfma_f32_16x16x32_bf16 v[212:215], a[40:43], a[136:139], v[212:215]
ds_read_b128 a[120:123], v2 offset:47104
v_and_b32 v252, 31, v0
v_mfma_f32_16x16x32_bf16 v[212:215], a[44:47], a[140:143], v[212:215]
v_lshrrev_b32 v253, 5, v0
v_xor_b32 v253, v253, v252
v_mfma_f32_16x16x32_bf16 v[216:219], a[48:51], a[136:139], v[216:219]
v_and_b32 v253, 7, v253
v_lshlrev_b32 v252, 8, v252
v_mfma_f32_16x16x32_bf16 v[216:219], a[52:55], a[140:143], v[216:219]
v_lshl_add_u32 v252, v253, 4, v252
v_add_u32 v252, 147456, v252
v_mfma_f32_16x16x32_bf16 v[220:223], a[56:59], a[136:139], v[220:223]
ds_read_b128 a[124:127], v3 offset:47104
v_mfma_f32_16x16x32_bf16 v[220:223], a[60:63], a[140:143], v[220:223]
s_waitcnt lgkmcnt(3)
v_mfma_f32_16x16x32_bf16 a[192:195], a[0:3], a[128:131], a[192:195]
ds_read_b64_tr_b16 a[136:137], v11 offset:0
v_mfma_f32_16x16x32_bf16 a[192:195], a[4:7], a[132:135], a[192:195]
v_mfma_f32_16x16x32_bf16 a[196:199], a[8:11], a[128:131], a[196:199]
ds_read_b64_tr_b16 a[138:139], v11 offset:2048
v_mfma_f32_16x16x32_bf16 a[196:199], a[12:15], a[132:135], a[196:199]
v_mfma_f32_16x16x32_bf16 a[200:203], a[16:19], a[128:131], a[200:203]
ds_read_b64_tr_b16 a[140:141], v11 offset:16384
v_mfma_f32_16x16x32_bf16 a[200:203], a[20:23], a[132:135], a[200:203]
v_mfma_f32_16x16x32_bf16 a[204:207], a[24:27], a[128:131], a[204:207]
ds_read_b64_tr_b16 a[142:143], v11 offset:18432
v_mfma_f32_16x16x32_bf16 a[204:207], a[28:31], a[132:135], a[204:207]
v_mfma_f32_16x16x32_bf16 a[208:211], a[32:35], a[128:131], a[208:211]
v_mfma_f32_16x16x32_bf16 a[208:211], a[36:39], a[132:135], a[208:211]
v_mfma_f32_16x16x32_bf16 a[212:215], a[40:43], a[128:131], a[212:215]
v_mfma_f32_16x16x32_bf16 a[212:215], a[44:47], a[132:135], a[212:215]
v_mfma_f32_16x16x32_bf16 a[216:219], a[48:51], a[128:131], a[216:219]
v_mfma_f32_16x16x32_bf16 a[216:219], a[52:55], a[132:135], a[216:219]
v_mfma_f32_16x16x32_bf16 a[220:223], a[56:59], a[128:131], a[220:223]
s_waitcnt vmcnt(2) lgkmcnt(0)
v_mfma_f32_16x16x32_bf16 a[220:223], a[60:63], a[132:135], a[220:223]
s_barrier
v_mfma_f32_16x16x32_bf16 a[224:227], a[0:3], a[136:139], a[224:227]
s_add_u32 m0, s29, 65536
ds_read_b64_tr_b16 a[128:129], v4 offset:32768
v_lshlrev_b32 v28, 16, v248
v_mfma_f32_16x16x32_bf16 a[224:227], a[4:7], a[140:143], a[224:227]
buffer_load_dwordx4 v16, s[12:15], s26 offen offset:0 lds
v_mfma_f32_16x16x32_bf16 a[228:231], a[8:11], a[136:139], a[228:231]
ds_read_b64_tr_b16 a[130:131], v4 offset:34816
v_and_b32 v29, s58, v248
v_mfma_f32_16x16x32_bf16 a[228:231], a[12:15], a[140:143], a[228:231]
v_lshlrev_b32 v30, 16, v249
v_and_b32 v253, s58, v249
v_mfma_f32_16x16x32_bf16 a[232:235], a[16:19], a[136:139], a[232:235]
ds_read_b64_tr_b16 a[132:133], v4 offset:49152
v_lshlrev_b32 v22, 16, v224
v_mfma_f32_16x16x32_bf16 a[232:235], a[20:23], a[140:143], a[232:235]
buffer_load_dwordx4 v17, s[12:15], s26 offen offset:1024 lds
v_mfma_f32_16x16x32_bf16 a[236:239], a[24:27], a[136:139], a[236:239]
ds_read_b64_tr_b16 a[134:135], v4 offset:51200
v_lshlrev_b32 v23, 16, v225
v_mfma_f32_16x16x32_bf16 a[236:239], a[28:31], a[140:143], a[236:239]
v_lshlrev_b32 v24, 16, v226
v_mul_f32 v254, v22, v253
v_mfma_f32_16x16x32_bf16 a[240:243], a[32:35], a[136:139], a[240:243]
v_lshlrev_b32 v25, 16, v227
v_lshlrev_b32 v247, 16, v236
v_mfma_f32_16x16x32_bf16 a[240:243], a[36:39], a[140:143], a[240:243]
buffer_load_dwordx4 v18, s[12:15], s26 offen offset:2048 lds
v_mfma_f32_16x16x32_bf16 a[244:247], a[40:43], a[136:139], a[244:247]
v_fmac_f32 v254, v23, v30
v_fmac_f32 v254, v24, v29
v_mfma_f32_16x16x32_bf16 a[244:247], a[44:47], a[140:143], a[244:247]
v_fmac_f32 v254, v25, v28
v_mul_f32 v254, v254, v247
v_mfma_f32_16x16x32_bf16 a[248:251], a[48:51], a[136:139], a[248:251]
v_mul_f32 v255, v23, v253
v_lshlrev_b32 v22, 16, v228
v_mfma_f32_16x16x32_bf16 a[248:251], a[52:55], a[140:143], a[248:251]
buffer_load_dwordx4 v19, s[12:15], s26 offen offset:3072 lds
v_mfma_f32_16x16x32_bf16 a[252:255], a[56:59], a[136:139], a[252:255]
s_add_u32 s26, s26, 524288
v_lshlrev_b32 v247, 16, v237
v_fmac_f32 v255, v24, v30
v_mfma_f32_16x16x32_bf16 a[252:255], a[60:63], a[140:143], a[252:255]
s_waitcnt lgkmcnt(0)
v_fmac_f32 v255, v25, v29
v_fmac_f32 v255, v22, v28
v_mfma_f32_16x16x32_bf16 v[32:35], a[64:67], a[128:131], v[32:35]
s_add_u32 m0, s29, 81920
ds_read_b64_tr_b16 a[136:137], v5 offset:32768
v_mul_f32 v255, v255, v247
v_mfma_f32_16x16x32_bf16 v[32:35], a[68:71], a[132:135], v[32:35]
buffer_load_dwordx4 v16, s[12:15], s27 offen offset:0 lds
v_mfma_f32_16x16x32_bf16 v[36:39], a[72:75], a[128:131], v[36:39]
ds_read_b64_tr_b16 a[138:139], v5 offset:34816
v_cvt_pk_bf16_f32 v246, v254, v255
v_mfma_f32_16x16x32_bf16 v[36:39], a[76:79], a[132:135], v[36:39]
v_accvgpr_write_b32 a180, v246
v_mul_f32 v254, v24, v253
v_mfma_f32_16x16x32_bf16 v[40:43], a[80:83], a[128:131], v[40:43]
ds_read_b64_tr_b16 a[140:141], v5 offset:49152
v_lshlrev_b32 v23, 16, v229
v_mfma_f32_16x16x32_bf16 v[40:43], a[84:87], a[132:135], v[40:43]
buffer_load_dwordx4 v17, s[12:15], s27 offen offset:1024 lds
v_lshlrev_b32 v247, 16, v238
v_mfma_f32_16x16x32_bf16 v[44:47], a[88:91], a[128:131], v[44:47]
ds_read_b64_tr_b16 a[142:143], v5 offset:51200
v_fmac_f32 v254, v25, v30
v_mfma_f32_16x16x32_bf16 v[44:47], a[92:95], a[132:135], v[44:47]
v_fmac_f32 v254, v22, v29
v_fmac_f32 v254, v23, v28
v_mfma_f32_16x16x32_bf16 v[48:51], a[96:99], a[128:131], v[48:51]
ds_read_b128 a[0:3], v2 offset:0
v_mul_f32 v254, v254, v247
v_mfma_f32_16x16x32_bf16 v[48:51], a[100:103], a[132:135], v[48:51]
buffer_load_dwordx4 v18, s[12:15], s27 offen offset:2048 lds
v_mfma_f32_16x16x32_bf16 v[52:55], a[104:107], a[128:131], v[52:55]
ds_read_b128 a[4:7], v3 offset:0
v_cvt_pk_bf16_f32 v246, v255, v254
v_accvgpr_write_b32 a176, v246
v_mfma_f32_16x16x32_bf16 v[52:55], a[108:111], a[132:135], v[52:55]
v_mul_f32 v255, v25, v253
v_lshlrev_b32 v24, 16, v230
v_mfma_f32_16x16x32_bf16 v[56:59], a[112:115], a[128:131], v[56:59]
v_lshlrev_b32 v247, 16, v239
v_fmac_f32 v255, v22, v30
v_mfma_f32_16x16x32_bf16 v[56:59], a[116:119], a[132:135], v[56:59]
buffer_load_dwordx4 v19, s[12:15], s27 offen offset:3072 lds
v_mfma_f32_16x16x32_bf16 v[60:63], a[120:123], a[128:131], v[60:63]
s_add_u32 s27, s27, 524288
ds_read_b128 a[8:11], v2 offset:2048
v_fmac_f32 v255, v23, v29
v_mfma_f32_16x16x32_bf16 v[60:63], a[124:127], a[132:135], v[60:63]
s_waitcnt lgkmcnt(3)
v_fmac_f32 v255, v24, v28
v_mul_f32 v255, v255, v247
v_mfma_f32_16x16x32_bf16 v[64:67], a[64:67], a[136:139], v[64:67]
s_add_u32 m0, s28, 32768
ds_read_b64_tr_b16 a[128:129], v6 offset:32768
v_cvt_pk_bf16_f32 v246, v254, v255
v_accvgpr_write_b32 a181, v246
v_mfma_f32_16x16x32_bf16 v[64:67], a[68:71], a[140:143], v[64:67]
buffer_load_dwordx4 v12, s[8:11], s24 offen offset:0 lds
v_mfma_f32_16x16x32_bf16 v[68:71], a[72:75], a[136:139], v[68:71]
ds_read_b64_tr_b16 a[130:131], v6 offset:34816
v_mul_f32 v254, v22, v253
v_mfma_f32_16x16x32_bf16 v[68:71], a[76:79], a[140:143], v[68:71]
v_lshlrev_b32 v25, 16, v231
v_lshlrev_b32 v247, 16, v240
v_mfma_f32_16x16x32_bf16 v[72:75], a[80:83], a[136:139], v[72:75]
ds_read_b64_tr_b16 a[132:133], v6 offset:49152
v_fmac_f32 v254, v23, v30
v_mfma_f32_16x16x32_bf16 v[72:75], a[84:87], a[140:143], v[72:75]
buffer_load_dwordx4 v13, s[8:11], s24 offen offset:1024 lds
v_fmac_f32 v254, v24, v29
v_mfma_f32_16x16x32_bf16 v[76:79], a[88:91], a[136:139], v[76:79]
ds_read_b64_tr_b16 a[134:135], v6 offset:51200
v_fmac_f32 v254, v25, v28
v_mfma_f32_16x16x32_bf16 v[76:79], a[92:95], a[140:143], v[76:79]
v_mul_f32 v254, v254, v247
v_cvt_pk_bf16_f32 v246, v255, v254
v_mfma_f32_16x16x32_bf16 v[80:83], a[96:99], a[136:139], v[80:83]
ds_read_b128 a[12:15], v3 offset:2048
v_accvgpr_write_b32 a177, v246
v_mfma_f32_16x16x32_bf16 v[80:83], a[100:103], a[140:143], v[80:83]
buffer_load_dwordx4 v14, s[8:11], s24 offen offset:2048 lds
v_mfma_f32_16x16x32_bf16 v[84:87], a[104:107], a[136:139], v[84:87]
v_mul_f32 v255, v23, v253
v_lshlrev_b32 v22, 16, v232
v_lshlrev_b32 v247, 16, v241
v_mfma_f32_16x16x32_bf16 v[84:87], a[108:111], a[140:143], v[84:87]
v_fmac_f32 v255, v24, v30
v_fmac_f32 v255, v25, v29
v_mfma_f32_16x16x32_bf16 v[88:91], a[112:115], a[136:139], v[88:91]
ds_read_b128 a[16:19], v2 offset:4096
v_fmac_f32 v255, v22, v28
v_mfma_f32_16x16x32_bf16 v[88:91], a[116:119], a[140:143], v[88:91]
buffer_load_dwordx4 v15, s[8:11], s24 offen offset:3072 lds
v_mfma_f32_16x16x32_bf16 v[92:95], a[120:123], a[136:139], v[92:95]
PAD_24:
s_cbranch_execz PAD_28
s_add_u32 s24, s24, 128
ds_read_b128 a[20:23], v3 offset:4096
v_mul_f32 v255, v255, v247
v_mfma_f32_16x16x32_bf16 v[92:95], a[124:127], a[140:143], v[92:95]
s_waitcnt lgkmcnt(3)
v_cvt_pk_bf16_f32 v246, v254, v255
v_accvgpr_write_b32 a182, v246
v_mfma_f32_16x16x32_bf16 v[96:99], a[64:67], a[128:131], v[96:99]
s_add_u32 m0, s28, 36864
ds_read_b64_tr_b16 a[136:137], v7 offset:32768
v_mul_f32 v254, v24, v253
v_lshlrev_b32 v23, 16, v233
v_mfma_f32_16x16x32_bf16 v[96:99], a[68:71], a[132:135], v[96:99]
buffer_load_dwordx4 v12, s[8:11], s25 offen offset:0 lds
v_mfma_f32_16x16x32_bf16 v[100:103], a[72:75], a[128:131], v[100:103]
ds_read_b64_tr_b16 a[138:139], v7 offset:34816
v_lshlrev_b32 v247, 16, v242
v_mfma_f32_16x16x32_bf16 v[100:103], a[76:79], a[132:135], v[100:103]
v_fmac_f32 v254, v25, v30
v_fmac_f32 v254, v22, v29
v_mfma_f32_16x16x32_bf16 v[104:107], a[80:83], a[128:131], v[104:107]
ds_read_b64_tr_b16 a[140:141], v7 offset:49152
v_fmac_f32 v254, v23, v28
v_mfma_f32_16x16x32_bf16 v[104:107], a[84:87], a[132:135], v[104:107]
buffer_load_dwordx4 v13, s[8:11], s25 offen offset:1024 lds
v_mul_f32 v254, v254, v247
v_mfma_f32_16x16x32_bf16 v[108:111], a[88:91], a[128:131], v[108:111]
ds_read_b64_tr_b16 a[142:143], v7 offset:51200
v_cvt_pk_bf16_f32 v246, v255, v254
v_mfma_f32_16x16x32_bf16 v[108:111], a[92:95], a[132:135], v[108:111]
v_accvgpr_write_b32 a178, v246
v_mul_f32 v255, v25, v253
v_mfma_f32_16x16x32_bf16 v[112:115], a[96:99], a[128:131], v[112:115]
v_lshlrev_b32 v24, 16, v234
v_lshlrev_b32 v247, 16, v243
v_mfma_f32_16x16x32_bf16 v[112:115], a[100:103], a[132:135], v[112:115]
buffer_load_dwordx4 v14, s[8:11], s25 offen offset:2048 lds
v_mfma_f32_16x16x32_bf16 v[116:119], a[104:107], a[128:131], v[116:119]
ds_read_b128 a[24:27], v2 offset:6144
v_fmac_f32 v255, v22, v30
v_fmac_f32 v255, v23, v29
v_mfma_f32_16x16x32_bf16 v[116:119], a[108:111], a[132:135], v[116:119]
v_fmac_f32 v255, v24, v28
v_mul_f32 v255, v255, v247
v_mfma_f32_16x16x32_bf16 v[120:123], a[112:115], a[128:131], v[120:123]
ds_read_b128 a[28:31], v3 offset:6144
v_cvt_pk_bf16_f32 v246, v254, v255
v_mfma_f32_16x16x32_bf16 v[120:123], a[116:119], a[132:135], v[120:123]
buffer_load_dwordx4 v15, s[8:11], s25 offen offset:3072 lds
v_mfma_f32_16x16x32_bf16 v[124:127], a[120:123], a[128:131], v[124:127]
s_add_u32 s25, s25, 128
v_accvgpr_write_b32 a183, v246
v_mul_f32 v254, v22, v253
v_mfma_f32_16x16x32_bf16 v[124:127], a[124:127], a[132:135], v[124:127]
s_waitcnt lgkmcnt(2)
v_lshlrev_b32 v25, 16, v235
v_lshlrev_b32 v247, 16, v244
v_mfma_f32_16x16x32_bf16 v[128:131], a[64:67], a[136:139], v[128:131]
ds_read_b64_tr_b16 a[128:129], v8 offset:32768
v_fmac_f32 v254, v23, v30
v_fmac_f32 v254, v24, v29
v_mfma_f32_16x16x32_bf16 v[128:131], a[68:71], a[140:143], v[128:131]
buffer_load_dword v21, v20, s[16:19], s43 offen
v_mfma_f32_16x16x32_bf16 v[132:135], a[72:75], a[136:139], v[132:135]
s_add_u32 s43, s43, s47
ds_read_b64_tr_b16 a[130:131], v8 offset:34816
v_fmac_f32 v254, v25, v28
v_mfma_f32_16x16x32_bf16 v[132:135], a[76:79], a[140:143], v[132:135]
s_cmp_ge_u32 s43, s51
v_mul_f32 v254, v254, v247
v_cvt_pk_bf16_f32 v246, v255, v254
v_mfma_f32_16x16x32_bf16 v[136:139], a[80:83], a[136:139], v[136:139]
s_cselect_b32 s43, 0, s43
ds_read_b64_tr_b16 a[132:133], v8 offset:49152
v_accvgpr_write_b32 a179, v246
v_mfma_f32_16x16x32_bf16 v[136:139], a[84:87], a[140:143], v[136:139]
s_cselect_b32 s51, s42, s51
v_lshlrev_b32 v28, 16, v250
v_and_b32 v29, s58, v250
v_lshlrev_b32 v30, 16, v251
v_mfma_f32_16x16x32_bf16 v[140:143], a[88:91], a[136:139], v[140:143]
s_cselect_b64 s[16:17], s[40:41], s[16:17]
ds_read_b64_tr_b16 a[134:135], v8 offset:51200
v_and_b32 v253, s58, v251
v_mfma_f32_16x16x32_bf16 v[140:143], a[92:95], a[140:143], v[140:143]
s_cselect_b32 s18, s42, s18
v_and_b32 v22, s58, v224
v_and_b32 v23, s58, v225
v_mfma_f32_16x16x32_bf16 v[144:147], a[96:99], a[136:139], v[144:147]
s_cselect_b64 s[40:41], s[44:45], s[40:41]
ds_read_b128 a[32:35], v2 offset:8192
v_and_b32 v24, s58, v226
v_mfma_f32_16x16x32_bf16 v[144:147], a[100:103], a[140:143], v[144:147]
s_cselect_b32 s42, s46, s42
v_mul_f32 v254, v22, v253
v_and_b32 v25, s58, v227
v_mfma_f32_16x16x32_bf16 v[148:151], a[104:107], a[136:139], v[148:151]
s_cselect_b32 s46, 0, s46
v_and_b32 v247, s58, v236
v_fmac_f32 v254, v23, v30
v_mfma_f32_16x16x32_bf16 v[148:151], a[108:111], a[140:143], v[148:151]
buffer_load_dword v245, off, s[60:63], 0 sc1
v_fmac_f32 v254, v24, v29
v_mfma_f32_16x16x32_bf16 v[152:155], a[112:115], a[136:139], v[152:155]
ds_read_b128 a[36:39], v3 offset:8192
v_fmac_f32 v254, v25, v28
v_mfma_f32_16x16x32_bf16 v[152:155], a[116:119], a[140:143], v[152:155]
v_mul_f32 v254, v254, v247
v_mul_f32 v255, v23, v253
v_mfma_f32_16x16x32_bf16 v[156:159], a[120:123], a[136:139], v[156:159]
ds_read_b128 a[40:43], v2 offset:10240
v_and_b32 v22, s58, v228
v_mfma_f32_16x16x32_bf16 v[156:159], a[124:127], a[140:143], v[156:159]
s_waitcnt lgkmcnt(3)
v_and_b32 v247, s58, v237
v_fmac_f32 v255, v24, v30
v_mfma_f32_16x16x32_bf16 v[160:163], a[64:67], a[128:131], v[160:163]
ds_read_b64_tr_b16 a[136:137], v9 offset:32768
v_fmac_f32 v255, v25, v29
v_fmac_f32 v255, v22, v28
v_mfma_f32_16x16x32_bf16 v[160:163], a[68:71], a[132:135], v[160:163]
v_mul_f32 v255, v255, v247
v_cvt_pk_bf16_f32 v246, v254, v255
v_mfma_f32_16x16x32_bf16 v[164:167], a[72:75], a[128:131], v[164:167]
ds_read_b64_tr_b16 a[138:139], v9 offset:34816
v_accvgpr_write_b32 a188, v246
v_mfma_f32_16x16x32_bf16 v[164:167], a[76:79], a[132:135], v[164:167]
v_mul_f32 v254, v24, v253
v_and_b32 v23, s58, v229
v_mfma_f32_16x16x32_bf16 v[168:171], a[80:83], a[128:131], v[168:171]
ds_read_b64_tr_b16 a[140:141], v9 offset:49152
v_and_b32 v247, s58, v238
v_mfma_f32_16x16x32_bf16 v[168:171], a[84:87], a[132:135], v[168:171]
v_fmac_f32 v254, v25, v30
v_fmac_f32 v254, v22, v29
v_fmac_f32 v254, v23, v28
v_mfma_f32_16x16x32_bf16 v[172:175], a[88:91], a[128:131], v[172:175]
ds_read_b64_tr_b16 a[142:143], v9 offset:51200
v_mul_f32 v254, v254, v247
v_mfma_f32_16x16x32_bf16 v[172:175], a[92:95], a[132:135], v[172:175]
v_cvt_pk_bf16_f32 v246, v255, v254
v_accvgpr_write_b32 a184, v246
v_mfma_f32_16x16x32_bf16 v[176:179], a[96:99], a[128:131], v[176:179]
v_mul_f32 v255, v25, v253
v_and_b32 v24, s58, v230
v_mfma_f32_16x16x32_bf16 v[176:179], a[100:103], a[132:135], v[176:179]
v_and_b32 v247, s58, v239
v_fmac_f32 v255, v22, v30
v_mfma_f32_16x16x32_bf16 v[180:183], a[104:107], a[128:131], v[180:183]
ds_read_b128 a[44:47], v3 offset:10240
v_fmac_f32 v255, v23, v29
v_mfma_f32_16x16x32_bf16 v[180:183], a[108:111], a[132:135], v[180:183]
v_fmac_f32 v255, v24, v28
v_mul_f32 v255, v255, v247
v_cvt_pk_bf16_f32 v246, v254, v255
v_mfma_f32_16x16x32_bf16 v[184:187], a[112:115], a[128:131], v[184:187]
ds_read_b128 a[48:51], v2 offset:12288
v_accvgpr_write_b32 a189, v246
v_mfma_f32_16x16x32_bf16 v[184:187], a[116:119], a[132:135], v[184:187]
v_mul_f32 v254, v22, v253
v_and_b32 v25, s58, v231
v_mfma_f32_16x16x32_bf16 v[188:191], a[120:123], a[128:131], v[188:191]
v_and_b32 v247, s58, v240
v_fmac_f32 v254, v23, v30
v_mfma_f32_16x16x32_bf16 v[188:191], a[124:127], a[132:135], v[188:191]
s_waitcnt lgkmcnt(2)
v_fmac_f32 v254, v24, v29
v_fmac_f32 v254, v25, v28
v_mfma_f32_16x16x32_bf16 v[192:195], a[64:67], a[136:139], v[192:195]
ds_read_b64_tr_b16 a[128:129], v10 offset:32768
v_mul_f32 v254, v254, v247
v_cvt_pk_bf16_f32 v246, v255, v254
v_mfma_f32_16x16x32_bf16 v[192:195], a[68:71], a[140:143], v[192:195]
v_accvgpr_write_b32 a185, v246
v_mul_f32 v255, v23, v253
v_mfma_f32_16x16x32_bf16 v[196:199], a[72:75], a[136:139], v[196:199]
ds_read_b64_tr_b16 a[130:131], v10 offset:34816
v_and_b32 v22, s58, v232
v_mfma_f32_16x16x32_bf16 v[196:199], a[76:79], a[140:143], v[196:199]
v_and_b32 v247, s58, v241
v_fmac_f32 v255, v24, v30
v_mfma_f32_16x16x32_bf16 v[200:203], a[80:83], a[136:139], v[200:203]
s_lshr_b32 s22, s3, 1
ds_read_b64_tr_b16 a[132:133], v10 offset:49152
v_fmac_f32 v255, v25, v29
v_mfma_f32_16x16x32_bf16 v[200:203], a[84:87], a[140:143], v[200:203]
s_mul_i32 s22, s22, 2097152
v_fmac_f32 v255, v22, v28
v_mul_f32 v255, v255, v247
v_cvt_pk_bf16_f32 v246, v254, v255
v_mfma_f32_16x16x32_bf16 v[204:207], a[88:91], a[136:139], v[204:207]
s_and_b32 s23, s3, 1
ds_read_b64_tr_b16 a[134:135], v10 offset:51200
v_accvgpr_write_b32 a190, v246
v_mfma_f32_16x16x32_bf16 v[204:207], a[92:95], a[140:143], v[204:207]
s_lshl_b32 s23, s23, 5
v_mul_f32 v254, v24, v253
v_and_b32 v23, s58, v233
v_mfma_f32_16x16x32_bf16 v[208:211], a[96:99], a[136:139], v[208:211]
s_lshl_b32 s56, s39, 6
ds_read_b128 a[52:55], v3 offset:12288
v_and_b32 v247, s58, v242
v_mfma_f32_16x16x32_bf16 v[208:211], a[100:103], a[140:143], v[208:211]
s_add_u32 s23, s23, s56
v_fmac_f32 v254, v25, v30
v_fmac_f32 v254, v22, v29
v_mfma_f32_16x16x32_bf16 v[212:215], a[104:107], a[136:139], v[212:215]
s_mul_i32 s23, s23, 4224
ds_read_b128 a[56:59], v2 offset:14336
v_fmac_f32 v254, v23, v28
v_mfma_f32_16x16x32_bf16 v[212:215], a[108:111], a[140:143], v[212:215]
s_add_u32 s22, s22, s23
v_mul_f32 v254, v254, v247
v_cvt_pk_bf16_f32 v246, v255, v254
v_accvgpr_write_b32 a186, v246
v_mfma_f32_16x16x32_bf16 v[216:219], a[112:115], a[136:139], v[216:219]
s_add_u32 s57, s22, 83886200
v_mul_f32 v255, v25, v253
v_and_b32 v24, s58, v234
v_mfma_f32_16x16x32_bf16 v[216:219], a[116:119], a[140:143], v[216:219]
s_lshl_b32 s23, s38, 7
v_and_b32 v247, s58, v243
v_fmac_f32 v255, v22, v30
v_mfma_f32_16x16x32_bf16 v[220:223], a[120:123], a[136:139], v[220:223]
s_add_u32 s22, s22, s23
ds_read_b128 a[60:63], v3 offset:14336
v_fmac_f32 v255, v23, v29
v_mfma_f32_16x16x32_bf16 v[220:223], a[124:127], a[140:143], v[220:223]
s_waitcnt lgkmcnt(3)
s_add_u32 s56, s22, 83886208
v_fmac_f32 v255, v24, v28
v_mul_f32 v255, v255, v247
v_mfma_f32_16x16x32_bf16 a[192:195], a[64:67], a[128:131], a[192:195]
s_cmp_lt_u32 s2, 224
ds_read_b64_tr_b16 a[136:137], v11 offset:32768
v_cvt_pk_bf16_f32 v246, v254, v255
v_accvgpr_write_b32 a191, v246
v_mfma_f32_16x16x32_bf16 a[192:195], a[68:71], a[132:135], a[192:195]
s_cselect_b32 s56, s56, 3221225472
v_mul_f32 v254, v22, v253
v_and_b32 v25, s58, v235
v_mfma_f32_16x16x32_bf16 a[196:199], a[72:75], a[128:131], a[196:199]
s_cmp_eq_u32 s38, 0
ds_read_b64_tr_b16 a[138:139], v11 offset:34816
v_and_b32 v247, s58, v244
v_mfma_f32_16x16x32_bf16 a[196:199], a[76:79], a[132:135], a[196:199]
s_cselect_b32 s57, s57, 3221225472
v_fmac_f32 v254, v23, v30
v_fmac_f32 v254, v24, v29
v_mfma_f32_16x16x32_bf16 a[200:203], a[80:83], a[128:131], a[200:203]
ds_read_b64_tr_b16 a[140:141], v11 offset:49152
v_fmac_f32 v254, v25, v28
v_mfma_f32_16x16x32_bf16 a[200:203], a[84:87], a[132:135], a[200:203]
v_mul_f32 v254, v254, v247
v_cvt_pk_bf16_f32 v246, v255, v254
v_accvgpr_write_b32 a187, v246
v_mfma_f32_16x16x32_bf16 a[204:207], a[88:91], a[128:131], a[204:207]
ds_read_b64_tr_b16 a[142:143], v11 offset:51200
v_mfma_f32_16x16x32_bf16 a[204:207], a[92:95], a[132:135], a[204:207]
ds_write_b128 v252, a[176:179] offset:0
v_mfma_f32_16x16x32_bf16 a[208:211], a[96:99], a[128:131], a[208:211]
v_mfma_f32_16x16x32_bf16 a[208:211], a[100:103], a[132:135], a[208:211]
ds_write_b128 v252, a[180:183] offset:8192
v_mfma_f32_16x16x32_bf16 a[212:215], a[104:107], a[128:131], a[212:215]
v_mfma_f32_16x16x32_bf16 a[212:215], a[108:111], a[132:135], a[212:215]
ds_write_b128 v252, a[184:187] offset:128
v_mfma_f32_16x16x32_bf16 a[216:219], a[112:115], a[128:131], a[216:219]
v_mfma_f32_16x16x32_bf16 a[216:219], a[116:119], a[132:135], a[216:219]
ds_write_b128 v252, a[188:191] offset:8320
v_mfma_f32_16x16x32_bf16 a[220:223], a[120:123], a[128:131], a[220:223]
s_waitcnt vmcnt(2) lgkmcnt(0)
v_mfma_f32_16x16x32_bf16 a[220:223], a[124:127], a[132:135], a[220:223]
s_barrier
v_mfma_f32_16x16x32_bf16 a[224:227], a[64:67], a[136:139], a[224:227]
s_add_u32 m0, s29, 98304
ds_read_b64_tr_b16 a[128:129], v4 offset:0
v_lshrrev_b32 v22, 8, v1
v_mfma_f32_16x16x32_bf16 a[224:227], a[68:71], a[140:143], a[224:227]
buffer_load_dwordx4 v16, s[12:15], s26 offen offset:0 lds
v_mfma_f32_16x16x32_bf16 a[228:231], a[72:75], a[136:139], a[228:231]
ds_read_b64_tr_b16 a[130:131], v4 offset:2048
v_lshlrev_b32 v22, 4, v22
v_mfma_f32_16x16x32_bf16 a[228:231], a[76:79], a[140:143], a[228:231]
v_xor_b32 v22, v22, v1
v_add_u32 v22, s29, v22
v_mfma_f32_16x16x32_bf16 a[232:235], a[80:83], a[136:139], a[232:235]
ds_read_b64_tr_b16 a[132:133], v4 offset:16384
v_add_u32 v22, 147456, v22
v_mfma_f32_16x16x32_bf16 a[232:235], a[84:87], a[140:143], a[232:235]
buffer_load_dwordx4 v17, s[12:15], s26 offen offset:1024 lds
v_mfma_f32_16x16x32_bf16 a[236:239], a[88:91], a[136:139], a[236:239]
ds_read_b64_tr_b16 a[134:135], v4 offset:18432
v_xor_b32 v23, 64, v22
v_mfma_f32_16x16x32_bf16 a[236:239], a[92:95], a[140:143], a[236:239]
v_lshrrev_b32 v224, 7, v1
v_mul_u32_u24 v224, 4224, v224
v_mfma_f32_16x16x32_bf16 a[240:243], a[96:99], a[136:139], a[240:243]
v_and_b32 v225, 0x70, v1
v_add_u32 v224, v224, v225
v_mfma_f32_16x16x32_bf16 a[240:243], a[100:103], a[140:143], a[240:243]
buffer_load_dwordx4 v18, s[12:15], s26 offen offset:2048 lds
v_mfma_f32_16x16x32_bf16 a[244:247], a[104:107], a[136:139], a[244:247]
v_bfe_u32 v225, v1, 4, 5
v_mul_u32_u24 v225, 4224, v225
v_mfma_f32_16x16x32_bf16 a[244:247], a[108:111], a[140:143], a[244:247]
v_mov_b32 v226, 0
v_mov_b32 v227, 0
v_mfma_f32_16x16x32_bf16 a[248:251], a[112:115], a[136:139], a[248:251]
v_mfma_f32_16x16x32_bf16 a[248:251], a[116:119], a[140:143], a[248:251]
buffer_load_dwordx4 v19, s[12:15], s26 offen offset:3072 lds
v_mfma_f32_16x16x32_bf16 a[252:255], a[120:123], a[136:139], a[252:255]
s_add_u32 s26, s26, 524288
v_mfma_f32_16x16x32_bf16 a[252:255], a[124:127], a[140:143], a[252:255]
s_waitcnt lgkmcnt(0)
v_mfma_f32_16x16x32_bf16 v[32:35], a[0:3], a[128:131], v[32:35]
s_add_u32 m0, s29, 114688
ds_read_b64_tr_b16 a[136:137], v5 offset:0
v_mfma_f32_16x16x32_bf16 v[32:35], a[4:7], a[132:135], v[32:35]
buffer_load_dwordx4 v16, s[12:15], s27 offen offset:0 lds
v_mfma_f32_16x16x32_bf16 v[36:39], a[8:11], a[128:131], v[36:39]
s_mul_i32 s52, s20, 7
ds_read_b64_tr_b16 a[138:139], v5 offset:2048
v_mfma_f32_16x16x32_bf16 v[36:39], a[12:15], a[132:135], v[36:39]
s_add_u32 s52, s52, s21
buffer_store_dwordx2 v[226:227], v225, s[4:7], s57 offen sc1
v_mfma_f32_16x16x32_bf16 v[40:43], a[16:19], a[128:131], v[40:43]
s_lshl_b32 s53, s52, 2
ds_read_b64_tr_b16 a[140:141], v5 offset:16384
v_mfma_f32_16x16x32_bf16 v[40:43], a[20:23], a[132:135], v[40:43]
s_add_u32 s53, s53, s3
buffer_load_dwordx4 v17, s[12:15], s27 offen offset:1024 lds
v_mfma_f32_16x16x32_bf16 v[44:47], a[24:27], a[128:131], v[44:47]
s_lshl_b32 s49, s53, 12
ds_read_b64_tr_b16 a[142:143], v5 offset:18432
v_mfma_f32_16x16x32_bf16 v[44:47], a[28:31], a[132:135], v[44:47]
s_mul_i32 s53, s53, 4224
v_mfma_f32_16x16x32_bf16 v[48:51], a[32:35], a[128:131], v[48:51]
s_add_u32 s53, s53, 83886080
ds_read_b128 a[64:67], v2 offset:32768
v_mfma_f32_16x16x32_bf16 v[48:51], a[36:39], a[132:135], v[48:51]
s_lshr_b32 s52, s52, 4
buffer_load_dwordx4 v18, s[12:15], s27 offen offset:2048 lds
v_mfma_f32_16x16x32_bf16 v[52:55], a[40:43], a[128:131], v[52:55]
s_min_u32 s52, s52, 6
ds_read_b128 a[68:71], v3 offset:32768
v_mfma_f32_16x16x32_bf16 v[52:55], a[44:47], a[132:135], v[52:55]
s_lshl_b32 s52, s52, 7
ds_read_b128 a[176:179], v22 offset:0
v_mfma_f32_16x16x32_bf16 v[56:59], a[48:51], a[128:131], v[56:59]
s_add_u32 s52, s52, 94392320
ds_read_b128 a[180:183], v23 offset:1024
v_mfma_f32_16x16x32_bf16 v[56:59], a[52:55], a[132:135], v[56:59]
buffer_load_dwordx4 v19, s[12:15], s27 offen offset:3072 lds
v_mfma_f32_16x16x32_bf16 v[60:63], a[56:59], a[128:131], v[60:63]
s_add_u32 s27, s27, 524288
ds_read_b128 a[72:75], v2 offset:34816
v_mfma_f32_16x16x32_bf16 v[60:63], a[60:63], a[132:135], v[60:63]
s_waitcnt lgkmcnt(5)
ds_read_b128 a[184:187], v22 offset:2048
v_mfma_f32_16x16x32_bf16 v[64:67], a[0:3], a[136:139], v[64:67]
s_add_u32 m0, s28, 0
ds_read_b64_tr_b16 a[128:129], v6 offset:0
v_mfma_f32_16x16x32_bf16 v[64:67], a[4:7], a[140:143], v[64:67]
buffer_load_dwordx4 v12, s[8:11], s24 offen offset:0 lds
v_mfma_f32_16x16x32_bf16 v[68:71], a[8:11], a[136:139], v[68:71]
ds_read_b64_tr_b16 a[130:131], v6 offset:2048
v_mfma_f32_16x16x32_bf16 v[68:71], a[12:15], a[140:143], v[68:71]
ds_read_b128 a[188:191], v23 offset:3072
v_mfma_f32_16x16x32_bf16 v[72:75], a[16:19], a[136:139], v[72:75]
ds_read_b64_tr_b16 a[132:133], v6 offset:16384
v_bfe_u32 v231, v1, 4, 5
v_mfma_f32_16x16x32_bf16 v[72:75], a[20:23], a[140:143], v[72:75]
buffer_load_dwordx4 v13, s[8:11], s24 offen offset:1024 lds
v_mfma_f32_16x16x32_bf16 v[76:79], a[24:27], a[136:139], v[76:79]
ds_read_b64_tr_b16 a[134:135], v6 offset:18432
v_lshlrev_b32 v231, 2, v231
v_mfma_f32_16x16x32_bf16 v[76:79], a[28:31], a[140:143], v[76:79]
v_lshlrev_b32 v229, 3, v1
v_min_u32 v229, 4096, v229
v_mfma_f32_16x16x32_bf16 v[80:83], a[32:35], a[136:139], v[80:83]
ds_read_b128 a[76:79], v3 offset:34816
v_mfma_f32_16x16x32_bf16 v[80:83], a[36:39], a[140:143], v[80:83]
buffer_load_dwordx4 v14, s[8:11], s24 offen offset:2048 lds
v_mfma_f32_16x16x32_bf16 v[84:87], a[40:43], a[136:139], v[84:87]
v_mfma_f32_16x16x32_bf16 v[84:87], a[44:47], a[140:143], v[84:87]
v_mfma_f32_16x16x32_bf16 v[88:91], a[48:51], a[136:139], v[88:91]
ds_read_b128 a[80:83], v2 offset:36864
v_mfma_f32_16x16x32_bf16 v[88:91], a[52:55], a[140:143], v[88:91]
buffer_load_dwordx4 v15, s[8:11], s24 offen offset:3072 lds
v_mfma_f32_16x16x32_bf16 v[92:95], a[56:59], a[136:139], v[92:95]
s_add_u32 s24, s24, 128
ds_read_b128 a[84:87], v3 offset:36864
v_mfma_f32_16x16x32_bf16 v[92:95], a[60:63], a[140:143], v[92:95]
s_waitcnt lgkmcnt(3)
v_mfma_f32_16x16x32_bf16 v[96:99], a[0:3], a[128:131], v[96:99]
s_add_u32 m0, s28, 4096
ds_read_b64_tr_b16 a[136:137], v7 offset:0
v_mfma_f32_16x16x32_bf16 v[96:99], a[4:7], a[132:135], v[96:99]
buffer_load_dwordx4 v12, s[8:11], s25 offen offset:0 lds
v_mfma_f32_16x16x32_bf16 v[100:103], a[8:11], a[128:131], v[100:103]
ds_read_b64_tr_b16 a[138:139], v7 offset:2048
v_mfma_f32_16x16x32_bf16 v[100:103], a[12:15], a[132:135], v[100:103]
v_mfma_f32_16x16x32_bf16 v[104:107], a[16:19], a[128:131], v[104:107]
ds_read_b64_tr_b16 a[140:141], v7 offset:16384
v_mfma_f32_16x16x32_bf16 v[104:107], a[20:23], a[132:135], v[104:107]
buffer_load_dwordx4 v13, s[8:11], s25 offen offset:1024 lds
v_mfma_f32_16x16x32_bf16 v[108:111], a[24:27], a[128:131], v[108:111]
ds_read_b64_tr_b16 a[142:143], v7 offset:18432
v_mfma_f32_16x16x32_bf16 v[108:111], a[28:31], a[132:135], v[108:111]
v_mfma_f32_16x16x32_bf16 v[112:115], a[32:35], a[128:131], v[112:115]
v_mfma_f32_16x16x32_bf16 v[112:115], a[36:39], a[132:135], v[112:115]
buffer_load_dwordx4 v14, s[8:11], s25 offen offset:2048 lds
v_mfma_f32_16x16x32_bf16 v[116:119], a[40:43], a[128:131], v[116:119]
ds_read_b128 a[88:91], v2 offset:38912
v_mfma_f32_16x16x32_bf16 v[116:119], a[44:47], a[132:135], v[116:119]
v_mfma_f32_16x16x32_bf16 v[120:123], a[48:51], a[128:131], v[120:123]
ds_read_b128 a[92:95], v3 offset:38912
v_mfma_f32_16x16x32_bf16 v[120:123], a[52:55], a[132:135], v[120:123]
buffer_load_dwordx4 v15, s[8:11], s25 offen offset:3072 lds
v_mfma_f32_16x16x32_bf16 v[124:127], a[56:59], a[128:131], v[124:127]
s_add_u32 s25, s25, 128
v_mfma_f32_16x16x32_bf16 v[124:127], a[60:63], a[132:135], v[124:127]
s_waitcnt lgkmcnt(2)
v_mfma_f32_16x16x32_bf16 v[128:131], a[0:3], a[136:139], v[128:131]
ds_read_b64_tr_b16 a[128:129], v8 offset:0
v_mfma_f32_16x16x32_bf16 v[128:131], a[4:7], a[140:143], v[128:131]
buffer_store_dwordx4 a[176:179], v224, s[4:7], s56 offen sc1
v_mfma_f32_16x16x32_bf16 v[132:135], a[8:11], a[136:139], v[132:135]
s_add_u32 s56, s56, 33792
ds_read_b64_tr_b16 a[130:131], v8 offset:2048
v_mfma_f32_16x16x32_bf16 v[132:135], a[12:15], a[140:143], v[132:135]
v_mfma_f32_16x16x32_bf16 v[136:139], a[16:19], a[136:139], v[136:139]
ds_read_b64_tr_b16 a[132:133], v8 offset:16384
v_mfma_f32_16x16x32_bf16 v[136:139], a[20:23], a[140:143], v[136:139]
v_mfma_f32_16x16x32_bf16 v[140:143], a[24:27], a[136:139], v[140:143]
s_cmp_lt_u32 s21, 7
ds_read_b64_tr_b16 a[134:135], v8 offset:18432
v_mfma_f32_16x16x32_bf16 v[140:143], a[28:31], a[140:143], v[140:143]
s_cselect_b32 s53, s53, 3221225472
v_mfma_f32_16x16x32_bf16 v[144:147], a[32:35], a[136:139], v[144:147]
s_cselect_b32 s49, s49, 3221225472
ds_read_b128 a[96:99], v2 offset:40960
v_mfma_f32_16x16x32_bf16 v[144:147], a[36:39], a[140:143], v[144:147]
s_add_u32 s48, s53, 2097152
v_mfma_f32_16x16x32_bf16 v[148:151], a[40:43], a[136:139], v[148:151]
v_mfma_f32_16x16x32_bf16 v[148:151], a[44:47], a[140:143], v[148:151]
v_mfma_f32_16x16x32_bf16 v[152:155], a[48:51], a[136:139], v[152:155]
ds_read_b128 a[100:103], v3 offset:40960
v_mfma_f32_16x16x32_bf16 v[152:155], a[52:55], a[140:143], v[152:155]
v_mfma_f32_16x16x32_bf16 v[156:159], a[56:59], a[136:139], v[156:159]
ds_read_b128 a[104:107], v2 offset:43008
v_mfma_f32_16x16x32_bf16 v[156:159], a[60:63], a[140:143], v[156:159]
s_waitcnt lgkmcnt(3)
v_mfma_f32_16x16x32_bf16 v[160:163], a[0:3], a[128:131], v[160:163]
ds_read_b64_tr_b16 a[136:137], v9 offset:0
v_mfma_f32_16x16x32_bf16 v[160:163], a[4:7], a[132:135], v[160:163]
v_mfma_f32_16x16x32_bf16 v[164:167], a[8:11], a[128:131], v[164:167]
ds_read_b64_tr_b16 a[138:139], v9 offset:2048
v_mfma_f32_16x16x32_bf16 v[164:167], a[12:15], a[132:135], v[164:167]
buffer_store_dwordx4 a[180:183], v224, s[4:7], s56 offen sc1
v_mfma_f32_16x16x32_bf16 v[168:171], a[16:19], a[128:131], v[168:171]
s_add_u32 s56, s56, 33792
ds_read_b64_tr_b16 a[140:141], v9 offset:16384
v_mfma_f32_16x16x32_bf16 v[168:171], a[20:23], a[132:135], v[168:171]
v_mfma_f32_16x16x32_bf16 v[172:175], a[24:27], a[128:131], v[172:175]
ds_read_b64_tr_b16 a[142:143], v9 offset:18432
v_mfma_f32_16x16x32_bf16 v[172:175], a[28:31], a[132:135], v[172:175]
v_mfma_f32_16x16x32_bf16 v[176:179], a[32:35], a[128:131], v[176:179]
v_mfma_f32_16x16x32_bf16 v[176:179], a[36:39], a[132:135], v[176:179]
v_mfma_f32_16x16x32_bf16 v[180:183], a[40:43], a[128:131], v[180:183]
ds_read_b128 a[108:111], v3 offset:43008
v_mfma_f32_16x16x32_bf16 v[180:183], a[44:47], a[132:135], v[180:183]
v_mfma_f32_16x16x32_bf16 v[184:187], a[48:51], a[128:131], v[184:187]
ds_read_b128 a[112:115], v2 offset:45056
v_mfma_f32_16x16x32_bf16 v[184:187], a[52:55], a[132:135], v[184:187]
v_mfma_f32_16x16x32_bf16 v[188:191], a[56:59], a[128:131], v[188:191]
v_mfma_f32_16x16x32_bf16 v[188:191], a[60:63], a[132:135], v[188:191]
s_waitcnt lgkmcnt(2)
v_mfma_f32_16x16x32_bf16 v[192:195], a[0:3], a[136:139], v[192:195]
ds_read_b64_tr_b16 a[128:129], v10 offset:0
v_mfma_f32_16x16x32_bf16 v[192:195], a[4:7], a[140:143], v[192:195]
v_mfma_f32_16x16x32_bf16 v[196:199], a[8:11], a[136:139], v[196:199]
ds_read_b64_tr_b16 a[130:131], v10 offset:2048
v_mfma_f32_16x16x32_bf16 v[196:199], a[12:15], a[140:143], v[196:199]
v_mfma_f32_16x16x32_bf16 v[200:203], a[16:19], a[136:139], v[200:203]
ds_read_b64_tr_b16 a[132:133], v10 offset:16384
v_mfma_f32_16x16x32_bf16 v[200:203], a[20:23], a[140:143], v[200:203]
buffer_store_dwordx4 a[184:187], v224, s[4:7], s56 offen sc1
v_mfma_f32_16x16x32_bf16 v[204:207], a[24:27], a[136:139], v[204:207]
s_add_u32 s56, s56, 33792
ds_read_b64_tr_b16 a[134:135], v10 offset:18432
v_mfma_f32_16x16x32_bf16 v[204:207], a[28:31], a[140:143], v[204:207]
v_mfma_f32_16x16x32_bf16 v[208:211], a[32:35], a[136:139], v[208:211]
ds_read_b128 a[116:119], v3 offset:45056
v_mfma_f32_16x16x32_bf16 v[208:211], a[36:39], a[140:143], v[208:211]
v_mfma_f32_16x16x32_bf16 v[212:215], a[40:43], a[136:139], v[212:215]
ds_read_b128 a[120:123], v2 offset:47104
v_mfma_f32_16x16x32_bf16 v[212:215], a[44:47], a[140:143], v[212:215]
v_mfma_f32_16x16x32_bf16 v[216:219], a[48:51], a[136:139], v[216:219]
v_mfma_f32_16x16x32_bf16 v[216:219], a[52:55], a[140:143], v[216:219]
v_mfma_f32_16x16x32_bf16 v[220:223], a[56:59], a[136:139], v[220:223]
ds_read_b128 a[124:127], v3 offset:47104
v_mfma_f32_16x16x32_bf16 v[220:223], a[60:63], a[140:143], v[220:223]
s_waitcnt lgkmcnt(3)
v_mfma_f32_16x16x32_bf16 a[192:195], a[0:3], a[128:131], a[192:195]
ds_read_b64_tr_b16 a[136:137], v11 offset:0
v_mfma_f32_16x16x32_bf16 a[192:195], a[4:7], a[132:135], a[192:195]
v_mfma_f32_16x16x32_bf16 a[196:199], a[8:11], a[128:131], a[196:199]
ds_read_b64_tr_b16 a[138:139], v11 offset:2048
v_mfma_f32_16x16x32_bf16 a[196:199], a[12:15], a[132:135], a[196:199]
v_mfma_f32_16x16x32_bf16 a[200:203], a[16:19], a[128:131], a[200:203]
ds_read_b64_tr_b16 a[140:141], v11 offset:16384
v_mfma_f32_16x16x32_bf16 a[200:203], a[20:23], a[132:135], a[200:203]
v_mfma_f32_16x16x32_bf16 a[204:207], a[24:27], a[128:131], a[204:207]
ds_read_b64_tr_b16 a[142:143], v11 offset:18432
v_mfma_f32_16x16x32_bf16 a[204:207], a[28:31], a[132:135], a[204:207]
buffer_store_dwordx4 a[188:191], v224, s[4:7], s56 offen sc1
v_mfma_f32_16x16x32_bf16 a[208:211], a[32:35], a[128:131], a[208:211]
s_add_u32 s56, s56, 33792
v_mfma_f32_16x16x32_bf16 a[208:211], a[36:39], a[132:135], a[208:211]
v_mfma_f32_16x16x32_bf16 a[212:215], a[40:43], a[128:131], a[212:215]
v_mfma_f32_16x16x32_bf16 a[212:215], a[44:47], a[132:135], a[212:215]
v_mfma_f32_16x16x32_bf16 a[216:219], a[48:51], a[128:131], a[216:219]
v_mfma_f32_16x16x32_bf16 a[216:219], a[52:55], a[132:135], a[216:219]
v_mfma_f32_16x16x32_bf16 a[220:223], a[56:59], a[128:131], a[220:223]
s_waitcnt vmcnt(4) lgkmcnt(0)
v_mfma_f32_16x16x32_bf16 a[220:223], a[60:63], a[132:135], a[220:223]
s_barrier
v_mfma_f32_16x16x32_bf16 a[224:227], a[0:3], a[136:139], a[224:227]
s_add_u32 m0, s29, 65536
ds_read_b64_tr_b16 a[128:129], v4 offset:32768
v_mfma_f32_16x16x32_bf16 a[224:227], a[4:7], a[140:143], a[224:227]
buffer_load_dwordx4 v16, s[12:15], s26 offen offset:0 lds
v_mfma_f32_16x16x32_bf16 a[228:231], a[8:11], a[136:139], a[228:231]
ds_read_b64_tr_b16 a[130:131], v4 offset:34816
v_cmp_gt_u32 vcc, 0x100, v245
v_mfma_f32_16x16x32_bf16 a[228:231], a[12:15], a[140:143], a[228:231]
v_mfma_f32_16x16x32_bf16 a[232:235], a[16:19], a[136:139], a[232:235]
ds_read_b64_tr_b16 a[132:133], v4 offset:49152
v_mfma_f32_16x16x32_bf16 a[232:235], a[20:23], a[140:143], a[232:235]
buffer_load_dwordx4 v17, s[12:15], s26 offen offset:1024 lds
v_mfma_f32_16x16x32_bf16 a[236:239], a[24:27], a[136:139], a[236:239]
ds_read_b64_tr_b16 a[134:135], v4 offset:51200
v_mfma_f32_16x16x32_bf16 a[236:239], a[28:31], a[140:143], a[236:239]
v_mfma_f32_16x16x32_bf16 a[240:243], a[32:35], a[136:139], a[240:243]
v_mfma_f32_16x16x32_bf16 a[240:243], a[36:39], a[140:143], a[240:243]
buffer_load_dwordx4 v18, s[12:15], s26 offen offset:2048 lds
v_mfma_f32_16x16x32_bf16 a[244:247], a[40:43], a[136:139], a[244:247]
v_mfma_f32_16x16x32_bf16 a[244:247], a[44:47], a[140:143], a[244:247]
v_mfma_f32_16x16x32_bf16 a[248:251], a[48:51], a[136:139], a[248:251]
v_mfma_f32_16x16x32_bf16 a[248:251], a[52:55], a[140:143], a[248:251]
buffer_load_dwordx4 v19, s[12:15], s26 offen offset:3072 lds
v_mfma_f32_16x16x32_bf16 a[252:255], a[56:59], a[136:139], a[252:255]
s_add_u32 s26, s26, 524288
v_mfma_f32_16x16x32_bf16 a[252:255], a[60:63], a[140:143], a[252:255]
s_waitcnt lgkmcnt(0)
s_mov_b32 s82, s59
s_cbranch_vccnz M_cntspinV
s_branch Lg_501
PAD_25:
s_cbranch_execz PAD_29
Lg_501t:
buffer_load_dword v230, v231, s[4:7], s52 offen sc1
v_mfma_f32_16x16x32_bf16 v[32:35], a[64:67], a[128:131], v[32:35]
s_add_u32 m0, s29, 81920
ds_read_b64_tr_b16 a[136:137], v5 offset:32768
v_mfma_f32_16x16x32_bf16 v[32:35], a[68:71], a[132:135], v[32:35]
buffer_load_dwordx4 v16, s[12:15], s27 offen offset:0 lds
v_mfma_f32_16x16x32_bf16 v[36:39], a[72:75], a[128:131], v[36:39]
s_and_b32 s44, s3, 1
ds_read_b64_tr_b16 a[138:139], v5 offset:34816
v_mfma_f32_16x16x32_bf16 v[36:39], a[76:79], a[132:135], v[36:39]
s_lshl_b32 s44, s44, 8
v_mfma_f32_16x16x32_bf16 v[40:43], a[80:83], a[128:131], v[40:43]
s_lshl_b32 s45, s3, 7
ds_read_b64_tr_b16 a[140:141], v5 offset:49152
v_mfma_f32_16x16x32_bf16 v[40:43], a[84:87], a[132:135], v[40:43]
s_xor_b32 s44, s44, s45
buffer_load_dwordx4 v17, s[12:15], s27 offen offset:1024 lds
v_mfma_f32_16x16x32_bf16 v[44:47], a[88:91], a[128:131], v[44:47]
s_xor_b32 s44, s44, 196608
ds_read_b64_tr_b16 a[142:143], v5 offset:51200
v_mfma_f32_16x16x32_bf16 v[44:47], a[92:95], a[132:135], v[44:47]
v_mfma_f32_16x16x32_bf16 v[48:51], a[96:99], a[128:131], v[48:51]
ds_read_b128 a[0:3], v2 offset:0
v_mfma_f32_16x16x32_bf16 v[48:51], a[100:103], a[132:135], v[48:51]
buffer_load_dwordx4 v18, s[12:15], s27 offen offset:2048 lds
v_mfma_f32_16x16x32_bf16 v[52:55], a[104:107], a[128:131], v[52:55]
ds_read_b128 a[4:7], v3 offset:0
v_mfma_f32_16x16x32_bf16 v[52:55], a[108:111], a[132:135], v[52:55]
v_mfma_f32_16x16x32_bf16 v[56:59], a[112:115], a[128:131], v[56:59]
v_mfma_f32_16x16x32_bf16 v[56:59], a[116:119], a[132:135], v[56:59]
buffer_load_dwordx4 v19, s[12:15], s27 offen offset:3072 lds
v_mfma_f32_16x16x32_bf16 v[60:63], a[120:123], a[128:131], v[60:63]
s_add_u32 s27, s27, 524288
ds_read_b128 a[8:11], v2 offset:2048
v_mfma_f32_16x16x32_bf16 v[60:63], a[124:127], a[132:135], v[60:63]
PAD_26:
s_cbranch_execz PAD_30
s_waitcnt lgkmcnt(3)
v_mfma_f32_16x16x32_bf16 v[64:67], a[64:67], a[136:139], v[64:67]
s_add_u32 m0, s28, 32768
ds_read_b64_tr_b16 a[128:129], v6 offset:32768
v_mfma_f32_16x16x32_bf16 v[64:67], a[68:71], a[140:143], v[64:67]
buffer_load_dwordx4 v12, s[8:11], s24 offen offset:0 lds
v_mfma_f32_16x16x32_bf16 v[68:71], a[72:75], a[136:139], v[68:71]
ds_read_b64_tr_b16 a[130:131], v6 offset:34816
v_mfma_f32_16x16x32_bf16 v[68:71], a[76:79], a[140:143], v[68:71]
v_mfma_f32_16x16x32_bf16 v[72:75], a[80:83], a[136:139], v[72:75]
s_mov_b64 s[56:57], s[72:73]
ds_read_b64_tr_b16 a[132:133], v6 offset:49152
v_mfma_f32_16x16x32_bf16 v[72:75], a[84:87], a[140:143], v[72:75]
s_mov_b32 s58, 1835008
buffer_load_dwordx4 v13, s[8:11], s24 offen offset:1024 lds
v_mfma_f32_16x16x32_bf16 v[76:79], a[88:91], a[136:139], v[76:79]
s_mov_b32 s59, 0x20000
ds_read_b64_tr_b16 a[134:135], v6 offset:51200
v_mfma_f32_16x16x32_bf16 v[76:79], a[92:95], a[140:143], v[76:79]
v_mfma_f32_16x16x32_bf16 v[80:83], a[96:99], a[136:139], v[80:83]
ds_read_b128 a[12:15], v3 offset:2048
v_mfma_f32_16x16x32_bf16 v[80:83], a[100:103], a[140:143], v[80:83]
buffer_load_dwordx4 v14, s[8:11], s24 offen offset:2048 lds
v_mfma_f32_16x16x32_bf16 v[84:87], a[104:107], a[136:139], v[84:87]
v_mfma_f32_16x16x32_bf16 v[84:87], a[108:111], a[140:143], v[84:87]
v_mfma_f32_16x16x32_bf16 v[88:91], a[112:115], a[136:139], v[88:91]
ds_read_b128 a[16:19], v2 offset:4096
v_mfma_f32_16x16x32_bf16 v[88:91], a[116:119], a[140:143], v[88:91]
buffer_load_dwordx4 v15, s[8:11], s24 offen offset:3072 lds
v_mfma_f32_16x16x32_bf16 v[92:95], a[120:123], a[136:139], v[92:95]
s_add_u32 s24, s24, 128
ds_read_b128 a[20:23], v3 offset:4096
v_mfma_f32_16x16x32_bf16 v[92:95], a[124:127], a[140:143], v[92:95]
s_waitcnt lgkmcnt(3)
v_mfma_f32_16x16x32_bf16 v[96:99], a[64:67], a[128:131], v[96:99]
s_add_u32 m0, s28, 36864
ds_read_b64_tr_b16 a[136:137], v7 offset:32768
v_mfma_f32_16x16x32_bf16 v[96:99], a[68:71], a[132:135], v[96:99]
buffer_load_dwordx4 v12, s[8:11], s25 offen offset:0 lds
v_mfma_f32_16x16x32_bf16 v[100:103], a[72:75], a[128:131], v[100:103]
ds_read_b64_tr_b16 a[138:139], v7 offset:34816
v_mfma_f32_16x16x32_bf16 v[100:103], a[76:79], a[132:135], v[100:103]
v_mfma_f32_16x16x32_bf16 v[104:107], a[80:83], a[128:131], v[104:107]
ds_read_b64_tr_b16 a[140:141], v7 offset:49152
v_mfma_f32_16x16x32_bf16 v[104:107], a[84:87], a[132:135], v[104:107]
buffer_load_dwordx4 v13, s[8:11], s25 offen offset:1024 lds
v_mfma_f32_16x16x32_bf16 v[108:111], a[88:91], a[128:131], v[108:111]
ds_read_b64_tr_b16 a[142:143], v7 offset:51200
v_mfma_f32_16x16x32_bf16 v[108:111], a[92:95], a[132:135], v[108:111]
v_mfma_f32_16x16x32_bf16 v[112:115], a[96:99], a[128:131], v[112:115]
v_mfma_f32_16x16x32_bf16 v[112:115], a[100:103], a[132:135], v[112:115]
buffer_load_dwordx4 v14, s[8:11], s25 offen offset:2048 lds
v_mfma_f32_16x16x32_bf16 v[116:119], a[104:107], a[128:131], v[116:119]
ds_read_b128 a[24:27], v2 offset:6144
v_mfma_f32_16x16x32_bf16 v[116:119], a[108:111], a[132:135], v[116:119]
v_mfma_f32_16x16x32_bf16 v[120:123], a[112:115], a[128:131], v[120:123]
ds_read_b128 a[28:31], v3 offset:6144
v_mfma_f32_16x16x32_bf16 v[120:123], a[116:119], a[132:135], v[120:123]
buffer_load_dwordx4 v15, s[8:11], s25 offen offset:3072 lds
v_mfma_f32_16x16x32_bf16 v[124:127], a[120:123], a[128:131], v[124:127]
s_add_u32 s25, s25, 128
s_waitcnt vmcnt(12)
v_mfma_f32_16x16x32_bf16 v[124:127], a[124:127], a[132:135], v[124:127]
s_waitcnt lgkmcnt(2)
v_cmp_gt_u32 vcc, 1, v230
v_mfma_f32_16x16x32_bf16 v[128:131], a[64:67], a[136:139], v[128:131]
s_cbranch_vccnz M_ppspinV
M_ppokV:
ds_read_b64_tr_b16 a[128:129], v8 offset:32768
v_mfma_f32_16x16x32_bf16 v[128:131], a[68:71], a[140:143], v[128:131]
buffer_load_dword v230, v229, s[4:7], s53 offen sc1
v_mfma_f32_16x16x32_bf16 v[132:135], a[72:75], a[136:139], v[132:135]
s_mov_b64 s[8:9], s[76:77]
ds_read_b64_tr_b16 a[130:131], v8 offset:34816
v_mfma_f32_16x16x32_bf16 v[132:135], a[76:79], a[140:143], v[132:135]
s_mov_b32 s10, 1835008
buffer_load_dword v230, v229, s[4:7], s48 offen sc1
v_mfma_f32_16x16x32_bf16 v[136:139], a[80:83], a[136:139], v[136:139]
s_lshl_b32 s24, s37, 2
ds_read_b64_tr_b16 a[132:133], v8 offset:49152
v_mfma_f32_16x16x32_bf16 v[136:139], a[84:87], a[140:143], v[136:139]
s_add_u32 s24, s24, s3
buffer_load_dword v230, v229, s[56:59], s49 offen
v_mfma_f32_16x16x32_bf16 v[140:143], a[88:91], a[136:139], v[140:143]
s_mul_i32 s24, s24, 28672
ds_read_b64_tr_b16 a[134:135], v8 offset:51200
v_mfma_f32_16x16x32_bf16 v[140:143], a[92:95], a[140:143], v[140:143]
s_mov_b32 s28, s29
buffer_load_dword v21, v20, s[16:19], s43 offen
v_mfma_f32_16x16x32_bf16 v[144:147], a[96:99], a[136:139], v[144:147]
ds_read_b128 a[32:35], v2 offset:8192
v_mfma_f32_16x16x32_bf16 v[144:147], a[100:103], a[140:143], v[144:147]
v_mfma_f32_16x16x32_bf16 v[148:151], a[104:107], a[136:139], v[148:151]
v_mfma_f32_16x16x32_bf16 v[148:151], a[108:111], a[140:143], v[148:151]
v_mfma_f32_16x16x32_bf16 v[152:155], a[112:115], a[136:139], v[152:155]
ds_read_b128 a[36:39], v3 offset:8192
v_lshrrev_b32 v28, 7, v1
v_mfma_f32_16x16x32_bf16 v[152:155], a[116:119], a[140:143], v[152:155]
v_lshrrev_b32 v29, 1, v28
v_lshlrev_b32 v29, 4, v29
v_mfma_f32_16x16x32_bf16 v[156:159], a[120:123], a[136:139], v[156:159]
ds_read_b128 a[40:43], v2 offset:10240
v_and_b32 v30, 0x70, v1
v_mfma_f32_16x16x32_bf16 v[156:159], a[124:127], a[140:143], v[156:159]
s_waitcnt lgkmcnt(3)
v_xor_b32 v29, v29, v30
v_mul_u32_u24 v28, 896, v28
v_mfma_f32_16x16x32_bf16 v[160:163], a[64:67], a[128:131], v[160:163]
ds_read_b64_tr_b16 a[136:137], v9 offset:32768
v_add_u32 v12, v28, v29
v_mfma_f32_16x16x32_bf16 v[160:163], a[68:71], a[132:135], v[160:163]
v_xor_b32 v29, 64, v29
v_add_u32 v28, v28, v29
v_mfma_f32_16x16x32_bf16 v[164:167], a[72:75], a[128:131], v[164:167]
ds_read_b64_tr_b16 a[138:139], v9 offset:34816
v_add_u32 v13, 6144, v28
v_mfma_f32_16x16x32_bf16 v[164:167], a[76:79], a[132:135], v[164:167]
v_add_u32 v14, 12288, v12
v_add_u32 v15, 18432, v28
v_mfma_f32_16x16x32_bf16 v[168:171], a[80:83], a[128:131], v[168:171]
ds_read_b64_tr_b16 a[140:141], v9 offset:49152
v_xor_b32 v22, s44, v4
v_mfma_f32_16x16x32_bf16 v[168:171], a[84:87], a[132:135], v[168:171]
v_xor_b32 v23, 32, v22
v_xor_b32 v24, 64, v22
v_mfma_f32_16x16x32_bf16 v[172:175], a[88:91], a[128:131], v[172:175]
ds_read_b64_tr_b16 a[142:143], v9 offset:51200
v_xor_b32 v25, 96, v22
v_mfma_f32_16x16x32_bf16 v[172:175], a[92:95], a[132:135], v[172:175]
v_mfma_f32_16x16x32_bf16 v[176:179], a[96:99], a[128:131], v[176:179]
v_mfma_f32_16x16x32_bf16 v[176:179], a[100:103], a[132:135], v[176:179]
v_mfma_f32_16x16x32_bf16 v[180:183], a[104:107], a[128:131], v[180:183]
ds_read_b128 a[44:47], v3 offset:10240
v_mfma_f32_16x16x32_bf16 v[180:183], a[108:111], a[132:135], v[180:183]
v_mfma_f32_16x16x32_bf16 v[184:187], a[112:115], a[128:131], v[184:187]
ds_read_b128 a[48:51], v2 offset:12288
v_mfma_f32_16x16x32_bf16 v[184:187], a[116:119], a[132:135], v[184:187]
v_mfma_f32_16x16x32_bf16 v[188:191], a[120:123], a[128:131], v[188:191]
v_mfma_f32_16x16x32_bf16 v[188:191], a[124:127], a[132:135], v[188:191]
s_waitcnt lgkmcnt(2)
v_mfma_f32_16x16x32_bf16 v[192:195], a[64:67], a[136:139], v[192:195]
ds_read_b64_tr_b16 a[128:129], v10 offset:32768
v_mfma_f32_16x16x32_bf16 v[192:195], a[68:71], a[140:143], v[192:195]
v_mfma_f32_16x16x32_bf16 v[196:199], a[72:75], a[136:139], v[196:199]
ds_read_b64_tr_b16 a[130:131], v10 offset:34816
v_mfma_f32_16x16x32_bf16 v[196:199], a[76:79], a[140:143], v[196:199]
v_mfma_f32_16x16x32_bf16 v[200:203], a[80:83], a[136:139], v[200:203]
ds_read_b64_tr_b16 a[132:133], v10 offset:49152
v_mfma_f32_16x16x32_bf16 v[200:203], a[84:87], a[140:143], v[200:203]
v_mfma_f32_16x16x32_bf16 v[204:207], a[88:91], a[136:139], v[204:207]
ds_read_b64_tr_b16 a[134:135], v10 offset:51200
v_mfma_f32_16x16x32_bf16 v[204:207], a[92:95], a[140:143], v[204:207]
v_mfma_f32_16x16x32_bf16 v[208:211], a[96:99], a[136:139], v[208:211]
ds_read_b128 a[52:55], v3 offset:12288
v_mfma_f32_16x16x32_bf16 v[208:211], a[100:103], a[140:143], v[208:211]
v_mfma_f32_16x16x32_bf16 v[212:215], a[104:107], a[136:139], v[212:215]
ds_read_b128 a[56:59], v2 offset:14336
v_mfma_f32_16x16x32_bf16 v[212:215], a[108:111], a[140:143], v[212:215]
v_mfma_f32_16x16x32_bf16 v[216:219], a[112:115], a[136:139], v[216:219]
v_mfma_f32_16x16x32_bf16 v[216:219], a[116:119], a[140:143], v[216:219]
v_mfma_f32_16x16x32_bf16 v[220:223], a[120:123], a[136:139], v[220:223]
ds_read_b128 a[60:63], v3 offset:14336
v_mfma_f32_16x16x32_bf16 v[220:223], a[124:127], a[140:143], v[220:223]
s_waitcnt lgkmcnt(3)
v_mfma_f32_16x16x32_bf16 a[192:195], a[64:67], a[128:131], a[192:195]
ds_read_b64_tr_b16 a[136:137], v11 offset:32768
v_mfma_f32_16x16x32_bf16 a[192:195], a[68:71], a[132:135], a[192:195]
v_mfma_f32_16x16x32_bf16 a[196:199], a[72:75], a[128:131], a[196:199]
ds_read_b64_tr_b16 a[138:139], v11 offset:34816
v_mfma_f32_16x16x32_bf16 a[196:199], a[76:79], a[132:135], a[196:199]
v_mfma_f32_16x16x32_bf16 a[200:203], a[80:83], a[128:131], a[200:203]
ds_read_b64_tr_b16 a[140:141], v11 offset:49152
v_mfma_f32_16x16x32_bf16 a[200:203], a[84:87], a[132:135], a[200:203]
v_mfma_f32_16x16x32_bf16 a[204:207], a[88:91], a[128:131], a[204:207]
ds_read_b64_tr_b16 a[142:143], v11 offset:51200
v_mfma_f32_16x16x32_bf16 a[204:207], a[92:95], a[132:135], a[204:207]
v_mfma_f32_16x16x32_bf16 a[208:211], a[96:99], a[128:131], a[208:211]
v_mfma_f32_16x16x32_bf16 a[208:211], a[100:103], a[132:135], a[208:211]
v_mfma_f32_16x16x32_bf16 a[212:215], a[104:107], a[128:131], a[212:215]
v_mfma_f32_16x16x32_bf16 a[212:215], a[108:111], a[132:135], a[212:215]
v_mfma_f32_16x16x32_bf16 a[216:219], a[112:115], a[128:131], a[216:219]
v_mfma_f32_16x16x32_bf16 a[216:219], a[116:119], a[132:135], a[216:219]
v_mfma_f32_16x16x32_bf16 a[220:223], a[120:123], a[128:131], a[220:223]
s_waitcnt vmcnt(4) lgkmcnt(0)
v_mfma_f32_16x16x32_bf16 a[220:223], a[124:127], a[132:135], a[220:223]
s_barrier
v_mfma_f32_16x16x32_bf16 a[224:227], a[64:67], a[136:139], a[224:227]
s_add_u32 m0, s29, 98304
ds_read_b64_tr_b16 a[128:129], v4 offset:0
v_mfma_f32_16x16x32_bf16 a[224:227], a[68:71], a[140:143], a[224:227]
buffer_load_dwordx4 v16, s[12:15], s26 offen offset:0 lds
v_mfma_f32_16x16x32_bf16 a[228:231], a[72:75], a[136:139], a[228:231]
ds_read_b64_tr_b16 a[130:131], v4 offset:2048
v_mfma_f32_16x16x32_bf16 a[228:231], a[76:79], a[140:143], a[228:231]
v_mfma_f32_16x16x32_bf16 a[232:235], a[80:83], a[136:139], a[232:235]
ds_read_b64_tr_b16 a[132:133], v4 offset:16384
v_mfma_f32_16x16x32_bf16 a[232:235], a[84:87], a[140:143], a[232:235]
buffer_load_dwordx4 v17, s[12:15], s26 offen offset:1024 lds
v_mfma_f32_16x16x32_bf16 a[236:239], a[88:91], a[136:139], a[236:239]
ds_read_b64_tr_b16 a[134:135], v4 offset:18432
v_mfma_f32_16x16x32_bf16 a[236:239], a[92:95], a[140:143], a[236:239]
v_mfma_f32_16x16x32_bf16 a[240:243], a[96:99], a[136:139], a[240:243]
v_mfma_f32_16x16x32_bf16 a[240:243], a[100:103], a[140:143], a[240:243]
buffer_load_dwordx4 v18, s[12:15], s26 offen offset:2048 lds
v_mfma_f32_16x16x32_bf16 a[244:247], a[104:107], a[136:139], a[244:247]
v_mfma_f32_16x16x32_bf16 a[244:247], a[108:111], a[140:143], a[244:247]
v_mfma_f32_16x16x32_bf16 a[248:251], a[112:115], a[136:139], a[248:251]
v_mfma_f32_16x16x32_bf16 a[248:251], a[116:119], a[140:143], a[248:251]
buffer_load_dwordx4 v19, s[12:15], s26 offen offset:3072 lds
v_mfma_f32_16x16x32_bf16 a[252:255], a[120:123], a[136:139], a[252:255]
s_add_u32 s26, s26, 524288
v_mfma_f32_16x16x32_bf16 a[252:255], a[124:127], a[140:143], a[252:255]
s_waitcnt lgkmcnt(0)
v_mfma_f32_16x16x32_bf16 v[32:35], a[0:3], a[128:131], v[32:35]
s_add_u32 m0, s29, 114688
ds_read_b64_tr_b16 a[136:137], v5 offset:0
v_mfma_f32_16x16x32_bf16 v[32:35], a[4:7], a[132:135], v[32:35]
buffer_load_dwordx4 v16, s[12:15], s27 offen offset:0 lds
v_mfma_f32_16x16x32_bf16 v[36:39], a[8:11], a[128:131], v[36:39]
ds_read_b64_tr_b16 a[138:139], v5 offset:2048
v_mfma_f32_16x16x32_bf16 v[36:39], a[12:15], a[132:135], v[36:39]
v_mfma_f32_16x16x32_bf16 v[40:43], a[16:19], a[128:131], v[40:43]
ds_read_b64_tr_b16 a[140:141], v5 offset:16384
v_mfma_f32_16x16x32_bf16 v[40:43], a[20:23], a[132:135], v[40:43]
buffer_load_dwordx4 v17, s[12:15], s27 offen offset:1024 lds
v_mfma_f32_16x16x32_bf16 v[44:47], a[24:27], a[128:131], v[44:47]
ds_read_b64_tr_b16 a[142:143], v5 offset:18432
v_mfma_f32_16x16x32_bf16 v[44:47], a[28:31], a[132:135], v[44:47]
v_mfma_f32_16x16x32_bf16 v[48:51], a[32:35], a[128:131], v[48:51]
ds_read_b128 a[64:67], v2 offset:32768
v_mfma_f32_16x16x32_bf16 v[48:51], a[36:39], a[132:135], v[48:51]
buffer_load_dwordx4 v18, s[12:15], s27 offen offset:2048 lds
v_mfma_f32_16x16x32_bf16 v[52:55], a[40:43], a[128:131], v[52:55]
ds_read_b128 a[68:71], v3 offset:32768
v_mfma_f32_16x16x32_bf16 v[52:55], a[44:47], a[132:135], v[52:55]
v_mfma_f32_16x16x32_bf16 v[56:59], a[48:51], a[128:131], v[56:59]
v_mfma_f32_16x16x32_bf16 v[56:59], a[52:55], a[132:135], v[56:59]
buffer_load_dwordx4 v19, s[12:15], s27 offen offset:3072 lds
v_mfma_f32_16x16x32_bf16 v[60:63], a[56:59], a[128:131], v[60:63]
s_add_u32 s27, s27, 524288
ds_read_b128 a[72:75], v2 offset:34816
v_mfma_f32_16x16x32_bf16 v[60:63], a[60:63], a[132:135], v[60:63]
s_waitcnt lgkmcnt(3)
v_mfma_f32_16x16x32_bf16 v[64:67], a[0:3], a[136:139], v[64:67]
s_add_u32 m0, s28, 0
ds_read_b64_tr_b16 a[128:129], v6 offset:0
v_mfma_f32_16x16x32_bf16 v[64:67], a[4:7], a[140:143], v[64:67]
buffer_load_dwordx4 v12, s[8:11], s24 offen offset:0 lds
v_mfma_f32_16x16x32_bf16 v[68:71], a[8:11], a[136:139], v[68:71]
ds_read_b64_tr_b16 a[130:131], v6 offset:2048
v_mfma_f32_16x16x32_bf16 v[68:71], a[12:15], a[140:143], v[68:71]
v_mfma_f32_16x16x32_bf16 v[72:75], a[16:19], a[136:139], v[72:75]
ds_read_b64_tr_b16 a[132:133], v6 offset:16384
v_mfma_f32_16x16x32_bf16 v[72:75], a[20:23], a[140:143], v[72:75]
buffer_load_dwordx4 v13, s[8:11], s24 offen offset:1024 lds
v_mfma_f32_16x16x32_bf16 v[76:79], a[24:27], a[136:139], v[76:79]
ds_read_b64_tr_b16 a[134:135], v6 offset:18432
v_mfma_f32_16x16x32_bf16 v[76:79], a[28:31], a[140:143], v[76:79]
v_mfma_f32_16x16x32_bf16 v[80:83], a[32:35], a[136:139], v[80:83]
ds_read_b128 a[76:79], v3 offset:34816
v_mfma_f32_16x16x32_bf16 v[80:83], a[36:39], a[140:143], v[80:83]
buffer_load_dwordx4 v14, s[8:11], s24 offen offset:2048 lds
v_mfma_f32_16x16x32_bf16 v[84:87], a[40:43], a[136:139], v[84:87]
v_mfma_f32_16x16x32_bf16 v[84:87], a[44:47], a[140:143], v[84:87]
v_mfma_f32_16x16x32_bf16 v[88:91], a[48:51], a[136:139], v[88:91]
ds_read_b128 a[80:83], v2 offset:36864
v_mfma_f32_16x16x32_bf16 v[88:91], a[52:55], a[140:143], v[88:91]
buffer_load_dwordx4 v15, s[8:11], s24 offen offset:3072 lds
v_mfma_f32_16x16x32_bf16 v[92:95], a[56:59], a[136:139], v[92:95]
s_add_u32 s24, s24, 128
ds_read_b128 a[84:87], v3 offset:36864
v_mfma_f32_16x16x32_bf16 v[92:95], a[60:63], a[140:143], v[92:95]
s_waitcnt lgkmcnt(3)
s_mov_b64 s[12:13], s[80:81]
v_mfma_f32_16x16x32_bf16 v[96:99], a[0:3], a[128:131], v[96:99]
s_mov_b32 s14, 3670016
s_add_u32 m0, s28, 16384
ds_read_b64_tr_b16 a[136:137], v7 offset:0
v_mfma_f32_16x16x32_bf16 v[96:99], a[4:7], a[132:135], v[96:99]
buffer_load_dwordx4 v12, s[8:11], s24 offen offset:0 lds
v_mfma_f32_16x16x32_bf16 v[100:103], a[8:11], a[128:131], v[100:103]
ds_read_b64_tr_b16 a[138:139], v7 offset:2048
v_mfma_f32_16x16x32_bf16 v[100:103], a[12:15], a[132:135], v[100:103]
v_mfma_f32_16x16x32_bf16 v[104:107], a[16:19], a[128:131], v[104:107]
ds_read_b64_tr_b16 a[140:141], v7 offset:16384
v_mfma_f32_16x16x32_bf16 v[104:107], a[20:23], a[132:135], v[104:107]
buffer_load_dwordx4 v13, s[8:11], s24 offen offset:1024 lds
v_mfma_f32_16x16x32_bf16 v[108:111], a[24:27], a[128:131], v[108:111]
ds_read_b64_tr_b16 a[142:143], v7 offset:18432
v_mfma_f32_16x16x32_bf16 v[108:111], a[28:31], a[132:135], v[108:111]
v_mfma_f32_16x16x32_bf16 v[112:115], a[32:35], a[128:131], v[112:115]
v_mfma_f32_16x16x32_bf16 v[112:115], a[36:39], a[132:135], v[112:115]
buffer_load_dwordx4 v14, s[8:11], s24 offen offset:2048 lds
v_mfma_f32_16x16x32_bf16 v[116:119], a[40:43], a[128:131], v[116:119]
ds_read_b128 a[88:91], v2 offset:38912
v_mfma_f32_16x16x32_bf16 v[116:119], a[44:47], a[132:135], v[116:119]
v_mfma_f32_16x16x32_bf16 v[120:123], a[48:51], a[128:131], v[120:123]
ds_read_b128 a[92:95], v3 offset:38912
v_mfma_f32_16x16x32_bf16 v[120:123], a[52:55], a[132:135], v[120:123]
buffer_load_dwordx4 v15, s[8:11], s24 offen offset:3072 lds
v_mfma_f32_16x16x32_bf16 v[124:127], a[56:59], a[128:131], v[124:127]
s_add_u32 s24, s24, 128
v_mfma_f32_16x16x32_bf16 v[124:127], a[60:63], a[132:135], v[124:127]
s_waitcnt lgkmcnt(2)
s_sub_u32 s26, s26, 8388608
v_mfma_f32_16x16x32_bf16 v[128:131], a[0:3], a[136:139], v[128:131]
s_sub_u32 s27, s27, 8388608
s_add_u32 m0, s29, 131072
ds_read_b64_tr_b16 a[128:129], v8 offset:0
v_mfma_f32_16x16x32_bf16 v[128:131], a[4:7], a[140:143], v[128:131]
buffer_load_dwordx4 v16, s[12:15], s26 offen offset:0 lds
v_mfma_f32_16x16x32_bf16 v[132:135], a[8:11], a[136:139], v[132:135]
ds_read_b64_tr_b16 a[130:131], v8 offset:2048
v_mfma_f32_16x16x32_bf16 v[132:135], a[12:15], a[140:143], v[132:135]
v_mfma_f32_16x16x32_bf16 v[136:139], a[16:19], a[136:139], v[136:139]
ds_read_b64_tr_b16 a[132:133], v8 offset:16384
v_mfma_f32_16x16x32_bf16 v[136:139], a[20:23], a[140:143], v[136:139]
buffer_load_dwordx4 v17, s[12:15], s26 offen offset:1024 lds
v_mfma_f32_16x16x32_bf16 v[140:143], a[24:27], a[136:139], v[140:143]
ds_read_b64_tr_b16 a[134:135], v8 offset:18432
v_mfma_f32_16x16x32_bf16 v[140:143], a[28:31], a[140:143], v[140:143]
v_mfma_f32_16x16x32_bf16 v[144:147], a[32:35], a[136:139], v[144:147]
ds_read_b128 a[96:99], v2 offset:40960
v_mfma_f32_16x16x32_bf16 v[144:147], a[36:39], a[140:143], v[144:147]
buffer_load_dwordx4 v18, s[12:15], s26 offen offset:2048 lds
v_mfma_f32_16x16x32_bf16 v[148:151], a[40:43], a[136:139], v[148:151]
v_mfma_f32_16x16x32_bf16 v[148:151], a[44:47], a[140:143], v[148:151]
v_mfma_f32_16x16x32_bf16 v[152:155], a[48:51], a[136:139], v[152:155]
ds_read_b128 a[100:103], v3 offset:40960
v_mfma_f32_16x16x32_bf16 v[152:155], a[52:55], a[140:143], v[152:155]
buffer_load_dwordx4 v19, s[12:15], s26 offen offset:3072 lds
v_mfma_f32_16x16x32_bf16 v[156:159], a[56:59], a[136:139], v[156:159]
s_add_u32 s26, s26, 524288
ds_read_b128 a[104:107], v2 offset:43008
v_mfma_f32_16x16x32_bf16 v[156:159], a[60:63], a[140:143], v[156:159]
s_waitcnt lgkmcnt(3)
v_mfma_f32_16x16x32_bf16 v[160:163], a[0:3], a[128:131], v[160:163]
s_add_u32 m0, s29, 147456
ds_read_b64_tr_b16 a[136:137], v9 offset:0
v_mfma_f32_16x16x32_bf16 v[160:163], a[4:7], a[132:135], v[160:163]
buffer_load_dwordx4 v16, s[12:15], s27 offen offset:0 lds
v_mfma_f32_16x16x32_bf16 v[164:167], a[8:11], a[128:131], v[164:167]
ds_read_b64_tr_b16 a[138:139], v9 offset:2048
v_mfma_f32_16x16x32_bf16 v[164:167], a[12:15], a[132:135], v[164:167]
v_mfma_f32_16x16x32_bf16 v[168:171], a[16:19], a[128:131], v[168:171]
ds_read_b64_tr_b16 a[140:141], v9 offset:16384
v_mfma_f32_16x16x32_bf16 v[168:171], a[20:23], a[132:135], v[168:171]
buffer_load_dwordx4 v17, s[12:15], s27 offen offset:1024 lds
v_mfma_f32_16x16x32_bf16 v[172:175], a[24:27], a[128:131], v[172:175]
ds_read_b64_tr_b16 a[142:143], v9 offset:18432
v_mfma_f32_16x16x32_bf16 v[172:175], a[28:31], a[132:135], v[172:175]
v_mfma_f32_16x16x32_bf16 v[176:179], a[32:35], a[128:131], v[176:179]
v_mfma_f32_16x16x32_bf16 v[176:179], a[36:39], a[132:135], v[176:179]
buffer_load_dwordx4 v18, s[12:15], s27 offen offset:2048 lds
v_mfma_f32_16x16x32_bf16 v[180:183], a[40:43], a[128:131], v[180:183]
ds_read_b128 a[108:111], v3 offset:43008
v_mfma_f32_16x16x32_bf16 v[180:183], a[44:47], a[132:135], v[180:183]
v_mfma_f32_16x16x32_bf16 v[184:187], a[48:51], a[128:131], v[184:187]
ds_read_b128 a[112:115], v2 offset:45056
v_mfma_f32_16x16x32_bf16 v[184:187], a[52:55], a[132:135], v[184:187]
buffer_load_dwordx4 v19, s[12:15], s27 offen offset:3072 lds
v_mfma_f32_16x16x32_bf16 v[188:191], a[56:59], a[128:131], v[188:191]
s_add_u32 s27, s27, 524288
v_mfma_f32_16x16x32_bf16 v[188:191], a[60:63], a[132:135], v[188:191]
s_waitcnt lgkmcnt(2)
v_mfma_f32_16x16x32_bf16 v[192:195], a[0:3], a[136:139], v[192:195]
ds_read_b64_tr_b16 a[128:129], v10 offset:0
v_mfma_f32_16x16x32_bf16 v[192:195], a[4:7], a[140:143], v[192:195]
v_mfma_f32_16x16x32_bf16 v[196:199], a[8:11], a[136:139], v[196:199]
ds_read_b64_tr_b16 a[130:131], v10 offset:2048
v_mfma_f32_16x16x32_bf16 v[196:199], a[12:15], a[140:143], v[196:199]
v_mfma_f32_16x16x32_bf16 v[200:203], a[16:19], a[136:139], v[200:203]
ds_read_b64_tr_b16 a[132:133], v10 offset:16384
v_mfma_f32_16x16x32_bf16 v[200:203], a[20:23], a[140:143], v[200:203]
v_mfma_f32_16x16x32_bf16 v[204:207], a[24:27], a[136:139], v[204:207]
ds_read_b64_tr_b16 a[134:135], v10 offset:18432
v_mfma_f32_16x16x32_bf16 v[204:207], a[28:31], a[140:143], v[204:207]
v_mfma_f32_16x16x32_bf16 v[208:211], a[32:35], a[136:139], v[208:211]
ds_read_b128 a[116:119], v3 offset:45056
v_mfma_f32_16x16x32_bf16 v[208:211], a[36:39], a[140:143], v[208:211]
v_mfma_f32_16x16x32_bf16 v[212:215], a[40:43], a[136:139], v[212:215]
ds_read_b128 a[120:123], v2 offset:47104
v_mfma_f32_16x16x32_bf16 v[212:215], a[44:47], a[140:143], v[212:215]
v_mfma_f32_16x16x32_bf16 v[216:219], a[48:51], a[136:139], v[216:219]
v_mfma_f32_16x16x32_bf16 v[216:219], a[52:55], a[140:143], v[216:219]
v_mfma_f32_16x16x32_bf16 v[220:223], a[56:59], a[136:139], v[220:223]
ds_read_b128 a[124:127], v3 offset:47104
v_mfma_f32_16x16x32_bf16 v[220:223], a[60:63], a[140:143], v[220:223]
s_waitcnt lgkmcnt(3)
v_mfma_f32_16x16x32_bf16 a[192:195], a[0:3], a[128:131], a[192:195]
ds_read_b64_tr_b16 a[136:137], v11 offset:0
v_mfma_f32_16x16x32_bf16 a[192:195], a[4:7], a[132:135], a[192:195]
v_mfma_f32_16x16x32_bf16 a[196:199], a[8:11], a[128:131], a[196:199]
ds_read_b64_tr_b16 a[138:139], v11 offset:2048
v_mfma_f32_16x16x32_bf16 a[196:199], a[12:15], a[132:135], a[196:199]
v_mfma_f32_16x16x32_bf16 a[200:203], a[16:19], a[128:131], a[200:203]
ds_read_b64_tr_b16 a[140:141], v11 offset:16384
v_mfma_f32_16x16x32_bf16 a[200:203], a[20:23], a[132:135], a[200:203]
v_mfma_f32_16x16x32_bf16 a[204:207], a[24:27], a[128:131], a[204:207]
ds_read_b64_tr_b16 a[142:143], v11 offset:18432
v_mfma_f32_16x16x32_bf16 a[204:207], a[28:31], a[132:135], a[204:207]
v_mfma_f32_16x16x32_bf16 a[208:211], a[32:35], a[128:131], a[208:211]
v_mfma_f32_16x16x32_bf16 a[208:211], a[36:39], a[132:135], a[208:211]
v_mfma_f32_16x16x32_bf16 a[212:215], a[40:43], a[128:131], a[212:215]
v_mfma_f32_16x16x32_bf16 a[212:215], a[44:47], a[132:135], a[212:215]
v_mfma_f32_16x16x32_bf16 a[216:219], a[48:51], a[128:131], a[216:219]
v_mfma_f32_16x16x32_bf16 a[216:219], a[52:55], a[132:135], a[216:219]
v_mfma_f32_16x16x32_bf16 a[220:223], a[56:59], a[128:131], a[220:223]
s_waitcnt vmcnt(12) lgkmcnt(0)
v_mfma_f32_16x16x32_bf16 a[220:223], a[60:63], a[132:135], a[220:223]
s_barrier
v_mfma_f32_16x16x32_bf16 a[224:227], a[0:3], a[136:139], a[224:227]
s_add_u32 m0, s28, 32768
ds_read_b64_tr_b16 a[128:129], v4 offset:32768
v_mfma_f32_16x16x32_bf16 a[224:227], a[4:7], a[140:143], a[224:227]
s_lshr_b32 s22, s3, 1
buffer_load_dwordx4 v12, s[8:11], s24 offen offset:0 lds
v_mfma_f32_16x16x32_bf16 a[228:231], a[8:11], a[136:139], a[228:231]
s_lshl_b32 s22, s22, 14
ds_read_b64_tr_b16 a[130:131], v4 offset:34816
v_subrev_u32 v2, s22, v2
v_mfma_f32_16x16x32_bf16 a[228:231], a[12:15], a[140:143], a[228:231]
v_subrev_u32 v3, s22, v3
v_mfma_f32_16x16x32_bf16 a[232:235], a[16:19], a[136:139], a[232:235]
ds_read_b64_tr_b16 a[132:133], v4 offset:49152
v_mfma_f32_16x16x32_bf16 a[232:235], a[20:23], a[140:143], a[232:235]
buffer_load_dwordx4 v13, s[8:11], s24 offen offset:1024 lds
v_mfma_f32_16x16x32_bf16 a[236:239], a[24:27], a[136:139], a[236:239]
ds_read_b64_tr_b16 a[134:135], v4 offset:51200
v_mfma_f32_16x16x32_bf16 a[236:239], a[28:31], a[140:143], a[236:239]
v_mfma_f32_16x16x32_bf16 a[240:243], a[32:35], a[136:139], a[240:243]
v_mfma_f32_16x16x32_bf16 a[240:243], a[36:39], a[140:143], a[240:243]
buffer_load_dwordx4 v14, s[8:11], s24 offen offset:2048 lds
v_mfma_f32_16x16x32_bf16 a[244:247], a[40:43], a[136:139], a[244:247]
v_mfma_f32_16x16x32_bf16 a[244:247], a[44:47], a[140:143], a[244:247]
v_mfma_f32_16x16x32_bf16 a[248:251], a[48:51], a[136:139], a[248:251]
v_mfma_f32_16x16x32_bf16 a[248:251], a[52:55], a[140:143], a[248:251]
buffer_load_dwordx4 v15, s[8:11], s24 offen offset:3072 lds
v_mfma_f32_16x16x32_bf16 a[252:255], a[56:59], a[136:139], a[252:255]
s_add_u32 s24, s24, 128
v_mfma_f32_16x16x32_bf16 a[252:255], a[60:63], a[140:143], a[252:255]
s_waitcnt lgkmcnt(0)
v_mfma_f32_16x16x32_bf16 v[32:35], a[64:67], a[128:131], v[32:35]
s_add_u32 m0, s29, 65536
ds_read_b64_tr_b16 a[136:137], v5 offset:32768
v_mfma_f32_16x16x32_bf16 v[32:35], a[68:71], a[132:135], v[32:35]
buffer_load_dwordx4 v16, s[12:15], s26 offen offset:0 lds
v_mfma_f32_16x16x32_bf16 v[36:39], a[72:75], a[128:131], v[36:39]
ds_read_b64_tr_b16 a[138:139], v5 offset:34816
v_mfma_f32_16x16x32_bf16 v[36:39], a[76:79], a[132:135], v[36:39]
v_mfma_f32_16x16x32_bf16 v[40:43], a[80:83], a[128:131], v[40:43]
ds_read_b64_tr_b16 a[140:141], v5 offset:49152
v_mfma_f32_16x16x32_bf16 v[40:43], a[84:87], a[132:135], v[40:43]
buffer_load_dwordx4 v17, s[12:15], s26 offen offset:1024 lds
v_mfma_f32_16x16x32_bf16 v[44:47], a[88:91], a[128:131], v[44:47]
ds_read_b64_tr_b16 a[142:143], v5 offset:51200
v_mfma_f32_16x16x32_bf16 v[44:47], a[92:95], a[132:135], v[44:47]
v_mfma_f32_16x16x32_bf16 v[48:51], a[96:99], a[128:131], v[48:51]
ds_read_b128 a[0:3], v2 offset:0
v_cvt_pk_bf16_f32 v32, v32, v33
v_mfma_f32_16x16x32_bf16 v[48:51], a[100:103], a[132:135], v[48:51]
buffer_load_dwordx4 v18, s[12:15], s26 offen offset:2048 lds
v_mfma_f32_16x16x32_bf16 v[52:55], a[104:107], a[128:131], v[52:55]
ds_read_b128 a[4:7], v3 offset:0
v_cvt_pk_bf16_f32 v33, v34, v35
v_mfma_f32_16x16x32_bf16 v[52:55], a[108:111], a[132:135], v[52:55]
v_cvt_pk_bf16_f32 v34, v36, v37
v_cvt_pk_bf16_f32 v35, v38, v39
v_mfma_f32_16x16x32_bf16 v[56:59], a[112:115], a[128:131], v[56:59]
v_cvt_pk_bf16_f32 v40, v40, v41
v_cvt_pk_bf16_f32 v41, v42, v43
v_mfma_f32_16x16x32_bf16 v[56:59], a[116:119], a[132:135], v[56:59]
buffer_load_dwordx4 v19, s[12:15], s26 offen offset:3072 lds
v_mfma_f32_16x16x32_bf16 v[60:63], a[120:123], a[128:131], v[60:63]
s_add_u32 s26, s26, 524288
ds_read_b128 a[8:11], v2 offset:2048
v_cvt_pk_bf16_f32 v42, v44, v45
v_mfma_f32_16x16x32_bf16 v[60:63], a[124:127], a[132:135], v[60:63]
s_waitcnt lgkmcnt(3)
v_cvt_pk_bf16_f32 v43, v46, v47
v_mfma_f32_16x16x32_bf16 v[64:67], a[64:67], a[136:139], v[64:67]
s_add_u32 m0, s29, 81920
ds_read_b64_tr_b16 a[128:129], v6 offset:32768
v_cvt_pk_bf16_f32 v48, v48, v49
v_mfma_f32_16x16x32_bf16 v[64:67], a[68:71], a[140:143], v[64:67]
buffer_load_dwordx4 v16, s[12:15], s27 offen offset:0 lds
v_mfma_f32_16x16x32_bf16 v[68:71], a[72:75], a[136:139], v[68:71]
ds_read_b64_tr_b16 a[130:131], v6 offset:34816
v_cvt_pk_bf16_f32 v49, v50, v51
v_mfma_f32_16x16x32_bf16 v[68:71], a[76:79], a[140:143], v[68:71]
v_cvt_pk_bf16_f32 v50, v52, v53
v_cvt_pk_bf16_f32 v51, v54, v55
v_mfma_f32_16x16x32_bf16 v[72:75], a[80:83], a[136:139], v[72:75]
ds_read_b64_tr_b16 a[132:133], v6 offset:49152
v_cvt_pk_bf16_f32 v56, v56, v57
v_mfma_f32_16x16x32_bf16 v[72:75], a[84:87], a[140:143], v[72:75]
buffer_load_dwordx4 v17, s[12:15], s27 offen offset:1024 lds
v_mfma_f32_16x16x32_bf16 v[76:79], a[88:91], a[136:139], v[76:79]
ds_read_b64_tr_b16 a[134:135], v6 offset:51200
v_cvt_pk_bf16_f32 v57, v58, v59
v_mfma_f32_16x16x32_bf16 v[76:79], a[92:95], a[140:143], v[76:79]
v_cvt_pk_bf16_f32 v58, v60, v61
v_cvt_pk_bf16_f32 v59, v62, v63
v_mfma_f32_16x16x32_bf16 v[80:83], a[96:99], a[136:139], v[80:83]
ds_read_b128 a[12:15], v3 offset:2048
v_cvt_pk_bf16_f32 v64, v64, v65
v_mfma_f32_16x16x32_bf16 v[80:83], a[100:103], a[140:143], v[80:83]
buffer_load_dwordx4 v18, s[12:15], s27 offen offset:2048 lds
v_mfma_f32_16x16x32_bf16 v[84:87], a[104:107], a[136:139], v[84:87]
v_cvt_pk_bf16_f32 v65, v66, v67
v_cvt_pk_bf16_f32 v66, v68, v69
v_mfma_f32_16x16x32_bf16 v[84:87], a[108:111], a[140:143], v[84:87]
v_cvt_pk_bf16_f32 v67, v70, v71
v_mfma_f32_16x16x32_bf16 v[88:91], a[112:115], a[136:139], v[88:91]
ds_read_b128 a[16:19], v2 offset:4096
v_cvt_pk_bf16_f32 v72, v72, v73
v_mfma_f32_16x16x32_bf16 v[88:91], a[116:119], a[140:143], v[88:91]
buffer_load_dwordx4 v19, s[12:15], s27 offen offset:3072 lds
v_mfma_f32_16x16x32_bf16 v[92:95], a[120:123], a[136:139], v[92:95]
s_add_u32 s27, s27, 524288
ds_read_b128 a[20:23], v3 offset:4096
v_cvt_pk_bf16_f32 v73, v74, v75
v_mfma_f32_16x16x32_bf16 v[92:95], a[124:127], a[140:143], v[92:95]
s_waitcnt lgkmcnt(3)
v_cvt_pk_bf16_f32 v74, v76, v77
v_cvt_pk_bf16_f32 v75, v78, v79
v_mfma_f32_16x16x32_bf16 v[96:99], a[64:67], a[128:131], v[96:99]
s_add_u32 m0, s28, 49152
ds_read_b64_tr_b16 a[136:137], v7 offset:32768
v_cvt_pk_bf16_f32 v80, v80, v81
v_mfma_f32_16x16x32_bf16 v[96:99], a[68:71], a[132:135], v[96:99]
PAD_27:
s_cbranch_execz PAD_31
buffer_load_dwordx4 v12, s[8:11], s24 offen offset:0 lds
v_mfma_f32_16x16x32_bf16 v[100:103], a[72:75], a[128:131], v[100:103]
ds_read_b64_tr_b16 a[138:139], v7 offset:34816
v_cvt_pk_bf16_f32 v81, v82, v83
v_mfma_f32_16x16x32_bf16 v[100:103], a[76:79], a[132:135], v[100:103]
v_cvt_pk_bf16_f32 v82, v84, v85
v_cvt_pk_bf16_f32 v83, v86, v87
v_mfma_f32_16x16x32_bf16 v[104:107], a[80:83], a[128:131], v[104:107]
ds_read_b64_tr_b16 a[140:141], v7 offset:49152
v_cvt_pk_bf16_f32 v88, v88, v89
v_mfma_f32_16x16x32_bf16 v[104:107], a[84:87], a[132:135], v[104:107]
buffer_load_dwordx4 v13, s[8:11], s24 offen offset:1024 lds
v_mfma_f32_16x16x32_bf16 v[108:111], a[88:91], a[128:131], v[108:111]
ds_read_b64_tr_b16 a[142:143], v7 offset:51200
v_cvt_pk_bf16_f32 v89, v90, v91
v_mfma_f32_16x16x32_bf16 v[108:111], a[92:95], a[132:135], v[108:111]
v_cvt_pk_bf16_f32 v90, v92, v93
v_cvt_pk_bf16_f32 v91, v94, v95
v_mfma_f32_16x16x32_bf16 v[112:115], a[96:99], a[128:131], v[112:115]
v_cvt_pk_bf16_f32 v96, v96, v97
v_cvt_pk_bf16_f32 v97, v98, v99
v_mfma_f32_16x16x32_bf16 v[112:115], a[100:103], a[132:135], v[112:115]
buffer_load_dwordx4 v14, s[8:11], s24 offen offset:2048 lds
v_mfma_f32_16x16x32_bf16 v[116:119], a[104:107], a[128:131], v[116:119]
ds_read_b128 a[24:27], v2 offset:6144
v_cvt_pk_bf16_f32 v98, v100, v101
v_mfma_f32_16x16x32_bf16 v[116:119], a[108:111], a[132:135], v[116:119]
buffer_store_dwordx4 v[32:35], v1, s[4:7], s31 offen sc1
v_mfma_f32_16x16x32_bf16 v[120:123], a[112:115], a[128:131], v[120:123]
s_add_u32 s31, s31, s32
ds_read_b128 a[28:31], v3 offset:6144
v_cvt_pk_bf16_f32 v99, v102, v103
v_mfma_f32_16x16x32_bf16 v[120:123], a[116:119], a[132:135], v[120:123]
buffer_load_dwordx4 v15, s[8:11], s24 offen offset:3072 lds
v_mfma_f32_16x16x32_bf16 v[124:127], a[120:123], a[128:131], v[124:127]
s_add_u32 s24, s24, 128
v_cvt_pk_bf16_f32 v104, v104, v105
v_cvt_pk_bf16_f32 v105, v106, v107
v_mfma_f32_16x16x32_bf16 v[124:127], a[124:127], a[132:135], v[124:127]
s_waitcnt lgkmcnt(2)
v_cvt_pk_bf16_f32 v106, v108, v109
v_cvt_pk_bf16_f32 v107, v110, v111
v_mfma_f32_16x16x32_bf16 v[128:131], a[64:67], a[136:139], v[128:131]
ds_read_b64_tr_b16 a[128:129], v8 offset:32768
v_cvt_pk_bf16_f32 v112, v112, v113
v_mfma_f32_16x16x32_bf16 v[128:131], a[68:71], a[140:143], v[128:131]
v_cvt_pk_bf16_f32 v113, v114, v115
v_cvt_pk_bf16_f32 v114, v116, v117
v_mfma_f32_16x16x32_bf16 v[132:135], a[72:75], a[136:139], v[132:135]
ds_read_b64_tr_b16 a[130:131], v8 offset:34816
v_cvt_pk_bf16_f32 v115, v118, v119
v_mfma_f32_16x16x32_bf16 v[132:135], a[76:79], a[140:143], v[132:135]
buffer_store_dwordx4 v[40:43], v1, s[4:7], s31 offen sc1
v_mfma_f32_16x16x32_bf16 v[136:139], a[80:83], a[136:139], v[136:139]
s_add_u32 s31, s31, s33
ds_read_b64_tr_b16 a[132:133], v8 offset:49152
v_cvt_pk_bf16_f32 v120, v120, v121
v_mfma_f32_16x16x32_bf16 v[136:139], a[84:87], a[140:143], v[136:139]
v_cvt_pk_bf16_f32 v121, v122, v123
v_cvt_pk_bf16_f32 v122, v124, v125
v_mfma_f32_16x16x32_bf16 v[140:143], a[88:91], a[136:139], v[140:143]
ds_read_b64_tr_b16 a[134:135], v8 offset:51200
v_cvt_pk_bf16_f32 v123, v126, v127
v_mfma_f32_16x16x32_bf16 v[140:143], a[92:95], a[140:143], v[140:143]
v_mfma_f32_16x16x32_bf16 v[144:147], a[96:99], a[136:139], v[144:147]
ds_read_b128 a[32:35], v2 offset:8192
v_cvt_pk_bf16_f32 v128, v128, v129
v_mfma_f32_16x16x32_bf16 v[144:147], a[100:103], a[140:143], v[144:147]
v_cvt_pk_bf16_f32 v129, v130, v131
v_cvt_pk_bf16_f32 v130, v132, v133
v_mfma_f32_16x16x32_bf16 v[148:151], a[104:107], a[136:139], v[148:151]
v_cvt_pk_bf16_f32 v131, v134, v135
v_mfma_f32_16x16x32_bf16 v[148:151], a[108:111], a[140:143], v[148:151]
v_mfma_f32_16x16x32_bf16 v[152:155], a[112:115], a[136:139], v[152:155]
ds_read_b128 a[36:39], v3 offset:8192
v_cvt_pk_bf16_f32 v136, v136, v137
v_mfma_f32_16x16x32_bf16 v[152:155], a[116:119], a[140:143], v[152:155]
v_cvt_pk_bf16_f32 v137, v138, v139
v_cvt_pk_bf16_f32 v138, v140, v141
v_mfma_f32_16x16x32_bf16 v[156:159], a[120:123], a[136:139], v[156:159]
ds_read_b128 a[40:43], v2 offset:10240
v_cvt_pk_bf16_f32 v139, v142, v143
v_mfma_f32_16x16x32_bf16 v[156:159], a[124:127], a[140:143], v[156:159]
s_waitcnt lgkmcnt(3)
buffer_store_dwordx4 v[48:51], v1, s[4:7], s31 offen sc1
v_mfma_f32_16x16x32_bf16 v[160:163], a[64:67], a[128:131], v[160:163]
s_add_u32 s31, s31, s32
ds_read_b64_tr_b16 a[136:137], v9 offset:32768
v_cvt_pk_bf16_f32 v144, v144, v145
v_mfma_f32_16x16x32_bf16 v[160:163], a[68:71], a[132:135], v[160:163]
v_cvt_pk_bf16_f32 v145, v146, v147
v_cvt_pk_bf16_f32 v146, v148, v149
v_mfma_f32_16x16x32_bf16 v[164:167], a[72:75], a[128:131], v[164:167]
ds_read_b64_tr_b16 a[138:139], v9 offset:34816
v_cvt_pk_bf16_f32 v147, v150, v151
v_mfma_f32_16x16x32_bf16 v[164:167], a[76:79], a[132:135], v[164:167]
v_mfma_f32_16x16x32_bf16 v[168:171], a[80:83], a[128:131], v[168:171]
ds_read_b64_tr_b16 a[140:141], v9 offset:49152
v_cvt_pk_bf16_f32 v152, v152, v153
v_mfma_f32_16x16x32_bf16 v[168:171], a[84:87], a[132:135], v[168:171]
v_cvt_pk_bf16_f32 v153, v154, v155
v_cvt_pk_bf16_f32 v154, v156, v157
v_mfma_f32_16x16x32_bf16 v[172:175], a[88:91], a[128:131], v[172:175]
ds_read_b64_tr_b16 a[142:143], v9 offset:51200
v_cvt_pk_bf16_f32 v155, v158, v159
v_mfma_f32_16x16x32_bf16 v[172:175], a[92:95], a[132:135], v[172:175]
v_mfma_f32_16x16x32_bf16 v[176:179], a[96:99], a[128:131], v[176:179]
buffer_store_dwordx4 v[56:59], v1, s[4:7], s31 offen sc1
v_mfma_f32_16x16x32_bf16 v[176:179], a[100:103], a[132:135], v[176:179]
s_add_u32 s31, s31, s34
v_cvt_pk_bf16_f32 v160, v160, v161
v_cvt_pk_bf16_f32 v161, v162, v163
v_mfma_f32_16x16x32_bf16 v[180:183], a[104:107], a[128:131], v[180:183]
ds_read_b128 a[44:47], v3 offset:10240
v_cvt_pk_bf16_f32 v162, v164, v165
v_mfma_f32_16x16x32_bf16 v[180:183], a[108:111], a[132:135], v[180:183]
v_cvt_pk_bf16_f32 v163, v166, v167
v_mfma_f32_16x16x32_bf16 v[184:187], a[112:115], a[128:131], v[184:187]
ds_read_b128 a[48:51], v2 offset:12288
v_cvt_pk_bf16_f32 v168, v168, v169
v_mfma_f32_16x16x32_bf16 v[184:187], a[116:119], a[132:135], v[184:187]
v_cvt_pk_bf16_f32 v169, v170, v171
v_cvt_pk_bf16_f32 v170, v172, v173
v_mfma_f32_16x16x32_bf16 v[188:191], a[120:123], a[128:131], v[188:191]
v_cvt_pk_bf16_f32 v171, v174, v175
v_mfma_f32_16x16x32_bf16 v[188:191], a[124:127], a[132:135], v[188:191]
s_waitcnt lgkmcnt(2)
v_mfma_f32_16x16x32_bf16 v[192:195], a[64:67], a[136:139], v[192:195]
ds_read_b64_tr_b16 a[128:129], v10 offset:32768
v_cvt_pk_bf16_f32 v176, v176, v177
v_mfma_f32_16x16x32_bf16 v[192:195], a[68:71], a[140:143], v[192:195]
v_cvt_pk_bf16_f32 v177, v178, v179
v_cvt_pk_bf16_f32 v178, v180, v181
v_mfma_f32_16x16x32_bf16 v[196:199], a[72:75], a[136:139], v[196:199]
ds_read_b64_tr_b16 a[130:131], v10 offset:34816
v_cvt_pk_bf16_f32 v179, v182, v183
v_mfma_f32_16x16x32_bf16 v[196:199], a[76:79], a[140:143], v[196:199]
buffer_store_dwordx4 v[64:67], v1, s[4:7], s31 offen sc1
v_mfma_f32_16x16x32_bf16 v[200:203], a[80:83], a[136:139], v[200:203]
s_add_u32 s31, s31, s32
ds_read_b64_tr_b16 a[132:133], v10 offset:49152
v_cvt_pk_bf16_f32 v184, v184, v185
v_mfma_f32_16x16x32_bf16 v[200:203], a[84:87], a[140:143], v[200:203]
v_cvt_pk_bf16_f32 v185, v186, v187
v_cvt_pk_bf16_f32 v186, v188, v189
v_mfma_f32_16x16x32_bf16 v[204:207], a[88:91], a[136:139], v[204:207]
ds_read_b64_tr_b16 a[134:135], v10 offset:51200
v_cvt_pk_bf16_f32 v187, v190, v191
v_mfma_f32_16x16x32_bf16 v[204:207], a[92:95], a[140:143], v[204:207]
v_mfma_f32_16x16x32_bf16 v[208:211], a[96:99], a[136:139], v[208:211]
ds_read_b128 a[52:55], v3 offset:12288
v_cvt_pk_bf16_f32 v192, v192, v193
v_mfma_f32_16x16x32_bf16 v[208:211], a[100:103], a[140:143], v[208:211]
v_cvt_pk_bf16_f32 v193, v194, v195
v_cvt_pk_bf16_f32 v194, v196, v197
v_mfma_f32_16x16x32_bf16 v[212:215], a[104:107], a[136:139], v[212:215]
ds_read_b128 a[56:59], v2 offset:14336
v_cvt_pk_bf16_f32 v195, v198, v199
v_mfma_f32_16x16x32_bf16 v[212:215], a[108:111], a[140:143], v[212:215]
v_mfma_f32_16x16x32_bf16 v[216:219], a[112:115], a[136:139], v[216:219]
v_cvt_pk_bf16_f32 v200, v200, v201
v_cvt_pk_bf16_f32 v201, v202, v203
v_mfma_f32_16x16x32_bf16 v[216:219], a[116:119], a[140:143], v[216:219]
buffer_store_dwordx4 v[72:75], v1, s[4:7], s31 offen sc1
v_mfma_f32_16x16x32_bf16 v[220:223], a[120:123], a[136:139], v[220:223]
s_add_u32 s31, s31, s33
ds_read_b128 a[60:63], v3 offset:14336
v_cvt_pk_bf16_f32 v202, v204, v205
v_mfma_f32_16x16x32_bf16 v[220:223], a[124:127], a[140:143], v[220:223]
s_waitcnt lgkmcnt(3)
v_cvt_pk_bf16_f32 v203, v206, v207
v_mfma_f32_16x16x32_bf16 a[192:195], a[64:67], a[128:131], a[192:195]
ds_read_b64_tr_b16 a[136:137], v11 offset:32768
v_cvt_pk_bf16_f32 v208, v208, v209
v_mfma_f32_16x16x32_bf16 a[192:195], a[68:71], a[132:135], a[192:195]
v_cvt_pk_bf16_f32 v209, v210, v211
v_cvt_pk_bf16_f32 v210, v212, v213
v_mfma_f32_16x16x32_bf16 a[196:199], a[72:75], a[128:131], a[196:199]
ds_read_b64_tr_b16 a[138:139], v11 offset:34816
v_cvt_pk_bf16_f32 v211, v214, v215
v_mfma_f32_16x16x32_bf16 a[196:199], a[76:79], a[132:135], a[196:199]
v_mfma_f32_16x16x32_bf16 a[200:203], a[80:83], a[128:131], a[200:203]
ds_read_b64_tr_b16 a[140:141], v11 offset:49152
v_cvt_pk_bf16_f32 v216, v216, v217
v_mfma_f32_16x16x32_bf16 a[200:203], a[84:87], a[132:135], a[200:203]
v_cvt_pk_bf16_f32 v217, v218, v219
v_cvt_pk_bf16_f32 v218, v220, v221
v_mfma_f32_16x16x32_bf16 a[204:207], a[88:91], a[128:131], a[204:207]
ds_read_b64_tr_b16 a[142:143], v11 offset:51200
v_cvt_pk_bf16_f32 v219, v222, v223
v_mfma_f32_16x16x32_bf16 a[204:207], a[92:95], a[132:135], a[204:207]
v_mfma_f32_16x16x32_bf16 a[208:211], a[96:99], a[128:131], a[208:211]
buffer_store_dwordx4 v[80:83], v1, s[4:7], s31 offen sc1
v_mfma_f32_16x16x32_bf16 a[208:211], a[100:103], a[132:135], a[208:211]
s_add_u32 s31, s31, s32
v_mfma_f32_16x16x32_bf16 a[212:215], a[104:107], a[128:131], a[212:215]
v_mfma_f32_16x16x32_bf16 a[212:215], a[108:111], a[132:135], a[212:215]
v_mfma_f32_16x16x32_bf16 a[216:219], a[112:115], a[128:131], a[216:219]
v_mfma_f32_16x16x32_bf16 a[216:219], a[116:119], a[132:135], a[216:219]
v_mfma_f32_16x16x32_bf16 a[220:223], a[120:123], a[128:131], a[220:223]
s_waitcnt vmcnt(23) lgkmcnt(0)
v_mfma_f32_16x16x32_bf16 a[220:223], a[124:127], a[132:135], a[220:223]
s_barrier
v_mfma_f32_16x16x32_bf16 a[224:227], a[64:67], a[136:139], a[224:227]
s_add_u32 m0, s29, 98304
ds_read_b64_tr_b16 a[128:129], v22 offset:0
v_mfma_f32_16x16x32_bf16 a[224:227], a[68:71], a[140:143], a[224:227]
buffer_load_dwordx4 v16, s[12:15], s26 offen offset:0 lds
v_mfma_f32_16x16x32_bf16 a[228:231], a[72:75], a[136:139], a[228:231]
ds_read_b64_tr_b16 a[130:131], v22 offset:2048
v_mfma_f32_16x16x32_bf16 a[228:231], a[76:79], a[140:143], a[228:231]
buffer_store_dwordx4 v[88:91], v1, s[4:7], s31 offen sc1
v_mfma_f32_16x16x32_bf16 a[232:235], a[80:83], a[136:139], a[232:235]
s_add_u32 s31, s31, s35
ds_read_b64_tr_b16 a[132:133], v22 offset:16384
v_mfma_f32_16x16x32_bf16 a[232:235], a[84:87], a[140:143], a[232:235]
buffer_load_dwordx4 v17, s[12:15], s26 offen offset:1024 lds
v_mfma_f32_16x16x32_bf16 a[236:239], a[88:91], a[136:139], a[236:239]
ds_read_b64_tr_b16 a[134:135], v22 offset:18432
v_add_u32 v22, 4294901760, v22
v_mfma_f32_16x16x32_bf16 a[236:239], a[92:95], a[140:143], a[236:239]
v_mfma_f32_16x16x32_bf16 a[240:243], a[96:99], a[136:139], a[240:243]
v_mfma_f32_16x16x32_bf16 a[240:243], a[100:103], a[140:143], a[240:243]
buffer_load_dwordx4 v18, s[12:15], s26 offen offset:2048 lds
v_mfma_f32_16x16x32_bf16 a[244:247], a[104:107], a[136:139], a[244:247]
v_mfma_f32_16x16x32_bf16 a[244:247], a[108:111], a[140:143], a[244:247]
v_mfma_f32_16x16x32_bf16 a[248:251], a[112:115], a[136:139], a[248:251]
v_mfma_f32_16x16x32_bf16 a[248:251], a[116:119], a[140:143], a[248:251]
buffer_load_dwordx4 v19, s[12:15], s26 offen offset:3072 lds
v_mfma_f32_16x16x32_bf16 a[252:255], a[120:123], a[136:139], a[252:255]
s_add_u32 s26, s26, 524288
v_mfma_f32_16x16x32_bf16 a[252:255], a[124:127], a[140:143], a[252:255]
s_waitcnt lgkmcnt(0)
s_cmp_ge_u32 s21, 7
s_cbranch_scc1 M_Q
M_conv:
v_mfma_f32_16x16x32_bf16 v[36:39], a[128:131], a[0:3], 0
s_add_u32 m0, s29, 114688
ds_read_b64_tr_b16 a[136:137], v23 offset:0
v_mfma_f32_16x16x32_bf16 v[36:39], a[132:135], a[4:7], v[36:39]
buffer_load_dwordx4 v16, s[12:15], s27 offen offset:0 lds
v_mfma_f32_16x16x32_bf16 v[44:47], a[128:131], a[8:11], 0
ds_read_b64_tr_b16 a[138:139], v23 offset:2048
v_mfma_f32_16x16x32_bf16 v[44:47], a[132:135], a[12:15], v[44:47]
ds_read_b128 a[64:67], v2 offset:16384
ds_read_b128 a[68:71], v3 offset:16384
v_mfma_f32_16x16x32_bf16 v[52:55], a[128:131], a[16:19], 0
ds_read_b64_tr_b16 a[140:141], v23 offset:16384
v_mfma_f32_16x16x32_bf16 v[52:55], a[132:135], a[20:23], v[52:55]
buffer_load_dwordx4 v17, s[12:15], s27 offen offset:1024 lds
v_mfma_f32_16x16x32_bf16 v[60:63], a[128:131], a[24:27], 0
ds_read_b64_tr_b16 a[142:143], v23 offset:18432
v_add_u32 v23, 4294901760, v23
v_mfma_f32_16x16x32_bf16 v[60:63], a[132:135], a[28:31], v[60:63]
buffer_store_dwordx4 v[96:99], v1, s[4:7], s31 offen sc1
v_mfma_f32_16x16x32_bf16 v[68:71], a[128:131], a[32:35], 0
s_add_u32 s31, s31, s32
ds_read_b128 a[72:75], v2 offset:18432
v_mfma_f32_16x16x32_bf16 v[68:71], a[132:135], a[36:39], v[68:71]
buffer_load_dwordx4 v18, s[12:15], s27 offen offset:2048 lds
v_mfma_f32_16x16x32_bf16 v[76:79], a[128:131], a[40:43], 0
ds_read_b128 a[76:79], v3 offset:18432
v_mfma_f32_16x16x32_bf16 v[76:79], a[132:135], a[44:47], v[76:79]
ds_read_b128 a[80:83], v2 offset:20480
v_mfma_f32_16x16x32_bf16 v[84:87], a[128:131], a[48:51], 0
ds_read_b128 a[84:87], v3 offset:20480
v_mfma_f32_16x16x32_bf16 v[84:87], a[132:135], a[52:55], v[84:87]
buffer_load_dwordx4 v19, s[12:15], s27 offen offset:3072 lds
v_mfma_f32_16x16x32_bf16 v[92:95], a[128:131], a[56:59], 0
s_add_u32 s27, s27, 524288
ds_read_b128 a[88:91], v2 offset:22528
v_mfma_f32_16x16x32_bf16 v[92:95], a[132:135], a[60:63], v[92:95]
s_waitcnt lgkmcnt(5)
buffer_store_dwordx4 v[104:107], v1, s[4:7], s31 offen sc1
v_mfma_f32_16x16x32_bf16 v[100:103], a[136:139], a[0:3], 0
s_add_u32 m0, s28, 0
ds_read_b64_tr_b16 a[128:129], v24 offset:0
v_mfma_f32_16x16x32_bf16 v[100:103], a[140:143], a[4:7], v[100:103]
s_add_u32 s31, s31, s33
buffer_load_dwordx4 v12, s[8:11], s24 offen offset:0 lds
v_mfma_f32_16x16x32_bf16 v[108:111], a[136:139], a[8:11], 0
ds_read_b64_tr_b16 a[130:131], v24 offset:2048
v_mfma_f32_16x16x32_bf16 v[108:111], a[140:143], a[12:15], v[108:111]
ds_read_b128 a[92:95], v3 offset:22528
v_mfma_f32_16x16x32_bf16 v[116:119], a[136:139], a[16:19], 0
ds_read_b64_tr_b16 a[132:133], v24 offset:16384
v_mfma_f32_16x16x32_bf16 v[116:119], a[140:143], a[20:23], v[116:119]
buffer_load_dwordx4 v13, s[8:11], s24 offen offset:1024 lds
v_mfma_f32_16x16x32_bf16 v[124:127], a[136:139], a[24:27], 0
ds_read_b64_tr_b16 a[134:135], v24 offset:18432
v_add_u32 v24, 4294901760, v24
v_mfma_f32_16x16x32_bf16 v[124:127], a[140:143], a[28:31], v[124:127]
v_mfma_f32_16x16x32_bf16 v[132:135], a[136:139], a[32:35], 0
ds_read_b128 a[96:99], v2 offset:24576
v_mfma_f32_16x16x32_bf16 v[132:135], a[140:143], a[36:39], v[132:135]
buffer_load_dwordx4 v14, s[8:11], s24 offen offset:2048 lds
v_mfma_f32_16x16x32_bf16 v[140:143], a[136:139], a[40:43], 0
ds_read_b128 a[100:103], v3 offset:24576
v_mfma_f32_16x16x32_bf16 v[140:143], a[140:143], a[44:47], v[140:143]
ds_read_b128 a[104:107], v2 offset:26624
v_mfma_f32_16x16x32_bf16 v[148:151], a[136:139], a[48:51], 0
ds_read_b128 a[108:111], v3 offset:26624
v_mfma_f32_16x16x32_bf16 v[148:151], a[140:143], a[52:55], v[148:151]
buffer_load_dwordx4 v15, s[8:11], s24 offen offset:3072 lds
v_mfma_f32_16x16x32_bf16 v[156:159], a[136:139], a[56:59], 0
s_add_u32 s24, s24, 128
ds_read_b128 a[112:115], v2 offset:28672
v_mfma_f32_16x16x32_bf16 v[156:159], a[140:143], a[60:63], v[156:159]
s_waitcnt lgkmcnt(5)
buffer_store_dwordx4 v[112:115], v1, s[4:7], s31 offen sc1
v_mfma_f32_16x16x32_bf16 v[164:167], a[128:131], a[0:3], 0
s_add_u32 s31, s31, s32
ds_read_b64_tr_b16 a[136:137], v25 offset:0
v_mfma_f32_16x16x32_bf16 v[164:167], a[132:135], a[4:7], v[164:167]
v_mfma_f32_16x16x32_bf16 v[172:175], a[128:131], a[8:11], 0
ds_read_b64_tr_b16 a[138:139], v25 offset:2048
v_mfma_f32_16x16x32_bf16 v[172:175], a[132:135], a[12:15], v[172:175]
ds_read_b128 a[116:119], v3 offset:28672
v_mfma_f32_16x16x32_bf16 v[180:183], a[128:131], a[16:19], 0
ds_read_b64_tr_b16 a[140:141], v25 offset:16384
v_mfma_f32_16x16x32_bf16 v[180:183], a[132:135], a[20:23], v[180:183]
v_mfma_f32_16x16x32_bf16 v[188:191], a[128:131], a[24:27], 0
ds_read_b64_tr_b16 a[142:143], v25 offset:18432
v_add_u32 v25, 4294901760, v25
v_mfma_f32_16x16x32_bf16 v[188:191], a[132:135], a[28:31], v[188:191]
v_mfma_f32_16x16x32_bf16 v[196:199], a[128:131], a[32:35], 0
ds_read_b128 a[120:123], v2 offset:30720
v_mfma_f32_16x16x32_bf16 v[196:199], a[132:135], a[36:39], v[196:199]
v_mfma_f32_16x16x32_bf16 v[204:207], a[128:131], a[40:43], 0
ds_read_b128 a[124:127], v3 offset:30720
v_mfma_f32_16x16x32_bf16 v[204:207], a[132:135], a[44:47], v[204:207]
v_mfma_f32_16x16x32_bf16 v[212:215], a[128:131], a[48:51], 0
v_mfma_f32_16x16x32_bf16 v[212:215], a[132:135], a[52:55], v[212:215]
buffer_store_dwordx4 v[120:123], v1, s[4:7], s31 offen sc1
v_mfma_f32_16x16x32_bf16 v[220:223], a[128:131], a[56:59], 0
s_add_u32 s31, s31, s34
v_mfma_f32_16x16x32_bf16 v[220:223], a[132:135], a[60:63], v[220:223]
s_waitcnt vmcnt(28) lgkmcnt(0)
s_barrier
v_mfma_f32_16x16x32_bf16 v[224:227], a[136:139], a[0:3], 0
s_add_u32 m0, s29, 131072
ds_read_b64_tr_b16 a[128:129], v22 offset:0
v_mfma_f32_16x16x32_bf16 v[224:227], a[140:143], a[4:7], v[224:227]
buffer_load_dwordx4 v16, s[12:15], s26 offen offset:0 lds
v_mfma_f32_16x16x32_bf16 v[228:231], a[136:139], a[8:11], 0
ds_read_b64_tr_b16 a[130:131], v22 offset:2048
v_mfma_f32_16x16x32_bf16 v[228:231], a[140:143], a[12:15], v[228:231]
v_mfma_f32_16x16x32_bf16 v[232:235], a[136:139], a[16:19], 0
ds_read_b64_tr_b16 a[132:133], v22 offset:16384
v_mfma_f32_16x16x32_bf16 v[232:235], a[140:143], a[20:23], v[232:235]
buffer_load_dwordx4 v17, s[12:15], s26 offen offset:1024 lds
v_mfma_f32_16x16x32_bf16 v[236:239], a[136:139], a[24:27], 0
ds_read_b64_tr_b16 a[134:135], v22 offset:18432
v_add_u32 v22, 32768, v22
v_mfma_f32_16x16x32_bf16 v[236:239], a[140:143], a[28:31], v[236:239]
v_mfma_f32_16x16x32_bf16 v[240:243], a[136:139], a[32:35], 0
v_mfma_f32_16x16x32_bf16 v[240:243], a[140:143], a[36:39], v[240:243]
buffer_load_dwordx4 v18, s[12:15], s26 offen offset:2048 lds
v_mfma_f32_16x16x32_bf16 v[244:247], a[136:139], a[40:43], 0
v_mfma_f32_16x16x32_bf16 v[244:247], a[140:143], a[44:47], v[244:247]
v_mfma_f32_16x16x32_bf16 v[248:251], a[136:139], a[48:51], 0
v_mfma_f32_16x16x32_bf16 v[248:251], a[140:143], a[52:55], v[248:251]
buffer_load_dwordx4 v19, s[12:15], s26 offen offset:3072 lds
v_mfma_f32_16x16x32_bf16 v[252:255], a[136:139], a[56:59], 0
s_add_u32 s26, s26, 524288
v_mfma_f32_16x16x32_bf16 v[252:255], a[140:143], a[60:63], v[252:255]
s_waitcnt lgkmcnt(0)
v_mfma_f32_16x16x32_bf16 v[36:39], a[128:131], a[64:67], v[36:39]
s_add_u32 m0, s29, 147456
ds_read_b64_tr_b16 a[136:137], v23 offset:0
v_mfma_f32_16x16x32_bf16 v[36:39], a[132:135], a[68:71], v[36:39]
buffer_load_dwordx4 v16, s[12:15], s27 offen offset:0 lds
v_mfma_f32_16x16x32_bf16 v[44:47], a[128:131], a[72:75], v[44:47]
ds_read_b64_tr_b16 a[138:139], v23 offset:2048
v_mfma_f32_16x16x32_bf16 v[44:47], a[132:135], a[76:79], v[44:47]
ds_read_b128 a[0:3], v2 offset:32768
ds_read_b128 a[4:7], v3 offset:32768
v_mfma_f32_16x16x32_bf16 v[52:55], a[128:131], a[80:83], v[52:55]
ds_read_b64_tr_b16 a[140:141], v23 offset:16384
v_mfma_f32_16x16x32_bf16 v[52:55], a[132:135], a[84:87], v[52:55]
buffer_load_dwordx4 v17, s[12:15], s27 offen offset:1024 lds
v_mfma_f32_16x16x32_bf16 v[60:63], a[128:131], a[88:91], v[60:63]
ds_read_b64_tr_b16 a[142:143], v23 offset:18432
v_add_u32 v23, 32768, v23
v_mfma_f32_16x16x32_bf16 v[60:63], a[132:135], a[92:95], v[60:63]
buffer_store_dwordx4 v[128:131], v1, s[4:7], s31 offen sc1
v_mfma_f32_16x16x32_bf16 v[68:71], a[128:131], a[96:99], v[68:71]
s_add_u32 s31, s31, s32
ds_read_b128 a[8:11], v2 offset:34816
v_accvgpr_read_b32 v32, a192
v_mfma_f32_16x16x32_bf16 v[68:71], a[132:135], a[100:103], v[68:71]
buffer_load_dwordx4 v18, s[12:15], s27 offen offset:2048 lds
v_mfma_f32_16x16x32_bf16 v[76:79], a[128:131], a[104:107], v[76:79]
ds_read_b128 a[12:15], v3 offset:34816
v_accvgpr_read_b32 v33, a193
v_mfma_f32_16x16x32_bf16 v[76:79], a[132:135], a[108:111], v[76:79]
ds_read_b128 a[16:19], v2 offset:36864
v_accvgpr_read_b32 v34, a194
v_mfma_f32_16x16x32_bf16 v[84:87], a[128:131], a[112:115], v[84:87]
ds_read_b128 a[20:23], v3 offset:36864
v_accvgpr_read_b32 v35, a195
v_mfma_f32_16x16x32_bf16 v[84:87], a[132:135], a[116:119], v[84:87]
buffer_load_dwordx4 v19, s[12:15], s27 offen offset:3072 lds
v_mfma_f32_16x16x32_bf16 v[92:95], a[128:131], a[120:123], v[92:95]
s_add_u32 s27, s27, 524288
ds_read_b128 a[24:27], v2 offset:38912
v_accvgpr_read_b32 v96, a196
v_mfma_f32_16x16x32_bf16 v[92:95], a[132:135], a[124:127], v[92:95]
s_waitcnt lgkmcnt(5)
buffer_store_dwordx4 v[136:139], v1, s[4:7], s31 offen sc1
v_mfma_f32_16x16x32_bf16 v[100:103], a[136:139], a[64:67], v[100:103]
s_add_u32 m0, s28, 16384
ds_read_b64_tr_b16 a[128:129], v24 offset:0
v_accvgpr_read_b32 v97, a197
v_mfma_f32_16x16x32_bf16 v[100:103], a[140:143], a[68:71], v[100:103]
s_add_u32 s31, s31, s33
buffer_load_dwordx4 v12, s[8:11], s24 offen offset:0 lds
v_mfma_f32_16x16x32_bf16 v[108:111], a[136:139], a[72:75], v[108:111]
ds_read_b64_tr_b16 a[130:131], v24 offset:2048
v_accvgpr_read_b32 v98, a198
v_mfma_f32_16x16x32_bf16 v[108:111], a[140:143], a[76:79], v[108:111]
ds_read_b128 a[28:31], v3 offset:38912
v_accvgpr_read_b32 v99, a199
v_mfma_f32_16x16x32_bf16 v[116:119], a[136:139], a[80:83], v[116:119]
ds_read_b64_tr_b16 a[132:133], v24 offset:16384
v_cvt_pk_bf16_f32 v32, v32, v33
v_mfma_f32_16x16x32_bf16 v[116:119], a[140:143], a[84:87], v[116:119]
buffer_load_dwordx4 v13, s[8:11], s24 offen offset:1024 lds
v_mfma_f32_16x16x32_bf16 v[124:127], a[136:139], a[88:91], v[124:127]
ds_read_b64_tr_b16 a[134:135], v24 offset:18432
v_add_u32 v24, 32768, v24
v_mfma_f32_16x16x32_bf16 v[124:127], a[140:143], a[92:95], v[124:127]
v_cvt_pk_bf16_f32 v33, v34, v35
v_cvt_pk_bf16_f32 v34, v96, v97
v_mfma_f32_16x16x32_bf16 v[132:135], a[136:139], a[96:99], v[132:135]
ds_read_b128 a[32:35], v2 offset:40960
v_cvt_pk_bf16_f32 v35, v98, v99
v_mfma_f32_16x16x32_bf16 v[132:135], a[140:143], a[100:103], v[132:135]
buffer_load_dwordx4 v14, s[8:11], s24 offen offset:2048 lds
v_mfma_f32_16x16x32_bf16 v[140:143], a[136:139], a[104:107], v[140:143]
ds_read_b128 a[36:39], v3 offset:40960
v_accvgpr_read_b32 v40, a200
v_mfma_f32_16x16x32_bf16 v[140:143], a[140:143], a[108:111], v[140:143]
ds_read_b128 a[40:43], v2 offset:43008
v_accvgpr_read_b32 v41, a201
v_mfma_f32_16x16x32_bf16 v[148:151], a[136:139], a[112:115], v[148:151]
ds_read_b128 a[44:47], v3 offset:43008
v_accvgpr_read_b32 v42, a202
v_mfma_f32_16x16x32_bf16 v[148:151], a[140:143], a[116:119], v[148:151]
buffer_load_dwordx4 v15, s[8:11], s24 offen offset:3072 lds
v_mfma_f32_16x16x32_bf16 v[156:159], a[136:139], a[120:123], v[156:159]
s_add_u32 s24, s24, 128
ds_read_b128 a[48:51], v2 offset:45056
v_accvgpr_read_b32 v43, a203
v_mfma_f32_16x16x32_bf16 v[156:159], a[140:143], a[124:127], v[156:159]
s_waitcnt lgkmcnt(5)
buffer_store_dwordx4 v[144:147], v1, s[4:7], s31 offen sc1
v_mfma_f32_16x16x32_bf16 v[164:167], a[128:131], a[64:67], v[164:167]
s_add_u32 s31, s31, s32
ds_read_b64_tr_b16 a[136:137], v25 offset:0
v_accvgpr_read_b32 v96, a204
v_mfma_f32_16x16x32_bf16 v[164:167], a[132:135], a[68:71], v[164:167]
v_accvgpr_read_b32 v97, a205
v_accvgpr_read_b32 v98, a206
v_mfma_f32_16x16x32_bf16 v[172:175], a[128:131], a[72:75], v[172:175]
ds_read_b64_tr_b16 a[138:139], v25 offset:2048
v_accvgpr_read_b32 v99, a207
v_mfma_f32_16x16x32_bf16 v[172:175], a[132:135], a[76:79], v[172:175]
ds_read_b128 a[52:55], v3 offset:45056
v_cvt_pk_bf16_f32 v40, v40, v41
v_mfma_f32_16x16x32_bf16 v[180:183], a[128:131], a[80:83], v[180:183]
ds_read_b64_tr_b16 a[140:141], v25 offset:16384
v_cvt_pk_bf16_f32 v41, v42, v43
v_mfma_f32_16x16x32_bf16 v[180:183], a[132:135], a[84:87], v[180:183]
v_cvt_pk_bf16_f32 v42, v96, v97
v_cvt_pk_bf16_f32 v43, v98, v99
v_mfma_f32_16x16x32_bf16 v[188:191], a[128:131], a[88:91], v[188:191]
ds_read_b64_tr_b16 a[142:143], v25 offset:18432
v_add_u32 v25, 32768, v25
v_mfma_f32_16x16x32_bf16 v[188:191], a[132:135], a[92:95], v[188:191]
v_accvgpr_read_b32 v48, a208
v_accvgpr_read_b32 v49, a209
v_mfma_f32_16x16x32_bf16 v[196:199], a[128:131], a[96:99], v[196:199]
ds_read_b128 a[56:59], v2 offset:47104
v_accvgpr_read_b32 v50, a210
v_mfma_f32_16x16x32_bf16 v[196:199], a[132:135], a[100:103], v[196:199]
v_accvgpr_read_b32 v51, a211
v_accvgpr_read_b32 v96, a212
v_mfma_f32_16x16x32_bf16 v[204:207], a[128:131], a[104:107], v[204:207]
ds_read_b128 a[60:63], v3 offset:47104
v_accvgpr_read_b32 v97, a213
v_mfma_f32_16x16x32_bf16 v[204:207], a[132:135], a[108:111], v[204:207]
v_accvgpr_read_b32 v98, a214
v_accvgpr_read_b32 v99, a215
v_mfma_f32_16x16x32_bf16 v[212:215], a[128:131], a[112:115], v[212:215]
v_cvt_pk_bf16_f32 v48, v48, v49
v_cvt_pk_bf16_f32 v49, v50, v51
v_mfma_f32_16x16x32_bf16 v[212:215], a[132:135], a[116:119], v[212:215]
buffer_store_dwordx4 v[152:155], v1, s[4:7], s31 offen sc1
v_mfma_f32_16x16x32_bf16 v[220:223], a[128:131], a[120:123], v[220:223]
s_add_u32 s31, s31, s36
v_cvt_pk_bf16_f32 v50, v96, v97
v_cvt_pk_bf16_f32 v51, v98, v99
v_mfma_f32_16x16x32_bf16 v[220:223], a[132:135], a[124:127], v[220:223]
s_waitcnt vmcnt(23) lgkmcnt(0)
s_barrier
v_accvgpr_read_b32 v56, a216
v_mfma_f32_16x16x32_bf16 v[224:227], a[136:139], a[64:67], v[224:227]
s_add_u32 m0, s29, 65536
ds_read_b64_tr_b16 a[128:129], v22 offset:0
v_accvgpr_read_b32 v57, a217
v_mfma_f32_16x16x32_bf16 v[224:227], a[140:143], a[68:71], v[224:227]
buffer_load_dwordx4 v16, s[12:15], s26 offen offset:0 lds
v_mfma_f32_16x16x32_bf16 v[228:231], a[136:139], a[72:75], v[228:231]
ds_read_b64_tr_b16 a[130:131], v22 offset:2048
v_accvgpr_read_b32 v58, a218
v_mfma_f32_16x16x32_bf16 v[228:231], a[140:143], a[76:79], v[228:231]
v_accvgpr_read_b32 v59, a219
v_accvgpr_read_b32 v96, a220
v_mfma_f32_16x16x32_bf16 v[232:235], a[136:139], a[80:83], v[232:235]
ds_read_b64_tr_b16 a[132:133], v22 offset:16384
v_accvgpr_read_b32 v97, a221
v_mfma_f32_16x16x32_bf16 v[232:235], a[140:143], a[84:87], v[232:235]
buffer_load_dwordx4 v17, s[12:15], s26 offen offset:1024 lds
v_mfma_f32_16x16x32_bf16 v[236:239], a[136:139], a[88:91], v[236:239]
ds_read_b64_tr_b16 a[134:135], v22 offset:18432
v_add_u32 v22, 32768, v22
v_mfma_f32_16x16x32_bf16 v[236:239], a[140:143], a[92:95], v[236:239]
v_accvgpr_read_b32 v98, a222
v_accvgpr_read_b32 v99, a223
v_mfma_f32_16x16x32_bf16 v[240:243], a[136:139], a[96:99], v[240:243]
PAD_28:
s_cbranch_execz M_tret
v_cvt_pk_bf16_f32 v56, v56, v57
v_cvt_pk_bf16_f32 v57, v58, v59
v_mfma_f32_16x16x32_bf16 v[240:243], a[140:143], a[100:103], v[240:243]
buffer_load_dwordx4 v18, s[12:15], s26 offen offset:2048 lds
v_mfma_f32_16x16x32_bf16 v[244:247], a[136:139], a[104:107], v[244:247]
v_cvt_pk_bf16_f32 v58, v96, v97
v_cvt_pk_bf16_f32 v59, v98, v99
v_mfma_f32_16x16x32_bf16 v[244:247], a[140:143], a[108:111], v[244:247]
v_accvgpr_read_b32 v64, a224
v_accvgpr_read_b32 v65, a225
v_mfma_f32_16x16x32_bf16 v[248:251], a[136:139], a[112:115], v[248:251]
v_accvgpr_read_b32 v66, a226
v_accvgpr_read_b32 v67, a227
v_mfma_f32_16x16x32_bf16 v[248:251], a[140:143], a[116:119], v[248:251]
buffer_load_dwordx4 v19, s[12:15], s26 offen offset:3072 lds
v_mfma_f32_16x16x32_bf16 v[252:255], a[136:139], a[120:123], v[252:255]
s_add_u32 s26, s26, 524288
v_accvgpr_read_b32 v96, a228
v_accvgpr_read_b32 v97, a229
v_mfma_f32_16x16x32_bf16 v[252:255], a[140:143], a[124:127], v[252:255]
s_waitcnt lgkmcnt(0)
v_accvgpr_read_b32 v98, a230
v_accvgpr_read_b32 v99, a231
v_mfma_f32_16x16x32_bf16 v[36:39], a[128:131], a[0:3], v[36:39]
s_add_u32 m0, s29, 81920
ds_read_b64_tr_b16 a[136:137], v23 offset:0
v_cvt_pk_bf16_f32 v64, v64, v65
v_mfma_f32_16x16x32_bf16 v[36:39], a[132:135], a[4:7], v[36:39]
buffer_load_dwordx4 v16, s[12:15], s27 offen offset:0 lds
v_mfma_f32_16x16x32_bf16 v[44:47], a[128:131], a[8:11], v[44:47]
ds_read_b64_tr_b16 a[138:139], v23 offset:2048
v_cvt_pk_bf16_f32 v65, v66, v67
v_mfma_f32_16x16x32_bf16 v[44:47], a[132:135], a[12:15], v[44:47]
ds_read_b128 a[64:67], v2 offset:49152
ds_read_b128 a[68:71], v3 offset:49152
v_mfma_f32_16x16x32_bf16 v[52:55], a[128:131], a[16:19], v[52:55]
ds_read_b64_tr_b16 a[140:141], v23 offset:16384
v_cvt_pk_bf16_f32 v66, v96, v97
v_mfma_f32_16x16x32_bf16 v[52:55], a[132:135], a[20:23], v[52:55]
buffer_load_dwordx4 v17, s[12:15], s27 offen offset:1024 lds
v_mfma_f32_16x16x32_bf16 v[60:63], a[128:131], a[24:27], v[60:63]
ds_read_b64_tr_b16 a[142:143], v23 offset:18432
v_add_u32 v23, 32768, v23
v_mfma_f32_16x16x32_bf16 v[60:63], a[132:135], a[28:31], v[60:63]
buffer_store_dwordx4 v[160:163], v1, s[4:7], s31 offen sc1
v_mfma_f32_16x16x32_bf16 v[68:71], a[128:131], a[32:35], v[68:71]
s_add_u32 s31, s31, s32
ds_read_b128 a[72:75], v2 offset:51200
v_cvt_pk_bf16_f32 v67, v98, v99
v_mfma_f32_16x16x32_bf16 v[68:71], a[132:135], a[36:39], v[68:71]
buffer_load_dwordx4 v18, s[12:15], s27 offen offset:2048 lds
v_mfma_f32_16x16x32_bf16 v[76:79], a[128:131], a[40:43], v[76:79]
ds_read_b128 a[76:79], v3 offset:51200
v_accvgpr_read_b32 v72, a232
v_mfma_f32_16x16x32_bf16 v[76:79], a[132:135], a[44:47], v[76:79]
ds_read_b128 a[80:83], v2 offset:53248
v_accvgpr_read_b32 v73, a233
v_mfma_f32_16x16x32_bf16 v[84:87], a[128:131], a[48:51], v[84:87]
ds_read_b128 a[84:87], v3 offset:53248
v_accvgpr_read_b32 v74, a234
v_mfma_f32_16x16x32_bf16 v[84:87], a[132:135], a[52:55], v[84:87]
buffer_load_dwordx4 v19, s[12:15], s27 offen offset:3072 lds
v_mfma_f32_16x16x32_bf16 v[92:95], a[128:131], a[56:59], v[92:95]
s_add_u32 s27, s27, 524288
ds_read_b128 a[88:91], v2 offset:55296
v_accvgpr_read_b32 v75, a235
v_mfma_f32_16x16x32_bf16 v[92:95], a[132:135], a[60:63], v[92:95]
s_waitcnt lgkmcnt(5)
buffer_store_dwordx4 v[168:171], v1, s[4:7], s31 offen sc1
v_mfma_f32_16x16x32_bf16 v[100:103], a[136:139], a[0:3], v[100:103]
s_add_u32 m0, s28, 32768
ds_read_b64_tr_b16 a[128:129], v24 offset:0
v_accvgpr_read_b32 v96, a236
v_mfma_f32_16x16x32_bf16 v[100:103], a[140:143], a[4:7], v[100:103]
s_add_u32 s31, s31, s33
buffer_load_dwordx4 v12, s[8:11], s24 offen offset:0 lds
v_mfma_f32_16x16x32_bf16 v[108:111], a[136:139], a[8:11], v[108:111]
ds_read_b64_tr_b16 a[130:131], v24 offset:2048
v_accvgpr_read_b32 v97, a237
v_mfma_f32_16x16x32_bf16 v[108:111], a[140:143], a[12:15], v[108:111]
ds_read_b128 a[92:95], v3 offset:55296
v_accvgpr_read_b32 v98, a238
v_mfma_f32_16x16x32_bf16 v[116:119], a[136:139], a[16:19], v[116:119]
ds_read_b64_tr_b16 a[132:133], v24 offset:16384
v_accvgpr_read_b32 v99, a239
v_mfma_f32_16x16x32_bf16 v[116:119], a[140:143], a[20:23], v[116:119]
buffer_load_dwordx4 v13, s[8:11], s24 offen offset:1024 lds
v_mfma_f32_16x16x32_bf16 v[124:127], a[136:139], a[24:27], v[124:127]
ds_read_b64_tr_b16 a[134:135], v24 offset:18432
v_add_u32 v24, 32768, v24
v_mfma_f32_16x16x32_bf16 v[124:127], a[140:143], a[28:31], v[124:127]
v_cvt_pk_bf16_f32 v72, v72, v73
v_cvt_pk_bf16_f32 v73, v74, v75
v_mfma_f32_16x16x32_bf16 v[132:135], a[136:139], a[32:35], v[132:135]
ds_read_b128 a[96:99], v2 offset:57344
v_cvt_pk_bf16_f32 v74, v96, v97
v_mfma_f32_16x16x32_bf16 v[132:135], a[140:143], a[36:39], v[132:135]
buffer_load_dwordx4 v14, s[8:11], s24 offen offset:2048 lds
v_mfma_f32_16x16x32_bf16 v[140:143], a[136:139], a[40:43], v[140:143]
ds_read_b128 a[100:103], v3 offset:57344
v_cvt_pk_bf16_f32 v75, v98, v99
v_mfma_f32_16x16x32_bf16 v[140:143], a[140:143], a[44:47], v[140:143]
ds_read_b128 a[104:107], v2 offset:59392
v_accvgpr_read_b32 v80, a240
v_mfma_f32_16x16x32_bf16 v[148:151], a[136:139], a[48:51], v[148:151]
ds_read_b128 a[108:111], v3 offset:59392
v_accvgpr_read_b32 v81, a241
v_mfma_f32_16x16x32_bf16 v[148:151], a[140:143], a[52:55], v[148:151]
buffer_load_dwordx4 v15, s[8:11], s24 offen offset:3072 lds
v_mfma_f32_16x16x32_bf16 v[156:159], a[136:139], a[56:59], v[156:159]
s_add_u32 s24, s24, 128
ds_read_b128 a[112:115], v2 offset:61440
v_accvgpr_read_b32 v82, a242
v_mfma_f32_16x16x32_bf16 v[156:159], a[140:143], a[60:63], v[156:159]
s_waitcnt lgkmcnt(5)
buffer_store_dwordx4 v[176:179], v1, s[4:7], s31 offen sc1
v_mfma_f32_16x16x32_bf16 v[164:167], a[128:131], a[0:3], v[164:167]
s_add_u32 s31, s31, s32
ds_read_b64_tr_b16 a[136:137], v25 offset:0
v_accvgpr_read_b32 v83, a243
v_mfma_f32_16x16x32_bf16 v[164:167], a[132:135], a[4:7], v[164:167]
v_accvgpr_read_b32 v96, a244
v_accvgpr_read_b32 v97, a245
v_mfma_f32_16x16x32_bf16 v[172:175], a[128:131], a[8:11], v[172:175]
ds_read_b64_tr_b16 a[138:139], v25 offset:2048
v_accvgpr_read_b32 v98, a246
v_mfma_f32_16x16x32_bf16 v[172:175], a[132:135], a[12:15], v[172:175]
ds_read_b128 a[116:119], v3 offset:61440
v_accvgpr_read_b32 v99, a247
v_mfma_f32_16x16x32_bf16 v[180:183], a[128:131], a[16:19], v[180:183]
ds_read_b64_tr_b16 a[140:141], v25 offset:16384
v_cvt_pk_bf16_f32 v80, v80, v81
v_mfma_f32_16x16x32_bf16 v[180:183], a[132:135], a[20:23], v[180:183]
buffer_store_dwordx4 v[184:187], v1, s[4:7], s31 offen sc1
v_mfma_f32_16x16x32_bf16 v[188:191], a[128:131], a[24:27], v[188:191]
s_add_u32 s31, s31, s34
ds_read_b64_tr_b16 a[142:143], v25 offset:18432
v_add_u32 v25, 32768, v25
v_mfma_f32_16x16x32_bf16 v[188:191], a[132:135], a[28:31], v[188:191]
v_cvt_pk_bf16_f32 v81, v82, v83
v_cvt_pk_bf16_f32 v82, v96, v97
v_mfma_f32_16x16x32_bf16 v[196:199], a[128:131], a[32:35], v[196:199]
ds_read_b128 a[120:123], v2 offset:63488
v_cvt_pk_bf16_f32 v83, v98, v99
v_mfma_f32_16x16x32_bf16 v[196:199], a[132:135], a[36:39], v[196:199]
v_accvgpr_read_b32 v88, a248
v_accvgpr_read_b32 v89, a249
v_mfma_f32_16x16x32_bf16 v[204:207], a[128:131], a[40:43], v[204:207]
ds_read_b128 a[124:127], v3 offset:63488
v_accvgpr_read_b32 v90, a250
v_mfma_f32_16x16x32_bf16 v[204:207], a[132:135], a[44:47], v[204:207]
v_accvgpr_read_b32 v91, a251
v_accvgpr_read_b32 v96, a252
v_mfma_f32_16x16x32_bf16 v[212:215], a[128:131], a[48:51], v[212:215]
v_accvgpr_read_b32 v97, a253
v_accvgpr_read_b32 v98, a254
v_mfma_f32_16x16x32_bf16 v[212:215], a[132:135], a[52:55], v[212:215]
v_accvgpr_read_b32 v99, a255
v_cvt_pk_bf16_f32 v88, v88, v89
v_mfma_f32_16x16x32_bf16 v[220:223], a[128:131], a[56:59], v[220:223]
v_cvt_pk_bf16_f32 v89, v90, v91
v_cvt_pk_bf16_f32 v90, v96, v97
v_mfma_f32_16x16x32_bf16 v[220:223], a[132:135], a[60:63], v[220:223]
s_waitcnt vmcnt(23) lgkmcnt(0)
s_barrier
v_cvt_pk_bf16_f32 v91, v98, v99
v_mfma_f32_16x16x32_bf16 v[224:227], a[136:139], a[0:3], v[224:227]
s_add_u32 m0, s29, 98304
ds_read_b64_tr_b16 a[128:129], v22 offset:0
v_mfma_f32_16x16x32_bf16 v[224:227], a[140:143], a[4:7], v[224:227]
buffer_load_dwordx4 v16, s[12:15], s26 offen offset:0 lds
v_mfma_f32_16x16x32_bf16 v[228:231], a[136:139], a[8:11], v[228:231]
ds_read_b64_tr_b16 a[130:131], v22 offset:2048
v_mfma_f32_16x16x32_bf16 v[228:231], a[140:143], a[12:15], v[228:231]
buffer_store_dwordx4 v[192:195], v1, s[4:7], s31 offen sc1
v_mfma_f32_16x16x32_bf16 v[232:235], a[136:139], a[16:19], v[232:235]
s_add_u32 s31, s31, s32
ds_read_b64_tr_b16 a[132:133], v22 offset:16384
v_mfma_f32_16x16x32_bf16 v[232:235], a[140:143], a[20:23], v[232:235]
buffer_load_dwordx4 v17, s[12:15], s26 offen offset:1024 lds
v_mfma_f32_16x16x32_bf16 v[236:239], a[136:139], a[24:27], v[236:239]
ds_read_b64_tr_b16 a[134:135], v22 offset:18432
v_add_u32 v22, 4294901760, v22
v_mfma_f32_16x16x32_bf16 v[236:239], a[140:143], a[28:31], v[236:239]
v_mfma_f32_16x16x32_bf16 v[240:243], a[136:139], a[32:35], v[240:243]
v_mfma_f32_16x16x32_bf16 v[240:243], a[140:143], a[36:39], v[240:243]
buffer_load_dwordx4 v18, s[12:15], s26 offen offset:2048 lds
v_mfma_f32_16x16x32_bf16 v[244:247], a[136:139], a[40:43], v[244:247]
v_mfma_f32_16x16x32_bf16 v[244:247], a[140:143], a[44:47], v[244:247]
v_mfma_f32_16x16x32_bf16 v[248:251], a[136:139], a[48:51], v[248:251]
v_mfma_f32_16x16x32_bf16 v[248:251], a[140:143], a[52:55], v[248:251]
buffer_load_dwordx4 v19, s[12:15], s26 offen offset:3072 lds
v_mfma_f32_16x16x32_bf16 v[252:255], a[136:139], a[56:59], v[252:255]
s_add_u32 s26, s26, 524288
v_mfma_f32_16x16x32_bf16 v[252:255], a[140:143], a[60:63], v[252:255]
s_waitcnt lgkmcnt(0)
v_mfma_f32_16x16x32_bf16 v[36:39], a[128:131], a[64:67], v[36:39]
s_add_u32 m0, s29, 114688
ds_read_b64_tr_b16 a[136:137], v23 offset:0
v_mfma_f32_16x16x32_bf16 v[36:39], a[132:135], a[68:71], v[36:39]
buffer_load_dwordx4 v16, s[12:15], s27 offen offset:0 lds
v_mfma_f32_16x16x32_bf16 v[44:47], a[128:131], a[72:75], v[44:47]
ds_read_b64_tr_b16 a[138:139], v23 offset:2048
v_mfma_f32_16x16x32_bf16 v[44:47], a[132:135], a[76:79], v[44:47]
ds_read_b128 a[0:3], v2 offset:0
ds_read_b128 a[4:7], v3 offset:0
v_mfma_f32_16x16x32_bf16 v[52:55], a[128:131], a[80:83], v[52:55]
ds_read_b64_tr_b16 a[140:141], v23 offset:16384
v_mfma_f32_16x16x32_bf16 v[52:55], a[132:135], a[84:87], v[52:55]
buffer_load_dwordx4 v17, s[12:15], s27 offen offset:1024 lds
v_mfma_f32_16x16x32_bf16 v[60:63], a[128:131], a[88:91], v[60:63]
ds_read_b64_tr_b16 a[142:143], v23 offset:18432
v_add_u32 v23, 4294901760, v23
v_mfma_f32_16x16x32_bf16 v[60:63], a[132:135], a[92:95], v[60:63]
buffer_store_dwordx4 v[200:203], v1, s[4:7], s31 offen sc1
v_mfma_f32_16x16x32_bf16 v[68:71], a[128:131], a[96:99], v[68:71]
s_add_u32 s31, s31, s33
ds_read_b128 a[8:11], v2 offset:2048
v_mfma_f32_16x16x32_bf16 v[68:71], a[132:135], a[100:103], v[68:71]
buffer_load_dwordx4 v18, s[12:15], s27 offen offset:2048 lds
v_mfma_f32_16x16x32_bf16 v[76:79], a[128:131], a[104:107], v[76:79]
ds_read_b128 a[12:15], v3 offset:2048
v_mfma_f32_16x16x32_bf16 v[76:79], a[132:135], a[108:111], v[76:79]
ds_read_b128 a[16:19], v2 offset:4096
v_mfma_f32_16x16x32_bf16 v[84:87], a[128:131], a[112:115], v[84:87]
ds_read_b128 a[20:23], v3 offset:4096
v_mfma_f32_16x16x32_bf16 v[84:87], a[132:135], a[116:119], v[84:87]
buffer_load_dwordx4 v19, s[12:15], s27 offen offset:3072 lds
v_mfma_f32_16x16x32_bf16 v[92:95], a[128:131], a[120:123], v[92:95]
s_add_u32 s27, s27, 524288
ds_read_b128 a[24:27], v2 offset:6144
v_mfma_f32_16x16x32_bf16 v[92:95], a[132:135], a[124:127], v[92:95]
s_waitcnt lgkmcnt(5)
buffer_store_dwordx4 v[208:211], v1, s[4:7], s31 offen sc1
v_mfma_f32_16x16x32_bf16 v[100:103], a[136:139], a[64:67], v[100:103]
s_add_u32 s31, s31, s32
ds_read_b64_tr_b16 a[128:129], v24 offset:0
v_mfma_f32_16x16x32_bf16 v[100:103], a[140:143], a[68:71], v[100:103]
v_mfma_f32_16x16x32_bf16 v[108:111], a[136:139], a[72:75], v[108:111]
ds_read_b64_tr_b16 a[130:131], v24 offset:2048
v_mfma_f32_16x16x32_bf16 v[108:111], a[140:143], a[76:79], v[108:111]
ds_read_b128 a[28:31], v3 offset:6144
v_mfma_f32_16x16x32_bf16 v[116:119], a[136:139], a[80:83], v[116:119]
ds_read_b64_tr_b16 a[132:133], v24 offset:16384
v_mfma_f32_16x16x32_bf16 v[116:119], a[140:143], a[84:87], v[116:119]
v_mfma_f32_16x16x32_bf16 v[124:127], a[136:139], a[88:91], v[124:127]
ds_read_b64_tr_b16 a[134:135], v24 offset:18432
v_add_u32 v24, 4294901760, v24
v_mfma_f32_16x16x32_bf16 v[124:127], a[140:143], a[92:95], v[124:127]
v_mfma_f32_16x16x32_bf16 v[132:135], a[136:139], a[96:99], v[132:135]
ds_read_b128 a[32:35], v2 offset:8192
v_mfma_f32_16x16x32_bf16 v[132:135], a[140:143], a[100:103], v[132:135]
buffer_store_dwordx4 v[216:219], v1, s[4:7], s31 offen sc1
v_mfma_f32_16x16x32_bf16 v[140:143], a[136:139], a[104:107], v[140:143]
s_add_u32 s31, s31, s35
ds_read_b128 a[36:39], v3 offset:8192
v_mfma_f32_16x16x32_bf16 v[140:143], a[140:143], a[108:111], v[140:143]
ds_read_b128 a[40:43], v2 offset:10240
v_mfma_f32_16x16x32_bf16 v[148:151], a[136:139], a[112:115], v[148:151]
ds_read_b128 a[44:47], v3 offset:10240
v_mfma_f32_16x16x32_bf16 v[148:151], a[140:143], a[116:119], v[148:151]
v_mfma_f32_16x16x32_bf16 v[156:159], a[136:139], a[120:123], v[156:159]
ds_read_b128 a[48:51], v2 offset:12288
v_mfma_f32_16x16x32_bf16 v[156:159], a[140:143], a[124:127], v[156:159]
s_waitcnt lgkmcnt(5)
v_mfma_f32_16x16x32_bf16 v[164:167], a[128:131], a[64:67], v[164:167]
ds_read_b64_tr_b16 a[136:137], v25 offset:0
v_mfma_f32_16x16x32_bf16 v[164:167], a[132:135], a[68:71], v[164:167]
v_mfma_f32_16x16x32_bf16 v[172:175], a[128:131], a[72:75], v[172:175]
ds_read_b64_tr_b16 a[138:139], v25 offset:2048
v_mfma_f32_16x16x32_bf16 v[172:175], a[132:135], a[76:79], v[172:175]
ds_read_b128 a[52:55], v3 offset:12288
v_mfma_f32_16x16x32_bf16 v[180:183], a[128:131], a[80:83], v[180:183]
ds_read_b64_tr_b16 a[140:141], v25 offset:16384
v_mfma_f32_16x16x32_bf16 v[180:183], a[132:135], a[84:87], v[180:183]
buffer_store_dwordx4 v[32:35], v1, s[4:7], s31 offen sc1
v_mfma_f32_16x16x32_bf16 v[188:191], a[128:131], a[88:91], v[188:191]
s_add_u32 s31, s31, s32
ds_read_b64_tr_b16 a[142:143], v25 offset:18432
v_add_u32 v25, 4294901760, v25
v_mfma_f32_16x16x32_bf16 v[188:191], a[132:135], a[92:95], v[188:191]
v_mfma_f32_16x16x32_bf16 v[196:199], a[128:131], a[96:99], v[196:199]
ds_read_b128 a[56:59], v2 offset:14336
v_mfma_f32_16x16x32_bf16 v[196:199], a[132:135], a[100:103], v[196:199]
v_mfma_f32_16x16x32_bf16 v[204:207], a[128:131], a[104:107], v[204:207]
ds_read_b128 a[60:63], v3 offset:14336
v_mfma_f32_16x16x32_bf16 v[204:207], a[132:135], a[108:111], v[204:207]
v_mfma_f32_16x16x32_bf16 v[212:215], a[128:131], a[112:115], v[212:215]
v_mfma_f32_16x16x32_bf16 v[212:215], a[132:135], a[116:119], v[212:215]
v_mfma_f32_16x16x32_bf16 v[220:223], a[128:131], a[120:123], v[220:223]
v_mfma_f32_16x16x32_bf16 v[220:223], a[132:135], a[124:127], v[220:223]
s_waitcnt vmcnt(20) lgkmcnt(0)
s_barrier
v_mfma_f32_16x16x32_bf16 v[224:227], a[136:139], a[64:67], v[224:227]
s_add_u32 m0, s29, 131072
ds_read_b64_tr_b16 a[128:129], v22 offset:0
v_mfma_f32_16x16x32_bf16 v[224:227], a[140:143], a[68:71], v[224:227]
buffer_load_dwordx4 v16, s[12:15], s26 offen offset:0 lds
v_mfma_f32_16x16x32_bf16 v[228:231], a[136:139], a[72:75], v[228:231]
ds_read_b64_tr_b16 a[130:131], v22 offset:2048
v_mfma_f32_16x16x32_bf16 v[228:231], a[140:143], a[76:79], v[228:231]
buffer_store_dwordx4 v[40:43], v1, s[4:7], s31 offen sc1
v_mfma_f32_16x16x32_bf16 v[232:235], a[136:139], a[80:83], v[232:235]
s_add_u32 s31, s31, s33
ds_read_b64_tr_b16 a[132:133], v22 offset:16384
v_mfma_f32_16x16x32_bf16 v[232:235], a[140:143], a[84:87], v[232:235]
buffer_load_dwordx4 v17, s[12:15], s26 offen offset:1024 lds
v_mfma_f32_16x16x32_bf16 v[236:239], a[136:139], a[88:91], v[236:239]
ds_read_b64_tr_b16 a[134:135], v22 offset:18432
v_add_u32 v22, 32768, v22
v_mfma_f32_16x16x32_bf16 v[236:239], a[140:143], a[92:95], v[236:239]
v_mfma_f32_16x16x32_bf16 v[240:243], a[136:139], a[96:99], v[240:243]
v_mfma_f32_16x16x32_bf16 v[240:243], a[140:143], a[100:103], v[240:243]
buffer_load_dwordx4 v18, s[12:15], s26 offen offset:2048 lds
v_mfma_f32_16x16x32_bf16 v[244:247], a[136:139], a[104:107], v[244:247]
v_mfma_f32_16x16x32_bf16 v[244:247], a[140:143], a[108:111], v[244:247]
v_mfma_f32_16x16x32_bf16 v[248:251], a[136:139], a[112:115], v[248:251]
v_mfma_f32_16x16x32_bf16 v[248:251], a[140:143], a[116:119], v[248:251]
buffer_load_dwordx4 v19, s[12:15], s26 offen offset:3072 lds
v_mfma_f32_16x16x32_bf16 v[252:255], a[136:139], a[120:123], v[252:255]
s_add_u32 s26, s26, 524288
v_mfma_f32_16x16x32_bf16 v[252:255], a[140:143], a[124:127], v[252:255]
s_waitcnt lgkmcnt(0)
v_mfma_f32_16x16x32_bf16 v[36:39], a[128:131], a[0:3], v[36:39]
s_add_u32 m0, s29, 147456
ds_read_b64_tr_b16 a[136:137], v23 offset:0
v_mfma_f32_16x16x32_bf16 v[36:39], a[132:135], a[4:7], v[36:39]
buffer_load_dwordx4 v16, s[12:15], s27 offen offset:0 lds
v_mfma_f32_16x16x32_bf16 v[44:47], a[128:131], a[8:11], v[44:47]
s_lshl_b32 s22, s20, 7
ds_read_b64_tr_b16 a[138:139], v23 offset:2048
v_bfe_u32 v20, v1, 4, 3
v_mfma_f32_16x16x32_bf16 v[44:47], a[132:135], a[12:15], v[44:47]
s_add_u32 s70, s22, 94371840
ds_read_b128 a[64:67], v2 offset:16384
ds_read_b128 a[68:71], v3 offset:16384
v_mfma_f32_16x16x32_bf16 v[52:55], a[128:131], a[16:19], v[52:55]
s_lshr_b32 s22, s2, 4
ds_read_b64_tr_b16 a[140:141], v23 offset:16384
v_lshlrev_b32 v20, 3, v20
v_mfma_f32_16x16x32_bf16 v[52:55], a[132:135], a[20:23], v[52:55]
s_lshl_b32 s22, s22, 2
buffer_load_dwordx4 v17, s[12:15], s27 offen offset:1024 lds
v_mfma_f32_16x16x32_bf16 v[60:63], a[128:131], a[24:27], v[60:63]
s_add_u32 s66, s70, s22
ds_read_b64_tr_b16 a[142:143], v23 offset:18432
v_add_u32 v23, 32768, v23
v_mfma_f32_16x16x32_bf16 v[60:63], a[132:135], a[28:31], v[60:63]
s_and_b32 s22, s2, 16
buffer_store_dwordx4 v[48:51], v1, s[4:7], s31 offen sc1
v_mfma_f32_16x16x32_bf16 v[68:71], a[128:131], a[32:35], v[68:71]
s_add_u32 s31, s31, s32
ds_read_b128 a[72:75], v2 offset:18432
v_add_u32 v15, 2052, v20
v_mfma_f32_16x16x32_bf16 v[68:71], a[132:135], a[36:39], v[68:71]
s_lshl_b32 s22, s22, 7
buffer_load_dwordx4 v18, s[12:15], s27 offen offset:2048 lds
v_mfma_f32_16x16x32_bf16 v[76:79], a[128:131], a[40:43], v[76:79]
s_add_u32 s66, s66, s22
ds_read_b128 a[76:79], v3 offset:18432
v_mfma_f32_16x16x32_bf16 v[76:79], a[132:135], a[44:47], v[76:79]
s_lshl_b32 s67, s20, 20
ds_read_b128 a[80:83], v2 offset:20480
v_mfma_f32_16x16x32_bf16 v[84:87], a[128:131], a[48:51], v[84:87]
s_lshl_b32 s22, s37, 16
ds_read_b128 a[84:87], v3 offset:20480
v_mfma_f32_16x16x32_bf16 v[84:87], a[132:135], a[52:55], v[84:87]
s_add_u32 s67, s67, s22
buffer_load_dwordx4 v19, s[12:15], s27 offen offset:3072 lds
v_mfma_f32_16x16x32_bf16 v[92:95], a[128:131], a[56:59], v[92:95]
s_waitcnt lgkmcnt(5)
s_add_u32 s27, s27, 524288
ds_read_b128 a[88:91], v2 offset:22528
v_mfma_f32_16x16x32_bf16 v[92:95], a[132:135], a[60:63], v[92:95]
s_lshl_b32 s22, s3, 11
buffer_store_dwordx4 v[56:59], v1, s[4:7], s31 offen sc1
v_mfma_f32_16x16x32_bf16 v[100:103], a[136:139], a[0:3], v[100:103]
s_waitcnt lgkmcnt(5)
s_add_u32 s31, s31, s34
ds_read_b64_tr_b16 a[128:129], v24 offset:0
v_mfma_f32_16x16x32_bf16 v[100:103], a[140:143], a[4:7], v[100:103]
s_add_u32 s67, s67, s22
v_mfma_f32_16x16x32_bf16 v[108:111], a[136:139], a[8:11], v[108:111]
s_add_u32 s67, s67, 33554432
ds_read_b64_tr_b16 a[130:131], v24 offset:2048
v_mfma_f32_16x16x32_bf16 v[108:111], a[140:143], a[12:15], v[108:111]
s_mov_b32 s68, 1035512379
ds_read_b128 a[92:95], v3 offset:22528
v_mfma_f32_16x16x32_bf16 v[116:119], a[136:139], a[16:19], v[116:119]
s_mov_b32 s69, 1035512379
ds_read_b64_tr_b16 a[132:133], v24 offset:16384
v_mfma_f32_16x16x32_bf16 v[116:119], a[140:143], a[20:23], v[116:119]
buffer_store_dwordx4 v[64:67], v1, s[4:7], s31 offen sc1
v_mfma_f32_16x16x32_bf16 v[124:127], a[136:139], a[24:27], v[124:127]
s_add_u32 s31, s31, s32
ds_read_b64_tr_b16 a[134:135], v24 offset:18432
v_add_u32 v24, 32768, v24
v_mfma_f32_16x16x32_bf16 v[124:127], a[140:143], a[28:31], v[124:127]
v_mfma_f32_16x16x32_bf16 v[132:135], a[136:139], a[32:35], v[132:135]
ds_read_b128 a[96:99], v2 offset:24576
v_mfma_f32_16x16x32_bf16 v[132:135], a[140:143], a[36:39], v[132:135]
v_mfma_f32_16x16x32_bf16 v[140:143], a[136:139], a[40:43], v[140:143]
ds_read_b128 a[100:103], v3 offset:24576
v_mfma_f32_16x16x32_bf16 v[140:143], a[140:143], a[44:47], v[140:143]
ds_read_b128 a[104:107], v2 offset:26624
v_mfma_f32_16x16x32_bf16 v[148:151], a[136:139], a[48:51], v[148:151]
ds_read_b128 a[108:111], v3 offset:26624
v_mfma_f32_16x16x32_bf16 v[148:151], a[140:143], a[52:55], v[148:151]
v_mfma_f32_16x16x32_bf16 v[156:159], a[136:139], a[56:59], v[156:159]
ds_read_b128 a[112:115], v2 offset:28672
v_mfma_f32_16x16x32_bf16 v[156:159], a[140:143], a[60:63], v[156:159]
s_waitcnt lgkmcnt(5)
buffer_store_dwordx4 v[72:75], v1, s[4:7], s31 offen sc1
v_mfma_f32_16x16x32_bf16 v[164:167], a[128:131], a[0:3], v[164:167]
s_add_u32 s31, s31, s33
ds_read_b64_tr_b16 a[136:137], v25 offset:0
v_mfma_f32_16x16x32_bf16 v[164:167], a[132:135], a[4:7], v[164:167]
v_mfma_f32_16x16x32_bf16 v[172:175], a[128:131], a[8:11], v[172:175]
ds_read_b64_tr_b16 a[138:139], v25 offset:2048
v_mfma_f32_16x16x32_bf16 v[172:175], a[132:135], a[12:15], v[172:175]
ds_read_b128 a[116:119], v3 offset:28672
v_mfma_f32_16x16x32_bf16 v[180:183], a[128:131], a[16:19], v[180:183]
ds_read_b64_tr_b16 a[140:141], v25 offset:16384
v_mfma_f32_16x16x32_bf16 v[180:183], a[132:135], a[20:23], v[180:183]
v_mfma_f32_16x16x32_bf16 v[188:191], a[128:131], a[24:27], v[188:191]
ds_read_b64_tr_b16 a[142:143], v25 offset:18432
v_add_u32 v25, 32768, v25
v_mfma_f32_16x16x32_bf16 v[188:191], a[132:135], a[28:31], v[188:191]
v_mfma_f32_16x16x32_bf16 v[196:199], a[128:131], a[32:35], v[196:199]
ds_read_b128 a[120:123], v2 offset:30720
v_mfma_f32_16x16x32_bf16 v[196:199], a[132:135], a[36:39], v[196:199]
buffer_store_dwordx4 v[80:83], v1, s[4:7], s31 offen sc1
v_mfma_f32_16x16x32_bf16 v[204:207], a[128:131], a[40:43], v[204:207]
s_add_u32 s31, s31, s32
ds_read_b128 a[124:127], v3 offset:30720
v_mfma_f32_16x16x32_bf16 v[204:207], a[132:135], a[44:47], v[204:207]
v_mfma_f32_16x16x32_bf16 v[212:215], a[128:131], a[48:51], v[212:215]
v_mfma_f32_16x16x32_bf16 v[212:215], a[132:135], a[52:55], v[212:215]
v_mfma_f32_16x16x32_bf16 v[220:223], a[128:131], a[56:59], v[220:223]
v_mfma_f32_16x16x32_bf16 v[220:223], a[132:135], a[60:63], v[220:223]
s_waitcnt vmcnt(17) lgkmcnt(0)
s_barrier
v_mfma_f32_16x16x32_bf16 v[224:227], a[136:139], a[0:3], v[224:227]
ds_read_b64_tr_b16 a[128:129], v22 offset:0
v_mfma_f32_16x16x32_bf16 v[224:227], a[140:143], a[4:7], v[224:227]
v_mfma_f32_16x16x32_bf16 v[228:231], a[136:139], a[8:11], v[228:231]
ds_read_b64_tr_b16 a[130:131], v22 offset:2048
v_mfma_f32_16x16x32_bf16 v[228:231], a[140:143], a[12:15], v[228:231]
buffer_store_dwordx4 v[88:91], v1, s[4:7], s31 offen sc1
v_mfma_f32_16x16x32_bf16 v[232:235], a[136:139], a[16:19], v[232:235]
ds_read_b64_tr_b16 a[132:133], v22 offset:16384
v_mfma_f32_16x16x32_bf16 v[232:235], a[140:143], a[20:23], v[232:235]
v_mfma_f32_16x16x32_bf16 v[236:239], a[136:139], a[24:27], v[236:239]
ds_read_b64_tr_b16 a[134:135], v22 offset:18432
v_add_u32 v22, 32768, v22
v_mfma_f32_16x16x32_bf16 v[236:239], a[140:143], a[28:31], v[236:239]
v_mfma_f32_16x16x32_bf16 v[240:243], a[136:139], a[32:35], v[240:243]
v_mfma_f32_16x16x32_bf16 v[240:243], a[140:143], a[36:39], v[240:243]
v_mfma_f32_16x16x32_bf16 v[244:247], a[136:139], a[40:43], v[244:247]
v_mfma_f32_16x16x32_bf16 v[244:247], a[140:143], a[44:47], v[244:247]
v_mfma_f32_16x16x32_bf16 v[248:251], a[136:139], a[48:51], v[248:251]
v_mfma_f32_16x16x32_bf16 v[248:251], a[140:143], a[52:55], v[248:251]
v_mfma_f32_16x16x32_bf16 v[252:255], a[136:139], a[56:59], v[252:255]
v_mfma_f32_16x16x32_bf16 v[252:255], a[140:143], a[60:63], v[252:255]
s_waitcnt lgkmcnt(0)
v_mfma_f32_16x16x32_bf16 v[36:39], a[128:131], a[64:67], v[36:39]
ds_read_b64_tr_b16 a[136:137], v23 offset:0
v_mfma_f32_16x16x32_bf16 v[36:39], a[132:135], a[68:71], v[36:39]
v_mfma_f32_16x16x32_bf16 v[44:47], a[128:131], a[72:75], v[44:47]
s_mul_i32 s85, s20, 7
ds_read_b64_tr_b16 a[138:139], v23 offset:2048
v_mfma_f32_16x16x32_bf16 v[44:47], a[132:135], a[76:79], v[44:47]
s_add_u32 s85, s85, s21
ds_read_b128 a[0:3], v2 offset:32768
ds_read_b128 a[4:7], v3 offset:32768
v_mfma_f32_16x16x32_bf16 v[52:55], a[128:131], a[80:83], v[52:55]
s_lshl_b32 s85, s85, 2
ds_read_b64_tr_b16 a[140:141], v23 offset:16384
v_mfma_f32_16x16x32_bf16 v[52:55], a[132:135], a[84:87], v[52:55]
s_add_u32 s85, s85, s3
v_mfma_f32_16x16x32_bf16 v[60:63], a[128:131], a[88:91], v[60:63]
s_mul_i32 s82, s85, 4224
ds_read_b64_tr_b16 a[142:143], v23 offset:18432
v_add_u32 v23, 32768, v23
v_mfma_f32_16x16x32_bf16 v[60:63], a[132:135], a[92:95], v[60:63]
s_add_u32 s82, s82, 83886208
v_mfma_f32_16x16x32_bf16 v[68:71], a[128:131], a[96:99], v[68:71]
s_lshl_b32 s83, s85, 12
ds_read_b128 a[8:11], v2 offset:34816
v_mfma_f32_16x16x32_bf16 v[68:71], a[132:135], a[100:103], v[68:71]
s_mul_i32 s84, s3, 21248
v_mfma_f32_16x16x32_bf16 v[76:79], a[128:131], a[104:107], v[76:79]
s_add_u32 s84, s84, 46080
ds_read_b128 a[12:15], v3 offset:34816
v_mfma_f32_16x16x32_bf16 v[76:79], a[132:135], a[108:111], v[76:79]
s_mov_b64 s[60:61], s[72:73]
ds_read_b128 a[16:19], v2 offset:36864
v_mfma_f32_16x16x32_bf16 v[84:87], a[128:131], a[112:115], v[84:87]
s_mov_b32 s62, 1835008
ds_read_b128 a[20:23], v3 offset:36864
v_mfma_f32_16x16x32_bf16 v[84:87], a[132:135], a[116:119], v[84:87]
v_mfma_f32_16x16x32_bf16 v[92:95], a[128:131], a[120:123], v[92:95]
ds_read_b128 a[24:27], v2 offset:38912
v_mfma_f32_16x16x32_bf16 v[92:95], a[132:135], a[124:127], v[92:95]
s_waitcnt lgkmcnt(5)
v_mfma_f32_16x16x32_bf16 v[100:103], a[136:139], a[64:67], v[100:103]
ds_read_b64_tr_b16 a[128:129], v24 offset:0
v_mfma_f32_16x16x32_bf16 v[100:103], a[140:143], a[68:71], v[100:103]
v_mfma_f32_16x16x32_bf16 v[108:111], a[136:139], a[72:75], v[108:111]
ds_read_b64_tr_b16 a[130:131], v24 offset:2048
v_mfma_f32_16x16x32_bf16 v[108:111], a[140:143], a[76:79], v[108:111]
ds_read_b128 a[28:31], v3 offset:38912
v_mfma_f32_16x16x32_bf16 v[116:119], a[136:139], a[80:83], v[116:119]
ds_read_b64_tr_b16 a[132:133], v24 offset:16384
v_mfma_f32_16x16x32_bf16 v[116:119], a[140:143], a[84:87], v[116:119]
v_mfma_f32_16x16x32_bf16 v[124:127], a[136:139], a[88:91], v[124:127]
ds_read_b64_tr_b16 a[134:135], v24 offset:18432
v_add_u32 v24, 32768, v24
v_mfma_f32_16x16x32_bf16 v[124:127], a[140:143], a[92:95], v[124:127]
v_mfma_f32_16x16x32_bf16 v[132:135], a[136:139], a[96:99], v[132:135]
ds_read_b128 a[32:35], v2 offset:40960
v_mfma_f32_16x16x32_bf16 v[132:135], a[140:143], a[100:103], v[132:135]
v_mfma_f32_16x16x32_bf16 v[140:143], a[136:139], a[104:107], v[140:143]
ds_read_b128 a[36:39], v3 offset:40960
v_mfma_f32_16x16x32_bf16 v[140:143], a[140:143], a[108:111], v[140:143]
ds_read_b128 a[40:43], v2 offset:43008
v_mfma_f32_16x16x32_bf16 v[148:151], a[136:139], a[112:115], v[148:151]
ds_read_b128 a[44:47], v3 offset:43008
v_mfma_f32_16x16x32_bf16 v[148:151], a[140:143], a[116:119], v[148:151]
v_mfma_f32_16x16x32_bf16 v[156:159], a[136:139], a[120:123], v[156:159]
ds_read_b128 a[48:51], v2 offset:45056
v_mfma_f32_16x16x32_bf16 v[156:159], a[140:143], a[124:127], v[156:159]
s_waitcnt lgkmcnt(5)
v_mfma_f32_16x16x32_bf16 v[164:167], a[128:131], a[64:67], v[164:167]
ds_read_b64_tr_b16 a[136:137], v25 offset:0
v_mfma_f32_16x16x32_bf16 v[164:167], a[132:135], a[68:71], v[164:167]
v_mfma_f32_16x16x32_bf16 v[172:175], a[128:131], a[72:75], v[172:175]
ds_read_b64_tr_b16 a[138:139], v25 offset:2048
v_mfma_f32_16x16x32_bf16 v[172:175], a[132:135], a[76:79], v[172:175]
ds_read_b128 a[52:55], v3 offset:45056
v_mfma_f32_16x16x32_bf16 v[180:183], a[128:131], a[80:83], v[180:183]
ds_read_b64_tr_b16 a[140:141], v25 offset:16384
v_mfma_f32_16x16x32_bf16 v[180:183], a[132:135], a[84:87], v[180:183]
PAD_29:
s_cbranch_execz M_tret
v_mfma_f32_16x16x32_bf16 v[188:191], a[128:131], a[88:91], v[188:191]
ds_read_b64_tr_b16 a[142:143], v25 offset:18432
v_add_u32 v25, 32768, v25
v_mfma_f32_16x16x32_bf16 v[188:191], a[132:135], a[92:95], v[188:191]
v_mfma_f32_16x16x32_bf16 v[196:199], a[128:131], a[96:99], v[196:199]
ds_read_b128 a[56:59], v2 offset:47104
v_mfma_f32_16x16x32_bf16 v[196:199], a[132:135], a[100:103], v[196:199]
v_mfma_f32_16x16x32_bf16 v[204:207], a[128:131], a[104:107], v[204:207]
ds_read_b128 a[60:63], v3 offset:47104
v_mfma_f32_16x16x32_bf16 v[204:207], a[132:135], a[108:111], v[204:207]
v_mfma_f32_16x16x32_bf16 v[212:215], a[128:131], a[112:115], v[212:215]
v_mfma_f32_16x16x32_bf16 v[212:215], a[132:135], a[116:119], v[212:215]
v_mfma_f32_16x16x32_bf16 v[220:223], a[128:131], a[120:123], v[220:223]
v_mfma_f32_16x16x32_bf16 v[220:223], a[132:135], a[124:127], v[220:223]
s_waitcnt vmcnt(0) lgkmcnt(0)
s_barrier
v_mfma_f32_16x16x32_bf16 v[224:227], a[136:139], a[64:67], v[224:227]
ds_read_b64_tr_b16 a[128:129], v22 offset:0
v_mfma_f32_16x16x32_bf16 v[224:227], a[140:143], a[68:71], v[224:227]
buffer_store_dword v27, v26, s[4:7], s66 offen sc1
v_mfma_f32_16x16x32_bf16 v[228:231], a[136:139], a[72:75], v[228:231]
ds_read_b64_tr_b16 a[130:131], v22 offset:2048
v_mfma_f32_16x16x32_bf16 v[228:231], a[140:143], a[76:79], v[228:231]
v_mfma_f32_16x16x32_bf16 v[232:235], a[136:139], a[80:83], v[232:235]
ds_read_b64_tr_b16 a[132:133], v22 offset:16384
v_mfma_f32_16x16x32_bf16 v[232:235], a[140:143], a[84:87], v[232:235]
v_mfma_f32_16x16x32_bf16 v[236:239], a[136:139], a[88:91], v[236:239]
ds_read_b64_tr_b16 a[134:135], v22 offset:18432
v_mfma_f32_16x16x32_bf16 v[236:239], a[140:143], a[92:95], v[236:239]
v_mfma_f32_16x16x32_bf16 v[240:243], a[136:139], a[96:99], v[240:243]
v_mfma_f32_16x16x32_bf16 v[240:243], a[140:143], a[100:103], v[240:243]
v_mfma_f32_16x16x32_bf16 v[244:247], a[136:139], a[104:107], v[244:247]
v_mfma_f32_16x16x32_bf16 v[244:247], a[140:143], a[108:111], v[244:247]
v_mfma_f32_16x16x32_bf16 v[248:251], a[136:139], a[112:115], v[248:251]
v_mfma_f32_16x16x32_bf16 v[248:251], a[140:143], a[116:119], v[248:251]
v_mfma_f32_16x16x32_bf16 v[252:255], a[136:139], a[120:123], v[252:255]
v_mfma_f32_16x16x32_bf16 v[252:255], a[140:143], a[124:127], v[252:255]
s_waitcnt lgkmcnt(0)
v_mfma_f32_16x16x32_bf16 v[36:39], a[128:131], a[0:3], v[36:39]
s_add_u32 m0, s84, 17152
ds_read_b64_tr_b16 a[136:137], v23 offset:0
v_lshrrev_b32 v9, 4, v1
v_mfma_f32_16x16x32_bf16 v[36:39], a[132:135], a[4:7], v[36:39]
buffer_load_dwordx4 v1, s[60:63], s83 offen offset:0 lds
v_mfma_f32_16x16x32_bf16 v[44:47], a[128:131], a[8:11], v[44:47]
ds_read_b64_tr_b16 a[138:139], v23 offset:2048
v_and_b32 v10, 15, v9
v_mfma_f32_16x16x32_bf16 v[44:47], a[132:135], a[12:15], v[44:47]
buffer_load_dwordx4 v1, s[60:63], s83 offen offset:1024 lds
v_mfma_f32_16x16x32_bf16 v[52:55], a[128:131], a[16:19], v[52:55]
ds_read_b64_tr_b16 a[140:141], v23 offset:16384
v_lshrrev_b32 v11, 4, v9
v_mfma_f32_16x16x32_bf16 v[52:55], a[132:135], a[20:23], v[52:55]
buffer_load_dwordx4 v1, s[60:63], s83 offen offset:2048 lds
v_mfma_f32_16x16x32_bf16 v[60:63], a[128:131], a[24:27], v[60:63]
ds_read_b64_tr_b16 a[142:143], v23 offset:18432
v_lshrrev_b32 v12, 2, v10
v_mfma_f32_16x16x32_bf16 v[60:63], a[132:135], a[28:31], v[60:63]
buffer_load_dwordx4 v1, s[60:63], s83 offen offset:3072 lds
v_mfma_f32_16x16x32_bf16 v[68:71], a[128:131], a[32:35], v[68:71]
s_add_u32 m0, s84, 64
v_mul_u32_u24 v12, 4160, v12
v_and_b32 v13, 3, v9
v_mfma_f32_16x16x32_bf16 v[68:71], a[132:135], a[36:39], v[68:71]
buffer_load_dwordx4 v1, s[4:7], s82 offen offset:0 sc1 lds
v_mfma_f32_16x16x32_bf16 v[76:79], a[128:131], a[40:43], v[76:79]
buffer_load_dwordx4 v1, s[4:7], s82 offen offset:1024 sc1 lds
v_mfma_f32_16x16x32_bf16 v[76:79], a[132:135], a[44:47], v[76:79]
buffer_load_dwordx4 v1, s[4:7], s82 offen offset:2048 sc1 lds
v_mfma_f32_16x16x32_bf16 v[84:87], a[128:131], a[48:51], v[84:87]
buffer_load_dwordx4 v1, s[4:7], s82 offen offset:3072 sc1 lds
v_mfma_f32_16x16x32_bf16 v[84:87], a[132:135], a[52:55], v[84:87]
s_add_u32 s82, s82, 2097152
v_lshl_add_u32 v12, v13, 3, v12
v_lshlrev_b32 v13, 4, v11
v_mfma_f32_16x16x32_bf16 v[92:95], a[128:131], a[56:59], v[92:95]
s_add_u32 m0, s84, 4224
v_sub_u32 v12, v12, v13
v_add_u32 v12, 88, v12
v_mfma_f32_16x16x32_bf16 v[92:95], a[132:135], a[60:63], v[92:95]
s_waitcnt lgkmcnt(0)
buffer_load_dwordx4 v1, s[4:7], s82 offen offset:0 sc1 lds
v_mfma_f32_16x16x32_bf16 v[100:103], a[136:139], a[0:3], v[100:103]
ds_read_b64_tr_b16 a[128:129], v24 offset:0
v_add_u32 v16, s84, v12
v_mfma_f32_16x16x32_bf16 v[100:103], a[140:143], a[4:7], v[100:103]
buffer_load_dwordx4 v1, s[4:7], s82 offen offset:1024 sc1 lds
v_mfma_f32_16x16x32_bf16 v[108:111], a[136:139], a[8:11], v[108:111]
ds_read_b64_tr_b16 a[130:131], v24 offset:2048
v_lshl_add_u32 v12, v10, 5, v13
v_mfma_f32_16x16x32_bf16 v[108:111], a[140:143], a[12:15], v[108:111]
buffer_load_dwordx4 v1, s[4:7], s82 offen offset:2048 sc1 lds
v_mfma_f32_16x16x32_bf16 v[116:119], a[136:139], a[16:19], v[116:119]
ds_read_b64_tr_b16 a[132:133], v24 offset:16384
v_add_u32 v12, 16672, v12
v_mfma_f32_16x16x32_bf16 v[116:119], a[140:143], a[20:23], v[116:119]
buffer_load_dwordx4 v1, s[4:7], s82 offen offset:3072 sc1 lds
v_mfma_f32_16x16x32_bf16 v[124:127], a[136:139], a[24:27], v[124:127]
s_add_u32 s82, s82, 4292870140
ds_read_b64_tr_b16 a[134:135], v24 offset:18432
v_add_u32 v17, s84, v12
v_mfma_f32_16x16x32_bf16 v[124:127], a[140:143], a[28:31], v[124:127]
s_add_u32 m0, s84, 8384
v_lshlrev_b32 v12, 5, v10
v_lshl_add_u32 v8, v11, 3, v12
v_mfma_f32_16x16x32_bf16 v[132:135], a[136:139], a[32:35], v[132:135]
buffer_load_dwordx4 v1, s[4:7], s82 offen offset:0 sc1 lds
v_mfma_f32_16x16x32_bf16 v[132:135], a[140:143], a[36:39], v[132:135]
buffer_load_dwordx4 v1, s[4:7], s82 offen offset:1024 sc1 lds
v_mfma_f32_16x16x32_bf16 v[140:143], a[136:139], a[40:43], v[140:143]
buffer_load_dwordx4 v1, s[4:7], s82 offen offset:2048 sc1 lds
v_mfma_f32_16x16x32_bf16 v[140:143], a[140:143], a[44:47], v[140:143]
buffer_load_dwordx4 v1, s[4:7], s82 offen offset:3072 sc1 lds
v_mfma_f32_16x16x32_bf16 v[148:151], a[136:139], a[48:51], v[148:151]
s_add_u32 s82, s82, 2097152
v_add3_u32 v18, s84, 64, v8
v_mov_b32 v19, 0
v_mfma_f32_16x16x32_bf16 v[148:151], a[140:143], a[52:55], v[148:151]
s_add_u32 m0, s84, 12544
v_mov_b32 v12, 0
v_mov_b32 v13, 0
v_mfma_f32_16x16x32_bf16 v[156:159], a[136:139], a[56:59], v[156:159]
buffer_load_dwordx4 v1, s[4:7], s82 offen offset:0 sc1 lds
v_mfma_f32_16x16x32_bf16 v[156:159], a[140:143], a[60:63], v[156:159]
s_waitcnt lgkmcnt(0)
buffer_load_dwordx4 v1, s[4:7], s82 offen offset:1024 sc1 lds
v_mfma_f32_16x16x32_bf16 v[164:167], a[128:131], a[0:3], v[164:167]
ds_read_b64_tr_b16 a[136:137], v25 offset:0
v_lshl_add_u32 v14, v9, 3, s84
v_mfma_f32_16x16x32_bf16 v[164:167], a[132:135], a[4:7], v[164:167]
buffer_load_dwordx4 v1, s[4:7], s82 offen offset:2048 sc1 lds
v_mfma_f32_16x16x32_bf16 v[172:175], a[128:131], a[8:11], v[172:175]
ds_read_b64_tr_b16 a[138:139], v25 offset:2048
v_mfma_f32_16x16x32_bf16 v[172:175], a[132:135], a[12:15], v[172:175]
buffer_load_dwordx4 v1, s[4:7], s82 offen offset:3072 sc1 lds
v_mfma_f32_16x16x32_bf16 v[180:183], a[128:131], a[16:19], v[180:183]
ds_read_b64_tr_b16 a[140:141], v25 offset:16384
v_mfma_f32_16x16x32_bf16 v[180:183], a[132:135], a[20:23], v[180:183]
ds_write_b64 v14, v[12:13] offset:16640
v_mul_u32_u24 v14, 4160, v11
v_mfma_f32_16x16x32_bf16 v[188:191], a[128:131], a[24:27], v[188:191]
ds_read_b64_tr_b16 a[142:143], v25 offset:18432
v_lshl_add_u32 v14, v10, 2, v14
v_mfma_f32_16x16x32_bf16 v[188:191], a[132:135], a[28:31], v[188:191]
v_add_u32 v14, s84, v14
v_mfma_f32_16x16x32_bf16 v[196:199], a[128:131], a[32:35], v[196:199]
ds_write_b32 v14, v12
v_lshrrev_b32 v30, 6, v0
v_mfma_f32_16x16x32_bf16 v[196:199], a[132:135], a[36:39], v[196:199]
v_lshl_add_u32 v28, v30, 11, v1
v_add_u32 v29, 0x20000, v28
v_mfma_f32_16x16x32_bf16 v[204:207], a[128:131], a[40:43], v[204:207]
v_lshl_add_u32 v30, v30, 13, v1
v_add_u32 v31, 0x20000, v30
v_mfma_f32_16x16x32_bf16 v[204:207], a[132:135], a[44:47], v[204:207]
v_mul_f32 v36, s68, v36
v_mul_f32 v37, s68, v37
v_mfma_f32_16x16x32_bf16 v[212:215], a[128:131], a[48:51], v[212:215]
v_mul_f32 v38, s68, v38
v_mul_f32 v39, s68, v39
v_mfma_f32_16x16x32_bf16 v[212:215], a[132:135], a[52:55], v[212:215]
v_mul_f32 v100, s68, v100
v_mul_f32 v101, s68, v101
v_mfma_f32_16x16x32_bf16 v[220:223], a[128:131], a[56:59], v[220:223]
v_mul_f32 v102, s68, v102
v_mul_f32 v103, s68, v103
v_mfma_f32_16x16x32_bf16 v[220:223], a[132:135], a[60:63], v[220:223]
s_waitcnt lgkmcnt(0)
s_waitcnt lgkmcnt(0)
s_barrier
v_mfma_f32_16x16x32_bf16 v[224:227], a[136:139], a[0:3], v[224:227]
v_cvt_pk_bf16_f32 v36, v36, v37
v_cvt_pk_bf16_f32 v37, v38, v39
v_mfma_f32_16x16x32_bf16 v[224:227], a[140:143], a[4:7], v[224:227]
v_cvt_pk_bf16_f32 v38, v100, v101
v_cvt_pk_bf16_f32 v39, v102, v103
v_mfma_f32_16x16x32_bf16 v[228:231], a[136:139], a[8:11], v[228:231]
v_mul_f32 v44, s68, v44
v_mul_f32 v45, s68, v45
v_mfma_f32_16x16x32_bf16 v[228:231], a[140:143], a[12:15], v[228:231]
v_mul_f32 v46, s68, v46
v_mul_f32 v47, s68, v47
v_mfma_f32_16x16x32_bf16 v[232:235], a[136:139], a[16:19], v[232:235]
v_mul_f32 v108, s68, v108
v_mul_f32 v109, s68, v109
v_mfma_f32_16x16x32_bf16 v[232:235], a[140:143], a[20:23], v[232:235]
v_mul_f32 v110, s68, v110
v_mul_f32 v111, s68, v111
v_mfma_f32_16x16x32_bf16 v[236:239], a[136:139], a[24:27], v[236:239]
v_cvt_pk_bf16_f32 v44, v44, v45
v_cvt_pk_bf16_f32 v45, v46, v47
v_mfma_f32_16x16x32_bf16 v[236:239], a[140:143], a[28:31], v[236:239]
v_cvt_pk_bf16_f32 v46, v108, v109
v_cvt_pk_bf16_f32 v47, v110, v111
v_mfma_f32_16x16x32_bf16 v[240:243], a[136:139], a[32:35], v[240:243]
v_mul_f32 v52, s68, v52
v_mul_f32 v53, s68, v53
v_mfma_f32_16x16x32_bf16 v[240:243], a[140:143], a[36:39], v[240:243]
v_mul_f32 v54, s68, v54
v_mul_f32 v55, s68, v55
v_mfma_f32_16x16x32_bf16 v[244:247], a[136:139], a[40:43], v[244:247]
v_mul_f32 v116, s68, v116
v_mul_f32 v117, s68, v117
v_mfma_f32_16x16x32_bf16 v[244:247], a[140:143], a[44:47], v[244:247]
v_mul_f32 v118, s68, v118
v_mul_f32 v119, s68, v119
v_mfma_f32_16x16x32_bf16 v[248:251], a[136:139], a[48:51], v[248:251]
v_cvt_pk_bf16_f32 v52, v52, v53
v_cvt_pk_bf16_f32 v53, v54, v55
v_mfma_f32_16x16x32_bf16 v[248:251], a[140:143], a[52:55], v[248:251]
v_cvt_pk_bf16_f32 v54, v116, v117
v_cvt_pk_bf16_f32 v55, v118, v119
v_mfma_f32_16x16x32_bf16 v[252:255], a[136:139], a[56:59], v[252:255]
v_mfma_f32_16x16x32_bf16 v[252:255], a[140:143], a[60:63], v[252:255]
s_mov_b64 s[60:61], s[74:75]
s_mov_b32 s62, 896
s_lshl_b32 s79, s85, 1
buffer_load_short_d16_hi v19, off, s[60:63], s79
s_lshl_b32 s83, s85, 12
s_add_u32 s83, s83, 88080384
ds_write_b128 v28, v[36:39] offset:0
ds_write_b128 v28, v[44:47] offset:8192
ds_write_b128 v28, v[52:55] offset:16384
v_pk_mul_f32 v[60:61], v[60:61], s[68:69]
v_pk_mul_f32 v[62:63], v[62:63], s[68:69]
v_pk_mul_f32 v[124:125], v[124:125], s[68:69]
v_pk_mul_f32 v[126:127], v[126:127], s[68:69]
v_cvt_pk_bf16_f32 v60, v60, v61
v_cvt_pk_bf16_f32 v61, v62, v63
v_cvt_pk_bf16_f32 v62, v124, v125
v_cvt_pk_bf16_f32 v63, v126, v127
ds_write_b128 v28, v[60:63] offset:24576
v_pk_mul_f32 v[68:69], v[68:69], s[68:69]
v_pk_mul_f32 v[70:71], v[70:71], s[68:69]
v_pk_mul_f32 v[132:133], v[132:133], s[68:69]
v_pk_mul_f32 v[134:135], v[134:135], s[68:69]
v_cvt_pk_bf16_f32 v68, v68, v69
v_cvt_pk_bf16_f32 v69, v70, v71
v_cvt_pk_bf16_f32 v70, v132, v133
v_cvt_pk_bf16_f32 v71, v134, v135
ds_write_b128 v29, v[68:71] offset:0
v_pk_mul_f32 v[76:77], v[76:77], s[68:69]
v_pk_mul_f32 v[78:79], v[78:79], s[68:69]
v_pk_mul_f32 v[140:141], v[140:141], s[68:69]
v_pk_mul_f32 v[142:143], v[142:143], s[68:69]
v_cvt_pk_bf16_f32 v76, v76, v77
v_cvt_pk_bf16_f32 v77, v78, v79
v_cvt_pk_bf16_f32 v78, v140, v141
v_cvt_pk_bf16_f32 v79, v142, v143
ds_write_b128 v29, v[76:79] offset:8192
v_pk_mul_f32 v[84:85], v[84:85], s[68:69]
v_pk_mul_f32 v[86:87], v[86:87], s[68:69]
v_pk_mul_f32 v[148:149], v[148:149], s[68:69]
v_pk_mul_f32 v[150:151], v[150:151], s[68:69]
v_cvt_pk_bf16_f32 v84, v84, v85
v_cvt_pk_bf16_f32 v85, v86, v87
v_cvt_pk_bf16_f32 v86, v148, v149
v_cvt_pk_bf16_f32 v87, v150, v151
ds_write_b128 v29, v[84:87] offset:16384
v_pk_mul_f32 v[92:93], v[92:93], s[68:69]
v_pk_mul_f32 v[94:95], v[94:95], s[68:69]
v_pk_mul_f32 v[156:157], v[156:157], s[68:69]
v_pk_mul_f32 v[158:159], v[158:159], s[68:69]
v_cvt_pk_bf16_f32 v92, v92, v93
v_cvt_pk_bf16_f32 v93, v94, v95
v_cvt_pk_bf16_f32 v94, v156, v157
v_cvt_pk_bf16_f32 v95, v158, v159
ds_write_b128 v29, v[92:95] offset:24576
v_pk_mul_f32 v[164:165], v[164:165], s[68:69]
v_pk_mul_f32 v[166:167], v[166:167], s[68:69]
v_pk_mul_f32 v[224:225], v[224:225], s[68:69]
v_pk_mul_f32 v[226:227], v[226:227], s[68:69]
v_cvt_pk_bf16_f32 v164, v164, v165
v_cvt_pk_bf16_f32 v165, v166, v167
v_cvt_pk_bf16_f32 v166, v224, v225
v_cvt_pk_bf16_f32 v167, v226, v227
ds_write_b128 v28, v[164:167] offset:1024
v_pk_mul_f32 v[172:173], v[172:173], s[68:69]
v_pk_mul_f32 v[174:175], v[174:175], s[68:69]
v_pk_mul_f32 v[228:229], v[228:229], s[68:69]
v_pk_mul_f32 v[230:231], v[230:231], s[68:69]
v_cvt_pk_bf16_f32 v172, v172, v173
v_cvt_pk_bf16_f32 v173, v174, v175
v_cvt_pk_bf16_f32 v174, v228, v229
v_cvt_pk_bf16_f32 v175, v230, v231
ds_write_b128 v28, v[172:175] offset:9216
v_pk_mul_f32 v[180:181], v[180:181], s[68:69]
v_pk_mul_f32 v[182:183], v[182:183], s[68:69]
v_pk_mul_f32 v[232:233], v[232:233], s[68:69]
v_pk_mul_f32 v[234:235], v[234:235], s[68:69]
v_cvt_pk_bf16_f32 v180, v180, v181
v_cvt_pk_bf16_f32 v181, v182, v183
v_cvt_pk_bf16_f32 v182, v232, v233
v_cvt_pk_bf16_f32 v183, v234, v235
ds_write_b128 v28, v[180:183] offset:17408
v_pk_mul_f32 v[188:189], v[188:189], s[68:69]
v_pk_mul_f32 v[190:191], v[190:191], s[68:69]
v_pk_mul_f32 v[236:237], v[236:237], s[68:69]
v_pk_mul_f32 v[238:239], v[238:239], s[68:69]
v_cvt_pk_bf16_f32 v188, v188, v189
v_cvt_pk_bf16_f32 v189, v190, v191
v_cvt_pk_bf16_f32 v190, v236, v237
v_cvt_pk_bf16_f32 v191, v238, v239
ds_write_b128 v28, v[188:191] offset:25600
v_pk_mul_f32 v[196:197], v[196:197], s[68:69]
v_pk_mul_f32 v[198:199], v[198:199], s[68:69]
v_pk_mul_f32 v[240:241], v[240:241], s[68:69]
v_pk_mul_f32 v[242:243], v[242:243], s[68:69]
v_cvt_pk_bf16_f32 v196, v196, v197
v_cvt_pk_bf16_f32 v197, v198, v199
v_cvt_pk_bf16_f32 v198, v240, v241
v_cvt_pk_bf16_f32 v199, v242, v243
ds_write_b128 v29, v[196:199] offset:1024
v_pk_mul_f32 v[204:205], v[204:205], s[68:69]
v_pk_mul_f32 v[206:207], v[206:207], s[68:69]
v_pk_mul_f32 v[244:245], v[244:245], s[68:69]
v_pk_mul_f32 v[246:247], v[246:247], s[68:69]
v_cvt_pk_bf16_f32 v204, v204, v205
v_cvt_pk_bf16_f32 v205, v206, v207
v_cvt_pk_bf16_f32 v206, v244, v245
v_cvt_pk_bf16_f32 v207, v246, v247
ds_write_b128 v29, v[204:207] offset:9216
v_pk_mul_f32 v[212:213], v[212:213], s[68:69]
v_pk_mul_f32 v[214:215], v[214:215], s[68:69]
v_pk_mul_f32 v[248:249], v[248:249], s[68:69]
v_pk_mul_f32 v[250:251], v[250:251], s[68:69]
v_cvt_pk_bf16_f32 v212, v212, v213
v_cvt_pk_bf16_f32 v213, v214, v215
v_cvt_pk_bf16_f32 v214, v248, v249
v_cvt_pk_bf16_f32 v215, v250, v251
ds_write_b128 v29, v[212:215] offset:17408
v_pk_mul_f32 v[220:221], v[220:221], s[68:69]
v_pk_mul_f32 v[222:223], v[222:223], s[68:69]
v_pk_mul_f32 v[252:253], v[252:253], s[68:69]
v_pk_mul_f32 v[254:255], v[254:255], s[68:69]
v_cvt_pk_bf16_f32 v220, v220, v221
v_cvt_pk_bf16_f32 v221, v222, v223
v_cvt_pk_bf16_f32 v222, v252, v253
v_cvt_pk_bf16_f32 v223, v254, v255
ds_write_b128 v29, v[220:223] offset:25600
s_waitcnt vmcnt(1) lgkmcnt(0)
s_barrier
buffer_load_dword v21, v20, s[4:7], s70 offen sc1
ds_read_b64_tr_b16 a[64:65], v16 offset:8
ds_read_b64_tr_b16 a[66:67], v16 offset:0
ds_read_b128 a[96:99], v17 offset:448
ds_read_b64_tr_b16 a[68:69], v16 offset:520
ds_read_b64_tr_b16 a[70:71], v16 offset:512
ds_read_b128 a[100:103], v17 offset:960
ds_read_b64_tr_b16 a[72:73], v16 offset:1032
ds_read_b64_tr_b16 a[74:75], v16 offset:1024
ds_read_b128 a[104:107], v17 offset:1472
ds_read_b64_tr_b16 a[76:77], v16 offset:1544
ds_read_b64_tr_b16 a[78:79], v16 offset:1536
ds_read_b128 a[108:111], v17 offset:1984
ds_read_b64_tr_b16 a[80:81], v16 offset:2056
ds_read_b64_tr_b16 a[82:83], v16 offset:2048
ds_read_b128 a[112:115], v17 offset:2496
ds_read_b64_tr_b16 a[84:85], v16 offset:2568
ds_read_b64_tr_b16 a[86:87], v16 offset:2560
ds_read_b128 a[116:119], v17 offset:3008
ds_read_b64_tr_b16 a[88:89], v16 offset:3080
ds_read_b64_tr_b16 a[90:91], v16 offset:3072
ds_read_b128 a[120:123], v17 offset:3520
ds_read_b64_tr_b16 a[92:93], v16 offset:3592
ds_read_b64_tr_b16 a[94:95], v16 offset:3584
ds_read_b128 a[124:127], v17 offset:4032
s_waitcnt lgkmcnt(15)
v_mfma_f32_16x16x32_bf16 v[96:99], a[64:67], a[96:99], 0
s_waitcnt lgkmcnt(12)
s_lshl_b32 s18, s3, 13
ds_read_b64_tr_b16 a[128:129], v16 offset:72
v_mov_b32 v24, 0
v_mfma_f32_16x16x32_bf16 v[100:103], a[64:67], a[100:103], 0
s_lshl_b32 s30, s20, 20
ds_read_b64_tr_b16 a[130:131], v16 offset:64
v_lshrrev_b32 v3, 6, v0
v_mfma_f32_16x16x32_bf16 v[100:103], a[68:71], a[96:99], v[100:103]
s_add_u32 s30, s30, s18
ds_read_b128 a[160:163], v17 offset:384
v_and_b32 v4, 63, v0
v_mfma_f32_16x16x32_bf16 v[104:107], a[64:67], a[104:107], 0
s_lshl_b32 s22, s21, 1
ds_read_b128 a[192:195], v30 offset:0
v_add_u32 v2, 0x10000, v1
v_mfma_f32_16x16x32_bf16 v[104:107], a[68:71], a[100:103], v[104:107]
s_lshl_b32 s85, s21, 2
ds_read_b64_tr_b16 a[132:133], v16 offset:584
v_and_b32 v5, 15, v4
v_mfma_f32_16x16x32_bf16 v[104:107], a[72:75], a[96:99], v[104:107]
s_lshr_b32 s85, 2386092, s85
ds_read_b64_tr_b16 a[134:135], v16 offset:576
v_lshrrev_b32 v6, 4, v4
v_mfma_f32_16x16x32_bf16 v[108:111], a[64:67], a[108:111], 0
s_and_b32 s9, s85, 15
ds_read_b128 a[164:167], v17 offset:896
v_lshlrev_b32 v6, 2, v6
v_mfma_f32_16x16x32_bf16 v[108:111], a[68:71], a[104:107], v[108:111]
s_and_b32 s84, s85, 1
ds_read_b128 a[196:199], v30 offset:1024
v_sub_u32 v5, v5, v6
v_mfma_f32_16x16x32_bf16 v[108:111], a[72:75], a[100:103], v[108:111]
s_lshl_b32 s84, s84, 17
ds_read_b64_tr_b16 a[136:137], v16 offset:1096
v_lshl_add_u32 v5, v3, 4, v5
v_mfma_f32_16x16x32_bf16 v[108:111], a[76:79], a[96:99], v[108:111]
s_waitcnt lgkmcnt(8)
s_add_u32 s84, s84, s18
ds_read_b64_tr_b16 a[138:139], v16 offset:1088
v_cmp_gt_i32 s[32:33], 0, v5
v_mfma_f32_16x16x32_bf16 v[112:115], a[64:67], a[112:115], 0
s_xor_b32 s85, s84, 0x20000
ds_read_b128 a[168:171], v17 offset:1408
v_cmp_gt_i32 s[34:35], 1, v5
v_mfma_f32_16x16x32_bf16 v[112:115], a[68:71], a[108:111], v[112:115]
s_sub_u32 s29, 15, s21
ds_read_b128 a[200:203], v30 offset:2048
v_cmp_gt_i32 s[36:37], 2, v5
v_mfma_f32_16x16x32_bf16 v[112:115], a[72:75], a[104:107], v[112:115]
s_mov_b32 s8, s30
ds_read_b64_tr_b16 a[140:141], v16 offset:1608
v_cmp_gt_i32 s[38:39], 3, v5
v_mfma_f32_16x16x32_bf16 v[112:115], a[76:79], a[100:103], v[112:115]
s_add_u32 s11, s22, 2
ds_read_b64_tr_b16 a[142:143], v16 offset:1600
v_cmp_gt_i32 s[40:41], 16, v5
v_mfma_f32_16x16x32_bf16 v[112:115], a[80:83], a[96:99], v[112:115]
s_add_u32 s14, s30, 16777216
ds_read_b128 a[172:175], v17 offset:1920
v_cmp_gt_i32 s[42:43], 17, v5
v_mfma_f32_16x16x32_bf16 v[116:119], a[64:67], a[116:119], 0
s_lshr_b32 s19, s9, 1
ds_read_b128 a[204:207], v30 offset:3072
v_cmp_gt_i32 s[44:45], 18, v5
v_mfma_f32_16x16x32_bf16 v[116:119], a[68:71], a[112:115], v[116:119]
s_cmp_lg_u32 s9, 0
ds_read_b64_tr_b16 a[144:145], v16 offset:2120
v_cmp_gt_i32 s[46:47], 19, v5
v_mfma_f32_16x16x32_bf16 v[116:119], a[72:75], a[108:111], v[116:119]
s_cselect_b32 s10, s30, 3221225472
ds_read_b64_tr_b16 a[146:147], v16 offset:2112
v_cmp_gt_i32 s[48:49], 32, v5
v_mfma_f32_16x16x32_bf16 v[116:119], a[76:79], a[104:107], v[116:119]
s_cselect_b32 s14, s14, 3221225472
ds_read_b128 a[176:179], v17 offset:2432
v_cmp_gt_i32 s[50:51], 33, v5
v_mfma_f32_16x16x32_bf16 v[116:119], a[80:83], a[100:103], v[116:119]
s_cselect_b32 s9, s9, s11
ds_read_b128 a[208:211], v30 offset:4096
v_cmp_gt_i32 s[52:53], 34, v5
v_mfma_f32_16x16x32_bf16 v[116:119], a[84:87], a[96:99], v[116:119]
s_cselect_b32 s19, s19, s21
ds_read_b64_tr_b16 a[148:149], v16 offset:2632
v_cmp_gt_i32 s[54:55], 35, v5
v_mfma_f32_16x16x32_bf16 v[120:123], a[64:67], a[120:123], 0
s_cselect_b32 s29, s29, s21
ds_read_b64_tr_b16 a[150:151], v16 offset:2624
v_cmp_gt_i32 s[56:57], 48, v5
v_mfma_f32_16x16x32_bf16 v[120:123], a[68:71], a[116:119], v[120:123]
s_cselect_b32 s24, 2, 0
ds_read_b128 a[180:183], v17 offset:2944
v_cmp_gt_i32 s[58:59], 49, v5
v_mfma_f32_16x16x32_bf16 v[120:123], a[72:75], a[112:115], v[120:123]
s_add_u32 s12, s8, 16777216
ds_read_b128 a[212:215], v30 offset:5120
v_cmp_gt_i32 s[60:61], 50, v5
v_mfma_f32_16x16x32_bf16 v[120:123], a[76:79], a[108:111], v[120:123]
s_mov_b32 s13, s9
ds_read_b64_tr_b16 a[152:153], v16 offset:3144
v_cmp_gt_i32 s[62:63], 51, v5
v_mfma_f32_16x16x32_bf16 v[120:123], a[80:83], a[104:107], v[120:123]
s_mov_b32 s15, s11
ds_read_b64_tr_b16 a[154:155], v16 offset:3136
v_mov_b32 v7, 0xff800000
v_mfma_f32_16x16x32_bf16 v[120:123], a[84:87], a[100:103], v[120:123]
s_mov_b32 s25, 1266679808
ds_read_b128 a[184:187], v17 offset:3456
v_mov_b32 v6, 1
v_mfma_f32_16x16x32_bf16 v[120:123], a[88:91], a[96:99], v[120:123]
s_lshl_b32 s22, s21, 3
ds_read_b128 a[216:219], v30 offset:6144
v_mov_b32 v5, v26
v_mfma_f32_16x16x32_bf16 v[124:127], a[64:67], a[124:127], 0
s_add_u32 s28, s70, s22
ds_read_b64_tr_b16 a[156:157], v16 offset:3656
v_add_u32 v4, 0x20000, v1
v_mfma_f32_16x16x32_bf16 v[124:127], a[68:71], a[120:123], v[124:127]
s_add_u32 s28, s28, 6148
ds_read_b64_tr_b16 a[158:159], v16 offset:3648
v_mfma_f32_16x16x32_bf16 v[124:127], a[72:75], a[116:119], v[124:127]
s_lshl_b32 s26, s21, 16
ds_read_b128 a[188:191], v17 offset:3968
v_mfma_f32_16x16x32_bf16 v[124:127], a[76:79], a[112:115], v[124:127]
s_add_u32 s26, s26, s30
ds_read_b128 a[220:223], v30 offset:7168
v_mfma_f32_16x16x32_bf16 v[124:127], a[80:83], a[108:111], v[124:127]
s_add_u32 s26, s26, 33554432
ds_read_b128 a[224:227], v31 offset:0
v_mfma_f32_16x16x32_bf16 v[124:127], a[84:87], a[104:107], v[124:127]
s_lshl_b32 s76, s20, 3
ds_read_b128 a[228:231], v31 offset:1024
v_mfma_f32_16x16x32_bf16 v[124:127], a[88:91], a[100:103], v[124:127]
s_add_u32 s76, s76, s21
ds_read_b128 a[232:235], v31 offset:2048
v_mfma_f32_16x16x32_bf16 v[124:127], a[92:95], a[96:99], v[124:127]
s_waitcnt lgkmcnt(8)
s_lshl_b32 s76, s76, 2
ds_read_b128 a[236:239], v31 offset:3072
v_mfma_f32_16x16x32_bf16 v[96:99], a[128:131], a[160:163], v[96:99]
s_add_u32 s76, s76, s3
ds_read_b64_tr_b16 a[64:65], v16 offset:136
v_mfma_f32_16x16x32_bf16 v[100:103], a[128:131], a[164:167], v[100:103]
s_lshl_b32 s27, s76, 10
ds_read_b64_tr_b16 a[66:67], v16 offset:128
v_mfma_f32_16x16x32_bf16 v[100:103], a[132:135], a[160:163], v[100:103]
s_add_u32 s27, s27, 75497472
ds_read_b128 a[96:99], v17 offset:320
v_mfma_f32_16x16x32_bf16 v[104:107], a[128:131], a[168:171], v[104:107]
s_lshl_b32 s76, s76, 14
ds_read_b128 a[240:243], v31 offset:4096
v_mfma_f32_16x16x32_bf16 v[104:107], a[132:135], a[164:167], v[104:107]
s_add_u32 s76, s76, 67108864
ds_read_b64_tr_b16 a[68:69], v16 offset:648
v_mfma_f32_16x16x32_bf16 v[104:107], a[136:139], a[160:163], v[104:107]
s_lshl_b32 s81, s20, 2
ds_read_b64_tr_b16 a[70:71], v16 offset:640
v_mfma_f32_16x16x32_bf16 v[108:111], a[128:131], a[172:175], v[108:111]
s_add_u32 s81, s81, s3
ds_read_b128 a[100:103], v17 offset:832
v_mfma_f32_16x16x32_bf16 v[108:111], a[132:135], a[168:171], v[108:111]
s_mul_i32 s81, s81, 57344
ds_read_b128 a[244:247], v31 offset:5120
v_mfma_f32_16x16x32_bf16 v[108:111], a[136:139], a[164:167], v[108:111]
s_cmp_eq_u32 s24, 1
ds_read_b64_tr_b16 a[72:73], v16 offset:1160
v_mfma_f32_16x16x32_bf16 v[108:111], a[140:143], a[160:163], v[108:111]
s_cselect_b32 s80, s28, s70
ds_read_b64_tr_b16 a[74:75], v16 offset:1152
v_mfma_f32_16x16x32_bf16 v[112:115], a[128:131], a[176:179], v[112:115]
s_add_u32 s77, s76, 8192
ds_read_b128 a[104:107], v17 offset:1344
v_mfma_f32_16x16x32_bf16 v[112:115], a[132:135], a[172:175], v[112:115]
s_lshl_b32 s71, s2, 2
ds_read_b128 a[248:251], v31 offset:6144
v_mfma_f32_16x16x32_bf16 v[112:115], a[136:139], a[168:171], v[112:115]
s_add_u32 s71, s71, 94384128
ds_read_b64_tr_b16 a[76:77], v16 offset:1672
v_mfma_f32_16x16x32_bf16 v[112:115], a[140:143], a[164:167], v[112:115]
s_lshl_b32 s78, s29, 16
ds_read_b64_tr_b16 a[78:79], v16 offset:1664
v_mfma_f32_16x16x32_bf16 v[112:115], a[144:147], a[160:163], v[112:115]
s_add_u32 s78, s78, s30
ds_read_b128 a[108:111], v17 offset:1856
v_mfma_f32_16x16x32_bf16 v[116:119], a[128:131], a[180:183], v[116:119]
s_add_u32 s78, s78, 33554432
ds_read_b128 a[252:255], v31 offset:7168
v_mfma_f32_16x16x32_bf16 v[116:119], a[132:135], a[176:179], v[116:119]
s_cmp_eq_u32 s24, 0
ds_read_b64_tr_b16 a[80:81], v16 offset:2184
v_mfma_f32_16x16x32_bf16 v[116:119], a[136:139], a[172:175], v[116:119]
s_cselect_b32 s78, 3221225472, s78
ds_read_b64_tr_b16 a[82:83], v16 offset:2176
v_mfma_f32_16x16x32_bf16 v[116:119], a[140:143], a[168:171], v[116:119]
s_lshl_b32 s22, s21, 3
ds_read_b128 a[112:115], v17 offset:2368
v_mfma_f32_16x16x32_bf16 v[116:119], a[144:147], a[164:167], v[116:119]
PAD_30:
s_cbranch_execz M_tret
s_add_u32 s22, s22, 16384
v_mfma_f32_16x16x32_bf16 v[116:119], a[148:151], a[160:163], v[116:119]
ds_read_b64_tr_b16 a[84:85], v16 offset:2696
v_writelane_b32 v15, s22, 63
v_mfma_f32_16x16x32_bf16 v[120:123], a[128:131], a[184:187], v[120:123]
ds_read_b64_tr_b16 a[86:87], v16 offset:2688
v_mov_b32 v25, 0
v_mfma_f32_16x16x32_bf16 v[120:123], a[132:135], a[180:183], v[120:123]
s_waitcnt vmcnt(0) lgkmcnt(5)
s_barrier
ds_read_b128 a[116:119], v17 offset:2880
v_cmp_gt_u32 vcc, 1, v21
v_mfma_f32_16x16x32_bf16 v[120:123], a[136:139], a[176:179], v[120:123]
s_cbranch_vccnz M_kspin2
M_kok2:
v_mov_b32 v128, 0
v_mov_b32 v129, 0
v_mfma_f32_16x16x32_bf16 v[120:123], a[140:143], a[172:175], v[120:123]
s_mov_b32 m0, s84
ds_read_b64_tr_b16 a[88:89], v16 offset:3208
v_mov_b32 v130, 0
v_mfma_f32_16x16x32_bf16 v[120:123], a[144:147], a[168:171], v[120:123]
ds_read_b64_tr_b16 a[90:91], v16 offset:3200
v_mov_b32 v131, 0
v_mfma_f32_16x16x32_bf16 v[120:123], a[148:151], a[164:167], v[120:123]
ds_read_b128 a[120:123], v17 offset:3392
v_mov_b32 v132, 0
v_mfma_f32_16x16x32_bf16 v[120:123], a[152:155], a[160:163], v[120:123]
buffer_load_dwordx4 v1, s[4:7], s8 offen offset:0 sc1 lds
v_mfma_f32_16x16x32_bf16 v[124:127], a[128:131], a[188:191], v[124:127]
ds_read_b64_tr_b16 a[92:93], v16 offset:3720
v_mov_b32 v133, 0
v_mfma_f32_16x16x32_bf16 v[124:127], a[132:135], a[184:187], v[124:127]
ds_read_b64_tr_b16 a[94:95], v16 offset:3712
v_mov_b32 v134, 0
v_mfma_f32_16x16x32_bf16 v[124:127], a[136:139], a[180:183], v[124:127]
ds_read_b128 a[124:127], v17 offset:3904
v_mov_b32 v135, 0
v_mfma_f32_16x16x32_bf16 v[124:127], a[140:143], a[176:179], v[124:127]
buffer_load_dwordx4 v1, s[4:7], s8 offen offset:1024 sc1 lds
v_mfma_f32_16x16x32_bf16 v[124:127], a[144:147], a[172:175], v[124:127]
buffer_load_dwordx4 v1, s[4:7], s8 offen offset:2048 sc1 lds
v_mfma_f32_16x16x32_bf16 v[124:127], a[148:151], a[168:171], v[124:127]
buffer_load_dwordx4 v1, s[4:7], s8 offen offset:3072 sc1 lds
v_mfma_f32_16x16x32_bf16 v[124:127], a[152:155], a[164:167], v[124:127]
s_add_u32 s8, s8, 4096
v_mov_b32 v136, 0
v_mov_b32 v137, 0
v_mfma_f32_16x16x32_bf16 v[124:127], a[156:159], a[160:163], v[124:127]
s_add_u32 m0, s84, 4096
v_mov_b32 v138, 0
v_mov_b32 v139, 0
v_mfma_f32_16x16x32_bf16 v[96:99], a[64:67], a[96:99], v[96:99]
ds_read_b64_tr_b16 a[128:129], v16 offset:200
v_mov_b32 v140, 0
v_mfma_f32_16x16x32_bf16 v[100:103], a[64:67], a[100:103], v[100:103]
ds_read_b64_tr_b16 a[130:131], v16 offset:192
v_mov_b32 v141, 0
v_mfma_f32_16x16x32_bf16 v[100:103], a[68:71], a[96:99], v[100:103]
ds_read_b128 a[160:163], v17 offset:256
v_mov_b32 v142, 0
v_mfma_f32_16x16x32_bf16 v[104:107], a[64:67], a[104:107], v[104:107]
buffer_load_dwordx4 v1, s[4:7], s8 offen offset:0 sc1 lds
v_mfma_f32_16x16x32_bf16 v[104:107], a[68:71], a[100:103], v[104:107]
ds_read_b64_tr_b16 a[132:133], v16 offset:712
v_mov_b32 v143, 0
v_mfma_f32_16x16x32_bf16 v[104:107], a[72:75], a[96:99], v[104:107]
ds_read_b64_tr_b16 a[134:135], v16 offset:704
v_mov_b32 v144, 0
v_mfma_f32_16x16x32_bf16 v[108:111], a[64:67], a[108:111], v[108:111]
ds_read_b128 a[164:167], v17 offset:768
v_mov_b32 v145, 0
v_mfma_f32_16x16x32_bf16 v[108:111], a[68:71], a[104:107], v[108:111]
buffer_load_dwordx4 v1, s[4:7], s8 offen offset:1024 sc1 lds
v_mfma_f32_16x16x32_bf16 v[108:111], a[72:75], a[100:103], v[108:111]
ds_read_b64_tr_b16 a[136:137], v16 offset:1224
v_mov_b32 v146, 0
v_mfma_f32_16x16x32_bf16 v[108:111], a[76:79], a[96:99], v[108:111]
s_waitcnt lgkmcnt(6)
ds_read_b64_tr_b16 a[138:139], v16 offset:1216
v_mov_b32 v147, 0
v_mfma_f32_16x16x32_bf16 v[112:115], a[64:67], a[112:115], v[112:115]
ds_read_b128 a[168:171], v17 offset:1280
v_mov_b32 v148, 0
v_mfma_f32_16x16x32_bf16 v[112:115], a[68:71], a[108:111], v[112:115]
buffer_load_dwordx4 v1, s[4:7], s8 offen offset:2048 sc1 lds
v_mfma_f32_16x16x32_bf16 v[112:115], a[72:75], a[104:107], v[112:115]
ds_read_b64_tr_b16 a[140:141], v16 offset:1736
v_mov_b32 v149, 0
v_mfma_f32_16x16x32_bf16 v[112:115], a[76:79], a[100:103], v[112:115]
ds_read_b64_tr_b16 a[142:143], v16 offset:1728
v_mov_b32 v150, 0
v_mfma_f32_16x16x32_bf16 v[112:115], a[80:83], a[96:99], v[112:115]
ds_read_b128 a[172:175], v17 offset:1792
v_mov_b32 v151, 0
v_mfma_f32_16x16x32_bf16 v[116:119], a[64:67], a[116:119], v[116:119]
buffer_load_dwordx4 v1, s[4:7], s8 offen offset:3072 sc1 lds
v_mfma_f32_16x16x32_bf16 v[116:119], a[68:71], a[112:115], v[116:119]
s_add_u32 s8, s8, 28672
ds_read_b64_tr_b16 a[144:145], v16 offset:2248
v_mov_b32 v152, 0
v_mfma_f32_16x16x32_bf16 v[116:119], a[72:75], a[108:111], v[116:119]
s_sub_u32 s9, s9, 1
ds_read_b64_tr_b16 a[146:147], v16 offset:2240
v_mov_b32 v153, 0
v_mfma_f32_16x16x32_bf16 v[116:119], a[76:79], a[104:107], v[116:119]
s_cmp_eq_u32 s9, 0
ds_read_b128 a[176:179], v17 offset:2304
v_mov_b32 v154, 0
v_mfma_f32_16x16x32_bf16 v[116:119], a[80:83], a[100:103], v[116:119]
s_cselect_b32 s8, s10, s8
v_mov_b32 v155, 0
v_mov_b32 v156, 0
v_mfma_f32_16x16x32_bf16 v[116:119], a[84:87], a[96:99], v[116:119]
s_cselect_b32 s9, s11, s9
ds_read_b64_tr_b16 a[148:149], v16 offset:2760
v_mov_b32 v157, 0
v_mfma_f32_16x16x32_bf16 v[120:123], a[64:67], a[120:123], v[120:123]
s_cselect_b32 s10, 3221225472, s10
ds_read_b64_tr_b16 a[150:151], v16 offset:2752
v_mov_b32 v158, 0
v_mfma_f32_16x16x32_bf16 v[120:123], a[68:71], a[116:119], v[120:123]
s_mov_b32 m0, s85
ds_read_b128 a[180:183], v17 offset:2816
v_mov_b32 v159, 0
v_mfma_f32_16x16x32_bf16 v[120:123], a[72:75], a[112:115], v[120:123]
buffer_load_dwordx4 v1, s[4:7], s8 offen offset:0 sc1 lds
v_mfma_f32_16x16x32_bf16 v[120:123], a[76:79], a[108:111], v[120:123]
ds_read_b64_tr_b16 a[152:153], v16 offset:3272
v_mov_b32 v160, 0
v_mfma_f32_16x16x32_bf16 v[120:123], a[80:83], a[104:107], v[120:123]
ds_read_b64_tr_b16 a[154:155], v16 offset:3264
v_mov_b32 v161, 0
v_mfma_f32_16x16x32_bf16 v[120:123], a[84:87], a[100:103], v[120:123]
ds_read_b128 a[184:187], v17 offset:3328
v_mov_b32 v162, 0
v_mfma_f32_16x16x32_bf16 v[120:123], a[88:91], a[96:99], v[120:123]
buffer_load_dwordx4 v1, s[4:7], s8 offen offset:1024 sc1 lds
v_mfma_f32_16x16x32_bf16 v[124:127], a[64:67], a[124:127], v[124:127]
ds_read_b64_tr_b16 a[156:157], v16 offset:3784
v_mov_b32 v163, 0
v_mfma_f32_16x16x32_bf16 v[124:127], a[68:71], a[120:123], v[124:127]
ds_read_b64_tr_b16 a[158:159], v16 offset:3776
v_mov_b32 v164, 0
v_mfma_f32_16x16x32_bf16 v[124:127], a[72:75], a[116:119], v[124:127]
ds_read_b128 a[188:191], v17 offset:3840
v_mov_b32 v165, 0
v_mfma_f32_16x16x32_bf16 v[124:127], a[76:79], a[112:115], v[124:127]
buffer_load_dwordx4 v1, s[4:7], s8 offen offset:2048 sc1 lds
v_mfma_f32_16x16x32_bf16 v[124:127], a[80:83], a[108:111], v[124:127]
buffer_load_dwordx4 v1, s[4:7], s8 offen offset:3072 sc1 lds
v_mfma_f32_16x16x32_bf16 v[124:127], a[84:87], a[104:107], v[124:127]
s_add_u32 s8, s8, 4096
v_mov_b32 v166, 0
v_mov_b32 v167, 0
v_mfma_f32_16x16x32_bf16 v[124:127], a[88:91], a[100:103], v[124:127]
s_add_u32 m0, s85, 4096
v_mov_b32 v168, 0
v_mov_b32 v169, 0
v_mfma_f32_16x16x32_bf16 v[124:127], a[92:95], a[96:99], v[124:127]
s_waitcnt lgkmcnt(3)
buffer_load_dwordx4 v1, s[4:7], s8 offen offset:0 sc1 lds
v_mfma_f32_16x16x32_bf16 v[96:99], a[128:131], a[160:163], v[96:99]
ds_read_b64_tr_b16 a[64:65], v16 offset:264
v_mov_b32 v170, 0
v_mfma_f32_16x16x32_bf16 v[100:103], a[128:131], a[164:167], v[100:103]
ds_read_b64_tr_b16 a[66:67], v16 offset:256
v_mov_b32 v171, 0
v_mfma_f32_16x16x32_bf16 v[100:103], a[132:135], a[160:163], v[100:103]
ds_read_b128 a[96:99], v17 offset:192
v_mov_b32 v172, 0
v_mfma_f32_16x16x32_bf16 v[104:107], a[128:131], a[168:171], v[104:107]
buffer_load_dwordx4 v1, s[4:7], s8 offen offset:1024 sc1 lds
v_mfma_f32_16x16x32_bf16 v[104:107], a[132:135], a[164:167], v[104:107]
ds_read_b64_tr_b16 a[68:69], v16 offset:776
v_mov_b32 v173, 0
v_mfma_f32_16x16x32_bf16 v[104:107], a[136:139], a[160:163], v[104:107]
ds_read_b64_tr_b16 a[70:71], v16 offset:768
v_mov_b32 v174, 0
v_mfma_f32_16x16x32_bf16 v[108:111], a[128:131], a[172:175], v[108:111]
ds_read_b128 a[100:103], v17 offset:704
v_mov_b32 v175, 0
v_mfma_f32_16x16x32_bf16 v[108:111], a[132:135], a[168:171], v[108:111]
buffer_load_dwordx4 v1, s[4:7], s8 offen offset:2048 sc1 lds
v_mfma_f32_16x16x32_bf16 v[108:111], a[136:139], a[164:167], v[108:111]
ds_read_b64_tr_b16 a[72:73], v16 offset:1288
v_mov_b32 v176, 0
v_mfma_f32_16x16x32_bf16 v[108:111], a[140:143], a[160:163], v[108:111]
ds_read_b64_tr_b16 a[74:75], v16 offset:1280
v_mov_b32 v177, 0
v_mfma_f32_16x16x32_bf16 v[112:115], a[128:131], a[176:179], v[112:115]
ds_read_b128 a[104:107], v17 offset:1216
v_mov_b32 v178, 0
v_mfma_f32_16x16x32_bf16 v[112:115], a[132:135], a[172:175], v[112:115]
buffer_load_dwordx4 v1, s[4:7], s8 offen offset:3072 sc1 lds
v_mfma_f32_16x16x32_bf16 v[112:115], a[136:139], a[168:171], v[112:115]
s_add_u32 s8, s8, 28672
ds_read_b64_tr_b16 a[76:77], v16 offset:1800
v_mov_b32 v179, 0
v_mfma_f32_16x16x32_bf16 v[112:115], a[140:143], a[164:167], v[112:115]
s_sub_u32 s9, s9, 1
ds_read_b64_tr_b16 a[78:79], v16 offset:1792
v_mov_b32 v180, 0
v_mfma_f32_16x16x32_bf16 v[112:115], a[144:147], a[160:163], v[112:115]
s_cmp_eq_u32 s9, 0
ds_read_b128 a[108:111], v17 offset:1728
v_mov_b32 v181, 0
v_mfma_f32_16x16x32_bf16 v[116:119], a[128:131], a[180:183], v[116:119]
s_cselect_b32 s8, s10, s8
buffer_load_dword v14, v15, s[4:7], s70 offen sc1
v_mfma_f32_16x16x32_bf16 v[116:119], a[132:135], a[176:179], v[116:119]
s_cselect_b32 s9, s11, s9
ds_read_b64_tr_b16 a[80:81], v16 offset:2312
v_mov_b32 v182, 0
v_mfma_f32_16x16x32_bf16 v[116:119], a[136:139], a[172:175], v[116:119]
s_cselect_b32 s10, 3221225472, s10
ds_read_b64_tr_b16 a[82:83], v16 offset:2304
v_mov_b32 v183, 0
v_mfma_f32_16x16x32_bf16 v[116:119], a[140:143], a[168:171], v[116:119]
ds_read_b128 a[112:115], v17 offset:2240
v_mov_b32 v184, 0
v_mfma_f32_16x16x32_bf16 v[116:119], a[144:147], a[164:167], v[116:119]
v_mov_b32 v185, 0
v_mov_b32 v186, 0
v_mfma_f32_16x16x32_bf16 v[116:119], a[148:151], a[160:163], v[116:119]
ds_read_b64_tr_b16 a[84:85], v16 offset:2824
v_mov_b32 v187, 0
v_mfma_f32_16x16x32_bf16 v[120:123], a[128:131], a[184:187], v[120:123]
ds_read_b64_tr_b16 a[86:87], v16 offset:2816
v_mov_b32 v188, 0
v_mfma_f32_16x16x32_bf16 v[120:123], a[132:135], a[180:183], v[120:123]
ds_read_b128 a[116:119], v17 offset:2752
v_mov_b32 v189, 0
v_mfma_f32_16x16x32_bf16 v[120:123], a[136:139], a[176:179], v[120:123]
v_mov_b32 v190, 0
v_mov_b32 v191, 0
v_mfma_f32_16x16x32_bf16 v[120:123], a[140:143], a[172:175], v[120:123]
ds_read_b64_tr_b16 a[88:89], v16 offset:3336
v_mov_b32 v192, 0
v_mfma_f32_16x16x32_bf16 v[120:123], a[144:147], a[168:171], v[120:123]
ds_read_b64_tr_b16 a[90:91], v16 offset:3328
v_mov_b32 v193, 0
v_mfma_f32_16x16x32_bf16 v[120:123], a[148:151], a[164:167], v[120:123]
ds_read_b128 a[120:123], v17 offset:3264
v_mov_b32 v194, 0
v_mfma_f32_16x16x32_bf16 v[120:123], a[152:155], a[160:163], v[120:123]
s_waitcnt lgkmcnt(6)
v_mov_b32 v195, 0
v_mov_b32 v196, 0
v_mfma_f32_16x16x32_bf16 v[124:127], a[128:131], a[188:191], v[124:127]
ds_read_b64_tr_b16 a[92:93], v16 offset:3848
v_mov_b32 v197, 0
v_mfma_f32_16x16x32_bf16 v[124:127], a[132:135], a[184:187], v[124:127]
ds_read_b64_tr_b16 a[94:95], v16 offset:3840
v_mov_b32 v198, 0
v_mfma_f32_16x16x32_bf16 v[124:127], a[136:139], a[180:183], v[124:127]
ds_read_b128 a[124:127], v17 offset:3776
v_mov_b32 v199, 0
v_mfma_f32_16x16x32_bf16 v[124:127], a[140:143], a[176:179], v[124:127]
v_mov_b32 v200, 0
v_mov_b32 v201, 0
v_mfma_f32_16x16x32_bf16 v[124:127], a[144:147], a[172:175], v[124:127]
v_mov_b32 v202, 0
v_mov_b32 v203, 0
v_mfma_f32_16x16x32_bf16 v[124:127], a[148:151], a[168:171], v[124:127]
v_mov_b32 v204, 0
v_mov_b32 v205, 0
v_mfma_f32_16x16x32_bf16 v[124:127], a[152:155], a[164:167], v[124:127]
v_mov_b32 v206, 0
v_mov_b32 v207, 0
v_mfma_f32_16x16x32_bf16 v[124:127], a[156:159], a[160:163], v[124:127]
v_mov_b32 v208, 0
v_mov_b32 v209, 0
s_waitcnt vmcnt(0)
v_cmp_gt_u32 vcc, 1, v14
s_cbranch_vccnz M_cspin
M_cok:
v_mfma_f32_16x16x32_bf16 v[96:99], a[64:67], a[96:99], v[96:99]
s_add_u32 s22, s78, 0
ds_read_b64_tr_b16 a[128:129], v16 offset:328
v_mov_b32 v210, 0
v_mfma_f32_16x16x32_bf16 v[100:103], a[64:67], a[100:103], v[100:103]
ds_read_b64_tr_b16 a[130:131], v16 offset:320
v_mov_b32 v211, 0
v_mfma_f32_16x16x32_bf16 v[100:103], a[68:71], a[96:99], v[100:103]
ds_read_b128 a[160:163], v17 offset:128
v_mov_b32 v212, 0
v_mfma_f32_16x16x32_bf16 v[104:107], a[64:67], a[104:107], v[104:107]
buffer_load_dwordx4 a[0:3], v1, s[4:7], s22 offen offset:0 sc1
v_mfma_f32_16x16x32_bf16 v[104:107], a[68:71], a[100:103], v[104:107]
ds_read_b64_tr_b16 a[132:133], v16 offset:840
v_mov_b32 v213, 0
v_mfma_f32_16x16x32_bf16 v[104:107], a[72:75], a[96:99], v[104:107]
ds_read_b64_tr_b16 a[134:135], v16 offset:832
v_mov_b32 v214, 0
v_mfma_f32_16x16x32_bf16 v[108:111], a[64:67], a[108:111], v[108:111]
ds_read_b128 a[164:167], v17 offset:640
v_mov_b32 v215, 0
v_mfma_f32_16x16x32_bf16 v[108:111], a[68:71], a[104:107], v[108:111]
buffer_load_dwordx4 a[4:7], v1, s[4:7], s22 offen offset:1024 sc1
v_mfma_f32_16x16x32_bf16 v[108:111], a[72:75], a[100:103], v[108:111]
ds_read_b64_tr_b16 a[136:137], v16 offset:1352
v_mov_b32 v216, 0
v_mfma_f32_16x16x32_bf16 v[108:111], a[76:79], a[96:99], v[108:111]
ds_read_b64_tr_b16 a[138:139], v16 offset:1344
v_mov_b32 v217, 0
v_mfma_f32_16x16x32_bf16 v[112:115], a[64:67], a[112:115], v[112:115]
ds_read_b128 a[168:171], v17 offset:1152
v_mov_b32 v218, 0
v_mfma_f32_16x16x32_bf16 v[112:115], a[68:71], a[108:111], v[112:115]
buffer_load_dwordx4 a[8:11], v1, s[4:7], s22 offen offset:2048 sc1
v_mfma_f32_16x16x32_bf16 v[112:115], a[72:75], a[104:107], v[112:115]
ds_read_b64_tr_b16 a[140:141], v16 offset:1864
v_mov_b32 v219, 0
v_mfma_f32_16x16x32_bf16 v[112:115], a[76:79], a[100:103], v[112:115]
ds_read_b64_tr_b16 a[142:143], v16 offset:1856
v_mov_b32 v220, 0
v_mfma_f32_16x16x32_bf16 v[112:115], a[80:83], a[96:99], v[112:115]
s_waitcnt lgkmcnt(6)
ds_read_b128 a[172:175], v17 offset:1664
v_mov_b32 v221, 0
v_mfma_f32_16x16x32_bf16 v[116:119], a[64:67], a[116:119], v[116:119]
buffer_load_dwordx4 a[12:15], v1, s[4:7], s22 offen offset:3072 sc1
v_mfma_f32_16x16x32_bf16 v[116:119], a[68:71], a[112:115], v[116:119]
s_add_u32 s22, s78, 4096
ds_read_b64_tr_b16 a[144:145], v16 offset:2376
v_mov_b32 v222, 0
v_mfma_f32_16x16x32_bf16 v[116:119], a[72:75], a[108:111], v[116:119]
ds_read_b64_tr_b16 a[146:147], v16 offset:2368
v_mov_b32 v223, 0
v_mfma_f32_16x16x32_bf16 v[116:119], a[76:79], a[104:107], v[116:119]
ds_read_b128 a[176:179], v17 offset:2176
v_mov_b32 v224, 0
v_mfma_f32_16x16x32_bf16 v[116:119], a[80:83], a[100:103], v[116:119]
buffer_load_dwordx4 a[16:19], v1, s[4:7], s22 offen offset:0 sc1
v_mfma_f32_16x16x32_bf16 v[116:119], a[84:87], a[96:99], v[116:119]
ds_read_b64_tr_b16 a[148:149], v16 offset:2888
v_mov_b32 v225, 0
v_mfma_f32_16x16x32_bf16 v[120:123], a[64:67], a[120:123], v[120:123]
ds_read_b64_tr_b16 a[150:151], v16 offset:2880
v_mov_b32 v226, 0
v_mfma_f32_16x16x32_bf16 v[120:123], a[68:71], a[116:119], v[120:123]
ds_read_b128 a[180:183], v17 offset:2688
v_mov_b32 v227, 0
v_mfma_f32_16x16x32_bf16 v[120:123], a[72:75], a[112:115], v[120:123]
buffer_load_dwordx4 a[20:23], v1, s[4:7], s22 offen offset:1024 sc1
v_mfma_f32_16x16x32_bf16 v[120:123], a[76:79], a[108:111], v[120:123]
ds_read_b64_tr_b16 a[152:153], v16 offset:3400
v_mov_b32 v228, 0
v_mfma_f32_16x16x32_bf16 v[120:123], a[80:83], a[104:107], v[120:123]
ds_read_b64_tr_b16 a[154:155], v16 offset:3392
v_mov_b32 v229, 0
v_mfma_f32_16x16x32_bf16 v[120:123], a[84:87], a[100:103], v[120:123]
ds_read_b128 a[184:187], v17 offset:3200
v_mov_b32 v230, 0
v_mfma_f32_16x16x32_bf16 v[120:123], a[88:91], a[96:99], v[120:123]
buffer_load_dwordx4 a[24:27], v1, s[4:7], s22 offen offset:2048 sc1
v_mfma_f32_16x16x32_bf16 v[124:127], a[64:67], a[124:127], v[124:127]
ds_read_b64_tr_b16 a[156:157], v16 offset:3912
v_mov_b32 v231, 0
v_mfma_f32_16x16x32_bf16 v[124:127], a[68:71], a[120:123], v[124:127]
ds_read_b64_tr_b16 a[158:159], v16 offset:3904
v_mov_b32 v232, 0
v_mfma_f32_16x16x32_bf16 v[124:127], a[72:75], a[116:119], v[124:127]
ds_read_b128 a[188:191], v17 offset:3712
v_mov_b32 v233, 0
v_mfma_f32_16x16x32_bf16 v[124:127], a[76:79], a[112:115], v[124:127]
buffer_load_dwordx4 a[28:31], v1, s[4:7], s22 offen offset:3072 sc1
v_mfma_f32_16x16x32_bf16 v[124:127], a[80:83], a[108:111], v[124:127]
s_add_u32 s22, s78, 32768
buffer_load_dwordx4 a[32:35], v1, s[4:7], s22 offen offset:0 sc1
v_mfma_f32_16x16x32_bf16 v[124:127], a[84:87], a[104:107], v[124:127]
buffer_load_dwordx4 a[36:39], v1, s[4:7], s22 offen offset:1024 sc1
v_mfma_f32_16x16x32_bf16 v[124:127], a[88:91], a[100:103], v[124:127]
buffer_load_dwordx4 a[40:43], v1, s[4:7], s22 offen offset:2048 sc1
v_mfma_f32_16x16x32_bf16 v[124:127], a[92:95], a[96:99], v[124:127]
s_waitcnt lgkmcnt(3)
buffer_load_dwordx4 a[44:47], v1, s[4:7], s22 offen offset:3072 sc1
v_mfma_f32_16x16x32_bf16 v[96:99], a[128:131], a[160:163], v[96:99]
s_add_u32 s22, s78, 36864
ds_read_b64_tr_b16 a[64:65], v16 offset:392
v_mov_b32 v234, 0
v_mfma_f32_16x16x32_bf16 v[100:103], a[128:131], a[164:167], v[100:103]
ds_read_b64_tr_b16 a[66:67], v16 offset:384
v_mov_b32 v235, 0
v_mfma_f32_16x16x32_bf16 v[100:103], a[132:135], a[160:163], v[100:103]
ds_read_b128 a[96:99], v17 offset:64
v_mov_b32 v236, 0
v_mfma_f32_16x16x32_bf16 v[104:107], a[128:131], a[168:171], v[104:107]
ds_read_b64 v[36:37], v18 offset:0
v_mov_b32 v237, 0
v_mfma_f32_16x16x32_bf16 v[104:107], a[132:135], a[164:167], v[104:107]
ds_read_b64_tr_b16 a[68:69], v16 offset:904
v_mov_b32 v238, 0
v_mfma_f32_16x16x32_bf16 v[104:107], a[136:139], a[160:163], v[104:107]
ds_read_b64_tr_b16 a[70:71], v16 offset:896
v_mov_b32 v239, 0
v_mfma_f32_16x16x32_bf16 v[108:111], a[128:131], a[172:175], v[108:111]
ds_read_b128 a[100:103], v17 offset:576
v_mov_b32 v240, 0
v_mfma_f32_16x16x32_bf16 v[108:111], a[132:135], a[168:171], v[108:111]
ds_read_b64 v[38:39], v18 offset:512
v_mov_b32 v241, 0
v_mfma_f32_16x16x32_bf16 v[108:111], a[136:139], a[164:167], v[108:111]
ds_read_b64_tr_b16 a[72:73], v16 offset:1416
v_mov_b32 v242, 0
v_mfma_f32_16x16x32_bf16 v[108:111], a[140:143], a[160:163], v[108:111]
ds_read_b64_tr_b16 a[74:75], v16 offset:1408
v_mov_b32 v243, 0
v_mfma_f32_16x16x32_bf16 v[112:115], a[128:131], a[176:179], v[112:115]
ds_read_b128 a[104:107], v17 offset:1088
v_mov_b32 v244, 0
v_mfma_f32_16x16x32_bf16 v[112:115], a[132:135], a[172:175], v[112:115]
ds_read_b64 v[44:45], v18 offset:1024
v_mov_b32 v245, 0
v_mfma_f32_16x16x32_bf16 v[112:115], a[136:139], a[168:171], v[112:115]
ds_read_b64_tr_b16 a[76:77], v16 offset:1928
v_mov_b32 v246, 0
v_mfma_f32_16x16x32_bf16 v[112:115], a[140:143], a[164:167], v[112:115]
ds_read_b64_tr_b16 a[78:79], v16 offset:1920
v_mov_b32 v247, 0
v_mfma_f32_16x16x32_bf16 v[112:115], a[144:147], a[160:163], v[112:115]
ds_read_b128 a[108:111], v17 offset:1600
v_mov_b32 v248, 0
v_mfma_f32_16x16x32_bf16 v[116:119], a[128:131], a[180:183], v[116:119]
ds_read_b64 v[46:47], v18 offset:1536
v_mov_b32 v249, 0
v_mfma_f32_16x16x32_bf16 v[116:119], a[132:135], a[176:179], v[116:119]
ds_read_b64_tr_b16 a[80:81], v16 offset:2440
v_mov_b32 v250, 0
v_mfma_f32_16x16x32_bf16 v[116:119], a[136:139], a[172:175], v[116:119]
ds_read_b64_tr_b16 a[82:83], v16 offset:2432
v_mov_b32 v251, 0
v_mfma_f32_16x16x32_bf16 v[116:119], a[140:143], a[168:171], v[116:119]
ds_read_b128 a[112:115], v17 offset:2112
v_mov_b32 v252, 0
v_mfma_f32_16x16x32_bf16 v[116:119], a[144:147], a[164:167], v[116:119]
ds_read_b64 v[52:53], v18 offset:2048
v_mov_b32 v253, 0
v_mfma_f32_16x16x32_bf16 v[116:119], a[148:151], a[160:163], v[116:119]
ds_read_b64_tr_b16 a[84:85], v16 offset:2952
v_mov_b32 v254, 0
v_mfma_f32_16x16x32_bf16 v[120:123], a[128:131], a[184:187], v[120:123]
ds_read_b64_tr_b16 a[86:87], v16 offset:2944
v_mov_b32 v255, 0
v_mfma_f32_16x16x32_bf16 v[120:123], a[132:135], a[180:183], v[120:123]
ds_read_b128 a[116:119], v17 offset:2624
v_mfma_f32_16x16x32_bf16 v[120:123], a[136:139], a[176:179], v[120:123]
ds_read_b64 v[54:55], v18 offset:2560
v_mfma_f32_16x16x32_bf16 v[120:123], a[140:143], a[172:175], v[120:123]
ds_read_b64_tr_b16 a[88:89], v16 offset:3464
v_mfma_f32_16x16x32_bf16 v[120:123], a[144:147], a[168:171], v[120:123]
ds_read_b64_tr_b16 a[90:91], v16 offset:3456
v_mfma_f32_16x16x32_bf16 v[120:123], a[148:151], a[164:167], v[120:123]
ds_read_b128 a[120:123], v17 offset:3136
v_mfma_f32_16x16x32_bf16 v[120:123], a[152:155], a[160:163], v[120:123]
s_waitcnt lgkmcnt(8)
ds_read_b64 v[60:61], v18 offset:3072
v_mfma_f32_16x16x32_bf16 v[124:127], a[128:131], a[188:191], v[124:127]
ds_read_b64_tr_b16 a[92:93], v16 offset:3976
v_mfma_f32_16x16x32_bf16 v[124:127], a[132:135], a[184:187], v[124:127]
ds_read_b64_tr_b16 a[94:95], v16 offset:3968
v_mfma_f32_16x16x32_bf16 v[124:127], a[136:139], a[180:183], v[124:127]
ds_read_b128 a[124:127], v17 offset:3648
v_mfma_f32_16x16x32_bf16 v[124:127], a[140:143], a[176:179], v[124:127]
ds_read_b64 v[62:63], v18 offset:3584
v_mfma_f32_16x16x32_bf16 v[124:127], a[144:147], a[172:175], v[124:127]
buffer_load_dwordx4 a[48:51], v1, s[4:7], s22 offen offset:0 sc1
v_mfma_f32_16x16x32_bf16 v[124:127], a[148:151], a[168:171], v[124:127]
buffer_load_dwordx4 a[52:55], v1, s[4:7], s22 offen offset:1024 sc1
v_mfma_f32_16x16x32_bf16 v[124:127], a[152:155], a[164:167], v[124:127]
buffer_load_dwordx4 a[56:59], v1, s[4:7], s22 offen offset:2048 sc1
v_mfma_f32_16x16x32_bf16 v[124:127], a[156:159], a[160:163], v[124:127]
buffer_load_dwordx4 a[60:63], v1, s[4:7], s22 offen offset:3072 sc1
v_mfma_f32_16x16x32_bf16 v[96:99], a[64:67], a[96:99], v[96:99]
ds_read_b64_tr_b16 a[128:129], v16 offset:456
v_mfma_f32_16x16x32_bf16 v[100:103], a[64:67], a[100:103], v[100:103]
ds_read_b64_tr_b16 a[130:131], v16 offset:448
v_mfma_f32_16x16x32_bf16 v[100:103], a[68:71], a[96:99], v[100:103]
ds_read_b128 a[160:163], v17 offset:0
v_mfma_f32_16x16x32_bf16 v[104:107], a[64:67], a[104:107], v[104:107]
v_mfma_f32_16x16x32_bf16 v[104:107], a[68:71], a[100:103], v[104:107]
ds_read_b64_tr_b16 a[132:133], v16 offset:968
v_mfma_f32_16x16x32_bf16 v[104:107], a[72:75], a[96:99], v[104:107]
ds_read_b64_tr_b16 a[134:135], v16 offset:960
v_mfma_f32_16x16x32_bf16 v[108:111], a[64:67], a[108:111], v[108:111]
ds_read_b128 a[164:167], v17 offset:512
v_mfma_f32_16x16x32_bf16 v[108:111], a[68:71], a[104:107], v[108:111]
v_mfma_f32_16x16x32_bf16 v[108:111], a[72:75], a[100:103], v[108:111]
ds_read_b64_tr_b16 a[136:137], v16 offset:1480
v_mfma_f32_16x16x32_bf16 v[108:111], a[76:79], a[96:99], v[108:111]
ds_read_b64_tr_b16 a[138:139], v16 offset:1472
v_mfma_f32_16x16x32_bf16 v[112:115], a[64:67], a[112:115], v[112:115]
ds_read_b128 a[168:171], v17 offset:1024
v_mfma_f32_16x16x32_bf16 v[112:115], a[68:71], a[108:111], v[112:115]
v_mfma_f32_16x16x32_bf16 v[112:115], a[72:75], a[104:107], v[112:115]
ds_read_b64_tr_b16 a[140:141], v16 offset:1992
v_mfma_f32_16x16x32_bf16 v[112:115], a[76:79], a[100:103], v[112:115]
ds_read_b64_tr_b16 a[142:143], v16 offset:1984
v_mfma_f32_16x16x32_bf16 v[112:115], a[80:83], a[96:99], v[112:115]
s_waitcnt lgkmcnt(6)
ds_read_b128 a[172:175], v17 offset:1536
v_mfma_f32_16x16x32_bf16 v[116:119], a[64:67], a[116:119], v[116:119]
v_mfma_f32_16x16x32_bf16 v[116:119], a[68:71], a[112:115], v[116:119]
ds_read_b64_tr_b16 a[144:145], v16 offset:2504
v_mfma_f32_16x16x32_bf16 v[116:119], a[72:75], a[108:111], v[116:119]
ds_read_b64_tr_b16 a[146:147], v16 offset:2496
v_mfma_f32_16x16x32_bf16 v[116:119], a[76:79], a[104:107], v[116:119]
ds_read_b128 a[176:179], v17 offset:2048
v_mfma_f32_16x16x32_bf16 v[116:119], a[80:83], a[100:103], v[116:119]
v_mfma_f32_16x16x32_bf16 v[116:119], a[84:87], a[96:99], v[116:119]
ds_read_b64_tr_b16 a[148:149], v16 offset:3016
v_mfma_f32_16x16x32_bf16 v[120:123], a[64:67], a[120:123], v[120:123]
ds_read_b64_tr_b16 a[150:151], v16 offset:3008
v_mfma_f32_16x16x32_bf16 v[120:123], a[68:71], a[116:119], v[120:123]
ds_read_b128 a[180:183], v17 offset:2560
v_mfma_f32_16x16x32_bf16 v[120:123], a[72:75], a[112:115], v[120:123]
v_mfma_f32_16x16x32_bf16 v[120:123], a[76:79], a[108:111], v[120:123]
ds_read_b64_tr_b16 a[152:153], v16 offset:3528
v_mfma_f32_16x16x32_bf16 v[120:123], a[80:83], a[104:107], v[120:123]
ds_read_b64_tr_b16 a[154:155], v16 offset:3520
v_mfma_f32_16x16x32_bf16 v[120:123], a[84:87], a[100:103], v[120:123]
ds_read_b128 a[184:187], v17 offset:3072
v_mfma_f32_16x16x32_bf16 v[120:123], a[88:91], a[96:99], v[120:123]
v_mfma_f32_16x16x32_bf16 v[124:127], a[64:67], a[124:127], v[124:127]
ds_read_b64_tr_b16 a[156:157], v16 offset:4040
v_mfma_f32_16x16x32_bf16 v[124:127], a[68:71], a[120:123], v[124:127]
ds_read_b64_tr_b16 a[158:159], v16 offset:4032
v_mfma_f32_16x16x32_bf16 v[124:127], a[72:75], a[116:119], v[124:127]
ds_read_b128 a[188:191], v17 offset:3584
v_mfma_f32_16x16x32_bf16 v[124:127], a[76:79], a[112:115], v[124:127]
v_mfma_f32_16x16x32_bf16 v[124:127], a[80:83], a[108:111], v[124:127]
v_mfma_f32_16x16x32_bf16 v[124:127], a[84:87], a[104:107], v[124:127]
v_mfma_f32_16x16x32_bf16 v[124:127], a[88:91], a[100:103], v[124:127]
v_mfma_f32_16x16x32_bf16 v[124:127], a[92:95], a[96:99], v[124:127]
v_mfma_f32_16x16x32_bf16 v[96:99], a[128:131], a[160:163], v[96:99]
s_waitcnt lgkmcnt(3)
v_mfma_f32_16x16x32_bf16 v[100:103], a[128:131], a[164:167], v[100:103]
v_mfma_f32_16x16x32_bf16 v[100:103], a[132:135], a[160:163], v[100:103]
v_mfma_f32_16x16x32_bf16 v[104:107], a[128:131], a[168:171], v[104:107]
v_mfma_f32_16x16x32_bf16 v[104:107], a[132:135], a[164:167], v[104:107]
v_mfma_f32_16x16x32_bf16 v[104:107], a[136:139], a[160:163], v[104:107]
v_mfma_f32_16x16x32_bf16 v[108:111], a[128:131], a[172:175], v[108:111]
v_mfma_f32_16x16x32_bf16 v[108:111], a[132:135], a[168:171], v[108:111]
v_mfma_f32_16x16x32_bf16 v[108:111], a[136:139], a[164:167], v[108:111]
v_lshlrev_b32 v10, 16, v36
v_fmac_f32 v96, v19, v10
v_mfma_f32_16x16x32_bf16 v[108:111], a[140:143], a[160:163], v[108:111]
v_and_b32 v11, 0xffff0000, v36
v_fmac_f32 v97, v19, v11
v_mfma_f32_16x16x32_bf16 v[112:115], a[128:131], a[176:179], v[112:115]
v_lshlrev_b32 v12, 16, v37
v_fmac_f32 v98, v19, v12
v_mfma_f32_16x16x32_bf16 v[112:115], a[132:135], a[172:175], v[112:115]
v_and_b32 v13, 0xffff0000, v37
v_fmac_f32 v99, v19, v13
v_mfma_f32_16x16x32_bf16 v[112:115], a[136:139], a[168:171], v[112:115]
v_cvt_pk_bf16_f32 v96, v96, v97
v_cvt_pk_bf16_f32 v97, v98, v99
v_mfma_f32_16x16x32_bf16 v[112:115], a[140:143], a[164:167], v[112:115]
buffer_store_dwordx2 v[96:97], v8, s[4:7], s83 offen offset:0 sc1
v_mfma_f32_16x16x32_bf16 v[112:115], a[144:147], a[160:163], v[112:115]
v_lshlrev_b32 v10, 16, v38
v_fmac_f32 v100, v19, v10
v_mfma_f32_16x16x32_bf16 v[116:119], a[128:131], a[180:183], v[116:119]
v_and_b32 v11, 0xffff0000, v38
v_fmac_f32 v101, v19, v11
v_mfma_f32_16x16x32_bf16 v[116:119], a[132:135], a[176:179], v[116:119]
v_lshlrev_b32 v12, 16, v39
v_fmac_f32 v102, v19, v12
v_mfma_f32_16x16x32_bf16 v[116:119], a[136:139], a[172:175], v[116:119]
v_and_b32 v13, 0xffff0000, v39
v_fmac_f32 v103, v19, v13
v_mfma_f32_16x16x32_bf16 v[116:119], a[140:143], a[168:171], v[116:119]
v_cvt_pk_bf16_f32 v100, v100, v101
v_cvt_pk_bf16_f32 v101, v102, v103
v_mfma_f32_16x16x32_bf16 v[116:119], a[144:147], a[164:167], v[116:119]
buffer_store_dwordx2 v[100:101], v8, s[4:7], s83 offen offset:512 sc1
v_mfma_f32_16x16x32_bf16 v[116:119], a[148:151], a[160:163], v[116:119]
v_lshlrev_b32 v10, 16, v44
v_fmac_f32 v104, v19, v10
v_mfma_f32_16x16x32_bf16 v[120:123], a[128:131], a[184:187], v[120:123]
v_and_b32 v11, 0xffff0000, v44
v_fmac_f32 v105, v19, v11
v_mfma_f32_16x16x32_bf16 v[120:123], a[132:135], a[180:183], v[120:123]
v_lshlrev_b32 v12, 16, v45
v_fmac_f32 v106, v19, v12
v_mfma_f32_16x16x32_bf16 v[120:123], a[136:139], a[176:179], v[120:123]
v_and_b32 v13, 0xffff0000, v45
v_fmac_f32 v107, v19, v13
v_mfma_f32_16x16x32_bf16 v[120:123], a[140:143], a[172:175], v[120:123]
v_cvt_pk_bf16_f32 v104, v104, v105
v_cvt_pk_bf16_f32 v105, v106, v107
v_mfma_f32_16x16x32_bf16 v[120:123], a[144:147], a[168:171], v[120:123]
PAD_31:
s_cbranch_execz M_tret
buffer_store_dwordx2 v[104:105], v8, s[4:7], s83 offen offset:1024 sc1
v_mfma_f32_16x16x32_bf16 v[120:123], a[148:151], a[164:167], v[120:123]
v_lshlrev_b32 v10, 16, v46
v_fmac_f32 v108, v19, v10
v_mfma_f32_16x16x32_bf16 v[120:123], a[152:155], a[160:163], v[120:123]
s_waitcnt lgkmcnt(0)
v_and_b32 v11, 0xffff0000, v46
v_fmac_f32 v109, v19, v11
v_mfma_f32_16x16x32_bf16 v[124:127], a[128:131], a[188:191], v[124:127]
v_lshlrev_b32 v12, 16, v47
v_fmac_f32 v110, v19, v12
v_mfma_f32_16x16x32_bf16 v[124:127], a[132:135], a[184:187], v[124:127]
v_and_b32 v13, 0xffff0000, v47
v_fmac_f32 v111, v19, v13
v_mfma_f32_16x16x32_bf16 v[124:127], a[136:139], a[180:183], v[124:127]
v_cvt_pk_bf16_f32 v108, v108, v109
v_cvt_pk_bf16_f32 v109, v110, v111
v_mfma_f32_16x16x32_bf16 v[124:127], a[140:143], a[176:179], v[124:127]
buffer_store_dwordx2 v[108:109], v8, s[4:7], s83 offen offset:1536 sc1
v_mfma_f32_16x16x32_bf16 v[124:127], a[144:147], a[172:175], v[124:127]
v_lshlrev_b32 v10, 16, v52
v_fmac_f32 v112, v19, v10
v_mfma_f32_16x16x32_bf16 v[124:127], a[148:151], a[168:171], v[124:127]
v_and_b32 v11, 0xffff0000, v52
v_fmac_f32 v113, v19, v11
v_mfma_f32_16x16x32_bf16 v[124:127], a[152:155], a[164:167], v[124:127]
v_lshlrev_b32 v12, 16, v53
v_fmac_f32 v114, v19, v12
v_mfma_f32_16x16x32_bf16 v[124:127], a[156:159], a[160:163], v[124:127]
v_and_b32 v13, 0xffff0000, v53
v_fmac_f32 v115, v19, v13
v_cvt_pk_bf16_f32 v112, v112, v113
v_cvt_pk_bf16_f32 v113, v114, v115
buffer_store_dwordx2 v[112:113], v8, s[4:7], s83 offen offset:2048 sc1
v_lshlrev_b32 v10, 16, v54
v_fmac_f32 v116, v19, v10
v_and_b32 v11, 0xffff0000, v54
v_fmac_f32 v117, v19, v11
v_lshlrev_b32 v12, 16, v55
v_fmac_f32 v118, v19, v12
v_and_b32 v13, 0xffff0000, v55
v_fmac_f32 v119, v19, v13
v_cvt_pk_bf16_f32 v116, v116, v117
v_cvt_pk_bf16_f32 v117, v118, v119
buffer_store_dwordx2 v[116:117], v8, s[4:7], s83 offen offset:2560 sc1
v_lshlrev_b32 v10, 16, v60
v_fmac_f32 v120, v19, v10
v_and_b32 v11, 0xffff0000, v60
v_fmac_f32 v121, v19, v11
v_lshlrev_b32 v12, 16, v61
v_fmac_f32 v122, v19, v12
v_and_b32 v13, 0xffff0000, v61
v_fmac_f32 v123, v19, v13
v_cvt_pk_bf16_f32 v120, v120, v121
v_cvt_pk_bf16_f32 v121, v122, v123
buffer_store_dwordx2 v[120:121], v8, s[4:7], s83 offen offset:3072 sc1
v_lshlrev_b32 v10, 16, v62
v_fmac_f32 v124, v19, v10
v_and_b32 v11, 0xffff0000, v62
v_fmac_f32 v125, v19, v11
v_lshlrev_b32 v12, 16, v63
v_fmac_f32 v126, v19, v12
v_and_b32 v13, 0xffff0000, v63
v_fmac_f32 v127, v19, v13
v_cvt_pk_bf16_f32 v124, v124, v125
v_cvt_pk_bf16_f32 v125, v126, v127
buffer_store_dwordx2 v[124:125], v8, s[4:7], s83 offen offset:3584 sc1
v_lshrrev_b32 v8, 7, v1
v_and_b32 v9, 6, v8
v_lshlrev_b32 v9, 4, v9
v_and_b32 v10, 0x70, v1
v_xor_b32 v9, v9, v10
v_mul_u32_u24 v8, 896, v8
v_add_u32 v8, v8, v9
v_accvgpr_write_b32 a184, v8
v_add_u32 v8, 6144, v8
v_accvgpr_write_b32 a185, v8
v_add_u32 v8, 6144, v8
v_accvgpr_write_b32 a186, v8
v_add_u32 v8, 6144, v8
v_accvgpr_write_b32 a187, v8
v_lshrrev_b32 v8, 6, v1
v_bfe_u32 v9, v1, 7, 2
v_lshlrev_b32 v9, 5, v9
v_lshl_add_u32 v8, v8, 7, v9
v_bfe_u32 v9, v1, 4, 2
v_lshl_add_u32 v8, v9, 3, v8
v_add_u32 v8, 32768, v8
v_accvgpr_write_b32 a188, v8
v_xor_b32 v9, 32, v8
v_accvgpr_write_b32 a189, v9
v_xor_b32 v9, 64, v8
v_accvgpr_write_b32 a190, v9
v_xor_b32 v9, 96, v8
v_accvgpr_write_b32 a191, v9
s_branch M_t2B
M_t2Br:
s_waitcnt vmcnt(8)
s_barrier
s_cmp_lg_u32 s24, 0
s_cbranch_scc1 K2_item
v_accvgpr_mov_b32 a0, a192
v_accvgpr_mov_b32 a1, a193
v_accvgpr_mov_b32 a2, a194
v_accvgpr_mov_b32 a3, a195
v_accvgpr_mov_b32 a4, a196
v_accvgpr_mov_b32 a5, a197
v_accvgpr_mov_b32 a6, a198
v_accvgpr_mov_b32 a7, a199
v_accvgpr_mov_b32 a8, a200
v_accvgpr_mov_b32 a9, a201
v_accvgpr_mov_b32 a10, a202
v_accvgpr_mov_b32 a11, a203
v_accvgpr_mov_b32 a12, a204
v_accvgpr_mov_b32 a13, a205
v_accvgpr_mov_b32 a14, a206
v_accvgpr_mov_b32 a15, a207
v_accvgpr_mov_b32 a16, a208
v_accvgpr_mov_b32 a17, a209
v_accvgpr_mov_b32 a18, a210
v_accvgpr_mov_b32 a19, a211
v_accvgpr_mov_b32 a20, a212
v_accvgpr_mov_b32 a21, a213
v_accvgpr_mov_b32 a22, a214
v_accvgpr_mov_b32 a23, a215
v_accvgpr_mov_b32 a24, a216
v_accvgpr_mov_b32 a25, a217
v_accvgpr_mov_b32 a26, a218
v_accvgpr_mov_b32 a27, a219
v_accvgpr_mov_b32 a28, a220
v_accvgpr_mov_b32 a29, a221
v_accvgpr_mov_b32 a30, a222
v_accvgpr_mov_b32 a31, a223
v_accvgpr_mov_b32 a32, a224
v_accvgpr_mov_b32 a33, a225
v_accvgpr_mov_b32 a34, a226
v_accvgpr_mov_b32 a35, a227
v_accvgpr_mov_b32 a36, a228
v_accvgpr_mov_b32 a37, a229
v_accvgpr_mov_b32 a38, a230
v_accvgpr_mov_b32 a39, a231
v_accvgpr_mov_b32 a40, a232
v_accvgpr_mov_b32 a41, a233
v_accvgpr_mov_b32 a42, a234
v_accvgpr_mov_b32 a43, a235
v_accvgpr_mov_b32 a44, a236
v_accvgpr_mov_b32 a45, a237
v_accvgpr_mov_b32 a46, a238
v_accvgpr_mov_b32 a47, a239
v_accvgpr_mov_b32 a48, a240
v_accvgpr_mov_b32 a49, a241
v_accvgpr_mov_b32 a50, a242
v_accvgpr_mov_b32 a51, a243
v_accvgpr_mov_b32 a52, a244
v_accvgpr_mov_b32 a53, a245
v_accvgpr_mov_b32 a54, a246
v_accvgpr_mov_b32 a55, a247
v_accvgpr_mov_b32 a56, a248
v_accvgpr_mov_b32 a57, a249
v_accvgpr_mov_b32 a58, a250
v_accvgpr_mov_b32 a59, a251
v_accvgpr_mov_b32 a60, a252
v_accvgpr_mov_b32 a61, a253
v_accvgpr_mov_b32 a62, a254
v_accvgpr_mov_b32 a63, a255
s_branch K2_item
M_cend:
M_cspin:
Lp_16:
buffer_load_dword v14, v15, s[4:7], s70 offen sc1
s_waitcnt vmcnt(0)
v_cmp_gt_u32 vcc, 1, v14
s_cbranch_vccz Lpd_17
s_sleep 8
s_sub_u32 s101, s101, 1
s_cbranch_scc0 Lp_16
s_mov_b32 s101, 0
Lpd_17:
s_branch M_cok
M_kspin:
Lp_18:
buffer_load_dword v21, v20, s[4:7], s70 offen sc1
s_waitcnt vmcnt(0)
v_cmp_gt_u32 vcc, 1, v21
s_cbranch_vccz Lpd_19
s_sleep 8
s_sub_u32 s101, s101, 1
s_cbranch_scc0 Lp_18
s_mov_b32 s101, 0
Lpd_19:
s_branch M_kok
M_kspin2:
Lp_20:
buffer_load_dword v21, v20, s[4:7], s70 offen sc1
s_waitcnt vmcnt(0)
v_cmp_gt_u32 vcc, 1, v21
s_cbranch_vccz Lpd_21
s_sleep 8
s_sub_u32 s101, s101, 1
s_cbranch_scc0 Lp_20
s_mov_b32 s101, 0
Lpd_21:
s_branch M_kok2
M_vspin:
Lp_22:
buffer_load_dword v21, v15, s[4:7], s70 offen sc1
s_waitcnt vmcnt(0)
v_cmp_gt_u32 vcc, 1, v21
s_cbranch_vccz Lpd_23
s_sleep 8
s_sub_u32 s101, s101, 1
s_cbranch_scc0 Lp_22
s_mov_b32 s101, 0
Lpd_23:
s_branch M_vok
PAD_32:
s_cbranch_execz M_tret
K2_plain:
v_mfma_f32_16x16x32_bf16 v[128:131], a[64:67], v[96:99], v[128:131]
s_waitcnt lgkmcnt(6)
ds_read_b128 a[96:99], v2 offset:8192
v_add_f32 v24, v24, v26
v_mfma_f32_16x16x32_bf16 v[128:131], a[68:71], v[100:103], v[128:131]
s_waitcnt lgkmcnt(5)
v_mfma_f32_16x16x32_bf16 v[132:135], a[68:71], v[108:111], v[132:135]
s_mov_b64 s[36:37], s[86:87]
ds_read_b128 a[100:103], v2 offset:9216
v_add_f32 v25, v25, v27
v_mfma_f32_16x16x32_bf16 v[132:135], a[64:67], v[104:107], v[132:135]
s_mov_b32 s38, 3670016
v_exp_f32 v8, v68
v_mfma_f32_16x16x32_bf16 v[136:139], a[72:75], v[96:99], v[136:139]
s_mov_b32 s39, 0x20000
ds_read_b128 a[104:107], v2 offset:10240
v_accvgpr_read_b32 v112, a184
v_mfma_f32_16x16x32_bf16 v[136:139], a[76:79], v[100:103], v[136:139]
v_accvgpr_read_b32 v113, a185
v_accvgpr_read_b32 v114, a186
v_mfma_f32_16x16x32_bf16 v[140:143], a[76:79], v[108:111], v[140:143]
ds_read_b128 a[108:111], v2 offset:11264
v_accvgpr_read_b32 v115, a187
v_mfma_f32_16x16x32_bf16 v[140:143], a[72:75], v[104:107], v[140:143]
s_waitcnt lgkmcnt(5)
v_accvgpr_read_b32 v116, a188
v_accvgpr_read_b32 v117, a189
v_mfma_f32_16x16x32_bf16 v[144:147], a[80:83], v[96:99], v[144:147]
ds_read_b128 a[112:115], v2 offset:12288
v_accvgpr_read_b32 v118, a190
v_mfma_f32_16x16x32_bf16 v[144:147], a[84:87], v[100:103], v[144:147]
v_accvgpr_read_b32 v119, a191
v_mfma_f32_16x16x32_bf16 v[148:151], a[84:87], v[108:111], v[148:151]
s_add_u32 m0, s18, 32768
ds_read_b128 a[116:119], v2 offset:13312
v_cvt_pk_bf16_f32 v128, v128, v129
v_mfma_f32_16x16x32_bf16 v[148:151], a[80:83], v[104:107], v[148:151]
buffer_load_dwordx4 v112, s[36:39], s81 offen offset:0 lds
v_mfma_f32_16x16x32_bf16 v[152:155], a[88:91], v[96:99], v[152:155]
s_waitcnt lgkmcnt(4)
ds_read_b128 a[120:123], v2 offset:14336
v_cvt_pk_bf16_f32 v129, v130, v131
v_mfma_f32_16x16x32_bf16 v[152:155], a[92:95], v[100:103], v[152:155]
v_exp_f32 v9, v69
v_mfma_f32_16x16x32_bf16 v[156:159], a[92:95], v[108:111], v[156:159]
ds_read_b128 a[124:127], v2 offset:15360
v_add_f32 v27, v8, v9
v_mfma_f32_16x16x32_bf16 v[156:159], a[88:91], v[104:107], v[156:159]
buffer_load_dwordx4 v113, s[36:39], s81 offen offset:1024 lds
v_mfma_f32_16x16x32_bf16 v[160:163], a[96:99], v[96:99], v[160:163]
ds_read_b128 a[64:67], v2 offset:16384
v_cvt_pk_bf16_f32 v120, v8, v9
v_mfma_f32_16x16x32_bf16 v[160:163], a[100:103], v[100:103], v[160:163]
v_exp_f32 v10, v70
v_mfma_f32_16x16x32_bf16 v[164:167], a[100:103], v[108:111], v[164:167]
ds_read_b128 a[68:71], v2 offset:17408
v_add_f32 v27, v27, v10
v_mfma_f32_16x16x32_bf16 v[164:167], a[96:99], v[104:107], v[164:167]
s_waitcnt lgkmcnt(4)
buffer_load_dwordx4 v114, s[36:39], s81 offen offset:2048 lds
v_mfma_f32_16x16x32_bf16 v[168:171], a[104:107], v[96:99], v[168:171]
ds_read_b128 a[72:75], v2 offset:18432
v_cvt_pk_bf16_f32 v130, v136, v137
v_mfma_f32_16x16x32_bf16 v[168:171], a[108:111], v[100:103], v[168:171]
v_exp_f32 v11, v71
v_mfma_f32_16x16x32_bf16 v[172:175], a[108:111], v[108:111], v[172:175]
ds_read_b128 a[76:79], v2 offset:19456
v_add_f32 v27, v27, v11
v_mfma_f32_16x16x32_bf16 v[172:175], a[104:107], v[104:107], v[172:175]
buffer_load_dwordx4 v115, s[36:39], s81 offen offset:3072 lds
v_mfma_f32_16x16x32_bf16 v[176:179], a[112:115], v[96:99], v[176:179]
ds_read_b128 a[80:83], v2 offset:20480
v_cvt_pk_bf16_f32 v121, v10, v11
v_mfma_f32_16x16x32_bf16 v[176:179], a[116:119], v[100:103], v[176:179]
s_waitcnt lgkmcnt(4)
v_exp_f32 v12, v76
v_mfma_f32_16x16x32_bf16 v[180:183], a[116:119], v[108:111], v[180:183]
s_add_u32 s81, s81, 28672
ds_read_b128 a[84:87], v2 offset:21504
v_add_f32 v27, v27, v12
v_mfma_f32_16x16x32_bf16 v[180:183], a[112:115], v[104:107], v[180:183]
s_add_u32 m0, s18, 36864
v_exp_f32 v13, v77
v_mfma_f32_16x16x32_bf16 v[184:187], a[120:123], v[96:99], v[184:187]
ds_read_b128 a[88:91], v2 offset:22528
v_add_f32 v27, v27, v13
v_mfma_f32_16x16x32_bf16 v[184:187], a[124:127], v[100:103], v[184:187]
buffer_load_dwordx4 v112, s[36:39], s81 offen offset:0 lds
v_mfma_f32_16x16x32_bf16 v[188:191], a[124:127], v[108:111], v[188:191]
ds_read_b128 a[92:95], v2 offset:23552
v_cvt_pk_bf16_f32 v122, v12, v13
v_mfma_f32_16x16x32_bf16 v[188:191], a[120:123], v[104:107], v[188:191]
v_exp_f32 v14, v78
v_mfma_f32_16x16x32_bf16 v[192:195], a[64:67], v[96:99], v[192:195]
s_waitcnt lgkmcnt(4)
ds_read_b128 a[96:99], v2 offset:24576
v_add_f32 v27, v27, v14
v_mfma_f32_16x16x32_bf16 v[192:195], a[68:71], v[100:103], v[192:195]
buffer_load_dwordx4 v113, s[36:39], s81 offen offset:1024 lds
v_mfma_f32_16x16x32_bf16 v[196:199], a[68:71], v[108:111], v[196:199]
ds_read_b128 a[100:103], v2 offset:25600
v_cvt_pk_bf16_f32 v131, v138, v139
v_mfma_f32_16x16x32_bf16 v[196:199], a[64:67], v[104:107], v[196:199]
v_exp_f32 v15, v79
v_mfma_f32_16x16x32_bf16 v[200:203], a[72:75], v[96:99], v[200:203]
ds_read_b128 a[104:107], v2 offset:26624
v_add_f32 v27, v27, v15
v_mfma_f32_16x16x32_bf16 v[200:203], a[76:79], v[100:103], v[200:203]
buffer_load_dwordx4 v114, s[36:39], s81 offen offset:2048 lds
v_mfma_f32_16x16x32_bf16 v[204:207], a[76:79], v[108:111], v[204:207]
ds_read_b128 a[108:111], v2 offset:27648
v_cvt_pk_bf16_f32 v123, v14, v15
v_mfma_f32_16x16x32_bf16 v[204:207], a[72:75], v[104:107], v[204:207]
s_waitcnt lgkmcnt(4)
v_exp_f32 v8, v84
v_mfma_f32_16x16x32_bf16 v[208:211], a[80:83], v[96:99], v[208:211]
ds_read_b128 a[112:115], v2 offset:28672
v_add_f32 v27, v27, v8
v_mfma_f32_16x16x32_bf16 v[208:211], a[84:87], v[100:103], v[208:211]
buffer_load_dwordx4 v115, s[36:39], s81 offen offset:3072 lds
v_mfma_f32_16x16x32_bf16 v[212:215], a[84:87], v[108:111], v[212:215]
ds_read_b128 a[116:119], v2 offset:29696
v_cvt_pk_bf16_f32 v144, v144, v145
v_mfma_f32_16x16x32_bf16 v[212:215], a[80:83], v[104:107], v[212:215]
v_exp_f32 v9, v85
v_mfma_f32_16x16x32_bf16 v[216:219], a[88:91], v[96:99], v[216:219]
s_sub_u32 s81, s81, 28544
ds_read_b128 a[120:123], v2 offset:30720
v_add_f32 v27, v27, v9
v_mfma_f32_16x16x32_bf16 v[216:219], a[92:95], v[100:103], v[216:219]
v_exp_f32 v10, v86
v_mfma_f32_16x16x32_bf16 v[220:223], a[92:95], v[108:111], v[220:223]
s_waitcnt vmcnt(8) lgkmcnt(4)
ds_read_b128 a[124:127], v2 offset:31744
v_cvt_pk_bf16_f32 v124, v8, v9
v_mfma_f32_16x16x32_bf16 v[220:223], a[88:91], v[104:107], v[220:223]
s_barrier
v_mfma_f32_16x16x32_bf16 v[224:227], a[96:99], v[96:99], v[224:227]
ds_read_b128 a[64:67], v1 offset:0
v_add_f32 v27, v27, v10
v_mfma_f32_16x16x32_bf16 v[224:227], a[100:103], v[100:103], v[224:227]
v_exp_f32 v11, v87
v_mfma_f32_16x16x32_bf16 v[228:231], a[100:103], v[108:111], v[228:231]
ds_read_b128 a[68:71], v1 offset:1024
v_add_f32 v27, v27, v11
v_mfma_f32_16x16x32_bf16 v[228:231], a[96:99], v[104:107], v[228:231]
v_exp_f32 v12, v92
v_mfma_f32_16x16x32_bf16 v[232:235], a[104:107], v[96:99], v[232:235]
s_waitcnt lgkmcnt(4)
ds_read_b128 a[72:75], v1 offset:2048
v_cvt_pk_bf16_f32 v125, v10, v11
v_mfma_f32_16x16x32_bf16 v[232:235], a[108:111], v[100:103], v[232:235]
v_exp_f32 v13, v93
v_mfma_f32_16x16x32_bf16 v[236:239], a[108:111], v[108:111], v[236:239]
ds_read_b128 a[76:79], v1 offset:3072
v_add_f32 v27, v27, v12
v_mfma_f32_16x16x32_bf16 v[236:239], a[104:107], v[104:107], v[236:239]
v_exp_f32 v14, v94
v_mfma_f32_16x16x32_bf16 v[240:243], a[112:115], v[96:99], v[240:243]
ds_read_b128 a[80:83], v1 offset:4096
v_add_f32 v27, v27, v13
v_mfma_f32_16x16x32_bf16 v[240:243], a[116:119], v[100:103], v[240:243]
v_exp_f32 v15, v95
v_mfma_f32_16x16x32_bf16 v[244:247], a[116:119], v[108:111], v[244:247]
ds_read_b128 a[84:87], v1 offset:5120
v_cvt_pk_bf16_f32 v126, v12, v13
v_mfma_f32_16x16x32_bf16 v[244:247], a[112:115], v[104:107], v[244:247]
s_waitcnt lgkmcnt(4)
v_add_f32 v27, v27, v14
v_add_f32 v27, v27, v15
v_mfma_f32_16x16x32_bf16 v[248:251], a[120:123], v[96:99], v[248:251]
ds_read_b128 a[88:91], v1 offset:6144
v_cvt_pk_bf16_f32 v127, v14, v15
v_mfma_f32_16x16x32_bf16 v[248:251], a[124:127], v[100:103], v[248:251]
v_cmp_nge_f32 vcc, s25, v27
v_cvt_pk_bf16_f32 v145, v146, v147
v_mfma_f32_16x16x32_bf16 v[252:255], a[124:127], v[108:111], v[252:255]
ds_read_b128 a[92:95], v1 offset:7168
v_cvt_pk_bf16_f32 v146, v152, v153
v_mfma_f32_16x16x32_bf16 v[252:255], a[120:123], v[104:107], v[252:255]
s_waitcnt lgkmcnt(2)
v_cvt_pk_bf16_f32 v147, v154, v155
v_cvt_pk_bf16_f32 v160, v160, v161
s_cbranch_vccnz Lstub_12
Lback_13:
v_mfma_f32_16x16x32_bf16 v[132:135], a[64:67], v[120:123], v[132:135]
s_lshl_b32 s8, s29, 3
ds_read_b128 a[96:99], v1 offset:8192
v_add_f32 v25, v25, v27
v_mfma_f32_16x16x32_bf16 v[132:135], a[68:71], v[124:127], v[132:135]
s_add_u32 s8, s8, s3
ds_read_b128 a[100:103], v1 offset:9216
v_cvt_pk_bf16_f32 v161, v162, v163
v_mfma_f32_16x16x32_bf16 v[140:143], a[72:75], v[120:123], v[140:143]
s_lshl_b32 s8, s8, 4
ds_read_b128 a[104:107], v1 offset:10240
v_cvt_pk_bf16_f32 v162, v168, v169
v_mfma_f32_16x16x32_bf16 v[140:143], a[76:79], v[124:127], v[140:143]
s_add_u32 s8, s8, s20
ds_read_b128 a[108:111], v1 offset:11264
v_cvt_pk_bf16_f32 v163, v170, v171
v_mfma_f32_16x16x32_bf16 v[148:151], a[80:83], v[120:123], v[148:151]
s_mul_i32 s8, s8, 14336
ds_read_b128 a[112:115], v1 offset:12288
v_cvt_pk_bf16_f32 v176, v176, v177
v_mfma_f32_16x16x32_bf16 v[148:151], a[84:87], v[124:127], v[148:151]
s_waitcnt lgkmcnt(5)
s_add_u32 s8, s8, 104857600
ds_read_b128 a[116:119], v1 offset:13312
v_cvt_pk_bf16_f32 v177, v178, v179
v_mfma_f32_16x16x32_bf16 v[156:159], a[88:91], v[120:123], v[156:159]
s_add_u32 s12, s8, 917504
ds_read_b128 a[120:123], v1 offset:14336
v_cvt_pk_bf16_f32 v178, v184, v185
v_mfma_f32_16x16x32_bf16 v[156:159], a[92:95], v[124:127], v[156:159]
s_waitcnt lgkmcnt(6)
ds_read_b128 a[124:127], v1 offset:15360
v_cvt_pk_bf16_f32 v179, v186, v187
v_mfma_f32_16x16x32_bf16 v[164:167], a[96:99], v[120:123], v[164:167]
s_waitcnt lgkmcnt(6)
ds_read_b128 a[64:67], v1 offset:16384
v_cvt_pk_bf16_f32 v192, v192, v193
v_mfma_f32_16x16x32_bf16 v[164:167], a[100:103], v[124:127], v[164:167]
s_waitcnt lgkmcnt(6)
ds_read_b128 a[68:71], v1 offset:17408
v_cvt_pk_bf16_f32 v193, v194, v195
v_mfma_f32_16x16x32_bf16 v[172:175], a[104:107], v[120:123], v[172:175]
s_waitcnt lgkmcnt(6)
ds_read_b128 a[72:75], v1 offset:18432
v_cvt_pk_bf16_f32 v194, v200, v201
v_mfma_f32_16x16x32_bf16 v[172:175], a[108:111], v[124:127], v[172:175]
s_waitcnt lgkmcnt(6)
ds_read_b128 a[76:79], v1 offset:19456
v_cvt_pk_bf16_f32 v195, v202, v203
v_mfma_f32_16x16x32_bf16 v[180:183], a[112:115], v[120:123], v[180:183]
s_waitcnt lgkmcnt(6)
ds_read_b128 a[80:83], v1 offset:20480
v_cvt_pk_bf16_f32 v208, v208, v209
v_mfma_f32_16x16x32_bf16 v[180:183], a[116:119], v[124:127], v[180:183]
s_waitcnt lgkmcnt(6)
ds_read_b128 a[84:87], v1 offset:21504
v_cvt_pk_bf16_f32 v209, v210, v211
v_mfma_f32_16x16x32_bf16 v[188:191], a[120:123], v[120:123], v[188:191]
s_waitcnt lgkmcnt(6)
ds_read_b128 a[88:91], v1 offset:22528
v_cvt_pk_bf16_f32 v210, v216, v217
v_mfma_f32_16x16x32_bf16 v[188:191], a[124:127], v[124:127], v[188:191]
s_waitcnt lgkmcnt(6)
ds_read_b128 a[92:95], v1 offset:23552
v_cvt_pk_bf16_f32 v211, v218, v219
v_mfma_f32_16x16x32_bf16 v[196:199], a[64:67], v[120:123], v[196:199]
s_waitcnt lgkmcnt(6)
ds_read_b128 a[96:99], v1 offset:24576
v_cvt_pk_bf16_f32 v224, v224, v225
v_mfma_f32_16x16x32_bf16 v[196:199], a[68:71], v[124:127], v[196:199]
s_waitcnt lgkmcnt(6)
ds_read_b128 a[100:103], v1 offset:25600
v_cvt_pk_bf16_f32 v225, v226, v227
v_mfma_f32_16x16x32_bf16 v[204:207], a[72:75], v[120:123], v[204:207]
s_waitcnt lgkmcnt(6)
ds_read_b128 a[104:107], v1 offset:26624
v_cvt_pk_bf16_f32 v226, v232, v233
v_mfma_f32_16x16x32_bf16 v[204:207], a[76:79], v[124:127], v[204:207]
s_waitcnt lgkmcnt(6)
ds_read_b128 a[108:111], v1 offset:27648
v_cvt_pk_bf16_f32 v227, v234, v235
v_mfma_f32_16x16x32_bf16 v[212:215], a[80:83], v[120:123], v[212:215]
s_waitcnt lgkmcnt(6)
ds_read_b128 a[112:115], v1 offset:28672
v_cvt_pk_bf16_f32 v240, v240, v241
v_mfma_f32_16x16x32_bf16 v[212:215], a[84:87], v[124:127], v[212:215]
s_waitcnt lgkmcnt(5)
ds_read_b128 a[116:119], v1 offset:29696
v_cvt_pk_bf16_f32 v241, v242, v243
v_mfma_f32_16x16x32_bf16 v[220:223], a[88:91], v[120:123], v[220:223]
s_add_u32 m0, s18, 98304
ds_read_b128 a[120:123], v1 offset:30720
v_cvt_pk_bf16_f32 v242, v248, v249
v_mfma_f32_16x16x32_bf16 v[220:223], a[92:95], v[124:127], v[220:223]
s_waitcnt lgkmcnt(6)
ds_read_b128 a[124:127], v1 offset:31744
v_cvt_pk_bf16_f32 v243, v250, v251
v_mfma_f32_16x16x32_bf16 v[228:231], a[96:99], v[120:123], v[228:231]
s_waitcnt lgkmcnt(6)
buffer_load_dwordx4 v112, s[36:39], s81 offen offset:0 lds
v_mfma_f32_16x16x32_bf16 v[228:231], a[100:103], v[124:127], v[228:231]
s_waitcnt lgkmcnt(5)
buffer_load_dwordx4 v113, s[36:39], s81 offen offset:1024 lds
v_mfma_f32_16x16x32_bf16 v[236:239], a[104:107], v[120:123], v[236:239]
s_waitcnt lgkmcnt(4)
buffer_load_dwordx4 v114, s[36:39], s81 offen offset:2048 lds
v_mfma_f32_16x16x32_bf16 v[236:239], a[108:111], v[124:127], v[236:239]
s_waitcnt lgkmcnt(1)
buffer_load_dwordx4 v115, s[36:39], s81 offen offset:3072 lds
v_mfma_f32_16x16x32_bf16 v[244:247], a[112:115], v[120:123], v[244:247]
s_add_u32 s81, s81, 28672
v_cvt_pk_bf16_f32 v132, v132, v133
v_cvt_pk_bf16_f32 v133, v134, v135
v_mfma_f32_16x16x32_bf16 v[244:247], a[116:119], v[124:127], v[244:247]
s_add_u32 m0, s18, 102400
v_cvt_pk_bf16_f32 v134, v140, v141
v_cvt_pk_bf16_f32 v135, v142, v143
v_mfma_f32_16x16x32_bf16 v[252:255], a[120:123], v[120:123], v[252:255]
s_waitcnt lgkmcnt(0)
buffer_load_dwordx4 v112, s[36:39], s81 offen offset:0 lds
v_mfma_f32_16x16x32_bf16 v[252:255], a[124:127], v[124:127], v[252:255]
buffer_load_dwordx4 v113, s[36:39], s81 offen offset:1024 lds
buffer_load_dwordx4 v114, s[36:39], s81 offen offset:2048 lds
buffer_load_dwordx4 v115, s[36:39], s81 offen offset:3072 lds
s_sub_u32 s81, s81, 28544
s_add_u32 m0, s18, 131072
s_nop 0
buffer_load_dwordx4 v112, s[36:39], s81 offen offset:0 lds
v_cvt_pk_bf16_f32 v148, v148, v149
v_cvt_pk_bf16_f32 v149, v150, v151
v_cvt_pk_bf16_f32 v150, v156, v157
v_cvt_pk_bf16_f32 v151, v158, v159
buffer_load_dwordx4 v113, s[36:39], s81 offen offset:1024 lds
v_cvt_pk_bf16_f32 v164, v164, v165
v_cvt_pk_bf16_f32 v165, v166, v167
v_cvt_pk_bf16_f32 v166, v172, v173
v_cvt_pk_bf16_f32 v167, v174, v175
buffer_load_dwordx4 v114, s[36:39], s81 offen offset:2048 lds
v_cvt_pk_bf16_f32 v180, v180, v181
v_cvt_pk_bf16_f32 v181, v182, v183
v_cvt_pk_bf16_f32 v182, v188, v189
v_cvt_pk_bf16_f32 v183, v190, v191
buffer_load_dwordx4 v115, s[36:39], s81 offen offset:3072 lds
v_cvt_pk_bf16_f32 v196, v196, v197
v_cvt_pk_bf16_f32 v197, v198, v199
v_cvt_pk_bf16_f32 v198, v204, v205
v_cvt_pk_bf16_f32 v199, v206, v207
s_add_u32 s81, s81, 28672
s_add_u32 m0, s18, 135168
s_nop 0
buffer_load_dwordx4 v112, s[36:39], s81 offen offset:0 lds
v_cvt_pk_bf16_f32 v212, v212, v213
v_cvt_pk_bf16_f32 v213, v214, v215
v_cvt_pk_bf16_f32 v214, v220, v221
v_cvt_pk_bf16_f32 v215, v222, v223
buffer_load_dwordx4 v113, s[36:39], s81 offen offset:1024 lds
v_cvt_pk_bf16_f32 v228, v228, v229
v_cvt_pk_bf16_f32 v229, v230, v231
v_cvt_pk_bf16_f32 v230, v236, v237
v_cvt_pk_bf16_f32 v231, v238, v239
buffer_load_dwordx4 v114, s[36:39], s81 offen offset:2048 lds
v_cvt_pk_bf16_f32 v244, v244, v245
v_cvt_pk_bf16_f32 v245, v246, v247
v_cvt_pk_bf16_f32 v246, v252, v253
v_cvt_pk_bf16_f32 v247, v254, v255
buffer_load_dwordx4 v115, s[36:39], s81 offen offset:3072 lds
s_sub_u32 s81, s81, 28544
s_branch K2_done
K2_cfix:
s_nop 7
v_max_f32 v12, 0, v8
v_exp_f32 v13, -v12
v_sub_f32 v8, v8, v12
v_mul_f32 v24, v24, v13
v_mul_f32 v128, v128, v13
v_mul_f32 v129, v129, v13
v_mul_f32 v130, v130, v13
v_mul_f32 v131, v131, v13
v_mul_f32 v136, v136, v13
v_mul_f32 v137, v137, v13
v_mul_f32 v138, v138, v13
v_mul_f32 v139, v139, v13
v_mul_f32 v144, v144, v13
v_mul_f32 v145, v145, v13
v_mul_f32 v146, v146, v13
v_mul_f32 v147, v147, v13
v_mul_f32 v152, v152, v13
v_mul_f32 v153, v153, v13
v_mul_f32 v154, v154, v13
v_mul_f32 v155, v155, v13
v_mul_f32 v160, v160, v13
v_mul_f32 v161, v161, v13
v_mul_f32 v162, v162, v13
v_mul_f32 v163, v163, v13
v_mul_f32 v168, v168, v13
v_mul_f32 v169, v169, v13
v_mul_f32 v170, v170, v13
v_mul_f32 v171, v171, v13
v_mul_f32 v176, v176, v13
v_mul_f32 v177, v177, v13
v_mul_f32 v178, v178, v13
v_mul_f32 v179, v179, v13
v_mul_f32 v184, v184, v13
v_mul_f32 v185, v185, v13
v_mul_f32 v186, v186, v13
v_mul_f32 v187, v187, v13
v_mul_f32 v192, v192, v13
v_mul_f32 v193, v193, v13
v_mul_f32 v194, v194, v13
v_mul_f32 v195, v195, v13
v_mul_f32 v200, v200, v13
v_mul_f32 v201, v201, v13
v_mul_f32 v202, v202, v13
v_mul_f32 v203, v203, v13
v_mul_f32 v208, v208, v13
v_mul_f32 v209, v209, v13
v_mul_f32 v210, v210, v13
v_mul_f32 v211, v211, v13
v_mul_f32 v216, v216, v13
v_mul_f32 v217, v217, v13
v_mul_f32 v218, v218, v13
v_mul_f32 v219, v219, v13
v_mul_f32 v224, v224, v13
v_mul_f32 v225, v225, v13
v_mul_f32 v226, v226, v13
v_mul_f32 v227, v227, v13
v_mul_f32 v232, v232, v13
v_mul_f32 v233, v233, v13
v_mul_f32 v234, v234, v13
v_mul_f32 v235, v235, v13
v_mul_f32 v240, v240, v13
v_mul_f32 v241, v241, v13
v_mul_f32 v242, v242, v13
v_mul_f32 v243, v243, v13
v_mul_f32 v248, v248, v13
v_mul_f32 v249, v249, v13
v_mul_f32 v250, v250, v13
v_mul_f32 v251, v251, v13
v_max_f32 v12, 0, v10
v_exp_f32 v13, -v12
v_sub_f32 v10, v10, v12
v_mul_f32 v25, v25, v13
v_mul_f32 v132, v132, v13
v_mul_f32 v133, v133, v13
v_mul_f32 v134, v134, v13
v_mul_f32 v135, v135, v13
v_mul_f32 v140, v140, v13
v_mul_f32 v141, v141, v13
v_mul_f32 v142, v142, v13
v_mul_f32 v143, v143, v13
v_mul_f32 v148, v148, v13
v_mul_f32 v149, v149, v13
v_mul_f32 v150, v150, v13
v_mul_f32 v151, v151, v13
v_mul_f32 v156, v156, v13
v_mul_f32 v157, v157, v13
v_mul_f32 v158, v158, v13
v_mul_f32 v159, v159, v13
v_mul_f32 v164, v164, v13
v_mul_f32 v165, v165, v13
v_mul_f32 v166, v166, v13
v_mul_f32 v167, v167, v13
v_mul_f32 v172, v172, v13
v_mul_f32 v173, v173, v13
v_mul_f32 v174, v174, v13
v_mul_f32 v175, v175, v13
v_mul_f32 v180, v180, v13
v_mul_f32 v181, v181, v13
v_mul_f32 v182, v182, v13
v_mul_f32 v183, v183, v13
v_mul_f32 v188, v188, v13
v_mul_f32 v189, v189, v13
v_mul_f32 v190, v190, v13
v_mul_f32 v191, v191, v13
v_mul_f32 v196, v196, v13
v_mul_f32 v197, v197, v13
v_mul_f32 v198, v198, v13
v_mul_f32 v199, v199, v13
v_mul_f32 v204, v204, v13
v_mul_f32 v205, v205, v13
v_mul_f32 v206, v206, v13
v_mul_f32 v207, v207, v13
v_mul_f32 v212, v212, v13
v_mul_f32 v213, v213, v13
v_mul_f32 v214, v214, v13
v_mul_f32 v215, v215, v13
v_mul_f32 v220, v220, v13
v_mul_f32 v221, v221, v13
v_mul_f32 v222, v222, v13
v_mul_f32 v223, v223, v13
v_mul_f32 v228, v228, v13
v_mul_f32 v229, v229, v13
v_mul_f32 v230, v230, v13
v_mul_f32 v231, v231, v13
v_mul_f32 v236, v236, v13
v_mul_f32 v237, v237, v13
v_mul_f32 v238, v238, v13
v_mul_f32 v239, v239, v13
v_mul_f32 v244, v244, v13
v_mul_f32 v245, v245, v13
v_mul_f32 v246, v246, v13
v_mul_f32 v247, v247, v13
v_mul_f32 v252, v252, v13
v_mul_f32 v253, v253, v13
v_mul_f32 v254, v254, v13
v_mul_f32 v255, v255, v13
s_branch K2_cok
K2_tspin:
Lp_9101:
buffer_load_dword v3, off, s[4:7], s80 sc1
s_waitcnt vmcnt(0)
v_cmp_gt_u32 vcc, 1, v3
s_cbranch_vccz Lpd_9102
s_sleep 8
s_sub_u32 s101, s101, 1
s_cbranch_scc0 Lp_9101
s_mov_b32 s101, 0
Lpd_9102:
s_branch K2_tok
K2_p0d:
ds_read_b128 a[64:67], v1 offset:0
ds_read_b128 a[68:71], v1 offset:1024
ds_read_b128 a[72:75], v1 offset:2048
ds_read_b128 a[76:79], v1 offset:3072
ds_read_b128 a[80:83], v1 offset:4096
ds_read_b128 a[84:87], v1 offset:5120
ds_read_b128 a[88:91], v1 offset:6144
ds_read_b128 a[92:95], v1 offset:7168
v_cndmask_b32 v32, 0, v7, s[32:33]
v_cndmask_b32 v33, 0, v7, s[34:35]
v_cndmask_b32 v34, 0, v7, s[36:37]
v_cndmask_b32 v35, 0, v7, s[38:39]
v_cndmask_b32 v40, 0, v7, s[40:41]
v_cndmask_b32 v41, 0, v7, s[42:43]
v_cndmask_b32 v42, 0, v7, s[44:45]
v_cndmask_b32 v43, 0, v7, s[46:47]
s_waitcnt lgkmcnt(7)
v_mfma_f32_16x16x32_bf16 v[32:35], a[64:67], a[0:3], v[32:35]
s_waitcnt lgkmcnt(6)
s_add_u32 m0, s18, 65536
ds_read_b128 a[96:99], v1 offset:8192
v_mfma_f32_16x16x32_bf16 v[32:35], a[68:71], a[4:7], v[32:35]
s_waitcnt lgkmcnt(6)
buffer_load_dwordx4 v1, s[4:7], s12 offen offset:0 sc1 lds
v_mfma_f32_16x16x32_bf16 v[32:35], a[72:75], a[8:11], v[32:35]
s_waitcnt lgkmcnt(5)
ds_read_b128 a[100:103], v1 offset:9216
v_mfma_f32_16x16x32_bf16 v[32:35], a[76:79], a[12:15], v[32:35]
s_waitcnt lgkmcnt(5)
buffer_load_dwordx4 v1, s[4:7], s12 offen offset:1024 sc1 lds
v_mfma_f32_16x16x32_bf16 v[32:35], a[80:83], a[16:19], v[32:35]
s_waitcnt lgkmcnt(4)
ds_read_b128 a[104:107], v1 offset:10240
v_mfma_f32_16x16x32_bf16 v[32:35], a[84:87], a[20:23], v[32:35]
s_waitcnt lgkmcnt(4)
buffer_load_dwordx4 v1, s[4:7], s12 offen offset:2048 sc1 lds
v_mfma_f32_16x16x32_bf16 v[32:35], a[88:91], a[24:27], v[32:35]
s_waitcnt lgkmcnt(3)
ds_read_b128 a[108:111], v1 offset:11264
v_mfma_f32_16x16x32_bf16 v[32:35], a[92:95], a[28:31], v[32:35]
buffer_load_dwordx4 v1, s[4:7], s12 offen offset:3072 sc1 lds
v_mfma_f32_16x16x32_bf16 v[36:39], a[64:67], a[32:35], 0
s_add_u32 s12, s12, 4096
s_add_u32 m0, s18, 69632
ds_read_b128 a[112:115], v1 offset:12288
v_mfma_f32_16x16x32_bf16 v[36:39], a[68:71], a[36:39], v[36:39]
buffer_load_dwordx4 v1, s[4:7], s12 offen offset:0 sc1 lds
v_mfma_f32_16x16x32_bf16 v[36:39], a[72:75], a[40:43], v[36:39]
ds_read_b128 a[116:119], v1 offset:13312
v_mfma_f32_16x16x32_bf16 v[36:39], a[76:79], a[44:47], v[36:39]
buffer_load_dwordx4 v1, s[4:7], s12 offen offset:1024 sc1 lds
v_mfma_f32_16x16x32_bf16 v[36:39], a[80:83], a[48:51], v[36:39]
ds_read_b128 a[120:123], v1 offset:14336
v_max3_f32 v28, v32, v33, v34
v_mfma_f32_16x16x32_bf16 v[36:39], a[84:87], a[52:55], v[36:39]
buffer_load_dwordx4 v1, s[4:7], s12 offen offset:2048 sc1 lds
v_mfma_f32_16x16x32_bf16 v[36:39], a[88:91], a[56:59], v[36:39]
ds_read_b128 a[124:127], v1 offset:15360
v_max_f32 v28, v28, v35
v_mfma_f32_16x16x32_bf16 v[36:39], a[92:95], a[60:63], v[36:39]
s_waitcnt lgkmcnt(4)
buffer_load_dwordx4 v1, s[4:7], s12 offen offset:3072 sc1 lds
v_mfma_f32_16x16x32_bf16 v[40:43], a[96:99], a[0:3], v[40:43]
s_add_u32 s12, s12, 28672
ds_read_b128 a[64:67], v1 offset:16384
v_mov_b32 v30, v28
v_mfma_f32_16x16x32_bf16 v[40:43], a[100:103], a[4:7], v[40:43]
s_waitcnt lgkmcnt(2)
s_sub_u32 s13, s13, 1
v_mfma_f32_16x16x32_bf16 v[40:43], a[104:107], a[8:11], v[40:43]
s_cmp_eq_u32 s13, 0
ds_read_b128 a[68:71], v1 offset:17408
v_permlane16_swap_b32 v28, v30
v_mfma_f32_16x16x32_bf16 v[40:43], a[108:111], a[12:15], v[40:43]
s_cselect_b32 s12, s14, s12
v_max_f32 v28, v28, v30
v_mov_b32 v30, v28
v_mfma_f32_16x16x32_bf16 v[40:43], a[112:115], a[16:19], v[40:43]
s_cselect_b32 s13, s15, s13
ds_read_b128 a[72:75], v1 offset:18432
v_max3_f32 v29, v36, v37, v38
v_mfma_f32_16x16x32_bf16 v[40:43], a[116:119], a[20:23], v[40:43]
s_cselect_b32 s14, 3221225472, s14
v_permlane32_swap_b32 v28, v30
v_max_f32 v28, v28, v30
v_mfma_f32_16x16x32_bf16 v[40:43], a[120:123], a[24:27], v[40:43]
s_waitcnt lgkmcnt(3)
ds_read_b128 a[76:79], v1 offset:19456
v_sub_f32 v16, 0, v28
v_mfma_f32_16x16x32_bf16 v[40:43], a[124:127], a[28:31], v[40:43]
v_sub_f32 v17, 0, v28
v_sub_f32 v18, 0, v28
v_mfma_f32_16x16x32_bf16 v[44:47], a[96:99], a[32:35], 0
ds_read_b128 a[80:83], v1 offset:20480
v_sub_f32 v19, 0, v28
v_mfma_f32_16x16x32_bf16 v[44:47], a[100:103], a[36:39], v[44:47]
v_max_f32 v29, v29, v39
v_mov_b32 v31, v29
v_cndmask_b32 v48, v16, v7, s[48:49]
v_mfma_f32_16x16x32_bf16 v[44:47], a[104:107], a[40:43], v[44:47]
ds_read_b128 a[84:87], v1 offset:21504
v_cndmask_b32 v49, v16, v7, s[50:51]
v_mfma_f32_16x16x32_bf16 v[44:47], a[108:111], a[44:47], v[44:47]
v_permlane16_swap_b32 v29, v31
v_max_f32 v29, v29, v31
v_cndmask_b32 v50, v16, v7, s[52:53]
v_mfma_f32_16x16x32_bf16 v[44:47], a[112:115], a[48:51], v[44:47]
ds_read_b128 a[88:91], v1 offset:22528
v_mov_b32 v31, v29
v_cndmask_b32 v51, v16, v7, s[54:55]
v_mfma_f32_16x16x32_bf16 v[44:47], a[116:119], a[52:55], v[44:47]
v_cndmask_b32 v56, v16, v7, s[56:57]
v_cndmask_b32 v57, v16, v7, s[58:59]
v_mfma_f32_16x16x32_bf16 v[44:47], a[120:123], a[56:59], v[44:47]
ds_read_b128 a[92:95], v1 offset:23552
v_permlane32_swap_b32 v29, v31
v_mfma_f32_16x16x32_bf16 v[44:47], a[124:127], a[60:63], v[44:47]
s_waitcnt lgkmcnt(4)
v_max_f32 v29, v29, v31
v_sub_f32 v20, 0, v29
v_mfma_f32_16x16x32_bf16 v[48:51], a[64:67], a[0:3], v[48:51]
ds_read_b128 a[96:99], v1 offset:24576
v_sub_f32 v21, 0, v29
v_mfma_f32_16x16x32_bf16 v[48:51], a[68:71], a[4:7], v[48:51]
v_sub_f32 v22, 0, v29
v_sub_f32 v23, 0, v29
v_mfma_f32_16x16x32_bf16 v[48:51], a[72:75], a[8:11], v[48:51]
ds_read_b128 a[100:103], v1 offset:25600
v_cndmask_b32 v58, v16, v7, s[60:61]
v_mfma_f32_16x16x32_bf16 v[48:51], a[76:79], a[12:15], v[48:51]
s_waitcnt lgkmcnt(4)
v_cndmask_b32 v59, v16, v7, s[62:63]
v_mfma_f32_16x16x32_bf16 v[48:51], a[80:83], a[16:19], v[48:51]
ds_read_b128 a[104:107], v1 offset:26624
v_mfma_f32_16x16x32_bf16 v[48:51], a[84:87], a[20:23], v[48:51]
s_waitcnt lgkmcnt(4)
v_add_f32 v32, v32, v16
v_add_f32 v33, v33, v16
v_add_f32 v34, v34, v16
v_add_f32 v35, v35, v16
v_mfma_f32_16x16x32_bf16 v[48:51], a[88:91], a[24:27], v[48:51]
s_waitcnt lgkmcnt(3)
ds_read_b128 a[108:111], v1 offset:27648
v_add_f32 v36, v36, v20
v_add_f32 v37, v37, v20
v_add_f32 v38, v38, v20
v_add_f32 v39, v39, v20
v_mfma_f32_16x16x32_bf16 v[48:51], a[92:95], a[28:31], v[48:51]
v_add_f32 v40, v40, v16
v_add_f32 v41, v41, v16
v_add_f32 v42, v42, v16
v_add_f32 v43, v43, v16
v_mfma_f32_16x16x32_bf16 v[52:55], a[64:67], a[32:35], v[20:23]
ds_read_b128 a[112:115], v1 offset:28672
v_add_f32 v44, v44, v20
v_add_f32 v45, v45, v20
v_add_f32 v46, v46, v20
v_add_f32 v47, v47, v20
v_mfma_f32_16x16x32_bf16 v[52:55], a[68:71], a[36:39], v[52:55]
v_exp_f32 v8, v32
v_mfma_f32_16x16x32_bf16 v[52:55], a[72:75], a[40:43], v[52:55]
ds_read_b128 a[116:119], v1 offset:29696
v_exp_f32 v9, v33
v_mfma_f32_16x16x32_bf16 v[52:55], a[76:79], a[44:47], v[52:55]
v_exp_f32 v10, v34
v_add_f32 v26, v8, v9
v_cvt_pk_bf16_f32 v96, v8, v9
v_mfma_f32_16x16x32_bf16 v[52:55], a[80:83], a[48:51], v[52:55]
ds_read_b128 a[120:123], v1 offset:30720
v_exp_f32 v11, v35
v_add_f32 v26, v26, v10
v_mfma_f32_16x16x32_bf16 v[52:55], a[84:87], a[52:55], v[52:55]
v_exp_f32 v12, v36
v_add_f32 v26, v26, v11
v_cvt_pk_bf16_f32 v97, v10, v11
v_mfma_f32_16x16x32_bf16 v[52:55], a[88:91], a[56:59], v[52:55]
s_waitcnt vmcnt(8) lgkmcnt(4)
ds_read_b128 a[124:127], v1 offset:31744
v_exp_f32 v13, v37
v_mfma_f32_16x16x32_bf16 v[52:55], a[92:95], a[60:63], v[52:55]
s_barrier
v_mfma_f32_16x16x32_bf16 v[56:59], a[96:99], a[0:3], v[56:59]
ds_read_b128 a[64:67], v4 offset:0
v_exp_f32 v14, v38
v_mfma_f32_16x16x32_bf16 v[56:59], a[100:103], a[4:7], v[56:59]
buffer_store_dword v6, v5, s[4:7], s71 offen sc1
v_mfma_f32_16x16x32_bf16 v[56:59], a[104:107], a[8:11], v[56:59]
s_waitcnt lgkmcnt(4)
ds_read_b128 a[68:71], v4 offset:1024
v_add_f32 v27, v12, v13
v_cvt_pk_bf16_f32 v104, v12, v13
v_add_f32 v27, v27, v14
v_mfma_f32_16x16x32_bf16 v[56:59], a[108:111], a[12:15], v[56:59]
v_exp_f32 v15, v39
v_mfma_f32_16x16x32_bf16 v[56:59], a[112:115], a[16:19], v[56:59]
s_waitcnt lgkmcnt(4)
ds_read_b128 a[72:75], v4 offset:2048
v_exp_f32 v8, v40
v_add_f32 v27, v27, v15
v_cvt_pk_bf16_f32 v105, v14, v15
v_mfma_f32_16x16x32_bf16 v[56:59], a[116:119], a[20:23], v[56:59]
s_waitcnt lgkmcnt(4)
v_exp_f32 v9, v41
v_add_f32 v26, v26, v8
v_mfma_f32_16x16x32_bf16 v[56:59], a[120:123], a[24:27], v[56:59]
s_waitcnt lgkmcnt(3)
ds_read_b128 a[76:79], v4 offset:3072
v_exp_f32 v10, v42
v_add_f32 v26, v26, v9
v_cvt_pk_bf16_f32 v98, v8, v9
v_mfma_f32_16x16x32_bf16 v[56:59], a[124:127], a[28:31], v[56:59]
v_exp_f32 v11, v43
v_add_f32 v26, v26, v10
v_mfma_f32_16x16x32_bf16 v[60:63], a[96:99], a[32:35], v[20:23]
ds_read_b128 a[80:83], v4 offset:4096
v_exp_f32 v12, v44
v_mfma_f32_16x16x32_bf16 v[60:63], a[100:103], a[36:39], v[60:63]
v_exp_f32 v13, v45
v_mfma_f32_16x16x32_bf16 v[60:63], a[104:107], a[40:43], v[60:63]
ds_read_b128 a[84:87], v4 offset:5120
v_exp_f32 v14, v46
v_mfma_f32_16x16x32_bf16 v[60:63], a[108:111], a[44:47], v[60:63]
v_exp_f32 v15, v47
v_mfma_f32_16x16x32_bf16 v[60:63], a[112:115], a[48:51], v[60:63]
ds_read_b128 a[88:91], v4 offset:6144
v_add_f32 v26, v26, v11
v_cvt_pk_bf16_f32 v99, v10, v11
v_mfma_f32_16x16x32_bf16 v[60:63], a[116:119], a[52:55], v[60:63]
v_add_f32 v27, v27, v12
v_add_f32 v27, v27, v13
v_cvt_pk_bf16_f32 v106, v12, v13
v_mfma_f32_16x16x32_bf16 v[60:63], a[120:123], a[56:59], v[60:63]
s_waitcnt lgkmcnt(7)
s_barrier
ds_read_b128 a[92:95], v4 offset:7168
v_mfma_f32_16x16x32_bf16 v[60:63], a[124:127], a[60:63], v[60:63]
s_waitcnt lgkmcnt(4)
v_add_f32 v27, v27, v14
v_add_f32 v27, v27, v15
v_cvt_pk_bf16_f32 v107, v14, v15
s_branch K2_dx1
PAD_33:
s_cbranch_execz M_tret
K2_ntail:
v_mfma_f32_16x16x32_bf16 v[128:131], a[64:67], v[96:99], v[128:131]
s_add_u32 m0, s18, 98304
ds_read_b128 a[96:99], v2 offset:8192
v_add_f32 v24, v24, v26
v_mfma_f32_16x16x32_bf16 v[128:131], a[68:71], v[100:103], v[128:131]
buffer_load_dwordx4 v1, s[4:7], s12 offen offset:0 sc1 lds
v_mfma_f32_16x16x32_bf16 v[132:135], a[68:71], v[108:111], v[132:135]
ds_read_b128 a[100:103], v2 offset:9216
v_add_f32 v25, v25, v27
v_mfma_f32_16x16x32_bf16 v[132:135], a[64:67], v[104:107], v[132:135]
buffer_load_dwordx4 v1, s[4:7], s12 offen offset:1024 sc1 lds
v_mfma_f32_16x16x32_bf16 v[136:139], a[72:75], v[96:99], v[136:139]
ds_read_b128 a[104:107], v2 offset:10240
v_exp_f32 v8, v64
v_mfma_f32_16x16x32_bf16 v[136:139], a[76:79], v[100:103], v[136:139]
buffer_load_dwordx4 v1, s[4:7], s12 offen offset:2048 sc1 lds
v_mfma_f32_16x16x32_bf16 v[140:143], a[76:79], v[108:111], v[140:143]
ds_read_b128 a[108:111], v2 offset:11264
v_mfma_f32_16x16x32_bf16 v[140:143], a[72:75], v[104:107], v[140:143]
s_waitcnt lgkmcnt(4)
buffer_load_dwordx4 v1, s[4:7], s12 offen offset:3072 sc1 lds
v_mfma_f32_16x16x32_bf16 v[144:147], a[80:83], v[96:99], v[144:147]
s_add_u32 s12, s12, 4096
s_add_u32 m0, s18, 102400
ds_read_b128 a[112:115], v2 offset:12288
v_mfma_f32_16x16x32_bf16 v[144:147], a[84:87], v[100:103], v[144:147]
buffer_load_dwordx4 v1, s[4:7], s12 offen offset:0 sc1 lds
v_mfma_f32_16x16x32_bf16 v[148:151], a[84:87], v[108:111], v[148:151]
ds_read_b128 a[116:119], v2 offset:13312
v_exp_f32 v9, v65
v_mfma_f32_16x16x32_bf16 v[148:151], a[80:83], v[104:107], v[148:151]
buffer_load_dwordx4 v1, s[4:7], s12 offen offset:1024 sc1 lds
v_mfma_f32_16x16x32_bf16 v[152:155], a[88:91], v[96:99], v[152:155]
ds_read_b128 a[120:123], v2 offset:14336
v_add_f32 v26, v8, v9
v_cvt_pk_bf16_f32 v112, v8, v9
v_mfma_f32_16x16x32_bf16 v[152:155], a[92:95], v[100:103], v[152:155]
buffer_load_dwordx4 v1, s[4:7], s12 offen offset:2048 sc1 lds
v_mfma_f32_16x16x32_bf16 v[156:159], a[92:95], v[108:111], v[156:159]
ds_read_b128 a[124:127], v2 offset:15360
v_exp_f32 v10, v66
v_mfma_f32_16x16x32_bf16 v[156:159], a[88:91], v[104:107], v[156:159]
s_waitcnt lgkmcnt(4)
buffer_load_dwordx4 v1, s[4:7], s12 offen offset:3072 sc1 lds
v_mfma_f32_16x16x32_bf16 v[160:163], a[96:99], v[96:99], v[160:163]
s_add_u32 s12, s12, 28672
ds_read_b128 a[64:67], v2 offset:16384
v_add_f32 v26, v26, v10
v_mfma_f32_16x16x32_bf16 v[160:163], a[100:103], v[100:103], v[160:163]
s_sub_u32 s13, s13, 1
v_exp_f32 v11, v67
v_mfma_f32_16x16x32_bf16 v[164:167], a[100:103], v[108:111], v[164:167]
s_cmp_eq_u32 s13, 0
ds_read_b128 a[68:71], v2 offset:17408
v_exp_f32 v12, v68
v_mfma_f32_16x16x32_bf16 v[164:167], a[96:99], v[104:107], v[164:167]
s_cselect_b32 s12, s14, s12
v_exp_f32 v13, v69
v_mfma_f32_16x16x32_bf16 v[168:171], a[104:107], v[96:99], v[168:171]
s_cselect_b32 s13, s15, s13
ds_read_b128 a[72:75], v2 offset:18432
v_add_f32 v26, v26, v11
v_cvt_pk_bf16_f32 v113, v10, v11
v_mfma_f32_16x16x32_bf16 v[168:171], a[108:111], v[100:103], v[168:171]
s_cselect_b32 s14, 3221225472, s14
v_exp_f32 v14, v70
v_mfma_f32_16x16x32_bf16 v[172:175], a[108:111], v[108:111], v[172:175]
ds_read_b128 a[76:79], v2 offset:19456
v_exp_f32 v15, v71
v_mfma_f32_16x16x32_bf16 v[172:175], a[104:107], v[104:107], v[172:175]
s_waitcnt lgkmcnt(4)
v_exp_f32 v8, v72
v_mfma_f32_16x16x32_bf16 v[176:179], a[112:115], v[96:99], v[176:179]
ds_read_b128 a[80:83], v2 offset:20480
v_add_f32 v27, v12, v13
v_cvt_pk_bf16_f32 v120, v12, v13
v_add_f32 v27, v27, v14
v_add_f32 v27, v27, v15
v_cvt_pk_bf16_f32 v121, v14, v15
v_mfma_f32_16x16x32_bf16 v[176:179], a[116:119], v[100:103], v[176:179]
v_exp_f32 v9, v73
v_mfma_f32_16x16x32_bf16 v[180:183], a[116:119], v[108:111], v[180:183]
ds_read_b128 a[84:87], v2 offset:21504
v_exp_f32 v10, v74
v_mfma_f32_16x16x32_bf16 v[180:183], a[112:115], v[104:107], v[180:183]
v_exp_f32 v11, v75
v_mfma_f32_16x16x32_bf16 v[184:187], a[120:123], v[96:99], v[184:187]
ds_read_b128 a[88:91], v2 offset:22528
v_add_f32 v26, v26, v8
v_mfma_f32_16x16x32_bf16 v[184:187], a[124:127], v[100:103], v[184:187]
v_exp_f32 v12, v76
v_mfma_f32_16x16x32_bf16 v[188:191], a[124:127], v[108:111], v[188:191]
ds_read_b128 a[92:95], v2 offset:23552
v_add_f32 v26, v26, v9
v_cvt_pk_bf16_f32 v114, v8, v9
v_add_f32 v26, v26, v10
v_add_f32 v26, v26, v11
v_cvt_pk_bf16_f32 v115, v10, v11
v_mfma_f32_16x16x32_bf16 v[188:191], a[120:123], v[104:107], v[188:191]
s_waitcnt lgkmcnt(4)
v_exp_f32 v13, v77
v_mfma_f32_16x16x32_bf16 v[192:195], a[64:67], v[96:99], v[192:195]
ds_read_b128 a[96:99], v2 offset:24576
v_exp_f32 v14, v78
v_mfma_f32_16x16x32_bf16 v[192:195], a[68:71], v[100:103], v[192:195]
v_exp_f32 v15, v79
v_mfma_f32_16x16x32_bf16 v[196:199], a[68:71], v[108:111], v[196:199]
ds_read_b128 a[100:103], v2 offset:25600
v_add_f32 v27, v27, v12
v_add_f32 v27, v27, v13
v_cvt_pk_bf16_f32 v122, v12, v13
v_add_f32 v27, v27, v14
v_mfma_f32_16x16x32_bf16 v[196:199], a[64:67], v[104:107], v[196:199]
v_exp_f32 v8, v80
v_mfma_f32_16x16x32_bf16 v[200:203], a[72:75], v[96:99], v[200:203]
ds_read_b128 a[104:107], v2 offset:26624
v_exp_f32 v9, v81
v_mfma_f32_16x16x32_bf16 v[200:203], a[76:79], v[100:103], v[200:203]
v_exp_f32 v10, v82
v_mfma_f32_16x16x32_bf16 v[204:207], a[76:79], v[108:111], v[204:207]
ds_read_b128 a[108:111], v2 offset:27648
v_add_f32 v27, v27, v15
v_cvt_pk_bf16_f32 v123, v14, v15
v_add_f32 v26, v26, v8
v_add_f32 v26, v26, v9
v_cvt_pk_bf16_f32 v116, v8, v9
v_mfma_f32_16x16x32_bf16 v[204:207], a[72:75], v[104:107], v[204:207]
s_waitcnt lgkmcnt(4)
v_exp_f32 v11, v83
v_mfma_f32_16x16x32_bf16 v[208:211], a[80:83], v[96:99], v[208:211]
ds_read_b128 a[112:115], v2 offset:28672
v_exp_f32 v12, v84
v_mfma_f32_16x16x32_bf16 v[208:211], a[84:87], v[100:103], v[208:211]
v_exp_f32 v13, v85
v_mfma_f32_16x16x32_bf16 v[212:215], a[84:87], v[108:111], v[212:215]
ds_read_b128 a[116:119], v2 offset:29696
v_add_f32 v26, v26, v10
v_add_f32 v26, v26, v11
v_cvt_pk_bf16_f32 v117, v10, v11
v_add_f32 v27, v27, v12
v_mfma_f32_16x16x32_bf16 v[212:215], a[80:83], v[104:107], v[212:215]
v_exp_f32 v14, v86
v_mfma_f32_16x16x32_bf16 v[216:219], a[88:91], v[96:99], v[216:219]
ds_read_b128 a[120:123], v2 offset:30720
v_exp_f32 v15, v87
v_mfma_f32_16x16x32_bf16 v[216:219], a[92:95], v[100:103], v[216:219]
v_exp_f32 v8, v88
v_mfma_f32_16x16x32_bf16 v[220:223], a[92:95], v[108:111], v[220:223]
s_waitcnt vmcnt(0) lgkmcnt(4)
ds_read_b128 a[124:127], v2 offset:31744
v_add_f32 v27, v27, v13
v_cvt_pk_bf16_f32 v124, v12, v13
v_add_f32 v27, v27, v14
v_add_f32 v27, v27, v15
v_cvt_pk_bf16_f32 v125, v14, v15
v_mfma_f32_16x16x32_bf16 v[220:223], a[88:91], v[104:107], v[220:223]
s_barrier
v_mfma_f32_16x16x32_bf16 v[224:227], a[96:99], v[96:99], v[224:227]
ds_read_b128 a[64:67], v2 offset:32768
v_exp_f32 v9, v89
v_mfma_f32_16x16x32_bf16 v[224:227], a[100:103], v[100:103], v[224:227]
v_exp_f32 v10, v90
v_mfma_f32_16x16x32_bf16 v[228:231], a[100:103], v[108:111], v[228:231]
ds_read_b128 a[68:71], v2 offset:33792
v_add_f32 v26, v26, v8
v_add_f32 v26, v26, v9
v_cvt_pk_bf16_f32 v118, v8, v9
v_mfma_f32_16x16x32_bf16 v[228:231], a[96:99], v[104:107], v[228:231]
v_exp_f32 v11, v91
v_mfma_f32_16x16x32_bf16 v[232:235], a[104:107], v[96:99], v[232:235]
s_waitcnt lgkmcnt(4)
ds_read_b128 a[72:75], v2 offset:34816
v_exp_f32 v12, v92
v_mfma_f32_16x16x32_bf16 v[232:235], a[108:111], v[100:103], v[232:235]
v_exp_f32 v13, v93
v_mfma_f32_16x16x32_bf16 v[236:239], a[108:111], v[108:111], v[236:239]
ds_read_b128 a[76:79], v2 offset:35840
v_add_f32 v26, v26, v10
v_mfma_f32_16x16x32_bf16 v[236:239], a[104:107], v[104:107], v[236:239]
v_exp_f32 v14, v94
v_mfma_f32_16x16x32_bf16 v[240:243], a[112:115], v[96:99], v[240:243]
ds_read_b128 a[80:83], v2 offset:36864
v_add_f32 v26, v26, v11
v_cvt_pk_bf16_f32 v119, v10, v11
v_add_f32 v27, v27, v12
v_mfma_f32_16x16x32_bf16 v[240:243], a[116:119], v[100:103], v[240:243]
v_exp_f32 v15, v95
v_mfma_f32_16x16x32_bf16 v[244:247], a[116:119], v[108:111], v[244:247]
ds_read_b128 a[84:87], v2 offset:37888
v_add_f32 v27, v27, v13
v_cvt_pk_bf16_f32 v126, v12, v13
v_mfma_f32_16x16x32_bf16 v[244:247], a[112:115], v[104:107], v[244:247]
s_waitcnt lgkmcnt(4)
v_add_f32 v27, v27, v14
v_add_f32 v27, v27, v15
v_mfma_f32_16x16x32_bf16 v[248:251], a[120:123], v[96:99], v[248:251]
ds_read_b128 a[88:91], v2 offset:38912
v_cvt_pk_bf16_f32 v127, v14, v15
v_mfma_f32_16x16x32_bf16 v[248:251], a[124:127], v[100:103], v[248:251]
v_add_f32 v28, v26, v27
v_cmp_nge_f32 vcc, s25, v28
v_mfma_f32_16x16x32_bf16 v[252:255], a[124:127], v[108:111], v[252:255]
ds_read_b128 a[92:95], v2 offset:39936
v_mfma_f32_16x16x32_bf16 v[252:255], a[120:123], v[104:107], v[252:255]
s_cbranch_vccnz Lstub_14
Lback_15:
v_mfma_f32_16x16x32_bf16 v[128:131], a[64:67], v[112:115], v[128:131]
s_add_u32 m0, s18, 131072
ds_read_b128 a[96:99], v2 offset:40960
v_add_f32 v24, v24, v26
v_mfma_f32_16x16x32_bf16 v[128:131], a[68:71], v[116:119], v[128:131]
buffer_load_dwordx4 v1, s[4:7], s8 offen offset:0 sc1 lds
v_mfma_f32_16x16x32_bf16 v[132:135], a[68:71], v[124:127], v[132:135]
ds_read_b128 a[100:103], v2 offset:41984
v_add_f32 v25, v25, v27
v_mfma_f32_16x16x32_bf16 v[132:135], a[64:67], v[120:123], v[132:135]
s_waitcnt lgkmcnt(4)
buffer_load_dwordx4 v1, s[4:7], s8 offen offset:1024 sc1 lds
v_mfma_f32_16x16x32_bf16 v[136:139], a[72:75], v[112:115], v[136:139]
ds_read_b128 a[104:107], v2 offset:43008
v_mov_b32 v8, v16
v_mfma_f32_16x16x32_bf16 v[136:139], a[76:79], v[116:119], v[136:139]
buffer_load_dwordx4 v1, s[4:7], s8 offen offset:2048 sc1 lds
v_mfma_f32_16x16x32_bf16 v[140:143], a[76:79], v[124:127], v[140:143]
ds_read_b128 a[108:111], v2 offset:44032
v_mov_b32 v9, v24
v_mfma_f32_16x16x32_bf16 v[140:143], a[72:75], v[120:123], v[140:143]
buffer_load_dwordx4 v1, s[4:7], s8 offen offset:3072 sc1 lds
v_mfma_f32_16x16x32_bf16 v[144:147], a[80:83], v[112:115], v[144:147]
s_add_u32 s8, s8, 4096
s_add_u32 m0, s18, 135168
ds_read_b128 a[112:115], v2 offset:45056
v_mfma_f32_16x16x32_bf16 v[144:147], a[84:87], v[116:119], v[144:147]
buffer_load_dwordx4 v1, s[4:7], s8 offen offset:0 sc1 lds
v_mfma_f32_16x16x32_bf16 v[148:151], a[84:87], v[124:127], v[148:151]
ds_read_b128 a[116:119], v2 offset:46080
v_mov_b32 v10, v20
v_mfma_f32_16x16x32_bf16 v[148:151], a[80:83], v[120:123], v[148:151]
s_waitcnt lgkmcnt(4)
buffer_load_dwordx4 v1, s[4:7], s8 offen offset:1024 sc1 lds
v_mfma_f32_16x16x32_bf16 v[152:155], a[88:91], v[112:115], v[152:155]
ds_read_b128 a[120:123], v2 offset:47104
v_mov_b32 v11, v25
v_mfma_f32_16x16x32_bf16 v[152:155], a[92:95], v[116:119], v[152:155]
buffer_load_dwordx4 v1, s[4:7], s8 offen offset:2048 sc1 lds
v_mfma_f32_16x16x32_bf16 v[156:159], a[92:95], v[124:127], v[156:159]
ds_read_b128 a[124:127], v2 offset:48128
v_cvt_pk_bf16_f32 v128, v128, v129
v_mfma_f32_16x16x32_bf16 v[156:159], a[88:91], v[120:123], v[156:159]
s_waitcnt lgkmcnt(4)
buffer_load_dwordx4 v1, s[4:7], s8 offen offset:3072 sc1 lds
v_mfma_f32_16x16x32_bf16 v[160:163], a[96:99], v[112:115], v[160:163]
s_add_u32 s8, s8, 28672
ds_read_b128 a[64:67], v2 offset:49152
v_cvt_pk_bf16_f32 v129, v130, v131
v_mfma_f32_16x16x32_bf16 v[160:163], a[100:103], v[116:119], v[160:163]
s_sub_u32 s9, s9, 1
buffer_store_dwordx4 v[8:11], v1, s[4:7], s27 offen sc1
v_mfma_f32_16x16x32_bf16 v[164:167], a[100:103], v[124:127], v[164:167]
s_cmp_eq_u32 s9, 0
ds_read_b128 a[68:71], v2 offset:50176
v_cvt_pk_bf16_f32 v130, v136, v137
v_mfma_f32_16x16x32_bf16 v[164:167], a[96:99], v[120:123], v[164:167]
s_cselect_b32 s8, s10, s8
v_cvt_pk_bf16_f32 v131, v138, v139
v_accvgpr_mov_b32 a0, a192
v_mfma_f32_16x16x32_bf16 v[168:171], a[104:107], v[112:115], v[168:171]
s_cselect_b32 s9, s11, s9
ds_read_b128 a[72:75], v2 offset:51200
v_accvgpr_mov_b32 a1, a193
v_mfma_f32_16x16x32_bf16 v[168:171], a[108:111], v[116:119], v[168:171]
s_cselect_b32 s10, 3221225472, s10
buffer_store_dwordx4 v[128:131], v1, s[4:7], s76 offen offset:0 sc1
v_mfma_f32_16x16x32_bf16 v[172:175], a[108:111], v[124:127], v[172:175]
ds_read_b128 a[76:79], v2 offset:52224
v_cvt_pk_bf16_f32 v132, v132, v133
v_mfma_f32_16x16x32_bf16 v[172:175], a[104:107], v[120:123], v[172:175]
s_waitcnt lgkmcnt(4)
v_cvt_pk_bf16_f32 v133, v134, v135
v_cvt_pk_bf16_f32 v134, v140, v141
v_mfma_f32_16x16x32_bf16 v[176:179], a[112:115], v[112:115], v[176:179]
ds_read_b128 a[80:83], v2 offset:53248
v_cvt_pk_bf16_f32 v135, v142, v143
v_mfma_f32_16x16x32_bf16 v[176:179], a[116:119], v[116:119], v[176:179]
buffer_store_dwordx4 v[132:135], v1, s[4:7], s77 offen offset:0 sc1
v_mfma_f32_16x16x32_bf16 v[180:183], a[116:119], v[124:127], v[180:183]
ds_read_b128 a[84:87], v2 offset:54272
v_cvt_pk_bf16_f32 v144, v144, v145
v_mfma_f32_16x16x32_bf16 v[180:183], a[112:115], v[120:123], v[180:183]
v_cvt_pk_bf16_f32 v145, v146, v147
v_cvt_pk_bf16_f32 v146, v152, v153
v_mfma_f32_16x16x32_bf16 v[184:187], a[120:123], v[112:115], v[184:187]
ds_read_b128 a[88:91], v2 offset:55296
v_cvt_pk_bf16_f32 v147, v154, v155
v_mfma_f32_16x16x32_bf16 v[184:187], a[124:127], v[116:119], v[184:187]
buffer_store_dwordx4 v[144:147], v1, s[4:7], s76 offen offset:1024 sc1
v_mfma_f32_16x16x32_bf16 v[188:191], a[124:127], v[124:127], v[188:191]
ds_read_b128 a[92:95], v2 offset:56320
v_cvt_pk_bf16_f32 v148, v148, v149
v_mfma_f32_16x16x32_bf16 v[188:191], a[120:123], v[120:123], v[188:191]
s_waitcnt lgkmcnt(4)
v_cvt_pk_bf16_f32 v149, v150, v151
v_cvt_pk_bf16_f32 v150, v156, v157
v_mfma_f32_16x16x32_bf16 v[192:195], a[64:67], v[112:115], v[192:195]
ds_read_b128 a[96:99], v2 offset:57344
v_cvt_pk_bf16_f32 v151, v158, v159
v_mfma_f32_16x16x32_bf16 v[192:195], a[68:71], v[116:119], v[192:195]
buffer_store_dwordx4 v[148:151], v1, s[4:7], s77 offen offset:1024 sc1
v_mfma_f32_16x16x32_bf16 v[196:199], a[68:71], v[124:127], v[196:199]
ds_read_b128 a[100:103], v2 offset:58368
v_cvt_pk_bf16_f32 v160, v160, v161
v_mfma_f32_16x16x32_bf16 v[196:199], a[64:67], v[120:123], v[196:199]
v_cvt_pk_bf16_f32 v161, v162, v163
v_cvt_pk_bf16_f32 v162, v168, v169
v_mfma_f32_16x16x32_bf16 v[200:203], a[72:75], v[112:115], v[200:203]
ds_read_b128 a[104:107], v2 offset:59392
v_cvt_pk_bf16_f32 v163, v170, v171
v_mfma_f32_16x16x32_bf16 v[200:203], a[76:79], v[116:119], v[200:203]
buffer_store_dwordx4 v[160:163], v1, s[4:7], s76 offen offset:2048 sc1
v_mfma_f32_16x16x32_bf16 v[204:207], a[76:79], v[124:127], v[204:207]
ds_read_b128 a[108:111], v2 offset:60416
v_cvt_pk_bf16_f32 v164, v164, v165
v_mfma_f32_16x16x32_bf16 v[204:207], a[72:75], v[120:123], v[204:207]
s_waitcnt lgkmcnt(4)
v_cvt_pk_bf16_f32 v165, v166, v167
v_cvt_pk_bf16_f32 v166, v172, v173
v_mfma_f32_16x16x32_bf16 v[208:211], a[80:83], v[112:115], v[208:211]
ds_read_b128 a[112:115], v2 offset:61440
v_cvt_pk_bf16_f32 v167, v174, v175
v_mfma_f32_16x16x32_bf16 v[208:211], a[84:87], v[116:119], v[208:211]
buffer_store_dwordx4 v[164:167], v1, s[4:7], s77 offen offset:2048 sc1
v_mfma_f32_16x16x32_bf16 v[212:215], a[84:87], v[124:127], v[212:215]
ds_read_b128 a[116:119], v2 offset:62464
v_cvt_pk_bf16_f32 v176, v176, v177
v_mfma_f32_16x16x32_bf16 v[212:215], a[80:83], v[120:123], v[212:215]
v_cvt_pk_bf16_f32 v177, v178, v179
v_cvt_pk_bf16_f32 v178, v184, v185
v_mfma_f32_16x16x32_bf16 v[216:219], a[88:91], v[112:115], v[216:219]
ds_read_b128 a[120:123], v2 offset:63488
v_cvt_pk_bf16_f32 v179, v186, v187
v_mfma_f32_16x16x32_bf16 v[216:219], a[92:95], v[116:119], v[216:219]
buffer_store_dwordx4 v[176:179], v1, s[4:7], s76 offen offset:3072 sc1
v_mfma_f32_16x16x32_bf16 v[220:223], a[92:95], v[124:127], v[220:223]
ds_read_b128 a[124:127], v2 offset:64512
v_cvt_pk_bf16_f32 v180, v180, v181
v_mfma_f32_16x16x32_bf16 v[220:223], a[88:91], v[120:123], v[220:223]
s_waitcnt lgkmcnt(4)
v_cvt_pk_bf16_f32 v181, v182, v183
v_cvt_pk_bf16_f32 v182, v188, v189
v_mfma_f32_16x16x32_bf16 v[224:227], a[96:99], v[112:115], v[224:227]
v_cvt_pk_bf16_f32 v183, v190, v191
v_accvgpr_mov_b32 a2, a194
v_mfma_f32_16x16x32_bf16 v[224:227], a[100:103], v[116:119], v[224:227]
buffer_store_dwordx4 v[180:183], v1, s[4:7], s77 offen offset:3072 sc1
v_mfma_f32_16x16x32_bf16 v[228:231], a[100:103], v[124:127], v[228:231]
s_add_u32 s76, s76, 4096
v_accvgpr_mov_b32 a3, a195
v_accvgpr_mov_b32 a4, a196
v_mfma_f32_16x16x32_bf16 v[228:231], a[96:99], v[120:123], v[228:231]
s_add_u32 s77, s77, 4096
v_cvt_pk_bf16_f32 v192, v192, v193
v_cvt_pk_bf16_f32 v193, v194, v195
v_mfma_f32_16x16x32_bf16 v[232:235], a[104:107], v[112:115], v[232:235]
v_cvt_pk_bf16_f32 v194, v200, v201
v_cvt_pk_bf16_f32 v195, v202, v203
v_mfma_f32_16x16x32_bf16 v[232:235], a[108:111], v[116:119], v[232:235]
PAD_34:
s_cbranch_execz M_tret
buffer_store_dwordx4 v[192:195], v1, s[4:7], s76 offen offset:0 sc1
v_mfma_f32_16x16x32_bf16 v[236:239], a[108:111], v[124:127], v[236:239]
v_cvt_pk_bf16_f32 v196, v196, v197
v_cvt_pk_bf16_f32 v197, v198, v199
v_mfma_f32_16x16x32_bf16 v[236:239], a[104:107], v[120:123], v[236:239]
s_waitcnt lgkmcnt(0)
v_cvt_pk_bf16_f32 v198, v204, v205
v_cvt_pk_bf16_f32 v199, v206, v207
v_mfma_f32_16x16x32_bf16 v[240:243], a[112:115], v[112:115], v[240:243]
buffer_store_dwordx4 v[196:199], v1, s[4:7], s77 offen offset:0 sc1
v_mfma_f32_16x16x32_bf16 v[240:243], a[116:119], v[116:119], v[240:243]
v_cvt_pk_bf16_f32 v208, v208, v209
v_cvt_pk_bf16_f32 v209, v210, v211
v_mfma_f32_16x16x32_bf16 v[244:247], a[116:119], v[124:127], v[244:247]
v_cvt_pk_bf16_f32 v210, v216, v217
v_cvt_pk_bf16_f32 v211, v218, v219
v_mfma_f32_16x16x32_bf16 v[244:247], a[112:115], v[120:123], v[244:247]
buffer_store_dwordx4 v[208:211], v1, s[4:7], s76 offen offset:1024 sc1
v_mfma_f32_16x16x32_bf16 v[248:251], a[120:123], v[112:115], v[248:251]
v_cvt_pk_bf16_f32 v212, v212, v213
v_cvt_pk_bf16_f32 v213, v214, v215
v_mfma_f32_16x16x32_bf16 v[248:251], a[124:127], v[116:119], v[248:251]
v_cvt_pk_bf16_f32 v214, v220, v221
v_cvt_pk_bf16_f32 v215, v222, v223
v_mfma_f32_16x16x32_bf16 v[252:255], a[124:127], v[124:127], v[252:255]
buffer_store_dwordx4 v[212:215], v1, s[4:7], s77 offen offset:1024 sc1
v_mfma_f32_16x16x32_bf16 v[252:255], a[120:123], v[120:123], v[252:255]
v_cvt_pk_bf16_f32 v224, v224, v225
v_cvt_pk_bf16_f32 v225, v226, v227
v_accvgpr_mov_b32 a5, a197
v_accvgpr_mov_b32 a6, a198
v_accvgpr_mov_b32 a7, a199
v_accvgpr_mov_b32 a8, a200
v_accvgpr_mov_b32 a9, a201
v_accvgpr_mov_b32 a10, a202
v_accvgpr_mov_b32 a11, a203
v_accvgpr_mov_b32 a12, a204
v_cvt_pk_bf16_f32 v226, v232, v233
v_cvt_pk_bf16_f32 v227, v234, v235
buffer_store_dwordx4 v[224:227], v1, s[4:7], s76 offen offset:2048 sc1
v_cvt_pk_bf16_f32 v228, v228, v229
v_cvt_pk_bf16_f32 v229, v230, v231
v_cvt_pk_bf16_f32 v230, v236, v237
v_cvt_pk_bf16_f32 v231, v238, v239
buffer_store_dwordx4 v[228:231], v1, s[4:7], s77 offen offset:2048 sc1
v_cvt_pk_bf16_f32 v240, v240, v241
v_cvt_pk_bf16_f32 v241, v242, v243
v_cvt_pk_bf16_f32 v242, v248, v249
v_cvt_pk_bf16_f32 v243, v250, v251
buffer_store_dwordx4 v[240:243], v1, s[4:7], s76 offen offset:3072 sc1
v_cvt_pk_bf16_f32 v244, v244, v245
v_cvt_pk_bf16_f32 v245, v246, v247
v_cvt_pk_bf16_f32 v246, v252, v253
v_cvt_pk_bf16_f32 v247, v254, v255
buffer_store_dwordx4 v[244:247], v1, s[4:7], s77 offen offset:3072 sc1
v_accvgpr_mov_b32 a13, a205
v_accvgpr_mov_b32 a14, a206
v_accvgpr_mov_b32 a15, a207
v_accvgpr_mov_b32 a16, a208
v_accvgpr_mov_b32 a17, a209
v_accvgpr_mov_b32 a18, a210
v_accvgpr_mov_b32 a19, a211
v_accvgpr_mov_b32 a20, a212
v_accvgpr_mov_b32 a21, a213
v_accvgpr_mov_b32 a22, a214
v_accvgpr_mov_b32 a23, a215
v_accvgpr_mov_b32 a24, a216
v_accvgpr_mov_b32 a25, a217
v_accvgpr_mov_b32 a26, a218
v_accvgpr_mov_b32 a27, a219
v_accvgpr_mov_b32 a28, a220
v_accvgpr_mov_b32 a29, a221
v_accvgpr_mov_b32 a30, a222
v_accvgpr_mov_b32 a31, a223
v_accvgpr_mov_b32 a32, a224
v_accvgpr_mov_b32 a33, a225
v_accvgpr_mov_b32 a34, a226
v_accvgpr_mov_b32 a35, a227
v_accvgpr_mov_b32 a36, a228
v_accvgpr_mov_b32 a37, a229
v_accvgpr_mov_b32 a38, a230
v_accvgpr_mov_b32 a39, a231
v_accvgpr_mov_b32 a40, a232
v_accvgpr_mov_b32 a41, a233
v_accvgpr_mov_b32 a42, a234
v_accvgpr_mov_b32 a43, a235
v_accvgpr_mov_b32 a44, a236
v_accvgpr_mov_b32 a45, a237
v_accvgpr_mov_b32 a46, a238
v_accvgpr_mov_b32 a47, a239
v_accvgpr_mov_b32 a48, a240
v_accvgpr_mov_b32 a49, a241
v_accvgpr_mov_b32 a50, a242
v_accvgpr_mov_b32 a51, a243
v_accvgpr_mov_b32 a52, a244
v_accvgpr_mov_b32 a53, a245
v_accvgpr_mov_b32 a54, a246
v_accvgpr_mov_b32 a55, a247
v_accvgpr_mov_b32 a56, a248
v_accvgpr_mov_b32 a57, a249
v_accvgpr_mov_b32 a58, a250
v_accvgpr_mov_b32 a59, a251
v_accvgpr_mov_b32 a60, a252
v_accvgpr_mov_b32 a61, a253
v_accvgpr_mov_b32 a62, a254
v_accvgpr_mov_b32 a63, a255
s_mov_b32 s24, 0
s_mov_b32 s29, s21
s_mov_b32 s19, s21
v_mov_b64 v[128:129], 0
v_mov_b64 v[130:131], 0
v_mov_b64 v[132:133], 0
v_mov_b64 v[134:135], 0
v_mov_b64 v[136:137], 0
v_mov_b64 v[138:139], 0
v_mov_b64 v[140:141], 0
v_mov_b64 v[142:143], 0
v_mov_b64 v[144:145], 0
v_mov_b64 v[146:147], 0
v_mov_b64 v[148:149], 0
v_mov_b64 v[150:151], 0
v_mov_b64 v[152:153], 0
v_mov_b64 v[154:155], 0
v_mov_b64 v[156:157], 0
v_mov_b64 v[158:159], 0
v_mov_b64 v[160:161], 0
v_mov_b64 v[162:163], 0
v_mov_b64 v[164:165], 0
v_mov_b64 v[166:167], 0
v_mov_b64 v[168:169], 0
v_mov_b64 v[170:171], 0
v_mov_b64 v[172:173], 0
v_mov_b64 v[174:175], 0
v_mov_b64 v[176:177], 0
v_mov_b64 v[178:179], 0
v_mov_b64 v[180:181], 0
v_mov_b64 v[182:183], 0
v_mov_b64 v[184:185], 0
v_mov_b64 v[186:187], 0
v_mov_b64 v[188:189], 0
v_mov_b64 v[190:191], 0
v_mov_b64 v[192:193], 0
v_mov_b64 v[194:195], 0
v_mov_b64 v[196:197], 0
v_mov_b64 v[198:199], 0
v_mov_b64 v[200:201], 0
v_mov_b64 v[202:203], 0
v_mov_b64 v[204:205], 0
v_mov_b64 v[206:207], 0
v_mov_b64 v[208:209], 0
v_mov_b64 v[210:211], 0
v_mov_b64 v[212:213], 0
v_mov_b64 v[214:215], 0
v_mov_b64 v[216:217], 0
v_mov_b64 v[218:219], 0
v_mov_b64 v[220:221], 0
v_mov_b64 v[222:223], 0
v_mov_b64 v[224:225], 0
v_mov_b64 v[226:227], 0
v_mov_b64 v[228:229], 0
v_mov_b64 v[230:231], 0
v_mov_b64 v[232:233], 0
v_mov_b64 v[234:235], 0
v_mov_b64 v[236:237], 0
v_mov_b64 v[238:239], 0
v_mov_b64 v[240:241], 0
v_mov_b64 v[242:243], 0
v_mov_b64 v[244:245], 0
v_mov_b64 v[246:247], 0
v_mov_b64 v[248:249], 0
v_mov_b64 v[250:251], 0
v_mov_b64 v[252:253], 0
v_mov_b64 v[254:255], 0
v_mov_b64 v[24:25], 0
s_mov_b32 s71, s28
s_mov_b32 s84, 0
s_barrier
s_branch K2_item
K2_nend:
Lstub_2:
s_call_b64 s[16:17], K2_slow1
s_branch Lback_3
Lstub_4:
s_call_b64 s[16:17], K2_slow0
s_branch Lback_5
Lstub_6:
s_call_b64 s[16:17], K2_slow1
s_branch Lback_7
Lstub_8:
s_call_b64 s[16:17], K2_slow0
s_branch Lback_9
Lstub_10:
s_call_b64 s[16:17], K2_slow2
s_branch Lback_11
Lstub_12:
s_call_b64 s[16:17], K2_slow2
s_branch Lback_13
Lstub_14:
s_call_b64 s[16:17], K2_slow1
s_branch Lback_15
K2_slow0:
s_nop 7
s_nop 7
v_max3_f32 v8, v32, v33, 0
v_max3_f32 v8, v34, v35, v8
v_max3_f32 v8, v40, v41, v8
v_max3_f32 v8, v42, v43, v8
v_max3_f32 v8, v48, v49, v8
v_max3_f32 v8, v50, v51, v8
v_max3_f32 v8, v56, v57, v8
v_max3_f32 v8, v58, v59, v8
v_mov_b32 v9, v8
s_nop 1
v_permlane16_swap_b32 v8, v9
v_max_f32 v8, v8, v9
v_mov_b32 v9, v8
s_nop 1
v_permlane32_swap_b32 v8, v9
v_max_f32 v8, v8, v9
v_exp_f32 v9, -v8
v_sub_f32 v16, v16, v8
v_sub_f32 v17, v17, v8
v_sub_f32 v18, v18, v8
v_sub_f32 v19, v19, v8
v_mul_f32 v24, v24, v9
v_mul_f32 v128, v128, v9
v_mul_f32 v129, v129, v9
v_mul_f32 v130, v130, v9
v_mul_f32 v131, v131, v9
v_mul_f32 v136, v136, v9
v_mul_f32 v137, v137, v9
v_mul_f32 v138, v138, v9
v_mul_f32 v139, v139, v9
v_mul_f32 v144, v144, v9
v_mul_f32 v145, v145, v9
v_mul_f32 v146, v146, v9
v_mul_f32 v147, v147, v9
v_mul_f32 v152, v152, v9
v_mul_f32 v153, v153, v9
v_mul_f32 v154, v154, v9
v_mul_f32 v155, v155, v9
v_mul_f32 v160, v160, v9
v_mul_f32 v161, v161, v9
v_mul_f32 v162, v162, v9
v_mul_f32 v163, v163, v9
v_mul_f32 v168, v168, v9
v_mul_f32 v169, v169, v9
v_mul_f32 v170, v170, v9
v_mul_f32 v171, v171, v9
v_mul_f32 v176, v176, v9
v_mul_f32 v177, v177, v9
v_mul_f32 v178, v178, v9
v_mul_f32 v179, v179, v9
v_mul_f32 v184, v184, v9
v_mul_f32 v185, v185, v9
v_mul_f32 v186, v186, v9
v_mul_f32 v187, v187, v9
v_mul_f32 v192, v192, v9
v_mul_f32 v193, v193, v9
v_mul_f32 v194, v194, v9
v_mul_f32 v195, v195, v9
v_mul_f32 v200, v200, v9
v_mul_f32 v201, v201, v9
v_mul_f32 v202, v202, v9
v_mul_f32 v203, v203, v9
v_mul_f32 v208, v208, v9
v_mul_f32 v209, v209, v9
v_mul_f32 v210, v210, v9
v_mul_f32 v211, v211, v9
v_mul_f32 v216, v216, v9
v_mul_f32 v217, v217, v9
v_mul_f32 v218, v218, v9
v_mul_f32 v219, v219, v9
v_mul_f32 v224, v224, v9
v_mul_f32 v225, v225, v9
v_mul_f32 v226, v226, v9
v_mul_f32 v227, v227, v9
v_mul_f32 v232, v232, v9
v_mul_f32 v233, v233, v9
v_mul_f32 v234, v234, v9
v_mul_f32 v235, v235, v9
v_mul_f32 v240, v240, v9
v_mul_f32 v241, v241, v9
v_mul_f32 v242, v242, v9
v_mul_f32 v243, v243, v9
v_mul_f32 v248, v248, v9
v_mul_f32 v249, v249, v9
v_mul_f32 v250, v250, v9
v_mul_f32 v251, v251, v9
v_sub_f32 v32, v32, v8
v_sub_f32 v33, v33, v8
v_sub_f32 v34, v34, v8
v_sub_f32 v35, v35, v8
v_sub_f32 v40, v40, v8
v_sub_f32 v41, v41, v8
v_sub_f32 v42, v42, v8
v_sub_f32 v43, v43, v8
v_sub_f32 v48, v48, v8
v_sub_f32 v49, v49, v8
v_sub_f32 v50, v50, v8
v_sub_f32 v51, v51, v8
v_sub_f32 v56, v56, v8
v_sub_f32 v57, v57, v8
v_sub_f32 v58, v58, v8
v_sub_f32 v59, v59, v8
v_sub_f32 v64, v64, v8
v_sub_f32 v65, v65, v8
v_sub_f32 v66, v66, v8
v_sub_f32 v67, v67, v8
v_sub_f32 v72, v72, v8
v_sub_f32 v73, v73, v8
v_sub_f32 v74, v74, v8
v_sub_f32 v75, v75, v8
v_sub_f32 v80, v80, v8
v_sub_f32 v81, v81, v8
v_sub_f32 v82, v82, v8
v_sub_f32 v83, v83, v8
v_sub_f32 v88, v88, v8
v_sub_f32 v89, v89, v8
v_sub_f32 v90, v90, v8
v_sub_f32 v91, v91, v8
v_max3_f32 v8, v36, v37, 0
v_max3_f32 v8, v38, v39, v8
v_max3_f32 v8, v44, v45, v8
v_max3_f32 v8, v46, v47, v8
v_max3_f32 v8, v52, v53, v8
v_max3_f32 v8, v54, v55, v8
v_max3_f32 v8, v60, v61, v8
v_max3_f32 v8, v62, v63, v8
v_mov_b32 v9, v8
s_nop 1
v_permlane16_swap_b32 v8, v9
v_max_f32 v8, v8, v9
v_mov_b32 v9, v8
s_nop 1
v_permlane32_swap_b32 v8, v9
v_max_f32 v8, v8, v9
v_exp_f32 v9, -v8
v_sub_f32 v20, v20, v8
v_sub_f32 v21, v21, v8
v_sub_f32 v22, v22, v8
v_sub_f32 v23, v23, v8
v_mul_f32 v25, v25, v9
v_mul_f32 v132, v132, v9
v_mul_f32 v133, v133, v9
v_mul_f32 v134, v134, v9
v_mul_f32 v135, v135, v9
v_mul_f32 v140, v140, v9
v_mul_f32 v141, v141, v9
v_mul_f32 v142, v142, v9
v_mul_f32 v143, v143, v9
v_mul_f32 v148, v148, v9
v_mul_f32 v149, v149, v9
v_mul_f32 v150, v150, v9
v_mul_f32 v151, v151, v9
v_mul_f32 v156, v156, v9
v_mul_f32 v157, v157, v9
v_mul_f32 v158, v158, v9
v_mul_f32 v159, v159, v9
v_mul_f32 v164, v164, v9
v_mul_f32 v165, v165, v9
v_mul_f32 v166, v166, v9
v_mul_f32 v167, v167, v9
v_mul_f32 v172, v172, v9
v_mul_f32 v173, v173, v9
v_mul_f32 v174, v174, v9
v_mul_f32 v175, v175, v9
v_mul_f32 v180, v180, v9
v_mul_f32 v181, v181, v9
v_mul_f32 v182, v182, v9
v_mul_f32 v183, v183, v9
v_mul_f32 v188, v188, v9
v_mul_f32 v189, v189, v9
v_mul_f32 v190, v190, v9
v_mul_f32 v191, v191, v9
v_mul_f32 v196, v196, v9
v_mul_f32 v197, v197, v9
v_mul_f32 v198, v198, v9
v_mul_f32 v199, v199, v9
v_mul_f32 v204, v204, v9
v_mul_f32 v205, v205, v9
v_mul_f32 v206, v206, v9
v_mul_f32 v207, v207, v9
v_mul_f32 v212, v212, v9
v_mul_f32 v213, v213, v9
v_mul_f32 v214, v214, v9
v_mul_f32 v215, v215, v9
v_mul_f32 v220, v220, v9
v_mul_f32 v221, v221, v9
v_mul_f32 v222, v222, v9
v_mul_f32 v223, v223, v9
v_mul_f32 v228, v228, v9
v_mul_f32 v229, v229, v9
v_mul_f32 v230, v230, v9
v_mul_f32 v231, v231, v9
v_mul_f32 v236, v236, v9
v_mul_f32 v237, v237, v9
v_mul_f32 v238, v238, v9
v_mul_f32 v239, v239, v9
v_mul_f32 v244, v244, v9
v_mul_f32 v245, v245, v9
v_mul_f32 v246, v246, v9
v_mul_f32 v247, v247, v9
v_mul_f32 v252, v252, v9
v_mul_f32 v253, v253, v9
v_mul_f32 v254, v254, v9
v_mul_f32 v255, v255, v9
v_sub_f32 v36, v36, v8
v_sub_f32 v37, v37, v8
v_sub_f32 v38, v38, v8
v_sub_f32 v39, v39, v8
v_sub_f32 v44, v44, v8
v_sub_f32 v45, v45, v8
v_sub_f32 v46, v46, v8
v_sub_f32 v47, v47, v8
v_sub_f32 v52, v52, v8
v_sub_f32 v53, v53, v8
v_sub_f32 v54, v54, v8
v_sub_f32 v55, v55, v8
v_sub_f32 v60, v60, v8
v_sub_f32 v61, v61, v8
v_sub_f32 v62, v62, v8
v_sub_f32 v63, v63, v8
v_sub_f32 v68, v68, v8
v_sub_f32 v69, v69, v8
v_sub_f32 v70, v70, v8
v_sub_f32 v71, v71, v8
v_sub_f32 v76, v76, v8
v_sub_f32 v77, v77, v8
v_sub_f32 v78, v78, v8
v_sub_f32 v79, v79, v8
v_sub_f32 v84, v84, v8
v_sub_f32 v85, v85, v8
v_sub_f32 v86, v86, v8
v_sub_f32 v87, v87, v8
v_sub_f32 v92, v92, v8
v_sub_f32 v93, v93, v8
v_sub_f32 v94, v94, v8
v_sub_f32 v95, v95, v8
v_exp_f32 v8, v32
v_exp_f32 v9, v33
v_exp_f32 v10, v34
v_exp_f32 v11, v35
s_nop 0
v_add_f32 v26, v8, v9
v_cvt_pk_bf16_f32 v96, v8, v9
v_add_f32 v26, v26, v10
v_add_f32 v26, v26, v11
v_cvt_pk_bf16_f32 v97, v10, v11
v_exp_f32 v12, v36
v_exp_f32 v13, v37
v_exp_f32 v14, v38
v_exp_f32 v15, v39
s_nop 0
v_add_f32 v27, v12, v13
v_cvt_pk_bf16_f32 v104, v12, v13
v_add_f32 v27, v27, v14
v_add_f32 v27, v27, v15
v_cvt_pk_bf16_f32 v105, v14, v15
v_exp_f32 v8, v40
v_exp_f32 v9, v41
v_exp_f32 v10, v42
v_exp_f32 v11, v43
s_nop 0
v_add_f32 v26, v26, v8
v_add_f32 v26, v26, v9
v_cvt_pk_bf16_f32 v98, v8, v9
v_add_f32 v26, v26, v10
v_add_f32 v26, v26, v11
v_cvt_pk_bf16_f32 v99, v10, v11
v_exp_f32 v12, v44
v_exp_f32 v13, v45
v_exp_f32 v14, v46
v_exp_f32 v15, v47
s_nop 0
v_add_f32 v27, v27, v12
v_add_f32 v27, v27, v13
v_cvt_pk_bf16_f32 v106, v12, v13
v_add_f32 v27, v27, v14
v_add_f32 v27, v27, v15
v_cvt_pk_bf16_f32 v107, v14, v15
v_exp_f32 v8, v48
v_exp_f32 v9, v49
v_exp_f32 v10, v50
v_exp_f32 v11, v51
s_nop 0
v_add_f32 v26, v26, v8
v_add_f32 v26, v26, v9
v_cvt_pk_bf16_f32 v100, v8, v9
v_add_f32 v26, v26, v10
v_add_f32 v26, v26, v11
v_cvt_pk_bf16_f32 v101, v10, v11
v_exp_f32 v12, v52
v_exp_f32 v13, v53
v_exp_f32 v14, v54
v_exp_f32 v15, v55
s_nop 0
v_add_f32 v27, v27, v12
v_add_f32 v27, v27, v13
v_cvt_pk_bf16_f32 v108, v12, v13
v_add_f32 v27, v27, v14
v_add_f32 v27, v27, v15
v_cvt_pk_bf16_f32 v109, v14, v15
v_exp_f32 v8, v56
v_exp_f32 v9, v57
v_exp_f32 v10, v58
v_exp_f32 v11, v59
s_nop 0
v_add_f32 v26, v26, v8
v_add_f32 v26, v26, v9
v_cvt_pk_bf16_f32 v102, v8, v9
v_add_f32 v26, v26, v10
v_add_f32 v26, v26, v11
v_cvt_pk_bf16_f32 v103, v10, v11
v_exp_f32 v12, v60
v_exp_f32 v13, v61
v_exp_f32 v14, v62
v_exp_f32 v15, v63
s_nop 0
v_add_f32 v27, v27, v12
v_add_f32 v27, v27, v13
v_cvt_pk_bf16_f32 v110, v12, v13
v_add_f32 v27, v27, v14
v_add_f32 v27, v27, v15
v_cvt_pk_bf16_f32 v111, v14, v15
s_nop 1
s_setpc_b64 s[16:17]
K2_slow1:
s_nop 7
s_nop 7
v_max3_f32 v8, v64, v65, 0
v_max3_f32 v8, v66, v67, v8
v_max3_f32 v8, v72, v73, v8
v_max3_f32 v8, v74, v75, v8
v_max3_f32 v8, v80, v81, v8
v_max3_f32 v8, v82, v83, v8
v_max3_f32 v8, v88, v89, v8
v_max3_f32 v8, v90, v91, v8
v_mov_b32 v9, v8
s_nop 1
v_permlane16_swap_b32 v8, v9
v_max_f32 v8, v8, v9
v_mov_b32 v9, v8
s_nop 1
v_permlane32_swap_b32 v8, v9
v_max_f32 v8, v8, v9
v_exp_f32 v9, -v8
v_sub_f32 v16, v16, v8
v_sub_f32 v17, v17, v8
v_sub_f32 v18, v18, v8
v_sub_f32 v19, v19, v8
v_mul_f32 v24, v24, v9
v_mul_f32 v128, v128, v9
v_mul_f32 v129, v129, v9
v_mul_f32 v130, v130, v9
v_mul_f32 v131, v131, v9
v_mul_f32 v136, v136, v9
v_mul_f32 v137, v137, v9
v_mul_f32 v138, v138, v9
v_mul_f32 v139, v139, v9
v_mul_f32 v144, v144, v9
v_mul_f32 v145, v145, v9
v_mul_f32 v146, v146, v9
v_mul_f32 v147, v147, v9
v_mul_f32 v152, v152, v9
v_mul_f32 v153, v153, v9
v_mul_f32 v154, v154, v9
v_mul_f32 v155, v155, v9
v_mul_f32 v160, v160, v9
v_mul_f32 v161, v161, v9
v_mul_f32 v162, v162, v9
v_mul_f32 v163, v163, v9
v_mul_f32 v168, v168, v9
v_mul_f32 v169, v169, v9
v_mul_f32 v170, v170, v9
v_mul_f32 v171, v171, v9
v_mul_f32 v176, v176, v9
v_mul_f32 v177, v177, v9
v_mul_f32 v178, v178, v9
v_mul_f32 v179, v179, v9
v_mul_f32 v184, v184, v9
v_mul_f32 v185, v185, v9
v_mul_f32 v186, v186, v9
v_mul_f32 v187, v187, v9
v_mul_f32 v192, v192, v9
v_mul_f32 v193, v193, v9
v_mul_f32 v194, v194, v9
v_mul_f32 v195, v195, v9
v_mul_f32 v200, v200, v9
v_mul_f32 v201, v201, v9
v_mul_f32 v202, v202, v9
v_mul_f32 v203, v203, v9
v_mul_f32 v208, v208, v9
v_mul_f32 v209, v209, v9
v_mul_f32 v210, v210, v9
v_mul_f32 v211, v211, v9
v_mul_f32 v216, v216, v9
v_mul_f32 v217, v217, v9
v_mul_f32 v218, v218, v9
v_mul_f32 v219, v219, v9
v_mul_f32 v224, v224, v9
v_mul_f32 v225, v225, v9
v_mul_f32 v226, v226, v9
v_mul_f32 v227, v227, v9
v_mul_f32 v232, v232, v9
v_mul_f32 v233, v233, v9
v_mul_f32 v234, v234, v9
v_mul_f32 v235, v235, v9
v_mul_f32 v240, v240, v9
v_mul_f32 v241, v241, v9
v_mul_f32 v242, v242, v9
v_mul_f32 v243, v243, v9
v_mul_f32 v248, v248, v9
v_mul_f32 v249, v249, v9
v_mul_f32 v250, v250, v9
v_mul_f32 v251, v251, v9
v_sub_f32 v32, v32, v8
v_sub_f32 v33, v33, v8
v_sub_f32 v34, v34, v8
v_sub_f32 v35, v35, v8
v_sub_f32 v40, v40, v8
v_sub_f32 v41, v41, v8
v_sub_f32 v42, v42, v8
v_sub_f32 v43, v43, v8
v_sub_f32 v48, v48, v8
v_sub_f32 v49, v49, v8
v_sub_f32 v50, v50, v8
v_sub_f32 v51, v51, v8
v_sub_f32 v56, v56, v8
v_sub_f32 v57, v57, v8
v_sub_f32 v58, v58, v8
v_sub_f32 v59, v59, v8
v_sub_f32 v64, v64, v8
v_sub_f32 v65, v65, v8
v_sub_f32 v66, v66, v8
v_sub_f32 v67, v67, v8
v_sub_f32 v72, v72, v8
v_sub_f32 v73, v73, v8
v_sub_f32 v74, v74, v8
v_sub_f32 v75, v75, v8
v_sub_f32 v80, v80, v8
v_sub_f32 v81, v81, v8
v_sub_f32 v82, v82, v8
v_sub_f32 v83, v83, v8
v_sub_f32 v88, v88, v8
v_sub_f32 v89, v89, v8
v_sub_f32 v90, v90, v8
v_sub_f32 v91, v91, v8
v_max3_f32 v8, v68, v69, 0
v_max3_f32 v8, v70, v71, v8
v_max3_f32 v8, v76, v77, v8
v_max3_f32 v8, v78, v79, v8
v_max3_f32 v8, v84, v85, v8
v_max3_f32 v8, v86, v87, v8
v_max3_f32 v8, v92, v93, v8
v_max3_f32 v8, v94, v95, v8
v_mov_b32 v9, v8
s_nop 1
v_permlane16_swap_b32 v8, v9
v_max_f32 v8, v8, v9
v_mov_b32 v9, v8
s_nop 1
v_permlane32_swap_b32 v8, v9
v_max_f32 v8, v8, v9
v_exp_f32 v9, -v8
v_sub_f32 v20, v20, v8
v_sub_f32 v21, v21, v8
v_sub_f32 v22, v22, v8
v_sub_f32 v23, v23, v8
v_mul_f32 v25, v25, v9
v_mul_f32 v132, v132, v9
v_mul_f32 v133, v133, v9
v_mul_f32 v134, v134, v9
v_mul_f32 v135, v135, v9
v_mul_f32 v140, v140, v9
v_mul_f32 v141, v141, v9
v_mul_f32 v142, v142, v9
v_mul_f32 v143, v143, v9
v_mul_f32 v148, v148, v9
v_mul_f32 v149, v149, v9
v_mul_f32 v150, v150, v9
v_mul_f32 v151, v151, v9
v_mul_f32 v156, v156, v9
v_mul_f32 v157, v157, v9
v_mul_f32 v158, v158, v9
v_mul_f32 v159, v159, v9
v_mul_f32 v164, v164, v9
v_mul_f32 v165, v165, v9
v_mul_f32 v166, v166, v9
v_mul_f32 v167, v167, v9
v_mul_f32 v172, v172, v9
v_mul_f32 v173, v173, v9
v_mul_f32 v174, v174, v9
v_mul_f32 v175, v175, v9
v_mul_f32 v180, v180, v9
v_mul_f32 v181, v181, v9
v_mul_f32 v182, v182, v9
v_mul_f32 v183, v183, v9
v_mul_f32 v188, v188, v9
v_mul_f32 v189, v189, v9
v_mul_f32 v190, v190, v9
v_mul_f32 v191, v191, v9
v_mul_f32 v196, v196, v9
v_mul_f32 v197, v197, v9
v_mul_f32 v198, v198, v9
v_mul_f32 v199, v199, v9
v_mul_f32 v204, v204, v9
v_mul_f32 v205, v205, v9
v_mul_f32 v206, v206, v9
v_mul_f32 v207, v207, v9
v_mul_f32 v212, v212, v9
v_mul_f32 v213, v213, v9
v_mul_f32 v214, v214, v9
v_mul_f32 v215, v215, v9
v_mul_f32 v220, v220, v9
v_mul_f32 v221, v221, v9
v_mul_f32 v222, v222, v9
v_mul_f32 v223, v223, v9
v_mul_f32 v228, v228, v9
v_mul_f32 v229, v229, v9
v_mul_f32 v230, v230, v9
v_mul_f32 v231, v231, v9
v_mul_f32 v236, v236, v9
v_mul_f32 v237, v237, v9
v_mul_f32 v238, v238, v9
v_mul_f32 v239, v239, v9
v_mul_f32 v244, v244, v9
v_mul_f32 v245, v245, v9
v_mul_f32 v246, v246, v9
v_mul_f32 v247, v247, v9
v_mul_f32 v252, v252, v9
v_mul_f32 v253, v253, v9
v_mul_f32 v254, v254, v9
v_mul_f32 v255, v255, v9
v_sub_f32 v36, v36, v8
v_sub_f32 v37, v37, v8
v_sub_f32 v38, v38, v8
v_sub_f32 v39, v39, v8
v_sub_f32 v44, v44, v8
v_sub_f32 v45, v45, v8
v_sub_f32 v46, v46, v8
v_sub_f32 v47, v47, v8
v_sub_f32 v52, v52, v8
v_sub_f32 v53, v53, v8
v_sub_f32 v54, v54, v8
v_sub_f32 v55, v55, v8
v_sub_f32 v60, v60, v8
v_sub_f32 v61, v61, v8
v_sub_f32 v62, v62, v8
v_sub_f32 v63, v63, v8
v_sub_f32 v68, v68, v8
v_sub_f32 v69, v69, v8
v_sub_f32 v70, v70, v8
v_sub_f32 v71, v71, v8
v_sub_f32 v76, v76, v8
v_sub_f32 v77, v77, v8
v_sub_f32 v78, v78, v8
v_sub_f32 v79, v79, v8
v_sub_f32 v84, v84, v8
v_sub_f32 v85, v85, v8
v_sub_f32 v86, v86, v8
v_sub_f32 v87, v87, v8
v_sub_f32 v92, v92, v8
v_sub_f32 v93, v93, v8
v_sub_f32 v94, v94, v8
v_sub_f32 v95, v95, v8
v_exp_f32 v8, v64
v_exp_f32 v9, v65
v_exp_f32 v10, v66
v_exp_f32 v11, v67
s_nop 0
v_add_f32 v26, v8, v9
v_cvt_pk_bf16_f32 v112, v8, v9
v_add_f32 v26, v26, v10
v_add_f32 v26, v26, v11
v_cvt_pk_bf16_f32 v113, v10, v11
v_exp_f32 v12, v68
v_exp_f32 v13, v69
v_exp_f32 v14, v70
v_exp_f32 v15, v71
s_nop 0
v_add_f32 v27, v12, v13
v_cvt_pk_bf16_f32 v120, v12, v13
v_add_f32 v27, v27, v14
v_add_f32 v27, v27, v15
v_cvt_pk_bf16_f32 v121, v14, v15
v_exp_f32 v8, v72
v_exp_f32 v9, v73
v_exp_f32 v10, v74
v_exp_f32 v11, v75
s_nop 0
v_add_f32 v26, v26, v8
v_add_f32 v26, v26, v9
v_cvt_pk_bf16_f32 v114, v8, v9
v_add_f32 v26, v26, v10
v_add_f32 v26, v26, v11
v_cvt_pk_bf16_f32 v115, v10, v11
v_exp_f32 v12, v76
v_exp_f32 v13, v77
v_exp_f32 v14, v78
v_exp_f32 v15, v79
s_nop 0
v_add_f32 v27, v27, v12
v_add_f32 v27, v27, v13
v_cvt_pk_bf16_f32 v122, v12, v13
v_add_f32 v27, v27, v14
v_add_f32 v27, v27, v15
v_cvt_pk_bf16_f32 v123, v14, v15
v_exp_f32 v8, v80
v_exp_f32 v9, v81
v_exp_f32 v10, v82
v_exp_f32 v11, v83
s_nop 0
v_add_f32 v26, v26, v8
v_add_f32 v26, v26, v9
v_cvt_pk_bf16_f32 v116, v8, v9
v_add_f32 v26, v26, v10
v_add_f32 v26, v26, v11
v_cvt_pk_bf16_f32 v117, v10, v11
v_exp_f32 v12, v84
v_exp_f32 v13, v85
v_exp_f32 v14, v86
v_exp_f32 v15, v87
s_nop 0
v_add_f32 v27, v27, v12
v_add_f32 v27, v27, v13
v_cvt_pk_bf16_f32 v124, v12, v13
v_add_f32 v27, v27, v14
v_add_f32 v27, v27, v15
v_cvt_pk_bf16_f32 v125, v14, v15
v_exp_f32 v8, v88
v_exp_f32 v9, v89
v_exp_f32 v10, v90
v_exp_f32 v11, v91
s_nop 0
v_add_f32 v26, v26, v8
v_add_f32 v26, v26, v9
v_cvt_pk_bf16_f32 v118, v8, v9
v_add_f32 v26, v26, v10
v_add_f32 v26, v26, v11
v_cvt_pk_bf16_f32 v119, v10, v11
v_exp_f32 v12, v92
v_exp_f32 v13, v93
v_exp_f32 v14, v94
v_exp_f32 v15, v95
s_nop 0
v_add_f32 v27, v27, v12
v_add_f32 v27, v27, v13
v_cvt_pk_bf16_f32 v126, v12, v13
v_add_f32 v27, v27, v14
v_add_f32 v27, v27, v15
v_cvt_pk_bf16_f32 v127, v14, v15
s_nop 1
s_setpc_b64 s[16:17]
K2_slow2:
s_nop 7
s_nop 7
v_max3_f32 v8, v68, v69, 0
v_max3_f32 v8, v70, v71, v8
v_max3_f32 v8, v76, v77, v8
v_max3_f32 v8, v78, v79, v8
v_max3_f32 v8, v84, v85, v8
v_max3_f32 v8, v86, v87, v8
v_max3_f32 v8, v92, v93, v8
v_max3_f32 v8, v94, v95, v8
v_mov_b32 v9, v8
s_nop 1
v_permlane16_swap_b32 v8, v9
v_max_f32 v8, v8, v9
v_mov_b32 v9, v8
s_nop 1
v_permlane32_swap_b32 v8, v9
v_max_f32 v8, v8, v9
v_exp_f32 v9, -v8
v_sub_f32 v20, v20, v8
v_sub_f32 v21, v21, v8
v_sub_f32 v22, v22, v8
v_sub_f32 v23, v23, v8
v_mul_f32 v25, v25, v9
v_mul_f32 v132, v132, v9
v_mul_f32 v133, v133, v9
v_mul_f32 v134, v134, v9
v_mul_f32 v135, v135, v9
v_mul_f32 v140, v140, v9
v_mul_f32 v141, v141, v9
v_mul_f32 v142, v142, v9
v_mul_f32 v143, v143, v9
v_mul_f32 v148, v148, v9
v_mul_f32 v149, v149, v9
v_mul_f32 v150, v150, v9
v_mul_f32 v151, v151, v9
v_mul_f32 v156, v156, v9
v_mul_f32 v157, v157, v9
v_mul_f32 v158, v158, v9
v_mul_f32 v159, v159, v9
v_mul_f32 v164, v164, v9
v_mul_f32 v165, v165, v9
v_mul_f32 v166, v166, v9
v_mul_f32 v167, v167, v9
v_mul_f32 v172, v172, v9
v_mul_f32 v173, v173, v9
v_mul_f32 v174, v174, v9
v_mul_f32 v175, v175, v9
v_mul_f32 v180, v180, v9
v_mul_f32 v181, v181, v9
v_mul_f32 v182, v182, v9
v_mul_f32 v183, v183, v9
v_mul_f32 v188, v188, v9
v_mul_f32 v189, v189, v9
v_mul_f32 v190, v190, v9
v_mul_f32 v191, v191, v9
v_mul_f32 v196, v196, v9
v_mul_f32 v197, v197, v9
v_mul_f32 v198, v198, v9
v_mul_f32 v199, v199, v9
v_mul_f32 v204, v204, v9
v_mul_f32 v205, v205, v9
v_mul_f32 v206, v206, v9
v_mul_f32 v207, v207, v9
v_mul_f32 v212, v212, v9
v_mul_f32 v213, v213, v9
v_mul_f32 v214, v214, v9
v_mul_f32 v215, v215, v9
v_mul_f32 v220, v220, v9
v_mul_f32 v221, v221, v9
v_mul_f32 v222, v222, v9
v_mul_f32 v223, v223, v9
v_mul_f32 v228, v228, v9
v_mul_f32 v229, v229, v9
v_mul_f32 v230, v230, v9
v_mul_f32 v231, v231, v9
v_mul_f32 v236, v236, v9
v_mul_f32 v237, v237, v9
v_mul_f32 v238, v238, v9
v_mul_f32 v239, v239, v9
v_mul_f32 v244, v244, v9
v_mul_f32 v245, v245, v9
v_mul_f32 v246, v246, v9
v_mul_f32 v247, v247, v9
v_mul_f32 v252, v252, v9
v_mul_f32 v253, v253, v9
v_mul_f32 v254, v254, v9
v_mul_f32 v255, v255, v9
v_sub_f32 v68, v68, v8
v_sub_f32 v69, v69, v8
v_sub_f32 v70, v70, v8
v_sub_f32 v71, v71, v8
v_sub_f32 v76, v76, v8
v_sub_f32 v77, v77, v8
v_sub_f32 v78, v78, v8
v_sub_f32 v79, v79, v8
v_sub_f32 v84, v84, v8
v_sub_f32 v85, v85, v8
v_sub_f32 v86, v86, v8
v_sub_f32 v87, v87, v8
v_sub_f32 v92, v92, v8
v_sub_f32 v93, v93, v8
v_sub_f32 v94, v94, v8
v_sub_f32 v95, v95, v8
v_exp_f32 v8, v68
v_exp_f32 v9, v69
v_exp_f32 v10, v70
v_exp_f32 v11, v71
s_nop 0
v_add_f32 v27, v8, v9
v_cvt_pk_bf16_f32 v120, v8, v9
v_add_f32 v27, v27, v10
v_add_f32 v27, v27, v11
v_cvt_pk_bf16_f32 v121, v10, v11
v_exp_f32 v12, v76
v_exp_f32 v13, v77
v_exp_f32 v14, v78
v_exp_f32 v15, v79
s_nop 0
v_add_f32 v27, v27, v12
v_add_f32 v27, v27, v13
v_cvt_pk_bf16_f32 v122, v12, v13
v_add_f32 v27, v27, v14
v_add_f32 v27, v27, v15
v_cvt_pk_bf16_f32 v123, v14, v15
v_exp_f32 v8, v84
v_exp_f32 v9, v85
v_exp_f32 v10, v86
v_exp_f32 v11, v87
s_nop 0
v_add_f32 v27, v27, v8
v_add_f32 v27, v27, v9
v_cvt_pk_bf16_f32 v124, v8, v9
v_add_f32 v27, v27, v10
v_add_f32 v27, v27, v11
v_cvt_pk_bf16_f32 v125, v10, v11
v_exp_f32 v12, v92
v_exp_f32 v13, v93
v_exp_f32 v14, v94
v_exp_f32 v15, v95
s_nop 0
v_add_f32 v27, v27, v12
v_add_f32 v27, v27, v13
v_cvt_pk_bf16_f32 v126, v12, v13
v_add_f32 v27, v27, v14
v_add_f32 v27, v27, v15
v_cvt_pk_bf16_f32 v127, v14, v15
s_nop 1
s_setpc_b64 s[16:17]
M_cntspinK:
Lp_9801:
buffer_load_dword v245, off, s[60:63], 0 sc1
s_waitcnt vmcnt(0)
v_cmp_gt_u32 vcc, 0x100, v245
s_cbranch_vccz Lpd_9802
s_sleep 8
s_sub_u32 s101, s101, 1
s_cbranch_scc0 Lp_9801
s_mov_b32 s101, 0
Lpd_9802:
s_branch Lg_1
M_ppspinK:
Lp_9803:
buffer_load_dword v230, v231, s[4:7], s52 offen sc1
s_waitcnt vmcnt(0)
v_cmp_gt_u32 vcc, 1, v230
s_cbranch_vccz Lpd_9804
s_sleep 8
s_sub_u32 s101, s101, 1
s_cbranch_scc0 Lp_9803
s_mov_b32 s101, 0
Lpd_9804:
s_branch M_ppokK
M_cntspinV:
Lp_9805:
buffer_load_dword v245, off, s[60:63], 0 sc1
s_waitcnt vmcnt(0)
v_cmp_gt_u32 vcc, 0x100, v245
s_cbranch_vccz Lpd_9806
s_sleep 8
s_sub_u32 s101, s101, 1
s_cbranch_scc0 Lp_9805
s_mov_b32 s101, 0
Lpd_9806:
s_branch Lg_501
M_ppspinV:
Lp_9807:
buffer_load_dword v230, v231, s[4:7], s52 offen sc1
s_waitcnt vmcnt(0)
v_cmp_gt_u32 vcc, 1, v230
s_cbranch_vccz Lpd_9808
s_sleep 8
s_sub_u32 s101, s101, 1
s_cbranch_scc0 Lp_9807
s_mov_b32 s101, 0
Lpd_9808:
s_branch M_ppokV
M_end:
s_endpgm
.section .rodata,"a"
.p2align 6
.amdhsa_kernel concat_heads__ssm_conv_h3__compressed_kv_cla__prompt_kernel
  .amdhsa_next_free_vgpr 512
  .amdhsa_next_free_sgpr 102
  .amdhsa_accum_offset 256
  .amdhsa_group_segment_fixed_size 0
  .amdhsa_kernarg_size 120
  .amdhsa_user_sgpr_count 2
  .amdhsa_user_sgpr_kernarg_segment_ptr 1
  .amdhsa_system_sgpr_workgroup_id_x 1
  .amdhsa_float_denorm_mode_32 3
  .amdhsa_float_denorm_mode_16_64 3
  .amdhsa_ieee_mode 0
  .amdhsa_dx10_clamp 0
.end_amdhsa_kernel
```

```asm
; @launch grid=(256,1,1) block=(256,1,1) lds=163840
.amdgcn_target "amdgcn-amd-amdhsa--gfx950"
.text
.globl concat_heads__ssm_conv_h3__compressed_kv_cla__prompt_kernel
.p2align 8
.type concat_heads__ssm_conv_h3__compressed_kv_cla__prompt_kernel,@function
concat_heads__ssm_conv_h3__compressed_kv_cla__prompt_kernel:
s_cmp_ge_u32 s2, 256
s_cbranch_scc1 M_end
s_load_dwordx16 s[64:79], s[0:1], 0
s_load_dwordx8 s[80:87], s[0:1], 64
s_load_dwordx4 s[88:91], s[0:1], 96
s_load_dwordx2 s[92:93], s[0:1], 112
s_getpc_b64 s[58:59]
M_pc:
s_lshr_b32 s22, s2, 3
s_lshl_b32 s22, s22, 5
v_and_b32 v26, 31, v0
v_add_u32 v26, s22, v26
v_lshlrev_b32 v26, 7, v26
v_min_u32 v26, M_end-M_pc, v26
v_mov_b32 v27, s59
v_add_co_u32 v26, vcc, s58, v26
s_nop 1
v_addc_co_u32 v27, vcc, 0, v27, vcc
global_load_dword v21, v[26:27], off
v_lshrrev_b32 v28, 6, v0
v_and_b32 v29, 63, v0
v_lshlrev_b32 v1, 4, v29
v_readfirstlane_b32 s3, v28
s_lshr_b32 s21, s2, 5
v_lshrrev_b32 v26, 7, v1
v_lshrrev_b32 v27, 1, v26
v_lshlrev_b32 v27, 4, v27
v_and_b32 v28, 0x70, v1
v_xor_b32 v27, v27, v28
v_mul_u32_u24 v26, 2048, v26
v_add_u32 v12, v26, v27
v_xor_b32 v27, 64, v27
v_add_u32 v26, v26, v27
v_add_u32 v13, 15360, v26
v_add_u32 v14, 30720, v12
v_add_u32 v15, 46080, v26
s_lshl_b32 s28, s3, 13
s_lshl_b32 s24, s21, 19
s_lshl_b32 s22, s3, 17
s_add_u32 s24, s24, s22
s_add_u32 s25, s24, 65536
s_mov_b32 s10, 4194304
s_mov_b32 s11, 0x20000
s_and_b32 s20, s2, 7
s_lshl_b32 s20, s20, 1
s_bfe_u32 s22, s2, 0x10003
s_add_u32 s20, s20, s22
v_lshrrev_b32 v26, 5, v29
v_and_b32 v27, 31, v29
s_and_b32 s22, s3, 1
s_lshl_b32 s22, s22, 2
v_or_b32 v28, s22, v26
v_lshlrev_b32 v28, 1, v28
v_xor_b32 v27, v27, v28
v_lshlrev_b32 v27, 4, v27
v_lshl_add_u32 v16, v26, 13, v27
v_xor_b32 v26, 64, v16
v_add_u32 v17, 15360, v26
v_add_u32 v18, 30720, v16
v_add_u32 v19, 46080, v26
s_lshl_b32 s29, s3, 12
s_lshl_b32 s26, s3, 16
s_lshl_b32 s22, s20, 9
s_add_u32 s26, s26, s22
s_add_u32 s27, s26, 262144
s_mov_b32 s14, 8388608
s_mov_b32 s15, 0x20000
s_mov_b32 s101, 0x40000
v_and_b32 v30, 15, v29
v_lshrrev_b32 v31, 4, v29
v_lshrrev_b32 v26, 1, v30
v_xor_b32 v26, v31, v26
v_lshlrev_b32 v26, 4, v26
v_lshl_add_u32 v2, v30, 7, v26
s_lshr_b32 s22, s3, 1
s_lshl_b32 s22, s22, 14
v_add_u32 v2, s22, v2
v_xor_b32 v3, 64, v2
v_lshrrev_b32 v26, 2, v30
v_and_b32 v27, 1, v31
v_lshl_or_b32 v27, v27, 2, v26
v_lshl_add_u32 v26, v31, 3, v26
v_lshlrev_b32 v26, 9, v26
v_lshl_add_u32 v26, v27, 5, v26
v_and_b32 v27, 3, v29
v_lshl_add_u32 v26, v27, 3, v26
s_and_b32 s22, s3, 1
s_lshl_b32 s22, s22, 8
s_add_u32 s22, s22, 0x10000
v_xor_b32 v4, s22, v26
v_xor_b32 v5, 32, v4
v_xor_b32 v6, 64, v4
v_xor_b32 v7, 96, v4
v_xor_b32 v8, 128, v4
v_xor_b32 v9, 160, v4
v_xor_b32 v10, 192, v4
v_xor_b32 v11, 224, v4
s_mov_b32 s19, 0x20000
s_cmp_eq_u32 s3, 2
s_cbranch_scc1 M_pf2
s_cmp_lg_u32 s3, 0
s_cbranch_scc1 M_pf3
s_mov_b32 s18, 8388608
s_mov_b32 s51, 8388608
s_mov_b32 s47, 524288
s_mov_b32 s43, 524288
s_lshl_b32 s22, s21, 16
s_lshl_b32 s23, s20, 9
s_add_u32 s22, s22, s23
v_bfe_u32 v26, v29, 2, 3
v_lshl_add_u32 v26, v26, 13, s22
v_and_b32 v27, 3, v29
v_lshl_add_u32 v20, v27, 7, v26
v_lshrrev_b32 v27, 5, v29
v_lshl_add_u32 v22, v27, 19, v20
v_cmp_gt_u32 vcc, 32, v29
s_branch M_pfd
M_pf2:
s_mov_b32 s18, 4194304
s_mov_b32 s51, 2048
s_mov_b32 s47, 256
s_mov_b32 s43, 0
s_lshl_b32 s22, s2, 14
v_bfe_u32 v26, v29, 1, 3
v_lshl_add_u32 v26, v26, 11, s22
v_and_b32 v27, 1, v29
v_lshl_add_u32 v20, v27, 7, v26
v_bfe_u32 v27, v29, 4, 1
v_lshl_add_u32 v22, v27, 8, v20
v_cmp_gt_u32 vcc, 16, v29
s_branch M_pfd
M_pf3:
s_mov_b32 s18, 0
s_mov_b32 s51, 3112960
s_mov_b32 s47, 622592
s_mov_b32 s43, 0
s_mul_i32 s22, s2, 2432
v_lshl_add_u32 v20, v29, 7, s22
v_mov_b32 v22, v20
v_cmp_gt_u32 vcc, 19, v29
M_pfd:
v_mov_b32 v26, 3221225472
s_nop 0
v_cndmask_b32 v20, v26, v20, vcc
s_bitcmp1_b32 s2, 4
s_waitcnt lgkmcnt(0)
s_mov_b64 s[8:9], s[78:79]
s_cselect_b64 s[12:13], s[84:85], s[82:83]
s_add_u32 m0, s28, 0
s_nop 0
buffer_load_dwordx4 v12, s[8:11], s24 offen offset:0 lds
buffer_load_dwordx4 v13, s[8:11], s24 offen offset:1024 lds
buffer_load_dwordx4 v14, s[8:11], s24 offen offset:2048 lds
buffer_load_dwordx4 v15, s[8:11], s24 offen offset:3072 lds
s_add_u32 s24, s24, 128
s_add_u32 m0, s28, 4096
s_nop 0
buffer_load_dwordx4 v12, s[8:11], s25 offen offset:0 lds
buffer_load_dwordx4 v13, s[8:11], s25 offen offset:1024 lds
buffer_load_dwordx4 v14, s[8:11], s25 offen offset:2048 lds
buffer_load_dwordx4 v15, s[8:11], s25 offen offset:3072 lds
s_add_u32 s25, s25, 128
s_add_u32 m0, s29, 65536
s_nop 0
buffer_load_dwordx4 v16, s[12:15], s26 offen offset:0 lds
buffer_load_dwordx4 v17, s[12:15], s26 offen offset:1024 lds
buffer_load_dwordx4 v18, s[12:15], s26 offen offset:2048 lds
buffer_load_dwordx4 v19, s[12:15], s26 offen offset:3072 lds
s_add_u32 s26, s26, 524288
s_add_u32 m0, s29, 81920
s_nop 0
buffer_load_dwordx4 v16, s[12:15], s27 offen offset:0 lds
buffer_load_dwordx4 v17, s[12:15], s27 offen offset:1024 lds
buffer_load_dwordx4 v18, s[12:15], s27 offen offset:2048 lds
buffer_load_dwordx4 v19, s[12:15], s27 offen offset:3072 lds
s_add_u32 s27, s27, 524288
s_mov_b64 exec, 0
s_bfe_u32 s22, s2, 0x10004
s_lshl_b32 s22, s22, 2
s_add_u32 s22, s22, s3
s_cmp_lg_u32 s22, 0
s_cbranch_scc1 M_tw1
s_call_b64 s[98:99], PAD_0
s_call_b64 s[98:99], PAD_8
s_branch M_td
M_tw1:
s_cmp_lg_u32 s22, 1
s_cbranch_scc1 M_tw2
s_call_b64 s[98:99], PAD_1
s_call_b64 s[98:99], PAD_9
s_branch M_td
M_tw2:
s_cmp_lg_u32 s22, 2
s_cbranch_scc1 M_tw3
s_call_b64 s[98:99], PAD_2
s_call_b64 s[98:99], PAD_6
s_call_b64 s[98:99], PAD_10
s_branch M_td
M_tw3:
s_cmp_lg_u32 s22, 3
s_cbranch_scc1 M_tw4
s_call_b64 s[98:99], PAD_3
s_call_b64 s[98:99], PAD_7
s_call_b64 s[98:99], PAD_11
s_branch M_td
M_tw4:
s_cmp_lg_u32 s22, 4
s_cbranch_scc1 M_tw5
s_call_b64 s[98:99], PAD_22
s_branch M_td
M_tw5:
s_cmp_lg_u32 s22, 5
s_cbranch_scc1 M_tw6
s_call_b64 s[98:99], PAD_23
s_branch M_td
M_tw6:
s_cmp_lg_u32 s22, 6
s_cbranch_scc1 M_tw7
s_call_b64 s[98:99], PAD_24
s_branch M_td
M_tw7:
s_call_b64 s[98:99], PAD_21
M_td:
s_mov_b64 exec, -1
s_add_u32 m0, s28, 32768
s_nop 0
buffer_load_dwordx4 v12, s[8:11], s24 offen offset:0 lds
buffer_load_dwordx4 v13, s[8:11], s24 offen offset:1024 lds
buffer_load_dwordx4 v14, s[8:11], s24 offen offset:2048 lds
buffer_load_dwordx4 v15, s[8:11], s24 offen offset:3072 lds
s_add_u32 s24, s24, 128
s_add_u32 m0, s28, 36864
s_nop 0
buffer_load_dwordx4 v12, s[8:11], s25 offen offset:0 lds
buffer_load_dwordx4 v13, s[8:11], s25 offen offset:1024 lds
buffer_load_dwordx4 v14, s[8:11], s25 offen offset:2048 lds
buffer_load_dwordx4 v15, s[8:11], s25 offen offset:3072 lds
s_add_u32 s25, s25, 128
s_cmp_eq_u32 s3, 0
s_cselect_b64 s[16:17], s[12:13], s[8:9]
buffer_load_dword v21, v22, s[16:19], s43 offen
s_add_u32 s43, s43, s47
s_add_u32 s43, s43, s47
s_mov_b32 s4, s92
s_mov_b32 s5, s93
s_mov_b32 s6, 268435456
s_mov_b32 s7, 0x20000
s_cmp_eq_u32 s3, 3
s_cselect_b64 s[40:41], s[76:77], s[80:81]
s_cselect_b32 s42, 1835008, 0
s_cmp_eq_u32 s3, 1
s_cselect_b32 s42, 3670016, s42
s_cmp_eq_u32 s3, 3
s_cselect_b64 s[44:45], s[86:87], s[72:73]
s_cselect_b32 s46, 3670016, 0
s_cmp_eq_u32 s3, 1
s_cselect_b32 s46, 1835008, s46
s_cmp_eq_u32 s3, 2
s_cselect_b64 s[40:41], s[64:65], s[40:41]
s_cselect_b32 s42, 1835008, s42
s_waitcnt vmcnt(9)
s_barrier
ds_read_b64_tr_b16 a[128:129], v4 offset:0
ds_read_b64_tr_b16 a[130:131], v4 offset:2048
ds_read_b64_tr_b16 a[132:133], v4 offset:16384
ds_read_b64_tr_b16 a[134:135], v4 offset:18432
ds_read_b128 a[0:3], v2 offset:0
ds_read_b128 a[4:7], v3 offset:0
ds_read_b128 a[8:11], v2 offset:2048
ds_read_b128 a[12:15], v3 offset:2048
ds_read_b128 a[16:19], v2 offset:4096
ds_read_b128 a[20:23], v3 offset:4096
ds_read_b128 a[24:27], v2 offset:6144
ds_read_b128 a[28:31], v3 offset:6144
ds_read_b128 a[32:35], v2 offset:8192
ds_read_b128 a[36:39], v3 offset:8192
ds_read_b128 a[40:43], v2 offset:10240
ds_read_b128 a[44:47], v3 offset:10240
ds_read_b128 a[48:51], v2 offset:12288
ds_read_b128 a[52:55], v3 offset:12288
ds_read_b128 a[56:59], v2 offset:14336
ds_read_b128 a[60:63], v3 offset:14336
s_add_u32 m0, s29, 98304
s_nop 0
buffer_load_dwordx4 v16, s[12:15], s26 offen offset:0 lds
buffer_load_dwordx4 v17, s[12:15], s26 offen offset:1024 lds
buffer_load_dwordx4 v18, s[12:15], s26 offen offset:2048 lds
buffer_load_dwordx4 v19, s[12:15], s26 offen offset:3072 lds
s_add_u32 s26, s26, 524288
s_waitcnt lgkmcnt(0)
s_barrier
s_bitcmp1_b32 s2, 4
s_cbranch_scc1 M_V
s_branch M_K
M_t2B:
s_mov_b64 exec, 0
s_cmp_lg_u32 s3, 0
s_cbranch_scc1 M_uw1
s_call_b64 s[98:99], PAD_32
s_call_b64 s[98:99], PAD_16
s_branch M_ud
M_uw1:
s_cmp_lg_u32 s3, 1
s_cbranch_scc1 M_uw2
s_call_b64 s[98:99], PAD_9
s_call_b64 s[98:99], PAD_33
s_call_b64 s[98:99], PAD_13
s_branch M_ud
M_uw2:
s_cmp_lg_u32 s3, 2
s_cbranch_scc1 M_uw3
s_call_b64 s[98:99], PAD_10
s_call_b64 s[98:99], PAD_34
s_call_b64 s[98:99], PAD_14
s_branch M_ud
M_uw3:
s_call_b64 s[98:99], PAD_11
s_call_b64 s[98:99], PAD_15
M_ud:
s_mov_b64 exec, -1
s_branch M_t2Br
M_t2A:
s_mov_b64 exec, 0
s_lshl_b32 s22, s24, 2
s_add_u32 s22, s22, s3
s_cmp_lg_u32 s22, 0
s_cbranch_scc1 M_vw1
s_call_b64 s[98:99], PAD_32
s_call_b64 s[98:99], PAD_16
s_branch M_vd
M_vw1:
s_cmp_lg_u32 s22, 1
s_cbranch_scc1 M_vw2
s_call_b64 s[98:99], PAD_13
s_branch M_vd
M_vw2:
s_cmp_lg_u32 s22, 2
s_cbranch_scc1 M_vw3
s_call_b64 s[98:99], PAD_14
s_call_b64 s[98:99], PAD_19
s_branch M_vd
M_vw3:
s_cmp_lg_u32 s22, 3
s_cbranch_scc1 M_vw4
s_call_b64 s[98:99], PAD_15
s_call_b64 s[98:99], PAD_20
s_branch M_vd
M_vw4:
s_cmp_lg_u32 s22, 4
s_cbranch_scc1 M_vw5
s_call_b64 s[98:99], PAD_12
s_call_b64 s[98:99], PAD_16
s_branch M_vd
M_vw5:
s_cmp_lg_u32 s22, 5
s_cbranch_scc1 M_vw6
s_call_b64 s[98:99], PAD_13
s_branch M_vd
M_vw6:
s_cmp_lg_u32 s22, 6
s_cbranch_scc1 M_vw7
s_call_b64 s[98:99], PAD_14
s_branch M_vd
M_vw7:
s_call_b64 s[98:99], PAD_15
M_vd:
s_mov_b64 exec, -1
s_branch M_t2Ar
M_tret:
s_setpc_b64 s[98:99]
.p2align 12
PAD_0:
s_cbranch_execz PAD_4
M_K:
v_mfma_f32_16x16x32_bf16 v[32:35], a[128:131], a[0:3], 0
s_add_u32 m0, s29, 114688
ds_read_b64_tr_b16 a[136:137], v5 offset:0
v_mfma_f32_16x16x32_bf16 v[32:35], a[132:135], a[4:7], v[32:35]
s_mov_b32 s32, 8192
buffer_load_dwordx4 v16, s[12:15], s27 offen offset:0 lds
v_mfma_f32_16x16x32_bf16 v[40:43], a[128:131], a[8:11], 0
s_mov_b32 s33, 8192
ds_read_b64_tr_b16 a[138:139], v5 offset:2048
v_mfma_f32_16x16x32_bf16 v[40:43], a[132:135], a[12:15], v[40:43]
s_mov_b32 s34, 8192
v_mfma_f32_16x16x32_bf16 v[48:51], a[128:131], a[16:19], 0
s_mov_b32 s35, 4294910976
ds_read_b64_tr_b16 a[140:141], v5 offset:16384
v_mfma_f32_16x16x32_bf16 v[48:51], a[132:135], a[20:23], v[48:51]
s_mov_b32 s36, 4294910976
buffer_load_dwordx4 v17, s[12:15], s27 offen offset:1024 lds
v_mfma_f32_16x16x32_bf16 v[56:59], a[128:131], a[24:27], 0
s_mov_b32 s30, 8
ds_read_b64_tr_b16 a[142:143], v5 offset:18432
v_mfma_f32_16x16x32_bf16 v[56:59], a[132:135], a[28:31], v[56:59]
s_mov_b32 s82, 3221225472
v_mfma_f32_16x16x32_bf16 v[64:67], a[128:131], a[32:35], 0
s_mul_hi_u32 s38, s2, 613566757
v_mfma_f32_16x16x32_bf16 v[64:67], a[132:135], a[36:39], v[64:67]
s_mul_i32 s39, s38, 7
buffer_load_dwordx4 v18, s[12:15], s27 offen offset:2048 lds
v_mfma_f32_16x16x32_bf16 v[72:75], a[128:131], a[40:43], 0
s_sub_u32 s39, s2, s39
v_mov_b32 v246, 0
v_mov_b32 v229, 0
v_mfma_f32_16x16x32_bf16 v[72:75], a[132:135], a[44:47], v[72:75]
v_mov_b32 v231, 0
v_mfma_f32_16x16x32_bf16 v[80:83], a[128:131], a[48:51], 0
s_mov_b32 s60, s90
v_mfma_f32_16x16x32_bf16 v[80:83], a[132:135], a[52:55], v[80:83]
s_mov_b32 s61, s91
buffer_load_dwordx4 v19, s[12:15], s27 offen offset:3072 lds
v_mfma_f32_16x16x32_bf16 v[88:91], a[128:131], a[56:59], 0
s_add_u32 s27, s27, 524288
v_mfma_f32_16x16x32_bf16 v[88:91], a[132:135], a[60:63], v[88:91]
s_waitcnt lgkmcnt(0)
s_mov_b32 s62, 256
v_mfma_f32_16x16x32_bf16 v[36:39], a[136:139], a[0:3], 0
s_add_u32 m0, s28, 0
ds_read_b64_tr_b16 a[128:129], v6 offset:0
v_mfma_f32_16x16x32_bf16 v[36:39], a[140:143], a[4:7], v[36:39]
s_mov_b32 s63, 0x20000
buffer_load_dwordx4 v12, s[8:11], s24 offen offset:0 lds
v_mfma_f32_16x16x32_bf16 v[44:47], a[136:139], a[8:11], 0
s_mul_hi_u32 s55, s2, 1431655766
ds_read_b64_tr_b16 a[130:131], v6 offset:2048
v_mfma_f32_16x16x32_bf16 v[44:47], a[140:143], a[12:15], v[44:47]
s_mul_i32 s55, s55, 3
v_mfma_f32_16x16x32_bf16 v[52:55], a[136:139], a[16:19], 0
s_sub_u32 s55, s2, s55
ds_read_b64_tr_b16 a[132:133], v6 offset:16384
v_mfma_f32_16x16x32_bf16 v[52:55], a[140:143], a[20:23], v[52:55]
s_add_u32 s55, s55, 5
buffer_load_dwordx4 v13, s[8:11], s24 offen offset:1024 lds
v_mfma_f32_16x16x32_bf16 v[60:63], a[136:139], a[24:27], 0
s_lshr_b32 s22, s2, 4
ds_read_b64_tr_b16 a[134:135], v6 offset:18432
v_mfma_f32_16x16x32_bf16 v[60:63], a[140:143], a[28:31], v[60:63]
s_lshl_b32 s23, s20, 5
v_mfma_f32_16x16x32_bf16 v[68:71], a[136:139], a[32:35], 0
s_add_u32 s23, s23, s22
v_mfma_f32_16x16x32_bf16 v[68:71], a[140:143], a[36:39], v[68:71]
s_lshl_b32 s23, s23, 2
buffer_load_dwordx4 v14, s[8:11], s24 offen offset:2048 lds
v_mfma_f32_16x16x32_bf16 v[76:79], a[136:139], a[40:43], 0
s_and_b32 s22, s2, 16
v_mfma_f32_16x16x32_bf16 v[76:79], a[140:143], a[44:47], v[76:79]
s_lshl_b32 s22, s22, 7
v_mfma_f32_16x16x32_bf16 v[84:87], a[136:139], a[48:51], 0
s_add_u32 s23, s23, s22
v_mov_b32 v28, 3221225472
v_writelane_b32 v28, s23, 0
v_mfma_f32_16x16x32_bf16 v[84:87], a[140:143], a[52:55], v[84:87]
s_add_u32 s56, s23, 16384
buffer_load_dwordx4 v15, s[8:11], s24 offen offset:3072 lds
v_mfma_f32_16x16x32_bf16 v[92:95], a[136:139], a[56:59], 0
s_add_u32 s24, s24, 128
v_writelane_b32 v28, s56, 1
v_mfma_f32_16x16x32_bf16 v[92:95], a[140:143], a[60:63], v[92:95]
s_waitcnt lgkmcnt(0)
s_add_u32 s56, s23, 4096
v_writelane_b32 v28, s56, 2
v_mfma_f32_16x16x32_bf16 v[96:99], a[128:131], a[0:3], 0
s_add_u32 m0, s28, 4096
ds_read_b64_tr_b16 a[136:137], v7 offset:0
v_mfma_f32_16x16x32_bf16 v[96:99], a[132:135], a[4:7], v[96:99]
s_sub_u32 s37, 15, s21
buffer_load_dwordx4 v12, s[8:11], s25 offen offset:0 lds
v_mfma_f32_16x16x32_bf16 v[104:107], a[128:131], a[8:11], 0
ds_read_b64_tr_b16 a[138:139], v7 offset:2048
v_mfma_f32_16x16x32_bf16 v[104:107], a[132:135], a[12:15], v[104:107]
v_mfma_f32_16x16x32_bf16 v[112:115], a[128:131], a[16:19], 0
ds_read_b64_tr_b16 a[140:141], v7 offset:16384
v_mfma_f32_16x16x32_bf16 v[112:115], a[132:135], a[20:23], v[112:115]
buffer_load_dwordx4 v13, s[8:11], s25 offen offset:1024 lds
v_mfma_f32_16x16x32_bf16 v[120:123], a[128:131], a[24:27], 0
ds_read_b64_tr_b16 a[142:143], v7 offset:18432
v_mfma_f32_16x16x32_bf16 v[120:123], a[132:135], a[28:31], v[120:123]
v_mfma_f32_16x16x32_bf16 v[128:131], a[128:131], a[32:35], 0
v_mfma_f32_16x16x32_bf16 v[128:131], a[132:135], a[36:39], v[128:131]
buffer_load_dwordx4 v14, s[8:11], s25 offen offset:2048 lds
v_mfma_f32_16x16x32_bf16 v[136:139], a[128:131], a[40:43], 0
v_mfma_f32_16x16x32_bf16 v[136:139], a[132:135], a[44:47], v[136:139]
v_mfma_f32_16x16x32_bf16 v[144:147], a[128:131], a[48:51], 0
v_mfma_f32_16x16x32_bf16 v[144:147], a[132:135], a[52:55], v[144:147]
buffer_load_dwordx4 v15, s[8:11], s25 offen offset:3072 lds
v_mfma_f32_16x16x32_bf16 v[152:155], a[128:131], a[56:59], 0
s_add_u32 s25, s25, 128
v_mfma_f32_16x16x32_bf16 v[152:155], a[132:135], a[60:63], v[152:155]
s_waitcnt vmcnt(17) lgkmcnt(0)
s_barrier
v_mfma_f32_16x16x32_bf16 v[100:103], a[136:139], a[0:3], 0
ds_read_b64_tr_b16 a[128:129], v8 offset:0
v_mfma_f32_16x16x32_bf16 v[100:103], a[140:143], a[4:7], v[100:103]
buffer_load_dword v21, v20, s[16:19], s43 offen
v_mfma_f32_16x16x32_bf16 v[108:111], a[136:139], a[8:11], 0
s_add_u32 s43, s43, s47
ds_read_b64_tr_b16 a[130:131], v8 offset:2048
v_mfma_f32_16x16x32_bf16 v[108:111], a[140:143], a[12:15], v[108:111]
s_cmp_ge_u32 s43, s51
v_mfma_f32_16x16x32_bf16 v[116:119], a[136:139], a[16:19], 0
s_cselect_b32 s43, 0, s43
ds_read_b64_tr_b16 a[132:133], v8 offset:16384
v_mfma_f32_16x16x32_bf16 v[116:119], a[140:143], a[20:23], v[116:119]
s_cselect_b32 s51, s42, s51
v_mfma_f32_16x16x32_bf16 v[124:127], a[136:139], a[24:27], 0
s_cselect_b64 s[16:17], s[40:41], s[16:17]
ds_read_b64_tr_b16 a[134:135], v8 offset:18432
v_mfma_f32_16x16x32_bf16 v[124:127], a[140:143], a[28:31], v[124:127]
s_cselect_b32 s18, s42, s18
v_mfma_f32_16x16x32_bf16 v[132:135], a[136:139], a[32:35], 0
s_cselect_b64 s[40:41], s[44:45], s[40:41]
ds_read_b128 a[64:67], v2 offset:32768
v_mfma_f32_16x16x32_bf16 v[132:135], a[140:143], a[36:39], v[132:135]
s_cselect_b32 s42, s46, s42
v_mfma_f32_16x16x32_bf16 v[140:143], a[136:139], a[40:43], 0
s_cselect_b32 s46, 0, s46
ds_read_b128 a[68:71], v3 offset:32768
v_mfma_f32_16x16x32_bf16 v[140:143], a[140:143], a[44:47], v[140:143]
ds_read_b128 a[72:75], v2 offset:34816
v_mfma_f32_16x16x32_bf16 v[148:151], a[136:139], a[48:51], 0
ds_read_b128 a[76:79], v3 offset:34816
v_mfma_f32_16x16x32_bf16 v[148:151], a[140:143], a[52:55], v[148:151]
buffer_load_dword v21, v20, s[16:19], s43 offen
v_mfma_f32_16x16x32_bf16 v[156:159], a[136:139], a[56:59], 0
s_add_u32 s43, s43, s47
ds_read_b128 a[80:83], v2 offset:36864
v_mfma_f32_16x16x32_bf16 v[156:159], a[140:143], a[60:63], v[156:159]
s_waitcnt lgkmcnt(5)
s_cmp_ge_u32 s43, s51
ds_read_b128 a[84:87], v3 offset:36864
v_mfma_f32_16x16x32_bf16 v[160:163], a[128:131], a[0:3], 0
s_cselect_b32 s43, 0, s43
ds_read_b64_tr_b16 a[136:137], v9 offset:0
v_mfma_f32_16x16x32_bf16 v[160:163], a[132:135], a[4:7], v[160:163]
s_cselect_b32 s51, s42, s51
v_mfma_f32_16x16x32_bf16 v[168:171], a[128:131], a[8:11], 0
s_cselect_b64 s[16:17], s[40:41], s[16:17]
ds_read_b64_tr_b16 a[138:139], v9 offset:2048
v_mfma_f32_16x16x32_bf16 v[168:171], a[132:135], a[12:15], v[168:171]
s_cselect_b32 s18, s42, s18
v_mfma_f32_16x16x32_bf16 v[176:179], a[128:131], a[16:19], 0
s_cselect_b64 s[40:41], s[44:45], s[40:41]
ds_read_b64_tr_b16 a[140:141], v9 offset:16384
v_mfma_f32_16x16x32_bf16 v[176:179], a[132:135], a[20:23], v[176:179]
s_cselect_b32 s42, s46, s42
v_mfma_f32_16x16x32_bf16 v[184:187], a[128:131], a[24:27], 0
s_cselect_b32 s46, 0, s46
ds_read_b64_tr_b16 a[142:143], v9 offset:18432
v_mfma_f32_16x16x32_bf16 v[184:187], a[132:135], a[28:31], v[184:187]
s_bitcmp1_b32 s2, 4
s_cselect_b32 s37, s21, s37
s_lshl_b32 s56, s37, 5
v_mfma_f32_16x16x32_bf16 v[192:195], a[128:131], a[32:35], 0
s_add_u32 s56, s56, s20
s_lshl_b32 s56, s56, 2
s_add_u32 s56, s56, 8192
v_mfma_f32_16x16x32_bf16 v[192:195], a[132:135], a[36:39], v[192:195]
v_writelane_b32 v28, s56, 3
v_mfma_f32_16x16x32_bf16 v[200:203], a[128:131], a[40:43], 0
s_add_u32 s56, s56, 2048
ds_read_b128 a[88:91], v2 offset:38912
v_writelane_b32 v28, s56, 6
v_mfma_f32_16x16x32_bf16 v[200:203], a[132:135], a[44:47], v[200:203]
s_lshl_b32 s56, s2, 2
s_add_u32 s56, s56, 12288
ds_read_b128 a[92:95], v3 offset:38912
v_mfma_f32_16x16x32_bf16 v[208:211], a[128:131], a[48:51], 0
s_waitcnt lgkmcnt(2)
ds_read_b128 a[96:99], v2 offset:40960
v_writelane_b32 v28, s56, 4
v_mfma_f32_16x16x32_bf16 v[208:211], a[132:135], a[52:55], v[208:211]
s_lshl_b32 s56, s39, 5
s_add_u32 s56, s56, s38
s_lshl_b32 s56, s56, 2
v_mfma_f32_16x16x32_bf16 v[216:219], a[128:131], a[56:59], 0
s_add_u32 s56, s56, 20480
s_cmp_lt_u32 s2, 224
ds_read_b128 a[100:103], v3 offset:40960
v_mfma_f32_16x16x32_bf16 v[216:219], a[132:135], a[60:63], v[216:219]
s_cselect_b32 s56, s56, 3221225472
ds_read_b128 a[104:107], v2 offset:43008
v_writelane_b32 v28, s56, 7
v_mfma_f32_16x16x32_bf16 v[164:167], a[136:139], a[0:3], 0
s_cmp_eq_u32 s3, 0
s_cselect_b32 s56, 94371840, 3221225472
ds_read_b64_tr_b16 a[128:129], v10 offset:0
v_mfma_f32_16x16x32_bf16 v[164:167], a[140:143], a[4:7], v[164:167]
buffer_store_dword v246, v28, s[4:7], s56 offen sc1
v_mfma_f32_16x16x32_bf16 v[172:175], a[136:139], a[8:11], 0
ds_read_b64_tr_b16 a[130:131], v10 offset:2048
v_mov_b32 v27, 1
v_mfma_f32_16x16x32_bf16 v[172:175], a[140:143], a[12:15], v[172:175]
v_cmp_eq_u32 vcc, 0, v0
v_mov_b32 v26, 3221225472
v_mfma_f32_16x16x32_bf16 v[180:183], a[136:139], a[16:19], 0
s_lshl_b32 s31, s20, 20
s_lshl_b32 s22, s21, 17
ds_read_b64_tr_b16 a[132:133], v10 offset:16384
v_mfma_f32_16x16x32_bf16 v[180:183], a[140:143], a[20:23], v[180:183]
v_cndmask_b32 v26, v26, v246, vcc
v_mfma_f32_16x16x32_bf16 v[188:191], a[136:139], a[24:27], 0
s_add_u32 s31, s31, s22
s_lshr_b32 s22, s3, 1
ds_read_b64_tr_b16 a[134:135], v10 offset:18432
v_mfma_f32_16x16x32_bf16 v[188:191], a[140:143], a[28:31], v[188:191]
s_lshl_b32 s22, s22, 16
s_add_u32 s31, s31, s22
s_and_b32 s22, s3, 1
v_mfma_f32_16x16x32_bf16 v[196:199], a[136:139], a[32:35], 0
s_lshl_b32 s22, s22, 12
s_add_u32 s31, s31, s22
v_mfma_f32_16x16x32_bf16 v[196:199], a[140:143], a[36:39], v[196:199]
v_mfma_f32_16x16x32_bf16 v[204:207], a[136:139], a[40:43], 0
ds_read_b128 a[108:111], v3 offset:43008
v_mfma_f32_16x16x32_bf16 v[204:207], a[140:143], a[44:47], v[204:207]
ds_read_b128 a[112:115], v2 offset:45056
v_mfma_f32_16x16x32_bf16 v[212:215], a[136:139], a[48:51], 0
ds_read_b128 a[116:119], v3 offset:45056
v_mfma_f32_16x16x32_bf16 v[212:215], a[140:143], a[52:55], v[212:215]
v_mfma_f32_16x16x32_bf16 v[220:223], a[136:139], a[56:59], 0
ds_read_b128 a[120:123], v2 offset:47104
v_mfma_f32_16x16x32_bf16 v[220:223], a[140:143], a[60:63], v[220:223]
s_waitcnt lgkmcnt(4)
ds_read_b128 a[124:127], v3 offset:47104
v_mfma_f32_16x16x32_bf16 a[192:195], a[128:131], a[0:3], 0
ds_read_b64_tr_b16 a[136:137], v11 offset:0
v_mfma_f32_16x16x32_bf16 a[192:195], a[132:135], a[4:7], a[192:195]
v_mfma_f32_16x16x32_bf16 a[200:203], a[128:131], a[8:11], 0
ds_read_b64_tr_b16 a[138:139], v11 offset:2048
v_mfma_f32_16x16x32_bf16 a[200:203], a[132:135], a[12:15], a[200:203]
v_mfma_f32_16x16x32_bf16 a[208:211], a[128:131], a[16:19], 0
ds_read_b64_tr_b16 a[140:141], v11 offset:16384
v_mfma_f32_16x16x32_bf16 a[208:211], a[132:135], a[20:23], a[208:211]
v_mfma_f32_16x16x32_bf16 a[216:219], a[128:131], a[24:27], 0
ds_read_b64_tr_b16 a[142:143], v11 offset:18432
v_mfma_f32_16x16x32_bf16 a[216:219], a[132:135], a[28:31], a[216:219]
v_mfma_f32_16x16x32_bf16 a[224:227], a[128:131], a[32:35], 0
v_mfma_f32_16x16x32_bf16 a[224:227], a[132:135], a[36:39], a[224:227]
v_mfma_f32_16x16x32_bf16 a[232:235], a[128:131], a[40:43], 0
v_mfma_f32_16x16x32_bf16 a[232:235], a[132:135], a[44:47], a[232:235]
v_mfma_f32_16x16x32_bf16 a[240:243], a[128:131], a[48:51], 0
v_mfma_f32_16x16x32_bf16 a[240:243], a[132:135], a[52:55], a[240:243]
v_mfma_f32_16x16x32_bf16 a[248:251], a[128:131], a[56:59], 0
s_waitcnt vmcnt(3) lgkmcnt(0)
v_mfma_f32_16x16x32_bf16 a[248:251], a[132:135], a[60:63], a[248:251]
s_barrier
v_mfma_f32_16x16x32_bf16 a[196:199], a[136:139], a[0:3], 0
s_add_u32 m0, s29, 65536
ds_read_b64_tr_b16 a[128:129], v4 offset:32768
v_mfma_f32_16x16x32_bf16 a[196:199], a[140:143], a[4:7], a[196:199]
buffer_load_dwordx4 v16, s[12:15], s26 offen offset:0 lds
v_mfma_f32_16x16x32_bf16 a[204:207], a[136:139], a[8:11], 0
ds_read_b64_tr_b16 a[130:131], v4 offset:34816
v_mfma_f32_16x16x32_bf16 a[204:207], a[140:143], a[12:15], a[204:207]
v_mfma_f32_16x16x32_bf16 a[212:215], a[136:139], a[16:19], 0
ds_read_b64_tr_b16 a[132:133], v4 offset:49152
v_mfma_f32_16x16x32_bf16 a[212:215], a[140:143], a[20:23], a[212:215]
buffer_load_dwordx4 v17, s[12:15], s26 offen offset:1024 lds
v_mfma_f32_16x16x32_bf16 a[220:223], a[136:139], a[24:27], 0
ds_read_b64_tr_b16 a[134:135], v4 offset:51200
v_mfma_f32_16x16x32_bf16 a[220:223], a[140:143], a[28:31], a[220:223]
v_mfma_f32_16x16x32_bf16 a[228:231], a[136:139], a[32:35], 0
v_mfma_f32_16x16x32_bf16 a[228:231], a[140:143], a[36:39], a[228:231]
buffer_load_dwordx4 v18, s[12:15], s26 offen offset:2048 lds
v_mfma_f32_16x16x32_bf16 a[236:239], a[136:139], a[40:43], 0
v_mfma_f32_16x16x32_bf16 a[236:239], a[140:143], a[44:47], a[236:239]
v_mfma_f32_16x16x32_bf16 a[244:247], a[136:139], a[48:51], 0
v_mfma_f32_16x16x32_bf16 a[244:247], a[140:143], a[52:55], a[244:247]
buffer_load_dwordx4 v19, s[12:15], s26 offen offset:3072 lds
v_mfma_f32_16x16x32_bf16 a[252:255], a[136:139], a[56:59], 0
s_add_u32 s26, s26, 524288
v_mfma_f32_16x16x32_bf16 a[252:255], a[140:143], a[60:63], a[252:255]
s_waitcnt lgkmcnt(0)
Lg_1:
v_mfma_f32_16x16x32_bf16 v[32:35], a[128:131], a[64:67], v[32:35]
s_add_u32 m0, s29, 81920
ds_read_b64_tr_b16 a[136:137], v5 offset:32768
v_mfma_f32_16x16x32_bf16 v[32:35], a[132:135], a[68:71], v[32:35]
buffer_load_dwordx4 v16, s[12:15], s27 offen offset:0 lds
v_mfma_f32_16x16x32_bf16 v[40:43], a[128:131], a[72:75], v[40:43]
ds_read_b64_tr_b16 a[138:139], v5 offset:34816
v_mfma_f32_16x16x32_bf16 v[40:43], a[132:135], a[76:79], v[40:43]
v_mfma_f32_16x16x32_bf16 v[48:51], a[128:131], a[80:83], v[48:51]
ds_read_b64_tr_b16 a[140:141], v5 offset:49152
v_mfma_f32_16x16x32_bf16 v[48:51], a[132:135], a[84:87], v[48:51]
buffer_load_dwordx4 v17, s[12:15], s27 offen offset:1024 lds
v_mfma_f32_16x16x32_bf16 v[56:59], a[128:131], a[88:91], v[56:59]
ds_read_b64_tr_b16 a[142:143], v5 offset:51200
v_mfma_f32_16x16x32_bf16 v[56:59], a[132:135], a[92:95], v[56:59]
v_mfma_f32_16x16x32_bf16 v[64:67], a[128:131], a[96:99], v[64:67]
ds_read_b128 a[0:3], v2 offset:0
v_mfma_f32_16x16x32_bf16 v[64:67], a[132:135], a[100:103], v[64:67]
buffer_load_dwordx4 v18, s[12:15], s27 offen offset:2048 lds
v_mfma_f32_16x16x32_bf16 v[72:75], a[128:131], a[104:107], v[72:75]
ds_read_b128 a[4:7], v3 offset:0
v_mfma_f32_16x16x32_bf16 v[72:75], a[132:135], a[108:111], v[72:75]
v_mfma_f32_16x16x32_bf16 v[80:83], a[128:131], a[112:115], v[80:83]
v_mfma_f32_16x16x32_bf16 v[80:83], a[132:135], a[116:119], v[80:83]
buffer_load_dwordx4 v19, s[12:15], s27 offen offset:3072 lds
v_mfma_f32_16x16x32_bf16 v[88:91], a[128:131], a[120:123], v[88:91]
s_add_u32 s27, s27, 524288
ds_read_b128 a[8:11], v2 offset:2048
v_mfma_f32_16x16x32_bf16 v[88:91], a[132:135], a[124:127], v[88:91]
s_waitcnt lgkmcnt(3)
v_mfma_f32_16x16x32_bf16 v[36:39], a[136:139], a[64:67], v[36:39]
s_add_u32 m0, s28, 32768
ds_read_b64_tr_b16 a[128:129], v6 offset:32768
v_mfma_f32_16x16x32_bf16 v[36:39], a[140:143], a[68:71], v[36:39]
buffer_load_dwordx4 v12, s[8:11], s24 offen offset:0 lds
v_mfma_f32_16x16x32_bf16 v[44:47], a[136:139], a[72:75], v[44:47]
ds_read_b64_tr_b16 a[130:131], v6 offset:34816
v_mfma_f32_16x16x32_bf16 v[44:47], a[140:143], a[76:79], v[44:47]
v_mfma_f32_16x16x32_bf16 v[52:55], a[136:139], a[80:83], v[52:55]
ds_read_b64_tr_b16 a[132:133], v6 offset:49152
v_mfma_f32_16x16x32_bf16 v[52:55], a[140:143], a[84:87], v[52:55]
buffer_load_dwordx4 v13, s[8:11], s24 offen offset:1024 lds
v_mfma_f32_16x16x32_bf16 v[60:63], a[136:139], a[88:91], v[60:63]
ds_read_b64_tr_b16 a[134:135], v6 offset:51200
v_mfma_f32_16x16x32_bf16 v[60:63], a[140:143], a[92:95], v[60:63]
v_mfma_f32_16x16x32_bf16 v[68:71], a[136:139], a[96:99], v[68:71]
ds_read_b128 a[12:15], v3 offset:2048
v_mfma_f32_16x16x32_bf16 v[68:71], a[140:143], a[100:103], v[68:71]
buffer_load_dwordx4 v14, s[8:11], s24 offen offset:2048 lds
v_mfma_f32_16x16x32_bf16 v[76:79], a[136:139], a[104:107], v[76:79]
v_mfma_f32_16x16x32_bf16 v[76:79], a[140:143], a[108:111], v[76:79]
v_mfma_f32_16x16x32_bf16 v[84:87], a[136:139], a[112:115], v[84:87]
ds_read_b128 a[16:19], v2 offset:4096
v_mfma_f32_16x16x32_bf16 v[84:87], a[140:143], a[116:119], v[84:87]
buffer_load_dwordx4 v15, s[8:11], s24 offen offset:3072 lds
v_mfma_f32_16x16x32_bf16 v[92:95], a[136:139], a[120:123], v[92:95]
s_add_u32 s24, s24, 128
ds_read_b128 a[20:23], v3 offset:4096
v_mfma_f32_16x16x32_bf16 v[92:95], a[140:143], a[124:127], v[92:95]
s_waitcnt lgkmcnt(3)
v_mfma_f32_16x16x32_bf16 v[96:99], a[128:131], a[64:67], v[96:99]
s_add_u32 m0, s28, 36864
ds_read_b64_tr_b16 a[136:137], v7 offset:32768
v_mfma_f32_16x16x32_bf16 v[96:99], a[132:135], a[68:71], v[96:99]
buffer_load_dwordx4 v12, s[8:11], s25 offen offset:0 lds
v_mfma_f32_16x16x32_bf16 v[104:107], a[128:131], a[72:75], v[104:107]
ds_read_b64_tr_b16 a[138:139], v7 offset:34816
v_mfma_f32_16x16x32_bf16 v[104:107], a[132:135], a[76:79], v[104:107]
v_mfma_f32_16x16x32_bf16 v[112:115], a[128:131], a[80:83], v[112:115]
ds_read_b64_tr_b16 a[140:141], v7 offset:49152
v_mfma_f32_16x16x32_bf16 v[112:115], a[132:135], a[84:87], v[112:115]
buffer_load_dwordx4 v13, s[8:11], s25 offen offset:1024 lds
v_mfma_f32_16x16x32_bf16 v[120:123], a[128:131], a[88:91], v[120:123]
ds_read_b64_tr_b16 a[142:143], v7 offset:51200
v_mfma_f32_16x16x32_bf16 v[120:123], a[132:135], a[92:95], v[120:123]
v_mfma_f32_16x16x32_bf16 v[128:131], a[128:131], a[96:99], v[128:131]
v_mfma_f32_16x16x32_bf16 v[128:131], a[132:135], a[100:103], v[128:131]
buffer_load_dwordx4 v14, s[8:11], s25 offen offset:2048 lds
v_mfma_f32_16x16x32_bf16 v[136:139], a[128:131], a[104:107], v[136:139]
ds_read_b128 a[24:27], v2 offset:6144
v_mfma_f32_16x16x32_bf16 v[136:139], a[132:135], a[108:111], v[136:139]
v_mfma_f32_16x16x32_bf16 v[144:147], a[128:131], a[112:115], v[144:147]
ds_read_b128 a[28:31], v3 offset:6144
v_mfma_f32_16x16x32_bf16 v[144:147], a[132:135], a[116:119], v[144:147]
buffer_load_dwordx4 v15, s[8:11], s25 offen offset:3072 lds
v_mfma_f32_16x16x32_bf16 v[152:155], a[128:131], a[120:123], v[152:155]
s_add_u32 s25, s25, 128
v_mfma_f32_16x16x32_bf16 v[152:155], a[132:135], a[124:127], v[152:155]
s_waitcnt lgkmcnt(2)
v_mfma_f32_16x16x32_bf16 v[100:103], a[136:139], a[64:67], v[100:103]
ds_read_b64_tr_b16 a[128:129], v8 offset:32768
v_mfma_f32_16x16x32_bf16 v[100:103], a[140:143], a[68:71], v[100:103]
buffer_load_dword v21, v20, s[16:19], s43 offen
v_mfma_f32_16x16x32_bf16 v[108:111], a[136:139], a[72:75], v[108:111]
s_add_u32 s43, s43, s47
ds_read_b64_tr_b16 a[130:131], v8 offset:34816
v_mfma_f32_16x16x32_bf16 v[108:111], a[140:143], a[76:79], v[108:111]
s_cmp_ge_u32 s43, s51
v_mfma_f32_16x16x32_bf16 v[116:119], a[136:139], a[80:83], v[116:119]
s_cselect_b32 s43, 0, s43
ds_read_b64_tr_b16 a[132:133], v8 offset:49152
v_mfma_f32_16x16x32_bf16 v[116:119], a[140:143], a[84:87], v[116:119]
s_cselect_b32 s51, s42, s51
v_mfma_f32_16x16x32_bf16 v[124:127], a[136:139], a[88:91], v[124:127]
s_cselect_b64 s[16:17], s[40:41], s[16:17]
ds_read_b64_tr_b16 a[134:135], v8 offset:51200
v_mfma_f32_16x16x32_bf16 v[124:127], a[140:143], a[92:95], v[124:127]
s_cselect_b32 s18, s42, s18
v_mfma_f32_16x16x32_bf16 v[132:135], a[136:139], a[96:99], v[132:135]
s_cselect_b64 s[40:41], s[44:45], s[40:41]
ds_read_b128 a[32:35], v2 offset:8192
v_mfma_f32_16x16x32_bf16 v[132:135], a[140:143], a[100:103], v[132:135]
s_cselect_b32 s42, s46, s42
v_mfma_f32_16x16x32_bf16 v[140:143], a[136:139], a[104:107], v[140:143]
s_cselect_b32 s46, 0, s46
v_mfma_f32_16x16x32_bf16 v[140:143], a[140:143], a[108:111], v[140:143]
s_cmp_eq_u32 s30, s55
v_mfma_f32_16x16x32_bf16 v[148:151], a[136:139], a[112:115], v[148:151]
s_cselect_b32 s22, 0, 3221225472
ds_read_b128 a[36:39], v3 offset:8192
v_mfma_f32_16x16x32_bf16 v[148:151], a[140:143], a[116:119], v[148:151]
s_sub_u32 s30, s30, 1
buffer_atomic_add v27, v26, s[60:63], s22 offen sc1
v_mfma_f32_16x16x32_bf16 v[156:159], a[136:139], a[120:123], v[156:159]
ds_read_b128 a[40:43], v2 offset:10240
v_mfma_f32_16x16x32_bf16 v[156:159], a[140:143], a[124:127], v[156:159]
s_waitcnt lgkmcnt(3)
v_mfma_f32_16x16x32_bf16 v[160:163], a[128:131], a[64:67], v[160:163]
ds_read_b64_tr_b16 a[136:137], v9 offset:32768
v_mfma_f32_16x16x32_bf16 v[160:163], a[132:135], a[68:71], v[160:163]
v_mfma_f32_16x16x32_bf16 v[168:171], a[128:131], a[72:75], v[168:171]
ds_read_b64_tr_b16 a[138:139], v9 offset:34816
v_mfma_f32_16x16x32_bf16 v[168:171], a[132:135], a[76:79], v[168:171]
v_mfma_f32_16x16x32_bf16 v[176:179], a[128:131], a[80:83], v[176:179]
ds_read_b64_tr_b16 a[140:141], v9 offset:49152
v_mfma_f32_16x16x32_bf16 v[176:179], a[132:135], a[84:87], v[176:179]
v_mfma_f32_16x16x32_bf16 v[184:187], a[128:131], a[88:91], v[184:187]
ds_read_b64_tr_b16 a[142:143], v9 offset:51200
v_mfma_f32_16x16x32_bf16 v[184:187], a[132:135], a[92:95], v[184:187]
v_mfma_f32_16x16x32_bf16 v[192:195], a[128:131], a[96:99], v[192:195]
v_mfma_f32_16x16x32_bf16 v[192:195], a[132:135], a[100:103], v[192:195]
v_mfma_f32_16x16x32_bf16 v[200:203], a[128:131], a[104:107], v[200:203]
ds_read_b128 a[44:47], v3 offset:10240
v_mfma_f32_16x16x32_bf16 v[200:203], a[132:135], a[108:111], v[200:203]
v_mfma_f32_16x16x32_bf16 v[208:211], a[128:131], a[112:115], v[208:211]
ds_read_b128 a[48:51], v2 offset:12288
v_mfma_f32_16x16x32_bf16 v[208:211], a[132:135], a[116:119], v[208:211]
v_mfma_f32_16x16x32_bf16 v[216:219], a[128:131], a[120:123], v[216:219]
v_mfma_f32_16x16x32_bf16 v[216:219], a[132:135], a[124:127], v[216:219]
s_waitcnt lgkmcnt(2)
v_mfma_f32_16x16x32_bf16 v[164:167], a[136:139], a[64:67], v[164:167]
ds_read_b64_tr_b16 a[128:129], v10 offset:32768
v_mfma_f32_16x16x32_bf16 v[164:167], a[140:143], a[68:71], v[164:167]
v_mfma_f32_16x16x32_bf16 v[172:175], a[136:139], a[72:75], v[172:175]
ds_read_b64_tr_b16 a[130:131], v10 offset:34816
v_mfma_f32_16x16x32_bf16 v[172:175], a[140:143], a[76:79], v[172:175]
v_mfma_f32_16x16x32_bf16 v[180:183], a[136:139], a[80:83], v[180:183]
ds_read_b64_tr_b16 a[132:133], v10 offset:49152
v_mfma_f32_16x16x32_bf16 v[180:183], a[140:143], a[84:87], v[180:183]
v_mfma_f32_16x16x32_bf16 v[188:191], a[136:139], a[88:91], v[188:191]
ds_read_b64_tr_b16 a[134:135], v10 offset:51200
v_mfma_f32_16x16x32_bf16 v[188:191], a[140:143], a[92:95], v[188:191]
v_mfma_f32_16x16x32_bf16 v[196:199], a[136:139], a[96:99], v[196:199]
ds_read_b128 a[52:55], v3 offset:12288
v_mfma_f32_16x16x32_bf16 v[196:199], a[140:143], a[100:103], v[196:199]
v_mfma_f32_16x16x32_bf16 v[204:207], a[136:139], a[104:107], v[204:207]
ds_read_b128 a[56:59], v2 offset:14336
v_mfma_f32_16x16x32_bf16 v[204:207], a[140:143], a[108:111], v[204:207]
v_mfma_f32_16x16x32_bf16 v[212:215], a[136:139], a[112:115], v[212:215]
v_mfma_f32_16x16x32_bf16 v[212:215], a[140:143], a[116:119], v[212:215]
v_mfma_f32_16x16x32_bf16 v[220:223], a[136:139], a[120:123], v[220:223]
ds_read_b128 a[60:63], v3 offset:14336
v_mfma_f32_16x16x32_bf16 v[220:223], a[140:143], a[124:127], v[220:223]
s_waitcnt lgkmcnt(3)
v_mfma_f32_16x16x32_bf16 a[192:195], a[128:131], a[64:67], a[192:195]
ds_read_b64_tr_b16 a[136:137], v11 offset:32768
v_mfma_f32_16x16x32_bf16 a[192:195], a[132:135], a[68:71], a[192:195]
v_mfma_f32_16x16x32_bf16 a[200:203], a[128:131], a[72:75], a[200:203]
ds_read_b64_tr_b16 a[138:139], v11 offset:34816
v_mfma_f32_16x16x32_bf16 a[200:203], a[132:135], a[76:79], a[200:203]
v_mfma_f32_16x16x32_bf16 a[208:211], a[128:131], a[80:83], a[208:211]
ds_read_b64_tr_b16 a[140:141], v11 offset:49152
v_mfma_f32_16x16x32_bf16 a[208:211], a[132:135], a[84:87], a[208:211]
v_mfma_f32_16x16x32_bf16 a[216:219], a[128:131], a[88:91], a[216:219]
ds_read_b64_tr_b16 a[142:143], v11 offset:51200
v_mfma_f32_16x16x32_bf16 a[216:219], a[132:135], a[92:95], a[216:219]
v_mfma_f32_16x16x32_bf16 a[224:227], a[128:131], a[96:99], a[224:227]
v_mfma_f32_16x16x32_bf16 a[224:227], a[132:135], a[100:103], a[224:227]
v_mfma_f32_16x16x32_bf16 a[232:235], a[128:131], a[104:107], a[232:235]
v_mfma_f32_16x16x32_bf16 a[232:235], a[132:135], a[108:111], a[232:235]
v_mfma_f32_16x16x32_bf16 a[240:243], a[128:131], a[112:115], a[240:243]
v_mfma_f32_16x16x32_bf16 a[240:243], a[132:135], a[116:119], a[240:243]
v_mfma_f32_16x16x32_bf16 a[248:251], a[128:131], a[120:123], a[248:251]
s_waitcnt vmcnt(2) lgkmcnt(0)
v_mfma_f32_16x16x32_bf16 a[248:251], a[132:135], a[124:127], a[248:251]
s_barrier
v_mfma_f32_16x16x32_bf16 a[196:199], a[136:139], a[64:67], a[196:199]
s_add_u32 m0, s29, 98304
ds_read_b64_tr_b16 a[128:129], v4 offset:0
v_mfma_f32_16x16x32_bf16 a[196:199], a[140:143], a[68:71], a[196:199]
buffer_load_dwordx4 v16, s[12:15], s26 offen offset:0 lds
v_mfma_f32_16x16x32_bf16 a[204:207], a[136:139], a[72:75], a[204:207]
ds_read_b64_tr_b16 a[130:131], v4 offset:2048
v_mfma_f32_16x16x32_bf16 a[204:207], a[140:143], a[76:79], a[204:207]
v_mfma_f32_16x16x32_bf16 a[212:215], a[136:139], a[80:83], a[212:215]
ds_read_b64_tr_b16 a[132:133], v4 offset:16384
v_mfma_f32_16x16x32_bf16 a[212:215], a[140:143], a[84:87], a[212:215]
buffer_load_dwordx4 v17, s[12:15], s26 offen offset:1024 lds
v_mfma_f32_16x16x32_bf16 a[220:223], a[136:139], a[88:91], a[220:223]
ds_read_b64_tr_b16 a[134:135], v4 offset:18432
v_mfma_f32_16x16x32_bf16 a[220:223], a[140:143], a[92:95], a[220:223]
v_mfma_f32_16x16x32_bf16 a[228:231], a[136:139], a[96:99], a[228:231]
v_mfma_f32_16x16x32_bf16 a[228:231], a[140:143], a[100:103], a[228:231]
buffer_load_dwordx4 v18, s[12:15], s26 offen offset:2048 lds
v_mfma_f32_16x16x32_bf16 a[236:239], a[136:139], a[104:107], a[236:239]
v_mfma_f32_16x16x32_bf16 a[236:239], a[140:143], a[108:111], a[236:239]
v_mfma_f32_16x16x32_bf16 a[244:247], a[136:139], a[112:115], a[244:247]
v_mfma_f32_16x16x32_bf16 a[244:247], a[140:143], a[116:119], a[244:247]
buffer_load_dwordx4 v19, s[12:15], s26 offen offset:3072 lds
v_mfma_f32_16x16x32_bf16 a[252:255], a[136:139], a[120:123], a[252:255]
s_add_u32 s26, s26, 524288
v_mfma_f32_16x16x32_bf16 a[252:255], a[140:143], a[124:127], a[252:255]
s_waitcnt lgkmcnt(0)
buffer_store_dword v27, v26, s[4:7], s82 offen sc1
v_mfma_f32_16x16x32_bf16 v[32:35], a[128:131], a[0:3], v[32:35]
s_add_u32 m0, s29, 114688
ds_read_b64_tr_b16 a[136:137], v5 offset:0
v_mfma_f32_16x16x32_bf16 v[32:35], a[132:135], a[4:7], v[32:35]
buffer_load_dwordx4 v16, s[12:15], s27 offen offset:0 lds
v_mfma_f32_16x16x32_bf16 v[40:43], a[128:131], a[8:11], v[40:43]
ds_read_b64_tr_b16 a[138:139], v5 offset:2048
v_mfma_f32_16x16x32_bf16 v[40:43], a[132:135], a[12:15], v[40:43]
v_mfma_f32_16x16x32_bf16 v[48:51], a[128:131], a[16:19], v[48:51]
ds_read_b64_tr_b16 a[140:141], v5 offset:16384
v_mfma_f32_16x16x32_bf16 v[48:51], a[132:135], a[20:23], v[48:51]
buffer_load_dwordx4 v17, s[12:15], s27 offen offset:1024 lds
v_mfma_f32_16x16x32_bf16 v[56:59], a[128:131], a[24:27], v[56:59]
ds_read_b64_tr_b16 a[142:143], v5 offset:18432
v_mfma_f32_16x16x32_bf16 v[56:59], a[132:135], a[28:31], v[56:59]
v_mfma_f32_16x16x32_bf16 v[64:67], a[128:131], a[32:35], v[64:67]
ds_read_b128 a[64:67], v2 offset:32768
v_mfma_f32_16x16x32_bf16 v[64:67], a[132:135], a[36:39], v[64:67]
buffer_load_dwordx4 v18, s[12:15], s27 offen offset:2048 lds
v_mfma_f32_16x16x32_bf16 v[72:75], a[128:131], a[40:43], v[72:75]
ds_read_b128 a[68:71], v3 offset:32768
v_mfma_f32_16x16x32_bf16 v[72:75], a[132:135], a[44:47], v[72:75]
v_mfma_f32_16x16x32_bf16 v[80:83], a[128:131], a[48:51], v[80:83]
v_mfma_f32_16x16x32_bf16 v[80:83], a[132:135], a[52:55], v[80:83]
buffer_load_dwordx4 v19, s[12:15], s27 offen offset:3072 lds
v_mfma_f32_16x16x32_bf16 v[88:91], a[128:131], a[56:59], v[88:91]
s_add_u32 s27, s27, 524288
ds_read_b128 a[72:75], v2 offset:34816
v_mfma_f32_16x16x32_bf16 v[88:91], a[132:135], a[60:63], v[88:91]
s_waitcnt lgkmcnt(3)
v_mfma_f32_16x16x32_bf16 v[36:39], a[136:139], a[0:3], v[36:39]
s_add_u32 m0, s28, 0
ds_read_b64_tr_b16 a[128:129], v6 offset:0
v_mfma_f32_16x16x32_bf16 v[36:39], a[140:143], a[4:7], v[36:39]
buffer_load_dwordx4 v12, s[8:11], s24 offen offset:0 lds
v_mfma_f32_16x16x32_bf16 v[44:47], a[136:139], a[8:11], v[44:47]
ds_read_b64_tr_b16 a[130:131], v6 offset:2048
v_mfma_f32_16x16x32_bf16 v[44:47], a[140:143], a[12:15], v[44:47]
PAD_1:
s_cbranch_execz PAD_5
v_mfma_f32_16x16x32_bf16 v[52:55], a[136:139], a[16:19], v[52:55]
ds_read_b64_tr_b16 a[132:133], v6 offset:16384
v_mfma_f32_16x16x32_bf16 v[52:55], a[140:143], a[20:23], v[52:55]
buffer_load_dwordx4 v13, s[8:11], s24 offen offset:1024 lds
v_mfma_f32_16x16x32_bf16 v[60:63], a[136:139], a[24:27], v[60:63]
ds_read_b64_tr_b16 a[134:135], v6 offset:18432
v_mfma_f32_16x16x32_bf16 v[60:63], a[140:143], a[28:31], v[60:63]
v_mfma_f32_16x16x32_bf16 v[68:71], a[136:139], a[32:35], v[68:71]
ds_read_b128 a[76:79], v3 offset:34816
v_mfma_f32_16x16x32_bf16 v[68:71], a[140:143], a[36:39], v[68:71]
buffer_load_dwordx4 v14, s[8:11], s24 offen offset:2048 lds
v_mfma_f32_16x16x32_bf16 v[76:79], a[136:139], a[40:43], v[76:79]
v_mfma_f32_16x16x32_bf16 v[76:79], a[140:143], a[44:47], v[76:79]
v_mfma_f32_16x16x32_bf16 v[84:87], a[136:139], a[48:51], v[84:87]
ds_read_b128 a[80:83], v2 offset:36864
v_mfma_f32_16x16x32_bf16 v[84:87], a[140:143], a[52:55], v[84:87]
buffer_load_dwordx4 v15, s[8:11], s24 offen offset:3072 lds
v_mfma_f32_16x16x32_bf16 v[92:95], a[136:139], a[56:59], v[92:95]
s_add_u32 s24, s24, 128
ds_read_b128 a[84:87], v3 offset:36864
v_mfma_f32_16x16x32_bf16 v[92:95], a[140:143], a[60:63], v[92:95]
s_waitcnt lgkmcnt(3)
v_mfma_f32_16x16x32_bf16 v[96:99], a[128:131], a[0:3], v[96:99]
s_add_u32 m0, s28, 4096
ds_read_b64_tr_b16 a[136:137], v7 offset:0
v_mfma_f32_16x16x32_bf16 v[96:99], a[132:135], a[4:7], v[96:99]
buffer_load_dwordx4 v12, s[8:11], s25 offen offset:0 lds
v_mfma_f32_16x16x32_bf16 v[104:107], a[128:131], a[8:11], v[104:107]
ds_read_b64_tr_b16 a[138:139], v7 offset:2048
v_mfma_f32_16x16x32_bf16 v[104:107], a[132:135], a[12:15], v[104:107]
v_mfma_f32_16x16x32_bf16 v[112:115], a[128:131], a[16:19], v[112:115]
ds_read_b64_tr_b16 a[140:141], v7 offset:16384
v_mfma_f32_16x16x32_bf16 v[112:115], a[132:135], a[20:23], v[112:115]
buffer_load_dwordx4 v13, s[8:11], s25 offen offset:1024 lds
v_mfma_f32_16x16x32_bf16 v[120:123], a[128:131], a[24:27], v[120:123]
ds_read_b64_tr_b16 a[142:143], v7 offset:18432
v_mfma_f32_16x16x32_bf16 v[120:123], a[132:135], a[28:31], v[120:123]
v_mfma_f32_16x16x32_bf16 v[128:131], a[128:131], a[32:35], v[128:131]
v_mfma_f32_16x16x32_bf16 v[128:131], a[132:135], a[36:39], v[128:131]
buffer_load_dwordx4 v14, s[8:11], s25 offen offset:2048 lds
v_mfma_f32_16x16x32_bf16 v[136:139], a[128:131], a[40:43], v[136:139]
ds_read_b128 a[88:91], v2 offset:38912
v_mfma_f32_16x16x32_bf16 v[136:139], a[132:135], a[44:47], v[136:139]
v_mfma_f32_16x16x32_bf16 v[144:147], a[128:131], a[48:51], v[144:147]
ds_read_b128 a[92:95], v3 offset:38912
v_mfma_f32_16x16x32_bf16 v[144:147], a[132:135], a[52:55], v[144:147]
buffer_load_dwordx4 v15, s[8:11], s25 offen offset:3072 lds
v_mfma_f32_16x16x32_bf16 v[152:155], a[128:131], a[56:59], v[152:155]
s_add_u32 s25, s25, 128
v_mfma_f32_16x16x32_bf16 v[152:155], a[132:135], a[60:63], v[152:155]
s_waitcnt lgkmcnt(2)
v_mfma_f32_16x16x32_bf16 v[100:103], a[136:139], a[0:3], v[100:103]
ds_read_b64_tr_b16 a[128:129], v8 offset:0
v_mfma_f32_16x16x32_bf16 v[100:103], a[140:143], a[4:7], v[100:103]
buffer_load_dword v21, v20, s[16:19], s43 offen
v_mfma_f32_16x16x32_bf16 v[108:111], a[136:139], a[8:11], v[108:111]
s_add_u32 s43, s43, s47
ds_read_b64_tr_b16 a[130:131], v8 offset:2048
v_mfma_f32_16x16x32_bf16 v[108:111], a[140:143], a[12:15], v[108:111]
s_cmp_ge_u32 s43, s51
v_mfma_f32_16x16x32_bf16 v[116:119], a[136:139], a[16:19], v[116:119]
s_cselect_b32 s43, 0, s43
ds_read_b64_tr_b16 a[132:133], v8 offset:16384
v_mfma_f32_16x16x32_bf16 v[116:119], a[140:143], a[20:23], v[116:119]
s_cselect_b32 s51, s42, s51
v_mfma_f32_16x16x32_bf16 v[124:127], a[136:139], a[24:27], v[124:127]
s_cselect_b64 s[16:17], s[40:41], s[16:17]
ds_read_b64_tr_b16 a[134:135], v8 offset:18432
v_mfma_f32_16x16x32_bf16 v[124:127], a[140:143], a[28:31], v[124:127]
s_cselect_b32 s18, s42, s18
v_mfma_f32_16x16x32_bf16 v[132:135], a[136:139], a[32:35], v[132:135]
s_cselect_b64 s[40:41], s[44:45], s[40:41]
ds_read_b128 a[96:99], v2 offset:40960
v_mfma_f32_16x16x32_bf16 v[132:135], a[140:143], a[36:39], v[132:135]
s_cselect_b32 s42, s46, s42
v_mfma_f32_16x16x32_bf16 v[140:143], a[136:139], a[40:43], v[140:143]
s_cselect_b32 s46, 0, s46
v_mfma_f32_16x16x32_bf16 v[140:143], a[140:143], a[44:47], v[140:143]
s_cmp_eq_u32 s30, s55
v_mfma_f32_16x16x32_bf16 v[148:151], a[136:139], a[48:51], v[148:151]
s_cselect_b32 s22, 0, 3221225472
ds_read_b128 a[100:103], v3 offset:40960
v_mfma_f32_16x16x32_bf16 v[148:151], a[140:143], a[52:55], v[148:151]
s_sub_u32 s30, s30, 1
buffer_atomic_add v27, v26, s[60:63], s22 offen sc1
v_mfma_f32_16x16x32_bf16 v[156:159], a[136:139], a[56:59], v[156:159]
ds_read_b128 a[104:107], v2 offset:43008
v_mfma_f32_16x16x32_bf16 v[156:159], a[140:143], a[60:63], v[156:159]
s_waitcnt lgkmcnt(3)
v_mfma_f32_16x16x32_bf16 v[160:163], a[128:131], a[0:3], v[160:163]
ds_read_b64_tr_b16 a[136:137], v9 offset:0
v_mfma_f32_16x16x32_bf16 v[160:163], a[132:135], a[4:7], v[160:163]
v_mfma_f32_16x16x32_bf16 v[168:171], a[128:131], a[8:11], v[168:171]
ds_read_b64_tr_b16 a[138:139], v9 offset:2048
v_mfma_f32_16x16x32_bf16 v[168:171], a[132:135], a[12:15], v[168:171]
v_mfma_f32_16x16x32_bf16 v[176:179], a[128:131], a[16:19], v[176:179]
ds_read_b64_tr_b16 a[140:141], v9 offset:16384
v_mfma_f32_16x16x32_bf16 v[176:179], a[132:135], a[20:23], v[176:179]
v_mfma_f32_16x16x32_bf16 v[184:187], a[128:131], a[24:27], v[184:187]
ds_read_b64_tr_b16 a[142:143], v9 offset:18432
v_mfma_f32_16x16x32_bf16 v[184:187], a[132:135], a[28:31], v[184:187]
v_mfma_f32_16x16x32_bf16 v[192:195], a[128:131], a[32:35], v[192:195]
v_mfma_f32_16x16x32_bf16 v[192:195], a[132:135], a[36:39], v[192:195]
v_mfma_f32_16x16x32_bf16 v[200:203], a[128:131], a[40:43], v[200:203]
ds_read_b128 a[108:111], v3 offset:43008
v_mfma_f32_16x16x32_bf16 v[200:203], a[132:135], a[44:47], v[200:203]
v_mfma_f32_16x16x32_bf16 v[208:211], a[128:131], a[48:51], v[208:211]
ds_read_b128 a[112:115], v2 offset:45056
v_mfma_f32_16x16x32_bf16 v[208:211], a[132:135], a[52:55], v[208:211]
v_mfma_f32_16x16x32_bf16 v[216:219], a[128:131], a[56:59], v[216:219]
v_mfma_f32_16x16x32_bf16 v[216:219], a[132:135], a[60:63], v[216:219]
s_waitcnt lgkmcnt(2)
v_mfma_f32_16x16x32_bf16 v[164:167], a[136:139], a[0:3], v[164:167]
ds_read_b64_tr_b16 a[128:129], v10 offset:0
v_mfma_f32_16x16x32_bf16 v[164:167], a[140:143], a[4:7], v[164:167]
v_mfma_f32_16x16x32_bf16 v[172:175], a[136:139], a[8:11], v[172:175]
ds_read_b64_tr_b16 a[130:131], v10 offset:2048
v_mfma_f32_16x16x32_bf16 v[172:175], a[140:143], a[12:15], v[172:175]
v_mfma_f32_16x16x32_bf16 v[180:183], a[136:139], a[16:19], v[180:183]
ds_read_b64_tr_b16 a[132:133], v10 offset:16384
v_mfma_f32_16x16x32_bf16 v[180:183], a[140:143], a[20:23], v[180:183]
v_mfma_f32_16x16x32_bf16 v[188:191], a[136:139], a[24:27], v[188:191]
ds_read_b64_tr_b16 a[134:135], v10 offset:18432
v_mfma_f32_16x16x32_bf16 v[188:191], a[140:143], a[28:31], v[188:191]
v_mfma_f32_16x16x32_bf16 v[196:199], a[136:139], a[32:35], v[196:199]
ds_read_b128 a[116:119], v3 offset:45056
v_mfma_f32_16x16x32_bf16 v[196:199], a[140:143], a[36:39], v[196:199]
v_mfma_f32_16x16x32_bf16 v[204:207], a[136:139], a[40:43], v[204:207]
ds_read_b128 a[120:123], v2 offset:47104
v_mfma_f32_16x16x32_bf16 v[204:207], a[140:143], a[44:47], v[204:207]
v_mfma_f32_16x16x32_bf16 v[212:215], a[136:139], a[48:51], v[212:215]
v_mfma_f32_16x16x32_bf16 v[212:215], a[140:143], a[52:55], v[212:215]
v_mfma_f32_16x16x32_bf16 v[220:223], a[136:139], a[56:59], v[220:223]
ds_read_b128 a[124:127], v3 offset:47104
v_mfma_f32_16x16x32_bf16 v[220:223], a[140:143], a[60:63], v[220:223]
s_waitcnt lgkmcnt(3)
v_mfma_f32_16x16x32_bf16 a[192:195], a[128:131], a[0:3], a[192:195]
ds_read_b64_tr_b16 a[136:137], v11 offset:0
v_mfma_f32_16x16x32_bf16 a[192:195], a[132:135], a[4:7], a[192:195]
v_mfma_f32_16x16x32_bf16 a[200:203], a[128:131], a[8:11], a[200:203]
ds_read_b64_tr_b16 a[138:139], v11 offset:2048
v_mfma_f32_16x16x32_bf16 a[200:203], a[132:135], a[12:15], a[200:203]
v_mfma_f32_16x16x32_bf16 a[208:211], a[128:131], a[16:19], a[208:211]
ds_read_b64_tr_b16 a[140:141], v11 offset:16384
v_mfma_f32_16x16x32_bf16 a[208:211], a[132:135], a[20:23], a[208:211]
v_mfma_f32_16x16x32_bf16 a[216:219], a[128:131], a[24:27], a[216:219]
ds_read_b64_tr_b16 a[142:143], v11 offset:18432
v_mfma_f32_16x16x32_bf16 a[216:219], a[132:135], a[28:31], a[216:219]
v_mfma_f32_16x16x32_bf16 a[224:227], a[128:131], a[32:35], a[224:227]
v_mfma_f32_16x16x32_bf16 a[224:227], a[132:135], a[36:39], a[224:227]
v_mfma_f32_16x16x32_bf16 a[232:235], a[128:131], a[40:43], a[232:235]
v_mfma_f32_16x16x32_bf16 a[232:235], a[132:135], a[44:47], a[232:235]
v_mfma_f32_16x16x32_bf16 a[240:243], a[128:131], a[48:51], a[240:243]
v_mfma_f32_16x16x32_bf16 a[240:243], a[132:135], a[52:55], a[240:243]
v_mfma_f32_16x16x32_bf16 a[248:251], a[128:131], a[56:59], a[248:251]
s_waitcnt vmcnt(2) lgkmcnt(0)
v_mfma_f32_16x16x32_bf16 a[248:251], a[132:135], a[60:63], a[248:251]
s_barrier
v_mfma_f32_16x16x32_bf16 a[196:199], a[136:139], a[0:3], a[196:199]
s_add_u32 m0, s29, 65536
ds_read_b64_tr_b16 a[128:129], v4 offset:32768
v_mfma_f32_16x16x32_bf16 a[196:199], a[140:143], a[4:7], a[196:199]
buffer_load_dwordx4 v16, s[12:15], s26 offen offset:0 lds
v_mfma_f32_16x16x32_bf16 a[204:207], a[136:139], a[8:11], a[204:207]
ds_read_b64_tr_b16 a[130:131], v4 offset:34816
v_mfma_f32_16x16x32_bf16 a[204:207], a[140:143], a[12:15], a[204:207]
v_mfma_f32_16x16x32_bf16 a[212:215], a[136:139], a[16:19], a[212:215]
ds_read_b64_tr_b16 a[132:133], v4 offset:49152
v_mfma_f32_16x16x32_bf16 a[212:215], a[140:143], a[20:23], a[212:215]
buffer_load_dwordx4 v17, s[12:15], s26 offen offset:1024 lds
v_mfma_f32_16x16x32_bf16 a[220:223], a[136:139], a[24:27], a[220:223]
ds_read_b64_tr_b16 a[134:135], v4 offset:51200
v_mfma_f32_16x16x32_bf16 a[220:223], a[140:143], a[28:31], a[220:223]
v_mfma_f32_16x16x32_bf16 a[228:231], a[136:139], a[32:35], a[228:231]
v_mfma_f32_16x16x32_bf16 a[228:231], a[140:143], a[36:39], a[228:231]
buffer_load_dwordx4 v18, s[12:15], s26 offen offset:2048 lds
v_mfma_f32_16x16x32_bf16 a[236:239], a[136:139], a[40:43], a[236:239]
v_mfma_f32_16x16x32_bf16 a[236:239], a[140:143], a[44:47], a[236:239]
v_mfma_f32_16x16x32_bf16 a[244:247], a[136:139], a[48:51], a[244:247]
v_mfma_f32_16x16x32_bf16 a[244:247], a[140:143], a[52:55], a[244:247]
s_waitcnt lgkmcnt(0)
buffer_load_dwordx4 v19, s[12:15], s26 offen offset:3072 lds
v_mfma_f32_16x16x32_bf16 a[252:255], a[136:139], a[56:59], a[252:255]
s_add_u32 s26, s26, 524288
s_bitcmp1_b32 s30, 1
v_mfma_f32_16x16x32_bf16 a[252:255], a[140:143], a[60:63], a[252:255]
s_cbranch_scc1 Lg_1
s_cmp_eq_u32 s30, 0
s_cbranch_scc1 Lg_1t
v_mfma_f32_16x16x32_bf16 v[32:35], a[128:131], a[64:67], v[32:35]
s_add_u32 m0, s29, 81920
ds_read_b64_tr_b16 a[136:137], v5 offset:32768
v_mfma_f32_16x16x32_bf16 v[32:35], a[132:135], a[68:71], v[32:35]
buffer_load_dwordx4 v16, s[12:15], s27 offen offset:0 lds
v_mfma_f32_16x16x32_bf16 v[40:43], a[128:131], a[72:75], v[40:43]
s_lshl_b32 s22, s38, 3
ds_read_b64_tr_b16 a[138:139], v5 offset:34816
v_mfma_f32_16x16x32_bf16 v[40:43], a[132:135], a[76:79], v[40:43]
s_lshl_b32 s23, s39, 5
v_and_b32 v252, 31, v0
v_lshrrev_b32 v253, 5, v0
v_mfma_f32_16x16x32_bf16 v[48:51], a[128:131], a[80:83], v[48:51]
ds_read_b64_tr_b16 a[140:141], v5 offset:49152
v_add_u32 v253, s22, v253
v_mfma_f32_16x16x32_bf16 v[48:51], a[132:135], a[84:87], v[48:51]
buffer_load_dwordx4 v17, s[12:15], s27 offen offset:1024 lds
v_mfma_f32_16x16x32_bf16 v[56:59], a[128:131], a[88:91], v[56:59]
ds_read_b64_tr_b16 a[142:143], v5 offset:51200
v_add_u32 v252, s23, v252
v_mfma_f32_16x16x32_bf16 v[56:59], a[132:135], a[92:95], v[56:59]
v_mul_u32_u24 v254, 7168, v253
v_lshl_add_u32 v254, v252, 2, v254
v_mfma_f32_16x16x32_bf16 v[64:67], a[128:131], a[96:99], v[64:67]
ds_read_b128 a[0:3], v2 offset:0
v_lshlrev_b32 v252, 4, v252
v_mfma_f32_16x16x32_bf16 v[64:67], a[132:135], a[100:103], v[64:67]
buffer_load_dwordx4 v18, s[12:15], s27 offen offset:2048 lds
v_mfma_f32_16x16x32_bf16 v[72:75], a[128:131], a[104:107], v[72:75]
ds_read_b128 a[4:7], v3 offset:0
v_add_u32 v255, 3584, v254
v_mfma_f32_16x16x32_bf16 v[72:75], a[132:135], a[108:111], v[72:75]
v_subrev_u32 v22, 3584, v254
v_subrev_u32 v23, 2688, v254
v_mfma_f32_16x16x32_bf16 v[80:83], a[128:131], a[112:115], v[80:83]
v_subrev_u32 v24, 1792, v254
v_subrev_u32 v25, 896, v254
v_mfma_f32_16x16x32_bf16 v[80:83], a[132:135], a[116:119], v[80:83]
buffer_load_dwordx4 v19, s[12:15], s27 offen offset:3072 lds
v_mfma_f32_16x16x32_bf16 v[88:91], a[128:131], a[120:123], v[88:91]
s_add_u32 s27, s27, 524288
ds_read_b128 a[8:11], v2 offset:2048
v_mfma_f32_16x16x32_bf16 v[88:91], a[132:135], a[124:127], v[88:91]
s_waitcnt lgkmcnt(3)
v_mfma_f32_16x16x32_bf16 v[36:39], a[136:139], a[64:67], v[36:39]
s_add_u32 m0, s28, 32768
ds_read_b64_tr_b16 a[128:129], v6 offset:32768
v_mfma_f32_16x16x32_bf16 v[36:39], a[140:143], a[68:71], v[36:39]
buffer_load_dwordx4 v12, s[8:11], s24 offen offset:0 lds
v_mfma_f32_16x16x32_bf16 v[44:47], a[136:139], a[72:75], v[44:47]
ds_read_b64_tr_b16 a[130:131], v6 offset:34816
v_mfma_f32_16x16x32_bf16 v[44:47], a[140:143], a[76:79], v[44:47]
v_mfma_f32_16x16x32_bf16 v[52:55], a[136:139], a[80:83], v[52:55]
ds_read_b64_tr_b16 a[132:133], v6 offset:49152
v_mfma_f32_16x16x32_bf16 v[52:55], a[140:143], a[84:87], v[52:55]
buffer_load_dwordx4 v13, s[8:11], s24 offen offset:1024 lds
v_mfma_f32_16x16x32_bf16 v[60:63], a[136:139], a[88:91], v[60:63]
ds_read_b64_tr_b16 a[134:135], v6 offset:51200
v_mfma_f32_16x16x32_bf16 v[60:63], a[140:143], a[92:95], v[60:63]
v_mfma_f32_16x16x32_bf16 v[68:71], a[136:139], a[96:99], v[68:71]
ds_read_b128 a[12:15], v3 offset:2048
v_mfma_f32_16x16x32_bf16 v[68:71], a[140:143], a[100:103], v[68:71]
buffer_load_dwordx4 v14, s[8:11], s24 offen offset:2048 lds
v_mfma_f32_16x16x32_bf16 v[76:79], a[136:139], a[104:107], v[76:79]
v_mfma_f32_16x16x32_bf16 v[76:79], a[140:143], a[108:111], v[76:79]
v_mfma_f32_16x16x32_bf16 v[84:87], a[136:139], a[112:115], v[84:87]
ds_read_b128 a[16:19], v2 offset:4096
v_mfma_f32_16x16x32_bf16 v[84:87], a[140:143], a[116:119], v[84:87]
buffer_load_dwordx4 v15, s[8:11], s24 offen offset:3072 lds
v_mfma_f32_16x16x32_bf16 v[92:95], a[136:139], a[120:123], v[92:95]
s_add_u32 s24, s24, 128
ds_read_b128 a[20:23], v3 offset:4096
v_mfma_f32_16x16x32_bf16 v[92:95], a[140:143], a[124:127], v[92:95]
s_waitcnt lgkmcnt(3)
v_mfma_f32_16x16x32_bf16 v[96:99], a[128:131], a[64:67], v[96:99]
s_add_u32 m0, s28, 36864
ds_read_b64_tr_b16 a[136:137], v7 offset:32768
v_mfma_f32_16x16x32_bf16 v[96:99], a[132:135], a[68:71], v[96:99]
buffer_load_dwordx4 v12, s[8:11], s25 offen offset:0 lds
v_mfma_f32_16x16x32_bf16 v[104:107], a[128:131], a[72:75], v[104:107]
ds_read_b64_tr_b16 a[138:139], v7 offset:34816
v_mfma_f32_16x16x32_bf16 v[104:107], a[132:135], a[76:79], v[104:107]
v_mfma_f32_16x16x32_bf16 v[112:115], a[128:131], a[80:83], v[112:115]
ds_read_b64_tr_b16 a[140:141], v7 offset:49152
v_mfma_f32_16x16x32_bf16 v[112:115], a[132:135], a[84:87], v[112:115]
buffer_load_dwordx4 v13, s[8:11], s25 offen offset:1024 lds
v_mfma_f32_16x16x32_bf16 v[120:123], a[128:131], a[88:91], v[120:123]
ds_read_b64_tr_b16 a[142:143], v7 offset:51200
v_mfma_f32_16x16x32_bf16 v[120:123], a[132:135], a[92:95], v[120:123]
v_mfma_f32_16x16x32_bf16 v[128:131], a[128:131], a[96:99], v[128:131]
v_mfma_f32_16x16x32_bf16 v[128:131], a[132:135], a[100:103], v[128:131]
buffer_load_dwordx4 v14, s[8:11], s25 offen offset:2048 lds
v_mfma_f32_16x16x32_bf16 v[136:139], a[128:131], a[104:107], v[136:139]
ds_read_b128 a[24:27], v2 offset:6144
v_mfma_f32_16x16x32_bf16 v[136:139], a[132:135], a[108:111], v[136:139]
v_mfma_f32_16x16x32_bf16 v[144:147], a[128:131], a[112:115], v[144:147]
ds_read_b128 a[28:31], v3 offset:6144
v_mfma_f32_16x16x32_bf16 v[144:147], a[132:135], a[116:119], v[144:147]
buffer_load_dwordx4 v15, s[8:11], s25 offen offset:3072 lds
v_mfma_f32_16x16x32_bf16 v[152:155], a[128:131], a[120:123], v[152:155]
s_add_u32 s25, s25, 128
v_mfma_f32_16x16x32_bf16 v[152:155], a[132:135], a[124:127], v[152:155]
s_waitcnt lgkmcnt(2)
v_mfma_f32_16x16x32_bf16 v[100:103], a[136:139], a[64:67], v[100:103]
s_mov_b64 s[56:57], s[70:71]
s_mov_b32 s58, 3584
s_mov_b32 s59, 0x20000
ds_read_b64_tr_b16 a[128:129], v8 offset:32768
buffer_load_dwordx4 v[248:251], v252, s[56:59], 0 offen
v_mfma_f32_16x16x32_bf16 v[100:103], a[140:143], a[68:71], v[100:103]
s_mov_b64 s[56:57], s[66:67]
s_mov_b32 s58, 1835008
buffer_load_dword v224, v22, s[56:59], 0 offen nt
v_mfma_f32_16x16x32_bf16 v[108:111], a[136:139], a[72:75], v[108:111]
ds_read_b64_tr_b16 a[130:131], v8 offset:34816
buffer_load_dword v225, v23, s[56:59], 0 offen nt
v_mfma_f32_16x16x32_bf16 v[108:111], a[140:143], a[76:79], v[108:111]
buffer_load_dword v226, v24, s[56:59], 0 offen nt
v_mfma_f32_16x16x32_bf16 v[116:119], a[136:139], a[80:83], v[116:119]
ds_read_b64_tr_b16 a[132:133], v8 offset:49152
buffer_load_dword v227, v25, s[56:59], 0 offen nt
v_mfma_f32_16x16x32_bf16 v[116:119], a[140:143], a[84:87], v[116:119]
buffer_load_dword v228, v254, s[56:59], 0 offen offset:0 nt
v_mfma_f32_16x16x32_bf16 v[124:127], a[136:139], a[88:91], v[124:127]
ds_read_b64_tr_b16 a[134:135], v8 offset:51200
buffer_load_dword v229, v254, s[56:59], 0 offen offset:896 nt
v_mfma_f32_16x16x32_bf16 v[124:127], a[140:143], a[92:95], v[124:127]
buffer_load_dword v230, v254, s[56:59], 0 offen offset:1792 nt
v_mfma_f32_16x16x32_bf16 v[132:135], a[136:139], a[96:99], v[132:135]
ds_read_b128 a[32:35], v2 offset:8192
buffer_load_dword v231, v254, s[56:59], 0 offen offset:2688 nt
v_mfma_f32_16x16x32_bf16 v[132:135], a[140:143], a[100:103], v[132:135]
buffer_load_dword v232, v255, s[56:59], 0 offen offset:0 nt
v_mfma_f32_16x16x32_bf16 v[140:143], a[136:139], a[104:107], v[140:143]
buffer_load_dword v233, v255, s[56:59], 0 offen offset:896 nt
v_mfma_f32_16x16x32_bf16 v[140:143], a[140:143], a[108:111], v[140:143]
buffer_load_dword v234, v255, s[56:59], 0 offen offset:1792 nt
v_mfma_f32_16x16x32_bf16 v[148:151], a[136:139], a[112:115], v[148:151]
ds_read_b128 a[36:39], v3 offset:8192
buffer_load_dword v235, v255, s[56:59], 0 offen offset:2688 nt
v_mfma_f32_16x16x32_bf16 v[148:151], a[140:143], a[116:119], v[148:151]
s_mov_b64 s[56:57], s[68:69]
buffer_load_dword v236, v25, s[56:59], 0 offen nt
v_mfma_f32_16x16x32_bf16 v[156:159], a[136:139], a[120:123], v[156:159]
ds_read_b128 a[40:43], v2 offset:10240
buffer_load_dword v237, v254, s[56:59], 0 offen offset:0 nt
v_mfma_f32_16x16x32_bf16 v[156:159], a[140:143], a[124:127], v[156:159]
s_waitcnt lgkmcnt(3)
buffer_load_dword v238, v254, s[56:59], 0 offen offset:896 nt
v_mfma_f32_16x16x32_bf16 v[160:163], a[128:131], a[64:67], v[160:163]
ds_read_b64_tr_b16 a[136:137], v9 offset:32768
buffer_load_dword v239, v254, s[56:59], 0 offen offset:1792 nt
v_mfma_f32_16x16x32_bf16 v[160:163], a[132:135], a[68:71], v[160:163]
buffer_load_dword v240, v254, s[56:59], 0 offen offset:2688 nt
v_mfma_f32_16x16x32_bf16 v[168:171], a[128:131], a[72:75], v[168:171]
ds_read_b64_tr_b16 a[138:139], v9 offset:34816
buffer_load_dword v241, v255, s[56:59], 0 offen offset:0 nt
v_mfma_f32_16x16x32_bf16 v[168:171], a[132:135], a[76:79], v[168:171]
buffer_load_dword v242, v255, s[56:59], 0 offen offset:896 nt
v_mfma_f32_16x16x32_bf16 v[176:179], a[128:131], a[80:83], v[176:179]
ds_read_b64_tr_b16 a[140:141], v9 offset:49152
buffer_load_dword v243, v255, s[56:59], 0 offen offset:1792 nt
v_mfma_f32_16x16x32_bf16 v[176:179], a[132:135], a[84:87], v[176:179]
buffer_load_dword v244, v255, s[56:59], 0 offen offset:2688 nt
v_mfma_f32_16x16x32_bf16 v[184:187], a[128:131], a[88:91], v[184:187]
ds_read_b64_tr_b16 a[142:143], v9 offset:51200
v_mfma_f32_16x16x32_bf16 v[184:187], a[132:135], a[92:95], v[184:187]
v_mfma_f32_16x16x32_bf16 v[192:195], a[128:131], a[96:99], v[192:195]
v_mfma_f32_16x16x32_bf16 v[192:195], a[132:135], a[100:103], v[192:195]
v_mfma_f32_16x16x32_bf16 v[200:203], a[128:131], a[104:107], v[200:203]
ds_read_b128 a[44:47], v3 offset:10240
v_mfma_f32_16x16x32_bf16 v[200:203], a[132:135], a[108:111], v[200:203]
v_mfma_f32_16x16x32_bf16 v[208:211], a[128:131], a[112:115], v[208:211]
ds_read_b128 a[48:51], v2 offset:12288
v_mfma_f32_16x16x32_bf16 v[208:211], a[132:135], a[116:119], v[208:211]
v_mfma_f32_16x16x32_bf16 v[216:219], a[128:131], a[120:123], v[216:219]
v_mfma_f32_16x16x32_bf16 v[216:219], a[132:135], a[124:127], v[216:219]
s_waitcnt lgkmcnt(2)
v_mfma_f32_16x16x32_bf16 v[164:167], a[136:139], a[64:67], v[164:167]
ds_read_b64_tr_b16 a[128:129], v10 offset:32768
v_mfma_f32_16x16x32_bf16 v[164:167], a[140:143], a[68:71], v[164:167]
v_mfma_f32_16x16x32_bf16 v[172:175], a[136:139], a[72:75], v[172:175]
ds_read_b64_tr_b16 a[130:131], v10 offset:34816
v_mfma_f32_16x16x32_bf16 v[172:175], a[140:143], a[76:79], v[172:175]
v_mfma_f32_16x16x32_bf16 v[180:183], a[136:139], a[80:83], v[180:183]
ds_read_b64_tr_b16 a[132:133], v10 offset:49152
v_mfma_f32_16x16x32_bf16 v[180:183], a[140:143], a[84:87], v[180:183]
v_mfma_f32_16x16x32_bf16 v[188:191], a[136:139], a[88:91], v[188:191]
ds_read_b64_tr_b16 a[134:135], v10 offset:51200
v_mfma_f32_16x16x32_bf16 v[188:191], a[140:143], a[92:95], v[188:191]
v_mfma_f32_16x16x32_bf16 v[196:199], a[136:139], a[96:99], v[196:199]
ds_read_b128 a[52:55], v3 offset:12288
v_mfma_f32_16x16x32_bf16 v[196:199], a[140:143], a[100:103], v[196:199]
v_mfma_f32_16x16x32_bf16 v[204:207], a[136:139], a[104:107], v[204:207]
ds_read_b128 a[56:59], v2 offset:14336
v_mfma_f32_16x16x32_bf16 v[204:207], a[140:143], a[108:111], v[204:207]
v_mfma_f32_16x16x32_bf16 v[212:215], a[136:139], a[112:115], v[212:215]
v_mfma_f32_16x16x32_bf16 v[212:215], a[140:143], a[116:119], v[212:215]
v_mfma_f32_16x16x32_bf16 v[220:223], a[136:139], a[120:123], v[220:223]
ds_read_b128 a[60:63], v3 offset:14336
v_mfma_f32_16x16x32_bf16 v[220:223], a[140:143], a[124:127], v[220:223]
s_waitcnt lgkmcnt(3)
v_mfma_f32_16x16x32_bf16 a[192:195], a[128:131], a[64:67], a[192:195]
ds_read_b64_tr_b16 a[136:137], v11 offset:32768
v_mfma_f32_16x16x32_bf16 a[192:195], a[132:135], a[68:71], a[192:195]
v_mfma_f32_16x16x32_bf16 a[200:203], a[128:131], a[72:75], a[200:203]
ds_read_b64_tr_b16 a[138:139], v11 offset:34816
v_mfma_f32_16x16x32_bf16 a[200:203], a[132:135], a[76:79], a[200:203]
v_mfma_f32_16x16x32_bf16 a[208:211], a[128:131], a[80:83], a[208:211]
ds_read_b64_tr_b16 a[140:141], v11 offset:49152
v_mfma_f32_16x16x32_bf16 a[208:211], a[132:135], a[84:87], a[208:211]
v_mfma_f32_16x16x32_bf16 a[216:219], a[128:131], a[88:91], a[216:219]
ds_read_b64_tr_b16 a[142:143], v11 offset:51200
v_mfma_f32_16x16x32_bf16 a[216:219], a[132:135], a[92:95], a[216:219]
v_mfma_f32_16x16x32_bf16 a[224:227], a[128:131], a[96:99], a[224:227]
v_mfma_f32_16x16x32_bf16 a[224:227], a[132:135], a[100:103], a[224:227]
v_mfma_f32_16x16x32_bf16 a[232:235], a[128:131], a[104:107], a[232:235]
v_mfma_f32_16x16x32_bf16 a[232:235], a[132:135], a[108:111], a[232:235]
v_mfma_f32_16x16x32_bf16 a[240:243], a[128:131], a[112:115], a[240:243]
v_mfma_f32_16x16x32_bf16 a[240:243], a[132:135], a[116:119], a[240:243]
v_mfma_f32_16x16x32_bf16 a[248:251], a[128:131], a[120:123], a[248:251]
s_waitcnt vmcnt(22) lgkmcnt(0)
v_mfma_f32_16x16x32_bf16 a[248:251], a[132:135], a[124:127], a[248:251]
s_barrier
v_mfma_f32_16x16x32_bf16 a[196:199], a[136:139], a[64:67], a[196:199]
s_add_u32 m0, s29, 98304
ds_read_b64_tr_b16 a[128:129], v4 offset:0
v_mfma_f32_16x16x32_bf16 a[196:199], a[140:143], a[68:71], a[196:199]
buffer_load_dwordx4 v16, s[12:15], s26 offen offset:0 lds
v_mfma_f32_16x16x32_bf16 a[204:207], a[136:139], a[72:75], a[204:207]
ds_read_b64_tr_b16 a[130:131], v4 offset:2048
v_mfma_f32_16x16x32_bf16 a[204:207], a[140:143], a[76:79], a[204:207]
v_mfma_f32_16x16x32_bf16 a[212:215], a[136:139], a[80:83], a[212:215]
ds_read_b64_tr_b16 a[132:133], v4 offset:16384
v_mfma_f32_16x16x32_bf16 a[212:215], a[140:143], a[84:87], a[212:215]
buffer_load_dwordx4 v17, s[12:15], s26 offen offset:1024 lds
v_mfma_f32_16x16x32_bf16 a[220:223], a[136:139], a[88:91], a[220:223]
ds_read_b64_tr_b16 a[134:135], v4 offset:18432
v_mfma_f32_16x16x32_bf16 a[220:223], a[140:143], a[92:95], a[220:223]
v_mfma_f32_16x16x32_bf16 a[228:231], a[136:139], a[96:99], a[228:231]
v_mfma_f32_16x16x32_bf16 a[228:231], a[140:143], a[100:103], a[228:231]
buffer_load_dwordx4 v18, s[12:15], s26 offen offset:2048 lds
v_mfma_f32_16x16x32_bf16 a[236:239], a[136:139], a[104:107], a[236:239]
v_mfma_f32_16x16x32_bf16 a[236:239], a[140:143], a[108:111], a[236:239]
v_mfma_f32_16x16x32_bf16 a[244:247], a[136:139], a[112:115], a[244:247]
v_mfma_f32_16x16x32_bf16 a[244:247], a[140:143], a[116:119], a[244:247]
buffer_load_dwordx4 v19, s[12:15], s26 offen offset:3072 lds
v_mfma_f32_16x16x32_bf16 a[252:255], a[136:139], a[120:123], a[252:255]
s_add_u32 s26, s26, 524288
v_mfma_f32_16x16x32_bf16 a[252:255], a[140:143], a[124:127], a[252:255]
s_waitcnt lgkmcnt(0)
v_mfma_f32_16x16x32_bf16 v[32:35], a[128:131], a[0:3], v[32:35]
s_add_u32 m0, s29, 114688
ds_read_b64_tr_b16 a[136:137], v5 offset:0
v_mfma_f32_16x16x32_bf16 v[32:35], a[132:135], a[4:7], v[32:35]
buffer_load_dwordx4 v16, s[12:15], s27 offen offset:0 lds
v_mfma_f32_16x16x32_bf16 v[40:43], a[128:131], a[8:11], v[40:43]
ds_read_b64_tr_b16 a[138:139], v5 offset:2048
v_mfma_f32_16x16x32_bf16 v[40:43], a[132:135], a[12:15], v[40:43]
v_mfma_f32_16x16x32_bf16 v[48:51], a[128:131], a[16:19], v[48:51]
ds_read_b64_tr_b16 a[140:141], v5 offset:16384
v_mfma_f32_16x16x32_bf16 v[48:51], a[132:135], a[20:23], v[48:51]
buffer_load_dwordx4 v17, s[12:15], s27 offen offset:1024 lds
v_mfma_f32_16x16x32_bf16 v[56:59], a[128:131], a[24:27], v[56:59]
ds_read_b64_tr_b16 a[142:143], v5 offset:18432
v_mfma_f32_16x16x32_bf16 v[56:59], a[132:135], a[28:31], v[56:59]
v_mfma_f32_16x16x32_bf16 v[64:67], a[128:131], a[32:35], v[64:67]
ds_read_b128 a[64:67], v2 offset:32768
v_mfma_f32_16x16x32_bf16 v[64:67], a[132:135], a[36:39], v[64:67]
buffer_load_dwordx4 v18, s[12:15], s27 offen offset:2048 lds
v_mfma_f32_16x16x32_bf16 v[72:75], a[128:131], a[40:43], v[72:75]
ds_read_b128 a[68:71], v3 offset:32768
v_mfma_f32_16x16x32_bf16 v[72:75], a[132:135], a[44:47], v[72:75]
v_mfma_f32_16x16x32_bf16 v[80:83], a[128:131], a[48:51], v[80:83]
v_mfma_f32_16x16x32_bf16 v[80:83], a[132:135], a[52:55], v[80:83]
buffer_load_dwordx4 v19, s[12:15], s27 offen offset:3072 lds
v_mfma_f32_16x16x32_bf16 v[88:91], a[128:131], a[56:59], v[88:91]
s_add_u32 s27, s27, 524288
ds_read_b128 a[72:75], v2 offset:34816
v_mfma_f32_16x16x32_bf16 v[88:91], a[132:135], a[60:63], v[88:91]
s_waitcnt lgkmcnt(3)
v_mfma_f32_16x16x32_bf16 v[36:39], a[136:139], a[0:3], v[36:39]
s_add_u32 m0, s28, 0
ds_read_b64_tr_b16 a[128:129], v6 offset:0
v_mfma_f32_16x16x32_bf16 v[36:39], a[140:143], a[4:7], v[36:39]
buffer_load_dwordx4 v12, s[8:11], s24 offen offset:0 lds
v_mfma_f32_16x16x32_bf16 v[44:47], a[136:139], a[8:11], v[44:47]
ds_read_b64_tr_b16 a[130:131], v6 offset:2048
v_mfma_f32_16x16x32_bf16 v[44:47], a[140:143], a[12:15], v[44:47]
v_mfma_f32_16x16x32_bf16 v[52:55], a[136:139], a[16:19], v[52:55]
ds_read_b64_tr_b16 a[132:133], v6 offset:16384
v_mfma_f32_16x16x32_bf16 v[52:55], a[140:143], a[20:23], v[52:55]
buffer_load_dwordx4 v13, s[8:11], s24 offen offset:1024 lds
v_mfma_f32_16x16x32_bf16 v[60:63], a[136:139], a[24:27], v[60:63]
ds_read_b64_tr_b16 a[134:135], v6 offset:18432
v_mfma_f32_16x16x32_bf16 v[60:63], a[140:143], a[28:31], v[60:63]
v_mfma_f32_16x16x32_bf16 v[68:71], a[136:139], a[32:35], v[68:71]
ds_read_b128 a[76:79], v3 offset:34816
v_mfma_f32_16x16x32_bf16 v[68:71], a[140:143], a[36:39], v[68:71]
buffer_load_dwordx4 v14, s[8:11], s24 offen offset:2048 lds
v_mfma_f32_16x16x32_bf16 v[76:79], a[136:139], a[40:43], v[76:79]
v_mfma_f32_16x16x32_bf16 v[76:79], a[140:143], a[44:47], v[76:79]
v_mfma_f32_16x16x32_bf16 v[84:87], a[136:139], a[48:51], v[84:87]
ds_read_b128 a[80:83], v2 offset:36864
v_mfma_f32_16x16x32_bf16 v[84:87], a[140:143], a[52:55], v[84:87]
buffer_load_dwordx4 v15, s[8:11], s24 offen offset:3072 lds
v_mfma_f32_16x16x32_bf16 v[92:95], a[136:139], a[56:59], v[92:95]
s_add_u32 s24, s24, 128
ds_read_b128 a[84:87], v3 offset:36864
v_mfma_f32_16x16x32_bf16 v[92:95], a[140:143], a[60:63], v[92:95]
s_waitcnt lgkmcnt(3)
v_mfma_f32_16x16x32_bf16 v[96:99], a[128:131], a[0:3], v[96:99]
s_add_u32 m0, s28, 4096
ds_read_b64_tr_b16 a[136:137], v7 offset:0
v_mfma_f32_16x16x32_bf16 v[96:99], a[132:135], a[4:7], v[96:99]
buffer_load_dwordx4 v12, s[8:11], s25 offen offset:0 lds
v_mfma_f32_16x16x32_bf16 v[104:107], a[128:131], a[8:11], v[104:107]
ds_read_b64_tr_b16 a[138:139], v7 offset:2048
v_mfma_f32_16x16x32_bf16 v[104:107], a[132:135], a[12:15], v[104:107]
v_mfma_f32_16x16x32_bf16 v[112:115], a[128:131], a[16:19], v[112:115]
ds_read_b64_tr_b16 a[140:141], v7 offset:16384
v_mfma_f32_16x16x32_bf16 v[112:115], a[132:135], a[20:23], v[112:115]
buffer_load_dwordx4 v13, s[8:11], s25 offen offset:1024 lds
v_mfma_f32_16x16x32_bf16 v[120:123], a[128:131], a[24:27], v[120:123]
ds_read_b64_tr_b16 a[142:143], v7 offset:18432
v_mfma_f32_16x16x32_bf16 v[120:123], a[132:135], a[28:31], v[120:123]
v_mfma_f32_16x16x32_bf16 v[128:131], a[128:131], a[32:35], v[128:131]
v_mfma_f32_16x16x32_bf16 v[128:131], a[132:135], a[36:39], v[128:131]
buffer_load_dwordx4 v14, s[8:11], s25 offen offset:2048 lds
v_mfma_f32_16x16x32_bf16 v[136:139], a[128:131], a[40:43], v[136:139]
ds_read_b128 a[88:91], v2 offset:38912
v_mfma_f32_16x16x32_bf16 v[136:139], a[132:135], a[44:47], v[136:139]
v_mfma_f32_16x16x32_bf16 v[144:147], a[128:131], a[48:51], v[144:147]
ds_read_b128 a[92:95], v3 offset:38912
v_mfma_f32_16x16x32_bf16 v[144:147], a[132:135], a[52:55], v[144:147]
buffer_load_dwordx4 v15, s[8:11], s25 offen offset:3072 lds
v_mfma_f32_16x16x32_bf16 v[152:155], a[128:131], a[56:59], v[152:155]
s_add_u32 s25, s25, 128
v_mfma_f32_16x16x32_bf16 v[152:155], a[132:135], a[60:63], v[152:155]
s_waitcnt lgkmcnt(2)
v_mfma_f32_16x16x32_bf16 v[100:103], a[136:139], a[0:3], v[100:103]
ds_read_b64_tr_b16 a[128:129], v8 offset:0
v_mfma_f32_16x16x32_bf16 v[100:103], a[140:143], a[4:7], v[100:103]
buffer_load_dword v21, v20, s[16:19], s43 offen
v_mfma_f32_16x16x32_bf16 v[108:111], a[136:139], a[8:11], v[108:111]
s_add_u32 s43, s43, s47
ds_read_b64_tr_b16 a[130:131], v8 offset:2048
v_mfma_f32_16x16x32_bf16 v[108:111], a[140:143], a[12:15], v[108:111]
PAD_2:
s_cbranch_execz M_tret
s_cmp_ge_u32 s43, s51
v_mfma_f32_16x16x32_bf16 v[116:119], a[136:139], a[16:19], v[116:119]
s_cselect_b32 s43, 0, s43
ds_read_b64_tr_b16 a[132:133], v8 offset:16384
v_mfma_f32_16x16x32_bf16 v[116:119], a[140:143], a[20:23], v[116:119]
s_cselect_b32 s51, s42, s51
v_mfma_f32_16x16x32_bf16 v[124:127], a[136:139], a[24:27], v[124:127]
s_cselect_b64 s[16:17], s[40:41], s[16:17]
ds_read_b64_tr_b16 a[134:135], v8 offset:18432
v_mfma_f32_16x16x32_bf16 v[124:127], a[140:143], a[28:31], v[124:127]
s_cselect_b32 s18, s42, s18
v_mfma_f32_16x16x32_bf16 v[132:135], a[136:139], a[32:35], v[132:135]
s_cselect_b64 s[40:41], s[44:45], s[40:41]
ds_read_b128 a[96:99], v2 offset:40960
v_mfma_f32_16x16x32_bf16 v[132:135], a[140:143], a[36:39], v[132:135]
s_cselect_b32 s42, s46, s42
v_mfma_f32_16x16x32_bf16 v[140:143], a[136:139], a[40:43], v[140:143]
s_cselect_b32 s46, 0, s46
v_mfma_f32_16x16x32_bf16 v[140:143], a[140:143], a[44:47], v[140:143]
s_lshl_b32 s59, s39, 5
v_mfma_f32_16x16x32_bf16 v[148:151], a[136:139], a[48:51], v[148:151]
s_add_u32 s59, s59, s38
ds_read_b128 a[100:103], v3 offset:40960
v_mfma_f32_16x16x32_bf16 v[148:151], a[140:143], a[52:55], v[148:151]
s_lshl_b32 s59, s59, 2
v_mfma_f32_16x16x32_bf16 v[156:159], a[136:139], a[56:59], v[156:159]
s_add_u32 s59, s59, 94392320
ds_read_b128 a[104:107], v2 offset:43008
v_mfma_f32_16x16x32_bf16 v[156:159], a[140:143], a[60:63], v[156:159]
s_waitcnt lgkmcnt(3)
s_cmp_lt_u32 s2, 224
v_mfma_f32_16x16x32_bf16 v[160:163], a[128:131], a[0:3], v[160:163]
s_cselect_b32 s59, s59, 3221225472
ds_read_b64_tr_b16 a[136:137], v9 offset:0
v_mfma_f32_16x16x32_bf16 v[160:163], a[132:135], a[4:7], v[160:163]
s_mov_b32 s58, 0xffff0000
v_mfma_f32_16x16x32_bf16 v[168:171], a[128:131], a[8:11], v[168:171]
ds_read_b64_tr_b16 a[138:139], v9 offset:2048
v_mfma_f32_16x16x32_bf16 v[168:171], a[132:135], a[12:15], v[168:171]
buffer_load_dword v21, v20, s[16:19], s43 offen
v_mfma_f32_16x16x32_bf16 v[176:179], a[128:131], a[16:19], v[176:179]
s_add_u32 s43, s43, s47
ds_read_b64_tr_b16 a[140:141], v9 offset:16384
v_mfma_f32_16x16x32_bf16 v[176:179], a[132:135], a[20:23], v[176:179]
s_cmp_ge_u32 s43, s51
v_mfma_f32_16x16x32_bf16 v[184:187], a[128:131], a[24:27], v[184:187]
s_cselect_b32 s43, 0, s43
ds_read_b64_tr_b16 a[142:143], v9 offset:18432
v_mfma_f32_16x16x32_bf16 v[184:187], a[132:135], a[28:31], v[184:187]
s_cselect_b32 s51, s42, s51
v_mfma_f32_16x16x32_bf16 v[192:195], a[128:131], a[32:35], v[192:195]
s_cselect_b64 s[16:17], s[40:41], s[16:17]
v_mfma_f32_16x16x32_bf16 v[192:195], a[132:135], a[36:39], v[192:195]
s_cselect_b32 s18, s42, s18
v_mfma_f32_16x16x32_bf16 v[200:203], a[128:131], a[40:43], v[200:203]
s_cselect_b64 s[40:41], s[44:45], s[40:41]
ds_read_b128 a[108:111], v3 offset:43008
v_mfma_f32_16x16x32_bf16 v[200:203], a[132:135], a[44:47], v[200:203]
s_cselect_b32 s42, s46, s42
v_mfma_f32_16x16x32_bf16 v[208:211], a[128:131], a[48:51], v[208:211]
s_cselect_b32 s46, 0, s46
ds_read_b128 a[112:115], v2 offset:45056
v_mfma_f32_16x16x32_bf16 v[208:211], a[132:135], a[52:55], v[208:211]
v_mfma_f32_16x16x32_bf16 v[216:219], a[128:131], a[56:59], v[216:219]
v_mfma_f32_16x16x32_bf16 v[216:219], a[132:135], a[60:63], v[216:219]
s_waitcnt lgkmcnt(2)
v_mfma_f32_16x16x32_bf16 v[164:167], a[136:139], a[0:3], v[164:167]
ds_read_b64_tr_b16 a[128:129], v10 offset:0
v_mfma_f32_16x16x32_bf16 v[164:167], a[140:143], a[4:7], v[164:167]
v_mfma_f32_16x16x32_bf16 v[172:175], a[136:139], a[8:11], v[172:175]
ds_read_b64_tr_b16 a[130:131], v10 offset:2048
v_mfma_f32_16x16x32_bf16 v[172:175], a[140:143], a[12:15], v[172:175]
v_mfma_f32_16x16x32_bf16 v[180:183], a[136:139], a[16:19], v[180:183]
ds_read_b64_tr_b16 a[132:133], v10 offset:16384
v_mfma_f32_16x16x32_bf16 v[180:183], a[140:143], a[20:23], v[180:183]
v_mfma_f32_16x16x32_bf16 v[188:191], a[136:139], a[24:27], v[188:191]
ds_read_b64_tr_b16 a[134:135], v10 offset:18432
v_mfma_f32_16x16x32_bf16 v[188:191], a[140:143], a[28:31], v[188:191]
v_mfma_f32_16x16x32_bf16 v[196:199], a[136:139], a[32:35], v[196:199]
ds_read_b128 a[116:119], v3 offset:45056
v_mfma_f32_16x16x32_bf16 v[196:199], a[140:143], a[36:39], v[196:199]
v_mfma_f32_16x16x32_bf16 v[204:207], a[136:139], a[40:43], v[204:207]
ds_read_b128 a[120:123], v2 offset:47104
v_and_b32 v252, 31, v0
v_mfma_f32_16x16x32_bf16 v[204:207], a[140:143], a[44:47], v[204:207]
v_lshrrev_b32 v253, 5, v0
v_xor_b32 v253, v253, v252
v_mfma_f32_16x16x32_bf16 v[212:215], a[136:139], a[48:51], v[212:215]
v_and_b32 v253, 7, v253
v_lshlrev_b32 v252, 8, v252
v_mfma_f32_16x16x32_bf16 v[212:215], a[140:143], a[52:55], v[212:215]
v_lshl_add_u32 v252, v253, 4, v252
v_add_u32 v252, 147456, v252
v_mfma_f32_16x16x32_bf16 v[220:223], a[136:139], a[56:59], v[220:223]
ds_read_b128 a[124:127], v3 offset:47104
v_mfma_f32_16x16x32_bf16 v[220:223], a[140:143], a[60:63], v[220:223]
s_waitcnt lgkmcnt(3)
v_mfma_f32_16x16x32_bf16 a[192:195], a[128:131], a[0:3], a[192:195]
ds_read_b64_tr_b16 a[136:137], v11 offset:0
v_mfma_f32_16x16x32_bf16 a[192:195], a[132:135], a[4:7], a[192:195]
v_mfma_f32_16x16x32_bf16 a[200:203], a[128:131], a[8:11], a[200:203]
ds_read_b64_tr_b16 a[138:139], v11 offset:2048
v_mfma_f32_16x16x32_bf16 a[200:203], a[132:135], a[12:15], a[200:203]
v_mfma_f32_16x16x32_bf16 a[208:211], a[128:131], a[16:19], a[208:211]
ds_read_b64_tr_b16 a[140:141], v11 offset:16384
v_mfma_f32_16x16x32_bf16 a[208:211], a[132:135], a[20:23], a[208:211]
v_mfma_f32_16x16x32_bf16 a[216:219], a[128:131], a[24:27], a[216:219]
ds_read_b64_tr_b16 a[142:143], v11 offset:18432
v_mfma_f32_16x16x32_bf16 a[216:219], a[132:135], a[28:31], a[216:219]
v_mfma_f32_16x16x32_bf16 a[224:227], a[128:131], a[32:35], a[224:227]
v_mfma_f32_16x16x32_bf16 a[224:227], a[132:135], a[36:39], a[224:227]
v_mfma_f32_16x16x32_bf16 a[232:235], a[128:131], a[40:43], a[232:235]
v_mfma_f32_16x16x32_bf16 a[232:235], a[132:135], a[44:47], a[232:235]
v_mfma_f32_16x16x32_bf16 a[240:243], a[128:131], a[48:51], a[240:243]
v_mfma_f32_16x16x32_bf16 a[240:243], a[132:135], a[52:55], a[240:243]
v_mfma_f32_16x16x32_bf16 a[248:251], a[128:131], a[56:59], a[248:251]
s_waitcnt vmcnt(2) lgkmcnt(0)
v_mfma_f32_16x16x32_bf16 a[248:251], a[132:135], a[60:63], a[248:251]
s_barrier
v_mfma_f32_16x16x32_bf16 a[196:199], a[136:139], a[0:3], a[196:199]
s_add_u32 m0, s29, 65536
ds_read_b64_tr_b16 a[128:129], v4 offset:32768
v_lshlrev_b32 v28, 16, v248
v_mfma_f32_16x16x32_bf16 a[196:199], a[140:143], a[4:7], a[196:199]
buffer_load_dwordx4 v16, s[12:15], s26 offen offset:0 lds
v_mfma_f32_16x16x32_bf16 a[204:207], a[136:139], a[8:11], a[204:207]
ds_read_b64_tr_b16 a[130:131], v4 offset:34816
v_and_b32 v29, s58, v248
v_mfma_f32_16x16x32_bf16 a[204:207], a[140:143], a[12:15], a[204:207]
v_lshlrev_b32 v30, 16, v249
v_and_b32 v253, s58, v249
v_mfma_f32_16x16x32_bf16 a[212:215], a[136:139], a[16:19], a[212:215]
ds_read_b64_tr_b16 a[132:133], v4 offset:49152
v_lshlrev_b32 v22, 16, v224
v_mfma_f32_16x16x32_bf16 a[212:215], a[140:143], a[20:23], a[212:215]
buffer_load_dwordx4 v17, s[12:15], s26 offen offset:1024 lds
v_mfma_f32_16x16x32_bf16 a[220:223], a[136:139], a[24:27], a[220:223]
ds_read_b64_tr_b16 a[134:135], v4 offset:51200
v_lshlrev_b32 v23, 16, v225
v_mfma_f32_16x16x32_bf16 a[220:223], a[140:143], a[28:31], a[220:223]
v_lshlrev_b32 v24, 16, v226
v_mul_f32 v254, v22, v253
v_mfma_f32_16x16x32_bf16 a[228:231], a[136:139], a[32:35], a[228:231]
v_lshlrev_b32 v25, 16, v227
v_lshlrev_b32 v247, 16, v236
v_mfma_f32_16x16x32_bf16 a[228:231], a[140:143], a[36:39], a[228:231]
buffer_load_dwordx4 v18, s[12:15], s26 offen offset:2048 lds
v_mfma_f32_16x16x32_bf16 a[236:239], a[136:139], a[40:43], a[236:239]
v_fmac_f32 v254, v23, v30
v_fmac_f32 v254, v24, v29
v_mfma_f32_16x16x32_bf16 a[236:239], a[140:143], a[44:47], a[236:239]
v_fmac_f32 v254, v25, v28
v_mul_f32 v254, v254, v247
v_mfma_f32_16x16x32_bf16 a[244:247], a[136:139], a[48:51], a[244:247]
v_mul_f32 v255, v23, v253
v_lshlrev_b32 v22, 16, v228
v_mfma_f32_16x16x32_bf16 a[244:247], a[140:143], a[52:55], a[244:247]
buffer_load_dwordx4 v19, s[12:15], s26 offen offset:3072 lds
v_mfma_f32_16x16x32_bf16 a[252:255], a[136:139], a[56:59], a[252:255]
s_add_u32 s26, s26, 524288
v_lshlrev_b32 v247, 16, v237
v_fmac_f32 v255, v24, v30
v_mfma_f32_16x16x32_bf16 a[252:255], a[140:143], a[60:63], a[252:255]
s_waitcnt lgkmcnt(0)
v_fmac_f32 v255, v25, v29
v_fmac_f32 v255, v22, v28
v_mfma_f32_16x16x32_bf16 v[32:35], a[128:131], a[64:67], v[32:35]
s_add_u32 m0, s29, 81920
ds_read_b64_tr_b16 a[136:137], v5 offset:32768
v_mul_f32 v255, v255, v247
v_mfma_f32_16x16x32_bf16 v[32:35], a[132:135], a[68:71], v[32:35]
buffer_load_dwordx4 v16, s[12:15], s27 offen offset:0 lds
v_mfma_f32_16x16x32_bf16 v[40:43], a[128:131], a[72:75], v[40:43]
ds_read_b64_tr_b16 a[138:139], v5 offset:34816
v_cvt_pk_bf16_f32 v246, v254, v255
v_mfma_f32_16x16x32_bf16 v[40:43], a[132:135], a[76:79], v[40:43]
v_accvgpr_write_b32 a180, v246
v_mul_f32 v254, v24, v253
v_mfma_f32_16x16x32_bf16 v[48:51], a[128:131], a[80:83], v[48:51]
ds_read_b64_tr_b16 a[140:141], v5 offset:49152
v_lshlrev_b32 v23, 16, v229
v_mfma_f32_16x16x32_bf16 v[48:51], a[132:135], a[84:87], v[48:51]
buffer_load_dwordx4 v17, s[12:15], s27 offen offset:1024 lds
v_lshlrev_b32 v247, 16, v238
v_mfma_f32_16x16x32_bf16 v[56:59], a[128:131], a[88:91], v[56:59]
ds_read_b64_tr_b16 a[142:143], v5 offset:51200
v_fmac_f32 v254, v25, v30
v_mfma_f32_16x16x32_bf16 v[56:59], a[132:135], a[92:95], v[56:59]
v_fmac_f32 v254, v22, v29
v_fmac_f32 v254, v23, v28
v_mfma_f32_16x16x32_bf16 v[64:67], a[128:131], a[96:99], v[64:67]
ds_read_b128 a[0:3], v2 offset:0
v_mul_f32 v254, v254, v247
v_mfma_f32_16x16x32_bf16 v[64:67], a[132:135], a[100:103], v[64:67]
buffer_load_dwordx4 v18, s[12:15], s27 offen offset:2048 lds
v_mfma_f32_16x16x32_bf16 v[72:75], a[128:131], a[104:107], v[72:75]
ds_read_b128 a[4:7], v3 offset:0
v_cvt_pk_bf16_f32 v246, v255, v254
v_accvgpr_write_b32 a176, v246
v_mfma_f32_16x16x32_bf16 v[72:75], a[132:135], a[108:111], v[72:75]
v_mul_f32 v255, v25, v253
v_lshlrev_b32 v24, 16, v230
v_mfma_f32_16x16x32_bf16 v[80:83], a[128:131], a[112:115], v[80:83]
v_lshlrev_b32 v247, 16, v239
v_fmac_f32 v255, v22, v30
v_mfma_f32_16x16x32_bf16 v[80:83], a[132:135], a[116:119], v[80:83]
buffer_load_dwordx4 v19, s[12:15], s27 offen offset:3072 lds
v_mfma_f32_16x16x32_bf16 v[88:91], a[128:131], a[120:123], v[88:91]
s_add_u32 s27, s27, 524288
ds_read_b128 a[8:11], v2 offset:2048
v_fmac_f32 v255, v23, v29
v_mfma_f32_16x16x32_bf16 v[88:91], a[132:135], a[124:127], v[88:91]
s_waitcnt lgkmcnt(3)
v_fmac_f32 v255, v24, v28
v_mul_f32 v255, v255, v247
v_mfma_f32_16x16x32_bf16 v[36:39], a[136:139], a[64:67], v[36:39]
s_add_u32 m0, s28, 32768
ds_read_b64_tr_b16 a[128:129], v6 offset:32768
v_cvt_pk_bf16_f32 v246, v254, v255
v_accvgpr_write_b32 a181, v246
v_mfma_f32_16x16x32_bf16 v[36:39], a[140:143], a[68:71], v[36:39]
buffer_load_dwordx4 v12, s[8:11], s24 offen offset:0 lds
v_mfma_f32_16x16x32_bf16 v[44:47], a[136:139], a[72:75], v[44:47]
ds_read_b64_tr_b16 a[130:131], v6 offset:34816
v_mul_f32 v254, v22, v253
v_mfma_f32_16x16x32_bf16 v[44:47], a[140:143], a[76:79], v[44:47]
v_lshlrev_b32 v25, 16, v231
v_lshlrev_b32 v247, 16, v240
v_mfma_f32_16x16x32_bf16 v[52:55], a[136:139], a[80:83], v[52:55]
ds_read_b64_tr_b16 a[132:133], v6 offset:49152
v_fmac_f32 v254, v23, v30
v_mfma_f32_16x16x32_bf16 v[52:55], a[140:143], a[84:87], v[52:55]
buffer_load_dwordx4 v13, s[8:11], s24 offen offset:1024 lds
v_fmac_f32 v254, v24, v29
v_mfma_f32_16x16x32_bf16 v[60:63], a[136:139], a[88:91], v[60:63]
ds_read_b64_tr_b16 a[134:135], v6 offset:51200
v_fmac_f32 v254, v25, v28
v_mfma_f32_16x16x32_bf16 v[60:63], a[140:143], a[92:95], v[60:63]
v_mul_f32 v254, v254, v247
v_cvt_pk_bf16_f32 v246, v255, v254
v_mfma_f32_16x16x32_bf16 v[68:71], a[136:139], a[96:99], v[68:71]
ds_read_b128 a[12:15], v3 offset:2048
v_accvgpr_write_b32 a177, v246
v_mfma_f32_16x16x32_bf16 v[68:71], a[140:143], a[100:103], v[68:71]
buffer_load_dwordx4 v14, s[8:11], s24 offen offset:2048 lds
v_mfma_f32_16x16x32_bf16 v[76:79], a[136:139], a[104:107], v[76:79]
v_mul_f32 v255, v23, v253
v_lshlrev_b32 v22, 16, v232
v_lshlrev_b32 v247, 16, v241
v_mfma_f32_16x16x32_bf16 v[76:79], a[140:143], a[108:111], v[76:79]
v_fmac_f32 v255, v24, v30
v_fmac_f32 v255, v25, v29
v_mfma_f32_16x16x32_bf16 v[84:87], a[136:139], a[112:115], v[84:87]
ds_read_b128 a[16:19], v2 offset:4096
v_fmac_f32 v255, v22, v28
v_mfma_f32_16x16x32_bf16 v[84:87], a[140:143], a[116:119], v[84:87]
buffer_load_dwordx4 v15, s[8:11], s24 offen offset:3072 lds
v_mfma_f32_16x16x32_bf16 v[92:95], a[136:139], a[120:123], v[92:95]
s_add_u32 s24, s24, 128
ds_read_b128 a[20:23], v3 offset:4096
v_mul_f32 v255, v255, v247
v_mfma_f32_16x16x32_bf16 v[92:95], a[140:143], a[124:127], v[92:95]
s_waitcnt lgkmcnt(3)
v_cvt_pk_bf16_f32 v246, v254, v255
v_accvgpr_write_b32 a182, v246
v_mfma_f32_16x16x32_bf16 v[96:99], a[128:131], a[64:67], v[96:99]
s_add_u32 m0, s28, 36864
ds_read_b64_tr_b16 a[136:137], v7 offset:32768
v_mul_f32 v254, v24, v253
v_lshlrev_b32 v23, 16, v233
v_mfma_f32_16x16x32_bf16 v[96:99], a[132:135], a[68:71], v[96:99]
buffer_load_dwordx4 v12, s[8:11], s25 offen offset:0 lds
v_mfma_f32_16x16x32_bf16 v[104:107], a[128:131], a[72:75], v[104:107]
ds_read_b64_tr_b16 a[138:139], v7 offset:34816
v_lshlrev_b32 v247, 16, v242
v_mfma_f32_16x16x32_bf16 v[104:107], a[132:135], a[76:79], v[104:107]
v_fmac_f32 v254, v25, v30
v_fmac_f32 v254, v22, v29
v_mfma_f32_16x16x32_bf16 v[112:115], a[128:131], a[80:83], v[112:115]
ds_read_b64_tr_b16 a[140:141], v7 offset:49152
v_fmac_f32 v254, v23, v28
v_mfma_f32_16x16x32_bf16 v[112:115], a[132:135], a[84:87], v[112:115]
buffer_load_dwordx4 v13, s[8:11], s25 offen offset:1024 lds
v_mul_f32 v254, v254, v247
v_mfma_f32_16x16x32_bf16 v[120:123], a[128:131], a[88:91], v[120:123]
ds_read_b64_tr_b16 a[142:143], v7 offset:51200
v_cvt_pk_bf16_f32 v246, v255, v254
v_mfma_f32_16x16x32_bf16 v[120:123], a[132:135], a[92:95], v[120:123]
v_accvgpr_write_b32 a178, v246
v_mul_f32 v255, v25, v253
v_mfma_f32_16x16x32_bf16 v[128:131], a[128:131], a[96:99], v[128:131]
v_lshlrev_b32 v24, 16, v234
v_lshlrev_b32 v247, 16, v243
v_mfma_f32_16x16x32_bf16 v[128:131], a[132:135], a[100:103], v[128:131]
buffer_load_dwordx4 v14, s[8:11], s25 offen offset:2048 lds
v_mfma_f32_16x16x32_bf16 v[136:139], a[128:131], a[104:107], v[136:139]
ds_read_b128 a[24:27], v2 offset:6144
v_fmac_f32 v255, v22, v30
v_fmac_f32 v255, v23, v29
v_mfma_f32_16x16x32_bf16 v[136:139], a[132:135], a[108:111], v[136:139]
v_fmac_f32 v255, v24, v28
v_mul_f32 v255, v255, v247
v_mfma_f32_16x16x32_bf16 v[144:147], a[128:131], a[112:115], v[144:147]
ds_read_b128 a[28:31], v3 offset:6144
v_cvt_pk_bf16_f32 v246, v254, v255
v_mfma_f32_16x16x32_bf16 v[144:147], a[132:135], a[116:119], v[144:147]
buffer_load_dwordx4 v15, s[8:11], s25 offen offset:3072 lds
v_mfma_f32_16x16x32_bf16 v[152:155], a[128:131], a[120:123], v[152:155]
s_add_u32 s25, s25, 128
v_accvgpr_write_b32 a183, v246
v_mul_f32 v254, v22, v253
v_mfma_f32_16x16x32_bf16 v[152:155], a[132:135], a[124:127], v[152:155]
s_waitcnt lgkmcnt(2)
v_lshlrev_b32 v25, 16, v235
v_lshlrev_b32 v247, 16, v244
v_mfma_f32_16x16x32_bf16 v[100:103], a[136:139], a[64:67], v[100:103]
ds_read_b64_tr_b16 a[128:129], v8 offset:32768
v_fmac_f32 v254, v23, v30
v_fmac_f32 v254, v24, v29
v_mfma_f32_16x16x32_bf16 v[100:103], a[140:143], a[68:71], v[100:103]
buffer_load_dword v21, v20, s[16:19], s43 offen
v_mfma_f32_16x16x32_bf16 v[108:111], a[136:139], a[72:75], v[108:111]
s_add_u32 s43, s43, s47
ds_read_b64_tr_b16 a[130:131], v8 offset:34816
v_fmac_f32 v254, v25, v28
v_mfma_f32_16x16x32_bf16 v[108:111], a[140:143], a[76:79], v[108:111]
s_cmp_ge_u32 s43, s51
v_mul_f32 v254, v254, v247
v_cvt_pk_bf16_f32 v246, v255, v254
v_mfma_f32_16x16x32_bf16 v[116:119], a[136:139], a[80:83], v[116:119]
s_cselect_b32 s43, 0, s43
ds_read_b64_tr_b16 a[132:133], v8 offset:49152
v_accvgpr_write_b32 a179, v246
v_mfma_f32_16x16x32_bf16 v[116:119], a[140:143], a[84:87], v[116:119]
s_cselect_b32 s51, s42, s51
v_lshlrev_b32 v28, 16, v250
v_and_b32 v29, s58, v250
v_lshlrev_b32 v30, 16, v251
v_mfma_f32_16x16x32_bf16 v[124:127], a[136:139], a[88:91], v[124:127]
s_cselect_b64 s[16:17], s[40:41], s[16:17]
ds_read_b64_tr_b16 a[134:135], v8 offset:51200
v_and_b32 v253, s58, v251
v_mfma_f32_16x16x32_bf16 v[124:127], a[140:143], a[92:95], v[124:127]
s_cselect_b32 s18, s42, s18
v_and_b32 v22, s58, v224
v_and_b32 v23, s58, v225
v_mfma_f32_16x16x32_bf16 v[132:135], a[136:139], a[96:99], v[132:135]
s_cselect_b64 s[40:41], s[44:45], s[40:41]
ds_read_b128 a[32:35], v2 offset:8192
v_and_b32 v24, s58, v226
v_mfma_f32_16x16x32_bf16 v[132:135], a[140:143], a[100:103], v[132:135]
s_cselect_b32 s42, s46, s42
v_mul_f32 v254, v22, v253
v_and_b32 v25, s58, v227
v_mfma_f32_16x16x32_bf16 v[140:143], a[136:139], a[104:107], v[140:143]
s_cselect_b32 s46, 0, s46
v_and_b32 v247, s58, v236
v_fmac_f32 v254, v23, v30
v_mfma_f32_16x16x32_bf16 v[140:143], a[140:143], a[108:111], v[140:143]
buffer_load_dword v245, off, s[60:63], 0 sc1
v_fmac_f32 v254, v24, v29
v_mfma_f32_16x16x32_bf16 v[148:151], a[136:139], a[112:115], v[148:151]
ds_read_b128 a[36:39], v3 offset:8192
v_fmac_f32 v254, v25, v28
v_mfma_f32_16x16x32_bf16 v[148:151], a[140:143], a[116:119], v[148:151]
v_mul_f32 v254, v254, v247
v_mul_f32 v255, v23, v253
v_mfma_f32_16x16x32_bf16 v[156:159], a[136:139], a[120:123], v[156:159]
ds_read_b128 a[40:43], v2 offset:10240
v_and_b32 v22, s58, v228
v_mfma_f32_16x16x32_bf16 v[156:159], a[140:143], a[124:127], v[156:159]
s_waitcnt lgkmcnt(3)
v_and_b32 v247, s58, v237
v_fmac_f32 v255, v24, v30
v_mfma_f32_16x16x32_bf16 v[160:163], a[128:131], a[64:67], v[160:163]
ds_read_b64_tr_b16 a[136:137], v9 offset:32768
v_fmac_f32 v255, v25, v29
v_fmac_f32 v255, v22, v28
v_mfma_f32_16x16x32_bf16 v[160:163], a[132:135], a[68:71], v[160:163]
v_mul_f32 v255, v255, v247
v_cvt_pk_bf16_f32 v246, v254, v255
v_mfma_f32_16x16x32_bf16 v[168:171], a[128:131], a[72:75], v[168:171]
ds_read_b64_tr_b16 a[138:139], v9 offset:34816
v_accvgpr_write_b32 a188, v246
v_mfma_f32_16x16x32_bf16 v[168:171], a[132:135], a[76:79], v[168:171]
v_mul_f32 v254, v24, v253
v_and_b32 v23, s58, v229
v_mfma_f32_16x16x32_bf16 v[176:179], a[128:131], a[80:83], v[176:179]
ds_read_b64_tr_b16 a[140:141], v9 offset:49152
v_and_b32 v247, s58, v238
v_mfma_f32_16x16x32_bf16 v[176:179], a[132:135], a[84:87], v[176:179]
v_fmac_f32 v254, v25, v30
v_fmac_f32 v254, v22, v29
v_fmac_f32 v254, v23, v28
v_mfma_f32_16x16x32_bf16 v[184:187], a[128:131], a[88:91], v[184:187]
ds_read_b64_tr_b16 a[142:143], v9 offset:51200
v_mul_f32 v254, v254, v247
v_mfma_f32_16x16x32_bf16 v[184:187], a[132:135], a[92:95], v[184:187]
v_cvt_pk_bf16_f32 v246, v255, v254
v_accvgpr_write_b32 a184, v246
v_mfma_f32_16x16x32_bf16 v[192:195], a[128:131], a[96:99], v[192:195]
v_mul_f32 v255, v25, v253
v_and_b32 v24, s58, v230
v_mfma_f32_16x16x32_bf16 v[192:195], a[132:135], a[100:103], v[192:195]
v_and_b32 v247, s58, v239
v_fmac_f32 v255, v22, v30
v_mfma_f32_16x16x32_bf16 v[200:203], a[128:131], a[104:107], v[200:203]
ds_read_b128 a[44:47], v3 offset:10240
v_fmac_f32 v255, v23, v29
v_mfma_f32_16x16x32_bf16 v[200:203], a[132:135], a[108:111], v[200:203]
v_fmac_f32 v255, v24, v28
v_mul_f32 v255, v255, v247
v_cvt_pk_bf16_f32 v246, v254, v255
v_mfma_f32_16x16x32_bf16 v[208:211], a[128:131], a[112:115], v[208:211]
ds_read_b128 a[48:51], v2 offset:12288
v_accvgpr_write_b32 a189, v246
v_mfma_f32_16x16x32_bf16 v[208:211], a[132:135], a[116:119], v[208:211]
v_mul_f32 v254, v22, v253
v_and_b32 v25, s58, v231
v_mfma_f32_16x16x32_bf16 v[216:219], a[128:131], a[120:123], v[216:219]
v_and_b32 v247, s58, v240
v_fmac_f32 v254, v23, v30
v_mfma_f32_16x16x32_bf16 v[216:219], a[132:135], a[124:127], v[216:219]
s_waitcnt lgkmcnt(2)
v_fmac_f32 v254, v24, v29
v_fmac_f32 v254, v25, v28
v_mfma_f32_16x16x32_bf16 v[164:167], a[136:139], a[64:67], v[164:167]
ds_read_b64_tr_b16 a[128:129], v10 offset:32768
v_mul_f32 v254, v254, v247
v_cvt_pk_bf16_f32 v246, v255, v254
v_mfma_f32_16x16x32_bf16 v[164:167], a[140:143], a[68:71], v[164:167]
v_accvgpr_write_b32 a185, v246
v_mul_f32 v255, v23, v253
v_mfma_f32_16x16x32_bf16 v[172:175], a[136:139], a[72:75], v[172:175]
ds_read_b64_tr_b16 a[130:131], v10 offset:34816
v_and_b32 v22, s58, v232
v_mfma_f32_16x16x32_bf16 v[172:175], a[140:143], a[76:79], v[172:175]
v_and_b32 v247, s58, v241
v_fmac_f32 v255, v24, v30
v_mfma_f32_16x16x32_bf16 v[180:183], a[136:139], a[80:83], v[180:183]
s_lshr_b32 s22, s3, 1
ds_read_b64_tr_b16 a[132:133], v10 offset:49152
v_fmac_f32 v255, v25, v29
v_mfma_f32_16x16x32_bf16 v[180:183], a[140:143], a[84:87], v[180:183]
s_mul_i32 s22, s22, 2097152
v_fmac_f32 v255, v22, v28
v_mul_f32 v255, v255, v247
v_cvt_pk_bf16_f32 v246, v254, v255
v_mfma_f32_16x16x32_bf16 v[188:191], a[136:139], a[88:91], v[188:191]
s_and_b32 s23, s3, 1
ds_read_b64_tr_b16 a[134:135], v10 offset:51200
v_accvgpr_write_b32 a190, v246
v_mfma_f32_16x16x32_bf16 v[188:191], a[140:143], a[92:95], v[188:191]
s_lshl_b32 s23, s23, 5
v_mul_f32 v254, v24, v253
v_and_b32 v23, s58, v233
v_mfma_f32_16x16x32_bf16 v[196:199], a[136:139], a[96:99], v[196:199]
s_lshl_b32 s56, s39, 6
ds_read_b128 a[52:55], v3 offset:12288
v_and_b32 v247, s58, v242
v_mfma_f32_16x16x32_bf16 v[196:199], a[140:143], a[100:103], v[196:199]
s_add_u32 s23, s23, s56
v_fmac_f32 v254, v25, v30
v_fmac_f32 v254, v22, v29
v_mfma_f32_16x16x32_bf16 v[204:207], a[136:139], a[104:107], v[204:207]
s_mul_i32 s23, s23, 4224
ds_read_b128 a[56:59], v2 offset:14336
v_fmac_f32 v254, v23, v28
v_mfma_f32_16x16x32_bf16 v[204:207], a[140:143], a[108:111], v[204:207]
s_add_u32 s22, s22, s23
v_mul_f32 v254, v254, v247
v_cvt_pk_bf16_f32 v246, v255, v254
v_accvgpr_write_b32 a186, v246
v_mfma_f32_16x16x32_bf16 v[212:215], a[136:139], a[112:115], v[212:215]
s_add_u32 s57, s22, 83886200
v_mul_f32 v255, v25, v253
v_and_b32 v24, s58, v234
v_mfma_f32_16x16x32_bf16 v[212:215], a[140:143], a[116:119], v[212:215]
s_lshl_b32 s23, s38, 7
v_and_b32 v247, s58, v243
v_fmac_f32 v255, v22, v30
v_mfma_f32_16x16x32_bf16 v[220:223], a[136:139], a[120:123], v[220:223]
s_add_u32 s22, s22, s23
ds_read_b128 a[60:63], v3 offset:14336
v_fmac_f32 v255, v23, v29
v_mfma_f32_16x16x32_bf16 v[220:223], a[140:143], a[124:127], v[220:223]
s_waitcnt lgkmcnt(3)
s_add_u32 s56, s22, 83886208
v_fmac_f32 v255, v24, v28
v_mul_f32 v255, v255, v247
v_mfma_f32_16x16x32_bf16 a[192:195], a[128:131], a[64:67], a[192:195]
s_cmp_lt_u32 s2, 224
ds_read_b64_tr_b16 a[136:137], v11 offset:32768
v_cvt_pk_bf16_f32 v246, v254, v255
v_accvgpr_write_b32 a191, v246
v_mfma_f32_16x16x32_bf16 a[192:195], a[132:135], a[68:71], a[192:195]
s_cselect_b32 s56, s56, 3221225472
v_mul_f32 v254, v22, v253
v_and_b32 v25, s58, v235
v_mfma_f32_16x16x32_bf16 a[200:203], a[128:131], a[72:75], a[200:203]
s_cmp_eq_u32 s38, 0
ds_read_b64_tr_b16 a[138:139], v11 offset:34816
v_and_b32 v247, s58, v244
v_mfma_f32_16x16x32_bf16 a[200:203], a[132:135], a[76:79], a[200:203]
s_cselect_b32 s57, s57, 3221225472
v_fmac_f32 v254, v23, v30
v_fmac_f32 v254, v24, v29
v_mfma_f32_16x16x32_bf16 a[208:211], a[128:131], a[80:83], a[208:211]
ds_read_b64_tr_b16 a[140:141], v11 offset:49152
v_fmac_f32 v254, v25, v28
v_mfma_f32_16x16x32_bf16 a[208:211], a[132:135], a[84:87], a[208:211]
v_mul_f32 v254, v254, v247
v_cvt_pk_bf16_f32 v246, v255, v254
v_accvgpr_write_b32 a187, v246
v_mfma_f32_16x16x32_bf16 a[216:219], a[128:131], a[88:91], a[216:219]
ds_read_b64_tr_b16 a[142:143], v11 offset:51200
v_mfma_f32_16x16x32_bf16 a[216:219], a[132:135], a[92:95], a[216:219]
ds_write_b128 v252, a[176:179] offset:0
v_mfma_f32_16x16x32_bf16 a[224:227], a[128:131], a[96:99], a[224:227]
v_mfma_f32_16x16x32_bf16 a[224:227], a[132:135], a[100:103], a[224:227]
ds_write_b128 v252, a[180:183] offset:8192
v_mfma_f32_16x16x32_bf16 a[232:235], a[128:131], a[104:107], a[232:235]
v_mfma_f32_16x16x32_bf16 a[232:235], a[132:135], a[108:111], a[232:235]
ds_write_b128 v252, a[184:187] offset:128
v_mfma_f32_16x16x32_bf16 a[240:243], a[128:131], a[112:115], a[240:243]
v_mfma_f32_16x16x32_bf16 a[240:243], a[132:135], a[116:119], a[240:243]
ds_write_b128 v252, a[188:191] offset:8320
v_mfma_f32_16x16x32_bf16 a[248:251], a[128:131], a[120:123], a[248:251]
s_waitcnt vmcnt(2) lgkmcnt(0)
v_mfma_f32_16x16x32_bf16 a[248:251], a[132:135], a[124:127], a[248:251]
s_barrier
v_mfma_f32_16x16x32_bf16 a[196:199], a[136:139], a[64:67], a[196:199]
s_add_u32 m0, s29, 98304
ds_read_b64_tr_b16 a[128:129], v4 offset:0
v_lshrrev_b32 v22, 8, v1
v_mfma_f32_16x16x32_bf16 a[196:199], a[140:143], a[68:71], a[196:199]
buffer_load_dwordx4 v16, s[12:15], s26 offen offset:0 lds
v_mfma_f32_16x16x32_bf16 a[204:207], a[136:139], a[72:75], a[204:207]
ds_read_b64_tr_b16 a[130:131], v4 offset:2048
v_lshlrev_b32 v22, 4, v22
v_mfma_f32_16x16x32_bf16 a[204:207], a[140:143], a[76:79], a[204:207]
v_xor_b32 v22, v22, v1
v_add_u32 v22, s29, v22
v_mfma_f32_16x16x32_bf16 a[212:215], a[136:139], a[80:83], a[212:215]
ds_read_b64_tr_b16 a[132:133], v4 offset:16384
v_add_u32 v22, 147456, v22
v_mfma_f32_16x16x32_bf16 a[212:215], a[140:143], a[84:87], a[212:215]
buffer_load_dwordx4 v17, s[12:15], s26 offen offset:1024 lds
v_mfma_f32_16x16x32_bf16 a[220:223], a[136:139], a[88:91], a[220:223]
ds_read_b64_tr_b16 a[134:135], v4 offset:18432
v_xor_b32 v23, 64, v22
v_mfma_f32_16x16x32_bf16 a[220:223], a[140:143], a[92:95], a[220:223]
v_lshrrev_b32 v224, 7, v1
v_mul_u32_u24 v224, 4224, v224
v_mfma_f32_16x16x32_bf16 a[228:231], a[136:139], a[96:99], a[228:231]
v_and_b32 v225, 0x70, v1
v_add_u32 v224, v224, v225
v_mfma_f32_16x16x32_bf16 a[228:231], a[140:143], a[100:103], a[228:231]
buffer_load_dwordx4 v18, s[12:15], s26 offen offset:2048 lds
v_mfma_f32_16x16x32_bf16 a[236:239], a[136:139], a[104:107], a[236:239]
v_bfe_u32 v225, v1, 4, 5
v_mul_u32_u24 v225, 4224, v225
v_mfma_f32_16x16x32_bf16 a[236:239], a[140:143], a[108:111], a[236:239]
v_mov_b32 v226, 0
v_mov_b32 v227, 0
v_mfma_f32_16x16x32_bf16 a[244:247], a[136:139], a[112:115], a[244:247]
v_mfma_f32_16x16x32_bf16 a[244:247], a[140:143], a[116:119], a[244:247]
buffer_load_dwordx4 v19, s[12:15], s26 offen offset:3072 lds
v_mfma_f32_16x16x32_bf16 a[252:255], a[136:139], a[120:123], a[252:255]
s_add_u32 s26, s26, 524288
v_mfma_f32_16x16x32_bf16 a[252:255], a[140:143], a[124:127], a[252:255]
s_waitcnt lgkmcnt(0)
v_mfma_f32_16x16x32_bf16 v[32:35], a[128:131], a[0:3], v[32:35]
s_add_u32 m0, s29, 114688
ds_read_b64_tr_b16 a[136:137], v5 offset:0
v_mfma_f32_16x16x32_bf16 v[32:35], a[132:135], a[4:7], v[32:35]
buffer_load_dwordx4 v16, s[12:15], s27 offen offset:0 lds
v_mfma_f32_16x16x32_bf16 v[40:43], a[128:131], a[8:11], v[40:43]
s_mul_i32 s52, s20, 7
ds_read_b64_tr_b16 a[138:139], v5 offset:2048
v_mfma_f32_16x16x32_bf16 v[40:43], a[132:135], a[12:15], v[40:43]
s_add_u32 s52, s52, s21
buffer_store_dwordx2 v[226:227], v225, s[4:7], s57 offen sc1
v_mfma_f32_16x16x32_bf16 v[48:51], a[128:131], a[16:19], v[48:51]
s_lshl_b32 s53, s52, 2
ds_read_b64_tr_b16 a[140:141], v5 offset:16384
v_mfma_f32_16x16x32_bf16 v[48:51], a[132:135], a[20:23], v[48:51]
s_add_u32 s53, s53, s3
buffer_load_dwordx4 v17, s[12:15], s27 offen offset:1024 lds
v_mfma_f32_16x16x32_bf16 v[56:59], a[128:131], a[24:27], v[56:59]
s_lshl_b32 s49, s53, 12
ds_read_b64_tr_b16 a[142:143], v5 offset:18432
v_mfma_f32_16x16x32_bf16 v[56:59], a[132:135], a[28:31], v[56:59]
s_mul_i32 s53, s53, 4224
v_mfma_f32_16x16x32_bf16 v[64:67], a[128:131], a[32:35], v[64:67]
s_add_u32 s53, s53, 83886080
ds_read_b128 a[64:67], v2 offset:32768
v_mfma_f32_16x16x32_bf16 v[64:67], a[132:135], a[36:39], v[64:67]
s_lshr_b32 s52, s52, 4
buffer_load_dwordx4 v18, s[12:15], s27 offen offset:2048 lds
v_mfma_f32_16x16x32_bf16 v[72:75], a[128:131], a[40:43], v[72:75]
s_min_u32 s52, s52, 6
ds_read_b128 a[68:71], v3 offset:32768
v_mfma_f32_16x16x32_bf16 v[72:75], a[132:135], a[44:47], v[72:75]
s_lshl_b32 s52, s52, 7
ds_read_b128 a[176:179], v22 offset:0
v_mfma_f32_16x16x32_bf16 v[80:83], a[128:131], a[48:51], v[80:83]
s_add_u32 s52, s52, 94392320
ds_read_b128 a[180:183], v23 offset:1024
v_mfma_f32_16x16x32_bf16 v[80:83], a[132:135], a[52:55], v[80:83]
buffer_load_dwordx4 v19, s[12:15], s27 offen offset:3072 lds
v_mfma_f32_16x16x32_bf16 v[88:91], a[128:131], a[56:59], v[88:91]
s_add_u32 s27, s27, 524288
ds_read_b128 a[72:75], v2 offset:34816
v_mfma_f32_16x16x32_bf16 v[88:91], a[132:135], a[60:63], v[88:91]
s_waitcnt lgkmcnt(5)
ds_read_b128 a[184:187], v22 offset:2048
v_mfma_f32_16x16x32_bf16 v[36:39], a[136:139], a[0:3], v[36:39]
s_add_u32 m0, s28, 0
ds_read_b64_tr_b16 a[128:129], v6 offset:0
v_mfma_f32_16x16x32_bf16 v[36:39], a[140:143], a[4:7], v[36:39]
buffer_load_dwordx4 v12, s[8:11], s24 offen offset:0 lds
v_mfma_f32_16x16x32_bf16 v[44:47], a[136:139], a[8:11], v[44:47]
PAD_3:
s_cbranch_execz M_tret
ds_read_b64_tr_b16 a[130:131], v6 offset:2048
v_mfma_f32_16x16x32_bf16 v[44:47], a[140:143], a[12:15], v[44:47]
ds_read_b128 a[188:191], v23 offset:3072
v_mfma_f32_16x16x32_bf16 v[52:55], a[136:139], a[16:19], v[52:55]
ds_read_b64_tr_b16 a[132:133], v6 offset:16384
v_bfe_u32 v231, v1, 4, 5
v_mfma_f32_16x16x32_bf16 v[52:55], a[140:143], a[20:23], v[52:55]
buffer_load_dwordx4 v13, s[8:11], s24 offen offset:1024 lds
v_mfma_f32_16x16x32_bf16 v[60:63], a[136:139], a[24:27], v[60:63]
ds_read_b64_tr_b16 a[134:135], v6 offset:18432
v_lshlrev_b32 v231, 2, v231
v_mfma_f32_16x16x32_bf16 v[60:63], a[140:143], a[28:31], v[60:63]
v_lshlrev_b32 v229, 3, v1
v_min_u32 v229, 4096, v229
v_mfma_f32_16x16x32_bf16 v[68:71], a[136:139], a[32:35], v[68:71]
ds_read_b128 a[76:79], v3 offset:34816
v_mfma_f32_16x16x32_bf16 v[68:71], a[140:143], a[36:39], v[68:71]
buffer_load_dwordx4 v14, s[8:11], s24 offen offset:2048 lds
v_mfma_f32_16x16x32_bf16 v[76:79], a[136:139], a[40:43], v[76:79]
v_mfma_f32_16x16x32_bf16 v[76:79], a[140:143], a[44:47], v[76:79]
v_mfma_f32_16x16x32_bf16 v[84:87], a[136:139], a[48:51], v[84:87]
ds_read_b128 a[80:83], v2 offset:36864
v_mfma_f32_16x16x32_bf16 v[84:87], a[140:143], a[52:55], v[84:87]
buffer_load_dwordx4 v15, s[8:11], s24 offen offset:3072 lds
v_mfma_f32_16x16x32_bf16 v[92:95], a[136:139], a[56:59], v[92:95]
s_add_u32 s24, s24, 128
ds_read_b128 a[84:87], v3 offset:36864
v_mfma_f32_16x16x32_bf16 v[92:95], a[140:143], a[60:63], v[92:95]
s_waitcnt lgkmcnt(3)
v_mfma_f32_16x16x32_bf16 v[96:99], a[128:131], a[0:3], v[96:99]
s_add_u32 m0, s28, 4096
ds_read_b64_tr_b16 a[136:137], v7 offset:0
v_mfma_f32_16x16x32_bf16 v[96:99], a[132:135], a[4:7], v[96:99]
buffer_load_dwordx4 v12, s[8:11], s25 offen offset:0 lds
v_mfma_f32_16x16x32_bf16 v[104:107], a[128:131], a[8:11], v[104:107]
ds_read_b64_tr_b16 a[138:139], v7 offset:2048
v_mfma_f32_16x16x32_bf16 v[104:107], a[132:135], a[12:15], v[104:107]
v_mfma_f32_16x16x32_bf16 v[112:115], a[128:131], a[16:19], v[112:115]
ds_read_b64_tr_b16 a[140:141], v7 offset:16384
v_mfma_f32_16x16x32_bf16 v[112:115], a[132:135], a[20:23], v[112:115]
buffer_load_dwordx4 v13, s[8:11], s25 offen offset:1024 lds
v_mfma_f32_16x16x32_bf16 v[120:123], a[128:131], a[24:27], v[120:123]
ds_read_b64_tr_b16 a[142:143], v7 offset:18432
v_mfma_f32_16x16x32_bf16 v[120:123], a[132:135], a[28:31], v[120:123]
v_mfma_f32_16x16x32_bf16 v[128:131], a[128:131], a[32:35], v[128:131]
v_mfma_f32_16x16x32_bf16 v[128:131], a[132:135], a[36:39], v[128:131]
buffer_load_dwordx4 v14, s[8:11], s25 offen offset:2048 lds
v_mfma_f32_16x16x32_bf16 v[136:139], a[128:131], a[40:43], v[136:139]
ds_read_b128 a[88:91], v2 offset:38912
v_mfma_f32_16x16x32_bf16 v[136:139], a[132:135], a[44:47], v[136:139]
v_mfma_f32_16x16x32_bf16 v[144:147], a[128:131], a[48:51], v[144:147]
ds_read_b128 a[92:95], v3 offset:38912
v_mfma_f32_16x16x32_bf16 v[144:147], a[132:135], a[52:55], v[144:147]
buffer_load_dwordx4 v15, s[8:11], s25 offen offset:3072 lds
v_mfma_f32_16x16x32_bf16 v[152:155], a[128:131], a[56:59], v[152:155]
s_add_u32 s25, s25, 128
v_mfma_f32_16x16x32_bf16 v[152:155], a[132:135], a[60:63], v[152:155]
s_waitcnt lgkmcnt(2)
v_mfma_f32_16x16x32_bf16 v[100:103], a[136:139], a[0:3], v[100:103]
ds_read_b64_tr_b16 a[128:129], v8 offset:0
v_mfma_f32_16x16x32_bf16 v[100:103], a[140:143], a[4:7], v[100:103]
buffer_store_dwordx4 a[176:179], v224, s[4:7], s56 offen sc1
v_mfma_f32_16x16x32_bf16 v[108:111], a[136:139], a[8:11], v[108:111]
s_add_u32 s56, s56, 33792
ds_read_b64_tr_b16 a[130:131], v8 offset:2048
v_mfma_f32_16x16x32_bf16 v[108:111], a[140:143], a[12:15], v[108:111]
v_mfma_f32_16x16x32_bf16 v[116:119], a[136:139], a[16:19], v[116:119]
ds_read_b64_tr_b16 a[132:133], v8 offset:16384
v_mfma_f32_16x16x32_bf16 v[116:119], a[140:143], a[20:23], v[116:119]
v_mfma_f32_16x16x32_bf16 v[124:127], a[136:139], a[24:27], v[124:127]
s_cmp_lt_u32 s21, 0
ds_read_b64_tr_b16 a[134:135], v8 offset:18432
v_mfma_f32_16x16x32_bf16 v[124:127], a[140:143], a[28:31], v[124:127]
s_cselect_b32 s53, s53, 3221225472
v_mfma_f32_16x16x32_bf16 v[132:135], a[136:139], a[32:35], v[132:135]
s_cselect_b32 s49, s49, 3221225472
ds_read_b128 a[96:99], v2 offset:40960
v_mfma_f32_16x16x32_bf16 v[132:135], a[140:143], a[36:39], v[132:135]
s_add_u32 s48, s53, 2097152
v_mfma_f32_16x16x32_bf16 v[140:143], a[136:139], a[40:43], v[140:143]
v_mfma_f32_16x16x32_bf16 v[140:143], a[140:143], a[44:47], v[140:143]
v_mfma_f32_16x16x32_bf16 v[148:151], a[136:139], a[48:51], v[148:151]
ds_read_b128 a[100:103], v3 offset:40960
v_mfma_f32_16x16x32_bf16 v[148:151], a[140:143], a[52:55], v[148:151]
v_mfma_f32_16x16x32_bf16 v[156:159], a[136:139], a[56:59], v[156:159]
ds_read_b128 a[104:107], v2 offset:43008
v_mfma_f32_16x16x32_bf16 v[156:159], a[140:143], a[60:63], v[156:159]
s_waitcnt lgkmcnt(3)
v_mfma_f32_16x16x32_bf16 v[160:163], a[128:131], a[0:3], v[160:163]
ds_read_b64_tr_b16 a[136:137], v9 offset:0
v_mfma_f32_16x16x32_bf16 v[160:163], a[132:135], a[4:7], v[160:163]
v_mfma_f32_16x16x32_bf16 v[168:171], a[128:131], a[8:11], v[168:171]
ds_read_b64_tr_b16 a[138:139], v9 offset:2048
v_mfma_f32_16x16x32_bf16 v[168:171], a[132:135], a[12:15], v[168:171]
buffer_store_dwordx4 a[180:183], v224, s[4:7], s56 offen sc1
v_mfma_f32_16x16x32_bf16 v[176:179], a[128:131], a[16:19], v[176:179]
s_add_u32 s56, s56, 33792
ds_read_b64_tr_b16 a[140:141], v9 offset:16384
v_mfma_f32_16x16x32_bf16 v[176:179], a[132:135], a[20:23], v[176:179]
v_mfma_f32_16x16x32_bf16 v[184:187], a[128:131], a[24:27], v[184:187]
ds_read_b64_tr_b16 a[142:143], v9 offset:18432
v_mfma_f32_16x16x32_bf16 v[184:187], a[132:135], a[28:31], v[184:187]
v_mfma_f32_16x16x32_bf16 v[192:195], a[128:131], a[32:35], v[192:195]
v_mfma_f32_16x16x32_bf16 v[192:195], a[132:135], a[36:39], v[192:195]
v_mfma_f32_16x16x32_bf16 v[200:203], a[128:131], a[40:43], v[200:203]
ds_read_b128 a[108:111], v3 offset:43008
v_mfma_f32_16x16x32_bf16 v[200:203], a[132:135], a[44:47], v[200:203]
v_mfma_f32_16x16x32_bf16 v[208:211], a[128:131], a[48:51], v[208:211]
ds_read_b128 a[112:115], v2 offset:45056
v_mfma_f32_16x16x32_bf16 v[208:211], a[132:135], a[52:55], v[208:211]
v_mfma_f32_16x16x32_bf16 v[216:219], a[128:131], a[56:59], v[216:219]
v_mfma_f32_16x16x32_bf16 v[216:219], a[132:135], a[60:63], v[216:219]
s_waitcnt lgkmcnt(2)
v_mfma_f32_16x16x32_bf16 v[164:167], a[136:139], a[0:3], v[164:167]
ds_read_b64_tr_b16 a[128:129], v10 offset:0
v_mfma_f32_16x16x32_bf16 v[164:167], a[140:143], a[4:7], v[164:167]
v_mfma_f32_16x16x32_bf16 v[172:175], a[136:139], a[8:11], v[172:175]
ds_read_b64_tr_b16 a[130:131], v10 offset:2048
v_mfma_f32_16x16x32_bf16 v[172:175], a[140:143], a[12:15], v[172:175]
v_mfma_f32_16x16x32_bf16 v[180:183], a[136:139], a[16:19], v[180:183]
ds_read_b64_tr_b16 a[132:133], v10 offset:16384
v_mfma_f32_16x16x32_bf16 v[180:183], a[140:143], a[20:23], v[180:183]
buffer_store_dwordx4 a[184:187], v224, s[4:7], s56 offen sc1
v_mfma_f32_16x16x32_bf16 v[188:191], a[136:139], a[24:27], v[188:191]
s_add_u32 s56, s56, 33792
ds_read_b64_tr_b16 a[134:135], v10 offset:18432
v_mfma_f32_16x16x32_bf16 v[188:191], a[140:143], a[28:31], v[188:191]
v_mfma_f32_16x16x32_bf16 v[196:199], a[136:139], a[32:35], v[196:199]
ds_read_b128 a[116:119], v3 offset:45056
v_mfma_f32_16x16x32_bf16 v[196:199], a[140:143], a[36:39], v[196:199]
v_mfma_f32_16x16x32_bf16 v[204:207], a[136:139], a[40:43], v[204:207]
ds_read_b128 a[120:123], v2 offset:47104
v_mfma_f32_16x16x32_bf16 v[204:207], a[140:143], a[44:47], v[204:207]
v_mfma_f32_16x16x32_bf16 v[212:215], a[136:139], a[48:51], v[212:215]
v_mfma_f32_16x16x32_bf16 v[212:215], a[140:143], a[52:55], v[212:215]
v_mfma_f32_16x16x32_bf16 v[220:223], a[136:139], a[56:59], v[220:223]
ds_read_b128 a[124:127], v3 offset:47104
v_mfma_f32_16x16x32_bf16 v[220:223], a[140:143], a[60:63], v[220:223]
s_waitcnt lgkmcnt(3)
v_mfma_f32_16x16x32_bf16 a[192:195], a[128:131], a[0:3], a[192:195]
ds_read_b64_tr_b16 a[136:137], v11 offset:0
v_mfma_f32_16x16x32_bf16 a[192:195], a[132:135], a[4:7], a[192:195]
v_mfma_f32_16x16x32_bf16 a[200:203], a[128:131], a[8:11], a[200:203]
ds_read_b64_tr_b16 a[138:139], v11 offset:2048
v_mfma_f32_16x16x32_bf16 a[200:203], a[132:135], a[12:15], a[200:203]
v_mfma_f32_16x16x32_bf16 a[208:211], a[128:131], a[16:19], a[208:211]
ds_read_b64_tr_b16 a[140:141], v11 offset:16384
v_mfma_f32_16x16x32_bf16 a[208:211], a[132:135], a[20:23], a[208:211]
v_mfma_f32_16x16x32_bf16 a[216:219], a[128:131], a[24:27], a[216:219]
ds_read_b64_tr_b16 a[142:143], v11 offset:18432
v_mfma_f32_16x16x32_bf16 a[216:219], a[132:135], a[28:31], a[216:219]
buffer_store_dwordx4 a[188:191], v224, s[4:7], s56 offen sc1
v_mfma_f32_16x16x32_bf16 a[224:227], a[128:131], a[32:35], a[224:227]
s_add_u32 s56, s56, 33792
v_mfma_f32_16x16x32_bf16 a[224:227], a[132:135], a[36:39], a[224:227]
v_mfma_f32_16x16x32_bf16 a[232:235], a[128:131], a[40:43], a[232:235]
v_mfma_f32_16x16x32_bf16 a[232:235], a[132:135], a[44:47], a[232:235]
v_mfma_f32_16x16x32_bf16 a[240:243], a[128:131], a[48:51], a[240:243]
v_mfma_f32_16x16x32_bf16 a[240:243], a[132:135], a[52:55], a[240:243]
v_mfma_f32_16x16x32_bf16 a[248:251], a[128:131], a[56:59], a[248:251]
s_waitcnt vmcnt(4) lgkmcnt(0)
v_mfma_f32_16x16x32_bf16 a[248:251], a[132:135], a[60:63], a[248:251]
s_barrier
v_mfma_f32_16x16x32_bf16 a[196:199], a[136:139], a[0:3], a[196:199]
s_add_u32 m0, s29, 65536
ds_read_b64_tr_b16 a[128:129], v4 offset:32768
v_mfma_f32_16x16x32_bf16 a[196:199], a[140:143], a[4:7], a[196:199]
buffer_load_dwordx4 v16, s[12:15], s26 offen offset:0 lds
v_mfma_f32_16x16x32_bf16 a[204:207], a[136:139], a[8:11], a[204:207]
ds_read_b64_tr_b16 a[130:131], v4 offset:34816
v_cmp_gt_u32 vcc, 0x100, v245
v_mfma_f32_16x16x32_bf16 a[204:207], a[140:143], a[12:15], a[204:207]
v_mfma_f32_16x16x32_bf16 a[212:215], a[136:139], a[16:19], a[212:215]
ds_read_b64_tr_b16 a[132:133], v4 offset:49152
v_mfma_f32_16x16x32_bf16 a[212:215], a[140:143], a[20:23], a[212:215]
buffer_load_dwordx4 v17, s[12:15], s26 offen offset:1024 lds
v_mfma_f32_16x16x32_bf16 a[220:223], a[136:139], a[24:27], a[220:223]
ds_read_b64_tr_b16 a[134:135], v4 offset:51200
v_mfma_f32_16x16x32_bf16 a[220:223], a[140:143], a[28:31], a[220:223]
v_mfma_f32_16x16x32_bf16 a[228:231], a[136:139], a[32:35], a[228:231]
v_mfma_f32_16x16x32_bf16 a[228:231], a[140:143], a[36:39], a[228:231]
buffer_load_dwordx4 v18, s[12:15], s26 offen offset:2048 lds
v_mfma_f32_16x16x32_bf16 a[236:239], a[136:139], a[40:43], a[236:239]
v_mfma_f32_16x16x32_bf16 a[236:239], a[140:143], a[44:47], a[236:239]
v_mfma_f32_16x16x32_bf16 a[244:247], a[136:139], a[48:51], a[244:247]
v_mfma_f32_16x16x32_bf16 a[244:247], a[140:143], a[52:55], a[244:247]
buffer_load_dwordx4 v19, s[12:15], s26 offen offset:3072 lds
v_mfma_f32_16x16x32_bf16 a[252:255], a[136:139], a[56:59], a[252:255]
s_add_u32 s26, s26, 524288
v_mfma_f32_16x16x32_bf16 a[252:255], a[140:143], a[60:63], a[252:255]
s_waitcnt lgkmcnt(0)
s_mov_b32 s82, s59
s_cbranch_vccnz M_cntspinK
s_branch Lg_1
Lg_1t:
PAD_4:
s_cbranch_execz M_tret
buffer_load_dword v230, v231, s[4:7], s52 offen sc1
v_mfma_f32_16x16x32_bf16 v[32:35], a[128:131], a[64:67], v[32:35]
s_add_u32 m0, s29, 81920
ds_read_b64_tr_b16 a[136:137], v5 offset:32768
v_mfma_f32_16x16x32_bf16 v[32:35], a[132:135], a[68:71], v[32:35]
buffer_load_dwordx4 v16, s[12:15], s27 offen offset:0 lds
v_mfma_f32_16x16x32_bf16 v[40:43], a[128:131], a[72:75], v[40:43]
s_and_b32 s44, s3, 1
ds_read_b64_tr_b16 a[138:139], v5 offset:34816
v_mfma_f32_16x16x32_bf16 v[40:43], a[132:135], a[76:79], v[40:43]
s_lshl_b32 s44, s44, 8
v_mfma_f32_16x16x32_bf16 v[48:51], a[128:131], a[80:83], v[48:51]
s_lshl_b32 s45, s3, 7
ds_read_b64_tr_b16 a[140:141], v5 offset:49152
v_mfma_f32_16x16x32_bf16 v[48:51], a[132:135], a[84:87], v[48:51]
s_xor_b32 s44, s44, s45
buffer_load_dwordx4 v17, s[12:15], s27 offen offset:1024 lds
v_mfma_f32_16x16x32_bf16 v[56:59], a[128:131], a[88:91], v[56:59]
s_xor_b32 s44, s44, 196608
ds_read_b64_tr_b16 a[142:143], v5 offset:51200
v_mfma_f32_16x16x32_bf16 v[56:59], a[132:135], a[92:95], v[56:59]
v_mfma_f32_16x16x32_bf16 v[64:67], a[128:131], a[96:99], v[64:67]
ds_read_b128 a[0:3], v2 offset:0
v_mfma_f32_16x16x32_bf16 v[64:67], a[132:135], a[100:103], v[64:67]
buffer_load_dwordx4 v18, s[12:15], s27 offen offset:2048 lds
v_mfma_f32_16x16x32_bf16 v[72:75], a[128:131], a[104:107], v[72:75]
ds_read_b128 a[4:7], v3 offset:0
v_mfma_f32_16x16x32_bf16 v[72:75], a[132:135], a[108:111], v[72:75]
v_mfma_f32_16x16x32_bf16 v[80:83], a[128:131], a[112:115], v[80:83]
v_mfma_f32_16x16x32_bf16 v[80:83], a[132:135], a[116:119], v[80:83]
buffer_load_dwordx4 v19, s[12:15], s27 offen offset:3072 lds
v_mfma_f32_16x16x32_bf16 v[88:91], a[128:131], a[120:123], v[88:91]
s_add_u32 s27, s27, 524288
ds_read_b128 a[8:11], v2 offset:2048
v_mfma_f32_16x16x32_bf16 v[88:91], a[132:135], a[124:127], v[88:91]
s_waitcnt lgkmcnt(3)
v_mfma_f32_16x16x32_bf16 v[36:39], a[136:139], a[64:67], v[36:39]
s_add_u32 m0, s28, 32768
ds_read_b64_tr_b16 a[128:129], v6 offset:32768
v_mfma_f32_16x16x32_bf16 v[36:39], a[140:143], a[68:71], v[36:39]
buffer_load_dwordx4 v12, s[8:11], s24 offen offset:0 lds
v_mfma_f32_16x16x32_bf16 v[44:47], a[136:139], a[72:75], v[44:47]
ds_read_b64_tr_b16 a[130:131], v6 offset:34816
v_mfma_f32_16x16x32_bf16 v[44:47], a[140:143], a[76:79], v[44:47]
v_mfma_f32_16x16x32_bf16 v[52:55], a[136:139], a[80:83], v[52:55]
s_mov_b64 s[56:57], s[72:73]
ds_read_b64_tr_b16 a[132:133], v6 offset:49152
v_mfma_f32_16x16x32_bf16 v[52:55], a[140:143], a[84:87], v[52:55]
s_mov_b32 s58, 1835008
buffer_load_dwordx4 v13, s[8:11], s24 offen offset:1024 lds
v_mfma_f32_16x16x32_bf16 v[60:63], a[136:139], a[88:91], v[60:63]
s_mov_b32 s59, 0x20000
ds_read_b64_tr_b16 a[134:135], v6 offset:51200
v_mfma_f32_16x16x32_bf16 v[60:63], a[140:143], a[92:95], v[60:63]
v_mfma_f32_16x16x32_bf16 v[68:71], a[136:139], a[96:99], v[68:71]
ds_read_b128 a[12:15], v3 offset:2048
v_mfma_f32_16x16x32_bf16 v[68:71], a[140:143], a[100:103], v[68:71]
buffer_load_dwordx4 v14, s[8:11], s24 offen offset:2048 lds
v_mfma_f32_16x16x32_bf16 v[76:79], a[136:139], a[104:107], v[76:79]
v_mfma_f32_16x16x32_bf16 v[76:79], a[140:143], a[108:111], v[76:79]
v_mfma_f32_16x16x32_bf16 v[84:87], a[136:139], a[112:115], v[84:87]
ds_read_b128 a[16:19], v2 offset:4096
v_mfma_f32_16x16x32_bf16 v[84:87], a[140:143], a[116:119], v[84:87]
buffer_load_dwordx4 v15, s[8:11], s24 offen offset:3072 lds
v_mfma_f32_16x16x32_bf16 v[92:95], a[136:139], a[120:123], v[92:95]
s_add_u32 s24, s24, 128
ds_read_b128 a[20:23], v3 offset:4096
v_mfma_f32_16x16x32_bf16 v[92:95], a[140:143], a[124:127], v[92:95]
s_waitcnt lgkmcnt(3)
v_mfma_f32_16x16x32_bf16 v[96:99], a[128:131], a[64:67], v[96:99]
s_add_u32 m0, s28, 36864
ds_read_b64_tr_b16 a[136:137], v7 offset:32768
v_mfma_f32_16x16x32_bf16 v[96:99], a[132:135], a[68:71], v[96:99]
buffer_load_dwordx4 v12, s[8:11], s25 offen offset:0 lds
v_mfma_f32_16x16x32_bf16 v[104:107], a[128:131], a[72:75], v[104:107]
ds_read_b64_tr_b16 a[138:139], v7 offset:34816
v_mfma_f32_16x16x32_bf16 v[104:107], a[132:135], a[76:79], v[104:107]
v_mfma_f32_16x16x32_bf16 v[112:115], a[128:131], a[80:83], v[112:115]
ds_read_b64_tr_b16 a[140:141], v7 offset:49152
v_mfma_f32_16x16x32_bf16 v[112:115], a[132:135], a[84:87], v[112:115]
buffer_load_dwordx4 v13, s[8:11], s25 offen offset:1024 lds
v_mfma_f32_16x16x32_bf16 v[120:123], a[128:131], a[88:91], v[120:123]
ds_read_b64_tr_b16 a[142:143], v7 offset:51200
v_mfma_f32_16x16x32_bf16 v[120:123], a[132:135], a[92:95], v[120:123]
v_mfma_f32_16x16x32_bf16 v[128:131], a[128:131], a[96:99], v[128:131]
v_mfma_f32_16x16x32_bf16 v[128:131], a[132:135], a[100:103], v[128:131]
buffer_load_dwordx4 v14, s[8:11], s25 offen offset:2048 lds
v_mfma_f32_16x16x32_bf16 v[136:139], a[128:131], a[104:107], v[136:139]
ds_read_b128 a[24:27], v2 offset:6144
v_mfma_f32_16x16x32_bf16 v[136:139], a[132:135], a[108:111], v[136:139]
v_mfma_f32_16x16x32_bf16 v[144:147], a[128:131], a[112:115], v[144:147]
ds_read_b128 a[28:31], v3 offset:6144
v_mfma_f32_16x16x32_bf16 v[144:147], a[132:135], a[116:119], v[144:147]
buffer_load_dwordx4 v15, s[8:11], s25 offen offset:3072 lds
v_mfma_f32_16x16x32_bf16 v[152:155], a[128:131], a[120:123], v[152:155]
s_add_u32 s25, s25, 128
s_waitcnt vmcnt(12)
v_mfma_f32_16x16x32_bf16 v[152:155], a[132:135], a[124:127], v[152:155]
s_waitcnt lgkmcnt(2)
v_cmp_gt_u32 vcc, 1, v230
v_mfma_f32_16x16x32_bf16 v[100:103], a[136:139], a[64:67], v[100:103]
s_cbranch_vccnz M_ppspinK
M_ppokK:
ds_read_b64_tr_b16 a[128:129], v8 offset:32768
v_mfma_f32_16x16x32_bf16 v[100:103], a[140:143], a[68:71], v[100:103]
buffer_load_dword v230, v229, s[4:7], s53 offen sc1
v_mfma_f32_16x16x32_bf16 v[108:111], a[136:139], a[72:75], v[108:111]
s_mov_b64 s[8:9], s[76:77]
ds_read_b64_tr_b16 a[130:131], v8 offset:34816
v_mfma_f32_16x16x32_bf16 v[108:111], a[140:143], a[76:79], v[108:111]
s_mov_b32 s10, 1835008
buffer_load_dword v230, v229, s[4:7], s48 offen sc1
v_mfma_f32_16x16x32_bf16 v[116:119], a[136:139], a[80:83], v[116:119]
s_lshl_b32 s24, s37, 2
ds_read_b64_tr_b16 a[132:133], v8 offset:49152
v_mfma_f32_16x16x32_bf16 v[116:119], a[140:143], a[84:87], v[116:119]
s_add_u32 s24, s24, s3
buffer_load_dword v230, v229, s[56:59], s49 offen
v_mfma_f32_16x16x32_bf16 v[124:127], a[136:139], a[88:91], v[124:127]
s_mul_i32 s24, s24, 28672
ds_read_b64_tr_b16 a[134:135], v8 offset:51200
v_mfma_f32_16x16x32_bf16 v[124:127], a[140:143], a[92:95], v[124:127]
s_mov_b32 s28, s29
buffer_load_dword v21, v20, s[16:19], s43 offen
v_mfma_f32_16x16x32_bf16 v[132:135], a[136:139], a[96:99], v[132:135]
ds_read_b128 a[32:35], v2 offset:8192
v_mfma_f32_16x16x32_bf16 v[132:135], a[140:143], a[100:103], v[132:135]
v_mfma_f32_16x16x32_bf16 v[140:143], a[136:139], a[104:107], v[140:143]
v_mfma_f32_16x16x32_bf16 v[140:143], a[140:143], a[108:111], v[140:143]
v_mfma_f32_16x16x32_bf16 v[148:151], a[136:139], a[112:115], v[148:151]
ds_read_b128 a[36:39], v3 offset:8192
v_lshrrev_b32 v28, 7, v1
v_mfma_f32_16x16x32_bf16 v[148:151], a[140:143], a[116:119], v[148:151]
v_lshrrev_b32 v29, 1, v28
v_lshlrev_b32 v29, 4, v29
v_mfma_f32_16x16x32_bf16 v[156:159], a[136:139], a[120:123], v[156:159]
ds_read_b128 a[40:43], v2 offset:10240
v_and_b32 v30, 0x70, v1
v_mfma_f32_16x16x32_bf16 v[156:159], a[140:143], a[124:127], v[156:159]
s_waitcnt lgkmcnt(3)
v_xor_b32 v29, v29, v30
v_mul_u32_u24 v28, 896, v28
v_mfma_f32_16x16x32_bf16 v[160:163], a[128:131], a[64:67], v[160:163]
ds_read_b64_tr_b16 a[136:137], v9 offset:32768
v_add_u32 v12, v28, v29
v_mfma_f32_16x16x32_bf16 v[160:163], a[132:135], a[68:71], v[160:163]
v_xor_b32 v29, 64, v29
v_add_u32 v28, v28, v29
v_mfma_f32_16x16x32_bf16 v[168:171], a[128:131], a[72:75], v[168:171]
ds_read_b64_tr_b16 a[138:139], v9 offset:34816
v_add_u32 v13, 6144, v28
v_mfma_f32_16x16x32_bf16 v[168:171], a[132:135], a[76:79], v[168:171]
v_add_u32 v14, 12288, v12
v_add_u32 v15, 18432, v28
v_mfma_f32_16x16x32_bf16 v[176:179], a[128:131], a[80:83], v[176:179]
ds_read_b64_tr_b16 a[140:141], v9 offset:49152
v_xor_b32 v22, s44, v4
v_mfma_f32_16x16x32_bf16 v[176:179], a[132:135], a[84:87], v[176:179]
v_xor_b32 v23, 32, v22
v_xor_b32 v24, 64, v22
v_mfma_f32_16x16x32_bf16 v[184:187], a[128:131], a[88:91], v[184:187]
ds_read_b64_tr_b16 a[142:143], v9 offset:51200
v_xor_b32 v25, 96, v22
v_mfma_f32_16x16x32_bf16 v[184:187], a[132:135], a[92:95], v[184:187]
v_mfma_f32_16x16x32_bf16 v[192:195], a[128:131], a[96:99], v[192:195]
v_mfma_f32_16x16x32_bf16 v[192:195], a[132:135], a[100:103], v[192:195]
v_mfma_f32_16x16x32_bf16 v[200:203], a[128:131], a[104:107], v[200:203]
ds_read_b128 a[44:47], v3 offset:10240
v_mfma_f32_16x16x32_bf16 v[200:203], a[132:135], a[108:111], v[200:203]
v_mfma_f32_16x16x32_bf16 v[208:211], a[128:131], a[112:115], v[208:211]
ds_read_b128 a[48:51], v2 offset:12288
v_mfma_f32_16x16x32_bf16 v[208:211], a[132:135], a[116:119], v[208:211]
v_mfma_f32_16x16x32_bf16 v[216:219], a[128:131], a[120:123], v[216:219]
v_mfma_f32_16x16x32_bf16 v[216:219], a[132:135], a[124:127], v[216:219]
s_waitcnt lgkmcnt(2)
v_mfma_f32_16x16x32_bf16 v[164:167], a[136:139], a[64:67], v[164:167]
ds_read_b64_tr_b16 a[128:129], v10 offset:32768
v_mfma_f32_16x16x32_bf16 v[164:167], a[140:143], a[68:71], v[164:167]
v_mfma_f32_16x16x32_bf16 v[172:175], a[136:139], a[72:75], v[172:175]
ds_read_b64_tr_b16 a[130:131], v10 offset:34816
v_mfma_f32_16x16x32_bf16 v[172:175], a[140:143], a[76:79], v[172:175]
v_mfma_f32_16x16x32_bf16 v[180:183], a[136:139], a[80:83], v[180:183]
ds_read_b64_tr_b16 a[132:133], v10 offset:49152
v_mfma_f32_16x16x32_bf16 v[180:183], a[140:143], a[84:87], v[180:183]
v_mfma_f32_16x16x32_bf16 v[188:191], a[136:139], a[88:91], v[188:191]
ds_read_b64_tr_b16 a[134:135], v10 offset:51200
v_mfma_f32_16x16x32_bf16 v[188:191], a[140:143], a[92:95], v[188:191]
v_mfma_f32_16x16x32_bf16 v[196:199], a[136:139], a[96:99], v[196:199]
ds_read_b128 a[52:55], v3 offset:12288
v_mfma_f32_16x16x32_bf16 v[196:199], a[140:143], a[100:103], v[196:199]
v_mfma_f32_16x16x32_bf16 v[204:207], a[136:139], a[104:107], v[204:207]
ds_read_b128 a[56:59], v2 offset:14336
v_mfma_f32_16x16x32_bf16 v[204:207], a[140:143], a[108:111], v[204:207]
v_mfma_f32_16x16x32_bf16 v[212:215], a[136:139], a[112:115], v[212:215]
v_mfma_f32_16x16x32_bf16 v[212:215], a[140:143], a[116:119], v[212:215]
v_mfma_f32_16x16x32_bf16 v[220:223], a[136:139], a[120:123], v[220:223]
ds_read_b128 a[60:63], v3 offset:14336
v_mfma_f32_16x16x32_bf16 v[220:223], a[140:143], a[124:127], v[220:223]
s_waitcnt lgkmcnt(3)
v_mfma_f32_16x16x32_bf16 a[192:195], a[128:131], a[64:67], a[192:195]
ds_read_b64_tr_b16 a[136:137], v11 offset:32768
v_mfma_f32_16x16x32_bf16 a[192:195], a[132:135], a[68:71], a[192:195]
v_mfma_f32_16x16x32_bf16 a[200:203], a[128:131], a[72:75], a[200:203]
ds_read_b64_tr_b16 a[138:139], v11 offset:34816
v_mfma_f32_16x16x32_bf16 a[200:203], a[132:135], a[76:79], a[200:203]
v_mfma_f32_16x16x32_bf16 a[208:211], a[128:131], a[80:83], a[208:211]
ds_read_b64_tr_b16 a[140:141], v11 offset:49152
v_mfma_f32_16x16x32_bf16 a[208:211], a[132:135], a[84:87], a[208:211]
v_mfma_f32_16x16x32_bf16 a[216:219], a[128:131], a[88:91], a[216:219]
ds_read_b64_tr_b16 a[142:143], v11 offset:51200
v_mfma_f32_16x16x32_bf16 a[216:219], a[132:135], a[92:95], a[216:219]
v_mfma_f32_16x16x32_bf16 a[224:227], a[128:131], a[96:99], a[224:227]
v_mfma_f32_16x16x32_bf16 a[224:227], a[132:135], a[100:103], a[224:227]
v_mfma_f32_16x16x32_bf16 a[232:235], a[128:131], a[104:107], a[232:235]
v_mfma_f32_16x16x32_bf16 a[232:235], a[132:135], a[108:111], a[232:235]
v_mfma_f32_16x16x32_bf16 a[240:243], a[128:131], a[112:115], a[240:243]
v_mfma_f32_16x16x32_bf16 a[240:243], a[132:135], a[116:119], a[240:243]
v_mfma_f32_16x16x32_bf16 a[248:251], a[128:131], a[120:123], a[248:251]
s_waitcnt vmcnt(4) lgkmcnt(0)
v_mfma_f32_16x16x32_bf16 a[248:251], a[132:135], a[124:127], a[248:251]
s_barrier
v_mfma_f32_16x16x32_bf16 a[196:199], a[136:139], a[64:67], a[196:199]
s_add_u32 m0, s29, 98304
ds_read_b64_tr_b16 a[128:129], v4 offset:0
v_mfma_f32_16x16x32_bf16 a[196:199], a[140:143], a[68:71], a[196:199]
buffer_load_dwordx4 v16, s[12:15], s26 offen offset:0 lds
v_mfma_f32_16x16x32_bf16 a[204:207], a[136:139], a[72:75], a[204:207]
ds_read_b64_tr_b16 a[130:131], v4 offset:2048
v_mfma_f32_16x16x32_bf16 a[204:207], a[140:143], a[76:79], a[204:207]
v_mfma_f32_16x16x32_bf16 a[212:215], a[136:139], a[80:83], a[212:215]
ds_read_b64_tr_b16 a[132:133], v4 offset:16384
v_mfma_f32_16x16x32_bf16 a[212:215], a[140:143], a[84:87], a[212:215]
buffer_load_dwordx4 v17, s[12:15], s26 offen offset:1024 lds
v_mfma_f32_16x16x32_bf16 a[220:223], a[136:139], a[88:91], a[220:223]
ds_read_b64_tr_b16 a[134:135], v4 offset:18432
v_mfma_f32_16x16x32_bf16 a[220:223], a[140:143], a[92:95], a[220:223]
v_mfma_f32_16x16x32_bf16 a[228:231], a[136:139], a[96:99], a[228:231]
v_mfma_f32_16x16x32_bf16 a[228:231], a[140:143], a[100:103], a[228:231]
buffer_load_dwordx4 v18, s[12:15], s26 offen offset:2048 lds
v_mfma_f32_16x16x32_bf16 a[236:239], a[136:139], a[104:107], a[236:239]
v_mfma_f32_16x16x32_bf16 a[236:239], a[140:143], a[108:111], a[236:239]
v_mfma_f32_16x16x32_bf16 a[244:247], a[136:139], a[112:115], a[244:247]
v_mfma_f32_16x16x32_bf16 a[244:247], a[140:143], a[116:119], a[244:247]
buffer_load_dwordx4 v19, s[12:15], s26 offen offset:3072 lds
v_mfma_f32_16x16x32_bf16 a[252:255], a[136:139], a[120:123], a[252:255]
s_add_u32 s26, s26, 524288
v_mfma_f32_16x16x32_bf16 a[252:255], a[140:143], a[124:127], a[252:255]
s_waitcnt lgkmcnt(0)
v_mfma_f32_16x16x32_bf16 v[32:35], a[128:131], a[0:3], v[32:35]
s_add_u32 m0, s29, 114688
ds_read_b64_tr_b16 a[136:137], v5 offset:0
v_mfma_f32_16x16x32_bf16 v[32:35], a[132:135], a[4:7], v[32:35]
buffer_load_dwordx4 v16, s[12:15], s27 offen offset:0 lds
v_mfma_f32_16x16x32_bf16 v[40:43], a[128:131], a[8:11], v[40:43]
ds_read_b64_tr_b16 a[138:139], v5 offset:2048
v_mfma_f32_16x16x32_bf16 v[40:43], a[132:135], a[12:15], v[40:43]
v_mfma_f32_16x16x32_bf16 v[48:51], a[128:131], a[16:19], v[48:51]
ds_read_b64_tr_b16 a[140:141], v5 offset:16384
v_mfma_f32_16x16x32_bf16 v[48:51], a[132:135], a[20:23], v[48:51]
buffer_load_dwordx4 v17, s[12:15], s27 offen offset:1024 lds
v_mfma_f32_16x16x32_bf16 v[56:59], a[128:131], a[24:27], v[56:59]
ds_read_b64_tr_b16 a[142:143], v5 offset:18432
v_mfma_f32_16x16x32_bf16 v[56:59], a[132:135], a[28:31], v[56:59]
v_mfma_f32_16x16x32_bf16 v[64:67], a[128:131], a[32:35], v[64:67]
ds_read_b128 a[64:67], v2 offset:32768
v_mfma_f32_16x16x32_bf16 v[64:67], a[132:135], a[36:39], v[64:67]
buffer_load_dwordx4 v18, s[12:15], s27 offen offset:2048 lds
v_mfma_f32_16x16x32_bf16 v[72:75], a[128:131], a[40:43], v[72:75]
ds_read_b128 a[68:71], v3 offset:32768
v_mfma_f32_16x16x32_bf16 v[72:75], a[132:135], a[44:47], v[72:75]
v_mfma_f32_16x16x32_bf16 v[80:83], a[128:131], a[48:51], v[80:83]
v_mfma_f32_16x16x32_bf16 v[80:83], a[132:135], a[52:55], v[80:83]
buffer_load_dwordx4 v19, s[12:15], s27 offen offset:3072 lds
v_mfma_f32_16x16x32_bf16 v[88:91], a[128:131], a[56:59], v[88:91]
s_add_u32 s27, s27, 524288
ds_read_b128 a[72:75], v2 offset:34816
v_mfma_f32_16x16x32_bf16 v[88:91], a[132:135], a[60:63], v[88:91]
s_waitcnt lgkmcnt(3)
v_mfma_f32_16x16x32_bf16 v[36:39], a[136:139], a[0:3], v[36:39]
s_add_u32 m0, s28, 0
ds_read_b64_tr_b16 a[128:129], v6 offset:0
v_mfma_f32_16x16x32_bf16 v[36:39], a[140:143], a[4:7], v[36:39]
buffer_load_dwordx4 v12, s[8:11], s24 offen offset:0 lds
v_mfma_f32_16x16x32_bf16 v[44:47], a[136:139], a[8:11], v[44:47]
ds_read_b64_tr_b16 a[130:131], v6 offset:2048
v_mfma_f32_16x16x32_bf16 v[44:47], a[140:143], a[12:15], v[44:47]
v_mfma_f32_16x16x32_bf16 v[52:55], a[136:139], a[16:19], v[52:55]
ds_read_b64_tr_b16 a[132:133], v6 offset:16384
v_mfma_f32_16x16x32_bf16 v[52:55], a[140:143], a[20:23], v[52:55]
buffer_load_dwordx4 v13, s[8:11], s24 offen offset:1024 lds
v_mfma_f32_16x16x32_bf16 v[60:63], a[136:139], a[24:27], v[60:63]
ds_read_b64_tr_b16 a[134:135], v6 offset:18432
v_mfma_f32_16x16x32_bf16 v[60:63], a[140:143], a[28:31], v[60:63]
v_mfma_f32_16x16x32_bf16 v[68:71], a[136:139], a[32:35], v[68:71]
ds_read_b128 a[76:79], v3 offset:34816
v_mfma_f32_16x16x32_bf16 v[68:71], a[140:143], a[36:39], v[68:71]
buffer_load_dwordx4 v14, s[8:11], s24 offen offset:2048 lds
v_mfma_f32_16x16x32_bf16 v[76:79], a[136:139], a[40:43], v[76:79]
v_mfma_f32_16x16x32_bf16 v[76:79], a[140:143], a[44:47], v[76:79]
v_mfma_f32_16x16x32_bf16 v[84:87], a[136:139], a[48:51], v[84:87]
ds_read_b128 a[80:83], v2 offset:36864
v_mfma_f32_16x16x32_bf16 v[84:87], a[140:143], a[52:55], v[84:87]
buffer_load_dwordx4 v15, s[8:11], s24 offen offset:3072 lds
v_mfma_f32_16x16x32_bf16 v[92:95], a[136:139], a[56:59], v[92:95]
s_add_u32 s24, s24, 128
ds_read_b128 a[84:87], v3 offset:36864
v_mfma_f32_16x16x32_bf16 v[92:95], a[140:143], a[60:63], v[92:95]
s_waitcnt lgkmcnt(3)
s_mov_b64 s[12:13], s[80:81]
v_mfma_f32_16x16x32_bf16 v[96:99], a[128:131], a[0:3], v[96:99]
s_mov_b32 s14, 3670016
s_add_u32 m0, s28, 16384
ds_read_b64_tr_b16 a[136:137], v7 offset:0
v_mfma_f32_16x16x32_bf16 v[96:99], a[132:135], a[4:7], v[96:99]
buffer_load_dwordx4 v12, s[8:11], s24 offen offset:0 lds
v_mfma_f32_16x16x32_bf16 v[104:107], a[128:131], a[8:11], v[104:107]
ds_read_b64_tr_b16 a[138:139], v7 offset:2048
v_mfma_f32_16x16x32_bf16 v[104:107], a[132:135], a[12:15], v[104:107]
v_mfma_f32_16x16x32_bf16 v[112:115], a[128:131], a[16:19], v[112:115]
ds_read_b64_tr_b16 a[140:141], v7 offset:16384
v_mfma_f32_16x16x32_bf16 v[112:115], a[132:135], a[20:23], v[112:115]
buffer_load_dwordx4 v13, s[8:11], s24 offen offset:1024 lds
v_mfma_f32_16x16x32_bf16 v[120:123], a[128:131], a[24:27], v[120:123]
ds_read_b64_tr_b16 a[142:143], v7 offset:18432
v_mfma_f32_16x16x32_bf16 v[120:123], a[132:135], a[28:31], v[120:123]
v_mfma_f32_16x16x32_bf16 v[128:131], a[128:131], a[32:35], v[128:131]
v_mfma_f32_16x16x32_bf16 v[128:131], a[132:135], a[36:39], v[128:131]
buffer_load_dwordx4 v14, s[8:11], s24 offen offset:2048 lds
v_mfma_f32_16x16x32_bf16 v[136:139], a[128:131], a[40:43], v[136:139]
ds_read_b128 a[88:91], v2 offset:38912
v_mfma_f32_16x16x32_bf16 v[136:139], a[132:135], a[44:47], v[136:139]
v_mfma_f32_16x16x32_bf16 v[144:147], a[128:131], a[48:51], v[144:147]
ds_read_b128 a[92:95], v3 offset:38912
v_mfma_f32_16x16x32_bf16 v[144:147], a[132:135], a[52:55], v[144:147]
buffer_load_dwordx4 v15, s[8:11], s24 offen offset:3072 lds
v_mfma_f32_16x16x32_bf16 v[152:155], a[128:131], a[56:59], v[152:155]
s_add_u32 s24, s24, 128
v_mfma_f32_16x16x32_bf16 v[152:155], a[132:135], a[60:63], v[152:155]
s_waitcnt lgkmcnt(2)
s_sub_u32 s26, s26, 8388608
v_mfma_f32_16x16x32_bf16 v[100:103], a[136:139], a[0:3], v[100:103]
s_sub_u32 s27, s27, 8388608
s_add_u32 m0, s29, 131072
ds_read_b64_tr_b16 a[128:129], v8 offset:0
v_mfma_f32_16x16x32_bf16 v[100:103], a[140:143], a[4:7], v[100:103]
PAD_5:
s_cbranch_execz M_tret
buffer_load_dwordx4 v16, s[12:15], s26 offen offset:0 lds
v_mfma_f32_16x16x32_bf16 v[108:111], a[136:139], a[8:11], v[108:111]
ds_read_b64_tr_b16 a[130:131], v8 offset:2048
v_mfma_f32_16x16x32_bf16 v[108:111], a[140:143], a[12:15], v[108:111]
v_mfma_f32_16x16x32_bf16 v[116:119], a[136:139], a[16:19], v[116:119]
ds_read_b64_tr_b16 a[132:133], v8 offset:16384
v_mfma_f32_16x16x32_bf16 v[116:119], a[140:143], a[20:23], v[116:119]
buffer_load_dwordx4 v17, s[12:15], s26 offen offset:1024 lds
v_mfma_f32_16x16x32_bf16 v[124:127], a[136:139], a[24:27], v[124:127]
ds_read_b64_tr_b16 a[134:135], v8 offset:18432
v_mfma_f32_16x16x32_bf16 v[124:127], a[140:143], a[28:31], v[124:127]
v_mfma_f32_16x16x32_bf16 v[132:135], a[136:139], a[32:35], v[132:135]
ds_read_b128 a[96:99], v2 offset:40960
v_mfma_f32_16x16x32_bf16 v[132:135], a[140:143], a[36:39], v[132:135]
buffer_load_dwordx4 v18, s[12:15], s26 offen offset:2048 lds
v_mfma_f32_16x16x32_bf16 v[140:143], a[136:139], a[40:43], v[140:143]
v_mfma_f32_16x16x32_bf16 v[140:143], a[140:143], a[44:47], v[140:143]
v_mfma_f32_16x16x32_bf16 v[148:151], a[136:139], a[48:51], v[148:151]
ds_read_b128 a[100:103], v3 offset:40960
v_mfma_f32_16x16x32_bf16 v[148:151], a[140:143], a[52:55], v[148:151]
buffer_load_dwordx4 v19, s[12:15], s26 offen offset:3072 lds
v_mfma_f32_16x16x32_bf16 v[156:159], a[136:139], a[56:59], v[156:159]
s_add_u32 s26, s26, 524288
ds_read_b128 a[104:107], v2 offset:43008
v_mfma_f32_16x16x32_bf16 v[156:159], a[140:143], a[60:63], v[156:159]
s_waitcnt lgkmcnt(3)
v_mfma_f32_16x16x32_bf16 v[160:163], a[128:131], a[0:3], v[160:163]
s_add_u32 m0, s29, 147456
ds_read_b64_tr_b16 a[136:137], v9 offset:0
v_mfma_f32_16x16x32_bf16 v[160:163], a[132:135], a[4:7], v[160:163]
buffer_load_dwordx4 v16, s[12:15], s27 offen offset:0 lds
v_mfma_f32_16x16x32_bf16 v[168:171], a[128:131], a[8:11], v[168:171]
ds_read_b64_tr_b16 a[138:139], v9 offset:2048
v_mfma_f32_16x16x32_bf16 v[168:171], a[132:135], a[12:15], v[168:171]
v_mfma_f32_16x16x32_bf16 v[176:179], a[128:131], a[16:19], v[176:179]
ds_read_b64_tr_b16 a[140:141], v9 offset:16384
v_mfma_f32_16x16x32_bf16 v[176:179], a[132:135], a[20:23], v[176:179]
buffer_load_dwordx4 v17, s[12:15], s27 offen offset:1024 lds
v_mfma_f32_16x16x32_bf16 v[184:187], a[128:131], a[24:27], v[184:187]
ds_read_b64_tr_b16 a[142:143], v9 offset:18432
v_mfma_f32_16x16x32_bf16 v[184:187], a[132:135], a[28:31], v[184:187]
v_mfma_f32_16x16x32_bf16 v[192:195], a[128:131], a[32:35], v[192:195]
v_mfma_f32_16x16x32_bf16 v[192:195], a[132:135], a[36:39], v[192:195]
buffer_load_dwordx4 v18, s[12:15], s27 offen offset:2048 lds
v_mfma_f32_16x16x32_bf16 v[200:203], a[128:131], a[40:43], v[200:203]
ds_read_b128 a[108:111], v3 offset:43008
v_mfma_f32_16x16x32_bf16 v[200:203], a[132:135], a[44:47], v[200:203]
v_mfma_f32_16x16x32_bf16 v[208:211], a[128:131], a[48:51], v[208:211]
ds_read_b128 a[112:115], v2 offset:45056
v_mfma_f32_16x16x32_bf16 v[208:211], a[132:135], a[52:55], v[208:211]
buffer_load_dwordx4 v19, s[12:15], s27 offen offset:3072 lds
v_mfma_f32_16x16x32_bf16 v[216:219], a[128:131], a[56:59], v[216:219]
s_add_u32 s27, s27, 524288
v_mfma_f32_16x16x32_bf16 v[216:219], a[132:135], a[60:63], v[216:219]
s_waitcnt lgkmcnt(2)
v_mfma_f32_16x16x32_bf16 v[164:167], a[136:139], a[0:3], v[164:167]
ds_read_b64_tr_b16 a[128:129], v10 offset:0
v_mfma_f32_16x16x32_bf16 v[164:167], a[140:143], a[4:7], v[164:167]
v_mfma_f32_16x16x32_bf16 v[172:175], a[136:139], a[8:11], v[172:175]
ds_read_b64_tr_b16 a[130:131], v10 offset:2048
v_mfma_f32_16x16x32_bf16 v[172:175], a[140:143], a[12:15], v[172:175]
v_mfma_f32_16x16x32_bf16 v[180:183], a[136:139], a[16:19], v[180:183]
ds_read_b64_tr_b16 a[132:133], v10 offset:16384
v_mfma_f32_16x16x32_bf16 v[180:183], a[140:143], a[20:23], v[180:183]
v_mfma_f32_16x16x32_bf16 v[188:191], a[136:139], a[24:27], v[188:191]
ds_read_b64_tr_b16 a[134:135], v10 offset:18432
v_mfma_f32_16x16x32_bf16 v[188:191], a[140:143], a[28:31], v[188:191]
v_mfma_f32_16x16x32_bf16 v[196:199], a[136:139], a[32:35], v[196:199]
ds_read_b128 a[116:119], v3 offset:45056
v_mfma_f32_16x16x32_bf16 v[196:199], a[140:143], a[36:39], v[196:199]
v_mfma_f32_16x16x32_bf16 v[204:207], a[136:139], a[40:43], v[204:207]
ds_read_b128 a[120:123], v2 offset:47104
v_mfma_f32_16x16x32_bf16 v[204:207], a[140:143], a[44:47], v[204:207]
v_mfma_f32_16x16x32_bf16 v[212:215], a[136:139], a[48:51], v[212:215]
v_mfma_f32_16x16x32_bf16 v[212:215], a[140:143], a[52:55], v[212:215]
v_mfma_f32_16x16x32_bf16 v[220:223], a[136:139], a[56:59], v[220:223]
ds_read_b128 a[124:127], v3 offset:47104
v_mfma_f32_16x16x32_bf16 v[220:223], a[140:143], a[60:63], v[220:223]
s_waitcnt lgkmcnt(3)
v_mfma_f32_16x16x32_bf16 a[192:195], a[128:131], a[0:3], a[192:195]
ds_read_b64_tr_b16 a[136:137], v11 offset:0
v_mfma_f32_16x16x32_bf16 a[192:195], a[132:135], a[4:7], a[192:195]
v_mfma_f32_16x16x32_bf16 a[200:203], a[128:131], a[8:11], a[200:203]
ds_read_b64_tr_b16 a[138:139], v11 offset:2048
v_mfma_f32_16x16x32_bf16 a[200:203], a[132:135], a[12:15], a[200:203]
v_mfma_f32_16x16x32_bf16 a[208:211], a[128:131], a[16:19], a[208:211]
ds_read_b64_tr_b16 a[140:141], v11 offset:16384
v_mfma_f32_16x16x32_bf16 a[208:211], a[132:135], a[20:23], a[208:211]
v_mfma_f32_16x16x32_bf16 a[216:219], a[128:131], a[24:27], a[216:219]
ds_read_b64_tr_b16 a[142:143], v11 offset:18432
v_mfma_f32_16x16x32_bf16 a[216:219], a[132:135], a[28:31], a[216:219]
v_mfma_f32_16x16x32_bf16 a[224:227], a[128:131], a[32:35], a[224:227]
v_mfma_f32_16x16x32_bf16 a[224:227], a[132:135], a[36:39], a[224:227]
v_mfma_f32_16x16x32_bf16 a[232:235], a[128:131], a[40:43], a[232:235]
v_mfma_f32_16x16x32_bf16 a[232:235], a[132:135], a[44:47], a[232:235]
v_mfma_f32_16x16x32_bf16 a[240:243], a[128:131], a[48:51], a[240:243]
v_mfma_f32_16x16x32_bf16 a[240:243], a[132:135], a[52:55], a[240:243]
v_mfma_f32_16x16x32_bf16 a[248:251], a[128:131], a[56:59], a[248:251]
s_waitcnt vmcnt(12) lgkmcnt(0)
v_mfma_f32_16x16x32_bf16 a[248:251], a[132:135], a[60:63], a[248:251]
s_barrier
v_mfma_f32_16x16x32_bf16 a[196:199], a[136:139], a[0:3], a[196:199]
s_add_u32 m0, s28, 32768
ds_read_b64_tr_b16 a[128:129], v4 offset:32768
v_mfma_f32_16x16x32_bf16 a[196:199], a[140:143], a[4:7], a[196:199]
s_lshr_b32 s22, s3, 1
buffer_load_dwordx4 v12, s[8:11], s24 offen offset:0 lds
v_mfma_f32_16x16x32_bf16 a[204:207], a[136:139], a[8:11], a[204:207]
s_lshl_b32 s22, s22, 14
ds_read_b64_tr_b16 a[130:131], v4 offset:34816
v_subrev_u32 v2, s22, v2
v_mfma_f32_16x16x32_bf16 a[204:207], a[140:143], a[12:15], a[204:207]
v_subrev_u32 v3, s22, v3
v_mfma_f32_16x16x32_bf16 a[212:215], a[136:139], a[16:19], a[212:215]
ds_read_b64_tr_b16 a[132:133], v4 offset:49152
v_mfma_f32_16x16x32_bf16 a[212:215], a[140:143], a[20:23], a[212:215]
buffer_load_dwordx4 v13, s[8:11], s24 offen offset:1024 lds
v_mfma_f32_16x16x32_bf16 a[220:223], a[136:139], a[24:27], a[220:223]
ds_read_b64_tr_b16 a[134:135], v4 offset:51200
v_mfma_f32_16x16x32_bf16 a[220:223], a[140:143], a[28:31], a[220:223]
v_mfma_f32_16x16x32_bf16 a[228:231], a[136:139], a[32:35], a[228:231]
v_mfma_f32_16x16x32_bf16 a[228:231], a[140:143], a[36:39], a[228:231]
buffer_load_dwordx4 v14, s[8:11], s24 offen offset:2048 lds
v_mfma_f32_16x16x32_bf16 a[236:239], a[136:139], a[40:43], a[236:239]
v_mfma_f32_16x16x32_bf16 a[236:239], a[140:143], a[44:47], a[236:239]
v_mfma_f32_16x16x32_bf16 a[244:247], a[136:139], a[48:51], a[244:247]
v_mfma_f32_16x16x32_bf16 a[244:247], a[140:143], a[52:55], a[244:247]
buffer_load_dwordx4 v15, s[8:11], s24 offen offset:3072 lds
v_mfma_f32_16x16x32_bf16 a[252:255], a[136:139], a[56:59], a[252:255]
s_add_u32 s24, s24, 128
v_mfma_f32_16x16x32_bf16 a[252:255], a[140:143], a[60:63], a[252:255]
s_waitcnt lgkmcnt(0)
v_mfma_f32_16x16x32_bf16 v[32:35], a[128:131], a[64:67], v[32:35]
s_add_u32 m0, s29, 65536
ds_read_b64_tr_b16 a[136:137], v5 offset:32768
v_mfma_f32_16x16x32_bf16 v[32:35], a[132:135], a[68:71], v[32:35]
buffer_load_dwordx4 v16, s[12:15], s26 offen offset:0 lds
v_mfma_f32_16x16x32_bf16 v[40:43], a[128:131], a[72:75], v[40:43]
ds_read_b64_tr_b16 a[138:139], v5 offset:34816
v_mfma_f32_16x16x32_bf16 v[40:43], a[132:135], a[76:79], v[40:43]
v_mfma_f32_16x16x32_bf16 v[48:51], a[128:131], a[80:83], v[48:51]
ds_read_b64_tr_b16 a[140:141], v5 offset:49152
v_mfma_f32_16x16x32_bf16 v[48:51], a[132:135], a[84:87], v[48:51]
buffer_load_dwordx4 v17, s[12:15], s26 offen offset:1024 lds
v_mfma_f32_16x16x32_bf16 v[56:59], a[128:131], a[88:91], v[56:59]
ds_read_b64_tr_b16 a[142:143], v5 offset:51200
v_mfma_f32_16x16x32_bf16 v[56:59], a[132:135], a[92:95], v[56:59]
v_mfma_f32_16x16x32_bf16 v[64:67], a[128:131], a[96:99], v[64:67]
ds_read_b128 a[0:3], v2 offset:0
v_mfma_f32_16x16x32_bf16 v[64:67], a[132:135], a[100:103], v[64:67]
buffer_load_dwordx4 v18, s[12:15], s26 offen offset:2048 lds
v_mfma_f32_16x16x32_bf16 v[72:75], a[128:131], a[104:107], v[72:75]
ds_read_b128 a[4:7], v3 offset:0
v_mfma_f32_16x16x32_bf16 v[72:75], a[132:135], a[108:111], v[72:75]
v_mfma_f32_16x16x32_bf16 v[80:83], a[128:131], a[112:115], v[80:83]
v_mfma_f32_16x16x32_bf16 v[80:83], a[132:135], a[116:119], v[80:83]
buffer_load_dwordx4 v19, s[12:15], s26 offen offset:3072 lds
v_mfma_f32_16x16x32_bf16 v[88:91], a[128:131], a[120:123], v[88:91]
s_add_u32 s26, s26, 524288
ds_read_b128 a[8:11], v2 offset:2048
v_mfma_f32_16x16x32_bf16 v[88:91], a[132:135], a[124:127], v[88:91]
s_waitcnt lgkmcnt(3)
v_mfma_f32_16x16x32_bf16 v[36:39], a[136:139], a[64:67], v[36:39]
s_add_u32 m0, s29, 81920
ds_read_b64_tr_b16 a[128:129], v6 offset:32768
v_mfma_f32_16x16x32_bf16 v[36:39], a[140:143], a[68:71], v[36:39]
buffer_load_dwordx4 v16, s[12:15], s27 offen offset:0 lds
v_mfma_f32_16x16x32_bf16 v[44:47], a[136:139], a[72:75], v[44:47]
ds_read_b64_tr_b16 a[130:131], v6 offset:34816
v_mfma_f32_16x16x32_bf16 v[44:47], a[140:143], a[76:79], v[44:47]
v_mfma_f32_16x16x32_bf16 v[52:55], a[136:139], a[80:83], v[52:55]
ds_read_b64_tr_b16 a[132:133], v6 offset:49152
v_mfma_f32_16x16x32_bf16 v[52:55], a[140:143], a[84:87], v[52:55]
buffer_load_dwordx4 v17, s[12:15], s27 offen offset:1024 lds
v_mfma_f32_16x16x32_bf16 v[60:63], a[136:139], a[88:91], v[60:63]
ds_read_b64_tr_b16 a[134:135], v6 offset:51200
v_cvt_pk_bf16_f32 v32, v32, v33
v_mfma_f32_16x16x32_bf16 v[60:63], a[140:143], a[92:95], v[60:63]
v_cvt_pk_bf16_f32 v33, v34, v35
v_cvt_pk_bf16_f32 v34, v36, v37
v_mfma_f32_16x16x32_bf16 v[68:71], a[136:139], a[96:99], v[68:71]
ds_read_b128 a[12:15], v3 offset:2048
v_cvt_pk_bf16_f32 v35, v38, v39
v_mfma_f32_16x16x32_bf16 v[68:71], a[140:143], a[100:103], v[68:71]
buffer_load_dwordx4 v18, s[12:15], s27 offen offset:2048 lds
v_mfma_f32_16x16x32_bf16 v[76:79], a[136:139], a[104:107], v[76:79]
v_cvt_pk_bf16_f32 v40, v40, v41
v_cvt_pk_bf16_f32 v41, v42, v43
v_mfma_f32_16x16x32_bf16 v[76:79], a[140:143], a[108:111], v[76:79]
v_cvt_pk_bf16_f32 v42, v44, v45
v_cvt_pk_bf16_f32 v43, v46, v47
v_mfma_f32_16x16x32_bf16 v[84:87], a[136:139], a[112:115], v[84:87]
ds_read_b128 a[16:19], v2 offset:4096
v_cvt_pk_bf16_f32 v48, v48, v49
v_mfma_f32_16x16x32_bf16 v[84:87], a[140:143], a[116:119], v[84:87]
buffer_load_dwordx4 v19, s[12:15], s27 offen offset:3072 lds
v_mfma_f32_16x16x32_bf16 v[92:95], a[136:139], a[120:123], v[92:95]
s_add_u32 s27, s27, 524288
ds_read_b128 a[20:23], v3 offset:4096
v_cvt_pk_bf16_f32 v49, v50, v51
v_mfma_f32_16x16x32_bf16 v[92:95], a[140:143], a[124:127], v[92:95]
s_waitcnt lgkmcnt(3)
v_cvt_pk_bf16_f32 v50, v52, v53
v_cvt_pk_bf16_f32 v51, v54, v55
v_mfma_f32_16x16x32_bf16 v[96:99], a[128:131], a[64:67], v[96:99]
s_add_u32 m0, s28, 49152
ds_read_b64_tr_b16 a[136:137], v7 offset:32768
v_cvt_pk_bf16_f32 v56, v56, v57
v_mfma_f32_16x16x32_bf16 v[96:99], a[132:135], a[68:71], v[96:99]
buffer_load_dwordx4 v12, s[8:11], s24 offen offset:0 lds
v_mfma_f32_16x16x32_bf16 v[104:107], a[128:131], a[72:75], v[104:107]
ds_read_b64_tr_b16 a[138:139], v7 offset:34816
v_cvt_pk_bf16_f32 v57, v58, v59
v_mfma_f32_16x16x32_bf16 v[104:107], a[132:135], a[76:79], v[104:107]
v_cvt_pk_bf16_f32 v58, v60, v61
v_cvt_pk_bf16_f32 v59, v62, v63
v_mfma_f32_16x16x32_bf16 v[112:115], a[128:131], a[80:83], v[112:115]
ds_read_b64_tr_b16 a[140:141], v7 offset:49152
v_cvt_pk_bf16_f32 v64, v64, v65
v_mfma_f32_16x16x32_bf16 v[112:115], a[132:135], a[84:87], v[112:115]
buffer_load_dwordx4 v13, s[8:11], s24 offen offset:1024 lds
v_mfma_f32_16x16x32_bf16 v[120:123], a[128:131], a[88:91], v[120:123]
ds_read_b64_tr_b16 a[142:143], v7 offset:51200
v_cvt_pk_bf16_f32 v65, v66, v67
v_mfma_f32_16x16x32_bf16 v[120:123], a[132:135], a[92:95], v[120:123]
v_cvt_pk_bf16_f32 v66, v68, v69
v_cvt_pk_bf16_f32 v67, v70, v71
v_mfma_f32_16x16x32_bf16 v[128:131], a[128:131], a[96:99], v[128:131]
v_cvt_pk_bf16_f32 v72, v72, v73
v_cvt_pk_bf16_f32 v73, v74, v75
v_mfma_f32_16x16x32_bf16 v[128:131], a[132:135], a[100:103], v[128:131]
buffer_load_dwordx4 v14, s[8:11], s24 offen offset:2048 lds
v_mfma_f32_16x16x32_bf16 v[136:139], a[128:131], a[104:107], v[136:139]
ds_read_b128 a[24:27], v2 offset:6144
v_cvt_pk_bf16_f32 v74, v76, v77
v_mfma_f32_16x16x32_bf16 v[136:139], a[132:135], a[108:111], v[136:139]
buffer_store_dwordx4 v[32:35], v1, s[4:7], s31 offen sc1
v_mfma_f32_16x16x32_bf16 v[144:147], a[128:131], a[112:115], v[144:147]
s_add_u32 s31, s31, s32
ds_read_b128 a[28:31], v3 offset:6144
v_cvt_pk_bf16_f32 v75, v78, v79
v_mfma_f32_16x16x32_bf16 v[144:147], a[132:135], a[116:119], v[144:147]
buffer_load_dwordx4 v15, s[8:11], s24 offen offset:3072 lds
v_mfma_f32_16x16x32_bf16 v[152:155], a[128:131], a[120:123], v[152:155]
s_add_u32 s24, s24, 128
v_cvt_pk_bf16_f32 v80, v80, v81
v_cvt_pk_bf16_f32 v81, v82, v83
v_mfma_f32_16x16x32_bf16 v[152:155], a[132:135], a[124:127], v[152:155]
s_waitcnt lgkmcnt(2)
v_cvt_pk_bf16_f32 v82, v84, v85
v_cvt_pk_bf16_f32 v83, v86, v87
v_mfma_f32_16x16x32_bf16 v[100:103], a[136:139], a[64:67], v[100:103]
ds_read_b64_tr_b16 a[128:129], v8 offset:32768
v_cvt_pk_bf16_f32 v88, v88, v89
v_mfma_f32_16x16x32_bf16 v[100:103], a[140:143], a[68:71], v[100:103]
v_cvt_pk_bf16_f32 v89, v90, v91
v_cvt_pk_bf16_f32 v90, v92, v93
v_mfma_f32_16x16x32_bf16 v[108:111], a[136:139], a[72:75], v[108:111]
ds_read_b64_tr_b16 a[130:131], v8 offset:34816
v_cvt_pk_bf16_f32 v91, v94, v95
v_mfma_f32_16x16x32_bf16 v[108:111], a[140:143], a[76:79], v[108:111]
buffer_store_dwordx4 v[40:43], v1, s[4:7], s31 offen sc1
v_mfma_f32_16x16x32_bf16 v[116:119], a[136:139], a[80:83], v[116:119]
s_add_u32 s31, s31, s33
ds_read_b64_tr_b16 a[132:133], v8 offset:49152
v_mfma_f32_16x16x32_bf16 v[116:119], a[140:143], a[84:87], v[116:119]
v_mfma_f32_16x16x32_bf16 v[124:127], a[136:139], a[88:91], v[124:127]
ds_read_b64_tr_b16 a[134:135], v8 offset:51200
v_cvt_pk_bf16_f32 v96, v96, v97
v_mfma_f32_16x16x32_bf16 v[124:127], a[140:143], a[92:95], v[124:127]
v_cvt_pk_bf16_f32 v97, v98, v99
v_cvt_pk_bf16_f32 v98, v100, v101
v_mfma_f32_16x16x32_bf16 v[132:135], a[136:139], a[96:99], v[132:135]
ds_read_b128 a[32:35], v2 offset:8192
v_cvt_pk_bf16_f32 v99, v102, v103
v_mfma_f32_16x16x32_bf16 v[132:135], a[140:143], a[100:103], v[132:135]
v_cvt_pk_bf16_f32 v104, v104, v105
v_cvt_pk_bf16_f32 v105, v106, v107
v_mfma_f32_16x16x32_bf16 v[140:143], a[136:139], a[104:107], v[140:143]
v_cvt_pk_bf16_f32 v106, v108, v109
v_cvt_pk_bf16_f32 v107, v110, v111
v_mfma_f32_16x16x32_bf16 v[140:143], a[140:143], a[108:111], v[140:143]
v_cvt_pk_bf16_f32 v112, v112, v113
v_cvt_pk_bf16_f32 v113, v114, v115
v_mfma_f32_16x16x32_bf16 v[148:151], a[136:139], a[112:115], v[148:151]
ds_read_b128 a[36:39], v3 offset:8192
v_cvt_pk_bf16_f32 v114, v116, v117
v_mfma_f32_16x16x32_bf16 v[148:151], a[140:143], a[116:119], v[148:151]
v_cvt_pk_bf16_f32 v115, v118, v119
v_cvt_pk_bf16_f32 v120, v120, v121
v_mfma_f32_16x16x32_bf16 v[156:159], a[136:139], a[120:123], v[156:159]
ds_read_b128 a[40:43], v2 offset:10240
v_cvt_pk_bf16_f32 v121, v122, v123
v_mfma_f32_16x16x32_bf16 v[156:159], a[140:143], a[124:127], v[156:159]
s_waitcnt lgkmcnt(3)
buffer_store_dwordx4 v[48:51], v1, s[4:7], s31 offen sc1
v_mfma_f32_16x16x32_bf16 v[160:163], a[128:131], a[64:67], v[160:163]
s_add_u32 s31, s31, s32
ds_read_b64_tr_b16 a[136:137], v9 offset:32768
v_cvt_pk_bf16_f32 v122, v124, v125
v_mfma_f32_16x16x32_bf16 v[160:163], a[132:135], a[68:71], v[160:163]
v_cvt_pk_bf16_f32 v123, v126, v127
v_cvt_pk_bf16_f32 v128, v128, v129
v_mfma_f32_16x16x32_bf16 v[168:171], a[128:131], a[72:75], v[168:171]
ds_read_b64_tr_b16 a[138:139], v9 offset:34816
v_cvt_pk_bf16_f32 v129, v130, v131
v_mfma_f32_16x16x32_bf16 v[168:171], a[132:135], a[76:79], v[168:171]
v_cvt_pk_bf16_f32 v130, v132, v133
v_cvt_pk_bf16_f32 v131, v134, v135
v_mfma_f32_16x16x32_bf16 v[176:179], a[128:131], a[80:83], v[176:179]
ds_read_b64_tr_b16 a[140:141], v9 offset:49152
v_cvt_pk_bf16_f32 v136, v136, v137
v_mfma_f32_16x16x32_bf16 v[176:179], a[132:135], a[84:87], v[176:179]
v_cvt_pk_bf16_f32 v137, v138, v139
v_cvt_pk_bf16_f32 v138, v140, v141
v_mfma_f32_16x16x32_bf16 v[184:187], a[128:131], a[88:91], v[184:187]
ds_read_b64_tr_b16 a[142:143], v9 offset:51200
v_cvt_pk_bf16_f32 v139, v142, v143
v_mfma_f32_16x16x32_bf16 v[184:187], a[132:135], a[92:95], v[184:187]
v_cvt_pk_bf16_f32 v144, v144, v145
v_cvt_pk_bf16_f32 v145, v146, v147
v_mfma_f32_16x16x32_bf16 v[192:195], a[128:131], a[96:99], v[192:195]
buffer_store_dwordx4 v[56:59], v1, s[4:7], s31 offen sc1
v_mfma_f32_16x16x32_bf16 v[192:195], a[132:135], a[100:103], v[192:195]
s_add_u32 s31, s31, s34
v_cvt_pk_bf16_f32 v146, v148, v149
v_cvt_pk_bf16_f32 v147, v150, v151
v_mfma_f32_16x16x32_bf16 v[200:203], a[128:131], a[104:107], v[200:203]
ds_read_b128 a[44:47], v3 offset:10240
v_cvt_pk_bf16_f32 v152, v152, v153
v_mfma_f32_16x16x32_bf16 v[200:203], a[132:135], a[108:111], v[200:203]
v_cvt_pk_bf16_f32 v153, v154, v155
v_cvt_pk_bf16_f32 v154, v156, v157
v_mfma_f32_16x16x32_bf16 v[208:211], a[128:131], a[112:115], v[208:211]
ds_read_b128 a[48:51], v2 offset:12288
v_cvt_pk_bf16_f32 v155, v158, v159
v_mfma_f32_16x16x32_bf16 v[208:211], a[132:135], a[116:119], v[208:211]
v_mfma_f32_16x16x32_bf16 v[216:219], a[128:131], a[120:123], v[216:219]
v_mfma_f32_16x16x32_bf16 v[216:219], a[132:135], a[124:127], v[216:219]
s_waitcnt lgkmcnt(2)
v_mfma_f32_16x16x32_bf16 v[164:167], a[136:139], a[64:67], v[164:167]
ds_read_b64_tr_b16 a[128:129], v10 offset:32768
v_mfma_f32_16x16x32_bf16 v[164:167], a[140:143], a[68:71], v[164:167]
v_mfma_f32_16x16x32_bf16 v[172:175], a[136:139], a[72:75], v[172:175]
ds_read_b64_tr_b16 a[130:131], v10 offset:34816
v_mfma_f32_16x16x32_bf16 v[172:175], a[140:143], a[76:79], v[172:175]
buffer_store_dwordx4 v[64:67], v1, s[4:7], s31 offen sc1
v_mfma_f32_16x16x32_bf16 v[180:183], a[136:139], a[80:83], v[180:183]
s_add_u32 s31, s31, s32
ds_read_b64_tr_b16 a[132:133], v10 offset:49152
v_mfma_f32_16x16x32_bf16 v[180:183], a[140:143], a[84:87], v[180:183]
v_mfma_f32_16x16x32_bf16 v[188:191], a[136:139], a[88:91], v[188:191]
ds_read_b64_tr_b16 a[134:135], v10 offset:51200
v_cvt_pk_bf16_f32 v160, v160, v161
v_mfma_f32_16x16x32_bf16 v[188:191], a[140:143], a[92:95], v[188:191]
v_cvt_pk_bf16_f32 v161, v162, v163
v_cvt_pk_bf16_f32 v162, v164, v165
v_mfma_f32_16x16x32_bf16 v[196:199], a[136:139], a[96:99], v[196:199]
ds_read_b128 a[52:55], v3 offset:12288
v_cvt_pk_bf16_f32 v163, v166, v167
v_mfma_f32_16x16x32_bf16 v[196:199], a[140:143], a[100:103], v[196:199]
v_cvt_pk_bf16_f32 v168, v168, v169
v_cvt_pk_bf16_f32 v169, v170, v171
v_mfma_f32_16x16x32_bf16 v[204:207], a[136:139], a[104:107], v[204:207]
ds_read_b128 a[56:59], v2 offset:14336
v_cvt_pk_bf16_f32 v170, v172, v173
v_mfma_f32_16x16x32_bf16 v[204:207], a[140:143], a[108:111], v[204:207]
v_cvt_pk_bf16_f32 v171, v174, v175
v_cvt_pk_bf16_f32 v176, v176, v177
v_mfma_f32_16x16x32_bf16 v[212:215], a[136:139], a[112:115], v[212:215]
v_cvt_pk_bf16_f32 v177, v178, v179
v_cvt_pk_bf16_f32 v178, v180, v181
v_mfma_f32_16x16x32_bf16 v[212:215], a[140:143], a[116:119], v[212:215]
buffer_store_dwordx4 v[72:75], v1, s[4:7], s31 offen sc1
v_mfma_f32_16x16x32_bf16 v[220:223], a[136:139], a[120:123], v[220:223]
s_add_u32 s31, s31, s33
ds_read_b128 a[60:63], v3 offset:14336
v_cvt_pk_bf16_f32 v179, v182, v183
v_mfma_f32_16x16x32_bf16 v[220:223], a[140:143], a[124:127], v[220:223]
s_waitcnt lgkmcnt(3)
v_cvt_pk_bf16_f32 v184, v184, v185
v_cvt_pk_bf16_f32 v185, v186, v187
v_mfma_f32_16x16x32_bf16 a[192:195], a[128:131], a[64:67], a[192:195]
ds_read_b64_tr_b16 a[136:137], v11 offset:32768
v_cvt_pk_bf16_f32 v186, v188, v189
v_mfma_f32_16x16x32_bf16 a[192:195], a[132:135], a[68:71], a[192:195]
v_cvt_pk_bf16_f32 v187, v190, v191
v_cvt_pk_bf16_f32 v192, v192, v193
v_mfma_f32_16x16x32_bf16 a[200:203], a[128:131], a[72:75], a[200:203]
ds_read_b64_tr_b16 a[138:139], v11 offset:34816
v_cvt_pk_bf16_f32 v193, v194, v195
v_mfma_f32_16x16x32_bf16 a[200:203], a[132:135], a[76:79], a[200:203]
v_cvt_pk_bf16_f32 v194, v196, v197
v_cvt_pk_bf16_f32 v195, v198, v199
v_mfma_f32_16x16x32_bf16 a[208:211], a[128:131], a[80:83], a[208:211]
ds_read_b64_tr_b16 a[140:141], v11 offset:49152
v_cvt_pk_bf16_f32 v200, v200, v201
v_mfma_f32_16x16x32_bf16 a[208:211], a[132:135], a[84:87], a[208:211]
v_cvt_pk_bf16_f32 v201, v202, v203
v_cvt_pk_bf16_f32 v202, v204, v205
v_mfma_f32_16x16x32_bf16 a[216:219], a[128:131], a[88:91], a[216:219]
ds_read_b64_tr_b16 a[142:143], v11 offset:51200
v_cvt_pk_bf16_f32 v203, v206, v207
v_mfma_f32_16x16x32_bf16 a[216:219], a[132:135], a[92:95], a[216:219]
v_cvt_pk_bf16_f32 v208, v208, v209
v_cvt_pk_bf16_f32 v209, v210, v211
v_mfma_f32_16x16x32_bf16 a[224:227], a[128:131], a[96:99], a[224:227]
buffer_store_dwordx4 v[80:83], v1, s[4:7], s31 offen sc1
v_mfma_f32_16x16x32_bf16 a[224:227], a[132:135], a[100:103], a[224:227]
s_add_u32 s31, s31, s32
v_cvt_pk_bf16_f32 v210, v212, v213
v_cvt_pk_bf16_f32 v211, v214, v215
v_mfma_f32_16x16x32_bf16 a[232:235], a[128:131], a[104:107], a[232:235]
v_cvt_pk_bf16_f32 v216, v216, v217
v_cvt_pk_bf16_f32 v217, v218, v219
v_mfma_f32_16x16x32_bf16 a[232:235], a[132:135], a[108:111], a[232:235]
v_cvt_pk_bf16_f32 v218, v220, v221
v_cvt_pk_bf16_f32 v219, v222, v223
v_mfma_f32_16x16x32_bf16 a[240:243], a[128:131], a[112:115], a[240:243]
v_mfma_f32_16x16x32_bf16 a[240:243], a[132:135], a[116:119], a[240:243]
v_mfma_f32_16x16x32_bf16 a[248:251], a[128:131], a[120:123], a[248:251]
s_waitcnt vmcnt(23) lgkmcnt(0)
v_mfma_f32_16x16x32_bf16 a[248:251], a[132:135], a[124:127], a[248:251]
s_barrier
v_mfma_f32_16x16x32_bf16 a[196:199], a[136:139], a[64:67], a[196:199]
s_add_u32 m0, s29, 98304
ds_read_b64_tr_b16 a[128:129], v22 offset:0
v_mfma_f32_16x16x32_bf16 a[196:199], a[140:143], a[68:71], a[196:199]
buffer_load_dwordx4 v16, s[12:15], s26 offen offset:0 lds
v_mfma_f32_16x16x32_bf16 a[204:207], a[136:139], a[72:75], a[204:207]
ds_read_b64_tr_b16 a[130:131], v22 offset:2048
v_mfma_f32_16x16x32_bf16 a[204:207], a[140:143], a[76:79], a[204:207]
buffer_store_dwordx4 v[88:91], v1, s[4:7], s31 offen sc1
v_mfma_f32_16x16x32_bf16 a[212:215], a[136:139], a[80:83], a[212:215]
s_add_u32 s31, s31, s35
ds_read_b64_tr_b16 a[132:133], v22 offset:16384
v_mfma_f32_16x16x32_bf16 a[212:215], a[140:143], a[84:87], a[212:215]
buffer_load_dwordx4 v17, s[12:15], s26 offen offset:1024 lds
v_mfma_f32_16x16x32_bf16 a[220:223], a[136:139], a[88:91], a[220:223]
ds_read_b64_tr_b16 a[134:135], v22 offset:18432
v_add_u32 v22, 4294901760, v22
v_mfma_f32_16x16x32_bf16 a[220:223], a[140:143], a[92:95], a[220:223]
v_mfma_f32_16x16x32_bf16 a[228:231], a[136:139], a[96:99], a[228:231]
v_mfma_f32_16x16x32_bf16 a[228:231], a[140:143], a[100:103], a[228:231]
buffer_load_dwordx4 v18, s[12:15], s26 offen offset:2048 lds
v_mfma_f32_16x16x32_bf16 a[236:239], a[136:139], a[104:107], a[236:239]
v_mfma_f32_16x16x32_bf16 a[236:239], a[140:143], a[108:111], a[236:239]
v_mfma_f32_16x16x32_bf16 a[244:247], a[136:139], a[112:115], a[244:247]
v_mfma_f32_16x16x32_bf16 a[244:247], a[140:143], a[116:119], a[244:247]
buffer_load_dwordx4 v19, s[12:15], s26 offen offset:3072 lds
v_mfma_f32_16x16x32_bf16 a[252:255], a[136:139], a[120:123], a[252:255]
s_add_u32 s26, s26, 524288
v_mfma_f32_16x16x32_bf16 a[252:255], a[140:143], a[124:127], a[252:255]
s_waitcnt lgkmcnt(0)
M_Q:
v_mfma_f32_16x16x32_bf16 v[36:39], a[128:131], a[0:3], 0
s_add_u32 m0, s29, 114688
ds_read_b64_tr_b16 a[136:137], v23 offset:0
v_mfma_f32_16x16x32_bf16 v[36:39], a[132:135], a[4:7], v[36:39]
buffer_load_dwordx4 v16, s[12:15], s27 offen offset:0 lds
v_mfma_f32_16x16x32_bf16 v[44:47], a[128:131], a[8:11], 0
ds_read_b64_tr_b16 a[138:139], v23 offset:2048
v_mfma_f32_16x16x32_bf16 v[44:47], a[132:135], a[12:15], v[44:47]
ds_read_b128 a[64:67], v2 offset:16384
ds_read_b128 a[68:71], v3 offset:16384
v_mfma_f32_16x16x32_bf16 v[52:55], a[128:131], a[16:19], 0
ds_read_b64_tr_b16 a[140:141], v23 offset:16384
v_mfma_f32_16x16x32_bf16 v[52:55], a[132:135], a[20:23], v[52:55]
buffer_load_dwordx4 v17, s[12:15], s27 offen offset:1024 lds
v_mfma_f32_16x16x32_bf16 v[60:63], a[128:131], a[24:27], 0
ds_read_b64_tr_b16 a[142:143], v23 offset:18432
v_add_u32 v23, 4294901760, v23
v_mfma_f32_16x16x32_bf16 v[60:63], a[132:135], a[28:31], v[60:63]
buffer_store_dwordx4 v[96:99], v1, s[4:7], s31 offen sc1
v_mfma_f32_16x16x32_bf16 v[68:71], a[128:131], a[32:35], 0
s_add_u32 s31, s31, s32
ds_read_b128 a[72:75], v2 offset:18432
v_mfma_f32_16x16x32_bf16 v[68:71], a[132:135], a[36:39], v[68:71]
buffer_load_dwordx4 v18, s[12:15], s27 offen offset:2048 lds
v_mfma_f32_16x16x32_bf16 v[76:79], a[128:131], a[40:43], 0
ds_read_b128 a[76:79], v3 offset:18432
v_mfma_f32_16x16x32_bf16 v[76:79], a[132:135], a[44:47], v[76:79]
ds_read_b128 a[80:83], v2 offset:20480
v_mfma_f32_16x16x32_bf16 v[84:87], a[128:131], a[48:51], 0
ds_read_b128 a[84:87], v3 offset:20480
v_mfma_f32_16x16x32_bf16 v[84:87], a[132:135], a[52:55], v[84:87]
buffer_load_dwordx4 v19, s[12:15], s27 offen offset:3072 lds
v_mfma_f32_16x16x32_bf16 v[92:95], a[128:131], a[56:59], 0
s_add_u32 s27, s27, 524288
ds_read_b128 a[88:91], v2 offset:22528
v_mfma_f32_16x16x32_bf16 v[92:95], a[132:135], a[60:63], v[92:95]
s_waitcnt lgkmcnt(5)
buffer_store_dwordx4 v[104:107], v1, s[4:7], s31 offen sc1
v_mfma_f32_16x16x32_bf16 v[100:103], a[136:139], a[0:3], 0
s_add_u32 m0, s28, 0
ds_read_b64_tr_b16 a[128:129], v24 offset:0
v_mfma_f32_16x16x32_bf16 v[100:103], a[140:143], a[4:7], v[100:103]
s_add_u32 s31, s31, s33
buffer_load_dwordx4 v12, s[8:11], s24 offen offset:0 lds
v_mfma_f32_16x16x32_bf16 v[108:111], a[136:139], a[8:11], 0
ds_read_b64_tr_b16 a[130:131], v24 offset:2048
v_mfma_f32_16x16x32_bf16 v[108:111], a[140:143], a[12:15], v[108:111]
ds_read_b128 a[92:95], v3 offset:22528
v_mfma_f32_16x16x32_bf16 v[116:119], a[136:139], a[16:19], 0
ds_read_b64_tr_b16 a[132:133], v24 offset:16384
v_mfma_f32_16x16x32_bf16 v[116:119], a[140:143], a[20:23], v[116:119]
buffer_load_dwordx4 v13, s[8:11], s24 offen offset:1024 lds
v_mfma_f32_16x16x32_bf16 v[124:127], a[136:139], a[24:27], 0
ds_read_b64_tr_b16 a[134:135], v24 offset:18432
v_add_u32 v24, 4294901760, v24
v_mfma_f32_16x16x32_bf16 v[124:127], a[140:143], a[28:31], v[124:127]
v_mfma_f32_16x16x32_bf16 v[132:135], a[136:139], a[32:35], 0
ds_read_b128 a[96:99], v2 offset:24576
v_mfma_f32_16x16x32_bf16 v[132:135], a[140:143], a[36:39], v[132:135]
buffer_load_dwordx4 v14, s[8:11], s24 offen offset:2048 lds
v_mfma_f32_16x16x32_bf16 v[140:143], a[136:139], a[40:43], 0
ds_read_b128 a[100:103], v3 offset:24576
v_mfma_f32_16x16x32_bf16 v[140:143], a[140:143], a[44:47], v[140:143]
ds_read_b128 a[104:107], v2 offset:26624
v_mfma_f32_16x16x32_bf16 v[148:151], a[136:139], a[48:51], 0
ds_read_b128 a[108:111], v3 offset:26624
v_mfma_f32_16x16x32_bf16 v[148:151], a[140:143], a[52:55], v[148:151]
PAD_6:
s_cbranch_execz M_tret
buffer_load_dwordx4 v15, s[8:11], s24 offen offset:3072 lds
v_mfma_f32_16x16x32_bf16 v[156:159], a[136:139], a[56:59], 0
s_add_u32 s24, s24, 128
ds_read_b128 a[112:115], v2 offset:28672
v_mfma_f32_16x16x32_bf16 v[156:159], a[140:143], a[60:63], v[156:159]
s_waitcnt lgkmcnt(5)
buffer_store_dwordx4 v[112:115], v1, s[4:7], s31 offen sc1
v_mfma_f32_16x16x32_bf16 v[164:167], a[128:131], a[0:3], 0
s_add_u32 s31, s31, s32
ds_read_b64_tr_b16 a[136:137], v25 offset:0
v_mfma_f32_16x16x32_bf16 v[164:167], a[132:135], a[4:7], v[164:167]
v_mfma_f32_16x16x32_bf16 v[172:175], a[128:131], a[8:11], 0
ds_read_b64_tr_b16 a[138:139], v25 offset:2048
v_mfma_f32_16x16x32_bf16 v[172:175], a[132:135], a[12:15], v[172:175]
ds_read_b128 a[116:119], v3 offset:28672
v_mfma_f32_16x16x32_bf16 v[180:183], a[128:131], a[16:19], 0
ds_read_b64_tr_b16 a[140:141], v25 offset:16384
v_mfma_f32_16x16x32_bf16 v[180:183], a[132:135], a[20:23], v[180:183]
v_mfma_f32_16x16x32_bf16 v[188:191], a[128:131], a[24:27], 0
ds_read_b64_tr_b16 a[142:143], v25 offset:18432
v_add_u32 v25, 4294901760, v25
v_mfma_f32_16x16x32_bf16 v[188:191], a[132:135], a[28:31], v[188:191]
v_mfma_f32_16x16x32_bf16 v[196:199], a[128:131], a[32:35], 0
ds_read_b128 a[120:123], v2 offset:30720
v_mfma_f32_16x16x32_bf16 v[196:199], a[132:135], a[36:39], v[196:199]
v_mfma_f32_16x16x32_bf16 v[204:207], a[128:131], a[40:43], 0
ds_read_b128 a[124:127], v3 offset:30720
v_mfma_f32_16x16x32_bf16 v[204:207], a[132:135], a[44:47], v[204:207]
v_mfma_f32_16x16x32_bf16 v[212:215], a[128:131], a[48:51], 0
v_mfma_f32_16x16x32_bf16 v[212:215], a[132:135], a[52:55], v[212:215]
buffer_store_dwordx4 v[120:123], v1, s[4:7], s31 offen sc1
v_mfma_f32_16x16x32_bf16 v[220:223], a[128:131], a[56:59], 0
s_add_u32 s31, s31, s34
v_mfma_f32_16x16x32_bf16 v[220:223], a[132:135], a[60:63], v[220:223]
s_waitcnt vmcnt(28) lgkmcnt(0)
s_barrier
v_mfma_f32_16x16x32_bf16 v[224:227], a[136:139], a[0:3], 0
s_add_u32 m0, s29, 131072
ds_read_b64_tr_b16 a[128:129], v22 offset:0
v_mfma_f32_16x16x32_bf16 v[224:227], a[140:143], a[4:7], v[224:227]
buffer_load_dwordx4 v16, s[12:15], s26 offen offset:0 lds
v_mfma_f32_16x16x32_bf16 v[228:231], a[136:139], a[8:11], 0
ds_read_b64_tr_b16 a[130:131], v22 offset:2048
v_mfma_f32_16x16x32_bf16 v[228:231], a[140:143], a[12:15], v[228:231]
v_mfma_f32_16x16x32_bf16 v[232:235], a[136:139], a[16:19], 0
ds_read_b64_tr_b16 a[132:133], v22 offset:16384
v_mfma_f32_16x16x32_bf16 v[232:235], a[140:143], a[20:23], v[232:235]
buffer_load_dwordx4 v17, s[12:15], s26 offen offset:1024 lds
v_mfma_f32_16x16x32_bf16 v[236:239], a[136:139], a[24:27], 0
ds_read_b64_tr_b16 a[134:135], v22 offset:18432
v_add_u32 v22, 32768, v22
v_mfma_f32_16x16x32_bf16 v[236:239], a[140:143], a[28:31], v[236:239]
v_mfma_f32_16x16x32_bf16 v[240:243], a[136:139], a[32:35], 0
v_mfma_f32_16x16x32_bf16 v[240:243], a[140:143], a[36:39], v[240:243]
buffer_load_dwordx4 v18, s[12:15], s26 offen offset:2048 lds
v_mfma_f32_16x16x32_bf16 v[244:247], a[136:139], a[40:43], 0
v_mfma_f32_16x16x32_bf16 v[244:247], a[140:143], a[44:47], v[244:247]
v_mfma_f32_16x16x32_bf16 v[248:251], a[136:139], a[48:51], 0
v_mfma_f32_16x16x32_bf16 v[248:251], a[140:143], a[52:55], v[248:251]
buffer_load_dwordx4 v19, s[12:15], s26 offen offset:3072 lds
v_mfma_f32_16x16x32_bf16 v[252:255], a[136:139], a[56:59], 0
s_add_u32 s26, s26, 524288
v_mfma_f32_16x16x32_bf16 v[252:255], a[140:143], a[60:63], v[252:255]
s_waitcnt lgkmcnt(0)
v_mfma_f32_16x16x32_bf16 v[36:39], a[128:131], a[64:67], v[36:39]
s_add_u32 m0, s29, 147456
ds_read_b64_tr_b16 a[136:137], v23 offset:0
v_mfma_f32_16x16x32_bf16 v[36:39], a[132:135], a[68:71], v[36:39]
buffer_load_dwordx4 v16, s[12:15], s27 offen offset:0 lds
v_mfma_f32_16x16x32_bf16 v[44:47], a[128:131], a[72:75], v[44:47]
ds_read_b64_tr_b16 a[138:139], v23 offset:2048
v_mfma_f32_16x16x32_bf16 v[44:47], a[132:135], a[76:79], v[44:47]
ds_read_b128 a[0:3], v2 offset:32768
ds_read_b128 a[4:7], v3 offset:32768
v_mfma_f32_16x16x32_bf16 v[52:55], a[128:131], a[80:83], v[52:55]
ds_read_b64_tr_b16 a[140:141], v23 offset:16384
v_mfma_f32_16x16x32_bf16 v[52:55], a[132:135], a[84:87], v[52:55]
buffer_load_dwordx4 v17, s[12:15], s27 offen offset:1024 lds
v_mfma_f32_16x16x32_bf16 v[60:63], a[128:131], a[88:91], v[60:63]
ds_read_b64_tr_b16 a[142:143], v23 offset:18432
v_add_u32 v23, 32768, v23
v_mfma_f32_16x16x32_bf16 v[60:63], a[132:135], a[92:95], v[60:63]
buffer_store_dwordx4 v[128:131], v1, s[4:7], s31 offen sc1
v_mfma_f32_16x16x32_bf16 v[68:71], a[128:131], a[96:99], v[68:71]
s_add_u32 s31, s31, s32
ds_read_b128 a[8:11], v2 offset:34816
v_accvgpr_read_b32 v32, a192
v_mfma_f32_16x16x32_bf16 v[68:71], a[132:135], a[100:103], v[68:71]
buffer_load_dwordx4 v18, s[12:15], s27 offen offset:2048 lds
v_mfma_f32_16x16x32_bf16 v[76:79], a[128:131], a[104:107], v[76:79]
ds_read_b128 a[12:15], v3 offset:34816
v_accvgpr_read_b32 v33, a193
v_mfma_f32_16x16x32_bf16 v[76:79], a[132:135], a[108:111], v[76:79]
ds_read_b128 a[16:19], v2 offset:36864
v_accvgpr_read_b32 v34, a194
v_mfma_f32_16x16x32_bf16 v[84:87], a[128:131], a[112:115], v[84:87]
ds_read_b128 a[20:23], v3 offset:36864
v_accvgpr_read_b32 v35, a195
v_mfma_f32_16x16x32_bf16 v[84:87], a[132:135], a[116:119], v[84:87]
buffer_load_dwordx4 v19, s[12:15], s27 offen offset:3072 lds
v_mfma_f32_16x16x32_bf16 v[92:95], a[128:131], a[120:123], v[92:95]
s_add_u32 s27, s27, 524288
ds_read_b128 a[24:27], v2 offset:38912
v_accvgpr_read_b32 v96, a196
v_mfma_f32_16x16x32_bf16 v[92:95], a[132:135], a[124:127], v[92:95]
s_waitcnt lgkmcnt(5)
buffer_store_dwordx4 v[136:139], v1, s[4:7], s31 offen sc1
v_mfma_f32_16x16x32_bf16 v[100:103], a[136:139], a[64:67], v[100:103]
s_add_u32 m0, s28, 16384
ds_read_b64_tr_b16 a[128:129], v24 offset:0
v_accvgpr_read_b32 v97, a197
v_mfma_f32_16x16x32_bf16 v[100:103], a[140:143], a[68:71], v[100:103]
s_add_u32 s31, s31, s33
buffer_load_dwordx4 v12, s[8:11], s24 offen offset:0 lds
v_mfma_f32_16x16x32_bf16 v[108:111], a[136:139], a[72:75], v[108:111]
ds_read_b64_tr_b16 a[130:131], v24 offset:2048
v_accvgpr_read_b32 v98, a198
v_mfma_f32_16x16x32_bf16 v[108:111], a[140:143], a[76:79], v[108:111]
ds_read_b128 a[28:31], v3 offset:38912
v_accvgpr_read_b32 v99, a199
v_mfma_f32_16x16x32_bf16 v[116:119], a[136:139], a[80:83], v[116:119]
ds_read_b64_tr_b16 a[132:133], v24 offset:16384
v_cvt_pk_bf16_f32 v32, v32, v33
v_mfma_f32_16x16x32_bf16 v[116:119], a[140:143], a[84:87], v[116:119]
buffer_load_dwordx4 v13, s[8:11], s24 offen offset:1024 lds
v_mfma_f32_16x16x32_bf16 v[124:127], a[136:139], a[88:91], v[124:127]
ds_read_b64_tr_b16 a[134:135], v24 offset:18432
v_add_u32 v24, 32768, v24
v_mfma_f32_16x16x32_bf16 v[124:127], a[140:143], a[92:95], v[124:127]
v_cvt_pk_bf16_f32 v33, v34, v35
v_cvt_pk_bf16_f32 v34, v96, v97
v_mfma_f32_16x16x32_bf16 v[132:135], a[136:139], a[96:99], v[132:135]
ds_read_b128 a[32:35], v2 offset:40960
v_cvt_pk_bf16_f32 v35, v98, v99
v_mfma_f32_16x16x32_bf16 v[132:135], a[140:143], a[100:103], v[132:135]
buffer_load_dwordx4 v14, s[8:11], s24 offen offset:2048 lds
v_mfma_f32_16x16x32_bf16 v[140:143], a[136:139], a[104:107], v[140:143]
ds_read_b128 a[36:39], v3 offset:40960
v_accvgpr_read_b32 v40, a200
v_mfma_f32_16x16x32_bf16 v[140:143], a[140:143], a[108:111], v[140:143]
ds_read_b128 a[40:43], v2 offset:43008
v_accvgpr_read_b32 v41, a201
v_mfma_f32_16x16x32_bf16 v[148:151], a[136:139], a[112:115], v[148:151]
ds_read_b128 a[44:47], v3 offset:43008
v_accvgpr_read_b32 v42, a202
v_mfma_f32_16x16x32_bf16 v[148:151], a[140:143], a[116:119], v[148:151]
buffer_load_dwordx4 v15, s[8:11], s24 offen offset:3072 lds
v_mfma_f32_16x16x32_bf16 v[156:159], a[136:139], a[120:123], v[156:159]
s_add_u32 s24, s24, 128
ds_read_b128 a[48:51], v2 offset:45056
v_accvgpr_read_b32 v43, a203
v_mfma_f32_16x16x32_bf16 v[156:159], a[140:143], a[124:127], v[156:159]
s_waitcnt lgkmcnt(5)
buffer_store_dwordx4 v[144:147], v1, s[4:7], s31 offen sc1
v_mfma_f32_16x16x32_bf16 v[164:167], a[128:131], a[64:67], v[164:167]
s_add_u32 s31, s31, s32
ds_read_b64_tr_b16 a[136:137], v25 offset:0
v_accvgpr_read_b32 v96, a204
v_mfma_f32_16x16x32_bf16 v[164:167], a[132:135], a[68:71], v[164:167]
v_accvgpr_read_b32 v97, a205
v_accvgpr_read_b32 v98, a206
v_mfma_f32_16x16x32_bf16 v[172:175], a[128:131], a[72:75], v[172:175]
ds_read_b64_tr_b16 a[138:139], v25 offset:2048
v_accvgpr_read_b32 v99, a207
v_mfma_f32_16x16x32_bf16 v[172:175], a[132:135], a[76:79], v[172:175]
ds_read_b128 a[52:55], v3 offset:45056
v_cvt_pk_bf16_f32 v40, v40, v41
v_mfma_f32_16x16x32_bf16 v[180:183], a[128:131], a[80:83], v[180:183]
ds_read_b64_tr_b16 a[140:141], v25 offset:16384
v_cvt_pk_bf16_f32 v41, v42, v43
v_mfma_f32_16x16x32_bf16 v[180:183], a[132:135], a[84:87], v[180:183]
v_cvt_pk_bf16_f32 v42, v96, v97
v_cvt_pk_bf16_f32 v43, v98, v99
v_mfma_f32_16x16x32_bf16 v[188:191], a[128:131], a[88:91], v[188:191]
ds_read_b64_tr_b16 a[142:143], v25 offset:18432
v_add_u32 v25, 32768, v25
v_mfma_f32_16x16x32_bf16 v[188:191], a[132:135], a[92:95], v[188:191]
v_accvgpr_read_b32 v48, a208
v_accvgpr_read_b32 v49, a209
v_mfma_f32_16x16x32_bf16 v[196:199], a[128:131], a[96:99], v[196:199]
ds_read_b128 a[56:59], v2 offset:47104
v_accvgpr_read_b32 v50, a210
v_mfma_f32_16x16x32_bf16 v[196:199], a[132:135], a[100:103], v[196:199]
v_accvgpr_read_b32 v51, a211
v_accvgpr_read_b32 v96, a212
v_mfma_f32_16x16x32_bf16 v[204:207], a[128:131], a[104:107], v[204:207]
ds_read_b128 a[60:63], v3 offset:47104
v_accvgpr_read_b32 v97, a213
v_mfma_f32_16x16x32_bf16 v[204:207], a[132:135], a[108:111], v[204:207]
v_accvgpr_read_b32 v98, a214
v_accvgpr_read_b32 v99, a215
v_mfma_f32_16x16x32_bf16 v[212:215], a[128:131], a[112:115], v[212:215]
v_cvt_pk_bf16_f32 v48, v48, v49
v_cvt_pk_bf16_f32 v49, v50, v51
v_mfma_f32_16x16x32_bf16 v[212:215], a[132:135], a[116:119], v[212:215]
buffer_store_dwordx4 v[152:155], v1, s[4:7], s31 offen sc1
v_mfma_f32_16x16x32_bf16 v[220:223], a[128:131], a[120:123], v[220:223]
s_add_u32 s31, s31, s36
v_cvt_pk_bf16_f32 v50, v96, v97
v_cvt_pk_bf16_f32 v51, v98, v99
v_mfma_f32_16x16x32_bf16 v[220:223], a[132:135], a[124:127], v[220:223]
s_waitcnt vmcnt(23) lgkmcnt(0)
s_barrier
v_accvgpr_read_b32 v56, a216
v_mfma_f32_16x16x32_bf16 v[224:227], a[136:139], a[64:67], v[224:227]
s_add_u32 m0, s29, 65536
ds_read_b64_tr_b16 a[128:129], v22 offset:0
v_accvgpr_read_b32 v57, a217
v_mfma_f32_16x16x32_bf16 v[224:227], a[140:143], a[68:71], v[224:227]
buffer_load_dwordx4 v16, s[12:15], s26 offen offset:0 lds
v_mfma_f32_16x16x32_bf16 v[228:231], a[136:139], a[72:75], v[228:231]
ds_read_b64_tr_b16 a[130:131], v22 offset:2048
v_accvgpr_read_b32 v58, a218
v_mfma_f32_16x16x32_bf16 v[228:231], a[140:143], a[76:79], v[228:231]
v_accvgpr_read_b32 v59, a219
v_accvgpr_read_b32 v96, a220
v_mfma_f32_16x16x32_bf16 v[232:235], a[136:139], a[80:83], v[232:235]
ds_read_b64_tr_b16 a[132:133], v22 offset:16384
v_accvgpr_read_b32 v97, a221
v_mfma_f32_16x16x32_bf16 v[232:235], a[140:143], a[84:87], v[232:235]
buffer_load_dwordx4 v17, s[12:15], s26 offen offset:1024 lds
v_mfma_f32_16x16x32_bf16 v[236:239], a[136:139], a[88:91], v[236:239]
ds_read_b64_tr_b16 a[134:135], v22 offset:18432
v_add_u32 v22, 32768, v22
v_mfma_f32_16x16x32_bf16 v[236:239], a[140:143], a[92:95], v[236:239]
v_accvgpr_read_b32 v98, a222
v_accvgpr_read_b32 v99, a223
v_mfma_f32_16x16x32_bf16 v[240:243], a[136:139], a[96:99], v[240:243]
v_cvt_pk_bf16_f32 v56, v56, v57
v_cvt_pk_bf16_f32 v57, v58, v59
v_mfma_f32_16x16x32_bf16 v[240:243], a[140:143], a[100:103], v[240:243]
buffer_load_dwordx4 v18, s[12:15], s26 offen offset:2048 lds
v_mfma_f32_16x16x32_bf16 v[244:247], a[136:139], a[104:107], v[244:247]
v_cvt_pk_bf16_f32 v58, v96, v97
v_cvt_pk_bf16_f32 v59, v98, v99
v_mfma_f32_16x16x32_bf16 v[244:247], a[140:143], a[108:111], v[244:247]
v_accvgpr_read_b32 v64, a224
v_accvgpr_read_b32 v65, a225
v_mfma_f32_16x16x32_bf16 v[248:251], a[136:139], a[112:115], v[248:251]
v_accvgpr_read_b32 v66, a226
v_accvgpr_read_b32 v67, a227
v_mfma_f32_16x16x32_bf16 v[248:251], a[140:143], a[116:119], v[248:251]
buffer_load_dwordx4 v19, s[12:15], s26 offen offset:3072 lds
v_mfma_f32_16x16x32_bf16 v[252:255], a[136:139], a[120:123], v[252:255]
s_add_u32 s26, s26, 524288
v_accvgpr_read_b32 v96, a228
v_accvgpr_read_b32 v97, a229
v_mfma_f32_16x16x32_bf16 v[252:255], a[140:143], a[124:127], v[252:255]
s_waitcnt lgkmcnt(0)
v_accvgpr_read_b32 v98, a230
v_accvgpr_read_b32 v99, a231
v_mfma_f32_16x16x32_bf16 v[36:39], a[128:131], a[0:3], v[36:39]
s_add_u32 m0, s29, 81920
ds_read_b64_tr_b16 a[136:137], v23 offset:0
v_cvt_pk_bf16_f32 v64, v64, v65
v_mfma_f32_16x16x32_bf16 v[36:39], a[132:135], a[4:7], v[36:39]
buffer_load_dwordx4 v16, s[12:15], s27 offen offset:0 lds
v_mfma_f32_16x16x32_bf16 v[44:47], a[128:131], a[8:11], v[44:47]
ds_read_b64_tr_b16 a[138:139], v23 offset:2048
v_cvt_pk_bf16_f32 v65, v66, v67
v_mfma_f32_16x16x32_bf16 v[44:47], a[132:135], a[12:15], v[44:47]
ds_read_b128 a[64:67], v2 offset:49152
ds_read_b128 a[68:71], v3 offset:49152
v_mfma_f32_16x16x32_bf16 v[52:55], a[128:131], a[16:19], v[52:55]
ds_read_b64_tr_b16 a[140:141], v23 offset:16384
v_cvt_pk_bf16_f32 v66, v96, v97
v_mfma_f32_16x16x32_bf16 v[52:55], a[132:135], a[20:23], v[52:55]
buffer_load_dwordx4 v17, s[12:15], s27 offen offset:1024 lds
v_mfma_f32_16x16x32_bf16 v[60:63], a[128:131], a[24:27], v[60:63]
ds_read_b64_tr_b16 a[142:143], v23 offset:18432
v_add_u32 v23, 32768, v23
v_mfma_f32_16x16x32_bf16 v[60:63], a[132:135], a[28:31], v[60:63]
buffer_store_dwordx4 v[160:163], v1, s[4:7], s31 offen sc1
v_mfma_f32_16x16x32_bf16 v[68:71], a[128:131], a[32:35], v[68:71]
s_add_u32 s31, s31, s32
ds_read_b128 a[72:75], v2 offset:51200
v_cvt_pk_bf16_f32 v67, v98, v99
v_mfma_f32_16x16x32_bf16 v[68:71], a[132:135], a[36:39], v[68:71]
buffer_load_dwordx4 v18, s[12:15], s27 offen offset:2048 lds
v_mfma_f32_16x16x32_bf16 v[76:79], a[128:131], a[40:43], v[76:79]
ds_read_b128 a[76:79], v3 offset:51200
v_accvgpr_read_b32 v72, a232
v_mfma_f32_16x16x32_bf16 v[76:79], a[132:135], a[44:47], v[76:79]
ds_read_b128 a[80:83], v2 offset:53248
v_accvgpr_read_b32 v73, a233
v_mfma_f32_16x16x32_bf16 v[84:87], a[128:131], a[48:51], v[84:87]
ds_read_b128 a[84:87], v3 offset:53248
v_accvgpr_read_b32 v74, a234
v_mfma_f32_16x16x32_bf16 v[84:87], a[132:135], a[52:55], v[84:87]
buffer_load_dwordx4 v19, s[12:15], s27 offen offset:3072 lds
v_mfma_f32_16x16x32_bf16 v[92:95], a[128:131], a[56:59], v[92:95]
s_add_u32 s27, s27, 524288
ds_read_b128 a[88:91], v2 offset:55296
v_accvgpr_read_b32 v75, a235
v_mfma_f32_16x16x32_bf16 v[92:95], a[132:135], a[60:63], v[92:95]
s_waitcnt lgkmcnt(5)
buffer_store_dwordx4 v[168:171], v1, s[4:7], s31 offen sc1
v_mfma_f32_16x16x32_bf16 v[100:103], a[136:139], a[0:3], v[100:103]
s_add_u32 m0, s28, 32768
ds_read_b64_tr_b16 a[128:129], v24 offset:0
v_accvgpr_read_b32 v96, a236
v_mfma_f32_16x16x32_bf16 v[100:103], a[140:143], a[4:7], v[100:103]
s_add_u32 s31, s31, s33
buffer_load_dwordx4 v12, s[8:11], s24 offen offset:0 lds
v_mfma_f32_16x16x32_bf16 v[108:111], a[136:139], a[8:11], v[108:111]
ds_read_b64_tr_b16 a[130:131], v24 offset:2048
v_accvgpr_read_b32 v97, a237
v_mfma_f32_16x16x32_bf16 v[108:111], a[140:143], a[12:15], v[108:111]
ds_read_b128 a[92:95], v3 offset:55296
v_accvgpr_read_b32 v98, a238
v_mfma_f32_16x16x32_bf16 v[116:119], a[136:139], a[16:19], v[116:119]
ds_read_b64_tr_b16 a[132:133], v24 offset:16384
v_accvgpr_read_b32 v99, a239
v_mfma_f32_16x16x32_bf16 v[116:119], a[140:143], a[20:23], v[116:119]
buffer_load_dwordx4 v13, s[8:11], s24 offen offset:1024 lds
v_mfma_f32_16x16x32_bf16 v[124:127], a[136:139], a[24:27], v[124:127]
ds_read_b64_tr_b16 a[134:135], v24 offset:18432
v_add_u32 v24, 32768, v24
v_mfma_f32_16x16x32_bf16 v[124:127], a[140:143], a[28:31], v[124:127]
v_cvt_pk_bf16_f32 v72, v72, v73
v_cvt_pk_bf16_f32 v73, v74, v75
v_mfma_f32_16x16x32_bf16 v[132:135], a[136:139], a[32:35], v[132:135]
ds_read_b128 a[96:99], v2 offset:57344
v_cvt_pk_bf16_f32 v74, v96, v97
v_mfma_f32_16x16x32_bf16 v[132:135], a[140:143], a[36:39], v[132:135]
buffer_load_dwordx4 v14, s[8:11], s24 offen offset:2048 lds
v_mfma_f32_16x16x32_bf16 v[140:143], a[136:139], a[40:43], v[140:143]
ds_read_b128 a[100:103], v3 offset:57344
v_cvt_pk_bf16_f32 v75, v98, v99
v_mfma_f32_16x16x32_bf16 v[140:143], a[140:143], a[44:47], v[140:143]
ds_read_b128 a[104:107], v2 offset:59392
v_accvgpr_read_b32 v80, a240
v_mfma_f32_16x16x32_bf16 v[148:151], a[136:139], a[48:51], v[148:151]
ds_read_b128 a[108:111], v3 offset:59392
v_accvgpr_read_b32 v81, a241
v_mfma_f32_16x16x32_bf16 v[148:151], a[140:143], a[52:55], v[148:151]
buffer_load_dwordx4 v15, s[8:11], s24 offen offset:3072 lds
v_mfma_f32_16x16x32_bf16 v[156:159], a[136:139], a[56:59], v[156:159]
s_add_u32 s24, s24, 128
ds_read_b128 a[112:115], v2 offset:61440
v_accvgpr_read_b32 v82, a242
v_mfma_f32_16x16x32_bf16 v[156:159], a[140:143], a[60:63], v[156:159]
s_waitcnt lgkmcnt(5)
buffer_store_dwordx4 v[176:179], v1, s[4:7], s31 offen sc1
v_mfma_f32_16x16x32_bf16 v[164:167], a[128:131], a[0:3], v[164:167]
s_add_u32 s31, s31, s32
ds_read_b64_tr_b16 a[136:137], v25 offset:0
v_accvgpr_read_b32 v83, a243
v_mfma_f32_16x16x32_bf16 v[164:167], a[132:135], a[4:7], v[164:167]
v_accvgpr_read_b32 v96, a244
v_accvgpr_read_b32 v97, a245
v_mfma_f32_16x16x32_bf16 v[172:175], a[128:131], a[8:11], v[172:175]
ds_read_b64_tr_b16 a[138:139], v25 offset:2048
v_accvgpr_read_b32 v98, a246
v_mfma_f32_16x16x32_bf16 v[172:175], a[132:135], a[12:15], v[172:175]
ds_read_b128 a[116:119], v3 offset:61440
v_accvgpr_read_b32 v99, a247
v_mfma_f32_16x16x32_bf16 v[180:183], a[128:131], a[16:19], v[180:183]
ds_read_b64_tr_b16 a[140:141], v25 offset:16384
v_cvt_pk_bf16_f32 v80, v80, v81
v_mfma_f32_16x16x32_bf16 v[180:183], a[132:135], a[20:23], v[180:183]
buffer_store_dwordx4 v[184:187], v1, s[4:7], s31 offen sc1
v_mfma_f32_16x16x32_bf16 v[188:191], a[128:131], a[24:27], v[188:191]
s_add_u32 s31, s31, s34
ds_read_b64_tr_b16 a[142:143], v25 offset:18432
v_add_u32 v25, 32768, v25
v_mfma_f32_16x16x32_bf16 v[188:191], a[132:135], a[28:31], v[188:191]
v_cvt_pk_bf16_f32 v81, v82, v83
v_cvt_pk_bf16_f32 v82, v96, v97
v_mfma_f32_16x16x32_bf16 v[196:199], a[128:131], a[32:35], v[196:199]
ds_read_b128 a[120:123], v2 offset:63488
v_cvt_pk_bf16_f32 v83, v98, v99
v_mfma_f32_16x16x32_bf16 v[196:199], a[132:135], a[36:39], v[196:199]
v_accvgpr_read_b32 v88, a248
v_accvgpr_read_b32 v89, a249
v_mfma_f32_16x16x32_bf16 v[204:207], a[128:131], a[40:43], v[204:207]
ds_read_b128 a[124:127], v3 offset:63488
v_accvgpr_read_b32 v90, a250
v_mfma_f32_16x16x32_bf16 v[204:207], a[132:135], a[44:47], v[204:207]
v_accvgpr_read_b32 v91, a251
v_accvgpr_read_b32 v96, a252
v_mfma_f32_16x16x32_bf16 v[212:215], a[128:131], a[48:51], v[212:215]
v_accvgpr_read_b32 v97, a253
v_accvgpr_read_b32 v98, a254
v_mfma_f32_16x16x32_bf16 v[212:215], a[132:135], a[52:55], v[212:215]
v_accvgpr_read_b32 v99, a255
v_cvt_pk_bf16_f32 v88, v88, v89
v_mfma_f32_16x16x32_bf16 v[220:223], a[128:131], a[56:59], v[220:223]
v_cvt_pk_bf16_f32 v89, v90, v91
v_cvt_pk_bf16_f32 v90, v96, v97
v_mfma_f32_16x16x32_bf16 v[220:223], a[132:135], a[60:63], v[220:223]
s_waitcnt vmcnt(23) lgkmcnt(0)
s_barrier
v_cvt_pk_bf16_f32 v91, v98, v99
v_mfma_f32_16x16x32_bf16 v[224:227], a[136:139], a[0:3], v[224:227]
s_add_u32 m0, s29, 98304
ds_read_b64_tr_b16 a[128:129], v22 offset:0
v_mfma_f32_16x16x32_bf16 v[224:227], a[140:143], a[4:7], v[224:227]
buffer_load_dwordx4 v16, s[12:15], s26 offen offset:0 lds
v_mfma_f32_16x16x32_bf16 v[228:231], a[136:139], a[8:11], v[228:231]
ds_read_b64_tr_b16 a[130:131], v22 offset:2048
v_mfma_f32_16x16x32_bf16 v[228:231], a[140:143], a[12:15], v[228:231]
buffer_store_dwordx4 v[192:195], v1, s[4:7], s31 offen sc1
v_mfma_f32_16x16x32_bf16 v[232:235], a[136:139], a[16:19], v[232:235]
s_add_u32 s31, s31, s32
ds_read_b64_tr_b16 a[132:133], v22 offset:16384
v_mfma_f32_16x16x32_bf16 v[232:235], a[140:143], a[20:23], v[232:235]
buffer_load_dwordx4 v17, s[12:15], s26 offen offset:1024 lds
v_mfma_f32_16x16x32_bf16 v[236:239], a[136:139], a[24:27], v[236:239]
ds_read_b64_tr_b16 a[134:135], v22 offset:18432
v_add_u32 v22, 4294901760, v22
v_mfma_f32_16x16x32_bf16 v[236:239], a[140:143], a[28:31], v[236:239]
v_mfma_f32_16x16x32_bf16 v[240:243], a[136:139], a[32:35], v[240:243]
v_mfma_f32_16x16x32_bf16 v[240:243], a[140:143], a[36:39], v[240:243]
buffer_load_dwordx4 v18, s[12:15], s26 offen offset:2048 lds
v_mfma_f32_16x16x32_bf16 v[244:247], a[136:139], a[40:43], v[244:247]
v_mfma_f32_16x16x32_bf16 v[244:247], a[140:143], a[44:47], v[244:247]
v_mfma_f32_16x16x32_bf16 v[248:251], a[136:139], a[48:51], v[248:251]
v_mfma_f32_16x16x32_bf16 v[248:251], a[140:143], a[52:55], v[248:251]
buffer_load_dwordx4 v19, s[12:15], s26 offen offset:3072 lds
v_mfma_f32_16x16x32_bf16 v[252:255], a[136:139], a[56:59], v[252:255]
s_add_u32 s26, s26, 524288
v_mfma_f32_16x16x32_bf16 v[252:255], a[140:143], a[60:63], v[252:255]
s_waitcnt lgkmcnt(0)
v_mfma_f32_16x16x32_bf16 v[36:39], a[128:131], a[64:67], v[36:39]
s_add_u32 m0, s29, 114688
ds_read_b64_tr_b16 a[136:137], v23 offset:0
v_mfma_f32_16x16x32_bf16 v[36:39], a[132:135], a[68:71], v[36:39]
buffer_load_dwordx4 v16, s[12:15], s27 offen offset:0 lds
v_mfma_f32_16x16x32_bf16 v[44:47], a[128:131], a[72:75], v[44:47]
ds_read_b64_tr_b16 a[138:139], v23 offset:2048
v_mfma_f32_16x16x32_bf16 v[44:47], a[132:135], a[76:79], v[44:47]
ds_read_b128 a[0:3], v2 offset:0
ds_read_b128 a[4:7], v3 offset:0
v_mfma_f32_16x16x32_bf16 v[52:55], a[128:131], a[80:83], v[52:55]
ds_read_b64_tr_b16 a[140:141], v23 offset:16384
v_mfma_f32_16x16x32_bf16 v[52:55], a[132:135], a[84:87], v[52:55]
buffer_load_dwordx4 v17, s[12:15], s27 offen offset:1024 lds
v_mfma_f32_16x16x32_bf16 v[60:63], a[128:131], a[88:91], v[60:63]
ds_read_b64_tr_b16 a[142:143], v23 offset:18432
v_add_u32 v23, 4294901760, v23
v_mfma_f32_16x16x32_bf16 v[60:63], a[132:135], a[92:95], v[60:63]
buffer_store_dwordx4 v[200:203], v1, s[4:7], s31 offen sc1
v_mfma_f32_16x16x32_bf16 v[68:71], a[128:131], a[96:99], v[68:71]
s_add_u32 s31, s31, s33
ds_read_b128 a[8:11], v2 offset:2048
v_mfma_f32_16x16x32_bf16 v[68:71], a[132:135], a[100:103], v[68:71]
buffer_load_dwordx4 v18, s[12:15], s27 offen offset:2048 lds
v_mfma_f32_16x16x32_bf16 v[76:79], a[128:131], a[104:107], v[76:79]
ds_read_b128 a[12:15], v3 offset:2048
v_mfma_f32_16x16x32_bf16 v[76:79], a[132:135], a[108:111], v[76:79]
ds_read_b128 a[16:19], v2 offset:4096
v_mfma_f32_16x16x32_bf16 v[84:87], a[128:131], a[112:115], v[84:87]
ds_read_b128 a[20:23], v3 offset:4096
v_mfma_f32_16x16x32_bf16 v[84:87], a[132:135], a[116:119], v[84:87]
buffer_load_dwordx4 v19, s[12:15], s27 offen offset:3072 lds
v_mfma_f32_16x16x32_bf16 v[92:95], a[128:131], a[120:123], v[92:95]
s_add_u32 s27, s27, 524288
ds_read_b128 a[24:27], v2 offset:6144
v_mfma_f32_16x16x32_bf16 v[92:95], a[132:135], a[124:127], v[92:95]
s_waitcnt lgkmcnt(5)
buffer_store_dwordx4 v[208:211], v1, s[4:7], s31 offen sc1
v_mfma_f32_16x16x32_bf16 v[100:103], a[136:139], a[64:67], v[100:103]
s_add_u32 s31, s31, s32
ds_read_b64_tr_b16 a[128:129], v24 offset:0
v_mfma_f32_16x16x32_bf16 v[100:103], a[140:143], a[68:71], v[100:103]
v_mfma_f32_16x16x32_bf16 v[108:111], a[136:139], a[72:75], v[108:111]
ds_read_b64_tr_b16 a[130:131], v24 offset:2048
v_mfma_f32_16x16x32_bf16 v[108:111], a[140:143], a[76:79], v[108:111]
ds_read_b128 a[28:31], v3 offset:6144
v_mfma_f32_16x16x32_bf16 v[116:119], a[136:139], a[80:83], v[116:119]
ds_read_b64_tr_b16 a[132:133], v24 offset:16384
v_mfma_f32_16x16x32_bf16 v[116:119], a[140:143], a[84:87], v[116:119]
v_mfma_f32_16x16x32_bf16 v[124:127], a[136:139], a[88:91], v[124:127]
ds_read_b64_tr_b16 a[134:135], v24 offset:18432
v_add_u32 v24, 4294901760, v24
v_mfma_f32_16x16x32_bf16 v[124:127], a[140:143], a[92:95], v[124:127]
v_mfma_f32_16x16x32_bf16 v[132:135], a[136:139], a[96:99], v[132:135]
ds_read_b128 a[32:35], v2 offset:8192
v_mfma_f32_16x16x32_bf16 v[132:135], a[140:143], a[100:103], v[132:135]
buffer_store_dwordx4 v[216:219], v1, s[4:7], s31 offen sc1
v_mfma_f32_16x16x32_bf16 v[140:143], a[136:139], a[104:107], v[140:143]
s_add_u32 s31, s31, s35
ds_read_b128 a[36:39], v3 offset:8192
v_mfma_f32_16x16x32_bf16 v[140:143], a[140:143], a[108:111], v[140:143]
ds_read_b128 a[40:43], v2 offset:10240
v_mfma_f32_16x16x32_bf16 v[148:151], a[136:139], a[112:115], v[148:151]
ds_read_b128 a[44:47], v3 offset:10240
v_mfma_f32_16x16x32_bf16 v[148:151], a[140:143], a[116:119], v[148:151]
v_mfma_f32_16x16x32_bf16 v[156:159], a[136:139], a[120:123], v[156:159]
ds_read_b128 a[48:51], v2 offset:12288
v_mfma_f32_16x16x32_bf16 v[156:159], a[140:143], a[124:127], v[156:159]
s_waitcnt lgkmcnt(5)
v_mfma_f32_16x16x32_bf16 v[164:167], a[128:131], a[64:67], v[164:167]
ds_read_b64_tr_b16 a[136:137], v25 offset:0
v_mfma_f32_16x16x32_bf16 v[164:167], a[132:135], a[68:71], v[164:167]
v_mfma_f32_16x16x32_bf16 v[172:175], a[128:131], a[72:75], v[172:175]
ds_read_b64_tr_b16 a[138:139], v25 offset:2048
v_mfma_f32_16x16x32_bf16 v[172:175], a[132:135], a[76:79], v[172:175]
ds_read_b128 a[52:55], v3 offset:12288
v_mfma_f32_16x16x32_bf16 v[180:183], a[128:131], a[80:83], v[180:183]
ds_read_b64_tr_b16 a[140:141], v25 offset:16384
v_mfma_f32_16x16x32_bf16 v[180:183], a[132:135], a[84:87], v[180:183]
buffer_store_dwordx4 v[32:35], v1, s[4:7], s31 offen sc1
v_mfma_f32_16x16x32_bf16 v[188:191], a[128:131], a[88:91], v[188:191]
s_add_u32 s31, s31, s32
ds_read_b64_tr_b16 a[142:143], v25 offset:18432
v_add_u32 v25, 4294901760, v25
v_mfma_f32_16x16x32_bf16 v[188:191], a[132:135], a[92:95], v[188:191]
v_mfma_f32_16x16x32_bf16 v[196:199], a[128:131], a[96:99], v[196:199]
ds_read_b128 a[56:59], v2 offset:14336
v_mfma_f32_16x16x32_bf16 v[196:199], a[132:135], a[100:103], v[196:199]
v_mfma_f32_16x16x32_bf16 v[204:207], a[128:131], a[104:107], v[204:207]
ds_read_b128 a[60:63], v3 offset:14336
v_mfma_f32_16x16x32_bf16 v[204:207], a[132:135], a[108:111], v[204:207]
v_mfma_f32_16x16x32_bf16 v[212:215], a[128:131], a[112:115], v[212:215]
v_mfma_f32_16x16x32_bf16 v[212:215], a[132:135], a[116:119], v[212:215]
v_mfma_f32_16x16x32_bf16 v[220:223], a[128:131], a[120:123], v[220:223]
v_mfma_f32_16x16x32_bf16 v[220:223], a[132:135], a[124:127], v[220:223]
s_waitcnt vmcnt(20) lgkmcnt(0)
s_barrier
v_mfma_f32_16x16x32_bf16 v[224:227], a[136:139], a[64:67], v[224:227]
s_add_u32 m0, s29, 131072
ds_read_b64_tr_b16 a[128:129], v22 offset:0
v_mfma_f32_16x16x32_bf16 v[224:227], a[140:143], a[68:71], v[224:227]
buffer_load_dwordx4 v16, s[12:15], s26 offen offset:0 lds
v_mfma_f32_16x16x32_bf16 v[228:231], a[136:139], a[72:75], v[228:231]
ds_read_b64_tr_b16 a[130:131], v22 offset:2048
v_mfma_f32_16x16x32_bf16 v[228:231], a[140:143], a[76:79], v[228:231]
PAD_7:
s_cbranch_execz M_tret
buffer_store_dwordx4 v[40:43], v1, s[4:7], s31 offen sc1
v_mfma_f32_16x16x32_bf16 v[232:235], a[136:139], a[80:83], v[232:235]
s_add_u32 s31, s31, s33
ds_read_b64_tr_b16 a[132:133], v22 offset:16384
v_mfma_f32_16x16x32_bf16 v[232:235], a[140:143], a[84:87], v[232:235]
buffer_load_dwordx4 v17, s[12:15], s26 offen offset:1024 lds
v_mfma_f32_16x16x32_bf16 v[236:239], a[136:139], a[88:91], v[236:239]
ds_read_b64_tr_b16 a[134:135], v22 offset:18432
v_add_u32 v22, 32768, v22
v_mfma_f32_16x16x32_bf16 v[236:239], a[140:143], a[92:95], v[236:239]
v_mfma_f32_16x16x32_bf16 v[240:243], a[136:139], a[96:99], v[240:243]
v_mfma_f32_16x16x32_bf16 v[240:243], a[140:143], a[100:103], v[240:243]
buffer_load_dwordx4 v18, s[12:15], s26 offen offset:2048 lds
v_mfma_f32_16x16x32_bf16 v[244:247], a[136:139], a[104:107], v[244:247]
v_mfma_f32_16x16x32_bf16 v[244:247], a[140:143], a[108:111], v[244:247]
v_mfma_f32_16x16x32_bf16 v[248:251], a[136:139], a[112:115], v[248:251]
v_mfma_f32_16x16x32_bf16 v[248:251], a[140:143], a[116:119], v[248:251]
buffer_load_dwordx4 v19, s[12:15], s26 offen offset:3072 lds
v_mfma_f32_16x16x32_bf16 v[252:255], a[136:139], a[120:123], v[252:255]
s_add_u32 s26, s26, 524288
v_mfma_f32_16x16x32_bf16 v[252:255], a[140:143], a[124:127], v[252:255]
s_waitcnt lgkmcnt(0)
v_mfma_f32_16x16x32_bf16 v[36:39], a[128:131], a[0:3], v[36:39]
s_add_u32 m0, s29, 147456
ds_read_b64_tr_b16 a[136:137], v23 offset:0
v_mfma_f32_16x16x32_bf16 v[36:39], a[132:135], a[4:7], v[36:39]
buffer_load_dwordx4 v16, s[12:15], s27 offen offset:0 lds
v_mfma_f32_16x16x32_bf16 v[44:47], a[128:131], a[8:11], v[44:47]
s_lshl_b32 s22, s20, 7
ds_read_b64_tr_b16 a[138:139], v23 offset:2048
v_bfe_u32 v20, v1, 4, 3
v_mfma_f32_16x16x32_bf16 v[44:47], a[132:135], a[12:15], v[44:47]
s_add_u32 s70, s22, 94371840
ds_read_b128 a[64:67], v2 offset:16384
ds_read_b128 a[68:71], v3 offset:16384
v_mfma_f32_16x16x32_bf16 v[52:55], a[128:131], a[16:19], v[52:55]
s_lshr_b32 s22, s2, 4
ds_read_b64_tr_b16 a[140:141], v23 offset:16384
v_lshlrev_b32 v20, 3, v20
v_mfma_f32_16x16x32_bf16 v[52:55], a[132:135], a[20:23], v[52:55]
s_lshl_b32 s22, s22, 2
buffer_load_dwordx4 v17, s[12:15], s27 offen offset:1024 lds
v_mfma_f32_16x16x32_bf16 v[60:63], a[128:131], a[24:27], v[60:63]
s_add_u32 s66, s70, s22
ds_read_b64_tr_b16 a[142:143], v23 offset:18432
v_add_u32 v23, 32768, v23
v_mfma_f32_16x16x32_bf16 v[60:63], a[132:135], a[28:31], v[60:63]
s_and_b32 s22, s2, 16
buffer_store_dwordx4 v[48:51], v1, s[4:7], s31 offen sc1
v_mfma_f32_16x16x32_bf16 v[68:71], a[128:131], a[32:35], v[68:71]
s_add_u32 s31, s31, s32
ds_read_b128 a[72:75], v2 offset:18432
v_add_u32 v15, 2052, v20
v_mfma_f32_16x16x32_bf16 v[68:71], a[132:135], a[36:39], v[68:71]
s_lshl_b32 s22, s22, 7
buffer_load_dwordx4 v18, s[12:15], s27 offen offset:2048 lds
v_mfma_f32_16x16x32_bf16 v[76:79], a[128:131], a[40:43], v[76:79]
s_add_u32 s66, s66, s22
ds_read_b128 a[76:79], v3 offset:18432
v_mfma_f32_16x16x32_bf16 v[76:79], a[132:135], a[44:47], v[76:79]
s_lshl_b32 s67, s20, 20
ds_read_b128 a[80:83], v2 offset:20480
v_mfma_f32_16x16x32_bf16 v[84:87], a[128:131], a[48:51], v[84:87]
s_lshl_b32 s22, s37, 16
ds_read_b128 a[84:87], v3 offset:20480
v_mfma_f32_16x16x32_bf16 v[84:87], a[132:135], a[52:55], v[84:87]
s_add_u32 s67, s67, s22
buffer_load_dwordx4 v19, s[12:15], s27 offen offset:3072 lds
v_mfma_f32_16x16x32_bf16 v[92:95], a[128:131], a[56:59], v[92:95]
s_waitcnt lgkmcnt(5)
s_add_u32 s27, s27, 524288
ds_read_b128 a[88:91], v2 offset:22528
v_mfma_f32_16x16x32_bf16 v[92:95], a[132:135], a[60:63], v[92:95]
s_lshl_b32 s22, s3, 11
buffer_store_dwordx4 v[56:59], v1, s[4:7], s31 offen sc1
v_mfma_f32_16x16x32_bf16 v[100:103], a[136:139], a[0:3], v[100:103]
s_waitcnt lgkmcnt(5)
s_add_u32 s31, s31, s34
ds_read_b64_tr_b16 a[128:129], v24 offset:0
v_mfma_f32_16x16x32_bf16 v[100:103], a[140:143], a[4:7], v[100:103]
s_add_u32 s67, s67, s22
v_mfma_f32_16x16x32_bf16 v[108:111], a[136:139], a[8:11], v[108:111]
s_add_u32 s67, s67, 33554432
ds_read_b64_tr_b16 a[130:131], v24 offset:2048
v_mfma_f32_16x16x32_bf16 v[108:111], a[140:143], a[12:15], v[108:111]
s_mov_b32 s68, 1035512379
ds_read_b128 a[92:95], v3 offset:22528
v_mfma_f32_16x16x32_bf16 v[116:119], a[136:139], a[16:19], v[116:119]
s_mov_b32 s69, 1035512379
ds_read_b64_tr_b16 a[132:133], v24 offset:16384
v_mfma_f32_16x16x32_bf16 v[116:119], a[140:143], a[20:23], v[116:119]
buffer_store_dwordx4 v[64:67], v1, s[4:7], s31 offen sc1
v_mfma_f32_16x16x32_bf16 v[124:127], a[136:139], a[24:27], v[124:127]
s_add_u32 s31, s31, s32
ds_read_b64_tr_b16 a[134:135], v24 offset:18432
v_add_u32 v24, 32768, v24
v_mfma_f32_16x16x32_bf16 v[124:127], a[140:143], a[28:31], v[124:127]
v_mfma_f32_16x16x32_bf16 v[132:135], a[136:139], a[32:35], v[132:135]
ds_read_b128 a[96:99], v2 offset:24576
v_mfma_f32_16x16x32_bf16 v[132:135], a[140:143], a[36:39], v[132:135]
v_mfma_f32_16x16x32_bf16 v[140:143], a[136:139], a[40:43], v[140:143]
ds_read_b128 a[100:103], v3 offset:24576
v_mfma_f32_16x16x32_bf16 v[140:143], a[140:143], a[44:47], v[140:143]
ds_read_b128 a[104:107], v2 offset:26624
v_mfma_f32_16x16x32_bf16 v[148:151], a[136:139], a[48:51], v[148:151]
ds_read_b128 a[108:111], v3 offset:26624
v_mfma_f32_16x16x32_bf16 v[148:151], a[140:143], a[52:55], v[148:151]
v_mfma_f32_16x16x32_bf16 v[156:159], a[136:139], a[56:59], v[156:159]
ds_read_b128 a[112:115], v2 offset:28672
v_mfma_f32_16x16x32_bf16 v[156:159], a[140:143], a[60:63], v[156:159]
s_waitcnt lgkmcnt(5)
buffer_store_dwordx4 v[72:75], v1, s[4:7], s31 offen sc1
v_mfma_f32_16x16x32_bf16 v[164:167], a[128:131], a[0:3], v[164:167]
s_add_u32 s31, s31, s33
ds_read_b64_tr_b16 a[136:137], v25 offset:0
v_mfma_f32_16x16x32_bf16 v[164:167], a[132:135], a[4:7], v[164:167]
v_mfma_f32_16x16x32_bf16 v[172:175], a[128:131], a[8:11], v[172:175]
ds_read_b64_tr_b16 a[138:139], v25 offset:2048
v_mfma_f32_16x16x32_bf16 v[172:175], a[132:135], a[12:15], v[172:175]
ds_read_b128 a[116:119], v3 offset:28672
v_mfma_f32_16x16x32_bf16 v[180:183], a[128:131], a[16:19], v[180:183]
ds_read_b64_tr_b16 a[140:141], v25 offset:16384
v_mfma_f32_16x16x32_bf16 v[180:183], a[132:135], a[20:23], v[180:183]
v_mfma_f32_16x16x32_bf16 v[188:191], a[128:131], a[24:27], v[188:191]
ds_read_b64_tr_b16 a[142:143], v25 offset:18432
v_add_u32 v25, 32768, v25
v_mfma_f32_16x16x32_bf16 v[188:191], a[132:135], a[28:31], v[188:191]
v_mfma_f32_16x16x32_bf16 v[196:199], a[128:131], a[32:35], v[196:199]
ds_read_b128 a[120:123], v2 offset:30720
v_mfma_f32_16x16x32_bf16 v[196:199], a[132:135], a[36:39], v[196:199]
buffer_store_dwordx4 v[80:83], v1, s[4:7], s31 offen sc1
v_mfma_f32_16x16x32_bf16 v[204:207], a[128:131], a[40:43], v[204:207]
s_add_u32 s31, s31, s32
ds_read_b128 a[124:127], v3 offset:30720
v_mfma_f32_16x16x32_bf16 v[204:207], a[132:135], a[44:47], v[204:207]
v_mfma_f32_16x16x32_bf16 v[212:215], a[128:131], a[48:51], v[212:215]
v_mfma_f32_16x16x32_bf16 v[212:215], a[132:135], a[52:55], v[212:215]
v_mfma_f32_16x16x32_bf16 v[220:223], a[128:131], a[56:59], v[220:223]
v_mfma_f32_16x16x32_bf16 v[220:223], a[132:135], a[60:63], v[220:223]
s_waitcnt vmcnt(17) lgkmcnt(0)
s_barrier
v_mfma_f32_16x16x32_bf16 v[224:227], a[136:139], a[0:3], v[224:227]
ds_read_b64_tr_b16 a[128:129], v22 offset:0
v_mfma_f32_16x16x32_bf16 v[224:227], a[140:143], a[4:7], v[224:227]
v_mfma_f32_16x16x32_bf16 v[228:231], a[136:139], a[8:11], v[228:231]
ds_read_b64_tr_b16 a[130:131], v22 offset:2048
v_mfma_f32_16x16x32_bf16 v[228:231], a[140:143], a[12:15], v[228:231]
buffer_store_dwordx4 v[88:91], v1, s[4:7], s31 offen sc1
v_mfma_f32_16x16x32_bf16 v[232:235], a[136:139], a[16:19], v[232:235]
ds_read_b64_tr_b16 a[132:133], v22 offset:16384
v_mfma_f32_16x16x32_bf16 v[232:235], a[140:143], a[20:23], v[232:235]
v_mfma_f32_16x16x32_bf16 v[236:239], a[136:139], a[24:27], v[236:239]
ds_read_b64_tr_b16 a[134:135], v22 offset:18432
v_add_u32 v22, 32768, v22
v_mfma_f32_16x16x32_bf16 v[236:239], a[140:143], a[28:31], v[236:239]
v_mfma_f32_16x16x32_bf16 v[240:243], a[136:139], a[32:35], v[240:243]
v_mfma_f32_16x16x32_bf16 v[240:243], a[140:143], a[36:39], v[240:243]
v_mfma_f32_16x16x32_bf16 v[244:247], a[136:139], a[40:43], v[244:247]
v_mfma_f32_16x16x32_bf16 v[244:247], a[140:143], a[44:47], v[244:247]
v_mfma_f32_16x16x32_bf16 v[248:251], a[136:139], a[48:51], v[248:251]
v_mfma_f32_16x16x32_bf16 v[248:251], a[140:143], a[52:55], v[248:251]
v_mfma_f32_16x16x32_bf16 v[252:255], a[136:139], a[56:59], v[252:255]
v_mfma_f32_16x16x32_bf16 v[252:255], a[140:143], a[60:63], v[252:255]
s_waitcnt lgkmcnt(0)
v_mfma_f32_16x16x32_bf16 v[36:39], a[128:131], a[64:67], v[36:39]
ds_read_b64_tr_b16 a[136:137], v23 offset:0
v_mfma_f32_16x16x32_bf16 v[36:39], a[132:135], a[68:71], v[36:39]
v_mfma_f32_16x16x32_bf16 v[44:47], a[128:131], a[72:75], v[44:47]
ds_read_b64_tr_b16 a[138:139], v23 offset:2048
v_mfma_f32_16x16x32_bf16 v[44:47], a[132:135], a[76:79], v[44:47]
ds_read_b128 a[0:3], v2 offset:32768
ds_read_b128 a[4:7], v3 offset:32768
v_mfma_f32_16x16x32_bf16 v[52:55], a[128:131], a[80:83], v[52:55]
ds_read_b64_tr_b16 a[140:141], v23 offset:16384
v_mfma_f32_16x16x32_bf16 v[52:55], a[132:135], a[84:87], v[52:55]
v_mfma_f32_16x16x32_bf16 v[60:63], a[128:131], a[88:91], v[60:63]
ds_read_b64_tr_b16 a[142:143], v23 offset:18432
v_add_u32 v23, 32768, v23
v_mfma_f32_16x16x32_bf16 v[60:63], a[132:135], a[92:95], v[60:63]
v_mfma_f32_16x16x32_bf16 v[68:71], a[128:131], a[96:99], v[68:71]
ds_read_b128 a[8:11], v2 offset:34816
v_mfma_f32_16x16x32_bf16 v[68:71], a[132:135], a[100:103], v[68:71]
v_mfma_f32_16x16x32_bf16 v[76:79], a[128:131], a[104:107], v[76:79]
ds_read_b128 a[12:15], v3 offset:34816
v_mfma_f32_16x16x32_bf16 v[76:79], a[132:135], a[108:111], v[76:79]
ds_read_b128 a[16:19], v2 offset:36864
v_mfma_f32_16x16x32_bf16 v[84:87], a[128:131], a[112:115], v[84:87]
ds_read_b128 a[20:23], v3 offset:36864
v_mfma_f32_16x16x32_bf16 v[84:87], a[132:135], a[116:119], v[84:87]
v_mfma_f32_16x16x32_bf16 v[92:95], a[128:131], a[120:123], v[92:95]
ds_read_b128 a[24:27], v2 offset:38912
v_mfma_f32_16x16x32_bf16 v[92:95], a[132:135], a[124:127], v[92:95]
s_waitcnt lgkmcnt(5)
v_mfma_f32_16x16x32_bf16 v[100:103], a[136:139], a[64:67], v[100:103]
ds_read_b64_tr_b16 a[128:129], v24 offset:0
v_mfma_f32_16x16x32_bf16 v[100:103], a[140:143], a[68:71], v[100:103]
v_mfma_f32_16x16x32_bf16 v[108:111], a[136:139], a[72:75], v[108:111]
ds_read_b64_tr_b16 a[130:131], v24 offset:2048
v_mfma_f32_16x16x32_bf16 v[108:111], a[140:143], a[76:79], v[108:111]
ds_read_b128 a[28:31], v3 offset:38912
v_mfma_f32_16x16x32_bf16 v[116:119], a[136:139], a[80:83], v[116:119]
ds_read_b64_tr_b16 a[132:133], v24 offset:16384
v_mfma_f32_16x16x32_bf16 v[116:119], a[140:143], a[84:87], v[116:119]
v_mfma_f32_16x16x32_bf16 v[124:127], a[136:139], a[88:91], v[124:127]
ds_read_b64_tr_b16 a[134:135], v24 offset:18432
v_add_u32 v24, 32768, v24
v_mfma_f32_16x16x32_bf16 v[124:127], a[140:143], a[92:95], v[124:127]
v_mfma_f32_16x16x32_bf16 v[132:135], a[136:139], a[96:99], v[132:135]
ds_read_b128 a[32:35], v2 offset:40960
v_mfma_f32_16x16x32_bf16 v[132:135], a[140:143], a[100:103], v[132:135]
v_mfma_f32_16x16x32_bf16 v[140:143], a[136:139], a[104:107], v[140:143]
ds_read_b128 a[36:39], v3 offset:40960
v_mfma_f32_16x16x32_bf16 v[140:143], a[140:143], a[108:111], v[140:143]
ds_read_b128 a[40:43], v2 offset:43008
v_mfma_f32_16x16x32_bf16 v[148:151], a[136:139], a[112:115], v[148:151]
ds_read_b128 a[44:47], v3 offset:43008
v_mfma_f32_16x16x32_bf16 v[148:151], a[140:143], a[116:119], v[148:151]
v_mfma_f32_16x16x32_bf16 v[156:159], a[136:139], a[120:123], v[156:159]
ds_read_b128 a[48:51], v2 offset:45056
v_mfma_f32_16x16x32_bf16 v[156:159], a[140:143], a[124:127], v[156:159]
s_waitcnt lgkmcnt(5)
v_mfma_f32_16x16x32_bf16 v[164:167], a[128:131], a[64:67], v[164:167]
ds_read_b64_tr_b16 a[136:137], v25 offset:0
v_mfma_f32_16x16x32_bf16 v[164:167], a[132:135], a[68:71], v[164:167]
v_mfma_f32_16x16x32_bf16 v[172:175], a[128:131], a[72:75], v[172:175]
ds_read_b64_tr_b16 a[138:139], v25 offset:2048
v_mfma_f32_16x16x32_bf16 v[172:175], a[132:135], a[76:79], v[172:175]
ds_read_b128 a[52:55], v3 offset:45056
v_mfma_f32_16x16x32_bf16 v[180:183], a[128:131], a[80:83], v[180:183]
ds_read_b64_tr_b16 a[140:141], v25 offset:16384
v_mfma_f32_16x16x32_bf16 v[180:183], a[132:135], a[84:87], v[180:183]
v_mfma_f32_16x16x32_bf16 v[188:191], a[128:131], a[88:91], v[188:191]
ds_read_b64_tr_b16 a[142:143], v25 offset:18432
v_add_u32 v25, 32768, v25
v_mfma_f32_16x16x32_bf16 v[188:191], a[132:135], a[92:95], v[188:191]
v_mfma_f32_16x16x32_bf16 v[196:199], a[128:131], a[96:99], v[196:199]
ds_read_b128 a[56:59], v2 offset:47104
v_mfma_f32_16x16x32_bf16 v[196:199], a[132:135], a[100:103], v[196:199]
v_mfma_f32_16x16x32_bf16 v[204:207], a[128:131], a[104:107], v[204:207]
ds_read_b128 a[60:63], v3 offset:47104
v_mfma_f32_16x16x32_bf16 v[204:207], a[132:135], a[108:111], v[204:207]
v_mfma_f32_16x16x32_bf16 v[212:215], a[128:131], a[112:115], v[212:215]
v_mfma_f32_16x16x32_bf16 v[212:215], a[132:135], a[116:119], v[212:215]
v_mfma_f32_16x16x32_bf16 v[220:223], a[128:131], a[120:123], v[220:223]
v_mfma_f32_16x16x32_bf16 v[220:223], a[132:135], a[124:127], v[220:223]
s_waitcnt vmcnt(0) lgkmcnt(0)
s_barrier
v_mfma_f32_16x16x32_bf16 v[224:227], a[136:139], a[64:67], v[224:227]
ds_read_b64_tr_b16 a[128:129], v22 offset:0
v_mfma_f32_16x16x32_bf16 v[224:227], a[140:143], a[68:71], v[224:227]
buffer_store_dword v27, v26, s[4:7], s66 offen sc1
v_mfma_f32_16x16x32_bf16 v[228:231], a[136:139], a[72:75], v[228:231]
ds_read_b64_tr_b16 a[130:131], v22 offset:2048
v_mfma_f32_16x16x32_bf16 v[228:231], a[140:143], a[76:79], v[228:231]
v_mfma_f32_16x16x32_bf16 v[232:235], a[136:139], a[80:83], v[232:235]
ds_read_b64_tr_b16 a[132:133], v22 offset:16384
v_mfma_f32_16x16x32_bf16 v[232:235], a[140:143], a[84:87], v[232:235]
v_mfma_f32_16x16x32_bf16 v[236:239], a[136:139], a[88:91], v[236:239]
ds_read_b64_tr_b16 a[134:135], v22 offset:18432
v_mfma_f32_16x16x32_bf16 v[236:239], a[140:143], a[92:95], v[236:239]
v_mfma_f32_16x16x32_bf16 v[240:243], a[136:139], a[96:99], v[240:243]
v_mfma_f32_16x16x32_bf16 v[240:243], a[140:143], a[100:103], v[240:243]
v_mfma_f32_16x16x32_bf16 v[244:247], a[136:139], a[104:107], v[244:247]
v_mfma_f32_16x16x32_bf16 v[244:247], a[140:143], a[108:111], v[244:247]
v_mfma_f32_16x16x32_bf16 v[248:251], a[136:139], a[112:115], v[248:251]
v_mfma_f32_16x16x32_bf16 v[248:251], a[140:143], a[116:119], v[248:251]
v_mfma_f32_16x16x32_bf16 v[252:255], a[136:139], a[120:123], v[252:255]
v_mfma_f32_16x16x32_bf16 v[252:255], a[140:143], a[124:127], v[252:255]
s_waitcnt lgkmcnt(0)
v_mfma_f32_16x16x32_bf16 v[36:39], a[128:131], a[0:3], v[36:39]
s_lshl_b32 s18, s3, 13
ds_read_b64_tr_b16 a[136:137], v23 offset:0
v_lshrrev_b32 v28, 6, v0
v_mfma_f32_16x16x32_bf16 v[36:39], a[132:135], a[4:7], v[36:39]
s_lshl_b32 s30, s20, 20
v_lshl_add_u32 v28, v28, 11, v1
v_add_u32 v28, 65536, v28
v_mfma_f32_16x16x32_bf16 v[44:47], a[128:131], a[8:11], v[44:47]
s_add_u32 s30, s30, s18
ds_read_b64_tr_b16 a[138:139], v23 offset:2048
v_lshrrev_b32 v3, 6, v0
v_mfma_f32_16x16x32_bf16 v[44:47], a[132:135], a[12:15], v[44:47]
s_lshl_b32 s22, s21, 1
v_and_b32 v4, 63, v0
v_add_u32 v2, 0x10000, v1
v_mfma_f32_16x16x32_bf16 v[52:55], a[128:131], a[16:19], v[52:55]
s_and_b32 s84, s2, 1
ds_read_b64_tr_b16 a[140:141], v23 offset:16384
v_and_b32 v5, 15, v4
v_mfma_f32_16x16x32_bf16 v[52:55], a[132:135], a[20:23], v[52:55]
s_mul_i32 s84, s84, 0
v_lshrrev_b32 v6, 4, v4
v_lshlrev_b32 v6, 2, v6
v_mfma_f32_16x16x32_bf16 v[60:63], a[128:131], a[24:27], v[60:63]
s_add_u32 s84, s84, 2386092
ds_read_b64_tr_b16 a[142:143], v23 offset:18432
v_sub_u32 v5, v5, v6
v_mfma_f32_16x16x32_bf16 v[60:63], a[132:135], a[28:31], v[60:63]
s_lshl_b32 s85, s21, 2
v_lshl_add_u32 v5, v3, 4, v5
v_cmp_gt_i32 s[32:33], 0, v5
v_mfma_f32_16x16x32_bf16 v[68:71], a[128:131], a[32:35], v[68:71]
s_lshr_b32 s85, s84, s85
v_cmp_gt_i32 s[34:35], 1, v5
v_cmp_gt_i32 s[36:37], 2, v5
v_mfma_f32_16x16x32_bf16 v[68:71], a[132:135], a[36:39], v[68:71]
s_and_b32 s9, s85, 15
v_cmp_gt_i32 s[38:39], 3, v5
v_cmp_gt_i32 s[40:41], 16, v5
v_mfma_f32_16x16x32_bf16 v[76:79], a[128:131], a[40:43], v[76:79]
s_and_b32 s84, s85, 1
v_cmp_gt_i32 s[42:43], 17, v5
v_cmp_gt_i32 s[44:45], 18, v5
v_mfma_f32_16x16x32_bf16 v[76:79], a[132:135], a[44:47], v[76:79]
s_lshl_b32 s84, s84, 17
v_cmp_gt_i32 s[46:47], 19, v5
v_cmp_gt_i32 s[48:49], 32, v5
v_mfma_f32_16x16x32_bf16 v[84:87], a[128:131], a[48:51], v[84:87]
s_add_u32 s84, s84, s18
v_cmp_gt_i32 s[50:51], 33, v5
v_cmp_gt_i32 s[52:53], 34, v5
v_mfma_f32_16x16x32_bf16 v[84:87], a[132:135], a[52:55], v[84:87]
s_xor_b32 s85, s84, 0x20000
v_cmp_gt_i32 s[54:55], 35, v5
v_cmp_gt_i32 s[56:57], 48, v5
v_mfma_f32_16x16x32_bf16 v[92:95], a[128:131], a[56:59], v[92:95]
s_sub_u32 s29, 15, s21
v_cmp_gt_i32 s[58:59], 49, v5
v_cmp_gt_i32 s[60:61], 50, v5
v_mfma_f32_16x16x32_bf16 v[92:95], a[132:135], a[60:63], v[92:95]
s_waitcnt lgkmcnt(0)
v_cmp_gt_i32 s[62:63], 51, v5
v_mov_b32 v7, 0xff800000
v_mfma_f32_16x16x32_bf16 v[100:103], a[136:139], a[0:3], v[100:103]
s_cmp_lg_u32 s9, 0
ds_read_b64_tr_b16 a[128:129], v24 offset:0
v_mov_b32 v6, 1
v_mfma_f32_16x16x32_bf16 v[100:103], a[140:143], a[4:7], v[100:103]
s_cselect_b32 s24, 1, 0
v_mov_b32 v5, v26
v_add_u32 v4, 0x20000, v1
v_mfma_f32_16x16x32_bf16 v[108:111], a[136:139], a[8:11], v[108:111]
s_cselect_b32 s67, s67, 3221225472
ds_read_b64_tr_b16 a[130:131], v24 offset:2048
v_mfma_f32_16x16x32_bf16 v[108:111], a[140:143], a[12:15], v[108:111]
s_lshl_b32 s8, s9, 15
v_mfma_f32_16x16x32_bf16 v[116:119], a[136:139], a[16:19], v[116:119]
s_add_u32 s8, s8, s30
ds_read_b64_tr_b16 a[132:133], v24 offset:16384
v_mfma_f32_16x16x32_bf16 v[116:119], a[140:143], a[20:23], v[116:119]
s_add_u32 s9, s9, s22
v_mfma_f32_16x16x32_bf16 v[124:127], a[136:139], a[24:27], v[124:127]
s_sub_u32 s9, 32, s9
ds_read_b64_tr_b16 a[134:135], v24 offset:18432
v_mul_f32 v36, s68, v36
v_mfma_f32_16x16x32_bf16 v[124:127], a[140:143], a[28:31], v[124:127]
s_bitcmp1_b32 s2, 4
v_mul_f32 v37, s68, v37
v_mul_f32 v38, s68, v38
v_mfma_f32_16x16x32_bf16 v[132:135], a[136:139], a[32:35], v[132:135]
s_cselect_b32 s9, 16, s9
v_mul_f32 v39, s68, v39
v_mul_f32 v100, s68, v100
v_mfma_f32_16x16x32_bf16 v[132:135], a[140:143], a[36:39], v[132:135]
s_cselect_b32 s29, 7, s29
v_mul_f32 v101, s68, v101
v_mul_f32 v102, s68, v102
v_mfma_f32_16x16x32_bf16 v[140:143], a[136:139], a[40:43], v[140:143]
s_mov_b32 s10, 3221225472
v_mul_f32 v103, s68, v103
v_cvt_pk_bf16_f32 v36, v36, v37
v_mfma_f32_16x16x32_bf16 v[140:143], a[140:143], a[44:47], v[140:143]
s_mov_b32 s14, 3221225472
v_cvt_pk_bf16_f32 v37, v38, v39
v_cvt_pk_bf16_f32 v38, v100, v101
v_mfma_f32_16x16x32_bf16 v[148:151], a[136:139], a[48:51], v[148:151]
s_mov_b32 s11, 0
v_cvt_pk_bf16_f32 v39, v102, v103
v_mul_f32 v44, s68, v44
v_mfma_f32_16x16x32_bf16 v[148:151], a[140:143], a[52:55], v[148:151]
s_lshr_b32 s19, s9, 1
ds_write_b128 v28, v[36:39] offset:0
v_mul_f32 v45, s68, v45
v_mfma_f32_16x16x32_bf16 v[156:159], a[136:139], a[56:59], v[156:159]
s_sub_u32 s19, s19, 1
s_add_u32 s23, s67, 0
buffer_store_dwordx4 v[36:39], v1, s[4:7], s23 offen offset:0 sc1
v_mfma_f32_16x16x32_bf16 v[156:159], a[140:143], a[60:63], v[156:159]
s_waitcnt lgkmcnt(1)
v_mul_f32 v46, s68, v46
v_mul_f32 v47, s68, v47
v_mfma_f32_16x16x32_bf16 v[164:167], a[128:131], a[0:3], v[164:167]
s_add_u32 s12, s8, 16777216
ds_read_b64_tr_b16 a[136:137], v25 offset:0
v_mul_f32 v108, s68, v108
v_mfma_f32_16x16x32_bf16 v[164:167], a[132:135], a[4:7], v[164:167]
s_mov_b32 s13, s9
v_mul_f32 v109, s68, v109
v_mul_f32 v110, s68, v110
v_mfma_f32_16x16x32_bf16 v[172:175], a[128:131], a[8:11], v[172:175]
s_mov_b32 s15, s11
ds_read_b64_tr_b16 a[138:139], v25 offset:2048
v_mul_f32 v111, s68, v111
v_mfma_f32_16x16x32_bf16 v[172:175], a[132:135], a[12:15], v[172:175]
v_cvt_pk_bf16_f32 v44, v44, v45
v_cvt_pk_bf16_f32 v45, v46, v47
v_mfma_f32_16x16x32_bf16 v[180:183], a[128:131], a[16:19], v[180:183]
ds_read_b64_tr_b16 a[140:141], v25 offset:16384
v_cvt_pk_bf16_f32 v46, v108, v109
v_mfma_f32_16x16x32_bf16 v[180:183], a[132:135], a[20:23], v[180:183]
v_cvt_pk_bf16_f32 v47, v110, v111
v_mul_f32 v52, s68, v52
v_mfma_f32_16x16x32_bf16 v[188:191], a[128:131], a[24:27], v[188:191]
ds_read_b64_tr_b16 a[142:143], v25 offset:18432
v_mul_f32 v53, s68, v53
v_mfma_f32_16x16x32_bf16 v[188:191], a[132:135], a[28:31], v[188:191]
ds_write_b128 v28, v[44:47] offset:8192
v_mul_f32 v54, s68, v54
v_mfma_f32_16x16x32_bf16 v[196:199], a[128:131], a[32:35], v[196:199]
s_add_u32 s23, s67, 8192
buffer_store_dwordx4 v[44:47], v1, s[4:7], s23 offen offset:0 sc1
v_mfma_f32_16x16x32_bf16 v[196:199], a[132:135], a[36:39], v[196:199]
v_mul_f32 v55, s68, v55
v_mul_f32 v116, s68, v116
v_mfma_f32_16x16x32_bf16 v[204:207], a[128:131], a[40:43], v[204:207]
v_mul_f32 v117, s68, v117
v_mul_f32 v118, s68, v118
v_mfma_f32_16x16x32_bf16 v[204:207], a[132:135], a[44:47], v[204:207]
v_mul_f32 v119, s68, v119
v_cvt_pk_bf16_f32 v52, v52, v53
v_mfma_f32_16x16x32_bf16 v[212:215], a[128:131], a[48:51], v[212:215]
v_cvt_pk_bf16_f32 v53, v54, v55
v_cvt_pk_bf16_f32 v54, v116, v117
v_mfma_f32_16x16x32_bf16 v[212:215], a[132:135], a[52:55], v[212:215]
v_cvt_pk_bf16_f32 v55, v118, v119
v_mul_f32 v60, s68, v60
v_mfma_f32_16x16x32_bf16 v[220:223], a[128:131], a[56:59], v[220:223]
ds_write_b128 v28, v[52:55] offset:16384
v_mul_f32 v61, s68, v61
v_mfma_f32_16x16x32_bf16 v[220:223], a[132:135], a[60:63], v[220:223]
s_waitcnt lgkmcnt(0)
s_waitcnt lgkmcnt(0)
s_barrier
v_mfma_f32_16x16x32_bf16 v[224:227], a[136:139], a[0:3], v[224:227]
s_add_u32 s23, s67, 16384
buffer_store_dwordx4 v[52:55], v1, s[4:7], s23 offen offset:0 sc1
v_mfma_f32_16x16x32_bf16 v[224:227], a[140:143], a[4:7], v[224:227]
v_mul_f32 v62, s68, v62
v_mul_f32 v63, s68, v63
v_mfma_f32_16x16x32_bf16 v[228:231], a[136:139], a[8:11], v[228:231]
v_mul_f32 v124, s68, v124
v_mul_f32 v125, s68, v125
v_mfma_f32_16x16x32_bf16 v[228:231], a[140:143], a[12:15], v[228:231]
v_mul_f32 v126, s68, v126
v_mul_f32 v127, s68, v127
v_mfma_f32_16x16x32_bf16 v[232:235], a[136:139], a[16:19], v[232:235]
v_cvt_pk_bf16_f32 v60, v60, v61
v_cvt_pk_bf16_f32 v61, v62, v63
v_mfma_f32_16x16x32_bf16 v[232:235], a[140:143], a[20:23], v[232:235]
v_cvt_pk_bf16_f32 v62, v124, v125
v_cvt_pk_bf16_f32 v63, v126, v127
v_mfma_f32_16x16x32_bf16 v[236:239], a[136:139], a[24:27], v[236:239]
ds_write_b128 v28, v[60:63] offset:24576
v_mul_f32 v68, s68, v68
v_mfma_f32_16x16x32_bf16 v[236:239], a[140:143], a[28:31], v[236:239]
s_add_u32 s23, s67, 24576
buffer_store_dwordx4 v[60:63], v1, s[4:7], s23 offen offset:0 sc1
v_mfma_f32_16x16x32_bf16 v[240:243], a[136:139], a[32:35], v[240:243]
v_mul_f32 v69, s68, v69
v_mul_f32 v70, s68, v70
v_mfma_f32_16x16x32_bf16 v[240:243], a[140:143], a[36:39], v[240:243]
v_mul_f32 v71, s68, v71
v_mul_f32 v132, s68, v132
v_mfma_f32_16x16x32_bf16 v[244:247], a[136:139], a[40:43], v[244:247]
v_mul_f32 v133, s68, v133
v_mul_f32 v134, s68, v134
v_mfma_f32_16x16x32_bf16 v[244:247], a[140:143], a[44:47], v[244:247]
v_mul_f32 v135, s68, v135
v_cvt_pk_bf16_f32 v68, v68, v69
v_mfma_f32_16x16x32_bf16 v[248:251], a[136:139], a[48:51], v[248:251]
v_cvt_pk_bf16_f32 v69, v70, v71
v_cvt_pk_bf16_f32 v70, v132, v133
v_mfma_f32_16x16x32_bf16 v[248:251], a[140:143], a[52:55], v[248:251]
v_cvt_pk_bf16_f32 v71, v134, v135
v_mfma_f32_16x16x32_bf16 v[252:255], a[136:139], a[56:59], v[252:255]
ds_write_b128 v28, v[68:71] offset:32768
v_mfma_f32_16x16x32_bf16 v[252:255], a[140:143], a[60:63], v[252:255]
s_add_u32 s23, s67, 32768
buffer_store_dwordx4 v[68:71], v1, s[4:7], s23 offen offset:0 sc1
buffer_load_dword v21, v20, s[4:7], s70 offen sc1
v_pk_mul_f32 v[76:77], v[76:77], s[68:69]
v_pk_mul_f32 v[78:79], v[78:79], s[68:69]
v_pk_mul_f32 v[140:141], v[140:141], s[68:69]
v_pk_mul_f32 v[142:143], v[142:143], s[68:69]
v_cvt_pk_bf16_f32 v76, v76, v77
v_cvt_pk_bf16_f32 v77, v78, v79
v_cvt_pk_bf16_f32 v78, v140, v141
v_cvt_pk_bf16_f32 v79, v142, v143
ds_write_b128 v28, v[76:79] offset:40960
s_add_u32 s23, s67, 40960
buffer_store_dwordx4 v[76:79], v1, s[4:7], s23 offen offset:0 sc1
v_pk_mul_f32 v[84:85], v[84:85], s[68:69]
v_pk_mul_f32 v[86:87], v[86:87], s[68:69]
v_pk_mul_f32 v[148:149], v[148:149], s[68:69]
v_pk_mul_f32 v[150:151], v[150:151], s[68:69]
v_cvt_pk_bf16_f32 v84, v84, v85
v_cvt_pk_bf16_f32 v85, v86, v87
v_cvt_pk_bf16_f32 v86, v148, v149
v_cvt_pk_bf16_f32 v87, v150, v151
ds_write_b128 v28, v[84:87] offset:49152
s_add_u32 s23, s67, 49152
buffer_store_dwordx4 v[84:87], v1, s[4:7], s23 offen offset:0 sc1
v_pk_mul_f32 v[92:93], v[92:93], s[68:69]
v_pk_mul_f32 v[94:95], v[94:95], s[68:69]
v_pk_mul_f32 v[156:157], v[156:157], s[68:69]
v_pk_mul_f32 v[158:159], v[158:159], s[68:69]
v_cvt_pk_bf16_f32 v92, v92, v93
v_cvt_pk_bf16_f32 v93, v94, v95
v_cvt_pk_bf16_f32 v94, v156, v157
v_cvt_pk_bf16_f32 v95, v158, v159
ds_write_b128 v28, v[92:95] offset:57344
s_add_u32 s23, s67, 57344
buffer_store_dwordx4 v[92:95], v1, s[4:7], s23 offen offset:0 sc1
v_pk_mul_f32 v[164:165], v[164:165], s[68:69]
v_pk_mul_f32 v[166:167], v[166:167], s[68:69]
v_pk_mul_f32 v[224:225], v[224:225], s[68:69]
v_pk_mul_f32 v[226:227], v[226:227], s[68:69]
v_cvt_pk_bf16_f32 v164, v164, v165
v_cvt_pk_bf16_f32 v165, v166, v167
v_cvt_pk_bf16_f32 v166, v224, v225
v_cvt_pk_bf16_f32 v167, v226, v227
ds_write_b128 v28, v[164:167] offset:1024
s_add_u32 s23, s67, 0
buffer_store_dwordx4 v[164:167], v1, s[4:7], s23 offen offset:1024 sc1
v_pk_mul_f32 v[172:173], v[172:173], s[68:69]
v_pk_mul_f32 v[174:175], v[174:175], s[68:69]
v_pk_mul_f32 v[228:229], v[228:229], s[68:69]
v_pk_mul_f32 v[230:231], v[230:231], s[68:69]
v_cvt_pk_bf16_f32 v172, v172, v173
v_cvt_pk_bf16_f32 v173, v174, v175
v_cvt_pk_bf16_f32 v174, v228, v229
v_cvt_pk_bf16_f32 v175, v230, v231
ds_write_b128 v28, v[172:175] offset:9216
s_add_u32 s23, s67, 8192
buffer_store_dwordx4 v[172:175], v1, s[4:7], s23 offen offset:1024 sc1
v_pk_mul_f32 v[180:181], v[180:181], s[68:69]
v_pk_mul_f32 v[182:183], v[182:183], s[68:69]
v_pk_mul_f32 v[232:233], v[232:233], s[68:69]
v_pk_mul_f32 v[234:235], v[234:235], s[68:69]
v_cvt_pk_bf16_f32 v180, v180, v181
v_cvt_pk_bf16_f32 v181, v182, v183
v_cvt_pk_bf16_f32 v182, v232, v233
v_cvt_pk_bf16_f32 v183, v234, v235
ds_write_b128 v28, v[180:183] offset:17408
s_add_u32 s23, s67, 16384
buffer_store_dwordx4 v[180:183], v1, s[4:7], s23 offen offset:1024 sc1
v_pk_mul_f32 v[188:189], v[188:189], s[68:69]
v_pk_mul_f32 v[190:191], v[190:191], s[68:69]
v_pk_mul_f32 v[236:237], v[236:237], s[68:69]
v_pk_mul_f32 v[238:239], v[238:239], s[68:69]
v_cvt_pk_bf16_f32 v188, v188, v189
v_cvt_pk_bf16_f32 v189, v190, v191
v_cvt_pk_bf16_f32 v190, v236, v237
v_cvt_pk_bf16_f32 v191, v238, v239
ds_write_b128 v28, v[188:191] offset:25600
s_add_u32 s23, s67, 24576
buffer_store_dwordx4 v[188:191], v1, s[4:7], s23 offen offset:1024 sc1
v_pk_mul_f32 v[196:197], v[196:197], s[68:69]
v_pk_mul_f32 v[198:199], v[198:199], s[68:69]
PAD_8:
s_cbranch_execz M_tret
v_pk_mul_f32 v[240:241], v[240:241], s[68:69]
v_pk_mul_f32 v[242:243], v[242:243], s[68:69]
v_cvt_pk_bf16_f32 v196, v196, v197
v_cvt_pk_bf16_f32 v197, v198, v199
v_cvt_pk_bf16_f32 v198, v240, v241
v_cvt_pk_bf16_f32 v199, v242, v243
ds_write_b128 v28, v[196:199] offset:33792
s_add_u32 s23, s67, 32768
buffer_store_dwordx4 v[196:199], v1, s[4:7], s23 offen offset:1024 sc1
v_pk_mul_f32 v[204:205], v[204:205], s[68:69]
v_pk_mul_f32 v[206:207], v[206:207], s[68:69]
v_pk_mul_f32 v[244:245], v[244:245], s[68:69]
v_pk_mul_f32 v[246:247], v[246:247], s[68:69]
v_cvt_pk_bf16_f32 v204, v204, v205
v_cvt_pk_bf16_f32 v205, v206, v207
v_cvt_pk_bf16_f32 v206, v244, v245
v_cvt_pk_bf16_f32 v207, v246, v247
ds_write_b128 v28, v[204:207] offset:41984
s_add_u32 s23, s67, 40960
buffer_store_dwordx4 v[204:207], v1, s[4:7], s23 offen offset:1024 sc1
v_pk_mul_f32 v[212:213], v[212:213], s[68:69]
v_pk_mul_f32 v[214:215], v[214:215], s[68:69]
v_pk_mul_f32 v[248:249], v[248:249], s[68:69]
v_pk_mul_f32 v[250:251], v[250:251], s[68:69]
v_cvt_pk_bf16_f32 v212, v212, v213
v_cvt_pk_bf16_f32 v213, v214, v215
v_cvt_pk_bf16_f32 v214, v248, v249
v_cvt_pk_bf16_f32 v215, v250, v251
ds_write_b128 v28, v[212:215] offset:50176
s_add_u32 s23, s67, 49152
buffer_store_dwordx4 v[212:215], v1, s[4:7], s23 offen offset:1024 sc1
v_pk_mul_f32 v[220:221], v[220:221], s[68:69]
v_pk_mul_f32 v[222:223], v[222:223], s[68:69]
v_pk_mul_f32 v[252:253], v[252:253], s[68:69]
v_pk_mul_f32 v[254:255], v[254:255], s[68:69]
v_cvt_pk_bf16_f32 v220, v220, v221
v_cvt_pk_bf16_f32 v221, v222, v223
v_cvt_pk_bf16_f32 v222, v252, v253
v_cvt_pk_bf16_f32 v223, v254, v255
ds_write_b128 v28, v[220:223] offset:58368
s_add_u32 s23, s67, 57344
buffer_store_dwordx4 v[220:223], v1, s[4:7], s23 offen offset:1024 sc1
s_waitcnt vmcnt(11)
v_cmp_gt_u32 vcc, 1, v21
s_cbranch_vccnz M_kspin
M_kok:
buffer_load_dword v21, v15, s[4:7], s70 offen sc1
s_mov_b32 m0, s84
s_nop 0
buffer_load_dwordx4 v1, s[4:7], s8 offen offset:0 sc1 lds
buffer_load_dwordx4 v1, s[4:7], s8 offen offset:1024 sc1 lds
buffer_load_dwordx4 v1, s[4:7], s8 offen offset:2048 sc1 lds
buffer_load_dwordx4 v1, s[4:7], s8 offen offset:3072 sc1 lds
s_add_u32 s8, s8, 4096
s_add_u32 m0, s84, 4096
s_nop 0
buffer_load_dwordx4 v1, s[4:7], s8 offen offset:0 sc1 lds
buffer_load_dwordx4 v1, s[4:7], s8 offen offset:1024 sc1 lds
buffer_load_dwordx4 v1, s[4:7], s8 offen offset:2048 sc1 lds
buffer_load_dwordx4 v1, s[4:7], s8 offen offset:3072 sc1 lds
s_add_u32 s8, s8, 28672
s_sub_u32 s9, s9, 1
s_cmp_eq_u32 s9, 0
s_cselect_b32 s8, s10, s8
s_cselect_b32 s9, s11, s9
s_cselect_b32 s10, 3221225472, s10
v_add_u32 v28, s18, v2
s_waitcnt lgkmcnt(0)
s_barrier
ds_read_b128 a[0:3], v28 offset:0
ds_read_b128 a[4:7], v28 offset:1024
ds_read_b128 a[8:11], v28 offset:2048
ds_read_b128 a[12:15], v28 offset:3072
ds_read_b128 a[16:19], v28 offset:4096
ds_read_b128 a[20:23], v28 offset:5120
ds_read_b128 a[24:27], v28 offset:6144
ds_read_b128 a[28:31], v28 offset:7168
ds_read_b128 a[32:35], v28 offset:32768
ds_read_b128 a[36:39], v28 offset:33792
ds_read_b128 a[40:43], v28 offset:34816
ds_read_b128 a[44:47], v28 offset:35840
ds_read_b128 a[48:51], v28 offset:36864
ds_read_b128 a[52:55], v28 offset:37888
ds_read_b128 a[56:59], v28 offset:38912
ds_read_b128 a[60:63], v28 offset:39936
s_mov_b32 m0, s85
s_nop 0
buffer_load_dwordx4 v1, s[4:7], s8 offen offset:0 sc1 lds
buffer_load_dwordx4 v1, s[4:7], s8 offen offset:1024 sc1 lds
buffer_load_dwordx4 v1, s[4:7], s8 offen offset:2048 sc1 lds
buffer_load_dwordx4 v1, s[4:7], s8 offen offset:3072 sc1 lds
s_add_u32 s8, s8, 4096
s_add_u32 m0, s85, 4096
s_nop 0
buffer_load_dwordx4 v1, s[4:7], s8 offen offset:0 sc1 lds
buffer_load_dwordx4 v1, s[4:7], s8 offen offset:1024 sc1 lds
buffer_load_dwordx4 v1, s[4:7], s8 offen offset:2048 sc1 lds
buffer_load_dwordx4 v1, s[4:7], s8 offen offset:3072 sc1 lds
s_add_u32 s8, s8, 28672
s_sub_u32 s9, s9, 1
s_cmp_eq_u32 s9, 0
s_cselect_b32 s8, s10, s8
s_cselect_b32 s9, s11, s9
s_cselect_b32 s10, 3221225472, s10
s_mov_b32 s25, 1266679808
s_lshl_b32 s22, s21, 3
s_xor_b32 s28, s70, 256
s_add_u32 s28, s28, s22
s_add_u32 s28, s28, 6148
s_lshl_b32 s26, s21, 16
s_add_u32 s26, s26, s30
s_add_u32 s26, s26, 33554432
s_xor_b32 s76, s20, 0
s_lshl_b32 s76, s76, 3
s_add_u32 s76, s76, s21
s_lshl_b32 s76, s76, 2
s_add_u32 s76, s76, s3
s_lshl_b32 s27, s76, 10
s_add_u32 s27, s27, 75497472
s_lshl_b32 s76, s76, 14
s_add_u32 s76, s76, 67108864
s_lshl_b32 s81, s20, 2
s_add_u32 s81, s81, s3
s_mul_i32 s81, s81, 57344
s_cmp_eq_u32 s24, 1
s_cselect_b32 s80, s28, s70
s_add_u32 s77, s76, 8192
v_lshrrev_b32 v8, 7, v1
v_and_b32 v9, 6, v8
v_lshlrev_b32 v9, 4, v9
v_and_b32 v10, 0x70, v1
v_xor_b32 v9, v9, v10
v_mul_u32_u24 v8, 896, v8
v_add_u32 v8, v8, v9
v_accvgpr_write_b32 a184, v8
v_add_u32 v8, 6144, v8
v_accvgpr_write_b32 a185, v8
v_add_u32 v8, 6144, v8
v_accvgpr_write_b32 a186, v8
v_add_u32 v8, 6144, v8
v_accvgpr_write_b32 a187, v8
v_lshrrev_b32 v8, 6, v1
v_bfe_u32 v9, v1, 7, 2
v_lshlrev_b32 v9, 5, v9
v_lshl_add_u32 v8, v8, 7, v9
v_bfe_u32 v9, v1, 4, 2
v_lshl_add_u32 v8, v9, 3, v8
v_add_u32 v8, 32768, v8
v_accvgpr_write_b32 a188, v8
v_xor_b32 v9, 32, v8
v_accvgpr_write_b32 a189, v9
v_xor_b32 v9, 64, v8
v_accvgpr_write_b32 a190, v9
v_xor_b32 v9, 96, v8
v_accvgpr_write_b32 a191, v9
s_add_u32 s22, s66, 16384
s_mov_b32 s71, 3221225472
s_waitcnt vmcnt(17)
s_barrier
buffer_store_dword v6, v5, s[4:7], s22 offen sc1
v_mov_b64 v[128:129], 0
v_mov_b64 v[130:131], 0
v_mov_b64 v[132:133], 0
v_mov_b64 v[134:135], 0
v_mov_b64 v[136:137], 0
v_mov_b64 v[138:139], 0
v_mov_b64 v[140:141], 0
v_mov_b64 v[142:143], 0
v_mov_b64 v[144:145], 0
v_mov_b64 v[146:147], 0
v_mov_b64 v[148:149], 0
v_mov_b64 v[150:151], 0
v_mov_b64 v[152:153], 0
v_mov_b64 v[154:155], 0
v_mov_b64 v[156:157], 0
v_mov_b64 v[158:159], 0
v_mov_b64 v[160:161], 0
v_mov_b64 v[162:163], 0
v_mov_b64 v[164:165], 0
v_mov_b64 v[166:167], 0
v_mov_b64 v[168:169], 0
v_mov_b64 v[170:171], 0
v_mov_b64 v[172:173], 0
v_mov_b64 v[174:175], 0
v_mov_b64 v[176:177], 0
v_mov_b64 v[178:179], 0
v_mov_b64 v[180:181], 0
v_mov_b64 v[182:183], 0
v_mov_b64 v[184:185], 0
v_mov_b64 v[186:187], 0
v_mov_b64 v[188:189], 0
v_mov_b64 v[190:191], 0
v_mov_b64 v[192:193], 0
v_mov_b64 v[194:195], 0
v_mov_b64 v[196:197], 0
v_mov_b64 v[198:199], 0
v_mov_b64 v[200:201], 0
v_mov_b64 v[202:203], 0
v_mov_b64 v[204:205], 0
v_mov_b64 v[206:207], 0
v_mov_b64 v[208:209], 0
v_mov_b64 v[210:211], 0
v_mov_b64 v[212:213], 0
v_mov_b64 v[214:215], 0
v_mov_b64 v[216:217], 0
v_mov_b64 v[218:219], 0
v_mov_b64 v[220:221], 0
v_mov_b64 v[222:223], 0
v_mov_b64 v[224:225], 0
v_mov_b64 v[226:227], 0
v_mov_b64 v[228:229], 0
v_mov_b64 v[230:231], 0
v_mov_b64 v[232:233], 0
v_mov_b64 v[234:235], 0
v_mov_b64 v[236:237], 0
v_mov_b64 v[238:239], 0
v_mov_b64 v[240:241], 0
v_mov_b64 v[242:243], 0
v_mov_b64 v[244:245], 0
v_mov_b64 v[246:247], 0
v_mov_b64 v[248:249], 0
v_mov_b64 v[250:251], 0
v_mov_b64 v[252:253], 0
v_mov_b64 v[254:255], 0
v_mov_b64 v[24:25], 0
s_cmp_eq_u32 s24, 9
s_cbranch_scc1 M_t2A
M_t2Ar:
s_waitcnt vmcnt(9) lgkmcnt(0)
v_cmp_gt_u32 vcc, 1, v21
s_cbranch_vccnz M_vspin
M_vok:
s_barrier
K2_item:
PAD_9:
s_cbranch_execz M_tret
s_cmp_eq_u32 s19, 0
s_cbranch_scc1 K2_p0d
ds_read_b128 a[64:67], v1 offset:0
ds_read_b128 a[68:71], v1 offset:1024
ds_read_b128 a[72:75], v1 offset:2048
ds_read_b128 a[76:79], v1 offset:3072
ds_read_b128 a[80:83], v1 offset:4096
ds_read_b128 a[84:87], v1 offset:5120
ds_read_b128 a[88:91], v1 offset:6144
ds_read_b128 a[92:95], v1 offset:7168
s_waitcnt lgkmcnt(7)
v_mfma_f32_16x16x32_bf16 v[32:35], a[64:67], a[0:3], 0
s_waitcnt lgkmcnt(6)
s_add_u32 m0, s18, 65536
ds_read_b128 a[96:99], v1 offset:8192
v_mfma_f32_16x16x32_bf16 v[32:35], a[68:71], a[4:7], v[32:35]
s_waitcnt lgkmcnt(6)
buffer_load_dwordx4 v1, s[4:7], s12 offen offset:0 sc1 lds
v_mfma_f32_16x16x32_bf16 v[32:35], a[72:75], a[8:11], v[32:35]
s_waitcnt lgkmcnt(5)
ds_read_b128 a[100:103], v1 offset:9216
v_mfma_f32_16x16x32_bf16 v[32:35], a[76:79], a[12:15], v[32:35]
s_waitcnt lgkmcnt(5)
buffer_load_dwordx4 v1, s[4:7], s12 offen offset:1024 sc1 lds
v_mfma_f32_16x16x32_bf16 v[32:35], a[80:83], a[16:19], v[32:35]
s_waitcnt lgkmcnt(4)
ds_read_b128 a[104:107], v1 offset:10240
v_mfma_f32_16x16x32_bf16 v[32:35], a[84:87], a[20:23], v[32:35]
s_waitcnt lgkmcnt(4)
buffer_load_dwordx4 v1, s[4:7], s12 offen offset:2048 sc1 lds
v_mfma_f32_16x16x32_bf16 v[32:35], a[88:91], a[24:27], v[32:35]
s_waitcnt lgkmcnt(3)
ds_read_b128 a[108:111], v1 offset:11264
v_mfma_f32_16x16x32_bf16 v[32:35], a[92:95], a[28:31], v[32:35]
buffer_load_dwordx4 v1, s[4:7], s12 offen offset:3072 sc1 lds
v_mfma_f32_16x16x32_bf16 v[36:39], a[64:67], a[32:35], 0
s_add_u32 s12, s12, 4096
s_add_u32 m0, s18, 69632
ds_read_b128 a[112:115], v1 offset:12288
v_mfma_f32_16x16x32_bf16 v[36:39], a[68:71], a[36:39], v[36:39]
buffer_load_dwordx4 v1, s[4:7], s12 offen offset:0 sc1 lds
v_mfma_f32_16x16x32_bf16 v[36:39], a[72:75], a[40:43], v[36:39]
ds_read_b128 a[116:119], v1 offset:13312
v_mfma_f32_16x16x32_bf16 v[36:39], a[76:79], a[44:47], v[36:39]
buffer_load_dwordx4 v1, s[4:7], s12 offen offset:1024 sc1 lds
v_mfma_f32_16x16x32_bf16 v[36:39], a[80:83], a[48:51], v[36:39]
ds_read_b128 a[120:123], v1 offset:14336
v_max3_f32 v28, v32, v33, v34
v_mfma_f32_16x16x32_bf16 v[36:39], a[84:87], a[52:55], v[36:39]
buffer_load_dwordx4 v1, s[4:7], s12 offen offset:2048 sc1 lds
v_mfma_f32_16x16x32_bf16 v[36:39], a[88:91], a[56:59], v[36:39]
ds_read_b128 a[124:127], v1 offset:15360
v_max_f32 v28, v28, v35
v_mfma_f32_16x16x32_bf16 v[36:39], a[92:95], a[60:63], v[36:39]
s_waitcnt lgkmcnt(4)
buffer_load_dwordx4 v1, s[4:7], s12 offen offset:3072 sc1 lds
v_mfma_f32_16x16x32_bf16 v[40:43], a[96:99], a[0:3], 0
s_add_u32 s12, s12, 28672
ds_read_b128 a[64:67], v1 offset:16384
v_mov_b32 v30, v28
v_mfma_f32_16x16x32_bf16 v[40:43], a[100:103], a[4:7], v[40:43]
s_waitcnt lgkmcnt(2)
s_sub_u32 s13, s13, 1
v_mfma_f32_16x16x32_bf16 v[40:43], a[104:107], a[8:11], v[40:43]
s_cmp_eq_u32 s13, 0
ds_read_b128 a[68:71], v1 offset:17408
v_permlane16_swap_b32 v28, v30
v_mfma_f32_16x16x32_bf16 v[40:43], a[108:111], a[12:15], v[40:43]
s_cselect_b32 s12, s14, s12
v_max_f32 v28, v28, v30
v_mov_b32 v30, v28
v_mfma_f32_16x16x32_bf16 v[40:43], a[112:115], a[16:19], v[40:43]
s_cselect_b32 s13, s15, s13
ds_read_b128 a[72:75], v1 offset:18432
v_max3_f32 v29, v36, v37, v38
v_mfma_f32_16x16x32_bf16 v[40:43], a[116:119], a[20:23], v[40:43]
s_cselect_b32 s14, 3221225472, s14
v_permlane32_swap_b32 v28, v30
v_max_f32 v28, v28, v30
v_mfma_f32_16x16x32_bf16 v[40:43], a[120:123], a[24:27], v[40:43]
s_waitcnt lgkmcnt(3)
ds_read_b128 a[76:79], v1 offset:19456
v_sub_f32 v16, 0, v28
v_mfma_f32_16x16x32_bf16 v[40:43], a[124:127], a[28:31], v[40:43]
v_sub_f32 v17, 0, v28
v_sub_f32 v18, 0, v28
v_mfma_f32_16x16x32_bf16 v[44:47], a[96:99], a[32:35], 0
ds_read_b128 a[80:83], v1 offset:20480
v_sub_f32 v19, 0, v28
v_mfma_f32_16x16x32_bf16 v[44:47], a[100:103], a[36:39], v[44:47]
v_max_f32 v29, v29, v39
v_mov_b32 v31, v29
v_mfma_f32_16x16x32_bf16 v[44:47], a[104:107], a[40:43], v[44:47]
ds_read_b128 a[84:87], v1 offset:21504
v_mfma_f32_16x16x32_bf16 v[44:47], a[108:111], a[44:47], v[44:47]
v_permlane16_swap_b32 v29, v31
v_max_f32 v29, v29, v31
v_mfma_f32_16x16x32_bf16 v[44:47], a[112:115], a[48:51], v[44:47]
ds_read_b128 a[88:91], v1 offset:22528
v_mov_b32 v31, v29
v_mfma_f32_16x16x32_bf16 v[44:47], a[116:119], a[52:55], v[44:47]
v_mfma_f32_16x16x32_bf16 v[44:47], a[120:123], a[56:59], v[44:47]
ds_read_b128 a[92:95], v1 offset:23552
v_permlane32_swap_b32 v29, v31
v_mfma_f32_16x16x32_bf16 v[44:47], a[124:127], a[60:63], v[44:47]
s_waitcnt lgkmcnt(4)
v_max_f32 v29, v29, v31
v_sub_f32 v20, 0, v29
v_mfma_f32_16x16x32_bf16 v[48:51], a[64:67], a[0:3], v[16:19]
ds_read_b128 a[96:99], v1 offset:24576
v_sub_f32 v21, 0, v29
v_mfma_f32_16x16x32_bf16 v[48:51], a[68:71], a[4:7], v[48:51]
v_sub_f32 v22, 0, v29
v_sub_f32 v23, 0, v29
v_mfma_f32_16x16x32_bf16 v[48:51], a[72:75], a[8:11], v[48:51]
ds_read_b128 a[100:103], v1 offset:25600
v_mfma_f32_16x16x32_bf16 v[48:51], a[76:79], a[12:15], v[48:51]
s_waitcnt lgkmcnt(4)
v_mfma_f32_16x16x32_bf16 v[48:51], a[80:83], a[16:19], v[48:51]
ds_read_b128 a[104:107], v1 offset:26624
v_mfma_f32_16x16x32_bf16 v[48:51], a[84:87], a[20:23], v[48:51]
s_waitcnt lgkmcnt(4)
v_add_f32 v32, v32, v16
v_add_f32 v33, v33, v16
v_add_f32 v34, v34, v16
v_add_f32 v35, v35, v16
v_mfma_f32_16x16x32_bf16 v[48:51], a[88:91], a[24:27], v[48:51]
s_waitcnt lgkmcnt(3)
ds_read_b128 a[108:111], v1 offset:27648
v_add_f32 v36, v36, v20
v_add_f32 v37, v37, v20
v_add_f32 v38, v38, v20
v_add_f32 v39, v39, v20
v_mfma_f32_16x16x32_bf16 v[48:51], a[92:95], a[28:31], v[48:51]
v_add_f32 v40, v40, v16
v_add_f32 v41, v41, v16
v_add_f32 v42, v42, v16
v_add_f32 v43, v43, v16
v_mfma_f32_16x16x32_bf16 v[52:55], a[64:67], a[32:35], v[20:23]
ds_read_b128 a[112:115], v1 offset:28672
v_add_f32 v44, v44, v20
v_add_f32 v45, v45, v20
v_add_f32 v46, v46, v20
v_add_f32 v47, v47, v20
v_mfma_f32_16x16x32_bf16 v[52:55], a[68:71], a[36:39], v[52:55]
v_exp_f32 v8, v32
v_mfma_f32_16x16x32_bf16 v[52:55], a[72:75], a[40:43], v[52:55]
ds_read_b128 a[116:119], v1 offset:29696
v_exp_f32 v9, v33
v_mfma_f32_16x16x32_bf16 v[52:55], a[76:79], a[44:47], v[52:55]
v_exp_f32 v10, v34
v_add_f32 v26, v8, v9
v_cvt_pk_bf16_f32 v96, v8, v9
v_mfma_f32_16x16x32_bf16 v[52:55], a[80:83], a[48:51], v[52:55]
ds_read_b128 a[120:123], v1 offset:30720
v_exp_f32 v11, v35
v_add_f32 v26, v26, v10
v_mfma_f32_16x16x32_bf16 v[52:55], a[84:87], a[52:55], v[52:55]
v_exp_f32 v12, v36
v_add_f32 v26, v26, v11
v_cvt_pk_bf16_f32 v97, v10, v11
v_mfma_f32_16x16x32_bf16 v[52:55], a[88:91], a[56:59], v[52:55]
s_waitcnt vmcnt(8) lgkmcnt(4)
ds_read_b128 a[124:127], v1 offset:31744
v_exp_f32 v13, v37
v_mfma_f32_16x16x32_bf16 v[52:55], a[92:95], a[60:63], v[52:55]
s_barrier
v_mfma_f32_16x16x32_bf16 v[56:59], a[96:99], a[0:3], v[16:19]
ds_read_b128 a[64:67], v4 offset:0
v_exp_f32 v14, v38
v_mfma_f32_16x16x32_bf16 v[56:59], a[100:103], a[4:7], v[56:59]
buffer_store_dword v6, v5, s[4:7], s71 offen sc1
v_mfma_f32_16x16x32_bf16 v[56:59], a[104:107], a[8:11], v[56:59]
s_waitcnt lgkmcnt(4)
ds_read_b128 a[68:71], v4 offset:1024
v_add_f32 v27, v12, v13
v_cvt_pk_bf16_f32 v104, v12, v13
v_add_f32 v27, v27, v14
v_mfma_f32_16x16x32_bf16 v[56:59], a[108:111], a[12:15], v[56:59]
v_exp_f32 v15, v39
v_mfma_f32_16x16x32_bf16 v[56:59], a[112:115], a[16:19], v[56:59]
s_waitcnt lgkmcnt(4)
ds_read_b128 a[72:75], v4 offset:2048
v_exp_f32 v8, v40
v_add_f32 v27, v27, v15
v_cvt_pk_bf16_f32 v105, v14, v15
v_mfma_f32_16x16x32_bf16 v[56:59], a[116:119], a[20:23], v[56:59]
s_waitcnt lgkmcnt(4)
v_exp_f32 v9, v41
v_add_f32 v26, v26, v8
v_mfma_f32_16x16x32_bf16 v[56:59], a[120:123], a[24:27], v[56:59]
s_waitcnt lgkmcnt(3)
ds_read_b128 a[76:79], v4 offset:3072
v_exp_f32 v10, v42
v_add_f32 v26, v26, v9
v_cvt_pk_bf16_f32 v98, v8, v9
v_mfma_f32_16x16x32_bf16 v[56:59], a[124:127], a[28:31], v[56:59]
v_exp_f32 v11, v43
v_add_f32 v26, v26, v10
v_mfma_f32_16x16x32_bf16 v[60:63], a[96:99], a[32:35], v[20:23]
ds_read_b128 a[80:83], v4 offset:4096
v_exp_f32 v12, v44
v_mfma_f32_16x16x32_bf16 v[60:63], a[100:103], a[36:39], v[60:63]
v_exp_f32 v13, v45
v_mfma_f32_16x16x32_bf16 v[60:63], a[104:107], a[40:43], v[60:63]
ds_read_b128 a[84:87], v4 offset:5120
v_exp_f32 v14, v46
v_mfma_f32_16x16x32_bf16 v[60:63], a[108:111], a[44:47], v[60:63]
v_exp_f32 v15, v47
v_mfma_f32_16x16x32_bf16 v[60:63], a[112:115], a[48:51], v[60:63]
ds_read_b128 a[88:91], v4 offset:6144
v_add_f32 v26, v26, v11
v_cvt_pk_bf16_f32 v99, v10, v11
v_mfma_f32_16x16x32_bf16 v[60:63], a[116:119], a[52:55], v[60:63]
v_add_f32 v27, v27, v12
v_add_f32 v27, v27, v13
v_cvt_pk_bf16_f32 v106, v12, v13
v_mfma_f32_16x16x32_bf16 v[60:63], a[120:123], a[56:59], v[60:63]
s_waitcnt lgkmcnt(7)
s_barrier
ds_read_b128 a[92:95], v4 offset:7168
v_mfma_f32_16x16x32_bf16 v[60:63], a[124:127], a[60:63], v[60:63]
s_waitcnt lgkmcnt(4)
v_add_f32 v27, v27, v14
v_add_f32 v27, v27, v15
v_cvt_pk_bf16_f32 v107, v14, v15
K2_x1:
v_mfma_f32_16x16x32_bf16 v[64:67], a[64:67], a[0:3], v[16:19]
s_add_u32 m0, s18, 0
ds_read_b128 a[96:99], v4 offset:8192
v_mfma_f32_16x16x32_bf16 v[64:67], a[68:71], a[4:7], v[64:67]
s_waitcnt lgkmcnt(4)
buffer_load_dwordx4 v1, s[4:7], s8 offen offset:0 sc1 lds
v_mfma_f32_16x16x32_bf16 v[64:67], a[72:75], a[8:11], v[64:67]
ds_read_b128 a[100:103], v4 offset:9216
v_mfma_f32_16x16x32_bf16 v[64:67], a[76:79], a[12:15], v[64:67]
s_waitcnt lgkmcnt(4)
v_exp_f32 v8, v48
v_mfma_f32_16x16x32_bf16 v[64:67], a[80:83], a[16:19], v[64:67]
ds_read_b128 a[104:107], v4 offset:10240
v_add_f32 v26, v26, v8
v_mfma_f32_16x16x32_bf16 v[64:67], a[84:87], a[20:23], v[64:67]
s_waitcnt lgkmcnt(4)
buffer_load_dwordx4 v1, s[4:7], s8 offen offset:1024 sc1 lds
v_mfma_f32_16x16x32_bf16 v[64:67], a[88:91], a[24:27], v[64:67]
s_waitcnt lgkmcnt(3)
ds_read_b128 a[108:111], v4 offset:11264
v_mfma_f32_16x16x32_bf16 v[64:67], a[92:95], a[28:31], v[64:67]
v_exp_f32 v9, v49
v_mfma_f32_16x16x32_bf16 v[68:71], a[64:67], a[32:35], v[20:23]
ds_read_b128 a[112:115], v4 offset:12288
v_add_f32 v26, v26, v9
v_mfma_f32_16x16x32_bf16 v[68:71], a[68:71], a[36:39], v[68:71]
buffer_load_dwordx4 v1, s[4:7], s8 offen offset:2048 sc1 lds
v_mfma_f32_16x16x32_bf16 v[68:71], a[72:75], a[40:43], v[68:71]
ds_read_b128 a[116:119], v4 offset:13312
v_cvt_pk_bf16_f32 v100, v8, v9
v_mfma_f32_16x16x32_bf16 v[68:71], a[76:79], a[44:47], v[68:71]
v_exp_f32 v10, v50
v_mfma_f32_16x16x32_bf16 v[68:71], a[80:83], a[48:51], v[68:71]
ds_read_b128 a[120:123], v4 offset:14336
v_add_f32 v26, v26, v10
v_mfma_f32_16x16x32_bf16 v[68:71], a[84:87], a[52:55], v[68:71]
buffer_load_dwordx4 v1, s[4:7], s8 offen offset:3072 sc1 lds
v_mfma_f32_16x16x32_bf16 v[68:71], a[88:91], a[56:59], v[68:71]
s_add_u32 s8, s8, 4096
ds_read_b128 a[124:127], v4 offset:15360
v_mfma_f32_16x16x32_bf16 v[68:71], a[92:95], a[60:63], v[68:71]
s_waitcnt lgkmcnt(4)
v_exp_f32 v11, v51
v_mfma_f32_16x16x32_bf16 v[72:75], a[96:99], a[0:3], v[16:19]
s_add_u32 m0, s18, 4096
ds_read_b128 a[64:67], v4 offset:16384
v_add_f32 v26, v26, v11
v_mfma_f32_16x16x32_bf16 v[72:75], a[100:103], a[4:7], v[72:75]
buffer_load_dwordx4 v1, s[4:7], s8 offen offset:0 sc1 lds
v_mfma_f32_16x16x32_bf16 v[72:75], a[104:107], a[8:11], v[72:75]
ds_read_b128 a[68:71], v4 offset:17408
v_cvt_pk_bf16_f32 v101, v10, v11
v_mfma_f32_16x16x32_bf16 v[72:75], a[108:111], a[12:15], v[72:75]
s_waitcnt lgkmcnt(4)
v_mfma_f32_16x16x32_bf16 v[72:75], a[112:115], a[16:19], v[72:75]
ds_read_b128 a[72:75], v4 offset:18432
v_mfma_f32_16x16x32_bf16 v[72:75], a[116:119], a[20:23], v[72:75]
s_waitcnt lgkmcnt(4)
buffer_load_dwordx4 v1, s[4:7], s8 offen offset:1024 sc1 lds
v_mfma_f32_16x16x32_bf16 v[72:75], a[120:123], a[24:27], v[72:75]
s_waitcnt lgkmcnt(3)
ds_read_b128 a[76:79], v4 offset:19456
v_mfma_f32_16x16x32_bf16 v[72:75], a[124:127], a[28:31], v[72:75]
v_exp_f32 v12, v52
v_mfma_f32_16x16x32_bf16 v[76:79], a[96:99], a[32:35], v[20:23]
ds_read_b128 a[80:83], v4 offset:20480
v_add_f32 v27, v27, v12
v_mfma_f32_16x16x32_bf16 v[76:79], a[100:103], a[36:39], v[76:79]
buffer_load_dwordx4 v1, s[4:7], s8 offen offset:2048 sc1 lds
v_mfma_f32_16x16x32_bf16 v[76:79], a[104:107], a[40:43], v[76:79]
ds_read_b128 a[84:87], v4 offset:21504
v_mfma_f32_16x16x32_bf16 v[76:79], a[108:111], a[44:47], v[76:79]
v_exp_f32 v13, v53
v_mfma_f32_16x16x32_bf16 v[76:79], a[112:115], a[48:51], v[76:79]
ds_read_b128 a[88:91], v4 offset:22528
v_add_f32 v27, v27, v13
v_mfma_f32_16x16x32_bf16 v[76:79], a[116:119], a[52:55], v[76:79]
s_waitcnt lgkmcnt(3)
buffer_load_dwordx4 v1, s[4:7], s8 offen offset:3072 sc1 lds
v_mfma_f32_16x16x32_bf16 v[76:79], a[120:123], a[56:59], v[76:79]
s_add_u32 s8, s8, 28672
ds_read_b128 a[92:95], v4 offset:23552
v_cvt_pk_bf16_f32 v108, v12, v13
v_mfma_f32_16x16x32_bf16 v[76:79], a[124:127], a[60:63], v[76:79]
s_sub_u32 s9, s9, 1
v_exp_f32 v14, v54
v_mfma_f32_16x16x32_bf16 v[80:83], a[64:67], a[0:3], v[16:19]
s_cmp_eq_u32 s9, 0
ds_read_b128 a[96:99], v4 offset:24576
v_add_f32 v27, v27, v14
v_mfma_f32_16x16x32_bf16 v[80:83], a[68:71], a[4:7], v[80:83]
s_cselect_b32 s8, s10, s8
v_exp_f32 v15, v55
v_mfma_f32_16x16x32_bf16 v[80:83], a[72:75], a[8:11], v[80:83]
s_cselect_b32 s9, s11, s9
ds_read_b128 a[100:103], v4 offset:25600
v_add_f32 v27, v27, v15
v_mfma_f32_16x16x32_bf16 v[80:83], a[76:79], a[12:15], v[80:83]
s_waitcnt lgkmcnt(4)
s_cselect_b32 s10, 3221225472, s10
v_cvt_pk_bf16_f32 v109, v14, v15
v_mfma_f32_16x16x32_bf16 v[80:83], a[80:83], a[16:19], v[80:83]
ds_read_b128 a[104:107], v4 offset:26624
v_mfma_f32_16x16x32_bf16 v[80:83], a[84:87], a[20:23], v[80:83]
s_waitcnt lgkmcnt(4)
v_exp_f32 v8, v56
v_mfma_f32_16x16x32_bf16 v[80:83], a[88:91], a[24:27], v[80:83]
s_waitcnt lgkmcnt(3)
ds_read_b128 a[108:111], v4 offset:27648
v_add_f32 v26, v26, v8
v_mfma_f32_16x16x32_bf16 v[80:83], a[92:95], a[28:31], v[80:83]
v_exp_f32 v9, v57
v_mfma_f32_16x16x32_bf16 v[84:87], a[64:67], a[32:35], v[20:23]
ds_read_b128 a[112:115], v4 offset:28672
v_add_f32 v26, v26, v9
v_mfma_f32_16x16x32_bf16 v[84:87], a[68:71], a[36:39], v[84:87]
v_exp_f32 v10, v58
v_mfma_f32_16x16x32_bf16 v[84:87], a[72:75], a[40:43], v[84:87]
ds_read_b128 a[116:119], v4 offset:29696
v_cvt_pk_bf16_f32 v102, v8, v9
v_mfma_f32_16x16x32_bf16 v[84:87], a[76:79], a[44:47], v[84:87]
v_exp_f32 v11, v59
v_mfma_f32_16x16x32_bf16 v[84:87], a[80:83], a[48:51], v[84:87]
ds_read_b128 a[120:123], v4 offset:30720
v_add_f32 v26, v26, v10
v_mfma_f32_16x16x32_bf16 v[84:87], a[84:87], a[52:55], v[84:87]
v_add_f32 v26, v26, v11
v_cvt_pk_bf16_f32 v103, v10, v11
v_mfma_f32_16x16x32_bf16 v[84:87], a[88:91], a[56:59], v[84:87]
s_waitcnt vmcnt(8) lgkmcnt(4)
ds_read_b128 a[124:127], v4 offset:31744
v_mfma_f32_16x16x32_bf16 v[84:87], a[92:95], a[60:63], v[84:87]
s_barrier
v_mfma_f32_16x16x32_bf16 v[88:91], a[96:99], a[0:3], v[16:19]
ds_read_b128 a[64:67], v2 offset:0
v_mfma_f32_16x16x32_bf16 v[88:91], a[100:103], a[4:7], v[88:91]
v_exp_f32 v12, v60
v_mfma_f32_16x16x32_bf16 v[88:91], a[104:107], a[8:11], v[88:91]
s_waitcnt lgkmcnt(4)
ds_read_b128 a[68:71], v2 offset:1024
v_add_f32 v27, v27, v12
v_mfma_f32_16x16x32_bf16 v[88:91], a[108:111], a[12:15], v[88:91]
v_exp_f32 v13, v61
v_mfma_f32_16x16x32_bf16 v[88:91], a[112:115], a[16:19], v[88:91]
s_waitcnt lgkmcnt(4)
ds_read_b128 a[72:75], v2 offset:2048
v_add_f32 v27, v27, v13
v_mfma_f32_16x16x32_bf16 v[88:91], a[116:119], a[20:23], v[88:91]
s_waitcnt lgkmcnt(4)
v_exp_f32 v14, v62
v_mfma_f32_16x16x32_bf16 v[88:91], a[120:123], a[24:27], v[88:91]
s_waitcnt lgkmcnt(3)
ds_read_b128 a[76:79], v2 offset:3072
v_cvt_pk_bf16_f32 v110, v12, v13
v_mfma_f32_16x16x32_bf16 v[88:91], a[124:127], a[28:31], v[88:91]
v_exp_f32 v15, v63
v_mfma_f32_16x16x32_bf16 v[92:95], a[96:99], a[32:35], v[20:23]
s_sub_u32 s19, s19, 1
ds_read_b128 a[80:83], v2 offset:4096
v_add_f32 v27, v27, v14
v_mfma_f32_16x16x32_bf16 v[92:95], a[100:103], a[36:39], v[92:95]
v_add_f32 v27, v27, v15
v_cvt_pk_bf16_f32 v111, v14, v15
v_mfma_f32_16x16x32_bf16 v[92:95], a[104:107], a[40:43], v[92:95]
ds_read_b128 a[84:87], v2 offset:5120
v_add_f32 v28, v26, v27
v_mfma_f32_16x16x32_bf16 v[92:95], a[108:111], a[44:47], v[92:95]
v_cmp_nge_f32 vcc, s25, v28
v_mfma_f32_16x16x32_bf16 v[92:95], a[112:115], a[48:51], v[92:95]
s_cmp_eq_u64 vcc, 0
ds_read_b128 a[88:91], v2 offset:6144
v_mfma_f32_16x16x32_bf16 v[92:95], a[116:119], a[52:55], v[92:95]
s_cselect_b32 s22, s19, 0
v_mfma_f32_16x16x32_bf16 v[92:95], a[120:123], a[56:59], v[92:95]
s_cmp_eq_u32 s22, 0
ds_read_b128 a[92:95], v2 offset:7168
v_mfma_f32_16x16x32_bf16 v[92:95], a[124:127], a[60:63], v[92:95]
s_waitcnt lgkmcnt(4)
s_cbranch_scc1 K2_xexit
K2_loop:
v_mfma_f32_16x16x32_bf16 v[128:131], a[64:67], v[96:99], v[128:131]
s_add_u32 m0, s18, 98304
ds_read_b128 a[96:99], v2 offset:8192
v_add_f32 v24, v24, v26
v_mfma_f32_16x16x32_bf16 v[128:131], a[68:71], v[100:103], v[128:131]
buffer_load_dwordx4 v1, s[4:7], s12 offen offset:0 sc1 lds
v_mfma_f32_16x16x32_bf16 v[132:135], a[68:71], v[108:111], v[132:135]
ds_read_b128 a[100:103], v2 offset:9216
v_add_f32 v25, v25, v27
v_mfma_f32_16x16x32_bf16 v[132:135], a[64:67], v[104:107], v[132:135]
v_exp_f32 v8, v64
v_mfma_f32_16x16x32_bf16 v[136:139], a[72:75], v[96:99], v[136:139]
ds_read_b128 a[104:107], v2 offset:10240
v_mfma_f32_16x16x32_bf16 v[136:139], a[76:79], v[100:103], v[136:139]
buffer_load_dwordx4 v1, s[4:7], s12 offen offset:1024 sc1 lds
v_mfma_f32_16x16x32_bf16 v[140:143], a[76:79], v[108:111], v[140:143]
ds_read_b128 a[108:111], v2 offset:11264
v_mfma_f32_16x16x32_bf16 v[140:143], a[72:75], v[104:107], v[140:143]
s_waitcnt lgkmcnt(4)
v_exp_f32 v9, v65
v_mfma_f32_16x16x32_bf16 v[144:147], a[80:83], v[96:99], v[144:147]
PAD_10:
s_cbranch_execz M_tret
ds_read_b128 a[112:115], v2 offset:12288
v_add_f32 v26, v8, v9
v_mfma_f32_16x16x32_bf16 v[144:147], a[84:87], v[100:103], v[144:147]
buffer_load_dwordx4 v1, s[4:7], s12 offen offset:2048 sc1 lds
v_mfma_f32_16x16x32_bf16 v[148:151], a[84:87], v[108:111], v[148:151]
ds_read_b128 a[116:119], v2 offset:13312
v_cvt_pk_bf16_f32 v112, v8, v9
v_mfma_f32_16x16x32_bf16 v[148:151], a[80:83], v[104:107], v[148:151]
v_exp_f32 v10, v66
v_mfma_f32_16x16x32_bf16 v[152:155], a[88:91], v[96:99], v[152:155]
ds_read_b128 a[120:123], v2 offset:14336
v_add_f32 v26, v26, v10
v_mfma_f32_16x16x32_bf16 v[152:155], a[92:95], v[100:103], v[152:155]
buffer_load_dwordx4 v1, s[4:7], s12 offen offset:3072 sc1 lds
v_mfma_f32_16x16x32_bf16 v[156:159], a[92:95], v[108:111], v[156:159]
s_add_u32 s12, s12, 4096
ds_read_b128 a[124:127], v2 offset:15360
v_mfma_f32_16x16x32_bf16 v[156:159], a[88:91], v[104:107], v[156:159]
s_waitcnt lgkmcnt(4)
v_exp_f32 v11, v67
v_mfma_f32_16x16x32_bf16 v[160:163], a[96:99], v[96:99], v[160:163]
s_add_u32 m0, s18, 102400
ds_read_b128 a[64:67], v2 offset:16384
v_add_f32 v26, v26, v11
v_mfma_f32_16x16x32_bf16 v[160:163], a[100:103], v[100:103], v[160:163]
buffer_load_dwordx4 v1, s[4:7], s12 offen offset:0 sc1 lds
v_mfma_f32_16x16x32_bf16 v[164:167], a[100:103], v[108:111], v[164:167]
ds_read_b128 a[68:71], v2 offset:17408
v_cvt_pk_bf16_f32 v113, v10, v11
v_mfma_f32_16x16x32_bf16 v[164:167], a[96:99], v[104:107], v[164:167]
v_mfma_f32_16x16x32_bf16 v[168:171], a[104:107], v[96:99], v[168:171]
ds_read_b128 a[72:75], v2 offset:18432
v_mfma_f32_16x16x32_bf16 v[168:171], a[108:111], v[100:103], v[168:171]
buffer_load_dwordx4 v1, s[4:7], s12 offen offset:1024 sc1 lds
v_mfma_f32_16x16x32_bf16 v[172:175], a[108:111], v[108:111], v[172:175]
ds_read_b128 a[76:79], v2 offset:19456
v_mfma_f32_16x16x32_bf16 v[172:175], a[104:107], v[104:107], v[172:175]
s_waitcnt lgkmcnt(4)
v_exp_f32 v12, v68
v_mfma_f32_16x16x32_bf16 v[176:179], a[112:115], v[96:99], v[176:179]
ds_read_b128 a[80:83], v2 offset:20480
v_mfma_f32_16x16x32_bf16 v[176:179], a[116:119], v[100:103], v[176:179]
buffer_load_dwordx4 v1, s[4:7], s12 offen offset:2048 sc1 lds
v_mfma_f32_16x16x32_bf16 v[180:183], a[116:119], v[108:111], v[180:183]
ds_read_b128 a[84:87], v2 offset:21504
v_mfma_f32_16x16x32_bf16 v[180:183], a[112:115], v[104:107], v[180:183]
v_exp_f32 v13, v69
v_mfma_f32_16x16x32_bf16 v[184:187], a[120:123], v[96:99], v[184:187]
ds_read_b128 a[88:91], v2 offset:22528
v_add_f32 v27, v12, v13
v_mfma_f32_16x16x32_bf16 v[184:187], a[124:127], v[100:103], v[184:187]
s_waitcnt lgkmcnt(4)
buffer_load_dwordx4 v1, s[4:7], s12 offen offset:3072 sc1 lds
v_mfma_f32_16x16x32_bf16 v[188:191], a[124:127], v[108:111], v[188:191]
s_add_u32 s12, s12, 28672
ds_read_b128 a[92:95], v2 offset:23552
v_cvt_pk_bf16_f32 v120, v12, v13
v_mfma_f32_16x16x32_bf16 v[188:191], a[120:123], v[104:107], v[188:191]
s_sub_u32 s13, s13, 1
v_exp_f32 v14, v70
v_mfma_f32_16x16x32_bf16 v[192:195], a[64:67], v[96:99], v[192:195]
s_cmp_eq_u32 s13, 0
ds_read_b128 a[96:99], v2 offset:24576
v_add_f32 v27, v27, v14
v_mfma_f32_16x16x32_bf16 v[192:195], a[68:71], v[100:103], v[192:195]
s_cselect_b32 s12, s14, s12
v_mfma_f32_16x16x32_bf16 v[196:199], a[68:71], v[108:111], v[196:199]
s_cselect_b32 s13, s15, s13
ds_read_b128 a[100:103], v2 offset:25600
v_mfma_f32_16x16x32_bf16 v[196:199], a[64:67], v[104:107], v[196:199]
s_cselect_b32 s14, 3221225472, s14
v_exp_f32 v15, v71
v_mfma_f32_16x16x32_bf16 v[200:203], a[72:75], v[96:99], v[200:203]
s_waitcnt lgkmcnt(4)
ds_read_b128 a[104:107], v2 offset:26624
v_add_f32 v27, v27, v15
v_mfma_f32_16x16x32_bf16 v[200:203], a[76:79], v[100:103], v[200:203]
v_exp_f32 v8, v72
v_mfma_f32_16x16x32_bf16 v[204:207], a[76:79], v[108:111], v[204:207]
ds_read_b128 a[108:111], v2 offset:27648
v_cvt_pk_bf16_f32 v121, v14, v15
v_mfma_f32_16x16x32_bf16 v[204:207], a[72:75], v[104:107], v[204:207]
v_exp_f32 v9, v73
v_mfma_f32_16x16x32_bf16 v[208:211], a[80:83], v[96:99], v[208:211]
ds_read_b128 a[112:115], v2 offset:28672
v_add_f32 v26, v26, v8
v_mfma_f32_16x16x32_bf16 v[208:211], a[84:87], v[100:103], v[208:211]
v_add_f32 v26, v26, v9
v_cvt_pk_bf16_f32 v114, v8, v9
v_mfma_f32_16x16x32_bf16 v[212:215], a[84:87], v[108:111], v[212:215]
ds_read_b128 a[116:119], v2 offset:29696
v_mfma_f32_16x16x32_bf16 v[212:215], a[80:83], v[104:107], v[212:215]
s_waitcnt lgkmcnt(4)
v_exp_f32 v10, v74
v_mfma_f32_16x16x32_bf16 v[216:219], a[88:91], v[96:99], v[216:219]
ds_read_b128 a[120:123], v2 offset:30720
v_add_f32 v26, v26, v10
v_mfma_f32_16x16x32_bf16 v[216:219], a[92:95], v[100:103], v[216:219]
v_exp_f32 v11, v75
v_mfma_f32_16x16x32_bf16 v[220:223], a[92:95], v[108:111], v[220:223]
s_waitcnt vmcnt(8)
ds_read_b128 a[124:127], v2 offset:31744
v_add_f32 v26, v26, v11
v_mfma_f32_16x16x32_bf16 v[220:223], a[88:91], v[104:107], v[220:223]
s_barrier
v_mfma_f32_16x16x32_bf16 v[224:227], a[96:99], v[96:99], v[224:227]
ds_read_b128 a[64:67], v1 offset:0
v_cvt_pk_bf16_f32 v115, v10, v11
v_mfma_f32_16x16x32_bf16 v[224:227], a[100:103], v[100:103], v[224:227]
v_exp_f32 v12, v76
v_mfma_f32_16x16x32_bf16 v[228:231], a[100:103], v[108:111], v[228:231]
ds_read_b128 a[68:71], v1 offset:1024
v_add_f32 v27, v27, v12
v_mfma_f32_16x16x32_bf16 v[228:231], a[96:99], v[104:107], v[228:231]
s_waitcnt lgkmcnt(4)
v_mfma_f32_16x16x32_bf16 v[232:235], a[104:107], v[96:99], v[232:235]
ds_read_b128 a[72:75], v1 offset:2048
v_mfma_f32_16x16x32_bf16 v[232:235], a[108:111], v[100:103], v[232:235]
v_exp_f32 v13, v77
v_mfma_f32_16x16x32_bf16 v[236:239], a[108:111], v[108:111], v[236:239]
ds_read_b128 a[76:79], v1 offset:3072
v_add_f32 v27, v27, v13
v_mfma_f32_16x16x32_bf16 v[236:239], a[104:107], v[104:107], v[236:239]
v_exp_f32 v14, v78
v_mfma_f32_16x16x32_bf16 v[240:243], a[112:115], v[96:99], v[240:243]
ds_read_b128 a[80:83], v1 offset:4096
v_cvt_pk_bf16_f32 v122, v12, v13
v_mfma_f32_16x16x32_bf16 v[240:243], a[116:119], v[100:103], v[240:243]
v_exp_f32 v15, v79
v_mfma_f32_16x16x32_bf16 v[244:247], a[116:119], v[108:111], v[244:247]
ds_read_b128 a[84:87], v1 offset:5120
v_add_f32 v27, v27, v14
v_mfma_f32_16x16x32_bf16 v[244:247], a[112:115], v[104:107], v[244:247]
s_waitcnt lgkmcnt(4)
v_add_f32 v27, v27, v15
v_cvt_pk_bf16_f32 v123, v14, v15
v_mfma_f32_16x16x32_bf16 v[248:251], a[120:123], v[96:99], v[248:251]
ds_read_b128 a[88:91], v1 offset:6144
v_mfma_f32_16x16x32_bf16 v[248:251], a[124:127], v[100:103], v[248:251]
v_mfma_f32_16x16x32_bf16 v[252:255], a[124:127], v[108:111], v[252:255]
ds_read_b128 a[92:95], v1 offset:7168
v_mfma_f32_16x16x32_bf16 v[252:255], a[120:123], v[104:107], v[252:255]
K2_x0:
v_mfma_f32_16x16x32_bf16 v[32:35], a[64:67], a[0:3], v[16:19]
s_add_u32 m0, s18, 131072
ds_read_b128 a[96:99], v1 offset:8192
v_mfma_f32_16x16x32_bf16 v[32:35], a[68:71], a[4:7], v[32:35]
s_waitcnt lgkmcnt(4)
buffer_load_dwordx4 v1, s[4:7], s8 offen offset:0 sc1 lds
v_mfma_f32_16x16x32_bf16 v[32:35], a[72:75], a[8:11], v[32:35]
ds_read_b128 a[100:103], v1 offset:9216
v_mfma_f32_16x16x32_bf16 v[32:35], a[76:79], a[12:15], v[32:35]
v_exp_f32 v8, v80
v_mfma_f32_16x16x32_bf16 v[32:35], a[80:83], a[16:19], v[32:35]
s_waitcnt lgkmcnt(4)
ds_read_b128 a[104:107], v1 offset:10240
v_add_f32 v26, v26, v8
v_mfma_f32_16x16x32_bf16 v[32:35], a[84:87], a[20:23], v[32:35]
s_waitcnt lgkmcnt(4)
buffer_load_dwordx4 v1, s[4:7], s8 offen offset:1024 sc1 lds
v_mfma_f32_16x16x32_bf16 v[32:35], a[88:91], a[24:27], v[32:35]
s_waitcnt lgkmcnt(3)
ds_read_b128 a[108:111], v1 offset:11264
v_mfma_f32_16x16x32_bf16 v[32:35], a[92:95], a[28:31], v[32:35]
v_exp_f32 v9, v81
v_mfma_f32_16x16x32_bf16 v[36:39], a[64:67], a[32:35], v[20:23]
ds_read_b128 a[112:115], v1 offset:12288
v_add_f32 v26, v26, v9
v_mfma_f32_16x16x32_bf16 v[36:39], a[68:71], a[36:39], v[36:39]
buffer_load_dwordx4 v1, s[4:7], s8 offen offset:2048 sc1 lds
v_mfma_f32_16x16x32_bf16 v[36:39], a[72:75], a[40:43], v[36:39]
ds_read_b128 a[116:119], v1 offset:13312
v_cvt_pk_bf16_f32 v116, v8, v9
v_mfma_f32_16x16x32_bf16 v[36:39], a[76:79], a[44:47], v[36:39]
v_exp_f32 v10, v82
v_mfma_f32_16x16x32_bf16 v[36:39], a[80:83], a[48:51], v[36:39]
ds_read_b128 a[120:123], v1 offset:14336
v_add_f32 v26, v26, v10
v_mfma_f32_16x16x32_bf16 v[36:39], a[84:87], a[52:55], v[36:39]
buffer_load_dwordx4 v1, s[4:7], s8 offen offset:3072 sc1 lds
v_mfma_f32_16x16x32_bf16 v[36:39], a[88:91], a[56:59], v[36:39]
s_add_u32 s8, s8, 4096
ds_read_b128 a[124:127], v1 offset:15360
v_mfma_f32_16x16x32_bf16 v[36:39], a[92:95], a[60:63], v[36:39]
s_waitcnt lgkmcnt(4)
v_exp_f32 v11, v83
v_mfma_f32_16x16x32_bf16 v[40:43], a[96:99], a[0:3], v[16:19]
s_add_u32 m0, s18, 135168
ds_read_b128 a[64:67], v1 offset:16384
v_add_f32 v26, v26, v11
v_mfma_f32_16x16x32_bf16 v[40:43], a[100:103], a[4:7], v[40:43]
buffer_load_dwordx4 v1, s[4:7], s8 offen offset:0 sc1 lds
v_mfma_f32_16x16x32_bf16 v[40:43], a[104:107], a[8:11], v[40:43]
ds_read_b128 a[68:71], v1 offset:17408
v_cvt_pk_bf16_f32 v117, v10, v11
v_mfma_f32_16x16x32_bf16 v[40:43], a[108:111], a[12:15], v[40:43]
s_waitcnt lgkmcnt(4)
v_mfma_f32_16x16x32_bf16 v[40:43], a[112:115], a[16:19], v[40:43]
ds_read_b128 a[72:75], v1 offset:18432
v_mfma_f32_16x16x32_bf16 v[40:43], a[116:119], a[20:23], v[40:43]
s_waitcnt lgkmcnt(4)
buffer_load_dwordx4 v1, s[4:7], s8 offen offset:1024 sc1 lds
v_mfma_f32_16x16x32_bf16 v[40:43], a[120:123], a[24:27], v[40:43]
s_waitcnt lgkmcnt(3)
ds_read_b128 a[76:79], v1 offset:19456
v_mfma_f32_16x16x32_bf16 v[40:43], a[124:127], a[28:31], v[40:43]
v_exp_f32 v12, v84
v_mfma_f32_16x16x32_bf16 v[44:47], a[96:99], a[32:35], v[20:23]
ds_read_b128 a[80:83], v1 offset:20480
v_add_f32 v27, v27, v12
v_mfma_f32_16x16x32_bf16 v[44:47], a[100:103], a[36:39], v[44:47]
buffer_load_dwordx4 v1, s[4:7], s8 offen offset:2048 sc1 lds
v_mfma_f32_16x16x32_bf16 v[44:47], a[104:107], a[40:43], v[44:47]
ds_read_b128 a[84:87], v1 offset:21504
v_mfma_f32_16x16x32_bf16 v[44:47], a[108:111], a[44:47], v[44:47]
v_exp_f32 v13, v85
v_mfma_f32_16x16x32_bf16 v[44:47], a[112:115], a[48:51], v[44:47]
ds_read_b128 a[88:91], v1 offset:22528
v_add_f32 v27, v27, v13
v_mfma_f32_16x16x32_bf16 v[44:47], a[116:119], a[52:55], v[44:47]
s_waitcnt lgkmcnt(3)
buffer_load_dwordx4 v1, s[4:7], s8 offen offset:3072 sc1 lds
v_mfma_f32_16x16x32_bf16 v[44:47], a[120:123], a[56:59], v[44:47]
s_add_u32 s8, s8, 28672
ds_read_b128 a[92:95], v1 offset:23552
v_cvt_pk_bf16_f32 v124, v12, v13
v_mfma_f32_16x16x32_bf16 v[44:47], a[124:127], a[60:63], v[44:47]
s_sub_u32 s9, s9, 1
v_exp_f32 v14, v86
v_mfma_f32_16x16x32_bf16 v[48:51], a[64:67], a[0:3], v[16:19]
s_cmp_eq_u32 s9, 0
ds_read_b128 a[96:99], v1 offset:24576
v_add_f32 v27, v27, v14
v_mfma_f32_16x16x32_bf16 v[48:51], a[68:71], a[4:7], v[48:51]
s_cselect_b32 s8, s10, s8
v_exp_f32 v15, v87
v_mfma_f32_16x16x32_bf16 v[48:51], a[72:75], a[8:11], v[48:51]
s_cselect_b32 s9, s11, s9
ds_read_b128 a[100:103], v1 offset:25600
v_add_f32 v27, v27, v15
v_mfma_f32_16x16x32_bf16 v[48:51], a[76:79], a[12:15], v[48:51]
s_waitcnt lgkmcnt(4)
s_cselect_b32 s10, 3221225472, s10
v_cvt_pk_bf16_f32 v125, v14, v15
v_mfma_f32_16x16x32_bf16 v[48:51], a[80:83], a[16:19], v[48:51]
ds_read_b128 a[104:107], v1 offset:26624
v_mfma_f32_16x16x32_bf16 v[48:51], a[84:87], a[20:23], v[48:51]
s_waitcnt lgkmcnt(4)
v_exp_f32 v8, v88
v_mfma_f32_16x16x32_bf16 v[48:51], a[88:91], a[24:27], v[48:51]
s_waitcnt lgkmcnt(3)
ds_read_b128 a[108:111], v1 offset:27648
v_add_f32 v26, v26, v8
v_mfma_f32_16x16x32_bf16 v[48:51], a[92:95], a[28:31], v[48:51]
v_exp_f32 v9, v89
v_mfma_f32_16x16x32_bf16 v[52:55], a[64:67], a[32:35], v[20:23]
ds_read_b128 a[112:115], v1 offset:28672
v_add_f32 v26, v26, v9
v_mfma_f32_16x16x32_bf16 v[52:55], a[68:71], a[36:39], v[52:55]
v_exp_f32 v10, v90
v_mfma_f32_16x16x32_bf16 v[52:55], a[72:75], a[40:43], v[52:55]
ds_read_b128 a[116:119], v1 offset:29696
v_cvt_pk_bf16_f32 v118, v8, v9
v_mfma_f32_16x16x32_bf16 v[52:55], a[76:79], a[44:47], v[52:55]
v_exp_f32 v11, v91
v_mfma_f32_16x16x32_bf16 v[52:55], a[80:83], a[48:51], v[52:55]
ds_read_b128 a[120:123], v1 offset:30720
v_add_f32 v26, v26, v10
v_mfma_f32_16x16x32_bf16 v[52:55], a[84:87], a[52:55], v[52:55]
v_add_f32 v26, v26, v11
v_cvt_pk_bf16_f32 v119, v10, v11
v_mfma_f32_16x16x32_bf16 v[52:55], a[88:91], a[56:59], v[52:55]
s_waitcnt vmcnt(8) lgkmcnt(4)
ds_read_b128 a[124:127], v1 offset:31744
v_mfma_f32_16x16x32_bf16 v[52:55], a[92:95], a[60:63], v[52:55]
s_barrier
v_mfma_f32_16x16x32_bf16 v[56:59], a[96:99], a[0:3], v[16:19]
ds_read_b128 a[64:67], v2 offset:32768
v_mfma_f32_16x16x32_bf16 v[56:59], a[100:103], a[4:7], v[56:59]
v_exp_f32 v12, v92
v_mfma_f32_16x16x32_bf16 v[56:59], a[104:107], a[8:11], v[56:59]
s_waitcnt lgkmcnt(4)
ds_read_b128 a[68:71], v2 offset:33792
v_add_f32 v27, v27, v12
v_mfma_f32_16x16x32_bf16 v[56:59], a[108:111], a[12:15], v[56:59]
v_exp_f32 v13, v93
v_mfma_f32_16x16x32_bf16 v[56:59], a[112:115], a[16:19], v[56:59]
s_waitcnt lgkmcnt(4)
ds_read_b128 a[72:75], v2 offset:34816
v_add_f32 v27, v27, v13
v_mfma_f32_16x16x32_bf16 v[56:59], a[116:119], a[20:23], v[56:59]
s_waitcnt lgkmcnt(4)
v_exp_f32 v14, v94
v_mfma_f32_16x16x32_bf16 v[56:59], a[120:123], a[24:27], v[56:59]
s_waitcnt lgkmcnt(3)
ds_read_b128 a[76:79], v2 offset:35840
v_cvt_pk_bf16_f32 v126, v12, v13
v_mfma_f32_16x16x32_bf16 v[56:59], a[124:127], a[28:31], v[56:59]
v_exp_f32 v15, v95
v_mfma_f32_16x16x32_bf16 v[60:63], a[96:99], a[32:35], v[20:23]
ds_read_b128 a[80:83], v2 offset:36864
v_add_f32 v27, v27, v14
v_mfma_f32_16x16x32_bf16 v[60:63], a[100:103], a[36:39], v[60:63]
v_add_f32 v27, v27, v15
v_cvt_pk_bf16_f32 v127, v14, v15
v_mfma_f32_16x16x32_bf16 v[60:63], a[104:107], a[40:43], v[60:63]
ds_read_b128 a[84:87], v2 offset:37888
v_add_f32 v28, v26, v27
v_mfma_f32_16x16x32_bf16 v[60:63], a[108:111], a[44:47], v[60:63]
v_cmp_nge_f32 vcc, s25, v28
v_mfma_f32_16x16x32_bf16 v[60:63], a[112:115], a[48:51], v[60:63]
ds_read_b128 a[88:91], v2 offset:38912
v_mfma_f32_16x16x32_bf16 v[60:63], a[116:119], a[52:55], v[60:63]
v_mfma_f32_16x16x32_bf16 v[60:63], a[120:123], a[56:59], v[60:63]
ds_read_b128 a[92:95], v2 offset:39936
v_mfma_f32_16x16x32_bf16 v[60:63], a[124:127], a[60:63], v[60:63]
s_waitcnt lgkmcnt(4)
s_cbranch_vccnz Lstub_2
Lback_3:
v_mfma_f32_16x16x32_bf16 v[128:131], a[64:67], v[112:115], v[128:131]
s_add_u32 m0, s18, 65536
ds_read_b128 a[96:99], v2 offset:40960
v_add_f32 v24, v24, v26
v_mfma_f32_16x16x32_bf16 v[128:131], a[68:71], v[116:119], v[128:131]
buffer_load_dwordx4 v1, s[4:7], s12 offen offset:0 sc1 lds
v_mfma_f32_16x16x32_bf16 v[132:135], a[68:71], v[124:127], v[132:135]
ds_read_b128 a[100:103], v2 offset:41984
v_add_f32 v25, v25, v27
v_mfma_f32_16x16x32_bf16 v[132:135], a[64:67], v[120:123], v[132:135]
v_exp_f32 v8, v32
v_mfma_f32_16x16x32_bf16 v[136:139], a[72:75], v[112:115], v[136:139]
ds_read_b128 a[104:107], v2 offset:43008
v_mfma_f32_16x16x32_bf16 v[136:139], a[76:79], v[116:119], v[136:139]
buffer_load_dwordx4 v1, s[4:7], s12 offen offset:1024 sc1 lds
v_mfma_f32_16x16x32_bf16 v[140:143], a[76:79], v[124:127], v[140:143]
ds_read_b128 a[108:111], v2 offset:44032
v_mfma_f32_16x16x32_bf16 v[140:143], a[72:75], v[120:123], v[140:143]
s_waitcnt lgkmcnt(4)
v_exp_f32 v9, v33
v_mfma_f32_16x16x32_bf16 v[144:147], a[80:83], v[112:115], v[144:147]
ds_read_b128 a[112:115], v2 offset:45056
v_add_f32 v26, v8, v9
v_mfma_f32_16x16x32_bf16 v[144:147], a[84:87], v[116:119], v[144:147]
buffer_load_dwordx4 v1, s[4:7], s12 offen offset:2048 sc1 lds
v_mfma_f32_16x16x32_bf16 v[148:151], a[84:87], v[124:127], v[148:151]
ds_read_b128 a[116:119], v2 offset:46080
v_cvt_pk_bf16_f32 v96, v8, v9
v_mfma_f32_16x16x32_bf16 v[148:151], a[80:83], v[120:123], v[148:151]
v_exp_f32 v10, v34
v_mfma_f32_16x16x32_bf16 v[152:155], a[88:91], v[112:115], v[152:155]
ds_read_b128 a[120:123], v2 offset:47104
v_add_f32 v26, v26, v10
v_mfma_f32_16x16x32_bf16 v[152:155], a[92:95], v[116:119], v[152:155]
buffer_load_dwordx4 v1, s[4:7], s12 offen offset:3072 sc1 lds
v_mfma_f32_16x16x32_bf16 v[156:159], a[92:95], v[124:127], v[156:159]
s_add_u32 s12, s12, 4096
ds_read_b128 a[124:127], v2 offset:48128
v_mfma_f32_16x16x32_bf16 v[156:159], a[88:91], v[120:123], v[156:159]
s_waitcnt lgkmcnt(4)
v_exp_f32 v11, v35
v_mfma_f32_16x16x32_bf16 v[160:163], a[96:99], v[112:115], v[160:163]
s_add_u32 m0, s18, 69632
ds_read_b128 a[64:67], v2 offset:49152
v_add_f32 v26, v26, v11
v_mfma_f32_16x16x32_bf16 v[160:163], a[100:103], v[116:119], v[160:163]
buffer_load_dwordx4 v1, s[4:7], s12 offen offset:0 sc1 lds
v_mfma_f32_16x16x32_bf16 v[164:167], a[100:103], v[124:127], v[164:167]
ds_read_b128 a[68:71], v2 offset:50176
v_cvt_pk_bf16_f32 v97, v10, v11
v_mfma_f32_16x16x32_bf16 v[164:167], a[96:99], v[120:123], v[164:167]
v_mfma_f32_16x16x32_bf16 v[168:171], a[104:107], v[112:115], v[168:171]
ds_read_b128 a[72:75], v2 offset:51200
v_mfma_f32_16x16x32_bf16 v[168:171], a[108:111], v[116:119], v[168:171]
buffer_load_dwordx4 v1, s[4:7], s12 offen offset:1024 sc1 lds
v_mfma_f32_16x16x32_bf16 v[172:175], a[108:111], v[124:127], v[172:175]
ds_read_b128 a[76:79], v2 offset:52224
v_mfma_f32_16x16x32_bf16 v[172:175], a[104:107], v[120:123], v[172:175]
s_waitcnt lgkmcnt(4)
v_exp_f32 v12, v36
v_mfma_f32_16x16x32_bf16 v[176:179], a[112:115], v[112:115], v[176:179]
ds_read_b128 a[80:83], v2 offset:53248
v_mfma_f32_16x16x32_bf16 v[176:179], a[116:119], v[116:119], v[176:179]
buffer_load_dwordx4 v1, s[4:7], s12 offen offset:2048 sc1 lds
v_mfma_f32_16x16x32_bf16 v[180:183], a[116:119], v[124:127], v[180:183]
ds_read_b128 a[84:87], v2 offset:54272
v_mfma_f32_16x16x32_bf16 v[180:183], a[112:115], v[120:123], v[180:183]
v_exp_f32 v13, v37
v_mfma_f32_16x16x32_bf16 v[184:187], a[120:123], v[112:115], v[184:187]
ds_read_b128 a[88:91], v2 offset:55296
v_add_f32 v27, v12, v13
v_mfma_f32_16x16x32_bf16 v[184:187], a[124:127], v[116:119], v[184:187]
s_waitcnt lgkmcnt(4)
buffer_load_dwordx4 v1, s[4:7], s12 offen offset:3072 sc1 lds
v_mfma_f32_16x16x32_bf16 v[188:191], a[124:127], v[124:127], v[188:191]
s_add_u32 s12, s12, 28672
ds_read_b128 a[92:95], v2 offset:56320
v_cvt_pk_bf16_f32 v104, v12, v13
v_mfma_f32_16x16x32_bf16 v[188:191], a[120:123], v[120:123], v[188:191]
s_sub_u32 s13, s13, 1
v_exp_f32 v14, v38
v_mfma_f32_16x16x32_bf16 v[192:195], a[64:67], v[112:115], v[192:195]
s_cmp_eq_u32 s13, 0
ds_read_b128 a[96:99], v2 offset:57344
v_add_f32 v27, v27, v14
v_mfma_f32_16x16x32_bf16 v[192:195], a[68:71], v[116:119], v[192:195]
s_cselect_b32 s12, s14, s12
v_mfma_f32_16x16x32_bf16 v[196:199], a[68:71], v[124:127], v[196:199]
s_cselect_b32 s13, s15, s13
ds_read_b128 a[100:103], v2 offset:58368
v_mfma_f32_16x16x32_bf16 v[196:199], a[64:67], v[120:123], v[196:199]
s_cselect_b32 s14, 3221225472, s14
v_exp_f32 v15, v39
v_mfma_f32_16x16x32_bf16 v[200:203], a[72:75], v[112:115], v[200:203]
s_waitcnt lgkmcnt(4)
ds_read_b128 a[104:107], v2 offset:59392
v_add_f32 v27, v27, v15
v_mfma_f32_16x16x32_bf16 v[200:203], a[76:79], v[116:119], v[200:203]
v_exp_f32 v8, v40
v_mfma_f32_16x16x32_bf16 v[204:207], a[76:79], v[124:127], v[204:207]
ds_read_b128 a[108:111], v2 offset:60416
v_cvt_pk_bf16_f32 v105, v14, v15
v_mfma_f32_16x16x32_bf16 v[204:207], a[72:75], v[120:123], v[204:207]
v_exp_f32 v9, v41
v_mfma_f32_16x16x32_bf16 v[208:211], a[80:83], v[112:115], v[208:211]
ds_read_b128 a[112:115], v2 offset:61440
v_add_f32 v26, v26, v8
v_mfma_f32_16x16x32_bf16 v[208:211], a[84:87], v[116:119], v[208:211]
v_add_f32 v26, v26, v9
v_cvt_pk_bf16_f32 v98, v8, v9
v_mfma_f32_16x16x32_bf16 v[212:215], a[84:87], v[124:127], v[212:215]
ds_read_b128 a[116:119], v2 offset:62464
v_mfma_f32_16x16x32_bf16 v[212:215], a[80:83], v[120:123], v[212:215]
s_waitcnt lgkmcnt(4)
v_exp_f32 v10, v42
v_mfma_f32_16x16x32_bf16 v[216:219], a[88:91], v[112:115], v[216:219]
ds_read_b128 a[120:123], v2 offset:63488
v_add_f32 v26, v26, v10
v_mfma_f32_16x16x32_bf16 v[216:219], a[92:95], v[116:119], v[216:219]
v_exp_f32 v11, v43
v_mfma_f32_16x16x32_bf16 v[220:223], a[92:95], v[124:127], v[220:223]
s_waitcnt vmcnt(8)
ds_read_b128 a[124:127], v2 offset:64512
v_add_f32 v26, v26, v11
v_mfma_f32_16x16x32_bf16 v[220:223], a[88:91], v[120:123], v[220:223]
s_barrier
v_mfma_f32_16x16x32_bf16 v[224:227], a[96:99], v[112:115], v[224:227]
ds_read_b128 a[64:67], v4 offset:0
v_cvt_pk_bf16_f32 v99, v10, v11
v_mfma_f32_16x16x32_bf16 v[224:227], a[100:103], v[116:119], v[224:227]
v_exp_f32 v12, v44
v_mfma_f32_16x16x32_bf16 v[228:231], a[100:103], v[124:127], v[228:231]
ds_read_b128 a[68:71], v4 offset:1024
v_add_f32 v27, v27, v12
v_mfma_f32_16x16x32_bf16 v[228:231], a[96:99], v[120:123], v[228:231]
s_waitcnt lgkmcnt(4)
v_mfma_f32_16x16x32_bf16 v[232:235], a[104:107], v[112:115], v[232:235]
ds_read_b128 a[72:75], v4 offset:2048
v_mfma_f32_16x16x32_bf16 v[232:235], a[108:111], v[116:119], v[232:235]
v_exp_f32 v13, v45
v_mfma_f32_16x16x32_bf16 v[236:239], a[108:111], v[124:127], v[236:239]
ds_read_b128 a[76:79], v4 offset:3072
v_add_f32 v27, v27, v13
v_mfma_f32_16x16x32_bf16 v[236:239], a[104:107], v[120:123], v[236:239]
v_exp_f32 v14, v46
v_mfma_f32_16x16x32_bf16 v[240:243], a[112:115], v[112:115], v[240:243]
ds_read_b128 a[80:83], v4 offset:4096
v_cvt_pk_bf16_f32 v106, v12, v13
v_mfma_f32_16x16x32_bf16 v[240:243], a[116:119], v[116:119], v[240:243]
v_exp_f32 v15, v47
v_mfma_f32_16x16x32_bf16 v[244:247], a[116:119], v[124:127], v[244:247]
ds_read_b128 a[84:87], v4 offset:5120
v_add_f32 v27, v27, v14
v_mfma_f32_16x16x32_bf16 v[244:247], a[112:115], v[120:123], v[244:247]
s_waitcnt lgkmcnt(4)
v_add_f32 v27, v27, v15
v_cvt_pk_bf16_f32 v107, v14, v15
v_mfma_f32_16x16x32_bf16 v[248:251], a[120:123], v[112:115], v[248:251]
ds_read_b128 a[88:91], v4 offset:6144
v_mfma_f32_16x16x32_bf16 v[248:251], a[124:127], v[116:119], v[248:251]
v_mfma_f32_16x16x32_bf16 v[252:255], a[124:127], v[124:127], v[252:255]
s_waitcnt lgkmcnt(5)
ds_read_b128 a[92:95], v4 offset:7168
v_mfma_f32_16x16x32_bf16 v[252:255], a[120:123], v[120:123], v[252:255]
s_branch K2_x1
K2_xexit:
s_cbranch_vccnz Lstub_4
Lback_5:
s_cmp_lg_u32 s19, 0
s_cbranch_scc1 K2_loop
s_cmp_eq_u32 s24, 2
s_cbranch_scc1 K2_ntail
v_mfma_f32_16x16x32_bf16 v[128:131], a[64:67], v[96:99], v[128:131]
s_add_u32 m0, s18, 98304
ds_read_b128 a[96:99], v2 offset:8192
v_add_f32 v24, v24, v26
v_mfma_f32_16x16x32_bf16 v[128:131], a[68:71], v[100:103], v[128:131]
buffer_load_dwordx4 v1, s[4:7], s12 offen offset:0 sc1 lds
v_mfma_f32_16x16x32_bf16 v[132:135], a[68:71], v[108:111], v[132:135]
ds_read_b128 a[100:103], v2 offset:9216
v_add_f32 v25, v25, v27
v_mfma_f32_16x16x32_bf16 v[132:135], a[64:67], v[104:107], v[132:135]
v_exp_f32 v8, v64
v_mfma_f32_16x16x32_bf16 v[136:139], a[72:75], v[96:99], v[136:139]
ds_read_b128 a[104:107], v2 offset:10240
v_mfma_f32_16x16x32_bf16 v[136:139], a[76:79], v[100:103], v[136:139]
buffer_load_dwordx4 v1, s[4:7], s12 offen offset:1024 sc1 lds
v_mfma_f32_16x16x32_bf16 v[140:143], a[76:79], v[108:111], v[140:143]
ds_read_b128 a[108:111], v2 offset:11264
v_mfma_f32_16x16x32_bf16 v[140:143], a[72:75], v[104:107], v[140:143]
s_waitcnt lgkmcnt(4)
v_exp_f32 v9, v65
v_mfma_f32_16x16x32_bf16 v[144:147], a[80:83], v[96:99], v[144:147]
ds_read_b128 a[112:115], v2 offset:12288
v_add_f32 v26, v8, v9
v_mfma_f32_16x16x32_bf16 v[144:147], a[84:87], v[100:103], v[144:147]
buffer_load_dwordx4 v1, s[4:7], s12 offen offset:2048 sc1 lds
v_mfma_f32_16x16x32_bf16 v[148:151], a[84:87], v[108:111], v[148:151]
ds_read_b128 a[116:119], v2 offset:13312
v_cvt_pk_bf16_f32 v112, v8, v9
v_mfma_f32_16x16x32_bf16 v[148:151], a[80:83], v[104:107], v[148:151]
v_exp_f32 v10, v66
v_mfma_f32_16x16x32_bf16 v[152:155], a[88:91], v[96:99], v[152:155]
ds_read_b128 a[120:123], v2 offset:14336
v_add_f32 v26, v26, v10
v_mfma_f32_16x16x32_bf16 v[152:155], a[92:95], v[100:103], v[152:155]
buffer_load_dwordx4 v1, s[4:7], s12 offen offset:3072 sc1 lds
v_mfma_f32_16x16x32_bf16 v[156:159], a[92:95], v[108:111], v[156:159]
s_add_u32 s12, s12, 4096
ds_read_b128 a[124:127], v2 offset:15360
v_mfma_f32_16x16x32_bf16 v[156:159], a[88:91], v[104:107], v[156:159]
s_waitcnt lgkmcnt(4)
v_exp_f32 v11, v67
v_mfma_f32_16x16x32_bf16 v[160:163], a[96:99], v[96:99], v[160:163]
s_add_u32 m0, s18, 102400
ds_read_b128 a[64:67], v2 offset:16384
v_add_f32 v26, v26, v11
v_mfma_f32_16x16x32_bf16 v[160:163], a[100:103], v[100:103], v[160:163]
buffer_load_dwordx4 v1, s[4:7], s12 offen offset:0 sc1 lds
v_mfma_f32_16x16x32_bf16 v[164:167], a[100:103], v[108:111], v[164:167]
ds_read_b128 a[68:71], v2 offset:17408
v_cvt_pk_bf16_f32 v113, v10, v11
v_mfma_f32_16x16x32_bf16 v[164:167], a[96:99], v[104:107], v[164:167]
v_mfma_f32_16x16x32_bf16 v[168:171], a[104:107], v[96:99], v[168:171]
ds_read_b128 a[72:75], v2 offset:18432
v_mfma_f32_16x16x32_bf16 v[168:171], a[108:111], v[100:103], v[168:171]
buffer_load_dwordx4 v1, s[4:7], s12 offen offset:1024 sc1 lds
v_mfma_f32_16x16x32_bf16 v[172:175], a[108:111], v[108:111], v[172:175]
ds_read_b128 a[76:79], v2 offset:19456
v_mfma_f32_16x16x32_bf16 v[172:175], a[104:107], v[104:107], v[172:175]
s_waitcnt lgkmcnt(4)
v_exp_f32 v12, v68
v_mfma_f32_16x16x32_bf16 v[176:179], a[112:115], v[96:99], v[176:179]
ds_read_b128 a[80:83], v2 offset:20480
v_mfma_f32_16x16x32_bf16 v[176:179], a[116:119], v[100:103], v[176:179]
buffer_load_dwordx4 v1, s[4:7], s12 offen offset:2048 sc1 lds
v_mfma_f32_16x16x32_bf16 v[180:183], a[116:119], v[108:111], v[180:183]
ds_read_b128 a[84:87], v2 offset:21504
v_mfma_f32_16x16x32_bf16 v[180:183], a[112:115], v[104:107], v[180:183]
v_exp_f32 v13, v69
v_mfma_f32_16x16x32_bf16 v[184:187], a[120:123], v[96:99], v[184:187]
ds_read_b128 a[88:91], v2 offset:22528
v_add_f32 v27, v12, v13
v_mfma_f32_16x16x32_bf16 v[184:187], a[124:127], v[100:103], v[184:187]
s_waitcnt lgkmcnt(4)
buffer_load_dwordx4 v1, s[4:7], s12 offen offset:3072 sc1 lds
v_mfma_f32_16x16x32_bf16 v[188:191], a[124:127], v[108:111], v[188:191]
s_add_u32 s12, s12, 28672
ds_read_b128 a[92:95], v2 offset:23552
v_cvt_pk_bf16_f32 v120, v12, v13
v_mfma_f32_16x16x32_bf16 v[188:191], a[120:123], v[104:107], v[188:191]
s_sub_u32 s13, s13, 1
v_exp_f32 v14, v70
v_mfma_f32_16x16x32_bf16 v[192:195], a[64:67], v[96:99], v[192:195]
s_cmp_eq_u32 s13, 0
ds_read_b128 a[96:99], v2 offset:24576
v_add_f32 v27, v27, v14
v_mfma_f32_16x16x32_bf16 v[192:195], a[68:71], v[100:103], v[192:195]
s_cselect_b32 s12, s14, s12
v_mfma_f32_16x16x32_bf16 v[196:199], a[68:71], v[108:111], v[196:199]
s_cselect_b32 s13, s15, s13
ds_read_b128 a[100:103], v2 offset:25600
v_mfma_f32_16x16x32_bf16 v[196:199], a[64:67], v[104:107], v[196:199]
s_cselect_b32 s14, 3221225472, s14
v_exp_f32 v15, v71
v_mfma_f32_16x16x32_bf16 v[200:203], a[72:75], v[96:99], v[200:203]
s_waitcnt lgkmcnt(4)
ds_read_b128 a[104:107], v2 offset:26624
v_add_f32 v27, v27, v15
v_mfma_f32_16x16x32_bf16 v[200:203], a[76:79], v[100:103], v[200:203]
v_exp_f32 v8, v72
v_mfma_f32_16x16x32_bf16 v[204:207], a[76:79], v[108:111], v[204:207]
ds_read_b128 a[108:111], v2 offset:27648
v_cvt_pk_bf16_f32 v121, v14, v15
v_mfma_f32_16x16x32_bf16 v[204:207], a[72:75], v[104:107], v[204:207]
v_exp_f32 v9, v73
v_mfma_f32_16x16x32_bf16 v[208:211], a[80:83], v[96:99], v[208:211]
ds_read_b128 a[112:115], v2 offset:28672
v_add_f32 v26, v26, v8
v_mfma_f32_16x16x32_bf16 v[208:211], a[84:87], v[100:103], v[208:211]
v_add_f32 v26, v26, v9
v_cvt_pk_bf16_f32 v114, v8, v9
v_mfma_f32_16x16x32_bf16 v[212:215], a[84:87], v[108:111], v[212:215]
ds_read_b128 a[116:119], v2 offset:29696
v_mfma_f32_16x16x32_bf16 v[212:215], a[80:83], v[104:107], v[212:215]
s_waitcnt lgkmcnt(4)
v_exp_f32 v10, v74
v_mfma_f32_16x16x32_bf16 v[216:219], a[88:91], v[96:99], v[216:219]
ds_read_b128 a[120:123], v2 offset:30720
v_add_f32 v26, v26, v10
v_mfma_f32_16x16x32_bf16 v[216:219], a[92:95], v[100:103], v[216:219]
v_exp_f32 v11, v75
v_mfma_f32_16x16x32_bf16 v[220:223], a[92:95], v[108:111], v[220:223]
s_waitcnt vmcnt(8)
ds_read_b128 a[124:127], v2 offset:31744
v_add_f32 v26, v26, v11
v_mfma_f32_16x16x32_bf16 v[220:223], a[88:91], v[104:107], v[220:223]
PAD_11:
s_cbranch_execz M_tret
s_barrier
v_mfma_f32_16x16x32_bf16 v[224:227], a[96:99], v[96:99], v[224:227]
ds_read_b128 a[64:67], v1 offset:0
v_cvt_pk_bf16_f32 v115, v10, v11
v_mfma_f32_16x16x32_bf16 v[224:227], a[100:103], v[100:103], v[224:227]
v_exp_f32 v12, v76
v_mfma_f32_16x16x32_bf16 v[228:231], a[100:103], v[108:111], v[228:231]
ds_read_b128 a[68:71], v1 offset:1024
v_add_f32 v27, v27, v12
v_mfma_f32_16x16x32_bf16 v[228:231], a[96:99], v[104:107], v[228:231]
s_waitcnt lgkmcnt(4)
v_mfma_f32_16x16x32_bf16 v[232:235], a[104:107], v[96:99], v[232:235]
ds_read_b128 a[72:75], v1 offset:2048
v_mfma_f32_16x16x32_bf16 v[232:235], a[108:111], v[100:103], v[232:235]
v_exp_f32 v13, v77
v_mfma_f32_16x16x32_bf16 v[236:239], a[108:111], v[108:111], v[236:239]
ds_read_b128 a[76:79], v1 offset:3072
v_add_f32 v27, v27, v13
v_mfma_f32_16x16x32_bf16 v[236:239], a[104:107], v[104:107], v[236:239]
v_exp_f32 v14, v78
v_mfma_f32_16x16x32_bf16 v[240:243], a[112:115], v[96:99], v[240:243]
ds_read_b128 a[80:83], v1 offset:4096
v_cvt_pk_bf16_f32 v122, v12, v13
v_mfma_f32_16x16x32_bf16 v[240:243], a[116:119], v[100:103], v[240:243]
v_exp_f32 v15, v79
v_mfma_f32_16x16x32_bf16 v[244:247], a[116:119], v[108:111], v[244:247]
ds_read_b128 a[84:87], v1 offset:5120
v_add_f32 v27, v27, v14
v_mfma_f32_16x16x32_bf16 v[244:247], a[112:115], v[104:107], v[244:247]
s_waitcnt lgkmcnt(4)
v_add_f32 v27, v27, v15
v_cvt_pk_bf16_f32 v123, v14, v15
v_mfma_f32_16x16x32_bf16 v[248:251], a[120:123], v[96:99], v[248:251]
ds_read_b128 a[88:91], v1 offset:6144
v_mfma_f32_16x16x32_bf16 v[248:251], a[124:127], v[100:103], v[248:251]
v_mfma_f32_16x16x32_bf16 v[252:255], a[124:127], v[108:111], v[252:255]
ds_read_b128 a[92:95], v1 offset:7168
v_mfma_f32_16x16x32_bf16 v[252:255], a[120:123], v[104:107], v[252:255]
v_cndmask_b32 v32, v16, v7, s[32:33]
v_cndmask_b32 v33, v16, v7, s[34:35]
v_cndmask_b32 v34, v16, v7, s[36:37]
v_cndmask_b32 v35, v16, v7, s[38:39]
s_nop 1
v_mfma_f32_16x16x32_bf16 v[32:35], a[64:67], a[0:3], v[32:35]
s_add_u32 m0, s18, 131072
ds_read_b128 a[96:99], v1 offset:8192
v_cndmask_b32 v40, v16, v7, s[40:41]
v_mfma_f32_16x16x32_bf16 v[32:35], a[68:71], a[4:7], v[32:35]
s_waitcnt lgkmcnt(4)
buffer_load_dwordx4 v1, s[4:7], s8 offen offset:0 sc1 lds
v_mfma_f32_16x16x32_bf16 v[32:35], a[72:75], a[8:11], v[32:35]
ds_read_b128 a[100:103], v1 offset:9216
v_cndmask_b32 v41, v16, v7, s[42:43]
v_mfma_f32_16x16x32_bf16 v[32:35], a[76:79], a[12:15], v[32:35]
v_cndmask_b32 v42, v16, v7, s[44:45]
v_cndmask_b32 v43, v16, v7, s[46:47]
v_mfma_f32_16x16x32_bf16 v[32:35], a[80:83], a[16:19], v[32:35]
s_waitcnt lgkmcnt(4)
ds_read_b128 a[104:107], v1 offset:10240
v_mfma_f32_16x16x32_bf16 v[32:35], a[84:87], a[20:23], v[32:35]
s_waitcnt lgkmcnt(4)
buffer_load_dwordx4 v1, s[4:7], s8 offen offset:1024 sc1 lds
v_mfma_f32_16x16x32_bf16 v[32:35], a[88:91], a[24:27], v[32:35]
s_waitcnt lgkmcnt(3)
ds_read_b128 a[108:111], v1 offset:11264
v_mfma_f32_16x16x32_bf16 v[32:35], a[92:95], a[28:31], v[32:35]
v_exp_f32 v8, v80
v_mfma_f32_16x16x32_bf16 v[36:39], a[64:67], a[32:35], v[20:23]
ds_read_b128 a[112:115], v1 offset:12288
v_add_f32 v26, v26, v8
v_mfma_f32_16x16x32_bf16 v[36:39], a[68:71], a[36:39], v[36:39]
buffer_load_dwordx4 v1, s[4:7], s8 offen offset:2048 sc1 lds
v_mfma_f32_16x16x32_bf16 v[36:39], a[72:75], a[40:43], v[36:39]
ds_read_b128 a[116:119], v1 offset:13312
v_mfma_f32_16x16x32_bf16 v[36:39], a[76:79], a[44:47], v[36:39]
v_exp_f32 v9, v81
v_mfma_f32_16x16x32_bf16 v[36:39], a[80:83], a[48:51], v[36:39]
ds_read_b128 a[120:123], v1 offset:14336
v_add_f32 v26, v26, v9
v_mfma_f32_16x16x32_bf16 v[36:39], a[84:87], a[52:55], v[36:39]
buffer_load_dwordx4 v1, s[4:7], s8 offen offset:3072 sc1 lds
v_mfma_f32_16x16x32_bf16 v[36:39], a[88:91], a[56:59], v[36:39]
s_add_u32 s8, s8, 4096
ds_read_b128 a[124:127], v1 offset:15360
v_cvt_pk_bf16_f32 v116, v8, v9
v_mfma_f32_16x16x32_bf16 v[36:39], a[92:95], a[60:63], v[36:39]
s_waitcnt lgkmcnt(4)
v_exp_f32 v10, v82
v_mfma_f32_16x16x32_bf16 v[40:43], a[96:99], a[0:3], v[40:43]
s_add_u32 m0, s18, 135168
ds_read_b128 a[64:67], v1 offset:16384
v_cndmask_b32 v48, v16, v7, s[48:49]
v_mfma_f32_16x16x32_bf16 v[40:43], a[100:103], a[4:7], v[40:43]
buffer_load_dwordx4 v1, s[4:7], s8 offen offset:0 sc1 lds
v_mfma_f32_16x16x32_bf16 v[40:43], a[104:107], a[8:11], v[40:43]
ds_read_b128 a[68:71], v1 offset:17408
v_cndmask_b32 v49, v16, v7, s[50:51]
v_mfma_f32_16x16x32_bf16 v[40:43], a[108:111], a[12:15], v[40:43]
s_waitcnt lgkmcnt(4)
v_cndmask_b32 v50, v16, v7, s[52:53]
v_cndmask_b32 v51, v16, v7, s[54:55]
v_mfma_f32_16x16x32_bf16 v[40:43], a[112:115], a[16:19], v[40:43]
ds_read_b128 a[72:75], v1 offset:18432
v_add_f32 v26, v26, v10
v_mfma_f32_16x16x32_bf16 v[40:43], a[116:119], a[20:23], v[40:43]
s_waitcnt lgkmcnt(4)
buffer_load_dwordx4 v1, s[4:7], s8 offen offset:1024 sc1 lds
v_mfma_f32_16x16x32_bf16 v[40:43], a[120:123], a[24:27], v[40:43]
s_waitcnt lgkmcnt(3)
ds_read_b128 a[76:79], v1 offset:19456
v_mfma_f32_16x16x32_bf16 v[40:43], a[124:127], a[28:31], v[40:43]
v_exp_f32 v11, v83
v_mfma_f32_16x16x32_bf16 v[44:47], a[96:99], a[32:35], v[20:23]
ds_read_b128 a[80:83], v1 offset:20480
v_add_f32 v26, v26, v11
v_mfma_f32_16x16x32_bf16 v[44:47], a[100:103], a[36:39], v[44:47]
buffer_load_dwordx4 v1, s[4:7], s8 offen offset:2048 sc1 lds
v_mfma_f32_16x16x32_bf16 v[44:47], a[104:107], a[40:43], v[44:47]
ds_read_b128 a[84:87], v1 offset:21504
v_cvt_pk_bf16_f32 v117, v10, v11
v_mfma_f32_16x16x32_bf16 v[44:47], a[108:111], a[44:47], v[44:47]
v_exp_f32 v12, v84
v_mfma_f32_16x16x32_bf16 v[44:47], a[112:115], a[48:51], v[44:47]
ds_read_b128 a[88:91], v1 offset:22528
v_add_f32 v27, v27, v12
v_mfma_f32_16x16x32_bf16 v[44:47], a[116:119], a[52:55], v[44:47]
buffer_load_dwordx4 v1, s[4:7], s8 offen offset:3072 sc1 lds
v_mfma_f32_16x16x32_bf16 v[44:47], a[120:123], a[56:59], v[44:47]
s_waitcnt lgkmcnt(2)
s_add_u32 s8, s8, 28672
ds_read_b128 a[92:95], v1 offset:23552
v_mfma_f32_16x16x32_bf16 v[44:47], a[124:127], a[60:63], v[44:47]
s_sub_u32 s9, s9, 1
v_exp_f32 v13, v85
v_mfma_f32_16x16x32_bf16 v[48:51], a[64:67], a[0:3], v[48:51]
s_cmp_eq_u32 s9, 0
ds_read_b128 a[96:99], v1 offset:24576
v_cndmask_b32 v56, v16, v7, s[56:57]
v_mfma_f32_16x16x32_bf16 v[48:51], a[68:71], a[4:7], v[48:51]
s_cselect_b32 s8, s10, s8
v_cndmask_b32 v57, v16, v7, s[58:59]
v_cndmask_b32 v58, v16, v7, s[60:61]
v_mfma_f32_16x16x32_bf16 v[48:51], a[72:75], a[8:11], v[48:51]
s_cselect_b32 s9, s11, s9
ds_read_b128 a[100:103], v1 offset:25600
v_cndmask_b32 v59, v16, v7, s[62:63]
v_mfma_f32_16x16x32_bf16 v[48:51], a[76:79], a[12:15], v[48:51]
s_cselect_b32 s10, 3221225472, s10
v_exp_f32 v14, v86
v_mfma_f32_16x16x32_bf16 v[48:51], a[80:83], a[16:19], v[48:51]
s_waitcnt lgkmcnt(4)
ds_read_b128 a[104:107], v1 offset:26624
v_add_f32 v27, v27, v13
v_cvt_pk_bf16_f32 v124, v12, v13
v_mfma_f32_16x16x32_bf16 v[48:51], a[84:87], a[20:23], v[48:51]
s_waitcnt lgkmcnt(4)
v_exp_f32 v15, v87
v_mfma_f32_16x16x32_bf16 v[48:51], a[88:91], a[24:27], v[48:51]
s_waitcnt lgkmcnt(3)
ds_read_b128 a[108:111], v1 offset:27648
v_add_f32 v27, v27, v14
v_mfma_f32_16x16x32_bf16 v[48:51], a[92:95], a[28:31], v[48:51]
v_exp_f32 v8, v88
v_mfma_f32_16x16x32_bf16 v[52:55], a[64:67], a[32:35], v[20:23]
ds_read_b128 a[112:115], v1 offset:28672
v_add_f32 v27, v27, v15
v_mfma_f32_16x16x32_bf16 v[52:55], a[68:71], a[36:39], v[52:55]
v_exp_f32 v9, v89
v_mfma_f32_16x16x32_bf16 v[52:55], a[72:75], a[40:43], v[52:55]
ds_read_b128 a[116:119], v1 offset:29696
v_cvt_pk_bf16_f32 v125, v14, v15
v_mfma_f32_16x16x32_bf16 v[52:55], a[76:79], a[44:47], v[52:55]
v_exp_f32 v10, v90
v_mfma_f32_16x16x32_bf16 v[52:55], a[80:83], a[48:51], v[52:55]
ds_read_b128 a[120:123], v1 offset:30720
v_add_f32 v26, v26, v8
v_mfma_f32_16x16x32_bf16 v[52:55], a[84:87], a[52:55], v[52:55]
v_exp_f32 v11, v91
v_mfma_f32_16x16x32_bf16 v[52:55], a[88:91], a[56:59], v[52:55]
s_waitcnt vmcnt(8) lgkmcnt(4)
ds_read_b128 a[124:127], v1 offset:31744
v_add_f32 v26, v26, v9
v_cvt_pk_bf16_f32 v118, v8, v9
v_mfma_f32_16x16x32_bf16 v[52:55], a[92:95], a[60:63], v[52:55]
s_barrier
v_mfma_f32_16x16x32_bf16 v[56:59], a[96:99], a[0:3], v[56:59]
ds_read_b128 a[64:67], v2 offset:32768
v_add_f32 v26, v26, v10
v_mfma_f32_16x16x32_bf16 v[56:59], a[100:103], a[4:7], v[56:59]
v_exp_f32 v12, v92
v_mfma_f32_16x16x32_bf16 v[56:59], a[104:107], a[8:11], v[56:59]
s_waitcnt lgkmcnt(4)
ds_read_b128 a[68:71], v2 offset:33792
v_add_f32 v26, v26, v11
v_cvt_pk_bf16_f32 v119, v10, v11
v_mfma_f32_16x16x32_bf16 v[56:59], a[108:111], a[12:15], v[56:59]
v_exp_f32 v13, v93
v_mfma_f32_16x16x32_bf16 v[56:59], a[112:115], a[16:19], v[56:59]
s_waitcnt lgkmcnt(4)
ds_read_b128 a[72:75], v2 offset:34816
v_add_f32 v27, v27, v12
v_mfma_f32_16x16x32_bf16 v[56:59], a[116:119], a[20:23], v[56:59]
s_waitcnt lgkmcnt(4)
v_exp_f32 v14, v94
v_mfma_f32_16x16x32_bf16 v[56:59], a[120:123], a[24:27], v[56:59]
s_waitcnt lgkmcnt(3)
ds_read_b128 a[76:79], v2 offset:35840
v_add_f32 v27, v27, v13
v_mfma_f32_16x16x32_bf16 v[56:59], a[124:127], a[28:31], v[56:59]
v_exp_f32 v15, v95
v_mfma_f32_16x16x32_bf16 v[60:63], a[96:99], a[32:35], v[20:23]
ds_read_b128 a[80:83], v2 offset:36864
v_cvt_pk_bf16_f32 v126, v12, v13
v_mfma_f32_16x16x32_bf16 v[60:63], a[100:103], a[36:39], v[60:63]
v_add_f32 v27, v27, v14
v_add_f32 v27, v27, v15
v_mfma_f32_16x16x32_bf16 v[60:63], a[104:107], a[40:43], v[60:63]
ds_read_b128 a[84:87], v2 offset:37888
v_cvt_pk_bf16_f32 v127, v14, v15
v_mfma_f32_16x16x32_bf16 v[60:63], a[108:111], a[44:47], v[60:63]
v_add_f32 v28, v26, v27
v_cmp_nge_f32 vcc, s25, v28
v_mfma_f32_16x16x32_bf16 v[60:63], a[112:115], a[48:51], v[60:63]
ds_read_b128 a[88:91], v2 offset:38912
v_mfma_f32_16x16x32_bf16 v[60:63], a[116:119], a[52:55], v[60:63]
v_mfma_f32_16x16x32_bf16 v[60:63], a[120:123], a[56:59], v[60:63]
ds_read_b128 a[92:95], v2 offset:39936
v_mfma_f32_16x16x32_bf16 v[60:63], a[124:127], a[60:63], v[60:63]
s_waitcnt lgkmcnt(4)
s_cbranch_vccnz Lstub_6
Lback_7:
v_mfma_f32_16x16x32_bf16 v[128:131], a[64:67], v[112:115], v[128:131]
s_add_u32 m0, s18, 65536
ds_read_b128 a[96:99], v2 offset:40960
v_add_f32 v24, v24, v26
v_mfma_f32_16x16x32_bf16 v[128:131], a[68:71], v[116:119], v[128:131]
buffer_load_dwordx4 v1, s[4:7], s12 offen offset:0 sc1 lds
v_mfma_f32_16x16x32_bf16 v[132:135], a[68:71], v[124:127], v[132:135]
ds_read_b128 a[100:103], v2 offset:41984
v_add_f32 v25, v25, v27
v_mfma_f32_16x16x32_bf16 v[132:135], a[64:67], v[120:123], v[132:135]
v_exp_f32 v8, v32
v_mfma_f32_16x16x32_bf16 v[136:139], a[72:75], v[112:115], v[136:139]
ds_read_b128 a[104:107], v2 offset:43008
v_mfma_f32_16x16x32_bf16 v[136:139], a[76:79], v[116:119], v[136:139]
buffer_load_dwordx4 v1, s[4:7], s12 offen offset:1024 sc1 lds
v_mfma_f32_16x16x32_bf16 v[140:143], a[76:79], v[124:127], v[140:143]
ds_read_b128 a[108:111], v2 offset:44032
v_mfma_f32_16x16x32_bf16 v[140:143], a[72:75], v[120:123], v[140:143]
s_waitcnt lgkmcnt(4)
v_exp_f32 v9, v33
v_mfma_f32_16x16x32_bf16 v[144:147], a[80:83], v[112:115], v[144:147]
ds_read_b128 a[112:115], v2 offset:45056
v_add_f32 v26, v8, v9
v_mfma_f32_16x16x32_bf16 v[144:147], a[84:87], v[116:119], v[144:147]
buffer_load_dwordx4 v1, s[4:7], s12 offen offset:2048 sc1 lds
v_mfma_f32_16x16x32_bf16 v[148:151], a[84:87], v[124:127], v[148:151]
ds_read_b128 a[116:119], v2 offset:46080
v_cvt_pk_bf16_f32 v96, v8, v9
v_mfma_f32_16x16x32_bf16 v[148:151], a[80:83], v[120:123], v[148:151]
v_exp_f32 v10, v34
v_mfma_f32_16x16x32_bf16 v[152:155], a[88:91], v[112:115], v[152:155]
ds_read_b128 a[120:123], v2 offset:47104
v_add_f32 v26, v26, v10
v_mfma_f32_16x16x32_bf16 v[152:155], a[92:95], v[116:119], v[152:155]
buffer_load_dwordx4 v1, s[4:7], s12 offen offset:3072 sc1 lds
v_mfma_f32_16x16x32_bf16 v[156:159], a[92:95], v[124:127], v[156:159]
s_add_u32 s12, s12, 4096
ds_read_b128 a[124:127], v2 offset:48128
v_mfma_f32_16x16x32_bf16 v[156:159], a[88:91], v[120:123], v[156:159]
s_waitcnt lgkmcnt(4)
v_exp_f32 v11, v35
v_mfma_f32_16x16x32_bf16 v[160:163], a[96:99], v[112:115], v[160:163]
s_add_u32 m0, s18, 69632
ds_read_b128 a[64:67], v2 offset:49152
v_add_f32 v26, v26, v11
v_mfma_f32_16x16x32_bf16 v[160:163], a[100:103], v[116:119], v[160:163]
buffer_load_dwordx4 v1, s[4:7], s12 offen offset:0 sc1 lds
v_mfma_f32_16x16x32_bf16 v[164:167], a[100:103], v[124:127], v[164:167]
ds_read_b128 a[68:71], v2 offset:50176
v_cvt_pk_bf16_f32 v97, v10, v11
v_mfma_f32_16x16x32_bf16 v[164:167], a[96:99], v[120:123], v[164:167]
v_mfma_f32_16x16x32_bf16 v[168:171], a[104:107], v[112:115], v[168:171]
ds_read_b128 a[72:75], v2 offset:51200
v_mfma_f32_16x16x32_bf16 v[168:171], a[108:111], v[116:119], v[168:171]
buffer_load_dwordx4 v1, s[4:7], s12 offen offset:1024 sc1 lds
v_mfma_f32_16x16x32_bf16 v[172:175], a[108:111], v[124:127], v[172:175]
ds_read_b128 a[76:79], v2 offset:52224
v_mfma_f32_16x16x32_bf16 v[172:175], a[104:107], v[120:123], v[172:175]
s_waitcnt lgkmcnt(4)
v_exp_f32 v12, v36
v_mfma_f32_16x16x32_bf16 v[176:179], a[112:115], v[112:115], v[176:179]
ds_read_b128 a[80:83], v2 offset:53248
v_mfma_f32_16x16x32_bf16 v[176:179], a[116:119], v[116:119], v[176:179]
buffer_load_dwordx4 v1, s[4:7], s12 offen offset:2048 sc1 lds
v_mfma_f32_16x16x32_bf16 v[180:183], a[116:119], v[124:127], v[180:183]
ds_read_b128 a[84:87], v2 offset:54272
v_mfma_f32_16x16x32_bf16 v[180:183], a[112:115], v[120:123], v[180:183]
v_exp_f32 v13, v37
v_mfma_f32_16x16x32_bf16 v[184:187], a[120:123], v[112:115], v[184:187]
ds_read_b128 a[88:91], v2 offset:55296
v_add_f32 v27, v12, v13
v_mfma_f32_16x16x32_bf16 v[184:187], a[124:127], v[116:119], v[184:187]
s_waitcnt lgkmcnt(4)
buffer_load_dwordx4 v1, s[4:7], s12 offen offset:3072 sc1 lds
v_mfma_f32_16x16x32_bf16 v[188:191], a[124:127], v[124:127], v[188:191]
s_add_u32 s12, s12, 28672
ds_read_b128 a[92:95], v2 offset:56320
v_cvt_pk_bf16_f32 v104, v12, v13
v_mfma_f32_16x16x32_bf16 v[188:191], a[120:123], v[120:123], v[188:191]
s_sub_u32 s13, s13, 1
v_exp_f32 v14, v38
v_mfma_f32_16x16x32_bf16 v[192:195], a[64:67], v[112:115], v[192:195]
s_cmp_eq_u32 s13, 0
ds_read_b128 a[96:99], v2 offset:57344
v_add_f32 v27, v27, v14
v_mfma_f32_16x16x32_bf16 v[192:195], a[68:71], v[116:119], v[192:195]
s_cselect_b32 s12, s14, s12
v_exp_f32 v15, v39
v_mfma_f32_16x16x32_bf16 v[196:199], a[68:71], v[124:127], v[196:199]
s_cselect_b32 s13, s15, s13
ds_read_b128 a[100:103], v2 offset:58368
v_add_f32 v27, v27, v15
v_mfma_f32_16x16x32_bf16 v[196:199], a[64:67], v[120:123], v[196:199]
s_cselect_b32 s14, 3221225472, s14
v_cvt_pk_bf16_f32 v105, v14, v15
v_mfma_f32_16x16x32_bf16 v[200:203], a[72:75], v[112:115], v[200:203]
s_waitcnt lgkmcnt(4)
ds_read_b128 a[104:107], v2 offset:59392
v_mfma_f32_16x16x32_bf16 v[200:203], a[76:79], v[116:119], v[200:203]
buffer_load_dword v3, off, s[4:7], s80 sc1
v_mfma_f32_16x16x32_bf16 v[204:207], a[76:79], v[124:127], v[204:207]
ds_read_b128 a[108:111], v2 offset:60416
v_mfma_f32_16x16x32_bf16 v[204:207], a[72:75], v[120:123], v[204:207]
v_exp_f32 v8, v40
v_mfma_f32_16x16x32_bf16 v[208:211], a[80:83], v[112:115], v[208:211]
ds_read_b128 a[112:115], v2 offset:61440
v_add_f32 v26, v26, v8
v_mfma_f32_16x16x32_bf16 v[208:211], a[84:87], v[116:119], v[208:211]
v_exp_f32 v9, v41
v_mfma_f32_16x16x32_bf16 v[212:215], a[84:87], v[124:127], v[212:215]
ds_read_b128 a[116:119], v2 offset:62464
v_add_f32 v26, v26, v9
v_mfma_f32_16x16x32_bf16 v[212:215], a[80:83], v[120:123], v[212:215]
s_waitcnt lgkmcnt(4)
v_exp_f32 v10, v42
v_mfma_f32_16x16x32_bf16 v[216:219], a[88:91], v[112:115], v[216:219]
ds_read_b128 a[120:123], v2 offset:63488
v_cvt_pk_bf16_f32 v98, v8, v9
v_mfma_f32_16x16x32_bf16 v[216:219], a[92:95], v[116:119], v[216:219]
v_exp_f32 v11, v43
v_mfma_f32_16x16x32_bf16 v[220:223], a[92:95], v[124:127], v[220:223]
s_waitcnt vmcnt(9)
ds_read_b128 a[124:127], v2 offset:64512
v_add_f32 v26, v26, v10
v_mfma_f32_16x16x32_bf16 v[220:223], a[88:91], v[120:123], v[220:223]
s_barrier
v_mfma_f32_16x16x32_bf16 v[224:227], a[96:99], v[112:115], v[224:227]
ds_read_b128 a[64:67], v4 offset:0
v_add_f32 v26, v26, v11
v_mfma_f32_16x16x32_bf16 v[224:227], a[100:103], v[116:119], v[224:227]
v_cvt_pk_bf16_f32 v99, v10, v11
v_mfma_f32_16x16x32_bf16 v[228:231], a[100:103], v[124:127], v[228:231]
ds_read_b128 a[68:71], v4 offset:1024
v_mfma_f32_16x16x32_bf16 v[228:231], a[96:99], v[120:123], v[228:231]
s_waitcnt lgkmcnt(4)
v_exp_f32 v12, v44
v_mfma_f32_16x16x32_bf16 v[232:235], a[104:107], v[112:115], v[232:235]
ds_read_b128 a[72:75], v4 offset:2048
v_add_f32 v27, v27, v12
v_mfma_f32_16x16x32_bf16 v[232:235], a[108:111], v[116:119], v[232:235]
v_exp_f32 v13, v45
v_mfma_f32_16x16x32_bf16 v[236:239], a[108:111], v[124:127], v[236:239]
ds_read_b128 a[76:79], v4 offset:3072
v_add_f32 v27, v27, v13
v_mfma_f32_16x16x32_bf16 v[236:239], a[104:107], v[120:123], v[236:239]
v_exp_f32 v14, v46
v_mfma_f32_16x16x32_bf16 v[240:243], a[112:115], v[112:115], v[240:243]
ds_read_b128 a[80:83], v4 offset:4096
v_cvt_pk_bf16_f32 v106, v12, v13
v_mfma_f32_16x16x32_bf16 v[240:243], a[116:119], v[116:119], v[240:243]
v_exp_f32 v15, v47
v_mfma_f32_16x16x32_bf16 v[244:247], a[116:119], v[124:127], v[244:247]
ds_read_b128 a[84:87], v4 offset:5120
v_add_f32 v27, v27, v14
v_mfma_f32_16x16x32_bf16 v[244:247], a[112:115], v[120:123], v[244:247]
s_waitcnt lgkmcnt(4)
v_add_f32 v27, v27, v15
v_cvt_pk_bf16_f32 v107, v14, v15
v_mfma_f32_16x16x32_bf16 v[248:251], a[120:123], v[112:115], v[248:251]
ds_read_b128 a[88:91], v4 offset:6144
v_mfma_f32_16x16x32_bf16 v[248:251], a[124:127], v[116:119], v[248:251]
v_mfma_f32_16x16x32_bf16 v[252:255], a[124:127], v[124:127], v[252:255]
ds_read_b128 a[92:95], v4 offset:7168
v_mfma_f32_16x16x32_bf16 v[252:255], a[120:123], v[120:123], v[252:255]
K2_dx1:
v_cndmask_b32 v68, v20, v7, s[32:33]
v_cndmask_b32 v69, v20, v7, s[34:35]
v_cndmask_b32 v70, v20, v7, s[36:37]
v_cndmask_b32 v71, v20, v7, s[38:39]
s_nop 1
v_mfma_f32_16x16x32_bf16 v[68:71], a[64:67], a[32:35], v[68:71]
s_add_u32 m0, s18, 0
ds_read_b128 a[96:99], v4 offset:8192
v_cndmask_b32 v76, v20, v7, s[40:41]
v_cndmask_b32 v79, v20, v7, s[46:47]
v_mfma_f32_16x16x32_bf16 v[68:71], a[68:71], a[36:39], v[68:71]
s_waitcnt lgkmcnt(4)
ds_read_b128 a[100:103], v4 offset:9216
buffer_load_dwordx4 v1, s[4:7], s12 offen offset:0 sc1 lds
v_mfma_f32_16x16x32_bf16 v[68:71], a[72:75], a[40:43], v[68:71]
ds_read_b128 a[104:107], v4 offset:10240
v_cndmask_b32 v77, v20, v7, s[42:43]
v_mfma_f32_16x16x32_bf16 v[68:71], a[76:79], a[44:47], v[68:71]
ds_read_b128 a[108:111], v4 offset:11264
buffer_load_dwordx4 v1, s[4:7], s12 offen offset:1024 sc1 lds
v_mfma_f32_16x16x32_bf16 v[68:71], a[80:83], a[48:51], v[68:71]
s_waitcnt lgkmcnt(6)
ds_read_b128 a[112:115], v4 offset:12288
v_cndmask_b32 v78, v20, v7, s[44:45]
v_mfma_f32_16x16x32_bf16 v[68:71], a[84:87], a[52:55], v[68:71]
s_waitcnt lgkmcnt(6)
ds_read_b128 a[116:119], v4 offset:13312
buffer_load_dwordx4 v1, s[4:7], s12 offen offset:2048 sc1 lds
v_mfma_f32_16x16x32_bf16 v[68:71], a[88:91], a[56:59], v[68:71]
s_waitcnt lgkmcnt(6)
ds_read_b128 a[120:123], v4 offset:14336
v_exp_f32 v8, v48
v_exp_f32 v9, v49
v_exp_f32 v10, v50
v_mfma_f32_16x16x32_bf16 v[68:71], a[92:95], a[60:63], v[68:71]
s_waitcnt lgkmcnt(5)
ds_read_b128 a[124:127], v4 offset:15360
buffer_load_dwordx4 v1, s[4:7], s12 offen offset:3072 sc1 lds
v_add_f32 v26, v26, v8
v_add_f32 v26, v26, v9
v_cvt_pk_bf16_f32 v100, v8, v9
v_add_f32 v26, v26, v10
v_mfma_f32_16x16x32_bf16 v[76:79], a[96:99], a[32:35], v[76:79]
s_add_u32 s12, s12, 4096
s_add_u32 m0, s18, 4096
ds_read_b128 a[64:67], v4 offset:16384
v_cndmask_b32 v86, v20, v7, s[52:53]
v_cndmask_b32 v87, v20, v7, s[54:55]
v_mfma_f32_16x16x32_bf16 v[76:79], a[100:103], a[36:39], v[76:79]
s_waitcnt lgkmcnt(6)
ds_read_b128 a[68:71], v4 offset:17408
buffer_load_dwordx4 v1, s[4:7], s12 offen offset:0 sc1 lds
v_mfma_f32_16x16x32_bf16 v[76:79], a[104:107], a[40:43], v[76:79]
s_waitcnt lgkmcnt(6)
ds_read_b128 a[72:75], v4 offset:18432
v_cndmask_b32 v84, v20, v7, s[48:49]
v_mfma_f32_16x16x32_bf16 v[76:79], a[108:111], a[44:47], v[76:79]
s_waitcnt lgkmcnt(6)
ds_read_b128 a[76:79], v4 offset:19456
buffer_load_dwordx4 v1, s[4:7], s12 offen offset:1024 sc1 lds
v_mfma_f32_16x16x32_bf16 v[76:79], a[112:115], a[48:51], v[76:79]
s_waitcnt lgkmcnt(6)
ds_read_b128 a[80:83], v4 offset:20480
v_cndmask_b32 v85, v20, v7, s[50:51]
v_mfma_f32_16x16x32_bf16 v[76:79], a[116:119], a[52:55], v[76:79]
s_waitcnt lgkmcnt(6)
ds_read_b128 a[84:87], v4 offset:21504
buffer_load_dwordx4 v1, s[4:7], s12 offen offset:2048 sc1 lds
v_mfma_f32_16x16x32_bf16 v[76:79], a[120:123], a[56:59], v[76:79]
s_waitcnt lgkmcnt(6)
ds_read_b128 a[88:91], v4 offset:22528
v_exp_f32 v11, v51
v_exp_f32 v12, v52
v_mfma_f32_16x16x32_bf16 v[76:79], a[124:127], a[60:63], v[76:79]
s_waitcnt lgkmcnt(1)
ds_read_b128 a[92:95], v4 offset:23552
buffer_load_dwordx4 v1, s[4:7], s12 offen offset:3072 sc1 lds
v_add_f32 v26, v26, v11
v_cvt_pk_bf16_f32 v101, v10, v11
v_add_f32 v27, v27, v12
v_mfma_f32_16x16x32_bf16 v[84:87], a[64:67], a[32:35], v[84:87]
s_add_u32 s12, s12, 28672
ds_read_b128 a[96:99], v4 offset:24576
v_cndmask_b32 v92, v20, v7, s[56:57]
v_mfma_f32_16x16x32_bf16 v[84:87], a[68:71], a[36:39], v[84:87]
s_sub_u32 s13, s13, 1
ds_read_b128 a[100:103], v4 offset:25600
v_cndmask_b32 v93, v20, v7, s[58:59]
v_mfma_f32_16x16x32_bf16 v[84:87], a[72:75], a[40:43], v[84:87]
s_cmp_eq_u32 s13, 0
ds_read_b128 a[104:107], v4 offset:26624
v_cndmask_b32 v94, v20, v7, s[60:61]
v_mfma_f32_16x16x32_bf16 v[84:87], a[76:79], a[44:47], v[84:87]
s_cselect_b32 s12, s14, s12
ds_read_b128 a[108:111], v4 offset:27648
v_cndmask_b32 v95, v20, v7, s[62:63]
v_mfma_f32_16x16x32_bf16 v[84:87], a[80:83], a[48:51], v[84:87]
s_cselect_b32 s13, s15, s13
ds_read_b128 a[112:115], v4 offset:28672
v_exp_f32 v13, v53
v_exp_f32 v14, v54
v_mfma_f32_16x16x32_bf16 v[84:87], a[84:87], a[52:55], v[84:87]
s_waitcnt lgkmcnt(6)
s_cselect_b32 s14, 3221225472, s14
ds_read_b128 a[116:119], v4 offset:29696
v_exp_f32 v15, v55
v_exp_f32 v8, v56
v_exp_f32 v9, v57
v_add_f32 v27, v27, v13
v_cvt_pk_bf16_f32 v108, v12, v13
v_add_f32 v27, v27, v14
v_mfma_f32_16x16x32_bf16 v[84:87], a[88:91], a[56:59], v[84:87]
s_waitcnt lgkmcnt(6)
ds_read_b128 a[120:123], v4 offset:30720
v_exp_f32 v10, v58
v_exp_f32 v11, v59
v_add_f32 v27, v27, v15
v_cvt_pk_bf16_f32 v109, v14, v15
v_mfma_f32_16x16x32_bf16 v[84:87], a[92:95], a[60:63], v[84:87]
s_waitcnt vmcnt(8) lgkmcnt(6)
s_barrier
ds_read_b128 a[124:127], v4 offset:31744
v_mfma_f32_16x16x32_bf16 v[92:95], a[96:99], a[32:35], v[92:95]
s_waitcnt lgkmcnt(6)
ds_read_b128 a[64:67], v2 offset:0
v_exp_f32 v12, v60
v_exp_f32 v13, v61
v_mfma_f32_16x16x32_bf16 v[92:95], a[100:103], a[36:39], v[92:95]
s_waitcnt lgkmcnt(6)
ds_read_b128 a[68:71], v2 offset:1024
v_exp_f32 v14, v62
v_exp_f32 v15, v63
v_mfma_f32_16x16x32_bf16 v[92:95], a[104:107], a[40:43], v[92:95]
s_waitcnt lgkmcnt(6)
ds_read_b128 a[72:75], v2 offset:2048
v_add_f32 v26, v26, v8
v_add_f32 v26, v26, v9
v_cvt_pk_bf16_f32 v102, v8, v9
v_mfma_f32_16x16x32_bf16 v[92:95], a[108:111], a[44:47], v[92:95]
s_waitcnt lgkmcnt(6)
ds_read_b128 a[76:79], v2 offset:3072
v_add_f32 v26, v26, v10
v_add_f32 v26, v26, v11
v_cvt_pk_bf16_f32 v103, v10, v11
v_mfma_f32_16x16x32_bf16 v[92:95], a[112:115], a[48:51], v[92:95]
s_waitcnt lgkmcnt(6)
ds_read_b128 a[80:83], v2 offset:4096
v_add_f32 v27, v27, v12
v_mfma_f32_16x16x32_bf16 v[92:95], a[116:119], a[52:55], v[92:95]
s_waitcnt lgkmcnt(6)
ds_read_b128 a[84:87], v2 offset:5120
v_add_f32 v27, v27, v13
v_cvt_pk_bf16_f32 v110, v12, v13
v_mfma_f32_16x16x32_bf16 v[92:95], a[120:123], a[56:59], v[92:95]
s_waitcnt lgkmcnt(6)
ds_read_b128 a[88:91], v2 offset:6144
v_add_f32 v27, v27, v14
v_add_f32 v27, v27, v15
v_cvt_pk_bf16_f32 v111, v14, v15
v_mfma_f32_16x16x32_bf16 v[92:95], a[124:127], a[60:63], v[92:95]
s_waitcnt lgkmcnt(6)
ds_read_b128 a[92:95], v2 offset:7168
v_add_f32 v28, v26, v27
v_cmp_nge_f32 vcc, s25, v28
s_cbranch_vccnz Lstub_8
Lback_9:
s_cmp_lg_u32 s24, 1
s_cbranch_scc1 K2_plain
v_cmp_gt_u32 vcc, 1, v3
s_cbranch_vccnz K2_tspin
K2_tok:
v_mfma_f32_16x16x32_bf16 v[128:131], a[64:67], v[96:99], v[128:131]
s_waitcnt lgkmcnt(6)
ds_read_b128 a[96:99], v2 offset:8192
v_add_f32 v24, v24, v26
v_mfma_f32_16x16x32_bf16 v[128:131], a[68:71], v[100:103], v[128:131]
buffer_load_dwordx4 v[28:31], v1, s[4:7], s27 offen sc1
v_mfma_f32_16x16x32_bf16 v[132:135], a[68:71], v[108:111], v[132:135]
ds_read_b128 a[100:103], v2 offset:9216
v_add_f32 v25, v25, v27
v_mfma_f32_16x16x32_bf16 v[132:135], a[64:67], v[104:107], v[132:135]
s_waitcnt lgkmcnt(6)
v_exp_f32 v8, v68
v_mfma_f32_16x16x32_bf16 v[136:139], a[72:75], v[96:99], v[136:139]
s_add_u32 s22, s76, 0
ds_read_b128 a[104:107], v2 offset:10240
v_exp_f32 v9, v69
v_mfma_f32_16x16x32_bf16 v[136:139], a[76:79], v[100:103], v[136:139]
buffer_load_dwordx4 v[32:35], v1, s[4:7], s22 offen offset:0 sc1
v_mfma_f32_16x16x32_bf16 v[140:143], a[76:79], v[108:111], v[140:143]
ds_read_b128 a[108:111], v2 offset:11264
v_add_f32 v27, v8, v9
v_mfma_f32_16x16x32_bf16 v[140:143], a[72:75], v[104:107], v[140:143]
s_waitcnt lgkmcnt(5)
v_exp_f32 v10, v70
v_mfma_f32_16x16x32_bf16 v[144:147], a[80:83], v[96:99], v[144:147]
ds_read_b128 a[112:115], v2 offset:12288
v_cvt_pk_bf16_f32 v120, v8, v9
v_mfma_f32_16x16x32_bf16 v[144:147], a[84:87], v[100:103], v[144:147]
buffer_load_dwordx4 v[36:39], v1, s[4:7], s22 offen offset:1024 sc1
v_mfma_f32_16x16x32_bf16 v[148:151], a[84:87], v[108:111], v[148:151]
ds_read_b128 a[116:119], v2 offset:13312
v_add_f32 v27, v27, v10
v_mfma_f32_16x16x32_bf16 v[148:151], a[80:83], v[104:107], v[148:151]
v_exp_f32 v11, v71
v_mfma_f32_16x16x32_bf16 v[152:155], a[88:91], v[96:99], v[152:155]
s_waitcnt lgkmcnt(4)
ds_read_b128 a[120:123], v2 offset:14336
v_add_f32 v27, v27, v11
v_mfma_f32_16x16x32_bf16 v[152:155], a[92:95], v[100:103], v[152:155]
buffer_load_dwordx4 v[40:43], v1, s[4:7], s22 offen offset:2048 sc1
v_mfma_f32_16x16x32_bf16 v[156:159], a[92:95], v[108:111], v[156:159]
ds_read_b128 a[124:127], v2 offset:15360
v_cvt_pk_bf16_f32 v121, v10, v11
v_mfma_f32_16x16x32_bf16 v[156:159], a[88:91], v[104:107], v[156:159]
v_exp_f32 v12, v76
v_mfma_f32_16x16x32_bf16 v[160:163], a[96:99], v[96:99], v[160:163]
ds_read_b128 a[64:67], v2 offset:16384
v_add_f32 v27, v27, v12
v_mfma_f32_16x16x32_bf16 v[160:163], a[100:103], v[100:103], v[160:163]
buffer_load_dwordx4 v[44:47], v1, s[4:7], s22 offen offset:3072 sc1
v_mfma_f32_16x16x32_bf16 v[164:167], a[100:103], v[108:111], v[164:167]
PAD_12:
s_cbranch_execz M_tret
ds_read_b128 a[68:71], v2 offset:17408
v_mfma_f32_16x16x32_bf16 v[164:167], a[96:99], v[104:107], v[164:167]
s_waitcnt lgkmcnt(4)
v_exp_f32 v13, v77
v_mfma_f32_16x16x32_bf16 v[168:171], a[104:107], v[96:99], v[168:171]
s_add_u32 s22, s76, 4096
ds_read_b128 a[72:75], v2 offset:18432
v_add_f32 v27, v27, v13
v_mfma_f32_16x16x32_bf16 v[168:171], a[108:111], v[100:103], v[168:171]
buffer_load_dwordx4 v[48:51], v1, s[4:7], s22 offen offset:0 sc1
v_mfma_f32_16x16x32_bf16 v[172:175], a[108:111], v[108:111], v[172:175]
ds_read_b128 a[76:79], v2 offset:19456
v_exp_f32 v14, v78
v_mfma_f32_16x16x32_bf16 v[172:175], a[104:107], v[104:107], v[172:175]
v_exp_f32 v15, v79
v_mfma_f32_16x16x32_bf16 v[176:179], a[112:115], v[96:99], v[176:179]
ds_read_b128 a[80:83], v2 offset:20480
v_cvt_pk_bf16_f32 v122, v12, v13
v_mfma_f32_16x16x32_bf16 v[176:179], a[116:119], v[100:103], v[176:179]
buffer_load_dwordx4 v[52:55], v1, s[4:7], s22 offen offset:1024 sc1
v_mfma_f32_16x16x32_bf16 v[180:183], a[116:119], v[108:111], v[180:183]
ds_read_b128 a[84:87], v2 offset:21504
v_add_f32 v27, v27, v14
v_mfma_f32_16x16x32_bf16 v[180:183], a[112:115], v[104:107], v[180:183]
s_waitcnt lgkmcnt(4)
v_exp_f32 v8, v84
v_mfma_f32_16x16x32_bf16 v[184:187], a[120:123], v[96:99], v[184:187]
ds_read_b128 a[88:91], v2 offset:22528
v_add_f32 v27, v27, v15
v_cvt_pk_bf16_f32 v123, v14, v15
v_mfma_f32_16x16x32_bf16 v[184:187], a[124:127], v[100:103], v[184:187]
buffer_load_dwordx4 v[56:59], v1, s[4:7], s22 offen offset:2048 sc1
v_mfma_f32_16x16x32_bf16 v[188:191], a[124:127], v[108:111], v[188:191]
ds_read_b128 a[92:95], v2 offset:23552
v_add_f32 v27, v27, v8
v_mfma_f32_16x16x32_bf16 v[188:191], a[120:123], v[104:107], v[188:191]
v_exp_f32 v9, v85
v_mfma_f32_16x16x32_bf16 v[192:195], a[64:67], v[96:99], v[192:195]
ds_read_b128 a[96:99], v2 offset:24576
v_add_f32 v27, v27, v9
v_mfma_f32_16x16x32_bf16 v[192:195], a[68:71], v[100:103], v[192:195]
buffer_load_dwordx4 v[60:63], v1, s[4:7], s22 offen offset:3072 sc1
v_mfma_f32_16x16x32_bf16 v[196:199], a[68:71], v[108:111], v[196:199]
ds_read_b128 a[100:103], v2 offset:25600
v_cvt_pk_bf16_f32 v124, v8, v9
v_mfma_f32_16x16x32_bf16 v[196:199], a[64:67], v[104:107], v[196:199]
s_waitcnt lgkmcnt(4)
v_exp_f32 v10, v86
v_mfma_f32_16x16x32_bf16 v[200:203], a[72:75], v[96:99], v[200:203]
s_add_u32 s22, s76, 8192
ds_read_b128 a[104:107], v2 offset:26624
v_add_f32 v27, v27, v10
v_mfma_f32_16x16x32_bf16 v[200:203], a[76:79], v[100:103], v[200:203]
buffer_load_dwordx4 a[32:35], v1, s[4:7], s22 offen offset:0 sc1
v_mfma_f32_16x16x32_bf16 v[204:207], a[76:79], v[108:111], v[204:207]
ds_read_b128 a[108:111], v2 offset:27648
v_mfma_f32_16x16x32_bf16 v[204:207], a[72:75], v[104:107], v[204:207]
v_exp_f32 v11, v87
v_mfma_f32_16x16x32_bf16 v[208:211], a[80:83], v[96:99], v[208:211]
ds_read_b128 a[112:115], v2 offset:28672
v_exp_f32 v12, v92
v_mfma_f32_16x16x32_bf16 v[208:211], a[84:87], v[100:103], v[208:211]
buffer_load_dwordx4 a[36:39], v1, s[4:7], s22 offen offset:1024 sc1
v_mfma_f32_16x16x32_bf16 v[212:215], a[84:87], v[108:111], v[212:215]
ds_read_b128 a[116:119], v2 offset:29696
v_add_f32 v27, v27, v11
v_mfma_f32_16x16x32_bf16 v[212:215], a[80:83], v[104:107], v[212:215]
s_waitcnt lgkmcnt(4)
v_exp_f32 v13, v93
v_mfma_f32_16x16x32_bf16 v[216:219], a[88:91], v[96:99], v[216:219]
ds_read_b128 a[120:123], v2 offset:30720
v_cvt_pk_bf16_f32 v125, v10, v11
v_add_f32 v27, v27, v12
v_mfma_f32_16x16x32_bf16 v[216:219], a[92:95], v[100:103], v[216:219]
buffer_load_dwordx4 a[40:43], v1, s[4:7], s22 offen offset:2048 sc1
v_mfma_f32_16x16x32_bf16 v[220:223], a[92:95], v[108:111], v[220:223]
s_waitcnt vmcnt(12)
ds_read_b128 a[124:127], v2 offset:31744
v_add_f32 v27, v27, v13
v_mfma_f32_16x16x32_bf16 v[220:223], a[88:91], v[104:107], v[220:223]
s_barrier
v_mfma_f32_16x16x32_bf16 v[224:227], a[96:99], v[96:99], v[224:227]
ds_read_b128 a[64:67], v1 offset:0
v_cvt_pk_bf16_f32 v126, v12, v13
v_mfma_f32_16x16x32_bf16 v[224:227], a[100:103], v[100:103], v[224:227]
buffer_load_dwordx4 a[44:47], v1, s[4:7], s22 offen offset:3072 sc1
v_mfma_f32_16x16x32_bf16 v[228:231], a[100:103], v[108:111], v[228:231]
ds_read_b128 a[68:71], v1 offset:1024
v_mfma_f32_16x16x32_bf16 v[228:231], a[96:99], v[104:107], v[228:231]
s_waitcnt lgkmcnt(4)
v_exp_f32 v14, v94
v_mfma_f32_16x16x32_bf16 v[232:235], a[104:107], v[96:99], v[232:235]
s_add_u32 s22, s76, 12288
ds_read_b128 a[72:75], v1 offset:2048
v_add_f32 v27, v27, v14
v_mfma_f32_16x16x32_bf16 v[232:235], a[108:111], v[100:103], v[232:235]
buffer_load_dwordx4 a[48:51], v1, s[4:7], s22 offen offset:0 sc1
v_mfma_f32_16x16x32_bf16 v[236:239], a[108:111], v[108:111], v[236:239]
ds_read_b128 a[76:79], v1 offset:3072
v_mfma_f32_16x16x32_bf16 v[236:239], a[104:107], v[104:107], v[236:239]
v_exp_f32 v15, v95
v_mfma_f32_16x16x32_bf16 v[240:243], a[112:115], v[96:99], v[240:243]
ds_read_b128 a[80:83], v1 offset:4096
v_add_f32 v27, v27, v15
v_mfma_f32_16x16x32_bf16 v[240:243], a[116:119], v[100:103], v[240:243]
buffer_load_dwordx4 a[52:55], v1, s[4:7], s22 offen offset:1024 sc1
v_mfma_f32_16x16x32_bf16 v[244:247], a[116:119], v[108:111], v[244:247]
ds_read_b128 a[84:87], v1 offset:5120
v_cvt_pk_bf16_f32 v127, v14, v15
v_mfma_f32_16x16x32_bf16 v[244:247], a[112:115], v[104:107], v[244:247]
s_waitcnt lgkmcnt(4)
v_cmp_nge_f32 vcc, s25, v27
v_mfma_f32_16x16x32_bf16 v[248:251], a[120:123], v[96:99], v[248:251]
ds_read_b128 a[88:91], v1 offset:6144
v_mfma_f32_16x16x32_bf16 v[248:251], a[124:127], v[100:103], v[248:251]
buffer_load_dwordx4 a[56:59], v1, s[4:7], s22 offen offset:2048 sc1
v_mfma_f32_16x16x32_bf16 v[252:255], a[124:127], v[108:111], v[252:255]
ds_read_b128 a[92:95], v1 offset:7168
v_mfma_f32_16x16x32_bf16 v[252:255], a[120:123], v[104:107], v[252:255]
s_waitcnt lgkmcnt(2)
buffer_load_dwordx4 a[60:63], v1, s[4:7], s22 offen offset:3072 sc1
s_cbranch_vccnz Lstub_10
Lback_11:
v_mfma_f32_16x16x32_bf16 v[132:135], a[64:67], v[120:123], v[132:135]
s_mov_b64 s[36:37], s[86:87]
ds_read_b128 a[96:99], v1 offset:8192
v_add_f32 v25, v25, v27
v_mfma_f32_16x16x32_bf16 v[132:135], a[68:71], v[124:127], v[132:135]
s_mov_b32 s38, 3670016
ds_read_b128 a[100:103], v1 offset:9216
v_accvgpr_read_b32 v112, a184
v_mfma_f32_16x16x32_bf16 v[140:143], a[72:75], v[120:123], v[140:143]
s_mov_b32 s39, 0x20000
ds_read_b128 a[104:107], v1 offset:10240
v_accvgpr_read_b32 v113, a185
v_mfma_f32_16x16x32_bf16 v[140:143], a[76:79], v[124:127], v[140:143]
s_lshl_b32 s8, s29, 3
ds_read_b128 a[108:111], v1 offset:11264
v_accvgpr_read_b32 v114, a186
v_mfma_f32_16x16x32_bf16 v[148:151], a[80:83], v[120:123], v[148:151]
s_add_u32 s8, s8, s3
ds_read_b128 a[112:115], v1 offset:12288
v_accvgpr_read_b32 v115, a187
v_mfma_f32_16x16x32_bf16 v[148:151], a[84:87], v[124:127], v[148:151]
s_waitcnt lgkmcnt(3)
s_lshl_b32 s8, s8, 4
ds_read_b128 a[116:119], v1 offset:13312
v_accvgpr_read_b32 v116, a188
v_mfma_f32_16x16x32_bf16 v[156:159], a[88:91], v[120:123], v[156:159]
s_add_u32 s8, s8, s20
ds_read_b128 a[120:123], v1 offset:14336
v_accvgpr_read_b32 v117, a189
v_mfma_f32_16x16x32_bf16 v[156:159], a[92:95], v[124:127], v[156:159]
s_mul_i32 s8, s8, 14336
ds_read_b128 a[124:127], v1 offset:15360
v_accvgpr_read_b32 v118, a190
v_mfma_f32_16x16x32_bf16 v[164:167], a[96:99], v[120:123], v[164:167]
s_add_u32 s8, s8, 104857600
ds_read_b128 a[64:67], v1 offset:16384
v_accvgpr_read_b32 v119, a191
v_mfma_f32_16x16x32_bf16 v[164:167], a[100:103], v[124:127], v[164:167]
s_waitcnt lgkmcnt(6)
s_add_u32 s12, s8, 917504
ds_read_b128 a[68:71], v1 offset:17408
v_mfma_f32_16x16x32_bf16 v[172:175], a[104:107], v[120:123], v[172:175]
s_waitcnt lgkmcnt(6)
ds_read_b128 a[72:75], v1 offset:18432
v_mfma_f32_16x16x32_bf16 v[172:175], a[108:111], v[124:127], v[172:175]
s_waitcnt lgkmcnt(6)
ds_read_b128 a[76:79], v1 offset:19456
v_mfma_f32_16x16x32_bf16 v[180:183], a[112:115], v[120:123], v[180:183]
s_waitcnt lgkmcnt(6)
ds_read_b128 a[80:83], v1 offset:20480
v_mfma_f32_16x16x32_bf16 v[180:183], a[116:119], v[124:127], v[180:183]
s_waitcnt lgkmcnt(6)
ds_read_b128 a[84:87], v1 offset:21504
v_mfma_f32_16x16x32_bf16 v[188:191], a[120:123], v[120:123], v[188:191]
s_waitcnt lgkmcnt(6)
ds_read_b128 a[88:91], v1 offset:22528
v_mfma_f32_16x16x32_bf16 v[188:191], a[124:127], v[124:127], v[188:191]
s_waitcnt lgkmcnt(6)
ds_read_b128 a[92:95], v1 offset:23552
v_mfma_f32_16x16x32_bf16 v[196:199], a[64:67], v[120:123], v[196:199]
s_waitcnt lgkmcnt(6)
ds_read_b128 a[96:99], v1 offset:24576
v_mfma_f32_16x16x32_bf16 v[196:199], a[68:71], v[124:127], v[196:199]
s_waitcnt lgkmcnt(6)
ds_read_b128 a[100:103], v1 offset:25600
v_mfma_f32_16x16x32_bf16 v[204:207], a[72:75], v[120:123], v[204:207]
s_waitcnt lgkmcnt(6)
ds_read_b128 a[104:107], v1 offset:26624
v_mfma_f32_16x16x32_bf16 v[204:207], a[76:79], v[124:127], v[204:207]
s_waitcnt lgkmcnt(6)
ds_read_b128 a[108:111], v1 offset:27648
v_mfma_f32_16x16x32_bf16 v[212:215], a[80:83], v[120:123], v[212:215]
s_waitcnt lgkmcnt(6)
ds_read_b128 a[112:115], v1 offset:28672
v_mfma_f32_16x16x32_bf16 v[212:215], a[84:87], v[124:127], v[212:215]
s_waitcnt lgkmcnt(6)
ds_read_b128 a[116:119], v1 offset:29696
v_mfma_f32_16x16x32_bf16 v[220:223], a[88:91], v[120:123], v[220:223]
s_waitcnt lgkmcnt(6)
s_add_u32 m0, s18, 32768
ds_read_b128 a[120:123], v1 offset:30720
v_mfma_f32_16x16x32_bf16 v[220:223], a[92:95], v[124:127], v[220:223]
s_waitcnt lgkmcnt(6)
ds_read_b128 a[124:127], v1 offset:31744
v_mfma_f32_16x16x32_bf16 v[228:231], a[96:99], v[120:123], v[228:231]
s_waitcnt lgkmcnt(6)
buffer_load_dwordx4 v112, s[36:39], s81 offen offset:0 lds
v_mfma_f32_16x16x32_bf16 v[228:231], a[100:103], v[124:127], v[228:231]
s_waitcnt lgkmcnt(5)
buffer_load_dwordx4 v113, s[36:39], s81 offen offset:1024 lds
v_mfma_f32_16x16x32_bf16 v[236:239], a[104:107], v[120:123], v[236:239]
s_waitcnt lgkmcnt(4)
buffer_load_dwordx4 v114, s[36:39], s81 offen offset:2048 lds
v_mfma_f32_16x16x32_bf16 v[236:239], a[108:111], v[124:127], v[236:239]
s_waitcnt lgkmcnt(3)
buffer_load_dwordx4 v115, s[36:39], s81 offen offset:3072 lds
v_mfma_f32_16x16x32_bf16 v[244:247], a[112:115], v[120:123], v[244:247]
s_waitcnt lgkmcnt(2)
s_add_u32 s81, s81, 28672
v_mfma_f32_16x16x32_bf16 v[244:247], a[116:119], v[124:127], v[244:247]
s_waitcnt lgkmcnt(1)
s_add_u32 m0, s18, 36864
v_mfma_f32_16x16x32_bf16 v[252:255], a[120:123], v[120:123], v[252:255]
s_waitcnt lgkmcnt(0)
buffer_load_dwordx4 v112, s[36:39], s81 offen offset:0 lds
v_mfma_f32_16x16x32_bf16 v[252:255], a[124:127], v[124:127], v[252:255]
buffer_load_dwordx4 v113, s[36:39], s81 offen offset:1024 lds
buffer_load_dwordx4 v114, s[36:39], s81 offen offset:2048 lds
buffer_load_dwordx4 v115, s[36:39], s81 offen offset:3072 lds
s_sub_u32 s81, s81, 28544
s_waitcnt vmcnt(8)
v_sub_f32 v8, v16, v28
v_sub_f32 v10, v20, v30
v_max_f32 v9, v8, v10
v_cmp_lt_f32 vcc, 1114636288, v9
s_cbranch_vccnz K2_cfix
K2_cok:
v_exp_f32 v8, v8
v_exp_f32 v10, v10
s_nop 0
v_mov_b32 v9, v8
v_mov_b32 v11, v10
v_fmac_f32 v24, v8, v29
v_fmac_f32 v25, v10, v31
s_mov_b32 s23, 0xffff0000
v_lshlrev_b32 v64, 16, v32
v_and_b32 v65, s23, v32
v_lshlrev_b32 v66, 16, v33
v_and_b32 v67, s23, v33
v_lshlrev_b32 v68, 16, v34
v_and_b32 v69, s23, v34
v_lshlrev_b32 v70, 16, v35
v_and_b32 v71, s23, v35
v_pk_fma_f32 v[128:129], v[64:65], v[8:9], v[128:129]
v_pk_fma_f32 v[130:131], v[66:67], v[8:9], v[130:131]
v_pk_fma_f32 v[136:137], v[68:69], v[8:9], v[136:137]
v_pk_fma_f32 v[138:139], v[70:71], v[8:9], v[138:139]
v_cvt_pk_bf16_f32 v128, v128, v129
v_cvt_pk_bf16_f32 v129, v130, v131
v_cvt_pk_bf16_f32 v130, v136, v137
v_cvt_pk_bf16_f32 v131, v138, v139
s_add_u32 m0, s18, 98304
s_nop 0
buffer_load_dwordx4 v112, s[36:39], s81 offen offset:0 lds
v_lshlrev_b32 v64, 16, v36
v_and_b32 v65, s23, v36
v_lshlrev_b32 v66, 16, v37
v_and_b32 v67, s23, v37
v_lshlrev_b32 v68, 16, v38
v_and_b32 v69, s23, v38
v_lshlrev_b32 v70, 16, v39
v_and_b32 v71, s23, v39
v_pk_fma_f32 v[144:145], v[64:65], v[8:9], v[144:145]
v_pk_fma_f32 v[146:147], v[66:67], v[8:9], v[146:147]
v_pk_fma_f32 v[152:153], v[68:69], v[8:9], v[152:153]
v_pk_fma_f32 v[154:155], v[70:71], v[8:9], v[154:155]
v_cvt_pk_bf16_f32 v144, v144, v145
v_cvt_pk_bf16_f32 v145, v146, v147
v_cvt_pk_bf16_f32 v146, v152, v153
v_cvt_pk_bf16_f32 v147, v154, v155
buffer_load_dwordx4 v113, s[36:39], s81 offen offset:1024 lds
v_lshlrev_b32 v64, 16, v40
v_and_b32 v65, s23, v40
v_lshlrev_b32 v66, 16, v41
v_and_b32 v67, s23, v41
v_lshlrev_b32 v68, 16, v42
v_and_b32 v69, s23, v42
v_lshlrev_b32 v70, 16, v43
v_and_b32 v71, s23, v43
v_pk_fma_f32 v[160:161], v[64:65], v[8:9], v[160:161]
v_pk_fma_f32 v[162:163], v[66:67], v[8:9], v[162:163]
v_pk_fma_f32 v[168:169], v[68:69], v[8:9], v[168:169]
v_pk_fma_f32 v[170:171], v[70:71], v[8:9], v[170:171]
v_cvt_pk_bf16_f32 v160, v160, v161
v_cvt_pk_bf16_f32 v161, v162, v163
v_cvt_pk_bf16_f32 v162, v168, v169
v_cvt_pk_bf16_f32 v163, v170, v171
buffer_load_dwordx4 v114, s[36:39], s81 offen offset:2048 lds
v_lshlrev_b32 v64, 16, v44
v_and_b32 v65, s23, v44
v_lshlrev_b32 v66, 16, v45
v_and_b32 v67, s23, v45
v_lshlrev_b32 v68, 16, v46
v_and_b32 v69, s23, v46
v_lshlrev_b32 v70, 16, v47
v_and_b32 v71, s23, v47
v_pk_fma_f32 v[176:177], v[64:65], v[8:9], v[176:177]
v_pk_fma_f32 v[178:179], v[66:67], v[8:9], v[178:179]
v_pk_fma_f32 v[184:185], v[68:69], v[8:9], v[184:185]
v_pk_fma_f32 v[186:187], v[70:71], v[8:9], v[186:187]
v_cvt_pk_bf16_f32 v176, v176, v177
v_cvt_pk_bf16_f32 v177, v178, v179
v_cvt_pk_bf16_f32 v178, v184, v185
v_cvt_pk_bf16_f32 v179, v186, v187
buffer_load_dwordx4 v115, s[36:39], s81 offen offset:3072 lds
v_lshlrev_b32 v64, 16, v48
v_and_b32 v65, s23, v48
v_lshlrev_b32 v66, 16, v49
v_and_b32 v67, s23, v49
v_lshlrev_b32 v68, 16, v50
v_and_b32 v69, s23, v50
v_lshlrev_b32 v70, 16, v51
v_and_b32 v71, s23, v51
v_pk_fma_f32 v[192:193], v[64:65], v[8:9], v[192:193]
v_pk_fma_f32 v[194:195], v[66:67], v[8:9], v[194:195]
v_pk_fma_f32 v[200:201], v[68:69], v[8:9], v[200:201]
v_pk_fma_f32 v[202:203], v[70:71], v[8:9], v[202:203]
v_cvt_pk_bf16_f32 v192, v192, v193
v_cvt_pk_bf16_f32 v193, v194, v195
v_cvt_pk_bf16_f32 v194, v200, v201
v_cvt_pk_bf16_f32 v195, v202, v203
s_add_u32 s81, s81, 28672
s_add_u32 m0, s18, 102400
s_nop 0
buffer_load_dwordx4 v112, s[36:39], s81 offen offset:0 lds
v_lshlrev_b32 v64, 16, v52
v_and_b32 v65, s23, v52
v_lshlrev_b32 v66, 16, v53
v_and_b32 v67, s23, v53
v_lshlrev_b32 v68, 16, v54
v_and_b32 v69, s23, v54
v_lshlrev_b32 v70, 16, v55
v_and_b32 v71, s23, v55
v_pk_fma_f32 v[208:209], v[64:65], v[8:9], v[208:209]
v_pk_fma_f32 v[210:211], v[66:67], v[8:9], v[210:211]
v_pk_fma_f32 v[216:217], v[68:69], v[8:9], v[216:217]
v_pk_fma_f32 v[218:219], v[70:71], v[8:9], v[218:219]
v_cvt_pk_bf16_f32 v208, v208, v209
v_cvt_pk_bf16_f32 v209, v210, v211
v_cvt_pk_bf16_f32 v210, v216, v217
v_cvt_pk_bf16_f32 v211, v218, v219
buffer_load_dwordx4 v113, s[36:39], s81 offen offset:1024 lds
v_lshlrev_b32 v64, 16, v56
v_and_b32 v65, s23, v56
v_lshlrev_b32 v66, 16, v57
v_and_b32 v67, s23, v57
v_lshlrev_b32 v68, 16, v58
v_and_b32 v69, s23, v58
v_lshlrev_b32 v70, 16, v59
v_and_b32 v71, s23, v59
v_pk_fma_f32 v[224:225], v[64:65], v[8:9], v[224:225]
v_pk_fma_f32 v[226:227], v[66:67], v[8:9], v[226:227]
v_pk_fma_f32 v[232:233], v[68:69], v[8:9], v[232:233]
v_pk_fma_f32 v[234:235], v[70:71], v[8:9], v[234:235]
v_cvt_pk_bf16_f32 v224, v224, v225
v_cvt_pk_bf16_f32 v225, v226, v227
v_cvt_pk_bf16_f32 v226, v232, v233
v_cvt_pk_bf16_f32 v227, v234, v235
buffer_load_dwordx4 v114, s[36:39], s81 offen offset:2048 lds
v_lshlrev_b32 v64, 16, v60
v_and_b32 v65, s23, v60
v_lshlrev_b32 v66, 16, v61
v_and_b32 v67, s23, v61
v_lshlrev_b32 v68, 16, v62
v_and_b32 v69, s23, v62
v_lshlrev_b32 v70, 16, v63
v_and_b32 v71, s23, v63
v_pk_fma_f32 v[240:241], v[64:65], v[8:9], v[240:241]
v_pk_fma_f32 v[242:243], v[66:67], v[8:9], v[242:243]
v_pk_fma_f32 v[248:249], v[68:69], v[8:9], v[248:249]
v_pk_fma_f32 v[250:251], v[70:71], v[8:9], v[250:251]
v_cvt_pk_bf16_f32 v240, v240, v241
v_cvt_pk_bf16_f32 v241, v242, v243
v_cvt_pk_bf16_f32 v242, v248, v249
v_cvt_pk_bf16_f32 v243, v250, v251
buffer_load_dwordx4 v115, s[36:39], s81 offen offset:3072 lds
v_accvgpr_read_b32 v32, a32
v_accvgpr_read_b32 v33, a33
v_accvgpr_read_b32 v34, a34
v_accvgpr_read_b32 v35, a35
v_lshlrev_b32 v64, 16, v32
v_and_b32 v65, s23, v32
v_lshlrev_b32 v66, 16, v33
v_and_b32 v67, s23, v33
v_lshlrev_b32 v68, 16, v34
v_and_b32 v69, s23, v34
v_lshlrev_b32 v70, 16, v35
v_and_b32 v71, s23, v35
v_pk_fma_f32 v[132:133], v[64:65], v[10:11], v[132:133]
v_pk_fma_f32 v[134:135], v[66:67], v[10:11], v[134:135]
v_pk_fma_f32 v[140:141], v[68:69], v[10:11], v[140:141]
v_pk_fma_f32 v[142:143], v[70:71], v[10:11], v[142:143]
v_cvt_pk_bf16_f32 v132, v132, v133
v_cvt_pk_bf16_f32 v133, v134, v135
v_cvt_pk_bf16_f32 v134, v140, v141
v_cvt_pk_bf16_f32 v135, v142, v143
s_sub_u32 s81, s81, 28544
s_add_u32 m0, s18, 131072
s_nop 0
buffer_load_dwordx4 v112, s[36:39], s81 offen offset:0 lds
v_accvgpr_read_b32 v36, a36
v_accvgpr_read_b32 v37, a37
v_accvgpr_read_b32 v38, a38
v_accvgpr_read_b32 v39, a39
v_lshlrev_b32 v64, 16, v36
v_and_b32 v65, s23, v36
v_lshlrev_b32 v66, 16, v37
v_and_b32 v67, s23, v37
v_lshlrev_b32 v68, 16, v38
v_and_b32 v69, s23, v38
v_lshlrev_b32 v70, 16, v39
v_and_b32 v71, s23, v39
v_pk_fma_f32 v[148:149], v[64:65], v[10:11], v[148:149]
v_pk_fma_f32 v[150:151], v[66:67], v[10:11], v[150:151]
v_pk_fma_f32 v[156:157], v[68:69], v[10:11], v[156:157]
v_pk_fma_f32 v[158:159], v[70:71], v[10:11], v[158:159]
v_cvt_pk_bf16_f32 v148, v148, v149
v_cvt_pk_bf16_f32 v149, v150, v151
v_cvt_pk_bf16_f32 v150, v156, v157
v_cvt_pk_bf16_f32 v151, v158, v159
buffer_load_dwordx4 v113, s[36:39], s81 offen offset:1024 lds
v_accvgpr_read_b32 v40, a40
v_accvgpr_read_b32 v41, a41
v_accvgpr_read_b32 v42, a42
v_accvgpr_read_b32 v43, a43
v_lshlrev_b32 v64, 16, v40
v_and_b32 v65, s23, v40
v_lshlrev_b32 v66, 16, v41
v_and_b32 v67, s23, v41
v_lshlrev_b32 v68, 16, v42
v_and_b32 v69, s23, v42
v_lshlrev_b32 v70, 16, v43
v_and_b32 v71, s23, v43
v_pk_fma_f32 v[164:165], v[64:65], v[10:11], v[164:165]
v_pk_fma_f32 v[166:167], v[66:67], v[10:11], v[166:167]
v_pk_fma_f32 v[172:173], v[68:69], v[10:11], v[172:173]
v_pk_fma_f32 v[174:175], v[70:71], v[10:11], v[174:175]
v_cvt_pk_bf16_f32 v164, v164, v165
v_cvt_pk_bf16_f32 v165, v166, v167
v_cvt_pk_bf16_f32 v166, v172, v173
v_cvt_pk_bf16_f32 v167, v174, v175
buffer_load_dwordx4 v114, s[36:39], s81 offen offset:2048 lds
v_accvgpr_read_b32 v44, a44
v_accvgpr_read_b32 v45, a45
v_accvgpr_read_b32 v46, a46
v_accvgpr_read_b32 v47, a47
v_lshlrev_b32 v64, 16, v44
v_and_b32 v65, s23, v44
v_lshlrev_b32 v66, 16, v45
v_and_b32 v67, s23, v45
v_lshlrev_b32 v68, 16, v46
v_and_b32 v69, s23, v46
v_lshlrev_b32 v70, 16, v47
v_and_b32 v71, s23, v47
v_pk_fma_f32 v[180:181], v[64:65], v[10:11], v[180:181]
v_pk_fma_f32 v[182:183], v[66:67], v[10:11], v[182:183]
v_pk_fma_f32 v[188:189], v[68:69], v[10:11], v[188:189]
v_pk_fma_f32 v[190:191], v[70:71], v[10:11], v[190:191]
v_cvt_pk_bf16_f32 v180, v180, v181
v_cvt_pk_bf16_f32 v181, v182, v183
v_cvt_pk_bf16_f32 v182, v188, v189
v_cvt_pk_bf16_f32 v183, v190, v191
buffer_load_dwordx4 v115, s[36:39], s81 offen offset:3072 lds
v_accvgpr_read_b32 v48, a48
v_accvgpr_read_b32 v49, a49
v_accvgpr_read_b32 v50, a50
v_accvgpr_read_b32 v51, a51
v_lshlrev_b32 v64, 16, v48
v_and_b32 v65, s23, v48
v_lshlrev_b32 v66, 16, v49
v_and_b32 v67, s23, v49
v_lshlrev_b32 v68, 16, v50
v_and_b32 v69, s23, v50
v_lshlrev_b32 v70, 16, v51
v_and_b32 v71, s23, v51
v_pk_fma_f32 v[196:197], v[64:65], v[10:11], v[196:197]
v_pk_fma_f32 v[198:199], v[66:67], v[10:11], v[198:199]
v_pk_fma_f32 v[204:205], v[68:69], v[10:11], v[204:205]
v_pk_fma_f32 v[206:207], v[70:71], v[10:11], v[206:207]
v_cvt_pk_bf16_f32 v196, v196, v197
v_cvt_pk_bf16_f32 v197, v198, v199
v_cvt_pk_bf16_f32 v198, v204, v205
v_cvt_pk_bf16_f32 v199, v206, v207
s_add_u32 s81, s81, 28672
s_add_u32 m0, s18, 135168
s_nop 0
buffer_load_dwordx4 v112, s[36:39], s81 offen offset:0 lds
v_accvgpr_read_b32 v52, a52
v_accvgpr_read_b32 v53, a53
v_accvgpr_read_b32 v54, a54
v_accvgpr_read_b32 v55, a55
v_lshlrev_b32 v64, 16, v52
v_and_b32 v65, s23, v52
v_lshlrev_b32 v66, 16, v53
v_and_b32 v67, s23, v53
v_lshlrev_b32 v68, 16, v54
v_and_b32 v69, s23, v54
v_lshlrev_b32 v70, 16, v55
v_and_b32 v71, s23, v55
v_pk_fma_f32 v[212:213], v[64:65], v[10:11], v[212:213]
v_pk_fma_f32 v[214:215], v[66:67], v[10:11], v[214:215]
v_pk_fma_f32 v[220:221], v[68:69], v[10:11], v[220:221]
v_pk_fma_f32 v[222:223], v[70:71], v[10:11], v[222:223]
v_cvt_pk_bf16_f32 v212, v212, v213
v_cvt_pk_bf16_f32 v213, v214, v215
v_cvt_pk_bf16_f32 v214, v220, v221
v_cvt_pk_bf16_f32 v215, v222, v223
buffer_load_dwordx4 v113, s[36:39], s81 offen offset:1024 lds
v_accvgpr_read_b32 v56, a56
v_accvgpr_read_b32 v57, a57
v_accvgpr_read_b32 v58, a58
v_accvgpr_read_b32 v59, a59
v_lshlrev_b32 v64, 16, v56
v_and_b32 v65, s23, v56
v_lshlrev_b32 v66, 16, v57
v_and_b32 v67, s23, v57
v_lshlrev_b32 v68, 16, v58
v_and_b32 v69, s23, v58
v_lshlrev_b32 v70, 16, v59
v_and_b32 v71, s23, v59
v_pk_fma_f32 v[228:229], v[64:65], v[10:11], v[228:229]
v_pk_fma_f32 v[230:231], v[66:67], v[10:11], v[230:231]
v_pk_fma_f32 v[236:237], v[68:69], v[10:11], v[236:237]
v_pk_fma_f32 v[238:239], v[70:71], v[10:11], v[238:239]
v_cvt_pk_bf16_f32 v228, v228, v229
v_cvt_pk_bf16_f32 v229, v230, v231
v_cvt_pk_bf16_f32 v230, v236, v237
v_cvt_pk_bf16_f32 v231, v238, v239
buffer_load_dwordx4 v114, s[36:39], s81 offen offset:2048 lds
v_accvgpr_read_b32 v60, a60
v_accvgpr_read_b32 v61, a61
v_accvgpr_read_b32 v62, a62
v_accvgpr_read_b32 v63, a63
v_lshlrev_b32 v64, 16, v60
v_and_b32 v65, s23, v60
v_lshlrev_b32 v66, 16, v61
v_and_b32 v67, s23, v61
v_lshlrev_b32 v68, 16, v62
v_and_b32 v69, s23, v62
v_lshlrev_b32 v70, 16, v63
v_and_b32 v71, s23, v63
v_pk_fma_f32 v[244:245], v[64:65], v[10:11], v[244:245]
v_pk_fma_f32 v[246:247], v[66:67], v[10:11], v[246:247]
v_pk_fma_f32 v[252:253], v[68:69], v[10:11], v[252:253]
v_pk_fma_f32 v[254:255], v[70:71], v[10:11], v[254:255]
v_cvt_pk_bf16_f32 v244, v244, v245
v_cvt_pk_bf16_f32 v245, v246, v247
v_cvt_pk_bf16_f32 v246, v252, v253
v_cvt_pk_bf16_f32 v247, v254, v255
buffer_load_dwordx4 v115, s[36:39], s81 offen offset:3072 lds
s_sub_u32 s81, s81, 28544
K2_done:
PAD_13:
s_cbranch_execz PAD_17
s_waitcnt vmcnt(16)
s_barrier
ds_read_b64_tr_b16 a[64:65], v116 offset:0
ds_read_b64_tr_b16 a[66:67], v116 offset:2048
ds_read_b64_tr_b16 a[68:69], v116 offset:4096
ds_read_b64_tr_b16 a[70:71], v116 offset:6144
ds_read_b64_tr_b16 a[72:73], v116 offset:8192
ds_read_b64_tr_b16 a[74:75], v116 offset:10240
ds_read_b64_tr_b16 a[76:77], v116 offset:12288
ds_read_b64_tr_b16 a[78:79], v116 offset:14336
ds_read_b64_tr_b16 a[80:81], v116 offset:16384
ds_read_b64_tr_b16 a[82:83], v116 offset:18432
ds_read_b64_tr_b16 a[84:85], v116 offset:20480
ds_read_b64_tr_b16 a[86:87], v116 offset:22528
ds_read_b64_tr_b16 a[88:89], v116 offset:24576
ds_read_b64_tr_b16 a[90:91], v116 offset:26624
ds_read_b64_tr_b16 a[92:93], v116 offset:28672
ds_read_b64_tr_b16 a[94:95], v116 offset:30720
v_add_u32 v116, 65536, v116
s_waitcnt lgkmcnt(14)
v_mfma_f32_16x16x32_bf16 v[32:35], a[64:67], v[128:131], 0
s_waitcnt lgkmcnt(12)
s_add_u32 m0, s18, 65536
ds_read_b64_tr_b16 a[96:97], v117 offset:0
v_mov_b32 v28, v24
v_mfma_f32_16x16x32_bf16 v[32:35], a[68:71], v[144:147], v[32:35]
s_waitcnt lgkmcnt(11)
ds_read_b64_tr_b16 a[98:99], v117 offset:2048
buffer_load_dwordx4 v112, s[36:39], s81 offen offset:0 lds
v_mfma_f32_16x16x32_bf16 v[32:35], a[72:75], v[160:163], v[32:35]
s_waitcnt lgkmcnt(10)
ds_read_b64_tr_b16 a[100:101], v117 offset:4096
v_permlane16_swap_b32 v24, v28
v_mfma_f32_16x16x32_bf16 v[32:35], a[76:79], v[176:179], v[32:35]
s_waitcnt lgkmcnt(9)
ds_read_b64_tr_b16 a[102:103], v117 offset:6144
v_add_f32 v24, v24, v28
v_mfma_f32_16x16x32_bf16 v[32:35], a[80:83], v[192:195], v[32:35]
s_waitcnt lgkmcnt(8)
ds_read_b64_tr_b16 a[104:105], v117 offset:8192
buffer_load_dwordx4 v113, s[36:39], s81 offen offset:1024 lds
v_mfma_f32_16x16x32_bf16 v[32:35], a[84:87], v[208:211], v[32:35]
s_waitcnt lgkmcnt(7)
ds_read_b64_tr_b16 a[106:107], v117 offset:10240
v_mov_b32 v28, v24
v_mfma_f32_16x16x32_bf16 v[32:35], a[88:91], v[224:227], v[32:35]
s_waitcnt lgkmcnt(6)
ds_read_b64_tr_b16 a[108:109], v117 offset:12288
v_lshrrev_b32 v20, 4, v1
v_mfma_f32_16x16x32_bf16 v[32:35], a[92:95], v[240:243], v[32:35]
ds_read_b64_tr_b16 a[110:111], v117 offset:14336
buffer_load_dwordx4 v114, s[36:39], s81 offen offset:2048 lds
v_mfma_f32_16x16x32_bf16 v[36:39], a[64:67], v[132:135], 0
PAD_14:
s_cbranch_execz PAD_18
ds_read_b64_tr_b16 a[112:113], v117 offset:16384
v_permlane32_swap_b32 v24, v28
v_mfma_f32_16x16x32_bf16 v[36:39], a[68:71], v[148:151], v[36:39]
ds_read_b64_tr_b16 a[114:115], v117 offset:18432
v_add_f32 v24, v24, v28
v_mfma_f32_16x16x32_bf16 v[36:39], a[72:75], v[164:167], v[36:39]
ds_read_b64_tr_b16 a[116:117], v117 offset:20480
buffer_load_dwordx4 v115, s[36:39], s81 offen offset:3072 lds
v_mfma_f32_16x16x32_bf16 v[36:39], a[76:79], v[180:183], v[36:39]
ds_read_b64_tr_b16 a[118:119], v117 offset:22528
v_mov_b32 v29, v25
v_mfma_f32_16x16x32_bf16 v[36:39], a[80:83], v[196:199], v[36:39]
s_add_u32 s81, s81, 28672
s_add_u32 m0, s18, 69632
ds_read_b64_tr_b16 a[120:121], v117 offset:24576
v_mfma_f32_16x16x32_bf16 v[36:39], a[84:87], v[212:215], v[36:39]
ds_read_b64_tr_b16 a[122:123], v117 offset:26624
buffer_load_dwordx4 v112, s[36:39], s81 offen offset:0 lds
v_mfma_f32_16x16x32_bf16 v[36:39], a[88:91], v[228:231], v[36:39]
ds_read_b64_tr_b16 a[124:125], v117 offset:28672
v_permlane16_swap_b32 v25, v29
v_mfma_f32_16x16x32_bf16 v[36:39], a[92:95], v[244:247], v[36:39]
s_waitcnt lgkmcnt(8)
ds_read_b64_tr_b16 a[126:127], v117 offset:30720
v_add_u32 v117, 65536, v117
v_mfma_f32_16x16x32_bf16 v[40:43], a[96:99], v[128:131], 0
ds_read_b64_tr_b16 a[64:65], v118 offset:0
buffer_load_dwordx4 v113, s[36:39], s81 offen offset:1024 lds
v_mfma_f32_16x16x32_bf16 v[40:43], a[100:103], v[144:147], v[40:43]
ds_read_b64_tr_b16 a[66:67], v118 offset:2048
v_add_f32 v25, v25, v29
v_mfma_f32_16x16x32_bf16 v[40:43], a[104:107], v[160:163], v[40:43]
s_waitcnt lgkmcnt(8)
ds_read_b64_tr_b16 a[68:69], v118 offset:4096
v_mov_b32 v29, v25
v_mfma_f32_16x16x32_bf16 v[40:43], a[108:111], v[176:179], v[40:43]
ds_read_b64_tr_b16 a[70:71], v118 offset:6144
buffer_load_dwordx4 v114, s[36:39], s81 offen offset:2048 lds
v_mfma_f32_16x16x32_bf16 v[40:43], a[112:115], v[192:195], v[40:43]
s_waitcnt lgkmcnt(8)
ds_read_b64_tr_b16 a[72:73], v118 offset:8192
v_permlane32_swap_b32 v25, v29
v_mfma_f32_16x16x32_bf16 v[40:43], a[116:119], v[208:211], v[40:43]
s_waitcnt lgkmcnt(7)
ds_read_b64_tr_b16 a[74:75], v118 offset:10240
v_add_f32 v25, v25, v29
v_mfma_f32_16x16x32_bf16 v[40:43], a[120:123], v[224:227], v[40:43]
s_waitcnt lgkmcnt(6)
ds_read_b64_tr_b16 a[76:77], v118 offset:12288
buffer_load_dwordx4 v115, s[36:39], s81 offen offset:3072 lds
v_mfma_f32_16x16x32_bf16 v[40:43], a[124:127], v[240:243], v[40:43]
ds_read_b64_tr_b16 a[78:79], v118 offset:14336
v_rcp_f32 v24, v24
v_mfma_f32_16x16x32_bf16 v[44:47], a[96:99], v[132:135], 0
s_sub_u32 s81, s81, 28544
s_add_u32 m0, s18, 0
ds_read_b64_tr_b16 a[80:81], v118 offset:16384
v_mfma_f32_16x16x32_bf16 v[44:47], a[100:103], v[148:151], v[44:47]
ds_read_b64_tr_b16 a[82:83], v118 offset:18432
buffer_load_dwordx4 v112, s[36:39], s81 offen offset:0 lds
v_mfma_f32_16x16x32_bf16 v[44:47], a[104:107], v[164:167], v[44:47]
ds_read_b64_tr_b16 a[84:85], v118 offset:20480
v_rcp_f32 v25, v25
v_mfma_f32_16x16x32_bf16 v[44:47], a[108:111], v[180:183], v[44:47]
ds_read_b64_tr_b16 a[86:87], v118 offset:22528
v_and_b32 v19, 15, v20
v_mfma_f32_16x16x32_bf16 v[44:47], a[112:115], v[196:199], v[44:47]
ds_read_b64_tr_b16 a[88:89], v118 offset:24576
buffer_load_dwordx4 v113, s[36:39], s81 offen offset:1024 lds
v_mfma_f32_16x16x32_bf16 v[44:47], a[116:119], v[212:215], v[44:47]
ds_read_b64_tr_b16 a[90:91], v118 offset:26624
v_mul_f32 v32, v32, v24
v_mfma_f32_16x16x32_bf16 v[44:47], a[120:123], v[228:231], v[44:47]
ds_read_b64_tr_b16 a[92:93], v118 offset:28672
v_mul_f32 v33, v33, v24
v_mfma_f32_16x16x32_bf16 v[44:47], a[124:127], v[244:247], v[44:47]
s_waitcnt lgkmcnt(8)
ds_read_b64_tr_b16 a[94:95], v118 offset:30720
v_add_u32 v118, 65536, v118
v_mfma_f32_16x16x32_bf16 v[48:51], a[64:67], v[128:131], 0
ds_read_b64_tr_b16 a[96:97], v119 offset:0
buffer_load_dwordx4 v114, s[36:39], s81 offen offset:2048 lds
v_mfma_f32_16x16x32_bf16 v[48:51], a[68:71], v[144:147], v[48:51]
ds_read_b64_tr_b16 a[98:99], v119 offset:2048
v_mul_f32 v34, v34, v24
v_mfma_f32_16x16x32_bf16 v[48:51], a[72:75], v[160:163], v[48:51]
s_waitcnt lgkmcnt(8)
ds_read_b64_tr_b16 a[100:101], v119 offset:4096
v_mul_f32 v35, v35, v24
v_mfma_f32_16x16x32_bf16 v[48:51], a[76:79], v[176:179], v[48:51]
ds_read_b64_tr_b16 a[102:103], v119 offset:6144
buffer_load_dwordx4 v115, s[36:39], s81 offen offset:3072 lds
v_mfma_f32_16x16x32_bf16 v[48:51], a[80:83], v[192:195], v[48:51]
s_waitcnt lgkmcnt(6)
ds_read_b64_tr_b16 a[104:105], v119 offset:8192
v_mul_f32 v40, v40, v24
v_mfma_f32_16x16x32_bf16 v[48:51], a[84:87], v[208:211], v[48:51]
s_add_u32 s81, s81, 28672
s_add_u32 m0, s18, 4096
ds_read_b64_tr_b16 a[106:107], v119 offset:10240
v_mfma_f32_16x16x32_bf16 v[48:51], a[88:91], v[224:227], v[48:51]
s_waitcnt lgkmcnt(6)
ds_read_b64_tr_b16 a[108:109], v119 offset:12288
buffer_load_dwordx4 v112, s[36:39], s81 offen offset:0 lds
v_mfma_f32_16x16x32_bf16 v[48:51], a[92:95], v[240:243], v[48:51]
ds_read_b64_tr_b16 a[110:111], v119 offset:14336
v_mul_f32 v41, v41, v24
v_mfma_f32_16x16x32_bf16 v[52:55], a[64:67], v[132:135], 0
ds_read_b64_tr_b16 a[112:113], v119 offset:16384
v_mul_f32 v42, v42, v24
v_mfma_f32_16x16x32_bf16 v[52:55], a[68:71], v[148:151], v[52:55]
ds_read_b64_tr_b16 a[114:115], v119 offset:18432
buffer_load_dwordx4 v113, s[36:39], s81 offen offset:1024 lds
v_mfma_f32_16x16x32_bf16 v[52:55], a[72:75], v[164:167], v[52:55]
ds_read_b64_tr_b16 a[116:117], v119 offset:20480
v_mul_f32 v43, v43, v24
v_mfma_f32_16x16x32_bf16 v[52:55], a[76:79], v[180:183], v[52:55]
ds_read_b64_tr_b16 a[118:119], v119 offset:22528
v_cvt_pk_bf16_f32 v32, v32, v33
v_mfma_f32_16x16x32_bf16 v[52:55], a[80:83], v[196:199], v[52:55]
ds_read_b64_tr_b16 a[120:121], v119 offset:24576
buffer_load_dwordx4 v114, s[36:39], s81 offen offset:2048 lds
v_mfma_f32_16x16x32_bf16 v[52:55], a[84:87], v[212:215], v[52:55]
ds_read_b64_tr_b16 a[122:123], v119 offset:26624
v_cvt_pk_bf16_f32 v33, v34, v35
v_mfma_f32_16x16x32_bf16 v[52:55], a[88:91], v[228:231], v[52:55]
ds_read_b64_tr_b16 a[124:125], v119 offset:28672
ds_read_b64_tr_b16 a[126:127], v119 offset:30720
v_mfma_f32_16x16x32_bf16 v[52:55], a[92:95], v[244:247], v[52:55]
s_waitcnt vmcnt(23) lgkmcnt(9)
s_barrier
v_add_u32 v119, 65536, v119
v_mfma_f32_16x16x32_bf16 v[56:59], a[96:99], v[128:131], 0
ds_read_b64_tr_b16 a[64:65], v116 offset:0
buffer_load_dwordx4 v115, s[36:39], s81 offen offset:3072 lds
v_mfma_f32_16x16x32_bf16 v[56:59], a[100:103], v[144:147], v[56:59]
s_waitcnt lgkmcnt(8)
ds_read_b64_tr_b16 a[66:67], v116 offset:2048
v_cvt_pk_bf16_f32 v34, v40, v41
v_mfma_f32_16x16x32_bf16 v[56:59], a[104:107], v[160:163], v[56:59]
s_sub_u32 s81, s81, 28544
ds_read_b64_tr_b16 a[68:69], v116 offset:4096
v_cvt_pk_bf16_f32 v35, v42, v43
v_mfma_f32_16x16x32_bf16 v[56:59], a[108:111], v[176:179], v[56:59]
s_waitcnt lgkmcnt(8)
ds_read_b64_tr_b16 a[70:71], v116 offset:6144
buffer_store_dwordx4 v[32:35], v1, s[4:7], s8 offen offset:0 sc1
v_mfma_f32_16x16x32_bf16 v[56:59], a[112:115], v[192:195], v[56:59]
s_waitcnt lgkmcnt(8)
ds_read_b64_tr_b16 a[72:73], v116 offset:8192
v_mul_f32 v36, v36, v25
v_mfma_f32_16x16x32_bf16 v[56:59], a[116:119], v[208:211], v[56:59]
s_waitcnt lgkmcnt(7)
ds_read_b64_tr_b16 a[74:75], v116 offset:10240
v_mul_f32 v37, v37, v25
v_mfma_f32_16x16x32_bf16 v[56:59], a[120:123], v[224:227], v[56:59]
s_waitcnt lgkmcnt(6)
ds_read_b64_tr_b16 a[76:77], v116 offset:12288
v_mul_f32 v38, v38, v25
v_mfma_f32_16x16x32_bf16 v[56:59], a[124:127], v[240:243], v[56:59]
ds_read_b64_tr_b16 a[78:79], v116 offset:14336
v_mul_f32 v39, v39, v25
v_mfma_f32_16x16x32_bf16 v[60:63], a[96:99], v[132:135], 0
ds_read_b64_tr_b16 a[80:81], v116 offset:16384
v_mul_f32 v44, v44, v25
v_mfma_f32_16x16x32_bf16 v[60:63], a[100:103], v[148:151], v[60:63]
ds_read_b64_tr_b16 a[82:83], v116 offset:18432
v_mul_f32 v45, v45, v25
v_mfma_f32_16x16x32_bf16 v[60:63], a[104:107], v[164:167], v[60:63]
ds_read_b64_tr_b16 a[84:85], v116 offset:20480
v_mul_f32 v46, v46, v25
v_mfma_f32_16x16x32_bf16 v[60:63], a[108:111], v[180:183], v[60:63]
ds_read_b64_tr_b16 a[86:87], v116 offset:22528
v_mul_f32 v47, v47, v25
v_mfma_f32_16x16x32_bf16 v[60:63], a[112:115], v[196:199], v[60:63]
ds_read_b64_tr_b16 a[88:89], v116 offset:24576
v_cvt_pk_bf16_f32 v36, v36, v37
v_mfma_f32_16x16x32_bf16 v[60:63], a[116:119], v[212:215], v[60:63]
ds_read_b64_tr_b16 a[90:91], v116 offset:26624
v_cvt_pk_bf16_f32 v37, v38, v39
v_mfma_f32_16x16x32_bf16 v[60:63], a[120:123], v[228:231], v[60:63]
ds_read_b64_tr_b16 a[92:93], v116 offset:28672
v_cvt_pk_bf16_f32 v38, v44, v45
v_mfma_f32_16x16x32_bf16 v[60:63], a[124:127], v[244:247], v[60:63]
s_waitcnt lgkmcnt(3)
ds_read_b64_tr_b16 a[94:95], v116 offset:30720
v_add_u32 v116, 32768, v116
v_mfma_f32_16x16x32_bf16 v[64:67], a[64:67], v[128:131], 0
s_lshl_b32 s34, s29, 5
ds_read_b64_tr_b16 a[96:97], v117 offset:0
v_cvt_pk_bf16_f32 v39, v46, v47
v_mfma_f32_16x16x32_bf16 v[64:67], a[68:71], v[144:147], v[64:67]
s_add_u32 s34, s34, s20
ds_read_b64_tr_b16 a[98:99], v117 offset:2048
buffer_store_dwordx4 v[36:39], v1, s[4:7], s12 offen offset:0 sc1
v_mfma_f32_16x16x32_bf16 v[64:67], a[72:75], v[160:163], v[64:67]
s_lshl_b32 s34, s34, 2
ds_read_b64_tr_b16 a[100:101], v117 offset:4096
v_mul_f32 v48, v48, v24
v_mfma_f32_16x16x32_bf16 v[64:67], a[76:79], v[176:179], v[64:67]
s_add_u32 s34, s34, 94380032
ds_read_b64_tr_b16 a[102:103], v117 offset:6144
v_mul_f32 v49, v49, v24
v_mfma_f32_16x16x32_bf16 v[64:67], a[80:83], v[192:195], v[64:67]
s_add_u32 s35, s34, 2048
ds_read_b64_tr_b16 a[104:105], v117 offset:8192
v_mul_f32 v50, v50, v24
v_mfma_f32_16x16x32_bf16 v[64:67], a[84:87], v[208:211], v[64:67]
s_waitcnt lgkmcnt(5)
s_mov_b32 s80, s21
ds_read_b64_tr_b16 a[106:107], v117 offset:10240
v_mul_f32 v51, v51, v24
v_mfma_f32_16x16x32_bf16 v[64:67], a[88:91], v[224:227], v[64:67]
s_and_b32 s79, s2, 16
ds_read_b64_tr_b16 a[108:109], v117 offset:12288
v_mul_f32 v56, v56, v24
v_mfma_f32_16x16x32_bf16 v[64:67], a[92:95], v[240:243], v[64:67]
s_xor_b32 s79, s79, 16
ds_read_b64_tr_b16 a[110:111], v117 offset:14336
v_mul_f32 v57, v57, v24
v_mfma_f32_16x16x32_bf16 v[68:71], a[64:67], v[132:135], 0
s_add_u32 s79, s79, s20
ds_read_b64_tr_b16 a[112:113], v117 offset:16384
v_mul_f32 v58, v58, v24
v_mfma_f32_16x16x32_bf16 v[68:71], a[68:71], v[148:151], v[68:71]
s_lshl_b32 s22, s79, 2
ds_read_b64_tr_b16 a[114:115], v117 offset:18432
v_mul_f32 v59, v59, v24
v_mfma_f32_16x16x32_bf16 v[68:71], a[72:75], v[164:167], v[68:71]
s_add_u32 s22, s22, s3
ds_read_b64_tr_b16 a[116:117], v117 offset:20480
v_cvt_pk_bf16_f32 v48, v48, v49
v_mfma_f32_16x16x32_bf16 v[68:71], a[76:79], v[180:183], v[68:71]
s_mul_i32 s25, s22, 28672
ds_read_b64_tr_b16 a[118:119], v117 offset:22528
v_cvt_pk_bf16_f32 v49, v50, v51
v_mfma_f32_16x16x32_bf16 v[68:71], a[80:83], v[196:199], v[68:71]
s_lshl_b32 s23, s80, 6
ds_read_b64_tr_b16 a[120:121], v117 offset:24576
v_cvt_pk_bf16_f32 v50, v56, v57
v_mfma_f32_16x16x32_bf16 v[68:71], a[84:87], v[212:215], v[68:71]
s_add_u32 s25, s25, s23
ds_read_b64_tr_b16 a[122:123], v117 offset:26624
v_cvt_pk_bf16_f32 v51, v58, v59
v_mfma_f32_16x16x32_bf16 v[68:71], a[88:91], v[228:231], v[68:71]
s_mul_i32 s26, s22, 229376
ds_read_b64_tr_b16 a[124:125], v117 offset:28672
buffer_store_dwordx4 v[48:51], v1, s[4:7], s8 offen offset:1024 sc1
v_mfma_f32_16x16x32_bf16 v[68:71], a[92:95], v[244:247], v[68:71]
s_waitcnt lgkmcnt(3)
s_lshl_b32 s23, s80, 10
ds_read_b64_tr_b16 a[126:127], v117 offset:30720
v_add_u32 v117, 32768, v117
v_mfma_f32_16x16x32_bf16 v[72:75], a[96:99], v[128:131], 0
s_add_u32 s26, s26, s23
ds_read_b64_tr_b16 a[64:65], v118 offset:0
v_mul_f32 v52, v52, v25
v_mfma_f32_16x16x32_bf16 v[72:75], a[100:103], v[144:147], v[72:75]
s_add_u32 s26, s26, 104857600
ds_read_b64_tr_b16 a[66:67], v118 offset:2048
v_mul_f32 v53, v53, v25
v_mfma_f32_16x16x32_bf16 v[72:75], a[104:107], v[160:163], v[72:75]
s_lshr_b32 s22, s79, 1
ds_read_b64_tr_b16 a[68:69], v118 offset:4096
v_mul_f32 v54, v54, v25
v_mfma_f32_16x16x32_bf16 v[72:75], a[108:111], v[176:179], v[72:75]
s_lshl_b32 s22, s22, 7
ds_read_b64_tr_b16 a[70:71], v118 offset:6144
v_mul_f32 v55, v55, v25
v_mfma_f32_16x16x32_bf16 v[72:75], a[112:115], v[192:195], v[72:75]
s_add_u32 s33, s22, 94380032
ds_read_b64_tr_b16 a[72:73], v118 offset:8192
v_mul_f32 v60, v60, v25
v_mfma_f32_16x16x32_bf16 v[72:75], a[116:119], v[208:211], v[72:75]
s_waitcnt lgkmcnt(5)
s_mov_b64 s[40:41], s[88:89]
ds_read_b64_tr_b16 a[74:75], v118 offset:10240
v_mul_f32 v61, v61, v25
v_mfma_f32_16x16x32_bf16 v[72:75], a[120:123], v[224:227], v[72:75]
s_mov_b32 s42, 3670016
ds_read_b64_tr_b16 a[76:77], v118 offset:12288
v_mul_f32 v62, v62, v25
v_mfma_f32_16x16x32_bf16 v[72:75], a[124:127], v[240:243], v[72:75]
s_mov_b32 s43, 0x20000
ds_read_b64_tr_b16 a[78:79], v118 offset:14336
v_mul_f32 v63, v63, v25
v_mfma_f32_16x16x32_bf16 v[76:79], a[96:99], v[132:135], 0
ds_read_b64_tr_b16 a[80:81], v118 offset:16384
v_cvt_pk_bf16_f32 v52, v52, v53
v_mfma_f32_16x16x32_bf16 v[76:79], a[100:103], v[148:151], v[76:79]
ds_read_b64_tr_b16 a[82:83], v118 offset:18432
v_cvt_pk_bf16_f32 v53, v54, v55
v_mfma_f32_16x16x32_bf16 v[76:79], a[104:107], v[164:167], v[76:79]
ds_read_b64_tr_b16 a[84:85], v118 offset:20480
v_cvt_pk_bf16_f32 v54, v60, v61
v_mfma_f32_16x16x32_bf16 v[76:79], a[108:111], v[180:183], v[76:79]
ds_read_b64_tr_b16 a[86:87], v118 offset:22528
v_cvt_pk_bf16_f32 v55, v62, v63
v_mfma_f32_16x16x32_bf16 v[76:79], a[112:115], v[196:199], v[76:79]
ds_read_b64_tr_b16 a[88:89], v118 offset:24576
buffer_store_dwordx4 v[52:55], v1, s[4:7], s12 offen offset:1024 sc1
v_mfma_f32_16x16x32_bf16 v[76:79], a[116:119], v[212:215], v[76:79]
ds_read_b64_tr_b16 a[90:91], v118 offset:26624
v_mfma_f32_16x16x32_bf16 v[76:79], a[120:123], v[228:231], v[76:79]
ds_read_b64_tr_b16 a[92:93], v118 offset:28672
v_mul_f32 v64, v64, v24
v_mfma_f32_16x16x32_bf16 v[76:79], a[124:127], v[244:247], v[76:79]
s_waitcnt lgkmcnt(8)
ds_read_b64_tr_b16 a[94:95], v118 offset:30720
v_add_u32 v118, 32768, v118
v_mfma_f32_16x16x32_bf16 v[80:83], a[64:67], v[128:131], 0
ds_read_b64_tr_b16 a[96:97], v119 offset:0
v_mul_f32 v65, v65, v24
v_mfma_f32_16x16x32_bf16 v[80:83], a[68:71], v[144:147], v[80:83]
ds_read_b64_tr_b16 a[98:99], v119 offset:2048
v_mul_f32 v66, v66, v24
v_mfma_f32_16x16x32_bf16 v[80:83], a[72:75], v[160:163], v[80:83]
s_waitcnt lgkmcnt(8)
ds_read_b64_tr_b16 a[100:101], v119 offset:4096
v_mul_f32 v67, v67, v24
v_mfma_f32_16x16x32_bf16 v[80:83], a[76:79], v[176:179], v[80:83]
ds_read_b64_tr_b16 a[102:103], v119 offset:6144
v_mul_f32 v72, v72, v24
v_mfma_f32_16x16x32_bf16 v[80:83], a[80:83], v[192:195], v[80:83]
s_waitcnt lgkmcnt(8)
ds_read_b64_tr_b16 a[104:105], v119 offset:8192
v_mul_f32 v73, v73, v24
v_mfma_f32_16x16x32_bf16 v[80:83], a[84:87], v[208:211], v[80:83]
s_waitcnt lgkmcnt(7)
ds_read_b64_tr_b16 a[106:107], v119 offset:10240
v_mul_f32 v74, v74, v24
v_mfma_f32_16x16x32_bf16 v[80:83], a[88:91], v[224:227], v[80:83]
s_waitcnt lgkmcnt(6)
ds_read_b64_tr_b16 a[108:109], v119 offset:12288
v_mul_f32 v75, v75, v24
v_mfma_f32_16x16x32_bf16 v[80:83], a[92:95], v[240:243], v[80:83]
ds_read_b64_tr_b16 a[110:111], v119 offset:14336
v_cvt_pk_bf16_f32 v64, v64, v65
v_mfma_f32_16x16x32_bf16 v[84:87], a[64:67], v[132:135], 0
ds_read_b64_tr_b16 a[112:113], v119 offset:16384
v_cvt_pk_bf16_f32 v65, v66, v67
v_mfma_f32_16x16x32_bf16 v[84:87], a[68:71], v[148:151], v[84:87]
ds_read_b64_tr_b16 a[114:115], v119 offset:18432
v_cvt_pk_bf16_f32 v66, v72, v73
v_mfma_f32_16x16x32_bf16 v[84:87], a[72:75], v[164:167], v[84:87]
ds_read_b64_tr_b16 a[116:117], v119 offset:20480
v_cvt_pk_bf16_f32 v67, v74, v75
v_mfma_f32_16x16x32_bf16 v[84:87], a[76:79], v[180:183], v[84:87]
ds_read_b64_tr_b16 a[118:119], v119 offset:22528
buffer_store_dwordx4 v[64:67], v1, s[4:7], s8 offen offset:2048 sc1
v_mfma_f32_16x16x32_bf16 v[84:87], a[80:83], v[196:199], v[84:87]
ds_read_b64_tr_b16 a[120:121], v119 offset:24576
v_mul_f32 v68, v68, v25
v_mfma_f32_16x16x32_bf16 v[84:87], a[84:87], v[212:215], v[84:87]
ds_read_b64_tr_b16 a[122:123], v119 offset:26624
v_mul_f32 v69, v69, v25
v_mfma_f32_16x16x32_bf16 v[84:87], a[88:91], v[228:231], v[84:87]
ds_read_b64_tr_b16 a[124:125], v119 offset:28672
ds_read_b64_tr_b16 a[126:127], v119 offset:30720
v_mfma_f32_16x16x32_bf16 v[84:87], a[92:95], v[244:247], v[84:87]
s_waitcnt vmcnt(21) lgkmcnt(9)
s_barrier
v_add_u32 v119, 32768, v119
v_mfma_f32_16x16x32_bf16 v[88:91], a[96:99], v[128:131], 0
ds_read_b64_tr_b16 a[64:65], v116 offset:0
v_mul_f32 v70, v70, v25
v_mfma_f32_16x16x32_bf16 v[88:91], a[100:103], v[144:147], v[88:91]
ds_read_b64_tr_b16 a[66:67], v116 offset:2048
v_mul_f32 v71, v71, v25
v_mfma_f32_16x16x32_bf16 v[88:91], a[104:107], v[160:163], v[88:91]
s_waitcnt lgkmcnt(8)
ds_read_b64_tr_b16 a[68:69], v116 offset:4096
v_mul_f32 v76, v76, v25
v_mfma_f32_16x16x32_bf16 v[88:91], a[108:111], v[176:179], v[88:91]
ds_read_b64_tr_b16 a[70:71], v116 offset:6144
v_mul_f32 v77, v77, v25
v_mfma_f32_16x16x32_bf16 v[88:91], a[112:115], v[192:195], v[88:91]
s_waitcnt lgkmcnt(8)
ds_read_b64_tr_b16 a[72:73], v116 offset:8192
v_mul_f32 v78, v78, v25
v_mfma_f32_16x16x32_bf16 v[88:91], a[116:119], v[208:211], v[88:91]
s_waitcnt lgkmcnt(7)
ds_read_b64_tr_b16 a[74:75], v116 offset:10240
v_mul_f32 v79, v79, v25
v_mfma_f32_16x16x32_bf16 v[88:91], a[120:123], v[224:227], v[88:91]
s_waitcnt lgkmcnt(6)
ds_read_b64_tr_b16 a[76:77], v116 offset:12288
v_cvt_pk_bf16_f32 v68, v68, v69
v_mfma_f32_16x16x32_bf16 v[88:91], a[124:127], v[240:243], v[88:91]
ds_read_b64_tr_b16 a[78:79], v116 offset:14336
v_cvt_pk_bf16_f32 v69, v70, v71
v_mfma_f32_16x16x32_bf16 v[92:95], a[96:99], v[132:135], 0
ds_read_b64_tr_b16 a[80:81], v116 offset:16384
v_cvt_pk_bf16_f32 v70, v76, v77
v_mfma_f32_16x16x32_bf16 v[92:95], a[100:103], v[148:151], v[92:95]
ds_read_b64_tr_b16 a[82:83], v116 offset:18432
v_cvt_pk_bf16_f32 v71, v78, v79
v_mfma_f32_16x16x32_bf16 v[92:95], a[104:107], v[164:167], v[92:95]
ds_read_b64_tr_b16 a[84:85], v116 offset:20480
buffer_store_dwordx4 v[68:71], v1, s[4:7], s12 offen offset:2048 sc1
v_mfma_f32_16x16x32_bf16 v[92:95], a[108:111], v[180:183], v[92:95]
ds_read_b64_tr_b16 a[86:87], v116 offset:22528
v_mfma_f32_16x16x32_bf16 v[92:95], a[112:115], v[196:199], v[92:95]
ds_read_b64_tr_b16 a[88:89], v116 offset:24576
v_mfma_f32_16x16x32_bf16 v[92:95], a[116:119], v[212:215], v[92:95]
ds_read_b64_tr_b16 a[90:91], v116 offset:26624
v_mfma_f32_16x16x32_bf16 v[92:95], a[120:123], v[228:231], v[92:95]
ds_read_b64_tr_b16 a[92:93], v116 offset:28672
v_mfma_f32_16x16x32_bf16 v[92:95], a[124:127], v[244:247], v[92:95]
s_waitcnt lgkmcnt(8)
ds_read_b64_tr_b16 a[94:95], v116 offset:30720
v_add_u32 v116, 4294901760, v116
v_mfma_f32_16x16x32_bf16 v[32:35], a[64:67], v[128:131], 0
s_add_u32 m0, s18, 32768
ds_read_b64_tr_b16 a[96:97], v117 offset:0
v_mul_f32 v80, v80, v24
v_mfma_f32_16x16x32_bf16 v[32:35], a[68:71], v[144:147], v[32:35]
ds_read_b64_tr_b16 a[98:99], v117 offset:2048
buffer_load_dwordx4 v112, s[36:39], s81 offen offset:0 lds
v_mfma_f32_16x16x32_bf16 v[32:35], a[72:75], v[160:163], v[32:35]
s_waitcnt lgkmcnt(8)
ds_read_b64_tr_b16 a[100:101], v117 offset:4096
v_mul_f32 v81, v81, v24
v_mfma_f32_16x16x32_bf16 v[32:35], a[76:79], v[176:179], v[32:35]
ds_read_b64_tr_b16 a[102:103], v117 offset:6144
v_mul_f32 v82, v82, v24
v_mfma_f32_16x16x32_bf16 v[32:35], a[80:83], v[192:195], v[32:35]
s_waitcnt lgkmcnt(8)
ds_read_b64_tr_b16 a[104:105], v117 offset:8192
v_mul_f32 v83, v83, v24
v_mfma_f32_16x16x32_bf16 v[32:35], a[84:87], v[208:211], v[32:35]
s_waitcnt lgkmcnt(7)
ds_read_b64_tr_b16 a[106:107], v117 offset:10240
v_mul_f32 v88, v88, v24
v_mfma_f32_16x16x32_bf16 v[32:35], a[88:91], v[224:227], v[32:35]
s_waitcnt lgkmcnt(6)
ds_read_b64_tr_b16 a[108:109], v117 offset:12288
v_mul_f32 v89, v89, v24
v_mfma_f32_16x16x32_bf16 v[32:35], a[92:95], v[240:243], v[32:35]
ds_read_b64_tr_b16 a[110:111], v117 offset:14336
v_mul_f32 v90, v90, v24
v_mfma_f32_16x16x32_bf16 v[36:39], a[64:67], v[132:135], 0
ds_read_b64_tr_b16 a[112:113], v117 offset:16384
buffer_load_dwordx4 v113, s[36:39], s81 offen offset:1024 lds
v_mfma_f32_16x16x32_bf16 v[36:39], a[68:71], v[148:151], v[36:39]
ds_read_b64_tr_b16 a[114:115], v117 offset:18432
v_mul_f32 v91, v91, v24
v_mfma_f32_16x16x32_bf16 v[36:39], a[72:75], v[164:167], v[36:39]
ds_read_b64_tr_b16 a[116:117], v117 offset:20480
v_cvt_pk_bf16_f32 v80, v80, v81
v_mfma_f32_16x16x32_bf16 v[36:39], a[76:79], v[180:183], v[36:39]
ds_read_b64_tr_b16 a[118:119], v117 offset:22528
v_cvt_pk_bf16_f32 v81, v82, v83
v_mfma_f32_16x16x32_bf16 v[36:39], a[80:83], v[196:199], v[36:39]
ds_read_b64_tr_b16 a[120:121], v117 offset:24576
v_cvt_pk_bf16_f32 v82, v88, v89
v_mfma_f32_16x16x32_bf16 v[36:39], a[84:87], v[212:215], v[36:39]
ds_read_b64_tr_b16 a[122:123], v117 offset:26624
v_cvt_pk_bf16_f32 v83, v90, v91
v_mfma_f32_16x16x32_bf16 v[36:39], a[88:91], v[228:231], v[36:39]
ds_read_b64_tr_b16 a[124:125], v117 offset:28672
buffer_store_dwordx4 v[80:83], v1, s[4:7], s8 offen offset:3072 sc1
v_mfma_f32_16x16x32_bf16 v[36:39], a[92:95], v[244:247], v[36:39]
s_waitcnt lgkmcnt(8)
ds_read_b64_tr_b16 a[126:127], v117 offset:30720
v_add_u32 v117, 4294901760, v117
v_mfma_f32_16x16x32_bf16 v[40:43], a[96:99], v[128:131], 0
ds_read_b64_tr_b16 a[64:65], v118 offset:0
buffer_load_dwordx4 v114, s[36:39], s81 offen offset:2048 lds
v_mfma_f32_16x16x32_bf16 v[40:43], a[100:103], v[144:147], v[40:43]
ds_read_b64_tr_b16 a[66:67], v118 offset:2048
v_mul_f32 v84, v84, v25
v_mfma_f32_16x16x32_bf16 v[40:43], a[104:107], v[160:163], v[40:43]
s_waitcnt lgkmcnt(8)
ds_read_b64_tr_b16 a[68:69], v118 offset:4096
v_mul_f32 v85, v85, v25
v_mfma_f32_16x16x32_bf16 v[40:43], a[108:111], v[176:179], v[40:43]
ds_read_b64_tr_b16 a[70:71], v118 offset:6144
v_mul_f32 v86, v86, v25
v_mfma_f32_16x16x32_bf16 v[40:43], a[112:115], v[192:195], v[40:43]
s_waitcnt lgkmcnt(8)
ds_read_b64_tr_b16 a[72:73], v118 offset:8192
v_mul_f32 v87, v87, v25
v_mfma_f32_16x16x32_bf16 v[40:43], a[116:119], v[208:211], v[40:43]
s_waitcnt lgkmcnt(7)
ds_read_b64_tr_b16 a[74:75], v118 offset:10240
v_mul_f32 v92, v92, v25
v_mfma_f32_16x16x32_bf16 v[40:43], a[120:123], v[224:227], v[40:43]
s_waitcnt lgkmcnt(6)
ds_read_b64_tr_b16 a[76:77], v118 offset:12288
v_mul_f32 v93, v93, v25
v_mfma_f32_16x16x32_bf16 v[40:43], a[124:127], v[240:243], v[40:43]
ds_read_b64_tr_b16 a[78:79], v118 offset:14336
buffer_load_dwordx4 v115, s[36:39], s81 offen offset:3072 lds
v_mfma_f32_16x16x32_bf16 v[44:47], a[96:99], v[132:135], 0
ds_read_b64_tr_b16 a[80:81], v118 offset:16384
v_mul_f32 v94, v94, v25
v_mfma_f32_16x16x32_bf16 v[44:47], a[100:103], v[148:151], v[44:47]
ds_read_b64_tr_b16 a[82:83], v118 offset:18432
v_mul_f32 v95, v95, v25
v_mfma_f32_16x16x32_bf16 v[44:47], a[104:107], v[164:167], v[44:47]
ds_read_b64_tr_b16 a[84:85], v118 offset:20480
v_cvt_pk_bf16_f32 v84, v84, v85
v_mfma_f32_16x16x32_bf16 v[44:47], a[108:111], v[180:183], v[44:47]
ds_read_b64_tr_b16 a[86:87], v118 offset:22528
v_cvt_pk_bf16_f32 v85, v86, v87
v_mfma_f32_16x16x32_bf16 v[44:47], a[112:115], v[196:199], v[44:47]
ds_read_b64_tr_b16 a[88:89], v118 offset:24576
v_cvt_pk_bf16_f32 v86, v92, v93
v_mfma_f32_16x16x32_bf16 v[44:47], a[116:119], v[212:215], v[44:47]
s_add_u32 s81, s81, 28672
s_add_u32 m0, s18, 36864
ds_read_b64_tr_b16 a[90:91], v118 offset:26624
v_mfma_f32_16x16x32_bf16 v[44:47], a[120:123], v[228:231], v[44:47]
ds_read_b64_tr_b16 a[92:93], v118 offset:28672
buffer_load_dwordx4 v112, s[36:39], s81 offen offset:0 lds
v_mfma_f32_16x16x32_bf16 v[44:47], a[124:127], v[244:247], v[44:47]
s_waitcnt lgkmcnt(8)
ds_read_b64_tr_b16 a[94:95], v118 offset:30720
v_add_u32 v118, 4294901760, v118
v_mfma_f32_16x16x32_bf16 v[48:51], a[64:67], v[128:131], 0
ds_read_b64_tr_b16 a[96:97], v119 offset:0
v_cvt_pk_bf16_f32 v87, v94, v95
v_mfma_f32_16x16x32_bf16 v[48:51], a[68:71], v[144:147], v[48:51]
s_waitcnt lgkmcnt(8)
ds_read_b64_tr_b16 a[98:99], v119 offset:2048
buffer_store_dwordx4 v[84:87], v1, s[4:7], s12 offen offset:3072 sc1
v_mfma_f32_16x16x32_bf16 v[48:51], a[72:75], v[160:163], v[48:51]
s_add_u32 s8, s8, 4096
s_add_u32 s12, s12, 4096
ds_read_b64_tr_b16 a[100:101], v119 offset:4096
v_mfma_f32_16x16x32_bf16 v[48:51], a[76:79], v[176:179], v[48:51]
s_waitcnt lgkmcnt(8)
ds_read_b64_tr_b16 a[102:103], v119 offset:6144
v_mul_f32 v32, v32, v24
v_mfma_f32_16x16x32_bf16 v[48:51], a[80:83], v[192:195], v[48:51]
s_waitcnt lgkmcnt(8)
ds_read_b64_tr_b16 a[104:105], v119 offset:8192
v_mul_f32 v33, v33, v24
v_mfma_f32_16x16x32_bf16 v[48:51], a[84:87], v[208:211], v[48:51]
s_waitcnt lgkmcnt(7)
ds_read_b64_tr_b16 a[106:107], v119 offset:10240
buffer_load_dwordx4 v113, s[36:39], s81 offen offset:1024 lds
v_mfma_f32_16x16x32_bf16 v[48:51], a[88:91], v[224:227], v[48:51]
s_waitcnt lgkmcnt(6)
ds_read_b64_tr_b16 a[108:109], v119 offset:12288
v_mul_f32 v34, v34, v24
v_mfma_f32_16x16x32_bf16 v[48:51], a[92:95], v[240:243], v[48:51]
ds_read_b64_tr_b16 a[110:111], v119 offset:14336
v_mul_f32 v35, v35, v24
v_mfma_f32_16x16x32_bf16 v[52:55], a[64:67], v[132:135], 0
ds_read_b64_tr_b16 a[112:113], v119 offset:16384
v_mul_f32 v40, v40, v24
v_mfma_f32_16x16x32_bf16 v[52:55], a[68:71], v[148:151], v[52:55]
ds_read_b64_tr_b16 a[114:115], v119 offset:18432
v_mul_f32 v41, v41, v24
v_mfma_f32_16x16x32_bf16 v[52:55], a[72:75], v[164:167], v[52:55]
ds_read_b64_tr_b16 a[116:117], v119 offset:20480
v_mul_f32 v42, v42, v24
v_mfma_f32_16x16x32_bf16 v[52:55], a[76:79], v[180:183], v[52:55]
ds_read_b64_tr_b16 a[118:119], v119 offset:22528
v_mul_f32 v43, v43, v24
v_mfma_f32_16x16x32_bf16 v[52:55], a[80:83], v[196:199], v[52:55]
ds_read_b64_tr_b16 a[120:121], v119 offset:24576
buffer_load_dwordx4 v114, s[36:39], s81 offen offset:2048 lds
v_mfma_f32_16x16x32_bf16 v[52:55], a[84:87], v[212:215], v[52:55]
ds_read_b64_tr_b16 a[122:123], v119 offset:26624
v_cvt_pk_bf16_f32 v32, v32, v33
v_mfma_f32_16x16x32_bf16 v[52:55], a[88:91], v[228:231], v[52:55]
ds_read_b64_tr_b16 a[124:125], v119 offset:28672
ds_read_b64_tr_b16 a[126:127], v119 offset:30720
v_mfma_f32_16x16x32_bf16 v[52:55], a[92:95], v[244:247], v[52:55]
s_waitcnt vmcnt(23) lgkmcnt(9)
s_barrier
v_add_u32 v119, 4294901760, v119
v_mfma_f32_16x16x32_bf16 v[56:59], a[96:99], v[128:131], 0
ds_read_b64_tr_b16 a[64:65], v116 offset:0
v_cvt_pk_bf16_f32 v33, v34, v35
v_mfma_f32_16x16x32_bf16 v[56:59], a[100:103], v[144:147], v[56:59]
ds_read_b64_tr_b16 a[66:67], v116 offset:2048
v_cvt_pk_bf16_f32 v34, v40, v41
v_mfma_f32_16x16x32_bf16 v[56:59], a[104:107], v[160:163], v[56:59]
s_waitcnt lgkmcnt(8)
ds_read_b64_tr_b16 a[68:69], v116 offset:4096
v_cvt_pk_bf16_f32 v35, v42, v43
v_mfma_f32_16x16x32_bf16 v[56:59], a[108:111], v[176:179], v[56:59]
ds_read_b64_tr_b16 a[70:71], v116 offset:6144
buffer_load_dwordx4 v115, s[36:39], s81 offen offset:3072 lds
v_mfma_f32_16x16x32_bf16 v[56:59], a[112:115], v[192:195], v[56:59]
s_waitcnt lgkmcnt(8)
ds_read_b64_tr_b16 a[72:73], v116 offset:8192
buffer_store_dwordx4 v[32:35], v1, s[4:7], s8 offen offset:0 sc1
v_mfma_f32_16x16x32_bf16 v[56:59], a[116:119], v[208:211], v[56:59]
PAD_15:
s_cbranch_execz M_tret
s_waitcnt lgkmcnt(7)
ds_read_b64_tr_b16 a[74:75], v116 offset:10240
v_mul_f32 v36, v36, v25
v_mfma_f32_16x16x32_bf16 v[56:59], a[120:123], v[224:227], v[56:59]
s_waitcnt lgkmcnt(6)
ds_read_b64_tr_b16 a[76:77], v116 offset:12288
v_mul_f32 v37, v37, v25
v_mfma_f32_16x16x32_bf16 v[56:59], a[124:127], v[240:243], v[56:59]
ds_read_b64_tr_b16 a[78:79], v116 offset:14336
v_mul_f32 v38, v38, v25
v_mfma_f32_16x16x32_bf16 v[60:63], a[96:99], v[132:135], 0
ds_read_b64_tr_b16 a[80:81], v116 offset:16384
v_mul_f32 v39, v39, v25
v_mfma_f32_16x16x32_bf16 v[60:63], a[100:103], v[148:151], v[60:63]
s_sub_u32 s81, s81, 28544
ds_read_b64_tr_b16 a[82:83], v116 offset:18432
v_mul_f32 v44, v44, v25
v_mfma_f32_16x16x32_bf16 v[60:63], a[104:107], v[164:167], v[60:63]
ds_read_b64_tr_b16 a[84:85], v116 offset:20480
v_mul_f32 v45, v45, v25
v_mfma_f32_16x16x32_bf16 v[60:63], a[108:111], v[180:183], v[60:63]
ds_read_b64_tr_b16 a[86:87], v116 offset:22528
v_mul_f32 v46, v46, v25
v_mfma_f32_16x16x32_bf16 v[60:63], a[112:115], v[196:199], v[60:63]
ds_read_b64_tr_b16 a[88:89], v116 offset:24576
v_mul_f32 v47, v47, v25
v_mfma_f32_16x16x32_bf16 v[60:63], a[116:119], v[212:215], v[60:63]
ds_read_b64_tr_b16 a[90:91], v116 offset:26624
v_cvt_pk_bf16_f32 v36, v36, v37
v_mfma_f32_16x16x32_bf16 v[60:63], a[120:123], v[228:231], v[60:63]
ds_read_b64_tr_b16 a[92:93], v116 offset:28672
v_cvt_pk_bf16_f32 v37, v38, v39
v_mfma_f32_16x16x32_bf16 v[60:63], a[124:127], v[244:247], v[60:63]
s_waitcnt lgkmcnt(8)
ds_read_b64_tr_b16 a[94:95], v116 offset:30720
v_add_u32 v116, 4294901760, v116
v_mfma_f32_16x16x32_bf16 v[64:67], a[64:67], v[128:131], 0
s_add_u32 m0, s18, 98304
ds_read_b64_tr_b16 a[96:97], v117 offset:0
v_cvt_pk_bf16_f32 v38, v44, v45
v_mfma_f32_16x16x32_bf16 v[64:67], a[68:71], v[144:147], v[64:67]
ds_read_b64_tr_b16 a[98:99], v117 offset:2048
buffer_load_dwordx4 v112, s[36:39], s81 offen offset:0 lds
v_mfma_f32_16x16x32_bf16 v[64:67], a[72:75], v[160:163], v[64:67]
s_waitcnt lgkmcnt(8)
ds_read_b64_tr_b16 a[100:101], v117 offset:4096
v_cvt_pk_bf16_f32 v39, v46, v47
v_mfma_f32_16x16x32_bf16 v[64:67], a[76:79], v[176:179], v[64:67]
ds_read_b64_tr_b16 a[102:103], v117 offset:6144
buffer_store_dwordx4 v[36:39], v1, s[4:7], s12 offen offset:0 sc1
v_mfma_f32_16x16x32_bf16 v[64:67], a[80:83], v[192:195], v[64:67]
s_waitcnt lgkmcnt(8)
ds_read_b64_tr_b16 a[104:105], v117 offset:8192
v_mul_f32 v48, v48, v24
v_mfma_f32_16x16x32_bf16 v[64:67], a[84:87], v[208:211], v[64:67]
s_waitcnt lgkmcnt(7)
ds_read_b64_tr_b16 a[106:107], v117 offset:10240
v_mul_f32 v49, v49, v24
v_mfma_f32_16x16x32_bf16 v[64:67], a[88:91], v[224:227], v[64:67]
s_waitcnt lgkmcnt(6)
ds_read_b64_tr_b16 a[108:109], v117 offset:12288
v_mul_f32 v50, v50, v24
v_mfma_f32_16x16x32_bf16 v[64:67], a[92:95], v[240:243], v[64:67]
ds_read_b64_tr_b16 a[110:111], v117 offset:14336
v_mul_f32 v51, v51, v24
v_mfma_f32_16x16x32_bf16 v[68:71], a[64:67], v[132:135], 0
ds_read_b64_tr_b16 a[112:113], v117 offset:16384
buffer_load_dwordx4 v113, s[36:39], s81 offen offset:1024 lds
v_mfma_f32_16x16x32_bf16 v[68:71], a[68:71], v[148:151], v[68:71]
ds_read_b64_tr_b16 a[114:115], v117 offset:18432
v_mul_f32 v56, v56, v24
v_mfma_f32_16x16x32_bf16 v[68:71], a[72:75], v[164:167], v[68:71]
ds_read_b64_tr_b16 a[116:117], v117 offset:20480
v_mul_f32 v57, v57, v24
v_mfma_f32_16x16x32_bf16 v[68:71], a[76:79], v[180:183], v[68:71]
ds_read_b64_tr_b16 a[118:119], v117 offset:22528
v_mul_f32 v58, v58, v24
v_mfma_f32_16x16x32_bf16 v[68:71], a[80:83], v[196:199], v[68:71]
ds_read_b64_tr_b16 a[120:121], v117 offset:24576
v_mul_f32 v59, v59, v24
v_mfma_f32_16x16x32_bf16 v[68:71], a[84:87], v[212:215], v[68:71]
ds_read_b64_tr_b16 a[122:123], v117 offset:26624
v_cvt_pk_bf16_f32 v48, v48, v49
v_mfma_f32_16x16x32_bf16 v[68:71], a[88:91], v[228:231], v[68:71]
ds_read_b64_tr_b16 a[124:125], v117 offset:28672
v_cvt_pk_bf16_f32 v49, v50, v51
v_mfma_f32_16x16x32_bf16 v[68:71], a[92:95], v[244:247], v[68:71]
s_waitcnt lgkmcnt(8)
ds_read_b64_tr_b16 a[126:127], v117 offset:30720
v_add_u32 v117, 4294901760, v117
v_mfma_f32_16x16x32_bf16 v[72:75], a[96:99], v[128:131], 0
ds_read_b64_tr_b16 a[64:65], v118 offset:0
buffer_load_dwordx4 v114, s[36:39], s81 offen offset:2048 lds
v_mfma_f32_16x16x32_bf16 v[72:75], a[100:103], v[144:147], v[72:75]
ds_read_b64_tr_b16 a[66:67], v118 offset:2048
v_cvt_pk_bf16_f32 v50, v56, v57
v_mfma_f32_16x16x32_bf16 v[72:75], a[104:107], v[160:163], v[72:75]
s_waitcnt lgkmcnt(8)
ds_read_b64_tr_b16 a[68:69], v118 offset:4096
v_cvt_pk_bf16_f32 v51, v58, v59
v_mfma_f32_16x16x32_bf16 v[72:75], a[108:111], v[176:179], v[72:75]
ds_read_b64_tr_b16 a[70:71], v118 offset:6144
buffer_store_dwordx4 v[48:51], v1, s[4:7], s8 offen offset:1024 sc1
v_mfma_f32_16x16x32_bf16 v[72:75], a[112:115], v[192:195], v[72:75]
s_waitcnt lgkmcnt(8)
ds_read_b64_tr_b16 a[72:73], v118 offset:8192
v_mul_f32 v52, v52, v25
v_mfma_f32_16x16x32_bf16 v[72:75], a[116:119], v[208:211], v[72:75]
s_waitcnt lgkmcnt(7)
ds_read_b64_tr_b16 a[74:75], v118 offset:10240
v_mul_f32 v53, v53, v25
v_mfma_f32_16x16x32_bf16 v[72:75], a[120:123], v[224:227], v[72:75]
s_waitcnt lgkmcnt(6)
ds_read_b64_tr_b16 a[76:77], v118 offset:12288
v_mul_f32 v54, v54, v25
v_mfma_f32_16x16x32_bf16 v[72:75], a[124:127], v[240:243], v[72:75]
ds_read_b64_tr_b16 a[78:79], v118 offset:14336
buffer_load_dwordx4 v115, s[36:39], s81 offen offset:3072 lds
v_mfma_f32_16x16x32_bf16 v[76:79], a[96:99], v[132:135], 0
ds_read_b64_tr_b16 a[80:81], v118 offset:16384
v_mul_f32 v55, v55, v25
v_mfma_f32_16x16x32_bf16 v[76:79], a[100:103], v[148:151], v[76:79]
ds_read_b64_tr_b16 a[82:83], v118 offset:18432
v_mul_f32 v60, v60, v25
v_mfma_f32_16x16x32_bf16 v[76:79], a[104:107], v[164:167], v[76:79]
ds_read_b64_tr_b16 a[84:85], v118 offset:20480
v_mul_f32 v61, v61, v25
v_mfma_f32_16x16x32_bf16 v[76:79], a[108:111], v[180:183], v[76:79]
ds_read_b64_tr_b16 a[86:87], v118 offset:22528
v_mul_f32 v62, v62, v25
v_mfma_f32_16x16x32_bf16 v[76:79], a[112:115], v[196:199], v[76:79]
ds_read_b64_tr_b16 a[88:89], v118 offset:24576
v_mul_f32 v63, v63, v25
v_mfma_f32_16x16x32_bf16 v[76:79], a[116:119], v[212:215], v[76:79]
s_add_u32 s81, s81, 28672
s_add_u32 m0, s18, 102400
ds_read_b64_tr_b16 a[90:91], v118 offset:26624
v_mfma_f32_16x16x32_bf16 v[76:79], a[120:123], v[228:231], v[76:79]
ds_read_b64_tr_b16 a[92:93], v118 offset:28672
buffer_load_dwordx4 v112, s[36:39], s81 offen offset:0 lds
v_mfma_f32_16x16x32_bf16 v[76:79], a[124:127], v[244:247], v[76:79]
s_waitcnt lgkmcnt(8)
ds_read_b64_tr_b16 a[94:95], v118 offset:30720
v_add_u32 v118, 4294901760, v118
v_mfma_f32_16x16x32_bf16 v[80:83], a[64:67], v[128:131], 0
ds_read_b64_tr_b16 a[96:97], v119 offset:0
v_cvt_pk_bf16_f32 v52, v52, v53
v_mfma_f32_16x16x32_bf16 v[80:83], a[68:71], v[144:147], v[80:83]
ds_read_b64_tr_b16 a[98:99], v119 offset:2048
v_cvt_pk_bf16_f32 v53, v54, v55
v_mfma_f32_16x16x32_bf16 v[80:83], a[72:75], v[160:163], v[80:83]
s_waitcnt lgkmcnt(8)
ds_read_b64_tr_b16 a[100:101], v119 offset:4096
v_cvt_pk_bf16_f32 v54, v60, v61
v_mfma_f32_16x16x32_bf16 v[80:83], a[76:79], v[176:179], v[80:83]
ds_read_b64_tr_b16 a[102:103], v119 offset:6144
v_cvt_pk_bf16_f32 v55, v62, v63
v_mfma_f32_16x16x32_bf16 v[80:83], a[80:83], v[192:195], v[80:83]
s_waitcnt lgkmcnt(8)
ds_read_b64_tr_b16 a[104:105], v119 offset:8192
buffer_store_dwordx4 v[52:55], v1, s[4:7], s12 offen offset:1024 sc1
v_mfma_f32_16x16x32_bf16 v[80:83], a[84:87], v[208:211], v[80:83]
s_waitcnt lgkmcnt(7)
ds_read_b64_tr_b16 a[106:107], v119 offset:10240
buffer_load_dwordx4 v113, s[36:39], s81 offen offset:1024 lds
v_mfma_f32_16x16x32_bf16 v[80:83], a[88:91], v[224:227], v[80:83]
s_waitcnt lgkmcnt(6)
ds_read_b64_tr_b16 a[108:109], v119 offset:12288
v_mul_f32 v64, v64, v24
v_mfma_f32_16x16x32_bf16 v[80:83], a[92:95], v[240:243], v[80:83]
ds_read_b64_tr_b16 a[110:111], v119 offset:14336
v_mul_f32 v65, v65, v24
v_mfma_f32_16x16x32_bf16 v[84:87], a[64:67], v[132:135], 0
ds_read_b64_tr_b16 a[112:113], v119 offset:16384
v_mul_f32 v66, v66, v24
v_mfma_f32_16x16x32_bf16 v[84:87], a[68:71], v[148:151], v[84:87]
ds_read_b64_tr_b16 a[114:115], v119 offset:18432
v_mul_f32 v67, v67, v24
v_mfma_f32_16x16x32_bf16 v[84:87], a[72:75], v[164:167], v[84:87]
ds_read_b64_tr_b16 a[116:117], v119 offset:20480
v_mul_f32 v72, v72, v24
v_mfma_f32_16x16x32_bf16 v[84:87], a[76:79], v[180:183], v[84:87]
ds_read_b64_tr_b16 a[118:119], v119 offset:22528
v_mul_f32 v73, v73, v24
v_mfma_f32_16x16x32_bf16 v[84:87], a[80:83], v[196:199], v[84:87]
ds_read_b64_tr_b16 a[120:121], v119 offset:24576
buffer_load_dwordx4 v114, s[36:39], s81 offen offset:2048 lds
v_mfma_f32_16x16x32_bf16 v[84:87], a[84:87], v[212:215], v[84:87]
ds_read_b64_tr_b16 a[122:123], v119 offset:26624
v_mul_f32 v74, v74, v24
v_mfma_f32_16x16x32_bf16 v[84:87], a[88:91], v[228:231], v[84:87]
ds_read_b64_tr_b16 a[124:125], v119 offset:28672
ds_read_b64_tr_b16 a[126:127], v119 offset:30720
v_mfma_f32_16x16x32_bf16 v[84:87], a[92:95], v[244:247], v[84:87]
s_waitcnt vmcnt(27) lgkmcnt(9)
s_barrier
v_add_u32 v119, 4294901760, v119
v_mfma_f32_16x16x32_bf16 v[88:91], a[96:99], v[128:131], 0
ds_read_b64_tr_b16 a[64:65], v116 offset:0
v_mul_f32 v75, v75, v24
v_mfma_f32_16x16x32_bf16 v[88:91], a[100:103], v[144:147], v[88:91]
ds_read_b64_tr_b16 a[66:67], v116 offset:2048
v_cvt_pk_bf16_f32 v64, v64, v65
v_mfma_f32_16x16x32_bf16 v[88:91], a[104:107], v[160:163], v[88:91]
s_waitcnt lgkmcnt(8)
ds_read_b64_tr_b16 a[68:69], v116 offset:4096
v_cvt_pk_bf16_f32 v65, v66, v67
v_mfma_f32_16x16x32_bf16 v[88:91], a[108:111], v[176:179], v[88:91]
ds_read_b64_tr_b16 a[70:71], v116 offset:6144
buffer_load_dwordx4 v115, s[36:39], s81 offen offset:3072 lds
v_mfma_f32_16x16x32_bf16 v[88:91], a[112:115], v[192:195], v[88:91]
s_waitcnt lgkmcnt(8)
ds_read_b64_tr_b16 a[72:73], v116 offset:8192
v_cvt_pk_bf16_f32 v66, v72, v73
v_mfma_f32_16x16x32_bf16 v[88:91], a[116:119], v[208:211], v[88:91]
s_waitcnt lgkmcnt(7)
ds_read_b64_tr_b16 a[74:75], v116 offset:10240
v_cvt_pk_bf16_f32 v67, v74, v75
v_mfma_f32_16x16x32_bf16 v[88:91], a[120:123], v[224:227], v[88:91]
s_waitcnt lgkmcnt(6)
ds_read_b64_tr_b16 a[76:77], v116 offset:12288
buffer_store_dwordx4 v[64:67], v1, s[4:7], s8 offen offset:2048 sc1
v_mfma_f32_16x16x32_bf16 v[88:91], a[124:127], v[240:243], v[88:91]
ds_read_b64_tr_b16 a[78:79], v116 offset:14336
v_mul_f32 v68, v68, v25
v_mfma_f32_16x16x32_bf16 v[92:95], a[96:99], v[132:135], 0
ds_read_b64_tr_b16 a[80:81], v116 offset:16384
v_mul_f32 v69, v69, v25
v_mfma_f32_16x16x32_bf16 v[92:95], a[100:103], v[148:151], v[92:95]
s_sub_u32 s81, s81, 28544
ds_read_b64_tr_b16 a[82:83], v116 offset:18432
v_mul_f32 v70, v70, v25
v_mfma_f32_16x16x32_bf16 v[92:95], a[104:107], v[164:167], v[92:95]
ds_read_b64_tr_b16 a[84:85], v116 offset:20480
v_mul_f32 v71, v71, v25
v_mfma_f32_16x16x32_bf16 v[92:95], a[108:111], v[180:183], v[92:95]
ds_read_b64_tr_b16 a[86:87], v116 offset:22528
v_mul_f32 v76, v76, v25
v_mfma_f32_16x16x32_bf16 v[92:95], a[112:115], v[196:199], v[92:95]
ds_read_b64_tr_b16 a[88:89], v116 offset:24576
v_mul_f32 v77, v77, v25
v_mfma_f32_16x16x32_bf16 v[92:95], a[116:119], v[212:215], v[92:95]
ds_read_b64_tr_b16 a[90:91], v116 offset:26624
v_mul_f32 v78, v78, v25
v_mfma_f32_16x16x32_bf16 v[92:95], a[120:123], v[228:231], v[92:95]
ds_read_b64_tr_b16 a[92:93], v116 offset:28672
v_mul_f32 v79, v79, v25
v_mfma_f32_16x16x32_bf16 v[92:95], a[124:127], v[244:247], v[92:95]
s_waitcnt lgkmcnt(8)
ds_read_b64_tr_b16 a[94:95], v116 offset:30720
v_add_u32 v116, 32768, v116
v_mfma_f32_16x16x32_bf16 v[32:35], a[64:67], v[128:131], 0
ds_read_b64_tr_b16 a[96:97], v117 offset:0
v_cvt_pk_bf16_f32 v68, v68, v69
v_mfma_f32_16x16x32_bf16 v[32:35], a[68:71], v[144:147], v[32:35]
ds_read_b64_tr_b16 a[98:99], v117 offset:2048
v_cvt_pk_bf16_f32 v69, v70, v71
v_mfma_f32_16x16x32_bf16 v[32:35], a[72:75], v[160:163], v[32:35]
s_waitcnt lgkmcnt(8)
ds_read_b64_tr_b16 a[100:101], v117 offset:4096
v_cvt_pk_bf16_f32 v70, v76, v77
v_mfma_f32_16x16x32_bf16 v[32:35], a[76:79], v[176:179], v[32:35]
ds_read_b64_tr_b16 a[102:103], v117 offset:6144
v_cvt_pk_bf16_f32 v71, v78, v79
v_mfma_f32_16x16x32_bf16 v[32:35], a[80:83], v[192:195], v[32:35]
s_waitcnt lgkmcnt(8)
ds_read_b64_tr_b16 a[104:105], v117 offset:8192
buffer_store_dwordx4 v[68:71], v1, s[4:7], s12 offen offset:2048 sc1
v_mfma_f32_16x16x32_bf16 v[32:35], a[84:87], v[208:211], v[32:35]
s_waitcnt lgkmcnt(7)
ds_read_b64_tr_b16 a[106:107], v117 offset:10240
v_mul_f32 v80, v80, v24
v_mfma_f32_16x16x32_bf16 v[32:35], a[88:91], v[224:227], v[32:35]
s_waitcnt lgkmcnt(6)
ds_read_b64_tr_b16 a[108:109], v117 offset:12288
v_mul_f32 v81, v81, v24
v_mfma_f32_16x16x32_bf16 v[32:35], a[92:95], v[240:243], v[32:35]
ds_read_b64_tr_b16 a[110:111], v117 offset:14336
v_mul_f32 v82, v82, v24
v_mfma_f32_16x16x32_bf16 v[36:39], a[64:67], v[132:135], 0
ds_read_b64_tr_b16 a[112:113], v117 offset:16384
v_mul_f32 v83, v83, v24
v_mfma_f32_16x16x32_bf16 v[36:39], a[68:71], v[148:151], v[36:39]
ds_read_b64_tr_b16 a[114:115], v117 offset:18432
v_mul_f32 v88, v88, v24
v_mfma_f32_16x16x32_bf16 v[36:39], a[72:75], v[164:167], v[36:39]
ds_read_b64_tr_b16 a[116:117], v117 offset:20480
v_mul_f32 v89, v89, v24
v_mfma_f32_16x16x32_bf16 v[36:39], a[76:79], v[180:183], v[36:39]
ds_read_b64_tr_b16 a[118:119], v117 offset:22528
v_mul_f32 v90, v90, v24
v_mfma_f32_16x16x32_bf16 v[36:39], a[80:83], v[196:199], v[36:39]
ds_read_b64_tr_b16 a[120:121], v117 offset:24576
v_mul_f32 v91, v91, v24
v_mfma_f32_16x16x32_bf16 v[36:39], a[84:87], v[212:215], v[36:39]
ds_read_b64_tr_b16 a[122:123], v117 offset:26624
v_cvt_pk_bf16_f32 v80, v80, v81
v_mfma_f32_16x16x32_bf16 v[36:39], a[88:91], v[228:231], v[36:39]
ds_read_b64_tr_b16 a[124:125], v117 offset:28672
v_cvt_pk_bf16_f32 v81, v82, v83
v_mfma_f32_16x16x32_bf16 v[36:39], a[92:95], v[244:247], v[36:39]
s_waitcnt lgkmcnt(8)
ds_read_b64_tr_b16 a[126:127], v117 offset:30720
v_add_u32 v117, 32768, v117
v_mfma_f32_16x16x32_bf16 v[40:43], a[96:99], v[128:131], 0
ds_read_b64_tr_b16 a[64:65], v118 offset:0
v_cvt_pk_bf16_f32 v82, v88, v89
v_mfma_f32_16x16x32_bf16 v[40:43], a[100:103], v[144:147], v[40:43]
ds_read_b64_tr_b16 a[66:67], v118 offset:2048
v_cvt_pk_bf16_f32 v83, v90, v91
v_mfma_f32_16x16x32_bf16 v[40:43], a[104:107], v[160:163], v[40:43]
s_waitcnt lgkmcnt(8)
ds_read_b64_tr_b16 a[68:69], v118 offset:4096
buffer_store_dwordx4 v[80:83], v1, s[4:7], s8 offen offset:3072 sc1
v_mfma_f32_16x16x32_bf16 v[40:43], a[108:111], v[176:179], v[40:43]
ds_read_b64_tr_b16 a[70:71], v118 offset:6144
v_mul_f32 v84, v84, v25
v_mfma_f32_16x16x32_bf16 v[40:43], a[112:115], v[192:195], v[40:43]
s_waitcnt lgkmcnt(8)
ds_read_b64_tr_b16 a[72:73], v118 offset:8192
v_mul_f32 v85, v85, v25
v_mfma_f32_16x16x32_bf16 v[40:43], a[116:119], v[208:211], v[40:43]
s_waitcnt lgkmcnt(7)
ds_read_b64_tr_b16 a[74:75], v118 offset:10240
v_mul_f32 v86, v86, v25
v_mfma_f32_16x16x32_bf16 v[40:43], a[120:123], v[224:227], v[40:43]
s_waitcnt lgkmcnt(6)
ds_read_b64_tr_b16 a[76:77], v118 offset:12288
v_mul_f32 v87, v87, v25
v_mfma_f32_16x16x32_bf16 v[40:43], a[124:127], v[240:243], v[40:43]
ds_read_b64_tr_b16 a[78:79], v118 offset:14336
v_mul_f32 v92, v92, v25
v_mfma_f32_16x16x32_bf16 v[44:47], a[96:99], v[132:135], 0
ds_read_b64_tr_b16 a[80:81], v118 offset:16384
v_mul_f32 v93, v93, v25
v_mfma_f32_16x16x32_bf16 v[44:47], a[100:103], v[148:151], v[44:47]
ds_read_b64_tr_b16 a[82:83], v118 offset:18432
v_mul_f32 v94, v94, v25
v_mfma_f32_16x16x32_bf16 v[44:47], a[104:107], v[164:167], v[44:47]
ds_read_b64_tr_b16 a[84:85], v118 offset:20480
v_mul_f32 v95, v95, v25
v_mfma_f32_16x16x32_bf16 v[44:47], a[108:111], v[180:183], v[44:47]
ds_read_b64_tr_b16 a[86:87], v118 offset:22528
v_cvt_pk_bf16_f32 v84, v84, v85
v_mfma_f32_16x16x32_bf16 v[44:47], a[112:115], v[196:199], v[44:47]
ds_read_b64_tr_b16 a[88:89], v118 offset:24576
v_cvt_pk_bf16_f32 v85, v86, v87
v_mfma_f32_16x16x32_bf16 v[44:47], a[116:119], v[212:215], v[44:47]
ds_read_b64_tr_b16 a[90:91], v118 offset:26624
v_cvt_pk_bf16_f32 v86, v92, v93
v_mfma_f32_16x16x32_bf16 v[44:47], a[120:123], v[228:231], v[44:47]
ds_read_b64_tr_b16 a[92:93], v118 offset:28672
v_cvt_pk_bf16_f32 v87, v94, v95
v_mfma_f32_16x16x32_bf16 v[44:47], a[124:127], v[244:247], v[44:47]
s_waitcnt lgkmcnt(8)
ds_read_b64_tr_b16 a[94:95], v118 offset:30720
v_add_u32 v118, 32768, v118
v_mfma_f32_16x16x32_bf16 v[48:51], a[64:67], v[128:131], 0
ds_read_b64_tr_b16 a[96:97], v119 offset:0
buffer_store_dwordx4 v[84:87], v1, s[4:7], s12 offen offset:3072 sc1
v_mfma_f32_16x16x32_bf16 v[48:51], a[68:71], v[144:147], v[48:51]
s_add_u32 s8, s8, 4096
s_add_u32 s12, s12, 4096
ds_read_b64_tr_b16 a[98:99], v119 offset:2048
v_mfma_f32_16x16x32_bf16 v[48:51], a[72:75], v[160:163], v[48:51]
s_waitcnt lgkmcnt(8)
ds_read_b64_tr_b16 a[100:101], v119 offset:4096
v_mul_f32 v32, v32, v24
v_mfma_f32_16x16x32_bf16 v[48:51], a[76:79], v[176:179], v[48:51]
ds_read_b64_tr_b16 a[102:103], v119 offset:6144
v_mul_f32 v33, v33, v24
v_mfma_f32_16x16x32_bf16 v[48:51], a[80:83], v[192:195], v[48:51]
s_waitcnt lgkmcnt(8)
ds_read_b64_tr_b16 a[104:105], v119 offset:8192
v_mul_f32 v34, v34, v24
v_mfma_f32_16x16x32_bf16 v[48:51], a[84:87], v[208:211], v[48:51]
s_waitcnt lgkmcnt(7)
ds_read_b64_tr_b16 a[106:107], v119 offset:10240
v_mul_f32 v35, v35, v24
v_mfma_f32_16x16x32_bf16 v[48:51], a[88:91], v[224:227], v[48:51]
s_waitcnt lgkmcnt(6)
ds_read_b64_tr_b16 a[108:109], v119 offset:12288
v_mul_f32 v40, v40, v24
v_mfma_f32_16x16x32_bf16 v[48:51], a[92:95], v[240:243], v[48:51]
ds_read_b64_tr_b16 a[110:111], v119 offset:14336
v_mul_f32 v41, v41, v24
v_mfma_f32_16x16x32_bf16 v[52:55], a[64:67], v[132:135], 0
ds_read_b64_tr_b16 a[112:113], v119 offset:16384
v_mul_f32 v42, v42, v24
v_mfma_f32_16x16x32_bf16 v[52:55], a[68:71], v[148:151], v[52:55]
ds_read_b64_tr_b16 a[114:115], v119 offset:18432
v_mul_f32 v43, v43, v24
v_mfma_f32_16x16x32_bf16 v[52:55], a[72:75], v[164:167], v[52:55]
ds_read_b64_tr_b16 a[116:117], v119 offset:20480
v_cvt_pk_bf16_f32 v32, v32, v33
v_mfma_f32_16x16x32_bf16 v[52:55], a[76:79], v[180:183], v[52:55]
ds_read_b64_tr_b16 a[118:119], v119 offset:22528
v_cvt_pk_bf16_f32 v33, v34, v35
v_mfma_f32_16x16x32_bf16 v[52:55], a[80:83], v[196:199], v[52:55]
ds_read_b64_tr_b16 a[120:121], v119 offset:24576
v_cvt_pk_bf16_f32 v34, v40, v41
v_mfma_f32_16x16x32_bf16 v[52:55], a[84:87], v[212:215], v[52:55]
ds_read_b64_tr_b16 a[122:123], v119 offset:26624
v_cvt_pk_bf16_f32 v35, v42, v43
v_mfma_f32_16x16x32_bf16 v[52:55], a[88:91], v[228:231], v[52:55]
ds_read_b64_tr_b16 a[124:125], v119 offset:28672
ds_read_b64_tr_b16 a[126:127], v119 offset:30720
v_mfma_f32_16x16x32_bf16 v[52:55], a[92:95], v[244:247], v[52:55]
s_waitcnt vmcnt(16) lgkmcnt(9)
s_barrier
v_add_u32 v119, 32768, v119
v_mfma_f32_16x16x32_bf16 v[56:59], a[96:99], v[128:131], 0
ds_read_b64_tr_b16 a[64:65], v116 offset:0
buffer_store_dwordx4 v[32:35], v1, s[4:7], s8 offen offset:0 sc1
v_mfma_f32_16x16x32_bf16 v[56:59], a[100:103], v[144:147], v[56:59]
ds_read_b64_tr_b16 a[66:67], v116 offset:2048
v_mul_f32 v36, v36, v25
v_mfma_f32_16x16x32_bf16 v[56:59], a[104:107], v[160:163], v[56:59]
s_waitcnt lgkmcnt(8)
ds_read_b64_tr_b16 a[68:69], v116 offset:4096
v_mul_f32 v37, v37, v25
v_mfma_f32_16x16x32_bf16 v[56:59], a[108:111], v[176:179], v[56:59]
ds_read_b64_tr_b16 a[70:71], v116 offset:6144
v_mul_f32 v38, v38, v25
v_mfma_f32_16x16x32_bf16 v[56:59], a[112:115], v[192:195], v[56:59]
s_waitcnt lgkmcnt(8)
ds_read_b64_tr_b16 a[72:73], v116 offset:8192
v_mul_f32 v39, v39, v25
v_mfma_f32_16x16x32_bf16 v[56:59], a[116:119], v[208:211], v[56:59]
s_waitcnt lgkmcnt(7)
ds_read_b64_tr_b16 a[74:75], v116 offset:10240
v_mul_f32 v44, v44, v25
v_mfma_f32_16x16x32_bf16 v[56:59], a[120:123], v[224:227], v[56:59]
s_waitcnt lgkmcnt(6)
ds_read_b64_tr_b16 a[76:77], v116 offset:12288
v_mul_f32 v45, v45, v25
v_mfma_f32_16x16x32_bf16 v[56:59], a[124:127], v[240:243], v[56:59]
ds_read_b64_tr_b16 a[78:79], v116 offset:14336
v_mul_f32 v46, v46, v25
v_mfma_f32_16x16x32_bf16 v[60:63], a[96:99], v[132:135], 0
ds_read_b64_tr_b16 a[80:81], v116 offset:16384
v_mul_f32 v47, v47, v25
v_mfma_f32_16x16x32_bf16 v[60:63], a[100:103], v[148:151], v[60:63]
ds_read_b64_tr_b16 a[82:83], v116 offset:18432
v_cvt_pk_bf16_f32 v36, v36, v37
v_mfma_f32_16x16x32_bf16 v[60:63], a[104:107], v[164:167], v[60:63]
ds_read_b64_tr_b16 a[84:85], v116 offset:20480
v_cvt_pk_bf16_f32 v37, v38, v39
v_mfma_f32_16x16x32_bf16 v[60:63], a[108:111], v[180:183], v[60:63]
ds_read_b64_tr_b16 a[86:87], v116 offset:22528
v_cvt_pk_bf16_f32 v38, v44, v45
v_mfma_f32_16x16x32_bf16 v[60:63], a[112:115], v[196:199], v[60:63]
ds_read_b64_tr_b16 a[88:89], v116 offset:24576
v_cvt_pk_bf16_f32 v39, v46, v47
v_mfma_f32_16x16x32_bf16 v[60:63], a[116:119], v[212:215], v[60:63]
ds_read_b64_tr_b16 a[90:91], v116 offset:26624
buffer_store_dwordx4 v[36:39], v1, s[4:7], s12 offen offset:0 sc1
v_mfma_f32_16x16x32_bf16 v[60:63], a[120:123], v[228:231], v[60:63]
ds_read_b64_tr_b16 a[92:93], v116 offset:28672
v_mfma_f32_16x16x32_bf16 v[60:63], a[124:127], v[244:247], v[60:63]
s_waitcnt lgkmcnt(8)
ds_read_b64_tr_b16 a[94:95], v116 offset:30720
v_add_u32 v116, 65536, v116
v_mfma_f32_16x16x32_bf16 v[64:67], a[64:67], v[128:131], 0
ds_read_b64_tr_b16 a[96:97], v117 offset:0
v_mul_f32 v48, v48, v24
v_mfma_f32_16x16x32_bf16 v[64:67], a[68:71], v[144:147], v[64:67]
ds_read_b64_tr_b16 a[98:99], v117 offset:2048
v_mul_f32 v49, v49, v24
v_mfma_f32_16x16x32_bf16 v[64:67], a[72:75], v[160:163], v[64:67]
s_waitcnt lgkmcnt(8)
ds_read_b64_tr_b16 a[100:101], v117 offset:4096
v_mul_f32 v50, v50, v24
v_mfma_f32_16x16x32_bf16 v[64:67], a[76:79], v[176:179], v[64:67]
ds_read_b64_tr_b16 a[102:103], v117 offset:6144
v_mul_f32 v51, v51, v24
v_mfma_f32_16x16x32_bf16 v[64:67], a[80:83], v[192:195], v[64:67]
s_waitcnt lgkmcnt(8)
ds_read_b64_tr_b16 a[104:105], v117 offset:8192
v_mul_f32 v56, v56, v24
v_mfma_f32_16x16x32_bf16 v[64:67], a[84:87], v[208:211], v[64:67]
s_waitcnt lgkmcnt(7)
ds_read_b64_tr_b16 a[106:107], v117 offset:10240
v_mul_f32 v57, v57, v24
v_mfma_f32_16x16x32_bf16 v[64:67], a[88:91], v[224:227], v[64:67]
s_waitcnt lgkmcnt(6)
ds_read_b64_tr_b16 a[108:109], v117 offset:12288
v_mul_f32 v58, v58, v24
v_mfma_f32_16x16x32_bf16 v[64:67], a[92:95], v[240:243], v[64:67]
ds_read_b64_tr_b16 a[110:111], v117 offset:14336
v_mul_f32 v59, v59, v24
v_mfma_f32_16x16x32_bf16 v[68:71], a[64:67], v[132:135], 0
ds_read_b64_tr_b16 a[112:113], v117 offset:16384
v_cvt_pk_bf16_f32 v48, v48, v49
v_mfma_f32_16x16x32_bf16 v[68:71], a[68:71], v[148:151], v[68:71]
ds_read_b64_tr_b16 a[114:115], v117 offset:18432
v_cvt_pk_bf16_f32 v49, v50, v51
v_mfma_f32_16x16x32_bf16 v[68:71], a[72:75], v[164:167], v[68:71]
ds_read_b64_tr_b16 a[116:117], v117 offset:20480
v_cvt_pk_bf16_f32 v50, v56, v57
v_mfma_f32_16x16x32_bf16 v[68:71], a[76:79], v[180:183], v[68:71]
ds_read_b64_tr_b16 a[118:119], v117 offset:22528
v_cvt_pk_bf16_f32 v51, v58, v59
v_mfma_f32_16x16x32_bf16 v[68:71], a[80:83], v[196:199], v[68:71]
ds_read_b64_tr_b16 a[120:121], v117 offset:24576
buffer_store_dwordx4 v[48:51], v1, s[4:7], s8 offen offset:1024 sc1
v_mfma_f32_16x16x32_bf16 v[68:71], a[84:87], v[212:215], v[68:71]
ds_read_b64_tr_b16 a[122:123], v117 offset:26624
v_mul_f32 v52, v52, v25
v_mfma_f32_16x16x32_bf16 v[68:71], a[88:91], v[228:231], v[68:71]
ds_read_b64_tr_b16 a[124:125], v117 offset:28672
v_mul_f32 v53, v53, v25
v_mfma_f32_16x16x32_bf16 v[68:71], a[92:95], v[244:247], v[68:71]
s_waitcnt lgkmcnt(8)
ds_read_b64_tr_b16 a[126:127], v117 offset:30720
v_add_u32 v117, 65536, v117
v_mfma_f32_16x16x32_bf16 v[72:75], a[96:99], v[128:131], 0
ds_read_b64_tr_b16 a[64:65], v118 offset:0
v_mul_f32 v54, v54, v25
v_mfma_f32_16x16x32_bf16 v[72:75], a[100:103], v[144:147], v[72:75]
ds_read_b64_tr_b16 a[66:67], v118 offset:2048
v_mul_f32 v55, v55, v25
v_mfma_f32_16x16x32_bf16 v[72:75], a[104:107], v[160:163], v[72:75]
s_waitcnt lgkmcnt(8)
ds_read_b64_tr_b16 a[68:69], v118 offset:4096
v_mul_f32 v60, v60, v25
v_mfma_f32_16x16x32_bf16 v[72:75], a[108:111], v[176:179], v[72:75]
ds_read_b64_tr_b16 a[70:71], v118 offset:6144
v_mul_f32 v61, v61, v25
v_mfma_f32_16x16x32_bf16 v[72:75], a[112:115], v[192:195], v[72:75]
s_waitcnt lgkmcnt(8)
ds_read_b64_tr_b16 a[72:73], v118 offset:8192
v_mul_f32 v62, v62, v25
v_mfma_f32_16x16x32_bf16 v[72:75], a[116:119], v[208:211], v[72:75]
s_waitcnt lgkmcnt(7)
ds_read_b64_tr_b16 a[74:75], v118 offset:10240
v_mul_f32 v63, v63, v25
v_mfma_f32_16x16x32_bf16 v[72:75], a[120:123], v[224:227], v[72:75]
s_waitcnt lgkmcnt(6)
ds_read_b64_tr_b16 a[76:77], v118 offset:12288
v_cvt_pk_bf16_f32 v52, v52, v53
v_mfma_f32_16x16x32_bf16 v[72:75], a[124:127], v[240:243], v[72:75]
ds_read_b64_tr_b16 a[78:79], v118 offset:14336
v_cvt_pk_bf16_f32 v53, v54, v55
v_mfma_f32_16x16x32_bf16 v[76:79], a[96:99], v[132:135], 0
ds_read_b64_tr_b16 a[80:81], v118 offset:16384
v_cvt_pk_bf16_f32 v54, v60, v61
v_mfma_f32_16x16x32_bf16 v[76:79], a[100:103], v[148:151], v[76:79]
ds_read_b64_tr_b16 a[82:83], v118 offset:18432
v_cvt_pk_bf16_f32 v55, v62, v63
v_mfma_f32_16x16x32_bf16 v[76:79], a[104:107], v[164:167], v[76:79]
ds_read_b64_tr_b16 a[84:85], v118 offset:20480
buffer_store_dwordx4 v[52:55], v1, s[4:7], s12 offen offset:1024 sc1
v_mfma_f32_16x16x32_bf16 v[76:79], a[108:111], v[180:183], v[76:79]
ds_read_b64_tr_b16 a[86:87], v118 offset:22528
v_mul_u32_u24 v21, 1792, v19
v_mfma_f32_16x16x32_bf16 v[76:79], a[112:115], v[196:199], v[76:79]
ds_read_b64_tr_b16 a[88:89], v118 offset:24576
v_mul_f32 v64, v64, v24
v_mfma_f32_16x16x32_bf16 v[76:79], a[116:119], v[212:215], v[76:79]
ds_read_b64_tr_b16 a[90:91], v118 offset:26624
v_mul_f32 v65, v65, v24
v_mfma_f32_16x16x32_bf16 v[76:79], a[120:123], v[228:231], v[76:79]
ds_read_b64_tr_b16 a[92:93], v118 offset:28672
v_mul_f32 v66, v66, v24
v_mfma_f32_16x16x32_bf16 v[76:79], a[124:127], v[244:247], v[76:79]
s_waitcnt lgkmcnt(8)
ds_read_b64_tr_b16 a[94:95], v118 offset:30720
v_add_u32 v118, 65536, v118
v_mfma_f32_16x16x32_bf16 v[80:83], a[64:67], v[128:131], 0
ds_read_b64_tr_b16 a[96:97], v119 offset:0
v_mul_f32 v67, v67, v24
v_mfma_f32_16x16x32_bf16 v[80:83], a[68:71], v[144:147], v[80:83]
ds_read_b64_tr_b16 a[98:99], v119 offset:2048
v_mul_f32 v72, v72, v24
v_mfma_f32_16x16x32_bf16 v[80:83], a[72:75], v[160:163], v[80:83]
s_waitcnt lgkmcnt(8)
ds_read_b64_tr_b16 a[100:101], v119 offset:4096
v_mul_f32 v73, v73, v24
v_mfma_f32_16x16x32_bf16 v[80:83], a[76:79], v[176:179], v[80:83]
ds_read_b64_tr_b16 a[102:103], v119 offset:6144
v_mul_f32 v74, v74, v24
v_mfma_f32_16x16x32_bf16 v[80:83], a[80:83], v[192:195], v[80:83]
PAD_16:
s_cbranch_execz M_tret
s_waitcnt lgkmcnt(8)
ds_read_b64_tr_b16 a[104:105], v119 offset:8192
v_mul_f32 v75, v75, v24
v_mfma_f32_16x16x32_bf16 v[80:83], a[84:87], v[208:211], v[80:83]
s_waitcnt lgkmcnt(7)
ds_read_b64_tr_b16 a[106:107], v119 offset:10240
v_cvt_pk_bf16_f32 v64, v64, v65
v_mfma_f32_16x16x32_bf16 v[80:83], a[88:91], v[224:227], v[80:83]
s_waitcnt lgkmcnt(6)
ds_read_b64_tr_b16 a[108:109], v119 offset:12288
v_cvt_pk_bf16_f32 v65, v66, v67
v_mfma_f32_16x16x32_bf16 v[80:83], a[92:95], v[240:243], v[80:83]
ds_read_b64_tr_b16 a[110:111], v119 offset:14336
v_cvt_pk_bf16_f32 v66, v72, v73
v_mfma_f32_16x16x32_bf16 v[84:87], a[64:67], v[132:135], 0
ds_read_b64_tr_b16 a[112:113], v119 offset:16384
v_cvt_pk_bf16_f32 v67, v74, v75
v_mfma_f32_16x16x32_bf16 v[84:87], a[68:71], v[148:151], v[84:87]
ds_read_b64_tr_b16 a[114:115], v119 offset:18432
buffer_store_dwordx4 v[64:67], v1, s[4:7], s8 offen offset:2048 sc1
v_mfma_f32_16x16x32_bf16 v[84:87], a[72:75], v[164:167], v[84:87]
ds_read_b64_tr_b16 a[116:117], v119 offset:20480
v_mul_f32 v68, v68, v25
v_mfma_f32_16x16x32_bf16 v[84:87], a[76:79], v[180:183], v[84:87]
ds_read_b64_tr_b16 a[118:119], v119 offset:22528
v_mul_f32 v69, v69, v25
v_mfma_f32_16x16x32_bf16 v[84:87], a[80:83], v[196:199], v[84:87]
ds_read_b64_tr_b16 a[120:121], v119 offset:24576
v_mul_f32 v70, v70, v25
v_mfma_f32_16x16x32_bf16 v[84:87], a[84:87], v[212:215], v[84:87]
ds_read_b64_tr_b16 a[122:123], v119 offset:26624
v_mul_f32 v71, v71, v25
v_mfma_f32_16x16x32_bf16 v[84:87], a[88:91], v[228:231], v[84:87]
ds_read_b64_tr_b16 a[124:125], v119 offset:28672
ds_read_b64_tr_b16 a[126:127], v119 offset:30720
v_mfma_f32_16x16x32_bf16 v[84:87], a[92:95], v[244:247], v[84:87]
s_waitcnt vmcnt(7) lgkmcnt(9)
s_barrier
v_add_u32 v119, 65536, v119
v_mfma_f32_16x16x32_bf16 v[88:91], a[96:99], v[128:131], 0
ds_read_b64_tr_b16 a[64:65], v116 offset:0
v_mul_f32 v76, v76, v25
v_mfma_f32_16x16x32_bf16 v[88:91], a[100:103], v[144:147], v[88:91]
ds_read_b64_tr_b16 a[66:67], v116 offset:2048
buffer_store_dword v6, v5, s[4:7], s34 offen sc1
v_mfma_f32_16x16x32_bf16 v[88:91], a[104:107], v[160:163], v[88:91]
s_waitcnt lgkmcnt(8)
ds_read_b64_tr_b16 a[68:69], v116 offset:4096
v_mul_f32 v77, v77, v25
v_mfma_f32_16x16x32_bf16 v[88:91], a[108:111], v[176:179], v[88:91]
ds_read_b64_tr_b16 a[70:71], v116 offset:6144
v_mul_f32 v78, v78, v25
v_mfma_f32_16x16x32_bf16 v[88:91], a[112:115], v[192:195], v[88:91]
s_waitcnt lgkmcnt(8)
ds_read_b64_tr_b16 a[72:73], v116 offset:8192
v_mul_f32 v79, v79, v25
v_mfma_f32_16x16x32_bf16 v[88:91], a[116:119], v[208:211], v[88:91]
s_waitcnt lgkmcnt(7)
ds_read_b64_tr_b16 a[74:75], v116 offset:10240
v_cvt_pk_bf16_f32 v68, v68, v69
v_mfma_f32_16x16x32_bf16 v[88:91], a[120:123], v[224:227], v[88:91]
s_waitcnt lgkmcnt(6)
ds_read_b64_tr_b16 a[76:77], v116 offset:12288
v_cvt_pk_bf16_f32 v69, v70, v71
v_mfma_f32_16x16x32_bf16 v[88:91], a[124:127], v[240:243], v[88:91]
ds_read_b64_tr_b16 a[78:79], v116 offset:14336
v_cvt_pk_bf16_f32 v70, v76, v77
v_mfma_f32_16x16x32_bf16 v[92:95], a[96:99], v[132:135], 0
ds_read_b64_tr_b16 a[80:81], v116 offset:16384
v_cvt_pk_bf16_f32 v71, v78, v79
v_mfma_f32_16x16x32_bf16 v[92:95], a[100:103], v[148:151], v[92:95]
ds_read_b64_tr_b16 a[82:83], v116 offset:18432
buffer_store_dwordx4 v[68:71], v1, s[4:7], s12 offen offset:2048 sc1
v_mfma_f32_16x16x32_bf16 v[92:95], a[104:107], v[164:167], v[92:95]
ds_read_b64_tr_b16 a[84:85], v116 offset:20480
v_lshlrev_b32 v19, 2, v19
v_mfma_f32_16x16x32_bf16 v[92:95], a[108:111], v[180:183], v[92:95]
ds_read_b64_tr_b16 a[86:87], v116 offset:22528
v_mfma_f32_16x16x32_bf16 v[92:95], a[112:115], v[196:199], v[92:95]
ds_read_b64_tr_b16 a[88:89], v116 offset:24576
v_mfma_f32_16x16x32_bf16 v[92:95], a[116:119], v[212:215], v[92:95]
ds_read_b64_tr_b16 a[90:91], v116 offset:26624
v_mfma_f32_16x16x32_bf16 v[92:95], a[120:123], v[228:231], v[92:95]
ds_read_b64_tr_b16 a[92:93], v116 offset:28672
v_mfma_f32_16x16x32_bf16 v[92:95], a[124:127], v[244:247], v[92:95]
s_waitcnt lgkmcnt(8)
ds_read_b64_tr_b16 a[94:95], v116 offset:30720
v_mfma_f32_16x16x32_bf16 v[32:35], a[64:67], v[128:131], 0
ds_read_b64_tr_b16 a[96:97], v117 offset:0
v_mul_f32 v80, v80, v24
v_mfma_f32_16x16x32_bf16 v[32:35], a[68:71], v[144:147], v[32:35]
ds_read_b64_tr_b16 a[98:99], v117 offset:2048
v_mul_f32 v81, v81, v24
v_mfma_f32_16x16x32_bf16 v[32:35], a[72:75], v[160:163], v[32:35]
s_waitcnt lgkmcnt(8)
ds_read_b64_tr_b16 a[100:101], v117 offset:4096
v_mul_f32 v82, v82, v24
v_mfma_f32_16x16x32_bf16 v[32:35], a[76:79], v[176:179], v[32:35]
ds_read_b64_tr_b16 a[102:103], v117 offset:6144
v_mul_f32 v83, v83, v24
v_mfma_f32_16x16x32_bf16 v[32:35], a[80:83], v[192:195], v[32:35]
s_waitcnt lgkmcnt(8)
ds_read_b64_tr_b16 a[104:105], v117 offset:8192
v_mul_f32 v88, v88, v24
v_mfma_f32_16x16x32_bf16 v[32:35], a[84:87], v[208:211], v[32:35]
s_waitcnt lgkmcnt(7)
ds_read_b64_tr_b16 a[106:107], v117 offset:10240
v_mul_f32 v89, v89, v24
v_mfma_f32_16x16x32_bf16 v[32:35], a[88:91], v[224:227], v[32:35]
s_waitcnt lgkmcnt(6)
ds_read_b64_tr_b16 a[108:109], v117 offset:12288
v_mul_f32 v90, v90, v24
v_mfma_f32_16x16x32_bf16 v[32:35], a[92:95], v[240:243], v[32:35]
ds_read_b64_tr_b16 a[110:111], v117 offset:14336
v_mul_f32 v91, v91, v24
v_mfma_f32_16x16x32_bf16 v[36:39], a[64:67], v[132:135], 0
ds_read_b64_tr_b16 a[112:113], v117 offset:16384
v_cvt_pk_bf16_f32 v80, v80, v81
v_mfma_f32_16x16x32_bf16 v[36:39], a[68:71], v[148:151], v[36:39]
ds_read_b64_tr_b16 a[114:115], v117 offset:18432
v_cvt_pk_bf16_f32 v81, v82, v83
v_mfma_f32_16x16x32_bf16 v[36:39], a[72:75], v[164:167], v[36:39]
ds_read_b64_tr_b16 a[116:117], v117 offset:20480
v_cvt_pk_bf16_f32 v82, v88, v89
v_mfma_f32_16x16x32_bf16 v[36:39], a[76:79], v[180:183], v[36:39]
ds_read_b64_tr_b16 a[118:119], v117 offset:22528
v_cvt_pk_bf16_f32 v83, v90, v91
v_mfma_f32_16x16x32_bf16 v[36:39], a[80:83], v[196:199], v[36:39]
ds_read_b64_tr_b16 a[120:121], v117 offset:24576
buffer_store_dwordx4 v[80:83], v1, s[4:7], s8 offen offset:3072 sc1
v_mfma_f32_16x16x32_bf16 v[36:39], a[84:87], v[212:215], v[36:39]
ds_read_b64_tr_b16 a[122:123], v117 offset:26624
v_mul_f32 v84, v84, v25
v_mfma_f32_16x16x32_bf16 v[36:39], a[88:91], v[228:231], v[36:39]
ds_read_b64_tr_b16 a[124:125], v117 offset:28672
v_mul_f32 v85, v85, v25
v_mfma_f32_16x16x32_bf16 v[36:39], a[92:95], v[244:247], v[36:39]
s_waitcnt lgkmcnt(8)
ds_read_b64_tr_b16 a[126:127], v117 offset:30720
v_mul_f32 v86, v86, v25
v_mfma_f32_16x16x32_bf16 v[40:43], a[96:99], v[128:131], 0
ds_read_b64_tr_b16 a[64:65], v118 offset:0
v_mul_f32 v87, v87, v25
v_mfma_f32_16x16x32_bf16 v[40:43], a[100:103], v[144:147], v[40:43]
ds_read_b64_tr_b16 a[66:67], v118 offset:2048
v_mul_f32 v92, v92, v25
v_mfma_f32_16x16x32_bf16 v[40:43], a[104:107], v[160:163], v[40:43]
s_waitcnt lgkmcnt(8)
ds_read_b64_tr_b16 a[68:69], v118 offset:4096
v_mul_f32 v93, v93, v25
v_mfma_f32_16x16x32_bf16 v[40:43], a[108:111], v[176:179], v[40:43]
ds_read_b64_tr_b16 a[70:71], v118 offset:6144
v_mul_f32 v94, v94, v25
v_mfma_f32_16x16x32_bf16 v[40:43], a[112:115], v[192:195], v[40:43]
s_waitcnt lgkmcnt(8)
ds_read_b64_tr_b16 a[72:73], v118 offset:8192
v_mul_f32 v95, v95, v25
v_mfma_f32_16x16x32_bf16 v[40:43], a[116:119], v[208:211], v[40:43]
s_waitcnt lgkmcnt(7)
ds_read_b64_tr_b16 a[74:75], v118 offset:10240
v_cvt_pk_bf16_f32 v84, v84, v85
v_mfma_f32_16x16x32_bf16 v[40:43], a[120:123], v[224:227], v[40:43]
s_waitcnt lgkmcnt(6)
ds_read_b64_tr_b16 a[76:77], v118 offset:12288
v_cvt_pk_bf16_f32 v85, v86, v87
v_mfma_f32_16x16x32_bf16 v[40:43], a[124:127], v[240:243], v[40:43]
ds_read_b64_tr_b16 a[78:79], v118 offset:14336
v_cvt_pk_bf16_f32 v86, v92, v93
v_mfma_f32_16x16x32_bf16 v[44:47], a[96:99], v[132:135], 0
ds_read_b64_tr_b16 a[80:81], v118 offset:16384
v_cvt_pk_bf16_f32 v87, v94, v95
v_mfma_f32_16x16x32_bf16 v[44:47], a[100:103], v[148:151], v[44:47]
ds_read_b64_tr_b16 a[82:83], v118 offset:18432
buffer_store_dwordx4 v[84:87], v1, s[4:7], s12 offen offset:3072 sc1
v_mfma_f32_16x16x32_bf16 v[44:47], a[104:107], v[164:167], v[44:47]
s_add_u32 s8, s8, 4096
s_add_u32 s12, s12, 4096
ds_read_b64_tr_b16 a[84:85], v118 offset:20480
v_mfma_f32_16x16x32_bf16 v[44:47], a[108:111], v[180:183], v[44:47]
ds_read_b64_tr_b16 a[86:87], v118 offset:22528
v_lshrrev_b32 v22, 4, v20
v_mfma_f32_16x16x32_bf16 v[44:47], a[112:115], v[196:199], v[44:47]
ds_read_b64_tr_b16 a[88:89], v118 offset:24576
v_mul_f32 v32, v32, v24
v_mfma_f32_16x16x32_bf16 v[44:47], a[116:119], v[212:215], v[44:47]
ds_read_b64_tr_b16 a[90:91], v118 offset:26624
v_mul_f32 v33, v33, v24
v_mfma_f32_16x16x32_bf16 v[44:47], a[120:123], v[228:231], v[44:47]
ds_read_b64_tr_b16 a[92:93], v118 offset:28672
v_mul_f32 v34, v34, v24
v_mfma_f32_16x16x32_bf16 v[44:47], a[124:127], v[244:247], v[44:47]
s_waitcnt lgkmcnt(8)
ds_read_b64_tr_b16 a[94:95], v118 offset:30720
v_mul_f32 v35, v35, v24
v_mfma_f32_16x16x32_bf16 v[48:51], a[64:67], v[128:131], 0
ds_read_b64_tr_b16 a[96:97], v119 offset:0
v_mul_f32 v40, v40, v24
v_mfma_f32_16x16x32_bf16 v[48:51], a[68:71], v[144:147], v[48:51]
ds_read_b64_tr_b16 a[98:99], v119 offset:2048
v_mul_f32 v41, v41, v24
v_mfma_f32_16x16x32_bf16 v[48:51], a[72:75], v[160:163], v[48:51]
s_waitcnt lgkmcnt(8)
ds_read_b64_tr_b16 a[100:101], v119 offset:4096
v_mul_f32 v42, v42, v24
v_mfma_f32_16x16x32_bf16 v[48:51], a[76:79], v[176:179], v[48:51]
ds_read_b64_tr_b16 a[102:103], v119 offset:6144
v_mul_f32 v43, v43, v24
v_mfma_f32_16x16x32_bf16 v[48:51], a[80:83], v[192:195], v[48:51]
s_waitcnt lgkmcnt(8)
ds_read_b64_tr_b16 a[104:105], v119 offset:8192
v_cvt_pk_bf16_f32 v32, v32, v33
v_mfma_f32_16x16x32_bf16 v[48:51], a[84:87], v[208:211], v[48:51]
s_waitcnt lgkmcnt(7)
ds_read_b64_tr_b16 a[106:107], v119 offset:10240
v_cvt_pk_bf16_f32 v33, v34, v35
v_mfma_f32_16x16x32_bf16 v[48:51], a[88:91], v[224:227], v[48:51]
s_waitcnt lgkmcnt(6)
ds_read_b64_tr_b16 a[108:109], v119 offset:12288
v_cvt_pk_bf16_f32 v34, v40, v41
v_mfma_f32_16x16x32_bf16 v[48:51], a[92:95], v[240:243], v[48:51]
ds_read_b64_tr_b16 a[110:111], v119 offset:14336
v_cvt_pk_bf16_f32 v35, v42, v43
v_mfma_f32_16x16x32_bf16 v[52:55], a[64:67], v[132:135], 0
ds_read_b64_tr_b16 a[112:113], v119 offset:16384
buffer_store_dwordx4 v[32:35], v1, s[4:7], s8 offen offset:0 sc1
v_mfma_f32_16x16x32_bf16 v[52:55], a[68:71], v[148:151], v[52:55]
ds_read_b64_tr_b16 a[114:115], v119 offset:18432
v_mul_f32 v36, v36, v25
v_mfma_f32_16x16x32_bf16 v[52:55], a[72:75], v[164:167], v[52:55]
ds_read_b64_tr_b16 a[116:117], v119 offset:20480
v_mul_f32 v37, v37, v25
v_mfma_f32_16x16x32_bf16 v[52:55], a[76:79], v[180:183], v[52:55]
ds_read_b64_tr_b16 a[118:119], v119 offset:22528
v_mul_f32 v38, v38, v25
v_mfma_f32_16x16x32_bf16 v[52:55], a[80:83], v[196:199], v[52:55]
ds_read_b64_tr_b16 a[120:121], v119 offset:24576
v_mul_f32 v39, v39, v25
v_mfma_f32_16x16x32_bf16 v[52:55], a[84:87], v[212:215], v[52:55]
ds_read_b64_tr_b16 a[122:123], v119 offset:26624
v_mul_f32 v44, v44, v25
v_mfma_f32_16x16x32_bf16 v[52:55], a[88:91], v[228:231], v[52:55]
ds_read_b64_tr_b16 a[124:125], v119 offset:28672
ds_read_b64_tr_b16 a[126:127], v119 offset:30720
v_mfma_f32_16x16x32_bf16 v[52:55], a[92:95], v[244:247], v[52:55]
s_waitcnt lgkmcnt(9)
v_mul_f32 v45, v45, v25
v_mul_f32 v46, v46, v25
v_mfma_f32_16x16x32_bf16 v[56:59], a[96:99], v[128:131], 0
v_mul_f32 v47, v47, v25
v_cvt_pk_bf16_f32 v36, v36, v37
v_mfma_f32_16x16x32_bf16 v[56:59], a[100:103], v[144:147], v[56:59]
v_cvt_pk_bf16_f32 v37, v38, v39
v_cvt_pk_bf16_f32 v38, v44, v45
v_mfma_f32_16x16x32_bf16 v[56:59], a[104:107], v[160:163], v[56:59]
s_waitcnt lgkmcnt(6)
v_cvt_pk_bf16_f32 v39, v46, v47
v_lshl_add_u32 v21, v22, 3, v21
v_mfma_f32_16x16x32_bf16 v[56:59], a[108:111], v[176:179], v[56:59]
buffer_store_dwordx4 v[36:39], v1, s[4:7], s12 offen offset:0 sc1
v_mfma_f32_16x16x32_bf16 v[56:59], a[112:115], v[192:195], v[56:59]
s_waitcnt lgkmcnt(4)
v_mfma_f32_16x16x32_bf16 v[56:59], a[116:119], v[208:211], v[56:59]
s_waitcnt lgkmcnt(2)
v_mfma_f32_16x16x32_bf16 v[56:59], a[120:123], v[224:227], v[56:59]
s_waitcnt lgkmcnt(0)
v_mfma_f32_16x16x32_bf16 v[56:59], a[124:127], v[240:243], v[56:59]
v_mfma_f32_16x16x32_bf16 v[60:63], a[96:99], v[132:135], 0
v_mfma_f32_16x16x32_bf16 v[60:63], a[100:103], v[148:151], v[60:63]
v_mfma_f32_16x16x32_bf16 v[60:63], a[104:107], v[164:167], v[60:63]
v_mfma_f32_16x16x32_bf16 v[60:63], a[108:111], v[180:183], v[60:63]
v_mfma_f32_16x16x32_bf16 v[60:63], a[112:115], v[196:199], v[60:63]
buffer_load_dword v18, v19, s[4:7], s33 offen offset:0 sc1
v_mfma_f32_16x16x32_bf16 v[60:63], a[116:119], v[212:215], v[60:63]
v_mfma_f32_16x16x32_bf16 v[60:63], a[120:123], v[228:231], v[60:63]
v_mfma_f32_16x16x32_bf16 v[60:63], a[124:127], v[244:247], v[60:63]
v_mul_f32 v48, v48, v24
v_mul_f32 v49, v49, v24
v_mul_f32 v50, v50, v24
v_mul_f32 v51, v51, v24
v_mul_f32 v56, v56, v24
v_mul_f32 v57, v57, v24
v_mul_f32 v58, v58, v24
v_mul_f32 v59, v59, v24
v_cvt_pk_bf16_f32 v48, v48, v49
v_cvt_pk_bf16_f32 v49, v50, v51
v_cvt_pk_bf16_f32 v50, v56, v57
v_cvt_pk_bf16_f32 v51, v58, v59
buffer_store_dwordx4 v[48:51], v1, s[4:7], s8 offen offset:1024 sc1
v_mul_f32 v52, v52, v25
v_mul_f32 v53, v53, v25
v_mul_f32 v54, v54, v25
v_mul_f32 v55, v55, v25
v_mul_f32 v60, v60, v25
v_mul_f32 v61, v61, v25
v_mul_f32 v62, v62, v25
v_mul_f32 v63, v63, v25
v_cvt_pk_bf16_f32 v52, v52, v53
v_cvt_pk_bf16_f32 v53, v54, v55
v_cvt_pk_bf16_f32 v54, v60, v61
v_cvt_pk_bf16_f32 v55, v62, v63
buffer_store_dwordx4 v[52:55], v1, s[4:7], s12 offen offset:1024 sc1
s_and_b32 s22, s2, 224
s_cmp_eq_u32 s22, 224
s_cbranch_scc1 M_final
s_waitcnt vmcnt(0)
s_barrier
buffer_store_dword v6, v5, s[4:7], s35 offen sc1
s_bitcmp0_b32 s2, 4
s_cbranch_scc1 M_rA
v_cmp_gt_u32 vcc, 1, v18
s_cbranch_vccnz M_rslow
M_rjoin:
buffer_load_dwordx4 v[128:131], v1, s[4:7], s26 offen sc1
s_add_u32 s26, s26, 14336
buffer_load_dwordx4 v[132:135], v1, s[4:7], s26 offen sc1
s_add_u32 s26, s26, 14336
buffer_load_dwordx4 v[136:139], v1, s[4:7], s26 offen sc1
s_add_u32 s26, s26, 14336
buffer_load_dwordx4 v[140:143], v1, s[4:7], s26 offen sc1
s_add_u32 s26, s26, 14336
buffer_load_dwordx4 v[144:147], v1, s[4:7], s26 offen sc1
s_add_u32 s26, s26, 14336
buffer_load_dwordx4 v[148:151], v1, s[4:7], s26 offen sc1
s_add_u32 s26, s26, 14336
buffer_load_dwordx4 v[152:155], v1, s[4:7], s26 offen sc1
s_add_u32 s26, s26, 14336
buffer_load_dwordx4 v[156:159], v1, s[4:7], s26 offen sc1
s_add_u32 s26, s26, 14336
buffer_load_dwordx4 v[160:163], v1, s[4:7], s26 offen sc1
s_add_u32 s26, s26, 14336
buffer_load_dwordx4 v[164:167], v1, s[4:7], s26 offen sc1
s_add_u32 s26, s26, 14336
buffer_load_dwordx4 v[168:171], v1, s[4:7], s26 offen sc1
s_add_u32 s26, s26, 14336
buffer_load_dwordx4 v[172:175], v1, s[4:7], s26 offen sc1
s_add_u32 s26, s26, 14336
buffer_load_dwordx4 v[176:179], v1, s[4:7], s26 offen sc1
s_add_u32 s26, s26, 14336
buffer_load_dwordx4 v[180:183], v1, s[4:7], s26 offen sc1
s_add_u32 s26, s26, 14336
buffer_load_dwordx4 v[184:187], v1, s[4:7], s26 offen sc1
s_add_u32 s26, s26, 14336
buffer_load_dwordx4 v[188:191], v1, s[4:7], s26 offen sc1
Lp_9201:
buffer_load_dword v18, v19, s[4:7], s33 offen offset:2048 sc1
s_waitcnt vmcnt(0)
v_cmp_gt_u32 vcc, 1, v18
s_cbranch_vccz Lpd_9202
s_sleep 8
s_sub_u32 s101, s101, 1
s_cbranch_scc0 Lp_9201
s_mov_b32 s101, 0
Lpd_9202:
s_sub_u32 s26, s26, 207872
buffer_load_dwordx4 v[192:195], v1, s[4:7], s26 offen sc1
s_add_u32 s26, s26, 14336
buffer_load_dwordx4 v[196:199], v1, s[4:7], s26 offen sc1
s_add_u32 s26, s26, 14336
buffer_load_dwordx4 v[200:203], v1, s[4:7], s26 offen sc1
s_add_u32 s26, s26, 14336
buffer_load_dwordx4 v[204:207], v1, s[4:7], s26 offen sc1
s_add_u32 s26, s26, 14336
buffer_load_dwordx4 v[208:211], v1, s[4:7], s26 offen sc1
s_add_u32 s26, s26, 14336
buffer_load_dwordx4 v[212:215], v1, s[4:7], s26 offen sc1
s_add_u32 s26, s26, 14336
buffer_load_dwordx4 v[216:219], v1, s[4:7], s26 offen sc1
s_add_u32 s26, s26, 14336
buffer_load_dwordx4 v[220:223], v1, s[4:7], s26 offen sc1
s_add_u32 s26, s26, 14336
buffer_load_dwordx4 v[224:227], v1, s[4:7], s26 offen sc1
s_add_u32 s26, s26, 14336
buffer_load_dwordx4 v[228:231], v1, s[4:7], s26 offen sc1
s_add_u32 s26, s26, 14336
buffer_load_dwordx4 v[232:235], v1, s[4:7], s26 offen sc1
s_add_u32 s26, s26, 14336
buffer_load_dwordx4 v[236:239], v1, s[4:7], s26 offen sc1
s_add_u32 s26, s26, 14336
buffer_load_dwordx4 v[240:243], v1, s[4:7], s26 offen sc1
s_add_u32 s26, s26, 14336
buffer_load_dwordx4 v[244:247], v1, s[4:7], s26 offen sc1
s_add_u32 s26, s26, 14336
buffer_load_dwordx4 v[248:251], v1, s[4:7], s26 offen sc1
s_add_u32 s26, s26, 14336
buffer_load_dwordx4 v[252:255], v1, s[4:7], s26 offen sc1
v_lshlrev_b32 v96, 16, v128
v_and_b32 v97, 0xffff0000, v128
v_lshlrev_b32 v98, 16, v129
v_and_b32 v99, 0xffff0000, v129
v_lshlrev_b32 v100, 16, v130
v_and_b32 v101, 0xffff0000, v130
v_lshlrev_b32 v102, 16, v131
v_and_b32 v103, 0xffff0000, v131
v_lshlrev_b32 v10, 16, v132
v_and_b32 v11, 0xffff0000, v132
v_lshlrev_b32 v12, 16, v133
v_and_b32 v13, 0xffff0000, v133
v_lshlrev_b32 v14, 16, v134
v_and_b32 v15, 0xffff0000, v134
v_lshlrev_b32 v16, 16, v135
v_and_b32 v17, 0xffff0000, v135
v_pk_add_f32 v[96:97], v[96:97], v[10:11]
v_pk_add_f32 v[98:99], v[98:99], v[12:13]
v_pk_add_f32 v[100:101], v[100:101], v[14:15]
v_pk_add_f32 v[102:103], v[102:103], v[16:17]
v_lshlrev_b32 v10, 16, v136
v_and_b32 v11, 0xffff0000, v136
v_lshlrev_b32 v12, 16, v137
v_and_b32 v13, 0xffff0000, v137
v_lshlrev_b32 v14, 16, v138
v_and_b32 v15, 0xffff0000, v138
v_lshlrev_b32 v16, 16, v139
v_and_b32 v17, 0xffff0000, v139
v_pk_add_f32 v[96:97], v[96:97], v[10:11]
v_pk_add_f32 v[98:99], v[98:99], v[12:13]
v_pk_add_f32 v[100:101], v[100:101], v[14:15]
v_pk_add_f32 v[102:103], v[102:103], v[16:17]
v_lshlrev_b32 v10, 16, v140
v_and_b32 v11, 0xffff0000, v140
v_lshlrev_b32 v12, 16, v141
v_and_b32 v13, 0xffff0000, v141
v_lshlrev_b32 v14, 16, v142
v_and_b32 v15, 0xffff0000, v142
v_lshlrev_b32 v16, 16, v143
v_and_b32 v17, 0xffff0000, v143
v_pk_add_f32 v[96:97], v[96:97], v[10:11]
v_pk_add_f32 v[98:99], v[98:99], v[12:13]
v_pk_add_f32 v[100:101], v[100:101], v[14:15]
v_pk_add_f32 v[102:103], v[102:103], v[16:17]
v_lshlrev_b32 v10, 16, v144
v_and_b32 v11, 0xffff0000, v144
v_lshlrev_b32 v12, 16, v145
v_and_b32 v13, 0xffff0000, v145
v_lshlrev_b32 v14, 16, v146
v_and_b32 v15, 0xffff0000, v146
v_lshlrev_b32 v16, 16, v147
v_and_b32 v17, 0xffff0000, v147
v_pk_add_f32 v[96:97], v[96:97], v[10:11]
v_pk_add_f32 v[98:99], v[98:99], v[12:13]
v_pk_add_f32 v[100:101], v[100:101], v[14:15]
v_pk_add_f32 v[102:103], v[102:103], v[16:17]
v_lshlrev_b32 v10, 16, v148
v_and_b32 v11, 0xffff0000, v148
v_lshlrev_b32 v12, 16, v149
v_and_b32 v13, 0xffff0000, v149
v_lshlrev_b32 v14, 16, v150
v_and_b32 v15, 0xffff0000, v150
v_lshlrev_b32 v16, 16, v151
v_and_b32 v17, 0xffff0000, v151
v_pk_add_f32 v[96:97], v[96:97], v[10:11]
v_pk_add_f32 v[98:99], v[98:99], v[12:13]
v_pk_add_f32 v[100:101], v[100:101], v[14:15]
v_pk_add_f32 v[102:103], v[102:103], v[16:17]
v_lshlrev_b32 v10, 16, v152
v_and_b32 v11, 0xffff0000, v152
v_lshlrev_b32 v12, 16, v153
v_and_b32 v13, 0xffff0000, v153
v_lshlrev_b32 v14, 16, v154
v_and_b32 v15, 0xffff0000, v154
v_lshlrev_b32 v16, 16, v155
v_and_b32 v17, 0xffff0000, v155
v_pk_add_f32 v[96:97], v[96:97], v[10:11]
v_pk_add_f32 v[98:99], v[98:99], v[12:13]
v_pk_add_f32 v[100:101], v[100:101], v[14:15]
v_pk_add_f32 v[102:103], v[102:103], v[16:17]
v_lshlrev_b32 v10, 16, v156
v_and_b32 v11, 0xffff0000, v156
v_lshlrev_b32 v12, 16, v157
v_and_b32 v13, 0xffff0000, v157
v_lshlrev_b32 v14, 16, v158
v_and_b32 v15, 0xffff0000, v158
v_lshlrev_b32 v16, 16, v159
v_and_b32 v17, 0xffff0000, v159
v_pk_add_f32 v[96:97], v[96:97], v[10:11]
v_pk_add_f32 v[98:99], v[98:99], v[12:13]
v_pk_add_f32 v[100:101], v[100:101], v[14:15]
v_pk_add_f32 v[102:103], v[102:103], v[16:17]
v_lshlrev_b32 v10, 16, v160
v_and_b32 v11, 0xffff0000, v160
v_lshlrev_b32 v12, 16, v161
v_and_b32 v13, 0xffff0000, v161
v_lshlrev_b32 v14, 16, v162
v_and_b32 v15, 0xffff0000, v162
v_lshlrev_b32 v16, 16, v163
v_and_b32 v17, 0xffff0000, v163
v_pk_add_f32 v[96:97], v[96:97], v[10:11]
v_pk_add_f32 v[98:99], v[98:99], v[12:13]
v_pk_add_f32 v[100:101], v[100:101], v[14:15]
v_pk_add_f32 v[102:103], v[102:103], v[16:17]
v_lshlrev_b32 v10, 16, v164
v_and_b32 v11, 0xffff0000, v164
v_lshlrev_b32 v12, 16, v165
v_and_b32 v13, 0xffff0000, v165
v_lshlrev_b32 v14, 16, v166
v_and_b32 v15, 0xffff0000, v166
v_lshlrev_b32 v16, 16, v167
v_and_b32 v17, 0xffff0000, v167
v_pk_add_f32 v[96:97], v[96:97], v[10:11]
v_pk_add_f32 v[98:99], v[98:99], v[12:13]
v_pk_add_f32 v[100:101], v[100:101], v[14:15]
v_pk_add_f32 v[102:103], v[102:103], v[16:17]
v_lshlrev_b32 v10, 16, v168
v_and_b32 v11, 0xffff0000, v168
v_lshlrev_b32 v12, 16, v169
v_and_b32 v13, 0xffff0000, v169
v_lshlrev_b32 v14, 16, v170
v_and_b32 v15, 0xffff0000, v170
v_lshlrev_b32 v16, 16, v171
v_and_b32 v17, 0xffff0000, v171
v_pk_add_f32 v[96:97], v[96:97], v[10:11]
v_pk_add_f32 v[98:99], v[98:99], v[12:13]
v_pk_add_f32 v[100:101], v[100:101], v[14:15]
v_pk_add_f32 v[102:103], v[102:103], v[16:17]
v_lshlrev_b32 v10, 16, v172
v_and_b32 v11, 0xffff0000, v172
v_lshlrev_b32 v12, 16, v173
v_and_b32 v13, 0xffff0000, v173
v_lshlrev_b32 v14, 16, v174
v_and_b32 v15, 0xffff0000, v174
v_lshlrev_b32 v16, 16, v175
v_and_b32 v17, 0xffff0000, v175
v_pk_add_f32 v[96:97], v[96:97], v[10:11]
v_pk_add_f32 v[98:99], v[98:99], v[12:13]
v_pk_add_f32 v[100:101], v[100:101], v[14:15]
v_pk_add_f32 v[102:103], v[102:103], v[16:17]
v_lshlrev_b32 v10, 16, v176
v_and_b32 v11, 0xffff0000, v176
v_lshlrev_b32 v12, 16, v177
v_and_b32 v13, 0xffff0000, v177
v_lshlrev_b32 v14, 16, v178
v_and_b32 v15, 0xffff0000, v178
v_lshlrev_b32 v16, 16, v179
v_and_b32 v17, 0xffff0000, v179
v_pk_add_f32 v[96:97], v[96:97], v[10:11]
v_pk_add_f32 v[98:99], v[98:99], v[12:13]
v_pk_add_f32 v[100:101], v[100:101], v[14:15]
v_pk_add_f32 v[102:103], v[102:103], v[16:17]
v_lshlrev_b32 v10, 16, v180
v_and_b32 v11, 0xffff0000, v180
v_lshlrev_b32 v12, 16, v181
v_and_b32 v13, 0xffff0000, v181
v_lshlrev_b32 v14, 16, v182
v_and_b32 v15, 0xffff0000, v182
v_lshlrev_b32 v16, 16, v183
v_and_b32 v17, 0xffff0000, v183
v_pk_add_f32 v[96:97], v[96:97], v[10:11]
v_pk_add_f32 v[98:99], v[98:99], v[12:13]
v_pk_add_f32 v[100:101], v[100:101], v[14:15]
v_pk_add_f32 v[102:103], v[102:103], v[16:17]
v_lshlrev_b32 v10, 16, v184
v_and_b32 v11, 0xffff0000, v184
v_lshlrev_b32 v12, 16, v185
v_and_b32 v13, 0xffff0000, v185
v_lshlrev_b32 v14, 16, v186
v_and_b32 v15, 0xffff0000, v186
v_lshlrev_b32 v16, 16, v187
v_and_b32 v17, 0xffff0000, v187
v_pk_add_f32 v[96:97], v[96:97], v[10:11]
v_pk_add_f32 v[98:99], v[98:99], v[12:13]
v_pk_add_f32 v[100:101], v[100:101], v[14:15]
v_pk_add_f32 v[102:103], v[102:103], v[16:17]
v_lshlrev_b32 v10, 16, v188
v_and_b32 v11, 0xffff0000, v188
v_lshlrev_b32 v12, 16, v189
v_and_b32 v13, 0xffff0000, v189
v_lshlrev_b32 v14, 16, v190
v_and_b32 v15, 0xffff0000, v190
v_lshlrev_b32 v16, 16, v191
v_and_b32 v17, 0xffff0000, v191
v_pk_add_f32 v[96:97], v[96:97], v[10:11]
v_pk_add_f32 v[98:99], v[98:99], v[12:13]
v_pk_add_f32 v[100:101], v[100:101], v[14:15]
v_pk_add_f32 v[102:103], v[102:103], v[16:17]
v_cvt_pk_bf16_f32 v96, v96, v97
v_cvt_pk_bf16_f32 v97, v98, v99
v_cvt_pk_bf16_f32 v98, v100, v101
v_cvt_pk_bf16_f32 v99, v102, v103
buffer_store_dwordx2 v[96:97], v21, s[40:43], s25 offen offset:896
buffer_store_dwordx2 v[98:99], v21, s[40:43], s25 offen offset:928
s_waitcnt vmcnt(17)
v_lshlrev_b32 v104, 16, v192
v_and_b32 v105, 0xffff0000, v192
v_lshlrev_b32 v106, 16, v193
v_and_b32 v107, 0xffff0000, v193
v_lshlrev_b32 v108, 16, v194
v_and_b32 v109, 0xffff0000, v194
v_lshlrev_b32 v110, 16, v195
v_and_b32 v111, 0xffff0000, v195
s_waitcnt vmcnt(16)
v_lshlrev_b32 v10, 16, v196
v_and_b32 v11, 0xffff0000, v196
v_lshlrev_b32 v12, 16, v197
v_and_b32 v13, 0xffff0000, v197
v_lshlrev_b32 v14, 16, v198
v_and_b32 v15, 0xffff0000, v198
v_lshlrev_b32 v16, 16, v199
v_and_b32 v17, 0xffff0000, v199
v_pk_add_f32 v[104:105], v[104:105], v[10:11]
v_pk_add_f32 v[106:107], v[106:107], v[12:13]
v_pk_add_f32 v[108:109], v[108:109], v[14:15]
v_pk_add_f32 v[110:111], v[110:111], v[16:17]
PAD_17:
s_cbranch_execz M_tret
s_waitcnt vmcnt(15)
v_lshlrev_b32 v10, 16, v200
v_and_b32 v11, 0xffff0000, v200
v_lshlrev_b32 v12, 16, v201
v_and_b32 v13, 0xffff0000, v201
v_lshlrev_b32 v14, 16, v202
v_and_b32 v15, 0xffff0000, v202
v_lshlrev_b32 v16, 16, v203
v_and_b32 v17, 0xffff0000, v203
v_pk_add_f32 v[104:105], v[104:105], v[10:11]
v_pk_add_f32 v[106:107], v[106:107], v[12:13]
v_pk_add_f32 v[108:109], v[108:109], v[14:15]
v_pk_add_f32 v[110:111], v[110:111], v[16:17]
s_waitcnt vmcnt(14)
v_lshlrev_b32 v10, 16, v204
v_and_b32 v11, 0xffff0000, v204
v_lshlrev_b32 v12, 16, v205
v_and_b32 v13, 0xffff0000, v205
v_lshlrev_b32 v14, 16, v206
v_and_b32 v15, 0xffff0000, v206
v_lshlrev_b32 v16, 16, v207
v_and_b32 v17, 0xffff0000, v207
v_pk_add_f32 v[104:105], v[104:105], v[10:11]
v_pk_add_f32 v[106:107], v[106:107], v[12:13]
v_pk_add_f32 v[108:109], v[108:109], v[14:15]
v_pk_add_f32 v[110:111], v[110:111], v[16:17]
s_waitcnt vmcnt(13)
v_lshlrev_b32 v10, 16, v208
v_and_b32 v11, 0xffff0000, v208
v_lshlrev_b32 v12, 16, v209
v_and_b32 v13, 0xffff0000, v209
v_lshlrev_b32 v14, 16, v210
v_and_b32 v15, 0xffff0000, v210
v_lshlrev_b32 v16, 16, v211
v_and_b32 v17, 0xffff0000, v211
v_pk_add_f32 v[104:105], v[104:105], v[10:11]
v_pk_add_f32 v[106:107], v[106:107], v[12:13]
v_pk_add_f32 v[108:109], v[108:109], v[14:15]
v_pk_add_f32 v[110:111], v[110:111], v[16:17]
s_waitcnt vmcnt(12)
v_lshlrev_b32 v10, 16, v212
v_and_b32 v11, 0xffff0000, v212
v_lshlrev_b32 v12, 16, v213
v_and_b32 v13, 0xffff0000, v213
v_lshlrev_b32 v14, 16, v214
v_and_b32 v15, 0xffff0000, v214
v_lshlrev_b32 v16, 16, v215
v_and_b32 v17, 0xffff0000, v215
v_pk_add_f32 v[104:105], v[104:105], v[10:11]
v_pk_add_f32 v[106:107], v[106:107], v[12:13]
v_pk_add_f32 v[108:109], v[108:109], v[14:15]
v_pk_add_f32 v[110:111], v[110:111], v[16:17]
s_waitcnt vmcnt(11)
v_lshlrev_b32 v10, 16, v216
v_and_b32 v11, 0xffff0000, v216
v_lshlrev_b32 v12, 16, v217
v_and_b32 v13, 0xffff0000, v217
v_lshlrev_b32 v14, 16, v218
v_and_b32 v15, 0xffff0000, v218
v_lshlrev_b32 v16, 16, v219
v_and_b32 v17, 0xffff0000, v219
v_pk_add_f32 v[104:105], v[104:105], v[10:11]
v_pk_add_f32 v[106:107], v[106:107], v[12:13]
v_pk_add_f32 v[108:109], v[108:109], v[14:15]
v_pk_add_f32 v[110:111], v[110:111], v[16:17]
s_waitcnt vmcnt(10)
v_lshlrev_b32 v10, 16, v220
v_and_b32 v11, 0xffff0000, v220
v_lshlrev_b32 v12, 16, v221
v_and_b32 v13, 0xffff0000, v221
v_lshlrev_b32 v14, 16, v222
v_and_b32 v15, 0xffff0000, v222
v_lshlrev_b32 v16, 16, v223
v_and_b32 v17, 0xffff0000, v223
v_pk_add_f32 v[104:105], v[104:105], v[10:11]
v_pk_add_f32 v[106:107], v[106:107], v[12:13]
v_pk_add_f32 v[108:109], v[108:109], v[14:15]
v_pk_add_f32 v[110:111], v[110:111], v[16:17]
s_waitcnt vmcnt(9)
v_lshlrev_b32 v10, 16, v224
v_and_b32 v11, 0xffff0000, v224
v_lshlrev_b32 v12, 16, v225
v_and_b32 v13, 0xffff0000, v225
v_lshlrev_b32 v14, 16, v226
v_and_b32 v15, 0xffff0000, v226
v_lshlrev_b32 v16, 16, v227
v_and_b32 v17, 0xffff0000, v227
v_pk_add_f32 v[104:105], v[104:105], v[10:11]
v_pk_add_f32 v[106:107], v[106:107], v[12:13]
v_pk_add_f32 v[108:109], v[108:109], v[14:15]
v_pk_add_f32 v[110:111], v[110:111], v[16:17]
s_waitcnt vmcnt(8)
v_lshlrev_b32 v10, 16, v228
v_and_b32 v11, 0xffff0000, v228
v_lshlrev_b32 v12, 16, v229
v_and_b32 v13, 0xffff0000, v229
v_lshlrev_b32 v14, 16, v230
v_and_b32 v15, 0xffff0000, v230
v_lshlrev_b32 v16, 16, v231
v_and_b32 v17, 0xffff0000, v231
v_pk_add_f32 v[104:105], v[104:105], v[10:11]
v_pk_add_f32 v[106:107], v[106:107], v[12:13]
v_pk_add_f32 v[108:109], v[108:109], v[14:15]
v_pk_add_f32 v[110:111], v[110:111], v[16:17]
s_waitcnt vmcnt(7)
v_lshlrev_b32 v10, 16, v232
v_and_b32 v11, 0xffff0000, v232
v_lshlrev_b32 v12, 16, v233
v_and_b32 v13, 0xffff0000, v233
v_lshlrev_b32 v14, 16, v234
v_and_b32 v15, 0xffff0000, v234
v_lshlrev_b32 v16, 16, v235
v_and_b32 v17, 0xffff0000, v235
v_pk_add_f32 v[104:105], v[104:105], v[10:11]
v_pk_add_f32 v[106:107], v[106:107], v[12:13]
v_pk_add_f32 v[108:109], v[108:109], v[14:15]
v_pk_add_f32 v[110:111], v[110:111], v[16:17]
s_waitcnt vmcnt(6)
v_lshlrev_b32 v10, 16, v236
v_and_b32 v11, 0xffff0000, v236
v_lshlrev_b32 v12, 16, v237
v_and_b32 v13, 0xffff0000, v237
v_lshlrev_b32 v14, 16, v238
v_and_b32 v15, 0xffff0000, v238
v_lshlrev_b32 v16, 16, v239
v_and_b32 v17, 0xffff0000, v239
v_pk_add_f32 v[104:105], v[104:105], v[10:11]
v_pk_add_f32 v[106:107], v[106:107], v[12:13]
v_pk_add_f32 v[108:109], v[108:109], v[14:15]
v_pk_add_f32 v[110:111], v[110:111], v[16:17]
s_waitcnt vmcnt(5)
v_lshlrev_b32 v10, 16, v240
v_and_b32 v11, 0xffff0000, v240
v_lshlrev_b32 v12, 16, v241
v_and_b32 v13, 0xffff0000, v241
v_lshlrev_b32 v14, 16, v242
v_and_b32 v15, 0xffff0000, v242
v_lshlrev_b32 v16, 16, v243
v_and_b32 v17, 0xffff0000, v243
v_pk_add_f32 v[104:105], v[104:105], v[10:11]
v_pk_add_f32 v[106:107], v[106:107], v[12:13]
v_pk_add_f32 v[108:109], v[108:109], v[14:15]
v_pk_add_f32 v[110:111], v[110:111], v[16:17]
s_waitcnt vmcnt(4)
v_lshlrev_b32 v10, 16, v244
v_and_b32 v11, 0xffff0000, v244
v_lshlrev_b32 v12, 16, v245
v_and_b32 v13, 0xffff0000, v245
v_lshlrev_b32 v14, 16, v246
v_and_b32 v15, 0xffff0000, v246
v_lshlrev_b32 v16, 16, v247
v_and_b32 v17, 0xffff0000, v247
v_pk_add_f32 v[104:105], v[104:105], v[10:11]
v_pk_add_f32 v[106:107], v[106:107], v[12:13]
v_pk_add_f32 v[108:109], v[108:109], v[14:15]
v_pk_add_f32 v[110:111], v[110:111], v[16:17]
s_waitcnt vmcnt(3)
v_lshlrev_b32 v10, 16, v248
v_and_b32 v11, 0xffff0000, v248
v_lshlrev_b32 v12, 16, v249
v_and_b32 v13, 0xffff0000, v249
v_lshlrev_b32 v14, 16, v250
v_and_b32 v15, 0xffff0000, v250
v_lshlrev_b32 v16, 16, v251
v_and_b32 v17, 0xffff0000, v251
v_pk_add_f32 v[104:105], v[104:105], v[10:11]
v_pk_add_f32 v[106:107], v[106:107], v[12:13]
v_pk_add_f32 v[108:109], v[108:109], v[14:15]
v_pk_add_f32 v[110:111], v[110:111], v[16:17]
s_waitcnt vmcnt(2)
v_lshlrev_b32 v10, 16, v252
v_and_b32 v11, 0xffff0000, v252
v_lshlrev_b32 v12, 16, v253
v_and_b32 v13, 0xffff0000, v253
v_lshlrev_b32 v14, 16, v254
v_and_b32 v15, 0xffff0000, v254
v_lshlrev_b32 v16, 16, v255
v_and_b32 v17, 0xffff0000, v255
v_pk_add_f32 v[104:105], v[104:105], v[10:11]
v_pk_add_f32 v[106:107], v[106:107], v[12:13]
v_pk_add_f32 v[108:109], v[108:109], v[14:15]
v_pk_add_f32 v[110:111], v[110:111], v[16:17]
v_cvt_pk_bf16_f32 v104, v104, v105
v_cvt_pk_bf16_f32 v105, v106, v107
v_cvt_pk_bf16_f32 v106, v108, v109
v_cvt_pk_bf16_f32 v107, v110, v111
buffer_store_dwordx2 v[104:105], v21, s[40:43], s25 offen offset:1344
buffer_store_dwordx2 v[106:107], v21, s[40:43], s25 offen offset:1376
s_add_u32 s25, s25, 1835008
s_add_u32 s26, s26, 14457856
s_add_u32 s33, s33, 1024
s_branch M_r1
PAD_18:
s_cbranch_execz M_tret
M_rA:
s_add_u32 s25, s25, 448
s_add_u32 s26, s26, 7168
s_add_u32 s33, s33, 2048
M_r1:
Lp_9203:
buffer_load_dword v18, v19, s[4:7], s33 offen offset:0 sc1
s_waitcnt vmcnt(0)
v_cmp_gt_u32 vcc, 1, v18
s_cbranch_vccz Lpd_9204
s_sleep 8
s_sub_u32 s101, s101, 1
s_cbranch_scc0 Lp_9203
s_mov_b32 s101, 0
Lpd_9204:
buffer_load_dwordx4 v[128:131], v1, s[4:7], s26 offen sc1
s_add_u32 s26, s26, 14336
buffer_load_dwordx4 v[132:135], v1, s[4:7], s26 offen sc1
s_add_u32 s26, s26, 14336
buffer_load_dwordx4 v[136:139], v1, s[4:7], s26 offen sc1
s_add_u32 s26, s26, 14336
buffer_load_dwordx4 v[140:143], v1, s[4:7], s26 offen sc1
s_add_u32 s26, s26, 14336
buffer_load_dwordx4 v[144:147], v1, s[4:7], s26 offen sc1
s_add_u32 s26, s26, 14336
buffer_load_dwordx4 v[148:151], v1, s[4:7], s26 offen sc1
s_add_u32 s26, s26, 14336
buffer_load_dwordx4 v[152:155], v1, s[4:7], s26 offen sc1
s_add_u32 s26, s26, 14336
buffer_load_dwordx4 v[156:159], v1, s[4:7], s26 offen sc1
s_add_u32 s26, s26, 14336
buffer_load_dwordx4 v[160:163], v1, s[4:7], s26 offen sc1
s_add_u32 s26, s26, 14336
buffer_load_dwordx4 v[164:167], v1, s[4:7], s26 offen sc1
s_add_u32 s26, s26, 14336
buffer_load_dwordx4 v[168:171], v1, s[4:7], s26 offen sc1
s_add_u32 s26, s26, 14336
buffer_load_dwordx4 v[172:175], v1, s[4:7], s26 offen sc1
s_add_u32 s26, s26, 14336
buffer_load_dwordx4 v[176:179], v1, s[4:7], s26 offen sc1
s_add_u32 s26, s26, 14336
buffer_load_dwordx4 v[180:183], v1, s[4:7], s26 offen sc1
s_add_u32 s26, s26, 14336
buffer_load_dwordx4 v[184:187], v1, s[4:7], s26 offen sc1
s_add_u32 s26, s26, 14336
buffer_load_dwordx4 v[188:191], v1, s[4:7], s26 offen sc1
s_waitcnt vmcnt(15)
v_lshlrev_b32 v96, 16, v128
v_and_b32 v97, 0xffff0000, v128
v_lshlrev_b32 v98, 16, v129
v_and_b32 v99, 0xffff0000, v129
v_lshlrev_b32 v100, 16, v130
v_and_b32 v101, 0xffff0000, v130
v_lshlrev_b32 v102, 16, v131
v_and_b32 v103, 0xffff0000, v131
s_waitcnt vmcnt(14)
v_lshlrev_b32 v10, 16, v132
v_and_b32 v11, 0xffff0000, v132
v_lshlrev_b32 v12, 16, v133
v_and_b32 v13, 0xffff0000, v133
v_lshlrev_b32 v14, 16, v134
v_and_b32 v15, 0xffff0000, v134
v_lshlrev_b32 v16, 16, v135
v_and_b32 v17, 0xffff0000, v135
v_pk_add_f32 v[96:97], v[96:97], v[10:11]
v_pk_add_f32 v[98:99], v[98:99], v[12:13]
v_pk_add_f32 v[100:101], v[100:101], v[14:15]
v_pk_add_f32 v[102:103], v[102:103], v[16:17]
s_waitcnt vmcnt(13)
v_lshlrev_b32 v10, 16, v136
v_and_b32 v11, 0xffff0000, v136
v_lshlrev_b32 v12, 16, v137
v_and_b32 v13, 0xffff0000, v137
v_lshlrev_b32 v14, 16, v138
v_and_b32 v15, 0xffff0000, v138
v_lshlrev_b32 v16, 16, v139
v_and_b32 v17, 0xffff0000, v139
v_pk_add_f32 v[96:97], v[96:97], v[10:11]
v_pk_add_f32 v[98:99], v[98:99], v[12:13]
v_pk_add_f32 v[100:101], v[100:101], v[14:15]
v_pk_add_f32 v[102:103], v[102:103], v[16:17]
s_waitcnt vmcnt(12)
v_lshlrev_b32 v10, 16, v140
v_and_b32 v11, 0xffff0000, v140
v_lshlrev_b32 v12, 16, v141
v_and_b32 v13, 0xffff0000, v141
v_lshlrev_b32 v14, 16, v142
v_and_b32 v15, 0xffff0000, v142
v_lshlrev_b32 v16, 16, v143
v_and_b32 v17, 0xffff0000, v143
v_pk_add_f32 v[96:97], v[96:97], v[10:11]
v_pk_add_f32 v[98:99], v[98:99], v[12:13]
v_pk_add_f32 v[100:101], v[100:101], v[14:15]
v_pk_add_f32 v[102:103], v[102:103], v[16:17]
s_waitcnt vmcnt(11)
v_lshlrev_b32 v10, 16, v144
v_and_b32 v11, 0xffff0000, v144
v_lshlrev_b32 v12, 16, v145
v_and_b32 v13, 0xffff0000, v145
v_lshlrev_b32 v14, 16, v146
v_and_b32 v15, 0xffff0000, v146
v_lshlrev_b32 v16, 16, v147
v_and_b32 v17, 0xffff0000, v147
v_pk_add_f32 v[96:97], v[96:97], v[10:11]
v_pk_add_f32 v[98:99], v[98:99], v[12:13]
v_pk_add_f32 v[100:101], v[100:101], v[14:15]
v_pk_add_f32 v[102:103], v[102:103], v[16:17]
s_waitcnt vmcnt(10)
v_lshlrev_b32 v10, 16, v148
v_and_b32 v11, 0xffff0000, v148
v_lshlrev_b32 v12, 16, v149
v_and_b32 v13, 0xffff0000, v149
v_lshlrev_b32 v14, 16, v150
v_and_b32 v15, 0xffff0000, v150
v_lshlrev_b32 v16, 16, v151
v_and_b32 v17, 0xffff0000, v151
v_pk_add_f32 v[96:97], v[96:97], v[10:11]
v_pk_add_f32 v[98:99], v[98:99], v[12:13]
v_pk_add_f32 v[100:101], v[100:101], v[14:15]
v_pk_add_f32 v[102:103], v[102:103], v[16:17]
s_waitcnt vmcnt(9)
v_lshlrev_b32 v10, 16, v152
v_and_b32 v11, 0xffff0000, v152
v_lshlrev_b32 v12, 16, v153
v_and_b32 v13, 0xffff0000, v153
v_lshlrev_b32 v14, 16, v154
v_and_b32 v15, 0xffff0000, v154
v_lshlrev_b32 v16, 16, v155
v_and_b32 v17, 0xffff0000, v155
v_pk_add_f32 v[96:97], v[96:97], v[10:11]
v_pk_add_f32 v[98:99], v[98:99], v[12:13]
v_pk_add_f32 v[100:101], v[100:101], v[14:15]
v_pk_add_f32 v[102:103], v[102:103], v[16:17]
s_waitcnt vmcnt(8)
v_lshlrev_b32 v10, 16, v156
v_and_b32 v11, 0xffff0000, v156
v_lshlrev_b32 v12, 16, v157
v_and_b32 v13, 0xffff0000, v157
v_lshlrev_b32 v14, 16, v158
v_and_b32 v15, 0xffff0000, v158
v_lshlrev_b32 v16, 16, v159
v_and_b32 v17, 0xffff0000, v159
v_pk_add_f32 v[96:97], v[96:97], v[10:11]
v_pk_add_f32 v[98:99], v[98:99], v[12:13]
v_pk_add_f32 v[100:101], v[100:101], v[14:15]
v_pk_add_f32 v[102:103], v[102:103], v[16:17]
s_waitcnt vmcnt(7)
v_lshlrev_b32 v10, 16, v160
v_and_b32 v11, 0xffff0000, v160
v_lshlrev_b32 v12, 16, v161
v_and_b32 v13, 0xffff0000, v161
v_lshlrev_b32 v14, 16, v162
v_and_b32 v15, 0xffff0000, v162
v_lshlrev_b32 v16, 16, v163
v_and_b32 v17, 0xffff0000, v163
v_pk_add_f32 v[96:97], v[96:97], v[10:11]
v_pk_add_f32 v[98:99], v[98:99], v[12:13]
v_pk_add_f32 v[100:101], v[100:101], v[14:15]
v_pk_add_f32 v[102:103], v[102:103], v[16:17]
s_waitcnt vmcnt(6)
v_lshlrev_b32 v10, 16, v164
v_and_b32 v11, 0xffff0000, v164
v_lshlrev_b32 v12, 16, v165
v_and_b32 v13, 0xffff0000, v165
v_lshlrev_b32 v14, 16, v166
v_and_b32 v15, 0xffff0000, v166
v_lshlrev_b32 v16, 16, v167
v_and_b32 v17, 0xffff0000, v167
v_pk_add_f32 v[96:97], v[96:97], v[10:11]
v_pk_add_f32 v[98:99], v[98:99], v[12:13]
v_pk_add_f32 v[100:101], v[100:101], v[14:15]
v_pk_add_f32 v[102:103], v[102:103], v[16:17]
s_waitcnt vmcnt(5)
v_lshlrev_b32 v10, 16, v168
v_and_b32 v11, 0xffff0000, v168
v_lshlrev_b32 v12, 16, v169
v_and_b32 v13, 0xffff0000, v169
v_lshlrev_b32 v14, 16, v170
v_and_b32 v15, 0xffff0000, v170
v_lshlrev_b32 v16, 16, v171
v_and_b32 v17, 0xffff0000, v171
v_pk_add_f32 v[96:97], v[96:97], v[10:11]
v_pk_add_f32 v[98:99], v[98:99], v[12:13]
v_pk_add_f32 v[100:101], v[100:101], v[14:15]
v_pk_add_f32 v[102:103], v[102:103], v[16:17]
s_waitcnt vmcnt(4)
v_lshlrev_b32 v10, 16, v172
v_and_b32 v11, 0xffff0000, v172
v_lshlrev_b32 v12, 16, v173
v_and_b32 v13, 0xffff0000, v173
v_lshlrev_b32 v14, 16, v174
v_and_b32 v15, 0xffff0000, v174
v_lshlrev_b32 v16, 16, v175
v_and_b32 v17, 0xffff0000, v175
v_pk_add_f32 v[96:97], v[96:97], v[10:11]
v_pk_add_f32 v[98:99], v[98:99], v[12:13]
v_pk_add_f32 v[100:101], v[100:101], v[14:15]
v_pk_add_f32 v[102:103], v[102:103], v[16:17]
s_waitcnt vmcnt(3)
v_lshlrev_b32 v10, 16, v176
v_and_b32 v11, 0xffff0000, v176
v_lshlrev_b32 v12, 16, v177
v_and_b32 v13, 0xffff0000, v177
v_lshlrev_b32 v14, 16, v178
v_and_b32 v15, 0xffff0000, v178
v_lshlrev_b32 v16, 16, v179
v_and_b32 v17, 0xffff0000, v179
v_pk_add_f32 v[96:97], v[96:97], v[10:11]
v_pk_add_f32 v[98:99], v[98:99], v[12:13]
v_pk_add_f32 v[100:101], v[100:101], v[14:15]
v_pk_add_f32 v[102:103], v[102:103], v[16:17]
s_waitcnt vmcnt(2)
v_lshlrev_b32 v10, 16, v180
v_and_b32 v11, 0xffff0000, v180
v_lshlrev_b32 v12, 16, v181
v_and_b32 v13, 0xffff0000, v181
v_lshlrev_b32 v14, 16, v182
v_and_b32 v15, 0xffff0000, v182
v_lshlrev_b32 v16, 16, v183
v_and_b32 v17, 0xffff0000, v183
v_pk_add_f32 v[96:97], v[96:97], v[10:11]
v_pk_add_f32 v[98:99], v[98:99], v[12:13]
v_pk_add_f32 v[100:101], v[100:101], v[14:15]
v_pk_add_f32 v[102:103], v[102:103], v[16:17]
s_waitcnt vmcnt(1)
v_lshlrev_b32 v10, 16, v184
v_and_b32 v11, 0xffff0000, v184
v_lshlrev_b32 v12, 16, v185
v_and_b32 v13, 0xffff0000, v185
v_lshlrev_b32 v14, 16, v186
v_and_b32 v15, 0xffff0000, v186
v_lshlrev_b32 v16, 16, v187
v_and_b32 v17, 0xffff0000, v187
v_pk_add_f32 v[96:97], v[96:97], v[10:11]
v_pk_add_f32 v[98:99], v[98:99], v[12:13]
v_pk_add_f32 v[100:101], v[100:101], v[14:15]
v_pk_add_f32 v[102:103], v[102:103], v[16:17]
s_waitcnt vmcnt(0)
v_lshlrev_b32 v10, 16, v188
v_and_b32 v11, 0xffff0000, v188
v_lshlrev_b32 v12, 16, v189
v_and_b32 v13, 0xffff0000, v189
v_lshlrev_b32 v14, 16, v190
v_and_b32 v15, 0xffff0000, v190
v_lshlrev_b32 v16, 16, v191
v_and_b32 v17, 0xffff0000, v191
v_pk_add_f32 v[96:97], v[96:97], v[10:11]
v_pk_add_f32 v[98:99], v[98:99], v[12:13]
v_pk_add_f32 v[100:101], v[100:101], v[14:15]
v_pk_add_f32 v[102:103], v[102:103], v[16:17]
v_cvt_pk_bf16_f32 v96, v96, v97
v_cvt_pk_bf16_f32 v97, v98, v99
v_cvt_pk_bf16_f32 v98, v100, v101
v_cvt_pk_bf16_f32 v99, v102, v103
buffer_store_dwordx2 v[96:97], v21, s[40:43], s25 offen offset:896
buffer_store_dwordx2 v[98:99], v21, s[40:43], s25 offen offset:928
M_fin:
s_endpgm
M_final:
PAD_19:
s_cbranch_execz M_tret
s_mov_b32 s8, s64
s_mov_b32 s9, s65
s_mov_b32 s10, 1835008
s_mov_b32 s11, 0x20000
s_mov_b32 s12, s88
s_mov_b32 s13, s89
s_mov_b32 s14, 3670016
s_mov_b32 s15, 0x20000
s_and_b32 s24, s2, 16
s_add_u32 s24, s24, s20
v_lshrrev_b32 v20, 4, v1
v_and_b32 v21, 15, v20
v_lshrrev_b32 v22, 4, v20
v_mul_u32_u24 v2, 896, v21
v_lshlrev_b32 v9, 1, v2
v_lshl_add_u32 v2, v22, 4, v2
v_lshl_add_u32 v9, v22, 4, v9
s_lshl_b32 s22, s24, 2
s_add_u32 s22, s22, s3
s_mul_i32 s25, s22, 14336
s_lshl_b32 s26, s25, 1
v_lshlrev_b32 v10, 5, v22
v_add3_u32 v10, v10, v21, 16
v_lshlrev_b32 v10, 2, v10
v_min_u32 v11, 380, v10
v_add_u32 v11, 512, v11
s_mov_b32 s27, 94384128
Lfp:
buffer_load_dword v3, v10, s[4:7], s27 offen sc1
buffer_load_dword v4, v11, s[4:7], s27 offen sc1
s_waitcnt vmcnt(0)
v_and_b32 v3, v3, v4
v_cmp_gt_u32 vcc, 1, v3
s_cbranch_vccz Lfpd
s_sleep 2
s_sub_u32 s101, s101, 1
s_cbranch_scc0 Lfp
s_mov_b32 s101, 0
Lfpd:
s_barrier
buffer_store_dword v6, v5, s[4:7], s35 offen sc1
Lfg:
v_lshrrev_b32 v3, 3, v20
v_and_b32 v4, 7, v20
v_lshlrev_b32 v4, 4, v4
v_lshl_add_u32 v3, v3, 12, v4
s_mul_i32 s27, s3, 458752
s_lshl_b32 s22, s24, 7
s_add_u32 s27, s27, s22
s_add_u32 s27, s27, 88080384
s_mul_i32 s28, s3, 14336
s_add_u32 m0, s28, 0
s_nop 0
buffer_load_dwordx4 v3, s[4:7], s27 offen sc1 lds
s_add_u32 s27, s27, 32768
s_add_u32 m0, s28, 1024
s_nop 0
buffer_load_dwordx4 v3, s[4:7], s27 offen sc1 lds
s_add_u32 s27, s27, 32768
s_add_u32 m0, s28, 2048
s_nop 0
buffer_load_dwordx4 v3, s[4:7], s27 offen sc1 lds
s_add_u32 s27, s27, 32768
s_add_u32 m0, s28, 3072
s_nop 0
buffer_load_dwordx4 v3, s[4:7], s27 offen sc1 lds
s_add_u32 s27, s27, 32768
s_add_u32 m0, s28, 4096
s_nop 0
buffer_load_dwordx4 v3, s[4:7], s27 offen sc1 lds
s_add_u32 s27, s27, 32768
s_add_u32 m0, s28, 5120
s_nop 0
buffer_load_dwordx4 v3, s[4:7], s27 offen sc1 lds
s_add_u32 s27, s27, 32768
s_add_u32 m0, s28, 6144
s_nop 0
buffer_load_dwordx4 v3, s[4:7], s27 offen sc1 lds
s_add_u32 s27, s27, 32768
s_add_u32 m0, s28, 7168
s_nop 0
buffer_load_dwordx4 v3, s[4:7], s27 offen sc1 lds
s_add_u32 s27, s27, 32768
s_add_u32 m0, s28, 8192
s_nop 0
buffer_load_dwordx4 v3, s[4:7], s27 offen sc1 lds
s_add_u32 s27, s27, 32768
s_add_u32 m0, s28, 9216
s_nop 0
buffer_load_dwordx4 v3, s[4:7], s27 offen sc1 lds
s_add_u32 s27, s27, 32768
s_add_u32 m0, s28, 10240
s_nop 0
buffer_load_dwordx4 v3, s[4:7], s27 offen sc1 lds
s_add_u32 s27, s27, 32768
s_add_u32 m0, s28, 11264
s_nop 0
buffer_load_dwordx4 v3, s[4:7], s27 offen sc1 lds
s_add_u32 s27, s27, 32768
s_add_u32 m0, s28, 12288
s_nop 0
buffer_load_dwordx4 v3, s[4:7], s27 offen sc1 lds
s_add_u32 s27, s27, 32768
s_add_u32 m0, s28, 13312
s_nop 0
buffer_load_dwordx4 v3, s[4:7], s27 offen sc1 lds
s_add_u32 s27, s27, 32768
buffer_load_dwordx4 v[160:163], v2, s[8:11], s25 offen offset:0
buffer_load_dwordx4 v[164:167], v2, s[8:11], s25 offen offset:64
buffer_load_dwordx4 v[168:171], v2, s[8:11], s25 offen offset:128
buffer_load_dwordx4 v[172:175], v2, s[8:11], s25 offen offset:192
buffer_load_dwordx4 v[176:179], v2, s[8:11], s25 offen offset:256
buffer_load_dwordx4 v[180:183], v2, s[8:11], s25 offen offset:320
buffer_load_dwordx4 v[184:187], v2, s[8:11], s25 offen offset:384
buffer_load_dwordx4 v[188:191], v2, s[8:11], s25 offen offset:448
buffer_load_dwordx4 v[192:195], v2, s[8:11], s25 offen offset:512
buffer_load_dwordx4 v[196:199], v2, s[8:11], s25 offen offset:576
buffer_load_dwordx4 v[200:203], v2, s[8:11], s25 offen offset:640
buffer_load_dwordx4 v[204:207], v2, s[8:11], s25 offen offset:704
buffer_load_dwordx4 v[208:211], v2, s[8:11], s25 offen offset:768
buffer_load_dwordx4 v[212:215], v2, s[8:11], s25 offen offset:832
v_lshrrev_b32 v3, 2, v21
v_lshl_add_u32 v3, v22, 3, v3
v_lshlrev_b32 v3, 7, v3
v_and_b32 v4, 3, v20
v_lshl_add_u32 v3, v4, 3, v3
s_lshl_b32 s22, s3, 5
v_add_u32 v3, s22, v3
s_waitcnt vmcnt(14)
s_barrier
ds_read_b64_tr_b16 v[96:97], v3 offset:0
ds_read_b64_tr_b16 v[98:99], v3 offset:512
ds_read_b64_tr_b16 v[100:101], v3 offset:4096
ds_read_b64_tr_b16 v[102:103], v3 offset:4608
ds_read_b64_tr_b16 v[104:105], v3 offset:8192
ds_read_b64_tr_b16 v[106:107], v3 offset:8704
ds_read_b64_tr_b16 v[108:109], v3 offset:12288
ds_read_b64_tr_b16 v[110:111], v3 offset:12800
ds_read_b64_tr_b16 v[112:113], v3 offset:16384
ds_read_b64_tr_b16 v[114:115], v3 offset:16896
ds_read_b64_tr_b16 v[116:117], v3 offset:20480
ds_read_b64_tr_b16 v[118:119], v3 offset:20992
ds_read_b64_tr_b16 v[120:121], v3 offset:24576
ds_read_b64_tr_b16 v[122:123], v3 offset:25088
s_waitcnt lgkmcnt(0)
ds_read_b64_tr_b16 v[124:125], v3 offset:28672
ds_read_b64_tr_b16 v[126:127], v3 offset:29184
ds_read_b64_tr_b16 v[128:129], v3 offset:32768
ds_read_b64_tr_b16 v[130:131], v3 offset:33280
ds_read_b64_tr_b16 v[132:133], v3 offset:36864
ds_read_b64_tr_b16 v[134:135], v3 offset:37376
ds_read_b64_tr_b16 v[136:137], v3 offset:40960
ds_read_b64_tr_b16 v[138:139], v3 offset:41472
ds_read_b64_tr_b16 v[140:141], v3 offset:45056
ds_read_b64_tr_b16 v[142:143], v3 offset:45568
ds_read_b64_tr_b16 v[144:145], v3 offset:49152
ds_read_b64_tr_b16 v[146:147], v3 offset:49664
ds_read_b64_tr_b16 v[148:149], v3 offset:53248
ds_read_b64_tr_b16 v[150:151], v3 offset:53760
s_waitcnt vmcnt(13)
v_lshlrev_b32 v10, 16, v160
v_and_b32 v11, 0xffff0000, v160
v_lshlrev_b32 v12, 16, v96
v_and_b32 v13, 0xffff0000, v96
v_pk_mul_f32 v[10:11], v[10:11], v[12:13]
v_cvt_pk_bf16_f32 v160, v10, v11
v_lshlrev_b32 v10, 16, v161
v_and_b32 v11, 0xffff0000, v161
v_lshlrev_b32 v12, 16, v97
v_and_b32 v13, 0xffff0000, v97
v_pk_mul_f32 v[10:11], v[10:11], v[12:13]
v_cvt_pk_bf16_f32 v161, v10, v11
v_lshlrev_b32 v10, 16, v162
v_and_b32 v11, 0xffff0000, v162
v_lshlrev_b32 v12, 16, v98
v_and_b32 v13, 0xffff0000, v98
v_pk_mul_f32 v[10:11], v[10:11], v[12:13]
PAD_20:
s_cbranch_execz M_tret
v_cvt_pk_bf16_f32 v162, v10, v11
v_lshlrev_b32 v10, 16, v163
v_and_b32 v11, 0xffff0000, v163
v_lshlrev_b32 v12, 16, v99
v_and_b32 v13, 0xffff0000, v99
v_pk_mul_f32 v[10:11], v[10:11], v[12:13]
v_cvt_pk_bf16_f32 v163, v10, v11
buffer_store_dwordx4 v[160:163], v9, s[12:15], s26 offen offset:0
s_waitcnt vmcnt(13)
v_lshlrev_b32 v10, 16, v164
v_and_b32 v11, 0xffff0000, v164
v_lshlrev_b32 v12, 16, v100
v_and_b32 v13, 0xffff0000, v100
v_pk_mul_f32 v[10:11], v[10:11], v[12:13]
v_cvt_pk_bf16_f32 v164, v10, v11
v_lshlrev_b32 v10, 16, v165
v_and_b32 v11, 0xffff0000, v165
v_lshlrev_b32 v12, 16, v101
v_and_b32 v13, 0xffff0000, v101
v_pk_mul_f32 v[10:11], v[10:11], v[12:13]
v_cvt_pk_bf16_f32 v165, v10, v11
v_lshlrev_b32 v10, 16, v166
v_and_b32 v11, 0xffff0000, v166
v_lshlrev_b32 v12, 16, v102
v_and_b32 v13, 0xffff0000, v102
v_pk_mul_f32 v[10:11], v[10:11], v[12:13]
v_cvt_pk_bf16_f32 v166, v10, v11
v_lshlrev_b32 v10, 16, v167
v_and_b32 v11, 0xffff0000, v167
v_lshlrev_b32 v12, 16, v103
v_and_b32 v13, 0xffff0000, v103
v_pk_mul_f32 v[10:11], v[10:11], v[12:13]
v_cvt_pk_bf16_f32 v167, v10, v11
buffer_store_dwordx4 v[164:167], v9, s[12:15], s26 offen offset:64
s_waitcnt vmcnt(13)
v_lshlrev_b32 v10, 16, v168
v_and_b32 v11, 0xffff0000, v168
v_lshlrev_b32 v12, 16, v104
v_and_b32 v13, 0xffff0000, v104
v_pk_mul_f32 v[10:11], v[10:11], v[12:13]
v_cvt_pk_bf16_f32 v168, v10, v11
v_lshlrev_b32 v10, 16, v169
v_and_b32 v11, 0xffff0000, v169
v_lshlrev_b32 v12, 16, v105
v_and_b32 v13, 0xffff0000, v105
v_pk_mul_f32 v[10:11], v[10:11], v[12:13]
v_cvt_pk_bf16_f32 v169, v10, v11
v_lshlrev_b32 v10, 16, v170
v_and_b32 v11, 0xffff0000, v170
v_lshlrev_b32 v12, 16, v106
v_and_b32 v13, 0xffff0000, v106
v_pk_mul_f32 v[10:11], v[10:11], v[12:13]
v_cvt_pk_bf16_f32 v170, v10, v11
v_lshlrev_b32 v10, 16, v171
v_and_b32 v11, 0xffff0000, v171
v_lshlrev_b32 v12, 16, v107
v_and_b32 v13, 0xffff0000, v107
v_pk_mul_f32 v[10:11], v[10:11], v[12:13]
v_cvt_pk_bf16_f32 v171, v10, v11
buffer_store_dwordx4 v[168:171], v9, s[12:15], s26 offen offset:128
s_waitcnt vmcnt(13)
v_lshlrev_b32 v10, 16, v172
v_and_b32 v11, 0xffff0000, v172
v_lshlrev_b32 v12, 16, v108
v_and_b32 v13, 0xffff0000, v108
v_pk_mul_f32 v[10:11], v[10:11], v[12:13]
v_cvt_pk_bf16_f32 v172, v10, v11
v_lshlrev_b32 v10, 16, v173
v_and_b32 v11, 0xffff0000, v173
v_lshlrev_b32 v12, 16, v109
v_and_b32 v13, 0xffff0000, v109
v_pk_mul_f32 v[10:11], v[10:11], v[12:13]
v_cvt_pk_bf16_f32 v173, v10, v11
v_lshlrev_b32 v10, 16, v174
v_and_b32 v11, 0xffff0000, v174
v_lshlrev_b32 v12, 16, v110
v_and_b32 v13, 0xffff0000, v110
v_pk_mul_f32 v[10:11], v[10:11], v[12:13]
v_cvt_pk_bf16_f32 v174, v10, v11
v_lshlrev_b32 v10, 16, v175
v_and_b32 v11, 0xffff0000, v175
v_lshlrev_b32 v12, 16, v111
v_and_b32 v13, 0xffff0000, v111
v_pk_mul_f32 v[10:11], v[10:11], v[12:13]
v_cvt_pk_bf16_f32 v175, v10, v11
buffer_store_dwordx4 v[172:175], v9, s[12:15], s26 offen offset:192
s_waitcnt vmcnt(13)
v_lshlrev_b32 v10, 16, v176
v_and_b32 v11, 0xffff0000, v176
v_lshlrev_b32 v12, 16, v112
v_and_b32 v13, 0xffff0000, v112
v_pk_mul_f32 v[10:11], v[10:11], v[12:13]
v_cvt_pk_bf16_f32 v176, v10, v11
v_lshlrev_b32 v10, 16, v177
v_and_b32 v11, 0xffff0000, v177
v_lshlrev_b32 v12, 16, v113
v_and_b32 v13, 0xffff0000, v113
v_pk_mul_f32 v[10:11], v[10:11], v[12:13]
v_cvt_pk_bf16_f32 v177, v10, v11
v_lshlrev_b32 v10, 16, v178
v_and_b32 v11, 0xffff0000, v178
v_lshlrev_b32 v12, 16, v114
v_and_b32 v13, 0xffff0000, v114
v_pk_mul_f32 v[10:11], v[10:11], v[12:13]
v_cvt_pk_bf16_f32 v178, v10, v11
v_lshlrev_b32 v10, 16, v179
v_and_b32 v11, 0xffff0000, v179
v_lshlrev_b32 v12, 16, v115
v_and_b32 v13, 0xffff0000, v115
v_pk_mul_f32 v[10:11], v[10:11], v[12:13]
v_cvt_pk_bf16_f32 v179, v10, v11
buffer_store_dwordx4 v[176:179], v9, s[12:15], s26 offen offset:256
s_waitcnt vmcnt(13)
v_lshlrev_b32 v10, 16, v180
v_and_b32 v11, 0xffff0000, v180
v_lshlrev_b32 v12, 16, v116
v_and_b32 v13, 0xffff0000, v116
v_pk_mul_f32 v[10:11], v[10:11], v[12:13]
v_cvt_pk_bf16_f32 v180, v10, v11
v_lshlrev_b32 v10, 16, v181
v_and_b32 v11, 0xffff0000, v181
v_lshlrev_b32 v12, 16, v117
v_and_b32 v13, 0xffff0000, v117
v_pk_mul_f32 v[10:11], v[10:11], v[12:13]
v_cvt_pk_bf16_f32 v181, v10, v11
v_lshlrev_b32 v10, 16, v182
v_and_b32 v11, 0xffff0000, v182
v_lshlrev_b32 v12, 16, v118
v_and_b32 v13, 0xffff0000, v118
v_pk_mul_f32 v[10:11], v[10:11], v[12:13]
v_cvt_pk_bf16_f32 v182, v10, v11
v_lshlrev_b32 v10, 16, v183
v_and_b32 v11, 0xffff0000, v183
v_lshlrev_b32 v12, 16, v119
v_and_b32 v13, 0xffff0000, v119
v_pk_mul_f32 v[10:11], v[10:11], v[12:13]
v_cvt_pk_bf16_f32 v183, v10, v11
buffer_store_dwordx4 v[180:183], v9, s[12:15], s26 offen offset:320
s_waitcnt vmcnt(13)
v_lshlrev_b32 v10, 16, v184
v_and_b32 v11, 0xffff0000, v184
v_lshlrev_b32 v12, 16, v120
v_and_b32 v13, 0xffff0000, v120
v_pk_mul_f32 v[10:11], v[10:11], v[12:13]
v_cvt_pk_bf16_f32 v184, v10, v11
v_lshlrev_b32 v10, 16, v185
v_and_b32 v11, 0xffff0000, v185
v_lshlrev_b32 v12, 16, v121
v_and_b32 v13, 0xffff0000, v121
v_pk_mul_f32 v[10:11], v[10:11], v[12:13]
v_cvt_pk_bf16_f32 v185, v10, v11
v_lshlrev_b32 v10, 16, v186
v_and_b32 v11, 0xffff0000, v186
v_lshlrev_b32 v12, 16, v122
v_and_b32 v13, 0xffff0000, v122
v_pk_mul_f32 v[10:11], v[10:11], v[12:13]
v_cvt_pk_bf16_f32 v186, v10, v11
v_lshlrev_b32 v10, 16, v187
v_and_b32 v11, 0xffff0000, v187
v_lshlrev_b32 v12, 16, v123
v_and_b32 v13, 0xffff0000, v123
v_pk_mul_f32 v[10:11], v[10:11], v[12:13]
v_cvt_pk_bf16_f32 v187, v10, v11
buffer_store_dwordx4 v[184:187], v9, s[12:15], s26 offen offset:384
s_waitcnt lgkmcnt(0)
s_waitcnt vmcnt(13)
v_lshlrev_b32 v10, 16, v188
v_and_b32 v11, 0xffff0000, v188
v_lshlrev_b32 v12, 16, v124
v_and_b32 v13, 0xffff0000, v124
v_pk_mul_f32 v[10:11], v[10:11], v[12:13]
v_cvt_pk_bf16_f32 v188, v10, v11
v_lshlrev_b32 v10, 16, v189
v_and_b32 v11, 0xffff0000, v189
v_lshlrev_b32 v12, 16, v125
v_and_b32 v13, 0xffff0000, v125
v_pk_mul_f32 v[10:11], v[10:11], v[12:13]
v_cvt_pk_bf16_f32 v189, v10, v11
v_lshlrev_b32 v10, 16, v190
v_and_b32 v11, 0xffff0000, v190
v_lshlrev_b32 v12, 16, v126
v_and_b32 v13, 0xffff0000, v126
v_pk_mul_f32 v[10:11], v[10:11], v[12:13]
v_cvt_pk_bf16_f32 v190, v10, v11
v_lshlrev_b32 v10, 16, v191
v_and_b32 v11, 0xffff0000, v191
v_lshlrev_b32 v12, 16, v127
v_and_b32 v13, 0xffff0000, v127
v_pk_mul_f32 v[10:11], v[10:11], v[12:13]
v_cvt_pk_bf16_f32 v191, v10, v11
buffer_store_dwordx4 v[188:191], v9, s[12:15], s26 offen offset:448
s_waitcnt vmcnt(13)
v_lshlrev_b32 v10, 16, v192
v_and_b32 v11, 0xffff0000, v192
v_lshlrev_b32 v12, 16, v128
v_and_b32 v13, 0xffff0000, v128
v_pk_mul_f32 v[10:11], v[10:11], v[12:13]
v_cvt_pk_bf16_f32 v192, v10, v11
v_lshlrev_b32 v10, 16, v193
v_and_b32 v11, 0xffff0000, v193
v_lshlrev_b32 v12, 16, v129
v_and_b32 v13, 0xffff0000, v129
v_pk_mul_f32 v[10:11], v[10:11], v[12:13]
v_cvt_pk_bf16_f32 v193, v10, v11
v_lshlrev_b32 v10, 16, v194
v_and_b32 v11, 0xffff0000, v194
v_lshlrev_b32 v12, 16, v130
v_and_b32 v13, 0xffff0000, v130
v_pk_mul_f32 v[10:11], v[10:11], v[12:13]
v_cvt_pk_bf16_f32 v194, v10, v11
v_lshlrev_b32 v10, 16, v195
v_and_b32 v11, 0xffff0000, v195
v_lshlrev_b32 v12, 16, v131
v_and_b32 v13, 0xffff0000, v131
v_pk_mul_f32 v[10:11], v[10:11], v[12:13]
v_cvt_pk_bf16_f32 v195, v10, v11
buffer_store_dwordx4 v[192:195], v9, s[12:15], s26 offen offset:512
s_waitcnt vmcnt(13)
v_lshlrev_b32 v10, 16, v196
v_and_b32 v11, 0xffff0000, v196
v_lshlrev_b32 v12, 16, v132
v_and_b32 v13, 0xffff0000, v132
v_pk_mul_f32 v[10:11], v[10:11], v[12:13]
v_cvt_pk_bf16_f32 v196, v10, v11
v_lshlrev_b32 v10, 16, v197
v_and_b32 v11, 0xffff0000, v197
v_lshlrev_b32 v12, 16, v133
v_and_b32 v13, 0xffff0000, v133
v_pk_mul_f32 v[10:11], v[10:11], v[12:13]
v_cvt_pk_bf16_f32 v197, v10, v11
v_lshlrev_b32 v10, 16, v198
v_and_b32 v11, 0xffff0000, v198
v_lshlrev_b32 v12, 16, v134
v_and_b32 v13, 0xffff0000, v134
v_pk_mul_f32 v[10:11], v[10:11], v[12:13]
v_cvt_pk_bf16_f32 v198, v10, v11
v_lshlrev_b32 v10, 16, v199
v_and_b32 v11, 0xffff0000, v199
v_lshlrev_b32 v12, 16, v135
v_and_b32 v13, 0xffff0000, v135
v_pk_mul_f32 v[10:11], v[10:11], v[12:13]
v_cvt_pk_bf16_f32 v199, v10, v11
buffer_store_dwordx4 v[196:199], v9, s[12:15], s26 offen offset:576
s_waitcnt vmcnt(13)
v_lshlrev_b32 v10, 16, v200
v_and_b32 v11, 0xffff0000, v200
v_lshlrev_b32 v12, 16, v136
v_and_b32 v13, 0xffff0000, v136
v_pk_mul_f32 v[10:11], v[10:11], v[12:13]
v_cvt_pk_bf16_f32 v200, v10, v11
v_lshlrev_b32 v10, 16, v201
v_and_b32 v11, 0xffff0000, v201
v_lshlrev_b32 v12, 16, v137
v_and_b32 v13, 0xffff0000, v137
v_pk_mul_f32 v[10:11], v[10:11], v[12:13]
v_cvt_pk_bf16_f32 v201, v10, v11
v_lshlrev_b32 v10, 16, v202
v_and_b32 v11, 0xffff0000, v202
v_lshlrev_b32 v12, 16, v138
v_and_b32 v13, 0xffff0000, v138
v_pk_mul_f32 v[10:11], v[10:11], v[12:13]
v_cvt_pk_bf16_f32 v202, v10, v11
v_lshlrev_b32 v10, 16, v203
v_and_b32 v11, 0xffff0000, v203
v_lshlrev_b32 v12, 16, v139
v_and_b32 v13, 0xffff0000, v139
v_pk_mul_f32 v[10:11], v[10:11], v[12:13]
v_cvt_pk_bf16_f32 v203, v10, v11
buffer_store_dwordx4 v[200:203], v9, s[12:15], s26 offen offset:640
s_waitcnt vmcnt(13)
v_lshlrev_b32 v10, 16, v204
v_and_b32 v11, 0xffff0000, v204
v_lshlrev_b32 v12, 16, v140
v_and_b32 v13, 0xffff0000, v140
v_pk_mul_f32 v[10:11], v[10:11], v[12:13]
v_cvt_pk_bf16_f32 v204, v10, v11
v_lshlrev_b32 v10, 16, v205
v_and_b32 v11, 0xffff0000, v205
v_lshlrev_b32 v12, 16, v141
v_and_b32 v13, 0xffff0000, v141
v_pk_mul_f32 v[10:11], v[10:11], v[12:13]
v_cvt_pk_bf16_f32 v205, v10, v11
v_lshlrev_b32 v10, 16, v206
v_and_b32 v11, 0xffff0000, v206
v_lshlrev_b32 v12, 16, v142
v_and_b32 v13, 0xffff0000, v142
v_pk_mul_f32 v[10:11], v[10:11], v[12:13]
v_cvt_pk_bf16_f32 v206, v10, v11
v_lshlrev_b32 v10, 16, v207
v_and_b32 v11, 0xffff0000, v207
v_lshlrev_b32 v12, 16, v143
v_and_b32 v13, 0xffff0000, v143
v_pk_mul_f32 v[10:11], v[10:11], v[12:13]
v_cvt_pk_bf16_f32 v207, v10, v11
buffer_store_dwordx4 v[204:207], v9, s[12:15], s26 offen offset:704
s_waitcnt vmcnt(13)
v_lshlrev_b32 v10, 16, v208
v_and_b32 v11, 0xffff0000, v208
v_lshlrev_b32 v12, 16, v144
v_and_b32 v13, 0xffff0000, v144
v_pk_mul_f32 v[10:11], v[10:11], v[12:13]
v_cvt_pk_bf16_f32 v208, v10, v11
v_lshlrev_b32 v10, 16, v209
v_and_b32 v11, 0xffff0000, v209
v_lshlrev_b32 v12, 16, v145
v_and_b32 v13, 0xffff0000, v145
v_pk_mul_f32 v[10:11], v[10:11], v[12:13]
v_cvt_pk_bf16_f32 v209, v10, v11
v_lshlrev_b32 v10, 16, v210
v_and_b32 v11, 0xffff0000, v210
v_lshlrev_b32 v12, 16, v146
v_and_b32 v13, 0xffff0000, v146
v_pk_mul_f32 v[10:11], v[10:11], v[12:13]
v_cvt_pk_bf16_f32 v210, v10, v11
v_lshlrev_b32 v10, 16, v211
v_and_b32 v11, 0xffff0000, v211
v_lshlrev_b32 v12, 16, v147
v_and_b32 v13, 0xffff0000, v147
v_pk_mul_f32 v[10:11], v[10:11], v[12:13]
v_cvt_pk_bf16_f32 v211, v10, v11
buffer_store_dwordx4 v[208:211], v9, s[12:15], s26 offen offset:768
s_waitcnt vmcnt(13)
v_lshlrev_b32 v10, 16, v212
v_and_b32 v11, 0xffff0000, v212
v_lshlrev_b32 v12, 16, v148
v_and_b32 v13, 0xffff0000, v148
v_pk_mul_f32 v[10:11], v[10:11], v[12:13]
v_cvt_pk_bf16_f32 v212, v10, v11
v_lshlrev_b32 v10, 16, v213
v_and_b32 v11, 0xffff0000, v213
v_lshlrev_b32 v12, 16, v149
v_and_b32 v13, 0xffff0000, v149
v_pk_mul_f32 v[10:11], v[10:11], v[12:13]
v_cvt_pk_bf16_f32 v213, v10, v11
v_lshlrev_b32 v10, 16, v214
v_and_b32 v11, 0xffff0000, v214
v_lshlrev_b32 v12, 16, v150
v_and_b32 v13, 0xffff0000, v150
v_pk_mul_f32 v[10:11], v[10:11], v[12:13]
v_cvt_pk_bf16_f32 v214, v10, v11
v_lshlrev_b32 v10, 16, v215
v_and_b32 v11, 0xffff0000, v215
v_lshlrev_b32 v12, 16, v151
v_and_b32 v13, 0xffff0000, v151
v_pk_mul_f32 v[10:11], v[10:11], v[12:13]
v_cvt_pk_bf16_f32 v215, v10, v11
buffer_store_dwordx4 v[212:215], v9, s[12:15], s26 offen offset:832
s_branch M_fin
M_rslow:
Lp_9251:
buffer_load_dword v18, v19, s[4:7], s33 offen offset:0 sc1
s_waitcnt vmcnt(0)
v_cmp_gt_u32 vcc, 1, v18
s_cbranch_vccz Lpd_9252
s_sleep 8
s_sub_u32 s101, s101, 1
s_cbranch_scc0 Lp_9251
s_mov_b32 s101, 0
Lpd_9252:
s_branch M_rjoin
PAD_21:
s_cbranch_execz PAD_25
M_V:
v_mfma_f32_16x16x32_bf16 v[32:35], a[0:3], a[128:131], 0
s_add_u32 m0, s29, 114688
ds_read_b64_tr_b16 a[136:137], v5 offset:0
v_mfma_f32_16x16x32_bf16 v[32:35], a[4:7], a[132:135], v[32:35]
s_mov_b32 s32, 1024
buffer_load_dwordx4 v16, s[12:15], s27 offen offset:0 lds
v_mfma_f32_16x16x32_bf16 v[36:39], a[8:11], a[128:131], 0
s_mov_b32 s33, 31744
ds_read_b64_tr_b16 a[138:139], v5 offset:2048
v_mfma_f32_16x16x32_bf16 v[36:39], a[12:15], a[132:135], v[36:39]
s_mov_b32 s34, 4294935552
v_mfma_f32_16x16x32_bf16 v[40:43], a[16:19], a[128:131], 0
s_mov_b32 s35, 4294935552
ds_read_b64_tr_b16 a[140:141], v5 offset:16384
v_mfma_f32_16x16x32_bf16 v[40:43], a[20:23], a[132:135], v[40:43]
s_mov_b32 s36, 4294935552
buffer_load_dwordx4 v17, s[12:15], s27 offen offset:1024 lds
v_mfma_f32_16x16x32_bf16 v[44:47], a[24:27], a[128:131], 0
s_mov_b32 s30, 8
ds_read_b64_tr_b16 a[142:143], v5 offset:18432
v_mfma_f32_16x16x32_bf16 v[44:47], a[28:31], a[132:135], v[44:47]
s_mov_b32 s82, 3221225472
v_mfma_f32_16x16x32_bf16 v[48:51], a[32:35], a[128:131], 0
s_mul_hi_u32 s38, s2, 613566757
v_mfma_f32_16x16x32_bf16 v[48:51], a[36:39], a[132:135], v[48:51]
s_mul_i32 s39, s38, 7
buffer_load_dwordx4 v18, s[12:15], s27 offen offset:2048 lds
v_mfma_f32_16x16x32_bf16 v[52:55], a[40:43], a[128:131], 0
s_sub_u32 s39, s2, s39
v_mov_b32 v246, 0
v_mov_b32 v229, 0
v_mfma_f32_16x16x32_bf16 v[52:55], a[44:47], a[132:135], v[52:55]
v_mov_b32 v231, 0
v_mfma_f32_16x16x32_bf16 v[56:59], a[48:51], a[128:131], 0
s_mov_b32 s60, s90
v_mfma_f32_16x16x32_bf16 v[56:59], a[52:55], a[132:135], v[56:59]
s_mov_b32 s61, s91
buffer_load_dwordx4 v19, s[12:15], s27 offen offset:3072 lds
v_mfma_f32_16x16x32_bf16 v[60:63], a[56:59], a[128:131], 0
s_add_u32 s27, s27, 524288
v_mfma_f32_16x16x32_bf16 v[60:63], a[60:63], a[132:135], v[60:63]
s_waitcnt lgkmcnt(0)
s_mov_b32 s62, 256
v_mfma_f32_16x16x32_bf16 v[64:67], a[0:3], a[136:139], 0
s_add_u32 m0, s28, 0
ds_read_b64_tr_b16 a[128:129], v6 offset:0
v_mfma_f32_16x16x32_bf16 v[64:67], a[4:7], a[140:143], v[64:67]
s_mov_b32 s63, 0x20000
buffer_load_dwordx4 v12, s[8:11], s24 offen offset:0 lds
v_mfma_f32_16x16x32_bf16 v[68:71], a[8:11], a[136:139], 0
s_mul_hi_u32 s55, s2, 1431655766
ds_read_b64_tr_b16 a[130:131], v6 offset:2048
v_mfma_f32_16x16x32_bf16 v[68:71], a[12:15], a[140:143], v[68:71]
s_mul_i32 s55, s55, 3
v_mfma_f32_16x16x32_bf16 v[72:75], a[16:19], a[136:139], 0
s_sub_u32 s55, s2, s55
ds_read_b64_tr_b16 a[132:133], v6 offset:16384
v_mfma_f32_16x16x32_bf16 v[72:75], a[20:23], a[140:143], v[72:75]
s_add_u32 s55, s55, 5
buffer_load_dwordx4 v13, s[8:11], s24 offen offset:1024 lds
v_mfma_f32_16x16x32_bf16 v[76:79], a[24:27], a[136:139], 0
s_lshr_b32 s22, s2, 4
ds_read_b64_tr_b16 a[134:135], v6 offset:18432
v_mfma_f32_16x16x32_bf16 v[76:79], a[28:31], a[140:143], v[76:79]
s_lshl_b32 s23, s20, 5
v_mfma_f32_16x16x32_bf16 v[80:83], a[32:35], a[136:139], 0
s_add_u32 s23, s23, s22
v_mfma_f32_16x16x32_bf16 v[80:83], a[36:39], a[140:143], v[80:83]
s_lshl_b32 s23, s23, 2
buffer_load_dwordx4 v14, s[8:11], s24 offen offset:2048 lds
v_mfma_f32_16x16x32_bf16 v[84:87], a[40:43], a[136:139], 0
s_and_b32 s22, s2, 16
v_mfma_f32_16x16x32_bf16 v[84:87], a[44:47], a[140:143], v[84:87]
s_lshl_b32 s22, s22, 7
v_mfma_f32_16x16x32_bf16 v[88:91], a[48:51], a[136:139], 0
s_add_u32 s23, s23, s22
v_mov_b32 v28, 3221225472
v_writelane_b32 v28, s23, 0
v_mfma_f32_16x16x32_bf16 v[88:91], a[52:55], a[140:143], v[88:91]
s_add_u32 s56, s23, 16384
buffer_load_dwordx4 v15, s[8:11], s24 offen offset:3072 lds
v_mfma_f32_16x16x32_bf16 v[92:95], a[56:59], a[136:139], 0
s_add_u32 s24, s24, 128
v_writelane_b32 v28, s56, 1
v_mfma_f32_16x16x32_bf16 v[92:95], a[60:63], a[140:143], v[92:95]
s_waitcnt lgkmcnt(0)
s_add_u32 s56, s23, 4096
v_writelane_b32 v28, s56, 2
v_mfma_f32_16x16x32_bf16 v[96:99], a[0:3], a[128:131], 0
s_add_u32 m0, s28, 4096
ds_read_b64_tr_b16 a[136:137], v7 offset:0
v_mfma_f32_16x16x32_bf16 v[96:99], a[4:7], a[132:135], v[96:99]
s_sub_u32 s37, 15, s21
buffer_load_dwordx4 v12, s[8:11], s25 offen offset:0 lds
v_mfma_f32_16x16x32_bf16 v[100:103], a[8:11], a[128:131], 0
ds_read_b64_tr_b16 a[138:139], v7 offset:2048
v_mfma_f32_16x16x32_bf16 v[100:103], a[12:15], a[132:135], v[100:103]
v_mfma_f32_16x16x32_bf16 v[104:107], a[16:19], a[128:131], 0
ds_read_b64_tr_b16 a[140:141], v7 offset:16384
v_mfma_f32_16x16x32_bf16 v[104:107], a[20:23], a[132:135], v[104:107]
buffer_load_dwordx4 v13, s[8:11], s25 offen offset:1024 lds
v_mfma_f32_16x16x32_bf16 v[108:111], a[24:27], a[128:131], 0
ds_read_b64_tr_b16 a[142:143], v7 offset:18432
v_mfma_f32_16x16x32_bf16 v[108:111], a[28:31], a[132:135], v[108:111]
v_mfma_f32_16x16x32_bf16 v[112:115], a[32:35], a[128:131], 0
v_mfma_f32_16x16x32_bf16 v[112:115], a[36:39], a[132:135], v[112:115]
buffer_load_dwordx4 v14, s[8:11], s25 offen offset:2048 lds
v_mfma_f32_16x16x32_bf16 v[116:119], a[40:43], a[128:131], 0
v_mfma_f32_16x16x32_bf16 v[116:119], a[44:47], a[132:135], v[116:119]
v_mfma_f32_16x16x32_bf16 v[120:123], a[48:51], a[128:131], 0
v_mfma_f32_16x16x32_bf16 v[120:123], a[52:55], a[132:135], v[120:123]
buffer_load_dwordx4 v15, s[8:11], s25 offen offset:3072 lds
v_mfma_f32_16x16x32_bf16 v[124:127], a[56:59], a[128:131], 0
s_add_u32 s25, s25, 128
v_mfma_f32_16x16x32_bf16 v[124:127], a[60:63], a[132:135], v[124:127]
s_waitcnt vmcnt(17) lgkmcnt(0)
s_barrier
v_mfma_f32_16x16x32_bf16 v[128:131], a[0:3], a[136:139], 0
ds_read_b64_tr_b16 a[128:129], v8 offset:0
v_mfma_f32_16x16x32_bf16 v[128:131], a[4:7], a[140:143], v[128:131]
buffer_load_dword v21, v20, s[16:19], s43 offen
v_mfma_f32_16x16x32_bf16 v[132:135], a[8:11], a[136:139], 0
s_add_u32 s43, s43, s47
ds_read_b64_tr_b16 a[130:131], v8 offset:2048
v_mfma_f32_16x16x32_bf16 v[132:135], a[12:15], a[140:143], v[132:135]
s_cmp_ge_u32 s43, s51
v_mfma_f32_16x16x32_bf16 v[136:139], a[16:19], a[136:139], 0
s_cselect_b32 s43, 0, s43
ds_read_b64_tr_b16 a[132:133], v8 offset:16384
v_mfma_f32_16x16x32_bf16 v[136:139], a[20:23], a[140:143], v[136:139]
s_cselect_b32 s51, s42, s51
v_mfma_f32_16x16x32_bf16 v[140:143], a[24:27], a[136:139], 0
s_cselect_b64 s[16:17], s[40:41], s[16:17]
ds_read_b64_tr_b16 a[134:135], v8 offset:18432
v_mfma_f32_16x16x32_bf16 v[140:143], a[28:31], a[140:143], v[140:143]
s_cselect_b32 s18, s42, s18
v_mfma_f32_16x16x32_bf16 v[144:147], a[32:35], a[136:139], 0
s_cselect_b64 s[40:41], s[44:45], s[40:41]
ds_read_b128 a[64:67], v2 offset:32768
v_mfma_f32_16x16x32_bf16 v[144:147], a[36:39], a[140:143], v[144:147]
s_cselect_b32 s42, s46, s42
v_mfma_f32_16x16x32_bf16 v[148:151], a[40:43], a[136:139], 0
s_cselect_b32 s46, 0, s46
ds_read_b128 a[68:71], v3 offset:32768
v_mfma_f32_16x16x32_bf16 v[148:151], a[44:47], a[140:143], v[148:151]
ds_read_b128 a[72:75], v2 offset:34816
v_mfma_f32_16x16x32_bf16 v[152:155], a[48:51], a[136:139], 0
ds_read_b128 a[76:79], v3 offset:34816
v_mfma_f32_16x16x32_bf16 v[152:155], a[52:55], a[140:143], v[152:155]
buffer_load_dword v21, v20, s[16:19], s43 offen
v_mfma_f32_16x16x32_bf16 v[156:159], a[56:59], a[136:139], 0
s_add_u32 s43, s43, s47
ds_read_b128 a[80:83], v2 offset:36864
v_mfma_f32_16x16x32_bf16 v[156:159], a[60:63], a[140:143], v[156:159]
s_waitcnt lgkmcnt(5)
s_cmp_ge_u32 s43, s51
ds_read_b128 a[84:87], v3 offset:36864
v_mfma_f32_16x16x32_bf16 v[160:163], a[0:3], a[128:131], 0
s_cselect_b32 s43, 0, s43
ds_read_b64_tr_b16 a[136:137], v9 offset:0
v_mfma_f32_16x16x32_bf16 v[160:163], a[4:7], a[132:135], v[160:163]
s_cselect_b32 s51, s42, s51
v_mfma_f32_16x16x32_bf16 v[164:167], a[8:11], a[128:131], 0
s_cselect_b64 s[16:17], s[40:41], s[16:17]
ds_read_b64_tr_b16 a[138:139], v9 offset:2048
v_mfma_f32_16x16x32_bf16 v[164:167], a[12:15], a[132:135], v[164:167]
s_cselect_b32 s18, s42, s18
v_mfma_f32_16x16x32_bf16 v[168:171], a[16:19], a[128:131], 0
s_cselect_b64 s[40:41], s[44:45], s[40:41]
ds_read_b64_tr_b16 a[140:141], v9 offset:16384
v_mfma_f32_16x16x32_bf16 v[168:171], a[20:23], a[132:135], v[168:171]
s_cselect_b32 s42, s46, s42
v_mfma_f32_16x16x32_bf16 v[172:175], a[24:27], a[128:131], 0
s_cselect_b32 s46, 0, s46
ds_read_b64_tr_b16 a[142:143], v9 offset:18432
v_mfma_f32_16x16x32_bf16 v[172:175], a[28:31], a[132:135], v[172:175]
s_bitcmp1_b32 s2, 4
s_cselect_b32 s37, s21, s37
s_lshl_b32 s56, s37, 5
v_mfma_f32_16x16x32_bf16 v[176:179], a[32:35], a[128:131], 0
s_add_u32 s56, s56, s20
s_lshl_b32 s56, s56, 2
s_add_u32 s56, s56, 8192
v_mfma_f32_16x16x32_bf16 v[176:179], a[36:39], a[132:135], v[176:179]
v_writelane_b32 v28, s56, 3
v_mfma_f32_16x16x32_bf16 v[180:183], a[40:43], a[128:131], 0
s_add_u32 s56, s56, 2048
ds_read_b128 a[88:91], v2 offset:38912
v_writelane_b32 v28, s56, 6
v_mfma_f32_16x16x32_bf16 v[180:183], a[44:47], a[132:135], v[180:183]
s_lshl_b32 s56, s2, 2
s_add_u32 s56, s56, 12288
ds_read_b128 a[92:95], v3 offset:38912
v_mfma_f32_16x16x32_bf16 v[184:187], a[48:51], a[128:131], 0
s_waitcnt lgkmcnt(2)
ds_read_b128 a[96:99], v2 offset:40960
v_writelane_b32 v28, s56, 4
v_mfma_f32_16x16x32_bf16 v[184:187], a[52:55], a[132:135], v[184:187]
s_lshl_b32 s56, s39, 5
s_add_u32 s56, s56, s38
s_lshl_b32 s56, s56, 2
v_mfma_f32_16x16x32_bf16 v[188:191], a[56:59], a[128:131], 0
s_add_u32 s56, s56, 20480
s_cmp_lt_u32 s2, 224
ds_read_b128 a[100:103], v3 offset:40960
v_mfma_f32_16x16x32_bf16 v[188:191], a[60:63], a[132:135], v[188:191]
s_cselect_b32 s56, s56, 3221225472
ds_read_b128 a[104:107], v2 offset:43008
v_writelane_b32 v28, s56, 7
v_mfma_f32_16x16x32_bf16 v[192:195], a[0:3], a[136:139], 0
s_cmp_eq_u32 s3, 0
s_cselect_b32 s56, 94371840, 3221225472
ds_read_b64_tr_b16 a[128:129], v10 offset:0
v_mfma_f32_16x16x32_bf16 v[192:195], a[4:7], a[140:143], v[192:195]
buffer_store_dword v246, v28, s[4:7], s56 offen sc1
v_mfma_f32_16x16x32_bf16 v[196:199], a[8:11], a[136:139], 0
ds_read_b64_tr_b16 a[130:131], v10 offset:2048
v_mov_b32 v27, 1
v_mfma_f32_16x16x32_bf16 v[196:199], a[12:15], a[140:143], v[196:199]
v_cmp_eq_u32 vcc, 0, v0
v_mov_b32 v26, 3221225472
v_mfma_f32_16x16x32_bf16 v[200:203], a[16:19], a[136:139], 0
s_lshl_b32 s31, s20, 20
s_lshl_b32 s22, s21, 17
ds_read_b64_tr_b16 a[132:133], v10 offset:16384
v_mfma_f32_16x16x32_bf16 v[200:203], a[20:23], a[140:143], v[200:203]
v_cndmask_b32 v26, v26, v246, vcc
v_mfma_f32_16x16x32_bf16 v[204:207], a[24:27], a[136:139], 0
s_add_u32 s31, s31, s22
s_lshr_b32 s22, s3, 1
ds_read_b64_tr_b16 a[134:135], v10 offset:18432
v_mfma_f32_16x16x32_bf16 v[204:207], a[28:31], a[140:143], v[204:207]
s_lshl_b32 s22, s22, 16
s_add_u32 s31, s31, s22
s_and_b32 s22, s3, 1
v_mfma_f32_16x16x32_bf16 v[208:211], a[32:35], a[136:139], 0
s_lshl_b32 s22, s22, 14
s_add_u32 s31, s31, s22
s_add_u32 s31, s31, 16777216
v_mfma_f32_16x16x32_bf16 v[208:211], a[36:39], a[140:143], v[208:211]
v_mfma_f32_16x16x32_bf16 v[212:215], a[40:43], a[136:139], 0
ds_read_b128 a[108:111], v3 offset:43008
v_mfma_f32_16x16x32_bf16 v[212:215], a[44:47], a[140:143], v[212:215]
ds_read_b128 a[112:115], v2 offset:45056
v_mfma_f32_16x16x32_bf16 v[216:219], a[48:51], a[136:139], 0
ds_read_b128 a[116:119], v3 offset:45056
v_mfma_f32_16x16x32_bf16 v[216:219], a[52:55], a[140:143], v[216:219]
v_mfma_f32_16x16x32_bf16 v[220:223], a[56:59], a[136:139], 0
ds_read_b128 a[120:123], v2 offset:47104
v_mfma_f32_16x16x32_bf16 v[220:223], a[60:63], a[140:143], v[220:223]
s_waitcnt lgkmcnt(4)
ds_read_b128 a[124:127], v3 offset:47104
v_mfma_f32_16x16x32_bf16 a[192:195], a[0:3], a[128:131], 0
ds_read_b64_tr_b16 a[136:137], v11 offset:0
v_mfma_f32_16x16x32_bf16 a[192:195], a[4:7], a[132:135], a[192:195]
PAD_22:
s_cbranch_execz PAD_26
v_mfma_f32_16x16x32_bf16 a[196:199], a[8:11], a[128:131], 0
ds_read_b64_tr_b16 a[138:139], v11 offset:2048
v_mfma_f32_16x16x32_bf16 a[196:199], a[12:15], a[132:135], a[196:199]
v_mfma_f32_16x16x32_bf16 a[200:203], a[16:19], a[128:131], 0
ds_read_b64_tr_b16 a[140:141], v11 offset:16384
v_mfma_f32_16x16x32_bf16 a[200:203], a[20:23], a[132:135], a[200:203]
v_mfma_f32_16x16x32_bf16 a[204:207], a[24:27], a[128:131], 0
ds_read_b64_tr_b16 a[142:143], v11 offset:18432
v_mfma_f32_16x16x32_bf16 a[204:207], a[28:31], a[132:135], a[204:207]
v_mfma_f32_16x16x32_bf16 a[208:211], a[32:35], a[128:131], 0
v_mfma_f32_16x16x32_bf16 a[208:211], a[36:39], a[132:135], a[208:211]
v_mfma_f32_16x16x32_bf16 a[212:215], a[40:43], a[128:131], 0
v_mfma_f32_16x16x32_bf16 a[212:215], a[44:47], a[132:135], a[212:215]
v_mfma_f32_16x16x32_bf16 a[216:219], a[48:51], a[128:131], 0
v_mfma_f32_16x16x32_bf16 a[216:219], a[52:55], a[132:135], a[216:219]
v_mfma_f32_16x16x32_bf16 a[220:223], a[56:59], a[128:131], 0
s_waitcnt vmcnt(3) lgkmcnt(0)
v_mfma_f32_16x16x32_bf16 a[220:223], a[60:63], a[132:135], a[220:223]
s_barrier
v_mfma_f32_16x16x32_bf16 a[224:227], a[0:3], a[136:139], 0
s_add_u32 m0, s29, 65536
ds_read_b64_tr_b16 a[128:129], v4 offset:32768
v_mfma_f32_16x16x32_bf16 a[224:227], a[4:7], a[140:143], a[224:227]
buffer_load_dwordx4 v16, s[12:15], s26 offen offset:0 lds
v_mfma_f32_16x16x32_bf16 a[228:231], a[8:11], a[136:139], 0
ds_read_b64_tr_b16 a[130:131], v4 offset:34816
v_mfma_f32_16x16x32_bf16 a[228:231], a[12:15], a[140:143], a[228:231]
v_mfma_f32_16x16x32_bf16 a[232:235], a[16:19], a[136:139], 0
ds_read_b64_tr_b16 a[132:133], v4 offset:49152
v_mfma_f32_16x16x32_bf16 a[232:235], a[20:23], a[140:143], a[232:235]
buffer_load_dwordx4 v17, s[12:15], s26 offen offset:1024 lds
v_mfma_f32_16x16x32_bf16 a[236:239], a[24:27], a[136:139], 0
ds_read_b64_tr_b16 a[134:135], v4 offset:51200
v_mfma_f32_16x16x32_bf16 a[236:239], a[28:31], a[140:143], a[236:239]
v_mfma_f32_16x16x32_bf16 a[240:243], a[32:35], a[136:139], 0
v_mfma_f32_16x16x32_bf16 a[240:243], a[36:39], a[140:143], a[240:243]
buffer_load_dwordx4 v18, s[12:15], s26 offen offset:2048 lds
v_mfma_f32_16x16x32_bf16 a[244:247], a[40:43], a[136:139], 0
v_mfma_f32_16x16x32_bf16 a[244:247], a[44:47], a[140:143], a[244:247]
v_mfma_f32_16x16x32_bf16 a[248:251], a[48:51], a[136:139], 0
v_mfma_f32_16x16x32_bf16 a[248:251], a[52:55], a[140:143], a[248:251]
buffer_load_dwordx4 v19, s[12:15], s26 offen offset:3072 lds
v_mfma_f32_16x16x32_bf16 a[252:255], a[56:59], a[136:139], 0
s_add_u32 s26, s26, 524288
v_mfma_f32_16x16x32_bf16 a[252:255], a[60:63], a[140:143], a[252:255]
s_waitcnt lgkmcnt(0)
Lg_501:
v_mfma_f32_16x16x32_bf16 v[32:35], a[64:67], a[128:131], v[32:35]
s_add_u32 m0, s29, 81920
ds_read_b64_tr_b16 a[136:137], v5 offset:32768
v_mfma_f32_16x16x32_bf16 v[32:35], a[68:71], a[132:135], v[32:35]
buffer_load_dwordx4 v16, s[12:15], s27 offen offset:0 lds
v_mfma_f32_16x16x32_bf16 v[36:39], a[72:75], a[128:131], v[36:39]
ds_read_b64_tr_b16 a[138:139], v5 offset:34816
v_mfma_f32_16x16x32_bf16 v[36:39], a[76:79], a[132:135], v[36:39]
v_mfma_f32_16x16x32_bf16 v[40:43], a[80:83], a[128:131], v[40:43]
ds_read_b64_tr_b16 a[140:141], v5 offset:49152
v_mfma_f32_16x16x32_bf16 v[40:43], a[84:87], a[132:135], v[40:43]
buffer_load_dwordx4 v17, s[12:15], s27 offen offset:1024 lds
v_mfma_f32_16x16x32_bf16 v[44:47], a[88:91], a[128:131], v[44:47]
ds_read_b64_tr_b16 a[142:143], v5 offset:51200
v_mfma_f32_16x16x32_bf16 v[44:47], a[92:95], a[132:135], v[44:47]
v_mfma_f32_16x16x32_bf16 v[48:51], a[96:99], a[128:131], v[48:51]
ds_read_b128 a[0:3], v2 offset:0
v_mfma_f32_16x16x32_bf16 v[48:51], a[100:103], a[132:135], v[48:51]
buffer_load_dwordx4 v18, s[12:15], s27 offen offset:2048 lds
v_mfma_f32_16x16x32_bf16 v[52:55], a[104:107], a[128:131], v[52:55]
ds_read_b128 a[4:7], v3 offset:0
v_mfma_f32_16x16x32_bf16 v[52:55], a[108:111], a[132:135], v[52:55]
v_mfma_f32_16x16x32_bf16 v[56:59], a[112:115], a[128:131], v[56:59]
v_mfma_f32_16x16x32_bf16 v[56:59], a[116:119], a[132:135], v[56:59]
buffer_load_dwordx4 v19, s[12:15], s27 offen offset:3072 lds
v_mfma_f32_16x16x32_bf16 v[60:63], a[120:123], a[128:131], v[60:63]
s_add_u32 s27, s27, 524288
ds_read_b128 a[8:11], v2 offset:2048
v_mfma_f32_16x16x32_bf16 v[60:63], a[124:127], a[132:135], v[60:63]
s_waitcnt lgkmcnt(3)
v_mfma_f32_16x16x32_bf16 v[64:67], a[64:67], a[136:139], v[64:67]
s_add_u32 m0, s28, 32768
ds_read_b64_tr_b16 a[128:129], v6 offset:32768
v_mfma_f32_16x16x32_bf16 v[64:67], a[68:71], a[140:143], v[64:67]
buffer_load_dwordx4 v12, s[8:11], s24 offen offset:0 lds
v_mfma_f32_16x16x32_bf16 v[68:71], a[72:75], a[136:139], v[68:71]
ds_read_b64_tr_b16 a[130:131], v6 offset:34816
v_mfma_f32_16x16x32_bf16 v[68:71], a[76:79], a[140:143], v[68:71]
v_mfma_f32_16x16x32_bf16 v[72:75], a[80:83], a[136:139], v[72:75]
ds_read_b64_tr_b16 a[132:133], v6 offset:49152
v_mfma_f32_16x16x32_bf16 v[72:75], a[84:87], a[140:143], v[72:75]
buffer_load_dwordx4 v13, s[8:11], s24 offen offset:1024 lds
v_mfma_f32_16x16x32_bf16 v[76:79], a[88:91], a[136:139], v[76:79]
ds_read_b64_tr_b16 a[134:135], v6 offset:51200
v_mfma_f32_16x16x32_bf16 v[76:79], a[92:95], a[140:143], v[76:79]
v_mfma_f32_16x16x32_bf16 v[80:83], a[96:99], a[136:139], v[80:83]
ds_read_b128 a[12:15], v3 offset:2048
v_mfma_f32_16x16x32_bf16 v[80:83], a[100:103], a[140:143], v[80:83]
buffer_load_dwordx4 v14, s[8:11], s24 offen offset:2048 lds
v_mfma_f32_16x16x32_bf16 v[84:87], a[104:107], a[136:139], v[84:87]
v_mfma_f32_16x16x32_bf16 v[84:87], a[108:111], a[140:143], v[84:87]
v_mfma_f32_16x16x32_bf16 v[88:91], a[112:115], a[136:139], v[88:91]
ds_read_b128 a[16:19], v2 offset:4096
v_mfma_f32_16x16x32_bf16 v[88:91], a[116:119], a[140:143], v[88:91]
buffer_load_dwordx4 v15, s[8:11], s24 offen offset:3072 lds
v_mfma_f32_16x16x32_bf16 v[92:95], a[120:123], a[136:139], v[92:95]
s_add_u32 s24, s24, 128
ds_read_b128 a[20:23], v3 offset:4096
v_mfma_f32_16x16x32_bf16 v[92:95], a[124:127], a[140:143], v[92:95]
s_waitcnt lgkmcnt(3)
v_mfma_f32_16x16x32_bf16 v[96:99], a[64:67], a[128:131], v[96:99]
s_add_u32 m0, s28, 36864
ds_read_b64_tr_b16 a[136:137], v7 offset:32768
v_mfma_f32_16x16x32_bf16 v[96:99], a[68:71], a[132:135], v[96:99]
buffer_load_dwordx4 v12, s[8:11], s25 offen offset:0 lds
v_mfma_f32_16x16x32_bf16 v[100:103], a[72:75], a[128:131], v[100:103]
ds_read_b64_tr_b16 a[138:139], v7 offset:34816
v_mfma_f32_16x16x32_bf16 v[100:103], a[76:79], a[132:135], v[100:103]
v_mfma_f32_16x16x32_bf16 v[104:107], a[80:83], a[128:131], v[104:107]
ds_read_b64_tr_b16 a[140:141], v7 offset:49152
v_mfma_f32_16x16x32_bf16 v[104:107], a[84:87], a[132:135], v[104:107]
buffer_load_dwordx4 v13, s[8:11], s25 offen offset:1024 lds
v_mfma_f32_16x16x32_bf16 v[108:111], a[88:91], a[128:131], v[108:111]
ds_read_b64_tr_b16 a[142:143], v7 offset:51200
v_mfma_f32_16x16x32_bf16 v[108:111], a[92:95], a[132:135], v[108:111]
v_mfma_f32_16x16x32_bf16 v[112:115], a[96:99], a[128:131], v[112:115]
v_mfma_f32_16x16x32_bf16 v[112:115], a[100:103], a[132:135], v[112:115]
buffer_load_dwordx4 v14, s[8:11], s25 offen offset:2048 lds
v_mfma_f32_16x16x32_bf16 v[116:119], a[104:107], a[128:131], v[116:119]
ds_read_b128 a[24:27], v2 offset:6144
v_mfma_f32_16x16x32_bf16 v[116:119], a[108:111], a[132:135], v[116:119]
v_mfma_f32_16x16x32_bf16 v[120:123], a[112:115], a[128:131], v[120:123]
ds_read_b128 a[28:31], v3 offset:6144
v_mfma_f32_16x16x32_bf16 v[120:123], a[116:119], a[132:135], v[120:123]
buffer_load_dwordx4 v15, s[8:11], s25 offen offset:3072 lds
v_mfma_f32_16x16x32_bf16 v[124:127], a[120:123], a[128:131], v[124:127]
s_add_u32 s25, s25, 128
v_mfma_f32_16x16x32_bf16 v[124:127], a[124:127], a[132:135], v[124:127]
s_waitcnt lgkmcnt(2)
v_mfma_f32_16x16x32_bf16 v[128:131], a[64:67], a[136:139], v[128:131]
ds_read_b64_tr_b16 a[128:129], v8 offset:32768
v_mfma_f32_16x16x32_bf16 v[128:131], a[68:71], a[140:143], v[128:131]
buffer_load_dword v21, v20, s[16:19], s43 offen
v_mfma_f32_16x16x32_bf16 v[132:135], a[72:75], a[136:139], v[132:135]
s_add_u32 s43, s43, s47
ds_read_b64_tr_b16 a[130:131], v8 offset:34816
v_mfma_f32_16x16x32_bf16 v[132:135], a[76:79], a[140:143], v[132:135]
s_cmp_ge_u32 s43, s51
v_mfma_f32_16x16x32_bf16 v[136:139], a[80:83], a[136:139], v[136:139]
s_cselect_b32 s43, 0, s43
ds_read_b64_tr_b16 a[132:133], v8 offset:49152
v_mfma_f32_16x16x32_bf16 v[136:139], a[84:87], a[140:143], v[136:139]
s_cselect_b32 s51, s42, s51
v_mfma_f32_16x16x32_bf16 v[140:143], a[88:91], a[136:139], v[140:143]
s_cselect_b64 s[16:17], s[40:41], s[16:17]
ds_read_b64_tr_b16 a[134:135], v8 offset:51200
v_mfma_f32_16x16x32_bf16 v[140:143], a[92:95], a[140:143], v[140:143]
s_cselect_b32 s18, s42, s18
v_mfma_f32_16x16x32_bf16 v[144:147], a[96:99], a[136:139], v[144:147]
s_cselect_b64 s[40:41], s[44:45], s[40:41]
ds_read_b128 a[32:35], v2 offset:8192
v_mfma_f32_16x16x32_bf16 v[144:147], a[100:103], a[140:143], v[144:147]
s_cselect_b32 s42, s46, s42
v_mfma_f32_16x16x32_bf16 v[148:151], a[104:107], a[136:139], v[148:151]
s_cselect_b32 s46, 0, s46
v_mfma_f32_16x16x32_bf16 v[148:151], a[108:111], a[140:143], v[148:151]
s_cmp_eq_u32 s30, s55
v_mfma_f32_16x16x32_bf16 v[152:155], a[112:115], a[136:139], v[152:155]
s_cselect_b32 s22, 0, 3221225472
ds_read_b128 a[36:39], v3 offset:8192
v_mfma_f32_16x16x32_bf16 v[152:155], a[116:119], a[140:143], v[152:155]
s_sub_u32 s30, s30, 1
buffer_atomic_add v27, v26, s[60:63], s22 offen sc1
v_mfma_f32_16x16x32_bf16 v[156:159], a[120:123], a[136:139], v[156:159]
ds_read_b128 a[40:43], v2 offset:10240
v_mfma_f32_16x16x32_bf16 v[156:159], a[124:127], a[140:143], v[156:159]
s_waitcnt lgkmcnt(3)
v_mfma_f32_16x16x32_bf16 v[160:163], a[64:67], a[128:131], v[160:163]
ds_read_b64_tr_b16 a[136:137], v9 offset:32768
v_mfma_f32_16x16x32_bf16 v[160:163], a[68:71], a[132:135], v[160:163]
v_mfma_f32_16x16x32_bf16 v[164:167], a[72:75], a[128:131], v[164:167]
ds_read_b64_tr_b16 a[138:139], v9 offset:34816
v_mfma_f32_16x16x32_bf16 v[164:167], a[76:79], a[132:135], v[164:167]
v_mfma_f32_16x16x32_bf16 v[168:171], a[80:83], a[128:131], v[168:171]
ds_read_b64_tr_b16 a[140:141], v9 offset:49152
v_mfma_f32_16x16x32_bf16 v[168:171], a[84:87], a[132:135], v[168:171]
v_mfma_f32_16x16x32_bf16 v[172:175], a[88:91], a[128:131], v[172:175]
ds_read_b64_tr_b16 a[142:143], v9 offset:51200
v_mfma_f32_16x16x32_bf16 v[172:175], a[92:95], a[132:135], v[172:175]
v_mfma_f32_16x16x32_bf16 v[176:179], a[96:99], a[128:131], v[176:179]
v_mfma_f32_16x16x32_bf16 v[176:179], a[100:103], a[132:135], v[176:179]
v_mfma_f32_16x16x32_bf16 v[180:183], a[104:107], a[128:131], v[180:183]
ds_read_b128 a[44:47], v3 offset:10240
v_mfma_f32_16x16x32_bf16 v[180:183], a[108:111], a[132:135], v[180:183]
v_mfma_f32_16x16x32_bf16 v[184:187], a[112:115], a[128:131], v[184:187]
ds_read_b128 a[48:51], v2 offset:12288
v_mfma_f32_16x16x32_bf16 v[184:187], a[116:119], a[132:135], v[184:187]
v_mfma_f32_16x16x32_bf16 v[188:191], a[120:123], a[128:131], v[188:191]
v_mfma_f32_16x16x32_bf16 v[188:191], a[124:127], a[132:135], v[188:191]
s_waitcnt lgkmcnt(2)
v_mfma_f32_16x16x32_bf16 v[192:195], a[64:67], a[136:139], v[192:195]
ds_read_b64_tr_b16 a[128:129], v10 offset:32768
v_mfma_f32_16x16x32_bf16 v[192:195], a[68:71], a[140:143], v[192:195]
v_mfma_f32_16x16x32_bf16 v[196:199], a[72:75], a[136:139], v[196:199]
ds_read_b64_tr_b16 a[130:131], v10 offset:34816
v_mfma_f32_16x16x32_bf16 v[196:199], a[76:79], a[140:143], v[196:199]
v_mfma_f32_16x16x32_bf16 v[200:203], a[80:83], a[136:139], v[200:203]
ds_read_b64_tr_b16 a[132:133], v10 offset:49152
v_mfma_f32_16x16x32_bf16 v[200:203], a[84:87], a[140:143], v[200:203]
v_mfma_f32_16x16x32_bf16 v[204:207], a[88:91], a[136:139], v[204:207]
ds_read_b64_tr_b16 a[134:135], v10 offset:51200
v_mfma_f32_16x16x32_bf16 v[204:207], a[92:95], a[140:143], v[204:207]
v_mfma_f32_16x16x32_bf16 v[208:211], a[96:99], a[136:139], v[208:211]
ds_read_b128 a[52:55], v3 offset:12288
v_mfma_f32_16x16x32_bf16 v[208:211], a[100:103], a[140:143], v[208:211]
v_mfma_f32_16x16x32_bf16 v[212:215], a[104:107], a[136:139], v[212:215]
ds_read_b128 a[56:59], v2 offset:14336
v_mfma_f32_16x16x32_bf16 v[212:215], a[108:111], a[140:143], v[212:215]
v_mfma_f32_16x16x32_bf16 v[216:219], a[112:115], a[136:139], v[216:219]
v_mfma_f32_16x16x32_bf16 v[216:219], a[116:119], a[140:143], v[216:219]
v_mfma_f32_16x16x32_bf16 v[220:223], a[120:123], a[136:139], v[220:223]
ds_read_b128 a[60:63], v3 offset:14336
v_mfma_f32_16x16x32_bf16 v[220:223], a[124:127], a[140:143], v[220:223]
s_waitcnt lgkmcnt(3)
v_mfma_f32_16x16x32_bf16 a[192:195], a[64:67], a[128:131], a[192:195]
ds_read_b64_tr_b16 a[136:137], v11 offset:32768
v_mfma_f32_16x16x32_bf16 a[192:195], a[68:71], a[132:135], a[192:195]
v_mfma_f32_16x16x32_bf16 a[196:199], a[72:75], a[128:131], a[196:199]
ds_read_b64_tr_b16 a[138:139], v11 offset:34816
v_mfma_f32_16x16x32_bf16 a[196:199], a[76:79], a[132:135], a[196:199]
v_mfma_f32_16x16x32_bf16 a[200:203], a[80:83], a[128:131], a[200:203]
ds_read_b64_tr_b16 a[140:141], v11 offset:49152
v_mfma_f32_16x16x32_bf16 a[200:203], a[84:87], a[132:135], a[200:203]
v_mfma_f32_16x16x32_bf16 a[204:207], a[88:91], a[128:131], a[204:207]
ds_read_b64_tr_b16 a[142:143], v11 offset:51200
v_mfma_f32_16x16x32_bf16 a[204:207], a[92:95], a[132:135], a[204:207]
v_mfma_f32_16x16x32_bf16 a[208:211], a[96:99], a[128:131], a[208:211]
v_mfma_f32_16x16x32_bf16 a[208:211], a[100:103], a[132:135], a[208:211]
v_mfma_f32_16x16x32_bf16 a[212:215], a[104:107], a[128:131], a[212:215]
v_mfma_f32_16x16x32_bf16 a[212:215], a[108:111], a[132:135], a[212:215]
v_mfma_f32_16x16x32_bf16 a[216:219], a[112:115], a[128:131], a[216:219]
v_mfma_f32_16x16x32_bf16 a[216:219], a[116:119], a[132:135], a[216:219]
v_mfma_f32_16x16x32_bf16 a[220:223], a[120:123], a[128:131], a[220:223]
s_waitcnt vmcnt(2) lgkmcnt(0)
v_mfma_f32_16x16x32_bf16 a[220:223], a[124:127], a[132:135], a[220:223]
s_barrier
v_mfma_f32_16x16x32_bf16 a[224:227], a[64:67], a[136:139], a[224:227]
s_add_u32 m0, s29, 98304
ds_read_b64_tr_b16 a[128:129], v4 offset:0
v_mfma_f32_16x16x32_bf16 a[224:227], a[68:71], a[140:143], a[224:227]
buffer_load_dwordx4 v16, s[12:15], s26 offen offset:0 lds
v_mfma_f32_16x16x32_bf16 a[228:231], a[72:75], a[136:139], a[228:231]
ds_read_b64_tr_b16 a[130:131], v4 offset:2048
v_mfma_f32_16x16x32_bf16 a[228:231], a[76:79], a[140:143], a[228:231]
v_mfma_f32_16x16x32_bf16 a[232:235], a[80:83], a[136:139], a[232:235]
ds_read_b64_tr_b16 a[132:133], v4 offset:16384
v_mfma_f32_16x16x32_bf16 a[232:235], a[84:87], a[140:143], a[232:235]
buffer_load_dwordx4 v17, s[12:15], s26 offen offset:1024 lds
v_mfma_f32_16x16x32_bf16 a[236:239], a[88:91], a[136:139], a[236:239]
ds_read_b64_tr_b16 a[134:135], v4 offset:18432
v_mfma_f32_16x16x32_bf16 a[236:239], a[92:95], a[140:143], a[236:239]
v_mfma_f32_16x16x32_bf16 a[240:243], a[96:99], a[136:139], a[240:243]
v_mfma_f32_16x16x32_bf16 a[240:243], a[100:103], a[140:143], a[240:243]
buffer_load_dwordx4 v18, s[12:15], s26 offen offset:2048 lds
v_mfma_f32_16x16x32_bf16 a[244:247], a[104:107], a[136:139], a[244:247]
v_mfma_f32_16x16x32_bf16 a[244:247], a[108:111], a[140:143], a[244:247]
v_mfma_f32_16x16x32_bf16 a[248:251], a[112:115], a[136:139], a[248:251]
v_mfma_f32_16x16x32_bf16 a[248:251], a[116:119], a[140:143], a[248:251]
buffer_load_dwordx4 v19, s[12:15], s26 offen offset:3072 lds
v_mfma_f32_16x16x32_bf16 a[252:255], a[120:123], a[136:139], a[252:255]
s_add_u32 s26, s26, 524288
v_mfma_f32_16x16x32_bf16 a[252:255], a[124:127], a[140:143], a[252:255]
s_waitcnt lgkmcnt(0)
buffer_store_dword v27, v26, s[4:7], s82 offen sc1
v_mfma_f32_16x16x32_bf16 v[32:35], a[0:3], a[128:131], v[32:35]
s_add_u32 m0, s29, 114688
ds_read_b64_tr_b16 a[136:137], v5 offset:0
v_mfma_f32_16x16x32_bf16 v[32:35], a[4:7], a[132:135], v[32:35]
buffer_load_dwordx4 v16, s[12:15], s27 offen offset:0 lds
v_mfma_f32_16x16x32_bf16 v[36:39], a[8:11], a[128:131], v[36:39]
ds_read_b64_tr_b16 a[138:139], v5 offset:2048
v_mfma_f32_16x16x32_bf16 v[36:39], a[12:15], a[132:135], v[36:39]
v_mfma_f32_16x16x32_bf16 v[40:43], a[16:19], a[128:131], v[40:43]
ds_read_b64_tr_b16 a[140:141], v5 offset:16384
v_mfma_f32_16x16x32_bf16 v[40:43], a[20:23], a[132:135], v[40:43]
buffer_load_dwordx4 v17, s[12:15], s27 offen offset:1024 lds
v_mfma_f32_16x16x32_bf16 v[44:47], a[24:27], a[128:131], v[44:47]
ds_read_b64_tr_b16 a[142:143], v5 offset:18432
v_mfma_f32_16x16x32_bf16 v[44:47], a[28:31], a[132:135], v[44:47]
v_mfma_f32_16x16x32_bf16 v[48:51], a[32:35], a[128:131], v[48:51]
ds_read_b128 a[64:67], v2 offset:32768
v_mfma_f32_16x16x32_bf16 v[48:51], a[36:39], a[132:135], v[48:51]
buffer_load_dwordx4 v18, s[12:15], s27 offen offset:2048 lds
v_mfma_f32_16x16x32_bf16 v[52:55], a[40:43], a[128:131], v[52:55]
ds_read_b128 a[68:71], v3 offset:32768
v_mfma_f32_16x16x32_bf16 v[52:55], a[44:47], a[132:135], v[52:55]
v_mfma_f32_16x16x32_bf16 v[56:59], a[48:51], a[128:131], v[56:59]
v_mfma_f32_16x16x32_bf16 v[56:59], a[52:55], a[132:135], v[56:59]
buffer_load_dwordx4 v19, s[12:15], s27 offen offset:3072 lds
v_mfma_f32_16x16x32_bf16 v[60:63], a[56:59], a[128:131], v[60:63]
s_add_u32 s27, s27, 524288
ds_read_b128 a[72:75], v2 offset:34816
v_mfma_f32_16x16x32_bf16 v[60:63], a[60:63], a[132:135], v[60:63]
s_waitcnt lgkmcnt(3)
v_mfma_f32_16x16x32_bf16 v[64:67], a[0:3], a[136:139], v[64:67]
s_add_u32 m0, s28, 0
ds_read_b64_tr_b16 a[128:129], v6 offset:0
v_mfma_f32_16x16x32_bf16 v[64:67], a[4:7], a[140:143], v[64:67]
buffer_load_dwordx4 v12, s[8:11], s24 offen offset:0 lds
v_mfma_f32_16x16x32_bf16 v[68:71], a[8:11], a[136:139], v[68:71]
ds_read_b64_tr_b16 a[130:131], v6 offset:2048
v_mfma_f32_16x16x32_bf16 v[68:71], a[12:15], a[140:143], v[68:71]
v_mfma_f32_16x16x32_bf16 v[72:75], a[16:19], a[136:139], v[72:75]
ds_read_b64_tr_b16 a[132:133], v6 offset:16384
v_mfma_f32_16x16x32_bf16 v[72:75], a[20:23], a[140:143], v[72:75]
buffer_load_dwordx4 v13, s[8:11], s24 offen offset:1024 lds
v_mfma_f32_16x16x32_bf16 v[76:79], a[24:27], a[136:139], v[76:79]
ds_read_b64_tr_b16 a[134:135], v6 offset:18432
v_mfma_f32_16x16x32_bf16 v[76:79], a[28:31], a[140:143], v[76:79]
v_mfma_f32_16x16x32_bf16 v[80:83], a[32:35], a[136:139], v[80:83]
ds_read_b128 a[76:79], v3 offset:34816
v_mfma_f32_16x16x32_bf16 v[80:83], a[36:39], a[140:143], v[80:83]
buffer_load_dwordx4 v14, s[8:11], s24 offen offset:2048 lds
v_mfma_f32_16x16x32_bf16 v[84:87], a[40:43], a[136:139], v[84:87]
v_mfma_f32_16x16x32_bf16 v[84:87], a[44:47], a[140:143], v[84:87]
v_mfma_f32_16x16x32_bf16 v[88:91], a[48:51], a[136:139], v[88:91]
ds_read_b128 a[80:83], v2 offset:36864
v_mfma_f32_16x16x32_bf16 v[88:91], a[52:55], a[140:143], v[88:91]
buffer_load_dwordx4 v15, s[8:11], s24 offen offset:3072 lds
v_mfma_f32_16x16x32_bf16 v[92:95], a[56:59], a[136:139], v[92:95]
s_add_u32 s24, s24, 128
ds_read_b128 a[84:87], v3 offset:36864
v_mfma_f32_16x16x32_bf16 v[92:95], a[60:63], a[140:143], v[92:95]
s_waitcnt lgkmcnt(3)
v_mfma_f32_16x16x32_bf16 v[96:99], a[0:3], a[128:131], v[96:99]
s_add_u32 m0, s28, 4096
ds_read_b64_tr_b16 a[136:137], v7 offset:0
v_mfma_f32_16x16x32_bf16 v[96:99], a[4:7], a[132:135], v[96:99]
buffer_load_dwordx4 v12, s[8:11], s25 offen offset:0 lds
v_mfma_f32_16x16x32_bf16 v[100:103], a[8:11], a[128:131], v[100:103]
ds_read_b64_tr_b16 a[138:139], v7 offset:2048
v_mfma_f32_16x16x32_bf16 v[100:103], a[12:15], a[132:135], v[100:103]
v_mfma_f32_16x16x32_bf16 v[104:107], a[16:19], a[128:131], v[104:107]
ds_read_b64_tr_b16 a[140:141], v7 offset:16384
v_mfma_f32_16x16x32_bf16 v[104:107], a[20:23], a[132:135], v[104:107]
buffer_load_dwordx4 v13, s[8:11], s25 offen offset:1024 lds
v_mfma_f32_16x16x32_bf16 v[108:111], a[24:27], a[128:131], v[108:111]
ds_read_b64_tr_b16 a[142:143], v7 offset:18432
v_mfma_f32_16x16x32_bf16 v[108:111], a[28:31], a[132:135], v[108:111]
v_mfma_f32_16x16x32_bf16 v[112:115], a[32:35], a[128:131], v[112:115]
v_mfma_f32_16x16x32_bf16 v[112:115], a[36:39], a[132:135], v[112:115]
buffer_load_dwordx4 v14, s[8:11], s25 offen offset:2048 lds
v_mfma_f32_16x16x32_bf16 v[116:119], a[40:43], a[128:131], v[116:119]
ds_read_b128 a[88:91], v2 offset:38912
v_mfma_f32_16x16x32_bf16 v[116:119], a[44:47], a[132:135], v[116:119]
v_mfma_f32_16x16x32_bf16 v[120:123], a[48:51], a[128:131], v[120:123]
ds_read_b128 a[92:95], v3 offset:38912
v_mfma_f32_16x16x32_bf16 v[120:123], a[52:55], a[132:135], v[120:123]
buffer_load_dwordx4 v15, s[8:11], s25 offen offset:3072 lds
v_mfma_f32_16x16x32_bf16 v[124:127], a[56:59], a[128:131], v[124:127]
s_add_u32 s25, s25, 128
v_mfma_f32_16x16x32_bf16 v[124:127], a[60:63], a[132:135], v[124:127]
s_waitcnt lgkmcnt(2)
v_mfma_f32_16x16x32_bf16 v[128:131], a[0:3], a[136:139], v[128:131]
ds_read_b64_tr_b16 a[128:129], v8 offset:0
v_mfma_f32_16x16x32_bf16 v[128:131], a[4:7], a[140:143], v[128:131]
buffer_load_dword v21, v20, s[16:19], s43 offen
v_mfma_f32_16x16x32_bf16 v[132:135], a[8:11], a[136:139], v[132:135]
s_add_u32 s43, s43, s47
ds_read_b64_tr_b16 a[130:131], v8 offset:2048
v_mfma_f32_16x16x32_bf16 v[132:135], a[12:15], a[140:143], v[132:135]
s_cmp_ge_u32 s43, s51
v_mfma_f32_16x16x32_bf16 v[136:139], a[16:19], a[136:139], v[136:139]
s_cselect_b32 s43, 0, s43
ds_read_b64_tr_b16 a[132:133], v8 offset:16384
v_mfma_f32_16x16x32_bf16 v[136:139], a[20:23], a[140:143], v[136:139]
s_cselect_b32 s51, s42, s51
v_mfma_f32_16x16x32_bf16 v[140:143], a[24:27], a[136:139], v[140:143]
s_cselect_b64 s[16:17], s[40:41], s[16:17]
ds_read_b64_tr_b16 a[134:135], v8 offset:18432
v_mfma_f32_16x16x32_bf16 v[140:143], a[28:31], a[140:143], v[140:143]
s_cselect_b32 s18, s42, s18
v_mfma_f32_16x16x32_bf16 v[144:147], a[32:35], a[136:139], v[144:147]
s_cselect_b64 s[40:41], s[44:45], s[40:41]
ds_read_b128 a[96:99], v2 offset:40960
v_mfma_f32_16x16x32_bf16 v[144:147], a[36:39], a[140:143], v[144:147]
s_cselect_b32 s42, s46, s42
v_mfma_f32_16x16x32_bf16 v[148:151], a[40:43], a[136:139], v[148:151]
s_cselect_b32 s46, 0, s46
v_mfma_f32_16x16x32_bf16 v[148:151], a[44:47], a[140:143], v[148:151]
s_cmp_eq_u32 s30, s55
v_mfma_f32_16x16x32_bf16 v[152:155], a[48:51], a[136:139], v[152:155]
s_cselect_b32 s22, 0, 3221225472
ds_read_b128 a[100:103], v3 offset:40960
v_mfma_f32_16x16x32_bf16 v[152:155], a[52:55], a[140:143], v[152:155]
s_sub_u32 s30, s30, 1
buffer_atomic_add v27, v26, s[60:63], s22 offen sc1
v_mfma_f32_16x16x32_bf16 v[156:159], a[56:59], a[136:139], v[156:159]
ds_read_b128 a[104:107], v2 offset:43008
v_mfma_f32_16x16x32_bf16 v[156:159], a[60:63], a[140:143], v[156:159]
s_waitcnt lgkmcnt(3)
v_mfma_f32_16x16x32_bf16 v[160:163], a[0:3], a[128:131], v[160:163]
ds_read_b64_tr_b16 a[136:137], v9 offset:0
v_mfma_f32_16x16x32_bf16 v[160:163], a[4:7], a[132:135], v[160:163]
v_mfma_f32_16x16x32_bf16 v[164:167], a[8:11], a[128:131], v[164:167]
ds_read_b64_tr_b16 a[138:139], v9 offset:2048
v_mfma_f32_16x16x32_bf16 v[164:167], a[12:15], a[132:135], v[164:167]
v_mfma_f32_16x16x32_bf16 v[168:171], a[16:19], a[128:131], v[168:171]
ds_read_b64_tr_b16 a[140:141], v9 offset:16384
v_mfma_f32_16x16x32_bf16 v[168:171], a[20:23], a[132:135], v[168:171]
v_mfma_f32_16x16x32_bf16 v[172:175], a[24:27], a[128:131], v[172:175]
ds_read_b64_tr_b16 a[142:143], v9 offset:18432
v_mfma_f32_16x16x32_bf16 v[172:175], a[28:31], a[132:135], v[172:175]
v_mfma_f32_16x16x32_bf16 v[176:179], a[32:35], a[128:131], v[176:179]
v_mfma_f32_16x16x32_bf16 v[176:179], a[36:39], a[132:135], v[176:179]
v_mfma_f32_16x16x32_bf16 v[180:183], a[40:43], a[128:131], v[180:183]
ds_read_b128 a[108:111], v3 offset:43008
v_mfma_f32_16x16x32_bf16 v[180:183], a[44:47], a[132:135], v[180:183]
v_mfma_f32_16x16x32_bf16 v[184:187], a[48:51], a[128:131], v[184:187]
ds_read_b128 a[112:115], v2 offset:45056
v_mfma_f32_16x16x32_bf16 v[184:187], a[52:55], a[132:135], v[184:187]
v_mfma_f32_16x16x32_bf16 v[188:191], a[56:59], a[128:131], v[188:191]
v_mfma_f32_16x16x32_bf16 v[188:191], a[60:63], a[132:135], v[188:191]
s_waitcnt lgkmcnt(2)
v_mfma_f32_16x16x32_bf16 v[192:195], a[0:3], a[136:139], v[192:195]
ds_read_b64_tr_b16 a[128:129], v10 offset:0
v_mfma_f32_16x16x32_bf16 v[192:195], a[4:7], a[140:143], v[192:195]
v_mfma_f32_16x16x32_bf16 v[196:199], a[8:11], a[136:139], v[196:199]
ds_read_b64_tr_b16 a[130:131], v10 offset:2048
v_mfma_f32_16x16x32_bf16 v[196:199], a[12:15], a[140:143], v[196:199]
v_mfma_f32_16x16x32_bf16 v[200:203], a[16:19], a[136:139], v[200:203]
ds_read_b64_tr_b16 a[132:133], v10 offset:16384
v_mfma_f32_16x16x32_bf16 v[200:203], a[20:23], a[140:143], v[200:203]
v_mfma_f32_16x16x32_bf16 v[204:207], a[24:27], a[136:139], v[204:207]
ds_read_b64_tr_b16 a[134:135], v10 offset:18432
v_mfma_f32_16x16x32_bf16 v[204:207], a[28:31], a[140:143], v[204:207]
v_mfma_f32_16x16x32_bf16 v[208:211], a[32:35], a[136:139], v[208:211]
ds_read_b128 a[116:119], v3 offset:45056
v_mfma_f32_16x16x32_bf16 v[208:211], a[36:39], a[140:143], v[208:211]
v_mfma_f32_16x16x32_bf16 v[212:215], a[40:43], a[136:139], v[212:215]
ds_read_b128 a[120:123], v2 offset:47104
v_mfma_f32_16x16x32_bf16 v[212:215], a[44:47], a[140:143], v[212:215]
v_mfma_f32_16x16x32_bf16 v[216:219], a[48:51], a[136:139], v[216:219]
v_mfma_f32_16x16x32_bf16 v[216:219], a[52:55], a[140:143], v[216:219]
v_mfma_f32_16x16x32_bf16 v[220:223], a[56:59], a[136:139], v[220:223]
ds_read_b128 a[124:127], v3 offset:47104
v_mfma_f32_16x16x32_bf16 v[220:223], a[60:63], a[140:143], v[220:223]
s_waitcnt lgkmcnt(3)
v_mfma_f32_16x16x32_bf16 a[192:195], a[0:3], a[128:131], a[192:195]
ds_read_b64_tr_b16 a[136:137], v11 offset:0
v_mfma_f32_16x16x32_bf16 a[192:195], a[4:7], a[132:135], a[192:195]
v_mfma_f32_16x16x32_bf16 a[196:199], a[8:11], a[128:131], a[196:199]
ds_read_b64_tr_b16 a[138:139], v11 offset:2048
v_mfma_f32_16x16x32_bf16 a[196:199], a[12:15], a[132:135], a[196:199]
v_mfma_f32_16x16x32_bf16 a[200:203], a[16:19], a[128:131], a[200:203]
ds_read_b64_tr_b16 a[140:141], v11 offset:16384
v_mfma_f32_16x16x32_bf16 a[200:203], a[20:23], a[132:135], a[200:203]
v_mfma_f32_16x16x32_bf16 a[204:207], a[24:27], a[128:131], a[204:207]
ds_read_b64_tr_b16 a[142:143], v11 offset:18432
v_mfma_f32_16x16x32_bf16 a[204:207], a[28:31], a[132:135], a[204:207]
v_mfma_f32_16x16x32_bf16 a[208:211], a[32:35], a[128:131], a[208:211]
v_mfma_f32_16x16x32_bf16 a[208:211], a[36:39], a[132:135], a[208:211]
v_mfma_f32_16x16x32_bf16 a[212:215], a[40:43], a[128:131], a[212:215]
v_mfma_f32_16x16x32_bf16 a[212:215], a[44:47], a[132:135], a[212:215]
v_mfma_f32_16x16x32_bf16 a[216:219], a[48:51], a[128:131], a[216:219]
v_mfma_f32_16x16x32_bf16 a[216:219], a[52:55], a[132:135], a[216:219]
v_mfma_f32_16x16x32_bf16 a[220:223], a[56:59], a[128:131], a[220:223]
s_waitcnt vmcnt(2) lgkmcnt(0)
v_mfma_f32_16x16x32_bf16 a[220:223], a[60:63], a[132:135], a[220:223]
s_barrier
v_mfma_f32_16x16x32_bf16 a[224:227], a[0:3], a[136:139], a[224:227]
s_add_u32 m0, s29, 65536
ds_read_b64_tr_b16 a[128:129], v4 offset:32768
v_mfma_f32_16x16x32_bf16 a[224:227], a[4:7], a[140:143], a[224:227]
buffer_load_dwordx4 v16, s[12:15], s26 offen offset:0 lds
v_mfma_f32_16x16x32_bf16 a[228:231], a[8:11], a[136:139], a[228:231]
ds_read_b64_tr_b16 a[130:131], v4 offset:34816
v_mfma_f32_16x16x32_bf16 a[228:231], a[12:15], a[140:143], a[228:231]
v_mfma_f32_16x16x32_bf16 a[232:235], a[16:19], a[136:139], a[232:235]
ds_read_b64_tr_b16 a[132:133], v4 offset:49152
v_mfma_f32_16x16x32_bf16 a[232:235], a[20:23], a[140:143], a[232:235]
buffer_load_dwordx4 v17, s[12:15], s26 offen offset:1024 lds
v_mfma_f32_16x16x32_bf16 a[236:239], a[24:27], a[136:139], a[236:239]
ds_read_b64_tr_b16 a[134:135], v4 offset:51200
v_mfma_f32_16x16x32_bf16 a[236:239], a[28:31], a[140:143], a[236:239]
v_mfma_f32_16x16x32_bf16 a[240:243], a[32:35], a[136:139], a[240:243]
v_mfma_f32_16x16x32_bf16 a[240:243], a[36:39], a[140:143], a[240:243]
buffer_load_dwordx4 v18, s[12:15], s26 offen offset:2048 lds
v_mfma_f32_16x16x32_bf16 a[244:247], a[40:43], a[136:139], a[244:247]
v_mfma_f32_16x16x32_bf16 a[244:247], a[44:47], a[140:143], a[244:247]
v_mfma_f32_16x16x32_bf16 a[248:251], a[48:51], a[136:139], a[248:251]
v_mfma_f32_16x16x32_bf16 a[248:251], a[52:55], a[140:143], a[248:251]
s_waitcnt lgkmcnt(0)
buffer_load_dwordx4 v19, s[12:15], s26 offen offset:3072 lds
v_mfma_f32_16x16x32_bf16 a[252:255], a[56:59], a[136:139], a[252:255]
s_add_u32 s26, s26, 524288
s_bitcmp1_b32 s30, 1
v_mfma_f32_16x16x32_bf16 a[252:255], a[60:63], a[140:143], a[252:255]
s_cbranch_scc1 Lg_501
s_cmp_eq_u32 s30, 0
s_cbranch_scc1 Lg_501t
v_mfma_f32_16x16x32_bf16 v[32:35], a[64:67], a[128:131], v[32:35]
s_add_u32 m0, s29, 81920
ds_read_b64_tr_b16 a[136:137], v5 offset:32768
v_mfma_f32_16x16x32_bf16 v[32:35], a[68:71], a[132:135], v[32:35]
buffer_load_dwordx4 v16, s[12:15], s27 offen offset:0 lds
v_mfma_f32_16x16x32_bf16 v[36:39], a[72:75], a[128:131], v[36:39]
s_lshl_b32 s22, s38, 3
ds_read_b64_tr_b16 a[138:139], v5 offset:34816
v_mfma_f32_16x16x32_bf16 v[36:39], a[76:79], a[132:135], v[36:39]
s_lshl_b32 s23, s39, 5
v_and_b32 v252, 31, v0
v_lshrrev_b32 v253, 5, v0
v_mfma_f32_16x16x32_bf16 v[40:43], a[80:83], a[128:131], v[40:43]
ds_read_b64_tr_b16 a[140:141], v5 offset:49152
v_add_u32 v253, s22, v253
v_mfma_f32_16x16x32_bf16 v[40:43], a[84:87], a[132:135], v[40:43]
buffer_load_dwordx4 v17, s[12:15], s27 offen offset:1024 lds
v_mfma_f32_16x16x32_bf16 v[44:47], a[88:91], a[128:131], v[44:47]
ds_read_b64_tr_b16 a[142:143], v5 offset:51200
v_add_u32 v252, s23, v252
v_mfma_f32_16x16x32_bf16 v[44:47], a[92:95], a[132:135], v[44:47]
v_mul_u32_u24 v254, 7168, v253
v_lshl_add_u32 v254, v252, 2, v254
v_mfma_f32_16x16x32_bf16 v[48:51], a[96:99], a[128:131], v[48:51]
ds_read_b128 a[0:3], v2 offset:0
v_lshlrev_b32 v252, 4, v252
v_mfma_f32_16x16x32_bf16 v[48:51], a[100:103], a[132:135], v[48:51]
buffer_load_dwordx4 v18, s[12:15], s27 offen offset:2048 lds
v_mfma_f32_16x16x32_bf16 v[52:55], a[104:107], a[128:131], v[52:55]
ds_read_b128 a[4:7], v3 offset:0
v_add_u32 v255, 3584, v254
v_mfma_f32_16x16x32_bf16 v[52:55], a[108:111], a[132:135], v[52:55]
v_subrev_u32 v22, 3584, v254
v_subrev_u32 v23, 2688, v254
v_mfma_f32_16x16x32_bf16 v[56:59], a[112:115], a[128:131], v[56:59]
v_subrev_u32 v24, 1792, v254
v_subrev_u32 v25, 896, v254
v_mfma_f32_16x16x32_bf16 v[56:59], a[116:119], a[132:135], v[56:59]
buffer_load_dwordx4 v19, s[12:15], s27 offen offset:3072 lds
v_mfma_f32_16x16x32_bf16 v[60:63], a[120:123], a[128:131], v[60:63]
s_add_u32 s27, s27, 524288
ds_read_b128 a[8:11], v2 offset:2048
v_mfma_f32_16x16x32_bf16 v[60:63], a[124:127], a[132:135], v[60:63]
PAD_23:
s_cbranch_execz PAD_27
s_waitcnt lgkmcnt(3)
v_mfma_f32_16x16x32_bf16 v[64:67], a[64:67], a[136:139], v[64:67]
s_add_u32 m0, s28, 32768
ds_read_b64_tr_b16 a[128:129], v6 offset:32768
v_mfma_f32_16x16x32_bf16 v[64:67], a[68:71], a[140:143], v[64:67]
buffer_load_dwordx4 v12, s[8:11], s24 offen offset:0 lds
v_mfma_f32_16x16x32_bf16 v[68:71], a[72:75], a[136:139], v[68:71]
ds_read_b64_tr_b16 a[130:131], v6 offset:34816
v_mfma_f32_16x16x32_bf16 v[68:71], a[76:79], a[140:143], v[68:71]
v_mfma_f32_16x16x32_bf16 v[72:75], a[80:83], a[136:139], v[72:75]
ds_read_b64_tr_b16 a[132:133], v6 offset:49152
v_mfma_f32_16x16x32_bf16 v[72:75], a[84:87], a[140:143], v[72:75]
buffer_load_dwordx4 v13, s[8:11], s24 offen offset:1024 lds
v_mfma_f32_16x16x32_bf16 v[76:79], a[88:91], a[136:139], v[76:79]
ds_read_b64_tr_b16 a[134:135], v6 offset:51200
v_mfma_f32_16x16x32_bf16 v[76:79], a[92:95], a[140:143], v[76:79]
v_mfma_f32_16x16x32_bf16 v[80:83], a[96:99], a[136:139], v[80:83]
ds_read_b128 a[12:15], v3 offset:2048
v_mfma_f32_16x16x32_bf16 v[80:83], a[100:103], a[140:143], v[80:83]
buffer_load_dwordx4 v14, s[8:11], s24 offen offset:2048 lds
v_mfma_f32_16x16x32_bf16 v[84:87], a[104:107], a[136:139], v[84:87]
v_mfma_f32_16x16x32_bf16 v[84:87], a[108:111], a[140:143], v[84:87]
v_mfma_f32_16x16x32_bf16 v[88:91], a[112:115], a[136:139], v[88:91]
ds_read_b128 a[16:19], v2 offset:4096
v_mfma_f32_16x16x32_bf16 v[88:91], a[116:119], a[140:143], v[88:91]
buffer_load_dwordx4 v15, s[8:11], s24 offen offset:3072 lds
v_mfma_f32_16x16x32_bf16 v[92:95], a[120:123], a[136:139], v[92:95]
s_add_u32 s24, s24, 128
ds_read_b128 a[20:23], v3 offset:4096
v_mfma_f32_16x16x32_bf16 v[92:95], a[124:127], a[140:143], v[92:95]
s_waitcnt lgkmcnt(3)
v_mfma_f32_16x16x32_bf16 v[96:99], a[64:67], a[128:131], v[96:99]
s_add_u32 m0, s28, 36864
ds_read_b64_tr_b16 a[136:137], v7 offset:32768
v_mfma_f32_16x16x32_bf16 v[96:99], a[68:71], a[132:135], v[96:99]
buffer_load_dwordx4 v12, s[8:11], s25 offen offset:0 lds
v_mfma_f32_16x16x32_bf16 v[100:103], a[72:75], a[128:131], v[100:103]
ds_read_b64_tr_b16 a[138:139], v7 offset:34816
v_mfma_f32_16x16x32_bf16 v[100:103], a[76:79], a[132:135], v[100:103]
v_mfma_f32_16x16x32_bf16 v[104:107], a[80:83], a[128:131], v[104:107]
ds_read_b64_tr_b16 a[140:141], v7 offset:49152
v_mfma_f32_16x16x32_bf16 v[104:107], a[84:87], a[132:135], v[104:107]
buffer_load_dwordx4 v13, s[8:11], s25 offen offset:1024 lds
v_mfma_f32_16x16x32_bf16 v[108:111], a[88:91], a[128:131], v[108:111]
ds_read_b64_tr_b16 a[142:143], v7 offset:51200
v_mfma_f32_16x16x32_bf16 v[108:111], a[92:95], a[132:135], v[108:111]
v_mfma_f32_16x16x32_bf16 v[112:115], a[96:99], a[128:131], v[112:115]
v_mfma_f32_16x16x32_bf16 v[112:115], a[100:103], a[132:135], v[112:115]
buffer_load_dwordx4 v14, s[8:11], s25 offen offset:2048 lds
v_mfma_f32_16x16x32_bf16 v[116:119], a[104:107], a[128:131], v[116:119]
ds_read_b128 a[24:27], v2 offset:6144
v_mfma_f32_16x16x32_bf16 v[116:119], a[108:111], a[132:135], v[116:119]
v_mfma_f32_16x16x32_bf16 v[120:123], a[112:115], a[128:131], v[120:123]
ds_read_b128 a[28:31], v3 offset:6144
v_mfma_f32_16x16x32_bf16 v[120:123], a[116:119], a[132:135], v[120:123]
buffer_load_dwordx4 v15, s[8:11], s25 offen offset:3072 lds
v_mfma_f32_16x16x32_bf16 v[124:127], a[120:123], a[128:131], v[124:127]
s_add_u32 s25, s25, 128
v_mfma_f32_16x16x32_bf16 v[124:127], a[124:127], a[132:135], v[124:127]
s_waitcnt lgkmcnt(2)
v_mfma_f32_16x16x32_bf16 v[128:131], a[64:67], a[136:139], v[128:131]
s_mov_b64 s[56:57], s[70:71]
s_mov_b32 s58, 3584
s_mov_b32 s59, 0x20000
ds_read_b64_tr_b16 a[128:129], v8 offset:32768
buffer_load_dwordx4 v[248:251], v252, s[56:59], 0 offen
v_mfma_f32_16x16x32_bf16 v[128:131], a[68:71], a[140:143], v[128:131]
s_mov_b64 s[56:57], s[66:67]
s_mov_b32 s58, 1835008
buffer_load_dword v224, v22, s[56:59], 0 offen nt
v_mfma_f32_16x16x32_bf16 v[132:135], a[72:75], a[136:139], v[132:135]
ds_read_b64_tr_b16 a[130:131], v8 offset:34816
buffer_load_dword v225, v23, s[56:59], 0 offen nt
v_mfma_f32_16x16x32_bf16 v[132:135], a[76:79], a[140:143], v[132:135]
buffer_load_dword v226, v24, s[56:59], 0 offen nt
v_mfma_f32_16x16x32_bf16 v[136:139], a[80:83], a[136:139], v[136:139]
ds_read_b64_tr_b16 a[132:133], v8 offset:49152
buffer_load_dword v227, v25, s[56:59], 0 offen nt
v_mfma_f32_16x16x32_bf16 v[136:139], a[84:87], a[140:143], v[136:139]
buffer_load_dword v228, v254, s[56:59], 0 offen offset:0 nt
v_mfma_f32_16x16x32_bf16 v[140:143], a[88:91], a[136:139], v[140:143]
ds_read_b64_tr_b16 a[134:135], v8 offset:51200
buffer_load_dword v229, v254, s[56:59], 0 offen offset:896 nt
v_mfma_f32_16x16x32_bf16 v[140:143], a[92:95], a[140:143], v[140:143]
buffer_load_dword v230, v254, s[56:59], 0 offen offset:1792 nt
v_mfma_f32_16x16x32_bf16 v[144:147], a[96:99], a[136:139], v[144:147]
ds_read_b128 a[32:35], v2 offset:8192
buffer_load_dword v231, v254, s[56:59], 0 offen offset:2688 nt
v_mfma_f32_16x16x32_bf16 v[144:147], a[100:103], a[140:143], v[144:147]
buffer_load_dword v232, v255, s[56:59], 0 offen offset:0 nt
v_mfma_f32_16x16x32_bf16 v[148:151], a[104:107], a[136:139], v[148:151]
buffer_load_dword v233, v255, s[56:59], 0 offen offset:896 nt
v_mfma_f32_16x16x32_bf16 v[148:151], a[108:111], a[140:143], v[148:151]
buffer_load_dword v234, v255, s[56:59], 0 offen offset:1792 nt
v_mfma_f32_16x16x32_bf16 v[152:155], a[112:115], a[136:139], v[152:155]
ds_read_b128 a[36:39], v3 offset:8192
buffer_load_dword v235, v255, s[56:59], 0 offen offset:2688 nt
v_mfma_f32_16x16x32_bf16 v[152:155], a[116:119], a[140:143], v[152:155]
s_mov_b64 s[56:57], s[68:69]
buffer_load_dword v236, v25, s[56:59], 0 offen nt
v_mfma_f32_16x16x32_bf16 v[156:159], a[120:123], a[136:139], v[156:159]
ds_read_b128 a[40:43], v2 offset:10240
buffer_load_dword v237, v254, s[56:59], 0 offen offset:0 nt
v_mfma_f32_16x16x32_bf16 v[156:159], a[124:127], a[140:143], v[156:159]
s_waitcnt lgkmcnt(3)
buffer_load_dword v238, v254, s[56:59], 0 offen offset:896 nt
v_mfma_f32_16x16x32_bf16 v[160:163], a[64:67], a[128:131], v[160:163]
ds_read_b64_tr_b16 a[136:137], v9 offset:32768
buffer_load_dword v239, v254, s[56:59], 0 offen offset:1792 nt
v_mfma_f32_16x16x32_bf16 v[160:163], a[68:71], a[132:135], v[160:163]
buffer_load_dword v240, v254, s[56:59], 0 offen offset:2688 nt
v_mfma_f32_16x16x32_bf16 v[164:167], a[72:75], a[128:131], v[164:167]
ds_read_b64_tr_b16 a[138:139], v9 offset:34816
buffer_load_dword v241, v255, s[56:59], 0 offen offset:0 nt
v_mfma_f32_16x16x32_bf16 v[164:167], a[76:79], a[132:135], v[164:167]
buffer_load_dword v242, v255, s[56:59], 0 offen offset:896 nt
v_mfma_f32_16x16x32_bf16 v[168:171], a[80:83], a[128:131], v[168:171]
ds_read_b64_tr_b16 a[140:141], v9 offset:49152
buffer_load_dword v243, v255, s[56:59], 0 offen offset:1792 nt
v_mfma_f32_16x16x32_bf16 v[168:171], a[84:87], a[132:135], v[168:171]
buffer_load_dword v244, v255, s[56:59], 0 offen offset:2688 nt
v_mfma_f32_16x16x32_bf16 v[172:175], a[88:91], a[128:131], v[172:175]
ds_read_b64_tr_b16 a[142:143], v9 offset:51200
v_mfma_f32_16x16x32_bf16 v[172:175], a[92:95], a[132:135], v[172:175]
v_mfma_f32_16x16x32_bf16 v[176:179], a[96:99], a[128:131], v[176:179]
v_mfma_f32_16x16x32_bf16 v[176:179], a[100:103], a[132:135], v[176:179]
v_mfma_f32_16x16x32_bf16 v[180:183], a[104:107], a[128:131], v[180:183]
ds_read_b128 a[44:47], v3 offset:10240
v_mfma_f32_16x16x32_bf16 v[180:183], a[108:111], a[132:135], v[180:183]
v_mfma_f32_16x16x32_bf16 v[184:187], a[112:115], a[128:131], v[184:187]
ds_read_b128 a[48:51], v2 offset:12288
v_mfma_f32_16x16x32_bf16 v[184:187], a[116:119], a[132:135], v[184:187]
v_mfma_f32_16x16x32_bf16 v[188:191], a[120:123], a[128:131], v[188:191]
v_mfma_f32_16x16x32_bf16 v[188:191], a[124:127], a[132:135], v[188:191]
s_waitcnt lgkmcnt(2)
v_mfma_f32_16x16x32_bf16 v[192:195], a[64:67], a[136:139], v[192:195]
ds_read_b64_tr_b16 a[128:129], v10 offset:32768
v_mfma_f32_16x16x32_bf16 v[192:195], a[68:71], a[140:143], v[192:195]
v_mfma_f32_16x16x32_bf16 v[196:199], a[72:75], a[136:139], v[196:199]
ds_read_b64_tr_b16 a[130:131], v10 offset:34816
v_mfma_f32_16x16x32_bf16 v[196:199], a[76:79], a[140:143], v[196:199]
v_mfma_f32_16x16x32_bf16 v[200:203], a[80:83], a[136:139], v[200:203]
ds_read_b64_tr_b16 a[132:133], v10 offset:49152
v_mfma_f32_16x16x32_bf16 v[200:203], a[84:87], a[140:143], v[200:203]
v_mfma_f32_16x16x32_bf16 v[204:207], a[88:91], a[136:139], v[204:207]
ds_read_b64_tr_b16 a[134:135], v10 offset:51200
v_mfma_f32_16x16x32_bf16 v[204:207], a[92:95], a[140:143], v[204:207]
v_mfma_f32_16x16x32_bf16 v[208:211], a[96:99], a[136:139], v[208:211]
ds_read_b128 a[52:55], v3 offset:12288
v_mfma_f32_16x16x32_bf16 v[208:211], a[100:103], a[140:143], v[208:211]
v_mfma_f32_16x16x32_bf16 v[212:215], a[104:107], a[136:139], v[212:215]
ds_read_b128 a[56:59], v2 offset:14336
v_mfma_f32_16x16x32_bf16 v[212:215], a[108:111], a[140:143], v[212:215]
v_mfma_f32_16x16x32_bf16 v[216:219], a[112:115], a[136:139], v[216:219]
v_mfma_f32_16x16x32_bf16 v[216:219], a[116:119], a[140:143], v[216:219]
v_mfma_f32_16x16x32_bf16 v[220:223], a[120:123], a[136:139], v[220:223]
ds_read_b128 a[60:63], v3 offset:14336
v_mfma_f32_16x16x32_bf16 v[220:223], a[124:127], a[140:143], v[220:223]
s_waitcnt lgkmcnt(3)
v_mfma_f32_16x16x32_bf16 a[192:195], a[64:67], a[128:131], a[192:195]
ds_read_b64_tr_b16 a[136:137], v11 offset:32768
v_mfma_f32_16x16x32_bf16 a[192:195], a[68:71], a[132:135], a[192:195]
v_mfma_f32_16x16x32_bf16 a[196:199], a[72:75], a[128:131], a[196:199]
ds_read_b64_tr_b16 a[138:139], v11 offset:34816
v_mfma_f32_16x16x32_bf16 a[196:199], a[76:79], a[132:135], a[196:199]
v_mfma_f32_16x16x32_bf16 a[200:203], a[80:83], a[128:131], a[200:203]
ds_read_b64_tr_b16 a[140:141], v11 offset:49152
v_mfma_f32_16x16x32_bf16 a[200:203], a[84:87], a[132:135], a[200:203]
v_mfma_f32_16x16x32_bf16 a[204:207], a[88:91], a[128:131], a[204:207]
ds_read_b64_tr_b16 a[142:143], v11 offset:51200
v_mfma_f32_16x16x32_bf16 a[204:207], a[92:95], a[132:135], a[204:207]
v_mfma_f32_16x16x32_bf16 a[208:211], a[96:99], a[128:131], a[208:211]
v_mfma_f32_16x16x32_bf16 a[208:211], a[100:103], a[132:135], a[208:211]
v_mfma_f32_16x16x32_bf16 a[212:215], a[104:107], a[128:131], a[212:215]
v_mfma_f32_16x16x32_bf16 a[212:215], a[108:111], a[132:135], a[212:215]
v_mfma_f32_16x16x32_bf16 a[216:219], a[112:115], a[128:131], a[216:219]
v_mfma_f32_16x16x32_bf16 a[216:219], a[116:119], a[132:135], a[216:219]
v_mfma_f32_16x16x32_bf16 a[220:223], a[120:123], a[128:131], a[220:223]
s_waitcnt vmcnt(22) lgkmcnt(0)
v_mfma_f32_16x16x32_bf16 a[220:223], a[124:127], a[132:135], a[220:223]
s_barrier
v_mfma_f32_16x16x32_bf16 a[224:227], a[64:67], a[136:139], a[224:227]
s_add_u32 m0, s29, 98304
ds_read_b64_tr_b16 a[128:129], v4 offset:0
v_mfma_f32_16x16x32_bf16 a[224:227], a[68:71], a[140:143], a[224:227]
buffer_load_dwordx4 v16, s[12:15], s26 offen offset:0 lds
v_mfma_f32_16x16x32_bf16 a[228:231], a[72:75], a[136:139], a[228:231]
ds_read_b64_tr_b16 a[130:131], v4 offset:2048
v_mfma_f32_16x16x32_bf16 a[228:231], a[76:79], a[140:143], a[228:231]
v_mfma_f32_16x16x32_bf16 a[232:235], a[80:83], a[136:139], a[232:235]
ds_read_b64_tr_b16 a[132:133], v4 offset:16384
v_mfma_f32_16x16x32_bf16 a[232:235], a[84:87], a[140:143], a[232:235]
buffer_load_dwordx4 v17, s[12:15], s26 offen offset:1024 lds
v_mfma_f32_16x16x32_bf16 a[236:239], a[88:91], a[136:139], a[236:239]
ds_read_b64_tr_b16 a[134:135], v4 offset:18432
v_mfma_f32_16x16x32_bf16 a[236:239], a[92:95], a[140:143], a[236:239]
v_mfma_f32_16x16x32_bf16 a[240:243], a[96:99], a[136:139], a[240:243]
v_mfma_f32_16x16x32_bf16 a[240:243], a[100:103], a[140:143], a[240:243]
buffer_load_dwordx4 v18, s[12:15], s26 offen offset:2048 lds
v_mfma_f32_16x16x32_bf16 a[244:247], a[104:107], a[136:139], a[244:247]
v_mfma_f32_16x16x32_bf16 a[244:247], a[108:111], a[140:143], a[244:247]
v_mfma_f32_16x16x32_bf16 a[248:251], a[112:115], a[136:139], a[248:251]
v_mfma_f32_16x16x32_bf16 a[248:251], a[116:119], a[140:143], a[248:251]
buffer_load_dwordx4 v19, s[12:15], s26 offen offset:3072 lds
v_mfma_f32_16x16x32_bf16 a[252:255], a[120:123], a[136:139], a[252:255]
s_add_u32 s26, s26, 524288
v_mfma_f32_16x16x32_bf16 a[252:255], a[124:127], a[140:143], a[252:255]
s_waitcnt lgkmcnt(0)
v_mfma_f32_16x16x32_bf16 v[32:35], a[0:3], a[128:131], v[32:35]
s_add_u32 m0, s29, 114688
ds_read_b64_tr_b16 a[136:137], v5 offset:0
v_mfma_f32_16x16x32_bf16 v[32:35], a[4:7], a[132:135], v[32:35]
buffer_load_dwordx4 v16, s[12:15], s27 offen offset:0 lds
v_mfma_f32_16x16x32_bf16 v[36:39], a[8:11], a[128:131], v[36:39]
ds_read_b64_tr_b16 a[138:139], v5 offset:2048
v_mfma_f32_16x16x32_bf16 v[36:39], a[12:15], a[132:135], v[36:39]
v_mfma_f32_16x16x32_bf16 v[40:43], a[16:19], a[128:131], v[40:43]
ds_read_b64_tr_b16 a[140:141], v5 offset:16384
v_mfma_f32_16x16x32_bf16 v[40:43], a[20:23], a[132:135], v[40:43]
buffer_load_dwordx4 v17, s[12:15], s27 offen offset:1024 lds
v_mfma_f32_16x16x32_bf16 v[44:47], a[24:27], a[128:131], v[44:47]
ds_read_b64_tr_b16 a[142:143], v5 offset:18432
v_mfma_f32_16x16x32_bf16 v[44:47], a[28:31], a[132:135], v[44:47]
v_mfma_f32_16x16x32_bf16 v[48:51], a[32:35], a[128:131], v[48:51]
ds_read_b128 a[64:67], v2 offset:32768
v_mfma_f32_16x16x32_bf16 v[48:51], a[36:39], a[132:135], v[48:51]
buffer_load_dwordx4 v18, s[12:15], s27 offen offset:2048 lds
v_mfma_f32_16x16x32_bf16 v[52:55], a[40:43], a[128:131], v[52:55]
ds_read_b128 a[68:71], v3 offset:32768
v_mfma_f32_16x16x32_bf16 v[52:55], a[44:47], a[132:135], v[52:55]
v_mfma_f32_16x16x32_bf16 v[56:59], a[48:51], a[128:131], v[56:59]
v_mfma_f32_16x16x32_bf16 v[56:59], a[52:55], a[132:135], v[56:59]
buffer_load_dwordx4 v19, s[12:15], s27 offen offset:3072 lds
v_mfma_f32_16x16x32_bf16 v[60:63], a[56:59], a[128:131], v[60:63]
s_add_u32 s27, s27, 524288
ds_read_b128 a[72:75], v2 offset:34816
v_mfma_f32_16x16x32_bf16 v[60:63], a[60:63], a[132:135], v[60:63]
s_waitcnt lgkmcnt(3)
v_mfma_f32_16x16x32_bf16 v[64:67], a[0:3], a[136:139], v[64:67]
s_add_u32 m0, s28, 0
ds_read_b64_tr_b16 a[128:129], v6 offset:0
v_mfma_f32_16x16x32_bf16 v[64:67], a[4:7], a[140:143], v[64:67]
buffer_load_dwordx4 v12, s[8:11], s24 offen offset:0 lds
v_mfma_f32_16x16x32_bf16 v[68:71], a[8:11], a[136:139], v[68:71]
ds_read_b64_tr_b16 a[130:131], v6 offset:2048
v_mfma_f32_16x16x32_bf16 v[68:71], a[12:15], a[140:143], v[68:71]
v_mfma_f32_16x16x32_bf16 v[72:75], a[16:19], a[136:139], v[72:75]
ds_read_b64_tr_b16 a[132:133], v6 offset:16384
v_mfma_f32_16x16x32_bf16 v[72:75], a[20:23], a[140:143], v[72:75]
buffer_load_dwordx4 v13, s[8:11], s24 offen offset:1024 lds
v_mfma_f32_16x16x32_bf16 v[76:79], a[24:27], a[136:139], v[76:79]
ds_read_b64_tr_b16 a[134:135], v6 offset:18432
v_mfma_f32_16x16x32_bf16 v[76:79], a[28:31], a[140:143], v[76:79]
v_mfma_f32_16x16x32_bf16 v[80:83], a[32:35], a[136:139], v[80:83]
ds_read_b128 a[76:79], v3 offset:34816
v_mfma_f32_16x16x32_bf16 v[80:83], a[36:39], a[140:143], v[80:83]
buffer_load_dwordx4 v14, s[8:11], s24 offen offset:2048 lds
v_mfma_f32_16x16x32_bf16 v[84:87], a[40:43], a[136:139], v[84:87]
v_mfma_f32_16x16x32_bf16 v[84:87], a[44:47], a[140:143], v[84:87]
v_mfma_f32_16x16x32_bf16 v[88:91], a[48:51], a[136:139], v[88:91]
ds_read_b128 a[80:83], v2 offset:36864
v_mfma_f32_16x16x32_bf16 v[88:91], a[52:55], a[140:143], v[88:91]
buffer_load_dwordx4 v15, s[8:11], s24 offen offset:3072 lds
v_mfma_f32_16x16x32_bf16 v[92:95], a[56:59], a[136:139], v[92:95]
s_add_u32 s24, s24, 128
ds_read_b128 a[84:87], v3 offset:36864
v_mfma_f32_16x16x32_bf16 v[92:95], a[60:63], a[140:143], v[92:95]
s_waitcnt lgkmcnt(3)
v_mfma_f32_16x16x32_bf16 v[96:99], a[0:3], a[128:131], v[96:99]
s_add_u32 m0, s28, 4096
ds_read_b64_tr_b16 a[136:137], v7 offset:0
v_mfma_f32_16x16x32_bf16 v[96:99], a[4:7], a[132:135], v[96:99]
buffer_load_dwordx4 v12, s[8:11], s25 offen offset:0 lds
v_mfma_f32_16x16x32_bf16 v[100:103], a[8:11], a[128:131], v[100:103]
ds_read_b64_tr_b16 a[138:139], v7 offset:2048
v_mfma_f32_16x16x32_bf16 v[100:103], a[12:15], a[132:135], v[100:103]
v_mfma_f32_16x16x32_bf16 v[104:107], a[16:19], a[128:131], v[104:107]
ds_read_b64_tr_b16 a[140:141], v7 offset:16384
v_mfma_f32_16x16x32_bf16 v[104:107], a[20:23], a[132:135], v[104:107]
buffer_load_dwordx4 v13, s[8:11], s25 offen offset:1024 lds
v_mfma_f32_16x16x32_bf16 v[108:111], a[24:27], a[128:131], v[108:111]
ds_read_b64_tr_b16 a[142:143], v7 offset:18432
v_mfma_f32_16x16x32_bf16 v[108:111], a[28:31], a[132:135], v[108:111]
v_mfma_f32_16x16x32_bf16 v[112:115], a[32:35], a[128:131], v[112:115]
v_mfma_f32_16x16x32_bf16 v[112:115], a[36:39], a[132:135], v[112:115]
buffer_load_dwordx4 v14, s[8:11], s25 offen offset:2048 lds
v_mfma_f32_16x16x32_bf16 v[116:119], a[40:43], a[128:131], v[116:119]
ds_read_b128 a[88:91], v2 offset:38912
v_mfma_f32_16x16x32_bf16 v[116:119], a[44:47], a[132:135], v[116:119]
v_mfma_f32_16x16x32_bf16 v[120:123], a[48:51], a[128:131], v[120:123]
ds_read_b128 a[92:95], v3 offset:38912
v_mfma_f32_16x16x32_bf16 v[120:123], a[52:55], a[132:135], v[120:123]
buffer_load_dwordx4 v15, s[8:11], s25 offen offset:3072 lds
v_mfma_f32_16x16x32_bf16 v[124:127], a[56:59], a[128:131], v[124:127]
s_add_u32 s25, s25, 128
v_mfma_f32_16x16x32_bf16 v[124:127], a[60:63], a[132:135], v[124:127]
s_waitcnt lgkmcnt(2)
v_mfma_f32_16x16x32_bf16 v[128:131], a[0:3], a[136:139], v[128:131]
ds_read_b64_tr_b16 a[128:129], v8 offset:0
v_mfma_f32_16x16x32_bf16 v[128:131], a[4:7], a[140:143], v[128:131]
buffer_load_dword v21, v20, s[16:19], s43 offen
v_mfma_f32_16x16x32_bf16 v[132:135], a[8:11], a[136:139], v[132:135]
s_add_u32 s43, s43, s47
ds_read_b64_tr_b16 a[130:131], v8 offset:2048
v_mfma_f32_16x16x32_bf16 v[132:135], a[12:15], a[140:143], v[132:135]
s_cmp_ge_u32 s43, s51
v_mfma_f32_16x16x32_bf16 v[136:139], a[16:19], a[136:139], v[136:139]
s_cselect_b32 s43, 0, s43
ds_read_b64_tr_b16 a[132:133], v8 offset:16384
v_mfma_f32_16x16x32_bf16 v[136:139], a[20:23], a[140:143], v[136:139]
s_cselect_b32 s51, s42, s51
v_mfma_f32_16x16x32_bf16 v[140:143], a[24:27], a[136:139], v[140:143]
s_cselect_b64 s[16:17], s[40:41], s[16:17]
ds_read_b64_tr_b16 a[134:135], v8 offset:18432
v_mfma_f32_16x16x32_bf16 v[140:143], a[28:31], a[140:143], v[140:143]
s_cselect_b32 s18, s42, s18
v_mfma_f32_16x16x32_bf16 v[144:147], a[32:35], a[136:139], v[144:147]
s_cselect_b64 s[40:41], s[44:45], s[40:41]
ds_read_b128 a[96:99], v2 offset:40960
v_mfma_f32_16x16x32_bf16 v[144:147], a[36:39], a[140:143], v[144:147]
s_cselect_b32 s42, s46, s42
v_mfma_f32_16x16x32_bf16 v[148:151], a[40:43], a[136:139], v[148:151]
s_cselect_b32 s46, 0, s46
v_mfma_f32_16x16x32_bf16 v[148:151], a[44:47], a[140:143], v[148:151]
s_lshl_b32 s59, s39, 5
v_mfma_f32_16x16x32_bf16 v[152:155], a[48:51], a[136:139], v[152:155]
s_add_u32 s59, s59, s38
ds_read_b128 a[100:103], v3 offset:40960
v_mfma_f32_16x16x32_bf16 v[152:155], a[52:55], a[140:143], v[152:155]
s_lshl_b32 s59, s59, 2
v_mfma_f32_16x16x32_bf16 v[156:159], a[56:59], a[136:139], v[156:159]
s_add_u32 s59, s59, 94392320
ds_read_b128 a[104:107], v2 offset:43008
v_mfma_f32_16x16x32_bf16 v[156:159], a[60:63], a[140:143], v[156:159]
s_waitcnt lgkmcnt(3)
s_cmp_lt_u32 s2, 224
v_mfma_f32_16x16x32_bf16 v[160:163], a[0:3], a[128:131], v[160:163]
s_cselect_b32 s59, s59, 3221225472
ds_read_b64_tr_b16 a[136:137], v9 offset:0
v_mfma_f32_16x16x32_bf16 v[160:163], a[4:7], a[132:135], v[160:163]
s_mov_b32 s58, 0xffff0000
v_mfma_f32_16x16x32_bf16 v[164:167], a[8:11], a[128:131], v[164:167]
ds_read_b64_tr_b16 a[138:139], v9 offset:2048
v_mfma_f32_16x16x32_bf16 v[164:167], a[12:15], a[132:135], v[164:167]
buffer_load_dword v21, v20, s[16:19], s43 offen
v_mfma_f32_16x16x32_bf16 v[168:171], a[16:19], a[128:131], v[168:171]
s_add_u32 s43, s43, s47
ds_read_b64_tr_b16 a[140:141], v9 offset:16384
v_mfma_f32_16x16x32_bf16 v[168:171], a[20:23], a[132:135], v[168:171]
s_cmp_ge_u32 s43, s51
v_mfma_f32_16x16x32_bf16 v[172:175], a[24:27], a[128:131], v[172:175]
s_cselect_b32 s43, 0, s43
ds_read_b64_tr_b16 a[142:143], v9 offset:18432
v_mfma_f32_16x16x32_bf16 v[172:175], a[28:31], a[132:135], v[172:175]
s_cselect_b32 s51, s42, s51
v_mfma_f32_16x16x32_bf16 v[176:179], a[32:35], a[128:131], v[176:179]
s_cselect_b64 s[16:17], s[40:41], s[16:17]
v_mfma_f32_16x16x32_bf16 v[176:179], a[36:39], a[132:135], v[176:179]
s_cselect_b32 s18, s42, s18
v_mfma_f32_16x16x32_bf16 v[180:183], a[40:43], a[128:131], v[180:183]
s_cselect_b64 s[40:41], s[44:45], s[40:41]
ds_read_b128 a[108:111], v3 offset:43008
v_mfma_f32_16x16x32_bf16 v[180:183], a[44:47], a[132:135], v[180:183]
s_cselect_b32 s42, s46, s42
v_mfma_f32_16x16x32_bf16 v[184:187], a[48:51], a[128:131], v[184:187]
s_cselect_b32 s46, 0, s46
ds_read_b128 a[112:115], v2 offset:45056
v_mfma_f32_16x16x32_bf16 v[184:187], a[52:55], a[132:135], v[184:187]
v_mfma_f32_16x16x32_bf16 v[188:191], a[56:59], a[128:131], v[188:191]
v_mfma_f32_16x16x32_bf16 v[188:191], a[60:63], a[132:135], v[188:191]
s_waitcnt lgkmcnt(2)
v_mfma_f32_16x16x32_bf16 v[192:195], a[0:3], a[136:139], v[192:195]
ds_read_b64_tr_b16 a[128:129], v10 offset:0
v_mfma_f32_16x16x32_bf16 v[192:195], a[4:7], a[140:143], v[192:195]
v_mfma_f32_16x16x32_bf16 v[196:199], a[8:11], a[136:139], v[196:199]
ds_read_b64_tr_b16 a[130:131], v10 offset:2048
v_mfma_f32_16x16x32_bf16 v[196:199], a[12:15], a[140:143], v[196:199]
v_mfma_f32_16x16x32_bf16 v[200:203], a[16:19], a[136:139], v[200:203]
ds_read_b64_tr_b16 a[132:133], v10 offset:16384
v_mfma_f32_16x16x32_bf16 v[200:203], a[20:23], a[140:143], v[200:203]
v_mfma_f32_16x16x32_bf16 v[204:207], a[24:27], a[136:139], v[204:207]
ds_read_b64_tr_b16 a[134:135], v10 offset:18432
v_mfma_f32_16x16x32_bf16 v[204:207], a[28:31], a[140:143], v[204:207]
v_mfma_f32_16x16x32_bf16 v[208:211], a[32:35], a[136:139], v[208:211]
ds_read_b128 a[116:119], v3 offset:45056
v_mfma_f32_16x16x32_bf16 v[208:211], a[36:39], a[140:143], v[208:211]
v_mfma_f32_16x16x32_bf16 v[212:215], a[40:43], a[136:139], v[212:215]
ds_read_b128 a[120:123], v2 offset:47104
v_and_b32 v252, 31, v0
v_mfma_f32_16x16x32_bf16 v[212:215], a[44:47], a[140:143], v[212:215]
v_lshrrev_b32 v253, 5, v0
v_xor_b32 v253, v253, v252
v_mfma_f32_16x16x32_bf16 v[216:219], a[48:51], a[136:139], v[216:219]
v_and_b32 v253, 7, v253
v_lshlrev_b32 v252, 8, v252
v_mfma_f32_16x16x32_bf16 v[216:219], a[52:55], a[140:143], v[216:219]
v_lshl_add_u32 v252, v253, 4, v252
v_add_u32 v252, 147456, v252
v_mfma_f32_16x16x32_bf16 v[220:223], a[56:59], a[136:139], v[220:223]
ds_read_b128 a[124:127], v3 offset:47104
v_mfma_f32_16x16x32_bf16 v[220:223], a[60:63], a[140:143], v[220:223]
s_waitcnt lgkmcnt(3)
v_mfma_f32_16x16x32_bf16 a[192:195], a[0:3], a[128:131], a[192:195]
ds_read_b64_tr_b16 a[136:137], v11 offset:0
v_mfma_f32_16x16x32_bf16 a[192:195], a[4:7], a[132:135], a[192:195]
v_mfma_f32_16x16x32_bf16 a[196:199], a[8:11], a[128:131], a[196:199]
ds_read_b64_tr_b16 a[138:139], v11 offset:2048
v_mfma_f32_16x16x32_bf16 a[196:199], a[12:15], a[132:135], a[196:199]
v_mfma_f32_16x16x32_bf16 a[200:203], a[16:19], a[128:131], a[200:203]
ds_read_b64_tr_b16 a[140:141], v11 offset:16384
v_mfma_f32_16x16x32_bf16 a[200:203], a[20:23], a[132:135], a[200:203]
v_mfma_f32_16x16x32_bf16 a[204:207], a[24:27], a[128:131], a[204:207]
ds_read_b64_tr_b16 a[142:143], v11 offset:18432
v_mfma_f32_16x16x32_bf16 a[204:207], a[28:31], a[132:135], a[204:207]
v_mfma_f32_16x16x32_bf16 a[208:211], a[32:35], a[128:131], a[208:211]
v_mfma_f32_16x16x32_bf16 a[208:211], a[36:39], a[132:135], a[208:211]
v_mfma_f32_16x16x32_bf16 a[212:215], a[40:43], a[128:131], a[212:215]
v_mfma_f32_16x16x32_bf16 a[212:215], a[44:47], a[132:135], a[212:215]
v_mfma_f32_16x16x32_bf16 a[216:219], a[48:51], a[128:131], a[216:219]
v_mfma_f32_16x16x32_bf16 a[216:219], a[52:55], a[132:135], a[216:219]
v_mfma_f32_16x16x32_bf16 a[220:223], a[56:59], a[128:131], a[220:223]
s_waitcnt vmcnt(2) lgkmcnt(0)
v_mfma_f32_16x16x32_bf16 a[220:223], a[60:63], a[132:135], a[220:223]
s_barrier
v_mfma_f32_16x16x32_bf16 a[224:227], a[0:3], a[136:139], a[224:227]
s_add_u32 m0, s29, 65536
ds_read_b64_tr_b16 a[128:129], v4 offset:32768
v_lshlrev_b32 v28, 16, v248
v_mfma_f32_16x16x32_bf16 a[224:227], a[4:7], a[140:143], a[224:227]
buffer_load_dwordx4 v16, s[12:15], s26 offen offset:0 lds
v_mfma_f32_16x16x32_bf16 a[228:231], a[8:11], a[136:139], a[228:231]
ds_read_b64_tr_b16 a[130:131], v4 offset:34816
v_and_b32 v29, s58, v248
v_mfma_f32_16x16x32_bf16 a[228:231], a[12:15], a[140:143], a[228:231]
v_lshlrev_b32 v30, 16, v249
v_and_b32 v253, s58, v249
v_mfma_f32_16x16x32_bf16 a[232:235], a[16:19], a[136:139], a[232:235]
ds_read_b64_tr_b16 a[132:133], v4 offset:49152
v_lshlrev_b32 v22, 16, v224
v_mfma_f32_16x16x32_bf16 a[232:235], a[20:23], a[140:143], a[232:235]
buffer_load_dwordx4 v17, s[12:15], s26 offen offset:1024 lds
v_mfma_f32_16x16x32_bf16 a[236:239], a[24:27], a[136:139], a[236:239]
ds_read_b64_tr_b16 a[134:135], v4 offset:51200
v_lshlrev_b32 v23, 16, v225
v_mfma_f32_16x16x32_bf16 a[236:239], a[28:31], a[140:143], a[236:239]
v_lshlrev_b32 v24, 16, v226
v_mul_f32 v254, v22, v253
v_mfma_f32_16x16x32_bf16 a[240:243], a[32:35], a[136:139], a[240:243]
v_lshlrev_b32 v25, 16, v227
v_lshlrev_b32 v247, 16, v236
v_mfma_f32_16x16x32_bf16 a[240:243], a[36:39], a[140:143], a[240:243]
buffer_load_dwordx4 v18, s[12:15], s26 offen offset:2048 lds
v_mfma_f32_16x16x32_bf16 a[244:247], a[40:43], a[136:139], a[244:247]
v_fmac_f32 v254, v23, v30
v_fmac_f32 v254, v24, v29
v_mfma_f32_16x16x32_bf16 a[244:247], a[44:47], a[140:143], a[244:247]
v_fmac_f32 v254, v25, v28
v_mul_f32 v254, v254, v247
v_mfma_f32_16x16x32_bf16 a[248:251], a[48:51], a[136:139], a[248:251]
v_mul_f32 v255, v23, v253
v_lshlrev_b32 v22, 16, v228
v_mfma_f32_16x16x32_bf16 a[248:251], a[52:55], a[140:143], a[248:251]
buffer_load_dwordx4 v19, s[12:15], s26 offen offset:3072 lds
v_mfma_f32_16x16x32_bf16 a[252:255], a[56:59], a[136:139], a[252:255]
s_add_u32 s26, s26, 524288
v_lshlrev_b32 v247, 16, v237
v_fmac_f32 v255, v24, v30
v_mfma_f32_16x16x32_bf16 a[252:255], a[60:63], a[140:143], a[252:255]
s_waitcnt lgkmcnt(0)
v_fmac_f32 v255, v25, v29
v_fmac_f32 v255, v22, v28
v_mfma_f32_16x16x32_bf16 v[32:35], a[64:67], a[128:131], v[32:35]
s_add_u32 m0, s29, 81920
ds_read_b64_tr_b16 a[136:137], v5 offset:32768
v_mul_f32 v255, v255, v247
v_mfma_f32_16x16x32_bf16 v[32:35], a[68:71], a[132:135], v[32:35]
buffer_load_dwordx4 v16, s[12:15], s27 offen offset:0 lds
v_mfma_f32_16x16x32_bf16 v[36:39], a[72:75], a[128:131], v[36:39]
ds_read_b64_tr_b16 a[138:139], v5 offset:34816
v_cvt_pk_bf16_f32 v246, v254, v255
v_mfma_f32_16x16x32_bf16 v[36:39], a[76:79], a[132:135], v[36:39]
v_accvgpr_write_b32 a180, v246
v_mul_f32 v254, v24, v253
v_mfma_f32_16x16x32_bf16 v[40:43], a[80:83], a[128:131], v[40:43]
ds_read_b64_tr_b16 a[140:141], v5 offset:49152
v_lshlrev_b32 v23, 16, v229
v_mfma_f32_16x16x32_bf16 v[40:43], a[84:87], a[132:135], v[40:43]
buffer_load_dwordx4 v17, s[12:15], s27 offen offset:1024 lds
v_lshlrev_b32 v247, 16, v238
v_mfma_f32_16x16x32_bf16 v[44:47], a[88:91], a[128:131], v[44:47]
ds_read_b64_tr_b16 a[142:143], v5 offset:51200
v_fmac_f32 v254, v25, v30
v_mfma_f32_16x16x32_bf16 v[44:47], a[92:95], a[132:135], v[44:47]
v_fmac_f32 v254, v22, v29
v_fmac_f32 v254, v23, v28
v_mfma_f32_16x16x32_bf16 v[48:51], a[96:99], a[128:131], v[48:51]
ds_read_b128 a[0:3], v2 offset:0
v_mul_f32 v254, v254, v247
v_mfma_f32_16x16x32_bf16 v[48:51], a[100:103], a[132:135], v[48:51]
buffer_load_dwordx4 v18, s[12:15], s27 offen offset:2048 lds
v_mfma_f32_16x16x32_bf16 v[52:55], a[104:107], a[128:131], v[52:55]
ds_read_b128 a[4:7], v3 offset:0
v_cvt_pk_bf16_f32 v246, v255, v254
v_accvgpr_write_b32 a176, v246
v_mfma_f32_16x16x32_bf16 v[52:55], a[108:111], a[132:135], v[52:55]
v_mul_f32 v255, v25, v253
v_lshlrev_b32 v24, 16, v230
v_mfma_f32_16x16x32_bf16 v[56:59], a[112:115], a[128:131], v[56:59]
v_lshlrev_b32 v247, 16, v239
v_fmac_f32 v255, v22, v30
v_mfma_f32_16x16x32_bf16 v[56:59], a[116:119], a[132:135], v[56:59]
buffer_load_dwordx4 v19, s[12:15], s27 offen offset:3072 lds
v_mfma_f32_16x16x32_bf16 v[60:63], a[120:123], a[128:131], v[60:63]
s_add_u32 s27, s27, 524288
ds_read_b128 a[8:11], v2 offset:2048
v_fmac_f32 v255, v23, v29
v_mfma_f32_16x16x32_bf16 v[60:63], a[124:127], a[132:135], v[60:63]
s_waitcnt lgkmcnt(3)
v_fmac_f32 v255, v24, v28
v_mul_f32 v255, v255, v247
v_mfma_f32_16x16x32_bf16 v[64:67], a[64:67], a[136:139], v[64:67]
s_add_u32 m0, s28, 32768
ds_read_b64_tr_b16 a[128:129], v6 offset:32768
v_cvt_pk_bf16_f32 v246, v254, v255
v_accvgpr_write_b32 a181, v246
v_mfma_f32_16x16x32_bf16 v[64:67], a[68:71], a[140:143], v[64:67]
buffer_load_dwordx4 v12, s[8:11], s24 offen offset:0 lds
v_mfma_f32_16x16x32_bf16 v[68:71], a[72:75], a[136:139], v[68:71]
ds_read_b64_tr_b16 a[130:131], v6 offset:34816
v_mul_f32 v254, v22, v253
v_mfma_f32_16x16x32_bf16 v[68:71], a[76:79], a[140:143], v[68:71]
v_lshlrev_b32 v25, 16, v231
v_lshlrev_b32 v247, 16, v240
v_mfma_f32_16x16x32_bf16 v[72:75], a[80:83], a[136:139], v[72:75]
ds_read_b64_tr_b16 a[132:133], v6 offset:49152
v_fmac_f32 v254, v23, v30
v_mfma_f32_16x16x32_bf16 v[72:75], a[84:87], a[140:143], v[72:75]
buffer_load_dwordx4 v13, s[8:11], s24 offen offset:1024 lds
v_fmac_f32 v254, v24, v29
v_mfma_f32_16x16x32_bf16 v[76:79], a[88:91], a[136:139], v[76:79]
ds_read_b64_tr_b16 a[134:135], v6 offset:51200
v_fmac_f32 v254, v25, v28
v_mfma_f32_16x16x32_bf16 v[76:79], a[92:95], a[140:143], v[76:79]
v_mul_f32 v254, v254, v247
v_cvt_pk_bf16_f32 v246, v255, v254
v_mfma_f32_16x16x32_bf16 v[80:83], a[96:99], a[136:139], v[80:83]
ds_read_b128 a[12:15], v3 offset:2048
v_accvgpr_write_b32 a177, v246
v_mfma_f32_16x16x32_bf16 v[80:83], a[100:103], a[140:143], v[80:83]
buffer_load_dwordx4 v14, s[8:11], s24 offen offset:2048 lds
v_mfma_f32_16x16x32_bf16 v[84:87], a[104:107], a[136:139], v[84:87]
v_mul_f32 v255, v23, v253
v_lshlrev_b32 v22, 16, v232
v_lshlrev_b32 v247, 16, v241
v_mfma_f32_16x16x32_bf16 v[84:87], a[108:111], a[140:143], v[84:87]
v_fmac_f32 v255, v24, v30
v_fmac_f32 v255, v25, v29
v_mfma_f32_16x16x32_bf16 v[88:91], a[112:115], a[136:139], v[88:91]
ds_read_b128 a[16:19], v2 offset:4096
v_fmac_f32 v255, v22, v28
v_mfma_f32_16x16x32_bf16 v[88:91], a[116:119], a[140:143], v[88:91]
PAD_24:
s_cbranch_execz PAD_28
buffer_load_dwordx4 v15, s[8:11], s24 offen offset:3072 lds
v_mfma_f32_16x16x32_bf16 v[92:95], a[120:123], a[136:139], v[92:95]
s_add_u32 s24, s24, 128
ds_read_b128 a[20:23], v3 offset:4096
v_mul_f32 v255, v255, v247
v_mfma_f32_16x16x32_bf16 v[92:95], a[124:127], a[140:143], v[92:95]
s_waitcnt lgkmcnt(3)
v_cvt_pk_bf16_f32 v246, v254, v255
v_accvgpr_write_b32 a182, v246
v_mfma_f32_16x16x32_bf16 v[96:99], a[64:67], a[128:131], v[96:99]
s_add_u32 m0, s28, 36864
ds_read_b64_tr_b16 a[136:137], v7 offset:32768
v_mul_f32 v254, v24, v253
v_lshlrev_b32 v23, 16, v233
v_mfma_f32_16x16x32_bf16 v[96:99], a[68:71], a[132:135], v[96:99]
buffer_load_dwordx4 v12, s[8:11], s25 offen offset:0 lds
v_mfma_f32_16x16x32_bf16 v[100:103], a[72:75], a[128:131], v[100:103]
ds_read_b64_tr_b16 a[138:139], v7 offset:34816
v_lshlrev_b32 v247, 16, v242
v_mfma_f32_16x16x32_bf16 v[100:103], a[76:79], a[132:135], v[100:103]
v_fmac_f32 v254, v25, v30
v_fmac_f32 v254, v22, v29
v_mfma_f32_16x16x32_bf16 v[104:107], a[80:83], a[128:131], v[104:107]
ds_read_b64_tr_b16 a[140:141], v7 offset:49152
v_fmac_f32 v254, v23, v28
v_mfma_f32_16x16x32_bf16 v[104:107], a[84:87], a[132:135], v[104:107]
buffer_load_dwordx4 v13, s[8:11], s25 offen offset:1024 lds
v_mul_f32 v254, v254, v247
v_mfma_f32_16x16x32_bf16 v[108:111], a[88:91], a[128:131], v[108:111]
ds_read_b64_tr_b16 a[142:143], v7 offset:51200
v_cvt_pk_bf16_f32 v246, v255, v254
v_mfma_f32_16x16x32_bf16 v[108:111], a[92:95], a[132:135], v[108:111]
v_accvgpr_write_b32 a178, v246
v_mul_f32 v255, v25, v253
v_mfma_f32_16x16x32_bf16 v[112:115], a[96:99], a[128:131], v[112:115]
v_lshlrev_b32 v24, 16, v234
v_lshlrev_b32 v247, 16, v243
v_mfma_f32_16x16x32_bf16 v[112:115], a[100:103], a[132:135], v[112:115]
buffer_load_dwordx4 v14, s[8:11], s25 offen offset:2048 lds
v_mfma_f32_16x16x32_bf16 v[116:119], a[104:107], a[128:131], v[116:119]
ds_read_b128 a[24:27], v2 offset:6144
v_fmac_f32 v255, v22, v30
v_fmac_f32 v255, v23, v29
v_mfma_f32_16x16x32_bf16 v[116:119], a[108:111], a[132:135], v[116:119]
v_fmac_f32 v255, v24, v28
v_mul_f32 v255, v255, v247
v_mfma_f32_16x16x32_bf16 v[120:123], a[112:115], a[128:131], v[120:123]
ds_read_b128 a[28:31], v3 offset:6144
v_cvt_pk_bf16_f32 v246, v254, v255
v_mfma_f32_16x16x32_bf16 v[120:123], a[116:119], a[132:135], v[120:123]
buffer_load_dwordx4 v15, s[8:11], s25 offen offset:3072 lds
v_mfma_f32_16x16x32_bf16 v[124:127], a[120:123], a[128:131], v[124:127]
s_add_u32 s25, s25, 128
v_accvgpr_write_b32 a183, v246
v_mul_f32 v254, v22, v253
v_mfma_f32_16x16x32_bf16 v[124:127], a[124:127], a[132:135], v[124:127]
s_waitcnt lgkmcnt(2)
v_lshlrev_b32 v25, 16, v235
v_lshlrev_b32 v247, 16, v244
v_mfma_f32_16x16x32_bf16 v[128:131], a[64:67], a[136:139], v[128:131]
ds_read_b64_tr_b16 a[128:129], v8 offset:32768
v_fmac_f32 v254, v23, v30
v_fmac_f32 v254, v24, v29
v_mfma_f32_16x16x32_bf16 v[128:131], a[68:71], a[140:143], v[128:131]
buffer_load_dword v21, v20, s[16:19], s43 offen
v_mfma_f32_16x16x32_bf16 v[132:135], a[72:75], a[136:139], v[132:135]
s_add_u32 s43, s43, s47
ds_read_b64_tr_b16 a[130:131], v8 offset:34816
v_fmac_f32 v254, v25, v28
v_mfma_f32_16x16x32_bf16 v[132:135], a[76:79], a[140:143], v[132:135]
s_cmp_ge_u32 s43, s51
v_mul_f32 v254, v254, v247
v_cvt_pk_bf16_f32 v246, v255, v254
v_mfma_f32_16x16x32_bf16 v[136:139], a[80:83], a[136:139], v[136:139]
s_cselect_b32 s43, 0, s43
ds_read_b64_tr_b16 a[132:133], v8 offset:49152
v_accvgpr_write_b32 a179, v246
v_mfma_f32_16x16x32_bf16 v[136:139], a[84:87], a[140:143], v[136:139]
s_cselect_b32 s51, s42, s51
v_lshlrev_b32 v28, 16, v250
v_and_b32 v29, s58, v250
v_lshlrev_b32 v30, 16, v251
v_mfma_f32_16x16x32_bf16 v[140:143], a[88:91], a[136:139], v[140:143]
s_cselect_b64 s[16:17], s[40:41], s[16:17]
ds_read_b64_tr_b16 a[134:135], v8 offset:51200
v_and_b32 v253, s58, v251
v_mfma_f32_16x16x32_bf16 v[140:143], a[92:95], a[140:143], v[140:143]
s_cselect_b32 s18, s42, s18
v_and_b32 v22, s58, v224
v_and_b32 v23, s58, v225
v_mfma_f32_16x16x32_bf16 v[144:147], a[96:99], a[136:139], v[144:147]
s_cselect_b64 s[40:41], s[44:45], s[40:41]
ds_read_b128 a[32:35], v2 offset:8192
v_and_b32 v24, s58, v226
v_mfma_f32_16x16x32_bf16 v[144:147], a[100:103], a[140:143], v[144:147]
s_cselect_b32 s42, s46, s42
v_mul_f32 v254, v22, v253
v_and_b32 v25, s58, v227
v_mfma_f32_16x16x32_bf16 v[148:151], a[104:107], a[136:139], v[148:151]
s_cselect_b32 s46, 0, s46
v_and_b32 v247, s58, v236
v_fmac_f32 v254, v23, v30
v_mfma_f32_16x16x32_bf16 v[148:151], a[108:111], a[140:143], v[148:151]
buffer_load_dword v245, off, s[60:63], 0 sc1
v_fmac_f32 v254, v24, v29
v_mfma_f32_16x16x32_bf16 v[152:155], a[112:115], a[136:139], v[152:155]
ds_read_b128 a[36:39], v3 offset:8192
v_fmac_f32 v254, v25, v28
v_mfma_f32_16x16x32_bf16 v[152:155], a[116:119], a[140:143], v[152:155]
v_mul_f32 v254, v254, v247
v_mul_f32 v255, v23, v253
v_mfma_f32_16x16x32_bf16 v[156:159], a[120:123], a[136:139], v[156:159]
ds_read_b128 a[40:43], v2 offset:10240
v_and_b32 v22, s58, v228
v_mfma_f32_16x16x32_bf16 v[156:159], a[124:127], a[140:143], v[156:159]
s_waitcnt lgkmcnt(3)
v_and_b32 v247, s58, v237
v_fmac_f32 v255, v24, v30
v_mfma_f32_16x16x32_bf16 v[160:163], a[64:67], a[128:131], v[160:163]
ds_read_b64_tr_b16 a[136:137], v9 offset:32768
v_fmac_f32 v255, v25, v29
v_fmac_f32 v255, v22, v28
v_mfma_f32_16x16x32_bf16 v[160:163], a[68:71], a[132:135], v[160:163]
v_mul_f32 v255, v255, v247
v_cvt_pk_bf16_f32 v246, v254, v255
v_mfma_f32_16x16x32_bf16 v[164:167], a[72:75], a[128:131], v[164:167]
ds_read_b64_tr_b16 a[138:139], v9 offset:34816
v_accvgpr_write_b32 a188, v246
v_mfma_f32_16x16x32_bf16 v[164:167], a[76:79], a[132:135], v[164:167]
v_mul_f32 v254, v24, v253
v_and_b32 v23, s58, v229
v_mfma_f32_16x16x32_bf16 v[168:171], a[80:83], a[128:131], v[168:171]
ds_read_b64_tr_b16 a[140:141], v9 offset:49152
v_and_b32 v247, s58, v238
v_mfma_f32_16x16x32_bf16 v[168:171], a[84:87], a[132:135], v[168:171]
v_fmac_f32 v254, v25, v30
v_fmac_f32 v254, v22, v29
v_fmac_f32 v254, v23, v28
v_mfma_f32_16x16x32_bf16 v[172:175], a[88:91], a[128:131], v[172:175]
ds_read_b64_tr_b16 a[142:143], v9 offset:51200
v_mul_f32 v254, v254, v247
v_mfma_f32_16x16x32_bf16 v[172:175], a[92:95], a[132:135], v[172:175]
v_cvt_pk_bf16_f32 v246, v255, v254
v_accvgpr_write_b32 a184, v246
v_mfma_f32_16x16x32_bf16 v[176:179], a[96:99], a[128:131], v[176:179]
v_mul_f32 v255, v25, v253
v_and_b32 v24, s58, v230
v_mfma_f32_16x16x32_bf16 v[176:179], a[100:103], a[132:135], v[176:179]
v_and_b32 v247, s58, v239
v_fmac_f32 v255, v22, v30
v_mfma_f32_16x16x32_bf16 v[180:183], a[104:107], a[128:131], v[180:183]
ds_read_b128 a[44:47], v3 offset:10240
v_fmac_f32 v255, v23, v29
v_mfma_f32_16x16x32_bf16 v[180:183], a[108:111], a[132:135], v[180:183]
v_fmac_f32 v255, v24, v28
v_mul_f32 v255, v255, v247
v_cvt_pk_bf16_f32 v246, v254, v255
v_mfma_f32_16x16x32_bf16 v[184:187], a[112:115], a[128:131], v[184:187]
ds_read_b128 a[48:51], v2 offset:12288
v_accvgpr_write_b32 a189, v246
v_mfma_f32_16x16x32_bf16 v[184:187], a[116:119], a[132:135], v[184:187]
v_mul_f32 v254, v22, v253
v_and_b32 v25, s58, v231
v_mfma_f32_16x16x32_bf16 v[188:191], a[120:123], a[128:131], v[188:191]
v_and_b32 v247, s58, v240
v_fmac_f32 v254, v23, v30
v_mfma_f32_16x16x32_bf16 v[188:191], a[124:127], a[132:135], v[188:191]
s_waitcnt lgkmcnt(2)
v_fmac_f32 v254, v24, v29
v_fmac_f32 v254, v25, v28
v_mfma_f32_16x16x32_bf16 v[192:195], a[64:67], a[136:139], v[192:195]
ds_read_b64_tr_b16 a[128:129], v10 offset:32768
v_mul_f32 v254, v254, v247
v_cvt_pk_bf16_f32 v246, v255, v254
v_mfma_f32_16x16x32_bf16 v[192:195], a[68:71], a[140:143], v[192:195]
v_accvgpr_write_b32 a185, v246
v_mul_f32 v255, v23, v253
v_mfma_f32_16x16x32_bf16 v[196:199], a[72:75], a[136:139], v[196:199]
ds_read_b64_tr_b16 a[130:131], v10 offset:34816
v_and_b32 v22, s58, v232
v_mfma_f32_16x16x32_bf16 v[196:199], a[76:79], a[140:143], v[196:199]
v_and_b32 v247, s58, v241
v_fmac_f32 v255, v24, v30
v_mfma_f32_16x16x32_bf16 v[200:203], a[80:83], a[136:139], v[200:203]
s_lshr_b32 s22, s3, 1
ds_read_b64_tr_b16 a[132:133], v10 offset:49152
v_fmac_f32 v255, v25, v29
v_mfma_f32_16x16x32_bf16 v[200:203], a[84:87], a[140:143], v[200:203]
s_mul_i32 s22, s22, 2097152
v_fmac_f32 v255, v22, v28
v_mul_f32 v255, v255, v247
v_cvt_pk_bf16_f32 v246, v254, v255
v_mfma_f32_16x16x32_bf16 v[204:207], a[88:91], a[136:139], v[204:207]
s_and_b32 s23, s3, 1
ds_read_b64_tr_b16 a[134:135], v10 offset:51200
v_accvgpr_write_b32 a190, v246
v_mfma_f32_16x16x32_bf16 v[204:207], a[92:95], a[140:143], v[204:207]
s_lshl_b32 s23, s23, 5
v_mul_f32 v254, v24, v253
v_and_b32 v23, s58, v233
v_mfma_f32_16x16x32_bf16 v[208:211], a[96:99], a[136:139], v[208:211]
s_lshl_b32 s56, s39, 6
ds_read_b128 a[52:55], v3 offset:12288
v_and_b32 v247, s58, v242
v_mfma_f32_16x16x32_bf16 v[208:211], a[100:103], a[140:143], v[208:211]
s_add_u32 s23, s23, s56
v_fmac_f32 v254, v25, v30
v_fmac_f32 v254, v22, v29
v_mfma_f32_16x16x32_bf16 v[212:215], a[104:107], a[136:139], v[212:215]
s_mul_i32 s23, s23, 4224
ds_read_b128 a[56:59], v2 offset:14336
v_fmac_f32 v254, v23, v28
v_mfma_f32_16x16x32_bf16 v[212:215], a[108:111], a[140:143], v[212:215]
s_add_u32 s22, s22, s23
v_mul_f32 v254, v254, v247
v_cvt_pk_bf16_f32 v246, v255, v254
v_accvgpr_write_b32 a186, v246
v_mfma_f32_16x16x32_bf16 v[216:219], a[112:115], a[136:139], v[216:219]
s_add_u32 s57, s22, 83886200
v_mul_f32 v255, v25, v253
v_and_b32 v24, s58, v234
v_mfma_f32_16x16x32_bf16 v[216:219], a[116:119], a[140:143], v[216:219]
s_lshl_b32 s23, s38, 7
v_and_b32 v247, s58, v243
v_fmac_f32 v255, v22, v30
v_mfma_f32_16x16x32_bf16 v[220:223], a[120:123], a[136:139], v[220:223]
s_add_u32 s22, s22, s23
ds_read_b128 a[60:63], v3 offset:14336
v_fmac_f32 v255, v23, v29
v_mfma_f32_16x16x32_bf16 v[220:223], a[124:127], a[140:143], v[220:223]
s_waitcnt lgkmcnt(3)
s_add_u32 s56, s22, 83886208
v_fmac_f32 v255, v24, v28
v_mul_f32 v255, v255, v247
v_mfma_f32_16x16x32_bf16 a[192:195], a[64:67], a[128:131], a[192:195]
s_cmp_lt_u32 s2, 224
ds_read_b64_tr_b16 a[136:137], v11 offset:32768
v_cvt_pk_bf16_f32 v246, v254, v255
v_accvgpr_write_b32 a191, v246
v_mfma_f32_16x16x32_bf16 a[192:195], a[68:71], a[132:135], a[192:195]
s_cselect_b32 s56, s56, 3221225472
v_mul_f32 v254, v22, v253
v_and_b32 v25, s58, v235
v_mfma_f32_16x16x32_bf16 a[196:199], a[72:75], a[128:131], a[196:199]
s_cmp_eq_u32 s38, 0
ds_read_b64_tr_b16 a[138:139], v11 offset:34816
v_and_b32 v247, s58, v244
v_mfma_f32_16x16x32_bf16 a[196:199], a[76:79], a[132:135], a[196:199]
s_cselect_b32 s57, s57, 3221225472
v_fmac_f32 v254, v23, v30
v_fmac_f32 v254, v24, v29
v_mfma_f32_16x16x32_bf16 a[200:203], a[80:83], a[128:131], a[200:203]
ds_read_b64_tr_b16 a[140:141], v11 offset:49152
v_fmac_f32 v254, v25, v28
v_mfma_f32_16x16x32_bf16 a[200:203], a[84:87], a[132:135], a[200:203]
v_mul_f32 v254, v254, v247
v_cvt_pk_bf16_f32 v246, v255, v254
v_accvgpr_write_b32 a187, v246
v_mfma_f32_16x16x32_bf16 a[204:207], a[88:91], a[128:131], a[204:207]
ds_read_b64_tr_b16 a[142:143], v11 offset:51200
v_mfma_f32_16x16x32_bf16 a[204:207], a[92:95], a[132:135], a[204:207]
ds_write_b128 v252, a[176:179] offset:0
v_mfma_f32_16x16x32_bf16 a[208:211], a[96:99], a[128:131], a[208:211]
v_mfma_f32_16x16x32_bf16 a[208:211], a[100:103], a[132:135], a[208:211]
ds_write_b128 v252, a[180:183] offset:8192
v_mfma_f32_16x16x32_bf16 a[212:215], a[104:107], a[128:131], a[212:215]
v_mfma_f32_16x16x32_bf16 a[212:215], a[108:111], a[132:135], a[212:215]
ds_write_b128 v252, a[184:187] offset:128
v_mfma_f32_16x16x32_bf16 a[216:219], a[112:115], a[128:131], a[216:219]
v_mfma_f32_16x16x32_bf16 a[216:219], a[116:119], a[132:135], a[216:219]
ds_write_b128 v252, a[188:191] offset:8320
v_mfma_f32_16x16x32_bf16 a[220:223], a[120:123], a[128:131], a[220:223]
s_waitcnt vmcnt(2) lgkmcnt(0)
v_mfma_f32_16x16x32_bf16 a[220:223], a[124:127], a[132:135], a[220:223]
s_barrier
v_mfma_f32_16x16x32_bf16 a[224:227], a[64:67], a[136:139], a[224:227]
s_add_u32 m0, s29, 98304
ds_read_b64_tr_b16 a[128:129], v4 offset:0
v_lshrrev_b32 v22, 8, v1
v_mfma_f32_16x16x32_bf16 a[224:227], a[68:71], a[140:143], a[224:227]
buffer_load_dwordx4 v16, s[12:15], s26 offen offset:0 lds
v_mfma_f32_16x16x32_bf16 a[228:231], a[72:75], a[136:139], a[228:231]
ds_read_b64_tr_b16 a[130:131], v4 offset:2048
v_lshlrev_b32 v22, 4, v22
v_mfma_f32_16x16x32_bf16 a[228:231], a[76:79], a[140:143], a[228:231]
v_xor_b32 v22, v22, v1
v_add_u32 v22, s29, v22
v_mfma_f32_16x16x32_bf16 a[232:235], a[80:83], a[136:139], a[232:235]
ds_read_b64_tr_b16 a[132:133], v4 offset:16384
v_add_u32 v22, 147456, v22
v_mfma_f32_16x16x32_bf16 a[232:235], a[84:87], a[140:143], a[232:235]
buffer_load_dwordx4 v17, s[12:15], s26 offen offset:1024 lds
v_mfma_f32_16x16x32_bf16 a[236:239], a[88:91], a[136:139], a[236:239]
ds_read_b64_tr_b16 a[134:135], v4 offset:18432
v_xor_b32 v23, 64, v22
v_mfma_f32_16x16x32_bf16 a[236:239], a[92:95], a[140:143], a[236:239]
v_lshrrev_b32 v224, 7, v1
v_mul_u32_u24 v224, 4224, v224
v_mfma_f32_16x16x32_bf16 a[240:243], a[96:99], a[136:139], a[240:243]
v_and_b32 v225, 0x70, v1
v_add_u32 v224, v224, v225
v_mfma_f32_16x16x32_bf16 a[240:243], a[100:103], a[140:143], a[240:243]
buffer_load_dwordx4 v18, s[12:15], s26 offen offset:2048 lds
v_mfma_f32_16x16x32_bf16 a[244:247], a[104:107], a[136:139], a[244:247]
v_bfe_u32 v225, v1, 4, 5
v_mul_u32_u24 v225, 4224, v225
v_mfma_f32_16x16x32_bf16 a[244:247], a[108:111], a[140:143], a[244:247]
v_mov_b32 v226, 0
v_mov_b32 v227, 0
v_mfma_f32_16x16x32_bf16 a[248:251], a[112:115], a[136:139], a[248:251]
v_mfma_f32_16x16x32_bf16 a[248:251], a[116:119], a[140:143], a[248:251]
buffer_load_dwordx4 v19, s[12:15], s26 offen offset:3072 lds
v_mfma_f32_16x16x32_bf16 a[252:255], a[120:123], a[136:139], a[252:255]
s_add_u32 s26, s26, 524288
v_mfma_f32_16x16x32_bf16 a[252:255], a[124:127], a[140:143], a[252:255]
s_waitcnt lgkmcnt(0)
v_mfma_f32_16x16x32_bf16 v[32:35], a[0:3], a[128:131], v[32:35]
s_add_u32 m0, s29, 114688
ds_read_b64_tr_b16 a[136:137], v5 offset:0
v_mfma_f32_16x16x32_bf16 v[32:35], a[4:7], a[132:135], v[32:35]
buffer_load_dwordx4 v16, s[12:15], s27 offen offset:0 lds
v_mfma_f32_16x16x32_bf16 v[36:39], a[8:11], a[128:131], v[36:39]
s_mul_i32 s52, s20, 7
ds_read_b64_tr_b16 a[138:139], v5 offset:2048
v_mfma_f32_16x16x32_bf16 v[36:39], a[12:15], a[132:135], v[36:39]
s_add_u32 s52, s52, s21
buffer_store_dwordx2 v[226:227], v225, s[4:7], s57 offen sc1
v_mfma_f32_16x16x32_bf16 v[40:43], a[16:19], a[128:131], v[40:43]
s_lshl_b32 s53, s52, 2
ds_read_b64_tr_b16 a[140:141], v5 offset:16384
v_mfma_f32_16x16x32_bf16 v[40:43], a[20:23], a[132:135], v[40:43]
s_add_u32 s53, s53, s3
buffer_load_dwordx4 v17, s[12:15], s27 offen offset:1024 lds
v_mfma_f32_16x16x32_bf16 v[44:47], a[24:27], a[128:131], v[44:47]
s_lshl_b32 s49, s53, 12
ds_read_b64_tr_b16 a[142:143], v5 offset:18432
v_mfma_f32_16x16x32_bf16 v[44:47], a[28:31], a[132:135], v[44:47]
s_mul_i32 s53, s53, 4224
v_mfma_f32_16x16x32_bf16 v[48:51], a[32:35], a[128:131], v[48:51]
s_add_u32 s53, s53, 83886080
ds_read_b128 a[64:67], v2 offset:32768
v_mfma_f32_16x16x32_bf16 v[48:51], a[36:39], a[132:135], v[48:51]
s_lshr_b32 s52, s52, 4
buffer_load_dwordx4 v18, s[12:15], s27 offen offset:2048 lds
v_mfma_f32_16x16x32_bf16 v[52:55], a[40:43], a[128:131], v[52:55]
s_min_u32 s52, s52, 6
ds_read_b128 a[68:71], v3 offset:32768
v_mfma_f32_16x16x32_bf16 v[52:55], a[44:47], a[132:135], v[52:55]
s_lshl_b32 s52, s52, 7
ds_read_b128 a[176:179], v22 offset:0
v_mfma_f32_16x16x32_bf16 v[56:59], a[48:51], a[128:131], v[56:59]
s_add_u32 s52, s52, 94392320
ds_read_b128 a[180:183], v23 offset:1024
v_mfma_f32_16x16x32_bf16 v[56:59], a[52:55], a[132:135], v[56:59]
buffer_load_dwordx4 v19, s[12:15], s27 offen offset:3072 lds
v_mfma_f32_16x16x32_bf16 v[60:63], a[56:59], a[128:131], v[60:63]
s_add_u32 s27, s27, 524288
ds_read_b128 a[72:75], v2 offset:34816
v_mfma_f32_16x16x32_bf16 v[60:63], a[60:63], a[132:135], v[60:63]
s_waitcnt lgkmcnt(5)
ds_read_b128 a[184:187], v22 offset:2048
v_mfma_f32_16x16x32_bf16 v[64:67], a[0:3], a[136:139], v[64:67]
s_add_u32 m0, s28, 0
ds_read_b64_tr_b16 a[128:129], v6 offset:0
v_mfma_f32_16x16x32_bf16 v[64:67], a[4:7], a[140:143], v[64:67]
buffer_load_dwordx4 v12, s[8:11], s24 offen offset:0 lds
v_mfma_f32_16x16x32_bf16 v[68:71], a[8:11], a[136:139], v[68:71]
ds_read_b64_tr_b16 a[130:131], v6 offset:2048
v_mfma_f32_16x16x32_bf16 v[68:71], a[12:15], a[140:143], v[68:71]
ds_read_b128 a[188:191], v23 offset:3072
v_mfma_f32_16x16x32_bf16 v[72:75], a[16:19], a[136:139], v[72:75]
ds_read_b64_tr_b16 a[132:133], v6 offset:16384
v_bfe_u32 v231, v1, 4, 5
v_mfma_f32_16x16x32_bf16 v[72:75], a[20:23], a[140:143], v[72:75]
buffer_load_dwordx4 v13, s[8:11], s24 offen offset:1024 lds
v_mfma_f32_16x16x32_bf16 v[76:79], a[24:27], a[136:139], v[76:79]
ds_read_b64_tr_b16 a[134:135], v6 offset:18432
v_lshlrev_b32 v231, 2, v231
v_mfma_f32_16x16x32_bf16 v[76:79], a[28:31], a[140:143], v[76:79]
v_lshlrev_b32 v229, 3, v1
v_min_u32 v229, 4096, v229
v_mfma_f32_16x16x32_bf16 v[80:83], a[32:35], a[136:139], v[80:83]
ds_read_b128 a[76:79], v3 offset:34816
v_mfma_f32_16x16x32_bf16 v[80:83], a[36:39], a[140:143], v[80:83]
buffer_load_dwordx4 v14, s[8:11], s24 offen offset:2048 lds
v_mfma_f32_16x16x32_bf16 v[84:87], a[40:43], a[136:139], v[84:87]
v_mfma_f32_16x16x32_bf16 v[84:87], a[44:47], a[140:143], v[84:87]
v_mfma_f32_16x16x32_bf16 v[88:91], a[48:51], a[136:139], v[88:91]
ds_read_b128 a[80:83], v2 offset:36864
v_mfma_f32_16x16x32_bf16 v[88:91], a[52:55], a[140:143], v[88:91]
buffer_load_dwordx4 v15, s[8:11], s24 offen offset:3072 lds
v_mfma_f32_16x16x32_bf16 v[92:95], a[56:59], a[136:139], v[92:95]
s_add_u32 s24, s24, 128
ds_read_b128 a[84:87], v3 offset:36864
v_mfma_f32_16x16x32_bf16 v[92:95], a[60:63], a[140:143], v[92:95]
s_waitcnt lgkmcnt(3)
v_mfma_f32_16x16x32_bf16 v[96:99], a[0:3], a[128:131], v[96:99]
s_add_u32 m0, s28, 4096
ds_read_b64_tr_b16 a[136:137], v7 offset:0
v_mfma_f32_16x16x32_bf16 v[96:99], a[4:7], a[132:135], v[96:99]
buffer_load_dwordx4 v12, s[8:11], s25 offen offset:0 lds
v_mfma_f32_16x16x32_bf16 v[100:103], a[8:11], a[128:131], v[100:103]
ds_read_b64_tr_b16 a[138:139], v7 offset:2048
v_mfma_f32_16x16x32_bf16 v[100:103], a[12:15], a[132:135], v[100:103]
v_mfma_f32_16x16x32_bf16 v[104:107], a[16:19], a[128:131], v[104:107]
ds_read_b64_tr_b16 a[140:141], v7 offset:16384
v_mfma_f32_16x16x32_bf16 v[104:107], a[20:23], a[132:135], v[104:107]
buffer_load_dwordx4 v13, s[8:11], s25 offen offset:1024 lds
v_mfma_f32_16x16x32_bf16 v[108:111], a[24:27], a[128:131], v[108:111]
ds_read_b64_tr_b16 a[142:143], v7 offset:18432
v_mfma_f32_16x16x32_bf16 v[108:111], a[28:31], a[132:135], v[108:111]
v_mfma_f32_16x16x32_bf16 v[112:115], a[32:35], a[128:131], v[112:115]
v_mfma_f32_16x16x32_bf16 v[112:115], a[36:39], a[132:135], v[112:115]
buffer_load_dwordx4 v14, s[8:11], s25 offen offset:2048 lds
v_mfma_f32_16x16x32_bf16 v[116:119], a[40:43], a[128:131], v[116:119]
ds_read_b128 a[88:91], v2 offset:38912
v_mfma_f32_16x16x32_bf16 v[116:119], a[44:47], a[132:135], v[116:119]
v_mfma_f32_16x16x32_bf16 v[120:123], a[48:51], a[128:131], v[120:123]
ds_read_b128 a[92:95], v3 offset:38912
v_mfma_f32_16x16x32_bf16 v[120:123], a[52:55], a[132:135], v[120:123]
buffer_load_dwordx4 v15, s[8:11], s25 offen offset:3072 lds
v_mfma_f32_16x16x32_bf16 v[124:127], a[56:59], a[128:131], v[124:127]
s_add_u32 s25, s25, 128
v_mfma_f32_16x16x32_bf16 v[124:127], a[60:63], a[132:135], v[124:127]
s_waitcnt lgkmcnt(2)
v_mfma_f32_16x16x32_bf16 v[128:131], a[0:3], a[136:139], v[128:131]
ds_read_b64_tr_b16 a[128:129], v8 offset:0
v_mfma_f32_16x16x32_bf16 v[128:131], a[4:7], a[140:143], v[128:131]
buffer_store_dwordx4 a[176:179], v224, s[4:7], s56 offen sc1
v_mfma_f32_16x16x32_bf16 v[132:135], a[8:11], a[136:139], v[132:135]
s_add_u32 s56, s56, 33792
ds_read_b64_tr_b16 a[130:131], v8 offset:2048
v_mfma_f32_16x16x32_bf16 v[132:135], a[12:15], a[140:143], v[132:135]
v_mfma_f32_16x16x32_bf16 v[136:139], a[16:19], a[136:139], v[136:139]
ds_read_b64_tr_b16 a[132:133], v8 offset:16384
v_mfma_f32_16x16x32_bf16 v[136:139], a[20:23], a[140:143], v[136:139]
v_mfma_f32_16x16x32_bf16 v[140:143], a[24:27], a[136:139], v[140:143]
s_cmp_lt_u32 s21, 7
ds_read_b64_tr_b16 a[134:135], v8 offset:18432
v_mfma_f32_16x16x32_bf16 v[140:143], a[28:31], a[140:143], v[140:143]
s_cselect_b32 s53, s53, 3221225472
v_mfma_f32_16x16x32_bf16 v[144:147], a[32:35], a[136:139], v[144:147]
s_cselect_b32 s49, s49, 3221225472
ds_read_b128 a[96:99], v2 offset:40960
v_mfma_f32_16x16x32_bf16 v[144:147], a[36:39], a[140:143], v[144:147]
s_add_u32 s48, s53, 2097152
v_mfma_f32_16x16x32_bf16 v[148:151], a[40:43], a[136:139], v[148:151]
v_mfma_f32_16x16x32_bf16 v[148:151], a[44:47], a[140:143], v[148:151]
v_mfma_f32_16x16x32_bf16 v[152:155], a[48:51], a[136:139], v[152:155]
ds_read_b128 a[100:103], v3 offset:40960
v_mfma_f32_16x16x32_bf16 v[152:155], a[52:55], a[140:143], v[152:155]
v_mfma_f32_16x16x32_bf16 v[156:159], a[56:59], a[136:139], v[156:159]
ds_read_b128 a[104:107], v2 offset:43008
v_mfma_f32_16x16x32_bf16 v[156:159], a[60:63], a[140:143], v[156:159]
s_waitcnt lgkmcnt(3)
v_mfma_f32_16x16x32_bf16 v[160:163], a[0:3], a[128:131], v[160:163]
ds_read_b64_tr_b16 a[136:137], v9 offset:0
v_mfma_f32_16x16x32_bf16 v[160:163], a[4:7], a[132:135], v[160:163]
v_mfma_f32_16x16x32_bf16 v[164:167], a[8:11], a[128:131], v[164:167]
ds_read_b64_tr_b16 a[138:139], v9 offset:2048
v_mfma_f32_16x16x32_bf16 v[164:167], a[12:15], a[132:135], v[164:167]
buffer_store_dwordx4 a[180:183], v224, s[4:7], s56 offen sc1
v_mfma_f32_16x16x32_bf16 v[168:171], a[16:19], a[128:131], v[168:171]
s_add_u32 s56, s56, 33792
ds_read_b64_tr_b16 a[140:141], v9 offset:16384
v_mfma_f32_16x16x32_bf16 v[168:171], a[20:23], a[132:135], v[168:171]
v_mfma_f32_16x16x32_bf16 v[172:175], a[24:27], a[128:131], v[172:175]
ds_read_b64_tr_b16 a[142:143], v9 offset:18432
v_mfma_f32_16x16x32_bf16 v[172:175], a[28:31], a[132:135], v[172:175]
v_mfma_f32_16x16x32_bf16 v[176:179], a[32:35], a[128:131], v[176:179]
v_mfma_f32_16x16x32_bf16 v[176:179], a[36:39], a[132:135], v[176:179]
v_mfma_f32_16x16x32_bf16 v[180:183], a[40:43], a[128:131], v[180:183]
ds_read_b128 a[108:111], v3 offset:43008
v_mfma_f32_16x16x32_bf16 v[180:183], a[44:47], a[132:135], v[180:183]
v_mfma_f32_16x16x32_bf16 v[184:187], a[48:51], a[128:131], v[184:187]
ds_read_b128 a[112:115], v2 offset:45056
v_mfma_f32_16x16x32_bf16 v[184:187], a[52:55], a[132:135], v[184:187]
v_mfma_f32_16x16x32_bf16 v[188:191], a[56:59], a[128:131], v[188:191]
v_mfma_f32_16x16x32_bf16 v[188:191], a[60:63], a[132:135], v[188:191]
s_waitcnt lgkmcnt(2)
v_mfma_f32_16x16x32_bf16 v[192:195], a[0:3], a[136:139], v[192:195]
ds_read_b64_tr_b16 a[128:129], v10 offset:0
v_mfma_f32_16x16x32_bf16 v[192:195], a[4:7], a[140:143], v[192:195]
v_mfma_f32_16x16x32_bf16 v[196:199], a[8:11], a[136:139], v[196:199]
ds_read_b64_tr_b16 a[130:131], v10 offset:2048
v_mfma_f32_16x16x32_bf16 v[196:199], a[12:15], a[140:143], v[196:199]
v_mfma_f32_16x16x32_bf16 v[200:203], a[16:19], a[136:139], v[200:203]
ds_read_b64_tr_b16 a[132:133], v10 offset:16384
v_mfma_f32_16x16x32_bf16 v[200:203], a[20:23], a[140:143], v[200:203]
buffer_store_dwordx4 a[184:187], v224, s[4:7], s56 offen sc1
v_mfma_f32_16x16x32_bf16 v[204:207], a[24:27], a[136:139], v[204:207]
s_add_u32 s56, s56, 33792
ds_read_b64_tr_b16 a[134:135], v10 offset:18432
v_mfma_f32_16x16x32_bf16 v[204:207], a[28:31], a[140:143], v[204:207]
v_mfma_f32_16x16x32_bf16 v[208:211], a[32:35], a[136:139], v[208:211]
ds_read_b128 a[116:119], v3 offset:45056
v_mfma_f32_16x16x32_bf16 v[208:211], a[36:39], a[140:143], v[208:211]
v_mfma_f32_16x16x32_bf16 v[212:215], a[40:43], a[136:139], v[212:215]
ds_read_b128 a[120:123], v2 offset:47104
v_mfma_f32_16x16x32_bf16 v[212:215], a[44:47], a[140:143], v[212:215]
v_mfma_f32_16x16x32_bf16 v[216:219], a[48:51], a[136:139], v[216:219]
v_mfma_f32_16x16x32_bf16 v[216:219], a[52:55], a[140:143], v[216:219]
v_mfma_f32_16x16x32_bf16 v[220:223], a[56:59], a[136:139], v[220:223]
ds_read_b128 a[124:127], v3 offset:47104
v_mfma_f32_16x16x32_bf16 v[220:223], a[60:63], a[140:143], v[220:223]
s_waitcnt lgkmcnt(3)
v_mfma_f32_16x16x32_bf16 a[192:195], a[0:3], a[128:131], a[192:195]
ds_read_b64_tr_b16 a[136:137], v11 offset:0
v_mfma_f32_16x16x32_bf16 a[192:195], a[4:7], a[132:135], a[192:195]
v_mfma_f32_16x16x32_bf16 a[196:199], a[8:11], a[128:131], a[196:199]
ds_read_b64_tr_b16 a[138:139], v11 offset:2048
v_mfma_f32_16x16x32_bf16 a[196:199], a[12:15], a[132:135], a[196:199]
v_mfma_f32_16x16x32_bf16 a[200:203], a[16:19], a[128:131], a[200:203]
ds_read_b64_tr_b16 a[140:141], v11 offset:16384
v_mfma_f32_16x16x32_bf16 a[200:203], a[20:23], a[132:135], a[200:203]
v_mfma_f32_16x16x32_bf16 a[204:207], a[24:27], a[128:131], a[204:207]
ds_read_b64_tr_b16 a[142:143], v11 offset:18432
v_mfma_f32_16x16x32_bf16 a[204:207], a[28:31], a[132:135], a[204:207]
buffer_store_dwordx4 a[188:191], v224, s[4:7], s56 offen sc1
v_mfma_f32_16x16x32_bf16 a[208:211], a[32:35], a[128:131], a[208:211]
s_add_u32 s56, s56, 33792
v_mfma_f32_16x16x32_bf16 a[208:211], a[36:39], a[132:135], a[208:211]
v_mfma_f32_16x16x32_bf16 a[212:215], a[40:43], a[128:131], a[212:215]
v_mfma_f32_16x16x32_bf16 a[212:215], a[44:47], a[132:135], a[212:215]
v_mfma_f32_16x16x32_bf16 a[216:219], a[48:51], a[128:131], a[216:219]
v_mfma_f32_16x16x32_bf16 a[216:219], a[52:55], a[132:135], a[216:219]
v_mfma_f32_16x16x32_bf16 a[220:223], a[56:59], a[128:131], a[220:223]
s_waitcnt vmcnt(4) lgkmcnt(0)
v_mfma_f32_16x16x32_bf16 a[220:223], a[60:63], a[132:135], a[220:223]
s_barrier
v_mfma_f32_16x16x32_bf16 a[224:227], a[0:3], a[136:139], a[224:227]
s_add_u32 m0, s29, 65536
ds_read_b64_tr_b16 a[128:129], v4 offset:32768
v_mfma_f32_16x16x32_bf16 a[224:227], a[4:7], a[140:143], a[224:227]
buffer_load_dwordx4 v16, s[12:15], s26 offen offset:0 lds
v_mfma_f32_16x16x32_bf16 a[228:231], a[8:11], a[136:139], a[228:231]
ds_read_b64_tr_b16 a[130:131], v4 offset:34816
v_cmp_gt_u32 vcc, 0x100, v245
v_mfma_f32_16x16x32_bf16 a[228:231], a[12:15], a[140:143], a[228:231]
v_mfma_f32_16x16x32_bf16 a[232:235], a[16:19], a[136:139], a[232:235]
ds_read_b64_tr_b16 a[132:133], v4 offset:49152
v_mfma_f32_16x16x32_bf16 a[232:235], a[20:23], a[140:143], a[232:235]
buffer_load_dwordx4 v17, s[12:15], s26 offen offset:1024 lds
v_mfma_f32_16x16x32_bf16 a[236:239], a[24:27], a[136:139], a[236:239]
ds_read_b64_tr_b16 a[134:135], v4 offset:51200
v_mfma_f32_16x16x32_bf16 a[236:239], a[28:31], a[140:143], a[236:239]
v_mfma_f32_16x16x32_bf16 a[240:243], a[32:35], a[136:139], a[240:243]
v_mfma_f32_16x16x32_bf16 a[240:243], a[36:39], a[140:143], a[240:243]
buffer_load_dwordx4 v18, s[12:15], s26 offen offset:2048 lds
v_mfma_f32_16x16x32_bf16 a[244:247], a[40:43], a[136:139], a[244:247]
v_mfma_f32_16x16x32_bf16 a[244:247], a[44:47], a[140:143], a[244:247]
v_mfma_f32_16x16x32_bf16 a[248:251], a[48:51], a[136:139], a[248:251]
v_mfma_f32_16x16x32_bf16 a[248:251], a[52:55], a[140:143], a[248:251]
buffer_load_dwordx4 v19, s[12:15], s26 offen offset:3072 lds
v_mfma_f32_16x16x32_bf16 a[252:255], a[56:59], a[136:139], a[252:255]
s_add_u32 s26, s26, 524288
v_mfma_f32_16x16x32_bf16 a[252:255], a[60:63], a[140:143], a[252:255]
s_waitcnt lgkmcnt(0)
s_mov_b32 s82, s59
s_cbranch_vccnz M_cntspinV
s_branch Lg_501
PAD_25:
s_cbranch_execz PAD_29
Lg_501t:
buffer_load_dword v230, v231, s[4:7], s52 offen sc1
v_mfma_f32_16x16x32_bf16 v[32:35], a[64:67], a[128:131], v[32:35]
s_add_u32 m0, s29, 81920
ds_read_b64_tr_b16 a[136:137], v5 offset:32768
v_mfma_f32_16x16x32_bf16 v[32:35], a[68:71], a[132:135], v[32:35]
buffer_load_dwordx4 v16, s[12:15], s27 offen offset:0 lds
v_mfma_f32_16x16x32_bf16 v[36:39], a[72:75], a[128:131], v[36:39]
s_and_b32 s44, s3, 1
ds_read_b64_tr_b16 a[138:139], v5 offset:34816
v_mfma_f32_16x16x32_bf16 v[36:39], a[76:79], a[132:135], v[36:39]
s_lshl_b32 s44, s44, 8
v_mfma_f32_16x16x32_bf16 v[40:43], a[80:83], a[128:131], v[40:43]
s_lshl_b32 s45, s3, 7
ds_read_b64_tr_b16 a[140:141], v5 offset:49152
v_mfma_f32_16x16x32_bf16 v[40:43], a[84:87], a[132:135], v[40:43]
s_xor_b32 s44, s44, s45
buffer_load_dwordx4 v17, s[12:15], s27 offen offset:1024 lds
v_mfma_f32_16x16x32_bf16 v[44:47], a[88:91], a[128:131], v[44:47]
s_xor_b32 s44, s44, 196608
ds_read_b64_tr_b16 a[142:143], v5 offset:51200
v_mfma_f32_16x16x32_bf16 v[44:47], a[92:95], a[132:135], v[44:47]
v_mfma_f32_16x16x32_bf16 v[48:51], a[96:99], a[128:131], v[48:51]
ds_read_b128 a[0:3], v2 offset:0
v_mfma_f32_16x16x32_bf16 v[48:51], a[100:103], a[132:135], v[48:51]
buffer_load_dwordx4 v18, s[12:15], s27 offen offset:2048 lds
v_mfma_f32_16x16x32_bf16 v[52:55], a[104:107], a[128:131], v[52:55]
ds_read_b128 a[4:7], v3 offset:0
v_mfma_f32_16x16x32_bf16 v[52:55], a[108:111], a[132:135], v[52:55]
PAD_26:
s_cbranch_execz PAD_30
v_mfma_f32_16x16x32_bf16 v[56:59], a[112:115], a[128:131], v[56:59]
v_mfma_f32_16x16x32_bf16 v[56:59], a[116:119], a[132:135], v[56:59]
buffer_load_dwordx4 v19, s[12:15], s27 offen offset:3072 lds
v_mfma_f32_16x16x32_bf16 v[60:63], a[120:123], a[128:131], v[60:63]
s_add_u32 s27, s27, 524288
ds_read_b128 a[8:11], v2 offset:2048
v_mfma_f32_16x16x32_bf16 v[60:63], a[124:127], a[132:135], v[60:63]
s_waitcnt lgkmcnt(3)
v_mfma_f32_16x16x32_bf16 v[64:67], a[64:67], a[136:139], v[64:67]
s_add_u32 m0, s28, 32768
ds_read_b64_tr_b16 a[128:129], v6 offset:32768
v_mfma_f32_16x16x32_bf16 v[64:67], a[68:71], a[140:143], v[64:67]
buffer_load_dwordx4 v12, s[8:11], s24 offen offset:0 lds
v_mfma_f32_16x16x32_bf16 v[68:71], a[72:75], a[136:139], v[68:71]
ds_read_b64_tr_b16 a[130:131], v6 offset:34816
v_mfma_f32_16x16x32_bf16 v[68:71], a[76:79], a[140:143], v[68:71]
v_mfma_f32_16x16x32_bf16 v[72:75], a[80:83], a[136:139], v[72:75]
s_mov_b64 s[56:57], s[72:73]
ds_read_b64_tr_b16 a[132:133], v6 offset:49152
v_mfma_f32_16x16x32_bf16 v[72:75], a[84:87], a[140:143], v[72:75]
s_mov_b32 s58, 1835008
buffer_load_dwordx4 v13, s[8:11], s24 offen offset:1024 lds
v_mfma_f32_16x16x32_bf16 v[76:79], a[88:91], a[136:139], v[76:79]
s_mov_b32 s59, 0x20000
ds_read_b64_tr_b16 a[134:135], v6 offset:51200
v_mfma_f32_16x16x32_bf16 v[76:79], a[92:95], a[140:143], v[76:79]
v_mfma_f32_16x16x32_bf16 v[80:83], a[96:99], a[136:139], v[80:83]
ds_read_b128 a[12:15], v3 offset:2048
v_mfma_f32_16x16x32_bf16 v[80:83], a[100:103], a[140:143], v[80:83]
buffer_load_dwordx4 v14, s[8:11], s24 offen offset:2048 lds
v_mfma_f32_16x16x32_bf16 v[84:87], a[104:107], a[136:139], v[84:87]
v_mfma_f32_16x16x32_bf16 v[84:87], a[108:111], a[140:143], v[84:87]
v_mfma_f32_16x16x32_bf16 v[88:91], a[112:115], a[136:139], v[88:91]
ds_read_b128 a[16:19], v2 offset:4096
v_mfma_f32_16x16x32_bf16 v[88:91], a[116:119], a[140:143], v[88:91]
buffer_load_dwordx4 v15, s[8:11], s24 offen offset:3072 lds
v_mfma_f32_16x16x32_bf16 v[92:95], a[120:123], a[136:139], v[92:95]
s_add_u32 s24, s24, 128
ds_read_b128 a[20:23], v3 offset:4096
v_mfma_f32_16x16x32_bf16 v[92:95], a[124:127], a[140:143], v[92:95]
s_waitcnt lgkmcnt(3)
v_mfma_f32_16x16x32_bf16 v[96:99], a[64:67], a[128:131], v[96:99]
s_add_u32 m0, s28, 36864
ds_read_b64_tr_b16 a[136:137], v7 offset:32768
v_mfma_f32_16x16x32_bf16 v[96:99], a[68:71], a[132:135], v[96:99]
buffer_load_dwordx4 v12, s[8:11], s25 offen offset:0 lds
v_mfma_f32_16x16x32_bf16 v[100:103], a[72:75], a[128:131], v[100:103]
ds_read_b64_tr_b16 a[138:139], v7 offset:34816
v_mfma_f32_16x16x32_bf16 v[100:103], a[76:79], a[132:135], v[100:103]
v_mfma_f32_16x16x32_bf16 v[104:107], a[80:83], a[128:131], v[104:107]
ds_read_b64_tr_b16 a[140:141], v7 offset:49152
v_mfma_f32_16x16x32_bf16 v[104:107], a[84:87], a[132:135], v[104:107]
buffer_load_dwordx4 v13, s[8:11], s25 offen offset:1024 lds
v_mfma_f32_16x16x32_bf16 v[108:111], a[88:91], a[128:131], v[108:111]
ds_read_b64_tr_b16 a[142:143], v7 offset:51200
v_mfma_f32_16x16x32_bf16 v[108:111], a[92:95], a[132:135], v[108:111]
v_mfma_f32_16x16x32_bf16 v[112:115], a[96:99], a[128:131], v[112:115]
v_mfma_f32_16x16x32_bf16 v[112:115], a[100:103], a[132:135], v[112:115]
buffer_load_dwordx4 v14, s[8:11], s25 offen offset:2048 lds
v_mfma_f32_16x16x32_bf16 v[116:119], a[104:107], a[128:131], v[116:119]
ds_read_b128 a[24:27], v2 offset:6144
v_mfma_f32_16x16x32_bf16 v[116:119], a[108:111], a[132:135], v[116:119]
v_mfma_f32_16x16x32_bf16 v[120:123], a[112:115], a[128:131], v[120:123]
ds_read_b128 a[28:31], v3 offset:6144
v_mfma_f32_16x16x32_bf16 v[120:123], a[116:119], a[132:135], v[120:123]
buffer_load_dwordx4 v15, s[8:11], s25 offen offset:3072 lds
v_mfma_f32_16x16x32_bf16 v[124:127], a[120:123], a[128:131], v[124:127]
s_add_u32 s25, s25, 128
s_waitcnt vmcnt(12)
v_mfma_f32_16x16x32_bf16 v[124:127], a[124:127], a[132:135], v[124:127]
s_waitcnt lgkmcnt(2)
v_cmp_gt_u32 vcc, 1, v230
v_mfma_f32_16x16x32_bf16 v[128:131], a[64:67], a[136:139], v[128:131]
s_cbranch_vccnz M_ppspinV
M_ppokV:
ds_read_b64_tr_b16 a[128:129], v8 offset:32768
v_mfma_f32_16x16x32_bf16 v[128:131], a[68:71], a[140:143], v[128:131]
buffer_load_dword v230, v229, s[4:7], s53 offen sc1
v_mfma_f32_16x16x32_bf16 v[132:135], a[72:75], a[136:139], v[132:135]
s_mov_b64 s[8:9], s[76:77]
ds_read_b64_tr_b16 a[130:131], v8 offset:34816
v_mfma_f32_16x16x32_bf16 v[132:135], a[76:79], a[140:143], v[132:135]
s_mov_b32 s10, 1835008
buffer_load_dword v230, v229, s[4:7], s48 offen sc1
v_mfma_f32_16x16x32_bf16 v[136:139], a[80:83], a[136:139], v[136:139]
s_lshl_b32 s24, s37, 2
ds_read_b64_tr_b16 a[132:133], v8 offset:49152
v_mfma_f32_16x16x32_bf16 v[136:139], a[84:87], a[140:143], v[136:139]
s_add_u32 s24, s24, s3
buffer_load_dword v230, v229, s[56:59], s49 offen
v_mfma_f32_16x16x32_bf16 v[140:143], a[88:91], a[136:139], v[140:143]
s_mul_i32 s24, s24, 28672
ds_read_b64_tr_b16 a[134:135], v8 offset:51200
v_mfma_f32_16x16x32_bf16 v[140:143], a[92:95], a[140:143], v[140:143]
s_mov_b32 s28, s29
buffer_load_dword v21, v20, s[16:19], s43 offen
v_mfma_f32_16x16x32_bf16 v[144:147], a[96:99], a[136:139], v[144:147]
ds_read_b128 a[32:35], v2 offset:8192
v_mfma_f32_16x16x32_bf16 v[144:147], a[100:103], a[140:143], v[144:147]
v_mfma_f32_16x16x32_bf16 v[148:151], a[104:107], a[136:139], v[148:151]
v_mfma_f32_16x16x32_bf16 v[148:151], a[108:111], a[140:143], v[148:151]
v_mfma_f32_16x16x32_bf16 v[152:155], a[112:115], a[136:139], v[152:155]
ds_read_b128 a[36:39], v3 offset:8192
v_lshrrev_b32 v28, 7, v1
v_mfma_f32_16x16x32_bf16 v[152:155], a[116:119], a[140:143], v[152:155]
v_lshrrev_b32 v29, 1, v28
v_lshlrev_b32 v29, 4, v29
v_mfma_f32_16x16x32_bf16 v[156:159], a[120:123], a[136:139], v[156:159]
ds_read_b128 a[40:43], v2 offset:10240
v_and_b32 v30, 0x70, v1
v_mfma_f32_16x16x32_bf16 v[156:159], a[124:127], a[140:143], v[156:159]
s_waitcnt lgkmcnt(3)
v_xor_b32 v29, v29, v30
v_mul_u32_u24 v28, 896, v28
v_mfma_f32_16x16x32_bf16 v[160:163], a[64:67], a[128:131], v[160:163]
ds_read_b64_tr_b16 a[136:137], v9 offset:32768
v_add_u32 v12, v28, v29
v_mfma_f32_16x16x32_bf16 v[160:163], a[68:71], a[132:135], v[160:163]
v_xor_b32 v29, 64, v29
v_add_u32 v28, v28, v29
v_mfma_f32_16x16x32_bf16 v[164:167], a[72:75], a[128:131], v[164:167]
ds_read_b64_tr_b16 a[138:139], v9 offset:34816
v_add_u32 v13, 6144, v28
v_mfma_f32_16x16x32_bf16 v[164:167], a[76:79], a[132:135], v[164:167]
v_add_u32 v14, 12288, v12
v_add_u32 v15, 18432, v28
v_mfma_f32_16x16x32_bf16 v[168:171], a[80:83], a[128:131], v[168:171]
ds_read_b64_tr_b16 a[140:141], v9 offset:49152
v_xor_b32 v22, s44, v4
v_mfma_f32_16x16x32_bf16 v[168:171], a[84:87], a[132:135], v[168:171]
v_xor_b32 v23, 32, v22
v_xor_b32 v24, 64, v22
v_mfma_f32_16x16x32_bf16 v[172:175], a[88:91], a[128:131], v[172:175]
ds_read_b64_tr_b16 a[142:143], v9 offset:51200
v_xor_b32 v25, 96, v22
v_mfma_f32_16x16x32_bf16 v[172:175], a[92:95], a[132:135], v[172:175]
v_mfma_f32_16x16x32_bf16 v[176:179], a[96:99], a[128:131], v[176:179]
v_mfma_f32_16x16x32_bf16 v[176:179], a[100:103], a[132:135], v[176:179]
v_mfma_f32_16x16x32_bf16 v[180:183], a[104:107], a[128:131], v[180:183]
ds_read_b128 a[44:47], v3 offset:10240
v_mfma_f32_16x16x32_bf16 v[180:183], a[108:111], a[132:135], v[180:183]
v_mfma_f32_16x16x32_bf16 v[184:187], a[112:115], a[128:131], v[184:187]
ds_read_b128 a[48:51], v2 offset:12288
v_mfma_f32_16x16x32_bf16 v[184:187], a[116:119], a[132:135], v[184:187]
v_mfma_f32_16x16x32_bf16 v[188:191], a[120:123], a[128:131], v[188:191]
v_mfma_f32_16x16x32_bf16 v[188:191], a[124:127], a[132:135], v[188:191]
s_waitcnt lgkmcnt(2)
v_mfma_f32_16x16x32_bf16 v[192:195], a[64:67], a[136:139], v[192:195]
ds_read_b64_tr_b16 a[128:129], v10 offset:32768
v_mfma_f32_16x16x32_bf16 v[192:195], a[68:71], a[140:143], v[192:195]
v_mfma_f32_16x16x32_bf16 v[196:199], a[72:75], a[136:139], v[196:199]
ds_read_b64_tr_b16 a[130:131], v10 offset:34816
v_mfma_f32_16x16x32_bf16 v[196:199], a[76:79], a[140:143], v[196:199]
v_mfma_f32_16x16x32_bf16 v[200:203], a[80:83], a[136:139], v[200:203]
ds_read_b64_tr_b16 a[132:133], v10 offset:49152
v_mfma_f32_16x16x32_bf16 v[200:203], a[84:87], a[140:143], v[200:203]
v_mfma_f32_16x16x32_bf16 v[204:207], a[88:91], a[136:139], v[204:207]
ds_read_b64_tr_b16 a[134:135], v10 offset:51200
v_mfma_f32_16x16x32_bf16 v[204:207], a[92:95], a[140:143], v[204:207]
v_mfma_f32_16x16x32_bf16 v[208:211], a[96:99], a[136:139], v[208:211]
ds_read_b128 a[52:55], v3 offset:12288
v_mfma_f32_16x16x32_bf16 v[208:211], a[100:103], a[140:143], v[208:211]
v_mfma_f32_16x16x32_bf16 v[212:215], a[104:107], a[136:139], v[212:215]
ds_read_b128 a[56:59], v2 offset:14336
v_mfma_f32_16x16x32_bf16 v[212:215], a[108:111], a[140:143], v[212:215]
v_mfma_f32_16x16x32_bf16 v[216:219], a[112:115], a[136:139], v[216:219]
v_mfma_f32_16x16x32_bf16 v[216:219], a[116:119], a[140:143], v[216:219]
v_mfma_f32_16x16x32_bf16 v[220:223], a[120:123], a[136:139], v[220:223]
ds_read_b128 a[60:63], v3 offset:14336
v_mfma_f32_16x16x32_bf16 v[220:223], a[124:127], a[140:143], v[220:223]
s_waitcnt lgkmcnt(3)
v_mfma_f32_16x16x32_bf16 a[192:195], a[64:67], a[128:131], a[192:195]
ds_read_b64_tr_b16 a[136:137], v11 offset:32768
v_mfma_f32_16x16x32_bf16 a[192:195], a[68:71], a[132:135], a[192:195]
v_mfma_f32_16x16x32_bf16 a[196:199], a[72:75], a[128:131], a[196:199]
ds_read_b64_tr_b16 a[138:139], v11 offset:34816
v_mfma_f32_16x16x32_bf16 a[196:199], a[76:79], a[132:135], a[196:199]
v_mfma_f32_16x16x32_bf16 a[200:203], a[80:83], a[128:131], a[200:203]
ds_read_b64_tr_b16 a[140:141], v11 offset:49152
v_mfma_f32_16x16x32_bf16 a[200:203], a[84:87], a[132:135], a[200:203]
v_mfma_f32_16x16x32_bf16 a[204:207], a[88:91], a[128:131], a[204:207]
ds_read_b64_tr_b16 a[142:143], v11 offset:51200
v_mfma_f32_16x16x32_bf16 a[204:207], a[92:95], a[132:135], a[204:207]
v_mfma_f32_16x16x32_bf16 a[208:211], a[96:99], a[128:131], a[208:211]
v_mfma_f32_16x16x32_bf16 a[208:211], a[100:103], a[132:135], a[208:211]
v_mfma_f32_16x16x32_bf16 a[212:215], a[104:107], a[128:131], a[212:215]
v_mfma_f32_16x16x32_bf16 a[212:215], a[108:111], a[132:135], a[212:215]
v_mfma_f32_16x16x32_bf16 a[216:219], a[112:115], a[128:131], a[216:219]
v_mfma_f32_16x16x32_bf16 a[216:219], a[116:119], a[132:135], a[216:219]
v_mfma_f32_16x16x32_bf16 a[220:223], a[120:123], a[128:131], a[220:223]
s_waitcnt vmcnt(4) lgkmcnt(0)
v_mfma_f32_16x16x32_bf16 a[220:223], a[124:127], a[132:135], a[220:223]
s_barrier
v_mfma_f32_16x16x32_bf16 a[224:227], a[64:67], a[136:139], a[224:227]
s_add_u32 m0, s29, 98304
ds_read_b64_tr_b16 a[128:129], v4 offset:0
v_mfma_f32_16x16x32_bf16 a[224:227], a[68:71], a[140:143], a[224:227]
buffer_load_dwordx4 v16, s[12:15], s26 offen offset:0 lds
v_mfma_f32_16x16x32_bf16 a[228:231], a[72:75], a[136:139], a[228:231]
ds_read_b64_tr_b16 a[130:131], v4 offset:2048
v_mfma_f32_16x16x32_bf16 a[228:231], a[76:79], a[140:143], a[228:231]
v_mfma_f32_16x16x32_bf16 a[232:235], a[80:83], a[136:139], a[232:235]
ds_read_b64_tr_b16 a[132:133], v4 offset:16384
v_mfma_f32_16x16x32_bf16 a[232:235], a[84:87], a[140:143], a[232:235]
buffer_load_dwordx4 v17, s[12:15], s26 offen offset:1024 lds
v_mfma_f32_16x16x32_bf16 a[236:239], a[88:91], a[136:139], a[236:239]
ds_read_b64_tr_b16 a[134:135], v4 offset:18432
v_mfma_f32_16x16x32_bf16 a[236:239], a[92:95], a[140:143], a[236:239]
v_mfma_f32_16x16x32_bf16 a[240:243], a[96:99], a[136:139], a[240:243]
v_mfma_f32_16x16x32_bf16 a[240:243], a[100:103], a[140:143], a[240:243]
buffer_load_dwordx4 v18, s[12:15], s26 offen offset:2048 lds
v_mfma_f32_16x16x32_bf16 a[244:247], a[104:107], a[136:139], a[244:247]
v_mfma_f32_16x16x32_bf16 a[244:247], a[108:111], a[140:143], a[244:247]
v_mfma_f32_16x16x32_bf16 a[248:251], a[112:115], a[136:139], a[248:251]
v_mfma_f32_16x16x32_bf16 a[248:251], a[116:119], a[140:143], a[248:251]
buffer_load_dwordx4 v19, s[12:15], s26 offen offset:3072 lds
v_mfma_f32_16x16x32_bf16 a[252:255], a[120:123], a[136:139], a[252:255]
s_add_u32 s26, s26, 524288
v_mfma_f32_16x16x32_bf16 a[252:255], a[124:127], a[140:143], a[252:255]
s_waitcnt lgkmcnt(0)
v_mfma_f32_16x16x32_bf16 v[32:35], a[0:3], a[128:131], v[32:35]
s_add_u32 m0, s29, 114688
ds_read_b64_tr_b16 a[136:137], v5 offset:0
v_mfma_f32_16x16x32_bf16 v[32:35], a[4:7], a[132:135], v[32:35]
buffer_load_dwordx4 v16, s[12:15], s27 offen offset:0 lds
v_mfma_f32_16x16x32_bf16 v[36:39], a[8:11], a[128:131], v[36:39]
ds_read_b64_tr_b16 a[138:139], v5 offset:2048
v_mfma_f32_16x16x32_bf16 v[36:39], a[12:15], a[132:135], v[36:39]
v_mfma_f32_16x16x32_bf16 v[40:43], a[16:19], a[128:131], v[40:43]
ds_read_b64_tr_b16 a[140:141], v5 offset:16384
v_mfma_f32_16x16x32_bf16 v[40:43], a[20:23], a[132:135], v[40:43]
buffer_load_dwordx4 v17, s[12:15], s27 offen offset:1024 lds
v_mfma_f32_16x16x32_bf16 v[44:47], a[24:27], a[128:131], v[44:47]
ds_read_b64_tr_b16 a[142:143], v5 offset:18432
v_mfma_f32_16x16x32_bf16 v[44:47], a[28:31], a[132:135], v[44:47]
v_mfma_f32_16x16x32_bf16 v[48:51], a[32:35], a[128:131], v[48:51]
ds_read_b128 a[64:67], v2 offset:32768
v_mfma_f32_16x16x32_bf16 v[48:51], a[36:39], a[132:135], v[48:51]
buffer_load_dwordx4 v18, s[12:15], s27 offen offset:2048 lds
v_mfma_f32_16x16x32_bf16 v[52:55], a[40:43], a[128:131], v[52:55]
ds_read_b128 a[68:71], v3 offset:32768
v_mfma_f32_16x16x32_bf16 v[52:55], a[44:47], a[132:135], v[52:55]
v_mfma_f32_16x16x32_bf16 v[56:59], a[48:51], a[128:131], v[56:59]
v_mfma_f32_16x16x32_bf16 v[56:59], a[52:55], a[132:135], v[56:59]
buffer_load_dwordx4 v19, s[12:15], s27 offen offset:3072 lds
v_mfma_f32_16x16x32_bf16 v[60:63], a[56:59], a[128:131], v[60:63]
s_add_u32 s27, s27, 524288
ds_read_b128 a[72:75], v2 offset:34816
v_mfma_f32_16x16x32_bf16 v[60:63], a[60:63], a[132:135], v[60:63]
s_waitcnt lgkmcnt(3)
v_mfma_f32_16x16x32_bf16 v[64:67], a[0:3], a[136:139], v[64:67]
s_add_u32 m0, s28, 0
ds_read_b64_tr_b16 a[128:129], v6 offset:0
v_mfma_f32_16x16x32_bf16 v[64:67], a[4:7], a[140:143], v[64:67]
buffer_load_dwordx4 v12, s[8:11], s24 offen offset:0 lds
v_mfma_f32_16x16x32_bf16 v[68:71], a[8:11], a[136:139], v[68:71]
ds_read_b64_tr_b16 a[130:131], v6 offset:2048
v_mfma_f32_16x16x32_bf16 v[68:71], a[12:15], a[140:143], v[68:71]
v_mfma_f32_16x16x32_bf16 v[72:75], a[16:19], a[136:139], v[72:75]
ds_read_b64_tr_b16 a[132:133], v6 offset:16384
v_mfma_f32_16x16x32_bf16 v[72:75], a[20:23], a[140:143], v[72:75]
buffer_load_dwordx4 v13, s[8:11], s24 offen offset:1024 lds
v_mfma_f32_16x16x32_bf16 v[76:79], a[24:27], a[136:139], v[76:79]
ds_read_b64_tr_b16 a[134:135], v6 offset:18432
v_mfma_f32_16x16x32_bf16 v[76:79], a[28:31], a[140:143], v[76:79]
v_mfma_f32_16x16x32_bf16 v[80:83], a[32:35], a[136:139], v[80:83]
ds_read_b128 a[76:79], v3 offset:34816
v_mfma_f32_16x16x32_bf16 v[80:83], a[36:39], a[140:143], v[80:83]
buffer_load_dwordx4 v14, s[8:11], s24 offen offset:2048 lds
v_mfma_f32_16x16x32_bf16 v[84:87], a[40:43], a[136:139], v[84:87]
v_mfma_f32_16x16x32_bf16 v[84:87], a[44:47], a[140:143], v[84:87]
v_mfma_f32_16x16x32_bf16 v[88:91], a[48:51], a[136:139], v[88:91]
ds_read_b128 a[80:83], v2 offset:36864
v_mfma_f32_16x16x32_bf16 v[88:91], a[52:55], a[140:143], v[88:91]
buffer_load_dwordx4 v15, s[8:11], s24 offen offset:3072 lds
v_mfma_f32_16x16x32_bf16 v[92:95], a[56:59], a[136:139], v[92:95]
s_add_u32 s24, s24, 128
ds_read_b128 a[84:87], v3 offset:36864
v_mfma_f32_16x16x32_bf16 v[92:95], a[60:63], a[140:143], v[92:95]
s_waitcnt lgkmcnt(3)
s_mov_b64 s[12:13], s[80:81]
v_mfma_f32_16x16x32_bf16 v[96:99], a[0:3], a[128:131], v[96:99]
s_mov_b32 s14, 3670016
s_add_u32 m0, s28, 16384
ds_read_b64_tr_b16 a[136:137], v7 offset:0
v_mfma_f32_16x16x32_bf16 v[96:99], a[4:7], a[132:135], v[96:99]
buffer_load_dwordx4 v12, s[8:11], s24 offen offset:0 lds
v_mfma_f32_16x16x32_bf16 v[100:103], a[8:11], a[128:131], v[100:103]
ds_read_b64_tr_b16 a[138:139], v7 offset:2048
v_mfma_f32_16x16x32_bf16 v[100:103], a[12:15], a[132:135], v[100:103]
v_mfma_f32_16x16x32_bf16 v[104:107], a[16:19], a[128:131], v[104:107]
ds_read_b64_tr_b16 a[140:141], v7 offset:16384
v_mfma_f32_16x16x32_bf16 v[104:107], a[20:23], a[132:135], v[104:107]
buffer_load_dwordx4 v13, s[8:11], s24 offen offset:1024 lds
v_mfma_f32_16x16x32_bf16 v[108:111], a[24:27], a[128:131], v[108:111]
ds_read_b64_tr_b16 a[142:143], v7 offset:18432
v_mfma_f32_16x16x32_bf16 v[108:111], a[28:31], a[132:135], v[108:111]
v_mfma_f32_16x16x32_bf16 v[112:115], a[32:35], a[128:131], v[112:115]
v_mfma_f32_16x16x32_bf16 v[112:115], a[36:39], a[132:135], v[112:115]
buffer_load_dwordx4 v14, s[8:11], s24 offen offset:2048 lds
v_mfma_f32_16x16x32_bf16 v[116:119], a[40:43], a[128:131], v[116:119]
ds_read_b128 a[88:91], v2 offset:38912
v_mfma_f32_16x16x32_bf16 v[116:119], a[44:47], a[132:135], v[116:119]
v_mfma_f32_16x16x32_bf16 v[120:123], a[48:51], a[128:131], v[120:123]
ds_read_b128 a[92:95], v3 offset:38912
v_mfma_f32_16x16x32_bf16 v[120:123], a[52:55], a[132:135], v[120:123]
buffer_load_dwordx4 v15, s[8:11], s24 offen offset:3072 lds
v_mfma_f32_16x16x32_bf16 v[124:127], a[56:59], a[128:131], v[124:127]
s_add_u32 s24, s24, 128
v_mfma_f32_16x16x32_bf16 v[124:127], a[60:63], a[132:135], v[124:127]
s_waitcnt lgkmcnt(2)
s_sub_u32 s26, s26, 8388608
v_mfma_f32_16x16x32_bf16 v[128:131], a[0:3], a[136:139], v[128:131]
s_sub_u32 s27, s27, 8388608
s_add_u32 m0, s29, 131072
ds_read_b64_tr_b16 a[128:129], v8 offset:0
v_mfma_f32_16x16x32_bf16 v[128:131], a[4:7], a[140:143], v[128:131]
buffer_load_dwordx4 v16, s[12:15], s26 offen offset:0 lds
v_mfma_f32_16x16x32_bf16 v[132:135], a[8:11], a[136:139], v[132:135]
ds_read_b64_tr_b16 a[130:131], v8 offset:2048
v_mfma_f32_16x16x32_bf16 v[132:135], a[12:15], a[140:143], v[132:135]
v_mfma_f32_16x16x32_bf16 v[136:139], a[16:19], a[136:139], v[136:139]
ds_read_b64_tr_b16 a[132:133], v8 offset:16384
v_mfma_f32_16x16x32_bf16 v[136:139], a[20:23], a[140:143], v[136:139]
buffer_load_dwordx4 v17, s[12:15], s26 offen offset:1024 lds
v_mfma_f32_16x16x32_bf16 v[140:143], a[24:27], a[136:139], v[140:143]
ds_read_b64_tr_b16 a[134:135], v8 offset:18432
v_mfma_f32_16x16x32_bf16 v[140:143], a[28:31], a[140:143], v[140:143]
v_mfma_f32_16x16x32_bf16 v[144:147], a[32:35], a[136:139], v[144:147]
ds_read_b128 a[96:99], v2 offset:40960
v_mfma_f32_16x16x32_bf16 v[144:147], a[36:39], a[140:143], v[144:147]
buffer_load_dwordx4 v18, s[12:15], s26 offen offset:2048 lds
v_mfma_f32_16x16x32_bf16 v[148:151], a[40:43], a[136:139], v[148:151]
v_mfma_f32_16x16x32_bf16 v[148:151], a[44:47], a[140:143], v[148:151]
v_mfma_f32_16x16x32_bf16 v[152:155], a[48:51], a[136:139], v[152:155]
ds_read_b128 a[100:103], v3 offset:40960
v_mfma_f32_16x16x32_bf16 v[152:155], a[52:55], a[140:143], v[152:155]
buffer_load_dwordx4 v19, s[12:15], s26 offen offset:3072 lds
v_mfma_f32_16x16x32_bf16 v[156:159], a[56:59], a[136:139], v[156:159]
s_add_u32 s26, s26, 524288
ds_read_b128 a[104:107], v2 offset:43008
v_mfma_f32_16x16x32_bf16 v[156:159], a[60:63], a[140:143], v[156:159]
s_waitcnt lgkmcnt(3)
v_mfma_f32_16x16x32_bf16 v[160:163], a[0:3], a[128:131], v[160:163]
s_add_u32 m0, s29, 147456
ds_read_b64_tr_b16 a[136:137], v9 offset:0
v_mfma_f32_16x16x32_bf16 v[160:163], a[4:7], a[132:135], v[160:163]
buffer_load_dwordx4 v16, s[12:15], s27 offen offset:0 lds
v_mfma_f32_16x16x32_bf16 v[164:167], a[8:11], a[128:131], v[164:167]
ds_read_b64_tr_b16 a[138:139], v9 offset:2048
v_mfma_f32_16x16x32_bf16 v[164:167], a[12:15], a[132:135], v[164:167]
v_mfma_f32_16x16x32_bf16 v[168:171], a[16:19], a[128:131], v[168:171]
ds_read_b64_tr_b16 a[140:141], v9 offset:16384
v_mfma_f32_16x16x32_bf16 v[168:171], a[20:23], a[132:135], v[168:171]
buffer_load_dwordx4 v17, s[12:15], s27 offen offset:1024 lds
v_mfma_f32_16x16x32_bf16 v[172:175], a[24:27], a[128:131], v[172:175]
ds_read_b64_tr_b16 a[142:143], v9 offset:18432
v_mfma_f32_16x16x32_bf16 v[172:175], a[28:31], a[132:135], v[172:175]
v_mfma_f32_16x16x32_bf16 v[176:179], a[32:35], a[128:131], v[176:179]
v_mfma_f32_16x16x32_bf16 v[176:179], a[36:39], a[132:135], v[176:179]
buffer_load_dwordx4 v18, s[12:15], s27 offen offset:2048 lds
v_mfma_f32_16x16x32_bf16 v[180:183], a[40:43], a[128:131], v[180:183]
ds_read_b128 a[108:111], v3 offset:43008
v_mfma_f32_16x16x32_bf16 v[180:183], a[44:47], a[132:135], v[180:183]
v_mfma_f32_16x16x32_bf16 v[184:187], a[48:51], a[128:131], v[184:187]
ds_read_b128 a[112:115], v2 offset:45056
v_mfma_f32_16x16x32_bf16 v[184:187], a[52:55], a[132:135], v[184:187]
buffer_load_dwordx4 v19, s[12:15], s27 offen offset:3072 lds
v_mfma_f32_16x16x32_bf16 v[188:191], a[56:59], a[128:131], v[188:191]
s_add_u32 s27, s27, 524288
v_mfma_f32_16x16x32_bf16 v[188:191], a[60:63], a[132:135], v[188:191]
s_waitcnt lgkmcnt(2)
v_mfma_f32_16x16x32_bf16 v[192:195], a[0:3], a[136:139], v[192:195]
ds_read_b64_tr_b16 a[128:129], v10 offset:0
v_mfma_f32_16x16x32_bf16 v[192:195], a[4:7], a[140:143], v[192:195]
v_mfma_f32_16x16x32_bf16 v[196:199], a[8:11], a[136:139], v[196:199]
ds_read_b64_tr_b16 a[130:131], v10 offset:2048
v_mfma_f32_16x16x32_bf16 v[196:199], a[12:15], a[140:143], v[196:199]
v_mfma_f32_16x16x32_bf16 v[200:203], a[16:19], a[136:139], v[200:203]
ds_read_b64_tr_b16 a[132:133], v10 offset:16384
v_mfma_f32_16x16x32_bf16 v[200:203], a[20:23], a[140:143], v[200:203]
v_mfma_f32_16x16x32_bf16 v[204:207], a[24:27], a[136:139], v[204:207]
ds_read_b64_tr_b16 a[134:135], v10 offset:18432
v_mfma_f32_16x16x32_bf16 v[204:207], a[28:31], a[140:143], v[204:207]
v_mfma_f32_16x16x32_bf16 v[208:211], a[32:35], a[136:139], v[208:211]
ds_read_b128 a[116:119], v3 offset:45056
v_mfma_f32_16x16x32_bf16 v[208:211], a[36:39], a[140:143], v[208:211]
v_mfma_f32_16x16x32_bf16 v[212:215], a[40:43], a[136:139], v[212:215]
ds_read_b128 a[120:123], v2 offset:47104
v_mfma_f32_16x16x32_bf16 v[212:215], a[44:47], a[140:143], v[212:215]
v_mfma_f32_16x16x32_bf16 v[216:219], a[48:51], a[136:139], v[216:219]
v_mfma_f32_16x16x32_bf16 v[216:219], a[52:55], a[140:143], v[216:219]
v_mfma_f32_16x16x32_bf16 v[220:223], a[56:59], a[136:139], v[220:223]
ds_read_b128 a[124:127], v3 offset:47104
v_mfma_f32_16x16x32_bf16 v[220:223], a[60:63], a[140:143], v[220:223]
s_waitcnt lgkmcnt(3)
v_mfma_f32_16x16x32_bf16 a[192:195], a[0:3], a[128:131], a[192:195]
ds_read_b64_tr_b16 a[136:137], v11 offset:0
v_mfma_f32_16x16x32_bf16 a[192:195], a[4:7], a[132:135], a[192:195]
v_mfma_f32_16x16x32_bf16 a[196:199], a[8:11], a[128:131], a[196:199]
ds_read_b64_tr_b16 a[138:139], v11 offset:2048
v_mfma_f32_16x16x32_bf16 a[196:199], a[12:15], a[132:135], a[196:199]
v_mfma_f32_16x16x32_bf16 a[200:203], a[16:19], a[128:131], a[200:203]
ds_read_b64_tr_b16 a[140:141], v11 offset:16384
v_mfma_f32_16x16x32_bf16 a[200:203], a[20:23], a[132:135], a[200:203]
v_mfma_f32_16x16x32_bf16 a[204:207], a[24:27], a[128:131], a[204:207]
ds_read_b64_tr_b16 a[142:143], v11 offset:18432
v_mfma_f32_16x16x32_bf16 a[204:207], a[28:31], a[132:135], a[204:207]
v_mfma_f32_16x16x32_bf16 a[208:211], a[32:35], a[128:131], a[208:211]
v_mfma_f32_16x16x32_bf16 a[208:211], a[36:39], a[132:135], a[208:211]
v_mfma_f32_16x16x32_bf16 a[212:215], a[40:43], a[128:131], a[212:215]
v_mfma_f32_16x16x32_bf16 a[212:215], a[44:47], a[132:135], a[212:215]
v_mfma_f32_16x16x32_bf16 a[216:219], a[48:51], a[128:131], a[216:219]
v_mfma_f32_16x16x32_bf16 a[216:219], a[52:55], a[132:135], a[216:219]
v_mfma_f32_16x16x32_bf16 a[220:223], a[56:59], a[128:131], a[220:223]
s_waitcnt vmcnt(12) lgkmcnt(0)
v_mfma_f32_16x16x32_bf16 a[220:223], a[60:63], a[132:135], a[220:223]
s_barrier
v_mfma_f32_16x16x32_bf16 a[224:227], a[0:3], a[136:139], a[224:227]
s_add_u32 m0, s28, 32768
ds_read_b64_tr_b16 a[128:129], v4 offset:32768
v_mfma_f32_16x16x32_bf16 a[224:227], a[4:7], a[140:143], a[224:227]
s_lshr_b32 s22, s3, 1
buffer_load_dwordx4 v12, s[8:11], s24 offen offset:0 lds
v_mfma_f32_16x16x32_bf16 a[228:231], a[8:11], a[136:139], a[228:231]
s_lshl_b32 s22, s22, 14
ds_read_b64_tr_b16 a[130:131], v4 offset:34816
v_subrev_u32 v2, s22, v2
v_mfma_f32_16x16x32_bf16 a[228:231], a[12:15], a[140:143], a[228:231]
v_subrev_u32 v3, s22, v3
v_mfma_f32_16x16x32_bf16 a[232:235], a[16:19], a[136:139], a[232:235]
ds_read_b64_tr_b16 a[132:133], v4 offset:49152
v_mfma_f32_16x16x32_bf16 a[232:235], a[20:23], a[140:143], a[232:235]
buffer_load_dwordx4 v13, s[8:11], s24 offen offset:1024 lds
v_mfma_f32_16x16x32_bf16 a[236:239], a[24:27], a[136:139], a[236:239]
ds_read_b64_tr_b16 a[134:135], v4 offset:51200
v_mfma_f32_16x16x32_bf16 a[236:239], a[28:31], a[140:143], a[236:239]
v_mfma_f32_16x16x32_bf16 a[240:243], a[32:35], a[136:139], a[240:243]
v_mfma_f32_16x16x32_bf16 a[240:243], a[36:39], a[140:143], a[240:243]
buffer_load_dwordx4 v14, s[8:11], s24 offen offset:2048 lds
v_mfma_f32_16x16x32_bf16 a[244:247], a[40:43], a[136:139], a[244:247]
v_mfma_f32_16x16x32_bf16 a[244:247], a[44:47], a[140:143], a[244:247]
v_mfma_f32_16x16x32_bf16 a[248:251], a[48:51], a[136:139], a[248:251]
v_mfma_f32_16x16x32_bf16 a[248:251], a[52:55], a[140:143], a[248:251]
buffer_load_dwordx4 v15, s[8:11], s24 offen offset:3072 lds
v_mfma_f32_16x16x32_bf16 a[252:255], a[56:59], a[136:139], a[252:255]
s_add_u32 s24, s24, 128
v_mfma_f32_16x16x32_bf16 a[252:255], a[60:63], a[140:143], a[252:255]
s_waitcnt lgkmcnt(0)
v_mfma_f32_16x16x32_bf16 v[32:35], a[64:67], a[128:131], v[32:35]
s_add_u32 m0, s29, 65536
ds_read_b64_tr_b16 a[136:137], v5 offset:32768
v_mfma_f32_16x16x32_bf16 v[32:35], a[68:71], a[132:135], v[32:35]
buffer_load_dwordx4 v16, s[12:15], s26 offen offset:0 lds
v_mfma_f32_16x16x32_bf16 v[36:39], a[72:75], a[128:131], v[36:39]
ds_read_b64_tr_b16 a[138:139], v5 offset:34816
v_mfma_f32_16x16x32_bf16 v[36:39], a[76:79], a[132:135], v[36:39]
v_mfma_f32_16x16x32_bf16 v[40:43], a[80:83], a[128:131], v[40:43]
ds_read_b64_tr_b16 a[140:141], v5 offset:49152
v_mfma_f32_16x16x32_bf16 v[40:43], a[84:87], a[132:135], v[40:43]
buffer_load_dwordx4 v17, s[12:15], s26 offen offset:1024 lds
v_mfma_f32_16x16x32_bf16 v[44:47], a[88:91], a[128:131], v[44:47]
ds_read_b64_tr_b16 a[142:143], v5 offset:51200
v_mfma_f32_16x16x32_bf16 v[44:47], a[92:95], a[132:135], v[44:47]
v_mfma_f32_16x16x32_bf16 v[48:51], a[96:99], a[128:131], v[48:51]
ds_read_b128 a[0:3], v2 offset:0
v_cvt_pk_bf16_f32 v32, v32, v33
v_mfma_f32_16x16x32_bf16 v[48:51], a[100:103], a[132:135], v[48:51]
buffer_load_dwordx4 v18, s[12:15], s26 offen offset:2048 lds
v_mfma_f32_16x16x32_bf16 v[52:55], a[104:107], a[128:131], v[52:55]
ds_read_b128 a[4:7], v3 offset:0
v_cvt_pk_bf16_f32 v33, v34, v35
v_mfma_f32_16x16x32_bf16 v[52:55], a[108:111], a[132:135], v[52:55]
v_cvt_pk_bf16_f32 v34, v36, v37
v_cvt_pk_bf16_f32 v35, v38, v39
v_mfma_f32_16x16x32_bf16 v[56:59], a[112:115], a[128:131], v[56:59]
v_cvt_pk_bf16_f32 v40, v40, v41
v_cvt_pk_bf16_f32 v41, v42, v43
v_mfma_f32_16x16x32_bf16 v[56:59], a[116:119], a[132:135], v[56:59]
buffer_load_dwordx4 v19, s[12:15], s26 offen offset:3072 lds
v_mfma_f32_16x16x32_bf16 v[60:63], a[120:123], a[128:131], v[60:63]
s_add_u32 s26, s26, 524288
ds_read_b128 a[8:11], v2 offset:2048
v_cvt_pk_bf16_f32 v42, v44, v45
v_mfma_f32_16x16x32_bf16 v[60:63], a[124:127], a[132:135], v[60:63]
s_waitcnt lgkmcnt(3)
v_cvt_pk_bf16_f32 v43, v46, v47
v_mfma_f32_16x16x32_bf16 v[64:67], a[64:67], a[136:139], v[64:67]
s_add_u32 m0, s29, 81920
ds_read_b64_tr_b16 a[128:129], v6 offset:32768
v_cvt_pk_bf16_f32 v48, v48, v49
v_mfma_f32_16x16x32_bf16 v[64:67], a[68:71], a[140:143], v[64:67]
buffer_load_dwordx4 v16, s[12:15], s27 offen offset:0 lds
v_mfma_f32_16x16x32_bf16 v[68:71], a[72:75], a[136:139], v[68:71]
ds_read_b64_tr_b16 a[130:131], v6 offset:34816
v_cvt_pk_bf16_f32 v49, v50, v51
v_mfma_f32_16x16x32_bf16 v[68:71], a[76:79], a[140:143], v[68:71]
v_cvt_pk_bf16_f32 v50, v52, v53
v_cvt_pk_bf16_f32 v51, v54, v55
v_mfma_f32_16x16x32_bf16 v[72:75], a[80:83], a[136:139], v[72:75]
ds_read_b64_tr_b16 a[132:133], v6 offset:49152
v_cvt_pk_bf16_f32 v56, v56, v57
v_mfma_f32_16x16x32_bf16 v[72:75], a[84:87], a[140:143], v[72:75]
buffer_load_dwordx4 v17, s[12:15], s27 offen offset:1024 lds
v_mfma_f32_16x16x32_bf16 v[76:79], a[88:91], a[136:139], v[76:79]
ds_read_b64_tr_b16 a[134:135], v6 offset:51200
v_cvt_pk_bf16_f32 v57, v58, v59
v_mfma_f32_16x16x32_bf16 v[76:79], a[92:95], a[140:143], v[76:79]
v_cvt_pk_bf16_f32 v58, v60, v61
v_cvt_pk_bf16_f32 v59, v62, v63
v_mfma_f32_16x16x32_bf16 v[80:83], a[96:99], a[136:139], v[80:83]
ds_read_b128 a[12:15], v3 offset:2048
v_cvt_pk_bf16_f32 v64, v64, v65
v_mfma_f32_16x16x32_bf16 v[80:83], a[100:103], a[140:143], v[80:83]
buffer_load_dwordx4 v18, s[12:15], s27 offen offset:2048 lds
v_mfma_f32_16x16x32_bf16 v[84:87], a[104:107], a[136:139], v[84:87]
v_cvt_pk_bf16_f32 v65, v66, v67
v_cvt_pk_bf16_f32 v66, v68, v69
v_mfma_f32_16x16x32_bf16 v[84:87], a[108:111], a[140:143], v[84:87]
v_cvt_pk_bf16_f32 v67, v70, v71
v_mfma_f32_16x16x32_bf16 v[88:91], a[112:115], a[136:139], v[88:91]
ds_read_b128 a[16:19], v2 offset:4096
v_cvt_pk_bf16_f32 v72, v72, v73
v_mfma_f32_16x16x32_bf16 v[88:91], a[116:119], a[140:143], v[88:91]
buffer_load_dwordx4 v19, s[12:15], s27 offen offset:3072 lds
v_mfma_f32_16x16x32_bf16 v[92:95], a[120:123], a[136:139], v[92:95]
s_add_u32 s27, s27, 524288
ds_read_b128 a[20:23], v3 offset:4096
v_cvt_pk_bf16_f32 v73, v74, v75
v_mfma_f32_16x16x32_bf16 v[92:95], a[124:127], a[140:143], v[92:95]
s_waitcnt lgkmcnt(3)
v_cvt_pk_bf16_f32 v74, v76, v77
v_cvt_pk_bf16_f32 v75, v78, v79
v_mfma_f32_16x16x32_bf16 v[96:99], a[64:67], a[128:131], v[96:99]
s_add_u32 m0, s28, 49152
ds_read_b64_tr_b16 a[136:137], v7 offset:32768
v_cvt_pk_bf16_f32 v80, v80, v81
v_mfma_f32_16x16x32_bf16 v[96:99], a[68:71], a[132:135], v[96:99]
PAD_27:
s_cbranch_execz PAD_31
buffer_load_dwordx4 v12, s[8:11], s24 offen offset:0 lds
v_mfma_f32_16x16x32_bf16 v[100:103], a[72:75], a[128:131], v[100:103]
ds_read_b64_tr_b16 a[138:139], v7 offset:34816
v_cvt_pk_bf16_f32 v81, v82, v83
v_mfma_f32_16x16x32_bf16 v[100:103], a[76:79], a[132:135], v[100:103]
v_cvt_pk_bf16_f32 v82, v84, v85
v_cvt_pk_bf16_f32 v83, v86, v87
v_mfma_f32_16x16x32_bf16 v[104:107], a[80:83], a[128:131], v[104:107]
ds_read_b64_tr_b16 a[140:141], v7 offset:49152
v_cvt_pk_bf16_f32 v88, v88, v89
v_mfma_f32_16x16x32_bf16 v[104:107], a[84:87], a[132:135], v[104:107]
buffer_load_dwordx4 v13, s[8:11], s24 offen offset:1024 lds
v_mfma_f32_16x16x32_bf16 v[108:111], a[88:91], a[128:131], v[108:111]
ds_read_b64_tr_b16 a[142:143], v7 offset:51200
v_cvt_pk_bf16_f32 v89, v90, v91
v_mfma_f32_16x16x32_bf16 v[108:111], a[92:95], a[132:135], v[108:111]
v_cvt_pk_bf16_f32 v90, v92, v93
v_cvt_pk_bf16_f32 v91, v94, v95
v_mfma_f32_16x16x32_bf16 v[112:115], a[96:99], a[128:131], v[112:115]
v_cvt_pk_bf16_f32 v96, v96, v97
v_cvt_pk_bf16_f32 v97, v98, v99
v_mfma_f32_16x16x32_bf16 v[112:115], a[100:103], a[132:135], v[112:115]
buffer_load_dwordx4 v14, s[8:11], s24 offen offset:2048 lds
v_mfma_f32_16x16x32_bf16 v[116:119], a[104:107], a[128:131], v[116:119]
ds_read_b128 a[24:27], v2 offset:6144
v_cvt_pk_bf16_f32 v98, v100, v101
v_mfma_f32_16x16x32_bf16 v[116:119], a[108:111], a[132:135], v[116:119]
buffer_store_dwordx4 v[32:35], v1, s[4:7], s31 offen sc1
v_mfma_f32_16x16x32_bf16 v[120:123], a[112:115], a[128:131], v[120:123]
s_add_u32 s31, s31, s32
ds_read_b128 a[28:31], v3 offset:6144
v_cvt_pk_bf16_f32 v99, v102, v103
v_mfma_f32_16x16x32_bf16 v[120:123], a[116:119], a[132:135], v[120:123]
buffer_load_dwordx4 v15, s[8:11], s24 offen offset:3072 lds
v_mfma_f32_16x16x32_bf16 v[124:127], a[120:123], a[128:131], v[124:127]
s_add_u32 s24, s24, 128
v_cvt_pk_bf16_f32 v104, v104, v105
v_cvt_pk_bf16_f32 v105, v106, v107
v_mfma_f32_16x16x32_bf16 v[124:127], a[124:127], a[132:135], v[124:127]
s_waitcnt lgkmcnt(2)
v_cvt_pk_bf16_f32 v106, v108, v109
v_cvt_pk_bf16_f32 v107, v110, v111
v_mfma_f32_16x16x32_bf16 v[128:131], a[64:67], a[136:139], v[128:131]
ds_read_b64_tr_b16 a[128:129], v8 offset:32768
v_cvt_pk_bf16_f32 v112, v112, v113
v_mfma_f32_16x16x32_bf16 v[128:131], a[68:71], a[140:143], v[128:131]
v_cvt_pk_bf16_f32 v113, v114, v115
v_cvt_pk_bf16_f32 v114, v116, v117
v_mfma_f32_16x16x32_bf16 v[132:135], a[72:75], a[136:139], v[132:135]
ds_read_b64_tr_b16 a[130:131], v8 offset:34816
v_cvt_pk_bf16_f32 v115, v118, v119
v_mfma_f32_16x16x32_bf16 v[132:135], a[76:79], a[140:143], v[132:135]
buffer_store_dwordx4 v[40:43], v1, s[4:7], s31 offen sc1
v_mfma_f32_16x16x32_bf16 v[136:139], a[80:83], a[136:139], v[136:139]
s_add_u32 s31, s31, s33
ds_read_b64_tr_b16 a[132:133], v8 offset:49152
v_cvt_pk_bf16_f32 v120, v120, v121
v_mfma_f32_16x16x32_bf16 v[136:139], a[84:87], a[140:143], v[136:139]
v_cvt_pk_bf16_f32 v121, v122, v123
v_cvt_pk_bf16_f32 v122, v124, v125
v_mfma_f32_16x16x32_bf16 v[140:143], a[88:91], a[136:139], v[140:143]
ds_read_b64_tr_b16 a[134:135], v8 offset:51200
v_cvt_pk_bf16_f32 v123, v126, v127
v_mfma_f32_16x16x32_bf16 v[140:143], a[92:95], a[140:143], v[140:143]
v_mfma_f32_16x16x32_bf16 v[144:147], a[96:99], a[136:139], v[144:147]
ds_read_b128 a[32:35], v2 offset:8192
v_cvt_pk_bf16_f32 v128, v128, v129
v_mfma_f32_16x16x32_bf16 v[144:147], a[100:103], a[140:143], v[144:147]
v_cvt_pk_bf16_f32 v129, v130, v131
v_cvt_pk_bf16_f32 v130, v132, v133
v_mfma_f32_16x16x32_bf16 v[148:151], a[104:107], a[136:139], v[148:151]
v_cvt_pk_bf16_f32 v131, v134, v135
v_mfma_f32_16x16x32_bf16 v[148:151], a[108:111], a[140:143], v[148:151]
v_mfma_f32_16x16x32_bf16 v[152:155], a[112:115], a[136:139], v[152:155]
ds_read_b128 a[36:39], v3 offset:8192
v_cvt_pk_bf16_f32 v136, v136, v137
v_mfma_f32_16x16x32_bf16 v[152:155], a[116:119], a[140:143], v[152:155]
v_cvt_pk_bf16_f32 v137, v138, v139
v_cvt_pk_bf16_f32 v138, v140, v141
v_mfma_f32_16x16x32_bf16 v[156:159], a[120:123], a[136:139], v[156:159]
ds_read_b128 a[40:43], v2 offset:10240
v_cvt_pk_bf16_f32 v139, v142, v143
v_mfma_f32_16x16x32_bf16 v[156:159], a[124:127], a[140:143], v[156:159]
s_waitcnt lgkmcnt(3)
buffer_store_dwordx4 v[48:51], v1, s[4:7], s31 offen sc1
v_mfma_f32_16x16x32_bf16 v[160:163], a[64:67], a[128:131], v[160:163]
s_add_u32 s31, s31, s32
ds_read_b64_tr_b16 a[136:137], v9 offset:32768
v_cvt_pk_bf16_f32 v144, v144, v145
v_mfma_f32_16x16x32_bf16 v[160:163], a[68:71], a[132:135], v[160:163]
v_cvt_pk_bf16_f32 v145, v146, v147
v_cvt_pk_bf16_f32 v146, v148, v149
v_mfma_f32_16x16x32_bf16 v[164:167], a[72:75], a[128:131], v[164:167]
ds_read_b64_tr_b16 a[138:139], v9 offset:34816
v_cvt_pk_bf16_f32 v147, v150, v151
v_mfma_f32_16x16x32_bf16 v[164:167], a[76:79], a[132:135], v[164:167]
v_mfma_f32_16x16x32_bf16 v[168:171], a[80:83], a[128:131], v[168:171]
ds_read_b64_tr_b16 a[140:141], v9 offset:49152
v_cvt_pk_bf16_f32 v152, v152, v153
v_mfma_f32_16x16x32_bf16 v[168:171], a[84:87], a[132:135], v[168:171]
v_cvt_pk_bf16_f32 v153, v154, v155
v_cvt_pk_bf16_f32 v154, v156, v157
v_mfma_f32_16x16x32_bf16 v[172:175], a[88:91], a[128:131], v[172:175]
ds_read_b64_tr_b16 a[142:143], v9 offset:51200
v_cvt_pk_bf16_f32 v155, v158, v159
v_mfma_f32_16x16x32_bf16 v[172:175], a[92:95], a[132:135], v[172:175]
v_mfma_f32_16x16x32_bf16 v[176:179], a[96:99], a[128:131], v[176:179]
buffer_store_dwordx4 v[56:59], v1, s[4:7], s31 offen sc1
v_mfma_f32_16x16x32_bf16 v[176:179], a[100:103], a[132:135], v[176:179]
s_add_u32 s31, s31, s34
v_cvt_pk_bf16_f32 v160, v160, v161
v_cvt_pk_bf16_f32 v161, v162, v163
v_mfma_f32_16x16x32_bf16 v[180:183], a[104:107], a[128:131], v[180:183]
ds_read_b128 a[44:47], v3 offset:10240
v_cvt_pk_bf16_f32 v162, v164, v165
v_mfma_f32_16x16x32_bf16 v[180:183], a[108:111], a[132:135], v[180:183]
v_cvt_pk_bf16_f32 v163, v166, v167
v_mfma_f32_16x16x32_bf16 v[184:187], a[112:115], a[128:131], v[184:187]
ds_read_b128 a[48:51], v2 offset:12288
v_cvt_pk_bf16_f32 v168, v168, v169
v_mfma_f32_16x16x32_bf16 v[184:187], a[116:119], a[132:135], v[184:187]
v_cvt_pk_bf16_f32 v169, v170, v171
v_cvt_pk_bf16_f32 v170, v172, v173
v_mfma_f32_16x16x32_bf16 v[188:191], a[120:123], a[128:131], v[188:191]
v_cvt_pk_bf16_f32 v171, v174, v175
v_mfma_f32_16x16x32_bf16 v[188:191], a[124:127], a[132:135], v[188:191]
s_waitcnt lgkmcnt(2)
v_mfma_f32_16x16x32_bf16 v[192:195], a[64:67], a[136:139], v[192:195]
ds_read_b64_tr_b16 a[128:129], v10 offset:32768
v_cvt_pk_bf16_f32 v176, v176, v177
v_mfma_f32_16x16x32_bf16 v[192:195], a[68:71], a[140:143], v[192:195]
v_cvt_pk_bf16_f32 v177, v178, v179
v_cvt_pk_bf16_f32 v178, v180, v181
v_mfma_f32_16x16x32_bf16 v[196:199], a[72:75], a[136:139], v[196:199]
ds_read_b64_tr_b16 a[130:131], v10 offset:34816
v_cvt_pk_bf16_f32 v179, v182, v183
v_mfma_f32_16x16x32_bf16 v[196:199], a[76:79], a[140:143], v[196:199]
buffer_store_dwordx4 v[64:67], v1, s[4:7], s31 offen sc1
v_mfma_f32_16x16x32_bf16 v[200:203], a[80:83], a[136:139], v[200:203]
s_add_u32 s31, s31, s32
ds_read_b64_tr_b16 a[132:133], v10 offset:49152
v_cvt_pk_bf16_f32 v184, v184, v185
v_mfma_f32_16x16x32_bf16 v[200:203], a[84:87], a[140:143], v[200:203]
v_cvt_pk_bf16_f32 v185, v186, v187
v_cvt_pk_bf16_f32 v186, v188, v189
v_mfma_f32_16x16x32_bf16 v[204:207], a[88:91], a[136:139], v[204:207]
ds_read_b64_tr_b16 a[134:135], v10 offset:51200
v_cvt_pk_bf16_f32 v187, v190, v191
v_mfma_f32_16x16x32_bf16 v[204:207], a[92:95], a[140:143], v[204:207]
v_mfma_f32_16x16x32_bf16 v[208:211], a[96:99], a[136:139], v[208:211]
ds_read_b128 a[52:55], v3 offset:12288
v_cvt_pk_bf16_f32 v192, v192, v193
v_mfma_f32_16x16x32_bf16 v[208:211], a[100:103], a[140:143], v[208:211]
v_cvt_pk_bf16_f32 v193, v194, v195
v_cvt_pk_bf16_f32 v194, v196, v197
v_mfma_f32_16x16x32_bf16 v[212:215], a[104:107], a[136:139], v[212:215]
ds_read_b128 a[56:59], v2 offset:14336
v_cvt_pk_bf16_f32 v195, v198, v199
v_mfma_f32_16x16x32_bf16 v[212:215], a[108:111], a[140:143], v[212:215]
v_mfma_f32_16x16x32_bf16 v[216:219], a[112:115], a[136:139], v[216:219]
v_cvt_pk_bf16_f32 v200, v200, v201
v_cvt_pk_bf16_f32 v201, v202, v203
v_mfma_f32_16x16x32_bf16 v[216:219], a[116:119], a[140:143], v[216:219]
buffer_store_dwordx4 v[72:75], v1, s[4:7], s31 offen sc1
v_mfma_f32_16x16x32_bf16 v[220:223], a[120:123], a[136:139], v[220:223]
s_add_u32 s31, s31, s33
ds_read_b128 a[60:63], v3 offset:14336
v_cvt_pk_bf16_f32 v202, v204, v205
v_mfma_f32_16x16x32_bf16 v[220:223], a[124:127], a[140:143], v[220:223]
s_waitcnt lgkmcnt(3)
v_cvt_pk_bf16_f32 v203, v206, v207
v_mfma_f32_16x16x32_bf16 a[192:195], a[64:67], a[128:131], a[192:195]
ds_read_b64_tr_b16 a[136:137], v11 offset:32768
v_cvt_pk_bf16_f32 v208, v208, v209
v_mfma_f32_16x16x32_bf16 a[192:195], a[68:71], a[132:135], a[192:195]
v_cvt_pk_bf16_f32 v209, v210, v211
v_cvt_pk_bf16_f32 v210, v212, v213
v_mfma_f32_16x16x32_bf16 a[196:199], a[72:75], a[128:131], a[196:199]
ds_read_b64_tr_b16 a[138:139], v11 offset:34816
v_cvt_pk_bf16_f32 v211, v214, v215
v_mfma_f32_16x16x32_bf16 a[196:199], a[76:79], a[132:135], a[196:199]
v_mfma_f32_16x16x32_bf16 a[200:203], a[80:83], a[128:131], a[200:203]
ds_read_b64_tr_b16 a[140:141], v11 offset:49152
v_cvt_pk_bf16_f32 v216, v216, v217
v_mfma_f32_16x16x32_bf16 a[200:203], a[84:87], a[132:135], a[200:203]
v_cvt_pk_bf16_f32 v217, v218, v219
v_cvt_pk_bf16_f32 v218, v220, v221
v_mfma_f32_16x16x32_bf16 a[204:207], a[88:91], a[128:131], a[204:207]
ds_read_b64_tr_b16 a[142:143], v11 offset:51200
v_cvt_pk_bf16_f32 v219, v222, v223
v_mfma_f32_16x16x32_bf16 a[204:207], a[92:95], a[132:135], a[204:207]
v_mfma_f32_16x16x32_bf16 a[208:211], a[96:99], a[128:131], a[208:211]
buffer_store_dwordx4 v[80:83], v1, s[4:7], s31 offen sc1
v_mfma_f32_16x16x32_bf16 a[208:211], a[100:103], a[132:135], a[208:211]
s_add_u32 s31, s31, s32
v_mfma_f32_16x16x32_bf16 a[212:215], a[104:107], a[128:131], a[212:215]
v_mfma_f32_16x16x32_bf16 a[212:215], a[108:111], a[132:135], a[212:215]
v_mfma_f32_16x16x32_bf16 a[216:219], a[112:115], a[128:131], a[216:219]
v_mfma_f32_16x16x32_bf16 a[216:219], a[116:119], a[132:135], a[216:219]
v_mfma_f32_16x16x32_bf16 a[220:223], a[120:123], a[128:131], a[220:223]
s_waitcnt vmcnt(23) lgkmcnt(0)
v_mfma_f32_16x16x32_bf16 a[220:223], a[124:127], a[132:135], a[220:223]
s_barrier
v_mfma_f32_16x16x32_bf16 a[224:227], a[64:67], a[136:139], a[224:227]
s_add_u32 m0, s29, 98304
ds_read_b64_tr_b16 a[128:129], v22 offset:0
v_mfma_f32_16x16x32_bf16 a[224:227], a[68:71], a[140:143], a[224:227]
buffer_load_dwordx4 v16, s[12:15], s26 offen offset:0 lds
v_mfma_f32_16x16x32_bf16 a[228:231], a[72:75], a[136:139], a[228:231]
ds_read_b64_tr_b16 a[130:131], v22 offset:2048
v_mfma_f32_16x16x32_bf16 a[228:231], a[76:79], a[140:143], a[228:231]
buffer_store_dwordx4 v[88:91], v1, s[4:7], s31 offen sc1
v_mfma_f32_16x16x32_bf16 a[232:235], a[80:83], a[136:139], a[232:235]
s_add_u32 s31, s31, s35
ds_read_b64_tr_b16 a[132:133], v22 offset:16384
v_mfma_f32_16x16x32_bf16 a[232:235], a[84:87], a[140:143], a[232:235]
buffer_load_dwordx4 v17, s[12:15], s26 offen offset:1024 lds
v_mfma_f32_16x16x32_bf16 a[236:239], a[88:91], a[136:139], a[236:239]
ds_read_b64_tr_b16 a[134:135], v22 offset:18432
v_add_u32 v22, 4294901760, v22
v_mfma_f32_16x16x32_bf16 a[236:239], a[92:95], a[140:143], a[236:239]
v_mfma_f32_16x16x32_bf16 a[240:243], a[96:99], a[136:139], a[240:243]
v_mfma_f32_16x16x32_bf16 a[240:243], a[100:103], a[140:143], a[240:243]
buffer_load_dwordx4 v18, s[12:15], s26 offen offset:2048 lds
v_mfma_f32_16x16x32_bf16 a[244:247], a[104:107], a[136:139], a[244:247]
v_mfma_f32_16x16x32_bf16 a[244:247], a[108:111], a[140:143], a[244:247]
v_mfma_f32_16x16x32_bf16 a[248:251], a[112:115], a[136:139], a[248:251]
v_mfma_f32_16x16x32_bf16 a[248:251], a[116:119], a[140:143], a[248:251]
buffer_load_dwordx4 v19, s[12:15], s26 offen offset:3072 lds
v_mfma_f32_16x16x32_bf16 a[252:255], a[120:123], a[136:139], a[252:255]
s_add_u32 s26, s26, 524288
v_mfma_f32_16x16x32_bf16 a[252:255], a[124:127], a[140:143], a[252:255]
s_waitcnt lgkmcnt(0)
s_cmp_ge_u32 s21, 7
s_cbranch_scc1 M_Q
M_conv:
v_mfma_f32_16x16x32_bf16 v[36:39], a[128:131], a[0:3], 0
s_add_u32 m0, s29, 114688
ds_read_b64_tr_b16 a[136:137], v23 offset:0
v_mfma_f32_16x16x32_bf16 v[36:39], a[132:135], a[4:7], v[36:39]
buffer_load_dwordx4 v16, s[12:15], s27 offen offset:0 lds
v_mfma_f32_16x16x32_bf16 v[44:47], a[128:131], a[8:11], 0
ds_read_b64_tr_b16 a[138:139], v23 offset:2048
v_mfma_f32_16x16x32_bf16 v[44:47], a[132:135], a[12:15], v[44:47]
ds_read_b128 a[64:67], v2 offset:16384
ds_read_b128 a[68:71], v3 offset:16384
v_mfma_f32_16x16x32_bf16 v[52:55], a[128:131], a[16:19], 0
ds_read_b64_tr_b16 a[140:141], v23 offset:16384
v_mfma_f32_16x16x32_bf16 v[52:55], a[132:135], a[20:23], v[52:55]
buffer_load_dwordx4 v17, s[12:15], s27 offen offset:1024 lds
v_mfma_f32_16x16x32_bf16 v[60:63], a[128:131], a[24:27], 0
ds_read_b64_tr_b16 a[142:143], v23 offset:18432
v_add_u32 v23, 4294901760, v23
v_mfma_f32_16x16x32_bf16 v[60:63], a[132:135], a[28:31], v[60:63]
buffer_store_dwordx4 v[96:99], v1, s[4:7], s31 offen sc1
v_mfma_f32_16x16x32_bf16 v[68:71], a[128:131], a[32:35], 0
s_add_u32 s31, s31, s32
ds_read_b128 a[72:75], v2 offset:18432
v_mfma_f32_16x16x32_bf16 v[68:71], a[132:135], a[36:39], v[68:71]
buffer_load_dwordx4 v18, s[12:15], s27 offen offset:2048 lds
v_mfma_f32_16x16x32_bf16 v[76:79], a[128:131], a[40:43], 0
ds_read_b128 a[76:79], v3 offset:18432
v_mfma_f32_16x16x32_bf16 v[76:79], a[132:135], a[44:47], v[76:79]
ds_read_b128 a[80:83], v2 offset:20480
v_mfma_f32_16x16x32_bf16 v[84:87], a[128:131], a[48:51], 0
ds_read_b128 a[84:87], v3 offset:20480
v_mfma_f32_16x16x32_bf16 v[84:87], a[132:135], a[52:55], v[84:87]
buffer_load_dwordx4 v19, s[12:15], s27 offen offset:3072 lds
v_mfma_f32_16x16x32_bf16 v[92:95], a[128:131], a[56:59], 0
s_add_u32 s27, s27, 524288
ds_read_b128 a[88:91], v2 offset:22528
v_mfma_f32_16x16x32_bf16 v[92:95], a[132:135], a[60:63], v[92:95]
s_waitcnt lgkmcnt(5)
buffer_store_dwordx4 v[104:107], v1, s[4:7], s31 offen sc1
v_mfma_f32_16x16x32_bf16 v[100:103], a[136:139], a[0:3], 0
s_add_u32 m0, s28, 0
ds_read_b64_tr_b16 a[128:129], v24 offset:0
v_mfma_f32_16x16x32_bf16 v[100:103], a[140:143], a[4:7], v[100:103]
s_add_u32 s31, s31, s33
buffer_load_dwordx4 v12, s[8:11], s24 offen offset:0 lds
v_mfma_f32_16x16x32_bf16 v[108:111], a[136:139], a[8:11], 0
ds_read_b64_tr_b16 a[130:131], v24 offset:2048
v_mfma_f32_16x16x32_bf16 v[108:111], a[140:143], a[12:15], v[108:111]
ds_read_b128 a[92:95], v3 offset:22528
v_mfma_f32_16x16x32_bf16 v[116:119], a[136:139], a[16:19], 0
ds_read_b64_tr_b16 a[132:133], v24 offset:16384
v_mfma_f32_16x16x32_bf16 v[116:119], a[140:143], a[20:23], v[116:119]
buffer_load_dwordx4 v13, s[8:11], s24 offen offset:1024 lds
v_mfma_f32_16x16x32_bf16 v[124:127], a[136:139], a[24:27], 0
ds_read_b64_tr_b16 a[134:135], v24 offset:18432
v_add_u32 v24, 4294901760, v24
v_mfma_f32_16x16x32_bf16 v[124:127], a[140:143], a[28:31], v[124:127]
v_mfma_f32_16x16x32_bf16 v[132:135], a[136:139], a[32:35], 0
ds_read_b128 a[96:99], v2 offset:24576
v_mfma_f32_16x16x32_bf16 v[132:135], a[140:143], a[36:39], v[132:135]
buffer_load_dwordx4 v14, s[8:11], s24 offen offset:2048 lds
v_mfma_f32_16x16x32_bf16 v[140:143], a[136:139], a[40:43], 0
ds_read_b128 a[100:103], v3 offset:24576
v_mfma_f32_16x16x32_bf16 v[140:143], a[140:143], a[44:47], v[140:143]
ds_read_b128 a[104:107], v2 offset:26624
v_mfma_f32_16x16x32_bf16 v[148:151], a[136:139], a[48:51], 0
ds_read_b128 a[108:111], v3 offset:26624
v_mfma_f32_16x16x32_bf16 v[148:151], a[140:143], a[52:55], v[148:151]
buffer_load_dwordx4 v15, s[8:11], s24 offen offset:3072 lds
v_mfma_f32_16x16x32_bf16 v[156:159], a[136:139], a[56:59], 0
s_add_u32 s24, s24, 128
ds_read_b128 a[112:115], v2 offset:28672
v_mfma_f32_16x16x32_bf16 v[156:159], a[140:143], a[60:63], v[156:159]
s_waitcnt lgkmcnt(5)
buffer_store_dwordx4 v[112:115], v1, s[4:7], s31 offen sc1
v_mfma_f32_16x16x32_bf16 v[164:167], a[128:131], a[0:3], 0
s_add_u32 s31, s31, s32
ds_read_b64_tr_b16 a[136:137], v25 offset:0
v_mfma_f32_16x16x32_bf16 v[164:167], a[132:135], a[4:7], v[164:167]
v_mfma_f32_16x16x32_bf16 v[172:175], a[128:131], a[8:11], 0
ds_read_b64_tr_b16 a[138:139], v25 offset:2048
v_mfma_f32_16x16x32_bf16 v[172:175], a[132:135], a[12:15], v[172:175]
ds_read_b128 a[116:119], v3 offset:28672
v_mfma_f32_16x16x32_bf16 v[180:183], a[128:131], a[16:19], 0
ds_read_b64_tr_b16 a[140:141], v25 offset:16384
v_mfma_f32_16x16x32_bf16 v[180:183], a[132:135], a[20:23], v[180:183]
v_mfma_f32_16x16x32_bf16 v[188:191], a[128:131], a[24:27], 0
ds_read_b64_tr_b16 a[142:143], v25 offset:18432
v_add_u32 v25, 4294901760, v25
v_mfma_f32_16x16x32_bf16 v[188:191], a[132:135], a[28:31], v[188:191]
v_mfma_f32_16x16x32_bf16 v[196:199], a[128:131], a[32:35], 0
ds_read_b128 a[120:123], v2 offset:30720
v_mfma_f32_16x16x32_bf16 v[196:199], a[132:135], a[36:39], v[196:199]
v_mfma_f32_16x16x32_bf16 v[204:207], a[128:131], a[40:43], 0
ds_read_b128 a[124:127], v3 offset:30720
v_mfma_f32_16x16x32_bf16 v[204:207], a[132:135], a[44:47], v[204:207]
v_mfma_f32_16x16x32_bf16 v[212:215], a[128:131], a[48:51], 0
v_mfma_f32_16x16x32_bf16 v[212:215], a[132:135], a[52:55], v[212:215]
buffer_store_dwordx4 v[120:123], v1, s[4:7], s31 offen sc1
v_mfma_f32_16x16x32_bf16 v[220:223], a[128:131], a[56:59], 0
s_add_u32 s31, s31, s34
v_mfma_f32_16x16x32_bf16 v[220:223], a[132:135], a[60:63], v[220:223]
s_waitcnt vmcnt(28) lgkmcnt(0)
s_barrier
v_mfma_f32_16x16x32_bf16 v[224:227], a[136:139], a[0:3], 0
s_add_u32 m0, s29, 131072
ds_read_b64_tr_b16 a[128:129], v22 offset:0
v_mfma_f32_16x16x32_bf16 v[224:227], a[140:143], a[4:7], v[224:227]
buffer_load_dwordx4 v16, s[12:15], s26 offen offset:0 lds
v_mfma_f32_16x16x32_bf16 v[228:231], a[136:139], a[8:11], 0
ds_read_b64_tr_b16 a[130:131], v22 offset:2048
v_mfma_f32_16x16x32_bf16 v[228:231], a[140:143], a[12:15], v[228:231]
v_mfma_f32_16x16x32_bf16 v[232:235], a[136:139], a[16:19], 0
ds_read_b64_tr_b16 a[132:133], v22 offset:16384
v_mfma_f32_16x16x32_bf16 v[232:235], a[140:143], a[20:23], v[232:235]
buffer_load_dwordx4 v17, s[12:15], s26 offen offset:1024 lds
v_mfma_f32_16x16x32_bf16 v[236:239], a[136:139], a[24:27], 0
ds_read_b64_tr_b16 a[134:135], v22 offset:18432
v_add_u32 v22, 32768, v22
v_mfma_f32_16x16x32_bf16 v[236:239], a[140:143], a[28:31], v[236:239]
v_mfma_f32_16x16x32_bf16 v[240:243], a[136:139], a[32:35], 0
v_mfma_f32_16x16x32_bf16 v[240:243], a[140:143], a[36:39], v[240:243]
buffer_load_dwordx4 v18, s[12:15], s26 offen offset:2048 lds
v_mfma_f32_16x16x32_bf16 v[244:247], a[136:139], a[40:43], 0
v_mfma_f32_16x16x32_bf16 v[244:247], a[140:143], a[44:47], v[244:247]
v_mfma_f32_16x16x32_bf16 v[248:251], a[136:139], a[48:51], 0
v_mfma_f32_16x16x32_bf16 v[248:251], a[140:143], a[52:55], v[248:251]
buffer_load_dwordx4 v19, s[12:15], s26 offen offset:3072 lds
v_mfma_f32_16x16x32_bf16 v[252:255], a[136:139], a[56:59], 0
s_add_u32 s26, s26, 524288
v_mfma_f32_16x16x32_bf16 v[252:255], a[140:143], a[60:63], v[252:255]
s_waitcnt lgkmcnt(0)
v_mfma_f32_16x16x32_bf16 v[36:39], a[128:131], a[64:67], v[36:39]
s_add_u32 m0, s29, 147456
ds_read_b64_tr_b16 a[136:137], v23 offset:0
v_mfma_f32_16x16x32_bf16 v[36:39], a[132:135], a[68:71], v[36:39]
buffer_load_dwordx4 v16, s[12:15], s27 offen offset:0 lds
v_mfma_f32_16x16x32_bf16 v[44:47], a[128:131], a[72:75], v[44:47]
ds_read_b64_tr_b16 a[138:139], v23 offset:2048
v_mfma_f32_16x16x32_bf16 v[44:47], a[132:135], a[76:79], v[44:47]
ds_read_b128 a[0:3], v2 offset:32768
ds_read_b128 a[4:7], v3 offset:32768
v_mfma_f32_16x16x32_bf16 v[52:55], a[128:131], a[80:83], v[52:55]
ds_read_b64_tr_b16 a[140:141], v23 offset:16384
v_mfma_f32_16x16x32_bf16 v[52:55], a[132:135], a[84:87], v[52:55]
buffer_load_dwordx4 v17, s[12:15], s27 offen offset:1024 lds
v_mfma_f32_16x16x32_bf16 v[60:63], a[128:131], a[88:91], v[60:63]
ds_read_b64_tr_b16 a[142:143], v23 offset:18432
v_add_u32 v23, 32768, v23
v_mfma_f32_16x16x32_bf16 v[60:63], a[132:135], a[92:95], v[60:63]
buffer_store_dwordx4 v[128:131], v1, s[4:7], s31 offen sc1
v_mfma_f32_16x16x32_bf16 v[68:71], a[128:131], a[96:99], v[68:71]
s_add_u32 s31, s31, s32
ds_read_b128 a[8:11], v2 offset:34816
v_accvgpr_read_b32 v32, a192
v_mfma_f32_16x16x32_bf16 v[68:71], a[132:135], a[100:103], v[68:71]
buffer_load_dwordx4 v18, s[12:15], s27 offen offset:2048 lds
v_mfma_f32_16x16x32_bf16 v[76:79], a[128:131], a[104:107], v[76:79]
ds_read_b128 a[12:15], v3 offset:34816
v_accvgpr_read_b32 v33, a193
v_mfma_f32_16x16x32_bf16 v[76:79], a[132:135], a[108:111], v[76:79]
ds_read_b128 a[16:19], v2 offset:36864
v_accvgpr_read_b32 v34, a194
v_mfma_f32_16x16x32_bf16 v[84:87], a[128:131], a[112:115], v[84:87]
ds_read_b128 a[20:23], v3 offset:36864
v_accvgpr_read_b32 v35, a195
v_mfma_f32_16x16x32_bf16 v[84:87], a[132:135], a[116:119], v[84:87]
buffer_load_dwordx4 v19, s[12:15], s27 offen offset:3072 lds
v_mfma_f32_16x16x32_bf16 v[92:95], a[128:131], a[120:123], v[92:95]
s_add_u32 s27, s27, 524288
ds_read_b128 a[24:27], v2 offset:38912
v_accvgpr_read_b32 v96, a196
v_mfma_f32_16x16x32_bf16 v[92:95], a[132:135], a[124:127], v[92:95]
s_waitcnt lgkmcnt(5)
buffer_store_dwordx4 v[136:139], v1, s[4:7], s31 offen sc1
v_mfma_f32_16x16x32_bf16 v[100:103], a[136:139], a[64:67], v[100:103]
s_add_u32 m0, s28, 16384
ds_read_b64_tr_b16 a[128:129], v24 offset:0
v_accvgpr_read_b32 v97, a197
v_mfma_f32_16x16x32_bf16 v[100:103], a[140:143], a[68:71], v[100:103]
s_add_u32 s31, s31, s33
buffer_load_dwordx4 v12, s[8:11], s24 offen offset:0 lds
v_mfma_f32_16x16x32_bf16 v[108:111], a[136:139], a[72:75], v[108:111]
ds_read_b64_tr_b16 a[130:131], v24 offset:2048
v_accvgpr_read_b32 v98, a198
v_mfma_f32_16x16x32_bf16 v[108:111], a[140:143], a[76:79], v[108:111]
ds_read_b128 a[28:31], v3 offset:38912
v_accvgpr_read_b32 v99, a199
v_mfma_f32_16x16x32_bf16 v[116:119], a[136:139], a[80:83], v[116:119]
ds_read_b64_tr_b16 a[132:133], v24 offset:16384
v_cvt_pk_bf16_f32 v32, v32, v33
v_mfma_f32_16x16x32_bf16 v[116:119], a[140:143], a[84:87], v[116:119]
buffer_load_dwordx4 v13, s[8:11], s24 offen offset:1024 lds
v_mfma_f32_16x16x32_bf16 v[124:127], a[136:139], a[88:91], v[124:127]
ds_read_b64_tr_b16 a[134:135], v24 offset:18432
v_add_u32 v24, 32768, v24
v_mfma_f32_16x16x32_bf16 v[124:127], a[140:143], a[92:95], v[124:127]
v_cvt_pk_bf16_f32 v33, v34, v35
v_cvt_pk_bf16_f32 v34, v96, v97
v_mfma_f32_16x16x32_bf16 v[132:135], a[136:139], a[96:99], v[132:135]
ds_read_b128 a[32:35], v2 offset:40960
v_cvt_pk_bf16_f32 v35, v98, v99
v_mfma_f32_16x16x32_bf16 v[132:135], a[140:143], a[100:103], v[132:135]
buffer_load_dwordx4 v14, s[8:11], s24 offen offset:2048 lds
v_mfma_f32_16x16x32_bf16 v[140:143], a[136:139], a[104:107], v[140:143]
ds_read_b128 a[36:39], v3 offset:40960
v_accvgpr_read_b32 v40, a200
v_mfma_f32_16x16x32_bf16 v[140:143], a[140:143], a[108:111], v[140:143]
ds_read_b128 a[40:43], v2 offset:43008
v_accvgpr_read_b32 v41, a201
v_mfma_f32_16x16x32_bf16 v[148:151], a[136:139], a[112:115], v[148:151]
ds_read_b128 a[44:47], v3 offset:43008
v_accvgpr_read_b32 v42, a202
v_mfma_f32_16x16x32_bf16 v[148:151], a[140:143], a[116:119], v[148:151]
buffer_load_dwordx4 v15, s[8:11], s24 offen offset:3072 lds
v_mfma_f32_16x16x32_bf16 v[156:159], a[136:139], a[120:123], v[156:159]
s_add_u32 s24, s24, 128
ds_read_b128 a[48:51], v2 offset:45056
v_accvgpr_read_b32 v43, a203
v_mfma_f32_16x16x32_bf16 v[156:159], a[140:143], a[124:127], v[156:159]
s_waitcnt lgkmcnt(5)
buffer_store_dwordx4 v[144:147], v1, s[4:7], s31 offen sc1
v_mfma_f32_16x16x32_bf16 v[164:167], a[128:131], a[64:67], v[164:167]
s_add_u32 s31, s31, s32
ds_read_b64_tr_b16 a[136:137], v25 offset:0
v_accvgpr_read_b32 v96, a204
v_mfma_f32_16x16x32_bf16 v[164:167], a[132:135], a[68:71], v[164:167]
v_accvgpr_read_b32 v97, a205
v_accvgpr_read_b32 v98, a206
v_mfma_f32_16x16x32_bf16 v[172:175], a[128:131], a[72:75], v[172:175]
ds_read_b64_tr_b16 a[138:139], v25 offset:2048
v_accvgpr_read_b32 v99, a207
v_mfma_f32_16x16x32_bf16 v[172:175], a[132:135], a[76:79], v[172:175]
ds_read_b128 a[52:55], v3 offset:45056
v_cvt_pk_bf16_f32 v40, v40, v41
v_mfma_f32_16x16x32_bf16 v[180:183], a[128:131], a[80:83], v[180:183]
ds_read_b64_tr_b16 a[140:141], v25 offset:16384
v_cvt_pk_bf16_f32 v41, v42, v43
v_mfma_f32_16x16x32_bf16 v[180:183], a[132:135], a[84:87], v[180:183]
v_cvt_pk_bf16_f32 v42, v96, v97
v_cvt_pk_bf16_f32 v43, v98, v99
v_mfma_f32_16x16x32_bf16 v[188:191], a[128:131], a[88:91], v[188:191]
ds_read_b64_tr_b16 a[142:143], v25 offset:18432
v_add_u32 v25, 32768, v25
v_mfma_f32_16x16x32_bf16 v[188:191], a[132:135], a[92:95], v[188:191]
v_accvgpr_read_b32 v48, a208
v_accvgpr_read_b32 v49, a209
v_mfma_f32_16x16x32_bf16 v[196:199], a[128:131], a[96:99], v[196:199]
ds_read_b128 a[56:59], v2 offset:47104
v_accvgpr_read_b32 v50, a210
v_mfma_f32_16x16x32_bf16 v[196:199], a[132:135], a[100:103], v[196:199]
v_accvgpr_read_b32 v51, a211
v_accvgpr_read_b32 v96, a212
v_mfma_f32_16x16x32_bf16 v[204:207], a[128:131], a[104:107], v[204:207]
ds_read_b128 a[60:63], v3 offset:47104
v_accvgpr_read_b32 v97, a213
v_mfma_f32_16x16x32_bf16 v[204:207], a[132:135], a[108:111], v[204:207]
v_accvgpr_read_b32 v98, a214
v_accvgpr_read_b32 v99, a215
v_mfma_f32_16x16x32_bf16 v[212:215], a[128:131], a[112:115], v[212:215]
v_cvt_pk_bf16_f32 v48, v48, v49
v_cvt_pk_bf16_f32 v49, v50, v51
v_mfma_f32_16x16x32_bf16 v[212:215], a[132:135], a[116:119], v[212:215]
buffer_store_dwordx4 v[152:155], v1, s[4:7], s31 offen sc1
v_mfma_f32_16x16x32_bf16 v[220:223], a[128:131], a[120:123], v[220:223]
s_add_u32 s31, s31, s36
v_cvt_pk_bf16_f32 v50, v96, v97
v_cvt_pk_bf16_f32 v51, v98, v99
v_mfma_f32_16x16x32_bf16 v[220:223], a[132:135], a[124:127], v[220:223]
s_waitcnt vmcnt(23) lgkmcnt(0)
s_barrier
v_accvgpr_read_b32 v56, a216
v_mfma_f32_16x16x32_bf16 v[224:227], a[136:139], a[64:67], v[224:227]
s_add_u32 m0, s29, 65536
ds_read_b64_tr_b16 a[128:129], v22 offset:0
v_accvgpr_read_b32 v57, a217
v_mfma_f32_16x16x32_bf16 v[224:227], a[140:143], a[68:71], v[224:227]
buffer_load_dwordx4 v16, s[12:15], s26 offen offset:0 lds
v_mfma_f32_16x16x32_bf16 v[228:231], a[136:139], a[72:75], v[228:231]
ds_read_b64_tr_b16 a[130:131], v22 offset:2048
v_accvgpr_read_b32 v58, a218
v_mfma_f32_16x16x32_bf16 v[228:231], a[140:143], a[76:79], v[228:231]
v_accvgpr_read_b32 v59, a219
v_accvgpr_read_b32 v96, a220
v_mfma_f32_16x16x32_bf16 v[232:235], a[136:139], a[80:83], v[232:235]
ds_read_b64_tr_b16 a[132:133], v22 offset:16384
v_accvgpr_read_b32 v97, a221
v_mfma_f32_16x16x32_bf16 v[232:235], a[140:143], a[84:87], v[232:235]
buffer_load_dwordx4 v17, s[12:15], s26 offen offset:1024 lds
v_mfma_f32_16x16x32_bf16 v[236:239], a[136:139], a[88:91], v[236:239]
ds_read_b64_tr_b16 a[134:135], v22 offset:18432
v_add_u32 v22, 32768, v22
v_mfma_f32_16x16x32_bf16 v[236:239], a[140:143], a[92:95], v[236:239]
PAD_28:
s_cbranch_execz M_tret
v_accvgpr_read_b32 v98, a222
v_accvgpr_read_b32 v99, a223
v_mfma_f32_16x16x32_bf16 v[240:243], a[136:139], a[96:99], v[240:243]
v_cvt_pk_bf16_f32 v56, v56, v57
v_cvt_pk_bf16_f32 v57, v58, v59
v_mfma_f32_16x16x32_bf16 v[240:243], a[140:143], a[100:103], v[240:243]
buffer_load_dwordx4 v18, s[12:15], s26 offen offset:2048 lds
v_mfma_f32_16x16x32_bf16 v[244:247], a[136:139], a[104:107], v[244:247]
v_cvt_pk_bf16_f32 v58, v96, v97
v_cvt_pk_bf16_f32 v59, v98, v99
v_mfma_f32_16x16x32_bf16 v[244:247], a[140:143], a[108:111], v[244:247]
v_accvgpr_read_b32 v64, a224
v_accvgpr_read_b32 v65, a225
v_mfma_f32_16x16x32_bf16 v[248:251], a[136:139], a[112:115], v[248:251]
v_accvgpr_read_b32 v66, a226
v_accvgpr_read_b32 v67, a227
v_mfma_f32_16x16x32_bf16 v[248:251], a[140:143], a[116:119], v[248:251]
buffer_load_dwordx4 v19, s[12:15], s26 offen offset:3072 lds
v_mfma_f32_16x16x32_bf16 v[252:255], a[136:139], a[120:123], v[252:255]
s_add_u32 s26, s26, 524288
v_accvgpr_read_b32 v96, a228
v_accvgpr_read_b32 v97, a229
v_mfma_f32_16x16x32_bf16 v[252:255], a[140:143], a[124:127], v[252:255]
s_waitcnt lgkmcnt(0)
v_accvgpr_read_b32 v98, a230
v_accvgpr_read_b32 v99, a231
v_mfma_f32_16x16x32_bf16 v[36:39], a[128:131], a[0:3], v[36:39]
s_add_u32 m0, s29, 81920
ds_read_b64_tr_b16 a[136:137], v23 offset:0
v_cvt_pk_bf16_f32 v64, v64, v65
v_mfma_f32_16x16x32_bf16 v[36:39], a[132:135], a[4:7], v[36:39]
buffer_load_dwordx4 v16, s[12:15], s27 offen offset:0 lds
v_mfma_f32_16x16x32_bf16 v[44:47], a[128:131], a[8:11], v[44:47]
ds_read_b64_tr_b16 a[138:139], v23 offset:2048
v_cvt_pk_bf16_f32 v65, v66, v67
v_mfma_f32_16x16x32_bf16 v[44:47], a[132:135], a[12:15], v[44:47]
ds_read_b128 a[64:67], v2 offset:49152
ds_read_b128 a[68:71], v3 offset:49152
v_mfma_f32_16x16x32_bf16 v[52:55], a[128:131], a[16:19], v[52:55]
ds_read_b64_tr_b16 a[140:141], v23 offset:16384
v_cvt_pk_bf16_f32 v66, v96, v97
v_mfma_f32_16x16x32_bf16 v[52:55], a[132:135], a[20:23], v[52:55]
buffer_load_dwordx4 v17, s[12:15], s27 offen offset:1024 lds
v_mfma_f32_16x16x32_bf16 v[60:63], a[128:131], a[24:27], v[60:63]
ds_read_b64_tr_b16 a[142:143], v23 offset:18432
v_add_u32 v23, 32768, v23
v_mfma_f32_16x16x32_bf16 v[60:63], a[132:135], a[28:31], v[60:63]
buffer_store_dwordx4 v[160:163], v1, s[4:7], s31 offen sc1
v_mfma_f32_16x16x32_bf16 v[68:71], a[128:131], a[32:35], v[68:71]
s_add_u32 s31, s31, s32
ds_read_b128 a[72:75], v2 offset:51200
v_cvt_pk_bf16_f32 v67, v98, v99
v_mfma_f32_16x16x32_bf16 v[68:71], a[132:135], a[36:39], v[68:71]
buffer_load_dwordx4 v18, s[12:15], s27 offen offset:2048 lds
v_mfma_f32_16x16x32_bf16 v[76:79], a[128:131], a[40:43], v[76:79]
ds_read_b128 a[76:79], v3 offset:51200
v_accvgpr_read_b32 v72, a232
v_mfma_f32_16x16x32_bf16 v[76:79], a[132:135], a[44:47], v[76:79]
ds_read_b128 a[80:83], v2 offset:53248
v_accvgpr_read_b32 v73, a233
v_mfma_f32_16x16x32_bf16 v[84:87], a[128:131], a[48:51], v[84:87]
ds_read_b128 a[84:87], v3 offset:53248
v_accvgpr_read_b32 v74, a234
v_mfma_f32_16x16x32_bf16 v[84:87], a[132:135], a[52:55], v[84:87]
buffer_load_dwordx4 v19, s[12:15], s27 offen offset:3072 lds
v_mfma_f32_16x16x32_bf16 v[92:95], a[128:131], a[56:59], v[92:95]
s_add_u32 s27, s27, 524288
ds_read_b128 a[88:91], v2 offset:55296
v_accvgpr_read_b32 v75, a235
v_mfma_f32_16x16x32_bf16 v[92:95], a[132:135], a[60:63], v[92:95]
s_waitcnt lgkmcnt(5)
buffer_store_dwordx4 v[168:171], v1, s[4:7], s31 offen sc1
v_mfma_f32_16x16x32_bf16 v[100:103], a[136:139], a[0:3], v[100:103]
s_add_u32 m0, s28, 32768
ds_read_b64_tr_b16 a[128:129], v24 offset:0
v_accvgpr_read_b32 v96, a236
v_mfma_f32_16x16x32_bf16 v[100:103], a[140:143], a[4:7], v[100:103]
s_add_u32 s31, s31, s33
buffer_load_dwordx4 v12, s[8:11], s24 offen offset:0 lds
v_mfma_f32_16x16x32_bf16 v[108:111], a[136:139], a[8:11], v[108:111]
ds_read_b64_tr_b16 a[130:131], v24 offset:2048
v_accvgpr_read_b32 v97, a237
v_mfma_f32_16x16x32_bf16 v[108:111], a[140:143], a[12:15], v[108:111]
ds_read_b128 a[92:95], v3 offset:55296
v_accvgpr_read_b32 v98, a238
v_mfma_f32_16x16x32_bf16 v[116:119], a[136:139], a[16:19], v[116:119]
ds_read_b64_tr_b16 a[132:133], v24 offset:16384
v_accvgpr_read_b32 v99, a239
v_mfma_f32_16x16x32_bf16 v[116:119], a[140:143], a[20:23], v[116:119]
buffer_load_dwordx4 v13, s[8:11], s24 offen offset:1024 lds
v_mfma_f32_16x16x32_bf16 v[124:127], a[136:139], a[24:27], v[124:127]
ds_read_b64_tr_b16 a[134:135], v24 offset:18432
v_add_u32 v24, 32768, v24
v_mfma_f32_16x16x32_bf16 v[124:127], a[140:143], a[28:31], v[124:127]
v_cvt_pk_bf16_f32 v72, v72, v73
v_cvt_pk_bf16_f32 v73, v74, v75
v_mfma_f32_16x16x32_bf16 v[132:135], a[136:139], a[32:35], v[132:135]
ds_read_b128 a[96:99], v2 offset:57344
v_cvt_pk_bf16_f32 v74, v96, v97
v_mfma_f32_16x16x32_bf16 v[132:135], a[140:143], a[36:39], v[132:135]
buffer_load_dwordx4 v14, s[8:11], s24 offen offset:2048 lds
v_mfma_f32_16x16x32_bf16 v[140:143], a[136:139], a[40:43], v[140:143]
ds_read_b128 a[100:103], v3 offset:57344
v_cvt_pk_bf16_f32 v75, v98, v99
v_mfma_f32_16x16x32_bf16 v[140:143], a[140:143], a[44:47], v[140:143]
ds_read_b128 a[104:107], v2 offset:59392
v_accvgpr_read_b32 v80, a240
v_mfma_f32_16x16x32_bf16 v[148:151], a[136:139], a[48:51], v[148:151]
ds_read_b128 a[108:111], v3 offset:59392
v_accvgpr_read_b32 v81, a241
v_mfma_f32_16x16x32_bf16 v[148:151], a[140:143], a[52:55], v[148:151]
buffer_load_dwordx4 v15, s[8:11], s24 offen offset:3072 lds
v_mfma_f32_16x16x32_bf16 v[156:159], a[136:139], a[56:59], v[156:159]
s_add_u32 s24, s24, 128
ds_read_b128 a[112:115], v2 offset:61440
v_accvgpr_read_b32 v82, a242
v_mfma_f32_16x16x32_bf16 v[156:159], a[140:143], a[60:63], v[156:159]
s_waitcnt lgkmcnt(5)
buffer_store_dwordx4 v[176:179], v1, s[4:7], s31 offen sc1
v_mfma_f32_16x16x32_bf16 v[164:167], a[128:131], a[0:3], v[164:167]
s_add_u32 s31, s31, s32
ds_read_b64_tr_b16 a[136:137], v25 offset:0
v_accvgpr_read_b32 v83, a243
v_mfma_f32_16x16x32_bf16 v[164:167], a[132:135], a[4:7], v[164:167]
v_accvgpr_read_b32 v96, a244
v_accvgpr_read_b32 v97, a245
v_mfma_f32_16x16x32_bf16 v[172:175], a[128:131], a[8:11], v[172:175]
ds_read_b64_tr_b16 a[138:139], v25 offset:2048
v_accvgpr_read_b32 v98, a246
v_mfma_f32_16x16x32_bf16 v[172:175], a[132:135], a[12:15], v[172:175]
ds_read_b128 a[116:119], v3 offset:61440
v_accvgpr_read_b32 v99, a247
v_mfma_f32_16x16x32_bf16 v[180:183], a[128:131], a[16:19], v[180:183]
ds_read_b64_tr_b16 a[140:141], v25 offset:16384
v_cvt_pk_bf16_f32 v80, v80, v81
v_mfma_f32_16x16x32_bf16 v[180:183], a[132:135], a[20:23], v[180:183]
buffer_store_dwordx4 v[184:187], v1, s[4:7], s31 offen sc1
v_mfma_f32_16x16x32_bf16 v[188:191], a[128:131], a[24:27], v[188:191]
s_add_u32 s31, s31, s34
ds_read_b64_tr_b16 a[142:143], v25 offset:18432
v_add_u32 v25, 32768, v25
v_mfma_f32_16x16x32_bf16 v[188:191], a[132:135], a[28:31], v[188:191]
v_cvt_pk_bf16_f32 v81, v82, v83
v_cvt_pk_bf16_f32 v82, v96, v97
v_mfma_f32_16x16x32_bf16 v[196:199], a[128:131], a[32:35], v[196:199]
ds_read_b128 a[120:123], v2 offset:63488
v_cvt_pk_bf16_f32 v83, v98, v99
v_mfma_f32_16x16x32_bf16 v[196:199], a[132:135], a[36:39], v[196:199]
v_accvgpr_read_b32 v88, a248
v_accvgpr_read_b32 v89, a249
v_mfma_f32_16x16x32_bf16 v[204:207], a[128:131], a[40:43], v[204:207]
ds_read_b128 a[124:127], v3 offset:63488
v_accvgpr_read_b32 v90, a250
v_mfma_f32_16x16x32_bf16 v[204:207], a[132:135], a[44:47], v[204:207]
v_accvgpr_read_b32 v91, a251
v_accvgpr_read_b32 v96, a252
v_mfma_f32_16x16x32_bf16 v[212:215], a[128:131], a[48:51], v[212:215]
v_accvgpr_read_b32 v97, a253
v_accvgpr_read_b32 v98, a254
v_mfma_f32_16x16x32_bf16 v[212:215], a[132:135], a[52:55], v[212:215]
v_accvgpr_read_b32 v99, a255
v_cvt_pk_bf16_f32 v88, v88, v89
v_mfma_f32_16x16x32_bf16 v[220:223], a[128:131], a[56:59], v[220:223]
v_cvt_pk_bf16_f32 v89, v90, v91
v_cvt_pk_bf16_f32 v90, v96, v97
v_mfma_f32_16x16x32_bf16 v[220:223], a[132:135], a[60:63], v[220:223]
s_waitcnt vmcnt(23) lgkmcnt(0)
s_barrier
v_cvt_pk_bf16_f32 v91, v98, v99
v_mfma_f32_16x16x32_bf16 v[224:227], a[136:139], a[0:3], v[224:227]
s_add_u32 m0, s29, 98304
ds_read_b64_tr_b16 a[128:129], v22 offset:0
v_mfma_f32_16x16x32_bf16 v[224:227], a[140:143], a[4:7], v[224:227]
buffer_load_dwordx4 v16, s[12:15], s26 offen offset:0 lds
v_mfma_f32_16x16x32_bf16 v[228:231], a[136:139], a[8:11], v[228:231]
ds_read_b64_tr_b16 a[130:131], v22 offset:2048
v_mfma_f32_16x16x32_bf16 v[228:231], a[140:143], a[12:15], v[228:231]
buffer_store_dwordx4 v[192:195], v1, s[4:7], s31 offen sc1
v_mfma_f32_16x16x32_bf16 v[232:235], a[136:139], a[16:19], v[232:235]
s_add_u32 s31, s31, s32
ds_read_b64_tr_b16 a[132:133], v22 offset:16384
v_mfma_f32_16x16x32_bf16 v[232:235], a[140:143], a[20:23], v[232:235]
buffer_load_dwordx4 v17, s[12:15], s26 offen offset:1024 lds
v_mfma_f32_16x16x32_bf16 v[236:239], a[136:139], a[24:27], v[236:239]
ds_read_b64_tr_b16 a[134:135], v22 offset:18432
v_add_u32 v22, 4294901760, v22
v_mfma_f32_16x16x32_bf16 v[236:239], a[140:143], a[28:31], v[236:239]
v_mfma_f32_16x16x32_bf16 v[240:243], a[136:139], a[32:35], v[240:243]
v_mfma_f32_16x16x32_bf16 v[240:243], a[140:143], a[36:39], v[240:243]
buffer_load_dwordx4 v18, s[12:15], s26 offen offset:2048 lds
v_mfma_f32_16x16x32_bf16 v[244:247], a[136:139], a[40:43], v[244:247]
v_mfma_f32_16x16x32_bf16 v[244:247], a[140:143], a[44:47], v[244:247]
v_mfma_f32_16x16x32_bf16 v[248:251], a[136:139], a[48:51], v[248:251]
v_mfma_f32_16x16x32_bf16 v[248:251], a[140:143], a[52:55], v[248:251]
buffer_load_dwordx4 v19, s[12:15], s26 offen offset:3072 lds
v_mfma_f32_16x16x32_bf16 v[252:255], a[136:139], a[56:59], v[252:255]
s_add_u32 s26, s26, 524288
v_mfma_f32_16x16x32_bf16 v[252:255], a[140:143], a[60:63], v[252:255]
s_waitcnt lgkmcnt(0)
v_mfma_f32_16x16x32_bf16 v[36:39], a[128:131], a[64:67], v[36:39]
s_add_u32 m0, s29, 114688
ds_read_b64_tr_b16 a[136:137], v23 offset:0
v_mfma_f32_16x16x32_bf16 v[36:39], a[132:135], a[68:71], v[36:39]
buffer_load_dwordx4 v16, s[12:15], s27 offen offset:0 lds
v_mfma_f32_16x16x32_bf16 v[44:47], a[128:131], a[72:75], v[44:47]
ds_read_b64_tr_b16 a[138:139], v23 offset:2048
v_mfma_f32_16x16x32_bf16 v[44:47], a[132:135], a[76:79], v[44:47]
ds_read_b128 a[0:3], v2 offset:0
ds_read_b128 a[4:7], v3 offset:0
v_mfma_f32_16x16x32_bf16 v[52:55], a[128:131], a[80:83], v[52:55]
ds_read_b64_tr_b16 a[140:141], v23 offset:16384
v_mfma_f32_16x16x32_bf16 v[52:55], a[132:135], a[84:87], v[52:55]
buffer_load_dwordx4 v17, s[12:15], s27 offen offset:1024 lds
v_mfma_f32_16x16x32_bf16 v[60:63], a[128:131], a[88:91], v[60:63]
ds_read_b64_tr_b16 a[142:143], v23 offset:18432
v_add_u32 v23, 4294901760, v23
v_mfma_f32_16x16x32_bf16 v[60:63], a[132:135], a[92:95], v[60:63]
buffer_store_dwordx4 v[200:203], v1, s[4:7], s31 offen sc1
v_mfma_f32_16x16x32_bf16 v[68:71], a[128:131], a[96:99], v[68:71]
s_add_u32 s31, s31, s33
ds_read_b128 a[8:11], v2 offset:2048
v_mfma_f32_16x16x32_bf16 v[68:71], a[132:135], a[100:103], v[68:71]
buffer_load_dwordx4 v18, s[12:15], s27 offen offset:2048 lds
v_mfma_f32_16x16x32_bf16 v[76:79], a[128:131], a[104:107], v[76:79]
ds_read_b128 a[12:15], v3 offset:2048
v_mfma_f32_16x16x32_bf16 v[76:79], a[132:135], a[108:111], v[76:79]
ds_read_b128 a[16:19], v2 offset:4096
v_mfma_f32_16x16x32_bf16 v[84:87], a[128:131], a[112:115], v[84:87]
ds_read_b128 a[20:23], v3 offset:4096
v_mfma_f32_16x16x32_bf16 v[84:87], a[132:135], a[116:119], v[84:87]
buffer_load_dwordx4 v19, s[12:15], s27 offen offset:3072 lds
v_mfma_f32_16x16x32_bf16 v[92:95], a[128:131], a[120:123], v[92:95]
s_add_u32 s27, s27, 524288
ds_read_b128 a[24:27], v2 offset:6144
v_mfma_f32_16x16x32_bf16 v[92:95], a[132:135], a[124:127], v[92:95]
s_waitcnt lgkmcnt(5)
buffer_store_dwordx4 v[208:211], v1, s[4:7], s31 offen sc1
v_mfma_f32_16x16x32_bf16 v[100:103], a[136:139], a[64:67], v[100:103]
s_add_u32 s31, s31, s32
ds_read_b64_tr_b16 a[128:129], v24 offset:0
v_mfma_f32_16x16x32_bf16 v[100:103], a[140:143], a[68:71], v[100:103]
v_mfma_f32_16x16x32_bf16 v[108:111], a[136:139], a[72:75], v[108:111]
ds_read_b64_tr_b16 a[130:131], v24 offset:2048
v_mfma_f32_16x16x32_bf16 v[108:111], a[140:143], a[76:79], v[108:111]
ds_read_b128 a[28:31], v3 offset:6144
v_mfma_f32_16x16x32_bf16 v[116:119], a[136:139], a[80:83], v[116:119]
ds_read_b64_tr_b16 a[132:133], v24 offset:16384
v_mfma_f32_16x16x32_bf16 v[116:119], a[140:143], a[84:87], v[116:119]
v_mfma_f32_16x16x32_bf16 v[124:127], a[136:139], a[88:91], v[124:127]
ds_read_b64_tr_b16 a[134:135], v24 offset:18432
v_add_u32 v24, 4294901760, v24
v_mfma_f32_16x16x32_bf16 v[124:127], a[140:143], a[92:95], v[124:127]
v_mfma_f32_16x16x32_bf16 v[132:135], a[136:139], a[96:99], v[132:135]
ds_read_b128 a[32:35], v2 offset:8192
v_mfma_f32_16x16x32_bf16 v[132:135], a[140:143], a[100:103], v[132:135]
buffer_store_dwordx4 v[216:219], v1, s[4:7], s31 offen sc1
v_mfma_f32_16x16x32_bf16 v[140:143], a[136:139], a[104:107], v[140:143]
s_add_u32 s31, s31, s35
ds_read_b128 a[36:39], v3 offset:8192
v_mfma_f32_16x16x32_bf16 v[140:143], a[140:143], a[108:111], v[140:143]
ds_read_b128 a[40:43], v2 offset:10240
v_mfma_f32_16x16x32_bf16 v[148:151], a[136:139], a[112:115], v[148:151]
ds_read_b128 a[44:47], v3 offset:10240
v_mfma_f32_16x16x32_bf16 v[148:151], a[140:143], a[116:119], v[148:151]
v_mfma_f32_16x16x32_bf16 v[156:159], a[136:139], a[120:123], v[156:159]
ds_read_b128 a[48:51], v2 offset:12288
v_mfma_f32_16x16x32_bf16 v[156:159], a[140:143], a[124:127], v[156:159]
s_waitcnt lgkmcnt(5)
v_mfma_f32_16x16x32_bf16 v[164:167], a[128:131], a[64:67], v[164:167]
ds_read_b64_tr_b16 a[136:137], v25 offset:0
v_mfma_f32_16x16x32_bf16 v[164:167], a[132:135], a[68:71], v[164:167]
v_mfma_f32_16x16x32_bf16 v[172:175], a[128:131], a[72:75], v[172:175]
ds_read_b64_tr_b16 a[138:139], v25 offset:2048
v_mfma_f32_16x16x32_bf16 v[172:175], a[132:135], a[76:79], v[172:175]
ds_read_b128 a[52:55], v3 offset:12288
v_mfma_f32_16x16x32_bf16 v[180:183], a[128:131], a[80:83], v[180:183]
ds_read_b64_tr_b16 a[140:141], v25 offset:16384
v_mfma_f32_16x16x32_bf16 v[180:183], a[132:135], a[84:87], v[180:183]
buffer_store_dwordx4 v[32:35], v1, s[4:7], s31 offen sc1
v_mfma_f32_16x16x32_bf16 v[188:191], a[128:131], a[88:91], v[188:191]
s_add_u32 s31, s31, s32
ds_read_b64_tr_b16 a[142:143], v25 offset:18432
v_add_u32 v25, 4294901760, v25
v_mfma_f32_16x16x32_bf16 v[188:191], a[132:135], a[92:95], v[188:191]
v_mfma_f32_16x16x32_bf16 v[196:199], a[128:131], a[96:99], v[196:199]
ds_read_b128 a[56:59], v2 offset:14336
v_mfma_f32_16x16x32_bf16 v[196:199], a[132:135], a[100:103], v[196:199]
v_mfma_f32_16x16x32_bf16 v[204:207], a[128:131], a[104:107], v[204:207]
ds_read_b128 a[60:63], v3 offset:14336
v_mfma_f32_16x16x32_bf16 v[204:207], a[132:135], a[108:111], v[204:207]
v_mfma_f32_16x16x32_bf16 v[212:215], a[128:131], a[112:115], v[212:215]
v_mfma_f32_16x16x32_bf16 v[212:215], a[132:135], a[116:119], v[212:215]
v_mfma_f32_16x16x32_bf16 v[220:223], a[128:131], a[120:123], v[220:223]
v_mfma_f32_16x16x32_bf16 v[220:223], a[132:135], a[124:127], v[220:223]
s_waitcnt vmcnt(20) lgkmcnt(0)
s_barrier
v_mfma_f32_16x16x32_bf16 v[224:227], a[136:139], a[64:67], v[224:227]
s_add_u32 m0, s29, 131072
ds_read_b64_tr_b16 a[128:129], v22 offset:0
v_mfma_f32_16x16x32_bf16 v[224:227], a[140:143], a[68:71], v[224:227]
buffer_load_dwordx4 v16, s[12:15], s26 offen offset:0 lds
v_mfma_f32_16x16x32_bf16 v[228:231], a[136:139], a[72:75], v[228:231]
ds_read_b64_tr_b16 a[130:131], v22 offset:2048
v_mfma_f32_16x16x32_bf16 v[228:231], a[140:143], a[76:79], v[228:231]
buffer_store_dwordx4 v[40:43], v1, s[4:7], s31 offen sc1
v_mfma_f32_16x16x32_bf16 v[232:235], a[136:139], a[80:83], v[232:235]
s_add_u32 s31, s31, s33
ds_read_b64_tr_b16 a[132:133], v22 offset:16384
v_mfma_f32_16x16x32_bf16 v[232:235], a[140:143], a[84:87], v[232:235]
buffer_load_dwordx4 v17, s[12:15], s26 offen offset:1024 lds
v_mfma_f32_16x16x32_bf16 v[236:239], a[136:139], a[88:91], v[236:239]
ds_read_b64_tr_b16 a[134:135], v22 offset:18432
v_add_u32 v22, 32768, v22
v_mfma_f32_16x16x32_bf16 v[236:239], a[140:143], a[92:95], v[236:239]
v_mfma_f32_16x16x32_bf16 v[240:243], a[136:139], a[96:99], v[240:243]
v_mfma_f32_16x16x32_bf16 v[240:243], a[140:143], a[100:103], v[240:243]
buffer_load_dwordx4 v18, s[12:15], s26 offen offset:2048 lds
v_mfma_f32_16x16x32_bf16 v[244:247], a[136:139], a[104:107], v[244:247]
v_mfma_f32_16x16x32_bf16 v[244:247], a[140:143], a[108:111], v[244:247]
v_mfma_f32_16x16x32_bf16 v[248:251], a[136:139], a[112:115], v[248:251]
v_mfma_f32_16x16x32_bf16 v[248:251], a[140:143], a[116:119], v[248:251]
buffer_load_dwordx4 v19, s[12:15], s26 offen offset:3072 lds
v_mfma_f32_16x16x32_bf16 v[252:255], a[136:139], a[120:123], v[252:255]
s_add_u32 s26, s26, 524288
v_mfma_f32_16x16x32_bf16 v[252:255], a[140:143], a[124:127], v[252:255]
s_waitcnt lgkmcnt(0)
v_mfma_f32_16x16x32_bf16 v[36:39], a[128:131], a[0:3], v[36:39]
s_add_u32 m0, s29, 147456
ds_read_b64_tr_b16 a[136:137], v23 offset:0
v_mfma_f32_16x16x32_bf16 v[36:39], a[132:135], a[4:7], v[36:39]
buffer_load_dwordx4 v16, s[12:15], s27 offen offset:0 lds
v_mfma_f32_16x16x32_bf16 v[44:47], a[128:131], a[8:11], v[44:47]
s_lshl_b32 s22, s20, 7
ds_read_b64_tr_b16 a[138:139], v23 offset:2048
v_bfe_u32 v20, v1, 4, 3
v_mfma_f32_16x16x32_bf16 v[44:47], a[132:135], a[12:15], v[44:47]
s_add_u32 s70, s22, 94371840
ds_read_b128 a[64:67], v2 offset:16384
ds_read_b128 a[68:71], v3 offset:16384
v_mfma_f32_16x16x32_bf16 v[52:55], a[128:131], a[16:19], v[52:55]
s_lshr_b32 s22, s2, 4
ds_read_b64_tr_b16 a[140:141], v23 offset:16384
v_lshlrev_b32 v20, 3, v20
v_mfma_f32_16x16x32_bf16 v[52:55], a[132:135], a[20:23], v[52:55]
s_lshl_b32 s22, s22, 2
buffer_load_dwordx4 v17, s[12:15], s27 offen offset:1024 lds
v_mfma_f32_16x16x32_bf16 v[60:63], a[128:131], a[24:27], v[60:63]
s_add_u32 s66, s70, s22
ds_read_b64_tr_b16 a[142:143], v23 offset:18432
v_add_u32 v23, 32768, v23
v_mfma_f32_16x16x32_bf16 v[60:63], a[132:135], a[28:31], v[60:63]
s_and_b32 s22, s2, 16
buffer_store_dwordx4 v[48:51], v1, s[4:7], s31 offen sc1
v_mfma_f32_16x16x32_bf16 v[68:71], a[128:131], a[32:35], v[68:71]
s_add_u32 s31, s31, s32
ds_read_b128 a[72:75], v2 offset:18432
v_add_u32 v15, 2052, v20
v_mfma_f32_16x16x32_bf16 v[68:71], a[132:135], a[36:39], v[68:71]
s_lshl_b32 s22, s22, 7
buffer_load_dwordx4 v18, s[12:15], s27 offen offset:2048 lds
v_mfma_f32_16x16x32_bf16 v[76:79], a[128:131], a[40:43], v[76:79]
s_add_u32 s66, s66, s22
ds_read_b128 a[76:79], v3 offset:18432
v_mfma_f32_16x16x32_bf16 v[76:79], a[132:135], a[44:47], v[76:79]
s_lshl_b32 s67, s20, 20
ds_read_b128 a[80:83], v2 offset:20480
v_mfma_f32_16x16x32_bf16 v[84:87], a[128:131], a[48:51], v[84:87]
s_lshl_b32 s22, s37, 16
ds_read_b128 a[84:87], v3 offset:20480
v_mfma_f32_16x16x32_bf16 v[84:87], a[132:135], a[52:55], v[84:87]
s_add_u32 s67, s67, s22
buffer_load_dwordx4 v19, s[12:15], s27 offen offset:3072 lds
v_mfma_f32_16x16x32_bf16 v[92:95], a[128:131], a[56:59], v[92:95]
s_waitcnt lgkmcnt(5)
s_add_u32 s27, s27, 524288
ds_read_b128 a[88:91], v2 offset:22528
v_mfma_f32_16x16x32_bf16 v[92:95], a[132:135], a[60:63], v[92:95]
s_lshl_b32 s22, s3, 11
buffer_store_dwordx4 v[56:59], v1, s[4:7], s31 offen sc1
v_mfma_f32_16x16x32_bf16 v[100:103], a[136:139], a[0:3], v[100:103]
s_waitcnt lgkmcnt(5)
s_add_u32 s31, s31, s34
ds_read_b64_tr_b16 a[128:129], v24 offset:0
v_mfma_f32_16x16x32_bf16 v[100:103], a[140:143], a[4:7], v[100:103]
s_add_u32 s67, s67, s22
v_mfma_f32_16x16x32_bf16 v[108:111], a[136:139], a[8:11], v[108:111]
s_add_u32 s67, s67, 33554432
ds_read_b64_tr_b16 a[130:131], v24 offset:2048
v_mfma_f32_16x16x32_bf16 v[108:111], a[140:143], a[12:15], v[108:111]
s_mov_b32 s68, 1035512379
ds_read_b128 a[92:95], v3 offset:22528
v_mfma_f32_16x16x32_bf16 v[116:119], a[136:139], a[16:19], v[116:119]
s_mov_b32 s69, 1035512379
ds_read_b64_tr_b16 a[132:133], v24 offset:16384
v_mfma_f32_16x16x32_bf16 v[116:119], a[140:143], a[20:23], v[116:119]
buffer_store_dwordx4 v[64:67], v1, s[4:7], s31 offen sc1
v_mfma_f32_16x16x32_bf16 v[124:127], a[136:139], a[24:27], v[124:127]
s_add_u32 s31, s31, s32
ds_read_b64_tr_b16 a[134:135], v24 offset:18432
v_add_u32 v24, 32768, v24
v_mfma_f32_16x16x32_bf16 v[124:127], a[140:143], a[28:31], v[124:127]
v_mfma_f32_16x16x32_bf16 v[132:135], a[136:139], a[32:35], v[132:135]
ds_read_b128 a[96:99], v2 offset:24576
v_mfma_f32_16x16x32_bf16 v[132:135], a[140:143], a[36:39], v[132:135]
v_mfma_f32_16x16x32_bf16 v[140:143], a[136:139], a[40:43], v[140:143]
ds_read_b128 a[100:103], v3 offset:24576
v_mfma_f32_16x16x32_bf16 v[140:143], a[140:143], a[44:47], v[140:143]
ds_read_b128 a[104:107], v2 offset:26624
v_mfma_f32_16x16x32_bf16 v[148:151], a[136:139], a[48:51], v[148:151]
ds_read_b128 a[108:111], v3 offset:26624
v_mfma_f32_16x16x32_bf16 v[148:151], a[140:143], a[52:55], v[148:151]
v_mfma_f32_16x16x32_bf16 v[156:159], a[136:139], a[56:59], v[156:159]
ds_read_b128 a[112:115], v2 offset:28672
v_mfma_f32_16x16x32_bf16 v[156:159], a[140:143], a[60:63], v[156:159]
s_waitcnt lgkmcnt(5)
buffer_store_dwordx4 v[72:75], v1, s[4:7], s31 offen sc1
v_mfma_f32_16x16x32_bf16 v[164:167], a[128:131], a[0:3], v[164:167]
s_add_u32 s31, s31, s33
ds_read_b64_tr_b16 a[136:137], v25 offset:0
v_mfma_f32_16x16x32_bf16 v[164:167], a[132:135], a[4:7], v[164:167]
v_mfma_f32_16x16x32_bf16 v[172:175], a[128:131], a[8:11], v[172:175]
ds_read_b64_tr_b16 a[138:139], v25 offset:2048
v_mfma_f32_16x16x32_bf16 v[172:175], a[132:135], a[12:15], v[172:175]
ds_read_b128 a[116:119], v3 offset:28672
v_mfma_f32_16x16x32_bf16 v[180:183], a[128:131], a[16:19], v[180:183]
ds_read_b64_tr_b16 a[140:141], v25 offset:16384
v_mfma_f32_16x16x32_bf16 v[180:183], a[132:135], a[20:23], v[180:183]
v_mfma_f32_16x16x32_bf16 v[188:191], a[128:131], a[24:27], v[188:191]
ds_read_b64_tr_b16 a[142:143], v25 offset:18432
v_add_u32 v25, 32768, v25
v_mfma_f32_16x16x32_bf16 v[188:191], a[132:135], a[28:31], v[188:191]
v_mfma_f32_16x16x32_bf16 v[196:199], a[128:131], a[32:35], v[196:199]
ds_read_b128 a[120:123], v2 offset:30720
v_mfma_f32_16x16x32_bf16 v[196:199], a[132:135], a[36:39], v[196:199]
buffer_store_dwordx4 v[80:83], v1, s[4:7], s31 offen sc1
v_mfma_f32_16x16x32_bf16 v[204:207], a[128:131], a[40:43], v[204:207]
s_add_u32 s31, s31, s32
ds_read_b128 a[124:127], v3 offset:30720
v_mfma_f32_16x16x32_bf16 v[204:207], a[132:135], a[44:47], v[204:207]
v_mfma_f32_16x16x32_bf16 v[212:215], a[128:131], a[48:51], v[212:215]
v_mfma_f32_16x16x32_bf16 v[212:215], a[132:135], a[52:55], v[212:215]
v_mfma_f32_16x16x32_bf16 v[220:223], a[128:131], a[56:59], v[220:223]
v_mfma_f32_16x16x32_bf16 v[220:223], a[132:135], a[60:63], v[220:223]
s_waitcnt vmcnt(17) lgkmcnt(0)
s_barrier
v_mfma_f32_16x16x32_bf16 v[224:227], a[136:139], a[0:3], v[224:227]
ds_read_b64_tr_b16 a[128:129], v22 offset:0
v_mfma_f32_16x16x32_bf16 v[224:227], a[140:143], a[4:7], v[224:227]
v_mfma_f32_16x16x32_bf16 v[228:231], a[136:139], a[8:11], v[228:231]
ds_read_b64_tr_b16 a[130:131], v22 offset:2048
v_mfma_f32_16x16x32_bf16 v[228:231], a[140:143], a[12:15], v[228:231]
buffer_store_dwordx4 v[88:91], v1, s[4:7], s31 offen sc1
v_mfma_f32_16x16x32_bf16 v[232:235], a[136:139], a[16:19], v[232:235]
ds_read_b64_tr_b16 a[132:133], v22 offset:16384
v_mfma_f32_16x16x32_bf16 v[232:235], a[140:143], a[20:23], v[232:235]
v_mfma_f32_16x16x32_bf16 v[236:239], a[136:139], a[24:27], v[236:239]
ds_read_b64_tr_b16 a[134:135], v22 offset:18432
v_add_u32 v22, 32768, v22
v_mfma_f32_16x16x32_bf16 v[236:239], a[140:143], a[28:31], v[236:239]
v_mfma_f32_16x16x32_bf16 v[240:243], a[136:139], a[32:35], v[240:243]
v_mfma_f32_16x16x32_bf16 v[240:243], a[140:143], a[36:39], v[240:243]
v_mfma_f32_16x16x32_bf16 v[244:247], a[136:139], a[40:43], v[244:247]
v_mfma_f32_16x16x32_bf16 v[244:247], a[140:143], a[44:47], v[244:247]
v_mfma_f32_16x16x32_bf16 v[248:251], a[136:139], a[48:51], v[248:251]
v_mfma_f32_16x16x32_bf16 v[248:251], a[140:143], a[52:55], v[248:251]
v_mfma_f32_16x16x32_bf16 v[252:255], a[136:139], a[56:59], v[252:255]
v_mfma_f32_16x16x32_bf16 v[252:255], a[140:143], a[60:63], v[252:255]
s_waitcnt lgkmcnt(0)
v_mfma_f32_16x16x32_bf16 v[36:39], a[128:131], a[64:67], v[36:39]
ds_read_b64_tr_b16 a[136:137], v23 offset:0
v_and_b32 v14, 128, v1
v_mfma_f32_16x16x32_bf16 v[36:39], a[132:135], a[68:71], v[36:39]
v_mul_u32_u24 v14, 2, v14
v_add_u32 v20, v14, v20
v_mfma_f32_16x16x32_bf16 v[44:47], a[128:131], a[72:75], v[44:47]
s_mul_i32 s85, s20, 7
ds_read_b64_tr_b16 a[138:139], v23 offset:2048
v_add_u32 v15, v14, v15
v_mfma_f32_16x16x32_bf16 v[44:47], a[132:135], a[76:79], v[44:47]
s_add_u32 s85, s85, s21
ds_read_b128 a[0:3], v2 offset:32768
ds_read_b128 a[4:7], v3 offset:32768
v_mfma_f32_16x16x32_bf16 v[52:55], a[128:131], a[80:83], v[52:55]
s_lshl_b32 s85, s85, 2
ds_read_b64_tr_b16 a[140:141], v23 offset:16384
v_mfma_f32_16x16x32_bf16 v[52:55], a[132:135], a[84:87], v[52:55]
s_add_u32 s85, s85, s3
v_mfma_f32_16x16x32_bf16 v[60:63], a[128:131], a[88:91], v[60:63]
s_mul_i32 s82, s85, 4224
ds_read_b64_tr_b16 a[142:143], v23 offset:18432
v_add_u32 v23, 32768, v23
v_mfma_f32_16x16x32_bf16 v[60:63], a[132:135], a[92:95], v[60:63]
s_add_u32 s82, s82, 83886208
v_mfma_f32_16x16x32_bf16 v[68:71], a[128:131], a[96:99], v[68:71]
s_lshl_b32 s83, s85, 12
ds_read_b128 a[8:11], v2 offset:34816
v_mfma_f32_16x16x32_bf16 v[68:71], a[132:135], a[100:103], v[68:71]
s_mul_i32 s84, s3, 21248
v_mfma_f32_16x16x32_bf16 v[76:79], a[128:131], a[104:107], v[76:79]
s_add_u32 s84, s84, 46080
ds_read_b128 a[12:15], v3 offset:34816
v_mfma_f32_16x16x32_bf16 v[76:79], a[132:135], a[108:111], v[76:79]
s_mov_b64 s[60:61], s[72:73]
ds_read_b128 a[16:19], v2 offset:36864
v_mfma_f32_16x16x32_bf16 v[84:87], a[128:131], a[112:115], v[84:87]
s_mov_b32 s62, 1835008
ds_read_b128 a[20:23], v3 offset:36864
v_mfma_f32_16x16x32_bf16 v[84:87], a[132:135], a[116:119], v[84:87]
v_mfma_f32_16x16x32_bf16 v[92:95], a[128:131], a[120:123], v[92:95]
ds_read_b128 a[24:27], v2 offset:38912
v_mfma_f32_16x16x32_bf16 v[92:95], a[132:135], a[124:127], v[92:95]
s_waitcnt lgkmcnt(5)
v_mfma_f32_16x16x32_bf16 v[100:103], a[136:139], a[64:67], v[100:103]
ds_read_b64_tr_b16 a[128:129], v24 offset:0
v_mfma_f32_16x16x32_bf16 v[100:103], a[140:143], a[68:71], v[100:103]
v_mfma_f32_16x16x32_bf16 v[108:111], a[136:139], a[72:75], v[108:111]
ds_read_b64_tr_b16 a[130:131], v24 offset:2048
v_mfma_f32_16x16x32_bf16 v[108:111], a[140:143], a[76:79], v[108:111]
ds_read_b128 a[28:31], v3 offset:38912
v_mfma_f32_16x16x32_bf16 v[116:119], a[136:139], a[80:83], v[116:119]
ds_read_b64_tr_b16 a[132:133], v24 offset:16384
v_mfma_f32_16x16x32_bf16 v[116:119], a[140:143], a[84:87], v[116:119]
v_mfma_f32_16x16x32_bf16 v[124:127], a[136:139], a[88:91], v[124:127]
ds_read_b64_tr_b16 a[134:135], v24 offset:18432
v_add_u32 v24, 32768, v24
v_mfma_f32_16x16x32_bf16 v[124:127], a[140:143], a[92:95], v[124:127]
v_mfma_f32_16x16x32_bf16 v[132:135], a[136:139], a[96:99], v[132:135]
ds_read_b128 a[32:35], v2 offset:40960
v_mfma_f32_16x16x32_bf16 v[132:135], a[140:143], a[100:103], v[132:135]
v_mfma_f32_16x16x32_bf16 v[140:143], a[136:139], a[104:107], v[140:143]
ds_read_b128 a[36:39], v3 offset:40960
v_mfma_f32_16x16x32_bf16 v[140:143], a[140:143], a[108:111], v[140:143]
ds_read_b128 a[40:43], v2 offset:43008
v_mfma_f32_16x16x32_bf16 v[148:151], a[136:139], a[112:115], v[148:151]
ds_read_b128 a[44:47], v3 offset:43008
v_mfma_f32_16x16x32_bf16 v[148:151], a[140:143], a[116:119], v[148:151]
v_mfma_f32_16x16x32_bf16 v[156:159], a[136:139], a[120:123], v[156:159]
s_andn2_b32 s31, s70, 256
ds_read_b128 a[48:51], v2 offset:45056
v_mfma_f32_16x16x32_bf16 v[156:159], a[140:143], a[124:127], v[156:159]
s_waitcnt lgkmcnt(5)
v_mfma_f32_16x16x32_bf16 v[164:167], a[128:131], a[64:67], v[164:167]
ds_read_b64_tr_b16 a[136:137], v25 offset:0
v_mfma_f32_16x16x32_bf16 v[164:167], a[132:135], a[68:71], v[164:167]
PAD_29:
s_cbranch_execz M_tret
v_mfma_f32_16x16x32_bf16 v[172:175], a[128:131], a[72:75], v[172:175]
ds_read_b64_tr_b16 a[138:139], v25 offset:2048
v_mfma_f32_16x16x32_bf16 v[172:175], a[132:135], a[76:79], v[172:175]
ds_read_b128 a[52:55], v3 offset:45056
v_mfma_f32_16x16x32_bf16 v[180:183], a[128:131], a[80:83], v[180:183]
ds_read_b64_tr_b16 a[140:141], v25 offset:16384
v_mfma_f32_16x16x32_bf16 v[180:183], a[132:135], a[84:87], v[180:183]
v_mfma_f32_16x16x32_bf16 v[188:191], a[128:131], a[88:91], v[188:191]
ds_read_b64_tr_b16 a[142:143], v25 offset:18432
v_add_u32 v25, 32768, v25
v_mfma_f32_16x16x32_bf16 v[188:191], a[132:135], a[92:95], v[188:191]
v_mfma_f32_16x16x32_bf16 v[196:199], a[128:131], a[96:99], v[196:199]
ds_read_b128 a[56:59], v2 offset:47104
v_mfma_f32_16x16x32_bf16 v[196:199], a[132:135], a[100:103], v[196:199]
v_mfma_f32_16x16x32_bf16 v[204:207], a[128:131], a[104:107], v[204:207]
ds_read_b128 a[60:63], v3 offset:47104
v_mfma_f32_16x16x32_bf16 v[204:207], a[132:135], a[108:111], v[204:207]
v_mfma_f32_16x16x32_bf16 v[212:215], a[128:131], a[112:115], v[212:215]
v_mfma_f32_16x16x32_bf16 v[212:215], a[132:135], a[116:119], v[212:215]
v_mfma_f32_16x16x32_bf16 v[220:223], a[128:131], a[120:123], v[220:223]
v_mfma_f32_16x16x32_bf16 v[220:223], a[132:135], a[124:127], v[220:223]
s_waitcnt vmcnt(0) lgkmcnt(0)
s_barrier
v_mfma_f32_16x16x32_bf16 v[224:227], a[136:139], a[64:67], v[224:227]
ds_read_b64_tr_b16 a[128:129], v22 offset:0
v_mfma_f32_16x16x32_bf16 v[224:227], a[140:143], a[68:71], v[224:227]
buffer_store_dword v27, v26, s[4:7], s66 offen sc1
v_mfma_f32_16x16x32_bf16 v[228:231], a[136:139], a[72:75], v[228:231]
ds_read_b64_tr_b16 a[130:131], v22 offset:2048
v_mfma_f32_16x16x32_bf16 v[228:231], a[140:143], a[76:79], v[228:231]
v_mfma_f32_16x16x32_bf16 v[232:235], a[136:139], a[80:83], v[232:235]
ds_read_b64_tr_b16 a[132:133], v22 offset:16384
v_mfma_f32_16x16x32_bf16 v[232:235], a[140:143], a[84:87], v[232:235]
v_mfma_f32_16x16x32_bf16 v[236:239], a[136:139], a[88:91], v[236:239]
ds_read_b64_tr_b16 a[134:135], v22 offset:18432
v_mfma_f32_16x16x32_bf16 v[236:239], a[140:143], a[92:95], v[236:239]
v_mfma_f32_16x16x32_bf16 v[240:243], a[136:139], a[96:99], v[240:243]
v_mfma_f32_16x16x32_bf16 v[240:243], a[140:143], a[100:103], v[240:243]
v_mfma_f32_16x16x32_bf16 v[244:247], a[136:139], a[104:107], v[244:247]
v_mfma_f32_16x16x32_bf16 v[244:247], a[140:143], a[108:111], v[244:247]
v_mfma_f32_16x16x32_bf16 v[248:251], a[136:139], a[112:115], v[248:251]
v_mfma_f32_16x16x32_bf16 v[248:251], a[140:143], a[116:119], v[248:251]
v_mfma_f32_16x16x32_bf16 v[252:255], a[136:139], a[120:123], v[252:255]
v_mfma_f32_16x16x32_bf16 v[252:255], a[140:143], a[124:127], v[252:255]
s_waitcnt lgkmcnt(0)
v_mfma_f32_16x16x32_bf16 v[36:39], a[128:131], a[0:3], v[36:39]
s_add_u32 m0, s84, 17152
ds_read_b64_tr_b16 a[136:137], v23 offset:0
v_lshrrev_b32 v9, 4, v1
v_mfma_f32_16x16x32_bf16 v[36:39], a[132:135], a[4:7], v[36:39]
buffer_load_dwordx4 v1, s[60:63], s83 offen offset:0 lds
v_mfma_f32_16x16x32_bf16 v[44:47], a[128:131], a[8:11], v[44:47]
ds_read_b64_tr_b16 a[138:139], v23 offset:2048
v_and_b32 v10, 15, v9
v_mfma_f32_16x16x32_bf16 v[44:47], a[132:135], a[12:15], v[44:47]
buffer_load_dwordx4 v1, s[60:63], s83 offen offset:1024 lds
v_mfma_f32_16x16x32_bf16 v[52:55], a[128:131], a[16:19], v[52:55]
ds_read_b64_tr_b16 a[140:141], v23 offset:16384
v_lshrrev_b32 v11, 4, v9
v_mfma_f32_16x16x32_bf16 v[52:55], a[132:135], a[20:23], v[52:55]
buffer_load_dwordx4 v1, s[60:63], s83 offen offset:2048 lds
v_mfma_f32_16x16x32_bf16 v[60:63], a[128:131], a[24:27], v[60:63]
ds_read_b64_tr_b16 a[142:143], v23 offset:18432
v_lshrrev_b32 v12, 2, v10
v_mfma_f32_16x16x32_bf16 v[60:63], a[132:135], a[28:31], v[60:63]
buffer_load_dwordx4 v1, s[60:63], s83 offen offset:3072 lds
v_mfma_f32_16x16x32_bf16 v[68:71], a[128:131], a[32:35], v[68:71]
s_add_u32 m0, s84, 64
v_mul_u32_u24 v12, 4160, v12
v_and_b32 v13, 3, v9
v_mfma_f32_16x16x32_bf16 v[68:71], a[132:135], a[36:39], v[68:71]
buffer_load_dwordx4 v1, s[4:7], s82 offen offset:0 sc1 lds
v_mfma_f32_16x16x32_bf16 v[76:79], a[128:131], a[40:43], v[76:79]
buffer_load_dwordx4 v1, s[4:7], s82 offen offset:1024 sc1 lds
v_mfma_f32_16x16x32_bf16 v[76:79], a[132:135], a[44:47], v[76:79]
buffer_load_dwordx4 v1, s[4:7], s82 offen offset:2048 sc1 lds
v_mfma_f32_16x16x32_bf16 v[84:87], a[128:131], a[48:51], v[84:87]
buffer_load_dwordx4 v1, s[4:7], s82 offen offset:3072 sc1 lds
v_mfma_f32_16x16x32_bf16 v[84:87], a[132:135], a[52:55], v[84:87]
s_add_u32 s82, s82, 2097152
v_lshl_add_u32 v12, v13, 3, v12
v_lshlrev_b32 v13, 4, v11
v_mfma_f32_16x16x32_bf16 v[92:95], a[128:131], a[56:59], v[92:95]
s_add_u32 m0, s84, 4224
v_sub_u32 v12, v12, v13
v_add_u32 v12, 88, v12
v_mfma_f32_16x16x32_bf16 v[92:95], a[132:135], a[60:63], v[92:95]
s_waitcnt lgkmcnt(0)
buffer_load_dwordx4 v1, s[4:7], s82 offen offset:0 sc1 lds
v_mfma_f32_16x16x32_bf16 v[100:103], a[136:139], a[0:3], v[100:103]
ds_read_b64_tr_b16 a[128:129], v24 offset:0
v_add_u32 v16, s84, v12
v_mfma_f32_16x16x32_bf16 v[100:103], a[140:143], a[4:7], v[100:103]
buffer_load_dwordx4 v1, s[4:7], s82 offen offset:1024 sc1 lds
v_mfma_f32_16x16x32_bf16 v[108:111], a[136:139], a[8:11], v[108:111]
ds_read_b64_tr_b16 a[130:131], v24 offset:2048
v_lshl_add_u32 v12, v10, 5, v13
v_mfma_f32_16x16x32_bf16 v[108:111], a[140:143], a[12:15], v[108:111]
buffer_load_dwordx4 v1, s[4:7], s82 offen offset:2048 sc1 lds
v_mfma_f32_16x16x32_bf16 v[116:119], a[136:139], a[16:19], v[116:119]
ds_read_b64_tr_b16 a[132:133], v24 offset:16384
v_add_u32 v12, 16672, v12
v_mfma_f32_16x16x32_bf16 v[116:119], a[140:143], a[20:23], v[116:119]
buffer_load_dwordx4 v1, s[4:7], s82 offen offset:3072 sc1 lds
v_mfma_f32_16x16x32_bf16 v[124:127], a[136:139], a[24:27], v[124:127]
s_add_u32 s82, s82, 4292870140
ds_read_b64_tr_b16 a[134:135], v24 offset:18432
v_add_u32 v17, s84, v12
v_mfma_f32_16x16x32_bf16 v[124:127], a[140:143], a[28:31], v[124:127]
s_add_u32 m0, s84, 8384
v_lshlrev_b32 v12, 5, v10
v_lshl_add_u32 v8, v11, 3, v12
v_mfma_f32_16x16x32_bf16 v[132:135], a[136:139], a[32:35], v[132:135]
buffer_load_dwordx4 v1, s[4:7], s82 offen offset:0 sc1 lds
v_mfma_f32_16x16x32_bf16 v[132:135], a[140:143], a[36:39], v[132:135]
buffer_load_dwordx4 v1, s[4:7], s82 offen offset:1024 sc1 lds
v_mfma_f32_16x16x32_bf16 v[140:143], a[136:139], a[40:43], v[140:143]
buffer_load_dwordx4 v1, s[4:7], s82 offen offset:2048 sc1 lds
v_mfma_f32_16x16x32_bf16 v[140:143], a[140:143], a[44:47], v[140:143]
buffer_load_dwordx4 v1, s[4:7], s82 offen offset:3072 sc1 lds
v_mfma_f32_16x16x32_bf16 v[148:151], a[136:139], a[48:51], v[148:151]
s_add_u32 s82, s82, 2097152
v_add3_u32 v18, s84, 64, v8
v_mov_b32 v19, 0
v_mfma_f32_16x16x32_bf16 v[148:151], a[140:143], a[52:55], v[148:151]
s_add_u32 m0, s84, 12544
v_mov_b32 v12, 0
v_mov_b32 v13, 0
v_mfma_f32_16x16x32_bf16 v[156:159], a[136:139], a[56:59], v[156:159]
buffer_load_dwordx4 v1, s[4:7], s82 offen offset:0 sc1 lds
v_mfma_f32_16x16x32_bf16 v[156:159], a[140:143], a[60:63], v[156:159]
s_waitcnt lgkmcnt(0)
buffer_load_dwordx4 v1, s[4:7], s82 offen offset:1024 sc1 lds
v_mfma_f32_16x16x32_bf16 v[164:167], a[128:131], a[0:3], v[164:167]
ds_read_b64_tr_b16 a[136:137], v25 offset:0
v_lshl_add_u32 v14, v9, 3, s84
v_mfma_f32_16x16x32_bf16 v[164:167], a[132:135], a[4:7], v[164:167]
buffer_load_dwordx4 v1, s[4:7], s82 offen offset:2048 sc1 lds
v_mfma_f32_16x16x32_bf16 v[172:175], a[128:131], a[8:11], v[172:175]
ds_read_b64_tr_b16 a[138:139], v25 offset:2048
v_mfma_f32_16x16x32_bf16 v[172:175], a[132:135], a[12:15], v[172:175]
buffer_load_dwordx4 v1, s[4:7], s82 offen offset:3072 sc1 lds
v_mfma_f32_16x16x32_bf16 v[180:183], a[128:131], a[16:19], v[180:183]
ds_read_b64_tr_b16 a[140:141], v25 offset:16384
v_mfma_f32_16x16x32_bf16 v[180:183], a[132:135], a[20:23], v[180:183]
ds_write_b64 v14, v[12:13] offset:16640
v_mul_u32_u24 v14, 4160, v11
v_mfma_f32_16x16x32_bf16 v[188:191], a[128:131], a[24:27], v[188:191]
ds_read_b64_tr_b16 a[142:143], v25 offset:18432
v_lshl_add_u32 v14, v10, 2, v14
v_mfma_f32_16x16x32_bf16 v[188:191], a[132:135], a[28:31], v[188:191]
v_add_u32 v14, s84, v14
v_mfma_f32_16x16x32_bf16 v[196:199], a[128:131], a[32:35], v[196:199]
ds_write_b32 v14, v12
v_lshrrev_b32 v30, 6, v0
v_mfma_f32_16x16x32_bf16 v[196:199], a[132:135], a[36:39], v[196:199]
v_lshl_add_u32 v28, v30, 11, v1
v_add_u32 v29, 0x20000, v28
v_mfma_f32_16x16x32_bf16 v[204:207], a[128:131], a[40:43], v[204:207]
v_lshl_add_u32 v30, v30, 13, v1
v_add_u32 v31, 0x20000, v30
v_mfma_f32_16x16x32_bf16 v[204:207], a[132:135], a[44:47], v[204:207]
v_mul_f32 v36, s68, v36
v_mul_f32 v37, s68, v37
v_mfma_f32_16x16x32_bf16 v[212:215], a[128:131], a[48:51], v[212:215]
v_mul_f32 v38, s68, v38
v_mul_f32 v39, s68, v39
v_mfma_f32_16x16x32_bf16 v[212:215], a[132:135], a[52:55], v[212:215]
v_mul_f32 v100, s68, v100
v_mul_f32 v101, s68, v101
v_mfma_f32_16x16x32_bf16 v[220:223], a[128:131], a[56:59], v[220:223]
v_mul_f32 v102, s68, v102
v_mul_f32 v103, s68, v103
v_mfma_f32_16x16x32_bf16 v[220:223], a[132:135], a[60:63], v[220:223]
s_waitcnt lgkmcnt(0)
s_waitcnt lgkmcnt(0)
s_barrier
v_mfma_f32_16x16x32_bf16 v[224:227], a[136:139], a[0:3], v[224:227]
v_cvt_pk_bf16_f32 v36, v36, v37
v_cvt_pk_bf16_f32 v37, v38, v39
v_mfma_f32_16x16x32_bf16 v[224:227], a[140:143], a[4:7], v[224:227]
v_cvt_pk_bf16_f32 v38, v100, v101
v_cvt_pk_bf16_f32 v39, v102, v103
v_mfma_f32_16x16x32_bf16 v[228:231], a[136:139], a[8:11], v[228:231]
v_mul_f32 v44, s68, v44
v_mul_f32 v45, s68, v45
v_mfma_f32_16x16x32_bf16 v[228:231], a[140:143], a[12:15], v[228:231]
v_mul_f32 v46, s68, v46
v_mul_f32 v47, s68, v47
v_mfma_f32_16x16x32_bf16 v[232:235], a[136:139], a[16:19], v[232:235]
v_mul_f32 v108, s68, v108
v_mul_f32 v109, s68, v109
v_mfma_f32_16x16x32_bf16 v[232:235], a[140:143], a[20:23], v[232:235]
v_mul_f32 v110, s68, v110
v_mul_f32 v111, s68, v111
v_mfma_f32_16x16x32_bf16 v[236:239], a[136:139], a[24:27], v[236:239]
v_cvt_pk_bf16_f32 v44, v44, v45
v_cvt_pk_bf16_f32 v45, v46, v47
v_mfma_f32_16x16x32_bf16 v[236:239], a[140:143], a[28:31], v[236:239]
v_cvt_pk_bf16_f32 v46, v108, v109
v_cvt_pk_bf16_f32 v47, v110, v111
v_mfma_f32_16x16x32_bf16 v[240:243], a[136:139], a[32:35], v[240:243]
v_mul_f32 v52, s68, v52
v_mul_f32 v53, s68, v53
v_mfma_f32_16x16x32_bf16 v[240:243], a[140:143], a[36:39], v[240:243]
v_mul_f32 v54, s68, v54
v_mul_f32 v55, s68, v55
v_mfma_f32_16x16x32_bf16 v[244:247], a[136:139], a[40:43], v[244:247]
v_mul_f32 v116, s68, v116
v_mul_f32 v117, s68, v117
v_mfma_f32_16x16x32_bf16 v[244:247], a[140:143], a[44:47], v[244:247]
v_mul_f32 v118, s68, v118
v_mul_f32 v119, s68, v119
v_mfma_f32_16x16x32_bf16 v[248:251], a[136:139], a[48:51], v[248:251]
v_cvt_pk_bf16_f32 v52, v52, v53
v_cvt_pk_bf16_f32 v53, v54, v55
v_mfma_f32_16x16x32_bf16 v[248:251], a[140:143], a[52:55], v[248:251]
v_cvt_pk_bf16_f32 v54, v116, v117
v_cvt_pk_bf16_f32 v55, v118, v119
v_mfma_f32_16x16x32_bf16 v[252:255], a[136:139], a[56:59], v[252:255]
v_mfma_f32_16x16x32_bf16 v[252:255], a[140:143], a[60:63], v[252:255]
s_mov_b64 s[60:61], s[74:75]
s_mov_b32 s62, 896
s_lshl_b32 s79, s85, 1
buffer_load_short_d16_hi v19, off, s[60:63], s79
s_lshl_b32 s83, s85, 12
s_add_u32 s83, s83, 88080384
ds_write_b128 v28, v[36:39] offset:0
ds_write_b128 v28, v[44:47] offset:8192
ds_write_b128 v28, v[52:55] offset:16384
v_pk_mul_f32 v[60:61], v[60:61], s[68:69]
v_pk_mul_f32 v[62:63], v[62:63], s[68:69]
v_pk_mul_f32 v[124:125], v[124:125], s[68:69]
v_pk_mul_f32 v[126:127], v[126:127], s[68:69]
v_cvt_pk_bf16_f32 v60, v60, v61
v_cvt_pk_bf16_f32 v61, v62, v63
v_cvt_pk_bf16_f32 v62, v124, v125
v_cvt_pk_bf16_f32 v63, v126, v127
ds_write_b128 v28, v[60:63] offset:24576
v_pk_mul_f32 v[68:69], v[68:69], s[68:69]
v_pk_mul_f32 v[70:71], v[70:71], s[68:69]
v_pk_mul_f32 v[132:133], v[132:133], s[68:69]
v_pk_mul_f32 v[134:135], v[134:135], s[68:69]
v_cvt_pk_bf16_f32 v68, v68, v69
v_cvt_pk_bf16_f32 v69, v70, v71
v_cvt_pk_bf16_f32 v70, v132, v133
v_cvt_pk_bf16_f32 v71, v134, v135
ds_write_b128 v29, v[68:71] offset:0
v_pk_mul_f32 v[76:77], v[76:77], s[68:69]
v_pk_mul_f32 v[78:79], v[78:79], s[68:69]
v_pk_mul_f32 v[140:141], v[140:141], s[68:69]
v_pk_mul_f32 v[142:143], v[142:143], s[68:69]
v_cvt_pk_bf16_f32 v76, v76, v77
v_cvt_pk_bf16_f32 v77, v78, v79
v_cvt_pk_bf16_f32 v78, v140, v141
v_cvt_pk_bf16_f32 v79, v142, v143
ds_write_b128 v29, v[76:79] offset:8192
v_pk_mul_f32 v[84:85], v[84:85], s[68:69]
v_pk_mul_f32 v[86:87], v[86:87], s[68:69]
v_pk_mul_f32 v[148:149], v[148:149], s[68:69]
v_pk_mul_f32 v[150:151], v[150:151], s[68:69]
v_cvt_pk_bf16_f32 v84, v84, v85
v_cvt_pk_bf16_f32 v85, v86, v87
v_cvt_pk_bf16_f32 v86, v148, v149
v_cvt_pk_bf16_f32 v87, v150, v151
ds_write_b128 v29, v[84:87] offset:16384
v_pk_mul_f32 v[92:93], v[92:93], s[68:69]
v_pk_mul_f32 v[94:95], v[94:95], s[68:69]
v_pk_mul_f32 v[156:157], v[156:157], s[68:69]
v_pk_mul_f32 v[158:159], v[158:159], s[68:69]
v_cvt_pk_bf16_f32 v92, v92, v93
v_cvt_pk_bf16_f32 v93, v94, v95
v_cvt_pk_bf16_f32 v94, v156, v157
v_cvt_pk_bf16_f32 v95, v158, v159
ds_write_b128 v29, v[92:95] offset:24576
v_pk_mul_f32 v[164:165], v[164:165], s[68:69]
v_pk_mul_f32 v[166:167], v[166:167], s[68:69]
v_pk_mul_f32 v[224:225], v[224:225], s[68:69]
v_pk_mul_f32 v[226:227], v[226:227], s[68:69]
v_cvt_pk_bf16_f32 v164, v164, v165
v_cvt_pk_bf16_f32 v165, v166, v167
v_cvt_pk_bf16_f32 v166, v224, v225
v_cvt_pk_bf16_f32 v167, v226, v227
ds_write_b128 v28, v[164:167] offset:1024
v_pk_mul_f32 v[172:173], v[172:173], s[68:69]
v_pk_mul_f32 v[174:175], v[174:175], s[68:69]
v_pk_mul_f32 v[228:229], v[228:229], s[68:69]
v_pk_mul_f32 v[230:231], v[230:231], s[68:69]
v_cvt_pk_bf16_f32 v172, v172, v173
v_cvt_pk_bf16_f32 v173, v174, v175
v_cvt_pk_bf16_f32 v174, v228, v229
v_cvt_pk_bf16_f32 v175, v230, v231
ds_write_b128 v28, v[172:175] offset:9216
v_pk_mul_f32 v[180:181], v[180:181], s[68:69]
v_pk_mul_f32 v[182:183], v[182:183], s[68:69]
v_pk_mul_f32 v[232:233], v[232:233], s[68:69]
v_pk_mul_f32 v[234:235], v[234:235], s[68:69]
v_cvt_pk_bf16_f32 v180, v180, v181
v_cvt_pk_bf16_f32 v181, v182, v183
v_cvt_pk_bf16_f32 v182, v232, v233
v_cvt_pk_bf16_f32 v183, v234, v235
ds_write_b128 v28, v[180:183] offset:17408
v_pk_mul_f32 v[188:189], v[188:189], s[68:69]
v_pk_mul_f32 v[190:191], v[190:191], s[68:69]
v_pk_mul_f32 v[236:237], v[236:237], s[68:69]
v_pk_mul_f32 v[238:239], v[238:239], s[68:69]
v_cvt_pk_bf16_f32 v188, v188, v189
v_cvt_pk_bf16_f32 v189, v190, v191
v_cvt_pk_bf16_f32 v190, v236, v237
v_cvt_pk_bf16_f32 v191, v238, v239
ds_write_b128 v28, v[188:191] offset:25600
v_pk_mul_f32 v[196:197], v[196:197], s[68:69]
v_pk_mul_f32 v[198:199], v[198:199], s[68:69]
v_pk_mul_f32 v[240:241], v[240:241], s[68:69]
v_pk_mul_f32 v[242:243], v[242:243], s[68:69]
v_cvt_pk_bf16_f32 v196, v196, v197
v_cvt_pk_bf16_f32 v197, v198, v199
v_cvt_pk_bf16_f32 v198, v240, v241
v_cvt_pk_bf16_f32 v199, v242, v243
ds_write_b128 v29, v[196:199] offset:1024
v_pk_mul_f32 v[204:205], v[204:205], s[68:69]
v_pk_mul_f32 v[206:207], v[206:207], s[68:69]
v_pk_mul_f32 v[244:245], v[244:245], s[68:69]
v_pk_mul_f32 v[246:247], v[246:247], s[68:69]
v_cvt_pk_bf16_f32 v204, v204, v205
v_cvt_pk_bf16_f32 v205, v206, v207
v_cvt_pk_bf16_f32 v206, v244, v245
v_cvt_pk_bf16_f32 v207, v246, v247
ds_write_b128 v29, v[204:207] offset:9216
v_pk_mul_f32 v[212:213], v[212:213], s[68:69]
v_pk_mul_f32 v[214:215], v[214:215], s[68:69]
v_pk_mul_f32 v[248:249], v[248:249], s[68:69]
v_pk_mul_f32 v[250:251], v[250:251], s[68:69]
v_cvt_pk_bf16_f32 v212, v212, v213
v_cvt_pk_bf16_f32 v213, v214, v215
v_cvt_pk_bf16_f32 v214, v248, v249
v_cvt_pk_bf16_f32 v215, v250, v251
ds_write_b128 v29, v[212:215] offset:17408
v_pk_mul_f32 v[220:221], v[220:221], s[68:69]
v_pk_mul_f32 v[222:223], v[222:223], s[68:69]
v_pk_mul_f32 v[252:253], v[252:253], s[68:69]
v_pk_mul_f32 v[254:255], v[254:255], s[68:69]
v_cvt_pk_bf16_f32 v220, v220, v221
v_cvt_pk_bf16_f32 v221, v222, v223
v_cvt_pk_bf16_f32 v222, v252, v253
v_cvt_pk_bf16_f32 v223, v254, v255
ds_write_b128 v29, v[220:223] offset:25600
s_waitcnt vmcnt(1) lgkmcnt(0)
s_barrier
buffer_load_dword v21, v20, s[4:7], s31 offen sc1
ds_read_b64_tr_b16 a[64:65], v16 offset:8
ds_read_b64_tr_b16 a[66:67], v16 offset:0
ds_read_b128 a[96:99], v17 offset:448
ds_read_b64_tr_b16 a[68:69], v16 offset:520
ds_read_b64_tr_b16 a[70:71], v16 offset:512
ds_read_b128 a[100:103], v17 offset:960
ds_read_b64_tr_b16 a[72:73], v16 offset:1032
ds_read_b64_tr_b16 a[74:75], v16 offset:1024
ds_read_b128 a[104:107], v17 offset:1472
ds_read_b64_tr_b16 a[76:77], v16 offset:1544
ds_read_b64_tr_b16 a[78:79], v16 offset:1536
ds_read_b128 a[108:111], v17 offset:1984
ds_read_b64_tr_b16 a[80:81], v16 offset:2056
ds_read_b64_tr_b16 a[82:83], v16 offset:2048
ds_read_b128 a[112:115], v17 offset:2496
ds_read_b64_tr_b16 a[84:85], v16 offset:2568
ds_read_b64_tr_b16 a[86:87], v16 offset:2560
ds_read_b128 a[116:119], v17 offset:3008
ds_read_b64_tr_b16 a[88:89], v16 offset:3080
ds_read_b64_tr_b16 a[90:91], v16 offset:3072
ds_read_b128 a[120:123], v17 offset:3520
ds_read_b64_tr_b16 a[92:93], v16 offset:3592
ds_read_b64_tr_b16 a[94:95], v16 offset:3584
ds_read_b128 a[124:127], v17 offset:4032
s_waitcnt lgkmcnt(15)
v_mfma_f32_16x16x32_bf16 v[96:99], a[64:67], a[96:99], 0
s_waitcnt lgkmcnt(12)
s_lshl_b32 s18, s3, 13
ds_read_b64_tr_b16 a[128:129], v16 offset:72
v_mov_b32 v24, 0
v_mfma_f32_16x16x32_bf16 v[100:103], a[64:67], a[100:103], 0
s_lshl_b32 s30, s20, 20
ds_read_b64_tr_b16 a[130:131], v16 offset:64
v_lshrrev_b32 v3, 6, v0
v_mfma_f32_16x16x32_bf16 v[100:103], a[68:71], a[96:99], v[100:103]
s_add_u32 s30, s30, s18
ds_read_b128 a[160:163], v17 offset:384
v_and_b32 v4, 63, v0
v_mfma_f32_16x16x32_bf16 v[104:107], a[64:67], a[104:107], 0
s_lshl_b32 s22, s21, 1
ds_read_b128 a[192:195], v30 offset:0
v_add_u32 v2, 0x10000, v1
v_mfma_f32_16x16x32_bf16 v[104:107], a[68:71], a[100:103], v[104:107]
s_and_b32 s84, s2, 1
ds_read_b64_tr_b16 a[132:133], v16 offset:584
v_and_b32 v5, 15, v4
v_mfma_f32_16x16x32_bf16 v[104:107], a[72:75], a[96:99], v[104:107]
s_mul_i32 s84, s84, 0
ds_read_b64_tr_b16 a[134:135], v16 offset:576
v_lshrrev_b32 v6, 4, v4
v_mfma_f32_16x16x32_bf16 v[108:111], a[64:67], a[108:111], 0
s_add_u32 s84, s84, 2386092
ds_read_b128 a[164:167], v17 offset:896
v_lshlrev_b32 v6, 2, v6
v_mfma_f32_16x16x32_bf16 v[108:111], a[68:71], a[104:107], v[108:111]
s_lshl_b32 s85, s21, 2
ds_read_b128 a[196:199], v30 offset:1024
v_sub_u32 v5, v5, v6
v_mfma_f32_16x16x32_bf16 v[108:111], a[72:75], a[100:103], v[108:111]
s_lshr_b32 s85, s84, s85
ds_read_b64_tr_b16 a[136:137], v16 offset:1096
v_lshl_add_u32 v5, v3, 4, v5
v_mfma_f32_16x16x32_bf16 v[108:111], a[76:79], a[96:99], v[108:111]
s_waitcnt lgkmcnt(8)
s_and_b32 s9, s85, 15
ds_read_b64_tr_b16 a[138:139], v16 offset:1088
v_cmp_gt_i32 s[32:33], 0, v5
v_mfma_f32_16x16x32_bf16 v[112:115], a[64:67], a[112:115], 0
s_and_b32 s84, s85, 1
ds_read_b128 a[168:171], v17 offset:1408
v_cmp_gt_i32 s[34:35], 1, v5
v_mfma_f32_16x16x32_bf16 v[112:115], a[68:71], a[108:111], v[112:115]
s_lshl_b32 s84, s84, 17
ds_read_b128 a[200:203], v30 offset:2048
v_cmp_gt_i32 s[36:37], 2, v5
v_mfma_f32_16x16x32_bf16 v[112:115], a[72:75], a[104:107], v[112:115]
s_add_u32 s84, s84, s18
ds_read_b64_tr_b16 a[140:141], v16 offset:1608
v_cmp_gt_i32 s[38:39], 3, v5
v_mfma_f32_16x16x32_bf16 v[112:115], a[76:79], a[100:103], v[112:115]
s_xor_b32 s85, s84, 0x20000
ds_read_b64_tr_b16 a[142:143], v16 offset:1600
v_cmp_gt_i32 s[40:41], 16, v5
v_mfma_f32_16x16x32_bf16 v[112:115], a[80:83], a[96:99], v[112:115]
s_sub_u32 s29, 15, s21
ds_read_b128 a[172:175], v17 offset:1920
v_cmp_gt_i32 s[42:43], 17, v5
v_mfma_f32_16x16x32_bf16 v[116:119], a[64:67], a[116:119], 0
s_xor_b32 s8, s30, 2097152
ds_read_b128 a[204:207], v30 offset:3072
v_cmp_gt_i32 s[44:45], 18, v5
v_mfma_f32_16x16x32_bf16 v[116:119], a[68:71], a[112:115], v[116:119]
s_add_u32 s11, s22, 2
ds_read_b64_tr_b16 a[144:145], v16 offset:2120
v_cmp_gt_i32 s[46:47], 19, v5
v_mfma_f32_16x16x32_bf16 v[116:119], a[72:75], a[108:111], v[116:119]
s_add_u32 s14, s30, 16777216
ds_read_b64_tr_b16 a[146:147], v16 offset:2112
v_cmp_gt_i32 s[48:49], 32, v5
v_mfma_f32_16x16x32_bf16 v[116:119], a[76:79], a[104:107], v[116:119]
s_lshr_b32 s19, s9, 1
ds_read_b128 a[176:179], v17 offset:2432
v_cmp_gt_i32 s[50:51], 33, v5
v_mfma_f32_16x16x32_bf16 v[116:119], a[80:83], a[100:103], v[116:119]
s_cmp_lg_u32 s9, 0
ds_read_b128 a[208:211], v30 offset:4096
v_cmp_gt_i32 s[52:53], 34, v5
v_mfma_f32_16x16x32_bf16 v[116:119], a[84:87], a[96:99], v[116:119]
s_cselect_b32 s10, s30, 3221225472
ds_read_b64_tr_b16 a[148:149], v16 offset:2632
v_cmp_gt_i32 s[54:55], 35, v5
v_mfma_f32_16x16x32_bf16 v[120:123], a[64:67], a[120:123], 0
s_cselect_b32 s8, s8, s30
ds_read_b64_tr_b16 a[150:151], v16 offset:2624
v_cmp_gt_i32 s[56:57], 48, v5
v_mfma_f32_16x16x32_bf16 v[120:123], a[68:71], a[116:119], v[120:123]
s_cselect_b32 s14, s14, 3221225472
ds_read_b128 a[180:183], v17 offset:2944
v_cmp_gt_i32 s[58:59], 49, v5
v_mfma_f32_16x16x32_bf16 v[120:123], a[72:75], a[112:115], v[120:123]
s_cselect_b32 s9, s9, s11
ds_read_b128 a[212:215], v30 offset:5120
v_cmp_gt_i32 s[60:61], 50, v5
v_mfma_f32_16x16x32_bf16 v[120:123], a[76:79], a[108:111], v[120:123]
s_cselect_b32 s19, s19, s21
ds_read_b64_tr_b16 a[152:153], v16 offset:3144
v_cmp_gt_i32 s[62:63], 51, v5
v_mfma_f32_16x16x32_bf16 v[120:123], a[80:83], a[104:107], v[120:123]
s_cselect_b32 s29, s29, s21
ds_read_b64_tr_b16 a[154:155], v16 offset:3136
v_mov_b32 v7, 0xff800000
v_mfma_f32_16x16x32_bf16 v[120:123], a[84:87], a[100:103], v[120:123]
s_cselect_b32 s24, 2, 0
ds_read_b128 a[184:187], v17 offset:3456
v_mov_b32 v6, 1
v_mfma_f32_16x16x32_bf16 v[120:123], a[88:91], a[96:99], v[120:123]
s_add_u32 s12, s8, 16777216
ds_read_b128 a[216:219], v30 offset:6144
v_mov_b32 v5, v26
v_mfma_f32_16x16x32_bf16 v[124:127], a[64:67], a[124:127], 0
s_mov_b32 s13, s9
ds_read_b64_tr_b16 a[156:157], v16 offset:3656
v_add_u32 v4, 0x20000, v1
v_mfma_f32_16x16x32_bf16 v[124:127], a[68:71], a[120:123], v[124:127]
s_mov_b32 s15, s11
ds_read_b64_tr_b16 a[158:159], v16 offset:3648
v_mfma_f32_16x16x32_bf16 v[124:127], a[72:75], a[116:119], v[124:127]
s_mov_b32 s25, 1266679808
ds_read_b128 a[188:191], v17 offset:3968
v_mfma_f32_16x16x32_bf16 v[124:127], a[76:79], a[112:115], v[124:127]
s_lshl_b32 s22, s21, 3
ds_read_b128 a[220:223], v30 offset:7168
v_mfma_f32_16x16x32_bf16 v[124:127], a[80:83], a[108:111], v[124:127]
s_xor_b32 s28, s70, 0
ds_read_b128 a[224:227], v31 offset:0
v_mfma_f32_16x16x32_bf16 v[124:127], a[84:87], a[104:107], v[124:127]
s_add_u32 s28, s28, s22
ds_read_b128 a[228:231], v31 offset:1024
v_mfma_f32_16x16x32_bf16 v[124:127], a[88:91], a[100:103], v[124:127]
s_add_u32 s28, s28, 6148
ds_read_b128 a[232:235], v31 offset:2048
v_mfma_f32_16x16x32_bf16 v[124:127], a[92:95], a[96:99], v[124:127]
s_waitcnt lgkmcnt(8)
s_lshl_b32 s26, s21, 16
ds_read_b128 a[236:239], v31 offset:3072
v_mfma_f32_16x16x32_bf16 v[96:99], a[128:131], a[160:163], v[96:99]
s_add_u32 s26, s26, s30
ds_read_b64_tr_b16 a[64:65], v16 offset:136
v_mfma_f32_16x16x32_bf16 v[100:103], a[128:131], a[164:167], v[100:103]
s_add_u32 s26, s26, 33554432
ds_read_b64_tr_b16 a[66:67], v16 offset:128
v_mfma_f32_16x16x32_bf16 v[100:103], a[132:135], a[160:163], v[100:103]
s_xor_b32 s76, s20, 2
ds_read_b128 a[96:99], v17 offset:320
v_mfma_f32_16x16x32_bf16 v[104:107], a[128:131], a[168:171], v[104:107]
s_lshl_b32 s76, s76, 3
ds_read_b128 a[240:243], v31 offset:4096
v_mfma_f32_16x16x32_bf16 v[104:107], a[132:135], a[164:167], v[104:107]
s_add_u32 s76, s76, s21
ds_read_b64_tr_b16 a[68:69], v16 offset:648
v_mfma_f32_16x16x32_bf16 v[104:107], a[136:139], a[160:163], v[104:107]
s_lshl_b32 s76, s76, 2
ds_read_b64_tr_b16 a[70:71], v16 offset:640
v_mfma_f32_16x16x32_bf16 v[108:111], a[128:131], a[172:175], v[108:111]
s_add_u32 s76, s76, s3
ds_read_b128 a[100:103], v17 offset:832
v_mfma_f32_16x16x32_bf16 v[108:111], a[132:135], a[168:171], v[108:111]
s_lshl_b32 s27, s76, 10
ds_read_b128 a[244:247], v31 offset:5120
v_mfma_f32_16x16x32_bf16 v[108:111], a[136:139], a[164:167], v[108:111]
s_add_u32 s27, s27, 75497472
ds_read_b64_tr_b16 a[72:73], v16 offset:1160
v_mfma_f32_16x16x32_bf16 v[108:111], a[140:143], a[160:163], v[108:111]
s_lshl_b32 s76, s76, 14
ds_read_b64_tr_b16 a[74:75], v16 offset:1152
v_mfma_f32_16x16x32_bf16 v[112:115], a[128:131], a[176:179], v[112:115]
s_add_u32 s76, s76, 67108864
ds_read_b128 a[104:107], v17 offset:1344
v_mfma_f32_16x16x32_bf16 v[112:115], a[132:135], a[172:175], v[112:115]
s_lshl_b32 s81, s20, 2
ds_read_b128 a[248:251], v31 offset:6144
v_mfma_f32_16x16x32_bf16 v[112:115], a[136:139], a[168:171], v[112:115]
s_add_u32 s81, s81, s3
ds_read_b64_tr_b16 a[76:77], v16 offset:1672
v_mfma_f32_16x16x32_bf16 v[112:115], a[140:143], a[164:167], v[112:115]
s_mul_i32 s81, s81, 57344
ds_read_b64_tr_b16 a[78:79], v16 offset:1664
v_mfma_f32_16x16x32_bf16 v[112:115], a[144:147], a[160:163], v[112:115]
PAD_30:
s_cbranch_execz M_tret
s_cmp_eq_u32 s24, 1
ds_read_b128 a[108:111], v17 offset:1856
v_mfma_f32_16x16x32_bf16 v[116:119], a[128:131], a[180:183], v[116:119]
s_cselect_b32 s80, s28, s70
ds_read_b128 a[252:255], v31 offset:7168
v_mfma_f32_16x16x32_bf16 v[116:119], a[132:135], a[176:179], v[116:119]
s_add_u32 s77, s76, 8192
ds_read_b64_tr_b16 a[80:81], v16 offset:2184
v_mfma_f32_16x16x32_bf16 v[116:119], a[136:139], a[172:175], v[116:119]
s_lshl_b32 s71, s2, 2
ds_read_b64_tr_b16 a[82:83], v16 offset:2176
v_mfma_f32_16x16x32_bf16 v[116:119], a[140:143], a[168:171], v[116:119]
s_add_u32 s71, s71, 94384128
ds_read_b128 a[112:115], v17 offset:2368
v_mfma_f32_16x16x32_bf16 v[116:119], a[144:147], a[164:167], v[116:119]
s_lshl_b32 s78, s29, 16
v_mfma_f32_16x16x32_bf16 v[116:119], a[148:151], a[160:163], v[116:119]
s_add_u32 s78, s78, s8
ds_read_b64_tr_b16 a[84:85], v16 offset:2696
v_mfma_f32_16x16x32_bf16 v[120:123], a[128:131], a[184:187], v[120:123]
s_add_u32 s78, s78, 33554432
ds_read_b64_tr_b16 a[86:87], v16 offset:2688
v_mfma_f32_16x16x32_bf16 v[120:123], a[132:135], a[180:183], v[120:123]
s_cmp_eq_u32 s24, 0
ds_read_b128 a[116:119], v17 offset:2880
v_mfma_f32_16x16x32_bf16 v[120:123], a[136:139], a[176:179], v[120:123]
s_cselect_b32 s78, 3221225472, s78
v_mfma_f32_16x16x32_bf16 v[120:123], a[140:143], a[172:175], v[120:123]
s_lshl_b32 s22, s21, 3
ds_read_b64_tr_b16 a[88:89], v16 offset:3208
v_mfma_f32_16x16x32_bf16 v[120:123], a[144:147], a[168:171], v[120:123]
s_add_u32 s22, s22, 16384
ds_read_b64_tr_b16 a[90:91], v16 offset:3200
v_mfma_f32_16x16x32_bf16 v[120:123], a[148:151], a[164:167], v[120:123]
s_andn2_b32 s23, 256, s70
ds_read_b128 a[120:123], v17 offset:3392
v_mfma_f32_16x16x32_bf16 v[120:123], a[152:155], a[160:163], v[120:123]
s_waitcnt lgkmcnt(6)
s_add_u32 s22, s22, s23
v_mfma_f32_16x16x32_bf16 v[124:127], a[128:131], a[188:191], v[124:127]
s_waitcnt vmcnt(0) lgkmcnt(9)
s_barrier
ds_read_b64_tr_b16 a[92:93], v16 offset:3720
v_writelane_b32 v15, s22, 63
v_cmp_gt_u32 vcc, 1, v21
v_mfma_f32_16x16x32_bf16 v[124:127], a[132:135], a[184:187], v[124:127]
s_cbranch_vccnz M_kspin2
M_kok2:
ds_read_b64_tr_b16 a[94:95], v16 offset:3712
v_mov_b32 v25, 0
v_mfma_f32_16x16x32_bf16 v[124:127], a[136:139], a[180:183], v[124:127]
s_mov_b32 m0, s84
ds_read_b128 a[124:127], v17 offset:3904
v_mov_b32 v128, 0
v_mfma_f32_16x16x32_bf16 v[124:127], a[140:143], a[176:179], v[124:127]
buffer_load_dwordx4 v1, s[4:7], s8 offen offset:0 sc1 lds
v_mfma_f32_16x16x32_bf16 v[124:127], a[144:147], a[172:175], v[124:127]
buffer_load_dwordx4 v1, s[4:7], s8 offen offset:1024 sc1 lds
v_mfma_f32_16x16x32_bf16 v[124:127], a[148:151], a[168:171], v[124:127]
buffer_load_dwordx4 v1, s[4:7], s8 offen offset:2048 sc1 lds
v_mfma_f32_16x16x32_bf16 v[124:127], a[152:155], a[164:167], v[124:127]
buffer_load_dwordx4 v1, s[4:7], s8 offen offset:3072 sc1 lds
v_mfma_f32_16x16x32_bf16 v[124:127], a[156:159], a[160:163], v[124:127]
s_add_u32 s8, s8, 4096
v_mov_b32 v129, 0
v_mov_b32 v130, 0
v_mfma_f32_16x16x32_bf16 v[96:99], a[64:67], a[96:99], v[96:99]
s_add_u32 m0, s84, 4096
ds_read_b64_tr_b16 a[128:129], v16 offset:200
v_mov_b32 v131, 0
v_mfma_f32_16x16x32_bf16 v[100:103], a[64:67], a[100:103], v[100:103]
ds_read_b64_tr_b16 a[130:131], v16 offset:192
v_mov_b32 v132, 0
v_mfma_f32_16x16x32_bf16 v[100:103], a[68:71], a[96:99], v[100:103]
ds_read_b128 a[160:163], v17 offset:256
v_mov_b32 v133, 0
v_mfma_f32_16x16x32_bf16 v[104:107], a[64:67], a[104:107], v[104:107]
buffer_load_dwordx4 v1, s[4:7], s8 offen offset:0 sc1 lds
v_mfma_f32_16x16x32_bf16 v[104:107], a[68:71], a[100:103], v[104:107]
ds_read_b64_tr_b16 a[132:133], v16 offset:712
v_mov_b32 v134, 0
v_mfma_f32_16x16x32_bf16 v[104:107], a[72:75], a[96:99], v[104:107]
ds_read_b64_tr_b16 a[134:135], v16 offset:704
v_mov_b32 v135, 0
v_mfma_f32_16x16x32_bf16 v[108:111], a[64:67], a[108:111], v[108:111]
ds_read_b128 a[164:167], v17 offset:768
v_mov_b32 v136, 0
v_mfma_f32_16x16x32_bf16 v[108:111], a[68:71], a[104:107], v[108:111]
buffer_load_dwordx4 v1, s[4:7], s8 offen offset:1024 sc1 lds
v_mfma_f32_16x16x32_bf16 v[108:111], a[72:75], a[100:103], v[108:111]
ds_read_b64_tr_b16 a[136:137], v16 offset:1224
v_mov_b32 v137, 0
v_mfma_f32_16x16x32_bf16 v[108:111], a[76:79], a[96:99], v[108:111]
ds_read_b64_tr_b16 a[138:139], v16 offset:1216
v_mov_b32 v138, 0
v_mfma_f32_16x16x32_bf16 v[112:115], a[64:67], a[112:115], v[112:115]
ds_read_b128 a[168:171], v17 offset:1280
v_mov_b32 v139, 0
v_mfma_f32_16x16x32_bf16 v[112:115], a[68:71], a[108:111], v[112:115]
buffer_load_dwordx4 v1, s[4:7], s8 offen offset:2048 sc1 lds
v_mfma_f32_16x16x32_bf16 v[112:115], a[72:75], a[104:107], v[112:115]
ds_read_b64_tr_b16 a[140:141], v16 offset:1736
v_mov_b32 v140, 0
v_mfma_f32_16x16x32_bf16 v[112:115], a[76:79], a[100:103], v[112:115]
ds_read_b64_tr_b16 a[142:143], v16 offset:1728
v_mov_b32 v141, 0
v_mfma_f32_16x16x32_bf16 v[112:115], a[80:83], a[96:99], v[112:115]
s_waitcnt lgkmcnt(6)
ds_read_b128 a[172:175], v17 offset:1792
v_mov_b32 v142, 0
v_mfma_f32_16x16x32_bf16 v[116:119], a[64:67], a[116:119], v[116:119]
buffer_load_dwordx4 v1, s[4:7], s8 offen offset:3072 sc1 lds
v_mfma_f32_16x16x32_bf16 v[116:119], a[68:71], a[112:115], v[116:119]
s_add_u32 s8, s8, 28672
ds_read_b64_tr_b16 a[144:145], v16 offset:2248
v_mov_b32 v143, 0
v_mfma_f32_16x16x32_bf16 v[116:119], a[72:75], a[108:111], v[116:119]
s_sub_u32 s9, s9, 1
ds_read_b64_tr_b16 a[146:147], v16 offset:2240
v_mov_b32 v144, 0
v_mfma_f32_16x16x32_bf16 v[116:119], a[76:79], a[104:107], v[116:119]
s_cmp_eq_u32 s9, 0
ds_read_b128 a[176:179], v17 offset:2304
v_mov_b32 v145, 0
v_mfma_f32_16x16x32_bf16 v[116:119], a[80:83], a[100:103], v[116:119]
s_cselect_b32 s8, s10, s8
v_mov_b32 v146, 0
v_mov_b32 v147, 0
v_mfma_f32_16x16x32_bf16 v[116:119], a[84:87], a[96:99], v[116:119]
s_cselect_b32 s9, s11, s9
ds_read_b64_tr_b16 a[148:149], v16 offset:2760
v_mov_b32 v148, 0
v_mfma_f32_16x16x32_bf16 v[120:123], a[64:67], a[120:123], v[120:123]
s_cselect_b32 s10, 3221225472, s10
ds_read_b64_tr_b16 a[150:151], v16 offset:2752
v_mov_b32 v149, 0
v_mfma_f32_16x16x32_bf16 v[120:123], a[68:71], a[116:119], v[120:123]
s_mov_b32 m0, s85
ds_read_b128 a[180:183], v17 offset:2816
v_mov_b32 v150, 0
v_mfma_f32_16x16x32_bf16 v[120:123], a[72:75], a[112:115], v[120:123]
buffer_load_dwordx4 v1, s[4:7], s8 offen offset:0 sc1 lds
v_mfma_f32_16x16x32_bf16 v[120:123], a[76:79], a[108:111], v[120:123]
ds_read_b64_tr_b16 a[152:153], v16 offset:3272
v_mov_b32 v151, 0
v_mfma_f32_16x16x32_bf16 v[120:123], a[80:83], a[104:107], v[120:123]
ds_read_b64_tr_b16 a[154:155], v16 offset:3264
v_mov_b32 v152, 0
v_mfma_f32_16x16x32_bf16 v[120:123], a[84:87], a[100:103], v[120:123]
ds_read_b128 a[184:187], v17 offset:3328
v_mov_b32 v153, 0
v_mfma_f32_16x16x32_bf16 v[120:123], a[88:91], a[96:99], v[120:123]
buffer_load_dwordx4 v1, s[4:7], s8 offen offset:1024 sc1 lds
v_mfma_f32_16x16x32_bf16 v[124:127], a[64:67], a[124:127], v[124:127]
ds_read_b64_tr_b16 a[156:157], v16 offset:3784
v_mov_b32 v154, 0
v_mfma_f32_16x16x32_bf16 v[124:127], a[68:71], a[120:123], v[124:127]
ds_read_b64_tr_b16 a[158:159], v16 offset:3776
v_mov_b32 v155, 0
v_mfma_f32_16x16x32_bf16 v[124:127], a[72:75], a[116:119], v[124:127]
ds_read_b128 a[188:191], v17 offset:3840
v_mov_b32 v156, 0
v_mfma_f32_16x16x32_bf16 v[124:127], a[76:79], a[112:115], v[124:127]
buffer_load_dwordx4 v1, s[4:7], s8 offen offset:2048 sc1 lds
v_mfma_f32_16x16x32_bf16 v[124:127], a[80:83], a[108:111], v[124:127]
buffer_load_dwordx4 v1, s[4:7], s8 offen offset:3072 sc1 lds
v_mfma_f32_16x16x32_bf16 v[124:127], a[84:87], a[104:107], v[124:127]
s_add_u32 s8, s8, 4096
v_mov_b32 v157, 0
v_mov_b32 v158, 0
v_mfma_f32_16x16x32_bf16 v[124:127], a[88:91], a[100:103], v[124:127]
s_add_u32 m0, s85, 4096
v_mov_b32 v159, 0
v_mov_b32 v160, 0
v_mfma_f32_16x16x32_bf16 v[124:127], a[92:95], a[96:99], v[124:127]
buffer_load_dwordx4 v1, s[4:7], s8 offen offset:0 sc1 lds
v_mfma_f32_16x16x32_bf16 v[96:99], a[128:131], a[160:163], v[96:99]
s_waitcnt lgkmcnt(3)
ds_read_b64_tr_b16 a[64:65], v16 offset:264
v_mov_b32 v161, 0
v_mfma_f32_16x16x32_bf16 v[100:103], a[128:131], a[164:167], v[100:103]
ds_read_b64_tr_b16 a[66:67], v16 offset:256
v_mov_b32 v162, 0
v_mfma_f32_16x16x32_bf16 v[100:103], a[132:135], a[160:163], v[100:103]
ds_read_b128 a[96:99], v17 offset:192
v_mov_b32 v163, 0
v_mfma_f32_16x16x32_bf16 v[104:107], a[128:131], a[168:171], v[104:107]
buffer_load_dwordx4 v1, s[4:7], s8 offen offset:1024 sc1 lds
v_mfma_f32_16x16x32_bf16 v[104:107], a[132:135], a[164:167], v[104:107]
ds_read_b64_tr_b16 a[68:69], v16 offset:776
v_mov_b32 v164, 0
v_mfma_f32_16x16x32_bf16 v[104:107], a[136:139], a[160:163], v[104:107]
ds_read_b64_tr_b16 a[70:71], v16 offset:768
v_mov_b32 v165, 0
v_mfma_f32_16x16x32_bf16 v[108:111], a[128:131], a[172:175], v[108:111]
ds_read_b128 a[100:103], v17 offset:704
v_mov_b32 v166, 0
v_mfma_f32_16x16x32_bf16 v[108:111], a[132:135], a[168:171], v[108:111]
buffer_load_dwordx4 v1, s[4:7], s8 offen offset:2048 sc1 lds
v_mfma_f32_16x16x32_bf16 v[108:111], a[136:139], a[164:167], v[108:111]
ds_read_b64_tr_b16 a[72:73], v16 offset:1288
v_mov_b32 v167, 0
v_mfma_f32_16x16x32_bf16 v[108:111], a[140:143], a[160:163], v[108:111]
ds_read_b64_tr_b16 a[74:75], v16 offset:1280
v_mov_b32 v168, 0
v_mfma_f32_16x16x32_bf16 v[112:115], a[128:131], a[176:179], v[112:115]
ds_read_b128 a[104:107], v17 offset:1216
v_mov_b32 v169, 0
v_mfma_f32_16x16x32_bf16 v[112:115], a[132:135], a[172:175], v[112:115]
buffer_load_dwordx4 v1, s[4:7], s8 offen offset:3072 sc1 lds
v_mfma_f32_16x16x32_bf16 v[112:115], a[136:139], a[168:171], v[112:115]
s_add_u32 s8, s8, 28672
ds_read_b64_tr_b16 a[76:77], v16 offset:1800
v_mov_b32 v170, 0
v_mfma_f32_16x16x32_bf16 v[112:115], a[140:143], a[164:167], v[112:115]
s_sub_u32 s9, s9, 1
ds_read_b64_tr_b16 a[78:79], v16 offset:1792
v_mov_b32 v171, 0
v_mfma_f32_16x16x32_bf16 v[112:115], a[144:147], a[160:163], v[112:115]
s_cmp_eq_u32 s9, 0
ds_read_b128 a[108:111], v17 offset:1728
v_mov_b32 v172, 0
v_mfma_f32_16x16x32_bf16 v[116:119], a[128:131], a[180:183], v[116:119]
s_cselect_b32 s8, s10, s8
buffer_load_dword v14, v15, s[4:7], s31 offen sc1
v_mfma_f32_16x16x32_bf16 v[116:119], a[132:135], a[176:179], v[116:119]
s_cselect_b32 s9, s11, s9
ds_read_b64_tr_b16 a[80:81], v16 offset:2312
v_mov_b32 v173, 0
v_mfma_f32_16x16x32_bf16 v[116:119], a[136:139], a[172:175], v[116:119]
s_cselect_b32 s10, 3221225472, s10
ds_read_b64_tr_b16 a[82:83], v16 offset:2304
v_mov_b32 v174, 0
v_mfma_f32_16x16x32_bf16 v[116:119], a[140:143], a[168:171], v[116:119]
ds_read_b128 a[112:115], v17 offset:2240
v_mov_b32 v175, 0
v_mfma_f32_16x16x32_bf16 v[116:119], a[144:147], a[164:167], v[116:119]
v_mov_b32 v176, 0
v_mov_b32 v177, 0
v_mfma_f32_16x16x32_bf16 v[116:119], a[148:151], a[160:163], v[116:119]
ds_read_b64_tr_b16 a[84:85], v16 offset:2824
v_mov_b32 v178, 0
v_mfma_f32_16x16x32_bf16 v[120:123], a[128:131], a[184:187], v[120:123]
ds_read_b64_tr_b16 a[86:87], v16 offset:2816
v_mov_b32 v179, 0
v_mfma_f32_16x16x32_bf16 v[120:123], a[132:135], a[180:183], v[120:123]
ds_read_b128 a[116:119], v17 offset:2752
v_mov_b32 v180, 0
v_mfma_f32_16x16x32_bf16 v[120:123], a[136:139], a[176:179], v[120:123]
v_mov_b32 v181, 0
v_mov_b32 v182, 0
v_mfma_f32_16x16x32_bf16 v[120:123], a[140:143], a[172:175], v[120:123]
ds_read_b64_tr_b16 a[88:89], v16 offset:3336
v_mov_b32 v183, 0
v_mfma_f32_16x16x32_bf16 v[120:123], a[144:147], a[168:171], v[120:123]
ds_read_b64_tr_b16 a[90:91], v16 offset:3328
v_mov_b32 v184, 0
v_mfma_f32_16x16x32_bf16 v[120:123], a[148:151], a[164:167], v[120:123]
ds_read_b128 a[120:123], v17 offset:3264
v_mov_b32 v185, 0
v_mfma_f32_16x16x32_bf16 v[120:123], a[152:155], a[160:163], v[120:123]
s_waitcnt lgkmcnt(6)
v_mov_b32 v186, 0
v_mov_b32 v187, 0
v_mfma_f32_16x16x32_bf16 v[124:127], a[128:131], a[188:191], v[124:127]
ds_read_b64_tr_b16 a[92:93], v16 offset:3848
v_mov_b32 v188, 0
v_mfma_f32_16x16x32_bf16 v[124:127], a[132:135], a[184:187], v[124:127]
ds_read_b64_tr_b16 a[94:95], v16 offset:3840
v_mov_b32 v189, 0
v_mfma_f32_16x16x32_bf16 v[124:127], a[136:139], a[180:183], v[124:127]
ds_read_b128 a[124:127], v17 offset:3776
v_mov_b32 v190, 0
v_mfma_f32_16x16x32_bf16 v[124:127], a[140:143], a[176:179], v[124:127]
v_mov_b32 v191, 0
v_mov_b32 v192, 0
v_mfma_f32_16x16x32_bf16 v[124:127], a[144:147], a[172:175], v[124:127]
v_mov_b32 v193, 0
v_mov_b32 v194, 0
v_mfma_f32_16x16x32_bf16 v[124:127], a[148:151], a[168:171], v[124:127]
v_mov_b32 v195, 0
v_mov_b32 v196, 0
v_mfma_f32_16x16x32_bf16 v[124:127], a[152:155], a[164:167], v[124:127]
v_mov_b32 v197, 0
v_mov_b32 v198, 0
v_mfma_f32_16x16x32_bf16 v[124:127], a[156:159], a[160:163], v[124:127]
v_mov_b32 v199, 0
v_mov_b32 v200, 0
s_waitcnt vmcnt(0)
v_cmp_gt_u32 vcc, 1, v14
s_cbranch_vccnz M_cspin
M_cok:
v_mfma_f32_16x16x32_bf16 v[96:99], a[64:67], a[96:99], v[96:99]
s_add_u32 s22, s78, 0
ds_read_b64_tr_b16 a[128:129], v16 offset:328
v_mov_b32 v201, 0
v_mfma_f32_16x16x32_bf16 v[100:103], a[64:67], a[100:103], v[100:103]
ds_read_b64_tr_b16 a[130:131], v16 offset:320
v_mov_b32 v202, 0
v_mfma_f32_16x16x32_bf16 v[100:103], a[68:71], a[96:99], v[100:103]
ds_read_b128 a[160:163], v17 offset:128
v_mov_b32 v203, 0
v_mfma_f32_16x16x32_bf16 v[104:107], a[64:67], a[104:107], v[104:107]
buffer_load_dwordx4 a[0:3], v1, s[4:7], s22 offen offset:0 sc1
v_mfma_f32_16x16x32_bf16 v[104:107], a[68:71], a[100:103], v[104:107]
ds_read_b64_tr_b16 a[132:133], v16 offset:840
v_mov_b32 v204, 0
v_mfma_f32_16x16x32_bf16 v[104:107], a[72:75], a[96:99], v[104:107]
ds_read_b64_tr_b16 a[134:135], v16 offset:832
v_mov_b32 v205, 0
v_mfma_f32_16x16x32_bf16 v[108:111], a[64:67], a[108:111], v[108:111]
ds_read_b128 a[164:167], v17 offset:640
v_mov_b32 v206, 0
v_mfma_f32_16x16x32_bf16 v[108:111], a[68:71], a[104:107], v[108:111]
buffer_load_dwordx4 a[4:7], v1, s[4:7], s22 offen offset:1024 sc1
v_mfma_f32_16x16x32_bf16 v[108:111], a[72:75], a[100:103], v[108:111]
ds_read_b64_tr_b16 a[136:137], v16 offset:1352
v_mov_b32 v207, 0
v_mfma_f32_16x16x32_bf16 v[108:111], a[76:79], a[96:99], v[108:111]
ds_read_b64_tr_b16 a[138:139], v16 offset:1344
v_mov_b32 v208, 0
v_mfma_f32_16x16x32_bf16 v[112:115], a[64:67], a[112:115], v[112:115]
ds_read_b128 a[168:171], v17 offset:1152
v_mov_b32 v209, 0
v_mfma_f32_16x16x32_bf16 v[112:115], a[68:71], a[108:111], v[112:115]
buffer_load_dwordx4 a[8:11], v1, s[4:7], s22 offen offset:2048 sc1
v_mfma_f32_16x16x32_bf16 v[112:115], a[72:75], a[104:107], v[112:115]
ds_read_b64_tr_b16 a[140:141], v16 offset:1864
v_mov_b32 v210, 0
v_mfma_f32_16x16x32_bf16 v[112:115], a[76:79], a[100:103], v[112:115]
ds_read_b64_tr_b16 a[142:143], v16 offset:1856
v_mov_b32 v211, 0
v_mfma_f32_16x16x32_bf16 v[112:115], a[80:83], a[96:99], v[112:115]
s_waitcnt lgkmcnt(6)
ds_read_b128 a[172:175], v17 offset:1664
v_mov_b32 v212, 0
v_mfma_f32_16x16x32_bf16 v[116:119], a[64:67], a[116:119], v[116:119]
buffer_load_dwordx4 a[12:15], v1, s[4:7], s22 offen offset:3072 sc1
v_mfma_f32_16x16x32_bf16 v[116:119], a[68:71], a[112:115], v[116:119]
s_add_u32 s22, s78, 4096
ds_read_b64_tr_b16 a[144:145], v16 offset:2376
v_mov_b32 v213, 0
v_mfma_f32_16x16x32_bf16 v[116:119], a[72:75], a[108:111], v[116:119]
ds_read_b64_tr_b16 a[146:147], v16 offset:2368
v_mov_b32 v214, 0
v_mfma_f32_16x16x32_bf16 v[116:119], a[76:79], a[104:107], v[116:119]
ds_read_b128 a[176:179], v17 offset:2176
v_mov_b32 v215, 0
v_mfma_f32_16x16x32_bf16 v[116:119], a[80:83], a[100:103], v[116:119]
buffer_load_dwordx4 a[16:19], v1, s[4:7], s22 offen offset:0 sc1
v_mfma_f32_16x16x32_bf16 v[116:119], a[84:87], a[96:99], v[116:119]
ds_read_b64_tr_b16 a[148:149], v16 offset:2888
v_mov_b32 v216, 0
v_mfma_f32_16x16x32_bf16 v[120:123], a[64:67], a[120:123], v[120:123]
ds_read_b64_tr_b16 a[150:151], v16 offset:2880
v_mov_b32 v217, 0
v_mfma_f32_16x16x32_bf16 v[120:123], a[68:71], a[116:119], v[120:123]
ds_read_b128 a[180:183], v17 offset:2688
v_mov_b32 v218, 0
v_mfma_f32_16x16x32_bf16 v[120:123], a[72:75], a[112:115], v[120:123]
buffer_load_dwordx4 a[20:23], v1, s[4:7], s22 offen offset:1024 sc1
v_mfma_f32_16x16x32_bf16 v[120:123], a[76:79], a[108:111], v[120:123]
ds_read_b64_tr_b16 a[152:153], v16 offset:3400
v_mov_b32 v219, 0
v_mfma_f32_16x16x32_bf16 v[120:123], a[80:83], a[104:107], v[120:123]
ds_read_b64_tr_b16 a[154:155], v16 offset:3392
v_mov_b32 v220, 0
v_mfma_f32_16x16x32_bf16 v[120:123], a[84:87], a[100:103], v[120:123]
ds_read_b128 a[184:187], v17 offset:3200
v_mov_b32 v221, 0
v_mfma_f32_16x16x32_bf16 v[120:123], a[88:91], a[96:99], v[120:123]
buffer_load_dwordx4 a[24:27], v1, s[4:7], s22 offen offset:2048 sc1
v_mfma_f32_16x16x32_bf16 v[124:127], a[64:67], a[124:127], v[124:127]
ds_read_b64_tr_b16 a[156:157], v16 offset:3912
v_mov_b32 v222, 0
v_mfma_f32_16x16x32_bf16 v[124:127], a[68:71], a[120:123], v[124:127]
ds_read_b64_tr_b16 a[158:159], v16 offset:3904
v_mov_b32 v223, 0
v_mfma_f32_16x16x32_bf16 v[124:127], a[72:75], a[116:119], v[124:127]
ds_read_b128 a[188:191], v17 offset:3712
v_mov_b32 v224, 0
v_mfma_f32_16x16x32_bf16 v[124:127], a[76:79], a[112:115], v[124:127]
buffer_load_dwordx4 a[28:31], v1, s[4:7], s22 offen offset:3072 sc1
v_mfma_f32_16x16x32_bf16 v[124:127], a[80:83], a[108:111], v[124:127]
s_add_u32 s22, s78, 32768
buffer_load_dwordx4 a[32:35], v1, s[4:7], s22 offen offset:0 sc1
v_mfma_f32_16x16x32_bf16 v[124:127], a[84:87], a[104:107], v[124:127]
buffer_load_dwordx4 a[36:39], v1, s[4:7], s22 offen offset:1024 sc1
v_mfma_f32_16x16x32_bf16 v[124:127], a[88:91], a[100:103], v[124:127]
buffer_load_dwordx4 a[40:43], v1, s[4:7], s22 offen offset:2048 sc1
v_mfma_f32_16x16x32_bf16 v[124:127], a[92:95], a[96:99], v[124:127]
s_waitcnt lgkmcnt(3)
buffer_load_dwordx4 a[44:47], v1, s[4:7], s22 offen offset:3072 sc1
v_mfma_f32_16x16x32_bf16 v[96:99], a[128:131], a[160:163], v[96:99]
s_add_u32 s22, s78, 36864
ds_read_b64_tr_b16 a[64:65], v16 offset:392
v_mov_b32 v225, 0
v_mfma_f32_16x16x32_bf16 v[100:103], a[128:131], a[164:167], v[100:103]
ds_read_b64_tr_b16 a[66:67], v16 offset:384
v_mov_b32 v226, 0
v_mfma_f32_16x16x32_bf16 v[100:103], a[132:135], a[160:163], v[100:103]
ds_read_b128 a[96:99], v17 offset:64
v_mov_b32 v227, 0
v_mfma_f32_16x16x32_bf16 v[104:107], a[128:131], a[168:171], v[104:107]
ds_read_b64 v[36:37], v18 offset:0
v_mov_b32 v228, 0
v_mfma_f32_16x16x32_bf16 v[104:107], a[132:135], a[164:167], v[104:107]
ds_read_b64_tr_b16 a[68:69], v16 offset:904
v_mov_b32 v229, 0
v_mfma_f32_16x16x32_bf16 v[104:107], a[136:139], a[160:163], v[104:107]
ds_read_b64_tr_b16 a[70:71], v16 offset:896
v_mov_b32 v230, 0
v_mfma_f32_16x16x32_bf16 v[108:111], a[128:131], a[172:175], v[108:111]
ds_read_b128 a[100:103], v17 offset:576
v_mov_b32 v231, 0
v_mfma_f32_16x16x32_bf16 v[108:111], a[132:135], a[168:171], v[108:111]
ds_read_b64 v[38:39], v18 offset:512
v_mov_b32 v232, 0
v_mfma_f32_16x16x32_bf16 v[108:111], a[136:139], a[164:167], v[108:111]
ds_read_b64_tr_b16 a[72:73], v16 offset:1416
v_mov_b32 v233, 0
v_mfma_f32_16x16x32_bf16 v[108:111], a[140:143], a[160:163], v[108:111]
ds_read_b64_tr_b16 a[74:75], v16 offset:1408
v_mov_b32 v234, 0
v_mfma_f32_16x16x32_bf16 v[112:115], a[128:131], a[176:179], v[112:115]
ds_read_b128 a[104:107], v17 offset:1088
v_mov_b32 v235, 0
v_mfma_f32_16x16x32_bf16 v[112:115], a[132:135], a[172:175], v[112:115]
ds_read_b64 v[44:45], v18 offset:1024
v_mov_b32 v236, 0
v_mfma_f32_16x16x32_bf16 v[112:115], a[136:139], a[168:171], v[112:115]
ds_read_b64_tr_b16 a[76:77], v16 offset:1928
v_mov_b32 v237, 0
v_mfma_f32_16x16x32_bf16 v[112:115], a[140:143], a[164:167], v[112:115]
ds_read_b64_tr_b16 a[78:79], v16 offset:1920
v_mov_b32 v238, 0
v_mfma_f32_16x16x32_bf16 v[112:115], a[144:147], a[160:163], v[112:115]
ds_read_b128 a[108:111], v17 offset:1600
v_mov_b32 v239, 0
v_mfma_f32_16x16x32_bf16 v[116:119], a[128:131], a[180:183], v[116:119]
ds_read_b64 v[46:47], v18 offset:1536
v_mov_b32 v240, 0
v_mfma_f32_16x16x32_bf16 v[116:119], a[132:135], a[176:179], v[116:119]
ds_read_b64_tr_b16 a[80:81], v16 offset:2440
v_mov_b32 v241, 0
v_mfma_f32_16x16x32_bf16 v[116:119], a[136:139], a[172:175], v[116:119]
ds_read_b64_tr_b16 a[82:83], v16 offset:2432
v_mov_b32 v242, 0
v_mfma_f32_16x16x32_bf16 v[116:119], a[140:143], a[168:171], v[116:119]
ds_read_b128 a[112:115], v17 offset:2112
v_mov_b32 v243, 0
v_mfma_f32_16x16x32_bf16 v[116:119], a[144:147], a[164:167], v[116:119]
ds_read_b64 v[52:53], v18 offset:2048
v_mov_b32 v244, 0
v_mfma_f32_16x16x32_bf16 v[116:119], a[148:151], a[160:163], v[116:119]
ds_read_b64_tr_b16 a[84:85], v16 offset:2952
v_mov_b32 v245, 0
v_mfma_f32_16x16x32_bf16 v[120:123], a[128:131], a[184:187], v[120:123]
ds_read_b64_tr_b16 a[86:87], v16 offset:2944
v_mov_b32 v246, 0
v_mfma_f32_16x16x32_bf16 v[120:123], a[132:135], a[180:183], v[120:123]
ds_read_b128 a[116:119], v17 offset:2624
v_mov_b32 v247, 0
v_mfma_f32_16x16x32_bf16 v[120:123], a[136:139], a[176:179], v[120:123]
ds_read_b64 v[54:55], v18 offset:2560
v_mov_b32 v248, 0
v_mfma_f32_16x16x32_bf16 v[120:123], a[140:143], a[172:175], v[120:123]
ds_read_b64_tr_b16 a[88:89], v16 offset:3464
v_mov_b32 v249, 0
v_mfma_f32_16x16x32_bf16 v[120:123], a[144:147], a[168:171], v[120:123]
ds_read_b64_tr_b16 a[90:91], v16 offset:3456
v_mov_b32 v250, 0
v_mfma_f32_16x16x32_bf16 v[120:123], a[148:151], a[164:167], v[120:123]
ds_read_b128 a[120:123], v17 offset:3136
v_mov_b32 v251, 0
v_mfma_f32_16x16x32_bf16 v[120:123], a[152:155], a[160:163], v[120:123]
s_waitcnt lgkmcnt(8)
ds_read_b64 v[60:61], v18 offset:3072
v_mov_b32 v252, 0
v_mfma_f32_16x16x32_bf16 v[124:127], a[128:131], a[188:191], v[124:127]
ds_read_b64_tr_b16 a[92:93], v16 offset:3976
v_mov_b32 v253, 0
v_mfma_f32_16x16x32_bf16 v[124:127], a[132:135], a[184:187], v[124:127]
ds_read_b64_tr_b16 a[94:95], v16 offset:3968
v_mov_b32 v254, 0
v_mfma_f32_16x16x32_bf16 v[124:127], a[136:139], a[180:183], v[124:127]
ds_read_b128 a[124:127], v17 offset:3648
v_mov_b32 v255, 0
v_mfma_f32_16x16x32_bf16 v[124:127], a[140:143], a[176:179], v[124:127]
ds_read_b64 v[62:63], v18 offset:3584
v_mfma_f32_16x16x32_bf16 v[124:127], a[144:147], a[172:175], v[124:127]
buffer_load_dwordx4 a[48:51], v1, s[4:7], s22 offen offset:0 sc1
v_mfma_f32_16x16x32_bf16 v[124:127], a[148:151], a[168:171], v[124:127]
buffer_load_dwordx4 a[52:55], v1, s[4:7], s22 offen offset:1024 sc1
v_mfma_f32_16x16x32_bf16 v[124:127], a[152:155], a[164:167], v[124:127]
buffer_load_dwordx4 a[56:59], v1, s[4:7], s22 offen offset:2048 sc1
v_mfma_f32_16x16x32_bf16 v[124:127], a[156:159], a[160:163], v[124:127]
buffer_load_dwordx4 a[60:63], v1, s[4:7], s22 offen offset:3072 sc1
v_mfma_f32_16x16x32_bf16 v[96:99], a[64:67], a[96:99], v[96:99]
ds_read_b64_tr_b16 a[128:129], v16 offset:456
v_mfma_f32_16x16x32_bf16 v[100:103], a[64:67], a[100:103], v[100:103]
ds_read_b64_tr_b16 a[130:131], v16 offset:448
v_mfma_f32_16x16x32_bf16 v[100:103], a[68:71], a[96:99], v[100:103]
ds_read_b128 a[160:163], v17 offset:0
v_mfma_f32_16x16x32_bf16 v[104:107], a[64:67], a[104:107], v[104:107]
v_mfma_f32_16x16x32_bf16 v[104:107], a[68:71], a[100:103], v[104:107]
ds_read_b64_tr_b16 a[132:133], v16 offset:968
v_mfma_f32_16x16x32_bf16 v[104:107], a[72:75], a[96:99], v[104:107]
ds_read_b64_tr_b16 a[134:135], v16 offset:960
v_mfma_f32_16x16x32_bf16 v[108:111], a[64:67], a[108:111], v[108:111]
ds_read_b128 a[164:167], v17 offset:512
v_mfma_f32_16x16x32_bf16 v[108:111], a[68:71], a[104:107], v[108:111]
v_mfma_f32_16x16x32_bf16 v[108:111], a[72:75], a[100:103], v[108:111]
ds_read_b64_tr_b16 a[136:137], v16 offset:1480
v_mfma_f32_16x16x32_bf16 v[108:111], a[76:79], a[96:99], v[108:111]
ds_read_b64_tr_b16 a[138:139], v16 offset:1472
v_mfma_f32_16x16x32_bf16 v[112:115], a[64:67], a[112:115], v[112:115]
ds_read_b128 a[168:171], v17 offset:1024
v_mfma_f32_16x16x32_bf16 v[112:115], a[68:71], a[108:111], v[112:115]
v_mfma_f32_16x16x32_bf16 v[112:115], a[72:75], a[104:107], v[112:115]
ds_read_b64_tr_b16 a[140:141], v16 offset:1992
v_mfma_f32_16x16x32_bf16 v[112:115], a[76:79], a[100:103], v[112:115]
ds_read_b64_tr_b16 a[142:143], v16 offset:1984
v_mfma_f32_16x16x32_bf16 v[112:115], a[80:83], a[96:99], v[112:115]
s_waitcnt lgkmcnt(6)
ds_read_b128 a[172:175], v17 offset:1536
v_mfma_f32_16x16x32_bf16 v[116:119], a[64:67], a[116:119], v[116:119]
v_mfma_f32_16x16x32_bf16 v[116:119], a[68:71], a[112:115], v[116:119]
ds_read_b64_tr_b16 a[144:145], v16 offset:2504
v_mfma_f32_16x16x32_bf16 v[116:119], a[72:75], a[108:111], v[116:119]
ds_read_b64_tr_b16 a[146:147], v16 offset:2496
v_mfma_f32_16x16x32_bf16 v[116:119], a[76:79], a[104:107], v[116:119]
ds_read_b128 a[176:179], v17 offset:2048
v_mfma_f32_16x16x32_bf16 v[116:119], a[80:83], a[100:103], v[116:119]
v_mfma_f32_16x16x32_bf16 v[116:119], a[84:87], a[96:99], v[116:119]
ds_read_b64_tr_b16 a[148:149], v16 offset:3016
v_mfma_f32_16x16x32_bf16 v[120:123], a[64:67], a[120:123], v[120:123]
ds_read_b64_tr_b16 a[150:151], v16 offset:3008
v_mfma_f32_16x16x32_bf16 v[120:123], a[68:71], a[116:119], v[120:123]
ds_read_b128 a[180:183], v17 offset:2560
v_mfma_f32_16x16x32_bf16 v[120:123], a[72:75], a[112:115], v[120:123]
v_mfma_f32_16x16x32_bf16 v[120:123], a[76:79], a[108:111], v[120:123]
ds_read_b64_tr_b16 a[152:153], v16 offset:3528
v_mfma_f32_16x16x32_bf16 v[120:123], a[80:83], a[104:107], v[120:123]
ds_read_b64_tr_b16 a[154:155], v16 offset:3520
v_mfma_f32_16x16x32_bf16 v[120:123], a[84:87], a[100:103], v[120:123]
ds_read_b128 a[184:187], v17 offset:3072
v_mfma_f32_16x16x32_bf16 v[120:123], a[88:91], a[96:99], v[120:123]
v_mfma_f32_16x16x32_bf16 v[124:127], a[64:67], a[124:127], v[124:127]
ds_read_b64_tr_b16 a[156:157], v16 offset:4040
v_mfma_f32_16x16x32_bf16 v[124:127], a[68:71], a[120:123], v[124:127]
ds_read_b64_tr_b16 a[158:159], v16 offset:4032
v_mfma_f32_16x16x32_bf16 v[124:127], a[72:75], a[116:119], v[124:127]
ds_read_b128 a[188:191], v17 offset:3584
v_mfma_f32_16x16x32_bf16 v[124:127], a[76:79], a[112:115], v[124:127]
v_mfma_f32_16x16x32_bf16 v[124:127], a[80:83], a[108:111], v[124:127]
v_mfma_f32_16x16x32_bf16 v[124:127], a[84:87], a[104:107], v[124:127]
v_mfma_f32_16x16x32_bf16 v[124:127], a[88:91], a[100:103], v[124:127]
v_mfma_f32_16x16x32_bf16 v[124:127], a[92:95], a[96:99], v[124:127]
v_mfma_f32_16x16x32_bf16 v[96:99], a[128:131], a[160:163], v[96:99]
s_waitcnt lgkmcnt(3)
v_mfma_f32_16x16x32_bf16 v[100:103], a[128:131], a[164:167], v[100:103]
v_mfma_f32_16x16x32_bf16 v[100:103], a[132:135], a[160:163], v[100:103]
v_mfma_f32_16x16x32_bf16 v[104:107], a[128:131], a[168:171], v[104:107]
v_mfma_f32_16x16x32_bf16 v[104:107], a[132:135], a[164:167], v[104:107]
v_mfma_f32_16x16x32_bf16 v[104:107], a[136:139], a[160:163], v[104:107]
v_mfma_f32_16x16x32_bf16 v[108:111], a[128:131], a[172:175], v[108:111]
v_mfma_f32_16x16x32_bf16 v[108:111], a[132:135], a[168:171], v[108:111]
v_mfma_f32_16x16x32_bf16 v[108:111], a[136:139], a[164:167], v[108:111]
v_lshlrev_b32 v10, 16, v36
v_fmac_f32 v96, v19, v10
v_mfma_f32_16x16x32_bf16 v[108:111], a[140:143], a[160:163], v[108:111]
v_and_b32 v11, 0xffff0000, v36
v_fmac_f32 v97, v19, v11
v_mfma_f32_16x16x32_bf16 v[112:115], a[128:131], a[176:179], v[112:115]
v_lshlrev_b32 v12, 16, v37
v_fmac_f32 v98, v19, v12
v_mfma_f32_16x16x32_bf16 v[112:115], a[132:135], a[172:175], v[112:115]
v_and_b32 v13, 0xffff0000, v37
v_fmac_f32 v99, v19, v13
v_mfma_f32_16x16x32_bf16 v[112:115], a[136:139], a[168:171], v[112:115]
v_cvt_pk_bf16_f32 v96, v96, v97
v_cvt_pk_bf16_f32 v97, v98, v99
v_mfma_f32_16x16x32_bf16 v[112:115], a[140:143], a[164:167], v[112:115]
buffer_store_dwordx2 v[96:97], v8, s[4:7], s83 offen offset:0 sc1
v_mfma_f32_16x16x32_bf16 v[112:115], a[144:147], a[160:163], v[112:115]
v_lshlrev_b32 v10, 16, v38
v_fmac_f32 v100, v19, v10
v_mfma_f32_16x16x32_bf16 v[116:119], a[128:131], a[180:183], v[116:119]
v_and_b32 v11, 0xffff0000, v38
v_fmac_f32 v101, v19, v11
v_mfma_f32_16x16x32_bf16 v[116:119], a[132:135], a[176:179], v[116:119]
v_lshlrev_b32 v12, 16, v39
v_fmac_f32 v102, v19, v12
v_mfma_f32_16x16x32_bf16 v[116:119], a[136:139], a[172:175], v[116:119]
v_and_b32 v13, 0xffff0000, v39
v_fmac_f32 v103, v19, v13
v_mfma_f32_16x16x32_bf16 v[116:119], a[140:143], a[168:171], v[116:119]
v_cvt_pk_bf16_f32 v100, v100, v101
v_cvt_pk_bf16_f32 v101, v102, v103
v_mfma_f32_16x16x32_bf16 v[116:119], a[144:147], a[164:167], v[116:119]
buffer_store_dwordx2 v[100:101], v8, s[4:7], s83 offen offset:512 sc1
v_mfma_f32_16x16x32_bf16 v[116:119], a[148:151], a[160:163], v[116:119]
PAD_31:
s_cbranch_execz M_tret
v_lshlrev_b32 v10, 16, v44
v_fmac_f32 v104, v19, v10
v_mfma_f32_16x16x32_bf16 v[120:123], a[128:131], a[184:187], v[120:123]
v_and_b32 v11, 0xffff0000, v44
v_fmac_f32 v105, v19, v11
v_mfma_f32_16x16x32_bf16 v[120:123], a[132:135], a[180:183], v[120:123]
v_lshlrev_b32 v12, 16, v45
v_fmac_f32 v106, v19, v12
v_mfma_f32_16x16x32_bf16 v[120:123], a[136:139], a[176:179], v[120:123]
v_and_b32 v13, 0xffff0000, v45
v_fmac_f32 v107, v19, v13
v_mfma_f32_16x16x32_bf16 v[120:123], a[140:143], a[172:175], v[120:123]
v_cvt_pk_bf16_f32 v104, v104, v105
v_cvt_pk_bf16_f32 v105, v106, v107
v_mfma_f32_16x16x32_bf16 v[120:123], a[144:147], a[168:171], v[120:123]
buffer_store_dwordx2 v[104:105], v8, s[4:7], s83 offen offset:1024 sc1
v_mfma_f32_16x16x32_bf16 v[120:123], a[148:151], a[164:167], v[120:123]
v_lshlrev_b32 v10, 16, v46
v_fmac_f32 v108, v19, v10
v_mfma_f32_16x16x32_bf16 v[120:123], a[152:155], a[160:163], v[120:123]
s_waitcnt lgkmcnt(0)
v_and_b32 v11, 0xffff0000, v46
v_fmac_f32 v109, v19, v11
v_mfma_f32_16x16x32_bf16 v[124:127], a[128:131], a[188:191], v[124:127]
v_lshlrev_b32 v12, 16, v47
v_fmac_f32 v110, v19, v12
v_mfma_f32_16x16x32_bf16 v[124:127], a[132:135], a[184:187], v[124:127]
v_and_b32 v13, 0xffff0000, v47
v_fmac_f32 v111, v19, v13
v_mfma_f32_16x16x32_bf16 v[124:127], a[136:139], a[180:183], v[124:127]
v_cvt_pk_bf16_f32 v108, v108, v109
v_cvt_pk_bf16_f32 v109, v110, v111
v_mfma_f32_16x16x32_bf16 v[124:127], a[140:143], a[176:179], v[124:127]
buffer_store_dwordx2 v[108:109], v8, s[4:7], s83 offen offset:1536 sc1
v_mfma_f32_16x16x32_bf16 v[124:127], a[144:147], a[172:175], v[124:127]
v_lshlrev_b32 v10, 16, v52
v_fmac_f32 v112, v19, v10
v_mfma_f32_16x16x32_bf16 v[124:127], a[148:151], a[168:171], v[124:127]
v_and_b32 v11, 0xffff0000, v52
v_fmac_f32 v113, v19, v11
v_mfma_f32_16x16x32_bf16 v[124:127], a[152:155], a[164:167], v[124:127]
v_lshlrev_b32 v12, 16, v53
v_fmac_f32 v114, v19, v12
v_mfma_f32_16x16x32_bf16 v[124:127], a[156:159], a[160:163], v[124:127]
v_and_b32 v13, 0xffff0000, v53
v_fmac_f32 v115, v19, v13
v_cvt_pk_bf16_f32 v112, v112, v113
v_cvt_pk_bf16_f32 v113, v114, v115
buffer_store_dwordx2 v[112:113], v8, s[4:7], s83 offen offset:2048 sc1
v_lshlrev_b32 v10, 16, v54
v_fmac_f32 v116, v19, v10
v_and_b32 v11, 0xffff0000, v54
v_fmac_f32 v117, v19, v11
v_lshlrev_b32 v12, 16, v55
v_fmac_f32 v118, v19, v12
v_and_b32 v13, 0xffff0000, v55
v_fmac_f32 v119, v19, v13
v_cvt_pk_bf16_f32 v116, v116, v117
v_cvt_pk_bf16_f32 v117, v118, v119
buffer_store_dwordx2 v[116:117], v8, s[4:7], s83 offen offset:2560 sc1
v_lshlrev_b32 v10, 16, v60
v_fmac_f32 v120, v19, v10
v_and_b32 v11, 0xffff0000, v60
v_fmac_f32 v121, v19, v11
v_lshlrev_b32 v12, 16, v61
v_fmac_f32 v122, v19, v12
v_and_b32 v13, 0xffff0000, v61
v_fmac_f32 v123, v19, v13
v_cvt_pk_bf16_f32 v120, v120, v121
v_cvt_pk_bf16_f32 v121, v122, v123
buffer_store_dwordx2 v[120:121], v8, s[4:7], s83 offen offset:3072 sc1
v_lshlrev_b32 v10, 16, v62
v_fmac_f32 v124, v19, v10
v_and_b32 v11, 0xffff0000, v62
v_fmac_f32 v125, v19, v11
v_lshlrev_b32 v12, 16, v63
v_fmac_f32 v126, v19, v12
v_and_b32 v13, 0xffff0000, v63
v_fmac_f32 v127, v19, v13
v_cvt_pk_bf16_f32 v124, v124, v125
v_cvt_pk_bf16_f32 v125, v126, v127
buffer_store_dwordx2 v[124:125], v8, s[4:7], s83 offen offset:3584 sc1
v_lshrrev_b32 v8, 7, v1
v_and_b32 v9, 6, v8
v_lshlrev_b32 v9, 4, v9
v_and_b32 v10, 0x70, v1
v_xor_b32 v9, v9, v10
v_mul_u32_u24 v8, 896, v8
v_add_u32 v8, v8, v9
v_accvgpr_write_b32 a184, v8
v_add_u32 v8, 6144, v8
v_accvgpr_write_b32 a185, v8
v_add_u32 v8, 6144, v8
v_accvgpr_write_b32 a186, v8
v_add_u32 v8, 6144, v8
v_accvgpr_write_b32 a187, v8
v_lshrrev_b32 v8, 6, v1
v_bfe_u32 v9, v1, 7, 2
v_lshlrev_b32 v9, 5, v9
v_lshl_add_u32 v8, v8, 7, v9
v_bfe_u32 v9, v1, 4, 2
v_lshl_add_u32 v8, v9, 3, v8
v_add_u32 v8, 32768, v8
v_accvgpr_write_b32 a188, v8
v_xor_b32 v9, 32, v8
v_accvgpr_write_b32 a189, v9
v_xor_b32 v9, 64, v8
v_accvgpr_write_b32 a190, v9
v_xor_b32 v9, 96, v8
v_accvgpr_write_b32 a191, v9
s_branch M_t2B
M_t2Br:
s_waitcnt vmcnt(8)
s_barrier
s_cmp_lg_u32 s24, 0
s_cbranch_scc1 K2_item
v_accvgpr_mov_b32 a0, a192
v_accvgpr_mov_b32 a1, a193
v_accvgpr_mov_b32 a2, a194
v_accvgpr_mov_b32 a3, a195
v_accvgpr_mov_b32 a4, a196
v_accvgpr_mov_b32 a5, a197
v_accvgpr_mov_b32 a6, a198
v_accvgpr_mov_b32 a7, a199
v_accvgpr_mov_b32 a8, a200
v_accvgpr_mov_b32 a9, a201
v_accvgpr_mov_b32 a10, a202
v_accvgpr_mov_b32 a11, a203
v_accvgpr_mov_b32 a12, a204
v_accvgpr_mov_b32 a13, a205
v_accvgpr_mov_b32 a14, a206
v_accvgpr_mov_b32 a15, a207
v_accvgpr_mov_b32 a16, a208
v_accvgpr_mov_b32 a17, a209
v_accvgpr_mov_b32 a18, a210
v_accvgpr_mov_b32 a19, a211
v_accvgpr_mov_b32 a20, a212
v_accvgpr_mov_b32 a21, a213
v_accvgpr_mov_b32 a22, a214
v_accvgpr_mov_b32 a23, a215
v_accvgpr_mov_b32 a24, a216
v_accvgpr_mov_b32 a25, a217
v_accvgpr_mov_b32 a26, a218
v_accvgpr_mov_b32 a27, a219
v_accvgpr_mov_b32 a28, a220
v_accvgpr_mov_b32 a29, a221
v_accvgpr_mov_b32 a30, a222
v_accvgpr_mov_b32 a31, a223
v_accvgpr_mov_b32 a32, a224
v_accvgpr_mov_b32 a33, a225
v_accvgpr_mov_b32 a34, a226
v_accvgpr_mov_b32 a35, a227
v_accvgpr_mov_b32 a36, a228
v_accvgpr_mov_b32 a37, a229
v_accvgpr_mov_b32 a38, a230
v_accvgpr_mov_b32 a39, a231
v_accvgpr_mov_b32 a40, a232
v_accvgpr_mov_b32 a41, a233
v_accvgpr_mov_b32 a42, a234
v_accvgpr_mov_b32 a43, a235
v_accvgpr_mov_b32 a44, a236
v_accvgpr_mov_b32 a45, a237
v_accvgpr_mov_b32 a46, a238
v_accvgpr_mov_b32 a47, a239
v_accvgpr_mov_b32 a48, a240
v_accvgpr_mov_b32 a49, a241
v_accvgpr_mov_b32 a50, a242
v_accvgpr_mov_b32 a51, a243
v_accvgpr_mov_b32 a52, a244
v_accvgpr_mov_b32 a53, a245
v_accvgpr_mov_b32 a54, a246
v_accvgpr_mov_b32 a55, a247
v_accvgpr_mov_b32 a56, a248
v_accvgpr_mov_b32 a57, a249
v_accvgpr_mov_b32 a58, a250
v_accvgpr_mov_b32 a59, a251
v_accvgpr_mov_b32 a60, a252
v_accvgpr_mov_b32 a61, a253
v_accvgpr_mov_b32 a62, a254
v_accvgpr_mov_b32 a63, a255
s_branch K2_item
M_cend:
M_cspin:
Lp_16:
buffer_load_dword v14, v15, s[4:7], s31 offen sc1
s_waitcnt vmcnt(0)
v_cmp_gt_u32 vcc, 1, v14
s_cbranch_vccz Lpd_17
s_sleep 8
s_sub_u32 s101, s101, 1
s_cbranch_scc0 Lp_16
s_mov_b32 s101, 0
Lpd_17:
s_branch M_cok
M_kspin:
Lp_18:
buffer_load_dword v21, v20, s[4:7], s70 offen sc1
s_waitcnt vmcnt(0)
v_cmp_gt_u32 vcc, 1, v21
s_cbranch_vccz Lpd_19
s_sleep 8
s_sub_u32 s101, s101, 1
s_cbranch_scc0 Lp_18
s_mov_b32 s101, 0
Lpd_19:
s_branch M_kok
M_kspin2:
Lp_20:
buffer_load_dword v21, v20, s[4:7], s31 offen sc1
s_waitcnt vmcnt(0)
v_cmp_gt_u32 vcc, 1, v21
s_cbranch_vccz Lpd_21
s_sleep 8
s_sub_u32 s101, s101, 1
s_cbranch_scc0 Lp_20
s_mov_b32 s101, 0
Lpd_21:
s_branch M_kok2
M_vspin:
Lp_22:
buffer_load_dword v21, v15, s[4:7], s70 offen sc1
s_waitcnt vmcnt(0)
v_cmp_gt_u32 vcc, 1, v21
s_cbranch_vccz Lpd_23
s_sleep 8
s_sub_u32 s101, s101, 1
s_cbranch_scc0 Lp_22
s_mov_b32 s101, 0
Lpd_23:
s_branch M_vok
PAD_32:
s_cbranch_execz M_tret
K2_plain:
v_mfma_f32_16x16x32_bf16 v[128:131], a[64:67], v[96:99], v[128:131]
s_waitcnt lgkmcnt(6)
ds_read_b128 a[96:99], v2 offset:8192
v_add_f32 v24, v24, v26
v_mfma_f32_16x16x32_bf16 v[128:131], a[68:71], v[100:103], v[128:131]
s_waitcnt lgkmcnt(5)
v_mfma_f32_16x16x32_bf16 v[132:135], a[68:71], v[108:111], v[132:135]
s_mov_b64 s[36:37], s[86:87]
ds_read_b128 a[100:103], v2 offset:9216
v_add_f32 v25, v25, v27
v_mfma_f32_16x16x32_bf16 v[132:135], a[64:67], v[104:107], v[132:135]
s_mov_b32 s38, 3670016
v_exp_f32 v8, v68
v_mfma_f32_16x16x32_bf16 v[136:139], a[72:75], v[96:99], v[136:139]
s_mov_b32 s39, 0x20000
ds_read_b128 a[104:107], v2 offset:10240
v_accvgpr_read_b32 v112, a184
v_mfma_f32_16x16x32_bf16 v[136:139], a[76:79], v[100:103], v[136:139]
v_accvgpr_read_b32 v113, a185
v_accvgpr_read_b32 v114, a186
v_mfma_f32_16x16x32_bf16 v[140:143], a[76:79], v[108:111], v[140:143]
ds_read_b128 a[108:111], v2 offset:11264
v_accvgpr_read_b32 v115, a187
v_mfma_f32_16x16x32_bf16 v[140:143], a[72:75], v[104:107], v[140:143]
s_waitcnt lgkmcnt(5)
v_accvgpr_read_b32 v116, a188
v_accvgpr_read_b32 v117, a189
v_mfma_f32_16x16x32_bf16 v[144:147], a[80:83], v[96:99], v[144:147]
ds_read_b128 a[112:115], v2 offset:12288
v_accvgpr_read_b32 v118, a190
v_mfma_f32_16x16x32_bf16 v[144:147], a[84:87], v[100:103], v[144:147]
v_accvgpr_read_b32 v119, a191
v_mfma_f32_16x16x32_bf16 v[148:151], a[84:87], v[108:111], v[148:151]
s_add_u32 m0, s18, 32768
ds_read_b128 a[116:119], v2 offset:13312
v_cvt_pk_bf16_f32 v128, v128, v129
v_mfma_f32_16x16x32_bf16 v[148:151], a[80:83], v[104:107], v[148:151]
buffer_load_dwordx4 v112, s[36:39], s81 offen offset:0 lds
v_mfma_f32_16x16x32_bf16 v[152:155], a[88:91], v[96:99], v[152:155]
s_waitcnt lgkmcnt(4)
ds_read_b128 a[120:123], v2 offset:14336
v_cvt_pk_bf16_f32 v129, v130, v131
v_mfma_f32_16x16x32_bf16 v[152:155], a[92:95], v[100:103], v[152:155]
v_exp_f32 v9, v69
v_mfma_f32_16x16x32_bf16 v[156:159], a[92:95], v[108:111], v[156:159]
ds_read_b128 a[124:127], v2 offset:15360
v_add_f32 v27, v8, v9
v_mfma_f32_16x16x32_bf16 v[156:159], a[88:91], v[104:107], v[156:159]
buffer_load_dwordx4 v113, s[36:39], s81 offen offset:1024 lds
v_mfma_f32_16x16x32_bf16 v[160:163], a[96:99], v[96:99], v[160:163]
ds_read_b128 a[64:67], v2 offset:16384
v_cvt_pk_bf16_f32 v120, v8, v9
v_mfma_f32_16x16x32_bf16 v[160:163], a[100:103], v[100:103], v[160:163]
v_exp_f32 v10, v70
v_mfma_f32_16x16x32_bf16 v[164:167], a[100:103], v[108:111], v[164:167]
ds_read_b128 a[68:71], v2 offset:17408
v_add_f32 v27, v27, v10
v_mfma_f32_16x16x32_bf16 v[164:167], a[96:99], v[104:107], v[164:167]
s_waitcnt lgkmcnt(4)
buffer_load_dwordx4 v114, s[36:39], s81 offen offset:2048 lds
v_mfma_f32_16x16x32_bf16 v[168:171], a[104:107], v[96:99], v[168:171]
ds_read_b128 a[72:75], v2 offset:18432
v_cvt_pk_bf16_f32 v130, v136, v137
v_mfma_f32_16x16x32_bf16 v[168:171], a[108:111], v[100:103], v[168:171]
v_exp_f32 v11, v71
v_mfma_f32_16x16x32_bf16 v[172:175], a[108:111], v[108:111], v[172:175]
ds_read_b128 a[76:79], v2 offset:19456
v_add_f32 v27, v27, v11
v_mfma_f32_16x16x32_bf16 v[172:175], a[104:107], v[104:107], v[172:175]
buffer_load_dwordx4 v115, s[36:39], s81 offen offset:3072 lds
v_mfma_f32_16x16x32_bf16 v[176:179], a[112:115], v[96:99], v[176:179]
ds_read_b128 a[80:83], v2 offset:20480
v_cvt_pk_bf16_f32 v121, v10, v11
v_mfma_f32_16x16x32_bf16 v[176:179], a[116:119], v[100:103], v[176:179]
s_waitcnt lgkmcnt(4)
v_exp_f32 v12, v76
v_mfma_f32_16x16x32_bf16 v[180:183], a[116:119], v[108:111], v[180:183]
s_add_u32 s81, s81, 28672
ds_read_b128 a[84:87], v2 offset:21504
v_add_f32 v27, v27, v12
v_mfma_f32_16x16x32_bf16 v[180:183], a[112:115], v[104:107], v[180:183]
s_add_u32 m0, s18, 36864
v_exp_f32 v13, v77
v_mfma_f32_16x16x32_bf16 v[184:187], a[120:123], v[96:99], v[184:187]
ds_read_b128 a[88:91], v2 offset:22528
v_add_f32 v27, v27, v13
v_mfma_f32_16x16x32_bf16 v[184:187], a[124:127], v[100:103], v[184:187]
buffer_load_dwordx4 v112, s[36:39], s81 offen offset:0 lds
v_mfma_f32_16x16x32_bf16 v[188:191], a[124:127], v[108:111], v[188:191]
ds_read_b128 a[92:95], v2 offset:23552
v_cvt_pk_bf16_f32 v122, v12, v13
v_mfma_f32_16x16x32_bf16 v[188:191], a[120:123], v[104:107], v[188:191]
v_exp_f32 v14, v78
v_mfma_f32_16x16x32_bf16 v[192:195], a[64:67], v[96:99], v[192:195]
s_waitcnt lgkmcnt(4)
ds_read_b128 a[96:99], v2 offset:24576
v_add_f32 v27, v27, v14
v_mfma_f32_16x16x32_bf16 v[192:195], a[68:71], v[100:103], v[192:195]
buffer_load_dwordx4 v113, s[36:39], s81 offen offset:1024 lds
v_mfma_f32_16x16x32_bf16 v[196:199], a[68:71], v[108:111], v[196:199]
ds_read_b128 a[100:103], v2 offset:25600
v_cvt_pk_bf16_f32 v131, v138, v139
v_mfma_f32_16x16x32_bf16 v[196:199], a[64:67], v[104:107], v[196:199]
v_exp_f32 v15, v79
v_mfma_f32_16x16x32_bf16 v[200:203], a[72:75], v[96:99], v[200:203]
ds_read_b128 a[104:107], v2 offset:26624
v_add_f32 v27, v27, v15
v_mfma_f32_16x16x32_bf16 v[200:203], a[76:79], v[100:103], v[200:203]
buffer_load_dwordx4 v114, s[36:39], s81 offen offset:2048 lds
v_mfma_f32_16x16x32_bf16 v[204:207], a[76:79], v[108:111], v[204:207]
ds_read_b128 a[108:111], v2 offset:27648
v_cvt_pk_bf16_f32 v123, v14, v15
v_mfma_f32_16x16x32_bf16 v[204:207], a[72:75], v[104:107], v[204:207]
s_waitcnt lgkmcnt(4)
v_exp_f32 v8, v84
v_mfma_f32_16x16x32_bf16 v[208:211], a[80:83], v[96:99], v[208:211]
ds_read_b128 a[112:115], v2 offset:28672
v_add_f32 v27, v27, v8
v_mfma_f32_16x16x32_bf16 v[208:211], a[84:87], v[100:103], v[208:211]
buffer_load_dwordx4 v115, s[36:39], s81 offen offset:3072 lds
v_mfma_f32_16x16x32_bf16 v[212:215], a[84:87], v[108:111], v[212:215]
ds_read_b128 a[116:119], v2 offset:29696
v_cvt_pk_bf16_f32 v144, v144, v145
v_mfma_f32_16x16x32_bf16 v[212:215], a[80:83], v[104:107], v[212:215]
v_exp_f32 v9, v85
v_mfma_f32_16x16x32_bf16 v[216:219], a[88:91], v[96:99], v[216:219]
s_sub_u32 s81, s81, 28544
ds_read_b128 a[120:123], v2 offset:30720
v_add_f32 v27, v27, v9
v_mfma_f32_16x16x32_bf16 v[216:219], a[92:95], v[100:103], v[216:219]
v_exp_f32 v10, v86
v_mfma_f32_16x16x32_bf16 v[220:223], a[92:95], v[108:111], v[220:223]
s_waitcnt vmcnt(8) lgkmcnt(4)
ds_read_b128 a[124:127], v2 offset:31744
v_cvt_pk_bf16_f32 v124, v8, v9
v_mfma_f32_16x16x32_bf16 v[220:223], a[88:91], v[104:107], v[220:223]
s_barrier
v_mfma_f32_16x16x32_bf16 v[224:227], a[96:99], v[96:99], v[224:227]
ds_read_b128 a[64:67], v1 offset:0
v_add_f32 v27, v27, v10
v_mfma_f32_16x16x32_bf16 v[224:227], a[100:103], v[100:103], v[224:227]
v_exp_f32 v11, v87
v_mfma_f32_16x16x32_bf16 v[228:231], a[100:103], v[108:111], v[228:231]
ds_read_b128 a[68:71], v1 offset:1024
v_add_f32 v27, v27, v11
v_mfma_f32_16x16x32_bf16 v[228:231], a[96:99], v[104:107], v[228:231]
v_exp_f32 v12, v92
v_mfma_f32_16x16x32_bf16 v[232:235], a[104:107], v[96:99], v[232:235]
s_waitcnt lgkmcnt(4)
ds_read_b128 a[72:75], v1 offset:2048
v_cvt_pk_bf16_f32 v125, v10, v11
v_mfma_f32_16x16x32_bf16 v[232:235], a[108:111], v[100:103], v[232:235]
v_exp_f32 v13, v93
v_mfma_f32_16x16x32_bf16 v[236:239], a[108:111], v[108:111], v[236:239]
ds_read_b128 a[76:79], v1 offset:3072
v_add_f32 v27, v27, v12
v_mfma_f32_16x16x32_bf16 v[236:239], a[104:107], v[104:107], v[236:239]
v_exp_f32 v14, v94
v_mfma_f32_16x16x32_bf16 v[240:243], a[112:115], v[96:99], v[240:243]
ds_read_b128 a[80:83], v1 offset:4096
v_add_f32 v27, v27, v13
v_mfma_f32_16x16x32_bf16 v[240:243], a[116:119], v[100:103], v[240:243]
v_exp_f32 v15, v95
v_mfma_f32_16x16x32_bf16 v[244:247], a[116:119], v[108:111], v[244:247]
ds_read_b128 a[84:87], v1 offset:5120
v_cvt_pk_bf16_f32 v126, v12, v13
v_mfma_f32_16x16x32_bf16 v[244:247], a[112:115], v[104:107], v[244:247]
s_waitcnt lgkmcnt(4)
v_add_f32 v27, v27, v14
v_add_f32 v27, v27, v15
v_mfma_f32_16x16x32_bf16 v[248:251], a[120:123], v[96:99], v[248:251]
ds_read_b128 a[88:91], v1 offset:6144
v_cvt_pk_bf16_f32 v127, v14, v15
v_mfma_f32_16x16x32_bf16 v[248:251], a[124:127], v[100:103], v[248:251]
v_cmp_nge_f32 vcc, s25, v27
v_cvt_pk_bf16_f32 v145, v146, v147
v_mfma_f32_16x16x32_bf16 v[252:255], a[124:127], v[108:111], v[252:255]
ds_read_b128 a[92:95], v1 offset:7168
v_cvt_pk_bf16_f32 v146, v152, v153
v_mfma_f32_16x16x32_bf16 v[252:255], a[120:123], v[104:107], v[252:255]
s_waitcnt lgkmcnt(2)
v_cvt_pk_bf16_f32 v147, v154, v155
v_cvt_pk_bf16_f32 v160, v160, v161
s_cbranch_vccnz Lstub_12
Lback_13:
v_mfma_f32_16x16x32_bf16 v[132:135], a[64:67], v[120:123], v[132:135]
s_lshl_b32 s8, s29, 3
ds_read_b128 a[96:99], v1 offset:8192
v_add_f32 v25, v25, v27
v_mfma_f32_16x16x32_bf16 v[132:135], a[68:71], v[124:127], v[132:135]
s_add_u32 s8, s8, s3
ds_read_b128 a[100:103], v1 offset:9216
v_cvt_pk_bf16_f32 v161, v162, v163
v_mfma_f32_16x16x32_bf16 v[140:143], a[72:75], v[120:123], v[140:143]
s_lshl_b32 s8, s8, 4
ds_read_b128 a[104:107], v1 offset:10240
v_cvt_pk_bf16_f32 v162, v168, v169
v_mfma_f32_16x16x32_bf16 v[140:143], a[76:79], v[124:127], v[140:143]
s_add_u32 s8, s8, s20
ds_read_b128 a[108:111], v1 offset:11264
v_cvt_pk_bf16_f32 v163, v170, v171
v_mfma_f32_16x16x32_bf16 v[148:151], a[80:83], v[120:123], v[148:151]
s_mul_i32 s8, s8, 14336
ds_read_b128 a[112:115], v1 offset:12288
v_cvt_pk_bf16_f32 v176, v176, v177
v_mfma_f32_16x16x32_bf16 v[148:151], a[84:87], v[124:127], v[148:151]
s_waitcnt lgkmcnt(5)
s_add_u32 s8, s8, 104857600
ds_read_b128 a[116:119], v1 offset:13312
v_cvt_pk_bf16_f32 v177, v178, v179
v_mfma_f32_16x16x32_bf16 v[156:159], a[88:91], v[120:123], v[156:159]
s_add_u32 s12, s8, 917504
ds_read_b128 a[120:123], v1 offset:14336
v_cvt_pk_bf16_f32 v178, v184, v185
v_mfma_f32_16x16x32_bf16 v[156:159], a[92:95], v[124:127], v[156:159]
s_waitcnt lgkmcnt(6)
ds_read_b128 a[124:127], v1 offset:15360
v_cvt_pk_bf16_f32 v179, v186, v187
v_mfma_f32_16x16x32_bf16 v[164:167], a[96:99], v[120:123], v[164:167]
s_waitcnt lgkmcnt(6)
ds_read_b128 a[64:67], v1 offset:16384
v_cvt_pk_bf16_f32 v192, v192, v193
v_mfma_f32_16x16x32_bf16 v[164:167], a[100:103], v[124:127], v[164:167]
s_waitcnt lgkmcnt(6)
ds_read_b128 a[68:71], v1 offset:17408
v_cvt_pk_bf16_f32 v193, v194, v195
v_mfma_f32_16x16x32_bf16 v[172:175], a[104:107], v[120:123], v[172:175]
s_waitcnt lgkmcnt(6)
ds_read_b128 a[72:75], v1 offset:18432
v_cvt_pk_bf16_f32 v194, v200, v201
v_mfma_f32_16x16x32_bf16 v[172:175], a[108:111], v[124:127], v[172:175]
s_waitcnt lgkmcnt(6)
ds_read_b128 a[76:79], v1 offset:19456
v_cvt_pk_bf16_f32 v195, v202, v203
v_mfma_f32_16x16x32_bf16 v[180:183], a[112:115], v[120:123], v[180:183]
s_waitcnt lgkmcnt(6)
ds_read_b128 a[80:83], v1 offset:20480
v_cvt_pk_bf16_f32 v208, v208, v209
v_mfma_f32_16x16x32_bf16 v[180:183], a[116:119], v[124:127], v[180:183]
s_waitcnt lgkmcnt(6)
ds_read_b128 a[84:87], v1 offset:21504
v_cvt_pk_bf16_f32 v209, v210, v211
v_mfma_f32_16x16x32_bf16 v[188:191], a[120:123], v[120:123], v[188:191]
s_waitcnt lgkmcnt(6)
ds_read_b128 a[88:91], v1 offset:22528
v_cvt_pk_bf16_f32 v210, v216, v217
v_mfma_f32_16x16x32_bf16 v[188:191], a[124:127], v[124:127], v[188:191]
s_waitcnt lgkmcnt(6)
ds_read_b128 a[92:95], v1 offset:23552
v_cvt_pk_bf16_f32 v211, v218, v219
v_mfma_f32_16x16x32_bf16 v[196:199], a[64:67], v[120:123], v[196:199]
s_waitcnt lgkmcnt(6)
ds_read_b128 a[96:99], v1 offset:24576
v_cvt_pk_bf16_f32 v224, v224, v225
v_mfma_f32_16x16x32_bf16 v[196:199], a[68:71], v[124:127], v[196:199]
s_waitcnt lgkmcnt(6)
ds_read_b128 a[100:103], v1 offset:25600
v_cvt_pk_bf16_f32 v225, v226, v227
v_mfma_f32_16x16x32_bf16 v[204:207], a[72:75], v[120:123], v[204:207]
s_waitcnt lgkmcnt(6)
ds_read_b128 a[104:107], v1 offset:26624
v_cvt_pk_bf16_f32 v226, v232, v233
v_mfma_f32_16x16x32_bf16 v[204:207], a[76:79], v[124:127], v[204:207]
s_waitcnt lgkmcnt(6)
ds_read_b128 a[108:111], v1 offset:27648
v_cvt_pk_bf16_f32 v227, v234, v235
v_mfma_f32_16x16x32_bf16 v[212:215], a[80:83], v[120:123], v[212:215]
s_waitcnt lgkmcnt(6)
ds_read_b128 a[112:115], v1 offset:28672
v_cvt_pk_bf16_f32 v240, v240, v241
v_mfma_f32_16x16x32_bf16 v[212:215], a[84:87], v[124:127], v[212:215]
s_waitcnt lgkmcnt(5)
ds_read_b128 a[116:119], v1 offset:29696
v_cvt_pk_bf16_f32 v241, v242, v243
v_mfma_f32_16x16x32_bf16 v[220:223], a[88:91], v[120:123], v[220:223]
s_add_u32 m0, s18, 98304
ds_read_b128 a[120:123], v1 offset:30720
v_cvt_pk_bf16_f32 v242, v248, v249
v_mfma_f32_16x16x32_bf16 v[220:223], a[92:95], v[124:127], v[220:223]
s_waitcnt lgkmcnt(6)
ds_read_b128 a[124:127], v1 offset:31744
v_cvt_pk_bf16_f32 v243, v250, v251
v_mfma_f32_16x16x32_bf16 v[228:231], a[96:99], v[120:123], v[228:231]
s_waitcnt lgkmcnt(6)
buffer_load_dwordx4 v112, s[36:39], s81 offen offset:0 lds
v_mfma_f32_16x16x32_bf16 v[228:231], a[100:103], v[124:127], v[228:231]
s_waitcnt lgkmcnt(5)
buffer_load_dwordx4 v113, s[36:39], s81 offen offset:1024 lds
v_mfma_f32_16x16x32_bf16 v[236:239], a[104:107], v[120:123], v[236:239]
s_waitcnt lgkmcnt(4)
buffer_load_dwordx4 v114, s[36:39], s81 offen offset:2048 lds
v_mfma_f32_16x16x32_bf16 v[236:239], a[108:111], v[124:127], v[236:239]
s_waitcnt lgkmcnt(1)
buffer_load_dwordx4 v115, s[36:39], s81 offen offset:3072 lds
v_mfma_f32_16x16x32_bf16 v[244:247], a[112:115], v[120:123], v[244:247]
s_add_u32 s81, s81, 28672
v_cvt_pk_bf16_f32 v132, v132, v133
v_cvt_pk_bf16_f32 v133, v134, v135
v_mfma_f32_16x16x32_bf16 v[244:247], a[116:119], v[124:127], v[244:247]
s_add_u32 m0, s18, 102400
v_cvt_pk_bf16_f32 v134, v140, v141
v_cvt_pk_bf16_f32 v135, v142, v143
v_mfma_f32_16x16x32_bf16 v[252:255], a[120:123], v[120:123], v[252:255]
s_waitcnt lgkmcnt(0)
buffer_load_dwordx4 v112, s[36:39], s81 offen offset:0 lds
v_mfma_f32_16x16x32_bf16 v[252:255], a[124:127], v[124:127], v[252:255]
buffer_load_dwordx4 v113, s[36:39], s81 offen offset:1024 lds
buffer_load_dwordx4 v114, s[36:39], s81 offen offset:2048 lds
buffer_load_dwordx4 v115, s[36:39], s81 offen offset:3072 lds
s_sub_u32 s81, s81, 28544
s_add_u32 m0, s18, 131072
s_nop 0
buffer_load_dwordx4 v112, s[36:39], s81 offen offset:0 lds
v_cvt_pk_bf16_f32 v148, v148, v149
v_cvt_pk_bf16_f32 v149, v150, v151
v_cvt_pk_bf16_f32 v150, v156, v157
v_cvt_pk_bf16_f32 v151, v158, v159
buffer_load_dwordx4 v113, s[36:39], s81 offen offset:1024 lds
v_cvt_pk_bf16_f32 v164, v164, v165
v_cvt_pk_bf16_f32 v165, v166, v167
v_cvt_pk_bf16_f32 v166, v172, v173
v_cvt_pk_bf16_f32 v167, v174, v175
buffer_load_dwordx4 v114, s[36:39], s81 offen offset:2048 lds
v_cvt_pk_bf16_f32 v180, v180, v181
v_cvt_pk_bf16_f32 v181, v182, v183
v_cvt_pk_bf16_f32 v182, v188, v189
v_cvt_pk_bf16_f32 v183, v190, v191
buffer_load_dwordx4 v115, s[36:39], s81 offen offset:3072 lds
v_cvt_pk_bf16_f32 v196, v196, v197
v_cvt_pk_bf16_f32 v197, v198, v199
v_cvt_pk_bf16_f32 v198, v204, v205
v_cvt_pk_bf16_f32 v199, v206, v207
s_add_u32 s81, s81, 28672
s_add_u32 m0, s18, 135168
s_nop 0
buffer_load_dwordx4 v112, s[36:39], s81 offen offset:0 lds
v_cvt_pk_bf16_f32 v212, v212, v213
v_cvt_pk_bf16_f32 v213, v214, v215
v_cvt_pk_bf16_f32 v214, v220, v221
v_cvt_pk_bf16_f32 v215, v222, v223
buffer_load_dwordx4 v113, s[36:39], s81 offen offset:1024 lds
v_cvt_pk_bf16_f32 v228, v228, v229
v_cvt_pk_bf16_f32 v229, v230, v231
v_cvt_pk_bf16_f32 v230, v236, v237
v_cvt_pk_bf16_f32 v231, v238, v239
buffer_load_dwordx4 v114, s[36:39], s81 offen offset:2048 lds
v_cvt_pk_bf16_f32 v244, v244, v245
v_cvt_pk_bf16_f32 v245, v246, v247
v_cvt_pk_bf16_f32 v246, v252, v253
v_cvt_pk_bf16_f32 v247, v254, v255
buffer_load_dwordx4 v115, s[36:39], s81 offen offset:3072 lds
s_sub_u32 s81, s81, 28544
s_branch K2_done
K2_cfix:
s_nop 7
v_max_f32 v12, 0, v8
v_exp_f32 v13, -v12
v_sub_f32 v8, v8, v12
v_mul_f32 v24, v24, v13
v_mul_f32 v128, v128, v13
v_mul_f32 v129, v129, v13
v_mul_f32 v130, v130, v13
v_mul_f32 v131, v131, v13
v_mul_f32 v136, v136, v13
v_mul_f32 v137, v137, v13
v_mul_f32 v138, v138, v13
v_mul_f32 v139, v139, v13
v_mul_f32 v144, v144, v13
v_mul_f32 v145, v145, v13
v_mul_f32 v146, v146, v13
v_mul_f32 v147, v147, v13
v_mul_f32 v152, v152, v13
v_mul_f32 v153, v153, v13
v_mul_f32 v154, v154, v13
v_mul_f32 v155, v155, v13
v_mul_f32 v160, v160, v13
v_mul_f32 v161, v161, v13
v_mul_f32 v162, v162, v13
v_mul_f32 v163, v163, v13
v_mul_f32 v168, v168, v13
v_mul_f32 v169, v169, v13
v_mul_f32 v170, v170, v13
v_mul_f32 v171, v171, v13
v_mul_f32 v176, v176, v13
v_mul_f32 v177, v177, v13
v_mul_f32 v178, v178, v13
v_mul_f32 v179, v179, v13
v_mul_f32 v184, v184, v13
v_mul_f32 v185, v185, v13
v_mul_f32 v186, v186, v13
v_mul_f32 v187, v187, v13
v_mul_f32 v192, v192, v13
v_mul_f32 v193, v193, v13
v_mul_f32 v194, v194, v13
v_mul_f32 v195, v195, v13
v_mul_f32 v200, v200, v13
v_mul_f32 v201, v201, v13
v_mul_f32 v202, v202, v13
v_mul_f32 v203, v203, v13
v_mul_f32 v208, v208, v13
v_mul_f32 v209, v209, v13
v_mul_f32 v210, v210, v13
v_mul_f32 v211, v211, v13
v_mul_f32 v216, v216, v13
v_mul_f32 v217, v217, v13
v_mul_f32 v218, v218, v13
v_mul_f32 v219, v219, v13
v_mul_f32 v224, v224, v13
v_mul_f32 v225, v225, v13
v_mul_f32 v226, v226, v13
v_mul_f32 v227, v227, v13
v_mul_f32 v232, v232, v13
v_mul_f32 v233, v233, v13
v_mul_f32 v234, v234, v13
v_mul_f32 v235, v235, v13
v_mul_f32 v240, v240, v13
v_mul_f32 v241, v241, v13
v_mul_f32 v242, v242, v13
v_mul_f32 v243, v243, v13
v_mul_f32 v248, v248, v13
v_mul_f32 v249, v249, v13
v_mul_f32 v250, v250, v13
v_mul_f32 v251, v251, v13
v_max_f32 v12, 0, v10
v_exp_f32 v13, -v12
v_sub_f32 v10, v10, v12
v_mul_f32 v25, v25, v13
v_mul_f32 v132, v132, v13
v_mul_f32 v133, v133, v13
v_mul_f32 v134, v134, v13
v_mul_f32 v135, v135, v13
v_mul_f32 v140, v140, v13
v_mul_f32 v141, v141, v13
v_mul_f32 v142, v142, v13
v_mul_f32 v143, v143, v13
v_mul_f32 v148, v148, v13
v_mul_f32 v149, v149, v13
v_mul_f32 v150, v150, v13
v_mul_f32 v151, v151, v13
v_mul_f32 v156, v156, v13
v_mul_f32 v157, v157, v13
v_mul_f32 v158, v158, v13
v_mul_f32 v159, v159, v13
v_mul_f32 v164, v164, v13
v_mul_f32 v165, v165, v13
v_mul_f32 v166, v166, v13
v_mul_f32 v167, v167, v13
v_mul_f32 v172, v172, v13
v_mul_f32 v173, v173, v13
v_mul_f32 v174, v174, v13
v_mul_f32 v175, v175, v13
v_mul_f32 v180, v180, v13
v_mul_f32 v181, v181, v13
v_mul_f32 v182, v182, v13
v_mul_f32 v183, v183, v13
v_mul_f32 v188, v188, v13
v_mul_f32 v189, v189, v13
v_mul_f32 v190, v190, v13
v_mul_f32 v191, v191, v13
v_mul_f32 v196, v196, v13
v_mul_f32 v197, v197, v13
v_mul_f32 v198, v198, v13
v_mul_f32 v199, v199, v13
v_mul_f32 v204, v204, v13
v_mul_f32 v205, v205, v13
v_mul_f32 v206, v206, v13
v_mul_f32 v207, v207, v13
v_mul_f32 v212, v212, v13
v_mul_f32 v213, v213, v13
v_mul_f32 v214, v214, v13
v_mul_f32 v215, v215, v13
v_mul_f32 v220, v220, v13
v_mul_f32 v221, v221, v13
v_mul_f32 v222, v222, v13
v_mul_f32 v223, v223, v13
v_mul_f32 v228, v228, v13
v_mul_f32 v229, v229, v13
v_mul_f32 v230, v230, v13
v_mul_f32 v231, v231, v13
v_mul_f32 v236, v236, v13
v_mul_f32 v237, v237, v13
v_mul_f32 v238, v238, v13
v_mul_f32 v239, v239, v13
v_mul_f32 v244, v244, v13
v_mul_f32 v245, v245, v13
v_mul_f32 v246, v246, v13
v_mul_f32 v247, v247, v13
v_mul_f32 v252, v252, v13
v_mul_f32 v253, v253, v13
v_mul_f32 v254, v254, v13
v_mul_f32 v255, v255, v13
s_branch K2_cok
K2_tspin:
Lp_9101:
buffer_load_dword v3, off, s[4:7], s80 sc1
s_waitcnt vmcnt(0)
v_cmp_gt_u32 vcc, 1, v3
s_cbranch_vccz Lpd_9102
s_sleep 8
s_sub_u32 s101, s101, 1
s_cbranch_scc0 Lp_9101
s_mov_b32 s101, 0
Lpd_9102:
s_branch K2_tok
K2_p0d:
ds_read_b128 a[64:67], v1 offset:0
ds_read_b128 a[68:71], v1 offset:1024
ds_read_b128 a[72:75], v1 offset:2048
ds_read_b128 a[76:79], v1 offset:3072
ds_read_b128 a[80:83], v1 offset:4096
ds_read_b128 a[84:87], v1 offset:5120
ds_read_b128 a[88:91], v1 offset:6144
ds_read_b128 a[92:95], v1 offset:7168
v_cndmask_b32 v32, 0, v7, s[32:33]
v_cndmask_b32 v33, 0, v7, s[34:35]
v_cndmask_b32 v34, 0, v7, s[36:37]
v_cndmask_b32 v35, 0, v7, s[38:39]
v_cndmask_b32 v40, 0, v7, s[40:41]
v_cndmask_b32 v41, 0, v7, s[42:43]
v_cndmask_b32 v42, 0, v7, s[44:45]
v_cndmask_b32 v43, 0, v7, s[46:47]
s_waitcnt lgkmcnt(7)
v_mfma_f32_16x16x32_bf16 v[32:35], a[64:67], a[0:3], v[32:35]
s_waitcnt lgkmcnt(6)
s_add_u32 m0, s18, 65536
ds_read_b128 a[96:99], v1 offset:8192
v_mfma_f32_16x16x32_bf16 v[32:35], a[68:71], a[4:7], v[32:35]
s_waitcnt lgkmcnt(6)
buffer_load_dwordx4 v1, s[4:7], s12 offen offset:0 sc1 lds
v_mfma_f32_16x16x32_bf16 v[32:35], a[72:75], a[8:11], v[32:35]
s_waitcnt lgkmcnt(5)
ds_read_b128 a[100:103], v1 offset:9216
v_mfma_f32_16x16x32_bf16 v[32:35], a[76:79], a[12:15], v[32:35]
s_waitcnt lgkmcnt(5)
buffer_load_dwordx4 v1, s[4:7], s12 offen offset:1024 sc1 lds
v_mfma_f32_16x16x32_bf16 v[32:35], a[80:83], a[16:19], v[32:35]
s_waitcnt lgkmcnt(4)
ds_read_b128 a[104:107], v1 offset:10240
v_mfma_f32_16x16x32_bf16 v[32:35], a[84:87], a[20:23], v[32:35]
s_waitcnt lgkmcnt(4)
buffer_load_dwordx4 v1, s[4:7], s12 offen offset:2048 sc1 lds
v_mfma_f32_16x16x32_bf16 v[32:35], a[88:91], a[24:27], v[32:35]
s_waitcnt lgkmcnt(3)
ds_read_b128 a[108:111], v1 offset:11264
v_mfma_f32_16x16x32_bf16 v[32:35], a[92:95], a[28:31], v[32:35]
buffer_load_dwordx4 v1, s[4:7], s12 offen offset:3072 sc1 lds
v_mfma_f32_16x16x32_bf16 v[36:39], a[64:67], a[32:35], 0
s_add_u32 s12, s12, 4096
s_add_u32 m0, s18, 69632
ds_read_b128 a[112:115], v1 offset:12288
v_mfma_f32_16x16x32_bf16 v[36:39], a[68:71], a[36:39], v[36:39]
buffer_load_dwordx4 v1, s[4:7], s12 offen offset:0 sc1 lds
v_mfma_f32_16x16x32_bf16 v[36:39], a[72:75], a[40:43], v[36:39]
ds_read_b128 a[116:119], v1 offset:13312
v_mfma_f32_16x16x32_bf16 v[36:39], a[76:79], a[44:47], v[36:39]
buffer_load_dwordx4 v1, s[4:7], s12 offen offset:1024 sc1 lds
v_mfma_f32_16x16x32_bf16 v[36:39], a[80:83], a[48:51], v[36:39]
ds_read_b128 a[120:123], v1 offset:14336
v_max3_f32 v28, v32, v33, v34
v_mfma_f32_16x16x32_bf16 v[36:39], a[84:87], a[52:55], v[36:39]
buffer_load_dwordx4 v1, s[4:7], s12 offen offset:2048 sc1 lds
v_mfma_f32_16x16x32_bf16 v[36:39], a[88:91], a[56:59], v[36:39]
ds_read_b128 a[124:127], v1 offset:15360
v_max_f32 v28, v28, v35
v_mfma_f32_16x16x32_bf16 v[36:39], a[92:95], a[60:63], v[36:39]
s_waitcnt lgkmcnt(4)
buffer_load_dwordx4 v1, s[4:7], s12 offen offset:3072 sc1 lds
v_mfma_f32_16x16x32_bf16 v[40:43], a[96:99], a[0:3], v[40:43]
s_add_u32 s12, s12, 28672
ds_read_b128 a[64:67], v1 offset:16384
v_mov_b32 v30, v28
v_mfma_f32_16x16x32_bf16 v[40:43], a[100:103], a[4:7], v[40:43]
s_waitcnt lgkmcnt(2)
s_sub_u32 s13, s13, 1
v_mfma_f32_16x16x32_bf16 v[40:43], a[104:107], a[8:11], v[40:43]
s_cmp_eq_u32 s13, 0
ds_read_b128 a[68:71], v1 offset:17408
v_permlane16_swap_b32 v28, v30
v_mfma_f32_16x16x32_bf16 v[40:43], a[108:111], a[12:15], v[40:43]
s_cselect_b32 s12, s14, s12
v_max_f32 v28, v28, v30
v_mov_b32 v30, v28
v_mfma_f32_16x16x32_bf16 v[40:43], a[112:115], a[16:19], v[40:43]
s_cselect_b32 s13, s15, s13
ds_read_b128 a[72:75], v1 offset:18432
v_max3_f32 v29, v36, v37, v38
v_mfma_f32_16x16x32_bf16 v[40:43], a[116:119], a[20:23], v[40:43]
s_cselect_b32 s14, 3221225472, s14
v_permlane32_swap_b32 v28, v30
v_max_f32 v28, v28, v30
v_mfma_f32_16x16x32_bf16 v[40:43], a[120:123], a[24:27], v[40:43]
s_waitcnt lgkmcnt(3)
ds_read_b128 a[76:79], v1 offset:19456
v_sub_f32 v16, 0, v28
v_mfma_f32_16x16x32_bf16 v[40:43], a[124:127], a[28:31], v[40:43]
v_sub_f32 v17, 0, v28
v_sub_f32 v18, 0, v28
v_mfma_f32_16x16x32_bf16 v[44:47], a[96:99], a[32:35], 0
ds_read_b128 a[80:83], v1 offset:20480
v_sub_f32 v19, 0, v28
v_mfma_f32_16x16x32_bf16 v[44:47], a[100:103], a[36:39], v[44:47]
v_max_f32 v29, v29, v39
v_mov_b32 v31, v29
v_cndmask_b32 v48, v16, v7, s[48:49]
v_mfma_f32_16x16x32_bf16 v[44:47], a[104:107], a[40:43], v[44:47]
ds_read_b128 a[84:87], v1 offset:21504
v_cndmask_b32 v49, v16, v7, s[50:51]
v_mfma_f32_16x16x32_bf16 v[44:47], a[108:111], a[44:47], v[44:47]
v_permlane16_swap_b32 v29, v31
v_max_f32 v29, v29, v31
v_cndmask_b32 v50, v16, v7, s[52:53]
v_mfma_f32_16x16x32_bf16 v[44:47], a[112:115], a[48:51], v[44:47]
ds_read_b128 a[88:91], v1 offset:22528
v_mov_b32 v31, v29
v_cndmask_b32 v51, v16, v7, s[54:55]
v_mfma_f32_16x16x32_bf16 v[44:47], a[116:119], a[52:55], v[44:47]
v_cndmask_b32 v56, v16, v7, s[56:57]
v_cndmask_b32 v57, v16, v7, s[58:59]
v_mfma_f32_16x16x32_bf16 v[44:47], a[120:123], a[56:59], v[44:47]
ds_read_b128 a[92:95], v1 offset:23552
v_permlane32_swap_b32 v29, v31
v_mfma_f32_16x16x32_bf16 v[44:47], a[124:127], a[60:63], v[44:47]
s_waitcnt lgkmcnt(4)
v_max_f32 v29, v29, v31
v_sub_f32 v20, 0, v29
v_mfma_f32_16x16x32_bf16 v[48:51], a[64:67], a[0:3], v[48:51]
ds_read_b128 a[96:99], v1 offset:24576
v_sub_f32 v21, 0, v29
v_mfma_f32_16x16x32_bf16 v[48:51], a[68:71], a[4:7], v[48:51]
v_sub_f32 v22, 0, v29
v_sub_f32 v23, 0, v29
v_mfma_f32_16x16x32_bf16 v[48:51], a[72:75], a[8:11], v[48:51]
ds_read_b128 a[100:103], v1 offset:25600
v_cndmask_b32 v58, v16, v7, s[60:61]
v_mfma_f32_16x16x32_bf16 v[48:51], a[76:79], a[12:15], v[48:51]
s_waitcnt lgkmcnt(4)
v_cndmask_b32 v59, v16, v7, s[62:63]
v_mfma_f32_16x16x32_bf16 v[48:51], a[80:83], a[16:19], v[48:51]
ds_read_b128 a[104:107], v1 offset:26624
v_mfma_f32_16x16x32_bf16 v[48:51], a[84:87], a[20:23], v[48:51]
s_waitcnt lgkmcnt(4)
v_add_f32 v32, v32, v16
v_add_f32 v33, v33, v16
v_add_f32 v34, v34, v16
v_add_f32 v35, v35, v16
v_mfma_f32_16x16x32_bf16 v[48:51], a[88:91], a[24:27], v[48:51]
s_waitcnt lgkmcnt(3)
ds_read_b128 a[108:111], v1 offset:27648
v_add_f32 v36, v36, v20
v_add_f32 v37, v37, v20
v_add_f32 v38, v38, v20
v_add_f32 v39, v39, v20
v_mfma_f32_16x16x32_bf16 v[48:51], a[92:95], a[28:31], v[48:51]
v_add_f32 v40, v40, v16
v_add_f32 v41, v41, v16
v_add_f32 v42, v42, v16
v_add_f32 v43, v43, v16
v_mfma_f32_16x16x32_bf16 v[52:55], a[64:67], a[32:35], v[20:23]
ds_read_b128 a[112:115], v1 offset:28672
v_add_f32 v44, v44, v20
v_add_f32 v45, v45, v20
v_add_f32 v46, v46, v20
v_add_f32 v47, v47, v20
v_mfma_f32_16x16x32_bf16 v[52:55], a[68:71], a[36:39], v[52:55]
v_exp_f32 v8, v32
v_mfma_f32_16x16x32_bf16 v[52:55], a[72:75], a[40:43], v[52:55]
ds_read_b128 a[116:119], v1 offset:29696
v_exp_f32 v9, v33
v_mfma_f32_16x16x32_bf16 v[52:55], a[76:79], a[44:47], v[52:55]
v_exp_f32 v10, v34
v_add_f32 v26, v8, v9
v_cvt_pk_bf16_f32 v96, v8, v9
v_mfma_f32_16x16x32_bf16 v[52:55], a[80:83], a[48:51], v[52:55]
ds_read_b128 a[120:123], v1 offset:30720
v_exp_f32 v11, v35
v_add_f32 v26, v26, v10
v_mfma_f32_16x16x32_bf16 v[52:55], a[84:87], a[52:55], v[52:55]
v_exp_f32 v12, v36
v_add_f32 v26, v26, v11
v_cvt_pk_bf16_f32 v97, v10, v11
v_mfma_f32_16x16x32_bf16 v[52:55], a[88:91], a[56:59], v[52:55]
s_waitcnt vmcnt(8) lgkmcnt(4)
ds_read_b128 a[124:127], v1 offset:31744
v_exp_f32 v13, v37
v_mfma_f32_16x16x32_bf16 v[52:55], a[92:95], a[60:63], v[52:55]
s_barrier
v_mfma_f32_16x16x32_bf16 v[56:59], a[96:99], a[0:3], v[56:59]
ds_read_b128 a[64:67], v4 offset:0
v_exp_f32 v14, v38
v_mfma_f32_16x16x32_bf16 v[56:59], a[100:103], a[4:7], v[56:59]
buffer_store_dword v6, v5, s[4:7], s71 offen sc1
v_mfma_f32_16x16x32_bf16 v[56:59], a[104:107], a[8:11], v[56:59]
s_waitcnt lgkmcnt(4)
ds_read_b128 a[68:71], v4 offset:1024
v_add_f32 v27, v12, v13
v_cvt_pk_bf16_f32 v104, v12, v13
v_add_f32 v27, v27, v14
v_mfma_f32_16x16x32_bf16 v[56:59], a[108:111], a[12:15], v[56:59]
v_exp_f32 v15, v39
v_mfma_f32_16x16x32_bf16 v[56:59], a[112:115], a[16:19], v[56:59]
s_waitcnt lgkmcnt(4)
ds_read_b128 a[72:75], v4 offset:2048
v_exp_f32 v8, v40
v_add_f32 v27, v27, v15
v_cvt_pk_bf16_f32 v105, v14, v15
v_mfma_f32_16x16x32_bf16 v[56:59], a[116:119], a[20:23], v[56:59]
s_waitcnt lgkmcnt(4)
v_exp_f32 v9, v41
v_add_f32 v26, v26, v8
v_mfma_f32_16x16x32_bf16 v[56:59], a[120:123], a[24:27], v[56:59]
s_waitcnt lgkmcnt(3)
ds_read_b128 a[76:79], v4 offset:3072
v_exp_f32 v10, v42
v_add_f32 v26, v26, v9
v_cvt_pk_bf16_f32 v98, v8, v9
v_mfma_f32_16x16x32_bf16 v[56:59], a[124:127], a[28:31], v[56:59]
v_exp_f32 v11, v43
v_add_f32 v26, v26, v10
v_mfma_f32_16x16x32_bf16 v[60:63], a[96:99], a[32:35], v[20:23]
ds_read_b128 a[80:83], v4 offset:4096
v_exp_f32 v12, v44
v_mfma_f32_16x16x32_bf16 v[60:63], a[100:103], a[36:39], v[60:63]
v_exp_f32 v13, v45
v_mfma_f32_16x16x32_bf16 v[60:63], a[104:107], a[40:43], v[60:63]
ds_read_b128 a[84:87], v4 offset:5120
v_exp_f32 v14, v46
v_mfma_f32_16x16x32_bf16 v[60:63], a[108:111], a[44:47], v[60:63]
v_exp_f32 v15, v47
v_mfma_f32_16x16x32_bf16 v[60:63], a[112:115], a[48:51], v[60:63]
ds_read_b128 a[88:91], v4 offset:6144
v_add_f32 v26, v26, v11
v_cvt_pk_bf16_f32 v99, v10, v11
v_mfma_f32_16x16x32_bf16 v[60:63], a[116:119], a[52:55], v[60:63]
v_add_f32 v27, v27, v12
v_add_f32 v27, v27, v13
v_cvt_pk_bf16_f32 v106, v12, v13
v_mfma_f32_16x16x32_bf16 v[60:63], a[120:123], a[56:59], v[60:63]
s_waitcnt lgkmcnt(7)
s_barrier
ds_read_b128 a[92:95], v4 offset:7168
v_mfma_f32_16x16x32_bf16 v[60:63], a[124:127], a[60:63], v[60:63]
s_waitcnt lgkmcnt(4)
v_add_f32 v27, v27, v14
v_add_f32 v27, v27, v15
v_cvt_pk_bf16_f32 v107, v14, v15
s_branch K2_dx1
PAD_33:
s_cbranch_execz M_tret
K2_ntail:
v_mfma_f32_16x16x32_bf16 v[128:131], a[64:67], v[96:99], v[128:131]
s_add_u32 m0, s18, 98304
ds_read_b128 a[96:99], v2 offset:8192
v_add_f32 v24, v24, v26
v_mfma_f32_16x16x32_bf16 v[128:131], a[68:71], v[100:103], v[128:131]
buffer_load_dwordx4 v1, s[4:7], s12 offen offset:0 sc1 lds
v_mfma_f32_16x16x32_bf16 v[132:135], a[68:71], v[108:111], v[132:135]
ds_read_b128 a[100:103], v2 offset:9216
v_add_f32 v25, v25, v27
v_mfma_f32_16x16x32_bf16 v[132:135], a[64:67], v[104:107], v[132:135]
buffer_load_dwordx4 v1, s[4:7], s12 offen offset:1024 sc1 lds
v_mfma_f32_16x16x32_bf16 v[136:139], a[72:75], v[96:99], v[136:139]
ds_read_b128 a[104:107], v2 offset:10240
v_exp_f32 v8, v64
v_mfma_f32_16x16x32_bf16 v[136:139], a[76:79], v[100:103], v[136:139]
buffer_load_dwordx4 v1, s[4:7], s12 offen offset:2048 sc1 lds
v_mfma_f32_16x16x32_bf16 v[140:143], a[76:79], v[108:111], v[140:143]
ds_read_b128 a[108:111], v2 offset:11264
v_mfma_f32_16x16x32_bf16 v[140:143], a[72:75], v[104:107], v[140:143]
s_waitcnt lgkmcnt(4)
buffer_load_dwordx4 v1, s[4:7], s12 offen offset:3072 sc1 lds
v_mfma_f32_16x16x32_bf16 v[144:147], a[80:83], v[96:99], v[144:147]
s_add_u32 s12, s12, 4096
s_add_u32 m0, s18, 102400
ds_read_b128 a[112:115], v2 offset:12288
v_mfma_f32_16x16x32_bf16 v[144:147], a[84:87], v[100:103], v[144:147]
buffer_load_dwordx4 v1, s[4:7], s12 offen offset:0 sc1 lds
v_mfma_f32_16x16x32_bf16 v[148:151], a[84:87], v[108:111], v[148:151]
ds_read_b128 a[116:119], v2 offset:13312
v_exp_f32 v9, v65
v_mfma_f32_16x16x32_bf16 v[148:151], a[80:83], v[104:107], v[148:151]
buffer_load_dwordx4 v1, s[4:7], s12 offen offset:1024 sc1 lds
v_mfma_f32_16x16x32_bf16 v[152:155], a[88:91], v[96:99], v[152:155]
ds_read_b128 a[120:123], v2 offset:14336
v_add_f32 v26, v8, v9
v_cvt_pk_bf16_f32 v112, v8, v9
v_mfma_f32_16x16x32_bf16 v[152:155], a[92:95], v[100:103], v[152:155]
buffer_load_dwordx4 v1, s[4:7], s12 offen offset:2048 sc1 lds
v_mfma_f32_16x16x32_bf16 v[156:159], a[92:95], v[108:111], v[156:159]
ds_read_b128 a[124:127], v2 offset:15360
v_exp_f32 v10, v66
v_mfma_f32_16x16x32_bf16 v[156:159], a[88:91], v[104:107], v[156:159]
s_waitcnt lgkmcnt(4)
buffer_load_dwordx4 v1, s[4:7], s12 offen offset:3072 sc1 lds
v_mfma_f32_16x16x32_bf16 v[160:163], a[96:99], v[96:99], v[160:163]
s_add_u32 s12, s12, 28672
ds_read_b128 a[64:67], v2 offset:16384
v_add_f32 v26, v26, v10
v_mfma_f32_16x16x32_bf16 v[160:163], a[100:103], v[100:103], v[160:163]
s_sub_u32 s13, s13, 1
v_exp_f32 v11, v67
v_mfma_f32_16x16x32_bf16 v[164:167], a[100:103], v[108:111], v[164:167]
s_cmp_eq_u32 s13, 0
ds_read_b128 a[68:71], v2 offset:17408
v_exp_f32 v12, v68
v_mfma_f32_16x16x32_bf16 v[164:167], a[96:99], v[104:107], v[164:167]
s_cselect_b32 s12, s14, s12
v_exp_f32 v13, v69
v_mfma_f32_16x16x32_bf16 v[168:171], a[104:107], v[96:99], v[168:171]
s_cselect_b32 s13, s15, s13
ds_read_b128 a[72:75], v2 offset:18432
v_add_f32 v26, v26, v11
v_cvt_pk_bf16_f32 v113, v10, v11
v_mfma_f32_16x16x32_bf16 v[168:171], a[108:111], v[100:103], v[168:171]
s_cselect_b32 s14, 3221225472, s14
v_exp_f32 v14, v70
v_mfma_f32_16x16x32_bf16 v[172:175], a[108:111], v[108:111], v[172:175]
ds_read_b128 a[76:79], v2 offset:19456
v_exp_f32 v15, v71
v_mfma_f32_16x16x32_bf16 v[172:175], a[104:107], v[104:107], v[172:175]
s_waitcnt lgkmcnt(4)
v_exp_f32 v8, v72
v_mfma_f32_16x16x32_bf16 v[176:179], a[112:115], v[96:99], v[176:179]
ds_read_b128 a[80:83], v2 offset:20480
v_add_f32 v27, v12, v13
v_cvt_pk_bf16_f32 v120, v12, v13
v_add_f32 v27, v27, v14
v_add_f32 v27, v27, v15
v_cvt_pk_bf16_f32 v121, v14, v15
v_mfma_f32_16x16x32_bf16 v[176:179], a[116:119], v[100:103], v[176:179]
v_exp_f32 v9, v73
v_mfma_f32_16x16x32_bf16 v[180:183], a[116:119], v[108:111], v[180:183]
ds_read_b128 a[84:87], v2 offset:21504
v_exp_f32 v10, v74
v_mfma_f32_16x16x32_bf16 v[180:183], a[112:115], v[104:107], v[180:183]
v_exp_f32 v11, v75
v_mfma_f32_16x16x32_bf16 v[184:187], a[120:123], v[96:99], v[184:187]
ds_read_b128 a[88:91], v2 offset:22528
v_add_f32 v26, v26, v8
v_mfma_f32_16x16x32_bf16 v[184:187], a[124:127], v[100:103], v[184:187]
v_exp_f32 v12, v76
v_mfma_f32_16x16x32_bf16 v[188:191], a[124:127], v[108:111], v[188:191]
ds_read_b128 a[92:95], v2 offset:23552
v_add_f32 v26, v26, v9
v_cvt_pk_bf16_f32 v114, v8, v9
v_add_f32 v26, v26, v10
v_add_f32 v26, v26, v11
v_cvt_pk_bf16_f32 v115, v10, v11
v_mfma_f32_16x16x32_bf16 v[188:191], a[120:123], v[104:107], v[188:191]
s_waitcnt lgkmcnt(4)
v_exp_f32 v13, v77
v_mfma_f32_16x16x32_bf16 v[192:195], a[64:67], v[96:99], v[192:195]
ds_read_b128 a[96:99], v2 offset:24576
v_exp_f32 v14, v78
v_mfma_f32_16x16x32_bf16 v[192:195], a[68:71], v[100:103], v[192:195]
v_exp_f32 v15, v79
v_mfma_f32_16x16x32_bf16 v[196:199], a[68:71], v[108:111], v[196:199]
ds_read_b128 a[100:103], v2 offset:25600
v_add_f32 v27, v27, v12
v_add_f32 v27, v27, v13
v_cvt_pk_bf16_f32 v122, v12, v13
v_add_f32 v27, v27, v14
v_mfma_f32_16x16x32_bf16 v[196:199], a[64:67], v[104:107], v[196:199]
v_exp_f32 v8, v80
v_mfma_f32_16x16x32_bf16 v[200:203], a[72:75], v[96:99], v[200:203]
ds_read_b128 a[104:107], v2 offset:26624
v_exp_f32 v9, v81
v_mfma_f32_16x16x32_bf16 v[200:203], a[76:79], v[100:103], v[200:203]
v_exp_f32 v10, v82
v_mfma_f32_16x16x32_bf16 v[204:207], a[76:79], v[108:111], v[204:207]
ds_read_b128 a[108:111], v2 offset:27648
v_add_f32 v27, v27, v15
v_cvt_pk_bf16_f32 v123, v14, v15
v_add_f32 v26, v26, v8
v_add_f32 v26, v26, v9
v_cvt_pk_bf16_f32 v116, v8, v9
v_mfma_f32_16x16x32_bf16 v[204:207], a[72:75], v[104:107], v[204:207]
s_waitcnt lgkmcnt(4)
v_exp_f32 v11, v83
v_mfma_f32_16x16x32_bf16 v[208:211], a[80:83], v[96:99], v[208:211]
ds_read_b128 a[112:115], v2 offset:28672
v_exp_f32 v12, v84
v_mfma_f32_16x16x32_bf16 v[208:211], a[84:87], v[100:103], v[208:211]
v_exp_f32 v13, v85
v_mfma_f32_16x16x32_bf16 v[212:215], a[84:87], v[108:111], v[212:215]
ds_read_b128 a[116:119], v2 offset:29696
v_add_f32 v26, v26, v10
v_add_f32 v26, v26, v11
v_cvt_pk_bf16_f32 v117, v10, v11
v_add_f32 v27, v27, v12
v_mfma_f32_16x16x32_bf16 v[212:215], a[80:83], v[104:107], v[212:215]
v_exp_f32 v14, v86
v_mfma_f32_16x16x32_bf16 v[216:219], a[88:91], v[96:99], v[216:219]
ds_read_b128 a[120:123], v2 offset:30720
v_exp_f32 v15, v87
v_mfma_f32_16x16x32_bf16 v[216:219], a[92:95], v[100:103], v[216:219]
v_exp_f32 v8, v88
v_mfma_f32_16x16x32_bf16 v[220:223], a[92:95], v[108:111], v[220:223]
s_waitcnt vmcnt(0) lgkmcnt(4)
ds_read_b128 a[124:127], v2 offset:31744
v_add_f32 v27, v27, v13
v_cvt_pk_bf16_f32 v124, v12, v13
v_add_f32 v27, v27, v14
v_add_f32 v27, v27, v15
v_cvt_pk_bf16_f32 v125, v14, v15
v_mfma_f32_16x16x32_bf16 v[220:223], a[88:91], v[104:107], v[220:223]
s_barrier
v_mfma_f32_16x16x32_bf16 v[224:227], a[96:99], v[96:99], v[224:227]
ds_read_b128 a[64:67], v2 offset:32768
v_exp_f32 v9, v89
v_mfma_f32_16x16x32_bf16 v[224:227], a[100:103], v[100:103], v[224:227]
v_exp_f32 v10, v90
v_mfma_f32_16x16x32_bf16 v[228:231], a[100:103], v[108:111], v[228:231]
ds_read_b128 a[68:71], v2 offset:33792
v_add_f32 v26, v26, v8
v_add_f32 v26, v26, v9
v_cvt_pk_bf16_f32 v118, v8, v9
v_mfma_f32_16x16x32_bf16 v[228:231], a[96:99], v[104:107], v[228:231]
v_exp_f32 v11, v91
v_mfma_f32_16x16x32_bf16 v[232:235], a[104:107], v[96:99], v[232:235]
s_waitcnt lgkmcnt(4)
ds_read_b128 a[72:75], v2 offset:34816
v_exp_f32 v12, v92
v_mfma_f32_16x16x32_bf16 v[232:235], a[108:111], v[100:103], v[232:235]
v_exp_f32 v13, v93
v_mfma_f32_16x16x32_bf16 v[236:239], a[108:111], v[108:111], v[236:239]
ds_read_b128 a[76:79], v2 offset:35840
v_add_f32 v26, v26, v10
v_mfma_f32_16x16x32_bf16 v[236:239], a[104:107], v[104:107], v[236:239]
v_exp_f32 v14, v94
v_mfma_f32_16x16x32_bf16 v[240:243], a[112:115], v[96:99], v[240:243]
ds_read_b128 a[80:83], v2 offset:36864
v_add_f32 v26, v26, v11
v_cvt_pk_bf16_f32 v119, v10, v11
v_add_f32 v27, v27, v12
v_mfma_f32_16x16x32_bf16 v[240:243], a[116:119], v[100:103], v[240:243]
v_exp_f32 v15, v95
v_mfma_f32_16x16x32_bf16 v[244:247], a[116:119], v[108:111], v[244:247]
ds_read_b128 a[84:87], v2 offset:37888
v_add_f32 v27, v27, v13
v_cvt_pk_bf16_f32 v126, v12, v13
v_mfma_f32_16x16x32_bf16 v[244:247], a[112:115], v[104:107], v[244:247]
s_waitcnt lgkmcnt(4)
v_add_f32 v27, v27, v14
v_add_f32 v27, v27, v15
v_mfma_f32_16x16x32_bf16 v[248:251], a[120:123], v[96:99], v[248:251]
ds_read_b128 a[88:91], v2 offset:38912
v_cvt_pk_bf16_f32 v127, v14, v15
v_mfma_f32_16x16x32_bf16 v[248:251], a[124:127], v[100:103], v[248:251]
v_add_f32 v28, v26, v27
v_cmp_nge_f32 vcc, s25, v28
v_mfma_f32_16x16x32_bf16 v[252:255], a[124:127], v[108:111], v[252:255]
ds_read_b128 a[92:95], v2 offset:39936
v_mfma_f32_16x16x32_bf16 v[252:255], a[120:123], v[104:107], v[252:255]
s_cbranch_vccnz Lstub_14
Lback_15:
v_mfma_f32_16x16x32_bf16 v[128:131], a[64:67], v[112:115], v[128:131]
s_add_u32 m0, s18, 131072
ds_read_b128 a[96:99], v2 offset:40960
v_add_f32 v24, v24, v26
v_mfma_f32_16x16x32_bf16 v[128:131], a[68:71], v[116:119], v[128:131]
buffer_load_dwordx4 v1, s[4:7], s8 offen offset:0 sc1 lds
v_mfma_f32_16x16x32_bf16 v[132:135], a[68:71], v[124:127], v[132:135]
ds_read_b128 a[100:103], v2 offset:41984
v_add_f32 v25, v25, v27
v_mfma_f32_16x16x32_bf16 v[132:135], a[64:67], v[120:123], v[132:135]
s_waitcnt lgkmcnt(4)
buffer_load_dwordx4 v1, s[4:7], s8 offen offset:1024 sc1 lds
v_mfma_f32_16x16x32_bf16 v[136:139], a[72:75], v[112:115], v[136:139]
ds_read_b128 a[104:107], v2 offset:43008
v_mov_b32 v8, v16
v_mfma_f32_16x16x32_bf16 v[136:139], a[76:79], v[116:119], v[136:139]
buffer_load_dwordx4 v1, s[4:7], s8 offen offset:2048 sc1 lds
v_mfma_f32_16x16x32_bf16 v[140:143], a[76:79], v[124:127], v[140:143]
ds_read_b128 a[108:111], v2 offset:44032
v_mov_b32 v9, v24
v_mfma_f32_16x16x32_bf16 v[140:143], a[72:75], v[120:123], v[140:143]
buffer_load_dwordx4 v1, s[4:7], s8 offen offset:3072 sc1 lds
v_mfma_f32_16x16x32_bf16 v[144:147], a[80:83], v[112:115], v[144:147]
s_add_u32 s8, s8, 4096
s_add_u32 m0, s18, 135168
ds_read_b128 a[112:115], v2 offset:45056
v_mfma_f32_16x16x32_bf16 v[144:147], a[84:87], v[116:119], v[144:147]
buffer_load_dwordx4 v1, s[4:7], s8 offen offset:0 sc1 lds
v_mfma_f32_16x16x32_bf16 v[148:151], a[84:87], v[124:127], v[148:151]
ds_read_b128 a[116:119], v2 offset:46080
v_mov_b32 v10, v20
v_mfma_f32_16x16x32_bf16 v[148:151], a[80:83], v[120:123], v[148:151]
s_waitcnt lgkmcnt(4)
buffer_load_dwordx4 v1, s[4:7], s8 offen offset:1024 sc1 lds
v_mfma_f32_16x16x32_bf16 v[152:155], a[88:91], v[112:115], v[152:155]
ds_read_b128 a[120:123], v2 offset:47104
v_mov_b32 v11, v25
v_mfma_f32_16x16x32_bf16 v[152:155], a[92:95], v[116:119], v[152:155]
buffer_load_dwordx4 v1, s[4:7], s8 offen offset:2048 sc1 lds
v_mfma_f32_16x16x32_bf16 v[156:159], a[92:95], v[124:127], v[156:159]
ds_read_b128 a[124:127], v2 offset:48128
v_cvt_pk_bf16_f32 v128, v128, v129
v_mfma_f32_16x16x32_bf16 v[156:159], a[88:91], v[120:123], v[156:159]
s_waitcnt lgkmcnt(4)
buffer_load_dwordx4 v1, s[4:7], s8 offen offset:3072 sc1 lds
v_mfma_f32_16x16x32_bf16 v[160:163], a[96:99], v[112:115], v[160:163]
s_add_u32 s8, s8, 28672
ds_read_b128 a[64:67], v2 offset:49152
v_cvt_pk_bf16_f32 v129, v130, v131
v_mfma_f32_16x16x32_bf16 v[160:163], a[100:103], v[116:119], v[160:163]
s_sub_u32 s9, s9, 1
buffer_store_dwordx4 v[8:11], v1, s[4:7], s27 offen sc1
v_mfma_f32_16x16x32_bf16 v[164:167], a[100:103], v[124:127], v[164:167]
s_cmp_eq_u32 s9, 0
ds_read_b128 a[68:71], v2 offset:50176
v_cvt_pk_bf16_f32 v130, v136, v137
v_mfma_f32_16x16x32_bf16 v[164:167], a[96:99], v[120:123], v[164:167]
s_cselect_b32 s8, s10, s8
v_cvt_pk_bf16_f32 v131, v138, v139
v_accvgpr_mov_b32 a0, a192
v_mfma_f32_16x16x32_bf16 v[168:171], a[104:107], v[112:115], v[168:171]
s_cselect_b32 s9, s11, s9
ds_read_b128 a[72:75], v2 offset:51200
v_accvgpr_mov_b32 a1, a193
v_mfma_f32_16x16x32_bf16 v[168:171], a[108:111], v[116:119], v[168:171]
s_cselect_b32 s10, 3221225472, s10
buffer_store_dwordx4 v[128:131], v1, s[4:7], s76 offen offset:0 sc1
v_mfma_f32_16x16x32_bf16 v[172:175], a[108:111], v[124:127], v[172:175]
ds_read_b128 a[76:79], v2 offset:52224
v_cvt_pk_bf16_f32 v132, v132, v133
v_mfma_f32_16x16x32_bf16 v[172:175], a[104:107], v[120:123], v[172:175]
s_waitcnt lgkmcnt(4)
v_cvt_pk_bf16_f32 v133, v134, v135
v_cvt_pk_bf16_f32 v134, v140, v141
v_mfma_f32_16x16x32_bf16 v[176:179], a[112:115], v[112:115], v[176:179]
ds_read_b128 a[80:83], v2 offset:53248
v_cvt_pk_bf16_f32 v135, v142, v143
v_mfma_f32_16x16x32_bf16 v[176:179], a[116:119], v[116:119], v[176:179]
buffer_store_dwordx4 v[132:135], v1, s[4:7], s77 offen offset:0 sc1
v_mfma_f32_16x16x32_bf16 v[180:183], a[116:119], v[124:127], v[180:183]
ds_read_b128 a[84:87], v2 offset:54272
v_cvt_pk_bf16_f32 v144, v144, v145
v_mfma_f32_16x16x32_bf16 v[180:183], a[112:115], v[120:123], v[180:183]
v_cvt_pk_bf16_f32 v145, v146, v147
v_cvt_pk_bf16_f32 v146, v152, v153
v_mfma_f32_16x16x32_bf16 v[184:187], a[120:123], v[112:115], v[184:187]
ds_read_b128 a[88:91], v2 offset:55296
v_cvt_pk_bf16_f32 v147, v154, v155
v_mfma_f32_16x16x32_bf16 v[184:187], a[124:127], v[116:119], v[184:187]
buffer_store_dwordx4 v[144:147], v1, s[4:7], s76 offen offset:1024 sc1
v_mfma_f32_16x16x32_bf16 v[188:191], a[124:127], v[124:127], v[188:191]
ds_read_b128 a[92:95], v2 offset:56320
v_cvt_pk_bf16_f32 v148, v148, v149
v_mfma_f32_16x16x32_bf16 v[188:191], a[120:123], v[120:123], v[188:191]
s_waitcnt lgkmcnt(4)
v_cvt_pk_bf16_f32 v149, v150, v151
v_cvt_pk_bf16_f32 v150, v156, v157
v_mfma_f32_16x16x32_bf16 v[192:195], a[64:67], v[112:115], v[192:195]
ds_read_b128 a[96:99], v2 offset:57344
v_cvt_pk_bf16_f32 v151, v158, v159
v_mfma_f32_16x16x32_bf16 v[192:195], a[68:71], v[116:119], v[192:195]
buffer_store_dwordx4 v[148:151], v1, s[4:7], s77 offen offset:1024 sc1
v_mfma_f32_16x16x32_bf16 v[196:199], a[68:71], v[124:127], v[196:199]
ds_read_b128 a[100:103], v2 offset:58368
v_cvt_pk_bf16_f32 v160, v160, v161
v_mfma_f32_16x16x32_bf16 v[196:199], a[64:67], v[120:123], v[196:199]
v_cvt_pk_bf16_f32 v161, v162, v163
v_cvt_pk_bf16_f32 v162, v168, v169
v_mfma_f32_16x16x32_bf16 v[200:203], a[72:75], v[112:115], v[200:203]
ds_read_b128 a[104:107], v2 offset:59392
v_cvt_pk_bf16_f32 v163, v170, v171
v_mfma_f32_16x16x32_bf16 v[200:203], a[76:79], v[116:119], v[200:203]
buffer_store_dwordx4 v[160:163], v1, s[4:7], s76 offen offset:2048 sc1
v_mfma_f32_16x16x32_bf16 v[204:207], a[76:79], v[124:127], v[204:207]
ds_read_b128 a[108:111], v2 offset:60416
v_cvt_pk_bf16_f32 v164, v164, v165
v_mfma_f32_16x16x32_bf16 v[204:207], a[72:75], v[120:123], v[204:207]
s_waitcnt lgkmcnt(4)
v_cvt_pk_bf16_f32 v165, v166, v167
v_cvt_pk_bf16_f32 v166, v172, v173
v_mfma_f32_16x16x32_bf16 v[208:211], a[80:83], v[112:115], v[208:211]
ds_read_b128 a[112:115], v2 offset:61440
v_cvt_pk_bf16_f32 v167, v174, v175
v_mfma_f32_16x16x32_bf16 v[208:211], a[84:87], v[116:119], v[208:211]
buffer_store_dwordx4 v[164:167], v1, s[4:7], s77 offen offset:2048 sc1
v_mfma_f32_16x16x32_bf16 v[212:215], a[84:87], v[124:127], v[212:215]
ds_read_b128 a[116:119], v2 offset:62464
v_cvt_pk_bf16_f32 v176, v176, v177
v_mfma_f32_16x16x32_bf16 v[212:215], a[80:83], v[120:123], v[212:215]
v_cvt_pk_bf16_f32 v177, v178, v179
v_cvt_pk_bf16_f32 v178, v184, v185
v_mfma_f32_16x16x32_bf16 v[216:219], a[88:91], v[112:115], v[216:219]
ds_read_b128 a[120:123], v2 offset:63488
v_cvt_pk_bf16_f32 v179, v186, v187
v_mfma_f32_16x16x32_bf16 v[216:219], a[92:95], v[116:119], v[216:219]
buffer_store_dwordx4 v[176:179], v1, s[4:7], s76 offen offset:3072 sc1
v_mfma_f32_16x16x32_bf16 v[220:223], a[92:95], v[124:127], v[220:223]
ds_read_b128 a[124:127], v2 offset:64512
v_cvt_pk_bf16_f32 v180, v180, v181
v_mfma_f32_16x16x32_bf16 v[220:223], a[88:91], v[120:123], v[220:223]
s_waitcnt lgkmcnt(4)
v_cvt_pk_bf16_f32 v181, v182, v183
v_cvt_pk_bf16_f32 v182, v188, v189
v_mfma_f32_16x16x32_bf16 v[224:227], a[96:99], v[112:115], v[224:227]
v_cvt_pk_bf16_f32 v183, v190, v191
v_accvgpr_mov_b32 a2, a194
v_mfma_f32_16x16x32_bf16 v[224:227], a[100:103], v[116:119], v[224:227]
PAD_34:
s_cbranch_execz M_tret
buffer_store_dwordx4 v[180:183], v1, s[4:7], s77 offen offset:3072 sc1
v_mfma_f32_16x16x32_bf16 v[228:231], a[100:103], v[124:127], v[228:231]
s_add_u32 s76, s76, 4096
v_accvgpr_mov_b32 a3, a195
v_accvgpr_mov_b32 a4, a196
v_mfma_f32_16x16x32_bf16 v[228:231], a[96:99], v[120:123], v[228:231]
s_add_u32 s77, s77, 4096
v_cvt_pk_bf16_f32 v192, v192, v193
v_cvt_pk_bf16_f32 v193, v194, v195
v_mfma_f32_16x16x32_bf16 v[232:235], a[104:107], v[112:115], v[232:235]
v_cvt_pk_bf16_f32 v194, v200, v201
v_cvt_pk_bf16_f32 v195, v202, v203
v_mfma_f32_16x16x32_bf16 v[232:235], a[108:111], v[116:119], v[232:235]
buffer_store_dwordx4 v[192:195], v1, s[4:7], s76 offen offset:0 sc1
v_mfma_f32_16x16x32_bf16 v[236:239], a[108:111], v[124:127], v[236:239]
v_cvt_pk_bf16_f32 v196, v196, v197
v_cvt_pk_bf16_f32 v197, v198, v199
v_mfma_f32_16x16x32_bf16 v[236:239], a[104:107], v[120:123], v[236:239]
s_waitcnt lgkmcnt(0)
v_cvt_pk_bf16_f32 v198, v204, v205
v_cvt_pk_bf16_f32 v199, v206, v207
v_mfma_f32_16x16x32_bf16 v[240:243], a[112:115], v[112:115], v[240:243]
buffer_store_dwordx4 v[196:199], v1, s[4:7], s77 offen offset:0 sc1
v_mfma_f32_16x16x32_bf16 v[240:243], a[116:119], v[116:119], v[240:243]
v_cvt_pk_bf16_f32 v208, v208, v209
v_cvt_pk_bf16_f32 v209, v210, v211
v_mfma_f32_16x16x32_bf16 v[244:247], a[116:119], v[124:127], v[244:247]
v_cvt_pk_bf16_f32 v210, v216, v217
v_cvt_pk_bf16_f32 v211, v218, v219
v_mfma_f32_16x16x32_bf16 v[244:247], a[112:115], v[120:123], v[244:247]
buffer_store_dwordx4 v[208:211], v1, s[4:7], s76 offen offset:1024 sc1
v_mfma_f32_16x16x32_bf16 v[248:251], a[120:123], v[112:115], v[248:251]
v_cvt_pk_bf16_f32 v212, v212, v213
v_cvt_pk_bf16_f32 v213, v214, v215
v_mfma_f32_16x16x32_bf16 v[248:251], a[124:127], v[116:119], v[248:251]
v_cvt_pk_bf16_f32 v214, v220, v221
v_cvt_pk_bf16_f32 v215, v222, v223
v_mfma_f32_16x16x32_bf16 v[252:255], a[124:127], v[124:127], v[252:255]
buffer_store_dwordx4 v[212:215], v1, s[4:7], s77 offen offset:1024 sc1
v_mfma_f32_16x16x32_bf16 v[252:255], a[120:123], v[120:123], v[252:255]
v_cvt_pk_bf16_f32 v224, v224, v225
v_cvt_pk_bf16_f32 v225, v226, v227
v_accvgpr_mov_b32 a5, a197
v_accvgpr_mov_b32 a6, a198
v_accvgpr_mov_b32 a7, a199
v_accvgpr_mov_b32 a8, a200
v_accvgpr_mov_b32 a9, a201
v_accvgpr_mov_b32 a10, a202
v_accvgpr_mov_b32 a11, a203
v_accvgpr_mov_b32 a12, a204
v_cvt_pk_bf16_f32 v226, v232, v233
v_cvt_pk_bf16_f32 v227, v234, v235
buffer_store_dwordx4 v[224:227], v1, s[4:7], s76 offen offset:2048 sc1
v_cvt_pk_bf16_f32 v228, v228, v229
v_cvt_pk_bf16_f32 v229, v230, v231
v_cvt_pk_bf16_f32 v230, v236, v237
v_cvt_pk_bf16_f32 v231, v238, v239
buffer_store_dwordx4 v[228:231], v1, s[4:7], s77 offen offset:2048 sc1
v_cvt_pk_bf16_f32 v240, v240, v241
v_cvt_pk_bf16_f32 v241, v242, v243
v_cvt_pk_bf16_f32 v242, v248, v249
v_cvt_pk_bf16_f32 v243, v250, v251
buffer_store_dwordx4 v[240:243], v1, s[4:7], s76 offen offset:3072 sc1
v_cvt_pk_bf16_f32 v244, v244, v245
v_cvt_pk_bf16_f32 v245, v246, v247
v_cvt_pk_bf16_f32 v246, v252, v253
v_cvt_pk_bf16_f32 v247, v254, v255
buffer_store_dwordx4 v[244:247], v1, s[4:7], s77 offen offset:3072 sc1
v_accvgpr_mov_b32 a13, a205
v_accvgpr_mov_b32 a14, a206
v_accvgpr_mov_b32 a15, a207
v_accvgpr_mov_b32 a16, a208
v_accvgpr_mov_b32 a17, a209
v_accvgpr_mov_b32 a18, a210
v_accvgpr_mov_b32 a19, a211
v_accvgpr_mov_b32 a20, a212
v_accvgpr_mov_b32 a21, a213
v_accvgpr_mov_b32 a22, a214
v_accvgpr_mov_b32 a23, a215
v_accvgpr_mov_b32 a24, a216
v_accvgpr_mov_b32 a25, a217
v_accvgpr_mov_b32 a26, a218
v_accvgpr_mov_b32 a27, a219
v_accvgpr_mov_b32 a28, a220
v_accvgpr_mov_b32 a29, a221
v_accvgpr_mov_b32 a30, a222
v_accvgpr_mov_b32 a31, a223
v_accvgpr_mov_b32 a32, a224
v_accvgpr_mov_b32 a33, a225
v_accvgpr_mov_b32 a34, a226
v_accvgpr_mov_b32 a35, a227
v_accvgpr_mov_b32 a36, a228
v_accvgpr_mov_b32 a37, a229
v_accvgpr_mov_b32 a38, a230
v_accvgpr_mov_b32 a39, a231
v_accvgpr_mov_b32 a40, a232
v_accvgpr_mov_b32 a41, a233
v_accvgpr_mov_b32 a42, a234
v_accvgpr_mov_b32 a43, a235
v_accvgpr_mov_b32 a44, a236
v_accvgpr_mov_b32 a45, a237
v_accvgpr_mov_b32 a46, a238
v_accvgpr_mov_b32 a47, a239
v_accvgpr_mov_b32 a48, a240
v_accvgpr_mov_b32 a49, a241
v_accvgpr_mov_b32 a50, a242
v_accvgpr_mov_b32 a51, a243
v_accvgpr_mov_b32 a52, a244
v_accvgpr_mov_b32 a53, a245
v_accvgpr_mov_b32 a54, a246
v_accvgpr_mov_b32 a55, a247
v_accvgpr_mov_b32 a56, a248
v_accvgpr_mov_b32 a57, a249
v_accvgpr_mov_b32 a58, a250
v_accvgpr_mov_b32 a59, a251
v_accvgpr_mov_b32 a60, a252
v_accvgpr_mov_b32 a61, a253
v_accvgpr_mov_b32 a62, a254
v_accvgpr_mov_b32 a63, a255
s_mov_b32 s24, 0
s_mov_b32 s29, s21
s_mov_b32 s19, s21
v_mov_b64 v[128:129], 0
v_mov_b64 v[130:131], 0
v_mov_b64 v[132:133], 0
v_mov_b64 v[134:135], 0
v_mov_b64 v[136:137], 0
v_mov_b64 v[138:139], 0
v_mov_b64 v[140:141], 0
v_mov_b64 v[142:143], 0
v_mov_b64 v[144:145], 0
v_mov_b64 v[146:147], 0
v_mov_b64 v[148:149], 0
v_mov_b64 v[150:151], 0
v_mov_b64 v[152:153], 0
v_mov_b64 v[154:155], 0
v_mov_b64 v[156:157], 0
v_mov_b64 v[158:159], 0
v_mov_b64 v[160:161], 0
v_mov_b64 v[162:163], 0
v_mov_b64 v[164:165], 0
v_mov_b64 v[166:167], 0
v_mov_b64 v[168:169], 0
v_mov_b64 v[170:171], 0
v_mov_b64 v[172:173], 0
v_mov_b64 v[174:175], 0
v_mov_b64 v[176:177], 0
v_mov_b64 v[178:179], 0
v_mov_b64 v[180:181], 0
v_mov_b64 v[182:183], 0
v_mov_b64 v[184:185], 0
v_mov_b64 v[186:187], 0
v_mov_b64 v[188:189], 0
v_mov_b64 v[190:191], 0
v_mov_b64 v[192:193], 0
v_mov_b64 v[194:195], 0
v_mov_b64 v[196:197], 0
v_mov_b64 v[198:199], 0
v_mov_b64 v[200:201], 0
v_mov_b64 v[202:203], 0
v_mov_b64 v[204:205], 0
v_mov_b64 v[206:207], 0
v_mov_b64 v[208:209], 0
v_mov_b64 v[210:211], 0
v_mov_b64 v[212:213], 0
v_mov_b64 v[214:215], 0
v_mov_b64 v[216:217], 0
v_mov_b64 v[218:219], 0
v_mov_b64 v[220:221], 0
v_mov_b64 v[222:223], 0
v_mov_b64 v[224:225], 0
v_mov_b64 v[226:227], 0
v_mov_b64 v[228:229], 0
v_mov_b64 v[230:231], 0
v_mov_b64 v[232:233], 0
v_mov_b64 v[234:235], 0
v_mov_b64 v[236:237], 0
v_mov_b64 v[238:239], 0
v_mov_b64 v[240:241], 0
v_mov_b64 v[242:243], 0
v_mov_b64 v[244:245], 0
v_mov_b64 v[246:247], 0
v_mov_b64 v[248:249], 0
v_mov_b64 v[250:251], 0
v_mov_b64 v[252:253], 0
v_mov_b64 v[254:255], 0
v_mov_b64 v[24:25], 0
s_mov_b32 s71, s28
s_mov_b32 s84, 0
s_barrier
s_branch K2_item
K2_nend:
Lstub_2:
s_call_b64 s[16:17], K2_slow1
s_branch Lback_3
Lstub_4:
s_call_b64 s[16:17], K2_slow0
s_branch Lback_5
Lstub_6:
s_call_b64 s[16:17], K2_slow1
s_branch Lback_7
Lstub_8:
s_call_b64 s[16:17], K2_slow0
s_branch Lback_9
Lstub_10:
s_call_b64 s[16:17], K2_slow2
s_branch Lback_11
Lstub_12:
s_call_b64 s[16:17], K2_slow2
s_branch Lback_13
Lstub_14:
s_call_b64 s[16:17], K2_slow1
s_branch Lback_15
K2_slow0:
s_nop 7
s_nop 7
v_max3_f32 v8, v32, v33, 0
v_max3_f32 v8, v34, v35, v8
v_max3_f32 v8, v40, v41, v8
v_max3_f32 v8, v42, v43, v8
v_max3_f32 v8, v48, v49, v8
v_max3_f32 v8, v50, v51, v8
v_max3_f32 v8, v56, v57, v8
v_max3_f32 v8, v58, v59, v8
v_mov_b32 v9, v8
s_nop 1
v_permlane16_swap_b32 v8, v9
v_max_f32 v8, v8, v9
v_mov_b32 v9, v8
s_nop 1
v_permlane32_swap_b32 v8, v9
v_max_f32 v8, v8, v9
v_exp_f32 v9, -v8
v_sub_f32 v16, v16, v8
v_sub_f32 v17, v17, v8
v_sub_f32 v18, v18, v8
v_sub_f32 v19, v19, v8
v_mul_f32 v24, v24, v9
v_mul_f32 v128, v128, v9
v_mul_f32 v129, v129, v9
v_mul_f32 v130, v130, v9
v_mul_f32 v131, v131, v9
v_mul_f32 v136, v136, v9
v_mul_f32 v137, v137, v9
v_mul_f32 v138, v138, v9
v_mul_f32 v139, v139, v9
v_mul_f32 v144, v144, v9
v_mul_f32 v145, v145, v9
v_mul_f32 v146, v146, v9
v_mul_f32 v147, v147, v9
v_mul_f32 v152, v152, v9
v_mul_f32 v153, v153, v9
v_mul_f32 v154, v154, v9
v_mul_f32 v155, v155, v9
v_mul_f32 v160, v160, v9
v_mul_f32 v161, v161, v9
v_mul_f32 v162, v162, v9
v_mul_f32 v163, v163, v9
v_mul_f32 v168, v168, v9
v_mul_f32 v169, v169, v9
v_mul_f32 v170, v170, v9
v_mul_f32 v171, v171, v9
v_mul_f32 v176, v176, v9
v_mul_f32 v177, v177, v9
v_mul_f32 v178, v178, v9
v_mul_f32 v179, v179, v9
v_mul_f32 v184, v184, v9
v_mul_f32 v185, v185, v9
v_mul_f32 v186, v186, v9
v_mul_f32 v187, v187, v9
v_mul_f32 v192, v192, v9
v_mul_f32 v193, v193, v9
v_mul_f32 v194, v194, v9
v_mul_f32 v195, v195, v9
v_mul_f32 v200, v200, v9
v_mul_f32 v201, v201, v9
v_mul_f32 v202, v202, v9
v_mul_f32 v203, v203, v9
v_mul_f32 v208, v208, v9
v_mul_f32 v209, v209, v9
v_mul_f32 v210, v210, v9
v_mul_f32 v211, v211, v9
v_mul_f32 v216, v216, v9
v_mul_f32 v217, v217, v9
v_mul_f32 v218, v218, v9
v_mul_f32 v219, v219, v9
v_mul_f32 v224, v224, v9
v_mul_f32 v225, v225, v9
v_mul_f32 v226, v226, v9
v_mul_f32 v227, v227, v9
v_mul_f32 v232, v232, v9
v_mul_f32 v233, v233, v9
v_mul_f32 v234, v234, v9
v_mul_f32 v235, v235, v9
v_mul_f32 v240, v240, v9
v_mul_f32 v241, v241, v9
v_mul_f32 v242, v242, v9
v_mul_f32 v243, v243, v9
v_mul_f32 v248, v248, v9
v_mul_f32 v249, v249, v9
v_mul_f32 v250, v250, v9
v_mul_f32 v251, v251, v9
v_sub_f32 v32, v32, v8
v_sub_f32 v33, v33, v8
v_sub_f32 v34, v34, v8
v_sub_f32 v35, v35, v8
v_sub_f32 v40, v40, v8
v_sub_f32 v41, v41, v8
v_sub_f32 v42, v42, v8
v_sub_f32 v43, v43, v8
v_sub_f32 v48, v48, v8
v_sub_f32 v49, v49, v8
v_sub_f32 v50, v50, v8
v_sub_f32 v51, v51, v8
v_sub_f32 v56, v56, v8
v_sub_f32 v57, v57, v8
v_sub_f32 v58, v58, v8
v_sub_f32 v59, v59, v8
v_sub_f32 v64, v64, v8
v_sub_f32 v65, v65, v8
v_sub_f32 v66, v66, v8
v_sub_f32 v67, v67, v8
v_sub_f32 v72, v72, v8
v_sub_f32 v73, v73, v8
v_sub_f32 v74, v74, v8
v_sub_f32 v75, v75, v8
v_sub_f32 v80, v80, v8
v_sub_f32 v81, v81, v8
v_sub_f32 v82, v82, v8
v_sub_f32 v83, v83, v8
v_sub_f32 v88, v88, v8
v_sub_f32 v89, v89, v8
v_sub_f32 v90, v90, v8
v_sub_f32 v91, v91, v8
v_max3_f32 v8, v36, v37, 0
v_max3_f32 v8, v38, v39, v8
v_max3_f32 v8, v44, v45, v8
v_max3_f32 v8, v46, v47, v8
v_max3_f32 v8, v52, v53, v8
v_max3_f32 v8, v54, v55, v8
v_max3_f32 v8, v60, v61, v8
v_max3_f32 v8, v62, v63, v8
v_mov_b32 v9, v8
s_nop 1
v_permlane16_swap_b32 v8, v9
v_max_f32 v8, v8, v9
v_mov_b32 v9, v8
s_nop 1
v_permlane32_swap_b32 v8, v9
v_max_f32 v8, v8, v9
v_exp_f32 v9, -v8
v_sub_f32 v20, v20, v8
v_sub_f32 v21, v21, v8
v_sub_f32 v22, v22, v8
v_sub_f32 v23, v23, v8
v_mul_f32 v25, v25, v9
v_mul_f32 v132, v132, v9
v_mul_f32 v133, v133, v9
v_mul_f32 v134, v134, v9
v_mul_f32 v135, v135, v9
v_mul_f32 v140, v140, v9
v_mul_f32 v141, v141, v9
v_mul_f32 v142, v142, v9
v_mul_f32 v143, v143, v9
v_mul_f32 v148, v148, v9
v_mul_f32 v149, v149, v9
v_mul_f32 v150, v150, v9
v_mul_f32 v151, v151, v9
v_mul_f32 v156, v156, v9
v_mul_f32 v157, v157, v9
v_mul_f32 v158, v158, v9
v_mul_f32 v159, v159, v9
v_mul_f32 v164, v164, v9
v_mul_f32 v165, v165, v9
v_mul_f32 v166, v166, v9
v_mul_f32 v167, v167, v9
v_mul_f32 v172, v172, v9
v_mul_f32 v173, v173, v9
v_mul_f32 v174, v174, v9
v_mul_f32 v175, v175, v9
v_mul_f32 v180, v180, v9
v_mul_f32 v181, v181, v9
v_mul_f32 v182, v182, v9
v_mul_f32 v183, v183, v9
v_mul_f32 v188, v188, v9
v_mul_f32 v189, v189, v9
v_mul_f32 v190, v190, v9
v_mul_f32 v191, v191, v9
v_mul_f32 v196, v196, v9
v_mul_f32 v197, v197, v9
v_mul_f32 v198, v198, v9
v_mul_f32 v199, v199, v9
v_mul_f32 v204, v204, v9
v_mul_f32 v205, v205, v9
v_mul_f32 v206, v206, v9
v_mul_f32 v207, v207, v9
v_mul_f32 v212, v212, v9
v_mul_f32 v213, v213, v9
v_mul_f32 v214, v214, v9
v_mul_f32 v215, v215, v9
v_mul_f32 v220, v220, v9
v_mul_f32 v221, v221, v9
v_mul_f32 v222, v222, v9
v_mul_f32 v223, v223, v9
v_mul_f32 v228, v228, v9
v_mul_f32 v229, v229, v9
v_mul_f32 v230, v230, v9
v_mul_f32 v231, v231, v9
v_mul_f32 v236, v236, v9
v_mul_f32 v237, v237, v9
v_mul_f32 v238, v238, v9
v_mul_f32 v239, v239, v9
v_mul_f32 v244, v244, v9
v_mul_f32 v245, v245, v9
v_mul_f32 v246, v246, v9
v_mul_f32 v247, v247, v9
v_mul_f32 v252, v252, v9
v_mul_f32 v253, v253, v9
v_mul_f32 v254, v254, v9
v_mul_f32 v255, v255, v9
v_sub_f32 v36, v36, v8
v_sub_f32 v37, v37, v8
v_sub_f32 v38, v38, v8
v_sub_f32 v39, v39, v8
v_sub_f32 v44, v44, v8
v_sub_f32 v45, v45, v8
v_sub_f32 v46, v46, v8
v_sub_f32 v47, v47, v8
v_sub_f32 v52, v52, v8
v_sub_f32 v53, v53, v8
v_sub_f32 v54, v54, v8
v_sub_f32 v55, v55, v8
v_sub_f32 v60, v60, v8
v_sub_f32 v61, v61, v8
v_sub_f32 v62, v62, v8
v_sub_f32 v63, v63, v8
v_sub_f32 v68, v68, v8
v_sub_f32 v69, v69, v8
v_sub_f32 v70, v70, v8
v_sub_f32 v71, v71, v8
v_sub_f32 v76, v76, v8
v_sub_f32 v77, v77, v8
v_sub_f32 v78, v78, v8
v_sub_f32 v79, v79, v8
v_sub_f32 v84, v84, v8
v_sub_f32 v85, v85, v8
v_sub_f32 v86, v86, v8
v_sub_f32 v87, v87, v8
v_sub_f32 v92, v92, v8
v_sub_f32 v93, v93, v8
v_sub_f32 v94, v94, v8
v_sub_f32 v95, v95, v8
v_exp_f32 v8, v32
v_exp_f32 v9, v33
v_exp_f32 v10, v34
v_exp_f32 v11, v35
s_nop 0
v_add_f32 v26, v8, v9
v_cvt_pk_bf16_f32 v96, v8, v9
v_add_f32 v26, v26, v10
v_add_f32 v26, v26, v11
v_cvt_pk_bf16_f32 v97, v10, v11
v_exp_f32 v12, v36
v_exp_f32 v13, v37
v_exp_f32 v14, v38
v_exp_f32 v15, v39
s_nop 0
v_add_f32 v27, v12, v13
v_cvt_pk_bf16_f32 v104, v12, v13
v_add_f32 v27, v27, v14
v_add_f32 v27, v27, v15
v_cvt_pk_bf16_f32 v105, v14, v15
v_exp_f32 v8, v40
v_exp_f32 v9, v41
v_exp_f32 v10, v42
v_exp_f32 v11, v43
s_nop 0
v_add_f32 v26, v26, v8
v_add_f32 v26, v26, v9
v_cvt_pk_bf16_f32 v98, v8, v9
v_add_f32 v26, v26, v10
v_add_f32 v26, v26, v11
v_cvt_pk_bf16_f32 v99, v10, v11
v_exp_f32 v12, v44
v_exp_f32 v13, v45
v_exp_f32 v14, v46
v_exp_f32 v15, v47
s_nop 0
v_add_f32 v27, v27, v12
v_add_f32 v27, v27, v13
v_cvt_pk_bf16_f32 v106, v12, v13
v_add_f32 v27, v27, v14
v_add_f32 v27, v27, v15
v_cvt_pk_bf16_f32 v107, v14, v15
v_exp_f32 v8, v48
v_exp_f32 v9, v49
v_exp_f32 v10, v50
v_exp_f32 v11, v51
s_nop 0
v_add_f32 v26, v26, v8
v_add_f32 v26, v26, v9
v_cvt_pk_bf16_f32 v100, v8, v9
v_add_f32 v26, v26, v10
v_add_f32 v26, v26, v11
v_cvt_pk_bf16_f32 v101, v10, v11
v_exp_f32 v12, v52
v_exp_f32 v13, v53
v_exp_f32 v14, v54
v_exp_f32 v15, v55
s_nop 0
v_add_f32 v27, v27, v12
v_add_f32 v27, v27, v13
v_cvt_pk_bf16_f32 v108, v12, v13
v_add_f32 v27, v27, v14
v_add_f32 v27, v27, v15
v_cvt_pk_bf16_f32 v109, v14, v15
v_exp_f32 v8, v56
v_exp_f32 v9, v57
v_exp_f32 v10, v58
v_exp_f32 v11, v59
s_nop 0
v_add_f32 v26, v26, v8
v_add_f32 v26, v26, v9
v_cvt_pk_bf16_f32 v102, v8, v9
v_add_f32 v26, v26, v10
v_add_f32 v26, v26, v11
v_cvt_pk_bf16_f32 v103, v10, v11
v_exp_f32 v12, v60
v_exp_f32 v13, v61
v_exp_f32 v14, v62
v_exp_f32 v15, v63
s_nop 0
v_add_f32 v27, v27, v12
v_add_f32 v27, v27, v13
v_cvt_pk_bf16_f32 v110, v12, v13
v_add_f32 v27, v27, v14
v_add_f32 v27, v27, v15
v_cvt_pk_bf16_f32 v111, v14, v15
s_nop 1
s_setpc_b64 s[16:17]
K2_slow1:
s_nop 7
s_nop 7
v_max3_f32 v8, v64, v65, 0
v_max3_f32 v8, v66, v67, v8
v_max3_f32 v8, v72, v73, v8
v_max3_f32 v8, v74, v75, v8
v_max3_f32 v8, v80, v81, v8
v_max3_f32 v8, v82, v83, v8
v_max3_f32 v8, v88, v89, v8
v_max3_f32 v8, v90, v91, v8
v_mov_b32 v9, v8
s_nop 1
v_permlane16_swap_b32 v8, v9
v_max_f32 v8, v8, v9
v_mov_b32 v9, v8
s_nop 1
v_permlane32_swap_b32 v8, v9
v_max_f32 v8, v8, v9
v_exp_f32 v9, -v8
v_sub_f32 v16, v16, v8
v_sub_f32 v17, v17, v8
v_sub_f32 v18, v18, v8
v_sub_f32 v19, v19, v8
v_mul_f32 v24, v24, v9
v_mul_f32 v128, v128, v9
v_mul_f32 v129, v129, v9
v_mul_f32 v130, v130, v9
v_mul_f32 v131, v131, v9
v_mul_f32 v136, v136, v9
v_mul_f32 v137, v137, v9
v_mul_f32 v138, v138, v9
v_mul_f32 v139, v139, v9
v_mul_f32 v144, v144, v9
v_mul_f32 v145, v145, v9
v_mul_f32 v146, v146, v9
v_mul_f32 v147, v147, v9
v_mul_f32 v152, v152, v9
v_mul_f32 v153, v153, v9
v_mul_f32 v154, v154, v9
v_mul_f32 v155, v155, v9
v_mul_f32 v160, v160, v9
v_mul_f32 v161, v161, v9
v_mul_f32 v162, v162, v9
v_mul_f32 v163, v163, v9
v_mul_f32 v168, v168, v9
v_mul_f32 v169, v169, v9
v_mul_f32 v170, v170, v9
v_mul_f32 v171, v171, v9
v_mul_f32 v176, v176, v9
v_mul_f32 v177, v177, v9
v_mul_f32 v178, v178, v9
v_mul_f32 v179, v179, v9
v_mul_f32 v184, v184, v9
v_mul_f32 v185, v185, v9
v_mul_f32 v186, v186, v9
v_mul_f32 v187, v187, v9
v_mul_f32 v192, v192, v9
v_mul_f32 v193, v193, v9
v_mul_f32 v194, v194, v9
v_mul_f32 v195, v195, v9
v_mul_f32 v200, v200, v9
v_mul_f32 v201, v201, v9
v_mul_f32 v202, v202, v9
v_mul_f32 v203, v203, v9
v_mul_f32 v208, v208, v9
v_mul_f32 v209, v209, v9
v_mul_f32 v210, v210, v9
v_mul_f32 v211, v211, v9
v_mul_f32 v216, v216, v9
v_mul_f32 v217, v217, v9
v_mul_f32 v218, v218, v9
v_mul_f32 v219, v219, v9
v_mul_f32 v224, v224, v9
v_mul_f32 v225, v225, v9
v_mul_f32 v226, v226, v9
v_mul_f32 v227, v227, v9
v_mul_f32 v232, v232, v9
v_mul_f32 v233, v233, v9
v_mul_f32 v234, v234, v9
v_mul_f32 v235, v235, v9
v_mul_f32 v240, v240, v9
v_mul_f32 v241, v241, v9
v_mul_f32 v242, v242, v9
v_mul_f32 v243, v243, v9
v_mul_f32 v248, v248, v9
v_mul_f32 v249, v249, v9
v_mul_f32 v250, v250, v9
v_mul_f32 v251, v251, v9
v_sub_f32 v32, v32, v8
v_sub_f32 v33, v33, v8
v_sub_f32 v34, v34, v8
v_sub_f32 v35, v35, v8
v_sub_f32 v40, v40, v8
v_sub_f32 v41, v41, v8
v_sub_f32 v42, v42, v8
v_sub_f32 v43, v43, v8
v_sub_f32 v48, v48, v8
v_sub_f32 v49, v49, v8
v_sub_f32 v50, v50, v8
v_sub_f32 v51, v51, v8
v_sub_f32 v56, v56, v8
v_sub_f32 v57, v57, v8
v_sub_f32 v58, v58, v8
v_sub_f32 v59, v59, v8
v_sub_f32 v64, v64, v8
v_sub_f32 v65, v65, v8
v_sub_f32 v66, v66, v8
v_sub_f32 v67, v67, v8
v_sub_f32 v72, v72, v8
v_sub_f32 v73, v73, v8
v_sub_f32 v74, v74, v8
v_sub_f32 v75, v75, v8
v_sub_f32 v80, v80, v8
v_sub_f32 v81, v81, v8
v_sub_f32 v82, v82, v8
v_sub_f32 v83, v83, v8
v_sub_f32 v88, v88, v8
v_sub_f32 v89, v89, v8
v_sub_f32 v90, v90, v8
v_sub_f32 v91, v91, v8
v_max3_f32 v8, v68, v69, 0
v_max3_f32 v8, v70, v71, v8
v_max3_f32 v8, v76, v77, v8
v_max3_f32 v8, v78, v79, v8
v_max3_f32 v8, v84, v85, v8
v_max3_f32 v8, v86, v87, v8
v_max3_f32 v8, v92, v93, v8
v_max3_f32 v8, v94, v95, v8
v_mov_b32 v9, v8
s_nop 1
v_permlane16_swap_b32 v8, v9
v_max_f32 v8, v8, v9
v_mov_b32 v9, v8
s_nop 1
v_permlane32_swap_b32 v8, v9
v_max_f32 v8, v8, v9
v_exp_f32 v9, -v8
v_sub_f32 v20, v20, v8
v_sub_f32 v21, v21, v8
v_sub_f32 v22, v22, v8
v_sub_f32 v23, v23, v8
v_mul_f32 v25, v25, v9
v_mul_f32 v132, v132, v9
v_mul_f32 v133, v133, v9
v_mul_f32 v134, v134, v9
v_mul_f32 v135, v135, v9
v_mul_f32 v140, v140, v9
v_mul_f32 v141, v141, v9
v_mul_f32 v142, v142, v9
v_mul_f32 v143, v143, v9
v_mul_f32 v148, v148, v9
v_mul_f32 v149, v149, v9
v_mul_f32 v150, v150, v9
v_mul_f32 v151, v151, v9
v_mul_f32 v156, v156, v9
v_mul_f32 v157, v157, v9
v_mul_f32 v158, v158, v9
v_mul_f32 v159, v159, v9
v_mul_f32 v164, v164, v9
v_mul_f32 v165, v165, v9
v_mul_f32 v166, v166, v9
v_mul_f32 v167, v167, v9
v_mul_f32 v172, v172, v9
v_mul_f32 v173, v173, v9
v_mul_f32 v174, v174, v9
v_mul_f32 v175, v175, v9
v_mul_f32 v180, v180, v9
v_mul_f32 v181, v181, v9
v_mul_f32 v182, v182, v9
v_mul_f32 v183, v183, v9
v_mul_f32 v188, v188, v9
v_mul_f32 v189, v189, v9
v_mul_f32 v190, v190, v9
v_mul_f32 v191, v191, v9
v_mul_f32 v196, v196, v9
v_mul_f32 v197, v197, v9
v_mul_f32 v198, v198, v9
v_mul_f32 v199, v199, v9
v_mul_f32 v204, v204, v9
v_mul_f32 v205, v205, v9
v_mul_f32 v206, v206, v9
v_mul_f32 v207, v207, v9
v_mul_f32 v212, v212, v9
v_mul_f32 v213, v213, v9
v_mul_f32 v214, v214, v9
v_mul_f32 v215, v215, v9
v_mul_f32 v220, v220, v9
v_mul_f32 v221, v221, v9
v_mul_f32 v222, v222, v9
v_mul_f32 v223, v223, v9
v_mul_f32 v228, v228, v9
v_mul_f32 v229, v229, v9
v_mul_f32 v230, v230, v9
v_mul_f32 v231, v231, v9
v_mul_f32 v236, v236, v9
v_mul_f32 v237, v237, v9
v_mul_f32 v238, v238, v9
v_mul_f32 v239, v239, v9
v_mul_f32 v244, v244, v9
v_mul_f32 v245, v245, v9
v_mul_f32 v246, v246, v9
v_mul_f32 v247, v247, v9
v_mul_f32 v252, v252, v9
v_mul_f32 v253, v253, v9
v_mul_f32 v254, v254, v9
v_mul_f32 v255, v255, v9
v_sub_f32 v36, v36, v8
v_sub_f32 v37, v37, v8
v_sub_f32 v38, v38, v8
v_sub_f32 v39, v39, v8
v_sub_f32 v44, v44, v8
v_sub_f32 v45, v45, v8
v_sub_f32 v46, v46, v8
v_sub_f32 v47, v47, v8
v_sub_f32 v52, v52, v8
v_sub_f32 v53, v53, v8
v_sub_f32 v54, v54, v8
v_sub_f32 v55, v55, v8
v_sub_f32 v60, v60, v8
v_sub_f32 v61, v61, v8
v_sub_f32 v62, v62, v8
v_sub_f32 v63, v63, v8
v_sub_f32 v68, v68, v8
v_sub_f32 v69, v69, v8
v_sub_f32 v70, v70, v8
v_sub_f32 v71, v71, v8
v_sub_f32 v76, v76, v8
v_sub_f32 v77, v77, v8
v_sub_f32 v78, v78, v8
v_sub_f32 v79, v79, v8
v_sub_f32 v84, v84, v8
v_sub_f32 v85, v85, v8
v_sub_f32 v86, v86, v8
v_sub_f32 v87, v87, v8
v_sub_f32 v92, v92, v8
v_sub_f32 v93, v93, v8
v_sub_f32 v94, v94, v8
v_sub_f32 v95, v95, v8
v_exp_f32 v8, v64
v_exp_f32 v9, v65
v_exp_f32 v10, v66
v_exp_f32 v11, v67
s_nop 0
v_add_f32 v26, v8, v9
v_cvt_pk_bf16_f32 v112, v8, v9
v_add_f32 v26, v26, v10
v_add_f32 v26, v26, v11
v_cvt_pk_bf16_f32 v113, v10, v11
v_exp_f32 v12, v68
v_exp_f32 v13, v69
v_exp_f32 v14, v70
v_exp_f32 v15, v71
s_nop 0
v_add_f32 v27, v12, v13
v_cvt_pk_bf16_f32 v120, v12, v13
v_add_f32 v27, v27, v14
v_add_f32 v27, v27, v15
v_cvt_pk_bf16_f32 v121, v14, v15
v_exp_f32 v8, v72
v_exp_f32 v9, v73
v_exp_f32 v10, v74
v_exp_f32 v11, v75
s_nop 0
v_add_f32 v26, v26, v8
v_add_f32 v26, v26, v9
v_cvt_pk_bf16_f32 v114, v8, v9
v_add_f32 v26, v26, v10
v_add_f32 v26, v26, v11
v_cvt_pk_bf16_f32 v115, v10, v11
v_exp_f32 v12, v76
v_exp_f32 v13, v77
v_exp_f32 v14, v78
v_exp_f32 v15, v79
s_nop 0
v_add_f32 v27, v27, v12
v_add_f32 v27, v27, v13
v_cvt_pk_bf16_f32 v122, v12, v13
v_add_f32 v27, v27, v14
v_add_f32 v27, v27, v15
v_cvt_pk_bf16_f32 v123, v14, v15
v_exp_f32 v8, v80
v_exp_f32 v9, v81
v_exp_f32 v10, v82
v_exp_f32 v11, v83
s_nop 0
v_add_f32 v26, v26, v8
v_add_f32 v26, v26, v9
v_cvt_pk_bf16_f32 v116, v8, v9
v_add_f32 v26, v26, v10
v_add_f32 v26, v26, v11
v_cvt_pk_bf16_f32 v117, v10, v11
v_exp_f32 v12, v84
v_exp_f32 v13, v85
v_exp_f32 v14, v86
v_exp_f32 v15, v87
s_nop 0
v_add_f32 v27, v27, v12
v_add_f32 v27, v27, v13
v_cvt_pk_bf16_f32 v124, v12, v13
v_add_f32 v27, v27, v14
v_add_f32 v27, v27, v15
v_cvt_pk_bf16_f32 v125, v14, v15
v_exp_f32 v8, v88
v_exp_f32 v9, v89
v_exp_f32 v10, v90
v_exp_f32 v11, v91
s_nop 0
v_add_f32 v26, v26, v8
v_add_f32 v26, v26, v9
v_cvt_pk_bf16_f32 v118, v8, v9
v_add_f32 v26, v26, v10
v_add_f32 v26, v26, v11
v_cvt_pk_bf16_f32 v119, v10, v11
v_exp_f32 v12, v92
v_exp_f32 v13, v93
v_exp_f32 v14, v94
v_exp_f32 v15, v95
s_nop 0
v_add_f32 v27, v27, v12
v_add_f32 v27, v27, v13
v_cvt_pk_bf16_f32 v126, v12, v13
v_add_f32 v27, v27, v14
v_add_f32 v27, v27, v15
v_cvt_pk_bf16_f32 v127, v14, v15
s_nop 1
s_setpc_b64 s[16:17]
K2_slow2:
s_nop 7
s_nop 7
v_max3_f32 v8, v68, v69, 0
v_max3_f32 v8, v70, v71, v8
v_max3_f32 v8, v76, v77, v8
v_max3_f32 v8, v78, v79, v8
v_max3_f32 v8, v84, v85, v8
v_max3_f32 v8, v86, v87, v8
v_max3_f32 v8, v92, v93, v8
v_max3_f32 v8, v94, v95, v8
v_mov_b32 v9, v8
s_nop 1
v_permlane16_swap_b32 v8, v9
v_max_f32 v8, v8, v9
v_mov_b32 v9, v8
s_nop 1
v_permlane32_swap_b32 v8, v9
v_max_f32 v8, v8, v9
v_exp_f32 v9, -v8
v_sub_f32 v20, v20, v8
v_sub_f32 v21, v21, v8
v_sub_f32 v22, v22, v8
v_sub_f32 v23, v23, v8
v_mul_f32 v25, v25, v9
v_mul_f32 v132, v132, v9
v_mul_f32 v133, v133, v9
v_mul_f32 v134, v134, v9
v_mul_f32 v135, v135, v9
v_mul_f32 v140, v140, v9
v_mul_f32 v141, v141, v9
v_mul_f32 v142, v142, v9
v_mul_f32 v143, v143, v9
v_mul_f32 v148, v148, v9
v_mul_f32 v149, v149, v9
v_mul_f32 v150, v150, v9
v_mul_f32 v151, v151, v9
v_mul_f32 v156, v156, v9
v_mul_f32 v157, v157, v9
v_mul_f32 v158, v158, v9
v_mul_f32 v159, v159, v9
v_mul_f32 v164, v164, v9
v_mul_f32 v165, v165, v9
v_mul_f32 v166, v166, v9
v_mul_f32 v167, v167, v9
v_mul_f32 v172, v172, v9
v_mul_f32 v173, v173, v9
v_mul_f32 v174, v174, v9
v_mul_f32 v175, v175, v9
v_mul_f32 v180, v180, v9
v_mul_f32 v181, v181, v9
v_mul_f32 v182, v182, v9
v_mul_f32 v183, v183, v9
v_mul_f32 v188, v188, v9
v_mul_f32 v189, v189, v9
v_mul_f32 v190, v190, v9
v_mul_f32 v191, v191, v9
v_mul_f32 v196, v196, v9
v_mul_f32 v197, v197, v9
v_mul_f32 v198, v198, v9
v_mul_f32 v199, v199, v9
v_mul_f32 v204, v204, v9
v_mul_f32 v205, v205, v9
v_mul_f32 v206, v206, v9
v_mul_f32 v207, v207, v9
v_mul_f32 v212, v212, v9
v_mul_f32 v213, v213, v9
v_mul_f32 v214, v214, v9
v_mul_f32 v215, v215, v9
v_mul_f32 v220, v220, v9
v_mul_f32 v221, v221, v9
v_mul_f32 v222, v222, v9
v_mul_f32 v223, v223, v9
v_mul_f32 v228, v228, v9
v_mul_f32 v229, v229, v9
v_mul_f32 v230, v230, v9
v_mul_f32 v231, v231, v9
v_mul_f32 v236, v236, v9
v_mul_f32 v237, v237, v9
v_mul_f32 v238, v238, v9
v_mul_f32 v239, v239, v9
v_mul_f32 v244, v244, v9
v_mul_f32 v245, v245, v9
v_mul_f32 v246, v246, v9
v_mul_f32 v247, v247, v9
v_mul_f32 v252, v252, v9
v_mul_f32 v253, v253, v9
v_mul_f32 v254, v254, v9
v_mul_f32 v255, v255, v9
v_sub_f32 v68, v68, v8
v_sub_f32 v69, v69, v8
v_sub_f32 v70, v70, v8
v_sub_f32 v71, v71, v8
v_sub_f32 v76, v76, v8
v_sub_f32 v77, v77, v8
v_sub_f32 v78, v78, v8
v_sub_f32 v79, v79, v8
v_sub_f32 v84, v84, v8
v_sub_f32 v85, v85, v8
v_sub_f32 v86, v86, v8
v_sub_f32 v87, v87, v8
v_sub_f32 v92, v92, v8
v_sub_f32 v93, v93, v8
v_sub_f32 v94, v94, v8
v_sub_f32 v95, v95, v8
v_exp_f32 v8, v68
v_exp_f32 v9, v69
v_exp_f32 v10, v70
v_exp_f32 v11, v71
s_nop 0
v_add_f32 v27, v8, v9
v_cvt_pk_bf16_f32 v120, v8, v9
v_add_f32 v27, v27, v10
v_add_f32 v27, v27, v11
v_cvt_pk_bf16_f32 v121, v10, v11
v_exp_f32 v12, v76
v_exp_f32 v13, v77
v_exp_f32 v14, v78
v_exp_f32 v15, v79
s_nop 0
v_add_f32 v27, v27, v12
v_add_f32 v27, v27, v13
v_cvt_pk_bf16_f32 v122, v12, v13
v_add_f32 v27, v27, v14
v_add_f32 v27, v27, v15
v_cvt_pk_bf16_f32 v123, v14, v15
v_exp_f32 v8, v84
v_exp_f32 v9, v85
v_exp_f32 v10, v86
v_exp_f32 v11, v87
s_nop 0
v_add_f32 v27, v27, v8
v_add_f32 v27, v27, v9
v_cvt_pk_bf16_f32 v124, v8, v9
v_add_f32 v27, v27, v10
v_add_f32 v27, v27, v11
v_cvt_pk_bf16_f32 v125, v10, v11
v_exp_f32 v12, v92
v_exp_f32 v13, v93
v_exp_f32 v14, v94
v_exp_f32 v15, v95
s_nop 0
v_add_f32 v27, v27, v12
v_add_f32 v27, v27, v13
v_cvt_pk_bf16_f32 v126, v12, v13
v_add_f32 v27, v27, v14
v_add_f32 v27, v27, v15
v_cvt_pk_bf16_f32 v127, v14, v15
s_nop 1
s_setpc_b64 s[16:17]
M_cntspinK:
Lp_9801:
buffer_load_dword v245, off, s[60:63], 0 sc1
s_waitcnt vmcnt(0)
v_cmp_gt_u32 vcc, 0x100, v245
s_cbranch_vccz Lpd_9802
s_sleep 8
s_sub_u32 s101, s101, 1
s_cbranch_scc0 Lp_9801
s_mov_b32 s101, 0
Lpd_9802:
s_branch Lg_1
M_ppspinK:
Lp_9803:
buffer_load_dword v230, v231, s[4:7], s52 offen sc1
s_waitcnt vmcnt(0)
v_cmp_gt_u32 vcc, 1, v230
s_cbranch_vccz Lpd_9804
s_sleep 8
s_sub_u32 s101, s101, 1
s_cbranch_scc0 Lp_9803
s_mov_b32 s101, 0
Lpd_9804:
s_branch M_ppokK
M_cntspinV:
Lp_9805:
buffer_load_dword v245, off, s[60:63], 0 sc1
s_waitcnt vmcnt(0)
v_cmp_gt_u32 vcc, 0x100, v245
s_cbranch_vccz Lpd_9806
s_sleep 8
s_sub_u32 s101, s101, 1
s_cbranch_scc0 Lp_9805
s_mov_b32 s101, 0
Lpd_9806:
s_branch Lg_501
M_ppspinV:
Lp_9807:
buffer_load_dword v230, v231, s[4:7], s52 offen sc1
s_waitcnt vmcnt(0)
v_cmp_gt_u32 vcc, 1, v230
s_cbranch_vccz Lpd_9808
s_sleep 8
s_sub_u32 s101, s101, 1
s_cbranch_scc0 Lp_9807
s_mov_b32 s101, 0
Lpd_9808:
s_branch M_ppokV
M_end:
s_endpgm
.section .rodata,"a"
.p2align 6
.amdhsa_kernel concat_heads__ssm_conv_h3__compressed_kv_cla__prompt_kernel
  .amdhsa_next_free_vgpr 512
  .amdhsa_next_free_sgpr 102
  .amdhsa_accum_offset 256
  .amdhsa_group_segment_fixed_size 0
  .amdhsa_kernarg_size 120
  .amdhsa_user_sgpr_count 2
  .amdhsa_user_sgpr_kernarg_segment_ptr 1
  .amdhsa_system_sgpr_workgroup_id_x 1
  .amdhsa_float_denorm_mode_32 3
  .amdhsa_float_denorm_mode_16_64 3
  .amdhsa_ieee_mode 0
  .amdhsa_dx10_clamp 0
.end_amdhsa_kernel
```

```asm
; @launch grid=(256,1,1) block=(256,1,1) lds=163840
.amdgcn_target "amdgcn-amd-amdhsa--gfx950"
.text
.globl concat_heads__ssm_conv_h3__compressed_kv_cla__prompt_kernel
.p2align 8
.type concat_heads__ssm_conv_h3__compressed_kv_cla__prompt_kernel,@function
concat_heads__ssm_conv_h3__compressed_kv_cla__prompt_kernel:
s_cmp_ge_u32 s2, 256
s_cbranch_scc1 M_end
s_load_dwordx16 s[64:79], s[0:1], 0
s_load_dwordx8 s[80:87], s[0:1], 64
s_load_dwordx4 s[88:91], s[0:1], 96
s_load_dwordx2 s[92:93], s[0:1], 112
s_getpc_b64 s[58:59]
M_pc:
s_lshr_b32 s22, s2, 3
s_lshl_b32 s22, s22, 5
v_and_b32 v26, 31, v0
v_add_u32 v26, s22, v26
v_lshlrev_b32 v26, 7, v26
v_min_u32 v26, M_end-M_pc, v26
v_mov_b32 v27, s59
v_add_co_u32 v26, vcc, s58, v26
s_nop 1
v_addc_co_u32 v27, vcc, 0, v27, vcc
global_load_dword v21, v[26:27], off
v_lshrrev_b32 v28, 6, v0
v_and_b32 v29, 63, v0
v_lshlrev_b32 v1, 4, v29
v_readfirstlane_b32 s3, v28
s_lshr_b32 s21, s2, 5
v_lshrrev_b32 v26, 7, v1
v_lshrrev_b32 v27, 1, v26
v_lshlrev_b32 v27, 4, v27
v_and_b32 v28, 0x70, v1
v_xor_b32 v27, v27, v28
v_mul_u32_u24 v26, 2048, v26
v_add_u32 v12, v26, v27
v_xor_b32 v27, 64, v27
v_add_u32 v26, v26, v27
v_add_u32 v13, 15360, v26
v_add_u32 v14, 30720, v12
v_add_u32 v15, 46080, v26
s_lshl_b32 s28, s3, 13
s_lshl_b32 s24, s21, 19
s_lshl_b32 s22, s3, 17
s_add_u32 s24, s24, s22
s_add_u32 s25, s24, 65536
s_mov_b32 s10, 4194304
s_mov_b32 s11, 0x20000
s_and_b32 s20, s2, 7
s_lshl_b32 s20, s20, 1
s_bfe_u32 s22, s2, 0x10003
s_add_u32 s20, s20, s22
v_lshrrev_b32 v26, 5, v29
v_and_b32 v27, 31, v29
s_and_b32 s22, s3, 1
s_lshl_b32 s22, s22, 2
v_or_b32 v28, s22, v26
v_lshlrev_b32 v28, 1, v28
v_xor_b32 v27, v27, v28
v_lshlrev_b32 v27, 4, v27
v_lshl_add_u32 v16, v26, 13, v27
v_xor_b32 v26, 64, v16
v_add_u32 v17, 15360, v26
v_add_u32 v18, 30720, v16
v_add_u32 v19, 46080, v26
s_lshl_b32 s29, s3, 12
s_lshl_b32 s26, s3, 16
s_lshl_b32 s22, s20, 9
s_add_u32 s26, s26, s22
s_add_u32 s27, s26, 262144
s_mov_b32 s14, 8388608
s_mov_b32 s15, 0x20000
s_mov_b32 s101, 0x40000
v_and_b32 v30, 15, v29
v_lshrrev_b32 v31, 4, v29
v_lshrrev_b32 v26, 1, v30
v_xor_b32 v26, v31, v26
v_lshlrev_b32 v26, 4, v26
v_lshl_add_u32 v2, v30, 7, v26
s_lshr_b32 s22, s3, 1
s_lshl_b32 s22, s22, 14
v_add_u32 v2, s22, v2
v_xor_b32 v3, 64, v2
v_lshrrev_b32 v26, 2, v30
v_and_b32 v27, 1, v31
v_lshl_or_b32 v27, v27, 2, v26
v_lshl_add_u32 v26, v31, 3, v26
v_lshlrev_b32 v26, 9, v26
v_lshl_add_u32 v26, v27, 5, v26
v_and_b32 v27, 3, v29
v_lshl_add_u32 v26, v27, 3, v26
s_and_b32 s22, s3, 1
s_lshl_b32 s22, s22, 8
s_add_u32 s22, s22, 0x10000
v_xor_b32 v4, s22, v26
v_xor_b32 v5, 32, v4
v_xor_b32 v6, 64, v4
v_xor_b32 v7, 96, v4
v_xor_b32 v8, 128, v4
v_xor_b32 v9, 160, v4
v_xor_b32 v10, 192, v4
v_xor_b32 v11, 224, v4
s_mov_b32 s19, 0x20000
s_cmp_eq_u32 s3, 2
s_cbranch_scc1 M_pf2
s_cmp_lg_u32 s3, 0
s_cbranch_scc1 M_pf3
s_mov_b32 s18, 8388608
s_mov_b32 s51, 8388608
s_mov_b32 s47, 524288
s_mov_b32 s43, 524288
s_lshl_b32 s22, s21, 16
s_lshl_b32 s23, s20, 9
s_add_u32 s22, s22, s23
v_bfe_u32 v26, v29, 2, 3
v_lshl_add_u32 v26, v26, 13, s22
v_and_b32 v27, 3, v29
v_lshl_add_u32 v20, v27, 7, v26
v_lshrrev_b32 v27, 5, v29
v_lshl_add_u32 v22, v27, 19, v20
v_cmp_gt_u32 vcc, 32, v29
s_branch M_pfd
M_pf2:
s_mov_b32 s18, 4194304
s_mov_b32 s51, 2048
s_mov_b32 s47, 256
s_mov_b32 s43, 0
s_lshl_b32 s22, s2, 14
v_bfe_u32 v26, v29, 1, 3
v_lshl_add_u32 v26, v26, 11, s22
v_and_b32 v27, 1, v29
v_lshl_add_u32 v20, v27, 7, v26
v_bfe_u32 v27, v29, 4, 1
v_lshl_add_u32 v22, v27, 8, v20
v_cmp_gt_u32 vcc, 16, v29
s_branch M_pfd
M_pf3:
s_mov_b32 s18, 0
s_mov_b32 s51, 3112960
s_mov_b32 s47, 622592
s_mov_b32 s43, 0
s_mul_i32 s22, s2, 2432
v_lshl_add_u32 v20, v29, 7, s22
v_mov_b32 v22, v20
v_cmp_gt_u32 vcc, 19, v29
M_pfd:
v_mov_b32 v26, 3221225472
s_nop 0
v_cndmask_b32 v20, v26, v20, vcc
s_bitcmp1_b32 s2, 4
s_waitcnt lgkmcnt(0)
s_mov_b64 s[8:9], s[78:79]
s_cselect_b64 s[12:13], s[84:85], s[82:83]
s_add_u32 m0, s28, 0
s_nop 0
buffer_load_dwordx4 v12, s[8:11], s24 offen offset:0 lds
buffer_load_dwordx4 v13, s[8:11], s24 offen offset:1024 lds
buffer_load_dwordx4 v14, s[8:11], s24 offen offset:2048 lds
buffer_load_dwordx4 v15, s[8:11], s24 offen offset:3072 lds
s_add_u32 s24, s24, 128
s_add_u32 m0, s28, 4096
s_nop 0
buffer_load_dwordx4 v12, s[8:11], s25 offen offset:0 lds
buffer_load_dwordx4 v13, s[8:11], s25 offen offset:1024 lds
buffer_load_dwordx4 v14, s[8:11], s25 offen offset:2048 lds
buffer_load_dwordx4 v15, s[8:11], s25 offen offset:3072 lds
s_add_u32 s25, s25, 128
s_add_u32 m0, s29, 65536
s_nop 0
buffer_load_dwordx4 v16, s[12:15], s26 offen offset:0 lds
buffer_load_dwordx4 v17, s[12:15], s26 offen offset:1024 lds
buffer_load_dwordx4 v18, s[12:15], s26 offen offset:2048 lds
buffer_load_dwordx4 v19, s[12:15], s26 offen offset:3072 lds
s_add_u32 s26, s26, 524288
s_add_u32 m0, s29, 81920
s_nop 0
buffer_load_dwordx4 v16, s[12:15], s27 offen offset:0 lds
buffer_load_dwordx4 v17, s[12:15], s27 offen offset:1024 lds
buffer_load_dwordx4 v18, s[12:15], s27 offen offset:2048 lds
buffer_load_dwordx4 v19, s[12:15], s27 offen offset:3072 lds
s_add_u32 s27, s27, 524288
s_mov_b64 exec, 0
s_bfe_u32 s22, s2, 0x10004
s_lshl_b32 s22, s22, 2
s_add_u32 s22, s22, s3
s_cmp_lg_u32 s22, 0
s_cbranch_scc1 M_tw1
s_call_b64 s[98:99], PAD_0
s_call_b64 s[98:99], PAD_8
s_branch M_td
M_tw1:
s_cmp_lg_u32 s22, 1
s_cbranch_scc1 M_tw2
s_call_b64 s[98:99], PAD_1
s_call_b64 s[98:99], PAD_9
s_branch M_td
M_tw2:
s_cmp_lg_u32 s22, 2
s_cbranch_scc1 M_tw3
s_call_b64 s[98:99], PAD_2
s_call_b64 s[98:99], PAD_6
s_call_b64 s[98:99], PAD_10
s_branch M_td
M_tw3:
s_cmp_lg_u32 s22, 3
s_cbranch_scc1 M_tw4
s_call_b64 s[98:99], PAD_3
s_call_b64 s[98:99], PAD_7
s_call_b64 s[98:99], PAD_11
s_branch M_td
M_tw4:
s_cmp_lg_u32 s22, 4
s_cbranch_scc1 M_tw5
s_call_b64 s[98:99], PAD_22
s_branch M_td
M_tw5:
s_cmp_lg_u32 s22, 5
s_cbranch_scc1 M_tw6
s_call_b64 s[98:99], PAD_23
s_branch M_td
M_tw6:
s_cmp_lg_u32 s22, 6
s_cbranch_scc1 M_tw7
s_call_b64 s[98:99], PAD_24
s_branch M_td
M_tw7:
s_call_b64 s[98:99], PAD_21
M_td:
s_mov_b64 exec, -1
s_add_u32 m0, s28, 32768
s_nop 0
buffer_load_dwordx4 v12, s[8:11], s24 offen offset:0 lds
buffer_load_dwordx4 v13, s[8:11], s24 offen offset:1024 lds
buffer_load_dwordx4 v14, s[8:11], s24 offen offset:2048 lds
buffer_load_dwordx4 v15, s[8:11], s24 offen offset:3072 lds
s_add_u32 s24, s24, 128
s_add_u32 m0, s28, 36864
s_nop 0
buffer_load_dwordx4 v12, s[8:11], s25 offen offset:0 lds
buffer_load_dwordx4 v13, s[8:11], s25 offen offset:1024 lds
buffer_load_dwordx4 v14, s[8:11], s25 offen offset:2048 lds
buffer_load_dwordx4 v15, s[8:11], s25 offen offset:3072 lds
s_add_u32 s25, s25, 128
s_cmp_eq_u32 s3, 0
s_cselect_b64 s[16:17], s[12:13], s[8:9]
buffer_load_dword v21, v22, s[16:19], s43 offen
s_add_u32 s43, s43, s47
s_add_u32 s43, s43, s47
s_mov_b32 s4, s92
s_mov_b32 s5, s93
s_mov_b32 s6, 268435456
s_mov_b32 s7, 0x20000
s_cmp_eq_u32 s3, 3
s_cselect_b64 s[40:41], s[76:77], s[80:81]
s_cselect_b32 s42, 1835008, 0
s_cmp_eq_u32 s3, 1
s_cselect_b32 s42, 3670016, s42
s_cmp_eq_u32 s3, 3
s_cselect_b64 s[44:45], s[86:87], s[72:73]
s_cselect_b32 s46, 3670016, 0
s_cmp_eq_u32 s3, 1
s_cselect_b32 s46, 1835008, s46
s_cmp_eq_u32 s3, 2
s_cselect_b64 s[40:41], s[64:65], s[40:41]
s_cselect_b32 s42, 1835008, s42
s_waitcnt vmcnt(9)
s_barrier
ds_read_b64_tr_b16 a[128:129], v4 offset:0
ds_read_b64_tr_b16 a[130:131], v4 offset:2048
ds_read_b64_tr_b16 a[132:133], v4 offset:16384
ds_read_b64_tr_b16 a[134:135], v4 offset:18432
ds_read_b128 a[0:3], v2 offset:0
ds_read_b128 a[4:7], v3 offset:0
ds_read_b128 a[8:11], v2 offset:2048
ds_read_b128 a[12:15], v3 offset:2048
ds_read_b128 a[16:19], v2 offset:4096
ds_read_b128 a[20:23], v3 offset:4096
ds_read_b128 a[24:27], v2 offset:6144
ds_read_b128 a[28:31], v3 offset:6144
ds_read_b128 a[32:35], v2 offset:8192
ds_read_b128 a[36:39], v3 offset:8192
ds_read_b128 a[40:43], v2 offset:10240
ds_read_b128 a[44:47], v3 offset:10240
ds_read_b128 a[48:51], v2 offset:12288
ds_read_b128 a[52:55], v3 offset:12288
ds_read_b128 a[56:59], v2 offset:14336
ds_read_b128 a[60:63], v3 offset:14336
s_add_u32 m0, s29, 98304
s_nop 0
buffer_load_dwordx4 v16, s[12:15], s26 offen offset:0 lds
buffer_load_dwordx4 v17, s[12:15], s26 offen offset:1024 lds
buffer_load_dwordx4 v18, s[12:15], s26 offen offset:2048 lds
buffer_load_dwordx4 v19, s[12:15], s26 offen offset:3072 lds
s_add_u32 s26, s26, 524288
s_waitcnt lgkmcnt(0)
s_barrier
s_bitcmp1_b32 s2, 4
s_cbranch_scc1 M_V
s_branch M_K
M_t2B:
s_mov_b64 exec, 0
s_cmp_lg_u32 s3, 0
s_cbranch_scc1 M_uw1
s_call_b64 s[98:99], PAD_32
s_call_b64 s[98:99], PAD_16
s_branch M_ud
M_uw1:
s_cmp_lg_u32 s3, 1
s_cbranch_scc1 M_uw2
s_call_b64 s[98:99], PAD_9
s_call_b64 s[98:99], PAD_33
s_call_b64 s[98:99], PAD_13
s_branch M_ud
M_uw2:
s_cmp_lg_u32 s3, 2
s_cbranch_scc1 M_uw3
s_call_b64 s[98:99], PAD_10
s_call_b64 s[98:99], PAD_34
s_call_b64 s[98:99], PAD_14
s_branch M_ud
M_uw3:
s_call_b64 s[98:99], PAD_11
s_call_b64 s[98:99], PAD_15
M_ud:
s_mov_b64 exec, -1
s_branch M_t2Br
M_t2A:
s_mov_b64 exec, 0
s_lshl_b32 s22, s24, 2
s_add_u32 s22, s22, s3
s_cmp_lg_u32 s22, 0
s_cbranch_scc1 M_vw1
s_call_b64 s[98:99], PAD_32
s_call_b64 s[98:99], PAD_16
s_branch M_vd
M_vw1:
s_cmp_lg_u32 s22, 1
s_cbranch_scc1 M_vw2
s_call_b64 s[98:99], PAD_13
s_branch M_vd
M_vw2:
s_cmp_lg_u32 s22, 2
s_cbranch_scc1 M_vw3
s_call_b64 s[98:99], PAD_14
s_call_b64 s[98:99], PAD_19
s_branch M_vd
M_vw3:
s_cmp_lg_u32 s22, 3
s_cbranch_scc1 M_vw4
s_call_b64 s[98:99], PAD_15
s_call_b64 s[98:99], PAD_20
s_branch M_vd
M_vw4:
s_cmp_lg_u32 s22, 4
s_cbranch_scc1 M_vw5
s_call_b64 s[98:99], PAD_12
s_call_b64 s[98:99], PAD_16
s_branch M_vd
M_vw5:
s_cmp_lg_u32 s22, 5
s_cbranch_scc1 M_vw6
s_call_b64 s[98:99], PAD_13
s_branch M_vd
M_vw6:
s_cmp_lg_u32 s22, 6
s_cbranch_scc1 M_vw7
s_call_b64 s[98:99], PAD_14
s_branch M_vd
M_vw7:
s_call_b64 s[98:99], PAD_15
M_vd:
s_mov_b64 exec, -1
s_branch M_t2Ar
M_tret:
s_setpc_b64 s[98:99]
.p2align 12
PAD_0:
s_cbranch_execz PAD_4
M_K:
v_mfma_f32_16x16x32_bf16 v[32:35], a[128:131], a[0:3], 0
s_add_u32 m0, s29, 114688
ds_read_b64_tr_b16 a[136:137], v5 offset:0
v_mfma_f32_16x16x32_bf16 v[32:35], a[132:135], a[4:7], v[32:35]
s_mov_b32 s32, 8192
buffer_load_dwordx4 v16, s[12:15], s27 offen offset:0 lds
v_mfma_f32_16x16x32_bf16 v[40:43], a[128:131], a[8:11], 0
s_mov_b32 s33, 8192
ds_read_b64_tr_b16 a[138:139], v5 offset:2048
v_mfma_f32_16x16x32_bf16 v[40:43], a[132:135], a[12:15], v[40:43]
s_mov_b32 s34, 8192
v_mfma_f32_16x16x32_bf16 v[48:51], a[128:131], a[16:19], 0
s_mov_b32 s35, 4294910976
ds_read_b64_tr_b16 a[140:141], v5 offset:16384
v_mfma_f32_16x16x32_bf16 v[48:51], a[132:135], a[20:23], v[48:51]
s_mov_b32 s36, 4294910976
buffer_load_dwordx4 v17, s[12:15], s27 offen offset:1024 lds
v_mfma_f32_16x16x32_bf16 v[56:59], a[128:131], a[24:27], 0
s_mov_b32 s30, 8
ds_read_b64_tr_b16 a[142:143], v5 offset:18432
v_mfma_f32_16x16x32_bf16 v[56:59], a[132:135], a[28:31], v[56:59]
s_mov_b32 s82, 3221225472
v_mfma_f32_16x16x32_bf16 v[64:67], a[128:131], a[32:35], 0
s_mul_hi_u32 s38, s2, 613566757
v_mfma_f32_16x16x32_bf16 v[64:67], a[132:135], a[36:39], v[64:67]
s_mul_i32 s39, s38, 7
buffer_load_dwordx4 v18, s[12:15], s27 offen offset:2048 lds
v_mfma_f32_16x16x32_bf16 v[72:75], a[128:131], a[40:43], 0
s_sub_u32 s39, s2, s39
v_mov_b32 v246, 0
v_mov_b32 v229, 0
v_mfma_f32_16x16x32_bf16 v[72:75], a[132:135], a[44:47], v[72:75]
v_mov_b32 v231, 0
v_mfma_f32_16x16x32_bf16 v[80:83], a[128:131], a[48:51], 0
s_mov_b32 s60, s90
v_mfma_f32_16x16x32_bf16 v[80:83], a[132:135], a[52:55], v[80:83]
s_mov_b32 s61, s91
buffer_load_dwordx4 v19, s[12:15], s27 offen offset:3072 lds
v_mfma_f32_16x16x32_bf16 v[88:91], a[128:131], a[56:59], 0
s_add_u32 s27, s27, 524288
v_mfma_f32_16x16x32_bf16 v[88:91], a[132:135], a[60:63], v[88:91]
s_waitcnt lgkmcnt(0)
s_mov_b32 s62, 256
v_mfma_f32_16x16x32_bf16 v[36:39], a[136:139], a[0:3], 0
s_add_u32 m0, s28, 0
ds_read_b64_tr_b16 a[128:129], v6 offset:0
v_mfma_f32_16x16x32_bf16 v[36:39], a[140:143], a[4:7], v[36:39]
s_mov_b32 s63, 0x20000
buffer_load_dwordx4 v12, s[8:11], s24 offen offset:0 lds
v_mfma_f32_16x16x32_bf16 v[44:47], a[136:139], a[8:11], 0
s_mul_hi_u32 s55, s2, 1431655766
ds_read_b64_tr_b16 a[130:131], v6 offset:2048
v_mfma_f32_16x16x32_bf16 v[44:47], a[140:143], a[12:15], v[44:47]
s_mul_i32 s55, s55, 3
v_mfma_f32_16x16x32_bf16 v[52:55], a[136:139], a[16:19], 0
s_sub_u32 s55, s2, s55
ds_read_b64_tr_b16 a[132:133], v6 offset:16384
v_mfma_f32_16x16x32_bf16 v[52:55], a[140:143], a[20:23], v[52:55]
s_add_u32 s55, s55, 5
buffer_load_dwordx4 v13, s[8:11], s24 offen offset:1024 lds
v_mfma_f32_16x16x32_bf16 v[60:63], a[136:139], a[24:27], 0
s_lshr_b32 s22, s2, 4
ds_read_b64_tr_b16 a[134:135], v6 offset:18432
v_mfma_f32_16x16x32_bf16 v[60:63], a[140:143], a[28:31], v[60:63]
s_lshl_b32 s23, s20, 5
v_mfma_f32_16x16x32_bf16 v[68:71], a[136:139], a[32:35], 0
s_add_u32 s23, s23, s22
v_mfma_f32_16x16x32_bf16 v[68:71], a[140:143], a[36:39], v[68:71]
s_lshl_b32 s23, s23, 2
buffer_load_dwordx4 v14, s[8:11], s24 offen offset:2048 lds
v_mfma_f32_16x16x32_bf16 v[76:79], a[136:139], a[40:43], 0
s_and_b32 s22, s2, 16
v_mfma_f32_16x16x32_bf16 v[76:79], a[140:143], a[44:47], v[76:79]
s_lshl_b32 s22, s22, 7
v_mfma_f32_16x16x32_bf16 v[84:87], a[136:139], a[48:51], 0
s_add_u32 s23, s23, s22
v_mov_b32 v28, 3221225472
v_writelane_b32 v28, s23, 0
v_mfma_f32_16x16x32_bf16 v[84:87], a[140:143], a[52:55], v[84:87]
s_add_u32 s56, s23, 16384
buffer_load_dwordx4 v15, s[8:11], s24 offen offset:3072 lds
v_mfma_f32_16x16x32_bf16 v[92:95], a[136:139], a[56:59], 0
s_add_u32 s24, s24, 128
v_writelane_b32 v28, s56, 1
v_mfma_f32_16x16x32_bf16 v[92:95], a[140:143], a[60:63], v[92:95]
s_waitcnt lgkmcnt(0)
s_add_u32 s56, s23, 4096
v_writelane_b32 v28, s56, 2
v_mfma_f32_16x16x32_bf16 v[96:99], a[128:131], a[0:3], 0
s_add_u32 m0, s28, 4096
ds_read_b64_tr_b16 a[136:137], v7 offset:0
v_mfma_f32_16x16x32_bf16 v[96:99], a[132:135], a[4:7], v[96:99]
s_sub_u32 s37, 15, s21
buffer_load_dwordx4 v12, s[8:11], s25 offen offset:0 lds
v_mfma_f32_16x16x32_bf16 v[104:107], a[128:131], a[8:11], 0
ds_read_b64_tr_b16 a[138:139], v7 offset:2048
v_mfma_f32_16x16x32_bf16 v[104:107], a[132:135], a[12:15], v[104:107]
v_mfma_f32_16x16x32_bf16 v[112:115], a[128:131], a[16:19], 0
ds_read_b64_tr_b16 a[140:141], v7 offset:16384
v_mfma_f32_16x16x32_bf16 v[112:115], a[132:135], a[20:23], v[112:115]
buffer_load_dwordx4 v13, s[8:11], s25 offen offset:1024 lds
v_mfma_f32_16x16x32_bf16 v[120:123], a[128:131], a[24:27], 0
ds_read_b64_tr_b16 a[142:143], v7 offset:18432
v_mfma_f32_16x16x32_bf16 v[120:123], a[132:135], a[28:31], v[120:123]
v_mfma_f32_16x16x32_bf16 v[128:131], a[128:131], a[32:35], 0
v_mfma_f32_16x16x32_bf16 v[128:131], a[132:135], a[36:39], v[128:131]
buffer_load_dwordx4 v14, s[8:11], s25 offen offset:2048 lds
v_mfma_f32_16x16x32_bf16 v[136:139], a[128:131], a[40:43], 0
v_mfma_f32_16x16x32_bf16 v[136:139], a[132:135], a[44:47], v[136:139]
v_mfma_f32_16x16x32_bf16 v[144:147], a[128:131], a[48:51], 0
v_mfma_f32_16x16x32_bf16 v[144:147], a[132:135], a[52:55], v[144:147]
buffer_load_dwordx4 v15, s[8:11], s25 offen offset:3072 lds
v_mfma_f32_16x16x32_bf16 v[152:155], a[128:131], a[56:59], 0
s_add_u32 s25, s25, 128
v_mfma_f32_16x16x32_bf16 v[152:155], a[132:135], a[60:63], v[152:155]
s_waitcnt vmcnt(17) lgkmcnt(0)
s_barrier
v_mfma_f32_16x16x32_bf16 v[100:103], a[136:139], a[0:3], 0
ds_read_b64_tr_b16 a[128:129], v8 offset:0
v_mfma_f32_16x16x32_bf16 v[100:103], a[140:143], a[4:7], v[100:103]
buffer_load_dword v21, v20, s[16:19], s43 offen
v_mfma_f32_16x16x32_bf16 v[108:111], a[136:139], a[8:11], 0
s_add_u32 s43, s43, s47
ds_read_b64_tr_b16 a[130:131], v8 offset:2048
v_mfma_f32_16x16x32_bf16 v[108:111], a[140:143], a[12:15], v[108:111]
s_cmp_ge_u32 s43, s51
v_mfma_f32_16x16x32_bf16 v[116:119], a[136:139], a[16:19], 0
s_cselect_b32 s43, 0, s43
ds_read_b64_tr_b16 a[132:133], v8 offset:16384
v_mfma_f32_16x16x32_bf16 v[116:119], a[140:143], a[20:23], v[116:119]
s_cselect_b32 s51, s42, s51
v_mfma_f32_16x16x32_bf16 v[124:127], a[136:139], a[24:27], 0
s_cselect_b64 s[16:17], s[40:41], s[16:17]
ds_read_b64_tr_b16 a[134:135], v8 offset:18432
v_mfma_f32_16x16x32_bf16 v[124:127], a[140:143], a[28:31], v[124:127]
s_cselect_b32 s18, s42, s18
v_mfma_f32_16x16x32_bf16 v[132:135], a[136:139], a[32:35], 0
s_cselect_b64 s[40:41], s[44:45], s[40:41]
ds_read_b128 a[64:67], v2 offset:32768
v_mfma_f32_16x16x32_bf16 v[132:135], a[140:143], a[36:39], v[132:135]
s_cselect_b32 s42, s46, s42
v_mfma_f32_16x16x32_bf16 v[140:143], a[136:139], a[40:43], 0
s_cselect_b32 s46, 0, s46
ds_read_b128 a[68:71], v3 offset:32768
v_mfma_f32_16x16x32_bf16 v[140:143], a[140:143], a[44:47], v[140:143]
ds_read_b128 a[72:75], v2 offset:34816
v_mfma_f32_16x16x32_bf16 v[148:151], a[136:139], a[48:51], 0
ds_read_b128 a[76:79], v3 offset:34816
v_mfma_f32_16x16x32_bf16 v[148:151], a[140:143], a[52:55], v[148:151]
buffer_load_dword v21, v20, s[16:19], s43 offen
v_mfma_f32_16x16x32_bf16 v[156:159], a[136:139], a[56:59], 0
s_add_u32 s43, s43, s47
ds_read_b128 a[80:83], v2 offset:36864
v_mfma_f32_16x16x32_bf16 v[156:159], a[140:143], a[60:63], v[156:159]
s_waitcnt lgkmcnt(5)
s_cmp_ge_u32 s43, s51
ds_read_b128 a[84:87], v3 offset:36864
v_mfma_f32_16x16x32_bf16 v[160:163], a[128:131], a[0:3], 0
s_cselect_b32 s43, 0, s43
ds_read_b64_tr_b16 a[136:137], v9 offset:0
v_mfma_f32_16x16x32_bf16 v[160:163], a[132:135], a[4:7], v[160:163]
s_cselect_b32 s51, s42, s51
v_mfma_f32_16x16x32_bf16 v[168:171], a[128:131], a[8:11], 0
s_cselect_b64 s[16:17], s[40:41], s[16:17]
ds_read_b64_tr_b16 a[138:139], v9 offset:2048
v_mfma_f32_16x16x32_bf16 v[168:171], a[132:135], a[12:15], v[168:171]
s_cselect_b32 s18, s42, s18
v_mfma_f32_16x16x32_bf16 v[176:179], a[128:131], a[16:19], 0
s_cselect_b64 s[40:41], s[44:45], s[40:41]
ds_read_b64_tr_b16 a[140:141], v9 offset:16384
v_mfma_f32_16x16x32_bf16 v[176:179], a[132:135], a[20:23], v[176:179]
s_cselect_b32 s42, s46, s42
v_mfma_f32_16x16x32_bf16 v[184:187], a[128:131], a[24:27], 0
s_cselect_b32 s46, 0, s46
ds_read_b64_tr_b16 a[142:143], v9 offset:18432
v_mfma_f32_16x16x32_bf16 v[184:187], a[132:135], a[28:31], v[184:187]
s_bitcmp1_b32 s2, 4
s_cselect_b32 s37, s21, s37
s_lshl_b32 s56, s37, 5
v_mfma_f32_16x16x32_bf16 v[192:195], a[128:131], a[32:35], 0
s_add_u32 s56, s56, s20
s_lshl_b32 s56, s56, 2
s_add_u32 s56, s56, 8192
v_mfma_f32_16x16x32_bf16 v[192:195], a[132:135], a[36:39], v[192:195]
v_writelane_b32 v28, s56, 3
v_mfma_f32_16x16x32_bf16 v[200:203], a[128:131], a[40:43], 0
s_add_u32 s56, s56, 2048
ds_read_b128 a[88:91], v2 offset:38912
v_writelane_b32 v28, s56, 6
v_mfma_f32_16x16x32_bf16 v[200:203], a[132:135], a[44:47], v[200:203]
s_lshl_b32 s56, s2, 2
s_add_u32 s56, s56, 12288
ds_read_b128 a[92:95], v3 offset:38912
v_mfma_f32_16x16x32_bf16 v[208:211], a[128:131], a[48:51], 0
s_waitcnt lgkmcnt(2)
ds_read_b128 a[96:99], v2 offset:40960
v_writelane_b32 v28, s56, 4
v_mfma_f32_16x16x32_bf16 v[208:211], a[132:135], a[52:55], v[208:211]
s_lshl_b32 s56, s39, 5
s_add_u32 s56, s56, s38
s_lshl_b32 s56, s56, 2
v_mfma_f32_16x16x32_bf16 v[216:219], a[128:131], a[56:59], 0
s_add_u32 s56, s56, 20480
s_cmp_lt_u32 s2, 224
ds_read_b128 a[100:103], v3 offset:40960
v_mfma_f32_16x16x32_bf16 v[216:219], a[132:135], a[60:63], v[216:219]
s_cselect_b32 s56, s56, 3221225472
ds_read_b128 a[104:107], v2 offset:43008
v_writelane_b32 v28, s56, 7
v_mfma_f32_16x16x32_bf16 v[164:167], a[136:139], a[0:3], 0
s_cmp_eq_u32 s3, 0
s_cselect_b32 s56, 94371840, 3221225472
ds_read_b64_tr_b16 a[128:129], v10 offset:0
v_mfma_f32_16x16x32_bf16 v[164:167], a[140:143], a[4:7], v[164:167]
buffer_store_dword v246, v28, s[4:7], s56 offen sc1
v_mfma_f32_16x16x32_bf16 v[172:175], a[136:139], a[8:11], 0
ds_read_b64_tr_b16 a[130:131], v10 offset:2048
v_mov_b32 v27, 1
v_mfma_f32_16x16x32_bf16 v[172:175], a[140:143], a[12:15], v[172:175]
v_cmp_eq_u32 vcc, 0, v0
v_mov_b32 v26, 3221225472
v_mfma_f32_16x16x32_bf16 v[180:183], a[136:139], a[16:19], 0
s_lshl_b32 s31, s20, 20
s_lshl_b32 s22, s21, 17
ds_read_b64_tr_b16 a[132:133], v10 offset:16384
v_mfma_f32_16x16x32_bf16 v[180:183], a[140:143], a[20:23], v[180:183]
v_cndmask_b32 v26, v26, v246, vcc
v_mfma_f32_16x16x32_bf16 v[188:191], a[136:139], a[24:27], 0
s_add_u32 s31, s31, s22
s_lshr_b32 s22, s3, 1
ds_read_b64_tr_b16 a[134:135], v10 offset:18432
v_mfma_f32_16x16x32_bf16 v[188:191], a[140:143], a[28:31], v[188:191]
s_lshl_b32 s22, s22, 16
s_add_u32 s31, s31, s22
s_and_b32 s22, s3, 1
v_mfma_f32_16x16x32_bf16 v[196:199], a[136:139], a[32:35], 0
s_lshl_b32 s22, s22, 12
s_add_u32 s31, s31, s22
v_mfma_f32_16x16x32_bf16 v[196:199], a[140:143], a[36:39], v[196:199]
v_mfma_f32_16x16x32_bf16 v[204:207], a[136:139], a[40:43], 0
ds_read_b128 a[108:111], v3 offset:43008
v_mfma_f32_16x16x32_bf16 v[204:207], a[140:143], a[44:47], v[204:207]
ds_read_b128 a[112:115], v2 offset:45056
v_mfma_f32_16x16x32_bf16 v[212:215], a[136:139], a[48:51], 0
ds_read_b128 a[116:119], v3 offset:45056
v_mfma_f32_16x16x32_bf16 v[212:215], a[140:143], a[52:55], v[212:215]
v_mfma_f32_16x16x32_bf16 v[220:223], a[136:139], a[56:59], 0
ds_read_b128 a[120:123], v2 offset:47104
v_mfma_f32_16x16x32_bf16 v[220:223], a[140:143], a[60:63], v[220:223]
s_waitcnt lgkmcnt(4)
ds_read_b128 a[124:127], v3 offset:47104
v_mfma_f32_16x16x32_bf16 a[192:195], a[128:131], a[0:3], 0
ds_read_b64_tr_b16 a[136:137], v11 offset:0
v_mfma_f32_16x16x32_bf16 a[192:195], a[132:135], a[4:7], a[192:195]
v_mfma_f32_16x16x32_bf16 a[200:203], a[128:131], a[8:11], 0
ds_read_b64_tr_b16 a[138:139], v11 offset:2048
v_mfma_f32_16x16x32_bf16 a[200:203], a[132:135], a[12:15], a[200:203]
v_mfma_f32_16x16x32_bf16 a[208:211], a[128:131], a[16:19], 0
ds_read_b64_tr_b16 a[140:141], v11 offset:16384
v_mfma_f32_16x16x32_bf16 a[208:211], a[132:135], a[20:23], a[208:211]
v_mfma_f32_16x16x32_bf16 a[216:219], a[128:131], a[24:27], 0
ds_read_b64_tr_b16 a[142:143], v11 offset:18432
v_mfma_f32_16x16x32_bf16 a[216:219], a[132:135], a[28:31], a[216:219]
v_mfma_f32_16x16x32_bf16 a[224:227], a[128:131], a[32:35], 0
v_mfma_f32_16x16x32_bf16 a[224:227], a[132:135], a[36:39], a[224:227]
v_mfma_f32_16x16x32_bf16 a[232:235], a[128:131], a[40:43], 0
v_mfma_f32_16x16x32_bf16 a[232:235], a[132:135], a[44:47], a[232:235]
v_mfma_f32_16x16x32_bf16 a[240:243], a[128:131], a[48:51], 0
v_mfma_f32_16x16x32_bf16 a[240:243], a[132:135], a[52:55], a[240:243]
v_mfma_f32_16x16x32_bf16 a[248:251], a[128:131], a[56:59], 0
s_waitcnt vmcnt(3) lgkmcnt(0)
v_mfma_f32_16x16x32_bf16 a[248:251], a[132:135], a[60:63], a[248:251]
s_barrier
v_mfma_f32_16x16x32_bf16 a[196:199], a[136:139], a[0:3], 0
s_add_u32 m0, s29, 65536
ds_read_b64_tr_b16 a[128:129], v4 offset:32768
v_mfma_f32_16x16x32_bf16 a[196:199], a[140:143], a[4:7], a[196:199]
buffer_load_dwordx4 v16, s[12:15], s26 offen offset:0 lds
v_mfma_f32_16x16x32_bf16 a[204:207], a[136:139], a[8:11], 0
ds_read_b64_tr_b16 a[130:131], v4 offset:34816
v_mfma_f32_16x16x32_bf16 a[204:207], a[140:143], a[12:15], a[204:207]
v_mfma_f32_16x16x32_bf16 a[212:215], a[136:139], a[16:19], 0
ds_read_b64_tr_b16 a[132:133], v4 offset:49152
v_mfma_f32_16x16x32_bf16 a[212:215], a[140:143], a[20:23], a[212:215]
buffer_load_dwordx4 v17, s[12:15], s26 offen offset:1024 lds
v_mfma_f32_16x16x32_bf16 a[220:223], a[136:139], a[24:27], 0
ds_read_b64_tr_b16 a[134:135], v4 offset:51200
v_mfma_f32_16x16x32_bf16 a[220:223], a[140:143], a[28:31], a[220:223]
v_mfma_f32_16x16x32_bf16 a[228:231], a[136:139], a[32:35], 0
v_mfma_f32_16x16x32_bf16 a[228:231], a[140:143], a[36:39], a[228:231]
buffer_load_dwordx4 v18, s[12:15], s26 offen offset:2048 lds
v_mfma_f32_16x16x32_bf16 a[236:239], a[136:139], a[40:43], 0
v_mfma_f32_16x16x32_bf16 a[236:239], a[140:143], a[44:47], a[236:239]
v_mfma_f32_16x16x32_bf16 a[244:247], a[136:139], a[48:51], 0
v_mfma_f32_16x16x32_bf16 a[244:247], a[140:143], a[52:55], a[244:247]
buffer_load_dwordx4 v19, s[12:15], s26 offen offset:3072 lds
v_mfma_f32_16x16x32_bf16 a[252:255], a[136:139], a[56:59], 0
s_add_u32 s26, s26, 524288
v_mfma_f32_16x16x32_bf16 a[252:255], a[140:143], a[60:63], a[252:255]
s_waitcnt lgkmcnt(0)
Lg_1:
v_mfma_f32_16x16x32_bf16 v[32:35], a[128:131], a[64:67], v[32:35]
s_add_u32 m0, s29, 81920
ds_read_b64_tr_b16 a[136:137], v5 offset:32768
v_mfma_f32_16x16x32_bf16 v[32:35], a[132:135], a[68:71], v[32:35]
buffer_load_dwordx4 v16, s[12:15], s27 offen offset:0 lds
v_mfma_f32_16x16x32_bf16 v[40:43], a[128:131], a[72:75], v[40:43]
ds_read_b64_tr_b16 a[138:139], v5 offset:34816
v_mfma_f32_16x16x32_bf16 v[40:43], a[132:135], a[76:79], v[40:43]
v_mfma_f32_16x16x32_bf16 v[48:51], a[128:131], a[80:83], v[48:51]
ds_read_b64_tr_b16 a[140:141], v5 offset:49152
v_mfma_f32_16x16x32_bf16 v[48:51], a[132:135], a[84:87], v[48:51]
buffer_load_dwordx4 v17, s[12:15], s27 offen offset:1024 lds
v_mfma_f32_16x16x32_bf16 v[56:59], a[128:131], a[88:91], v[56:59]
ds_read_b64_tr_b16 a[142:143], v5 offset:51200
v_mfma_f32_16x16x32_bf16 v[56:59], a[132:135], a[92:95], v[56:59]
v_mfma_f32_16x16x32_bf16 v[64:67], a[128:131], a[96:99], v[64:67]
ds_read_b128 a[0:3], v2 offset:0
v_mfma_f32_16x16x32_bf16 v[64:67], a[132:135], a[100:103], v[64:67]
buffer_load_dwordx4 v18, s[12:15], s27 offen offset:2048 lds
v_mfma_f32_16x16x32_bf16 v[72:75], a[128:131], a[104:107], v[72:75]
ds_read_b128 a[4:7], v3 offset:0
v_mfma_f32_16x16x32_bf16 v[72:75], a[132:135], a[108:111], v[72:75]
v_mfma_f32_16x16x32_bf16 v[80:83], a[128:131], a[112:115], v[80:83]
v_mfma_f32_16x16x32_bf16 v[80:83], a[132:135], a[116:119], v[80:83]
buffer_load_dwordx4 v19, s[12:15], s27 offen offset:3072 lds
v_mfma_f32_16x16x32_bf16 v[88:91], a[128:131], a[120:123], v[88:91]
s_add_u32 s27, s27, 524288
ds_read_b128 a[8:11], v2 offset:2048
v_mfma_f32_16x16x32_bf16 v[88:91], a[132:135], a[124:127], v[88:91]
s_waitcnt lgkmcnt(3)
v_mfma_f32_16x16x32_bf16 v[36:39], a[136:139], a[64:67], v[36:39]
s_add_u32 m0, s28, 32768
ds_read_b64_tr_b16 a[128:129], v6 offset:32768
v_mfma_f32_16x16x32_bf16 v[36:39], a[140:143], a[68:71], v[36:39]
buffer_load_dwordx4 v12, s[8:11], s24 offen offset:0 lds
v_mfma_f32_16x16x32_bf16 v[44:47], a[136:139], a[72:75], v[44:47]
ds_read_b64_tr_b16 a[130:131], v6 offset:34816
v_mfma_f32_16x16x32_bf16 v[44:47], a[140:143], a[76:79], v[44:47]
v_mfma_f32_16x16x32_bf16 v[52:55], a[136:139], a[80:83], v[52:55]
ds_read_b64_tr_b16 a[132:133], v6 offset:49152
v_mfma_f32_16x16x32_bf16 v[52:55], a[140:143], a[84:87], v[52:55]
buffer_load_dwordx4 v13, s[8:11], s24 offen offset:1024 lds
v_mfma_f32_16x16x32_bf16 v[60:63], a[136:139], a[88:91], v[60:63]
ds_read_b64_tr_b16 a[134:135], v6 offset:51200
v_mfma_f32_16x16x32_bf16 v[60:63], a[140:143], a[92:95], v[60:63]
v_mfma_f32_16x16x32_bf16 v[68:71], a[136:139], a[96:99], v[68:71]
ds_read_b128 a[12:15], v3 offset:2048
v_mfma_f32_16x16x32_bf16 v[68:71], a[140:143], a[100:103], v[68:71]
buffer_load_dwordx4 v14, s[8:11], s24 offen offset:2048 lds
v_mfma_f32_16x16x32_bf16 v[76:79], a[136:139], a[104:107], v[76:79]
v_mfma_f32_16x16x32_bf16 v[76:79], a[140:143], a[108:111], v[76:79]
v_mfma_f32_16x16x32_bf16 v[84:87], a[136:139], a[112:115], v[84:87]
ds_read_b128 a[16:19], v2 offset:4096
v_mfma_f32_16x16x32_bf16 v[84:87], a[140:143], a[116:119], v[84:87]
buffer_load_dwordx4 v15, s[8:11], s24 offen offset:3072 lds
v_mfma_f32_16x16x32_bf16 v[92:95], a[136:139], a[120:123], v[92:95]
s_add_u32 s24, s24, 128
ds_read_b128 a[20:23], v3 offset:4096
v_mfma_f32_16x16x32_bf16 v[92:95], a[140:143], a[124:127], v[92:95]
s_waitcnt lgkmcnt(3)
v_mfma_f32_16x16x32_bf16 v[96:99], a[128:131], a[64:67], v[96:99]
s_add_u32 m0, s28, 36864
ds_read_b64_tr_b16 a[136:137], v7 offset:32768
v_mfma_f32_16x16x32_bf16 v[96:99], a[132:135], a[68:71], v[96:99]
buffer_load_dwordx4 v12, s[8:11], s25 offen offset:0 lds
v_mfma_f32_16x16x32_bf16 v[104:107], a[128:131], a[72:75], v[104:107]
ds_read_b64_tr_b16 a[138:139], v7 offset:34816
v_mfma_f32_16x16x32_bf16 v[104:107], a[132:135], a[76:79], v[104:107]
v_mfma_f32_16x16x32_bf16 v[112:115], a[128:131], a[80:83], v[112:115]
ds_read_b64_tr_b16 a[140:141], v7 offset:49152
v_mfma_f32_16x16x32_bf16 v[112:115], a[132:135], a[84:87], v[112:115]
buffer_load_dwordx4 v13, s[8:11], s25 offen offset:1024 lds
v_mfma_f32_16x16x32_bf16 v[120:123], a[128:131], a[88:91], v[120:123]
ds_read_b64_tr_b16 a[142:143], v7 offset:51200
v_mfma_f32_16x16x32_bf16 v[120:123], a[132:135], a[92:95], v[120:123]
v_mfma_f32_16x16x32_bf16 v[128:131], a[128:131], a[96:99], v[128:131]
v_mfma_f32_16x16x32_bf16 v[128:131], a[132:135], a[100:103], v[128:131]
buffer_load_dwordx4 v14, s[8:11], s25 offen offset:2048 lds
v_mfma_f32_16x16x32_bf16 v[136:139], a[128:131], a[104:107], v[136:139]
ds_read_b128 a[24:27], v2 offset:6144
v_mfma_f32_16x16x32_bf16 v[136:139], a[132:135], a[108:111], v[136:139]
v_mfma_f32_16x16x32_bf16 v[144:147], a[128:131], a[112:115], v[144:147]
ds_read_b128 a[28:31], v3 offset:6144
v_mfma_f32_16x16x32_bf16 v[144:147], a[132:135], a[116:119], v[144:147]
buffer_load_dwordx4 v15, s[8:11], s25 offen offset:3072 lds
v_mfma_f32_16x16x32_bf16 v[152:155], a[128:131], a[120:123], v[152:155]
s_add_u32 s25, s25, 128
v_mfma_f32_16x16x32_bf16 v[152:155], a[132:135], a[124:127], v[152:155]
s_waitcnt lgkmcnt(2)
v_mfma_f32_16x16x32_bf16 v[100:103], a[136:139], a[64:67], v[100:103]
ds_read_b64_tr_b16 a[128:129], v8 offset:32768
v_mfma_f32_16x16x32_bf16 v[100:103], a[140:143], a[68:71], v[100:103]
buffer_load_dword v21, v20, s[16:19], s43 offen
v_mfma_f32_16x16x32_bf16 v[108:111], a[136:139], a[72:75], v[108:111]
s_add_u32 s43, s43, s47
ds_read_b64_tr_b16 a[130:131], v8 offset:34816
v_mfma_f32_16x16x32_bf16 v[108:111], a[140:143], a[76:79], v[108:111]
s_cmp_ge_u32 s43, s51
v_mfma_f32_16x16x32_bf16 v[116:119], a[136:139], a[80:83], v[116:119]
s_cselect_b32 s43, 0, s43
ds_read_b64_tr_b16 a[132:133], v8 offset:49152
v_mfma_f32_16x16x32_bf16 v[116:119], a[140:143], a[84:87], v[116:119]
s_cselect_b32 s51, s42, s51
v_mfma_f32_16x16x32_bf16 v[124:127], a[136:139], a[88:91], v[124:127]
s_cselect_b64 s[16:17], s[40:41], s[16:17]
ds_read_b64_tr_b16 a[134:135], v8 offset:51200
v_mfma_f32_16x16x32_bf16 v[124:127], a[140:143], a[92:95], v[124:127]
s_cselect_b32 s18, s42, s18
v_mfma_f32_16x16x32_bf16 v[132:135], a[136:139], a[96:99], v[132:135]
s_cselect_b64 s[40:41], s[44:45], s[40:41]
ds_read_b128 a[32:35], v2 offset:8192
v_mfma_f32_16x16x32_bf16 v[132:135], a[140:143], a[100:103], v[132:135]
s_cselect_b32 s42, s46, s42
v_mfma_f32_16x16x32_bf16 v[140:143], a[136:139], a[104:107], v[140:143]
s_cselect_b32 s46, 0, s46
v_mfma_f32_16x16x32_bf16 v[140:143], a[140:143], a[108:111], v[140:143]
s_cmp_eq_u32 s30, s55
v_mfma_f32_16x16x32_bf16 v[148:151], a[136:139], a[112:115], v[148:151]
s_cselect_b32 s22, 0, 3221225472
ds_read_b128 a[36:39], v3 offset:8192
v_mfma_f32_16x16x32_bf16 v[148:151], a[140:143], a[116:119], v[148:151]
s_sub_u32 s30, s30, 1
buffer_atomic_add v27, v26, s[60:63], s22 offen sc1
v_mfma_f32_16x16x32_bf16 v[156:159], a[136:139], a[120:123], v[156:159]
ds_read_b128 a[40:43], v2 offset:10240
v_mfma_f32_16x16x32_bf16 v[156:159], a[140:143], a[124:127], v[156:159]
s_waitcnt lgkmcnt(3)
v_mfma_f32_16x16x32_bf16 v[160:163], a[128:131], a[64:67], v[160:163]
ds_read_b64_tr_b16 a[136:137], v9 offset:32768
v_mfma_f32_16x16x32_bf16 v[160:163], a[132:135], a[68:71], v[160:163]
v_mfma_f32_16x16x32_bf16 v[168:171], a[128:131], a[72:75], v[168:171]
ds_read_b64_tr_b16 a[138:139], v9 offset:34816
v_mfma_f32_16x16x32_bf16 v[168:171], a[132:135], a[76:79], v[168:171]
v_mfma_f32_16x16x32_bf16 v[176:179], a[128:131], a[80:83], v[176:179]
ds_read_b64_tr_b16 a[140:141], v9 offset:49152
v_mfma_f32_16x16x32_bf16 v[176:179], a[132:135], a[84:87], v[176:179]
v_mfma_f32_16x16x32_bf16 v[184:187], a[128:131], a[88:91], v[184:187]
ds_read_b64_tr_b16 a[142:143], v9 offset:51200
v_mfma_f32_16x16x32_bf16 v[184:187], a[132:135], a[92:95], v[184:187]
v_mfma_f32_16x16x32_bf16 v[192:195], a[128:131], a[96:99], v[192:195]
v_mfma_f32_16x16x32_bf16 v[192:195], a[132:135], a[100:103], v[192:195]
v_mfma_f32_16x16x32_bf16 v[200:203], a[128:131], a[104:107], v[200:203]
ds_read_b128 a[44:47], v3 offset:10240
v_mfma_f32_16x16x32_bf16 v[200:203], a[132:135], a[108:111], v[200:203]
v_mfma_f32_16x16x32_bf16 v[208:211], a[128:131], a[112:115], v[208:211]
ds_read_b128 a[48:51], v2 offset:12288
v_mfma_f32_16x16x32_bf16 v[208:211], a[132:135], a[116:119], v[208:211]
v_mfma_f32_16x16x32_bf16 v[216:219], a[128:131], a[120:123], v[216:219]
v_mfma_f32_16x16x32_bf16 v[216:219], a[132:135], a[124:127], v[216:219]
s_waitcnt lgkmcnt(2)
v_mfma_f32_16x16x32_bf16 v[164:167], a[136:139], a[64:67], v[164:167]
ds_read_b64_tr_b16 a[128:129], v10 offset:32768
v_mfma_f32_16x16x32_bf16 v[164:167], a[140:143], a[68:71], v[164:167]
v_mfma_f32_16x16x32_bf16 v[172:175], a[136:139], a[72:75], v[172:175]
ds_read_b64_tr_b16 a[130:131], v10 offset:34816
v_mfma_f32_16x16x32_bf16 v[172:175], a[140:143], a[76:79], v[172:175]
v_mfma_f32_16x16x32_bf16 v[180:183], a[136:139], a[80:83], v[180:183]
ds_read_b64_tr_b16 a[132:133], v10 offset:49152
v_mfma_f32_16x16x32_bf16 v[180:183], a[140:143], a[84:87], v[180:183]
v_mfma_f32_16x16x32_bf16 v[188:191], a[136:139], a[88:91], v[188:191]
ds_read_b64_tr_b16 a[134:135], v10 offset:51200
v_mfma_f32_16x16x32_bf16 v[188:191], a[140:143], a[92:95], v[188:191]
v_mfma_f32_16x16x32_bf16 v[196:199], a[136:139], a[96:99], v[196:199]
ds_read_b128 a[52:55], v3 offset:12288
v_mfma_f32_16x16x32_bf16 v[196:199], a[140:143], a[100:103], v[196:199]
v_mfma_f32_16x16x32_bf16 v[204:207], a[136:139], a[104:107], v[204:207]
ds_read_b128 a[56:59], v2 offset:14336
v_mfma_f32_16x16x32_bf16 v[204:207], a[140:143], a[108:111], v[204:207]
v_mfma_f32_16x16x32_bf16 v[212:215], a[136:139], a[112:115], v[212:215]
v_mfma_f32_16x16x32_bf16 v[212:215], a[140:143], a[116:119], v[212:215]
v_mfma_f32_16x16x32_bf16 v[220:223], a[136:139], a[120:123], v[220:223]
ds_read_b128 a[60:63], v3 offset:14336
v_mfma_f32_16x16x32_bf16 v[220:223], a[140:143], a[124:127], v[220:223]
s_waitcnt lgkmcnt(3)
v_mfma_f32_16x16x32_bf16 a[192:195], a[128:131], a[64:67], a[192:195]
ds_read_b64_tr_b16 a[136:137], v11 offset:32768
v_mfma_f32_16x16x32_bf16 a[192:195], a[132:135], a[68:71], a[192:195]
v_mfma_f32_16x16x32_bf16 a[200:203], a[128:131], a[72:75], a[200:203]
ds_read_b64_tr_b16 a[138:139], v11 offset:34816
v_mfma_f32_16x16x32_bf16 a[200:203], a[132:135], a[76:79], a[200:203]
v_mfma_f32_16x16x32_bf16 a[208:211], a[128:131], a[80:83], a[208:211]
ds_read_b64_tr_b16 a[140:141], v11 offset:49152
v_mfma_f32_16x16x32_bf16 a[208:211], a[132:135], a[84:87], a[208:211]
v_mfma_f32_16x16x32_bf16 a[216:219], a[128:131], a[88:91], a[216:219]
ds_read_b64_tr_b16 a[142:143], v11 offset:51200
v_mfma_f32_16x16x32_bf16 a[216:219], a[132:135], a[92:95], a[216:219]
v_mfma_f32_16x16x32_bf16 a[224:227], a[128:131], a[96:99], a[224:227]
v_mfma_f32_16x16x32_bf16 a[224:227], a[132:135], a[100:103], a[224:227]
v_mfma_f32_16x16x32_bf16 a[232:235], a[128:131], a[104:107], a[232:235]
v_mfma_f32_16x16x32_bf16 a[232:235], a[132:135], a[108:111], a[232:235]
v_mfma_f32_16x16x32_bf16 a[240:243], a[128:131], a[112:115], a[240:243]
v_mfma_f32_16x16x32_bf16 a[240:243], a[132:135], a[116:119], a[240:243]
v_mfma_f32_16x16x32_bf16 a[248:251], a[128:131], a[120:123], a[248:251]
s_waitcnt vmcnt(2) lgkmcnt(0)
v_mfma_f32_16x16x32_bf16 a[248:251], a[132:135], a[124:127], a[248:251]
s_barrier
v_mfma_f32_16x16x32_bf16 a[196:199], a[136:139], a[64:67], a[196:199]
s_add_u32 m0, s29, 98304
ds_read_b64_tr_b16 a[128:129], v4 offset:0
v_mfma_f32_16x16x32_bf16 a[196:199], a[140:143], a[68:71], a[196:199]
buffer_load_dwordx4 v16, s[12:15], s26 offen offset:0 lds
v_mfma_f32_16x16x32_bf16 a[204:207], a[136:139], a[72:75], a[204:207]
ds_read_b64_tr_b16 a[130:131], v4 offset:2048
v_mfma_f32_16x16x32_bf16 a[204:207], a[140:143], a[76:79], a[204:207]
v_mfma_f32_16x16x32_bf16 a[212:215], a[136:139], a[80:83], a[212:215]
ds_read_b64_tr_b16 a[132:133], v4 offset:16384
v_mfma_f32_16x16x32_bf16 a[212:215], a[140:143], a[84:87], a[212:215]
buffer_load_dwordx4 v17, s[12:15], s26 offen offset:1024 lds
v_mfma_f32_16x16x32_bf16 a[220:223], a[136:139], a[88:91], a[220:223]
ds_read_b64_tr_b16 a[134:135], v4 offset:18432
v_mfma_f32_16x16x32_bf16 a[220:223], a[140:143], a[92:95], a[220:223]
v_mfma_f32_16x16x32_bf16 a[228:231], a[136:139], a[96:99], a[228:231]
v_mfma_f32_16x16x32_bf16 a[228:231], a[140:143], a[100:103], a[228:231]
buffer_load_dwordx4 v18, s[12:15], s26 offen offset:2048 lds
v_mfma_f32_16x16x32_bf16 a[236:239], a[136:139], a[104:107], a[236:239]
v_mfma_f32_16x16x32_bf16 a[236:239], a[140:143], a[108:111], a[236:239]
v_mfma_f32_16x16x32_bf16 a[244:247], a[136:139], a[112:115], a[244:247]
v_mfma_f32_16x16x32_bf16 a[244:247], a[140:143], a[116:119], a[244:247]
buffer_load_dwordx4 v19, s[12:15], s26 offen offset:3072 lds
v_mfma_f32_16x16x32_bf16 a[252:255], a[136:139], a[120:123], a[252:255]
s_add_u32 s26, s26, 524288
v_mfma_f32_16x16x32_bf16 a[252:255], a[140:143], a[124:127], a[252:255]
s_waitcnt lgkmcnt(0)
buffer_store_dword v27, v26, s[4:7], s82 offen sc1
v_mfma_f32_16x16x32_bf16 v[32:35], a[128:131], a[0:3], v[32:35]
s_add_u32 m0, s29, 114688
ds_read_b64_tr_b16 a[136:137], v5 offset:0
v_mfma_f32_16x16x32_bf16 v[32:35], a[132:135], a[4:7], v[32:35]
buffer_load_dwordx4 v16, s[12:15], s27 offen offset:0 lds
v_mfma_f32_16x16x32_bf16 v[40:43], a[128:131], a[8:11], v[40:43]
ds_read_b64_tr_b16 a[138:139], v5 offset:2048
v_mfma_f32_16x16x32_bf16 v[40:43], a[132:135], a[12:15], v[40:43]
v_mfma_f32_16x16x32_bf16 v[48:51], a[128:131], a[16:19], v[48:51]
ds_read_b64_tr_b16 a[140:141], v5 offset:16384
v_mfma_f32_16x16x32_bf16 v[48:51], a[132:135], a[20:23], v[48:51]
buffer_load_dwordx4 v17, s[12:15], s27 offen offset:1024 lds
v_mfma_f32_16x16x32_bf16 v[56:59], a[128:131], a[24:27], v[56:59]
ds_read_b64_tr_b16 a[142:143], v5 offset:18432
v_mfma_f32_16x16x32_bf16 v[56:59], a[132:135], a[28:31], v[56:59]
v_mfma_f32_16x16x32_bf16 v[64:67], a[128:131], a[32:35], v[64:67]
ds_read_b128 a[64:67], v2 offset:32768
v_mfma_f32_16x16x32_bf16 v[64:67], a[132:135], a[36:39], v[64:67]
buffer_load_dwordx4 v18, s[12:15], s27 offen offset:2048 lds
v_mfma_f32_16x16x32_bf16 v[72:75], a[128:131], a[40:43], v[72:75]
ds_read_b128 a[68:71], v3 offset:32768
v_mfma_f32_16x16x32_bf16 v[72:75], a[132:135], a[44:47], v[72:75]
v_mfma_f32_16x16x32_bf16 v[80:83], a[128:131], a[48:51], v[80:83]
v_mfma_f32_16x16x32_bf16 v[80:83], a[132:135], a[52:55], v[80:83]
buffer_load_dwordx4 v19, s[12:15], s27 offen offset:3072 lds
v_mfma_f32_16x16x32_bf16 v[88:91], a[128:131], a[56:59], v[88:91]
s_add_u32 s27, s27, 524288
ds_read_b128 a[72:75], v2 offset:34816
v_mfma_f32_16x16x32_bf16 v[88:91], a[132:135], a[60:63], v[88:91]
s_waitcnt lgkmcnt(3)
v_mfma_f32_16x16x32_bf16 v[36:39], a[136:139], a[0:3], v[36:39]
s_add_u32 m0, s28, 0
ds_read_b64_tr_b16 a[128:129], v6 offset:0
v_mfma_f32_16x16x32_bf16 v[36:39], a[140:143], a[4:7], v[36:39]
buffer_load_dwordx4 v12, s[8:11], s24 offen offset:0 lds
v_mfma_f32_16x16x32_bf16 v[44:47], a[136:139], a[8:11], v[44:47]
ds_read_b64_tr_b16 a[130:131], v6 offset:2048
v_mfma_f32_16x16x32_bf16 v[44:47], a[140:143], a[12:15], v[44:47]
PAD_1:
s_cbranch_execz PAD_5
v_mfma_f32_16x16x32_bf16 v[52:55], a[136:139], a[16:19], v[52:55]
ds_read_b64_tr_b16 a[132:133], v6 offset:16384
v_mfma_f32_16x16x32_bf16 v[52:55], a[140:143], a[20:23], v[52:55]
buffer_load_dwordx4 v13, s[8:11], s24 offen offset:1024 lds
v_mfma_f32_16x16x32_bf16 v[60:63], a[136:139], a[24:27], v[60:63]
ds_read_b64_tr_b16 a[134:135], v6 offset:18432
v_mfma_f32_16x16x32_bf16 v[60:63], a[140:143], a[28:31], v[60:63]
v_mfma_f32_16x16x32_bf16 v[68:71], a[136:139], a[32:35], v[68:71]
ds_read_b128 a[76:79], v3 offset:34816
v_mfma_f32_16x16x32_bf16 v[68:71], a[140:143], a[36:39], v[68:71]
buffer_load_dwordx4 v14, s[8:11], s24 offen offset:2048 lds
v_mfma_f32_16x16x32_bf16 v[76:79], a[136:139], a[40:43], v[76:79]
v_mfma_f32_16x16x32_bf16 v[76:79], a[140:143], a[44:47], v[76:79]
v_mfma_f32_16x16x32_bf16 v[84:87], a[136:139], a[48:51], v[84:87]
ds_read_b128 a[80:83], v2 offset:36864
v_mfma_f32_16x16x32_bf16 v[84:87], a[140:143], a[52:55], v[84:87]
buffer_load_dwordx4 v15, s[8:11], s24 offen offset:3072 lds
v_mfma_f32_16x16x32_bf16 v[92:95], a[136:139], a[56:59], v[92:95]
s_add_u32 s24, s24, 128
ds_read_b128 a[84:87], v3 offset:36864
v_mfma_f32_16x16x32_bf16 v[92:95], a[140:143], a[60:63], v[92:95]
s_waitcnt lgkmcnt(3)
v_mfma_f32_16x16x32_bf16 v[96:99], a[128:131], a[0:3], v[96:99]
s_add_u32 m0, s28, 4096
ds_read_b64_tr_b16 a[136:137], v7 offset:0
v_mfma_f32_16x16x32_bf16 v[96:99], a[132:135], a[4:7], v[96:99]
buffer_load_dwordx4 v12, s[8:11], s25 offen offset:0 lds
v_mfma_f32_16x16x32_bf16 v[104:107], a[128:131], a[8:11], v[104:107]
ds_read_b64_tr_b16 a[138:139], v7 offset:2048
v_mfma_f32_16x16x32_bf16 v[104:107], a[132:135], a[12:15], v[104:107]
v_mfma_f32_16x16x32_bf16 v[112:115], a[128:131], a[16:19], v[112:115]
ds_read_b64_tr_b16 a[140:141], v7 offset:16384
v_mfma_f32_16x16x32_bf16 v[112:115], a[132:135], a[20:23], v[112:115]
buffer_load_dwordx4 v13, s[8:11], s25 offen offset:1024 lds
v_mfma_f32_16x16x32_bf16 v[120:123], a[128:131], a[24:27], v[120:123]
ds_read_b64_tr_b16 a[142:143], v7 offset:18432
v_mfma_f32_16x16x32_bf16 v[120:123], a[132:135], a[28:31], v[120:123]
v_mfma_f32_16x16x32_bf16 v[128:131], a[128:131], a[32:35], v[128:131]
v_mfma_f32_16x16x32_bf16 v[128:131], a[132:135], a[36:39], v[128:131]
buffer_load_dwordx4 v14, s[8:11], s25 offen offset:2048 lds
v_mfma_f32_16x16x32_bf16 v[136:139], a[128:131], a[40:43], v[136:139]
ds_read_b128 a[88:91], v2 offset:38912
v_mfma_f32_16x16x32_bf16 v[136:139], a[132:135], a[44:47], v[136:139]
v_mfma_f32_16x16x32_bf16 v[144:147], a[128:131], a[48:51], v[144:147]
ds_read_b128 a[92:95], v3 offset:38912
v_mfma_f32_16x16x32_bf16 v[144:147], a[132:135], a[52:55], v[144:147]
buffer_load_dwordx4 v15, s[8:11], s25 offen offset:3072 lds
v_mfma_f32_16x16x32_bf16 v[152:155], a[128:131], a[56:59], v[152:155]
s_add_u32 s25, s25, 128
v_mfma_f32_16x16x32_bf16 v[152:155], a[132:135], a[60:63], v[152:155]
s_waitcnt lgkmcnt(2)
v_mfma_f32_16x16x32_bf16 v[100:103], a[136:139], a[0:3], v[100:103]
ds_read_b64_tr_b16 a[128:129], v8 offset:0
v_mfma_f32_16x16x32_bf16 v[100:103], a[140:143], a[4:7], v[100:103]
buffer_load_dword v21, v20, s[16:19], s43 offen
v_mfma_f32_16x16x32_bf16 v[108:111], a[136:139], a[8:11], v[108:111]
s_add_u32 s43, s43, s47
ds_read_b64_tr_b16 a[130:131], v8 offset:2048
v_mfma_f32_16x16x32_bf16 v[108:111], a[140:143], a[12:15], v[108:111]
s_cmp_ge_u32 s43, s51
v_mfma_f32_16x16x32_bf16 v[116:119], a[136:139], a[16:19], v[116:119]
s_cselect_b32 s43, 0, s43
ds_read_b64_tr_b16 a[132:133], v8 offset:16384
v_mfma_f32_16x16x32_bf16 v[116:119], a[140:143], a[20:23], v[116:119]
s_cselect_b32 s51, s42, s51
v_mfma_f32_16x16x32_bf16 v[124:127], a[136:139], a[24:27], v[124:127]
s_cselect_b64 s[16:17], s[40:41], s[16:17]
ds_read_b64_tr_b16 a[134:135], v8 offset:18432
v_mfma_f32_16x16x32_bf16 v[124:127], a[140:143], a[28:31], v[124:127]
s_cselect_b32 s18, s42, s18
v_mfma_f32_16x16x32_bf16 v[132:135], a[136:139], a[32:35], v[132:135]
s_cselect_b64 s[40:41], s[44:45], s[40:41]
ds_read_b128 a[96:99], v2 offset:40960
v_mfma_f32_16x16x32_bf16 v[132:135], a[140:143], a[36:39], v[132:135]
s_cselect_b32 s42, s46, s42
v_mfma_f32_16x16x32_bf16 v[140:143], a[136:139], a[40:43], v[140:143]
s_cselect_b32 s46, 0, s46
v_mfma_f32_16x16x32_bf16 v[140:143], a[140:143], a[44:47], v[140:143]
s_cmp_eq_u32 s30, s55
v_mfma_f32_16x16x32_bf16 v[148:151], a[136:139], a[48:51], v[148:151]
s_cselect_b32 s22, 0, 3221225472
ds_read_b128 a[100:103], v3 offset:40960
v_mfma_f32_16x16x32_bf16 v[148:151], a[140:143], a[52:55], v[148:151]
s_sub_u32 s30, s30, 1
buffer_atomic_add v27, v26, s[60:63], s22 offen sc1
v_mfma_f32_16x16x32_bf16 v[156:159], a[136:139], a[56:59], v[156:159]
ds_read_b128 a[104:107], v2 offset:43008
v_mfma_f32_16x16x32_bf16 v[156:159], a[140:143], a[60:63], v[156:159]
s_waitcnt lgkmcnt(3)
v_mfma_f32_16x16x32_bf16 v[160:163], a[128:131], a[0:3], v[160:163]
ds_read_b64_tr_b16 a[136:137], v9 offset:0
v_mfma_f32_16x16x32_bf16 v[160:163], a[132:135], a[4:7], v[160:163]
v_mfma_f32_16x16x32_bf16 v[168:171], a[128:131], a[8:11], v[168:171]
ds_read_b64_tr_b16 a[138:139], v9 offset:2048
v_mfma_f32_16x16x32_bf16 v[168:171], a[132:135], a[12:15], v[168:171]
v_mfma_f32_16x16x32_bf16 v[176:179], a[128:131], a[16:19], v[176:179]
ds_read_b64_tr_b16 a[140:141], v9 offset:16384
v_mfma_f32_16x16x32_bf16 v[176:179], a[132:135], a[20:23], v[176:179]
v_mfma_f32_16x16x32_bf16 v[184:187], a[128:131], a[24:27], v[184:187]
ds_read_b64_tr_b16 a[142:143], v9 offset:18432
v_mfma_f32_16x16x32_bf16 v[184:187], a[132:135], a[28:31], v[184:187]
v_mfma_f32_16x16x32_bf16 v[192:195], a[128:131], a[32:35], v[192:195]
v_mfma_f32_16x16x32_bf16 v[192:195], a[132:135], a[36:39], v[192:195]
v_mfma_f32_16x16x32_bf16 v[200:203], a[128:131], a[40:43], v[200:203]
ds_read_b128 a[108:111], v3 offset:43008
v_mfma_f32_16x16x32_bf16 v[200:203], a[132:135], a[44:47], v[200:203]
v_mfma_f32_16x16x32_bf16 v[208:211], a[128:131], a[48:51], v[208:211]
ds_read_b128 a[112:115], v2 offset:45056
v_mfma_f32_16x16x32_bf16 v[208:211], a[132:135], a[52:55], v[208:211]
v_mfma_f32_16x16x32_bf16 v[216:219], a[128:131], a[56:59], v[216:219]
v_mfma_f32_16x16x32_bf16 v[216:219], a[132:135], a[60:63], v[216:219]
s_waitcnt lgkmcnt(2)
v_mfma_f32_16x16x32_bf16 v[164:167], a[136:139], a[0:3], v[164:167]
ds_read_b64_tr_b16 a[128:129], v10 offset:0
v_mfma_f32_16x16x32_bf16 v[164:167], a[140:143], a[4:7], v[164:167]
v_mfma_f32_16x16x32_bf16 v[172:175], a[136:139], a[8:11], v[172:175]
ds_read_b64_tr_b16 a[130:131], v10 offset:2048
v_mfma_f32_16x16x32_bf16 v[172:175], a[140:143], a[12:15], v[172:175]
v_mfma_f32_16x16x32_bf16 v[180:183], a[136:139], a[16:19], v[180:183]
ds_read_b64_tr_b16 a[132:133], v10 offset:16384
v_mfma_f32_16x16x32_bf16 v[180:183], a[140:143], a[20:23], v[180:183]
v_mfma_f32_16x16x32_bf16 v[188:191], a[136:139], a[24:27], v[188:191]
ds_read_b64_tr_b16 a[134:135], v10 offset:18432
v_mfma_f32_16x16x32_bf16 v[188:191], a[140:143], a[28:31], v[188:191]
v_mfma_f32_16x16x32_bf16 v[196:199], a[136:139], a[32:35], v[196:199]
ds_read_b128 a[116:119], v3 offset:45056
v_mfma_f32_16x16x32_bf16 v[196:199], a[140:143], a[36:39], v[196:199]
v_mfma_f32_16x16x32_bf16 v[204:207], a[136:139], a[40:43], v[204:207]
ds_read_b128 a[120:123], v2 offset:47104
v_mfma_f32_16x16x32_bf16 v[204:207], a[140:143], a[44:47], v[204:207]
v_mfma_f32_16x16x32_bf16 v[212:215], a[136:139], a[48:51], v[212:215]
v_mfma_f32_16x16x32_bf16 v[212:215], a[140:143], a[52:55], v[212:215]
v_mfma_f32_16x16x32_bf16 v[220:223], a[136:139], a[56:59], v[220:223]
ds_read_b128 a[124:127], v3 offset:47104
v_mfma_f32_16x16x32_bf16 v[220:223], a[140:143], a[60:63], v[220:223]
s_waitcnt lgkmcnt(3)
v_mfma_f32_16x16x32_bf16 a[192:195], a[128:131], a[0:3], a[192:195]
ds_read_b64_tr_b16 a[136:137], v11 offset:0
v_mfma_f32_16x16x32_bf16 a[192:195], a[132:135], a[4:7], a[192:195]
v_mfma_f32_16x16x32_bf16 a[200:203], a[128:131], a[8:11], a[200:203]
ds_read_b64_tr_b16 a[138:139], v11 offset:2048
v_mfma_f32_16x16x32_bf16 a[200:203], a[132:135], a[12:15], a[200:203]
v_mfma_f32_16x16x32_bf16 a[208:211], a[128:131], a[16:19], a[208:211]
ds_read_b64_tr_b16 a[140:141], v11 offset:16384
v_mfma_f32_16x16x32_bf16 a[208:211], a[132:135], a[20:23], a[208:211]
v_mfma_f32_16x16x32_bf16 a[216:219], a[128:131], a[24:27], a[216:219]
ds_read_b64_tr_b16 a[142:143], v11 offset:18432
v_mfma_f32_16x16x32_bf16 a[216:219], a[132:135], a[28:31], a[216:219]
v_mfma_f32_16x16x32_bf16 a[224:227], a[128:131], a[32:35], a[224:227]
v_mfma_f32_16x16x32_bf16 a[224:227], a[132:135], a[36:39], a[224:227]
v_mfma_f32_16x16x32_bf16 a[232:235], a[128:131], a[40:43], a[232:235]
v_mfma_f32_16x16x32_bf16 a[232:235], a[132:135], a[44:47], a[232:235]
v_mfma_f32_16x16x32_bf16 a[240:243], a[128:131], a[48:51], a[240:243]
v_mfma_f32_16x16x32_bf16 a[240:243], a[132:135], a[52:55], a[240:243]
v_mfma_f32_16x16x32_bf16 a[248:251], a[128:131], a[56:59], a[248:251]
s_waitcnt vmcnt(2) lgkmcnt(0)
v_mfma_f32_16x16x32_bf16 a[248:251], a[132:135], a[60:63], a[248:251]
s_barrier
v_mfma_f32_16x16x32_bf16 a[196:199], a[136:139], a[0:3], a[196:199]
s_add_u32 m0, s29, 65536
ds_read_b64_tr_b16 a[128:129], v4 offset:32768
v_mfma_f32_16x16x32_bf16 a[196:199], a[140:143], a[4:7], a[196:199]
buffer_load_dwordx4 v16, s[12:15], s26 offen offset:0 lds
v_mfma_f32_16x16x32_bf16 a[204:207], a[136:139], a[8:11], a[204:207]
ds_read_b64_tr_b16 a[130:131], v4 offset:34816
v_mfma_f32_16x16x32_bf16 a[204:207], a[140:143], a[12:15], a[204:207]
v_mfma_f32_16x16x32_bf16 a[212:215], a[136:139], a[16:19], a[212:215]
ds_read_b64_tr_b16 a[132:133], v4 offset:49152
v_mfma_f32_16x16x32_bf16 a[212:215], a[140:143], a[20:23], a[212:215]
buffer_load_dwordx4 v17, s[12:15], s26 offen offset:1024 lds
v_mfma_f32_16x16x32_bf16 a[220:223], a[136:139], a[24:27], a[220:223]
ds_read_b64_tr_b16 a[134:135], v4 offset:51200
v_mfma_f32_16x16x32_bf16 a[220:223], a[140:143], a[28:31], a[220:223]
v_mfma_f32_16x16x32_bf16 a[228:231], a[136:139], a[32:35], a[228:231]
v_mfma_f32_16x16x32_bf16 a[228:231], a[140:143], a[36:39], a[228:231]
buffer_load_dwordx4 v18, s[12:15], s26 offen offset:2048 lds
v_mfma_f32_16x16x32_bf16 a[236:239], a[136:139], a[40:43], a[236:239]
v_mfma_f32_16x16x32_bf16 a[236:239], a[140:143], a[44:47], a[236:239]
v_mfma_f32_16x16x32_bf16 a[244:247], a[136:139], a[48:51], a[244:247]
v_mfma_f32_16x16x32_bf16 a[244:247], a[140:143], a[52:55], a[244:247]
s_waitcnt lgkmcnt(0)
buffer_load_dwordx4 v19, s[12:15], s26 offen offset:3072 lds
v_mfma_f32_16x16x32_bf16 a[252:255], a[136:139], a[56:59], a[252:255]
s_add_u32 s26, s26, 524288
s_bitcmp1_b32 s30, 1
v_mfma_f32_16x16x32_bf16 a[252:255], a[140:143], a[60:63], a[252:255]
s_cbranch_scc1 Lg_1
s_cmp_eq_u32 s30, 0
s_cbranch_scc1 Lg_1t
v_mfma_f32_16x16x32_bf16 v[32:35], a[128:131], a[64:67], v[32:35]
s_add_u32 m0, s29, 81920
ds_read_b64_tr_b16 a[136:137], v5 offset:32768
v_mfma_f32_16x16x32_bf16 v[32:35], a[132:135], a[68:71], v[32:35]
buffer_load_dwordx4 v16, s[12:15], s27 offen offset:0 lds
v_mfma_f32_16x16x32_bf16 v[40:43], a[128:131], a[72:75], v[40:43]
s_lshl_b32 s22, s38, 3
ds_read_b64_tr_b16 a[138:139], v5 offset:34816
v_mfma_f32_16x16x32_bf16 v[40:43], a[132:135], a[76:79], v[40:43]
s_lshl_b32 s23, s39, 5
v_and_b32 v252, 31, v0
v_lshrrev_b32 v253, 5, v0
v_mfma_f32_16x16x32_bf16 v[48:51], a[128:131], a[80:83], v[48:51]
ds_read_b64_tr_b16 a[140:141], v5 offset:49152
v_add_u32 v253, s22, v253
v_mfma_f32_16x16x32_bf16 v[48:51], a[132:135], a[84:87], v[48:51]
buffer_load_dwordx4 v17, s[12:15], s27 offen offset:1024 lds
v_mfma_f32_16x16x32_bf16 v[56:59], a[128:131], a[88:91], v[56:59]
ds_read_b64_tr_b16 a[142:143], v5 offset:51200
v_add_u32 v252, s23, v252
v_mfma_f32_16x16x32_bf16 v[56:59], a[132:135], a[92:95], v[56:59]
v_mul_u32_u24 v254, 7168, v253
v_lshl_add_u32 v254, v252, 2, v254
v_mfma_f32_16x16x32_bf16 v[64:67], a[128:131], a[96:99], v[64:67]
ds_read_b128 a[0:3], v2 offset:0
v_lshlrev_b32 v252, 4, v252
v_mfma_f32_16x16x32_bf16 v[64:67], a[132:135], a[100:103], v[64:67]
buffer_load_dwordx4 v18, s[12:15], s27 offen offset:2048 lds
v_mfma_f32_16x16x32_bf16 v[72:75], a[128:131], a[104:107], v[72:75]
ds_read_b128 a[4:7], v3 offset:0
v_add_u32 v255, 3584, v254
v_mfma_f32_16x16x32_bf16 v[72:75], a[132:135], a[108:111], v[72:75]
v_subrev_u32 v22, 3584, v254
v_subrev_u32 v23, 2688, v254
v_mfma_f32_16x16x32_bf16 v[80:83], a[128:131], a[112:115], v[80:83]
v_subrev_u32 v24, 1792, v254
v_subrev_u32 v25, 896, v254
v_mfma_f32_16x16x32_bf16 v[80:83], a[132:135], a[116:119], v[80:83]
buffer_load_dwordx4 v19, s[12:15], s27 offen offset:3072 lds
v_mfma_f32_16x16x32_bf16 v[88:91], a[128:131], a[120:123], v[88:91]
s_add_u32 s27, s27, 524288
ds_read_b128 a[8:11], v2 offset:2048
v_mfma_f32_16x16x32_bf16 v[88:91], a[132:135], a[124:127], v[88:91]
s_waitcnt lgkmcnt(3)
v_mfma_f32_16x16x32_bf16 v[36:39], a[136:139], a[64:67], v[36:39]
s_add_u32 m0, s28, 32768
ds_read_b64_tr_b16 a[128:129], v6 offset:32768
v_mfma_f32_16x16x32_bf16 v[36:39], a[140:143], a[68:71], v[36:39]
buffer_load_dwordx4 v12, s[8:11], s24 offen offset:0 lds
v_mfma_f32_16x16x32_bf16 v[44:47], a[136:139], a[72:75], v[44:47]
ds_read_b64_tr_b16 a[130:131], v6 offset:34816
v_mfma_f32_16x16x32_bf16 v[44:47], a[140:143], a[76:79], v[44:47]
v_mfma_f32_16x16x32_bf16 v[52:55], a[136:139], a[80:83], v[52:55]
ds_read_b64_tr_b16 a[132:133], v6 offset:49152
v_mfma_f32_16x16x32_bf16 v[52:55], a[140:143], a[84:87], v[52:55]
buffer_load_dwordx4 v13, s[8:11], s24 offen offset:1024 lds
v_mfma_f32_16x16x32_bf16 v[60:63], a[136:139], a[88:91], v[60:63]
ds_read_b64_tr_b16 a[134:135], v6 offset:51200
v_mfma_f32_16x16x32_bf16 v[60:63], a[140:143], a[92:95], v[60:63]
v_mfma_f32_16x16x32_bf16 v[68:71], a[136:139], a[96:99], v[68:71]
ds_read_b128 a[12:15], v3 offset:2048
v_mfma_f32_16x16x32_bf16 v[68:71], a[140:143], a[100:103], v[68:71]
buffer_load_dwordx4 v14, s[8:11], s24 offen offset:2048 lds
v_mfma_f32_16x16x32_bf16 v[76:79], a[136:139], a[104:107], v[76:79]
v_mfma_f32_16x16x32_bf16 v[76:79], a[140:143], a[108:111], v[76:79]
v_mfma_f32_16x16x32_bf16 v[84:87], a[136:139], a[112:115], v[84:87]
ds_read_b128 a[16:19], v2 offset:4096
v_mfma_f32_16x16x32_bf16 v[84:87], a[140:143], a[116:119], v[84:87]
buffer_load_dwordx4 v15, s[8:11], s24 offen offset:3072 lds
v_mfma_f32_16x16x32_bf16 v[92:95], a[136:139], a[120:123], v[92:95]
s_add_u32 s24, s24, 128
ds_read_b128 a[20:23], v3 offset:4096
v_mfma_f32_16x16x32_bf16 v[92:95], a[140:143], a[124:127], v[92:95]
s_waitcnt lgkmcnt(3)
v_mfma_f32_16x16x32_bf16 v[96:99], a[128:131], a[64:67], v[96:99]
s_add_u32 m0, s28, 36864
ds_read_b64_tr_b16 a[136:137], v7 offset:32768
v_mfma_f32_16x16x32_bf16 v[96:99], a[132:135], a[68:71], v[96:99]
buffer_load_dwordx4 v12, s[8:11], s25 offen offset:0 lds
v_mfma_f32_16x16x32_bf16 v[104:107], a[128:131], a[72:75], v[104:107]
ds_read_b64_tr_b16 a[138:139], v7 offset:34816
v_mfma_f32_16x16x32_bf16 v[104:107], a[132:135], a[76:79], v[104:107]
v_mfma_f32_16x16x32_bf16 v[112:115], a[128:131], a[80:83], v[112:115]
ds_read_b64_tr_b16 a[140:141], v7 offset:49152
v_mfma_f32_16x16x32_bf16 v[112:115], a[132:135], a[84:87], v[112:115]
buffer_load_dwordx4 v13, s[8:11], s25 offen offset:1024 lds
v_mfma_f32_16x16x32_bf16 v[120:123], a[128:131], a[88:91], v[120:123]
ds_read_b64_tr_b16 a[142:143], v7 offset:51200
v_mfma_f32_16x16x32_bf16 v[120:123], a[132:135], a[92:95], v[120:123]
v_mfma_f32_16x16x32_bf16 v[128:131], a[128:131], a[96:99], v[128:131]
v_mfma_f32_16x16x32_bf16 v[128:131], a[132:135], a[100:103], v[128:131]
buffer_load_dwordx4 v14, s[8:11], s25 offen offset:2048 lds
v_mfma_f32_16x16x32_bf16 v[136:139], a[128:131], a[104:107], v[136:139]
ds_read_b128 a[24:27], v2 offset:6144
v_mfma_f32_16x16x32_bf16 v[136:139], a[132:135], a[108:111], v[136:139]
v_mfma_f32_16x16x32_bf16 v[144:147], a[128:131], a[112:115], v[144:147]
ds_read_b128 a[28:31], v3 offset:6144
v_mfma_f32_16x16x32_bf16 v[144:147], a[132:135], a[116:119], v[144:147]
buffer_load_dwordx4 v15, s[8:11], s25 offen offset:3072 lds
v_mfma_f32_16x16x32_bf16 v[152:155], a[128:131], a[120:123], v[152:155]
s_add_u32 s25, s25, 128
v_mfma_f32_16x16x32_bf16 v[152:155], a[132:135], a[124:127], v[152:155]
s_waitcnt lgkmcnt(2)
v_mfma_f32_16x16x32_bf16 v[100:103], a[136:139], a[64:67], v[100:103]
s_mov_b64 s[56:57], s[70:71]
s_mov_b32 s58, 3584
s_mov_b32 s59, 0x20000
ds_read_b64_tr_b16 a[128:129], v8 offset:32768
buffer_load_dwordx4 v[248:251], v252, s[56:59], 0 offen
v_mfma_f32_16x16x32_bf16 v[100:103], a[140:143], a[68:71], v[100:103]
s_mov_b64 s[56:57], s[66:67]
s_mov_b32 s58, 1835008
buffer_load_dword v224, v22, s[56:59], 0 offen nt
v_mfma_f32_16x16x32_bf16 v[108:111], a[136:139], a[72:75], v[108:111]
ds_read_b64_tr_b16 a[130:131], v8 offset:34816
buffer_load_dword v225, v23, s[56:59], 0 offen nt
v_mfma_f32_16x16x32_bf16 v[108:111], a[140:143], a[76:79], v[108:111]
buffer_load_dword v226, v24, s[56:59], 0 offen nt
v_mfma_f32_16x16x32_bf16 v[116:119], a[136:139], a[80:83], v[116:119]
ds_read_b64_tr_b16 a[132:133], v8 offset:49152
buffer_load_dword v227, v25, s[56:59], 0 offen nt
v_mfma_f32_16x16x32_bf16 v[116:119], a[140:143], a[84:87], v[116:119]
buffer_load_dword v228, v254, s[56:59], 0 offen offset:0 nt
v_mfma_f32_16x16x32_bf16 v[124:127], a[136:139], a[88:91], v[124:127]
ds_read_b64_tr_b16 a[134:135], v8 offset:51200
buffer_load_dword v229, v254, s[56:59], 0 offen offset:896 nt
v_mfma_f32_16x16x32_bf16 v[124:127], a[140:143], a[92:95], v[124:127]
buffer_load_dword v230, v254, s[56:59], 0 offen offset:1792 nt
v_mfma_f32_16x16x32_bf16 v[132:135], a[136:139], a[96:99], v[132:135]
ds_read_b128 a[32:35], v2 offset:8192
buffer_load_dword v231, v254, s[56:59], 0 offen offset:2688 nt
v_mfma_f32_16x16x32_bf16 v[132:135], a[140:143], a[100:103], v[132:135]
buffer_load_dword v232, v255, s[56:59], 0 offen offset:0 nt
v_mfma_f32_16x16x32_bf16 v[140:143], a[136:139], a[104:107], v[140:143]
buffer_load_dword v233, v255, s[56:59], 0 offen offset:896 nt
v_mfma_f32_16x16x32_bf16 v[140:143], a[140:143], a[108:111], v[140:143]
buffer_load_dword v234, v255, s[56:59], 0 offen offset:1792 nt
v_mfma_f32_16x16x32_bf16 v[148:151], a[136:139], a[112:115], v[148:151]
ds_read_b128 a[36:39], v3 offset:8192
buffer_load_dword v235, v255, s[56:59], 0 offen offset:2688 nt
v_mfma_f32_16x16x32_bf16 v[148:151], a[140:143], a[116:119], v[148:151]
s_mov_b64 s[56:57], s[68:69]
buffer_load_dword v236, v25, s[56:59], 0 offen nt
v_mfma_f32_16x16x32_bf16 v[156:159], a[136:139], a[120:123], v[156:159]
ds_read_b128 a[40:43], v2 offset:10240
buffer_load_dword v237, v254, s[56:59], 0 offen offset:0 nt
v_mfma_f32_16x16x32_bf16 v[156:159], a[140:143], a[124:127], v[156:159]
s_waitcnt lgkmcnt(3)
buffer_load_dword v238, v254, s[56:59], 0 offen offset:896 nt
v_mfma_f32_16x16x32_bf16 v[160:163], a[128:131], a[64:67], v[160:163]
ds_read_b64_tr_b16 a[136:137], v9 offset:32768
buffer_load_dword v239, v254, s[56:59], 0 offen offset:1792 nt
v_mfma_f32_16x16x32_bf16 v[160:163], a[132:135], a[68:71], v[160:163]
buffer_load_dword v240, v254, s[56:59], 0 offen offset:2688 nt
v_mfma_f32_16x16x32_bf16 v[168:171], a[128:131], a[72:75], v[168:171]
ds_read_b64_tr_b16 a[138:139], v9 offset:34816
buffer_load_dword v241, v255, s[56:59], 0 offen offset:0 nt
v_mfma_f32_16x16x32_bf16 v[168:171], a[132:135], a[76:79], v[168:171]
buffer_load_dword v242, v255, s[56:59], 0 offen offset:896 nt
v_mfma_f32_16x16x32_bf16 v[176:179], a[128:131], a[80:83], v[176:179]
ds_read_b64_tr_b16 a[140:141], v9 offset:49152
buffer_load_dword v243, v255, s[56:59], 0 offen offset:1792 nt
v_mfma_f32_16x16x32_bf16 v[176:179], a[132:135], a[84:87], v[176:179]
buffer_load_dword v244, v255, s[56:59], 0 offen offset:2688 nt
v_mfma_f32_16x16x32_bf16 v[184:187], a[128:131], a[88:91], v[184:187]
ds_read_b64_tr_b16 a[142:143], v9 offset:51200
v_mfma_f32_16x16x32_bf16 v[184:187], a[132:135], a[92:95], v[184:187]
v_mfma_f32_16x16x32_bf16 v[192:195], a[128:131], a[96:99], v[192:195]
v_mfma_f32_16x16x32_bf16 v[192:195], a[132:135], a[100:103], v[192:195]
v_mfma_f32_16x16x32_bf16 v[200:203], a[128:131], a[104:107], v[200:203]
ds_read_b128 a[44:47], v3 offset:10240
v_mfma_f32_16x16x32_bf16 v[200:203], a[132:135], a[108:111], v[200:203]
v_mfma_f32_16x16x32_bf16 v[208:211], a[128:131], a[112:115], v[208:211]
ds_read_b128 a[48:51], v2 offset:12288
v_mfma_f32_16x16x32_bf16 v[208:211], a[132:135], a[116:119], v[208:211]
v_mfma_f32_16x16x32_bf16 v[216:219], a[128:131], a[120:123], v[216:219]
v_mfma_f32_16x16x32_bf16 v[216:219], a[132:135], a[124:127], v[216:219]
s_waitcnt lgkmcnt(2)
v_mfma_f32_16x16x32_bf16 v[164:167], a[136:139], a[64:67], v[164:167]
ds_read_b64_tr_b16 a[128:129], v10 offset:32768
v_mfma_f32_16x16x32_bf16 v[164:167], a[140:143], a[68:71], v[164:167]
v_mfma_f32_16x16x32_bf16 v[172:175], a[136:139], a[72:75], v[172:175]
ds_read_b64_tr_b16 a[130:131], v10 offset:34816
v_mfma_f32_16x16x32_bf16 v[172:175], a[140:143], a[76:79], v[172:175]
v_mfma_f32_16x16x32_bf16 v[180:183], a[136:139], a[80:83], v[180:183]
ds_read_b64_tr_b16 a[132:133], v10 offset:49152
v_mfma_f32_16x16x32_bf16 v[180:183], a[140:143], a[84:87], v[180:183]
v_mfma_f32_16x16x32_bf16 v[188:191], a[136:139], a[88:91], v[188:191]
ds_read_b64_tr_b16 a[134:135], v10 offset:51200
v_mfma_f32_16x16x32_bf16 v[188:191], a[140:143], a[92:95], v[188:191]
v_mfma_f32_16x16x32_bf16 v[196:199], a[136:139], a[96:99], v[196:199]
ds_read_b128 a[52:55], v3 offset:12288
v_mfma_f32_16x16x32_bf16 v[196:199], a[140:143], a[100:103], v[196:199]
v_mfma_f32_16x16x32_bf16 v[204:207], a[136:139], a[104:107], v[204:207]
ds_read_b128 a[56:59], v2 offset:14336
v_mfma_f32_16x16x32_bf16 v[204:207], a[140:143], a[108:111], v[204:207]
v_mfma_f32_16x16x32_bf16 v[212:215], a[136:139], a[112:115], v[212:215]
v_mfma_f32_16x16x32_bf16 v[212:215], a[140:143], a[116:119], v[212:215]
v_mfma_f32_16x16x32_bf16 v[220:223], a[136:139], a[120:123], v[220:223]
ds_read_b128 a[60:63], v3 offset:14336
v_mfma_f32_16x16x32_bf16 v[220:223], a[140:143], a[124:127], v[220:223]
s_waitcnt lgkmcnt(3)
v_mfma_f32_16x16x32_bf16 a[192:195], a[128:131], a[64:67], a[192:195]
ds_read_b64_tr_b16 a[136:137], v11 offset:32768
v_mfma_f32_16x16x32_bf16 a[192:195], a[132:135], a[68:71], a[192:195]
v_mfma_f32_16x16x32_bf16 a[200:203], a[128:131], a[72:75], a[200:203]
ds_read_b64_tr_b16 a[138:139], v11 offset:34816
v_mfma_f32_16x16x32_bf16 a[200:203], a[132:135], a[76:79], a[200:203]
v_mfma_f32_16x16x32_bf16 a[208:211], a[128:131], a[80:83], a[208:211]
ds_read_b64_tr_b16 a[140:141], v11 offset:49152
v_mfma_f32_16x16x32_bf16 a[208:211], a[132:135], a[84:87], a[208:211]
v_mfma_f32_16x16x32_bf16 a[216:219], a[128:131], a[88:91], a[216:219]
ds_read_b64_tr_b16 a[142:143], v11 offset:51200
v_mfma_f32_16x16x32_bf16 a[216:219], a[132:135], a[92:95], a[216:219]
v_mfma_f32_16x16x32_bf16 a[224:227], a[128:131], a[96:99], a[224:227]
v_mfma_f32_16x16x32_bf16 a[224:227], a[132:135], a[100:103], a[224:227]
v_mfma_f32_16x16x32_bf16 a[232:235], a[128:131], a[104:107], a[232:235]
v_mfma_f32_16x16x32_bf16 a[232:235], a[132:135], a[108:111], a[232:235]
v_mfma_f32_16x16x32_bf16 a[240:243], a[128:131], a[112:115], a[240:243]
v_mfma_f32_16x16x32_bf16 a[240:243], a[132:135], a[116:119], a[240:243]
v_mfma_f32_16x16x32_bf16 a[248:251], a[128:131], a[120:123], a[248:251]
s_waitcnt vmcnt(22) lgkmcnt(0)
v_mfma_f32_16x16x32_bf16 a[248:251], a[132:135], a[124:127], a[248:251]
s_barrier
v_mfma_f32_16x16x32_bf16 a[196:199], a[136:139], a[64:67], a[196:199]
s_add_u32 m0, s29, 98304
ds_read_b64_tr_b16 a[128:129], v4 offset:0
v_mfma_f32_16x16x32_bf16 a[196:199], a[140:143], a[68:71], a[196:199]
buffer_load_dwordx4 v16, s[12:15], s26 offen offset:0 lds
v_mfma_f32_16x16x32_bf16 a[204:207], a[136:139], a[72:75], a[204:207]
ds_read_b64_tr_b16 a[130:131], v4 offset:2048
v_mfma_f32_16x16x32_bf16 a[204:207], a[140:143], a[76:79], a[204:207]
v_mfma_f32_16x16x32_bf16 a[212:215], a[136:139], a[80:83], a[212:215]
ds_read_b64_tr_b16 a[132:133], v4 offset:16384
v_mfma_f32_16x16x32_bf16 a[212:215], a[140:143], a[84:87], a[212:215]
buffer_load_dwordx4 v17, s[12:15], s26 offen offset:1024 lds
v_mfma_f32_16x16x32_bf16 a[220:223], a[136:139], a[88:91], a[220:223]
ds_read_b64_tr_b16 a[134:135], v4 offset:18432
v_mfma_f32_16x16x32_bf16 a[220:223], a[140:143], a[92:95], a[220:223]
v_mfma_f32_16x16x32_bf16 a[228:231], a[136:139], a[96:99], a[228:231]
v_mfma_f32_16x16x32_bf16 a[228:231], a[140:143], a[100:103], a[228:231]
buffer_load_dwordx4 v18, s[12:15], s26 offen offset:2048 lds
v_mfma_f32_16x16x32_bf16 a[236:239], a[136:139], a[104:107], a[236:239]
v_mfma_f32_16x16x32_bf16 a[236:239], a[140:143], a[108:111], a[236:239]
v_mfma_f32_16x16x32_bf16 a[244:247], a[136:139], a[112:115], a[244:247]
v_mfma_f32_16x16x32_bf16 a[244:247], a[140:143], a[116:119], a[244:247]
buffer_load_dwordx4 v19, s[12:15], s26 offen offset:3072 lds
v_mfma_f32_16x16x32_bf16 a[252:255], a[136:139], a[120:123], a[252:255]
s_add_u32 s26, s26, 524288
v_mfma_f32_16x16x32_bf16 a[252:255], a[140:143], a[124:127], a[252:255]
s_waitcnt lgkmcnt(0)
v_mfma_f32_16x16x32_bf16 v[32:35], a[128:131], a[0:3], v[32:35]
s_add_u32 m0, s29, 114688
ds_read_b64_tr_b16 a[136:137], v5 offset:0
v_mfma_f32_16x16x32_bf16 v[32:35], a[132:135], a[4:7], v[32:35]
buffer_load_dwordx4 v16, s[12:15], s27 offen offset:0 lds
v_mfma_f32_16x16x32_bf16 v[40:43], a[128:131], a[8:11], v[40:43]
ds_read_b64_tr_b16 a[138:139], v5 offset:2048
v_mfma_f32_16x16x32_bf16 v[40:43], a[132:135], a[12:15], v[40:43]
v_mfma_f32_16x16x32_bf16 v[48:51], a[128:131], a[16:19], v[48:51]
ds_read_b64_tr_b16 a[140:141], v5 offset:16384
v_mfma_f32_16x16x32_bf16 v[48:51], a[132:135], a[20:23], v[48:51]
buffer_load_dwordx4 v17, s[12:15], s27 offen offset:1024 lds
v_mfma_f32_16x16x32_bf16 v[56:59], a[128:131], a[24:27], v[56:59]
ds_read_b64_tr_b16 a[142:143], v5 offset:18432
v_mfma_f32_16x16x32_bf16 v[56:59], a[132:135], a[28:31], v[56:59]
v_mfma_f32_16x16x32_bf16 v[64:67], a[128:131], a[32:35], v[64:67]
ds_read_b128 a[64:67], v2 offset:32768
v_mfma_f32_16x16x32_bf16 v[64:67], a[132:135], a[36:39], v[64:67]
buffer_load_dwordx4 v18, s[12:15], s27 offen offset:2048 lds
v_mfma_f32_16x16x32_bf16 v[72:75], a[128:131], a[40:43], v[72:75]
ds_read_b128 a[68:71], v3 offset:32768
v_mfma_f32_16x16x32_bf16 v[72:75], a[132:135], a[44:47], v[72:75]
v_mfma_f32_16x16x32_bf16 v[80:83], a[128:131], a[48:51], v[80:83]
v_mfma_f32_16x16x32_bf16 v[80:83], a[132:135], a[52:55], v[80:83]
buffer_load_dwordx4 v19, s[12:15], s27 offen offset:3072 lds
v_mfma_f32_16x16x32_bf16 v[88:91], a[128:131], a[56:59], v[88:91]
s_add_u32 s27, s27, 524288
ds_read_b128 a[72:75], v2 offset:34816
v_mfma_f32_16x16x32_bf16 v[88:91], a[132:135], a[60:63], v[88:91]
s_waitcnt lgkmcnt(3)
v_mfma_f32_16x16x32_bf16 v[36:39], a[136:139], a[0:3], v[36:39]
s_add_u32 m0, s28, 0
ds_read_b64_tr_b16 a[128:129], v6 offset:0
v_mfma_f32_16x16x32_bf16 v[36:39], a[140:143], a[4:7], v[36:39]
buffer_load_dwordx4 v12, s[8:11], s24 offen offset:0 lds
v_mfma_f32_16x16x32_bf16 v[44:47], a[136:139], a[8:11], v[44:47]
ds_read_b64_tr_b16 a[130:131], v6 offset:2048
v_mfma_f32_16x16x32_bf16 v[44:47], a[140:143], a[12:15], v[44:47]
v_mfma_f32_16x16x32_bf16 v[52:55], a[136:139], a[16:19], v[52:55]
ds_read_b64_tr_b16 a[132:133], v6 offset:16384
v_mfma_f32_16x16x32_bf16 v[52:55], a[140:143], a[20:23], v[52:55]
buffer_load_dwordx4 v13, s[8:11], s24 offen offset:1024 lds
v_mfma_f32_16x16x32_bf16 v[60:63], a[136:139], a[24:27], v[60:63]
ds_read_b64_tr_b16 a[134:135], v6 offset:18432
v_mfma_f32_16x16x32_bf16 v[60:63], a[140:143], a[28:31], v[60:63]
v_mfma_f32_16x16x32_bf16 v[68:71], a[136:139], a[32:35], v[68:71]
ds_read_b128 a[76:79], v3 offset:34816
v_mfma_f32_16x16x32_bf16 v[68:71], a[140:143], a[36:39], v[68:71]
buffer_load_dwordx4 v14, s[8:11], s24 offen offset:2048 lds
v_mfma_f32_16x16x32_bf16 v[76:79], a[136:139], a[40:43], v[76:79]
v_mfma_f32_16x16x32_bf16 v[76:79], a[140:143], a[44:47], v[76:79]
v_mfma_f32_16x16x32_bf16 v[84:87], a[136:139], a[48:51], v[84:87]
ds_read_b128 a[80:83], v2 offset:36864
v_mfma_f32_16x16x32_bf16 v[84:87], a[140:143], a[52:55], v[84:87]
buffer_load_dwordx4 v15, s[8:11], s24 offen offset:3072 lds
v_mfma_f32_16x16x32_bf16 v[92:95], a[136:139], a[56:59], v[92:95]
s_add_u32 s24, s24, 128
ds_read_b128 a[84:87], v3 offset:36864
v_mfma_f32_16x16x32_bf16 v[92:95], a[140:143], a[60:63], v[92:95]
s_waitcnt lgkmcnt(3)
v_mfma_f32_16x16x32_bf16 v[96:99], a[128:131], a[0:3], v[96:99]
s_add_u32 m0, s28, 4096
ds_read_b64_tr_b16 a[136:137], v7 offset:0
v_mfma_f32_16x16x32_bf16 v[96:99], a[132:135], a[4:7], v[96:99]
buffer_load_dwordx4 v12, s[8:11], s25 offen offset:0 lds
v_mfma_f32_16x16x32_bf16 v[104:107], a[128:131], a[8:11], v[104:107]
ds_read_b64_tr_b16 a[138:139], v7 offset:2048
v_mfma_f32_16x16x32_bf16 v[104:107], a[132:135], a[12:15], v[104:107]
v_mfma_f32_16x16x32_bf16 v[112:115], a[128:131], a[16:19], v[112:115]
ds_read_b64_tr_b16 a[140:141], v7 offset:16384
v_mfma_f32_16x16x32_bf16 v[112:115], a[132:135], a[20:23], v[112:115]
buffer_load_dwordx4 v13, s[8:11], s25 offen offset:1024 lds
v_mfma_f32_16x16x32_bf16 v[120:123], a[128:131], a[24:27], v[120:123]
ds_read_b64_tr_b16 a[142:143], v7 offset:18432
v_mfma_f32_16x16x32_bf16 v[120:123], a[132:135], a[28:31], v[120:123]
v_mfma_f32_16x16x32_bf16 v[128:131], a[128:131], a[32:35], v[128:131]
v_mfma_f32_16x16x32_bf16 v[128:131], a[132:135], a[36:39], v[128:131]
buffer_load_dwordx4 v14, s[8:11], s25 offen offset:2048 lds
v_mfma_f32_16x16x32_bf16 v[136:139], a[128:131], a[40:43], v[136:139]
ds_read_b128 a[88:91], v2 offset:38912
v_mfma_f32_16x16x32_bf16 v[136:139], a[132:135], a[44:47], v[136:139]
v_mfma_f32_16x16x32_bf16 v[144:147], a[128:131], a[48:51], v[144:147]
ds_read_b128 a[92:95], v3 offset:38912
v_mfma_f32_16x16x32_bf16 v[144:147], a[132:135], a[52:55], v[144:147]
buffer_load_dwordx4 v15, s[8:11], s25 offen offset:3072 lds
v_mfma_f32_16x16x32_bf16 v[152:155], a[128:131], a[56:59], v[152:155]
s_add_u32 s25, s25, 128
v_mfma_f32_16x16x32_bf16 v[152:155], a[132:135], a[60:63], v[152:155]
s_waitcnt lgkmcnt(2)
v_mfma_f32_16x16x32_bf16 v[100:103], a[136:139], a[0:3], v[100:103]
ds_read_b64_tr_b16 a[128:129], v8 offset:0
v_mfma_f32_16x16x32_bf16 v[100:103], a[140:143], a[4:7], v[100:103]
buffer_load_dword v21, v20, s[16:19], s43 offen
v_mfma_f32_16x16x32_bf16 v[108:111], a[136:139], a[8:11], v[108:111]
s_add_u32 s43, s43, s47
ds_read_b64_tr_b16 a[130:131], v8 offset:2048
v_mfma_f32_16x16x32_bf16 v[108:111], a[140:143], a[12:15], v[108:111]
PAD_2:
s_cbranch_execz M_tret
s_cmp_ge_u32 s43, s51
v_mfma_f32_16x16x32_bf16 v[116:119], a[136:139], a[16:19], v[116:119]
s_cselect_b32 s43, 0, s43
ds_read_b64_tr_b16 a[132:133], v8 offset:16384
v_mfma_f32_16x16x32_bf16 v[116:119], a[140:143], a[20:23], v[116:119]
s_cselect_b32 s51, s42, s51
v_mfma_f32_16x16x32_bf16 v[124:127], a[136:139], a[24:27], v[124:127]
s_cselect_b64 s[16:17], s[40:41], s[16:17]
ds_read_b64_tr_b16 a[134:135], v8 offset:18432
v_mfma_f32_16x16x32_bf16 v[124:127], a[140:143], a[28:31], v[124:127]
s_cselect_b32 s18, s42, s18
v_mfma_f32_16x16x32_bf16 v[132:135], a[136:139], a[32:35], v[132:135]
s_cselect_b64 s[40:41], s[44:45], s[40:41]
ds_read_b128 a[96:99], v2 offset:40960
v_mfma_f32_16x16x32_bf16 v[132:135], a[140:143], a[36:39], v[132:135]
s_cselect_b32 s42, s46, s42
v_mfma_f32_16x16x32_bf16 v[140:143], a[136:139], a[40:43], v[140:143]
s_cselect_b32 s46, 0, s46
v_mfma_f32_16x16x32_bf16 v[140:143], a[140:143], a[44:47], v[140:143]
s_lshl_b32 s59, s39, 5
v_mfma_f32_16x16x32_bf16 v[148:151], a[136:139], a[48:51], v[148:151]
s_add_u32 s59, s59, s38
ds_read_b128 a[100:103], v3 offset:40960
v_mfma_f32_16x16x32_bf16 v[148:151], a[140:143], a[52:55], v[148:151]
s_lshl_b32 s59, s59, 2
v_mfma_f32_16x16x32_bf16 v[156:159], a[136:139], a[56:59], v[156:159]
s_add_u32 s59, s59, 94392320
ds_read_b128 a[104:107], v2 offset:43008
v_mfma_f32_16x16x32_bf16 v[156:159], a[140:143], a[60:63], v[156:159]
s_waitcnt lgkmcnt(3)
s_cmp_lt_u32 s2, 224
v_mfma_f32_16x16x32_bf16 v[160:163], a[128:131], a[0:3], v[160:163]
s_cselect_b32 s59, s59, 3221225472
ds_read_b64_tr_b16 a[136:137], v9 offset:0
v_mfma_f32_16x16x32_bf16 v[160:163], a[132:135], a[4:7], v[160:163]
s_mov_b32 s58, 0xffff0000
v_mfma_f32_16x16x32_bf16 v[168:171], a[128:131], a[8:11], v[168:171]
ds_read_b64_tr_b16 a[138:139], v9 offset:2048
v_mfma_f32_16x16x32_bf16 v[168:171], a[132:135], a[12:15], v[168:171]
buffer_load_dword v21, v20, s[16:19], s43 offen
v_mfma_f32_16x16x32_bf16 v[176:179], a[128:131], a[16:19], v[176:179]
s_add_u32 s43, s43, s47
ds_read_b64_tr_b16 a[140:141], v9 offset:16384
v_mfma_f32_16x16x32_bf16 v[176:179], a[132:135], a[20:23], v[176:179]
s_cmp_ge_u32 s43, s51
v_mfma_f32_16x16x32_bf16 v[184:187], a[128:131], a[24:27], v[184:187]
s_cselect_b32 s43, 0, s43
ds_read_b64_tr_b16 a[142:143], v9 offset:18432
v_mfma_f32_16x16x32_bf16 v[184:187], a[132:135], a[28:31], v[184:187]
s_cselect_b32 s51, s42, s51
v_mfma_f32_16x16x32_bf16 v[192:195], a[128:131], a[32:35], v[192:195]
s_cselect_b64 s[16:17], s[40:41], s[16:17]
v_mfma_f32_16x16x32_bf16 v[192:195], a[132:135], a[36:39], v[192:195]
s_cselect_b32 s18, s42, s18
v_mfma_f32_16x16x32_bf16 v[200:203], a[128:131], a[40:43], v[200:203]
s_cselect_b64 s[40:41], s[44:45], s[40:41]
ds_read_b128 a[108:111], v3 offset:43008
v_mfma_f32_16x16x32_bf16 v[200:203], a[132:135], a[44:47], v[200:203]
s_cselect_b32 s42, s46, s42
v_mfma_f32_16x16x32_bf16 v[208:211], a[128:131], a[48:51], v[208:211]
s_cselect_b32 s46, 0, s46
ds_read_b128 a[112:115], v2 offset:45056
v_mfma_f32_16x16x32_bf16 v[208:211], a[132:135], a[52:55], v[208:211]
v_mfma_f32_16x16x32_bf16 v[216:219], a[128:131], a[56:59], v[216:219]
v_mfma_f32_16x16x32_bf16 v[216:219], a[132:135], a[60:63], v[216:219]
s_waitcnt lgkmcnt(2)
v_mfma_f32_16x16x32_bf16 v[164:167], a[136:139], a[0:3], v[164:167]
ds_read_b64_tr_b16 a[128:129], v10 offset:0
v_mfma_f32_16x16x32_bf16 v[164:167], a[140:143], a[4:7], v[164:167]
v_mfma_f32_16x16x32_bf16 v[172:175], a[136:139], a[8:11], v[172:175]
ds_read_b64_tr_b16 a[130:131], v10 offset:2048
v_mfma_f32_16x16x32_bf16 v[172:175], a[140:143], a[12:15], v[172:175]
v_mfma_f32_16x16x32_bf16 v[180:183], a[136:139], a[16:19], v[180:183]
ds_read_b64_tr_b16 a[132:133], v10 offset:16384
v_mfma_f32_16x16x32_bf16 v[180:183], a[140:143], a[20:23], v[180:183]
v_mfma_f32_16x16x32_bf16 v[188:191], a[136:139], a[24:27], v[188:191]
ds_read_b64_tr_b16 a[134:135], v10 offset:18432
v_mfma_f32_16x16x32_bf16 v[188:191], a[140:143], a[28:31], v[188:191]
v_mfma_f32_16x16x32_bf16 v[196:199], a[136:139], a[32:35], v[196:199]
ds_read_b128 a[116:119], v3 offset:45056
v_mfma_f32_16x16x32_bf16 v[196:199], a[140:143], a[36:39], v[196:199]
v_mfma_f32_16x16x32_bf16 v[204:207], a[136:139], a[40:43], v[204:207]
ds_read_b128 a[120:123], v2 offset:47104
v_and_b32 v252, 31, v0
v_mfma_f32_16x16x32_bf16 v[204:207], a[140:143], a[44:47], v[204:207]
v_lshrrev_b32 v253, 5, v0
v_xor_b32 v253, v253, v252
v_mfma_f32_16x16x32_bf16 v[212:215], a[136:139], a[48:51], v[212:215]
v_and_b32 v253, 7, v253
v_lshlrev_b32 v252, 8, v252
v_mfma_f32_16x16x32_bf16 v[212:215], a[140:143], a[52:55], v[212:215]
v_lshl_add_u32 v252, v253, 4, v252
v_add_u32 v252, 147456, v252
v_mfma_f32_16x16x32_bf16 v[220:223], a[136:139], a[56:59], v[220:223]
ds_read_b128 a[124:127], v3 offset:47104
v_mfma_f32_16x16x32_bf16 v[220:223], a[140:143], a[60:63], v[220:223]
s_waitcnt lgkmcnt(3)
v_mfma_f32_16x16x32_bf16 a[192:195], a[128:131], a[0:3], a[192:195]
ds_read_b64_tr_b16 a[136:137], v11 offset:0
v_mfma_f32_16x16x32_bf16 a[192:195], a[132:135], a[4:7], a[192:195]
v_mfma_f32_16x16x32_bf16 a[200:203], a[128:131], a[8:11], a[200:203]
ds_read_b64_tr_b16 a[138:139], v11 offset:2048
v_mfma_f32_16x16x32_bf16 a[200:203], a[132:135], a[12:15], a[200:203]
v_mfma_f32_16x16x32_bf16 a[208:211], a[128:131], a[16:19], a[208:211]
ds_read_b64_tr_b16 a[140:141], v11 offset:16384
v_mfma_f32_16x16x32_bf16 a[208:211], a[132:135], a[20:23], a[208:211]
v_mfma_f32_16x16x32_bf16 a[216:219], a[128:131], a[24:27], a[216:219]
ds_read_b64_tr_b16 a[142:143], v11 offset:18432
v_mfma_f32_16x16x32_bf16 a[216:219], a[132:135], a[28:31], a[216:219]
v_mfma_f32_16x16x32_bf16 a[224:227], a[128:131], a[32:35], a[224:227]
v_mfma_f32_16x16x32_bf16 a[224:227], a[132:135], a[36:39], a[224:227]
v_mfma_f32_16x16x32_bf16 a[232:235], a[128:131], a[40:43], a[232:235]
v_mfma_f32_16x16x32_bf16 a[232:235], a[132:135], a[44:47], a[232:235]
v_mfma_f32_16x16x32_bf16 a[240:243], a[128:131], a[48:51], a[240:243]
v_mfma_f32_16x16x32_bf16 a[240:243], a[132:135], a[52:55], a[240:243]
v_mfma_f32_16x16x32_bf16 a[248:251], a[128:131], a[56:59], a[248:251]
s_waitcnt vmcnt(2) lgkmcnt(0)
v_mfma_f32_16x16x32_bf16 a[248:251], a[132:135], a[60:63], a[248:251]
s_barrier
v_mfma_f32_16x16x32_bf16 a[196:199], a[136:139], a[0:3], a[196:199]
s_add_u32 m0, s29, 65536
ds_read_b64_tr_b16 a[128:129], v4 offset:32768
v_lshlrev_b32 v28, 16, v248
v_mfma_f32_16x16x32_bf16 a[196:199], a[140:143], a[4:7], a[196:199]
buffer_load_dwordx4 v16, s[12:15], s26 offen offset:0 lds
v_mfma_f32_16x16x32_bf16 a[204:207], a[136:139], a[8:11], a[204:207]
ds_read_b64_tr_b16 a[130:131], v4 offset:34816
v_and_b32 v29, s58, v248
v_mfma_f32_16x16x32_bf16 a[204:207], a[140:143], a[12:15], a[204:207]
v_lshlrev_b32 v30, 16, v249
v_and_b32 v253, s58, v249
v_mfma_f32_16x16x32_bf16 a[212:215], a[136:139], a[16:19], a[212:215]
ds_read_b64_tr_b16 a[132:133], v4 offset:49152
v_lshlrev_b32 v22, 16, v224
v_mfma_f32_16x16x32_bf16 a[212:215], a[140:143], a[20:23], a[212:215]
buffer_load_dwordx4 v17, s[12:15], s26 offen offset:1024 lds
v_mfma_f32_16x16x32_bf16 a[220:223], a[136:139], a[24:27], a[220:223]
ds_read_b64_tr_b16 a[134:135], v4 offset:51200
v_lshlrev_b32 v23, 16, v225
v_mfma_f32_16x16x32_bf16 a[220:223], a[140:143], a[28:31], a[220:223]
v_lshlrev_b32 v24, 16, v226
v_mul_f32 v254, v22, v253
v_mfma_f32_16x16x32_bf16 a[228:231], a[136:139], a[32:35], a[228:231]
v_lshlrev_b32 v25, 16, v227
v_lshlrev_b32 v247, 16, v236
v_mfma_f32_16x16x32_bf16 a[228:231], a[140:143], a[36:39], a[228:231]
buffer_load_dwordx4 v18, s[12:15], s26 offen offset:2048 lds
v_mfma_f32_16x16x32_bf16 a[236:239], a[136:139], a[40:43], a[236:239]
v_fmac_f32 v254, v23, v30
v_fmac_f32 v254, v24, v29
v_mfma_f32_16x16x32_bf16 a[236:239], a[140:143], a[44:47], a[236:239]
v_fmac_f32 v254, v25, v28
v_mul_f32 v254, v254, v247
v_mfma_f32_16x16x32_bf16 a[244:247], a[136:139], a[48:51], a[244:247]
v_mul_f32 v255, v23, v253
v_lshlrev_b32 v22, 16, v228
v_mfma_f32_16x16x32_bf16 a[244:247], a[140:143], a[52:55], a[244:247]
buffer_load_dwordx4 v19, s[12:15], s26 offen offset:3072 lds
v_mfma_f32_16x16x32_bf16 a[252:255], a[136:139], a[56:59], a[252:255]
s_add_u32 s26, s26, 524288
v_lshlrev_b32 v247, 16, v237
v_fmac_f32 v255, v24, v30
v_mfma_f32_16x16x32_bf16 a[252:255], a[140:143], a[60:63], a[252:255]
s_waitcnt lgkmcnt(0)
v_fmac_f32 v255, v25, v29
v_fmac_f32 v255, v22, v28
v_mfma_f32_16x16x32_bf16 v[32:35], a[128:131], a[64:67], v[32:35]
s_add_u32 m0, s29, 81920
ds_read_b64_tr_b16 a[136:137], v5 offset:32768
v_mul_f32 v255, v255, v247
v_mfma_f32_16x16x32_bf16 v[32:35], a[132:135], a[68:71], v[32:35]
buffer_load_dwordx4 v16, s[12:15], s27 offen offset:0 lds
v_mfma_f32_16x16x32_bf16 v[40:43], a[128:131], a[72:75], v[40:43]
ds_read_b64_tr_b16 a[138:139], v5 offset:34816
v_cvt_pk_bf16_f32 v246, v254, v255
v_mfma_f32_16x16x32_bf16 v[40:43], a[132:135], a[76:79], v[40:43]
v_accvgpr_write_b32 a180, v246
v_mul_f32 v254, v24, v253
v_mfma_f32_16x16x32_bf16 v[48:51], a[128:131], a[80:83], v[48:51]
ds_read_b64_tr_b16 a[140:141], v5 offset:49152
v_lshlrev_b32 v23, 16, v229
v_mfma_f32_16x16x32_bf16 v[48:51], a[132:135], a[84:87], v[48:51]
buffer_load_dwordx4 v17, s[12:15], s27 offen offset:1024 lds
v_lshlrev_b32 v247, 16, v238
v_mfma_f32_16x16x32_bf16 v[56:59], a[128:131], a[88:91], v[56:59]
ds_read_b64_tr_b16 a[142:143], v5 offset:51200
v_fmac_f32 v254, v25, v30
v_mfma_f32_16x16x32_bf16 v[56:59], a[132:135], a[92:95], v[56:59]
v_fmac_f32 v254, v22, v29
v_fmac_f32 v254, v23, v28
v_mfma_f32_16x16x32_bf16 v[64:67], a[128:131], a[96:99], v[64:67]
ds_read_b128 a[0:3], v2 offset:0
v_mul_f32 v254, v254, v247
v_mfma_f32_16x16x32_bf16 v[64:67], a[132:135], a[100:103], v[64:67]
buffer_load_dwordx4 v18, s[12:15], s27 offen offset:2048 lds
v_mfma_f32_16x16x32_bf16 v[72:75], a[128:131], a[104:107], v[72:75]
ds_read_b128 a[4:7], v3 offset:0
v_cvt_pk_bf16_f32 v246, v255, v254
v_accvgpr_write_b32 a176, v246
v_mfma_f32_16x16x32_bf16 v[72:75], a[132:135], a[108:111], v[72:75]
v_mul_f32 v255, v25, v253
v_lshlrev_b32 v24, 16, v230
v_mfma_f32_16x16x32_bf16 v[80:83], a[128:131], a[112:115], v[80:83]
v_lshlrev_b32 v247, 16, v239
v_fmac_f32 v255, v22, v30
v_mfma_f32_16x16x32_bf16 v[80:83], a[132:135], a[116:119], v[80:83]
buffer_load_dwordx4 v19, s[12:15], s27 offen offset:3072 lds
v_mfma_f32_16x16x32_bf16 v[88:91], a[128:131], a[120:123], v[88:91]
s_add_u32 s27, s27, 524288
ds_read_b128 a[8:11], v2 offset:2048
v_fmac_f32 v255, v23, v29
v_mfma_f32_16x16x32_bf16 v[88:91], a[132:135], a[124:127], v[88:91]
s_waitcnt lgkmcnt(3)
v_fmac_f32 v255, v24, v28
v_mul_f32 v255, v255, v247
v_mfma_f32_16x16x32_bf16 v[36:39], a[136:139], a[64:67], v[36:39]
s_add_u32 m0, s28, 32768
ds_read_b64_tr_b16 a[128:129], v6 offset:32768
v_cvt_pk_bf16_f32 v246, v254, v255
v_accvgpr_write_b32 a181, v246
v_mfma_f32_16x16x32_bf16 v[36:39], a[140:143], a[68:71], v[36:39]
buffer_load_dwordx4 v12, s[8:11], s24 offen offset:0 lds
v_mfma_f32_16x16x32_bf16 v[44:47], a[136:139], a[72:75], v[44:47]
ds_read_b64_tr_b16 a[130:131], v6 offset:34816
v_mul_f32 v254, v22, v253
v_mfma_f32_16x16x32_bf16 v[44:47], a[140:143], a[76:79], v[44:47]
v_lshlrev_b32 v25, 16, v231
v_lshlrev_b32 v247, 16, v240
v_mfma_f32_16x16x32_bf16 v[52:55], a[136:139], a[80:83], v[52:55]
ds_read_b64_tr_b16 a[132:133], v6 offset:49152
v_fmac_f32 v254, v23, v30
v_mfma_f32_16x16x32_bf16 v[52:55], a[140:143], a[84:87], v[52:55]
buffer_load_dwordx4 v13, s[8:11], s24 offen offset:1024 lds
v_fmac_f32 v254, v24, v29
v_mfma_f32_16x16x32_bf16 v[60:63], a[136:139], a[88:91], v[60:63]
ds_read_b64_tr_b16 a[134:135], v6 offset:51200
v_fmac_f32 v254, v25, v28
v_mfma_f32_16x16x32_bf16 v[60:63], a[140:143], a[92:95], v[60:63]
v_mul_f32 v254, v254, v247
v_cvt_pk_bf16_f32 v246, v255, v254
v_mfma_f32_16x16x32_bf16 v[68:71], a[136:139], a[96:99], v[68:71]
ds_read_b128 a[12:15], v3 offset:2048
v_accvgpr_write_b32 a177, v246
v_mfma_f32_16x16x32_bf16 v[68:71], a[140:143], a[100:103], v[68:71]
buffer_load_dwordx4 v14, s[8:11], s24 offen offset:2048 lds
v_mfma_f32_16x16x32_bf16 v[76:79], a[136:139], a[104:107], v[76:79]
v_mul_f32 v255, v23, v253
v_lshlrev_b32 v22, 16, v232
v_lshlrev_b32 v247, 16, v241
v_mfma_f32_16x16x32_bf16 v[76:79], a[140:143], a[108:111], v[76:79]
v_fmac_f32 v255, v24, v30
v_fmac_f32 v255, v25, v29
v_mfma_f32_16x16x32_bf16 v[84:87], a[136:139], a[112:115], v[84:87]
ds_read_b128 a[16:19], v2 offset:4096
v_fmac_f32 v255, v22, v28
v_mfma_f32_16x16x32_bf16 v[84:87], a[140:143], a[116:119], v[84:87]
buffer_load_dwordx4 v15, s[8:11], s24 offen offset:3072 lds
v_mfma_f32_16x16x32_bf16 v[92:95], a[136:139], a[120:123], v[92:95]
s_add_u32 s24, s24, 128
ds_read_b128 a[20:23], v3 offset:4096
v_mul_f32 v255, v255, v247
v_mfma_f32_16x16x32_bf16 v[92:95], a[140:143], a[124:127], v[92:95]
s_waitcnt lgkmcnt(3)
v_cvt_pk_bf16_f32 v246, v254, v255
v_accvgpr_write_b32 a182, v246
v_mfma_f32_16x16x32_bf16 v[96:99], a[128:131], a[64:67], v[96:99]
s_add_u32 m0, s28, 36864
ds_read_b64_tr_b16 a[136:137], v7 offset:32768
v_mul_f32 v254, v24, v253
v_lshlrev_b32 v23, 16, v233
v_mfma_f32_16x16x32_bf16 v[96:99], a[132:135], a[68:71], v[96:99]
buffer_load_dwordx4 v12, s[8:11], s25 offen offset:0 lds
v_mfma_f32_16x16x32_bf16 v[104:107], a[128:131], a[72:75], v[104:107]
ds_read_b64_tr_b16 a[138:139], v7 offset:34816
v_lshlrev_b32 v247, 16, v242
v_mfma_f32_16x16x32_bf16 v[104:107], a[132:135], a[76:79], v[104:107]
v_fmac_f32 v254, v25, v30
v_fmac_f32 v254, v22, v29
v_mfma_f32_16x16x32_bf16 v[112:115], a[128:131], a[80:83], v[112:115]
ds_read_b64_tr_b16 a[140:141], v7 offset:49152
v_fmac_f32 v254, v23, v28
v_mfma_f32_16x16x32_bf16 v[112:115], a[132:135], a[84:87], v[112:115]
buffer_load_dwordx4 v13, s[8:11], s25 offen offset:1024 lds
v_mul_f32 v254, v254, v247
v_mfma_f32_16x16x32_bf16 v[120:123], a[128:131], a[88:91], v[120:123]
ds_read_b64_tr_b16 a[142:143], v7 offset:51200
v_cvt_pk_bf16_f32 v246, v255, v254
v_mfma_f32_16x16x32_bf16 v[120:123], a[132:135], a[92:95], v[120:123]
v_accvgpr_write_b32 a178, v246
v_mul_f32 v255, v25, v253
v_mfma_f32_16x16x32_bf16 v[128:131], a[128:131], a[96:99], v[128:131]
v_lshlrev_b32 v24, 16, v234
v_lshlrev_b32 v247, 16, v243
v_mfma_f32_16x16x32_bf16 v[128:131], a[132:135], a[100:103], v[128:131]
buffer_load_dwordx4 v14, s[8:11], s25 offen offset:2048 lds
v_mfma_f32_16x16x32_bf16 v[136:139], a[128:131], a[104:107], v[136:139]
ds_read_b128 a[24:27], v2 offset:6144
v_fmac_f32 v255, v22, v30
v_fmac_f32 v255, v23, v29
v_mfma_f32_16x16x32_bf16 v[136:139], a[132:135], a[108:111], v[136:139]
v_fmac_f32 v255, v24, v28
v_mul_f32 v255, v255, v247
v_mfma_f32_16x16x32_bf16 v[144:147], a[128:131], a[112:115], v[144:147]
ds_read_b128 a[28:31], v3 offset:6144
v_cvt_pk_bf16_f32 v246, v254, v255
v_mfma_f32_16x16x32_bf16 v[144:147], a[132:135], a[116:119], v[144:147]
buffer_load_dwordx4 v15, s[8:11], s25 offen offset:3072 lds
v_mfma_f32_16x16x32_bf16 v[152:155], a[128:131], a[120:123], v[152:155]
s_add_u32 s25, s25, 128
v_accvgpr_write_b32 a183, v246
v_mul_f32 v254, v22, v253
v_mfma_f32_16x16x32_bf16 v[152:155], a[132:135], a[124:127], v[152:155]
s_waitcnt lgkmcnt(2)
v_lshlrev_b32 v25, 16, v235
v_lshlrev_b32 v247, 16, v244
v_mfma_f32_16x16x32_bf16 v[100:103], a[136:139], a[64:67], v[100:103]
ds_read_b64_tr_b16 a[128:129], v8 offset:32768
v_fmac_f32 v254, v23, v30
v_fmac_f32 v254, v24, v29
v_mfma_f32_16x16x32_bf16 v[100:103], a[140:143], a[68:71], v[100:103]
buffer_load_dword v21, v20, s[16:19], s43 offen
v_mfma_f32_16x16x32_bf16 v[108:111], a[136:139], a[72:75], v[108:111]
s_add_u32 s43, s43, s47
ds_read_b64_tr_b16 a[130:131], v8 offset:34816
v_fmac_f32 v254, v25, v28
v_mfma_f32_16x16x32_bf16 v[108:111], a[140:143], a[76:79], v[108:111]
s_cmp_ge_u32 s43, s51
v_mul_f32 v254, v254, v247
v_cvt_pk_bf16_f32 v246, v255, v254
v_mfma_f32_16x16x32_bf16 v[116:119], a[136:139], a[80:83], v[116:119]
s_cselect_b32 s43, 0, s43
ds_read_b64_tr_b16 a[132:133], v8 offset:49152
v_accvgpr_write_b32 a179, v246
v_mfma_f32_16x16x32_bf16 v[116:119], a[140:143], a[84:87], v[116:119]
s_cselect_b32 s51, s42, s51
v_lshlrev_b32 v28, 16, v250
v_and_b32 v29, s58, v250
v_lshlrev_b32 v30, 16, v251
v_mfma_f32_16x16x32_bf16 v[124:127], a[136:139], a[88:91], v[124:127]
s_cselect_b64 s[16:17], s[40:41], s[16:17]
ds_read_b64_tr_b16 a[134:135], v8 offset:51200
v_and_b32 v253, s58, v251
v_mfma_f32_16x16x32_bf16 v[124:127], a[140:143], a[92:95], v[124:127]
s_cselect_b32 s18, s42, s18
v_and_b32 v22, s58, v224
v_and_b32 v23, s58, v225
v_mfma_f32_16x16x32_bf16 v[132:135], a[136:139], a[96:99], v[132:135]
s_cselect_b64 s[40:41], s[44:45], s[40:41]
ds_read_b128 a[32:35], v2 offset:8192
v_and_b32 v24, s58, v226
v_mfma_f32_16x16x32_bf16 v[132:135], a[140:143], a[100:103], v[132:135]
s_cselect_b32 s42, s46, s42
v_mul_f32 v254, v22, v253
v_and_b32 v25, s58, v227
v_mfma_f32_16x16x32_bf16 v[140:143], a[136:139], a[104:107], v[140:143]
s_cselect_b32 s46, 0, s46
v_and_b32 v247, s58, v236
v_fmac_f32 v254, v23, v30
v_mfma_f32_16x16x32_bf16 v[140:143], a[140:143], a[108:111], v[140:143]
buffer_load_dword v245, off, s[60:63], 0 sc1
v_fmac_f32 v254, v24, v29
v_mfma_f32_16x16x32_bf16 v[148:151], a[136:139], a[112:115], v[148:151]
ds_read_b128 a[36:39], v3 offset:8192
v_fmac_f32 v254, v25, v28
v_mfma_f32_16x16x32_bf16 v[148:151], a[140:143], a[116:119], v[148:151]
v_mul_f32 v254, v254, v247
v_mul_f32 v255, v23, v253
v_mfma_f32_16x16x32_bf16 v[156:159], a[136:139], a[120:123], v[156:159]
ds_read_b128 a[40:43], v2 offset:10240
v_and_b32 v22, s58, v228
v_mfma_f32_16x16x32_bf16 v[156:159], a[140:143], a[124:127], v[156:159]
s_waitcnt lgkmcnt(3)
v_and_b32 v247, s58, v237
v_fmac_f32 v255, v24, v30
v_mfma_f32_16x16x32_bf16 v[160:163], a[128:131], a[64:67], v[160:163]
ds_read_b64_tr_b16 a[136:137], v9 offset:32768
v_fmac_f32 v255, v25, v29
v_fmac_f32 v255, v22, v28
v_mfma_f32_16x16x32_bf16 v[160:163], a[132:135], a[68:71], v[160:163]
v_mul_f32 v255, v255, v247
v_cvt_pk_bf16_f32 v246, v254, v255
v_mfma_f32_16x16x32_bf16 v[168:171], a[128:131], a[72:75], v[168:171]
ds_read_b64_tr_b16 a[138:139], v9 offset:34816
v_accvgpr_write_b32 a188, v246
v_mfma_f32_16x16x32_bf16 v[168:171], a[132:135], a[76:79], v[168:171]
v_mul_f32 v254, v24, v253
v_and_b32 v23, s58, v229
v_mfma_f32_16x16x32_bf16 v[176:179], a[128:131], a[80:83], v[176:179]
ds_read_b64_tr_b16 a[140:141], v9 offset:49152
v_and_b32 v247, s58, v238
v_mfma_f32_16x16x32_bf16 v[176:179], a[132:135], a[84:87], v[176:179]
v_fmac_f32 v254, v25, v30
v_fmac_f32 v254, v22, v29
v_fmac_f32 v254, v23, v28
v_mfma_f32_16x16x32_bf16 v[184:187], a[128:131], a[88:91], v[184:187]
ds_read_b64_tr_b16 a[142:143], v9 offset:51200
v_mul_f32 v254, v254, v247
v_mfma_f32_16x16x32_bf16 v[184:187], a[132:135], a[92:95], v[184:187]
v_cvt_pk_bf16_f32 v246, v255, v254
v_accvgpr_write_b32 a184, v246
v_mfma_f32_16x16x32_bf16 v[192:195], a[128:131], a[96:99], v[192:195]
v_mul_f32 v255, v25, v253
v_and_b32 v24, s58, v230
v_mfma_f32_16x16x32_bf16 v[192:195], a[132:135], a[100:103], v[192:195]
v_and_b32 v247, s58, v239
v_fmac_f32 v255, v22, v30
v_mfma_f32_16x16x32_bf16 v[200:203], a[128:131], a[104:107], v[200:203]
ds_read_b128 a[44:47], v3 offset:10240
v_fmac_f32 v255, v23, v29
v_mfma_f32_16x16x32_bf16 v[200:203], a[132:135], a[108:111], v[200:203]
v_fmac_f32 v255, v24, v28
v_mul_f32 v255, v255, v247
v_cvt_pk_bf16_f32 v246, v254, v255
v_mfma_f32_16x16x32_bf16 v[208:211], a[128:131], a[112:115], v[208:211]
ds_read_b128 a[48:51], v2 offset:12288
v_accvgpr_write_b32 a189, v246
v_mfma_f32_16x16x32_bf16 v[208:211], a[132:135], a[116:119], v[208:211]
v_mul_f32 v254, v22, v253
v_and_b32 v25, s58, v231
v_mfma_f32_16x16x32_bf16 v[216:219], a[128:131], a[120:123], v[216:219]
v_and_b32 v247, s58, v240
v_fmac_f32 v254, v23, v30
v_mfma_f32_16x16x32_bf16 v[216:219], a[132:135], a[124:127], v[216:219]
s_waitcnt lgkmcnt(2)
v_fmac_f32 v254, v24, v29
v_fmac_f32 v254, v25, v28
v_mfma_f32_16x16x32_bf16 v[164:167], a[136:139], a[64:67], v[164:167]
ds_read_b64_tr_b16 a[128:129], v10 offset:32768
v_mul_f32 v254, v254, v247
v_cvt_pk_bf16_f32 v246, v255, v254
v_mfma_f32_16x16x32_bf16 v[164:167], a[140:143], a[68:71], v[164:167]
v_accvgpr_write_b32 a185, v246
v_mul_f32 v255, v23, v253
v_mfma_f32_16x16x32_bf16 v[172:175], a[136:139], a[72:75], v[172:175]
ds_read_b64_tr_b16 a[130:131], v10 offset:34816
v_and_b32 v22, s58, v232
v_mfma_f32_16x16x32_bf16 v[172:175], a[140:143], a[76:79], v[172:175]
v_and_b32 v247, s58, v241
v_fmac_f32 v255, v24, v30
v_mfma_f32_16x16x32_bf16 v[180:183], a[136:139], a[80:83], v[180:183]
s_lshr_b32 s22, s3, 1
ds_read_b64_tr_b16 a[132:133], v10 offset:49152
v_fmac_f32 v255, v25, v29
v_mfma_f32_16x16x32_bf16 v[180:183], a[140:143], a[84:87], v[180:183]
s_mul_i32 s22, s22, 2097152
v_fmac_f32 v255, v22, v28
v_mul_f32 v255, v255, v247
v_cvt_pk_bf16_f32 v246, v254, v255
v_mfma_f32_16x16x32_bf16 v[188:191], a[136:139], a[88:91], v[188:191]
s_and_b32 s23, s3, 1
ds_read_b64_tr_b16 a[134:135], v10 offset:51200
v_accvgpr_write_b32 a190, v246
v_mfma_f32_16x16x32_bf16 v[188:191], a[140:143], a[92:95], v[188:191]
s_lshl_b32 s23, s23, 5
v_mul_f32 v254, v24, v253
v_and_b32 v23, s58, v233
v_mfma_f32_16x16x32_bf16 v[196:199], a[136:139], a[96:99], v[196:199]
s_lshl_b32 s56, s39, 6
ds_read_b128 a[52:55], v3 offset:12288
v_and_b32 v247, s58, v242
v_mfma_f32_16x16x32_bf16 v[196:199], a[140:143], a[100:103], v[196:199]
s_add_u32 s23, s23, s56
v_fmac_f32 v254, v25, v30
v_fmac_f32 v254, v22, v29
v_mfma_f32_16x16x32_bf16 v[204:207], a[136:139], a[104:107], v[204:207]
s_mul_i32 s23, s23, 4224
ds_read_b128 a[56:59], v2 offset:14336
v_fmac_f32 v254, v23, v28
v_mfma_f32_16x16x32_bf16 v[204:207], a[140:143], a[108:111], v[204:207]
s_add_u32 s22, s22, s23
v_mul_f32 v254, v254, v247
v_cvt_pk_bf16_f32 v246, v255, v254
v_accvgpr_write_b32 a186, v246
v_mfma_f32_16x16x32_bf16 v[212:215], a[136:139], a[112:115], v[212:215]
s_add_u32 s57, s22, 83886200
v_mul_f32 v255, v25, v253
v_and_b32 v24, s58, v234
v_mfma_f32_16x16x32_bf16 v[212:215], a[140:143], a[116:119], v[212:215]
s_lshl_b32 s23, s38, 7
v_and_b32 v247, s58, v243
v_fmac_f32 v255, v22, v30
v_mfma_f32_16x16x32_bf16 v[220:223], a[136:139], a[120:123], v[220:223]
s_add_u32 s22, s22, s23
ds_read_b128 a[60:63], v3 offset:14336
v_fmac_f32 v255, v23, v29
v_mfma_f32_16x16x32_bf16 v[220:223], a[140:143], a[124:127], v[220:223]
s_waitcnt lgkmcnt(3)
s_add_u32 s56, s22, 83886208
v_fmac_f32 v255, v24, v28
v_mul_f32 v255, v255, v247
v_mfma_f32_16x16x32_bf16 a[192:195], a[128:131], a[64:67], a[192:195]
s_cmp_lt_u32 s2, 224
ds_read_b64_tr_b16 a[136:137], v11 offset:32768
v_cvt_pk_bf16_f32 v246, v254, v255
v_accvgpr_write_b32 a191, v246
v_mfma_f32_16x16x32_bf16 a[192:195], a[132:135], a[68:71], a[192:195]
s_cselect_b32 s56, s56, 3221225472
v_mul_f32 v254, v22, v253
v_and_b32 v25, s58, v235
v_mfma_f32_16x16x32_bf16 a[200:203], a[128:131], a[72:75], a[200:203]
s_cmp_eq_u32 s38, 0
ds_read_b64_tr_b16 a[138:139], v11 offset:34816
v_and_b32 v247, s58, v244
v_mfma_f32_16x16x32_bf16 a[200:203], a[132:135], a[76:79], a[200:203]
s_cselect_b32 s57, s57, 3221225472
v_fmac_f32 v254, v23, v30
v_fmac_f32 v254, v24, v29
v_mfma_f32_16x16x32_bf16 a[208:211], a[128:131], a[80:83], a[208:211]
ds_read_b64_tr_b16 a[140:141], v11 offset:49152
v_fmac_f32 v254, v25, v28
v_mfma_f32_16x16x32_bf16 a[208:211], a[132:135], a[84:87], a[208:211]
v_mul_f32 v254, v254, v247
v_cvt_pk_bf16_f32 v246, v255, v254
v_accvgpr_write_b32 a187, v246
v_mfma_f32_16x16x32_bf16 a[216:219], a[128:131], a[88:91], a[216:219]
ds_read_b64_tr_b16 a[142:143], v11 offset:51200
v_mfma_f32_16x16x32_bf16 a[216:219], a[132:135], a[92:95], a[216:219]
ds_write_b128 v252, a[176:179] offset:0
v_mfma_f32_16x16x32_bf16 a[224:227], a[128:131], a[96:99], a[224:227]
v_mfma_f32_16x16x32_bf16 a[224:227], a[132:135], a[100:103], a[224:227]
ds_write_b128 v252, a[180:183] offset:8192
v_mfma_f32_16x16x32_bf16 a[232:235], a[128:131], a[104:107], a[232:235]
v_mfma_f32_16x16x32_bf16 a[232:235], a[132:135], a[108:111], a[232:235]
ds_write_b128 v252, a[184:187] offset:128
v_mfma_f32_16x16x32_bf16 a[240:243], a[128:131], a[112:115], a[240:243]
v_mfma_f32_16x16x32_bf16 a[240:243], a[132:135], a[116:119], a[240:243]
ds_write_b128 v252, a[188:191] offset:8320
v_mfma_f32_16x16x32_bf16 a[248:251], a[128:131], a[120:123], a[248:251]
s_waitcnt vmcnt(2) lgkmcnt(0)
v_mfma_f32_16x16x32_bf16 a[248:251], a[132:135], a[124:127], a[248:251]
s_barrier
v_mfma_f32_16x16x32_bf16 a[196:199], a[136:139], a[64:67], a[196:199]
s_add_u32 m0, s29, 98304
ds_read_b64_tr_b16 a[128:129], v4 offset:0
v_lshrrev_b32 v22, 8, v1
v_mfma_f32_16x16x32_bf16 a[196:199], a[140:143], a[68:71], a[196:199]
buffer_load_dwordx4 v16, s[12:15], s26 offen offset:0 lds
v_mfma_f32_16x16x32_bf16 a[204:207], a[136:139], a[72:75], a[204:207]
ds_read_b64_tr_b16 a[130:131], v4 offset:2048
v_lshlrev_b32 v22, 4, v22
v_mfma_f32_16x16x32_bf16 a[204:207], a[140:143], a[76:79], a[204:207]
v_xor_b32 v22, v22, v1
v_add_u32 v22, s29, v22
v_mfma_f32_16x16x32_bf16 a[212:215], a[136:139], a[80:83], a[212:215]
ds_read_b64_tr_b16 a[132:133], v4 offset:16384
v_add_u32 v22, 147456, v22
v_mfma_f32_16x16x32_bf16 a[212:215], a[140:143], a[84:87], a[212:215]
buffer_load_dwordx4 v17, s[12:15], s26 offen offset:1024 lds
v_mfma_f32_16x16x32_bf16 a[220:223], a[136:139], a[88:91], a[220:223]
ds_read_b64_tr_b16 a[134:135], v4 offset:18432
v_xor_b32 v23, 64, v22
v_mfma_f32_16x16x32_bf16 a[220:223], a[140:143], a[92:95], a[220:223]
v_lshrrev_b32 v224, 7, v1
v_mul_u32_u24 v224, 4224, v224
v_mfma_f32_16x16x32_bf16 a[228:231], a[136:139], a[96:99], a[228:231]
v_and_b32 v225, 0x70, v1
v_add_u32 v224, v224, v225
v_mfma_f32_16x16x32_bf16 a[228:231], a[140:143], a[100:103], a[228:231]
buffer_load_dwordx4 v18, s[12:15], s26 offen offset:2048 lds
v_mfma_f32_16x16x32_bf16 a[236:239], a[136:139], a[104:107], a[236:239]
v_bfe_u32 v225, v1, 4, 5
v_mul_u32_u24 v225, 4224, v225
v_mfma_f32_16x16x32_bf16 a[236:239], a[140:143], a[108:111], a[236:239]
v_mov_b32 v226, 0
v_mov_b32 v227, 0
v_mfma_f32_16x16x32_bf16 a[244:247], a[136:139], a[112:115], a[244:247]
v_mfma_f32_16x16x32_bf16 a[244:247], a[140:143], a[116:119], a[244:247]
buffer_load_dwordx4 v19, s[12:15], s26 offen offset:3072 lds
v_mfma_f32_16x16x32_bf16 a[252:255], a[136:139], a[120:123], a[252:255]
s_add_u32 s26, s26, 524288
v_mfma_f32_16x16x32_bf16 a[252:255], a[140:143], a[124:127], a[252:255]
s_waitcnt lgkmcnt(0)
v_mfma_f32_16x16x32_bf16 v[32:35], a[128:131], a[0:3], v[32:35]
s_add_u32 m0, s29, 114688
ds_read_b64_tr_b16 a[136:137], v5 offset:0
v_mfma_f32_16x16x32_bf16 v[32:35], a[132:135], a[4:7], v[32:35]
buffer_load_dwordx4 v16, s[12:15], s27 offen offset:0 lds
v_mfma_f32_16x16x32_bf16 v[40:43], a[128:131], a[8:11], v[40:43]
s_mul_i32 s52, s20, 7
ds_read_b64_tr_b16 a[138:139], v5 offset:2048
v_mfma_f32_16x16x32_bf16 v[40:43], a[132:135], a[12:15], v[40:43]
s_add_u32 s52, s52, s21
buffer_store_dwordx2 v[226:227], v225, s[4:7], s57 offen sc1
v_mfma_f32_16x16x32_bf16 v[48:51], a[128:131], a[16:19], v[48:51]
s_lshl_b32 s53, s52, 2
ds_read_b64_tr_b16 a[140:141], v5 offset:16384
v_mfma_f32_16x16x32_bf16 v[48:51], a[132:135], a[20:23], v[48:51]
s_add_u32 s53, s53, s3
buffer_load_dwordx4 v17, s[12:15], s27 offen offset:1024 lds
v_mfma_f32_16x16x32_bf16 v[56:59], a[128:131], a[24:27], v[56:59]
s_lshl_b32 s49, s53, 12
ds_read_b64_tr_b16 a[142:143], v5 offset:18432
v_mfma_f32_16x16x32_bf16 v[56:59], a[132:135], a[28:31], v[56:59]
s_mul_i32 s53, s53, 4224
v_mfma_f32_16x16x32_bf16 v[64:67], a[128:131], a[32:35], v[64:67]
s_add_u32 s53, s53, 83886080
ds_read_b128 a[64:67], v2 offset:32768
v_mfma_f32_16x16x32_bf16 v[64:67], a[132:135], a[36:39], v[64:67]
s_lshr_b32 s52, s52, 4
buffer_load_dwordx4 v18, s[12:15], s27 offen offset:2048 lds
v_mfma_f32_16x16x32_bf16 v[72:75], a[128:131], a[40:43], v[72:75]
s_min_u32 s52, s52, 6
ds_read_b128 a[68:71], v3 offset:32768
v_mfma_f32_16x16x32_bf16 v[72:75], a[132:135], a[44:47], v[72:75]
s_lshl_b32 s52, s52, 7
ds_read_b128 a[176:179], v22 offset:0
v_mfma_f32_16x16x32_bf16 v[80:83], a[128:131], a[48:51], v[80:83]
s_add_u32 s52, s52, 94392320
ds_read_b128 a[180:183], v23 offset:1024
v_mfma_f32_16x16x32_bf16 v[80:83], a[132:135], a[52:55], v[80:83]
buffer_load_dwordx4 v19, s[12:15], s27 offen offset:3072 lds
v_mfma_f32_16x16x32_bf16 v[88:91], a[128:131], a[56:59], v[88:91]
s_add_u32 s27, s27, 524288
ds_read_b128 a[72:75], v2 offset:34816
v_mfma_f32_16x16x32_bf16 v[88:91], a[132:135], a[60:63], v[88:91]
s_waitcnt lgkmcnt(5)
ds_read_b128 a[184:187], v22 offset:2048
v_mfma_f32_16x16x32_bf16 v[36:39], a[136:139], a[0:3], v[36:39]
s_add_u32 m0, s28, 0
ds_read_b64_tr_b16 a[128:129], v6 offset:0
v_mfma_f32_16x16x32_bf16 v[36:39], a[140:143], a[4:7], v[36:39]
buffer_load_dwordx4 v12, s[8:11], s24 offen offset:0 lds
v_mfma_f32_16x16x32_bf16 v[44:47], a[136:139], a[8:11], v[44:47]
PAD_3:
s_cbranch_execz M_tret
ds_read_b64_tr_b16 a[130:131], v6 offset:2048
v_mfma_f32_16x16x32_bf16 v[44:47], a[140:143], a[12:15], v[44:47]
ds_read_b128 a[188:191], v23 offset:3072
v_mfma_f32_16x16x32_bf16 v[52:55], a[136:139], a[16:19], v[52:55]
ds_read_b64_tr_b16 a[132:133], v6 offset:16384
v_bfe_u32 v231, v1, 4, 5
v_mfma_f32_16x16x32_bf16 v[52:55], a[140:143], a[20:23], v[52:55]
buffer_load_dwordx4 v13, s[8:11], s24 offen offset:1024 lds
v_mfma_f32_16x16x32_bf16 v[60:63], a[136:139], a[24:27], v[60:63]
ds_read_b64_tr_b16 a[134:135], v6 offset:18432
v_lshlrev_b32 v231, 2, v231
v_mfma_f32_16x16x32_bf16 v[60:63], a[140:143], a[28:31], v[60:63]
v_lshlrev_b32 v229, 3, v1
v_min_u32 v229, 4096, v229
v_mfma_f32_16x16x32_bf16 v[68:71], a[136:139], a[32:35], v[68:71]
ds_read_b128 a[76:79], v3 offset:34816
v_mfma_f32_16x16x32_bf16 v[68:71], a[140:143], a[36:39], v[68:71]
buffer_load_dwordx4 v14, s[8:11], s24 offen offset:2048 lds
v_mfma_f32_16x16x32_bf16 v[76:79], a[136:139], a[40:43], v[76:79]
v_mfma_f32_16x16x32_bf16 v[76:79], a[140:143], a[44:47], v[76:79]
v_mfma_f32_16x16x32_bf16 v[84:87], a[136:139], a[48:51], v[84:87]
ds_read_b128 a[80:83], v2 offset:36864
v_mfma_f32_16x16x32_bf16 v[84:87], a[140:143], a[52:55], v[84:87]
buffer_load_dwordx4 v15, s[8:11], s24 offen offset:3072 lds
v_mfma_f32_16x16x32_bf16 v[92:95], a[136:139], a[56:59], v[92:95]
s_add_u32 s24, s24, 128
ds_read_b128 a[84:87], v3 offset:36864
v_mfma_f32_16x16x32_bf16 v[92:95], a[140:143], a[60:63], v[92:95]
s_waitcnt lgkmcnt(3)
v_mfma_f32_16x16x32_bf16 v[96:99], a[128:131], a[0:3], v[96:99]
s_add_u32 m0, s28, 4096
ds_read_b64_tr_b16 a[136:137], v7 offset:0
v_mfma_f32_16x16x32_bf16 v[96:99], a[132:135], a[4:7], v[96:99]
buffer_load_dwordx4 v12, s[8:11], s25 offen offset:0 lds
v_mfma_f32_16x16x32_bf16 v[104:107], a[128:131], a[8:11], v[104:107]
ds_read_b64_tr_b16 a[138:139], v7 offset:2048
v_mfma_f32_16x16x32_bf16 v[104:107], a[132:135], a[12:15], v[104:107]
v_mfma_f32_16x16x32_bf16 v[112:115], a[128:131], a[16:19], v[112:115]
ds_read_b64_tr_b16 a[140:141], v7 offset:16384
v_mfma_f32_16x16x32_bf16 v[112:115], a[132:135], a[20:23], v[112:115]
buffer_load_dwordx4 v13, s[8:11], s25 offen offset:1024 lds
v_mfma_f32_16x16x32_bf16 v[120:123], a[128:131], a[24:27], v[120:123]
ds_read_b64_tr_b16 a[142:143], v7 offset:18432
v_mfma_f32_16x16x32_bf16 v[120:123], a[132:135], a[28:31], v[120:123]
v_mfma_f32_16x16x32_bf16 v[128:131], a[128:131], a[32:35], v[128:131]
v_mfma_f32_16x16x32_bf16 v[128:131], a[132:135], a[36:39], v[128:131]
buffer_load_dwordx4 v14, s[8:11], s25 offen offset:2048 lds
v_mfma_f32_16x16x32_bf16 v[136:139], a[128:131], a[40:43], v[136:139]
ds_read_b128 a[88:91], v2 offset:38912
v_mfma_f32_16x16x32_bf16 v[136:139], a[132:135], a[44:47], v[136:139]
v_mfma_f32_16x16x32_bf16 v[144:147], a[128:131], a[48:51], v[144:147]
ds_read_b128 a[92:95], v3 offset:38912
v_mfma_f32_16x16x32_bf16 v[144:147], a[132:135], a[52:55], v[144:147]
buffer_load_dwordx4 v15, s[8:11], s25 offen offset:3072 lds
v_mfma_f32_16x16x32_bf16 v[152:155], a[128:131], a[56:59], v[152:155]
s_add_u32 s25, s25, 128
v_mfma_f32_16x16x32_bf16 v[152:155], a[132:135], a[60:63], v[152:155]
s_waitcnt lgkmcnt(2)
v_mfma_f32_16x16x32_bf16 v[100:103], a[136:139], a[0:3], v[100:103]
ds_read_b64_tr_b16 a[128:129], v8 offset:0
v_mfma_f32_16x16x32_bf16 v[100:103], a[140:143], a[4:7], v[100:103]
buffer_store_dwordx4 a[176:179], v224, s[4:7], s56 offen sc1
v_mfma_f32_16x16x32_bf16 v[108:111], a[136:139], a[8:11], v[108:111]
s_add_u32 s56, s56, 33792
ds_read_b64_tr_b16 a[130:131], v8 offset:2048
v_mfma_f32_16x16x32_bf16 v[108:111], a[140:143], a[12:15], v[108:111]
v_mfma_f32_16x16x32_bf16 v[116:119], a[136:139], a[16:19], v[116:119]
ds_read_b64_tr_b16 a[132:133], v8 offset:16384
v_mfma_f32_16x16x32_bf16 v[116:119], a[140:143], a[20:23], v[116:119]
v_mfma_f32_16x16x32_bf16 v[124:127], a[136:139], a[24:27], v[124:127]
s_cmp_lt_u32 s21, 0
ds_read_b64_tr_b16 a[134:135], v8 offset:18432
v_mfma_f32_16x16x32_bf16 v[124:127], a[140:143], a[28:31], v[124:127]
s_cselect_b32 s53, s53, 3221225472
v_mfma_f32_16x16x32_bf16 v[132:135], a[136:139], a[32:35], v[132:135]
s_cselect_b32 s49, s49, 3221225472
ds_read_b128 a[96:99], v2 offset:40960
v_mfma_f32_16x16x32_bf16 v[132:135], a[140:143], a[36:39], v[132:135]
s_add_u32 s48, s53, 2097152
v_mfma_f32_16x16x32_bf16 v[140:143], a[136:139], a[40:43], v[140:143]
v_mfma_f32_16x16x32_bf16 v[140:143], a[140:143], a[44:47], v[140:143]
v_mfma_f32_16x16x32_bf16 v[148:151], a[136:139], a[48:51], v[148:151]
ds_read_b128 a[100:103], v3 offset:40960
v_mfma_f32_16x16x32_bf16 v[148:151], a[140:143], a[52:55], v[148:151]
v_mfma_f32_16x16x32_bf16 v[156:159], a[136:139], a[56:59], v[156:159]
ds_read_b128 a[104:107], v2 offset:43008
v_mfma_f32_16x16x32_bf16 v[156:159], a[140:143], a[60:63], v[156:159]
s_waitcnt lgkmcnt(3)
v_mfma_f32_16x16x32_bf16 v[160:163], a[128:131], a[0:3], v[160:163]
ds_read_b64_tr_b16 a[136:137], v9 offset:0
v_mfma_f32_16x16x32_bf16 v[160:163], a[132:135], a[4:7], v[160:163]
v_mfma_f32_16x16x32_bf16 v[168:171], a[128:131], a[8:11], v[168:171]
ds_read_b64_tr_b16 a[138:139], v9 offset:2048
v_mfma_f32_16x16x32_bf16 v[168:171], a[132:135], a[12:15], v[168:171]
buffer_store_dwordx4 a[180:183], v224, s[4:7], s56 offen sc1
v_mfma_f32_16x16x32_bf16 v[176:179], a[128:131], a[16:19], v[176:179]
s_add_u32 s56, s56, 33792
ds_read_b64_tr_b16 a[140:141], v9 offset:16384
v_mfma_f32_16x16x32_bf16 v[176:179], a[132:135], a[20:23], v[176:179]
v_mfma_f32_16x16x32_bf16 v[184:187], a[128:131], a[24:27], v[184:187]
ds_read_b64_tr_b16 a[142:143], v9 offset:18432
v_mfma_f32_16x16x32_bf16 v[184:187], a[132:135], a[28:31], v[184:187]
v_mfma_f32_16x16x32_bf16 v[192:195], a[128:131], a[32:35], v[192:195]
v_mfma_f32_16x16x32_bf16 v[192:195], a[132:135], a[36:39], v[192:195]
v_mfma_f32_16x16x32_bf16 v[200:203], a[128:131], a[40:43], v[200:203]
ds_read_b128 a[108:111], v3 offset:43008
v_mfma_f32_16x16x32_bf16 v[200:203], a[132:135], a[44:47], v[200:203]
v_mfma_f32_16x16x32_bf16 v[208:211], a[128:131], a[48:51], v[208:211]
ds_read_b128 a[112:115], v2 offset:45056
v_mfma_f32_16x16x32_bf16 v[208:211], a[132:135], a[52:55], v[208:211]
v_mfma_f32_16x16x32_bf16 v[216:219], a[128:131], a[56:59], v[216:219]
v_mfma_f32_16x16x32_bf16 v[216:219], a[132:135], a[60:63], v[216:219]
s_waitcnt lgkmcnt(2)
v_mfma_f32_16x16x32_bf16 v[164:167], a[136:139], a[0:3], v[164:167]
ds_read_b64_tr_b16 a[128:129], v10 offset:0
v_mfma_f32_16x16x32_bf16 v[164:167], a[140:143], a[4:7], v[164:167]
v_mfma_f32_16x16x32_bf16 v[172:175], a[136:139], a[8:11], v[172:175]
ds_read_b64_tr_b16 a[130:131], v10 offset:2048
v_mfma_f32_16x16x32_bf16 v[172:175], a[140:143], a[12:15], v[172:175]
v_mfma_f32_16x16x32_bf16 v[180:183], a[136:139], a[16:19], v[180:183]
ds_read_b64_tr_b16 a[132:133], v10 offset:16384
v_mfma_f32_16x16x32_bf16 v[180:183], a[140:143], a[20:23], v[180:183]
buffer_store_dwordx4 a[184:187], v224, s[4:7], s56 offen sc1
v_mfma_f32_16x16x32_bf16 v[188:191], a[136:139], a[24:27], v[188:191]
s_add_u32 s56, s56, 33792
ds_read_b64_tr_b16 a[134:135], v10 offset:18432
v_mfma_f32_16x16x32_bf16 v[188:191], a[140:143], a[28:31], v[188:191]
v_mfma_f32_16x16x32_bf16 v[196:199], a[136:139], a[32:35], v[196:199]
ds_read_b128 a[116:119], v3 offset:45056
v_mfma_f32_16x16x32_bf16 v[196:199], a[140:143], a[36:39], v[196:199]
v_mfma_f32_16x16x32_bf16 v[204:207], a[136:139], a[40:43], v[204:207]
ds_read_b128 a[120:123], v2 offset:47104
v_mfma_f32_16x16x32_bf16 v[204:207], a[140:143], a[44:47], v[204:207]
v_mfma_f32_16x16x32_bf16 v[212:215], a[136:139], a[48:51], v[212:215]
v_mfma_f32_16x16x32_bf16 v[212:215], a[140:143], a[52:55], v[212:215]
v_mfma_f32_16x16x32_bf16 v[220:223], a[136:139], a[56:59], v[220:223]
ds_read_b128 a[124:127], v3 offset:47104
v_mfma_f32_16x16x32_bf16 v[220:223], a[140:143], a[60:63], v[220:223]
s_waitcnt lgkmcnt(3)
v_mfma_f32_16x16x32_bf16 a[192:195], a[128:131], a[0:3], a[192:195]
ds_read_b64_tr_b16 a[136:137], v11 offset:0
v_mfma_f32_16x16x32_bf16 a[192:195], a[132:135], a[4:7], a[192:195]
v_mfma_f32_16x16x32_bf16 a[200:203], a[128:131], a[8:11], a[200:203]
ds_read_b64_tr_b16 a[138:139], v11 offset:2048
v_mfma_f32_16x16x32_bf16 a[200:203], a[132:135], a[12:15], a[200:203]
v_mfma_f32_16x16x32_bf16 a[208:211], a[128:131], a[16:19], a[208:211]
ds_read_b64_tr_b16 a[140:141], v11 offset:16384
v_mfma_f32_16x16x32_bf16 a[208:211], a[132:135], a[20:23], a[208:211]
v_mfma_f32_16x16x32_bf16 a[216:219], a[128:131], a[24:27], a[216:219]
ds_read_b64_tr_b16 a[142:143], v11 offset:18432
v_mfma_f32_16x16x32_bf16 a[216:219], a[132:135], a[28:31], a[216:219]
buffer_store_dwordx4 a[188:191], v224, s[4:7], s56 offen sc1
v_mfma_f32_16x16x32_bf16 a[224:227], a[128:131], a[32:35], a[224:227]
s_add_u32 s56, s56, 33792
v_mfma_f32_16x16x32_bf16 a[224:227], a[132:135], a[36:39], a[224:227]
v_mfma_f32_16x16x32_bf16 a[232:235], a[128:131], a[40:43], a[232:235]
v_mfma_f32_16x16x32_bf16 a[232:235], a[132:135], a[44:47], a[232:235]
v_mfma_f32_16x16x32_bf16 a[240:243], a[128:131], a[48:51], a[240:243]
v_mfma_f32_16x16x32_bf16 a[240:243], a[132:135], a[52:55], a[240:243]
v_mfma_f32_16x16x32_bf16 a[248:251], a[128:131], a[56:59], a[248:251]
s_waitcnt vmcnt(4) lgkmcnt(0)
v_mfma_f32_16x16x32_bf16 a[248:251], a[132:135], a[60:63], a[248:251]
s_barrier
v_mfma_f32_16x16x32_bf16 a[196:199], a[136:139], a[0:3], a[196:199]
s_add_u32 m0, s29, 65536
ds_read_b64_tr_b16 a[128:129], v4 offset:32768
v_mfma_f32_16x16x32_bf16 a[196:199], a[140:143], a[4:7], a[196:199]
buffer_load_dwordx4 v16, s[12:15], s26 offen offset:0 lds
v_mfma_f32_16x16x32_bf16 a[204:207], a[136:139], a[8:11], a[204:207]
ds_read_b64_tr_b16 a[130:131], v4 offset:34816
v_cmp_gt_u32 vcc, 0x100, v245
v_mfma_f32_16x16x32_bf16 a[204:207], a[140:143], a[12:15], a[204:207]
v_mfma_f32_16x16x32_bf16 a[212:215], a[136:139], a[16:19], a[212:215]
ds_read_b64_tr_b16 a[132:133], v4 offset:49152
v_mfma_f32_16x16x32_bf16 a[212:215], a[140:143], a[20:23], a[212:215]
buffer_load_dwordx4 v17, s[12:15], s26 offen offset:1024 lds
v_mfma_f32_16x16x32_bf16 a[220:223], a[136:139], a[24:27], a[220:223]
ds_read_b64_tr_b16 a[134:135], v4 offset:51200
v_mfma_f32_16x16x32_bf16 a[220:223], a[140:143], a[28:31], a[220:223]
v_mfma_f32_16x16x32_bf16 a[228:231], a[136:139], a[32:35], a[228:231]
v_mfma_f32_16x16x32_bf16 a[228:231], a[140:143], a[36:39], a[228:231]
buffer_load_dwordx4 v18, s[12:15], s26 offen offset:2048 lds
v_mfma_f32_16x16x32_bf16 a[236:239], a[136:139], a[40:43], a[236:239]
v_mfma_f32_16x16x32_bf16 a[236:239], a[140:143], a[44:47], a[236:239]
v_mfma_f32_16x16x32_bf16 a[244:247], a[136:139], a[48:51], a[244:247]
v_mfma_f32_16x16x32_bf16 a[244:247], a[140:143], a[52:55], a[244:247]
buffer_load_dwordx4 v19, s[12:15], s26 offen offset:3072 lds
v_mfma_f32_16x16x32_bf16 a[252:255], a[136:139], a[56:59], a[252:255]
s_add_u32 s26, s26, 524288
v_mfma_f32_16x16x32_bf16 a[252:255], a[140:143], a[60:63], a[252:255]
s_waitcnt lgkmcnt(0)
s_mov_b32 s82, s59
s_cbranch_vccnz M_cntspinK
s_branch Lg_1
Lg_1t:
PAD_4:
s_cbranch_execz M_tret
buffer_load_dword v230, v231, s[4:7], s52 offen sc1
v_mfma_f32_16x16x32_bf16 v[32:35], a[128:131], a[64:67], v[32:35]
s_add_u32 m0, s29, 81920
ds_read_b64_tr_b16 a[136:137], v5 offset:32768
v_mfma_f32_16x16x32_bf16 v[32:35], a[132:135], a[68:71], v[32:35]
buffer_load_dwordx4 v16, s[12:15], s27 offen offset:0 lds
v_mfma_f32_16x16x32_bf16 v[40:43], a[128:131], a[72:75], v[40:43]
s_and_b32 s44, s3, 1
ds_read_b64_tr_b16 a[138:139], v5 offset:34816
v_mfma_f32_16x16x32_bf16 v[40:43], a[132:135], a[76:79], v[40:43]
s_lshl_b32 s44, s44, 8
v_mfma_f32_16x16x32_bf16 v[48:51], a[128:131], a[80:83], v[48:51]
s_lshl_b32 s45, s3, 7
ds_read_b64_tr_b16 a[140:141], v5 offset:49152
v_mfma_f32_16x16x32_bf16 v[48:51], a[132:135], a[84:87], v[48:51]
s_xor_b32 s44, s44, s45
buffer_load_dwordx4 v17, s[12:15], s27 offen offset:1024 lds
v_mfma_f32_16x16x32_bf16 v[56:59], a[128:131], a[88:91], v[56:59]
s_xor_b32 s44, s44, 196608
ds_read_b64_tr_b16 a[142:143], v5 offset:51200
v_mfma_f32_16x16x32_bf16 v[56:59], a[132:135], a[92:95], v[56:59]
v_mfma_f32_16x16x32_bf16 v[64:67], a[128:131], a[96:99], v[64:67]
ds_read_b128 a[0:3], v2 offset:0
v_mfma_f32_16x16x32_bf16 v[64:67], a[132:135], a[100:103], v[64:67]
buffer_load_dwordx4 v18, s[12:15], s27 offen offset:2048 lds
v_mfma_f32_16x16x32_bf16 v[72:75], a[128:131], a[104:107], v[72:75]
ds_read_b128 a[4:7], v3 offset:0
v_mfma_f32_16x16x32_bf16 v[72:75], a[132:135], a[108:111], v[72:75]
v_mfma_f32_16x16x32_bf16 v[80:83], a[128:131], a[112:115], v[80:83]
v_mfma_f32_16x16x32_bf16 v[80:83], a[132:135], a[116:119], v[80:83]
buffer_load_dwordx4 v19, s[12:15], s27 offen offset:3072 lds
v_mfma_f32_16x16x32_bf16 v[88:91], a[128:131], a[120:123], v[88:91]
s_add_u32 s27, s27, 524288
ds_read_b128 a[8:11], v2 offset:2048
v_mfma_f32_16x16x32_bf16 v[88:91], a[132:135], a[124:127], v[88:91]
s_waitcnt lgkmcnt(3)
v_mfma_f32_16x16x32_bf16 v[36:39], a[136:139], a[64:67], v[36:39]
s_add_u32 m0, s28, 32768
ds_read_b64_tr_b16 a[128:129], v6 offset:32768
v_mfma_f32_16x16x32_bf16 v[36:39], a[140:143], a[68:71], v[36:39]
buffer_load_dwordx4 v12, s[8:11], s24 offen offset:0 lds
v_mfma_f32_16x16x32_bf16 v[44:47], a[136:139], a[72:75], v[44:47]
ds_read_b64_tr_b16 a[130:131], v6 offset:34816
v_mfma_f32_16x16x32_bf16 v[44:47], a[140:143], a[76:79], v[44:47]
v_mfma_f32_16x16x32_bf16 v[52:55], a[136:139], a[80:83], v[52:55]
s_mov_b64 s[56:57], s[72:73]
ds_read_b64_tr_b16 a[132:133], v6 offset:49152
v_mfma_f32_16x16x32_bf16 v[52:55], a[140:143], a[84:87], v[52:55]
s_mov_b32 s58, 1835008
buffer_load_dwordx4 v13, s[8:11], s24 offen offset:1024 lds
v_mfma_f32_16x16x32_bf16 v[60:63], a[136:139], a[88:91], v[60:63]
s_mov_b32 s59, 0x20000
ds_read_b64_tr_b16 a[134:135], v6 offset:51200
v_mfma_f32_16x16x32_bf16 v[60:63], a[140:143], a[92:95], v[60:63]
v_mfma_f32_16x16x32_bf16 v[68:71], a[136:139], a[96:99], v[68:71]
ds_read_b128 a[12:15], v3 offset:2048
v_mfma_f32_16x16x32_bf16 v[68:71], a[140:143], a[100:103], v[68:71]
buffer_load_dwordx4 v14, s[8:11], s24 offen offset:2048 lds
v_mfma_f32_16x16x32_bf16 v[76:79], a[136:139], a[104:107], v[76:79]
v_mfma_f32_16x16x32_bf16 v[76:79], a[140:143], a[108:111], v[76:79]
v_mfma_f32_16x16x32_bf16 v[84:87], a[136:139], a[112:115], v[84:87]
ds_read_b128 a[16:19], v2 offset:4096
v_mfma_f32_16x16x32_bf16 v[84:87], a[140:143], a[116:119], v[84:87]
buffer_load_dwordx4 v15, s[8:11], s24 offen offset:3072 lds
v_mfma_f32_16x16x32_bf16 v[92:95], a[136:139], a[120:123], v[92:95]
s_add_u32 s24, s24, 128
ds_read_b128 a[20:23], v3 offset:4096
v_mfma_f32_16x16x32_bf16 v[92:95], a[140:143], a[124:127], v[92:95]
s_waitcnt lgkmcnt(3)
v_mfma_f32_16x16x32_bf16 v[96:99], a[128:131], a[64:67], v[96:99]
s_add_u32 m0, s28, 36864
ds_read_b64_tr_b16 a[136:137], v7 offset:32768
v_mfma_f32_16x16x32_bf16 v[96:99], a[132:135], a[68:71], v[96:99]
buffer_load_dwordx4 v12, s[8:11], s25 offen offset:0 lds
v_mfma_f32_16x16x32_bf16 v[104:107], a[128:131], a[72:75], v[104:107]
ds_read_b64_tr_b16 a[138:139], v7 offset:34816
v_mfma_f32_16x16x32_bf16 v[104:107], a[132:135], a[76:79], v[104:107]
v_mfma_f32_16x16x32_bf16 v[112:115], a[128:131], a[80:83], v[112:115]
ds_read_b64_tr_b16 a[140:141], v7 offset:49152
v_mfma_f32_16x16x32_bf16 v[112:115], a[132:135], a[84:87], v[112:115]
buffer_load_dwordx4 v13, s[8:11], s25 offen offset:1024 lds
v_mfma_f32_16x16x32_bf16 v[120:123], a[128:131], a[88:91], v[120:123]
ds_read_b64_tr_b16 a[142:143], v7 offset:51200
v_mfma_f32_16x16x32_bf16 v[120:123], a[132:135], a[92:95], v[120:123]
v_mfma_f32_16x16x32_bf16 v[128:131], a[128:131], a[96:99], v[128:131]
v_mfma_f32_16x16x32_bf16 v[128:131], a[132:135], a[100:103], v[128:131]
buffer_load_dwordx4 v14, s[8:11], s25 offen offset:2048 lds
v_mfma_f32_16x16x32_bf16 v[136:139], a[128:131], a[104:107], v[136:139]
ds_read_b128 a[24:27], v2 offset:6144
v_mfma_f32_16x16x32_bf16 v[136:139], a[132:135], a[108:111], v[136:139]
v_mfma_f32_16x16x32_bf16 v[144:147], a[128:131], a[112:115], v[144:147]
ds_read_b128 a[28:31], v3 offset:6144
v_mfma_f32_16x16x32_bf16 v[144:147], a[132:135], a[116:119], v[144:147]
buffer_load_dwordx4 v15, s[8:11], s25 offen offset:3072 lds
v_mfma_f32_16x16x32_bf16 v[152:155], a[128:131], a[120:123], v[152:155]
s_add_u32 s25, s25, 128
s_waitcnt vmcnt(12)
v_mfma_f32_16x16x32_bf16 v[152:155], a[132:135], a[124:127], v[152:155]
s_waitcnt lgkmcnt(2)
v_cmp_gt_u32 vcc, 1, v230
v_mfma_f32_16x16x32_bf16 v[100:103], a[136:139], a[64:67], v[100:103]
s_cbranch_vccnz M_ppspinK
M_ppokK:
ds_read_b64_tr_b16 a[128:129], v8 offset:32768
v_mfma_f32_16x16x32_bf16 v[100:103], a[140:143], a[68:71], v[100:103]
buffer_load_dword v230, v229, s[4:7], s53 offen sc1
v_mfma_f32_16x16x32_bf16 v[108:111], a[136:139], a[72:75], v[108:111]
s_mov_b64 s[8:9], s[76:77]
ds_read_b64_tr_b16 a[130:131], v8 offset:34816
v_mfma_f32_16x16x32_bf16 v[108:111], a[140:143], a[76:79], v[108:111]
s_mov_b32 s10, 1835008
buffer_load_dword v230, v229, s[4:7], s48 offen sc1
v_mfma_f32_16x16x32_bf16 v[116:119], a[136:139], a[80:83], v[116:119]
s_lshl_b32 s24, s37, 2
ds_read_b64_tr_b16 a[132:133], v8 offset:49152
v_mfma_f32_16x16x32_bf16 v[116:119], a[140:143], a[84:87], v[116:119]
s_add_u32 s24, s24, s3
buffer_load_dword v230, v229, s[56:59], s49 offen
v_mfma_f32_16x16x32_bf16 v[124:127], a[136:139], a[88:91], v[124:127]
s_mul_i32 s24, s24, 28672
ds_read_b64_tr_b16 a[134:135], v8 offset:51200
v_mfma_f32_16x16x32_bf16 v[124:127], a[140:143], a[92:95], v[124:127]
s_mov_b32 s28, s29
buffer_load_dword v21, v20, s[16:19], s43 offen
v_mfma_f32_16x16x32_bf16 v[132:135], a[136:139], a[96:99], v[132:135]
ds_read_b128 a[32:35], v2 offset:8192
v_mfma_f32_16x16x32_bf16 v[132:135], a[140:143], a[100:103], v[132:135]
v_mfma_f32_16x16x32_bf16 v[140:143], a[136:139], a[104:107], v[140:143]
v_mfma_f32_16x16x32_bf16 v[140:143], a[140:143], a[108:111], v[140:143]
v_mfma_f32_16x16x32_bf16 v[148:151], a[136:139], a[112:115], v[148:151]
ds_read_b128 a[36:39], v3 offset:8192
v_lshrrev_b32 v28, 7, v1
v_mfma_f32_16x16x32_bf16 v[148:151], a[140:143], a[116:119], v[148:151]
v_lshrrev_b32 v29, 1, v28
v_lshlrev_b32 v29, 4, v29
v_mfma_f32_16x16x32_bf16 v[156:159], a[136:139], a[120:123], v[156:159]
ds_read_b128 a[40:43], v2 offset:10240
v_and_b32 v30, 0x70, v1
v_mfma_f32_16x16x32_bf16 v[156:159], a[140:143], a[124:127], v[156:159]
s_waitcnt lgkmcnt(3)
v_xor_b32 v29, v29, v30
v_mul_u32_u24 v28, 896, v28
v_mfma_f32_16x16x32_bf16 v[160:163], a[128:131], a[64:67], v[160:163]
ds_read_b64_tr_b16 a[136:137], v9 offset:32768
v_add_u32 v12, v28, v29
v_mfma_f32_16x16x32_bf16 v[160:163], a[132:135], a[68:71], v[160:163]
v_xor_b32 v29, 64, v29
v_add_u32 v28, v28, v29
v_mfma_f32_16x16x32_bf16 v[168:171], a[128:131], a[72:75], v[168:171]
ds_read_b64_tr_b16 a[138:139], v9 offset:34816
v_add_u32 v13, 6144, v28
v_mfma_f32_16x16x32_bf16 v[168:171], a[132:135], a[76:79], v[168:171]
v_add_u32 v14, 12288, v12
v_add_u32 v15, 18432, v28
v_mfma_f32_16x16x32_bf16 v[176:179], a[128:131], a[80:83], v[176:179]
ds_read_b64_tr_b16 a[140:141], v9 offset:49152
v_xor_b32 v22, s44, v4
v_mfma_f32_16x16x32_bf16 v[176:179], a[132:135], a[84:87], v[176:179]
v_xor_b32 v23, 32, v22
v_xor_b32 v24, 64, v22
v_mfma_f32_16x16x32_bf16 v[184:187], a[128:131], a[88:91], v[184:187]
ds_read_b64_tr_b16 a[142:143], v9 offset:51200
v_xor_b32 v25, 96, v22
v_mfma_f32_16x16x32_bf16 v[184:187], a[132:135], a[92:95], v[184:187]
v_mfma_f32_16x16x32_bf16 v[192:195], a[128:131], a[96:99], v[192:195]
v_mfma_f32_16x16x32_bf16 v[192:195], a[132:135], a[100:103], v[192:195]
v_mfma_f32_16x16x32_bf16 v[200:203], a[128:131], a[104:107], v[200:203]
ds_read_b128 a[44:47], v3 offset:10240
v_mfma_f32_16x16x32_bf16 v[200:203], a[132:135], a[108:111], v[200:203]
v_mfma_f32_16x16x32_bf16 v[208:211], a[128:131], a[112:115], v[208:211]
ds_read_b128 a[48:51], v2 offset:12288
v_mfma_f32_16x16x32_bf16 v[208:211], a[132:135], a[116:119], v[208:211]
v_mfma_f32_16x16x32_bf16 v[216:219], a[128:131], a[120:123], v[216:219]
v_mfma_f32_16x16x32_bf16 v[216:219], a[132:135], a[124:127], v[216:219]
s_waitcnt lgkmcnt(2)
v_mfma_f32_16x16x32_bf16 v[164:167], a[136:139], a[64:67], v[164:167]
ds_read_b64_tr_b16 a[128:129], v10 offset:32768
v_mfma_f32_16x16x32_bf16 v[164:167], a[140:143], a[68:71], v[164:167]
v_mfma_f32_16x16x32_bf16 v[172:175], a[136:139], a[72:75], v[172:175]
ds_read_b64_tr_b16 a[130:131], v10 offset:34816
v_mfma_f32_16x16x32_bf16 v[172:175], a[140:143], a[76:79], v[172:175]
v_mfma_f32_16x16x32_bf16 v[180:183], a[136:139], a[80:83], v[180:183]
ds_read_b64_tr_b16 a[132:133], v10 offset:49152
v_mfma_f32_16x16x32_bf16 v[180:183], a[140:143], a[84:87], v[180:183]
v_mfma_f32_16x16x32_bf16 v[188:191], a[136:139], a[88:91], v[188:191]
ds_read_b64_tr_b16 a[134:135], v10 offset:51200
v_mfma_f32_16x16x32_bf16 v[188:191], a[140:143], a[92:95], v[188:191]
v_mfma_f32_16x16x32_bf16 v[196:199], a[136:139], a[96:99], v[196:199]
ds_read_b128 a[52:55], v3 offset:12288
v_mfma_f32_16x16x32_bf16 v[196:199], a[140:143], a[100:103], v[196:199]
v_mfma_f32_16x16x32_bf16 v[204:207], a[136:139], a[104:107], v[204:207]
ds_read_b128 a[56:59], v2 offset:14336
v_mfma_f32_16x16x32_bf16 v[204:207], a[140:143], a[108:111], v[204:207]
v_mfma_f32_16x16x32_bf16 v[212:215], a[136:139], a[112:115], v[212:215]
v_mfma_f32_16x16x32_bf16 v[212:215], a[140:143], a[116:119], v[212:215]
v_mfma_f32_16x16x32_bf16 v[220:223], a[136:139], a[120:123], v[220:223]
ds_read_b128 a[60:63], v3 offset:14336
v_mfma_f32_16x16x32_bf16 v[220:223], a[140:143], a[124:127], v[220:223]
s_waitcnt lgkmcnt(3)
v_mfma_f32_16x16x32_bf16 a[192:195], a[128:131], a[64:67], a[192:195]
ds_read_b64_tr_b16 a[136:137], v11 offset:32768
v_mfma_f32_16x16x32_bf16 a[192:195], a[132:135], a[68:71], a[192:195]
v_mfma_f32_16x16x32_bf16 a[200:203], a[128:131], a[72:75], a[200:203]
ds_read_b64_tr_b16 a[138:139], v11 offset:34816
v_mfma_f32_16x16x32_bf16 a[200:203], a[132:135], a[76:79], a[200:203]
v_mfma_f32_16x16x32_bf16 a[208:211], a[128:131], a[80:83], a[208:211]
ds_read_b64_tr_b16 a[140:141], v11 offset:49152
v_mfma_f32_16x16x32_bf16 a[208:211], a[132:135], a[84:87], a[208:211]
v_mfma_f32_16x16x32_bf16 a[216:219], a[128:131], a[88:91], a[216:219]
ds_read_b64_tr_b16 a[142:143], v11 offset:51200
v_mfma_f32_16x16x32_bf16 a[216:219], a[132:135], a[92:95], a[216:219]
v_mfma_f32_16x16x32_bf16 a[224:227], a[128:131], a[96:99], a[224:227]
v_mfma_f32_16x16x32_bf16 a[224:227], a[132:135], a[100:103], a[224:227]
v_mfma_f32_16x16x32_bf16 a[232:235], a[128:131], a[104:107], a[232:235]
v_mfma_f32_16x16x32_bf16 a[232:235], a[132:135], a[108:111], a[232:235]
v_mfma_f32_16x16x32_bf16 a[240:243], a[128:131], a[112:115], a[240:243]
v_mfma_f32_16x16x32_bf16 a[240:243], a[132:135], a[116:119], a[240:243]
v_mfma_f32_16x16x32_bf16 a[248:251], a[128:131], a[120:123], a[248:251]
s_waitcnt vmcnt(4) lgkmcnt(0)
v_mfma_f32_16x16x32_bf16 a[248:251], a[132:135], a[124:127], a[248:251]
s_barrier
v_mfma_f32_16x16x32_bf16 a[196:199], a[136:139], a[64:67], a[196:199]
s_add_u32 m0, s29, 98304
ds_read_b64_tr_b16 a[128:129], v4 offset:0
v_mfma_f32_16x16x32_bf16 a[196:199], a[140:143], a[68:71], a[196:199]
buffer_load_dwordx4 v16, s[12:15], s26 offen offset:0 lds
v_mfma_f32_16x16x32_bf16 a[204:207], a[136:139], a[72:75], a[204:207]
ds_read_b64_tr_b16 a[130:131], v4 offset:2048
v_mfma_f32_16x16x32_bf16 a[204:207], a[140:143], a[76:79], a[204:207]
v_mfma_f32_16x16x32_bf16 a[212:215], a[136:139], a[80:83], a[212:215]
ds_read_b64_tr_b16 a[132:133], v4 offset:16384
v_mfma_f32_16x16x32_bf16 a[212:215], a[140:143], a[84:87], a[212:215]
buffer_load_dwordx4 v17, s[12:15], s26 offen offset:1024 lds
v_mfma_f32_16x16x32_bf16 a[220:223], a[136:139], a[88:91], a[220:223]
ds_read_b64_tr_b16 a[134:135], v4 offset:18432
v_mfma_f32_16x16x32_bf16 a[220:223], a[140:143], a[92:95], a[220:223]
v_mfma_f32_16x16x32_bf16 a[228:231], a[136:139], a[96:99], a[228:231]
v_mfma_f32_16x16x32_bf16 a[228:231], a[140:143], a[100:103], a[228:231]
buffer_load_dwordx4 v18, s[12:15], s26 offen offset:2048 lds
v_mfma_f32_16x16x32_bf16 a[236:239], a[136:139], a[104:107], a[236:239]
v_mfma_f32_16x16x32_bf16 a[236:239], a[140:143], a[108:111], a[236:239]
v_mfma_f32_16x16x32_bf16 a[244:247], a[136:139], a[112:115], a[244:247]
v_mfma_f32_16x16x32_bf16 a[244:247], a[140:143], a[116:119], a[244:247]
buffer_load_dwordx4 v19, s[12:15], s26 offen offset:3072 lds
v_mfma_f32_16x16x32_bf16 a[252:255], a[136:139], a[120:123], a[252:255]
s_add_u32 s26, s26, 524288
v_mfma_f32_16x16x32_bf16 a[252:255], a[140:143], a[124:127], a[252:255]
s_waitcnt lgkmcnt(0)
v_mfma_f32_16x16x32_bf16 v[32:35], a[128:131], a[0:3], v[32:35]
s_add_u32 m0, s29, 114688
ds_read_b64_tr_b16 a[136:137], v5 offset:0
v_mfma_f32_16x16x32_bf16 v[32:35], a[132:135], a[4:7], v[32:35]
buffer_load_dwordx4 v16, s[12:15], s27 offen offset:0 lds
v_mfma_f32_16x16x32_bf16 v[40:43], a[128:131], a[8:11], v[40:43]
ds_read_b64_tr_b16 a[138:139], v5 offset:2048
v_mfma_f32_16x16x32_bf16 v[40:43], a[132:135], a[12:15], v[40:43]
v_mfma_f32_16x16x32_bf16 v[48:51], a[128:131], a[16:19], v[48:51]
ds_read_b64_tr_b16 a[140:141], v5 offset:16384
v_mfma_f32_16x16x32_bf16 v[48:51], a[132:135], a[20:23], v[48:51]
buffer_load_dwordx4 v17, s[12:15], s27 offen offset:1024 lds
v_mfma_f32_16x16x32_bf16 v[56:59], a[128:131], a[24:27], v[56:59]
ds_read_b64_tr_b16 a[142:143], v5 offset:18432
v_mfma_f32_16x16x32_bf16 v[56:59], a[132:135], a[28:31], v[56:59]
v_mfma_f32_16x16x32_bf16 v[64:67], a[128:131], a[32:35], v[64:67]
ds_read_b128 a[64:67], v2 offset:32768
v_mfma_f32_16x16x32_bf16 v[64:67], a[132:135], a[36:39], v[64:67]
buffer_load_dwordx4 v18, s[12:15], s27 offen offset:2048 lds
v_mfma_f32_16x16x32_bf16 v[72:75], a[128:131], a[40:43], v[72:75]
ds_read_b128 a[68:71], v3 offset:32768
v_mfma_f32_16x16x32_bf16 v[72:75], a[132:135], a[44:47], v[72:75]
v_mfma_f32_16x16x32_bf16 v[80:83], a[128:131], a[48:51], v[80:83]
v_mfma_f32_16x16x32_bf16 v[80:83], a[132:135], a[52:55], v[80:83]
buffer_load_dwordx4 v19, s[12:15], s27 offen offset:3072 lds
v_mfma_f32_16x16x32_bf16 v[88:91], a[128:131], a[56:59], v[88:91]
s_add_u32 s27, s27, 524288
ds_read_b128 a[72:75], v2 offset:34816
v_mfma_f32_16x16x32_bf16 v[88:91], a[132:135], a[60:63], v[88:91]
s_waitcnt lgkmcnt(3)
v_mfma_f32_16x16x32_bf16 v[36:39], a[136:139], a[0:3], v[36:39]
s_add_u32 m0, s28, 0
ds_read_b64_tr_b16 a[128:129], v6 offset:0
v_mfma_f32_16x16x32_bf16 v[36:39], a[140:143], a[4:7], v[36:39]
buffer_load_dwordx4 v12, s[8:11], s24 offen offset:0 lds
v_mfma_f32_16x16x32_bf16 v[44:47], a[136:139], a[8:11], v[44:47]
ds_read_b64_tr_b16 a[130:131], v6 offset:2048
v_mfma_f32_16x16x32_bf16 v[44:47], a[140:143], a[12:15], v[44:47]
v_mfma_f32_16x16x32_bf16 v[52:55], a[136:139], a[16:19], v[52:55]
ds_read_b64_tr_b16 a[132:133], v6 offset:16384
v_mfma_f32_16x16x32_bf16 v[52:55], a[140:143], a[20:23], v[52:55]
buffer_load_dwordx4 v13, s[8:11], s24 offen offset:1024 lds
v_mfma_f32_16x16x32_bf16 v[60:63], a[136:139], a[24:27], v[60:63]
ds_read_b64_tr_b16 a[134:135], v6 offset:18432
v_mfma_f32_16x16x32_bf16 v[60:63], a[140:143], a[28:31], v[60:63]
v_mfma_f32_16x16x32_bf16 v[68:71], a[136:139], a[32:35], v[68:71]
ds_read_b128 a[76:79], v3 offset:34816
v_mfma_f32_16x16x32_bf16 v[68:71], a[140:143], a[36:39], v[68:71]
buffer_load_dwordx4 v14, s[8:11], s24 offen offset:2048 lds
v_mfma_f32_16x16x32_bf16 v[76:79], a[136:139], a[40:43], v[76:79]
v_mfma_f32_16x16x32_bf16 v[76:79], a[140:143], a[44:47], v[76:79]
v_mfma_f32_16x16x32_bf16 v[84:87], a[136:139], a[48:51], v[84:87]
ds_read_b128 a[80:83], v2 offset:36864
v_mfma_f32_16x16x32_bf16 v[84:87], a[140:143], a[52:55], v[84:87]
buffer_load_dwordx4 v15, s[8:11], s24 offen offset:3072 lds
v_mfma_f32_16x16x32_bf16 v[92:95], a[136:139], a[56:59], v[92:95]
s_add_u32 s24, s24, 128
ds_read_b128 a[84:87], v3 offset:36864
v_mfma_f32_16x16x32_bf16 v[92:95], a[140:143], a[60:63], v[92:95]
s_waitcnt lgkmcnt(3)
s_mov_b64 s[12:13], s[80:81]
v_mfma_f32_16x16x32_bf16 v[96:99], a[128:131], a[0:3], v[96:99]
s_mov_b32 s14, 3670016
s_add_u32 m0, s28, 16384
ds_read_b64_tr_b16 a[136:137], v7 offset:0
v_mfma_f32_16x16x32_bf16 v[96:99], a[132:135], a[4:7], v[96:99]
buffer_load_dwordx4 v12, s[8:11], s24 offen offset:0 lds
v_mfma_f32_16x16x32_bf16 v[104:107], a[128:131], a[8:11], v[104:107]
ds_read_b64_tr_b16 a[138:139], v7 offset:2048
v_mfma_f32_16x16x32_bf16 v[104:107], a[132:135], a[12:15], v[104:107]
v_mfma_f32_16x16x32_bf16 v[112:115], a[128:131], a[16:19], v[112:115]
ds_read_b64_tr_b16 a[140:141], v7 offset:16384
v_mfma_f32_16x16x32_bf16 v[112:115], a[132:135], a[20:23], v[112:115]
buffer_load_dwordx4 v13, s[8:11], s24 offen offset:1024 lds
v_mfma_f32_16x16x32_bf16 v[120:123], a[128:131], a[24:27], v[120:123]
ds_read_b64_tr_b16 a[142:143], v7 offset:18432
v_mfma_f32_16x16x32_bf16 v[120:123], a[132:135], a[28:31], v[120:123]
v_mfma_f32_16x16x32_bf16 v[128:131], a[128:131], a[32:35], v[128:131]
v_mfma_f32_16x16x32_bf16 v[128:131], a[132:135], a[36:39], v[128:131]
buffer_load_dwordx4 v14, s[8:11], s24 offen offset:2048 lds
v_mfma_f32_16x16x32_bf16 v[136:139], a[128:131], a[40:43], v[136:139]
ds_read_b128 a[88:91], v2 offset:38912
v_mfma_f32_16x16x32_bf16 v[136:139], a[132:135], a[44:47], v[136:139]
v_mfma_f32_16x16x32_bf16 v[144:147], a[128:131], a[48:51], v[144:147]
ds_read_b128 a[92:95], v3 offset:38912
v_mfma_f32_16x16x32_bf16 v[144:147], a[132:135], a[52:55], v[144:147]
buffer_load_dwordx4 v15, s[8:11], s24 offen offset:3072 lds
v_mfma_f32_16x16x32_bf16 v[152:155], a[128:131], a[56:59], v[152:155]
s_add_u32 s24, s24, 128
v_mfma_f32_16x16x32_bf16 v[152:155], a[132:135], a[60:63], v[152:155]
s_waitcnt lgkmcnt(2)
s_sub_u32 s26, s26, 8388608
v_mfma_f32_16x16x32_bf16 v[100:103], a[136:139], a[0:3], v[100:103]
s_sub_u32 s27, s27, 8388608
s_add_u32 m0, s29, 131072
ds_read_b64_tr_b16 a[128:129], v8 offset:0
v_mfma_f32_16x16x32_bf16 v[100:103], a[140:143], a[4:7], v[100:103]
PAD_5:
s_cbranch_execz M_tret
buffer_load_dwordx4 v16, s[12:15], s26 offen offset:0 lds
v_mfma_f32_16x16x32_bf16 v[108:111], a[136:139], a[8:11], v[108:111]
ds_read_b64_tr_b16 a[130:131], v8 offset:2048
v_mfma_f32_16x16x32_bf16 v[108:111], a[140:143], a[12:15], v[108:111]
v_mfma_f32_16x16x32_bf16 v[116:119], a[136:139], a[16:19], v[116:119]
ds_read_b64_tr_b16 a[132:133], v8 offset:16384
v_mfma_f32_16x16x32_bf16 v[116:119], a[140:143], a[20:23], v[116:119]
buffer_load_dwordx4 v17, s[12:15], s26 offen offset:1024 lds
v_mfma_f32_16x16x32_bf16 v[124:127], a[136:139], a[24:27], v[124:127]
ds_read_b64_tr_b16 a[134:135], v8 offset:18432
v_mfma_f32_16x16x32_bf16 v[124:127], a[140:143], a[28:31], v[124:127]
v_mfma_f32_16x16x32_bf16 v[132:135], a[136:139], a[32:35], v[132:135]
ds_read_b128 a[96:99], v2 offset:40960
v_mfma_f32_16x16x32_bf16 v[132:135], a[140:143], a[36:39], v[132:135]
buffer_load_dwordx4 v18, s[12:15], s26 offen offset:2048 lds
v_mfma_f32_16x16x32_bf16 v[140:143], a[136:139], a[40:43], v[140:143]
v_mfma_f32_16x16x32_bf16 v[140:143], a[140:143], a[44:47], v[140:143]
v_mfma_f32_16x16x32_bf16 v[148:151], a[136:139], a[48:51], v[148:151]
ds_read_b128 a[100:103], v3 offset:40960
v_mfma_f32_16x16x32_bf16 v[148:151], a[140:143], a[52:55], v[148:151]
buffer_load_dwordx4 v19, s[12:15], s26 offen offset:3072 lds
v_mfma_f32_16x16x32_bf16 v[156:159], a[136:139], a[56:59], v[156:159]
s_add_u32 s26, s26, 524288
ds_read_b128 a[104:107], v2 offset:43008
v_mfma_f32_16x16x32_bf16 v[156:159], a[140:143], a[60:63], v[156:159]
s_waitcnt lgkmcnt(3)
v_mfma_f32_16x16x32_bf16 v[160:163], a[128:131], a[0:3], v[160:163]
s_add_u32 m0, s29, 147456
ds_read_b64_tr_b16 a[136:137], v9 offset:0
v_mfma_f32_16x16x32_bf16 v[160:163], a[132:135], a[4:7], v[160:163]
buffer_load_dwordx4 v16, s[12:15], s27 offen offset:0 lds
v_mfma_f32_16x16x32_bf16 v[168:171], a[128:131], a[8:11], v[168:171]
ds_read_b64_tr_b16 a[138:139], v9 offset:2048
v_mfma_f32_16x16x32_bf16 v[168:171], a[132:135], a[12:15], v[168:171]
v_mfma_f32_16x16x32_bf16 v[176:179], a[128:131], a[16:19], v[176:179]
ds_read_b64_tr_b16 a[140:141], v9 offset:16384
v_mfma_f32_16x16x32_bf16 v[176:179], a[132:135], a[20:23], v[176:179]
buffer_load_dwordx4 v17, s[12:15], s27 offen offset:1024 lds
v_mfma_f32_16x16x32_bf16 v[184:187], a[128:131], a[24:27], v[184:187]
ds_read_b64_tr_b16 a[142:143], v9 offset:18432
v_mfma_f32_16x16x32_bf16 v[184:187], a[132:135], a[28:31], v[184:187]
v_mfma_f32_16x16x32_bf16 v[192:195], a[128:131], a[32:35], v[192:195]
v_mfma_f32_16x16x32_bf16 v[192:195], a[132:135], a[36:39], v[192:195]
buffer_load_dwordx4 v18, s[12:15], s27 offen offset:2048 lds
v_mfma_f32_16x16x32_bf16 v[200:203], a[128:131], a[40:43], v[200:203]
ds_read_b128 a[108:111], v3 offset:43008
v_mfma_f32_16x16x32_bf16 v[200:203], a[132:135], a[44:47], v[200:203]
v_mfma_f32_16x16x32_bf16 v[208:211], a[128:131], a[48:51], v[208:211]
ds_read_b128 a[112:115], v2 offset:45056
v_mfma_f32_16x16x32_bf16 v[208:211], a[132:135], a[52:55], v[208:211]
buffer_load_dwordx4 v19, s[12:15], s27 offen offset:3072 lds
v_mfma_f32_16x16x32_bf16 v[216:219], a[128:131], a[56:59], v[216:219]
s_add_u32 s27, s27, 524288
v_mfma_f32_16x16x32_bf16 v[216:219], a[132:135], a[60:63], v[216:219]
s_waitcnt lgkmcnt(2)
v_mfma_f32_16x16x32_bf16 v[164:167], a[136:139], a[0:3], v[164:167]
ds_read_b64_tr_b16 a[128:129], v10 offset:0
v_mfma_f32_16x16x32_bf16 v[164:167], a[140:143], a[4:7], v[164:167]
v_mfma_f32_16x16x32_bf16 v[172:175], a[136:139], a[8:11], v[172:175]
ds_read_b64_tr_b16 a[130:131], v10 offset:2048
v_mfma_f32_16x16x32_bf16 v[172:175], a[140:143], a[12:15], v[172:175]
v_mfma_f32_16x16x32_bf16 v[180:183], a[136:139], a[16:19], v[180:183]
ds_read_b64_tr_b16 a[132:133], v10 offset:16384
v_mfma_f32_16x16x32_bf16 v[180:183], a[140:143], a[20:23], v[180:183]
v_mfma_f32_16x16x32_bf16 v[188:191], a[136:139], a[24:27], v[188:191]
ds_read_b64_tr_b16 a[134:135], v10 offset:18432
v_mfma_f32_16x16x32_bf16 v[188:191], a[140:143], a[28:31], v[188:191]
v_mfma_f32_16x16x32_bf16 v[196:199], a[136:139], a[32:35], v[196:199]
ds_read_b128 a[116:119], v3 offset:45056
v_mfma_f32_16x16x32_bf16 v[196:199], a[140:143], a[36:39], v[196:199]
v_mfma_f32_16x16x32_bf16 v[204:207], a[136:139], a[40:43], v[204:207]
ds_read_b128 a[120:123], v2 offset:47104
v_mfma_f32_16x16x32_bf16 v[204:207], a[140:143], a[44:47], v[204:207]
v_mfma_f32_16x16x32_bf16 v[212:215], a[136:139], a[48:51], v[212:215]
v_mfma_f32_16x16x32_bf16 v[212:215], a[140:143], a[52:55], v[212:215]
v_mfma_f32_16x16x32_bf16 v[220:223], a[136:139], a[56:59], v[220:223]
ds_read_b128 a[124:127], v3 offset:47104
v_mfma_f32_16x16x32_bf16 v[220:223], a[140:143], a[60:63], v[220:223]
s_waitcnt lgkmcnt(3)
v_mfma_f32_16x16x32_bf16 a[192:195], a[128:131], a[0:3], a[192:195]
ds_read_b64_tr_b16 a[136:137], v11 offset:0
v_mfma_f32_16x16x32_bf16 a[192:195], a[132:135], a[4:7], a[192:195]
v_mfma_f32_16x16x32_bf16 a[200:203], a[128:131], a[8:11], a[200:203]
ds_read_b64_tr_b16 a[138:139], v11 offset:2048
v_mfma_f32_16x16x32_bf16 a[200:203], a[132:135], a[12:15], a[200:203]
v_mfma_f32_16x16x32_bf16 a[208:211], a[128:131], a[16:19], a[208:211]
ds_read_b64_tr_b16 a[140:141], v11 offset:16384
v_mfma_f32_16x16x32_bf16 a[208:211], a[132:135], a[20:23], a[208:211]
v_mfma_f32_16x16x32_bf16 a[216:219], a[128:131], a[24:27], a[216:219]
ds_read_b64_tr_b16 a[142:143], v11 offset:18432
v_mfma_f32_16x16x32_bf16 a[216:219], a[132:135], a[28:31], a[216:219]
v_mfma_f32_16x16x32_bf16 a[224:227], a[128:131], a[32:35], a[224:227]
v_mfma_f32_16x16x32_bf16 a[224:227], a[132:135], a[36:39], a[224:227]
v_mfma_f32_16x16x32_bf16 a[232:235], a[128:131], a[40:43], a[232:235]
v_mfma_f32_16x16x32_bf16 a[232:235], a[132:135], a[44:47], a[232:235]
v_mfma_f32_16x16x32_bf16 a[240:243], a[128:131], a[48:51], a[240:243]
v_mfma_f32_16x16x32_bf16 a[240:243], a[132:135], a[52:55], a[240:243]
v_mfma_f32_16x16x32_bf16 a[248:251], a[128:131], a[56:59], a[248:251]
s_waitcnt vmcnt(12) lgkmcnt(0)
v_mfma_f32_16x16x32_bf16 a[248:251], a[132:135], a[60:63], a[248:251]
s_barrier
v_mfma_f32_16x16x32_bf16 a[196:199], a[136:139], a[0:3], a[196:199]
s_add_u32 m0, s28, 32768
ds_read_b64_tr_b16 a[128:129], v4 offset:32768
v_mfma_f32_16x16x32_bf16 a[196:199], a[140:143], a[4:7], a[196:199]
s_lshr_b32 s22, s3, 1
buffer_load_dwordx4 v12, s[8:11], s24 offen offset:0 lds
v_mfma_f32_16x16x32_bf16 a[204:207], a[136:139], a[8:11], a[204:207]
s_lshl_b32 s22, s22, 14
ds_read_b64_tr_b16 a[130:131], v4 offset:34816
v_subrev_u32 v2, s22, v2
v_mfma_f32_16x16x32_bf16 a[204:207], a[140:143], a[12:15], a[204:207]
v_subrev_u32 v3, s22, v3
v_mfma_f32_16x16x32_bf16 a[212:215], a[136:139], a[16:19], a[212:215]
ds_read_b64_tr_b16 a[132:133], v4 offset:49152
v_mfma_f32_16x16x32_bf16 a[212:215], a[140:143], a[20:23], a[212:215]
buffer_load_dwordx4 v13, s[8:11], s24 offen offset:1024 lds
v_mfma_f32_16x16x32_bf16 a[220:223], a[136:139], a[24:27], a[220:223]
ds_read_b64_tr_b16 a[134:135], v4 offset:51200
v_mfma_f32_16x16x32_bf16 a[220:223], a[140:143], a[28:31], a[220:223]
v_mfma_f32_16x16x32_bf16 a[228:231], a[136:139], a[32:35], a[228:231]
v_mfma_f32_16x16x32_bf16 a[228:231], a[140:143], a[36:39], a[228:231]
buffer_load_dwordx4 v14, s[8:11], s24 offen offset:2048 lds
v_mfma_f32_16x16x32_bf16 a[236:239], a[136:139], a[40:43], a[236:239]
v_mfma_f32_16x16x32_bf16 a[236:239], a[140:143], a[44:47], a[236:239]
v_mfma_f32_16x16x32_bf16 a[244:247], a[136:139], a[48:51], a[244:247]
v_mfma_f32_16x16x32_bf16 a[244:247], a[140:143], a[52:55], a[244:247]
buffer_load_dwordx4 v15, s[8:11], s24 offen offset:3072 lds
v_mfma_f32_16x16x32_bf16 a[252:255], a[136:139], a[56:59], a[252:255]
s_add_u32 s24, s24, 128
v_mfma_f32_16x16x32_bf16 a[252:255], a[140:143], a[60:63], a[252:255]
s_waitcnt lgkmcnt(0)
v_mfma_f32_16x16x32_bf16 v[32:35], a[128:131], a[64:67], v[32:35]
s_add_u32 m0, s29, 65536
ds_read_b64_tr_b16 a[136:137], v5 offset:32768
v_mfma_f32_16x16x32_bf16 v[32:35], a[132:135], a[68:71], v[32:35]
buffer_load_dwordx4 v16, s[12:15], s26 offen offset:0 lds
v_mfma_f32_16x16x32_bf16 v[40:43], a[128:131], a[72:75], v[40:43]
ds_read_b64_tr_b16 a[138:139], v5 offset:34816
v_mfma_f32_16x16x32_bf16 v[40:43], a[132:135], a[76:79], v[40:43]
v_mfma_f32_16x16x32_bf16 v[48:51], a[128:131], a[80:83], v[48:51]
ds_read_b64_tr_b16 a[140:141], v5 offset:49152
v_mfma_f32_16x16x32_bf16 v[48:51], a[132:135], a[84:87], v[48:51]
buffer_load_dwordx4 v17, s[12:15], s26 offen offset:1024 lds
v_mfma_f32_16x16x32_bf16 v[56:59], a[128:131], a[88:91], v[56:59]
ds_read_b64_tr_b16 a[142:143], v5 offset:51200
v_mfma_f32_16x16x32_bf16 v[56:59], a[132:135], a[92:95], v[56:59]
v_mfma_f32_16x16x32_bf16 v[64:67], a[128:131], a[96:99], v[64:67]
ds_read_b128 a[0:3], v2 offset:0
v_mfma_f32_16x16x32_bf16 v[64:67], a[132:135], a[100:103], v[64:67]
buffer_load_dwordx4 v18, s[12:15], s26 offen offset:2048 lds
v_mfma_f32_16x16x32_bf16 v[72:75], a[128:131], a[104:107], v[72:75]
ds_read_b128 a[4:7], v3 offset:0
v_mfma_f32_16x16x32_bf16 v[72:75], a[132:135], a[108:111], v[72:75]
v_mfma_f32_16x16x32_bf16 v[80:83], a[128:131], a[112:115], v[80:83]
v_mfma_f32_16x16x32_bf16 v[80:83], a[132:135], a[116:119], v[80:83]
buffer_load_dwordx4 v19, s[12:15], s26 offen offset:3072 lds
v_mfma_f32_16x16x32_bf16 v[88:91], a[128:131], a[120:123], v[88:91]
s_add_u32 s26, s26, 524288
ds_read_b128 a[8:11], v2 offset:2048
v_mfma_f32_16x16x32_bf16 v[88:91], a[132:135], a[124:127], v[88:91]
s_waitcnt lgkmcnt(3)
v_mfma_f32_16x16x32_bf16 v[36:39], a[136:139], a[64:67], v[36:39]
s_add_u32 m0, s29, 81920
ds_read_b64_tr_b16 a[128:129], v6 offset:32768
v_mfma_f32_16x16x32_bf16 v[36:39], a[140:143], a[68:71], v[36:39]
buffer_load_dwordx4 v16, s[12:15], s27 offen offset:0 lds
v_mfma_f32_16x16x32_bf16 v[44:47], a[136:139], a[72:75], v[44:47]
ds_read_b64_tr_b16 a[130:131], v6 offset:34816
v_mfma_f32_16x16x32_bf16 v[44:47], a[140:143], a[76:79], v[44:47]
v_mfma_f32_16x16x32_bf16 v[52:55], a[136:139], a[80:83], v[52:55]
ds_read_b64_tr_b16 a[132:133], v6 offset:49152
v_mfma_f32_16x16x32_bf16 v[52:55], a[140:143], a[84:87], v[52:55]
buffer_load_dwordx4 v17, s[12:15], s27 offen offset:1024 lds
v_mfma_f32_16x16x32_bf16 v[60:63], a[136:139], a[88:91], v[60:63]
ds_read_b64_tr_b16 a[134:135], v6 offset:51200
v_cvt_pk_bf16_f32 v32, v32, v33
v_mfma_f32_16x16x32_bf16 v[60:63], a[140:143], a[92:95], v[60:63]
v_cvt_pk_bf16_f32 v33, v34, v35
v_cvt_pk_bf16_f32 v34, v36, v37
v_mfma_f32_16x16x32_bf16 v[68:71], a[136:139], a[96:99], v[68:71]
ds_read_b128 a[12:15], v3 offset:2048
v_cvt_pk_bf16_f32 v35, v38, v39
v_mfma_f32_16x16x32_bf16 v[68:71], a[140:143], a[100:103], v[68:71]
buffer_load_dwordx4 v18, s[12:15], s27 offen offset:2048 lds
v_mfma_f32_16x16x32_bf16 v[76:79], a[136:139], a[104:107], v[76:79]
v_cvt_pk_bf16_f32 v40, v40, v41
v_cvt_pk_bf16_f32 v41, v42, v43
v_mfma_f32_16x16x32_bf16 v[76:79], a[140:143], a[108:111], v[76:79]
v_cvt_pk_bf16_f32 v42, v44, v45
v_cvt_pk_bf16_f32 v43, v46, v47
v_mfma_f32_16x16x32_bf16 v[84:87], a[136:139], a[112:115], v[84:87]
ds_read_b128 a[16:19], v2 offset:4096
v_cvt_pk_bf16_f32 v48, v48, v49
v_mfma_f32_16x16x32_bf16 v[84:87], a[140:143], a[116:119], v[84:87]
buffer_load_dwordx4 v19, s[12:15], s27 offen offset:3072 lds
v_mfma_f32_16x16x32_bf16 v[92:95], a[136:139], a[120:123], v[92:95]
s_add_u32 s27, s27, 524288
ds_read_b128 a[20:23], v3 offset:4096
v_cvt_pk_bf16_f32 v49, v50, v51
v_mfma_f32_16x16x32_bf16 v[92:95], a[140:143], a[124:127], v[92:95]
s_waitcnt lgkmcnt(3)
v_cvt_pk_bf16_f32 v50, v52, v53
v_cvt_pk_bf16_f32 v51, v54, v55
v_mfma_f32_16x16x32_bf16 v[96:99], a[128:131], a[64:67], v[96:99]
s_add_u32 m0, s28, 49152
ds_read_b64_tr_b16 a[136:137], v7 offset:32768
v_cvt_pk_bf16_f32 v56, v56, v57
v_mfma_f32_16x16x32_bf16 v[96:99], a[132:135], a[68:71], v[96:99]
buffer_load_dwordx4 v12, s[8:11], s24 offen offset:0 lds
v_mfma_f32_16x16x32_bf16 v[104:107], a[128:131], a[72:75], v[104:107]
ds_read_b64_tr_b16 a[138:139], v7 offset:34816
v_cvt_pk_bf16_f32 v57, v58, v59
v_mfma_f32_16x16x32_bf16 v[104:107], a[132:135], a[76:79], v[104:107]
v_cvt_pk_bf16_f32 v58, v60, v61
v_cvt_pk_bf16_f32 v59, v62, v63
v_mfma_f32_16x16x32_bf16 v[112:115], a[128:131], a[80:83], v[112:115]
ds_read_b64_tr_b16 a[140:141], v7 offset:49152
v_cvt_pk_bf16_f32 v64, v64, v65
v_mfma_f32_16x16x32_bf16 v[112:115], a[132:135], a[84:87], v[112:115]
buffer_load_dwordx4 v13, s[8:11], s24 offen offset:1024 lds
v_mfma_f32_16x16x32_bf16 v[120:123], a[128:131], a[88:91], v[120:123]
ds_read_b64_tr_b16 a[142:143], v7 offset:51200
v_cvt_pk_bf16_f32 v65, v66, v67
v_mfma_f32_16x16x32_bf16 v[120:123], a[132:135], a[92:95], v[120:123]
v_cvt_pk_bf16_f32 v66, v68, v69
v_cvt_pk_bf16_f32 v67, v70, v71
v_mfma_f32_16x16x32_bf16 v[128:131], a[128:131], a[96:99], v[128:131]
v_cvt_pk_bf16_f32 v72, v72, v73
v_cvt_pk_bf16_f32 v73, v74, v75
v_mfma_f32_16x16x32_bf16 v[128:131], a[132:135], a[100:103], v[128:131]
buffer_load_dwordx4 v14, s[8:11], s24 offen offset:2048 lds
v_mfma_f32_16x16x32_bf16 v[136:139], a[128:131], a[104:107], v[136:139]
ds_read_b128 a[24:27], v2 offset:6144
v_cvt_pk_bf16_f32 v74, v76, v77
v_mfma_f32_16x16x32_bf16 v[136:139], a[132:135], a[108:111], v[136:139]
buffer_store_dwordx4 v[32:35], v1, s[4:7], s31 offen sc1
v_mfma_f32_16x16x32_bf16 v[144:147], a[128:131], a[112:115], v[144:147]
s_add_u32 s31, s31, s32
ds_read_b128 a[28:31], v3 offset:6144
v_cvt_pk_bf16_f32 v75, v78, v79
v_mfma_f32_16x16x32_bf16 v[144:147], a[132:135], a[116:119], v[144:147]
buffer_load_dwordx4 v15, s[8:11], s24 offen offset:3072 lds
v_mfma_f32_16x16x32_bf16 v[152:155], a[128:131], a[120:123], v[152:155]
s_add_u32 s24, s24, 128
v_cvt_pk_bf16_f32 v80, v80, v81
v_cvt_pk_bf16_f32 v81, v82, v83
v_mfma_f32_16x16x32_bf16 v[152:155], a[132:135], a[124:127], v[152:155]
s_waitcnt lgkmcnt(2)
v_cvt_pk_bf16_f32 v82, v84, v85
v_cvt_pk_bf16_f32 v83, v86, v87
v_mfma_f32_16x16x32_bf16 v[100:103], a[136:139], a[64:67], v[100:103]
ds_read_b64_tr_b16 a[128:129], v8 offset:32768
v_cvt_pk_bf16_f32 v88, v88, v89
v_mfma_f32_16x16x32_bf16 v[100:103], a[140:143], a[68:71], v[100:103]
v_cvt_pk_bf16_f32 v89, v90, v91
v_cvt_pk_bf16_f32 v90, v92, v93
v_mfma_f32_16x16x32_bf16 v[108:111], a[136:139], a[72:75], v[108:111]
ds_read_b64_tr_b16 a[130:131], v8 offset:34816
v_cvt_pk_bf16_f32 v91, v94, v95
v_mfma_f32_16x16x32_bf16 v[108:111], a[140:143], a[76:79], v[108:111]
buffer_store_dwordx4 v[40:43], v1, s[4:7], s31 offen sc1
v_mfma_f32_16x16x32_bf16 v[116:119], a[136:139], a[80:83], v[116:119]
s_add_u32 s31, s31, s33
ds_read_b64_tr_b16 a[132:133], v8 offset:49152
v_mfma_f32_16x16x32_bf16 v[116:119], a[140:143], a[84:87], v[116:119]
v_mfma_f32_16x16x32_bf16 v[124:127], a[136:139], a[88:91], v[124:127]
ds_read_b64_tr_b16 a[134:135], v8 offset:51200
v_cvt_pk_bf16_f32 v96, v96, v97
v_mfma_f32_16x16x32_bf16 v[124:127], a[140:143], a[92:95], v[124:127]
v_cvt_pk_bf16_f32 v97, v98, v99
v_cvt_pk_bf16_f32 v98, v100, v101
v_mfma_f32_16x16x32_bf16 v[132:135], a[136:139], a[96:99], v[132:135]
ds_read_b128 a[32:35], v2 offset:8192
v_cvt_pk_bf16_f32 v99, v102, v103
v_mfma_f32_16x16x32_bf16 v[132:135], a[140:143], a[100:103], v[132:135]
v_cvt_pk_bf16_f32 v104, v104, v105
v_cvt_pk_bf16_f32 v105, v106, v107
v_mfma_f32_16x16x32_bf16 v[140:143], a[136:139], a[104:107], v[140:143]
v_cvt_pk_bf16_f32 v106, v108, v109
v_cvt_pk_bf16_f32 v107, v110, v111
v_mfma_f32_16x16x32_bf16 v[140:143], a[140:143], a[108:111], v[140:143]
v_cvt_pk_bf16_f32 v112, v112, v113
v_cvt_pk_bf16_f32 v113, v114, v115
v_mfma_f32_16x16x32_bf16 v[148:151], a[136:139], a[112:115], v[148:151]
ds_read_b128 a[36:39], v3 offset:8192
v_cvt_pk_bf16_f32 v114, v116, v117
v_mfma_f32_16x16x32_bf16 v[148:151], a[140:143], a[116:119], v[148:151]
v_cvt_pk_bf16_f32 v115, v118, v119
v_cvt_pk_bf16_f32 v120, v120, v121
v_mfma_f32_16x16x32_bf16 v[156:159], a[136:139], a[120:123], v[156:159]
ds_read_b128 a[40:43], v2 offset:10240
v_cvt_pk_bf16_f32 v121, v122, v123
v_mfma_f32_16x16x32_bf16 v[156:159], a[140:143], a[124:127], v[156:159]
s_waitcnt lgkmcnt(3)
buffer_store_dwordx4 v[48:51], v1, s[4:7], s31 offen sc1
v_mfma_f32_16x16x32_bf16 v[160:163], a[128:131], a[64:67], v[160:163]
s_add_u32 s31, s31, s32
ds_read_b64_tr_b16 a[136:137], v9 offset:32768
v_cvt_pk_bf16_f32 v122, v124, v125
v_mfma_f32_16x16x32_bf16 v[160:163], a[132:135], a[68:71], v[160:163]
v_cvt_pk_bf16_f32 v123, v126, v127
v_cvt_pk_bf16_f32 v128, v128, v129
v_mfma_f32_16x16x32_bf16 v[168:171], a[128:131], a[72:75], v[168:171]
ds_read_b64_tr_b16 a[138:139], v9 offset:34816
v_cvt_pk_bf16_f32 v129, v130, v131
v_mfma_f32_16x16x32_bf16 v[168:171], a[132:135], a[76:79], v[168:171]
v_cvt_pk_bf16_f32 v130, v132, v133
v_cvt_pk_bf16_f32 v131, v134, v135
v_mfma_f32_16x16x32_bf16 v[176:179], a[128:131], a[80:83], v[176:179]
ds_read_b64_tr_b16 a[140:141], v9 offset:49152
v_cvt_pk_bf16_f32 v136, v136, v137
v_mfma_f32_16x16x32_bf16 v[176:179], a[132:135], a[84:87], v[176:179]
v_cvt_pk_bf16_f32 v137, v138, v139
v_cvt_pk_bf16_f32 v138, v140, v141
v_mfma_f32_16x16x32_bf16 v[184:187], a[128:131], a[88:91], v[184:187]
ds_read_b64_tr_b16 a[142:143], v9 offset:51200
v_cvt_pk_bf16_f32 v139, v142, v143
v_mfma_f32_16x16x32_bf16 v[184:187], a[132:135], a[92:95], v[184:187]
v_cvt_pk_bf16_f32 v144, v144, v145
v_cvt_pk_bf16_f32 v145, v146, v147
v_mfma_f32_16x16x32_bf16 v[192:195], a[128:131], a[96:99], v[192:195]
buffer_store_dwordx4 v[56:59], v1, s[4:7], s31 offen sc1
v_mfma_f32_16x16x32_bf16 v[192:195], a[132:135], a[100:103], v[192:195]
s_add_u32 s31, s31, s34
v_cvt_pk_bf16_f32 v146, v148, v149
v_cvt_pk_bf16_f32 v147, v150, v151
v_mfma_f32_16x16x32_bf16 v[200:203], a[128:131], a[104:107], v[200:203]
ds_read_b128 a[44:47], v3 offset:10240
v_cvt_pk_bf16_f32 v152, v152, v153
v_mfma_f32_16x16x32_bf16 v[200:203], a[132:135], a[108:111], v[200:203]
v_cvt_pk_bf16_f32 v153, v154, v155
v_cvt_pk_bf16_f32 v154, v156, v157
v_mfma_f32_16x16x32_bf16 v[208:211], a[128:131], a[112:115], v[208:211]
ds_read_b128 a[48:51], v2 offset:12288
v_cvt_pk_bf16_f32 v155, v158, v159
v_mfma_f32_16x16x32_bf16 v[208:211], a[132:135], a[116:119], v[208:211]
v_mfma_f32_16x16x32_bf16 v[216:219], a[128:131], a[120:123], v[216:219]
v_mfma_f32_16x16x32_bf16 v[216:219], a[132:135], a[124:127], v[216:219]
s_waitcnt lgkmcnt(2)
v_mfma_f32_16x16x32_bf16 v[164:167], a[136:139], a[64:67], v[164:167]
ds_read_b64_tr_b16 a[128:129], v10 offset:32768
v_mfma_f32_16x16x32_bf16 v[164:167], a[140:143], a[68:71], v[164:167]
v_mfma_f32_16x16x32_bf16 v[172:175], a[136:139], a[72:75], v[172:175]
ds_read_b64_tr_b16 a[130:131], v10 offset:34816
v_mfma_f32_16x16x32_bf16 v[172:175], a[140:143], a[76:79], v[172:175]
buffer_store_dwordx4 v[64:67], v1, s[4:7], s31 offen sc1
v_mfma_f32_16x16x32_bf16 v[180:183], a[136:139], a[80:83], v[180:183]
s_add_u32 s31, s31, s32
ds_read_b64_tr_b16 a[132:133], v10 offset:49152
v_mfma_f32_16x16x32_bf16 v[180:183], a[140:143], a[84:87], v[180:183]
v_mfma_f32_16x16x32_bf16 v[188:191], a[136:139], a[88:91], v[188:191]
ds_read_b64_tr_b16 a[134:135], v10 offset:51200
v_cvt_pk_bf16_f32 v160, v160, v161
v_mfma_f32_16x16x32_bf16 v[188:191], a[140:143], a[92:95], v[188:191]
v_cvt_pk_bf16_f32 v161, v162, v163
v_cvt_pk_bf16_f32 v162, v164, v165
v_mfma_f32_16x16x32_bf16 v[196:199], a[136:139], a[96:99], v[196:199]
ds_read_b128 a[52:55], v3 offset:12288
v_cvt_pk_bf16_f32 v163, v166, v167
v_mfma_f32_16x16x32_bf16 v[196:199], a[140:143], a[100:103], v[196:199]
v_cvt_pk_bf16_f32 v168, v168, v169
v_cvt_pk_bf16_f32 v169, v170, v171
v_mfma_f32_16x16x32_bf16 v[204:207], a[136:139], a[104:107], v[204:207]
ds_read_b128 a[56:59], v2 offset:14336
v_cvt_pk_bf16_f32 v170, v172, v173
v_mfma_f32_16x16x32_bf16 v[204:207], a[140:143], a[108:111], v[204:207]
v_cvt_pk_bf16_f32 v171, v174, v175
v_cvt_pk_bf16_f32 v176, v176, v177
v_mfma_f32_16x16x32_bf16 v[212:215], a[136:139], a[112:115], v[212:215]
v_cvt_pk_bf16_f32 v177, v178, v179
v_cvt_pk_bf16_f32 v178, v180, v181
v_mfma_f32_16x16x32_bf16 v[212:215], a[140:143], a[116:119], v[212:215]
buffer_store_dwordx4 v[72:75], v1, s[4:7], s31 offen sc1
v_mfma_f32_16x16x32_bf16 v[220:223], a[136:139], a[120:123], v[220:223]
s_add_u32 s31, s31, s33
ds_read_b128 a[60:63], v3 offset:14336
v_cvt_pk_bf16_f32 v179, v182, v183
v_mfma_f32_16x16x32_bf16 v[220:223], a[140:143], a[124:127], v[220:223]
s_waitcnt lgkmcnt(3)
v_cvt_pk_bf16_f32 v184, v184, v185
v_cvt_pk_bf16_f32 v185, v186, v187
v_mfma_f32_16x16x32_bf16 a[192:195], a[128:131], a[64:67], a[192:195]
ds_read_b64_tr_b16 a[136:137], v11 offset:32768
v_cvt_pk_bf16_f32 v186, v188, v189
v_mfma_f32_16x16x32_bf16 a[192:195], a[132:135], a[68:71], a[192:195]
v_cvt_pk_bf16_f32 v187, v190, v191
v_cvt_pk_bf16_f32 v192, v192, v193
v_mfma_f32_16x16x32_bf16 a[200:203], a[128:131], a[72:75], a[200:203]
ds_read_b64_tr_b16 a[138:139], v11 offset:34816
v_cvt_pk_bf16_f32 v193, v194, v195
v_mfma_f32_16x16x32_bf16 a[200:203], a[132:135], a[76:79], a[200:203]
v_cvt_pk_bf16_f32 v194, v196, v197
v_cvt_pk_bf16_f32 v195, v198, v199
v_mfma_f32_16x16x32_bf16 a[208:211], a[128:131], a[80:83], a[208:211]
ds_read_b64_tr_b16 a[140:141], v11 offset:49152
v_cvt_pk_bf16_f32 v200, v200, v201
v_mfma_f32_16x16x32_bf16 a[208:211], a[132:135], a[84:87], a[208:211]
v_cvt_pk_bf16_f32 v201, v202, v203
v_cvt_pk_bf16_f32 v202, v204, v205
v_mfma_f32_16x16x32_bf16 a[216:219], a[128:131], a[88:91], a[216:219]
ds_read_b64_tr_b16 a[142:143], v11 offset:51200
v_cvt_pk_bf16_f32 v203, v206, v207
v_mfma_f32_16x16x32_bf16 a[216:219], a[132:135], a[92:95], a[216:219]
v_cvt_pk_bf16_f32 v208, v208, v209
v_cvt_pk_bf16_f32 v209, v210, v211
v_mfma_f32_16x16x32_bf16 a[224:227], a[128:131], a[96:99], a[224:227]
buffer_store_dwordx4 v[80:83], v1, s[4:7], s31 offen sc1
v_mfma_f32_16x16x32_bf16 a[224:227], a[132:135], a[100:103], a[224:227]
s_add_u32 s31, s31, s32
v_cvt_pk_bf16_f32 v210, v212, v213
v_cvt_pk_bf16_f32 v211, v214, v215
v_mfma_f32_16x16x32_bf16 a[232:235], a[128:131], a[104:107], a[232:235]
v_cvt_pk_bf16_f32 v216, v216, v217
v_cvt_pk_bf16_f32 v217, v218, v219
v_mfma_f32_16x16x32_bf16 a[232:235], a[132:135], a[108:111], a[232:235]
v_cvt_pk_bf16_f32 v218, v220, v221
v_cvt_pk_bf16_f32 v219, v222, v223
v_mfma_f32_16x16x32_bf16 a[240:243], a[128:131], a[112:115], a[240:243]
v_mfma_f32_16x16x32_bf16 a[240:243], a[132:135], a[116:119], a[240:243]
v_mfma_f32_16x16x32_bf16 a[248:251], a[128:131], a[120:123], a[248:251]
s_waitcnt vmcnt(23) lgkmcnt(0)
v_mfma_f32_16x16x32_bf16 a[248:251], a[132:135], a[124:127], a[248:251]
s_barrier
v_mfma_f32_16x16x32_bf16 a[196:199], a[136:139], a[64:67], a[196:199]
s_add_u32 m0, s29, 98304
ds_read_b64_tr_b16 a[128:129], v22 offset:0
v_mfma_f32_16x16x32_bf16 a[196:199], a[140:143], a[68:71], a[196:199]
buffer_load_dwordx4 v16, s[12:15], s26 offen offset:0 lds
v_mfma_f32_16x16x32_bf16 a[204:207], a[136:139], a[72:75], a[204:207]
ds_read_b64_tr_b16 a[130:131], v22 offset:2048
v_mfma_f32_16x16x32_bf16 a[204:207], a[140:143], a[76:79], a[204:207]
buffer_store_dwordx4 v[88:91], v1, s[4:7], s31 offen sc1
v_mfma_f32_16x16x32_bf16 a[212:215], a[136:139], a[80:83], a[212:215]
s_add_u32 s31, s31, s35
ds_read_b64_tr_b16 a[132:133], v22 offset:16384
v_mfma_f32_16x16x32_bf16 a[212:215], a[140:143], a[84:87], a[212:215]
buffer_load_dwordx4 v17, s[12:15], s26 offen offset:1024 lds
v_mfma_f32_16x16x32_bf16 a[220:223], a[136:139], a[88:91], a[220:223]
ds_read_b64_tr_b16 a[134:135], v22 offset:18432
v_add_u32 v22, 4294901760, v22
v_mfma_f32_16x16x32_bf16 a[220:223], a[140:143], a[92:95], a[220:223]
v_mfma_f32_16x16x32_bf16 a[228:231], a[136:139], a[96:99], a[228:231]
v_mfma_f32_16x16x32_bf16 a[228:231], a[140:143], a[100:103], a[228:231]
buffer_load_dwordx4 v18, s[12:15], s26 offen offset:2048 lds
v_mfma_f32_16x16x32_bf16 a[236:239], a[136:139], a[104:107], a[236:239]
v_mfma_f32_16x16x32_bf16 a[236:239], a[140:143], a[108:111], a[236:239]
v_mfma_f32_16x16x32_bf16 a[244:247], a[136:139], a[112:115], a[244:247]
v_mfma_f32_16x16x32_bf16 a[244:247], a[140:143], a[116:119], a[244:247]
buffer_load_dwordx4 v19, s[12:15], s26 offen offset:3072 lds
v_mfma_f32_16x16x32_bf16 a[252:255], a[136:139], a[120:123], a[252:255]
s_add_u32 s26, s26, 524288
v_mfma_f32_16x16x32_bf16 a[252:255], a[140:143], a[124:127], a[252:255]
s_waitcnt lgkmcnt(0)
M_Q:
v_mfma_f32_16x16x32_bf16 v[36:39], a[128:131], a[0:3], 0
s_add_u32 m0, s29, 114688
ds_read_b64_tr_b16 a[136:137], v23 offset:0
v_mfma_f32_16x16x32_bf16 v[36:39], a[132:135], a[4:7], v[36:39]
buffer_load_dwordx4 v16, s[12:15], s27 offen offset:0 lds
v_mfma_f32_16x16x32_bf16 v[44:47], a[128:131], a[8:11], 0
ds_read_b64_tr_b16 a[138:139], v23 offset:2048
v_mfma_f32_16x16x32_bf16 v[44:47], a[132:135], a[12:15], v[44:47]
ds_read_b128 a[64:67], v2 offset:16384
ds_read_b128 a[68:71], v3 offset:16384
v_mfma_f32_16x16x32_bf16 v[52:55], a[128:131], a[16:19], 0
ds_read_b64_tr_b16 a[140:141], v23 offset:16384
v_mfma_f32_16x16x32_bf16 v[52:55], a[132:135], a[20:23], v[52:55]
buffer_load_dwordx4 v17, s[12:15], s27 offen offset:1024 lds
v_mfma_f32_16x16x32_bf16 v[60:63], a[128:131], a[24:27], 0
ds_read_b64_tr_b16 a[142:143], v23 offset:18432
v_add_u32 v23, 4294901760, v23
v_mfma_f32_16x16x32_bf16 v[60:63], a[132:135], a[28:31], v[60:63]
buffer_store_dwordx4 v[96:99], v1, s[4:7], s31 offen sc1
v_mfma_f32_16x16x32_bf16 v[68:71], a[128:131], a[32:35], 0
s_add_u32 s31, s31, s32
ds_read_b128 a[72:75], v2 offset:18432
v_mfma_f32_16x16x32_bf16 v[68:71], a[132:135], a[36:39], v[68:71]
buffer_load_dwordx4 v18, s[12:15], s27 offen offset:2048 lds
v_mfma_f32_16x16x32_bf16 v[76:79], a[128:131], a[40:43], 0
ds_read_b128 a[76:79], v3 offset:18432
v_mfma_f32_16x16x32_bf16 v[76:79], a[132:135], a[44:47], v[76:79]
ds_read_b128 a[80:83], v2 offset:20480
v_mfma_f32_16x16x32_bf16 v[84:87], a[128:131], a[48:51], 0
ds_read_b128 a[84:87], v3 offset:20480
v_mfma_f32_16x16x32_bf16 v[84:87], a[132:135], a[52:55], v[84:87]
buffer_load_dwordx4 v19, s[12:15], s27 offen offset:3072 lds
v_mfma_f32_16x16x32_bf16 v[92:95], a[128:131], a[56:59], 0
s_add_u32 s27, s27, 524288
ds_read_b128 a[88:91], v2 offset:22528
v_mfma_f32_16x16x32_bf16 v[92:95], a[132:135], a[60:63], v[92:95]
s_waitcnt lgkmcnt(5)
buffer_store_dwordx4 v[104:107], v1, s[4:7], s31 offen sc1
v_mfma_f32_16x16x32_bf16 v[100:103], a[136:139], a[0:3], 0
s_add_u32 m0, s28, 0
ds_read_b64_tr_b16 a[128:129], v24 offset:0
v_mfma_f32_16x16x32_bf16 v[100:103], a[140:143], a[4:7], v[100:103]
s_add_u32 s31, s31, s33
buffer_load_dwordx4 v12, s[8:11], s24 offen offset:0 lds
v_mfma_f32_16x16x32_bf16 v[108:111], a[136:139], a[8:11], 0
ds_read_b64_tr_b16 a[130:131], v24 offset:2048
v_mfma_f32_16x16x32_bf16 v[108:111], a[140:143], a[12:15], v[108:111]
ds_read_b128 a[92:95], v3 offset:22528
v_mfma_f32_16x16x32_bf16 v[116:119], a[136:139], a[16:19], 0
ds_read_b64_tr_b16 a[132:133], v24 offset:16384
v_mfma_f32_16x16x32_bf16 v[116:119], a[140:143], a[20:23], v[116:119]
buffer_load_dwordx4 v13, s[8:11], s24 offen offset:1024 lds
v_mfma_f32_16x16x32_bf16 v[124:127], a[136:139], a[24:27], 0
ds_read_b64_tr_b16 a[134:135], v24 offset:18432
v_add_u32 v24, 4294901760, v24
v_mfma_f32_16x16x32_bf16 v[124:127], a[140:143], a[28:31], v[124:127]
v_mfma_f32_16x16x32_bf16 v[132:135], a[136:139], a[32:35], 0
ds_read_b128 a[96:99], v2 offset:24576
v_mfma_f32_16x16x32_bf16 v[132:135], a[140:143], a[36:39], v[132:135]
buffer_load_dwordx4 v14, s[8:11], s24 offen offset:2048 lds
v_mfma_f32_16x16x32_bf16 v[140:143], a[136:139], a[40:43], 0
ds_read_b128 a[100:103], v3 offset:24576
v_mfma_f32_16x16x32_bf16 v[140:143], a[140:143], a[44:47], v[140:143]
ds_read_b128 a[104:107], v2 offset:26624
v_mfma_f32_16x16x32_bf16 v[148:151], a[136:139], a[48:51], 0
ds_read_b128 a[108:111], v3 offset:26624
v_mfma_f32_16x16x32_bf16 v[148:151], a[140:143], a[52:55], v[148:151]
PAD_6:
s_cbranch_execz M_tret
buffer_load_dwordx4 v15, s[8:11], s24 offen offset:3072 lds
v_mfma_f32_16x16x32_bf16 v[156:159], a[136:139], a[56:59], 0
s_add_u32 s24, s24, 128
ds_read_b128 a[112:115], v2 offset:28672
v_mfma_f32_16x16x32_bf16 v[156:159], a[140:143], a[60:63], v[156:159]
s_waitcnt lgkmcnt(5)
buffer_store_dwordx4 v[112:115], v1, s[4:7], s31 offen sc1
v_mfma_f32_16x16x32_bf16 v[164:167], a[128:131], a[0:3], 0
s_add_u32 s31, s31, s32
ds_read_b64_tr_b16 a[136:137], v25 offset:0
v_mfma_f32_16x16x32_bf16 v[164:167], a[132:135], a[4:7], v[164:167]
v_mfma_f32_16x16x32_bf16 v[172:175], a[128:131], a[8:11], 0
ds_read_b64_tr_b16 a[138:139], v25 offset:2048
v_mfma_f32_16x16x32_bf16 v[172:175], a[132:135], a[12:15], v[172:175]
ds_read_b128 a[116:119], v3 offset:28672
v_mfma_f32_16x16x32_bf16 v[180:183], a[128:131], a[16:19], 0
ds_read_b64_tr_b16 a[140:141], v25 offset:16384
v_mfma_f32_16x16x32_bf16 v[180:183], a[132:135], a[20:23], v[180:183]
v_mfma_f32_16x16x32_bf16 v[188:191], a[128:131], a[24:27], 0
ds_read_b64_tr_b16 a[142:143], v25 offset:18432
v_add_u32 v25, 4294901760, v25
v_mfma_f32_16x16x32_bf16 v[188:191], a[132:135], a[28:31], v[188:191]
v_mfma_f32_16x16x32_bf16 v[196:199], a[128:131], a[32:35], 0
ds_read_b128 a[120:123], v2 offset:30720
v_mfma_f32_16x16x32_bf16 v[196:199], a[132:135], a[36:39], v[196:199]
v_mfma_f32_16x16x32_bf16 v[204:207], a[128:131], a[40:43], 0
ds_read_b128 a[124:127], v3 offset:30720
v_mfma_f32_16x16x32_bf16 v[204:207], a[132:135], a[44:47], v[204:207]
v_mfma_f32_16x16x32_bf16 v[212:215], a[128:131], a[48:51], 0
v_mfma_f32_16x16x32_bf16 v[212:215], a[132:135], a[52:55], v[212:215]
buffer_store_dwordx4 v[120:123], v1, s[4:7], s31 offen sc1
v_mfma_f32_16x16x32_bf16 v[220:223], a[128:131], a[56:59], 0
s_add_u32 s31, s31, s34
v_mfma_f32_16x16x32_bf16 v[220:223], a[132:135], a[60:63], v[220:223]
s_waitcnt vmcnt(28) lgkmcnt(0)
s_barrier
v_mfma_f32_16x16x32_bf16 v[224:227], a[136:139], a[0:3], 0
s_add_u32 m0, s29, 131072
ds_read_b64_tr_b16 a[128:129], v22 offset:0
v_mfma_f32_16x16x32_bf16 v[224:227], a[140:143], a[4:7], v[224:227]
buffer_load_dwordx4 v16, s[12:15], s26 offen offset:0 lds
v_mfma_f32_16x16x32_bf16 v[228:231], a[136:139], a[8:11], 0
ds_read_b64_tr_b16 a[130:131], v22 offset:2048
v_mfma_f32_16x16x32_bf16 v[228:231], a[140:143], a[12:15], v[228:231]
v_mfma_f32_16x16x32_bf16 v[232:235], a[136:139], a[16:19], 0
ds_read_b64_tr_b16 a[132:133], v22 offset:16384
v_mfma_f32_16x16x32_bf16 v[232:235], a[140:143], a[20:23], v[232:235]
buffer_load_dwordx4 v17, s[12:15], s26 offen offset:1024 lds
v_mfma_f32_16x16x32_bf16 v[236:239], a[136:139], a[24:27], 0
ds_read_b64_tr_b16 a[134:135], v22 offset:18432
v_add_u32 v22, 32768, v22
v_mfma_f32_16x16x32_bf16 v[236:239], a[140:143], a[28:31], v[236:239]
v_mfma_f32_16x16x32_bf16 v[240:243], a[136:139], a[32:35], 0
v_mfma_f32_16x16x32_bf16 v[240:243], a[140:143], a[36:39], v[240:243]
buffer_load_dwordx4 v18, s[12:15], s26 offen offset:2048 lds
v_mfma_f32_16x16x32_bf16 v[244:247], a[136:139], a[40:43], 0
v_mfma_f32_16x16x32_bf16 v[244:247], a[140:143], a[44:47], v[244:247]
v_mfma_f32_16x16x32_bf16 v[248:251], a[136:139], a[48:51], 0
v_mfma_f32_16x16x32_bf16 v[248:251], a[140:143], a[52:55], v[248:251]
buffer_load_dwordx4 v19, s[12:15], s26 offen offset:3072 lds
v_mfma_f32_16x16x32_bf16 v[252:255], a[136:139], a[56:59], 0
s_add_u32 s26, s26, 524288
v_mfma_f32_16x16x32_bf16 v[252:255], a[140:143], a[60:63], v[252:255]
s_waitcnt lgkmcnt(0)
v_mfma_f32_16x16x32_bf16 v[36:39], a[128:131], a[64:67], v[36:39]
s_add_u32 m0, s29, 147456
ds_read_b64_tr_b16 a[136:137], v23 offset:0
v_mfma_f32_16x16x32_bf16 v[36:39], a[132:135], a[68:71], v[36:39]
buffer_load_dwordx4 v16, s[12:15], s27 offen offset:0 lds
v_mfma_f32_16x16x32_bf16 v[44:47], a[128:131], a[72:75], v[44:47]
ds_read_b64_tr_b16 a[138:139], v23 offset:2048
v_mfma_f32_16x16x32_bf16 v[44:47], a[132:135], a[76:79], v[44:47]
ds_read_b128 a[0:3], v2 offset:32768
ds_read_b128 a[4:7], v3 offset:32768
v_mfma_f32_16x16x32_bf16 v[52:55], a[128:131], a[80:83], v[52:55]
ds_read_b64_tr_b16 a[140:141], v23 offset:16384
v_mfma_f32_16x16x32_bf16 v[52:55], a[132:135], a[84:87], v[52:55]
buffer_load_dwordx4 v17, s[12:15], s27 offen offset:1024 lds
v_mfma_f32_16x16x32_bf16 v[60:63], a[128:131], a[88:91], v[60:63]
ds_read_b64_tr_b16 a[142:143], v23 offset:18432
v_add_u32 v23, 32768, v23
v_mfma_f32_16x16x32_bf16 v[60:63], a[132:135], a[92:95], v[60:63]
buffer_store_dwordx4 v[128:131], v1, s[4:7], s31 offen sc1
v_mfma_f32_16x16x32_bf16 v[68:71], a[128:131], a[96:99], v[68:71]
s_add_u32 s31, s31, s32
ds_read_b128 a[8:11], v2 offset:34816
v_accvgpr_read_b32 v32, a192
v_mfma_f32_16x16x32_bf16 v[68:71], a[132:135], a[100:103], v[68:71]
buffer_load_dwordx4 v18, s[12:15], s27 offen offset:2048 lds
v_mfma_f32_16x16x32_bf16 v[76:79], a[128:131], a[104:107], v[76:79]
ds_read_b128 a[12:15], v3 offset:34816
v_accvgpr_read_b32 v33, a193
v_mfma_f32_16x16x32_bf16 v[76:79], a[132:135], a[108:111], v[76:79]
ds_read_b128 a[16:19], v2 offset:36864
v_accvgpr_read_b32 v34, a194
v_mfma_f32_16x16x32_bf16 v[84:87], a[128:131], a[112:115], v[84:87]
ds_read_b128 a[20:23], v3 offset:36864
v_accvgpr_read_b32 v35, a195
v_mfma_f32_16x16x32_bf16 v[84:87], a[132:135], a[116:119], v[84:87]
buffer_load_dwordx4 v19, s[12:15], s27 offen offset:3072 lds
v_mfma_f32_16x16x32_bf16 v[92:95], a[128:131], a[120:123], v[92:95]
s_add_u32 s27, s27, 524288
ds_read_b128 a[24:27], v2 offset:38912
v_accvgpr_read_b32 v96, a196
v_mfma_f32_16x16x32_bf16 v[92:95], a[132:135], a[124:127], v[92:95]
s_waitcnt lgkmcnt(5)
buffer_store_dwordx4 v[136:139], v1, s[4:7], s31 offen sc1
v_mfma_f32_16x16x32_bf16 v[100:103], a[136:139], a[64:67], v[100:103]
s_add_u32 m0, s28, 16384
ds_read_b64_tr_b16 a[128:129], v24 offset:0
v_accvgpr_read_b32 v97, a197
v_mfma_f32_16x16x32_bf16 v[100:103], a[140:143], a[68:71], v[100:103]
s_add_u32 s31, s31, s33
buffer_load_dwordx4 v12, s[8:11], s24 offen offset:0 lds
v_mfma_f32_16x16x32_bf16 v[108:111], a[136:139], a[72:75], v[108:111]
ds_read_b64_tr_b16 a[130:131], v24 offset:2048
v_accvgpr_read_b32 v98, a198
v_mfma_f32_16x16x32_bf16 v[108:111], a[140:143], a[76:79], v[108:111]
ds_read_b128 a[28:31], v3 offset:38912
v_accvgpr_read_b32 v99, a199
v_mfma_f32_16x16x32_bf16 v[116:119], a[136:139], a[80:83], v[116:119]
ds_read_b64_tr_b16 a[132:133], v24 offset:16384
v_cvt_pk_bf16_f32 v32, v32, v33
v_mfma_f32_16x16x32_bf16 v[116:119], a[140:143], a[84:87], v[116:119]
buffer_load_dwordx4 v13, s[8:11], s24 offen offset:1024 lds
v_mfma_f32_16x16x32_bf16 v[124:127], a[136:139], a[88:91], v[124:127]
ds_read_b64_tr_b16 a[134:135], v24 offset:18432
v_add_u32 v24, 32768, v24
v_mfma_f32_16x16x32_bf16 v[124:127], a[140:143], a[92:95], v[124:127]
v_cvt_pk_bf16_f32 v33, v34, v35
v_cvt_pk_bf16_f32 v34, v96, v97
v_mfma_f32_16x16x32_bf16 v[132:135], a[136:139], a[96:99], v[132:135]
ds_read_b128 a[32:35], v2 offset:40960
v_cvt_pk_bf16_f32 v35, v98, v99
v_mfma_f32_16x16x32_bf16 v[132:135], a[140:143], a[100:103], v[132:135]
buffer_load_dwordx4 v14, s[8:11], s24 offen offset:2048 lds
v_mfma_f32_16x16x32_bf16 v[140:143], a[136:139], a[104:107], v[140:143]
ds_read_b128 a[36:39], v3 offset:40960
v_accvgpr_read_b32 v40, a200
v_mfma_f32_16x16x32_bf16 v[140:143], a[140:143], a[108:111], v[140:143]
ds_read_b128 a[40:43], v2 offset:43008
v_accvgpr_read_b32 v41, a201
v_mfma_f32_16x16x32_bf16 v[148:151], a[136:139], a[112:115], v[148:151]
ds_read_b128 a[44:47], v3 offset:43008
v_accvgpr_read_b32 v42, a202
v_mfma_f32_16x16x32_bf16 v[148:151], a[140:143], a[116:119], v[148:151]
buffer_load_dwordx4 v15, s[8:11], s24 offen offset:3072 lds
v_mfma_f32_16x16x32_bf16 v[156:159], a[136:139], a[120:123], v[156:159]
s_add_u32 s24, s24, 128
ds_read_b128 a[48:51], v2 offset:45056
v_accvgpr_read_b32 v43, a203
v_mfma_f32_16x16x32_bf16 v[156:159], a[140:143], a[124:127], v[156:159]
s_waitcnt lgkmcnt(5)
buffer_store_dwordx4 v[144:147], v1, s[4:7], s31 offen sc1
v_mfma_f32_16x16x32_bf16 v[164:167], a[128:131], a[64:67], v[164:167]
s_add_u32 s31, s31, s32
ds_read_b64_tr_b16 a[136:137], v25 offset:0
v_accvgpr_read_b32 v96, a204
v_mfma_f32_16x16x32_bf16 v[164:167], a[132:135], a[68:71], v[164:167]
v_accvgpr_read_b32 v97, a205
v_accvgpr_read_b32 v98, a206
v_mfma_f32_16x16x32_bf16 v[172:175], a[128:131], a[72:75], v[172:175]
ds_read_b64_tr_b16 a[138:139], v25 offset:2048
v_accvgpr_read_b32 v99, a207
v_mfma_f32_16x16x32_bf16 v[172:175], a[132:135], a[76:79], v[172:175]
ds_read_b128 a[52:55], v3 offset:45056
v_cvt_pk_bf16_f32 v40, v40, v41
v_mfma_f32_16x16x32_bf16 v[180:183], a[128:131], a[80:83], v[180:183]
ds_read_b64_tr_b16 a[140:141], v25 offset:16384
v_cvt_pk_bf16_f32 v41, v42, v43
v_mfma_f32_16x16x32_bf16 v[180:183], a[132:135], a[84:87], v[180:183]
v_cvt_pk_bf16_f32 v42, v96, v97
v_cvt_pk_bf16_f32 v43, v98, v99
v_mfma_f32_16x16x32_bf16 v[188:191], a[128:131], a[88:91], v[188:191]
ds_read_b64_tr_b16 a[142:143], v25 offset:18432
v_add_u32 v25, 32768, v25
v_mfma_f32_16x16x32_bf16 v[188:191], a[132:135], a[92:95], v[188:191]
v_accvgpr_read_b32 v48, a208
v_accvgpr_read_b32 v49, a209
v_mfma_f32_16x16x32_bf16 v[196:199], a[128:131], a[96:99], v[196:199]
ds_read_b128 a[56:59], v2 offset:47104
v_accvgpr_read_b32 v50, a210
v_mfma_f32_16x16x32_bf16 v[196:199], a[132:135], a[100:103], v[196:199]
v_accvgpr_read_b32 v51, a211
v_accvgpr_read_b32 v96, a212
v_mfma_f32_16x16x32_bf16 v[204:207], a[128:131], a[104:107], v[204:207]
ds_read_b128 a[60:63], v3 offset:47104
v_accvgpr_read_b32 v97, a213
v_mfma_f32_16x16x32_bf16 v[204:207], a[132:135], a[108:111], v[204:207]
v_accvgpr_read_b32 v98, a214
v_accvgpr_read_b32 v99, a215
v_mfma_f32_16x16x32_bf16 v[212:215], a[128:131], a[112:115], v[212:215]
v_cvt_pk_bf16_f32 v48, v48, v49
v_cvt_pk_bf16_f32 v49, v50, v51
v_mfma_f32_16x16x32_bf16 v[212:215], a[132:135], a[116:119], v[212:215]
buffer_store_dwordx4 v[152:155], v1, s[4:7], s31 offen sc1
v_mfma_f32_16x16x32_bf16 v[220:223], a[128:131], a[120:123], v[220:223]
s_add_u32 s31, s31, s36
v_cvt_pk_bf16_f32 v50, v96, v97
v_cvt_pk_bf16_f32 v51, v98, v99
v_mfma_f32_16x16x32_bf16 v[220:223], a[132:135], a[124:127], v[220:223]
s_waitcnt vmcnt(23) lgkmcnt(0)
s_barrier
v_accvgpr_read_b32 v56, a216
v_mfma_f32_16x16x32_bf16 v[224:227], a[136:139], a[64:67], v[224:227]
s_add_u32 m0, s29, 65536
ds_read_b64_tr_b16 a[128:129], v22 offset:0
v_accvgpr_read_b32 v57, a217
v_mfma_f32_16x16x32_bf16 v[224:227], a[140:143], a[68:71], v[224:227]
buffer_load_dwordx4 v16, s[12:15], s26 offen offset:0 lds
v_mfma_f32_16x16x32_bf16 v[228:231], a[136:139], a[72:75], v[228:231]
ds_read_b64_tr_b16 a[130:131], v22 offset:2048
v_accvgpr_read_b32 v58, a218
v_mfma_f32_16x16x32_bf16 v[228:231], a[140:143], a[76:79], v[228:231]
v_accvgpr_read_b32 v59, a219
v_accvgpr_read_b32 v96, a220
v_mfma_f32_16x16x32_bf16 v[232:235], a[136:139], a[80:83], v[232:235]
ds_read_b64_tr_b16 a[132:133], v22 offset:16384
v_accvgpr_read_b32 v97, a221
v_mfma_f32_16x16x32_bf16 v[232:235], a[140:143], a[84:87], v[232:235]
buffer_load_dwordx4 v17, s[12:15], s26 offen offset:1024 lds
v_mfma_f32_16x16x32_bf16 v[236:239], a[136:139], a[88:91], v[236:239]
ds_read_b64_tr_b16 a[134:135], v22 offset:18432
v_add_u32 v22, 32768, v22
v_mfma_f32_16x16x32_bf16 v[236:239], a[140:143], a[92:95], v[236:239]
v_accvgpr_read_b32 v98, a222
v_accvgpr_read_b32 v99, a223
v_mfma_f32_16x16x32_bf16 v[240:243], a[136:139], a[96:99], v[240:243]
v_cvt_pk_bf16_f32 v56, v56, v57
v_cvt_pk_bf16_f32 v57, v58, v59
v_mfma_f32_16x16x32_bf16 v[240:243], a[140:143], a[100:103], v[240:243]
buffer_load_dwordx4 v18, s[12:15], s26 offen offset:2048 lds
v_mfma_f32_16x16x32_bf16 v[244:247], a[136:139], a[104:107], v[244:247]
v_cvt_pk_bf16_f32 v58, v96, v97
v_cvt_pk_bf16_f32 v59, v98, v99
v_mfma_f32_16x16x32_bf16 v[244:247], a[140:143], a[108:111], v[244:247]
v_accvgpr_read_b32 v64, a224
v_accvgpr_read_b32 v65, a225
v_mfma_f32_16x16x32_bf16 v[248:251], a[136:139], a[112:115], v[248:251]
v_accvgpr_read_b32 v66, a226
v_accvgpr_read_b32 v67, a227
v_mfma_f32_16x16x32_bf16 v[248:251], a[140:143], a[116:119], v[248:251]
buffer_load_dwordx4 v19, s[12:15], s26 offen offset:3072 lds
v_mfma_f32_16x16x32_bf16 v[252:255], a[136:139], a[120:123], v[252:255]
s_add_u32 s26, s26, 524288
v_accvgpr_read_b32 v96, a228
v_accvgpr_read_b32 v97, a229
v_mfma_f32_16x16x32_bf16 v[252:255], a[140:143], a[124:127], v[252:255]
s_waitcnt lgkmcnt(0)
v_accvgpr_read_b32 v98, a230
v_accvgpr_read_b32 v99, a231
v_mfma_f32_16x16x32_bf16 v[36:39], a[128:131], a[0:3], v[36:39]
s_add_u32 m0, s29, 81920
ds_read_b64_tr_b16 a[136:137], v23 offset:0
v_cvt_pk_bf16_f32 v64, v64, v65
v_mfma_f32_16x16x32_bf16 v[36:39], a[132:135], a[4:7], v[36:39]
buffer_load_dwordx4 v16, s[12:15], s27 offen offset:0 lds
v_mfma_f32_16x16x32_bf16 v[44:47], a[128:131], a[8:11], v[44:47]
ds_read_b64_tr_b16 a[138:139], v23 offset:2048
v_cvt_pk_bf16_f32 v65, v66, v67
v_mfma_f32_16x16x32_bf16 v[44:47], a[132:135], a[12:15], v[44:47]
ds_read_b128 a[64:67], v2 offset:49152
ds_read_b128 a[68:71], v3 offset:49152
v_mfma_f32_16x16x32_bf16 v[52:55], a[128:131], a[16:19], v[52:55]
ds_read_b64_tr_b16 a[140:141], v23 offset:16384
v_cvt_pk_bf16_f32 v66, v96, v97
v_mfma_f32_16x16x32_bf16 v[52:55], a[132:135], a[20:23], v[52:55]
buffer_load_dwordx4 v17, s[12:15], s27 offen offset:1024 lds
v_mfma_f32_16x16x32_bf16 v[60:63], a[128:131], a[24:27], v[60:63]
ds_read_b64_tr_b16 a[142:143], v23 offset:18432
v_add_u32 v23, 32768, v23
v_mfma_f32_16x16x32_bf16 v[60:63], a[132:135], a[28:31], v[60:63]
buffer_store_dwordx4 v[160:163], v1, s[4:7], s31 offen sc1
v_mfma_f32_16x16x32_bf16 v[68:71], a[128:131], a[32:35], v[68:71]
s_add_u32 s31, s31, s32
ds_read_b128 a[72:75], v2 offset:51200
v_cvt_pk_bf16_f32 v67, v98, v99
v_mfma_f32_16x16x32_bf16 v[68:71], a[132:135], a[36:39], v[68:71]
buffer_load_dwordx4 v18, s[12:15], s27 offen offset:2048 lds
v_mfma_f32_16x16x32_bf16 v[76:79], a[128:131], a[40:43], v[76:79]
ds_read_b128 a[76:79], v3 offset:51200
v_accvgpr_read_b32 v72, a232
v_mfma_f32_16x16x32_bf16 v[76:79], a[132:135], a[44:47], v[76:79]
ds_read_b128 a[80:83], v2 offset:53248
v_accvgpr_read_b32 v73, a233
v_mfma_f32_16x16x32_bf16 v[84:87], a[128:131], a[48:51], v[84:87]
ds_read_b128 a[84:87], v3 offset:53248
v_accvgpr_read_b32 v74, a234
v_mfma_f32_16x16x32_bf16 v[84:87], a[132:135], a[52:55], v[84:87]
buffer_load_dwordx4 v19, s[12:15], s27 offen offset:3072 lds
v_mfma_f32_16x16x32_bf16 v[92:95], a[128:131], a[56:59], v[92:95]
s_add_u32 s27, s27, 524288
ds_read_b128 a[88:91], v2 offset:55296
v_accvgpr_read_b32 v75, a235
v_mfma_f32_16x16x32_bf16 v[92:95], a[132:135], a[60:63], v[92:95]
s_waitcnt lgkmcnt(5)
buffer_store_dwordx4 v[168:171], v1, s[4:7], s31 offen sc1
v_mfma_f32_16x16x32_bf16 v[100:103], a[136:139], a[0:3], v[100:103]
s_add_u32 m0, s28, 32768
ds_read_b64_tr_b16 a[128:129], v24 offset:0
v_accvgpr_read_b32 v96, a236
v_mfma_f32_16x16x32_bf16 v[100:103], a[140:143], a[4:7], v[100:103]
s_add_u32 s31, s31, s33
buffer_load_dwordx4 v12, s[8:11], s24 offen offset:0 lds
v_mfma_f32_16x16x32_bf16 v[108:111], a[136:139], a[8:11], v[108:111]
ds_read_b64_tr_b16 a[130:131], v24 offset:2048
v_accvgpr_read_b32 v97, a237
v_mfma_f32_16x16x32_bf16 v[108:111], a[140:143], a[12:15], v[108:111]
ds_read_b128 a[92:95], v3 offset:55296
v_accvgpr_read_b32 v98, a238
v_mfma_f32_16x16x32_bf16 v[116:119], a[136:139], a[16:19], v[116:119]
ds_read_b64_tr_b16 a[132:133], v24 offset:16384
v_accvgpr_read_b32 v99, a239
v_mfma_f32_16x16x32_bf16 v[116:119], a[140:143], a[20:23], v[116:119]
buffer_load_dwordx4 v13, s[8:11], s24 offen offset:1024 lds
v_mfma_f32_16x16x32_bf16 v[124:127], a[136:139], a[24:27], v[124:127]
ds_read_b64_tr_b16 a[134:135], v24 offset:18432
v_add_u32 v24, 32768, v24
v_mfma_f32_16x16x32_bf16 v[124:127], a[140:143], a[28:31], v[124:127]
v_cvt_pk_bf16_f32 v72, v72, v73
v_cvt_pk_bf16_f32 v73, v74, v75
v_mfma_f32_16x16x32_bf16 v[132:135], a[136:139], a[32:35], v[132:135]
ds_read_b128 a[96:99], v2 offset:57344
v_cvt_pk_bf16_f32 v74, v96, v97
v_mfma_f32_16x16x32_bf16 v[132:135], a[140:143], a[36:39], v[132:135]
buffer_load_dwordx4 v14, s[8:11], s24 offen offset:2048 lds
v_mfma_f32_16x16x32_bf16 v[140:143], a[136:139], a[40:43], v[140:143]
ds_read_b128 a[100:103], v3 offset:57344
v_cvt_pk_bf16_f32 v75, v98, v99
v_mfma_f32_16x16x32_bf16 v[140:143], a[140:143], a[44:47], v[140:143]
ds_read_b128 a[104:107], v2 offset:59392
v_accvgpr_read_b32 v80, a240
v_mfma_f32_16x16x32_bf16 v[148:151], a[136:139], a[48:51], v[148:151]
ds_read_b128 a[108:111], v3 offset:59392
v_accvgpr_read_b32 v81, a241
v_mfma_f32_16x16x32_bf16 v[148:151], a[140:143], a[52:55], v[148:151]
buffer_load_dwordx4 v15, s[8:11], s24 offen offset:3072 lds
v_mfma_f32_16x16x32_bf16 v[156:159], a[136:139], a[56:59], v[156:159]
s_add_u32 s24, s24, 128
ds_read_b128 a[112:115], v2 offset:61440
v_accvgpr_read_b32 v82, a242
v_mfma_f32_16x16x32_bf16 v[156:159], a[140:143], a[60:63], v[156:159]
s_waitcnt lgkmcnt(5)
buffer_store_dwordx4 v[176:179], v1, s[4:7], s31 offen sc1
v_mfma_f32_16x16x32_bf16 v[164:167], a[128:131], a[0:3], v[164:167]
s_add_u32 s31, s31, s32
ds_read_b64_tr_b16 a[136:137], v25 offset:0
v_accvgpr_read_b32 v83, a243
v_mfma_f32_16x16x32_bf16 v[164:167], a[132:135], a[4:7], v[164:167]
v_accvgpr_read_b32 v96, a244
v_accvgpr_read_b32 v97, a245
v_mfma_f32_16x16x32_bf16 v[172:175], a[128:131], a[8:11], v[172:175]
ds_read_b64_tr_b16 a[138:139], v25 offset:2048
v_accvgpr_read_b32 v98, a246
v_mfma_f32_16x16x32_bf16 v[172:175], a[132:135], a[12:15], v[172:175]
ds_read_b128 a[116:119], v3 offset:61440
v_accvgpr_read_b32 v99, a247
v_mfma_f32_16x16x32_bf16 v[180:183], a[128:131], a[16:19], v[180:183]
ds_read_b64_tr_b16 a[140:141], v25 offset:16384
v_cvt_pk_bf16_f32 v80, v80, v81
v_mfma_f32_16x16x32_bf16 v[180:183], a[132:135], a[20:23], v[180:183]
buffer_store_dwordx4 v[184:187], v1, s[4:7], s31 offen sc1
v_mfma_f32_16x16x32_bf16 v[188:191], a[128:131], a[24:27], v[188:191]
s_add_u32 s31, s31, s34
ds_read_b64_tr_b16 a[142:143], v25 offset:18432
v_add_u32 v25, 32768, v25
v_mfma_f32_16x16x32_bf16 v[188:191], a[132:135], a[28:31], v[188:191]
v_cvt_pk_bf16_f32 v81, v82, v83
v_cvt_pk_bf16_f32 v82, v96, v97
v_mfma_f32_16x16x32_bf16 v[196:199], a[128:131], a[32:35], v[196:199]
ds_read_b128 a[120:123], v2 offset:63488
v_cvt_pk_bf16_f32 v83, v98, v99
v_mfma_f32_16x16x32_bf16 v[196:199], a[132:135], a[36:39], v[196:199]
v_accvgpr_read_b32 v88, a248
v_accvgpr_read_b32 v89, a249
v_mfma_f32_16x16x32_bf16 v[204:207], a[128:131], a[40:43], v[204:207]
ds_read_b128 a[124:127], v3 offset:63488
v_accvgpr_read_b32 v90, a250
v_mfma_f32_16x16x32_bf16 v[204:207], a[132:135], a[44:47], v[204:207]
v_accvgpr_read_b32 v91, a251
v_accvgpr_read_b32 v96, a252
v_mfma_f32_16x16x32_bf16 v[212:215], a[128:131], a[48:51], v[212:215]
v_accvgpr_read_b32 v97, a253
v_accvgpr_read_b32 v98, a254
v_mfma_f32_16x16x32_bf16 v[212:215], a[132:135], a[52:55], v[212:215]
v_accvgpr_read_b32 v99, a255
v_cvt_pk_bf16_f32 v88, v88, v89
v_mfma_f32_16x16x32_bf16 v[220:223], a[128:131], a[56:59], v[220:223]
v_cvt_pk_bf16_f32 v89, v90, v91
v_cvt_pk_bf16_f32 v90, v96, v97
v_mfma_f32_16x16x32_bf16 v[220:223], a[132:135], a[60:63], v[220:223]
s_waitcnt vmcnt(23) lgkmcnt(0)
s_barrier
v_cvt_pk_bf16_f32 v91, v98, v99
v_mfma_f32_16x16x32_bf16 v[224:227], a[136:139], a[0:3], v[224:227]
s_add_u32 m0, s29, 98304
ds_read_b64_tr_b16 a[128:129], v22 offset:0
v_mfma_f32_16x16x32_bf16 v[224:227], a[140:143], a[4:7], v[224:227]
buffer_load_dwordx4 v16, s[12:15], s26 offen offset:0 lds
v_mfma_f32_16x16x32_bf16 v[228:231], a[136:139], a[8:11], v[228:231]
ds_read_b64_tr_b16 a[130:131], v22 offset:2048
v_mfma_f32_16x16x32_bf16 v[228:231], a[140:143], a[12:15], v[228:231]
buffer_store_dwordx4 v[192:195], v1, s[4:7], s31 offen sc1
v_mfma_f32_16x16x32_bf16 v[232:235], a[136:139], a[16:19], v[232:235]
s_add_u32 s31, s31, s32
ds_read_b64_tr_b16 a[132:133], v22 offset:16384
v_mfma_f32_16x16x32_bf16 v[232:235], a[140:143], a[20:23], v[232:235]
buffer_load_dwordx4 v17, s[12:15], s26 offen offset:1024 lds
v_mfma_f32_16x16x32_bf16 v[236:239], a[136:139], a[24:27], v[236:239]
ds_read_b64_tr_b16 a[134:135], v22 offset:18432
v_add_u32 v22, 4294901760, v22
v_mfma_f32_16x16x32_bf16 v[236:239], a[140:143], a[28:31], v[236:239]
v_mfma_f32_16x16x32_bf16 v[240:243], a[136:139], a[32:35], v[240:243]
v_mfma_f32_16x16x32_bf16 v[240:243], a[140:143], a[36:39], v[240:243]
buffer_load_dwordx4 v18, s[12:15], s26 offen offset:2048 lds
v_mfma_f32_16x16x32_bf16 v[244:247], a[136:139], a[40:43], v[244:247]
v_mfma_f32_16x16x32_bf16 v[244:247], a[140:143], a[44:47], v[244:247]
v_mfma_f32_16x16x32_bf16 v[248:251], a[136:139], a[48:51], v[248:251]
v_mfma_f32_16x16x32_bf16 v[248:251], a[140:143], a[52:55], v[248:251]
buffer_load_dwordx4 v19, s[12:15], s26 offen offset:3072 lds
v_mfma_f32_16x16x32_bf16 v[252:255], a[136:139], a[56:59], v[252:255]
s_add_u32 s26, s26, 524288
v_mfma_f32_16x16x32_bf16 v[252:255], a[140:143], a[60:63], v[252:255]
s_waitcnt lgkmcnt(0)
v_mfma_f32_16x16x32_bf16 v[36:39], a[128:131], a[64:67], v[36:39]
s_add_u32 m0, s29, 114688
ds_read_b64_tr_b16 a[136:137], v23 offset:0
v_mfma_f32_16x16x32_bf16 v[36:39], a[132:135], a[68:71], v[36:39]
buffer_load_dwordx4 v16, s[12:15], s27 offen offset:0 lds
v_mfma_f32_16x16x32_bf16 v[44:47], a[128:131], a[72:75], v[44:47]
ds_read_b64_tr_b16 a[138:139], v23 offset:2048
v_mfma_f32_16x16x32_bf16 v[44:47], a[132:135], a[76:79], v[44:47]
ds_read_b128 a[0:3], v2 offset:0
ds_read_b128 a[4:7], v3 offset:0
v_mfma_f32_16x16x32_bf16 v[52:55], a[128:131], a[80:83], v[52:55]
ds_read_b64_tr_b16 a[140:141], v23 offset:16384
v_mfma_f32_16x16x32_bf16 v[52:55], a[132:135], a[84:87], v[52:55]
buffer_load_dwordx4 v17, s[12:15], s27 offen offset:1024 lds
v_mfma_f32_16x16x32_bf16 v[60:63], a[128:131], a[88:91], v[60:63]
ds_read_b64_tr_b16 a[142:143], v23 offset:18432
v_add_u32 v23, 4294901760, v23
v_mfma_f32_16x16x32_bf16 v[60:63], a[132:135], a[92:95], v[60:63]
buffer_store_dwordx4 v[200:203], v1, s[4:7], s31 offen sc1
v_mfma_f32_16x16x32_bf16 v[68:71], a[128:131], a[96:99], v[68:71]
s_add_u32 s31, s31, s33
ds_read_b128 a[8:11], v2 offset:2048
v_mfma_f32_16x16x32_bf16 v[68:71], a[132:135], a[100:103], v[68:71]
buffer_load_dwordx4 v18, s[12:15], s27 offen offset:2048 lds
v_mfma_f32_16x16x32_bf16 v[76:79], a[128:131], a[104:107], v[76:79]
ds_read_b128 a[12:15], v3 offset:2048
v_mfma_f32_16x16x32_bf16 v[76:79], a[132:135], a[108:111], v[76:79]
ds_read_b128 a[16:19], v2 offset:4096
v_mfma_f32_16x16x32_bf16 v[84:87], a[128:131], a[112:115], v[84:87]
ds_read_b128 a[20:23], v3 offset:4096
v_mfma_f32_16x16x32_bf16 v[84:87], a[132:135], a[116:119], v[84:87]
buffer_load_dwordx4 v19, s[12:15], s27 offen offset:3072 lds
v_mfma_f32_16x16x32_bf16 v[92:95], a[128:131], a[120:123], v[92:95]
s_add_u32 s27, s27, 524288
ds_read_b128 a[24:27], v2 offset:6144
v_mfma_f32_16x16x32_bf16 v[92:95], a[132:135], a[124:127], v[92:95]
s_waitcnt lgkmcnt(5)
buffer_store_dwordx4 v[208:211], v1, s[4:7], s31 offen sc1
v_mfma_f32_16x16x32_bf16 v[100:103], a[136:139], a[64:67], v[100:103]
s_add_u32 s31, s31, s32
ds_read_b64_tr_b16 a[128:129], v24 offset:0
v_mfma_f32_16x16x32_bf16 v[100:103], a[140:143], a[68:71], v[100:103]
v_mfma_f32_16x16x32_bf16 v[108:111], a[136:139], a[72:75], v[108:111]
ds_read_b64_tr_b16 a[130:131], v24 offset:2048
v_mfma_f32_16x16x32_bf16 v[108:111], a[140:143], a[76:79], v[108:111]
ds_read_b128 a[28:31], v3 offset:6144
v_mfma_f32_16x16x32_bf16 v[116:119], a[136:139], a[80:83], v[116:119]
ds_read_b64_tr_b16 a[132:133], v24 offset:16384
v_mfma_f32_16x16x32_bf16 v[116:119], a[140:143], a[84:87], v[116:119]
v_mfma_f32_16x16x32_bf16 v[124:127], a[136:139], a[88:91], v[124:127]
ds_read_b64_tr_b16 a[134:135], v24 offset:18432
v_add_u32 v24, 4294901760, v24
v_mfma_f32_16x16x32_bf16 v[124:127], a[140:143], a[92:95], v[124:127]
v_mfma_f32_16x16x32_bf16 v[132:135], a[136:139], a[96:99], v[132:135]
ds_read_b128 a[32:35], v2 offset:8192
v_mfma_f32_16x16x32_bf16 v[132:135], a[140:143], a[100:103], v[132:135]
buffer_store_dwordx4 v[216:219], v1, s[4:7], s31 offen sc1
v_mfma_f32_16x16x32_bf16 v[140:143], a[136:139], a[104:107], v[140:143]
s_add_u32 s31, s31, s35
ds_read_b128 a[36:39], v3 offset:8192
v_mfma_f32_16x16x32_bf16 v[140:143], a[140:143], a[108:111], v[140:143]
ds_read_b128 a[40:43], v2 offset:10240
v_mfma_f32_16x16x32_bf16 v[148:151], a[136:139], a[112:115], v[148:151]
ds_read_b128 a[44:47], v3 offset:10240
v_mfma_f32_16x16x32_bf16 v[148:151], a[140:143], a[116:119], v[148:151]
v_mfma_f32_16x16x32_bf16 v[156:159], a[136:139], a[120:123], v[156:159]
ds_read_b128 a[48:51], v2 offset:12288
v_mfma_f32_16x16x32_bf16 v[156:159], a[140:143], a[124:127], v[156:159]
s_waitcnt lgkmcnt(5)
v_mfma_f32_16x16x32_bf16 v[164:167], a[128:131], a[64:67], v[164:167]
ds_read_b64_tr_b16 a[136:137], v25 offset:0
v_mfma_f32_16x16x32_bf16 v[164:167], a[132:135], a[68:71], v[164:167]
v_mfma_f32_16x16x32_bf16 v[172:175], a[128:131], a[72:75], v[172:175]
ds_read_b64_tr_b16 a[138:139], v25 offset:2048
v_mfma_f32_16x16x32_bf16 v[172:175], a[132:135], a[76:79], v[172:175]
ds_read_b128 a[52:55], v3 offset:12288
v_mfma_f32_16x16x32_bf16 v[180:183], a[128:131], a[80:83], v[180:183]
ds_read_b64_tr_b16 a[140:141], v25 offset:16384
v_mfma_f32_16x16x32_bf16 v[180:183], a[132:135], a[84:87], v[180:183]
buffer_store_dwordx4 v[32:35], v1, s[4:7], s31 offen sc1
v_mfma_f32_16x16x32_bf16 v[188:191], a[128:131], a[88:91], v[188:191]
s_add_u32 s31, s31, s32
ds_read_b64_tr_b16 a[142:143], v25 offset:18432
v_add_u32 v25, 4294901760, v25
v_mfma_f32_16x16x32_bf16 v[188:191], a[132:135], a[92:95], v[188:191]
v_mfma_f32_16x16x32_bf16 v[196:199], a[128:131], a[96:99], v[196:199]
ds_read_b128 a[56:59], v2 offset:14336
v_mfma_f32_16x16x32_bf16 v[196:199], a[132:135], a[100:103], v[196:199]
v_mfma_f32_16x16x32_bf16 v[204:207], a[128:131], a[104:107], v[204:207]
ds_read_b128 a[60:63], v3 offset:14336
v_mfma_f32_16x16x32_bf16 v[204:207], a[132:135], a[108:111], v[204:207]
v_mfma_f32_16x16x32_bf16 v[212:215], a[128:131], a[112:115], v[212:215]
v_mfma_f32_16x16x32_bf16 v[212:215], a[132:135], a[116:119], v[212:215]
v_mfma_f32_16x16x32_bf16 v[220:223], a[128:131], a[120:123], v[220:223]
v_mfma_f32_16x16x32_bf16 v[220:223], a[132:135], a[124:127], v[220:223]
s_waitcnt vmcnt(20) lgkmcnt(0)
s_barrier
v_mfma_f32_16x16x32_bf16 v[224:227], a[136:139], a[64:67], v[224:227]
s_add_u32 m0, s29, 131072
ds_read_b64_tr_b16 a[128:129], v22 offset:0
v_mfma_f32_16x16x32_bf16 v[224:227], a[140:143], a[68:71], v[224:227]
buffer_load_dwordx4 v16, s[12:15], s26 offen offset:0 lds
v_mfma_f32_16x16x32_bf16 v[228:231], a[136:139], a[72:75], v[228:231]
ds_read_b64_tr_b16 a[130:131], v22 offset:2048
v_mfma_f32_16x16x32_bf16 v[228:231], a[140:143], a[76:79], v[228:231]
PAD_7:
s_cbranch_execz M_tret
buffer_store_dwordx4 v[40:43], v1, s[4:7], s31 offen sc1
v_mfma_f32_16x16x32_bf16 v[232:235], a[136:139], a[80:83], v[232:235]
s_add_u32 s31, s31, s33
ds_read_b64_tr_b16 a[132:133], v22 offset:16384
v_mfma_f32_16x16x32_bf16 v[232:235], a[140:143], a[84:87], v[232:235]
buffer_load_dwordx4 v17, s[12:15], s26 offen offset:1024 lds
v_mfma_f32_16x16x32_bf16 v[236:239], a[136:139], a[88:91], v[236:239]
ds_read_b64_tr_b16 a[134:135], v22 offset:18432
v_add_u32 v22, 32768, v22
v_mfma_f32_16x16x32_bf16 v[236:239], a[140:143], a[92:95], v[236:239]
v_mfma_f32_16x16x32_bf16 v[240:243], a[136:139], a[96:99], v[240:243]
v_mfma_f32_16x16x32_bf16 v[240:243], a[140:143], a[100:103], v[240:243]
buffer_load_dwordx4 v18, s[12:15], s26 offen offset:2048 lds
v_mfma_f32_16x16x32_bf16 v[244:247], a[136:139], a[104:107], v[244:247]
v_mfma_f32_16x16x32_bf16 v[244:247], a[140:143], a[108:111], v[244:247]
v_mfma_f32_16x16x32_bf16 v[248:251], a[136:139], a[112:115], v[248:251]
v_mfma_f32_16x16x32_bf16 v[248:251], a[140:143], a[116:119], v[248:251]
buffer_load_dwordx4 v19, s[12:15], s26 offen offset:3072 lds
v_mfma_f32_16x16x32_bf16 v[252:255], a[136:139], a[120:123], v[252:255]
s_add_u32 s26, s26, 524288
v_mfma_f32_16x16x32_bf16 v[252:255], a[140:143], a[124:127], v[252:255]
s_waitcnt lgkmcnt(0)
v_mfma_f32_16x16x32_bf16 v[36:39], a[128:131], a[0:3], v[36:39]
s_add_u32 m0, s29, 147456
ds_read_b64_tr_b16 a[136:137], v23 offset:0
v_mfma_f32_16x16x32_bf16 v[36:39], a[132:135], a[4:7], v[36:39]
buffer_load_dwordx4 v16, s[12:15], s27 offen offset:0 lds
v_mfma_f32_16x16x32_bf16 v[44:47], a[128:131], a[8:11], v[44:47]
s_lshl_b32 s22, s20, 7
ds_read_b64_tr_b16 a[138:139], v23 offset:2048
v_bfe_u32 v20, v1, 4, 3
v_mfma_f32_16x16x32_bf16 v[44:47], a[132:135], a[12:15], v[44:47]
s_add_u32 s70, s22, 94371840
ds_read_b128 a[64:67], v2 offset:16384
ds_read_b128 a[68:71], v3 offset:16384
v_mfma_f32_16x16x32_bf16 v[52:55], a[128:131], a[16:19], v[52:55]
s_lshr_b32 s22, s2, 4
ds_read_b64_tr_b16 a[140:141], v23 offset:16384
v_lshlrev_b32 v20, 3, v20
v_mfma_f32_16x16x32_bf16 v[52:55], a[132:135], a[20:23], v[52:55]
s_lshl_b32 s22, s22, 2
buffer_load_dwordx4 v17, s[12:15], s27 offen offset:1024 lds
v_mfma_f32_16x16x32_bf16 v[60:63], a[128:131], a[24:27], v[60:63]
s_add_u32 s66, s70, s22
ds_read_b64_tr_b16 a[142:143], v23 offset:18432
v_add_u32 v23, 32768, v23
v_mfma_f32_16x16x32_bf16 v[60:63], a[132:135], a[28:31], v[60:63]
s_and_b32 s22, s2, 16
buffer_store_dwordx4 v[48:51], v1, s[4:7], s31 offen sc1
v_mfma_f32_16x16x32_bf16 v[68:71], a[128:131], a[32:35], v[68:71]
s_add_u32 s31, s31, s32
ds_read_b128 a[72:75], v2 offset:18432
v_add_u32 v15, 2052, v20
v_mfma_f32_16x16x32_bf16 v[68:71], a[132:135], a[36:39], v[68:71]
s_lshl_b32 s22, s22, 7
buffer_load_dwordx4 v18, s[12:15], s27 offen offset:2048 lds
v_mfma_f32_16x16x32_bf16 v[76:79], a[128:131], a[40:43], v[76:79]
s_add_u32 s66, s66, s22
ds_read_b128 a[76:79], v3 offset:18432
v_mfma_f32_16x16x32_bf16 v[76:79], a[132:135], a[44:47], v[76:79]
s_lshl_b32 s67, s20, 20
ds_read_b128 a[80:83], v2 offset:20480
v_mfma_f32_16x16x32_bf16 v[84:87], a[128:131], a[48:51], v[84:87]
s_lshl_b32 s22, s37, 16
ds_read_b128 a[84:87], v3 offset:20480
v_mfma_f32_16x16x32_bf16 v[84:87], a[132:135], a[52:55], v[84:87]
s_add_u32 s67, s67, s22
buffer_load_dwordx4 v19, s[12:15], s27 offen offset:3072 lds
v_mfma_f32_16x16x32_bf16 v[92:95], a[128:131], a[56:59], v[92:95]
s_waitcnt lgkmcnt(5)
s_add_u32 s27, s27, 524288
ds_read_b128 a[88:91], v2 offset:22528
v_mfma_f32_16x16x32_bf16 v[92:95], a[132:135], a[60:63], v[92:95]
s_lshl_b32 s22, s3, 11
buffer_store_dwordx4 v[56:59], v1, s[4:7], s31 offen sc1
v_mfma_f32_16x16x32_bf16 v[100:103], a[136:139], a[0:3], v[100:103]
s_waitcnt lgkmcnt(5)
s_add_u32 s31, s31, s34
ds_read_b64_tr_b16 a[128:129], v24 offset:0
v_mfma_f32_16x16x32_bf16 v[100:103], a[140:143], a[4:7], v[100:103]
s_add_u32 s67, s67, s22
v_mfma_f32_16x16x32_bf16 v[108:111], a[136:139], a[8:11], v[108:111]
s_add_u32 s67, s67, 33554432
ds_read_b64_tr_b16 a[130:131], v24 offset:2048
v_mfma_f32_16x16x32_bf16 v[108:111], a[140:143], a[12:15], v[108:111]
s_mov_b32 s68, 1035512379
ds_read_b128 a[92:95], v3 offset:22528
v_mfma_f32_16x16x32_bf16 v[116:119], a[136:139], a[16:19], v[116:119]
s_mov_b32 s69, 1035512379
ds_read_b64_tr_b16 a[132:133], v24 offset:16384
v_mfma_f32_16x16x32_bf16 v[116:119], a[140:143], a[20:23], v[116:119]
buffer_store_dwordx4 v[64:67], v1, s[4:7], s31 offen sc1
v_mfma_f32_16x16x32_bf16 v[124:127], a[136:139], a[24:27], v[124:127]
s_add_u32 s31, s31, s32
ds_read_b64_tr_b16 a[134:135], v24 offset:18432
v_add_u32 v24, 32768, v24
v_mfma_f32_16x16x32_bf16 v[124:127], a[140:143], a[28:31], v[124:127]
v_mfma_f32_16x16x32_bf16 v[132:135], a[136:139], a[32:35], v[132:135]
ds_read_b128 a[96:99], v2 offset:24576
v_mfma_f32_16x16x32_bf16 v[132:135], a[140:143], a[36:39], v[132:135]
v_mfma_f32_16x16x32_bf16 v[140:143], a[136:139], a[40:43], v[140:143]
ds_read_b128 a[100:103], v3 offset:24576
v_mfma_f32_16x16x32_bf16 v[140:143], a[140:143], a[44:47], v[140:143]
ds_read_b128 a[104:107], v2 offset:26624
v_mfma_f32_16x16x32_bf16 v[148:151], a[136:139], a[48:51], v[148:151]
ds_read_b128 a[108:111], v3 offset:26624
v_mfma_f32_16x16x32_bf16 v[148:151], a[140:143], a[52:55], v[148:151]
v_mfma_f32_16x16x32_bf16 v[156:159], a[136:139], a[56:59], v[156:159]
ds_read_b128 a[112:115], v2 offset:28672
v_mfma_f32_16x16x32_bf16 v[156:159], a[140:143], a[60:63], v[156:159]
s_waitcnt lgkmcnt(5)
buffer_store_dwordx4 v[72:75], v1, s[4:7], s31 offen sc1
v_mfma_f32_16x16x32_bf16 v[164:167], a[128:131], a[0:3], v[164:167]
s_add_u32 s31, s31, s33
ds_read_b64_tr_b16 a[136:137], v25 offset:0
v_mfma_f32_16x16x32_bf16 v[164:167], a[132:135], a[4:7], v[164:167]
v_mfma_f32_16x16x32_bf16 v[172:175], a[128:131], a[8:11], v[172:175]
ds_read_b64_tr_b16 a[138:139], v25 offset:2048
v_mfma_f32_16x16x32_bf16 v[172:175], a[132:135], a[12:15], v[172:175]
ds_read_b128 a[116:119], v3 offset:28672
v_mfma_f32_16x16x32_bf16 v[180:183], a[128:131], a[16:19], v[180:183]
ds_read_b64_tr_b16 a[140:141], v25 offset:16384
v_mfma_f32_16x16x32_bf16 v[180:183], a[132:135], a[20:23], v[180:183]
v_mfma_f32_16x16x32_bf16 v[188:191], a[128:131], a[24:27], v[188:191]
ds_read_b64_tr_b16 a[142:143], v25 offset:18432
v_add_u32 v25, 32768, v25
v_mfma_f32_16x16x32_bf16 v[188:191], a[132:135], a[28:31], v[188:191]
v_mfma_f32_16x16x32_bf16 v[196:199], a[128:131], a[32:35], v[196:199]
ds_read_b128 a[120:123], v2 offset:30720
v_mfma_f32_16x16x32_bf16 v[196:199], a[132:135], a[36:39], v[196:199]
buffer_store_dwordx4 v[80:83], v1, s[4:7], s31 offen sc1
v_mfma_f32_16x16x32_bf16 v[204:207], a[128:131], a[40:43], v[204:207]
s_add_u32 s31, s31, s32
ds_read_b128 a[124:127], v3 offset:30720
v_mfma_f32_16x16x32_bf16 v[204:207], a[132:135], a[44:47], v[204:207]
v_mfma_f32_16x16x32_bf16 v[212:215], a[128:131], a[48:51], v[212:215]
v_mfma_f32_16x16x32_bf16 v[212:215], a[132:135], a[52:55], v[212:215]
v_mfma_f32_16x16x32_bf16 v[220:223], a[128:131], a[56:59], v[220:223]
v_mfma_f32_16x16x32_bf16 v[220:223], a[132:135], a[60:63], v[220:223]
s_waitcnt vmcnt(17) lgkmcnt(0)
s_barrier
v_mfma_f32_16x16x32_bf16 v[224:227], a[136:139], a[0:3], v[224:227]
ds_read_b64_tr_b16 a[128:129], v22 offset:0
v_mfma_f32_16x16x32_bf16 v[224:227], a[140:143], a[4:7], v[224:227]
v_mfma_f32_16x16x32_bf16 v[228:231], a[136:139], a[8:11], v[228:231]
ds_read_b64_tr_b16 a[130:131], v22 offset:2048
v_mfma_f32_16x16x32_bf16 v[228:231], a[140:143], a[12:15], v[228:231]
buffer_store_dwordx4 v[88:91], v1, s[4:7], s31 offen sc1
v_mfma_f32_16x16x32_bf16 v[232:235], a[136:139], a[16:19], v[232:235]
ds_read_b64_tr_b16 a[132:133], v22 offset:16384
v_mfma_f32_16x16x32_bf16 v[232:235], a[140:143], a[20:23], v[232:235]
v_mfma_f32_16x16x32_bf16 v[236:239], a[136:139], a[24:27], v[236:239]
ds_read_b64_tr_b16 a[134:135], v22 offset:18432
v_add_u32 v22, 32768, v22
v_mfma_f32_16x16x32_bf16 v[236:239], a[140:143], a[28:31], v[236:239]
v_mfma_f32_16x16x32_bf16 v[240:243], a[136:139], a[32:35], v[240:243]
v_mfma_f32_16x16x32_bf16 v[240:243], a[140:143], a[36:39], v[240:243]
v_mfma_f32_16x16x32_bf16 v[244:247], a[136:139], a[40:43], v[244:247]
v_mfma_f32_16x16x32_bf16 v[244:247], a[140:143], a[44:47], v[244:247]
v_mfma_f32_16x16x32_bf16 v[248:251], a[136:139], a[48:51], v[248:251]
v_mfma_f32_16x16x32_bf16 v[248:251], a[140:143], a[52:55], v[248:251]
v_mfma_f32_16x16x32_bf16 v[252:255], a[136:139], a[56:59], v[252:255]
v_mfma_f32_16x16x32_bf16 v[252:255], a[140:143], a[60:63], v[252:255]
s_waitcnt lgkmcnt(0)
v_mfma_f32_16x16x32_bf16 v[36:39], a[128:131], a[64:67], v[36:39]
ds_read_b64_tr_b16 a[136:137], v23 offset:0
v_mfma_f32_16x16x32_bf16 v[36:39], a[132:135], a[68:71], v[36:39]
v_mfma_f32_16x16x32_bf16 v[44:47], a[128:131], a[72:75], v[44:47]
ds_read_b64_tr_b16 a[138:139], v23 offset:2048
v_mfma_f32_16x16x32_bf16 v[44:47], a[132:135], a[76:79], v[44:47]
ds_read_b128 a[0:3], v2 offset:32768
ds_read_b128 a[4:7], v3 offset:32768
v_mfma_f32_16x16x32_bf16 v[52:55], a[128:131], a[80:83], v[52:55]
ds_read_b64_tr_b16 a[140:141], v23 offset:16384
v_mfma_f32_16x16x32_bf16 v[52:55], a[132:135], a[84:87], v[52:55]
v_mfma_f32_16x16x32_bf16 v[60:63], a[128:131], a[88:91], v[60:63]
ds_read_b64_tr_b16 a[142:143], v23 offset:18432
v_add_u32 v23, 32768, v23
v_mfma_f32_16x16x32_bf16 v[60:63], a[132:135], a[92:95], v[60:63]
v_mfma_f32_16x16x32_bf16 v[68:71], a[128:131], a[96:99], v[68:71]
ds_read_b128 a[8:11], v2 offset:34816
v_mfma_f32_16x16x32_bf16 v[68:71], a[132:135], a[100:103], v[68:71]
v_mfma_f32_16x16x32_bf16 v[76:79], a[128:131], a[104:107], v[76:79]
ds_read_b128 a[12:15], v3 offset:34816
v_mfma_f32_16x16x32_bf16 v[76:79], a[132:135], a[108:111], v[76:79]
ds_read_b128 a[16:19], v2 offset:36864
v_mfma_f32_16x16x32_bf16 v[84:87], a[128:131], a[112:115], v[84:87]
ds_read_b128 a[20:23], v3 offset:36864
v_mfma_f32_16x16x32_bf16 v[84:87], a[132:135], a[116:119], v[84:87]
v_mfma_f32_16x16x32_bf16 v[92:95], a[128:131], a[120:123], v[92:95]
ds_read_b128 a[24:27], v2 offset:38912
v_mfma_f32_16x16x32_bf16 v[92:95], a[132:135], a[124:127], v[92:95]
s_waitcnt lgkmcnt(5)
v_mfma_f32_16x16x32_bf16 v[100:103], a[136:139], a[64:67], v[100:103]
ds_read_b64_tr_b16 a[128:129], v24 offset:0
v_mfma_f32_16x16x32_bf16 v[100:103], a[140:143], a[68:71], v[100:103]
v_mfma_f32_16x16x32_bf16 v[108:111], a[136:139], a[72:75], v[108:111]
ds_read_b64_tr_b16 a[130:131], v24 offset:2048
v_mfma_f32_16x16x32_bf16 v[108:111], a[140:143], a[76:79], v[108:111]
ds_read_b128 a[28:31], v3 offset:38912
v_mfma_f32_16x16x32_bf16 v[116:119], a[136:139], a[80:83], v[116:119]
ds_read_b64_tr_b16 a[132:133], v24 offset:16384
v_mfma_f32_16x16x32_bf16 v[116:119], a[140:143], a[84:87], v[116:119]
v_mfma_f32_16x16x32_bf16 v[124:127], a[136:139], a[88:91], v[124:127]
ds_read_b64_tr_b16 a[134:135], v24 offset:18432
v_add_u32 v24, 32768, v24
v_mfma_f32_16x16x32_bf16 v[124:127], a[140:143], a[92:95], v[124:127]
v_mfma_f32_16x16x32_bf16 v[132:135], a[136:139], a[96:99], v[132:135]
ds_read_b128 a[32:35], v2 offset:40960
v_mfma_f32_16x16x32_bf16 v[132:135], a[140:143], a[100:103], v[132:135]
v_mfma_f32_16x16x32_bf16 v[140:143], a[136:139], a[104:107], v[140:143]
ds_read_b128 a[36:39], v3 offset:40960
v_mfma_f32_16x16x32_bf16 v[140:143], a[140:143], a[108:111], v[140:143]
ds_read_b128 a[40:43], v2 offset:43008
v_mfma_f32_16x16x32_bf16 v[148:151], a[136:139], a[112:115], v[148:151]
ds_read_b128 a[44:47], v3 offset:43008
v_mfma_f32_16x16x32_bf16 v[148:151], a[140:143], a[116:119], v[148:151]
v_mfma_f32_16x16x32_bf16 v[156:159], a[136:139], a[120:123], v[156:159]
ds_read_b128 a[48:51], v2 offset:45056
v_mfma_f32_16x16x32_bf16 v[156:159], a[140:143], a[124:127], v[156:159]
s_waitcnt lgkmcnt(5)
v_mfma_f32_16x16x32_bf16 v[164:167], a[128:131], a[64:67], v[164:167]
ds_read_b64_tr_b16 a[136:137], v25 offset:0
v_mfma_f32_16x16x32_bf16 v[164:167], a[132:135], a[68:71], v[164:167]
v_mfma_f32_16x16x32_bf16 v[172:175], a[128:131], a[72:75], v[172:175]
ds_read_b64_tr_b16 a[138:139], v25 offset:2048
v_mfma_f32_16x16x32_bf16 v[172:175], a[132:135], a[76:79], v[172:175]
ds_read_b128 a[52:55], v3 offset:45056
v_mfma_f32_16x16x32_bf16 v[180:183], a[128:131], a[80:83], v[180:183]
ds_read_b64_tr_b16 a[140:141], v25 offset:16384
v_mfma_f32_16x16x32_bf16 v[180:183], a[132:135], a[84:87], v[180:183]
v_mfma_f32_16x16x32_bf16 v[188:191], a[128:131], a[88:91], v[188:191]
ds_read_b64_tr_b16 a[142:143], v25 offset:18432
v_add_u32 v25, 32768, v25
v_mfma_f32_16x16x32_bf16 v[188:191], a[132:135], a[92:95], v[188:191]
v_mfma_f32_16x16x32_bf16 v[196:199], a[128:131], a[96:99], v[196:199]
ds_read_b128 a[56:59], v2 offset:47104
v_mfma_f32_16x16x32_bf16 v[196:199], a[132:135], a[100:103], v[196:199]
v_mfma_f32_16x16x32_bf16 v[204:207], a[128:131], a[104:107], v[204:207]
ds_read_b128 a[60:63], v3 offset:47104
v_mfma_f32_16x16x32_bf16 v[204:207], a[132:135], a[108:111], v[204:207]
v_mfma_f32_16x16x32_bf16 v[212:215], a[128:131], a[112:115], v[212:215]
v_mfma_f32_16x16x32_bf16 v[212:215], a[132:135], a[116:119], v[212:215]
v_mfma_f32_16x16x32_bf16 v[220:223], a[128:131], a[120:123], v[220:223]
v_mfma_f32_16x16x32_bf16 v[220:223], a[132:135], a[124:127], v[220:223]
s_waitcnt vmcnt(0) lgkmcnt(0)
s_barrier
v_mfma_f32_16x16x32_bf16 v[224:227], a[136:139], a[64:67], v[224:227]
ds_read_b64_tr_b16 a[128:129], v22 offset:0
v_mfma_f32_16x16x32_bf16 v[224:227], a[140:143], a[68:71], v[224:227]
buffer_store_dword v27, v26, s[4:7], s66 offen sc1
v_mfma_f32_16x16x32_bf16 v[228:231], a[136:139], a[72:75], v[228:231]
ds_read_b64_tr_b16 a[130:131], v22 offset:2048
v_mfma_f32_16x16x32_bf16 v[228:231], a[140:143], a[76:79], v[228:231]
v_mfma_f32_16x16x32_bf16 v[232:235], a[136:139], a[80:83], v[232:235]
ds_read_b64_tr_b16 a[132:133], v22 offset:16384
v_mfma_f32_16x16x32_bf16 v[232:235], a[140:143], a[84:87], v[232:235]
v_mfma_f32_16x16x32_bf16 v[236:239], a[136:139], a[88:91], v[236:239]
ds_read_b64_tr_b16 a[134:135], v22 offset:18432
v_mfma_f32_16x16x32_bf16 v[236:239], a[140:143], a[92:95], v[236:239]
v_mfma_f32_16x16x32_bf16 v[240:243], a[136:139], a[96:99], v[240:243]
v_mfma_f32_16x16x32_bf16 v[240:243], a[140:143], a[100:103], v[240:243]
v_mfma_f32_16x16x32_bf16 v[244:247], a[136:139], a[104:107], v[244:247]
v_mfma_f32_16x16x32_bf16 v[244:247], a[140:143], a[108:111], v[244:247]
v_mfma_f32_16x16x32_bf16 v[248:251], a[136:139], a[112:115], v[248:251]
v_mfma_f32_16x16x32_bf16 v[248:251], a[140:143], a[116:119], v[248:251]
v_mfma_f32_16x16x32_bf16 v[252:255], a[136:139], a[120:123], v[252:255]
v_mfma_f32_16x16x32_bf16 v[252:255], a[140:143], a[124:127], v[252:255]
s_waitcnt lgkmcnt(0)
v_mfma_f32_16x16x32_bf16 v[36:39], a[128:131], a[0:3], v[36:39]
s_lshl_b32 s18, s3, 13
ds_read_b64_tr_b16 a[136:137], v23 offset:0
v_lshrrev_b32 v28, 6, v0
v_mfma_f32_16x16x32_bf16 v[36:39], a[132:135], a[4:7], v[36:39]
s_lshl_b32 s30, s20, 20
v_lshl_add_u32 v28, v28, 11, v1
v_add_u32 v28, 65536, v28
v_mfma_f32_16x16x32_bf16 v[44:47], a[128:131], a[8:11], v[44:47]
s_add_u32 s30, s30, s18
ds_read_b64_tr_b16 a[138:139], v23 offset:2048
v_lshrrev_b32 v3, 6, v0
v_mfma_f32_16x16x32_bf16 v[44:47], a[132:135], a[12:15], v[44:47]
s_lshl_b32 s22, s21, 1
v_and_b32 v4, 63, v0
v_add_u32 v2, 0x10000, v1
v_mfma_f32_16x16x32_bf16 v[52:55], a[128:131], a[16:19], v[52:55]
s_and_b32 s84, s2, 1
ds_read_b64_tr_b16 a[140:141], v23 offset:16384
v_and_b32 v5, 15, v4
v_mfma_f32_16x16x32_bf16 v[52:55], a[132:135], a[20:23], v[52:55]
s_mul_i32 s84, s84, 0
v_lshrrev_b32 v6, 4, v4
v_lshlrev_b32 v6, 2, v6
v_mfma_f32_16x16x32_bf16 v[60:63], a[128:131], a[24:27], v[60:63]
s_add_u32 s84, s84, 2386092
ds_read_b64_tr_b16 a[142:143], v23 offset:18432
v_sub_u32 v5, v5, v6
v_mfma_f32_16x16x32_bf16 v[60:63], a[132:135], a[28:31], v[60:63]
s_lshl_b32 s85, s21, 2
v_lshl_add_u32 v5, v3, 4, v5
v_cmp_gt_i32 s[32:33], 0, v5
v_mfma_f32_16x16x32_bf16 v[68:71], a[128:131], a[32:35], v[68:71]
s_lshr_b32 s85, s84, s85
v_cmp_gt_i32 s[34:35], 1, v5
v_cmp_gt_i32 s[36:37], 2, v5
v_mfma_f32_16x16x32_bf16 v[68:71], a[132:135], a[36:39], v[68:71]
s_and_b32 s9, s85, 15
v_cmp_gt_i32 s[38:39], 3, v5
v_cmp_gt_i32 s[40:41], 16, v5
v_mfma_f32_16x16x32_bf16 v[76:79], a[128:131], a[40:43], v[76:79]
s_and_b32 s84, s85, 1
v_cmp_gt_i32 s[42:43], 17, v5
v_cmp_gt_i32 s[44:45], 18, v5
v_mfma_f32_16x16x32_bf16 v[76:79], a[132:135], a[44:47], v[76:79]
s_lshl_b32 s84, s84, 17
v_cmp_gt_i32 s[46:47], 19, v5
v_cmp_gt_i32 s[48:49], 32, v5
v_mfma_f32_16x16x32_bf16 v[84:87], a[128:131], a[48:51], v[84:87]
s_add_u32 s84, s84, s18
v_cmp_gt_i32 s[50:51], 33, v5
v_cmp_gt_i32 s[52:53], 34, v5
v_mfma_f32_16x16x32_bf16 v[84:87], a[132:135], a[52:55], v[84:87]
s_xor_b32 s85, s84, 0x20000
v_cmp_gt_i32 s[54:55], 35, v5
v_cmp_gt_i32 s[56:57], 48, v5
v_mfma_f32_16x16x32_bf16 v[92:95], a[128:131], a[56:59], v[92:95]
s_sub_u32 s29, 15, s21
v_cmp_gt_i32 s[58:59], 49, v5
v_cmp_gt_i32 s[60:61], 50, v5
v_mfma_f32_16x16x32_bf16 v[92:95], a[132:135], a[60:63], v[92:95]
s_waitcnt lgkmcnt(0)
v_cmp_gt_i32 s[62:63], 51, v5
v_mov_b32 v7, 0xff800000
v_mfma_f32_16x16x32_bf16 v[100:103], a[136:139], a[0:3], v[100:103]
s_cmp_lg_u32 s9, 0
ds_read_b64_tr_b16 a[128:129], v24 offset:0
v_mov_b32 v6, 1
v_mfma_f32_16x16x32_bf16 v[100:103], a[140:143], a[4:7], v[100:103]
s_cselect_b32 s24, 1, 0
v_mov_b32 v5, v26
v_add_u32 v4, 0x20000, v1
v_mfma_f32_16x16x32_bf16 v[108:111], a[136:139], a[8:11], v[108:111]
s_cselect_b32 s67, s67, 3221225472
ds_read_b64_tr_b16 a[130:131], v24 offset:2048
v_mfma_f32_16x16x32_bf16 v[108:111], a[140:143], a[12:15], v[108:111]
s_lshl_b32 s8, s9, 15
v_mfma_f32_16x16x32_bf16 v[116:119], a[136:139], a[16:19], v[116:119]
s_add_u32 s8, s8, s30
ds_read_b64_tr_b16 a[132:133], v24 offset:16384
v_mfma_f32_16x16x32_bf16 v[116:119], a[140:143], a[20:23], v[116:119]
s_add_u32 s9, s9, s22
v_mfma_f32_16x16x32_bf16 v[124:127], a[136:139], a[24:27], v[124:127]
s_sub_u32 s9, 32, s9
ds_read_b64_tr_b16 a[134:135], v24 offset:18432
v_mul_f32 v36, s68, v36
v_mfma_f32_16x16x32_bf16 v[124:127], a[140:143], a[28:31], v[124:127]
s_bitcmp1_b32 s2, 4
v_mul_f32 v37, s68, v37
v_mul_f32 v38, s68, v38
v_mfma_f32_16x16x32_bf16 v[132:135], a[136:139], a[32:35], v[132:135]
s_cselect_b32 s9, 16, s9
v_mul_f32 v39, s68, v39
v_mul_f32 v100, s68, v100
v_mfma_f32_16x16x32_bf16 v[132:135], a[140:143], a[36:39], v[132:135]
s_cselect_b32 s29, 7, s29
v_mul_f32 v101, s68, v101
v_mul_f32 v102, s68, v102
v_mfma_f32_16x16x32_bf16 v[140:143], a[136:139], a[40:43], v[140:143]
s_mov_b32 s10, 3221225472
v_mul_f32 v103, s68, v103
v_cvt_pk_bf16_f32 v36, v36, v37
v_mfma_f32_16x16x32_bf16 v[140:143], a[140:143], a[44:47], v[140:143]
s_mov_b32 s14, 3221225472
v_cvt_pk_bf16_f32 v37, v38, v39
v_cvt_pk_bf16_f32 v38, v100, v101
v_mfma_f32_16x16x32_bf16 v[148:151], a[136:139], a[48:51], v[148:151]
s_mov_b32 s11, 0
v_cvt_pk_bf16_f32 v39, v102, v103
v_mul_f32 v44, s68, v44
v_mfma_f32_16x16x32_bf16 v[148:151], a[140:143], a[52:55], v[148:151]
s_lshr_b32 s19, s9, 1
ds_write_b128 v28, v[36:39] offset:0
v_mul_f32 v45, s68, v45
v_mfma_f32_16x16x32_bf16 v[156:159], a[136:139], a[56:59], v[156:159]
s_sub_u32 s19, s19, 1
s_add_u32 s23, s67, 0
buffer_store_dwordx4 v[36:39], v1, s[4:7], s23 offen offset:0 sc1
v_mfma_f32_16x16x32_bf16 v[156:159], a[140:143], a[60:63], v[156:159]
s_waitcnt lgkmcnt(1)
v_mul_f32 v46, s68, v46
v_mul_f32 v47, s68, v47
v_mfma_f32_16x16x32_bf16 v[164:167], a[128:131], a[0:3], v[164:167]
s_add_u32 s12, s8, 16777216
ds_read_b64_tr_b16 a[136:137], v25 offset:0
v_mul_f32 v108, s68, v108
v_mfma_f32_16x16x32_bf16 v[164:167], a[132:135], a[4:7], v[164:167]
s_mov_b32 s13, s9
v_mul_f32 v109, s68, v109
v_mul_f32 v110, s68, v110
v_mfma_f32_16x16x32_bf16 v[172:175], a[128:131], a[8:11], v[172:175]
s_mov_b32 s15, s11
ds_read_b64_tr_b16 a[138:139], v25 offset:2048
v_mul_f32 v111, s68, v111
v_mfma_f32_16x16x32_bf16 v[172:175], a[132:135], a[12:15], v[172:175]
v_cvt_pk_bf16_f32 v44, v44, v45
v_cvt_pk_bf16_f32 v45, v46, v47
v_mfma_f32_16x16x32_bf16 v[180:183], a[128:131], a[16:19], v[180:183]
ds_read_b64_tr_b16 a[140:141], v25 offset:16384
v_cvt_pk_bf16_f32 v46, v108, v109
v_mfma_f32_16x16x32_bf16 v[180:183], a[132:135], a[20:23], v[180:183]
v_cvt_pk_bf16_f32 v47, v110, v111
v_mul_f32 v52, s68, v52
v_mfma_f32_16x16x32_bf16 v[188:191], a[128:131], a[24:27], v[188:191]
ds_read_b64_tr_b16 a[142:143], v25 offset:18432
v_mul_f32 v53, s68, v53
v_mfma_f32_16x16x32_bf16 v[188:191], a[132:135], a[28:31], v[188:191]
ds_write_b128 v28, v[44:47] offset:8192
v_mul_f32 v54, s68, v54
v_mfma_f32_16x16x32_bf16 v[196:199], a[128:131], a[32:35], v[196:199]
s_add_u32 s23, s67, 8192
buffer_store_dwordx4 v[44:47], v1, s[4:7], s23 offen offset:0 sc1
v_mfma_f32_16x16x32_bf16 v[196:199], a[132:135], a[36:39], v[196:199]
v_mul_f32 v55, s68, v55
v_mul_f32 v116, s68, v116
v_mfma_f32_16x16x32_bf16 v[204:207], a[128:131], a[40:43], v[204:207]
v_mul_f32 v117, s68, v117
v_mul_f32 v118, s68, v118
v_mfma_f32_16x16x32_bf16 v[204:207], a[132:135], a[44:47], v[204:207]
v_mul_f32 v119, s68, v119
v_cvt_pk_bf16_f32 v52, v52, v53
v_mfma_f32_16x16x32_bf16 v[212:215], a[128:131], a[48:51], v[212:215]
v_cvt_pk_bf16_f32 v53, v54, v55
v_cvt_pk_bf16_f32 v54, v116, v117
v_mfma_f32_16x16x32_bf16 v[212:215], a[132:135], a[52:55], v[212:215]
v_cvt_pk_bf16_f32 v55, v118, v119
v_mul_f32 v60, s68, v60
v_mfma_f32_16x16x32_bf16 v[220:223], a[128:131], a[56:59], v[220:223]
ds_write_b128 v28, v[52:55] offset:16384
v_mul_f32 v61, s68, v61
v_mfma_f32_16x16x32_bf16 v[220:223], a[132:135], a[60:63], v[220:223]
s_waitcnt lgkmcnt(0)
s_waitcnt lgkmcnt(0)
s_barrier
v_mfma_f32_16x16x32_bf16 v[224:227], a[136:139], a[0:3], v[224:227]
s_add_u32 s23, s67, 16384
buffer_store_dwordx4 v[52:55], v1, s[4:7], s23 offen offset:0 sc1
v_mfma_f32_16x16x32_bf16 v[224:227], a[140:143], a[4:7], v[224:227]
v_mul_f32 v62, s68, v62
v_mul_f32 v63, s68, v63
v_mfma_f32_16x16x32_bf16 v[228:231], a[136:139], a[8:11], v[228:231]
v_mul_f32 v124, s68, v124
v_mul_f32 v125, s68, v125
v_mfma_f32_16x16x32_bf16 v[228:231], a[140:143], a[12:15], v[228:231]
v_mul_f32 v126, s68, v126
v_mul_f32 v127, s68, v127
v_mfma_f32_16x16x32_bf16 v[232:235], a[136:139], a[16:19], v[232:235]
v_cvt_pk_bf16_f32 v60, v60, v61
v_cvt_pk_bf16_f32 v61, v62, v63
v_mfma_f32_16x16x32_bf16 v[232:235], a[140:143], a[20:23], v[232:235]
v_cvt_pk_bf16_f32 v62, v124, v125
v_cvt_pk_bf16_f32 v63, v126, v127
v_mfma_f32_16x16x32_bf16 v[236:239], a[136:139], a[24:27], v[236:239]
ds_write_b128 v28, v[60:63] offset:24576
v_mul_f32 v68, s68, v68
v_mfma_f32_16x16x32_bf16 v[236:239], a[140:143], a[28:31], v[236:239]
s_add_u32 s23, s67, 24576
buffer_store_dwordx4 v[60:63], v1, s[4:7], s23 offen offset:0 sc1
v_mfma_f32_16x16x32_bf16 v[240:243], a[136:139], a[32:35], v[240:243]
v_mul_f32 v69, s68, v69
v_mul_f32 v70, s68, v70
v_mfma_f32_16x16x32_bf16 v[240:243], a[140:143], a[36:39], v[240:243]
v_mul_f32 v71, s68, v71
v_mul_f32 v132, s68, v132
v_mfma_f32_16x16x32_bf16 v[244:247], a[136:139], a[40:43], v[244:247]
v_mul_f32 v133, s68, v133
v_mul_f32 v134, s68, v134
v_mfma_f32_16x16x32_bf16 v[244:247], a[140:143], a[44:47], v[244:247]
v_mul_f32 v135, s68, v135
v_cvt_pk_bf16_f32 v68, v68, v69
v_mfma_f32_16x16x32_bf16 v[248:251], a[136:139], a[48:51], v[248:251]
v_cvt_pk_bf16_f32 v69, v70, v71
v_cvt_pk_bf16_f32 v70, v132, v133
v_mfma_f32_16x16x32_bf16 v[248:251], a[140:143], a[52:55], v[248:251]
v_cvt_pk_bf16_f32 v71, v134, v135
v_mfma_f32_16x16x32_bf16 v[252:255], a[136:139], a[56:59], v[252:255]
ds_write_b128 v28, v[68:71] offset:32768
v_mfma_f32_16x16x32_bf16 v[252:255], a[140:143], a[60:63], v[252:255]
s_add_u32 s23, s67, 32768
buffer_store_dwordx4 v[68:71], v1, s[4:7], s23 offen offset:0 sc1
buffer_load_dword v21, v20, s[4:7], s70 offen sc1
v_pk_mul_f32 v[76:77], v[76:77], s[68:69]
v_pk_mul_f32 v[78:79], v[78:79], s[68:69]
v_pk_mul_f32 v[140:141], v[140:141], s[68:69]
v_pk_mul_f32 v[142:143], v[142:143], s[68:69]
v_cvt_pk_bf16_f32 v76, v76, v77
v_cvt_pk_bf16_f32 v77, v78, v79
v_cvt_pk_bf16_f32 v78, v140, v141
v_cvt_pk_bf16_f32 v79, v142, v143
ds_write_b128 v28, v[76:79] offset:40960
s_add_u32 s23, s67, 40960
buffer_store_dwordx4 v[76:79], v1, s[4:7], s23 offen offset:0 sc1
v_pk_mul_f32 v[84:85], v[84:85], s[68:69]
v_pk_mul_f32 v[86:87], v[86:87], s[68:69]
v_pk_mul_f32 v[148:149], v[148:149], s[68:69]
v_pk_mul_f32 v[150:151], v[150:151], s[68:69]
v_cvt_pk_bf16_f32 v84, v84, v85
v_cvt_pk_bf16_f32 v85, v86, v87
v_cvt_pk_bf16_f32 v86, v148, v149
v_cvt_pk_bf16_f32 v87, v150, v151
ds_write_b128 v28, v[84:87] offset:49152
s_add_u32 s23, s67, 49152
buffer_store_dwordx4 v[84:87], v1, s[4:7], s23 offen offset:0 sc1
v_pk_mul_f32 v[92:93], v[92:93], s[68:69]
v_pk_mul_f32 v[94:95], v[94:95], s[68:69]
v_pk_mul_f32 v[156:157], v[156:157], s[68:69]
v_pk_mul_f32 v[158:159], v[158:159], s[68:69]
v_cvt_pk_bf16_f32 v92, v92, v93
v_cvt_pk_bf16_f32 v93, v94, v95
v_cvt_pk_bf16_f32 v94, v156, v157
v_cvt_pk_bf16_f32 v95, v158, v159
ds_write_b128 v28, v[92:95] offset:57344
s_add_u32 s23, s67, 57344
buffer_store_dwordx4 v[92:95], v1, s[4:7], s23 offen offset:0 sc1
v_pk_mul_f32 v[164:165], v[164:165], s[68:69]
v_pk_mul_f32 v[166:167], v[166:167], s[68:69]
v_pk_mul_f32 v[224:225], v[224:225], s[68:69]
v_pk_mul_f32 v[226:227], v[226:227], s[68:69]
v_cvt_pk_bf16_f32 v164, v164, v165
v_cvt_pk_bf16_f32 v165, v166, v167
v_cvt_pk_bf16_f32 v166, v224, v225
v_cvt_pk_bf16_f32 v167, v226, v227
ds_write_b128 v28, v[164:167] offset:1024
s_add_u32 s23, s67, 0
buffer_store_dwordx4 v[164:167], v1, s[4:7], s23 offen offset:1024 sc1
v_pk_mul_f32 v[172:173], v[172:173], s[68:69]
v_pk_mul_f32 v[174:175], v[174:175], s[68:69]
v_pk_mul_f32 v[228:229], v[228:229], s[68:69]
v_pk_mul_f32 v[230:231], v[230:231], s[68:69]
v_cvt_pk_bf16_f32 v172, v172, v173
v_cvt_pk_bf16_f32 v173, v174, v175
v_cvt_pk_bf16_f32 v174, v228, v229
v_cvt_pk_bf16_f32 v175, v230, v231
ds_write_b128 v28, v[172:175] offset:9216
s_add_u32 s23, s67, 8192
buffer_store_dwordx4 v[172:175], v1, s[4:7], s23 offen offset:1024 sc1
v_pk_mul_f32 v[180:181], v[180:181], s[68:69]
v_pk_mul_f32 v[182:183], v[182:183], s[68:69]
v_pk_mul_f32 v[232:233], v[232:233], s[68:69]
v_pk_mul_f32 v[234:235], v[234:235], s[68:69]
v_cvt_pk_bf16_f32 v180, v180, v181
v_cvt_pk_bf16_f32 v181, v182, v183
v_cvt_pk_bf16_f32 v182, v232, v233
v_cvt_pk_bf16_f32 v183, v234, v235
ds_write_b128 v28, v[180:183] offset:17408
s_add_u32 s23, s67, 16384
buffer_store_dwordx4 v[180:183], v1, s[4:7], s23 offen offset:1024 sc1
v_pk_mul_f32 v[188:189], v[188:189], s[68:69]
v_pk_mul_f32 v[190:191], v[190:191], s[68:69]
v_pk_mul_f32 v[236:237], v[236:237], s[68:69]
v_pk_mul_f32 v[238:239], v[238:239], s[68:69]
v_cvt_pk_bf16_f32 v188, v188, v189
v_cvt_pk_bf16_f32 v189, v190, v191
v_cvt_pk_bf16_f32 v190, v236, v237
v_cvt_pk_bf16_f32 v191, v238, v239
ds_write_b128 v28, v[188:191] offset:25600
s_add_u32 s23, s67, 24576
buffer_store_dwordx4 v[188:191], v1, s[4:7], s23 offen offset:1024 sc1
v_pk_mul_f32 v[196:197], v[196:197], s[68:69]
v_pk_mul_f32 v[198:199], v[198:199], s[68:69]
PAD_8:
s_cbranch_execz M_tret
v_pk_mul_f32 v[240:241], v[240:241], s[68:69]
v_pk_mul_f32 v[242:243], v[242:243], s[68:69]
v_cvt_pk_bf16_f32 v196, v196, v197
v_cvt_pk_bf16_f32 v197, v198, v199
v_cvt_pk_bf16_f32 v198, v240, v241
v_cvt_pk_bf16_f32 v199, v242, v243
ds_write_b128 v28, v[196:199] offset:33792
s_add_u32 s23, s67, 32768
buffer_store_dwordx4 v[196:199], v1, s[4:7], s23 offen offset:1024 sc1
v_pk_mul_f32 v[204:205], v[204:205], s[68:69]
v_pk_mul_f32 v[206:207], v[206:207], s[68:69]
v_pk_mul_f32 v[244:245], v[244:245], s[68:69]
v_pk_mul_f32 v[246:247], v[246:247], s[68:69]
v_cvt_pk_bf16_f32 v204, v204, v205
v_cvt_pk_bf16_f32 v205, v206, v207
v_cvt_pk_bf16_f32 v206, v244, v245
v_cvt_pk_bf16_f32 v207, v246, v247
ds_write_b128 v28, v[204:207] offset:41984
s_add_u32 s23, s67, 40960
buffer_store_dwordx4 v[204:207], v1, s[4:7], s23 offen offset:1024 sc1
v_pk_mul_f32 v[212:213], v[212:213], s[68:69]
v_pk_mul_f32 v[214:215], v[214:215], s[68:69]
v_pk_mul_f32 v[248:249], v[248:249], s[68:69]
v_pk_mul_f32 v[250:251], v[250:251], s[68:69]
v_cvt_pk_bf16_f32 v212, v212, v213
v_cvt_pk_bf16_f32 v213, v214, v215
v_cvt_pk_bf16_f32 v214, v248, v249
v_cvt_pk_bf16_f32 v215, v250, v251
ds_write_b128 v28, v[212:215] offset:50176
s_add_u32 s23, s67, 49152
buffer_store_dwordx4 v[212:215], v1, s[4:7], s23 offen offset:1024 sc1
v_pk_mul_f32 v[220:221], v[220:221], s[68:69]
v_pk_mul_f32 v[222:223], v[222:223], s[68:69]
v_pk_mul_f32 v[252:253], v[252:253], s[68:69]
v_pk_mul_f32 v[254:255], v[254:255], s[68:69]
v_cvt_pk_bf16_f32 v220, v220, v221
v_cvt_pk_bf16_f32 v221, v222, v223
v_cvt_pk_bf16_f32 v222, v252, v253
v_cvt_pk_bf16_f32 v223, v254, v255
ds_write_b128 v28, v[220:223] offset:58368
s_add_u32 s23, s67, 57344
buffer_store_dwordx4 v[220:223], v1, s[4:7], s23 offen offset:1024 sc1
s_waitcnt vmcnt(11)
v_cmp_gt_u32 vcc, 1, v21
s_cbranch_vccnz M_kspin
M_kok:
buffer_load_dword v21, v15, s[4:7], s70 offen sc1
s_mov_b32 m0, s84
s_nop 0
buffer_load_dwordx4 v1, s[4:7], s8 offen offset:0 sc1 lds
buffer_load_dwordx4 v1, s[4:7], s8 offen offset:1024 sc1 lds
buffer_load_dwordx4 v1, s[4:7], s8 offen offset:2048 sc1 lds
buffer_load_dwordx4 v1, s[4:7], s8 offen offset:3072 sc1 lds
s_add_u32 s8, s8, 4096
s_add_u32 m0, s84, 4096
s_nop 0
buffer_load_dwordx4 v1, s[4:7], s8 offen offset:0 sc1 lds
buffer_load_dwordx4 v1, s[4:7], s8 offen offset:1024 sc1 lds
buffer_load_dwordx4 v1, s[4:7], s8 offen offset:2048 sc1 lds
buffer_load_dwordx4 v1, s[4:7], s8 offen offset:3072 sc1 lds
s_add_u32 s8, s8, 28672
s_sub_u32 s9, s9, 1
s_cmp_eq_u32 s9, 0
s_cselect_b32 s8, s10, s8
s_cselect_b32 s9, s11, s9
s_cselect_b32 s10, 3221225472, s10
v_add_u32 v28, s18, v2
s_waitcnt lgkmcnt(0)
s_barrier
ds_read_b128 a[0:3], v28 offset:0
ds_read_b128 a[4:7], v28 offset:1024
ds_read_b128 a[8:11], v28 offset:2048
ds_read_b128 a[12:15], v28 offset:3072
ds_read_b128 a[16:19], v28 offset:4096
ds_read_b128 a[20:23], v28 offset:5120
ds_read_b128 a[24:27], v28 offset:6144
ds_read_b128 a[28:31], v28 offset:7168
ds_read_b128 a[32:35], v28 offset:32768
ds_read_b128 a[36:39], v28 offset:33792
ds_read_b128 a[40:43], v28 offset:34816
ds_read_b128 a[44:47], v28 offset:35840
ds_read_b128 a[48:51], v28 offset:36864
ds_read_b128 a[52:55], v28 offset:37888
ds_read_b128 a[56:59], v28 offset:38912
ds_read_b128 a[60:63], v28 offset:39936
s_mov_b32 m0, s85
s_nop 0
buffer_load_dwordx4 v1, s[4:7], s8 offen offset:0 sc1 lds
buffer_load_dwordx4 v1, s[4:7], s8 offen offset:1024 sc1 lds
buffer_load_dwordx4 v1, s[4:7], s8 offen offset:2048 sc1 lds
buffer_load_dwordx4 v1, s[4:7], s8 offen offset:3072 sc1 lds
s_add_u32 s8, s8, 4096
s_add_u32 m0, s85, 4096
s_nop 0
buffer_load_dwordx4 v1, s[4:7], s8 offen offset:0 sc1 lds
buffer_load_dwordx4 v1, s[4:7], s8 offen offset:1024 sc1 lds
buffer_load_dwordx4 v1, s[4:7], s8 offen offset:2048 sc1 lds
buffer_load_dwordx4 v1, s[4:7], s8 offen offset:3072 sc1 lds
s_add_u32 s8, s8, 28672
s_sub_u32 s9, s9, 1
s_cmp_eq_u32 s9, 0
s_cselect_b32 s8, s10, s8
s_cselect_b32 s9, s11, s9
s_cselect_b32 s10, 3221225472, s10
s_mov_b32 s25, 1266679808
s_lshl_b32 s22, s21, 3
s_xor_b32 s28, s70, 256
s_add_u32 s28, s28, s22
s_add_u32 s28, s28, 6148
s_lshl_b32 s26, s21, 16
s_add_u32 s26, s26, s30
s_add_u32 s26, s26, 33554432
s_xor_b32 s76, s20, 0
s_lshl_b32 s76, s76, 3
s_add_u32 s76, s76, s21
s_lshl_b32 s76, s76, 2
s_add_u32 s76, s76, s3
s_lshl_b32 s27, s76, 10
s_add_u32 s27, s27, 75497472
s_lshl_b32 s76, s76, 14
s_add_u32 s76, s76, 67108864
s_lshl_b32 s81, s20, 2
s_add_u32 s81, s81, s3
s_mul_i32 s81, s81, 57344
s_cmp_eq_u32 s24, 1
s_cselect_b32 s80, s28, s70
s_add_u32 s77, s76, 8192
v_lshrrev_b32 v8, 7, v1
v_and_b32 v9, 6, v8
v_lshlrev_b32 v9, 4, v9
v_and_b32 v10, 0x70, v1
v_xor_b32 v9, v9, v10
v_mul_u32_u24 v8, 896, v8
v_add_u32 v8, v8, v9
v_accvgpr_write_b32 a184, v8
v_add_u32 v8, 6144, v8
v_accvgpr_write_b32 a185, v8
v_add_u32 v8, 6144, v8
v_accvgpr_write_b32 a186, v8
v_add_u32 v8, 6144, v8
v_accvgpr_write_b32 a187, v8
v_lshrrev_b32 v8, 6, v1
v_bfe_u32 v9, v1, 7, 2
v_lshlrev_b32 v9, 5, v9
v_lshl_add_u32 v8, v8, 7, v9
v_bfe_u32 v9, v1, 4, 2
v_lshl_add_u32 v8, v9, 3, v8
v_add_u32 v8, 32768, v8
v_accvgpr_write_b32 a188, v8
v_xor_b32 v9, 32, v8
v_accvgpr_write_b32 a189, v9
v_xor_b32 v9, 64, v8
v_accvgpr_write_b32 a190, v9
v_xor_b32 v9, 96, v8
v_accvgpr_write_b32 a191, v9
s_add_u32 s22, s66, 16384
s_mov_b32 s71, 3221225472
s_waitcnt vmcnt(17)
s_barrier
buffer_store_dword v6, v5, s[4:7], s22 offen sc1
v_mov_b64 v[128:129], 0
v_mov_b64 v[130:131], 0
v_mov_b64 v[132:133], 0
v_mov_b64 v[134:135], 0
v_mov_b64 v[136:137], 0
v_mov_b64 v[138:139], 0
v_mov_b64 v[140:141], 0
v_mov_b64 v[142:143], 0
v_mov_b64 v[144:145], 0
v_mov_b64 v[146:147], 0
v_mov_b64 v[148:149], 0
v_mov_b64 v[150:151], 0
v_mov_b64 v[152:153], 0
v_mov_b64 v[154:155], 0
v_mov_b64 v[156:157], 0
v_mov_b64 v[158:159], 0
v_mov_b64 v[160:161], 0
v_mov_b64 v[162:163], 0
v_mov_b64 v[164:165], 0
v_mov_b64 v[166:167], 0
v_mov_b64 v[168:169], 0
v_mov_b64 v[170:171], 0
v_mov_b64 v[172:173], 0
v_mov_b64 v[174:175], 0
v_mov_b64 v[176:177], 0
v_mov_b64 v[178:179], 0
v_mov_b64 v[180:181], 0
v_mov_b64 v[182:183], 0
v_mov_b64 v[184:185], 0
v_mov_b64 v[186:187], 0
v_mov_b64 v[188:189], 0
v_mov_b64 v[190:191], 0
v_mov_b64 v[192:193], 0
v_mov_b64 v[194:195], 0
v_mov_b64 v[196:197], 0
v_mov_b64 v[198:199], 0
v_mov_b64 v[200:201], 0
v_mov_b64 v[202:203], 0
v_mov_b64 v[204:205], 0
v_mov_b64 v[206:207], 0
v_mov_b64 v[208:209], 0
v_mov_b64 v[210:211], 0
v_mov_b64 v[212:213], 0
v_mov_b64 v[214:215], 0
v_mov_b64 v[216:217], 0
v_mov_b64 v[218:219], 0
v_mov_b64 v[220:221], 0
v_mov_b64 v[222:223], 0
v_mov_b64 v[224:225], 0
v_mov_b64 v[226:227], 0
v_mov_b64 v[228:229], 0
v_mov_b64 v[230:231], 0
v_mov_b64 v[232:233], 0
v_mov_b64 v[234:235], 0
v_mov_b64 v[236:237], 0
v_mov_b64 v[238:239], 0
v_mov_b64 v[240:241], 0
v_mov_b64 v[242:243], 0
v_mov_b64 v[244:245], 0
v_mov_b64 v[246:247], 0
v_mov_b64 v[248:249], 0
v_mov_b64 v[250:251], 0
v_mov_b64 v[252:253], 0
v_mov_b64 v[254:255], 0
v_mov_b64 v[24:25], 0
s_cmp_eq_u32 s24, 9
s_cbranch_scc1 M_t2A
M_t2Ar:
s_waitcnt vmcnt(9) lgkmcnt(0)
v_cmp_gt_u32 vcc, 1, v21
s_cbranch_vccnz M_vspin
M_vok:
s_barrier
K2_item:
PAD_9:
s_cbranch_execz M_tret
s_cmp_eq_u32 s19, 0
s_cbranch_scc1 K2_p0d
ds_read_b128 a[64:67], v1 offset:0
ds_read_b128 a[68:71], v1 offset:1024
ds_read_b128 a[72:75], v1 offset:2048
ds_read_b128 a[76:79], v1 offset:3072
ds_read_b128 a[80:83], v1 offset:4096
ds_read_b128 a[84:87], v1 offset:5120
ds_read_b128 a[88:91], v1 offset:6144
ds_read_b128 a[92:95], v1 offset:7168
s_waitcnt lgkmcnt(7)
v_mfma_f32_16x16x32_bf16 v[32:35], a[64:67], a[0:3], 0
s_waitcnt lgkmcnt(6)
s_add_u32 m0, s18, 65536
ds_read_b128 a[96:99], v1 offset:8192
v_mfma_f32_16x16x32_bf16 v[32:35], a[68:71], a[4:7], v[32:35]
s_waitcnt lgkmcnt(6)
buffer_load_dwordx4 v1, s[4:7], s12 offen offset:0 sc1 lds
v_mfma_f32_16x16x32_bf16 v[32:35], a[72:75], a[8:11], v[32:35]
s_waitcnt lgkmcnt(5)
ds_read_b128 a[100:103], v1 offset:9216
v_mfma_f32_16x16x32_bf16 v[32:35], a[76:79], a[12:15], v[32:35]
s_waitcnt lgkmcnt(5)
buffer_load_dwordx4 v1, s[4:7], s12 offen offset:1024 sc1 lds
v_mfma_f32_16x16x32_bf16 v[32:35], a[80:83], a[16:19], v[32:35]
s_waitcnt lgkmcnt(4)
ds_read_b128 a[104:107], v1 offset:10240
v_mfma_f32_16x16x32_bf16 v[32:35], a[84:87], a[20:23], v[32:35]
s_waitcnt lgkmcnt(4)
buffer_load_dwordx4 v1, s[4:7], s12 offen offset:2048 sc1 lds
v_mfma_f32_16x16x32_bf16 v[32:35], a[88:91], a[24:27], v[32:35]
s_waitcnt lgkmcnt(3)
ds_read_b128 a[108:111], v1 offset:11264
v_mfma_f32_16x16x32_bf16 v[32:35], a[92:95], a[28:31], v[32:35]
buffer_load_dwordx4 v1, s[4:7], s12 offen offset:3072 sc1 lds
v_mfma_f32_16x16x32_bf16 v[36:39], a[64:67], a[32:35], 0
s_add_u32 s12, s12, 4096
s_add_u32 m0, s18, 69632
ds_read_b128 a[112:115], v1 offset:12288
v_mfma_f32_16x16x32_bf16 v[36:39], a[68:71], a[36:39], v[36:39]
buffer_load_dwordx4 v1, s[4:7], s12 offen offset:0 sc1 lds
v_mfma_f32_16x16x32_bf16 v[36:39], a[72:75], a[40:43], v[36:39]
ds_read_b128 a[116:119], v1 offset:13312
v_mfma_f32_16x16x32_bf16 v[36:39], a[76:79], a[44:47], v[36:39]
buffer_load_dwordx4 v1, s[4:7], s12 offen offset:1024 sc1 lds
v_mfma_f32_16x16x32_bf16 v[36:39], a[80:83], a[48:51], v[36:39]
ds_read_b128 a[120:123], v1 offset:14336
v_max3_f32 v28, v32, v33, v34
v_mfma_f32_16x16x32_bf16 v[36:39], a[84:87], a[52:55], v[36:39]
buffer_load_dwordx4 v1, s[4:7], s12 offen offset:2048 sc1 lds
v_mfma_f32_16x16x32_bf16 v[36:39], a[88:91], a[56:59], v[36:39]
ds_read_b128 a[124:127], v1 offset:15360
v_max_f32 v28, v28, v35
v_mfma_f32_16x16x32_bf16 v[36:39], a[92:95], a[60:63], v[36:39]
s_waitcnt lgkmcnt(4)
buffer_load_dwordx4 v1, s[4:7], s12 offen offset:3072 sc1 lds
v_mfma_f32_16x16x32_bf16 v[40:43], a[96:99], a[0:3], 0
s_add_u32 s12, s12, 28672
ds_read_b128 a[64:67], v1 offset:16384
v_mov_b32 v30, v28
v_mfma_f32_16x16x32_bf16 v[40:43], a[100:103], a[4:7], v[40:43]
s_waitcnt lgkmcnt(2)
s_sub_u32 s13, s13, 1
v_mfma_f32_16x16x32_bf16 v[40:43], a[104:107], a[8:11], v[40:43]
s_cmp_eq_u32 s13, 0
ds_read_b128 a[68:71], v1 offset:17408
v_permlane16_swap_b32 v28, v30
v_mfma_f32_16x16x32_bf16 v[40:43], a[108:111], a[12:15], v[40:43]
s_cselect_b32 s12, s14, s12
v_max_f32 v28, v28, v30
v_mov_b32 v30, v28
v_mfma_f32_16x16x32_bf16 v[40:43], a[112:115], a[16:19], v[40:43]
s_cselect_b32 s13, s15, s13
ds_read_b128 a[72:75], v1 offset:18432
v_max3_f32 v29, v36, v37, v38
v_mfma_f32_16x16x32_bf16 v[40:43], a[116:119], a[20:23], v[40:43]
s_cselect_b32 s14, 3221225472, s14
v_permlane32_swap_b32 v28, v30
v_max_f32 v28, v28, v30
v_mfma_f32_16x16x32_bf16 v[40:43], a[120:123], a[24:27], v[40:43]
s_waitcnt lgkmcnt(3)
ds_read_b128 a[76:79], v1 offset:19456
v_sub_f32 v16, 0, v28
v_mfma_f32_16x16x32_bf16 v[40:43], a[124:127], a[28:31], v[40:43]
v_sub_f32 v17, 0, v28
v_sub_f32 v18, 0, v28
v_mfma_f32_16x16x32_bf16 v[44:47], a[96:99], a[32:35], 0
ds_read_b128 a[80:83], v1 offset:20480
v_sub_f32 v19, 0, v28
v_mfma_f32_16x16x32_bf16 v[44:47], a[100:103], a[36:39], v[44:47]
v_max_f32 v29, v29, v39
v_mov_b32 v31, v29
v_mfma_f32_16x16x32_bf16 v[44:47], a[104:107], a[40:43], v[44:47]
ds_read_b128 a[84:87], v1 offset:21504
v_mfma_f32_16x16x32_bf16 v[44:47], a[108:111], a[44:47], v[44:47]
v_permlane16_swap_b32 v29, v31
v_max_f32 v29, v29, v31
v_mfma_f32_16x16x32_bf16 v[44:47], a[112:115], a[48:51], v[44:47]
ds_read_b128 a[88:91], v1 offset:22528
v_mov_b32 v31, v29
v_mfma_f32_16x16x32_bf16 v[44:47], a[116:119], a[52:55], v[44:47]
v_mfma_f32_16x16x32_bf16 v[44:47], a[120:123], a[56:59], v[44:47]
ds_read_b128 a[92:95], v1 offset:23552
v_permlane32_swap_b32 v29, v31
v_mfma_f32_16x16x32_bf16 v[44:47], a[124:127], a[60:63], v[44:47]
s_waitcnt lgkmcnt(4)
v_max_f32 v29, v29, v31
v_sub_f32 v20, 0, v29
v_mfma_f32_16x16x32_bf16 v[48:51], a[64:67], a[0:3], v[16:19]
ds_read_b128 a[96:99], v1 offset:24576
v_sub_f32 v21, 0, v29
v_mfma_f32_16x16x32_bf16 v[48:51], a[68:71], a[4:7], v[48:51]
v_sub_f32 v22, 0, v29
v_sub_f32 v23, 0, v29
v_mfma_f32_16x16x32_bf16 v[48:51], a[72:75], a[8:11], v[48:51]
ds_read_b128 a[100:103], v1 offset:25600
v_mfma_f32_16x16x32_bf16 v[48:51], a[76:79], a[12:15], v[48:51]
s_waitcnt lgkmcnt(4)
v_mfma_f32_16x16x32_bf16 v[48:51], a[80:83], a[16:19], v[48:51]
ds_read_b128 a[104:107], v1 offset:26624
v_mfma_f32_16x16x32_bf16 v[48:51], a[84:87], a[20:23], v[48:51]
s_waitcnt lgkmcnt(4)
v_add_f32 v32, v32, v16
v_add_f32 v33, v33, v16
v_add_f32 v34, v34, v16
v_add_f32 v35, v35, v16
v_mfma_f32_16x16x32_bf16 v[48:51], a[88:91], a[24:27], v[48:51]
s_waitcnt lgkmcnt(3)
ds_read_b128 a[108:111], v1 offset:27648
v_add_f32 v36, v36, v20
v_add_f32 v37, v37, v20
v_add_f32 v38, v38, v20
v_add_f32 v39, v39, v20
v_mfma_f32_16x16x32_bf16 v[48:51], a[92:95], a[28:31], v[48:51]
v_add_f32 v40, v40, v16
v_add_f32 v41, v41, v16
v_add_f32 v42, v42, v16
v_add_f32 v43, v43, v16
v_mfma_f32_16x16x32_bf16 v[52:55], a[64:67], a[32:35], v[20:23]
ds_read_b128 a[112:115], v1 offset:28672
v_add_f32 v44, v44, v20
v_add_f32 v45, v45, v20
v_add_f32 v46, v46, v20
v_add_f32 v47, v47, v20
v_mfma_f32_16x16x32_bf16 v[52:55], a[68:71], a[36:39], v[52:55]
v_exp_f32 v8, v32
v_mfma_f32_16x16x32_bf16 v[52:55], a[72:75], a[40:43], v[52:55]
ds_read_b128 a[116:119], v1 offset:29696
v_exp_f32 v9, v33
v_mfma_f32_16x16x32_bf16 v[52:55], a[76:79], a[44:47], v[52:55]
v_exp_f32 v10, v34
v_add_f32 v26, v8, v9
v_cvt_pk_bf16_f32 v96, v8, v9
v_mfma_f32_16x16x32_bf16 v[52:55], a[80:83], a[48:51], v[52:55]
ds_read_b128 a[120:123], v1 offset:30720
v_exp_f32 v11, v35
v_add_f32 v26, v26, v10
v_mfma_f32_16x16x32_bf16 v[52:55], a[84:87], a[52:55], v[52:55]
v_exp_f32 v12, v36
v_add_f32 v26, v26, v11
v_cvt_pk_bf16_f32 v97, v10, v11
v_mfma_f32_16x16x32_bf16 v[52:55], a[88:91], a[56:59], v[52:55]
s_waitcnt vmcnt(8) lgkmcnt(4)
ds_read_b128 a[124:127], v1 offset:31744
v_exp_f32 v13, v37
v_mfma_f32_16x16x32_bf16 v[52:55], a[92:95], a[60:63], v[52:55]
s_barrier
v_mfma_f32_16x16x32_bf16 v[56:59], a[96:99], a[0:3], v[16:19]
ds_read_b128 a[64:67], v4 offset:0
v_exp_f32 v14, v38
v_mfma_f32_16x16x32_bf16 v[56:59], a[100:103], a[4:7], v[56:59]
buffer_store_dword v6, v5, s[4:7], s71 offen sc1
v_mfma_f32_16x16x32_bf16 v[56:59], a[104:107], a[8:11], v[56:59]
s_waitcnt lgkmcnt(4)
ds_read_b128 a[68:71], v4 offset:1024
v_add_f32 v27, v12, v13
v_cvt_pk_bf16_f32 v104, v12, v13
v_add_f32 v27, v27, v14
v_mfma_f32_16x16x32_bf16 v[56:59], a[108:111], a[12:15], v[56:59]
v_exp_f32 v15, v39
v_mfma_f32_16x16x32_bf16 v[56:59], a[112:115], a[16:19], v[56:59]
s_waitcnt lgkmcnt(4)
ds_read_b128 a[72:75], v4 offset:2048
v_exp_f32 v8, v40
v_add_f32 v27, v27, v15
v_cvt_pk_bf16_f32 v105, v14, v15
v_mfma_f32_16x16x32_bf16 v[56:59], a[116:119], a[20:23], v[56:59]
s_waitcnt lgkmcnt(4)
v_exp_f32 v9, v41
v_add_f32 v26, v26, v8
v_mfma_f32_16x16x32_bf16 v[56:59], a[120:123], a[24:27], v[56:59]
s_waitcnt lgkmcnt(3)
ds_read_b128 a[76:79], v4 offset:3072
v_exp_f32 v10, v42
v_add_f32 v26, v26, v9
v_cvt_pk_bf16_f32 v98, v8, v9
v_mfma_f32_16x16x32_bf16 v[56:59], a[124:127], a[28:31], v[56:59]
v_exp_f32 v11, v43
v_add_f32 v26, v26, v10
v_mfma_f32_16x16x32_bf16 v[60:63], a[96:99], a[32:35], v[20:23]
ds_read_b128 a[80:83], v4 offset:4096
v_exp_f32 v12, v44
v_mfma_f32_16x16x32_bf16 v[60:63], a[100:103], a[36:39], v[60:63]
v_exp_f32 v13, v45
v_mfma_f32_16x16x32_bf16 v[60:63], a[104:107], a[40:43], v[60:63]
ds_read_b128 a[84:87], v4 offset:5120
v_exp_f32 v14, v46
v_mfma_f32_16x16x32_bf16 v[60:63], a[108:111], a[44:47], v[60:63]
v_exp_f32 v15, v47
v_mfma_f32_16x16x32_bf16 v[60:63], a[112:115], a[48:51], v[60:63]
ds_read_b128 a[88:91], v4 offset:6144
v_add_f32 v26, v26, v11
v_cvt_pk_bf16_f32 v99, v10, v11
v_mfma_f32_16x16x32_bf16 v[60:63], a[116:119], a[52:55], v[60:63]
v_add_f32 v27, v27, v12
v_add_f32 v27, v27, v13
v_cvt_pk_bf16_f32 v106, v12, v13
v_mfma_f32_16x16x32_bf16 v[60:63], a[120:123], a[56:59], v[60:63]
s_waitcnt lgkmcnt(7)
s_barrier
ds_read_b128 a[92:95], v4 offset:7168
v_mfma_f32_16x16x32_bf16 v[60:63], a[124:127], a[60:63], v[60:63]
s_waitcnt lgkmcnt(4)
v_add_f32 v27, v27, v14
v_add_f32 v27, v27, v15
v_cvt_pk_bf16_f32 v107, v14, v15
K2_x1:
v_mfma_f32_16x16x32_bf16 v[64:67], a[64:67], a[0:3], v[16:19]
s_add_u32 m0, s18, 0
ds_read_b128 a[96:99], v4 offset:8192
v_mfma_f32_16x16x32_bf16 v[64:67], a[68:71], a[4:7], v[64:67]
s_waitcnt lgkmcnt(4)
buffer_load_dwordx4 v1, s[4:7], s8 offen offset:0 sc1 lds
v_mfma_f32_16x16x32_bf16 v[64:67], a[72:75], a[8:11], v[64:67]
ds_read_b128 a[100:103], v4 offset:9216
v_mfma_f32_16x16x32_bf16 v[64:67], a[76:79], a[12:15], v[64:67]
s_waitcnt lgkmcnt(4)
v_exp_f32 v8, v48
v_mfma_f32_16x16x32_bf16 v[64:67], a[80:83], a[16:19], v[64:67]
ds_read_b128 a[104:107], v4 offset:10240
v_add_f32 v26, v26, v8
v_mfma_f32_16x16x32_bf16 v[64:67], a[84:87], a[20:23], v[64:67]
s_waitcnt lgkmcnt(4)
buffer_load_dwordx4 v1, s[4:7], s8 offen offset:1024 sc1 lds
v_mfma_f32_16x16x32_bf16 v[64:67], a[88:91], a[24:27], v[64:67]
s_waitcnt lgkmcnt(3)
ds_read_b128 a[108:111], v4 offset:11264
v_mfma_f32_16x16x32_bf16 v[64:67], a[92:95], a[28:31], v[64:67]
v_exp_f32 v9, v49
v_mfma_f32_16x16x32_bf16 v[68:71], a[64:67], a[32:35], v[20:23]
ds_read_b128 a[112:115], v4 offset:12288
v_add_f32 v26, v26, v9
v_mfma_f32_16x16x32_bf16 v[68:71], a[68:71], a[36:39], v[68:71]
buffer_load_dwordx4 v1, s[4:7], s8 offen offset:2048 sc1 lds
v_mfma_f32_16x16x32_bf16 v[68:71], a[72:75], a[40:43], v[68:71]
ds_read_b128 a[116:119], v4 offset:13312
v_cvt_pk_bf16_f32 v100, v8, v9
v_mfma_f32_16x16x32_bf16 v[68:71], a[76:79], a[44:47], v[68:71]
v_exp_f32 v10, v50
v_mfma_f32_16x16x32_bf16 v[68:71], a[80:83], a[48:51], v[68:71]
ds_read_b128 a[120:123], v4 offset:14336
v_add_f32 v26, v26, v10
v_mfma_f32_16x16x32_bf16 v[68:71], a[84:87], a[52:55], v[68:71]
buffer_load_dwordx4 v1, s[4:7], s8 offen offset:3072 sc1 lds
v_mfma_f32_16x16x32_bf16 v[68:71], a[88:91], a[56:59], v[68:71]
s_add_u32 s8, s8, 4096
ds_read_b128 a[124:127], v4 offset:15360
v_mfma_f32_16x16x32_bf16 v[68:71], a[92:95], a[60:63], v[68:71]
s_waitcnt lgkmcnt(4)
v_exp_f32 v11, v51
v_mfma_f32_16x16x32_bf16 v[72:75], a[96:99], a[0:3], v[16:19]
s_add_u32 m0, s18, 4096
ds_read_b128 a[64:67], v4 offset:16384
v_add_f32 v26, v26, v11
v_mfma_f32_16x16x32_bf16 v[72:75], a[100:103], a[4:7], v[72:75]
buffer_load_dwordx4 v1, s[4:7], s8 offen offset:0 sc1 lds
v_mfma_f32_16x16x32_bf16 v[72:75], a[104:107], a[8:11], v[72:75]
ds_read_b128 a[68:71], v4 offset:17408
v_cvt_pk_bf16_f32 v101, v10, v11
v_mfma_f32_16x16x32_bf16 v[72:75], a[108:111], a[12:15], v[72:75]
s_waitcnt lgkmcnt(4)
v_mfma_f32_16x16x32_bf16 v[72:75], a[112:115], a[16:19], v[72:75]
ds_read_b128 a[72:75], v4 offset:18432
v_mfma_f32_16x16x32_bf16 v[72:75], a[116:119], a[20:23], v[72:75]
s_waitcnt lgkmcnt(4)
buffer_load_dwordx4 v1, s[4:7], s8 offen offset:1024 sc1 lds
v_mfma_f32_16x16x32_bf16 v[72:75], a[120:123], a[24:27], v[72:75]
s_waitcnt lgkmcnt(3)
ds_read_b128 a[76:79], v4 offset:19456
v_mfma_f32_16x16x32_bf16 v[72:75], a[124:127], a[28:31], v[72:75]
v_exp_f32 v12, v52
v_mfma_f32_16x16x32_bf16 v[76:79], a[96:99], a[32:35], v[20:23]
ds_read_b128 a[80:83], v4 offset:20480
v_add_f32 v27, v27, v12
v_mfma_f32_16x16x32_bf16 v[76:79], a[100:103], a[36:39], v[76:79]
buffer_load_dwordx4 v1, s[4:7], s8 offen offset:2048 sc1 lds
v_mfma_f32_16x16x32_bf16 v[76:79], a[104:107], a[40:43], v[76:79]
ds_read_b128 a[84:87], v4 offset:21504
v_mfma_f32_16x16x32_bf16 v[76:79], a[108:111], a[44:47], v[76:79]
v_exp_f32 v13, v53
v_mfma_f32_16x16x32_bf16 v[76:79], a[112:115], a[48:51], v[76:79]
ds_read_b128 a[88:91], v4 offset:22528
v_add_f32 v27, v27, v13
v_mfma_f32_16x16x32_bf16 v[76:79], a[116:119], a[52:55], v[76:79]
s_waitcnt lgkmcnt(3)
buffer_load_dwordx4 v1, s[4:7], s8 offen offset:3072 sc1 lds
v_mfma_f32_16x16x32_bf16 v[76:79], a[120:123], a[56:59], v[76:79]
s_add_u32 s8, s8, 28672
ds_read_b128 a[92:95], v4 offset:23552
v_cvt_pk_bf16_f32 v108, v12, v13
v_mfma_f32_16x16x32_bf16 v[76:79], a[124:127], a[60:63], v[76:79]
s_sub_u32 s9, s9, 1
v_exp_f32 v14, v54
v_mfma_f32_16x16x32_bf16 v[80:83], a[64:67], a[0:3], v[16:19]
s_cmp_eq_u32 s9, 0
ds_read_b128 a[96:99], v4 offset:24576
v_add_f32 v27, v27, v14
v_mfma_f32_16x16x32_bf16 v[80:83], a[68:71], a[4:7], v[80:83]
s_cselect_b32 s8, s10, s8
v_exp_f32 v15, v55
v_mfma_f32_16x16x32_bf16 v[80:83], a[72:75], a[8:11], v[80:83]
s_cselect_b32 s9, s11, s9
ds_read_b128 a[100:103], v4 offset:25600
v_add_f32 v27, v27, v15
v_mfma_f32_16x16x32_bf16 v[80:83], a[76:79], a[12:15], v[80:83]
s_waitcnt lgkmcnt(4)
s_cselect_b32 s10, 3221225472, s10
v_cvt_pk_bf16_f32 v109, v14, v15
v_mfma_f32_16x16x32_bf16 v[80:83], a[80:83], a[16:19], v[80:83]
ds_read_b128 a[104:107], v4 offset:26624
v_mfma_f32_16x16x32_bf16 v[80:83], a[84:87], a[20:23], v[80:83]
s_waitcnt lgkmcnt(4)
v_exp_f32 v8, v56
v_mfma_f32_16x16x32_bf16 v[80:83], a[88:91], a[24:27], v[80:83]
s_waitcnt lgkmcnt(3)
ds_read_b128 a[108:111], v4 offset:27648
v_add_f32 v26, v26, v8
v_mfma_f32_16x16x32_bf16 v[80:83], a[92:95], a[28:31], v[80:83]
v_exp_f32 v9, v57
v_mfma_f32_16x16x32_bf16 v[84:87], a[64:67], a[32:35], v[20:23]
ds_read_b128 a[112:115], v4 offset:28672
v_add_f32 v26, v26, v9
v_mfma_f32_16x16x32_bf16 v[84:87], a[68:71], a[36:39], v[84:87]
v_exp_f32 v10, v58
v_mfma_f32_16x16x32_bf16 v[84:87], a[72:75], a[40:43], v[84:87]
ds_read_b128 a[116:119], v4 offset:29696
v_cvt_pk_bf16_f32 v102, v8, v9
v_mfma_f32_16x16x32_bf16 v[84:87], a[76:79], a[44:47], v[84:87]
v_exp_f32 v11, v59
v_mfma_f32_16x16x32_bf16 v[84:87], a[80:83], a[48:51], v[84:87]
ds_read_b128 a[120:123], v4 offset:30720
v_add_f32 v26, v26, v10
v_mfma_f32_16x16x32_bf16 v[84:87], a[84:87], a[52:55], v[84:87]
v_add_f32 v26, v26, v11
v_cvt_pk_bf16_f32 v103, v10, v11
v_mfma_f32_16x16x32_bf16 v[84:87], a[88:91], a[56:59], v[84:87]
s_waitcnt vmcnt(8) lgkmcnt(4)
ds_read_b128 a[124:127], v4 offset:31744
v_mfma_f32_16x16x32_bf16 v[84:87], a[92:95], a[60:63], v[84:87]
s_barrier
v_mfma_f32_16x16x32_bf16 v[88:91], a[96:99], a[0:3], v[16:19]
ds_read_b128 a[64:67], v2 offset:0
v_mfma_f32_16x16x32_bf16 v[88:91], a[100:103], a[4:7], v[88:91]
v_exp_f32 v12, v60
v_mfma_f32_16x16x32_bf16 v[88:91], a[104:107], a[8:11], v[88:91]
s_waitcnt lgkmcnt(4)
ds_read_b128 a[68:71], v2 offset:1024
v_add_f32 v27, v27, v12
v_mfma_f32_16x16x32_bf16 v[88:91], a[108:111], a[12:15], v[88:91]
v_exp_f32 v13, v61
v_mfma_f32_16x16x32_bf16 v[88:91], a[112:115], a[16:19], v[88:91]
s_waitcnt lgkmcnt(4)
ds_read_b128 a[72:75], v2 offset:2048
v_add_f32 v27, v27, v13
v_mfma_f32_16x16x32_bf16 v[88:91], a[116:119], a[20:23], v[88:91]
s_waitcnt lgkmcnt(4)
v_exp_f32 v14, v62
v_mfma_f32_16x16x32_bf16 v[88:91], a[120:123], a[24:27], v[88:91]
s_waitcnt lgkmcnt(3)
ds_read_b128 a[76:79], v2 offset:3072
v_cvt_pk_bf16_f32 v110, v12, v13
v_mfma_f32_16x16x32_bf16 v[88:91], a[124:127], a[28:31], v[88:91]
v_exp_f32 v15, v63
v_mfma_f32_16x16x32_bf16 v[92:95], a[96:99], a[32:35], v[20:23]
s_sub_u32 s19, s19, 1
ds_read_b128 a[80:83], v2 offset:4096
v_add_f32 v27, v27, v14
v_mfma_f32_16x16x32_bf16 v[92:95], a[100:103], a[36:39], v[92:95]
v_add_f32 v27, v27, v15
v_cvt_pk_bf16_f32 v111, v14, v15
v_mfma_f32_16x16x32_bf16 v[92:95], a[104:107], a[40:43], v[92:95]
ds_read_b128 a[84:87], v2 offset:5120
v_add_f32 v28, v26, v27
v_mfma_f32_16x16x32_bf16 v[92:95], a[108:111], a[44:47], v[92:95]
v_cmp_nge_f32 vcc, s25, v28
v_mfma_f32_16x16x32_bf16 v[92:95], a[112:115], a[48:51], v[92:95]
s_cmp_eq_u64 vcc, 0
ds_read_b128 a[88:91], v2 offset:6144
v_mfma_f32_16x16x32_bf16 v[92:95], a[116:119], a[52:55], v[92:95]
s_cselect_b32 s22, s19, 0
v_mfma_f32_16x16x32_bf16 v[92:95], a[120:123], a[56:59], v[92:95]
s_cmp_eq_u32 s22, 0
ds_read_b128 a[92:95], v2 offset:7168
v_mfma_f32_16x16x32_bf16 v[92:95], a[124:127], a[60:63], v[92:95]
s_waitcnt lgkmcnt(4)
s_cbranch_scc1 K2_xexit
K2_loop:
v_mfma_f32_16x16x32_bf16 v[128:131], a[64:67], v[96:99], v[128:131]
s_add_u32 m0, s18, 98304
ds_read_b128 a[96:99], v2 offset:8192
v_add_f32 v24, v24, v26
v_mfma_f32_16x16x32_bf16 v[128:131], a[68:71], v[100:103], v[128:131]
buffer_load_dwordx4 v1, s[4:7], s12 offen offset:0 sc1 lds
v_mfma_f32_16x16x32_bf16 v[132:135], a[68:71], v[108:111], v[132:135]
ds_read_b128 a[100:103], v2 offset:9216
v_add_f32 v25, v25, v27
v_mfma_f32_16x16x32_bf16 v[132:135], a[64:67], v[104:107], v[132:135]
v_exp_f32 v8, v64
v_mfma_f32_16x16x32_bf16 v[136:139], a[72:75], v[96:99], v[136:139]
ds_read_b128 a[104:107], v2 offset:10240
v_mfma_f32_16x16x32_bf16 v[136:139], a[76:79], v[100:103], v[136:139]
buffer_load_dwordx4 v1, s[4:7], s12 offen offset:1024 sc1 lds
v_mfma_f32_16x16x32_bf16 v[140:143], a[76:79], v[108:111], v[140:143]
ds_read_b128 a[108:111], v2 offset:11264
v_mfma_f32_16x16x32_bf16 v[140:143], a[72:75], v[104:107], v[140:143]
s_waitcnt lgkmcnt(4)
v_exp_f32 v9, v65
v_mfma_f32_16x16x32_bf16 v[144:147], a[80:83], v[96:99], v[144:147]
PAD_10:
s_cbranch_execz M_tret
ds_read_b128 a[112:115], v2 offset:12288
v_add_f32 v26, v8, v9
v_mfma_f32_16x16x32_bf16 v[144:147], a[84:87], v[100:103], v[144:147]
buffer_load_dwordx4 v1, s[4:7], s12 offen offset:2048 sc1 lds
v_mfma_f32_16x16x32_bf16 v[148:151], a[84:87], v[108:111], v[148:151]
ds_read_b128 a[116:119], v2 offset:13312
v_cvt_pk_bf16_f32 v112, v8, v9
v_mfma_f32_16x16x32_bf16 v[148:151], a[80:83], v[104:107], v[148:151]
v_exp_f32 v10, v66
v_mfma_f32_16x16x32_bf16 v[152:155], a[88:91], v[96:99], v[152:155]
ds_read_b128 a[120:123], v2 offset:14336
v_add_f32 v26, v26, v10
v_mfma_f32_16x16x32_bf16 v[152:155], a[92:95], v[100:103], v[152:155]
buffer_load_dwordx4 v1, s[4:7], s12 offen offset:3072 sc1 lds
v_mfma_f32_16x16x32_bf16 v[156:159], a[92:95], v[108:111], v[156:159]
s_add_u32 s12, s12, 4096
ds_read_b128 a[124:127], v2 offset:15360
v_mfma_f32_16x16x32_bf16 v[156:159], a[88:91], v[104:107], v[156:159]
s_waitcnt lgkmcnt(4)
v_exp_f32 v11, v67
v_mfma_f32_16x16x32_bf16 v[160:163], a[96:99], v[96:99], v[160:163]
s_add_u32 m0, s18, 102400
ds_read_b128 a[64:67], v2 offset:16384
v_add_f32 v26, v26, v11
v_mfma_f32_16x16x32_bf16 v[160:163], a[100:103], v[100:103], v[160:163]
buffer_load_dwordx4 v1, s[4:7], s12 offen offset:0 sc1 lds
v_mfma_f32_16x16x32_bf16 v[164:167], a[100:103], v[108:111], v[164:167]
ds_read_b128 a[68:71], v2 offset:17408
v_cvt_pk_bf16_f32 v113, v10, v11
v_mfma_f32_16x16x32_bf16 v[164:167], a[96:99], v[104:107], v[164:167]
v_mfma_f32_16x16x32_bf16 v[168:171], a[104:107], v[96:99], v[168:171]
ds_read_b128 a[72:75], v2 offset:18432
v_mfma_f32_16x16x32_bf16 v[168:171], a[108:111], v[100:103], v[168:171]
buffer_load_dwordx4 v1, s[4:7], s12 offen offset:1024 sc1 lds
v_mfma_f32_16x16x32_bf16 v[172:175], a[108:111], v[108:111], v[172:175]
ds_read_b128 a[76:79], v2 offset:19456
v_mfma_f32_16x16x32_bf16 v[172:175], a[104:107], v[104:107], v[172:175]
s_waitcnt lgkmcnt(4)
v_exp_f32 v12, v68
v_mfma_f32_16x16x32_bf16 v[176:179], a[112:115], v[96:99], v[176:179]
ds_read_b128 a[80:83], v2 offset:20480
v_mfma_f32_16x16x32_bf16 v[176:179], a[116:119], v[100:103], v[176:179]
buffer_load_dwordx4 v1, s[4:7], s12 offen offset:2048 sc1 lds
v_mfma_f32_16x16x32_bf16 v[180:183], a[116:119], v[108:111], v[180:183]
ds_read_b128 a[84:87], v2 offset:21504
v_mfma_f32_16x16x32_bf16 v[180:183], a[112:115], v[104:107], v[180:183]
v_exp_f32 v13, v69
v_mfma_f32_16x16x32_bf16 v[184:187], a[120:123], v[96:99], v[184:187]
ds_read_b128 a[88:91], v2 offset:22528
v_add_f32 v27, v12, v13
v_mfma_f32_16x16x32_bf16 v[184:187], a[124:127], v[100:103], v[184:187]
s_waitcnt lgkmcnt(4)
buffer_load_dwordx4 v1, s[4:7], s12 offen offset:3072 sc1 lds
v_mfma_f32_16x16x32_bf16 v[188:191], a[124:127], v[108:111], v[188:191]
s_add_u32 s12, s12, 28672
ds_read_b128 a[92:95], v2 offset:23552
v_cvt_pk_bf16_f32 v120, v12, v13
v_mfma_f32_16x16x32_bf16 v[188:191], a[120:123], v[104:107], v[188:191]
s_sub_u32 s13, s13, 1
v_exp_f32 v14, v70
v_mfma_f32_16x16x32_bf16 v[192:195], a[64:67], v[96:99], v[192:195]
s_cmp_eq_u32 s13, 0
ds_read_b128 a[96:99], v2 offset:24576
v_add_f32 v27, v27, v14
v_mfma_f32_16x16x32_bf16 v[192:195], a[68:71], v[100:103], v[192:195]
s_cselect_b32 s12, s14, s12
v_mfma_f32_16x16x32_bf16 v[196:199], a[68:71], v[108:111], v[196:199]
s_cselect_b32 s13, s15, s13
ds_read_b128 a[100:103], v2 offset:25600
v_mfma_f32_16x16x32_bf16 v[196:199], a[64:67], v[104:107], v[196:199]
s_cselect_b32 s14, 3221225472, s14
v_exp_f32 v15, v71
v_mfma_f32_16x16x32_bf16 v[200:203], a[72:75], v[96:99], v[200:203]
s_waitcnt lgkmcnt(4)
ds_read_b128 a[104:107], v2 offset:26624
v_add_f32 v27, v27, v15
v_mfma_f32_16x16x32_bf16 v[200:203], a[76:79], v[100:103], v[200:203]
v_exp_f32 v8, v72
v_mfma_f32_16x16x32_bf16 v[204:207], a[76:79], v[108:111], v[204:207]
ds_read_b128 a[108:111], v2 offset:27648
v_cvt_pk_bf16_f32 v121, v14, v15
v_mfma_f32_16x16x32_bf16 v[204:207], a[72:75], v[104:107], v[204:207]
v_exp_f32 v9, v73
v_mfma_f32_16x16x32_bf16 v[208:211], a[80:83], v[96:99], v[208:211]
ds_read_b128 a[112:115], v2 offset:28672
v_add_f32 v26, v26, v8
v_mfma_f32_16x16x32_bf16 v[208:211], a[84:87], v[100:103], v[208:211]
v_add_f32 v26, v26, v9
v_cvt_pk_bf16_f32 v114, v8, v9
v_mfma_f32_16x16x32_bf16 v[212:215], a[84:87], v[108:111], v[212:215]
ds_read_b128 a[116:119], v2 offset:29696
v_mfma_f32_16x16x32_bf16 v[212:215], a[80:83], v[104:107], v[212:215]
s_waitcnt lgkmcnt(4)
v_exp_f32 v10, v74
v_mfma_f32_16x16x32_bf16 v[216:219], a[88:91], v[96:99], v[216:219]
ds_read_b128 a[120:123], v2 offset:30720
v_add_f32 v26, v26, v10
v_mfma_f32_16x16x32_bf16 v[216:219], a[92:95], v[100:103], v[216:219]
v_exp_f32 v11, v75
v_mfma_f32_16x16x32_bf16 v[220:223], a[92:95], v[108:111], v[220:223]
s_waitcnt vmcnt(8)
ds_read_b128 a[124:127], v2 offset:31744
v_add_f32 v26, v26, v11
v_mfma_f32_16x16x32_bf16 v[220:223], a[88:91], v[104:107], v[220:223]
s_barrier
v_mfma_f32_16x16x32_bf16 v[224:227], a[96:99], v[96:99], v[224:227]
ds_read_b128 a[64:67], v1 offset:0
v_cvt_pk_bf16_f32 v115, v10, v11
v_mfma_f32_16x16x32_bf16 v[224:227], a[100:103], v[100:103], v[224:227]
v_exp_f32 v12, v76
v_mfma_f32_16x16x32_bf16 v[228:231], a[100:103], v[108:111], v[228:231]
ds_read_b128 a[68:71], v1 offset:1024
v_add_f32 v27, v27, v12
v_mfma_f32_16x16x32_bf16 v[228:231], a[96:99], v[104:107], v[228:231]
s_waitcnt lgkmcnt(4)
v_mfma_f32_16x16x32_bf16 v[232:235], a[104:107], v[96:99], v[232:235]
ds_read_b128 a[72:75], v1 offset:2048
v_mfma_f32_16x16x32_bf16 v[232:235], a[108:111], v[100:103], v[232:235]
v_exp_f32 v13, v77
v_mfma_f32_16x16x32_bf16 v[236:239], a[108:111], v[108:111], v[236:239]
ds_read_b128 a[76:79], v1 offset:3072
v_add_f32 v27, v27, v13
v_mfma_f32_16x16x32_bf16 v[236:239], a[104:107], v[104:107], v[236:239]
v_exp_f32 v14, v78
v_mfma_f32_16x16x32_bf16 v[240:243], a[112:115], v[96:99], v[240:243]
ds_read_b128 a[80:83], v1 offset:4096
v_cvt_pk_bf16_f32 v122, v12, v13
v_mfma_f32_16x16x32_bf16 v[240:243], a[116:119], v[100:103], v[240:243]
v_exp_f32 v15, v79
v_mfma_f32_16x16x32_bf16 v[244:247], a[116:119], v[108:111], v[244:247]
ds_read_b128 a[84:87], v1 offset:5120
v_add_f32 v27, v27, v14
v_mfma_f32_16x16x32_bf16 v[244:247], a[112:115], v[104:107], v[244:247]
s_waitcnt lgkmcnt(4)
v_add_f32 v27, v27, v15
v_cvt_pk_bf16_f32 v123, v14, v15
v_mfma_f32_16x16x32_bf16 v[248:251], a[120:123], v[96:99], v[248:251]
ds_read_b128 a[88:91], v1 offset:6144
v_mfma_f32_16x16x32_bf16 v[248:251], a[124:127], v[100:103], v[248:251]
v_mfma_f32_16x16x32_bf16 v[252:255], a[124:127], v[108:111], v[252:255]
ds_read_b128 a[92:95], v1 offset:7168
v_mfma_f32_16x16x32_bf16 v[252:255], a[120:123], v[104:107], v[252:255]
K2_x0:
v_mfma_f32_16x16x32_bf16 v[32:35], a[64:67], a[0:3], v[16:19]
s_add_u32 m0, s18, 131072
ds_read_b128 a[96:99], v1 offset:8192
v_mfma_f32_16x16x32_bf16 v[32:35], a[68:71], a[4:7], v[32:35]
s_waitcnt lgkmcnt(4)
buffer_load_dwordx4 v1, s[4:7], s8 offen offset:0 sc1 lds
v_mfma_f32_16x16x32_bf16 v[32:35], a[72:75], a[8:11], v[32:35]
ds_read_b128 a[100:103], v1 offset:9216
v_mfma_f32_16x16x32_bf16 v[32:35], a[76:79], a[12:15], v[32:35]
v_exp_f32 v8, v80
v_mfma_f32_16x16x32_bf16 v[32:35], a[80:83], a[16:19], v[32:35]
s_waitcnt lgkmcnt(4)
ds_read_b128 a[104:107], v1 offset:10240
v_add_f32 v26, v26, v8
v_mfma_f32_16x16x32_bf16 v[32:35], a[84:87], a[20:23], v[32:35]
s_waitcnt lgkmcnt(4)
buffer_load_dwordx4 v1, s[4:7], s8 offen offset:1024 sc1 lds
v_mfma_f32_16x16x32_bf16 v[32:35], a[88:91], a[24:27], v[32:35]
s_waitcnt lgkmcnt(3)
ds_read_b128 a[108:111], v1 offset:11264
v_mfma_f32_16x16x32_bf16 v[32:35], a[92:95], a[28:31], v[32:35]
v_exp_f32 v9, v81
v_mfma_f32_16x16x32_bf16 v[36:39], a[64:67], a[32:35], v[20:23]
ds_read_b128 a[112:115], v1 offset:12288
v_add_f32 v26, v26, v9
v_mfma_f32_16x16x32_bf16 v[36:39], a[68:71], a[36:39], v[36:39]
buffer_load_dwordx4 v1, s[4:7], s8 offen offset:2048 sc1 lds
v_mfma_f32_16x16x32_bf16 v[36:39], a[72:75], a[40:43], v[36:39]
ds_read_b128 a[116:119], v1 offset:13312
v_cvt_pk_bf16_f32 v116, v8, v9
v_mfma_f32_16x16x32_bf16 v[36:39], a[76:79], a[44:47], v[36:39]
v_exp_f32 v10, v82
v_mfma_f32_16x16x32_bf16 v[36:39], a[80:83], a[48:51], v[36:39]
ds_read_b128 a[120:123], v1 offset:14336
v_add_f32 v26, v26, v10
v_mfma_f32_16x16x32_bf16 v[36:39], a[84:87], a[52:55], v[36:39]
buffer_load_dwordx4 v1, s[4:7], s8 offen offset:3072 sc1 lds
v_mfma_f32_16x16x32_bf16 v[36:39], a[88:91], a[56:59], v[36:39]
s_add_u32 s8, s8, 4096
ds_read_b128 a[124:127], v1 offset:15360
v_mfma_f32_16x16x32_bf16 v[36:39], a[92:95], a[60:63], v[36:39]
s_waitcnt lgkmcnt(4)
v_exp_f32 v11, v83
v_mfma_f32_16x16x32_bf16 v[40:43], a[96:99], a[0:3], v[16:19]
s_add_u32 m0, s18, 135168
ds_read_b128 a[64:67], v1 offset:16384
v_add_f32 v26, v26, v11
v_mfma_f32_16x16x32_bf16 v[40:43], a[100:103], a[4:7], v[40:43]
buffer_load_dwordx4 v1, s[4:7], s8 offen offset:0 sc1 lds
v_mfma_f32_16x16x32_bf16 v[40:43], a[104:107], a[8:11], v[40:43]
ds_read_b128 a[68:71], v1 offset:17408
v_cvt_pk_bf16_f32 v117, v10, v11
v_mfma_f32_16x16x32_bf16 v[40:43], a[108:111], a[12:15], v[40:43]
s_waitcnt lgkmcnt(4)
v_mfma_f32_16x16x32_bf16 v[40:43], a[112:115], a[16:19], v[40:43]
ds_read_b128 a[72:75], v1 offset:18432
v_mfma_f32_16x16x32_bf16 v[40:43], a[116:119], a[20:23], v[40:43]
s_waitcnt lgkmcnt(4)
buffer_load_dwordx4 v1, s[4:7], s8 offen offset:1024 sc1 lds
v_mfma_f32_16x16x32_bf16 v[40:43], a[120:123], a[24:27], v[40:43]
s_waitcnt lgkmcnt(3)
ds_read_b128 a[76:79], v1 offset:19456
v_mfma_f32_16x16x32_bf16 v[40:43], a[124:127], a[28:31], v[40:43]
v_exp_f32 v12, v84
v_mfma_f32_16x16x32_bf16 v[44:47], a[96:99], a[32:35], v[20:23]
ds_read_b128 a[80:83], v1 offset:20480
v_add_f32 v27, v27, v12
v_mfma_f32_16x16x32_bf16 v[44:47], a[100:103], a[36:39], v[44:47]
buffer_load_dwordx4 v1, s[4:7], s8 offen offset:2048 sc1 lds
v_mfma_f32_16x16x32_bf16 v[44:47], a[104:107], a[40:43], v[44:47]
ds_read_b128 a[84:87], v1 offset:21504
v_mfma_f32_16x16x32_bf16 v[44:47], a[108:111], a[44:47], v[44:47]
v_exp_f32 v13, v85
v_mfma_f32_16x16x32_bf16 v[44:47], a[112:115], a[48:51], v[44:47]
ds_read_b128 a[88:91], v1 offset:22528
v_add_f32 v27, v27, v13
v_mfma_f32_16x16x32_bf16 v[44:47], a[116:119], a[52:55], v[44:47]
s_waitcnt lgkmcnt(3)
buffer_load_dwordx4 v1, s[4:7], s8 offen offset:3072 sc1 lds
v_mfma_f32_16x16x32_bf16 v[44:47], a[120:123], a[56:59], v[44:47]
s_add_u32 s8, s8, 28672
ds_read_b128 a[92:95], v1 offset:23552
v_cvt_pk_bf16_f32 v124, v12, v13
v_mfma_f32_16x16x32_bf16 v[44:47], a[124:127], a[60:63], v[44:47]
s_sub_u32 s9, s9, 1
v_exp_f32 v14, v86
v_mfma_f32_16x16x32_bf16 v[48:51], a[64:67], a[0:3], v[16:19]
s_cmp_eq_u32 s9, 0
ds_read_b128 a[96:99], v1 offset:24576
v_add_f32 v27, v27, v14
v_mfma_f32_16x16x32_bf16 v[48:51], a[68:71], a[4:7], v[48:51]
s_cselect_b32 s8, s10, s8
v_exp_f32 v15, v87
v_mfma_f32_16x16x32_bf16 v[48:51], a[72:75], a[8:11], v[48:51]
s_cselect_b32 s9, s11, s9
ds_read_b128 a[100:103], v1 offset:25600
v_add_f32 v27, v27, v15
v_mfma_f32_16x16x32_bf16 v[48:51], a[76:79], a[12:15], v[48:51]
s_waitcnt lgkmcnt(4)
s_cselect_b32 s10, 3221225472, s10
v_cvt_pk_bf16_f32 v125, v14, v15
v_mfma_f32_16x16x32_bf16 v[48:51], a[80:83], a[16:19], v[48:51]
ds_read_b128 a[104:107], v1 offset:26624
v_mfma_f32_16x16x32_bf16 v[48:51], a[84:87], a[20:23], v[48:51]
s_waitcnt lgkmcnt(4)
v_exp_f32 v8, v88
v_mfma_f32_16x16x32_bf16 v[48:51], a[88:91], a[24:27], v[48:51]
s_waitcnt lgkmcnt(3)
ds_read_b128 a[108:111], v1 offset:27648
v_add_f32 v26, v26, v8
v_mfma_f32_16x16x32_bf16 v[48:51], a[92:95], a[28:31], v[48:51]
v_exp_f32 v9, v89
v_mfma_f32_16x16x32_bf16 v[52:55], a[64:67], a[32:35], v[20:23]
ds_read_b128 a[112:115], v1 offset:28672
v_add_f32 v26, v26, v9
v_mfma_f32_16x16x32_bf16 v[52:55], a[68:71], a[36:39], v[52:55]
v_exp_f32 v10, v90
v_mfma_f32_16x16x32_bf16 v[52:55], a[72:75], a[40:43], v[52:55]
ds_read_b128 a[116:119], v1 offset:29696
v_cvt_pk_bf16_f32 v118, v8, v9
v_mfma_f32_16x16x32_bf16 v[52:55], a[76:79], a[44:47], v[52:55]
v_exp_f32 v11, v91
v_mfma_f32_16x16x32_bf16 v[52:55], a[80:83], a[48:51], v[52:55]
ds_read_b128 a[120:123], v1 offset:30720
v_add_f32 v26, v26, v10
v_mfma_f32_16x16x32_bf16 v[52:55], a[84:87], a[52:55], v[52:55]
v_add_f32 v26, v26, v11
v_cvt_pk_bf16_f32 v119, v10, v11
v_mfma_f32_16x16x32_bf16 v[52:55], a[88:91], a[56:59], v[52:55]
s_waitcnt vmcnt(8) lgkmcnt(4)
ds_read_b128 a[124:127], v1 offset:31744
v_mfma_f32_16x16x32_bf16 v[52:55], a[92:95], a[60:63], v[52:55]
s_barrier
v_mfma_f32_16x16x32_bf16 v[56:59], a[96:99], a[0:3], v[16:19]
ds_read_b128 a[64:67], v2 offset:32768
v_mfma_f32_16x16x32_bf16 v[56:59], a[100:103], a[4:7], v[56:59]
v_exp_f32 v12, v92
v_mfma_f32_16x16x32_bf16 v[56:59], a[104:107], a[8:11], v[56:59]
s_waitcnt lgkmcnt(4)
ds_read_b128 a[68:71], v2 offset:33792
v_add_f32 v27, v27, v12
v_mfma_f32_16x16x32_bf16 v[56:59], a[108:111], a[12:15], v[56:59]
v_exp_f32 v13, v93
v_mfma_f32_16x16x32_bf16 v[56:59], a[112:115], a[16:19], v[56:59]
s_waitcnt lgkmcnt(4)
ds_read_b128 a[72:75], v2 offset:34816
v_add_f32 v27, v27, v13
v_mfma_f32_16x16x32_bf16 v[56:59], a[116:119], a[20:23], v[56:59]
s_waitcnt lgkmcnt(4)
v_exp_f32 v14, v94
v_mfma_f32_16x16x32_bf16 v[56:59], a[120:123], a[24:27], v[56:59]
s_waitcnt lgkmcnt(3)
ds_read_b128 a[76:79], v2 offset:35840
v_cvt_pk_bf16_f32 v126, v12, v13
v_mfma_f32_16x16x32_bf16 v[56:59], a[124:127], a[28:31], v[56:59]
v_exp_f32 v15, v95
v_mfma_f32_16x16x32_bf16 v[60:63], a[96:99], a[32:35], v[20:23]
ds_read_b128 a[80:83], v2 offset:36864
v_add_f32 v27, v27, v14
v_mfma_f32_16x16x32_bf16 v[60:63], a[100:103], a[36:39], v[60:63]
v_add_f32 v27, v27, v15
v_cvt_pk_bf16_f32 v127, v14, v15
v_mfma_f32_16x16x32_bf16 v[60:63], a[104:107], a[40:43], v[60:63]
ds_read_b128 a[84:87], v2 offset:37888
v_add_f32 v28, v26, v27
v_mfma_f32_16x16x32_bf16 v[60:63], a[108:111], a[44:47], v[60:63]
v_cmp_nge_f32 vcc, s25, v28
v_mfma_f32_16x16x32_bf16 v[60:63], a[112:115], a[48:51], v[60:63]
ds_read_b128 a[88:91], v2 offset:38912
v_mfma_f32_16x16x32_bf16 v[60:63], a[116:119], a[52:55], v[60:63]
v_mfma_f32_16x16x32_bf16 v[60:63], a[120:123], a[56:59], v[60:63]
ds_read_b128 a[92:95], v2 offset:39936
v_mfma_f32_16x16x32_bf16 v[60:63], a[124:127], a[60:63], v[60:63]
s_waitcnt lgkmcnt(4)
s_cbranch_vccnz Lstub_2
Lback_3:
v_mfma_f32_16x16x32_bf16 v[128:131], a[64:67], v[112:115], v[128:131]
s_add_u32 m0, s18, 65536
ds_read_b128 a[96:99], v2 offset:40960
v_add_f32 v24, v24, v26
v_mfma_f32_16x16x32_bf16 v[128:131], a[68:71], v[116:119], v[128:131]
buffer_load_dwordx4 v1, s[4:7], s12 offen offset:0 sc1 lds
v_mfma_f32_16x16x32_bf16 v[132:135], a[68:71], v[124:127], v[132:135]
ds_read_b128 a[100:103], v2 offset:41984
v_add_f32 v25, v25, v27
v_mfma_f32_16x16x32_bf16 v[132:135], a[64:67], v[120:123], v[132:135]
v_exp_f32 v8, v32
v_mfma_f32_16x16x32_bf16 v[136:139], a[72:75], v[112:115], v[136:139]
ds_read_b128 a[104:107], v2 offset:43008
v_mfma_f32_16x16x32_bf16 v[136:139], a[76:79], v[116:119], v[136:139]
buffer_load_dwordx4 v1, s[4:7], s12 offen offset:1024 sc1 lds
v_mfma_f32_16x16x32_bf16 v[140:143], a[76:79], v[124:127], v[140:143]
ds_read_b128 a[108:111], v2 offset:44032
v_mfma_f32_16x16x32_bf16 v[140:143], a[72:75], v[120:123], v[140:143]
s_waitcnt lgkmcnt(4)
v_exp_f32 v9, v33
v_mfma_f32_16x16x32_bf16 v[144:147], a[80:83], v[112:115], v[144:147]
ds_read_b128 a[112:115], v2 offset:45056
v_add_f32 v26, v8, v9
v_mfma_f32_16x16x32_bf16 v[144:147], a[84:87], v[116:119], v[144:147]
buffer_load_dwordx4 v1, s[4:7], s12 offen offset:2048 sc1 lds
v_mfma_f32_16x16x32_bf16 v[148:151], a[84:87], v[124:127], v[148:151]
ds_read_b128 a[116:119], v2 offset:46080
v_cvt_pk_bf16_f32 v96, v8, v9
v_mfma_f32_16x16x32_bf16 v[148:151], a[80:83], v[120:123], v[148:151]
v_exp_f32 v10, v34
v_mfma_f32_16x16x32_bf16 v[152:155], a[88:91], v[112:115], v[152:155]
ds_read_b128 a[120:123], v2 offset:47104
v_add_f32 v26, v26, v10
v_mfma_f32_16x16x32_bf16 v[152:155], a[92:95], v[116:119], v[152:155]
buffer_load_dwordx4 v1, s[4:7], s12 offen offset:3072 sc1 lds
v_mfma_f32_16x16x32_bf16 v[156:159], a[92:95], v[124:127], v[156:159]
s_add_u32 s12, s12, 4096
ds_read_b128 a[124:127], v2 offset:48128
v_mfma_f32_16x16x32_bf16 v[156:159], a[88:91], v[120:123], v[156:159]
s_waitcnt lgkmcnt(4)
v_exp_f32 v11, v35
v_mfma_f32_16x16x32_bf16 v[160:163], a[96:99], v[112:115], v[160:163]
s_add_u32 m0, s18, 69632
ds_read_b128 a[64:67], v2 offset:49152
v_add_f32 v26, v26, v11
v_mfma_f32_16x16x32_bf16 v[160:163], a[100:103], v[116:119], v[160:163]
buffer_load_dwordx4 v1, s[4:7], s12 offen offset:0 sc1 lds
v_mfma_f32_16x16x32_bf16 v[164:167], a[100:103], v[124:127], v[164:167]
ds_read_b128 a[68:71], v2 offset:50176
v_cvt_pk_bf16_f32 v97, v10, v11
v_mfma_f32_16x16x32_bf16 v[164:167], a[96:99], v[120:123], v[164:167]
v_mfma_f32_16x16x32_bf16 v[168:171], a[104:107], v[112:115], v[168:171]
ds_read_b128 a[72:75], v2 offset:51200
v_mfma_f32_16x16x32_bf16 v[168:171], a[108:111], v[116:119], v[168:171]
buffer_load_dwordx4 v1, s[4:7], s12 offen offset:1024 sc1 lds
v_mfma_f32_16x16x32_bf16 v[172:175], a[108:111], v[124:127], v[172:175]
ds_read_b128 a[76:79], v2 offset:52224
v_mfma_f32_16x16x32_bf16 v[172:175], a[104:107], v[120:123], v[172:175]
s_waitcnt lgkmcnt(4)
v_exp_f32 v12, v36
v_mfma_f32_16x16x32_bf16 v[176:179], a[112:115], v[112:115], v[176:179]
ds_read_b128 a[80:83], v2 offset:53248
v_mfma_f32_16x16x32_bf16 v[176:179], a[116:119], v[116:119], v[176:179]
buffer_load_dwordx4 v1, s[4:7], s12 offen offset:2048 sc1 lds
v_mfma_f32_16x16x32_bf16 v[180:183], a[116:119], v[124:127], v[180:183]
ds_read_b128 a[84:87], v2 offset:54272
v_mfma_f32_16x16x32_bf16 v[180:183], a[112:115], v[120:123], v[180:183]
v_exp_f32 v13, v37
v_mfma_f32_16x16x32_bf16 v[184:187], a[120:123], v[112:115], v[184:187]
ds_read_b128 a[88:91], v2 offset:55296
v_add_f32 v27, v12, v13
v_mfma_f32_16x16x32_bf16 v[184:187], a[124:127], v[116:119], v[184:187]
s_waitcnt lgkmcnt(4)
buffer_load_dwordx4 v1, s[4:7], s12 offen offset:3072 sc1 lds
v_mfma_f32_16x16x32_bf16 v[188:191], a[124:127], v[124:127], v[188:191]
s_add_u32 s12, s12, 28672
ds_read_b128 a[92:95], v2 offset:56320
v_cvt_pk_bf16_f32 v104, v12, v13
v_mfma_f32_16x16x32_bf16 v[188:191], a[120:123], v[120:123], v[188:191]
s_sub_u32 s13, s13, 1
v_exp_f32 v14, v38
v_mfma_f32_16x16x32_bf16 v[192:195], a[64:67], v[112:115], v[192:195]
s_cmp_eq_u32 s13, 0
ds_read_b128 a[96:99], v2 offset:57344
v_add_f32 v27, v27, v14
v_mfma_f32_16x16x32_bf16 v[192:195], a[68:71], v[116:119], v[192:195]
s_cselect_b32 s12, s14, s12
v_mfma_f32_16x16x32_bf16 v[196:199], a[68:71], v[124:127], v[196:199]
s_cselect_b32 s13, s15, s13
ds_read_b128 a[100:103], v2 offset:58368
v_mfma_f32_16x16x32_bf16 v[196:199], a[64:67], v[120:123], v[196:199]
s_cselect_b32 s14, 3221225472, s14
v_exp_f32 v15, v39
v_mfma_f32_16x16x32_bf16 v[200:203], a[72:75], v[112:115], v[200:203]
s_waitcnt lgkmcnt(4)
ds_read_b128 a[104:107], v2 offset:59392
v_add_f32 v27, v27, v15
v_mfma_f32_16x16x32_bf16 v[200:203], a[76:79], v[116:119], v[200:203]
v_exp_f32 v8, v40
v_mfma_f32_16x16x32_bf16 v[204:207], a[76:79], v[124:127], v[204:207]
ds_read_b128 a[108:111], v2 offset:60416
v_cvt_pk_bf16_f32 v105, v14, v15
v_mfma_f32_16x16x32_bf16 v[204:207], a[72:75], v[120:123], v[204:207]
v_exp_f32 v9, v41
v_mfma_f32_16x16x32_bf16 v[208:211], a[80:83], v[112:115], v[208:211]
ds_read_b128 a[112:115], v2 offset:61440
v_add_f32 v26, v26, v8
v_mfma_f32_16x16x32_bf16 v[208:211], a[84:87], v[116:119], v[208:211]
v_add_f32 v26, v26, v9
v_cvt_pk_bf16_f32 v98, v8, v9
v_mfma_f32_16x16x32_bf16 v[212:215], a[84:87], v[124:127], v[212:215]
ds_read_b128 a[116:119], v2 offset:62464
v_mfma_f32_16x16x32_bf16 v[212:215], a[80:83], v[120:123], v[212:215]
s_waitcnt lgkmcnt(4)
v_exp_f32 v10, v42
v_mfma_f32_16x16x32_bf16 v[216:219], a[88:91], v[112:115], v[216:219]
ds_read_b128 a[120:123], v2 offset:63488
v_add_f32 v26, v26, v10
v_mfma_f32_16x16x32_bf16 v[216:219], a[92:95], v[116:119], v[216:219]
v_exp_f32 v11, v43
v_mfma_f32_16x16x32_bf16 v[220:223], a[92:95], v[124:127], v[220:223]
s_waitcnt vmcnt(8)
ds_read_b128 a[124:127], v2 offset:64512
v_add_f32 v26, v26, v11
v_mfma_f32_16x16x32_bf16 v[220:223], a[88:91], v[120:123], v[220:223]
s_barrier
v_mfma_f32_16x16x32_bf16 v[224:227], a[96:99], v[112:115], v[224:227]
ds_read_b128 a[64:67], v4 offset:0
v_cvt_pk_bf16_f32 v99, v10, v11
v_mfma_f32_16x16x32_bf16 v[224:227], a[100:103], v[116:119], v[224:227]
v_exp_f32 v12, v44
v_mfma_f32_16x16x32_bf16 v[228:231], a[100:103], v[124:127], v[228:231]
ds_read_b128 a[68:71], v4 offset:1024
v_add_f32 v27, v27, v12
v_mfma_f32_16x16x32_bf16 v[228:231], a[96:99], v[120:123], v[228:231]
s_waitcnt lgkmcnt(4)
v_mfma_f32_16x16x32_bf16 v[232:235], a[104:107], v[112:115], v[232:235]
ds_read_b128 a[72:75], v4 offset:2048
v_mfma_f32_16x16x32_bf16 v[232:235], a[108:111], v[116:119], v[232:235]
v_exp_f32 v13, v45
v_mfma_f32_16x16x32_bf16 v[236:239], a[108:111], v[124:127], v[236:239]
ds_read_b128 a[76:79], v4 offset:3072
v_add_f32 v27, v27, v13
v_mfma_f32_16x16x32_bf16 v[236:239], a[104:107], v[120:123], v[236:239]
v_exp_f32 v14, v46
v_mfma_f32_16x16x32_bf16 v[240:243], a[112:115], v[112:115], v[240:243]
ds_read_b128 a[80:83], v4 offset:4096
v_cvt_pk_bf16_f32 v106, v12, v13
v_mfma_f32_16x16x32_bf16 v[240:243], a[116:119], v[116:119], v[240:243]
v_exp_f32 v15, v47
v_mfma_f32_16x16x32_bf16 v[244:247], a[116:119], v[124:127], v[244:247]
ds_read_b128 a[84:87], v4 offset:5120
v_add_f32 v27, v27, v14
v_mfma_f32_16x16x32_bf16 v[244:247], a[112:115], v[120:123], v[244:247]
s_waitcnt lgkmcnt(4)
v_add_f32 v27, v27, v15
v_cvt_pk_bf16_f32 v107, v14, v15
v_mfma_f32_16x16x32_bf16 v[248:251], a[120:123], v[112:115], v[248:251]
ds_read_b128 a[88:91], v4 offset:6144
v_mfma_f32_16x16x32_bf16 v[248:251], a[124:127], v[116:119], v[248:251]
v_mfma_f32_16x16x32_bf16 v[252:255], a[124:127], v[124:127], v[252:255]
s_waitcnt lgkmcnt(5)
ds_read_b128 a[92:95], v4 offset:7168
v_mfma_f32_16x16x32_bf16 v[252:255], a[120:123], v[120:123], v[252:255]
s_branch K2_x1
K2_xexit:
s_cbranch_vccnz Lstub_4
Lback_5:
s_cmp_lg_u32 s19, 0
s_cbranch_scc1 K2_loop
s_cmp_eq_u32 s24, 2
s_cbranch_scc1 K2_ntail
v_mfma_f32_16x16x32_bf16 v[128:131], a[64:67], v[96:99], v[128:131]
s_add_u32 m0, s18, 98304
ds_read_b128 a[96:99], v2 offset:8192
v_add_f32 v24, v24, v26
v_mfma_f32_16x16x32_bf16 v[128:131], a[68:71], v[100:103], v[128:131]
buffer_load_dwordx4 v1, s[4:7], s12 offen offset:0 sc1 lds
v_mfma_f32_16x16x32_bf16 v[132:135], a[68:71], v[108:111], v[132:135]
ds_read_b128 a[100:103], v2 offset:9216
v_add_f32 v25, v25, v27
v_mfma_f32_16x16x32_bf16 v[132:135], a[64:67], v[104:107], v[132:135]
v_exp_f32 v8, v64
v_mfma_f32_16x16x32_bf16 v[136:139], a[72:75], v[96:99], v[136:139]
ds_read_b128 a[104:107], v2 offset:10240
v_mfma_f32_16x16x32_bf16 v[136:139], a[76:79], v[100:103], v[136:139]
buffer_load_dwordx4 v1, s[4:7], s12 offen offset:1024 sc1 lds
v_mfma_f32_16x16x32_bf16 v[140:143], a[76:79], v[108:111], v[140:143]
ds_read_b128 a[108:111], v2 offset:11264
v_mfma_f32_16x16x32_bf16 v[140:143], a[72:75], v[104:107], v[140:143]
s_waitcnt lgkmcnt(4)
v_exp_f32 v9, v65
v_mfma_f32_16x16x32_bf16 v[144:147], a[80:83], v[96:99], v[144:147]
ds_read_b128 a[112:115], v2 offset:12288
v_add_f32 v26, v8, v9
v_mfma_f32_16x16x32_bf16 v[144:147], a[84:87], v[100:103], v[144:147]
buffer_load_dwordx4 v1, s[4:7], s12 offen offset:2048 sc1 lds
v_mfma_f32_16x16x32_bf16 v[148:151], a[84:87], v[108:111], v[148:151]
ds_read_b128 a[116:119], v2 offset:13312
v_cvt_pk_bf16_f32 v112, v8, v9
v_mfma_f32_16x16x32_bf16 v[148:151], a[80:83], v[104:107], v[148:151]
v_exp_f32 v10, v66
v_mfma_f32_16x16x32_bf16 v[152:155], a[88:91], v[96:99], v[152:155]
ds_read_b128 a[120:123], v2 offset:14336
v_add_f32 v26, v26, v10
v_mfma_f32_16x16x32_bf16 v[152:155], a[92:95], v[100:103], v[152:155]
buffer_load_dwordx4 v1, s[4:7], s12 offen offset:3072 sc1 lds
v_mfma_f32_16x16x32_bf16 v[156:159], a[92:95], v[108:111], v[156:159]
s_add_u32 s12, s12, 4096
ds_read_b128 a[124:127], v2 offset:15360
v_mfma_f32_16x16x32_bf16 v[156:159], a[88:91], v[104:107], v[156:159]
s_waitcnt lgkmcnt(4)
v_exp_f32 v11, v67
v_mfma_f32_16x16x32_bf16 v[160:163], a[96:99], v[96:99], v[160:163]
s_add_u32 m0, s18, 102400
ds_read_b128 a[64:67], v2 offset:16384
v_add_f32 v26, v26, v11
v_mfma_f32_16x16x32_bf16 v[160:163], a[100:103], v[100:103], v[160:163]
buffer_load_dwordx4 v1, s[4:7], s12 offen offset:0 sc1 lds
v_mfma_f32_16x16x32_bf16 v[164:167], a[100:103], v[108:111], v[164:167]
ds_read_b128 a[68:71], v2 offset:17408
v_cvt_pk_bf16_f32 v113, v10, v11
v_mfma_f32_16x16x32_bf16 v[164:167], a[96:99], v[104:107], v[164:167]
v_mfma_f32_16x16x32_bf16 v[168:171], a[104:107], v[96:99], v[168:171]
ds_read_b128 a[72:75], v2 offset:18432
v_mfma_f32_16x16x32_bf16 v[168:171], a[108:111], v[100:103], v[168:171]
buffer_load_dwordx4 v1, s[4:7], s12 offen offset:1024 sc1 lds
v_mfma_f32_16x16x32_bf16 v[172:175], a[108:111], v[108:111], v[172:175]
ds_read_b128 a[76:79], v2 offset:19456
v_mfma_f32_16x16x32_bf16 v[172:175], a[104:107], v[104:107], v[172:175]
s_waitcnt lgkmcnt(4)
v_exp_f32 v12, v68
v_mfma_f32_16x16x32_bf16 v[176:179], a[112:115], v[96:99], v[176:179]
ds_read_b128 a[80:83], v2 offset:20480
v_mfma_f32_16x16x32_bf16 v[176:179], a[116:119], v[100:103], v[176:179]
buffer_load_dwordx4 v1, s[4:7], s12 offen offset:2048 sc1 lds
v_mfma_f32_16x16x32_bf16 v[180:183], a[116:119], v[108:111], v[180:183]
ds_read_b128 a[84:87], v2 offset:21504
v_mfma_f32_16x16x32_bf16 v[180:183], a[112:115], v[104:107], v[180:183]
v_exp_f32 v13, v69
v_mfma_f32_16x16x32_bf16 v[184:187], a[120:123], v[96:99], v[184:187]
ds_read_b128 a[88:91], v2 offset:22528
v_add_f32 v27, v12, v13
v_mfma_f32_16x16x32_bf16 v[184:187], a[124:127], v[100:103], v[184:187]
s_waitcnt lgkmcnt(4)
buffer_load_dwordx4 v1, s[4:7], s12 offen offset:3072 sc1 lds
v_mfma_f32_16x16x32_bf16 v[188:191], a[124:127], v[108:111], v[188:191]
s_add_u32 s12, s12, 28672
ds_read_b128 a[92:95], v2 offset:23552
v_cvt_pk_bf16_f32 v120, v12, v13
v_mfma_f32_16x16x32_bf16 v[188:191], a[120:123], v[104:107], v[188:191]
s_sub_u32 s13, s13, 1
v_exp_f32 v14, v70
v_mfma_f32_16x16x32_bf16 v[192:195], a[64:67], v[96:99], v[192:195]
s_cmp_eq_u32 s13, 0
ds_read_b128 a[96:99], v2 offset:24576
v_add_f32 v27, v27, v14
v_mfma_f32_16x16x32_bf16 v[192:195], a[68:71], v[100:103], v[192:195]
s_cselect_b32 s12, s14, s12
v_mfma_f32_16x16x32_bf16 v[196:199], a[68:71], v[108:111], v[196:199]
s_cselect_b32 s13, s15, s13
ds_read_b128 a[100:103], v2 offset:25600
v_mfma_f32_16x16x32_bf16 v[196:199], a[64:67], v[104:107], v[196:199]
s_cselect_b32 s14, 3221225472, s14
v_exp_f32 v15, v71
v_mfma_f32_16x16x32_bf16 v[200:203], a[72:75], v[96:99], v[200:203]
s_waitcnt lgkmcnt(4)
ds_read_b128 a[104:107], v2 offset:26624
v_add_f32 v27, v27, v15
v_mfma_f32_16x16x32_bf16 v[200:203], a[76:79], v[100:103], v[200:203]
v_exp_f32 v8, v72
v_mfma_f32_16x16x32_bf16 v[204:207], a[76:79], v[108:111], v[204:207]
ds_read_b128 a[108:111], v2 offset:27648
v_cvt_pk_bf16_f32 v121, v14, v15
v_mfma_f32_16x16x32_bf16 v[204:207], a[72:75], v[104:107], v[204:207]
v_exp_f32 v9, v73
v_mfma_f32_16x16x32_bf16 v[208:211], a[80:83], v[96:99], v[208:211]
ds_read_b128 a[112:115], v2 offset:28672
v_add_f32 v26, v26, v8
v_mfma_f32_16x16x32_bf16 v[208:211], a[84:87], v[100:103], v[208:211]
v_add_f32 v26, v26, v9
v_cvt_pk_bf16_f32 v114, v8, v9
v_mfma_f32_16x16x32_bf16 v[212:215], a[84:87], v[108:111], v[212:215]
ds_read_b128 a[116:119], v2 offset:29696
v_mfma_f32_16x16x32_bf16 v[212:215], a[80:83], v[104:107], v[212:215]
s_waitcnt lgkmcnt(4)
v_exp_f32 v10, v74
v_mfma_f32_16x16x32_bf16 v[216:219], a[88:91], v[96:99], v[216:219]
ds_read_b128 a[120:123], v2 offset:30720
v_add_f32 v26, v26, v10
v_mfma_f32_16x16x32_bf16 v[216:219], a[92:95], v[100:103], v[216:219]
v_exp_f32 v11, v75
v_mfma_f32_16x16x32_bf16 v[220:223], a[92:95], v[108:111], v[220:223]
s_waitcnt vmcnt(8)
ds_read_b128 a[124:127], v2 offset:31744
v_add_f32 v26, v26, v11
v_mfma_f32_16x16x32_bf16 v[220:223], a[88:91], v[104:107], v[220:223]
PAD_11:
s_cbranch_execz M_tret
s_barrier
v_mfma_f32_16x16x32_bf16 v[224:227], a[96:99], v[96:99], v[224:227]
ds_read_b128 a[64:67], v1 offset:0
v_cvt_pk_bf16_f32 v115, v10, v11
v_mfma_f32_16x16x32_bf16 v[224:227], a[100:103], v[100:103], v[224:227]
v_exp_f32 v12, v76
v_mfma_f32_16x16x32_bf16 v[228:231], a[100:103], v[108:111], v[228:231]
ds_read_b128 a[68:71], v1 offset:1024
v_add_f32 v27, v27, v12
v_mfma_f32_16x16x32_bf16 v[228:231], a[96:99], v[104:107], v[228:231]
s_waitcnt lgkmcnt(4)
v_mfma_f32_16x16x32_bf16 v[232:235], a[104:107], v[96:99], v[232:235]
ds_read_b128 a[72:75], v1 offset:2048
v_mfma_f32_16x16x32_bf16 v[232:235], a[108:111], v[100:103], v[232:235]
v_exp_f32 v13, v77
v_mfma_f32_16x16x32_bf16 v[236:239], a[108:111], v[108:111], v[236:239]
ds_read_b128 a[76:79], v1 offset:3072
v_add_f32 v27, v27, v13
v_mfma_f32_16x16x32_bf16 v[236:239], a[104:107], v[104:107], v[236:239]
v_exp_f32 v14, v78
v_mfma_f32_16x16x32_bf16 v[240:243], a[112:115], v[96:99], v[240:243]
ds_read_b128 a[80:83], v1 offset:4096
v_cvt_pk_bf16_f32 v122, v12, v13
v_mfma_f32_16x16x32_bf16 v[240:243], a[116:119], v[100:103], v[240:243]
v_exp_f32 v15, v79
v_mfma_f32_16x16x32_bf16 v[244:247], a[116:119], v[108:111], v[244:247]
ds_read_b128 a[84:87], v1 offset:5120
v_add_f32 v27, v27, v14
v_mfma_f32_16x16x32_bf16 v[244:247], a[112:115], v[104:107], v[244:247]
s_waitcnt lgkmcnt(4)
v_add_f32 v27, v27, v15
v_cvt_pk_bf16_f32 v123, v14, v15
v_mfma_f32_16x16x32_bf16 v[248:251], a[120:123], v[96:99], v[248:251]
ds_read_b128 a[88:91], v1 offset:6144
v_mfma_f32_16x16x32_bf16 v[248:251], a[124:127], v[100:103], v[248:251]
v_mfma_f32_16x16x32_bf16 v[252:255], a[124:127], v[108:111], v[252:255]
ds_read_b128 a[92:95], v1 offset:7168
v_mfma_f32_16x16x32_bf16 v[252:255], a[120:123], v[104:107], v[252:255]
v_cndmask_b32 v32, v16, v7, s[32:33]
v_cndmask_b32 v33, v16, v7, s[34:35]
v_cndmask_b32 v34, v16, v7, s[36:37]
v_cndmask_b32 v35, v16, v7, s[38:39]
s_nop 1
v_mfma_f32_16x16x32_bf16 v[32:35], a[64:67], a[0:3], v[32:35]
s_add_u32 m0, s18, 131072
ds_read_b128 a[96:99], v1 offset:8192
v_cndmask_b32 v40, v16, v7, s[40:41]
v_mfma_f32_16x16x32_bf16 v[32:35], a[68:71], a[4:7], v[32:35]
s_waitcnt lgkmcnt(4)
buffer_load_dwordx4 v1, s[4:7], s8 offen offset:0 sc1 lds
v_mfma_f32_16x16x32_bf16 v[32:35], a[72:75], a[8:11], v[32:35]
ds_read_b128 a[100:103], v1 offset:9216
v_cndmask_b32 v41, v16, v7, s[42:43]
v_mfma_f32_16x16x32_bf16 v[32:35], a[76:79], a[12:15], v[32:35]
v_cndmask_b32 v42, v16, v7, s[44:45]
v_cndmask_b32 v43, v16, v7, s[46:47]
v_mfma_f32_16x16x32_bf16 v[32:35], a[80:83], a[16:19], v[32:35]
s_waitcnt lgkmcnt(4)
ds_read_b128 a[104:107], v1 offset:10240
v_mfma_f32_16x16x32_bf16 v[32:35], a[84:87], a[20:23], v[32:35]
s_waitcnt lgkmcnt(4)
buffer_load_dwordx4 v1, s[4:7], s8 offen offset:1024 sc1 lds
v_mfma_f32_16x16x32_bf16 v[32:35], a[88:91], a[24:27], v[32:35]
s_waitcnt lgkmcnt(3)
ds_read_b128 a[108:111], v1 offset:11264
v_mfma_f32_16x16x32_bf16 v[32:35], a[92:95], a[28:31], v[32:35]
v_exp_f32 v8, v80
v_mfma_f32_16x16x32_bf16 v[36:39], a[64:67], a[32:35], v[20:23]
ds_read_b128 a[112:115], v1 offset:12288
v_add_f32 v26, v26, v8
v_mfma_f32_16x16x32_bf16 v[36:39], a[68:71], a[36:39], v[36:39]
buffer_load_dwordx4 v1, s[4:7], s8 offen offset:2048 sc1 lds
v_mfma_f32_16x16x32_bf16 v[36:39], a[72:75], a[40:43], v[36:39]
ds_read_b128 a[116:119], v1 offset:13312
v_mfma_f32_16x16x32_bf16 v[36:39], a[76:79], a[44:47], v[36:39]
v_exp_f32 v9, v81
v_mfma_f32_16x16x32_bf16 v[36:39], a[80:83], a[48:51], v[36:39]
ds_read_b128 a[120:123], v1 offset:14336
v_add_f32 v26, v26, v9
v_mfma_f32_16x16x32_bf16 v[36:39], a[84:87], a[52:55], v[36:39]
buffer_load_dwordx4 v1, s[4:7], s8 offen offset:3072 sc1 lds
v_mfma_f32_16x16x32_bf16 v[36:39], a[88:91], a[56:59], v[36:39]
s_add_u32 s8, s8, 4096
ds_read_b128 a[124:127], v1 offset:15360
v_cvt_pk_bf16_f32 v116, v8, v9
v_mfma_f32_16x16x32_bf16 v[36:39], a[92:95], a[60:63], v[36:39]
s_waitcnt lgkmcnt(4)
v_exp_f32 v10, v82
v_mfma_f32_16x16x32_bf16 v[40:43], a[96:99], a[0:3], v[40:43]
s_add_u32 m0, s18, 135168
ds_read_b128 a[64:67], v1 offset:16384
v_cndmask_b32 v48, v16, v7, s[48:49]
v_mfma_f32_16x16x32_bf16 v[40:43], a[100:103], a[4:7], v[40:43]
buffer_load_dwordx4 v1, s[4:7], s8 offen offset:0 sc1 lds
v_mfma_f32_16x16x32_bf16 v[40:43], a[104:107], a[8:11], v[40:43]
ds_read_b128 a[68:71], v1 offset:17408
v_cndmask_b32 v49, v16, v7, s[50:51]
v_mfma_f32_16x16x32_bf16 v[40:43], a[108:111], a[12:15], v[40:43]
s_waitcnt lgkmcnt(4)
v_cndmask_b32 v50, v16, v7, s[52:53]
v_cndmask_b32 v51, v16, v7, s[54:55]
v_mfma_f32_16x16x32_bf16 v[40:43], a[112:115], a[16:19], v[40:43]
ds_read_b128 a[72:75], v1 offset:18432
v_add_f32 v26, v26, v10
v_mfma_f32_16x16x32_bf16 v[40:43], a[116:119], a[20:23], v[40:43]
s_waitcnt lgkmcnt(4)
buffer_load_dwordx4 v1, s[4:7], s8 offen offset:1024 sc1 lds
v_mfma_f32_16x16x32_bf16 v[40:43], a[120:123], a[24:27], v[40:43]
s_waitcnt lgkmcnt(3)
ds_read_b128 a[76:79], v1 offset:19456
v_mfma_f32_16x16x32_bf16 v[40:43], a[124:127], a[28:31], v[40:43]
v_exp_f32 v11, v83
v_mfma_f32_16x16x32_bf16 v[44:47], a[96:99], a[32:35], v[20:23]
ds_read_b128 a[80:83], v1 offset:20480
v_add_f32 v26, v26, v11
v_mfma_f32_16x16x32_bf16 v[44:47], a[100:103], a[36:39], v[44:47]
buffer_load_dwordx4 v1, s[4:7], s8 offen offset:2048 sc1 lds
v_mfma_f32_16x16x32_bf16 v[44:47], a[104:107], a[40:43], v[44:47]
ds_read_b128 a[84:87], v1 offset:21504
v_cvt_pk_bf16_f32 v117, v10, v11
v_mfma_f32_16x16x32_bf16 v[44:47], a[108:111], a[44:47], v[44:47]
v_exp_f32 v12, v84
v_mfma_f32_16x16x32_bf16 v[44:47], a[112:115], a[48:51], v[44:47]
ds_read_b128 a[88:91], v1 offset:22528
v_add_f32 v27, v27, v12
v_mfma_f32_16x16x32_bf16 v[44:47], a[116:119], a[52:55], v[44:47]
buffer_load_dwordx4 v1, s[4:7], s8 offen offset:3072 sc1 lds
v_mfma_f32_16x16x32_bf16 v[44:47], a[120:123], a[56:59], v[44:47]
s_waitcnt lgkmcnt(2)
s_add_u32 s8, s8, 28672
ds_read_b128 a[92:95], v1 offset:23552
v_mfma_f32_16x16x32_bf16 v[44:47], a[124:127], a[60:63], v[44:47]
s_sub_u32 s9, s9, 1
v_exp_f32 v13, v85
v_mfma_f32_16x16x32_bf16 v[48:51], a[64:67], a[0:3], v[48:51]
s_cmp_eq_u32 s9, 0
ds_read_b128 a[96:99], v1 offset:24576
v_cndmask_b32 v56, v16, v7, s[56:57]
v_mfma_f32_16x16x32_bf16 v[48:51], a[68:71], a[4:7], v[48:51]
s_cselect_b32 s8, s10, s8
v_cndmask_b32 v57, v16, v7, s[58:59]
v_cndmask_b32 v58, v16, v7, s[60:61]
v_mfma_f32_16x16x32_bf16 v[48:51], a[72:75], a[8:11], v[48:51]
s_cselect_b32 s9, s11, s9
ds_read_b128 a[100:103], v1 offset:25600
v_cndmask_b32 v59, v16, v7, s[62:63]
v_mfma_f32_16x16x32_bf16 v[48:51], a[76:79], a[12:15], v[48:51]
s_cselect_b32 s10, 3221225472, s10
v_exp_f32 v14, v86
v_mfma_f32_16x16x32_bf16 v[48:51], a[80:83], a[16:19], v[48:51]
s_waitcnt lgkmcnt(4)
ds_read_b128 a[104:107], v1 offset:26624
v_add_f32 v27, v27, v13
v_cvt_pk_bf16_f32 v124, v12, v13
v_mfma_f32_16x16x32_bf16 v[48:51], a[84:87], a[20:23], v[48:51]
s_waitcnt lgkmcnt(4)
v_exp_f32 v15, v87
v_mfma_f32_16x16x32_bf16 v[48:51], a[88:91], a[24:27], v[48:51]
s_waitcnt lgkmcnt(3)
ds_read_b128 a[108:111], v1 offset:27648
v_add_f32 v27, v27, v14
v_mfma_f32_16x16x32_bf16 v[48:51], a[92:95], a[28:31], v[48:51]
v_exp_f32 v8, v88
v_mfma_f32_16x16x32_bf16 v[52:55], a[64:67], a[32:35], v[20:23]
ds_read_b128 a[112:115], v1 offset:28672
v_add_f32 v27, v27, v15
v_mfma_f32_16x16x32_bf16 v[52:55], a[68:71], a[36:39], v[52:55]
v_exp_f32 v9, v89
v_mfma_f32_16x16x32_bf16 v[52:55], a[72:75], a[40:43], v[52:55]
ds_read_b128 a[116:119], v1 offset:29696
v_cvt_pk_bf16_f32 v125, v14, v15
v_mfma_f32_16x16x32_bf16 v[52:55], a[76:79], a[44:47], v[52:55]
v_exp_f32 v10, v90
v_mfma_f32_16x16x32_bf16 v[52:55], a[80:83], a[48:51], v[52:55]
ds_read_b128 a[120:123], v1 offset:30720
v_add_f32 v26, v26, v8
v_mfma_f32_16x16x32_bf16 v[52:55], a[84:87], a[52:55], v[52:55]
v_exp_f32 v11, v91
v_mfma_f32_16x16x32_bf16 v[52:55], a[88:91], a[56:59], v[52:55]
s_waitcnt vmcnt(8) lgkmcnt(4)
ds_read_b128 a[124:127], v1 offset:31744
v_add_f32 v26, v26, v9
v_cvt_pk_bf16_f32 v118, v8, v9
v_mfma_f32_16x16x32_bf16 v[52:55], a[92:95], a[60:63], v[52:55]
s_barrier
v_mfma_f32_16x16x32_bf16 v[56:59], a[96:99], a[0:3], v[56:59]
ds_read_b128 a[64:67], v2 offset:32768
v_add_f32 v26, v26, v10
v_mfma_f32_16x16x32_bf16 v[56:59], a[100:103], a[4:7], v[56:59]
v_exp_f32 v12, v92
v_mfma_f32_16x16x32_bf16 v[56:59], a[104:107], a[8:11], v[56:59]
s_waitcnt lgkmcnt(4)
ds_read_b128 a[68:71], v2 offset:33792
v_add_f32 v26, v26, v11
v_cvt_pk_bf16_f32 v119, v10, v11
v_mfma_f32_16x16x32_bf16 v[56:59], a[108:111], a[12:15], v[56:59]
v_exp_f32 v13, v93
v_mfma_f32_16x16x32_bf16 v[56:59], a[112:115], a[16:19], v[56:59]
s_waitcnt lgkmcnt(4)
ds_read_b128 a[72:75], v2 offset:34816
v_add_f32 v27, v27, v12
v_mfma_f32_16x16x32_bf16 v[56:59], a[116:119], a[20:23], v[56:59]
s_waitcnt lgkmcnt(4)
v_exp_f32 v14, v94
v_mfma_f32_16x16x32_bf16 v[56:59], a[120:123], a[24:27], v[56:59]
s_waitcnt lgkmcnt(3)
ds_read_b128 a[76:79], v2 offset:35840
v_add_f32 v27, v27, v13
v_mfma_f32_16x16x32_bf16 v[56:59], a[124:127], a[28:31], v[56:59]
v_exp_f32 v15, v95
v_mfma_f32_16x16x32_bf16 v[60:63], a[96:99], a[32:35], v[20:23]
ds_read_b128 a[80:83], v2 offset:36864
v_cvt_pk_bf16_f32 v126, v12, v13
v_mfma_f32_16x16x32_bf16 v[60:63], a[100:103], a[36:39], v[60:63]
v_add_f32 v27, v27, v14
v_add_f32 v27, v27, v15
v_mfma_f32_16x16x32_bf16 v[60:63], a[104:107], a[40:43], v[60:63]
ds_read_b128 a[84:87], v2 offset:37888
v_cvt_pk_bf16_f32 v127, v14, v15
v_mfma_f32_16x16x32_bf16 v[60:63], a[108:111], a[44:47], v[60:63]
v_add_f32 v28, v26, v27
v_cmp_nge_f32 vcc, s25, v28
v_mfma_f32_16x16x32_bf16 v[60:63], a[112:115], a[48:51], v[60:63]
ds_read_b128 a[88:91], v2 offset:38912
v_mfma_f32_16x16x32_bf16 v[60:63], a[116:119], a[52:55], v[60:63]
v_mfma_f32_16x16x32_bf16 v[60:63], a[120:123], a[56:59], v[60:63]
ds_read_b128 a[92:95], v2 offset:39936
v_mfma_f32_16x16x32_bf16 v[60:63], a[124:127], a[60:63], v[60:63]
s_waitcnt lgkmcnt(4)
s_cbranch_vccnz Lstub_6
Lback_7:
v_mfma_f32_16x16x32_bf16 v[128:131], a[64:67], v[112:115], v[128:131]
s_add_u32 m0, s18, 65536
ds_read_b128 a[96:99], v2 offset:40960
v_add_f32 v24, v24, v26
v_mfma_f32_16x16x32_bf16 v[128:131], a[68:71], v[116:119], v[128:131]
buffer_load_dwordx4 v1, s[4:7], s12 offen offset:0 sc1 lds
v_mfma_f32_16x16x32_bf16 v[132:135], a[68:71], v[124:127], v[132:135]
ds_read_b128 a[100:103], v2 offset:41984
v_add_f32 v25, v25, v27
v_mfma_f32_16x16x32_bf16 v[132:135], a[64:67], v[120:123], v[132:135]
v_exp_f32 v8, v32
v_mfma_f32_16x16x32_bf16 v[136:139], a[72:75], v[112:115], v[136:139]
ds_read_b128 a[104:107], v2 offset:43008
v_mfma_f32_16x16x32_bf16 v[136:139], a[76:79], v[116:119], v[136:139]
buffer_load_dwordx4 v1, s[4:7], s12 offen offset:1024 sc1 lds
v_mfma_f32_16x16x32_bf16 v[140:143], a[76:79], v[124:127], v[140:143]
ds_read_b128 a[108:111], v2 offset:44032
v_mfma_f32_16x16x32_bf16 v[140:143], a[72:75], v[120:123], v[140:143]
s_waitcnt lgkmcnt(4)
v_exp_f32 v9, v33
v_mfma_f32_16x16x32_bf16 v[144:147], a[80:83], v[112:115], v[144:147]
ds_read_b128 a[112:115], v2 offset:45056
v_add_f32 v26, v8, v9
v_mfma_f32_16x16x32_bf16 v[144:147], a[84:87], v[116:119], v[144:147]
buffer_load_dwordx4 v1, s[4:7], s12 offen offset:2048 sc1 lds
v_mfma_f32_16x16x32_bf16 v[148:151], a[84:87], v[124:127], v[148:151]
ds_read_b128 a[116:119], v2 offset:46080
v_cvt_pk_bf16_f32 v96, v8, v9
v_mfma_f32_16x16x32_bf16 v[148:151], a[80:83], v[120:123], v[148:151]
v_exp_f32 v10, v34
v_mfma_f32_16x16x32_bf16 v[152:155], a[88:91], v[112:115], v[152:155]
ds_read_b128 a[120:123], v2 offset:47104
v_add_f32 v26, v26, v10
v_mfma_f32_16x16x32_bf16 v[152:155], a[92:95], v[116:119], v[152:155]
buffer_load_dwordx4 v1, s[4:7], s12 offen offset:3072 sc1 lds
v_mfma_f32_16x16x32_bf16 v[156:159], a[92:95], v[124:127], v[156:159]
s_add_u32 s12, s12, 4096
ds_read_b128 a[124:127], v2 offset:48128
v_mfma_f32_16x16x32_bf16 v[156:159], a[88:91], v[120:123], v[156:159]
s_waitcnt lgkmcnt(4)
v_exp_f32 v11, v35
v_mfma_f32_16x16x32_bf16 v[160:163], a[96:99], v[112:115], v[160:163]
s_add_u32 m0, s18, 69632
ds_read_b128 a[64:67], v2 offset:49152
v_add_f32 v26, v26, v11
v_mfma_f32_16x16x32_bf16 v[160:163], a[100:103], v[116:119], v[160:163]
buffer_load_dwordx4 v1, s[4:7], s12 offen offset:0 sc1 lds
v_mfma_f32_16x16x32_bf16 v[164:167], a[100:103], v[124:127], v[164:167]
ds_read_b128 a[68:71], v2 offset:50176
v_cvt_pk_bf16_f32 v97, v10, v11
v_mfma_f32_16x16x32_bf16 v[164:167], a[96:99], v[120:123], v[164:167]
v_mfma_f32_16x16x32_bf16 v[168:171], a[104:107], v[112:115], v[168:171]
ds_read_b128 a[72:75], v2 offset:51200
v_mfma_f32_16x16x32_bf16 v[168:171], a[108:111], v[116:119], v[168:171]
buffer_load_dwordx4 v1, s[4:7], s12 offen offset:1024 sc1 lds
v_mfma_f32_16x16x32_bf16 v[172:175], a[108:111], v[124:127], v[172:175]
ds_read_b128 a[76:79], v2 offset:52224
v_mfma_f32_16x16x32_bf16 v[172:175], a[104:107], v[120:123], v[172:175]
s_waitcnt lgkmcnt(4)
v_exp_f32 v12, v36
v_mfma_f32_16x16x32_bf16 v[176:179], a[112:115], v[112:115], v[176:179]
ds_read_b128 a[80:83], v2 offset:53248
v_mfma_f32_16x16x32_bf16 v[176:179], a[116:119], v[116:119], v[176:179]
buffer_load_dwordx4 v1, s[4:7], s12 offen offset:2048 sc1 lds
v_mfma_f32_16x16x32_bf16 v[180:183], a[116:119], v[124:127], v[180:183]
ds_read_b128 a[84:87], v2 offset:54272
v_mfma_f32_16x16x32_bf16 v[180:183], a[112:115], v[120:123], v[180:183]
v_exp_f32 v13, v37
v_mfma_f32_16x16x32_bf16 v[184:187], a[120:123], v[112:115], v[184:187]
ds_read_b128 a[88:91], v2 offset:55296
v_add_f32 v27, v12, v13
v_mfma_f32_16x16x32_bf16 v[184:187], a[124:127], v[116:119], v[184:187]
s_waitcnt lgkmcnt(4)
buffer_load_dwordx4 v1, s[4:7], s12 offen offset:3072 sc1 lds
v_mfma_f32_16x16x32_bf16 v[188:191], a[124:127], v[124:127], v[188:191]
s_add_u32 s12, s12, 28672
ds_read_b128 a[92:95], v2 offset:56320
v_cvt_pk_bf16_f32 v104, v12, v13
v_mfma_f32_16x16x32_bf16 v[188:191], a[120:123], v[120:123], v[188:191]
s_sub_u32 s13, s13, 1
v_exp_f32 v14, v38
v_mfma_f32_16x16x32_bf16 v[192:195], a[64:67], v[112:115], v[192:195]
s_cmp_eq_u32 s13, 0
ds_read_b128 a[96:99], v2 offset:57344
v_add_f32 v27, v27, v14
v_mfma_f32_16x16x32_bf16 v[192:195], a[68:71], v[116:119], v[192:195]
s_cselect_b32 s12, s14, s12
v_exp_f32 v15, v39
v_mfma_f32_16x16x32_bf16 v[196:199], a[68:71], v[124:127], v[196:199]
s_cselect_b32 s13, s15, s13
ds_read_b128 a[100:103], v2 offset:58368
v_add_f32 v27, v27, v15
v_mfma_f32_16x16x32_bf16 v[196:199], a[64:67], v[120:123], v[196:199]
s_cselect_b32 s14, 3221225472, s14
v_cvt_pk_bf16_f32 v105, v14, v15
v_mfma_f32_16x16x32_bf16 v[200:203], a[72:75], v[112:115], v[200:203]
s_waitcnt lgkmcnt(4)
ds_read_b128 a[104:107], v2 offset:59392
v_mfma_f32_16x16x32_bf16 v[200:203], a[76:79], v[116:119], v[200:203]
buffer_load_dword v3, off, s[4:7], s80 sc1
v_mfma_f32_16x16x32_bf16 v[204:207], a[76:79], v[124:127], v[204:207]
ds_read_b128 a[108:111], v2 offset:60416
v_mfma_f32_16x16x32_bf16 v[204:207], a[72:75], v[120:123], v[204:207]
v_exp_f32 v8, v40
v_mfma_f32_16x16x32_bf16 v[208:211], a[80:83], v[112:115], v[208:211]
ds_read_b128 a[112:115], v2 offset:61440
v_add_f32 v26, v26, v8
v_mfma_f32_16x16x32_bf16 v[208:211], a[84:87], v[116:119], v[208:211]
v_exp_f32 v9, v41
v_mfma_f32_16x16x32_bf16 v[212:215], a[84:87], v[124:127], v[212:215]
ds_read_b128 a[116:119], v2 offset:62464
v_add_f32 v26, v26, v9
v_mfma_f32_16x16x32_bf16 v[212:215], a[80:83], v[120:123], v[212:215]
s_waitcnt lgkmcnt(4)
v_exp_f32 v10, v42
v_mfma_f32_16x16x32_bf16 v[216:219], a[88:91], v[112:115], v[216:219]
ds_read_b128 a[120:123], v2 offset:63488
v_cvt_pk_bf16_f32 v98, v8, v9
v_mfma_f32_16x16x32_bf16 v[216:219], a[92:95], v[116:119], v[216:219]
v_exp_f32 v11, v43
v_mfma_f32_16x16x32_bf16 v[220:223], a[92:95], v[124:127], v[220:223]
s_waitcnt vmcnt(9)
ds_read_b128 a[124:127], v2 offset:64512
v_add_f32 v26, v26, v10
v_mfma_f32_16x16x32_bf16 v[220:223], a[88:91], v[120:123], v[220:223]
s_barrier
v_mfma_f32_16x16x32_bf16 v[224:227], a[96:99], v[112:115], v[224:227]
ds_read_b128 a[64:67], v4 offset:0
v_add_f32 v26, v26, v11
v_mfma_f32_16x16x32_bf16 v[224:227], a[100:103], v[116:119], v[224:227]
v_cvt_pk_bf16_f32 v99, v10, v11
v_mfma_f32_16x16x32_bf16 v[228:231], a[100:103], v[124:127], v[228:231]
ds_read_b128 a[68:71], v4 offset:1024
v_mfma_f32_16x16x32_bf16 v[228:231], a[96:99], v[120:123], v[228:231]
s_waitcnt lgkmcnt(4)
v_exp_f32 v12, v44
v_mfma_f32_16x16x32_bf16 v[232:235], a[104:107], v[112:115], v[232:235]
ds_read_b128 a[72:75], v4 offset:2048
v_add_f32 v27, v27, v12
v_mfma_f32_16x16x32_bf16 v[232:235], a[108:111], v[116:119], v[232:235]
v_exp_f32 v13, v45
v_mfma_f32_16x16x32_bf16 v[236:239], a[108:111], v[124:127], v[236:239]
ds_read_b128 a[76:79], v4 offset:3072
v_add_f32 v27, v27, v13
v_mfma_f32_16x16x32_bf16 v[236:239], a[104:107], v[120:123], v[236:239]
v_exp_f32 v14, v46
v_mfma_f32_16x16x32_bf16 v[240:243], a[112:115], v[112:115], v[240:243]
ds_read_b128 a[80:83], v4 offset:4096
v_cvt_pk_bf16_f32 v106, v12, v13
v_mfma_f32_16x16x32_bf16 v[240:243], a[116:119], v[116:119], v[240:243]
v_exp_f32 v15, v47
v_mfma_f32_16x16x32_bf16 v[244:247], a[116:119], v[124:127], v[244:247]
ds_read_b128 a[84:87], v4 offset:5120
v_add_f32 v27, v27, v14
v_mfma_f32_16x16x32_bf16 v[244:247], a[112:115], v[120:123], v[244:247]
s_waitcnt lgkmcnt(4)
v_add_f32 v27, v27, v15
v_cvt_pk_bf16_f32 v107, v14, v15
v_mfma_f32_16x16x32_bf16 v[248:251], a[120:123], v[112:115], v[248:251]
ds_read_b128 a[88:91], v4 offset:6144
v_mfma_f32_16x16x32_bf16 v[248:251], a[124:127], v[116:119], v[248:251]
v_mfma_f32_16x16x32_bf16 v[252:255], a[124:127], v[124:127], v[252:255]
ds_read_b128 a[92:95], v4 offset:7168
v_mfma_f32_16x16x32_bf16 v[252:255], a[120:123], v[120:123], v[252:255]
K2_dx1:
v_cndmask_b32 v68, v20, v7, s[32:33]
v_cndmask_b32 v69, v20, v7, s[34:35]
v_cndmask_b32 v70, v20, v7, s[36:37]
v_cndmask_b32 v71, v20, v7, s[38:39]
s_nop 1
v_mfma_f32_16x16x32_bf16 v[68:71], a[64:67], a[32:35], v[68:71]
s_add_u32 m0, s18, 0
ds_read_b128 a[96:99], v4 offset:8192
v_cndmask_b32 v76, v20, v7, s[40:41]
v_cndmask_b32 v79, v20, v7, s[46:47]
v_mfma_f32_16x16x32_bf16 v[68:71], a[68:71], a[36:39], v[68:71]
s_waitcnt lgkmcnt(4)
ds_read_b128 a[100:103], v4 offset:9216
buffer_load_dwordx4 v1, s[4:7], s12 offen offset:0 sc1 lds
v_mfma_f32_16x16x32_bf16 v[68:71], a[72:75], a[40:43], v[68:71]
ds_read_b128 a[104:107], v4 offset:10240
v_cndmask_b32 v77, v20, v7, s[42:43]
v_mfma_f32_16x16x32_bf16 v[68:71], a[76:79], a[44:47], v[68:71]
ds_read_b128 a[108:111], v4 offset:11264
buffer_load_dwordx4 v1, s[4:7], s12 offen offset:1024 sc1 lds
v_mfma_f32_16x16x32_bf16 v[68:71], a[80:83], a[48:51], v[68:71]
s_waitcnt lgkmcnt(6)
ds_read_b128 a[112:115], v4 offset:12288
v_cndmask_b32 v78, v20, v7, s[44:45]
v_mfma_f32_16x16x32_bf16 v[68:71], a[84:87], a[52:55], v[68:71]
s_waitcnt lgkmcnt(6)
ds_read_b128 a[116:119], v4 offset:13312
buffer_load_dwordx4 v1, s[4:7], s12 offen offset:2048 sc1 lds
v_mfma_f32_16x16x32_bf16 v[68:71], a[88:91], a[56:59], v[68:71]
s_waitcnt lgkmcnt(6)
ds_read_b128 a[120:123], v4 offset:14336
v_exp_f32 v8, v48
v_exp_f32 v9, v49
v_exp_f32 v10, v50
v_mfma_f32_16x16x32_bf16 v[68:71], a[92:95], a[60:63], v[68:71]
s_waitcnt lgkmcnt(5)
ds_read_b128 a[124:127], v4 offset:15360
buffer_load_dwordx4 v1, s[4:7], s12 offen offset:3072 sc1 lds
v_add_f32 v26, v26, v8
v_add_f32 v26, v26, v9
v_cvt_pk_bf16_f32 v100, v8, v9
v_add_f32 v26, v26, v10
v_mfma_f32_16x16x32_bf16 v[76:79], a[96:99], a[32:35], v[76:79]
s_add_u32 s12, s12, 4096
s_add_u32 m0, s18, 4096
ds_read_b128 a[64:67], v4 offset:16384
v_cndmask_b32 v86, v20, v7, s[52:53]
v_cndmask_b32 v87, v20, v7, s[54:55]
v_mfma_f32_16x16x32_bf16 v[76:79], a[100:103], a[36:39], v[76:79]
s_waitcnt lgkmcnt(6)
ds_read_b128 a[68:71], v4 offset:17408
buffer_load_dwordx4 v1, s[4:7], s12 offen offset:0 sc1 lds
v_mfma_f32_16x16x32_bf16 v[76:79], a[104:107], a[40:43], v[76:79]
s_waitcnt lgkmcnt(6)
ds_read_b128 a[72:75], v4 offset:18432
v_cndmask_b32 v84, v20, v7, s[48:49]
v_mfma_f32_16x16x32_bf16 v[76:79], a[108:111], a[44:47], v[76:79]
s_waitcnt lgkmcnt(6)
ds_read_b128 a[76:79], v4 offset:19456
buffer_load_dwordx4 v1, s[4:7], s12 offen offset:1024 sc1 lds
v_mfma_f32_16x16x32_bf16 v[76:79], a[112:115], a[48:51], v[76:79]
s_waitcnt lgkmcnt(6)
ds_read_b128 a[80:83], v4 offset:20480
v_cndmask_b32 v85, v20, v7, s[50:51]
v_mfma_f32_16x16x32_bf16 v[76:79], a[116:119], a[52:55], v[76:79]
s_waitcnt lgkmcnt(6)
ds_read_b128 a[84:87], v4 offset:21504
buffer_load_dwordx4 v1, s[4:7], s12 offen offset:2048 sc1 lds
v_mfma_f32_16x16x32_bf16 v[76:79], a[120:123], a[56:59], v[76:79]
s_waitcnt lgkmcnt(6)
ds_read_b128 a[88:91], v4 offset:22528
v_exp_f32 v11, v51
v_exp_f32 v12, v52
v_mfma_f32_16x16x32_bf16 v[76:79], a[124:127], a[60:63], v[76:79]
s_waitcnt lgkmcnt(1)
ds_read_b128 a[92:95], v4 offset:23552
buffer_load_dwordx4 v1, s[4:7], s12 offen offset:3072 sc1 lds
v_add_f32 v26, v26, v11
v_cvt_pk_bf16_f32 v101, v10, v11
v_add_f32 v27, v27, v12
v_mfma_f32_16x16x32_bf16 v[84:87], a[64:67], a[32:35], v[84:87]
s_add_u32 s12, s12, 28672
ds_read_b128 a[96:99], v4 offset:24576
v_cndmask_b32 v92, v20, v7, s[56:57]
v_mfma_f32_16x16x32_bf16 v[84:87], a[68:71], a[36:39], v[84:87]
s_sub_u32 s13, s13, 1
ds_read_b128 a[100:103], v4 offset:25600
v_cndmask_b32 v93, v20, v7, s[58:59]
v_mfma_f32_16x16x32_bf16 v[84:87], a[72:75], a[40:43], v[84:87]
s_cmp_eq_u32 s13, 0
ds_read_b128 a[104:107], v4 offset:26624
v_cndmask_b32 v94, v20, v7, s[60:61]
v_mfma_f32_16x16x32_bf16 v[84:87], a[76:79], a[44:47], v[84:87]
s_cselect_b32 s12, s14, s12
ds_read_b128 a[108:111], v4 offset:27648
v_cndmask_b32 v95, v20, v7, s[62:63]
v_mfma_f32_16x16x32_bf16 v[84:87], a[80:83], a[48:51], v[84:87]
s_cselect_b32 s13, s15, s13
ds_read_b128 a[112:115], v4 offset:28672
v_exp_f32 v13, v53
v_exp_f32 v14, v54
v_mfma_f32_16x16x32_bf16 v[84:87], a[84:87], a[52:55], v[84:87]
s_waitcnt lgkmcnt(6)
s_cselect_b32 s14, 3221225472, s14
ds_read_b128 a[116:119], v4 offset:29696
v_exp_f32 v15, v55
v_exp_f32 v8, v56
v_exp_f32 v9, v57
v_add_f32 v27, v27, v13
v_cvt_pk_bf16_f32 v108, v12, v13
v_add_f32 v27, v27, v14
v_mfma_f32_16x16x32_bf16 v[84:87], a[88:91], a[56:59], v[84:87]
s_waitcnt lgkmcnt(6)
ds_read_b128 a[120:123], v4 offset:30720
v_exp_f32 v10, v58
v_exp_f32 v11, v59
v_add_f32 v27, v27, v15
v_cvt_pk_bf16_f32 v109, v14, v15
v_mfma_f32_16x16x32_bf16 v[84:87], a[92:95], a[60:63], v[84:87]
s_waitcnt vmcnt(8) lgkmcnt(6)
s_barrier
ds_read_b128 a[124:127], v4 offset:31744
v_mfma_f32_16x16x32_bf16 v[92:95], a[96:99], a[32:35], v[92:95]
s_waitcnt lgkmcnt(6)
ds_read_b128 a[64:67], v2 offset:0
v_exp_f32 v12, v60
v_exp_f32 v13, v61
v_mfma_f32_16x16x32_bf16 v[92:95], a[100:103], a[36:39], v[92:95]
s_waitcnt lgkmcnt(6)
ds_read_b128 a[68:71], v2 offset:1024
v_exp_f32 v14, v62
v_exp_f32 v15, v63
v_mfma_f32_16x16x32_bf16 v[92:95], a[104:107], a[40:43], v[92:95]
s_waitcnt lgkmcnt(6)
ds_read_b128 a[72:75], v2 offset:2048
v_add_f32 v26, v26, v8
v_add_f32 v26, v26, v9
v_cvt_pk_bf16_f32 v102, v8, v9
v_mfma_f32_16x16x32_bf16 v[92:95], a[108:111], a[44:47], v[92:95]
s_waitcnt lgkmcnt(6)
ds_read_b128 a[76:79], v2 offset:3072
v_add_f32 v26, v26, v10
v_add_f32 v26, v26, v11
v_cvt_pk_bf16_f32 v103, v10, v11
v_mfma_f32_16x16x32_bf16 v[92:95], a[112:115], a[48:51], v[92:95]
s_waitcnt lgkmcnt(6)
ds_read_b128 a[80:83], v2 offset:4096
v_add_f32 v27, v27, v12
v_mfma_f32_16x16x32_bf16 v[92:95], a[116:119], a[52:55], v[92:95]
s_waitcnt lgkmcnt(6)
ds_read_b128 a[84:87], v2 offset:5120
v_add_f32 v27, v27, v13
v_cvt_pk_bf16_f32 v110, v12, v13
v_mfma_f32_16x16x32_bf16 v[92:95], a[120:123], a[56:59], v[92:95]
s_waitcnt lgkmcnt(6)
ds_read_b128 a[88:91], v2 offset:6144
v_add_f32 v27, v27, v14
v_add_f32 v27, v27, v15
v_cvt_pk_bf16_f32 v111, v14, v15
v_mfma_f32_16x16x32_bf16 v[92:95], a[124:127], a[60:63], v[92:95]
s_waitcnt lgkmcnt(6)
ds_read_b128 a[92:95], v2 offset:7168
v_add_f32 v28, v26, v27
v_cmp_nge_f32 vcc, s25, v28
s_cbranch_vccnz Lstub_8
Lback_9:
s_cmp_lg_u32 s24, 1
s_cbranch_scc1 K2_plain
v_cmp_gt_u32 vcc, 1, v3
s_cbranch_vccnz K2_tspin
K2_tok:
v_mfma_f32_16x16x32_bf16 v[128:131], a[64:67], v[96:99], v[128:131]
s_waitcnt lgkmcnt(6)
ds_read_b128 a[96:99], v2 offset:8192
v_add_f32 v24, v24, v26
v_mfma_f32_16x16x32_bf16 v[128:131], a[68:71], v[100:103], v[128:131]
buffer_load_dwordx4 v[28:31], v1, s[4:7], s27 offen sc1
v_mfma_f32_16x16x32_bf16 v[132:135], a[68:71], v[108:111], v[132:135]
ds_read_b128 a[100:103], v2 offset:9216
v_add_f32 v25, v25, v27
v_mfma_f32_16x16x32_bf16 v[132:135], a[64:67], v[104:107], v[132:135]
s_waitcnt lgkmcnt(6)
v_exp_f32 v8, v68
v_mfma_f32_16x16x32_bf16 v[136:139], a[72:75], v[96:99], v[136:139]
s_add_u32 s22, s76, 0
ds_read_b128 a[104:107], v2 offset:10240
v_exp_f32 v9, v69
v_mfma_f32_16x16x32_bf16 v[136:139], a[76:79], v[100:103], v[136:139]
buffer_load_dwordx4 v[32:35], v1, s[4:7], s22 offen offset:0 sc1
v_mfma_f32_16x16x32_bf16 v[140:143], a[76:79], v[108:111], v[140:143]
ds_read_b128 a[108:111], v2 offset:11264
v_add_f32 v27, v8, v9
v_mfma_f32_16x16x32_bf16 v[140:143], a[72:75], v[104:107], v[140:143]
s_waitcnt lgkmcnt(5)
v_exp_f32 v10, v70
v_mfma_f32_16x16x32_bf16 v[144:147], a[80:83], v[96:99], v[144:147]
ds_read_b128 a[112:115], v2 offset:12288
v_cvt_pk_bf16_f32 v120, v8, v9
v_mfma_f32_16x16x32_bf16 v[144:147], a[84:87], v[100:103], v[144:147]
buffer_load_dwordx4 v[36:39], v1, s[4:7], s22 offen offset:1024 sc1
v_mfma_f32_16x16x32_bf16 v[148:151], a[84:87], v[108:111], v[148:151]
ds_read_b128 a[116:119], v2 offset:13312
v_add_f32 v27, v27, v10
v_mfma_f32_16x16x32_bf16 v[148:151], a[80:83], v[104:107], v[148:151]
v_exp_f32 v11, v71
v_mfma_f32_16x16x32_bf16 v[152:155], a[88:91], v[96:99], v[152:155]
s_waitcnt lgkmcnt(4)
ds_read_b128 a[120:123], v2 offset:14336
v_add_f32 v27, v27, v11
v_mfma_f32_16x16x32_bf16 v[152:155], a[92:95], v[100:103], v[152:155]
buffer_load_dwordx4 v[40:43], v1, s[4:7], s22 offen offset:2048 sc1
v_mfma_f32_16x16x32_bf16 v[156:159], a[92:95], v[108:111], v[156:159]
ds_read_b128 a[124:127], v2 offset:15360
v_cvt_pk_bf16_f32 v121, v10, v11
v_mfma_f32_16x16x32_bf16 v[156:159], a[88:91], v[104:107], v[156:159]
v_exp_f32 v12, v76
v_mfma_f32_16x16x32_bf16 v[160:163], a[96:99], v[96:99], v[160:163]
ds_read_b128 a[64:67], v2 offset:16384
v_add_f32 v27, v27, v12
v_mfma_f32_16x16x32_bf16 v[160:163], a[100:103], v[100:103], v[160:163]
buffer_load_dwordx4 v[44:47], v1, s[4:7], s22 offen offset:3072 sc1
v_mfma_f32_16x16x32_bf16 v[164:167], a[100:103], v[108:111], v[164:167]
PAD_12:
s_cbranch_execz M_tret
ds_read_b128 a[68:71], v2 offset:17408
v_mfma_f32_16x16x32_bf16 v[164:167], a[96:99], v[104:107], v[164:167]
s_waitcnt lgkmcnt(4)
v_exp_f32 v13, v77
v_mfma_f32_16x16x32_bf16 v[168:171], a[104:107], v[96:99], v[168:171]
s_add_u32 s22, s76, 4096
ds_read_b128 a[72:75], v2 offset:18432
v_add_f32 v27, v27, v13
v_mfma_f32_16x16x32_bf16 v[168:171], a[108:111], v[100:103], v[168:171]
buffer_load_dwordx4 v[48:51], v1, s[4:7], s22 offen offset:0 sc1
v_mfma_f32_16x16x32_bf16 v[172:175], a[108:111], v[108:111], v[172:175]
ds_read_b128 a[76:79], v2 offset:19456
v_exp_f32 v14, v78
v_mfma_f32_16x16x32_bf16 v[172:175], a[104:107], v[104:107], v[172:175]
v_exp_f32 v15, v79
v_mfma_f32_16x16x32_bf16 v[176:179], a[112:115], v[96:99], v[176:179]
ds_read_b128 a[80:83], v2 offset:20480
v_cvt_pk_bf16_f32 v122, v12, v13
v_mfma_f32_16x16x32_bf16 v[176:179], a[116:119], v[100:103], v[176:179]
buffer_load_dwordx4 v[52:55], v1, s[4:7], s22 offen offset:1024 sc1
v_mfma_f32_16x16x32_bf16 v[180:183], a[116:119], v[108:111], v[180:183]
ds_read_b128 a[84:87], v2 offset:21504
v_add_f32 v27, v27, v14
v_mfma_f32_16x16x32_bf16 v[180:183], a[112:115], v[104:107], v[180:183]
s_waitcnt lgkmcnt(4)
v_exp_f32 v8, v84
v_mfma_f32_16x16x32_bf16 v[184:187], a[120:123], v[96:99], v[184:187]
ds_read_b128 a[88:91], v2 offset:22528
v_add_f32 v27, v27, v15
v_cvt_pk_bf16_f32 v123, v14, v15
v_mfma_f32_16x16x32_bf16 v[184:187], a[124:127], v[100:103], v[184:187]
buffer_load_dwordx4 v[56:59], v1, s[4:7], s22 offen offset:2048 sc1
v_mfma_f32_16x16x32_bf16 v[188:191], a[124:127], v[108:111], v[188:191]
ds_read_b128 a[92:95], v2 offset:23552
v_add_f32 v27, v27, v8
v_mfma_f32_16x16x32_bf16 v[188:191], a[120:123], v[104:107], v[188:191]
v_exp_f32 v9, v85
v_mfma_f32_16x16x32_bf16 v[192:195], a[64:67], v[96:99], v[192:195]
ds_read_b128 a[96:99], v2 offset:24576
v_add_f32 v27, v27, v9
v_mfma_f32_16x16x32_bf16 v[192:195], a[68:71], v[100:103], v[192:195]
buffer_load_dwordx4 v[60:63], v1, s[4:7], s22 offen offset:3072 sc1
v_mfma_f32_16x16x32_bf16 v[196:199], a[68:71], v[108:111], v[196:199]
ds_read_b128 a[100:103], v2 offset:25600
v_cvt_pk_bf16_f32 v124, v8, v9
v_mfma_f32_16x16x32_bf16 v[196:199], a[64:67], v[104:107], v[196:199]
s_waitcnt lgkmcnt(4)
v_exp_f32 v10, v86
v_mfma_f32_16x16x32_bf16 v[200:203], a[72:75], v[96:99], v[200:203]
s_add_u32 s22, s76, 8192
ds_read_b128 a[104:107], v2 offset:26624
v_add_f32 v27, v27, v10
v_mfma_f32_16x16x32_bf16 v[200:203], a[76:79], v[100:103], v[200:203]
buffer_load_dwordx4 a[32:35], v1, s[4:7], s22 offen offset:0 sc1
v_mfma_f32_16x16x32_bf16 v[204:207], a[76:79], v[108:111], v[204:207]
ds_read_b128 a[108:111], v2 offset:27648
v_mfma_f32_16x16x32_bf16 v[204:207], a[72:75], v[104:107], v[204:207]
v_exp_f32 v11, v87
v_mfma_f32_16x16x32_bf16 v[208:211], a[80:83], v[96:99], v[208:211]
ds_read_b128 a[112:115], v2 offset:28672
v_exp_f32 v12, v92
v_mfma_f32_16x16x32_bf16 v[208:211], a[84:87], v[100:103], v[208:211]
buffer_load_dwordx4 a[36:39], v1, s[4:7], s22 offen offset:1024 sc1
v_mfma_f32_16x16x32_bf16 v[212:215], a[84:87], v[108:111], v[212:215]
ds_read_b128 a[116:119], v2 offset:29696
v_add_f32 v27, v27, v11
v_mfma_f32_16x16x32_bf16 v[212:215], a[80:83], v[104:107], v[212:215]
s_waitcnt lgkmcnt(4)
v_exp_f32 v13, v93
v_mfma_f32_16x16x32_bf16 v[216:219], a[88:91], v[96:99], v[216:219]
ds_read_b128 a[120:123], v2 offset:30720
v_cvt_pk_bf16_f32 v125, v10, v11
v_add_f32 v27, v27, v12
v_mfma_f32_16x16x32_bf16 v[216:219], a[92:95], v[100:103], v[216:219]
buffer_load_dwordx4 a[40:43], v1, s[4:7], s22 offen offset:2048 sc1
v_mfma_f32_16x16x32_bf16 v[220:223], a[92:95], v[108:111], v[220:223]
s_waitcnt vmcnt(12)
ds_read_b128 a[124:127], v2 offset:31744
v_add_f32 v27, v27, v13
v_mfma_f32_16x16x32_bf16 v[220:223], a[88:91], v[104:107], v[220:223]
s_barrier
v_mfma_f32_16x16x32_bf16 v[224:227], a[96:99], v[96:99], v[224:227]
ds_read_b128 a[64:67], v1 offset:0
v_cvt_pk_bf16_f32 v126, v12, v13
v_mfma_f32_16x16x32_bf16 v[224:227], a[100:103], v[100:103], v[224:227]
buffer_load_dwordx4 a[44:47], v1, s[4:7], s22 offen offset:3072 sc1
v_mfma_f32_16x16x32_bf16 v[228:231], a[100:103], v[108:111], v[228:231]
ds_read_b128 a[68:71], v1 offset:1024
v_mfma_f32_16x16x32_bf16 v[228:231], a[96:99], v[104:107], v[228:231]
s_waitcnt lgkmcnt(4)
v_exp_f32 v14, v94
v_mfma_f32_16x16x32_bf16 v[232:235], a[104:107], v[96:99], v[232:235]
s_add_u32 s22, s76, 12288
ds_read_b128 a[72:75], v1 offset:2048
v_add_f32 v27, v27, v14
v_mfma_f32_16x16x32_bf16 v[232:235], a[108:111], v[100:103], v[232:235]
buffer_load_dwordx4 a[48:51], v1, s[4:7], s22 offen offset:0 sc1
v_mfma_f32_16x16x32_bf16 v[236:239], a[108:111], v[108:111], v[236:239]
ds_read_b128 a[76:79], v1 offset:3072
v_mfma_f32_16x16x32_bf16 v[236:239], a[104:107], v[104:107], v[236:239]
v_exp_f32 v15, v95
v_mfma_f32_16x16x32_bf16 v[240:243], a[112:115], v[96:99], v[240:243]
ds_read_b128 a[80:83], v1 offset:4096
v_add_f32 v27, v27, v15
v_mfma_f32_16x16x32_bf16 v[240:243], a[116:119], v[100:103], v[240:243]
buffer_load_dwordx4 a[52:55], v1, s[4:7], s22 offen offset:1024 sc1
v_mfma_f32_16x16x32_bf16 v[244:247], a[116:119], v[108:111], v[244:247]
ds_read_b128 a[84:87], v1 offset:5120
v_cvt_pk_bf16_f32 v127, v14, v15
v_mfma_f32_16x16x32_bf16 v[244:247], a[112:115], v[104:107], v[244:247]
s_waitcnt lgkmcnt(4)
v_cmp_nge_f32 vcc, s25, v27
v_mfma_f32_16x16x32_bf16 v[248:251], a[120:123], v[96:99], v[248:251]
ds_read_b128 a[88:91], v1 offset:6144
v_mfma_f32_16x16x32_bf16 v[248:251], a[124:127], v[100:103], v[248:251]
buffer_load_dwordx4 a[56:59], v1, s[4:7], s22 offen offset:2048 sc1
v_mfma_f32_16x16x32_bf16 v[252:255], a[124:127], v[108:111], v[252:255]
ds_read_b128 a[92:95], v1 offset:7168
v_mfma_f32_16x16x32_bf16 v[252:255], a[120:123], v[104:107], v[252:255]
s_waitcnt lgkmcnt(2)
buffer_load_dwordx4 a[60:63], v1, s[4:7], s22 offen offset:3072 sc1
s_cbranch_vccnz Lstub_10
Lback_11:
v_mfma_f32_16x16x32_bf16 v[132:135], a[64:67], v[120:123], v[132:135]
s_mov_b64 s[36:37], s[86:87]
ds_read_b128 a[96:99], v1 offset:8192
v_add_f32 v25, v25, v27
v_mfma_f32_16x16x32_bf16 v[132:135], a[68:71], v[124:127], v[132:135]
s_mov_b32 s38, 3670016
ds_read_b128 a[100:103], v1 offset:9216
v_accvgpr_read_b32 v112, a184
v_mfma_f32_16x16x32_bf16 v[140:143], a[72:75], v[120:123], v[140:143]
s_mov_b32 s39, 0x20000
ds_read_b128 a[104:107], v1 offset:10240
v_accvgpr_read_b32 v113, a185
v_mfma_f32_16x16x32_bf16 v[140:143], a[76:79], v[124:127], v[140:143]
s_lshl_b32 s8, s29, 3
ds_read_b128 a[108:111], v1 offset:11264
v_accvgpr_read_b32 v114, a186
v_mfma_f32_16x16x32_bf16 v[148:151], a[80:83], v[120:123], v[148:151]
s_add_u32 s8, s8, s3
ds_read_b128 a[112:115], v1 offset:12288
v_accvgpr_read_b32 v115, a187
v_mfma_f32_16x16x32_bf16 v[148:151], a[84:87], v[124:127], v[148:151]
s_waitcnt lgkmcnt(3)
s_lshl_b32 s8, s8, 4
ds_read_b128 a[116:119], v1 offset:13312
v_accvgpr_read_b32 v116, a188
v_mfma_f32_16x16x32_bf16 v[156:159], a[88:91], v[120:123], v[156:159]
s_add_u32 s8, s8, s20
ds_read_b128 a[120:123], v1 offset:14336
v_accvgpr_read_b32 v117, a189
v_mfma_f32_16x16x32_bf16 v[156:159], a[92:95], v[124:127], v[156:159]
s_mul_i32 s8, s8, 14336
ds_read_b128 a[124:127], v1 offset:15360
v_accvgpr_read_b32 v118, a190
v_mfma_f32_16x16x32_bf16 v[164:167], a[96:99], v[120:123], v[164:167]
s_add_u32 s8, s8, 104857600
ds_read_b128 a[64:67], v1 offset:16384
v_accvgpr_read_b32 v119, a191
v_mfma_f32_16x16x32_bf16 v[164:167], a[100:103], v[124:127], v[164:167]
s_waitcnt lgkmcnt(6)
s_add_u32 s12, s8, 917504
ds_read_b128 a[68:71], v1 offset:17408
v_mfma_f32_16x16x32_bf16 v[172:175], a[104:107], v[120:123], v[172:175]
s_waitcnt lgkmcnt(6)
ds_read_b128 a[72:75], v1 offset:18432
v_mfma_f32_16x16x32_bf16 v[172:175], a[108:111], v[124:127], v[172:175]
s_waitcnt lgkmcnt(6)
ds_read_b128 a[76:79], v1 offset:19456
v_mfma_f32_16x16x32_bf16 v[180:183], a[112:115], v[120:123], v[180:183]
s_waitcnt lgkmcnt(6)
ds_read_b128 a[80:83], v1 offset:20480
v_mfma_f32_16x16x32_bf16 v[180:183], a[116:119], v[124:127], v[180:183]
s_waitcnt lgkmcnt(6)
ds_read_b128 a[84:87], v1 offset:21504
v_mfma_f32_16x16x32_bf16 v[188:191], a[120:123], v[120:123], v[188:191]
s_waitcnt lgkmcnt(6)
ds_read_b128 a[88:91], v1 offset:22528
v_mfma_f32_16x16x32_bf16 v[188:191], a[124:127], v[124:127], v[188:191]
s_waitcnt lgkmcnt(6)
ds_read_b128 a[92:95], v1 offset:23552
v_mfma_f32_16x16x32_bf16 v[196:199], a[64:67], v[120:123], v[196:199]
s_waitcnt lgkmcnt(6)
ds_read_b128 a[96:99], v1 offset:24576
v_mfma_f32_16x16x32_bf16 v[196:199], a[68:71], v[124:127], v[196:199]
s_waitcnt lgkmcnt(6)
ds_read_b128 a[100:103], v1 offset:25600
v_mfma_f32_16x16x32_bf16 v[204:207], a[72:75], v[120:123], v[204:207]
s_waitcnt lgkmcnt(6)
ds_read_b128 a[104:107], v1 offset:26624
v_mfma_f32_16x16x32_bf16 v[204:207], a[76:79], v[124:127], v[204:207]
s_waitcnt lgkmcnt(6)
ds_read_b128 a[108:111], v1 offset:27648
v_mfma_f32_16x16x32_bf16 v[212:215], a[80:83], v[120:123], v[212:215]
s_waitcnt lgkmcnt(6)
ds_read_b128 a[112:115], v1 offset:28672
v_mfma_f32_16x16x32_bf16 v[212:215], a[84:87], v[124:127], v[212:215]
s_waitcnt lgkmcnt(6)
ds_read_b128 a[116:119], v1 offset:29696
v_mfma_f32_16x16x32_bf16 v[220:223], a[88:91], v[120:123], v[220:223]
s_waitcnt lgkmcnt(6)
s_add_u32 m0, s18, 32768
ds_read_b128 a[120:123], v1 offset:30720
v_mfma_f32_16x16x32_bf16 v[220:223], a[92:95], v[124:127], v[220:223]
s_waitcnt lgkmcnt(6)
ds_read_b128 a[124:127], v1 offset:31744
v_mfma_f32_16x16x32_bf16 v[228:231], a[96:99], v[120:123], v[228:231]
s_waitcnt lgkmcnt(6)
buffer_load_dwordx4 v112, s[36:39], s81 offen offset:0 lds
v_mfma_f32_16x16x32_bf16 v[228:231], a[100:103], v[124:127], v[228:231]
s_waitcnt lgkmcnt(5)
buffer_load_dwordx4 v113, s[36:39], s81 offen offset:1024 lds
v_mfma_f32_16x16x32_bf16 v[236:239], a[104:107], v[120:123], v[236:239]
s_waitcnt lgkmcnt(4)
buffer_load_dwordx4 v114, s[36:39], s81 offen offset:2048 lds
v_mfma_f32_16x16x32_bf16 v[236:239], a[108:111], v[124:127], v[236:239]
s_waitcnt lgkmcnt(3)
buffer_load_dwordx4 v115, s[36:39], s81 offen offset:3072 lds
v_mfma_f32_16x16x32_bf16 v[244:247], a[112:115], v[120:123], v[244:247]
s_waitcnt lgkmcnt(2)
s_add_u32 s81, s81, 28672
v_mfma_f32_16x16x32_bf16 v[244:247], a[116:119], v[124:127], v[244:247]
s_waitcnt lgkmcnt(1)
s_add_u32 m0, s18, 36864
v_mfma_f32_16x16x32_bf16 v[252:255], a[120:123], v[120:123], v[252:255]
s_waitcnt lgkmcnt(0)
buffer_load_dwordx4 v112, s[36:39], s81 offen offset:0 lds
v_mfma_f32_16x16x32_bf16 v[252:255], a[124:127], v[124:127], v[252:255]
buffer_load_dwordx4 v113, s[36:39], s81 offen offset:1024 lds
buffer_load_dwordx4 v114, s[36:39], s81 offen offset:2048 lds
buffer_load_dwordx4 v115, s[36:39], s81 offen offset:3072 lds
s_sub_u32 s81, s81, 28544
s_waitcnt vmcnt(8)
v_sub_f32 v8, v16, v28
v_sub_f32 v10, v20, v30
v_max_f32 v9, v8, v10
v_cmp_lt_f32 vcc, 1114636288, v9
s_cbranch_vccnz K2_cfix
K2_cok:
v_exp_f32 v8, v8
v_exp_f32 v10, v10
s_nop 0
v_mov_b32 v9, v8
v_mov_b32 v11, v10
v_fmac_f32 v24, v8, v29
v_fmac_f32 v25, v10, v31
s_mov_b32 s23, 0xffff0000
v_lshlrev_b32 v64, 16, v32
v_and_b32 v65, s23, v32
v_lshlrev_b32 v66, 16, v33
v_and_b32 v67, s23, v33
v_lshlrev_b32 v68, 16, v34
v_and_b32 v69, s23, v34
v_lshlrev_b32 v70, 16, v35
v_and_b32 v71, s23, v35
v_pk_fma_f32 v[128:129], v[64:65], v[8:9], v[128:129]
v_pk_fma_f32 v[130:131], v[66:67], v[8:9], v[130:131]
v_pk_fma_f32 v[136:137], v[68:69], v[8:9], v[136:137]
v_pk_fma_f32 v[138:139], v[70:71], v[8:9], v[138:139]
v_cvt_pk_bf16_f32 v128, v128, v129
v_cvt_pk_bf16_f32 v129, v130, v131
v_cvt_pk_bf16_f32 v130, v136, v137
v_cvt_pk_bf16_f32 v131, v138, v139
s_add_u32 m0, s18, 98304
s_nop 0
buffer_load_dwordx4 v112, s[36:39], s81 offen offset:0 lds
v_lshlrev_b32 v64, 16, v36
v_and_b32 v65, s23, v36
v_lshlrev_b32 v66, 16, v37
v_and_b32 v67, s23, v37
v_lshlrev_b32 v68, 16, v38
v_and_b32 v69, s23, v38
v_lshlrev_b32 v70, 16, v39
v_and_b32 v71, s23, v39
v_pk_fma_f32 v[144:145], v[64:65], v[8:9], v[144:145]
v_pk_fma_f32 v[146:147], v[66:67], v[8:9], v[146:147]
v_pk_fma_f32 v[152:153], v[68:69], v[8:9], v[152:153]
v_pk_fma_f32 v[154:155], v[70:71], v[8:9], v[154:155]
v_cvt_pk_bf16_f32 v144, v144, v145
v_cvt_pk_bf16_f32 v145, v146, v147
v_cvt_pk_bf16_f32 v146, v152, v153
v_cvt_pk_bf16_f32 v147, v154, v155
buffer_load_dwordx4 v113, s[36:39], s81 offen offset:1024 lds
v_lshlrev_b32 v64, 16, v40
v_and_b32 v65, s23, v40
v_lshlrev_b32 v66, 16, v41
v_and_b32 v67, s23, v41
v_lshlrev_b32 v68, 16, v42
v_and_b32 v69, s23, v42
v_lshlrev_b32 v70, 16, v43
v_and_b32 v71, s23, v43
v_pk_fma_f32 v[160:161], v[64:65], v[8:9], v[160:161]
v_pk_fma_f32 v[162:163], v[66:67], v[8:9], v[162:163]
v_pk_fma_f32 v[168:169], v[68:69], v[8:9], v[168:169]
v_pk_fma_f32 v[170:171], v[70:71], v[8:9], v[170:171]
v_cvt_pk_bf16_f32 v160, v160, v161
v_cvt_pk_bf16_f32 v161, v162, v163
v_cvt_pk_bf16_f32 v162, v168, v169
v_cvt_pk_bf16_f32 v163, v170, v171
buffer_load_dwordx4 v114, s[36:39], s81 offen offset:2048 lds
v_lshlrev_b32 v64, 16, v44
v_and_b32 v65, s23, v44
v_lshlrev_b32 v66, 16, v45
v_and_b32 v67, s23, v45
v_lshlrev_b32 v68, 16, v46
v_and_b32 v69, s23, v46
v_lshlrev_b32 v70, 16, v47
v_and_b32 v71, s23, v47
v_pk_fma_f32 v[176:177], v[64:65], v[8:9], v[176:177]
v_pk_fma_f32 v[178:179], v[66:67], v[8:9], v[178:179]
v_pk_fma_f32 v[184:185], v[68:69], v[8:9], v[184:185]
v_pk_fma_f32 v[186:187], v[70:71], v[8:9], v[186:187]
v_cvt_pk_bf16_f32 v176, v176, v177
v_cvt_pk_bf16_f32 v177, v178, v179
v_cvt_pk_bf16_f32 v178, v184, v185
v_cvt_pk_bf16_f32 v179, v186, v187
buffer_load_dwordx4 v115, s[36:39], s81 offen offset:3072 lds
v_lshlrev_b32 v64, 16, v48
v_and_b32 v65, s23, v48
v_lshlrev_b32 v66, 16, v49
v_and_b32 v67, s23, v49
v_lshlrev_b32 v68, 16, v50
v_and_b32 v69, s23, v50
v_lshlrev_b32 v70, 16, v51
v_and_b32 v71, s23, v51
v_pk_fma_f32 v[192:193], v[64:65], v[8:9], v[192:193]
v_pk_fma_f32 v[194:195], v[66:67], v[8:9], v[194:195]
v_pk_fma_f32 v[200:201], v[68:69], v[8:9], v[200:201]
v_pk_fma_f32 v[202:203], v[70:71], v[8:9], v[202:203]
v_cvt_pk_bf16_f32 v192, v192, v193
v_cvt_pk_bf16_f32 v193, v194, v195
v_cvt_pk_bf16_f32 v194, v200, v201
v_cvt_pk_bf16_f32 v195, v202, v203
s_add_u32 s81, s81, 28672
s_add_u32 m0, s18, 102400
s_nop 0
buffer_load_dwordx4 v112, s[36:39], s81 offen offset:0 lds
v_lshlrev_b32 v64, 16, v52
v_and_b32 v65, s23, v52
v_lshlrev_b32 v66, 16, v53
v_and_b32 v67, s23, v53
v_lshlrev_b32 v68, 16, v54
v_and_b32 v69, s23, v54
v_lshlrev_b32 v70, 16, v55
v_and_b32 v71, s23, v55
v_pk_fma_f32 v[208:209], v[64:65], v[8:9], v[208:209]
v_pk_fma_f32 v[210:211], v[66:67], v[8:9], v[210:211]
v_pk_fma_f32 v[216:217], v[68:69], v[8:9], v[216:217]
v_pk_fma_f32 v[218:219], v[70:71], v[8:9], v[218:219]
v_cvt_pk_bf16_f32 v208, v208, v209
v_cvt_pk_bf16_f32 v209, v210, v211
v_cvt_pk_bf16_f32 v210, v216, v217
v_cvt_pk_bf16_f32 v211, v218, v219
buffer_load_dwordx4 v113, s[36:39], s81 offen offset:1024 lds
v_lshlrev_b32 v64, 16, v56
v_and_b32 v65, s23, v56
v_lshlrev_b32 v66, 16, v57
v_and_b32 v67, s23, v57
v_lshlrev_b32 v68, 16, v58
v_and_b32 v69, s23, v58
v_lshlrev_b32 v70, 16, v59
v_and_b32 v71, s23, v59
v_pk_fma_f32 v[224:225], v[64:65], v[8:9], v[224:225]
v_pk_fma_f32 v[226:227], v[66:67], v[8:9], v[226:227]
v_pk_fma_f32 v[232:233], v[68:69], v[8:9], v[232:233]
v_pk_fma_f32 v[234:235], v[70:71], v[8:9], v[234:235]
v_cvt_pk_bf16_f32 v224, v224, v225
v_cvt_pk_bf16_f32 v225, v226, v227
v_cvt_pk_bf16_f32 v226, v232, v233
v_cvt_pk_bf16_f32 v227, v234, v235
buffer_load_dwordx4 v114, s[36:39], s81 offen offset:2048 lds
v_lshlrev_b32 v64, 16, v60
v_and_b32 v65, s23, v60
v_lshlrev_b32 v66, 16, v61
v_and_b32 v67, s23, v61
v_lshlrev_b32 v68, 16, v62
v_and_b32 v69, s23, v62
v_lshlrev_b32 v70, 16, v63
v_and_b32 v71, s23, v63
v_pk_fma_f32 v[240:241], v[64:65], v[8:9], v[240:241]
v_pk_fma_f32 v[242:243], v[66:67], v[8:9], v[242:243]
v_pk_fma_f32 v[248:249], v[68:69], v[8:9], v[248:249]
v_pk_fma_f32 v[250:251], v[70:71], v[8:9], v[250:251]
v_cvt_pk_bf16_f32 v240, v240, v241
v_cvt_pk_bf16_f32 v241, v242, v243
v_cvt_pk_bf16_f32 v242, v248, v249
v_cvt_pk_bf16_f32 v243, v250, v251
buffer_load_dwordx4 v115, s[36:39], s81 offen offset:3072 lds
v_accvgpr_read_b32 v32, a32
v_accvgpr_read_b32 v33, a33
v_accvgpr_read_b32 v34, a34
v_accvgpr_read_b32 v35, a35
v_lshlrev_b32 v64, 16, v32
v_and_b32 v65, s23, v32
v_lshlrev_b32 v66, 16, v33
v_and_b32 v67, s23, v33
v_lshlrev_b32 v68, 16, v34
v_and_b32 v69, s23, v34
v_lshlrev_b32 v70, 16, v35
v_and_b32 v71, s23, v35
v_pk_fma_f32 v[132:133], v[64:65], v[10:11], v[132:133]
v_pk_fma_f32 v[134:135], v[66:67], v[10:11], v[134:135]
v_pk_fma_f32 v[140:141], v[68:69], v[10:11], v[140:141]
v_pk_fma_f32 v[142:143], v[70:71], v[10:11], v[142:143]
v_cvt_pk_bf16_f32 v132, v132, v133
v_cvt_pk_bf16_f32 v133, v134, v135
v_cvt_pk_bf16_f32 v134, v140, v141
v_cvt_pk_bf16_f32 v135, v142, v143
s_sub_u32 s81, s81, 28544
s_add_u32 m0, s18, 131072
s_nop 0
buffer_load_dwordx4 v112, s[36:39], s81 offen offset:0 lds
v_accvgpr_read_b32 v36, a36
v_accvgpr_read_b32 v37, a37
v_accvgpr_read_b32 v38, a38
v_accvgpr_read_b32 v39, a39
v_lshlrev_b32 v64, 16, v36
v_and_b32 v65, s23, v36
v_lshlrev_b32 v66, 16, v37
v_and_b32 v67, s23, v37
v_lshlrev_b32 v68, 16, v38
v_and_b32 v69, s23, v38
v_lshlrev_b32 v70, 16, v39
v_and_b32 v71, s23, v39
v_pk_fma_f32 v[148:149], v[64:65], v[10:11], v[148:149]
v_pk_fma_f32 v[150:151], v[66:67], v[10:11], v[150:151]
v_pk_fma_f32 v[156:157], v[68:69], v[10:11], v[156:157]
v_pk_fma_f32 v[158:159], v[70:71], v[10:11], v[158:159]
v_cvt_pk_bf16_f32 v148, v148, v149
v_cvt_pk_bf16_f32 v149, v150, v151
v_cvt_pk_bf16_f32 v150, v156, v157
v_cvt_pk_bf16_f32 v151, v158, v159
buffer_load_dwordx4 v113, s[36:39], s81 offen offset:1024 lds
v_accvgpr_read_b32 v40, a40
v_accvgpr_read_b32 v41, a41
v_accvgpr_read_b32 v42, a42
v_accvgpr_read_b32 v43, a43
v_lshlrev_b32 v64, 16, v40
v_and_b32 v65, s23, v40
v_lshlrev_b32 v66, 16, v41
v_and_b32 v67, s23, v41
v_lshlrev_b32 v68, 16, v42
v_and_b32 v69, s23, v42
v_lshlrev_b32 v70, 16, v43
v_and_b32 v71, s23, v43
v_pk_fma_f32 v[164:165], v[64:65], v[10:11], v[164:165]
v_pk_fma_f32 v[166:167], v[66:67], v[10:11], v[166:167]
v_pk_fma_f32 v[172:173], v[68:69], v[10:11], v[172:173]
v_pk_fma_f32 v[174:175], v[70:71], v[10:11], v[174:175]
v_cvt_pk_bf16_f32 v164, v164, v165
v_cvt_pk_bf16_f32 v165, v166, v167
v_cvt_pk_bf16_f32 v166, v172, v173
v_cvt_pk_bf16_f32 v167, v174, v175
buffer_load_dwordx4 v114, s[36:39], s81 offen offset:2048 lds
v_accvgpr_read_b32 v44, a44
v_accvgpr_read_b32 v45, a45
v_accvgpr_read_b32 v46, a46
v_accvgpr_read_b32 v47, a47
v_lshlrev_b32 v64, 16, v44
v_and_b32 v65, s23, v44
v_lshlrev_b32 v66, 16, v45
v_and_b32 v67, s23, v45
v_lshlrev_b32 v68, 16, v46
v_and_b32 v69, s23, v46
v_lshlrev_b32 v70, 16, v47
v_and_b32 v71, s23, v47
v_pk_fma_f32 v[180:181], v[64:65], v[10:11], v[180:181]
v_pk_fma_f32 v[182:183], v[66:67], v[10:11], v[182:183]
v_pk_fma_f32 v[188:189], v[68:69], v[10:11], v[188:189]
v_pk_fma_f32 v[190:191], v[70:71], v[10:11], v[190:191]
v_cvt_pk_bf16_f32 v180, v180, v181
v_cvt_pk_bf16_f32 v181, v182, v183
v_cvt_pk_bf16_f32 v182, v188, v189
v_cvt_pk_bf16_f32 v183, v190, v191
buffer_load_dwordx4 v115, s[36:39], s81 offen offset:3072 lds
v_accvgpr_read_b32 v48, a48
v_accvgpr_read_b32 v49, a49
v_accvgpr_read_b32 v50, a50
v_accvgpr_read_b32 v51, a51
v_lshlrev_b32 v64, 16, v48
v_and_b32 v65, s23, v48
v_lshlrev_b32 v66, 16, v49
v_and_b32 v67, s23, v49
v_lshlrev_b32 v68, 16, v50
v_and_b32 v69, s23, v50
v_lshlrev_b32 v70, 16, v51
v_and_b32 v71, s23, v51
v_pk_fma_f32 v[196:197], v[64:65], v[10:11], v[196:197]
v_pk_fma_f32 v[198:199], v[66:67], v[10:11], v[198:199]
v_pk_fma_f32 v[204:205], v[68:69], v[10:11], v[204:205]
v_pk_fma_f32 v[206:207], v[70:71], v[10:11], v[206:207]
v_cvt_pk_bf16_f32 v196, v196, v197
v_cvt_pk_bf16_f32 v197, v198, v199
v_cvt_pk_bf16_f32 v198, v204, v205
v_cvt_pk_bf16_f32 v199, v206, v207
s_add_u32 s81, s81, 28672
s_add_u32 m0, s18, 135168
s_nop 0
buffer_load_dwordx4 v112, s[36:39], s81 offen offset:0 lds
v_accvgpr_read_b32 v52, a52
v_accvgpr_read_b32 v53, a53
v_accvgpr_read_b32 v54, a54
v_accvgpr_read_b32 v55, a55
v_lshlrev_b32 v64, 16, v52
v_and_b32 v65, s23, v52
v_lshlrev_b32 v66, 16, v53
v_and_b32 v67, s23, v53
v_lshlrev_b32 v68, 16, v54
v_and_b32 v69, s23, v54
v_lshlrev_b32 v70, 16, v55
v_and_b32 v71, s23, v55
v_pk_fma_f32 v[212:213], v[64:65], v[10:11], v[212:213]
v_pk_fma_f32 v[214:215], v[66:67], v[10:11], v[214:215]
v_pk_fma_f32 v[220:221], v[68:69], v[10:11], v[220:221]
v_pk_fma_f32 v[222:223], v[70:71], v[10:11], v[222:223]
v_cvt_pk_bf16_f32 v212, v212, v213
v_cvt_pk_bf16_f32 v213, v214, v215
v_cvt_pk_bf16_f32 v214, v220, v221
v_cvt_pk_bf16_f32 v215, v222, v223
buffer_load_dwordx4 v113, s[36:39], s81 offen offset:1024 lds
v_accvgpr_read_b32 v56, a56
v_accvgpr_read_b32 v57, a57
v_accvgpr_read_b32 v58, a58
v_accvgpr_read_b32 v59, a59
v_lshlrev_b32 v64, 16, v56
v_and_b32 v65, s23, v56
v_lshlrev_b32 v66, 16, v57
v_and_b32 v67, s23, v57
v_lshlrev_b32 v68, 16, v58
v_and_b32 v69, s23, v58
v_lshlrev_b32 v70, 16, v59
v_and_b32 v71, s23, v59
v_pk_fma_f32 v[228:229], v[64:65], v[10:11], v[228:229]
v_pk_fma_f32 v[230:231], v[66:67], v[10:11], v[230:231]
v_pk_fma_f32 v[236:237], v[68:69], v[10:11], v[236:237]
v_pk_fma_f32 v[238:239], v[70:71], v[10:11], v[238:239]
v_cvt_pk_bf16_f32 v228, v228, v229
v_cvt_pk_bf16_f32 v229, v230, v231
v_cvt_pk_bf16_f32 v230, v236, v237
v_cvt_pk_bf16_f32 v231, v238, v239
buffer_load_dwordx4 v114, s[36:39], s81 offen offset:2048 lds
v_accvgpr_read_b32 v60, a60
v_accvgpr_read_b32 v61, a61
v_accvgpr_read_b32 v62, a62
v_accvgpr_read_b32 v63, a63
v_lshlrev_b32 v64, 16, v60
v_and_b32 v65, s23, v60
v_lshlrev_b32 v66, 16, v61
v_and_b32 v67, s23, v61
v_lshlrev_b32 v68, 16, v62
v_and_b32 v69, s23, v62
v_lshlrev_b32 v70, 16, v63
v_and_b32 v71, s23, v63
v_pk_fma_f32 v[244:245], v[64:65], v[10:11], v[244:245]
v_pk_fma_f32 v[246:247], v[66:67], v[10:11], v[246:247]
v_pk_fma_f32 v[252:253], v[68:69], v[10:11], v[252:253]
v_pk_fma_f32 v[254:255], v[70:71], v[10:11], v[254:255]
v_cvt_pk_bf16_f32 v244, v244, v245
v_cvt_pk_bf16_f32 v245, v246, v247
v_cvt_pk_bf16_f32 v246, v252, v253
v_cvt_pk_bf16_f32 v247, v254, v255
buffer_load_dwordx4 v115, s[36:39], s81 offen offset:3072 lds
s_sub_u32 s81, s81, 28544
K2_done:
PAD_13:
s_cbranch_execz PAD_17
s_waitcnt vmcnt(16)
s_barrier
ds_read_b64_tr_b16 a[64:65], v116 offset:0
ds_read_b64_tr_b16 a[66:67], v116 offset:2048
ds_read_b64_tr_b16 a[68:69], v116 offset:4096
ds_read_b64_tr_b16 a[70:71], v116 offset:6144
ds_read_b64_tr_b16 a[72:73], v116 offset:8192
ds_read_b64_tr_b16 a[74:75], v116 offset:10240
ds_read_b64_tr_b16 a[76:77], v116 offset:12288
ds_read_b64_tr_b16 a[78:79], v116 offset:14336
ds_read_b64_tr_b16 a[80:81], v116 offset:16384
ds_read_b64_tr_b16 a[82:83], v116 offset:18432
ds_read_b64_tr_b16 a[84:85], v116 offset:20480
ds_read_b64_tr_b16 a[86:87], v116 offset:22528
ds_read_b64_tr_b16 a[88:89], v116 offset:24576
ds_read_b64_tr_b16 a[90:91], v116 offset:26624
ds_read_b64_tr_b16 a[92:93], v116 offset:28672
ds_read_b64_tr_b16 a[94:95], v116 offset:30720
v_add_u32 v116, 65536, v116
s_waitcnt lgkmcnt(14)
v_mfma_f32_16x16x32_bf16 v[32:35], a[64:67], v[128:131], 0
s_waitcnt lgkmcnt(12)
s_add_u32 m0, s18, 65536
ds_read_b64_tr_b16 a[96:97], v117 offset:0
v_mov_b32 v28, v24
v_mfma_f32_16x16x32_bf16 v[32:35], a[68:71], v[144:147], v[32:35]
s_waitcnt lgkmcnt(11)
buffer_load_dwordx4 v112, s[36:39], s81 offen offset:0 lds
ds_read_b64_tr_b16 a[98:99], v117 offset:2048
v_mfma_f32_16x16x32_bf16 v[32:35], a[72:75], v[160:163], v[32:35]
s_waitcnt lgkmcnt(10)
ds_read_b64_tr_b16 a[100:101], v117 offset:4096
v_permlane16_swap_b32 v24, v28
v_mfma_f32_16x16x32_bf16 v[32:35], a[76:79], v[176:179], v[32:35]
s_waitcnt lgkmcnt(9)
ds_read_b64_tr_b16 a[102:103], v117 offset:6144
v_add_f32 v24, v24, v28
v_mfma_f32_16x16x32_bf16 v[32:35], a[80:83], v[192:195], v[32:35]
s_waitcnt lgkmcnt(8)
buffer_load_dwordx4 v113, s[36:39], s81 offen offset:1024 lds
ds_read_b64_tr_b16 a[104:105], v117 offset:8192
v_mfma_f32_16x16x32_bf16 v[32:35], a[84:87], v[208:211], v[32:35]
s_waitcnt lgkmcnt(7)
ds_read_b64_tr_b16 a[106:107], v117 offset:10240
v_mov_b32 v28, v24
v_mfma_f32_16x16x32_bf16 v[32:35], a[88:91], v[224:227], v[32:35]
s_waitcnt lgkmcnt(6)
ds_read_b64_tr_b16 a[108:109], v117 offset:12288
v_lshrrev_b32 v20, 4, v1
v_mfma_f32_16x16x32_bf16 v[32:35], a[92:95], v[240:243], v[32:35]
buffer_load_dwordx4 v114, s[36:39], s81 offen offset:2048 lds
ds_read_b64_tr_b16 a[110:111], v117 offset:14336
v_mfma_f32_16x16x32_bf16 v[36:39], a[64:67], v[132:135], 0
PAD_14:
s_cbranch_execz PAD_18
ds_read_b64_tr_b16 a[112:113], v117 offset:16384
v_permlane32_swap_b32 v24, v28
v_mfma_f32_16x16x32_bf16 v[36:39], a[68:71], v[148:151], v[36:39]
ds_read_b64_tr_b16 a[114:115], v117 offset:18432
v_add_f32 v24, v24, v28
v_mfma_f32_16x16x32_bf16 v[36:39], a[72:75], v[164:167], v[36:39]
buffer_load_dwordx4 v115, s[36:39], s81 offen offset:3072 lds
ds_read_b64_tr_b16 a[116:117], v117 offset:20480
v_mfma_f32_16x16x32_bf16 v[36:39], a[76:79], v[180:183], v[36:39]
ds_read_b64_tr_b16 a[118:119], v117 offset:22528
v_mov_b32 v29, v25
v_mfma_f32_16x16x32_bf16 v[36:39], a[80:83], v[196:199], v[36:39]
s_add_u32 s81, s81, 28672
s_add_u32 m0, s18, 69632
ds_read_b64_tr_b16 a[120:121], v117 offset:24576
v_mfma_f32_16x16x32_bf16 v[36:39], a[84:87], v[212:215], v[36:39]
buffer_load_dwordx4 v112, s[36:39], s81 offen offset:0 lds
ds_read_b64_tr_b16 a[122:123], v117 offset:26624
v_mfma_f32_16x16x32_bf16 v[36:39], a[88:91], v[228:231], v[36:39]
ds_read_b64_tr_b16 a[124:125], v117 offset:28672
v_permlane16_swap_b32 v25, v29
v_mfma_f32_16x16x32_bf16 v[36:39], a[92:95], v[244:247], v[36:39]
s_waitcnt lgkmcnt(8)
ds_read_b64_tr_b16 a[126:127], v117 offset:30720
v_add_u32 v117, 65536, v117
v_mfma_f32_16x16x32_bf16 v[40:43], a[96:99], v[128:131], 0
buffer_load_dwordx4 v113, s[36:39], s81 offen offset:1024 lds
ds_read_b64_tr_b16 a[64:65], v118 offset:0
v_mfma_f32_16x16x32_bf16 v[40:43], a[100:103], v[144:147], v[40:43]
ds_read_b64_tr_b16 a[66:67], v118 offset:2048
v_add_f32 v25, v25, v29
v_mfma_f32_16x16x32_bf16 v[40:43], a[104:107], v[160:163], v[40:43]
s_waitcnt lgkmcnt(8)
ds_read_b64_tr_b16 a[68:69], v118 offset:4096
v_mov_b32 v29, v25
v_mfma_f32_16x16x32_bf16 v[40:43], a[108:111], v[176:179], v[40:43]
buffer_load_dwordx4 v114, s[36:39], s81 offen offset:2048 lds
ds_read_b64_tr_b16 a[70:71], v118 offset:6144
v_mfma_f32_16x16x32_bf16 v[40:43], a[112:115], v[192:195], v[40:43]
s_waitcnt lgkmcnt(8)
ds_read_b64_tr_b16 a[72:73], v118 offset:8192
v_permlane32_swap_b32 v25, v29
v_mfma_f32_16x16x32_bf16 v[40:43], a[116:119], v[208:211], v[40:43]
s_waitcnt lgkmcnt(7)
ds_read_b64_tr_b16 a[74:75], v118 offset:10240
v_add_f32 v25, v25, v29
v_mfma_f32_16x16x32_bf16 v[40:43], a[120:123], v[224:227], v[40:43]
s_waitcnt lgkmcnt(6)
buffer_load_dwordx4 v115, s[36:39], s81 offen offset:3072 lds
ds_read_b64_tr_b16 a[76:77], v118 offset:12288
v_mfma_f32_16x16x32_bf16 v[40:43], a[124:127], v[240:243], v[40:43]
ds_read_b64_tr_b16 a[78:79], v118 offset:14336
v_rcp_f32 v24, v24
v_mfma_f32_16x16x32_bf16 v[44:47], a[96:99], v[132:135], 0
s_sub_u32 s81, s81, 28544
s_add_u32 m0, s18, 0
ds_read_b64_tr_b16 a[80:81], v118 offset:16384
v_mfma_f32_16x16x32_bf16 v[44:47], a[100:103], v[148:151], v[44:47]
buffer_load_dwordx4 v112, s[36:39], s81 offen offset:0 lds
ds_read_b64_tr_b16 a[82:83], v118 offset:18432
v_mfma_f32_16x16x32_bf16 v[44:47], a[104:107], v[164:167], v[44:47]
ds_read_b64_tr_b16 a[84:85], v118 offset:20480
v_rcp_f32 v25, v25
v_mfma_f32_16x16x32_bf16 v[44:47], a[108:111], v[180:183], v[44:47]
ds_read_b64_tr_b16 a[86:87], v118 offset:22528
v_and_b32 v19, 15, v20
v_mfma_f32_16x16x32_bf16 v[44:47], a[112:115], v[196:199], v[44:47]
buffer_load_dwordx4 v113, s[36:39], s81 offen offset:1024 lds
ds_read_b64_tr_b16 a[88:89], v118 offset:24576
v_mfma_f32_16x16x32_bf16 v[44:47], a[116:119], v[212:215], v[44:47]
ds_read_b64_tr_b16 a[90:91], v118 offset:26624
v_mul_f32 v32, v32, v24
v_mfma_f32_16x16x32_bf16 v[44:47], a[120:123], v[228:231], v[44:47]
ds_read_b64_tr_b16 a[92:93], v118 offset:28672
v_mul_f32 v33, v33, v24
v_mfma_f32_16x16x32_bf16 v[44:47], a[124:127], v[244:247], v[44:47]
s_waitcnt lgkmcnt(8)
ds_read_b64_tr_b16 a[94:95], v118 offset:30720
v_add_u32 v118, 65536, v118
v_mfma_f32_16x16x32_bf16 v[48:51], a[64:67], v[128:131], 0
buffer_load_dwordx4 v114, s[36:39], s81 offen offset:2048 lds
ds_read_b64_tr_b16 a[96:97], v119 offset:0
v_mfma_f32_16x16x32_bf16 v[48:51], a[68:71], v[144:147], v[48:51]
ds_read_b64_tr_b16 a[98:99], v119 offset:2048
v_mul_f32 v34, v34, v24
v_mfma_f32_16x16x32_bf16 v[48:51], a[72:75], v[160:163], v[48:51]
s_waitcnt lgkmcnt(8)
ds_read_b64_tr_b16 a[100:101], v119 offset:4096
v_mul_f32 v35, v35, v24
v_mfma_f32_16x16x32_bf16 v[48:51], a[76:79], v[176:179], v[48:51]
buffer_load_dwordx4 v115, s[36:39], s81 offen offset:3072 lds
ds_read_b64_tr_b16 a[102:103], v119 offset:6144
v_mfma_f32_16x16x32_bf16 v[48:51], a[80:83], v[192:195], v[48:51]
s_waitcnt lgkmcnt(6)
ds_read_b64_tr_b16 a[104:105], v119 offset:8192
v_mul_f32 v40, v40, v24
v_mfma_f32_16x16x32_bf16 v[48:51], a[84:87], v[208:211], v[48:51]
s_add_u32 s81, s81, 28672
s_add_u32 m0, s18, 4096
ds_read_b64_tr_b16 a[106:107], v119 offset:10240
v_mfma_f32_16x16x32_bf16 v[48:51], a[88:91], v[224:227], v[48:51]
s_waitcnt lgkmcnt(6)
buffer_load_dwordx4 v112, s[36:39], s81 offen offset:0 lds
ds_read_b64_tr_b16 a[108:109], v119 offset:12288
v_mfma_f32_16x16x32_bf16 v[48:51], a[92:95], v[240:243], v[48:51]
ds_read_b64_tr_b16 a[110:111], v119 offset:14336
v_mul_f32 v41, v41, v24
v_mfma_f32_16x16x32_bf16 v[52:55], a[64:67], v[132:135], 0
ds_read_b64_tr_b16 a[112:113], v119 offset:16384
v_mul_f32 v42, v42, v24
v_mfma_f32_16x16x32_bf16 v[52:55], a[68:71], v[148:151], v[52:55]
buffer_load_dwordx4 v113, s[36:39], s81 offen offset:1024 lds
ds_read_b64_tr_b16 a[114:115], v119 offset:18432
v_mfma_f32_16x16x32_bf16 v[52:55], a[72:75], v[164:167], v[52:55]
ds_read_b64_tr_b16 a[116:117], v119 offset:20480
v_mul_f32 v43, v43, v24
v_mfma_f32_16x16x32_bf16 v[52:55], a[76:79], v[180:183], v[52:55]
ds_read_b64_tr_b16 a[118:119], v119 offset:22528
v_cvt_pk_bf16_f32 v32, v32, v33
v_mfma_f32_16x16x32_bf16 v[52:55], a[80:83], v[196:199], v[52:55]
buffer_load_dwordx4 v114, s[36:39], s81 offen offset:2048 lds
ds_read_b64_tr_b16 a[120:121], v119 offset:24576
v_mfma_f32_16x16x32_bf16 v[52:55], a[84:87], v[212:215], v[52:55]
ds_read_b64_tr_b16 a[122:123], v119 offset:26624
v_cvt_pk_bf16_f32 v33, v34, v35
v_mfma_f32_16x16x32_bf16 v[52:55], a[88:91], v[228:231], v[52:55]
ds_read_b64_tr_b16 a[124:125], v119 offset:28672
ds_read_b64_tr_b16 a[126:127], v119 offset:30720
v_mfma_f32_16x16x32_bf16 v[52:55], a[92:95], v[244:247], v[52:55]
s_waitcnt vmcnt(23) lgkmcnt(9)
s_barrier
v_add_u32 v119, 65536, v119
v_mfma_f32_16x16x32_bf16 v[56:59], a[96:99], v[128:131], 0
buffer_load_dwordx4 v115, s[36:39], s81 offen offset:3072 lds
ds_read_b64_tr_b16 a[64:65], v116 offset:0
v_mfma_f32_16x16x32_bf16 v[56:59], a[100:103], v[144:147], v[56:59]
s_waitcnt lgkmcnt(8)
ds_read_b64_tr_b16 a[66:67], v116 offset:2048
v_cvt_pk_bf16_f32 v34, v40, v41
v_mfma_f32_16x16x32_bf16 v[56:59], a[104:107], v[160:163], v[56:59]
s_sub_u32 s81, s81, 28544
ds_read_b64_tr_b16 a[68:69], v116 offset:4096
v_cvt_pk_bf16_f32 v35, v42, v43
v_mfma_f32_16x16x32_bf16 v[56:59], a[108:111], v[176:179], v[56:59]
s_waitcnt lgkmcnt(8)
buffer_store_dwordx4 v[32:35], v1, s[4:7], s8 offen offset:0 sc1
ds_read_b64_tr_b16 a[70:71], v116 offset:6144
v_mfma_f32_16x16x32_bf16 v[56:59], a[112:115], v[192:195], v[56:59]
s_waitcnt lgkmcnt(8)
ds_read_b64_tr_b16 a[72:73], v116 offset:8192
v_mul_f32 v36, v36, v25
v_mfma_f32_16x16x32_bf16 v[56:59], a[116:119], v[208:211], v[56:59]
s_waitcnt lgkmcnt(7)
ds_read_b64_tr_b16 a[74:75], v116 offset:10240
v_mul_f32 v37, v37, v25
v_mfma_f32_16x16x32_bf16 v[56:59], a[120:123], v[224:227], v[56:59]
s_waitcnt lgkmcnt(6)
ds_read_b64_tr_b16 a[76:77], v116 offset:12288
v_mul_f32 v38, v38, v25
v_mfma_f32_16x16x32_bf16 v[56:59], a[124:127], v[240:243], v[56:59]
ds_read_b64_tr_b16 a[78:79], v116 offset:14336
v_mul_f32 v39, v39, v25
v_mfma_f32_16x16x32_bf16 v[60:63], a[96:99], v[132:135], 0
ds_read_b64_tr_b16 a[80:81], v116 offset:16384
v_mul_f32 v44, v44, v25
v_mfma_f32_16x16x32_bf16 v[60:63], a[100:103], v[148:151], v[60:63]
ds_read_b64_tr_b16 a[82:83], v116 offset:18432
v_mul_f32 v45, v45, v25
v_mfma_f32_16x16x32_bf16 v[60:63], a[104:107], v[164:167], v[60:63]
ds_read_b64_tr_b16 a[84:85], v116 offset:20480
v_mul_f32 v46, v46, v25
v_mfma_f32_16x16x32_bf16 v[60:63], a[108:111], v[180:183], v[60:63]
ds_read_b64_tr_b16 a[86:87], v116 offset:22528
v_mul_f32 v47, v47, v25
v_mfma_f32_16x16x32_bf16 v[60:63], a[112:115], v[196:199], v[60:63]
ds_read_b64_tr_b16 a[88:89], v116 offset:24576
v_cvt_pk_bf16_f32 v36, v36, v37
v_mfma_f32_16x16x32_bf16 v[60:63], a[116:119], v[212:215], v[60:63]
ds_read_b64_tr_b16 a[90:91], v116 offset:26624
v_cvt_pk_bf16_f32 v37, v38, v39
v_mfma_f32_16x16x32_bf16 v[60:63], a[120:123], v[228:231], v[60:63]
ds_read_b64_tr_b16 a[92:93], v116 offset:28672
v_cvt_pk_bf16_f32 v38, v44, v45
v_mfma_f32_16x16x32_bf16 v[60:63], a[124:127], v[244:247], v[60:63]
s_waitcnt lgkmcnt(3)
ds_read_b64_tr_b16 a[94:95], v116 offset:30720
v_add_u32 v116, 32768, v116
v_mfma_f32_16x16x32_bf16 v[64:67], a[64:67], v[128:131], 0
s_lshl_b32 s34, s29, 5
ds_read_b64_tr_b16 a[96:97], v117 offset:0
v_cvt_pk_bf16_f32 v39, v46, v47
v_mfma_f32_16x16x32_bf16 v[64:67], a[68:71], v[144:147], v[64:67]
s_add_u32 s34, s34, s20
buffer_store_dwordx4 v[36:39], v1, s[4:7], s12 offen offset:0 sc1
ds_read_b64_tr_b16 a[98:99], v117 offset:2048
v_mfma_f32_16x16x32_bf16 v[64:67], a[72:75], v[160:163], v[64:67]
s_lshl_b32 s34, s34, 2
ds_read_b64_tr_b16 a[100:101], v117 offset:4096
v_mul_f32 v48, v48, v24
v_mfma_f32_16x16x32_bf16 v[64:67], a[76:79], v[176:179], v[64:67]
s_add_u32 s34, s34, 94380032
ds_read_b64_tr_b16 a[102:103], v117 offset:6144
v_mul_f32 v49, v49, v24
v_mfma_f32_16x16x32_bf16 v[64:67], a[80:83], v[192:195], v[64:67]
s_add_u32 s35, s34, 2048
ds_read_b64_tr_b16 a[104:105], v117 offset:8192
v_mul_f32 v50, v50, v24
v_mfma_f32_16x16x32_bf16 v[64:67], a[84:87], v[208:211], v[64:67]
s_waitcnt lgkmcnt(5)
s_mov_b32 s80, s21
ds_read_b64_tr_b16 a[106:107], v117 offset:10240
v_mul_f32 v51, v51, v24
v_mfma_f32_16x16x32_bf16 v[64:67], a[88:91], v[224:227], v[64:67]
s_and_b32 s79, s2, 16
ds_read_b64_tr_b16 a[108:109], v117 offset:12288
v_mul_f32 v56, v56, v24
v_mfma_f32_16x16x32_bf16 v[64:67], a[92:95], v[240:243], v[64:67]
s_xor_b32 s79, s79, 16
ds_read_b64_tr_b16 a[110:111], v117 offset:14336
v_mul_f32 v57, v57, v24
v_mfma_f32_16x16x32_bf16 v[68:71], a[64:67], v[132:135], 0
s_add_u32 s79, s79, s20
ds_read_b64_tr_b16 a[112:113], v117 offset:16384
v_mul_f32 v58, v58, v24
v_mfma_f32_16x16x32_bf16 v[68:71], a[68:71], v[148:151], v[68:71]
s_lshl_b32 s22, s79, 2
ds_read_b64_tr_b16 a[114:115], v117 offset:18432
v_mul_f32 v59, v59, v24
v_mfma_f32_16x16x32_bf16 v[68:71], a[72:75], v[164:167], v[68:71]
s_add_u32 s22, s22, s3
ds_read_b64_tr_b16 a[116:117], v117 offset:20480
v_cvt_pk_bf16_f32 v48, v48, v49
v_mfma_f32_16x16x32_bf16 v[68:71], a[76:79], v[180:183], v[68:71]
s_mul_i32 s25, s22, 28672
ds_read_b64_tr_b16 a[118:119], v117 offset:22528
v_cvt_pk_bf16_f32 v49, v50, v51
v_mfma_f32_16x16x32_bf16 v[68:71], a[80:83], v[196:199], v[68:71]
s_lshl_b32 s23, s80, 6
ds_read_b64_tr_b16 a[120:121], v117 offset:24576
v_cvt_pk_bf16_f32 v50, v56, v57
v_mfma_f32_16x16x32_bf16 v[68:71], a[84:87], v[212:215], v[68:71]
s_add_u32 s25, s25, s23
ds_read_b64_tr_b16 a[122:123], v117 offset:26624
v_cvt_pk_bf16_f32 v51, v58, v59
v_mfma_f32_16x16x32_bf16 v[68:71], a[88:91], v[228:231], v[68:71]
s_mul_i32 s26, s22, 229376
buffer_store_dwordx4 v[48:51], v1, s[4:7], s8 offen offset:1024 sc1
ds_read_b64_tr_b16 a[124:125], v117 offset:28672
v_mfma_f32_16x16x32_bf16 v[68:71], a[92:95], v[244:247], v[68:71]
s_waitcnt lgkmcnt(3)
s_lshl_b32 s23, s80, 10
ds_read_b64_tr_b16 a[126:127], v117 offset:30720
v_add_u32 v117, 32768, v117
v_mfma_f32_16x16x32_bf16 v[72:75], a[96:99], v[128:131], 0
s_add_u32 s26, s26, s23
ds_read_b64_tr_b16 a[64:65], v118 offset:0
v_mul_f32 v52, v52, v25
v_mfma_f32_16x16x32_bf16 v[72:75], a[100:103], v[144:147], v[72:75]
s_add_u32 s26, s26, 104857600
ds_read_b64_tr_b16 a[66:67], v118 offset:2048
v_mul_f32 v53, v53, v25
v_mfma_f32_16x16x32_bf16 v[72:75], a[104:107], v[160:163], v[72:75]
s_lshr_b32 s22, s79, 1
ds_read_b64_tr_b16 a[68:69], v118 offset:4096
v_mul_f32 v54, v54, v25
v_mfma_f32_16x16x32_bf16 v[72:75], a[108:111], v[176:179], v[72:75]
s_lshl_b32 s22, s22, 7
ds_read_b64_tr_b16 a[70:71], v118 offset:6144
v_mul_f32 v55, v55, v25
v_mfma_f32_16x16x32_bf16 v[72:75], a[112:115], v[192:195], v[72:75]
s_add_u32 s33, s22, 94380032
ds_read_b64_tr_b16 a[72:73], v118 offset:8192
v_mul_f32 v60, v60, v25
v_mfma_f32_16x16x32_bf16 v[72:75], a[116:119], v[208:211], v[72:75]
s_waitcnt lgkmcnt(5)
s_mov_b64 s[40:41], s[88:89]
ds_read_b64_tr_b16 a[74:75], v118 offset:10240
v_mul_f32 v61, v61, v25
v_mfma_f32_16x16x32_bf16 v[72:75], a[120:123], v[224:227], v[72:75]
s_mov_b32 s42, 3670016
ds_read_b64_tr_b16 a[76:77], v118 offset:12288
v_mul_f32 v62, v62, v25
v_mfma_f32_16x16x32_bf16 v[72:75], a[124:127], v[240:243], v[72:75]
s_mov_b32 s43, 0x20000
ds_read_b64_tr_b16 a[78:79], v118 offset:14336
v_mul_f32 v63, v63, v25
v_mfma_f32_16x16x32_bf16 v[76:79], a[96:99], v[132:135], 0
ds_read_b64_tr_b16 a[80:81], v118 offset:16384
v_cvt_pk_bf16_f32 v52, v52, v53
v_mfma_f32_16x16x32_bf16 v[76:79], a[100:103], v[148:151], v[76:79]
ds_read_b64_tr_b16 a[82:83], v118 offset:18432
v_cvt_pk_bf16_f32 v53, v54, v55
v_mfma_f32_16x16x32_bf16 v[76:79], a[104:107], v[164:167], v[76:79]
ds_read_b64_tr_b16 a[84:85], v118 offset:20480
v_cvt_pk_bf16_f32 v54, v60, v61
v_mfma_f32_16x16x32_bf16 v[76:79], a[108:111], v[180:183], v[76:79]
ds_read_b64_tr_b16 a[86:87], v118 offset:22528
v_cvt_pk_bf16_f32 v55, v62, v63
v_mfma_f32_16x16x32_bf16 v[76:79], a[112:115], v[196:199], v[76:79]
buffer_store_dwordx4 v[52:55], v1, s[4:7], s12 offen offset:1024 sc1
ds_read_b64_tr_b16 a[88:89], v118 offset:24576
v_mfma_f32_16x16x32_bf16 v[76:79], a[116:119], v[212:215], v[76:79]
ds_read_b64_tr_b16 a[90:91], v118 offset:26624
v_mfma_f32_16x16x32_bf16 v[76:79], a[120:123], v[228:231], v[76:79]
ds_read_b64_tr_b16 a[92:93], v118 offset:28672
v_mul_f32 v64, v64, v24
v_mfma_f32_16x16x32_bf16 v[76:79], a[124:127], v[244:247], v[76:79]
s_waitcnt lgkmcnt(8)
ds_read_b64_tr_b16 a[94:95], v118 offset:30720
v_add_u32 v118, 32768, v118
v_mfma_f32_16x16x32_bf16 v[80:83], a[64:67], v[128:131], 0
ds_read_b64_tr_b16 a[96:97], v119 offset:0
v_mul_f32 v65, v65, v24
v_mfma_f32_16x16x32_bf16 v[80:83], a[68:71], v[144:147], v[80:83]
ds_read_b64_tr_b16 a[98:99], v119 offset:2048
v_mul_f32 v66, v66, v24
v_mfma_f32_16x16x32_bf16 v[80:83], a[72:75], v[160:163], v[80:83]
s_waitcnt lgkmcnt(8)
ds_read_b64_tr_b16 a[100:101], v119 offset:4096
v_mul_f32 v67, v67, v24
v_mfma_f32_16x16x32_bf16 v[80:83], a[76:79], v[176:179], v[80:83]
ds_read_b64_tr_b16 a[102:103], v119 offset:6144
v_mul_f32 v72, v72, v24
v_mfma_f32_16x16x32_bf16 v[80:83], a[80:83], v[192:195], v[80:83]
s_waitcnt lgkmcnt(8)
ds_read_b64_tr_b16 a[104:105], v119 offset:8192
v_mul_f32 v73, v73, v24
v_mfma_f32_16x16x32_bf16 v[80:83], a[84:87], v[208:211], v[80:83]
s_waitcnt lgkmcnt(7)
ds_read_b64_tr_b16 a[106:107], v119 offset:10240
v_mul_f32 v74, v74, v24
v_mfma_f32_16x16x32_bf16 v[80:83], a[88:91], v[224:227], v[80:83]
s_waitcnt lgkmcnt(6)
ds_read_b64_tr_b16 a[108:109], v119 offset:12288
v_mul_f32 v75, v75, v24
v_mfma_f32_16x16x32_bf16 v[80:83], a[92:95], v[240:243], v[80:83]
ds_read_b64_tr_b16 a[110:111], v119 offset:14336
v_cvt_pk_bf16_f32 v64, v64, v65
v_mfma_f32_16x16x32_bf16 v[84:87], a[64:67], v[132:135], 0
ds_read_b64_tr_b16 a[112:113], v119 offset:16384
v_cvt_pk_bf16_f32 v65, v66, v67
v_mfma_f32_16x16x32_bf16 v[84:87], a[68:71], v[148:151], v[84:87]
ds_read_b64_tr_b16 a[114:115], v119 offset:18432
v_cvt_pk_bf16_f32 v66, v72, v73
v_mfma_f32_16x16x32_bf16 v[84:87], a[72:75], v[164:167], v[84:87]
ds_read_b64_tr_b16 a[116:117], v119 offset:20480
v_cvt_pk_bf16_f32 v67, v74, v75
v_mfma_f32_16x16x32_bf16 v[84:87], a[76:79], v[180:183], v[84:87]
buffer_store_dwordx4 v[64:67], v1, s[4:7], s8 offen offset:2048 sc1
ds_read_b64_tr_b16 a[118:119], v119 offset:22528
v_mfma_f32_16x16x32_bf16 v[84:87], a[80:83], v[196:199], v[84:87]
ds_read_b64_tr_b16 a[120:121], v119 offset:24576
v_mul_f32 v68, v68, v25
v_mfma_f32_16x16x32_bf16 v[84:87], a[84:87], v[212:215], v[84:87]
ds_read_b64_tr_b16 a[122:123], v119 offset:26624
v_mul_f32 v69, v69, v25
v_mfma_f32_16x16x32_bf16 v[84:87], a[88:91], v[228:231], v[84:87]
ds_read_b64_tr_b16 a[124:125], v119 offset:28672
ds_read_b64_tr_b16 a[126:127], v119 offset:30720
v_mfma_f32_16x16x32_bf16 v[84:87], a[92:95], v[244:247], v[84:87]
s_waitcnt vmcnt(21) lgkmcnt(9)
s_barrier
v_add_u32 v119, 32768, v119
v_mfma_f32_16x16x32_bf16 v[88:91], a[96:99], v[128:131], 0
ds_read_b64_tr_b16 a[64:65], v116 offset:0
v_mul_f32 v70, v70, v25
v_mfma_f32_16x16x32_bf16 v[88:91], a[100:103], v[144:147], v[88:91]
ds_read_b64_tr_b16 a[66:67], v116 offset:2048
v_mul_f32 v71, v71, v25
v_mfma_f32_16x16x32_bf16 v[88:91], a[104:107], v[160:163], v[88:91]
s_waitcnt lgkmcnt(8)
ds_read_b64_tr_b16 a[68:69], v116 offset:4096
v_mul_f32 v76, v76, v25
v_mfma_f32_16x16x32_bf16 v[88:91], a[108:111], v[176:179], v[88:91]
ds_read_b64_tr_b16 a[70:71], v116 offset:6144
v_mul_f32 v77, v77, v25
v_mfma_f32_16x16x32_bf16 v[88:91], a[112:115], v[192:195], v[88:91]
s_waitcnt lgkmcnt(8)
ds_read_b64_tr_b16 a[72:73], v116 offset:8192
v_mul_f32 v78, v78, v25
v_mfma_f32_16x16x32_bf16 v[88:91], a[116:119], v[208:211], v[88:91]
s_waitcnt lgkmcnt(7)
ds_read_b64_tr_b16 a[74:75], v116 offset:10240
v_mul_f32 v79, v79, v25
v_mfma_f32_16x16x32_bf16 v[88:91], a[120:123], v[224:227], v[88:91]
s_waitcnt lgkmcnt(6)
ds_read_b64_tr_b16 a[76:77], v116 offset:12288
v_cvt_pk_bf16_f32 v68, v68, v69
v_mfma_f32_16x16x32_bf16 v[88:91], a[124:127], v[240:243], v[88:91]
ds_read_b64_tr_b16 a[78:79], v116 offset:14336
v_cvt_pk_bf16_f32 v69, v70, v71
v_mfma_f32_16x16x32_bf16 v[92:95], a[96:99], v[132:135], 0
ds_read_b64_tr_b16 a[80:81], v116 offset:16384
v_cvt_pk_bf16_f32 v70, v76, v77
v_mfma_f32_16x16x32_bf16 v[92:95], a[100:103], v[148:151], v[92:95]
ds_read_b64_tr_b16 a[82:83], v116 offset:18432
v_cvt_pk_bf16_f32 v71, v78, v79
v_mfma_f32_16x16x32_bf16 v[92:95], a[104:107], v[164:167], v[92:95]
buffer_store_dwordx4 v[68:71], v1, s[4:7], s12 offen offset:2048 sc1
ds_read_b64_tr_b16 a[84:85], v116 offset:20480
v_mfma_f32_16x16x32_bf16 v[92:95], a[108:111], v[180:183], v[92:95]
ds_read_b64_tr_b16 a[86:87], v116 offset:22528
v_mfma_f32_16x16x32_bf16 v[92:95], a[112:115], v[196:199], v[92:95]
ds_read_b64_tr_b16 a[88:89], v116 offset:24576
v_mfma_f32_16x16x32_bf16 v[92:95], a[116:119], v[212:215], v[92:95]
ds_read_b64_tr_b16 a[90:91], v116 offset:26624
v_mfma_f32_16x16x32_bf16 v[92:95], a[120:123], v[228:231], v[92:95]
ds_read_b64_tr_b16 a[92:93], v116 offset:28672
v_mfma_f32_16x16x32_bf16 v[92:95], a[124:127], v[244:247], v[92:95]
s_waitcnt lgkmcnt(8)
ds_read_b64_tr_b16 a[94:95], v116 offset:30720
v_add_u32 v116, 4294901760, v116
v_mfma_f32_16x16x32_bf16 v[32:35], a[64:67], v[128:131], 0
s_add_u32 m0, s18, 32768
ds_read_b64_tr_b16 a[96:97], v117 offset:0
v_mul_f32 v80, v80, v24
v_mfma_f32_16x16x32_bf16 v[32:35], a[68:71], v[144:147], v[32:35]
buffer_load_dwordx4 v112, s[36:39], s81 offen offset:0 lds
ds_read_b64_tr_b16 a[98:99], v117 offset:2048
v_mfma_f32_16x16x32_bf16 v[32:35], a[72:75], v[160:163], v[32:35]
s_waitcnt lgkmcnt(8)
ds_read_b64_tr_b16 a[100:101], v117 offset:4096
v_mul_f32 v81, v81, v24
v_mfma_f32_16x16x32_bf16 v[32:35], a[76:79], v[176:179], v[32:35]
ds_read_b64_tr_b16 a[102:103], v117 offset:6144
v_mul_f32 v82, v82, v24
v_mfma_f32_16x16x32_bf16 v[32:35], a[80:83], v[192:195], v[32:35]
s_waitcnt lgkmcnt(8)
ds_read_b64_tr_b16 a[104:105], v117 offset:8192
v_mul_f32 v83, v83, v24
v_mfma_f32_16x16x32_bf16 v[32:35], a[84:87], v[208:211], v[32:35]
s_waitcnt lgkmcnt(7)
ds_read_b64_tr_b16 a[106:107], v117 offset:10240
v_mul_f32 v88, v88, v24
v_mfma_f32_16x16x32_bf16 v[32:35], a[88:91], v[224:227], v[32:35]
s_waitcnt lgkmcnt(6)
ds_read_b64_tr_b16 a[108:109], v117 offset:12288
v_mul_f32 v89, v89, v24
v_mfma_f32_16x16x32_bf16 v[32:35], a[92:95], v[240:243], v[32:35]
ds_read_b64_tr_b16 a[110:111], v117 offset:14336
v_mul_f32 v90, v90, v24
v_mfma_f32_16x16x32_bf16 v[36:39], a[64:67], v[132:135], 0
buffer_load_dwordx4 v113, s[36:39], s81 offen offset:1024 lds
ds_read_b64_tr_b16 a[112:113], v117 offset:16384
v_mfma_f32_16x16x32_bf16 v[36:39], a[68:71], v[148:151], v[36:39]
ds_read_b64_tr_b16 a[114:115], v117 offset:18432
v_mul_f32 v91, v91, v24
v_mfma_f32_16x16x32_bf16 v[36:39], a[72:75], v[164:167], v[36:39]
ds_read_b64_tr_b16 a[116:117], v117 offset:20480
v_cvt_pk_bf16_f32 v80, v80, v81
v_mfma_f32_16x16x32_bf16 v[36:39], a[76:79], v[180:183], v[36:39]
ds_read_b64_tr_b16 a[118:119], v117 offset:22528
v_cvt_pk_bf16_f32 v81, v82, v83
v_mfma_f32_16x16x32_bf16 v[36:39], a[80:83], v[196:199], v[36:39]
ds_read_b64_tr_b16 a[120:121], v117 offset:24576
v_cvt_pk_bf16_f32 v82, v88, v89
v_mfma_f32_16x16x32_bf16 v[36:39], a[84:87], v[212:215], v[36:39]
ds_read_b64_tr_b16 a[122:123], v117 offset:26624
v_cvt_pk_bf16_f32 v83, v90, v91
v_mfma_f32_16x16x32_bf16 v[36:39], a[88:91], v[228:231], v[36:39]
buffer_store_dwordx4 v[80:83], v1, s[4:7], s8 offen offset:3072 sc1
ds_read_b64_tr_b16 a[124:125], v117 offset:28672
v_mfma_f32_16x16x32_bf16 v[36:39], a[92:95], v[244:247], v[36:39]
s_waitcnt lgkmcnt(8)
ds_read_b64_tr_b16 a[126:127], v117 offset:30720
v_add_u32 v117, 4294901760, v117
v_mfma_f32_16x16x32_bf16 v[40:43], a[96:99], v[128:131], 0
buffer_load_dwordx4 v114, s[36:39], s81 offen offset:2048 lds
ds_read_b64_tr_b16 a[64:65], v118 offset:0
v_mfma_f32_16x16x32_bf16 v[40:43], a[100:103], v[144:147], v[40:43]
ds_read_b64_tr_b16 a[66:67], v118 offset:2048
v_mul_f32 v84, v84, v25
v_mfma_f32_16x16x32_bf16 v[40:43], a[104:107], v[160:163], v[40:43]
s_waitcnt lgkmcnt(8)
ds_read_b64_tr_b16 a[68:69], v118 offset:4096
v_mul_f32 v85, v85, v25
v_mfma_f32_16x16x32_bf16 v[40:43], a[108:111], v[176:179], v[40:43]
ds_read_b64_tr_b16 a[70:71], v118 offset:6144
v_mul_f32 v86, v86, v25
v_mfma_f32_16x16x32_bf16 v[40:43], a[112:115], v[192:195], v[40:43]
s_waitcnt lgkmcnt(8)
ds_read_b64_tr_b16 a[72:73], v118 offset:8192
v_mul_f32 v87, v87, v25
v_mfma_f32_16x16x32_bf16 v[40:43], a[116:119], v[208:211], v[40:43]
s_waitcnt lgkmcnt(7)
ds_read_b64_tr_b16 a[74:75], v118 offset:10240
v_mul_f32 v92, v92, v25
v_mfma_f32_16x16x32_bf16 v[40:43], a[120:123], v[224:227], v[40:43]
s_waitcnt lgkmcnt(6)
ds_read_b64_tr_b16 a[76:77], v118 offset:12288
v_mul_f32 v93, v93, v25
v_mfma_f32_16x16x32_bf16 v[40:43], a[124:127], v[240:243], v[40:43]
buffer_load_dwordx4 v115, s[36:39], s81 offen offset:3072 lds
ds_read_b64_tr_b16 a[78:79], v118 offset:14336
v_mfma_f32_16x16x32_bf16 v[44:47], a[96:99], v[132:135], 0
ds_read_b64_tr_b16 a[80:81], v118 offset:16384
v_mul_f32 v94, v94, v25
v_mfma_f32_16x16x32_bf16 v[44:47], a[100:103], v[148:151], v[44:47]
ds_read_b64_tr_b16 a[82:83], v118 offset:18432
v_mul_f32 v95, v95, v25
v_mfma_f32_16x16x32_bf16 v[44:47], a[104:107], v[164:167], v[44:47]
ds_read_b64_tr_b16 a[84:85], v118 offset:20480
v_cvt_pk_bf16_f32 v84, v84, v85
v_mfma_f32_16x16x32_bf16 v[44:47], a[108:111], v[180:183], v[44:47]
ds_read_b64_tr_b16 a[86:87], v118 offset:22528
v_cvt_pk_bf16_f32 v85, v86, v87
v_mfma_f32_16x16x32_bf16 v[44:47], a[112:115], v[196:199], v[44:47]
ds_read_b64_tr_b16 a[88:89], v118 offset:24576
v_cvt_pk_bf16_f32 v86, v92, v93
v_mfma_f32_16x16x32_bf16 v[44:47], a[116:119], v[212:215], v[44:47]
s_add_u32 s81, s81, 28672
s_add_u32 m0, s18, 36864
ds_read_b64_tr_b16 a[90:91], v118 offset:26624
v_mfma_f32_16x16x32_bf16 v[44:47], a[120:123], v[228:231], v[44:47]
buffer_load_dwordx4 v112, s[36:39], s81 offen offset:0 lds
ds_read_b64_tr_b16 a[92:93], v118 offset:28672
v_mfma_f32_16x16x32_bf16 v[44:47], a[124:127], v[244:247], v[44:47]
s_waitcnt lgkmcnt(8)
ds_read_b64_tr_b16 a[94:95], v118 offset:30720
v_add_u32 v118, 4294901760, v118
v_mfma_f32_16x16x32_bf16 v[48:51], a[64:67], v[128:131], 0
ds_read_b64_tr_b16 a[96:97], v119 offset:0
v_cvt_pk_bf16_f32 v87, v94, v95
v_mfma_f32_16x16x32_bf16 v[48:51], a[68:71], v[144:147], v[48:51]
s_waitcnt lgkmcnt(8)
buffer_store_dwordx4 v[84:87], v1, s[4:7], s12 offen offset:3072 sc1
ds_read_b64_tr_b16 a[98:99], v119 offset:2048
v_mfma_f32_16x16x32_bf16 v[48:51], a[72:75], v[160:163], v[48:51]
s_add_u32 s8, s8, 4096
s_add_u32 s12, s12, 4096
ds_read_b64_tr_b16 a[100:101], v119 offset:4096
v_mfma_f32_16x16x32_bf16 v[48:51], a[76:79], v[176:179], v[48:51]
s_waitcnt lgkmcnt(8)
ds_read_b64_tr_b16 a[102:103], v119 offset:6144
v_mul_f32 v32, v32, v24
v_mfma_f32_16x16x32_bf16 v[48:51], a[80:83], v[192:195], v[48:51]
s_waitcnt lgkmcnt(8)
ds_read_b64_tr_b16 a[104:105], v119 offset:8192
v_mul_f32 v33, v33, v24
v_mfma_f32_16x16x32_bf16 v[48:51], a[84:87], v[208:211], v[48:51]
s_waitcnt lgkmcnt(7)
buffer_load_dwordx4 v113, s[36:39], s81 offen offset:1024 lds
ds_read_b64_tr_b16 a[106:107], v119 offset:10240
v_mfma_f32_16x16x32_bf16 v[48:51], a[88:91], v[224:227], v[48:51]
s_waitcnt lgkmcnt(6)
ds_read_b64_tr_b16 a[108:109], v119 offset:12288
v_mul_f32 v34, v34, v24
v_mfma_f32_16x16x32_bf16 v[48:51], a[92:95], v[240:243], v[48:51]
ds_read_b64_tr_b16 a[110:111], v119 offset:14336
v_mul_f32 v35, v35, v24
v_mfma_f32_16x16x32_bf16 v[52:55], a[64:67], v[132:135], 0
ds_read_b64_tr_b16 a[112:113], v119 offset:16384
v_mul_f32 v40, v40, v24
v_mfma_f32_16x16x32_bf16 v[52:55], a[68:71], v[148:151], v[52:55]
ds_read_b64_tr_b16 a[114:115], v119 offset:18432
v_mul_f32 v41, v41, v24
v_mfma_f32_16x16x32_bf16 v[52:55], a[72:75], v[164:167], v[52:55]
ds_read_b64_tr_b16 a[116:117], v119 offset:20480
v_mul_f32 v42, v42, v24
v_mfma_f32_16x16x32_bf16 v[52:55], a[76:79], v[180:183], v[52:55]
ds_read_b64_tr_b16 a[118:119], v119 offset:22528
v_mul_f32 v43, v43, v24
v_mfma_f32_16x16x32_bf16 v[52:55], a[80:83], v[196:199], v[52:55]
buffer_load_dwordx4 v114, s[36:39], s81 offen offset:2048 lds
ds_read_b64_tr_b16 a[120:121], v119 offset:24576
v_mfma_f32_16x16x32_bf16 v[52:55], a[84:87], v[212:215], v[52:55]
ds_read_b64_tr_b16 a[122:123], v119 offset:26624
v_cvt_pk_bf16_f32 v32, v32, v33
v_mfma_f32_16x16x32_bf16 v[52:55], a[88:91], v[228:231], v[52:55]
ds_read_b64_tr_b16 a[124:125], v119 offset:28672
ds_read_b64_tr_b16 a[126:127], v119 offset:30720
v_mfma_f32_16x16x32_bf16 v[52:55], a[92:95], v[244:247], v[52:55]
s_waitcnt vmcnt(23) lgkmcnt(9)
s_barrier
v_add_u32 v119, 4294901760, v119
v_mfma_f32_16x16x32_bf16 v[56:59], a[96:99], v[128:131], 0
ds_read_b64_tr_b16 a[64:65], v116 offset:0
v_cvt_pk_bf16_f32 v33, v34, v35
v_mfma_f32_16x16x32_bf16 v[56:59], a[100:103], v[144:147], v[56:59]
ds_read_b64_tr_b16 a[66:67], v116 offset:2048
v_cvt_pk_bf16_f32 v34, v40, v41
v_mfma_f32_16x16x32_bf16 v[56:59], a[104:107], v[160:163], v[56:59]
s_waitcnt lgkmcnt(8)
ds_read_b64_tr_b16 a[68:69], v116 offset:4096
v_cvt_pk_bf16_f32 v35, v42, v43
v_mfma_f32_16x16x32_bf16 v[56:59], a[108:111], v[176:179], v[56:59]
buffer_load_dwordx4 v115, s[36:39], s81 offen offset:3072 lds
ds_read_b64_tr_b16 a[70:71], v116 offset:6144
v_mfma_f32_16x16x32_bf16 v[56:59], a[112:115], v[192:195], v[56:59]
s_waitcnt lgkmcnt(8)
buffer_store_dwordx4 v[32:35], v1, s[4:7], s8 offen offset:0 sc1
ds_read_b64_tr_b16 a[72:73], v116 offset:8192
v_mfma_f32_16x16x32_bf16 v[56:59], a[116:119], v[208:211], v[56:59]
PAD_15:
s_cbranch_execz M_tret
s_waitcnt lgkmcnt(7)
ds_read_b64_tr_b16 a[74:75], v116 offset:10240
v_mul_f32 v36, v36, v25
v_mfma_f32_16x16x32_bf16 v[56:59], a[120:123], v[224:227], v[56:59]
s_waitcnt lgkmcnt(6)
ds_read_b64_tr_b16 a[76:77], v116 offset:12288
v_mul_f32 v37, v37, v25
v_mfma_f32_16x16x32_bf16 v[56:59], a[124:127], v[240:243], v[56:59]
ds_read_b64_tr_b16 a[78:79], v116 offset:14336
v_mul_f32 v38, v38, v25
v_mfma_f32_16x16x32_bf16 v[60:63], a[96:99], v[132:135], 0
ds_read_b64_tr_b16 a[80:81], v116 offset:16384
v_mul_f32 v39, v39, v25
v_mfma_f32_16x16x32_bf16 v[60:63], a[100:103], v[148:151], v[60:63]
s_sub_u32 s81, s81, 28544
ds_read_b64_tr_b16 a[82:83], v116 offset:18432
v_mul_f32 v44, v44, v25
v_mfma_f32_16x16x32_bf16 v[60:63], a[104:107], v[164:167], v[60:63]
ds_read_b64_tr_b16 a[84:85], v116 offset:20480
v_mul_f32 v45, v45, v25
v_mfma_f32_16x16x32_bf16 v[60:63], a[108:111], v[180:183], v[60:63]
ds_read_b64_tr_b16 a[86:87], v116 offset:22528
v_mul_f32 v46, v46, v25
v_mfma_f32_16x16x32_bf16 v[60:63], a[112:115], v[196:199], v[60:63]
ds_read_b64_tr_b16 a[88:89], v116 offset:24576
v_mul_f32 v47, v47, v25
v_mfma_f32_16x16x32_bf16 v[60:63], a[116:119], v[212:215], v[60:63]
ds_read_b64_tr_b16 a[90:91], v116 offset:26624
v_cvt_pk_bf16_f32 v36, v36, v37
v_mfma_f32_16x16x32_bf16 v[60:63], a[120:123], v[228:231], v[60:63]
ds_read_b64_tr_b16 a[92:93], v116 offset:28672
v_cvt_pk_bf16_f32 v37, v38, v39
v_mfma_f32_16x16x32_bf16 v[60:63], a[124:127], v[244:247], v[60:63]
s_waitcnt lgkmcnt(8)
ds_read_b64_tr_b16 a[94:95], v116 offset:30720
v_add_u32 v116, 4294901760, v116
v_mfma_f32_16x16x32_bf16 v[64:67], a[64:67], v[128:131], 0
s_add_u32 m0, s18, 98304
ds_read_b64_tr_b16 a[96:97], v117 offset:0
v_cvt_pk_bf16_f32 v38, v44, v45
v_mfma_f32_16x16x32_bf16 v[64:67], a[68:71], v[144:147], v[64:67]
buffer_load_dwordx4 v112, s[36:39], s81 offen offset:0 lds
ds_read_b64_tr_b16 a[98:99], v117 offset:2048
v_mfma_f32_16x16x32_bf16 v[64:67], a[72:75], v[160:163], v[64:67]
s_waitcnt lgkmcnt(8)
ds_read_b64_tr_b16 a[100:101], v117 offset:4096
v_cvt_pk_bf16_f32 v39, v46, v47
v_mfma_f32_16x16x32_bf16 v[64:67], a[76:79], v[176:179], v[64:67]
buffer_store_dwordx4 v[36:39], v1, s[4:7], s12 offen offset:0 sc1
ds_read_b64_tr_b16 a[102:103], v117 offset:6144
v_mfma_f32_16x16x32_bf16 v[64:67], a[80:83], v[192:195], v[64:67]
s_waitcnt lgkmcnt(8)
ds_read_b64_tr_b16 a[104:105], v117 offset:8192
v_mul_f32 v48, v48, v24
v_mfma_f32_16x16x32_bf16 v[64:67], a[84:87], v[208:211], v[64:67]
s_waitcnt lgkmcnt(7)
ds_read_b64_tr_b16 a[106:107], v117 offset:10240
v_mul_f32 v49, v49, v24
v_mfma_f32_16x16x32_bf16 v[64:67], a[88:91], v[224:227], v[64:67]
s_waitcnt lgkmcnt(6)
ds_read_b64_tr_b16 a[108:109], v117 offset:12288
v_mul_f32 v50, v50, v24
v_mfma_f32_16x16x32_bf16 v[64:67], a[92:95], v[240:243], v[64:67]
ds_read_b64_tr_b16 a[110:111], v117 offset:14336
v_mul_f32 v51, v51, v24
v_mfma_f32_16x16x32_bf16 v[68:71], a[64:67], v[132:135], 0
buffer_load_dwordx4 v113, s[36:39], s81 offen offset:1024 lds
ds_read_b64_tr_b16 a[112:113], v117 offset:16384
v_mfma_f32_16x16x32_bf16 v[68:71], a[68:71], v[148:151], v[68:71]
ds_read_b64_tr_b16 a[114:115], v117 offset:18432
v_mul_f32 v56, v56, v24
v_mfma_f32_16x16x32_bf16 v[68:71], a[72:75], v[164:167], v[68:71]
ds_read_b64_tr_b16 a[116:117], v117 offset:20480
v_mul_f32 v57, v57, v24
v_mfma_f32_16x16x32_bf16 v[68:71], a[76:79], v[180:183], v[68:71]
ds_read_b64_tr_b16 a[118:119], v117 offset:22528
v_mul_f32 v58, v58, v24
v_mfma_f32_16x16x32_bf16 v[68:71], a[80:83], v[196:199], v[68:71]
ds_read_b64_tr_b16 a[120:121], v117 offset:24576
v_mul_f32 v59, v59, v24
v_mfma_f32_16x16x32_bf16 v[68:71], a[84:87], v[212:215], v[68:71]
ds_read_b64_tr_b16 a[122:123], v117 offset:26624
v_cvt_pk_bf16_f32 v48, v48, v49
v_mfma_f32_16x16x32_bf16 v[68:71], a[88:91], v[228:231], v[68:71]
ds_read_b64_tr_b16 a[124:125], v117 offset:28672
v_cvt_pk_bf16_f32 v49, v50, v51
v_mfma_f32_16x16x32_bf16 v[68:71], a[92:95], v[244:247], v[68:71]
s_waitcnt lgkmcnt(8)
ds_read_b64_tr_b16 a[126:127], v117 offset:30720
v_add_u32 v117, 4294901760, v117
v_mfma_f32_16x16x32_bf16 v[72:75], a[96:99], v[128:131], 0
buffer_load_dwordx4 v114, s[36:39], s81 offen offset:2048 lds
ds_read_b64_tr_b16 a[64:65], v118 offset:0
v_mfma_f32_16x16x32_bf16 v[72:75], a[100:103], v[144:147], v[72:75]
ds_read_b64_tr_b16 a[66:67], v118 offset:2048
v_cvt_pk_bf16_f32 v50, v56, v57
v_mfma_f32_16x16x32_bf16 v[72:75], a[104:107], v[160:163], v[72:75]
s_waitcnt lgkmcnt(8)
ds_read_b64_tr_b16 a[68:69], v118 offset:4096
v_cvt_pk_bf16_f32 v51, v58, v59
v_mfma_f32_16x16x32_bf16 v[72:75], a[108:111], v[176:179], v[72:75]
buffer_store_dwordx4 v[48:51], v1, s[4:7], s8 offen offset:1024 sc1
ds_read_b64_tr_b16 a[70:71], v118 offset:6144
v_mfma_f32_16x16x32_bf16 v[72:75], a[112:115], v[192:195], v[72:75]
s_waitcnt lgkmcnt(8)
ds_read_b64_tr_b16 a[72:73], v118 offset:8192
v_mul_f32 v52, v52, v25
v_mfma_f32_16x16x32_bf16 v[72:75], a[116:119], v[208:211], v[72:75]
s_waitcnt lgkmcnt(7)
ds_read_b64_tr_b16 a[74:75], v118 offset:10240
v_mul_f32 v53, v53, v25
v_mfma_f32_16x16x32_bf16 v[72:75], a[120:123], v[224:227], v[72:75]
s_waitcnt lgkmcnt(6)
ds_read_b64_tr_b16 a[76:77], v118 offset:12288
v_mul_f32 v54, v54, v25
v_mfma_f32_16x16x32_bf16 v[72:75], a[124:127], v[240:243], v[72:75]
buffer_load_dwordx4 v115, s[36:39], s81 offen offset:3072 lds
ds_read_b64_tr_b16 a[78:79], v118 offset:14336
v_mfma_f32_16x16x32_bf16 v[76:79], a[96:99], v[132:135], 0
ds_read_b64_tr_b16 a[80:81], v118 offset:16384
v_mul_f32 v55, v55, v25
v_mfma_f32_16x16x32_bf16 v[76:79], a[100:103], v[148:151], v[76:79]
ds_read_b64_tr_b16 a[82:83], v118 offset:18432
v_mul_f32 v60, v60, v25
v_mfma_f32_16x16x32_bf16 v[76:79], a[104:107], v[164:167], v[76:79]
ds_read_b64_tr_b16 a[84:85], v118 offset:20480
v_mul_f32 v61, v61, v25
v_mfma_f32_16x16x32_bf16 v[76:79], a[108:111], v[180:183], v[76:79]
ds_read_b64_tr_b16 a[86:87], v118 offset:22528
v_mul_f32 v62, v62, v25
v_mfma_f32_16x16x32_bf16 v[76:79], a[112:115], v[196:199], v[76:79]
ds_read_b64_tr_b16 a[88:89], v118 offset:24576
v_mul_f32 v63, v63, v25
v_mfma_f32_16x16x32_bf16 v[76:79], a[116:119], v[212:215], v[76:79]
s_add_u32 s81, s81, 28672
s_add_u32 m0, s18, 102400
ds_read_b64_tr_b16 a[90:91], v118 offset:26624
v_mfma_f32_16x16x32_bf16 v[76:79], a[120:123], v[228:231], v[76:79]
buffer_load_dwordx4 v112, s[36:39], s81 offen offset:0 lds
ds_read_b64_tr_b16 a[92:93], v118 offset:28672
v_mfma_f32_16x16x32_bf16 v[76:79], a[124:127], v[244:247], v[76:79]
s_waitcnt lgkmcnt(8)
ds_read_b64_tr_b16 a[94:95], v118 offset:30720
v_add_u32 v118, 4294901760, v118
v_mfma_f32_16x16x32_bf16 v[80:83], a[64:67], v[128:131], 0
ds_read_b64_tr_b16 a[96:97], v119 offset:0
v_cvt_pk_bf16_f32 v52, v52, v53
v_mfma_f32_16x16x32_bf16 v[80:83], a[68:71], v[144:147], v[80:83]
ds_read_b64_tr_b16 a[98:99], v119 offset:2048
v_cvt_pk_bf16_f32 v53, v54, v55
v_mfma_f32_16x16x32_bf16 v[80:83], a[72:75], v[160:163], v[80:83]
s_waitcnt lgkmcnt(8)
ds_read_b64_tr_b16 a[100:101], v119 offset:4096
v_cvt_pk_bf16_f32 v54, v60, v61
v_mfma_f32_16x16x32_bf16 v[80:83], a[76:79], v[176:179], v[80:83]
ds_read_b64_tr_b16 a[102:103], v119 offset:6144
v_cvt_pk_bf16_f32 v55, v62, v63
v_mfma_f32_16x16x32_bf16 v[80:83], a[80:83], v[192:195], v[80:83]
s_waitcnt lgkmcnt(8)
buffer_store_dwordx4 v[52:55], v1, s[4:7], s12 offen offset:1024 sc1
ds_read_b64_tr_b16 a[104:105], v119 offset:8192
v_mfma_f32_16x16x32_bf16 v[80:83], a[84:87], v[208:211], v[80:83]
s_waitcnt lgkmcnt(7)
buffer_load_dwordx4 v113, s[36:39], s81 offen offset:1024 lds
ds_read_b64_tr_b16 a[106:107], v119 offset:10240
v_mfma_f32_16x16x32_bf16 v[80:83], a[88:91], v[224:227], v[80:83]
s_waitcnt lgkmcnt(6)
ds_read_b64_tr_b16 a[108:109], v119 offset:12288
v_mul_f32 v64, v64, v24
v_mfma_f32_16x16x32_bf16 v[80:83], a[92:95], v[240:243], v[80:83]
ds_read_b64_tr_b16 a[110:111], v119 offset:14336
v_mul_f32 v65, v65, v24
v_mfma_f32_16x16x32_bf16 v[84:87], a[64:67], v[132:135], 0
ds_read_b64_tr_b16 a[112:113], v119 offset:16384
v_mul_f32 v66, v66, v24
v_mfma_f32_16x16x32_bf16 v[84:87], a[68:71], v[148:151], v[84:87]
ds_read_b64_tr_b16 a[114:115], v119 offset:18432
v_mul_f32 v67, v67, v24
v_mfma_f32_16x16x32_bf16 v[84:87], a[72:75], v[164:167], v[84:87]
ds_read_b64_tr_b16 a[116:117], v119 offset:20480
v_mul_f32 v72, v72, v24
v_mfma_f32_16x16x32_bf16 v[84:87], a[76:79], v[180:183], v[84:87]
ds_read_b64_tr_b16 a[118:119], v119 offset:22528
v_mul_f32 v73, v73, v24
v_mfma_f32_16x16x32_bf16 v[84:87], a[80:83], v[196:199], v[84:87]
buffer_load_dwordx4 v114, s[36:39], s81 offen offset:2048 lds
ds_read_b64_tr_b16 a[120:121], v119 offset:24576
v_mfma_f32_16x16x32_bf16 v[84:87], a[84:87], v[212:215], v[84:87]
ds_read_b64_tr_b16 a[122:123], v119 offset:26624
v_mul_f32 v74, v74, v24
v_mfma_f32_16x16x32_bf16 v[84:87], a[88:91], v[228:231], v[84:87]
ds_read_b64_tr_b16 a[124:125], v119 offset:28672
ds_read_b64_tr_b16 a[126:127], v119 offset:30720
v_mfma_f32_16x16x32_bf16 v[84:87], a[92:95], v[244:247], v[84:87]
s_waitcnt vmcnt(27) lgkmcnt(9)
s_barrier
v_add_u32 v119, 4294901760, v119
v_mfma_f32_16x16x32_bf16 v[88:91], a[96:99], v[128:131], 0
ds_read_b64_tr_b16 a[64:65], v116 offset:0
v_mul_f32 v75, v75, v24
v_mfma_f32_16x16x32_bf16 v[88:91], a[100:103], v[144:147], v[88:91]
ds_read_b64_tr_b16 a[66:67], v116 offset:2048
v_cvt_pk_bf16_f32 v64, v64, v65
v_mfma_f32_16x16x32_bf16 v[88:91], a[104:107], v[160:163], v[88:91]
s_waitcnt lgkmcnt(8)
ds_read_b64_tr_b16 a[68:69], v116 offset:4096
v_cvt_pk_bf16_f32 v65, v66, v67
v_mfma_f32_16x16x32_bf16 v[88:91], a[108:111], v[176:179], v[88:91]
buffer_load_dwordx4 v115, s[36:39], s81 offen offset:3072 lds
ds_read_b64_tr_b16 a[70:71], v116 offset:6144
v_mfma_f32_16x16x32_bf16 v[88:91], a[112:115], v[192:195], v[88:91]
s_waitcnt lgkmcnt(8)
ds_read_b64_tr_b16 a[72:73], v116 offset:8192
v_cvt_pk_bf16_f32 v66, v72, v73
v_mfma_f32_16x16x32_bf16 v[88:91], a[116:119], v[208:211], v[88:91]
s_waitcnt lgkmcnt(7)
ds_read_b64_tr_b16 a[74:75], v116 offset:10240
v_cvt_pk_bf16_f32 v67, v74, v75
v_mfma_f32_16x16x32_bf16 v[88:91], a[120:123], v[224:227], v[88:91]
s_waitcnt lgkmcnt(6)
buffer_store_dwordx4 v[64:67], v1, s[4:7], s8 offen offset:2048 sc1
ds_read_b64_tr_b16 a[76:77], v116 offset:12288
v_mfma_f32_16x16x32_bf16 v[88:91], a[124:127], v[240:243], v[88:91]
ds_read_b64_tr_b16 a[78:79], v116 offset:14336
v_mul_f32 v68, v68, v25
v_mfma_f32_16x16x32_bf16 v[92:95], a[96:99], v[132:135], 0
ds_read_b64_tr_b16 a[80:81], v116 offset:16384
v_mul_f32 v69, v69, v25
v_mfma_f32_16x16x32_bf16 v[92:95], a[100:103], v[148:151], v[92:95]
s_sub_u32 s81, s81, 28544
ds_read_b64_tr_b16 a[82:83], v116 offset:18432
v_mul_f32 v70, v70, v25
v_mfma_f32_16x16x32_bf16 v[92:95], a[104:107], v[164:167], v[92:95]
ds_read_b64_tr_b16 a[84:85], v116 offset:20480
v_mul_f32 v71, v71, v25
v_mfma_f32_16x16x32_bf16 v[92:95], a[108:111], v[180:183], v[92:95]
ds_read_b64_tr_b16 a[86:87], v116 offset:22528
v_mul_f32 v76, v76, v25
v_mfma_f32_16x16x32_bf16 v[92:95], a[112:115], v[196:199], v[92:95]
ds_read_b64_tr_b16 a[88:89], v116 offset:24576
v_mul_f32 v77, v77, v25
v_mfma_f32_16x16x32_bf16 v[92:95], a[116:119], v[212:215], v[92:95]
ds_read_b64_tr_b16 a[90:91], v116 offset:26624
v_mul_f32 v78, v78, v25
v_mfma_f32_16x16x32_bf16 v[92:95], a[120:123], v[228:231], v[92:95]
ds_read_b64_tr_b16 a[92:93], v116 offset:28672
v_mul_f32 v79, v79, v25
v_mfma_f32_16x16x32_bf16 v[92:95], a[124:127], v[244:247], v[92:95]
s_waitcnt lgkmcnt(8)
ds_read_b64_tr_b16 a[94:95], v116 offset:30720
v_add_u32 v116, 32768, v116
v_mfma_f32_16x16x32_bf16 v[32:35], a[64:67], v[128:131], 0
ds_read_b64_tr_b16 a[96:97], v117 offset:0
v_cvt_pk_bf16_f32 v68, v68, v69
v_mfma_f32_16x16x32_bf16 v[32:35], a[68:71], v[144:147], v[32:35]
ds_read_b64_tr_b16 a[98:99], v117 offset:2048
v_cvt_pk_bf16_f32 v69, v70, v71
v_mfma_f32_16x16x32_bf16 v[32:35], a[72:75], v[160:163], v[32:35]
s_waitcnt lgkmcnt(8)
ds_read_b64_tr_b16 a[100:101], v117 offset:4096
v_cvt_pk_bf16_f32 v70, v76, v77
v_mfma_f32_16x16x32_bf16 v[32:35], a[76:79], v[176:179], v[32:35]
ds_read_b64_tr_b16 a[102:103], v117 offset:6144
v_cvt_pk_bf16_f32 v71, v78, v79
v_mfma_f32_16x16x32_bf16 v[32:35], a[80:83], v[192:195], v[32:35]
s_waitcnt lgkmcnt(8)
buffer_store_dwordx4 v[68:71], v1, s[4:7], s12 offen offset:2048 sc1
ds_read_b64_tr_b16 a[104:105], v117 offset:8192
v_mfma_f32_16x16x32_bf16 v[32:35], a[84:87], v[208:211], v[32:35]
s_waitcnt lgkmcnt(7)
ds_read_b64_tr_b16 a[106:107], v117 offset:10240
v_mul_f32 v80, v80, v24
v_mfma_f32_16x16x32_bf16 v[32:35], a[88:91], v[224:227], v[32:35]
s_waitcnt lgkmcnt(6)
ds_read_b64_tr_b16 a[108:109], v117 offset:12288
v_mul_f32 v81, v81, v24
v_mfma_f32_16x16x32_bf16 v[32:35], a[92:95], v[240:243], v[32:35]
ds_read_b64_tr_b16 a[110:111], v117 offset:14336
v_mul_f32 v82, v82, v24
v_mfma_f32_16x16x32_bf16 v[36:39], a[64:67], v[132:135], 0
ds_read_b64_tr_b16 a[112:113], v117 offset:16384
v_mul_f32 v83, v83, v24
v_mfma_f32_16x16x32_bf16 v[36:39], a[68:71], v[148:151], v[36:39]
ds_read_b64_tr_b16 a[114:115], v117 offset:18432
v_mul_f32 v88, v88, v24
v_mfma_f32_16x16x32_bf16 v[36:39], a[72:75], v[164:167], v[36:39]
ds_read_b64_tr_b16 a[116:117], v117 offset:20480
v_mul_f32 v89, v89, v24
v_mfma_f32_16x16x32_bf16 v[36:39], a[76:79], v[180:183], v[36:39]
ds_read_b64_tr_b16 a[118:119], v117 offset:22528
v_mul_f32 v90, v90, v24
v_mfma_f32_16x16x32_bf16 v[36:39], a[80:83], v[196:199], v[36:39]
ds_read_b64_tr_b16 a[120:121], v117 offset:24576
v_mul_f32 v91, v91, v24
v_mfma_f32_16x16x32_bf16 v[36:39], a[84:87], v[212:215], v[36:39]
ds_read_b64_tr_b16 a[122:123], v117 offset:26624
v_cvt_pk_bf16_f32 v80, v80, v81
v_mfma_f32_16x16x32_bf16 v[36:39], a[88:91], v[228:231], v[36:39]
ds_read_b64_tr_b16 a[124:125], v117 offset:28672
v_cvt_pk_bf16_f32 v81, v82, v83
v_mfma_f32_16x16x32_bf16 v[36:39], a[92:95], v[244:247], v[36:39]
s_waitcnt lgkmcnt(8)
ds_read_b64_tr_b16 a[126:127], v117 offset:30720
v_add_u32 v117, 32768, v117
v_mfma_f32_16x16x32_bf16 v[40:43], a[96:99], v[128:131], 0
ds_read_b64_tr_b16 a[64:65], v118 offset:0
v_cvt_pk_bf16_f32 v82, v88, v89
v_mfma_f32_16x16x32_bf16 v[40:43], a[100:103], v[144:147], v[40:43]
ds_read_b64_tr_b16 a[66:67], v118 offset:2048
v_cvt_pk_bf16_f32 v83, v90, v91
v_mfma_f32_16x16x32_bf16 v[40:43], a[104:107], v[160:163], v[40:43]
s_waitcnt lgkmcnt(8)
buffer_store_dwordx4 v[80:83], v1, s[4:7], s8 offen offset:3072 sc1
ds_read_b64_tr_b16 a[68:69], v118 offset:4096
v_mfma_f32_16x16x32_bf16 v[40:43], a[108:111], v[176:179], v[40:43]
ds_read_b64_tr_b16 a[70:71], v118 offset:6144
v_mul_f32 v84, v84, v25
v_mfma_f32_16x16x32_bf16 v[40:43], a[112:115], v[192:195], v[40:43]
s_waitcnt lgkmcnt(8)
ds_read_b64_tr_b16 a[72:73], v118 offset:8192
v_mul_f32 v85, v85, v25
v_mfma_f32_16x16x32_bf16 v[40:43], a[116:119], v[208:211], v[40:43]
s_waitcnt lgkmcnt(7)
ds_read_b64_tr_b16 a[74:75], v118 offset:10240
v_mul_f32 v86, v86, v25
v_mfma_f32_16x16x32_bf16 v[40:43], a[120:123], v[224:227], v[40:43]
s_waitcnt lgkmcnt(6)
ds_read_b64_tr_b16 a[76:77], v118 offset:12288
v_mul_f32 v87, v87, v25
v_mfma_f32_16x16x32_bf16 v[40:43], a[124:127], v[240:243], v[40:43]
ds_read_b64_tr_b16 a[78:79], v118 offset:14336
v_mul_f32 v92, v92, v25
v_mfma_f32_16x16x32_bf16 v[44:47], a[96:99], v[132:135], 0
ds_read_b64_tr_b16 a[80:81], v118 offset:16384
v_mul_f32 v93, v93, v25
v_mfma_f32_16x16x32_bf16 v[44:47], a[100:103], v[148:151], v[44:47]
ds_read_b64_tr_b16 a[82:83], v118 offset:18432
v_mul_f32 v94, v94, v25
v_mfma_f32_16x16x32_bf16 v[44:47], a[104:107], v[164:167], v[44:47]
ds_read_b64_tr_b16 a[84:85], v118 offset:20480
v_mul_f32 v95, v95, v25
v_mfma_f32_16x16x32_bf16 v[44:47], a[108:111], v[180:183], v[44:47]
ds_read_b64_tr_b16 a[86:87], v118 offset:22528
v_cvt_pk_bf16_f32 v84, v84, v85
v_mfma_f32_16x16x32_bf16 v[44:47], a[112:115], v[196:199], v[44:47]
ds_read_b64_tr_b16 a[88:89], v118 offset:24576
v_cvt_pk_bf16_f32 v85, v86, v87
v_mfma_f32_16x16x32_bf16 v[44:47], a[116:119], v[212:215], v[44:47]
ds_read_b64_tr_b16 a[90:91], v118 offset:26624
v_cvt_pk_bf16_f32 v86, v92, v93
v_mfma_f32_16x16x32_bf16 v[44:47], a[120:123], v[228:231], v[44:47]
ds_read_b64_tr_b16 a[92:93], v118 offset:28672
v_cvt_pk_bf16_f32 v87, v94, v95
v_mfma_f32_16x16x32_bf16 v[44:47], a[124:127], v[244:247], v[44:47]
s_waitcnt lgkmcnt(8)
ds_read_b64_tr_b16 a[94:95], v118 offset:30720
v_add_u32 v118, 32768, v118
v_mfma_f32_16x16x32_bf16 v[48:51], a[64:67], v[128:131], 0
buffer_store_dwordx4 v[84:87], v1, s[4:7], s12 offen offset:3072 sc1
ds_read_b64_tr_b16 a[96:97], v119 offset:0
v_mfma_f32_16x16x32_bf16 v[48:51], a[68:71], v[144:147], v[48:51]
s_add_u32 s8, s8, 4096
s_add_u32 s12, s12, 4096
ds_read_b64_tr_b16 a[98:99], v119 offset:2048
v_mfma_f32_16x16x32_bf16 v[48:51], a[72:75], v[160:163], v[48:51]
s_waitcnt lgkmcnt(8)
ds_read_b64_tr_b16 a[100:101], v119 offset:4096
v_mul_f32 v32, v32, v24
v_mfma_f32_16x16x32_bf16 v[48:51], a[76:79], v[176:179], v[48:51]
ds_read_b64_tr_b16 a[102:103], v119 offset:6144
v_mul_f32 v33, v33, v24
v_mfma_f32_16x16x32_bf16 v[48:51], a[80:83], v[192:195], v[48:51]
s_waitcnt lgkmcnt(8)
ds_read_b64_tr_b16 a[104:105], v119 offset:8192
v_mul_f32 v34, v34, v24
v_mfma_f32_16x16x32_bf16 v[48:51], a[84:87], v[208:211], v[48:51]
s_waitcnt lgkmcnt(7)
ds_read_b64_tr_b16 a[106:107], v119 offset:10240
v_mul_f32 v35, v35, v24
v_mfma_f32_16x16x32_bf16 v[48:51], a[88:91], v[224:227], v[48:51]
s_waitcnt lgkmcnt(6)
ds_read_b64_tr_b16 a[108:109], v119 offset:12288
v_mul_f32 v40, v40, v24
v_mfma_f32_16x16x32_bf16 v[48:51], a[92:95], v[240:243], v[48:51]
ds_read_b64_tr_b16 a[110:111], v119 offset:14336
v_mul_f32 v41, v41, v24
v_mfma_f32_16x16x32_bf16 v[52:55], a[64:67], v[132:135], 0
ds_read_b64_tr_b16 a[112:113], v119 offset:16384
v_mul_f32 v42, v42, v24
v_mfma_f32_16x16x32_bf16 v[52:55], a[68:71], v[148:151], v[52:55]
ds_read_b64_tr_b16 a[114:115], v119 offset:18432
v_mul_f32 v43, v43, v24
v_mfma_f32_16x16x32_bf16 v[52:55], a[72:75], v[164:167], v[52:55]
ds_read_b64_tr_b16 a[116:117], v119 offset:20480
v_cvt_pk_bf16_f32 v32, v32, v33
v_mfma_f32_16x16x32_bf16 v[52:55], a[76:79], v[180:183], v[52:55]
ds_read_b64_tr_b16 a[118:119], v119 offset:22528
v_cvt_pk_bf16_f32 v33, v34, v35
v_mfma_f32_16x16x32_bf16 v[52:55], a[80:83], v[196:199], v[52:55]
ds_read_b64_tr_b16 a[120:121], v119 offset:24576
v_cvt_pk_bf16_f32 v34, v40, v41
v_mfma_f32_16x16x32_bf16 v[52:55], a[84:87], v[212:215], v[52:55]
ds_read_b64_tr_b16 a[122:123], v119 offset:26624
v_cvt_pk_bf16_f32 v35, v42, v43
v_mfma_f32_16x16x32_bf16 v[52:55], a[88:91], v[228:231], v[52:55]
ds_read_b64_tr_b16 a[124:125], v119 offset:28672
ds_read_b64_tr_b16 a[126:127], v119 offset:30720
v_mfma_f32_16x16x32_bf16 v[52:55], a[92:95], v[244:247], v[52:55]
s_waitcnt vmcnt(16) lgkmcnt(9)
s_barrier
v_add_u32 v119, 32768, v119
v_mfma_f32_16x16x32_bf16 v[56:59], a[96:99], v[128:131], 0
buffer_store_dwordx4 v[32:35], v1, s[4:7], s8 offen offset:0 sc1
ds_read_b64_tr_b16 a[64:65], v116 offset:0
v_mfma_f32_16x16x32_bf16 v[56:59], a[100:103], v[144:147], v[56:59]
ds_read_b64_tr_b16 a[66:67], v116 offset:2048
v_mul_f32 v36, v36, v25
v_mfma_f32_16x16x32_bf16 v[56:59], a[104:107], v[160:163], v[56:59]
s_waitcnt lgkmcnt(8)
ds_read_b64_tr_b16 a[68:69], v116 offset:4096
v_mul_f32 v37, v37, v25
v_mfma_f32_16x16x32_bf16 v[56:59], a[108:111], v[176:179], v[56:59]
ds_read_b64_tr_b16 a[70:71], v116 offset:6144
v_mul_f32 v38, v38, v25
v_mfma_f32_16x16x32_bf16 v[56:59], a[112:115], v[192:195], v[56:59]
s_waitcnt lgkmcnt(8)
ds_read_b64_tr_b16 a[72:73], v116 offset:8192
v_mul_f32 v39, v39, v25
v_mfma_f32_16x16x32_bf16 v[56:59], a[116:119], v[208:211], v[56:59]
s_waitcnt lgkmcnt(7)
ds_read_b64_tr_b16 a[74:75], v116 offset:10240
v_mul_f32 v44, v44, v25
v_mfma_f32_16x16x32_bf16 v[56:59], a[120:123], v[224:227], v[56:59]
s_waitcnt lgkmcnt(6)
ds_read_b64_tr_b16 a[76:77], v116 offset:12288
v_mul_f32 v45, v45, v25
v_mfma_f32_16x16x32_bf16 v[56:59], a[124:127], v[240:243], v[56:59]
ds_read_b64_tr_b16 a[78:79], v116 offset:14336
v_mul_f32 v46, v46, v25
v_mfma_f32_16x16x32_bf16 v[60:63], a[96:99], v[132:135], 0
ds_read_b64_tr_b16 a[80:81], v116 offset:16384
v_mul_f32 v47, v47, v25
v_mfma_f32_16x16x32_bf16 v[60:63], a[100:103], v[148:151], v[60:63]
ds_read_b64_tr_b16 a[82:83], v116 offset:18432
v_cvt_pk_bf16_f32 v36, v36, v37
v_mfma_f32_16x16x32_bf16 v[60:63], a[104:107], v[164:167], v[60:63]
ds_read_b64_tr_b16 a[84:85], v116 offset:20480
v_cvt_pk_bf16_f32 v37, v38, v39
v_mfma_f32_16x16x32_bf16 v[60:63], a[108:111], v[180:183], v[60:63]
ds_read_b64_tr_b16 a[86:87], v116 offset:22528
v_cvt_pk_bf16_f32 v38, v44, v45
v_mfma_f32_16x16x32_bf16 v[60:63], a[112:115], v[196:199], v[60:63]
ds_read_b64_tr_b16 a[88:89], v116 offset:24576
v_cvt_pk_bf16_f32 v39, v46, v47
v_mfma_f32_16x16x32_bf16 v[60:63], a[116:119], v[212:215], v[60:63]
buffer_store_dwordx4 v[36:39], v1, s[4:7], s12 offen offset:0 sc1
ds_read_b64_tr_b16 a[90:91], v116 offset:26624
v_mfma_f32_16x16x32_bf16 v[60:63], a[120:123], v[228:231], v[60:63]
ds_read_b64_tr_b16 a[92:93], v116 offset:28672
v_mfma_f32_16x16x32_bf16 v[60:63], a[124:127], v[244:247], v[60:63]
s_waitcnt lgkmcnt(8)
ds_read_b64_tr_b16 a[94:95], v116 offset:30720
v_add_u32 v116, 65536, v116
v_mfma_f32_16x16x32_bf16 v[64:67], a[64:67], v[128:131], 0
ds_read_b64_tr_b16 a[96:97], v117 offset:0
v_mul_f32 v48, v48, v24
v_mfma_f32_16x16x32_bf16 v[64:67], a[68:71], v[144:147], v[64:67]
ds_read_b64_tr_b16 a[98:99], v117 offset:2048
v_mul_f32 v49, v49, v24
v_mfma_f32_16x16x32_bf16 v[64:67], a[72:75], v[160:163], v[64:67]
s_waitcnt lgkmcnt(8)
ds_read_b64_tr_b16 a[100:101], v117 offset:4096
v_mul_f32 v50, v50, v24
v_mfma_f32_16x16x32_bf16 v[64:67], a[76:79], v[176:179], v[64:67]
ds_read_b64_tr_b16 a[102:103], v117 offset:6144
v_mul_f32 v51, v51, v24
v_mfma_f32_16x16x32_bf16 v[64:67], a[80:83], v[192:195], v[64:67]
s_waitcnt lgkmcnt(8)
ds_read_b64_tr_b16 a[104:105], v117 offset:8192
v_mul_f32 v56, v56, v24
v_mfma_f32_16x16x32_bf16 v[64:67], a[84:87], v[208:211], v[64:67]
s_waitcnt lgkmcnt(7)
ds_read_b64_tr_b16 a[106:107], v117 offset:10240
v_mul_f32 v57, v57, v24
v_mfma_f32_16x16x32_bf16 v[64:67], a[88:91], v[224:227], v[64:67]
s_waitcnt lgkmcnt(6)
ds_read_b64_tr_b16 a[108:109], v117 offset:12288
v_mul_f32 v58, v58, v24
v_mfma_f32_16x16x32_bf16 v[64:67], a[92:95], v[240:243], v[64:67]
ds_read_b64_tr_b16 a[110:111], v117 offset:14336
v_mul_f32 v59, v59, v24
v_mfma_f32_16x16x32_bf16 v[68:71], a[64:67], v[132:135], 0
ds_read_b64_tr_b16 a[112:113], v117 offset:16384
v_cvt_pk_bf16_f32 v48, v48, v49
v_mfma_f32_16x16x32_bf16 v[68:71], a[68:71], v[148:151], v[68:71]
ds_read_b64_tr_b16 a[114:115], v117 offset:18432
v_cvt_pk_bf16_f32 v49, v50, v51
v_mfma_f32_16x16x32_bf16 v[68:71], a[72:75], v[164:167], v[68:71]
ds_read_b64_tr_b16 a[116:117], v117 offset:20480
v_cvt_pk_bf16_f32 v50, v56, v57
v_mfma_f32_16x16x32_bf16 v[68:71], a[76:79], v[180:183], v[68:71]
ds_read_b64_tr_b16 a[118:119], v117 offset:22528
v_cvt_pk_bf16_f32 v51, v58, v59
v_mfma_f32_16x16x32_bf16 v[68:71], a[80:83], v[196:199], v[68:71]
buffer_store_dwordx4 v[48:51], v1, s[4:7], s8 offen offset:1024 sc1
ds_read_b64_tr_b16 a[120:121], v117 offset:24576
v_mfma_f32_16x16x32_bf16 v[68:71], a[84:87], v[212:215], v[68:71]
ds_read_b64_tr_b16 a[122:123], v117 offset:26624
v_mul_f32 v52, v52, v25
v_mfma_f32_16x16x32_bf16 v[68:71], a[88:91], v[228:231], v[68:71]
ds_read_b64_tr_b16 a[124:125], v117 offset:28672
v_mul_f32 v53, v53, v25
v_mfma_f32_16x16x32_bf16 v[68:71], a[92:95], v[244:247], v[68:71]
s_waitcnt lgkmcnt(8)
ds_read_b64_tr_b16 a[126:127], v117 offset:30720
v_add_u32 v117, 65536, v117
v_mfma_f32_16x16x32_bf16 v[72:75], a[96:99], v[128:131], 0
ds_read_b64_tr_b16 a[64:65], v118 offset:0
v_mul_f32 v54, v54, v25
v_mfma_f32_16x16x32_bf16 v[72:75], a[100:103], v[144:147], v[72:75]
ds_read_b64_tr_b16 a[66:67], v118 offset:2048
v_mul_f32 v55, v55, v25
v_mfma_f32_16x16x32_bf16 v[72:75], a[104:107], v[160:163], v[72:75]
s_waitcnt lgkmcnt(8)
ds_read_b64_tr_b16 a[68:69], v118 offset:4096
v_mul_f32 v60, v60, v25
v_mfma_f32_16x16x32_bf16 v[72:75], a[108:111], v[176:179], v[72:75]
ds_read_b64_tr_b16 a[70:71], v118 offset:6144
v_mul_f32 v61, v61, v25
v_mfma_f32_16x16x32_bf16 v[72:75], a[112:115], v[192:195], v[72:75]
s_waitcnt lgkmcnt(8)
ds_read_b64_tr_b16 a[72:73], v118 offset:8192
v_mul_f32 v62, v62, v25
v_mfma_f32_16x16x32_bf16 v[72:75], a[116:119], v[208:211], v[72:75]
s_waitcnt lgkmcnt(7)
ds_read_b64_tr_b16 a[74:75], v118 offset:10240
v_mul_f32 v63, v63, v25
v_mfma_f32_16x16x32_bf16 v[72:75], a[120:123], v[224:227], v[72:75]
s_waitcnt lgkmcnt(6)
ds_read_b64_tr_b16 a[76:77], v118 offset:12288
v_cvt_pk_bf16_f32 v52, v52, v53
v_mfma_f32_16x16x32_bf16 v[72:75], a[124:127], v[240:243], v[72:75]
ds_read_b64_tr_b16 a[78:79], v118 offset:14336
v_cvt_pk_bf16_f32 v53, v54, v55
v_mfma_f32_16x16x32_bf16 v[76:79], a[96:99], v[132:135], 0
ds_read_b64_tr_b16 a[80:81], v118 offset:16384
v_cvt_pk_bf16_f32 v54, v60, v61
v_mfma_f32_16x16x32_bf16 v[76:79], a[100:103], v[148:151], v[76:79]
ds_read_b64_tr_b16 a[82:83], v118 offset:18432
v_cvt_pk_bf16_f32 v55, v62, v63
v_mfma_f32_16x16x32_bf16 v[76:79], a[104:107], v[164:167], v[76:79]
buffer_store_dwordx4 v[52:55], v1, s[4:7], s12 offen offset:1024 sc1
ds_read_b64_tr_b16 a[84:85], v118 offset:20480
v_mfma_f32_16x16x32_bf16 v[76:79], a[108:111], v[180:183], v[76:79]
ds_read_b64_tr_b16 a[86:87], v118 offset:22528
v_mul_u32_u24 v21, 1792, v19
v_mfma_f32_16x16x32_bf16 v[76:79], a[112:115], v[196:199], v[76:79]
ds_read_b64_tr_b16 a[88:89], v118 offset:24576
v_mul_f32 v64, v64, v24
v_mfma_f32_16x16x32_bf16 v[76:79], a[116:119], v[212:215], v[76:79]
ds_read_b64_tr_b16 a[90:91], v118 offset:26624
v_mul_f32 v65, v65, v24
v_mfma_f32_16x16x32_bf16 v[76:79], a[120:123], v[228:231], v[76:79]
ds_read_b64_tr_b16 a[92:93], v118 offset:28672
v_mul_f32 v66, v66, v24
v_mfma_f32_16x16x32_bf16 v[76:79], a[124:127], v[244:247], v[76:79]
s_waitcnt lgkmcnt(8)
ds_read_b64_tr_b16 a[94:95], v118 offset:30720
v_add_u32 v118, 65536, v118
v_mfma_f32_16x16x32_bf16 v[80:83], a[64:67], v[128:131], 0
ds_read_b64_tr_b16 a[96:97], v119 offset:0
v_mul_f32 v67, v67, v24
v_mfma_f32_16x16x32_bf16 v[80:83], a[68:71], v[144:147], v[80:83]
ds_read_b64_tr_b16 a[98:99], v119 offset:2048
v_mul_f32 v72, v72, v24
v_mfma_f32_16x16x32_bf16 v[80:83], a[72:75], v[160:163], v[80:83]
s_waitcnt lgkmcnt(8)
ds_read_b64_tr_b16 a[100:101], v119 offset:4096
v_mul_f32 v73, v73, v24
v_mfma_f32_16x16x32_bf16 v[80:83], a[76:79], v[176:179], v[80:83]
ds_read_b64_tr_b16 a[102:103], v119 offset:6144
v_mul_f32 v74, v74, v24
v_mfma_f32_16x16x32_bf16 v[80:83], a[80:83], v[192:195], v[80:83]
PAD_16:
s_cbranch_execz M_tret
s_waitcnt lgkmcnt(8)
ds_read_b64_tr_b16 a[104:105], v119 offset:8192
v_mul_f32 v75, v75, v24
v_mfma_f32_16x16x32_bf16 v[80:83], a[84:87], v[208:211], v[80:83]
s_waitcnt lgkmcnt(7)
ds_read_b64_tr_b16 a[106:107], v119 offset:10240
v_cvt_pk_bf16_f32 v64, v64, v65
v_mfma_f32_16x16x32_bf16 v[80:83], a[88:91], v[224:227], v[80:83]
s_waitcnt lgkmcnt(6)
ds_read_b64_tr_b16 a[108:109], v119 offset:12288
v_cvt_pk_bf16_f32 v65, v66, v67
v_mfma_f32_16x16x32_bf16 v[80:83], a[92:95], v[240:243], v[80:83]
ds_read_b64_tr_b16 a[110:111], v119 offset:14336
v_cvt_pk_bf16_f32 v66, v72, v73
v_mfma_f32_16x16x32_bf16 v[84:87], a[64:67], v[132:135], 0
ds_read_b64_tr_b16 a[112:113], v119 offset:16384
v_cvt_pk_bf16_f32 v67, v74, v75
v_mfma_f32_16x16x32_bf16 v[84:87], a[68:71], v[148:151], v[84:87]
buffer_store_dwordx4 v[64:67], v1, s[4:7], s8 offen offset:2048 sc1
ds_read_b64_tr_b16 a[114:115], v119 offset:18432
v_mfma_f32_16x16x32_bf16 v[84:87], a[72:75], v[164:167], v[84:87]
ds_read_b64_tr_b16 a[116:117], v119 offset:20480
v_mul_f32 v68, v68, v25
v_mfma_f32_16x16x32_bf16 v[84:87], a[76:79], v[180:183], v[84:87]
ds_read_b64_tr_b16 a[118:119], v119 offset:22528
v_mul_f32 v69, v69, v25
v_mfma_f32_16x16x32_bf16 v[84:87], a[80:83], v[196:199], v[84:87]
ds_read_b64_tr_b16 a[120:121], v119 offset:24576
v_mul_f32 v70, v70, v25
v_mfma_f32_16x16x32_bf16 v[84:87], a[84:87], v[212:215], v[84:87]
ds_read_b64_tr_b16 a[122:123], v119 offset:26624
v_mul_f32 v71, v71, v25
v_mfma_f32_16x16x32_bf16 v[84:87], a[88:91], v[228:231], v[84:87]
ds_read_b64_tr_b16 a[124:125], v119 offset:28672
ds_read_b64_tr_b16 a[126:127], v119 offset:30720
v_mfma_f32_16x16x32_bf16 v[84:87], a[92:95], v[244:247], v[84:87]
s_waitcnt vmcnt(7) lgkmcnt(9)
s_barrier
v_add_u32 v119, 65536, v119
v_mfma_f32_16x16x32_bf16 v[88:91], a[96:99], v[128:131], 0
ds_read_b64_tr_b16 a[64:65], v116 offset:0
v_mul_f32 v76, v76, v25
v_mfma_f32_16x16x32_bf16 v[88:91], a[100:103], v[144:147], v[88:91]
buffer_store_dword v6, v5, s[4:7], s34 offen sc1
ds_read_b64_tr_b16 a[66:67], v116 offset:2048
v_mfma_f32_16x16x32_bf16 v[88:91], a[104:107], v[160:163], v[88:91]
s_waitcnt lgkmcnt(8)
ds_read_b64_tr_b16 a[68:69], v116 offset:4096
v_mul_f32 v77, v77, v25
v_mfma_f32_16x16x32_bf16 v[88:91], a[108:111], v[176:179], v[88:91]
ds_read_b64_tr_b16 a[70:71], v116 offset:6144
v_mul_f32 v78, v78, v25
v_mfma_f32_16x16x32_bf16 v[88:91], a[112:115], v[192:195], v[88:91]
s_waitcnt lgkmcnt(8)
ds_read_b64_tr_b16 a[72:73], v116 offset:8192
v_mul_f32 v79, v79, v25
v_mfma_f32_16x16x32_bf16 v[88:91], a[116:119], v[208:211], v[88:91]
s_waitcnt lgkmcnt(7)
ds_read_b64_tr_b16 a[74:75], v116 offset:10240
v_cvt_pk_bf16_f32 v68, v68, v69
v_mfma_f32_16x16x32_bf16 v[88:91], a[120:123], v[224:227], v[88:91]
s_waitcnt lgkmcnt(6)
ds_read_b64_tr_b16 a[76:77], v116 offset:12288
v_cvt_pk_bf16_f32 v69, v70, v71
v_mfma_f32_16x16x32_bf16 v[88:91], a[124:127], v[240:243], v[88:91]
ds_read_b64_tr_b16 a[78:79], v116 offset:14336
v_cvt_pk_bf16_f32 v70, v76, v77
v_mfma_f32_16x16x32_bf16 v[92:95], a[96:99], v[132:135], 0
ds_read_b64_tr_b16 a[80:81], v116 offset:16384
v_cvt_pk_bf16_f32 v71, v78, v79
v_mfma_f32_16x16x32_bf16 v[92:95], a[100:103], v[148:151], v[92:95]
buffer_store_dwordx4 v[68:71], v1, s[4:7], s12 offen offset:2048 sc1
ds_read_b64_tr_b16 a[82:83], v116 offset:18432
v_mfma_f32_16x16x32_bf16 v[92:95], a[104:107], v[164:167], v[92:95]
ds_read_b64_tr_b16 a[84:85], v116 offset:20480
v_lshlrev_b32 v19, 2, v19
v_mfma_f32_16x16x32_bf16 v[92:95], a[108:111], v[180:183], v[92:95]
ds_read_b64_tr_b16 a[86:87], v116 offset:22528
v_mfma_f32_16x16x32_bf16 v[92:95], a[112:115], v[196:199], v[92:95]
ds_read_b64_tr_b16 a[88:89], v116 offset:24576
v_mfma_f32_16x16x32_bf16 v[92:95], a[116:119], v[212:215], v[92:95]
ds_read_b64_tr_b16 a[90:91], v116 offset:26624
v_mfma_f32_16x16x32_bf16 v[92:95], a[120:123], v[228:231], v[92:95]
ds_read_b64_tr_b16 a[92:93], v116 offset:28672
v_mfma_f32_16x16x32_bf16 v[92:95], a[124:127], v[244:247], v[92:95]
s_waitcnt lgkmcnt(8)
ds_read_b64_tr_b16 a[94:95], v116 offset:30720
v_mfma_f32_16x16x32_bf16 v[32:35], a[64:67], v[128:131], 0
ds_read_b64_tr_b16 a[96:97], v117 offset:0
v_mul_f32 v80, v80, v24
v_mfma_f32_16x16x32_bf16 v[32:35], a[68:71], v[144:147], v[32:35]
ds_read_b64_tr_b16 a[98:99], v117 offset:2048
v_mul_f32 v81, v81, v24
v_mfma_f32_16x16x32_bf16 v[32:35], a[72:75], v[160:163], v[32:35]
s_waitcnt lgkmcnt(8)
ds_read_b64_tr_b16 a[100:101], v117 offset:4096
v_mul_f32 v82, v82, v24
v_mfma_f32_16x16x32_bf16 v[32:35], a[76:79], v[176:179], v[32:35]
ds_read_b64_tr_b16 a[102:103], v117 offset:6144
v_mul_f32 v83, v83, v24
v_mfma_f32_16x16x32_bf16 v[32:35], a[80:83], v[192:195], v[32:35]
s_waitcnt lgkmcnt(8)
ds_read_b64_tr_b16 a[104:105], v117 offset:8192
v_mul_f32 v88, v88, v24
v_mfma_f32_16x16x32_bf16 v[32:35], a[84:87], v[208:211], v[32:35]
s_waitcnt lgkmcnt(7)
ds_read_b64_tr_b16 a[106:107], v117 offset:10240
v_mul_f32 v89, v89, v24
v_mfma_f32_16x16x32_bf16 v[32:35], a[88:91], v[224:227], v[32:35]
s_waitcnt lgkmcnt(6)
ds_read_b64_tr_b16 a[108:109], v117 offset:12288
v_mul_f32 v90, v90, v24
v_mfma_f32_16x16x32_bf16 v[32:35], a[92:95], v[240:243], v[32:35]
ds_read_b64_tr_b16 a[110:111], v117 offset:14336
v_mul_f32 v91, v91, v24
v_mfma_f32_16x16x32_bf16 v[36:39], a[64:67], v[132:135], 0
ds_read_b64_tr_b16 a[112:113], v117 offset:16384
v_cvt_pk_bf16_f32 v80, v80, v81
v_mfma_f32_16x16x32_bf16 v[36:39], a[68:71], v[148:151], v[36:39]
ds_read_b64_tr_b16 a[114:115], v117 offset:18432
v_cvt_pk_bf16_f32 v81, v82, v83
v_mfma_f32_16x16x32_bf16 v[36:39], a[72:75], v[164:167], v[36:39]
ds_read_b64_tr_b16 a[116:117], v117 offset:20480
v_cvt_pk_bf16_f32 v82, v88, v89
v_mfma_f32_16x16x32_bf16 v[36:39], a[76:79], v[180:183], v[36:39]
ds_read_b64_tr_b16 a[118:119], v117 offset:22528
v_cvt_pk_bf16_f32 v83, v90, v91
v_mfma_f32_16x16x32_bf16 v[36:39], a[80:83], v[196:199], v[36:39]
buffer_store_dwordx4 v[80:83], v1, s[4:7], s8 offen offset:3072 sc1
ds_read_b64_tr_b16 a[120:121], v117 offset:24576
v_mfma_f32_16x16x32_bf16 v[36:39], a[84:87], v[212:215], v[36:39]
ds_read_b64_tr_b16 a[122:123], v117 offset:26624
v_mul_f32 v84, v84, v25
v_mfma_f32_16x16x32_bf16 v[36:39], a[88:91], v[228:231], v[36:39]
ds_read_b64_tr_b16 a[124:125], v117 offset:28672
v_mul_f32 v85, v85, v25
v_mfma_f32_16x16x32_bf16 v[36:39], a[92:95], v[244:247], v[36:39]
s_waitcnt lgkmcnt(8)
ds_read_b64_tr_b16 a[126:127], v117 offset:30720
v_mul_f32 v86, v86, v25
v_mfma_f32_16x16x32_bf16 v[40:43], a[96:99], v[128:131], 0
ds_read_b64_tr_b16 a[64:65], v118 offset:0
v_mul_f32 v87, v87, v25
v_mfma_f32_16x16x32_bf16 v[40:43], a[100:103], v[144:147], v[40:43]
ds_read_b64_tr_b16 a[66:67], v118 offset:2048
v_mul_f32 v92, v92, v25
v_mfma_f32_16x16x32_bf16 v[40:43], a[104:107], v[160:163], v[40:43]
s_waitcnt lgkmcnt(8)
ds_read_b64_tr_b16 a[68:69], v118 offset:4096
v_mul_f32 v93, v93, v25
v_mfma_f32_16x16x32_bf16 v[40:43], a[108:111], v[176:179], v[40:43]
ds_read_b64_tr_b16 a[70:71], v118 offset:6144
v_mul_f32 v94, v94, v25
v_mfma_f32_16x16x32_bf16 v[40:43], a[112:115], v[192:195], v[40:43]
s_waitcnt lgkmcnt(8)
ds_read_b64_tr_b16 a[72:73], v118 offset:8192
v_mul_f32 v95, v95, v25
v_mfma_f32_16x16x32_bf16 v[40:43], a[116:119], v[208:211], v[40:43]
s_waitcnt lgkmcnt(7)
ds_read_b64_tr_b16 a[74:75], v118 offset:10240
v_cvt_pk_bf16_f32 v84, v84, v85
v_mfma_f32_16x16x32_bf16 v[40:43], a[120:123], v[224:227], v[40:43]
s_waitcnt lgkmcnt(6)
ds_read_b64_tr_b16 a[76:77], v118 offset:12288
v_cvt_pk_bf16_f32 v85, v86, v87
v_mfma_f32_16x16x32_bf16 v[40:43], a[124:127], v[240:243], v[40:43]
ds_read_b64_tr_b16 a[78:79], v118 offset:14336
v_cvt_pk_bf16_f32 v86, v92, v93
v_mfma_f32_16x16x32_bf16 v[44:47], a[96:99], v[132:135], 0
ds_read_b64_tr_b16 a[80:81], v118 offset:16384
v_cvt_pk_bf16_f32 v87, v94, v95
v_mfma_f32_16x16x32_bf16 v[44:47], a[100:103], v[148:151], v[44:47]
buffer_store_dwordx4 v[84:87], v1, s[4:7], s12 offen offset:3072 sc1
ds_read_b64_tr_b16 a[82:83], v118 offset:18432
v_mfma_f32_16x16x32_bf16 v[44:47], a[104:107], v[164:167], v[44:47]
s_add_u32 s8, s8, 4096
s_add_u32 s12, s12, 4096
ds_read_b64_tr_b16 a[84:85], v118 offset:20480
v_mfma_f32_16x16x32_bf16 v[44:47], a[108:111], v[180:183], v[44:47]
ds_read_b64_tr_b16 a[86:87], v118 offset:22528
v_lshrrev_b32 v22, 4, v20
v_mfma_f32_16x16x32_bf16 v[44:47], a[112:115], v[196:199], v[44:47]
ds_read_b64_tr_b16 a[88:89], v118 offset:24576
v_mul_f32 v32, v32, v24
v_mfma_f32_16x16x32_bf16 v[44:47], a[116:119], v[212:215], v[44:47]
ds_read_b64_tr_b16 a[90:91], v118 offset:26624
v_mul_f32 v33, v33, v24
v_mfma_f32_16x16x32_bf16 v[44:47], a[120:123], v[228:231], v[44:47]
ds_read_b64_tr_b16 a[92:93], v118 offset:28672
v_mul_f32 v34, v34, v24
v_mfma_f32_16x16x32_bf16 v[44:47], a[124:127], v[244:247], v[44:47]
s_waitcnt lgkmcnt(8)
ds_read_b64_tr_b16 a[94:95], v118 offset:30720
v_mul_f32 v35, v35, v24
v_mfma_f32_16x16x32_bf16 v[48:51], a[64:67], v[128:131], 0
ds_read_b64_tr_b16 a[96:97], v119 offset:0
v_mul_f32 v40, v40, v24
v_mfma_f32_16x16x32_bf16 v[48:51], a[68:71], v[144:147], v[48:51]
ds_read_b64_tr_b16 a[98:99], v119 offset:2048
v_mul_f32 v41, v41, v24
v_mfma_f32_16x16x32_bf16 v[48:51], a[72:75], v[160:163], v[48:51]
s_waitcnt lgkmcnt(8)
ds_read_b64_tr_b16 a[100:101], v119 offset:4096
v_mul_f32 v42, v42, v24
v_mfma_f32_16x16x32_bf16 v[48:51], a[76:79], v[176:179], v[48:51]
ds_read_b64_tr_b16 a[102:103], v119 offset:6144
v_mul_f32 v43, v43, v24
v_mfma_f32_16x16x32_bf16 v[48:51], a[80:83], v[192:195], v[48:51]
s_waitcnt lgkmcnt(8)
ds_read_b64_tr_b16 a[104:105], v119 offset:8192
v_cvt_pk_bf16_f32 v32, v32, v33
v_mfma_f32_16x16x32_bf16 v[48:51], a[84:87], v[208:211], v[48:51]
s_waitcnt lgkmcnt(7)
ds_read_b64_tr_b16 a[106:107], v119 offset:10240
v_cvt_pk_bf16_f32 v33, v34, v35
v_mfma_f32_16x16x32_bf16 v[48:51], a[88:91], v[224:227], v[48:51]
s_waitcnt lgkmcnt(6)
ds_read_b64_tr_b16 a[108:109], v119 offset:12288
v_cvt_pk_bf16_f32 v34, v40, v41
v_mfma_f32_16x16x32_bf16 v[48:51], a[92:95], v[240:243], v[48:51]
ds_read_b64_tr_b16 a[110:111], v119 offset:14336
v_cvt_pk_bf16_f32 v35, v42, v43
v_mfma_f32_16x16x32_bf16 v[52:55], a[64:67], v[132:135], 0
buffer_store_dwordx4 v[32:35], v1, s[4:7], s8 offen offset:0 sc1
ds_read_b64_tr_b16 a[112:113], v119 offset:16384
v_mfma_f32_16x16x32_bf16 v[52:55], a[68:71], v[148:151], v[52:55]
ds_read_b64_tr_b16 a[114:115], v119 offset:18432
v_mul_f32 v36, v36, v25
v_mfma_f32_16x16x32_bf16 v[52:55], a[72:75], v[164:167], v[52:55]
ds_read_b64_tr_b16 a[116:117], v119 offset:20480
v_mul_f32 v37, v37, v25
v_mfma_f32_16x16x32_bf16 v[52:55], a[76:79], v[180:183], v[52:55]
ds_read_b64_tr_b16 a[118:119], v119 offset:22528
v_mul_f32 v38, v38, v25
v_mfma_f32_16x16x32_bf16 v[52:55], a[80:83], v[196:199], v[52:55]
ds_read_b64_tr_b16 a[120:121], v119 offset:24576
v_mul_f32 v39, v39, v25
v_mfma_f32_16x16x32_bf16 v[52:55], a[84:87], v[212:215], v[52:55]
ds_read_b64_tr_b16 a[122:123], v119 offset:26624
v_mul_f32 v44, v44, v25
v_mfma_f32_16x16x32_bf16 v[52:55], a[88:91], v[228:231], v[52:55]
ds_read_b64_tr_b16 a[124:125], v119 offset:28672
ds_read_b64_tr_b16 a[126:127], v119 offset:30720
v_mfma_f32_16x16x32_bf16 v[52:55], a[92:95], v[244:247], v[52:55]
s_waitcnt lgkmcnt(9)
v_mul_f32 v45, v45, v25
v_mul_f32 v46, v46, v25
v_mfma_f32_16x16x32_bf16 v[56:59], a[96:99], v[128:131], 0
v_mul_f32 v47, v47, v25
v_cvt_pk_bf16_f32 v36, v36, v37
v_mfma_f32_16x16x32_bf16 v[56:59], a[100:103], v[144:147], v[56:59]
v_cvt_pk_bf16_f32 v37, v38, v39
v_cvt_pk_bf16_f32 v38, v44, v45
v_mfma_f32_16x16x32_bf16 v[56:59], a[104:107], v[160:163], v[56:59]
s_waitcnt lgkmcnt(6)
v_cvt_pk_bf16_f32 v39, v46, v47
v_lshl_add_u32 v21, v22, 3, v21
v_mfma_f32_16x16x32_bf16 v[56:59], a[108:111], v[176:179], v[56:59]
buffer_store_dwordx4 v[36:39], v1, s[4:7], s12 offen offset:0 sc1
v_mfma_f32_16x16x32_bf16 v[56:59], a[112:115], v[192:195], v[56:59]
s_waitcnt lgkmcnt(4)
v_mfma_f32_16x16x32_bf16 v[56:59], a[116:119], v[208:211], v[56:59]
s_waitcnt lgkmcnt(2)
v_mfma_f32_16x16x32_bf16 v[56:59], a[120:123], v[224:227], v[56:59]
s_waitcnt lgkmcnt(0)
v_mfma_f32_16x16x32_bf16 v[56:59], a[124:127], v[240:243], v[56:59]
v_mfma_f32_16x16x32_bf16 v[60:63], a[96:99], v[132:135], 0
v_mfma_f32_16x16x32_bf16 v[60:63], a[100:103], v[148:151], v[60:63]
v_mfma_f32_16x16x32_bf16 v[60:63], a[104:107], v[164:167], v[60:63]
v_mfma_f32_16x16x32_bf16 v[60:63], a[108:111], v[180:183], v[60:63]
v_mfma_f32_16x16x32_bf16 v[60:63], a[112:115], v[196:199], v[60:63]
buffer_load_dword v18, v19, s[4:7], s33 offen offset:0 sc1
v_mfma_f32_16x16x32_bf16 v[60:63], a[116:119], v[212:215], v[60:63]
v_mfma_f32_16x16x32_bf16 v[60:63], a[120:123], v[228:231], v[60:63]
v_mfma_f32_16x16x32_bf16 v[60:63], a[124:127], v[244:247], v[60:63]
v_mul_f32 v48, v48, v24
v_mul_f32 v49, v49, v24
v_mul_f32 v50, v50, v24
v_mul_f32 v51, v51, v24
v_mul_f32 v56, v56, v24
v_mul_f32 v57, v57, v24
v_mul_f32 v58, v58, v24
v_mul_f32 v59, v59, v24
v_cvt_pk_bf16_f32 v48, v48, v49
v_cvt_pk_bf16_f32 v49, v50, v51
v_cvt_pk_bf16_f32 v50, v56, v57
v_cvt_pk_bf16_f32 v51, v58, v59
buffer_store_dwordx4 v[48:51], v1, s[4:7], s8 offen offset:1024 sc1
v_mul_f32 v52, v52, v25
v_mul_f32 v53, v53, v25
v_mul_f32 v54, v54, v25
v_mul_f32 v55, v55, v25
v_mul_f32 v60, v60, v25
v_mul_f32 v61, v61, v25
v_mul_f32 v62, v62, v25
v_mul_f32 v63, v63, v25
v_cvt_pk_bf16_f32 v52, v52, v53
v_cvt_pk_bf16_f32 v53, v54, v55
v_cvt_pk_bf16_f32 v54, v60, v61
v_cvt_pk_bf16_f32 v55, v62, v63
buffer_store_dwordx4 v[52:55], v1, s[4:7], s12 offen offset:1024 sc1
s_and_b32 s22, s2, 224
s_cmp_eq_u32 s22, 224
s_cbranch_scc1 M_final
s_waitcnt vmcnt(0)
s_barrier
buffer_store_dword v6, v5, s[4:7], s35 offen sc1
s_bitcmp0_b32 s2, 4
s_cbranch_scc1 M_rA
v_cmp_gt_u32 vcc, 1, v18
s_cbranch_vccnz M_rslow
M_rjoin:
buffer_load_dwordx4 v[128:131], v1, s[4:7], s26 offen sc1
s_add_u32 s26, s26, 14336
buffer_load_dwordx4 v[132:135], v1, s[4:7], s26 offen sc1
s_add_u32 s26, s26, 14336
buffer_load_dwordx4 v[136:139], v1, s[4:7], s26 offen sc1
s_add_u32 s26, s26, 14336
buffer_load_dwordx4 v[140:143], v1, s[4:7], s26 offen sc1
s_add_u32 s26, s26, 14336
buffer_load_dwordx4 v[144:147], v1, s[4:7], s26 offen sc1
s_add_u32 s26, s26, 14336
buffer_load_dwordx4 v[148:151], v1, s[4:7], s26 offen sc1
s_add_u32 s26, s26, 14336
buffer_load_dwordx4 v[152:155], v1, s[4:7], s26 offen sc1
s_add_u32 s26, s26, 14336
buffer_load_dwordx4 v[156:159], v1, s[4:7], s26 offen sc1
s_add_u32 s26, s26, 14336
buffer_load_dwordx4 v[160:163], v1, s[4:7], s26 offen sc1
s_add_u32 s26, s26, 14336
buffer_load_dwordx4 v[164:167], v1, s[4:7], s26 offen sc1
s_add_u32 s26, s26, 14336
buffer_load_dwordx4 v[168:171], v1, s[4:7], s26 offen sc1
s_add_u32 s26, s26, 14336
buffer_load_dwordx4 v[172:175], v1, s[4:7], s26 offen sc1
s_add_u32 s26, s26, 14336
buffer_load_dwordx4 v[176:179], v1, s[4:7], s26 offen sc1
s_add_u32 s26, s26, 14336
buffer_load_dwordx4 v[180:183], v1, s[4:7], s26 offen sc1
s_add_u32 s26, s26, 14336
buffer_load_dwordx4 v[184:187], v1, s[4:7], s26 offen sc1
s_add_u32 s26, s26, 14336
buffer_load_dwordx4 v[188:191], v1, s[4:7], s26 offen sc1
Lp_9201:
buffer_load_dword v18, v19, s[4:7], s33 offen offset:2048 sc1
s_waitcnt vmcnt(0)
v_cmp_gt_u32 vcc, 1, v18
s_cbranch_vccz Lpd_9202
s_sleep 8
s_sub_u32 s101, s101, 1
s_cbranch_scc0 Lp_9201
s_mov_b32 s101, 0
Lpd_9202:
s_sub_u32 s26, s26, 207872
buffer_load_dwordx4 v[192:195], v1, s[4:7], s26 offen sc1
s_add_u32 s26, s26, 14336
buffer_load_dwordx4 v[196:199], v1, s[4:7], s26 offen sc1
s_add_u32 s26, s26, 14336
buffer_load_dwordx4 v[200:203], v1, s[4:7], s26 offen sc1
s_add_u32 s26, s26, 14336
buffer_load_dwordx4 v[204:207], v1, s[4:7], s26 offen sc1
s_add_u32 s26, s26, 14336
buffer_load_dwordx4 v[208:211], v1, s[4:7], s26 offen sc1
s_add_u32 s26, s26, 14336
buffer_load_dwordx4 v[212:215], v1, s[4:7], s26 offen sc1
s_add_u32 s26, s26, 14336
buffer_load_dwordx4 v[216:219], v1, s[4:7], s26 offen sc1
s_add_u32 s26, s26, 14336
buffer_load_dwordx4 v[220:223], v1, s[4:7], s26 offen sc1
s_add_u32 s26, s26, 14336
buffer_load_dwordx4 v[224:227], v1, s[4:7], s26 offen sc1
s_add_u32 s26, s26, 14336
buffer_load_dwordx4 v[228:231], v1, s[4:7], s26 offen sc1
s_add_u32 s26, s26, 14336
buffer_load_dwordx4 v[232:235], v1, s[4:7], s26 offen sc1
s_add_u32 s26, s26, 14336
buffer_load_dwordx4 v[236:239], v1, s[4:7], s26 offen sc1
s_add_u32 s26, s26, 14336
buffer_load_dwordx4 v[240:243], v1, s[4:7], s26 offen sc1
s_add_u32 s26, s26, 14336
buffer_load_dwordx4 v[244:247], v1, s[4:7], s26 offen sc1
s_add_u32 s26, s26, 14336
buffer_load_dwordx4 v[248:251], v1, s[4:7], s26 offen sc1
s_add_u32 s26, s26, 14336
buffer_load_dwordx4 v[252:255], v1, s[4:7], s26 offen sc1
v_lshlrev_b32 v96, 16, v128
v_and_b32 v97, 0xffff0000, v128
v_lshlrev_b32 v98, 16, v129
v_and_b32 v99, 0xffff0000, v129
v_lshlrev_b32 v100, 16, v130
v_and_b32 v101, 0xffff0000, v130
v_lshlrev_b32 v102, 16, v131
v_and_b32 v103, 0xffff0000, v131
v_lshlrev_b32 v10, 16, v132
v_and_b32 v11, 0xffff0000, v132
v_lshlrev_b32 v12, 16, v133
v_and_b32 v13, 0xffff0000, v133
v_lshlrev_b32 v14, 16, v134
v_and_b32 v15, 0xffff0000, v134
v_lshlrev_b32 v16, 16, v135
v_and_b32 v17, 0xffff0000, v135
v_pk_add_f32 v[96:97], v[96:97], v[10:11]
v_pk_add_f32 v[98:99], v[98:99], v[12:13]
v_pk_add_f32 v[100:101], v[100:101], v[14:15]
v_pk_add_f32 v[102:103], v[102:103], v[16:17]
v_lshlrev_b32 v10, 16, v136
v_and_b32 v11, 0xffff0000, v136
v_lshlrev_b32 v12, 16, v137
v_and_b32 v13, 0xffff0000, v137
v_lshlrev_b32 v14, 16, v138
v_and_b32 v15, 0xffff0000, v138
v_lshlrev_b32 v16, 16, v139
v_and_b32 v17, 0xffff0000, v139
v_pk_add_f32 v[96:97], v[96:97], v[10:11]
v_pk_add_f32 v[98:99], v[98:99], v[12:13]
v_pk_add_f32 v[100:101], v[100:101], v[14:15]
v_pk_add_f32 v[102:103], v[102:103], v[16:17]
v_lshlrev_b32 v10, 16, v140
v_and_b32 v11, 0xffff0000, v140
v_lshlrev_b32 v12, 16, v141
v_and_b32 v13, 0xffff0000, v141
v_lshlrev_b32 v14, 16, v142
v_and_b32 v15, 0xffff0000, v142
v_lshlrev_b32 v16, 16, v143
v_and_b32 v17, 0xffff0000, v143
v_pk_add_f32 v[96:97], v[96:97], v[10:11]
v_pk_add_f32 v[98:99], v[98:99], v[12:13]
v_pk_add_f32 v[100:101], v[100:101], v[14:15]
v_pk_add_f32 v[102:103], v[102:103], v[16:17]
v_lshlrev_b32 v10, 16, v144
v_and_b32 v11, 0xffff0000, v144
v_lshlrev_b32 v12, 16, v145
v_and_b32 v13, 0xffff0000, v145
v_lshlrev_b32 v14, 16, v146
v_and_b32 v15, 0xffff0000, v146
v_lshlrev_b32 v16, 16, v147
v_and_b32 v17, 0xffff0000, v147
v_pk_add_f32 v[96:97], v[96:97], v[10:11]
v_pk_add_f32 v[98:99], v[98:99], v[12:13]
v_pk_add_f32 v[100:101], v[100:101], v[14:15]
v_pk_add_f32 v[102:103], v[102:103], v[16:17]
v_lshlrev_b32 v10, 16, v148
v_and_b32 v11, 0xffff0000, v148
v_lshlrev_b32 v12, 16, v149
v_and_b32 v13, 0xffff0000, v149
v_lshlrev_b32 v14, 16, v150
v_and_b32 v15, 0xffff0000, v150
v_lshlrev_b32 v16, 16, v151
v_and_b32 v17, 0xffff0000, v151
v_pk_add_f32 v[96:97], v[96:97], v[10:11]
v_pk_add_f32 v[98:99], v[98:99], v[12:13]
v_pk_add_f32 v[100:101], v[100:101], v[14:15]
v_pk_add_f32 v[102:103], v[102:103], v[16:17]
v_lshlrev_b32 v10, 16, v152
v_and_b32 v11, 0xffff0000, v152
v_lshlrev_b32 v12, 16, v153
v_and_b32 v13, 0xffff0000, v153
v_lshlrev_b32 v14, 16, v154
v_and_b32 v15, 0xffff0000, v154
v_lshlrev_b32 v16, 16, v155
v_and_b32 v17, 0xffff0000, v155
v_pk_add_f32 v[96:97], v[96:97], v[10:11]
v_pk_add_f32 v[98:99], v[98:99], v[12:13]
v_pk_add_f32 v[100:101], v[100:101], v[14:15]
v_pk_add_f32 v[102:103], v[102:103], v[16:17]
v_lshlrev_b32 v10, 16, v156
v_and_b32 v11, 0xffff0000, v156
v_lshlrev_b32 v12, 16, v157
v_and_b32 v13, 0xffff0000, v157
v_lshlrev_b32 v14, 16, v158
v_and_b32 v15, 0xffff0000, v158
v_lshlrev_b32 v16, 16, v159
v_and_b32 v17, 0xffff0000, v159
v_pk_add_f32 v[96:97], v[96:97], v[10:11]
v_pk_add_f32 v[98:99], v[98:99], v[12:13]
v_pk_add_f32 v[100:101], v[100:101], v[14:15]
v_pk_add_f32 v[102:103], v[102:103], v[16:17]
v_lshlrev_b32 v10, 16, v160
v_and_b32 v11, 0xffff0000, v160
v_lshlrev_b32 v12, 16, v161
v_and_b32 v13, 0xffff0000, v161
v_lshlrev_b32 v14, 16, v162
v_and_b32 v15, 0xffff0000, v162
v_lshlrev_b32 v16, 16, v163
v_and_b32 v17, 0xffff0000, v163
v_pk_add_f32 v[96:97], v[96:97], v[10:11]
v_pk_add_f32 v[98:99], v[98:99], v[12:13]
v_pk_add_f32 v[100:101], v[100:101], v[14:15]
v_pk_add_f32 v[102:103], v[102:103], v[16:17]
v_lshlrev_b32 v10, 16, v164
v_and_b32 v11, 0xffff0000, v164
v_lshlrev_b32 v12, 16, v165
v_and_b32 v13, 0xffff0000, v165
v_lshlrev_b32 v14, 16, v166
v_and_b32 v15, 0xffff0000, v166
v_lshlrev_b32 v16, 16, v167
v_and_b32 v17, 0xffff0000, v167
v_pk_add_f32 v[96:97], v[96:97], v[10:11]
v_pk_add_f32 v[98:99], v[98:99], v[12:13]
v_pk_add_f32 v[100:101], v[100:101], v[14:15]
v_pk_add_f32 v[102:103], v[102:103], v[16:17]
v_lshlrev_b32 v10, 16, v168
v_and_b32 v11, 0xffff0000, v168
v_lshlrev_b32 v12, 16, v169
v_and_b32 v13, 0xffff0000, v169
v_lshlrev_b32 v14, 16, v170
v_and_b32 v15, 0xffff0000, v170
v_lshlrev_b32 v16, 16, v171
v_and_b32 v17, 0xffff0000, v171
v_pk_add_f32 v[96:97], v[96:97], v[10:11]
v_pk_add_f32 v[98:99], v[98:99], v[12:13]
v_pk_add_f32 v[100:101], v[100:101], v[14:15]
v_pk_add_f32 v[102:103], v[102:103], v[16:17]
v_lshlrev_b32 v10, 16, v172
v_and_b32 v11, 0xffff0000, v172
v_lshlrev_b32 v12, 16, v173
v_and_b32 v13, 0xffff0000, v173
v_lshlrev_b32 v14, 16, v174
v_and_b32 v15, 0xffff0000, v174
v_lshlrev_b32 v16, 16, v175
v_and_b32 v17, 0xffff0000, v175
v_pk_add_f32 v[96:97], v[96:97], v[10:11]
v_pk_add_f32 v[98:99], v[98:99], v[12:13]
v_pk_add_f32 v[100:101], v[100:101], v[14:15]
v_pk_add_f32 v[102:103], v[102:103], v[16:17]
v_lshlrev_b32 v10, 16, v176
v_and_b32 v11, 0xffff0000, v176
v_lshlrev_b32 v12, 16, v177
v_and_b32 v13, 0xffff0000, v177
v_lshlrev_b32 v14, 16, v178
v_and_b32 v15, 0xffff0000, v178
v_lshlrev_b32 v16, 16, v179
v_and_b32 v17, 0xffff0000, v179
v_pk_add_f32 v[96:97], v[96:97], v[10:11]
v_pk_add_f32 v[98:99], v[98:99], v[12:13]
v_pk_add_f32 v[100:101], v[100:101], v[14:15]
v_pk_add_f32 v[102:103], v[102:103], v[16:17]
v_lshlrev_b32 v10, 16, v180
v_and_b32 v11, 0xffff0000, v180
v_lshlrev_b32 v12, 16, v181
v_and_b32 v13, 0xffff0000, v181
v_lshlrev_b32 v14, 16, v182
v_and_b32 v15, 0xffff0000, v182
v_lshlrev_b32 v16, 16, v183
v_and_b32 v17, 0xffff0000, v183
v_pk_add_f32 v[96:97], v[96:97], v[10:11]
v_pk_add_f32 v[98:99], v[98:99], v[12:13]
v_pk_add_f32 v[100:101], v[100:101], v[14:15]
v_pk_add_f32 v[102:103], v[102:103], v[16:17]
v_lshlrev_b32 v10, 16, v184
v_and_b32 v11, 0xffff0000, v184
v_lshlrev_b32 v12, 16, v185
v_and_b32 v13, 0xffff0000, v185
v_lshlrev_b32 v14, 16, v186
v_and_b32 v15, 0xffff0000, v186
v_lshlrev_b32 v16, 16, v187
v_and_b32 v17, 0xffff0000, v187
v_pk_add_f32 v[96:97], v[96:97], v[10:11]
v_pk_add_f32 v[98:99], v[98:99], v[12:13]
v_pk_add_f32 v[100:101], v[100:101], v[14:15]
v_pk_add_f32 v[102:103], v[102:103], v[16:17]
v_lshlrev_b32 v10, 16, v188
v_and_b32 v11, 0xffff0000, v188
v_lshlrev_b32 v12, 16, v189
v_and_b32 v13, 0xffff0000, v189
v_lshlrev_b32 v14, 16, v190
v_and_b32 v15, 0xffff0000, v190
v_lshlrev_b32 v16, 16, v191
v_and_b32 v17, 0xffff0000, v191
v_pk_add_f32 v[96:97], v[96:97], v[10:11]
v_pk_add_f32 v[98:99], v[98:99], v[12:13]
v_pk_add_f32 v[100:101], v[100:101], v[14:15]
v_pk_add_f32 v[102:103], v[102:103], v[16:17]
v_cvt_pk_bf16_f32 v96, v96, v97
v_cvt_pk_bf16_f32 v97, v98, v99
v_cvt_pk_bf16_f32 v98, v100, v101
v_cvt_pk_bf16_f32 v99, v102, v103
buffer_store_dwordx2 v[96:97], v21, s[40:43], s25 offen offset:896
buffer_store_dwordx2 v[98:99], v21, s[40:43], s25 offen offset:928
s_waitcnt vmcnt(17)
v_lshlrev_b32 v104, 16, v192
v_and_b32 v105, 0xffff0000, v192
v_lshlrev_b32 v106, 16, v193
v_and_b32 v107, 0xffff0000, v193
v_lshlrev_b32 v108, 16, v194
v_and_b32 v109, 0xffff0000, v194
v_lshlrev_b32 v110, 16, v195
v_and_b32 v111, 0xffff0000, v195
s_waitcnt vmcnt(16)
v_lshlrev_b32 v10, 16, v196
v_and_b32 v11, 0xffff0000, v196
v_lshlrev_b32 v12, 16, v197
v_and_b32 v13, 0xffff0000, v197
v_lshlrev_b32 v14, 16, v198
v_and_b32 v15, 0xffff0000, v198
v_lshlrev_b32 v16, 16, v199
v_and_b32 v17, 0xffff0000, v199
v_pk_add_f32 v[104:105], v[104:105], v[10:11]
v_pk_add_f32 v[106:107], v[106:107], v[12:13]
v_pk_add_f32 v[108:109], v[108:109], v[14:15]
v_pk_add_f32 v[110:111], v[110:111], v[16:17]
PAD_17:
s_cbranch_execz M_tret
s_waitcnt vmcnt(15)
v_lshlrev_b32 v10, 16, v200
v_and_b32 v11, 0xffff0000, v200
v_lshlrev_b32 v12, 16, v201
v_and_b32 v13, 0xffff0000, v201
v_lshlrev_b32 v14, 16, v202
v_and_b32 v15, 0xffff0000, v202
v_lshlrev_b32 v16, 16, v203
v_and_b32 v17, 0xffff0000, v203
v_pk_add_f32 v[104:105], v[104:105], v[10:11]
v_pk_add_f32 v[106:107], v[106:107], v[12:13]
v_pk_add_f32 v[108:109], v[108:109], v[14:15]
v_pk_add_f32 v[110:111], v[110:111], v[16:17]
s_waitcnt vmcnt(14)
v_lshlrev_b32 v10, 16, v204
v_and_b32 v11, 0xffff0000, v204
v_lshlrev_b32 v12, 16, v205
v_and_b32 v13, 0xffff0000, v205
v_lshlrev_b32 v14, 16, v206
v_and_b32 v15, 0xffff0000, v206
v_lshlrev_b32 v16, 16, v207
v_and_b32 v17, 0xffff0000, v207
v_pk_add_f32 v[104:105], v[104:105], v[10:11]
v_pk_add_f32 v[106:107], v[106:107], v[12:13]
v_pk_add_f32 v[108:109], v[108:109], v[14:15]
v_pk_add_f32 v[110:111], v[110:111], v[16:17]
s_waitcnt vmcnt(13)
v_lshlrev_b32 v10, 16, v208
v_and_b32 v11, 0xffff0000, v208
v_lshlrev_b32 v12, 16, v209
v_and_b32 v13, 0xffff0000, v209
v_lshlrev_b32 v14, 16, v210
v_and_b32 v15, 0xffff0000, v210
v_lshlrev_b32 v16, 16, v211
v_and_b32 v17, 0xffff0000, v211
v_pk_add_f32 v[104:105], v[104:105], v[10:11]
v_pk_add_f32 v[106:107], v[106:107], v[12:13]
v_pk_add_f32 v[108:109], v[108:109], v[14:15]
v_pk_add_f32 v[110:111], v[110:111], v[16:17]
s_waitcnt vmcnt(12)
v_lshlrev_b32 v10, 16, v212
v_and_b32 v11, 0xffff0000, v212
v_lshlrev_b32 v12, 16, v213
v_and_b32 v13, 0xffff0000, v213
v_lshlrev_b32 v14, 16, v214
v_and_b32 v15, 0xffff0000, v214
v_lshlrev_b32 v16, 16, v215
v_and_b32 v17, 0xffff0000, v215
v_pk_add_f32 v[104:105], v[104:105], v[10:11]
v_pk_add_f32 v[106:107], v[106:107], v[12:13]
v_pk_add_f32 v[108:109], v[108:109], v[14:15]
v_pk_add_f32 v[110:111], v[110:111], v[16:17]
s_waitcnt vmcnt(11)
v_lshlrev_b32 v10, 16, v216
v_and_b32 v11, 0xffff0000, v216
v_lshlrev_b32 v12, 16, v217
v_and_b32 v13, 0xffff0000, v217
v_lshlrev_b32 v14, 16, v218
v_and_b32 v15, 0xffff0000, v218
v_lshlrev_b32 v16, 16, v219
v_and_b32 v17, 0xffff0000, v219
v_pk_add_f32 v[104:105], v[104:105], v[10:11]
v_pk_add_f32 v[106:107], v[106:107], v[12:13]
v_pk_add_f32 v[108:109], v[108:109], v[14:15]
v_pk_add_f32 v[110:111], v[110:111], v[16:17]
s_waitcnt vmcnt(10)
v_lshlrev_b32 v10, 16, v220
v_and_b32 v11, 0xffff0000, v220
v_lshlrev_b32 v12, 16, v221
v_and_b32 v13, 0xffff0000, v221
v_lshlrev_b32 v14, 16, v222
v_and_b32 v15, 0xffff0000, v222
v_lshlrev_b32 v16, 16, v223
v_and_b32 v17, 0xffff0000, v223
v_pk_add_f32 v[104:105], v[104:105], v[10:11]
v_pk_add_f32 v[106:107], v[106:107], v[12:13]
v_pk_add_f32 v[108:109], v[108:109], v[14:15]
v_pk_add_f32 v[110:111], v[110:111], v[16:17]
s_waitcnt vmcnt(9)
v_lshlrev_b32 v10, 16, v224
v_and_b32 v11, 0xffff0000, v224
v_lshlrev_b32 v12, 16, v225
v_and_b32 v13, 0xffff0000, v225
v_lshlrev_b32 v14, 16, v226
v_and_b32 v15, 0xffff0000, v226
v_lshlrev_b32 v16, 16, v227
v_and_b32 v17, 0xffff0000, v227
v_pk_add_f32 v[104:105], v[104:105], v[10:11]
v_pk_add_f32 v[106:107], v[106:107], v[12:13]
v_pk_add_f32 v[108:109], v[108:109], v[14:15]
v_pk_add_f32 v[110:111], v[110:111], v[16:17]
s_waitcnt vmcnt(8)
v_lshlrev_b32 v10, 16, v228
v_and_b32 v11, 0xffff0000, v228
v_lshlrev_b32 v12, 16, v229
v_and_b32 v13, 0xffff0000, v229
v_lshlrev_b32 v14, 16, v230
v_and_b32 v15, 0xffff0000, v230
v_lshlrev_b32 v16, 16, v231
v_and_b32 v17, 0xffff0000, v231
v_pk_add_f32 v[104:105], v[104:105], v[10:11]
v_pk_add_f32 v[106:107], v[106:107], v[12:13]
v_pk_add_f32 v[108:109], v[108:109], v[14:15]
v_pk_add_f32 v[110:111], v[110:111], v[16:17]
s_waitcnt vmcnt(7)
v_lshlrev_b32 v10, 16, v232
v_and_b32 v11, 0xffff0000, v232
v_lshlrev_b32 v12, 16, v233
v_and_b32 v13, 0xffff0000, v233
v_lshlrev_b32 v14, 16, v234
v_and_b32 v15, 0xffff0000, v234
v_lshlrev_b32 v16, 16, v235
v_and_b32 v17, 0xffff0000, v235
v_pk_add_f32 v[104:105], v[104:105], v[10:11]
v_pk_add_f32 v[106:107], v[106:107], v[12:13]
v_pk_add_f32 v[108:109], v[108:109], v[14:15]
v_pk_add_f32 v[110:111], v[110:111], v[16:17]
s_waitcnt vmcnt(6)
v_lshlrev_b32 v10, 16, v236
v_and_b32 v11, 0xffff0000, v236
v_lshlrev_b32 v12, 16, v237
v_and_b32 v13, 0xffff0000, v237
v_lshlrev_b32 v14, 16, v238
v_and_b32 v15, 0xffff0000, v238
v_lshlrev_b32 v16, 16, v239
v_and_b32 v17, 0xffff0000, v239
v_pk_add_f32 v[104:105], v[104:105], v[10:11]
v_pk_add_f32 v[106:107], v[106:107], v[12:13]
v_pk_add_f32 v[108:109], v[108:109], v[14:15]
v_pk_add_f32 v[110:111], v[110:111], v[16:17]
s_waitcnt vmcnt(5)
v_lshlrev_b32 v10, 16, v240
v_and_b32 v11, 0xffff0000, v240
v_lshlrev_b32 v12, 16, v241
v_and_b32 v13, 0xffff0000, v241
v_lshlrev_b32 v14, 16, v242
v_and_b32 v15, 0xffff0000, v242
v_lshlrev_b32 v16, 16, v243
v_and_b32 v17, 0xffff0000, v243
v_pk_add_f32 v[104:105], v[104:105], v[10:11]
v_pk_add_f32 v[106:107], v[106:107], v[12:13]
v_pk_add_f32 v[108:109], v[108:109], v[14:15]
v_pk_add_f32 v[110:111], v[110:111], v[16:17]
s_waitcnt vmcnt(4)
v_lshlrev_b32 v10, 16, v244
v_and_b32 v11, 0xffff0000, v244
v_lshlrev_b32 v12, 16, v245
v_and_b32 v13, 0xffff0000, v245
v_lshlrev_b32 v14, 16, v246
v_and_b32 v15, 0xffff0000, v246
v_lshlrev_b32 v16, 16, v247
v_and_b32 v17, 0xffff0000, v247
v_pk_add_f32 v[104:105], v[104:105], v[10:11]
v_pk_add_f32 v[106:107], v[106:107], v[12:13]
v_pk_add_f32 v[108:109], v[108:109], v[14:15]
v_pk_add_f32 v[110:111], v[110:111], v[16:17]
s_waitcnt vmcnt(3)
v_lshlrev_b32 v10, 16, v248
v_and_b32 v11, 0xffff0000, v248
v_lshlrev_b32 v12, 16, v249
v_and_b32 v13, 0xffff0000, v249
v_lshlrev_b32 v14, 16, v250
v_and_b32 v15, 0xffff0000, v250
v_lshlrev_b32 v16, 16, v251
v_and_b32 v17, 0xffff0000, v251
v_pk_add_f32 v[104:105], v[104:105], v[10:11]
v_pk_add_f32 v[106:107], v[106:107], v[12:13]
v_pk_add_f32 v[108:109], v[108:109], v[14:15]
v_pk_add_f32 v[110:111], v[110:111], v[16:17]
s_waitcnt vmcnt(2)
v_lshlrev_b32 v10, 16, v252
v_and_b32 v11, 0xffff0000, v252
v_lshlrev_b32 v12, 16, v253
v_and_b32 v13, 0xffff0000, v253
v_lshlrev_b32 v14, 16, v254
v_and_b32 v15, 0xffff0000, v254
v_lshlrev_b32 v16, 16, v255
v_and_b32 v17, 0xffff0000, v255
v_pk_add_f32 v[104:105], v[104:105], v[10:11]
v_pk_add_f32 v[106:107], v[106:107], v[12:13]
v_pk_add_f32 v[108:109], v[108:109], v[14:15]
v_pk_add_f32 v[110:111], v[110:111], v[16:17]
v_cvt_pk_bf16_f32 v104, v104, v105
v_cvt_pk_bf16_f32 v105, v106, v107
v_cvt_pk_bf16_f32 v106, v108, v109
v_cvt_pk_bf16_f32 v107, v110, v111
buffer_store_dwordx2 v[104:105], v21, s[40:43], s25 offen offset:1344
buffer_store_dwordx2 v[106:107], v21, s[40:43], s25 offen offset:1376
s_add_u32 s25, s25, 1835008
s_add_u32 s26, s26, 14457856
s_add_u32 s33, s33, 1024
s_branch M_r1
PAD_18:
s_cbranch_execz M_tret
M_rA:
s_add_u32 s25, s25, 448
s_add_u32 s26, s26, 7168
s_add_u32 s33, s33, 2048
M_r1:
Lp_9203:
buffer_load_dword v18, v19, s[4:7], s33 offen offset:0 sc1
s_waitcnt vmcnt(0)
v_cmp_gt_u32 vcc, 1, v18
s_cbranch_vccz Lpd_9204
s_sleep 8
s_sub_u32 s101, s101, 1
s_cbranch_scc0 Lp_9203
s_mov_b32 s101, 0
Lpd_9204:
buffer_load_dwordx4 v[128:131], v1, s[4:7], s26 offen sc1
s_add_u32 s26, s26, 14336
buffer_load_dwordx4 v[132:135], v1, s[4:7], s26 offen sc1
s_add_u32 s26, s26, 14336
buffer_load_dwordx4 v[136:139], v1, s[4:7], s26 offen sc1
s_add_u32 s26, s26, 14336
buffer_load_dwordx4 v[140:143], v1, s[4:7], s26 offen sc1
s_add_u32 s26, s26, 14336
buffer_load_dwordx4 v[144:147], v1, s[4:7], s26 offen sc1
s_add_u32 s26, s26, 14336
buffer_load_dwordx4 v[148:151], v1, s[4:7], s26 offen sc1
s_add_u32 s26, s26, 14336
buffer_load_dwordx4 v[152:155], v1, s[4:7], s26 offen sc1
s_add_u32 s26, s26, 14336
buffer_load_dwordx4 v[156:159], v1, s[4:7], s26 offen sc1
s_add_u32 s26, s26, 14336
buffer_load_dwordx4 v[160:163], v1, s[4:7], s26 offen sc1
s_add_u32 s26, s26, 14336
buffer_load_dwordx4 v[164:167], v1, s[4:7], s26 offen sc1
s_add_u32 s26, s26, 14336
buffer_load_dwordx4 v[168:171], v1, s[4:7], s26 offen sc1
s_add_u32 s26, s26, 14336
buffer_load_dwordx4 v[172:175], v1, s[4:7], s26 offen sc1
s_add_u32 s26, s26, 14336
buffer_load_dwordx4 v[176:179], v1, s[4:7], s26 offen sc1
s_add_u32 s26, s26, 14336
buffer_load_dwordx4 v[180:183], v1, s[4:7], s26 offen sc1
s_add_u32 s26, s26, 14336
buffer_load_dwordx4 v[184:187], v1, s[4:7], s26 offen sc1
s_add_u32 s26, s26, 14336
buffer_load_dwordx4 v[188:191], v1, s[4:7], s26 offen sc1
s_waitcnt vmcnt(15)
v_lshlrev_b32 v96, 16, v128
v_and_b32 v97, 0xffff0000, v128
v_lshlrev_b32 v98, 16, v129
v_and_b32 v99, 0xffff0000, v129
v_lshlrev_b32 v100, 16, v130
v_and_b32 v101, 0xffff0000, v130
v_lshlrev_b32 v102, 16, v131
v_and_b32 v103, 0xffff0000, v131
s_waitcnt vmcnt(14)
v_lshlrev_b32 v10, 16, v132
v_and_b32 v11, 0xffff0000, v132
v_lshlrev_b32 v12, 16, v133
v_and_b32 v13, 0xffff0000, v133
v_lshlrev_b32 v14, 16, v134
v_and_b32 v15, 0xffff0000, v134
v_lshlrev_b32 v16, 16, v135
v_and_b32 v17, 0xffff0000, v135
v_pk_add_f32 v[96:97], v[96:97], v[10:11]
v_pk_add_f32 v[98:99], v[98:99], v[12:13]
v_pk_add_f32 v[100:101], v[100:101], v[14:15]
v_pk_add_f32 v[102:103], v[102:103], v[16:17]
s_waitcnt vmcnt(13)
v_lshlrev_b32 v10, 16, v136
v_and_b32 v11, 0xffff0000, v136
v_lshlrev_b32 v12, 16, v137
v_and_b32 v13, 0xffff0000, v137
v_lshlrev_b32 v14, 16, v138
v_and_b32 v15, 0xffff0000, v138
v_lshlrev_b32 v16, 16, v139
v_and_b32 v17, 0xffff0000, v139
v_pk_add_f32 v[96:97], v[96:97], v[10:11]
v_pk_add_f32 v[98:99], v[98:99], v[12:13]
v_pk_add_f32 v[100:101], v[100:101], v[14:15]
v_pk_add_f32 v[102:103], v[102:103], v[16:17]
s_waitcnt vmcnt(12)
v_lshlrev_b32 v10, 16, v140
v_and_b32 v11, 0xffff0000, v140
v_lshlrev_b32 v12, 16, v141
v_and_b32 v13, 0xffff0000, v141
v_lshlrev_b32 v14, 16, v142
v_and_b32 v15, 0xffff0000, v142
v_lshlrev_b32 v16, 16, v143
v_and_b32 v17, 0xffff0000, v143
v_pk_add_f32 v[96:97], v[96:97], v[10:11]
v_pk_add_f32 v[98:99], v[98:99], v[12:13]
v_pk_add_f32 v[100:101], v[100:101], v[14:15]
v_pk_add_f32 v[102:103], v[102:103], v[16:17]
s_waitcnt vmcnt(11)
v_lshlrev_b32 v10, 16, v144
v_and_b32 v11, 0xffff0000, v144
v_lshlrev_b32 v12, 16, v145
v_and_b32 v13, 0xffff0000, v145
v_lshlrev_b32 v14, 16, v146
v_and_b32 v15, 0xffff0000, v146
v_lshlrev_b32 v16, 16, v147
v_and_b32 v17, 0xffff0000, v147
v_pk_add_f32 v[96:97], v[96:97], v[10:11]
v_pk_add_f32 v[98:99], v[98:99], v[12:13]
v_pk_add_f32 v[100:101], v[100:101], v[14:15]
v_pk_add_f32 v[102:103], v[102:103], v[16:17]
s_waitcnt vmcnt(10)
v_lshlrev_b32 v10, 16, v148
v_and_b32 v11, 0xffff0000, v148
v_lshlrev_b32 v12, 16, v149
v_and_b32 v13, 0xffff0000, v149
v_lshlrev_b32 v14, 16, v150
v_and_b32 v15, 0xffff0000, v150
v_lshlrev_b32 v16, 16, v151
v_and_b32 v17, 0xffff0000, v151
v_pk_add_f32 v[96:97], v[96:97], v[10:11]
v_pk_add_f32 v[98:99], v[98:99], v[12:13]
v_pk_add_f32 v[100:101], v[100:101], v[14:15]
v_pk_add_f32 v[102:103], v[102:103], v[16:17]
s_waitcnt vmcnt(9)
v_lshlrev_b32 v10, 16, v152
v_and_b32 v11, 0xffff0000, v152
v_lshlrev_b32 v12, 16, v153
v_and_b32 v13, 0xffff0000, v153
v_lshlrev_b32 v14, 16, v154
v_and_b32 v15, 0xffff0000, v154
v_lshlrev_b32 v16, 16, v155
v_and_b32 v17, 0xffff0000, v155
v_pk_add_f32 v[96:97], v[96:97], v[10:11]
v_pk_add_f32 v[98:99], v[98:99], v[12:13]
v_pk_add_f32 v[100:101], v[100:101], v[14:15]
v_pk_add_f32 v[102:103], v[102:103], v[16:17]
s_waitcnt vmcnt(8)
v_lshlrev_b32 v10, 16, v156
v_and_b32 v11, 0xffff0000, v156
v_lshlrev_b32 v12, 16, v157
v_and_b32 v13, 0xffff0000, v157
v_lshlrev_b32 v14, 16, v158
v_and_b32 v15, 0xffff0000, v158
v_lshlrev_b32 v16, 16, v159
v_and_b32 v17, 0xffff0000, v159
v_pk_add_f32 v[96:97], v[96:97], v[10:11]
v_pk_add_f32 v[98:99], v[98:99], v[12:13]
v_pk_add_f32 v[100:101], v[100:101], v[14:15]
v_pk_add_f32 v[102:103], v[102:103], v[16:17]
s_waitcnt vmcnt(7)
v_lshlrev_b32 v10, 16, v160
v_and_b32 v11, 0xffff0000, v160
v_lshlrev_b32 v12, 16, v161
v_and_b32 v13, 0xffff0000, v161
v_lshlrev_b32 v14, 16, v162
v_and_b32 v15, 0xffff0000, v162
v_lshlrev_b32 v16, 16, v163
v_and_b32 v17, 0xffff0000, v163
v_pk_add_f32 v[96:97], v[96:97], v[10:11]
v_pk_add_f32 v[98:99], v[98:99], v[12:13]
v_pk_add_f32 v[100:101], v[100:101], v[14:15]
v_pk_add_f32 v[102:103], v[102:103], v[16:17]
s_waitcnt vmcnt(6)
v_lshlrev_b32 v10, 16, v164
v_and_b32 v11, 0xffff0000, v164
v_lshlrev_b32 v12, 16, v165
v_and_b32 v13, 0xffff0000, v165
v_lshlrev_b32 v14, 16, v166
v_and_b32 v15, 0xffff0000, v166
v_lshlrev_b32 v16, 16, v167
v_and_b32 v17, 0xffff0000, v167
v_pk_add_f32 v[96:97], v[96:97], v[10:11]
v_pk_add_f32 v[98:99], v[98:99], v[12:13]
v_pk_add_f32 v[100:101], v[100:101], v[14:15]
v_pk_add_f32 v[102:103], v[102:103], v[16:17]
s_waitcnt vmcnt(5)
v_lshlrev_b32 v10, 16, v168
v_and_b32 v11, 0xffff0000, v168
v_lshlrev_b32 v12, 16, v169
v_and_b32 v13, 0xffff0000, v169
v_lshlrev_b32 v14, 16, v170
v_and_b32 v15, 0xffff0000, v170
v_lshlrev_b32 v16, 16, v171
v_and_b32 v17, 0xffff0000, v171
v_pk_add_f32 v[96:97], v[96:97], v[10:11]
v_pk_add_f32 v[98:99], v[98:99], v[12:13]
v_pk_add_f32 v[100:101], v[100:101], v[14:15]
v_pk_add_f32 v[102:103], v[102:103], v[16:17]
s_waitcnt vmcnt(4)
v_lshlrev_b32 v10, 16, v172
v_and_b32 v11, 0xffff0000, v172
v_lshlrev_b32 v12, 16, v173
v_and_b32 v13, 0xffff0000, v173
v_lshlrev_b32 v14, 16, v174
v_and_b32 v15, 0xffff0000, v174
v_lshlrev_b32 v16, 16, v175
v_and_b32 v17, 0xffff0000, v175
v_pk_add_f32 v[96:97], v[96:97], v[10:11]
v_pk_add_f32 v[98:99], v[98:99], v[12:13]
v_pk_add_f32 v[100:101], v[100:101], v[14:15]
v_pk_add_f32 v[102:103], v[102:103], v[16:17]
s_waitcnt vmcnt(3)
v_lshlrev_b32 v10, 16, v176
v_and_b32 v11, 0xffff0000, v176
v_lshlrev_b32 v12, 16, v177
v_and_b32 v13, 0xffff0000, v177
v_lshlrev_b32 v14, 16, v178
v_and_b32 v15, 0xffff0000, v178
v_lshlrev_b32 v16, 16, v179
v_and_b32 v17, 0xffff0000, v179
v_pk_add_f32 v[96:97], v[96:97], v[10:11]
v_pk_add_f32 v[98:99], v[98:99], v[12:13]
v_pk_add_f32 v[100:101], v[100:101], v[14:15]
v_pk_add_f32 v[102:103], v[102:103], v[16:17]
s_waitcnt vmcnt(2)
v_lshlrev_b32 v10, 16, v180
v_and_b32 v11, 0xffff0000, v180
v_lshlrev_b32 v12, 16, v181
v_and_b32 v13, 0xffff0000, v181
v_lshlrev_b32 v14, 16, v182
v_and_b32 v15, 0xffff0000, v182
v_lshlrev_b32 v16, 16, v183
v_and_b32 v17, 0xffff0000, v183
v_pk_add_f32 v[96:97], v[96:97], v[10:11]
v_pk_add_f32 v[98:99], v[98:99], v[12:13]
v_pk_add_f32 v[100:101], v[100:101], v[14:15]
v_pk_add_f32 v[102:103], v[102:103], v[16:17]
s_waitcnt vmcnt(1)
v_lshlrev_b32 v10, 16, v184
v_and_b32 v11, 0xffff0000, v184
v_lshlrev_b32 v12, 16, v185
v_and_b32 v13, 0xffff0000, v185
v_lshlrev_b32 v14, 16, v186
v_and_b32 v15, 0xffff0000, v186
v_lshlrev_b32 v16, 16, v187
v_and_b32 v17, 0xffff0000, v187
v_pk_add_f32 v[96:97], v[96:97], v[10:11]
v_pk_add_f32 v[98:99], v[98:99], v[12:13]
v_pk_add_f32 v[100:101], v[100:101], v[14:15]
v_pk_add_f32 v[102:103], v[102:103], v[16:17]
s_waitcnt vmcnt(0)
v_lshlrev_b32 v10, 16, v188
v_and_b32 v11, 0xffff0000, v188
v_lshlrev_b32 v12, 16, v189
v_and_b32 v13, 0xffff0000, v189
v_lshlrev_b32 v14, 16, v190
v_and_b32 v15, 0xffff0000, v190
v_lshlrev_b32 v16, 16, v191
v_and_b32 v17, 0xffff0000, v191
v_pk_add_f32 v[96:97], v[96:97], v[10:11]
v_pk_add_f32 v[98:99], v[98:99], v[12:13]
v_pk_add_f32 v[100:101], v[100:101], v[14:15]
v_pk_add_f32 v[102:103], v[102:103], v[16:17]
v_cvt_pk_bf16_f32 v96, v96, v97
v_cvt_pk_bf16_f32 v97, v98, v99
v_cvt_pk_bf16_f32 v98, v100, v101
v_cvt_pk_bf16_f32 v99, v102, v103
buffer_store_dwordx2 v[96:97], v21, s[40:43], s25 offen offset:896
buffer_store_dwordx2 v[98:99], v21, s[40:43], s25 offen offset:928
M_fin:
s_endpgm
M_final:
PAD_19:
s_cbranch_execz M_tret
s_mov_b32 s8, s64
s_mov_b32 s9, s65
s_mov_b32 s10, 1835008
s_mov_b32 s11, 0x20000
s_mov_b32 s12, s88
s_mov_b32 s13, s89
s_mov_b32 s14, 3670016
s_mov_b32 s15, 0x20000
s_and_b32 s24, s2, 16
s_add_u32 s24, s24, s20
v_lshrrev_b32 v20, 4, v1
v_and_b32 v21, 15, v20
v_lshrrev_b32 v22, 4, v20
v_mul_u32_u24 v2, 896, v21
v_lshlrev_b32 v9, 1, v2
v_lshl_add_u32 v2, v22, 4, v2
v_lshl_add_u32 v9, v22, 4, v9
s_lshl_b32 s22, s24, 2
s_add_u32 s22, s22, s3
s_mul_i32 s25, s22, 14336
s_lshl_b32 s26, s25, 1
v_lshlrev_b32 v10, 5, v22
v_add3_u32 v10, v10, v21, 16
v_lshlrev_b32 v10, 2, v10
v_min_u32 v11, 380, v10
v_add_u32 v11, 512, v11
s_mov_b32 s27, 94384128
Lfp:
buffer_load_dword v3, v10, s[4:7], s27 offen sc1
buffer_load_dword v4, v11, s[4:7], s27 offen sc1
s_waitcnt vmcnt(0)
v_and_b32 v3, v3, v4
v_cmp_gt_u32 vcc, 1, v3
s_cbranch_vccz Lfpd
s_sleep 2
s_sub_u32 s101, s101, 1
s_cbranch_scc0 Lfp
s_mov_b32 s101, 0
Lfpd:
s_barrier
buffer_store_dword v6, v5, s[4:7], s35 offen sc1
Lfg:
v_lshrrev_b32 v3, 3, v20
v_and_b32 v4, 7, v20
v_lshlrev_b32 v4, 4, v4
v_lshl_add_u32 v3, v3, 12, v4
s_mul_i32 s27, s3, 458752
s_lshl_b32 s22, s24, 7
s_add_u32 s27, s27, s22
s_add_u32 s27, s27, 88080384
s_mul_i32 s28, s3, 14336
s_add_u32 m0, s28, 0
s_nop 0
buffer_load_dwordx4 v3, s[4:7], s27 offen sc1 lds
s_add_u32 s27, s27, 32768
s_add_u32 m0, s28, 1024
s_nop 0
buffer_load_dwordx4 v3, s[4:7], s27 offen sc1 lds
s_add_u32 s27, s27, 32768
s_add_u32 m0, s28, 2048
s_nop 0
buffer_load_dwordx4 v3, s[4:7], s27 offen sc1 lds
s_add_u32 s27, s27, 32768
s_add_u32 m0, s28, 3072
s_nop 0
buffer_load_dwordx4 v3, s[4:7], s27 offen sc1 lds
s_add_u32 s27, s27, 32768
s_add_u32 m0, s28, 4096
s_nop 0
buffer_load_dwordx4 v3, s[4:7], s27 offen sc1 lds
s_add_u32 s27, s27, 32768
s_add_u32 m0, s28, 5120
s_nop 0
buffer_load_dwordx4 v3, s[4:7], s27 offen sc1 lds
s_add_u32 s27, s27, 32768
s_add_u32 m0, s28, 6144
s_nop 0
buffer_load_dwordx4 v3, s[4:7], s27 offen sc1 lds
s_add_u32 s27, s27, 32768
s_add_u32 m0, s28, 7168
s_nop 0
buffer_load_dwordx4 v3, s[4:7], s27 offen sc1 lds
s_add_u32 s27, s27, 32768
s_add_u32 m0, s28, 8192
s_nop 0
buffer_load_dwordx4 v3, s[4:7], s27 offen sc1 lds
s_add_u32 s27, s27, 32768
s_add_u32 m0, s28, 9216
s_nop 0
buffer_load_dwordx4 v3, s[4:7], s27 offen sc1 lds
s_add_u32 s27, s27, 32768
s_add_u32 m0, s28, 10240
s_nop 0
buffer_load_dwordx4 v3, s[4:7], s27 offen sc1 lds
s_add_u32 s27, s27, 32768
s_add_u32 m0, s28, 11264
s_nop 0
buffer_load_dwordx4 v3, s[4:7], s27 offen sc1 lds
s_add_u32 s27, s27, 32768
s_add_u32 m0, s28, 12288
s_nop 0
buffer_load_dwordx4 v3, s[4:7], s27 offen sc1 lds
s_add_u32 s27, s27, 32768
s_add_u32 m0, s28, 13312
s_nop 0
buffer_load_dwordx4 v3, s[4:7], s27 offen sc1 lds
s_add_u32 s27, s27, 32768
buffer_load_dwordx4 v[160:163], v2, s[8:11], s25 offen offset:0
buffer_load_dwordx4 v[164:167], v2, s[8:11], s25 offen offset:64
buffer_load_dwordx4 v[168:171], v2, s[8:11], s25 offen offset:128
buffer_load_dwordx4 v[172:175], v2, s[8:11], s25 offen offset:192
buffer_load_dwordx4 v[176:179], v2, s[8:11], s25 offen offset:256
buffer_load_dwordx4 v[180:183], v2, s[8:11], s25 offen offset:320
buffer_load_dwordx4 v[184:187], v2, s[8:11], s25 offen offset:384
buffer_load_dwordx4 v[188:191], v2, s[8:11], s25 offen offset:448
buffer_load_dwordx4 v[192:195], v2, s[8:11], s25 offen offset:512
buffer_load_dwordx4 v[196:199], v2, s[8:11], s25 offen offset:576
buffer_load_dwordx4 v[200:203], v2, s[8:11], s25 offen offset:640
buffer_load_dwordx4 v[204:207], v2, s[8:11], s25 offen offset:704
buffer_load_dwordx4 v[208:211], v2, s[8:11], s25 offen offset:768
buffer_load_dwordx4 v[212:215], v2, s[8:11], s25 offen offset:832
v_lshrrev_b32 v3, 2, v21
v_lshl_add_u32 v3, v22, 3, v3
v_lshlrev_b32 v3, 7, v3
v_and_b32 v4, 3, v20
v_lshl_add_u32 v3, v4, 3, v3
s_lshl_b32 s22, s3, 5
v_add_u32 v3, s22, v3
s_waitcnt vmcnt(14)
s_barrier
ds_read_b64_tr_b16 v[96:97], v3 offset:0
ds_read_b64_tr_b16 v[98:99], v3 offset:512
ds_read_b64_tr_b16 v[100:101], v3 offset:4096
ds_read_b64_tr_b16 v[102:103], v3 offset:4608
ds_read_b64_tr_b16 v[104:105], v3 offset:8192
ds_read_b64_tr_b16 v[106:107], v3 offset:8704
ds_read_b64_tr_b16 v[108:109], v3 offset:12288
ds_read_b64_tr_b16 v[110:111], v3 offset:12800
ds_read_b64_tr_b16 v[112:113], v3 offset:16384
ds_read_b64_tr_b16 v[114:115], v3 offset:16896
ds_read_b64_tr_b16 v[116:117], v3 offset:20480
ds_read_b64_tr_b16 v[118:119], v3 offset:20992
ds_read_b64_tr_b16 v[120:121], v3 offset:24576
ds_read_b64_tr_b16 v[122:123], v3 offset:25088
s_waitcnt lgkmcnt(0)
ds_read_b64_tr_b16 v[124:125], v3 offset:28672
ds_read_b64_tr_b16 v[126:127], v3 offset:29184
ds_read_b64_tr_b16 v[128:129], v3 offset:32768
ds_read_b64_tr_b16 v[130:131], v3 offset:33280
ds_read_b64_tr_b16 v[132:133], v3 offset:36864
ds_read_b64_tr_b16 v[134:135], v3 offset:37376
ds_read_b64_tr_b16 v[136:137], v3 offset:40960
ds_read_b64_tr_b16 v[138:139], v3 offset:41472
ds_read_b64_tr_b16 v[140:141], v3 offset:45056
ds_read_b64_tr_b16 v[142:143], v3 offset:45568
ds_read_b64_tr_b16 v[144:145], v3 offset:49152
ds_read_b64_tr_b16 v[146:147], v3 offset:49664
ds_read_b64_tr_b16 v[148:149], v3 offset:53248
ds_read_b64_tr_b16 v[150:151], v3 offset:53760
s_waitcnt vmcnt(13)
v_lshlrev_b32 v10, 16, v160
v_and_b32 v11, 0xffff0000, v160
v_lshlrev_b32 v12, 16, v96
v_and_b32 v13, 0xffff0000, v96
v_pk_mul_f32 v[10:11], v[10:11], v[12:13]
v_cvt_pk_bf16_f32 v160, v10, v11
v_lshlrev_b32 v10, 16, v161
v_and_b32 v11, 0xffff0000, v161
v_lshlrev_b32 v12, 16, v97
v_and_b32 v13, 0xffff0000, v97
v_pk_mul_f32 v[10:11], v[10:11], v[12:13]
v_cvt_pk_bf16_f32 v161, v10, v11
v_lshlrev_b32 v10, 16, v162
v_and_b32 v11, 0xffff0000, v162
v_lshlrev_b32 v12, 16, v98
v_and_b32 v13, 0xffff0000, v98
v_pk_mul_f32 v[10:11], v[10:11], v[12:13]
PAD_20:
s_cbranch_execz M_tret
v_cvt_pk_bf16_f32 v162, v10, v11
v_lshlrev_b32 v10, 16, v163
v_and_b32 v11, 0xffff0000, v163
v_lshlrev_b32 v12, 16, v99
v_and_b32 v13, 0xffff0000, v99
v_pk_mul_f32 v[10:11], v[10:11], v[12:13]
v_cvt_pk_bf16_f32 v163, v10, v11
buffer_store_dwordx4 v[160:163], v9, s[12:15], s26 offen offset:0
s_waitcnt vmcnt(13)
v_lshlrev_b32 v10, 16, v164
v_and_b32 v11, 0xffff0000, v164
v_lshlrev_b32 v12, 16, v100
v_and_b32 v13, 0xffff0000, v100
v_pk_mul_f32 v[10:11], v[10:11], v[12:13]
v_cvt_pk_bf16_f32 v164, v10, v11
v_lshlrev_b32 v10, 16, v165
v_and_b32 v11, 0xffff0000, v165
v_lshlrev_b32 v12, 16, v101
v_and_b32 v13, 0xffff0000, v101
v_pk_mul_f32 v[10:11], v[10:11], v[12:13]
v_cvt_pk_bf16_f32 v165, v10, v11
v_lshlrev_b32 v10, 16, v166
v_and_b32 v11, 0xffff0000, v166
v_lshlrev_b32 v12, 16, v102
v_and_b32 v13, 0xffff0000, v102
v_pk_mul_f32 v[10:11], v[10:11], v[12:13]
v_cvt_pk_bf16_f32 v166, v10, v11
v_lshlrev_b32 v10, 16, v167
v_and_b32 v11, 0xffff0000, v167
v_lshlrev_b32 v12, 16, v103
v_and_b32 v13, 0xffff0000, v103
v_pk_mul_f32 v[10:11], v[10:11], v[12:13]
v_cvt_pk_bf16_f32 v167, v10, v11
buffer_store_dwordx4 v[164:167], v9, s[12:15], s26 offen offset:64
s_waitcnt vmcnt(13)
v_lshlrev_b32 v10, 16, v168
v_and_b32 v11, 0xffff0000, v168
v_lshlrev_b32 v12, 16, v104
v_and_b32 v13, 0xffff0000, v104
v_pk_mul_f32 v[10:11], v[10:11], v[12:13]
v_cvt_pk_bf16_f32 v168, v10, v11
v_lshlrev_b32 v10, 16, v169
v_and_b32 v11, 0xffff0000, v169
v_lshlrev_b32 v12, 16, v105
v_and_b32 v13, 0xffff0000, v105
v_pk_mul_f32 v[10:11], v[10:11], v[12:13]
v_cvt_pk_bf16_f32 v169, v10, v11
v_lshlrev_b32 v10, 16, v170
v_and_b32 v11, 0xffff0000, v170
v_lshlrev_b32 v12, 16, v106
v_and_b32 v13, 0xffff0000, v106
v_pk_mul_f32 v[10:11], v[10:11], v[12:13]
v_cvt_pk_bf16_f32 v170, v10, v11
v_lshlrev_b32 v10, 16, v171
v_and_b32 v11, 0xffff0000, v171
v_lshlrev_b32 v12, 16, v107
v_and_b32 v13, 0xffff0000, v107
v_pk_mul_f32 v[10:11], v[10:11], v[12:13]
v_cvt_pk_bf16_f32 v171, v10, v11
buffer_store_dwordx4 v[168:171], v9, s[12:15], s26 offen offset:128
s_waitcnt vmcnt(13)
v_lshlrev_b32 v10, 16, v172
v_and_b32 v11, 0xffff0000, v172
v_lshlrev_b32 v12, 16, v108
v_and_b32 v13, 0xffff0000, v108
v_pk_mul_f32 v[10:11], v[10:11], v[12:13]
v_cvt_pk_bf16_f32 v172, v10, v11
v_lshlrev_b32 v10, 16, v173
v_and_b32 v11, 0xffff0000, v173
v_lshlrev_b32 v12, 16, v109
v_and_b32 v13, 0xffff0000, v109
v_pk_mul_f32 v[10:11], v[10:11], v[12:13]
v_cvt_pk_bf16_f32 v173, v10, v11
v_lshlrev_b32 v10, 16, v174
v_and_b32 v11, 0xffff0000, v174
v_lshlrev_b32 v12, 16, v110
v_and_b32 v13, 0xffff0000, v110
v_pk_mul_f32 v[10:11], v[10:11], v[12:13]
v_cvt_pk_bf16_f32 v174, v10, v11
v_lshlrev_b32 v10, 16, v175
v_and_b32 v11, 0xffff0000, v175
v_lshlrev_b32 v12, 16, v111
v_and_b32 v13, 0xffff0000, v111
v_pk_mul_f32 v[10:11], v[10:11], v[12:13]
v_cvt_pk_bf16_f32 v175, v10, v11
buffer_store_dwordx4 v[172:175], v9, s[12:15], s26 offen offset:192
s_waitcnt vmcnt(13)
v_lshlrev_b32 v10, 16, v176
v_and_b32 v11, 0xffff0000, v176
v_lshlrev_b32 v12, 16, v112
v_and_b32 v13, 0xffff0000, v112
v_pk_mul_f32 v[10:11], v[10:11], v[12:13]
v_cvt_pk_bf16_f32 v176, v10, v11
v_lshlrev_b32 v10, 16, v177
v_and_b32 v11, 0xffff0000, v177
v_lshlrev_b32 v12, 16, v113
v_and_b32 v13, 0xffff0000, v113
v_pk_mul_f32 v[10:11], v[10:11], v[12:13]
v_cvt_pk_bf16_f32 v177, v10, v11
v_lshlrev_b32 v10, 16, v178
v_and_b32 v11, 0xffff0000, v178
v_lshlrev_b32 v12, 16, v114
v_and_b32 v13, 0xffff0000, v114
v_pk_mul_f32 v[10:11], v[10:11], v[12:13]
v_cvt_pk_bf16_f32 v178, v10, v11
v_lshlrev_b32 v10, 16, v179
v_and_b32 v11, 0xffff0000, v179
v_lshlrev_b32 v12, 16, v115
v_and_b32 v13, 0xffff0000, v115
v_pk_mul_f32 v[10:11], v[10:11], v[12:13]
v_cvt_pk_bf16_f32 v179, v10, v11
buffer_store_dwordx4 v[176:179], v9, s[12:15], s26 offen offset:256
s_waitcnt vmcnt(13)
v_lshlrev_b32 v10, 16, v180
v_and_b32 v11, 0xffff0000, v180
v_lshlrev_b32 v12, 16, v116
v_and_b32 v13, 0xffff0000, v116
v_pk_mul_f32 v[10:11], v[10:11], v[12:13]
v_cvt_pk_bf16_f32 v180, v10, v11
v_lshlrev_b32 v10, 16, v181
v_and_b32 v11, 0xffff0000, v181
v_lshlrev_b32 v12, 16, v117
v_and_b32 v13, 0xffff0000, v117
v_pk_mul_f32 v[10:11], v[10:11], v[12:13]
v_cvt_pk_bf16_f32 v181, v10, v11
v_lshlrev_b32 v10, 16, v182
v_and_b32 v11, 0xffff0000, v182
v_lshlrev_b32 v12, 16, v118
v_and_b32 v13, 0xffff0000, v118
v_pk_mul_f32 v[10:11], v[10:11], v[12:13]
v_cvt_pk_bf16_f32 v182, v10, v11
v_lshlrev_b32 v10, 16, v183
v_and_b32 v11, 0xffff0000, v183
v_lshlrev_b32 v12, 16, v119
v_and_b32 v13, 0xffff0000, v119
v_pk_mul_f32 v[10:11], v[10:11], v[12:13]
v_cvt_pk_bf16_f32 v183, v10, v11
buffer_store_dwordx4 v[180:183], v9, s[12:15], s26 offen offset:320
s_waitcnt vmcnt(13)
v_lshlrev_b32 v10, 16, v184
v_and_b32 v11, 0xffff0000, v184
v_lshlrev_b32 v12, 16, v120
v_and_b32 v13, 0xffff0000, v120
v_pk_mul_f32 v[10:11], v[10:11], v[12:13]
v_cvt_pk_bf16_f32 v184, v10, v11
v_lshlrev_b32 v10, 16, v185
v_and_b32 v11, 0xffff0000, v185
v_lshlrev_b32 v12, 16, v121
v_and_b32 v13, 0xffff0000, v121
v_pk_mul_f32 v[10:11], v[10:11], v[12:13]
v_cvt_pk_bf16_f32 v185, v10, v11
v_lshlrev_b32 v10, 16, v186
v_and_b32 v11, 0xffff0000, v186
v_lshlrev_b32 v12, 16, v122
v_and_b32 v13, 0xffff0000, v122
v_pk_mul_f32 v[10:11], v[10:11], v[12:13]
v_cvt_pk_bf16_f32 v186, v10, v11
v_lshlrev_b32 v10, 16, v187
v_and_b32 v11, 0xffff0000, v187
v_lshlrev_b32 v12, 16, v123
v_and_b32 v13, 0xffff0000, v123
v_pk_mul_f32 v[10:11], v[10:11], v[12:13]
v_cvt_pk_bf16_f32 v187, v10, v11
buffer_store_dwordx4 v[184:187], v9, s[12:15], s26 offen offset:384
s_waitcnt lgkmcnt(0)
s_waitcnt vmcnt(13)
v_lshlrev_b32 v10, 16, v188
v_and_b32 v11, 0xffff0000, v188
v_lshlrev_b32 v12, 16, v124
v_and_b32 v13, 0xffff0000, v124
v_pk_mul_f32 v[10:11], v[10:11], v[12:13]
v_cvt_pk_bf16_f32 v188, v10, v11
v_lshlrev_b32 v10, 16, v189
v_and_b32 v11, 0xffff0000, v189
v_lshlrev_b32 v12, 16, v125
v_and_b32 v13, 0xffff0000, v125
v_pk_mul_f32 v[10:11], v[10:11], v[12:13]
v_cvt_pk_bf16_f32 v189, v10, v11
v_lshlrev_b32 v10, 16, v190
v_and_b32 v11, 0xffff0000, v190
v_lshlrev_b32 v12, 16, v126
v_and_b32 v13, 0xffff0000, v126
v_pk_mul_f32 v[10:11], v[10:11], v[12:13]
v_cvt_pk_bf16_f32 v190, v10, v11
v_lshlrev_b32 v10, 16, v191
v_and_b32 v11, 0xffff0000, v191
v_lshlrev_b32 v12, 16, v127
v_and_b32 v13, 0xffff0000, v127
v_pk_mul_f32 v[10:11], v[10:11], v[12:13]
v_cvt_pk_bf16_f32 v191, v10, v11
buffer_store_dwordx4 v[188:191], v9, s[12:15], s26 offen offset:448
s_waitcnt vmcnt(13)
v_lshlrev_b32 v10, 16, v192
v_and_b32 v11, 0xffff0000, v192
v_lshlrev_b32 v12, 16, v128
v_and_b32 v13, 0xffff0000, v128
v_pk_mul_f32 v[10:11], v[10:11], v[12:13]
v_cvt_pk_bf16_f32 v192, v10, v11
v_lshlrev_b32 v10, 16, v193
v_and_b32 v11, 0xffff0000, v193
v_lshlrev_b32 v12, 16, v129
v_and_b32 v13, 0xffff0000, v129
v_pk_mul_f32 v[10:11], v[10:11], v[12:13]
v_cvt_pk_bf16_f32 v193, v10, v11
v_lshlrev_b32 v10, 16, v194
v_and_b32 v11, 0xffff0000, v194
v_lshlrev_b32 v12, 16, v130
v_and_b32 v13, 0xffff0000, v130
v_pk_mul_f32 v[10:11], v[10:11], v[12:13]
v_cvt_pk_bf16_f32 v194, v10, v11
v_lshlrev_b32 v10, 16, v195
v_and_b32 v11, 0xffff0000, v195
v_lshlrev_b32 v12, 16, v131
v_and_b32 v13, 0xffff0000, v131
v_pk_mul_f32 v[10:11], v[10:11], v[12:13]
v_cvt_pk_bf16_f32 v195, v10, v11
buffer_store_dwordx4 v[192:195], v9, s[12:15], s26 offen offset:512
s_waitcnt vmcnt(13)
v_lshlrev_b32 v10, 16, v196
v_and_b32 v11, 0xffff0000, v196
v_lshlrev_b32 v12, 16, v132
v_and_b32 v13, 0xffff0000, v132
v_pk_mul_f32 v[10:11], v[10:11], v[12:13]
v_cvt_pk_bf16_f32 v196, v10, v11
v_lshlrev_b32 v10, 16, v197
v_and_b32 v11, 0xffff0000, v197
v_lshlrev_b32 v12, 16, v133
v_and_b32 v13, 0xffff0000, v133
v_pk_mul_f32 v[10:11], v[10:11], v[12:13]
v_cvt_pk_bf16_f32 v197, v10, v11
v_lshlrev_b32 v10, 16, v198
v_and_b32 v11, 0xffff0000, v198
v_lshlrev_b32 v12, 16, v134
v_and_b32 v13, 0xffff0000, v134
v_pk_mul_f32 v[10:11], v[10:11], v[12:13]
v_cvt_pk_bf16_f32 v198, v10, v11
v_lshlrev_b32 v10, 16, v199
v_and_b32 v11, 0xffff0000, v199
v_lshlrev_b32 v12, 16, v135
v_and_b32 v13, 0xffff0000, v135
v_pk_mul_f32 v[10:11], v[10:11], v[12:13]
v_cvt_pk_bf16_f32 v199, v10, v11
buffer_store_dwordx4 v[196:199], v9, s[12:15], s26 offen offset:576
s_waitcnt vmcnt(13)
v_lshlrev_b32 v10, 16, v200
v_and_b32 v11, 0xffff0000, v200
v_lshlrev_b32 v12, 16, v136
v_and_b32 v13, 0xffff0000, v136
v_pk_mul_f32 v[10:11], v[10:11], v[12:13]
v_cvt_pk_bf16_f32 v200, v10, v11
v_lshlrev_b32 v10, 16, v201
v_and_b32 v11, 0xffff0000, v201
v_lshlrev_b32 v12, 16, v137
v_and_b32 v13, 0xffff0000, v137
v_pk_mul_f32 v[10:11], v[10:11], v[12:13]
v_cvt_pk_bf16_f32 v201, v10, v11
v_lshlrev_b32 v10, 16, v202
v_and_b32 v11, 0xffff0000, v202
v_lshlrev_b32 v12, 16, v138
v_and_b32 v13, 0xffff0000, v138
v_pk_mul_f32 v[10:11], v[10:11], v[12:13]
v_cvt_pk_bf16_f32 v202, v10, v11
v_lshlrev_b32 v10, 16, v203
v_and_b32 v11, 0xffff0000, v203
v_lshlrev_b32 v12, 16, v139
v_and_b32 v13, 0xffff0000, v139
v_pk_mul_f32 v[10:11], v[10:11], v[12:13]
v_cvt_pk_bf16_f32 v203, v10, v11
buffer_store_dwordx4 v[200:203], v9, s[12:15], s26 offen offset:640
s_waitcnt vmcnt(13)
v_lshlrev_b32 v10, 16, v204
v_and_b32 v11, 0xffff0000, v204
v_lshlrev_b32 v12, 16, v140
v_and_b32 v13, 0xffff0000, v140
v_pk_mul_f32 v[10:11], v[10:11], v[12:13]
v_cvt_pk_bf16_f32 v204, v10, v11
v_lshlrev_b32 v10, 16, v205
v_and_b32 v11, 0xffff0000, v205
v_lshlrev_b32 v12, 16, v141
v_and_b32 v13, 0xffff0000, v141
v_pk_mul_f32 v[10:11], v[10:11], v[12:13]
v_cvt_pk_bf16_f32 v205, v10, v11
v_lshlrev_b32 v10, 16, v206
v_and_b32 v11, 0xffff0000, v206
v_lshlrev_b32 v12, 16, v142
v_and_b32 v13, 0xffff0000, v142
v_pk_mul_f32 v[10:11], v[10:11], v[12:13]
v_cvt_pk_bf16_f32 v206, v10, v11
v_lshlrev_b32 v10, 16, v207
v_and_b32 v11, 0xffff0000, v207
v_lshlrev_b32 v12, 16, v143
v_and_b32 v13, 0xffff0000, v143
v_pk_mul_f32 v[10:11], v[10:11], v[12:13]
v_cvt_pk_bf16_f32 v207, v10, v11
buffer_store_dwordx4 v[204:207], v9, s[12:15], s26 offen offset:704
s_waitcnt vmcnt(13)
v_lshlrev_b32 v10, 16, v208
v_and_b32 v11, 0xffff0000, v208
v_lshlrev_b32 v12, 16, v144
v_and_b32 v13, 0xffff0000, v144
v_pk_mul_f32 v[10:11], v[10:11], v[12:13]
v_cvt_pk_bf16_f32 v208, v10, v11
v_lshlrev_b32 v10, 16, v209
v_and_b32 v11, 0xffff0000, v209
v_lshlrev_b32 v12, 16, v145
v_and_b32 v13, 0xffff0000, v145
v_pk_mul_f32 v[10:11], v[10:11], v[12:13]
v_cvt_pk_bf16_f32 v209, v10, v11
v_lshlrev_b32 v10, 16, v210
v_and_b32 v11, 0xffff0000, v210
v_lshlrev_b32 v12, 16, v146
v_and_b32 v13, 0xffff0000, v146
v_pk_mul_f32 v[10:11], v[10:11], v[12:13]
v_cvt_pk_bf16_f32 v210, v10, v11
v_lshlrev_b32 v10, 16, v211
v_and_b32 v11, 0xffff0000, v211
v_lshlrev_b32 v12, 16, v147
v_and_b32 v13, 0xffff0000, v147
v_pk_mul_f32 v[10:11], v[10:11], v[12:13]
v_cvt_pk_bf16_f32 v211, v10, v11
buffer_store_dwordx4 v[208:211], v9, s[12:15], s26 offen offset:768
s_waitcnt vmcnt(13)
v_lshlrev_b32 v10, 16, v212
v_and_b32 v11, 0xffff0000, v212
v_lshlrev_b32 v12, 16, v148
v_and_b32 v13, 0xffff0000, v148
v_pk_mul_f32 v[10:11], v[10:11], v[12:13]
v_cvt_pk_bf16_f32 v212, v10, v11
v_lshlrev_b32 v10, 16, v213
v_and_b32 v11, 0xffff0000, v213
v_lshlrev_b32 v12, 16, v149
v_and_b32 v13, 0xffff0000, v149
v_pk_mul_f32 v[10:11], v[10:11], v[12:13]
v_cvt_pk_bf16_f32 v213, v10, v11
v_lshlrev_b32 v10, 16, v214
v_and_b32 v11, 0xffff0000, v214
v_lshlrev_b32 v12, 16, v150
v_and_b32 v13, 0xffff0000, v150
v_pk_mul_f32 v[10:11], v[10:11], v[12:13]
v_cvt_pk_bf16_f32 v214, v10, v11
v_lshlrev_b32 v10, 16, v215
v_and_b32 v11, 0xffff0000, v215
v_lshlrev_b32 v12, 16, v151
v_and_b32 v13, 0xffff0000, v151
v_pk_mul_f32 v[10:11], v[10:11], v[12:13]
v_cvt_pk_bf16_f32 v215, v10, v11
buffer_store_dwordx4 v[212:215], v9, s[12:15], s26 offen offset:832
s_branch M_fin
M_fend:
M_rslow:
Lp_9251:
buffer_load_dword v18, v19, s[4:7], s33 offen offset:0 sc1
s_waitcnt vmcnt(0)
v_cmp_gt_u32 vcc, 1, v18
s_cbranch_vccz Lpd_9252
s_sleep 8
s_sub_u32 s101, s101, 1
s_cbranch_scc0 Lp_9251
s_mov_b32 s101, 0
Lpd_9252:
s_branch M_rjoin
PAD_21:
s_cbranch_execz PAD_25
M_V:
v_mfma_f32_16x16x32_bf16 v[32:35], a[0:3], a[128:131], 0
s_add_u32 m0, s29, 114688
ds_read_b64_tr_b16 a[136:137], v5 offset:0
v_mfma_f32_16x16x32_bf16 v[32:35], a[4:7], a[132:135], v[32:35]
s_mov_b32 s32, 1024
buffer_load_dwordx4 v16, s[12:15], s27 offen offset:0 lds
v_mfma_f32_16x16x32_bf16 v[36:39], a[8:11], a[128:131], 0
s_mov_b32 s33, 31744
ds_read_b64_tr_b16 a[138:139], v5 offset:2048
v_mfma_f32_16x16x32_bf16 v[36:39], a[12:15], a[132:135], v[36:39]
s_mov_b32 s34, 4294935552
v_mfma_f32_16x16x32_bf16 v[40:43], a[16:19], a[128:131], 0
s_mov_b32 s35, 4294935552
ds_read_b64_tr_b16 a[140:141], v5 offset:16384
v_mfma_f32_16x16x32_bf16 v[40:43], a[20:23], a[132:135], v[40:43]
s_mov_b32 s36, 4294935552
buffer_load_dwordx4 v17, s[12:15], s27 offen offset:1024 lds
v_mfma_f32_16x16x32_bf16 v[44:47], a[24:27], a[128:131], 0
s_mov_b32 s30, 8
ds_read_b64_tr_b16 a[142:143], v5 offset:18432
v_mfma_f32_16x16x32_bf16 v[44:47], a[28:31], a[132:135], v[44:47]
s_mov_b32 s82, 3221225472
v_mfma_f32_16x16x32_bf16 v[48:51], a[32:35], a[128:131], 0
s_mul_hi_u32 s38, s2, 613566757
v_mfma_f32_16x16x32_bf16 v[48:51], a[36:39], a[132:135], v[48:51]
s_mul_i32 s39, s38, 7
buffer_load_dwordx4 v18, s[12:15], s27 offen offset:2048 lds
v_mfma_f32_16x16x32_bf16 v[52:55], a[40:43], a[128:131], 0
s_sub_u32 s39, s2, s39
v_mov_b32 v246, 0
v_mov_b32 v229, 0
v_mfma_f32_16x16x32_bf16 v[52:55], a[44:47], a[132:135], v[52:55]
v_mov_b32 v231, 0
v_mfma_f32_16x16x32_bf16 v[56:59], a[48:51], a[128:131], 0
s_mov_b32 s60, s90
v_mfma_f32_16x16x32_bf16 v[56:59], a[52:55], a[132:135], v[56:59]
s_mov_b32 s61, s91
buffer_load_dwordx4 v19, s[12:15], s27 offen offset:3072 lds
v_mfma_f32_16x16x32_bf16 v[60:63], a[56:59], a[128:131], 0
s_add_u32 s27, s27, 524288
v_mfma_f32_16x16x32_bf16 v[60:63], a[60:63], a[132:135], v[60:63]
s_waitcnt lgkmcnt(0)
s_mov_b32 s62, 256
v_mfma_f32_16x16x32_bf16 v[64:67], a[0:3], a[136:139], 0
s_add_u32 m0, s28, 0
ds_read_b64_tr_b16 a[128:129], v6 offset:0
v_mfma_f32_16x16x32_bf16 v[64:67], a[4:7], a[140:143], v[64:67]
s_mov_b32 s63, 0x20000
buffer_load_dwordx4 v12, s[8:11], s24 offen offset:0 lds
v_mfma_f32_16x16x32_bf16 v[68:71], a[8:11], a[136:139], 0
s_mul_hi_u32 s55, s2, 1431655766
ds_read_b64_tr_b16 a[130:131], v6 offset:2048
v_mfma_f32_16x16x32_bf16 v[68:71], a[12:15], a[140:143], v[68:71]
s_mul_i32 s55, s55, 3
v_mfma_f32_16x16x32_bf16 v[72:75], a[16:19], a[136:139], 0
s_sub_u32 s55, s2, s55
ds_read_b64_tr_b16 a[132:133], v6 offset:16384
v_mfma_f32_16x16x32_bf16 v[72:75], a[20:23], a[140:143], v[72:75]
s_add_u32 s55, s55, 5
buffer_load_dwordx4 v13, s[8:11], s24 offen offset:1024 lds
v_mfma_f32_16x16x32_bf16 v[76:79], a[24:27], a[136:139], 0
s_lshr_b32 s22, s2, 4
ds_read_b64_tr_b16 a[134:135], v6 offset:18432
v_mfma_f32_16x16x32_bf16 v[76:79], a[28:31], a[140:143], v[76:79]
s_lshl_b32 s23, s20, 5
v_mfma_f32_16x16x32_bf16 v[80:83], a[32:35], a[136:139], 0
s_add_u32 s23, s23, s22
v_mfma_f32_16x16x32_bf16 v[80:83], a[36:39], a[140:143], v[80:83]
s_lshl_b32 s23, s23, 2
buffer_load_dwordx4 v14, s[8:11], s24 offen offset:2048 lds
v_mfma_f32_16x16x32_bf16 v[84:87], a[40:43], a[136:139], 0
s_and_b32 s22, s2, 16
v_mfma_f32_16x16x32_bf16 v[84:87], a[44:47], a[140:143], v[84:87]
s_lshl_b32 s22, s22, 7
v_mfma_f32_16x16x32_bf16 v[88:91], a[48:51], a[136:139], 0
s_add_u32 s23, s23, s22
v_mov_b32 v28, 3221225472
v_writelane_b32 v28, s23, 0
v_mfma_f32_16x16x32_bf16 v[88:91], a[52:55], a[140:143], v[88:91]
s_add_u32 s56, s23, 16384
buffer_load_dwordx4 v15, s[8:11], s24 offen offset:3072 lds
v_mfma_f32_16x16x32_bf16 v[92:95], a[56:59], a[136:139], 0
s_add_u32 s24, s24, 128
v_writelane_b32 v28, s56, 1
v_mfma_f32_16x16x32_bf16 v[92:95], a[60:63], a[140:143], v[92:95]
s_waitcnt lgkmcnt(0)
s_add_u32 s56, s23, 4096
v_writelane_b32 v28, s56, 2
v_mfma_f32_16x16x32_bf16 v[96:99], a[0:3], a[128:131], 0
s_add_u32 m0, s28, 4096
ds_read_b64_tr_b16 a[136:137], v7 offset:0
v_mfma_f32_16x16x32_bf16 v[96:99], a[4:7], a[132:135], v[96:99]
s_sub_u32 s37, 15, s21
buffer_load_dwordx4 v12, s[8:11], s25 offen offset:0 lds
v_mfma_f32_16x16x32_bf16 v[100:103], a[8:11], a[128:131], 0
ds_read_b64_tr_b16 a[138:139], v7 offset:2048
v_mfma_f32_16x16x32_bf16 v[100:103], a[12:15], a[132:135], v[100:103]
v_mfma_f32_16x16x32_bf16 v[104:107], a[16:19], a[128:131], 0
ds_read_b64_tr_b16 a[140:141], v7 offset:16384
v_mfma_f32_16x16x32_bf16 v[104:107], a[20:23], a[132:135], v[104:107]
buffer_load_dwordx4 v13, s[8:11], s25 offen offset:1024 lds
v_mfma_f32_16x16x32_bf16 v[108:111], a[24:27], a[128:131], 0
ds_read_b64_tr_b16 a[142:143], v7 offset:18432
v_mfma_f32_16x16x32_bf16 v[108:111], a[28:31], a[132:135], v[108:111]
v_mfma_f32_16x16x32_bf16 v[112:115], a[32:35], a[128:131], 0
v_mfma_f32_16x16x32_bf16 v[112:115], a[36:39], a[132:135], v[112:115]
buffer_load_dwordx4 v14, s[8:11], s25 offen offset:2048 lds
v_mfma_f32_16x16x32_bf16 v[116:119], a[40:43], a[128:131], 0
v_mfma_f32_16x16x32_bf16 v[116:119], a[44:47], a[132:135], v[116:119]
v_mfma_f32_16x16x32_bf16 v[120:123], a[48:51], a[128:131], 0
v_mfma_f32_16x16x32_bf16 v[120:123], a[52:55], a[132:135], v[120:123]
buffer_load_dwordx4 v15, s[8:11], s25 offen offset:3072 lds
v_mfma_f32_16x16x32_bf16 v[124:127], a[56:59], a[128:131], 0
s_add_u32 s25, s25, 128
v_mfma_f32_16x16x32_bf16 v[124:127], a[60:63], a[132:135], v[124:127]
s_waitcnt vmcnt(17) lgkmcnt(0)
s_barrier
v_mfma_f32_16x16x32_bf16 v[128:131], a[0:3], a[136:139], 0
ds_read_b64_tr_b16 a[128:129], v8 offset:0
v_mfma_f32_16x16x32_bf16 v[128:131], a[4:7], a[140:143], v[128:131]
buffer_load_dword v21, v20, s[16:19], s43 offen
v_mfma_f32_16x16x32_bf16 v[132:135], a[8:11], a[136:139], 0
s_add_u32 s43, s43, s47
ds_read_b64_tr_b16 a[130:131], v8 offset:2048
v_mfma_f32_16x16x32_bf16 v[132:135], a[12:15], a[140:143], v[132:135]
s_cmp_ge_u32 s43, s51
v_mfma_f32_16x16x32_bf16 v[136:139], a[16:19], a[136:139], 0
s_cselect_b32 s43, 0, s43
ds_read_b64_tr_b16 a[132:133], v8 offset:16384
v_mfma_f32_16x16x32_bf16 v[136:139], a[20:23], a[140:143], v[136:139]
s_cselect_b32 s51, s42, s51
v_mfma_f32_16x16x32_bf16 v[140:143], a[24:27], a[136:139], 0
s_cselect_b64 s[16:17], s[40:41], s[16:17]
ds_read_b64_tr_b16 a[134:135], v8 offset:18432
v_mfma_f32_16x16x32_bf16 v[140:143], a[28:31], a[140:143], v[140:143]
s_cselect_b32 s18, s42, s18
v_mfma_f32_16x16x32_bf16 v[144:147], a[32:35], a[136:139], 0
s_cselect_b64 s[40:41], s[44:45], s[40:41]
ds_read_b128 a[64:67], v2 offset:32768
v_mfma_f32_16x16x32_bf16 v[144:147], a[36:39], a[140:143], v[144:147]
s_cselect_b32 s42, s46, s42
v_mfma_f32_16x16x32_bf16 v[148:151], a[40:43], a[136:139], 0
s_cselect_b32 s46, 0, s46
ds_read_b128 a[68:71], v3 offset:32768
v_mfma_f32_16x16x32_bf16 v[148:151], a[44:47], a[140:143], v[148:151]
ds_read_b128 a[72:75], v2 offset:34816
v_mfma_f32_16x16x32_bf16 v[152:155], a[48:51], a[136:139], 0
ds_read_b128 a[76:79], v3 offset:34816
v_mfma_f32_16x16x32_bf16 v[152:155], a[52:55], a[140:143], v[152:155]
buffer_load_dword v21, v20, s[16:19], s43 offen
v_mfma_f32_16x16x32_bf16 v[156:159], a[56:59], a[136:139], 0
s_add_u32 s43, s43, s47
ds_read_b128 a[80:83], v2 offset:36864
v_mfma_f32_16x16x32_bf16 v[156:159], a[60:63], a[140:143], v[156:159]
s_waitcnt lgkmcnt(5)
s_cmp_ge_u32 s43, s51
ds_read_b128 a[84:87], v3 offset:36864
v_mfma_f32_16x16x32_bf16 v[160:163], a[0:3], a[128:131], 0
s_cselect_b32 s43, 0, s43
ds_read_b64_tr_b16 a[136:137], v9 offset:0
v_mfma_f32_16x16x32_bf16 v[160:163], a[4:7], a[132:135], v[160:163]
s_cselect_b32 s51, s42, s51
v_mfma_f32_16x16x32_bf16 v[164:167], a[8:11], a[128:131], 0
s_cselect_b64 s[16:17], s[40:41], s[16:17]
ds_read_b64_tr_b16 a[138:139], v9 offset:2048
v_mfma_f32_16x16x32_bf16 v[164:167], a[12:15], a[132:135], v[164:167]
s_cselect_b32 s18, s42, s18
v_mfma_f32_16x16x32_bf16 v[168:171], a[16:19], a[128:131], 0
s_cselect_b64 s[40:41], s[44:45], s[40:41]
ds_read_b64_tr_b16 a[140:141], v9 offset:16384
v_mfma_f32_16x16x32_bf16 v[168:171], a[20:23], a[132:135], v[168:171]
s_cselect_b32 s42, s46, s42
v_mfma_f32_16x16x32_bf16 v[172:175], a[24:27], a[128:131], 0
s_cselect_b32 s46, 0, s46
ds_read_b64_tr_b16 a[142:143], v9 offset:18432
v_mfma_f32_16x16x32_bf16 v[172:175], a[28:31], a[132:135], v[172:175]
s_bitcmp1_b32 s2, 4
s_cselect_b32 s37, s21, s37
s_lshl_b32 s56, s37, 5
v_mfma_f32_16x16x32_bf16 v[176:179], a[32:35], a[128:131], 0
s_add_u32 s56, s56, s20
s_lshl_b32 s56, s56, 2
s_add_u32 s56, s56, 8192
v_mfma_f32_16x16x32_bf16 v[176:179], a[36:39], a[132:135], v[176:179]
v_writelane_b32 v28, s56, 3
v_mfma_f32_16x16x32_bf16 v[180:183], a[40:43], a[128:131], 0
s_add_u32 s56, s56, 2048
ds_read_b128 a[88:91], v2 offset:38912
v_writelane_b32 v28, s56, 6
v_mfma_f32_16x16x32_bf16 v[180:183], a[44:47], a[132:135], v[180:183]
s_lshl_b32 s56, s2, 2
s_add_u32 s56, s56, 12288
ds_read_b128 a[92:95], v3 offset:38912
v_mfma_f32_16x16x32_bf16 v[184:187], a[48:51], a[128:131], 0
s_waitcnt lgkmcnt(2)
ds_read_b128 a[96:99], v2 offset:40960
v_writelane_b32 v28, s56, 4
v_mfma_f32_16x16x32_bf16 v[184:187], a[52:55], a[132:135], v[184:187]
s_lshl_b32 s56, s39, 5
s_add_u32 s56, s56, s38
s_lshl_b32 s56, s56, 2
v_mfma_f32_16x16x32_bf16 v[188:191], a[56:59], a[128:131], 0
s_add_u32 s56, s56, 20480
s_cmp_lt_u32 s2, 224
ds_read_b128 a[100:103], v3 offset:40960
v_mfma_f32_16x16x32_bf16 v[188:191], a[60:63], a[132:135], v[188:191]
s_cselect_b32 s56, s56, 3221225472
ds_read_b128 a[104:107], v2 offset:43008
v_writelane_b32 v28, s56, 7
v_mfma_f32_16x16x32_bf16 v[192:195], a[0:3], a[136:139], 0
s_cmp_eq_u32 s3, 0
s_cselect_b32 s56, 94371840, 3221225472
ds_read_b64_tr_b16 a[128:129], v10 offset:0
v_mfma_f32_16x16x32_bf16 v[192:195], a[4:7], a[140:143], v[192:195]
buffer_store_dword v246, v28, s[4:7], s56 offen sc1
v_mfma_f32_16x16x32_bf16 v[196:199], a[8:11], a[136:139], 0
ds_read_b64_tr_b16 a[130:131], v10 offset:2048
v_mov_b32 v27, 1
v_mfma_f32_16x16x32_bf16 v[196:199], a[12:15], a[140:143], v[196:199]
v_cmp_eq_u32 vcc, 0, v0
v_mov_b32 v26, 3221225472
v_mfma_f32_16x16x32_bf16 v[200:203], a[16:19], a[136:139], 0
s_lshl_b32 s31, s20, 20
s_lshl_b32 s22, s21, 17
ds_read_b64_tr_b16 a[132:133], v10 offset:16384
v_mfma_f32_16x16x32_bf16 v[200:203], a[20:23], a[140:143], v[200:203]
v_cndmask_b32 v26, v26, v246, vcc
v_mfma_f32_16x16x32_bf16 v[204:207], a[24:27], a[136:139], 0
s_add_u32 s31, s31, s22
s_lshr_b32 s22, s3, 1
ds_read_b64_tr_b16 a[134:135], v10 offset:18432
v_mfma_f32_16x16x32_bf16 v[204:207], a[28:31], a[140:143], v[204:207]
s_lshl_b32 s22, s22, 16
s_add_u32 s31, s31, s22
s_and_b32 s22, s3, 1
v_mfma_f32_16x16x32_bf16 v[208:211], a[32:35], a[136:139], 0
s_lshl_b32 s22, s22, 14
s_add_u32 s31, s31, s22
s_add_u32 s31, s31, 16777216
v_mfma_f32_16x16x32_bf16 v[208:211], a[36:39], a[140:143], v[208:211]
v_mfma_f32_16x16x32_bf16 v[212:215], a[40:43], a[136:139], 0
ds_read_b128 a[108:111], v3 offset:43008
v_mfma_f32_16x16x32_bf16 v[212:215], a[44:47], a[140:143], v[212:215]
ds_read_b128 a[112:115], v2 offset:45056
v_mfma_f32_16x16x32_bf16 v[216:219], a[48:51], a[136:139], 0
ds_read_b128 a[116:119], v3 offset:45056
v_mfma_f32_16x16x32_bf16 v[216:219], a[52:55], a[140:143], v[216:219]
v_mfma_f32_16x16x32_bf16 v[220:223], a[56:59], a[136:139], 0
ds_read_b128 a[120:123], v2 offset:47104
v_mfma_f32_16x16x32_bf16 v[220:223], a[60:63], a[140:143], v[220:223]
s_waitcnt lgkmcnt(4)
ds_read_b128 a[124:127], v3 offset:47104
v_mfma_f32_16x16x32_bf16 a[192:195], a[0:3], a[128:131], 0
ds_read_b64_tr_b16 a[136:137], v11 offset:0
v_mfma_f32_16x16x32_bf16 a[192:195], a[4:7], a[132:135], a[192:195]
PAD_22:
s_cbranch_execz PAD_26
v_mfma_f32_16x16x32_bf16 a[196:199], a[8:11], a[128:131], 0
ds_read_b64_tr_b16 a[138:139], v11 offset:2048
v_mfma_f32_16x16x32_bf16 a[196:199], a[12:15], a[132:135], a[196:199]
v_mfma_f32_16x16x32_bf16 a[200:203], a[16:19], a[128:131], 0
ds_read_b64_tr_b16 a[140:141], v11 offset:16384
v_mfma_f32_16x16x32_bf16 a[200:203], a[20:23], a[132:135], a[200:203]
v_mfma_f32_16x16x32_bf16 a[204:207], a[24:27], a[128:131], 0
ds_read_b64_tr_b16 a[142:143], v11 offset:18432
v_mfma_f32_16x16x32_bf16 a[204:207], a[28:31], a[132:135], a[204:207]
v_mfma_f32_16x16x32_bf16 a[208:211], a[32:35], a[128:131], 0
v_mfma_f32_16x16x32_bf16 a[208:211], a[36:39], a[132:135], a[208:211]
v_mfma_f32_16x16x32_bf16 a[212:215], a[40:43], a[128:131], 0
v_mfma_f32_16x16x32_bf16 a[212:215], a[44:47], a[132:135], a[212:215]
v_mfma_f32_16x16x32_bf16 a[216:219], a[48:51], a[128:131], 0
v_mfma_f32_16x16x32_bf16 a[216:219], a[52:55], a[132:135], a[216:219]
v_mfma_f32_16x16x32_bf16 a[220:223], a[56:59], a[128:131], 0
s_waitcnt vmcnt(3) lgkmcnt(0)
v_mfma_f32_16x16x32_bf16 a[220:223], a[60:63], a[132:135], a[220:223]
s_barrier
v_mfma_f32_16x16x32_bf16 a[224:227], a[0:3], a[136:139], 0
s_add_u32 m0, s29, 65536
ds_read_b64_tr_b16 a[128:129], v4 offset:32768
v_mfma_f32_16x16x32_bf16 a[224:227], a[4:7], a[140:143], a[224:227]
buffer_load_dwordx4 v16, s[12:15], s26 offen offset:0 lds
v_mfma_f32_16x16x32_bf16 a[228:231], a[8:11], a[136:139], 0
ds_read_b64_tr_b16 a[130:131], v4 offset:34816
v_mfma_f32_16x16x32_bf16 a[228:231], a[12:15], a[140:143], a[228:231]
v_mfma_f32_16x16x32_bf16 a[232:235], a[16:19], a[136:139], 0
ds_read_b64_tr_b16 a[132:133], v4 offset:49152
v_mfma_f32_16x16x32_bf16 a[232:235], a[20:23], a[140:143], a[232:235]
buffer_load_dwordx4 v17, s[12:15], s26 offen offset:1024 lds
v_mfma_f32_16x16x32_bf16 a[236:239], a[24:27], a[136:139], 0
ds_read_b64_tr_b16 a[134:135], v4 offset:51200
v_mfma_f32_16x16x32_bf16 a[236:239], a[28:31], a[140:143], a[236:239]
v_mfma_f32_16x16x32_bf16 a[240:243], a[32:35], a[136:139], 0
v_mfma_f32_16x16x32_bf16 a[240:243], a[36:39], a[140:143], a[240:243]
buffer_load_dwordx4 v18, s[12:15], s26 offen offset:2048 lds
v_mfma_f32_16x16x32_bf16 a[244:247], a[40:43], a[136:139], 0
v_mfma_f32_16x16x32_bf16 a[244:247], a[44:47], a[140:143], a[244:247]
v_mfma_f32_16x16x32_bf16 a[248:251], a[48:51], a[136:139], 0
v_mfma_f32_16x16x32_bf16 a[248:251], a[52:55], a[140:143], a[248:251]
buffer_load_dwordx4 v19, s[12:15], s26 offen offset:3072 lds
v_mfma_f32_16x16x32_bf16 a[252:255], a[56:59], a[136:139], 0
s_add_u32 s26, s26, 524288
v_mfma_f32_16x16x32_bf16 a[252:255], a[60:63], a[140:143], a[252:255]
s_waitcnt lgkmcnt(0)
Lg_501:
v_mfma_f32_16x16x32_bf16 v[32:35], a[64:67], a[128:131], v[32:35]
s_add_u32 m0, s29, 81920
ds_read_b64_tr_b16 a[136:137], v5 offset:32768
v_mfma_f32_16x16x32_bf16 v[32:35], a[68:71], a[132:135], v[32:35]
buffer_load_dwordx4 v16, s[12:15], s27 offen offset:0 lds
v_mfma_f32_16x16x32_bf16 v[36:39], a[72:75], a[128:131], v[36:39]
ds_read_b64_tr_b16 a[138:139], v5 offset:34816
v_mfma_f32_16x16x32_bf16 v[36:39], a[76:79], a[132:135], v[36:39]
v_mfma_f32_16x16x32_bf16 v[40:43], a[80:83], a[128:131], v[40:43]
ds_read_b64_tr_b16 a[140:141], v5 offset:49152
v_mfma_f32_16x16x32_bf16 v[40:43], a[84:87], a[132:135], v[40:43]
buffer_load_dwordx4 v17, s[12:15], s27 offen offset:1024 lds
v_mfma_f32_16x16x32_bf16 v[44:47], a[88:91], a[128:131], v[44:47]
ds_read_b64_tr_b16 a[142:143], v5 offset:51200
v_mfma_f32_16x16x32_bf16 v[44:47], a[92:95], a[132:135], v[44:47]
v_mfma_f32_16x16x32_bf16 v[48:51], a[96:99], a[128:131], v[48:51]
ds_read_b128 a[0:3], v2 offset:0
v_mfma_f32_16x16x32_bf16 v[48:51], a[100:103], a[132:135], v[48:51]
buffer_load_dwordx4 v18, s[12:15], s27 offen offset:2048 lds
v_mfma_f32_16x16x32_bf16 v[52:55], a[104:107], a[128:131], v[52:55]
ds_read_b128 a[4:7], v3 offset:0
v_mfma_f32_16x16x32_bf16 v[52:55], a[108:111], a[132:135], v[52:55]
v_mfma_f32_16x16x32_bf16 v[56:59], a[112:115], a[128:131], v[56:59]
v_mfma_f32_16x16x32_bf16 v[56:59], a[116:119], a[132:135], v[56:59]
buffer_load_dwordx4 v19, s[12:15], s27 offen offset:3072 lds
v_mfma_f32_16x16x32_bf16 v[60:63], a[120:123], a[128:131], v[60:63]
s_add_u32 s27, s27, 524288
ds_read_b128 a[8:11], v2 offset:2048
v_mfma_f32_16x16x32_bf16 v[60:63], a[124:127], a[132:135], v[60:63]
s_waitcnt lgkmcnt(3)
v_mfma_f32_16x16x32_bf16 v[64:67], a[64:67], a[136:139], v[64:67]
s_add_u32 m0, s28, 32768
ds_read_b64_tr_b16 a[128:129], v6 offset:32768
v_mfma_f32_16x16x32_bf16 v[64:67], a[68:71], a[140:143], v[64:67]
buffer_load_dwordx4 v12, s[8:11], s24 offen offset:0 lds
v_mfma_f32_16x16x32_bf16 v[68:71], a[72:75], a[136:139], v[68:71]
ds_read_b64_tr_b16 a[130:131], v6 offset:34816
v_mfma_f32_16x16x32_bf16 v[68:71], a[76:79], a[140:143], v[68:71]
v_mfma_f32_16x16x32_bf16 v[72:75], a[80:83], a[136:139], v[72:75]
ds_read_b64_tr_b16 a[132:133], v6 offset:49152
v_mfma_f32_16x16x32_bf16 v[72:75], a[84:87], a[140:143], v[72:75]
buffer_load_dwordx4 v13, s[8:11], s24 offen offset:1024 lds
v_mfma_f32_16x16x32_bf16 v[76:79], a[88:91], a[136:139], v[76:79]
ds_read_b64_tr_b16 a[134:135], v6 offset:51200
v_mfma_f32_16x16x32_bf16 v[76:79], a[92:95], a[140:143], v[76:79]
v_mfma_f32_16x16x32_bf16 v[80:83], a[96:99], a[136:139], v[80:83]
ds_read_b128 a[12:15], v3 offset:2048
v_mfma_f32_16x16x32_bf16 v[80:83], a[100:103], a[140:143], v[80:83]
buffer_load_dwordx4 v14, s[8:11], s24 offen offset:2048 lds
v_mfma_f32_16x16x32_bf16 v[84:87], a[104:107], a[136:139], v[84:87]
v_mfma_f32_16x16x32_bf16 v[84:87], a[108:111], a[140:143], v[84:87]
v_mfma_f32_16x16x32_bf16 v[88:91], a[112:115], a[136:139], v[88:91]
ds_read_b128 a[16:19], v2 offset:4096
v_mfma_f32_16x16x32_bf16 v[88:91], a[116:119], a[140:143], v[88:91]
buffer_load_dwordx4 v15, s[8:11], s24 offen offset:3072 lds
v_mfma_f32_16x16x32_bf16 v[92:95], a[120:123], a[136:139], v[92:95]
s_add_u32 s24, s24, 128
ds_read_b128 a[20:23], v3 offset:4096
v_mfma_f32_16x16x32_bf16 v[92:95], a[124:127], a[140:143], v[92:95]
s_waitcnt lgkmcnt(3)
v_mfma_f32_16x16x32_bf16 v[96:99], a[64:67], a[128:131], v[96:99]
s_add_u32 m0, s28, 36864
ds_read_b64_tr_b16 a[136:137], v7 offset:32768
v_mfma_f32_16x16x32_bf16 v[96:99], a[68:71], a[132:135], v[96:99]
buffer_load_dwordx4 v12, s[8:11], s25 offen offset:0 lds
v_mfma_f32_16x16x32_bf16 v[100:103], a[72:75], a[128:131], v[100:103]
ds_read_b64_tr_b16 a[138:139], v7 offset:34816
v_mfma_f32_16x16x32_bf16 v[100:103], a[76:79], a[132:135], v[100:103]
v_mfma_f32_16x16x32_bf16 v[104:107], a[80:83], a[128:131], v[104:107]
ds_read_b64_tr_b16 a[140:141], v7 offset:49152
v_mfma_f32_16x16x32_bf16 v[104:107], a[84:87], a[132:135], v[104:107]
buffer_load_dwordx4 v13, s[8:11], s25 offen offset:1024 lds
v_mfma_f32_16x16x32_bf16 v[108:111], a[88:91], a[128:131], v[108:111]
ds_read_b64_tr_b16 a[142:143], v7 offset:51200
v_mfma_f32_16x16x32_bf16 v[108:111], a[92:95], a[132:135], v[108:111]
v_mfma_f32_16x16x32_bf16 v[112:115], a[96:99], a[128:131], v[112:115]
v_mfma_f32_16x16x32_bf16 v[112:115], a[100:103], a[132:135], v[112:115]
buffer_load_dwordx4 v14, s[8:11], s25 offen offset:2048 lds
v_mfma_f32_16x16x32_bf16 v[116:119], a[104:107], a[128:131], v[116:119]
ds_read_b128 a[24:27], v2 offset:6144
v_mfma_f32_16x16x32_bf16 v[116:119], a[108:111], a[132:135], v[116:119]
v_mfma_f32_16x16x32_bf16 v[120:123], a[112:115], a[128:131], v[120:123]
ds_read_b128 a[28:31], v3 offset:6144
v_mfma_f32_16x16x32_bf16 v[120:123], a[116:119], a[132:135], v[120:123]
buffer_load_dwordx4 v15, s[8:11], s25 offen offset:3072 lds
v_mfma_f32_16x16x32_bf16 v[124:127], a[120:123], a[128:131], v[124:127]
s_add_u32 s25, s25, 128
v_mfma_f32_16x16x32_bf16 v[124:127], a[124:127], a[132:135], v[124:127]
s_waitcnt lgkmcnt(2)
v_mfma_f32_16x16x32_bf16 v[128:131], a[64:67], a[136:139], v[128:131]
ds_read_b64_tr_b16 a[128:129], v8 offset:32768
v_mfma_f32_16x16x32_bf16 v[128:131], a[68:71], a[140:143], v[128:131]
buffer_load_dword v21, v20, s[16:19], s43 offen
v_mfma_f32_16x16x32_bf16 v[132:135], a[72:75], a[136:139], v[132:135]
s_add_u32 s43, s43, s47
ds_read_b64_tr_b16 a[130:131], v8 offset:34816
v_mfma_f32_16x16x32_bf16 v[132:135], a[76:79], a[140:143], v[132:135]
s_cmp_ge_u32 s43, s51
v_mfma_f32_16x16x32_bf16 v[136:139], a[80:83], a[136:139], v[136:139]
s_cselect_b32 s43, 0, s43
ds_read_b64_tr_b16 a[132:133], v8 offset:49152
v_mfma_f32_16x16x32_bf16 v[136:139], a[84:87], a[140:143], v[136:139]
s_cselect_b32 s51, s42, s51
v_mfma_f32_16x16x32_bf16 v[140:143], a[88:91], a[136:139], v[140:143]
s_cselect_b64 s[16:17], s[40:41], s[16:17]
ds_read_b64_tr_b16 a[134:135], v8 offset:51200
v_mfma_f32_16x16x32_bf16 v[140:143], a[92:95], a[140:143], v[140:143]
s_cselect_b32 s18, s42, s18
v_mfma_f32_16x16x32_bf16 v[144:147], a[96:99], a[136:139], v[144:147]
s_cselect_b64 s[40:41], s[44:45], s[40:41]
ds_read_b128 a[32:35], v2 offset:8192
v_mfma_f32_16x16x32_bf16 v[144:147], a[100:103], a[140:143], v[144:147]
s_cselect_b32 s42, s46, s42
v_mfma_f32_16x16x32_bf16 v[148:151], a[104:107], a[136:139], v[148:151]
s_cselect_b32 s46, 0, s46
v_mfma_f32_16x16x32_bf16 v[148:151], a[108:111], a[140:143], v[148:151]
s_cmp_eq_u32 s30, s55
v_mfma_f32_16x16x32_bf16 v[152:155], a[112:115], a[136:139], v[152:155]
s_cselect_b32 s22, 0, 3221225472
ds_read_b128 a[36:39], v3 offset:8192
v_mfma_f32_16x16x32_bf16 v[152:155], a[116:119], a[140:143], v[152:155]
s_sub_u32 s30, s30, 1
buffer_atomic_add v27, v26, s[60:63], s22 offen sc1
v_mfma_f32_16x16x32_bf16 v[156:159], a[120:123], a[136:139], v[156:159]
ds_read_b128 a[40:43], v2 offset:10240
v_mfma_f32_16x16x32_bf16 v[156:159], a[124:127], a[140:143], v[156:159]
s_waitcnt lgkmcnt(3)
v_mfma_f32_16x16x32_bf16 v[160:163], a[64:67], a[128:131], v[160:163]
ds_read_b64_tr_b16 a[136:137], v9 offset:32768
v_mfma_f32_16x16x32_bf16 v[160:163], a[68:71], a[132:135], v[160:163]
v_mfma_f32_16x16x32_bf16 v[164:167], a[72:75], a[128:131], v[164:167]
ds_read_b64_tr_b16 a[138:139], v9 offset:34816
v_mfma_f32_16x16x32_bf16 v[164:167], a[76:79], a[132:135], v[164:167]
v_mfma_f32_16x16x32_bf16 v[168:171], a[80:83], a[128:131], v[168:171]
ds_read_b64_tr_b16 a[140:141], v9 offset:49152
v_mfma_f32_16x16x32_bf16 v[168:171], a[84:87], a[132:135], v[168:171]
v_mfma_f32_16x16x32_bf16 v[172:175], a[88:91], a[128:131], v[172:175]
ds_read_b64_tr_b16 a[142:143], v9 offset:51200
v_mfma_f32_16x16x32_bf16 v[172:175], a[92:95], a[132:135], v[172:175]
v_mfma_f32_16x16x32_bf16 v[176:179], a[96:99], a[128:131], v[176:179]
v_mfma_f32_16x16x32_bf16 v[176:179], a[100:103], a[132:135], v[176:179]
v_mfma_f32_16x16x32_bf16 v[180:183], a[104:107], a[128:131], v[180:183]
ds_read_b128 a[44:47], v3 offset:10240
v_mfma_f32_16x16x32_bf16 v[180:183], a[108:111], a[132:135], v[180:183]
v_mfma_f32_16x16x32_bf16 v[184:187], a[112:115], a[128:131], v[184:187]
ds_read_b128 a[48:51], v2 offset:12288
v_mfma_f32_16x16x32_bf16 v[184:187], a[116:119], a[132:135], v[184:187]
v_mfma_f32_16x16x32_bf16 v[188:191], a[120:123], a[128:131], v[188:191]
v_mfma_f32_16x16x32_bf16 v[188:191], a[124:127], a[132:135], v[188:191]
s_waitcnt lgkmcnt(2)
v_mfma_f32_16x16x32_bf16 v[192:195], a[64:67], a[136:139], v[192:195]
ds_read_b64_tr_b16 a[128:129], v10 offset:32768
v_mfma_f32_16x16x32_bf16 v[192:195], a[68:71], a[140:143], v[192:195]
v_mfma_f32_16x16x32_bf16 v[196:199], a[72:75], a[136:139], v[196:199]
ds_read_b64_tr_b16 a[130:131], v10 offset:34816
v_mfma_f32_16x16x32_bf16 v[196:199], a[76:79], a[140:143], v[196:199]
v_mfma_f32_16x16x32_bf16 v[200:203], a[80:83], a[136:139], v[200:203]
ds_read_b64_tr_b16 a[132:133], v10 offset:49152
v_mfma_f32_16x16x32_bf16 v[200:203], a[84:87], a[140:143], v[200:203]
v_mfma_f32_16x16x32_bf16 v[204:207], a[88:91], a[136:139], v[204:207]
ds_read_b64_tr_b16 a[134:135], v10 offset:51200
v_mfma_f32_16x16x32_bf16 v[204:207], a[92:95], a[140:143], v[204:207]
v_mfma_f32_16x16x32_bf16 v[208:211], a[96:99], a[136:139], v[208:211]
ds_read_b128 a[52:55], v3 offset:12288
v_mfma_f32_16x16x32_bf16 v[208:211], a[100:103], a[140:143], v[208:211]
v_mfma_f32_16x16x32_bf16 v[212:215], a[104:107], a[136:139], v[212:215]
ds_read_b128 a[56:59], v2 offset:14336
v_mfma_f32_16x16x32_bf16 v[212:215], a[108:111], a[140:143], v[212:215]
v_mfma_f32_16x16x32_bf16 v[216:219], a[112:115], a[136:139], v[216:219]
v_mfma_f32_16x16x32_bf16 v[216:219], a[116:119], a[140:143], v[216:219]
v_mfma_f32_16x16x32_bf16 v[220:223], a[120:123], a[136:139], v[220:223]
ds_read_b128 a[60:63], v3 offset:14336
v_mfma_f32_16x16x32_bf16 v[220:223], a[124:127], a[140:143], v[220:223]
s_waitcnt lgkmcnt(3)
v_mfma_f32_16x16x32_bf16 a[192:195], a[64:67], a[128:131], a[192:195]
ds_read_b64_tr_b16 a[136:137], v11 offset:32768
v_mfma_f32_16x16x32_bf16 a[192:195], a[68:71], a[132:135], a[192:195]
v_mfma_f32_16x16x32_bf16 a[196:199], a[72:75], a[128:131], a[196:199]
ds_read_b64_tr_b16 a[138:139], v11 offset:34816
v_mfma_f32_16x16x32_bf16 a[196:199], a[76:79], a[132:135], a[196:199]
v_mfma_f32_16x16x32_bf16 a[200:203], a[80:83], a[128:131], a[200:203]
ds_read_b64_tr_b16 a[140:141], v11 offset:49152
v_mfma_f32_16x16x32_bf16 a[200:203], a[84:87], a[132:135], a[200:203]
v_mfma_f32_16x16x32_bf16 a[204:207], a[88:91], a[128:131], a[204:207]
ds_read_b64_tr_b16 a[142:143], v11 offset:51200
v_mfma_f32_16x16x32_bf16 a[204:207], a[92:95], a[132:135], a[204:207]
v_mfma_f32_16x16x32_bf16 a[208:211], a[96:99], a[128:131], a[208:211]
v_mfma_f32_16x16x32_bf16 a[208:211], a[100:103], a[132:135], a[208:211]
v_mfma_f32_16x16x32_bf16 a[212:215], a[104:107], a[128:131], a[212:215]
v_mfma_f32_16x16x32_bf16 a[212:215], a[108:111], a[132:135], a[212:215]
v_mfma_f32_16x16x32_bf16 a[216:219], a[112:115], a[128:131], a[216:219]
v_mfma_f32_16x16x32_bf16 a[216:219], a[116:119], a[132:135], a[216:219]
v_mfma_f32_16x16x32_bf16 a[220:223], a[120:123], a[128:131], a[220:223]
s_waitcnt vmcnt(2) lgkmcnt(0)
v_mfma_f32_16x16x32_bf16 a[220:223], a[124:127], a[132:135], a[220:223]
s_barrier
v_mfma_f32_16x16x32_bf16 a[224:227], a[64:67], a[136:139], a[224:227]
s_add_u32 m0, s29, 98304
ds_read_b64_tr_b16 a[128:129], v4 offset:0
v_mfma_f32_16x16x32_bf16 a[224:227], a[68:71], a[140:143], a[224:227]
buffer_load_dwordx4 v16, s[12:15], s26 offen offset:0 lds
v_mfma_f32_16x16x32_bf16 a[228:231], a[72:75], a[136:139], a[228:231]
ds_read_b64_tr_b16 a[130:131], v4 offset:2048
v_mfma_f32_16x16x32_bf16 a[228:231], a[76:79], a[140:143], a[228:231]
v_mfma_f32_16x16x32_bf16 a[232:235], a[80:83], a[136:139], a[232:235]
ds_read_b64_tr_b16 a[132:133], v4 offset:16384
v_mfma_f32_16x16x32_bf16 a[232:235], a[84:87], a[140:143], a[232:235]
buffer_load_dwordx4 v17, s[12:15], s26 offen offset:1024 lds
v_mfma_f32_16x16x32_bf16 a[236:239], a[88:91], a[136:139], a[236:239]
ds_read_b64_tr_b16 a[134:135], v4 offset:18432
v_mfma_f32_16x16x32_bf16 a[236:239], a[92:95], a[140:143], a[236:239]
v_mfma_f32_16x16x32_bf16 a[240:243], a[96:99], a[136:139], a[240:243]
v_mfma_f32_16x16x32_bf16 a[240:243], a[100:103], a[140:143], a[240:243]
buffer_load_dwordx4 v18, s[12:15], s26 offen offset:2048 lds
v_mfma_f32_16x16x32_bf16 a[244:247], a[104:107], a[136:139], a[244:247]
v_mfma_f32_16x16x32_bf16 a[244:247], a[108:111], a[140:143], a[244:247]
v_mfma_f32_16x16x32_bf16 a[248:251], a[112:115], a[136:139], a[248:251]
v_mfma_f32_16x16x32_bf16 a[248:251], a[116:119], a[140:143], a[248:251]
buffer_load_dwordx4 v19, s[12:15], s26 offen offset:3072 lds
v_mfma_f32_16x16x32_bf16 a[252:255], a[120:123], a[136:139], a[252:255]
s_add_u32 s26, s26, 524288
v_mfma_f32_16x16x32_bf16 a[252:255], a[124:127], a[140:143], a[252:255]
s_waitcnt lgkmcnt(0)
buffer_store_dword v27, v26, s[4:7], s82 offen sc1
v_mfma_f32_16x16x32_bf16 v[32:35], a[0:3], a[128:131], v[32:35]
s_add_u32 m0, s29, 114688
ds_read_b64_tr_b16 a[136:137], v5 offset:0
v_mfma_f32_16x16x32_bf16 v[32:35], a[4:7], a[132:135], v[32:35]
buffer_load_dwordx4 v16, s[12:15], s27 offen offset:0 lds
v_mfma_f32_16x16x32_bf16 v[36:39], a[8:11], a[128:131], v[36:39]
ds_read_b64_tr_b16 a[138:139], v5 offset:2048
v_mfma_f32_16x16x32_bf16 v[36:39], a[12:15], a[132:135], v[36:39]
v_mfma_f32_16x16x32_bf16 v[40:43], a[16:19], a[128:131], v[40:43]
ds_read_b64_tr_b16 a[140:141], v5 offset:16384
v_mfma_f32_16x16x32_bf16 v[40:43], a[20:23], a[132:135], v[40:43]
buffer_load_dwordx4 v17, s[12:15], s27 offen offset:1024 lds
v_mfma_f32_16x16x32_bf16 v[44:47], a[24:27], a[128:131], v[44:47]
ds_read_b64_tr_b16 a[142:143], v5 offset:18432
v_mfma_f32_16x16x32_bf16 v[44:47], a[28:31], a[132:135], v[44:47]
v_mfma_f32_16x16x32_bf16 v[48:51], a[32:35], a[128:131], v[48:51]
ds_read_b128 a[64:67], v2 offset:32768
v_mfma_f32_16x16x32_bf16 v[48:51], a[36:39], a[132:135], v[48:51]
buffer_load_dwordx4 v18, s[12:15], s27 offen offset:2048 lds
v_mfma_f32_16x16x32_bf16 v[52:55], a[40:43], a[128:131], v[52:55]
ds_read_b128 a[68:71], v3 offset:32768
v_mfma_f32_16x16x32_bf16 v[52:55], a[44:47], a[132:135], v[52:55]
v_mfma_f32_16x16x32_bf16 v[56:59], a[48:51], a[128:131], v[56:59]
v_mfma_f32_16x16x32_bf16 v[56:59], a[52:55], a[132:135], v[56:59]
buffer_load_dwordx4 v19, s[12:15], s27 offen offset:3072 lds
v_mfma_f32_16x16x32_bf16 v[60:63], a[56:59], a[128:131], v[60:63]
s_add_u32 s27, s27, 524288
ds_read_b128 a[72:75], v2 offset:34816
v_mfma_f32_16x16x32_bf16 v[60:63], a[60:63], a[132:135], v[60:63]
s_waitcnt lgkmcnt(3)
v_mfma_f32_16x16x32_bf16 v[64:67], a[0:3], a[136:139], v[64:67]
s_add_u32 m0, s28, 0
ds_read_b64_tr_b16 a[128:129], v6 offset:0
v_mfma_f32_16x16x32_bf16 v[64:67], a[4:7], a[140:143], v[64:67]
buffer_load_dwordx4 v12, s[8:11], s24 offen offset:0 lds
v_mfma_f32_16x16x32_bf16 v[68:71], a[8:11], a[136:139], v[68:71]
ds_read_b64_tr_b16 a[130:131], v6 offset:2048
v_mfma_f32_16x16x32_bf16 v[68:71], a[12:15], a[140:143], v[68:71]
v_mfma_f32_16x16x32_bf16 v[72:75], a[16:19], a[136:139], v[72:75]
ds_read_b64_tr_b16 a[132:133], v6 offset:16384
v_mfma_f32_16x16x32_bf16 v[72:75], a[20:23], a[140:143], v[72:75]
buffer_load_dwordx4 v13, s[8:11], s24 offen offset:1024 lds
v_mfma_f32_16x16x32_bf16 v[76:79], a[24:27], a[136:139], v[76:79]
ds_read_b64_tr_b16 a[134:135], v6 offset:18432
v_mfma_f32_16x16x32_bf16 v[76:79], a[28:31], a[140:143], v[76:79]
v_mfma_f32_16x16x32_bf16 v[80:83], a[32:35], a[136:139], v[80:83]
ds_read_b128 a[76:79], v3 offset:34816
v_mfma_f32_16x16x32_bf16 v[80:83], a[36:39], a[140:143], v[80:83]
buffer_load_dwordx4 v14, s[8:11], s24 offen offset:2048 lds
v_mfma_f32_16x16x32_bf16 v[84:87], a[40:43], a[136:139], v[84:87]
v_mfma_f32_16x16x32_bf16 v[84:87], a[44:47], a[140:143], v[84:87]
v_mfma_f32_16x16x32_bf16 v[88:91], a[48:51], a[136:139], v[88:91]
ds_read_b128 a[80:83], v2 offset:36864
v_mfma_f32_16x16x32_bf16 v[88:91], a[52:55], a[140:143], v[88:91]
buffer_load_dwordx4 v15, s[8:11], s24 offen offset:3072 lds
v_mfma_f32_16x16x32_bf16 v[92:95], a[56:59], a[136:139], v[92:95]
s_add_u32 s24, s24, 128
ds_read_b128 a[84:87], v3 offset:36864
v_mfma_f32_16x16x32_bf16 v[92:95], a[60:63], a[140:143], v[92:95]
s_waitcnt lgkmcnt(3)
v_mfma_f32_16x16x32_bf16 v[96:99], a[0:3], a[128:131], v[96:99]
s_add_u32 m0, s28, 4096
ds_read_b64_tr_b16 a[136:137], v7 offset:0
v_mfma_f32_16x16x32_bf16 v[96:99], a[4:7], a[132:135], v[96:99]
buffer_load_dwordx4 v12, s[8:11], s25 offen offset:0 lds
v_mfma_f32_16x16x32_bf16 v[100:103], a[8:11], a[128:131], v[100:103]
ds_read_b64_tr_b16 a[138:139], v7 offset:2048
v_mfma_f32_16x16x32_bf16 v[100:103], a[12:15], a[132:135], v[100:103]
v_mfma_f32_16x16x32_bf16 v[104:107], a[16:19], a[128:131], v[104:107]
ds_read_b64_tr_b16 a[140:141], v7 offset:16384
v_mfma_f32_16x16x32_bf16 v[104:107], a[20:23], a[132:135], v[104:107]
buffer_load_dwordx4 v13, s[8:11], s25 offen offset:1024 lds
v_mfma_f32_16x16x32_bf16 v[108:111], a[24:27], a[128:131], v[108:111]
ds_read_b64_tr_b16 a[142:143], v7 offset:18432
v_mfma_f32_16x16x32_bf16 v[108:111], a[28:31], a[132:135], v[108:111]
v_mfma_f32_16x16x32_bf16 v[112:115], a[32:35], a[128:131], v[112:115]
v_mfma_f32_16x16x32_bf16 v[112:115], a[36:39], a[132:135], v[112:115]
buffer_load_dwordx4 v14, s[8:11], s25 offen offset:2048 lds
v_mfma_f32_16x16x32_bf16 v[116:119], a[40:43], a[128:131], v[116:119]
ds_read_b128 a[88:91], v2 offset:38912
v_mfma_f32_16x16x32_bf16 v[116:119], a[44:47], a[132:135], v[116:119]
v_mfma_f32_16x16x32_bf16 v[120:123], a[48:51], a[128:131], v[120:123]
ds_read_b128 a[92:95], v3 offset:38912
v_mfma_f32_16x16x32_bf16 v[120:123], a[52:55], a[132:135], v[120:123]
buffer_load_dwordx4 v15, s[8:11], s25 offen offset:3072 lds
v_mfma_f32_16x16x32_bf16 v[124:127], a[56:59], a[128:131], v[124:127]
s_add_u32 s25, s25, 128
v_mfma_f32_16x16x32_bf16 v[124:127], a[60:63], a[132:135], v[124:127]
s_waitcnt lgkmcnt(2)
v_mfma_f32_16x16x32_bf16 v[128:131], a[0:3], a[136:139], v[128:131]
ds_read_b64_tr_b16 a[128:129], v8 offset:0
v_mfma_f32_16x16x32_bf16 v[128:131], a[4:7], a[140:143], v[128:131]
buffer_load_dword v21, v20, s[16:19], s43 offen
v_mfma_f32_16x16x32_bf16 v[132:135], a[8:11], a[136:139], v[132:135]
s_add_u32 s43, s43, s47
ds_read_b64_tr_b16 a[130:131], v8 offset:2048
v_mfma_f32_16x16x32_bf16 v[132:135], a[12:15], a[140:143], v[132:135]
s_cmp_ge_u32 s43, s51
v_mfma_f32_16x16x32_bf16 v[136:139], a[16:19], a[136:139], v[136:139]
s_cselect_b32 s43, 0, s43
ds_read_b64_tr_b16 a[132:133], v8 offset:16384
v_mfma_f32_16x16x32_bf16 v[136:139], a[20:23], a[140:143], v[136:139]
s_cselect_b32 s51, s42, s51
v_mfma_f32_16x16x32_bf16 v[140:143], a[24:27], a[136:139], v[140:143]
s_cselect_b64 s[16:17], s[40:41], s[16:17]
ds_read_b64_tr_b16 a[134:135], v8 offset:18432
v_mfma_f32_16x16x32_bf16 v[140:143], a[28:31], a[140:143], v[140:143]
s_cselect_b32 s18, s42, s18
v_mfma_f32_16x16x32_bf16 v[144:147], a[32:35], a[136:139], v[144:147]
s_cselect_b64 s[40:41], s[44:45], s[40:41]
ds_read_b128 a[96:99], v2 offset:40960
v_mfma_f32_16x16x32_bf16 v[144:147], a[36:39], a[140:143], v[144:147]
s_cselect_b32 s42, s46, s42
v_mfma_f32_16x16x32_bf16 v[148:151], a[40:43], a[136:139], v[148:151]
s_cselect_b32 s46, 0, s46
v_mfma_f32_16x16x32_bf16 v[148:151], a[44:47], a[140:143], v[148:151]
s_cmp_eq_u32 s30, s55
v_mfma_f32_16x16x32_bf16 v[152:155], a[48:51], a[136:139], v[152:155]
s_cselect_b32 s22, 0, 3221225472
ds_read_b128 a[100:103], v3 offset:40960
v_mfma_f32_16x16x32_bf16 v[152:155], a[52:55], a[140:143], v[152:155]
s_sub_u32 s30, s30, 1
buffer_atomic_add v27, v26, s[60:63], s22 offen sc1
v_mfma_f32_16x16x32_bf16 v[156:159], a[56:59], a[136:139], v[156:159]
ds_read_b128 a[104:107], v2 offset:43008
v_mfma_f32_16x16x32_bf16 v[156:159], a[60:63], a[140:143], v[156:159]
s_waitcnt lgkmcnt(3)
v_mfma_f32_16x16x32_bf16 v[160:163], a[0:3], a[128:131], v[160:163]
ds_read_b64_tr_b16 a[136:137], v9 offset:0
v_mfma_f32_16x16x32_bf16 v[160:163], a[4:7], a[132:135], v[160:163]
v_mfma_f32_16x16x32_bf16 v[164:167], a[8:11], a[128:131], v[164:167]
ds_read_b64_tr_b16 a[138:139], v9 offset:2048
v_mfma_f32_16x16x32_bf16 v[164:167], a[12:15], a[132:135], v[164:167]
v_mfma_f32_16x16x32_bf16 v[168:171], a[16:19], a[128:131], v[168:171]
ds_read_b64_tr_b16 a[140:141], v9 offset:16384
v_mfma_f32_16x16x32_bf16 v[168:171], a[20:23], a[132:135], v[168:171]
v_mfma_f32_16x16x32_bf16 v[172:175], a[24:27], a[128:131], v[172:175]
ds_read_b64_tr_b16 a[142:143], v9 offset:18432
v_mfma_f32_16x16x32_bf16 v[172:175], a[28:31], a[132:135], v[172:175]
v_mfma_f32_16x16x32_bf16 v[176:179], a[32:35], a[128:131], v[176:179]
v_mfma_f32_16x16x32_bf16 v[176:179], a[36:39], a[132:135], v[176:179]
v_mfma_f32_16x16x32_bf16 v[180:183], a[40:43], a[128:131], v[180:183]
ds_read_b128 a[108:111], v3 offset:43008
v_mfma_f32_16x16x32_bf16 v[180:183], a[44:47], a[132:135], v[180:183]
v_mfma_f32_16x16x32_bf16 v[184:187], a[48:51], a[128:131], v[184:187]
ds_read_b128 a[112:115], v2 offset:45056
v_mfma_f32_16x16x32_bf16 v[184:187], a[52:55], a[132:135], v[184:187]
v_mfma_f32_16x16x32_bf16 v[188:191], a[56:59], a[128:131], v[188:191]
v_mfma_f32_16x16x32_bf16 v[188:191], a[60:63], a[132:135], v[188:191]
s_waitcnt lgkmcnt(2)
v_mfma_f32_16x16x32_bf16 v[192:195], a[0:3], a[136:139], v[192:195]
ds_read_b64_tr_b16 a[128:129], v10 offset:0
v_mfma_f32_16x16x32_bf16 v[192:195], a[4:7], a[140:143], v[192:195]
v_mfma_f32_16x16x32_bf16 v[196:199], a[8:11], a[136:139], v[196:199]
ds_read_b64_tr_b16 a[130:131], v10 offset:2048
v_mfma_f32_16x16x32_bf16 v[196:199], a[12:15], a[140:143], v[196:199]
v_mfma_f32_16x16x32_bf16 v[200:203], a[16:19], a[136:139], v[200:203]
ds_read_b64_tr_b16 a[132:133], v10 offset:16384
v_mfma_f32_16x16x32_bf16 v[200:203], a[20:23], a[140:143], v[200:203]
v_mfma_f32_16x16x32_bf16 v[204:207], a[24:27], a[136:139], v[204:207]
ds_read_b64_tr_b16 a[134:135], v10 offset:18432
v_mfma_f32_16x16x32_bf16 v[204:207], a[28:31], a[140:143], v[204:207]
v_mfma_f32_16x16x32_bf16 v[208:211], a[32:35], a[136:139], v[208:211]
ds_read_b128 a[116:119], v3 offset:45056
v_mfma_f32_16x16x32_bf16 v[208:211], a[36:39], a[140:143], v[208:211]
v_mfma_f32_16x16x32_bf16 v[212:215], a[40:43], a[136:139], v[212:215]
ds_read_b128 a[120:123], v2 offset:47104
v_mfma_f32_16x16x32_bf16 v[212:215], a[44:47], a[140:143], v[212:215]
v_mfma_f32_16x16x32_bf16 v[216:219], a[48:51], a[136:139], v[216:219]
v_mfma_f32_16x16x32_bf16 v[216:219], a[52:55], a[140:143], v[216:219]
v_mfma_f32_16x16x32_bf16 v[220:223], a[56:59], a[136:139], v[220:223]
ds_read_b128 a[124:127], v3 offset:47104
v_mfma_f32_16x16x32_bf16 v[220:223], a[60:63], a[140:143], v[220:223]
s_waitcnt lgkmcnt(3)
v_mfma_f32_16x16x32_bf16 a[192:195], a[0:3], a[128:131], a[192:195]
ds_read_b64_tr_b16 a[136:137], v11 offset:0
v_mfma_f32_16x16x32_bf16 a[192:195], a[4:7], a[132:135], a[192:195]
v_mfma_f32_16x16x32_bf16 a[196:199], a[8:11], a[128:131], a[196:199]
ds_read_b64_tr_b16 a[138:139], v11 offset:2048
v_mfma_f32_16x16x32_bf16 a[196:199], a[12:15], a[132:135], a[196:199]
v_mfma_f32_16x16x32_bf16 a[200:203], a[16:19], a[128:131], a[200:203]
ds_read_b64_tr_b16 a[140:141], v11 offset:16384
v_mfma_f32_16x16x32_bf16 a[200:203], a[20:23], a[132:135], a[200:203]
v_mfma_f32_16x16x32_bf16 a[204:207], a[24:27], a[128:131], a[204:207]
ds_read_b64_tr_b16 a[142:143], v11 offset:18432
v_mfma_f32_16x16x32_bf16 a[204:207], a[28:31], a[132:135], a[204:207]
v_mfma_f32_16x16x32_bf16 a[208:211], a[32:35], a[128:131], a[208:211]
v_mfma_f32_16x16x32_bf16 a[208:211], a[36:39], a[132:135], a[208:211]
v_mfma_f32_16x16x32_bf16 a[212:215], a[40:43], a[128:131], a[212:215]
v_mfma_f32_16x16x32_bf16 a[212:215], a[44:47], a[132:135], a[212:215]
v_mfma_f32_16x16x32_bf16 a[216:219], a[48:51], a[128:131], a[216:219]
v_mfma_f32_16x16x32_bf16 a[216:219], a[52:55], a[132:135], a[216:219]
v_mfma_f32_16x16x32_bf16 a[220:223], a[56:59], a[128:131], a[220:223]
s_waitcnt vmcnt(2) lgkmcnt(0)
v_mfma_f32_16x16x32_bf16 a[220:223], a[60:63], a[132:135], a[220:223]
s_barrier
v_mfma_f32_16x16x32_bf16 a[224:227], a[0:3], a[136:139], a[224:227]
s_add_u32 m0, s29, 65536
ds_read_b64_tr_b16 a[128:129], v4 offset:32768
v_mfma_f32_16x16x32_bf16 a[224:227], a[4:7], a[140:143], a[224:227]
buffer_load_dwordx4 v16, s[12:15], s26 offen offset:0 lds
v_mfma_f32_16x16x32_bf16 a[228:231], a[8:11], a[136:139], a[228:231]
ds_read_b64_tr_b16 a[130:131], v4 offset:34816
v_mfma_f32_16x16x32_bf16 a[228:231], a[12:15], a[140:143], a[228:231]
v_mfma_f32_16x16x32_bf16 a[232:235], a[16:19], a[136:139], a[232:235]
ds_read_b64_tr_b16 a[132:133], v4 offset:49152
v_mfma_f32_16x16x32_bf16 a[232:235], a[20:23], a[140:143], a[232:235]
buffer_load_dwordx4 v17, s[12:15], s26 offen offset:1024 lds
v_mfma_f32_16x16x32_bf16 a[236:239], a[24:27], a[136:139], a[236:239]
ds_read_b64_tr_b16 a[134:135], v4 offset:51200
v_mfma_f32_16x16x32_bf16 a[236:239], a[28:31], a[140:143], a[236:239]
v_mfma_f32_16x16x32_bf16 a[240:243], a[32:35], a[136:139], a[240:243]
v_mfma_f32_16x16x32_bf16 a[240:243], a[36:39], a[140:143], a[240:243]
buffer_load_dwordx4 v18, s[12:15], s26 offen offset:2048 lds
v_mfma_f32_16x16x32_bf16 a[244:247], a[40:43], a[136:139], a[244:247]
v_mfma_f32_16x16x32_bf16 a[244:247], a[44:47], a[140:143], a[244:247]
v_mfma_f32_16x16x32_bf16 a[248:251], a[48:51], a[136:139], a[248:251]
v_mfma_f32_16x16x32_bf16 a[248:251], a[52:55], a[140:143], a[248:251]
s_waitcnt lgkmcnt(0)
buffer_load_dwordx4 v19, s[12:15], s26 offen offset:3072 lds
v_mfma_f32_16x16x32_bf16 a[252:255], a[56:59], a[136:139], a[252:255]
s_add_u32 s26, s26, 524288
s_bitcmp1_b32 s30, 1
v_mfma_f32_16x16x32_bf16 a[252:255], a[60:63], a[140:143], a[252:255]
s_cbranch_scc1 Lg_501
s_cmp_eq_u32 s30, 0
s_cbranch_scc1 Lg_501t
v_mfma_f32_16x16x32_bf16 v[32:35], a[64:67], a[128:131], v[32:35]
s_add_u32 m0, s29, 81920
ds_read_b64_tr_b16 a[136:137], v5 offset:32768
v_mfma_f32_16x16x32_bf16 v[32:35], a[68:71], a[132:135], v[32:35]
buffer_load_dwordx4 v16, s[12:15], s27 offen offset:0 lds
v_mfma_f32_16x16x32_bf16 v[36:39], a[72:75], a[128:131], v[36:39]
s_lshl_b32 s22, s38, 3
ds_read_b64_tr_b16 a[138:139], v5 offset:34816
v_mfma_f32_16x16x32_bf16 v[36:39], a[76:79], a[132:135], v[36:39]
s_lshl_b32 s23, s39, 5
v_and_b32 v252, 31, v0
v_lshrrev_b32 v253, 5, v0
v_mfma_f32_16x16x32_bf16 v[40:43], a[80:83], a[128:131], v[40:43]
ds_read_b64_tr_b16 a[140:141], v5 offset:49152
v_add_u32 v253, s22, v253
v_mfma_f32_16x16x32_bf16 v[40:43], a[84:87], a[132:135], v[40:43]
buffer_load_dwordx4 v17, s[12:15], s27 offen offset:1024 lds
v_mfma_f32_16x16x32_bf16 v[44:47], a[88:91], a[128:131], v[44:47]
ds_read_b64_tr_b16 a[142:143], v5 offset:51200
v_add_u32 v252, s23, v252
v_mfma_f32_16x16x32_bf16 v[44:47], a[92:95], a[132:135], v[44:47]
v_mul_u32_u24 v254, 7168, v253
v_lshl_add_u32 v254, v252, 2, v254
v_mfma_f32_16x16x32_bf16 v[48:51], a[96:99], a[128:131], v[48:51]
ds_read_b128 a[0:3], v2 offset:0
v_lshlrev_b32 v252, 4, v252
v_mfma_f32_16x16x32_bf16 v[48:51], a[100:103], a[132:135], v[48:51]
buffer_load_dwordx4 v18, s[12:15], s27 offen offset:2048 lds
v_mfma_f32_16x16x32_bf16 v[52:55], a[104:107], a[128:131], v[52:55]
ds_read_b128 a[4:7], v3 offset:0
v_add_u32 v255, 3584, v254
v_mfma_f32_16x16x32_bf16 v[52:55], a[108:111], a[132:135], v[52:55]
v_subrev_u32 v22, 3584, v254
v_subrev_u32 v23, 2688, v254
v_mfma_f32_16x16x32_bf16 v[56:59], a[112:115], a[128:131], v[56:59]
v_subrev_u32 v24, 1792, v254
v_subrev_u32 v25, 896, v254
v_mfma_f32_16x16x32_bf16 v[56:59], a[116:119], a[132:135], v[56:59]
buffer_load_dwordx4 v19, s[12:15], s27 offen offset:3072 lds
v_mfma_f32_16x16x32_bf16 v[60:63], a[120:123], a[128:131], v[60:63]
s_add_u32 s27, s27, 524288
ds_read_b128 a[8:11], v2 offset:2048
v_mfma_f32_16x16x32_bf16 v[60:63], a[124:127], a[132:135], v[60:63]
PAD_23:
s_cbranch_execz PAD_27
s_waitcnt lgkmcnt(3)
v_mfma_f32_16x16x32_bf16 v[64:67], a[64:67], a[136:139], v[64:67]
s_add_u32 m0, s28, 32768
ds_read_b64_tr_b16 a[128:129], v6 offset:32768
v_mfma_f32_16x16x32_bf16 v[64:67], a[68:71], a[140:143], v[64:67]
buffer_load_dwordx4 v12, s[8:11], s24 offen offset:0 lds
v_mfma_f32_16x16x32_bf16 v[68:71], a[72:75], a[136:139], v[68:71]
ds_read_b64_tr_b16 a[130:131], v6 offset:34816
v_mfma_f32_16x16x32_bf16 v[68:71], a[76:79], a[140:143], v[68:71]
v_mfma_f32_16x16x32_bf16 v[72:75], a[80:83], a[136:139], v[72:75]
ds_read_b64_tr_b16 a[132:133], v6 offset:49152
v_mfma_f32_16x16x32_bf16 v[72:75], a[84:87], a[140:143], v[72:75]
buffer_load_dwordx4 v13, s[8:11], s24 offen offset:1024 lds
v_mfma_f32_16x16x32_bf16 v[76:79], a[88:91], a[136:139], v[76:79]
ds_read_b64_tr_b16 a[134:135], v6 offset:51200
v_mfma_f32_16x16x32_bf16 v[76:79], a[92:95], a[140:143], v[76:79]
v_mfma_f32_16x16x32_bf16 v[80:83], a[96:99], a[136:139], v[80:83]
ds_read_b128 a[12:15], v3 offset:2048
v_mfma_f32_16x16x32_bf16 v[80:83], a[100:103], a[140:143], v[80:83]
buffer_load_dwordx4 v14, s[8:11], s24 offen offset:2048 lds
v_mfma_f32_16x16x32_bf16 v[84:87], a[104:107], a[136:139], v[84:87]
v_mfma_f32_16x16x32_bf16 v[84:87], a[108:111], a[140:143], v[84:87]
v_mfma_f32_16x16x32_bf16 v[88:91], a[112:115], a[136:139], v[88:91]
ds_read_b128 a[16:19], v2 offset:4096
v_mfma_f32_16x16x32_bf16 v[88:91], a[116:119], a[140:143], v[88:91]
buffer_load_dwordx4 v15, s[8:11], s24 offen offset:3072 lds
v_mfma_f32_16x16x32_bf16 v[92:95], a[120:123], a[136:139], v[92:95]
s_add_u32 s24, s24, 128
ds_read_b128 a[20:23], v3 offset:4096
v_mfma_f32_16x16x32_bf16 v[92:95], a[124:127], a[140:143], v[92:95]
s_waitcnt lgkmcnt(3)
v_mfma_f32_16x16x32_bf16 v[96:99], a[64:67], a[128:131], v[96:99]
s_add_u32 m0, s28, 36864
ds_read_b64_tr_b16 a[136:137], v7 offset:32768
v_mfma_f32_16x16x32_bf16 v[96:99], a[68:71], a[132:135], v[96:99]
buffer_load_dwordx4 v12, s[8:11], s25 offen offset:0 lds
v_mfma_f32_16x16x32_bf16 v[100:103], a[72:75], a[128:131], v[100:103]
ds_read_b64_tr_b16 a[138:139], v7 offset:34816
v_mfma_f32_16x16x32_bf16 v[100:103], a[76:79], a[132:135], v[100:103]
v_mfma_f32_16x16x32_bf16 v[104:107], a[80:83], a[128:131], v[104:107]
ds_read_b64_tr_b16 a[140:141], v7 offset:49152
v_mfma_f32_16x16x32_bf16 v[104:107], a[84:87], a[132:135], v[104:107]
buffer_load_dwordx4 v13, s[8:11], s25 offen offset:1024 lds
v_mfma_f32_16x16x32_bf16 v[108:111], a[88:91], a[128:131], v[108:111]
ds_read_b64_tr_b16 a[142:143], v7 offset:51200
v_mfma_f32_16x16x32_bf16 v[108:111], a[92:95], a[132:135], v[108:111]
v_mfma_f32_16x16x32_bf16 v[112:115], a[96:99], a[128:131], v[112:115]
v_mfma_f32_16x16x32_bf16 v[112:115], a[100:103], a[132:135], v[112:115]
buffer_load_dwordx4 v14, s[8:11], s25 offen offset:2048 lds
v_mfma_f32_16x16x32_bf16 v[116:119], a[104:107], a[128:131], v[116:119]
ds_read_b128 a[24:27], v2 offset:6144
v_mfma_f32_16x16x32_bf16 v[116:119], a[108:111], a[132:135], v[116:119]
v_mfma_f32_16x16x32_bf16 v[120:123], a[112:115], a[128:131], v[120:123]
ds_read_b128 a[28:31], v3 offset:6144
v_mfma_f32_16x16x32_bf16 v[120:123], a[116:119], a[132:135], v[120:123]
buffer_load_dwordx4 v15, s[8:11], s25 offen offset:3072 lds
v_mfma_f32_16x16x32_bf16 v[124:127], a[120:123], a[128:131], v[124:127]
s_add_u32 s25, s25, 128
v_mfma_f32_16x16x32_bf16 v[124:127], a[124:127], a[132:135], v[124:127]
s_waitcnt lgkmcnt(2)
v_mfma_f32_16x16x32_bf16 v[128:131], a[64:67], a[136:139], v[128:131]
s_mov_b64 s[56:57], s[70:71]
s_mov_b32 s58, 3584
s_mov_b32 s59, 0x20000
ds_read_b64_tr_b16 a[128:129], v8 offset:32768
buffer_load_dwordx4 v[248:251], v252, s[56:59], 0 offen
v_mfma_f32_16x16x32_bf16 v[128:131], a[68:71], a[140:143], v[128:131]
s_mov_b64 s[56:57], s[66:67]
s_mov_b32 s58, 1835008
buffer_load_dword v224, v22, s[56:59], 0 offen nt
v_mfma_f32_16x16x32_bf16 v[132:135], a[72:75], a[136:139], v[132:135]
ds_read_b64_tr_b16 a[130:131], v8 offset:34816
buffer_load_dword v225, v23, s[56:59], 0 offen nt
v_mfma_f32_16x16x32_bf16 v[132:135], a[76:79], a[140:143], v[132:135]
buffer_load_dword v226, v24, s[56:59], 0 offen nt
v_mfma_f32_16x16x32_bf16 v[136:139], a[80:83], a[136:139], v[136:139]
ds_read_b64_tr_b16 a[132:133], v8 offset:49152
buffer_load_dword v227, v25, s[56:59], 0 offen nt
v_mfma_f32_16x16x32_bf16 v[136:139], a[84:87], a[140:143], v[136:139]
buffer_load_dword v228, v254, s[56:59], 0 offen offset:0 nt
v_mfma_f32_16x16x32_bf16 v[140:143], a[88:91], a[136:139], v[140:143]
ds_read_b64_tr_b16 a[134:135], v8 offset:51200
buffer_load_dword v229, v254, s[56:59], 0 offen offset:896 nt
v_mfma_f32_16x16x32_bf16 v[140:143], a[92:95], a[140:143], v[140:143]
buffer_load_dword v230, v254, s[56:59], 0 offen offset:1792 nt
v_mfma_f32_16x16x32_bf16 v[144:147], a[96:99], a[136:139], v[144:147]
ds_read_b128 a[32:35], v2 offset:8192
buffer_load_dword v231, v254, s[56:59], 0 offen offset:2688 nt
v_mfma_f32_16x16x32_bf16 v[144:147], a[100:103], a[140:143], v[144:147]
buffer_load_dword v232, v255, s[56:59], 0 offen offset:0 nt
v_mfma_f32_16x16x32_bf16 v[148:151], a[104:107], a[136:139], v[148:151]
buffer_load_dword v233, v255, s[56:59], 0 offen offset:896 nt
v_mfma_f32_16x16x32_bf16 v[148:151], a[108:111], a[140:143], v[148:151]
buffer_load_dword v234, v255, s[56:59], 0 offen offset:1792 nt
v_mfma_f32_16x16x32_bf16 v[152:155], a[112:115], a[136:139], v[152:155]
ds_read_b128 a[36:39], v3 offset:8192
buffer_load_dword v235, v255, s[56:59], 0 offen offset:2688 nt
v_mfma_f32_16x16x32_bf16 v[152:155], a[116:119], a[140:143], v[152:155]
s_mov_b64 s[56:57], s[68:69]
buffer_load_dword v236, v25, s[56:59], 0 offen nt
v_mfma_f32_16x16x32_bf16 v[156:159], a[120:123], a[136:139], v[156:159]
ds_read_b128 a[40:43], v2 offset:10240
buffer_load_dword v237, v254, s[56:59], 0 offen offset:0 nt
v_mfma_f32_16x16x32_bf16 v[156:159], a[124:127], a[140:143], v[156:159]
s_waitcnt lgkmcnt(3)
buffer_load_dword v238, v254, s[56:59], 0 offen offset:896 nt
v_mfma_f32_16x16x32_bf16 v[160:163], a[64:67], a[128:131], v[160:163]
ds_read_b64_tr_b16 a[136:137], v9 offset:32768
buffer_load_dword v239, v254, s[56:59], 0 offen offset:1792 nt
v_mfma_f32_16x16x32_bf16 v[160:163], a[68:71], a[132:135], v[160:163]
buffer_load_dword v240, v254, s[56:59], 0 offen offset:2688 nt
v_mfma_f32_16x16x32_bf16 v[164:167], a[72:75], a[128:131], v[164:167]
ds_read_b64_tr_b16 a[138:139], v9 offset:34816
buffer_load_dword v241, v255, s[56:59], 0 offen offset:0 nt
v_mfma_f32_16x16x32_bf16 v[164:167], a[76:79], a[132:135], v[164:167]
buffer_load_dword v242, v255, s[56:59], 0 offen offset:896 nt
v_mfma_f32_16x16x32_bf16 v[168:171], a[80:83], a[128:131], v[168:171]
ds_read_b64_tr_b16 a[140:141], v9 offset:49152
buffer_load_dword v243, v255, s[56:59], 0 offen offset:1792 nt
v_mfma_f32_16x16x32_bf16 v[168:171], a[84:87], a[132:135], v[168:171]
buffer_load_dword v244, v255, s[56:59], 0 offen offset:2688 nt
v_mfma_f32_16x16x32_bf16 v[172:175], a[88:91], a[128:131], v[172:175]
ds_read_b64_tr_b16 a[142:143], v9 offset:51200
v_mfma_f32_16x16x32_bf16 v[172:175], a[92:95], a[132:135], v[172:175]
v_mfma_f32_16x16x32_bf16 v[176:179], a[96:99], a[128:131], v[176:179]
v_mfma_f32_16x16x32_bf16 v[176:179], a[100:103], a[132:135], v[176:179]
v_mfma_f32_16x16x32_bf16 v[180:183], a[104:107], a[128:131], v[180:183]
ds_read_b128 a[44:47], v3 offset:10240
v_mfma_f32_16x16x32_bf16 v[180:183], a[108:111], a[132:135], v[180:183]
v_mfma_f32_16x16x32_bf16 v[184:187], a[112:115], a[128:131], v[184:187]
ds_read_b128 a[48:51], v2 offset:12288
v_mfma_f32_16x16x32_bf16 v[184:187], a[116:119], a[132:135], v[184:187]
v_mfma_f32_16x16x32_bf16 v[188:191], a[120:123], a[128:131], v[188:191]
v_mfma_f32_16x16x32_bf16 v[188:191], a[124:127], a[132:135], v[188:191]
s_waitcnt lgkmcnt(2)
v_mfma_f32_16x16x32_bf16 v[192:195], a[64:67], a[136:139], v[192:195]
ds_read_b64_tr_b16 a[128:129], v10 offset:32768
v_mfma_f32_16x16x32_bf16 v[192:195], a[68:71], a[140:143], v[192:195]
v_mfma_f32_16x16x32_bf16 v[196:199], a[72:75], a[136:139], v[196:199]
ds_read_b64_tr_b16 a[130:131], v10 offset:34816
v_mfma_f32_16x16x32_bf16 v[196:199], a[76:79], a[140:143], v[196:199]
v_mfma_f32_16x16x32_bf16 v[200:203], a[80:83], a[136:139], v[200:203]
ds_read_b64_tr_b16 a[132:133], v10 offset:49152
v_mfma_f32_16x16x32_bf16 v[200:203], a[84:87], a[140:143], v[200:203]
v_mfma_f32_16x16x32_bf16 v[204:207], a[88:91], a[136:139], v[204:207]
ds_read_b64_tr_b16 a[134:135], v10 offset:51200
v_mfma_f32_16x16x32_bf16 v[204:207], a[92:95], a[140:143], v[204:207]
v_mfma_f32_16x16x32_bf16 v[208:211], a[96:99], a[136:139], v[208:211]
ds_read_b128 a[52:55], v3 offset:12288
v_mfma_f32_16x16x32_bf16 v[208:211], a[100:103], a[140:143], v[208:211]
v_mfma_f32_16x16x32_bf16 v[212:215], a[104:107], a[136:139], v[212:215]
ds_read_b128 a[56:59], v2 offset:14336
v_mfma_f32_16x16x32_bf16 v[212:215], a[108:111], a[140:143], v[212:215]
v_mfma_f32_16x16x32_bf16 v[216:219], a[112:115], a[136:139], v[216:219]
v_mfma_f32_16x16x32_bf16 v[216:219], a[116:119], a[140:143], v[216:219]
v_mfma_f32_16x16x32_bf16 v[220:223], a[120:123], a[136:139], v[220:223]
ds_read_b128 a[60:63], v3 offset:14336
v_mfma_f32_16x16x32_bf16 v[220:223], a[124:127], a[140:143], v[220:223]
s_waitcnt lgkmcnt(3)
v_mfma_f32_16x16x32_bf16 a[192:195], a[64:67], a[128:131], a[192:195]
ds_read_b64_tr_b16 a[136:137], v11 offset:32768
v_mfma_f32_16x16x32_bf16 a[192:195], a[68:71], a[132:135], a[192:195]
v_mfma_f32_16x16x32_bf16 a[196:199], a[72:75], a[128:131], a[196:199]
ds_read_b64_tr_b16 a[138:139], v11 offset:34816
v_mfma_f32_16x16x32_bf16 a[196:199], a[76:79], a[132:135], a[196:199]
v_mfma_f32_16x16x32_bf16 a[200:203], a[80:83], a[128:131], a[200:203]
ds_read_b64_tr_b16 a[140:141], v11 offset:49152
v_mfma_f32_16x16x32_bf16 a[200:203], a[84:87], a[132:135], a[200:203]
v_mfma_f32_16x16x32_bf16 a[204:207], a[88:91], a[128:131], a[204:207]
ds_read_b64_tr_b16 a[142:143], v11 offset:51200
v_mfma_f32_16x16x32_bf16 a[204:207], a[92:95], a[132:135], a[204:207]
v_mfma_f32_16x16x32_bf16 a[208:211], a[96:99], a[128:131], a[208:211]
v_mfma_f32_16x16x32_bf16 a[208:211], a[100:103], a[132:135], a[208:211]
v_mfma_f32_16x16x32_bf16 a[212:215], a[104:107], a[128:131], a[212:215]
v_mfma_f32_16x16x32_bf16 a[212:215], a[108:111], a[132:135], a[212:215]
v_mfma_f32_16x16x32_bf16 a[216:219], a[112:115], a[128:131], a[216:219]
v_mfma_f32_16x16x32_bf16 a[216:219], a[116:119], a[132:135], a[216:219]
v_mfma_f32_16x16x32_bf16 a[220:223], a[120:123], a[128:131], a[220:223]
s_waitcnt vmcnt(22) lgkmcnt(0)
v_mfma_f32_16x16x32_bf16 a[220:223], a[124:127], a[132:135], a[220:223]
s_barrier
v_mfma_f32_16x16x32_bf16 a[224:227], a[64:67], a[136:139], a[224:227]
s_add_u32 m0, s29, 98304
ds_read_b64_tr_b16 a[128:129], v4 offset:0
v_mfma_f32_16x16x32_bf16 a[224:227], a[68:71], a[140:143], a[224:227]
buffer_load_dwordx4 v16, s[12:15], s26 offen offset:0 lds
v_mfma_f32_16x16x32_bf16 a[228:231], a[72:75], a[136:139], a[228:231]
ds_read_b64_tr_b16 a[130:131], v4 offset:2048
v_mfma_f32_16x16x32_bf16 a[228:231], a[76:79], a[140:143], a[228:231]
v_mfma_f32_16x16x32_bf16 a[232:235], a[80:83], a[136:139], a[232:235]
ds_read_b64_tr_b16 a[132:133], v4 offset:16384
v_mfma_f32_16x16x32_bf16 a[232:235], a[84:87], a[140:143], a[232:235]
buffer_load_dwordx4 v17, s[12:15], s26 offen offset:1024 lds
v_mfma_f32_16x16x32_bf16 a[236:239], a[88:91], a[136:139], a[236:239]
ds_read_b64_tr_b16 a[134:135], v4 offset:18432
v_mfma_f32_16x16x32_bf16 a[236:239], a[92:95], a[140:143], a[236:239]
v_mfma_f32_16x16x32_bf16 a[240:243], a[96:99], a[136:139], a[240:243]
v_mfma_f32_16x16x32_bf16 a[240:243], a[100:103], a[140:143], a[240:243]
buffer_load_dwordx4 v18, s[12:15], s26 offen offset:2048 lds
v_mfma_f32_16x16x32_bf16 a[244:247], a[104:107], a[136:139], a[244:247]
v_mfma_f32_16x16x32_bf16 a[244:247], a[108:111], a[140:143], a[244:247]
v_mfma_f32_16x16x32_bf16 a[248:251], a[112:115], a[136:139], a[248:251]
v_mfma_f32_16x16x32_bf16 a[248:251], a[116:119], a[140:143], a[248:251]
buffer_load_dwordx4 v19, s[12:15], s26 offen offset:3072 lds
v_mfma_f32_16x16x32_bf16 a[252:255], a[120:123], a[136:139], a[252:255]
s_add_u32 s26, s26, 524288
v_mfma_f32_16x16x32_bf16 a[252:255], a[124:127], a[140:143], a[252:255]
s_waitcnt lgkmcnt(0)
v_mfma_f32_16x16x32_bf16 v[32:35], a[0:3], a[128:131], v[32:35]
s_add_u32 m0, s29, 114688
ds_read_b64_tr_b16 a[136:137], v5 offset:0
v_mfma_f32_16x16x32_bf16 v[32:35], a[4:7], a[132:135], v[32:35]
buffer_load_dwordx4 v16, s[12:15], s27 offen offset:0 lds
v_mfma_f32_16x16x32_bf16 v[36:39], a[8:11], a[128:131], v[36:39]
ds_read_b64_tr_b16 a[138:139], v5 offset:2048
v_mfma_f32_16x16x32_bf16 v[36:39], a[12:15], a[132:135], v[36:39]
v_mfma_f32_16x16x32_bf16 v[40:43], a[16:19], a[128:131], v[40:43]
ds_read_b64_tr_b16 a[140:141], v5 offset:16384
v_mfma_f32_16x16x32_bf16 v[40:43], a[20:23], a[132:135], v[40:43]
buffer_load_dwordx4 v17, s[12:15], s27 offen offset:1024 lds
v_mfma_f32_16x16x32_bf16 v[44:47], a[24:27], a[128:131], v[44:47]
ds_read_b64_tr_b16 a[142:143], v5 offset:18432
v_mfma_f32_16x16x32_bf16 v[44:47], a[28:31], a[132:135], v[44:47]
v_mfma_f32_16x16x32_bf16 v[48:51], a[32:35], a[128:131], v[48:51]
ds_read_b128 a[64:67], v2 offset:32768
v_mfma_f32_16x16x32_bf16 v[48:51], a[36:39], a[132:135], v[48:51]
buffer_load_dwordx4 v18, s[12:15], s27 offen offset:2048 lds
v_mfma_f32_16x16x32_bf16 v[52:55], a[40:43], a[128:131], v[52:55]
ds_read_b128 a[68:71], v3 offset:32768
v_mfma_f32_16x16x32_bf16 v[52:55], a[44:47], a[132:135], v[52:55]
v_mfma_f32_16x16x32_bf16 v[56:59], a[48:51], a[128:131], v[56:59]
v_mfma_f32_16x16x32_bf16 v[56:59], a[52:55], a[132:135], v[56:59]
buffer_load_dwordx4 v19, s[12:15], s27 offen offset:3072 lds
v_mfma_f32_16x16x32_bf16 v[60:63], a[56:59], a[128:131], v[60:63]
s_add_u32 s27, s27, 524288
ds_read_b128 a[72:75], v2 offset:34816
v_mfma_f32_16x16x32_bf16 v[60:63], a[60:63], a[132:135], v[60:63]
s_waitcnt lgkmcnt(3)
v_mfma_f32_16x16x32_bf16 v[64:67], a[0:3], a[136:139], v[64:67]
s_add_u32 m0, s28, 0
ds_read_b64_tr_b16 a[128:129], v6 offset:0
v_mfma_f32_16x16x32_bf16 v[64:67], a[4:7], a[140:143], v[64:67]
buffer_load_dwordx4 v12, s[8:11], s24 offen offset:0 lds
v_mfma_f32_16x16x32_bf16 v[68:71], a[8:11], a[136:139], v[68:71]
ds_read_b64_tr_b16 a[130:131], v6 offset:2048
v_mfma_f32_16x16x32_bf16 v[68:71], a[12:15], a[140:143], v[68:71]
v_mfma_f32_16x16x32_bf16 v[72:75], a[16:19], a[136:139], v[72:75]
ds_read_b64_tr_b16 a[132:133], v6 offset:16384
v_mfma_f32_16x16x32_bf16 v[72:75], a[20:23], a[140:143], v[72:75]
buffer_load_dwordx4 v13, s[8:11], s24 offen offset:1024 lds
v_mfma_f32_16x16x32_bf16 v[76:79], a[24:27], a[136:139], v[76:79]
ds_read_b64_tr_b16 a[134:135], v6 offset:18432
v_mfma_f32_16x16x32_bf16 v[76:79], a[28:31], a[140:143], v[76:79]
v_mfma_f32_16x16x32_bf16 v[80:83], a[32:35], a[136:139], v[80:83]
ds_read_b128 a[76:79], v3 offset:34816
v_mfma_f32_16x16x32_bf16 v[80:83], a[36:39], a[140:143], v[80:83]
buffer_load_dwordx4 v14, s[8:11], s24 offen offset:2048 lds
v_mfma_f32_16x16x32_bf16 v[84:87], a[40:43], a[136:139], v[84:87]
v_mfma_f32_16x16x32_bf16 v[84:87], a[44:47], a[140:143], v[84:87]
v_mfma_f32_16x16x32_bf16 v[88:91], a[48:51], a[136:139], v[88:91]
ds_read_b128 a[80:83], v2 offset:36864
v_mfma_f32_16x16x32_bf16 v[88:91], a[52:55], a[140:143], v[88:91]
buffer_load_dwordx4 v15, s[8:11], s24 offen offset:3072 lds
v_mfma_f32_16x16x32_bf16 v[92:95], a[56:59], a[136:139], v[92:95]
s_add_u32 s24, s24, 128
ds_read_b128 a[84:87], v3 offset:36864
v_mfma_f32_16x16x32_bf16 v[92:95], a[60:63], a[140:143], v[92:95]
s_waitcnt lgkmcnt(3)
v_mfma_f32_16x16x32_bf16 v[96:99], a[0:3], a[128:131], v[96:99]
s_add_u32 m0, s28, 4096
ds_read_b64_tr_b16 a[136:137], v7 offset:0
v_mfma_f32_16x16x32_bf16 v[96:99], a[4:7], a[132:135], v[96:99]
buffer_load_dwordx4 v12, s[8:11], s25 offen offset:0 lds
v_mfma_f32_16x16x32_bf16 v[100:103], a[8:11], a[128:131], v[100:103]
ds_read_b64_tr_b16 a[138:139], v7 offset:2048
v_mfma_f32_16x16x32_bf16 v[100:103], a[12:15], a[132:135], v[100:103]
v_mfma_f32_16x16x32_bf16 v[104:107], a[16:19], a[128:131], v[104:107]
ds_read_b64_tr_b16 a[140:141], v7 offset:16384
v_mfma_f32_16x16x32_bf16 v[104:107], a[20:23], a[132:135], v[104:107]
buffer_load_dwordx4 v13, s[8:11], s25 offen offset:1024 lds
v_mfma_f32_16x16x32_bf16 v[108:111], a[24:27], a[128:131], v[108:111]
ds_read_b64_tr_b16 a[142:143], v7 offset:18432
v_mfma_f32_16x16x32_bf16 v[108:111], a[28:31], a[132:135], v[108:111]
v_mfma_f32_16x16x32_bf16 v[112:115], a[32:35], a[128:131], v[112:115]
v_mfma_f32_16x16x32_bf16 v[112:115], a[36:39], a[132:135], v[112:115]
buffer_load_dwordx4 v14, s[8:11], s25 offen offset:2048 lds
v_mfma_f32_16x16x32_bf16 v[116:119], a[40:43], a[128:131], v[116:119]
ds_read_b128 a[88:91], v2 offset:38912
v_mfma_f32_16x16x32_bf16 v[116:119], a[44:47], a[132:135], v[116:119]
v_mfma_f32_16x16x32_bf16 v[120:123], a[48:51], a[128:131], v[120:123]
ds_read_b128 a[92:95], v3 offset:38912
v_mfma_f32_16x16x32_bf16 v[120:123], a[52:55], a[132:135], v[120:123]
buffer_load_dwordx4 v15, s[8:11], s25 offen offset:3072 lds
v_mfma_f32_16x16x32_bf16 v[124:127], a[56:59], a[128:131], v[124:127]
s_add_u32 s25, s25, 128
v_mfma_f32_16x16x32_bf16 v[124:127], a[60:63], a[132:135], v[124:127]
s_waitcnt lgkmcnt(2)
v_mfma_f32_16x16x32_bf16 v[128:131], a[0:3], a[136:139], v[128:131]
ds_read_b64_tr_b16 a[128:129], v8 offset:0
v_mfma_f32_16x16x32_bf16 v[128:131], a[4:7], a[140:143], v[128:131]
buffer_load_dword v21, v20, s[16:19], s43 offen
v_mfma_f32_16x16x32_bf16 v[132:135], a[8:11], a[136:139], v[132:135]
s_add_u32 s43, s43, s47
ds_read_b64_tr_b16 a[130:131], v8 offset:2048
v_mfma_f32_16x16x32_bf16 v[132:135], a[12:15], a[140:143], v[132:135]
s_cmp_ge_u32 s43, s51
v_mfma_f32_16x16x32_bf16 v[136:139], a[16:19], a[136:139], v[136:139]
s_cselect_b32 s43, 0, s43
ds_read_b64_tr_b16 a[132:133], v8 offset:16384
v_mfma_f32_16x16x32_bf16 v[136:139], a[20:23], a[140:143], v[136:139]
s_cselect_b32 s51, s42, s51
v_mfma_f32_16x16x32_bf16 v[140:143], a[24:27], a[136:139], v[140:143]
s_cselect_b64 s[16:17], s[40:41], s[16:17]
ds_read_b64_tr_b16 a[134:135], v8 offset:18432
v_mfma_f32_16x16x32_bf16 v[140:143], a[28:31], a[140:143], v[140:143]
s_cselect_b32 s18, s42, s18
v_mfma_f32_16x16x32_bf16 v[144:147], a[32:35], a[136:139], v[144:147]
s_cselect_b64 s[40:41], s[44:45], s[40:41]
ds_read_b128 a[96:99], v2 offset:40960
v_mfma_f32_16x16x32_bf16 v[144:147], a[36:39], a[140:143], v[144:147]
s_cselect_b32 s42, s46, s42
v_mfma_f32_16x16x32_bf16 v[148:151], a[40:43], a[136:139], v[148:151]
s_cselect_b32 s46, 0, s46
v_mfma_f32_16x16x32_bf16 v[148:151], a[44:47], a[140:143], v[148:151]
s_lshl_b32 s59, s39, 5
v_mfma_f32_16x16x32_bf16 v[152:155], a[48:51], a[136:139], v[152:155]
s_add_u32 s59, s59, s38
ds_read_b128 a[100:103], v3 offset:40960
v_mfma_f32_16x16x32_bf16 v[152:155], a[52:55], a[140:143], v[152:155]
s_lshl_b32 s59, s59, 2
v_mfma_f32_16x16x32_bf16 v[156:159], a[56:59], a[136:139], v[156:159]
s_add_u32 s59, s59, 94392320
ds_read_b128 a[104:107], v2 offset:43008
v_mfma_f32_16x16x32_bf16 v[156:159], a[60:63], a[140:143], v[156:159]
s_waitcnt lgkmcnt(3)
s_cmp_lt_u32 s2, 224
v_mfma_f32_16x16x32_bf16 v[160:163], a[0:3], a[128:131], v[160:163]
s_cselect_b32 s59, s59, 3221225472
ds_read_b64_tr_b16 a[136:137], v9 offset:0
v_mfma_f32_16x16x32_bf16 v[160:163], a[4:7], a[132:135], v[160:163]
s_mov_b32 s58, 0xffff0000
v_mfma_f32_16x16x32_bf16 v[164:167], a[8:11], a[128:131], v[164:167]
ds_read_b64_tr_b16 a[138:139], v9 offset:2048
v_mfma_f32_16x16x32_bf16 v[164:167], a[12:15], a[132:135], v[164:167]
buffer_load_dword v21, v20, s[16:19], s43 offen
v_mfma_f32_16x16x32_bf16 v[168:171], a[16:19], a[128:131], v[168:171]
s_add_u32 s43, s43, s47
ds_read_b64_tr_b16 a[140:141], v9 offset:16384
v_mfma_f32_16x16x32_bf16 v[168:171], a[20:23], a[132:135], v[168:171]
s_cmp_ge_u32 s43, s51
v_mfma_f32_16x16x32_bf16 v[172:175], a[24:27], a[128:131], v[172:175]
s_cselect_b32 s43, 0, s43
ds_read_b64_tr_b16 a[142:143], v9 offset:18432
v_mfma_f32_16x16x32_bf16 v[172:175], a[28:31], a[132:135], v[172:175]
s_cselect_b32 s51, s42, s51
v_mfma_f32_16x16x32_bf16 v[176:179], a[32:35], a[128:131], v[176:179]
s_cselect_b64 s[16:17], s[40:41], s[16:17]
v_mfma_f32_16x16x32_bf16 v[176:179], a[36:39], a[132:135], v[176:179]
s_cselect_b32 s18, s42, s18
v_mfma_f32_16x16x32_bf16 v[180:183], a[40:43], a[128:131], v[180:183]
s_cselect_b64 s[40:41], s[44:45], s[40:41]
ds_read_b128 a[108:111], v3 offset:43008
v_mfma_f32_16x16x32_bf16 v[180:183], a[44:47], a[132:135], v[180:183]
s_cselect_b32 s42, s46, s42
v_mfma_f32_16x16x32_bf16 v[184:187], a[48:51], a[128:131], v[184:187]
s_cselect_b32 s46, 0, s46
ds_read_b128 a[112:115], v2 offset:45056
v_mfma_f32_16x16x32_bf16 v[184:187], a[52:55], a[132:135], v[184:187]
v_mfma_f32_16x16x32_bf16 v[188:191], a[56:59], a[128:131], v[188:191]
v_mfma_f32_16x16x32_bf16 v[188:191], a[60:63], a[132:135], v[188:191]
s_waitcnt lgkmcnt(2)
v_mfma_f32_16x16x32_bf16 v[192:195], a[0:3], a[136:139], v[192:195]
ds_read_b64_tr_b16 a[128:129], v10 offset:0
v_mfma_f32_16x16x32_bf16 v[192:195], a[4:7], a[140:143], v[192:195]
v_mfma_f32_16x16x32_bf16 v[196:199], a[8:11], a[136:139], v[196:199]
ds_read_b64_tr_b16 a[130:131], v10 offset:2048
v_mfma_f32_16x16x32_bf16 v[196:199], a[12:15], a[140:143], v[196:199]
v_mfma_f32_16x16x32_bf16 v[200:203], a[16:19], a[136:139], v[200:203]
ds_read_b64_tr_b16 a[132:133], v10 offset:16384
v_mfma_f32_16x16x32_bf16 v[200:203], a[20:23], a[140:143], v[200:203]
v_mfma_f32_16x16x32_bf16 v[204:207], a[24:27], a[136:139], v[204:207]
ds_read_b64_tr_b16 a[134:135], v10 offset:18432
v_mfma_f32_16x16x32_bf16 v[204:207], a[28:31], a[140:143], v[204:207]
v_mfma_f32_16x16x32_bf16 v[208:211], a[32:35], a[136:139], v[208:211]
ds_read_b128 a[116:119], v3 offset:45056
v_mfma_f32_16x16x32_bf16 v[208:211], a[36:39], a[140:143], v[208:211]
v_mfma_f32_16x16x32_bf16 v[212:215], a[40:43], a[136:139], v[212:215]
ds_read_b128 a[120:123], v2 offset:47104
v_and_b32 v252, 31, v0
v_mfma_f32_16x16x32_bf16 v[212:215], a[44:47], a[140:143], v[212:215]
v_lshrrev_b32 v253, 5, v0
v_xor_b32 v253, v253, v252
v_mfma_f32_16x16x32_bf16 v[216:219], a[48:51], a[136:139], v[216:219]
v_and_b32 v253, 7, v253
v_lshlrev_b32 v252, 8, v252
v_mfma_f32_16x16x32_bf16 v[216:219], a[52:55], a[140:143], v[216:219]
v_lshl_add_u32 v252, v253, 4, v252
v_add_u32 v252, 147456, v252
v_mfma_f32_16x16x32_bf16 v[220:223], a[56:59], a[136:139], v[220:223]
ds_read_b128 a[124:127], v3 offset:47104
v_mfma_f32_16x16x32_bf16 v[220:223], a[60:63], a[140:143], v[220:223]
s_waitcnt lgkmcnt(3)
v_mfma_f32_16x16x32_bf16 a[192:195], a[0:3], a[128:131], a[192:195]
ds_read_b64_tr_b16 a[136:137], v11 offset:0
v_mfma_f32_16x16x32_bf16 a[192:195], a[4:7], a[132:135], a[192:195]
v_mfma_f32_16x16x32_bf16 a[196:199], a[8:11], a[128:131], a[196:199]
ds_read_b64_tr_b16 a[138:139], v11 offset:2048
v_mfma_f32_16x16x32_bf16 a[196:199], a[12:15], a[132:135], a[196:199]
v_mfma_f32_16x16x32_bf16 a[200:203], a[16:19], a[128:131], a[200:203]
ds_read_b64_tr_b16 a[140:141], v11 offset:16384
v_mfma_f32_16x16x32_bf16 a[200:203], a[20:23], a[132:135], a[200:203]
v_mfma_f32_16x16x32_bf16 a[204:207], a[24:27], a[128:131], a[204:207]
ds_read_b64_tr_b16 a[142:143], v11 offset:18432
v_mfma_f32_16x16x32_bf16 a[204:207], a[28:31], a[132:135], a[204:207]
v_mfma_f32_16x16x32_bf16 a[208:211], a[32:35], a[128:131], a[208:211]
v_mfma_f32_16x16x32_bf16 a[208:211], a[36:39], a[132:135], a[208:211]
v_mfma_f32_16x16x32_bf16 a[212:215], a[40:43], a[128:131], a[212:215]
v_mfma_f32_16x16x32_bf16 a[212:215], a[44:47], a[132:135], a[212:215]
v_mfma_f32_16x16x32_bf16 a[216:219], a[48:51], a[128:131], a[216:219]
v_mfma_f32_16x16x32_bf16 a[216:219], a[52:55], a[132:135], a[216:219]
v_mfma_f32_16x16x32_bf16 a[220:223], a[56:59], a[128:131], a[220:223]
s_waitcnt vmcnt(2) lgkmcnt(0)
v_mfma_f32_16x16x32_bf16 a[220:223], a[60:63], a[132:135], a[220:223]
s_barrier
v_mfma_f32_16x16x32_bf16 a[224:227], a[0:3], a[136:139], a[224:227]
s_add_u32 m0, s29, 65536
ds_read_b64_tr_b16 a[128:129], v4 offset:32768
v_lshlrev_b32 v28, 16, v248
v_mfma_f32_16x16x32_bf16 a[224:227], a[4:7], a[140:143], a[224:227]
buffer_load_dwordx4 v16, s[12:15], s26 offen offset:0 lds
v_mfma_f32_16x16x32_bf16 a[228:231], a[8:11], a[136:139], a[228:231]
ds_read_b64_tr_b16 a[130:131], v4 offset:34816
v_and_b32 v29, s58, v248
v_mfma_f32_16x16x32_bf16 a[228:231], a[12:15], a[140:143], a[228:231]
v_lshlrev_b32 v30, 16, v249
v_and_b32 v253, s58, v249
v_mfma_f32_16x16x32_bf16 a[232:235], a[16:19], a[136:139], a[232:235]
ds_read_b64_tr_b16 a[132:133], v4 offset:49152
v_lshlrev_b32 v22, 16, v224
v_mfma_f32_16x16x32_bf16 a[232:235], a[20:23], a[140:143], a[232:235]
buffer_load_dwordx4 v17, s[12:15], s26 offen offset:1024 lds
v_mfma_f32_16x16x32_bf16 a[236:239], a[24:27], a[136:139], a[236:239]
ds_read_b64_tr_b16 a[134:135], v4 offset:51200
v_lshlrev_b32 v23, 16, v225
v_mfma_f32_16x16x32_bf16 a[236:239], a[28:31], a[140:143], a[236:239]
v_lshlrev_b32 v24, 16, v226
v_mul_f32 v254, v22, v253
v_mfma_f32_16x16x32_bf16 a[240:243], a[32:35], a[136:139], a[240:243]
v_lshlrev_b32 v25, 16, v227
v_lshlrev_b32 v247, 16, v236
v_mfma_f32_16x16x32_bf16 a[240:243], a[36:39], a[140:143], a[240:243]
buffer_load_dwordx4 v18, s[12:15], s26 offen offset:2048 lds
v_mfma_f32_16x16x32_bf16 a[244:247], a[40:43], a[136:139], a[244:247]
v_fmac_f32 v254, v23, v30
v_fmac_f32 v254, v24, v29
v_mfma_f32_16x16x32_bf16 a[244:247], a[44:47], a[140:143], a[244:247]
v_fmac_f32 v254, v25, v28
v_mul_f32 v254, v254, v247
v_mfma_f32_16x16x32_bf16 a[248:251], a[48:51], a[136:139], a[248:251]
v_mul_f32 v255, v23, v253
v_lshlrev_b32 v22, 16, v228
v_mfma_f32_16x16x32_bf16 a[248:251], a[52:55], a[140:143], a[248:251]
buffer_load_dwordx4 v19, s[12:15], s26 offen offset:3072 lds
v_mfma_f32_16x16x32_bf16 a[252:255], a[56:59], a[136:139], a[252:255]
s_add_u32 s26, s26, 524288
v_lshlrev_b32 v247, 16, v237
v_fmac_f32 v255, v24, v30
v_mfma_f32_16x16x32_bf16 a[252:255], a[60:63], a[140:143], a[252:255]
s_waitcnt lgkmcnt(0)
v_fmac_f32 v255, v25, v29
v_fmac_f32 v255, v22, v28
v_mfma_f32_16x16x32_bf16 v[32:35], a[64:67], a[128:131], v[32:35]
s_add_u32 m0, s29, 81920
ds_read_b64_tr_b16 a[136:137], v5 offset:32768
v_mul_f32 v255, v255, v247
v_mfma_f32_16x16x32_bf16 v[32:35], a[68:71], a[132:135], v[32:35]
buffer_load_dwordx4 v16, s[12:15], s27 offen offset:0 lds
v_mfma_f32_16x16x32_bf16 v[36:39], a[72:75], a[128:131], v[36:39]
ds_read_b64_tr_b16 a[138:139], v5 offset:34816
v_cvt_pk_bf16_f32 v246, v254, v255
v_mfma_f32_16x16x32_bf16 v[36:39], a[76:79], a[132:135], v[36:39]
v_accvgpr_write_b32 a180, v246
v_mul_f32 v254, v24, v253
v_mfma_f32_16x16x32_bf16 v[40:43], a[80:83], a[128:131], v[40:43]
ds_read_b64_tr_b16 a[140:141], v5 offset:49152
v_lshlrev_b32 v23, 16, v229
v_mfma_f32_16x16x32_bf16 v[40:43], a[84:87], a[132:135], v[40:43]
buffer_load_dwordx4 v17, s[12:15], s27 offen offset:1024 lds
v_lshlrev_b32 v247, 16, v238
v_mfma_f32_16x16x32_bf16 v[44:47], a[88:91], a[128:131], v[44:47]
ds_read_b64_tr_b16 a[142:143], v5 offset:51200
v_fmac_f32 v254, v25, v30
v_mfma_f32_16x16x32_bf16 v[44:47], a[92:95], a[132:135], v[44:47]
v_fmac_f32 v254, v22, v29
v_fmac_f32 v254, v23, v28
v_mfma_f32_16x16x32_bf16 v[48:51], a[96:99], a[128:131], v[48:51]
ds_read_b128 a[0:3], v2 offset:0
v_mul_f32 v254, v254, v247
v_mfma_f32_16x16x32_bf16 v[48:51], a[100:103], a[132:135], v[48:51]
buffer_load_dwordx4 v18, s[12:15], s27 offen offset:2048 lds
v_mfma_f32_16x16x32_bf16 v[52:55], a[104:107], a[128:131], v[52:55]
ds_read_b128 a[4:7], v3 offset:0
v_cvt_pk_bf16_f32 v246, v255, v254
v_accvgpr_write_b32 a176, v246
v_mfma_f32_16x16x32_bf16 v[52:55], a[108:111], a[132:135], v[52:55]
v_mul_f32 v255, v25, v253
v_lshlrev_b32 v24, 16, v230
v_mfma_f32_16x16x32_bf16 v[56:59], a[112:115], a[128:131], v[56:59]
v_lshlrev_b32 v247, 16, v239
v_fmac_f32 v255, v22, v30
v_mfma_f32_16x16x32_bf16 v[56:59], a[116:119], a[132:135], v[56:59]
buffer_load_dwordx4 v19, s[12:15], s27 offen offset:3072 lds
v_mfma_f32_16x16x32_bf16 v[60:63], a[120:123], a[128:131], v[60:63]
s_add_u32 s27, s27, 524288
ds_read_b128 a[8:11], v2 offset:2048
v_fmac_f32 v255, v23, v29
v_mfma_f32_16x16x32_bf16 v[60:63], a[124:127], a[132:135], v[60:63]
s_waitcnt lgkmcnt(3)
v_fmac_f32 v255, v24, v28
v_mul_f32 v255, v255, v247
v_mfma_f32_16x16x32_bf16 v[64:67], a[64:67], a[136:139], v[64:67]
s_add_u32 m0, s28, 32768
ds_read_b64_tr_b16 a[128:129], v6 offset:32768
v_cvt_pk_bf16_f32 v246, v254, v255
v_accvgpr_write_b32 a181, v246
v_mfma_f32_16x16x32_bf16 v[64:67], a[68:71], a[140:143], v[64:67]
buffer_load_dwordx4 v12, s[8:11], s24 offen offset:0 lds
v_mfma_f32_16x16x32_bf16 v[68:71], a[72:75], a[136:139], v[68:71]
ds_read_b64_tr_b16 a[130:131], v6 offset:34816
v_mul_f32 v254, v22, v253
v_mfma_f32_16x16x32_bf16 v[68:71], a[76:79], a[140:143], v[68:71]
v_lshlrev_b32 v25, 16, v231
v_lshlrev_b32 v247, 16, v240
v_mfma_f32_16x16x32_bf16 v[72:75], a[80:83], a[136:139], v[72:75]
ds_read_b64_tr_b16 a[132:133], v6 offset:49152
v_fmac_f32 v254, v23, v30
v_mfma_f32_16x16x32_bf16 v[72:75], a[84:87], a[140:143], v[72:75]
buffer_load_dwordx4 v13, s[8:11], s24 offen offset:1024 lds
v_fmac_f32 v254, v24, v29
v_mfma_f32_16x16x32_bf16 v[76:79], a[88:91], a[136:139], v[76:79]
ds_read_b64_tr_b16 a[134:135], v6 offset:51200
v_fmac_f32 v254, v25, v28
v_mfma_f32_16x16x32_bf16 v[76:79], a[92:95], a[140:143], v[76:79]
v_mul_f32 v254, v254, v247
v_cvt_pk_bf16_f32 v246, v255, v254
v_mfma_f32_16x16x32_bf16 v[80:83], a[96:99], a[136:139], v[80:83]
ds_read_b128 a[12:15], v3 offset:2048
v_accvgpr_write_b32 a177, v246
v_mfma_f32_16x16x32_bf16 v[80:83], a[100:103], a[140:143], v[80:83]
buffer_load_dwordx4 v14, s[8:11], s24 offen offset:2048 lds
v_mfma_f32_16x16x32_bf16 v[84:87], a[104:107], a[136:139], v[84:87]
v_mul_f32 v255, v23, v253
v_lshlrev_b32 v22, 16, v232
v_lshlrev_b32 v247, 16, v241
v_mfma_f32_16x16x32_bf16 v[84:87], a[108:111], a[140:143], v[84:87]
v_fmac_f32 v255, v24, v30
v_fmac_f32 v255, v25, v29
v_mfma_f32_16x16x32_bf16 v[88:91], a[112:115], a[136:139], v[88:91]
ds_read_b128 a[16:19], v2 offset:4096
v_fmac_f32 v255, v22, v28
v_mfma_f32_16x16x32_bf16 v[88:91], a[116:119], a[140:143], v[88:91]
PAD_24:
s_cbranch_execz PAD_28
buffer_load_dwordx4 v15, s[8:11], s24 offen offset:3072 lds
v_mfma_f32_16x16x32_bf16 v[92:95], a[120:123], a[136:139], v[92:95]
s_add_u32 s24, s24, 128
ds_read_b128 a[20:23], v3 offset:4096
v_mul_f32 v255, v255, v247
v_mfma_f32_16x16x32_bf16 v[92:95], a[124:127], a[140:143], v[92:95]
s_waitcnt lgkmcnt(3)
v_cvt_pk_bf16_f32 v246, v254, v255
v_accvgpr_write_b32 a182, v246
v_mfma_f32_16x16x32_bf16 v[96:99], a[64:67], a[128:131], v[96:99]
s_add_u32 m0, s28, 36864
ds_read_b64_tr_b16 a[136:137], v7 offset:32768
v_mul_f32 v254, v24, v253
v_lshlrev_b32 v23, 16, v233
v_mfma_f32_16x16x32_bf16 v[96:99], a[68:71], a[132:135], v[96:99]
buffer_load_dwordx4 v12, s[8:11], s25 offen offset:0 lds
v_mfma_f32_16x16x32_bf16 v[100:103], a[72:75], a[128:131], v[100:103]
ds_read_b64_tr_b16 a[138:139], v7 offset:34816
v_lshlrev_b32 v247, 16, v242
v_mfma_f32_16x16x32_bf16 v[100:103], a[76:79], a[132:135], v[100:103]
v_fmac_f32 v254, v25, v30
v_fmac_f32 v254, v22, v29
v_mfma_f32_16x16x32_bf16 v[104:107], a[80:83], a[128:131], v[104:107]
ds_read_b64_tr_b16 a[140:141], v7 offset:49152
v_fmac_f32 v254, v23, v28
v_mfma_f32_16x16x32_bf16 v[104:107], a[84:87], a[132:135], v[104:107]
buffer_load_dwordx4 v13, s[8:11], s25 offen offset:1024 lds
v_mul_f32 v254, v254, v247
v_mfma_f32_16x16x32_bf16 v[108:111], a[88:91], a[128:131], v[108:111]
ds_read_b64_tr_b16 a[142:143], v7 offset:51200
v_cvt_pk_bf16_f32 v246, v255, v254
v_mfma_f32_16x16x32_bf16 v[108:111], a[92:95], a[132:135], v[108:111]
v_accvgpr_write_b32 a178, v246
v_mul_f32 v255, v25, v253
v_mfma_f32_16x16x32_bf16 v[112:115], a[96:99], a[128:131], v[112:115]
v_lshlrev_b32 v24, 16, v234
v_lshlrev_b32 v247, 16, v243
v_mfma_f32_16x16x32_bf16 v[112:115], a[100:103], a[132:135], v[112:115]
buffer_load_dwordx4 v14, s[8:11], s25 offen offset:2048 lds
v_mfma_f32_16x16x32_bf16 v[116:119], a[104:107], a[128:131], v[116:119]
ds_read_b128 a[24:27], v2 offset:6144
v_fmac_f32 v255, v22, v30
v_fmac_f32 v255, v23, v29
v_mfma_f32_16x16x32_bf16 v[116:119], a[108:111], a[132:135], v[116:119]
v_fmac_f32 v255, v24, v28
v_mul_f32 v255, v255, v247
v_mfma_f32_16x16x32_bf16 v[120:123], a[112:115], a[128:131], v[120:123]
ds_read_b128 a[28:31], v3 offset:6144
v_cvt_pk_bf16_f32 v246, v254, v255
v_mfma_f32_16x16x32_bf16 v[120:123], a[116:119], a[132:135], v[120:123]
buffer_load_dwordx4 v15, s[8:11], s25 offen offset:3072 lds
v_mfma_f32_16x16x32_bf16 v[124:127], a[120:123], a[128:131], v[124:127]
s_add_u32 s25, s25, 128
v_accvgpr_write_b32 a183, v246
v_mul_f32 v254, v22, v253
v_mfma_f32_16x16x32_bf16 v[124:127], a[124:127], a[132:135], v[124:127]
s_waitcnt lgkmcnt(2)
v_lshlrev_b32 v25, 16, v235
v_lshlrev_b32 v247, 16, v244
v_mfma_f32_16x16x32_bf16 v[128:131], a[64:67], a[136:139], v[128:131]
ds_read_b64_tr_b16 a[128:129], v8 offset:32768
v_fmac_f32 v254, v23, v30
v_fmac_f32 v254, v24, v29
v_mfma_f32_16x16x32_bf16 v[128:131], a[68:71], a[140:143], v[128:131]
buffer_load_dword v21, v20, s[16:19], s43 offen
v_mfma_f32_16x16x32_bf16 v[132:135], a[72:75], a[136:139], v[132:135]
s_add_u32 s43, s43, s47
ds_read_b64_tr_b16 a[130:131], v8 offset:34816
v_fmac_f32 v254, v25, v28
v_mfma_f32_16x16x32_bf16 v[132:135], a[76:79], a[140:143], v[132:135]
s_cmp_ge_u32 s43, s51
v_mul_f32 v254, v254, v247
v_cvt_pk_bf16_f32 v246, v255, v254
v_mfma_f32_16x16x32_bf16 v[136:139], a[80:83], a[136:139], v[136:139]
s_cselect_b32 s43, 0, s43
ds_read_b64_tr_b16 a[132:133], v8 offset:49152
v_accvgpr_write_b32 a179, v246
v_mfma_f32_16x16x32_bf16 v[136:139], a[84:87], a[140:143], v[136:139]
s_cselect_b32 s51, s42, s51
v_lshlrev_b32 v28, 16, v250
v_and_b32 v29, s58, v250
v_lshlrev_b32 v30, 16, v251
v_mfma_f32_16x16x32_bf16 v[140:143], a[88:91], a[136:139], v[140:143]
s_cselect_b64 s[16:17], s[40:41], s[16:17]
ds_read_b64_tr_b16 a[134:135], v8 offset:51200
v_and_b32 v253, s58, v251
v_mfma_f32_16x16x32_bf16 v[140:143], a[92:95], a[140:143], v[140:143]
s_cselect_b32 s18, s42, s18
v_and_b32 v22, s58, v224
v_and_b32 v23, s58, v225
v_mfma_f32_16x16x32_bf16 v[144:147], a[96:99], a[136:139], v[144:147]
s_cselect_b64 s[40:41], s[44:45], s[40:41]
ds_read_b128 a[32:35], v2 offset:8192
v_and_b32 v24, s58, v226
v_mfma_f32_16x16x32_bf16 v[144:147], a[100:103], a[140:143], v[144:147]
s_cselect_b32 s42, s46, s42
v_mul_f32 v254, v22, v253
v_and_b32 v25, s58, v227
v_mfma_f32_16x16x32_bf16 v[148:151], a[104:107], a[136:139], v[148:151]
s_cselect_b32 s46, 0, s46
v_and_b32 v247, s58, v236
v_fmac_f32 v254, v23, v30
v_mfma_f32_16x16x32_bf16 v[148:151], a[108:111], a[140:143], v[148:151]
buffer_load_dword v245, off, s[60:63], 0 sc1
v_fmac_f32 v254, v24, v29
v_mfma_f32_16x16x32_bf16 v[152:155], a[112:115], a[136:139], v[152:155]
ds_read_b128 a[36:39], v3 offset:8192
v_fmac_f32 v254, v25, v28
v_mfma_f32_16x16x32_bf16 v[152:155], a[116:119], a[140:143], v[152:155]
v_mul_f32 v254, v254, v247
v_mul_f32 v255, v23, v253
v_mfma_f32_16x16x32_bf16 v[156:159], a[120:123], a[136:139], v[156:159]
ds_read_b128 a[40:43], v2 offset:10240
v_and_b32 v22, s58, v228
v_mfma_f32_16x16x32_bf16 v[156:159], a[124:127], a[140:143], v[156:159]
s_waitcnt lgkmcnt(3)
v_and_b32 v247, s58, v237
v_fmac_f32 v255, v24, v30
v_mfma_f32_16x16x32_bf16 v[160:163], a[64:67], a[128:131], v[160:163]
ds_read_b64_tr_b16 a[136:137], v9 offset:32768
v_fmac_f32 v255, v25, v29
v_fmac_f32 v255, v22, v28
v_mfma_f32_16x16x32_bf16 v[160:163], a[68:71], a[132:135], v[160:163]
v_mul_f32 v255, v255, v247
v_cvt_pk_bf16_f32 v246, v254, v255
v_mfma_f32_16x16x32_bf16 v[164:167], a[72:75], a[128:131], v[164:167]
ds_read_b64_tr_b16 a[138:139], v9 offset:34816
v_accvgpr_write_b32 a188, v246
v_mfma_f32_16x16x32_bf16 v[164:167], a[76:79], a[132:135], v[164:167]
v_mul_f32 v254, v24, v253
v_and_b32 v23, s58, v229
v_mfma_f32_16x16x32_bf16 v[168:171], a[80:83], a[128:131], v[168:171]
ds_read_b64_tr_b16 a[140:141], v9 offset:49152
v_and_b32 v247, s58, v238
v_mfma_f32_16x16x32_bf16 v[168:171], a[84:87], a[132:135], v[168:171]
v_fmac_f32 v254, v25, v30
v_fmac_f32 v254, v22, v29
v_fmac_f32 v254, v23, v28
v_mfma_f32_16x16x32_bf16 v[172:175], a[88:91], a[128:131], v[172:175]
ds_read_b64_tr_b16 a[142:143], v9 offset:51200
v_mul_f32 v254, v254, v247
v_mfma_f32_16x16x32_bf16 v[172:175], a[92:95], a[132:135], v[172:175]
v_cvt_pk_bf16_f32 v246, v255, v254
v_accvgpr_write_b32 a184, v246
v_mfma_f32_16x16x32_bf16 v[176:179], a[96:99], a[128:131], v[176:179]
v_mul_f32 v255, v25, v253
v_and_b32 v24, s58, v230
v_mfma_f32_16x16x32_bf16 v[176:179], a[100:103], a[132:135], v[176:179]
v_and_b32 v247, s58, v239
v_fmac_f32 v255, v22, v30
v_mfma_f32_16x16x32_bf16 v[180:183], a[104:107], a[128:131], v[180:183]
ds_read_b128 a[44:47], v3 offset:10240
v_fmac_f32 v255, v23, v29
v_mfma_f32_16x16x32_bf16 v[180:183], a[108:111], a[132:135], v[180:183]
v_fmac_f32 v255, v24, v28
v_mul_f32 v255, v255, v247
v_cvt_pk_bf16_f32 v246, v254, v255
v_mfma_f32_16x16x32_bf16 v[184:187], a[112:115], a[128:131], v[184:187]
ds_read_b128 a[48:51], v2 offset:12288
v_accvgpr_write_b32 a189, v246
v_mfma_f32_16x16x32_bf16 v[184:187], a[116:119], a[132:135], v[184:187]
v_mul_f32 v254, v22, v253
v_and_b32 v25, s58, v231
v_mfma_f32_16x16x32_bf16 v[188:191], a[120:123], a[128:131], v[188:191]
v_and_b32 v247, s58, v240
v_fmac_f32 v254, v23, v30
v_mfma_f32_16x16x32_bf16 v[188:191], a[124:127], a[132:135], v[188:191]
s_waitcnt lgkmcnt(2)
v_fmac_f32 v254, v24, v29
v_fmac_f32 v254, v25, v28
v_mfma_f32_16x16x32_bf16 v[192:195], a[64:67], a[136:139], v[192:195]
ds_read_b64_tr_b16 a[128:129], v10 offset:32768
v_mul_f32 v254, v254, v247
v_cvt_pk_bf16_f32 v246, v255, v254
v_mfma_f32_16x16x32_bf16 v[192:195], a[68:71], a[140:143], v[192:195]
v_accvgpr_write_b32 a185, v246
v_mul_f32 v255, v23, v253
v_mfma_f32_16x16x32_bf16 v[196:199], a[72:75], a[136:139], v[196:199]
ds_read_b64_tr_b16 a[130:131], v10 offset:34816
v_and_b32 v22, s58, v232
v_mfma_f32_16x16x32_bf16 v[196:199], a[76:79], a[140:143], v[196:199]
v_and_b32 v247, s58, v241
v_fmac_f32 v255, v24, v30
v_mfma_f32_16x16x32_bf16 v[200:203], a[80:83], a[136:139], v[200:203]
s_lshr_b32 s22, s3, 1
ds_read_b64_tr_b16 a[132:133], v10 offset:49152
v_fmac_f32 v255, v25, v29
v_mfma_f32_16x16x32_bf16 v[200:203], a[84:87], a[140:143], v[200:203]
s_mul_i32 s22, s22, 2097152
v_fmac_f32 v255, v22, v28
v_mul_f32 v255, v255, v247
v_cvt_pk_bf16_f32 v246, v254, v255
v_mfma_f32_16x16x32_bf16 v[204:207], a[88:91], a[136:139], v[204:207]
s_and_b32 s23, s3, 1
ds_read_b64_tr_b16 a[134:135], v10 offset:51200
v_accvgpr_write_b32 a190, v246
v_mfma_f32_16x16x32_bf16 v[204:207], a[92:95], a[140:143], v[204:207]
s_lshl_b32 s23, s23, 5
v_mul_f32 v254, v24, v253
v_and_b32 v23, s58, v233
v_mfma_f32_16x16x32_bf16 v[208:211], a[96:99], a[136:139], v[208:211]
s_lshl_b32 s56, s39, 6
ds_read_b128 a[52:55], v3 offset:12288
v_and_b32 v247, s58, v242
v_mfma_f32_16x16x32_bf16 v[208:211], a[100:103], a[140:143], v[208:211]
s_add_u32 s23, s23, s56
v_fmac_f32 v254, v25, v30
v_fmac_f32 v254, v22, v29
v_mfma_f32_16x16x32_bf16 v[212:215], a[104:107], a[136:139], v[212:215]
s_mul_i32 s23, s23, 4224
ds_read_b128 a[56:59], v2 offset:14336
v_fmac_f32 v254, v23, v28
v_mfma_f32_16x16x32_bf16 v[212:215], a[108:111], a[140:143], v[212:215]
s_add_u32 s22, s22, s23
v_mul_f32 v254, v254, v247
v_cvt_pk_bf16_f32 v246, v255, v254
v_accvgpr_write_b32 a186, v246
v_mfma_f32_16x16x32_bf16 v[216:219], a[112:115], a[136:139], v[216:219]
s_add_u32 s57, s22, 83886200
v_mul_f32 v255, v25, v253
v_and_b32 v24, s58, v234
v_mfma_f32_16x16x32_bf16 v[216:219], a[116:119], a[140:143], v[216:219]
s_lshl_b32 s23, s38, 7
v_and_b32 v247, s58, v243
v_fmac_f32 v255, v22, v30
v_mfma_f32_16x16x32_bf16 v[220:223], a[120:123], a[136:139], v[220:223]
s_add_u32 s22, s22, s23
ds_read_b128 a[60:63], v3 offset:14336
v_fmac_f32 v255, v23, v29
v_mfma_f32_16x16x32_bf16 v[220:223], a[124:127], a[140:143], v[220:223]
s_waitcnt lgkmcnt(3)
s_add_u32 s56, s22, 83886208
v_fmac_f32 v255, v24, v28
v_mul_f32 v255, v255, v247
v_mfma_f32_16x16x32_bf16 a[192:195], a[64:67], a[128:131], a[192:195]
s_cmp_lt_u32 s2, 224
ds_read_b64_tr_b16 a[136:137], v11 offset:32768
v_cvt_pk_bf16_f32 v246, v254, v255
v_accvgpr_write_b32 a191, v246
v_mfma_f32_16x16x32_bf16 a[192:195], a[68:71], a[132:135], a[192:195]
s_cselect_b32 s56, s56, 3221225472
v_mul_f32 v254, v22, v253
v_and_b32 v25, s58, v235
v_mfma_f32_16x16x32_bf16 a[196:199], a[72:75], a[128:131], a[196:199]
s_cmp_eq_u32 s38, 0
ds_read_b64_tr_b16 a[138:139], v11 offset:34816
v_and_b32 v247, s58, v244
v_mfma_f32_16x16x32_bf16 a[196:199], a[76:79], a[132:135], a[196:199]
s_cselect_b32 s57, s57, 3221225472
v_fmac_f32 v254, v23, v30
v_fmac_f32 v254, v24, v29
v_mfma_f32_16x16x32_bf16 a[200:203], a[80:83], a[128:131], a[200:203]
ds_read_b64_tr_b16 a[140:141], v11 offset:49152
v_fmac_f32 v254, v25, v28
v_mfma_f32_16x16x32_bf16 a[200:203], a[84:87], a[132:135], a[200:203]
v_mul_f32 v254, v254, v247
v_cvt_pk_bf16_f32 v246, v255, v254
v_accvgpr_write_b32 a187, v246
v_mfma_f32_16x16x32_bf16 a[204:207], a[88:91], a[128:131], a[204:207]
ds_read_b64_tr_b16 a[142:143], v11 offset:51200
v_mfma_f32_16x16x32_bf16 a[204:207], a[92:95], a[132:135], a[204:207]
ds_write_b128 v252, a[176:179] offset:0
v_mfma_f32_16x16x32_bf16 a[208:211], a[96:99], a[128:131], a[208:211]
v_mfma_f32_16x16x32_bf16 a[208:211], a[100:103], a[132:135], a[208:211]
ds_write_b128 v252, a[180:183] offset:8192
v_mfma_f32_16x16x32_bf16 a[212:215], a[104:107], a[128:131], a[212:215]
v_mfma_f32_16x16x32_bf16 a[212:215], a[108:111], a[132:135], a[212:215]
ds_write_b128 v252, a[184:187] offset:128
v_mfma_f32_16x16x32_bf16 a[216:219], a[112:115], a[128:131], a[216:219]
v_mfma_f32_16x16x32_bf16 a[216:219], a[116:119], a[132:135], a[216:219]
ds_write_b128 v252, a[188:191] offset:8320
v_mfma_f32_16x16x32_bf16 a[220:223], a[120:123], a[128:131], a[220:223]
s_waitcnt vmcnt(2) lgkmcnt(0)
v_mfma_f32_16x16x32_bf16 a[220:223], a[124:127], a[132:135], a[220:223]
s_barrier
v_mfma_f32_16x16x32_bf16 a[224:227], a[64:67], a[136:139], a[224:227]
s_add_u32 m0, s29, 98304
ds_read_b64_tr_b16 a[128:129], v4 offset:0
v_lshrrev_b32 v22, 8, v1
v_mfma_f32_16x16x32_bf16 a[224:227], a[68:71], a[140:143], a[224:227]
buffer_load_dwordx4 v16, s[12:15], s26 offen offset:0 lds
v_mfma_f32_16x16x32_bf16 a[228:231], a[72:75], a[136:139], a[228:231]
ds_read_b64_tr_b16 a[130:131], v4 offset:2048
v_lshlrev_b32 v22, 4, v22
v_mfma_f32_16x16x32_bf16 a[228:231], a[76:79], a[140:143], a[228:231]
v_xor_b32 v22, v22, v1
v_add_u32 v22, s29, v22
v_mfma_f32_16x16x32_bf16 a[232:235], a[80:83], a[136:139], a[232:235]
ds_read_b64_tr_b16 a[132:133], v4 offset:16384
v_add_u32 v22, 147456, v22
v_mfma_f32_16x16x32_bf16 a[232:235], a[84:87], a[140:143], a[232:235]
buffer_load_dwordx4 v17, s[12:15], s26 offen offset:1024 lds
v_mfma_f32_16x16x32_bf16 a[236:239], a[88:91], a[136:139], a[236:239]
ds_read_b64_tr_b16 a[134:135], v4 offset:18432
v_xor_b32 v23, 64, v22
v_mfma_f32_16x16x32_bf16 a[236:239], a[92:95], a[140:143], a[236:239]
v_lshrrev_b32 v224, 7, v1
v_mul_u32_u24 v224, 4224, v224
v_mfma_f32_16x16x32_bf16 a[240:243], a[96:99], a[136:139], a[240:243]
v_and_b32 v225, 0x70, v1
v_add_u32 v224, v224, v225
v_mfma_f32_16x16x32_bf16 a[240:243], a[100:103], a[140:143], a[240:243]
buffer_load_dwordx4 v18, s[12:15], s26 offen offset:2048 lds
v_mfma_f32_16x16x32_bf16 a[244:247], a[104:107], a[136:139], a[244:247]
v_bfe_u32 v225, v1, 4, 5
v_mul_u32_u24 v225, 4224, v225
v_mfma_f32_16x16x32_bf16 a[244:247], a[108:111], a[140:143], a[244:247]
v_mov_b32 v226, 0
v_mov_b32 v227, 0
v_mfma_f32_16x16x32_bf16 a[248:251], a[112:115], a[136:139], a[248:251]
v_mfma_f32_16x16x32_bf16 a[248:251], a[116:119], a[140:143], a[248:251]
buffer_load_dwordx4 v19, s[12:15], s26 offen offset:3072 lds
v_mfma_f32_16x16x32_bf16 a[252:255], a[120:123], a[136:139], a[252:255]
s_add_u32 s26, s26, 524288
v_mfma_f32_16x16x32_bf16 a[252:255], a[124:127], a[140:143], a[252:255]
s_waitcnt lgkmcnt(0)
v_mfma_f32_16x16x32_bf16 v[32:35], a[0:3], a[128:131], v[32:35]
s_add_u32 m0, s29, 114688
ds_read_b64_tr_b16 a[136:137], v5 offset:0
v_mfma_f32_16x16x32_bf16 v[32:35], a[4:7], a[132:135], v[32:35]
buffer_load_dwordx4 v16, s[12:15], s27 offen offset:0 lds
v_mfma_f32_16x16x32_bf16 v[36:39], a[8:11], a[128:131], v[36:39]
s_mul_i32 s52, s20, 7
ds_read_b64_tr_b16 a[138:139], v5 offset:2048
v_mfma_f32_16x16x32_bf16 v[36:39], a[12:15], a[132:135], v[36:39]
s_add_u32 s52, s52, s21
buffer_store_dwordx2 v[226:227], v225, s[4:7], s57 offen sc1
v_mfma_f32_16x16x32_bf16 v[40:43], a[16:19], a[128:131], v[40:43]
s_lshl_b32 s53, s52, 2
ds_read_b64_tr_b16 a[140:141], v5 offset:16384
v_mfma_f32_16x16x32_bf16 v[40:43], a[20:23], a[132:135], v[40:43]
s_add_u32 s53, s53, s3
buffer_load_dwordx4 v17, s[12:15], s27 offen offset:1024 lds
v_mfma_f32_16x16x32_bf16 v[44:47], a[24:27], a[128:131], v[44:47]
s_lshl_b32 s49, s53, 12
ds_read_b64_tr_b16 a[142:143], v5 offset:18432
v_mfma_f32_16x16x32_bf16 v[44:47], a[28:31], a[132:135], v[44:47]
s_mul_i32 s53, s53, 4224
v_mfma_f32_16x16x32_bf16 v[48:51], a[32:35], a[128:131], v[48:51]
s_add_u32 s53, s53, 83886080
ds_read_b128 a[64:67], v2 offset:32768
v_mfma_f32_16x16x32_bf16 v[48:51], a[36:39], a[132:135], v[48:51]
s_lshr_b32 s52, s52, 4
buffer_load_dwordx4 v18, s[12:15], s27 offen offset:2048 lds
v_mfma_f32_16x16x32_bf16 v[52:55], a[40:43], a[128:131], v[52:55]
s_min_u32 s52, s52, 6
ds_read_b128 a[68:71], v3 offset:32768
v_mfma_f32_16x16x32_bf16 v[52:55], a[44:47], a[132:135], v[52:55]
s_lshl_b32 s52, s52, 7
ds_read_b128 a[176:179], v22 offset:0
v_mfma_f32_16x16x32_bf16 v[56:59], a[48:51], a[128:131], v[56:59]
s_add_u32 s52, s52, 94392320
ds_read_b128 a[180:183], v23 offset:1024
v_mfma_f32_16x16x32_bf16 v[56:59], a[52:55], a[132:135], v[56:59]
buffer_load_dwordx4 v19, s[12:15], s27 offen offset:3072 lds
v_mfma_f32_16x16x32_bf16 v[60:63], a[56:59], a[128:131], v[60:63]
s_add_u32 s27, s27, 524288
ds_read_b128 a[72:75], v2 offset:34816
v_mfma_f32_16x16x32_bf16 v[60:63], a[60:63], a[132:135], v[60:63]
s_waitcnt lgkmcnt(5)
ds_read_b128 a[184:187], v22 offset:2048
v_mfma_f32_16x16x32_bf16 v[64:67], a[0:3], a[136:139], v[64:67]
s_add_u32 m0, s28, 0
ds_read_b64_tr_b16 a[128:129], v6 offset:0
v_mfma_f32_16x16x32_bf16 v[64:67], a[4:7], a[140:143], v[64:67]
buffer_load_dwordx4 v12, s[8:11], s24 offen offset:0 lds
v_mfma_f32_16x16x32_bf16 v[68:71], a[8:11], a[136:139], v[68:71]
ds_read_b64_tr_b16 a[130:131], v6 offset:2048
v_mfma_f32_16x16x32_bf16 v[68:71], a[12:15], a[140:143], v[68:71]
ds_read_b128 a[188:191], v23 offset:3072
v_mfma_f32_16x16x32_bf16 v[72:75], a[16:19], a[136:139], v[72:75]
ds_read_b64_tr_b16 a[132:133], v6 offset:16384
v_bfe_u32 v231, v1, 4, 5
v_mfma_f32_16x16x32_bf16 v[72:75], a[20:23], a[140:143], v[72:75]
buffer_load_dwordx4 v13, s[8:11], s24 offen offset:1024 lds
v_mfma_f32_16x16x32_bf16 v[76:79], a[24:27], a[136:139], v[76:79]
ds_read_b64_tr_b16 a[134:135], v6 offset:18432
v_lshlrev_b32 v231, 2, v231
v_mfma_f32_16x16x32_bf16 v[76:79], a[28:31], a[140:143], v[76:79]
v_lshlrev_b32 v229, 3, v1
v_min_u32 v229, 4096, v229
v_mfma_f32_16x16x32_bf16 v[80:83], a[32:35], a[136:139], v[80:83]
ds_read_b128 a[76:79], v3 offset:34816
v_mfma_f32_16x16x32_bf16 v[80:83], a[36:39], a[140:143], v[80:83]
buffer_load_dwordx4 v14, s[8:11], s24 offen offset:2048 lds
v_mfma_f32_16x16x32_bf16 v[84:87], a[40:43], a[136:139], v[84:87]
v_mfma_f32_16x16x32_bf16 v[84:87], a[44:47], a[140:143], v[84:87]
v_mfma_f32_16x16x32_bf16 v[88:91], a[48:51], a[136:139], v[88:91]
ds_read_b128 a[80:83], v2 offset:36864
v_mfma_f32_16x16x32_bf16 v[88:91], a[52:55], a[140:143], v[88:91]
buffer_load_dwordx4 v15, s[8:11], s24 offen offset:3072 lds
v_mfma_f32_16x16x32_bf16 v[92:95], a[56:59], a[136:139], v[92:95]
s_add_u32 s24, s24, 128
ds_read_b128 a[84:87], v3 offset:36864
v_mfma_f32_16x16x32_bf16 v[92:95], a[60:63], a[140:143], v[92:95]
s_waitcnt lgkmcnt(3)
v_mfma_f32_16x16x32_bf16 v[96:99], a[0:3], a[128:131], v[96:99]
s_add_u32 m0, s28, 4096
ds_read_b64_tr_b16 a[136:137], v7 offset:0
v_mfma_f32_16x16x32_bf16 v[96:99], a[4:7], a[132:135], v[96:99]
buffer_load_dwordx4 v12, s[8:11], s25 offen offset:0 lds
v_mfma_f32_16x16x32_bf16 v[100:103], a[8:11], a[128:131], v[100:103]
ds_read_b64_tr_b16 a[138:139], v7 offset:2048
v_mfma_f32_16x16x32_bf16 v[100:103], a[12:15], a[132:135], v[100:103]
v_mfma_f32_16x16x32_bf16 v[104:107], a[16:19], a[128:131], v[104:107]
ds_read_b64_tr_b16 a[140:141], v7 offset:16384
v_mfma_f32_16x16x32_bf16 v[104:107], a[20:23], a[132:135], v[104:107]
buffer_load_dwordx4 v13, s[8:11], s25 offen offset:1024 lds
v_mfma_f32_16x16x32_bf16 v[108:111], a[24:27], a[128:131], v[108:111]
ds_read_b64_tr_b16 a[142:143], v7 offset:18432
v_mfma_f32_16x16x32_bf16 v[108:111], a[28:31], a[132:135], v[108:111]
v_mfma_f32_16x16x32_bf16 v[112:115], a[32:35], a[128:131], v[112:115]
v_mfma_f32_16x16x32_bf16 v[112:115], a[36:39], a[132:135], v[112:115]
buffer_load_dwordx4 v14, s[8:11], s25 offen offset:2048 lds
v_mfma_f32_16x16x32_bf16 v[116:119], a[40:43], a[128:131], v[116:119]
ds_read_b128 a[88:91], v2 offset:38912
v_mfma_f32_16x16x32_bf16 v[116:119], a[44:47], a[132:135], v[116:119]
v_mfma_f32_16x16x32_bf16 v[120:123], a[48:51], a[128:131], v[120:123]
ds_read_b128 a[92:95], v3 offset:38912
v_mfma_f32_16x16x32_bf16 v[120:123], a[52:55], a[132:135], v[120:123]
buffer_load_dwordx4 v15, s[8:11], s25 offen offset:3072 lds
v_mfma_f32_16x16x32_bf16 v[124:127], a[56:59], a[128:131], v[124:127]
s_add_u32 s25, s25, 128
v_mfma_f32_16x16x32_bf16 v[124:127], a[60:63], a[132:135], v[124:127]
s_waitcnt lgkmcnt(2)
v_mfma_f32_16x16x32_bf16 v[128:131], a[0:3], a[136:139], v[128:131]
ds_read_b64_tr_b16 a[128:129], v8 offset:0
v_mfma_f32_16x16x32_bf16 v[128:131], a[4:7], a[140:143], v[128:131]
buffer_store_dwordx4 a[176:179], v224, s[4:7], s56 offen sc1
v_mfma_f32_16x16x32_bf16 v[132:135], a[8:11], a[136:139], v[132:135]
s_add_u32 s56, s56, 33792
ds_read_b64_tr_b16 a[130:131], v8 offset:2048
v_mfma_f32_16x16x32_bf16 v[132:135], a[12:15], a[140:143], v[132:135]
v_mfma_f32_16x16x32_bf16 v[136:139], a[16:19], a[136:139], v[136:139]
ds_read_b64_tr_b16 a[132:133], v8 offset:16384
v_mfma_f32_16x16x32_bf16 v[136:139], a[20:23], a[140:143], v[136:139]
v_mfma_f32_16x16x32_bf16 v[140:143], a[24:27], a[136:139], v[140:143]
s_cmp_lt_u32 s21, 7
ds_read_b64_tr_b16 a[134:135], v8 offset:18432
v_mfma_f32_16x16x32_bf16 v[140:143], a[28:31], a[140:143], v[140:143]
s_cselect_b32 s53, s53, 3221225472
v_mfma_f32_16x16x32_bf16 v[144:147], a[32:35], a[136:139], v[144:147]
s_cselect_b32 s49, s49, 3221225472
ds_read_b128 a[96:99], v2 offset:40960
v_mfma_f32_16x16x32_bf16 v[144:147], a[36:39], a[140:143], v[144:147]
s_add_u32 s48, s53, 2097152
v_mfma_f32_16x16x32_bf16 v[148:151], a[40:43], a[136:139], v[148:151]
v_mfma_f32_16x16x32_bf16 v[148:151], a[44:47], a[140:143], v[148:151]
v_mfma_f32_16x16x32_bf16 v[152:155], a[48:51], a[136:139], v[152:155]
ds_read_b128 a[100:103], v3 offset:40960
v_mfma_f32_16x16x32_bf16 v[152:155], a[52:55], a[140:143], v[152:155]
v_mfma_f32_16x16x32_bf16 v[156:159], a[56:59], a[136:139], v[156:159]
ds_read_b128 a[104:107], v2 offset:43008
v_mfma_f32_16x16x32_bf16 v[156:159], a[60:63], a[140:143], v[156:159]
s_waitcnt lgkmcnt(3)
v_mfma_f32_16x16x32_bf16 v[160:163], a[0:3], a[128:131], v[160:163]
ds_read_b64_tr_b16 a[136:137], v9 offset:0
v_mfma_f32_16x16x32_bf16 v[160:163], a[4:7], a[132:135], v[160:163]
v_mfma_f32_16x16x32_bf16 v[164:167], a[8:11], a[128:131], v[164:167]
ds_read_b64_tr_b16 a[138:139], v9 offset:2048
v_mfma_f32_16x16x32_bf16 v[164:167], a[12:15], a[132:135], v[164:167]
buffer_store_dwordx4 a[180:183], v224, s[4:7], s56 offen sc1
v_mfma_f32_16x16x32_bf16 v[168:171], a[16:19], a[128:131], v[168:171]
s_add_u32 s56, s56, 33792
ds_read_b64_tr_b16 a[140:141], v9 offset:16384
v_mfma_f32_16x16x32_bf16 v[168:171], a[20:23], a[132:135], v[168:171]
v_mfma_f32_16x16x32_bf16 v[172:175], a[24:27], a[128:131], v[172:175]
ds_read_b64_tr_b16 a[142:143], v9 offset:18432
v_mfma_f32_16x16x32_bf16 v[172:175], a[28:31], a[132:135], v[172:175]
v_mfma_f32_16x16x32_bf16 v[176:179], a[32:35], a[128:131], v[176:179]
v_mfma_f32_16x16x32_bf16 v[176:179], a[36:39], a[132:135], v[176:179]
v_mfma_f32_16x16x32_bf16 v[180:183], a[40:43], a[128:131], v[180:183]
ds_read_b128 a[108:111], v3 offset:43008
v_mfma_f32_16x16x32_bf16 v[180:183], a[44:47], a[132:135], v[180:183]
v_mfma_f32_16x16x32_bf16 v[184:187], a[48:51], a[128:131], v[184:187]
ds_read_b128 a[112:115], v2 offset:45056
v_mfma_f32_16x16x32_bf16 v[184:187], a[52:55], a[132:135], v[184:187]
v_mfma_f32_16x16x32_bf16 v[188:191], a[56:59], a[128:131], v[188:191]
v_mfma_f32_16x16x32_bf16 v[188:191], a[60:63], a[132:135], v[188:191]
s_waitcnt lgkmcnt(2)
v_mfma_f32_16x16x32_bf16 v[192:195], a[0:3], a[136:139], v[192:195]
ds_read_b64_tr_b16 a[128:129], v10 offset:0
v_mfma_f32_16x16x32_bf16 v[192:195], a[4:7], a[140:143], v[192:195]
v_mfma_f32_16x16x32_bf16 v[196:199], a[8:11], a[136:139], v[196:199]
ds_read_b64_tr_b16 a[130:131], v10 offset:2048
v_mfma_f32_16x16x32_bf16 v[196:199], a[12:15], a[140:143], v[196:199]
v_mfma_f32_16x16x32_bf16 v[200:203], a[16:19], a[136:139], v[200:203]
ds_read_b64_tr_b16 a[132:133], v10 offset:16384
v_mfma_f32_16x16x32_bf16 v[200:203], a[20:23], a[140:143], v[200:203]
buffer_store_dwordx4 a[184:187], v224, s[4:7], s56 offen sc1
v_mfma_f32_16x16x32_bf16 v[204:207], a[24:27], a[136:139], v[204:207]
s_add_u32 s56, s56, 33792
ds_read_b64_tr_b16 a[134:135], v10 offset:18432
v_mfma_f32_16x16x32_bf16 v[204:207], a[28:31], a[140:143], v[204:207]
v_mfma_f32_16x16x32_bf16 v[208:211], a[32:35], a[136:139], v[208:211]
ds_read_b128 a[116:119], v3 offset:45056
v_mfma_f32_16x16x32_bf16 v[208:211], a[36:39], a[140:143], v[208:211]
v_mfma_f32_16x16x32_bf16 v[212:215], a[40:43], a[136:139], v[212:215]
ds_read_b128 a[120:123], v2 offset:47104
v_mfma_f32_16x16x32_bf16 v[212:215], a[44:47], a[140:143], v[212:215]
v_mfma_f32_16x16x32_bf16 v[216:219], a[48:51], a[136:139], v[216:219]
v_mfma_f32_16x16x32_bf16 v[216:219], a[52:55], a[140:143], v[216:219]
v_mfma_f32_16x16x32_bf16 v[220:223], a[56:59], a[136:139], v[220:223]
ds_read_b128 a[124:127], v3 offset:47104
v_mfma_f32_16x16x32_bf16 v[220:223], a[60:63], a[140:143], v[220:223]
s_waitcnt lgkmcnt(3)
v_mfma_f32_16x16x32_bf16 a[192:195], a[0:3], a[128:131], a[192:195]
ds_read_b64_tr_b16 a[136:137], v11 offset:0
v_mfma_f32_16x16x32_bf16 a[192:195], a[4:7], a[132:135], a[192:195]
v_mfma_f32_16x16x32_bf16 a[196:199], a[8:11], a[128:131], a[196:199]
ds_read_b64_tr_b16 a[138:139], v11 offset:2048
v_mfma_f32_16x16x32_bf16 a[196:199], a[12:15], a[132:135], a[196:199]
v_mfma_f32_16x16x32_bf16 a[200:203], a[16:19], a[128:131], a[200:203]
ds_read_b64_tr_b16 a[140:141], v11 offset:16384
v_mfma_f32_16x16x32_bf16 a[200:203], a[20:23], a[132:135], a[200:203]
v_mfma_f32_16x16x32_bf16 a[204:207], a[24:27], a[128:131], a[204:207]
ds_read_b64_tr_b16 a[142:143], v11 offset:18432
v_mfma_f32_16x16x32_bf16 a[204:207], a[28:31], a[132:135], a[204:207]
buffer_store_dwordx4 a[188:191], v224, s[4:7], s56 offen sc1
v_mfma_f32_16x16x32_bf16 a[208:211], a[32:35], a[128:131], a[208:211]
s_add_u32 s56, s56, 33792
v_mfma_f32_16x16x32_bf16 a[208:211], a[36:39], a[132:135], a[208:211]
v_mfma_f32_16x16x32_bf16 a[212:215], a[40:43], a[128:131], a[212:215]
v_mfma_f32_16x16x32_bf16 a[212:215], a[44:47], a[132:135], a[212:215]
v_mfma_f32_16x16x32_bf16 a[216:219], a[48:51], a[128:131], a[216:219]
v_mfma_f32_16x16x32_bf16 a[216:219], a[52:55], a[132:135], a[216:219]
v_mfma_f32_16x16x32_bf16 a[220:223], a[56:59], a[128:131], a[220:223]
s_waitcnt vmcnt(4) lgkmcnt(0)
v_mfma_f32_16x16x32_bf16 a[220:223], a[60:63], a[132:135], a[220:223]
s_barrier
v_mfma_f32_16x16x32_bf16 a[224:227], a[0:3], a[136:139], a[224:227]
s_add_u32 m0, s29, 65536
ds_read_b64_tr_b16 a[128:129], v4 offset:32768
v_mfma_f32_16x16x32_bf16 a[224:227], a[4:7], a[140:143], a[224:227]
buffer_load_dwordx4 v16, s[12:15], s26 offen offset:0 lds
v_mfma_f32_16x16x32_bf16 a[228:231], a[8:11], a[136:139], a[228:231]
ds_read_b64_tr_b16 a[130:131], v4 offset:34816
v_cmp_gt_u32 vcc, 0x100, v245
v_mfma_f32_16x16x32_bf16 a[228:231], a[12:15], a[140:143], a[228:231]
v_mfma_f32_16x16x32_bf16 a[232:235], a[16:19], a[136:139], a[232:235]
ds_read_b64_tr_b16 a[132:133], v4 offset:49152
v_mfma_f32_16x16x32_bf16 a[232:235], a[20:23], a[140:143], a[232:235]
buffer_load_dwordx4 v17, s[12:15], s26 offen offset:1024 lds
v_mfma_f32_16x16x32_bf16 a[236:239], a[24:27], a[136:139], a[236:239]
ds_read_b64_tr_b16 a[134:135], v4 offset:51200
v_mfma_f32_16x16x32_bf16 a[236:239], a[28:31], a[140:143], a[236:239]
v_mfma_f32_16x16x32_bf16 a[240:243], a[32:35], a[136:139], a[240:243]
v_mfma_f32_16x16x32_bf16 a[240:243], a[36:39], a[140:143], a[240:243]
buffer_load_dwordx4 v18, s[12:15], s26 offen offset:2048 lds
v_mfma_f32_16x16x32_bf16 a[244:247], a[40:43], a[136:139], a[244:247]
v_mfma_f32_16x16x32_bf16 a[244:247], a[44:47], a[140:143], a[244:247]
v_mfma_f32_16x16x32_bf16 a[248:251], a[48:51], a[136:139], a[248:251]
v_mfma_f32_16x16x32_bf16 a[248:251], a[52:55], a[140:143], a[248:251]
buffer_load_dwordx4 v19, s[12:15], s26 offen offset:3072 lds
v_mfma_f32_16x16x32_bf16 a[252:255], a[56:59], a[136:139], a[252:255]
s_add_u32 s26, s26, 524288
v_mfma_f32_16x16x32_bf16 a[252:255], a[60:63], a[140:143], a[252:255]
s_waitcnt lgkmcnt(0)
s_mov_b32 s82, s59
s_cbranch_vccnz M_cntspinV
s_branch Lg_501
PAD_25:
s_cbranch_execz PAD_29
Lg_501t:
buffer_load_dword v230, v231, s[4:7], s52 offen sc1
v_mfma_f32_16x16x32_bf16 v[32:35], a[64:67], a[128:131], v[32:35]
s_add_u32 m0, s29, 81920
ds_read_b64_tr_b16 a[136:137], v5 offset:32768
v_mfma_f32_16x16x32_bf16 v[32:35], a[68:71], a[132:135], v[32:35]
buffer_load_dwordx4 v16, s[12:15], s27 offen offset:0 lds
v_mfma_f32_16x16x32_bf16 v[36:39], a[72:75], a[128:131], v[36:39]
s_and_b32 s44, s3, 1
ds_read_b64_tr_b16 a[138:139], v5 offset:34816
v_mfma_f32_16x16x32_bf16 v[36:39], a[76:79], a[132:135], v[36:39]
s_lshl_b32 s44, s44, 8
v_mfma_f32_16x16x32_bf16 v[40:43], a[80:83], a[128:131], v[40:43]
s_lshl_b32 s45, s3, 7
ds_read_b64_tr_b16 a[140:141], v5 offset:49152
v_mfma_f32_16x16x32_bf16 v[40:43], a[84:87], a[132:135], v[40:43]
s_xor_b32 s44, s44, s45
buffer_load_dwordx4 v17, s[12:15], s27 offen offset:1024 lds
v_mfma_f32_16x16x32_bf16 v[44:47], a[88:91], a[128:131], v[44:47]
s_xor_b32 s44, s44, 196608
ds_read_b64_tr_b16 a[142:143], v5 offset:51200
v_mfma_f32_16x16x32_bf16 v[44:47], a[92:95], a[132:135], v[44:47]
v_mfma_f32_16x16x32_bf16 v[48:51], a[96:99], a[128:131], v[48:51]
ds_read_b128 a[0:3], v2 offset:0
v_mfma_f32_16x16x32_bf16 v[48:51], a[100:103], a[132:135], v[48:51]
buffer_load_dwordx4 v18, s[12:15], s27 offen offset:2048 lds
v_mfma_f32_16x16x32_bf16 v[52:55], a[104:107], a[128:131], v[52:55]
ds_read_b128 a[4:7], v3 offset:0
v_mfma_f32_16x16x32_bf16 v[52:55], a[108:111], a[132:135], v[52:55]
PAD_26:
s_cbranch_execz PAD_30
v_mfma_f32_16x16x32_bf16 v[56:59], a[112:115], a[128:131], v[56:59]
v_mfma_f32_16x16x32_bf16 v[56:59], a[116:119], a[132:135], v[56:59]
buffer_load_dwordx4 v19, s[12:15], s27 offen offset:3072 lds
v_mfma_f32_16x16x32_bf16 v[60:63], a[120:123], a[128:131], v[60:63]
s_add_u32 s27, s27, 524288
ds_read_b128 a[8:11], v2 offset:2048
v_mfma_f32_16x16x32_bf16 v[60:63], a[124:127], a[132:135], v[60:63]
s_waitcnt lgkmcnt(3)
v_mfma_f32_16x16x32_bf16 v[64:67], a[64:67], a[136:139], v[64:67]
s_add_u32 m0, s28, 32768
ds_read_b64_tr_b16 a[128:129], v6 offset:32768
v_mfma_f32_16x16x32_bf16 v[64:67], a[68:71], a[140:143], v[64:67]
buffer_load_dwordx4 v12, s[8:11], s24 offen offset:0 lds
v_mfma_f32_16x16x32_bf16 v[68:71], a[72:75], a[136:139], v[68:71]
ds_read_b64_tr_b16 a[130:131], v6 offset:34816
v_mfma_f32_16x16x32_bf16 v[68:71], a[76:79], a[140:143], v[68:71]
v_mfma_f32_16x16x32_bf16 v[72:75], a[80:83], a[136:139], v[72:75]
s_mov_b64 s[56:57], s[72:73]
ds_read_b64_tr_b16 a[132:133], v6 offset:49152
v_mfma_f32_16x16x32_bf16 v[72:75], a[84:87], a[140:143], v[72:75]
s_mov_b32 s58, 1835008
buffer_load_dwordx4 v13, s[8:11], s24 offen offset:1024 lds
v_mfma_f32_16x16x32_bf16 v[76:79], a[88:91], a[136:139], v[76:79]
s_mov_b32 s59, 0x20000
ds_read_b64_tr_b16 a[134:135], v6 offset:51200
v_mfma_f32_16x16x32_bf16 v[76:79], a[92:95], a[140:143], v[76:79]
v_mfma_f32_16x16x32_bf16 v[80:83], a[96:99], a[136:139], v[80:83]
ds_read_b128 a[12:15], v3 offset:2048
v_mfma_f32_16x16x32_bf16 v[80:83], a[100:103], a[140:143], v[80:83]
buffer_load_dwordx4 v14, s[8:11], s24 offen offset:2048 lds
v_mfma_f32_16x16x32_bf16 v[84:87], a[104:107], a[136:139], v[84:87]
v_mfma_f32_16x16x32_bf16 v[84:87], a[108:111], a[140:143], v[84:87]
v_mfma_f32_16x16x32_bf16 v[88:91], a[112:115], a[136:139], v[88:91]
ds_read_b128 a[16:19], v2 offset:4096
v_mfma_f32_16x16x32_bf16 v[88:91], a[116:119], a[140:143], v[88:91]
buffer_load_dwordx4 v15, s[8:11], s24 offen offset:3072 lds
v_mfma_f32_16x16x32_bf16 v[92:95], a[120:123], a[136:139], v[92:95]
s_add_u32 s24, s24, 128
ds_read_b128 a[20:23], v3 offset:4096
v_mfma_f32_16x16x32_bf16 v[92:95], a[124:127], a[140:143], v[92:95]
s_waitcnt lgkmcnt(3)
v_mfma_f32_16x16x32_bf16 v[96:99], a[64:67], a[128:131], v[96:99]
s_add_u32 m0, s28, 36864
ds_read_b64_tr_b16 a[136:137], v7 offset:32768
v_mfma_f32_16x16x32_bf16 v[96:99], a[68:71], a[132:135], v[96:99]
buffer_load_dwordx4 v12, s[8:11], s25 offen offset:0 lds
v_mfma_f32_16x16x32_bf16 v[100:103], a[72:75], a[128:131], v[100:103]
ds_read_b64_tr_b16 a[138:139], v7 offset:34816
v_mfma_f32_16x16x32_bf16 v[100:103], a[76:79], a[132:135], v[100:103]
v_mfma_f32_16x16x32_bf16 v[104:107], a[80:83], a[128:131], v[104:107]
ds_read_b64_tr_b16 a[140:141], v7 offset:49152
v_mfma_f32_16x16x32_bf16 v[104:107], a[84:87], a[132:135], v[104:107]
buffer_load_dwordx4 v13, s[8:11], s25 offen offset:1024 lds
v_mfma_f32_16x16x32_bf16 v[108:111], a[88:91], a[128:131], v[108:111]
ds_read_b64_tr_b16 a[142:143], v7 offset:51200
v_mfma_f32_16x16x32_bf16 v[108:111], a[92:95], a[132:135], v[108:111]
v_mfma_f32_16x16x32_bf16 v[112:115], a[96:99], a[128:131], v[112:115]
v_mfma_f32_16x16x32_bf16 v[112:115], a[100:103], a[132:135], v[112:115]
buffer_load_dwordx4 v14, s[8:11], s25 offen offset:2048 lds
v_mfma_f32_16x16x32_bf16 v[116:119], a[104:107], a[128:131], v[116:119]
ds_read_b128 a[24:27], v2 offset:6144
v_mfma_f32_16x16x32_bf16 v[116:119], a[108:111], a[132:135], v[116:119]
v_mfma_f32_16x16x32_bf16 v[120:123], a[112:115], a[128:131], v[120:123]
ds_read_b128 a[28:31], v3 offset:6144
v_mfma_f32_16x16x32_bf16 v[120:123], a[116:119], a[132:135], v[120:123]
buffer_load_dwordx4 v15, s[8:11], s25 offen offset:3072 lds
v_mfma_f32_16x16x32_bf16 v[124:127], a[120:123], a[128:131], v[124:127]
s_add_u32 s25, s25, 128
s_waitcnt vmcnt(12)
v_mfma_f32_16x16x32_bf16 v[124:127], a[124:127], a[132:135], v[124:127]
s_waitcnt lgkmcnt(2)
v_cmp_gt_u32 vcc, 1, v230
v_mfma_f32_16x16x32_bf16 v[128:131], a[64:67], a[136:139], v[128:131]
s_cbranch_vccnz M_ppspinV
M_ppokV:
ds_read_b64_tr_b16 a[128:129], v8 offset:32768
v_mfma_f32_16x16x32_bf16 v[128:131], a[68:71], a[140:143], v[128:131]
buffer_load_dword v230, v229, s[4:7], s53 offen sc1
v_mfma_f32_16x16x32_bf16 v[132:135], a[72:75], a[136:139], v[132:135]
s_mov_b64 s[8:9], s[76:77]
ds_read_b64_tr_b16 a[130:131], v8 offset:34816
v_mfma_f32_16x16x32_bf16 v[132:135], a[76:79], a[140:143], v[132:135]
s_mov_b32 s10, 1835008
buffer_load_dword v230, v229, s[4:7], s48 offen sc1
v_mfma_f32_16x16x32_bf16 v[136:139], a[80:83], a[136:139], v[136:139]
s_lshl_b32 s24, s37, 2
ds_read_b64_tr_b16 a[132:133], v8 offset:49152
v_mfma_f32_16x16x32_bf16 v[136:139], a[84:87], a[140:143], v[136:139]
s_add_u32 s24, s24, s3
buffer_load_dword v230, v229, s[56:59], s49 offen
v_mfma_f32_16x16x32_bf16 v[140:143], a[88:91], a[136:139], v[140:143]
s_mul_i32 s24, s24, 28672
ds_read_b64_tr_b16 a[134:135], v8 offset:51200
v_mfma_f32_16x16x32_bf16 v[140:143], a[92:95], a[140:143], v[140:143]
s_mov_b32 s28, s29
buffer_load_dword v21, v20, s[16:19], s43 offen
v_mfma_f32_16x16x32_bf16 v[144:147], a[96:99], a[136:139], v[144:147]
ds_read_b128 a[32:35], v2 offset:8192
v_mfma_f32_16x16x32_bf16 v[144:147], a[100:103], a[140:143], v[144:147]
v_mfma_f32_16x16x32_bf16 v[148:151], a[104:107], a[136:139], v[148:151]
v_mfma_f32_16x16x32_bf16 v[148:151], a[108:111], a[140:143], v[148:151]
v_mfma_f32_16x16x32_bf16 v[152:155], a[112:115], a[136:139], v[152:155]
ds_read_b128 a[36:39], v3 offset:8192
v_lshrrev_b32 v28, 7, v1
v_mfma_f32_16x16x32_bf16 v[152:155], a[116:119], a[140:143], v[152:155]
v_lshrrev_b32 v29, 1, v28
v_lshlrev_b32 v29, 4, v29
v_mfma_f32_16x16x32_bf16 v[156:159], a[120:123], a[136:139], v[156:159]
ds_read_b128 a[40:43], v2 offset:10240
v_and_b32 v30, 0x70, v1
v_mfma_f32_16x16x32_bf16 v[156:159], a[124:127], a[140:143], v[156:159]
s_waitcnt lgkmcnt(3)
v_xor_b32 v29, v29, v30
v_mul_u32_u24 v28, 896, v28
v_mfma_f32_16x16x32_bf16 v[160:163], a[64:67], a[128:131], v[160:163]
ds_read_b64_tr_b16 a[136:137], v9 offset:32768
v_add_u32 v12, v28, v29
v_mfma_f32_16x16x32_bf16 v[160:163], a[68:71], a[132:135], v[160:163]
v_xor_b32 v29, 64, v29
v_add_u32 v28, v28, v29
v_mfma_f32_16x16x32_bf16 v[164:167], a[72:75], a[128:131], v[164:167]
ds_read_b64_tr_b16 a[138:139], v9 offset:34816
v_add_u32 v13, 6144, v28
v_mfma_f32_16x16x32_bf16 v[164:167], a[76:79], a[132:135], v[164:167]
v_add_u32 v14, 12288, v12
v_add_u32 v15, 18432, v28
v_mfma_f32_16x16x32_bf16 v[168:171], a[80:83], a[128:131], v[168:171]
ds_read_b64_tr_b16 a[140:141], v9 offset:49152
v_xor_b32 v22, s44, v4
v_mfma_f32_16x16x32_bf16 v[168:171], a[84:87], a[132:135], v[168:171]
v_xor_b32 v23, 32, v22
v_xor_b32 v24, 64, v22
v_mfma_f32_16x16x32_bf16 v[172:175], a[88:91], a[128:131], v[172:175]
ds_read_b64_tr_b16 a[142:143], v9 offset:51200
v_xor_b32 v25, 96, v22
v_mfma_f32_16x16x32_bf16 v[172:175], a[92:95], a[132:135], v[172:175]
v_mfma_f32_16x16x32_bf16 v[176:179], a[96:99], a[128:131], v[176:179]
v_mfma_f32_16x16x32_bf16 v[176:179], a[100:103], a[132:135], v[176:179]
v_mfma_f32_16x16x32_bf16 v[180:183], a[104:107], a[128:131], v[180:183]
ds_read_b128 a[44:47], v3 offset:10240
v_mfma_f32_16x16x32_bf16 v[180:183], a[108:111], a[132:135], v[180:183]
v_mfma_f32_16x16x32_bf16 v[184:187], a[112:115], a[128:131], v[184:187]
ds_read_b128 a[48:51], v2 offset:12288
v_mfma_f32_16x16x32_bf16 v[184:187], a[116:119], a[132:135], v[184:187]
v_mfma_f32_16x16x32_bf16 v[188:191], a[120:123], a[128:131], v[188:191]
v_mfma_f32_16x16x32_bf16 v[188:191], a[124:127], a[132:135], v[188:191]
s_waitcnt lgkmcnt(2)
v_mfma_f32_16x16x32_bf16 v[192:195], a[64:67], a[136:139], v[192:195]
ds_read_b64_tr_b16 a[128:129], v10 offset:32768
v_mfma_f32_16x16x32_bf16 v[192:195], a[68:71], a[140:143], v[192:195]
v_mfma_f32_16x16x32_bf16 v[196:199], a[72:75], a[136:139], v[196:199]
ds_read_b64_tr_b16 a[130:131], v10 offset:34816
v_mfma_f32_16x16x32_bf16 v[196:199], a[76:79], a[140:143], v[196:199]
v_mfma_f32_16x16x32_bf16 v[200:203], a[80:83], a[136:139], v[200:203]
ds_read_b64_tr_b16 a[132:133], v10 offset:49152
v_mfma_f32_16x16x32_bf16 v[200:203], a[84:87], a[140:143], v[200:203]
v_mfma_f32_16x16x32_bf16 v[204:207], a[88:91], a[136:139], v[204:207]
ds_read_b64_tr_b16 a[134:135], v10 offset:51200
v_mfma_f32_16x16x32_bf16 v[204:207], a[92:95], a[140:143], v[204:207]
v_mfma_f32_16x16x32_bf16 v[208:211], a[96:99], a[136:139], v[208:211]
ds_read_b128 a[52:55], v3 offset:12288
v_mfma_f32_16x16x32_bf16 v[208:211], a[100:103], a[140:143], v[208:211]
v_mfma_f32_16x16x32_bf16 v[212:215], a[104:107], a[136:139], v[212:215]
ds_read_b128 a[56:59], v2 offset:14336
v_mfma_f32_16x16x32_bf16 v[212:215], a[108:111], a[140:143], v[212:215]
v_mfma_f32_16x16x32_bf16 v[216:219], a[112:115], a[136:139], v[216:219]
v_mfma_f32_16x16x32_bf16 v[216:219], a[116:119], a[140:143], v[216:219]
v_mfma_f32_16x16x32_bf16 v[220:223], a[120:123], a[136:139], v[220:223]
ds_read_b128 a[60:63], v3 offset:14336
v_mfma_f32_16x16x32_bf16 v[220:223], a[124:127], a[140:143], v[220:223]
s_waitcnt lgkmcnt(3)
v_mfma_f32_16x16x32_bf16 a[192:195], a[64:67], a[128:131], a[192:195]
ds_read_b64_tr_b16 a[136:137], v11 offset:32768
v_mfma_f32_16x16x32_bf16 a[192:195], a[68:71], a[132:135], a[192:195]
v_mfma_f32_16x16x32_bf16 a[196:199], a[72:75], a[128:131], a[196:199]
ds_read_b64_tr_b16 a[138:139], v11 offset:34816
v_mfma_f32_16x16x32_bf16 a[196:199], a[76:79], a[132:135], a[196:199]
v_mfma_f32_16x16x32_bf16 a[200:203], a[80:83], a[128:131], a[200:203]
ds_read_b64_tr_b16 a[140:141], v11 offset:49152
v_mfma_f32_16x16x32_bf16 a[200:203], a[84:87], a[132:135], a[200:203]
v_mfma_f32_16x16x32_bf16 a[204:207], a[88:91], a[128:131], a[204:207]
ds_read_b64_tr_b16 a[142:143], v11 offset:51200
v_mfma_f32_16x16x32_bf16 a[204:207], a[92:95], a[132:135], a[204:207]
v_mfma_f32_16x16x32_bf16 a[208:211], a[96:99], a[128:131], a[208:211]
v_mfma_f32_16x16x32_bf16 a[208:211], a[100:103], a[132:135], a[208:211]
v_mfma_f32_16x16x32_bf16 a[212:215], a[104:107], a[128:131], a[212:215]
v_mfma_f32_16x16x32_bf16 a[212:215], a[108:111], a[132:135], a[212:215]
v_mfma_f32_16x16x32_bf16 a[216:219], a[112:115], a[128:131], a[216:219]
v_mfma_f32_16x16x32_bf16 a[216:219], a[116:119], a[132:135], a[216:219]
v_mfma_f32_16x16x32_bf16 a[220:223], a[120:123], a[128:131], a[220:223]
s_waitcnt vmcnt(4) lgkmcnt(0)
v_mfma_f32_16x16x32_bf16 a[220:223], a[124:127], a[132:135], a[220:223]
s_barrier
v_mfma_f32_16x16x32_bf16 a[224:227], a[64:67], a[136:139], a[224:227]
s_add_u32 m0, s29, 98304
ds_read_b64_tr_b16 a[128:129], v4 offset:0
v_mfma_f32_16x16x32_bf16 a[224:227], a[68:71], a[140:143], a[224:227]
buffer_load_dwordx4 v16, s[12:15], s26 offen offset:0 lds
v_mfma_f32_16x16x32_bf16 a[228:231], a[72:75], a[136:139], a[228:231]
ds_read_b64_tr_b16 a[130:131], v4 offset:2048
v_mfma_f32_16x16x32_bf16 a[228:231], a[76:79], a[140:143], a[228:231]
v_mfma_f32_16x16x32_bf16 a[232:235], a[80:83], a[136:139], a[232:235]
ds_read_b64_tr_b16 a[132:133], v4 offset:16384
v_mfma_f32_16x16x32_bf16 a[232:235], a[84:87], a[140:143], a[232:235]
buffer_load_dwordx4 v17, s[12:15], s26 offen offset:1024 lds
v_mfma_f32_16x16x32_bf16 a[236:239], a[88:91], a[136:139], a[236:239]
ds_read_b64_tr_b16 a[134:135], v4 offset:18432
v_mfma_f32_16x16x32_bf16 a[236:239], a[92:95], a[140:143], a[236:239]
v_mfma_f32_16x16x32_bf16 a[240:243], a[96:99], a[136:139], a[240:243]
v_mfma_f32_16x16x32_bf16 a[240:243], a[100:103], a[140:143], a[240:243]
buffer_load_dwordx4 v18, s[12:15], s26 offen offset:2048 lds
v_mfma_f32_16x16x32_bf16 a[244:247], a[104:107], a[136:139], a[244:247]
v_mfma_f32_16x16x32_bf16 a[244:247], a[108:111], a[140:143], a[244:247]
v_mfma_f32_16x16x32_bf16 a[248:251], a[112:115], a[136:139], a[248:251]
v_mfma_f32_16x16x32_bf16 a[248:251], a[116:119], a[140:143], a[248:251]
buffer_load_dwordx4 v19, s[12:15], s26 offen offset:3072 lds
v_mfma_f32_16x16x32_bf16 a[252:255], a[120:123], a[136:139], a[252:255]
s_add_u32 s26, s26, 524288
v_mfma_f32_16x16x32_bf16 a[252:255], a[124:127], a[140:143], a[252:255]
s_waitcnt lgkmcnt(0)
v_mfma_f32_16x16x32_bf16 v[32:35], a[0:3], a[128:131], v[32:35]
s_add_u32 m0, s29, 114688
ds_read_b64_tr_b16 a[136:137], v5 offset:0
v_mfma_f32_16x16x32_bf16 v[32:35], a[4:7], a[132:135], v[32:35]
buffer_load_dwordx4 v16, s[12:15], s27 offen offset:0 lds
v_mfma_f32_16x16x32_bf16 v[36:39], a[8:11], a[128:131], v[36:39]
ds_read_b64_tr_b16 a[138:139], v5 offset:2048
v_mfma_f32_16x16x32_bf16 v[36:39], a[12:15], a[132:135], v[36:39]
v_mfma_f32_16x16x32_bf16 v[40:43], a[16:19], a[128:131], v[40:43]
ds_read_b64_tr_b16 a[140:141], v5 offset:16384
v_mfma_f32_16x16x32_bf16 v[40:43], a[20:23], a[132:135], v[40:43]
buffer_load_dwordx4 v17, s[12:15], s27 offen offset:1024 lds
v_mfma_f32_16x16x32_bf16 v[44:47], a[24:27], a[128:131], v[44:47]
ds_read_b64_tr_b16 a[142:143], v5 offset:18432
v_mfma_f32_16x16x32_bf16 v[44:47], a[28:31], a[132:135], v[44:47]
v_mfma_f32_16x16x32_bf16 v[48:51], a[32:35], a[128:131], v[48:51]
ds_read_b128 a[64:67], v2 offset:32768
v_mfma_f32_16x16x32_bf16 v[48:51], a[36:39], a[132:135], v[48:51]
buffer_load_dwordx4 v18, s[12:15], s27 offen offset:2048 lds
v_mfma_f32_16x16x32_bf16 v[52:55], a[40:43], a[128:131], v[52:55]
ds_read_b128 a[68:71], v3 offset:32768
v_mfma_f32_16x16x32_bf16 v[52:55], a[44:47], a[132:135], v[52:55]
v_mfma_f32_16x16x32_bf16 v[56:59], a[48:51], a[128:131], v[56:59]
v_mfma_f32_16x16x32_bf16 v[56:59], a[52:55], a[132:135], v[56:59]
buffer_load_dwordx4 v19, s[12:15], s27 offen offset:3072 lds
v_mfma_f32_16x16x32_bf16 v[60:63], a[56:59], a[128:131], v[60:63]
s_add_u32 s27, s27, 524288
ds_read_b128 a[72:75], v2 offset:34816
v_mfma_f32_16x16x32_bf16 v[60:63], a[60:63], a[132:135], v[60:63]
s_waitcnt lgkmcnt(3)
v_mfma_f32_16x16x32_bf16 v[64:67], a[0:3], a[136:139], v[64:67]
s_add_u32 m0, s28, 0
ds_read_b64_tr_b16 a[128:129], v6 offset:0
v_mfma_f32_16x16x32_bf16 v[64:67], a[4:7], a[140:143], v[64:67]
buffer_load_dwordx4 v12, s[8:11], s24 offen offset:0 lds
v_mfma_f32_16x16x32_bf16 v[68:71], a[8:11], a[136:139], v[68:71]
ds_read_b64_tr_b16 a[130:131], v6 offset:2048
v_mfma_f32_16x16x32_bf16 v[68:71], a[12:15], a[140:143], v[68:71]
v_mfma_f32_16x16x32_bf16 v[72:75], a[16:19], a[136:139], v[72:75]
ds_read_b64_tr_b16 a[132:133], v6 offset:16384
v_mfma_f32_16x16x32_bf16 v[72:75], a[20:23], a[140:143], v[72:75]
buffer_load_dwordx4 v13, s[8:11], s24 offen offset:1024 lds
v_mfma_f32_16x16x32_bf16 v[76:79], a[24:27], a[136:139], v[76:79]
ds_read_b64_tr_b16 a[134:135], v6 offset:18432
v_mfma_f32_16x16x32_bf16 v[76:79], a[28:31], a[140:143], v[76:79]
v_mfma_f32_16x16x32_bf16 v[80:83], a[32:35], a[136:139], v[80:83]
ds_read_b128 a[76:79], v3 offset:34816
v_mfma_f32_16x16x32_bf16 v[80:83], a[36:39], a[140:143], v[80:83]
buffer_load_dwordx4 v14, s[8:11], s24 offen offset:2048 lds
v_mfma_f32_16x16x32_bf16 v[84:87], a[40:43], a[136:139], v[84:87]
v_mfma_f32_16x16x32_bf16 v[84:87], a[44:47], a[140:143], v[84:87]
v_mfma_f32_16x16x32_bf16 v[88:91], a[48:51], a[136:139], v[88:91]
ds_read_b128 a[80:83], v2 offset:36864
v_mfma_f32_16x16x32_bf16 v[88:91], a[52:55], a[140:143], v[88:91]
buffer_load_dwordx4 v15, s[8:11], s24 offen offset:3072 lds
v_mfma_f32_16x16x32_bf16 v[92:95], a[56:59], a[136:139], v[92:95]
s_add_u32 s24, s24, 128
ds_read_b128 a[84:87], v3 offset:36864
v_mfma_f32_16x16x32_bf16 v[92:95], a[60:63], a[140:143], v[92:95]
s_waitcnt lgkmcnt(3)
s_mov_b64 s[12:13], s[80:81]
v_mfma_f32_16x16x32_bf16 v[96:99], a[0:3], a[128:131], v[96:99]
s_mov_b32 s14, 3670016
s_add_u32 m0, s28, 16384
ds_read_b64_tr_b16 a[136:137], v7 offset:0
v_mfma_f32_16x16x32_bf16 v[96:99], a[4:7], a[132:135], v[96:99]
buffer_load_dwordx4 v12, s[8:11], s24 offen offset:0 lds
v_mfma_f32_16x16x32_bf16 v[100:103], a[8:11], a[128:131], v[100:103]
ds_read_b64_tr_b16 a[138:139], v7 offset:2048
v_mfma_f32_16x16x32_bf16 v[100:103], a[12:15], a[132:135], v[100:103]
v_mfma_f32_16x16x32_bf16 v[104:107], a[16:19], a[128:131], v[104:107]
ds_read_b64_tr_b16 a[140:141], v7 offset:16384
v_mfma_f32_16x16x32_bf16 v[104:107], a[20:23], a[132:135], v[104:107]
buffer_load_dwordx4 v13, s[8:11], s24 offen offset:1024 lds
v_mfma_f32_16x16x32_bf16 v[108:111], a[24:27], a[128:131], v[108:111]
ds_read_b64_tr_b16 a[142:143], v7 offset:18432
v_mfma_f32_16x16x32_bf16 v[108:111], a[28:31], a[132:135], v[108:111]
v_mfma_f32_16x16x32_bf16 v[112:115], a[32:35], a[128:131], v[112:115]
v_mfma_f32_16x16x32_bf16 v[112:115], a[36:39], a[132:135], v[112:115]
buffer_load_dwordx4 v14, s[8:11], s24 offen offset:2048 lds
v_mfma_f32_16x16x32_bf16 v[116:119], a[40:43], a[128:131], v[116:119]
ds_read_b128 a[88:91], v2 offset:38912
v_mfma_f32_16x16x32_bf16 v[116:119], a[44:47], a[132:135], v[116:119]
v_mfma_f32_16x16x32_bf16 v[120:123], a[48:51], a[128:131], v[120:123]
ds_read_b128 a[92:95], v3 offset:38912
v_mfma_f32_16x16x32_bf16 v[120:123], a[52:55], a[132:135], v[120:123]
buffer_load_dwordx4 v15, s[8:11], s24 offen offset:3072 lds
v_mfma_f32_16x16x32_bf16 v[124:127], a[56:59], a[128:131], v[124:127]
s_add_u32 s24, s24, 128
v_mfma_f32_16x16x32_bf16 v[124:127], a[60:63], a[132:135], v[124:127]
s_waitcnt lgkmcnt(2)
s_sub_u32 s26, s26, 8388608
v_mfma_f32_16x16x32_bf16 v[128:131], a[0:3], a[136:139], v[128:131]
s_sub_u32 s27, s27, 8388608
s_add_u32 m0, s29, 131072
ds_read_b64_tr_b16 a[128:129], v8 offset:0
v_mfma_f32_16x16x32_bf16 v[128:131], a[4:7], a[140:143], v[128:131]
buffer_load_dwordx4 v16, s[12:15], s26 offen offset:0 lds
v_mfma_f32_16x16x32_bf16 v[132:135], a[8:11], a[136:139], v[132:135]
ds_read_b64_tr_b16 a[130:131], v8 offset:2048
v_mfma_f32_16x16x32_bf16 v[132:135], a[12:15], a[140:143], v[132:135]
v_mfma_f32_16x16x32_bf16 v[136:139], a[16:19], a[136:139], v[136:139]
ds_read_b64_tr_b16 a[132:133], v8 offset:16384
v_mfma_f32_16x16x32_bf16 v[136:139], a[20:23], a[140:143], v[136:139]
buffer_load_dwordx4 v17, s[12:15], s26 offen offset:1024 lds
v_mfma_f32_16x16x32_bf16 v[140:143], a[24:27], a[136:139], v[140:143]
ds_read_b64_tr_b16 a[134:135], v8 offset:18432
v_mfma_f32_16x16x32_bf16 v[140:143], a[28:31], a[140:143], v[140:143]
v_mfma_f32_16x16x32_bf16 v[144:147], a[32:35], a[136:139], v[144:147]
ds_read_b128 a[96:99], v2 offset:40960
v_mfma_f32_16x16x32_bf16 v[144:147], a[36:39], a[140:143], v[144:147]
buffer_load_dwordx4 v18, s[12:15], s26 offen offset:2048 lds
v_mfma_f32_16x16x32_bf16 v[148:151], a[40:43], a[136:139], v[148:151]
v_mfma_f32_16x16x32_bf16 v[148:151], a[44:47], a[140:143], v[148:151]
v_mfma_f32_16x16x32_bf16 v[152:155], a[48:51], a[136:139], v[152:155]
ds_read_b128 a[100:103], v3 offset:40960
v_mfma_f32_16x16x32_bf16 v[152:155], a[52:55], a[140:143], v[152:155]
buffer_load_dwordx4 v19, s[12:15], s26 offen offset:3072 lds
v_mfma_f32_16x16x32_bf16 v[156:159], a[56:59], a[136:139], v[156:159]
s_add_u32 s26, s26, 524288
ds_read_b128 a[104:107], v2 offset:43008
v_mfma_f32_16x16x32_bf16 v[156:159], a[60:63], a[140:143], v[156:159]
s_waitcnt lgkmcnt(3)
v_mfma_f32_16x16x32_bf16 v[160:163], a[0:3], a[128:131], v[160:163]
s_add_u32 m0, s29, 147456
ds_read_b64_tr_b16 a[136:137], v9 offset:0
v_mfma_f32_16x16x32_bf16 v[160:163], a[4:7], a[132:135], v[160:163]
buffer_load_dwordx4 v16, s[12:15], s27 offen offset:0 lds
v_mfma_f32_16x16x32_bf16 v[164:167], a[8:11], a[128:131], v[164:167]
ds_read_b64_tr_b16 a[138:139], v9 offset:2048
v_mfma_f32_16x16x32_bf16 v[164:167], a[12:15], a[132:135], v[164:167]
v_mfma_f32_16x16x32_bf16 v[168:171], a[16:19], a[128:131], v[168:171]
ds_read_b64_tr_b16 a[140:141], v9 offset:16384
v_mfma_f32_16x16x32_bf16 v[168:171], a[20:23], a[132:135], v[168:171]
buffer_load_dwordx4 v17, s[12:15], s27 offen offset:1024 lds
v_mfma_f32_16x16x32_bf16 v[172:175], a[24:27], a[128:131], v[172:175]
ds_read_b64_tr_b16 a[142:143], v9 offset:18432
v_mfma_f32_16x16x32_bf16 v[172:175], a[28:31], a[132:135], v[172:175]
v_mfma_f32_16x16x32_bf16 v[176:179], a[32:35], a[128:131], v[176:179]
v_mfma_f32_16x16x32_bf16 v[176:179], a[36:39], a[132:135], v[176:179]
buffer_load_dwordx4 v18, s[12:15], s27 offen offset:2048 lds
v_mfma_f32_16x16x32_bf16 v[180:183], a[40:43], a[128:131], v[180:183]
ds_read_b128 a[108:111], v3 offset:43008
v_mfma_f32_16x16x32_bf16 v[180:183], a[44:47], a[132:135], v[180:183]
v_mfma_f32_16x16x32_bf16 v[184:187], a[48:51], a[128:131], v[184:187]
ds_read_b128 a[112:115], v2 offset:45056
v_mfma_f32_16x16x32_bf16 v[184:187], a[52:55], a[132:135], v[184:187]
buffer_load_dwordx4 v19, s[12:15], s27 offen offset:3072 lds
v_mfma_f32_16x16x32_bf16 v[188:191], a[56:59], a[128:131], v[188:191]
s_add_u32 s27, s27, 524288
v_mfma_f32_16x16x32_bf16 v[188:191], a[60:63], a[132:135], v[188:191]
s_waitcnt lgkmcnt(2)
v_mfma_f32_16x16x32_bf16 v[192:195], a[0:3], a[136:139], v[192:195]
ds_read_b64_tr_b16 a[128:129], v10 offset:0
v_mfma_f32_16x16x32_bf16 v[192:195], a[4:7], a[140:143], v[192:195]
v_mfma_f32_16x16x32_bf16 v[196:199], a[8:11], a[136:139], v[196:199]
ds_read_b64_tr_b16 a[130:131], v10 offset:2048
v_mfma_f32_16x16x32_bf16 v[196:199], a[12:15], a[140:143], v[196:199]
v_mfma_f32_16x16x32_bf16 v[200:203], a[16:19], a[136:139], v[200:203]
ds_read_b64_tr_b16 a[132:133], v10 offset:16384
v_mfma_f32_16x16x32_bf16 v[200:203], a[20:23], a[140:143], v[200:203]
v_mfma_f32_16x16x32_bf16 v[204:207], a[24:27], a[136:139], v[204:207]
ds_read_b64_tr_b16 a[134:135], v10 offset:18432
v_mfma_f32_16x16x32_bf16 v[204:207], a[28:31], a[140:143], v[204:207]
v_mfma_f32_16x16x32_bf16 v[208:211], a[32:35], a[136:139], v[208:211]
ds_read_b128 a[116:119], v3 offset:45056
v_mfma_f32_16x16x32_bf16 v[208:211], a[36:39], a[140:143], v[208:211]
v_mfma_f32_16x16x32_bf16 v[212:215], a[40:43], a[136:139], v[212:215]
ds_read_b128 a[120:123], v2 offset:47104
v_mfma_f32_16x16x32_bf16 v[212:215], a[44:47], a[140:143], v[212:215]
v_mfma_f32_16x16x32_bf16 v[216:219], a[48:51], a[136:139], v[216:219]
v_mfma_f32_16x16x32_bf16 v[216:219], a[52:55], a[140:143], v[216:219]
v_mfma_f32_16x16x32_bf16 v[220:223], a[56:59], a[136:139], v[220:223]
ds_read_b128 a[124:127], v3 offset:47104
v_mfma_f32_16x16x32_bf16 v[220:223], a[60:63], a[140:143], v[220:223]
s_waitcnt lgkmcnt(3)
v_mfma_f32_16x16x32_bf16 a[192:195], a[0:3], a[128:131], a[192:195]
ds_read_b64_tr_b16 a[136:137], v11 offset:0
v_mfma_f32_16x16x32_bf16 a[192:195], a[4:7], a[132:135], a[192:195]
v_mfma_f32_16x16x32_bf16 a[196:199], a[8:11], a[128:131], a[196:199]
ds_read_b64_tr_b16 a[138:139], v11 offset:2048
v_mfma_f32_16x16x32_bf16 a[196:199], a[12:15], a[132:135], a[196:199]
v_mfma_f32_16x16x32_bf16 a[200:203], a[16:19], a[128:131], a[200:203]
ds_read_b64_tr_b16 a[140:141], v11 offset:16384
v_mfma_f32_16x16x32_bf16 a[200:203], a[20:23], a[132:135], a[200:203]
v_mfma_f32_16x16x32_bf16 a[204:207], a[24:27], a[128:131], a[204:207]
ds_read_b64_tr_b16 a[142:143], v11 offset:18432
v_mfma_f32_16x16x32_bf16 a[204:207], a[28:31], a[132:135], a[204:207]
v_mfma_f32_16x16x32_bf16 a[208:211], a[32:35], a[128:131], a[208:211]
v_mfma_f32_16x16x32_bf16 a[208:211], a[36:39], a[132:135], a[208:211]
v_mfma_f32_16x16x32_bf16 a[212:215], a[40:43], a[128:131], a[212:215]
v_mfma_f32_16x16x32_bf16 a[212:215], a[44:47], a[132:135], a[212:215]
v_mfma_f32_16x16x32_bf16 a[216:219], a[48:51], a[128:131], a[216:219]
v_mfma_f32_16x16x32_bf16 a[216:219], a[52:55], a[132:135], a[216:219]
v_mfma_f32_16x16x32_bf16 a[220:223], a[56:59], a[128:131], a[220:223]
s_waitcnt vmcnt(12) lgkmcnt(0)
v_mfma_f32_16x16x32_bf16 a[220:223], a[60:63], a[132:135], a[220:223]
s_barrier
v_mfma_f32_16x16x32_bf16 a[224:227], a[0:3], a[136:139], a[224:227]
s_add_u32 m0, s28, 32768
ds_read_b64_tr_b16 a[128:129], v4 offset:32768
v_mfma_f32_16x16x32_bf16 a[224:227], a[4:7], a[140:143], a[224:227]
s_lshr_b32 s22, s3, 1
buffer_load_dwordx4 v12, s[8:11], s24 offen offset:0 lds
v_mfma_f32_16x16x32_bf16 a[228:231], a[8:11], a[136:139], a[228:231]
s_lshl_b32 s22, s22, 14
ds_read_b64_tr_b16 a[130:131], v4 offset:34816
v_subrev_u32 v2, s22, v2
v_mfma_f32_16x16x32_bf16 a[228:231], a[12:15], a[140:143], a[228:231]
v_subrev_u32 v3, s22, v3
v_mfma_f32_16x16x32_bf16 a[232:235], a[16:19], a[136:139], a[232:235]
ds_read_b64_tr_b16 a[132:133], v4 offset:49152
v_mfma_f32_16x16x32_bf16 a[232:235], a[20:23], a[140:143], a[232:235]
buffer_load_dwordx4 v13, s[8:11], s24 offen offset:1024 lds
v_mfma_f32_16x16x32_bf16 a[236:239], a[24:27], a[136:139], a[236:239]
ds_read_b64_tr_b16 a[134:135], v4 offset:51200
v_mfma_f32_16x16x32_bf16 a[236:239], a[28:31], a[140:143], a[236:239]
v_mfma_f32_16x16x32_bf16 a[240:243], a[32:35], a[136:139], a[240:243]
v_mfma_f32_16x16x32_bf16 a[240:243], a[36:39], a[140:143], a[240:243]
buffer_load_dwordx4 v14, s[8:11], s24 offen offset:2048 lds
v_mfma_f32_16x16x32_bf16 a[244:247], a[40:43], a[136:139], a[244:247]
v_mfma_f32_16x16x32_bf16 a[244:247], a[44:47], a[140:143], a[244:247]
v_mfma_f32_16x16x32_bf16 a[248:251], a[48:51], a[136:139], a[248:251]
v_mfma_f32_16x16x32_bf16 a[248:251], a[52:55], a[140:143], a[248:251]
buffer_load_dwordx4 v15, s[8:11], s24 offen offset:3072 lds
v_mfma_f32_16x16x32_bf16 a[252:255], a[56:59], a[136:139], a[252:255]
s_add_u32 s24, s24, 128
v_mfma_f32_16x16x32_bf16 a[252:255], a[60:63], a[140:143], a[252:255]
s_waitcnt lgkmcnt(0)
v_mfma_f32_16x16x32_bf16 v[32:35], a[64:67], a[128:131], v[32:35]
s_add_u32 m0, s29, 65536
ds_read_b64_tr_b16 a[136:137], v5 offset:32768
v_mfma_f32_16x16x32_bf16 v[32:35], a[68:71], a[132:135], v[32:35]
buffer_load_dwordx4 v16, s[12:15], s26 offen offset:0 lds
v_mfma_f32_16x16x32_bf16 v[36:39], a[72:75], a[128:131], v[36:39]
ds_read_b64_tr_b16 a[138:139], v5 offset:34816
v_mfma_f32_16x16x32_bf16 v[36:39], a[76:79], a[132:135], v[36:39]
v_mfma_f32_16x16x32_bf16 v[40:43], a[80:83], a[128:131], v[40:43]
ds_read_b64_tr_b16 a[140:141], v5 offset:49152
v_mfma_f32_16x16x32_bf16 v[40:43], a[84:87], a[132:135], v[40:43]
buffer_load_dwordx4 v17, s[12:15], s26 offen offset:1024 lds
v_mfma_f32_16x16x32_bf16 v[44:47], a[88:91], a[128:131], v[44:47]
ds_read_b64_tr_b16 a[142:143], v5 offset:51200
v_mfma_f32_16x16x32_bf16 v[44:47], a[92:95], a[132:135], v[44:47]
v_mfma_f32_16x16x32_bf16 v[48:51], a[96:99], a[128:131], v[48:51]
ds_read_b128 a[0:3], v2 offset:0
v_cvt_pk_bf16_f32 v32, v32, v33
v_mfma_f32_16x16x32_bf16 v[48:51], a[100:103], a[132:135], v[48:51]
buffer_load_dwordx4 v18, s[12:15], s26 offen offset:2048 lds
v_mfma_f32_16x16x32_bf16 v[52:55], a[104:107], a[128:131], v[52:55]
ds_read_b128 a[4:7], v3 offset:0
v_cvt_pk_bf16_f32 v33, v34, v35
v_mfma_f32_16x16x32_bf16 v[52:55], a[108:111], a[132:135], v[52:55]
v_cvt_pk_bf16_f32 v34, v36, v37
v_cvt_pk_bf16_f32 v35, v38, v39
v_mfma_f32_16x16x32_bf16 v[56:59], a[112:115], a[128:131], v[56:59]
v_cvt_pk_bf16_f32 v40, v40, v41
v_cvt_pk_bf16_f32 v41, v42, v43
v_mfma_f32_16x16x32_bf16 v[56:59], a[116:119], a[132:135], v[56:59]
buffer_load_dwordx4 v19, s[12:15], s26 offen offset:3072 lds
v_mfma_f32_16x16x32_bf16 v[60:63], a[120:123], a[128:131], v[60:63]
s_add_u32 s26, s26, 524288
ds_read_b128 a[8:11], v2 offset:2048
v_cvt_pk_bf16_f32 v42, v44, v45
v_mfma_f32_16x16x32_bf16 v[60:63], a[124:127], a[132:135], v[60:63]
s_waitcnt lgkmcnt(3)
v_cvt_pk_bf16_f32 v43, v46, v47
v_mfma_f32_16x16x32_bf16 v[64:67], a[64:67], a[136:139], v[64:67]
s_add_u32 m0, s29, 81920
ds_read_b64_tr_b16 a[128:129], v6 offset:32768
v_cvt_pk_bf16_f32 v48, v48, v49
v_mfma_f32_16x16x32_bf16 v[64:67], a[68:71], a[140:143], v[64:67]
buffer_load_dwordx4 v16, s[12:15], s27 offen offset:0 lds
v_mfma_f32_16x16x32_bf16 v[68:71], a[72:75], a[136:139], v[68:71]
ds_read_b64_tr_b16 a[130:131], v6 offset:34816
v_cvt_pk_bf16_f32 v49, v50, v51
v_mfma_f32_16x16x32_bf16 v[68:71], a[76:79], a[140:143], v[68:71]
v_cvt_pk_bf16_f32 v50, v52, v53
v_cvt_pk_bf16_f32 v51, v54, v55
v_mfma_f32_16x16x32_bf16 v[72:75], a[80:83], a[136:139], v[72:75]
ds_read_b64_tr_b16 a[132:133], v6 offset:49152
v_cvt_pk_bf16_f32 v56, v56, v57
v_mfma_f32_16x16x32_bf16 v[72:75], a[84:87], a[140:143], v[72:75]
buffer_load_dwordx4 v17, s[12:15], s27 offen offset:1024 lds
v_mfma_f32_16x16x32_bf16 v[76:79], a[88:91], a[136:139], v[76:79]
ds_read_b64_tr_b16 a[134:135], v6 offset:51200
v_cvt_pk_bf16_f32 v57, v58, v59
v_mfma_f32_16x16x32_bf16 v[76:79], a[92:95], a[140:143], v[76:79]
v_cvt_pk_bf16_f32 v58, v60, v61
v_cvt_pk_bf16_f32 v59, v62, v63
v_mfma_f32_16x16x32_bf16 v[80:83], a[96:99], a[136:139], v[80:83]
ds_read_b128 a[12:15], v3 offset:2048
v_cvt_pk_bf16_f32 v64, v64, v65
v_mfma_f32_16x16x32_bf16 v[80:83], a[100:103], a[140:143], v[80:83]
buffer_load_dwordx4 v18, s[12:15], s27 offen offset:2048 lds
v_mfma_f32_16x16x32_bf16 v[84:87], a[104:107], a[136:139], v[84:87]
v_cvt_pk_bf16_f32 v65, v66, v67
v_cvt_pk_bf16_f32 v66, v68, v69
v_mfma_f32_16x16x32_bf16 v[84:87], a[108:111], a[140:143], v[84:87]
v_cvt_pk_bf16_f32 v67, v70, v71
v_mfma_f32_16x16x32_bf16 v[88:91], a[112:115], a[136:139], v[88:91]
ds_read_b128 a[16:19], v2 offset:4096
v_cvt_pk_bf16_f32 v72, v72, v73
v_mfma_f32_16x16x32_bf16 v[88:91], a[116:119], a[140:143], v[88:91]
buffer_load_dwordx4 v19, s[12:15], s27 offen offset:3072 lds
v_mfma_f32_16x16x32_bf16 v[92:95], a[120:123], a[136:139], v[92:95]
s_add_u32 s27, s27, 524288
ds_read_b128 a[20:23], v3 offset:4096
v_cvt_pk_bf16_f32 v73, v74, v75
v_mfma_f32_16x16x32_bf16 v[92:95], a[124:127], a[140:143], v[92:95]
s_waitcnt lgkmcnt(3)
v_cvt_pk_bf16_f32 v74, v76, v77
v_cvt_pk_bf16_f32 v75, v78, v79
v_mfma_f32_16x16x32_bf16 v[96:99], a[64:67], a[128:131], v[96:99]
s_add_u32 m0, s28, 49152
ds_read_b64_tr_b16 a[136:137], v7 offset:32768
v_cvt_pk_bf16_f32 v80, v80, v81
v_mfma_f32_16x16x32_bf16 v[96:99], a[68:71], a[132:135], v[96:99]
PAD_27:
s_cbranch_execz PAD_31
buffer_load_dwordx4 v12, s[8:11], s24 offen offset:0 lds
v_mfma_f32_16x16x32_bf16 v[100:103], a[72:75], a[128:131], v[100:103]
ds_read_b64_tr_b16 a[138:139], v7 offset:34816
v_cvt_pk_bf16_f32 v81, v82, v83
v_mfma_f32_16x16x32_bf16 v[100:103], a[76:79], a[132:135], v[100:103]
v_cvt_pk_bf16_f32 v82, v84, v85
v_cvt_pk_bf16_f32 v83, v86, v87
v_mfma_f32_16x16x32_bf16 v[104:107], a[80:83], a[128:131], v[104:107]
ds_read_b64_tr_b16 a[140:141], v7 offset:49152
v_cvt_pk_bf16_f32 v88, v88, v89
v_mfma_f32_16x16x32_bf16 v[104:107], a[84:87], a[132:135], v[104:107]
buffer_load_dwordx4 v13, s[8:11], s24 offen offset:1024 lds
v_mfma_f32_16x16x32_bf16 v[108:111], a[88:91], a[128:131], v[108:111]
ds_read_b64_tr_b16 a[142:143], v7 offset:51200
v_cvt_pk_bf16_f32 v89, v90, v91
v_mfma_f32_16x16x32_bf16 v[108:111], a[92:95], a[132:135], v[108:111]
v_cvt_pk_bf16_f32 v90, v92, v93
v_cvt_pk_bf16_f32 v91, v94, v95
v_mfma_f32_16x16x32_bf16 v[112:115], a[96:99], a[128:131], v[112:115]
v_cvt_pk_bf16_f32 v96, v96, v97
v_cvt_pk_bf16_f32 v97, v98, v99
v_mfma_f32_16x16x32_bf16 v[112:115], a[100:103], a[132:135], v[112:115]
buffer_load_dwordx4 v14, s[8:11], s24 offen offset:2048 lds
v_mfma_f32_16x16x32_bf16 v[116:119], a[104:107], a[128:131], v[116:119]
ds_read_b128 a[24:27], v2 offset:6144
v_cvt_pk_bf16_f32 v98, v100, v101
v_mfma_f32_16x16x32_bf16 v[116:119], a[108:111], a[132:135], v[116:119]
buffer_store_dwordx4 v[32:35], v1, s[4:7], s31 offen sc1
v_mfma_f32_16x16x32_bf16 v[120:123], a[112:115], a[128:131], v[120:123]
s_add_u32 s31, s31, s32
ds_read_b128 a[28:31], v3 offset:6144
v_cvt_pk_bf16_f32 v99, v102, v103
v_mfma_f32_16x16x32_bf16 v[120:123], a[116:119], a[132:135], v[120:123]
buffer_load_dwordx4 v15, s[8:11], s24 offen offset:3072 lds
v_mfma_f32_16x16x32_bf16 v[124:127], a[120:123], a[128:131], v[124:127]
s_add_u32 s24, s24, 128
v_cvt_pk_bf16_f32 v104, v104, v105
v_cvt_pk_bf16_f32 v105, v106, v107
v_mfma_f32_16x16x32_bf16 v[124:127], a[124:127], a[132:135], v[124:127]
s_waitcnt lgkmcnt(2)
v_cvt_pk_bf16_f32 v106, v108, v109
v_cvt_pk_bf16_f32 v107, v110, v111
v_mfma_f32_16x16x32_bf16 v[128:131], a[64:67], a[136:139], v[128:131]
ds_read_b64_tr_b16 a[128:129], v8 offset:32768
v_cvt_pk_bf16_f32 v112, v112, v113
v_mfma_f32_16x16x32_bf16 v[128:131], a[68:71], a[140:143], v[128:131]
v_cvt_pk_bf16_f32 v113, v114, v115
v_cvt_pk_bf16_f32 v114, v116, v117
v_mfma_f32_16x16x32_bf16 v[132:135], a[72:75], a[136:139], v[132:135]
ds_read_b64_tr_b16 a[130:131], v8 offset:34816
v_cvt_pk_bf16_f32 v115, v118, v119
v_mfma_f32_16x16x32_bf16 v[132:135], a[76:79], a[140:143], v[132:135]
buffer_store_dwordx4 v[40:43], v1, s[4:7], s31 offen sc1
v_mfma_f32_16x16x32_bf16 v[136:139], a[80:83], a[136:139], v[136:139]
s_add_u32 s31, s31, s33
ds_read_b64_tr_b16 a[132:133], v8 offset:49152
v_cvt_pk_bf16_f32 v120, v120, v121
v_mfma_f32_16x16x32_bf16 v[136:139], a[84:87], a[140:143], v[136:139]
v_cvt_pk_bf16_f32 v121, v122, v123
v_cvt_pk_bf16_f32 v122, v124, v125
v_mfma_f32_16x16x32_bf16 v[140:143], a[88:91], a[136:139], v[140:143]
ds_read_b64_tr_b16 a[134:135], v8 offset:51200
v_cvt_pk_bf16_f32 v123, v126, v127
v_mfma_f32_16x16x32_bf16 v[140:143], a[92:95], a[140:143], v[140:143]
v_mfma_f32_16x16x32_bf16 v[144:147], a[96:99], a[136:139], v[144:147]
ds_read_b128 a[32:35], v2 offset:8192
v_cvt_pk_bf16_f32 v128, v128, v129
v_mfma_f32_16x16x32_bf16 v[144:147], a[100:103], a[140:143], v[144:147]
v_cvt_pk_bf16_f32 v129, v130, v131
v_cvt_pk_bf16_f32 v130, v132, v133
v_mfma_f32_16x16x32_bf16 v[148:151], a[104:107], a[136:139], v[148:151]
v_cvt_pk_bf16_f32 v131, v134, v135
v_mfma_f32_16x16x32_bf16 v[148:151], a[108:111], a[140:143], v[148:151]
v_mfma_f32_16x16x32_bf16 v[152:155], a[112:115], a[136:139], v[152:155]
ds_read_b128 a[36:39], v3 offset:8192
v_cvt_pk_bf16_f32 v136, v136, v137
v_mfma_f32_16x16x32_bf16 v[152:155], a[116:119], a[140:143], v[152:155]
v_cvt_pk_bf16_f32 v137, v138, v139
v_cvt_pk_bf16_f32 v138, v140, v141
v_mfma_f32_16x16x32_bf16 v[156:159], a[120:123], a[136:139], v[156:159]
ds_read_b128 a[40:43], v2 offset:10240
v_cvt_pk_bf16_f32 v139, v142, v143
v_mfma_f32_16x16x32_bf16 v[156:159], a[124:127], a[140:143], v[156:159]
s_waitcnt lgkmcnt(3)
buffer_store_dwordx4 v[48:51], v1, s[4:7], s31 offen sc1
v_mfma_f32_16x16x32_bf16 v[160:163], a[64:67], a[128:131], v[160:163]
s_add_u32 s31, s31, s32
ds_read_b64_tr_b16 a[136:137], v9 offset:32768
v_cvt_pk_bf16_f32 v144, v144, v145
v_mfma_f32_16x16x32_bf16 v[160:163], a[68:71], a[132:135], v[160:163]
v_cvt_pk_bf16_f32 v145, v146, v147
v_cvt_pk_bf16_f32 v146, v148, v149
v_mfma_f32_16x16x32_bf16 v[164:167], a[72:75], a[128:131], v[164:167]
ds_read_b64_tr_b16 a[138:139], v9 offset:34816
v_cvt_pk_bf16_f32 v147, v150, v151
v_mfma_f32_16x16x32_bf16 v[164:167], a[76:79], a[132:135], v[164:167]
v_mfma_f32_16x16x32_bf16 v[168:171], a[80:83], a[128:131], v[168:171]
ds_read_b64_tr_b16 a[140:141], v9 offset:49152
v_cvt_pk_bf16_f32 v152, v152, v153
v_mfma_f32_16x16x32_bf16 v[168:171], a[84:87], a[132:135], v[168:171]
v_cvt_pk_bf16_f32 v153, v154, v155
v_cvt_pk_bf16_f32 v154, v156, v157
v_mfma_f32_16x16x32_bf16 v[172:175], a[88:91], a[128:131], v[172:175]
ds_read_b64_tr_b16 a[142:143], v9 offset:51200
v_cvt_pk_bf16_f32 v155, v158, v159
v_mfma_f32_16x16x32_bf16 v[172:175], a[92:95], a[132:135], v[172:175]
v_mfma_f32_16x16x32_bf16 v[176:179], a[96:99], a[128:131], v[176:179]
buffer_store_dwordx4 v[56:59], v1, s[4:7], s31 offen sc1
v_mfma_f32_16x16x32_bf16 v[176:179], a[100:103], a[132:135], v[176:179]
s_add_u32 s31, s31, s34
v_cvt_pk_bf16_f32 v160, v160, v161
v_cvt_pk_bf16_f32 v161, v162, v163
v_mfma_f32_16x16x32_bf16 v[180:183], a[104:107], a[128:131], v[180:183]
ds_read_b128 a[44:47], v3 offset:10240
v_cvt_pk_bf16_f32 v162, v164, v165
v_mfma_f32_16x16x32_bf16 v[180:183], a[108:111], a[132:135], v[180:183]
v_cvt_pk_bf16_f32 v163, v166, v167
v_mfma_f32_16x16x32_bf16 v[184:187], a[112:115], a[128:131], v[184:187]
ds_read_b128 a[48:51], v2 offset:12288
v_cvt_pk_bf16_f32 v168, v168, v169
v_mfma_f32_16x16x32_bf16 v[184:187], a[116:119], a[132:135], v[184:187]
v_cvt_pk_bf16_f32 v169, v170, v171
v_cvt_pk_bf16_f32 v170, v172, v173
v_mfma_f32_16x16x32_bf16 v[188:191], a[120:123], a[128:131], v[188:191]
v_cvt_pk_bf16_f32 v171, v174, v175
v_mfma_f32_16x16x32_bf16 v[188:191], a[124:127], a[132:135], v[188:191]
s_waitcnt lgkmcnt(2)
v_mfma_f32_16x16x32_bf16 v[192:195], a[64:67], a[136:139], v[192:195]
ds_read_b64_tr_b16 a[128:129], v10 offset:32768
v_cvt_pk_bf16_f32 v176, v176, v177
v_mfma_f32_16x16x32_bf16 v[192:195], a[68:71], a[140:143], v[192:195]
v_cvt_pk_bf16_f32 v177, v178, v179
v_cvt_pk_bf16_f32 v178, v180, v181
v_mfma_f32_16x16x32_bf16 v[196:199], a[72:75], a[136:139], v[196:199]
ds_read_b64_tr_b16 a[130:131], v10 offset:34816
v_cvt_pk_bf16_f32 v179, v182, v183
v_mfma_f32_16x16x32_bf16 v[196:199], a[76:79], a[140:143], v[196:199]
buffer_store_dwordx4 v[64:67], v1, s[4:7], s31 offen sc1
v_mfma_f32_16x16x32_bf16 v[200:203], a[80:83], a[136:139], v[200:203]
s_add_u32 s31, s31, s32
ds_read_b64_tr_b16 a[132:133], v10 offset:49152
v_cvt_pk_bf16_f32 v184, v184, v185
v_mfma_f32_16x16x32_bf16 v[200:203], a[84:87], a[140:143], v[200:203]
v_cvt_pk_bf16_f32 v185, v186, v187
v_cvt_pk_bf16_f32 v186, v188, v189
v_mfma_f32_16x16x32_bf16 v[204:207], a[88:91], a[136:139], v[204:207]
ds_read_b64_tr_b16 a[134:135], v10 offset:51200
v_cvt_pk_bf16_f32 v187, v190, v191
v_mfma_f32_16x16x32_bf16 v[204:207], a[92:95], a[140:143], v[204:207]
v_mfma_f32_16x16x32_bf16 v[208:211], a[96:99], a[136:139], v[208:211]
ds_read_b128 a[52:55], v3 offset:12288
v_cvt_pk_bf16_f32 v192, v192, v193
v_mfma_f32_16x16x32_bf16 v[208:211], a[100:103], a[140:143], v[208:211]
v_cvt_pk_bf16_f32 v193, v194, v195
v_cvt_pk_bf16_f32 v194, v196, v197
v_mfma_f32_16x16x32_bf16 v[212:215], a[104:107], a[136:139], v[212:215]
ds_read_b128 a[56:59], v2 offset:14336
v_cvt_pk_bf16_f32 v195, v198, v199
v_mfma_f32_16x16x32_bf16 v[212:215], a[108:111], a[140:143], v[212:215]
v_mfma_f32_16x16x32_bf16 v[216:219], a[112:115], a[136:139], v[216:219]
v_cvt_pk_bf16_f32 v200, v200, v201
v_cvt_pk_bf16_f32 v201, v202, v203
v_mfma_f32_16x16x32_bf16 v[216:219], a[116:119], a[140:143], v[216:219]
buffer_store_dwordx4 v[72:75], v1, s[4:7], s31 offen sc1
v_mfma_f32_16x16x32_bf16 v[220:223], a[120:123], a[136:139], v[220:223]
s_add_u32 s31, s31, s33
ds_read_b128 a[60:63], v3 offset:14336
v_cvt_pk_bf16_f32 v202, v204, v205
v_mfma_f32_16x16x32_bf16 v[220:223], a[124:127], a[140:143], v[220:223]
s_waitcnt lgkmcnt(3)
v_cvt_pk_bf16_f32 v203, v206, v207
v_mfma_f32_16x16x32_bf16 a[192:195], a[64:67], a[128:131], a[192:195]
ds_read_b64_tr_b16 a[136:137], v11 offset:32768
v_cvt_pk_bf16_f32 v208, v208, v209
v_mfma_f32_16x16x32_bf16 a[192:195], a[68:71], a[132:135], a[192:195]
v_cvt_pk_bf16_f32 v209, v210, v211
v_cvt_pk_bf16_f32 v210, v212, v213
v_mfma_f32_16x16x32_bf16 a[196:199], a[72:75], a[128:131], a[196:199]
ds_read_b64_tr_b16 a[138:139], v11 offset:34816
v_cvt_pk_bf16_f32 v211, v214, v215
v_mfma_f32_16x16x32_bf16 a[196:199], a[76:79], a[132:135], a[196:199]
v_mfma_f32_16x16x32_bf16 a[200:203], a[80:83], a[128:131], a[200:203]
ds_read_b64_tr_b16 a[140:141], v11 offset:49152
v_cvt_pk_bf16_f32 v216, v216, v217
v_mfma_f32_16x16x32_bf16 a[200:203], a[84:87], a[132:135], a[200:203]
v_cvt_pk_bf16_f32 v217, v218, v219
v_cvt_pk_bf16_f32 v218, v220, v221
v_mfma_f32_16x16x32_bf16 a[204:207], a[88:91], a[128:131], a[204:207]
ds_read_b64_tr_b16 a[142:143], v11 offset:51200
v_cvt_pk_bf16_f32 v219, v222, v223
v_mfma_f32_16x16x32_bf16 a[204:207], a[92:95], a[132:135], a[204:207]
v_mfma_f32_16x16x32_bf16 a[208:211], a[96:99], a[128:131], a[208:211]
buffer_store_dwordx4 v[80:83], v1, s[4:7], s31 offen sc1
v_mfma_f32_16x16x32_bf16 a[208:211], a[100:103], a[132:135], a[208:211]
s_add_u32 s31, s31, s32
v_mfma_f32_16x16x32_bf16 a[212:215], a[104:107], a[128:131], a[212:215]
v_mfma_f32_16x16x32_bf16 a[212:215], a[108:111], a[132:135], a[212:215]
v_mfma_f32_16x16x32_bf16 a[216:219], a[112:115], a[128:131], a[216:219]
v_mfma_f32_16x16x32_bf16 a[216:219], a[116:119], a[132:135], a[216:219]
v_mfma_f32_16x16x32_bf16 a[220:223], a[120:123], a[128:131], a[220:223]
s_waitcnt vmcnt(23) lgkmcnt(0)
v_mfma_f32_16x16x32_bf16 a[220:223], a[124:127], a[132:135], a[220:223]
s_barrier
v_mfma_f32_16x16x32_bf16 a[224:227], a[64:67], a[136:139], a[224:227]
s_add_u32 m0, s29, 98304
ds_read_b64_tr_b16 a[128:129], v22 offset:0
v_mfma_f32_16x16x32_bf16 a[224:227], a[68:71], a[140:143], a[224:227]
buffer_load_dwordx4 v16, s[12:15], s26 offen offset:0 lds
v_mfma_f32_16x16x32_bf16 a[228:231], a[72:75], a[136:139], a[228:231]
ds_read_b64_tr_b16 a[130:131], v22 offset:2048
v_mfma_f32_16x16x32_bf16 a[228:231], a[76:79], a[140:143], a[228:231]
buffer_store_dwordx4 v[88:91], v1, s[4:7], s31 offen sc1
v_mfma_f32_16x16x32_bf16 a[232:235], a[80:83], a[136:139], a[232:235]
s_add_u32 s31, s31, s35
ds_read_b64_tr_b16 a[132:133], v22 offset:16384
v_mfma_f32_16x16x32_bf16 a[232:235], a[84:87], a[140:143], a[232:235]
buffer_load_dwordx4 v17, s[12:15], s26 offen offset:1024 lds
v_mfma_f32_16x16x32_bf16 a[236:239], a[88:91], a[136:139], a[236:239]
ds_read_b64_tr_b16 a[134:135], v22 offset:18432
v_add_u32 v22, 4294901760, v22
v_mfma_f32_16x16x32_bf16 a[236:239], a[92:95], a[140:143], a[236:239]
v_mfma_f32_16x16x32_bf16 a[240:243], a[96:99], a[136:139], a[240:243]
v_mfma_f32_16x16x32_bf16 a[240:243], a[100:103], a[140:143], a[240:243]
buffer_load_dwordx4 v18, s[12:15], s26 offen offset:2048 lds
v_mfma_f32_16x16x32_bf16 a[244:247], a[104:107], a[136:139], a[244:247]
v_mfma_f32_16x16x32_bf16 a[244:247], a[108:111], a[140:143], a[244:247]
v_mfma_f32_16x16x32_bf16 a[248:251], a[112:115], a[136:139], a[248:251]
v_mfma_f32_16x16x32_bf16 a[248:251], a[116:119], a[140:143], a[248:251]
buffer_load_dwordx4 v19, s[12:15], s26 offen offset:3072 lds
v_mfma_f32_16x16x32_bf16 a[252:255], a[120:123], a[136:139], a[252:255]
s_add_u32 s26, s26, 524288
v_mfma_f32_16x16x32_bf16 a[252:255], a[124:127], a[140:143], a[252:255]
s_waitcnt lgkmcnt(0)
s_cmp_ge_u32 s21, 7
s_cbranch_scc1 M_Q
M_conv:
v_mfma_f32_16x16x32_bf16 v[36:39], a[128:131], a[0:3], 0
s_add_u32 m0, s29, 114688
ds_read_b64_tr_b16 a[136:137], v23 offset:0
v_mfma_f32_16x16x32_bf16 v[36:39], a[132:135], a[4:7], v[36:39]
buffer_load_dwordx4 v16, s[12:15], s27 offen offset:0 lds
v_mfma_f32_16x16x32_bf16 v[44:47], a[128:131], a[8:11], 0
ds_read_b64_tr_b16 a[138:139], v23 offset:2048
v_mfma_f32_16x16x32_bf16 v[44:47], a[132:135], a[12:15], v[44:47]
ds_read_b128 a[64:67], v2 offset:16384
ds_read_b128 a[68:71], v3 offset:16384
v_mfma_f32_16x16x32_bf16 v[52:55], a[128:131], a[16:19], 0
ds_read_b64_tr_b16 a[140:141], v23 offset:16384
v_mfma_f32_16x16x32_bf16 v[52:55], a[132:135], a[20:23], v[52:55]
buffer_load_dwordx4 v17, s[12:15], s27 offen offset:1024 lds
v_mfma_f32_16x16x32_bf16 v[60:63], a[128:131], a[24:27], 0
ds_read_b64_tr_b16 a[142:143], v23 offset:18432
v_add_u32 v23, 4294901760, v23
v_mfma_f32_16x16x32_bf16 v[60:63], a[132:135], a[28:31], v[60:63]
buffer_store_dwordx4 v[96:99], v1, s[4:7], s31 offen sc1
v_mfma_f32_16x16x32_bf16 v[68:71], a[128:131], a[32:35], 0
s_add_u32 s31, s31, s32
ds_read_b128 a[72:75], v2 offset:18432
v_mfma_f32_16x16x32_bf16 v[68:71], a[132:135], a[36:39], v[68:71]
buffer_load_dwordx4 v18, s[12:15], s27 offen offset:2048 lds
v_mfma_f32_16x16x32_bf16 v[76:79], a[128:131], a[40:43], 0
ds_read_b128 a[76:79], v3 offset:18432
v_mfma_f32_16x16x32_bf16 v[76:79], a[132:135], a[44:47], v[76:79]
ds_read_b128 a[80:83], v2 offset:20480
v_mfma_f32_16x16x32_bf16 v[84:87], a[128:131], a[48:51], 0
ds_read_b128 a[84:87], v3 offset:20480
v_mfma_f32_16x16x32_bf16 v[84:87], a[132:135], a[52:55], v[84:87]
buffer_load_dwordx4 v19, s[12:15], s27 offen offset:3072 lds
v_mfma_f32_16x16x32_bf16 v[92:95], a[128:131], a[56:59], 0
s_add_u32 s27, s27, 524288
ds_read_b128 a[88:91], v2 offset:22528
v_mfma_f32_16x16x32_bf16 v[92:95], a[132:135], a[60:63], v[92:95]
s_waitcnt lgkmcnt(5)
buffer_store_dwordx4 v[104:107], v1, s[4:7], s31 offen sc1
v_mfma_f32_16x16x32_bf16 v[100:103], a[136:139], a[0:3], 0
s_add_u32 m0, s28, 0
ds_read_b64_tr_b16 a[128:129], v24 offset:0
v_mfma_f32_16x16x32_bf16 v[100:103], a[140:143], a[4:7], v[100:103]
s_add_u32 s31, s31, s33
buffer_load_dwordx4 v12, s[8:11], s24 offen offset:0 lds
v_mfma_f32_16x16x32_bf16 v[108:111], a[136:139], a[8:11], 0
ds_read_b64_tr_b16 a[130:131], v24 offset:2048
v_mfma_f32_16x16x32_bf16 v[108:111], a[140:143], a[12:15], v[108:111]
ds_read_b128 a[92:95], v3 offset:22528
v_mfma_f32_16x16x32_bf16 v[116:119], a[136:139], a[16:19], 0
ds_read_b64_tr_b16 a[132:133], v24 offset:16384
v_mfma_f32_16x16x32_bf16 v[116:119], a[140:143], a[20:23], v[116:119]
buffer_load_dwordx4 v13, s[8:11], s24 offen offset:1024 lds
v_mfma_f32_16x16x32_bf16 v[124:127], a[136:139], a[24:27], 0
ds_read_b64_tr_b16 a[134:135], v24 offset:18432
v_add_u32 v24, 4294901760, v24
v_mfma_f32_16x16x32_bf16 v[124:127], a[140:143], a[28:31], v[124:127]
v_mfma_f32_16x16x32_bf16 v[132:135], a[136:139], a[32:35], 0
ds_read_b128 a[96:99], v2 offset:24576
v_mfma_f32_16x16x32_bf16 v[132:135], a[140:143], a[36:39], v[132:135]
buffer_load_dwordx4 v14, s[8:11], s24 offen offset:2048 lds
v_mfma_f32_16x16x32_bf16 v[140:143], a[136:139], a[40:43], 0
ds_read_b128 a[100:103], v3 offset:24576
v_mfma_f32_16x16x32_bf16 v[140:143], a[140:143], a[44:47], v[140:143]
ds_read_b128 a[104:107], v2 offset:26624
v_mfma_f32_16x16x32_bf16 v[148:151], a[136:139], a[48:51], 0
ds_read_b128 a[108:111], v3 offset:26624
v_mfma_f32_16x16x32_bf16 v[148:151], a[140:143], a[52:55], v[148:151]
buffer_load_dwordx4 v15, s[8:11], s24 offen offset:3072 lds
v_mfma_f32_16x16x32_bf16 v[156:159], a[136:139], a[56:59], 0
s_add_u32 s24, s24, 128
ds_read_b128 a[112:115], v2 offset:28672
v_mfma_f32_16x16x32_bf16 v[156:159], a[140:143], a[60:63], v[156:159]
s_waitcnt lgkmcnt(5)
buffer_store_dwordx4 v[112:115], v1, s[4:7], s31 offen sc1
v_mfma_f32_16x16x32_bf16 v[164:167], a[128:131], a[0:3], 0
s_add_u32 s31, s31, s32
ds_read_b64_tr_b16 a[136:137], v25 offset:0
v_mfma_f32_16x16x32_bf16 v[164:167], a[132:135], a[4:7], v[164:167]
v_mfma_f32_16x16x32_bf16 v[172:175], a[128:131], a[8:11], 0
ds_read_b64_tr_b16 a[138:139], v25 offset:2048
v_mfma_f32_16x16x32_bf16 v[172:175], a[132:135], a[12:15], v[172:175]
ds_read_b128 a[116:119], v3 offset:28672
v_mfma_f32_16x16x32_bf16 v[180:183], a[128:131], a[16:19], 0
ds_read_b64_tr_b16 a[140:141], v25 offset:16384
v_mfma_f32_16x16x32_bf16 v[180:183], a[132:135], a[20:23], v[180:183]
v_mfma_f32_16x16x32_bf16 v[188:191], a[128:131], a[24:27], 0
ds_read_b64_tr_b16 a[142:143], v25 offset:18432
v_add_u32 v25, 4294901760, v25
v_mfma_f32_16x16x32_bf16 v[188:191], a[132:135], a[28:31], v[188:191]
v_mfma_f32_16x16x32_bf16 v[196:199], a[128:131], a[32:35], 0
ds_read_b128 a[120:123], v2 offset:30720
v_mfma_f32_16x16x32_bf16 v[196:199], a[132:135], a[36:39], v[196:199]
v_mfma_f32_16x16x32_bf16 v[204:207], a[128:131], a[40:43], 0
ds_read_b128 a[124:127], v3 offset:30720
v_mfma_f32_16x16x32_bf16 v[204:207], a[132:135], a[44:47], v[204:207]
v_mfma_f32_16x16x32_bf16 v[212:215], a[128:131], a[48:51], 0
v_mfma_f32_16x16x32_bf16 v[212:215], a[132:135], a[52:55], v[212:215]
buffer_store_dwordx4 v[120:123], v1, s[4:7], s31 offen sc1
v_mfma_f32_16x16x32_bf16 v[220:223], a[128:131], a[56:59], 0
s_add_u32 s31, s31, s34
v_mfma_f32_16x16x32_bf16 v[220:223], a[132:135], a[60:63], v[220:223]
s_waitcnt vmcnt(28) lgkmcnt(0)
s_barrier
v_mfma_f32_16x16x32_bf16 v[224:227], a[136:139], a[0:3], 0
s_add_u32 m0, s29, 131072
ds_read_b64_tr_b16 a[128:129], v22 offset:0
v_mfma_f32_16x16x32_bf16 v[224:227], a[140:143], a[4:7], v[224:227]
buffer_load_dwordx4 v16, s[12:15], s26 offen offset:0 lds
v_mfma_f32_16x16x32_bf16 v[228:231], a[136:139], a[8:11], 0
ds_read_b64_tr_b16 a[130:131], v22 offset:2048
v_mfma_f32_16x16x32_bf16 v[228:231], a[140:143], a[12:15], v[228:231]
v_mfma_f32_16x16x32_bf16 v[232:235], a[136:139], a[16:19], 0
ds_read_b64_tr_b16 a[132:133], v22 offset:16384
v_mfma_f32_16x16x32_bf16 v[232:235], a[140:143], a[20:23], v[232:235]
buffer_load_dwordx4 v17, s[12:15], s26 offen offset:1024 lds
v_mfma_f32_16x16x32_bf16 v[236:239], a[136:139], a[24:27], 0
ds_read_b64_tr_b16 a[134:135], v22 offset:18432
v_add_u32 v22, 32768, v22
v_mfma_f32_16x16x32_bf16 v[236:239], a[140:143], a[28:31], v[236:239]
v_mfma_f32_16x16x32_bf16 v[240:243], a[136:139], a[32:35], 0
v_mfma_f32_16x16x32_bf16 v[240:243], a[140:143], a[36:39], v[240:243]
buffer_load_dwordx4 v18, s[12:15], s26 offen offset:2048 lds
v_mfma_f32_16x16x32_bf16 v[244:247], a[136:139], a[40:43], 0
v_mfma_f32_16x16x32_bf16 v[244:247], a[140:143], a[44:47], v[244:247]
v_mfma_f32_16x16x32_bf16 v[248:251], a[136:139], a[48:51], 0
v_mfma_f32_16x16x32_bf16 v[248:251], a[140:143], a[52:55], v[248:251]
buffer_load_dwordx4 v19, s[12:15], s26 offen offset:3072 lds
v_mfma_f32_16x16x32_bf16 v[252:255], a[136:139], a[56:59], 0
s_add_u32 s26, s26, 524288
v_mfma_f32_16x16x32_bf16 v[252:255], a[140:143], a[60:63], v[252:255]
s_waitcnt lgkmcnt(0)
v_mfma_f32_16x16x32_bf16 v[36:39], a[128:131], a[64:67], v[36:39]
s_add_u32 m0, s29, 147456
ds_read_b64_tr_b16 a[136:137], v23 offset:0
v_mfma_f32_16x16x32_bf16 v[36:39], a[132:135], a[68:71], v[36:39]
buffer_load_dwordx4 v16, s[12:15], s27 offen offset:0 lds
v_mfma_f32_16x16x32_bf16 v[44:47], a[128:131], a[72:75], v[44:47]
ds_read_b64_tr_b16 a[138:139], v23 offset:2048
v_mfma_f32_16x16x32_bf16 v[44:47], a[132:135], a[76:79], v[44:47]
ds_read_b128 a[0:3], v2 offset:32768
ds_read_b128 a[4:7], v3 offset:32768
v_mfma_f32_16x16x32_bf16 v[52:55], a[128:131], a[80:83], v[52:55]
ds_read_b64_tr_b16 a[140:141], v23 offset:16384
v_mfma_f32_16x16x32_bf16 v[52:55], a[132:135], a[84:87], v[52:55]
buffer_load_dwordx4 v17, s[12:15], s27 offen offset:1024 lds
v_mfma_f32_16x16x32_bf16 v[60:63], a[128:131], a[88:91], v[60:63]
ds_read_b64_tr_b16 a[142:143], v23 offset:18432
v_add_u32 v23, 32768, v23
v_mfma_f32_16x16x32_bf16 v[60:63], a[132:135], a[92:95], v[60:63]
buffer_store_dwordx4 v[128:131], v1, s[4:7], s31 offen sc1
v_mfma_f32_16x16x32_bf16 v[68:71], a[128:131], a[96:99], v[68:71]
s_add_u32 s31, s31, s32
ds_read_b128 a[8:11], v2 offset:34816
v_accvgpr_read_b32 v32, a192
v_mfma_f32_16x16x32_bf16 v[68:71], a[132:135], a[100:103], v[68:71]
buffer_load_dwordx4 v18, s[12:15], s27 offen offset:2048 lds
v_mfma_f32_16x16x32_bf16 v[76:79], a[128:131], a[104:107], v[76:79]
ds_read_b128 a[12:15], v3 offset:34816
v_accvgpr_read_b32 v33, a193
v_mfma_f32_16x16x32_bf16 v[76:79], a[132:135], a[108:111], v[76:79]
ds_read_b128 a[16:19], v2 offset:36864
v_accvgpr_read_b32 v34, a194
v_mfma_f32_16x16x32_bf16 v[84:87], a[128:131], a[112:115], v[84:87]
ds_read_b128 a[20:23], v3 offset:36864
v_accvgpr_read_b32 v35, a195
v_mfma_f32_16x16x32_bf16 v[84:87], a[132:135], a[116:119], v[84:87]
buffer_load_dwordx4 v19, s[12:15], s27 offen offset:3072 lds
v_mfma_f32_16x16x32_bf16 v[92:95], a[128:131], a[120:123], v[92:95]
s_add_u32 s27, s27, 524288
ds_read_b128 a[24:27], v2 offset:38912
v_accvgpr_read_b32 v96, a196
v_mfma_f32_16x16x32_bf16 v[92:95], a[132:135], a[124:127], v[92:95]
s_waitcnt lgkmcnt(5)
buffer_store_dwordx4 v[136:139], v1, s[4:7], s31 offen sc1
v_mfma_f32_16x16x32_bf16 v[100:103], a[136:139], a[64:67], v[100:103]
s_add_u32 m0, s28, 16384
ds_read_b64_tr_b16 a[128:129], v24 offset:0
v_accvgpr_read_b32 v97, a197
v_mfma_f32_16x16x32_bf16 v[100:103], a[140:143], a[68:71], v[100:103]
s_add_u32 s31, s31, s33
buffer_load_dwordx4 v12, s[8:11], s24 offen offset:0 lds
v_mfma_f32_16x16x32_bf16 v[108:111], a[136:139], a[72:75], v[108:111]
ds_read_b64_tr_b16 a[130:131], v24 offset:2048
v_accvgpr_read_b32 v98, a198
v_mfma_f32_16x16x32_bf16 v[108:111], a[140:143], a[76:79], v[108:111]
ds_read_b128 a[28:31], v3 offset:38912
v_accvgpr_read_b32 v99, a199
v_mfma_f32_16x16x32_bf16 v[116:119], a[136:139], a[80:83], v[116:119]
ds_read_b64_tr_b16 a[132:133], v24 offset:16384
v_cvt_pk_bf16_f32 v32, v32, v33
v_mfma_f32_16x16x32_bf16 v[116:119], a[140:143], a[84:87], v[116:119]
buffer_load_dwordx4 v13, s[8:11], s24 offen offset:1024 lds
v_mfma_f32_16x16x32_bf16 v[124:127], a[136:139], a[88:91], v[124:127]
ds_read_b64_tr_b16 a[134:135], v24 offset:18432
v_add_u32 v24, 32768, v24
v_mfma_f32_16x16x32_bf16 v[124:127], a[140:143], a[92:95], v[124:127]
v_cvt_pk_bf16_f32 v33, v34, v35
v_cvt_pk_bf16_f32 v34, v96, v97
v_mfma_f32_16x16x32_bf16 v[132:135], a[136:139], a[96:99], v[132:135]
ds_read_b128 a[32:35], v2 offset:40960
v_cvt_pk_bf16_f32 v35, v98, v99
v_mfma_f32_16x16x32_bf16 v[132:135], a[140:143], a[100:103], v[132:135]
buffer_load_dwordx4 v14, s[8:11], s24 offen offset:2048 lds
v_mfma_f32_16x16x32_bf16 v[140:143], a[136:139], a[104:107], v[140:143]
ds_read_b128 a[36:39], v3 offset:40960
v_accvgpr_read_b32 v40, a200
v_mfma_f32_16x16x32_bf16 v[140:143], a[140:143], a[108:111], v[140:143]
ds_read_b128 a[40:43], v2 offset:43008
v_accvgpr_read_b32 v41, a201
v_mfma_f32_16x16x32_bf16 v[148:151], a[136:139], a[112:115], v[148:151]
ds_read_b128 a[44:47], v3 offset:43008
v_accvgpr_read_b32 v42, a202
v_mfma_f32_16x16x32_bf16 v[148:151], a[140:143], a[116:119], v[148:151]
buffer_load_dwordx4 v15, s[8:11], s24 offen offset:3072 lds
v_mfma_f32_16x16x32_bf16 v[156:159], a[136:139], a[120:123], v[156:159]
s_add_u32 s24, s24, 128
ds_read_b128 a[48:51], v2 offset:45056
v_accvgpr_read_b32 v43, a203
v_mfma_f32_16x16x32_bf16 v[156:159], a[140:143], a[124:127], v[156:159]
s_waitcnt lgkmcnt(5)
buffer_store_dwordx4 v[144:147], v1, s[4:7], s31 offen sc1
v_mfma_f32_16x16x32_bf16 v[164:167], a[128:131], a[64:67], v[164:167]
s_add_u32 s31, s31, s32
ds_read_b64_tr_b16 a[136:137], v25 offset:0
v_accvgpr_read_b32 v96, a204
v_mfma_f32_16x16x32_bf16 v[164:167], a[132:135], a[68:71], v[164:167]
v_accvgpr_read_b32 v97, a205
v_accvgpr_read_b32 v98, a206
v_mfma_f32_16x16x32_bf16 v[172:175], a[128:131], a[72:75], v[172:175]
ds_read_b64_tr_b16 a[138:139], v25 offset:2048
v_accvgpr_read_b32 v99, a207
v_mfma_f32_16x16x32_bf16 v[172:175], a[132:135], a[76:79], v[172:175]
ds_read_b128 a[52:55], v3 offset:45056
v_cvt_pk_bf16_f32 v40, v40, v41
v_mfma_f32_16x16x32_bf16 v[180:183], a[128:131], a[80:83], v[180:183]
ds_read_b64_tr_b16 a[140:141], v25 offset:16384
v_cvt_pk_bf16_f32 v41, v42, v43
v_mfma_f32_16x16x32_bf16 v[180:183], a[132:135], a[84:87], v[180:183]
v_cvt_pk_bf16_f32 v42, v96, v97
v_cvt_pk_bf16_f32 v43, v98, v99
v_mfma_f32_16x16x32_bf16 v[188:191], a[128:131], a[88:91], v[188:191]
ds_read_b64_tr_b16 a[142:143], v25 offset:18432
v_add_u32 v25, 32768, v25
v_mfma_f32_16x16x32_bf16 v[188:191], a[132:135], a[92:95], v[188:191]
v_accvgpr_read_b32 v48, a208
v_accvgpr_read_b32 v49, a209
v_mfma_f32_16x16x32_bf16 v[196:199], a[128:131], a[96:99], v[196:199]
ds_read_b128 a[56:59], v2 offset:47104
v_accvgpr_read_b32 v50, a210
v_mfma_f32_16x16x32_bf16 v[196:199], a[132:135], a[100:103], v[196:199]
v_accvgpr_read_b32 v51, a211
v_accvgpr_read_b32 v96, a212
v_mfma_f32_16x16x32_bf16 v[204:207], a[128:131], a[104:107], v[204:207]
ds_read_b128 a[60:63], v3 offset:47104
v_accvgpr_read_b32 v97, a213
v_mfma_f32_16x16x32_bf16 v[204:207], a[132:135], a[108:111], v[204:207]
v_accvgpr_read_b32 v98, a214
v_accvgpr_read_b32 v99, a215
v_mfma_f32_16x16x32_bf16 v[212:215], a[128:131], a[112:115], v[212:215]
v_cvt_pk_bf16_f32 v48, v48, v49
v_cvt_pk_bf16_f32 v49, v50, v51
v_mfma_f32_16x16x32_bf16 v[212:215], a[132:135], a[116:119], v[212:215]
buffer_store_dwordx4 v[152:155], v1, s[4:7], s31 offen sc1
v_mfma_f32_16x16x32_bf16 v[220:223], a[128:131], a[120:123], v[220:223]
s_add_u32 s31, s31, s36
v_cvt_pk_bf16_f32 v50, v96, v97
v_cvt_pk_bf16_f32 v51, v98, v99
v_mfma_f32_16x16x32_bf16 v[220:223], a[132:135], a[124:127], v[220:223]
s_waitcnt vmcnt(23) lgkmcnt(0)
s_barrier
v_accvgpr_read_b32 v56, a216
v_mfma_f32_16x16x32_bf16 v[224:227], a[136:139], a[64:67], v[224:227]
s_add_u32 m0, s29, 65536
ds_read_b64_tr_b16 a[128:129], v22 offset:0
v_accvgpr_read_b32 v57, a217
v_mfma_f32_16x16x32_bf16 v[224:227], a[140:143], a[68:71], v[224:227]
buffer_load_dwordx4 v16, s[12:15], s26 offen offset:0 lds
v_mfma_f32_16x16x32_bf16 v[228:231], a[136:139], a[72:75], v[228:231]
ds_read_b64_tr_b16 a[130:131], v22 offset:2048
v_accvgpr_read_b32 v58, a218
v_mfma_f32_16x16x32_bf16 v[228:231], a[140:143], a[76:79], v[228:231]
v_accvgpr_read_b32 v59, a219
v_accvgpr_read_b32 v96, a220
v_mfma_f32_16x16x32_bf16 v[232:235], a[136:139], a[80:83], v[232:235]
ds_read_b64_tr_b16 a[132:133], v22 offset:16384
v_accvgpr_read_b32 v97, a221
v_mfma_f32_16x16x32_bf16 v[232:235], a[140:143], a[84:87], v[232:235]
buffer_load_dwordx4 v17, s[12:15], s26 offen offset:1024 lds
v_mfma_f32_16x16x32_bf16 v[236:239], a[136:139], a[88:91], v[236:239]
ds_read_b64_tr_b16 a[134:135], v22 offset:18432
v_add_u32 v22, 32768, v22
v_mfma_f32_16x16x32_bf16 v[236:239], a[140:143], a[92:95], v[236:239]
PAD_28:
s_cbranch_execz M_tret
v_accvgpr_read_b32 v98, a222
v_accvgpr_read_b32 v99, a223
v_mfma_f32_16x16x32_bf16 v[240:243], a[136:139], a[96:99], v[240:243]
v_cvt_pk_bf16_f32 v56, v56, v57
v_cvt_pk_bf16_f32 v57, v58, v59
v_mfma_f32_16x16x32_bf16 v[240:243], a[140:143], a[100:103], v[240:243]
buffer_load_dwordx4 v18, s[12:15], s26 offen offset:2048 lds
v_mfma_f32_16x16x32_bf16 v[244:247], a[136:139], a[104:107], v[244:247]
v_cvt_pk_bf16_f32 v58, v96, v97
v_cvt_pk_bf16_f32 v59, v98, v99
v_mfma_f32_16x16x32_bf16 v[244:247], a[140:143], a[108:111], v[244:247]
v_accvgpr_read_b32 v64, a224
v_accvgpr_read_b32 v65, a225
v_mfma_f32_16x16x32_bf16 v[248:251], a[136:139], a[112:115], v[248:251]
v_accvgpr_read_b32 v66, a226
v_accvgpr_read_b32 v67, a227
v_mfma_f32_16x16x32_bf16 v[248:251], a[140:143], a[116:119], v[248:251]
buffer_load_dwordx4 v19, s[12:15], s26 offen offset:3072 lds
v_mfma_f32_16x16x32_bf16 v[252:255], a[136:139], a[120:123], v[252:255]
s_add_u32 s26, s26, 524288
v_accvgpr_read_b32 v96, a228
v_accvgpr_read_b32 v97, a229
v_mfma_f32_16x16x32_bf16 v[252:255], a[140:143], a[124:127], v[252:255]
s_waitcnt lgkmcnt(0)
v_accvgpr_read_b32 v98, a230
v_accvgpr_read_b32 v99, a231
v_mfma_f32_16x16x32_bf16 v[36:39], a[128:131], a[0:3], v[36:39]
s_add_u32 m0, s29, 81920
ds_read_b64_tr_b16 a[136:137], v23 offset:0
v_cvt_pk_bf16_f32 v64, v64, v65
v_mfma_f32_16x16x32_bf16 v[36:39], a[132:135], a[4:7], v[36:39]
buffer_load_dwordx4 v16, s[12:15], s27 offen offset:0 lds
v_mfma_f32_16x16x32_bf16 v[44:47], a[128:131], a[8:11], v[44:47]
ds_read_b64_tr_b16 a[138:139], v23 offset:2048
v_cvt_pk_bf16_f32 v65, v66, v67
v_mfma_f32_16x16x32_bf16 v[44:47], a[132:135], a[12:15], v[44:47]
ds_read_b128 a[64:67], v2 offset:49152
ds_read_b128 a[68:71], v3 offset:49152
v_mfma_f32_16x16x32_bf16 v[52:55], a[128:131], a[16:19], v[52:55]
ds_read_b64_tr_b16 a[140:141], v23 offset:16384
v_cvt_pk_bf16_f32 v66, v96, v97
v_mfma_f32_16x16x32_bf16 v[52:55], a[132:135], a[20:23], v[52:55]
buffer_load_dwordx4 v17, s[12:15], s27 offen offset:1024 lds
v_mfma_f32_16x16x32_bf16 v[60:63], a[128:131], a[24:27], v[60:63]
ds_read_b64_tr_b16 a[142:143], v23 offset:18432
v_add_u32 v23, 32768, v23
v_mfma_f32_16x16x32_bf16 v[60:63], a[132:135], a[28:31], v[60:63]
buffer_store_dwordx4 v[160:163], v1, s[4:7], s31 offen sc1
v_mfma_f32_16x16x32_bf16 v[68:71], a[128:131], a[32:35], v[68:71]
s_add_u32 s31, s31, s32
ds_read_b128 a[72:75], v2 offset:51200
v_cvt_pk_bf16_f32 v67, v98, v99
v_mfma_f32_16x16x32_bf16 v[68:71], a[132:135], a[36:39], v[68:71]
buffer_load_dwordx4 v18, s[12:15], s27 offen offset:2048 lds
v_mfma_f32_16x16x32_bf16 v[76:79], a[128:131], a[40:43], v[76:79]
ds_read_b128 a[76:79], v3 offset:51200
v_accvgpr_read_b32 v72, a232
v_mfma_f32_16x16x32_bf16 v[76:79], a[132:135], a[44:47], v[76:79]
ds_read_b128 a[80:83], v2 offset:53248
v_accvgpr_read_b32 v73, a233
v_mfma_f32_16x16x32_bf16 v[84:87], a[128:131], a[48:51], v[84:87]
ds_read_b128 a[84:87], v3 offset:53248
v_accvgpr_read_b32 v74, a234
v_mfma_f32_16x16x32_bf16 v[84:87], a[132:135], a[52:55], v[84:87]
buffer_load_dwordx4 v19, s[12:15], s27 offen offset:3072 lds
v_mfma_f32_16x16x32_bf16 v[92:95], a[128:131], a[56:59], v[92:95]
s_add_u32 s27, s27, 524288
ds_read_b128 a[88:91], v2 offset:55296
v_accvgpr_read_b32 v75, a235
v_mfma_f32_16x16x32_bf16 v[92:95], a[132:135], a[60:63], v[92:95]
s_waitcnt lgkmcnt(5)
buffer_store_dwordx4 v[168:171], v1, s[4:7], s31 offen sc1
v_mfma_f32_16x16x32_bf16 v[100:103], a[136:139], a[0:3], v[100:103]
s_add_u32 m0, s28, 32768
ds_read_b64_tr_b16 a[128:129], v24 offset:0
v_accvgpr_read_b32 v96, a236
v_mfma_f32_16x16x32_bf16 v[100:103], a[140:143], a[4:7], v[100:103]
s_add_u32 s31, s31, s33
buffer_load_dwordx4 v12, s[8:11], s24 offen offset:0 lds
v_mfma_f32_16x16x32_bf16 v[108:111], a[136:139], a[8:11], v[108:111]
ds_read_b64_tr_b16 a[130:131], v24 offset:2048
v_accvgpr_read_b32 v97, a237
v_mfma_f32_16x16x32_bf16 v[108:111], a[140:143], a[12:15], v[108:111]
ds_read_b128 a[92:95], v3 offset:55296
v_accvgpr_read_b32 v98, a238
v_mfma_f32_16x16x32_bf16 v[116:119], a[136:139], a[16:19], v[116:119]
ds_read_b64_tr_b16 a[132:133], v24 offset:16384
v_accvgpr_read_b32 v99, a239
v_mfma_f32_16x16x32_bf16 v[116:119], a[140:143], a[20:23], v[116:119]
buffer_load_dwordx4 v13, s[8:11], s24 offen offset:1024 lds
v_mfma_f32_16x16x32_bf16 v[124:127], a[136:139], a[24:27], v[124:127]
ds_read_b64_tr_b16 a[134:135], v24 offset:18432
v_add_u32 v24, 32768, v24
v_mfma_f32_16x16x32_bf16 v[124:127], a[140:143], a[28:31], v[124:127]
v_cvt_pk_bf16_f32 v72, v72, v73
v_cvt_pk_bf16_f32 v73, v74, v75
v_mfma_f32_16x16x32_bf16 v[132:135], a[136:139], a[32:35], v[132:135]
ds_read_b128 a[96:99], v2 offset:57344
v_cvt_pk_bf16_f32 v74, v96, v97
v_mfma_f32_16x16x32_bf16 v[132:135], a[140:143], a[36:39], v[132:135]
buffer_load_dwordx4 v14, s[8:11], s24 offen offset:2048 lds
v_mfma_f32_16x16x32_bf16 v[140:143], a[136:139], a[40:43], v[140:143]
ds_read_b128 a[100:103], v3 offset:57344
v_cvt_pk_bf16_f32 v75, v98, v99
v_mfma_f32_16x16x32_bf16 v[140:143], a[140:143], a[44:47], v[140:143]
ds_read_b128 a[104:107], v2 offset:59392
v_accvgpr_read_b32 v80, a240
v_mfma_f32_16x16x32_bf16 v[148:151], a[136:139], a[48:51], v[148:151]
ds_read_b128 a[108:111], v3 offset:59392
v_accvgpr_read_b32 v81, a241
v_mfma_f32_16x16x32_bf16 v[148:151], a[140:143], a[52:55], v[148:151]
buffer_load_dwordx4 v15, s[8:11], s24 offen offset:3072 lds
v_mfma_f32_16x16x32_bf16 v[156:159], a[136:139], a[56:59], v[156:159]
s_add_u32 s24, s24, 128
ds_read_b128 a[112:115], v2 offset:61440
v_accvgpr_read_b32 v82, a242
v_mfma_f32_16x16x32_bf16 v[156:159], a[140:143], a[60:63], v[156:159]
s_waitcnt lgkmcnt(5)
buffer_store_dwordx4 v[176:179], v1, s[4:7], s31 offen sc1
v_mfma_f32_16x16x32_bf16 v[164:167], a[128:131], a[0:3], v[164:167]
s_add_u32 s31, s31, s32
ds_read_b64_tr_b16 a[136:137], v25 offset:0
v_accvgpr_read_b32 v83, a243
v_mfma_f32_16x16x32_bf16 v[164:167], a[132:135], a[4:7], v[164:167]
v_accvgpr_read_b32 v96, a244
v_accvgpr_read_b32 v97, a245
v_mfma_f32_16x16x32_bf16 v[172:175], a[128:131], a[8:11], v[172:175]
ds_read_b64_tr_b16 a[138:139], v25 offset:2048
v_accvgpr_read_b32 v98, a246
v_mfma_f32_16x16x32_bf16 v[172:175], a[132:135], a[12:15], v[172:175]
ds_read_b128 a[116:119], v3 offset:61440
v_accvgpr_read_b32 v99, a247
v_mfma_f32_16x16x32_bf16 v[180:183], a[128:131], a[16:19], v[180:183]
ds_read_b64_tr_b16 a[140:141], v25 offset:16384
v_cvt_pk_bf16_f32 v80, v80, v81
v_mfma_f32_16x16x32_bf16 v[180:183], a[132:135], a[20:23], v[180:183]
buffer_store_dwordx4 v[184:187], v1, s[4:7], s31 offen sc1
v_mfma_f32_16x16x32_bf16 v[188:191], a[128:131], a[24:27], v[188:191]
s_add_u32 s31, s31, s34
ds_read_b64_tr_b16 a[142:143], v25 offset:18432
v_add_u32 v25, 32768, v25
v_mfma_f32_16x16x32_bf16 v[188:191], a[132:135], a[28:31], v[188:191]
v_cvt_pk_bf16_f32 v81, v82, v83
v_cvt_pk_bf16_f32 v82, v96, v97
v_mfma_f32_16x16x32_bf16 v[196:199], a[128:131], a[32:35], v[196:199]
ds_read_b128 a[120:123], v2 offset:63488
v_cvt_pk_bf16_f32 v83, v98, v99
v_mfma_f32_16x16x32_bf16 v[196:199], a[132:135], a[36:39], v[196:199]
v_accvgpr_read_b32 v88, a248
v_accvgpr_read_b32 v89, a249
v_mfma_f32_16x16x32_bf16 v[204:207], a[128:131], a[40:43], v[204:207]
ds_read_b128 a[124:127], v3 offset:63488
v_accvgpr_read_b32 v90, a250
v_mfma_f32_16x16x32_bf16 v[204:207], a[132:135], a[44:47], v[204:207]
v_accvgpr_read_b32 v91, a251
v_accvgpr_read_b32 v96, a252
v_mfma_f32_16x16x32_bf16 v[212:215], a[128:131], a[48:51], v[212:215]
v_accvgpr_read_b32 v97, a253
v_accvgpr_read_b32 v98, a254
v_mfma_f32_16x16x32_bf16 v[212:215], a[132:135], a[52:55], v[212:215]
v_accvgpr_read_b32 v99, a255
v_cvt_pk_bf16_f32 v88, v88, v89
v_mfma_f32_16x16x32_bf16 v[220:223], a[128:131], a[56:59], v[220:223]
v_cvt_pk_bf16_f32 v89, v90, v91
v_cvt_pk_bf16_f32 v90, v96, v97
v_mfma_f32_16x16x32_bf16 v[220:223], a[132:135], a[60:63], v[220:223]
s_waitcnt vmcnt(23) lgkmcnt(0)
s_barrier
v_cvt_pk_bf16_f32 v91, v98, v99
v_mfma_f32_16x16x32_bf16 v[224:227], a[136:139], a[0:3], v[224:227]
s_add_u32 m0, s29, 98304
ds_read_b64_tr_b16 a[128:129], v22 offset:0
v_mfma_f32_16x16x32_bf16 v[224:227], a[140:143], a[4:7], v[224:227]
buffer_load_dwordx4 v16, s[12:15], s26 offen offset:0 lds
v_mfma_f32_16x16x32_bf16 v[228:231], a[136:139], a[8:11], v[228:231]
ds_read_b64_tr_b16 a[130:131], v22 offset:2048
v_mfma_f32_16x16x32_bf16 v[228:231], a[140:143], a[12:15], v[228:231]
buffer_store_dwordx4 v[192:195], v1, s[4:7], s31 offen sc1
v_mfma_f32_16x16x32_bf16 v[232:235], a[136:139], a[16:19], v[232:235]
s_add_u32 s31, s31, s32
ds_read_b64_tr_b16 a[132:133], v22 offset:16384
v_mfma_f32_16x16x32_bf16 v[232:235], a[140:143], a[20:23], v[232:235]
buffer_load_dwordx4 v17, s[12:15], s26 offen offset:1024 lds
v_mfma_f32_16x16x32_bf16 v[236:239], a[136:139], a[24:27], v[236:239]
ds_read_b64_tr_b16 a[134:135], v22 offset:18432
v_add_u32 v22, 4294901760, v22
v_mfma_f32_16x16x32_bf16 v[236:239], a[140:143], a[28:31], v[236:239]
v_mfma_f32_16x16x32_bf16 v[240:243], a[136:139], a[32:35], v[240:243]
v_mfma_f32_16x16x32_bf16 v[240:243], a[140:143], a[36:39], v[240:243]
buffer_load_dwordx4 v18, s[12:15], s26 offen offset:2048 lds
v_mfma_f32_16x16x32_bf16 v[244:247], a[136:139], a[40:43], v[244:247]
v_mfma_f32_16x16x32_bf16 v[244:247], a[140:143], a[44:47], v[244:247]
v_mfma_f32_16x16x32_bf16 v[248:251], a[136:139], a[48:51], v[248:251]
v_mfma_f32_16x16x32_bf16 v[248:251], a[140:143], a[52:55], v[248:251]
buffer_load_dwordx4 v19, s[12:15], s26 offen offset:3072 lds
v_mfma_f32_16x16x32_bf16 v[252:255], a[136:139], a[56:59], v[252:255]
s_add_u32 s26, s26, 524288
v_mfma_f32_16x16x32_bf16 v[252:255], a[140:143], a[60:63], v[252:255]
s_waitcnt lgkmcnt(0)
v_mfma_f32_16x16x32_bf16 v[36:39], a[128:131], a[64:67], v[36:39]
s_add_u32 m0, s29, 114688
ds_read_b64_tr_b16 a[136:137], v23 offset:0
v_mfma_f32_16x16x32_bf16 v[36:39], a[132:135], a[68:71], v[36:39]
buffer_load_dwordx4 v16, s[12:15], s27 offen offset:0 lds
v_mfma_f32_16x16x32_bf16 v[44:47], a[128:131], a[72:75], v[44:47]
ds_read_b64_tr_b16 a[138:139], v23 offset:2048
v_mfma_f32_16x16x32_bf16 v[44:47], a[132:135], a[76:79], v[44:47]
ds_read_b128 a[0:3], v2 offset:0
ds_read_b128 a[4:7], v3 offset:0
v_mfma_f32_16x16x32_bf16 v[52:55], a[128:131], a[80:83], v[52:55]
ds_read_b64_tr_b16 a[140:141], v23 offset:16384
v_mfma_f32_16x16x32_bf16 v[52:55], a[132:135], a[84:87], v[52:55]
buffer_load_dwordx4 v17, s[12:15], s27 offen offset:1024 lds
v_mfma_f32_16x16x32_bf16 v[60:63], a[128:131], a[88:91], v[60:63]
ds_read_b64_tr_b16 a[142:143], v23 offset:18432
v_add_u32 v23, 4294901760, v23
v_mfma_f32_16x16x32_bf16 v[60:63], a[132:135], a[92:95], v[60:63]
buffer_store_dwordx4 v[200:203], v1, s[4:7], s31 offen sc1
v_mfma_f32_16x16x32_bf16 v[68:71], a[128:131], a[96:99], v[68:71]
s_add_u32 s31, s31, s33
ds_read_b128 a[8:11], v2 offset:2048
v_mfma_f32_16x16x32_bf16 v[68:71], a[132:135], a[100:103], v[68:71]
buffer_load_dwordx4 v18, s[12:15], s27 offen offset:2048 lds
v_mfma_f32_16x16x32_bf16 v[76:79], a[128:131], a[104:107], v[76:79]
ds_read_b128 a[12:15], v3 offset:2048
v_mfma_f32_16x16x32_bf16 v[76:79], a[132:135], a[108:111], v[76:79]
ds_read_b128 a[16:19], v2 offset:4096
v_mfma_f32_16x16x32_bf16 v[84:87], a[128:131], a[112:115], v[84:87]
ds_read_b128 a[20:23], v3 offset:4096
v_mfma_f32_16x16x32_bf16 v[84:87], a[132:135], a[116:119], v[84:87]
buffer_load_dwordx4 v19, s[12:15], s27 offen offset:3072 lds
v_mfma_f32_16x16x32_bf16 v[92:95], a[128:131], a[120:123], v[92:95]
s_add_u32 s27, s27, 524288
ds_read_b128 a[24:27], v2 offset:6144
v_mfma_f32_16x16x32_bf16 v[92:95], a[132:135], a[124:127], v[92:95]
s_waitcnt lgkmcnt(5)
buffer_store_dwordx4 v[208:211], v1, s[4:7], s31 offen sc1
v_mfma_f32_16x16x32_bf16 v[100:103], a[136:139], a[64:67], v[100:103]
s_add_u32 s31, s31, s32
ds_read_b64_tr_b16 a[128:129], v24 offset:0
v_mfma_f32_16x16x32_bf16 v[100:103], a[140:143], a[68:71], v[100:103]
v_mfma_f32_16x16x32_bf16 v[108:111], a[136:139], a[72:75], v[108:111]
ds_read_b64_tr_b16 a[130:131], v24 offset:2048
v_mfma_f32_16x16x32_bf16 v[108:111], a[140:143], a[76:79], v[108:111]
ds_read_b128 a[28:31], v3 offset:6144
v_mfma_f32_16x16x32_bf16 v[116:119], a[136:139], a[80:83], v[116:119]
ds_read_b64_tr_b16 a[132:133], v24 offset:16384
v_mfma_f32_16x16x32_bf16 v[116:119], a[140:143], a[84:87], v[116:119]
v_mfma_f32_16x16x32_bf16 v[124:127], a[136:139], a[88:91], v[124:127]
ds_read_b64_tr_b16 a[134:135], v24 offset:18432
v_add_u32 v24, 4294901760, v24
v_mfma_f32_16x16x32_bf16 v[124:127], a[140:143], a[92:95], v[124:127]
v_mfma_f32_16x16x32_bf16 v[132:135], a[136:139], a[96:99], v[132:135]
ds_read_b128 a[32:35], v2 offset:8192
v_mfma_f32_16x16x32_bf16 v[132:135], a[140:143], a[100:103], v[132:135]
buffer_store_dwordx4 v[216:219], v1, s[4:7], s31 offen sc1
v_mfma_f32_16x16x32_bf16 v[140:143], a[136:139], a[104:107], v[140:143]
s_add_u32 s31, s31, s35
ds_read_b128 a[36:39], v3 offset:8192
v_mfma_f32_16x16x32_bf16 v[140:143], a[140:143], a[108:111], v[140:143]
ds_read_b128 a[40:43], v2 offset:10240
v_mfma_f32_16x16x32_bf16 v[148:151], a[136:139], a[112:115], v[148:151]
ds_read_b128 a[44:47], v3 offset:10240
v_mfma_f32_16x16x32_bf16 v[148:151], a[140:143], a[116:119], v[148:151]
v_mfma_f32_16x16x32_bf16 v[156:159], a[136:139], a[120:123], v[156:159]
ds_read_b128 a[48:51], v2 offset:12288
v_mfma_f32_16x16x32_bf16 v[156:159], a[140:143], a[124:127], v[156:159]
s_waitcnt lgkmcnt(5)
v_mfma_f32_16x16x32_bf16 v[164:167], a[128:131], a[64:67], v[164:167]
ds_read_b64_tr_b16 a[136:137], v25 offset:0
v_mfma_f32_16x16x32_bf16 v[164:167], a[132:135], a[68:71], v[164:167]
v_mfma_f32_16x16x32_bf16 v[172:175], a[128:131], a[72:75], v[172:175]
ds_read_b64_tr_b16 a[138:139], v25 offset:2048
v_mfma_f32_16x16x32_bf16 v[172:175], a[132:135], a[76:79], v[172:175]
ds_read_b128 a[52:55], v3 offset:12288
v_mfma_f32_16x16x32_bf16 v[180:183], a[128:131], a[80:83], v[180:183]
ds_read_b64_tr_b16 a[140:141], v25 offset:16384
v_mfma_f32_16x16x32_bf16 v[180:183], a[132:135], a[84:87], v[180:183]
buffer_store_dwordx4 v[32:35], v1, s[4:7], s31 offen sc1
v_mfma_f32_16x16x32_bf16 v[188:191], a[128:131], a[88:91], v[188:191]
s_add_u32 s31, s31, s32
ds_read_b64_tr_b16 a[142:143], v25 offset:18432
v_add_u32 v25, 4294901760, v25
v_mfma_f32_16x16x32_bf16 v[188:191], a[132:135], a[92:95], v[188:191]
v_mfma_f32_16x16x32_bf16 v[196:199], a[128:131], a[96:99], v[196:199]
ds_read_b128 a[56:59], v2 offset:14336
v_mfma_f32_16x16x32_bf16 v[196:199], a[132:135], a[100:103], v[196:199]
v_mfma_f32_16x16x32_bf16 v[204:207], a[128:131], a[104:107], v[204:207]
ds_read_b128 a[60:63], v3 offset:14336
v_mfma_f32_16x16x32_bf16 v[204:207], a[132:135], a[108:111], v[204:207]
v_mfma_f32_16x16x32_bf16 v[212:215], a[128:131], a[112:115], v[212:215]
v_mfma_f32_16x16x32_bf16 v[212:215], a[132:135], a[116:119], v[212:215]
v_mfma_f32_16x16x32_bf16 v[220:223], a[128:131], a[120:123], v[220:223]
v_mfma_f32_16x16x32_bf16 v[220:223], a[132:135], a[124:127], v[220:223]
s_waitcnt vmcnt(20) lgkmcnt(0)
s_barrier
v_mfma_f32_16x16x32_bf16 v[224:227], a[136:139], a[64:67], v[224:227]
s_add_u32 m0, s29, 131072
ds_read_b64_tr_b16 a[128:129], v22 offset:0
v_mfma_f32_16x16x32_bf16 v[224:227], a[140:143], a[68:71], v[224:227]
buffer_load_dwordx4 v16, s[12:15], s26 offen offset:0 lds
v_mfma_f32_16x16x32_bf16 v[228:231], a[136:139], a[72:75], v[228:231]
ds_read_b64_tr_b16 a[130:131], v22 offset:2048
v_mfma_f32_16x16x32_bf16 v[228:231], a[140:143], a[76:79], v[228:231]
buffer_store_dwordx4 v[40:43], v1, s[4:7], s31 offen sc1
v_mfma_f32_16x16x32_bf16 v[232:235], a[136:139], a[80:83], v[232:235]
s_add_u32 s31, s31, s33
ds_read_b64_tr_b16 a[132:133], v22 offset:16384
v_mfma_f32_16x16x32_bf16 v[232:235], a[140:143], a[84:87], v[232:235]
buffer_load_dwordx4 v17, s[12:15], s26 offen offset:1024 lds
v_mfma_f32_16x16x32_bf16 v[236:239], a[136:139], a[88:91], v[236:239]
ds_read_b64_tr_b16 a[134:135], v22 offset:18432
v_add_u32 v22, 32768, v22
v_mfma_f32_16x16x32_bf16 v[236:239], a[140:143], a[92:95], v[236:239]
v_mfma_f32_16x16x32_bf16 v[240:243], a[136:139], a[96:99], v[240:243]
v_mfma_f32_16x16x32_bf16 v[240:243], a[140:143], a[100:103], v[240:243]
buffer_load_dwordx4 v18, s[12:15], s26 offen offset:2048 lds
v_mfma_f32_16x16x32_bf16 v[244:247], a[136:139], a[104:107], v[244:247]
v_mfma_f32_16x16x32_bf16 v[244:247], a[140:143], a[108:111], v[244:247]
v_mfma_f32_16x16x32_bf16 v[248:251], a[136:139], a[112:115], v[248:251]
v_mfma_f32_16x16x32_bf16 v[248:251], a[140:143], a[116:119], v[248:251]
buffer_load_dwordx4 v19, s[12:15], s26 offen offset:3072 lds
v_mfma_f32_16x16x32_bf16 v[252:255], a[136:139], a[120:123], v[252:255]
s_add_u32 s26, s26, 524288
v_mfma_f32_16x16x32_bf16 v[252:255], a[140:143], a[124:127], v[252:255]
s_waitcnt lgkmcnt(0)
v_mfma_f32_16x16x32_bf16 v[36:39], a[128:131], a[0:3], v[36:39]
s_add_u32 m0, s29, 147456
ds_read_b64_tr_b16 a[136:137], v23 offset:0
v_mfma_f32_16x16x32_bf16 v[36:39], a[132:135], a[4:7], v[36:39]
buffer_load_dwordx4 v16, s[12:15], s27 offen offset:0 lds
v_mfma_f32_16x16x32_bf16 v[44:47], a[128:131], a[8:11], v[44:47]
s_lshl_b32 s22, s20, 7
ds_read_b64_tr_b16 a[138:139], v23 offset:2048
v_bfe_u32 v20, v1, 4, 3
v_mfma_f32_16x16x32_bf16 v[44:47], a[132:135], a[12:15], v[44:47]
s_add_u32 s70, s22, 94371840
ds_read_b128 a[64:67], v2 offset:16384
ds_read_b128 a[68:71], v3 offset:16384
v_mfma_f32_16x16x32_bf16 v[52:55], a[128:131], a[16:19], v[52:55]
s_lshr_b32 s22, s2, 4
ds_read_b64_tr_b16 a[140:141], v23 offset:16384
v_lshlrev_b32 v20, 3, v20
v_mfma_f32_16x16x32_bf16 v[52:55], a[132:135], a[20:23], v[52:55]
s_lshl_b32 s22, s22, 2
buffer_load_dwordx4 v17, s[12:15], s27 offen offset:1024 lds
v_mfma_f32_16x16x32_bf16 v[60:63], a[128:131], a[24:27], v[60:63]
s_add_u32 s66, s70, s22
ds_read_b64_tr_b16 a[142:143], v23 offset:18432
v_add_u32 v23, 32768, v23
v_mfma_f32_16x16x32_bf16 v[60:63], a[132:135], a[28:31], v[60:63]
s_and_b32 s22, s2, 16
buffer_store_dwordx4 v[48:51], v1, s[4:7], s31 offen sc1
v_mfma_f32_16x16x32_bf16 v[68:71], a[128:131], a[32:35], v[68:71]
s_add_u32 s31, s31, s32
ds_read_b128 a[72:75], v2 offset:18432
v_add_u32 v15, 2052, v20
v_mfma_f32_16x16x32_bf16 v[68:71], a[132:135], a[36:39], v[68:71]
s_lshl_b32 s22, s22, 7
buffer_load_dwordx4 v18, s[12:15], s27 offen offset:2048 lds
v_mfma_f32_16x16x32_bf16 v[76:79], a[128:131], a[40:43], v[76:79]
s_add_u32 s66, s66, s22
ds_read_b128 a[76:79], v3 offset:18432
v_mfma_f32_16x16x32_bf16 v[76:79], a[132:135], a[44:47], v[76:79]
s_lshl_b32 s67, s20, 20
ds_read_b128 a[80:83], v2 offset:20480
v_mfma_f32_16x16x32_bf16 v[84:87], a[128:131], a[48:51], v[84:87]
s_lshl_b32 s22, s37, 16
ds_read_b128 a[84:87], v3 offset:20480
v_mfma_f32_16x16x32_bf16 v[84:87], a[132:135], a[52:55], v[84:87]
s_add_u32 s67, s67, s22
buffer_load_dwordx4 v19, s[12:15], s27 offen offset:3072 lds
v_mfma_f32_16x16x32_bf16 v[92:95], a[128:131], a[56:59], v[92:95]
s_waitcnt lgkmcnt(5)
s_add_u32 s27, s27, 524288
ds_read_b128 a[88:91], v2 offset:22528
v_mfma_f32_16x16x32_bf16 v[92:95], a[132:135], a[60:63], v[92:95]
s_lshl_b32 s22, s3, 11
buffer_store_dwordx4 v[56:59], v1, s[4:7], s31 offen sc1
v_mfma_f32_16x16x32_bf16 v[100:103], a[136:139], a[0:3], v[100:103]
s_waitcnt lgkmcnt(5)
s_add_u32 s31, s31, s34
ds_read_b64_tr_b16 a[128:129], v24 offset:0
v_mfma_f32_16x16x32_bf16 v[100:103], a[140:143], a[4:7], v[100:103]
s_add_u32 s67, s67, s22
v_mfma_f32_16x16x32_bf16 v[108:111], a[136:139], a[8:11], v[108:111]
s_add_u32 s67, s67, 33554432
ds_read_b64_tr_b16 a[130:131], v24 offset:2048
v_mfma_f32_16x16x32_bf16 v[108:111], a[140:143], a[12:15], v[108:111]
s_mov_b32 s68, 1035512379
ds_read_b128 a[92:95], v3 offset:22528
v_mfma_f32_16x16x32_bf16 v[116:119], a[136:139], a[16:19], v[116:119]
s_mov_b32 s69, 1035512379
ds_read_b64_tr_b16 a[132:133], v24 offset:16384
v_mfma_f32_16x16x32_bf16 v[116:119], a[140:143], a[20:23], v[116:119]
buffer_store_dwordx4 v[64:67], v1, s[4:7], s31 offen sc1
v_mfma_f32_16x16x32_bf16 v[124:127], a[136:139], a[24:27], v[124:127]
s_add_u32 s31, s31, s32
ds_read_b64_tr_b16 a[134:135], v24 offset:18432
v_add_u32 v24, 32768, v24
v_mfma_f32_16x16x32_bf16 v[124:127], a[140:143], a[28:31], v[124:127]
v_mfma_f32_16x16x32_bf16 v[132:135], a[136:139], a[32:35], v[132:135]
ds_read_b128 a[96:99], v2 offset:24576
v_mfma_f32_16x16x32_bf16 v[132:135], a[140:143], a[36:39], v[132:135]
v_mfma_f32_16x16x32_bf16 v[140:143], a[136:139], a[40:43], v[140:143]
ds_read_b128 a[100:103], v3 offset:24576
v_mfma_f32_16x16x32_bf16 v[140:143], a[140:143], a[44:47], v[140:143]
ds_read_b128 a[104:107], v2 offset:26624
v_mfma_f32_16x16x32_bf16 v[148:151], a[136:139], a[48:51], v[148:151]
ds_read_b128 a[108:111], v3 offset:26624
v_mfma_f32_16x16x32_bf16 v[148:151], a[140:143], a[52:55], v[148:151]
v_mfma_f32_16x16x32_bf16 v[156:159], a[136:139], a[56:59], v[156:159]
ds_read_b128 a[112:115], v2 offset:28672
v_mfma_f32_16x16x32_bf16 v[156:159], a[140:143], a[60:63], v[156:159]
s_waitcnt lgkmcnt(5)
buffer_store_dwordx4 v[72:75], v1, s[4:7], s31 offen sc1
v_mfma_f32_16x16x32_bf16 v[164:167], a[128:131], a[0:3], v[164:167]
s_add_u32 s31, s31, s33
ds_read_b64_tr_b16 a[136:137], v25 offset:0
v_mfma_f32_16x16x32_bf16 v[164:167], a[132:135], a[4:7], v[164:167]
v_mfma_f32_16x16x32_bf16 v[172:175], a[128:131], a[8:11], v[172:175]
ds_read_b64_tr_b16 a[138:139], v25 offset:2048
v_mfma_f32_16x16x32_bf16 v[172:175], a[132:135], a[12:15], v[172:175]
ds_read_b128 a[116:119], v3 offset:28672
v_mfma_f32_16x16x32_bf16 v[180:183], a[128:131], a[16:19], v[180:183]
ds_read_b64_tr_b16 a[140:141], v25 offset:16384
v_mfma_f32_16x16x32_bf16 v[180:183], a[132:135], a[20:23], v[180:183]
v_mfma_f32_16x16x32_bf16 v[188:191], a[128:131], a[24:27], v[188:191]
ds_read_b64_tr_b16 a[142:143], v25 offset:18432
v_add_u32 v25, 32768, v25
v_mfma_f32_16x16x32_bf16 v[188:191], a[132:135], a[28:31], v[188:191]
v_mfma_f32_16x16x32_bf16 v[196:199], a[128:131], a[32:35], v[196:199]
ds_read_b128 a[120:123], v2 offset:30720
v_mfma_f32_16x16x32_bf16 v[196:199], a[132:135], a[36:39], v[196:199]
buffer_store_dwordx4 v[80:83], v1, s[4:7], s31 offen sc1
v_mfma_f32_16x16x32_bf16 v[204:207], a[128:131], a[40:43], v[204:207]
s_add_u32 s31, s31, s32
ds_read_b128 a[124:127], v3 offset:30720
v_mfma_f32_16x16x32_bf16 v[204:207], a[132:135], a[44:47], v[204:207]
v_mfma_f32_16x16x32_bf16 v[212:215], a[128:131], a[48:51], v[212:215]
v_mfma_f32_16x16x32_bf16 v[212:215], a[132:135], a[52:55], v[212:215]
v_mfma_f32_16x16x32_bf16 v[220:223], a[128:131], a[56:59], v[220:223]
v_mfma_f32_16x16x32_bf16 v[220:223], a[132:135], a[60:63], v[220:223]
s_waitcnt vmcnt(17) lgkmcnt(0)
s_barrier
v_mfma_f32_16x16x32_bf16 v[224:227], a[136:139], a[0:3], v[224:227]
ds_read_b64_tr_b16 a[128:129], v22 offset:0
v_mfma_f32_16x16x32_bf16 v[224:227], a[140:143], a[4:7], v[224:227]
v_mfma_f32_16x16x32_bf16 v[228:231], a[136:139], a[8:11], v[228:231]
ds_read_b64_tr_b16 a[130:131], v22 offset:2048
v_mfma_f32_16x16x32_bf16 v[228:231], a[140:143], a[12:15], v[228:231]
buffer_store_dwordx4 v[88:91], v1, s[4:7], s31 offen sc1
v_mfma_f32_16x16x32_bf16 v[232:235], a[136:139], a[16:19], v[232:235]
ds_read_b64_tr_b16 a[132:133], v22 offset:16384
v_mfma_f32_16x16x32_bf16 v[232:235], a[140:143], a[20:23], v[232:235]
v_mfma_f32_16x16x32_bf16 v[236:239], a[136:139], a[24:27], v[236:239]
ds_read_b64_tr_b16 a[134:135], v22 offset:18432
v_add_u32 v22, 32768, v22
v_mfma_f32_16x16x32_bf16 v[236:239], a[140:143], a[28:31], v[236:239]
v_mfma_f32_16x16x32_bf16 v[240:243], a[136:139], a[32:35], v[240:243]
v_mfma_f32_16x16x32_bf16 v[240:243], a[140:143], a[36:39], v[240:243]
v_mfma_f32_16x16x32_bf16 v[244:247], a[136:139], a[40:43], v[244:247]
v_mfma_f32_16x16x32_bf16 v[244:247], a[140:143], a[44:47], v[244:247]
v_mfma_f32_16x16x32_bf16 v[248:251], a[136:139], a[48:51], v[248:251]
v_mfma_f32_16x16x32_bf16 v[248:251], a[140:143], a[52:55], v[248:251]
v_mfma_f32_16x16x32_bf16 v[252:255], a[136:139], a[56:59], v[252:255]
v_mfma_f32_16x16x32_bf16 v[252:255], a[140:143], a[60:63], v[252:255]
s_waitcnt lgkmcnt(0)
v_mfma_f32_16x16x32_bf16 v[36:39], a[128:131], a[64:67], v[36:39]
ds_read_b64_tr_b16 a[136:137], v23 offset:0
v_and_b32 v14, 128, v1
v_mfma_f32_16x16x32_bf16 v[36:39], a[132:135], a[68:71], v[36:39]
v_mul_u32_u24 v14, 2, v14
v_add_u32 v20, v14, v20
v_mfma_f32_16x16x32_bf16 v[44:47], a[128:131], a[72:75], v[44:47]
s_mul_i32 s85, s20, 7
ds_read_b64_tr_b16 a[138:139], v23 offset:2048
v_add_u32 v15, v14, v15
v_mfma_f32_16x16x32_bf16 v[44:47], a[132:135], a[76:79], v[44:47]
s_add_u32 s85, s85, s21
ds_read_b128 a[0:3], v2 offset:32768
ds_read_b128 a[4:7], v3 offset:32768
v_mfma_f32_16x16x32_bf16 v[52:55], a[128:131], a[80:83], v[52:55]
s_lshl_b32 s85, s85, 2
ds_read_b64_tr_b16 a[140:141], v23 offset:16384
v_mfma_f32_16x16x32_bf16 v[52:55], a[132:135], a[84:87], v[52:55]
s_add_u32 s85, s85, s3
v_mfma_f32_16x16x32_bf16 v[60:63], a[128:131], a[88:91], v[60:63]
s_mul_i32 s82, s85, 4224
ds_read_b64_tr_b16 a[142:143], v23 offset:18432
v_add_u32 v23, 32768, v23
v_mfma_f32_16x16x32_bf16 v[60:63], a[132:135], a[92:95], v[60:63]
s_add_u32 s82, s82, 83886208
v_mfma_f32_16x16x32_bf16 v[68:71], a[128:131], a[96:99], v[68:71]
s_lshl_b32 s83, s85, 12
ds_read_b128 a[8:11], v2 offset:34816
v_mfma_f32_16x16x32_bf16 v[68:71], a[132:135], a[100:103], v[68:71]
s_mul_i32 s84, s3, 21248
v_mfma_f32_16x16x32_bf16 v[76:79], a[128:131], a[104:107], v[76:79]
s_add_u32 s84, s84, 46080
ds_read_b128 a[12:15], v3 offset:34816
v_mfma_f32_16x16x32_bf16 v[76:79], a[132:135], a[108:111], v[76:79]
s_mov_b64 s[60:61], s[72:73]
ds_read_b128 a[16:19], v2 offset:36864
v_mfma_f32_16x16x32_bf16 v[84:87], a[128:131], a[112:115], v[84:87]
s_mov_b32 s62, 1835008
ds_read_b128 a[20:23], v3 offset:36864
v_mfma_f32_16x16x32_bf16 v[84:87], a[132:135], a[116:119], v[84:87]
v_mfma_f32_16x16x32_bf16 v[92:95], a[128:131], a[120:123], v[92:95]
ds_read_b128 a[24:27], v2 offset:38912
v_mfma_f32_16x16x32_bf16 v[92:95], a[132:135], a[124:127], v[92:95]
s_waitcnt lgkmcnt(5)
v_mfma_f32_16x16x32_bf16 v[100:103], a[136:139], a[64:67], v[100:103]
ds_read_b64_tr_b16 a[128:129], v24 offset:0
v_mfma_f32_16x16x32_bf16 v[100:103], a[140:143], a[68:71], v[100:103]
v_mfma_f32_16x16x32_bf16 v[108:111], a[136:139], a[72:75], v[108:111]
ds_read_b64_tr_b16 a[130:131], v24 offset:2048
v_mfma_f32_16x16x32_bf16 v[108:111], a[140:143], a[76:79], v[108:111]
ds_read_b128 a[28:31], v3 offset:38912
v_mfma_f32_16x16x32_bf16 v[116:119], a[136:139], a[80:83], v[116:119]
ds_read_b64_tr_b16 a[132:133], v24 offset:16384
v_mfma_f32_16x16x32_bf16 v[116:119], a[140:143], a[84:87], v[116:119]
v_mfma_f32_16x16x32_bf16 v[124:127], a[136:139], a[88:91], v[124:127]
ds_read_b64_tr_b16 a[134:135], v24 offset:18432
v_add_u32 v24, 32768, v24
v_mfma_f32_16x16x32_bf16 v[124:127], a[140:143], a[92:95], v[124:127]
v_mfma_f32_16x16x32_bf16 v[132:135], a[136:139], a[96:99], v[132:135]
ds_read_b128 a[32:35], v2 offset:40960
v_mfma_f32_16x16x32_bf16 v[132:135], a[140:143], a[100:103], v[132:135]
v_mfma_f32_16x16x32_bf16 v[140:143], a[136:139], a[104:107], v[140:143]
ds_read_b128 a[36:39], v3 offset:40960
v_mfma_f32_16x16x32_bf16 v[140:143], a[140:143], a[108:111], v[140:143]
ds_read_b128 a[40:43], v2 offset:43008
v_mfma_f32_16x16x32_bf16 v[148:151], a[136:139], a[112:115], v[148:151]
ds_read_b128 a[44:47], v3 offset:43008
v_mfma_f32_16x16x32_bf16 v[148:151], a[140:143], a[116:119], v[148:151]
v_mfma_f32_16x16x32_bf16 v[156:159], a[136:139], a[120:123], v[156:159]
s_andn2_b32 s31, s70, 256
ds_read_b128 a[48:51], v2 offset:45056
v_mfma_f32_16x16x32_bf16 v[156:159], a[140:143], a[124:127], v[156:159]
s_waitcnt lgkmcnt(5)
v_mfma_f32_16x16x32_bf16 v[164:167], a[128:131], a[64:67], v[164:167]
ds_read_b64_tr_b16 a[136:137], v25 offset:0
v_mfma_f32_16x16x32_bf16 v[164:167], a[132:135], a[68:71], v[164:167]
PAD_29:
s_cbranch_execz M_tret
v_mfma_f32_16x16x32_bf16 v[172:175], a[128:131], a[72:75], v[172:175]
ds_read_b64_tr_b16 a[138:139], v25 offset:2048
v_mfma_f32_16x16x32_bf16 v[172:175], a[132:135], a[76:79], v[172:175]
ds_read_b128 a[52:55], v3 offset:45056
v_mfma_f32_16x16x32_bf16 v[180:183], a[128:131], a[80:83], v[180:183]
ds_read_b64_tr_b16 a[140:141], v25 offset:16384
v_mfma_f32_16x16x32_bf16 v[180:183], a[132:135], a[84:87], v[180:183]
v_mfma_f32_16x16x32_bf16 v[188:191], a[128:131], a[88:91], v[188:191]
ds_read_b64_tr_b16 a[142:143], v25 offset:18432
v_add_u32 v25, 32768, v25
v_mfma_f32_16x16x32_bf16 v[188:191], a[132:135], a[92:95], v[188:191]
v_mfma_f32_16x16x32_bf16 v[196:199], a[128:131], a[96:99], v[196:199]
ds_read_b128 a[56:59], v2 offset:47104
v_mfma_f32_16x16x32_bf16 v[196:199], a[132:135], a[100:103], v[196:199]
v_mfma_f32_16x16x32_bf16 v[204:207], a[128:131], a[104:107], v[204:207]
ds_read_b128 a[60:63], v3 offset:47104
v_mfma_f32_16x16x32_bf16 v[204:207], a[132:135], a[108:111], v[204:207]
v_mfma_f32_16x16x32_bf16 v[212:215], a[128:131], a[112:115], v[212:215]
v_mfma_f32_16x16x32_bf16 v[212:215], a[132:135], a[116:119], v[212:215]
v_mfma_f32_16x16x32_bf16 v[220:223], a[128:131], a[120:123], v[220:223]
v_mfma_f32_16x16x32_bf16 v[220:223], a[132:135], a[124:127], v[220:223]
s_waitcnt vmcnt(0) lgkmcnt(0)
s_barrier
v_mfma_f32_16x16x32_bf16 v[224:227], a[136:139], a[64:67], v[224:227]
ds_read_b64_tr_b16 a[128:129], v22 offset:0
v_mfma_f32_16x16x32_bf16 v[224:227], a[140:143], a[68:71], v[224:227]
buffer_store_dword v27, v26, s[4:7], s66 offen sc1
v_mfma_f32_16x16x32_bf16 v[228:231], a[136:139], a[72:75], v[228:231]
ds_read_b64_tr_b16 a[130:131], v22 offset:2048
v_mfma_f32_16x16x32_bf16 v[228:231], a[140:143], a[76:79], v[228:231]
v_mfma_f32_16x16x32_bf16 v[232:235], a[136:139], a[80:83], v[232:235]
ds_read_b64_tr_b16 a[132:133], v22 offset:16384
v_mfma_f32_16x16x32_bf16 v[232:235], a[140:143], a[84:87], v[232:235]
v_mfma_f32_16x16x32_bf16 v[236:239], a[136:139], a[88:91], v[236:239]
ds_read_b64_tr_b16 a[134:135], v22 offset:18432
v_mfma_f32_16x16x32_bf16 v[236:239], a[140:143], a[92:95], v[236:239]
v_mfma_f32_16x16x32_bf16 v[240:243], a[136:139], a[96:99], v[240:243]
v_mfma_f32_16x16x32_bf16 v[240:243], a[140:143], a[100:103], v[240:243]
v_mfma_f32_16x16x32_bf16 v[244:247], a[136:139], a[104:107], v[244:247]
v_mfma_f32_16x16x32_bf16 v[244:247], a[140:143], a[108:111], v[244:247]
v_mfma_f32_16x16x32_bf16 v[248:251], a[136:139], a[112:115], v[248:251]
v_mfma_f32_16x16x32_bf16 v[248:251], a[140:143], a[116:119], v[248:251]
v_mfma_f32_16x16x32_bf16 v[252:255], a[136:139], a[120:123], v[252:255]
v_mfma_f32_16x16x32_bf16 v[252:255], a[140:143], a[124:127], v[252:255]
s_waitcnt lgkmcnt(0)
v_mfma_f32_16x16x32_bf16 v[36:39], a[128:131], a[0:3], v[36:39]
s_add_u32 m0, s84, 17152
ds_read_b64_tr_b16 a[136:137], v23 offset:0
v_lshrrev_b32 v9, 4, v1
v_mfma_f32_16x16x32_bf16 v[36:39], a[132:135], a[4:7], v[36:39]
buffer_load_dwordx4 v1, s[60:63], s83 offen offset:0 lds
v_mfma_f32_16x16x32_bf16 v[44:47], a[128:131], a[8:11], v[44:47]
ds_read_b64_tr_b16 a[138:139], v23 offset:2048
v_and_b32 v10, 15, v9
v_mfma_f32_16x16x32_bf16 v[44:47], a[132:135], a[12:15], v[44:47]
buffer_load_dwordx4 v1, s[60:63], s83 offen offset:1024 lds
v_mfma_f32_16x16x32_bf16 v[52:55], a[128:131], a[16:19], v[52:55]
ds_read_b64_tr_b16 a[140:141], v23 offset:16384
v_lshrrev_b32 v11, 4, v9
v_mfma_f32_16x16x32_bf16 v[52:55], a[132:135], a[20:23], v[52:55]
buffer_load_dwordx4 v1, s[60:63], s83 offen offset:2048 lds
v_mfma_f32_16x16x32_bf16 v[60:63], a[128:131], a[24:27], v[60:63]
ds_read_b64_tr_b16 a[142:143], v23 offset:18432
v_lshrrev_b32 v12, 2, v10
v_mfma_f32_16x16x32_bf16 v[60:63], a[132:135], a[28:31], v[60:63]
buffer_load_dwordx4 v1, s[60:63], s83 offen offset:3072 lds
v_mfma_f32_16x16x32_bf16 v[68:71], a[128:131], a[32:35], v[68:71]
s_add_u32 m0, s84, 64
v_mul_u32_u24 v12, 4160, v12
v_and_b32 v13, 3, v9
v_mfma_f32_16x16x32_bf16 v[68:71], a[132:135], a[36:39], v[68:71]
buffer_load_dwordx4 v1, s[4:7], s82 offen offset:0 sc1 lds
v_mfma_f32_16x16x32_bf16 v[76:79], a[128:131], a[40:43], v[76:79]
buffer_load_dwordx4 v1, s[4:7], s82 offen offset:1024 sc1 lds
v_mfma_f32_16x16x32_bf16 v[76:79], a[132:135], a[44:47], v[76:79]
buffer_load_dwordx4 v1, s[4:7], s82 offen offset:2048 sc1 lds
v_mfma_f32_16x16x32_bf16 v[84:87], a[128:131], a[48:51], v[84:87]
buffer_load_dwordx4 v1, s[4:7], s82 offen offset:3072 sc1 lds
v_mfma_f32_16x16x32_bf16 v[84:87], a[132:135], a[52:55], v[84:87]
s_add_u32 s82, s82, 2097152
v_lshl_add_u32 v12, v13, 3, v12
v_lshlrev_b32 v13, 4, v11
v_mfma_f32_16x16x32_bf16 v[92:95], a[128:131], a[56:59], v[92:95]
s_add_u32 m0, s84, 4224
v_sub_u32 v12, v12, v13
v_add_u32 v12, 88, v12
v_mfma_f32_16x16x32_bf16 v[92:95], a[132:135], a[60:63], v[92:95]
s_waitcnt lgkmcnt(0)
buffer_load_dwordx4 v1, s[4:7], s82 offen offset:0 sc1 lds
v_mfma_f32_16x16x32_bf16 v[100:103], a[136:139], a[0:3], v[100:103]
ds_read_b64_tr_b16 a[128:129], v24 offset:0
v_add_u32 v16, s84, v12
v_mfma_f32_16x16x32_bf16 v[100:103], a[140:143], a[4:7], v[100:103]
buffer_load_dwordx4 v1, s[4:7], s82 offen offset:1024 sc1 lds
v_mfma_f32_16x16x32_bf16 v[108:111], a[136:139], a[8:11], v[108:111]
ds_read_b64_tr_b16 a[130:131], v24 offset:2048
v_lshl_add_u32 v12, v10, 5, v13
v_mfma_f32_16x16x32_bf16 v[108:111], a[140:143], a[12:15], v[108:111]
buffer_load_dwordx4 v1, s[4:7], s82 offen offset:2048 sc1 lds
v_mfma_f32_16x16x32_bf16 v[116:119], a[136:139], a[16:19], v[116:119]
ds_read_b64_tr_b16 a[132:133], v24 offset:16384
v_add_u32 v12, 16672, v12
v_mfma_f32_16x16x32_bf16 v[116:119], a[140:143], a[20:23], v[116:119]
buffer_load_dwordx4 v1, s[4:7], s82 offen offset:3072 sc1 lds
v_mfma_f32_16x16x32_bf16 v[124:127], a[136:139], a[24:27], v[124:127]
s_add_u32 s82, s82, 4292870140
ds_read_b64_tr_b16 a[134:135], v24 offset:18432
v_add_u32 v17, s84, v12
v_mfma_f32_16x16x32_bf16 v[124:127], a[140:143], a[28:31], v[124:127]
s_add_u32 m0, s84, 8384
v_lshlrev_b32 v12, 5, v10
v_lshl_add_u32 v8, v11, 3, v12
v_mfma_f32_16x16x32_bf16 v[132:135], a[136:139], a[32:35], v[132:135]
buffer_load_dwordx4 v1, s[4:7], s82 offen offset:0 sc1 lds
v_mfma_f32_16x16x32_bf16 v[132:135], a[140:143], a[36:39], v[132:135]
buffer_load_dwordx4 v1, s[4:7], s82 offen offset:1024 sc1 lds
v_mfma_f32_16x16x32_bf16 v[140:143], a[136:139], a[40:43], v[140:143]
buffer_load_dwordx4 v1, s[4:7], s82 offen offset:2048 sc1 lds
v_mfma_f32_16x16x32_bf16 v[140:143], a[140:143], a[44:47], v[140:143]
buffer_load_dwordx4 v1, s[4:7], s82 offen offset:3072 sc1 lds
v_mfma_f32_16x16x32_bf16 v[148:151], a[136:139], a[48:51], v[148:151]
s_add_u32 s82, s82, 2097152
v_add3_u32 v18, s84, 64, v8
v_mov_b32 v19, 0
v_mfma_f32_16x16x32_bf16 v[148:151], a[140:143], a[52:55], v[148:151]
s_add_u32 m0, s84, 12544
v_mov_b32 v12, 0
v_mov_b32 v13, 0
v_mfma_f32_16x16x32_bf16 v[156:159], a[136:139], a[56:59], v[156:159]
buffer_load_dwordx4 v1, s[4:7], s82 offen offset:0 sc1 lds
v_mfma_f32_16x16x32_bf16 v[156:159], a[140:143], a[60:63], v[156:159]
s_waitcnt lgkmcnt(0)
buffer_load_dwordx4 v1, s[4:7], s82 offen offset:1024 sc1 lds
v_mfma_f32_16x16x32_bf16 v[164:167], a[128:131], a[0:3], v[164:167]
ds_read_b64_tr_b16 a[136:137], v25 offset:0
v_lshl_add_u32 v14, v9, 3, s84
v_mfma_f32_16x16x32_bf16 v[164:167], a[132:135], a[4:7], v[164:167]
buffer_load_dwordx4 v1, s[4:7], s82 offen offset:2048 sc1 lds
v_mfma_f32_16x16x32_bf16 v[172:175], a[128:131], a[8:11], v[172:175]
ds_read_b64_tr_b16 a[138:139], v25 offset:2048
v_mfma_f32_16x16x32_bf16 v[172:175], a[132:135], a[12:15], v[172:175]
buffer_load_dwordx4 v1, s[4:7], s82 offen offset:3072 sc1 lds
v_mfma_f32_16x16x32_bf16 v[180:183], a[128:131], a[16:19], v[180:183]
ds_read_b64_tr_b16 a[140:141], v25 offset:16384
v_mfma_f32_16x16x32_bf16 v[180:183], a[132:135], a[20:23], v[180:183]
ds_write_b64 v14, v[12:13] offset:16640
v_mul_u32_u24 v14, 4160, v11
v_mfma_f32_16x16x32_bf16 v[188:191], a[128:131], a[24:27], v[188:191]
ds_read_b64_tr_b16 a[142:143], v25 offset:18432
v_lshl_add_u32 v14, v10, 2, v14
v_mfma_f32_16x16x32_bf16 v[188:191], a[132:135], a[28:31], v[188:191]
v_add_u32 v14, s84, v14
v_mfma_f32_16x16x32_bf16 v[196:199], a[128:131], a[32:35], v[196:199]
ds_write_b32 v14, v12
v_lshrrev_b32 v30, 6, v0
v_mfma_f32_16x16x32_bf16 v[196:199], a[132:135], a[36:39], v[196:199]
v_lshl_add_u32 v28, v30, 11, v1
v_add_u32 v29, 0x20000, v28
v_mfma_f32_16x16x32_bf16 v[204:207], a[128:131], a[40:43], v[204:207]
v_lshl_add_u32 v30, v30, 13, v1
v_add_u32 v31, 0x20000, v30
v_mfma_f32_16x16x32_bf16 v[204:207], a[132:135], a[44:47], v[204:207]
v_mul_f32 v36, s68, v36
v_mul_f32 v37, s68, v37
v_mfma_f32_16x16x32_bf16 v[212:215], a[128:131], a[48:51], v[212:215]
v_mul_f32 v38, s68, v38
v_mul_f32 v39, s68, v39
v_mfma_f32_16x16x32_bf16 v[212:215], a[132:135], a[52:55], v[212:215]
v_mul_f32 v100, s68, v100
v_mul_f32 v101, s68, v101
v_mfma_f32_16x16x32_bf16 v[220:223], a[128:131], a[56:59], v[220:223]
v_mul_f32 v102, s68, v102
v_mul_f32 v103, s68, v103
v_mfma_f32_16x16x32_bf16 v[220:223], a[132:135], a[60:63], v[220:223]
s_waitcnt lgkmcnt(0)
s_waitcnt lgkmcnt(0)
s_barrier
v_mfma_f32_16x16x32_bf16 v[224:227], a[136:139], a[0:3], v[224:227]
v_cvt_pk_bf16_f32 v36, v36, v37
v_cvt_pk_bf16_f32 v37, v38, v39
v_mfma_f32_16x16x32_bf16 v[224:227], a[140:143], a[4:7], v[224:227]
v_cvt_pk_bf16_f32 v38, v100, v101
v_cvt_pk_bf16_f32 v39, v102, v103
v_mfma_f32_16x16x32_bf16 v[228:231], a[136:139], a[8:11], v[228:231]
v_mul_f32 v44, s68, v44
v_mul_f32 v45, s68, v45
v_mfma_f32_16x16x32_bf16 v[228:231], a[140:143], a[12:15], v[228:231]
v_mul_f32 v46, s68, v46
v_mul_f32 v47, s68, v47
v_mfma_f32_16x16x32_bf16 v[232:235], a[136:139], a[16:19], v[232:235]
v_mul_f32 v108, s68, v108
v_mul_f32 v109, s68, v109
v_mfma_f32_16x16x32_bf16 v[232:235], a[140:143], a[20:23], v[232:235]
v_mul_f32 v110, s68, v110
v_mul_f32 v111, s68, v111
v_mfma_f32_16x16x32_bf16 v[236:239], a[136:139], a[24:27], v[236:239]
v_cvt_pk_bf16_f32 v44, v44, v45
v_cvt_pk_bf16_f32 v45, v46, v47
v_mfma_f32_16x16x32_bf16 v[236:239], a[140:143], a[28:31], v[236:239]
v_cvt_pk_bf16_f32 v46, v108, v109
v_cvt_pk_bf16_f32 v47, v110, v111
v_mfma_f32_16x16x32_bf16 v[240:243], a[136:139], a[32:35], v[240:243]
v_mul_f32 v52, s68, v52
v_mul_f32 v53, s68, v53
v_mfma_f32_16x16x32_bf16 v[240:243], a[140:143], a[36:39], v[240:243]
v_mul_f32 v54, s68, v54
v_mul_f32 v55, s68, v55
v_mfma_f32_16x16x32_bf16 v[244:247], a[136:139], a[40:43], v[244:247]
v_mul_f32 v116, s68, v116
v_mul_f32 v117, s68, v117
v_mfma_f32_16x16x32_bf16 v[244:247], a[140:143], a[44:47], v[244:247]
v_mul_f32 v118, s68, v118
v_mul_f32 v119, s68, v119
v_mfma_f32_16x16x32_bf16 v[248:251], a[136:139], a[48:51], v[248:251]
v_cvt_pk_bf16_f32 v52, v52, v53
v_cvt_pk_bf16_f32 v53, v54, v55
v_mfma_f32_16x16x32_bf16 v[248:251], a[140:143], a[52:55], v[248:251]
v_cvt_pk_bf16_f32 v54, v116, v117
v_cvt_pk_bf16_f32 v55, v118, v119
v_mfma_f32_16x16x32_bf16 v[252:255], a[136:139], a[56:59], v[252:255]
v_mfma_f32_16x16x32_bf16 v[252:255], a[140:143], a[60:63], v[252:255]
s_mov_b64 s[60:61], s[74:75]
s_mov_b32 s62, 896
s_lshl_b32 s79, s85, 1
buffer_load_short_d16_hi v19, off, s[60:63], s79
s_lshl_b32 s83, s85, 12
s_add_u32 s83, s83, 88080384
ds_write_b128 v28, v[36:39] offset:0
ds_write_b128 v28, v[44:47] offset:8192
ds_write_b128 v28, v[52:55] offset:16384
v_pk_mul_f32 v[60:61], v[60:61], s[68:69]
v_pk_mul_f32 v[62:63], v[62:63], s[68:69]
v_pk_mul_f32 v[124:125], v[124:125], s[68:69]
v_pk_mul_f32 v[126:127], v[126:127], s[68:69]
v_cvt_pk_bf16_f32 v60, v60, v61
v_cvt_pk_bf16_f32 v61, v62, v63
v_cvt_pk_bf16_f32 v62, v124, v125
v_cvt_pk_bf16_f32 v63, v126, v127
ds_write_b128 v28, v[60:63] offset:24576
v_pk_mul_f32 v[68:69], v[68:69], s[68:69]
v_pk_mul_f32 v[70:71], v[70:71], s[68:69]
v_pk_mul_f32 v[132:133], v[132:133], s[68:69]
v_pk_mul_f32 v[134:135], v[134:135], s[68:69]
v_cvt_pk_bf16_f32 v68, v68, v69
v_cvt_pk_bf16_f32 v69, v70, v71
v_cvt_pk_bf16_f32 v70, v132, v133
v_cvt_pk_bf16_f32 v71, v134, v135
ds_write_b128 v29, v[68:71] offset:0
v_pk_mul_f32 v[76:77], v[76:77], s[68:69]
v_pk_mul_f32 v[78:79], v[78:79], s[68:69]
v_pk_mul_f32 v[140:141], v[140:141], s[68:69]
v_pk_mul_f32 v[142:143], v[142:143], s[68:69]
v_cvt_pk_bf16_f32 v76, v76, v77
v_cvt_pk_bf16_f32 v77, v78, v79
v_cvt_pk_bf16_f32 v78, v140, v141
v_cvt_pk_bf16_f32 v79, v142, v143
ds_write_b128 v29, v[76:79] offset:8192
v_pk_mul_f32 v[84:85], v[84:85], s[68:69]
v_pk_mul_f32 v[86:87], v[86:87], s[68:69]
v_pk_mul_f32 v[148:149], v[148:149], s[68:69]
v_pk_mul_f32 v[150:151], v[150:151], s[68:69]
v_cvt_pk_bf16_f32 v84, v84, v85
v_cvt_pk_bf16_f32 v85, v86, v87
v_cvt_pk_bf16_f32 v86, v148, v149
v_cvt_pk_bf16_f32 v87, v150, v151
ds_write_b128 v29, v[84:87] offset:16384
v_pk_mul_f32 v[92:93], v[92:93], s[68:69]
v_pk_mul_f32 v[94:95], v[94:95], s[68:69]
v_pk_mul_f32 v[156:157], v[156:157], s[68:69]
v_pk_mul_f32 v[158:159], v[158:159], s[68:69]
v_cvt_pk_bf16_f32 v92, v92, v93
v_cvt_pk_bf16_f32 v93, v94, v95
v_cvt_pk_bf16_f32 v94, v156, v157
v_cvt_pk_bf16_f32 v95, v158, v159
ds_write_b128 v29, v[92:95] offset:24576
v_pk_mul_f32 v[164:165], v[164:165], s[68:69]
v_pk_mul_f32 v[166:167], v[166:167], s[68:69]
v_pk_mul_f32 v[224:225], v[224:225], s[68:69]
v_pk_mul_f32 v[226:227], v[226:227], s[68:69]
v_cvt_pk_bf16_f32 v164, v164, v165
v_cvt_pk_bf16_f32 v165, v166, v167
v_cvt_pk_bf16_f32 v166, v224, v225
v_cvt_pk_bf16_f32 v167, v226, v227
ds_write_b128 v28, v[164:167] offset:1024
v_pk_mul_f32 v[172:173], v[172:173], s[68:69]
v_pk_mul_f32 v[174:175], v[174:175], s[68:69]
v_pk_mul_f32 v[228:229], v[228:229], s[68:69]
v_pk_mul_f32 v[230:231], v[230:231], s[68:69]
v_cvt_pk_bf16_f32 v172, v172, v173
v_cvt_pk_bf16_f32 v173, v174, v175
v_cvt_pk_bf16_f32 v174, v228, v229
v_cvt_pk_bf16_f32 v175, v230, v231
ds_write_b128 v28, v[172:175] offset:9216
v_pk_mul_f32 v[180:181], v[180:181], s[68:69]
v_pk_mul_f32 v[182:183], v[182:183], s[68:69]
v_pk_mul_f32 v[232:233], v[232:233], s[68:69]
v_pk_mul_f32 v[234:235], v[234:235], s[68:69]
v_cvt_pk_bf16_f32 v180, v180, v181
v_cvt_pk_bf16_f32 v181, v182, v183
v_cvt_pk_bf16_f32 v182, v232, v233
v_cvt_pk_bf16_f32 v183, v234, v235
ds_write_b128 v28, v[180:183] offset:17408
v_pk_mul_f32 v[188:189], v[188:189], s[68:69]
v_pk_mul_f32 v[190:191], v[190:191], s[68:69]
v_pk_mul_f32 v[236:237], v[236:237], s[68:69]
v_pk_mul_f32 v[238:239], v[238:239], s[68:69]
v_cvt_pk_bf16_f32 v188, v188, v189
v_cvt_pk_bf16_f32 v189, v190, v191
v_cvt_pk_bf16_f32 v190, v236, v237
v_cvt_pk_bf16_f32 v191, v238, v239
ds_write_b128 v28, v[188:191] offset:25600
v_pk_mul_f32 v[196:197], v[196:197], s[68:69]
v_pk_mul_f32 v[198:199], v[198:199], s[68:69]
v_pk_mul_f32 v[240:241], v[240:241], s[68:69]
v_pk_mul_f32 v[242:243], v[242:243], s[68:69]
v_cvt_pk_bf16_f32 v196, v196, v197
v_cvt_pk_bf16_f32 v197, v198, v199
v_cvt_pk_bf16_f32 v198, v240, v241
v_cvt_pk_bf16_f32 v199, v242, v243
ds_write_b128 v29, v[196:199] offset:1024
v_pk_mul_f32 v[204:205], v[204:205], s[68:69]
v_pk_mul_f32 v[206:207], v[206:207], s[68:69]
v_pk_mul_f32 v[244:245], v[244:245], s[68:69]
v_pk_mul_f32 v[246:247], v[246:247], s[68:69]
v_cvt_pk_bf16_f32 v204, v204, v205
v_cvt_pk_bf16_f32 v205, v206, v207
v_cvt_pk_bf16_f32 v206, v244, v245
v_cvt_pk_bf16_f32 v207, v246, v247
ds_write_b128 v29, v[204:207] offset:9216
v_pk_mul_f32 v[212:213], v[212:213], s[68:69]
v_pk_mul_f32 v[214:215], v[214:215], s[68:69]
v_pk_mul_f32 v[248:249], v[248:249], s[68:69]
v_pk_mul_f32 v[250:251], v[250:251], s[68:69]
v_cvt_pk_bf16_f32 v212, v212, v213
v_cvt_pk_bf16_f32 v213, v214, v215
v_cvt_pk_bf16_f32 v214, v248, v249
v_cvt_pk_bf16_f32 v215, v250, v251
ds_write_b128 v29, v[212:215] offset:17408
v_pk_mul_f32 v[220:221], v[220:221], s[68:69]
v_pk_mul_f32 v[222:223], v[222:223], s[68:69]
v_pk_mul_f32 v[252:253], v[252:253], s[68:69]
v_pk_mul_f32 v[254:255], v[254:255], s[68:69]
v_cvt_pk_bf16_f32 v220, v220, v221
v_cvt_pk_bf16_f32 v221, v222, v223
v_cvt_pk_bf16_f32 v222, v252, v253
v_cvt_pk_bf16_f32 v223, v254, v255
ds_write_b128 v29, v[220:223] offset:25600
s_waitcnt vmcnt(1) lgkmcnt(0)
s_barrier
buffer_load_dword v21, v20, s[4:7], s31 offen sc1
ds_read_b64_tr_b16 a[64:65], v16 offset:8
ds_read_b64_tr_b16 a[66:67], v16 offset:0
ds_read_b128 a[96:99], v17 offset:448
ds_read_b64_tr_b16 a[68:69], v16 offset:520
ds_read_b64_tr_b16 a[70:71], v16 offset:512
ds_read_b128 a[100:103], v17 offset:960
ds_read_b64_tr_b16 a[72:73], v16 offset:1032
ds_read_b64_tr_b16 a[74:75], v16 offset:1024
ds_read_b128 a[104:107], v17 offset:1472
ds_read_b64_tr_b16 a[76:77], v16 offset:1544
ds_read_b64_tr_b16 a[78:79], v16 offset:1536
ds_read_b128 a[108:111], v17 offset:1984
ds_read_b64_tr_b16 a[80:81], v16 offset:2056
ds_read_b64_tr_b16 a[82:83], v16 offset:2048
ds_read_b128 a[112:115], v17 offset:2496
ds_read_b64_tr_b16 a[84:85], v16 offset:2568
ds_read_b64_tr_b16 a[86:87], v16 offset:2560
ds_read_b128 a[116:119], v17 offset:3008
ds_read_b64_tr_b16 a[88:89], v16 offset:3080
ds_read_b64_tr_b16 a[90:91], v16 offset:3072
ds_read_b128 a[120:123], v17 offset:3520
ds_read_b64_tr_b16 a[92:93], v16 offset:3592
ds_read_b64_tr_b16 a[94:95], v16 offset:3584
ds_read_b128 a[124:127], v17 offset:4032
s_waitcnt lgkmcnt(15)
v_mfma_f32_16x16x32_bf16 v[96:99], a[64:67], a[96:99], 0
s_waitcnt lgkmcnt(12)
s_lshl_b32 s18, s3, 13
ds_read_b64_tr_b16 a[128:129], v16 offset:72
v_mov_b32 v24, 0
v_mfma_f32_16x16x32_bf16 v[100:103], a[64:67], a[100:103], 0
s_lshl_b32 s30, s20, 20
ds_read_b64_tr_b16 a[130:131], v16 offset:64
v_lshrrev_b32 v3, 6, v0
v_mfma_f32_16x16x32_bf16 v[100:103], a[68:71], a[96:99], v[100:103]
s_add_u32 s30, s30, s18
ds_read_b128 a[160:163], v17 offset:384
v_and_b32 v4, 63, v0
v_mfma_f32_16x16x32_bf16 v[104:107], a[64:67], a[104:107], 0
s_lshl_b32 s22, s21, 1
ds_read_b128 a[192:195], v30 offset:0
v_add_u32 v2, 0x10000, v1
v_mfma_f32_16x16x32_bf16 v[104:107], a[68:71], a[100:103], v[104:107]
s_and_b32 s84, s2, 1
ds_read_b64_tr_b16 a[132:133], v16 offset:584
v_and_b32 v5, 15, v4
v_mfma_f32_16x16x32_bf16 v[104:107], a[72:75], a[96:99], v[104:107]
s_mul_i32 s84, s84, 0
ds_read_b64_tr_b16 a[134:135], v16 offset:576
v_lshrrev_b32 v6, 4, v4
v_mfma_f32_16x16x32_bf16 v[108:111], a[64:67], a[108:111], 0
s_add_u32 s84, s84, 2386092
ds_read_b128 a[164:167], v17 offset:896
v_lshlrev_b32 v6, 2, v6
v_mfma_f32_16x16x32_bf16 v[108:111], a[68:71], a[104:107], v[108:111]
s_lshl_b32 s85, s21, 2
ds_read_b128 a[196:199], v30 offset:1024
v_sub_u32 v5, v5, v6
v_mfma_f32_16x16x32_bf16 v[108:111], a[72:75], a[100:103], v[108:111]
s_lshr_b32 s85, s84, s85
ds_read_b64_tr_b16 a[136:137], v16 offset:1096
v_lshl_add_u32 v5, v3, 4, v5
v_mfma_f32_16x16x32_bf16 v[108:111], a[76:79], a[96:99], v[108:111]
s_waitcnt lgkmcnt(8)
s_and_b32 s9, s85, 15
ds_read_b64_tr_b16 a[138:139], v16 offset:1088
v_cmp_gt_i32 s[32:33], 0, v5
v_mfma_f32_16x16x32_bf16 v[112:115], a[64:67], a[112:115], 0
s_and_b32 s84, s85, 1
ds_read_b128 a[168:171], v17 offset:1408
v_cmp_gt_i32 s[34:35], 1, v5
v_mfma_f32_16x16x32_bf16 v[112:115], a[68:71], a[108:111], v[112:115]
s_lshl_b32 s84, s84, 17
ds_read_b128 a[200:203], v30 offset:2048
v_cmp_gt_i32 s[36:37], 2, v5
v_mfma_f32_16x16x32_bf16 v[112:115], a[72:75], a[104:107], v[112:115]
s_add_u32 s84, s84, s18
ds_read_b64_tr_b16 a[140:141], v16 offset:1608
v_cmp_gt_i32 s[38:39], 3, v5
v_mfma_f32_16x16x32_bf16 v[112:115], a[76:79], a[100:103], v[112:115]
s_xor_b32 s85, s84, 0x20000
ds_read_b64_tr_b16 a[142:143], v16 offset:1600
v_cmp_gt_i32 s[40:41], 16, v5
v_mfma_f32_16x16x32_bf16 v[112:115], a[80:83], a[96:99], v[112:115]
s_sub_u32 s29, 15, s21
ds_read_b128 a[172:175], v17 offset:1920
v_cmp_gt_i32 s[42:43], 17, v5
v_mfma_f32_16x16x32_bf16 v[116:119], a[64:67], a[116:119], 0
s_xor_b32 s8, s30, 2097152
ds_read_b128 a[204:207], v30 offset:3072
v_cmp_gt_i32 s[44:45], 18, v5
v_mfma_f32_16x16x32_bf16 v[116:119], a[68:71], a[112:115], v[116:119]
s_add_u32 s11, s22, 2
ds_read_b64_tr_b16 a[144:145], v16 offset:2120
v_cmp_gt_i32 s[46:47], 19, v5
v_mfma_f32_16x16x32_bf16 v[116:119], a[72:75], a[108:111], v[116:119]
s_add_u32 s14, s30, 16777216
ds_read_b64_tr_b16 a[146:147], v16 offset:2112
v_cmp_gt_i32 s[48:49], 32, v5
v_mfma_f32_16x16x32_bf16 v[116:119], a[76:79], a[104:107], v[116:119]
s_lshr_b32 s19, s9, 1
ds_read_b128 a[176:179], v17 offset:2432
v_cmp_gt_i32 s[50:51], 33, v5
v_mfma_f32_16x16x32_bf16 v[116:119], a[80:83], a[100:103], v[116:119]
s_cmp_lg_u32 s9, 0
ds_read_b128 a[208:211], v30 offset:4096
v_cmp_gt_i32 s[52:53], 34, v5
v_mfma_f32_16x16x32_bf16 v[116:119], a[84:87], a[96:99], v[116:119]
s_cselect_b32 s10, s30, 3221225472
ds_read_b64_tr_b16 a[148:149], v16 offset:2632
v_cmp_gt_i32 s[54:55], 35, v5
v_mfma_f32_16x16x32_bf16 v[120:123], a[64:67], a[120:123], 0
s_cselect_b32 s8, s8, s30
ds_read_b64_tr_b16 a[150:151], v16 offset:2624
v_cmp_gt_i32 s[56:57], 48, v5
v_mfma_f32_16x16x32_bf16 v[120:123], a[68:71], a[116:119], v[120:123]
s_cselect_b32 s14, s14, 3221225472
ds_read_b128 a[180:183], v17 offset:2944
v_cmp_gt_i32 s[58:59], 49, v5
v_mfma_f32_16x16x32_bf16 v[120:123], a[72:75], a[112:115], v[120:123]
s_cselect_b32 s9, s9, s11
ds_read_b128 a[212:215], v30 offset:5120
v_cmp_gt_i32 s[60:61], 50, v5
v_mfma_f32_16x16x32_bf16 v[120:123], a[76:79], a[108:111], v[120:123]
s_cselect_b32 s19, s19, s21
ds_read_b64_tr_b16 a[152:153], v16 offset:3144
v_cmp_gt_i32 s[62:63], 51, v5
v_mfma_f32_16x16x32_bf16 v[120:123], a[80:83], a[104:107], v[120:123]
s_cselect_b32 s29, s29, s21
ds_read_b64_tr_b16 a[154:155], v16 offset:3136
v_mov_b32 v7, 0xff800000
v_mfma_f32_16x16x32_bf16 v[120:123], a[84:87], a[100:103], v[120:123]
s_cselect_b32 s24, 2, 0
ds_read_b128 a[184:187], v17 offset:3456
v_mov_b32 v6, 1
v_mfma_f32_16x16x32_bf16 v[120:123], a[88:91], a[96:99], v[120:123]
s_add_u32 s12, s8, 16777216
ds_read_b128 a[216:219], v30 offset:6144
v_mov_b32 v5, v26
v_mfma_f32_16x16x32_bf16 v[124:127], a[64:67], a[124:127], 0
s_mov_b32 s13, s9
ds_read_b64_tr_b16 a[156:157], v16 offset:3656
v_add_u32 v4, 0x20000, v1
v_mfma_f32_16x16x32_bf16 v[124:127], a[68:71], a[120:123], v[124:127]
s_mov_b32 s15, s11
ds_read_b64_tr_b16 a[158:159], v16 offset:3648
v_mfma_f32_16x16x32_bf16 v[124:127], a[72:75], a[116:119], v[124:127]
s_mov_b32 s25, 1266679808
ds_read_b128 a[188:191], v17 offset:3968
v_mfma_f32_16x16x32_bf16 v[124:127], a[76:79], a[112:115], v[124:127]
s_lshl_b32 s22, s21, 3
ds_read_b128 a[220:223], v30 offset:7168
v_mfma_f32_16x16x32_bf16 v[124:127], a[80:83], a[108:111], v[124:127]
s_xor_b32 s28, s70, 0
ds_read_b128 a[224:227], v31 offset:0
v_mfma_f32_16x16x32_bf16 v[124:127], a[84:87], a[104:107], v[124:127]
s_add_u32 s28, s28, s22
ds_read_b128 a[228:231], v31 offset:1024
v_mfma_f32_16x16x32_bf16 v[124:127], a[88:91], a[100:103], v[124:127]
s_add_u32 s28, s28, 6148
ds_read_b128 a[232:235], v31 offset:2048
v_mfma_f32_16x16x32_bf16 v[124:127], a[92:95], a[96:99], v[124:127]
s_waitcnt lgkmcnt(8)
s_lshl_b32 s26, s21, 16
ds_read_b128 a[236:239], v31 offset:3072
v_mfma_f32_16x16x32_bf16 v[96:99], a[128:131], a[160:163], v[96:99]
s_add_u32 s26, s26, s30
ds_read_b64_tr_b16 a[64:65], v16 offset:136
v_mfma_f32_16x16x32_bf16 v[100:103], a[128:131], a[164:167], v[100:103]
s_add_u32 s26, s26, 33554432
ds_read_b64_tr_b16 a[66:67], v16 offset:128
v_mfma_f32_16x16x32_bf16 v[100:103], a[132:135], a[160:163], v[100:103]
s_xor_b32 s76, s20, 2
ds_read_b128 a[96:99], v17 offset:320
v_mfma_f32_16x16x32_bf16 v[104:107], a[128:131], a[168:171], v[104:107]
s_lshl_b32 s76, s76, 3
ds_read_b128 a[240:243], v31 offset:4096
v_mfma_f32_16x16x32_bf16 v[104:107], a[132:135], a[164:167], v[104:107]
s_add_u32 s76, s76, s21
ds_read_b64_tr_b16 a[68:69], v16 offset:648
v_mfma_f32_16x16x32_bf16 v[104:107], a[136:139], a[160:163], v[104:107]
s_lshl_b32 s76, s76, 2
ds_read_b64_tr_b16 a[70:71], v16 offset:640
v_mfma_f32_16x16x32_bf16 v[108:111], a[128:131], a[172:175], v[108:111]
s_add_u32 s76, s76, s3
ds_read_b128 a[100:103], v17 offset:832
v_mfma_f32_16x16x32_bf16 v[108:111], a[132:135], a[168:171], v[108:111]
s_lshl_b32 s27, s76, 10
ds_read_b128 a[244:247], v31 offset:5120
v_mfma_f32_16x16x32_bf16 v[108:111], a[136:139], a[164:167], v[108:111]
s_add_u32 s27, s27, 75497472
ds_read_b64_tr_b16 a[72:73], v16 offset:1160
v_mfma_f32_16x16x32_bf16 v[108:111], a[140:143], a[160:163], v[108:111]
s_lshl_b32 s76, s76, 14
ds_read_b64_tr_b16 a[74:75], v16 offset:1152
v_mfma_f32_16x16x32_bf16 v[112:115], a[128:131], a[176:179], v[112:115]
s_add_u32 s76, s76, 67108864
ds_read_b128 a[104:107], v17 offset:1344
v_mfma_f32_16x16x32_bf16 v[112:115], a[132:135], a[172:175], v[112:115]
s_lshl_b32 s81, s20, 2
ds_read_b128 a[248:251], v31 offset:6144
v_mfma_f32_16x16x32_bf16 v[112:115], a[136:139], a[168:171], v[112:115]
s_add_u32 s81, s81, s3
ds_read_b64_tr_b16 a[76:77], v16 offset:1672
v_mfma_f32_16x16x32_bf16 v[112:115], a[140:143], a[164:167], v[112:115]
s_mul_i32 s81, s81, 57344
ds_read_b64_tr_b16 a[78:79], v16 offset:1664
v_mfma_f32_16x16x32_bf16 v[112:115], a[144:147], a[160:163], v[112:115]
PAD_30:
s_cbranch_execz M_tret
s_cmp_eq_u32 s24, 1
ds_read_b128 a[108:111], v17 offset:1856
v_mfma_f32_16x16x32_bf16 v[116:119], a[128:131], a[180:183], v[116:119]
s_cselect_b32 s80, s28, s70
ds_read_b128 a[252:255], v31 offset:7168
v_mfma_f32_16x16x32_bf16 v[116:119], a[132:135], a[176:179], v[116:119]
s_add_u32 s77, s76, 8192
ds_read_b64_tr_b16 a[80:81], v16 offset:2184
v_mfma_f32_16x16x32_bf16 v[116:119], a[136:139], a[172:175], v[116:119]
s_lshl_b32 s71, s2, 2
ds_read_b64_tr_b16 a[82:83], v16 offset:2176
v_mfma_f32_16x16x32_bf16 v[116:119], a[140:143], a[168:171], v[116:119]
s_add_u32 s71, s71, 94384128
ds_read_b128 a[112:115], v17 offset:2368
v_mfma_f32_16x16x32_bf16 v[116:119], a[144:147], a[164:167], v[116:119]
s_lshl_b32 s78, s29, 16
v_mfma_f32_16x16x32_bf16 v[116:119], a[148:151], a[160:163], v[116:119]
s_add_u32 s78, s78, s8
ds_read_b64_tr_b16 a[84:85], v16 offset:2696
v_mfma_f32_16x16x32_bf16 v[120:123], a[128:131], a[184:187], v[120:123]
s_add_u32 s78, s78, 33554432
ds_read_b64_tr_b16 a[86:87], v16 offset:2688
v_mfma_f32_16x16x32_bf16 v[120:123], a[132:135], a[180:183], v[120:123]
s_cmp_eq_u32 s24, 0
ds_read_b128 a[116:119], v17 offset:2880
v_mfma_f32_16x16x32_bf16 v[120:123], a[136:139], a[176:179], v[120:123]
s_cselect_b32 s78, 3221225472, s78
v_mfma_f32_16x16x32_bf16 v[120:123], a[140:143], a[172:175], v[120:123]
s_lshl_b32 s22, s21, 3
ds_read_b64_tr_b16 a[88:89], v16 offset:3208
v_mfma_f32_16x16x32_bf16 v[120:123], a[144:147], a[168:171], v[120:123]
s_add_u32 s22, s22, 16384
ds_read_b64_tr_b16 a[90:91], v16 offset:3200
v_mfma_f32_16x16x32_bf16 v[120:123], a[148:151], a[164:167], v[120:123]
s_andn2_b32 s23, 256, s70
ds_read_b128 a[120:123], v17 offset:3392
v_mfma_f32_16x16x32_bf16 v[120:123], a[152:155], a[160:163], v[120:123]
s_waitcnt lgkmcnt(6)
s_add_u32 s22, s22, s23
v_mfma_f32_16x16x32_bf16 v[124:127], a[128:131], a[188:191], v[124:127]
s_waitcnt vmcnt(0) lgkmcnt(9)
s_barrier
ds_read_b64_tr_b16 a[92:93], v16 offset:3720
v_writelane_b32 v15, s22, 63
v_cmp_gt_u32 vcc, 1, v21
v_mfma_f32_16x16x32_bf16 v[124:127], a[132:135], a[184:187], v[124:127]
s_cbranch_vccnz M_kspin2
M_kok2:
ds_read_b64_tr_b16 a[94:95], v16 offset:3712
v_mov_b32 v25, 0
v_mfma_f32_16x16x32_bf16 v[124:127], a[136:139], a[180:183], v[124:127]
s_mov_b32 m0, s84
ds_read_b128 a[124:127], v17 offset:3904
v_mov_b32 v128, 0
v_mfma_f32_16x16x32_bf16 v[124:127], a[140:143], a[176:179], v[124:127]
buffer_load_dwordx4 v1, s[4:7], s8 offen offset:0 sc1 lds
v_mfma_f32_16x16x32_bf16 v[124:127], a[144:147], a[172:175], v[124:127]
buffer_load_dwordx4 v1, s[4:7], s8 offen offset:1024 sc1 lds
v_mfma_f32_16x16x32_bf16 v[124:127], a[148:151], a[168:171], v[124:127]
buffer_load_dwordx4 v1, s[4:7], s8 offen offset:2048 sc1 lds
v_mfma_f32_16x16x32_bf16 v[124:127], a[152:155], a[164:167], v[124:127]
buffer_load_dwordx4 v1, s[4:7], s8 offen offset:3072 sc1 lds
v_mfma_f32_16x16x32_bf16 v[124:127], a[156:159], a[160:163], v[124:127]
s_add_u32 s8, s8, 4096
v_mov_b32 v129, 0
v_mov_b32 v130, 0
v_mfma_f32_16x16x32_bf16 v[96:99], a[64:67], a[96:99], v[96:99]
s_add_u32 m0, s84, 4096
ds_read_b64_tr_b16 a[128:129], v16 offset:200
v_mov_b32 v131, 0
v_mfma_f32_16x16x32_bf16 v[100:103], a[64:67], a[100:103], v[100:103]
ds_read_b64_tr_b16 a[130:131], v16 offset:192
v_mov_b32 v132, 0
v_mfma_f32_16x16x32_bf16 v[100:103], a[68:71], a[96:99], v[100:103]
ds_read_b128 a[160:163], v17 offset:256
v_mov_b32 v133, 0
v_mfma_f32_16x16x32_bf16 v[104:107], a[64:67], a[104:107], v[104:107]
buffer_load_dwordx4 v1, s[4:7], s8 offen offset:0 sc1 lds
v_mfma_f32_16x16x32_bf16 v[104:107], a[68:71], a[100:103], v[104:107]
ds_read_b64_tr_b16 a[132:133], v16 offset:712
v_mov_b32 v134, 0
v_mfma_f32_16x16x32_bf16 v[104:107], a[72:75], a[96:99], v[104:107]
ds_read_b64_tr_b16 a[134:135], v16 offset:704
v_mov_b32 v135, 0
v_mfma_f32_16x16x32_bf16 v[108:111], a[64:67], a[108:111], v[108:111]
ds_read_b128 a[164:167], v17 offset:768
v_mov_b32 v136, 0
v_mfma_f32_16x16x32_bf16 v[108:111], a[68:71], a[104:107], v[108:111]
buffer_load_dwordx4 v1, s[4:7], s8 offen offset:1024 sc1 lds
v_mfma_f32_16x16x32_bf16 v[108:111], a[72:75], a[100:103], v[108:111]
ds_read_b64_tr_b16 a[136:137], v16 offset:1224
v_mov_b32 v137, 0
v_mfma_f32_16x16x32_bf16 v[108:111], a[76:79], a[96:99], v[108:111]
ds_read_b64_tr_b16 a[138:139], v16 offset:1216
v_mov_b32 v138, 0
v_mfma_f32_16x16x32_bf16 v[112:115], a[64:67], a[112:115], v[112:115]
ds_read_b128 a[168:171], v17 offset:1280
v_mov_b32 v139, 0
v_mfma_f32_16x16x32_bf16 v[112:115], a[68:71], a[108:111], v[112:115]
buffer_load_dwordx4 v1, s[4:7], s8 offen offset:2048 sc1 lds
v_mfma_f32_16x16x32_bf16 v[112:115], a[72:75], a[104:107], v[112:115]
ds_read_b64_tr_b16 a[140:141], v16 offset:1736
v_mov_b32 v140, 0
v_mfma_f32_16x16x32_bf16 v[112:115], a[76:79], a[100:103], v[112:115]
ds_read_b64_tr_b16 a[142:143], v16 offset:1728
v_mov_b32 v141, 0
v_mfma_f32_16x16x32_bf16 v[112:115], a[80:83], a[96:99], v[112:115]
s_waitcnt lgkmcnt(6)
ds_read_b128 a[172:175], v17 offset:1792
v_mov_b32 v142, 0
v_mfma_f32_16x16x32_bf16 v[116:119], a[64:67], a[116:119], v[116:119]
buffer_load_dwordx4 v1, s[4:7], s8 offen offset:3072 sc1 lds
v_mfma_f32_16x16x32_bf16 v[116:119], a[68:71], a[112:115], v[116:119]
s_add_u32 s8, s8, 28672
ds_read_b64_tr_b16 a[144:145], v16 offset:2248
v_mov_b32 v143, 0
v_mfma_f32_16x16x32_bf16 v[116:119], a[72:75], a[108:111], v[116:119]
s_sub_u32 s9, s9, 1
ds_read_b64_tr_b16 a[146:147], v16 offset:2240
v_mov_b32 v144, 0
v_mfma_f32_16x16x32_bf16 v[116:119], a[76:79], a[104:107], v[116:119]
s_cmp_eq_u32 s9, 0
ds_read_b128 a[176:179], v17 offset:2304
v_mov_b32 v145, 0
v_mfma_f32_16x16x32_bf16 v[116:119], a[80:83], a[100:103], v[116:119]
s_cselect_b32 s8, s10, s8
v_mov_b32 v146, 0
v_mov_b32 v147, 0
v_mfma_f32_16x16x32_bf16 v[116:119], a[84:87], a[96:99], v[116:119]
s_cselect_b32 s9, s11, s9
ds_read_b64_tr_b16 a[148:149], v16 offset:2760
v_mov_b32 v148, 0
v_mfma_f32_16x16x32_bf16 v[120:123], a[64:67], a[120:123], v[120:123]
s_cselect_b32 s10, 3221225472, s10
ds_read_b64_tr_b16 a[150:151], v16 offset:2752
v_mov_b32 v149, 0
v_mfma_f32_16x16x32_bf16 v[120:123], a[68:71], a[116:119], v[120:123]
s_mov_b32 m0, s85
ds_read_b128 a[180:183], v17 offset:2816
v_mov_b32 v150, 0
v_mfma_f32_16x16x32_bf16 v[120:123], a[72:75], a[112:115], v[120:123]
buffer_load_dwordx4 v1, s[4:7], s8 offen offset:0 sc1 lds
v_mfma_f32_16x16x32_bf16 v[120:123], a[76:79], a[108:111], v[120:123]
ds_read_b64_tr_b16 a[152:153], v16 offset:3272
v_mov_b32 v151, 0
v_mfma_f32_16x16x32_bf16 v[120:123], a[80:83], a[104:107], v[120:123]
ds_read_b64_tr_b16 a[154:155], v16 offset:3264
v_mov_b32 v152, 0
v_mfma_f32_16x16x32_bf16 v[120:123], a[84:87], a[100:103], v[120:123]
ds_read_b128 a[184:187], v17 offset:3328
v_mov_b32 v153, 0
v_mfma_f32_16x16x32_bf16 v[120:123], a[88:91], a[96:99], v[120:123]
buffer_load_dwordx4 v1, s[4:7], s8 offen offset:1024 sc1 lds
v_mfma_f32_16x16x32_bf16 v[124:127], a[64:67], a[124:127], v[124:127]
ds_read_b64_tr_b16 a[156:157], v16 offset:3784
v_mov_b32 v154, 0
v_mfma_f32_16x16x32_bf16 v[124:127], a[68:71], a[120:123], v[124:127]
ds_read_b64_tr_b16 a[158:159], v16 offset:3776
v_mov_b32 v155, 0
v_mfma_f32_16x16x32_bf16 v[124:127], a[72:75], a[116:119], v[124:127]
ds_read_b128 a[188:191], v17 offset:3840
v_mov_b32 v156, 0
v_mfma_f32_16x16x32_bf16 v[124:127], a[76:79], a[112:115], v[124:127]
buffer_load_dwordx4 v1, s[4:7], s8 offen offset:2048 sc1 lds
v_mfma_f32_16x16x32_bf16 v[124:127], a[80:83], a[108:111], v[124:127]
buffer_load_dwordx4 v1, s[4:7], s8 offen offset:3072 sc1 lds
v_mfma_f32_16x16x32_bf16 v[124:127], a[84:87], a[104:107], v[124:127]
s_add_u32 s8, s8, 4096
v_mov_b32 v157, 0
v_mov_b32 v158, 0
v_mfma_f32_16x16x32_bf16 v[124:127], a[88:91], a[100:103], v[124:127]
s_add_u32 m0, s85, 4096
v_mov_b32 v159, 0
v_mov_b32 v160, 0
v_mfma_f32_16x16x32_bf16 v[124:127], a[92:95], a[96:99], v[124:127]
buffer_load_dwordx4 v1, s[4:7], s8 offen offset:0 sc1 lds
v_mfma_f32_16x16x32_bf16 v[96:99], a[128:131], a[160:163], v[96:99]
s_waitcnt lgkmcnt(3)
ds_read_b64_tr_b16 a[64:65], v16 offset:264
v_mov_b32 v161, 0
v_mfma_f32_16x16x32_bf16 v[100:103], a[128:131], a[164:167], v[100:103]
ds_read_b64_tr_b16 a[66:67], v16 offset:256
v_mov_b32 v162, 0
v_mfma_f32_16x16x32_bf16 v[100:103], a[132:135], a[160:163], v[100:103]
ds_read_b128 a[96:99], v17 offset:192
v_mov_b32 v163, 0
v_mfma_f32_16x16x32_bf16 v[104:107], a[128:131], a[168:171], v[104:107]
buffer_load_dwordx4 v1, s[4:7], s8 offen offset:1024 sc1 lds
v_mfma_f32_16x16x32_bf16 v[104:107], a[132:135], a[164:167], v[104:107]
ds_read_b64_tr_b16 a[68:69], v16 offset:776
v_mov_b32 v164, 0
v_mfma_f32_16x16x32_bf16 v[104:107], a[136:139], a[160:163], v[104:107]
ds_read_b64_tr_b16 a[70:71], v16 offset:768
v_mov_b32 v165, 0
v_mfma_f32_16x16x32_bf16 v[108:111], a[128:131], a[172:175], v[108:111]
ds_read_b128 a[100:103], v17 offset:704
v_mov_b32 v166, 0
v_mfma_f32_16x16x32_bf16 v[108:111], a[132:135], a[168:171], v[108:111]
buffer_load_dwordx4 v1, s[4:7], s8 offen offset:2048 sc1 lds
v_mfma_f32_16x16x32_bf16 v[108:111], a[136:139], a[164:167], v[108:111]
ds_read_b64_tr_b16 a[72:73], v16 offset:1288
v_mov_b32 v167, 0
v_mfma_f32_16x16x32_bf16 v[108:111], a[140:143], a[160:163], v[108:111]
ds_read_b64_tr_b16 a[74:75], v16 offset:1280
v_mov_b32 v168, 0
v_mfma_f32_16x16x32_bf16 v[112:115], a[128:131], a[176:179], v[112:115]
ds_read_b128 a[104:107], v17 offset:1216
v_mov_b32 v169, 0
v_mfma_f32_16x16x32_bf16 v[112:115], a[132:135], a[172:175], v[112:115]
buffer_load_dwordx4 v1, s[4:7], s8 offen offset:3072 sc1 lds
v_mfma_f32_16x16x32_bf16 v[112:115], a[136:139], a[168:171], v[112:115]
s_add_u32 s8, s8, 28672
ds_read_b64_tr_b16 a[76:77], v16 offset:1800
v_mov_b32 v170, 0
v_mfma_f32_16x16x32_bf16 v[112:115], a[140:143], a[164:167], v[112:115]
s_sub_u32 s9, s9, 1
ds_read_b64_tr_b16 a[78:79], v16 offset:1792
v_mov_b32 v171, 0
v_mfma_f32_16x16x32_bf16 v[112:115], a[144:147], a[160:163], v[112:115]
s_cmp_eq_u32 s9, 0
ds_read_b128 a[108:111], v17 offset:1728
v_mov_b32 v172, 0
v_mfma_f32_16x16x32_bf16 v[116:119], a[128:131], a[180:183], v[116:119]
s_cselect_b32 s8, s10, s8
buffer_load_dword v14, v15, s[4:7], s31 offen sc1
v_mfma_f32_16x16x32_bf16 v[116:119], a[132:135], a[176:179], v[116:119]
s_cselect_b32 s9, s11, s9
ds_read_b64_tr_b16 a[80:81], v16 offset:2312
v_mov_b32 v173, 0
v_mfma_f32_16x16x32_bf16 v[116:119], a[136:139], a[172:175], v[116:119]
s_cselect_b32 s10, 3221225472, s10
ds_read_b64_tr_b16 a[82:83], v16 offset:2304
v_mov_b32 v174, 0
v_mfma_f32_16x16x32_bf16 v[116:119], a[140:143], a[168:171], v[116:119]
ds_read_b128 a[112:115], v17 offset:2240
v_mov_b32 v175, 0
v_mfma_f32_16x16x32_bf16 v[116:119], a[144:147], a[164:167], v[116:119]
v_mov_b32 v176, 0
v_mov_b32 v177, 0
v_mfma_f32_16x16x32_bf16 v[116:119], a[148:151], a[160:163], v[116:119]
ds_read_b64_tr_b16 a[84:85], v16 offset:2824
v_mov_b32 v178, 0
v_mfma_f32_16x16x32_bf16 v[120:123], a[128:131], a[184:187], v[120:123]
ds_read_b64_tr_b16 a[86:87], v16 offset:2816
v_mov_b32 v179, 0
v_mfma_f32_16x16x32_bf16 v[120:123], a[132:135], a[180:183], v[120:123]
ds_read_b128 a[116:119], v17 offset:2752
v_mov_b32 v180, 0
v_mfma_f32_16x16x32_bf16 v[120:123], a[136:139], a[176:179], v[120:123]
v_mov_b32 v181, 0
v_mov_b32 v182, 0
v_mfma_f32_16x16x32_bf16 v[120:123], a[140:143], a[172:175], v[120:123]
ds_read_b64_tr_b16 a[88:89], v16 offset:3336
v_mov_b32 v183, 0
v_mfma_f32_16x16x32_bf16 v[120:123], a[144:147], a[168:171], v[120:123]
ds_read_b64_tr_b16 a[90:91], v16 offset:3328
v_mov_b32 v184, 0
v_mfma_f32_16x16x32_bf16 v[120:123], a[148:151], a[164:167], v[120:123]
ds_read_b128 a[120:123], v17 offset:3264
v_mov_b32 v185, 0
v_mfma_f32_16x16x32_bf16 v[120:123], a[152:155], a[160:163], v[120:123]
s_waitcnt lgkmcnt(6)
v_mov_b32 v186, 0
v_mov_b32 v187, 0
v_mfma_f32_16x16x32_bf16 v[124:127], a[128:131], a[188:191], v[124:127]
ds_read_b64_tr_b16 a[92:93], v16 offset:3848
v_mov_b32 v188, 0
v_mfma_f32_16x16x32_bf16 v[124:127], a[132:135], a[184:187], v[124:127]
ds_read_b64_tr_b16 a[94:95], v16 offset:3840
v_mov_b32 v189, 0
v_mfma_f32_16x16x32_bf16 v[124:127], a[136:139], a[180:183], v[124:127]
ds_read_b128 a[124:127], v17 offset:3776
v_mov_b32 v190, 0
v_mfma_f32_16x16x32_bf16 v[124:127], a[140:143], a[176:179], v[124:127]
v_mov_b32 v191, 0
v_mov_b32 v192, 0
v_mfma_f32_16x16x32_bf16 v[124:127], a[144:147], a[172:175], v[124:127]
v_mov_b32 v193, 0
v_mov_b32 v194, 0
v_mfma_f32_16x16x32_bf16 v[124:127], a[148:151], a[168:171], v[124:127]
v_mov_b32 v195, 0
v_mov_b32 v196, 0
v_mfma_f32_16x16x32_bf16 v[124:127], a[152:155], a[164:167], v[124:127]
v_mov_b32 v197, 0
v_mov_b32 v198, 0
v_mfma_f32_16x16x32_bf16 v[124:127], a[156:159], a[160:163], v[124:127]
v_mov_b32 v199, 0
v_mov_b32 v200, 0
s_waitcnt vmcnt(0)
v_cmp_gt_u32 vcc, 1, v14
s_cbranch_vccnz M_cspin
M_cok:
v_mfma_f32_16x16x32_bf16 v[96:99], a[64:67], a[96:99], v[96:99]
s_add_u32 s22, s78, 0
ds_read_b64_tr_b16 a[128:129], v16 offset:328
v_mov_b32 v201, 0
v_mfma_f32_16x16x32_bf16 v[100:103], a[64:67], a[100:103], v[100:103]
ds_read_b64_tr_b16 a[130:131], v16 offset:320
v_mov_b32 v202, 0
v_mfma_f32_16x16x32_bf16 v[100:103], a[68:71], a[96:99], v[100:103]
ds_read_b128 a[160:163], v17 offset:128
v_mov_b32 v203, 0
v_mfma_f32_16x16x32_bf16 v[104:107], a[64:67], a[104:107], v[104:107]
buffer_load_dwordx4 a[0:3], v1, s[4:7], s22 offen offset:0 sc1
v_mfma_f32_16x16x32_bf16 v[104:107], a[68:71], a[100:103], v[104:107]
ds_read_b64_tr_b16 a[132:133], v16 offset:840
v_mov_b32 v204, 0
v_mfma_f32_16x16x32_bf16 v[104:107], a[72:75], a[96:99], v[104:107]
ds_read_b64_tr_b16 a[134:135], v16 offset:832
v_mov_b32 v205, 0
v_mfma_f32_16x16x32_bf16 v[108:111], a[64:67], a[108:111], v[108:111]
ds_read_b128 a[164:167], v17 offset:640
v_mov_b32 v206, 0
v_mfma_f32_16x16x32_bf16 v[108:111], a[68:71], a[104:107], v[108:111]
buffer_load_dwordx4 a[4:7], v1, s[4:7], s22 offen offset:1024 sc1
v_mfma_f32_16x16x32_bf16 v[108:111], a[72:75], a[100:103], v[108:111]
ds_read_b64_tr_b16 a[136:137], v16 offset:1352
v_mov_b32 v207, 0
v_mfma_f32_16x16x32_bf16 v[108:111], a[76:79], a[96:99], v[108:111]
ds_read_b64_tr_b16 a[138:139], v16 offset:1344
v_mov_b32 v208, 0
v_mfma_f32_16x16x32_bf16 v[112:115], a[64:67], a[112:115], v[112:115]
ds_read_b128 a[168:171], v17 offset:1152
v_mov_b32 v209, 0
v_mfma_f32_16x16x32_bf16 v[112:115], a[68:71], a[108:111], v[112:115]
buffer_load_dwordx4 a[8:11], v1, s[4:7], s22 offen offset:2048 sc1
v_mfma_f32_16x16x32_bf16 v[112:115], a[72:75], a[104:107], v[112:115]
ds_read_b64_tr_b16 a[140:141], v16 offset:1864
v_mov_b32 v210, 0
v_mfma_f32_16x16x32_bf16 v[112:115], a[76:79], a[100:103], v[112:115]
ds_read_b64_tr_b16 a[142:143], v16 offset:1856
v_mov_b32 v211, 0
v_mfma_f32_16x16x32_bf16 v[112:115], a[80:83], a[96:99], v[112:115]
s_waitcnt lgkmcnt(6)
ds_read_b128 a[172:175], v17 offset:1664
v_mov_b32 v212, 0
v_mfma_f32_16x16x32_bf16 v[116:119], a[64:67], a[116:119], v[116:119]
buffer_load_dwordx4 a[12:15], v1, s[4:7], s22 offen offset:3072 sc1
v_mfma_f32_16x16x32_bf16 v[116:119], a[68:71], a[112:115], v[116:119]
s_add_u32 s22, s78, 4096
ds_read_b64_tr_b16 a[144:145], v16 offset:2376
v_mov_b32 v213, 0
v_mfma_f32_16x16x32_bf16 v[116:119], a[72:75], a[108:111], v[116:119]
ds_read_b64_tr_b16 a[146:147], v16 offset:2368
v_mov_b32 v214, 0
v_mfma_f32_16x16x32_bf16 v[116:119], a[76:79], a[104:107], v[116:119]
ds_read_b128 a[176:179], v17 offset:2176
v_mov_b32 v215, 0
v_mfma_f32_16x16x32_bf16 v[116:119], a[80:83], a[100:103], v[116:119]
buffer_load_dwordx4 a[16:19], v1, s[4:7], s22 offen offset:0 sc1
v_mfma_f32_16x16x32_bf16 v[116:119], a[84:87], a[96:99], v[116:119]
ds_read_b64_tr_b16 a[148:149], v16 offset:2888
v_mov_b32 v216, 0
v_mfma_f32_16x16x32_bf16 v[120:123], a[64:67], a[120:123], v[120:123]
ds_read_b64_tr_b16 a[150:151], v16 offset:2880
v_mov_b32 v217, 0
v_mfma_f32_16x16x32_bf16 v[120:123], a[68:71], a[116:119], v[120:123]
ds_read_b128 a[180:183], v17 offset:2688
v_mov_b32 v218, 0
v_mfma_f32_16x16x32_bf16 v[120:123], a[72:75], a[112:115], v[120:123]
buffer_load_dwordx4 a[20:23], v1, s[4:7], s22 offen offset:1024 sc1
v_mfma_f32_16x16x32_bf16 v[120:123], a[76:79], a[108:111], v[120:123]
ds_read_b64_tr_b16 a[152:153], v16 offset:3400
v_mov_b32 v219, 0
v_mfma_f32_16x16x32_bf16 v[120:123], a[80:83], a[104:107], v[120:123]
ds_read_b64_tr_b16 a[154:155], v16 offset:3392
v_mov_b32 v220, 0
v_mfma_f32_16x16x32_bf16 v[120:123], a[84:87], a[100:103], v[120:123]
ds_read_b128 a[184:187], v17 offset:3200
v_mov_b32 v221, 0
v_mfma_f32_16x16x32_bf16 v[120:123], a[88:91], a[96:99], v[120:123]
buffer_load_dwordx4 a[24:27], v1, s[4:7], s22 offen offset:2048 sc1
v_mfma_f32_16x16x32_bf16 v[124:127], a[64:67], a[124:127], v[124:127]
ds_read_b64_tr_b16 a[156:157], v16 offset:3912
v_mov_b32 v222, 0
v_mfma_f32_16x16x32_bf16 v[124:127], a[68:71], a[120:123], v[124:127]
ds_read_b64_tr_b16 a[158:159], v16 offset:3904
v_mov_b32 v223, 0
v_mfma_f32_16x16x32_bf16 v[124:127], a[72:75], a[116:119], v[124:127]
ds_read_b128 a[188:191], v17 offset:3712
v_mov_b32 v224, 0
v_mfma_f32_16x16x32_bf16 v[124:127], a[76:79], a[112:115], v[124:127]
buffer_load_dwordx4 a[28:31], v1, s[4:7], s22 offen offset:3072 sc1
v_mfma_f32_16x16x32_bf16 v[124:127], a[80:83], a[108:111], v[124:127]
s_add_u32 s22, s78, 32768
buffer_load_dwordx4 a[32:35], v1, s[4:7], s22 offen offset:0 sc1
v_mfma_f32_16x16x32_bf16 v[124:127], a[84:87], a[104:107], v[124:127]
buffer_load_dwordx4 a[36:39], v1, s[4:7], s22 offen offset:1024 sc1
v_mfma_f32_16x16x32_bf16 v[124:127], a[88:91], a[100:103], v[124:127]
buffer_load_dwordx4 a[40:43], v1, s[4:7], s22 offen offset:2048 sc1
v_mfma_f32_16x16x32_bf16 v[124:127], a[92:95], a[96:99], v[124:127]
s_waitcnt lgkmcnt(3)
buffer_load_dwordx4 a[44:47], v1, s[4:7], s22 offen offset:3072 sc1
v_mfma_f32_16x16x32_bf16 v[96:99], a[128:131], a[160:163], v[96:99]
s_add_u32 s22, s78, 36864
ds_read_b64_tr_b16 a[64:65], v16 offset:392
v_mov_b32 v225, 0
v_mfma_f32_16x16x32_bf16 v[100:103], a[128:131], a[164:167], v[100:103]
ds_read_b64_tr_b16 a[66:67], v16 offset:384
v_mov_b32 v226, 0
v_mfma_f32_16x16x32_bf16 v[100:103], a[132:135], a[160:163], v[100:103]
ds_read_b128 a[96:99], v17 offset:64
v_mov_b32 v227, 0
v_mfma_f32_16x16x32_bf16 v[104:107], a[128:131], a[168:171], v[104:107]
ds_read_b64 v[36:37], v18 offset:0
v_mov_b32 v228, 0
v_mfma_f32_16x16x32_bf16 v[104:107], a[132:135], a[164:167], v[104:107]
ds_read_b64_tr_b16 a[68:69], v16 offset:904
v_mov_b32 v229, 0
v_mfma_f32_16x16x32_bf16 v[104:107], a[136:139], a[160:163], v[104:107]
ds_read_b64_tr_b16 a[70:71], v16 offset:896
v_mov_b32 v230, 0
v_mfma_f32_16x16x32_bf16 v[108:111], a[128:131], a[172:175], v[108:111]
ds_read_b128 a[100:103], v17 offset:576
v_mov_b32 v231, 0
v_mfma_f32_16x16x32_bf16 v[108:111], a[132:135], a[168:171], v[108:111]
ds_read_b64 v[38:39], v18 offset:512
v_mov_b32 v232, 0
v_mfma_f32_16x16x32_bf16 v[108:111], a[136:139], a[164:167], v[108:111]
ds_read_b64_tr_b16 a[72:73], v16 offset:1416
v_mov_b32 v233, 0
v_mfma_f32_16x16x32_bf16 v[108:111], a[140:143], a[160:163], v[108:111]
ds_read_b64_tr_b16 a[74:75], v16 offset:1408
v_mov_b32 v234, 0
v_mfma_f32_16x16x32_bf16 v[112:115], a[128:131], a[176:179], v[112:115]
ds_read_b128 a[104:107], v17 offset:1088
v_mov_b32 v235, 0
v_mfma_f32_16x16x32_bf16 v[112:115], a[132:135], a[172:175], v[112:115]
ds_read_b64 v[44:45], v18 offset:1024
v_mov_b32 v236, 0
v_mfma_f32_16x16x32_bf16 v[112:115], a[136:139], a[168:171], v[112:115]
ds_read_b64_tr_b16 a[76:77], v16 offset:1928
v_mov_b32 v237, 0
v_mfma_f32_16x16x32_bf16 v[112:115], a[140:143], a[164:167], v[112:115]
ds_read_b64_tr_b16 a[78:79], v16 offset:1920
v_mov_b32 v238, 0
v_mfma_f32_16x16x32_bf16 v[112:115], a[144:147], a[160:163], v[112:115]
ds_read_b128 a[108:111], v17 offset:1600
v_mov_b32 v239, 0
v_mfma_f32_16x16x32_bf16 v[116:119], a[128:131], a[180:183], v[116:119]
ds_read_b64 v[46:47], v18 offset:1536
v_mov_b32 v240, 0
v_mfma_f32_16x16x32_bf16 v[116:119], a[132:135], a[176:179], v[116:119]
ds_read_b64_tr_b16 a[80:81], v16 offset:2440
v_mov_b32 v241, 0
v_mfma_f32_16x16x32_bf16 v[116:119], a[136:139], a[172:175], v[116:119]
ds_read_b64_tr_b16 a[82:83], v16 offset:2432
v_mov_b32 v242, 0
v_mfma_f32_16x16x32_bf16 v[116:119], a[140:143], a[168:171], v[116:119]
ds_read_b128 a[112:115], v17 offset:2112
v_mov_b32 v243, 0
v_mfma_f32_16x16x32_bf16 v[116:119], a[144:147], a[164:167], v[116:119]
ds_read_b64 v[52:53], v18 offset:2048
v_mov_b32 v244, 0
v_mfma_f32_16x16x32_bf16 v[116:119], a[148:151], a[160:163], v[116:119]
ds_read_b64_tr_b16 a[84:85], v16 offset:2952
v_mov_b32 v245, 0
v_mfma_f32_16x16x32_bf16 v[120:123], a[128:131], a[184:187], v[120:123]
ds_read_b64_tr_b16 a[86:87], v16 offset:2944
v_mov_b32 v246, 0
v_mfma_f32_16x16x32_bf16 v[120:123], a[132:135], a[180:183], v[120:123]
ds_read_b128 a[116:119], v17 offset:2624
v_mov_b32 v247, 0
v_mfma_f32_16x16x32_bf16 v[120:123], a[136:139], a[176:179], v[120:123]
ds_read_b64 v[54:55], v18 offset:2560
v_mov_b32 v248, 0
v_mfma_f32_16x16x32_bf16 v[120:123], a[140:143], a[172:175], v[120:123]
ds_read_b64_tr_b16 a[88:89], v16 offset:3464
v_mov_b32 v249, 0
v_mfma_f32_16x16x32_bf16 v[120:123], a[144:147], a[168:171], v[120:123]
ds_read_b64_tr_b16 a[90:91], v16 offset:3456
v_mov_b32 v250, 0
v_mfma_f32_16x16x32_bf16 v[120:123], a[148:151], a[164:167], v[120:123]
ds_read_b128 a[120:123], v17 offset:3136
v_mov_b32 v251, 0
v_mfma_f32_16x16x32_bf16 v[120:123], a[152:155], a[160:163], v[120:123]
s_waitcnt lgkmcnt(8)
ds_read_b64 v[60:61], v18 offset:3072
v_mov_b32 v252, 0
v_mfma_f32_16x16x32_bf16 v[124:127], a[128:131], a[188:191], v[124:127]
ds_read_b64_tr_b16 a[92:93], v16 offset:3976
v_mov_b32 v253, 0
v_mfma_f32_16x16x32_bf16 v[124:127], a[132:135], a[184:187], v[124:127]
ds_read_b64_tr_b16 a[94:95], v16 offset:3968
v_mov_b32 v254, 0
v_mfma_f32_16x16x32_bf16 v[124:127], a[136:139], a[180:183], v[124:127]
ds_read_b128 a[124:127], v17 offset:3648
v_mov_b32 v255, 0
v_mfma_f32_16x16x32_bf16 v[124:127], a[140:143], a[176:179], v[124:127]
ds_read_b64 v[62:63], v18 offset:3584
v_mfma_f32_16x16x32_bf16 v[124:127], a[144:147], a[172:175], v[124:127]
buffer_load_dwordx4 a[48:51], v1, s[4:7], s22 offen offset:0 sc1
v_mfma_f32_16x16x32_bf16 v[124:127], a[148:151], a[168:171], v[124:127]
buffer_load_dwordx4 a[52:55], v1, s[4:7], s22 offen offset:1024 sc1
v_mfma_f32_16x16x32_bf16 v[124:127], a[152:155], a[164:167], v[124:127]
buffer_load_dwordx4 a[56:59], v1, s[4:7], s22 offen offset:2048 sc1
v_mfma_f32_16x16x32_bf16 v[124:127], a[156:159], a[160:163], v[124:127]
buffer_load_dwordx4 a[60:63], v1, s[4:7], s22 offen offset:3072 sc1
v_mfma_f32_16x16x32_bf16 v[96:99], a[64:67], a[96:99], v[96:99]
ds_read_b64_tr_b16 a[128:129], v16 offset:456
v_mfma_f32_16x16x32_bf16 v[100:103], a[64:67], a[100:103], v[100:103]
ds_read_b64_tr_b16 a[130:131], v16 offset:448
v_mfma_f32_16x16x32_bf16 v[100:103], a[68:71], a[96:99], v[100:103]
ds_read_b128 a[160:163], v17 offset:0
v_mfma_f32_16x16x32_bf16 v[104:107], a[64:67], a[104:107], v[104:107]
v_mfma_f32_16x16x32_bf16 v[104:107], a[68:71], a[100:103], v[104:107]
ds_read_b64_tr_b16 a[132:133], v16 offset:968
v_mfma_f32_16x16x32_bf16 v[104:107], a[72:75], a[96:99], v[104:107]
ds_read_b64_tr_b16 a[134:135], v16 offset:960
v_mfma_f32_16x16x32_bf16 v[108:111], a[64:67], a[108:111], v[108:111]
ds_read_b128 a[164:167], v17 offset:512
v_mfma_f32_16x16x32_bf16 v[108:111], a[68:71], a[104:107], v[108:111]
v_mfma_f32_16x16x32_bf16 v[108:111], a[72:75], a[100:103], v[108:111]
ds_read_b64_tr_b16 a[136:137], v16 offset:1480
v_mfma_f32_16x16x32_bf16 v[108:111], a[76:79], a[96:99], v[108:111]
ds_read_b64_tr_b16 a[138:139], v16 offset:1472
v_mfma_f32_16x16x32_bf16 v[112:115], a[64:67], a[112:115], v[112:115]
ds_read_b128 a[168:171], v17 offset:1024
v_mfma_f32_16x16x32_bf16 v[112:115], a[68:71], a[108:111], v[112:115]
v_mfma_f32_16x16x32_bf16 v[112:115], a[72:75], a[104:107], v[112:115]
ds_read_b64_tr_b16 a[140:141], v16 offset:1992
v_mfma_f32_16x16x32_bf16 v[112:115], a[76:79], a[100:103], v[112:115]
ds_read_b64_tr_b16 a[142:143], v16 offset:1984
v_mfma_f32_16x16x32_bf16 v[112:115], a[80:83], a[96:99], v[112:115]
s_waitcnt lgkmcnt(6)
ds_read_b128 a[172:175], v17 offset:1536
v_mfma_f32_16x16x32_bf16 v[116:119], a[64:67], a[116:119], v[116:119]
v_mfma_f32_16x16x32_bf16 v[116:119], a[68:71], a[112:115], v[116:119]
ds_read_b64_tr_b16 a[144:145], v16 offset:2504
v_mfma_f32_16x16x32_bf16 v[116:119], a[72:75], a[108:111], v[116:119]
ds_read_b64_tr_b16 a[146:147], v16 offset:2496
v_mfma_f32_16x16x32_bf16 v[116:119], a[76:79], a[104:107], v[116:119]
ds_read_b128 a[176:179], v17 offset:2048
v_mfma_f32_16x16x32_bf16 v[116:119], a[80:83], a[100:103], v[116:119]
v_mfma_f32_16x16x32_bf16 v[116:119], a[84:87], a[96:99], v[116:119]
ds_read_b64_tr_b16 a[148:149], v16 offset:3016
v_mfma_f32_16x16x32_bf16 v[120:123], a[64:67], a[120:123], v[120:123]
ds_read_b64_tr_b16 a[150:151], v16 offset:3008
v_mfma_f32_16x16x32_bf16 v[120:123], a[68:71], a[116:119], v[120:123]
ds_read_b128 a[180:183], v17 offset:2560
v_mfma_f32_16x16x32_bf16 v[120:123], a[72:75], a[112:115], v[120:123]
v_mfma_f32_16x16x32_bf16 v[120:123], a[76:79], a[108:111], v[120:123]
ds_read_b64_tr_b16 a[152:153], v16 offset:3528
v_mfma_f32_16x16x32_bf16 v[120:123], a[80:83], a[104:107], v[120:123]
ds_read_b64_tr_b16 a[154:155], v16 offset:3520
v_mfma_f32_16x16x32_bf16 v[120:123], a[84:87], a[100:103], v[120:123]
ds_read_b128 a[184:187], v17 offset:3072
v_mfma_f32_16x16x32_bf16 v[120:123], a[88:91], a[96:99], v[120:123]
v_mfma_f32_16x16x32_bf16 v[124:127], a[64:67], a[124:127], v[124:127]
ds_read_b64_tr_b16 a[156:157], v16 offset:4040
v_mfma_f32_16x16x32_bf16 v[124:127], a[68:71], a[120:123], v[124:127]
ds_read_b64_tr_b16 a[158:159], v16 offset:4032
v_mfma_f32_16x16x32_bf16 v[124:127], a[72:75], a[116:119], v[124:127]
ds_read_b128 a[188:191], v17 offset:3584
v_mfma_f32_16x16x32_bf16 v[124:127], a[76:79], a[112:115], v[124:127]
v_mfma_f32_16x16x32_bf16 v[124:127], a[80:83], a[108:111], v[124:127]
v_mfma_f32_16x16x32_bf16 v[124:127], a[84:87], a[104:107], v[124:127]
v_mfma_f32_16x16x32_bf16 v[124:127], a[88:91], a[100:103], v[124:127]
v_mfma_f32_16x16x32_bf16 v[124:127], a[92:95], a[96:99], v[124:127]
v_mfma_f32_16x16x32_bf16 v[96:99], a[128:131], a[160:163], v[96:99]
s_waitcnt lgkmcnt(3)
v_mfma_f32_16x16x32_bf16 v[100:103], a[128:131], a[164:167], v[100:103]
v_mfma_f32_16x16x32_bf16 v[100:103], a[132:135], a[160:163], v[100:103]
v_mfma_f32_16x16x32_bf16 v[104:107], a[128:131], a[168:171], v[104:107]
v_mfma_f32_16x16x32_bf16 v[104:107], a[132:135], a[164:167], v[104:107]
v_mfma_f32_16x16x32_bf16 v[104:107], a[136:139], a[160:163], v[104:107]
v_mfma_f32_16x16x32_bf16 v[108:111], a[128:131], a[172:175], v[108:111]
v_mfma_f32_16x16x32_bf16 v[108:111], a[132:135], a[168:171], v[108:111]
v_mfma_f32_16x16x32_bf16 v[108:111], a[136:139], a[164:167], v[108:111]
v_lshlrev_b32 v10, 16, v36
v_fmac_f32 v96, v19, v10
v_mfma_f32_16x16x32_bf16 v[108:111], a[140:143], a[160:163], v[108:111]
v_and_b32 v11, 0xffff0000, v36
v_fmac_f32 v97, v19, v11
v_mfma_f32_16x16x32_bf16 v[112:115], a[128:131], a[176:179], v[112:115]
v_lshlrev_b32 v12, 16, v37
v_fmac_f32 v98, v19, v12
v_mfma_f32_16x16x32_bf16 v[112:115], a[132:135], a[172:175], v[112:115]
v_and_b32 v13, 0xffff0000, v37
v_fmac_f32 v99, v19, v13
v_mfma_f32_16x16x32_bf16 v[112:115], a[136:139], a[168:171], v[112:115]
v_cvt_pk_bf16_f32 v96, v96, v97
v_cvt_pk_bf16_f32 v97, v98, v99
v_mfma_f32_16x16x32_bf16 v[112:115], a[140:143], a[164:167], v[112:115]
buffer_store_dwordx2 v[96:97], v8, s[4:7], s83 offen offset:0 sc1
v_mfma_f32_16x16x32_bf16 v[112:115], a[144:147], a[160:163], v[112:115]
v_lshlrev_b32 v10, 16, v38
v_fmac_f32 v100, v19, v10
v_mfma_f32_16x16x32_bf16 v[116:119], a[128:131], a[180:183], v[116:119]
v_and_b32 v11, 0xffff0000, v38
v_fmac_f32 v101, v19, v11
v_mfma_f32_16x16x32_bf16 v[116:119], a[132:135], a[176:179], v[116:119]
v_lshlrev_b32 v12, 16, v39
v_fmac_f32 v102, v19, v12
v_mfma_f32_16x16x32_bf16 v[116:119], a[136:139], a[172:175], v[116:119]
v_and_b32 v13, 0xffff0000, v39
v_fmac_f32 v103, v19, v13
v_mfma_f32_16x16x32_bf16 v[116:119], a[140:143], a[168:171], v[116:119]
v_cvt_pk_bf16_f32 v100, v100, v101
v_cvt_pk_bf16_f32 v101, v102, v103
v_mfma_f32_16x16x32_bf16 v[116:119], a[144:147], a[164:167], v[116:119]
buffer_store_dwordx2 v[100:101], v8, s[4:7], s83 offen offset:512 sc1
v_mfma_f32_16x16x32_bf16 v[116:119], a[148:151], a[160:163], v[116:119]
PAD_31:
s_cbranch_execz M_tret
v_lshlrev_b32 v10, 16, v44
v_fmac_f32 v104, v19, v10
v_mfma_f32_16x16x32_bf16 v[120:123], a[128:131], a[184:187], v[120:123]
v_and_b32 v11, 0xffff0000, v44
v_fmac_f32 v105, v19, v11
v_mfma_f32_16x16x32_bf16 v[120:123], a[132:135], a[180:183], v[120:123]
v_lshlrev_b32 v12, 16, v45
v_fmac_f32 v106, v19, v12
v_mfma_f32_16x16x32_bf16 v[120:123], a[136:139], a[176:179], v[120:123]
v_and_b32 v13, 0xffff0000, v45
v_fmac_f32 v107, v19, v13
v_mfma_f32_16x16x32_bf16 v[120:123], a[140:143], a[172:175], v[120:123]
v_cvt_pk_bf16_f32 v104, v104, v105
v_cvt_pk_bf16_f32 v105, v106, v107
v_mfma_f32_16x16x32_bf16 v[120:123], a[144:147], a[168:171], v[120:123]
buffer_store_dwordx2 v[104:105], v8, s[4:7], s83 offen offset:1024 sc1
v_mfma_f32_16x16x32_bf16 v[120:123], a[148:151], a[164:167], v[120:123]
v_lshlrev_b32 v10, 16, v46
v_fmac_f32 v108, v19, v10
v_mfma_f32_16x16x32_bf16 v[120:123], a[152:155], a[160:163], v[120:123]
s_waitcnt lgkmcnt(0)
v_and_b32 v11, 0xffff0000, v46
v_fmac_f32 v109, v19, v11
v_mfma_f32_16x16x32_bf16 v[124:127], a[128:131], a[188:191], v[124:127]
v_lshlrev_b32 v12, 16, v47
v_fmac_f32 v110, v19, v12
v_mfma_f32_16x16x32_bf16 v[124:127], a[132:135], a[184:187], v[124:127]
v_and_b32 v13, 0xffff0000, v47
v_fmac_f32 v111, v19, v13
v_mfma_f32_16x16x32_bf16 v[124:127], a[136:139], a[180:183], v[124:127]
v_cvt_pk_bf16_f32 v108, v108, v109
v_cvt_pk_bf16_f32 v109, v110, v111
v_mfma_f32_16x16x32_bf16 v[124:127], a[140:143], a[176:179], v[124:127]
buffer_store_dwordx2 v[108:109], v8, s[4:7], s83 offen offset:1536 sc1
v_mfma_f32_16x16x32_bf16 v[124:127], a[144:147], a[172:175], v[124:127]
v_lshlrev_b32 v10, 16, v52
v_fmac_f32 v112, v19, v10
v_mfma_f32_16x16x32_bf16 v[124:127], a[148:151], a[168:171], v[124:127]
v_and_b32 v11, 0xffff0000, v52
v_fmac_f32 v113, v19, v11
v_mfma_f32_16x16x32_bf16 v[124:127], a[152:155], a[164:167], v[124:127]
v_lshlrev_b32 v12, 16, v53
v_fmac_f32 v114, v19, v12
v_mfma_f32_16x16x32_bf16 v[124:127], a[156:159], a[160:163], v[124:127]
v_and_b32 v13, 0xffff0000, v53
v_fmac_f32 v115, v19, v13
v_cvt_pk_bf16_f32 v112, v112, v113
v_cvt_pk_bf16_f32 v113, v114, v115
buffer_store_dwordx2 v[112:113], v8, s[4:7], s83 offen offset:2048 sc1
v_lshlrev_b32 v10, 16, v54
v_fmac_f32 v116, v19, v10
v_and_b32 v11, 0xffff0000, v54
v_fmac_f32 v117, v19, v11
v_lshlrev_b32 v12, 16, v55
v_fmac_f32 v118, v19, v12
v_and_b32 v13, 0xffff0000, v55
v_fmac_f32 v119, v19, v13
v_cvt_pk_bf16_f32 v116, v116, v117
v_cvt_pk_bf16_f32 v117, v118, v119
buffer_store_dwordx2 v[116:117], v8, s[4:7], s83 offen offset:2560 sc1
v_lshlrev_b32 v10, 16, v60
v_fmac_f32 v120, v19, v10
v_and_b32 v11, 0xffff0000, v60
v_fmac_f32 v121, v19, v11
v_lshlrev_b32 v12, 16, v61
v_fmac_f32 v122, v19, v12
v_and_b32 v13, 0xffff0000, v61
v_fmac_f32 v123, v19, v13
v_cvt_pk_bf16_f32 v120, v120, v121
v_cvt_pk_bf16_f32 v121, v122, v123
buffer_store_dwordx2 v[120:121], v8, s[4:7], s83 offen offset:3072 sc1
v_lshlrev_b32 v10, 16, v62
v_fmac_f32 v124, v19, v10
v_and_b32 v11, 0xffff0000, v62
v_fmac_f32 v125, v19, v11
v_lshlrev_b32 v12, 16, v63
v_fmac_f32 v126, v19, v12
v_and_b32 v13, 0xffff0000, v63
v_fmac_f32 v127, v19, v13
v_cvt_pk_bf16_f32 v124, v124, v125
v_cvt_pk_bf16_f32 v125, v126, v127
buffer_store_dwordx2 v[124:125], v8, s[4:7], s83 offen offset:3584 sc1
v_lshrrev_b32 v8, 7, v1
v_and_b32 v9, 6, v8
v_lshlrev_b32 v9, 4, v9
v_and_b32 v10, 0x70, v1
v_xor_b32 v9, v9, v10
v_mul_u32_u24 v8, 896, v8
v_add_u32 v8, v8, v9
v_accvgpr_write_b32 a184, v8
v_add_u32 v8, 6144, v8
v_accvgpr_write_b32 a185, v8
v_add_u32 v8, 6144, v8
v_accvgpr_write_b32 a186, v8
v_add_u32 v8, 6144, v8
v_accvgpr_write_b32 a187, v8
v_lshrrev_b32 v8, 6, v1
v_bfe_u32 v9, v1, 7, 2
v_lshlrev_b32 v9, 5, v9
v_lshl_add_u32 v8, v8, 7, v9
v_bfe_u32 v9, v1, 4, 2
v_lshl_add_u32 v8, v9, 3, v8
v_add_u32 v8, 32768, v8
v_accvgpr_write_b32 a188, v8
v_xor_b32 v9, 32, v8
v_accvgpr_write_b32 a189, v9
v_xor_b32 v9, 64, v8
v_accvgpr_write_b32 a190, v9
v_xor_b32 v9, 96, v8
v_accvgpr_write_b32 a191, v9
s_branch M_t2B
M_t2Br:
s_waitcnt vmcnt(8)
s_barrier
s_cmp_lg_u32 s24, 0
s_cbranch_scc1 K2_item
v_accvgpr_mov_b32 a0, a192
v_accvgpr_mov_b32 a1, a193
v_accvgpr_mov_b32 a2, a194
v_accvgpr_mov_b32 a3, a195
v_accvgpr_mov_b32 a4, a196
v_accvgpr_mov_b32 a5, a197
v_accvgpr_mov_b32 a6, a198
v_accvgpr_mov_b32 a7, a199
v_accvgpr_mov_b32 a8, a200
v_accvgpr_mov_b32 a9, a201
v_accvgpr_mov_b32 a10, a202
v_accvgpr_mov_b32 a11, a203
v_accvgpr_mov_b32 a12, a204
v_accvgpr_mov_b32 a13, a205
v_accvgpr_mov_b32 a14, a206
v_accvgpr_mov_b32 a15, a207
v_accvgpr_mov_b32 a16, a208
v_accvgpr_mov_b32 a17, a209
v_accvgpr_mov_b32 a18, a210
v_accvgpr_mov_b32 a19, a211
v_accvgpr_mov_b32 a20, a212
v_accvgpr_mov_b32 a21, a213
v_accvgpr_mov_b32 a22, a214
v_accvgpr_mov_b32 a23, a215
v_accvgpr_mov_b32 a24, a216
v_accvgpr_mov_b32 a25, a217
v_accvgpr_mov_b32 a26, a218
v_accvgpr_mov_b32 a27, a219
v_accvgpr_mov_b32 a28, a220
v_accvgpr_mov_b32 a29, a221
v_accvgpr_mov_b32 a30, a222
v_accvgpr_mov_b32 a31, a223
v_accvgpr_mov_b32 a32, a224
v_accvgpr_mov_b32 a33, a225
v_accvgpr_mov_b32 a34, a226
v_accvgpr_mov_b32 a35, a227
v_accvgpr_mov_b32 a36, a228
v_accvgpr_mov_b32 a37, a229
v_accvgpr_mov_b32 a38, a230
v_accvgpr_mov_b32 a39, a231
v_accvgpr_mov_b32 a40, a232
v_accvgpr_mov_b32 a41, a233
v_accvgpr_mov_b32 a42, a234
v_accvgpr_mov_b32 a43, a235
v_accvgpr_mov_b32 a44, a236
v_accvgpr_mov_b32 a45, a237
v_accvgpr_mov_b32 a46, a238
v_accvgpr_mov_b32 a47, a239
v_accvgpr_mov_b32 a48, a240
v_accvgpr_mov_b32 a49, a241
v_accvgpr_mov_b32 a50, a242
v_accvgpr_mov_b32 a51, a243
v_accvgpr_mov_b32 a52, a244
v_accvgpr_mov_b32 a53, a245
v_accvgpr_mov_b32 a54, a246
v_accvgpr_mov_b32 a55, a247
v_accvgpr_mov_b32 a56, a248
v_accvgpr_mov_b32 a57, a249
v_accvgpr_mov_b32 a58, a250
v_accvgpr_mov_b32 a59, a251
v_accvgpr_mov_b32 a60, a252
v_accvgpr_mov_b32 a61, a253
v_accvgpr_mov_b32 a62, a254
v_accvgpr_mov_b32 a63, a255
s_branch K2_item
M_cend:
M_cspin:
Lp_16:
buffer_load_dword v14, v15, s[4:7], s31 offen sc1
s_waitcnt vmcnt(0)
v_cmp_gt_u32 vcc, 1, v14
s_cbranch_vccz Lpd_17
s_sleep 8
s_sub_u32 s101, s101, 1
s_cbranch_scc0 Lp_16
s_mov_b32 s101, 0
Lpd_17:
s_branch M_cok
M_kspin:
Lp_18:
buffer_load_dword v21, v20, s[4:7], s70 offen sc1
s_waitcnt vmcnt(0)
v_cmp_gt_u32 vcc, 1, v21
s_cbranch_vccz Lpd_19
s_sleep 8
s_sub_u32 s101, s101, 1
s_cbranch_scc0 Lp_18
s_mov_b32 s101, 0
Lpd_19:
s_branch M_kok
M_kspin2:
Lp_20:
buffer_load_dword v21, v20, s[4:7], s31 offen sc1
s_waitcnt vmcnt(0)
v_cmp_gt_u32 vcc, 1, v21
s_cbranch_vccz Lpd_21
s_sleep 8
s_sub_u32 s101, s101, 1
s_cbranch_scc0 Lp_20
s_mov_b32 s101, 0
Lpd_21:
s_branch M_kok2
M_vspin:
Lp_22:
buffer_load_dword v21, v15, s[4:7], s70 offen sc1
s_waitcnt vmcnt(0)
v_cmp_gt_u32 vcc, 1, v21
s_cbranch_vccz Lpd_23
s_sleep 8
s_sub_u32 s101, s101, 1
s_cbranch_scc0 Lp_22
s_mov_b32 s101, 0
Lpd_23:
s_branch M_vok
PAD_32:
s_cbranch_execz M_tret
K2_plain:
v_mfma_f32_16x16x32_bf16 v[128:131], a[64:67], v[96:99], v[128:131]
s_waitcnt lgkmcnt(6)
ds_read_b128 a[96:99], v2 offset:8192
v_add_f32 v24, v24, v26
v_mfma_f32_16x16x32_bf16 v[128:131], a[68:71], v[100:103], v[128:131]
s_waitcnt lgkmcnt(5)
v_mfma_f32_16x16x32_bf16 v[132:135], a[68:71], v[108:111], v[132:135]
s_mov_b64 s[36:37], s[86:87]
ds_read_b128 a[100:103], v2 offset:9216
v_add_f32 v25, v25, v27
v_mfma_f32_16x16x32_bf16 v[132:135], a[64:67], v[104:107], v[132:135]
s_mov_b32 s38, 3670016
v_exp_f32 v8, v68
v_mfma_f32_16x16x32_bf16 v[136:139], a[72:75], v[96:99], v[136:139]
s_mov_b32 s39, 0x20000
ds_read_b128 a[104:107], v2 offset:10240
v_accvgpr_read_b32 v112, a184
v_mfma_f32_16x16x32_bf16 v[136:139], a[76:79], v[100:103], v[136:139]
v_accvgpr_read_b32 v113, a185
v_accvgpr_read_b32 v114, a186
v_mfma_f32_16x16x32_bf16 v[140:143], a[76:79], v[108:111], v[140:143]
ds_read_b128 a[108:111], v2 offset:11264
v_accvgpr_read_b32 v115, a187
v_mfma_f32_16x16x32_bf16 v[140:143], a[72:75], v[104:107], v[140:143]
s_waitcnt lgkmcnt(5)
v_accvgpr_read_b32 v116, a188
v_accvgpr_read_b32 v117, a189
v_mfma_f32_16x16x32_bf16 v[144:147], a[80:83], v[96:99], v[144:147]
ds_read_b128 a[112:115], v2 offset:12288
v_accvgpr_read_b32 v118, a190
v_mfma_f32_16x16x32_bf16 v[144:147], a[84:87], v[100:103], v[144:147]
v_accvgpr_read_b32 v119, a191
v_mfma_f32_16x16x32_bf16 v[148:151], a[84:87], v[108:111], v[148:151]
s_add_u32 m0, s18, 32768
ds_read_b128 a[116:119], v2 offset:13312
v_cvt_pk_bf16_f32 v128, v128, v129
v_mfma_f32_16x16x32_bf16 v[148:151], a[80:83], v[104:107], v[148:151]
buffer_load_dwordx4 v112, s[36:39], s81 offen offset:0 lds
v_mfma_f32_16x16x32_bf16 v[152:155], a[88:91], v[96:99], v[152:155]
s_waitcnt lgkmcnt(4)
ds_read_b128 a[120:123], v2 offset:14336
v_cvt_pk_bf16_f32 v129, v130, v131
v_mfma_f32_16x16x32_bf16 v[152:155], a[92:95], v[100:103], v[152:155]
v_exp_f32 v9, v69
v_mfma_f32_16x16x32_bf16 v[156:159], a[92:95], v[108:111], v[156:159]
ds_read_b128 a[124:127], v2 offset:15360
v_add_f32 v27, v8, v9
v_mfma_f32_16x16x32_bf16 v[156:159], a[88:91], v[104:107], v[156:159]
buffer_load_dwordx4 v113, s[36:39], s81 offen offset:1024 lds
v_mfma_f32_16x16x32_bf16 v[160:163], a[96:99], v[96:99], v[160:163]
ds_read_b128 a[64:67], v2 offset:16384
v_cvt_pk_bf16_f32 v120, v8, v9
v_mfma_f32_16x16x32_bf16 v[160:163], a[100:103], v[100:103], v[160:163]
v_exp_f32 v10, v70
v_mfma_f32_16x16x32_bf16 v[164:167], a[100:103], v[108:111], v[164:167]
ds_read_b128 a[68:71], v2 offset:17408
v_add_f32 v27, v27, v10
v_mfma_f32_16x16x32_bf16 v[164:167], a[96:99], v[104:107], v[164:167]
s_waitcnt lgkmcnt(4)
buffer_load_dwordx4 v114, s[36:39], s81 offen offset:2048 lds
v_mfma_f32_16x16x32_bf16 v[168:171], a[104:107], v[96:99], v[168:171]
ds_read_b128 a[72:75], v2 offset:18432
v_cvt_pk_bf16_f32 v130, v136, v137
v_mfma_f32_16x16x32_bf16 v[168:171], a[108:111], v[100:103], v[168:171]
v_exp_f32 v11, v71
v_mfma_f32_16x16x32_bf16 v[172:175], a[108:111], v[108:111], v[172:175]
ds_read_b128 a[76:79], v2 offset:19456
v_add_f32 v27, v27, v11
v_mfma_f32_16x16x32_bf16 v[172:175], a[104:107], v[104:107], v[172:175]
buffer_load_dwordx4 v115, s[36:39], s81 offen offset:3072 lds
v_mfma_f32_16x16x32_bf16 v[176:179], a[112:115], v[96:99], v[176:179]
ds_read_b128 a[80:83], v2 offset:20480
v_cvt_pk_bf16_f32 v121, v10, v11
v_mfma_f32_16x16x32_bf16 v[176:179], a[116:119], v[100:103], v[176:179]
s_waitcnt lgkmcnt(4)
v_exp_f32 v12, v76
v_mfma_f32_16x16x32_bf16 v[180:183], a[116:119], v[108:111], v[180:183]
s_add_u32 s81, s81, 28672
ds_read_b128 a[84:87], v2 offset:21504
v_add_f32 v27, v27, v12
v_mfma_f32_16x16x32_bf16 v[180:183], a[112:115], v[104:107], v[180:183]
s_add_u32 m0, s18, 36864
v_exp_f32 v13, v77
v_mfma_f32_16x16x32_bf16 v[184:187], a[120:123], v[96:99], v[184:187]
ds_read_b128 a[88:91], v2 offset:22528
v_add_f32 v27, v27, v13
v_mfma_f32_16x16x32_bf16 v[184:187], a[124:127], v[100:103], v[184:187]
buffer_load_dwordx4 v112, s[36:39], s81 offen offset:0 lds
v_mfma_f32_16x16x32_bf16 v[188:191], a[124:127], v[108:111], v[188:191]
ds_read_b128 a[92:95], v2 offset:23552
v_cvt_pk_bf16_f32 v122, v12, v13
v_mfma_f32_16x16x32_bf16 v[188:191], a[120:123], v[104:107], v[188:191]
v_exp_f32 v14, v78
v_mfma_f32_16x16x32_bf16 v[192:195], a[64:67], v[96:99], v[192:195]
s_waitcnt lgkmcnt(4)
ds_read_b128 a[96:99], v2 offset:24576
v_add_f32 v27, v27, v14
v_mfma_f32_16x16x32_bf16 v[192:195], a[68:71], v[100:103], v[192:195]
buffer_load_dwordx4 v113, s[36:39], s81 offen offset:1024 lds
v_mfma_f32_16x16x32_bf16 v[196:199], a[68:71], v[108:111], v[196:199]
ds_read_b128 a[100:103], v2 offset:25600
v_cvt_pk_bf16_f32 v131, v138, v139
v_mfma_f32_16x16x32_bf16 v[196:199], a[64:67], v[104:107], v[196:199]
v_exp_f32 v15, v79
v_mfma_f32_16x16x32_bf16 v[200:203], a[72:75], v[96:99], v[200:203]
ds_read_b128 a[104:107], v2 offset:26624
v_add_f32 v27, v27, v15
v_mfma_f32_16x16x32_bf16 v[200:203], a[76:79], v[100:103], v[200:203]
buffer_load_dwordx4 v114, s[36:39], s81 offen offset:2048 lds
v_mfma_f32_16x16x32_bf16 v[204:207], a[76:79], v[108:111], v[204:207]
ds_read_b128 a[108:111], v2 offset:27648
v_cvt_pk_bf16_f32 v123, v14, v15
v_mfma_f32_16x16x32_bf16 v[204:207], a[72:75], v[104:107], v[204:207]
s_waitcnt lgkmcnt(4)
v_exp_f32 v8, v84
v_mfma_f32_16x16x32_bf16 v[208:211], a[80:83], v[96:99], v[208:211]
ds_read_b128 a[112:115], v2 offset:28672
v_add_f32 v27, v27, v8
v_mfma_f32_16x16x32_bf16 v[208:211], a[84:87], v[100:103], v[208:211]
buffer_load_dwordx4 v115, s[36:39], s81 offen offset:3072 lds
v_mfma_f32_16x16x32_bf16 v[212:215], a[84:87], v[108:111], v[212:215]
ds_read_b128 a[116:119], v2 offset:29696
v_cvt_pk_bf16_f32 v144, v144, v145
v_mfma_f32_16x16x32_bf16 v[212:215], a[80:83], v[104:107], v[212:215]
v_exp_f32 v9, v85
v_mfma_f32_16x16x32_bf16 v[216:219], a[88:91], v[96:99], v[216:219]
s_sub_u32 s81, s81, 28544
ds_read_b128 a[120:123], v2 offset:30720
v_add_f32 v27, v27, v9
v_mfma_f32_16x16x32_bf16 v[216:219], a[92:95], v[100:103], v[216:219]
v_exp_f32 v10, v86
v_mfma_f32_16x16x32_bf16 v[220:223], a[92:95], v[108:111], v[220:223]
s_waitcnt vmcnt(8) lgkmcnt(4)
ds_read_b128 a[124:127], v2 offset:31744
v_cvt_pk_bf16_f32 v124, v8, v9
v_mfma_f32_16x16x32_bf16 v[220:223], a[88:91], v[104:107], v[220:223]
s_barrier
v_mfma_f32_16x16x32_bf16 v[224:227], a[96:99], v[96:99], v[224:227]
ds_read_b128 a[64:67], v1 offset:0
v_add_f32 v27, v27, v10
v_mfma_f32_16x16x32_bf16 v[224:227], a[100:103], v[100:103], v[224:227]
v_exp_f32 v11, v87
v_mfma_f32_16x16x32_bf16 v[228:231], a[100:103], v[108:111], v[228:231]
ds_read_b128 a[68:71], v1 offset:1024
v_add_f32 v27, v27, v11
v_mfma_f32_16x16x32_bf16 v[228:231], a[96:99], v[104:107], v[228:231]
v_exp_f32 v12, v92
v_mfma_f32_16x16x32_bf16 v[232:235], a[104:107], v[96:99], v[232:235]
s_waitcnt lgkmcnt(4)
ds_read_b128 a[72:75], v1 offset:2048
v_cvt_pk_bf16_f32 v125, v10, v11
v_mfma_f32_16x16x32_bf16 v[232:235], a[108:111], v[100:103], v[232:235]
v_exp_f32 v13, v93
v_mfma_f32_16x16x32_bf16 v[236:239], a[108:111], v[108:111], v[236:239]
ds_read_b128 a[76:79], v1 offset:3072
v_add_f32 v27, v27, v12
v_mfma_f32_16x16x32_bf16 v[236:239], a[104:107], v[104:107], v[236:239]
v_exp_f32 v14, v94
v_mfma_f32_16x16x32_bf16 v[240:243], a[112:115], v[96:99], v[240:243]
ds_read_b128 a[80:83], v1 offset:4096
v_add_f32 v27, v27, v13
v_mfma_f32_16x16x32_bf16 v[240:243], a[116:119], v[100:103], v[240:243]
v_exp_f32 v15, v95
v_mfma_f32_16x16x32_bf16 v[244:247], a[116:119], v[108:111], v[244:247]
ds_read_b128 a[84:87], v1 offset:5120
v_cvt_pk_bf16_f32 v126, v12, v13
v_mfma_f32_16x16x32_bf16 v[244:247], a[112:115], v[104:107], v[244:247]
s_waitcnt lgkmcnt(4)
v_add_f32 v27, v27, v14
v_add_f32 v27, v27, v15
v_mfma_f32_16x16x32_bf16 v[248:251], a[120:123], v[96:99], v[248:251]
ds_read_b128 a[88:91], v1 offset:6144
v_cvt_pk_bf16_f32 v127, v14, v15
v_mfma_f32_16x16x32_bf16 v[248:251], a[124:127], v[100:103], v[248:251]
v_cmp_nge_f32 vcc, s25, v27
v_cvt_pk_bf16_f32 v145, v146, v147
v_mfma_f32_16x16x32_bf16 v[252:255], a[124:127], v[108:111], v[252:255]
ds_read_b128 a[92:95], v1 offset:7168
v_cvt_pk_bf16_f32 v146, v152, v153
v_mfma_f32_16x16x32_bf16 v[252:255], a[120:123], v[104:107], v[252:255]
s_waitcnt lgkmcnt(2)
v_cvt_pk_bf16_f32 v147, v154, v155
v_cvt_pk_bf16_f32 v160, v160, v161
s_cbranch_vccnz Lstub_12
Lback_13:
v_mfma_f32_16x16x32_bf16 v[132:135], a[64:67], v[120:123], v[132:135]
s_lshl_b32 s8, s29, 3
ds_read_b128 a[96:99], v1 offset:8192
v_add_f32 v25, v25, v27
v_mfma_f32_16x16x32_bf16 v[132:135], a[68:71], v[124:127], v[132:135]
s_add_u32 s8, s8, s3
ds_read_b128 a[100:103], v1 offset:9216
v_cvt_pk_bf16_f32 v161, v162, v163
v_mfma_f32_16x16x32_bf16 v[140:143], a[72:75], v[120:123], v[140:143]
s_lshl_b32 s8, s8, 4
ds_read_b128 a[104:107], v1 offset:10240
v_cvt_pk_bf16_f32 v162, v168, v169
v_mfma_f32_16x16x32_bf16 v[140:143], a[76:79], v[124:127], v[140:143]
s_add_u32 s8, s8, s20
ds_read_b128 a[108:111], v1 offset:11264
v_cvt_pk_bf16_f32 v163, v170, v171
v_mfma_f32_16x16x32_bf16 v[148:151], a[80:83], v[120:123], v[148:151]
s_mul_i32 s8, s8, 14336
ds_read_b128 a[112:115], v1 offset:12288
v_cvt_pk_bf16_f32 v176, v176, v177
v_mfma_f32_16x16x32_bf16 v[148:151], a[84:87], v[124:127], v[148:151]
s_waitcnt lgkmcnt(5)
s_add_u32 s8, s8, 104857600
ds_read_b128 a[116:119], v1 offset:13312
v_cvt_pk_bf16_f32 v177, v178, v179
v_mfma_f32_16x16x32_bf16 v[156:159], a[88:91], v[120:123], v[156:159]
s_add_u32 s12, s8, 917504
ds_read_b128 a[120:123], v1 offset:14336
v_cvt_pk_bf16_f32 v178, v184, v185
v_mfma_f32_16x16x32_bf16 v[156:159], a[92:95], v[124:127], v[156:159]
s_waitcnt lgkmcnt(6)
ds_read_b128 a[124:127], v1 offset:15360
v_cvt_pk_bf16_f32 v179, v186, v187
v_mfma_f32_16x16x32_bf16 v[164:167], a[96:99], v[120:123], v[164:167]
s_waitcnt lgkmcnt(6)
ds_read_b128 a[64:67], v1 offset:16384
v_cvt_pk_bf16_f32 v192, v192, v193
v_mfma_f32_16x16x32_bf16 v[164:167], a[100:103], v[124:127], v[164:167]
s_waitcnt lgkmcnt(6)
ds_read_b128 a[68:71], v1 offset:17408
v_cvt_pk_bf16_f32 v193, v194, v195
v_mfma_f32_16x16x32_bf16 v[172:175], a[104:107], v[120:123], v[172:175]
s_waitcnt lgkmcnt(6)
ds_read_b128 a[72:75], v1 offset:18432
v_cvt_pk_bf16_f32 v194, v200, v201
v_mfma_f32_16x16x32_bf16 v[172:175], a[108:111], v[124:127], v[172:175]
s_waitcnt lgkmcnt(6)
ds_read_b128 a[76:79], v1 offset:19456
v_cvt_pk_bf16_f32 v195, v202, v203
v_mfma_f32_16x16x32_bf16 v[180:183], a[112:115], v[120:123], v[180:183]
s_waitcnt lgkmcnt(6)
ds_read_b128 a[80:83], v1 offset:20480
v_cvt_pk_bf16_f32 v208, v208, v209
v_mfma_f32_16x16x32_bf16 v[180:183], a[116:119], v[124:127], v[180:183]
s_waitcnt lgkmcnt(6)
ds_read_b128 a[84:87], v1 offset:21504
v_cvt_pk_bf16_f32 v209, v210, v211
v_mfma_f32_16x16x32_bf16 v[188:191], a[120:123], v[120:123], v[188:191]
s_waitcnt lgkmcnt(6)
ds_read_b128 a[88:91], v1 offset:22528
v_cvt_pk_bf16_f32 v210, v216, v217
v_mfma_f32_16x16x32_bf16 v[188:191], a[124:127], v[124:127], v[188:191]
s_waitcnt lgkmcnt(6)
ds_read_b128 a[92:95], v1 offset:23552
v_cvt_pk_bf16_f32 v211, v218, v219
v_mfma_f32_16x16x32_bf16 v[196:199], a[64:67], v[120:123], v[196:199]
s_waitcnt lgkmcnt(6)
ds_read_b128 a[96:99], v1 offset:24576
v_cvt_pk_bf16_f32 v224, v224, v225
v_mfma_f32_16x16x32_bf16 v[196:199], a[68:71], v[124:127], v[196:199]
s_waitcnt lgkmcnt(6)
ds_read_b128 a[100:103], v1 offset:25600
v_cvt_pk_bf16_f32 v225, v226, v227
v_mfma_f32_16x16x32_bf16 v[204:207], a[72:75], v[120:123], v[204:207]
s_waitcnt lgkmcnt(6)
ds_read_b128 a[104:107], v1 offset:26624
v_cvt_pk_bf16_f32 v226, v232, v233
v_mfma_f32_16x16x32_bf16 v[204:207], a[76:79], v[124:127], v[204:207]
s_waitcnt lgkmcnt(6)
ds_read_b128 a[108:111], v1 offset:27648
v_cvt_pk_bf16_f32 v227, v234, v235
v_mfma_f32_16x16x32_bf16 v[212:215], a[80:83], v[120:123], v[212:215]
s_waitcnt lgkmcnt(6)
ds_read_b128 a[112:115], v1 offset:28672
v_cvt_pk_bf16_f32 v240, v240, v241
v_mfma_f32_16x16x32_bf16 v[212:215], a[84:87], v[124:127], v[212:215]
s_waitcnt lgkmcnt(5)
ds_read_b128 a[116:119], v1 offset:29696
v_cvt_pk_bf16_f32 v241, v242, v243
v_mfma_f32_16x16x32_bf16 v[220:223], a[88:91], v[120:123], v[220:223]
s_add_u32 m0, s18, 98304
ds_read_b128 a[120:123], v1 offset:30720
v_cvt_pk_bf16_f32 v242, v248, v249
v_mfma_f32_16x16x32_bf16 v[220:223], a[92:95], v[124:127], v[220:223]
s_waitcnt lgkmcnt(6)
ds_read_b128 a[124:127], v1 offset:31744
v_cvt_pk_bf16_f32 v243, v250, v251
v_mfma_f32_16x16x32_bf16 v[228:231], a[96:99], v[120:123], v[228:231]
s_waitcnt lgkmcnt(6)
buffer_load_dwordx4 v112, s[36:39], s81 offen offset:0 lds
v_mfma_f32_16x16x32_bf16 v[228:231], a[100:103], v[124:127], v[228:231]
s_waitcnt lgkmcnt(5)
buffer_load_dwordx4 v113, s[36:39], s81 offen offset:1024 lds
v_mfma_f32_16x16x32_bf16 v[236:239], a[104:107], v[120:123], v[236:239]
s_waitcnt lgkmcnt(4)
buffer_load_dwordx4 v114, s[36:39], s81 offen offset:2048 lds
v_mfma_f32_16x16x32_bf16 v[236:239], a[108:111], v[124:127], v[236:239]
s_waitcnt lgkmcnt(1)
buffer_load_dwordx4 v115, s[36:39], s81 offen offset:3072 lds
v_mfma_f32_16x16x32_bf16 v[244:247], a[112:115], v[120:123], v[244:247]
s_add_u32 s81, s81, 28672
v_cvt_pk_bf16_f32 v132, v132, v133
v_cvt_pk_bf16_f32 v133, v134, v135
v_mfma_f32_16x16x32_bf16 v[244:247], a[116:119], v[124:127], v[244:247]
s_add_u32 m0, s18, 102400
v_cvt_pk_bf16_f32 v134, v140, v141
v_cvt_pk_bf16_f32 v135, v142, v143
v_mfma_f32_16x16x32_bf16 v[252:255], a[120:123], v[120:123], v[252:255]
s_waitcnt lgkmcnt(0)
buffer_load_dwordx4 v112, s[36:39], s81 offen offset:0 lds
v_mfma_f32_16x16x32_bf16 v[252:255], a[124:127], v[124:127], v[252:255]
buffer_load_dwordx4 v113, s[36:39], s81 offen offset:1024 lds
buffer_load_dwordx4 v114, s[36:39], s81 offen offset:2048 lds
buffer_load_dwordx4 v115, s[36:39], s81 offen offset:3072 lds
s_sub_u32 s81, s81, 28544
s_add_u32 m0, s18, 131072
s_nop 0
buffer_load_dwordx4 v112, s[36:39], s81 offen offset:0 lds
v_cvt_pk_bf16_f32 v148, v148, v149
v_cvt_pk_bf16_f32 v149, v150, v151
v_cvt_pk_bf16_f32 v150, v156, v157
v_cvt_pk_bf16_f32 v151, v158, v159
buffer_load_dwordx4 v113, s[36:39], s81 offen offset:1024 lds
v_cvt_pk_bf16_f32 v164, v164, v165
v_cvt_pk_bf16_f32 v165, v166, v167
v_cvt_pk_bf16_f32 v166, v172, v173
v_cvt_pk_bf16_f32 v167, v174, v175
buffer_load_dwordx4 v114, s[36:39], s81 offen offset:2048 lds
v_cvt_pk_bf16_f32 v180, v180, v181
v_cvt_pk_bf16_f32 v181, v182, v183
v_cvt_pk_bf16_f32 v182, v188, v189
v_cvt_pk_bf16_f32 v183, v190, v191
buffer_load_dwordx4 v115, s[36:39], s81 offen offset:3072 lds
v_cvt_pk_bf16_f32 v196, v196, v197
v_cvt_pk_bf16_f32 v197, v198, v199
v_cvt_pk_bf16_f32 v198, v204, v205
v_cvt_pk_bf16_f32 v199, v206, v207
s_add_u32 s81, s81, 28672
s_add_u32 m0, s18, 135168
s_nop 0
buffer_load_dwordx4 v112, s[36:39], s81 offen offset:0 lds
v_cvt_pk_bf16_f32 v212, v212, v213
v_cvt_pk_bf16_f32 v213, v214, v215
v_cvt_pk_bf16_f32 v214, v220, v221
v_cvt_pk_bf16_f32 v215, v222, v223
buffer_load_dwordx4 v113, s[36:39], s81 offen offset:1024 lds
v_cvt_pk_bf16_f32 v228, v228, v229
v_cvt_pk_bf16_f32 v229, v230, v231
v_cvt_pk_bf16_f32 v230, v236, v237
v_cvt_pk_bf16_f32 v231, v238, v239
buffer_load_dwordx4 v114, s[36:39], s81 offen offset:2048 lds
v_cvt_pk_bf16_f32 v244, v244, v245
v_cvt_pk_bf16_f32 v245, v246, v247
v_cvt_pk_bf16_f32 v246, v252, v253
v_cvt_pk_bf16_f32 v247, v254, v255
buffer_load_dwordx4 v115, s[36:39], s81 offen offset:3072 lds
s_sub_u32 s81, s81, 28544
s_branch K2_done
K2_cfix:
s_nop 7
v_max_f32 v12, 0, v8
v_exp_f32 v13, -v12
v_sub_f32 v8, v8, v12
v_mul_f32 v24, v24, v13
v_mul_f32 v128, v128, v13
v_mul_f32 v129, v129, v13
v_mul_f32 v130, v130, v13
v_mul_f32 v131, v131, v13
v_mul_f32 v136, v136, v13
v_mul_f32 v137, v137, v13
v_mul_f32 v138, v138, v13
v_mul_f32 v139, v139, v13
v_mul_f32 v144, v144, v13
v_mul_f32 v145, v145, v13
v_mul_f32 v146, v146, v13
v_mul_f32 v147, v147, v13
v_mul_f32 v152, v152, v13
v_mul_f32 v153, v153, v13
v_mul_f32 v154, v154, v13
v_mul_f32 v155, v155, v13
v_mul_f32 v160, v160, v13
v_mul_f32 v161, v161, v13
v_mul_f32 v162, v162, v13
v_mul_f32 v163, v163, v13
v_mul_f32 v168, v168, v13
v_mul_f32 v169, v169, v13
v_mul_f32 v170, v170, v13
v_mul_f32 v171, v171, v13
v_mul_f32 v176, v176, v13
v_mul_f32 v177, v177, v13
v_mul_f32 v178, v178, v13
v_mul_f32 v179, v179, v13
v_mul_f32 v184, v184, v13
v_mul_f32 v185, v185, v13
v_mul_f32 v186, v186, v13
v_mul_f32 v187, v187, v13
v_mul_f32 v192, v192, v13
v_mul_f32 v193, v193, v13
v_mul_f32 v194, v194, v13
v_mul_f32 v195, v195, v13
v_mul_f32 v200, v200, v13
v_mul_f32 v201, v201, v13
v_mul_f32 v202, v202, v13
v_mul_f32 v203, v203, v13
v_mul_f32 v208, v208, v13
v_mul_f32 v209, v209, v13
v_mul_f32 v210, v210, v13
v_mul_f32 v211, v211, v13
v_mul_f32 v216, v216, v13
v_mul_f32 v217, v217, v13
v_mul_f32 v218, v218, v13
v_mul_f32 v219, v219, v13
v_mul_f32 v224, v224, v13
v_mul_f32 v225, v225, v13
v_mul_f32 v226, v226, v13
v_mul_f32 v227, v227, v13
v_mul_f32 v232, v232, v13
v_mul_f32 v233, v233, v13
v_mul_f32 v234, v234, v13
v_mul_f32 v235, v235, v13
v_mul_f32 v240, v240, v13
v_mul_f32 v241, v241, v13
v_mul_f32 v242, v242, v13
v_mul_f32 v243, v243, v13
v_mul_f32 v248, v248, v13
v_mul_f32 v249, v249, v13
v_mul_f32 v250, v250, v13
v_mul_f32 v251, v251, v13
v_max_f32 v12, 0, v10
v_exp_f32 v13, -v12
v_sub_f32 v10, v10, v12
v_mul_f32 v25, v25, v13
v_mul_f32 v132, v132, v13
v_mul_f32 v133, v133, v13
v_mul_f32 v134, v134, v13
v_mul_f32 v135, v135, v13
v_mul_f32 v140, v140, v13
v_mul_f32 v141, v141, v13
v_mul_f32 v142, v142, v13
v_mul_f32 v143, v143, v13
v_mul_f32 v148, v148, v13
v_mul_f32 v149, v149, v13
v_mul_f32 v150, v150, v13
v_mul_f32 v151, v151, v13
v_mul_f32 v156, v156, v13
v_mul_f32 v157, v157, v13
v_mul_f32 v158, v158, v13
v_mul_f32 v159, v159, v13
v_mul_f32 v164, v164, v13
v_mul_f32 v165, v165, v13
v_mul_f32 v166, v166, v13
v_mul_f32 v167, v167, v13
v_mul_f32 v172, v172, v13
v_mul_f32 v173, v173, v13
v_mul_f32 v174, v174, v13
v_mul_f32 v175, v175, v13
v_mul_f32 v180, v180, v13
v_mul_f32 v181, v181, v13
v_mul_f32 v182, v182, v13
v_mul_f32 v183, v183, v13
v_mul_f32 v188, v188, v13
v_mul_f32 v189, v189, v13
v_mul_f32 v190, v190, v13
v_mul_f32 v191, v191, v13
v_mul_f32 v196, v196, v13
v_mul_f32 v197, v197, v13
v_mul_f32 v198, v198, v13
v_mul_f32 v199, v199, v13
v_mul_f32 v204, v204, v13
v_mul_f32 v205, v205, v13
v_mul_f32 v206, v206, v13
v_mul_f32 v207, v207, v13
v_mul_f32 v212, v212, v13
v_mul_f32 v213, v213, v13
v_mul_f32 v214, v214, v13
v_mul_f32 v215, v215, v13
v_mul_f32 v220, v220, v13
v_mul_f32 v221, v221, v13
v_mul_f32 v222, v222, v13
v_mul_f32 v223, v223, v13
v_mul_f32 v228, v228, v13
v_mul_f32 v229, v229, v13
v_mul_f32 v230, v230, v13
v_mul_f32 v231, v231, v13
v_mul_f32 v236, v236, v13
v_mul_f32 v237, v237, v13
v_mul_f32 v238, v238, v13
v_mul_f32 v239, v239, v13
v_mul_f32 v244, v244, v13
v_mul_f32 v245, v245, v13
v_mul_f32 v246, v246, v13
v_mul_f32 v247, v247, v13
v_mul_f32 v252, v252, v13
v_mul_f32 v253, v253, v13
v_mul_f32 v254, v254, v13
v_mul_f32 v255, v255, v13
s_branch K2_cok
K2_tspin:
Lp_9101:
buffer_load_dword v3, off, s[4:7], s80 sc1
s_waitcnt vmcnt(0)
v_cmp_gt_u32 vcc, 1, v3
s_cbranch_vccz Lpd_9102
s_sleep 8
s_sub_u32 s101, s101, 1
s_cbranch_scc0 Lp_9101
s_mov_b32 s101, 0
Lpd_9102:
s_branch K2_tok
K2_p0d:
ds_read_b128 a[64:67], v1 offset:0
ds_read_b128 a[68:71], v1 offset:1024
ds_read_b128 a[72:75], v1 offset:2048
ds_read_b128 a[76:79], v1 offset:3072
ds_read_b128 a[80:83], v1 offset:4096
ds_read_b128 a[84:87], v1 offset:5120
ds_read_b128 a[88:91], v1 offset:6144
ds_read_b128 a[92:95], v1 offset:7168
v_cndmask_b32 v32, 0, v7, s[32:33]
v_cndmask_b32 v33, 0, v7, s[34:35]
v_cndmask_b32 v34, 0, v7, s[36:37]
v_cndmask_b32 v35, 0, v7, s[38:39]
v_cndmask_b32 v40, 0, v7, s[40:41]
v_cndmask_b32 v41, 0, v7, s[42:43]
v_cndmask_b32 v42, 0, v7, s[44:45]
v_cndmask_b32 v43, 0, v7, s[46:47]
s_waitcnt lgkmcnt(7)
v_mfma_f32_16x16x32_bf16 v[32:35], a[64:67], a[0:3], v[32:35]
s_waitcnt lgkmcnt(6)
s_add_u32 m0, s18, 65536
ds_read_b128 a[96:99], v1 offset:8192
v_mfma_f32_16x16x32_bf16 v[32:35], a[68:71], a[4:7], v[32:35]
s_waitcnt lgkmcnt(6)
buffer_load_dwordx4 v1, s[4:7], s12 offen offset:0 sc1 lds
v_mfma_f32_16x16x32_bf16 v[32:35], a[72:75], a[8:11], v[32:35]
s_waitcnt lgkmcnt(5)
ds_read_b128 a[100:103], v1 offset:9216
v_mfma_f32_16x16x32_bf16 v[32:35], a[76:79], a[12:15], v[32:35]
s_waitcnt lgkmcnt(5)
buffer_load_dwordx4 v1, s[4:7], s12 offen offset:1024 sc1 lds
v_mfma_f32_16x16x32_bf16 v[32:35], a[80:83], a[16:19], v[32:35]
s_waitcnt lgkmcnt(4)
ds_read_b128 a[104:107], v1 offset:10240
v_mfma_f32_16x16x32_bf16 v[32:35], a[84:87], a[20:23], v[32:35]
s_waitcnt lgkmcnt(4)
buffer_load_dwordx4 v1, s[4:7], s12 offen offset:2048 sc1 lds
v_mfma_f32_16x16x32_bf16 v[32:35], a[88:91], a[24:27], v[32:35]
s_waitcnt lgkmcnt(3)
ds_read_b128 a[108:111], v1 offset:11264
v_mfma_f32_16x16x32_bf16 v[32:35], a[92:95], a[28:31], v[32:35]
buffer_load_dwordx4 v1, s[4:7], s12 offen offset:3072 sc1 lds
v_mfma_f32_16x16x32_bf16 v[36:39], a[64:67], a[32:35], 0
s_add_u32 s12, s12, 4096
s_add_u32 m0, s18, 69632
ds_read_b128 a[112:115], v1 offset:12288
v_mfma_f32_16x16x32_bf16 v[36:39], a[68:71], a[36:39], v[36:39]
buffer_load_dwordx4 v1, s[4:7], s12 offen offset:0 sc1 lds
v_mfma_f32_16x16x32_bf16 v[36:39], a[72:75], a[40:43], v[36:39]
ds_read_b128 a[116:119], v1 offset:13312
v_mfma_f32_16x16x32_bf16 v[36:39], a[76:79], a[44:47], v[36:39]
buffer_load_dwordx4 v1, s[4:7], s12 offen offset:1024 sc1 lds
v_mfma_f32_16x16x32_bf16 v[36:39], a[80:83], a[48:51], v[36:39]
ds_read_b128 a[120:123], v1 offset:14336
v_max3_f32 v28, v32, v33, v34
v_mfma_f32_16x16x32_bf16 v[36:39], a[84:87], a[52:55], v[36:39]
buffer_load_dwordx4 v1, s[4:7], s12 offen offset:2048 sc1 lds
v_mfma_f32_16x16x32_bf16 v[36:39], a[88:91], a[56:59], v[36:39]
ds_read_b128 a[124:127], v1 offset:15360
v_max_f32 v28, v28, v35
v_mfma_f32_16x16x32_bf16 v[36:39], a[92:95], a[60:63], v[36:39]
s_waitcnt lgkmcnt(4)
buffer_load_dwordx4 v1, s[4:7], s12 offen offset:3072 sc1 lds
v_mfma_f32_16x16x32_bf16 v[40:43], a[96:99], a[0:3], v[40:43]
s_add_u32 s12, s12, 28672
ds_read_b128 a[64:67], v1 offset:16384
v_mov_b32 v30, v28
v_mfma_f32_16x16x32_bf16 v[40:43], a[100:103], a[4:7], v[40:43]
s_waitcnt lgkmcnt(2)
s_sub_u32 s13, s13, 1
v_mfma_f32_16x16x32_bf16 v[40:43], a[104:107], a[8:11], v[40:43]
s_cmp_eq_u32 s13, 0
ds_read_b128 a[68:71], v1 offset:17408
v_permlane16_swap_b32 v28, v30
v_mfma_f32_16x16x32_bf16 v[40:43], a[108:111], a[12:15], v[40:43]
s_cselect_b32 s12, s14, s12
v_max_f32 v28, v28, v30
v_mov_b32 v30, v28
v_mfma_f32_16x16x32_bf16 v[40:43], a[112:115], a[16:19], v[40:43]
s_cselect_b32 s13, s15, s13
ds_read_b128 a[72:75], v1 offset:18432
v_max3_f32 v29, v36, v37, v38
v_mfma_f32_16x16x32_bf16 v[40:43], a[116:119], a[20:23], v[40:43]
s_cselect_b32 s14, 3221225472, s14
v_permlane32_swap_b32 v28, v30
v_max_f32 v28, v28, v30
v_mfma_f32_16x16x32_bf16 v[40:43], a[120:123], a[24:27], v[40:43]
s_waitcnt lgkmcnt(3)
ds_read_b128 a[76:79], v1 offset:19456
v_sub_f32 v16, 0, v28
v_mfma_f32_16x16x32_bf16 v[40:43], a[124:127], a[28:31], v[40:43]
v_sub_f32 v17, 0, v28
v_sub_f32 v18, 0, v28
v_mfma_f32_16x16x32_bf16 v[44:47], a[96:99], a[32:35], 0
ds_read_b128 a[80:83], v1 offset:20480
v_sub_f32 v19, 0, v28
v_mfma_f32_16x16x32_bf16 v[44:47], a[100:103], a[36:39], v[44:47]
v_max_f32 v29, v29, v39
v_mov_b32 v31, v29
v_cndmask_b32 v48, v16, v7, s[48:49]
v_mfma_f32_16x16x32_bf16 v[44:47], a[104:107], a[40:43], v[44:47]
ds_read_b128 a[84:87], v1 offset:21504
v_cndmask_b32 v49, v16, v7, s[50:51]
v_mfma_f32_16x16x32_bf16 v[44:47], a[108:111], a[44:47], v[44:47]
v_permlane16_swap_b32 v29, v31
v_max_f32 v29, v29, v31
v_cndmask_b32 v50, v16, v7, s[52:53]
v_mfma_f32_16x16x32_bf16 v[44:47], a[112:115], a[48:51], v[44:47]
ds_read_b128 a[88:91], v1 offset:22528
v_mov_b32 v31, v29
v_cndmask_b32 v51, v16, v7, s[54:55]
v_mfma_f32_16x16x32_bf16 v[44:47], a[116:119], a[52:55], v[44:47]
v_cndmask_b32 v56, v16, v7, s[56:57]
v_cndmask_b32 v57, v16, v7, s[58:59]
v_mfma_f32_16x16x32_bf16 v[44:47], a[120:123], a[56:59], v[44:47]
ds_read_b128 a[92:95], v1 offset:23552
v_permlane32_swap_b32 v29, v31
v_mfma_f32_16x16x32_bf16 v[44:47], a[124:127], a[60:63], v[44:47]
s_waitcnt lgkmcnt(4)
v_max_f32 v29, v29, v31
v_sub_f32 v20, 0, v29
v_mfma_f32_16x16x32_bf16 v[48:51], a[64:67], a[0:3], v[48:51]
ds_read_b128 a[96:99], v1 offset:24576
v_sub_f32 v21, 0, v29
v_mfma_f32_16x16x32_bf16 v[48:51], a[68:71], a[4:7], v[48:51]
v_sub_f32 v22, 0, v29
v_sub_f32 v23, 0, v29
v_mfma_f32_16x16x32_bf16 v[48:51], a[72:75], a[8:11], v[48:51]
ds_read_b128 a[100:103], v1 offset:25600
v_cndmask_b32 v58, v16, v7, s[60:61]
v_mfma_f32_16x16x32_bf16 v[48:51], a[76:79], a[12:15], v[48:51]
s_waitcnt lgkmcnt(4)
v_cndmask_b32 v59, v16, v7, s[62:63]
v_mfma_f32_16x16x32_bf16 v[48:51], a[80:83], a[16:19], v[48:51]
ds_read_b128 a[104:107], v1 offset:26624
v_mfma_f32_16x16x32_bf16 v[48:51], a[84:87], a[20:23], v[48:51]
s_waitcnt lgkmcnt(4)
v_add_f32 v32, v32, v16
v_add_f32 v33, v33, v16
v_add_f32 v34, v34, v16
v_add_f32 v35, v35, v16
v_mfma_f32_16x16x32_bf16 v[48:51], a[88:91], a[24:27], v[48:51]
s_waitcnt lgkmcnt(3)
ds_read_b128 a[108:111], v1 offset:27648
v_add_f32 v36, v36, v20
v_add_f32 v37, v37, v20
v_add_f32 v38, v38, v20
v_add_f32 v39, v39, v20
v_mfma_f32_16x16x32_bf16 v[48:51], a[92:95], a[28:31], v[48:51]
v_add_f32 v40, v40, v16
v_add_f32 v41, v41, v16
v_add_f32 v42, v42, v16
v_add_f32 v43, v43, v16
v_mfma_f32_16x16x32_bf16 v[52:55], a[64:67], a[32:35], v[20:23]
ds_read_b128 a[112:115], v1 offset:28672
v_add_f32 v44, v44, v20
v_add_f32 v45, v45, v20
v_add_f32 v46, v46, v20
v_add_f32 v47, v47, v20
v_mfma_f32_16x16x32_bf16 v[52:55], a[68:71], a[36:39], v[52:55]
v_exp_f32 v8, v32
v_mfma_f32_16x16x32_bf16 v[52:55], a[72:75], a[40:43], v[52:55]
ds_read_b128 a[116:119], v1 offset:29696
v_exp_f32 v9, v33
v_mfma_f32_16x16x32_bf16 v[52:55], a[76:79], a[44:47], v[52:55]
v_exp_f32 v10, v34
v_add_f32 v26, v8, v9
v_cvt_pk_bf16_f32 v96, v8, v9
v_mfma_f32_16x16x32_bf16 v[52:55], a[80:83], a[48:51], v[52:55]
ds_read_b128 a[120:123], v1 offset:30720
v_exp_f32 v11, v35
v_add_f32 v26, v26, v10
v_mfma_f32_16x16x32_bf16 v[52:55], a[84:87], a[52:55], v[52:55]
v_exp_f32 v12, v36
v_add_f32 v26, v26, v11
v_cvt_pk_bf16_f32 v97, v10, v11
v_mfma_f32_16x16x32_bf16 v[52:55], a[88:91], a[56:59], v[52:55]
s_waitcnt vmcnt(8) lgkmcnt(4)
ds_read_b128 a[124:127], v1 offset:31744
v_exp_f32 v13, v37
v_mfma_f32_16x16x32_bf16 v[52:55], a[92:95], a[60:63], v[52:55]
s_barrier
v_mfma_f32_16x16x32_bf16 v[56:59], a[96:99], a[0:3], v[56:59]
ds_read_b128 a[64:67], v4 offset:0
v_exp_f32 v14, v38
v_mfma_f32_16x16x32_bf16 v[56:59], a[100:103], a[4:7], v[56:59]
buffer_store_dword v6, v5, s[4:7], s71 offen sc1
v_mfma_f32_16x16x32_bf16 v[56:59], a[104:107], a[8:11], v[56:59]
s_waitcnt lgkmcnt(4)
ds_read_b128 a[68:71], v4 offset:1024
v_add_f32 v27, v12, v13
v_cvt_pk_bf16_f32 v104, v12, v13
v_add_f32 v27, v27, v14
v_mfma_f32_16x16x32_bf16 v[56:59], a[108:111], a[12:15], v[56:59]
v_exp_f32 v15, v39
v_mfma_f32_16x16x32_bf16 v[56:59], a[112:115], a[16:19], v[56:59]
s_waitcnt lgkmcnt(4)
ds_read_b128 a[72:75], v4 offset:2048
v_exp_f32 v8, v40
v_add_f32 v27, v27, v15
v_cvt_pk_bf16_f32 v105, v14, v15
v_mfma_f32_16x16x32_bf16 v[56:59], a[116:119], a[20:23], v[56:59]
s_waitcnt lgkmcnt(4)
v_exp_f32 v9, v41
v_add_f32 v26, v26, v8
v_mfma_f32_16x16x32_bf16 v[56:59], a[120:123], a[24:27], v[56:59]
s_waitcnt lgkmcnt(3)
ds_read_b128 a[76:79], v4 offset:3072
v_exp_f32 v10, v42
v_add_f32 v26, v26, v9
v_cvt_pk_bf16_f32 v98, v8, v9
v_mfma_f32_16x16x32_bf16 v[56:59], a[124:127], a[28:31], v[56:59]
v_exp_f32 v11, v43
v_add_f32 v26, v26, v10
v_mfma_f32_16x16x32_bf16 v[60:63], a[96:99], a[32:35], v[20:23]
ds_read_b128 a[80:83], v4 offset:4096
v_exp_f32 v12, v44
v_mfma_f32_16x16x32_bf16 v[60:63], a[100:103], a[36:39], v[60:63]
v_exp_f32 v13, v45
v_mfma_f32_16x16x32_bf16 v[60:63], a[104:107], a[40:43], v[60:63]
ds_read_b128 a[84:87], v4 offset:5120
v_exp_f32 v14, v46
v_mfma_f32_16x16x32_bf16 v[60:63], a[108:111], a[44:47], v[60:63]
v_exp_f32 v15, v47
v_mfma_f32_16x16x32_bf16 v[60:63], a[112:115], a[48:51], v[60:63]
ds_read_b128 a[88:91], v4 offset:6144
v_add_f32 v26, v26, v11
v_cvt_pk_bf16_f32 v99, v10, v11
v_mfma_f32_16x16x32_bf16 v[60:63], a[116:119], a[52:55], v[60:63]
v_add_f32 v27, v27, v12
v_add_f32 v27, v27, v13
v_cvt_pk_bf16_f32 v106, v12, v13
v_mfma_f32_16x16x32_bf16 v[60:63], a[120:123], a[56:59], v[60:63]
s_waitcnt lgkmcnt(7)
s_barrier
ds_read_b128 a[92:95], v4 offset:7168
v_mfma_f32_16x16x32_bf16 v[60:63], a[124:127], a[60:63], v[60:63]
s_waitcnt lgkmcnt(4)
v_add_f32 v27, v27, v14
v_add_f32 v27, v27, v15
v_cvt_pk_bf16_f32 v107, v14, v15
s_branch K2_dx1
PAD_33:
s_cbranch_execz M_tret
K2_ntail:
v_mfma_f32_16x16x32_bf16 v[128:131], a[64:67], v[96:99], v[128:131]
s_add_u32 m0, s18, 98304
ds_read_b128 a[96:99], v2 offset:8192
v_add_f32 v24, v24, v26
v_mfma_f32_16x16x32_bf16 v[128:131], a[68:71], v[100:103], v[128:131]
buffer_load_dwordx4 v1, s[4:7], s12 offen offset:0 sc1 lds
v_mfma_f32_16x16x32_bf16 v[132:135], a[68:71], v[108:111], v[132:135]
ds_read_b128 a[100:103], v2 offset:9216
v_add_f32 v25, v25, v27
v_mfma_f32_16x16x32_bf16 v[132:135], a[64:67], v[104:107], v[132:135]
buffer_load_dwordx4 v1, s[4:7], s12 offen offset:1024 sc1 lds
v_mfma_f32_16x16x32_bf16 v[136:139], a[72:75], v[96:99], v[136:139]
ds_read_b128 a[104:107], v2 offset:10240
v_exp_f32 v8, v64
v_mfma_f32_16x16x32_bf16 v[136:139], a[76:79], v[100:103], v[136:139]
buffer_load_dwordx4 v1, s[4:7], s12 offen offset:2048 sc1 lds
v_mfma_f32_16x16x32_bf16 v[140:143], a[76:79], v[108:111], v[140:143]
ds_read_b128 a[108:111], v2 offset:11264
v_mfma_f32_16x16x32_bf16 v[140:143], a[72:75], v[104:107], v[140:143]
s_waitcnt lgkmcnt(4)
buffer_load_dwordx4 v1, s[4:7], s12 offen offset:3072 sc1 lds
v_mfma_f32_16x16x32_bf16 v[144:147], a[80:83], v[96:99], v[144:147]
s_add_u32 s12, s12, 4096
s_add_u32 m0, s18, 102400
ds_read_b128 a[112:115], v2 offset:12288
v_mfma_f32_16x16x32_bf16 v[144:147], a[84:87], v[100:103], v[144:147]
buffer_load_dwordx4 v1, s[4:7], s12 offen offset:0 sc1 lds
v_mfma_f32_16x16x32_bf16 v[148:151], a[84:87], v[108:111], v[148:151]
ds_read_b128 a[116:119], v2 offset:13312
v_exp_f32 v9, v65
v_mfma_f32_16x16x32_bf16 v[148:151], a[80:83], v[104:107], v[148:151]
buffer_load_dwordx4 v1, s[4:7], s12 offen offset:1024 sc1 lds
v_mfma_f32_16x16x32_bf16 v[152:155], a[88:91], v[96:99], v[152:155]
ds_read_b128 a[120:123], v2 offset:14336
v_add_f32 v26, v8, v9
v_cvt_pk_bf16_f32 v112, v8, v9
v_mfma_f32_16x16x32_bf16 v[152:155], a[92:95], v[100:103], v[152:155]
buffer_load_dwordx4 v1, s[4:7], s12 offen offset:2048 sc1 lds
v_mfma_f32_16x16x32_bf16 v[156:159], a[92:95], v[108:111], v[156:159]
ds_read_b128 a[124:127], v2 offset:15360
v_exp_f32 v10, v66
v_mfma_f32_16x16x32_bf16 v[156:159], a[88:91], v[104:107], v[156:159]
s_waitcnt lgkmcnt(4)
buffer_load_dwordx4 v1, s[4:7], s12 offen offset:3072 sc1 lds
v_mfma_f32_16x16x32_bf16 v[160:163], a[96:99], v[96:99], v[160:163]
s_add_u32 s12, s12, 28672
ds_read_b128 a[64:67], v2 offset:16384
v_add_f32 v26, v26, v10
v_mfma_f32_16x16x32_bf16 v[160:163], a[100:103], v[100:103], v[160:163]
s_sub_u32 s13, s13, 1
v_exp_f32 v11, v67
v_mfma_f32_16x16x32_bf16 v[164:167], a[100:103], v[108:111], v[164:167]
s_cmp_eq_u32 s13, 0
ds_read_b128 a[68:71], v2 offset:17408
v_exp_f32 v12, v68
v_mfma_f32_16x16x32_bf16 v[164:167], a[96:99], v[104:107], v[164:167]
s_cselect_b32 s12, s14, s12
v_exp_f32 v13, v69
v_mfma_f32_16x16x32_bf16 v[168:171], a[104:107], v[96:99], v[168:171]
s_cselect_b32 s13, s15, s13
ds_read_b128 a[72:75], v2 offset:18432
v_add_f32 v26, v26, v11
v_cvt_pk_bf16_f32 v113, v10, v11
v_mfma_f32_16x16x32_bf16 v[168:171], a[108:111], v[100:103], v[168:171]
s_cselect_b32 s14, 3221225472, s14
v_exp_f32 v14, v70
v_mfma_f32_16x16x32_bf16 v[172:175], a[108:111], v[108:111], v[172:175]
ds_read_b128 a[76:79], v2 offset:19456
v_exp_f32 v15, v71
v_mfma_f32_16x16x32_bf16 v[172:175], a[104:107], v[104:107], v[172:175]
s_waitcnt lgkmcnt(4)
v_exp_f32 v8, v72
v_mfma_f32_16x16x32_bf16 v[176:179], a[112:115], v[96:99], v[176:179]
ds_read_b128 a[80:83], v2 offset:20480
v_add_f32 v27, v12, v13
v_cvt_pk_bf16_f32 v120, v12, v13
v_add_f32 v27, v27, v14
v_add_f32 v27, v27, v15
v_cvt_pk_bf16_f32 v121, v14, v15
v_mfma_f32_16x16x32_bf16 v[176:179], a[116:119], v[100:103], v[176:179]
v_exp_f32 v9, v73
v_mfma_f32_16x16x32_bf16 v[180:183], a[116:119], v[108:111], v[180:183]
ds_read_b128 a[84:87], v2 offset:21504
v_exp_f32 v10, v74
v_mfma_f32_16x16x32_bf16 v[180:183], a[112:115], v[104:107], v[180:183]
v_exp_f32 v11, v75
v_mfma_f32_16x16x32_bf16 v[184:187], a[120:123], v[96:99], v[184:187]
ds_read_b128 a[88:91], v2 offset:22528
v_add_f32 v26, v26, v8
v_mfma_f32_16x16x32_bf16 v[184:187], a[124:127], v[100:103], v[184:187]
v_exp_f32 v12, v76
v_mfma_f32_16x16x32_bf16 v[188:191], a[124:127], v[108:111], v[188:191]
ds_read_b128 a[92:95], v2 offset:23552
v_add_f32 v26, v26, v9
v_cvt_pk_bf16_f32 v114, v8, v9
v_add_f32 v26, v26, v10
v_add_f32 v26, v26, v11
v_cvt_pk_bf16_f32 v115, v10, v11
v_mfma_f32_16x16x32_bf16 v[188:191], a[120:123], v[104:107], v[188:191]
s_waitcnt lgkmcnt(4)
v_exp_f32 v13, v77
v_mfma_f32_16x16x32_bf16 v[192:195], a[64:67], v[96:99], v[192:195]
ds_read_b128 a[96:99], v2 offset:24576
v_exp_f32 v14, v78
v_mfma_f32_16x16x32_bf16 v[192:195], a[68:71], v[100:103], v[192:195]
v_exp_f32 v15, v79
v_mfma_f32_16x16x32_bf16 v[196:199], a[68:71], v[108:111], v[196:199]
ds_read_b128 a[100:103], v2 offset:25600
v_add_f32 v27, v27, v12
v_add_f32 v27, v27, v13
v_cvt_pk_bf16_f32 v122, v12, v13
v_add_f32 v27, v27, v14
v_mfma_f32_16x16x32_bf16 v[196:199], a[64:67], v[104:107], v[196:199]
v_exp_f32 v8, v80
v_mfma_f32_16x16x32_bf16 v[200:203], a[72:75], v[96:99], v[200:203]
ds_read_b128 a[104:107], v2 offset:26624
v_exp_f32 v9, v81
v_mfma_f32_16x16x32_bf16 v[200:203], a[76:79], v[100:103], v[200:203]
v_exp_f32 v10, v82
v_mfma_f32_16x16x32_bf16 v[204:207], a[76:79], v[108:111], v[204:207]
ds_read_b128 a[108:111], v2 offset:27648
v_add_f32 v27, v27, v15
v_cvt_pk_bf16_f32 v123, v14, v15
v_add_f32 v26, v26, v8
v_add_f32 v26, v26, v9
v_cvt_pk_bf16_f32 v116, v8, v9
v_mfma_f32_16x16x32_bf16 v[204:207], a[72:75], v[104:107], v[204:207]
s_waitcnt lgkmcnt(4)
v_exp_f32 v11, v83
v_mfma_f32_16x16x32_bf16 v[208:211], a[80:83], v[96:99], v[208:211]
ds_read_b128 a[112:115], v2 offset:28672
v_exp_f32 v12, v84
v_mfma_f32_16x16x32_bf16 v[208:211], a[84:87], v[100:103], v[208:211]
v_exp_f32 v13, v85
v_mfma_f32_16x16x32_bf16 v[212:215], a[84:87], v[108:111], v[212:215]
ds_read_b128 a[116:119], v2 offset:29696
v_add_f32 v26, v26, v10
v_add_f32 v26, v26, v11
v_cvt_pk_bf16_f32 v117, v10, v11
v_add_f32 v27, v27, v12
v_mfma_f32_16x16x32_bf16 v[212:215], a[80:83], v[104:107], v[212:215]
v_exp_f32 v14, v86
v_mfma_f32_16x16x32_bf16 v[216:219], a[88:91], v[96:99], v[216:219]
ds_read_b128 a[120:123], v2 offset:30720
v_exp_f32 v15, v87
v_mfma_f32_16x16x32_bf16 v[216:219], a[92:95], v[100:103], v[216:219]
v_exp_f32 v8, v88
v_mfma_f32_16x16x32_bf16 v[220:223], a[92:95], v[108:111], v[220:223]
s_waitcnt vmcnt(0) lgkmcnt(4)
ds_read_b128 a[124:127], v2 offset:31744
v_add_f32 v27, v27, v13
v_cvt_pk_bf16_f32 v124, v12, v13
v_add_f32 v27, v27, v14
v_add_f32 v27, v27, v15
v_cvt_pk_bf16_f32 v125, v14, v15
v_mfma_f32_16x16x32_bf16 v[220:223], a[88:91], v[104:107], v[220:223]
s_barrier
v_mfma_f32_16x16x32_bf16 v[224:227], a[96:99], v[96:99], v[224:227]
ds_read_b128 a[64:67], v2 offset:32768
v_exp_f32 v9, v89
v_mfma_f32_16x16x32_bf16 v[224:227], a[100:103], v[100:103], v[224:227]
v_exp_f32 v10, v90
v_mfma_f32_16x16x32_bf16 v[228:231], a[100:103], v[108:111], v[228:231]
ds_read_b128 a[68:71], v2 offset:33792
v_add_f32 v26, v26, v8
v_add_f32 v26, v26, v9
v_cvt_pk_bf16_f32 v118, v8, v9
v_mfma_f32_16x16x32_bf16 v[228:231], a[96:99], v[104:107], v[228:231]
v_exp_f32 v11, v91
v_mfma_f32_16x16x32_bf16 v[232:235], a[104:107], v[96:99], v[232:235]
s_waitcnt lgkmcnt(4)
ds_read_b128 a[72:75], v2 offset:34816
v_exp_f32 v12, v92
v_mfma_f32_16x16x32_bf16 v[232:235], a[108:111], v[100:103], v[232:235]
v_exp_f32 v13, v93
v_mfma_f32_16x16x32_bf16 v[236:239], a[108:111], v[108:111], v[236:239]
ds_read_b128 a[76:79], v2 offset:35840
v_add_f32 v26, v26, v10
v_mfma_f32_16x16x32_bf16 v[236:239], a[104:107], v[104:107], v[236:239]
v_exp_f32 v14, v94
v_mfma_f32_16x16x32_bf16 v[240:243], a[112:115], v[96:99], v[240:243]
ds_read_b128 a[80:83], v2 offset:36864
v_add_f32 v26, v26, v11
v_cvt_pk_bf16_f32 v119, v10, v11
v_add_f32 v27, v27, v12
v_mfma_f32_16x16x32_bf16 v[240:243], a[116:119], v[100:103], v[240:243]
v_exp_f32 v15, v95
v_mfma_f32_16x16x32_bf16 v[244:247], a[116:119], v[108:111], v[244:247]
ds_read_b128 a[84:87], v2 offset:37888
v_add_f32 v27, v27, v13
v_cvt_pk_bf16_f32 v126, v12, v13
v_mfma_f32_16x16x32_bf16 v[244:247], a[112:115], v[104:107], v[244:247]
s_waitcnt lgkmcnt(4)
v_add_f32 v27, v27, v14
v_add_f32 v27, v27, v15
v_mfma_f32_16x16x32_bf16 v[248:251], a[120:123], v[96:99], v[248:251]
ds_read_b128 a[88:91], v2 offset:38912
v_cvt_pk_bf16_f32 v127, v14, v15
v_mfma_f32_16x16x32_bf16 v[248:251], a[124:127], v[100:103], v[248:251]
v_add_f32 v28, v26, v27
v_cmp_nge_f32 vcc, s25, v28
v_mfma_f32_16x16x32_bf16 v[252:255], a[124:127], v[108:111], v[252:255]
ds_read_b128 a[92:95], v2 offset:39936
v_mfma_f32_16x16x32_bf16 v[252:255], a[120:123], v[104:107], v[252:255]
s_cbranch_vccnz Lstub_14
Lback_15:
v_mfma_f32_16x16x32_bf16 v[128:131], a[64:67], v[112:115], v[128:131]
s_add_u32 m0, s18, 131072
ds_read_b128 a[96:99], v2 offset:40960
v_add_f32 v24, v24, v26
v_mfma_f32_16x16x32_bf16 v[128:131], a[68:71], v[116:119], v[128:131]
buffer_load_dwordx4 v1, s[4:7], s8 offen offset:0 sc1 lds
v_mfma_f32_16x16x32_bf16 v[132:135], a[68:71], v[124:127], v[132:135]
ds_read_b128 a[100:103], v2 offset:41984
v_add_f32 v25, v25, v27
v_mfma_f32_16x16x32_bf16 v[132:135], a[64:67], v[120:123], v[132:135]
s_waitcnt lgkmcnt(4)
buffer_load_dwordx4 v1, s[4:7], s8 offen offset:1024 sc1 lds
v_mfma_f32_16x16x32_bf16 v[136:139], a[72:75], v[112:115], v[136:139]
ds_read_b128 a[104:107], v2 offset:43008
v_mov_b32 v8, v16
v_mfma_f32_16x16x32_bf16 v[136:139], a[76:79], v[116:119], v[136:139]
buffer_load_dwordx4 v1, s[4:7], s8 offen offset:2048 sc1 lds
v_mfma_f32_16x16x32_bf16 v[140:143], a[76:79], v[124:127], v[140:143]
ds_read_b128 a[108:111], v2 offset:44032
v_mov_b32 v9, v24
v_mfma_f32_16x16x32_bf16 v[140:143], a[72:75], v[120:123], v[140:143]
buffer_load_dwordx4 v1, s[4:7], s8 offen offset:3072 sc1 lds
v_mfma_f32_16x16x32_bf16 v[144:147], a[80:83], v[112:115], v[144:147]
s_add_u32 s8, s8, 4096
s_add_u32 m0, s18, 135168
ds_read_b128 a[112:115], v2 offset:45056
v_mfma_f32_16x16x32_bf16 v[144:147], a[84:87], v[116:119], v[144:147]
buffer_load_dwordx4 v1, s[4:7], s8 offen offset:0 sc1 lds
v_mfma_f32_16x16x32_bf16 v[148:151], a[84:87], v[124:127], v[148:151]
ds_read_b128 a[116:119], v2 offset:46080
v_mov_b32 v10, v20
v_mfma_f32_16x16x32_bf16 v[148:151], a[80:83], v[120:123], v[148:151]
s_waitcnt lgkmcnt(4)
buffer_load_dwordx4 v1, s[4:7], s8 offen offset:1024 sc1 lds
v_mfma_f32_16x16x32_bf16 v[152:155], a[88:91], v[112:115], v[152:155]
ds_read_b128 a[120:123], v2 offset:47104
v_mov_b32 v11, v25
v_mfma_f32_16x16x32_bf16 v[152:155], a[92:95], v[116:119], v[152:155]
buffer_load_dwordx4 v1, s[4:7], s8 offen offset:2048 sc1 lds
v_mfma_f32_16x16x32_bf16 v[156:159], a[92:95], v[124:127], v[156:159]
ds_read_b128 a[124:127], v2 offset:48128
v_cvt_pk_bf16_f32 v128, v128, v129
v_mfma_f32_16x16x32_bf16 v[156:159], a[88:91], v[120:123], v[156:159]
s_waitcnt lgkmcnt(4)
buffer_load_dwordx4 v1, s[4:7], s8 offen offset:3072 sc1 lds
v_mfma_f32_16x16x32_bf16 v[160:163], a[96:99], v[112:115], v[160:163]
s_add_u32 s8, s8, 28672
ds_read_b128 a[64:67], v2 offset:49152
v_cvt_pk_bf16_f32 v129, v130, v131
v_mfma_f32_16x16x32_bf16 v[160:163], a[100:103], v[116:119], v[160:163]
s_sub_u32 s9, s9, 1
buffer_store_dwordx4 v[8:11], v1, s[4:7], s27 offen sc1
v_mfma_f32_16x16x32_bf16 v[164:167], a[100:103], v[124:127], v[164:167]
s_cmp_eq_u32 s9, 0
ds_read_b128 a[68:71], v2 offset:50176
v_cvt_pk_bf16_f32 v130, v136, v137
v_mfma_f32_16x16x32_bf16 v[164:167], a[96:99], v[120:123], v[164:167]
s_cselect_b32 s8, s10, s8
v_cvt_pk_bf16_f32 v131, v138, v139
v_accvgpr_mov_b32 a0, a192
v_mfma_f32_16x16x32_bf16 v[168:171], a[104:107], v[112:115], v[168:171]
s_cselect_b32 s9, s11, s9
ds_read_b128 a[72:75], v2 offset:51200
v_accvgpr_mov_b32 a1, a193
v_mfma_f32_16x16x32_bf16 v[168:171], a[108:111], v[116:119], v[168:171]
s_cselect_b32 s10, 3221225472, s10
buffer_store_dwordx4 v[128:131], v1, s[4:7], s76 offen offset:0 sc1
v_mfma_f32_16x16x32_bf16 v[172:175], a[108:111], v[124:127], v[172:175]
ds_read_b128 a[76:79], v2 offset:52224
v_cvt_pk_bf16_f32 v132, v132, v133
v_mfma_f32_16x16x32_bf16 v[172:175], a[104:107], v[120:123], v[172:175]
s_waitcnt lgkmcnt(4)
v_cvt_pk_bf16_f32 v133, v134, v135
v_cvt_pk_bf16_f32 v134, v140, v141
v_mfma_f32_16x16x32_bf16 v[176:179], a[112:115], v[112:115], v[176:179]
ds_read_b128 a[80:83], v2 offset:53248
v_cvt_pk_bf16_f32 v135, v142, v143
v_mfma_f32_16x16x32_bf16 v[176:179], a[116:119], v[116:119], v[176:179]
buffer_store_dwordx4 v[132:135], v1, s[4:7], s77 offen offset:0 sc1
v_mfma_f32_16x16x32_bf16 v[180:183], a[116:119], v[124:127], v[180:183]
ds_read_b128 a[84:87], v2 offset:54272
v_cvt_pk_bf16_f32 v144, v144, v145
v_mfma_f32_16x16x32_bf16 v[180:183], a[112:115], v[120:123], v[180:183]
v_cvt_pk_bf16_f32 v145, v146, v147
v_cvt_pk_bf16_f32 v146, v152, v153
v_mfma_f32_16x16x32_bf16 v[184:187], a[120:123], v[112:115], v[184:187]
ds_read_b128 a[88:91], v2 offset:55296
v_cvt_pk_bf16_f32 v147, v154, v155
v_mfma_f32_16x16x32_bf16 v[184:187], a[124:127], v[116:119], v[184:187]
buffer_store_dwordx4 v[144:147], v1, s[4:7], s76 offen offset:1024 sc1
v_mfma_f32_16x16x32_bf16 v[188:191], a[124:127], v[124:127], v[188:191]
ds_read_b128 a[92:95], v2 offset:56320
v_cvt_pk_bf16_f32 v148, v148, v149
v_mfma_f32_16x16x32_bf16 v[188:191], a[120:123], v[120:123], v[188:191]
s_waitcnt lgkmcnt(4)
v_cvt_pk_bf16_f32 v149, v150, v151
v_cvt_pk_bf16_f32 v150, v156, v157
v_mfma_f32_16x16x32_bf16 v[192:195], a[64:67], v[112:115], v[192:195]
ds_read_b128 a[96:99], v2 offset:57344
v_cvt_pk_bf16_f32 v151, v158, v159
v_mfma_f32_16x16x32_bf16 v[192:195], a[68:71], v[116:119], v[192:195]
buffer_store_dwordx4 v[148:151], v1, s[4:7], s77 offen offset:1024 sc1
v_mfma_f32_16x16x32_bf16 v[196:199], a[68:71], v[124:127], v[196:199]
ds_read_b128 a[100:103], v2 offset:58368
v_cvt_pk_bf16_f32 v160, v160, v161
v_mfma_f32_16x16x32_bf16 v[196:199], a[64:67], v[120:123], v[196:199]
v_cvt_pk_bf16_f32 v161, v162, v163
v_cvt_pk_bf16_f32 v162, v168, v169
v_mfma_f32_16x16x32_bf16 v[200:203], a[72:75], v[112:115], v[200:203]
ds_read_b128 a[104:107], v2 offset:59392
v_cvt_pk_bf16_f32 v163, v170, v171
v_mfma_f32_16x16x32_bf16 v[200:203], a[76:79], v[116:119], v[200:203]
buffer_store_dwordx4 v[160:163], v1, s[4:7], s76 offen offset:2048 sc1
v_mfma_f32_16x16x32_bf16 v[204:207], a[76:79], v[124:127], v[204:207]
ds_read_b128 a[108:111], v2 offset:60416
v_cvt_pk_bf16_f32 v164, v164, v165
v_mfma_f32_16x16x32_bf16 v[204:207], a[72:75], v[120:123], v[204:207]
s_waitcnt lgkmcnt(4)
v_cvt_pk_bf16_f32 v165, v166, v167
v_cvt_pk_bf16_f32 v166, v172, v173
v_mfma_f32_16x16x32_bf16 v[208:211], a[80:83], v[112:115], v[208:211]
ds_read_b128 a[112:115], v2 offset:61440
v_cvt_pk_bf16_f32 v167, v174, v175
v_mfma_f32_16x16x32_bf16 v[208:211], a[84:87], v[116:119], v[208:211]
buffer_store_dwordx4 v[164:167], v1, s[4:7], s77 offen offset:2048 sc1
v_mfma_f32_16x16x32_bf16 v[212:215], a[84:87], v[124:127], v[212:215]
ds_read_b128 a[116:119], v2 offset:62464
v_cvt_pk_bf16_f32 v176, v176, v177
v_mfma_f32_16x16x32_bf16 v[212:215], a[80:83], v[120:123], v[212:215]
v_cvt_pk_bf16_f32 v177, v178, v179
v_cvt_pk_bf16_f32 v178, v184, v185
v_mfma_f32_16x16x32_bf16 v[216:219], a[88:91], v[112:115], v[216:219]
ds_read_b128 a[120:123], v2 offset:63488
v_cvt_pk_bf16_f32 v179, v186, v187
v_mfma_f32_16x16x32_bf16 v[216:219], a[92:95], v[116:119], v[216:219]
buffer_store_dwordx4 v[176:179], v1, s[4:7], s76 offen offset:3072 sc1
v_mfma_f32_16x16x32_bf16 v[220:223], a[92:95], v[124:127], v[220:223]
ds_read_b128 a[124:127], v2 offset:64512
v_cvt_pk_bf16_f32 v180, v180, v181
v_mfma_f32_16x16x32_bf16 v[220:223], a[88:91], v[120:123], v[220:223]
s_waitcnt lgkmcnt(4)
v_cvt_pk_bf16_f32 v181, v182, v183
v_cvt_pk_bf16_f32 v182, v188, v189
v_mfma_f32_16x16x32_bf16 v[224:227], a[96:99], v[112:115], v[224:227]
v_cvt_pk_bf16_f32 v183, v190, v191
v_accvgpr_mov_b32 a2, a194
v_mfma_f32_16x16x32_bf16 v[224:227], a[100:103], v[116:119], v[224:227]
PAD_34:
s_cbranch_execz M_tret
buffer_store_dwordx4 v[180:183], v1, s[4:7], s77 offen offset:3072 sc1
v_mfma_f32_16x16x32_bf16 v[228:231], a[100:103], v[124:127], v[228:231]
s_add_u32 s76, s76, 4096
v_accvgpr_mov_b32 a3, a195
v_accvgpr_mov_b32 a4, a196
v_mfma_f32_16x16x32_bf16 v[228:231], a[96:99], v[120:123], v[228:231]
s_add_u32 s77, s77, 4096
v_cvt_pk_bf16_f32 v192, v192, v193
v_cvt_pk_bf16_f32 v193, v194, v195
v_mfma_f32_16x16x32_bf16 v[232:235], a[104:107], v[112:115], v[232:235]
v_cvt_pk_bf16_f32 v194, v200, v201
v_cvt_pk_bf16_f32 v195, v202, v203
v_mfma_f32_16x16x32_bf16 v[232:235], a[108:111], v[116:119], v[232:235]
buffer_store_dwordx4 v[192:195], v1, s[4:7], s76 offen offset:0 sc1
v_mfma_f32_16x16x32_bf16 v[236:239], a[108:111], v[124:127], v[236:239]
v_cvt_pk_bf16_f32 v196, v196, v197
v_cvt_pk_bf16_f32 v197, v198, v199
v_mfma_f32_16x16x32_bf16 v[236:239], a[104:107], v[120:123], v[236:239]
s_waitcnt lgkmcnt(0)
v_cvt_pk_bf16_f32 v198, v204, v205
v_cvt_pk_bf16_f32 v199, v206, v207
v_mfma_f32_16x16x32_bf16 v[240:243], a[112:115], v[112:115], v[240:243]
buffer_store_dwordx4 v[196:199], v1, s[4:7], s77 offen offset:0 sc1
v_mfma_f32_16x16x32_bf16 v[240:243], a[116:119], v[116:119], v[240:243]
v_cvt_pk_bf16_f32 v208, v208, v209
v_cvt_pk_bf16_f32 v209, v210, v211
v_mfma_f32_16x16x32_bf16 v[244:247], a[116:119], v[124:127], v[244:247]
v_cvt_pk_bf16_f32 v210, v216, v217
v_cvt_pk_bf16_f32 v211, v218, v219
v_mfma_f32_16x16x32_bf16 v[244:247], a[112:115], v[120:123], v[244:247]
buffer_store_dwordx4 v[208:211], v1, s[4:7], s76 offen offset:1024 sc1
v_mfma_f32_16x16x32_bf16 v[248:251], a[120:123], v[112:115], v[248:251]
v_cvt_pk_bf16_f32 v212, v212, v213
v_cvt_pk_bf16_f32 v213, v214, v215
v_mfma_f32_16x16x32_bf16 v[248:251], a[124:127], v[116:119], v[248:251]
v_cvt_pk_bf16_f32 v214, v220, v221
v_cvt_pk_bf16_f32 v215, v222, v223
v_mfma_f32_16x16x32_bf16 v[252:255], a[124:127], v[124:127], v[252:255]
buffer_store_dwordx4 v[212:215], v1, s[4:7], s77 offen offset:1024 sc1
v_mfma_f32_16x16x32_bf16 v[252:255], a[120:123], v[120:123], v[252:255]
v_cvt_pk_bf16_f32 v224, v224, v225
v_cvt_pk_bf16_f32 v225, v226, v227
v_accvgpr_mov_b32 a5, a197
v_accvgpr_mov_b32 a6, a198
v_accvgpr_mov_b32 a7, a199
v_accvgpr_mov_b32 a8, a200
v_accvgpr_mov_b32 a9, a201
v_accvgpr_mov_b32 a10, a202
v_accvgpr_mov_b32 a11, a203
v_accvgpr_mov_b32 a12, a204
v_cvt_pk_bf16_f32 v226, v232, v233
v_cvt_pk_bf16_f32 v227, v234, v235
buffer_store_dwordx4 v[224:227], v1, s[4:7], s76 offen offset:2048 sc1
v_cvt_pk_bf16_f32 v228, v228, v229
v_cvt_pk_bf16_f32 v229, v230, v231
v_cvt_pk_bf16_f32 v230, v236, v237
v_cvt_pk_bf16_f32 v231, v238, v239
buffer_store_dwordx4 v[228:231], v1, s[4:7], s77 offen offset:2048 sc1
v_cvt_pk_bf16_f32 v240, v240, v241
v_cvt_pk_bf16_f32 v241, v242, v243
v_cvt_pk_bf16_f32 v242, v248, v249
v_cvt_pk_bf16_f32 v243, v250, v251
buffer_store_dwordx4 v[240:243], v1, s[4:7], s76 offen offset:3072 sc1
v_cvt_pk_bf16_f32 v244, v244, v245
v_cvt_pk_bf16_f32 v245, v246, v247
v_cvt_pk_bf16_f32 v246, v252, v253
v_cvt_pk_bf16_f32 v247, v254, v255
buffer_store_dwordx4 v[244:247], v1, s[4:7], s77 offen offset:3072 sc1
v_accvgpr_mov_b32 a13, a205
v_accvgpr_mov_b32 a14, a206
v_accvgpr_mov_b32 a15, a207
v_accvgpr_mov_b32 a16, a208
v_accvgpr_mov_b32 a17, a209
v_accvgpr_mov_b32 a18, a210
v_accvgpr_mov_b32 a19, a211
v_accvgpr_mov_b32 a20, a212
v_accvgpr_mov_b32 a21, a213
v_accvgpr_mov_b32 a22, a214
v_accvgpr_mov_b32 a23, a215
v_accvgpr_mov_b32 a24, a216
v_accvgpr_mov_b32 a25, a217
v_accvgpr_mov_b32 a26, a218
v_accvgpr_mov_b32 a27, a219
v_accvgpr_mov_b32 a28, a220
v_accvgpr_mov_b32 a29, a221
v_accvgpr_mov_b32 a30, a222
v_accvgpr_mov_b32 a31, a223
v_accvgpr_mov_b32 a32, a224
v_accvgpr_mov_b32 a33, a225
v_accvgpr_mov_b32 a34, a226
v_accvgpr_mov_b32 a35, a227
v_accvgpr_mov_b32 a36, a228
v_accvgpr_mov_b32 a37, a229
v_accvgpr_mov_b32 a38, a230
v_accvgpr_mov_b32 a39, a231
v_accvgpr_mov_b32 a40, a232
v_accvgpr_mov_b32 a41, a233
v_accvgpr_mov_b32 a42, a234
v_accvgpr_mov_b32 a43, a235
v_accvgpr_mov_b32 a44, a236
v_accvgpr_mov_b32 a45, a237
v_accvgpr_mov_b32 a46, a238
v_accvgpr_mov_b32 a47, a239
v_accvgpr_mov_b32 a48, a240
v_accvgpr_mov_b32 a49, a241
v_accvgpr_mov_b32 a50, a242
v_accvgpr_mov_b32 a51, a243
v_accvgpr_mov_b32 a52, a244
v_accvgpr_mov_b32 a53, a245
v_accvgpr_mov_b32 a54, a246
v_accvgpr_mov_b32 a55, a247
v_accvgpr_mov_b32 a56, a248
v_accvgpr_mov_b32 a57, a249
v_accvgpr_mov_b32 a58, a250
v_accvgpr_mov_b32 a59, a251
v_accvgpr_mov_b32 a60, a252
v_accvgpr_mov_b32 a61, a253
v_accvgpr_mov_b32 a62, a254
v_accvgpr_mov_b32 a63, a255
s_mov_b32 s24, 0
s_mov_b32 s29, s21
s_mov_b32 s19, s21
v_mov_b64 v[128:129], 0
v_mov_b64 v[130:131], 0
v_mov_b64 v[132:133], 0
v_mov_b64 v[134:135], 0
v_mov_b64 v[136:137], 0
v_mov_b64 v[138:139], 0
v_mov_b64 v[140:141], 0
v_mov_b64 v[142:143], 0
v_mov_b64 v[144:145], 0
v_mov_b64 v[146:147], 0
v_mov_b64 v[148:149], 0
v_mov_b64 v[150:151], 0
v_mov_b64 v[152:153], 0
v_mov_b64 v[154:155], 0
v_mov_b64 v[156:157], 0
v_mov_b64 v[158:159], 0
v_mov_b64 v[160:161], 0
v_mov_b64 v[162:163], 0
v_mov_b64 v[164:165], 0
v_mov_b64 v[166:167], 0
v_mov_b64 v[168:169], 0
v_mov_b64 v[170:171], 0
v_mov_b64 v[172:173], 0
v_mov_b64 v[174:175], 0
v_mov_b64 v[176:177], 0
v_mov_b64 v[178:179], 0
v_mov_b64 v[180:181], 0
v_mov_b64 v[182:183], 0
v_mov_b64 v[184:185], 0
v_mov_b64 v[186:187], 0
v_mov_b64 v[188:189], 0
v_mov_b64 v[190:191], 0
v_mov_b64 v[192:193], 0
v_mov_b64 v[194:195], 0
v_mov_b64 v[196:197], 0
v_mov_b64 v[198:199], 0
v_mov_b64 v[200:201], 0
v_mov_b64 v[202:203], 0
v_mov_b64 v[204:205], 0
v_mov_b64 v[206:207], 0
v_mov_b64 v[208:209], 0
v_mov_b64 v[210:211], 0
v_mov_b64 v[212:213], 0
v_mov_b64 v[214:215], 0
v_mov_b64 v[216:217], 0
v_mov_b64 v[218:219], 0
v_mov_b64 v[220:221], 0
v_mov_b64 v[222:223], 0
v_mov_b64 v[224:225], 0
v_mov_b64 v[226:227], 0
v_mov_b64 v[228:229], 0
v_mov_b64 v[230:231], 0
v_mov_b64 v[232:233], 0
v_mov_b64 v[234:235], 0
v_mov_b64 v[236:237], 0
v_mov_b64 v[238:239], 0
v_mov_b64 v[240:241], 0
v_mov_b64 v[242:243], 0
v_mov_b64 v[244:245], 0
v_mov_b64 v[246:247], 0
v_mov_b64 v[248:249], 0
v_mov_b64 v[250:251], 0
v_mov_b64 v[252:253], 0
v_mov_b64 v[254:255], 0
v_mov_b64 v[24:25], 0
s_mov_b32 s71, s28
s_mov_b32 s84, 0
s_barrier
s_branch K2_item
K2_nend:
Lstub_2:
s_call_b64 s[16:17], K2_slow1
s_branch Lback_3
Lstub_4:
s_call_b64 s[16:17], K2_slow0
s_branch Lback_5
Lstub_6:
s_call_b64 s[16:17], K2_slow1
s_branch Lback_7
Lstub_8:
s_call_b64 s[16:17], K2_slow0
s_branch Lback_9
Lstub_10:
s_call_b64 s[16:17], K2_slow2
s_branch Lback_11
Lstub_12:
s_call_b64 s[16:17], K2_slow2
s_branch Lback_13
Lstub_14:
s_call_b64 s[16:17], K2_slow1
s_branch Lback_15
K2_slow0:
s_nop 7
s_nop 7
v_max3_f32 v8, v32, v33, 0
v_max3_f32 v8, v34, v35, v8
v_max3_f32 v8, v40, v41, v8
v_max3_f32 v8, v42, v43, v8
v_max3_f32 v8, v48, v49, v8
v_max3_f32 v8, v50, v51, v8
v_max3_f32 v8, v56, v57, v8
v_max3_f32 v8, v58, v59, v8
v_mov_b32 v9, v8
s_nop 1
v_permlane16_swap_b32 v8, v9
v_max_f32 v8, v8, v9
v_mov_b32 v9, v8
s_nop 1
v_permlane32_swap_b32 v8, v9
v_max_f32 v8, v8, v9
v_exp_f32 v9, -v8
v_sub_f32 v16, v16, v8
v_sub_f32 v17, v17, v8
v_sub_f32 v18, v18, v8
v_sub_f32 v19, v19, v8
v_mul_f32 v24, v24, v9
v_mul_f32 v128, v128, v9
v_mul_f32 v129, v129, v9
v_mul_f32 v130, v130, v9
v_mul_f32 v131, v131, v9
v_mul_f32 v136, v136, v9
v_mul_f32 v137, v137, v9
v_mul_f32 v138, v138, v9
v_mul_f32 v139, v139, v9
v_mul_f32 v144, v144, v9
v_mul_f32 v145, v145, v9
v_mul_f32 v146, v146, v9
v_mul_f32 v147, v147, v9
v_mul_f32 v152, v152, v9
v_mul_f32 v153, v153, v9
v_mul_f32 v154, v154, v9
v_mul_f32 v155, v155, v9
v_mul_f32 v160, v160, v9
v_mul_f32 v161, v161, v9
v_mul_f32 v162, v162, v9
v_mul_f32 v163, v163, v9
v_mul_f32 v168, v168, v9
v_mul_f32 v169, v169, v9
v_mul_f32 v170, v170, v9
v_mul_f32 v171, v171, v9
v_mul_f32 v176, v176, v9
v_mul_f32 v177, v177, v9
v_mul_f32 v178, v178, v9
v_mul_f32 v179, v179, v9
v_mul_f32 v184, v184, v9
v_mul_f32 v185, v185, v9
v_mul_f32 v186, v186, v9
v_mul_f32 v187, v187, v9
v_mul_f32 v192, v192, v9
v_mul_f32 v193, v193, v9
v_mul_f32 v194, v194, v9
v_mul_f32 v195, v195, v9
v_mul_f32 v200, v200, v9
v_mul_f32 v201, v201, v9
v_mul_f32 v202, v202, v9
v_mul_f32 v203, v203, v9
v_mul_f32 v208, v208, v9
v_mul_f32 v209, v209, v9
v_mul_f32 v210, v210, v9
v_mul_f32 v211, v211, v9
v_mul_f32 v216, v216, v9
v_mul_f32 v217, v217, v9
v_mul_f32 v218, v218, v9
v_mul_f32 v219, v219, v9
v_mul_f32 v224, v224, v9
v_mul_f32 v225, v225, v9
v_mul_f32 v226, v226, v9
v_mul_f32 v227, v227, v9
v_mul_f32 v232, v232, v9
v_mul_f32 v233, v233, v9
v_mul_f32 v234, v234, v9
v_mul_f32 v235, v235, v9
v_mul_f32 v240, v240, v9
v_mul_f32 v241, v241, v9
v_mul_f32 v242, v242, v9
v_mul_f32 v243, v243, v9
v_mul_f32 v248, v248, v9
v_mul_f32 v249, v249, v9
v_mul_f32 v250, v250, v9
v_mul_f32 v251, v251, v9
v_sub_f32 v32, v32, v8
v_sub_f32 v33, v33, v8
v_sub_f32 v34, v34, v8
v_sub_f32 v35, v35, v8
v_sub_f32 v40, v40, v8
v_sub_f32 v41, v41, v8
v_sub_f32 v42, v42, v8
v_sub_f32 v43, v43, v8
v_sub_f32 v48, v48, v8
v_sub_f32 v49, v49, v8
v_sub_f32 v50, v50, v8
v_sub_f32 v51, v51, v8
v_sub_f32 v56, v56, v8
v_sub_f32 v57, v57, v8
v_sub_f32 v58, v58, v8
v_sub_f32 v59, v59, v8
v_sub_f32 v64, v64, v8
v_sub_f32 v65, v65, v8
v_sub_f32 v66, v66, v8
v_sub_f32 v67, v67, v8
v_sub_f32 v72, v72, v8
v_sub_f32 v73, v73, v8
v_sub_f32 v74, v74, v8
v_sub_f32 v75, v75, v8
v_sub_f32 v80, v80, v8
v_sub_f32 v81, v81, v8
v_sub_f32 v82, v82, v8
v_sub_f32 v83, v83, v8
v_sub_f32 v88, v88, v8
v_sub_f32 v89, v89, v8
v_sub_f32 v90, v90, v8
v_sub_f32 v91, v91, v8
v_max3_f32 v8, v36, v37, 0
v_max3_f32 v8, v38, v39, v8
v_max3_f32 v8, v44, v45, v8
v_max3_f32 v8, v46, v47, v8
v_max3_f32 v8, v52, v53, v8
v_max3_f32 v8, v54, v55, v8
v_max3_f32 v8, v60, v61, v8
v_max3_f32 v8, v62, v63, v8
v_mov_b32 v9, v8
s_nop 1
v_permlane16_swap_b32 v8, v9
v_max_f32 v8, v8, v9
v_mov_b32 v9, v8
s_nop 1
v_permlane32_swap_b32 v8, v9
v_max_f32 v8, v8, v9
v_exp_f32 v9, -v8
v_sub_f32 v20, v20, v8
v_sub_f32 v21, v21, v8
v_sub_f32 v22, v22, v8
v_sub_f32 v23, v23, v8
v_mul_f32 v25, v25, v9
v_mul_f32 v132, v132, v9
v_mul_f32 v133, v133, v9
v_mul_f32 v134, v134, v9
v_mul_f32 v135, v135, v9
v_mul_f32 v140, v140, v9
v_mul_f32 v141, v141, v9
v_mul_f32 v142, v142, v9
v_mul_f32 v143, v143, v9
v_mul_f32 v148, v148, v9
v_mul_f32 v149, v149, v9
v_mul_f32 v150, v150, v9
v_mul_f32 v151, v151, v9
v_mul_f32 v156, v156, v9
v_mul_f32 v157, v157, v9
v_mul_f32 v158, v158, v9
v_mul_f32 v159, v159, v9
v_mul_f32 v164, v164, v9
v_mul_f32 v165, v165, v9
v_mul_f32 v166, v166, v9
v_mul_f32 v167, v167, v9
v_mul_f32 v172, v172, v9
v_mul_f32 v173, v173, v9
v_mul_f32 v174, v174, v9
v_mul_f32 v175, v175, v9
v_mul_f32 v180, v180, v9
v_mul_f32 v181, v181, v9
v_mul_f32 v182, v182, v9
v_mul_f32 v183, v183, v9
v_mul_f32 v188, v188, v9
v_mul_f32 v189, v189, v9
v_mul_f32 v190, v190, v9
v_mul_f32 v191, v191, v9
v_mul_f32 v196, v196, v9
v_mul_f32 v197, v197, v9
v_mul_f32 v198, v198, v9
v_mul_f32 v199, v199, v9
v_mul_f32 v204, v204, v9
v_mul_f32 v205, v205, v9
v_mul_f32 v206, v206, v9
v_mul_f32 v207, v207, v9
v_mul_f32 v212, v212, v9
v_mul_f32 v213, v213, v9
v_mul_f32 v214, v214, v9
v_mul_f32 v215, v215, v9
v_mul_f32 v220, v220, v9
v_mul_f32 v221, v221, v9
v_mul_f32 v222, v222, v9
v_mul_f32 v223, v223, v9
v_mul_f32 v228, v228, v9
v_mul_f32 v229, v229, v9
v_mul_f32 v230, v230, v9
v_mul_f32 v231, v231, v9
v_mul_f32 v236, v236, v9
v_mul_f32 v237, v237, v9
v_mul_f32 v238, v238, v9
v_mul_f32 v239, v239, v9
v_mul_f32 v244, v244, v9
v_mul_f32 v245, v245, v9
v_mul_f32 v246, v246, v9
v_mul_f32 v247, v247, v9
v_mul_f32 v252, v252, v9
v_mul_f32 v253, v253, v9
v_mul_f32 v254, v254, v9
v_mul_f32 v255, v255, v9
v_sub_f32 v36, v36, v8
v_sub_f32 v37, v37, v8
v_sub_f32 v38, v38, v8
v_sub_f32 v39, v39, v8
v_sub_f32 v44, v44, v8
v_sub_f32 v45, v45, v8
v_sub_f32 v46, v46, v8
v_sub_f32 v47, v47, v8
v_sub_f32 v52, v52, v8
v_sub_f32 v53, v53, v8
v_sub_f32 v54, v54, v8
v_sub_f32 v55, v55, v8
v_sub_f32 v60, v60, v8
v_sub_f32 v61, v61, v8
v_sub_f32 v62, v62, v8
v_sub_f32 v63, v63, v8
v_sub_f32 v68, v68, v8
v_sub_f32 v69, v69, v8
v_sub_f32 v70, v70, v8
v_sub_f32 v71, v71, v8
v_sub_f32 v76, v76, v8
v_sub_f32 v77, v77, v8
v_sub_f32 v78, v78, v8
v_sub_f32 v79, v79, v8
v_sub_f32 v84, v84, v8
v_sub_f32 v85, v85, v8
v_sub_f32 v86, v86, v8
v_sub_f32 v87, v87, v8
v_sub_f32 v92, v92, v8
v_sub_f32 v93, v93, v8
v_sub_f32 v94, v94, v8
v_sub_f32 v95, v95, v8
v_exp_f32 v8, v32
v_exp_f32 v9, v33
v_exp_f32 v10, v34
v_exp_f32 v11, v35
s_nop 0
v_add_f32 v26, v8, v9
v_cvt_pk_bf16_f32 v96, v8, v9
v_add_f32 v26, v26, v10
v_add_f32 v26, v26, v11
v_cvt_pk_bf16_f32 v97, v10, v11
v_exp_f32 v12, v36
v_exp_f32 v13, v37
v_exp_f32 v14, v38
v_exp_f32 v15, v39
s_nop 0
v_add_f32 v27, v12, v13
v_cvt_pk_bf16_f32 v104, v12, v13
v_add_f32 v27, v27, v14
v_add_f32 v27, v27, v15
v_cvt_pk_bf16_f32 v105, v14, v15
v_exp_f32 v8, v40
v_exp_f32 v9, v41
v_exp_f32 v10, v42
v_exp_f32 v11, v43
s_nop 0
v_add_f32 v26, v26, v8
v_add_f32 v26, v26, v9
v_cvt_pk_bf16_f32 v98, v8, v9
v_add_f32 v26, v26, v10
v_add_f32 v26, v26, v11
v_cvt_pk_bf16_f32 v99, v10, v11
v_exp_f32 v12, v44
v_exp_f32 v13, v45
v_exp_f32 v14, v46
v_exp_f32 v15, v47
s_nop 0
v_add_f32 v27, v27, v12
v_add_f32 v27, v27, v13
v_cvt_pk_bf16_f32 v106, v12, v13
v_add_f32 v27, v27, v14
v_add_f32 v27, v27, v15
v_cvt_pk_bf16_f32 v107, v14, v15
v_exp_f32 v8, v48
v_exp_f32 v9, v49
v_exp_f32 v10, v50
v_exp_f32 v11, v51
s_nop 0
v_add_f32 v26, v26, v8
v_add_f32 v26, v26, v9
v_cvt_pk_bf16_f32 v100, v8, v9
v_add_f32 v26, v26, v10
v_add_f32 v26, v26, v11
v_cvt_pk_bf16_f32 v101, v10, v11
v_exp_f32 v12, v52
v_exp_f32 v13, v53
v_exp_f32 v14, v54
v_exp_f32 v15, v55
s_nop 0
v_add_f32 v27, v27, v12
v_add_f32 v27, v27, v13
v_cvt_pk_bf16_f32 v108, v12, v13
v_add_f32 v27, v27, v14
v_add_f32 v27, v27, v15
v_cvt_pk_bf16_f32 v109, v14, v15
v_exp_f32 v8, v56
v_exp_f32 v9, v57
v_exp_f32 v10, v58
v_exp_f32 v11, v59
s_nop 0
v_add_f32 v26, v26, v8
v_add_f32 v26, v26, v9
v_cvt_pk_bf16_f32 v102, v8, v9
v_add_f32 v26, v26, v10
v_add_f32 v26, v26, v11
v_cvt_pk_bf16_f32 v103, v10, v11
v_exp_f32 v12, v60
v_exp_f32 v13, v61
v_exp_f32 v14, v62
v_exp_f32 v15, v63
s_nop 0
v_add_f32 v27, v27, v12
v_add_f32 v27, v27, v13
v_cvt_pk_bf16_f32 v110, v12, v13
v_add_f32 v27, v27, v14
v_add_f32 v27, v27, v15
v_cvt_pk_bf16_f32 v111, v14, v15
s_nop 1
s_setpc_b64 s[16:17]
K2_slow1:
s_nop 7
s_nop 7
v_max3_f32 v8, v64, v65, 0
v_max3_f32 v8, v66, v67, v8
v_max3_f32 v8, v72, v73, v8
v_max3_f32 v8, v74, v75, v8
v_max3_f32 v8, v80, v81, v8
v_max3_f32 v8, v82, v83, v8
v_max3_f32 v8, v88, v89, v8
v_max3_f32 v8, v90, v91, v8
v_mov_b32 v9, v8
s_nop 1
v_permlane16_swap_b32 v8, v9
v_max_f32 v8, v8, v9
v_mov_b32 v9, v8
s_nop 1
v_permlane32_swap_b32 v8, v9
v_max_f32 v8, v8, v9
v_exp_f32 v9, -v8
v_sub_f32 v16, v16, v8
v_sub_f32 v17, v17, v8
v_sub_f32 v18, v18, v8
v_sub_f32 v19, v19, v8
v_mul_f32 v24, v24, v9
v_mul_f32 v128, v128, v9
v_mul_f32 v129, v129, v9
v_mul_f32 v130, v130, v9
v_mul_f32 v131, v131, v9
v_mul_f32 v136, v136, v9
v_mul_f32 v137, v137, v9
v_mul_f32 v138, v138, v9
v_mul_f32 v139, v139, v9
v_mul_f32 v144, v144, v9
v_mul_f32 v145, v145, v9
v_mul_f32 v146, v146, v9
v_mul_f32 v147, v147, v9
v_mul_f32 v152, v152, v9
v_mul_f32 v153, v153, v9
v_mul_f32 v154, v154, v9
v_mul_f32 v155, v155, v9
v_mul_f32 v160, v160, v9
v_mul_f32 v161, v161, v9
v_mul_f32 v162, v162, v9
v_mul_f32 v163, v163, v9
v_mul_f32 v168, v168, v9
v_mul_f32 v169, v169, v9
v_mul_f32 v170, v170, v9
v_mul_f32 v171, v171, v9
v_mul_f32 v176, v176, v9
v_mul_f32 v177, v177, v9
v_mul_f32 v178, v178, v9
v_mul_f32 v179, v179, v9
v_mul_f32 v184, v184, v9
v_mul_f32 v185, v185, v9
v_mul_f32 v186, v186, v9
v_mul_f32 v187, v187, v9
v_mul_f32 v192, v192, v9
v_mul_f32 v193, v193, v9
v_mul_f32 v194, v194, v9
v_mul_f32 v195, v195, v9
v_mul_f32 v200, v200, v9
v_mul_f32 v201, v201, v9
v_mul_f32 v202, v202, v9
v_mul_f32 v203, v203, v9
v_mul_f32 v208, v208, v9
v_mul_f32 v209, v209, v9
v_mul_f32 v210, v210, v9
v_mul_f32 v211, v211, v9
v_mul_f32 v216, v216, v9
v_mul_f32 v217, v217, v9
v_mul_f32 v218, v218, v9
v_mul_f32 v219, v219, v9
v_mul_f32 v224, v224, v9
v_mul_f32 v225, v225, v9
v_mul_f32 v226, v226, v9
v_mul_f32 v227, v227, v9
v_mul_f32 v232, v232, v9
v_mul_f32 v233, v233, v9
v_mul_f32 v234, v234, v9
v_mul_f32 v235, v235, v9
v_mul_f32 v240, v240, v9
v_mul_f32 v241, v241, v9
v_mul_f32 v242, v242, v9
v_mul_f32 v243, v243, v9
v_mul_f32 v248, v248, v9
v_mul_f32 v249, v249, v9
v_mul_f32 v250, v250, v9
v_mul_f32 v251, v251, v9
v_sub_f32 v32, v32, v8
v_sub_f32 v33, v33, v8
v_sub_f32 v34, v34, v8
v_sub_f32 v35, v35, v8
v_sub_f32 v40, v40, v8
v_sub_f32 v41, v41, v8
v_sub_f32 v42, v42, v8
v_sub_f32 v43, v43, v8
v_sub_f32 v48, v48, v8
v_sub_f32 v49, v49, v8
v_sub_f32 v50, v50, v8
v_sub_f32 v51, v51, v8
v_sub_f32 v56, v56, v8
v_sub_f32 v57, v57, v8
v_sub_f32 v58, v58, v8
v_sub_f32 v59, v59, v8
v_sub_f32 v64, v64, v8
v_sub_f32 v65, v65, v8
v_sub_f32 v66, v66, v8
v_sub_f32 v67, v67, v8
v_sub_f32 v72, v72, v8
v_sub_f32 v73, v73, v8
v_sub_f32 v74, v74, v8
v_sub_f32 v75, v75, v8
v_sub_f32 v80, v80, v8
v_sub_f32 v81, v81, v8
v_sub_f32 v82, v82, v8
v_sub_f32 v83, v83, v8
v_sub_f32 v88, v88, v8
v_sub_f32 v89, v89, v8
v_sub_f32 v90, v90, v8
v_sub_f32 v91, v91, v8
v_max3_f32 v8, v68, v69, 0
v_max3_f32 v8, v70, v71, v8
v_max3_f32 v8, v76, v77, v8
v_max3_f32 v8, v78, v79, v8
v_max3_f32 v8, v84, v85, v8
v_max3_f32 v8, v86, v87, v8
v_max3_f32 v8, v92, v93, v8
v_max3_f32 v8, v94, v95, v8
v_mov_b32 v9, v8
s_nop 1
v_permlane16_swap_b32 v8, v9
v_max_f32 v8, v8, v9
v_mov_b32 v9, v8
s_nop 1
v_permlane32_swap_b32 v8, v9
v_max_f32 v8, v8, v9
v_exp_f32 v9, -v8
v_sub_f32 v20, v20, v8
v_sub_f32 v21, v21, v8
v_sub_f32 v22, v22, v8
v_sub_f32 v23, v23, v8
v_mul_f32 v25, v25, v9
v_mul_f32 v132, v132, v9
v_mul_f32 v133, v133, v9
v_mul_f32 v134, v134, v9
v_mul_f32 v135, v135, v9
v_mul_f32 v140, v140, v9
v_mul_f32 v141, v141, v9
v_mul_f32 v142, v142, v9
v_mul_f32 v143, v143, v9
v_mul_f32 v148, v148, v9
v_mul_f32 v149, v149, v9
v_mul_f32 v150, v150, v9
v_mul_f32 v151, v151, v9
v_mul_f32 v156, v156, v9
v_mul_f32 v157, v157, v9
v_mul_f32 v158, v158, v9
v_mul_f32 v159, v159, v9
v_mul_f32 v164, v164, v9
v_mul_f32 v165, v165, v9
v_mul_f32 v166, v166, v9
v_mul_f32 v167, v167, v9
v_mul_f32 v172, v172, v9
v_mul_f32 v173, v173, v9
v_mul_f32 v174, v174, v9
v_mul_f32 v175, v175, v9
v_mul_f32 v180, v180, v9
v_mul_f32 v181, v181, v9
v_mul_f32 v182, v182, v9
v_mul_f32 v183, v183, v9
v_mul_f32 v188, v188, v9
v_mul_f32 v189, v189, v9
v_mul_f32 v190, v190, v9
v_mul_f32 v191, v191, v9
v_mul_f32 v196, v196, v9
v_mul_f32 v197, v197, v9
v_mul_f32 v198, v198, v9
v_mul_f32 v199, v199, v9
v_mul_f32 v204, v204, v9
v_mul_f32 v205, v205, v9
v_mul_f32 v206, v206, v9
v_mul_f32 v207, v207, v9
v_mul_f32 v212, v212, v9
v_mul_f32 v213, v213, v9
v_mul_f32 v214, v214, v9
v_mul_f32 v215, v215, v9
v_mul_f32 v220, v220, v9
v_mul_f32 v221, v221, v9
v_mul_f32 v222, v222, v9
v_mul_f32 v223, v223, v9
v_mul_f32 v228, v228, v9
v_mul_f32 v229, v229, v9
v_mul_f32 v230, v230, v9
v_mul_f32 v231, v231, v9
v_mul_f32 v236, v236, v9
v_mul_f32 v237, v237, v9
v_mul_f32 v238, v238, v9
v_mul_f32 v239, v239, v9
v_mul_f32 v244, v244, v9
v_mul_f32 v245, v245, v9
v_mul_f32 v246, v246, v9
v_mul_f32 v247, v247, v9
v_mul_f32 v252, v252, v9
v_mul_f32 v253, v253, v9
v_mul_f32 v254, v254, v9
v_mul_f32 v255, v255, v9
v_sub_f32 v36, v36, v8
v_sub_f32 v37, v37, v8
v_sub_f32 v38, v38, v8
v_sub_f32 v39, v39, v8
v_sub_f32 v44, v44, v8
v_sub_f32 v45, v45, v8
v_sub_f32 v46, v46, v8
v_sub_f32 v47, v47, v8
v_sub_f32 v52, v52, v8
v_sub_f32 v53, v53, v8
v_sub_f32 v54, v54, v8
v_sub_f32 v55, v55, v8
v_sub_f32 v60, v60, v8
v_sub_f32 v61, v61, v8
v_sub_f32 v62, v62, v8
v_sub_f32 v63, v63, v8
v_sub_f32 v68, v68, v8
v_sub_f32 v69, v69, v8
v_sub_f32 v70, v70, v8
v_sub_f32 v71, v71, v8
v_sub_f32 v76, v76, v8
v_sub_f32 v77, v77, v8
v_sub_f32 v78, v78, v8
v_sub_f32 v79, v79, v8
v_sub_f32 v84, v84, v8
v_sub_f32 v85, v85, v8
v_sub_f32 v86, v86, v8
v_sub_f32 v87, v87, v8
v_sub_f32 v92, v92, v8
v_sub_f32 v93, v93, v8
v_sub_f32 v94, v94, v8
v_sub_f32 v95, v95, v8
v_exp_f32 v8, v64
v_exp_f32 v9, v65
v_exp_f32 v10, v66
v_exp_f32 v11, v67
s_nop 0
v_add_f32 v26, v8, v9
v_cvt_pk_bf16_f32 v112, v8, v9
v_add_f32 v26, v26, v10
v_add_f32 v26, v26, v11
v_cvt_pk_bf16_f32 v113, v10, v11
v_exp_f32 v12, v68
v_exp_f32 v13, v69
v_exp_f32 v14, v70
v_exp_f32 v15, v71
s_nop 0
v_add_f32 v27, v12, v13
v_cvt_pk_bf16_f32 v120, v12, v13
v_add_f32 v27, v27, v14
v_add_f32 v27, v27, v15
v_cvt_pk_bf16_f32 v121, v14, v15
v_exp_f32 v8, v72
v_exp_f32 v9, v73
v_exp_f32 v10, v74
v_exp_f32 v11, v75
s_nop 0
v_add_f32 v26, v26, v8
v_add_f32 v26, v26, v9
v_cvt_pk_bf16_f32 v114, v8, v9
v_add_f32 v26, v26, v10
v_add_f32 v26, v26, v11
v_cvt_pk_bf16_f32 v115, v10, v11
v_exp_f32 v12, v76
v_exp_f32 v13, v77
v_exp_f32 v14, v78
v_exp_f32 v15, v79
s_nop 0
v_add_f32 v27, v27, v12
v_add_f32 v27, v27, v13
v_cvt_pk_bf16_f32 v122, v12, v13
v_add_f32 v27, v27, v14
v_add_f32 v27, v27, v15
v_cvt_pk_bf16_f32 v123, v14, v15
v_exp_f32 v8, v80
v_exp_f32 v9, v81
v_exp_f32 v10, v82
v_exp_f32 v11, v83
s_nop 0
v_add_f32 v26, v26, v8
v_add_f32 v26, v26, v9
v_cvt_pk_bf16_f32 v116, v8, v9
v_add_f32 v26, v26, v10
v_add_f32 v26, v26, v11
v_cvt_pk_bf16_f32 v117, v10, v11
v_exp_f32 v12, v84
v_exp_f32 v13, v85
v_exp_f32 v14, v86
v_exp_f32 v15, v87
s_nop 0
v_add_f32 v27, v27, v12
v_add_f32 v27, v27, v13
v_cvt_pk_bf16_f32 v124, v12, v13
v_add_f32 v27, v27, v14
v_add_f32 v27, v27, v15
v_cvt_pk_bf16_f32 v125, v14, v15
v_exp_f32 v8, v88
v_exp_f32 v9, v89
v_exp_f32 v10, v90
v_exp_f32 v11, v91
s_nop 0
v_add_f32 v26, v26, v8
v_add_f32 v26, v26, v9
v_cvt_pk_bf16_f32 v118, v8, v9
v_add_f32 v26, v26, v10
v_add_f32 v26, v26, v11
v_cvt_pk_bf16_f32 v119, v10, v11
v_exp_f32 v12, v92
v_exp_f32 v13, v93
v_exp_f32 v14, v94
v_exp_f32 v15, v95
s_nop 0
v_add_f32 v27, v27, v12
v_add_f32 v27, v27, v13
v_cvt_pk_bf16_f32 v126, v12, v13
v_add_f32 v27, v27, v14
v_add_f32 v27, v27, v15
v_cvt_pk_bf16_f32 v127, v14, v15
s_nop 1
s_setpc_b64 s[16:17]
K2_slow2:
s_nop 7
s_nop 7
v_max3_f32 v8, v68, v69, 0
v_max3_f32 v8, v70, v71, v8
v_max3_f32 v8, v76, v77, v8
v_max3_f32 v8, v78, v79, v8
v_max3_f32 v8, v84, v85, v8
v_max3_f32 v8, v86, v87, v8
v_max3_f32 v8, v92, v93, v8
v_max3_f32 v8, v94, v95, v8
v_mov_b32 v9, v8
s_nop 1
v_permlane16_swap_b32 v8, v9
v_max_f32 v8, v8, v9
v_mov_b32 v9, v8
s_nop 1
v_permlane32_swap_b32 v8, v9
v_max_f32 v8, v8, v9
v_exp_f32 v9, -v8
v_sub_f32 v20, v20, v8
v_sub_f32 v21, v21, v8
v_sub_f32 v22, v22, v8
v_sub_f32 v23, v23, v8
v_mul_f32 v25, v25, v9
v_mul_f32 v132, v132, v9
v_mul_f32 v133, v133, v9
v_mul_f32 v134, v134, v9
v_mul_f32 v135, v135, v9
v_mul_f32 v140, v140, v9
v_mul_f32 v141, v141, v9
v_mul_f32 v142, v142, v9
v_mul_f32 v143, v143, v9
v_mul_f32 v148, v148, v9
v_mul_f32 v149, v149, v9
v_mul_f32 v150, v150, v9
v_mul_f32 v151, v151, v9
v_mul_f32 v156, v156, v9
v_mul_f32 v157, v157, v9
v_mul_f32 v158, v158, v9
v_mul_f32 v159, v159, v9
v_mul_f32 v164, v164, v9
v_mul_f32 v165, v165, v9
v_mul_f32 v166, v166, v9
v_mul_f32 v167, v167, v9
v_mul_f32 v172, v172, v9
v_mul_f32 v173, v173, v9
v_mul_f32 v174, v174, v9
v_mul_f32 v175, v175, v9
v_mul_f32 v180, v180, v9
v_mul_f32 v181, v181, v9
v_mul_f32 v182, v182, v9
v_mul_f32 v183, v183, v9
v_mul_f32 v188, v188, v9
v_mul_f32 v189, v189, v9
v_mul_f32 v190, v190, v9
v_mul_f32 v191, v191, v9
v_mul_f32 v196, v196, v9
v_mul_f32 v197, v197, v9
v_mul_f32 v198, v198, v9
v_mul_f32 v199, v199, v9
v_mul_f32 v204, v204, v9
v_mul_f32 v205, v205, v9
v_mul_f32 v206, v206, v9
v_mul_f32 v207, v207, v9
v_mul_f32 v212, v212, v9
v_mul_f32 v213, v213, v9
v_mul_f32 v214, v214, v9
v_mul_f32 v215, v215, v9
v_mul_f32 v220, v220, v9
v_mul_f32 v221, v221, v9
v_mul_f32 v222, v222, v9
v_mul_f32 v223, v223, v9
v_mul_f32 v228, v228, v9
v_mul_f32 v229, v229, v9
v_mul_f32 v230, v230, v9
v_mul_f32 v231, v231, v9
v_mul_f32 v236, v236, v9
v_mul_f32 v237, v237, v9
v_mul_f32 v238, v238, v9
v_mul_f32 v239, v239, v9
v_mul_f32 v244, v244, v9
v_mul_f32 v245, v245, v9
v_mul_f32 v246, v246, v9
v_mul_f32 v247, v247, v9
v_mul_f32 v252, v252, v9
v_mul_f32 v253, v253, v9
v_mul_f32 v254, v254, v9
v_mul_f32 v255, v255, v9
v_sub_f32 v68, v68, v8
v_sub_f32 v69, v69, v8
v_sub_f32 v70, v70, v8
v_sub_f32 v71, v71, v8
v_sub_f32 v76, v76, v8
v_sub_f32 v77, v77, v8
v_sub_f32 v78, v78, v8
v_sub_f32 v79, v79, v8
v_sub_f32 v84, v84, v8
v_sub_f32 v85, v85, v8
v_sub_f32 v86, v86, v8
v_sub_f32 v87, v87, v8
v_sub_f32 v92, v92, v8
v_sub_f32 v93, v93, v8
v_sub_f32 v94, v94, v8
v_sub_f32 v95, v95, v8
v_exp_f32 v8, v68
v_exp_f32 v9, v69
v_exp_f32 v10, v70
v_exp_f32 v11, v71
s_nop 0
v_add_f32 v27, v8, v9
v_cvt_pk_bf16_f32 v120, v8, v9
v_add_f32 v27, v27, v10
v_add_f32 v27, v27, v11
v_cvt_pk_bf16_f32 v121, v10, v11
v_exp_f32 v12, v76
v_exp_f32 v13, v77
v_exp_f32 v14, v78
v_exp_f32 v15, v79
s_nop 0
v_add_f32 v27, v27, v12
v_add_f32 v27, v27, v13
v_cvt_pk_bf16_f32 v122, v12, v13
v_add_f32 v27, v27, v14
v_add_f32 v27, v27, v15
v_cvt_pk_bf16_f32 v123, v14, v15
v_exp_f32 v8, v84
v_exp_f32 v9, v85
v_exp_f32 v10, v86
v_exp_f32 v11, v87
s_nop 0
v_add_f32 v27, v27, v8
v_add_f32 v27, v27, v9
v_cvt_pk_bf16_f32 v124, v8, v9
v_add_f32 v27, v27, v10
v_add_f32 v27, v27, v11
v_cvt_pk_bf16_f32 v125, v10, v11
v_exp_f32 v12, v92
v_exp_f32 v13, v93
v_exp_f32 v14, v94
v_exp_f32 v15, v95
s_nop 0
v_add_f32 v27, v27, v12
v_add_f32 v27, v27, v13
v_cvt_pk_bf16_f32 v126, v12, v13
v_add_f32 v27, v27, v14
v_add_f32 v27, v27, v15
v_cvt_pk_bf16_f32 v127, v14, v15
s_nop 1
s_setpc_b64 s[16:17]
M_cntspinK:
Lp_9801:
buffer_load_dword v245, off, s[60:63], 0 sc1
s_waitcnt vmcnt(0)
v_cmp_gt_u32 vcc, 0x100, v245
s_cbranch_vccz Lpd_9802
s_sleep 8
s_sub_u32 s101, s101, 1
s_cbranch_scc0 Lp_9801
s_mov_b32 s101, 0
Lpd_9802:
s_branch Lg_1
M_ppspinK:
Lp_9803:
buffer_load_dword v230, v231, s[4:7], s52 offen sc1
s_waitcnt vmcnt(0)
v_cmp_gt_u32 vcc, 1, v230
s_cbranch_vccz Lpd_9804
s_sleep 8
s_sub_u32 s101, s101, 1
s_cbranch_scc0 Lp_9803
s_mov_b32 s101, 0
Lpd_9804:
s_branch M_ppokK
M_cntspinV:
Lp_9805:
buffer_load_dword v245, off, s[60:63], 0 sc1
s_waitcnt vmcnt(0)
v_cmp_gt_u32 vcc, 0x100, v245
s_cbranch_vccz Lpd_9806
s_sleep 8
s_sub_u32 s101, s101, 1
s_cbranch_scc0 Lp_9805
s_mov_b32 s101, 0
Lpd_9806:
s_branch Lg_501
M_ppspinV:
Lp_9807:
buffer_load_dword v230, v231, s[4:7], s52 offen sc1
s_waitcnt vmcnt(0)
v_cmp_gt_u32 vcc, 1, v230
s_cbranch_vccz Lpd_9808
s_sleep 8
s_sub_u32 s101, s101, 1
s_cbranch_scc0 Lp_9807
s_mov_b32 s101, 0
Lpd_9808:
s_branch M_ppokV
M_end:
s_endpgm
.section .rodata,"a"
.p2align 6
.amdhsa_kernel concat_heads__ssm_conv_h3__compressed_kv_cla__prompt_kernel
  .amdhsa_next_free_vgpr 512
  .amdhsa_next_free_sgpr 102
  .amdhsa_accum_offset 256
  .amdhsa_group_segment_fixed_size 0
  .amdhsa_kernarg_size 120
  .amdhsa_user_sgpr_count 2
  .amdhsa_user_sgpr_kernarg_segment_ptr 1
  .amdhsa_system_sgpr_workgroup_id_x 1
  .amdhsa_float_denorm_mode_32 3
  .amdhsa_float_denorm_mode_16_64 3
  .amdhsa_ieee_mode 0
  .amdhsa_dx10_clamp 0
.end_amdhsa_kernel
```

```asm
; @launch grid=(256,1,1) block=(256,1,1) lds=163840
.amdgcn_target "amdgcn-amd-amdhsa--gfx950"
.text
.globl concat_heads__ssm_conv_h3__compressed_kv_cla__prompt_kernel
.p2align 8
.type concat_heads__ssm_conv_h3__compressed_kv_cla__prompt_kernel,@function
concat_heads__ssm_conv_h3__compressed_kv_cla__prompt_kernel:
s_cmp_ge_u32 s2, 256
s_cbranch_scc1 M_end
s_load_dwordx16 s[64:79], s[0:1], 0
s_load_dwordx8 s[80:87], s[0:1], 64
s_load_dwordx4 s[88:91], s[0:1], 96
s_load_dwordx2 s[92:93], s[0:1], 112
s_getpc_b64 s[58:59]
M_pc:
s_lshr_b32 s22, s2, 3
s_lshl_b32 s22, s22, 5
v_and_b32 v26, 31, v0
v_add_u32 v26, s22, v26
v_lshlrev_b32 v26, 7, v26
v_min_u32 v26, M_end-M_pc, v26
v_mov_b32 v27, s59
v_add_co_u32 v26, vcc, s58, v26
s_nop 1
v_addc_co_u32 v27, vcc, 0, v27, vcc
global_load_dword v21, v[26:27], off
v_lshrrev_b32 v28, 6, v0
v_and_b32 v29, 63, v0
v_lshlrev_b32 v1, 4, v29
v_readfirstlane_b32 s3, v28
s_lshr_b32 s21, s2, 5
v_lshrrev_b32 v26, 7, v1
v_lshrrev_b32 v27, 1, v26
v_lshlrev_b32 v27, 4, v27
v_and_b32 v28, 0x70, v1
v_xor_b32 v27, v27, v28
v_mul_u32_u24 v26, 2048, v26
v_add_u32 v12, v26, v27
v_xor_b32 v27, 64, v27
v_add_u32 v26, v26, v27
v_add_u32 v13, 15360, v26
v_add_u32 v14, 30720, v12
v_add_u32 v15, 46080, v26
s_lshl_b32 s28, s3, 13
s_lshl_b32 s24, s21, 19
s_lshl_b32 s22, s3, 17
s_add_u32 s24, s24, s22
s_add_u32 s25, s24, 65536
s_mov_b32 s10, 4194304
s_mov_b32 s11, 0x20000
s_and_b32 s20, s2, 7
s_lshl_b32 s20, s20, 1
s_bfe_u32 s22, s2, 0x10003
s_add_u32 s20, s20, s22
v_lshrrev_b32 v26, 5, v29
v_and_b32 v27, 31, v29
s_and_b32 s22, s3, 1
s_lshl_b32 s22, s22, 2
v_or_b32 v28, s22, v26
v_lshlrev_b32 v28, 1, v28
v_xor_b32 v27, v27, v28
v_lshlrev_b32 v27, 4, v27
v_lshl_add_u32 v16, v26, 13, v27
v_xor_b32 v26, 64, v16
v_add_u32 v17, 15360, v26
v_add_u32 v18, 30720, v16
v_add_u32 v19, 46080, v26
s_lshl_b32 s29, s3, 12
s_lshl_b32 s26, s3, 16
s_lshl_b32 s22, s20, 9
s_add_u32 s26, s26, s22
s_add_u32 s27, s26, 262144
s_mov_b32 s14, 8388608
s_mov_b32 s15, 0x20000
s_mov_b32 s101, 0x40000
v_and_b32 v30, 15, v29
v_lshrrev_b32 v31, 4, v29
v_lshrrev_b32 v26, 1, v30
v_xor_b32 v26, v31, v26
v_lshlrev_b32 v26, 4, v26
v_lshl_add_u32 v2, v30, 7, v26
s_lshr_b32 s22, s3, 1
s_lshl_b32 s22, s22, 14
v_add_u32 v2, s22, v2
v_xor_b32 v3, 64, v2
v_lshrrev_b32 v26, 2, v30
v_and_b32 v27, 1, v31
v_lshl_or_b32 v27, v27, 2, v26
v_lshl_add_u32 v26, v31, 3, v26
v_lshlrev_b32 v26, 9, v26
v_lshl_add_u32 v26, v27, 5, v26
v_and_b32 v27, 3, v29
v_lshl_add_u32 v26, v27, 3, v26
s_and_b32 s22, s3, 1
s_lshl_b32 s22, s22, 8
s_add_u32 s22, s22, 0x10000
v_xor_b32 v4, s22, v26
v_xor_b32 v5, 32, v4
v_xor_b32 v6, 64, v4
v_xor_b32 v7, 96, v4
v_xor_b32 v8, 128, v4
v_xor_b32 v9, 160, v4
v_xor_b32 v10, 192, v4
v_xor_b32 v11, 224, v4
s_mov_b32 s19, 0x20000
s_cmp_eq_u32 s3, 2
s_cbranch_scc1 M_pf2
s_cmp_lg_u32 s3, 0
s_cbranch_scc1 M_pf3
s_mov_b32 s18, 8388608
s_mov_b32 s51, 8388608
s_mov_b32 s47, 524288
s_mov_b32 s43, 524288
s_lshl_b32 s22, s21, 16
s_lshl_b32 s23, s20, 9
s_add_u32 s22, s22, s23
v_bfe_u32 v26, v29, 2, 3
v_lshl_add_u32 v26, v26, 13, s22
v_and_b32 v27, 3, v29
v_lshl_add_u32 v20, v27, 7, v26
v_lshrrev_b32 v27, 5, v29
v_lshl_add_u32 v22, v27, 19, v20
v_cmp_gt_u32 vcc, 32, v29
s_branch M_pfd
M_pf2:
s_mov_b32 s18, 4194304
s_mov_b32 s51, 2048
s_mov_b32 s47, 256
s_mov_b32 s43, 0
s_lshl_b32 s22, s2, 14
v_bfe_u32 v26, v29, 1, 3
v_lshl_add_u32 v26, v26, 11, s22
v_and_b32 v27, 1, v29
v_lshl_add_u32 v20, v27, 7, v26
v_bfe_u32 v27, v29, 4, 1
v_lshl_add_u32 v22, v27, 8, v20
v_cmp_gt_u32 vcc, 16, v29
s_branch M_pfd
M_pf3:
s_mov_b32 s18, 0
s_mov_b32 s51, 3112960
s_mov_b32 s47, 622592
s_mov_b32 s43, 0
s_mul_i32 s22, s2, 2432
v_lshl_add_u32 v20, v29, 7, s22
v_mov_b32 v22, v20
v_cmp_gt_u32 vcc, 19, v29
M_pfd:
v_mov_b32 v26, 3221225472
s_nop 0
v_cndmask_b32 v20, v26, v20, vcc
s_bitcmp1_b32 s2, 4
s_waitcnt lgkmcnt(0)
s_mov_b64 s[8:9], s[78:79]
s_cselect_b64 s[12:13], s[84:85], s[82:83]
s_add_u32 m0, s28, 0
s_nop 0
buffer_load_dwordx4 v12, s[8:11], s24 offen offset:0 lds
buffer_load_dwordx4 v13, s[8:11], s24 offen offset:1024 lds
buffer_load_dwordx4 v14, s[8:11], s24 offen offset:2048 lds
buffer_load_dwordx4 v15, s[8:11], s24 offen offset:3072 lds
s_add_u32 s24, s24, 128
s_add_u32 m0, s28, 4096
s_nop 0
buffer_load_dwordx4 v12, s[8:11], s25 offen offset:0 lds
buffer_load_dwordx4 v13, s[8:11], s25 offen offset:1024 lds
buffer_load_dwordx4 v14, s[8:11], s25 offen offset:2048 lds
buffer_load_dwordx4 v15, s[8:11], s25 offen offset:3072 lds
s_add_u32 s25, s25, 128
s_add_u32 m0, s29, 65536
s_nop 0
buffer_load_dwordx4 v16, s[12:15], s26 offen offset:0 lds
buffer_load_dwordx4 v17, s[12:15], s26 offen offset:1024 lds
buffer_load_dwordx4 v18, s[12:15], s26 offen offset:2048 lds
buffer_load_dwordx4 v19, s[12:15], s26 offen offset:3072 lds
s_add_u32 s26, s26, 524288
s_add_u32 m0, s29, 81920
s_nop 0
buffer_load_dwordx4 v16, s[12:15], s27 offen offset:0 lds
buffer_load_dwordx4 v17, s[12:15], s27 offen offset:1024 lds
buffer_load_dwordx4 v18, s[12:15], s27 offen offset:2048 lds
buffer_load_dwordx4 v19, s[12:15], s27 offen offset:3072 lds
s_add_u32 s27, s27, 524288
s_mov_b64 exec, 0
s_bfe_u32 s22, s2, 0x10004
s_lshl_b32 s22, s22, 2
s_add_u32 s22, s22, s3
s_cmp_lg_u32 s22, 0
s_cbranch_scc1 M_tw1
s_call_b64 s[98:99], PAD_0
s_call_b64 s[98:99], PAD_8
s_branch M_td
M_tw1:
s_cmp_lg_u32 s22, 1
s_cbranch_scc1 M_tw2
s_call_b64 s[98:99], PAD_1
s_call_b64 s[98:99], PAD_9
s_branch M_td
M_tw2:
s_cmp_lg_u32 s22, 2
s_cbranch_scc1 M_tw3
s_call_b64 s[98:99], PAD_2
s_call_b64 s[98:99], PAD_6
s_call_b64 s[98:99], PAD_10
s_branch M_td
M_tw3:
s_cmp_lg_u32 s22, 3
s_cbranch_scc1 M_tw4
s_call_b64 s[98:99], PAD_3
s_call_b64 s[98:99], PAD_7
s_call_b64 s[98:99], PAD_11
s_branch M_td
M_tw4:
s_cmp_lg_u32 s22, 4
s_cbranch_scc1 M_tw5
s_call_b64 s[98:99], PAD_22
s_branch M_td
M_tw5:
s_cmp_lg_u32 s22, 5
s_cbranch_scc1 M_tw6
s_call_b64 s[98:99], PAD_23
s_branch M_td
M_tw6:
s_cmp_lg_u32 s22, 6
s_cbranch_scc1 M_tw7
s_call_b64 s[98:99], PAD_24
s_branch M_td
M_tw7:
s_call_b64 s[98:99], PAD_21
M_td:
s_mov_b64 exec, -1
s_add_u32 m0, s28, 32768
s_nop 0
buffer_load_dwordx4 v12, s[8:11], s24 offen offset:0 lds
buffer_load_dwordx4 v13, s[8:11], s24 offen offset:1024 lds
buffer_load_dwordx4 v14, s[8:11], s24 offen offset:2048 lds
buffer_load_dwordx4 v15, s[8:11], s24 offen offset:3072 lds
s_add_u32 s24, s24, 128
s_add_u32 m0, s28, 36864
s_nop 0
buffer_load_dwordx4 v12, s[8:11], s25 offen offset:0 lds
buffer_load_dwordx4 v13, s[8:11], s25 offen offset:1024 lds
buffer_load_dwordx4 v14, s[8:11], s25 offen offset:2048 lds
buffer_load_dwordx4 v15, s[8:11], s25 offen offset:3072 lds
s_add_u32 s25, s25, 128
s_cmp_eq_u32 s3, 0
s_cselect_b64 s[16:17], s[12:13], s[8:9]
buffer_load_dword v21, v22, s[16:19], s43 offen
s_add_u32 s43, s43, s47
s_add_u32 s43, s43, s47
s_mov_b32 s4, s92
s_mov_b32 s5, s93
s_mov_b32 s6, 268435456
s_mov_b32 s7, 0x20000
s_cmp_eq_u32 s3, 3
s_cselect_b64 s[40:41], s[76:77], s[80:81]
s_cselect_b32 s42, 1835008, 0
s_cmp_eq_u32 s3, 1
s_cselect_b32 s42, 3670016, s42
s_cmp_eq_u32 s3, 3
s_cselect_b64 s[44:45], s[86:87], s[72:73]
s_cselect_b32 s46, 3670016, 0
s_cmp_eq_u32 s3, 1
s_cselect_b32 s46, 1835008, s46
s_cmp_eq_u32 s3, 2
s_cselect_b64 s[40:41], s[64:65], s[40:41]
s_cselect_b32 s42, 1835008, s42
s_waitcnt vmcnt(9)
s_barrier
ds_read_b64_tr_b16 a[128:129], v4 offset:0
ds_read_b64_tr_b16 a[130:131], v4 offset:2048
ds_read_b64_tr_b16 a[132:133], v4 offset:16384
ds_read_b64_tr_b16 a[134:135], v4 offset:18432
ds_read_b128 a[0:3], v2 offset:0
ds_read_b128 a[4:7], v3 offset:0
ds_read_b128 a[8:11], v2 offset:2048
ds_read_b128 a[12:15], v3 offset:2048
ds_read_b128 a[16:19], v2 offset:4096
ds_read_b128 a[20:23], v3 offset:4096
ds_read_b128 a[24:27], v2 offset:6144
ds_read_b128 a[28:31], v3 offset:6144
ds_read_b128 a[32:35], v2 offset:8192
ds_read_b128 a[36:39], v3 offset:8192
ds_read_b128 a[40:43], v2 offset:10240
ds_read_b128 a[44:47], v3 offset:10240
ds_read_b128 a[48:51], v2 offset:12288
ds_read_b128 a[52:55], v3 offset:12288
ds_read_b128 a[56:59], v2 offset:14336
ds_read_b128 a[60:63], v3 offset:14336
s_add_u32 m0, s29, 98304
s_nop 0
buffer_load_dwordx4 v16, s[12:15], s26 offen offset:0 lds
buffer_load_dwordx4 v17, s[12:15], s26 offen offset:1024 lds
buffer_load_dwordx4 v18, s[12:15], s26 offen offset:2048 lds
buffer_load_dwordx4 v19, s[12:15], s26 offen offset:3072 lds
s_add_u32 s26, s26, 524288
s_waitcnt lgkmcnt(0)
s_barrier
s_bitcmp1_b32 s2, 4
s_cbranch_scc1 M_V
s_branch M_K
M_t2B:
s_mov_b64 exec, 0
s_cmp_lg_u32 s3, 0
s_cbranch_scc1 M_uw1
s_call_b64 s[98:99], PAD_32
s_call_b64 s[98:99], PAD_16
s_branch M_ud
M_uw1:
s_cmp_lg_u32 s3, 1
s_cbranch_scc1 M_uw2
s_call_b64 s[98:99], PAD_9
s_call_b64 s[98:99], PAD_33
s_call_b64 s[98:99], PAD_13
s_branch M_ud
M_uw2:
s_cmp_lg_u32 s3, 2
s_cbranch_scc1 M_uw3
s_call_b64 s[98:99], PAD_10
s_call_b64 s[98:99], PAD_34
s_call_b64 s[98:99], PAD_14
s_branch M_ud
M_uw3:
s_call_b64 s[98:99], PAD_11
s_call_b64 s[98:99], PAD_15
M_ud:
s_mov_b64 exec, -1
s_branch M_t2Br
M_t2A:
s_mov_b64 exec, 0
s_lshl_b32 s22, s24, 2
s_add_u32 s22, s22, s3
s_cmp_lg_u32 s22, 0
s_cbranch_scc1 M_vw1
s_call_b64 s[98:99], PAD_32
s_call_b64 s[98:99], PAD_16
s_branch M_vd
M_vw1:
s_cmp_lg_u32 s22, 1
s_cbranch_scc1 M_vw2
s_call_b64 s[98:99], PAD_13
s_branch M_vd
M_vw2:
s_cmp_lg_u32 s22, 2
s_cbranch_scc1 M_vw3
s_call_b64 s[98:99], PAD_14
s_call_b64 s[98:99], PAD_19
s_branch M_vd
M_vw3:
s_cmp_lg_u32 s22, 3
s_cbranch_scc1 M_vw4
s_call_b64 s[98:99], PAD_15
s_call_b64 s[98:99], PAD_20
s_branch M_vd
M_vw4:
s_cmp_lg_u32 s22, 4
s_cbranch_scc1 M_vw5
s_call_b64 s[98:99], PAD_12
s_call_b64 s[98:99], PAD_16
s_branch M_vd
M_vw5:
s_cmp_lg_u32 s22, 5
s_cbranch_scc1 M_vw6
s_call_b64 s[98:99], PAD_13
s_branch M_vd
M_vw6:
s_cmp_lg_u32 s22, 6
s_cbranch_scc1 M_vw7
s_call_b64 s[98:99], PAD_14
s_branch M_vd
M_vw7:
s_call_b64 s[98:99], PAD_15
M_vd:
s_mov_b64 exec, -1
s_branch M_t2Ar
M_tret:
s_setpc_b64 s[98:99]
.p2align 12
PAD_0:
s_cbranch_execz PAD_4
M_K:
v_mfma_f32_16x16x32_bf16 v[32:35], a[128:131], a[0:3], 0
s_add_u32 m0, s29, 114688
ds_read_b64_tr_b16 a[136:137], v5 offset:0
v_mfma_f32_16x16x32_bf16 v[32:35], a[132:135], a[4:7], v[32:35]
s_mov_b32 s32, 8192
buffer_load_dwordx4 v16, s[12:15], s27 offen offset:0 lds
v_mfma_f32_16x16x32_bf16 v[40:43], a[128:131], a[8:11], 0
s_mov_b32 s33, 8192
ds_read_b64_tr_b16 a[138:139], v5 offset:2048
v_mfma_f32_16x16x32_bf16 v[40:43], a[132:135], a[12:15], v[40:43]
s_mov_b32 s34, 8192
v_mfma_f32_16x16x32_bf16 v[48:51], a[128:131], a[16:19], 0
s_mov_b32 s35, 4294910976
ds_read_b64_tr_b16 a[140:141], v5 offset:16384
v_mfma_f32_16x16x32_bf16 v[48:51], a[132:135], a[20:23], v[48:51]
s_mov_b32 s36, 4294910976
buffer_load_dwordx4 v17, s[12:15], s27 offen offset:1024 lds
v_mfma_f32_16x16x32_bf16 v[56:59], a[128:131], a[24:27], 0
s_mov_b32 s30, 8
ds_read_b64_tr_b16 a[142:143], v5 offset:18432
v_mfma_f32_16x16x32_bf16 v[56:59], a[132:135], a[28:31], v[56:59]
s_mov_b32 s82, 3221225472
v_mfma_f32_16x16x32_bf16 v[64:67], a[128:131], a[32:35], 0
s_mul_hi_u32 s38, s2, 613566757
v_mfma_f32_16x16x32_bf16 v[64:67], a[132:135], a[36:39], v[64:67]
s_mul_i32 s39, s38, 7
buffer_load_dwordx4 v18, s[12:15], s27 offen offset:2048 lds
v_mfma_f32_16x16x32_bf16 v[72:75], a[128:131], a[40:43], 0
s_sub_u32 s39, s2, s39
v_mov_b32 v246, 0
v_mov_b32 v229, 0
v_mfma_f32_16x16x32_bf16 v[72:75], a[132:135], a[44:47], v[72:75]
v_mov_b32 v231, 0
v_mfma_f32_16x16x32_bf16 v[80:83], a[128:131], a[48:51], 0
s_mov_b32 s60, s90
v_mfma_f32_16x16x32_bf16 v[80:83], a[132:135], a[52:55], v[80:83]
s_mov_b32 s61, s91
buffer_load_dwordx4 v19, s[12:15], s27 offen offset:3072 lds
v_mfma_f32_16x16x32_bf16 v[88:91], a[128:131], a[56:59], 0
s_add_u32 s27, s27, 524288
v_mfma_f32_16x16x32_bf16 v[88:91], a[132:135], a[60:63], v[88:91]
s_waitcnt lgkmcnt(0)
s_mov_b32 s62, 256
v_mfma_f32_16x16x32_bf16 v[36:39], a[136:139], a[0:3], 0
s_add_u32 m0, s28, 0
ds_read_b64_tr_b16 a[128:129], v6 offset:0
v_mfma_f32_16x16x32_bf16 v[36:39], a[140:143], a[4:7], v[36:39]
s_mov_b32 s63, 0x20000
buffer_load_dwordx4 v12, s[8:11], s24 offen offset:0 lds
v_mfma_f32_16x16x32_bf16 v[44:47], a[136:139], a[8:11], 0
s_mul_hi_u32 s55, s2, 1431655766
ds_read_b64_tr_b16 a[130:131], v6 offset:2048
v_mfma_f32_16x16x32_bf16 v[44:47], a[140:143], a[12:15], v[44:47]
s_mul_i32 s55, s55, 3
v_mfma_f32_16x16x32_bf16 v[52:55], a[136:139], a[16:19], 0
s_sub_u32 s55, s2, s55
ds_read_b64_tr_b16 a[132:133], v6 offset:16384
v_mfma_f32_16x16x32_bf16 v[52:55], a[140:143], a[20:23], v[52:55]
s_add_u32 s55, s55, 5
buffer_load_dwordx4 v13, s[8:11], s24 offen offset:1024 lds
v_mfma_f32_16x16x32_bf16 v[60:63], a[136:139], a[24:27], 0
s_lshr_b32 s22, s2, 4
ds_read_b64_tr_b16 a[134:135], v6 offset:18432
v_mfma_f32_16x16x32_bf16 v[60:63], a[140:143], a[28:31], v[60:63]
s_lshl_b32 s23, s20, 5
v_mfma_f32_16x16x32_bf16 v[68:71], a[136:139], a[32:35], 0
s_add_u32 s23, s23, s22
v_mfma_f32_16x16x32_bf16 v[68:71], a[140:143], a[36:39], v[68:71]
s_lshl_b32 s23, s23, 2
buffer_load_dwordx4 v14, s[8:11], s24 offen offset:2048 lds
v_mfma_f32_16x16x32_bf16 v[76:79], a[136:139], a[40:43], 0
s_and_b32 s22, s2, 16
v_mfma_f32_16x16x32_bf16 v[76:79], a[140:143], a[44:47], v[76:79]
s_lshl_b32 s22, s22, 7
v_mfma_f32_16x16x32_bf16 v[84:87], a[136:139], a[48:51], 0
s_add_u32 s23, s23, s22
v_mov_b32 v28, 3221225472
v_writelane_b32 v28, s23, 0
v_mfma_f32_16x16x32_bf16 v[84:87], a[140:143], a[52:55], v[84:87]
s_add_u32 s56, s23, 16384
buffer_load_dwordx4 v15, s[8:11], s24 offen offset:3072 lds
v_mfma_f32_16x16x32_bf16 v[92:95], a[136:139], a[56:59], 0
s_add_u32 s24, s24, 128
v_writelane_b32 v28, s56, 1
v_mfma_f32_16x16x32_bf16 v[92:95], a[140:143], a[60:63], v[92:95]
s_waitcnt lgkmcnt(0)
s_add_u32 s56, s23, 4096
v_writelane_b32 v28, s56, 2
v_mfma_f32_16x16x32_bf16 v[96:99], a[128:131], a[0:3], 0
s_add_u32 m0, s28, 4096
ds_read_b64_tr_b16 a[136:137], v7 offset:0
v_mfma_f32_16x16x32_bf16 v[96:99], a[132:135], a[4:7], v[96:99]
s_sub_u32 s37, 15, s21
buffer_load_dwordx4 v12, s[8:11], s25 offen offset:0 lds
v_mfma_f32_16x16x32_bf16 v[104:107], a[128:131], a[8:11], 0
ds_read_b64_tr_b16 a[138:139], v7 offset:2048
v_mfma_f32_16x16x32_bf16 v[104:107], a[132:135], a[12:15], v[104:107]
v_mfma_f32_16x16x32_bf16 v[112:115], a[128:131], a[16:19], 0
ds_read_b64_tr_b16 a[140:141], v7 offset:16384
v_mfma_f32_16x16x32_bf16 v[112:115], a[132:135], a[20:23], v[112:115]
buffer_load_dwordx4 v13, s[8:11], s25 offen offset:1024 lds
v_mfma_f32_16x16x32_bf16 v[120:123], a[128:131], a[24:27], 0
ds_read_b64_tr_b16 a[142:143], v7 offset:18432
v_mfma_f32_16x16x32_bf16 v[120:123], a[132:135], a[28:31], v[120:123]
v_mfma_f32_16x16x32_bf16 v[128:131], a[128:131], a[32:35], 0
v_mfma_f32_16x16x32_bf16 v[128:131], a[132:135], a[36:39], v[128:131]
buffer_load_dwordx4 v14, s[8:11], s25 offen offset:2048 lds
v_mfma_f32_16x16x32_bf16 v[136:139], a[128:131], a[40:43], 0
v_mfma_f32_16x16x32_bf16 v[136:139], a[132:135], a[44:47], v[136:139]
v_mfma_f32_16x16x32_bf16 v[144:147], a[128:131], a[48:51], 0
v_mfma_f32_16x16x32_bf16 v[144:147], a[132:135], a[52:55], v[144:147]
buffer_load_dwordx4 v15, s[8:11], s25 offen offset:3072 lds
v_mfma_f32_16x16x32_bf16 v[152:155], a[128:131], a[56:59], 0
s_add_u32 s25, s25, 128
v_mfma_f32_16x16x32_bf16 v[152:155], a[132:135], a[60:63], v[152:155]
s_waitcnt vmcnt(17) lgkmcnt(0)
s_barrier
v_mfma_f32_16x16x32_bf16 v[100:103], a[136:139], a[0:3], 0
ds_read_b64_tr_b16 a[128:129], v8 offset:0
v_mfma_f32_16x16x32_bf16 v[100:103], a[140:143], a[4:7], v[100:103]
buffer_load_dword v21, v20, s[16:19], s43 offen
v_mfma_f32_16x16x32_bf16 v[108:111], a[136:139], a[8:11], 0
s_add_u32 s43, s43, s47
ds_read_b64_tr_b16 a[130:131], v8 offset:2048
v_mfma_f32_16x16x32_bf16 v[108:111], a[140:143], a[12:15], v[108:111]
s_cmp_ge_u32 s43, s51
v_mfma_f32_16x16x32_bf16 v[116:119], a[136:139], a[16:19], 0
s_cselect_b32 s43, 0, s43
ds_read_b64_tr_b16 a[132:133], v8 offset:16384
v_mfma_f32_16x16x32_bf16 v[116:119], a[140:143], a[20:23], v[116:119]
s_cselect_b32 s51, s42, s51
v_mfma_f32_16x16x32_bf16 v[124:127], a[136:139], a[24:27], 0
s_cselect_b64 s[16:17], s[40:41], s[16:17]
ds_read_b64_tr_b16 a[134:135], v8 offset:18432
v_mfma_f32_16x16x32_bf16 v[124:127], a[140:143], a[28:31], v[124:127]
s_cselect_b32 s18, s42, s18
v_mfma_f32_16x16x32_bf16 v[132:135], a[136:139], a[32:35], 0
s_cselect_b64 s[40:41], s[44:45], s[40:41]
ds_read_b128 a[64:67], v2 offset:32768
v_mfma_f32_16x16x32_bf16 v[132:135], a[140:143], a[36:39], v[132:135]
s_cselect_b32 s42, s46, s42
v_mfma_f32_16x16x32_bf16 v[140:143], a[136:139], a[40:43], 0
s_cselect_b32 s46, 0, s46
ds_read_b128 a[68:71], v3 offset:32768
v_mfma_f32_16x16x32_bf16 v[140:143], a[140:143], a[44:47], v[140:143]
ds_read_b128 a[72:75], v2 offset:34816
v_mfma_f32_16x16x32_bf16 v[148:151], a[136:139], a[48:51], 0
ds_read_b128 a[76:79], v3 offset:34816
v_mfma_f32_16x16x32_bf16 v[148:151], a[140:143], a[52:55], v[148:151]
buffer_load_dword v21, v20, s[16:19], s43 offen
v_mfma_f32_16x16x32_bf16 v[156:159], a[136:139], a[56:59], 0
s_add_u32 s43, s43, s47
ds_read_b128 a[80:83], v2 offset:36864
v_mfma_f32_16x16x32_bf16 v[156:159], a[140:143], a[60:63], v[156:159]
s_waitcnt lgkmcnt(5)
s_cmp_ge_u32 s43, s51
ds_read_b128 a[84:87], v3 offset:36864
v_mfma_f32_16x16x32_bf16 v[160:163], a[128:131], a[0:3], 0
s_cselect_b32 s43, 0, s43
ds_read_b64_tr_b16 a[136:137], v9 offset:0
v_mfma_f32_16x16x32_bf16 v[160:163], a[132:135], a[4:7], v[160:163]
s_cselect_b32 s51, s42, s51
v_mfma_f32_16x16x32_bf16 v[168:171], a[128:131], a[8:11], 0
s_cselect_b64 s[16:17], s[40:41], s[16:17]
ds_read_b64_tr_b16 a[138:139], v9 offset:2048
v_mfma_f32_16x16x32_bf16 v[168:171], a[132:135], a[12:15], v[168:171]
s_cselect_b32 s18, s42, s18
v_mfma_f32_16x16x32_bf16 v[176:179], a[128:131], a[16:19], 0
s_cselect_b64 s[40:41], s[44:45], s[40:41]
ds_read_b64_tr_b16 a[140:141], v9 offset:16384
v_mfma_f32_16x16x32_bf16 v[176:179], a[132:135], a[20:23], v[176:179]
s_cselect_b32 s42, s46, s42
v_mfma_f32_16x16x32_bf16 v[184:187], a[128:131], a[24:27], 0
s_cselect_b32 s46, 0, s46
ds_read_b64_tr_b16 a[142:143], v9 offset:18432
v_mfma_f32_16x16x32_bf16 v[184:187], a[132:135], a[28:31], v[184:187]
s_bitcmp1_b32 s2, 4
s_cselect_b32 s37, s21, s37
s_lshl_b32 s56, s37, 5
v_mfma_f32_16x16x32_bf16 v[192:195], a[128:131], a[32:35], 0
s_add_u32 s56, s56, s20
s_lshl_b32 s56, s56, 2
s_add_u32 s56, s56, 8192
v_mfma_f32_16x16x32_bf16 v[192:195], a[132:135], a[36:39], v[192:195]
v_writelane_b32 v28, s56, 3
v_mfma_f32_16x16x32_bf16 v[200:203], a[128:131], a[40:43], 0
s_add_u32 s56, s56, 2048
ds_read_b128 a[88:91], v2 offset:38912
v_writelane_b32 v28, s56, 6
v_mfma_f32_16x16x32_bf16 v[200:203], a[132:135], a[44:47], v[200:203]
s_lshl_b32 s56, s2, 2
s_add_u32 s56, s56, 12288
ds_read_b128 a[92:95], v3 offset:38912
v_mfma_f32_16x16x32_bf16 v[208:211], a[128:131], a[48:51], 0
s_waitcnt lgkmcnt(2)
ds_read_b128 a[96:99], v2 offset:40960
v_writelane_b32 v28, s56, 4
v_mfma_f32_16x16x32_bf16 v[208:211], a[132:135], a[52:55], v[208:211]
s_lshl_b32 s56, s39, 5
s_add_u32 s56, s56, s38
s_lshl_b32 s56, s56, 2
v_mfma_f32_16x16x32_bf16 v[216:219], a[128:131], a[56:59], 0
s_add_u32 s56, s56, 20480
s_cmp_lt_u32 s2, 224
ds_read_b128 a[100:103], v3 offset:40960
v_mfma_f32_16x16x32_bf16 v[216:219], a[132:135], a[60:63], v[216:219]
s_cselect_b32 s56, s56, 3221225472
ds_read_b128 a[104:107], v2 offset:43008
v_writelane_b32 v28, s56, 7
v_mfma_f32_16x16x32_bf16 v[164:167], a[136:139], a[0:3], 0
s_cmp_eq_u32 s3, 0
s_cselect_b32 s56, 94371840, 3221225472
ds_read_b64_tr_b16 a[128:129], v10 offset:0
v_mfma_f32_16x16x32_bf16 v[164:167], a[140:143], a[4:7], v[164:167]
buffer_store_dword v246, v28, s[4:7], s56 offen sc1
v_mfma_f32_16x16x32_bf16 v[172:175], a[136:139], a[8:11], 0
ds_read_b64_tr_b16 a[130:131], v10 offset:2048
v_mov_b32 v27, 1
v_mfma_f32_16x16x32_bf16 v[172:175], a[140:143], a[12:15], v[172:175]
v_cmp_eq_u32 vcc, 0, v0
v_mov_b32 v26, 3221225472
v_mfma_f32_16x16x32_bf16 v[180:183], a[136:139], a[16:19], 0
s_lshl_b32 s31, s20, 20
s_lshl_b32 s22, s21, 17
ds_read_b64_tr_b16 a[132:133], v10 offset:16384
v_mfma_f32_16x16x32_bf16 v[180:183], a[140:143], a[20:23], v[180:183]
v_cndmask_b32 v26, v26, v246, vcc
v_mfma_f32_16x16x32_bf16 v[188:191], a[136:139], a[24:27], 0
s_add_u32 s31, s31, s22
s_lshr_b32 s22, s3, 1
ds_read_b64_tr_b16 a[134:135], v10 offset:18432
v_mfma_f32_16x16x32_bf16 v[188:191], a[140:143], a[28:31], v[188:191]
s_lshl_b32 s22, s22, 16
s_add_u32 s31, s31, s22
s_and_b32 s22, s3, 1
v_mfma_f32_16x16x32_bf16 v[196:199], a[136:139], a[32:35], 0
s_lshl_b32 s22, s22, 12
s_add_u32 s31, s31, s22
v_mfma_f32_16x16x32_bf16 v[196:199], a[140:143], a[36:39], v[196:199]
v_mfma_f32_16x16x32_bf16 v[204:207], a[136:139], a[40:43], 0
ds_read_b128 a[108:111], v3 offset:43008
v_mfma_f32_16x16x32_bf16 v[204:207], a[140:143], a[44:47], v[204:207]
ds_read_b128 a[112:115], v2 offset:45056
v_mfma_f32_16x16x32_bf16 v[212:215], a[136:139], a[48:51], 0
ds_read_b128 a[116:119], v3 offset:45056
v_mfma_f32_16x16x32_bf16 v[212:215], a[140:143], a[52:55], v[212:215]
v_mfma_f32_16x16x32_bf16 v[220:223], a[136:139], a[56:59], 0
ds_read_b128 a[120:123], v2 offset:47104
v_mfma_f32_16x16x32_bf16 v[220:223], a[140:143], a[60:63], v[220:223]
s_waitcnt lgkmcnt(4)
ds_read_b128 a[124:127], v3 offset:47104
v_mfma_f32_16x16x32_bf16 a[192:195], a[128:131], a[0:3], 0
ds_read_b64_tr_b16 a[136:137], v11 offset:0
v_mfma_f32_16x16x32_bf16 a[192:195], a[132:135], a[4:7], a[192:195]
v_mfma_f32_16x16x32_bf16 a[200:203], a[128:131], a[8:11], 0
ds_read_b64_tr_b16 a[138:139], v11 offset:2048
v_mfma_f32_16x16x32_bf16 a[200:203], a[132:135], a[12:15], a[200:203]
v_mfma_f32_16x16x32_bf16 a[208:211], a[128:131], a[16:19], 0
ds_read_b64_tr_b16 a[140:141], v11 offset:16384
v_mfma_f32_16x16x32_bf16 a[208:211], a[132:135], a[20:23], a[208:211]
v_mfma_f32_16x16x32_bf16 a[216:219], a[128:131], a[24:27], 0
ds_read_b64_tr_b16 a[142:143], v11 offset:18432
v_mfma_f32_16x16x32_bf16 a[216:219], a[132:135], a[28:31], a[216:219]
v_mfma_f32_16x16x32_bf16 a[224:227], a[128:131], a[32:35], 0
v_mfma_f32_16x16x32_bf16 a[224:227], a[132:135], a[36:39], a[224:227]
v_mfma_f32_16x16x32_bf16 a[232:235], a[128:131], a[40:43], 0
v_mfma_f32_16x16x32_bf16 a[232:235], a[132:135], a[44:47], a[232:235]
v_mfma_f32_16x16x32_bf16 a[240:243], a[128:131], a[48:51], 0
v_mfma_f32_16x16x32_bf16 a[240:243], a[132:135], a[52:55], a[240:243]
v_mfma_f32_16x16x32_bf16 a[248:251], a[128:131], a[56:59], 0
s_waitcnt vmcnt(3) lgkmcnt(0)
v_mfma_f32_16x16x32_bf16 a[248:251], a[132:135], a[60:63], a[248:251]
s_barrier
v_mfma_f32_16x16x32_bf16 a[196:199], a[136:139], a[0:3], 0
s_add_u32 m0, s29, 65536
ds_read_b64_tr_b16 a[128:129], v4 offset:32768
v_mfma_f32_16x16x32_bf16 a[196:199], a[140:143], a[4:7], a[196:199]
buffer_load_dwordx4 v16, s[12:15], s26 offen offset:0 lds
v_mfma_f32_16x16x32_bf16 a[204:207], a[136:139], a[8:11], 0
ds_read_b64_tr_b16 a[130:131], v4 offset:34816
v_mfma_f32_16x16x32_bf16 a[204:207], a[140:143], a[12:15], a[204:207]
v_mfma_f32_16x16x32_bf16 a[212:215], a[136:139], a[16:19], 0
ds_read_b64_tr_b16 a[132:133], v4 offset:49152
v_mfma_f32_16x16x32_bf16 a[212:215], a[140:143], a[20:23], a[212:215]
buffer_load_dwordx4 v17, s[12:15], s26 offen offset:1024 lds
v_mfma_f32_16x16x32_bf16 a[220:223], a[136:139], a[24:27], 0
ds_read_b64_tr_b16 a[134:135], v4 offset:51200
v_mfma_f32_16x16x32_bf16 a[220:223], a[140:143], a[28:31], a[220:223]
v_mfma_f32_16x16x32_bf16 a[228:231], a[136:139], a[32:35], 0
v_mfma_f32_16x16x32_bf16 a[228:231], a[140:143], a[36:39], a[228:231]
buffer_load_dwordx4 v18, s[12:15], s26 offen offset:2048 lds
v_mfma_f32_16x16x32_bf16 a[236:239], a[136:139], a[40:43], 0
v_mfma_f32_16x16x32_bf16 a[236:239], a[140:143], a[44:47], a[236:239]
v_mfma_f32_16x16x32_bf16 a[244:247], a[136:139], a[48:51], 0
v_mfma_f32_16x16x32_bf16 a[244:247], a[140:143], a[52:55], a[244:247]
buffer_load_dwordx4 v19, s[12:15], s26 offen offset:3072 lds
v_mfma_f32_16x16x32_bf16 a[252:255], a[136:139], a[56:59], 0
s_add_u32 s26, s26, 524288
v_mfma_f32_16x16x32_bf16 a[252:255], a[140:143], a[60:63], a[252:255]
s_waitcnt lgkmcnt(0)
Lg_1:
v_mfma_f32_16x16x32_bf16 v[32:35], a[128:131], a[64:67], v[32:35]
s_add_u32 m0, s29, 81920
ds_read_b64_tr_b16 a[136:137], v5 offset:32768
v_mfma_f32_16x16x32_bf16 v[32:35], a[132:135], a[68:71], v[32:35]
buffer_load_dwordx4 v16, s[12:15], s27 offen offset:0 lds
v_mfma_f32_16x16x32_bf16 v[40:43], a[128:131], a[72:75], v[40:43]
ds_read_b64_tr_b16 a[138:139], v5 offset:34816
v_mfma_f32_16x16x32_bf16 v[40:43], a[132:135], a[76:79], v[40:43]
v_mfma_f32_16x16x32_bf16 v[48:51], a[128:131], a[80:83], v[48:51]
ds_read_b64_tr_b16 a[140:141], v5 offset:49152
v_mfma_f32_16x16x32_bf16 v[48:51], a[132:135], a[84:87], v[48:51]
buffer_load_dwordx4 v17, s[12:15], s27 offen offset:1024 lds
v_mfma_f32_16x16x32_bf16 v[56:59], a[128:131], a[88:91], v[56:59]
ds_read_b64_tr_b16 a[142:143], v5 offset:51200
v_mfma_f32_16x16x32_bf16 v[56:59], a[132:135], a[92:95], v[56:59]
v_mfma_f32_16x16x32_bf16 v[64:67], a[128:131], a[96:99], v[64:67]
ds_read_b128 a[0:3], v2 offset:0
v_mfma_f32_16x16x32_bf16 v[64:67], a[132:135], a[100:103], v[64:67]
buffer_load_dwordx4 v18, s[12:15], s27 offen offset:2048 lds
v_mfma_f32_16x16x32_bf16 v[72:75], a[128:131], a[104:107], v[72:75]
ds_read_b128 a[4:7], v3 offset:0
v_mfma_f32_16x16x32_bf16 v[72:75], a[132:135], a[108:111], v[72:75]
v_mfma_f32_16x16x32_bf16 v[80:83], a[128:131], a[112:115], v[80:83]
v_mfma_f32_16x16x32_bf16 v[80:83], a[132:135], a[116:119], v[80:83]
buffer_load_dwordx4 v19, s[12:15], s27 offen offset:3072 lds
v_mfma_f32_16x16x32_bf16 v[88:91], a[128:131], a[120:123], v[88:91]
s_add_u32 s27, s27, 524288
ds_read_b128 a[8:11], v2 offset:2048
v_mfma_f32_16x16x32_bf16 v[88:91], a[132:135], a[124:127], v[88:91]
s_waitcnt lgkmcnt(3)
v_mfma_f32_16x16x32_bf16 v[36:39], a[136:139], a[64:67], v[36:39]
s_add_u32 m0, s28, 32768
ds_read_b64_tr_b16 a[128:129], v6 offset:32768
v_mfma_f32_16x16x32_bf16 v[36:39], a[140:143], a[68:71], v[36:39]
buffer_load_dwordx4 v12, s[8:11], s24 offen offset:0 lds
v_mfma_f32_16x16x32_bf16 v[44:47], a[136:139], a[72:75], v[44:47]
ds_read_b64_tr_b16 a[130:131], v6 offset:34816
v_mfma_f32_16x16x32_bf16 v[44:47], a[140:143], a[76:79], v[44:47]
v_mfma_f32_16x16x32_bf16 v[52:55], a[136:139], a[80:83], v[52:55]
ds_read_b64_tr_b16 a[132:133], v6 offset:49152
v_mfma_f32_16x16x32_bf16 v[52:55], a[140:143], a[84:87], v[52:55]
buffer_load_dwordx4 v13, s[8:11], s24 offen offset:1024 lds
v_mfma_f32_16x16x32_bf16 v[60:63], a[136:139], a[88:91], v[60:63]
ds_read_b64_tr_b16 a[134:135], v6 offset:51200
v_mfma_f32_16x16x32_bf16 v[60:63], a[140:143], a[92:95], v[60:63]
v_mfma_f32_16x16x32_bf16 v[68:71], a[136:139], a[96:99], v[68:71]
ds_read_b128 a[12:15], v3 offset:2048
v_mfma_f32_16x16x32_bf16 v[68:71], a[140:143], a[100:103], v[68:71]
buffer_load_dwordx4 v14, s[8:11], s24 offen offset:2048 lds
v_mfma_f32_16x16x32_bf16 v[76:79], a[136:139], a[104:107], v[76:79]
v_mfma_f32_16x16x32_bf16 v[76:79], a[140:143], a[108:111], v[76:79]
v_mfma_f32_16x16x32_bf16 v[84:87], a[136:139], a[112:115], v[84:87]
ds_read_b128 a[16:19], v2 offset:4096
v_mfma_f32_16x16x32_bf16 v[84:87], a[140:143], a[116:119], v[84:87]
buffer_load_dwordx4 v15, s[8:11], s24 offen offset:3072 lds
v_mfma_f32_16x16x32_bf16 v[92:95], a[136:139], a[120:123], v[92:95]
s_add_u32 s24, s24, 128
ds_read_b128 a[20:23], v3 offset:4096
v_mfma_f32_16x16x32_bf16 v[92:95], a[140:143], a[124:127], v[92:95]
s_waitcnt lgkmcnt(3)
v_mfma_f32_16x16x32_bf16 v[96:99], a[128:131], a[64:67], v[96:99]
s_add_u32 m0, s28, 36864
ds_read_b64_tr_b16 a[136:137], v7 offset:32768
v_mfma_f32_16x16x32_bf16 v[96:99], a[132:135], a[68:71], v[96:99]
buffer_load_dwordx4 v12, s[8:11], s25 offen offset:0 lds
v_mfma_f32_16x16x32_bf16 v[104:107], a[128:131], a[72:75], v[104:107]
ds_read_b64_tr_b16 a[138:139], v7 offset:34816
v_mfma_f32_16x16x32_bf16 v[104:107], a[132:135], a[76:79], v[104:107]
v_mfma_f32_16x16x32_bf16 v[112:115], a[128:131], a[80:83], v[112:115]
ds_read_b64_tr_b16 a[140:141], v7 offset:49152
v_mfma_f32_16x16x32_bf16 v[112:115], a[132:135], a[84:87], v[112:115]
buffer_load_dwordx4 v13, s[8:11], s25 offen offset:1024 lds
v_mfma_f32_16x16x32_bf16 v[120:123], a[128:131], a[88:91], v[120:123]
ds_read_b64_tr_b16 a[142:143], v7 offset:51200
v_mfma_f32_16x16x32_bf16 v[120:123], a[132:135], a[92:95], v[120:123]
v_mfma_f32_16x16x32_bf16 v[128:131], a[128:131], a[96:99], v[128:131]
v_mfma_f32_16x16x32_bf16 v[128:131], a[132:135], a[100:103], v[128:131]
buffer_load_dwordx4 v14, s[8:11], s25 offen offset:2048 lds
v_mfma_f32_16x16x32_bf16 v[136:139], a[128:131], a[104:107], v[136:139]
ds_read_b128 a[24:27], v2 offset:6144
v_mfma_f32_16x16x32_bf16 v[136:139], a[132:135], a[108:111], v[136:139]
v_mfma_f32_16x16x32_bf16 v[144:147], a[128:131], a[112:115], v[144:147]
ds_read_b128 a[28:31], v3 offset:6144
v_mfma_f32_16x16x32_bf16 v[144:147], a[132:135], a[116:119], v[144:147]
buffer_load_dwordx4 v15, s[8:11], s25 offen offset:3072 lds
v_mfma_f32_16x16x32_bf16 v[152:155], a[128:131], a[120:123], v[152:155]
s_add_u32 s25, s25, 128
v_mfma_f32_16x16x32_bf16 v[152:155], a[132:135], a[124:127], v[152:155]
s_waitcnt lgkmcnt(2)
v_mfma_f32_16x16x32_bf16 v[100:103], a[136:139], a[64:67], v[100:103]
ds_read_b64_tr_b16 a[128:129], v8 offset:32768
v_mfma_f32_16x16x32_bf16 v[100:103], a[140:143], a[68:71], v[100:103]
buffer_load_dword v21, v20, s[16:19], s43 offen
v_mfma_f32_16x16x32_bf16 v[108:111], a[136:139], a[72:75], v[108:111]
s_add_u32 s43, s43, s47
ds_read_b64_tr_b16 a[130:131], v8 offset:34816
v_mfma_f32_16x16x32_bf16 v[108:111], a[140:143], a[76:79], v[108:111]
s_cmp_ge_u32 s43, s51
v_mfma_f32_16x16x32_bf16 v[116:119], a[136:139], a[80:83], v[116:119]
s_cselect_b32 s43, 0, s43
ds_read_b64_tr_b16 a[132:133], v8 offset:49152
v_mfma_f32_16x16x32_bf16 v[116:119], a[140:143], a[84:87], v[116:119]
s_cselect_b32 s51, s42, s51
v_mfma_f32_16x16x32_bf16 v[124:127], a[136:139], a[88:91], v[124:127]
s_cselect_b64 s[16:17], s[40:41], s[16:17]
ds_read_b64_tr_b16 a[134:135], v8 offset:51200
v_mfma_f32_16x16x32_bf16 v[124:127], a[140:143], a[92:95], v[124:127]
s_cselect_b32 s18, s42, s18
v_mfma_f32_16x16x32_bf16 v[132:135], a[136:139], a[96:99], v[132:135]
s_cselect_b64 s[40:41], s[44:45], s[40:41]
ds_read_b128 a[32:35], v2 offset:8192
v_mfma_f32_16x16x32_bf16 v[132:135], a[140:143], a[100:103], v[132:135]
s_cselect_b32 s42, s46, s42
v_mfma_f32_16x16x32_bf16 v[140:143], a[136:139], a[104:107], v[140:143]
s_cselect_b32 s46, 0, s46
v_mfma_f32_16x16x32_bf16 v[140:143], a[140:143], a[108:111], v[140:143]
s_cmp_eq_u32 s30, s55
v_mfma_f32_16x16x32_bf16 v[148:151], a[136:139], a[112:115], v[148:151]
s_cselect_b32 s22, 0, 3221225472
ds_read_b128 a[36:39], v3 offset:8192
v_mfma_f32_16x16x32_bf16 v[148:151], a[140:143], a[116:119], v[148:151]
s_sub_u32 s30, s30, 1
buffer_atomic_add v27, v26, s[60:63], s22 offen sc1
v_mfma_f32_16x16x32_bf16 v[156:159], a[136:139], a[120:123], v[156:159]
ds_read_b128 a[40:43], v2 offset:10240
v_mfma_f32_16x16x32_bf16 v[156:159], a[140:143], a[124:127], v[156:159]
s_waitcnt lgkmcnt(3)
v_mfma_f32_16x16x32_bf16 v[160:163], a[128:131], a[64:67], v[160:163]
ds_read_b64_tr_b16 a[136:137], v9 offset:32768
v_mfma_f32_16x16x32_bf16 v[160:163], a[132:135], a[68:71], v[160:163]
v_mfma_f32_16x16x32_bf16 v[168:171], a[128:131], a[72:75], v[168:171]
ds_read_b64_tr_b16 a[138:139], v9 offset:34816
v_mfma_f32_16x16x32_bf16 v[168:171], a[132:135], a[76:79], v[168:171]
v_mfma_f32_16x16x32_bf16 v[176:179], a[128:131], a[80:83], v[176:179]
ds_read_b64_tr_b16 a[140:141], v9 offset:49152
v_mfma_f32_16x16x32_bf16 v[176:179], a[132:135], a[84:87], v[176:179]
v_mfma_f32_16x16x32_bf16 v[184:187], a[128:131], a[88:91], v[184:187]
ds_read_b64_tr_b16 a[142:143], v9 offset:51200
v_mfma_f32_16x16x32_bf16 v[184:187], a[132:135], a[92:95], v[184:187]
v_mfma_f32_16x16x32_bf16 v[192:195], a[128:131], a[96:99], v[192:195]
v_mfma_f32_16x16x32_bf16 v[192:195], a[132:135], a[100:103], v[192:195]
v_mfma_f32_16x16x32_bf16 v[200:203], a[128:131], a[104:107], v[200:203]
ds_read_b128 a[44:47], v3 offset:10240
v_mfma_f32_16x16x32_bf16 v[200:203], a[132:135], a[108:111], v[200:203]
v_mfma_f32_16x16x32_bf16 v[208:211], a[128:131], a[112:115], v[208:211]
ds_read_b128 a[48:51], v2 offset:12288
v_mfma_f32_16x16x32_bf16 v[208:211], a[132:135], a[116:119], v[208:211]
v_mfma_f32_16x16x32_bf16 v[216:219], a[128:131], a[120:123], v[216:219]
v_mfma_f32_16x16x32_bf16 v[216:219], a[132:135], a[124:127], v[216:219]
s_waitcnt lgkmcnt(2)
v_mfma_f32_16x16x32_bf16 v[164:167], a[136:139], a[64:67], v[164:167]
ds_read_b64_tr_b16 a[128:129], v10 offset:32768
v_mfma_f32_16x16x32_bf16 v[164:167], a[140:143], a[68:71], v[164:167]
v_mfma_f32_16x16x32_bf16 v[172:175], a[136:139], a[72:75], v[172:175]
ds_read_b64_tr_b16 a[130:131], v10 offset:34816
v_mfma_f32_16x16x32_bf16 v[172:175], a[140:143], a[76:79], v[172:175]
v_mfma_f32_16x16x32_bf16 v[180:183], a[136:139], a[80:83], v[180:183]
ds_read_b64_tr_b16 a[132:133], v10 offset:49152
v_mfma_f32_16x16x32_bf16 v[180:183], a[140:143], a[84:87], v[180:183]
v_mfma_f32_16x16x32_bf16 v[188:191], a[136:139], a[88:91], v[188:191]
ds_read_b64_tr_b16 a[134:135], v10 offset:51200
v_mfma_f32_16x16x32_bf16 v[188:191], a[140:143], a[92:95], v[188:191]
v_mfma_f32_16x16x32_bf16 v[196:199], a[136:139], a[96:99], v[196:199]
ds_read_b128 a[52:55], v3 offset:12288
v_mfma_f32_16x16x32_bf16 v[196:199], a[140:143], a[100:103], v[196:199]
v_mfma_f32_16x16x32_bf16 v[204:207], a[136:139], a[104:107], v[204:207]
ds_read_b128 a[56:59], v2 offset:14336
v_mfma_f32_16x16x32_bf16 v[204:207], a[140:143], a[108:111], v[204:207]
v_mfma_f32_16x16x32_bf16 v[212:215], a[136:139], a[112:115], v[212:215]
v_mfma_f32_16x16x32_bf16 v[212:215], a[140:143], a[116:119], v[212:215]
v_mfma_f32_16x16x32_bf16 v[220:223], a[136:139], a[120:123], v[220:223]
ds_read_b128 a[60:63], v3 offset:14336
v_mfma_f32_16x16x32_bf16 v[220:223], a[140:143], a[124:127], v[220:223]
s_waitcnt lgkmcnt(3)
v_mfma_f32_16x16x32_bf16 a[192:195], a[128:131], a[64:67], a[192:195]
ds_read_b64_tr_b16 a[136:137], v11 offset:32768
v_mfma_f32_16x16x32_bf16 a[192:195], a[132:135], a[68:71], a[192:195]
v_mfma_f32_16x16x32_bf16 a[200:203], a[128:131], a[72:75], a[200:203]
ds_read_b64_tr_b16 a[138:139], v11 offset:34816
v_mfma_f32_16x16x32_bf16 a[200:203], a[132:135], a[76:79], a[200:203]
v_mfma_f32_16x16x32_bf16 a[208:211], a[128:131], a[80:83], a[208:211]
ds_read_b64_tr_b16 a[140:141], v11 offset:49152
v_mfma_f32_16x16x32_bf16 a[208:211], a[132:135], a[84:87], a[208:211]
v_mfma_f32_16x16x32_bf16 a[216:219], a[128:131], a[88:91], a[216:219]
ds_read_b64_tr_b16 a[142:143], v11 offset:51200
v_mfma_f32_16x16x32_bf16 a[216:219], a[132:135], a[92:95], a[216:219]
v_mfma_f32_16x16x32_bf16 a[224:227], a[128:131], a[96:99], a[224:227]
v_mfma_f32_16x16x32_bf16 a[224:227], a[132:135], a[100:103], a[224:227]
v_mfma_f32_16x16x32_bf16 a[232:235], a[128:131], a[104:107], a[232:235]
v_mfma_f32_16x16x32_bf16 a[232:235], a[132:135], a[108:111], a[232:235]
v_mfma_f32_16x16x32_bf16 a[240:243], a[128:131], a[112:115], a[240:243]
v_mfma_f32_16x16x32_bf16 a[240:243], a[132:135], a[116:119], a[240:243]
v_mfma_f32_16x16x32_bf16 a[248:251], a[128:131], a[120:123], a[248:251]
s_waitcnt vmcnt(2) lgkmcnt(0)
v_mfma_f32_16x16x32_bf16 a[248:251], a[132:135], a[124:127], a[248:251]
s_barrier
v_mfma_f32_16x16x32_bf16 a[196:199], a[136:139], a[64:67], a[196:199]
s_add_u32 m0, s29, 98304
ds_read_b64_tr_b16 a[128:129], v4 offset:0
v_mfma_f32_16x16x32_bf16 a[196:199], a[140:143], a[68:71], a[196:199]
buffer_load_dwordx4 v16, s[12:15], s26 offen offset:0 lds
v_mfma_f32_16x16x32_bf16 a[204:207], a[136:139], a[72:75], a[204:207]
ds_read_b64_tr_b16 a[130:131], v4 offset:2048
v_mfma_f32_16x16x32_bf16 a[204:207], a[140:143], a[76:79], a[204:207]
v_mfma_f32_16x16x32_bf16 a[212:215], a[136:139], a[80:83], a[212:215]
ds_read_b64_tr_b16 a[132:133], v4 offset:16384
v_mfma_f32_16x16x32_bf16 a[212:215], a[140:143], a[84:87], a[212:215]
buffer_load_dwordx4 v17, s[12:15], s26 offen offset:1024 lds
v_mfma_f32_16x16x32_bf16 a[220:223], a[136:139], a[88:91], a[220:223]
ds_read_b64_tr_b16 a[134:135], v4 offset:18432
v_mfma_f32_16x16x32_bf16 a[220:223], a[140:143], a[92:95], a[220:223]
v_mfma_f32_16x16x32_bf16 a[228:231], a[136:139], a[96:99], a[228:231]
v_mfma_f32_16x16x32_bf16 a[228:231], a[140:143], a[100:103], a[228:231]
buffer_load_dwordx4 v18, s[12:15], s26 offen offset:2048 lds
v_mfma_f32_16x16x32_bf16 a[236:239], a[136:139], a[104:107], a[236:239]
v_mfma_f32_16x16x32_bf16 a[236:239], a[140:143], a[108:111], a[236:239]
v_mfma_f32_16x16x32_bf16 a[244:247], a[136:139], a[112:115], a[244:247]
v_mfma_f32_16x16x32_bf16 a[244:247], a[140:143], a[116:119], a[244:247]
buffer_load_dwordx4 v19, s[12:15], s26 offen offset:3072 lds
v_mfma_f32_16x16x32_bf16 a[252:255], a[136:139], a[120:123], a[252:255]
s_add_u32 s26, s26, 524288
v_mfma_f32_16x16x32_bf16 a[252:255], a[140:143], a[124:127], a[252:255]
s_waitcnt lgkmcnt(0)
buffer_store_dword v27, v26, s[4:7], s82 offen sc1
v_mfma_f32_16x16x32_bf16 v[32:35], a[128:131], a[0:3], v[32:35]
s_add_u32 m0, s29, 114688
ds_read_b64_tr_b16 a[136:137], v5 offset:0
v_mfma_f32_16x16x32_bf16 v[32:35], a[132:135], a[4:7], v[32:35]
buffer_load_dwordx4 v16, s[12:15], s27 offen offset:0 lds
v_mfma_f32_16x16x32_bf16 v[40:43], a[128:131], a[8:11], v[40:43]
ds_read_b64_tr_b16 a[138:139], v5 offset:2048
v_mfma_f32_16x16x32_bf16 v[40:43], a[132:135], a[12:15], v[40:43]
v_mfma_f32_16x16x32_bf16 v[48:51], a[128:131], a[16:19], v[48:51]
ds_read_b64_tr_b16 a[140:141], v5 offset:16384
v_mfma_f32_16x16x32_bf16 v[48:51], a[132:135], a[20:23], v[48:51]
buffer_load_dwordx4 v17, s[12:15], s27 offen offset:1024 lds
v_mfma_f32_16x16x32_bf16 v[56:59], a[128:131], a[24:27], v[56:59]
ds_read_b64_tr_b16 a[142:143], v5 offset:18432
v_mfma_f32_16x16x32_bf16 v[56:59], a[132:135], a[28:31], v[56:59]
v_mfma_f32_16x16x32_bf16 v[64:67], a[128:131], a[32:35], v[64:67]
ds_read_b128 a[64:67], v2 offset:32768
v_mfma_f32_16x16x32_bf16 v[64:67], a[132:135], a[36:39], v[64:67]
buffer_load_dwordx4 v18, s[12:15], s27 offen offset:2048 lds
v_mfma_f32_16x16x32_bf16 v[72:75], a[128:131], a[40:43], v[72:75]
ds_read_b128 a[68:71], v3 offset:32768
v_mfma_f32_16x16x32_bf16 v[72:75], a[132:135], a[44:47], v[72:75]
v_mfma_f32_16x16x32_bf16 v[80:83], a[128:131], a[48:51], v[80:83]
v_mfma_f32_16x16x32_bf16 v[80:83], a[132:135], a[52:55], v[80:83]
buffer_load_dwordx4 v19, s[12:15], s27 offen offset:3072 lds
v_mfma_f32_16x16x32_bf16 v[88:91], a[128:131], a[56:59], v[88:91]
s_add_u32 s27, s27, 524288
ds_read_b128 a[72:75], v2 offset:34816
v_mfma_f32_16x16x32_bf16 v[88:91], a[132:135], a[60:63], v[88:91]
s_waitcnt lgkmcnt(3)
v_mfma_f32_16x16x32_bf16 v[36:39], a[136:139], a[0:3], v[36:39]
s_add_u32 m0, s28, 0
ds_read_b64_tr_b16 a[128:129], v6 offset:0
v_mfma_f32_16x16x32_bf16 v[36:39], a[140:143], a[4:7], v[36:39]
buffer_load_dwordx4 v12, s[8:11], s24 offen offset:0 lds
v_mfma_f32_16x16x32_bf16 v[44:47], a[136:139], a[8:11], v[44:47]
ds_read_b64_tr_b16 a[130:131], v6 offset:2048
v_mfma_f32_16x16x32_bf16 v[44:47], a[140:143], a[12:15], v[44:47]
PAD_1:
s_cbranch_execz PAD_5
v_mfma_f32_16x16x32_bf16 v[52:55], a[136:139], a[16:19], v[52:55]
ds_read_b64_tr_b16 a[132:133], v6 offset:16384
v_mfma_f32_16x16x32_bf16 v[52:55], a[140:143], a[20:23], v[52:55]
buffer_load_dwordx4 v13, s[8:11], s24 offen offset:1024 lds
v_mfma_f32_16x16x32_bf16 v[60:63], a[136:139], a[24:27], v[60:63]
ds_read_b64_tr_b16 a[134:135], v6 offset:18432
v_mfma_f32_16x16x32_bf16 v[60:63], a[140:143], a[28:31], v[60:63]
v_mfma_f32_16x16x32_bf16 v[68:71], a[136:139], a[32:35], v[68:71]
ds_read_b128 a[76:79], v3 offset:34816
v_mfma_f32_16x16x32_bf16 v[68:71], a[140:143], a[36:39], v[68:71]
buffer_load_dwordx4 v14, s[8:11], s24 offen offset:2048 lds
v_mfma_f32_16x16x32_bf16 v[76:79], a[136:139], a[40:43], v[76:79]
v_mfma_f32_16x16x32_bf16 v[76:79], a[140:143], a[44:47], v[76:79]
v_mfma_f32_16x16x32_bf16 v[84:87], a[136:139], a[48:51], v[84:87]
ds_read_b128 a[80:83], v2 offset:36864
v_mfma_f32_16x16x32_bf16 v[84:87], a[140:143], a[52:55], v[84:87]
buffer_load_dwordx4 v15, s[8:11], s24 offen offset:3072 lds
v_mfma_f32_16x16x32_bf16 v[92:95], a[136:139], a[56:59], v[92:95]
s_add_u32 s24, s24, 128
ds_read_b128 a[84:87], v3 offset:36864
v_mfma_f32_16x16x32_bf16 v[92:95], a[140:143], a[60:63], v[92:95]
s_waitcnt lgkmcnt(3)
v_mfma_f32_16x16x32_bf16 v[96:99], a[128:131], a[0:3], v[96:99]
s_add_u32 m0, s28, 4096
ds_read_b64_tr_b16 a[136:137], v7 offset:0
v_mfma_f32_16x16x32_bf16 v[96:99], a[132:135], a[4:7], v[96:99]
buffer_load_dwordx4 v12, s[8:11], s25 offen offset:0 lds
v_mfma_f32_16x16x32_bf16 v[104:107], a[128:131], a[8:11], v[104:107]
ds_read_b64_tr_b16 a[138:139], v7 offset:2048
v_mfma_f32_16x16x32_bf16 v[104:107], a[132:135], a[12:15], v[104:107]
v_mfma_f32_16x16x32_bf16 v[112:115], a[128:131], a[16:19], v[112:115]
ds_read_b64_tr_b16 a[140:141], v7 offset:16384
v_mfma_f32_16x16x32_bf16 v[112:115], a[132:135], a[20:23], v[112:115]
buffer_load_dwordx4 v13, s[8:11], s25 offen offset:1024 lds
v_mfma_f32_16x16x32_bf16 v[120:123], a[128:131], a[24:27], v[120:123]
ds_read_b64_tr_b16 a[142:143], v7 offset:18432
v_mfma_f32_16x16x32_bf16 v[120:123], a[132:135], a[28:31], v[120:123]
v_mfma_f32_16x16x32_bf16 v[128:131], a[128:131], a[32:35], v[128:131]
v_mfma_f32_16x16x32_bf16 v[128:131], a[132:135], a[36:39], v[128:131]
buffer_load_dwordx4 v14, s[8:11], s25 offen offset:2048 lds
v_mfma_f32_16x16x32_bf16 v[136:139], a[128:131], a[40:43], v[136:139]
ds_read_b128 a[88:91], v2 offset:38912
v_mfma_f32_16x16x32_bf16 v[136:139], a[132:135], a[44:47], v[136:139]
v_mfma_f32_16x16x32_bf16 v[144:147], a[128:131], a[48:51], v[144:147]
ds_read_b128 a[92:95], v3 offset:38912
v_mfma_f32_16x16x32_bf16 v[144:147], a[132:135], a[52:55], v[144:147]
buffer_load_dwordx4 v15, s[8:11], s25 offen offset:3072 lds
v_mfma_f32_16x16x32_bf16 v[152:155], a[128:131], a[56:59], v[152:155]
s_add_u32 s25, s25, 128
v_mfma_f32_16x16x32_bf16 v[152:155], a[132:135], a[60:63], v[152:155]
s_waitcnt lgkmcnt(2)
v_mfma_f32_16x16x32_bf16 v[100:103], a[136:139], a[0:3], v[100:103]
ds_read_b64_tr_b16 a[128:129], v8 offset:0
v_mfma_f32_16x16x32_bf16 v[100:103], a[140:143], a[4:7], v[100:103]
buffer_load_dword v21, v20, s[16:19], s43 offen
v_mfma_f32_16x16x32_bf16 v[108:111], a[136:139], a[8:11], v[108:111]
s_add_u32 s43, s43, s47
ds_read_b64_tr_b16 a[130:131], v8 offset:2048
v_mfma_f32_16x16x32_bf16 v[108:111], a[140:143], a[12:15], v[108:111]
s_cmp_ge_u32 s43, s51
v_mfma_f32_16x16x32_bf16 v[116:119], a[136:139], a[16:19], v[116:119]
s_cselect_b32 s43, 0, s43
ds_read_b64_tr_b16 a[132:133], v8 offset:16384
v_mfma_f32_16x16x32_bf16 v[116:119], a[140:143], a[20:23], v[116:119]
s_cselect_b32 s51, s42, s51
v_mfma_f32_16x16x32_bf16 v[124:127], a[136:139], a[24:27], v[124:127]
s_cselect_b64 s[16:17], s[40:41], s[16:17]
ds_read_b64_tr_b16 a[134:135], v8 offset:18432
v_mfma_f32_16x16x32_bf16 v[124:127], a[140:143], a[28:31], v[124:127]
s_cselect_b32 s18, s42, s18
v_mfma_f32_16x16x32_bf16 v[132:135], a[136:139], a[32:35], v[132:135]
s_cselect_b64 s[40:41], s[44:45], s[40:41]
ds_read_b128 a[96:99], v2 offset:40960
v_mfma_f32_16x16x32_bf16 v[132:135], a[140:143], a[36:39], v[132:135]
s_cselect_b32 s42, s46, s42
v_mfma_f32_16x16x32_bf16 v[140:143], a[136:139], a[40:43], v[140:143]
s_cselect_b32 s46, 0, s46
v_mfma_f32_16x16x32_bf16 v[140:143], a[140:143], a[44:47], v[140:143]
s_cmp_eq_u32 s30, s55
v_mfma_f32_16x16x32_bf16 v[148:151], a[136:139], a[48:51], v[148:151]
s_cselect_b32 s22, 0, 3221225472
ds_read_b128 a[100:103], v3 offset:40960
v_mfma_f32_16x16x32_bf16 v[148:151], a[140:143], a[52:55], v[148:151]
s_sub_u32 s30, s30, 1
buffer_atomic_add v27, v26, s[60:63], s22 offen sc1
v_mfma_f32_16x16x32_bf16 v[156:159], a[136:139], a[56:59], v[156:159]
ds_read_b128 a[104:107], v2 offset:43008
v_mfma_f32_16x16x32_bf16 v[156:159], a[140:143], a[60:63], v[156:159]
s_waitcnt lgkmcnt(3)
v_mfma_f32_16x16x32_bf16 v[160:163], a[128:131], a[0:3], v[160:163]
ds_read_b64_tr_b16 a[136:137], v9 offset:0
v_mfma_f32_16x16x32_bf16 v[160:163], a[132:135], a[4:7], v[160:163]
v_mfma_f32_16x16x32_bf16 v[168:171], a[128:131], a[8:11], v[168:171]
ds_read_b64_tr_b16 a[138:139], v9 offset:2048
v_mfma_f32_16x16x32_bf16 v[168:171], a[132:135], a[12:15], v[168:171]
v_mfma_f32_16x16x32_bf16 v[176:179], a[128:131], a[16:19], v[176:179]
ds_read_b64_tr_b16 a[140:141], v9 offset:16384
v_mfma_f32_16x16x32_bf16 v[176:179], a[132:135], a[20:23], v[176:179]
v_mfma_f32_16x16x32_bf16 v[184:187], a[128:131], a[24:27], v[184:187]
ds_read_b64_tr_b16 a[142:143], v9 offset:18432
v_mfma_f32_16x16x32_bf16 v[184:187], a[132:135], a[28:31], v[184:187]
v_mfma_f32_16x16x32_bf16 v[192:195], a[128:131], a[32:35], v[192:195]
v_mfma_f32_16x16x32_bf16 v[192:195], a[132:135], a[36:39], v[192:195]
v_mfma_f32_16x16x32_bf16 v[200:203], a[128:131], a[40:43], v[200:203]
ds_read_b128 a[108:111], v3 offset:43008
v_mfma_f32_16x16x32_bf16 v[200:203], a[132:135], a[44:47], v[200:203]
v_mfma_f32_16x16x32_bf16 v[208:211], a[128:131], a[48:51], v[208:211]
ds_read_b128 a[112:115], v2 offset:45056
v_mfma_f32_16x16x32_bf16 v[208:211], a[132:135], a[52:55], v[208:211]
v_mfma_f32_16x16x32_bf16 v[216:219], a[128:131], a[56:59], v[216:219]
v_mfma_f32_16x16x32_bf16 v[216:219], a[132:135], a[60:63], v[216:219]
s_waitcnt lgkmcnt(2)
v_mfma_f32_16x16x32_bf16 v[164:167], a[136:139], a[0:3], v[164:167]
ds_read_b64_tr_b16 a[128:129], v10 offset:0
v_mfma_f32_16x16x32_bf16 v[164:167], a[140:143], a[4:7], v[164:167]
v_mfma_f32_16x16x32_bf16 v[172:175], a[136:139], a[8:11], v[172:175]
ds_read_b64_tr_b16 a[130:131], v10 offset:2048
v_mfma_f32_16x16x32_bf16 v[172:175], a[140:143], a[12:15], v[172:175]
v_mfma_f32_16x16x32_bf16 v[180:183], a[136:139], a[16:19], v[180:183]
ds_read_b64_tr_b16 a[132:133], v10 offset:16384
v_mfma_f32_16x16x32_bf16 v[180:183], a[140:143], a[20:23], v[180:183]
v_mfma_f32_16x16x32_bf16 v[188:191], a[136:139], a[24:27], v[188:191]
ds_read_b64_tr_b16 a[134:135], v10 offset:18432
v_mfma_f32_16x16x32_bf16 v[188:191], a[140:143], a[28:31], v[188:191]
v_mfma_f32_16x16x32_bf16 v[196:199], a[136:139], a[32:35], v[196:199]
ds_read_b128 a[116:119], v3 offset:45056
v_mfma_f32_16x16x32_bf16 v[196:199], a[140:143], a[36:39], v[196:199]
v_mfma_f32_16x16x32_bf16 v[204:207], a[136:139], a[40:43], v[204:207]
ds_read_b128 a[120:123], v2 offset:47104
v_mfma_f32_16x16x32_bf16 v[204:207], a[140:143], a[44:47], v[204:207]
v_mfma_f32_16x16x32_bf16 v[212:215], a[136:139], a[48:51], v[212:215]
v_mfma_f32_16x16x32_bf16 v[212:215], a[140:143], a[52:55], v[212:215]
v_mfma_f32_16x16x32_bf16 v[220:223], a[136:139], a[56:59], v[220:223]
ds_read_b128 a[124:127], v3 offset:47104
v_mfma_f32_16x16x32_bf16 v[220:223], a[140:143], a[60:63], v[220:223]
s_waitcnt lgkmcnt(3)
v_mfma_f32_16x16x32_bf16 a[192:195], a[128:131], a[0:3], a[192:195]
ds_read_b64_tr_b16 a[136:137], v11 offset:0
v_mfma_f32_16x16x32_bf16 a[192:195], a[132:135], a[4:7], a[192:195]
v_mfma_f32_16x16x32_bf16 a[200:203], a[128:131], a[8:11], a[200:203]
ds_read_b64_tr_b16 a[138:139], v11 offset:2048
v_mfma_f32_16x16x32_bf16 a[200:203], a[132:135], a[12:15], a[200:203]
v_mfma_f32_16x16x32_bf16 a[208:211], a[128:131], a[16:19], a[208:211]
ds_read_b64_tr_b16 a[140:141], v11 offset:16384
v_mfma_f32_16x16x32_bf16 a[208:211], a[132:135], a[20:23], a[208:211]
v_mfma_f32_16x16x32_bf16 a[216:219], a[128:131], a[24:27], a[216:219]
ds_read_b64_tr_b16 a[142:143], v11 offset:18432
v_mfma_f32_16x16x32_bf16 a[216:219], a[132:135], a[28:31], a[216:219]
v_mfma_f32_16x16x32_bf16 a[224:227], a[128:131], a[32:35], a[224:227]
v_mfma_f32_16x16x32_bf16 a[224:227], a[132:135], a[36:39], a[224:227]
v_mfma_f32_16x16x32_bf16 a[232:235], a[128:131], a[40:43], a[232:235]
v_mfma_f32_16x16x32_bf16 a[232:235], a[132:135], a[44:47], a[232:235]
v_mfma_f32_16x16x32_bf16 a[240:243], a[128:131], a[48:51], a[240:243]
v_mfma_f32_16x16x32_bf16 a[240:243], a[132:135], a[52:55], a[240:243]
v_mfma_f32_16x16x32_bf16 a[248:251], a[128:131], a[56:59], a[248:251]
s_waitcnt vmcnt(2) lgkmcnt(0)
v_mfma_f32_16x16x32_bf16 a[248:251], a[132:135], a[60:63], a[248:251]
s_barrier
v_mfma_f32_16x16x32_bf16 a[196:199], a[136:139], a[0:3], a[196:199]
s_add_u32 m0, s29, 65536
ds_read_b64_tr_b16 a[128:129], v4 offset:32768
v_mfma_f32_16x16x32_bf16 a[196:199], a[140:143], a[4:7], a[196:199]
buffer_load_dwordx4 v16, s[12:15], s26 offen offset:0 lds
v_mfma_f32_16x16x32_bf16 a[204:207], a[136:139], a[8:11], a[204:207]
ds_read_b64_tr_b16 a[130:131], v4 offset:34816
v_mfma_f32_16x16x32_bf16 a[204:207], a[140:143], a[12:15], a[204:207]
v_mfma_f32_16x16x32_bf16 a[212:215], a[136:139], a[16:19], a[212:215]
ds_read_b64_tr_b16 a[132:133], v4 offset:49152
v_mfma_f32_16x16x32_bf16 a[212:215], a[140:143], a[20:23], a[212:215]
buffer_load_dwordx4 v17, s[12:15], s26 offen offset:1024 lds
v_mfma_f32_16x16x32_bf16 a[220:223], a[136:139], a[24:27], a[220:223]
ds_read_b64_tr_b16 a[134:135], v4 offset:51200
v_mfma_f32_16x16x32_bf16 a[220:223], a[140:143], a[28:31], a[220:223]
v_mfma_f32_16x16x32_bf16 a[228:231], a[136:139], a[32:35], a[228:231]
v_mfma_f32_16x16x32_bf16 a[228:231], a[140:143], a[36:39], a[228:231]
buffer_load_dwordx4 v18, s[12:15], s26 offen offset:2048 lds
v_mfma_f32_16x16x32_bf16 a[236:239], a[136:139], a[40:43], a[236:239]
v_mfma_f32_16x16x32_bf16 a[236:239], a[140:143], a[44:47], a[236:239]
v_mfma_f32_16x16x32_bf16 a[244:247], a[136:139], a[48:51], a[244:247]
v_mfma_f32_16x16x32_bf16 a[244:247], a[140:143], a[52:55], a[244:247]
s_waitcnt lgkmcnt(0)
buffer_load_dwordx4 v19, s[12:15], s26 offen offset:3072 lds
v_mfma_f32_16x16x32_bf16 a[252:255], a[136:139], a[56:59], a[252:255]
s_add_u32 s26, s26, 524288
s_bitcmp1_b32 s30, 1
v_mfma_f32_16x16x32_bf16 a[252:255], a[140:143], a[60:63], a[252:255]
s_cbranch_scc1 Lg_1
s_cmp_eq_u32 s30, 0
s_cbranch_scc1 Lg_1t
v_mfma_f32_16x16x32_bf16 v[32:35], a[128:131], a[64:67], v[32:35]
s_add_u32 m0, s29, 81920
ds_read_b64_tr_b16 a[136:137], v5 offset:32768
v_mfma_f32_16x16x32_bf16 v[32:35], a[132:135], a[68:71], v[32:35]
buffer_load_dwordx4 v16, s[12:15], s27 offen offset:0 lds
v_mfma_f32_16x16x32_bf16 v[40:43], a[128:131], a[72:75], v[40:43]
s_lshl_b32 s22, s38, 3
ds_read_b64_tr_b16 a[138:139], v5 offset:34816
v_mfma_f32_16x16x32_bf16 v[40:43], a[132:135], a[76:79], v[40:43]
s_lshl_b32 s23, s39, 5
v_and_b32 v252, 31, v0
v_lshrrev_b32 v253, 5, v0
v_mfma_f32_16x16x32_bf16 v[48:51], a[128:131], a[80:83], v[48:51]
ds_read_b64_tr_b16 a[140:141], v5 offset:49152
v_add_u32 v253, s22, v253
v_mfma_f32_16x16x32_bf16 v[48:51], a[132:135], a[84:87], v[48:51]
buffer_load_dwordx4 v17, s[12:15], s27 offen offset:1024 lds
v_mfma_f32_16x16x32_bf16 v[56:59], a[128:131], a[88:91], v[56:59]
ds_read_b64_tr_b16 a[142:143], v5 offset:51200
v_add_u32 v252, s23, v252
v_mfma_f32_16x16x32_bf16 v[56:59], a[132:135], a[92:95], v[56:59]
v_mul_u32_u24 v254, 7168, v253
v_lshl_add_u32 v254, v252, 2, v254
v_mfma_f32_16x16x32_bf16 v[64:67], a[128:131], a[96:99], v[64:67]
ds_read_b128 a[0:3], v2 offset:0
v_lshlrev_b32 v252, 4, v252
v_mfma_f32_16x16x32_bf16 v[64:67], a[132:135], a[100:103], v[64:67]
buffer_load_dwordx4 v18, s[12:15], s27 offen offset:2048 lds
v_mfma_f32_16x16x32_bf16 v[72:75], a[128:131], a[104:107], v[72:75]
ds_read_b128 a[4:7], v3 offset:0
v_add_u32 v255, 3584, v254
v_mfma_f32_16x16x32_bf16 v[72:75], a[132:135], a[108:111], v[72:75]
v_subrev_u32 v22, 3584, v254
v_subrev_u32 v23, 2688, v254
v_mfma_f32_16x16x32_bf16 v[80:83], a[128:131], a[112:115], v[80:83]
v_subrev_u32 v24, 1792, v254
v_subrev_u32 v25, 896, v254
v_mfma_f32_16x16x32_bf16 v[80:83], a[132:135], a[116:119], v[80:83]
buffer_load_dwordx4 v19, s[12:15], s27 offen offset:3072 lds
v_mfma_f32_16x16x32_bf16 v[88:91], a[128:131], a[120:123], v[88:91]
s_add_u32 s27, s27, 524288
ds_read_b128 a[8:11], v2 offset:2048
v_mfma_f32_16x16x32_bf16 v[88:91], a[132:135], a[124:127], v[88:91]
s_waitcnt lgkmcnt(3)
v_mfma_f32_16x16x32_bf16 v[36:39], a[136:139], a[64:67], v[36:39]
s_add_u32 m0, s28, 32768
ds_read_b64_tr_b16 a[128:129], v6 offset:32768
v_mfma_f32_16x16x32_bf16 v[36:39], a[140:143], a[68:71], v[36:39]
buffer_load_dwordx4 v12, s[8:11], s24 offen offset:0 lds
v_mfma_f32_16x16x32_bf16 v[44:47], a[136:139], a[72:75], v[44:47]
ds_read_b64_tr_b16 a[130:131], v6 offset:34816
v_mfma_f32_16x16x32_bf16 v[44:47], a[140:143], a[76:79], v[44:47]
v_mfma_f32_16x16x32_bf16 v[52:55], a[136:139], a[80:83], v[52:55]
ds_read_b64_tr_b16 a[132:133], v6 offset:49152
v_mfma_f32_16x16x32_bf16 v[52:55], a[140:143], a[84:87], v[52:55]
buffer_load_dwordx4 v13, s[8:11], s24 offen offset:1024 lds
v_mfma_f32_16x16x32_bf16 v[60:63], a[136:139], a[88:91], v[60:63]
ds_read_b64_tr_b16 a[134:135], v6 offset:51200
v_mfma_f32_16x16x32_bf16 v[60:63], a[140:143], a[92:95], v[60:63]
v_mfma_f32_16x16x32_bf16 v[68:71], a[136:139], a[96:99], v[68:71]
ds_read_b128 a[12:15], v3 offset:2048
v_mfma_f32_16x16x32_bf16 v[68:71], a[140:143], a[100:103], v[68:71]
buffer_load_dwordx4 v14, s[8:11], s24 offen offset:2048 lds
v_mfma_f32_16x16x32_bf16 v[76:79], a[136:139], a[104:107], v[76:79]
v_mfma_f32_16x16x32_bf16 v[76:79], a[140:143], a[108:111], v[76:79]
v_mfma_f32_16x16x32_bf16 v[84:87], a[136:139], a[112:115], v[84:87]
ds_read_b128 a[16:19], v2 offset:4096
v_mfma_f32_16x16x32_bf16 v[84:87], a[140:143], a[116:119], v[84:87]
buffer_load_dwordx4 v15, s[8:11], s24 offen offset:3072 lds
v_mfma_f32_16x16x32_bf16 v[92:95], a[136:139], a[120:123], v[92:95]
s_add_u32 s24, s24, 128
ds_read_b128 a[20:23], v3 offset:4096
v_mfma_f32_16x16x32_bf16 v[92:95], a[140:143], a[124:127], v[92:95]
s_waitcnt lgkmcnt(3)
v_mfma_f32_16x16x32_bf16 v[96:99], a[128:131], a[64:67], v[96:99]
s_add_u32 m0, s28, 36864
ds_read_b64_tr_b16 a[136:137], v7 offset:32768
v_mfma_f32_16x16x32_bf16 v[96:99], a[132:135], a[68:71], v[96:99]
buffer_load_dwordx4 v12, s[8:11], s25 offen offset:0 lds
v_mfma_f32_16x16x32_bf16 v[104:107], a[128:131], a[72:75], v[104:107]
ds_read_b64_tr_b16 a[138:139], v7 offset:34816
v_mfma_f32_16x16x32_bf16 v[104:107], a[132:135], a[76:79], v[104:107]
v_mfma_f32_16x16x32_bf16 v[112:115], a[128:131], a[80:83], v[112:115]
ds_read_b64_tr_b16 a[140:141], v7 offset:49152
v_mfma_f32_16x16x32_bf16 v[112:115], a[132:135], a[84:87], v[112:115]
buffer_load_dwordx4 v13, s[8:11], s25 offen offset:1024 lds
v_mfma_f32_16x16x32_bf16 v[120:123], a[128:131], a[88:91], v[120:123]
ds_read_b64_tr_b16 a[142:143], v7 offset:51200
v_mfma_f32_16x16x32_bf16 v[120:123], a[132:135], a[92:95], v[120:123]
v_mfma_f32_16x16x32_bf16 v[128:131], a[128:131], a[96:99], v[128:131]
v_mfma_f32_16x16x32_bf16 v[128:131], a[132:135], a[100:103], v[128:131]
buffer_load_dwordx4 v14, s[8:11], s25 offen offset:2048 lds
v_mfma_f32_16x16x32_bf16 v[136:139], a[128:131], a[104:107], v[136:139]
ds_read_b128 a[24:27], v2 offset:6144
v_mfma_f32_16x16x32_bf16 v[136:139], a[132:135], a[108:111], v[136:139]
v_mfma_f32_16x16x32_bf16 v[144:147], a[128:131], a[112:115], v[144:147]
ds_read_b128 a[28:31], v3 offset:6144
v_mfma_f32_16x16x32_bf16 v[144:147], a[132:135], a[116:119], v[144:147]
buffer_load_dwordx4 v15, s[8:11], s25 offen offset:3072 lds
v_mfma_f32_16x16x32_bf16 v[152:155], a[128:131], a[120:123], v[152:155]
s_add_u32 s25, s25, 128
v_mfma_f32_16x16x32_bf16 v[152:155], a[132:135], a[124:127], v[152:155]
s_waitcnt lgkmcnt(2)
v_mfma_f32_16x16x32_bf16 v[100:103], a[136:139], a[64:67], v[100:103]
s_mov_b64 s[56:57], s[70:71]
s_mov_b32 s58, 3584
s_mov_b32 s59, 0x20000
ds_read_b64_tr_b16 a[128:129], v8 offset:32768
v_mfma_f32_16x16x32_bf16 v[100:103], a[140:143], a[68:71], v[100:103]
buffer_load_dwordx4 v[248:251], v252, s[56:59], 0 offen
v_mfma_f32_16x16x32_bf16 v[108:111], a[136:139], a[72:75], v[108:111]
s_mov_b64 s[56:57], s[66:67]
s_mov_b32 s58, 1835008
ds_read_b64_tr_b16 a[130:131], v8 offset:34816
v_mfma_f32_16x16x32_bf16 v[108:111], a[140:143], a[76:79], v[108:111]
buffer_load_dword v224, v22, s[56:59], 0 offen nt
v_mfma_f32_16x16x32_bf16 v[116:119], a[136:139], a[80:83], v[116:119]
ds_read_b64_tr_b16 a[132:133], v8 offset:49152
v_mfma_f32_16x16x32_bf16 v[116:119], a[140:143], a[84:87], v[116:119]
buffer_load_dword v225, v23, s[56:59], 0 offen nt
v_mfma_f32_16x16x32_bf16 v[124:127], a[136:139], a[88:91], v[124:127]
ds_read_b64_tr_b16 a[134:135], v8 offset:51200
v_mfma_f32_16x16x32_bf16 v[124:127], a[140:143], a[92:95], v[124:127]
buffer_load_dword v226, v24, s[56:59], 0 offen nt
v_mfma_f32_16x16x32_bf16 v[132:135], a[136:139], a[96:99], v[132:135]
ds_read_b128 a[32:35], v2 offset:8192
v_mfma_f32_16x16x32_bf16 v[132:135], a[140:143], a[100:103], v[132:135]
buffer_load_dword v227, v25, s[56:59], 0 offen nt
v_mfma_f32_16x16x32_bf16 v[140:143], a[136:139], a[104:107], v[140:143]
buffer_load_dword v228, v254, s[56:59], 0 offen offset:0 nt
v_mfma_f32_16x16x32_bf16 v[140:143], a[140:143], a[108:111], v[140:143]
buffer_load_dword v229, v254, s[56:59], 0 offen offset:896 nt
v_mfma_f32_16x16x32_bf16 v[148:151], a[136:139], a[112:115], v[148:151]
ds_read_b128 a[36:39], v3 offset:8192
v_mfma_f32_16x16x32_bf16 v[148:151], a[140:143], a[116:119], v[148:151]
buffer_load_dword v230, v254, s[56:59], 0 offen offset:1792 nt
v_mfma_f32_16x16x32_bf16 v[156:159], a[136:139], a[120:123], v[156:159]
ds_read_b128 a[40:43], v2 offset:10240
v_mfma_f32_16x16x32_bf16 v[156:159], a[140:143], a[124:127], v[156:159]
s_waitcnt lgkmcnt(3)
buffer_load_dword v231, v254, s[56:59], 0 offen offset:2688 nt
v_mfma_f32_16x16x32_bf16 v[160:163], a[128:131], a[64:67], v[160:163]
ds_read_b64_tr_b16 a[136:137], v9 offset:32768
v_mfma_f32_16x16x32_bf16 v[160:163], a[132:135], a[68:71], v[160:163]
buffer_load_dword v232, v255, s[56:59], 0 offen offset:0 nt
v_mfma_f32_16x16x32_bf16 v[168:171], a[128:131], a[72:75], v[168:171]
ds_read_b64_tr_b16 a[138:139], v9 offset:34816
v_mfma_f32_16x16x32_bf16 v[168:171], a[132:135], a[76:79], v[168:171]
buffer_load_dword v233, v255, s[56:59], 0 offen offset:896 nt
v_mfma_f32_16x16x32_bf16 v[176:179], a[128:131], a[80:83], v[176:179]
ds_read_b64_tr_b16 a[140:141], v9 offset:49152
v_mfma_f32_16x16x32_bf16 v[176:179], a[132:135], a[84:87], v[176:179]
buffer_load_dword v234, v255, s[56:59], 0 offen offset:1792 nt
v_mfma_f32_16x16x32_bf16 v[184:187], a[128:131], a[88:91], v[184:187]
ds_read_b64_tr_b16 a[142:143], v9 offset:51200
v_mfma_f32_16x16x32_bf16 v[184:187], a[132:135], a[92:95], v[184:187]
buffer_load_dword v235, v255, s[56:59], 0 offen offset:2688 nt
v_mfma_f32_16x16x32_bf16 v[192:195], a[128:131], a[96:99], v[192:195]
s_mov_b64 s[56:57], s[68:69]
buffer_load_dword v236, v25, s[56:59], 0 offen nt
v_mfma_f32_16x16x32_bf16 v[192:195], a[132:135], a[100:103], v[192:195]
buffer_load_dword v237, v254, s[56:59], 0 offen offset:0 nt
v_mfma_f32_16x16x32_bf16 v[200:203], a[128:131], a[104:107], v[200:203]
ds_read_b128 a[44:47], v3 offset:10240
v_mfma_f32_16x16x32_bf16 v[200:203], a[132:135], a[108:111], v[200:203]
buffer_load_dword v238, v254, s[56:59], 0 offen offset:896 nt
v_mfma_f32_16x16x32_bf16 v[208:211], a[128:131], a[112:115], v[208:211]
ds_read_b128 a[48:51], v2 offset:12288
v_mfma_f32_16x16x32_bf16 v[208:211], a[132:135], a[116:119], v[208:211]
buffer_load_dword v239, v254, s[56:59], 0 offen offset:1792 nt
v_mfma_f32_16x16x32_bf16 v[216:219], a[128:131], a[120:123], v[216:219]
buffer_load_dword v240, v254, s[56:59], 0 offen offset:2688 nt
v_mfma_f32_16x16x32_bf16 v[216:219], a[132:135], a[124:127], v[216:219]
s_waitcnt lgkmcnt(2)
buffer_load_dword v241, v255, s[56:59], 0 offen offset:0 nt
v_mfma_f32_16x16x32_bf16 v[164:167], a[136:139], a[64:67], v[164:167]
ds_read_b64_tr_b16 a[128:129], v10 offset:32768
v_mfma_f32_16x16x32_bf16 v[164:167], a[140:143], a[68:71], v[164:167]
buffer_load_dword v242, v255, s[56:59], 0 offen offset:896 nt
v_mfma_f32_16x16x32_bf16 v[172:175], a[136:139], a[72:75], v[172:175]
ds_read_b64_tr_b16 a[130:131], v10 offset:34816
v_mfma_f32_16x16x32_bf16 v[172:175], a[140:143], a[76:79], v[172:175]
buffer_load_dword v243, v255, s[56:59], 0 offen offset:1792 nt
v_mfma_f32_16x16x32_bf16 v[180:183], a[136:139], a[80:83], v[180:183]
ds_read_b64_tr_b16 a[132:133], v10 offset:49152
v_mfma_f32_16x16x32_bf16 v[180:183], a[140:143], a[84:87], v[180:183]
buffer_load_dword v244, v255, s[56:59], 0 offen offset:2688 nt
v_mfma_f32_16x16x32_bf16 v[188:191], a[136:139], a[88:91], v[188:191]
ds_read_b64_tr_b16 a[134:135], v10 offset:51200
v_mfma_f32_16x16x32_bf16 v[188:191], a[140:143], a[92:95], v[188:191]
v_mfma_f32_16x16x32_bf16 v[196:199], a[136:139], a[96:99], v[196:199]
ds_read_b128 a[52:55], v3 offset:12288
v_mfma_f32_16x16x32_bf16 v[196:199], a[140:143], a[100:103], v[196:199]
v_mfma_f32_16x16x32_bf16 v[204:207], a[136:139], a[104:107], v[204:207]
ds_read_b128 a[56:59], v2 offset:14336
v_mfma_f32_16x16x32_bf16 v[204:207], a[140:143], a[108:111], v[204:207]
v_mfma_f32_16x16x32_bf16 v[212:215], a[136:139], a[112:115], v[212:215]
v_mfma_f32_16x16x32_bf16 v[212:215], a[140:143], a[116:119], v[212:215]
v_mfma_f32_16x16x32_bf16 v[220:223], a[136:139], a[120:123], v[220:223]
ds_read_b128 a[60:63], v3 offset:14336
v_mfma_f32_16x16x32_bf16 v[220:223], a[140:143], a[124:127], v[220:223]
s_waitcnt lgkmcnt(3)
v_mfma_f32_16x16x32_bf16 a[192:195], a[128:131], a[64:67], a[192:195]
ds_read_b64_tr_b16 a[136:137], v11 offset:32768
v_mfma_f32_16x16x32_bf16 a[192:195], a[132:135], a[68:71], a[192:195]
v_mfma_f32_16x16x32_bf16 a[200:203], a[128:131], a[72:75], a[200:203]
ds_read_b64_tr_b16 a[138:139], v11 offset:34816
v_mfma_f32_16x16x32_bf16 a[200:203], a[132:135], a[76:79], a[200:203]
v_mfma_f32_16x16x32_bf16 a[208:211], a[128:131], a[80:83], a[208:211]
ds_read_b64_tr_b16 a[140:141], v11 offset:49152
v_mfma_f32_16x16x32_bf16 a[208:211], a[132:135], a[84:87], a[208:211]
v_mfma_f32_16x16x32_bf16 a[216:219], a[128:131], a[88:91], a[216:219]
ds_read_b64_tr_b16 a[142:143], v11 offset:51200
v_mfma_f32_16x16x32_bf16 a[216:219], a[132:135], a[92:95], a[216:219]
v_mfma_f32_16x16x32_bf16 a[224:227], a[128:131], a[96:99], a[224:227]
v_mfma_f32_16x16x32_bf16 a[224:227], a[132:135], a[100:103], a[224:227]
v_mfma_f32_16x16x32_bf16 a[232:235], a[128:131], a[104:107], a[232:235]
v_mfma_f32_16x16x32_bf16 a[232:235], a[132:135], a[108:111], a[232:235]
v_mfma_f32_16x16x32_bf16 a[240:243], a[128:131], a[112:115], a[240:243]
v_mfma_f32_16x16x32_bf16 a[240:243], a[132:135], a[116:119], a[240:243]
v_mfma_f32_16x16x32_bf16 a[248:251], a[128:131], a[120:123], a[248:251]
s_waitcnt vmcnt(22) lgkmcnt(0)
v_mfma_f32_16x16x32_bf16 a[248:251], a[132:135], a[124:127], a[248:251]
s_barrier
v_mfma_f32_16x16x32_bf16 a[196:199], a[136:139], a[64:67], a[196:199]
s_add_u32 m0, s29, 98304
ds_read_b64_tr_b16 a[128:129], v4 offset:0
v_mfma_f32_16x16x32_bf16 a[196:199], a[140:143], a[68:71], a[196:199]
buffer_load_dwordx4 v16, s[12:15], s26 offen offset:0 lds
v_mfma_f32_16x16x32_bf16 a[204:207], a[136:139], a[72:75], a[204:207]
ds_read_b64_tr_b16 a[130:131], v4 offset:2048
v_mfma_f32_16x16x32_bf16 a[204:207], a[140:143], a[76:79], a[204:207]
v_mfma_f32_16x16x32_bf16 a[212:215], a[136:139], a[80:83], a[212:215]
ds_read_b64_tr_b16 a[132:133], v4 offset:16384
v_mfma_f32_16x16x32_bf16 a[212:215], a[140:143], a[84:87], a[212:215]
buffer_load_dwordx4 v17, s[12:15], s26 offen offset:1024 lds
v_mfma_f32_16x16x32_bf16 a[220:223], a[136:139], a[88:91], a[220:223]
ds_read_b64_tr_b16 a[134:135], v4 offset:18432
v_mfma_f32_16x16x32_bf16 a[220:223], a[140:143], a[92:95], a[220:223]
v_mfma_f32_16x16x32_bf16 a[228:231], a[136:139], a[96:99], a[228:231]
v_mfma_f32_16x16x32_bf16 a[228:231], a[140:143], a[100:103], a[228:231]
buffer_load_dwordx4 v18, s[12:15], s26 offen offset:2048 lds
v_mfma_f32_16x16x32_bf16 a[236:239], a[136:139], a[104:107], a[236:239]
v_mfma_f32_16x16x32_bf16 a[236:239], a[140:143], a[108:111], a[236:239]
v_mfma_f32_16x16x32_bf16 a[244:247], a[136:139], a[112:115], a[244:247]
v_mfma_f32_16x16x32_bf16 a[244:247], a[140:143], a[116:119], a[244:247]
buffer_load_dwordx4 v19, s[12:15], s26 offen offset:3072 lds
v_mfma_f32_16x16x32_bf16 a[252:255], a[136:139], a[120:123], a[252:255]
s_add_u32 s26, s26, 524288
v_mfma_f32_16x16x32_bf16 a[252:255], a[140:143], a[124:127], a[252:255]
s_waitcnt lgkmcnt(0)
v_mfma_f32_16x16x32_bf16 v[32:35], a[128:131], a[0:3], v[32:35]
s_add_u32 m0, s29, 114688
ds_read_b64_tr_b16 a[136:137], v5 offset:0
v_mfma_f32_16x16x32_bf16 v[32:35], a[132:135], a[4:7], v[32:35]
buffer_load_dwordx4 v16, s[12:15], s27 offen offset:0 lds
v_mfma_f32_16x16x32_bf16 v[40:43], a[128:131], a[8:11], v[40:43]
ds_read_b64_tr_b16 a[138:139], v5 offset:2048
v_mfma_f32_16x16x32_bf16 v[40:43], a[132:135], a[12:15], v[40:43]
v_mfma_f32_16x16x32_bf16 v[48:51], a[128:131], a[16:19], v[48:51]
ds_read_b64_tr_b16 a[140:141], v5 offset:16384
v_mfma_f32_16x16x32_bf16 v[48:51], a[132:135], a[20:23], v[48:51]
buffer_load_dwordx4 v17, s[12:15], s27 offen offset:1024 lds
v_mfma_f32_16x16x32_bf16 v[56:59], a[128:131], a[24:27], v[56:59]
ds_read_b64_tr_b16 a[142:143], v5 offset:18432
v_mfma_f32_16x16x32_bf16 v[56:59], a[132:135], a[28:31], v[56:59]
v_mfma_f32_16x16x32_bf16 v[64:67], a[128:131], a[32:35], v[64:67]
ds_read_b128 a[64:67], v2 offset:32768
v_mfma_f32_16x16x32_bf16 v[64:67], a[132:135], a[36:39], v[64:67]
buffer_load_dwordx4 v18, s[12:15], s27 offen offset:2048 lds
v_mfma_f32_16x16x32_bf16 v[72:75], a[128:131], a[40:43], v[72:75]
ds_read_b128 a[68:71], v3 offset:32768
v_mfma_f32_16x16x32_bf16 v[72:75], a[132:135], a[44:47], v[72:75]
v_mfma_f32_16x16x32_bf16 v[80:83], a[128:131], a[48:51], v[80:83]
v_mfma_f32_16x16x32_bf16 v[80:83], a[132:135], a[52:55], v[80:83]
buffer_load_dwordx4 v19, s[12:15], s27 offen offset:3072 lds
v_mfma_f32_16x16x32_bf16 v[88:91], a[128:131], a[56:59], v[88:91]
s_add_u32 s27, s27, 524288
ds_read_b128 a[72:75], v2 offset:34816
v_mfma_f32_16x16x32_bf16 v[88:91], a[132:135], a[60:63], v[88:91]
s_waitcnt lgkmcnt(3)
v_mfma_f32_16x16x32_bf16 v[36:39], a[136:139], a[0:3], v[36:39]
s_add_u32 m0, s28, 0
ds_read_b64_tr_b16 a[128:129], v6 offset:0
v_mfma_f32_16x16x32_bf16 v[36:39], a[140:143], a[4:7], v[36:39]
buffer_load_dwordx4 v12, s[8:11], s24 offen offset:0 lds
v_mfma_f32_16x16x32_bf16 v[44:47], a[136:139], a[8:11], v[44:47]
ds_read_b64_tr_b16 a[130:131], v6 offset:2048
v_mfma_f32_16x16x32_bf16 v[44:47], a[140:143], a[12:15], v[44:47]
v_mfma_f32_16x16x32_bf16 v[52:55], a[136:139], a[16:19], v[52:55]
ds_read_b64_tr_b16 a[132:133], v6 offset:16384
v_mfma_f32_16x16x32_bf16 v[52:55], a[140:143], a[20:23], v[52:55]
buffer_load_dwordx4 v13, s[8:11], s24 offen offset:1024 lds
v_mfma_f32_16x16x32_bf16 v[60:63], a[136:139], a[24:27], v[60:63]
ds_read_b64_tr_b16 a[134:135], v6 offset:18432
v_mfma_f32_16x16x32_bf16 v[60:63], a[140:143], a[28:31], v[60:63]
v_mfma_f32_16x16x32_bf16 v[68:71], a[136:139], a[32:35], v[68:71]
ds_read_b128 a[76:79], v3 offset:34816
v_mfma_f32_16x16x32_bf16 v[68:71], a[140:143], a[36:39], v[68:71]
buffer_load_dwordx4 v14, s[8:11], s24 offen offset:2048 lds
v_mfma_f32_16x16x32_bf16 v[76:79], a[136:139], a[40:43], v[76:79]
v_mfma_f32_16x16x32_bf16 v[76:79], a[140:143], a[44:47], v[76:79]
v_mfma_f32_16x16x32_bf16 v[84:87], a[136:139], a[48:51], v[84:87]
ds_read_b128 a[80:83], v2 offset:36864
v_mfma_f32_16x16x32_bf16 v[84:87], a[140:143], a[52:55], v[84:87]
buffer_load_dwordx4 v15, s[8:11], s24 offen offset:3072 lds
v_mfma_f32_16x16x32_bf16 v[92:95], a[136:139], a[56:59], v[92:95]
s_add_u32 s24, s24, 128
ds_read_b128 a[84:87], v3 offset:36864
v_mfma_f32_16x16x32_bf16 v[92:95], a[140:143], a[60:63], v[92:95]
s_waitcnt lgkmcnt(3)
v_mfma_f32_16x16x32_bf16 v[96:99], a[128:131], a[0:3], v[96:99]
s_add_u32 m0, s28, 4096
ds_read_b64_tr_b16 a[136:137], v7 offset:0
v_mfma_f32_16x16x32_bf16 v[96:99], a[132:135], a[4:7], v[96:99]
buffer_load_dwordx4 v12, s[8:11], s25 offen offset:0 lds
v_mfma_f32_16x16x32_bf16 v[104:107], a[128:131], a[8:11], v[104:107]
ds_read_b64_tr_b16 a[138:139], v7 offset:2048
v_mfma_f32_16x16x32_bf16 v[104:107], a[132:135], a[12:15], v[104:107]
v_mfma_f32_16x16x32_bf16 v[112:115], a[128:131], a[16:19], v[112:115]
ds_read_b64_tr_b16 a[140:141], v7 offset:16384
v_mfma_f32_16x16x32_bf16 v[112:115], a[132:135], a[20:23], v[112:115]
buffer_load_dwordx4 v13, s[8:11], s25 offen offset:1024 lds
v_mfma_f32_16x16x32_bf16 v[120:123], a[128:131], a[24:27], v[120:123]
ds_read_b64_tr_b16 a[142:143], v7 offset:18432
v_mfma_f32_16x16x32_bf16 v[120:123], a[132:135], a[28:31], v[120:123]
v_mfma_f32_16x16x32_bf16 v[128:131], a[128:131], a[32:35], v[128:131]
v_mfma_f32_16x16x32_bf16 v[128:131], a[132:135], a[36:39], v[128:131]
buffer_load_dwordx4 v14, s[8:11], s25 offen offset:2048 lds
v_mfma_f32_16x16x32_bf16 v[136:139], a[128:131], a[40:43], v[136:139]
ds_read_b128 a[88:91], v2 offset:38912
v_mfma_f32_16x16x32_bf16 v[136:139], a[132:135], a[44:47], v[136:139]
v_mfma_f32_16x16x32_bf16 v[144:147], a[128:131], a[48:51], v[144:147]
ds_read_b128 a[92:95], v3 offset:38912
v_mfma_f32_16x16x32_bf16 v[144:147], a[132:135], a[52:55], v[144:147]
buffer_load_dwordx4 v15, s[8:11], s25 offen offset:3072 lds
v_mfma_f32_16x16x32_bf16 v[152:155], a[128:131], a[56:59], v[152:155]
s_add_u32 s25, s25, 128
v_mfma_f32_16x16x32_bf16 v[152:155], a[132:135], a[60:63], v[152:155]
s_waitcnt lgkmcnt(2)
v_mfma_f32_16x16x32_bf16 v[100:103], a[136:139], a[0:3], v[100:103]
ds_read_b64_tr_b16 a[128:129], v8 offset:0
v_mfma_f32_16x16x32_bf16 v[100:103], a[140:143], a[4:7], v[100:103]
buffer_load_dword v21, v20, s[16:19], s43 offen
v_mfma_f32_16x16x32_bf16 v[108:111], a[136:139], a[8:11], v[108:111]
s_add_u32 s43, s43, s47
ds_read_b64_tr_b16 a[130:131], v8 offset:2048
v_mfma_f32_16x16x32_bf16 v[108:111], a[140:143], a[12:15], v[108:111]
PAD_2:
s_cbranch_execz M_tret
s_cmp_ge_u32 s43, s51
v_mfma_f32_16x16x32_bf16 v[116:119], a[136:139], a[16:19], v[116:119]
s_cselect_b32 s43, 0, s43
ds_read_b64_tr_b16 a[132:133], v8 offset:16384
v_mfma_f32_16x16x32_bf16 v[116:119], a[140:143], a[20:23], v[116:119]
s_cselect_b32 s51, s42, s51
v_mfma_f32_16x16x32_bf16 v[124:127], a[136:139], a[24:27], v[124:127]
s_cselect_b64 s[16:17], s[40:41], s[16:17]
ds_read_b64_tr_b16 a[134:135], v8 offset:18432
v_mfma_f32_16x16x32_bf16 v[124:127], a[140:143], a[28:31], v[124:127]
s_cselect_b32 s18, s42, s18
v_mfma_f32_16x16x32_bf16 v[132:135], a[136:139], a[32:35], v[132:135]
s_cselect_b64 s[40:41], s[44:45], s[40:41]
ds_read_b128 a[96:99], v2 offset:40960
v_mfma_f32_16x16x32_bf16 v[132:135], a[140:143], a[36:39], v[132:135]
s_cselect_b32 s42, s46, s42
v_mfma_f32_16x16x32_bf16 v[140:143], a[136:139], a[40:43], v[140:143]
s_cselect_b32 s46, 0, s46
v_mfma_f32_16x16x32_bf16 v[140:143], a[140:143], a[44:47], v[140:143]
s_lshl_b32 s59, s39, 5
v_mfma_f32_16x16x32_bf16 v[148:151], a[136:139], a[48:51], v[148:151]
s_add_u32 s59, s59, s38
ds_read_b128 a[100:103], v3 offset:40960
v_mfma_f32_16x16x32_bf16 v[148:151], a[140:143], a[52:55], v[148:151]
s_lshl_b32 s59, s59, 2
v_mfma_f32_16x16x32_bf16 v[156:159], a[136:139], a[56:59], v[156:159]
s_add_u32 s59, s59, 94392320
ds_read_b128 a[104:107], v2 offset:43008
v_mfma_f32_16x16x32_bf16 v[156:159], a[140:143], a[60:63], v[156:159]
s_waitcnt lgkmcnt(3)
s_cmp_lt_u32 s2, 224
v_mfma_f32_16x16x32_bf16 v[160:163], a[128:131], a[0:3], v[160:163]
s_cselect_b32 s59, s59, 3221225472
ds_read_b64_tr_b16 a[136:137], v9 offset:0
v_mfma_f32_16x16x32_bf16 v[160:163], a[132:135], a[4:7], v[160:163]
s_mov_b32 s58, 0xffff0000
v_mfma_f32_16x16x32_bf16 v[168:171], a[128:131], a[8:11], v[168:171]
ds_read_b64_tr_b16 a[138:139], v9 offset:2048
v_mfma_f32_16x16x32_bf16 v[168:171], a[132:135], a[12:15], v[168:171]
buffer_load_dword v21, v20, s[16:19], s43 offen
v_mfma_f32_16x16x32_bf16 v[176:179], a[128:131], a[16:19], v[176:179]
s_add_u32 s43, s43, s47
ds_read_b64_tr_b16 a[140:141], v9 offset:16384
v_mfma_f32_16x16x32_bf16 v[176:179], a[132:135], a[20:23], v[176:179]
s_cmp_ge_u32 s43, s51
v_mfma_f32_16x16x32_bf16 v[184:187], a[128:131], a[24:27], v[184:187]
s_cselect_b32 s43, 0, s43
ds_read_b64_tr_b16 a[142:143], v9 offset:18432
v_mfma_f32_16x16x32_bf16 v[184:187], a[132:135], a[28:31], v[184:187]
s_cselect_b32 s51, s42, s51
v_mfma_f32_16x16x32_bf16 v[192:195], a[128:131], a[32:35], v[192:195]
s_cselect_b64 s[16:17], s[40:41], s[16:17]
v_mfma_f32_16x16x32_bf16 v[192:195], a[132:135], a[36:39], v[192:195]
s_cselect_b32 s18, s42, s18
v_mfma_f32_16x16x32_bf16 v[200:203], a[128:131], a[40:43], v[200:203]
s_cselect_b64 s[40:41], s[44:45], s[40:41]
ds_read_b128 a[108:111], v3 offset:43008
v_mfma_f32_16x16x32_bf16 v[200:203], a[132:135], a[44:47], v[200:203]
s_cselect_b32 s42, s46, s42
v_mfma_f32_16x16x32_bf16 v[208:211], a[128:131], a[48:51], v[208:211]
s_cselect_b32 s46, 0, s46
ds_read_b128 a[112:115], v2 offset:45056
v_mfma_f32_16x16x32_bf16 v[208:211], a[132:135], a[52:55], v[208:211]
v_mfma_f32_16x16x32_bf16 v[216:219], a[128:131], a[56:59], v[216:219]
v_mfma_f32_16x16x32_bf16 v[216:219], a[132:135], a[60:63], v[216:219]
s_waitcnt lgkmcnt(2)
v_mfma_f32_16x16x32_bf16 v[164:167], a[136:139], a[0:3], v[164:167]
ds_read_b64_tr_b16 a[128:129], v10 offset:0
v_mfma_f32_16x16x32_bf16 v[164:167], a[140:143], a[4:7], v[164:167]
v_mfma_f32_16x16x32_bf16 v[172:175], a[136:139], a[8:11], v[172:175]
ds_read_b64_tr_b16 a[130:131], v10 offset:2048
v_mfma_f32_16x16x32_bf16 v[172:175], a[140:143], a[12:15], v[172:175]
v_mfma_f32_16x16x32_bf16 v[180:183], a[136:139], a[16:19], v[180:183]
ds_read_b64_tr_b16 a[132:133], v10 offset:16384
v_mfma_f32_16x16x32_bf16 v[180:183], a[140:143], a[20:23], v[180:183]
v_mfma_f32_16x16x32_bf16 v[188:191], a[136:139], a[24:27], v[188:191]
ds_read_b64_tr_b16 a[134:135], v10 offset:18432
v_mfma_f32_16x16x32_bf16 v[188:191], a[140:143], a[28:31], v[188:191]
v_mfma_f32_16x16x32_bf16 v[196:199], a[136:139], a[32:35], v[196:199]
ds_read_b128 a[116:119], v3 offset:45056
v_mfma_f32_16x16x32_bf16 v[196:199], a[140:143], a[36:39], v[196:199]
v_mfma_f32_16x16x32_bf16 v[204:207], a[136:139], a[40:43], v[204:207]
ds_read_b128 a[120:123], v2 offset:47104
v_and_b32 v252, 31, v0
v_mfma_f32_16x16x32_bf16 v[204:207], a[140:143], a[44:47], v[204:207]
v_lshrrev_b32 v253, 5, v0
v_xor_b32 v253, v253, v252
v_mfma_f32_16x16x32_bf16 v[212:215], a[136:139], a[48:51], v[212:215]
v_and_b32 v253, 7, v253
v_lshlrev_b32 v252, 8, v252
v_mfma_f32_16x16x32_bf16 v[212:215], a[140:143], a[52:55], v[212:215]
v_lshl_add_u32 v252, v253, 4, v252
v_add_u32 v252, 147456, v252
v_mfma_f32_16x16x32_bf16 v[220:223], a[136:139], a[56:59], v[220:223]
ds_read_b128 a[124:127], v3 offset:47104
v_mfma_f32_16x16x32_bf16 v[220:223], a[140:143], a[60:63], v[220:223]
s_waitcnt lgkmcnt(3)
v_mfma_f32_16x16x32_bf16 a[192:195], a[128:131], a[0:3], a[192:195]
ds_read_b64_tr_b16 a[136:137], v11 offset:0
v_mfma_f32_16x16x32_bf16 a[192:195], a[132:135], a[4:7], a[192:195]
v_mfma_f32_16x16x32_bf16 a[200:203], a[128:131], a[8:11], a[200:203]
ds_read_b64_tr_b16 a[138:139], v11 offset:2048
v_mfma_f32_16x16x32_bf16 a[200:203], a[132:135], a[12:15], a[200:203]
v_mfma_f32_16x16x32_bf16 a[208:211], a[128:131], a[16:19], a[208:211]
ds_read_b64_tr_b16 a[140:141], v11 offset:16384
v_mfma_f32_16x16x32_bf16 a[208:211], a[132:135], a[20:23], a[208:211]
v_mfma_f32_16x16x32_bf16 a[216:219], a[128:131], a[24:27], a[216:219]
ds_read_b64_tr_b16 a[142:143], v11 offset:18432
v_mfma_f32_16x16x32_bf16 a[216:219], a[132:135], a[28:31], a[216:219]
v_mfma_f32_16x16x32_bf16 a[224:227], a[128:131], a[32:35], a[224:227]
v_mfma_f32_16x16x32_bf16 a[224:227], a[132:135], a[36:39], a[224:227]
v_mfma_f32_16x16x32_bf16 a[232:235], a[128:131], a[40:43], a[232:235]
v_mfma_f32_16x16x32_bf16 a[232:235], a[132:135], a[44:47], a[232:235]
v_mfma_f32_16x16x32_bf16 a[240:243], a[128:131], a[48:51], a[240:243]
v_mfma_f32_16x16x32_bf16 a[240:243], a[132:135], a[52:55], a[240:243]
v_mfma_f32_16x16x32_bf16 a[248:251], a[128:131], a[56:59], a[248:251]
s_waitcnt vmcnt(2) lgkmcnt(0)
v_mfma_f32_16x16x32_bf16 a[248:251], a[132:135], a[60:63], a[248:251]
s_barrier
v_mfma_f32_16x16x32_bf16 a[196:199], a[136:139], a[0:3], a[196:199]
s_add_u32 m0, s29, 65536
ds_read_b64_tr_b16 a[128:129], v4 offset:32768
v_lshlrev_b32 v28, 16, v248
v_mfma_f32_16x16x32_bf16 a[196:199], a[140:143], a[4:7], a[196:199]
buffer_load_dwordx4 v16, s[12:15], s26 offen offset:0 lds
v_mfma_f32_16x16x32_bf16 a[204:207], a[136:139], a[8:11], a[204:207]
ds_read_b64_tr_b16 a[130:131], v4 offset:34816
v_and_b32 v29, s58, v248
v_mfma_f32_16x16x32_bf16 a[204:207], a[140:143], a[12:15], a[204:207]
v_lshlrev_b32 v30, 16, v249
v_and_b32 v253, s58, v249
v_mfma_f32_16x16x32_bf16 a[212:215], a[136:139], a[16:19], a[212:215]
ds_read_b64_tr_b16 a[132:133], v4 offset:49152
v_lshlrev_b32 v22, 16, v224
v_mfma_f32_16x16x32_bf16 a[212:215], a[140:143], a[20:23], a[212:215]
buffer_load_dwordx4 v17, s[12:15], s26 offen offset:1024 lds
v_mfma_f32_16x16x32_bf16 a[220:223], a[136:139], a[24:27], a[220:223]
ds_read_b64_tr_b16 a[134:135], v4 offset:51200
v_lshlrev_b32 v23, 16, v225
v_mfma_f32_16x16x32_bf16 a[220:223], a[140:143], a[28:31], a[220:223]
v_lshlrev_b32 v24, 16, v226
v_mul_f32 v254, v22, v253
v_mfma_f32_16x16x32_bf16 a[228:231], a[136:139], a[32:35], a[228:231]
v_lshlrev_b32 v25, 16, v227
v_lshlrev_b32 v247, 16, v236
v_mfma_f32_16x16x32_bf16 a[228:231], a[140:143], a[36:39], a[228:231]
buffer_load_dwordx4 v18, s[12:15], s26 offen offset:2048 lds
v_mfma_f32_16x16x32_bf16 a[236:239], a[136:139], a[40:43], a[236:239]
v_fmac_f32 v254, v23, v30
v_fmac_f32 v254, v24, v29
v_mfma_f32_16x16x32_bf16 a[236:239], a[140:143], a[44:47], a[236:239]
v_fmac_f32 v254, v25, v28
v_mul_f32 v254, v254, v247
v_mfma_f32_16x16x32_bf16 a[244:247], a[136:139], a[48:51], a[244:247]
v_mul_f32 v255, v23, v253
v_lshlrev_b32 v22, 16, v228
v_mfma_f32_16x16x32_bf16 a[244:247], a[140:143], a[52:55], a[244:247]
buffer_load_dwordx4 v19, s[12:15], s26 offen offset:3072 lds
v_mfma_f32_16x16x32_bf16 a[252:255], a[136:139], a[56:59], a[252:255]
s_add_u32 s26, s26, 524288
v_lshlrev_b32 v247, 16, v237
v_fmac_f32 v255, v24, v30
v_mfma_f32_16x16x32_bf16 a[252:255], a[140:143], a[60:63], a[252:255]
s_waitcnt lgkmcnt(0)
v_fmac_f32 v255, v25, v29
v_fmac_f32 v255, v22, v28
v_mfma_f32_16x16x32_bf16 v[32:35], a[128:131], a[64:67], v[32:35]
s_add_u32 m0, s29, 81920
ds_read_b64_tr_b16 a[136:137], v5 offset:32768
v_mul_f32 v255, v255, v247
v_mfma_f32_16x16x32_bf16 v[32:35], a[132:135], a[68:71], v[32:35]
buffer_load_dwordx4 v16, s[12:15], s27 offen offset:0 lds
v_mfma_f32_16x16x32_bf16 v[40:43], a[128:131], a[72:75], v[40:43]
ds_read_b64_tr_b16 a[138:139], v5 offset:34816
v_cvt_pk_bf16_f32 v246, v254, v255
v_mfma_f32_16x16x32_bf16 v[40:43], a[132:135], a[76:79], v[40:43]
v_accvgpr_write_b32 a180, v246
v_mul_f32 v254, v24, v253
v_mfma_f32_16x16x32_bf16 v[48:51], a[128:131], a[80:83], v[48:51]
ds_read_b64_tr_b16 a[140:141], v5 offset:49152
v_lshlrev_b32 v23, 16, v229
v_mfma_f32_16x16x32_bf16 v[48:51], a[132:135], a[84:87], v[48:51]
buffer_load_dwordx4 v17, s[12:15], s27 offen offset:1024 lds
v_mfma_f32_16x16x32_bf16 v[56:59], a[128:131], a[88:91], v[56:59]
ds_read_b64_tr_b16 a[142:143], v5 offset:51200
v_lshlrev_b32 v247, 16, v238
v_mfma_f32_16x16x32_bf16 v[56:59], a[132:135], a[92:95], v[56:59]
v_fmac_f32 v254, v25, v30
v_fmac_f32 v254, v22, v29
v_fmac_f32 v254, v23, v28
v_mfma_f32_16x16x32_bf16 v[64:67], a[128:131], a[96:99], v[64:67]
ds_read_b128 a[0:3], v2 offset:0
v_mul_f32 v254, v254, v247
v_mfma_f32_16x16x32_bf16 v[64:67], a[132:135], a[100:103], v[64:67]
buffer_load_dwordx4 v18, s[12:15], s27 offen offset:2048 lds
v_mfma_f32_16x16x32_bf16 v[72:75], a[128:131], a[104:107], v[72:75]
ds_read_b128 a[4:7], v3 offset:0
v_cvt_pk_bf16_f32 v246, v255, v254
v_mfma_f32_16x16x32_bf16 v[72:75], a[132:135], a[108:111], v[72:75]
v_accvgpr_write_b32 a176, v246
v_mul_f32 v255, v25, v253
v_mfma_f32_16x16x32_bf16 v[80:83], a[128:131], a[112:115], v[80:83]
v_lshlrev_b32 v24, 16, v230
v_lshlrev_b32 v247, 16, v239
v_mfma_f32_16x16x32_bf16 v[80:83], a[132:135], a[116:119], v[80:83]
buffer_load_dwordx4 v19, s[12:15], s27 offen offset:3072 lds
v_mfma_f32_16x16x32_bf16 v[88:91], a[128:131], a[120:123], v[88:91]
s_add_u32 s27, s27, 524288
ds_read_b128 a[8:11], v2 offset:2048
v_fmac_f32 v255, v22, v30
v_mfma_f32_16x16x32_bf16 v[88:91], a[132:135], a[124:127], v[88:91]
s_waitcnt lgkmcnt(3)
v_fmac_f32 v255, v23, v29
v_fmac_f32 v255, v24, v28
v_mul_f32 v255, v255, v247
v_mfma_f32_16x16x32_bf16 v[36:39], a[136:139], a[64:67], v[36:39]
s_add_u32 m0, s28, 32768
ds_read_b64_tr_b16 a[128:129], v6 offset:32768
v_cvt_pk_bf16_f32 v246, v254, v255
v_mfma_f32_16x16x32_bf16 v[36:39], a[140:143], a[68:71], v[36:39]
buffer_load_dwordx4 v12, s[8:11], s24 offen offset:0 lds
v_mfma_f32_16x16x32_bf16 v[44:47], a[136:139], a[72:75], v[44:47]
ds_read_b64_tr_b16 a[130:131], v6 offset:34816
v_accvgpr_write_b32 a181, v246
v_mfma_f32_16x16x32_bf16 v[44:47], a[140:143], a[76:79], v[44:47]
v_mul_f32 v254, v22, v253
v_lshlrev_b32 v25, 16, v231
v_mfma_f32_16x16x32_bf16 v[52:55], a[136:139], a[80:83], v[52:55]
ds_read_b64_tr_b16 a[132:133], v6 offset:49152
v_lshlrev_b32 v247, 16, v240
v_mfma_f32_16x16x32_bf16 v[52:55], a[140:143], a[84:87], v[52:55]
buffer_load_dwordx4 v13, s[8:11], s24 offen offset:1024 lds
v_mfma_f32_16x16x32_bf16 v[60:63], a[136:139], a[88:91], v[60:63]
ds_read_b64_tr_b16 a[134:135], v6 offset:51200
v_fmac_f32 v254, v23, v30
v_fmac_f32 v254, v24, v29
v_mfma_f32_16x16x32_bf16 v[60:63], a[140:143], a[92:95], v[60:63]
v_fmac_f32 v254, v25, v28
v_mul_f32 v254, v254, v247
v_mfma_f32_16x16x32_bf16 v[68:71], a[136:139], a[96:99], v[68:71]
ds_read_b128 a[12:15], v3 offset:2048
v_cvt_pk_bf16_f32 v246, v255, v254
v_mfma_f32_16x16x32_bf16 v[68:71], a[140:143], a[100:103], v[68:71]
buffer_load_dwordx4 v14, s[8:11], s24 offen offset:2048 lds
v_mfma_f32_16x16x32_bf16 v[76:79], a[136:139], a[104:107], v[76:79]
v_accvgpr_write_b32 a177, v246
v_mul_f32 v255, v23, v253
v_mfma_f32_16x16x32_bf16 v[76:79], a[140:143], a[108:111], v[76:79]
v_lshlrev_b32 v22, 16, v232
v_lshlrev_b32 v247, 16, v241
v_mfma_f32_16x16x32_bf16 v[84:87], a[136:139], a[112:115], v[84:87]
ds_read_b128 a[16:19], v2 offset:4096
v_fmac_f32 v255, v24, v30
v_mfma_f32_16x16x32_bf16 v[84:87], a[140:143], a[116:119], v[84:87]
buffer_load_dwordx4 v15, s[8:11], s24 offen offset:3072 lds
v_mfma_f32_16x16x32_bf16 v[92:95], a[136:139], a[120:123], v[92:95]
s_add_u32 s24, s24, 128
ds_read_b128 a[20:23], v3 offset:4096
v_fmac_f32 v255, v25, v29
v_fmac_f32 v255, v22, v28
v_mfma_f32_16x16x32_bf16 v[92:95], a[140:143], a[124:127], v[92:95]
s_waitcnt lgkmcnt(3)
v_mul_f32 v255, v255, v247
v_cvt_pk_bf16_f32 v246, v254, v255
v_mfma_f32_16x16x32_bf16 v[96:99], a[128:131], a[64:67], v[96:99]
s_add_u32 m0, s28, 36864
ds_read_b64_tr_b16 a[136:137], v7 offset:32768
v_accvgpr_write_b32 a182, v246
v_mfma_f32_16x16x32_bf16 v[96:99], a[132:135], a[68:71], v[96:99]
buffer_load_dwordx4 v12, s[8:11], s25 offen offset:0 lds
v_mfma_f32_16x16x32_bf16 v[104:107], a[128:131], a[72:75], v[104:107]
ds_read_b64_tr_b16 a[138:139], v7 offset:34816
v_mul_f32 v254, v24, v253
v_mfma_f32_16x16x32_bf16 v[104:107], a[132:135], a[76:79], v[104:107]
v_lshlrev_b32 v23, 16, v233
v_lshlrev_b32 v247, 16, v242
v_mfma_f32_16x16x32_bf16 v[112:115], a[128:131], a[80:83], v[112:115]
ds_read_b64_tr_b16 a[140:141], v7 offset:49152
v_fmac_f32 v254, v25, v30
v_mfma_f32_16x16x32_bf16 v[112:115], a[132:135], a[84:87], v[112:115]
buffer_load_dwordx4 v13, s[8:11], s25 offen offset:1024 lds
v_fmac_f32 v254, v22, v29
v_mfma_f32_16x16x32_bf16 v[120:123], a[128:131], a[88:91], v[120:123]
ds_read_b64_tr_b16 a[142:143], v7 offset:51200
v_fmac_f32 v254, v23, v28
v_mfma_f32_16x16x32_bf16 v[120:123], a[132:135], a[92:95], v[120:123]
v_mul_f32 v254, v254, v247
v_cvt_pk_bf16_f32 v246, v255, v254
v_mfma_f32_16x16x32_bf16 v[128:131], a[128:131], a[96:99], v[128:131]
v_accvgpr_write_b32 a178, v246
v_mul_f32 v255, v25, v253
v_mfma_f32_16x16x32_bf16 v[128:131], a[132:135], a[100:103], v[128:131]
buffer_load_dwordx4 v14, s[8:11], s25 offen offset:2048 lds
v_mfma_f32_16x16x32_bf16 v[136:139], a[128:131], a[104:107], v[136:139]
ds_read_b128 a[24:27], v2 offset:6144
v_lshlrev_b32 v24, 16, v234
v_mfma_f32_16x16x32_bf16 v[136:139], a[132:135], a[108:111], v[136:139]
v_lshlrev_b32 v247, 16, v243
v_fmac_f32 v255, v22, v30
v_mfma_f32_16x16x32_bf16 v[144:147], a[128:131], a[112:115], v[144:147]
ds_read_b128 a[28:31], v3 offset:6144
v_fmac_f32 v255, v23, v29
v_mfma_f32_16x16x32_bf16 v[144:147], a[132:135], a[116:119], v[144:147]
buffer_load_dwordx4 v15, s[8:11], s25 offen offset:3072 lds
v_fmac_f32 v255, v24, v28
v_mfma_f32_16x16x32_bf16 v[152:155], a[128:131], a[120:123], v[152:155]
s_add_u32 s25, s25, 128
v_mul_f32 v255, v255, v247
v_cvt_pk_bf16_f32 v246, v254, v255
v_mfma_f32_16x16x32_bf16 v[152:155], a[132:135], a[124:127], v[152:155]
s_waitcnt lgkmcnt(2)
v_accvgpr_write_b32 a183, v246
v_mul_f32 v254, v22, v253
v_mfma_f32_16x16x32_bf16 v[100:103], a[136:139], a[64:67], v[100:103]
ds_read_b64_tr_b16 a[128:129], v8 offset:32768
v_lshlrev_b32 v25, 16, v235
v_mfma_f32_16x16x32_bf16 v[100:103], a[140:143], a[68:71], v[100:103]
buffer_load_dword v21, v20, s[16:19], s43 offen
v_mfma_f32_16x16x32_bf16 v[108:111], a[136:139], a[72:75], v[108:111]
s_add_u32 s43, s43, s47
ds_read_b64_tr_b16 a[130:131], v8 offset:34816
v_lshlrev_b32 v247, 16, v244
v_mfma_f32_16x16x32_bf16 v[108:111], a[140:143], a[76:79], v[108:111]
s_cmp_ge_u32 s43, s51
v_fmac_f32 v254, v23, v30
v_fmac_f32 v254, v24, v29
v_mfma_f32_16x16x32_bf16 v[116:119], a[136:139], a[80:83], v[116:119]
s_cselect_b32 s43, 0, s43
ds_read_b64_tr_b16 a[132:133], v8 offset:49152
v_fmac_f32 v254, v25, v28
v_mul_f32 v254, v254, v247
v_mfma_f32_16x16x32_bf16 v[116:119], a[140:143], a[84:87], v[116:119]
s_cselect_b32 s51, s42, s51
v_cvt_pk_bf16_f32 v246, v255, v254
v_accvgpr_write_b32 a179, v246
v_mfma_f32_16x16x32_bf16 v[124:127], a[136:139], a[88:91], v[124:127]
s_cselect_b64 s[16:17], s[40:41], s[16:17]
ds_read_b64_tr_b16 a[134:135], v8 offset:51200
v_lshlrev_b32 v28, 16, v250
v_mfma_f32_16x16x32_bf16 v[124:127], a[140:143], a[92:95], v[124:127]
s_cselect_b32 s18, s42, s18
v_and_b32 v29, s58, v250
v_lshlrev_b32 v30, 16, v251
v_mfma_f32_16x16x32_bf16 v[132:135], a[136:139], a[96:99], v[132:135]
s_cselect_b64 s[40:41], s[44:45], s[40:41]
ds_read_b128 a[32:35], v2 offset:8192
v_and_b32 v253, s58, v251
v_mfma_f32_16x16x32_bf16 v[132:135], a[140:143], a[100:103], v[132:135]
s_cselect_b32 s42, s46, s42
v_and_b32 v22, s58, v224
v_and_b32 v23, s58, v225
v_mfma_f32_16x16x32_bf16 v[140:143], a[136:139], a[104:107], v[140:143]
s_cselect_b32 s46, 0, s46
v_and_b32 v24, s58, v226
v_mul_f32 v254, v22, v253
v_mfma_f32_16x16x32_bf16 v[140:143], a[140:143], a[108:111], v[140:143]
buffer_load_dword v245, off, s[60:63], 0 sc1
v_mfma_f32_16x16x32_bf16 v[148:151], a[136:139], a[112:115], v[148:151]
ds_read_b128 a[36:39], v3 offset:8192
v_and_b32 v25, s58, v227
v_and_b32 v247, s58, v236
v_mfma_f32_16x16x32_bf16 v[148:151], a[140:143], a[116:119], v[148:151]
v_fmac_f32 v254, v23, v30
v_fmac_f32 v254, v24, v29
v_mfma_f32_16x16x32_bf16 v[156:159], a[136:139], a[120:123], v[156:159]
ds_read_b128 a[40:43], v2 offset:10240
v_fmac_f32 v254, v25, v28
v_mfma_f32_16x16x32_bf16 v[156:159], a[140:143], a[124:127], v[156:159]
s_waitcnt lgkmcnt(3)
v_mul_f32 v254, v254, v247
v_mul_f32 v255, v23, v253
v_mfma_f32_16x16x32_bf16 v[160:163], a[128:131], a[64:67], v[160:163]
ds_read_b64_tr_b16 a[136:137], v9 offset:32768
v_and_b32 v22, s58, v228
v_mfma_f32_16x16x32_bf16 v[160:163], a[132:135], a[68:71], v[160:163]
v_and_b32 v247, s58, v237
v_fmac_f32 v255, v24, v30
v_mfma_f32_16x16x32_bf16 v[168:171], a[128:131], a[72:75], v[168:171]
ds_read_b64_tr_b16 a[138:139], v9 offset:34816
v_fmac_f32 v255, v25, v29
v_mfma_f32_16x16x32_bf16 v[168:171], a[132:135], a[76:79], v[168:171]
v_fmac_f32 v255, v22, v28
v_mul_f32 v255, v255, v247
v_mfma_f32_16x16x32_bf16 v[176:179], a[128:131], a[80:83], v[176:179]
ds_read_b64_tr_b16 a[140:141], v9 offset:49152
v_cvt_pk_bf16_f32 v246, v254, v255
v_accvgpr_write_b32 a188, v246
v_mfma_f32_16x16x32_bf16 v[176:179], a[132:135], a[84:87], v[176:179]
v_mul_f32 v254, v24, v253
v_and_b32 v23, s58, v229
v_mfma_f32_16x16x32_bf16 v[184:187], a[128:131], a[88:91], v[184:187]
ds_read_b64_tr_b16 a[142:143], v9 offset:51200
v_and_b32 v247, s58, v238
v_mfma_f32_16x16x32_bf16 v[184:187], a[132:135], a[92:95], v[184:187]
v_fmac_f32 v254, v25, v30
v_fmac_f32 v254, v22, v29
v_mfma_f32_16x16x32_bf16 v[192:195], a[128:131], a[96:99], v[192:195]
v_fmac_f32 v254, v23, v28
v_mul_f32 v254, v254, v247
v_mfma_f32_16x16x32_bf16 v[192:195], a[132:135], a[100:103], v[192:195]
v_cvt_pk_bf16_f32 v246, v255, v254
v_accvgpr_write_b32 a184, v246
v_mfma_f32_16x16x32_bf16 v[200:203], a[128:131], a[104:107], v[200:203]
ds_read_b128 a[44:47], v3 offset:10240
v_mul_f32 v255, v25, v253
v_mfma_f32_16x16x32_bf16 v[200:203], a[132:135], a[108:111], v[200:203]
v_and_b32 v24, s58, v230
v_and_b32 v247, s58, v239
v_fmac_f32 v255, v22, v30
v_mfma_f32_16x16x32_bf16 v[208:211], a[128:131], a[112:115], v[208:211]
ds_read_b128 a[48:51], v2 offset:12288
v_fmac_f32 v255, v23, v29
v_mfma_f32_16x16x32_bf16 v[208:211], a[132:135], a[116:119], v[208:211]
v_fmac_f32 v255, v24, v28
v_mul_f32 v255, v255, v247
v_mfma_f32_16x16x32_bf16 v[216:219], a[128:131], a[120:123], v[216:219]
v_cvt_pk_bf16_f32 v246, v254, v255
v_accvgpr_write_b32 a189, v246
v_mfma_f32_16x16x32_bf16 v[216:219], a[132:135], a[124:127], v[216:219]
s_waitcnt lgkmcnt(2)
v_mul_f32 v254, v22, v253
v_and_b32 v25, s58, v231
v_mfma_f32_16x16x32_bf16 v[164:167], a[136:139], a[64:67], v[164:167]
ds_read_b64_tr_b16 a[128:129], v10 offset:32768
v_and_b32 v247, s58, v240
v_mfma_f32_16x16x32_bf16 v[164:167], a[140:143], a[68:71], v[164:167]
v_fmac_f32 v254, v23, v30
v_fmac_f32 v254, v24, v29
v_mfma_f32_16x16x32_bf16 v[172:175], a[136:139], a[72:75], v[172:175]
ds_read_b64_tr_b16 a[130:131], v10 offset:34816
v_fmac_f32 v254, v25, v28
v_mfma_f32_16x16x32_bf16 v[172:175], a[140:143], a[76:79], v[172:175]
v_mul_f32 v254, v254, v247
v_cvt_pk_bf16_f32 v246, v255, v254
v_accvgpr_write_b32 a185, v246
v_mfma_f32_16x16x32_bf16 v[180:183], a[136:139], a[80:83], v[180:183]
s_lshr_b32 s22, s3, 1
ds_read_b64_tr_b16 a[132:133], v10 offset:49152
v_mul_f32 v255, v23, v253
v_mfma_f32_16x16x32_bf16 v[180:183], a[140:143], a[84:87], v[180:183]
s_mul_i32 s22, s22, 2097152
v_and_b32 v22, s58, v232
v_and_b32 v247, s58, v241
v_mfma_f32_16x16x32_bf16 v[188:191], a[136:139], a[88:91], v[188:191]
s_and_b32 s23, s3, 1
ds_read_b64_tr_b16 a[134:135], v10 offset:51200
v_fmac_f32 v255, v24, v30
v_mfma_f32_16x16x32_bf16 v[188:191], a[140:143], a[92:95], v[188:191]
s_lshl_b32 s23, s23, 5
v_fmac_f32 v255, v25, v29
v_fmac_f32 v255, v22, v28
v_mfma_f32_16x16x32_bf16 v[196:199], a[136:139], a[96:99], v[196:199]
s_lshl_b32 s56, s39, 6
ds_read_b128 a[52:55], v3 offset:12288
v_mul_f32 v255, v255, v247
v_mfma_f32_16x16x32_bf16 v[196:199], a[140:143], a[100:103], v[196:199]
s_add_u32 s23, s23, s56
v_cvt_pk_bf16_f32 v246, v254, v255
v_accvgpr_write_b32 a190, v246
v_mfma_f32_16x16x32_bf16 v[204:207], a[136:139], a[104:107], v[204:207]
s_mul_i32 s23, s23, 4224
ds_read_b128 a[56:59], v2 offset:14336
v_mul_f32 v254, v24, v253
v_and_b32 v23, s58, v233
v_mfma_f32_16x16x32_bf16 v[204:207], a[140:143], a[108:111], v[204:207]
s_add_u32 s22, s22, s23
v_and_b32 v247, s58, v242
v_fmac_f32 v254, v25, v30
v_mfma_f32_16x16x32_bf16 v[212:215], a[136:139], a[112:115], v[212:215]
s_add_u32 s57, s22, 83886200
v_fmac_f32 v254, v22, v29
v_fmac_f32 v254, v23, v28
v_mfma_f32_16x16x32_bf16 v[212:215], a[140:143], a[116:119], v[212:215]
s_lshl_b32 s23, s38, 7
v_mul_f32 v254, v254, v247
v_cvt_pk_bf16_f32 v246, v255, v254
v_mfma_f32_16x16x32_bf16 v[220:223], a[136:139], a[120:123], v[220:223]
s_add_u32 s22, s22, s23
ds_read_b128 a[60:63], v3 offset:14336
v_accvgpr_write_b32 a186, v246
v_mfma_f32_16x16x32_bf16 v[220:223], a[140:143], a[124:127], v[220:223]
s_waitcnt lgkmcnt(3)
s_add_u32 s56, s22, 83886208
v_mul_f32 v255, v25, v253
v_and_b32 v24, s58, v234
v_mfma_f32_16x16x32_bf16 a[192:195], a[128:131], a[64:67], a[192:195]
s_cmp_lt_u32 s2, 224
ds_read_b64_tr_b16 a[136:137], v11 offset:32768
v_and_b32 v247, s58, v243
v_mfma_f32_16x16x32_bf16 a[192:195], a[132:135], a[68:71], a[192:195]
s_cselect_b32 s56, s56, 3221225472
v_fmac_f32 v255, v22, v30
v_fmac_f32 v255, v23, v29
v_mfma_f32_16x16x32_bf16 a[200:203], a[128:131], a[72:75], a[200:203]
s_cmp_eq_u32 s38, 0
ds_read_b64_tr_b16 a[138:139], v11 offset:34816
v_fmac_f32 v255, v24, v28
v_mul_f32 v255, v255, v247
v_mfma_f32_16x16x32_bf16 a[200:203], a[132:135], a[76:79], a[200:203]
s_cselect_b32 s57, s57, 3221225472
v_cvt_pk_bf16_f32 v246, v254, v255
v_accvgpr_write_b32 a191, v246
v_mfma_f32_16x16x32_bf16 a[208:211], a[128:131], a[80:83], a[208:211]
ds_read_b64_tr_b16 a[140:141], v11 offset:49152
v_mul_f32 v254, v22, v253
v_mfma_f32_16x16x32_bf16 a[208:211], a[132:135], a[84:87], a[208:211]
v_and_b32 v25, s58, v235
v_and_b32 v247, s58, v244
v_mfma_f32_16x16x32_bf16 a[216:219], a[128:131], a[88:91], a[216:219]
ds_read_b64_tr_b16 a[142:143], v11 offset:51200
v_fmac_f32 v254, v23, v30
v_mfma_f32_16x16x32_bf16 a[216:219], a[132:135], a[92:95], a[216:219]
ds_write_b128 v252, a[176:179] offset:0
v_fmac_f32 v254, v24, v29
v_mfma_f32_16x16x32_bf16 a[224:227], a[128:131], a[96:99], a[224:227]
v_fmac_f32 v254, v25, v28
v_mul_f32 v254, v254, v247
v_mfma_f32_16x16x32_bf16 a[224:227], a[132:135], a[100:103], a[224:227]
ds_write_b128 v252, a[180:183] offset:8192
v_cvt_pk_bf16_f32 v246, v255, v254
v_accvgpr_write_b32 a187, v246
v_mfma_f32_16x16x32_bf16 a[232:235], a[128:131], a[104:107], a[232:235]
v_mfma_f32_16x16x32_bf16 a[232:235], a[132:135], a[108:111], a[232:235]
ds_write_b128 v252, a[184:187] offset:128
v_mfma_f32_16x16x32_bf16 a[240:243], a[128:131], a[112:115], a[240:243]
v_mfma_f32_16x16x32_bf16 a[240:243], a[132:135], a[116:119], a[240:243]
ds_write_b128 v252, a[188:191] offset:8320
v_mfma_f32_16x16x32_bf16 a[248:251], a[128:131], a[120:123], a[248:251]
s_waitcnt vmcnt(2) lgkmcnt(0)
v_mfma_f32_16x16x32_bf16 a[248:251], a[132:135], a[124:127], a[248:251]
s_barrier
v_mfma_f32_16x16x32_bf16 a[196:199], a[136:139], a[64:67], a[196:199]
s_add_u32 m0, s29, 98304
ds_read_b64_tr_b16 a[128:129], v4 offset:0
v_lshrrev_b32 v22, 8, v1
v_mfma_f32_16x16x32_bf16 a[196:199], a[140:143], a[68:71], a[196:199]
buffer_load_dwordx4 v16, s[12:15], s26 offen offset:0 lds
v_mfma_f32_16x16x32_bf16 a[204:207], a[136:139], a[72:75], a[204:207]
ds_read_b64_tr_b16 a[130:131], v4 offset:2048
v_lshlrev_b32 v22, 4, v22
v_mfma_f32_16x16x32_bf16 a[204:207], a[140:143], a[76:79], a[204:207]
v_xor_b32 v22, v22, v1
v_add_u32 v22, s29, v22
v_mfma_f32_16x16x32_bf16 a[212:215], a[136:139], a[80:83], a[212:215]
ds_read_b64_tr_b16 a[132:133], v4 offset:16384
v_add_u32 v22, 147456, v22
v_mfma_f32_16x16x32_bf16 a[212:215], a[140:143], a[84:87], a[212:215]
buffer_load_dwordx4 v17, s[12:15], s26 offen offset:1024 lds
v_mfma_f32_16x16x32_bf16 a[220:223], a[136:139], a[88:91], a[220:223]
ds_read_b64_tr_b16 a[134:135], v4 offset:18432
v_xor_b32 v23, 64, v22
v_mfma_f32_16x16x32_bf16 a[220:223], a[140:143], a[92:95], a[220:223]
v_lshrrev_b32 v224, 7, v1
v_mul_u32_u24 v224, 4224, v224
v_mfma_f32_16x16x32_bf16 a[228:231], a[136:139], a[96:99], a[228:231]
v_and_b32 v225, 0x70, v1
v_add_u32 v224, v224, v225
v_mfma_f32_16x16x32_bf16 a[228:231], a[140:143], a[100:103], a[228:231]
buffer_load_dwordx4 v18, s[12:15], s26 offen offset:2048 lds
v_mfma_f32_16x16x32_bf16 a[236:239], a[136:139], a[104:107], a[236:239]
v_bfe_u32 v225, v1, 4, 5
v_mul_u32_u24 v225, 4224, v225
v_mfma_f32_16x16x32_bf16 a[236:239], a[140:143], a[108:111], a[236:239]
v_mov_b32 v226, 0
v_mov_b32 v227, 0
v_mfma_f32_16x16x32_bf16 a[244:247], a[136:139], a[112:115], a[244:247]
v_mfma_f32_16x16x32_bf16 a[244:247], a[140:143], a[116:119], a[244:247]
buffer_load_dwordx4 v19, s[12:15], s26 offen offset:3072 lds
v_mfma_f32_16x16x32_bf16 a[252:255], a[136:139], a[120:123], a[252:255]
s_add_u32 s26, s26, 524288
v_mfma_f32_16x16x32_bf16 a[252:255], a[140:143], a[124:127], a[252:255]
s_waitcnt lgkmcnt(0)
v_mfma_f32_16x16x32_bf16 v[32:35], a[128:131], a[0:3], v[32:35]
s_add_u32 m0, s29, 114688
ds_read_b64_tr_b16 a[136:137], v5 offset:0
v_mfma_f32_16x16x32_bf16 v[32:35], a[132:135], a[4:7], v[32:35]
buffer_load_dwordx4 v16, s[12:15], s27 offen offset:0 lds
v_mfma_f32_16x16x32_bf16 v[40:43], a[128:131], a[8:11], v[40:43]
s_mul_i32 s52, s20, 7
ds_read_b64_tr_b16 a[138:139], v5 offset:2048
v_mfma_f32_16x16x32_bf16 v[40:43], a[132:135], a[12:15], v[40:43]
s_add_u32 s52, s52, s21
buffer_store_dwordx2 v[226:227], v225, s[4:7], s57 offen sc1
v_mfma_f32_16x16x32_bf16 v[48:51], a[128:131], a[16:19], v[48:51]
s_lshl_b32 s53, s52, 2
ds_read_b64_tr_b16 a[140:141], v5 offset:16384
v_mfma_f32_16x16x32_bf16 v[48:51], a[132:135], a[20:23], v[48:51]
s_add_u32 s53, s53, s3
buffer_load_dwordx4 v17, s[12:15], s27 offen offset:1024 lds
v_mfma_f32_16x16x32_bf16 v[56:59], a[128:131], a[24:27], v[56:59]
s_lshl_b32 s49, s53, 12
ds_read_b64_tr_b16 a[142:143], v5 offset:18432
v_mfma_f32_16x16x32_bf16 v[56:59], a[132:135], a[28:31], v[56:59]
s_mul_i32 s53, s53, 4224
v_mfma_f32_16x16x32_bf16 v[64:67], a[128:131], a[32:35], v[64:67]
s_add_u32 s53, s53, 83886080
ds_read_b128 a[64:67], v2 offset:32768
v_mfma_f32_16x16x32_bf16 v[64:67], a[132:135], a[36:39], v[64:67]
s_lshr_b32 s52, s52, 4
buffer_load_dwordx4 v18, s[12:15], s27 offen offset:2048 lds
v_mfma_f32_16x16x32_bf16 v[72:75], a[128:131], a[40:43], v[72:75]
s_min_u32 s52, s52, 6
ds_read_b128 a[68:71], v3 offset:32768
v_mfma_f32_16x16x32_bf16 v[72:75], a[132:135], a[44:47], v[72:75]
s_lshl_b32 s52, s52, 7
ds_read_b128 a[176:179], v22 offset:0
v_mfma_f32_16x16x32_bf16 v[80:83], a[128:131], a[48:51], v[80:83]
s_add_u32 s52, s52, 94392320
ds_read_b128 a[180:183], v23 offset:1024
v_mfma_f32_16x16x32_bf16 v[80:83], a[132:135], a[52:55], v[80:83]
buffer_load_dwordx4 v19, s[12:15], s27 offen offset:3072 lds
v_mfma_f32_16x16x32_bf16 v[88:91], a[128:131], a[56:59], v[88:91]
s_add_u32 s27, s27, 524288
ds_read_b128 a[72:75], v2 offset:34816
v_mfma_f32_16x16x32_bf16 v[88:91], a[132:135], a[60:63], v[88:91]
s_waitcnt lgkmcnt(5)
ds_read_b128 a[184:187], v22 offset:2048
v_mfma_f32_16x16x32_bf16 v[36:39], a[136:139], a[0:3], v[36:39]
s_add_u32 m0, s28, 0
ds_read_b64_tr_b16 a[128:129], v6 offset:0
v_mfma_f32_16x16x32_bf16 v[36:39], a[140:143], a[4:7], v[36:39]
buffer_load_dwordx4 v12, s[8:11], s24 offen offset:0 lds
v_mfma_f32_16x16x32_bf16 v[44:47], a[136:139], a[8:11], v[44:47]
PAD_3:
s_cbranch_execz M_tret
ds_read_b64_tr_b16 a[130:131], v6 offset:2048
v_mfma_f32_16x16x32_bf16 v[44:47], a[140:143], a[12:15], v[44:47]
ds_read_b128 a[188:191], v23 offset:3072
v_mfma_f32_16x16x32_bf16 v[52:55], a[136:139], a[16:19], v[52:55]
ds_read_b64_tr_b16 a[132:133], v6 offset:16384
v_bfe_u32 v231, v1, 4, 5
v_mfma_f32_16x16x32_bf16 v[52:55], a[140:143], a[20:23], v[52:55]
buffer_load_dwordx4 v13, s[8:11], s24 offen offset:1024 lds
v_mfma_f32_16x16x32_bf16 v[60:63], a[136:139], a[24:27], v[60:63]
ds_read_b64_tr_b16 a[134:135], v6 offset:18432
v_lshlrev_b32 v231, 2, v231
v_mfma_f32_16x16x32_bf16 v[60:63], a[140:143], a[28:31], v[60:63]
v_lshlrev_b32 v229, 3, v1
v_min_u32 v229, 4096, v229
v_mfma_f32_16x16x32_bf16 v[68:71], a[136:139], a[32:35], v[68:71]
ds_read_b128 a[76:79], v3 offset:34816
v_mfma_f32_16x16x32_bf16 v[68:71], a[140:143], a[36:39], v[68:71]
buffer_load_dwordx4 v14, s[8:11], s24 offen offset:2048 lds
v_mfma_f32_16x16x32_bf16 v[76:79], a[136:139], a[40:43], v[76:79]
v_mfma_f32_16x16x32_bf16 v[76:79], a[140:143], a[44:47], v[76:79]
v_mfma_f32_16x16x32_bf16 v[84:87], a[136:139], a[48:51], v[84:87]
ds_read_b128 a[80:83], v2 offset:36864
v_mfma_f32_16x16x32_bf16 v[84:87], a[140:143], a[52:55], v[84:87]
buffer_load_dwordx4 v15, s[8:11], s24 offen offset:3072 lds
v_mfma_f32_16x16x32_bf16 v[92:95], a[136:139], a[56:59], v[92:95]
s_add_u32 s24, s24, 128
ds_read_b128 a[84:87], v3 offset:36864
v_mfma_f32_16x16x32_bf16 v[92:95], a[140:143], a[60:63], v[92:95]
s_waitcnt lgkmcnt(3)
v_mfma_f32_16x16x32_bf16 v[96:99], a[128:131], a[0:3], v[96:99]
s_add_u32 m0, s28, 4096
ds_read_b64_tr_b16 a[136:137], v7 offset:0
v_mfma_f32_16x16x32_bf16 v[96:99], a[132:135], a[4:7], v[96:99]
buffer_load_dwordx4 v12, s[8:11], s25 offen offset:0 lds
v_mfma_f32_16x16x32_bf16 v[104:107], a[128:131], a[8:11], v[104:107]
ds_read_b64_tr_b16 a[138:139], v7 offset:2048
v_mfma_f32_16x16x32_bf16 v[104:107], a[132:135], a[12:15], v[104:107]
v_mfma_f32_16x16x32_bf16 v[112:115], a[128:131], a[16:19], v[112:115]
ds_read_b64_tr_b16 a[140:141], v7 offset:16384
v_mfma_f32_16x16x32_bf16 v[112:115], a[132:135], a[20:23], v[112:115]
buffer_load_dwordx4 v13, s[8:11], s25 offen offset:1024 lds
v_mfma_f32_16x16x32_bf16 v[120:123], a[128:131], a[24:27], v[120:123]
ds_read_b64_tr_b16 a[142:143], v7 offset:18432
v_mfma_f32_16x16x32_bf16 v[120:123], a[132:135], a[28:31], v[120:123]
v_mfma_f32_16x16x32_bf16 v[128:131], a[128:131], a[32:35], v[128:131]
v_mfma_f32_16x16x32_bf16 v[128:131], a[132:135], a[36:39], v[128:131]
buffer_load_dwordx4 v14, s[8:11], s25 offen offset:2048 lds
v_mfma_f32_16x16x32_bf16 v[136:139], a[128:131], a[40:43], v[136:139]
ds_read_b128 a[88:91], v2 offset:38912
v_mfma_f32_16x16x32_bf16 v[136:139], a[132:135], a[44:47], v[136:139]
v_mfma_f32_16x16x32_bf16 v[144:147], a[128:131], a[48:51], v[144:147]
ds_read_b128 a[92:95], v3 offset:38912
v_mfma_f32_16x16x32_bf16 v[144:147], a[132:135], a[52:55], v[144:147]
buffer_load_dwordx4 v15, s[8:11], s25 offen offset:3072 lds
v_mfma_f32_16x16x32_bf16 v[152:155], a[128:131], a[56:59], v[152:155]
s_add_u32 s25, s25, 128
v_mfma_f32_16x16x32_bf16 v[152:155], a[132:135], a[60:63], v[152:155]
s_waitcnt lgkmcnt(2)
v_mfma_f32_16x16x32_bf16 v[100:103], a[136:139], a[0:3], v[100:103]
ds_read_b64_tr_b16 a[128:129], v8 offset:0
v_mfma_f32_16x16x32_bf16 v[100:103], a[140:143], a[4:7], v[100:103]
buffer_store_dwordx4 a[176:179], v224, s[4:7], s56 offen sc1
v_mfma_f32_16x16x32_bf16 v[108:111], a[136:139], a[8:11], v[108:111]
s_add_u32 s56, s56, 33792
ds_read_b64_tr_b16 a[130:131], v8 offset:2048
v_mfma_f32_16x16x32_bf16 v[108:111], a[140:143], a[12:15], v[108:111]
v_mfma_f32_16x16x32_bf16 v[116:119], a[136:139], a[16:19], v[116:119]
ds_read_b64_tr_b16 a[132:133], v8 offset:16384
v_mfma_f32_16x16x32_bf16 v[116:119], a[140:143], a[20:23], v[116:119]
v_mfma_f32_16x16x32_bf16 v[124:127], a[136:139], a[24:27], v[124:127]
s_cmp_lt_u32 s21, 0
ds_read_b64_tr_b16 a[134:135], v8 offset:18432
v_mfma_f32_16x16x32_bf16 v[124:127], a[140:143], a[28:31], v[124:127]
s_cselect_b32 s53, s53, 3221225472
v_mfma_f32_16x16x32_bf16 v[132:135], a[136:139], a[32:35], v[132:135]
s_cselect_b32 s49, s49, 3221225472
ds_read_b128 a[96:99], v2 offset:40960
v_mfma_f32_16x16x32_bf16 v[132:135], a[140:143], a[36:39], v[132:135]
s_add_u32 s48, s53, 2097152
v_mfma_f32_16x16x32_bf16 v[140:143], a[136:139], a[40:43], v[140:143]
v_mfma_f32_16x16x32_bf16 v[140:143], a[140:143], a[44:47], v[140:143]
v_mfma_f32_16x16x32_bf16 v[148:151], a[136:139], a[48:51], v[148:151]
ds_read_b128 a[100:103], v3 offset:40960
v_mfma_f32_16x16x32_bf16 v[148:151], a[140:143], a[52:55], v[148:151]
v_mfma_f32_16x16x32_bf16 v[156:159], a[136:139], a[56:59], v[156:159]
ds_read_b128 a[104:107], v2 offset:43008
v_mfma_f32_16x16x32_bf16 v[156:159], a[140:143], a[60:63], v[156:159]
s_waitcnt lgkmcnt(3)
v_mfma_f32_16x16x32_bf16 v[160:163], a[128:131], a[0:3], v[160:163]
ds_read_b64_tr_b16 a[136:137], v9 offset:0
v_mfma_f32_16x16x32_bf16 v[160:163], a[132:135], a[4:7], v[160:163]
v_mfma_f32_16x16x32_bf16 v[168:171], a[128:131], a[8:11], v[168:171]
ds_read_b64_tr_b16 a[138:139], v9 offset:2048
v_mfma_f32_16x16x32_bf16 v[168:171], a[132:135], a[12:15], v[168:171]
buffer_store_dwordx4 a[180:183], v224, s[4:7], s56 offen sc1
v_mfma_f32_16x16x32_bf16 v[176:179], a[128:131], a[16:19], v[176:179]
s_add_u32 s56, s56, 33792
ds_read_b64_tr_b16 a[140:141], v9 offset:16384
v_mfma_f32_16x16x32_bf16 v[176:179], a[132:135], a[20:23], v[176:179]
v_mfma_f32_16x16x32_bf16 v[184:187], a[128:131], a[24:27], v[184:187]
ds_read_b64_tr_b16 a[142:143], v9 offset:18432
v_mfma_f32_16x16x32_bf16 v[184:187], a[132:135], a[28:31], v[184:187]
v_mfma_f32_16x16x32_bf16 v[192:195], a[128:131], a[32:35], v[192:195]
v_mfma_f32_16x16x32_bf16 v[192:195], a[132:135], a[36:39], v[192:195]
v_mfma_f32_16x16x32_bf16 v[200:203], a[128:131], a[40:43], v[200:203]
ds_read_b128 a[108:111], v3 offset:43008
v_mfma_f32_16x16x32_bf16 v[200:203], a[132:135], a[44:47], v[200:203]
v_mfma_f32_16x16x32_bf16 v[208:211], a[128:131], a[48:51], v[208:211]
ds_read_b128 a[112:115], v2 offset:45056
v_mfma_f32_16x16x32_bf16 v[208:211], a[132:135], a[52:55], v[208:211]
v_mfma_f32_16x16x32_bf16 v[216:219], a[128:131], a[56:59], v[216:219]
v_mfma_f32_16x16x32_bf16 v[216:219], a[132:135], a[60:63], v[216:219]
s_waitcnt lgkmcnt(2)
v_mfma_f32_16x16x32_bf16 v[164:167], a[136:139], a[0:3], v[164:167]
ds_read_b64_tr_b16 a[128:129], v10 offset:0
v_mfma_f32_16x16x32_bf16 v[164:167], a[140:143], a[4:7], v[164:167]
v_mfma_f32_16x16x32_bf16 v[172:175], a[136:139], a[8:11], v[172:175]
ds_read_b64_tr_b16 a[130:131], v10 offset:2048
v_mfma_f32_16x16x32_bf16 v[172:175], a[140:143], a[12:15], v[172:175]
v_mfma_f32_16x16x32_bf16 v[180:183], a[136:139], a[16:19], v[180:183]
ds_read_b64_tr_b16 a[132:133], v10 offset:16384
v_mfma_f32_16x16x32_bf16 v[180:183], a[140:143], a[20:23], v[180:183]
buffer_store_dwordx4 a[184:187], v224, s[4:7], s56 offen sc1
v_mfma_f32_16x16x32_bf16 v[188:191], a[136:139], a[24:27], v[188:191]
s_add_u32 s56, s56, 33792
ds_read_b64_tr_b16 a[134:135], v10 offset:18432
v_mfma_f32_16x16x32_bf16 v[188:191], a[140:143], a[28:31], v[188:191]
v_mfma_f32_16x16x32_bf16 v[196:199], a[136:139], a[32:35], v[196:199]
ds_read_b128 a[116:119], v3 offset:45056
v_mfma_f32_16x16x32_bf16 v[196:199], a[140:143], a[36:39], v[196:199]
v_mfma_f32_16x16x32_bf16 v[204:207], a[136:139], a[40:43], v[204:207]
ds_read_b128 a[120:123], v2 offset:47104
v_mfma_f32_16x16x32_bf16 v[204:207], a[140:143], a[44:47], v[204:207]
v_mfma_f32_16x16x32_bf16 v[212:215], a[136:139], a[48:51], v[212:215]
v_mfma_f32_16x16x32_bf16 v[212:215], a[140:143], a[52:55], v[212:215]
v_mfma_f32_16x16x32_bf16 v[220:223], a[136:139], a[56:59], v[220:223]
ds_read_b128 a[124:127], v3 offset:47104
v_mfma_f32_16x16x32_bf16 v[220:223], a[140:143], a[60:63], v[220:223]
s_waitcnt lgkmcnt(3)
v_mfma_f32_16x16x32_bf16 a[192:195], a[128:131], a[0:3], a[192:195]
ds_read_b64_tr_b16 a[136:137], v11 offset:0
v_mfma_f32_16x16x32_bf16 a[192:195], a[132:135], a[4:7], a[192:195]
v_mfma_f32_16x16x32_bf16 a[200:203], a[128:131], a[8:11], a[200:203]
ds_read_b64_tr_b16 a[138:139], v11 offset:2048
v_mfma_f32_16x16x32_bf16 a[200:203], a[132:135], a[12:15], a[200:203]
v_mfma_f32_16x16x32_bf16 a[208:211], a[128:131], a[16:19], a[208:211]
ds_read_b64_tr_b16 a[140:141], v11 offset:16384
v_mfma_f32_16x16x32_bf16 a[208:211], a[132:135], a[20:23], a[208:211]
v_mfma_f32_16x16x32_bf16 a[216:219], a[128:131], a[24:27], a[216:219]
ds_read_b64_tr_b16 a[142:143], v11 offset:18432
v_mfma_f32_16x16x32_bf16 a[216:219], a[132:135], a[28:31], a[216:219]
buffer_store_dwordx4 a[188:191], v224, s[4:7], s56 offen sc1
v_mfma_f32_16x16x32_bf16 a[224:227], a[128:131], a[32:35], a[224:227]
s_add_u32 s56, s56, 33792
v_mfma_f32_16x16x32_bf16 a[224:227], a[132:135], a[36:39], a[224:227]
v_mfma_f32_16x16x32_bf16 a[232:235], a[128:131], a[40:43], a[232:235]
v_mfma_f32_16x16x32_bf16 a[232:235], a[132:135], a[44:47], a[232:235]
v_mfma_f32_16x16x32_bf16 a[240:243], a[128:131], a[48:51], a[240:243]
v_mfma_f32_16x16x32_bf16 a[240:243], a[132:135], a[52:55], a[240:243]
v_mfma_f32_16x16x32_bf16 a[248:251], a[128:131], a[56:59], a[248:251]
s_waitcnt vmcnt(4) lgkmcnt(0)
v_mfma_f32_16x16x32_bf16 a[248:251], a[132:135], a[60:63], a[248:251]
s_barrier
v_mfma_f32_16x16x32_bf16 a[196:199], a[136:139], a[0:3], a[196:199]
s_add_u32 m0, s29, 65536
ds_read_b64_tr_b16 a[128:129], v4 offset:32768
v_mfma_f32_16x16x32_bf16 a[196:199], a[140:143], a[4:7], a[196:199]
buffer_load_dwordx4 v16, s[12:15], s26 offen offset:0 lds
v_mfma_f32_16x16x32_bf16 a[204:207], a[136:139], a[8:11], a[204:207]
ds_read_b64_tr_b16 a[130:131], v4 offset:34816
v_cmp_gt_u32 vcc, 0x100, v245
v_mfma_f32_16x16x32_bf16 a[204:207], a[140:143], a[12:15], a[204:207]
v_mfma_f32_16x16x32_bf16 a[212:215], a[136:139], a[16:19], a[212:215]
ds_read_b64_tr_b16 a[132:133], v4 offset:49152
v_mfma_f32_16x16x32_bf16 a[212:215], a[140:143], a[20:23], a[212:215]
buffer_load_dwordx4 v17, s[12:15], s26 offen offset:1024 lds
v_mfma_f32_16x16x32_bf16 a[220:223], a[136:139], a[24:27], a[220:223]
ds_read_b64_tr_b16 a[134:135], v4 offset:51200
v_mfma_f32_16x16x32_bf16 a[220:223], a[140:143], a[28:31], a[220:223]
v_mfma_f32_16x16x32_bf16 a[228:231], a[136:139], a[32:35], a[228:231]
v_mfma_f32_16x16x32_bf16 a[228:231], a[140:143], a[36:39], a[228:231]
buffer_load_dwordx4 v18, s[12:15], s26 offen offset:2048 lds
v_mfma_f32_16x16x32_bf16 a[236:239], a[136:139], a[40:43], a[236:239]
v_mfma_f32_16x16x32_bf16 a[236:239], a[140:143], a[44:47], a[236:239]
v_mfma_f32_16x16x32_bf16 a[244:247], a[136:139], a[48:51], a[244:247]
v_mfma_f32_16x16x32_bf16 a[244:247], a[140:143], a[52:55], a[244:247]
buffer_load_dwordx4 v19, s[12:15], s26 offen offset:3072 lds
v_mfma_f32_16x16x32_bf16 a[252:255], a[136:139], a[56:59], a[252:255]
s_add_u32 s26, s26, 524288
v_mfma_f32_16x16x32_bf16 a[252:255], a[140:143], a[60:63], a[252:255]
s_waitcnt lgkmcnt(0)
s_mov_b32 s82, s59
s_cbranch_vccnz M_cntspinK
s_branch Lg_1
Lg_1t:
PAD_4:
s_cbranch_execz M_tret
buffer_load_dword v230, v231, s[4:7], s52 offen sc1
v_mfma_f32_16x16x32_bf16 v[32:35], a[128:131], a[64:67], v[32:35]
s_add_u32 m0, s29, 81920
ds_read_b64_tr_b16 a[136:137], v5 offset:32768
v_mfma_f32_16x16x32_bf16 v[32:35], a[132:135], a[68:71], v[32:35]
buffer_load_dwordx4 v16, s[12:15], s27 offen offset:0 lds
v_mfma_f32_16x16x32_bf16 v[40:43], a[128:131], a[72:75], v[40:43]
s_and_b32 s44, s3, 1
ds_read_b64_tr_b16 a[138:139], v5 offset:34816
v_mfma_f32_16x16x32_bf16 v[40:43], a[132:135], a[76:79], v[40:43]
s_lshl_b32 s44, s44, 8
v_mfma_f32_16x16x32_bf16 v[48:51], a[128:131], a[80:83], v[48:51]
s_lshl_b32 s45, s3, 7
ds_read_b64_tr_b16 a[140:141], v5 offset:49152
v_mfma_f32_16x16x32_bf16 v[48:51], a[132:135], a[84:87], v[48:51]
s_xor_b32 s44, s44, s45
buffer_load_dwordx4 v17, s[12:15], s27 offen offset:1024 lds
v_mfma_f32_16x16x32_bf16 v[56:59], a[128:131], a[88:91], v[56:59]
s_xor_b32 s44, s44, 196608
ds_read_b64_tr_b16 a[142:143], v5 offset:51200
v_mfma_f32_16x16x32_bf16 v[56:59], a[132:135], a[92:95], v[56:59]
v_mfma_f32_16x16x32_bf16 v[64:67], a[128:131], a[96:99], v[64:67]
ds_read_b128 a[0:3], v2 offset:0
v_mfma_f32_16x16x32_bf16 v[64:67], a[132:135], a[100:103], v[64:67]
buffer_load_dwordx4 v18, s[12:15], s27 offen offset:2048 lds
v_mfma_f32_16x16x32_bf16 v[72:75], a[128:131], a[104:107], v[72:75]
ds_read_b128 a[4:7], v3 offset:0
v_mfma_f32_16x16x32_bf16 v[72:75], a[132:135], a[108:111], v[72:75]
v_mfma_f32_16x16x32_bf16 v[80:83], a[128:131], a[112:115], v[80:83]
v_mfma_f32_16x16x32_bf16 v[80:83], a[132:135], a[116:119], v[80:83]
buffer_load_dwordx4 v19, s[12:15], s27 offen offset:3072 lds
v_mfma_f32_16x16x32_bf16 v[88:91], a[128:131], a[120:123], v[88:91]
s_add_u32 s27, s27, 524288
ds_read_b128 a[8:11], v2 offset:2048
v_mfma_f32_16x16x32_bf16 v[88:91], a[132:135], a[124:127], v[88:91]
s_waitcnt lgkmcnt(3)
v_mfma_f32_16x16x32_bf16 v[36:39], a[136:139], a[64:67], v[36:39]
s_add_u32 m0, s28, 32768
ds_read_b64_tr_b16 a[128:129], v6 offset:32768
v_mfma_f32_16x16x32_bf16 v[36:39], a[140:143], a[68:71], v[36:39]
buffer_load_dwordx4 v12, s[8:11], s24 offen offset:0 lds
v_mfma_f32_16x16x32_bf16 v[44:47], a[136:139], a[72:75], v[44:47]
ds_read_b64_tr_b16 a[130:131], v6 offset:34816
v_mfma_f32_16x16x32_bf16 v[44:47], a[140:143], a[76:79], v[44:47]
v_mfma_f32_16x16x32_bf16 v[52:55], a[136:139], a[80:83], v[52:55]
s_mov_b64 s[56:57], s[72:73]
ds_read_b64_tr_b16 a[132:133], v6 offset:49152
v_mfma_f32_16x16x32_bf16 v[52:55], a[140:143], a[84:87], v[52:55]
s_mov_b32 s58, 1835008
buffer_load_dwordx4 v13, s[8:11], s24 offen offset:1024 lds
v_mfma_f32_16x16x32_bf16 v[60:63], a[136:139], a[88:91], v[60:63]
s_mov_b32 s59, 0x20000
ds_read_b64_tr_b16 a[134:135], v6 offset:51200
v_mfma_f32_16x16x32_bf16 v[60:63], a[140:143], a[92:95], v[60:63]
v_mfma_f32_16x16x32_bf16 v[68:71], a[136:139], a[96:99], v[68:71]
ds_read_b128 a[12:15], v3 offset:2048
v_mfma_f32_16x16x32_bf16 v[68:71], a[140:143], a[100:103], v[68:71]
buffer_load_dwordx4 v14, s[8:11], s24 offen offset:2048 lds
v_mfma_f32_16x16x32_bf16 v[76:79], a[136:139], a[104:107], v[76:79]
v_mfma_f32_16x16x32_bf16 v[76:79], a[140:143], a[108:111], v[76:79]
v_mfma_f32_16x16x32_bf16 v[84:87], a[136:139], a[112:115], v[84:87]
ds_read_b128 a[16:19], v2 offset:4096
v_mfma_f32_16x16x32_bf16 v[84:87], a[140:143], a[116:119], v[84:87]
buffer_load_dwordx4 v15, s[8:11], s24 offen offset:3072 lds
v_mfma_f32_16x16x32_bf16 v[92:95], a[136:139], a[120:123], v[92:95]
s_add_u32 s24, s24, 128
ds_read_b128 a[20:23], v3 offset:4096
v_mfma_f32_16x16x32_bf16 v[92:95], a[140:143], a[124:127], v[92:95]
s_waitcnt lgkmcnt(3)
v_mfma_f32_16x16x32_bf16 v[96:99], a[128:131], a[64:67], v[96:99]
s_add_u32 m0, s28, 36864
ds_read_b64_tr_b16 a[136:137], v7 offset:32768
v_mfma_f32_16x16x32_bf16 v[96:99], a[132:135], a[68:71], v[96:99]
buffer_load_dwordx4 v12, s[8:11], s25 offen offset:0 lds
v_mfma_f32_16x16x32_bf16 v[104:107], a[128:131], a[72:75], v[104:107]
ds_read_b64_tr_b16 a[138:139], v7 offset:34816
v_mfma_f32_16x16x32_bf16 v[104:107], a[132:135], a[76:79], v[104:107]
v_mfma_f32_16x16x32_bf16 v[112:115], a[128:131], a[80:83], v[112:115]
ds_read_b64_tr_b16 a[140:141], v7 offset:49152
v_mfma_f32_16x16x32_bf16 v[112:115], a[132:135], a[84:87], v[112:115]
buffer_load_dwordx4 v13, s[8:11], s25 offen offset:1024 lds
v_mfma_f32_16x16x32_bf16 v[120:123], a[128:131], a[88:91], v[120:123]
ds_read_b64_tr_b16 a[142:143], v7 offset:51200
v_mfma_f32_16x16x32_bf16 v[120:123], a[132:135], a[92:95], v[120:123]
v_mfma_f32_16x16x32_bf16 v[128:131], a[128:131], a[96:99], v[128:131]
v_mfma_f32_16x16x32_bf16 v[128:131], a[132:135], a[100:103], v[128:131]
buffer_load_dwordx4 v14, s[8:11], s25 offen offset:2048 lds
v_mfma_f32_16x16x32_bf16 v[136:139], a[128:131], a[104:107], v[136:139]
ds_read_b128 a[24:27], v2 offset:6144
v_mfma_f32_16x16x32_bf16 v[136:139], a[132:135], a[108:111], v[136:139]
v_mfma_f32_16x16x32_bf16 v[144:147], a[128:131], a[112:115], v[144:147]
ds_read_b128 a[28:31], v3 offset:6144
v_mfma_f32_16x16x32_bf16 v[144:147], a[132:135], a[116:119], v[144:147]
buffer_load_dwordx4 v15, s[8:11], s25 offen offset:3072 lds
v_mfma_f32_16x16x32_bf16 v[152:155], a[128:131], a[120:123], v[152:155]
s_add_u32 s25, s25, 128
s_waitcnt vmcnt(12)
v_mfma_f32_16x16x32_bf16 v[152:155], a[132:135], a[124:127], v[152:155]
s_waitcnt lgkmcnt(2)
v_cmp_gt_u32 vcc, 1, v230
v_mfma_f32_16x16x32_bf16 v[100:103], a[136:139], a[64:67], v[100:103]
s_cbranch_vccnz M_ppspinK
M_ppokK:
ds_read_b64_tr_b16 a[128:129], v8 offset:32768
v_mfma_f32_16x16x32_bf16 v[100:103], a[140:143], a[68:71], v[100:103]
buffer_load_dword v230, v229, s[4:7], s53 offen sc1
v_mfma_f32_16x16x32_bf16 v[108:111], a[136:139], a[72:75], v[108:111]
s_mov_b64 s[8:9], s[76:77]
ds_read_b64_tr_b16 a[130:131], v8 offset:34816
v_mfma_f32_16x16x32_bf16 v[108:111], a[140:143], a[76:79], v[108:111]
s_mov_b32 s10, 1835008
buffer_load_dword v230, v229, s[4:7], s48 offen sc1
v_mfma_f32_16x16x32_bf16 v[116:119], a[136:139], a[80:83], v[116:119]
s_lshl_b32 s24, s37, 2
ds_read_b64_tr_b16 a[132:133], v8 offset:49152
v_mfma_f32_16x16x32_bf16 v[116:119], a[140:143], a[84:87], v[116:119]
s_add_u32 s24, s24, s3
buffer_load_dword v230, v229, s[56:59], s49 offen
v_mfma_f32_16x16x32_bf16 v[124:127], a[136:139], a[88:91], v[124:127]
s_mul_i32 s24, s24, 28672
ds_read_b64_tr_b16 a[134:135], v8 offset:51200
v_mfma_f32_16x16x32_bf16 v[124:127], a[140:143], a[92:95], v[124:127]
s_mov_b32 s28, s29
buffer_load_dword v21, v20, s[16:19], s43 offen
v_mfma_f32_16x16x32_bf16 v[132:135], a[136:139], a[96:99], v[132:135]
ds_read_b128 a[32:35], v2 offset:8192
v_mfma_f32_16x16x32_bf16 v[132:135], a[140:143], a[100:103], v[132:135]
v_mfma_f32_16x16x32_bf16 v[140:143], a[136:139], a[104:107], v[140:143]
v_mfma_f32_16x16x32_bf16 v[140:143], a[140:143], a[108:111], v[140:143]
v_mfma_f32_16x16x32_bf16 v[148:151], a[136:139], a[112:115], v[148:151]
ds_read_b128 a[36:39], v3 offset:8192
v_lshrrev_b32 v28, 7, v1
v_mfma_f32_16x16x32_bf16 v[148:151], a[140:143], a[116:119], v[148:151]
v_lshrrev_b32 v29, 1, v28
v_lshlrev_b32 v29, 4, v29
v_mfma_f32_16x16x32_bf16 v[156:159], a[136:139], a[120:123], v[156:159]
ds_read_b128 a[40:43], v2 offset:10240
v_and_b32 v30, 0x70, v1
v_mfma_f32_16x16x32_bf16 v[156:159], a[140:143], a[124:127], v[156:159]
s_waitcnt lgkmcnt(3)
v_xor_b32 v29, v29, v30
v_mul_u32_u24 v28, 896, v28
v_mfma_f32_16x16x32_bf16 v[160:163], a[128:131], a[64:67], v[160:163]
ds_read_b64_tr_b16 a[136:137], v9 offset:32768
v_add_u32 v12, v28, v29
v_mfma_f32_16x16x32_bf16 v[160:163], a[132:135], a[68:71], v[160:163]
v_xor_b32 v29, 64, v29
v_add_u32 v28, v28, v29
v_mfma_f32_16x16x32_bf16 v[168:171], a[128:131], a[72:75], v[168:171]
ds_read_b64_tr_b16 a[138:139], v9 offset:34816
v_add_u32 v13, 6144, v28
v_mfma_f32_16x16x32_bf16 v[168:171], a[132:135], a[76:79], v[168:171]
v_add_u32 v14, 12288, v12
v_add_u32 v15, 18432, v28
v_mfma_f32_16x16x32_bf16 v[176:179], a[128:131], a[80:83], v[176:179]
ds_read_b64_tr_b16 a[140:141], v9 offset:49152
v_xor_b32 v22, s44, v4
v_mfma_f32_16x16x32_bf16 v[176:179], a[132:135], a[84:87], v[176:179]
v_xor_b32 v23, 32, v22
v_xor_b32 v24, 64, v22
v_mfma_f32_16x16x32_bf16 v[184:187], a[128:131], a[88:91], v[184:187]
ds_read_b64_tr_b16 a[142:143], v9 offset:51200
v_xor_b32 v25, 96, v22
v_mfma_f32_16x16x32_bf16 v[184:187], a[132:135], a[92:95], v[184:187]
v_mfma_f32_16x16x32_bf16 v[192:195], a[128:131], a[96:99], v[192:195]
v_mfma_f32_16x16x32_bf16 v[192:195], a[132:135], a[100:103], v[192:195]
v_mfma_f32_16x16x32_bf16 v[200:203], a[128:131], a[104:107], v[200:203]
ds_read_b128 a[44:47], v3 offset:10240
v_mfma_f32_16x16x32_bf16 v[200:203], a[132:135], a[108:111], v[200:203]
v_mfma_f32_16x16x32_bf16 v[208:211], a[128:131], a[112:115], v[208:211]
ds_read_b128 a[48:51], v2 offset:12288
v_mfma_f32_16x16x32_bf16 v[208:211], a[132:135], a[116:119], v[208:211]
v_mfma_f32_16x16x32_bf16 v[216:219], a[128:131], a[120:123], v[216:219]
v_mfma_f32_16x16x32_bf16 v[216:219], a[132:135], a[124:127], v[216:219]
s_waitcnt lgkmcnt(2)
v_mfma_f32_16x16x32_bf16 v[164:167], a[136:139], a[64:67], v[164:167]
ds_read_b64_tr_b16 a[128:129], v10 offset:32768
v_mfma_f32_16x16x32_bf16 v[164:167], a[140:143], a[68:71], v[164:167]
v_mfma_f32_16x16x32_bf16 v[172:175], a[136:139], a[72:75], v[172:175]
ds_read_b64_tr_b16 a[130:131], v10 offset:34816
v_mfma_f32_16x16x32_bf16 v[172:175], a[140:143], a[76:79], v[172:175]
v_mfma_f32_16x16x32_bf16 v[180:183], a[136:139], a[80:83], v[180:183]
ds_read_b64_tr_b16 a[132:133], v10 offset:49152
v_mfma_f32_16x16x32_bf16 v[180:183], a[140:143], a[84:87], v[180:183]
v_mfma_f32_16x16x32_bf16 v[188:191], a[136:139], a[88:91], v[188:191]
ds_read_b64_tr_b16 a[134:135], v10 offset:51200
v_mfma_f32_16x16x32_bf16 v[188:191], a[140:143], a[92:95], v[188:191]
v_mfma_f32_16x16x32_bf16 v[196:199], a[136:139], a[96:99], v[196:199]
ds_read_b128 a[52:55], v3 offset:12288
v_mfma_f32_16x16x32_bf16 v[196:199], a[140:143], a[100:103], v[196:199]
v_mfma_f32_16x16x32_bf16 v[204:207], a[136:139], a[104:107], v[204:207]
ds_read_b128 a[56:59], v2 offset:14336
v_mfma_f32_16x16x32_bf16 v[204:207], a[140:143], a[108:111], v[204:207]
v_mfma_f32_16x16x32_bf16 v[212:215], a[136:139], a[112:115], v[212:215]
v_mfma_f32_16x16x32_bf16 v[212:215], a[140:143], a[116:119], v[212:215]
v_mfma_f32_16x16x32_bf16 v[220:223], a[136:139], a[120:123], v[220:223]
ds_read_b128 a[60:63], v3 offset:14336
v_mfma_f32_16x16x32_bf16 v[220:223], a[140:143], a[124:127], v[220:223]
s_waitcnt lgkmcnt(3)
v_mfma_f32_16x16x32_bf16 a[192:195], a[128:131], a[64:67], a[192:195]
ds_read_b64_tr_b16 a[136:137], v11 offset:32768
v_mfma_f32_16x16x32_bf16 a[192:195], a[132:135], a[68:71], a[192:195]
v_mfma_f32_16x16x32_bf16 a[200:203], a[128:131], a[72:75], a[200:203]
ds_read_b64_tr_b16 a[138:139], v11 offset:34816
v_mfma_f32_16x16x32_bf16 a[200:203], a[132:135], a[76:79], a[200:203]
v_mfma_f32_16x16x32_bf16 a[208:211], a[128:131], a[80:83], a[208:211]
ds_read_b64_tr_b16 a[140:141], v11 offset:49152
v_mfma_f32_16x16x32_bf16 a[208:211], a[132:135], a[84:87], a[208:211]
v_mfma_f32_16x16x32_bf16 a[216:219], a[128:131], a[88:91], a[216:219]
ds_read_b64_tr_b16 a[142:143], v11 offset:51200
v_mfma_f32_16x16x32_bf16 a[216:219], a[132:135], a[92:95], a[216:219]
v_mfma_f32_16x16x32_bf16 a[224:227], a[128:131], a[96:99], a[224:227]
v_mfma_f32_16x16x32_bf16 a[224:227], a[132:135], a[100:103], a[224:227]
v_mfma_f32_16x16x32_bf16 a[232:235], a[128:131], a[104:107], a[232:235]
v_mfma_f32_16x16x32_bf16 a[232:235], a[132:135], a[108:111], a[232:235]
v_mfma_f32_16x16x32_bf16 a[240:243], a[128:131], a[112:115], a[240:243]
v_mfma_f32_16x16x32_bf16 a[240:243], a[132:135], a[116:119], a[240:243]
v_mfma_f32_16x16x32_bf16 a[248:251], a[128:131], a[120:123], a[248:251]
s_waitcnt vmcnt(4) lgkmcnt(0)
v_mfma_f32_16x16x32_bf16 a[248:251], a[132:135], a[124:127], a[248:251]
s_barrier
v_mfma_f32_16x16x32_bf16 a[196:199], a[136:139], a[64:67], a[196:199]
s_add_u32 m0, s29, 98304
ds_read_b64_tr_b16 a[128:129], v4 offset:0
v_mfma_f32_16x16x32_bf16 a[196:199], a[140:143], a[68:71], a[196:199]
buffer_load_dwordx4 v16, s[12:15], s26 offen offset:0 lds
v_mfma_f32_16x16x32_bf16 a[204:207], a[136:139], a[72:75], a[204:207]
ds_read_b64_tr_b16 a[130:131], v4 offset:2048
v_mfma_f32_16x16x32_bf16 a[204:207], a[140:143], a[76:79], a[204:207]
v_mfma_f32_16x16x32_bf16 a[212:215], a[136:139], a[80:83], a[212:215]
ds_read_b64_tr_b16 a[132:133], v4 offset:16384
v_mfma_f32_16x16x32_bf16 a[212:215], a[140:143], a[84:87], a[212:215]
buffer_load_dwordx4 v17, s[12:15], s26 offen offset:1024 lds
v_mfma_f32_16x16x32_bf16 a[220:223], a[136:139], a[88:91], a[220:223]
ds_read_b64_tr_b16 a[134:135], v4 offset:18432
v_mfma_f32_16x16x32_bf16 a[220:223], a[140:143], a[92:95], a[220:223]
v_mfma_f32_16x16x32_bf16 a[228:231], a[136:139], a[96:99], a[228:231]
v_mfma_f32_16x16x32_bf16 a[228:231], a[140:143], a[100:103], a[228:231]
buffer_load_dwordx4 v18, s[12:15], s26 offen offset:2048 lds
v_mfma_f32_16x16x32_bf16 a[236:239], a[136:139], a[104:107], a[236:239]
v_mfma_f32_16x16x32_bf16 a[236:239], a[140:143], a[108:111], a[236:239]
v_mfma_f32_16x16x32_bf16 a[244:247], a[136:139], a[112:115], a[244:247]
v_mfma_f32_16x16x32_bf16 a[244:247], a[140:143], a[116:119], a[244:247]
buffer_load_dwordx4 v19, s[12:15], s26 offen offset:3072 lds
v_mfma_f32_16x16x32_bf16 a[252:255], a[136:139], a[120:123], a[252:255]
s_add_u32 s26, s26, 524288
v_mfma_f32_16x16x32_bf16 a[252:255], a[140:143], a[124:127], a[252:255]
s_waitcnt lgkmcnt(0)
v_mfma_f32_16x16x32_bf16 v[32:35], a[128:131], a[0:3], v[32:35]
s_add_u32 m0, s29, 114688
ds_read_b64_tr_b16 a[136:137], v5 offset:0
v_mfma_f32_16x16x32_bf16 v[32:35], a[132:135], a[4:7], v[32:35]
buffer_load_dwordx4 v16, s[12:15], s27 offen offset:0 lds
v_mfma_f32_16x16x32_bf16 v[40:43], a[128:131], a[8:11], v[40:43]
ds_read_b64_tr_b16 a[138:139], v5 offset:2048
v_mfma_f32_16x16x32_bf16 v[40:43], a[132:135], a[12:15], v[40:43]
v_mfma_f32_16x16x32_bf16 v[48:51], a[128:131], a[16:19], v[48:51]
ds_read_b64_tr_b16 a[140:141], v5 offset:16384
v_mfma_f32_16x16x32_bf16 v[48:51], a[132:135], a[20:23], v[48:51]
buffer_load_dwordx4 v17, s[12:15], s27 offen offset:1024 lds
v_mfma_f32_16x16x32_bf16 v[56:59], a[128:131], a[24:27], v[56:59]
ds_read_b64_tr_b16 a[142:143], v5 offset:18432
v_mfma_f32_16x16x32_bf16 v[56:59], a[132:135], a[28:31], v[56:59]
v_mfma_f32_16x16x32_bf16 v[64:67], a[128:131], a[32:35], v[64:67]
ds_read_b128 a[64:67], v2 offset:32768
v_mfma_f32_16x16x32_bf16 v[64:67], a[132:135], a[36:39], v[64:67]
buffer_load_dwordx4 v18, s[12:15], s27 offen offset:2048 lds
v_mfma_f32_16x16x32_bf16 v[72:75], a[128:131], a[40:43], v[72:75]
ds_read_b128 a[68:71], v3 offset:32768
v_mfma_f32_16x16x32_bf16 v[72:75], a[132:135], a[44:47], v[72:75]
v_mfma_f32_16x16x32_bf16 v[80:83], a[128:131], a[48:51], v[80:83]
v_mfma_f32_16x16x32_bf16 v[80:83], a[132:135], a[52:55], v[80:83]
buffer_load_dwordx4 v19, s[12:15], s27 offen offset:3072 lds
v_mfma_f32_16x16x32_bf16 v[88:91], a[128:131], a[56:59], v[88:91]
s_add_u32 s27, s27, 524288
ds_read_b128 a[72:75], v2 offset:34816
v_mfma_f32_16x16x32_bf16 v[88:91], a[132:135], a[60:63], v[88:91]
s_waitcnt lgkmcnt(3)
v_mfma_f32_16x16x32_bf16 v[36:39], a[136:139], a[0:3], v[36:39]
s_add_u32 m0, s28, 0
ds_read_b64_tr_b16 a[128:129], v6 offset:0
v_mfma_f32_16x16x32_bf16 v[36:39], a[140:143], a[4:7], v[36:39]
buffer_load_dwordx4 v12, s[8:11], s24 offen offset:0 lds
v_mfma_f32_16x16x32_bf16 v[44:47], a[136:139], a[8:11], v[44:47]
ds_read_b64_tr_b16 a[130:131], v6 offset:2048
v_mfma_f32_16x16x32_bf16 v[44:47], a[140:143], a[12:15], v[44:47]
v_mfma_f32_16x16x32_bf16 v[52:55], a[136:139], a[16:19], v[52:55]
ds_read_b64_tr_b16 a[132:133], v6 offset:16384
v_mfma_f32_16x16x32_bf16 v[52:55], a[140:143], a[20:23], v[52:55]
buffer_load_dwordx4 v13, s[8:11], s24 offen offset:1024 lds
v_mfma_f32_16x16x32_bf16 v[60:63], a[136:139], a[24:27], v[60:63]
ds_read_b64_tr_b16 a[134:135], v6 offset:18432
v_mfma_f32_16x16x32_bf16 v[60:63], a[140:143], a[28:31], v[60:63]
v_mfma_f32_16x16x32_bf16 v[68:71], a[136:139], a[32:35], v[68:71]
ds_read_b128 a[76:79], v3 offset:34816
v_mfma_f32_16x16x32_bf16 v[68:71], a[140:143], a[36:39], v[68:71]
buffer_load_dwordx4 v14, s[8:11], s24 offen offset:2048 lds
v_mfma_f32_16x16x32_bf16 v[76:79], a[136:139], a[40:43], v[76:79]
v_mfma_f32_16x16x32_bf16 v[76:79], a[140:143], a[44:47], v[76:79]
v_mfma_f32_16x16x32_bf16 v[84:87], a[136:139], a[48:51], v[84:87]
ds_read_b128 a[80:83], v2 offset:36864
v_mfma_f32_16x16x32_bf16 v[84:87], a[140:143], a[52:55], v[84:87]
buffer_load_dwordx4 v15, s[8:11], s24 offen offset:3072 lds
v_mfma_f32_16x16x32_bf16 v[92:95], a[136:139], a[56:59], v[92:95]
s_add_u32 s24, s24, 128
ds_read_b128 a[84:87], v3 offset:36864
v_mfma_f32_16x16x32_bf16 v[92:95], a[140:143], a[60:63], v[92:95]
s_waitcnt lgkmcnt(3)
s_mov_b64 s[12:13], s[80:81]
v_mfma_f32_16x16x32_bf16 v[96:99], a[128:131], a[0:3], v[96:99]
s_mov_b32 s14, 3670016
s_add_u32 m0, s28, 16384
ds_read_b64_tr_b16 a[136:137], v7 offset:0
v_mfma_f32_16x16x32_bf16 v[96:99], a[132:135], a[4:7], v[96:99]
buffer_load_dwordx4 v12, s[8:11], s24 offen offset:0 lds
v_mfma_f32_16x16x32_bf16 v[104:107], a[128:131], a[8:11], v[104:107]
ds_read_b64_tr_b16 a[138:139], v7 offset:2048
v_mfma_f32_16x16x32_bf16 v[104:107], a[132:135], a[12:15], v[104:107]
v_mfma_f32_16x16x32_bf16 v[112:115], a[128:131], a[16:19], v[112:115]
ds_read_b64_tr_b16 a[140:141], v7 offset:16384
v_mfma_f32_16x16x32_bf16 v[112:115], a[132:135], a[20:23], v[112:115]
buffer_load_dwordx4 v13, s[8:11], s24 offen offset:1024 lds
v_mfma_f32_16x16x32_bf16 v[120:123], a[128:131], a[24:27], v[120:123]
ds_read_b64_tr_b16 a[142:143], v7 offset:18432
v_mfma_f32_16x16x32_bf16 v[120:123], a[132:135], a[28:31], v[120:123]
v_mfma_f32_16x16x32_bf16 v[128:131], a[128:131], a[32:35], v[128:131]
v_mfma_f32_16x16x32_bf16 v[128:131], a[132:135], a[36:39], v[128:131]
buffer_load_dwordx4 v14, s[8:11], s24 offen offset:2048 lds
v_mfma_f32_16x16x32_bf16 v[136:139], a[128:131], a[40:43], v[136:139]
ds_read_b128 a[88:91], v2 offset:38912
v_mfma_f32_16x16x32_bf16 v[136:139], a[132:135], a[44:47], v[136:139]
v_mfma_f32_16x16x32_bf16 v[144:147], a[128:131], a[48:51], v[144:147]
ds_read_b128 a[92:95], v3 offset:38912
v_mfma_f32_16x16x32_bf16 v[144:147], a[132:135], a[52:55], v[144:147]
buffer_load_dwordx4 v15, s[8:11], s24 offen offset:3072 lds
v_mfma_f32_16x16x32_bf16 v[152:155], a[128:131], a[56:59], v[152:155]
s_add_u32 s24, s24, 128
v_mfma_f32_16x16x32_bf16 v[152:155], a[132:135], a[60:63], v[152:155]
s_waitcnt lgkmcnt(2)
s_sub_u32 s26, s26, 8388608
v_mfma_f32_16x16x32_bf16 v[100:103], a[136:139], a[0:3], v[100:103]
s_sub_u32 s27, s27, 8388608
s_add_u32 m0, s29, 131072
ds_read_b64_tr_b16 a[128:129], v8 offset:0
v_mfma_f32_16x16x32_bf16 v[100:103], a[140:143], a[4:7], v[100:103]
PAD_5:
s_cbranch_execz M_tret
buffer_load_dwordx4 v16, s[12:15], s26 offen offset:0 lds
v_mfma_f32_16x16x32_bf16 v[108:111], a[136:139], a[8:11], v[108:111]
ds_read_b64_tr_b16 a[130:131], v8 offset:2048
v_mfma_f32_16x16x32_bf16 v[108:111], a[140:143], a[12:15], v[108:111]
v_mfma_f32_16x16x32_bf16 v[116:119], a[136:139], a[16:19], v[116:119]
ds_read_b64_tr_b16 a[132:133], v8 offset:16384
v_mfma_f32_16x16x32_bf16 v[116:119], a[140:143], a[20:23], v[116:119]
buffer_load_dwordx4 v17, s[12:15], s26 offen offset:1024 lds
v_mfma_f32_16x16x32_bf16 v[124:127], a[136:139], a[24:27], v[124:127]
ds_read_b64_tr_b16 a[134:135], v8 offset:18432
v_mfma_f32_16x16x32_bf16 v[124:127], a[140:143], a[28:31], v[124:127]
v_mfma_f32_16x16x32_bf16 v[132:135], a[136:139], a[32:35], v[132:135]
ds_read_b128 a[96:99], v2 offset:40960
v_mfma_f32_16x16x32_bf16 v[132:135], a[140:143], a[36:39], v[132:135]
buffer_load_dwordx4 v18, s[12:15], s26 offen offset:2048 lds
v_mfma_f32_16x16x32_bf16 v[140:143], a[136:139], a[40:43], v[140:143]
v_mfma_f32_16x16x32_bf16 v[140:143], a[140:143], a[44:47], v[140:143]
v_mfma_f32_16x16x32_bf16 v[148:151], a[136:139], a[48:51], v[148:151]
ds_read_b128 a[100:103], v3 offset:40960
v_mfma_f32_16x16x32_bf16 v[148:151], a[140:143], a[52:55], v[148:151]
buffer_load_dwordx4 v19, s[12:15], s26 offen offset:3072 lds
v_mfma_f32_16x16x32_bf16 v[156:159], a[136:139], a[56:59], v[156:159]
s_add_u32 s26, s26, 524288
ds_read_b128 a[104:107], v2 offset:43008
v_mfma_f32_16x16x32_bf16 v[156:159], a[140:143], a[60:63], v[156:159]
s_waitcnt lgkmcnt(3)
v_mfma_f32_16x16x32_bf16 v[160:163], a[128:131], a[0:3], v[160:163]
s_add_u32 m0, s29, 147456
ds_read_b64_tr_b16 a[136:137], v9 offset:0
v_mfma_f32_16x16x32_bf16 v[160:163], a[132:135], a[4:7], v[160:163]
buffer_load_dwordx4 v16, s[12:15], s27 offen offset:0 lds
v_mfma_f32_16x16x32_bf16 v[168:171], a[128:131], a[8:11], v[168:171]
ds_read_b64_tr_b16 a[138:139], v9 offset:2048
v_mfma_f32_16x16x32_bf16 v[168:171], a[132:135], a[12:15], v[168:171]
v_mfma_f32_16x16x32_bf16 v[176:179], a[128:131], a[16:19], v[176:179]
ds_read_b64_tr_b16 a[140:141], v9 offset:16384
v_mfma_f32_16x16x32_bf16 v[176:179], a[132:135], a[20:23], v[176:179]
buffer_load_dwordx4 v17, s[12:15], s27 offen offset:1024 lds
v_mfma_f32_16x16x32_bf16 v[184:187], a[128:131], a[24:27], v[184:187]
ds_read_b64_tr_b16 a[142:143], v9 offset:18432
v_mfma_f32_16x16x32_bf16 v[184:187], a[132:135], a[28:31], v[184:187]
v_mfma_f32_16x16x32_bf16 v[192:195], a[128:131], a[32:35], v[192:195]
v_mfma_f32_16x16x32_bf16 v[192:195], a[132:135], a[36:39], v[192:195]
buffer_load_dwordx4 v18, s[12:15], s27 offen offset:2048 lds
v_mfma_f32_16x16x32_bf16 v[200:203], a[128:131], a[40:43], v[200:203]
ds_read_b128 a[108:111], v3 offset:43008
v_mfma_f32_16x16x32_bf16 v[200:203], a[132:135], a[44:47], v[200:203]
v_mfma_f32_16x16x32_bf16 v[208:211], a[128:131], a[48:51], v[208:211]
ds_read_b128 a[112:115], v2 offset:45056
v_mfma_f32_16x16x32_bf16 v[208:211], a[132:135], a[52:55], v[208:211]
buffer_load_dwordx4 v19, s[12:15], s27 offen offset:3072 lds
v_mfma_f32_16x16x32_bf16 v[216:219], a[128:131], a[56:59], v[216:219]
s_add_u32 s27, s27, 524288
v_mfma_f32_16x16x32_bf16 v[216:219], a[132:135], a[60:63], v[216:219]
s_waitcnt lgkmcnt(2)
v_mfma_f32_16x16x32_bf16 v[164:167], a[136:139], a[0:3], v[164:167]
ds_read_b64_tr_b16 a[128:129], v10 offset:0
v_mfma_f32_16x16x32_bf16 v[164:167], a[140:143], a[4:7], v[164:167]
v_mfma_f32_16x16x32_bf16 v[172:175], a[136:139], a[8:11], v[172:175]
ds_read_b64_tr_b16 a[130:131], v10 offset:2048
v_mfma_f32_16x16x32_bf16 v[172:175], a[140:143], a[12:15], v[172:175]
v_mfma_f32_16x16x32_bf16 v[180:183], a[136:139], a[16:19], v[180:183]
ds_read_b64_tr_b16 a[132:133], v10 offset:16384
v_mfma_f32_16x16x32_bf16 v[180:183], a[140:143], a[20:23], v[180:183]
v_mfma_f32_16x16x32_bf16 v[188:191], a[136:139], a[24:27], v[188:191]
ds_read_b64_tr_b16 a[134:135], v10 offset:18432
v_mfma_f32_16x16x32_bf16 v[188:191], a[140:143], a[28:31], v[188:191]
v_mfma_f32_16x16x32_bf16 v[196:199], a[136:139], a[32:35], v[196:199]
ds_read_b128 a[116:119], v3 offset:45056
v_mfma_f32_16x16x32_bf16 v[196:199], a[140:143], a[36:39], v[196:199]
v_mfma_f32_16x16x32_bf16 v[204:207], a[136:139], a[40:43], v[204:207]
ds_read_b128 a[120:123], v2 offset:47104
v_mfma_f32_16x16x32_bf16 v[204:207], a[140:143], a[44:47], v[204:207]
v_mfma_f32_16x16x32_bf16 v[212:215], a[136:139], a[48:51], v[212:215]
v_mfma_f32_16x16x32_bf16 v[212:215], a[140:143], a[52:55], v[212:215]
v_mfma_f32_16x16x32_bf16 v[220:223], a[136:139], a[56:59], v[220:223]
ds_read_b128 a[124:127], v3 offset:47104
v_mfma_f32_16x16x32_bf16 v[220:223], a[140:143], a[60:63], v[220:223]
s_waitcnt lgkmcnt(3)
v_mfma_f32_16x16x32_bf16 a[192:195], a[128:131], a[0:3], a[192:195]
ds_read_b64_tr_b16 a[136:137], v11 offset:0
v_mfma_f32_16x16x32_bf16 a[192:195], a[132:135], a[4:7], a[192:195]
v_mfma_f32_16x16x32_bf16 a[200:203], a[128:131], a[8:11], a[200:203]
ds_read_b64_tr_b16 a[138:139], v11 offset:2048
v_mfma_f32_16x16x32_bf16 a[200:203], a[132:135], a[12:15], a[200:203]
v_mfma_f32_16x16x32_bf16 a[208:211], a[128:131], a[16:19], a[208:211]
ds_read_b64_tr_b16 a[140:141], v11 offset:16384
v_mfma_f32_16x16x32_bf16 a[208:211], a[132:135], a[20:23], a[208:211]
v_mfma_f32_16x16x32_bf16 a[216:219], a[128:131], a[24:27], a[216:219]
ds_read_b64_tr_b16 a[142:143], v11 offset:18432
v_mfma_f32_16x16x32_bf16 a[216:219], a[132:135], a[28:31], a[216:219]
v_mfma_f32_16x16x32_bf16 a[224:227], a[128:131], a[32:35], a[224:227]
v_mfma_f32_16x16x32_bf16 a[224:227], a[132:135], a[36:39], a[224:227]
v_mfma_f32_16x16x32_bf16 a[232:235], a[128:131], a[40:43], a[232:235]
v_mfma_f32_16x16x32_bf16 a[232:235], a[132:135], a[44:47], a[232:235]
v_mfma_f32_16x16x32_bf16 a[240:243], a[128:131], a[48:51], a[240:243]
v_mfma_f32_16x16x32_bf16 a[240:243], a[132:135], a[52:55], a[240:243]
v_mfma_f32_16x16x32_bf16 a[248:251], a[128:131], a[56:59], a[248:251]
s_waitcnt vmcnt(12) lgkmcnt(0)
v_mfma_f32_16x16x32_bf16 a[248:251], a[132:135], a[60:63], a[248:251]
s_barrier
v_mfma_f32_16x16x32_bf16 a[196:199], a[136:139], a[0:3], a[196:199]
s_add_u32 m0, s28, 32768
ds_read_b64_tr_b16 a[128:129], v4 offset:32768
v_mfma_f32_16x16x32_bf16 a[196:199], a[140:143], a[4:7], a[196:199]
s_lshr_b32 s22, s3, 1
buffer_load_dwordx4 v12, s[8:11], s24 offen offset:0 lds
v_mfma_f32_16x16x32_bf16 a[204:207], a[136:139], a[8:11], a[204:207]
s_lshl_b32 s22, s22, 14
ds_read_b64_tr_b16 a[130:131], v4 offset:34816
v_subrev_u32 v2, s22, v2
v_mfma_f32_16x16x32_bf16 a[204:207], a[140:143], a[12:15], a[204:207]
v_subrev_u32 v3, s22, v3
v_mfma_f32_16x16x32_bf16 a[212:215], a[136:139], a[16:19], a[212:215]
ds_read_b64_tr_b16 a[132:133], v4 offset:49152
v_mfma_f32_16x16x32_bf16 a[212:215], a[140:143], a[20:23], a[212:215]
buffer_load_dwordx4 v13, s[8:11], s24 offen offset:1024 lds
v_mfma_f32_16x16x32_bf16 a[220:223], a[136:139], a[24:27], a[220:223]
ds_read_b64_tr_b16 a[134:135], v4 offset:51200
v_mfma_f32_16x16x32_bf16 a[220:223], a[140:143], a[28:31], a[220:223]
v_mfma_f32_16x16x32_bf16 a[228:231], a[136:139], a[32:35], a[228:231]
v_mfma_f32_16x16x32_bf16 a[228:231], a[140:143], a[36:39], a[228:231]
buffer_load_dwordx4 v14, s[8:11], s24 offen offset:2048 lds
v_mfma_f32_16x16x32_bf16 a[236:239], a[136:139], a[40:43], a[236:239]
v_mfma_f32_16x16x32_bf16 a[236:239], a[140:143], a[44:47], a[236:239]
v_mfma_f32_16x16x32_bf16 a[244:247], a[136:139], a[48:51], a[244:247]
v_mfma_f32_16x16x32_bf16 a[244:247], a[140:143], a[52:55], a[244:247]
buffer_load_dwordx4 v15, s[8:11], s24 offen offset:3072 lds
v_mfma_f32_16x16x32_bf16 a[252:255], a[136:139], a[56:59], a[252:255]
s_add_u32 s24, s24, 128
v_mfma_f32_16x16x32_bf16 a[252:255], a[140:143], a[60:63], a[252:255]
s_waitcnt lgkmcnt(0)
v_mfma_f32_16x16x32_bf16 v[32:35], a[128:131], a[64:67], v[32:35]
s_add_u32 m0, s29, 65536
ds_read_b64_tr_b16 a[136:137], v5 offset:32768
v_mfma_f32_16x16x32_bf16 v[32:35], a[132:135], a[68:71], v[32:35]
buffer_load_dwordx4 v16, s[12:15], s26 offen offset:0 lds
v_mfma_f32_16x16x32_bf16 v[40:43], a[128:131], a[72:75], v[40:43]
ds_read_b64_tr_b16 a[138:139], v5 offset:34816
v_mfma_f32_16x16x32_bf16 v[40:43], a[132:135], a[76:79], v[40:43]
v_mfma_f32_16x16x32_bf16 v[48:51], a[128:131], a[80:83], v[48:51]
ds_read_b64_tr_b16 a[140:141], v5 offset:49152
v_mfma_f32_16x16x32_bf16 v[48:51], a[132:135], a[84:87], v[48:51]
buffer_load_dwordx4 v17, s[12:15], s26 offen offset:1024 lds
v_mfma_f32_16x16x32_bf16 v[56:59], a[128:131], a[88:91], v[56:59]
ds_read_b64_tr_b16 a[142:143], v5 offset:51200
v_mfma_f32_16x16x32_bf16 v[56:59], a[132:135], a[92:95], v[56:59]
v_mfma_f32_16x16x32_bf16 v[64:67], a[128:131], a[96:99], v[64:67]
ds_read_b128 a[0:3], v2 offset:0
v_mfma_f32_16x16x32_bf16 v[64:67], a[132:135], a[100:103], v[64:67]
buffer_load_dwordx4 v18, s[12:15], s26 offen offset:2048 lds
v_mfma_f32_16x16x32_bf16 v[72:75], a[128:131], a[104:107], v[72:75]
ds_read_b128 a[4:7], v3 offset:0
v_mfma_f32_16x16x32_bf16 v[72:75], a[132:135], a[108:111], v[72:75]
v_mfma_f32_16x16x32_bf16 v[80:83], a[128:131], a[112:115], v[80:83]
v_mfma_f32_16x16x32_bf16 v[80:83], a[132:135], a[116:119], v[80:83]
buffer_load_dwordx4 v19, s[12:15], s26 offen offset:3072 lds
v_mfma_f32_16x16x32_bf16 v[88:91], a[128:131], a[120:123], v[88:91]
s_add_u32 s26, s26, 524288
ds_read_b128 a[8:11], v2 offset:2048
v_mfma_f32_16x16x32_bf16 v[88:91], a[132:135], a[124:127], v[88:91]
s_waitcnt lgkmcnt(3)
v_mfma_f32_16x16x32_bf16 v[36:39], a[136:139], a[64:67], v[36:39]
s_add_u32 m0, s29, 81920
ds_read_b64_tr_b16 a[128:129], v6 offset:32768
v_mfma_f32_16x16x32_bf16 v[36:39], a[140:143], a[68:71], v[36:39]
buffer_load_dwordx4 v16, s[12:15], s27 offen offset:0 lds
v_mfma_f32_16x16x32_bf16 v[44:47], a[136:139], a[72:75], v[44:47]
ds_read_b64_tr_b16 a[130:131], v6 offset:34816
v_mfma_f32_16x16x32_bf16 v[44:47], a[140:143], a[76:79], v[44:47]
v_mfma_f32_16x16x32_bf16 v[52:55], a[136:139], a[80:83], v[52:55]
ds_read_b64_tr_b16 a[132:133], v6 offset:49152
v_mfma_f32_16x16x32_bf16 v[52:55], a[140:143], a[84:87], v[52:55]
buffer_load_dwordx4 v17, s[12:15], s27 offen offset:1024 lds
v_mfma_f32_16x16x32_bf16 v[60:63], a[136:139], a[88:91], v[60:63]
ds_read_b64_tr_b16 a[134:135], v6 offset:51200
v_cvt_pk_bf16_f32 v32, v32, v33
v_mfma_f32_16x16x32_bf16 v[60:63], a[140:143], a[92:95], v[60:63]
v_cvt_pk_bf16_f32 v33, v34, v35
v_cvt_pk_bf16_f32 v34, v36, v37
v_mfma_f32_16x16x32_bf16 v[68:71], a[136:139], a[96:99], v[68:71]
ds_read_b128 a[12:15], v3 offset:2048
v_cvt_pk_bf16_f32 v35, v38, v39
v_mfma_f32_16x16x32_bf16 v[68:71], a[140:143], a[100:103], v[68:71]
buffer_load_dwordx4 v18, s[12:15], s27 offen offset:2048 lds
v_mfma_f32_16x16x32_bf16 v[76:79], a[136:139], a[104:107], v[76:79]
v_cvt_pk_bf16_f32 v40, v40, v41
v_cvt_pk_bf16_f32 v41, v42, v43
v_mfma_f32_16x16x32_bf16 v[76:79], a[140:143], a[108:111], v[76:79]
v_cvt_pk_bf16_f32 v42, v44, v45
v_cvt_pk_bf16_f32 v43, v46, v47
v_mfma_f32_16x16x32_bf16 v[84:87], a[136:139], a[112:115], v[84:87]
ds_read_b128 a[16:19], v2 offset:4096
v_cvt_pk_bf16_f32 v48, v48, v49
v_mfma_f32_16x16x32_bf16 v[84:87], a[140:143], a[116:119], v[84:87]
buffer_load_dwordx4 v19, s[12:15], s27 offen offset:3072 lds
v_mfma_f32_16x16x32_bf16 v[92:95], a[136:139], a[120:123], v[92:95]
s_add_u32 s27, s27, 524288
ds_read_b128 a[20:23], v3 offset:4096
v_cvt_pk_bf16_f32 v49, v50, v51
v_mfma_f32_16x16x32_bf16 v[92:95], a[140:143], a[124:127], v[92:95]
s_waitcnt lgkmcnt(3)
v_cvt_pk_bf16_f32 v50, v52, v53
v_cvt_pk_bf16_f32 v51, v54, v55
v_mfma_f32_16x16x32_bf16 v[96:99], a[128:131], a[64:67], v[96:99]
s_add_u32 m0, s28, 49152
ds_read_b64_tr_b16 a[136:137], v7 offset:32768
v_cvt_pk_bf16_f32 v56, v56, v57
v_mfma_f32_16x16x32_bf16 v[96:99], a[132:135], a[68:71], v[96:99]
buffer_load_dwordx4 v12, s[8:11], s24 offen offset:0 lds
v_mfma_f32_16x16x32_bf16 v[104:107], a[128:131], a[72:75], v[104:107]
ds_read_b64_tr_b16 a[138:139], v7 offset:34816
v_cvt_pk_bf16_f32 v57, v58, v59
v_mfma_f32_16x16x32_bf16 v[104:107], a[132:135], a[76:79], v[104:107]
v_cvt_pk_bf16_f32 v58, v60, v61
v_cvt_pk_bf16_f32 v59, v62, v63
v_mfma_f32_16x16x32_bf16 v[112:115], a[128:131], a[80:83], v[112:115]
ds_read_b64_tr_b16 a[140:141], v7 offset:49152
v_cvt_pk_bf16_f32 v64, v64, v65
v_mfma_f32_16x16x32_bf16 v[112:115], a[132:135], a[84:87], v[112:115]
buffer_load_dwordx4 v13, s[8:11], s24 offen offset:1024 lds
v_mfma_f32_16x16x32_bf16 v[120:123], a[128:131], a[88:91], v[120:123]
ds_read_b64_tr_b16 a[142:143], v7 offset:51200
v_cvt_pk_bf16_f32 v65, v66, v67
v_mfma_f32_16x16x32_bf16 v[120:123], a[132:135], a[92:95], v[120:123]
v_cvt_pk_bf16_f32 v66, v68, v69
v_cvt_pk_bf16_f32 v67, v70, v71
v_mfma_f32_16x16x32_bf16 v[128:131], a[128:131], a[96:99], v[128:131]
v_cvt_pk_bf16_f32 v72, v72, v73
v_cvt_pk_bf16_f32 v73, v74, v75
v_mfma_f32_16x16x32_bf16 v[128:131], a[132:135], a[100:103], v[128:131]
buffer_load_dwordx4 v14, s[8:11], s24 offen offset:2048 lds
v_mfma_f32_16x16x32_bf16 v[136:139], a[128:131], a[104:107], v[136:139]
ds_read_b128 a[24:27], v2 offset:6144
v_cvt_pk_bf16_f32 v74, v76, v77
v_mfma_f32_16x16x32_bf16 v[136:139], a[132:135], a[108:111], v[136:139]
buffer_store_dwordx4 v[32:35], v1, s[4:7], s31 offen sc1
v_mfma_f32_16x16x32_bf16 v[144:147], a[128:131], a[112:115], v[144:147]
s_add_u32 s31, s31, s32
ds_read_b128 a[28:31], v3 offset:6144
v_cvt_pk_bf16_f32 v75, v78, v79
v_mfma_f32_16x16x32_bf16 v[144:147], a[132:135], a[116:119], v[144:147]
buffer_load_dwordx4 v15, s[8:11], s24 offen offset:3072 lds
v_mfma_f32_16x16x32_bf16 v[152:155], a[128:131], a[120:123], v[152:155]
s_add_u32 s24, s24, 128
v_cvt_pk_bf16_f32 v80, v80, v81
v_cvt_pk_bf16_f32 v81, v82, v83
v_mfma_f32_16x16x32_bf16 v[152:155], a[132:135], a[124:127], v[152:155]
s_waitcnt lgkmcnt(2)
v_cvt_pk_bf16_f32 v82, v84, v85
v_cvt_pk_bf16_f32 v83, v86, v87
v_mfma_f32_16x16x32_bf16 v[100:103], a[136:139], a[64:67], v[100:103]
ds_read_b64_tr_b16 a[128:129], v8 offset:32768
v_cvt_pk_bf16_f32 v88, v88, v89
v_mfma_f32_16x16x32_bf16 v[100:103], a[140:143], a[68:71], v[100:103]
v_cvt_pk_bf16_f32 v89, v90, v91
v_cvt_pk_bf16_f32 v90, v92, v93
v_mfma_f32_16x16x32_bf16 v[108:111], a[136:139], a[72:75], v[108:111]
ds_read_b64_tr_b16 a[130:131], v8 offset:34816
v_cvt_pk_bf16_f32 v91, v94, v95
v_mfma_f32_16x16x32_bf16 v[108:111], a[140:143], a[76:79], v[108:111]
buffer_store_dwordx4 v[40:43], v1, s[4:7], s31 offen sc1
v_mfma_f32_16x16x32_bf16 v[116:119], a[136:139], a[80:83], v[116:119]
s_add_u32 s31, s31, s33
ds_read_b64_tr_b16 a[132:133], v8 offset:49152
v_mfma_f32_16x16x32_bf16 v[116:119], a[140:143], a[84:87], v[116:119]
v_mfma_f32_16x16x32_bf16 v[124:127], a[136:139], a[88:91], v[124:127]
ds_read_b64_tr_b16 a[134:135], v8 offset:51200
v_cvt_pk_bf16_f32 v96, v96, v97
v_mfma_f32_16x16x32_bf16 v[124:127], a[140:143], a[92:95], v[124:127]
v_cvt_pk_bf16_f32 v97, v98, v99
v_cvt_pk_bf16_f32 v98, v100, v101
v_mfma_f32_16x16x32_bf16 v[132:135], a[136:139], a[96:99], v[132:135]
ds_read_b128 a[32:35], v2 offset:8192
v_cvt_pk_bf16_f32 v99, v102, v103
v_mfma_f32_16x16x32_bf16 v[132:135], a[140:143], a[100:103], v[132:135]
v_cvt_pk_bf16_f32 v104, v104, v105
v_cvt_pk_bf16_f32 v105, v106, v107
v_mfma_f32_16x16x32_bf16 v[140:143], a[136:139], a[104:107], v[140:143]
v_cvt_pk_bf16_f32 v106, v108, v109
v_cvt_pk_bf16_f32 v107, v110, v111
v_mfma_f32_16x16x32_bf16 v[140:143], a[140:143], a[108:111], v[140:143]
v_cvt_pk_bf16_f32 v112, v112, v113
v_cvt_pk_bf16_f32 v113, v114, v115
v_mfma_f32_16x16x32_bf16 v[148:151], a[136:139], a[112:115], v[148:151]
ds_read_b128 a[36:39], v3 offset:8192
v_cvt_pk_bf16_f32 v114, v116, v117
v_mfma_f32_16x16x32_bf16 v[148:151], a[140:143], a[116:119], v[148:151]
v_cvt_pk_bf16_f32 v115, v118, v119
v_cvt_pk_bf16_f32 v120, v120, v121
v_mfma_f32_16x16x32_bf16 v[156:159], a[136:139], a[120:123], v[156:159]
ds_read_b128 a[40:43], v2 offset:10240
v_cvt_pk_bf16_f32 v121, v122, v123
v_mfma_f32_16x16x32_bf16 v[156:159], a[140:143], a[124:127], v[156:159]
s_waitcnt lgkmcnt(3)
buffer_store_dwordx4 v[48:51], v1, s[4:7], s31 offen sc1
v_mfma_f32_16x16x32_bf16 v[160:163], a[128:131], a[64:67], v[160:163]
s_add_u32 s31, s31, s32
ds_read_b64_tr_b16 a[136:137], v9 offset:32768
v_cvt_pk_bf16_f32 v122, v124, v125
v_mfma_f32_16x16x32_bf16 v[160:163], a[132:135], a[68:71], v[160:163]
v_cvt_pk_bf16_f32 v123, v126, v127
v_cvt_pk_bf16_f32 v128, v128, v129
v_mfma_f32_16x16x32_bf16 v[168:171], a[128:131], a[72:75], v[168:171]
ds_read_b64_tr_b16 a[138:139], v9 offset:34816
v_cvt_pk_bf16_f32 v129, v130, v131
v_mfma_f32_16x16x32_bf16 v[168:171], a[132:135], a[76:79], v[168:171]
v_cvt_pk_bf16_f32 v130, v132, v133
v_cvt_pk_bf16_f32 v131, v134, v135
v_mfma_f32_16x16x32_bf16 v[176:179], a[128:131], a[80:83], v[176:179]
ds_read_b64_tr_b16 a[140:141], v9 offset:49152
v_cvt_pk_bf16_f32 v136, v136, v137
v_mfma_f32_16x16x32_bf16 v[176:179], a[132:135], a[84:87], v[176:179]
v_cvt_pk_bf16_f32 v137, v138, v139
v_cvt_pk_bf16_f32 v138, v140, v141
v_mfma_f32_16x16x32_bf16 v[184:187], a[128:131], a[88:91], v[184:187]
ds_read_b64_tr_b16 a[142:143], v9 offset:51200
v_cvt_pk_bf16_f32 v139, v142, v143
v_mfma_f32_16x16x32_bf16 v[184:187], a[132:135], a[92:95], v[184:187]
v_cvt_pk_bf16_f32 v144, v144, v145
v_cvt_pk_bf16_f32 v145, v146, v147
v_mfma_f32_16x16x32_bf16 v[192:195], a[128:131], a[96:99], v[192:195]
buffer_store_dwordx4 v[56:59], v1, s[4:7], s31 offen sc1
v_mfma_f32_16x16x32_bf16 v[192:195], a[132:135], a[100:103], v[192:195]
s_add_u32 s31, s31, s34
v_cvt_pk_bf16_f32 v146, v148, v149
v_cvt_pk_bf16_f32 v147, v150, v151
v_mfma_f32_16x16x32_bf16 v[200:203], a[128:131], a[104:107], v[200:203]
ds_read_b128 a[44:47], v3 offset:10240
v_cvt_pk_bf16_f32 v152, v152, v153
v_mfma_f32_16x16x32_bf16 v[200:203], a[132:135], a[108:111], v[200:203]
v_cvt_pk_bf16_f32 v153, v154, v155
v_cvt_pk_bf16_f32 v154, v156, v157
v_mfma_f32_16x16x32_bf16 v[208:211], a[128:131], a[112:115], v[208:211]
ds_read_b128 a[48:51], v2 offset:12288
v_cvt_pk_bf16_f32 v155, v158, v159
v_mfma_f32_16x16x32_bf16 v[208:211], a[132:135], a[116:119], v[208:211]
v_mfma_f32_16x16x32_bf16 v[216:219], a[128:131], a[120:123], v[216:219]
v_mfma_f32_16x16x32_bf16 v[216:219], a[132:135], a[124:127], v[216:219]
s_waitcnt lgkmcnt(2)
v_mfma_f32_16x16x32_bf16 v[164:167], a[136:139], a[64:67], v[164:167]
ds_read_b64_tr_b16 a[128:129], v10 offset:32768
v_mfma_f32_16x16x32_bf16 v[164:167], a[140:143], a[68:71], v[164:167]
v_mfma_f32_16x16x32_bf16 v[172:175], a[136:139], a[72:75], v[172:175]
ds_read_b64_tr_b16 a[130:131], v10 offset:34816
v_mfma_f32_16x16x32_bf16 v[172:175], a[140:143], a[76:79], v[172:175]
buffer_store_dwordx4 v[64:67], v1, s[4:7], s31 offen sc1
v_mfma_f32_16x16x32_bf16 v[180:183], a[136:139], a[80:83], v[180:183]
s_add_u32 s31, s31, s32
ds_read_b64_tr_b16 a[132:133], v10 offset:49152
v_mfma_f32_16x16x32_bf16 v[180:183], a[140:143], a[84:87], v[180:183]
v_mfma_f32_16x16x32_bf16 v[188:191], a[136:139], a[88:91], v[188:191]
ds_read_b64_tr_b16 a[134:135], v10 offset:51200
v_cvt_pk_bf16_f32 v160, v160, v161
v_mfma_f32_16x16x32_bf16 v[188:191], a[140:143], a[92:95], v[188:191]
v_cvt_pk_bf16_f32 v161, v162, v163
v_cvt_pk_bf16_f32 v162, v164, v165
v_mfma_f32_16x16x32_bf16 v[196:199], a[136:139], a[96:99], v[196:199]
ds_read_b128 a[52:55], v3 offset:12288
v_cvt_pk_bf16_f32 v163, v166, v167
v_mfma_f32_16x16x32_bf16 v[196:199], a[140:143], a[100:103], v[196:199]
v_cvt_pk_bf16_f32 v168, v168, v169
v_cvt_pk_bf16_f32 v169, v170, v171
v_mfma_f32_16x16x32_bf16 v[204:207], a[136:139], a[104:107], v[204:207]
ds_read_b128 a[56:59], v2 offset:14336
v_cvt_pk_bf16_f32 v170, v172, v173
v_mfma_f32_16x16x32_bf16 v[204:207], a[140:143], a[108:111], v[204:207]
v_cvt_pk_bf16_f32 v171, v174, v175
v_cvt_pk_bf16_f32 v176, v176, v177
v_mfma_f32_16x16x32_bf16 v[212:215], a[136:139], a[112:115], v[212:215]
v_cvt_pk_bf16_f32 v177, v178, v179
v_cvt_pk_bf16_f32 v178, v180, v181
v_mfma_f32_16x16x32_bf16 v[212:215], a[140:143], a[116:119], v[212:215]
buffer_store_dwordx4 v[72:75], v1, s[4:7], s31 offen sc1
v_mfma_f32_16x16x32_bf16 v[220:223], a[136:139], a[120:123], v[220:223]
s_add_u32 s31, s31, s33
ds_read_b128 a[60:63], v3 offset:14336
v_cvt_pk_bf16_f32 v179, v182, v183
v_mfma_f32_16x16x32_bf16 v[220:223], a[140:143], a[124:127], v[220:223]
s_waitcnt lgkmcnt(3)
v_cvt_pk_bf16_f32 v184, v184, v185
v_cvt_pk_bf16_f32 v185, v186, v187
v_mfma_f32_16x16x32_bf16 a[192:195], a[128:131], a[64:67], a[192:195]
ds_read_b64_tr_b16 a[136:137], v11 offset:32768
v_cvt_pk_bf16_f32 v186, v188, v189
v_mfma_f32_16x16x32_bf16 a[192:195], a[132:135], a[68:71], a[192:195]
v_cvt_pk_bf16_f32 v187, v190, v191
v_cvt_pk_bf16_f32 v192, v192, v193
v_mfma_f32_16x16x32_bf16 a[200:203], a[128:131], a[72:75], a[200:203]
ds_read_b64_tr_b16 a[138:139], v11 offset:34816
v_cvt_pk_bf16_f32 v193, v194, v195
v_mfma_f32_16x16x32_bf16 a[200:203], a[132:135], a[76:79], a[200:203]
v_cvt_pk_bf16_f32 v194, v196, v197
v_cvt_pk_bf16_f32 v195, v198, v199
v_mfma_f32_16x16x32_bf16 a[208:211], a[128:131], a[80:83], a[208:211]
ds_read_b64_tr_b16 a[140:141], v11 offset:49152
v_cvt_pk_bf16_f32 v200, v200, v201
v_mfma_f32_16x16x32_bf16 a[208:211], a[132:135], a[84:87], a[208:211]
v_cvt_pk_bf16_f32 v201, v202, v203
v_cvt_pk_bf16_f32 v202, v204, v205
v_mfma_f32_16x16x32_bf16 a[216:219], a[128:131], a[88:91], a[216:219]
ds_read_b64_tr_b16 a[142:143], v11 offset:51200
v_cvt_pk_bf16_f32 v203, v206, v207
v_mfma_f32_16x16x32_bf16 a[216:219], a[132:135], a[92:95], a[216:219]
v_cvt_pk_bf16_f32 v208, v208, v209
v_cvt_pk_bf16_f32 v209, v210, v211
v_mfma_f32_16x16x32_bf16 a[224:227], a[128:131], a[96:99], a[224:227]
buffer_store_dwordx4 v[80:83], v1, s[4:7], s31 offen sc1
v_mfma_f32_16x16x32_bf16 a[224:227], a[132:135], a[100:103], a[224:227]
s_add_u32 s31, s31, s32
v_cvt_pk_bf16_f32 v210, v212, v213
v_cvt_pk_bf16_f32 v211, v214, v215
v_mfma_f32_16x16x32_bf16 a[232:235], a[128:131], a[104:107], a[232:235]
v_cvt_pk_bf16_f32 v216, v216, v217
v_cvt_pk_bf16_f32 v217, v218, v219
v_mfma_f32_16x16x32_bf16 a[232:235], a[132:135], a[108:111], a[232:235]
v_cvt_pk_bf16_f32 v218, v220, v221
v_cvt_pk_bf16_f32 v219, v222, v223
v_mfma_f32_16x16x32_bf16 a[240:243], a[128:131], a[112:115], a[240:243]
v_mfma_f32_16x16x32_bf16 a[240:243], a[132:135], a[116:119], a[240:243]
v_mfma_f32_16x16x32_bf16 a[248:251], a[128:131], a[120:123], a[248:251]
s_waitcnt vmcnt(23) lgkmcnt(0)
v_mfma_f32_16x16x32_bf16 a[248:251], a[132:135], a[124:127], a[248:251]
s_barrier
v_mfma_f32_16x16x32_bf16 a[196:199], a[136:139], a[64:67], a[196:199]
s_add_u32 m0, s29, 98304
ds_read_b64_tr_b16 a[128:129], v22 offset:0
v_mfma_f32_16x16x32_bf16 a[196:199], a[140:143], a[68:71], a[196:199]
buffer_load_dwordx4 v16, s[12:15], s26 offen offset:0 lds
v_mfma_f32_16x16x32_bf16 a[204:207], a[136:139], a[72:75], a[204:207]
ds_read_b64_tr_b16 a[130:131], v22 offset:2048
v_mfma_f32_16x16x32_bf16 a[204:207], a[140:143], a[76:79], a[204:207]
buffer_store_dwordx4 v[88:91], v1, s[4:7], s31 offen sc1
v_mfma_f32_16x16x32_bf16 a[212:215], a[136:139], a[80:83], a[212:215]
s_add_u32 s31, s31, s35
ds_read_b64_tr_b16 a[132:133], v22 offset:16384
v_mfma_f32_16x16x32_bf16 a[212:215], a[140:143], a[84:87], a[212:215]
buffer_load_dwordx4 v17, s[12:15], s26 offen offset:1024 lds
v_mfma_f32_16x16x32_bf16 a[220:223], a[136:139], a[88:91], a[220:223]
ds_read_b64_tr_b16 a[134:135], v22 offset:18432
v_add_u32 v22, 4294901760, v22
v_mfma_f32_16x16x32_bf16 a[220:223], a[140:143], a[92:95], a[220:223]
v_mfma_f32_16x16x32_bf16 a[228:231], a[136:139], a[96:99], a[228:231]
v_mfma_f32_16x16x32_bf16 a[228:231], a[140:143], a[100:103], a[228:231]
buffer_load_dwordx4 v18, s[12:15], s26 offen offset:2048 lds
v_mfma_f32_16x16x32_bf16 a[236:239], a[136:139], a[104:107], a[236:239]
v_mfma_f32_16x16x32_bf16 a[236:239], a[140:143], a[108:111], a[236:239]
v_mfma_f32_16x16x32_bf16 a[244:247], a[136:139], a[112:115], a[244:247]
v_mfma_f32_16x16x32_bf16 a[244:247], a[140:143], a[116:119], a[244:247]
buffer_load_dwordx4 v19, s[12:15], s26 offen offset:3072 lds
v_mfma_f32_16x16x32_bf16 a[252:255], a[136:139], a[120:123], a[252:255]
s_add_u32 s26, s26, 524288
v_mfma_f32_16x16x32_bf16 a[252:255], a[140:143], a[124:127], a[252:255]
s_waitcnt lgkmcnt(0)
M_Q:
v_mfma_f32_16x16x32_bf16 v[36:39], a[128:131], a[0:3], 0
s_add_u32 m0, s29, 114688
ds_read_b64_tr_b16 a[136:137], v23 offset:0
v_mfma_f32_16x16x32_bf16 v[36:39], a[132:135], a[4:7], v[36:39]
buffer_load_dwordx4 v16, s[12:15], s27 offen offset:0 lds
v_mfma_f32_16x16x32_bf16 v[44:47], a[128:131], a[8:11], 0
ds_read_b64_tr_b16 a[138:139], v23 offset:2048
v_mfma_f32_16x16x32_bf16 v[44:47], a[132:135], a[12:15], v[44:47]
ds_read_b128 a[64:67], v2 offset:16384
ds_read_b128 a[68:71], v3 offset:16384
v_mfma_f32_16x16x32_bf16 v[52:55], a[128:131], a[16:19], 0
ds_read_b64_tr_b16 a[140:141], v23 offset:16384
v_mfma_f32_16x16x32_bf16 v[52:55], a[132:135], a[20:23], v[52:55]
buffer_load_dwordx4 v17, s[12:15], s27 offen offset:1024 lds
v_mfma_f32_16x16x32_bf16 v[60:63], a[128:131], a[24:27], 0
ds_read_b64_tr_b16 a[142:143], v23 offset:18432
v_add_u32 v23, 4294901760, v23
v_mfma_f32_16x16x32_bf16 v[60:63], a[132:135], a[28:31], v[60:63]
buffer_store_dwordx4 v[96:99], v1, s[4:7], s31 offen sc1
v_mfma_f32_16x16x32_bf16 v[68:71], a[128:131], a[32:35], 0
s_add_u32 s31, s31, s32
ds_read_b128 a[72:75], v2 offset:18432
v_mfma_f32_16x16x32_bf16 v[68:71], a[132:135], a[36:39], v[68:71]
buffer_load_dwordx4 v18, s[12:15], s27 offen offset:2048 lds
v_mfma_f32_16x16x32_bf16 v[76:79], a[128:131], a[40:43], 0
ds_read_b128 a[76:79], v3 offset:18432
v_mfma_f32_16x16x32_bf16 v[76:79], a[132:135], a[44:47], v[76:79]
ds_read_b128 a[80:83], v2 offset:20480
v_mfma_f32_16x16x32_bf16 v[84:87], a[128:131], a[48:51], 0
ds_read_b128 a[84:87], v3 offset:20480
v_mfma_f32_16x16x32_bf16 v[84:87], a[132:135], a[52:55], v[84:87]
buffer_load_dwordx4 v19, s[12:15], s27 offen offset:3072 lds
v_mfma_f32_16x16x32_bf16 v[92:95], a[128:131], a[56:59], 0
s_add_u32 s27, s27, 524288
ds_read_b128 a[88:91], v2 offset:22528
v_mfma_f32_16x16x32_bf16 v[92:95], a[132:135], a[60:63], v[92:95]
s_waitcnt lgkmcnt(5)
buffer_store_dwordx4 v[104:107], v1, s[4:7], s31 offen sc1
v_mfma_f32_16x16x32_bf16 v[100:103], a[136:139], a[0:3], 0
s_add_u32 m0, s28, 0
ds_read_b64_tr_b16 a[128:129], v24 offset:0
v_mfma_f32_16x16x32_bf16 v[100:103], a[140:143], a[4:7], v[100:103]
s_add_u32 s31, s31, s33
buffer_load_dwordx4 v12, s[8:11], s24 offen offset:0 lds
v_mfma_f32_16x16x32_bf16 v[108:111], a[136:139], a[8:11], 0
ds_read_b64_tr_b16 a[130:131], v24 offset:2048
v_mfma_f32_16x16x32_bf16 v[108:111], a[140:143], a[12:15], v[108:111]
ds_read_b128 a[92:95], v3 offset:22528
v_mfma_f32_16x16x32_bf16 v[116:119], a[136:139], a[16:19], 0
ds_read_b64_tr_b16 a[132:133], v24 offset:16384
v_mfma_f32_16x16x32_bf16 v[116:119], a[140:143], a[20:23], v[116:119]
buffer_load_dwordx4 v13, s[8:11], s24 offen offset:1024 lds
v_mfma_f32_16x16x32_bf16 v[124:127], a[136:139], a[24:27], 0
ds_read_b64_tr_b16 a[134:135], v24 offset:18432
v_add_u32 v24, 4294901760, v24
v_mfma_f32_16x16x32_bf16 v[124:127], a[140:143], a[28:31], v[124:127]
v_mfma_f32_16x16x32_bf16 v[132:135], a[136:139], a[32:35], 0
ds_read_b128 a[96:99], v2 offset:24576
v_mfma_f32_16x16x32_bf16 v[132:135], a[140:143], a[36:39], v[132:135]
buffer_load_dwordx4 v14, s[8:11], s24 offen offset:2048 lds
v_mfma_f32_16x16x32_bf16 v[140:143], a[136:139], a[40:43], 0
ds_read_b128 a[100:103], v3 offset:24576
v_mfma_f32_16x16x32_bf16 v[140:143], a[140:143], a[44:47], v[140:143]
ds_read_b128 a[104:107], v2 offset:26624
v_mfma_f32_16x16x32_bf16 v[148:151], a[136:139], a[48:51], 0
ds_read_b128 a[108:111], v3 offset:26624
v_mfma_f32_16x16x32_bf16 v[148:151], a[140:143], a[52:55], v[148:151]
PAD_6:
s_cbranch_execz M_tret
buffer_load_dwordx4 v15, s[8:11], s24 offen offset:3072 lds
v_mfma_f32_16x16x32_bf16 v[156:159], a[136:139], a[56:59], 0
s_add_u32 s24, s24, 128
ds_read_b128 a[112:115], v2 offset:28672
v_mfma_f32_16x16x32_bf16 v[156:159], a[140:143], a[60:63], v[156:159]
s_waitcnt lgkmcnt(5)
buffer_store_dwordx4 v[112:115], v1, s[4:7], s31 offen sc1
v_mfma_f32_16x16x32_bf16 v[164:167], a[128:131], a[0:3], 0
s_add_u32 s31, s31, s32
ds_read_b64_tr_b16 a[136:137], v25 offset:0
v_mfma_f32_16x16x32_bf16 v[164:167], a[132:135], a[4:7], v[164:167]
v_mfma_f32_16x16x32_bf16 v[172:175], a[128:131], a[8:11], 0
ds_read_b64_tr_b16 a[138:139], v25 offset:2048
v_mfma_f32_16x16x32_bf16 v[172:175], a[132:135], a[12:15], v[172:175]
ds_read_b128 a[116:119], v3 offset:28672
v_mfma_f32_16x16x32_bf16 v[180:183], a[128:131], a[16:19], 0
ds_read_b64_tr_b16 a[140:141], v25 offset:16384
v_mfma_f32_16x16x32_bf16 v[180:183], a[132:135], a[20:23], v[180:183]
v_mfma_f32_16x16x32_bf16 v[188:191], a[128:131], a[24:27], 0
ds_read_b64_tr_b16 a[142:143], v25 offset:18432
v_add_u32 v25, 4294901760, v25
v_mfma_f32_16x16x32_bf16 v[188:191], a[132:135], a[28:31], v[188:191]
v_mfma_f32_16x16x32_bf16 v[196:199], a[128:131], a[32:35], 0
ds_read_b128 a[120:123], v2 offset:30720
v_mfma_f32_16x16x32_bf16 v[196:199], a[132:135], a[36:39], v[196:199]
v_mfma_f32_16x16x32_bf16 v[204:207], a[128:131], a[40:43], 0
ds_read_b128 a[124:127], v3 offset:30720
v_mfma_f32_16x16x32_bf16 v[204:207], a[132:135], a[44:47], v[204:207]
v_mfma_f32_16x16x32_bf16 v[212:215], a[128:131], a[48:51], 0
v_mfma_f32_16x16x32_bf16 v[212:215], a[132:135], a[52:55], v[212:215]
buffer_store_dwordx4 v[120:123], v1, s[4:7], s31 offen sc1
v_mfma_f32_16x16x32_bf16 v[220:223], a[128:131], a[56:59], 0
s_add_u32 s31, s31, s34
v_mfma_f32_16x16x32_bf16 v[220:223], a[132:135], a[60:63], v[220:223]
s_waitcnt vmcnt(28) lgkmcnt(0)
s_barrier
v_mfma_f32_16x16x32_bf16 v[224:227], a[136:139], a[0:3], 0
s_add_u32 m0, s29, 131072
ds_read_b64_tr_b16 a[128:129], v22 offset:0
v_mfma_f32_16x16x32_bf16 v[224:227], a[140:143], a[4:7], v[224:227]
buffer_load_dwordx4 v16, s[12:15], s26 offen offset:0 lds
v_mfma_f32_16x16x32_bf16 v[228:231], a[136:139], a[8:11], 0
ds_read_b64_tr_b16 a[130:131], v22 offset:2048
v_mfma_f32_16x16x32_bf16 v[228:231], a[140:143], a[12:15], v[228:231]
v_mfma_f32_16x16x32_bf16 v[232:235], a[136:139], a[16:19], 0
ds_read_b64_tr_b16 a[132:133], v22 offset:16384
v_mfma_f32_16x16x32_bf16 v[232:235], a[140:143], a[20:23], v[232:235]
buffer_load_dwordx4 v17, s[12:15], s26 offen offset:1024 lds
v_mfma_f32_16x16x32_bf16 v[236:239], a[136:139], a[24:27], 0
ds_read_b64_tr_b16 a[134:135], v22 offset:18432
v_add_u32 v22, 32768, v22
v_mfma_f32_16x16x32_bf16 v[236:239], a[140:143], a[28:31], v[236:239]
v_mfma_f32_16x16x32_bf16 v[240:243], a[136:139], a[32:35], 0
v_mfma_f32_16x16x32_bf16 v[240:243], a[140:143], a[36:39], v[240:243]
buffer_load_dwordx4 v18, s[12:15], s26 offen offset:2048 lds
v_mfma_f32_16x16x32_bf16 v[244:247], a[136:139], a[40:43], 0
v_mfma_f32_16x16x32_bf16 v[244:247], a[140:143], a[44:47], v[244:247]
v_mfma_f32_16x16x32_bf16 v[248:251], a[136:139], a[48:51], 0
v_mfma_f32_16x16x32_bf16 v[248:251], a[140:143], a[52:55], v[248:251]
buffer_load_dwordx4 v19, s[12:15], s26 offen offset:3072 lds
v_mfma_f32_16x16x32_bf16 v[252:255], a[136:139], a[56:59], 0
s_add_u32 s26, s26, 524288
v_mfma_f32_16x16x32_bf16 v[252:255], a[140:143], a[60:63], v[252:255]
s_waitcnt lgkmcnt(0)
v_mfma_f32_16x16x32_bf16 v[36:39], a[128:131], a[64:67], v[36:39]
s_add_u32 m0, s29, 147456
ds_read_b64_tr_b16 a[136:137], v23 offset:0
v_mfma_f32_16x16x32_bf16 v[36:39], a[132:135], a[68:71], v[36:39]
buffer_load_dwordx4 v16, s[12:15], s27 offen offset:0 lds
v_mfma_f32_16x16x32_bf16 v[44:47], a[128:131], a[72:75], v[44:47]
ds_read_b64_tr_b16 a[138:139], v23 offset:2048
v_mfma_f32_16x16x32_bf16 v[44:47], a[132:135], a[76:79], v[44:47]
ds_read_b128 a[0:3], v2 offset:32768
ds_read_b128 a[4:7], v3 offset:32768
v_mfma_f32_16x16x32_bf16 v[52:55], a[128:131], a[80:83], v[52:55]
ds_read_b64_tr_b16 a[140:141], v23 offset:16384
v_mfma_f32_16x16x32_bf16 v[52:55], a[132:135], a[84:87], v[52:55]
buffer_load_dwordx4 v17, s[12:15], s27 offen offset:1024 lds
v_mfma_f32_16x16x32_bf16 v[60:63], a[128:131], a[88:91], v[60:63]
ds_read_b64_tr_b16 a[142:143], v23 offset:18432
v_add_u32 v23, 32768, v23
v_mfma_f32_16x16x32_bf16 v[60:63], a[132:135], a[92:95], v[60:63]
buffer_store_dwordx4 v[128:131], v1, s[4:7], s31 offen sc1
v_mfma_f32_16x16x32_bf16 v[68:71], a[128:131], a[96:99], v[68:71]
s_add_u32 s31, s31, s32
ds_read_b128 a[8:11], v2 offset:34816
v_accvgpr_read_b32 v32, a192
v_mfma_f32_16x16x32_bf16 v[68:71], a[132:135], a[100:103], v[68:71]
buffer_load_dwordx4 v18, s[12:15], s27 offen offset:2048 lds
v_mfma_f32_16x16x32_bf16 v[76:79], a[128:131], a[104:107], v[76:79]
ds_read_b128 a[12:15], v3 offset:34816
v_accvgpr_read_b32 v33, a193
v_mfma_f32_16x16x32_bf16 v[76:79], a[132:135], a[108:111], v[76:79]
ds_read_b128 a[16:19], v2 offset:36864
v_accvgpr_read_b32 v34, a194
v_mfma_f32_16x16x32_bf16 v[84:87], a[128:131], a[112:115], v[84:87]
ds_read_b128 a[20:23], v3 offset:36864
v_accvgpr_read_b32 v35, a195
v_mfma_f32_16x16x32_bf16 v[84:87], a[132:135], a[116:119], v[84:87]
buffer_load_dwordx4 v19, s[12:15], s27 offen offset:3072 lds
v_mfma_f32_16x16x32_bf16 v[92:95], a[128:131], a[120:123], v[92:95]
s_add_u32 s27, s27, 524288
ds_read_b128 a[24:27], v2 offset:38912
v_accvgpr_read_b32 v96, a196
v_mfma_f32_16x16x32_bf16 v[92:95], a[132:135], a[124:127], v[92:95]
s_waitcnt lgkmcnt(5)
buffer_store_dwordx4 v[136:139], v1, s[4:7], s31 offen sc1
v_mfma_f32_16x16x32_bf16 v[100:103], a[136:139], a[64:67], v[100:103]
s_add_u32 m0, s28, 16384
ds_read_b64_tr_b16 a[128:129], v24 offset:0
v_accvgpr_read_b32 v97, a197
v_mfma_f32_16x16x32_bf16 v[100:103], a[140:143], a[68:71], v[100:103]
s_add_u32 s31, s31, s33
buffer_load_dwordx4 v12, s[8:11], s24 offen offset:0 lds
v_mfma_f32_16x16x32_bf16 v[108:111], a[136:139], a[72:75], v[108:111]
ds_read_b64_tr_b16 a[130:131], v24 offset:2048
v_accvgpr_read_b32 v98, a198
v_mfma_f32_16x16x32_bf16 v[108:111], a[140:143], a[76:79], v[108:111]
ds_read_b128 a[28:31], v3 offset:38912
v_accvgpr_read_b32 v99, a199
v_mfma_f32_16x16x32_bf16 v[116:119], a[136:139], a[80:83], v[116:119]
ds_read_b64_tr_b16 a[132:133], v24 offset:16384
v_cvt_pk_bf16_f32 v32, v32, v33
v_mfma_f32_16x16x32_bf16 v[116:119], a[140:143], a[84:87], v[116:119]
buffer_load_dwordx4 v13, s[8:11], s24 offen offset:1024 lds
v_mfma_f32_16x16x32_bf16 v[124:127], a[136:139], a[88:91], v[124:127]
ds_read_b64_tr_b16 a[134:135], v24 offset:18432
v_add_u32 v24, 32768, v24
v_mfma_f32_16x16x32_bf16 v[124:127], a[140:143], a[92:95], v[124:127]
v_cvt_pk_bf16_f32 v33, v34, v35
v_cvt_pk_bf16_f32 v34, v96, v97
v_mfma_f32_16x16x32_bf16 v[132:135], a[136:139], a[96:99], v[132:135]
ds_read_b128 a[32:35], v2 offset:40960
v_cvt_pk_bf16_f32 v35, v98, v99
v_mfma_f32_16x16x32_bf16 v[132:135], a[140:143], a[100:103], v[132:135]
buffer_load_dwordx4 v14, s[8:11], s24 offen offset:2048 lds
v_mfma_f32_16x16x32_bf16 v[140:143], a[136:139], a[104:107], v[140:143]
ds_read_b128 a[36:39], v3 offset:40960
v_accvgpr_read_b32 v40, a200
v_mfma_f32_16x16x32_bf16 v[140:143], a[140:143], a[108:111], v[140:143]
ds_read_b128 a[40:43], v2 offset:43008
v_accvgpr_read_b32 v41, a201
v_mfma_f32_16x16x32_bf16 v[148:151], a[136:139], a[112:115], v[148:151]
ds_read_b128 a[44:47], v3 offset:43008
v_accvgpr_read_b32 v42, a202
v_mfma_f32_16x16x32_bf16 v[148:151], a[140:143], a[116:119], v[148:151]
buffer_load_dwordx4 v15, s[8:11], s24 offen offset:3072 lds
v_mfma_f32_16x16x32_bf16 v[156:159], a[136:139], a[120:123], v[156:159]
s_add_u32 s24, s24, 128
ds_read_b128 a[48:51], v2 offset:45056
v_accvgpr_read_b32 v43, a203
v_mfma_f32_16x16x32_bf16 v[156:159], a[140:143], a[124:127], v[156:159]
s_waitcnt lgkmcnt(5)
buffer_store_dwordx4 v[144:147], v1, s[4:7], s31 offen sc1
v_mfma_f32_16x16x32_bf16 v[164:167], a[128:131], a[64:67], v[164:167]
s_add_u32 s31, s31, s32
ds_read_b64_tr_b16 a[136:137], v25 offset:0
v_accvgpr_read_b32 v96, a204
v_mfma_f32_16x16x32_bf16 v[164:167], a[132:135], a[68:71], v[164:167]
v_accvgpr_read_b32 v97, a205
v_accvgpr_read_b32 v98, a206
v_mfma_f32_16x16x32_bf16 v[172:175], a[128:131], a[72:75], v[172:175]
ds_read_b64_tr_b16 a[138:139], v25 offset:2048
v_accvgpr_read_b32 v99, a207
v_mfma_f32_16x16x32_bf16 v[172:175], a[132:135], a[76:79], v[172:175]
ds_read_b128 a[52:55], v3 offset:45056
v_cvt_pk_bf16_f32 v40, v40, v41
v_mfma_f32_16x16x32_bf16 v[180:183], a[128:131], a[80:83], v[180:183]
ds_read_b64_tr_b16 a[140:141], v25 offset:16384
v_cvt_pk_bf16_f32 v41, v42, v43
v_mfma_f32_16x16x32_bf16 v[180:183], a[132:135], a[84:87], v[180:183]
v_cvt_pk_bf16_f32 v42, v96, v97
v_cvt_pk_bf16_f32 v43, v98, v99
v_mfma_f32_16x16x32_bf16 v[188:191], a[128:131], a[88:91], v[188:191]
ds_read_b64_tr_b16 a[142:143], v25 offset:18432
v_add_u32 v25, 32768, v25
v_mfma_f32_16x16x32_bf16 v[188:191], a[132:135], a[92:95], v[188:191]
v_accvgpr_read_b32 v48, a208
v_accvgpr_read_b32 v49, a209
v_mfma_f32_16x16x32_bf16 v[196:199], a[128:131], a[96:99], v[196:199]
ds_read_b128 a[56:59], v2 offset:47104
v_accvgpr_read_b32 v50, a210
v_mfma_f32_16x16x32_bf16 v[196:199], a[132:135], a[100:103], v[196:199]
v_accvgpr_read_b32 v51, a211
v_accvgpr_read_b32 v96, a212
v_mfma_f32_16x16x32_bf16 v[204:207], a[128:131], a[104:107], v[204:207]
ds_read_b128 a[60:63], v3 offset:47104
v_accvgpr_read_b32 v97, a213
v_mfma_f32_16x16x32_bf16 v[204:207], a[132:135], a[108:111], v[204:207]
v_accvgpr_read_b32 v98, a214
v_accvgpr_read_b32 v99, a215
v_mfma_f32_16x16x32_bf16 v[212:215], a[128:131], a[112:115], v[212:215]
v_cvt_pk_bf16_f32 v48, v48, v49
v_cvt_pk_bf16_f32 v49, v50, v51
v_mfma_f32_16x16x32_bf16 v[212:215], a[132:135], a[116:119], v[212:215]
buffer_store_dwordx4 v[152:155], v1, s[4:7], s31 offen sc1
v_mfma_f32_16x16x32_bf16 v[220:223], a[128:131], a[120:123], v[220:223]
s_add_u32 s31, s31, s36
v_cvt_pk_bf16_f32 v50, v96, v97
v_cvt_pk_bf16_f32 v51, v98, v99
v_mfma_f32_16x16x32_bf16 v[220:223], a[132:135], a[124:127], v[220:223]
s_waitcnt vmcnt(23) lgkmcnt(0)
s_barrier
v_accvgpr_read_b32 v56, a216
v_mfma_f32_16x16x32_bf16 v[224:227], a[136:139], a[64:67], v[224:227]
s_add_u32 m0, s29, 65536
ds_read_b64_tr_b16 a[128:129], v22 offset:0
v_accvgpr_read_b32 v57, a217
v_mfma_f32_16x16x32_bf16 v[224:227], a[140:143], a[68:71], v[224:227]
buffer_load_dwordx4 v16, s[12:15], s26 offen offset:0 lds
v_mfma_f32_16x16x32_bf16 v[228:231], a[136:139], a[72:75], v[228:231]
ds_read_b64_tr_b16 a[130:131], v22 offset:2048
v_accvgpr_read_b32 v58, a218
v_mfma_f32_16x16x32_bf16 v[228:231], a[140:143], a[76:79], v[228:231]
v_accvgpr_read_b32 v59, a219
v_accvgpr_read_b32 v96, a220
v_mfma_f32_16x16x32_bf16 v[232:235], a[136:139], a[80:83], v[232:235]
ds_read_b64_tr_b16 a[132:133], v22 offset:16384
v_accvgpr_read_b32 v97, a221
v_mfma_f32_16x16x32_bf16 v[232:235], a[140:143], a[84:87], v[232:235]
buffer_load_dwordx4 v17, s[12:15], s26 offen offset:1024 lds
v_mfma_f32_16x16x32_bf16 v[236:239], a[136:139], a[88:91], v[236:239]
ds_read_b64_tr_b16 a[134:135], v22 offset:18432
v_add_u32 v22, 32768, v22
v_mfma_f32_16x16x32_bf16 v[236:239], a[140:143], a[92:95], v[236:239]
v_accvgpr_read_b32 v98, a222
v_accvgpr_read_b32 v99, a223
v_mfma_f32_16x16x32_bf16 v[240:243], a[136:139], a[96:99], v[240:243]
v_cvt_pk_bf16_f32 v56, v56, v57
v_cvt_pk_bf16_f32 v57, v58, v59
v_mfma_f32_16x16x32_bf16 v[240:243], a[140:143], a[100:103], v[240:243]
buffer_load_dwordx4 v18, s[12:15], s26 offen offset:2048 lds
v_mfma_f32_16x16x32_bf16 v[244:247], a[136:139], a[104:107], v[244:247]
v_cvt_pk_bf16_f32 v58, v96, v97
v_cvt_pk_bf16_f32 v59, v98, v99
v_mfma_f32_16x16x32_bf16 v[244:247], a[140:143], a[108:111], v[244:247]
v_accvgpr_read_b32 v64, a224
v_accvgpr_read_b32 v65, a225
v_mfma_f32_16x16x32_bf16 v[248:251], a[136:139], a[112:115], v[248:251]
v_accvgpr_read_b32 v66, a226
v_accvgpr_read_b32 v67, a227
v_mfma_f32_16x16x32_bf16 v[248:251], a[140:143], a[116:119], v[248:251]
buffer_load_dwordx4 v19, s[12:15], s26 offen offset:3072 lds
v_mfma_f32_16x16x32_bf16 v[252:255], a[136:139], a[120:123], v[252:255]
s_add_u32 s26, s26, 524288
v_accvgpr_read_b32 v96, a228
v_accvgpr_read_b32 v97, a229
v_mfma_f32_16x16x32_bf16 v[252:255], a[140:143], a[124:127], v[252:255]
s_waitcnt lgkmcnt(0)
v_accvgpr_read_b32 v98, a230
v_accvgpr_read_b32 v99, a231
v_mfma_f32_16x16x32_bf16 v[36:39], a[128:131], a[0:3], v[36:39]
s_add_u32 m0, s29, 81920
ds_read_b64_tr_b16 a[136:137], v23 offset:0
v_cvt_pk_bf16_f32 v64, v64, v65
v_mfma_f32_16x16x32_bf16 v[36:39], a[132:135], a[4:7], v[36:39]
buffer_load_dwordx4 v16, s[12:15], s27 offen offset:0 lds
v_mfma_f32_16x16x32_bf16 v[44:47], a[128:131], a[8:11], v[44:47]
ds_read_b64_tr_b16 a[138:139], v23 offset:2048
v_cvt_pk_bf16_f32 v65, v66, v67
v_mfma_f32_16x16x32_bf16 v[44:47], a[132:135], a[12:15], v[44:47]
ds_read_b128 a[64:67], v2 offset:49152
ds_read_b128 a[68:71], v3 offset:49152
v_mfma_f32_16x16x32_bf16 v[52:55], a[128:131], a[16:19], v[52:55]
ds_read_b64_tr_b16 a[140:141], v23 offset:16384
v_cvt_pk_bf16_f32 v66, v96, v97
v_mfma_f32_16x16x32_bf16 v[52:55], a[132:135], a[20:23], v[52:55]
buffer_load_dwordx4 v17, s[12:15], s27 offen offset:1024 lds
v_mfma_f32_16x16x32_bf16 v[60:63], a[128:131], a[24:27], v[60:63]
ds_read_b64_tr_b16 a[142:143], v23 offset:18432
v_add_u32 v23, 32768, v23
v_mfma_f32_16x16x32_bf16 v[60:63], a[132:135], a[28:31], v[60:63]
buffer_store_dwordx4 v[160:163], v1, s[4:7], s31 offen sc1
v_mfma_f32_16x16x32_bf16 v[68:71], a[128:131], a[32:35], v[68:71]
s_add_u32 s31, s31, s32
ds_read_b128 a[72:75], v2 offset:51200
v_cvt_pk_bf16_f32 v67, v98, v99
v_mfma_f32_16x16x32_bf16 v[68:71], a[132:135], a[36:39], v[68:71]
buffer_load_dwordx4 v18, s[12:15], s27 offen offset:2048 lds
v_mfma_f32_16x16x32_bf16 v[76:79], a[128:131], a[40:43], v[76:79]
ds_read_b128 a[76:79], v3 offset:51200
v_accvgpr_read_b32 v72, a232
v_mfma_f32_16x16x32_bf16 v[76:79], a[132:135], a[44:47], v[76:79]
ds_read_b128 a[80:83], v2 offset:53248
v_accvgpr_read_b32 v73, a233
v_mfma_f32_16x16x32_bf16 v[84:87], a[128:131], a[48:51], v[84:87]
ds_read_b128 a[84:87], v3 offset:53248
v_accvgpr_read_b32 v74, a234
v_mfma_f32_16x16x32_bf16 v[84:87], a[132:135], a[52:55], v[84:87]
buffer_load_dwordx4 v19, s[12:15], s27 offen offset:3072 lds
v_mfma_f32_16x16x32_bf16 v[92:95], a[128:131], a[56:59], v[92:95]
s_add_u32 s27, s27, 524288
ds_read_b128 a[88:91], v2 offset:55296
v_accvgpr_read_b32 v75, a235
v_mfma_f32_16x16x32_bf16 v[92:95], a[132:135], a[60:63], v[92:95]
s_waitcnt lgkmcnt(5)
buffer_store_dwordx4 v[168:171], v1, s[4:7], s31 offen sc1
v_mfma_f32_16x16x32_bf16 v[100:103], a[136:139], a[0:3], v[100:103]
s_add_u32 m0, s28, 32768
ds_read_b64_tr_b16 a[128:129], v24 offset:0
v_accvgpr_read_b32 v96, a236
v_mfma_f32_16x16x32_bf16 v[100:103], a[140:143], a[4:7], v[100:103]
s_add_u32 s31, s31, s33
buffer_load_dwordx4 v12, s[8:11], s24 offen offset:0 lds
v_mfma_f32_16x16x32_bf16 v[108:111], a[136:139], a[8:11], v[108:111]
ds_read_b64_tr_b16 a[130:131], v24 offset:2048
v_accvgpr_read_b32 v97, a237
v_mfma_f32_16x16x32_bf16 v[108:111], a[140:143], a[12:15], v[108:111]
ds_read_b128 a[92:95], v3 offset:55296
v_accvgpr_read_b32 v98, a238
v_mfma_f32_16x16x32_bf16 v[116:119], a[136:139], a[16:19], v[116:119]
ds_read_b64_tr_b16 a[132:133], v24 offset:16384
v_accvgpr_read_b32 v99, a239
v_mfma_f32_16x16x32_bf16 v[116:119], a[140:143], a[20:23], v[116:119]
buffer_load_dwordx4 v13, s[8:11], s24 offen offset:1024 lds
v_mfma_f32_16x16x32_bf16 v[124:127], a[136:139], a[24:27], v[124:127]
ds_read_b64_tr_b16 a[134:135], v24 offset:18432
v_add_u32 v24, 32768, v24
v_mfma_f32_16x16x32_bf16 v[124:127], a[140:143], a[28:31], v[124:127]
v_cvt_pk_bf16_f32 v72, v72, v73
v_cvt_pk_bf16_f32 v73, v74, v75
v_mfma_f32_16x16x32_bf16 v[132:135], a[136:139], a[32:35], v[132:135]
ds_read_b128 a[96:99], v2 offset:57344
v_cvt_pk_bf16_f32 v74, v96, v97
v_mfma_f32_16x16x32_bf16 v[132:135], a[140:143], a[36:39], v[132:135]
buffer_load_dwordx4 v14, s[8:11], s24 offen offset:2048 lds
v_mfma_f32_16x16x32_bf16 v[140:143], a[136:139], a[40:43], v[140:143]
ds_read_b128 a[100:103], v3 offset:57344
v_cvt_pk_bf16_f32 v75, v98, v99
v_mfma_f32_16x16x32_bf16 v[140:143], a[140:143], a[44:47], v[140:143]
ds_read_b128 a[104:107], v2 offset:59392
v_accvgpr_read_b32 v80, a240
v_mfma_f32_16x16x32_bf16 v[148:151], a[136:139], a[48:51], v[148:151]
ds_read_b128 a[108:111], v3 offset:59392
v_accvgpr_read_b32 v81, a241
v_mfma_f32_16x16x32_bf16 v[148:151], a[140:143], a[52:55], v[148:151]
buffer_load_dwordx4 v15, s[8:11], s24 offen offset:3072 lds
v_mfma_f32_16x16x32_bf16 v[156:159], a[136:139], a[56:59], v[156:159]
s_add_u32 s24, s24, 128
ds_read_b128 a[112:115], v2 offset:61440
v_accvgpr_read_b32 v82, a242
v_mfma_f32_16x16x32_bf16 v[156:159], a[140:143], a[60:63], v[156:159]
s_waitcnt lgkmcnt(5)
buffer_store_dwordx4 v[176:179], v1, s[4:7], s31 offen sc1
v_mfma_f32_16x16x32_bf16 v[164:167], a[128:131], a[0:3], v[164:167]
s_add_u32 s31, s31, s32
ds_read_b64_tr_b16 a[136:137], v25 offset:0
v_accvgpr_read_b32 v83, a243
v_mfma_f32_16x16x32_bf16 v[164:167], a[132:135], a[4:7], v[164:167]
v_accvgpr_read_b32 v96, a244
v_accvgpr_read_b32 v97, a245
v_mfma_f32_16x16x32_bf16 v[172:175], a[128:131], a[8:11], v[172:175]
ds_read_b64_tr_b16 a[138:139], v25 offset:2048
v_accvgpr_read_b32 v98, a246
v_mfma_f32_16x16x32_bf16 v[172:175], a[132:135], a[12:15], v[172:175]
ds_read_b128 a[116:119], v3 offset:61440
v_accvgpr_read_b32 v99, a247
v_mfma_f32_16x16x32_bf16 v[180:183], a[128:131], a[16:19], v[180:183]
ds_read_b64_tr_b16 a[140:141], v25 offset:16384
v_cvt_pk_bf16_f32 v80, v80, v81
v_mfma_f32_16x16x32_bf16 v[180:183], a[132:135], a[20:23], v[180:183]
buffer_store_dwordx4 v[184:187], v1, s[4:7], s31 offen sc1
v_mfma_f32_16x16x32_bf16 v[188:191], a[128:131], a[24:27], v[188:191]
s_add_u32 s31, s31, s34
ds_read_b64_tr_b16 a[142:143], v25 offset:18432
v_add_u32 v25, 32768, v25
v_mfma_f32_16x16x32_bf16 v[188:191], a[132:135], a[28:31], v[188:191]
v_cvt_pk_bf16_f32 v81, v82, v83
v_cvt_pk_bf16_f32 v82, v96, v97
v_mfma_f32_16x16x32_bf16 v[196:199], a[128:131], a[32:35], v[196:199]
ds_read_b128 a[120:123], v2 offset:63488
v_cvt_pk_bf16_f32 v83, v98, v99
v_mfma_f32_16x16x32_bf16 v[196:199], a[132:135], a[36:39], v[196:199]
v_accvgpr_read_b32 v88, a248
v_accvgpr_read_b32 v89, a249
v_mfma_f32_16x16x32_bf16 v[204:207], a[128:131], a[40:43], v[204:207]
ds_read_b128 a[124:127], v3 offset:63488
v_accvgpr_read_b32 v90, a250
v_mfma_f32_16x16x32_bf16 v[204:207], a[132:135], a[44:47], v[204:207]
v_accvgpr_read_b32 v91, a251
v_accvgpr_read_b32 v96, a252
v_mfma_f32_16x16x32_bf16 v[212:215], a[128:131], a[48:51], v[212:215]
v_accvgpr_read_b32 v97, a253
v_accvgpr_read_b32 v98, a254
v_mfma_f32_16x16x32_bf16 v[212:215], a[132:135], a[52:55], v[212:215]
v_accvgpr_read_b32 v99, a255
v_cvt_pk_bf16_f32 v88, v88, v89
v_mfma_f32_16x16x32_bf16 v[220:223], a[128:131], a[56:59], v[220:223]
v_cvt_pk_bf16_f32 v89, v90, v91
v_cvt_pk_bf16_f32 v90, v96, v97
v_mfma_f32_16x16x32_bf16 v[220:223], a[132:135], a[60:63], v[220:223]
s_waitcnt vmcnt(23) lgkmcnt(0)
s_barrier
v_cvt_pk_bf16_f32 v91, v98, v99
v_mfma_f32_16x16x32_bf16 v[224:227], a[136:139], a[0:3], v[224:227]
s_add_u32 m0, s29, 98304
ds_read_b64_tr_b16 a[128:129], v22 offset:0
v_mfma_f32_16x16x32_bf16 v[224:227], a[140:143], a[4:7], v[224:227]
buffer_load_dwordx4 v16, s[12:15], s26 offen offset:0 lds
v_mfma_f32_16x16x32_bf16 v[228:231], a[136:139], a[8:11], v[228:231]
ds_read_b64_tr_b16 a[130:131], v22 offset:2048
v_mfma_f32_16x16x32_bf16 v[228:231], a[140:143], a[12:15], v[228:231]
buffer_store_dwordx4 v[192:195], v1, s[4:7], s31 offen sc1
v_mfma_f32_16x16x32_bf16 v[232:235], a[136:139], a[16:19], v[232:235]
s_add_u32 s31, s31, s32
ds_read_b64_tr_b16 a[132:133], v22 offset:16384
v_mfma_f32_16x16x32_bf16 v[232:235], a[140:143], a[20:23], v[232:235]
buffer_load_dwordx4 v17, s[12:15], s26 offen offset:1024 lds
v_mfma_f32_16x16x32_bf16 v[236:239], a[136:139], a[24:27], v[236:239]
ds_read_b64_tr_b16 a[134:135], v22 offset:18432
v_add_u32 v22, 4294901760, v22
v_mfma_f32_16x16x32_bf16 v[236:239], a[140:143], a[28:31], v[236:239]
v_mfma_f32_16x16x32_bf16 v[240:243], a[136:139], a[32:35], v[240:243]
v_mfma_f32_16x16x32_bf16 v[240:243], a[140:143], a[36:39], v[240:243]
buffer_load_dwordx4 v18, s[12:15], s26 offen offset:2048 lds
v_mfma_f32_16x16x32_bf16 v[244:247], a[136:139], a[40:43], v[244:247]
v_mfma_f32_16x16x32_bf16 v[244:247], a[140:143], a[44:47], v[244:247]
v_mfma_f32_16x16x32_bf16 v[248:251], a[136:139], a[48:51], v[248:251]
v_mfma_f32_16x16x32_bf16 v[248:251], a[140:143], a[52:55], v[248:251]
buffer_load_dwordx4 v19, s[12:15], s26 offen offset:3072 lds
v_mfma_f32_16x16x32_bf16 v[252:255], a[136:139], a[56:59], v[252:255]
s_add_u32 s26, s26, 524288
v_mfma_f32_16x16x32_bf16 v[252:255], a[140:143], a[60:63], v[252:255]
s_waitcnt lgkmcnt(0)
v_mfma_f32_16x16x32_bf16 v[36:39], a[128:131], a[64:67], v[36:39]
s_add_u32 m0, s29, 114688
ds_read_b64_tr_b16 a[136:137], v23 offset:0
v_mfma_f32_16x16x32_bf16 v[36:39], a[132:135], a[68:71], v[36:39]
buffer_load_dwordx4 v16, s[12:15], s27 offen offset:0 lds
v_mfma_f32_16x16x32_bf16 v[44:47], a[128:131], a[72:75], v[44:47]
ds_read_b64_tr_b16 a[138:139], v23 offset:2048
v_mfma_f32_16x16x32_bf16 v[44:47], a[132:135], a[76:79], v[44:47]
ds_read_b128 a[0:3], v2 offset:0
ds_read_b128 a[4:7], v3 offset:0
v_mfma_f32_16x16x32_bf16 v[52:55], a[128:131], a[80:83], v[52:55]
ds_read_b64_tr_b16 a[140:141], v23 offset:16384
v_mfma_f32_16x16x32_bf16 v[52:55], a[132:135], a[84:87], v[52:55]
buffer_load_dwordx4 v17, s[12:15], s27 offen offset:1024 lds
v_mfma_f32_16x16x32_bf16 v[60:63], a[128:131], a[88:91], v[60:63]
ds_read_b64_tr_b16 a[142:143], v23 offset:18432
v_add_u32 v23, 4294901760, v23
v_mfma_f32_16x16x32_bf16 v[60:63], a[132:135], a[92:95], v[60:63]
buffer_store_dwordx4 v[200:203], v1, s[4:7], s31 offen sc1
v_mfma_f32_16x16x32_bf16 v[68:71], a[128:131], a[96:99], v[68:71]
s_add_u32 s31, s31, s33
ds_read_b128 a[8:11], v2 offset:2048
v_mfma_f32_16x16x32_bf16 v[68:71], a[132:135], a[100:103], v[68:71]
buffer_load_dwordx4 v18, s[12:15], s27 offen offset:2048 lds
v_mfma_f32_16x16x32_bf16 v[76:79], a[128:131], a[104:107], v[76:79]
ds_read_b128 a[12:15], v3 offset:2048
v_mfma_f32_16x16x32_bf16 v[76:79], a[132:135], a[108:111], v[76:79]
ds_read_b128 a[16:19], v2 offset:4096
v_mfma_f32_16x16x32_bf16 v[84:87], a[128:131], a[112:115], v[84:87]
ds_read_b128 a[20:23], v3 offset:4096
v_mfma_f32_16x16x32_bf16 v[84:87], a[132:135], a[116:119], v[84:87]
buffer_load_dwordx4 v19, s[12:15], s27 offen offset:3072 lds
v_mfma_f32_16x16x32_bf16 v[92:95], a[128:131], a[120:123], v[92:95]
s_add_u32 s27, s27, 524288
ds_read_b128 a[24:27], v2 offset:6144
v_mfma_f32_16x16x32_bf16 v[92:95], a[132:135], a[124:127], v[92:95]
s_waitcnt lgkmcnt(5)
buffer_store_dwordx4 v[208:211], v1, s[4:7], s31 offen sc1
v_mfma_f32_16x16x32_bf16 v[100:103], a[136:139], a[64:67], v[100:103]
s_add_u32 s31, s31, s32
ds_read_b64_tr_b16 a[128:129], v24 offset:0
v_mfma_f32_16x16x32_bf16 v[100:103], a[140:143], a[68:71], v[100:103]
v_mfma_f32_16x16x32_bf16 v[108:111], a[136:139], a[72:75], v[108:111]
ds_read_b64_tr_b16 a[130:131], v24 offset:2048
v_mfma_f32_16x16x32_bf16 v[108:111], a[140:143], a[76:79], v[108:111]
ds_read_b128 a[28:31], v3 offset:6144
v_mfma_f32_16x16x32_bf16 v[116:119], a[136:139], a[80:83], v[116:119]
ds_read_b64_tr_b16 a[132:133], v24 offset:16384
v_mfma_f32_16x16x32_bf16 v[116:119], a[140:143], a[84:87], v[116:119]
v_mfma_f32_16x16x32_bf16 v[124:127], a[136:139], a[88:91], v[124:127]
ds_read_b64_tr_b16 a[134:135], v24 offset:18432
v_add_u32 v24, 4294901760, v24
v_mfma_f32_16x16x32_bf16 v[124:127], a[140:143], a[92:95], v[124:127]
v_mfma_f32_16x16x32_bf16 v[132:135], a[136:139], a[96:99], v[132:135]
ds_read_b128 a[32:35], v2 offset:8192
v_mfma_f32_16x16x32_bf16 v[132:135], a[140:143], a[100:103], v[132:135]
buffer_store_dwordx4 v[216:219], v1, s[4:7], s31 offen sc1
v_mfma_f32_16x16x32_bf16 v[140:143], a[136:139], a[104:107], v[140:143]
s_add_u32 s31, s31, s35
ds_read_b128 a[36:39], v3 offset:8192
v_mfma_f32_16x16x32_bf16 v[140:143], a[140:143], a[108:111], v[140:143]
ds_read_b128 a[40:43], v2 offset:10240
v_mfma_f32_16x16x32_bf16 v[148:151], a[136:139], a[112:115], v[148:151]
ds_read_b128 a[44:47], v3 offset:10240
v_mfma_f32_16x16x32_bf16 v[148:151], a[140:143], a[116:119], v[148:151]
v_mfma_f32_16x16x32_bf16 v[156:159], a[136:139], a[120:123], v[156:159]
ds_read_b128 a[48:51], v2 offset:12288
v_mfma_f32_16x16x32_bf16 v[156:159], a[140:143], a[124:127], v[156:159]
s_waitcnt lgkmcnt(5)
v_mfma_f32_16x16x32_bf16 v[164:167], a[128:131], a[64:67], v[164:167]
ds_read_b64_tr_b16 a[136:137], v25 offset:0
v_mfma_f32_16x16x32_bf16 v[164:167], a[132:135], a[68:71], v[164:167]
v_mfma_f32_16x16x32_bf16 v[172:175], a[128:131], a[72:75], v[172:175]
ds_read_b64_tr_b16 a[138:139], v25 offset:2048
v_mfma_f32_16x16x32_bf16 v[172:175], a[132:135], a[76:79], v[172:175]
ds_read_b128 a[52:55], v3 offset:12288
v_mfma_f32_16x16x32_bf16 v[180:183], a[128:131], a[80:83], v[180:183]
ds_read_b64_tr_b16 a[140:141], v25 offset:16384
v_mfma_f32_16x16x32_bf16 v[180:183], a[132:135], a[84:87], v[180:183]
buffer_store_dwordx4 v[32:35], v1, s[4:7], s31 offen sc1
v_mfma_f32_16x16x32_bf16 v[188:191], a[128:131], a[88:91], v[188:191]
s_add_u32 s31, s31, s32
ds_read_b64_tr_b16 a[142:143], v25 offset:18432
v_add_u32 v25, 4294901760, v25
v_mfma_f32_16x16x32_bf16 v[188:191], a[132:135], a[92:95], v[188:191]
v_mfma_f32_16x16x32_bf16 v[196:199], a[128:131], a[96:99], v[196:199]
ds_read_b128 a[56:59], v2 offset:14336
v_mfma_f32_16x16x32_bf16 v[196:199], a[132:135], a[100:103], v[196:199]
v_mfma_f32_16x16x32_bf16 v[204:207], a[128:131], a[104:107], v[204:207]
ds_read_b128 a[60:63], v3 offset:14336
v_mfma_f32_16x16x32_bf16 v[204:207], a[132:135], a[108:111], v[204:207]
v_mfma_f32_16x16x32_bf16 v[212:215], a[128:131], a[112:115], v[212:215]
v_mfma_f32_16x16x32_bf16 v[212:215], a[132:135], a[116:119], v[212:215]
v_mfma_f32_16x16x32_bf16 v[220:223], a[128:131], a[120:123], v[220:223]
v_mfma_f32_16x16x32_bf16 v[220:223], a[132:135], a[124:127], v[220:223]
s_waitcnt vmcnt(20) lgkmcnt(0)
s_barrier
v_mfma_f32_16x16x32_bf16 v[224:227], a[136:139], a[64:67], v[224:227]
s_add_u32 m0, s29, 131072
ds_read_b64_tr_b16 a[128:129], v22 offset:0
v_mfma_f32_16x16x32_bf16 v[224:227], a[140:143], a[68:71], v[224:227]
buffer_load_dwordx4 v16, s[12:15], s26 offen offset:0 lds
v_mfma_f32_16x16x32_bf16 v[228:231], a[136:139], a[72:75], v[228:231]
ds_read_b64_tr_b16 a[130:131], v22 offset:2048
v_mfma_f32_16x16x32_bf16 v[228:231], a[140:143], a[76:79], v[228:231]
PAD_7:
s_cbranch_execz M_tret
buffer_store_dwordx4 v[40:43], v1, s[4:7], s31 offen sc1
v_mfma_f32_16x16x32_bf16 v[232:235], a[136:139], a[80:83], v[232:235]
s_add_u32 s31, s31, s33
ds_read_b64_tr_b16 a[132:133], v22 offset:16384
v_mfma_f32_16x16x32_bf16 v[232:235], a[140:143], a[84:87], v[232:235]
buffer_load_dwordx4 v17, s[12:15], s26 offen offset:1024 lds
v_mfma_f32_16x16x32_bf16 v[236:239], a[136:139], a[88:91], v[236:239]
ds_read_b64_tr_b16 a[134:135], v22 offset:18432
v_add_u32 v22, 32768, v22
v_mfma_f32_16x16x32_bf16 v[236:239], a[140:143], a[92:95], v[236:239]
v_mfma_f32_16x16x32_bf16 v[240:243], a[136:139], a[96:99], v[240:243]
v_mfma_f32_16x16x32_bf16 v[240:243], a[140:143], a[100:103], v[240:243]
buffer_load_dwordx4 v18, s[12:15], s26 offen offset:2048 lds
v_mfma_f32_16x16x32_bf16 v[244:247], a[136:139], a[104:107], v[244:247]
v_mfma_f32_16x16x32_bf16 v[244:247], a[140:143], a[108:111], v[244:247]
v_mfma_f32_16x16x32_bf16 v[248:251], a[136:139], a[112:115], v[248:251]
v_mfma_f32_16x16x32_bf16 v[248:251], a[140:143], a[116:119], v[248:251]
buffer_load_dwordx4 v19, s[12:15], s26 offen offset:3072 lds
v_mfma_f32_16x16x32_bf16 v[252:255], a[136:139], a[120:123], v[252:255]
s_add_u32 s26, s26, 524288
v_mfma_f32_16x16x32_bf16 v[252:255], a[140:143], a[124:127], v[252:255]
s_waitcnt lgkmcnt(0)
v_mfma_f32_16x16x32_bf16 v[36:39], a[128:131], a[0:3], v[36:39]
s_add_u32 m0, s29, 147456
ds_read_b64_tr_b16 a[136:137], v23 offset:0
v_mfma_f32_16x16x32_bf16 v[36:39], a[132:135], a[4:7], v[36:39]
buffer_load_dwordx4 v16, s[12:15], s27 offen offset:0 lds
v_mfma_f32_16x16x32_bf16 v[44:47], a[128:131], a[8:11], v[44:47]
s_lshl_b32 s22, s20, 7
ds_read_b64_tr_b16 a[138:139], v23 offset:2048
v_bfe_u32 v20, v1, 4, 3
v_mfma_f32_16x16x32_bf16 v[44:47], a[132:135], a[12:15], v[44:47]
s_add_u32 s70, s22, 94371840
ds_read_b128 a[64:67], v2 offset:16384
ds_read_b128 a[68:71], v3 offset:16384
v_mfma_f32_16x16x32_bf16 v[52:55], a[128:131], a[16:19], v[52:55]
s_lshr_b32 s22, s2, 4
ds_read_b64_tr_b16 a[140:141], v23 offset:16384
v_lshlrev_b32 v20, 3, v20
v_mfma_f32_16x16x32_bf16 v[52:55], a[132:135], a[20:23], v[52:55]
s_lshl_b32 s22, s22, 2
buffer_load_dwordx4 v17, s[12:15], s27 offen offset:1024 lds
v_mfma_f32_16x16x32_bf16 v[60:63], a[128:131], a[24:27], v[60:63]
s_add_u32 s66, s70, s22
ds_read_b64_tr_b16 a[142:143], v23 offset:18432
v_add_u32 v23, 32768, v23
v_mfma_f32_16x16x32_bf16 v[60:63], a[132:135], a[28:31], v[60:63]
s_and_b32 s22, s2, 16
buffer_store_dwordx4 v[48:51], v1, s[4:7], s31 offen sc1
v_mfma_f32_16x16x32_bf16 v[68:71], a[128:131], a[32:35], v[68:71]
s_add_u32 s31, s31, s32
ds_read_b128 a[72:75], v2 offset:18432
v_add_u32 v15, 2052, v20
v_mfma_f32_16x16x32_bf16 v[68:71], a[132:135], a[36:39], v[68:71]
s_lshl_b32 s22, s22, 7
buffer_load_dwordx4 v18, s[12:15], s27 offen offset:2048 lds
v_mfma_f32_16x16x32_bf16 v[76:79], a[128:131], a[40:43], v[76:79]
s_add_u32 s66, s66, s22
ds_read_b128 a[76:79], v3 offset:18432
v_mfma_f32_16x16x32_bf16 v[76:79], a[132:135], a[44:47], v[76:79]
s_lshl_b32 s67, s20, 20
ds_read_b128 a[80:83], v2 offset:20480
v_mfma_f32_16x16x32_bf16 v[84:87], a[128:131], a[48:51], v[84:87]
s_lshl_b32 s22, s37, 16
ds_read_b128 a[84:87], v3 offset:20480
v_mfma_f32_16x16x32_bf16 v[84:87], a[132:135], a[52:55], v[84:87]
s_add_u32 s67, s67, s22
buffer_load_dwordx4 v19, s[12:15], s27 offen offset:3072 lds
v_mfma_f32_16x16x32_bf16 v[92:95], a[128:131], a[56:59], v[92:95]
s_waitcnt lgkmcnt(5)
s_add_u32 s27, s27, 524288
ds_read_b128 a[88:91], v2 offset:22528
v_mfma_f32_16x16x32_bf16 v[92:95], a[132:135], a[60:63], v[92:95]
s_lshl_b32 s22, s3, 11
buffer_store_dwordx4 v[56:59], v1, s[4:7], s31 offen sc1
v_mfma_f32_16x16x32_bf16 v[100:103], a[136:139], a[0:3], v[100:103]
s_waitcnt lgkmcnt(5)
s_add_u32 s31, s31, s34
ds_read_b64_tr_b16 a[128:129], v24 offset:0
v_mfma_f32_16x16x32_bf16 v[100:103], a[140:143], a[4:7], v[100:103]
s_add_u32 s67, s67, s22
v_mfma_f32_16x16x32_bf16 v[108:111], a[136:139], a[8:11], v[108:111]
s_add_u32 s67, s67, 33554432
ds_read_b64_tr_b16 a[130:131], v24 offset:2048
v_mfma_f32_16x16x32_bf16 v[108:111], a[140:143], a[12:15], v[108:111]
s_mov_b32 s68, 1035512379
ds_read_b128 a[92:95], v3 offset:22528
v_mfma_f32_16x16x32_bf16 v[116:119], a[136:139], a[16:19], v[116:119]
s_mov_b32 s69, 1035512379
ds_read_b64_tr_b16 a[132:133], v24 offset:16384
v_mfma_f32_16x16x32_bf16 v[116:119], a[140:143], a[20:23], v[116:119]
buffer_store_dwordx4 v[64:67], v1, s[4:7], s31 offen sc1
v_mfma_f32_16x16x32_bf16 v[124:127], a[136:139], a[24:27], v[124:127]
s_add_u32 s31, s31, s32
ds_read_b64_tr_b16 a[134:135], v24 offset:18432
v_add_u32 v24, 32768, v24
v_mfma_f32_16x16x32_bf16 v[124:127], a[140:143], a[28:31], v[124:127]
v_mfma_f32_16x16x32_bf16 v[132:135], a[136:139], a[32:35], v[132:135]
ds_read_b128 a[96:99], v2 offset:24576
v_mfma_f32_16x16x32_bf16 v[132:135], a[140:143], a[36:39], v[132:135]
v_mfma_f32_16x16x32_bf16 v[140:143], a[136:139], a[40:43], v[140:143]
ds_read_b128 a[100:103], v3 offset:24576
v_mfma_f32_16x16x32_bf16 v[140:143], a[140:143], a[44:47], v[140:143]
ds_read_b128 a[104:107], v2 offset:26624
v_mfma_f32_16x16x32_bf16 v[148:151], a[136:139], a[48:51], v[148:151]
ds_read_b128 a[108:111], v3 offset:26624
v_mfma_f32_16x16x32_bf16 v[148:151], a[140:143], a[52:55], v[148:151]
v_mfma_f32_16x16x32_bf16 v[156:159], a[136:139], a[56:59], v[156:159]
ds_read_b128 a[112:115], v2 offset:28672
v_mfma_f32_16x16x32_bf16 v[156:159], a[140:143], a[60:63], v[156:159]
s_waitcnt lgkmcnt(5)
buffer_store_dwordx4 v[72:75], v1, s[4:7], s31 offen sc1
v_mfma_f32_16x16x32_bf16 v[164:167], a[128:131], a[0:3], v[164:167]
s_add_u32 s31, s31, s33
ds_read_b64_tr_b16 a[136:137], v25 offset:0
v_mfma_f32_16x16x32_bf16 v[164:167], a[132:135], a[4:7], v[164:167]
v_mfma_f32_16x16x32_bf16 v[172:175], a[128:131], a[8:11], v[172:175]
ds_read_b64_tr_b16 a[138:139], v25 offset:2048
v_mfma_f32_16x16x32_bf16 v[172:175], a[132:135], a[12:15], v[172:175]
ds_read_b128 a[116:119], v3 offset:28672
v_mfma_f32_16x16x32_bf16 v[180:183], a[128:131], a[16:19], v[180:183]
ds_read_b64_tr_b16 a[140:141], v25 offset:16384
v_mfma_f32_16x16x32_bf16 v[180:183], a[132:135], a[20:23], v[180:183]
v_mfma_f32_16x16x32_bf16 v[188:191], a[128:131], a[24:27], v[188:191]
ds_read_b64_tr_b16 a[142:143], v25 offset:18432
v_add_u32 v25, 32768, v25
v_mfma_f32_16x16x32_bf16 v[188:191], a[132:135], a[28:31], v[188:191]
v_mfma_f32_16x16x32_bf16 v[196:199], a[128:131], a[32:35], v[196:199]
ds_read_b128 a[120:123], v2 offset:30720
v_mfma_f32_16x16x32_bf16 v[196:199], a[132:135], a[36:39], v[196:199]
buffer_store_dwordx4 v[80:83], v1, s[4:7], s31 offen sc1
v_mfma_f32_16x16x32_bf16 v[204:207], a[128:131], a[40:43], v[204:207]
s_add_u32 s31, s31, s32
ds_read_b128 a[124:127], v3 offset:30720
v_mfma_f32_16x16x32_bf16 v[204:207], a[132:135], a[44:47], v[204:207]
v_mfma_f32_16x16x32_bf16 v[212:215], a[128:131], a[48:51], v[212:215]
v_mfma_f32_16x16x32_bf16 v[212:215], a[132:135], a[52:55], v[212:215]
v_mfma_f32_16x16x32_bf16 v[220:223], a[128:131], a[56:59], v[220:223]
v_mfma_f32_16x16x32_bf16 v[220:223], a[132:135], a[60:63], v[220:223]
s_waitcnt vmcnt(17) lgkmcnt(0)
s_barrier
v_mfma_f32_16x16x32_bf16 v[224:227], a[136:139], a[0:3], v[224:227]
ds_read_b64_tr_b16 a[128:129], v22 offset:0
v_mfma_f32_16x16x32_bf16 v[224:227], a[140:143], a[4:7], v[224:227]
v_mfma_f32_16x16x32_bf16 v[228:231], a[136:139], a[8:11], v[228:231]
ds_read_b64_tr_b16 a[130:131], v22 offset:2048
v_mfma_f32_16x16x32_bf16 v[228:231], a[140:143], a[12:15], v[228:231]
buffer_store_dwordx4 v[88:91], v1, s[4:7], s31 offen sc1
v_mfma_f32_16x16x32_bf16 v[232:235], a[136:139], a[16:19], v[232:235]
ds_read_b64_tr_b16 a[132:133], v22 offset:16384
v_mfma_f32_16x16x32_bf16 v[232:235], a[140:143], a[20:23], v[232:235]
v_mfma_f32_16x16x32_bf16 v[236:239], a[136:139], a[24:27], v[236:239]
ds_read_b64_tr_b16 a[134:135], v22 offset:18432
v_add_u32 v22, 32768, v22
v_mfma_f32_16x16x32_bf16 v[236:239], a[140:143], a[28:31], v[236:239]
v_mfma_f32_16x16x32_bf16 v[240:243], a[136:139], a[32:35], v[240:243]
v_mfma_f32_16x16x32_bf16 v[240:243], a[140:143], a[36:39], v[240:243]
v_mfma_f32_16x16x32_bf16 v[244:247], a[136:139], a[40:43], v[244:247]
v_mfma_f32_16x16x32_bf16 v[244:247], a[140:143], a[44:47], v[244:247]
v_mfma_f32_16x16x32_bf16 v[248:251], a[136:139], a[48:51], v[248:251]
v_mfma_f32_16x16x32_bf16 v[248:251], a[140:143], a[52:55], v[248:251]
v_mfma_f32_16x16x32_bf16 v[252:255], a[136:139], a[56:59], v[252:255]
v_mfma_f32_16x16x32_bf16 v[252:255], a[140:143], a[60:63], v[252:255]
s_waitcnt lgkmcnt(0)
v_mfma_f32_16x16x32_bf16 v[36:39], a[128:131], a[64:67], v[36:39]
ds_read_b64_tr_b16 a[136:137], v23 offset:0
v_mfma_f32_16x16x32_bf16 v[36:39], a[132:135], a[68:71], v[36:39]
v_mfma_f32_16x16x32_bf16 v[44:47], a[128:131], a[72:75], v[44:47]
ds_read_b64_tr_b16 a[138:139], v23 offset:2048
v_mfma_f32_16x16x32_bf16 v[44:47], a[132:135], a[76:79], v[44:47]
ds_read_b128 a[0:3], v2 offset:32768
ds_read_b128 a[4:7], v3 offset:32768
v_mfma_f32_16x16x32_bf16 v[52:55], a[128:131], a[80:83], v[52:55]
ds_read_b64_tr_b16 a[140:141], v23 offset:16384
v_mfma_f32_16x16x32_bf16 v[52:55], a[132:135], a[84:87], v[52:55]
v_mfma_f32_16x16x32_bf16 v[60:63], a[128:131], a[88:91], v[60:63]
ds_read_b64_tr_b16 a[142:143], v23 offset:18432
v_add_u32 v23, 32768, v23
v_mfma_f32_16x16x32_bf16 v[60:63], a[132:135], a[92:95], v[60:63]
v_mfma_f32_16x16x32_bf16 v[68:71], a[128:131], a[96:99], v[68:71]
ds_read_b128 a[8:11], v2 offset:34816
v_mfma_f32_16x16x32_bf16 v[68:71], a[132:135], a[100:103], v[68:71]
v_mfma_f32_16x16x32_bf16 v[76:79], a[128:131], a[104:107], v[76:79]
ds_read_b128 a[12:15], v3 offset:34816
v_mfma_f32_16x16x32_bf16 v[76:79], a[132:135], a[108:111], v[76:79]
ds_read_b128 a[16:19], v2 offset:36864
v_mfma_f32_16x16x32_bf16 v[84:87], a[128:131], a[112:115], v[84:87]
ds_read_b128 a[20:23], v3 offset:36864
v_mfma_f32_16x16x32_bf16 v[84:87], a[132:135], a[116:119], v[84:87]
v_mfma_f32_16x16x32_bf16 v[92:95], a[128:131], a[120:123], v[92:95]
ds_read_b128 a[24:27], v2 offset:38912
v_mfma_f32_16x16x32_bf16 v[92:95], a[132:135], a[124:127], v[92:95]
s_waitcnt lgkmcnt(5)
v_mfma_f32_16x16x32_bf16 v[100:103], a[136:139], a[64:67], v[100:103]
ds_read_b64_tr_b16 a[128:129], v24 offset:0
v_mfma_f32_16x16x32_bf16 v[100:103], a[140:143], a[68:71], v[100:103]
v_mfma_f32_16x16x32_bf16 v[108:111], a[136:139], a[72:75], v[108:111]
ds_read_b64_tr_b16 a[130:131], v24 offset:2048
v_mfma_f32_16x16x32_bf16 v[108:111], a[140:143], a[76:79], v[108:111]
ds_read_b128 a[28:31], v3 offset:38912
v_mfma_f32_16x16x32_bf16 v[116:119], a[136:139], a[80:83], v[116:119]
ds_read_b64_tr_b16 a[132:133], v24 offset:16384
v_mfma_f32_16x16x32_bf16 v[116:119], a[140:143], a[84:87], v[116:119]
v_mfma_f32_16x16x32_bf16 v[124:127], a[136:139], a[88:91], v[124:127]
ds_read_b64_tr_b16 a[134:135], v24 offset:18432
v_add_u32 v24, 32768, v24
v_mfma_f32_16x16x32_bf16 v[124:127], a[140:143], a[92:95], v[124:127]
v_mfma_f32_16x16x32_bf16 v[132:135], a[136:139], a[96:99], v[132:135]
ds_read_b128 a[32:35], v2 offset:40960
v_mfma_f32_16x16x32_bf16 v[132:135], a[140:143], a[100:103], v[132:135]
v_mfma_f32_16x16x32_bf16 v[140:143], a[136:139], a[104:107], v[140:143]
ds_read_b128 a[36:39], v3 offset:40960
v_mfma_f32_16x16x32_bf16 v[140:143], a[140:143], a[108:111], v[140:143]
ds_read_b128 a[40:43], v2 offset:43008
v_mfma_f32_16x16x32_bf16 v[148:151], a[136:139], a[112:115], v[148:151]
ds_read_b128 a[44:47], v3 offset:43008
v_mfma_f32_16x16x32_bf16 v[148:151], a[140:143], a[116:119], v[148:151]
v_mfma_f32_16x16x32_bf16 v[156:159], a[136:139], a[120:123], v[156:159]
ds_read_b128 a[48:51], v2 offset:45056
v_mfma_f32_16x16x32_bf16 v[156:159], a[140:143], a[124:127], v[156:159]
s_waitcnt lgkmcnt(5)
v_mfma_f32_16x16x32_bf16 v[164:167], a[128:131], a[64:67], v[164:167]
ds_read_b64_tr_b16 a[136:137], v25 offset:0
v_mfma_f32_16x16x32_bf16 v[164:167], a[132:135], a[68:71], v[164:167]
v_mfma_f32_16x16x32_bf16 v[172:175], a[128:131], a[72:75], v[172:175]
ds_read_b64_tr_b16 a[138:139], v25 offset:2048
v_mfma_f32_16x16x32_bf16 v[172:175], a[132:135], a[76:79], v[172:175]
ds_read_b128 a[52:55], v3 offset:45056
v_mfma_f32_16x16x32_bf16 v[180:183], a[128:131], a[80:83], v[180:183]
ds_read_b64_tr_b16 a[140:141], v25 offset:16384
v_mfma_f32_16x16x32_bf16 v[180:183], a[132:135], a[84:87], v[180:183]
v_mfma_f32_16x16x32_bf16 v[188:191], a[128:131], a[88:91], v[188:191]
ds_read_b64_tr_b16 a[142:143], v25 offset:18432
v_add_u32 v25, 32768, v25
v_mfma_f32_16x16x32_bf16 v[188:191], a[132:135], a[92:95], v[188:191]
v_mfma_f32_16x16x32_bf16 v[196:199], a[128:131], a[96:99], v[196:199]
ds_read_b128 a[56:59], v2 offset:47104
v_mfma_f32_16x16x32_bf16 v[196:199], a[132:135], a[100:103], v[196:199]
v_mfma_f32_16x16x32_bf16 v[204:207], a[128:131], a[104:107], v[204:207]
ds_read_b128 a[60:63], v3 offset:47104
v_mfma_f32_16x16x32_bf16 v[204:207], a[132:135], a[108:111], v[204:207]
v_mfma_f32_16x16x32_bf16 v[212:215], a[128:131], a[112:115], v[212:215]
v_mfma_f32_16x16x32_bf16 v[212:215], a[132:135], a[116:119], v[212:215]
v_mfma_f32_16x16x32_bf16 v[220:223], a[128:131], a[120:123], v[220:223]
v_mfma_f32_16x16x32_bf16 v[220:223], a[132:135], a[124:127], v[220:223]
s_waitcnt vmcnt(0) lgkmcnt(0)
s_barrier
v_mfma_f32_16x16x32_bf16 v[224:227], a[136:139], a[64:67], v[224:227]
ds_read_b64_tr_b16 a[128:129], v22 offset:0
v_mfma_f32_16x16x32_bf16 v[224:227], a[140:143], a[68:71], v[224:227]
buffer_store_dword v27, v26, s[4:7], s66 offen sc1
v_mfma_f32_16x16x32_bf16 v[228:231], a[136:139], a[72:75], v[228:231]
ds_read_b64_tr_b16 a[130:131], v22 offset:2048
v_mfma_f32_16x16x32_bf16 v[228:231], a[140:143], a[76:79], v[228:231]
v_mfma_f32_16x16x32_bf16 v[232:235], a[136:139], a[80:83], v[232:235]
ds_read_b64_tr_b16 a[132:133], v22 offset:16384
v_mfma_f32_16x16x32_bf16 v[232:235], a[140:143], a[84:87], v[232:235]
v_mfma_f32_16x16x32_bf16 v[236:239], a[136:139], a[88:91], v[236:239]
ds_read_b64_tr_b16 a[134:135], v22 offset:18432
v_mfma_f32_16x16x32_bf16 v[236:239], a[140:143], a[92:95], v[236:239]
v_mfma_f32_16x16x32_bf16 v[240:243], a[136:139], a[96:99], v[240:243]
v_mfma_f32_16x16x32_bf16 v[240:243], a[140:143], a[100:103], v[240:243]
v_mfma_f32_16x16x32_bf16 v[244:247], a[136:139], a[104:107], v[244:247]
v_mfma_f32_16x16x32_bf16 v[244:247], a[140:143], a[108:111], v[244:247]
v_mfma_f32_16x16x32_bf16 v[248:251], a[136:139], a[112:115], v[248:251]
v_mfma_f32_16x16x32_bf16 v[248:251], a[140:143], a[116:119], v[248:251]
v_mfma_f32_16x16x32_bf16 v[252:255], a[136:139], a[120:123], v[252:255]
v_mfma_f32_16x16x32_bf16 v[252:255], a[140:143], a[124:127], v[252:255]
s_waitcnt lgkmcnt(0)
v_mfma_f32_16x16x32_bf16 v[36:39], a[128:131], a[0:3], v[36:39]
s_lshl_b32 s18, s3, 13
ds_read_b64_tr_b16 a[136:137], v23 offset:0
v_lshrrev_b32 v28, 6, v0
v_mfma_f32_16x16x32_bf16 v[36:39], a[132:135], a[4:7], v[36:39]
s_lshl_b32 s30, s20, 20
v_lshl_add_u32 v28, v28, 11, v1
v_add_u32 v28, 65536, v28
v_mfma_f32_16x16x32_bf16 v[44:47], a[128:131], a[8:11], v[44:47]
s_add_u32 s30, s30, s18
ds_read_b64_tr_b16 a[138:139], v23 offset:2048
v_lshrrev_b32 v3, 6, v0
v_mfma_f32_16x16x32_bf16 v[44:47], a[132:135], a[12:15], v[44:47]
s_lshl_b32 s22, s21, 1
v_and_b32 v4, 63, v0
v_add_u32 v2, 0x10000, v1
v_mfma_f32_16x16x32_bf16 v[52:55], a[128:131], a[16:19], v[52:55]
s_and_b32 s84, s2, 1
ds_read_b64_tr_b16 a[140:141], v23 offset:16384
v_and_b32 v5, 15, v4
v_mfma_f32_16x16x32_bf16 v[52:55], a[132:135], a[20:23], v[52:55]
s_mul_i32 s84, s84, 0
v_lshrrev_b32 v6, 4, v4
v_lshlrev_b32 v6, 2, v6
v_mfma_f32_16x16x32_bf16 v[60:63], a[128:131], a[24:27], v[60:63]
s_add_u32 s84, s84, 2386092
ds_read_b64_tr_b16 a[142:143], v23 offset:18432
v_sub_u32 v5, v5, v6
v_mfma_f32_16x16x32_bf16 v[60:63], a[132:135], a[28:31], v[60:63]
s_lshl_b32 s85, s21, 2
v_lshl_add_u32 v5, v3, 4, v5
v_cmp_gt_i32 s[32:33], 0, v5
v_mfma_f32_16x16x32_bf16 v[68:71], a[128:131], a[32:35], v[68:71]
s_lshr_b32 s85, s84, s85
v_cmp_gt_i32 s[34:35], 1, v5
v_cmp_gt_i32 s[36:37], 2, v5
v_mfma_f32_16x16x32_bf16 v[68:71], a[132:135], a[36:39], v[68:71]
s_and_b32 s9, s85, 15
v_cmp_gt_i32 s[38:39], 3, v5
v_cmp_gt_i32 s[40:41], 16, v5
v_mfma_f32_16x16x32_bf16 v[76:79], a[128:131], a[40:43], v[76:79]
s_and_b32 s84, s85, 1
v_cmp_gt_i32 s[42:43], 17, v5
v_cmp_gt_i32 s[44:45], 18, v5
v_mfma_f32_16x16x32_bf16 v[76:79], a[132:135], a[44:47], v[76:79]
s_lshl_b32 s84, s84, 17
v_cmp_gt_i32 s[46:47], 19, v5
v_cmp_gt_i32 s[48:49], 32, v5
v_mfma_f32_16x16x32_bf16 v[84:87], a[128:131], a[48:51], v[84:87]
s_add_u32 s84, s84, s18
v_cmp_gt_i32 s[50:51], 33, v5
v_cmp_gt_i32 s[52:53], 34, v5
v_mfma_f32_16x16x32_bf16 v[84:87], a[132:135], a[52:55], v[84:87]
s_xor_b32 s85, s84, 0x20000
v_cmp_gt_i32 s[54:55], 35, v5
v_cmp_gt_i32 s[56:57], 48, v5
v_mfma_f32_16x16x32_bf16 v[92:95], a[128:131], a[56:59], v[92:95]
s_sub_u32 s29, 15, s21
v_cmp_gt_i32 s[58:59], 49, v5
v_cmp_gt_i32 s[60:61], 50, v5
v_mfma_f32_16x16x32_bf16 v[92:95], a[132:135], a[60:63], v[92:95]
s_waitcnt lgkmcnt(0)
v_cmp_gt_i32 s[62:63], 51, v5
v_mov_b32 v7, 0xff800000
v_mfma_f32_16x16x32_bf16 v[100:103], a[136:139], a[0:3], v[100:103]
s_cmp_lg_u32 s9, 0
ds_read_b64_tr_b16 a[128:129], v24 offset:0
v_mov_b32 v6, 1
v_mfma_f32_16x16x32_bf16 v[100:103], a[140:143], a[4:7], v[100:103]
s_cselect_b32 s24, 1, 0
v_mov_b32 v5, v26
v_add_u32 v4, 0x20000, v1
v_mfma_f32_16x16x32_bf16 v[108:111], a[136:139], a[8:11], v[108:111]
s_cselect_b32 s67, s67, 3221225472
ds_read_b64_tr_b16 a[130:131], v24 offset:2048
v_mfma_f32_16x16x32_bf16 v[108:111], a[140:143], a[12:15], v[108:111]
s_lshl_b32 s8, s9, 15
v_mfma_f32_16x16x32_bf16 v[116:119], a[136:139], a[16:19], v[116:119]
s_add_u32 s8, s8, s30
ds_read_b64_tr_b16 a[132:133], v24 offset:16384
v_mfma_f32_16x16x32_bf16 v[116:119], a[140:143], a[20:23], v[116:119]
s_add_u32 s9, s9, s22
v_mfma_f32_16x16x32_bf16 v[124:127], a[136:139], a[24:27], v[124:127]
s_sub_u32 s9, 32, s9
ds_read_b64_tr_b16 a[134:135], v24 offset:18432
v_mul_f32 v36, s68, v36
v_mfma_f32_16x16x32_bf16 v[124:127], a[140:143], a[28:31], v[124:127]
s_bitcmp1_b32 s2, 4
v_mul_f32 v37, s68, v37
v_mul_f32 v38, s68, v38
v_mfma_f32_16x16x32_bf16 v[132:135], a[136:139], a[32:35], v[132:135]
s_cselect_b32 s9, 16, s9
v_mul_f32 v39, s68, v39
v_mul_f32 v100, s68, v100
v_mfma_f32_16x16x32_bf16 v[132:135], a[140:143], a[36:39], v[132:135]
s_cselect_b32 s29, 7, s29
v_mul_f32 v101, s68, v101
v_mul_f32 v102, s68, v102
v_mfma_f32_16x16x32_bf16 v[140:143], a[136:139], a[40:43], v[140:143]
s_mov_b32 s10, 3221225472
v_mul_f32 v103, s68, v103
v_cvt_pk_bf16_f32 v36, v36, v37
v_mfma_f32_16x16x32_bf16 v[140:143], a[140:143], a[44:47], v[140:143]
s_mov_b32 s14, 3221225472
v_cvt_pk_bf16_f32 v37, v38, v39
v_cvt_pk_bf16_f32 v38, v100, v101
v_mfma_f32_16x16x32_bf16 v[148:151], a[136:139], a[48:51], v[148:151]
s_mov_b32 s11, 0
v_cvt_pk_bf16_f32 v39, v102, v103
v_mul_f32 v44, s68, v44
v_mfma_f32_16x16x32_bf16 v[148:151], a[140:143], a[52:55], v[148:151]
s_lshr_b32 s19, s9, 1
ds_write_b128 v28, v[36:39] offset:0
v_mul_f32 v45, s68, v45
v_mfma_f32_16x16x32_bf16 v[156:159], a[136:139], a[56:59], v[156:159]
s_sub_u32 s19, s19, 1
s_add_u32 s23, s67, 0
buffer_store_dwordx4 v[36:39], v1, s[4:7], s23 offen offset:0 sc1
v_mfma_f32_16x16x32_bf16 v[156:159], a[140:143], a[60:63], v[156:159]
s_waitcnt lgkmcnt(1)
v_mul_f32 v46, s68, v46
v_mul_f32 v47, s68, v47
v_mfma_f32_16x16x32_bf16 v[164:167], a[128:131], a[0:3], v[164:167]
s_add_u32 s12, s8, 16777216
ds_read_b64_tr_b16 a[136:137], v25 offset:0
v_mul_f32 v108, s68, v108
v_mfma_f32_16x16x32_bf16 v[164:167], a[132:135], a[4:7], v[164:167]
s_mov_b32 s13, s9
v_mul_f32 v109, s68, v109
v_mul_f32 v110, s68, v110
v_mfma_f32_16x16x32_bf16 v[172:175], a[128:131], a[8:11], v[172:175]
s_mov_b32 s15, s11
ds_read_b64_tr_b16 a[138:139], v25 offset:2048
v_mul_f32 v111, s68, v111
v_mfma_f32_16x16x32_bf16 v[172:175], a[132:135], a[12:15], v[172:175]
v_cvt_pk_bf16_f32 v44, v44, v45
v_cvt_pk_bf16_f32 v45, v46, v47
v_mfma_f32_16x16x32_bf16 v[180:183], a[128:131], a[16:19], v[180:183]
ds_read_b64_tr_b16 a[140:141], v25 offset:16384
v_cvt_pk_bf16_f32 v46, v108, v109
v_mfma_f32_16x16x32_bf16 v[180:183], a[132:135], a[20:23], v[180:183]
v_cvt_pk_bf16_f32 v47, v110, v111
v_mul_f32 v52, s68, v52
v_mfma_f32_16x16x32_bf16 v[188:191], a[128:131], a[24:27], v[188:191]
ds_read_b64_tr_b16 a[142:143], v25 offset:18432
v_mul_f32 v53, s68, v53
v_mfma_f32_16x16x32_bf16 v[188:191], a[132:135], a[28:31], v[188:191]
ds_write_b128 v28, v[44:47] offset:8192
v_mul_f32 v54, s68, v54
v_mfma_f32_16x16x32_bf16 v[196:199], a[128:131], a[32:35], v[196:199]
s_add_u32 s23, s67, 8192
buffer_store_dwordx4 v[44:47], v1, s[4:7], s23 offen offset:0 sc1
v_mfma_f32_16x16x32_bf16 v[196:199], a[132:135], a[36:39], v[196:199]
v_mul_f32 v55, s68, v55
v_mul_f32 v116, s68, v116
v_mfma_f32_16x16x32_bf16 v[204:207], a[128:131], a[40:43], v[204:207]
v_mul_f32 v117, s68, v117
v_mul_f32 v118, s68, v118
v_mfma_f32_16x16x32_bf16 v[204:207], a[132:135], a[44:47], v[204:207]
v_mul_f32 v119, s68, v119
v_cvt_pk_bf16_f32 v52, v52, v53
v_mfma_f32_16x16x32_bf16 v[212:215], a[128:131], a[48:51], v[212:215]
v_cvt_pk_bf16_f32 v53, v54, v55
v_cvt_pk_bf16_f32 v54, v116, v117
v_mfma_f32_16x16x32_bf16 v[212:215], a[132:135], a[52:55], v[212:215]
v_cvt_pk_bf16_f32 v55, v118, v119
v_mul_f32 v60, s68, v60
v_mfma_f32_16x16x32_bf16 v[220:223], a[128:131], a[56:59], v[220:223]
ds_write_b128 v28, v[52:55] offset:16384
v_mul_f32 v61, s68, v61
v_mfma_f32_16x16x32_bf16 v[220:223], a[132:135], a[60:63], v[220:223]
s_waitcnt lgkmcnt(0)
s_waitcnt lgkmcnt(0)
s_barrier
v_mfma_f32_16x16x32_bf16 v[224:227], a[136:139], a[0:3], v[224:227]
s_add_u32 s23, s67, 16384
buffer_store_dwordx4 v[52:55], v1, s[4:7], s23 offen offset:0 sc1
v_mfma_f32_16x16x32_bf16 v[224:227], a[140:143], a[4:7], v[224:227]
v_mul_f32 v62, s68, v62
v_mul_f32 v63, s68, v63
v_mfma_f32_16x16x32_bf16 v[228:231], a[136:139], a[8:11], v[228:231]
v_mul_f32 v124, s68, v124
v_mul_f32 v125, s68, v125
v_mfma_f32_16x16x32_bf16 v[228:231], a[140:143], a[12:15], v[228:231]
v_mul_f32 v126, s68, v126
v_mul_f32 v127, s68, v127
v_mfma_f32_16x16x32_bf16 v[232:235], a[136:139], a[16:19], v[232:235]
v_cvt_pk_bf16_f32 v60, v60, v61
v_cvt_pk_bf16_f32 v61, v62, v63
v_mfma_f32_16x16x32_bf16 v[232:235], a[140:143], a[20:23], v[232:235]
v_cvt_pk_bf16_f32 v62, v124, v125
v_cvt_pk_bf16_f32 v63, v126, v127
v_mfma_f32_16x16x32_bf16 v[236:239], a[136:139], a[24:27], v[236:239]
ds_write_b128 v28, v[60:63] offset:24576
v_mul_f32 v68, s68, v68
v_mfma_f32_16x16x32_bf16 v[236:239], a[140:143], a[28:31], v[236:239]
s_add_u32 s23, s67, 24576
buffer_store_dwordx4 v[60:63], v1, s[4:7], s23 offen offset:0 sc1
v_mfma_f32_16x16x32_bf16 v[240:243], a[136:139], a[32:35], v[240:243]
v_mul_f32 v69, s68, v69
v_mul_f32 v70, s68, v70
v_mfma_f32_16x16x32_bf16 v[240:243], a[140:143], a[36:39], v[240:243]
v_mul_f32 v71, s68, v71
v_mul_f32 v132, s68, v132
v_mfma_f32_16x16x32_bf16 v[244:247], a[136:139], a[40:43], v[244:247]
v_mul_f32 v133, s68, v133
v_mul_f32 v134, s68, v134
v_mfma_f32_16x16x32_bf16 v[244:247], a[140:143], a[44:47], v[244:247]
v_mul_f32 v135, s68, v135
v_cvt_pk_bf16_f32 v68, v68, v69
v_mfma_f32_16x16x32_bf16 v[248:251], a[136:139], a[48:51], v[248:251]
v_cvt_pk_bf16_f32 v69, v70, v71
v_cvt_pk_bf16_f32 v70, v132, v133
v_mfma_f32_16x16x32_bf16 v[248:251], a[140:143], a[52:55], v[248:251]
v_cvt_pk_bf16_f32 v71, v134, v135
v_mfma_f32_16x16x32_bf16 v[252:255], a[136:139], a[56:59], v[252:255]
ds_write_b128 v28, v[68:71] offset:32768
v_mfma_f32_16x16x32_bf16 v[252:255], a[140:143], a[60:63], v[252:255]
s_add_u32 s23, s67, 32768
buffer_store_dwordx4 v[68:71], v1, s[4:7], s23 offen offset:0 sc1
buffer_load_dword v21, v20, s[4:7], s70 offen sc1
v_pk_mul_f32 v[76:77], v[76:77], s[68:69]
v_pk_mul_f32 v[78:79], v[78:79], s[68:69]
v_pk_mul_f32 v[140:141], v[140:141], s[68:69]
v_pk_mul_f32 v[142:143], v[142:143], s[68:69]
v_cvt_pk_bf16_f32 v76, v76, v77
v_cvt_pk_bf16_f32 v77, v78, v79
v_cvt_pk_bf16_f32 v78, v140, v141
v_cvt_pk_bf16_f32 v79, v142, v143
ds_write_b128 v28, v[76:79] offset:40960
s_add_u32 s23, s67, 40960
buffer_store_dwordx4 v[76:79], v1, s[4:7], s23 offen offset:0 sc1
v_pk_mul_f32 v[84:85], v[84:85], s[68:69]
v_pk_mul_f32 v[86:87], v[86:87], s[68:69]
v_pk_mul_f32 v[148:149], v[148:149], s[68:69]
v_pk_mul_f32 v[150:151], v[150:151], s[68:69]
v_cvt_pk_bf16_f32 v84, v84, v85
v_cvt_pk_bf16_f32 v85, v86, v87
v_cvt_pk_bf16_f32 v86, v148, v149
v_cvt_pk_bf16_f32 v87, v150, v151
ds_write_b128 v28, v[84:87] offset:49152
s_add_u32 s23, s67, 49152
buffer_store_dwordx4 v[84:87], v1, s[4:7], s23 offen offset:0 sc1
v_pk_mul_f32 v[92:93], v[92:93], s[68:69]
v_pk_mul_f32 v[94:95], v[94:95], s[68:69]
v_pk_mul_f32 v[156:157], v[156:157], s[68:69]
v_pk_mul_f32 v[158:159], v[158:159], s[68:69]
v_cvt_pk_bf16_f32 v92, v92, v93
v_cvt_pk_bf16_f32 v93, v94, v95
v_cvt_pk_bf16_f32 v94, v156, v157
v_cvt_pk_bf16_f32 v95, v158, v159
ds_write_b128 v28, v[92:95] offset:57344
s_add_u32 s23, s67, 57344
buffer_store_dwordx4 v[92:95], v1, s[4:7], s23 offen offset:0 sc1
v_pk_mul_f32 v[164:165], v[164:165], s[68:69]
v_pk_mul_f32 v[166:167], v[166:167], s[68:69]
v_pk_mul_f32 v[224:225], v[224:225], s[68:69]
v_pk_mul_f32 v[226:227], v[226:227], s[68:69]
v_cvt_pk_bf16_f32 v164, v164, v165
v_cvt_pk_bf16_f32 v165, v166, v167
v_cvt_pk_bf16_f32 v166, v224, v225
v_cvt_pk_bf16_f32 v167, v226, v227
ds_write_b128 v28, v[164:167] offset:1024
s_add_u32 s23, s67, 0
buffer_store_dwordx4 v[164:167], v1, s[4:7], s23 offen offset:1024 sc1
v_pk_mul_f32 v[172:173], v[172:173], s[68:69]
v_pk_mul_f32 v[174:175], v[174:175], s[68:69]
v_pk_mul_f32 v[228:229], v[228:229], s[68:69]
v_pk_mul_f32 v[230:231], v[230:231], s[68:69]
v_cvt_pk_bf16_f32 v172, v172, v173
v_cvt_pk_bf16_f32 v173, v174, v175
v_cvt_pk_bf16_f32 v174, v228, v229
v_cvt_pk_bf16_f32 v175, v230, v231
ds_write_b128 v28, v[172:175] offset:9216
s_add_u32 s23, s67, 8192
buffer_store_dwordx4 v[172:175], v1, s[4:7], s23 offen offset:1024 sc1
v_pk_mul_f32 v[180:181], v[180:181], s[68:69]
v_pk_mul_f32 v[182:183], v[182:183], s[68:69]
v_pk_mul_f32 v[232:233], v[232:233], s[68:69]
v_pk_mul_f32 v[234:235], v[234:235], s[68:69]
v_cvt_pk_bf16_f32 v180, v180, v181
v_cvt_pk_bf16_f32 v181, v182, v183
v_cvt_pk_bf16_f32 v182, v232, v233
v_cvt_pk_bf16_f32 v183, v234, v235
ds_write_b128 v28, v[180:183] offset:17408
s_add_u32 s23, s67, 16384
buffer_store_dwordx4 v[180:183], v1, s[4:7], s23 offen offset:1024 sc1
v_pk_mul_f32 v[188:189], v[188:189], s[68:69]
v_pk_mul_f32 v[190:191], v[190:191], s[68:69]
v_pk_mul_f32 v[236:237], v[236:237], s[68:69]
v_pk_mul_f32 v[238:239], v[238:239], s[68:69]
v_cvt_pk_bf16_f32 v188, v188, v189
v_cvt_pk_bf16_f32 v189, v190, v191
v_cvt_pk_bf16_f32 v190, v236, v237
v_cvt_pk_bf16_f32 v191, v238, v239
ds_write_b128 v28, v[188:191] offset:25600
s_add_u32 s23, s67, 24576
buffer_store_dwordx4 v[188:191], v1, s[4:7], s23 offen offset:1024 sc1
v_pk_mul_f32 v[196:197], v[196:197], s[68:69]
v_pk_mul_f32 v[198:199], v[198:199], s[68:69]
PAD_8:
s_cbranch_execz M_tret
v_pk_mul_f32 v[240:241], v[240:241], s[68:69]
v_pk_mul_f32 v[242:243], v[242:243], s[68:69]
v_cvt_pk_bf16_f32 v196, v196, v197
v_cvt_pk_bf16_f32 v197, v198, v199
v_cvt_pk_bf16_f32 v198, v240, v241
v_cvt_pk_bf16_f32 v199, v242, v243
ds_write_b128 v28, v[196:199] offset:33792
s_add_u32 s23, s67, 32768
buffer_store_dwordx4 v[196:199], v1, s[4:7], s23 offen offset:1024 sc1
v_pk_mul_f32 v[204:205], v[204:205], s[68:69]
v_pk_mul_f32 v[206:207], v[206:207], s[68:69]
v_pk_mul_f32 v[244:245], v[244:245], s[68:69]
v_pk_mul_f32 v[246:247], v[246:247], s[68:69]
v_cvt_pk_bf16_f32 v204, v204, v205
v_cvt_pk_bf16_f32 v205, v206, v207
v_cvt_pk_bf16_f32 v206, v244, v245
v_cvt_pk_bf16_f32 v207, v246, v247
ds_write_b128 v28, v[204:207] offset:41984
s_add_u32 s23, s67, 40960
buffer_store_dwordx4 v[204:207], v1, s[4:7], s23 offen offset:1024 sc1
v_pk_mul_f32 v[212:213], v[212:213], s[68:69]
v_pk_mul_f32 v[214:215], v[214:215], s[68:69]
v_pk_mul_f32 v[248:249], v[248:249], s[68:69]
v_pk_mul_f32 v[250:251], v[250:251], s[68:69]
v_cvt_pk_bf16_f32 v212, v212, v213
v_cvt_pk_bf16_f32 v213, v214, v215
v_cvt_pk_bf16_f32 v214, v248, v249
v_cvt_pk_bf16_f32 v215, v250, v251
ds_write_b128 v28, v[212:215] offset:50176
s_add_u32 s23, s67, 49152
buffer_store_dwordx4 v[212:215], v1, s[4:7], s23 offen offset:1024 sc1
v_pk_mul_f32 v[220:221], v[220:221], s[68:69]
v_pk_mul_f32 v[222:223], v[222:223], s[68:69]
v_pk_mul_f32 v[252:253], v[252:253], s[68:69]
v_pk_mul_f32 v[254:255], v[254:255], s[68:69]
v_cvt_pk_bf16_f32 v220, v220, v221
v_cvt_pk_bf16_f32 v221, v222, v223
v_cvt_pk_bf16_f32 v222, v252, v253
v_cvt_pk_bf16_f32 v223, v254, v255
ds_write_b128 v28, v[220:223] offset:58368
s_add_u32 s23, s67, 57344
buffer_store_dwordx4 v[220:223], v1, s[4:7], s23 offen offset:1024 sc1
s_waitcnt vmcnt(11)
v_cmp_gt_u32 vcc, 1, v21
s_cbranch_vccnz M_kspin
M_kok:
buffer_load_dword v21, v15, s[4:7], s70 offen sc1
s_mov_b32 m0, s84
s_nop 0
buffer_load_dwordx4 v1, s[4:7], s8 offen offset:0 sc1 lds
buffer_load_dwordx4 v1, s[4:7], s8 offen offset:1024 sc1 lds
buffer_load_dwordx4 v1, s[4:7], s8 offen offset:2048 sc1 lds
buffer_load_dwordx4 v1, s[4:7], s8 offen offset:3072 sc1 lds
s_add_u32 s8, s8, 4096
s_add_u32 m0, s84, 4096
s_nop 0
buffer_load_dwordx4 v1, s[4:7], s8 offen offset:0 sc1 lds
buffer_load_dwordx4 v1, s[4:7], s8 offen offset:1024 sc1 lds
buffer_load_dwordx4 v1, s[4:7], s8 offen offset:2048 sc1 lds
buffer_load_dwordx4 v1, s[4:7], s8 offen offset:3072 sc1 lds
s_add_u32 s8, s8, 28672
s_sub_u32 s9, s9, 1
s_cmp_eq_u32 s9, 0
s_cselect_b32 s8, s10, s8
s_cselect_b32 s9, s11, s9
s_cselect_b32 s10, 3221225472, s10
v_add_u32 v28, s18, v2
s_waitcnt lgkmcnt(0)
s_barrier
ds_read_b128 a[0:3], v28 offset:0
ds_read_b128 a[4:7], v28 offset:1024
ds_read_b128 a[8:11], v28 offset:2048
ds_read_b128 a[12:15], v28 offset:3072
ds_read_b128 a[16:19], v28 offset:4096
ds_read_b128 a[20:23], v28 offset:5120
ds_read_b128 a[24:27], v28 offset:6144
ds_read_b128 a[28:31], v28 offset:7168
ds_read_b128 a[32:35], v28 offset:32768
ds_read_b128 a[36:39], v28 offset:33792
ds_read_b128 a[40:43], v28 offset:34816
ds_read_b128 a[44:47], v28 offset:35840
ds_read_b128 a[48:51], v28 offset:36864
ds_read_b128 a[52:55], v28 offset:37888
ds_read_b128 a[56:59], v28 offset:38912
ds_read_b128 a[60:63], v28 offset:39936
s_mov_b32 m0, s85
s_nop 0
buffer_load_dwordx4 v1, s[4:7], s8 offen offset:0 sc1 lds
buffer_load_dwordx4 v1, s[4:7], s8 offen offset:1024 sc1 lds
buffer_load_dwordx4 v1, s[4:7], s8 offen offset:2048 sc1 lds
buffer_load_dwordx4 v1, s[4:7], s8 offen offset:3072 sc1 lds
s_add_u32 s8, s8, 4096
s_add_u32 m0, s85, 4096
s_nop 0
buffer_load_dwordx4 v1, s[4:7], s8 offen offset:0 sc1 lds
buffer_load_dwordx4 v1, s[4:7], s8 offen offset:1024 sc1 lds
buffer_load_dwordx4 v1, s[4:7], s8 offen offset:2048 sc1 lds
buffer_load_dwordx4 v1, s[4:7], s8 offen offset:3072 sc1 lds
s_add_u32 s8, s8, 28672
s_sub_u32 s9, s9, 1
s_cmp_eq_u32 s9, 0
s_cselect_b32 s8, s10, s8
s_cselect_b32 s9, s11, s9
s_cselect_b32 s10, 3221225472, s10
s_mov_b32 s25, 1266679808
s_lshl_b32 s22, s21, 3
s_xor_b32 s28, s70, 256
s_add_u32 s28, s28, s22
s_add_u32 s28, s28, 6148
s_lshl_b32 s26, s21, 16
s_add_u32 s26, s26, s30
s_add_u32 s26, s26, 33554432
s_xor_b32 s76, s20, 0
s_lshl_b32 s76, s76, 3
s_add_u32 s76, s76, s21
s_lshl_b32 s76, s76, 2
s_add_u32 s76, s76, s3
s_lshl_b32 s27, s76, 10
s_add_u32 s27, s27, 75497472
s_lshl_b32 s76, s76, 14
s_add_u32 s76, s76, 67108864
s_lshl_b32 s81, s20, 2
s_add_u32 s81, s81, s3
s_mul_i32 s81, s81, 57344
s_cmp_eq_u32 s24, 1
s_cselect_b32 s80, s28, s70
s_add_u32 s77, s76, 8192
v_lshrrev_b32 v8, 7, v1
v_and_b32 v9, 6, v8
v_lshlrev_b32 v9, 4, v9
v_and_b32 v10, 0x70, v1
v_xor_b32 v9, v9, v10
v_mul_u32_u24 v8, 896, v8
v_add_u32 v8, v8, v9
v_accvgpr_write_b32 a184, v8
v_add_u32 v8, 6144, v8
v_accvgpr_write_b32 a185, v8
v_add_u32 v8, 6144, v8
v_accvgpr_write_b32 a186, v8
v_add_u32 v8, 6144, v8
v_accvgpr_write_b32 a187, v8
v_lshrrev_b32 v8, 6, v1
v_bfe_u32 v9, v1, 7, 2
v_lshlrev_b32 v9, 5, v9
v_lshl_add_u32 v8, v8, 7, v9
v_bfe_u32 v9, v1, 4, 2
v_lshl_add_u32 v8, v9, 3, v8
v_add_u32 v8, 32768, v8
v_accvgpr_write_b32 a188, v8
v_xor_b32 v9, 32, v8
v_accvgpr_write_b32 a189, v9
v_xor_b32 v9, 64, v8
v_accvgpr_write_b32 a190, v9
v_xor_b32 v9, 96, v8
v_accvgpr_write_b32 a191, v9
s_add_u32 s22, s66, 16384
s_mov_b32 s71, 3221225472
s_waitcnt vmcnt(17)
s_barrier
buffer_store_dword v6, v5, s[4:7], s22 offen sc1
v_mov_b64 v[128:129], 0
v_mov_b64 v[130:131], 0
v_mov_b64 v[132:133], 0
v_mov_b64 v[134:135], 0
v_mov_b64 v[136:137], 0
v_mov_b64 v[138:139], 0
v_mov_b64 v[140:141], 0
v_mov_b64 v[142:143], 0
v_mov_b64 v[144:145], 0
v_mov_b64 v[146:147], 0
v_mov_b64 v[148:149], 0
v_mov_b64 v[150:151], 0
v_mov_b64 v[152:153], 0
v_mov_b64 v[154:155], 0
v_mov_b64 v[156:157], 0
v_mov_b64 v[158:159], 0
v_mov_b64 v[160:161], 0
v_mov_b64 v[162:163], 0
v_mov_b64 v[164:165], 0
v_mov_b64 v[166:167], 0
v_mov_b64 v[168:169], 0
v_mov_b64 v[170:171], 0
v_mov_b64 v[172:173], 0
v_mov_b64 v[174:175], 0
v_mov_b64 v[176:177], 0
v_mov_b64 v[178:179], 0
v_mov_b64 v[180:181], 0
v_mov_b64 v[182:183], 0
v_mov_b64 v[184:185], 0
v_mov_b64 v[186:187], 0
v_mov_b64 v[188:189], 0
v_mov_b64 v[190:191], 0
v_mov_b64 v[192:193], 0
v_mov_b64 v[194:195], 0
v_mov_b64 v[196:197], 0
v_mov_b64 v[198:199], 0
v_mov_b64 v[200:201], 0
v_mov_b64 v[202:203], 0
v_mov_b64 v[204:205], 0
v_mov_b64 v[206:207], 0
v_mov_b64 v[208:209], 0
v_mov_b64 v[210:211], 0
v_mov_b64 v[212:213], 0
v_mov_b64 v[214:215], 0
v_mov_b64 v[216:217], 0
v_mov_b64 v[218:219], 0
v_mov_b64 v[220:221], 0
v_mov_b64 v[222:223], 0
v_mov_b64 v[224:225], 0
v_mov_b64 v[226:227], 0
v_mov_b64 v[228:229], 0
v_mov_b64 v[230:231], 0
v_mov_b64 v[232:233], 0
v_mov_b64 v[234:235], 0
v_mov_b64 v[236:237], 0
v_mov_b64 v[238:239], 0
v_mov_b64 v[240:241], 0
v_mov_b64 v[242:243], 0
v_mov_b64 v[244:245], 0
v_mov_b64 v[246:247], 0
v_mov_b64 v[248:249], 0
v_mov_b64 v[250:251], 0
v_mov_b64 v[252:253], 0
v_mov_b64 v[254:255], 0
v_mov_b64 v[24:25], 0
s_cmp_eq_u32 s24, 9
s_cbranch_scc1 M_t2A
M_t2Ar:
s_waitcnt vmcnt(9) lgkmcnt(0)
v_cmp_gt_u32 vcc, 1, v21
s_cbranch_vccnz M_vspin
M_vok:
s_barrier
K2_item:
PAD_9:
s_cbranch_execz M_tret
s_cmp_eq_u32 s19, 0
s_cbranch_scc1 K2_p0d
ds_read_b128 a[64:67], v1 offset:0
ds_read_b128 a[68:71], v1 offset:1024
ds_read_b128 a[72:75], v1 offset:2048
ds_read_b128 a[76:79], v1 offset:3072
ds_read_b128 a[80:83], v1 offset:4096
ds_read_b128 a[84:87], v1 offset:5120
ds_read_b128 a[88:91], v1 offset:6144
ds_read_b128 a[92:95], v1 offset:7168
s_waitcnt lgkmcnt(7)
v_mfma_f32_16x16x32_bf16 v[32:35], a[64:67], a[0:3], 0
s_waitcnt lgkmcnt(6)
s_add_u32 m0, s18, 65536
ds_read_b128 a[96:99], v1 offset:8192
v_mfma_f32_16x16x32_bf16 v[32:35], a[68:71], a[4:7], v[32:35]
s_waitcnt lgkmcnt(6)
buffer_load_dwordx4 v1, s[4:7], s12 offen offset:0 sc1 lds
v_mfma_f32_16x16x32_bf16 v[32:35], a[72:75], a[8:11], v[32:35]
s_waitcnt lgkmcnt(5)
ds_read_b128 a[100:103], v1 offset:9216
v_mfma_f32_16x16x32_bf16 v[32:35], a[76:79], a[12:15], v[32:35]
s_waitcnt lgkmcnt(5)
buffer_load_dwordx4 v1, s[4:7], s12 offen offset:1024 sc1 lds
v_mfma_f32_16x16x32_bf16 v[32:35], a[80:83], a[16:19], v[32:35]
s_waitcnt lgkmcnt(4)
ds_read_b128 a[104:107], v1 offset:10240
v_mfma_f32_16x16x32_bf16 v[32:35], a[84:87], a[20:23], v[32:35]
s_waitcnt lgkmcnt(4)
buffer_load_dwordx4 v1, s[4:7], s12 offen offset:2048 sc1 lds
v_mfma_f32_16x16x32_bf16 v[32:35], a[88:91], a[24:27], v[32:35]
s_waitcnt lgkmcnt(3)
ds_read_b128 a[108:111], v1 offset:11264
v_mfma_f32_16x16x32_bf16 v[32:35], a[92:95], a[28:31], v[32:35]
buffer_load_dwordx4 v1, s[4:7], s12 offen offset:3072 sc1 lds
v_mfma_f32_16x16x32_bf16 v[36:39], a[64:67], a[32:35], 0
s_add_u32 s12, s12, 4096
s_add_u32 m0, s18, 69632
ds_read_b128 a[112:115], v1 offset:12288
v_mfma_f32_16x16x32_bf16 v[36:39], a[68:71], a[36:39], v[36:39]
buffer_load_dwordx4 v1, s[4:7], s12 offen offset:0 sc1 lds
v_mfma_f32_16x16x32_bf16 v[36:39], a[72:75], a[40:43], v[36:39]
ds_read_b128 a[116:119], v1 offset:13312
v_mfma_f32_16x16x32_bf16 v[36:39], a[76:79], a[44:47], v[36:39]
buffer_load_dwordx4 v1, s[4:7], s12 offen offset:1024 sc1 lds
v_mfma_f32_16x16x32_bf16 v[36:39], a[80:83], a[48:51], v[36:39]
ds_read_b128 a[120:123], v1 offset:14336
v_max3_f32 v28, v32, v33, v34
v_mfma_f32_16x16x32_bf16 v[36:39], a[84:87], a[52:55], v[36:39]
buffer_load_dwordx4 v1, s[4:7], s12 offen offset:2048 sc1 lds
v_mfma_f32_16x16x32_bf16 v[36:39], a[88:91], a[56:59], v[36:39]
ds_read_b128 a[124:127], v1 offset:15360
v_max_f32 v28, v28, v35
v_mfma_f32_16x16x32_bf16 v[36:39], a[92:95], a[60:63], v[36:39]
s_waitcnt lgkmcnt(4)
buffer_load_dwordx4 v1, s[4:7], s12 offen offset:3072 sc1 lds
v_mfma_f32_16x16x32_bf16 v[40:43], a[96:99], a[0:3], 0
s_add_u32 s12, s12, 28672
ds_read_b128 a[64:67], v1 offset:16384
v_mov_b32 v30, v28
v_mfma_f32_16x16x32_bf16 v[40:43], a[100:103], a[4:7], v[40:43]
s_waitcnt lgkmcnt(2)
s_sub_u32 s13, s13, 1
v_mfma_f32_16x16x32_bf16 v[40:43], a[104:107], a[8:11], v[40:43]
s_cmp_eq_u32 s13, 0
ds_read_b128 a[68:71], v1 offset:17408
v_permlane16_swap_b32 v28, v30
v_mfma_f32_16x16x32_bf16 v[40:43], a[108:111], a[12:15], v[40:43]
s_cselect_b32 s12, s14, s12
v_max_f32 v28, v28, v30
v_mov_b32 v30, v28
v_mfma_f32_16x16x32_bf16 v[40:43], a[112:115], a[16:19], v[40:43]
s_cselect_b32 s13, s15, s13
ds_read_b128 a[72:75], v1 offset:18432
v_max3_f32 v29, v36, v37, v38
v_mfma_f32_16x16x32_bf16 v[40:43], a[116:119], a[20:23], v[40:43]
s_cselect_b32 s14, 3221225472, s14
v_permlane32_swap_b32 v28, v30
v_max_f32 v28, v28, v30
v_mfma_f32_16x16x32_bf16 v[40:43], a[120:123], a[24:27], v[40:43]
s_waitcnt lgkmcnt(3)
ds_read_b128 a[76:79], v1 offset:19456
v_sub_f32 v16, 0, v28
v_mfma_f32_16x16x32_bf16 v[40:43], a[124:127], a[28:31], v[40:43]
v_sub_f32 v17, 0, v28
v_sub_f32 v18, 0, v28
v_mfma_f32_16x16x32_bf16 v[44:47], a[96:99], a[32:35], 0
ds_read_b128 a[80:83], v1 offset:20480
v_sub_f32 v19, 0, v28
v_mfma_f32_16x16x32_bf16 v[44:47], a[100:103], a[36:39], v[44:47]
v_max_f32 v29, v29, v39
v_mov_b32 v31, v29
v_mfma_f32_16x16x32_bf16 v[44:47], a[104:107], a[40:43], v[44:47]
ds_read_b128 a[84:87], v1 offset:21504
v_mfma_f32_16x16x32_bf16 v[44:47], a[108:111], a[44:47], v[44:47]
v_permlane16_swap_b32 v29, v31
v_max_f32 v29, v29, v31
v_mfma_f32_16x16x32_bf16 v[44:47], a[112:115], a[48:51], v[44:47]
ds_read_b128 a[88:91], v1 offset:22528
v_mov_b32 v31, v29
v_mfma_f32_16x16x32_bf16 v[44:47], a[116:119], a[52:55], v[44:47]
v_mfma_f32_16x16x32_bf16 v[44:47], a[120:123], a[56:59], v[44:47]
ds_read_b128 a[92:95], v1 offset:23552
v_permlane32_swap_b32 v29, v31
v_mfma_f32_16x16x32_bf16 v[44:47], a[124:127], a[60:63], v[44:47]
s_waitcnt lgkmcnt(4)
v_max_f32 v29, v29, v31
v_sub_f32 v20, 0, v29
v_mfma_f32_16x16x32_bf16 v[48:51], a[64:67], a[0:3], v[16:19]
ds_read_b128 a[96:99], v1 offset:24576
v_sub_f32 v21, 0, v29
v_mfma_f32_16x16x32_bf16 v[48:51], a[68:71], a[4:7], v[48:51]
v_sub_f32 v22, 0, v29
v_sub_f32 v23, 0, v29
v_mfma_f32_16x16x32_bf16 v[48:51], a[72:75], a[8:11], v[48:51]
ds_read_b128 a[100:103], v1 offset:25600
v_mfma_f32_16x16x32_bf16 v[48:51], a[76:79], a[12:15], v[48:51]
s_waitcnt lgkmcnt(4)
v_mfma_f32_16x16x32_bf16 v[48:51], a[80:83], a[16:19], v[48:51]
ds_read_b128 a[104:107], v1 offset:26624
v_mfma_f32_16x16x32_bf16 v[48:51], a[84:87], a[20:23], v[48:51]
s_waitcnt lgkmcnt(4)
v_add_f32 v32, v32, v16
v_add_f32 v33, v33, v16
v_add_f32 v34, v34, v16
v_add_f32 v35, v35, v16
v_mfma_f32_16x16x32_bf16 v[48:51], a[88:91], a[24:27], v[48:51]
s_waitcnt lgkmcnt(3)
ds_read_b128 a[108:111], v1 offset:27648
v_add_f32 v36, v36, v20
v_add_f32 v37, v37, v20
v_add_f32 v38, v38, v20
v_add_f32 v39, v39, v20
v_mfma_f32_16x16x32_bf16 v[48:51], a[92:95], a[28:31], v[48:51]
v_add_f32 v40, v40, v16
v_add_f32 v41, v41, v16
v_add_f32 v42, v42, v16
v_add_f32 v43, v43, v16
v_mfma_f32_16x16x32_bf16 v[52:55], a[64:67], a[32:35], v[20:23]
ds_read_b128 a[112:115], v1 offset:28672
v_add_f32 v44, v44, v20
v_add_f32 v45, v45, v20
v_add_f32 v46, v46, v20
v_add_f32 v47, v47, v20
v_mfma_f32_16x16x32_bf16 v[52:55], a[68:71], a[36:39], v[52:55]
v_exp_f32 v8, v32
v_mfma_f32_16x16x32_bf16 v[52:55], a[72:75], a[40:43], v[52:55]
ds_read_b128 a[116:119], v1 offset:29696
v_exp_f32 v9, v33
v_mfma_f32_16x16x32_bf16 v[52:55], a[76:79], a[44:47], v[52:55]
v_exp_f32 v10, v34
v_add_f32 v26, v8, v9
v_cvt_pk_bf16_f32 v96, v8, v9
v_mfma_f32_16x16x32_bf16 v[52:55], a[80:83], a[48:51], v[52:55]
ds_read_b128 a[120:123], v1 offset:30720
v_exp_f32 v11, v35
v_add_f32 v26, v26, v10
v_mfma_f32_16x16x32_bf16 v[52:55], a[84:87], a[52:55], v[52:55]
v_exp_f32 v12, v36
v_add_f32 v26, v26, v11
v_cvt_pk_bf16_f32 v97, v10, v11
v_mfma_f32_16x16x32_bf16 v[52:55], a[88:91], a[56:59], v[52:55]
s_waitcnt vmcnt(8) lgkmcnt(4)
ds_read_b128 a[124:127], v1 offset:31744
v_exp_f32 v13, v37
v_mfma_f32_16x16x32_bf16 v[52:55], a[92:95], a[60:63], v[52:55]
s_barrier
v_mfma_f32_16x16x32_bf16 v[56:59], a[96:99], a[0:3], v[16:19]
ds_read_b128 a[64:67], v4 offset:0
v_exp_f32 v14, v38
v_mfma_f32_16x16x32_bf16 v[56:59], a[100:103], a[4:7], v[56:59]
buffer_store_dword v6, v5, s[4:7], s71 offen sc1
v_mfma_f32_16x16x32_bf16 v[56:59], a[104:107], a[8:11], v[56:59]
s_waitcnt lgkmcnt(4)
ds_read_b128 a[68:71], v4 offset:1024
v_add_f32 v27, v12, v13
v_cvt_pk_bf16_f32 v104, v12, v13
v_add_f32 v27, v27, v14
v_mfma_f32_16x16x32_bf16 v[56:59], a[108:111], a[12:15], v[56:59]
v_exp_f32 v15, v39
v_mfma_f32_16x16x32_bf16 v[56:59], a[112:115], a[16:19], v[56:59]
s_waitcnt lgkmcnt(4)
ds_read_b128 a[72:75], v4 offset:2048
v_exp_f32 v8, v40
v_add_f32 v27, v27, v15
v_cvt_pk_bf16_f32 v105, v14, v15
v_mfma_f32_16x16x32_bf16 v[56:59], a[116:119], a[20:23], v[56:59]
s_waitcnt lgkmcnt(4)
v_exp_f32 v9, v41
v_add_f32 v26, v26, v8
v_mfma_f32_16x16x32_bf16 v[56:59], a[120:123], a[24:27], v[56:59]
s_waitcnt lgkmcnt(3)
ds_read_b128 a[76:79], v4 offset:3072
v_exp_f32 v10, v42
v_add_f32 v26, v26, v9
v_cvt_pk_bf16_f32 v98, v8, v9
v_mfma_f32_16x16x32_bf16 v[56:59], a[124:127], a[28:31], v[56:59]
v_exp_f32 v11, v43
v_add_f32 v26, v26, v10
v_mfma_f32_16x16x32_bf16 v[60:63], a[96:99], a[32:35], v[20:23]
ds_read_b128 a[80:83], v4 offset:4096
v_exp_f32 v12, v44
v_mfma_f32_16x16x32_bf16 v[60:63], a[100:103], a[36:39], v[60:63]
v_exp_f32 v13, v45
v_mfma_f32_16x16x32_bf16 v[60:63], a[104:107], a[40:43], v[60:63]
ds_read_b128 a[84:87], v4 offset:5120
v_exp_f32 v14, v46
v_mfma_f32_16x16x32_bf16 v[60:63], a[108:111], a[44:47], v[60:63]
v_exp_f32 v15, v47
v_mfma_f32_16x16x32_bf16 v[60:63], a[112:115], a[48:51], v[60:63]
ds_read_b128 a[88:91], v4 offset:6144
v_add_f32 v26, v26, v11
v_cvt_pk_bf16_f32 v99, v10, v11
v_mfma_f32_16x16x32_bf16 v[60:63], a[116:119], a[52:55], v[60:63]
v_add_f32 v27, v27, v12
v_add_f32 v27, v27, v13
v_cvt_pk_bf16_f32 v106, v12, v13
v_mfma_f32_16x16x32_bf16 v[60:63], a[120:123], a[56:59], v[60:63]
s_waitcnt lgkmcnt(7)
s_barrier
ds_read_b128 a[92:95], v4 offset:7168
v_mfma_f32_16x16x32_bf16 v[60:63], a[124:127], a[60:63], v[60:63]
s_waitcnt lgkmcnt(4)
v_add_f32 v27, v27, v14
v_add_f32 v27, v27, v15
v_cvt_pk_bf16_f32 v107, v14, v15
K2_x1:
v_mfma_f32_16x16x32_bf16 v[64:67], a[64:67], a[0:3], v[16:19]
s_add_u32 m0, s18, 0
ds_read_b128 a[96:99], v4 offset:8192
v_mfma_f32_16x16x32_bf16 v[64:67], a[68:71], a[4:7], v[64:67]
s_waitcnt lgkmcnt(4)
buffer_load_dwordx4 v1, s[4:7], s8 offen offset:0 sc1 lds
v_mfma_f32_16x16x32_bf16 v[64:67], a[72:75], a[8:11], v[64:67]
ds_read_b128 a[100:103], v4 offset:9216
v_mfma_f32_16x16x32_bf16 v[64:67], a[76:79], a[12:15], v[64:67]
s_waitcnt lgkmcnt(4)
v_exp_f32 v8, v48
v_mfma_f32_16x16x32_bf16 v[64:67], a[80:83], a[16:19], v[64:67]
ds_read_b128 a[104:107], v4 offset:10240
v_add_f32 v26, v26, v8
v_mfma_f32_16x16x32_bf16 v[64:67], a[84:87], a[20:23], v[64:67]
s_waitcnt lgkmcnt(4)
buffer_load_dwordx4 v1, s[4:7], s8 offen offset:1024 sc1 lds
v_mfma_f32_16x16x32_bf16 v[64:67], a[88:91], a[24:27], v[64:67]
s_waitcnt lgkmcnt(3)
ds_read_b128 a[108:111], v4 offset:11264
v_mfma_f32_16x16x32_bf16 v[64:67], a[92:95], a[28:31], v[64:67]
v_exp_f32 v9, v49
v_mfma_f32_16x16x32_bf16 v[68:71], a[64:67], a[32:35], v[20:23]
ds_read_b128 a[112:115], v4 offset:12288
v_add_f32 v26, v26, v9
v_mfma_f32_16x16x32_bf16 v[68:71], a[68:71], a[36:39], v[68:71]
buffer_load_dwordx4 v1, s[4:7], s8 offen offset:2048 sc1 lds
v_mfma_f32_16x16x32_bf16 v[68:71], a[72:75], a[40:43], v[68:71]
ds_read_b128 a[116:119], v4 offset:13312
v_cvt_pk_bf16_f32 v100, v8, v9
v_mfma_f32_16x16x32_bf16 v[68:71], a[76:79], a[44:47], v[68:71]
v_exp_f32 v10, v50
v_mfma_f32_16x16x32_bf16 v[68:71], a[80:83], a[48:51], v[68:71]
ds_read_b128 a[120:123], v4 offset:14336
v_add_f32 v26, v26, v10
v_mfma_f32_16x16x32_bf16 v[68:71], a[84:87], a[52:55], v[68:71]
buffer_load_dwordx4 v1, s[4:7], s8 offen offset:3072 sc1 lds
v_mfma_f32_16x16x32_bf16 v[68:71], a[88:91], a[56:59], v[68:71]
s_add_u32 s8, s8, 4096
ds_read_b128 a[124:127], v4 offset:15360
v_mfma_f32_16x16x32_bf16 v[68:71], a[92:95], a[60:63], v[68:71]
s_waitcnt lgkmcnt(4)
v_exp_f32 v11, v51
v_mfma_f32_16x16x32_bf16 v[72:75], a[96:99], a[0:3], v[16:19]
s_add_u32 m0, s18, 4096
ds_read_b128 a[64:67], v4 offset:16384
v_add_f32 v26, v26, v11
v_mfma_f32_16x16x32_bf16 v[72:75], a[100:103], a[4:7], v[72:75]
buffer_load_dwordx4 v1, s[4:7], s8 offen offset:0 sc1 lds
v_mfma_f32_16x16x32_bf16 v[72:75], a[104:107], a[8:11], v[72:75]
ds_read_b128 a[68:71], v4 offset:17408
v_cvt_pk_bf16_f32 v101, v10, v11
v_mfma_f32_16x16x32_bf16 v[72:75], a[108:111], a[12:15], v[72:75]
s_waitcnt lgkmcnt(4)
v_mfma_f32_16x16x32_bf16 v[72:75], a[112:115], a[16:19], v[72:75]
ds_read_b128 a[72:75], v4 offset:18432
v_mfma_f32_16x16x32_bf16 v[72:75], a[116:119], a[20:23], v[72:75]
s_waitcnt lgkmcnt(4)
buffer_load_dwordx4 v1, s[4:7], s8 offen offset:1024 sc1 lds
v_mfma_f32_16x16x32_bf16 v[72:75], a[120:123], a[24:27], v[72:75]
s_waitcnt lgkmcnt(3)
ds_read_b128 a[76:79], v4 offset:19456
v_mfma_f32_16x16x32_bf16 v[72:75], a[124:127], a[28:31], v[72:75]
v_exp_f32 v12, v52
v_mfma_f32_16x16x32_bf16 v[76:79], a[96:99], a[32:35], v[20:23]
ds_read_b128 a[80:83], v4 offset:20480
v_add_f32 v27, v27, v12
v_mfma_f32_16x16x32_bf16 v[76:79], a[100:103], a[36:39], v[76:79]
buffer_load_dwordx4 v1, s[4:7], s8 offen offset:2048 sc1 lds
v_mfma_f32_16x16x32_bf16 v[76:79], a[104:107], a[40:43], v[76:79]
ds_read_b128 a[84:87], v4 offset:21504
v_mfma_f32_16x16x32_bf16 v[76:79], a[108:111], a[44:47], v[76:79]
v_exp_f32 v13, v53
v_mfma_f32_16x16x32_bf16 v[76:79], a[112:115], a[48:51], v[76:79]
ds_read_b128 a[88:91], v4 offset:22528
v_add_f32 v27, v27, v13
v_mfma_f32_16x16x32_bf16 v[76:79], a[116:119], a[52:55], v[76:79]
s_waitcnt lgkmcnt(3)
buffer_load_dwordx4 v1, s[4:7], s8 offen offset:3072 sc1 lds
v_mfma_f32_16x16x32_bf16 v[76:79], a[120:123], a[56:59], v[76:79]
s_add_u32 s8, s8, 28672
ds_read_b128 a[92:95], v4 offset:23552
v_cvt_pk_bf16_f32 v108, v12, v13
v_mfma_f32_16x16x32_bf16 v[76:79], a[124:127], a[60:63], v[76:79]
s_sub_u32 s9, s9, 1
v_exp_f32 v14, v54
v_mfma_f32_16x16x32_bf16 v[80:83], a[64:67], a[0:3], v[16:19]
s_cmp_eq_u32 s9, 0
ds_read_b128 a[96:99], v4 offset:24576
v_add_f32 v27, v27, v14
v_mfma_f32_16x16x32_bf16 v[80:83], a[68:71], a[4:7], v[80:83]
s_cselect_b32 s8, s10, s8
v_exp_f32 v15, v55
v_mfma_f32_16x16x32_bf16 v[80:83], a[72:75], a[8:11], v[80:83]
s_cselect_b32 s9, s11, s9
ds_read_b128 a[100:103], v4 offset:25600
v_add_f32 v27, v27, v15
v_mfma_f32_16x16x32_bf16 v[80:83], a[76:79], a[12:15], v[80:83]
s_waitcnt lgkmcnt(4)
s_cselect_b32 s10, 3221225472, s10
v_cvt_pk_bf16_f32 v109, v14, v15
v_mfma_f32_16x16x32_bf16 v[80:83], a[80:83], a[16:19], v[80:83]
ds_read_b128 a[104:107], v4 offset:26624
v_mfma_f32_16x16x32_bf16 v[80:83], a[84:87], a[20:23], v[80:83]
s_waitcnt lgkmcnt(4)
v_exp_f32 v8, v56
v_mfma_f32_16x16x32_bf16 v[80:83], a[88:91], a[24:27], v[80:83]
s_waitcnt lgkmcnt(3)
ds_read_b128 a[108:111], v4 offset:27648
v_add_f32 v26, v26, v8
v_mfma_f32_16x16x32_bf16 v[80:83], a[92:95], a[28:31], v[80:83]
v_exp_f32 v9, v57
v_mfma_f32_16x16x32_bf16 v[84:87], a[64:67], a[32:35], v[20:23]
ds_read_b128 a[112:115], v4 offset:28672
v_add_f32 v26, v26, v9
v_mfma_f32_16x16x32_bf16 v[84:87], a[68:71], a[36:39], v[84:87]
v_exp_f32 v10, v58
v_mfma_f32_16x16x32_bf16 v[84:87], a[72:75], a[40:43], v[84:87]
ds_read_b128 a[116:119], v4 offset:29696
v_cvt_pk_bf16_f32 v102, v8, v9
v_mfma_f32_16x16x32_bf16 v[84:87], a[76:79], a[44:47], v[84:87]
v_exp_f32 v11, v59
v_mfma_f32_16x16x32_bf16 v[84:87], a[80:83], a[48:51], v[84:87]
ds_read_b128 a[120:123], v4 offset:30720
v_add_f32 v26, v26, v10
v_mfma_f32_16x16x32_bf16 v[84:87], a[84:87], a[52:55], v[84:87]
v_add_f32 v26, v26, v11
v_cvt_pk_bf16_f32 v103, v10, v11
v_mfma_f32_16x16x32_bf16 v[84:87], a[88:91], a[56:59], v[84:87]
s_waitcnt vmcnt(8) lgkmcnt(4)
ds_read_b128 a[124:127], v4 offset:31744
v_mfma_f32_16x16x32_bf16 v[84:87], a[92:95], a[60:63], v[84:87]
s_barrier
v_mfma_f32_16x16x32_bf16 v[88:91], a[96:99], a[0:3], v[16:19]
ds_read_b128 a[64:67], v2 offset:0
v_mfma_f32_16x16x32_bf16 v[88:91], a[100:103], a[4:7], v[88:91]
v_exp_f32 v12, v60
v_mfma_f32_16x16x32_bf16 v[88:91], a[104:107], a[8:11], v[88:91]
s_waitcnt lgkmcnt(4)
ds_read_b128 a[68:71], v2 offset:1024
v_add_f32 v27, v27, v12
v_mfma_f32_16x16x32_bf16 v[88:91], a[108:111], a[12:15], v[88:91]
v_exp_f32 v13, v61
v_mfma_f32_16x16x32_bf16 v[88:91], a[112:115], a[16:19], v[88:91]
s_waitcnt lgkmcnt(4)
ds_read_b128 a[72:75], v2 offset:2048
v_add_f32 v27, v27, v13
v_mfma_f32_16x16x32_bf16 v[88:91], a[116:119], a[20:23], v[88:91]
s_waitcnt lgkmcnt(4)
v_exp_f32 v14, v62
v_mfma_f32_16x16x32_bf16 v[88:91], a[120:123], a[24:27], v[88:91]
s_waitcnt lgkmcnt(3)
ds_read_b128 a[76:79], v2 offset:3072
v_cvt_pk_bf16_f32 v110, v12, v13
v_mfma_f32_16x16x32_bf16 v[88:91], a[124:127], a[28:31], v[88:91]
v_exp_f32 v15, v63
v_mfma_f32_16x16x32_bf16 v[92:95], a[96:99], a[32:35], v[20:23]
s_sub_u32 s19, s19, 1
ds_read_b128 a[80:83], v2 offset:4096
v_add_f32 v27, v27, v14
v_mfma_f32_16x16x32_bf16 v[92:95], a[100:103], a[36:39], v[92:95]
v_add_f32 v27, v27, v15
v_cvt_pk_bf16_f32 v111, v14, v15
v_mfma_f32_16x16x32_bf16 v[92:95], a[104:107], a[40:43], v[92:95]
ds_read_b128 a[84:87], v2 offset:5120
v_add_f32 v28, v26, v27
v_mfma_f32_16x16x32_bf16 v[92:95], a[108:111], a[44:47], v[92:95]
v_cmp_nge_f32 vcc, s25, v28
v_mfma_f32_16x16x32_bf16 v[92:95], a[112:115], a[48:51], v[92:95]
s_cmp_eq_u64 vcc, 0
ds_read_b128 a[88:91], v2 offset:6144
v_mfma_f32_16x16x32_bf16 v[92:95], a[116:119], a[52:55], v[92:95]
s_cselect_b32 s22, s19, 0
v_mfma_f32_16x16x32_bf16 v[92:95], a[120:123], a[56:59], v[92:95]
s_cmp_eq_u32 s22, 0
ds_read_b128 a[92:95], v2 offset:7168
v_mfma_f32_16x16x32_bf16 v[92:95], a[124:127], a[60:63], v[92:95]
s_waitcnt lgkmcnt(4)
s_cbranch_scc1 K2_xexit
K2_loop:
v_mfma_f32_16x16x32_bf16 v[128:131], a[64:67], v[96:99], v[128:131]
s_add_u32 m0, s18, 98304
ds_read_b128 a[96:99], v2 offset:8192
v_add_f32 v24, v24, v26
v_mfma_f32_16x16x32_bf16 v[128:131], a[68:71], v[100:103], v[128:131]
buffer_load_dwordx4 v1, s[4:7], s12 offen offset:0 sc1 lds
v_mfma_f32_16x16x32_bf16 v[132:135], a[68:71], v[108:111], v[132:135]
ds_read_b128 a[100:103], v2 offset:9216
v_add_f32 v25, v25, v27
v_mfma_f32_16x16x32_bf16 v[132:135], a[64:67], v[104:107], v[132:135]
v_exp_f32 v8, v64
v_mfma_f32_16x16x32_bf16 v[136:139], a[72:75], v[96:99], v[136:139]
ds_read_b128 a[104:107], v2 offset:10240
v_mfma_f32_16x16x32_bf16 v[136:139], a[76:79], v[100:103], v[136:139]
buffer_load_dwordx4 v1, s[4:7], s12 offen offset:1024 sc1 lds
v_mfma_f32_16x16x32_bf16 v[140:143], a[76:79], v[108:111], v[140:143]
ds_read_b128 a[108:111], v2 offset:11264
v_mfma_f32_16x16x32_bf16 v[140:143], a[72:75], v[104:107], v[140:143]
s_waitcnt lgkmcnt(4)
v_exp_f32 v9, v65
v_mfma_f32_16x16x32_bf16 v[144:147], a[80:83], v[96:99], v[144:147]
PAD_10:
s_cbranch_execz M_tret
ds_read_b128 a[112:115], v2 offset:12288
v_add_f32 v26, v8, v9
v_mfma_f32_16x16x32_bf16 v[144:147], a[84:87], v[100:103], v[144:147]
buffer_load_dwordx4 v1, s[4:7], s12 offen offset:2048 sc1 lds
v_mfma_f32_16x16x32_bf16 v[148:151], a[84:87], v[108:111], v[148:151]
ds_read_b128 a[116:119], v2 offset:13312
v_cvt_pk_bf16_f32 v112, v8, v9
v_mfma_f32_16x16x32_bf16 v[148:151], a[80:83], v[104:107], v[148:151]
v_exp_f32 v10, v66
v_mfma_f32_16x16x32_bf16 v[152:155], a[88:91], v[96:99], v[152:155]
ds_read_b128 a[120:123], v2 offset:14336
v_add_f32 v26, v26, v10
v_mfma_f32_16x16x32_bf16 v[152:155], a[92:95], v[100:103], v[152:155]
buffer_load_dwordx4 v1, s[4:7], s12 offen offset:3072 sc1 lds
v_mfma_f32_16x16x32_bf16 v[156:159], a[92:95], v[108:111], v[156:159]
s_add_u32 s12, s12, 4096
ds_read_b128 a[124:127], v2 offset:15360
v_mfma_f32_16x16x32_bf16 v[156:159], a[88:91], v[104:107], v[156:159]
s_waitcnt lgkmcnt(4)
v_exp_f32 v11, v67
v_mfma_f32_16x16x32_bf16 v[160:163], a[96:99], v[96:99], v[160:163]
s_add_u32 m0, s18, 102400
ds_read_b128 a[64:67], v2 offset:16384
v_add_f32 v26, v26, v11
v_mfma_f32_16x16x32_bf16 v[160:163], a[100:103], v[100:103], v[160:163]
buffer_load_dwordx4 v1, s[4:7], s12 offen offset:0 sc1 lds
v_mfma_f32_16x16x32_bf16 v[164:167], a[100:103], v[108:111], v[164:167]
ds_read_b128 a[68:71], v2 offset:17408
v_cvt_pk_bf16_f32 v113, v10, v11
v_mfma_f32_16x16x32_bf16 v[164:167], a[96:99], v[104:107], v[164:167]
v_mfma_f32_16x16x32_bf16 v[168:171], a[104:107], v[96:99], v[168:171]
ds_read_b128 a[72:75], v2 offset:18432
v_mfma_f32_16x16x32_bf16 v[168:171], a[108:111], v[100:103], v[168:171]
buffer_load_dwordx4 v1, s[4:7], s12 offen offset:1024 sc1 lds
v_mfma_f32_16x16x32_bf16 v[172:175], a[108:111], v[108:111], v[172:175]
ds_read_b128 a[76:79], v2 offset:19456
v_mfma_f32_16x16x32_bf16 v[172:175], a[104:107], v[104:107], v[172:175]
s_waitcnt lgkmcnt(4)
v_exp_f32 v12, v68
v_mfma_f32_16x16x32_bf16 v[176:179], a[112:115], v[96:99], v[176:179]
ds_read_b128 a[80:83], v2 offset:20480
v_mfma_f32_16x16x32_bf16 v[176:179], a[116:119], v[100:103], v[176:179]
buffer_load_dwordx4 v1, s[4:7], s12 offen offset:2048 sc1 lds
v_mfma_f32_16x16x32_bf16 v[180:183], a[116:119], v[108:111], v[180:183]
ds_read_b128 a[84:87], v2 offset:21504
v_mfma_f32_16x16x32_bf16 v[180:183], a[112:115], v[104:107], v[180:183]
v_exp_f32 v13, v69
v_mfma_f32_16x16x32_bf16 v[184:187], a[120:123], v[96:99], v[184:187]
ds_read_b128 a[88:91], v2 offset:22528
v_add_f32 v27, v12, v13
v_mfma_f32_16x16x32_bf16 v[184:187], a[124:127], v[100:103], v[184:187]
s_waitcnt lgkmcnt(4)
buffer_load_dwordx4 v1, s[4:7], s12 offen offset:3072 sc1 lds
v_mfma_f32_16x16x32_bf16 v[188:191], a[124:127], v[108:111], v[188:191]
s_add_u32 s12, s12, 28672
ds_read_b128 a[92:95], v2 offset:23552
v_cvt_pk_bf16_f32 v120, v12, v13
v_mfma_f32_16x16x32_bf16 v[188:191], a[120:123], v[104:107], v[188:191]
s_sub_u32 s13, s13, 1
v_exp_f32 v14, v70
v_mfma_f32_16x16x32_bf16 v[192:195], a[64:67], v[96:99], v[192:195]
s_cmp_eq_u32 s13, 0
ds_read_b128 a[96:99], v2 offset:24576
v_add_f32 v27, v27, v14
v_mfma_f32_16x16x32_bf16 v[192:195], a[68:71], v[100:103], v[192:195]
s_cselect_b32 s12, s14, s12
v_mfma_f32_16x16x32_bf16 v[196:199], a[68:71], v[108:111], v[196:199]
s_cselect_b32 s13, s15, s13
ds_read_b128 a[100:103], v2 offset:25600
v_mfma_f32_16x16x32_bf16 v[196:199], a[64:67], v[104:107], v[196:199]
s_cselect_b32 s14, 3221225472, s14
v_exp_f32 v15, v71
v_mfma_f32_16x16x32_bf16 v[200:203], a[72:75], v[96:99], v[200:203]
s_waitcnt lgkmcnt(4)
ds_read_b128 a[104:107], v2 offset:26624
v_add_f32 v27, v27, v15
v_mfma_f32_16x16x32_bf16 v[200:203], a[76:79], v[100:103], v[200:203]
v_exp_f32 v8, v72
v_mfma_f32_16x16x32_bf16 v[204:207], a[76:79], v[108:111], v[204:207]
ds_read_b128 a[108:111], v2 offset:27648
v_cvt_pk_bf16_f32 v121, v14, v15
v_mfma_f32_16x16x32_bf16 v[204:207], a[72:75], v[104:107], v[204:207]
v_exp_f32 v9, v73
v_mfma_f32_16x16x32_bf16 v[208:211], a[80:83], v[96:99], v[208:211]
ds_read_b128 a[112:115], v2 offset:28672
v_add_f32 v26, v26, v8
v_mfma_f32_16x16x32_bf16 v[208:211], a[84:87], v[100:103], v[208:211]
v_add_f32 v26, v26, v9
v_cvt_pk_bf16_f32 v114, v8, v9
v_mfma_f32_16x16x32_bf16 v[212:215], a[84:87], v[108:111], v[212:215]
ds_read_b128 a[116:119], v2 offset:29696
v_mfma_f32_16x16x32_bf16 v[212:215], a[80:83], v[104:107], v[212:215]
s_waitcnt lgkmcnt(4)
v_exp_f32 v10, v74
v_mfma_f32_16x16x32_bf16 v[216:219], a[88:91], v[96:99], v[216:219]
ds_read_b128 a[120:123], v2 offset:30720
v_add_f32 v26, v26, v10
v_mfma_f32_16x16x32_bf16 v[216:219], a[92:95], v[100:103], v[216:219]
v_exp_f32 v11, v75
v_mfma_f32_16x16x32_bf16 v[220:223], a[92:95], v[108:111], v[220:223]
s_waitcnt vmcnt(8)
ds_read_b128 a[124:127], v2 offset:31744
v_add_f32 v26, v26, v11
v_mfma_f32_16x16x32_bf16 v[220:223], a[88:91], v[104:107], v[220:223]
s_barrier
v_mfma_f32_16x16x32_bf16 v[224:227], a[96:99], v[96:99], v[224:227]
ds_read_b128 a[64:67], v1 offset:0
v_cvt_pk_bf16_f32 v115, v10, v11
v_mfma_f32_16x16x32_bf16 v[224:227], a[100:103], v[100:103], v[224:227]
v_exp_f32 v12, v76
v_mfma_f32_16x16x32_bf16 v[228:231], a[100:103], v[108:111], v[228:231]
ds_read_b128 a[68:71], v1 offset:1024
v_add_f32 v27, v27, v12
v_mfma_f32_16x16x32_bf16 v[228:231], a[96:99], v[104:107], v[228:231]
s_waitcnt lgkmcnt(4)
v_mfma_f32_16x16x32_bf16 v[232:235], a[104:107], v[96:99], v[232:235]
ds_read_b128 a[72:75], v1 offset:2048
v_mfma_f32_16x16x32_bf16 v[232:235], a[108:111], v[100:103], v[232:235]
v_exp_f32 v13, v77
v_mfma_f32_16x16x32_bf16 v[236:239], a[108:111], v[108:111], v[236:239]
ds_read_b128 a[76:79], v1 offset:3072
v_add_f32 v27, v27, v13
v_mfma_f32_16x16x32_bf16 v[236:239], a[104:107], v[104:107], v[236:239]
v_exp_f32 v14, v78
v_mfma_f32_16x16x32_bf16 v[240:243], a[112:115], v[96:99], v[240:243]
ds_read_b128 a[80:83], v1 offset:4096
v_cvt_pk_bf16_f32 v122, v12, v13
v_mfma_f32_16x16x32_bf16 v[240:243], a[116:119], v[100:103], v[240:243]
v_exp_f32 v15, v79
v_mfma_f32_16x16x32_bf16 v[244:247], a[116:119], v[108:111], v[244:247]
ds_read_b128 a[84:87], v1 offset:5120
v_add_f32 v27, v27, v14
v_mfma_f32_16x16x32_bf16 v[244:247], a[112:115], v[104:107], v[244:247]
s_waitcnt lgkmcnt(4)
v_add_f32 v27, v27, v15
v_cvt_pk_bf16_f32 v123, v14, v15
v_mfma_f32_16x16x32_bf16 v[248:251], a[120:123], v[96:99], v[248:251]
ds_read_b128 a[88:91], v1 offset:6144
v_mfma_f32_16x16x32_bf16 v[248:251], a[124:127], v[100:103], v[248:251]
v_mfma_f32_16x16x32_bf16 v[252:255], a[124:127], v[108:111], v[252:255]
ds_read_b128 a[92:95], v1 offset:7168
v_mfma_f32_16x16x32_bf16 v[252:255], a[120:123], v[104:107], v[252:255]
K2_x0:
v_mfma_f32_16x16x32_bf16 v[32:35], a[64:67], a[0:3], v[16:19]
s_add_u32 m0, s18, 131072
ds_read_b128 a[96:99], v1 offset:8192
v_mfma_f32_16x16x32_bf16 v[32:35], a[68:71], a[4:7], v[32:35]
s_waitcnt lgkmcnt(4)
buffer_load_dwordx4 v1, s[4:7], s8 offen offset:0 sc1 lds
v_mfma_f32_16x16x32_bf16 v[32:35], a[72:75], a[8:11], v[32:35]
ds_read_b128 a[100:103], v1 offset:9216
v_mfma_f32_16x16x32_bf16 v[32:35], a[76:79], a[12:15], v[32:35]
v_exp_f32 v8, v80
v_mfma_f32_16x16x32_bf16 v[32:35], a[80:83], a[16:19], v[32:35]
s_waitcnt lgkmcnt(4)
ds_read_b128 a[104:107], v1 offset:10240
v_add_f32 v26, v26, v8
v_mfma_f32_16x16x32_bf16 v[32:35], a[84:87], a[20:23], v[32:35]
s_waitcnt lgkmcnt(4)
buffer_load_dwordx4 v1, s[4:7], s8 offen offset:1024 sc1 lds
v_mfma_f32_16x16x32_bf16 v[32:35], a[88:91], a[24:27], v[32:35]
s_waitcnt lgkmcnt(3)
ds_read_b128 a[108:111], v1 offset:11264
v_mfma_f32_16x16x32_bf16 v[32:35], a[92:95], a[28:31], v[32:35]
v_exp_f32 v9, v81
v_mfma_f32_16x16x32_bf16 v[36:39], a[64:67], a[32:35], v[20:23]
ds_read_b128 a[112:115], v1 offset:12288
v_add_f32 v26, v26, v9
v_mfma_f32_16x16x32_bf16 v[36:39], a[68:71], a[36:39], v[36:39]
buffer_load_dwordx4 v1, s[4:7], s8 offen offset:2048 sc1 lds
v_mfma_f32_16x16x32_bf16 v[36:39], a[72:75], a[40:43], v[36:39]
ds_read_b128 a[116:119], v1 offset:13312
v_cvt_pk_bf16_f32 v116, v8, v9
v_mfma_f32_16x16x32_bf16 v[36:39], a[76:79], a[44:47], v[36:39]
v_exp_f32 v10, v82
v_mfma_f32_16x16x32_bf16 v[36:39], a[80:83], a[48:51], v[36:39]
ds_read_b128 a[120:123], v1 offset:14336
v_add_f32 v26, v26, v10
v_mfma_f32_16x16x32_bf16 v[36:39], a[84:87], a[52:55], v[36:39]
buffer_load_dwordx4 v1, s[4:7], s8 offen offset:3072 sc1 lds
v_mfma_f32_16x16x32_bf16 v[36:39], a[88:91], a[56:59], v[36:39]
s_add_u32 s8, s8, 4096
ds_read_b128 a[124:127], v1 offset:15360
v_mfma_f32_16x16x32_bf16 v[36:39], a[92:95], a[60:63], v[36:39]
s_waitcnt lgkmcnt(4)
v_exp_f32 v11, v83
v_mfma_f32_16x16x32_bf16 v[40:43], a[96:99], a[0:3], v[16:19]
s_add_u32 m0, s18, 135168
ds_read_b128 a[64:67], v1 offset:16384
v_add_f32 v26, v26, v11
v_mfma_f32_16x16x32_bf16 v[40:43], a[100:103], a[4:7], v[40:43]
buffer_load_dwordx4 v1, s[4:7], s8 offen offset:0 sc1 lds
v_mfma_f32_16x16x32_bf16 v[40:43], a[104:107], a[8:11], v[40:43]
ds_read_b128 a[68:71], v1 offset:17408
v_cvt_pk_bf16_f32 v117, v10, v11
v_mfma_f32_16x16x32_bf16 v[40:43], a[108:111], a[12:15], v[40:43]
s_waitcnt lgkmcnt(4)
v_mfma_f32_16x16x32_bf16 v[40:43], a[112:115], a[16:19], v[40:43]
ds_read_b128 a[72:75], v1 offset:18432
v_mfma_f32_16x16x32_bf16 v[40:43], a[116:119], a[20:23], v[40:43]
s_waitcnt lgkmcnt(4)
buffer_load_dwordx4 v1, s[4:7], s8 offen offset:1024 sc1 lds
v_mfma_f32_16x16x32_bf16 v[40:43], a[120:123], a[24:27], v[40:43]
s_waitcnt lgkmcnt(3)
ds_read_b128 a[76:79], v1 offset:19456
v_mfma_f32_16x16x32_bf16 v[40:43], a[124:127], a[28:31], v[40:43]
v_exp_f32 v12, v84
v_mfma_f32_16x16x32_bf16 v[44:47], a[96:99], a[32:35], v[20:23]
ds_read_b128 a[80:83], v1 offset:20480
v_add_f32 v27, v27, v12
v_mfma_f32_16x16x32_bf16 v[44:47], a[100:103], a[36:39], v[44:47]
buffer_load_dwordx4 v1, s[4:7], s8 offen offset:2048 sc1 lds
v_mfma_f32_16x16x32_bf16 v[44:47], a[104:107], a[40:43], v[44:47]
ds_read_b128 a[84:87], v1 offset:21504
v_mfma_f32_16x16x32_bf16 v[44:47], a[108:111], a[44:47], v[44:47]
v_exp_f32 v13, v85
v_mfma_f32_16x16x32_bf16 v[44:47], a[112:115], a[48:51], v[44:47]
ds_read_b128 a[88:91], v1 offset:22528
v_add_f32 v27, v27, v13
v_mfma_f32_16x16x32_bf16 v[44:47], a[116:119], a[52:55], v[44:47]
s_waitcnt lgkmcnt(3)
buffer_load_dwordx4 v1, s[4:7], s8 offen offset:3072 sc1 lds
v_mfma_f32_16x16x32_bf16 v[44:47], a[120:123], a[56:59], v[44:47]
s_add_u32 s8, s8, 28672
ds_read_b128 a[92:95], v1 offset:23552
v_cvt_pk_bf16_f32 v124, v12, v13
v_mfma_f32_16x16x32_bf16 v[44:47], a[124:127], a[60:63], v[44:47]
s_sub_u32 s9, s9, 1
v_exp_f32 v14, v86
v_mfma_f32_16x16x32_bf16 v[48:51], a[64:67], a[0:3], v[16:19]
s_cmp_eq_u32 s9, 0
ds_read_b128 a[96:99], v1 offset:24576
v_add_f32 v27, v27, v14
v_mfma_f32_16x16x32_bf16 v[48:51], a[68:71], a[4:7], v[48:51]
s_cselect_b32 s8, s10, s8
v_exp_f32 v15, v87
v_mfma_f32_16x16x32_bf16 v[48:51], a[72:75], a[8:11], v[48:51]
s_cselect_b32 s9, s11, s9
ds_read_b128 a[100:103], v1 offset:25600
v_add_f32 v27, v27, v15
v_mfma_f32_16x16x32_bf16 v[48:51], a[76:79], a[12:15], v[48:51]
s_waitcnt lgkmcnt(4)
s_cselect_b32 s10, 3221225472, s10
v_cvt_pk_bf16_f32 v125, v14, v15
v_mfma_f32_16x16x32_bf16 v[48:51], a[80:83], a[16:19], v[48:51]
ds_read_b128 a[104:107], v1 offset:26624
v_mfma_f32_16x16x32_bf16 v[48:51], a[84:87], a[20:23], v[48:51]
s_waitcnt lgkmcnt(4)
v_exp_f32 v8, v88
v_mfma_f32_16x16x32_bf16 v[48:51], a[88:91], a[24:27], v[48:51]
s_waitcnt lgkmcnt(3)
ds_read_b128 a[108:111], v1 offset:27648
v_add_f32 v26, v26, v8
v_mfma_f32_16x16x32_bf16 v[48:51], a[92:95], a[28:31], v[48:51]
v_exp_f32 v9, v89
v_mfma_f32_16x16x32_bf16 v[52:55], a[64:67], a[32:35], v[20:23]
ds_read_b128 a[112:115], v1 offset:28672
v_add_f32 v26, v26, v9
v_mfma_f32_16x16x32_bf16 v[52:55], a[68:71], a[36:39], v[52:55]
v_exp_f32 v10, v90
v_mfma_f32_16x16x32_bf16 v[52:55], a[72:75], a[40:43], v[52:55]
ds_read_b128 a[116:119], v1 offset:29696
v_cvt_pk_bf16_f32 v118, v8, v9
v_mfma_f32_16x16x32_bf16 v[52:55], a[76:79], a[44:47], v[52:55]
v_exp_f32 v11, v91
v_mfma_f32_16x16x32_bf16 v[52:55], a[80:83], a[48:51], v[52:55]
ds_read_b128 a[120:123], v1 offset:30720
v_add_f32 v26, v26, v10
v_mfma_f32_16x16x32_bf16 v[52:55], a[84:87], a[52:55], v[52:55]
v_add_f32 v26, v26, v11
v_cvt_pk_bf16_f32 v119, v10, v11
v_mfma_f32_16x16x32_bf16 v[52:55], a[88:91], a[56:59], v[52:55]
s_waitcnt vmcnt(8) lgkmcnt(4)
ds_read_b128 a[124:127], v1 offset:31744
v_mfma_f32_16x16x32_bf16 v[52:55], a[92:95], a[60:63], v[52:55]
s_barrier
v_mfma_f32_16x16x32_bf16 v[56:59], a[96:99], a[0:3], v[16:19]
ds_read_b128 a[64:67], v2 offset:32768
v_mfma_f32_16x16x32_bf16 v[56:59], a[100:103], a[4:7], v[56:59]
v_exp_f32 v12, v92
v_mfma_f32_16x16x32_bf16 v[56:59], a[104:107], a[8:11], v[56:59]
s_waitcnt lgkmcnt(4)
ds_read_b128 a[68:71], v2 offset:33792
v_add_f32 v27, v27, v12
v_mfma_f32_16x16x32_bf16 v[56:59], a[108:111], a[12:15], v[56:59]
v_exp_f32 v13, v93
v_mfma_f32_16x16x32_bf16 v[56:59], a[112:115], a[16:19], v[56:59]
s_waitcnt lgkmcnt(4)
ds_read_b128 a[72:75], v2 offset:34816
v_add_f32 v27, v27, v13
v_mfma_f32_16x16x32_bf16 v[56:59], a[116:119], a[20:23], v[56:59]
s_waitcnt lgkmcnt(4)
v_exp_f32 v14, v94
v_mfma_f32_16x16x32_bf16 v[56:59], a[120:123], a[24:27], v[56:59]
s_waitcnt lgkmcnt(3)
ds_read_b128 a[76:79], v2 offset:35840
v_cvt_pk_bf16_f32 v126, v12, v13
v_mfma_f32_16x16x32_bf16 v[56:59], a[124:127], a[28:31], v[56:59]
v_exp_f32 v15, v95
v_mfma_f32_16x16x32_bf16 v[60:63], a[96:99], a[32:35], v[20:23]
ds_read_b128 a[80:83], v2 offset:36864
v_add_f32 v27, v27, v14
v_mfma_f32_16x16x32_bf16 v[60:63], a[100:103], a[36:39], v[60:63]
v_add_f32 v27, v27, v15
v_cvt_pk_bf16_f32 v127, v14, v15
v_mfma_f32_16x16x32_bf16 v[60:63], a[104:107], a[40:43], v[60:63]
ds_read_b128 a[84:87], v2 offset:37888
v_add_f32 v28, v26, v27
v_mfma_f32_16x16x32_bf16 v[60:63], a[108:111], a[44:47], v[60:63]
v_cmp_nge_f32 vcc, s25, v28
v_mfma_f32_16x16x32_bf16 v[60:63], a[112:115], a[48:51], v[60:63]
ds_read_b128 a[88:91], v2 offset:38912
v_mfma_f32_16x16x32_bf16 v[60:63], a[116:119], a[52:55], v[60:63]
v_mfma_f32_16x16x32_bf16 v[60:63], a[120:123], a[56:59], v[60:63]
ds_read_b128 a[92:95], v2 offset:39936
v_mfma_f32_16x16x32_bf16 v[60:63], a[124:127], a[60:63], v[60:63]
s_waitcnt lgkmcnt(4)
s_cbranch_vccnz Lstub_2
Lback_3:
v_mfma_f32_16x16x32_bf16 v[128:131], a[64:67], v[112:115], v[128:131]
s_add_u32 m0, s18, 65536
ds_read_b128 a[96:99], v2 offset:40960
v_add_f32 v24, v24, v26
v_mfma_f32_16x16x32_bf16 v[128:131], a[68:71], v[116:119], v[128:131]
buffer_load_dwordx4 v1, s[4:7], s12 offen offset:0 sc1 lds
v_mfma_f32_16x16x32_bf16 v[132:135], a[68:71], v[124:127], v[132:135]
ds_read_b128 a[100:103], v2 offset:41984
v_add_f32 v25, v25, v27
v_mfma_f32_16x16x32_bf16 v[132:135], a[64:67], v[120:123], v[132:135]
v_exp_f32 v8, v32
v_mfma_f32_16x16x32_bf16 v[136:139], a[72:75], v[112:115], v[136:139]
ds_read_b128 a[104:107], v2 offset:43008
v_mfma_f32_16x16x32_bf16 v[136:139], a[76:79], v[116:119], v[136:139]
buffer_load_dwordx4 v1, s[4:7], s12 offen offset:1024 sc1 lds
v_mfma_f32_16x16x32_bf16 v[140:143], a[76:79], v[124:127], v[140:143]
ds_read_b128 a[108:111], v2 offset:44032
v_mfma_f32_16x16x32_bf16 v[140:143], a[72:75], v[120:123], v[140:143]
s_waitcnt lgkmcnt(4)
v_exp_f32 v9, v33
v_mfma_f32_16x16x32_bf16 v[144:147], a[80:83], v[112:115], v[144:147]
ds_read_b128 a[112:115], v2 offset:45056
v_add_f32 v26, v8, v9
v_mfma_f32_16x16x32_bf16 v[144:147], a[84:87], v[116:119], v[144:147]
buffer_load_dwordx4 v1, s[4:7], s12 offen offset:2048 sc1 lds
v_mfma_f32_16x16x32_bf16 v[148:151], a[84:87], v[124:127], v[148:151]
ds_read_b128 a[116:119], v2 offset:46080
v_cvt_pk_bf16_f32 v96, v8, v9
v_mfma_f32_16x16x32_bf16 v[148:151], a[80:83], v[120:123], v[148:151]
v_exp_f32 v10, v34
v_mfma_f32_16x16x32_bf16 v[152:155], a[88:91], v[112:115], v[152:155]
ds_read_b128 a[120:123], v2 offset:47104
v_add_f32 v26, v26, v10
v_mfma_f32_16x16x32_bf16 v[152:155], a[92:95], v[116:119], v[152:155]
buffer_load_dwordx4 v1, s[4:7], s12 offen offset:3072 sc1 lds
v_mfma_f32_16x16x32_bf16 v[156:159], a[92:95], v[124:127], v[156:159]
s_add_u32 s12, s12, 4096
ds_read_b128 a[124:127], v2 offset:48128
v_mfma_f32_16x16x32_bf16 v[156:159], a[88:91], v[120:123], v[156:159]
s_waitcnt lgkmcnt(4)
v_exp_f32 v11, v35
v_mfma_f32_16x16x32_bf16 v[160:163], a[96:99], v[112:115], v[160:163]
s_add_u32 m0, s18, 69632
ds_read_b128 a[64:67], v2 offset:49152
v_add_f32 v26, v26, v11
v_mfma_f32_16x16x32_bf16 v[160:163], a[100:103], v[116:119], v[160:163]
buffer_load_dwordx4 v1, s[4:7], s12 offen offset:0 sc1 lds
v_mfma_f32_16x16x32_bf16 v[164:167], a[100:103], v[124:127], v[164:167]
ds_read_b128 a[68:71], v2 offset:50176
v_cvt_pk_bf16_f32 v97, v10, v11
v_mfma_f32_16x16x32_bf16 v[164:167], a[96:99], v[120:123], v[164:167]
v_mfma_f32_16x16x32_bf16 v[168:171], a[104:107], v[112:115], v[168:171]
ds_read_b128 a[72:75], v2 offset:51200
v_mfma_f32_16x16x32_bf16 v[168:171], a[108:111], v[116:119], v[168:171]
buffer_load_dwordx4 v1, s[4:7], s12 offen offset:1024 sc1 lds
v_mfma_f32_16x16x32_bf16 v[172:175], a[108:111], v[124:127], v[172:175]
ds_read_b128 a[76:79], v2 offset:52224
v_mfma_f32_16x16x32_bf16 v[172:175], a[104:107], v[120:123], v[172:175]
s_waitcnt lgkmcnt(4)
v_exp_f32 v12, v36
v_mfma_f32_16x16x32_bf16 v[176:179], a[112:115], v[112:115], v[176:179]
ds_read_b128 a[80:83], v2 offset:53248
v_mfma_f32_16x16x32_bf16 v[176:179], a[116:119], v[116:119], v[176:179]
buffer_load_dwordx4 v1, s[4:7], s12 offen offset:2048 sc1 lds
v_mfma_f32_16x16x32_bf16 v[180:183], a[116:119], v[124:127], v[180:183]
ds_read_b128 a[84:87], v2 offset:54272
v_mfma_f32_16x16x32_bf16 v[180:183], a[112:115], v[120:123], v[180:183]
v_exp_f32 v13, v37
v_mfma_f32_16x16x32_bf16 v[184:187], a[120:123], v[112:115], v[184:187]
ds_read_b128 a[88:91], v2 offset:55296
v_add_f32 v27, v12, v13
v_mfma_f32_16x16x32_bf16 v[184:187], a[124:127], v[116:119], v[184:187]
s_waitcnt lgkmcnt(4)
buffer_load_dwordx4 v1, s[4:7], s12 offen offset:3072 sc1 lds
v_mfma_f32_16x16x32_bf16 v[188:191], a[124:127], v[124:127], v[188:191]
s_add_u32 s12, s12, 28672
ds_read_b128 a[92:95], v2 offset:56320
v_cvt_pk_bf16_f32 v104, v12, v13
v_mfma_f32_16x16x32_bf16 v[188:191], a[120:123], v[120:123], v[188:191]
s_sub_u32 s13, s13, 1
v_exp_f32 v14, v38
v_mfma_f32_16x16x32_bf16 v[192:195], a[64:67], v[112:115], v[192:195]
s_cmp_eq_u32 s13, 0
ds_read_b128 a[96:99], v2 offset:57344
v_add_f32 v27, v27, v14
v_mfma_f32_16x16x32_bf16 v[192:195], a[68:71], v[116:119], v[192:195]
s_cselect_b32 s12, s14, s12
v_mfma_f32_16x16x32_bf16 v[196:199], a[68:71], v[124:127], v[196:199]
s_cselect_b32 s13, s15, s13
ds_read_b128 a[100:103], v2 offset:58368
v_mfma_f32_16x16x32_bf16 v[196:199], a[64:67], v[120:123], v[196:199]
s_cselect_b32 s14, 3221225472, s14
v_exp_f32 v15, v39
v_mfma_f32_16x16x32_bf16 v[200:203], a[72:75], v[112:115], v[200:203]
s_waitcnt lgkmcnt(4)
ds_read_b128 a[104:107], v2 offset:59392
v_add_f32 v27, v27, v15
v_mfma_f32_16x16x32_bf16 v[200:203], a[76:79], v[116:119], v[200:203]
v_exp_f32 v8, v40
v_mfma_f32_16x16x32_bf16 v[204:207], a[76:79], v[124:127], v[204:207]
ds_read_b128 a[108:111], v2 offset:60416
v_cvt_pk_bf16_f32 v105, v14, v15
v_mfma_f32_16x16x32_bf16 v[204:207], a[72:75], v[120:123], v[204:207]
v_exp_f32 v9, v41
v_mfma_f32_16x16x32_bf16 v[208:211], a[80:83], v[112:115], v[208:211]
ds_read_b128 a[112:115], v2 offset:61440
v_add_f32 v26, v26, v8
v_mfma_f32_16x16x32_bf16 v[208:211], a[84:87], v[116:119], v[208:211]
v_add_f32 v26, v26, v9
v_cvt_pk_bf16_f32 v98, v8, v9
v_mfma_f32_16x16x32_bf16 v[212:215], a[84:87], v[124:127], v[212:215]
ds_read_b128 a[116:119], v2 offset:62464
v_mfma_f32_16x16x32_bf16 v[212:215], a[80:83], v[120:123], v[212:215]
s_waitcnt lgkmcnt(4)
v_exp_f32 v10, v42
v_mfma_f32_16x16x32_bf16 v[216:219], a[88:91], v[112:115], v[216:219]
ds_read_b128 a[120:123], v2 offset:63488
v_add_f32 v26, v26, v10
v_mfma_f32_16x16x32_bf16 v[216:219], a[92:95], v[116:119], v[216:219]
v_exp_f32 v11, v43
v_mfma_f32_16x16x32_bf16 v[220:223], a[92:95], v[124:127], v[220:223]
s_waitcnt vmcnt(8)
ds_read_b128 a[124:127], v2 offset:64512
v_add_f32 v26, v26, v11
v_mfma_f32_16x16x32_bf16 v[220:223], a[88:91], v[120:123], v[220:223]
s_barrier
v_mfma_f32_16x16x32_bf16 v[224:227], a[96:99], v[112:115], v[224:227]
ds_read_b128 a[64:67], v4 offset:0
v_cvt_pk_bf16_f32 v99, v10, v11
v_mfma_f32_16x16x32_bf16 v[224:227], a[100:103], v[116:119], v[224:227]
v_exp_f32 v12, v44
v_mfma_f32_16x16x32_bf16 v[228:231], a[100:103], v[124:127], v[228:231]
ds_read_b128 a[68:71], v4 offset:1024
v_add_f32 v27, v27, v12
v_mfma_f32_16x16x32_bf16 v[228:231], a[96:99], v[120:123], v[228:231]
s_waitcnt lgkmcnt(4)
v_mfma_f32_16x16x32_bf16 v[232:235], a[104:107], v[112:115], v[232:235]
ds_read_b128 a[72:75], v4 offset:2048
v_mfma_f32_16x16x32_bf16 v[232:235], a[108:111], v[116:119], v[232:235]
v_exp_f32 v13, v45
v_mfma_f32_16x16x32_bf16 v[236:239], a[108:111], v[124:127], v[236:239]
ds_read_b128 a[76:79], v4 offset:3072
v_add_f32 v27, v27, v13
v_mfma_f32_16x16x32_bf16 v[236:239], a[104:107], v[120:123], v[236:239]
v_exp_f32 v14, v46
v_mfma_f32_16x16x32_bf16 v[240:243], a[112:115], v[112:115], v[240:243]
ds_read_b128 a[80:83], v4 offset:4096
v_cvt_pk_bf16_f32 v106, v12, v13
v_mfma_f32_16x16x32_bf16 v[240:243], a[116:119], v[116:119], v[240:243]
v_exp_f32 v15, v47
v_mfma_f32_16x16x32_bf16 v[244:247], a[116:119], v[124:127], v[244:247]
ds_read_b128 a[84:87], v4 offset:5120
v_add_f32 v27, v27, v14
v_mfma_f32_16x16x32_bf16 v[244:247], a[112:115], v[120:123], v[244:247]
s_waitcnt lgkmcnt(4)
v_add_f32 v27, v27, v15
v_cvt_pk_bf16_f32 v107, v14, v15
v_mfma_f32_16x16x32_bf16 v[248:251], a[120:123], v[112:115], v[248:251]
ds_read_b128 a[88:91], v4 offset:6144
v_mfma_f32_16x16x32_bf16 v[248:251], a[124:127], v[116:119], v[248:251]
v_mfma_f32_16x16x32_bf16 v[252:255], a[124:127], v[124:127], v[252:255]
s_waitcnt lgkmcnt(5)
ds_read_b128 a[92:95], v4 offset:7168
v_mfma_f32_16x16x32_bf16 v[252:255], a[120:123], v[120:123], v[252:255]
s_branch K2_x1
K2_xexit:
s_cbranch_vccnz Lstub_4
Lback_5:
s_cmp_lg_u32 s19, 0
s_cbranch_scc1 K2_loop
s_cmp_eq_u32 s24, 2
s_cbranch_scc1 K2_ntail
v_mfma_f32_16x16x32_bf16 v[128:131], a[64:67], v[96:99], v[128:131]
s_add_u32 m0, s18, 98304
ds_read_b128 a[96:99], v2 offset:8192
v_add_f32 v24, v24, v26
v_mfma_f32_16x16x32_bf16 v[128:131], a[68:71], v[100:103], v[128:131]
buffer_load_dwordx4 v1, s[4:7], s12 offen offset:0 sc1 lds
v_mfma_f32_16x16x32_bf16 v[132:135], a[68:71], v[108:111], v[132:135]
ds_read_b128 a[100:103], v2 offset:9216
v_add_f32 v25, v25, v27
v_mfma_f32_16x16x32_bf16 v[132:135], a[64:67], v[104:107], v[132:135]
v_exp_f32 v8, v64
v_mfma_f32_16x16x32_bf16 v[136:139], a[72:75], v[96:99], v[136:139]
ds_read_b128 a[104:107], v2 offset:10240
v_mfma_f32_16x16x32_bf16 v[136:139], a[76:79], v[100:103], v[136:139]
buffer_load_dwordx4 v1, s[4:7], s12 offen offset:1024 sc1 lds
v_mfma_f32_16x16x32_bf16 v[140:143], a[76:79], v[108:111], v[140:143]
ds_read_b128 a[108:111], v2 offset:11264
v_mfma_f32_16x16x32_bf16 v[140:143], a[72:75], v[104:107], v[140:143]
s_waitcnt lgkmcnt(4)
v_exp_f32 v9, v65
v_mfma_f32_16x16x32_bf16 v[144:147], a[80:83], v[96:99], v[144:147]
ds_read_b128 a[112:115], v2 offset:12288
v_add_f32 v26, v8, v9
v_mfma_f32_16x16x32_bf16 v[144:147], a[84:87], v[100:103], v[144:147]
buffer_load_dwordx4 v1, s[4:7], s12 offen offset:2048 sc1 lds
v_mfma_f32_16x16x32_bf16 v[148:151], a[84:87], v[108:111], v[148:151]
ds_read_b128 a[116:119], v2 offset:13312
v_cvt_pk_bf16_f32 v112, v8, v9
v_mfma_f32_16x16x32_bf16 v[148:151], a[80:83], v[104:107], v[148:151]
v_exp_f32 v10, v66
v_mfma_f32_16x16x32_bf16 v[152:155], a[88:91], v[96:99], v[152:155]
ds_read_b128 a[120:123], v2 offset:14336
v_add_f32 v26, v26, v10
v_mfma_f32_16x16x32_bf16 v[152:155], a[92:95], v[100:103], v[152:155]
buffer_load_dwordx4 v1, s[4:7], s12 offen offset:3072 sc1 lds
v_mfma_f32_16x16x32_bf16 v[156:159], a[92:95], v[108:111], v[156:159]
s_add_u32 s12, s12, 4096
ds_read_b128 a[124:127], v2 offset:15360
v_mfma_f32_16x16x32_bf16 v[156:159], a[88:91], v[104:107], v[156:159]
s_waitcnt lgkmcnt(4)
v_exp_f32 v11, v67
v_mfma_f32_16x16x32_bf16 v[160:163], a[96:99], v[96:99], v[160:163]
s_add_u32 m0, s18, 102400
ds_read_b128 a[64:67], v2 offset:16384
v_add_f32 v26, v26, v11
v_mfma_f32_16x16x32_bf16 v[160:163], a[100:103], v[100:103], v[160:163]
buffer_load_dwordx4 v1, s[4:7], s12 offen offset:0 sc1 lds
v_mfma_f32_16x16x32_bf16 v[164:167], a[100:103], v[108:111], v[164:167]
ds_read_b128 a[68:71], v2 offset:17408
v_cvt_pk_bf16_f32 v113, v10, v11
v_mfma_f32_16x16x32_bf16 v[164:167], a[96:99], v[104:107], v[164:167]
v_mfma_f32_16x16x32_bf16 v[168:171], a[104:107], v[96:99], v[168:171]
ds_read_b128 a[72:75], v2 offset:18432
v_mfma_f32_16x16x32_bf16 v[168:171], a[108:111], v[100:103], v[168:171]
buffer_load_dwordx4 v1, s[4:7], s12 offen offset:1024 sc1 lds
v_mfma_f32_16x16x32_bf16 v[172:175], a[108:111], v[108:111], v[172:175]
ds_read_b128 a[76:79], v2 offset:19456
v_mfma_f32_16x16x32_bf16 v[172:175], a[104:107], v[104:107], v[172:175]
s_waitcnt lgkmcnt(4)
v_exp_f32 v12, v68
v_mfma_f32_16x16x32_bf16 v[176:179], a[112:115], v[96:99], v[176:179]
ds_read_b128 a[80:83], v2 offset:20480
v_mfma_f32_16x16x32_bf16 v[176:179], a[116:119], v[100:103], v[176:179]
buffer_load_dwordx4 v1, s[4:7], s12 offen offset:2048 sc1 lds
v_mfma_f32_16x16x32_bf16 v[180:183], a[116:119], v[108:111], v[180:183]
ds_read_b128 a[84:87], v2 offset:21504
v_mfma_f32_16x16x32_bf16 v[180:183], a[112:115], v[104:107], v[180:183]
v_exp_f32 v13, v69
v_mfma_f32_16x16x32_bf16 v[184:187], a[120:123], v[96:99], v[184:187]
ds_read_b128 a[88:91], v2 offset:22528
v_add_f32 v27, v12, v13
v_mfma_f32_16x16x32_bf16 v[184:187], a[124:127], v[100:103], v[184:187]
s_waitcnt lgkmcnt(4)
buffer_load_dwordx4 v1, s[4:7], s12 offen offset:3072 sc1 lds
v_mfma_f32_16x16x32_bf16 v[188:191], a[124:127], v[108:111], v[188:191]
s_add_u32 s12, s12, 28672
ds_read_b128 a[92:95], v2 offset:23552
v_cvt_pk_bf16_f32 v120, v12, v13
v_mfma_f32_16x16x32_bf16 v[188:191], a[120:123], v[104:107], v[188:191]
s_sub_u32 s13, s13, 1
v_exp_f32 v14, v70
v_mfma_f32_16x16x32_bf16 v[192:195], a[64:67], v[96:99], v[192:195]
s_cmp_eq_u32 s13, 0
ds_read_b128 a[96:99], v2 offset:24576
v_add_f32 v27, v27, v14
v_mfma_f32_16x16x32_bf16 v[192:195], a[68:71], v[100:103], v[192:195]
s_cselect_b32 s12, s14, s12
v_mfma_f32_16x16x32_bf16 v[196:199], a[68:71], v[108:111], v[196:199]
s_cselect_b32 s13, s15, s13
ds_read_b128 a[100:103], v2 offset:25600
v_mfma_f32_16x16x32_bf16 v[196:199], a[64:67], v[104:107], v[196:199]
s_cselect_b32 s14, 3221225472, s14
v_exp_f32 v15, v71
v_mfma_f32_16x16x32_bf16 v[200:203], a[72:75], v[96:99], v[200:203]
s_waitcnt lgkmcnt(4)
ds_read_b128 a[104:107], v2 offset:26624
v_add_f32 v27, v27, v15
v_mfma_f32_16x16x32_bf16 v[200:203], a[76:79], v[100:103], v[200:203]
v_exp_f32 v8, v72
v_mfma_f32_16x16x32_bf16 v[204:207], a[76:79], v[108:111], v[204:207]
ds_read_b128 a[108:111], v2 offset:27648
v_cvt_pk_bf16_f32 v121, v14, v15
v_mfma_f32_16x16x32_bf16 v[204:207], a[72:75], v[104:107], v[204:207]
v_exp_f32 v9, v73
v_mfma_f32_16x16x32_bf16 v[208:211], a[80:83], v[96:99], v[208:211]
ds_read_b128 a[112:115], v2 offset:28672
v_add_f32 v26, v26, v8
v_mfma_f32_16x16x32_bf16 v[208:211], a[84:87], v[100:103], v[208:211]
v_add_f32 v26, v26, v9
v_cvt_pk_bf16_f32 v114, v8, v9
v_mfma_f32_16x16x32_bf16 v[212:215], a[84:87], v[108:111], v[212:215]
ds_read_b128 a[116:119], v2 offset:29696
v_mfma_f32_16x16x32_bf16 v[212:215], a[80:83], v[104:107], v[212:215]
s_waitcnt lgkmcnt(4)
v_exp_f32 v10, v74
v_mfma_f32_16x16x32_bf16 v[216:219], a[88:91], v[96:99], v[216:219]
ds_read_b128 a[120:123], v2 offset:30720
v_add_f32 v26, v26, v10
v_mfma_f32_16x16x32_bf16 v[216:219], a[92:95], v[100:103], v[216:219]
v_exp_f32 v11, v75
v_mfma_f32_16x16x32_bf16 v[220:223], a[92:95], v[108:111], v[220:223]
s_waitcnt vmcnt(8)
ds_read_b128 a[124:127], v2 offset:31744
v_add_f32 v26, v26, v11
v_mfma_f32_16x16x32_bf16 v[220:223], a[88:91], v[104:107], v[220:223]
PAD_11:
s_cbranch_execz M_tret
s_barrier
v_mfma_f32_16x16x32_bf16 v[224:227], a[96:99], v[96:99], v[224:227]
ds_read_b128 a[64:67], v1 offset:0
v_cvt_pk_bf16_f32 v115, v10, v11
v_mfma_f32_16x16x32_bf16 v[224:227], a[100:103], v[100:103], v[224:227]
v_exp_f32 v12, v76
v_mfma_f32_16x16x32_bf16 v[228:231], a[100:103], v[108:111], v[228:231]
ds_read_b128 a[68:71], v1 offset:1024
v_add_f32 v27, v27, v12
v_mfma_f32_16x16x32_bf16 v[228:231], a[96:99], v[104:107], v[228:231]
s_waitcnt lgkmcnt(4)
v_mfma_f32_16x16x32_bf16 v[232:235], a[104:107], v[96:99], v[232:235]
ds_read_b128 a[72:75], v1 offset:2048
v_mfma_f32_16x16x32_bf16 v[232:235], a[108:111], v[100:103], v[232:235]
v_exp_f32 v13, v77
v_mfma_f32_16x16x32_bf16 v[236:239], a[108:111], v[108:111], v[236:239]
ds_read_b128 a[76:79], v1 offset:3072
v_add_f32 v27, v27, v13
v_mfma_f32_16x16x32_bf16 v[236:239], a[104:107], v[104:107], v[236:239]
v_exp_f32 v14, v78
v_mfma_f32_16x16x32_bf16 v[240:243], a[112:115], v[96:99], v[240:243]
ds_read_b128 a[80:83], v1 offset:4096
v_cvt_pk_bf16_f32 v122, v12, v13
v_mfma_f32_16x16x32_bf16 v[240:243], a[116:119], v[100:103], v[240:243]
v_exp_f32 v15, v79
v_mfma_f32_16x16x32_bf16 v[244:247], a[116:119], v[108:111], v[244:247]
ds_read_b128 a[84:87], v1 offset:5120
v_add_f32 v27, v27, v14
v_mfma_f32_16x16x32_bf16 v[244:247], a[112:115], v[104:107], v[244:247]
s_waitcnt lgkmcnt(4)
v_add_f32 v27, v27, v15
v_cvt_pk_bf16_f32 v123, v14, v15
v_mfma_f32_16x16x32_bf16 v[248:251], a[120:123], v[96:99], v[248:251]
ds_read_b128 a[88:91], v1 offset:6144
v_mfma_f32_16x16x32_bf16 v[248:251], a[124:127], v[100:103], v[248:251]
v_mfma_f32_16x16x32_bf16 v[252:255], a[124:127], v[108:111], v[252:255]
ds_read_b128 a[92:95], v1 offset:7168
v_mfma_f32_16x16x32_bf16 v[252:255], a[120:123], v[104:107], v[252:255]
v_cndmask_b32 v32, v16, v7, s[32:33]
v_cndmask_b32 v33, v16, v7, s[34:35]
v_cndmask_b32 v34, v16, v7, s[36:37]
v_cndmask_b32 v35, v16, v7, s[38:39]
s_nop 1
v_mfma_f32_16x16x32_bf16 v[32:35], a[64:67], a[0:3], v[32:35]
s_add_u32 m0, s18, 131072
ds_read_b128 a[96:99], v1 offset:8192
v_cndmask_b32 v40, v16, v7, s[40:41]
v_mfma_f32_16x16x32_bf16 v[32:35], a[68:71], a[4:7], v[32:35]
s_waitcnt lgkmcnt(4)
buffer_load_dwordx4 v1, s[4:7], s8 offen offset:0 sc1 lds
v_mfma_f32_16x16x32_bf16 v[32:35], a[72:75], a[8:11], v[32:35]
ds_read_b128 a[100:103], v1 offset:9216
v_cndmask_b32 v41, v16, v7, s[42:43]
v_mfma_f32_16x16x32_bf16 v[32:35], a[76:79], a[12:15], v[32:35]
v_cndmask_b32 v42, v16, v7, s[44:45]
v_cndmask_b32 v43, v16, v7, s[46:47]
v_mfma_f32_16x16x32_bf16 v[32:35], a[80:83], a[16:19], v[32:35]
s_waitcnt lgkmcnt(4)
ds_read_b128 a[104:107], v1 offset:10240
v_mfma_f32_16x16x32_bf16 v[32:35], a[84:87], a[20:23], v[32:35]
s_waitcnt lgkmcnt(4)
buffer_load_dwordx4 v1, s[4:7], s8 offen offset:1024 sc1 lds
v_mfma_f32_16x16x32_bf16 v[32:35], a[88:91], a[24:27], v[32:35]
s_waitcnt lgkmcnt(3)
ds_read_b128 a[108:111], v1 offset:11264
v_mfma_f32_16x16x32_bf16 v[32:35], a[92:95], a[28:31], v[32:35]
v_exp_f32 v8, v80
v_mfma_f32_16x16x32_bf16 v[36:39], a[64:67], a[32:35], v[20:23]
ds_read_b128 a[112:115], v1 offset:12288
v_add_f32 v26, v26, v8
v_mfma_f32_16x16x32_bf16 v[36:39], a[68:71], a[36:39], v[36:39]
buffer_load_dwordx4 v1, s[4:7], s8 offen offset:2048 sc1 lds
v_mfma_f32_16x16x32_bf16 v[36:39], a[72:75], a[40:43], v[36:39]
ds_read_b128 a[116:119], v1 offset:13312
v_mfma_f32_16x16x32_bf16 v[36:39], a[76:79], a[44:47], v[36:39]
v_exp_f32 v9, v81
v_mfma_f32_16x16x32_bf16 v[36:39], a[80:83], a[48:51], v[36:39]
ds_read_b128 a[120:123], v1 offset:14336
v_add_f32 v26, v26, v9
v_mfma_f32_16x16x32_bf16 v[36:39], a[84:87], a[52:55], v[36:39]
buffer_load_dwordx4 v1, s[4:7], s8 offen offset:3072 sc1 lds
v_mfma_f32_16x16x32_bf16 v[36:39], a[88:91], a[56:59], v[36:39]
s_add_u32 s8, s8, 4096
ds_read_b128 a[124:127], v1 offset:15360
v_cvt_pk_bf16_f32 v116, v8, v9
v_mfma_f32_16x16x32_bf16 v[36:39], a[92:95], a[60:63], v[36:39]
s_waitcnt lgkmcnt(4)
v_exp_f32 v10, v82
v_mfma_f32_16x16x32_bf16 v[40:43], a[96:99], a[0:3], v[40:43]
s_add_u32 m0, s18, 135168
ds_read_b128 a[64:67], v1 offset:16384
v_cndmask_b32 v48, v16, v7, s[48:49]
v_mfma_f32_16x16x32_bf16 v[40:43], a[100:103], a[4:7], v[40:43]
buffer_load_dwordx4 v1, s[4:7], s8 offen offset:0 sc1 lds
v_mfma_f32_16x16x32_bf16 v[40:43], a[104:107], a[8:11], v[40:43]
ds_read_b128 a[68:71], v1 offset:17408
v_cndmask_b32 v49, v16, v7, s[50:51]
v_mfma_f32_16x16x32_bf16 v[40:43], a[108:111], a[12:15], v[40:43]
s_waitcnt lgkmcnt(4)
v_cndmask_b32 v50, v16, v7, s[52:53]
v_cndmask_b32 v51, v16, v7, s[54:55]
v_mfma_f32_16x16x32_bf16 v[40:43], a[112:115], a[16:19], v[40:43]
ds_read_b128 a[72:75], v1 offset:18432
v_add_f32 v26, v26, v10
v_mfma_f32_16x16x32_bf16 v[40:43], a[116:119], a[20:23], v[40:43]
s_waitcnt lgkmcnt(4)
buffer_load_dwordx4 v1, s[4:7], s8 offen offset:1024 sc1 lds
v_mfma_f32_16x16x32_bf16 v[40:43], a[120:123], a[24:27], v[40:43]
s_waitcnt lgkmcnt(3)
ds_read_b128 a[76:79], v1 offset:19456
v_mfma_f32_16x16x32_bf16 v[40:43], a[124:127], a[28:31], v[40:43]
v_exp_f32 v11, v83
v_mfma_f32_16x16x32_bf16 v[44:47], a[96:99], a[32:35], v[20:23]
ds_read_b128 a[80:83], v1 offset:20480
v_add_f32 v26, v26, v11
v_mfma_f32_16x16x32_bf16 v[44:47], a[100:103], a[36:39], v[44:47]
buffer_load_dwordx4 v1, s[4:7], s8 offen offset:2048 sc1 lds
v_mfma_f32_16x16x32_bf16 v[44:47], a[104:107], a[40:43], v[44:47]
ds_read_b128 a[84:87], v1 offset:21504
v_cvt_pk_bf16_f32 v117, v10, v11
v_mfma_f32_16x16x32_bf16 v[44:47], a[108:111], a[44:47], v[44:47]
v_exp_f32 v12, v84
v_mfma_f32_16x16x32_bf16 v[44:47], a[112:115], a[48:51], v[44:47]
ds_read_b128 a[88:91], v1 offset:22528
v_add_f32 v27, v27, v12
v_mfma_f32_16x16x32_bf16 v[44:47], a[116:119], a[52:55], v[44:47]
buffer_load_dwordx4 v1, s[4:7], s8 offen offset:3072 sc1 lds
v_mfma_f32_16x16x32_bf16 v[44:47], a[120:123], a[56:59], v[44:47]
s_waitcnt lgkmcnt(2)
s_add_u32 s8, s8, 28672
ds_read_b128 a[92:95], v1 offset:23552
v_mfma_f32_16x16x32_bf16 v[44:47], a[124:127], a[60:63], v[44:47]
s_sub_u32 s9, s9, 1
v_exp_f32 v13, v85
v_mfma_f32_16x16x32_bf16 v[48:51], a[64:67], a[0:3], v[48:51]
s_cmp_eq_u32 s9, 0
ds_read_b128 a[96:99], v1 offset:24576
v_cndmask_b32 v56, v16, v7, s[56:57]
v_mfma_f32_16x16x32_bf16 v[48:51], a[68:71], a[4:7], v[48:51]
s_cselect_b32 s8, s10, s8
v_cndmask_b32 v57, v16, v7, s[58:59]
v_cndmask_b32 v58, v16, v7, s[60:61]
v_mfma_f32_16x16x32_bf16 v[48:51], a[72:75], a[8:11], v[48:51]
s_cselect_b32 s9, s11, s9
ds_read_b128 a[100:103], v1 offset:25600
v_cndmask_b32 v59, v16, v7, s[62:63]
v_mfma_f32_16x16x32_bf16 v[48:51], a[76:79], a[12:15], v[48:51]
s_cselect_b32 s10, 3221225472, s10
v_exp_f32 v14, v86
v_mfma_f32_16x16x32_bf16 v[48:51], a[80:83], a[16:19], v[48:51]
s_waitcnt lgkmcnt(4)
ds_read_b128 a[104:107], v1 offset:26624
v_add_f32 v27, v27, v13
v_cvt_pk_bf16_f32 v124, v12, v13
v_mfma_f32_16x16x32_bf16 v[48:51], a[84:87], a[20:23], v[48:51]
s_waitcnt lgkmcnt(4)
v_exp_f32 v15, v87
v_mfma_f32_16x16x32_bf16 v[48:51], a[88:91], a[24:27], v[48:51]
s_waitcnt lgkmcnt(3)
ds_read_b128 a[108:111], v1 offset:27648
v_add_f32 v27, v27, v14
v_mfma_f32_16x16x32_bf16 v[48:51], a[92:95], a[28:31], v[48:51]
v_exp_f32 v8, v88
v_mfma_f32_16x16x32_bf16 v[52:55], a[64:67], a[32:35], v[20:23]
ds_read_b128 a[112:115], v1 offset:28672
v_add_f32 v27, v27, v15
v_mfma_f32_16x16x32_bf16 v[52:55], a[68:71], a[36:39], v[52:55]
v_exp_f32 v9, v89
v_mfma_f32_16x16x32_bf16 v[52:55], a[72:75], a[40:43], v[52:55]
ds_read_b128 a[116:119], v1 offset:29696
v_cvt_pk_bf16_f32 v125, v14, v15
v_mfma_f32_16x16x32_bf16 v[52:55], a[76:79], a[44:47], v[52:55]
v_exp_f32 v10, v90
v_mfma_f32_16x16x32_bf16 v[52:55], a[80:83], a[48:51], v[52:55]
ds_read_b128 a[120:123], v1 offset:30720
v_add_f32 v26, v26, v8
v_mfma_f32_16x16x32_bf16 v[52:55], a[84:87], a[52:55], v[52:55]
v_exp_f32 v11, v91
v_mfma_f32_16x16x32_bf16 v[52:55], a[88:91], a[56:59], v[52:55]
s_waitcnt vmcnt(8) lgkmcnt(4)
ds_read_b128 a[124:127], v1 offset:31744
v_add_f32 v26, v26, v9
v_cvt_pk_bf16_f32 v118, v8, v9
v_mfma_f32_16x16x32_bf16 v[52:55], a[92:95], a[60:63], v[52:55]
s_barrier
v_mfma_f32_16x16x32_bf16 v[56:59], a[96:99], a[0:3], v[56:59]
ds_read_b128 a[64:67], v2 offset:32768
v_add_f32 v26, v26, v10
v_mfma_f32_16x16x32_bf16 v[56:59], a[100:103], a[4:7], v[56:59]
v_exp_f32 v12, v92
v_mfma_f32_16x16x32_bf16 v[56:59], a[104:107], a[8:11], v[56:59]
s_waitcnt lgkmcnt(4)
ds_read_b128 a[68:71], v2 offset:33792
v_add_f32 v26, v26, v11
v_cvt_pk_bf16_f32 v119, v10, v11
v_mfma_f32_16x16x32_bf16 v[56:59], a[108:111], a[12:15], v[56:59]
v_exp_f32 v13, v93
v_mfma_f32_16x16x32_bf16 v[56:59], a[112:115], a[16:19], v[56:59]
s_waitcnt lgkmcnt(4)
ds_read_b128 a[72:75], v2 offset:34816
v_add_f32 v27, v27, v12
v_mfma_f32_16x16x32_bf16 v[56:59], a[116:119], a[20:23], v[56:59]
s_waitcnt lgkmcnt(4)
v_exp_f32 v14, v94
v_mfma_f32_16x16x32_bf16 v[56:59], a[120:123], a[24:27], v[56:59]
s_waitcnt lgkmcnt(3)
ds_read_b128 a[76:79], v2 offset:35840
v_add_f32 v27, v27, v13
v_mfma_f32_16x16x32_bf16 v[56:59], a[124:127], a[28:31], v[56:59]
v_exp_f32 v15, v95
v_mfma_f32_16x16x32_bf16 v[60:63], a[96:99], a[32:35], v[20:23]
ds_read_b128 a[80:83], v2 offset:36864
v_cvt_pk_bf16_f32 v126, v12, v13
v_mfma_f32_16x16x32_bf16 v[60:63], a[100:103], a[36:39], v[60:63]
v_add_f32 v27, v27, v14
v_add_f32 v27, v27, v15
v_mfma_f32_16x16x32_bf16 v[60:63], a[104:107], a[40:43], v[60:63]
ds_read_b128 a[84:87], v2 offset:37888
v_cvt_pk_bf16_f32 v127, v14, v15
v_mfma_f32_16x16x32_bf16 v[60:63], a[108:111], a[44:47], v[60:63]
v_add_f32 v28, v26, v27
v_cmp_nge_f32 vcc, s25, v28
v_mfma_f32_16x16x32_bf16 v[60:63], a[112:115], a[48:51], v[60:63]
ds_read_b128 a[88:91], v2 offset:38912
v_mfma_f32_16x16x32_bf16 v[60:63], a[116:119], a[52:55], v[60:63]
v_mfma_f32_16x16x32_bf16 v[60:63], a[120:123], a[56:59], v[60:63]
ds_read_b128 a[92:95], v2 offset:39936
v_mfma_f32_16x16x32_bf16 v[60:63], a[124:127], a[60:63], v[60:63]
s_waitcnt lgkmcnt(4)
s_cbranch_vccnz Lstub_6
Lback_7:
v_mfma_f32_16x16x32_bf16 v[128:131], a[64:67], v[112:115], v[128:131]
s_add_u32 m0, s18, 65536
ds_read_b128 a[96:99], v2 offset:40960
v_add_f32 v24, v24, v26
v_mfma_f32_16x16x32_bf16 v[128:131], a[68:71], v[116:119], v[128:131]
buffer_load_dwordx4 v1, s[4:7], s12 offen offset:0 sc1 lds
v_mfma_f32_16x16x32_bf16 v[132:135], a[68:71], v[124:127], v[132:135]
ds_read_b128 a[100:103], v2 offset:41984
v_add_f32 v25, v25, v27
v_mfma_f32_16x16x32_bf16 v[132:135], a[64:67], v[120:123], v[132:135]
v_exp_f32 v8, v32
v_mfma_f32_16x16x32_bf16 v[136:139], a[72:75], v[112:115], v[136:139]
ds_read_b128 a[104:107], v2 offset:43008
v_mfma_f32_16x16x32_bf16 v[136:139], a[76:79], v[116:119], v[136:139]
buffer_load_dwordx4 v1, s[4:7], s12 offen offset:1024 sc1 lds
v_mfma_f32_16x16x32_bf16 v[140:143], a[76:79], v[124:127], v[140:143]
ds_read_b128 a[108:111], v2 offset:44032
v_mfma_f32_16x16x32_bf16 v[140:143], a[72:75], v[120:123], v[140:143]
s_waitcnt lgkmcnt(4)
v_exp_f32 v9, v33
v_mfma_f32_16x16x32_bf16 v[144:147], a[80:83], v[112:115], v[144:147]
ds_read_b128 a[112:115], v2 offset:45056
v_add_f32 v26, v8, v9
v_mfma_f32_16x16x32_bf16 v[144:147], a[84:87], v[116:119], v[144:147]
buffer_load_dwordx4 v1, s[4:7], s12 offen offset:2048 sc1 lds
v_mfma_f32_16x16x32_bf16 v[148:151], a[84:87], v[124:127], v[148:151]
ds_read_b128 a[116:119], v2 offset:46080
v_cvt_pk_bf16_f32 v96, v8, v9
v_mfma_f32_16x16x32_bf16 v[148:151], a[80:83], v[120:123], v[148:151]
v_exp_f32 v10, v34
v_mfma_f32_16x16x32_bf16 v[152:155], a[88:91], v[112:115], v[152:155]
ds_read_b128 a[120:123], v2 offset:47104
v_add_f32 v26, v26, v10
v_mfma_f32_16x16x32_bf16 v[152:155], a[92:95], v[116:119], v[152:155]
buffer_load_dwordx4 v1, s[4:7], s12 offen offset:3072 sc1 lds
v_mfma_f32_16x16x32_bf16 v[156:159], a[92:95], v[124:127], v[156:159]
s_add_u32 s12, s12, 4096
ds_read_b128 a[124:127], v2 offset:48128
v_mfma_f32_16x16x32_bf16 v[156:159], a[88:91], v[120:123], v[156:159]
s_waitcnt lgkmcnt(4)
v_exp_f32 v11, v35
v_mfma_f32_16x16x32_bf16 v[160:163], a[96:99], v[112:115], v[160:163]
s_add_u32 m0, s18, 69632
ds_read_b128 a[64:67], v2 offset:49152
v_add_f32 v26, v26, v11
v_mfma_f32_16x16x32_bf16 v[160:163], a[100:103], v[116:119], v[160:163]
buffer_load_dwordx4 v1, s[4:7], s12 offen offset:0 sc1 lds
v_mfma_f32_16x16x32_bf16 v[164:167], a[100:103], v[124:127], v[164:167]
ds_read_b128 a[68:71], v2 offset:50176
v_cvt_pk_bf16_f32 v97, v10, v11
v_mfma_f32_16x16x32_bf16 v[164:167], a[96:99], v[120:123], v[164:167]
v_mfma_f32_16x16x32_bf16 v[168:171], a[104:107], v[112:115], v[168:171]
ds_read_b128 a[72:75], v2 offset:51200
v_mfma_f32_16x16x32_bf16 v[168:171], a[108:111], v[116:119], v[168:171]
buffer_load_dwordx4 v1, s[4:7], s12 offen offset:1024 sc1 lds
v_mfma_f32_16x16x32_bf16 v[172:175], a[108:111], v[124:127], v[172:175]
ds_read_b128 a[76:79], v2 offset:52224
v_mfma_f32_16x16x32_bf16 v[172:175], a[104:107], v[120:123], v[172:175]
s_waitcnt lgkmcnt(4)
v_exp_f32 v12, v36
v_mfma_f32_16x16x32_bf16 v[176:179], a[112:115], v[112:115], v[176:179]
ds_read_b128 a[80:83], v2 offset:53248
v_mfma_f32_16x16x32_bf16 v[176:179], a[116:119], v[116:119], v[176:179]
buffer_load_dwordx4 v1, s[4:7], s12 offen offset:2048 sc1 lds
v_mfma_f32_16x16x32_bf16 v[180:183], a[116:119], v[124:127], v[180:183]
ds_read_b128 a[84:87], v2 offset:54272
v_mfma_f32_16x16x32_bf16 v[180:183], a[112:115], v[120:123], v[180:183]
v_exp_f32 v13, v37
v_mfma_f32_16x16x32_bf16 v[184:187], a[120:123], v[112:115], v[184:187]
ds_read_b128 a[88:91], v2 offset:55296
v_add_f32 v27, v12, v13
v_mfma_f32_16x16x32_bf16 v[184:187], a[124:127], v[116:119], v[184:187]
s_waitcnt lgkmcnt(4)
buffer_load_dwordx4 v1, s[4:7], s12 offen offset:3072 sc1 lds
v_mfma_f32_16x16x32_bf16 v[188:191], a[124:127], v[124:127], v[188:191]
s_add_u32 s12, s12, 28672
ds_read_b128 a[92:95], v2 offset:56320
v_cvt_pk_bf16_f32 v104, v12, v13
v_mfma_f32_16x16x32_bf16 v[188:191], a[120:123], v[120:123], v[188:191]
s_sub_u32 s13, s13, 1
v_exp_f32 v14, v38
v_mfma_f32_16x16x32_bf16 v[192:195], a[64:67], v[112:115], v[192:195]
s_cmp_eq_u32 s13, 0
ds_read_b128 a[96:99], v2 offset:57344
v_add_f32 v27, v27, v14
v_mfma_f32_16x16x32_bf16 v[192:195], a[68:71], v[116:119], v[192:195]
s_cselect_b32 s12, s14, s12
v_exp_f32 v15, v39
v_mfma_f32_16x16x32_bf16 v[196:199], a[68:71], v[124:127], v[196:199]
s_cselect_b32 s13, s15, s13
ds_read_b128 a[100:103], v2 offset:58368
v_add_f32 v27, v27, v15
v_mfma_f32_16x16x32_bf16 v[196:199], a[64:67], v[120:123], v[196:199]
s_cselect_b32 s14, 3221225472, s14
v_cvt_pk_bf16_f32 v105, v14, v15
v_mfma_f32_16x16x32_bf16 v[200:203], a[72:75], v[112:115], v[200:203]
s_waitcnt lgkmcnt(4)
ds_read_b128 a[104:107], v2 offset:59392
v_mfma_f32_16x16x32_bf16 v[200:203], a[76:79], v[116:119], v[200:203]
buffer_load_dword v3, off, s[4:7], s80 sc1
v_mfma_f32_16x16x32_bf16 v[204:207], a[76:79], v[124:127], v[204:207]
ds_read_b128 a[108:111], v2 offset:60416
v_mfma_f32_16x16x32_bf16 v[204:207], a[72:75], v[120:123], v[204:207]
v_exp_f32 v8, v40
v_mfma_f32_16x16x32_bf16 v[208:211], a[80:83], v[112:115], v[208:211]
ds_read_b128 a[112:115], v2 offset:61440
v_add_f32 v26, v26, v8
v_mfma_f32_16x16x32_bf16 v[208:211], a[84:87], v[116:119], v[208:211]
v_exp_f32 v9, v41
v_mfma_f32_16x16x32_bf16 v[212:215], a[84:87], v[124:127], v[212:215]
ds_read_b128 a[116:119], v2 offset:62464
v_add_f32 v26, v26, v9
v_mfma_f32_16x16x32_bf16 v[212:215], a[80:83], v[120:123], v[212:215]
s_waitcnt lgkmcnt(4)
v_exp_f32 v10, v42
v_mfma_f32_16x16x32_bf16 v[216:219], a[88:91], v[112:115], v[216:219]
ds_read_b128 a[120:123], v2 offset:63488
v_cvt_pk_bf16_f32 v98, v8, v9
v_mfma_f32_16x16x32_bf16 v[216:219], a[92:95], v[116:119], v[216:219]
v_exp_f32 v11, v43
v_mfma_f32_16x16x32_bf16 v[220:223], a[92:95], v[124:127], v[220:223]
s_waitcnt vmcnt(9)
ds_read_b128 a[124:127], v2 offset:64512
v_add_f32 v26, v26, v10
v_mfma_f32_16x16x32_bf16 v[220:223], a[88:91], v[120:123], v[220:223]
s_barrier
v_mfma_f32_16x16x32_bf16 v[224:227], a[96:99], v[112:115], v[224:227]
ds_read_b128 a[64:67], v4 offset:0
v_add_f32 v26, v26, v11
v_mfma_f32_16x16x32_bf16 v[224:227], a[100:103], v[116:119], v[224:227]
v_cvt_pk_bf16_f32 v99, v10, v11
v_mfma_f32_16x16x32_bf16 v[228:231], a[100:103], v[124:127], v[228:231]
ds_read_b128 a[68:71], v4 offset:1024
v_mfma_f32_16x16x32_bf16 v[228:231], a[96:99], v[120:123], v[228:231]
s_waitcnt lgkmcnt(4)
v_exp_f32 v12, v44
v_mfma_f32_16x16x32_bf16 v[232:235], a[104:107], v[112:115], v[232:235]
ds_read_b128 a[72:75], v4 offset:2048
v_add_f32 v27, v27, v12
v_mfma_f32_16x16x32_bf16 v[232:235], a[108:111], v[116:119], v[232:235]
v_exp_f32 v13, v45
v_mfma_f32_16x16x32_bf16 v[236:239], a[108:111], v[124:127], v[236:239]
ds_read_b128 a[76:79], v4 offset:3072
v_add_f32 v27, v27, v13
v_mfma_f32_16x16x32_bf16 v[236:239], a[104:107], v[120:123], v[236:239]
v_exp_f32 v14, v46
v_mfma_f32_16x16x32_bf16 v[240:243], a[112:115], v[112:115], v[240:243]
ds_read_b128 a[80:83], v4 offset:4096
v_cvt_pk_bf16_f32 v106, v12, v13
v_mfma_f32_16x16x32_bf16 v[240:243], a[116:119], v[116:119], v[240:243]
v_exp_f32 v15, v47
v_mfma_f32_16x16x32_bf16 v[244:247], a[116:119], v[124:127], v[244:247]
ds_read_b128 a[84:87], v4 offset:5120
v_add_f32 v27, v27, v14
v_mfma_f32_16x16x32_bf16 v[244:247], a[112:115], v[120:123], v[244:247]
s_waitcnt lgkmcnt(4)
v_add_f32 v27, v27, v15
v_cvt_pk_bf16_f32 v107, v14, v15
v_mfma_f32_16x16x32_bf16 v[248:251], a[120:123], v[112:115], v[248:251]
ds_read_b128 a[88:91], v4 offset:6144
v_mfma_f32_16x16x32_bf16 v[248:251], a[124:127], v[116:119], v[248:251]
v_mfma_f32_16x16x32_bf16 v[252:255], a[124:127], v[124:127], v[252:255]
ds_read_b128 a[92:95], v4 offset:7168
v_mfma_f32_16x16x32_bf16 v[252:255], a[120:123], v[120:123], v[252:255]
K2_dx1:
v_cndmask_b32 v68, v20, v7, s[32:33]
v_cndmask_b32 v69, v20, v7, s[34:35]
v_cndmask_b32 v70, v20, v7, s[36:37]
v_cndmask_b32 v71, v20, v7, s[38:39]
s_nop 1
v_mfma_f32_16x16x32_bf16 v[68:71], a[64:67], a[32:35], v[68:71]
s_add_u32 m0, s18, 0
ds_read_b128 a[96:99], v4 offset:8192
v_cndmask_b32 v76, v20, v7, s[40:41]
v_cndmask_b32 v79, v20, v7, s[46:47]
v_mfma_f32_16x16x32_bf16 v[68:71], a[68:71], a[36:39], v[68:71]
s_waitcnt lgkmcnt(4)
ds_read_b128 a[100:103], v4 offset:9216
buffer_load_dwordx4 v1, s[4:7], s12 offen offset:0 sc1 lds
v_mfma_f32_16x16x32_bf16 v[68:71], a[72:75], a[40:43], v[68:71]
ds_read_b128 a[104:107], v4 offset:10240
v_cndmask_b32 v77, v20, v7, s[42:43]
v_mfma_f32_16x16x32_bf16 v[68:71], a[76:79], a[44:47], v[68:71]
ds_read_b128 a[108:111], v4 offset:11264
buffer_load_dwordx4 v1, s[4:7], s12 offen offset:1024 sc1 lds
v_mfma_f32_16x16x32_bf16 v[68:71], a[80:83], a[48:51], v[68:71]
s_waitcnt lgkmcnt(6)
ds_read_b128 a[112:115], v4 offset:12288
v_cndmask_b32 v78, v20, v7, s[44:45]
v_mfma_f32_16x16x32_bf16 v[68:71], a[84:87], a[52:55], v[68:71]
s_waitcnt lgkmcnt(6)
ds_read_b128 a[116:119], v4 offset:13312
buffer_load_dwordx4 v1, s[4:7], s12 offen offset:2048 sc1 lds
v_mfma_f32_16x16x32_bf16 v[68:71], a[88:91], a[56:59], v[68:71]
s_waitcnt lgkmcnt(6)
ds_read_b128 a[120:123], v4 offset:14336
v_exp_f32 v8, v48
v_exp_f32 v9, v49
v_exp_f32 v10, v50
v_mfma_f32_16x16x32_bf16 v[68:71], a[92:95], a[60:63], v[68:71]
s_waitcnt lgkmcnt(5)
ds_read_b128 a[124:127], v4 offset:15360
buffer_load_dwordx4 v1, s[4:7], s12 offen offset:3072 sc1 lds
v_add_f32 v26, v26, v8
v_add_f32 v26, v26, v9
v_cvt_pk_bf16_f32 v100, v8, v9
v_add_f32 v26, v26, v10
v_mfma_f32_16x16x32_bf16 v[76:79], a[96:99], a[32:35], v[76:79]
s_add_u32 s12, s12, 4096
s_add_u32 m0, s18, 4096
ds_read_b128 a[64:67], v4 offset:16384
v_cndmask_b32 v86, v20, v7, s[52:53]
v_cndmask_b32 v87, v20, v7, s[54:55]
v_mfma_f32_16x16x32_bf16 v[76:79], a[100:103], a[36:39], v[76:79]
s_waitcnt lgkmcnt(6)
ds_read_b128 a[68:71], v4 offset:17408
buffer_load_dwordx4 v1, s[4:7], s12 offen offset:0 sc1 lds
v_mfma_f32_16x16x32_bf16 v[76:79], a[104:107], a[40:43], v[76:79]
s_waitcnt lgkmcnt(6)
ds_read_b128 a[72:75], v4 offset:18432
v_cndmask_b32 v84, v20, v7, s[48:49]
v_mfma_f32_16x16x32_bf16 v[76:79], a[108:111], a[44:47], v[76:79]
s_waitcnt lgkmcnt(6)
ds_read_b128 a[76:79], v4 offset:19456
buffer_load_dwordx4 v1, s[4:7], s12 offen offset:1024 sc1 lds
v_mfma_f32_16x16x32_bf16 v[76:79], a[112:115], a[48:51], v[76:79]
s_waitcnt lgkmcnt(6)
ds_read_b128 a[80:83], v4 offset:20480
v_cndmask_b32 v85, v20, v7, s[50:51]
v_mfma_f32_16x16x32_bf16 v[76:79], a[116:119], a[52:55], v[76:79]
s_waitcnt lgkmcnt(6)
ds_read_b128 a[84:87], v4 offset:21504
buffer_load_dwordx4 v1, s[4:7], s12 offen offset:2048 sc1 lds
v_mfma_f32_16x16x32_bf16 v[76:79], a[120:123], a[56:59], v[76:79]
s_waitcnt lgkmcnt(6)
ds_read_b128 a[88:91], v4 offset:22528
v_exp_f32 v11, v51
v_exp_f32 v12, v52
v_mfma_f32_16x16x32_bf16 v[76:79], a[124:127], a[60:63], v[76:79]
s_waitcnt lgkmcnt(1)
ds_read_b128 a[92:95], v4 offset:23552
buffer_load_dwordx4 v1, s[4:7], s12 offen offset:3072 sc1 lds
v_add_f32 v26, v26, v11
v_cvt_pk_bf16_f32 v101, v10, v11
v_add_f32 v27, v27, v12
v_mfma_f32_16x16x32_bf16 v[84:87], a[64:67], a[32:35], v[84:87]
s_add_u32 s12, s12, 28672
ds_read_b128 a[96:99], v4 offset:24576
v_cndmask_b32 v92, v20, v7, s[56:57]
v_mfma_f32_16x16x32_bf16 v[84:87], a[68:71], a[36:39], v[84:87]
s_sub_u32 s13, s13, 1
ds_read_b128 a[100:103], v4 offset:25600
v_cndmask_b32 v93, v20, v7, s[58:59]
v_mfma_f32_16x16x32_bf16 v[84:87], a[72:75], a[40:43], v[84:87]
s_cmp_eq_u32 s13, 0
ds_read_b128 a[104:107], v4 offset:26624
v_cndmask_b32 v94, v20, v7, s[60:61]
v_mfma_f32_16x16x32_bf16 v[84:87], a[76:79], a[44:47], v[84:87]
s_cselect_b32 s12, s14, s12
ds_read_b128 a[108:111], v4 offset:27648
v_cndmask_b32 v95, v20, v7, s[62:63]
v_mfma_f32_16x16x32_bf16 v[84:87], a[80:83], a[48:51], v[84:87]
s_cselect_b32 s13, s15, s13
ds_read_b128 a[112:115], v4 offset:28672
v_exp_f32 v13, v53
v_exp_f32 v14, v54
v_mfma_f32_16x16x32_bf16 v[84:87], a[84:87], a[52:55], v[84:87]
s_waitcnt lgkmcnt(6)
s_cselect_b32 s14, 3221225472, s14
ds_read_b128 a[116:119], v4 offset:29696
v_exp_f32 v15, v55
v_exp_f32 v8, v56
v_exp_f32 v9, v57
v_add_f32 v27, v27, v13
v_cvt_pk_bf16_f32 v108, v12, v13
v_add_f32 v27, v27, v14
v_mfma_f32_16x16x32_bf16 v[84:87], a[88:91], a[56:59], v[84:87]
s_waitcnt lgkmcnt(6)
ds_read_b128 a[120:123], v4 offset:30720
v_exp_f32 v10, v58
v_exp_f32 v11, v59
v_add_f32 v27, v27, v15
v_cvt_pk_bf16_f32 v109, v14, v15
v_mfma_f32_16x16x32_bf16 v[84:87], a[92:95], a[60:63], v[84:87]
s_waitcnt vmcnt(8) lgkmcnt(6)
s_barrier
ds_read_b128 a[124:127], v4 offset:31744
v_mfma_f32_16x16x32_bf16 v[92:95], a[96:99], a[32:35], v[92:95]
s_waitcnt lgkmcnt(6)
ds_read_b128 a[64:67], v2 offset:0
v_exp_f32 v12, v60
v_exp_f32 v13, v61
v_mfma_f32_16x16x32_bf16 v[92:95], a[100:103], a[36:39], v[92:95]
s_waitcnt lgkmcnt(6)
ds_read_b128 a[68:71], v2 offset:1024
v_exp_f32 v14, v62
v_exp_f32 v15, v63
v_mfma_f32_16x16x32_bf16 v[92:95], a[104:107], a[40:43], v[92:95]
s_waitcnt lgkmcnt(6)
ds_read_b128 a[72:75], v2 offset:2048
v_add_f32 v26, v26, v8
v_add_f32 v26, v26, v9
v_cvt_pk_bf16_f32 v102, v8, v9
v_mfma_f32_16x16x32_bf16 v[92:95], a[108:111], a[44:47], v[92:95]
s_waitcnt lgkmcnt(6)
ds_read_b128 a[76:79], v2 offset:3072
v_add_f32 v26, v26, v10
v_add_f32 v26, v26, v11
v_cvt_pk_bf16_f32 v103, v10, v11
v_mfma_f32_16x16x32_bf16 v[92:95], a[112:115], a[48:51], v[92:95]
s_waitcnt lgkmcnt(6)
ds_read_b128 a[80:83], v2 offset:4096
v_add_f32 v27, v27, v12
v_mfma_f32_16x16x32_bf16 v[92:95], a[116:119], a[52:55], v[92:95]
s_waitcnt lgkmcnt(6)
ds_read_b128 a[84:87], v2 offset:5120
v_add_f32 v27, v27, v13
v_cvt_pk_bf16_f32 v110, v12, v13
v_mfma_f32_16x16x32_bf16 v[92:95], a[120:123], a[56:59], v[92:95]
s_waitcnt lgkmcnt(6)
ds_read_b128 a[88:91], v2 offset:6144
v_add_f32 v27, v27, v14
v_add_f32 v27, v27, v15
v_cvt_pk_bf16_f32 v111, v14, v15
v_mfma_f32_16x16x32_bf16 v[92:95], a[124:127], a[60:63], v[92:95]
s_waitcnt lgkmcnt(6)
ds_read_b128 a[92:95], v2 offset:7168
v_add_f32 v28, v26, v27
v_cmp_nge_f32 vcc, s25, v28
s_cbranch_vccnz Lstub_8
Lback_9:
s_cmp_lg_u32 s24, 1
s_cbranch_scc1 K2_plain
v_cmp_gt_u32 vcc, 1, v3
s_cbranch_vccnz K2_tspin
K2_tok:
v_mfma_f32_16x16x32_bf16 v[128:131], a[64:67], v[96:99], v[128:131]
s_waitcnt lgkmcnt(6)
ds_read_b128 a[96:99], v2 offset:8192
v_add_f32 v24, v24, v26
v_mfma_f32_16x16x32_bf16 v[128:131], a[68:71], v[100:103], v[128:131]
buffer_load_dwordx4 v[28:31], v1, s[4:7], s27 offen sc1
v_mfma_f32_16x16x32_bf16 v[132:135], a[68:71], v[108:111], v[132:135]
ds_read_b128 a[100:103], v2 offset:9216
v_add_f32 v25, v25, v27
v_mfma_f32_16x16x32_bf16 v[132:135], a[64:67], v[104:107], v[132:135]
s_waitcnt lgkmcnt(6)
v_exp_f32 v8, v68
v_mfma_f32_16x16x32_bf16 v[136:139], a[72:75], v[96:99], v[136:139]
s_add_u32 s22, s76, 0
ds_read_b128 a[104:107], v2 offset:10240
v_exp_f32 v9, v69
v_mfma_f32_16x16x32_bf16 v[136:139], a[76:79], v[100:103], v[136:139]
buffer_load_dwordx4 v[32:35], v1, s[4:7], s22 offen offset:0 sc1
v_mfma_f32_16x16x32_bf16 v[140:143], a[76:79], v[108:111], v[140:143]
ds_read_b128 a[108:111], v2 offset:11264
v_add_f32 v27, v8, v9
v_mfma_f32_16x16x32_bf16 v[140:143], a[72:75], v[104:107], v[140:143]
s_waitcnt lgkmcnt(5)
v_exp_f32 v10, v70
v_mfma_f32_16x16x32_bf16 v[144:147], a[80:83], v[96:99], v[144:147]
ds_read_b128 a[112:115], v2 offset:12288
v_cvt_pk_bf16_f32 v120, v8, v9
v_mfma_f32_16x16x32_bf16 v[144:147], a[84:87], v[100:103], v[144:147]
buffer_load_dwordx4 v[36:39], v1, s[4:7], s22 offen offset:1024 sc1
v_mfma_f32_16x16x32_bf16 v[148:151], a[84:87], v[108:111], v[148:151]
ds_read_b128 a[116:119], v2 offset:13312
v_add_f32 v27, v27, v10
v_mfma_f32_16x16x32_bf16 v[148:151], a[80:83], v[104:107], v[148:151]
v_exp_f32 v11, v71
v_mfma_f32_16x16x32_bf16 v[152:155], a[88:91], v[96:99], v[152:155]
s_waitcnt lgkmcnt(4)
ds_read_b128 a[120:123], v2 offset:14336
v_add_f32 v27, v27, v11
v_mfma_f32_16x16x32_bf16 v[152:155], a[92:95], v[100:103], v[152:155]
buffer_load_dwordx4 v[40:43], v1, s[4:7], s22 offen offset:2048 sc1
v_mfma_f32_16x16x32_bf16 v[156:159], a[92:95], v[108:111], v[156:159]
ds_read_b128 a[124:127], v2 offset:15360
v_cvt_pk_bf16_f32 v121, v10, v11
v_mfma_f32_16x16x32_bf16 v[156:159], a[88:91], v[104:107], v[156:159]
v_exp_f32 v12, v76
v_mfma_f32_16x16x32_bf16 v[160:163], a[96:99], v[96:99], v[160:163]
ds_read_b128 a[64:67], v2 offset:16384
v_add_f32 v27, v27, v12
v_mfma_f32_16x16x32_bf16 v[160:163], a[100:103], v[100:103], v[160:163]
buffer_load_dwordx4 v[44:47], v1, s[4:7], s22 offen offset:3072 sc1
v_mfma_f32_16x16x32_bf16 v[164:167], a[100:103], v[108:111], v[164:167]
PAD_12:
s_cbranch_execz M_tret
ds_read_b128 a[68:71], v2 offset:17408
v_mfma_f32_16x16x32_bf16 v[164:167], a[96:99], v[104:107], v[164:167]
s_waitcnt lgkmcnt(4)
v_exp_f32 v13, v77
v_mfma_f32_16x16x32_bf16 v[168:171], a[104:107], v[96:99], v[168:171]
s_add_u32 s22, s76, 4096
ds_read_b128 a[72:75], v2 offset:18432
v_add_f32 v27, v27, v13
v_mfma_f32_16x16x32_bf16 v[168:171], a[108:111], v[100:103], v[168:171]
buffer_load_dwordx4 v[48:51], v1, s[4:7], s22 offen offset:0 sc1
v_mfma_f32_16x16x32_bf16 v[172:175], a[108:111], v[108:111], v[172:175]
ds_read_b128 a[76:79], v2 offset:19456
v_exp_f32 v14, v78
v_mfma_f32_16x16x32_bf16 v[172:175], a[104:107], v[104:107], v[172:175]
v_exp_f32 v15, v79
v_mfma_f32_16x16x32_bf16 v[176:179], a[112:115], v[96:99], v[176:179]
ds_read_b128 a[80:83], v2 offset:20480
v_cvt_pk_bf16_f32 v122, v12, v13
v_mfma_f32_16x16x32_bf16 v[176:179], a[116:119], v[100:103], v[176:179]
buffer_load_dwordx4 v[52:55], v1, s[4:7], s22 offen offset:1024 sc1
v_mfma_f32_16x16x32_bf16 v[180:183], a[116:119], v[108:111], v[180:183]
ds_read_b128 a[84:87], v2 offset:21504
v_add_f32 v27, v27, v14
v_mfma_f32_16x16x32_bf16 v[180:183], a[112:115], v[104:107], v[180:183]
s_waitcnt lgkmcnt(4)
v_exp_f32 v8, v84
v_mfma_f32_16x16x32_bf16 v[184:187], a[120:123], v[96:99], v[184:187]
ds_read_b128 a[88:91], v2 offset:22528
v_add_f32 v27, v27, v15
v_cvt_pk_bf16_f32 v123, v14, v15
v_mfma_f32_16x16x32_bf16 v[184:187], a[124:127], v[100:103], v[184:187]
buffer_load_dwordx4 v[56:59], v1, s[4:7], s22 offen offset:2048 sc1
v_mfma_f32_16x16x32_bf16 v[188:191], a[124:127], v[108:111], v[188:191]
ds_read_b128 a[92:95], v2 offset:23552
v_add_f32 v27, v27, v8
v_mfma_f32_16x16x32_bf16 v[188:191], a[120:123], v[104:107], v[188:191]
v_exp_f32 v9, v85
v_mfma_f32_16x16x32_bf16 v[192:195], a[64:67], v[96:99], v[192:195]
ds_read_b128 a[96:99], v2 offset:24576
v_add_f32 v27, v27, v9
v_mfma_f32_16x16x32_bf16 v[192:195], a[68:71], v[100:103], v[192:195]
buffer_load_dwordx4 v[60:63], v1, s[4:7], s22 offen offset:3072 sc1
v_mfma_f32_16x16x32_bf16 v[196:199], a[68:71], v[108:111], v[196:199]
ds_read_b128 a[100:103], v2 offset:25600
v_cvt_pk_bf16_f32 v124, v8, v9
v_mfma_f32_16x16x32_bf16 v[196:199], a[64:67], v[104:107], v[196:199]
s_waitcnt lgkmcnt(4)
v_exp_f32 v10, v86
v_mfma_f32_16x16x32_bf16 v[200:203], a[72:75], v[96:99], v[200:203]
s_add_u32 s22, s76, 8192
ds_read_b128 a[104:107], v2 offset:26624
v_add_f32 v27, v27, v10
v_mfma_f32_16x16x32_bf16 v[200:203], a[76:79], v[100:103], v[200:203]
buffer_load_dwordx4 a[32:35], v1, s[4:7], s22 offen offset:0 sc1
v_mfma_f32_16x16x32_bf16 v[204:207], a[76:79], v[108:111], v[204:207]
ds_read_b128 a[108:111], v2 offset:27648
v_mfma_f32_16x16x32_bf16 v[204:207], a[72:75], v[104:107], v[204:207]
v_exp_f32 v11, v87
v_mfma_f32_16x16x32_bf16 v[208:211], a[80:83], v[96:99], v[208:211]
ds_read_b128 a[112:115], v2 offset:28672
v_exp_f32 v12, v92
v_mfma_f32_16x16x32_bf16 v[208:211], a[84:87], v[100:103], v[208:211]
buffer_load_dwordx4 a[36:39], v1, s[4:7], s22 offen offset:1024 sc1
v_mfma_f32_16x16x32_bf16 v[212:215], a[84:87], v[108:111], v[212:215]
ds_read_b128 a[116:119], v2 offset:29696
v_add_f32 v27, v27, v11
v_mfma_f32_16x16x32_bf16 v[212:215], a[80:83], v[104:107], v[212:215]
s_waitcnt lgkmcnt(4)
v_exp_f32 v13, v93
v_mfma_f32_16x16x32_bf16 v[216:219], a[88:91], v[96:99], v[216:219]
ds_read_b128 a[120:123], v2 offset:30720
v_cvt_pk_bf16_f32 v125, v10, v11
v_add_f32 v27, v27, v12
v_mfma_f32_16x16x32_bf16 v[216:219], a[92:95], v[100:103], v[216:219]
buffer_load_dwordx4 a[40:43], v1, s[4:7], s22 offen offset:2048 sc1
v_mfma_f32_16x16x32_bf16 v[220:223], a[92:95], v[108:111], v[220:223]
s_waitcnt vmcnt(12)
ds_read_b128 a[124:127], v2 offset:31744
v_add_f32 v27, v27, v13
v_mfma_f32_16x16x32_bf16 v[220:223], a[88:91], v[104:107], v[220:223]
s_barrier
v_mfma_f32_16x16x32_bf16 v[224:227], a[96:99], v[96:99], v[224:227]
ds_read_b128 a[64:67], v1 offset:0
v_cvt_pk_bf16_f32 v126, v12, v13
v_mfma_f32_16x16x32_bf16 v[224:227], a[100:103], v[100:103], v[224:227]
buffer_load_dwordx4 a[44:47], v1, s[4:7], s22 offen offset:3072 sc1
v_mfma_f32_16x16x32_bf16 v[228:231], a[100:103], v[108:111], v[228:231]
ds_read_b128 a[68:71], v1 offset:1024
v_mfma_f32_16x16x32_bf16 v[228:231], a[96:99], v[104:107], v[228:231]
s_waitcnt lgkmcnt(4)
v_exp_f32 v14, v94
v_mfma_f32_16x16x32_bf16 v[232:235], a[104:107], v[96:99], v[232:235]
s_add_u32 s22, s76, 12288
ds_read_b128 a[72:75], v1 offset:2048
v_add_f32 v27, v27, v14
v_mfma_f32_16x16x32_bf16 v[232:235], a[108:111], v[100:103], v[232:235]
buffer_load_dwordx4 a[48:51], v1, s[4:7], s22 offen offset:0 sc1
v_mfma_f32_16x16x32_bf16 v[236:239], a[108:111], v[108:111], v[236:239]
ds_read_b128 a[76:79], v1 offset:3072
v_mfma_f32_16x16x32_bf16 v[236:239], a[104:107], v[104:107], v[236:239]
v_exp_f32 v15, v95
v_mfma_f32_16x16x32_bf16 v[240:243], a[112:115], v[96:99], v[240:243]
ds_read_b128 a[80:83], v1 offset:4096
v_add_f32 v27, v27, v15
v_mfma_f32_16x16x32_bf16 v[240:243], a[116:119], v[100:103], v[240:243]
buffer_load_dwordx4 a[52:55], v1, s[4:7], s22 offen offset:1024 sc1
v_mfma_f32_16x16x32_bf16 v[244:247], a[116:119], v[108:111], v[244:247]
ds_read_b128 a[84:87], v1 offset:5120
v_cvt_pk_bf16_f32 v127, v14, v15
v_mfma_f32_16x16x32_bf16 v[244:247], a[112:115], v[104:107], v[244:247]
s_waitcnt lgkmcnt(4)
v_cmp_nge_f32 vcc, s25, v27
v_mfma_f32_16x16x32_bf16 v[248:251], a[120:123], v[96:99], v[248:251]
ds_read_b128 a[88:91], v1 offset:6144
v_mfma_f32_16x16x32_bf16 v[248:251], a[124:127], v[100:103], v[248:251]
buffer_load_dwordx4 a[56:59], v1, s[4:7], s22 offen offset:2048 sc1
v_mfma_f32_16x16x32_bf16 v[252:255], a[124:127], v[108:111], v[252:255]
ds_read_b128 a[92:95], v1 offset:7168
v_mfma_f32_16x16x32_bf16 v[252:255], a[120:123], v[104:107], v[252:255]
s_waitcnt lgkmcnt(2)
buffer_load_dwordx4 a[60:63], v1, s[4:7], s22 offen offset:3072 sc1
s_cbranch_vccnz Lstub_10
Lback_11:
v_mfma_f32_16x16x32_bf16 v[132:135], a[64:67], v[120:123], v[132:135]
s_mov_b64 s[36:37], s[86:87]
ds_read_b128 a[96:99], v1 offset:8192
v_add_f32 v25, v25, v27
v_mfma_f32_16x16x32_bf16 v[132:135], a[68:71], v[124:127], v[132:135]
s_mov_b32 s38, 3670016
ds_read_b128 a[100:103], v1 offset:9216
v_accvgpr_read_b32 v112, a184
v_mfma_f32_16x16x32_bf16 v[140:143], a[72:75], v[120:123], v[140:143]
s_mov_b32 s39, 0x20000
ds_read_b128 a[104:107], v1 offset:10240
v_accvgpr_read_b32 v113, a185
v_mfma_f32_16x16x32_bf16 v[140:143], a[76:79], v[124:127], v[140:143]
s_lshl_b32 s8, s29, 3
ds_read_b128 a[108:111], v1 offset:11264
v_accvgpr_read_b32 v114, a186
v_mfma_f32_16x16x32_bf16 v[148:151], a[80:83], v[120:123], v[148:151]
s_add_u32 s8, s8, s3
ds_read_b128 a[112:115], v1 offset:12288
v_accvgpr_read_b32 v115, a187
v_mfma_f32_16x16x32_bf16 v[148:151], a[84:87], v[124:127], v[148:151]
s_waitcnt lgkmcnt(3)
s_lshl_b32 s8, s8, 4
ds_read_b128 a[116:119], v1 offset:13312
v_accvgpr_read_b32 v116, a188
v_mfma_f32_16x16x32_bf16 v[156:159], a[88:91], v[120:123], v[156:159]
s_add_u32 s8, s8, s20
ds_read_b128 a[120:123], v1 offset:14336
v_accvgpr_read_b32 v117, a189
v_mfma_f32_16x16x32_bf16 v[156:159], a[92:95], v[124:127], v[156:159]
s_mul_i32 s8, s8, 14336
ds_read_b128 a[124:127], v1 offset:15360
v_accvgpr_read_b32 v118, a190
v_mfma_f32_16x16x32_bf16 v[164:167], a[96:99], v[120:123], v[164:167]
s_add_u32 s8, s8, 104857600
ds_read_b128 a[64:67], v1 offset:16384
v_accvgpr_read_b32 v119, a191
v_mfma_f32_16x16x32_bf16 v[164:167], a[100:103], v[124:127], v[164:167]
s_waitcnt lgkmcnt(6)
s_add_u32 s12, s8, 917504
ds_read_b128 a[68:71], v1 offset:17408
v_mfma_f32_16x16x32_bf16 v[172:175], a[104:107], v[120:123], v[172:175]
s_waitcnt lgkmcnt(6)
ds_read_b128 a[72:75], v1 offset:18432
v_mfma_f32_16x16x32_bf16 v[172:175], a[108:111], v[124:127], v[172:175]
s_waitcnt lgkmcnt(6)
ds_read_b128 a[76:79], v1 offset:19456
v_mfma_f32_16x16x32_bf16 v[180:183], a[112:115], v[120:123], v[180:183]
s_waitcnt lgkmcnt(6)
ds_read_b128 a[80:83], v1 offset:20480
v_mfma_f32_16x16x32_bf16 v[180:183], a[116:119], v[124:127], v[180:183]
s_waitcnt lgkmcnt(6)
ds_read_b128 a[84:87], v1 offset:21504
v_mfma_f32_16x16x32_bf16 v[188:191], a[120:123], v[120:123], v[188:191]
s_waitcnt lgkmcnt(6)
ds_read_b128 a[88:91], v1 offset:22528
v_mfma_f32_16x16x32_bf16 v[188:191], a[124:127], v[124:127], v[188:191]
s_waitcnt lgkmcnt(6)
ds_read_b128 a[92:95], v1 offset:23552
v_mfma_f32_16x16x32_bf16 v[196:199], a[64:67], v[120:123], v[196:199]
s_waitcnt lgkmcnt(6)
ds_read_b128 a[96:99], v1 offset:24576
v_mfma_f32_16x16x32_bf16 v[196:199], a[68:71], v[124:127], v[196:199]
s_waitcnt lgkmcnt(6)
ds_read_b128 a[100:103], v1 offset:25600
v_mfma_f32_16x16x32_bf16 v[204:207], a[72:75], v[120:123], v[204:207]
s_waitcnt lgkmcnt(6)
ds_read_b128 a[104:107], v1 offset:26624
v_mfma_f32_16x16x32_bf16 v[204:207], a[76:79], v[124:127], v[204:207]
s_waitcnt lgkmcnt(6)
ds_read_b128 a[108:111], v1 offset:27648
v_mfma_f32_16x16x32_bf16 v[212:215], a[80:83], v[120:123], v[212:215]
s_waitcnt lgkmcnt(6)
ds_read_b128 a[112:115], v1 offset:28672
v_mfma_f32_16x16x32_bf16 v[212:215], a[84:87], v[124:127], v[212:215]
s_waitcnt lgkmcnt(6)
ds_read_b128 a[116:119], v1 offset:29696
v_mfma_f32_16x16x32_bf16 v[220:223], a[88:91], v[120:123], v[220:223]
s_waitcnt lgkmcnt(6)
s_add_u32 m0, s18, 32768
ds_read_b128 a[120:123], v1 offset:30720
v_mfma_f32_16x16x32_bf16 v[220:223], a[92:95], v[124:127], v[220:223]
s_waitcnt lgkmcnt(6)
ds_read_b128 a[124:127], v1 offset:31744
v_mfma_f32_16x16x32_bf16 v[228:231], a[96:99], v[120:123], v[228:231]
s_waitcnt lgkmcnt(6)
buffer_load_dwordx4 v112, s[36:39], s81 offen offset:0 lds
v_mfma_f32_16x16x32_bf16 v[228:231], a[100:103], v[124:127], v[228:231]
s_waitcnt lgkmcnt(5)
buffer_load_dwordx4 v113, s[36:39], s81 offen offset:1024 lds
v_mfma_f32_16x16x32_bf16 v[236:239], a[104:107], v[120:123], v[236:239]
s_waitcnt lgkmcnt(4)
buffer_load_dwordx4 v114, s[36:39], s81 offen offset:2048 lds
v_mfma_f32_16x16x32_bf16 v[236:239], a[108:111], v[124:127], v[236:239]
s_waitcnt lgkmcnt(3)
buffer_load_dwordx4 v115, s[36:39], s81 offen offset:3072 lds
v_mfma_f32_16x16x32_bf16 v[244:247], a[112:115], v[120:123], v[244:247]
s_waitcnt lgkmcnt(2)
s_add_u32 s81, s81, 28672
v_mfma_f32_16x16x32_bf16 v[244:247], a[116:119], v[124:127], v[244:247]
s_waitcnt lgkmcnt(1)
s_add_u32 m0, s18, 36864
v_mfma_f32_16x16x32_bf16 v[252:255], a[120:123], v[120:123], v[252:255]
s_waitcnt lgkmcnt(0)
buffer_load_dwordx4 v112, s[36:39], s81 offen offset:0 lds
v_mfma_f32_16x16x32_bf16 v[252:255], a[124:127], v[124:127], v[252:255]
buffer_load_dwordx4 v113, s[36:39], s81 offen offset:1024 lds
buffer_load_dwordx4 v114, s[36:39], s81 offen offset:2048 lds
buffer_load_dwordx4 v115, s[36:39], s81 offen offset:3072 lds
s_sub_u32 s81, s81, 28544
s_waitcnt vmcnt(8)
v_sub_f32 v8, v16, v28
v_sub_f32 v10, v20, v30
v_max_f32 v9, v8, v10
v_cmp_lt_f32 vcc, 1114636288, v9
s_cbranch_vccnz K2_cfix
K2_cok:
v_exp_f32 v8, v8
v_exp_f32 v10, v10
s_nop 0
v_mov_b32 v9, v8
v_mov_b32 v11, v10
v_fmac_f32 v24, v8, v29
v_fmac_f32 v25, v10, v31
s_mov_b32 s23, 0xffff0000
v_lshlrev_b32 v64, 16, v32
v_and_b32 v65, s23, v32
v_lshlrev_b32 v66, 16, v33
v_and_b32 v67, s23, v33
v_lshlrev_b32 v68, 16, v34
v_and_b32 v69, s23, v34
v_lshlrev_b32 v70, 16, v35
v_and_b32 v71, s23, v35
v_pk_fma_f32 v[128:129], v[64:65], v[8:9], v[128:129]
v_pk_fma_f32 v[130:131], v[66:67], v[8:9], v[130:131]
v_pk_fma_f32 v[136:137], v[68:69], v[8:9], v[136:137]
v_pk_fma_f32 v[138:139], v[70:71], v[8:9], v[138:139]
v_cvt_pk_bf16_f32 v128, v128, v129
v_cvt_pk_bf16_f32 v129, v130, v131
v_cvt_pk_bf16_f32 v130, v136, v137
v_cvt_pk_bf16_f32 v131, v138, v139
s_add_u32 m0, s18, 98304
s_nop 0
buffer_load_dwordx4 v112, s[36:39], s81 offen offset:0 lds
v_lshlrev_b32 v64, 16, v36
v_and_b32 v65, s23, v36
v_lshlrev_b32 v66, 16, v37
v_and_b32 v67, s23, v37
v_lshlrev_b32 v68, 16, v38
v_and_b32 v69, s23, v38
v_lshlrev_b32 v70, 16, v39
v_and_b32 v71, s23, v39
v_pk_fma_f32 v[144:145], v[64:65], v[8:9], v[144:145]
v_pk_fma_f32 v[146:147], v[66:67], v[8:9], v[146:147]
v_pk_fma_f32 v[152:153], v[68:69], v[8:9], v[152:153]
v_pk_fma_f32 v[154:155], v[70:71], v[8:9], v[154:155]
v_cvt_pk_bf16_f32 v144, v144, v145
v_cvt_pk_bf16_f32 v145, v146, v147
v_cvt_pk_bf16_f32 v146, v152, v153
v_cvt_pk_bf16_f32 v147, v154, v155
buffer_load_dwordx4 v113, s[36:39], s81 offen offset:1024 lds
v_lshlrev_b32 v64, 16, v40
v_and_b32 v65, s23, v40
v_lshlrev_b32 v66, 16, v41
v_and_b32 v67, s23, v41
v_lshlrev_b32 v68, 16, v42
v_and_b32 v69, s23, v42
v_lshlrev_b32 v70, 16, v43
v_and_b32 v71, s23, v43
v_pk_fma_f32 v[160:161], v[64:65], v[8:9], v[160:161]
v_pk_fma_f32 v[162:163], v[66:67], v[8:9], v[162:163]
v_pk_fma_f32 v[168:169], v[68:69], v[8:9], v[168:169]
v_pk_fma_f32 v[170:171], v[70:71], v[8:9], v[170:171]
v_cvt_pk_bf16_f32 v160, v160, v161
v_cvt_pk_bf16_f32 v161, v162, v163
v_cvt_pk_bf16_f32 v162, v168, v169
v_cvt_pk_bf16_f32 v163, v170, v171
buffer_load_dwordx4 v114, s[36:39], s81 offen offset:2048 lds
v_lshlrev_b32 v64, 16, v44
v_and_b32 v65, s23, v44
v_lshlrev_b32 v66, 16, v45
v_and_b32 v67, s23, v45
v_lshlrev_b32 v68, 16, v46
v_and_b32 v69, s23, v46
v_lshlrev_b32 v70, 16, v47
v_and_b32 v71, s23, v47
v_pk_fma_f32 v[176:177], v[64:65], v[8:9], v[176:177]
v_pk_fma_f32 v[178:179], v[66:67], v[8:9], v[178:179]
v_pk_fma_f32 v[184:185], v[68:69], v[8:9], v[184:185]
v_pk_fma_f32 v[186:187], v[70:71], v[8:9], v[186:187]
v_cvt_pk_bf16_f32 v176, v176, v177
v_cvt_pk_bf16_f32 v177, v178, v179
v_cvt_pk_bf16_f32 v178, v184, v185
v_cvt_pk_bf16_f32 v179, v186, v187
buffer_load_dwordx4 v115, s[36:39], s81 offen offset:3072 lds
v_lshlrev_b32 v64, 16, v48
v_and_b32 v65, s23, v48
v_lshlrev_b32 v66, 16, v49
v_and_b32 v67, s23, v49
v_lshlrev_b32 v68, 16, v50
v_and_b32 v69, s23, v50
v_lshlrev_b32 v70, 16, v51
v_and_b32 v71, s23, v51
v_pk_fma_f32 v[192:193], v[64:65], v[8:9], v[192:193]
v_pk_fma_f32 v[194:195], v[66:67], v[8:9], v[194:195]
v_pk_fma_f32 v[200:201], v[68:69], v[8:9], v[200:201]
v_pk_fma_f32 v[202:203], v[70:71], v[8:9], v[202:203]
v_cvt_pk_bf16_f32 v192, v192, v193
v_cvt_pk_bf16_f32 v193, v194, v195
v_cvt_pk_bf16_f32 v194, v200, v201
v_cvt_pk_bf16_f32 v195, v202, v203
s_add_u32 s81, s81, 28672
s_add_u32 m0, s18, 102400
s_nop 0
buffer_load_dwordx4 v112, s[36:39], s81 offen offset:0 lds
v_lshlrev_b32 v64, 16, v52
v_and_b32 v65, s23, v52
v_lshlrev_b32 v66, 16, v53
v_and_b32 v67, s23, v53
v_lshlrev_b32 v68, 16, v54
v_and_b32 v69, s23, v54
v_lshlrev_b32 v70, 16, v55
v_and_b32 v71, s23, v55
v_pk_fma_f32 v[208:209], v[64:65], v[8:9], v[208:209]
v_pk_fma_f32 v[210:211], v[66:67], v[8:9], v[210:211]
v_pk_fma_f32 v[216:217], v[68:69], v[8:9], v[216:217]
v_pk_fma_f32 v[218:219], v[70:71], v[8:9], v[218:219]
v_cvt_pk_bf16_f32 v208, v208, v209
v_cvt_pk_bf16_f32 v209, v210, v211
v_cvt_pk_bf16_f32 v210, v216, v217
v_cvt_pk_bf16_f32 v211, v218, v219
buffer_load_dwordx4 v113, s[36:39], s81 offen offset:1024 lds
v_lshlrev_b32 v64, 16, v56
v_and_b32 v65, s23, v56
v_lshlrev_b32 v66, 16, v57
v_and_b32 v67, s23, v57
v_lshlrev_b32 v68, 16, v58
v_and_b32 v69, s23, v58
v_lshlrev_b32 v70, 16, v59
v_and_b32 v71, s23, v59
v_pk_fma_f32 v[224:225], v[64:65], v[8:9], v[224:225]
v_pk_fma_f32 v[226:227], v[66:67], v[8:9], v[226:227]
v_pk_fma_f32 v[232:233], v[68:69], v[8:9], v[232:233]
v_pk_fma_f32 v[234:235], v[70:71], v[8:9], v[234:235]
v_cvt_pk_bf16_f32 v224, v224, v225
v_cvt_pk_bf16_f32 v225, v226, v227
v_cvt_pk_bf16_f32 v226, v232, v233
v_cvt_pk_bf16_f32 v227, v234, v235
buffer_load_dwordx4 v114, s[36:39], s81 offen offset:2048 lds
v_lshlrev_b32 v64, 16, v60
v_and_b32 v65, s23, v60
v_lshlrev_b32 v66, 16, v61
v_and_b32 v67, s23, v61
v_lshlrev_b32 v68, 16, v62
v_and_b32 v69, s23, v62
v_lshlrev_b32 v70, 16, v63
v_and_b32 v71, s23, v63
v_pk_fma_f32 v[240:241], v[64:65], v[8:9], v[240:241]
v_pk_fma_f32 v[242:243], v[66:67], v[8:9], v[242:243]
v_pk_fma_f32 v[248:249], v[68:69], v[8:9], v[248:249]
v_pk_fma_f32 v[250:251], v[70:71], v[8:9], v[250:251]
v_cvt_pk_bf16_f32 v240, v240, v241
v_cvt_pk_bf16_f32 v241, v242, v243
v_cvt_pk_bf16_f32 v242, v248, v249
v_cvt_pk_bf16_f32 v243, v250, v251
buffer_load_dwordx4 v115, s[36:39], s81 offen offset:3072 lds
v_accvgpr_read_b32 v32, a32
v_accvgpr_read_b32 v33, a33
v_accvgpr_read_b32 v34, a34
v_accvgpr_read_b32 v35, a35
v_lshlrev_b32 v64, 16, v32
v_and_b32 v65, s23, v32
v_lshlrev_b32 v66, 16, v33
v_and_b32 v67, s23, v33
v_lshlrev_b32 v68, 16, v34
v_and_b32 v69, s23, v34
v_lshlrev_b32 v70, 16, v35
v_and_b32 v71, s23, v35
v_pk_fma_f32 v[132:133], v[64:65], v[10:11], v[132:133]
v_pk_fma_f32 v[134:135], v[66:67], v[10:11], v[134:135]
v_pk_fma_f32 v[140:141], v[68:69], v[10:11], v[140:141]
v_pk_fma_f32 v[142:143], v[70:71], v[10:11], v[142:143]
v_cvt_pk_bf16_f32 v132, v132, v133
v_cvt_pk_bf16_f32 v133, v134, v135
v_cvt_pk_bf16_f32 v134, v140, v141
v_cvt_pk_bf16_f32 v135, v142, v143
s_sub_u32 s81, s81, 28544
s_add_u32 m0, s18, 131072
s_nop 0
buffer_load_dwordx4 v112, s[36:39], s81 offen offset:0 lds
v_accvgpr_read_b32 v36, a36
v_accvgpr_read_b32 v37, a37
v_accvgpr_read_b32 v38, a38
v_accvgpr_read_b32 v39, a39
v_lshlrev_b32 v64, 16, v36
v_and_b32 v65, s23, v36
v_lshlrev_b32 v66, 16, v37
v_and_b32 v67, s23, v37
v_lshlrev_b32 v68, 16, v38
v_and_b32 v69, s23, v38
v_lshlrev_b32 v70, 16, v39
v_and_b32 v71, s23, v39
v_pk_fma_f32 v[148:149], v[64:65], v[10:11], v[148:149]
v_pk_fma_f32 v[150:151], v[66:67], v[10:11], v[150:151]
v_pk_fma_f32 v[156:157], v[68:69], v[10:11], v[156:157]
v_pk_fma_f32 v[158:159], v[70:71], v[10:11], v[158:159]
v_cvt_pk_bf16_f32 v148, v148, v149
v_cvt_pk_bf16_f32 v149, v150, v151
v_cvt_pk_bf16_f32 v150, v156, v157
v_cvt_pk_bf16_f32 v151, v158, v159
buffer_load_dwordx4 v113, s[36:39], s81 offen offset:1024 lds
v_accvgpr_read_b32 v40, a40
v_accvgpr_read_b32 v41, a41
v_accvgpr_read_b32 v42, a42
v_accvgpr_read_b32 v43, a43
v_lshlrev_b32 v64, 16, v40
v_and_b32 v65, s23, v40
v_lshlrev_b32 v66, 16, v41
v_and_b32 v67, s23, v41
v_lshlrev_b32 v68, 16, v42
v_and_b32 v69, s23, v42
v_lshlrev_b32 v70, 16, v43
v_and_b32 v71, s23, v43
v_pk_fma_f32 v[164:165], v[64:65], v[10:11], v[164:165]
v_pk_fma_f32 v[166:167], v[66:67], v[10:11], v[166:167]
v_pk_fma_f32 v[172:173], v[68:69], v[10:11], v[172:173]
v_pk_fma_f32 v[174:175], v[70:71], v[10:11], v[174:175]
v_cvt_pk_bf16_f32 v164, v164, v165
v_cvt_pk_bf16_f32 v165, v166, v167
v_cvt_pk_bf16_f32 v166, v172, v173
v_cvt_pk_bf16_f32 v167, v174, v175
buffer_load_dwordx4 v114, s[36:39], s81 offen offset:2048 lds
v_accvgpr_read_b32 v44, a44
v_accvgpr_read_b32 v45, a45
v_accvgpr_read_b32 v46, a46
v_accvgpr_read_b32 v47, a47
v_lshlrev_b32 v64, 16, v44
v_and_b32 v65, s23, v44
v_lshlrev_b32 v66, 16, v45
v_and_b32 v67, s23, v45
v_lshlrev_b32 v68, 16, v46
v_and_b32 v69, s23, v46
v_lshlrev_b32 v70, 16, v47
v_and_b32 v71, s23, v47
v_pk_fma_f32 v[180:181], v[64:65], v[10:11], v[180:181]
v_pk_fma_f32 v[182:183], v[66:67], v[10:11], v[182:183]
v_pk_fma_f32 v[188:189], v[68:69], v[10:11], v[188:189]
v_pk_fma_f32 v[190:191], v[70:71], v[10:11], v[190:191]
v_cvt_pk_bf16_f32 v180, v180, v181
v_cvt_pk_bf16_f32 v181, v182, v183
v_cvt_pk_bf16_f32 v182, v188, v189
v_cvt_pk_bf16_f32 v183, v190, v191
buffer_load_dwordx4 v115, s[36:39], s81 offen offset:3072 lds
v_accvgpr_read_b32 v48, a48
v_accvgpr_read_b32 v49, a49
v_accvgpr_read_b32 v50, a50
v_accvgpr_read_b32 v51, a51
v_lshlrev_b32 v64, 16, v48
v_and_b32 v65, s23, v48
v_lshlrev_b32 v66, 16, v49
v_and_b32 v67, s23, v49
v_lshlrev_b32 v68, 16, v50
v_and_b32 v69, s23, v50
v_lshlrev_b32 v70, 16, v51
v_and_b32 v71, s23, v51
v_pk_fma_f32 v[196:197], v[64:65], v[10:11], v[196:197]
v_pk_fma_f32 v[198:199], v[66:67], v[10:11], v[198:199]
v_pk_fma_f32 v[204:205], v[68:69], v[10:11], v[204:205]
v_pk_fma_f32 v[206:207], v[70:71], v[10:11], v[206:207]
v_cvt_pk_bf16_f32 v196, v196, v197
v_cvt_pk_bf16_f32 v197, v198, v199
v_cvt_pk_bf16_f32 v198, v204, v205
v_cvt_pk_bf16_f32 v199, v206, v207
s_add_u32 s81, s81, 28672
s_add_u32 m0, s18, 135168
s_nop 0
buffer_load_dwordx4 v112, s[36:39], s81 offen offset:0 lds
v_accvgpr_read_b32 v52, a52
v_accvgpr_read_b32 v53, a53
v_accvgpr_read_b32 v54, a54
v_accvgpr_read_b32 v55, a55
v_lshlrev_b32 v64, 16, v52
v_and_b32 v65, s23, v52
v_lshlrev_b32 v66, 16, v53
v_and_b32 v67, s23, v53
v_lshlrev_b32 v68, 16, v54
v_and_b32 v69, s23, v54
v_lshlrev_b32 v70, 16, v55
v_and_b32 v71, s23, v55
v_pk_fma_f32 v[212:213], v[64:65], v[10:11], v[212:213]
v_pk_fma_f32 v[214:215], v[66:67], v[10:11], v[214:215]
v_pk_fma_f32 v[220:221], v[68:69], v[10:11], v[220:221]
v_pk_fma_f32 v[222:223], v[70:71], v[10:11], v[222:223]
v_cvt_pk_bf16_f32 v212, v212, v213
v_cvt_pk_bf16_f32 v213, v214, v215
v_cvt_pk_bf16_f32 v214, v220, v221
v_cvt_pk_bf16_f32 v215, v222, v223
buffer_load_dwordx4 v113, s[36:39], s81 offen offset:1024 lds
v_accvgpr_read_b32 v56, a56
v_accvgpr_read_b32 v57, a57
v_accvgpr_read_b32 v58, a58
v_accvgpr_read_b32 v59, a59
v_lshlrev_b32 v64, 16, v56
v_and_b32 v65, s23, v56
v_lshlrev_b32 v66, 16, v57
v_and_b32 v67, s23, v57
v_lshlrev_b32 v68, 16, v58
v_and_b32 v69, s23, v58
v_lshlrev_b32 v70, 16, v59
v_and_b32 v71, s23, v59
v_pk_fma_f32 v[228:229], v[64:65], v[10:11], v[228:229]
v_pk_fma_f32 v[230:231], v[66:67], v[10:11], v[230:231]
v_pk_fma_f32 v[236:237], v[68:69], v[10:11], v[236:237]
v_pk_fma_f32 v[238:239], v[70:71], v[10:11], v[238:239]
v_cvt_pk_bf16_f32 v228, v228, v229
v_cvt_pk_bf16_f32 v229, v230, v231
v_cvt_pk_bf16_f32 v230, v236, v237
v_cvt_pk_bf16_f32 v231, v238, v239
buffer_load_dwordx4 v114, s[36:39], s81 offen offset:2048 lds
v_accvgpr_read_b32 v60, a60
v_accvgpr_read_b32 v61, a61
v_accvgpr_read_b32 v62, a62
v_accvgpr_read_b32 v63, a63
v_lshlrev_b32 v64, 16, v60
v_and_b32 v65, s23, v60
v_lshlrev_b32 v66, 16, v61
v_and_b32 v67, s23, v61
v_lshlrev_b32 v68, 16, v62
v_and_b32 v69, s23, v62
v_lshlrev_b32 v70, 16, v63
v_and_b32 v71, s23, v63
v_pk_fma_f32 v[244:245], v[64:65], v[10:11], v[244:245]
v_pk_fma_f32 v[246:247], v[66:67], v[10:11], v[246:247]
v_pk_fma_f32 v[252:253], v[68:69], v[10:11], v[252:253]
v_pk_fma_f32 v[254:255], v[70:71], v[10:11], v[254:255]
v_cvt_pk_bf16_f32 v244, v244, v245
v_cvt_pk_bf16_f32 v245, v246, v247
v_cvt_pk_bf16_f32 v246, v252, v253
v_cvt_pk_bf16_f32 v247, v254, v255
buffer_load_dwordx4 v115, s[36:39], s81 offen offset:3072 lds
s_sub_u32 s81, s81, 28544
K2_done:
PAD_13:
s_cbranch_execz PAD_17
s_waitcnt vmcnt(16)
s_barrier
ds_read_b64_tr_b16 a[64:65], v116 offset:0
ds_read_b64_tr_b16 a[66:67], v116 offset:2048
ds_read_b64_tr_b16 a[68:69], v116 offset:4096
ds_read_b64_tr_b16 a[70:71], v116 offset:6144
ds_read_b64_tr_b16 a[72:73], v116 offset:8192
ds_read_b64_tr_b16 a[74:75], v116 offset:10240
ds_read_b64_tr_b16 a[76:77], v116 offset:12288
ds_read_b64_tr_b16 a[78:79], v116 offset:14336
ds_read_b64_tr_b16 a[80:81], v116 offset:16384
ds_read_b64_tr_b16 a[82:83], v116 offset:18432
ds_read_b64_tr_b16 a[84:85], v116 offset:20480
ds_read_b64_tr_b16 a[86:87], v116 offset:22528
ds_read_b64_tr_b16 a[88:89], v116 offset:24576
ds_read_b64_tr_b16 a[90:91], v116 offset:26624
ds_read_b64_tr_b16 a[92:93], v116 offset:28672
ds_read_b64_tr_b16 a[94:95], v116 offset:30720
v_add_u32 v116, 65536, v116
s_waitcnt lgkmcnt(14)
v_mfma_f32_16x16x32_bf16 v[32:35], a[64:67], v[128:131], 0
s_waitcnt lgkmcnt(12)
s_add_u32 m0, s18, 65536
ds_read_b64_tr_b16 a[96:97], v117 offset:0
v_mov_b32 v28, v24
v_mfma_f32_16x16x32_bf16 v[32:35], a[68:71], v[144:147], v[32:35]
s_waitcnt lgkmcnt(11)
buffer_load_dwordx4 v112, s[36:39], s81 offen offset:0 lds
ds_read_b64_tr_b16 a[98:99], v117 offset:2048
v_mfma_f32_16x16x32_bf16 v[32:35], a[72:75], v[160:163], v[32:35]
s_waitcnt lgkmcnt(10)
ds_read_b64_tr_b16 a[100:101], v117 offset:4096
v_permlane16_swap_b32 v24, v28
v_mfma_f32_16x16x32_bf16 v[32:35], a[76:79], v[176:179], v[32:35]
s_waitcnt lgkmcnt(9)
ds_read_b64_tr_b16 a[102:103], v117 offset:6144
v_add_f32 v24, v24, v28
v_mfma_f32_16x16x32_bf16 v[32:35], a[80:83], v[192:195], v[32:35]
s_waitcnt lgkmcnt(8)
buffer_load_dwordx4 v113, s[36:39], s81 offen offset:1024 lds
ds_read_b64_tr_b16 a[104:105], v117 offset:8192
v_mfma_f32_16x16x32_bf16 v[32:35], a[84:87], v[208:211], v[32:35]
s_waitcnt lgkmcnt(7)
ds_read_b64_tr_b16 a[106:107], v117 offset:10240
v_mov_b32 v28, v24
v_mfma_f32_16x16x32_bf16 v[32:35], a[88:91], v[224:227], v[32:35]
s_waitcnt lgkmcnt(6)
ds_read_b64_tr_b16 a[108:109], v117 offset:12288
v_lshrrev_b32 v20, 4, v1
v_mfma_f32_16x16x32_bf16 v[32:35], a[92:95], v[240:243], v[32:35]
buffer_load_dwordx4 v114, s[36:39], s81 offen offset:2048 lds
ds_read_b64_tr_b16 a[110:111], v117 offset:14336
v_mfma_f32_16x16x32_bf16 v[36:39], a[64:67], v[132:135], 0
PAD_14:
s_cbranch_execz PAD_18
ds_read_b64_tr_b16 a[112:113], v117 offset:16384
v_permlane32_swap_b32 v24, v28
v_mfma_f32_16x16x32_bf16 v[36:39], a[68:71], v[148:151], v[36:39]
ds_read_b64_tr_b16 a[114:115], v117 offset:18432
v_add_f32 v24, v24, v28
v_mfma_f32_16x16x32_bf16 v[36:39], a[72:75], v[164:167], v[36:39]
buffer_load_dwordx4 v115, s[36:39], s81 offen offset:3072 lds
ds_read_b64_tr_b16 a[116:117], v117 offset:20480
v_mfma_f32_16x16x32_bf16 v[36:39], a[76:79], v[180:183], v[36:39]
ds_read_b64_tr_b16 a[118:119], v117 offset:22528
v_mov_b32 v29, v25
v_mfma_f32_16x16x32_bf16 v[36:39], a[80:83], v[196:199], v[36:39]
s_add_u32 s81, s81, 28672
s_add_u32 m0, s18, 69632
ds_read_b64_tr_b16 a[120:121], v117 offset:24576
v_mfma_f32_16x16x32_bf16 v[36:39], a[84:87], v[212:215], v[36:39]
buffer_load_dwordx4 v112, s[36:39], s81 offen offset:0 lds
ds_read_b64_tr_b16 a[122:123], v117 offset:26624
v_mfma_f32_16x16x32_bf16 v[36:39], a[88:91], v[228:231], v[36:39]
ds_read_b64_tr_b16 a[124:125], v117 offset:28672
v_permlane16_swap_b32 v25, v29
v_mfma_f32_16x16x32_bf16 v[36:39], a[92:95], v[244:247], v[36:39]
s_waitcnt lgkmcnt(8)
ds_read_b64_tr_b16 a[126:127], v117 offset:30720
v_add_u32 v117, 65536, v117
v_mfma_f32_16x16x32_bf16 v[40:43], a[96:99], v[128:131], 0
buffer_load_dwordx4 v113, s[36:39], s81 offen offset:1024 lds
ds_read_b64_tr_b16 a[64:65], v118 offset:0
v_mfma_f32_16x16x32_bf16 v[40:43], a[100:103], v[144:147], v[40:43]
ds_read_b64_tr_b16 a[66:67], v118 offset:2048
v_add_f32 v25, v25, v29
v_mfma_f32_16x16x32_bf16 v[40:43], a[104:107], v[160:163], v[40:43]
s_waitcnt lgkmcnt(8)
ds_read_b64_tr_b16 a[68:69], v118 offset:4096
v_mov_b32 v29, v25
v_mfma_f32_16x16x32_bf16 v[40:43], a[108:111], v[176:179], v[40:43]
buffer_load_dwordx4 v114, s[36:39], s81 offen offset:2048 lds
ds_read_b64_tr_b16 a[70:71], v118 offset:6144
v_mfma_f32_16x16x32_bf16 v[40:43], a[112:115], v[192:195], v[40:43]
s_waitcnt lgkmcnt(8)
ds_read_b64_tr_b16 a[72:73], v118 offset:8192
v_permlane32_swap_b32 v25, v29
v_mfma_f32_16x16x32_bf16 v[40:43], a[116:119], v[208:211], v[40:43]
s_waitcnt lgkmcnt(7)
ds_read_b64_tr_b16 a[74:75], v118 offset:10240
v_add_f32 v25, v25, v29
v_mfma_f32_16x16x32_bf16 v[40:43], a[120:123], v[224:227], v[40:43]
s_waitcnt lgkmcnt(6)
buffer_load_dwordx4 v115, s[36:39], s81 offen offset:3072 lds
ds_read_b64_tr_b16 a[76:77], v118 offset:12288
v_mfma_f32_16x16x32_bf16 v[40:43], a[124:127], v[240:243], v[40:43]
ds_read_b64_tr_b16 a[78:79], v118 offset:14336
v_rcp_f32 v24, v24
v_mfma_f32_16x16x32_bf16 v[44:47], a[96:99], v[132:135], 0
s_sub_u32 s81, s81, 28544
s_add_u32 m0, s18, 0
ds_read_b64_tr_b16 a[80:81], v118 offset:16384
v_mfma_f32_16x16x32_bf16 v[44:47], a[100:103], v[148:151], v[44:47]
buffer_load_dwordx4 v112, s[36:39], s81 offen offset:0 lds
ds_read_b64_tr_b16 a[82:83], v118 offset:18432
v_mfma_f32_16x16x32_bf16 v[44:47], a[104:107], v[164:167], v[44:47]
ds_read_b64_tr_b16 a[84:85], v118 offset:20480
v_rcp_f32 v25, v25
v_mfma_f32_16x16x32_bf16 v[44:47], a[108:111], v[180:183], v[44:47]
ds_read_b64_tr_b16 a[86:87], v118 offset:22528
v_and_b32 v19, 15, v20
v_mfma_f32_16x16x32_bf16 v[44:47], a[112:115], v[196:199], v[44:47]
buffer_load_dwordx4 v113, s[36:39], s81 offen offset:1024 lds
ds_read_b64_tr_b16 a[88:89], v118 offset:24576
v_mfma_f32_16x16x32_bf16 v[44:47], a[116:119], v[212:215], v[44:47]
ds_read_b64_tr_b16 a[90:91], v118 offset:26624
v_mul_f32 v32, v32, v24
v_mfma_f32_16x16x32_bf16 v[44:47], a[120:123], v[228:231], v[44:47]
ds_read_b64_tr_b16 a[92:93], v118 offset:28672
v_mul_f32 v33, v33, v24
v_mfma_f32_16x16x32_bf16 v[44:47], a[124:127], v[244:247], v[44:47]
s_waitcnt lgkmcnt(8)
ds_read_b64_tr_b16 a[94:95], v118 offset:30720
v_add_u32 v118, 65536, v118
v_mfma_f32_16x16x32_bf16 v[48:51], a[64:67], v[128:131], 0
buffer_load_dwordx4 v114, s[36:39], s81 offen offset:2048 lds
ds_read_b64_tr_b16 a[96:97], v119 offset:0
v_mfma_f32_16x16x32_bf16 v[48:51], a[68:71], v[144:147], v[48:51]
ds_read_b64_tr_b16 a[98:99], v119 offset:2048
v_mul_f32 v34, v34, v24
v_mfma_f32_16x16x32_bf16 v[48:51], a[72:75], v[160:163], v[48:51]
s_waitcnt lgkmcnt(8)
ds_read_b64_tr_b16 a[100:101], v119 offset:4096
v_mul_f32 v35, v35, v24
v_mfma_f32_16x16x32_bf16 v[48:51], a[76:79], v[176:179], v[48:51]
buffer_load_dwordx4 v115, s[36:39], s81 offen offset:3072 lds
ds_read_b64_tr_b16 a[102:103], v119 offset:6144
v_mfma_f32_16x16x32_bf16 v[48:51], a[80:83], v[192:195], v[48:51]
s_waitcnt lgkmcnt(6)
ds_read_b64_tr_b16 a[104:105], v119 offset:8192
v_mul_f32 v40, v40, v24
v_mfma_f32_16x16x32_bf16 v[48:51], a[84:87], v[208:211], v[48:51]
s_add_u32 s81, s81, 28672
s_add_u32 m0, s18, 4096
ds_read_b64_tr_b16 a[106:107], v119 offset:10240
v_mfma_f32_16x16x32_bf16 v[48:51], a[88:91], v[224:227], v[48:51]
s_waitcnt lgkmcnt(6)
buffer_load_dwordx4 v112, s[36:39], s81 offen offset:0 lds
ds_read_b64_tr_b16 a[108:109], v119 offset:12288
v_mfma_f32_16x16x32_bf16 v[48:51], a[92:95], v[240:243], v[48:51]
ds_read_b64_tr_b16 a[110:111], v119 offset:14336
v_mul_f32 v41, v41, v24
v_mfma_f32_16x16x32_bf16 v[52:55], a[64:67], v[132:135], 0
ds_read_b64_tr_b16 a[112:113], v119 offset:16384
v_mul_f32 v42, v42, v24
v_mfma_f32_16x16x32_bf16 v[52:55], a[68:71], v[148:151], v[52:55]
buffer_load_dwordx4 v113, s[36:39], s81 offen offset:1024 lds
ds_read_b64_tr_b16 a[114:115], v119 offset:18432
v_mfma_f32_16x16x32_bf16 v[52:55], a[72:75], v[164:167], v[52:55]
ds_read_b64_tr_b16 a[116:117], v119 offset:20480
v_mul_f32 v43, v43, v24
v_mfma_f32_16x16x32_bf16 v[52:55], a[76:79], v[180:183], v[52:55]
ds_read_b64_tr_b16 a[118:119], v119 offset:22528
v_cvt_pk_bf16_f32 v32, v32, v33
v_mfma_f32_16x16x32_bf16 v[52:55], a[80:83], v[196:199], v[52:55]
buffer_load_dwordx4 v114, s[36:39], s81 offen offset:2048 lds
ds_read_b64_tr_b16 a[120:121], v119 offset:24576
v_mfma_f32_16x16x32_bf16 v[52:55], a[84:87], v[212:215], v[52:55]
ds_read_b64_tr_b16 a[122:123], v119 offset:26624
v_cvt_pk_bf16_f32 v33, v34, v35
v_mfma_f32_16x16x32_bf16 v[52:55], a[88:91], v[228:231], v[52:55]
ds_read_b64_tr_b16 a[124:125], v119 offset:28672
ds_read_b64_tr_b16 a[126:127], v119 offset:30720
v_mfma_f32_16x16x32_bf16 v[52:55], a[92:95], v[244:247], v[52:55]
s_waitcnt vmcnt(23) lgkmcnt(9)
s_barrier
v_add_u32 v119, 65536, v119
v_mfma_f32_16x16x32_bf16 v[56:59], a[96:99], v[128:131], 0
buffer_load_dwordx4 v115, s[36:39], s81 offen offset:3072 lds
ds_read_b64_tr_b16 a[64:65], v116 offset:0
v_mfma_f32_16x16x32_bf16 v[56:59], a[100:103], v[144:147], v[56:59]
s_waitcnt lgkmcnt(8)
ds_read_b64_tr_b16 a[66:67], v116 offset:2048
v_cvt_pk_bf16_f32 v34, v40, v41
v_mfma_f32_16x16x32_bf16 v[56:59], a[104:107], v[160:163], v[56:59]
s_sub_u32 s81, s81, 28544
ds_read_b64_tr_b16 a[68:69], v116 offset:4096
v_cvt_pk_bf16_f32 v35, v42, v43
v_mfma_f32_16x16x32_bf16 v[56:59], a[108:111], v[176:179], v[56:59]
s_waitcnt lgkmcnt(8)
buffer_store_dwordx4 v[32:35], v1, s[4:7], s8 offen offset:0 sc1
ds_read_b64_tr_b16 a[70:71], v116 offset:6144
v_mfma_f32_16x16x32_bf16 v[56:59], a[112:115], v[192:195], v[56:59]
s_waitcnt lgkmcnt(8)
ds_read_b64_tr_b16 a[72:73], v116 offset:8192
v_mul_f32 v36, v36, v25
v_mfma_f32_16x16x32_bf16 v[56:59], a[116:119], v[208:211], v[56:59]
s_waitcnt lgkmcnt(7)
ds_read_b64_tr_b16 a[74:75], v116 offset:10240
v_mul_f32 v37, v37, v25
v_mfma_f32_16x16x32_bf16 v[56:59], a[120:123], v[224:227], v[56:59]
s_waitcnt lgkmcnt(6)
ds_read_b64_tr_b16 a[76:77], v116 offset:12288
v_mul_f32 v38, v38, v25
v_mfma_f32_16x16x32_bf16 v[56:59], a[124:127], v[240:243], v[56:59]
ds_read_b64_tr_b16 a[78:79], v116 offset:14336
v_mul_f32 v39, v39, v25
v_mfma_f32_16x16x32_bf16 v[60:63], a[96:99], v[132:135], 0
ds_read_b64_tr_b16 a[80:81], v116 offset:16384
v_mul_f32 v44, v44, v25
v_mfma_f32_16x16x32_bf16 v[60:63], a[100:103], v[148:151], v[60:63]
ds_read_b64_tr_b16 a[82:83], v116 offset:18432
v_mul_f32 v45, v45, v25
v_mfma_f32_16x16x32_bf16 v[60:63], a[104:107], v[164:167], v[60:63]
ds_read_b64_tr_b16 a[84:85], v116 offset:20480
v_mul_f32 v46, v46, v25
v_mfma_f32_16x16x32_bf16 v[60:63], a[108:111], v[180:183], v[60:63]
ds_read_b64_tr_b16 a[86:87], v116 offset:22528
v_mul_f32 v47, v47, v25
v_mfma_f32_16x16x32_bf16 v[60:63], a[112:115], v[196:199], v[60:63]
ds_read_b64_tr_b16 a[88:89], v116 offset:24576
v_cvt_pk_bf16_f32 v36, v36, v37
v_mfma_f32_16x16x32_bf16 v[60:63], a[116:119], v[212:215], v[60:63]
ds_read_b64_tr_b16 a[90:91], v116 offset:26624
v_cvt_pk_bf16_f32 v37, v38, v39
v_mfma_f32_16x16x32_bf16 v[60:63], a[120:123], v[228:231], v[60:63]
ds_read_b64_tr_b16 a[92:93], v116 offset:28672
v_cvt_pk_bf16_f32 v38, v44, v45
v_mfma_f32_16x16x32_bf16 v[60:63], a[124:127], v[244:247], v[60:63]
s_waitcnt lgkmcnt(3)
ds_read_b64_tr_b16 a[94:95], v116 offset:30720
v_add_u32 v116, 32768, v116
v_mfma_f32_16x16x32_bf16 v[64:67], a[64:67], v[128:131], 0
s_lshl_b32 s34, s29, 5
ds_read_b64_tr_b16 a[96:97], v117 offset:0
v_cvt_pk_bf16_f32 v39, v46, v47
v_mfma_f32_16x16x32_bf16 v[64:67], a[68:71], v[144:147], v[64:67]
s_add_u32 s34, s34, s20
buffer_store_dwordx4 v[36:39], v1, s[4:7], s12 offen offset:0 sc1
ds_read_b64_tr_b16 a[98:99], v117 offset:2048
v_mfma_f32_16x16x32_bf16 v[64:67], a[72:75], v[160:163], v[64:67]
s_lshl_b32 s34, s34, 2
ds_read_b64_tr_b16 a[100:101], v117 offset:4096
v_mul_f32 v48, v48, v24
v_mfma_f32_16x16x32_bf16 v[64:67], a[76:79], v[176:179], v[64:67]
s_add_u32 s34, s34, 94380032
ds_read_b64_tr_b16 a[102:103], v117 offset:6144
v_mul_f32 v49, v49, v24
v_mfma_f32_16x16x32_bf16 v[64:67], a[80:83], v[192:195], v[64:67]
s_add_u32 s35, s34, 2048
ds_read_b64_tr_b16 a[104:105], v117 offset:8192
v_mul_f32 v50, v50, v24
v_mfma_f32_16x16x32_bf16 v[64:67], a[84:87], v[208:211], v[64:67]
s_waitcnt lgkmcnt(5)
s_mov_b32 s80, s21
ds_read_b64_tr_b16 a[106:107], v117 offset:10240
v_mul_f32 v51, v51, v24
v_mfma_f32_16x16x32_bf16 v[64:67], a[88:91], v[224:227], v[64:67]
s_and_b32 s79, s2, 16
ds_read_b64_tr_b16 a[108:109], v117 offset:12288
v_mul_f32 v56, v56, v24
v_mfma_f32_16x16x32_bf16 v[64:67], a[92:95], v[240:243], v[64:67]
s_xor_b32 s79, s79, 16
ds_read_b64_tr_b16 a[110:111], v117 offset:14336
v_mul_f32 v57, v57, v24
v_mfma_f32_16x16x32_bf16 v[68:71], a[64:67], v[132:135], 0
s_add_u32 s79, s79, s20
ds_read_b64_tr_b16 a[112:113], v117 offset:16384
v_mul_f32 v58, v58, v24
v_mfma_f32_16x16x32_bf16 v[68:71], a[68:71], v[148:151], v[68:71]
s_lshl_b32 s22, s79, 2
ds_read_b64_tr_b16 a[114:115], v117 offset:18432
v_mul_f32 v59, v59, v24
v_mfma_f32_16x16x32_bf16 v[68:71], a[72:75], v[164:167], v[68:71]
s_add_u32 s22, s22, s3
ds_read_b64_tr_b16 a[116:117], v117 offset:20480
v_cvt_pk_bf16_f32 v48, v48, v49
v_mfma_f32_16x16x32_bf16 v[68:71], a[76:79], v[180:183], v[68:71]
s_mul_i32 s25, s22, 28672
ds_read_b64_tr_b16 a[118:119], v117 offset:22528
v_cvt_pk_bf16_f32 v49, v50, v51
v_mfma_f32_16x16x32_bf16 v[68:71], a[80:83], v[196:199], v[68:71]
s_lshl_b32 s23, s80, 6
ds_read_b64_tr_b16 a[120:121], v117 offset:24576
v_cvt_pk_bf16_f32 v50, v56, v57
v_mfma_f32_16x16x32_bf16 v[68:71], a[84:87], v[212:215], v[68:71]
s_add_u32 s25, s25, s23
ds_read_b64_tr_b16 a[122:123], v117 offset:26624
v_cvt_pk_bf16_f32 v51, v58, v59
v_mfma_f32_16x16x32_bf16 v[68:71], a[88:91], v[228:231], v[68:71]
s_mul_i32 s26, s22, 229376
buffer_store_dwordx4 v[48:51], v1, s[4:7], s8 offen offset:1024 sc1
ds_read_b64_tr_b16 a[124:125], v117 offset:28672
v_mfma_f32_16x16x32_bf16 v[68:71], a[92:95], v[244:247], v[68:71]
s_waitcnt lgkmcnt(3)
s_lshl_b32 s23, s80, 10
ds_read_b64_tr_b16 a[126:127], v117 offset:30720
v_add_u32 v117, 32768, v117
v_mfma_f32_16x16x32_bf16 v[72:75], a[96:99], v[128:131], 0
s_add_u32 s26, s26, s23
ds_read_b64_tr_b16 a[64:65], v118 offset:0
v_mul_f32 v52, v52, v25
v_mfma_f32_16x16x32_bf16 v[72:75], a[100:103], v[144:147], v[72:75]
s_add_u32 s26, s26, 104857600
ds_read_b64_tr_b16 a[66:67], v118 offset:2048
v_mul_f32 v53, v53, v25
v_mfma_f32_16x16x32_bf16 v[72:75], a[104:107], v[160:163], v[72:75]
s_lshr_b32 s22, s79, 1
ds_read_b64_tr_b16 a[68:69], v118 offset:4096
v_mul_f32 v54, v54, v25
v_mfma_f32_16x16x32_bf16 v[72:75], a[108:111], v[176:179], v[72:75]
s_lshl_b32 s22, s22, 7
ds_read_b64_tr_b16 a[70:71], v118 offset:6144
v_mul_f32 v55, v55, v25
v_mfma_f32_16x16x32_bf16 v[72:75], a[112:115], v[192:195], v[72:75]
s_add_u32 s33, s22, 94380032
ds_read_b64_tr_b16 a[72:73], v118 offset:8192
v_mul_f32 v60, v60, v25
v_mfma_f32_16x16x32_bf16 v[72:75], a[116:119], v[208:211], v[72:75]
s_waitcnt lgkmcnt(5)
s_mov_b64 s[40:41], s[88:89]
ds_read_b64_tr_b16 a[74:75], v118 offset:10240
v_mul_f32 v61, v61, v25
v_mfma_f32_16x16x32_bf16 v[72:75], a[120:123], v[224:227], v[72:75]
s_mov_b32 s42, 3670016
ds_read_b64_tr_b16 a[76:77], v118 offset:12288
v_mul_f32 v62, v62, v25
v_mfma_f32_16x16x32_bf16 v[72:75], a[124:127], v[240:243], v[72:75]
s_mov_b32 s43, 0x20000
ds_read_b64_tr_b16 a[78:79], v118 offset:14336
v_mul_f32 v63, v63, v25
v_mfma_f32_16x16x32_bf16 v[76:79], a[96:99], v[132:135], 0
ds_read_b64_tr_b16 a[80:81], v118 offset:16384
v_cvt_pk_bf16_f32 v52, v52, v53
v_mfma_f32_16x16x32_bf16 v[76:79], a[100:103], v[148:151], v[76:79]
ds_read_b64_tr_b16 a[82:83], v118 offset:18432
v_cvt_pk_bf16_f32 v53, v54, v55
v_mfma_f32_16x16x32_bf16 v[76:79], a[104:107], v[164:167], v[76:79]
ds_read_b64_tr_b16 a[84:85], v118 offset:20480
v_cvt_pk_bf16_f32 v54, v60, v61
v_mfma_f32_16x16x32_bf16 v[76:79], a[108:111], v[180:183], v[76:79]
ds_read_b64_tr_b16 a[86:87], v118 offset:22528
v_cvt_pk_bf16_f32 v55, v62, v63
v_mfma_f32_16x16x32_bf16 v[76:79], a[112:115], v[196:199], v[76:79]
buffer_store_dwordx4 v[52:55], v1, s[4:7], s12 offen offset:1024 sc1
ds_read_b64_tr_b16 a[88:89], v118 offset:24576
v_mfma_f32_16x16x32_bf16 v[76:79], a[116:119], v[212:215], v[76:79]
ds_read_b64_tr_b16 a[90:91], v118 offset:26624
v_mfma_f32_16x16x32_bf16 v[76:79], a[120:123], v[228:231], v[76:79]
ds_read_b64_tr_b16 a[92:93], v118 offset:28672
v_mul_f32 v64, v64, v24
v_mfma_f32_16x16x32_bf16 v[76:79], a[124:127], v[244:247], v[76:79]
s_waitcnt lgkmcnt(8)
ds_read_b64_tr_b16 a[94:95], v118 offset:30720
v_add_u32 v118, 32768, v118
v_mfma_f32_16x16x32_bf16 v[80:83], a[64:67], v[128:131], 0
ds_read_b64_tr_b16 a[96:97], v119 offset:0
v_mul_f32 v65, v65, v24
v_mfma_f32_16x16x32_bf16 v[80:83], a[68:71], v[144:147], v[80:83]
ds_read_b64_tr_b16 a[98:99], v119 offset:2048
v_mul_f32 v66, v66, v24
v_mfma_f32_16x16x32_bf16 v[80:83], a[72:75], v[160:163], v[80:83]
s_waitcnt lgkmcnt(8)
ds_read_b64_tr_b16 a[100:101], v119 offset:4096
v_mul_f32 v67, v67, v24
v_mfma_f32_16x16x32_bf16 v[80:83], a[76:79], v[176:179], v[80:83]
ds_read_b64_tr_b16 a[102:103], v119 offset:6144
v_mul_f32 v72, v72, v24
v_mfma_f32_16x16x32_bf16 v[80:83], a[80:83], v[192:195], v[80:83]
s_waitcnt lgkmcnt(8)
ds_read_b64_tr_b16 a[104:105], v119 offset:8192
v_mul_f32 v73, v73, v24
v_mfma_f32_16x16x32_bf16 v[80:83], a[84:87], v[208:211], v[80:83]
s_waitcnt lgkmcnt(7)
ds_read_b64_tr_b16 a[106:107], v119 offset:10240
v_mul_f32 v74, v74, v24
v_mfma_f32_16x16x32_bf16 v[80:83], a[88:91], v[224:227], v[80:83]
s_waitcnt lgkmcnt(6)
ds_read_b64_tr_b16 a[108:109], v119 offset:12288
v_mul_f32 v75, v75, v24
v_mfma_f32_16x16x32_bf16 v[80:83], a[92:95], v[240:243], v[80:83]
ds_read_b64_tr_b16 a[110:111], v119 offset:14336
v_cvt_pk_bf16_f32 v64, v64, v65
v_mfma_f32_16x16x32_bf16 v[84:87], a[64:67], v[132:135], 0
ds_read_b64_tr_b16 a[112:113], v119 offset:16384
v_cvt_pk_bf16_f32 v65, v66, v67
v_mfma_f32_16x16x32_bf16 v[84:87], a[68:71], v[148:151], v[84:87]
ds_read_b64_tr_b16 a[114:115], v119 offset:18432
v_cvt_pk_bf16_f32 v66, v72, v73
v_mfma_f32_16x16x32_bf16 v[84:87], a[72:75], v[164:167], v[84:87]
ds_read_b64_tr_b16 a[116:117], v119 offset:20480
v_cvt_pk_bf16_f32 v67, v74, v75
v_mfma_f32_16x16x32_bf16 v[84:87], a[76:79], v[180:183], v[84:87]
buffer_store_dwordx4 v[64:67], v1, s[4:7], s8 offen offset:2048 sc1
ds_read_b64_tr_b16 a[118:119], v119 offset:22528
v_mfma_f32_16x16x32_bf16 v[84:87], a[80:83], v[196:199], v[84:87]
ds_read_b64_tr_b16 a[120:121], v119 offset:24576
v_mul_f32 v68, v68, v25
v_mfma_f32_16x16x32_bf16 v[84:87], a[84:87], v[212:215], v[84:87]
ds_read_b64_tr_b16 a[122:123], v119 offset:26624
v_mul_f32 v69, v69, v25
v_mfma_f32_16x16x32_bf16 v[84:87], a[88:91], v[228:231], v[84:87]
ds_read_b64_tr_b16 a[124:125], v119 offset:28672
ds_read_b64_tr_b16 a[126:127], v119 offset:30720
v_mfma_f32_16x16x32_bf16 v[84:87], a[92:95], v[244:247], v[84:87]
s_waitcnt vmcnt(21) lgkmcnt(9)
s_barrier
v_add_u32 v119, 32768, v119
v_mfma_f32_16x16x32_bf16 v[88:91], a[96:99], v[128:131], 0
ds_read_b64_tr_b16 a[64:65], v116 offset:0
v_mul_f32 v70, v70, v25
v_mfma_f32_16x16x32_bf16 v[88:91], a[100:103], v[144:147], v[88:91]
ds_read_b64_tr_b16 a[66:67], v116 offset:2048
v_mul_f32 v71, v71, v25
v_mfma_f32_16x16x32_bf16 v[88:91], a[104:107], v[160:163], v[88:91]
s_waitcnt lgkmcnt(8)
ds_read_b64_tr_b16 a[68:69], v116 offset:4096
v_mul_f32 v76, v76, v25
v_mfma_f32_16x16x32_bf16 v[88:91], a[108:111], v[176:179], v[88:91]
ds_read_b64_tr_b16 a[70:71], v116 offset:6144
v_mul_f32 v77, v77, v25
v_mfma_f32_16x16x32_bf16 v[88:91], a[112:115], v[192:195], v[88:91]
s_waitcnt lgkmcnt(8)
ds_read_b64_tr_b16 a[72:73], v116 offset:8192
v_mul_f32 v78, v78, v25
v_mfma_f32_16x16x32_bf16 v[88:91], a[116:119], v[208:211], v[88:91]
s_waitcnt lgkmcnt(7)
ds_read_b64_tr_b16 a[74:75], v116 offset:10240
v_mul_f32 v79, v79, v25
v_mfma_f32_16x16x32_bf16 v[88:91], a[120:123], v[224:227], v[88:91]
s_waitcnt lgkmcnt(6)
ds_read_b64_tr_b16 a[76:77], v116 offset:12288
v_cvt_pk_bf16_f32 v68, v68, v69
v_mfma_f32_16x16x32_bf16 v[88:91], a[124:127], v[240:243], v[88:91]
ds_read_b64_tr_b16 a[78:79], v116 offset:14336
v_cvt_pk_bf16_f32 v69, v70, v71
v_mfma_f32_16x16x32_bf16 v[92:95], a[96:99], v[132:135], 0
ds_read_b64_tr_b16 a[80:81], v116 offset:16384
v_cvt_pk_bf16_f32 v70, v76, v77
v_mfma_f32_16x16x32_bf16 v[92:95], a[100:103], v[148:151], v[92:95]
ds_read_b64_tr_b16 a[82:83], v116 offset:18432
v_cvt_pk_bf16_f32 v71, v78, v79
v_mfma_f32_16x16x32_bf16 v[92:95], a[104:107], v[164:167], v[92:95]
buffer_store_dwordx4 v[68:71], v1, s[4:7], s12 offen offset:2048 sc1
ds_read_b64_tr_b16 a[84:85], v116 offset:20480
v_mfma_f32_16x16x32_bf16 v[92:95], a[108:111], v[180:183], v[92:95]
ds_read_b64_tr_b16 a[86:87], v116 offset:22528
v_mfma_f32_16x16x32_bf16 v[92:95], a[112:115], v[196:199], v[92:95]
ds_read_b64_tr_b16 a[88:89], v116 offset:24576
v_mfma_f32_16x16x32_bf16 v[92:95], a[116:119], v[212:215], v[92:95]
ds_read_b64_tr_b16 a[90:91], v116 offset:26624
v_mfma_f32_16x16x32_bf16 v[92:95], a[120:123], v[228:231], v[92:95]
ds_read_b64_tr_b16 a[92:93], v116 offset:28672
v_mfma_f32_16x16x32_bf16 v[92:95], a[124:127], v[244:247], v[92:95]
s_waitcnt lgkmcnt(8)
ds_read_b64_tr_b16 a[94:95], v116 offset:30720
v_add_u32 v116, 4294901760, v116
v_mfma_f32_16x16x32_bf16 v[32:35], a[64:67], v[128:131], 0
s_add_u32 m0, s18, 32768
ds_read_b64_tr_b16 a[96:97], v117 offset:0
v_mul_f32 v80, v80, v24
v_mfma_f32_16x16x32_bf16 v[32:35], a[68:71], v[144:147], v[32:35]
buffer_load_dwordx4 v112, s[36:39], s81 offen offset:0 lds
ds_read_b64_tr_b16 a[98:99], v117 offset:2048
v_mfma_f32_16x16x32_bf16 v[32:35], a[72:75], v[160:163], v[32:35]
s_waitcnt lgkmcnt(8)
ds_read_b64_tr_b16 a[100:101], v117 offset:4096
v_mul_f32 v81, v81, v24
v_mfma_f32_16x16x32_bf16 v[32:35], a[76:79], v[176:179], v[32:35]
ds_read_b64_tr_b16 a[102:103], v117 offset:6144
v_mul_f32 v82, v82, v24
v_mfma_f32_16x16x32_bf16 v[32:35], a[80:83], v[192:195], v[32:35]
s_waitcnt lgkmcnt(8)
ds_read_b64_tr_b16 a[104:105], v117 offset:8192
v_mul_f32 v83, v83, v24
v_mfma_f32_16x16x32_bf16 v[32:35], a[84:87], v[208:211], v[32:35]
s_waitcnt lgkmcnt(7)
ds_read_b64_tr_b16 a[106:107], v117 offset:10240
v_mul_f32 v88, v88, v24
v_mfma_f32_16x16x32_bf16 v[32:35], a[88:91], v[224:227], v[32:35]
s_waitcnt lgkmcnt(6)
ds_read_b64_tr_b16 a[108:109], v117 offset:12288
v_mul_f32 v89, v89, v24
v_mfma_f32_16x16x32_bf16 v[32:35], a[92:95], v[240:243], v[32:35]
ds_read_b64_tr_b16 a[110:111], v117 offset:14336
v_mul_f32 v90, v90, v24
v_mfma_f32_16x16x32_bf16 v[36:39], a[64:67], v[132:135], 0
buffer_load_dwordx4 v113, s[36:39], s81 offen offset:1024 lds
ds_read_b64_tr_b16 a[112:113], v117 offset:16384
v_mfma_f32_16x16x32_bf16 v[36:39], a[68:71], v[148:151], v[36:39]
ds_read_b64_tr_b16 a[114:115], v117 offset:18432
v_mul_f32 v91, v91, v24
v_mfma_f32_16x16x32_bf16 v[36:39], a[72:75], v[164:167], v[36:39]
ds_read_b64_tr_b16 a[116:117], v117 offset:20480
v_cvt_pk_bf16_f32 v80, v80, v81
v_mfma_f32_16x16x32_bf16 v[36:39], a[76:79], v[180:183], v[36:39]
ds_read_b64_tr_b16 a[118:119], v117 offset:22528
v_cvt_pk_bf16_f32 v81, v82, v83
v_mfma_f32_16x16x32_bf16 v[36:39], a[80:83], v[196:199], v[36:39]
ds_read_b64_tr_b16 a[120:121], v117 offset:24576
v_cvt_pk_bf16_f32 v82, v88, v89
v_mfma_f32_16x16x32_bf16 v[36:39], a[84:87], v[212:215], v[36:39]
ds_read_b64_tr_b16 a[122:123], v117 offset:26624
v_cvt_pk_bf16_f32 v83, v90, v91
v_mfma_f32_16x16x32_bf16 v[36:39], a[88:91], v[228:231], v[36:39]
buffer_store_dwordx4 v[80:83], v1, s[4:7], s8 offen offset:3072 sc1
ds_read_b64_tr_b16 a[124:125], v117 offset:28672
v_mfma_f32_16x16x32_bf16 v[36:39], a[92:95], v[244:247], v[36:39]
s_waitcnt lgkmcnt(8)
ds_read_b64_tr_b16 a[126:127], v117 offset:30720
v_add_u32 v117, 4294901760, v117
v_mfma_f32_16x16x32_bf16 v[40:43], a[96:99], v[128:131], 0
buffer_load_dwordx4 v114, s[36:39], s81 offen offset:2048 lds
ds_read_b64_tr_b16 a[64:65], v118 offset:0
v_mfma_f32_16x16x32_bf16 v[40:43], a[100:103], v[144:147], v[40:43]
ds_read_b64_tr_b16 a[66:67], v118 offset:2048
v_mul_f32 v84, v84, v25
v_mfma_f32_16x16x32_bf16 v[40:43], a[104:107], v[160:163], v[40:43]
s_waitcnt lgkmcnt(8)
ds_read_b64_tr_b16 a[68:69], v118 offset:4096
v_mul_f32 v85, v85, v25
v_mfma_f32_16x16x32_bf16 v[40:43], a[108:111], v[176:179], v[40:43]
ds_read_b64_tr_b16 a[70:71], v118 offset:6144
v_mul_f32 v86, v86, v25
v_mfma_f32_16x16x32_bf16 v[40:43], a[112:115], v[192:195], v[40:43]
s_waitcnt lgkmcnt(8)
ds_read_b64_tr_b16 a[72:73], v118 offset:8192
v_mul_f32 v87, v87, v25
v_mfma_f32_16x16x32_bf16 v[40:43], a[116:119], v[208:211], v[40:43]
s_waitcnt lgkmcnt(7)
ds_read_b64_tr_b16 a[74:75], v118 offset:10240
v_mul_f32 v92, v92, v25
v_mfma_f32_16x16x32_bf16 v[40:43], a[120:123], v[224:227], v[40:43]
s_waitcnt lgkmcnt(6)
ds_read_b64_tr_b16 a[76:77], v118 offset:12288
v_mul_f32 v93, v93, v25
v_mfma_f32_16x16x32_bf16 v[40:43], a[124:127], v[240:243], v[40:43]
buffer_load_dwordx4 v115, s[36:39], s81 offen offset:3072 lds
ds_read_b64_tr_b16 a[78:79], v118 offset:14336
v_mfma_f32_16x16x32_bf16 v[44:47], a[96:99], v[132:135], 0
ds_read_b64_tr_b16 a[80:81], v118 offset:16384
v_mul_f32 v94, v94, v25
v_mfma_f32_16x16x32_bf16 v[44:47], a[100:103], v[148:151], v[44:47]
ds_read_b64_tr_b16 a[82:83], v118 offset:18432
v_mul_f32 v95, v95, v25
v_mfma_f32_16x16x32_bf16 v[44:47], a[104:107], v[164:167], v[44:47]
ds_read_b64_tr_b16 a[84:85], v118 offset:20480
v_cvt_pk_bf16_f32 v84, v84, v85
v_mfma_f32_16x16x32_bf16 v[44:47], a[108:111], v[180:183], v[44:47]
ds_read_b64_tr_b16 a[86:87], v118 offset:22528
v_cvt_pk_bf16_f32 v85, v86, v87
v_mfma_f32_16x16x32_bf16 v[44:47], a[112:115], v[196:199], v[44:47]
ds_read_b64_tr_b16 a[88:89], v118 offset:24576
v_cvt_pk_bf16_f32 v86, v92, v93
v_mfma_f32_16x16x32_bf16 v[44:47], a[116:119], v[212:215], v[44:47]
s_add_u32 s81, s81, 28672
s_add_u32 m0, s18, 36864
ds_read_b64_tr_b16 a[90:91], v118 offset:26624
v_mfma_f32_16x16x32_bf16 v[44:47], a[120:123], v[228:231], v[44:47]
buffer_load_dwordx4 v112, s[36:39], s81 offen offset:0 lds
ds_read_b64_tr_b16 a[92:93], v118 offset:28672
v_mfma_f32_16x16x32_bf16 v[44:47], a[124:127], v[244:247], v[44:47]
s_waitcnt lgkmcnt(8)
ds_read_b64_tr_b16 a[94:95], v118 offset:30720
v_add_u32 v118, 4294901760, v118
v_mfma_f32_16x16x32_bf16 v[48:51], a[64:67], v[128:131], 0
ds_read_b64_tr_b16 a[96:97], v119 offset:0
v_cvt_pk_bf16_f32 v87, v94, v95
v_mfma_f32_16x16x32_bf16 v[48:51], a[68:71], v[144:147], v[48:51]
s_waitcnt lgkmcnt(8)
buffer_store_dwordx4 v[84:87], v1, s[4:7], s12 offen offset:3072 sc1
ds_read_b64_tr_b16 a[98:99], v119 offset:2048
v_mfma_f32_16x16x32_bf16 v[48:51], a[72:75], v[160:163], v[48:51]
s_add_u32 s8, s8, 4096
s_add_u32 s12, s12, 4096
ds_read_b64_tr_b16 a[100:101], v119 offset:4096
v_mfma_f32_16x16x32_bf16 v[48:51], a[76:79], v[176:179], v[48:51]
s_waitcnt lgkmcnt(8)
ds_read_b64_tr_b16 a[102:103], v119 offset:6144
v_mul_f32 v32, v32, v24
v_mfma_f32_16x16x32_bf16 v[48:51], a[80:83], v[192:195], v[48:51]
s_waitcnt lgkmcnt(8)
ds_read_b64_tr_b16 a[104:105], v119 offset:8192
v_mul_f32 v33, v33, v24
v_mfma_f32_16x16x32_bf16 v[48:51], a[84:87], v[208:211], v[48:51]
s_waitcnt lgkmcnt(7)
buffer_load_dwordx4 v113, s[36:39], s81 offen offset:1024 lds
ds_read_b64_tr_b16 a[106:107], v119 offset:10240
v_mfma_f32_16x16x32_bf16 v[48:51], a[88:91], v[224:227], v[48:51]
s_waitcnt lgkmcnt(6)
ds_read_b64_tr_b16 a[108:109], v119 offset:12288
v_mul_f32 v34, v34, v24
v_mfma_f32_16x16x32_bf16 v[48:51], a[92:95], v[240:243], v[48:51]
ds_read_b64_tr_b16 a[110:111], v119 offset:14336
v_mul_f32 v35, v35, v24
v_mfma_f32_16x16x32_bf16 v[52:55], a[64:67], v[132:135], 0
ds_read_b64_tr_b16 a[112:113], v119 offset:16384
v_mul_f32 v40, v40, v24
v_mfma_f32_16x16x32_bf16 v[52:55], a[68:71], v[148:151], v[52:55]
ds_read_b64_tr_b16 a[114:115], v119 offset:18432
v_mul_f32 v41, v41, v24
v_mfma_f32_16x16x32_bf16 v[52:55], a[72:75], v[164:167], v[52:55]
ds_read_b64_tr_b16 a[116:117], v119 offset:20480
v_mul_f32 v42, v42, v24
v_mfma_f32_16x16x32_bf16 v[52:55], a[76:79], v[180:183], v[52:55]
ds_read_b64_tr_b16 a[118:119], v119 offset:22528
v_mul_f32 v43, v43, v24
v_mfma_f32_16x16x32_bf16 v[52:55], a[80:83], v[196:199], v[52:55]
buffer_load_dwordx4 v114, s[36:39], s81 offen offset:2048 lds
ds_read_b64_tr_b16 a[120:121], v119 offset:24576
v_mfma_f32_16x16x32_bf16 v[52:55], a[84:87], v[212:215], v[52:55]
ds_read_b64_tr_b16 a[122:123], v119 offset:26624
v_cvt_pk_bf16_f32 v32, v32, v33
v_mfma_f32_16x16x32_bf16 v[52:55], a[88:91], v[228:231], v[52:55]
ds_read_b64_tr_b16 a[124:125], v119 offset:28672
ds_read_b64_tr_b16 a[126:127], v119 offset:30720
v_mfma_f32_16x16x32_bf16 v[52:55], a[92:95], v[244:247], v[52:55]
s_waitcnt vmcnt(23) lgkmcnt(9)
s_barrier
v_add_u32 v119, 4294901760, v119
v_mfma_f32_16x16x32_bf16 v[56:59], a[96:99], v[128:131], 0
ds_read_b64_tr_b16 a[64:65], v116 offset:0
v_cvt_pk_bf16_f32 v33, v34, v35
v_mfma_f32_16x16x32_bf16 v[56:59], a[100:103], v[144:147], v[56:59]
ds_read_b64_tr_b16 a[66:67], v116 offset:2048
v_cvt_pk_bf16_f32 v34, v40, v41
v_mfma_f32_16x16x32_bf16 v[56:59], a[104:107], v[160:163], v[56:59]
s_waitcnt lgkmcnt(8)
ds_read_b64_tr_b16 a[68:69], v116 offset:4096
v_cvt_pk_bf16_f32 v35, v42, v43
v_mfma_f32_16x16x32_bf16 v[56:59], a[108:111], v[176:179], v[56:59]
buffer_load_dwordx4 v115, s[36:39], s81 offen offset:3072 lds
ds_read_b64_tr_b16 a[70:71], v116 offset:6144
v_mfma_f32_16x16x32_bf16 v[56:59], a[112:115], v[192:195], v[56:59]
s_waitcnt lgkmcnt(8)
buffer_store_dwordx4 v[32:35], v1, s[4:7], s8 offen offset:0 sc1
ds_read_b64_tr_b16 a[72:73], v116 offset:8192
v_mfma_f32_16x16x32_bf16 v[56:59], a[116:119], v[208:211], v[56:59]
PAD_15:
s_cbranch_execz M_tret
s_waitcnt lgkmcnt(7)
ds_read_b64_tr_b16 a[74:75], v116 offset:10240
v_mul_f32 v36, v36, v25
v_mfma_f32_16x16x32_bf16 v[56:59], a[120:123], v[224:227], v[56:59]
s_waitcnt lgkmcnt(6)
ds_read_b64_tr_b16 a[76:77], v116 offset:12288
v_mul_f32 v37, v37, v25
v_mfma_f32_16x16x32_bf16 v[56:59], a[124:127], v[240:243], v[56:59]
ds_read_b64_tr_b16 a[78:79], v116 offset:14336
v_mul_f32 v38, v38, v25
v_mfma_f32_16x16x32_bf16 v[60:63], a[96:99], v[132:135], 0
ds_read_b64_tr_b16 a[80:81], v116 offset:16384
v_mul_f32 v39, v39, v25
v_mfma_f32_16x16x32_bf16 v[60:63], a[100:103], v[148:151], v[60:63]
s_sub_u32 s81, s81, 28544
ds_read_b64_tr_b16 a[82:83], v116 offset:18432
v_mul_f32 v44, v44, v25
v_mfma_f32_16x16x32_bf16 v[60:63], a[104:107], v[164:167], v[60:63]
ds_read_b64_tr_b16 a[84:85], v116 offset:20480
v_mul_f32 v45, v45, v25
v_mfma_f32_16x16x32_bf16 v[60:63], a[108:111], v[180:183], v[60:63]
ds_read_b64_tr_b16 a[86:87], v116 offset:22528
v_mul_f32 v46, v46, v25
v_mfma_f32_16x16x32_bf16 v[60:63], a[112:115], v[196:199], v[60:63]
ds_read_b64_tr_b16 a[88:89], v116 offset:24576
v_mul_f32 v47, v47, v25
v_mfma_f32_16x16x32_bf16 v[60:63], a[116:119], v[212:215], v[60:63]
ds_read_b64_tr_b16 a[90:91], v116 offset:26624
v_cvt_pk_bf16_f32 v36, v36, v37
v_mfma_f32_16x16x32_bf16 v[60:63], a[120:123], v[228:231], v[60:63]
ds_read_b64_tr_b16 a[92:93], v116 offset:28672
v_cvt_pk_bf16_f32 v37, v38, v39
v_mfma_f32_16x16x32_bf16 v[60:63], a[124:127], v[244:247], v[60:63]
s_waitcnt lgkmcnt(8)
ds_read_b64_tr_b16 a[94:95], v116 offset:30720
v_add_u32 v116, 4294901760, v116
v_mfma_f32_16x16x32_bf16 v[64:67], a[64:67], v[128:131], 0
s_add_u32 m0, s18, 98304
ds_read_b64_tr_b16 a[96:97], v117 offset:0
v_cvt_pk_bf16_f32 v38, v44, v45
v_mfma_f32_16x16x32_bf16 v[64:67], a[68:71], v[144:147], v[64:67]
buffer_load_dwordx4 v112, s[36:39], s81 offen offset:0 lds
ds_read_b64_tr_b16 a[98:99], v117 offset:2048
v_mfma_f32_16x16x32_bf16 v[64:67], a[72:75], v[160:163], v[64:67]
s_waitcnt lgkmcnt(8)
ds_read_b64_tr_b16 a[100:101], v117 offset:4096
v_cvt_pk_bf16_f32 v39, v46, v47
v_mfma_f32_16x16x32_bf16 v[64:67], a[76:79], v[176:179], v[64:67]
buffer_store_dwordx4 v[36:39], v1, s[4:7], s12 offen offset:0 sc1
ds_read_b64_tr_b16 a[102:103], v117 offset:6144
v_mfma_f32_16x16x32_bf16 v[64:67], a[80:83], v[192:195], v[64:67]
s_waitcnt lgkmcnt(8)
ds_read_b64_tr_b16 a[104:105], v117 offset:8192
v_mul_f32 v48, v48, v24
v_mfma_f32_16x16x32_bf16 v[64:67], a[84:87], v[208:211], v[64:67]
s_waitcnt lgkmcnt(7)
ds_read_b64_tr_b16 a[106:107], v117 offset:10240
v_mul_f32 v49, v49, v24
v_mfma_f32_16x16x32_bf16 v[64:67], a[88:91], v[224:227], v[64:67]
s_waitcnt lgkmcnt(6)
ds_read_b64_tr_b16 a[108:109], v117 offset:12288
v_mul_f32 v50, v50, v24
v_mfma_f32_16x16x32_bf16 v[64:67], a[92:95], v[240:243], v[64:67]
ds_read_b64_tr_b16 a[110:111], v117 offset:14336
v_mul_f32 v51, v51, v24
v_mfma_f32_16x16x32_bf16 v[68:71], a[64:67], v[132:135], 0
buffer_load_dwordx4 v113, s[36:39], s81 offen offset:1024 lds
ds_read_b64_tr_b16 a[112:113], v117 offset:16384
v_mfma_f32_16x16x32_bf16 v[68:71], a[68:71], v[148:151], v[68:71]
ds_read_b64_tr_b16 a[114:115], v117 offset:18432
v_mul_f32 v56, v56, v24
v_mfma_f32_16x16x32_bf16 v[68:71], a[72:75], v[164:167], v[68:71]
ds_read_b64_tr_b16 a[116:117], v117 offset:20480
v_mul_f32 v57, v57, v24
v_mfma_f32_16x16x32_bf16 v[68:71], a[76:79], v[180:183], v[68:71]
ds_read_b64_tr_b16 a[118:119], v117 offset:22528
v_mul_f32 v58, v58, v24
v_mfma_f32_16x16x32_bf16 v[68:71], a[80:83], v[196:199], v[68:71]
ds_read_b64_tr_b16 a[120:121], v117 offset:24576
v_mul_f32 v59, v59, v24
v_mfma_f32_16x16x32_bf16 v[68:71], a[84:87], v[212:215], v[68:71]
ds_read_b64_tr_b16 a[122:123], v117 offset:26624
v_cvt_pk_bf16_f32 v48, v48, v49
v_mfma_f32_16x16x32_bf16 v[68:71], a[88:91], v[228:231], v[68:71]
ds_read_b64_tr_b16 a[124:125], v117 offset:28672
v_cvt_pk_bf16_f32 v49, v50, v51
v_mfma_f32_16x16x32_bf16 v[68:71], a[92:95], v[244:247], v[68:71]
s_waitcnt lgkmcnt(8)
ds_read_b64_tr_b16 a[126:127], v117 offset:30720
v_add_u32 v117, 4294901760, v117
v_mfma_f32_16x16x32_bf16 v[72:75], a[96:99], v[128:131], 0
buffer_load_dwordx4 v114, s[36:39], s81 offen offset:2048 lds
ds_read_b64_tr_b16 a[64:65], v118 offset:0
v_mfma_f32_16x16x32_bf16 v[72:75], a[100:103], v[144:147], v[72:75]
ds_read_b64_tr_b16 a[66:67], v118 offset:2048
v_cvt_pk_bf16_f32 v50, v56, v57
v_mfma_f32_16x16x32_bf16 v[72:75], a[104:107], v[160:163], v[72:75]
s_waitcnt lgkmcnt(8)
ds_read_b64_tr_b16 a[68:69], v118 offset:4096
v_cvt_pk_bf16_f32 v51, v58, v59
v_mfma_f32_16x16x32_bf16 v[72:75], a[108:111], v[176:179], v[72:75]
buffer_store_dwordx4 v[48:51], v1, s[4:7], s8 offen offset:1024 sc1
ds_read_b64_tr_b16 a[70:71], v118 offset:6144
v_mfma_f32_16x16x32_bf16 v[72:75], a[112:115], v[192:195], v[72:75]
s_waitcnt lgkmcnt(8)
ds_read_b64_tr_b16 a[72:73], v118 offset:8192
v_mul_f32 v52, v52, v25
v_mfma_f32_16x16x32_bf16 v[72:75], a[116:119], v[208:211], v[72:75]
s_waitcnt lgkmcnt(7)
ds_read_b64_tr_b16 a[74:75], v118 offset:10240
v_mul_f32 v53, v53, v25
v_mfma_f32_16x16x32_bf16 v[72:75], a[120:123], v[224:227], v[72:75]
s_waitcnt lgkmcnt(6)
ds_read_b64_tr_b16 a[76:77], v118 offset:12288
v_mul_f32 v54, v54, v25
v_mfma_f32_16x16x32_bf16 v[72:75], a[124:127], v[240:243], v[72:75]
buffer_load_dwordx4 v115, s[36:39], s81 offen offset:3072 lds
ds_read_b64_tr_b16 a[78:79], v118 offset:14336
v_mfma_f32_16x16x32_bf16 v[76:79], a[96:99], v[132:135], 0
ds_read_b64_tr_b16 a[80:81], v118 offset:16384
v_mul_f32 v55, v55, v25
v_mfma_f32_16x16x32_bf16 v[76:79], a[100:103], v[148:151], v[76:79]
ds_read_b64_tr_b16 a[82:83], v118 offset:18432
v_mul_f32 v60, v60, v25
v_mfma_f32_16x16x32_bf16 v[76:79], a[104:107], v[164:167], v[76:79]
ds_read_b64_tr_b16 a[84:85], v118 offset:20480
v_mul_f32 v61, v61, v25
v_mfma_f32_16x16x32_bf16 v[76:79], a[108:111], v[180:183], v[76:79]
ds_read_b64_tr_b16 a[86:87], v118 offset:22528
v_mul_f32 v62, v62, v25
v_mfma_f32_16x16x32_bf16 v[76:79], a[112:115], v[196:199], v[76:79]
ds_read_b64_tr_b16 a[88:89], v118 offset:24576
v_mul_f32 v63, v63, v25
v_mfma_f32_16x16x32_bf16 v[76:79], a[116:119], v[212:215], v[76:79]
s_add_u32 s81, s81, 28672
s_add_u32 m0, s18, 102400
ds_read_b64_tr_b16 a[90:91], v118 offset:26624
v_mfma_f32_16x16x32_bf16 v[76:79], a[120:123], v[228:231], v[76:79]
buffer_load_dwordx4 v112, s[36:39], s81 offen offset:0 lds
ds_read_b64_tr_b16 a[92:93], v118 offset:28672
v_mfma_f32_16x16x32_bf16 v[76:79], a[124:127], v[244:247], v[76:79]
s_waitcnt lgkmcnt(8)
ds_read_b64_tr_b16 a[94:95], v118 offset:30720
v_add_u32 v118, 4294901760, v118
v_mfma_f32_16x16x32_bf16 v[80:83], a[64:67], v[128:131], 0
ds_read_b64_tr_b16 a[96:97], v119 offset:0
v_cvt_pk_bf16_f32 v52, v52, v53
v_mfma_f32_16x16x32_bf16 v[80:83], a[68:71], v[144:147], v[80:83]
ds_read_b64_tr_b16 a[98:99], v119 offset:2048
v_cvt_pk_bf16_f32 v53, v54, v55
v_mfma_f32_16x16x32_bf16 v[80:83], a[72:75], v[160:163], v[80:83]
s_waitcnt lgkmcnt(8)
ds_read_b64_tr_b16 a[100:101], v119 offset:4096
v_cvt_pk_bf16_f32 v54, v60, v61
v_mfma_f32_16x16x32_bf16 v[80:83], a[76:79], v[176:179], v[80:83]
ds_read_b64_tr_b16 a[102:103], v119 offset:6144
v_cvt_pk_bf16_f32 v55, v62, v63
v_mfma_f32_16x16x32_bf16 v[80:83], a[80:83], v[192:195], v[80:83]
s_waitcnt lgkmcnt(8)
buffer_store_dwordx4 v[52:55], v1, s[4:7], s12 offen offset:1024 sc1
ds_read_b64_tr_b16 a[104:105], v119 offset:8192
v_mfma_f32_16x16x32_bf16 v[80:83], a[84:87], v[208:211], v[80:83]
s_waitcnt lgkmcnt(7)
buffer_load_dwordx4 v113, s[36:39], s81 offen offset:1024 lds
ds_read_b64_tr_b16 a[106:107], v119 offset:10240
v_mfma_f32_16x16x32_bf16 v[80:83], a[88:91], v[224:227], v[80:83]
s_waitcnt lgkmcnt(6)
ds_read_b64_tr_b16 a[108:109], v119 offset:12288
v_mul_f32 v64, v64, v24
v_mfma_f32_16x16x32_bf16 v[80:83], a[92:95], v[240:243], v[80:83]
ds_read_b64_tr_b16 a[110:111], v119 offset:14336
v_mul_f32 v65, v65, v24
v_mfma_f32_16x16x32_bf16 v[84:87], a[64:67], v[132:135], 0
ds_read_b64_tr_b16 a[112:113], v119 offset:16384
v_mul_f32 v66, v66, v24
v_mfma_f32_16x16x32_bf16 v[84:87], a[68:71], v[148:151], v[84:87]
ds_read_b64_tr_b16 a[114:115], v119 offset:18432
v_mul_f32 v67, v67, v24
v_mfma_f32_16x16x32_bf16 v[84:87], a[72:75], v[164:167], v[84:87]
ds_read_b64_tr_b16 a[116:117], v119 offset:20480
v_mul_f32 v72, v72, v24
v_mfma_f32_16x16x32_bf16 v[84:87], a[76:79], v[180:183], v[84:87]
ds_read_b64_tr_b16 a[118:119], v119 offset:22528
v_mul_f32 v73, v73, v24
v_mfma_f32_16x16x32_bf16 v[84:87], a[80:83], v[196:199], v[84:87]
buffer_load_dwordx4 v114, s[36:39], s81 offen offset:2048 lds
ds_read_b64_tr_b16 a[120:121], v119 offset:24576
v_mfma_f32_16x16x32_bf16 v[84:87], a[84:87], v[212:215], v[84:87]
ds_read_b64_tr_b16 a[122:123], v119 offset:26624
v_mul_f32 v74, v74, v24
v_mfma_f32_16x16x32_bf16 v[84:87], a[88:91], v[228:231], v[84:87]
ds_read_b64_tr_b16 a[124:125], v119 offset:28672
ds_read_b64_tr_b16 a[126:127], v119 offset:30720
v_mfma_f32_16x16x32_bf16 v[84:87], a[92:95], v[244:247], v[84:87]
s_waitcnt vmcnt(27) lgkmcnt(9)
s_barrier
v_add_u32 v119, 4294901760, v119
v_mfma_f32_16x16x32_bf16 v[88:91], a[96:99], v[128:131], 0
ds_read_b64_tr_b16 a[64:65], v116 offset:0
v_mul_f32 v75, v75, v24
v_mfma_f32_16x16x32_bf16 v[88:91], a[100:103], v[144:147], v[88:91]
ds_read_b64_tr_b16 a[66:67], v116 offset:2048
v_cvt_pk_bf16_f32 v64, v64, v65
v_mfma_f32_16x16x32_bf16 v[88:91], a[104:107], v[160:163], v[88:91]
s_waitcnt lgkmcnt(8)
ds_read_b64_tr_b16 a[68:69], v116 offset:4096
v_cvt_pk_bf16_f32 v65, v66, v67
v_mfma_f32_16x16x32_bf16 v[88:91], a[108:111], v[176:179], v[88:91]
buffer_load_dwordx4 v115, s[36:39], s81 offen offset:3072 lds
ds_read_b64_tr_b16 a[70:71], v116 offset:6144
v_mfma_f32_16x16x32_bf16 v[88:91], a[112:115], v[192:195], v[88:91]
s_waitcnt lgkmcnt(8)
ds_read_b64_tr_b16 a[72:73], v116 offset:8192
v_cvt_pk_bf16_f32 v66, v72, v73
v_mfma_f32_16x16x32_bf16 v[88:91], a[116:119], v[208:211], v[88:91]
s_waitcnt lgkmcnt(7)
ds_read_b64_tr_b16 a[74:75], v116 offset:10240
v_cvt_pk_bf16_f32 v67, v74, v75
v_mfma_f32_16x16x32_bf16 v[88:91], a[120:123], v[224:227], v[88:91]
s_waitcnt lgkmcnt(6)
buffer_store_dwordx4 v[64:67], v1, s[4:7], s8 offen offset:2048 sc1
ds_read_b64_tr_b16 a[76:77], v116 offset:12288
v_mfma_f32_16x16x32_bf16 v[88:91], a[124:127], v[240:243], v[88:91]
ds_read_b64_tr_b16 a[78:79], v116 offset:14336
v_mul_f32 v68, v68, v25
v_mfma_f32_16x16x32_bf16 v[92:95], a[96:99], v[132:135], 0
ds_read_b64_tr_b16 a[80:81], v116 offset:16384
v_mul_f32 v69, v69, v25
v_mfma_f32_16x16x32_bf16 v[92:95], a[100:103], v[148:151], v[92:95]
s_sub_u32 s81, s81, 28544
ds_read_b64_tr_b16 a[82:83], v116 offset:18432
v_mul_f32 v70, v70, v25
v_mfma_f32_16x16x32_bf16 v[92:95], a[104:107], v[164:167], v[92:95]
ds_read_b64_tr_b16 a[84:85], v116 offset:20480
v_mul_f32 v71, v71, v25
v_mfma_f32_16x16x32_bf16 v[92:95], a[108:111], v[180:183], v[92:95]
ds_read_b64_tr_b16 a[86:87], v116 offset:22528
v_mul_f32 v76, v76, v25
v_mfma_f32_16x16x32_bf16 v[92:95], a[112:115], v[196:199], v[92:95]
ds_read_b64_tr_b16 a[88:89], v116 offset:24576
v_mul_f32 v77, v77, v25
v_mfma_f32_16x16x32_bf16 v[92:95], a[116:119], v[212:215], v[92:95]
ds_read_b64_tr_b16 a[90:91], v116 offset:26624
v_mul_f32 v78, v78, v25
v_mfma_f32_16x16x32_bf16 v[92:95], a[120:123], v[228:231], v[92:95]
ds_read_b64_tr_b16 a[92:93], v116 offset:28672
v_mul_f32 v79, v79, v25
v_mfma_f32_16x16x32_bf16 v[92:95], a[124:127], v[244:247], v[92:95]
s_waitcnt lgkmcnt(8)
ds_read_b64_tr_b16 a[94:95], v116 offset:30720
v_add_u32 v116, 32768, v116
v_mfma_f32_16x16x32_bf16 v[32:35], a[64:67], v[128:131], 0
ds_read_b64_tr_b16 a[96:97], v117 offset:0
v_cvt_pk_bf16_f32 v68, v68, v69
v_mfma_f32_16x16x32_bf16 v[32:35], a[68:71], v[144:147], v[32:35]
ds_read_b64_tr_b16 a[98:99], v117 offset:2048
v_cvt_pk_bf16_f32 v69, v70, v71
v_mfma_f32_16x16x32_bf16 v[32:35], a[72:75], v[160:163], v[32:35]
s_waitcnt lgkmcnt(8)
ds_read_b64_tr_b16 a[100:101], v117 offset:4096
v_cvt_pk_bf16_f32 v70, v76, v77
v_mfma_f32_16x16x32_bf16 v[32:35], a[76:79], v[176:179], v[32:35]
ds_read_b64_tr_b16 a[102:103], v117 offset:6144
v_cvt_pk_bf16_f32 v71, v78, v79
v_mfma_f32_16x16x32_bf16 v[32:35], a[80:83], v[192:195], v[32:35]
s_waitcnt lgkmcnt(8)
buffer_store_dwordx4 v[68:71], v1, s[4:7], s12 offen offset:2048 sc1
ds_read_b64_tr_b16 a[104:105], v117 offset:8192
v_mfma_f32_16x16x32_bf16 v[32:35], a[84:87], v[208:211], v[32:35]
s_waitcnt lgkmcnt(7)
ds_read_b64_tr_b16 a[106:107], v117 offset:10240
v_mul_f32 v80, v80, v24
v_mfma_f32_16x16x32_bf16 v[32:35], a[88:91], v[224:227], v[32:35]
s_waitcnt lgkmcnt(6)
ds_read_b64_tr_b16 a[108:109], v117 offset:12288
v_mul_f32 v81, v81, v24
v_mfma_f32_16x16x32_bf16 v[32:35], a[92:95], v[240:243], v[32:35]
ds_read_b64_tr_b16 a[110:111], v117 offset:14336
v_mul_f32 v82, v82, v24
v_mfma_f32_16x16x32_bf16 v[36:39], a[64:67], v[132:135], 0
ds_read_b64_tr_b16 a[112:113], v117 offset:16384
v_mul_f32 v83, v83, v24
v_mfma_f32_16x16x32_bf16 v[36:39], a[68:71], v[148:151], v[36:39]
ds_read_b64_tr_b16 a[114:115], v117 offset:18432
v_mul_f32 v88, v88, v24
v_mfma_f32_16x16x32_bf16 v[36:39], a[72:75], v[164:167], v[36:39]
ds_read_b64_tr_b16 a[116:117], v117 offset:20480
v_mul_f32 v89, v89, v24
v_mfma_f32_16x16x32_bf16 v[36:39], a[76:79], v[180:183], v[36:39]
ds_read_b64_tr_b16 a[118:119], v117 offset:22528
v_mul_f32 v90, v90, v24
v_mfma_f32_16x16x32_bf16 v[36:39], a[80:83], v[196:199], v[36:39]
ds_read_b64_tr_b16 a[120:121], v117 offset:24576
v_mul_f32 v91, v91, v24
v_mfma_f32_16x16x32_bf16 v[36:39], a[84:87], v[212:215], v[36:39]
ds_read_b64_tr_b16 a[122:123], v117 offset:26624
v_cvt_pk_bf16_f32 v80, v80, v81
v_mfma_f32_16x16x32_bf16 v[36:39], a[88:91], v[228:231], v[36:39]
ds_read_b64_tr_b16 a[124:125], v117 offset:28672
v_cvt_pk_bf16_f32 v81, v82, v83
v_mfma_f32_16x16x32_bf16 v[36:39], a[92:95], v[244:247], v[36:39]
s_waitcnt lgkmcnt(8)
ds_read_b64_tr_b16 a[126:127], v117 offset:30720
v_add_u32 v117, 32768, v117
v_mfma_f32_16x16x32_bf16 v[40:43], a[96:99], v[128:131], 0
ds_read_b64_tr_b16 a[64:65], v118 offset:0
v_cvt_pk_bf16_f32 v82, v88, v89
v_mfma_f32_16x16x32_bf16 v[40:43], a[100:103], v[144:147], v[40:43]
ds_read_b64_tr_b16 a[66:67], v118 offset:2048
v_cvt_pk_bf16_f32 v83, v90, v91
v_mfma_f32_16x16x32_bf16 v[40:43], a[104:107], v[160:163], v[40:43]
s_waitcnt lgkmcnt(8)
buffer_store_dwordx4 v[80:83], v1, s[4:7], s8 offen offset:3072 sc1
ds_read_b64_tr_b16 a[68:69], v118 offset:4096
v_mfma_f32_16x16x32_bf16 v[40:43], a[108:111], v[176:179], v[40:43]
ds_read_b64_tr_b16 a[70:71], v118 offset:6144
v_mul_f32 v84, v84, v25
v_mfma_f32_16x16x32_bf16 v[40:43], a[112:115], v[192:195], v[40:43]
s_waitcnt lgkmcnt(8)
ds_read_b64_tr_b16 a[72:73], v118 offset:8192
v_mul_f32 v85, v85, v25
v_mfma_f32_16x16x32_bf16 v[40:43], a[116:119], v[208:211], v[40:43]
s_waitcnt lgkmcnt(7)
ds_read_b64_tr_b16 a[74:75], v118 offset:10240
v_mul_f32 v86, v86, v25
v_mfma_f32_16x16x32_bf16 v[40:43], a[120:123], v[224:227], v[40:43]
s_waitcnt lgkmcnt(6)
ds_read_b64_tr_b16 a[76:77], v118 offset:12288
v_mul_f32 v87, v87, v25
v_mfma_f32_16x16x32_bf16 v[40:43], a[124:127], v[240:243], v[40:43]
ds_read_b64_tr_b16 a[78:79], v118 offset:14336
v_mul_f32 v92, v92, v25
v_mfma_f32_16x16x32_bf16 v[44:47], a[96:99], v[132:135], 0
ds_read_b64_tr_b16 a[80:81], v118 offset:16384
v_mul_f32 v93, v93, v25
v_mfma_f32_16x16x32_bf16 v[44:47], a[100:103], v[148:151], v[44:47]
ds_read_b64_tr_b16 a[82:83], v118 offset:18432
v_mul_f32 v94, v94, v25
v_mfma_f32_16x16x32_bf16 v[44:47], a[104:107], v[164:167], v[44:47]
ds_read_b64_tr_b16 a[84:85], v118 offset:20480
v_mul_f32 v95, v95, v25
v_mfma_f32_16x16x32_bf16 v[44:47], a[108:111], v[180:183], v[44:47]
ds_read_b64_tr_b16 a[86:87], v118 offset:22528
v_cvt_pk_bf16_f32 v84, v84, v85
v_mfma_f32_16x16x32_bf16 v[44:47], a[112:115], v[196:199], v[44:47]
ds_read_b64_tr_b16 a[88:89], v118 offset:24576
v_cvt_pk_bf16_f32 v85, v86, v87
v_mfma_f32_16x16x32_bf16 v[44:47], a[116:119], v[212:215], v[44:47]
ds_read_b64_tr_b16 a[90:91], v118 offset:26624
v_cvt_pk_bf16_f32 v86, v92, v93
v_mfma_f32_16x16x32_bf16 v[44:47], a[120:123], v[228:231], v[44:47]
ds_read_b64_tr_b16 a[92:93], v118 offset:28672
v_cvt_pk_bf16_f32 v87, v94, v95
v_mfma_f32_16x16x32_bf16 v[44:47], a[124:127], v[244:247], v[44:47]
s_waitcnt lgkmcnt(8)
ds_read_b64_tr_b16 a[94:95], v118 offset:30720
v_add_u32 v118, 32768, v118
v_mfma_f32_16x16x32_bf16 v[48:51], a[64:67], v[128:131], 0
buffer_store_dwordx4 v[84:87], v1, s[4:7], s12 offen offset:3072 sc1
ds_read_b64_tr_b16 a[96:97], v119 offset:0
v_mfma_f32_16x16x32_bf16 v[48:51], a[68:71], v[144:147], v[48:51]
s_add_u32 s8, s8, 4096
s_add_u32 s12, s12, 4096
ds_read_b64_tr_b16 a[98:99], v119 offset:2048
v_mfma_f32_16x16x32_bf16 v[48:51], a[72:75], v[160:163], v[48:51]
s_waitcnt lgkmcnt(8)
ds_read_b64_tr_b16 a[100:101], v119 offset:4096
v_mul_f32 v32, v32, v24
v_mfma_f32_16x16x32_bf16 v[48:51], a[76:79], v[176:179], v[48:51]
ds_read_b64_tr_b16 a[102:103], v119 offset:6144
v_mul_f32 v33, v33, v24
v_mfma_f32_16x16x32_bf16 v[48:51], a[80:83], v[192:195], v[48:51]
s_waitcnt lgkmcnt(8)
ds_read_b64_tr_b16 a[104:105], v119 offset:8192
v_mul_f32 v34, v34, v24
v_mfma_f32_16x16x32_bf16 v[48:51], a[84:87], v[208:211], v[48:51]
s_waitcnt lgkmcnt(7)
ds_read_b64_tr_b16 a[106:107], v119 offset:10240
v_mul_f32 v35, v35, v24
v_mfma_f32_16x16x32_bf16 v[48:51], a[88:91], v[224:227], v[48:51]
s_waitcnt lgkmcnt(6)
ds_read_b64_tr_b16 a[108:109], v119 offset:12288
v_mul_f32 v40, v40, v24
v_mfma_f32_16x16x32_bf16 v[48:51], a[92:95], v[240:243], v[48:51]
ds_read_b64_tr_b16 a[110:111], v119 offset:14336
v_mul_f32 v41, v41, v24
v_mfma_f32_16x16x32_bf16 v[52:55], a[64:67], v[132:135], 0
ds_read_b64_tr_b16 a[112:113], v119 offset:16384
v_mul_f32 v42, v42, v24
v_mfma_f32_16x16x32_bf16 v[52:55], a[68:71], v[148:151], v[52:55]
ds_read_b64_tr_b16 a[114:115], v119 offset:18432
v_mul_f32 v43, v43, v24
v_mfma_f32_16x16x32_bf16 v[52:55], a[72:75], v[164:167], v[52:55]
ds_read_b64_tr_b16 a[116:117], v119 offset:20480
v_cvt_pk_bf16_f32 v32, v32, v33
v_mfma_f32_16x16x32_bf16 v[52:55], a[76:79], v[180:183], v[52:55]
ds_read_b64_tr_b16 a[118:119], v119 offset:22528
v_cvt_pk_bf16_f32 v33, v34, v35
v_mfma_f32_16x16x32_bf16 v[52:55], a[80:83], v[196:199], v[52:55]
ds_read_b64_tr_b16 a[120:121], v119 offset:24576
v_cvt_pk_bf16_f32 v34, v40, v41
v_mfma_f32_16x16x32_bf16 v[52:55], a[84:87], v[212:215], v[52:55]
ds_read_b64_tr_b16 a[122:123], v119 offset:26624
v_cvt_pk_bf16_f32 v35, v42, v43
v_mfma_f32_16x16x32_bf16 v[52:55], a[88:91], v[228:231], v[52:55]
ds_read_b64_tr_b16 a[124:125], v119 offset:28672
ds_read_b64_tr_b16 a[126:127], v119 offset:30720
v_mfma_f32_16x16x32_bf16 v[52:55], a[92:95], v[244:247], v[52:55]
s_waitcnt vmcnt(16) lgkmcnt(9)
s_barrier
v_add_u32 v119, 32768, v119
v_mfma_f32_16x16x32_bf16 v[56:59], a[96:99], v[128:131], 0
buffer_store_dwordx4 v[32:35], v1, s[4:7], s8 offen offset:0 sc1
ds_read_b64_tr_b16 a[64:65], v116 offset:0
v_mfma_f32_16x16x32_bf16 v[56:59], a[100:103], v[144:147], v[56:59]
ds_read_b64_tr_b16 a[66:67], v116 offset:2048
v_mul_f32 v36, v36, v25
v_mfma_f32_16x16x32_bf16 v[56:59], a[104:107], v[160:163], v[56:59]
s_waitcnt lgkmcnt(8)
ds_read_b64_tr_b16 a[68:69], v116 offset:4096
v_mul_f32 v37, v37, v25
v_mfma_f32_16x16x32_bf16 v[56:59], a[108:111], v[176:179], v[56:59]
ds_read_b64_tr_b16 a[70:71], v116 offset:6144
v_mul_f32 v38, v38, v25
v_mfma_f32_16x16x32_bf16 v[56:59], a[112:115], v[192:195], v[56:59]
s_waitcnt lgkmcnt(8)
ds_read_b64_tr_b16 a[72:73], v116 offset:8192
v_mul_f32 v39, v39, v25
v_mfma_f32_16x16x32_bf16 v[56:59], a[116:119], v[208:211], v[56:59]
s_waitcnt lgkmcnt(7)
ds_read_b64_tr_b16 a[74:75], v116 offset:10240
v_mul_f32 v44, v44, v25
v_mfma_f32_16x16x32_bf16 v[56:59], a[120:123], v[224:227], v[56:59]
s_waitcnt lgkmcnt(6)
ds_read_b64_tr_b16 a[76:77], v116 offset:12288
v_mul_f32 v45, v45, v25
v_mfma_f32_16x16x32_bf16 v[56:59], a[124:127], v[240:243], v[56:59]
ds_read_b64_tr_b16 a[78:79], v116 offset:14336
v_mul_f32 v46, v46, v25
v_mfma_f32_16x16x32_bf16 v[60:63], a[96:99], v[132:135], 0
ds_read_b64_tr_b16 a[80:81], v116 offset:16384
v_mul_f32 v47, v47, v25
v_mfma_f32_16x16x32_bf16 v[60:63], a[100:103], v[148:151], v[60:63]
ds_read_b64_tr_b16 a[82:83], v116 offset:18432
v_cvt_pk_bf16_f32 v36, v36, v37
v_mfma_f32_16x16x32_bf16 v[60:63], a[104:107], v[164:167], v[60:63]
ds_read_b64_tr_b16 a[84:85], v116 offset:20480
v_cvt_pk_bf16_f32 v37, v38, v39
v_mfma_f32_16x16x32_bf16 v[60:63], a[108:111], v[180:183], v[60:63]
ds_read_b64_tr_b16 a[86:87], v116 offset:22528
v_cvt_pk_bf16_f32 v38, v44, v45
v_mfma_f32_16x16x32_bf16 v[60:63], a[112:115], v[196:199], v[60:63]
ds_read_b64_tr_b16 a[88:89], v116 offset:24576
v_cvt_pk_bf16_f32 v39, v46, v47
v_mfma_f32_16x16x32_bf16 v[60:63], a[116:119], v[212:215], v[60:63]
buffer_store_dwordx4 v[36:39], v1, s[4:7], s12 offen offset:0 sc1
ds_read_b64_tr_b16 a[90:91], v116 offset:26624
v_mfma_f32_16x16x32_bf16 v[60:63], a[120:123], v[228:231], v[60:63]
ds_read_b64_tr_b16 a[92:93], v116 offset:28672
v_mfma_f32_16x16x32_bf16 v[60:63], a[124:127], v[244:247], v[60:63]
s_waitcnt lgkmcnt(8)
ds_read_b64_tr_b16 a[94:95], v116 offset:30720
v_add_u32 v116, 65536, v116
v_mfma_f32_16x16x32_bf16 v[64:67], a[64:67], v[128:131], 0
ds_read_b64_tr_b16 a[96:97], v117 offset:0
v_mul_f32 v48, v48, v24
v_mfma_f32_16x16x32_bf16 v[64:67], a[68:71], v[144:147], v[64:67]
ds_read_b64_tr_b16 a[98:99], v117 offset:2048
v_mul_f32 v49, v49, v24
v_mfma_f32_16x16x32_bf16 v[64:67], a[72:75], v[160:163], v[64:67]
s_waitcnt lgkmcnt(8)
ds_read_b64_tr_b16 a[100:101], v117 offset:4096
v_mul_f32 v50, v50, v24
v_mfma_f32_16x16x32_bf16 v[64:67], a[76:79], v[176:179], v[64:67]
ds_read_b64_tr_b16 a[102:103], v117 offset:6144
v_mul_f32 v51, v51, v24
v_mfma_f32_16x16x32_bf16 v[64:67], a[80:83], v[192:195], v[64:67]
s_waitcnt lgkmcnt(8)
ds_read_b64_tr_b16 a[104:105], v117 offset:8192
v_mul_f32 v56, v56, v24
v_mfma_f32_16x16x32_bf16 v[64:67], a[84:87], v[208:211], v[64:67]
s_waitcnt lgkmcnt(7)
ds_read_b64_tr_b16 a[106:107], v117 offset:10240
v_mul_f32 v57, v57, v24
v_mfma_f32_16x16x32_bf16 v[64:67], a[88:91], v[224:227], v[64:67]
s_waitcnt lgkmcnt(6)
ds_read_b64_tr_b16 a[108:109], v117 offset:12288
v_mul_f32 v58, v58, v24
v_mfma_f32_16x16x32_bf16 v[64:67], a[92:95], v[240:243], v[64:67]
ds_read_b64_tr_b16 a[110:111], v117 offset:14336
v_mul_f32 v59, v59, v24
v_mfma_f32_16x16x32_bf16 v[68:71], a[64:67], v[132:135], 0
ds_read_b64_tr_b16 a[112:113], v117 offset:16384
v_cvt_pk_bf16_f32 v48, v48, v49
v_mfma_f32_16x16x32_bf16 v[68:71], a[68:71], v[148:151], v[68:71]
ds_read_b64_tr_b16 a[114:115], v117 offset:18432
v_cvt_pk_bf16_f32 v49, v50, v51
v_mfma_f32_16x16x32_bf16 v[68:71], a[72:75], v[164:167], v[68:71]
ds_read_b64_tr_b16 a[116:117], v117 offset:20480
v_cvt_pk_bf16_f32 v50, v56, v57
v_mfma_f32_16x16x32_bf16 v[68:71], a[76:79], v[180:183], v[68:71]
ds_read_b64_tr_b16 a[118:119], v117 offset:22528
v_cvt_pk_bf16_f32 v51, v58, v59
v_mfma_f32_16x16x32_bf16 v[68:71], a[80:83], v[196:199], v[68:71]
buffer_store_dwordx4 v[48:51], v1, s[4:7], s8 offen offset:1024 sc1
ds_read_b64_tr_b16 a[120:121], v117 offset:24576
v_mfma_f32_16x16x32_bf16 v[68:71], a[84:87], v[212:215], v[68:71]
ds_read_b64_tr_b16 a[122:123], v117 offset:26624
v_mul_f32 v52, v52, v25
v_mfma_f32_16x16x32_bf16 v[68:71], a[88:91], v[228:231], v[68:71]
ds_read_b64_tr_b16 a[124:125], v117 offset:28672
v_mul_f32 v53, v53, v25
v_mfma_f32_16x16x32_bf16 v[68:71], a[92:95], v[244:247], v[68:71]
s_waitcnt lgkmcnt(8)
ds_read_b64_tr_b16 a[126:127], v117 offset:30720
v_add_u32 v117, 65536, v117
v_mfma_f32_16x16x32_bf16 v[72:75], a[96:99], v[128:131], 0
ds_read_b64_tr_b16 a[64:65], v118 offset:0
v_mul_f32 v54, v54, v25
v_mfma_f32_16x16x32_bf16 v[72:75], a[100:103], v[144:147], v[72:75]
ds_read_b64_tr_b16 a[66:67], v118 offset:2048
v_mul_f32 v55, v55, v25
v_mfma_f32_16x16x32_bf16 v[72:75], a[104:107], v[160:163], v[72:75]
s_waitcnt lgkmcnt(8)
ds_read_b64_tr_b16 a[68:69], v118 offset:4096
v_mul_f32 v60, v60, v25
v_mfma_f32_16x16x32_bf16 v[72:75], a[108:111], v[176:179], v[72:75]
ds_read_b64_tr_b16 a[70:71], v118 offset:6144
v_mul_f32 v61, v61, v25
v_mfma_f32_16x16x32_bf16 v[72:75], a[112:115], v[192:195], v[72:75]
s_waitcnt lgkmcnt(8)
ds_read_b64_tr_b16 a[72:73], v118 offset:8192
v_mul_f32 v62, v62, v25
v_mfma_f32_16x16x32_bf16 v[72:75], a[116:119], v[208:211], v[72:75]
s_waitcnt lgkmcnt(7)
ds_read_b64_tr_b16 a[74:75], v118 offset:10240
v_mul_f32 v63, v63, v25
v_mfma_f32_16x16x32_bf16 v[72:75], a[120:123], v[224:227], v[72:75]
s_waitcnt lgkmcnt(6)
ds_read_b64_tr_b16 a[76:77], v118 offset:12288
v_cvt_pk_bf16_f32 v52, v52, v53
v_mfma_f32_16x16x32_bf16 v[72:75], a[124:127], v[240:243], v[72:75]
ds_read_b64_tr_b16 a[78:79], v118 offset:14336
v_cvt_pk_bf16_f32 v53, v54, v55
v_mfma_f32_16x16x32_bf16 v[76:79], a[96:99], v[132:135], 0
ds_read_b64_tr_b16 a[80:81], v118 offset:16384
v_cvt_pk_bf16_f32 v54, v60, v61
v_mfma_f32_16x16x32_bf16 v[76:79], a[100:103], v[148:151], v[76:79]
ds_read_b64_tr_b16 a[82:83], v118 offset:18432
v_cvt_pk_bf16_f32 v55, v62, v63
v_mfma_f32_16x16x32_bf16 v[76:79], a[104:107], v[164:167], v[76:79]
buffer_store_dwordx4 v[52:55], v1, s[4:7], s12 offen offset:1024 sc1
ds_read_b64_tr_b16 a[84:85], v118 offset:20480
v_mfma_f32_16x16x32_bf16 v[76:79], a[108:111], v[180:183], v[76:79]
ds_read_b64_tr_b16 a[86:87], v118 offset:22528
v_mul_u32_u24 v21, 1792, v19
v_mfma_f32_16x16x32_bf16 v[76:79], a[112:115], v[196:199], v[76:79]
ds_read_b64_tr_b16 a[88:89], v118 offset:24576
v_mul_f32 v64, v64, v24
v_mfma_f32_16x16x32_bf16 v[76:79], a[116:119], v[212:215], v[76:79]
ds_read_b64_tr_b16 a[90:91], v118 offset:26624
v_mul_f32 v65, v65, v24
v_mfma_f32_16x16x32_bf16 v[76:79], a[120:123], v[228:231], v[76:79]
ds_read_b64_tr_b16 a[92:93], v118 offset:28672
v_mul_f32 v66, v66, v24
v_mfma_f32_16x16x32_bf16 v[76:79], a[124:127], v[244:247], v[76:79]
s_waitcnt lgkmcnt(8)
ds_read_b64_tr_b16 a[94:95], v118 offset:30720
v_add_u32 v118, 65536, v118
v_mfma_f32_16x16x32_bf16 v[80:83], a[64:67], v[128:131], 0
ds_read_b64_tr_b16 a[96:97], v119 offset:0
v_mul_f32 v67, v67, v24
v_mfma_f32_16x16x32_bf16 v[80:83], a[68:71], v[144:147], v[80:83]
ds_read_b64_tr_b16 a[98:99], v119 offset:2048
v_mul_f32 v72, v72, v24
v_mfma_f32_16x16x32_bf16 v[80:83], a[72:75], v[160:163], v[80:83]
s_waitcnt lgkmcnt(8)
ds_read_b64_tr_b16 a[100:101], v119 offset:4096
v_mul_f32 v73, v73, v24
v_mfma_f32_16x16x32_bf16 v[80:83], a[76:79], v[176:179], v[80:83]
ds_read_b64_tr_b16 a[102:103], v119 offset:6144
v_mul_f32 v74, v74, v24
v_mfma_f32_16x16x32_bf16 v[80:83], a[80:83], v[192:195], v[80:83]
PAD_16:
s_cbranch_execz M_tret
s_waitcnt lgkmcnt(8)
ds_read_b64_tr_b16 a[104:105], v119 offset:8192
v_mul_f32 v75, v75, v24
v_mfma_f32_16x16x32_bf16 v[80:83], a[84:87], v[208:211], v[80:83]
s_waitcnt lgkmcnt(7)
ds_read_b64_tr_b16 a[106:107], v119 offset:10240
v_cvt_pk_bf16_f32 v64, v64, v65
v_mfma_f32_16x16x32_bf16 v[80:83], a[88:91], v[224:227], v[80:83]
s_waitcnt lgkmcnt(6)
ds_read_b64_tr_b16 a[108:109], v119 offset:12288
v_cvt_pk_bf16_f32 v65, v66, v67
v_mfma_f32_16x16x32_bf16 v[80:83], a[92:95], v[240:243], v[80:83]
ds_read_b64_tr_b16 a[110:111], v119 offset:14336
v_cvt_pk_bf16_f32 v66, v72, v73
v_mfma_f32_16x16x32_bf16 v[84:87], a[64:67], v[132:135], 0
ds_read_b64_tr_b16 a[112:113], v119 offset:16384
v_cvt_pk_bf16_f32 v67, v74, v75
v_mfma_f32_16x16x32_bf16 v[84:87], a[68:71], v[148:151], v[84:87]
buffer_store_dwordx4 v[64:67], v1, s[4:7], s8 offen offset:2048 sc1
ds_read_b64_tr_b16 a[114:115], v119 offset:18432
v_mfma_f32_16x16x32_bf16 v[84:87], a[72:75], v[164:167], v[84:87]
ds_read_b64_tr_b16 a[116:117], v119 offset:20480
v_mul_f32 v68, v68, v25
v_mfma_f32_16x16x32_bf16 v[84:87], a[76:79], v[180:183], v[84:87]
ds_read_b64_tr_b16 a[118:119], v119 offset:22528
v_mul_f32 v69, v69, v25
v_mfma_f32_16x16x32_bf16 v[84:87], a[80:83], v[196:199], v[84:87]
ds_read_b64_tr_b16 a[120:121], v119 offset:24576
v_mul_f32 v70, v70, v25
v_mfma_f32_16x16x32_bf16 v[84:87], a[84:87], v[212:215], v[84:87]
ds_read_b64_tr_b16 a[122:123], v119 offset:26624
v_mul_f32 v71, v71, v25
v_mfma_f32_16x16x32_bf16 v[84:87], a[88:91], v[228:231], v[84:87]
ds_read_b64_tr_b16 a[124:125], v119 offset:28672
ds_read_b64_tr_b16 a[126:127], v119 offset:30720
v_mfma_f32_16x16x32_bf16 v[84:87], a[92:95], v[244:247], v[84:87]
s_waitcnt vmcnt(7) lgkmcnt(9)
s_barrier
v_add_u32 v119, 65536, v119
v_mfma_f32_16x16x32_bf16 v[88:91], a[96:99], v[128:131], 0
ds_read_b64_tr_b16 a[64:65], v116 offset:0
v_mul_f32 v76, v76, v25
v_mfma_f32_16x16x32_bf16 v[88:91], a[100:103], v[144:147], v[88:91]
buffer_store_dword v6, v5, s[4:7], s34 offen sc1
ds_read_b64_tr_b16 a[66:67], v116 offset:2048
v_mfma_f32_16x16x32_bf16 v[88:91], a[104:107], v[160:163], v[88:91]
s_waitcnt lgkmcnt(8)
ds_read_b64_tr_b16 a[68:69], v116 offset:4096
v_mul_f32 v77, v77, v25
v_mfma_f32_16x16x32_bf16 v[88:91], a[108:111], v[176:179], v[88:91]
ds_read_b64_tr_b16 a[70:71], v116 offset:6144
v_mul_f32 v78, v78, v25
v_mfma_f32_16x16x32_bf16 v[88:91], a[112:115], v[192:195], v[88:91]
s_waitcnt lgkmcnt(8)
ds_read_b64_tr_b16 a[72:73], v116 offset:8192
v_mul_f32 v79, v79, v25
v_mfma_f32_16x16x32_bf16 v[88:91], a[116:119], v[208:211], v[88:91]
s_waitcnt lgkmcnt(7)
ds_read_b64_tr_b16 a[74:75], v116 offset:10240
v_cvt_pk_bf16_f32 v68, v68, v69
v_mfma_f32_16x16x32_bf16 v[88:91], a[120:123], v[224:227], v[88:91]
s_waitcnt lgkmcnt(6)
ds_read_b64_tr_b16 a[76:77], v116 offset:12288
v_cvt_pk_bf16_f32 v69, v70, v71
v_mfma_f32_16x16x32_bf16 v[88:91], a[124:127], v[240:243], v[88:91]
ds_read_b64_tr_b16 a[78:79], v116 offset:14336
v_cvt_pk_bf16_f32 v70, v76, v77
v_mfma_f32_16x16x32_bf16 v[92:95], a[96:99], v[132:135], 0
ds_read_b64_tr_b16 a[80:81], v116 offset:16384
v_cvt_pk_bf16_f32 v71, v78, v79
v_mfma_f32_16x16x32_bf16 v[92:95], a[100:103], v[148:151], v[92:95]
buffer_store_dwordx4 v[68:71], v1, s[4:7], s12 offen offset:2048 sc1
ds_read_b64_tr_b16 a[82:83], v116 offset:18432
v_mfma_f32_16x16x32_bf16 v[92:95], a[104:107], v[164:167], v[92:95]
ds_read_b64_tr_b16 a[84:85], v116 offset:20480
v_lshlrev_b32 v19, 2, v19
v_mfma_f32_16x16x32_bf16 v[92:95], a[108:111], v[180:183], v[92:95]
ds_read_b64_tr_b16 a[86:87], v116 offset:22528
v_mfma_f32_16x16x32_bf16 v[92:95], a[112:115], v[196:199], v[92:95]
ds_read_b64_tr_b16 a[88:89], v116 offset:24576
v_mfma_f32_16x16x32_bf16 v[92:95], a[116:119], v[212:215], v[92:95]
ds_read_b64_tr_b16 a[90:91], v116 offset:26624
v_mfma_f32_16x16x32_bf16 v[92:95], a[120:123], v[228:231], v[92:95]
ds_read_b64_tr_b16 a[92:93], v116 offset:28672
v_mfma_f32_16x16x32_bf16 v[92:95], a[124:127], v[244:247], v[92:95]
s_waitcnt lgkmcnt(8)
ds_read_b64_tr_b16 a[94:95], v116 offset:30720
v_mfma_f32_16x16x32_bf16 v[32:35], a[64:67], v[128:131], 0
ds_read_b64_tr_b16 a[96:97], v117 offset:0
v_mul_f32 v80, v80, v24
v_mfma_f32_16x16x32_bf16 v[32:35], a[68:71], v[144:147], v[32:35]
ds_read_b64_tr_b16 a[98:99], v117 offset:2048
v_mul_f32 v81, v81, v24
v_mfma_f32_16x16x32_bf16 v[32:35], a[72:75], v[160:163], v[32:35]
s_waitcnt lgkmcnt(8)
ds_read_b64_tr_b16 a[100:101], v117 offset:4096
v_mul_f32 v82, v82, v24
v_mfma_f32_16x16x32_bf16 v[32:35], a[76:79], v[176:179], v[32:35]
ds_read_b64_tr_b16 a[102:103], v117 offset:6144
v_mul_f32 v83, v83, v24
v_mfma_f32_16x16x32_bf16 v[32:35], a[80:83], v[192:195], v[32:35]
s_waitcnt lgkmcnt(8)
ds_read_b64_tr_b16 a[104:105], v117 offset:8192
v_mul_f32 v88, v88, v24
v_mfma_f32_16x16x32_bf16 v[32:35], a[84:87], v[208:211], v[32:35]
s_waitcnt lgkmcnt(7)
ds_read_b64_tr_b16 a[106:107], v117 offset:10240
v_mul_f32 v89, v89, v24
v_mfma_f32_16x16x32_bf16 v[32:35], a[88:91], v[224:227], v[32:35]
s_waitcnt lgkmcnt(6)
ds_read_b64_tr_b16 a[108:109], v117 offset:12288
v_mul_f32 v90, v90, v24
v_mfma_f32_16x16x32_bf16 v[32:35], a[92:95], v[240:243], v[32:35]
ds_read_b64_tr_b16 a[110:111], v117 offset:14336
v_mul_f32 v91, v91, v24
v_mfma_f32_16x16x32_bf16 v[36:39], a[64:67], v[132:135], 0
ds_read_b64_tr_b16 a[112:113], v117 offset:16384
v_cvt_pk_bf16_f32 v80, v80, v81
v_mfma_f32_16x16x32_bf16 v[36:39], a[68:71], v[148:151], v[36:39]
ds_read_b64_tr_b16 a[114:115], v117 offset:18432
v_cvt_pk_bf16_f32 v81, v82, v83
v_mfma_f32_16x16x32_bf16 v[36:39], a[72:75], v[164:167], v[36:39]
ds_read_b64_tr_b16 a[116:117], v117 offset:20480
v_cvt_pk_bf16_f32 v82, v88, v89
v_mfma_f32_16x16x32_bf16 v[36:39], a[76:79], v[180:183], v[36:39]
ds_read_b64_tr_b16 a[118:119], v117 offset:22528
v_cvt_pk_bf16_f32 v83, v90, v91
v_mfma_f32_16x16x32_bf16 v[36:39], a[80:83], v[196:199], v[36:39]
buffer_store_dwordx4 v[80:83], v1, s[4:7], s8 offen offset:3072 sc1
ds_read_b64_tr_b16 a[120:121], v117 offset:24576
v_mfma_f32_16x16x32_bf16 v[36:39], a[84:87], v[212:215], v[36:39]
ds_read_b64_tr_b16 a[122:123], v117 offset:26624
v_mul_f32 v84, v84, v25
v_mfma_f32_16x16x32_bf16 v[36:39], a[88:91], v[228:231], v[36:39]
ds_read_b64_tr_b16 a[124:125], v117 offset:28672
v_mul_f32 v85, v85, v25
v_mfma_f32_16x16x32_bf16 v[36:39], a[92:95], v[244:247], v[36:39]
s_waitcnt lgkmcnt(8)
ds_read_b64_tr_b16 a[126:127], v117 offset:30720
v_mul_f32 v86, v86, v25
v_mfma_f32_16x16x32_bf16 v[40:43], a[96:99], v[128:131], 0
ds_read_b64_tr_b16 a[64:65], v118 offset:0
v_mul_f32 v87, v87, v25
v_mfma_f32_16x16x32_bf16 v[40:43], a[100:103], v[144:147], v[40:43]
ds_read_b64_tr_b16 a[66:67], v118 offset:2048
v_mul_f32 v92, v92, v25
v_mfma_f32_16x16x32_bf16 v[40:43], a[104:107], v[160:163], v[40:43]
s_waitcnt lgkmcnt(8)
ds_read_b64_tr_b16 a[68:69], v118 offset:4096
v_mul_f32 v93, v93, v25
v_mfma_f32_16x16x32_bf16 v[40:43], a[108:111], v[176:179], v[40:43]
ds_read_b64_tr_b16 a[70:71], v118 offset:6144
v_mul_f32 v94, v94, v25
v_mfma_f32_16x16x32_bf16 v[40:43], a[112:115], v[192:195], v[40:43]
s_waitcnt lgkmcnt(8)
ds_read_b64_tr_b16 a[72:73], v118 offset:8192
v_mul_f32 v95, v95, v25
v_mfma_f32_16x16x32_bf16 v[40:43], a[116:119], v[208:211], v[40:43]
s_waitcnt lgkmcnt(7)
ds_read_b64_tr_b16 a[74:75], v118 offset:10240
v_cvt_pk_bf16_f32 v84, v84, v85
v_mfma_f32_16x16x32_bf16 v[40:43], a[120:123], v[224:227], v[40:43]
s_waitcnt lgkmcnt(6)
ds_read_b64_tr_b16 a[76:77], v118 offset:12288
v_cvt_pk_bf16_f32 v85, v86, v87
v_mfma_f32_16x16x32_bf16 v[40:43], a[124:127], v[240:243], v[40:43]
ds_read_b64_tr_b16 a[78:79], v118 offset:14336
v_cvt_pk_bf16_f32 v86, v92, v93
v_mfma_f32_16x16x32_bf16 v[44:47], a[96:99], v[132:135], 0
ds_read_b64_tr_b16 a[80:81], v118 offset:16384
v_cvt_pk_bf16_f32 v87, v94, v95
v_mfma_f32_16x16x32_bf16 v[44:47], a[100:103], v[148:151], v[44:47]
buffer_store_dwordx4 v[84:87], v1, s[4:7], s12 offen offset:3072 sc1
ds_read_b64_tr_b16 a[82:83], v118 offset:18432
v_mfma_f32_16x16x32_bf16 v[44:47], a[104:107], v[164:167], v[44:47]
s_add_u32 s8, s8, 4096
s_add_u32 s12, s12, 4096
ds_read_b64_tr_b16 a[84:85], v118 offset:20480
v_mfma_f32_16x16x32_bf16 v[44:47], a[108:111], v[180:183], v[44:47]
ds_read_b64_tr_b16 a[86:87], v118 offset:22528
v_lshrrev_b32 v22, 4, v20
v_mfma_f32_16x16x32_bf16 v[44:47], a[112:115], v[196:199], v[44:47]
ds_read_b64_tr_b16 a[88:89], v118 offset:24576
v_mul_f32 v32, v32, v24
v_mfma_f32_16x16x32_bf16 v[44:47], a[116:119], v[212:215], v[44:47]
ds_read_b64_tr_b16 a[90:91], v118 offset:26624
v_mul_f32 v33, v33, v24
v_mfma_f32_16x16x32_bf16 v[44:47], a[120:123], v[228:231], v[44:47]
ds_read_b64_tr_b16 a[92:93], v118 offset:28672
v_mul_f32 v34, v34, v24
v_mfma_f32_16x16x32_bf16 v[44:47], a[124:127], v[244:247], v[44:47]
s_waitcnt lgkmcnt(8)
ds_read_b64_tr_b16 a[94:95], v118 offset:30720
v_mul_f32 v35, v35, v24
v_mfma_f32_16x16x32_bf16 v[48:51], a[64:67], v[128:131], 0
ds_read_b64_tr_b16 a[96:97], v119 offset:0
v_mul_f32 v40, v40, v24
v_mfma_f32_16x16x32_bf16 v[48:51], a[68:71], v[144:147], v[48:51]
ds_read_b64_tr_b16 a[98:99], v119 offset:2048
v_mul_f32 v41, v41, v24
v_mfma_f32_16x16x32_bf16 v[48:51], a[72:75], v[160:163], v[48:51]
s_waitcnt lgkmcnt(8)
ds_read_b64_tr_b16 a[100:101], v119 offset:4096
v_mul_f32 v42, v42, v24
v_mfma_f32_16x16x32_bf16 v[48:51], a[76:79], v[176:179], v[48:51]
ds_read_b64_tr_b16 a[102:103], v119 offset:6144
v_mul_f32 v43, v43, v24
v_mfma_f32_16x16x32_bf16 v[48:51], a[80:83], v[192:195], v[48:51]
s_waitcnt lgkmcnt(8)
ds_read_b64_tr_b16 a[104:105], v119 offset:8192
v_cvt_pk_bf16_f32 v32, v32, v33
v_mfma_f32_16x16x32_bf16 v[48:51], a[84:87], v[208:211], v[48:51]
s_waitcnt lgkmcnt(7)
ds_read_b64_tr_b16 a[106:107], v119 offset:10240
v_cvt_pk_bf16_f32 v33, v34, v35
v_mfma_f32_16x16x32_bf16 v[48:51], a[88:91], v[224:227], v[48:51]
s_waitcnt lgkmcnt(6)
ds_read_b64_tr_b16 a[108:109], v119 offset:12288
v_cvt_pk_bf16_f32 v34, v40, v41
v_mfma_f32_16x16x32_bf16 v[48:51], a[92:95], v[240:243], v[48:51]
ds_read_b64_tr_b16 a[110:111], v119 offset:14336
v_cvt_pk_bf16_f32 v35, v42, v43
v_mfma_f32_16x16x32_bf16 v[52:55], a[64:67], v[132:135], 0
buffer_store_dwordx4 v[32:35], v1, s[4:7], s8 offen offset:0 sc1
ds_read_b64_tr_b16 a[112:113], v119 offset:16384
v_mfma_f32_16x16x32_bf16 v[52:55], a[68:71], v[148:151], v[52:55]
ds_read_b64_tr_b16 a[114:115], v119 offset:18432
v_mul_f32 v36, v36, v25
v_mfma_f32_16x16x32_bf16 v[52:55], a[72:75], v[164:167], v[52:55]
ds_read_b64_tr_b16 a[116:117], v119 offset:20480
v_mul_f32 v37, v37, v25
v_mfma_f32_16x16x32_bf16 v[52:55], a[76:79], v[180:183], v[52:55]
ds_read_b64_tr_b16 a[118:119], v119 offset:22528
v_mul_f32 v38, v38, v25
v_mfma_f32_16x16x32_bf16 v[52:55], a[80:83], v[196:199], v[52:55]
ds_read_b64_tr_b16 a[120:121], v119 offset:24576
v_mul_f32 v39, v39, v25
v_mfma_f32_16x16x32_bf16 v[52:55], a[84:87], v[212:215], v[52:55]
ds_read_b64_tr_b16 a[122:123], v119 offset:26624
v_mul_f32 v44, v44, v25
v_mfma_f32_16x16x32_bf16 v[52:55], a[88:91], v[228:231], v[52:55]
ds_read_b64_tr_b16 a[124:125], v119 offset:28672
ds_read_b64_tr_b16 a[126:127], v119 offset:30720
v_mfma_f32_16x16x32_bf16 v[52:55], a[92:95], v[244:247], v[52:55]
s_waitcnt lgkmcnt(9)
v_mul_f32 v45, v45, v25
v_mul_f32 v46, v46, v25
v_mfma_f32_16x16x32_bf16 v[56:59], a[96:99], v[128:131], 0
v_mul_f32 v47, v47, v25
v_cvt_pk_bf16_f32 v36, v36, v37
v_mfma_f32_16x16x32_bf16 v[56:59], a[100:103], v[144:147], v[56:59]
v_cvt_pk_bf16_f32 v37, v38, v39
v_cvt_pk_bf16_f32 v38, v44, v45
v_mfma_f32_16x16x32_bf16 v[56:59], a[104:107], v[160:163], v[56:59]
s_waitcnt lgkmcnt(6)
v_cvt_pk_bf16_f32 v39, v46, v47
v_lshl_add_u32 v21, v22, 3, v21
v_mfma_f32_16x16x32_bf16 v[56:59], a[108:111], v[176:179], v[56:59]
buffer_store_dwordx4 v[36:39], v1, s[4:7], s12 offen offset:0 sc1
v_mfma_f32_16x16x32_bf16 v[56:59], a[112:115], v[192:195], v[56:59]
s_waitcnt lgkmcnt(4)
v_mfma_f32_16x16x32_bf16 v[56:59], a[116:119], v[208:211], v[56:59]
s_waitcnt lgkmcnt(2)
v_mfma_f32_16x16x32_bf16 v[56:59], a[120:123], v[224:227], v[56:59]
s_waitcnt lgkmcnt(0)
v_mfma_f32_16x16x32_bf16 v[56:59], a[124:127], v[240:243], v[56:59]
v_mfma_f32_16x16x32_bf16 v[60:63], a[96:99], v[132:135], 0
v_mfma_f32_16x16x32_bf16 v[60:63], a[100:103], v[148:151], v[60:63]
v_mfma_f32_16x16x32_bf16 v[60:63], a[104:107], v[164:167], v[60:63]
v_mfma_f32_16x16x32_bf16 v[60:63], a[108:111], v[180:183], v[60:63]
v_mfma_f32_16x16x32_bf16 v[60:63], a[112:115], v[196:199], v[60:63]
buffer_load_dword v18, v19, s[4:7], s33 offen offset:0 sc1
v_mfma_f32_16x16x32_bf16 v[60:63], a[116:119], v[212:215], v[60:63]
v_mfma_f32_16x16x32_bf16 v[60:63], a[120:123], v[228:231], v[60:63]
v_mfma_f32_16x16x32_bf16 v[60:63], a[124:127], v[244:247], v[60:63]
v_mul_f32 v48, v48, v24
v_mul_f32 v49, v49, v24
v_mul_f32 v50, v50, v24
v_mul_f32 v51, v51, v24
v_mul_f32 v56, v56, v24
v_mul_f32 v57, v57, v24
v_mul_f32 v58, v58, v24
v_mul_f32 v59, v59, v24
v_cvt_pk_bf16_f32 v48, v48, v49
v_cvt_pk_bf16_f32 v49, v50, v51
v_cvt_pk_bf16_f32 v50, v56, v57
v_cvt_pk_bf16_f32 v51, v58, v59
buffer_store_dwordx4 v[48:51], v1, s[4:7], s8 offen offset:1024 sc1
v_mul_f32 v52, v52, v25
v_mul_f32 v53, v53, v25
v_mul_f32 v54, v54, v25
v_mul_f32 v55, v55, v25
v_mul_f32 v60, v60, v25
v_mul_f32 v61, v61, v25
v_mul_f32 v62, v62, v25
v_mul_f32 v63, v63, v25
v_cvt_pk_bf16_f32 v52, v52, v53
v_cvt_pk_bf16_f32 v53, v54, v55
v_cvt_pk_bf16_f32 v54, v60, v61
v_cvt_pk_bf16_f32 v55, v62, v63
buffer_store_dwordx4 v[52:55], v1, s[4:7], s12 offen offset:1024 sc1
s_and_b32 s22, s2, 224
s_cmp_eq_u32 s22, 224
s_cbranch_scc1 M_final
s_waitcnt vmcnt(0)
s_barrier
buffer_store_dword v6, v5, s[4:7], s35 offen sc1
s_bitcmp0_b32 s2, 4
s_cbranch_scc1 M_rA
v_cmp_gt_u32 vcc, 1, v18
s_cbranch_vccnz M_rslow
M_rjoin:
buffer_load_dwordx4 v[128:131], v1, s[4:7], s26 offen sc1
s_add_u32 s26, s26, 14336
buffer_load_dwordx4 v[132:135], v1, s[4:7], s26 offen sc1
s_add_u32 s26, s26, 14336
buffer_load_dwordx4 v[136:139], v1, s[4:7], s26 offen sc1
s_add_u32 s26, s26, 14336
buffer_load_dwordx4 v[140:143], v1, s[4:7], s26 offen sc1
s_add_u32 s26, s26, 14336
buffer_load_dwordx4 v[144:147], v1, s[4:7], s26 offen sc1
s_add_u32 s26, s26, 14336
buffer_load_dwordx4 v[148:151], v1, s[4:7], s26 offen sc1
s_add_u32 s26, s26, 14336
buffer_load_dwordx4 v[152:155], v1, s[4:7], s26 offen sc1
s_add_u32 s26, s26, 14336
buffer_load_dwordx4 v[156:159], v1, s[4:7], s26 offen sc1
s_add_u32 s26, s26, 14336
buffer_load_dwordx4 v[160:163], v1, s[4:7], s26 offen sc1
s_add_u32 s26, s26, 14336
buffer_load_dwordx4 v[164:167], v1, s[4:7], s26 offen sc1
s_add_u32 s26, s26, 14336
buffer_load_dwordx4 v[168:171], v1, s[4:7], s26 offen sc1
s_add_u32 s26, s26, 14336
buffer_load_dwordx4 v[172:175], v1, s[4:7], s26 offen sc1
s_add_u32 s26, s26, 14336
buffer_load_dwordx4 v[176:179], v1, s[4:7], s26 offen sc1
s_add_u32 s26, s26, 14336
buffer_load_dwordx4 v[180:183], v1, s[4:7], s26 offen sc1
s_add_u32 s26, s26, 14336
buffer_load_dwordx4 v[184:187], v1, s[4:7], s26 offen sc1
s_add_u32 s26, s26, 14336
buffer_load_dwordx4 v[188:191], v1, s[4:7], s26 offen sc1
Lp_9201:
buffer_load_dword v18, v19, s[4:7], s33 offen offset:2048 sc1
s_waitcnt vmcnt(0)
v_cmp_gt_u32 vcc, 1, v18
s_cbranch_vccz Lpd_9202
s_sleep 8
s_sub_u32 s101, s101, 1
s_cbranch_scc0 Lp_9201
s_mov_b32 s101, 0
Lpd_9202:
s_sub_u32 s26, s26, 207872
buffer_load_dwordx4 v[192:195], v1, s[4:7], s26 offen sc1
s_add_u32 s26, s26, 14336
buffer_load_dwordx4 v[196:199], v1, s[4:7], s26 offen sc1
s_add_u32 s26, s26, 14336
buffer_load_dwordx4 v[200:203], v1, s[4:7], s26 offen sc1
s_add_u32 s26, s26, 14336
buffer_load_dwordx4 v[204:207], v1, s[4:7], s26 offen sc1
s_add_u32 s26, s26, 14336
buffer_load_dwordx4 v[208:211], v1, s[4:7], s26 offen sc1
s_add_u32 s26, s26, 14336
buffer_load_dwordx4 v[212:215], v1, s[4:7], s26 offen sc1
s_add_u32 s26, s26, 14336
buffer_load_dwordx4 v[216:219], v1, s[4:7], s26 offen sc1
s_add_u32 s26, s26, 14336
buffer_load_dwordx4 v[220:223], v1, s[4:7], s26 offen sc1
s_add_u32 s26, s26, 14336
buffer_load_dwordx4 v[224:227], v1, s[4:7], s26 offen sc1
s_add_u32 s26, s26, 14336
buffer_load_dwordx4 v[228:231], v1, s[4:7], s26 offen sc1
s_add_u32 s26, s26, 14336
buffer_load_dwordx4 v[232:235], v1, s[4:7], s26 offen sc1
s_add_u32 s26, s26, 14336
buffer_load_dwordx4 v[236:239], v1, s[4:7], s26 offen sc1
s_add_u32 s26, s26, 14336
buffer_load_dwordx4 v[240:243], v1, s[4:7], s26 offen sc1
s_add_u32 s26, s26, 14336
buffer_load_dwordx4 v[244:247], v1, s[4:7], s26 offen sc1
s_add_u32 s26, s26, 14336
buffer_load_dwordx4 v[248:251], v1, s[4:7], s26 offen sc1
s_add_u32 s26, s26, 14336
buffer_load_dwordx4 v[252:255], v1, s[4:7], s26 offen sc1
v_lshlrev_b32 v96, 16, v128
v_and_b32 v97, 0xffff0000, v128
v_lshlrev_b32 v98, 16, v129
v_and_b32 v99, 0xffff0000, v129
v_lshlrev_b32 v100, 16, v130
v_and_b32 v101, 0xffff0000, v130
v_lshlrev_b32 v102, 16, v131
v_and_b32 v103, 0xffff0000, v131
v_lshlrev_b32 v10, 16, v132
v_and_b32 v11, 0xffff0000, v132
v_lshlrev_b32 v12, 16, v133
v_and_b32 v13, 0xffff0000, v133
v_lshlrev_b32 v14, 16, v134
v_and_b32 v15, 0xffff0000, v134
v_lshlrev_b32 v16, 16, v135
v_and_b32 v17, 0xffff0000, v135
v_pk_add_f32 v[96:97], v[96:97], v[10:11]
v_pk_add_f32 v[98:99], v[98:99], v[12:13]
v_pk_add_f32 v[100:101], v[100:101], v[14:15]
v_pk_add_f32 v[102:103], v[102:103], v[16:17]
v_lshlrev_b32 v10, 16, v136
v_and_b32 v11, 0xffff0000, v136
v_lshlrev_b32 v12, 16, v137
v_and_b32 v13, 0xffff0000, v137
v_lshlrev_b32 v14, 16, v138
v_and_b32 v15, 0xffff0000, v138
v_lshlrev_b32 v16, 16, v139
v_and_b32 v17, 0xffff0000, v139
v_pk_add_f32 v[96:97], v[96:97], v[10:11]
v_pk_add_f32 v[98:99], v[98:99], v[12:13]
v_pk_add_f32 v[100:101], v[100:101], v[14:15]
v_pk_add_f32 v[102:103], v[102:103], v[16:17]
v_lshlrev_b32 v10, 16, v140
v_and_b32 v11, 0xffff0000, v140
v_lshlrev_b32 v12, 16, v141
v_and_b32 v13, 0xffff0000, v141
v_lshlrev_b32 v14, 16, v142
v_and_b32 v15, 0xffff0000, v142
v_lshlrev_b32 v16, 16, v143
v_and_b32 v17, 0xffff0000, v143
v_pk_add_f32 v[96:97], v[96:97], v[10:11]
v_pk_add_f32 v[98:99], v[98:99], v[12:13]
v_pk_add_f32 v[100:101], v[100:101], v[14:15]
v_pk_add_f32 v[102:103], v[102:103], v[16:17]
v_lshlrev_b32 v10, 16, v144
v_and_b32 v11, 0xffff0000, v144
v_lshlrev_b32 v12, 16, v145
v_and_b32 v13, 0xffff0000, v145
v_lshlrev_b32 v14, 16, v146
v_and_b32 v15, 0xffff0000, v146
v_lshlrev_b32 v16, 16, v147
v_and_b32 v17, 0xffff0000, v147
v_pk_add_f32 v[96:97], v[96:97], v[10:11]
v_pk_add_f32 v[98:99], v[98:99], v[12:13]
v_pk_add_f32 v[100:101], v[100:101], v[14:15]
v_pk_add_f32 v[102:103], v[102:103], v[16:17]
v_lshlrev_b32 v10, 16, v148
v_and_b32 v11, 0xffff0000, v148
v_lshlrev_b32 v12, 16, v149
v_and_b32 v13, 0xffff0000, v149
v_lshlrev_b32 v14, 16, v150
v_and_b32 v15, 0xffff0000, v150
v_lshlrev_b32 v16, 16, v151
v_and_b32 v17, 0xffff0000, v151
v_pk_add_f32 v[96:97], v[96:97], v[10:11]
v_pk_add_f32 v[98:99], v[98:99], v[12:13]
v_pk_add_f32 v[100:101], v[100:101], v[14:15]
v_pk_add_f32 v[102:103], v[102:103], v[16:17]
v_lshlrev_b32 v10, 16, v152
v_and_b32 v11, 0xffff0000, v152
v_lshlrev_b32 v12, 16, v153
v_and_b32 v13, 0xffff0000, v153
v_lshlrev_b32 v14, 16, v154
v_and_b32 v15, 0xffff0000, v154
v_lshlrev_b32 v16, 16, v155
v_and_b32 v17, 0xffff0000, v155
v_pk_add_f32 v[96:97], v[96:97], v[10:11]
v_pk_add_f32 v[98:99], v[98:99], v[12:13]
v_pk_add_f32 v[100:101], v[100:101], v[14:15]
v_pk_add_f32 v[102:103], v[102:103], v[16:17]
v_lshlrev_b32 v10, 16, v156
v_and_b32 v11, 0xffff0000, v156
v_lshlrev_b32 v12, 16, v157
v_and_b32 v13, 0xffff0000, v157
v_lshlrev_b32 v14, 16, v158
v_and_b32 v15, 0xffff0000, v158
v_lshlrev_b32 v16, 16, v159
v_and_b32 v17, 0xffff0000, v159
v_pk_add_f32 v[96:97], v[96:97], v[10:11]
v_pk_add_f32 v[98:99], v[98:99], v[12:13]
v_pk_add_f32 v[100:101], v[100:101], v[14:15]
v_pk_add_f32 v[102:103], v[102:103], v[16:17]
v_lshlrev_b32 v10, 16, v160
v_and_b32 v11, 0xffff0000, v160
v_lshlrev_b32 v12, 16, v161
v_and_b32 v13, 0xffff0000, v161
v_lshlrev_b32 v14, 16, v162
v_and_b32 v15, 0xffff0000, v162
v_lshlrev_b32 v16, 16, v163
v_and_b32 v17, 0xffff0000, v163
v_pk_add_f32 v[96:97], v[96:97], v[10:11]
v_pk_add_f32 v[98:99], v[98:99], v[12:13]
v_pk_add_f32 v[100:101], v[100:101], v[14:15]
v_pk_add_f32 v[102:103], v[102:103], v[16:17]
v_lshlrev_b32 v10, 16, v164
v_and_b32 v11, 0xffff0000, v164
v_lshlrev_b32 v12, 16, v165
v_and_b32 v13, 0xffff0000, v165
v_lshlrev_b32 v14, 16, v166
v_and_b32 v15, 0xffff0000, v166
v_lshlrev_b32 v16, 16, v167
v_and_b32 v17, 0xffff0000, v167
v_pk_add_f32 v[96:97], v[96:97], v[10:11]
v_pk_add_f32 v[98:99], v[98:99], v[12:13]
v_pk_add_f32 v[100:101], v[100:101], v[14:15]
v_pk_add_f32 v[102:103], v[102:103], v[16:17]
v_lshlrev_b32 v10, 16, v168
v_and_b32 v11, 0xffff0000, v168
v_lshlrev_b32 v12, 16, v169
v_and_b32 v13, 0xffff0000, v169
v_lshlrev_b32 v14, 16, v170
v_and_b32 v15, 0xffff0000, v170
v_lshlrev_b32 v16, 16, v171
v_and_b32 v17, 0xffff0000, v171
v_pk_add_f32 v[96:97], v[96:97], v[10:11]
v_pk_add_f32 v[98:99], v[98:99], v[12:13]
v_pk_add_f32 v[100:101], v[100:101], v[14:15]
v_pk_add_f32 v[102:103], v[102:103], v[16:17]
v_lshlrev_b32 v10, 16, v172
v_and_b32 v11, 0xffff0000, v172
v_lshlrev_b32 v12, 16, v173
v_and_b32 v13, 0xffff0000, v173
v_lshlrev_b32 v14, 16, v174
v_and_b32 v15, 0xffff0000, v174
v_lshlrev_b32 v16, 16, v175
v_and_b32 v17, 0xffff0000, v175
v_pk_add_f32 v[96:97], v[96:97], v[10:11]
v_pk_add_f32 v[98:99], v[98:99], v[12:13]
v_pk_add_f32 v[100:101], v[100:101], v[14:15]
v_pk_add_f32 v[102:103], v[102:103], v[16:17]
v_lshlrev_b32 v10, 16, v176
v_and_b32 v11, 0xffff0000, v176
v_lshlrev_b32 v12, 16, v177
v_and_b32 v13, 0xffff0000, v177
v_lshlrev_b32 v14, 16, v178
v_and_b32 v15, 0xffff0000, v178
v_lshlrev_b32 v16, 16, v179
v_and_b32 v17, 0xffff0000, v179
v_pk_add_f32 v[96:97], v[96:97], v[10:11]
v_pk_add_f32 v[98:99], v[98:99], v[12:13]
v_pk_add_f32 v[100:101], v[100:101], v[14:15]
v_pk_add_f32 v[102:103], v[102:103], v[16:17]
v_lshlrev_b32 v10, 16, v180
v_and_b32 v11, 0xffff0000, v180
v_lshlrev_b32 v12, 16, v181
v_and_b32 v13, 0xffff0000, v181
v_lshlrev_b32 v14, 16, v182
v_and_b32 v15, 0xffff0000, v182
v_lshlrev_b32 v16, 16, v183
v_and_b32 v17, 0xffff0000, v183
v_pk_add_f32 v[96:97], v[96:97], v[10:11]
v_pk_add_f32 v[98:99], v[98:99], v[12:13]
v_pk_add_f32 v[100:101], v[100:101], v[14:15]
v_pk_add_f32 v[102:103], v[102:103], v[16:17]
v_lshlrev_b32 v10, 16, v184
v_and_b32 v11, 0xffff0000, v184
v_lshlrev_b32 v12, 16, v185
v_and_b32 v13, 0xffff0000, v185
v_lshlrev_b32 v14, 16, v186
v_and_b32 v15, 0xffff0000, v186
v_lshlrev_b32 v16, 16, v187
v_and_b32 v17, 0xffff0000, v187
v_pk_add_f32 v[96:97], v[96:97], v[10:11]
v_pk_add_f32 v[98:99], v[98:99], v[12:13]
v_pk_add_f32 v[100:101], v[100:101], v[14:15]
v_pk_add_f32 v[102:103], v[102:103], v[16:17]
v_lshlrev_b32 v10, 16, v188
v_and_b32 v11, 0xffff0000, v188
v_lshlrev_b32 v12, 16, v189
v_and_b32 v13, 0xffff0000, v189
v_lshlrev_b32 v14, 16, v190
v_and_b32 v15, 0xffff0000, v190
v_lshlrev_b32 v16, 16, v191
v_and_b32 v17, 0xffff0000, v191
v_pk_add_f32 v[96:97], v[96:97], v[10:11]
v_pk_add_f32 v[98:99], v[98:99], v[12:13]
v_pk_add_f32 v[100:101], v[100:101], v[14:15]
v_pk_add_f32 v[102:103], v[102:103], v[16:17]
v_cvt_pk_bf16_f32 v96, v96, v97
v_cvt_pk_bf16_f32 v97, v98, v99
v_cvt_pk_bf16_f32 v98, v100, v101
v_cvt_pk_bf16_f32 v99, v102, v103
buffer_store_dwordx2 v[96:97], v21, s[40:43], s25 offen offset:896
buffer_store_dwordx2 v[98:99], v21, s[40:43], s25 offen offset:928
s_waitcnt vmcnt(17)
v_lshlrev_b32 v104, 16, v192
v_and_b32 v105, 0xffff0000, v192
v_lshlrev_b32 v106, 16, v193
v_and_b32 v107, 0xffff0000, v193
v_lshlrev_b32 v108, 16, v194
v_and_b32 v109, 0xffff0000, v194
v_lshlrev_b32 v110, 16, v195
v_and_b32 v111, 0xffff0000, v195
s_waitcnt vmcnt(16)
v_lshlrev_b32 v10, 16, v196
v_and_b32 v11, 0xffff0000, v196
v_lshlrev_b32 v12, 16, v197
v_and_b32 v13, 0xffff0000, v197
v_lshlrev_b32 v14, 16, v198
v_and_b32 v15, 0xffff0000, v198
v_lshlrev_b32 v16, 16, v199
v_and_b32 v17, 0xffff0000, v199
v_pk_add_f32 v[104:105], v[104:105], v[10:11]
v_pk_add_f32 v[106:107], v[106:107], v[12:13]
v_pk_add_f32 v[108:109], v[108:109], v[14:15]
v_pk_add_f32 v[110:111], v[110:111], v[16:17]
PAD_17:
s_cbranch_execz M_tret
s_waitcnt vmcnt(15)
v_lshlrev_b32 v10, 16, v200
v_and_b32 v11, 0xffff0000, v200
v_lshlrev_b32 v12, 16, v201
v_and_b32 v13, 0xffff0000, v201
v_lshlrev_b32 v14, 16, v202
v_and_b32 v15, 0xffff0000, v202
v_lshlrev_b32 v16, 16, v203
v_and_b32 v17, 0xffff0000, v203
v_pk_add_f32 v[104:105], v[104:105], v[10:11]
v_pk_add_f32 v[106:107], v[106:107], v[12:13]
v_pk_add_f32 v[108:109], v[108:109], v[14:15]
v_pk_add_f32 v[110:111], v[110:111], v[16:17]
s_waitcnt vmcnt(14)
v_lshlrev_b32 v10, 16, v204
v_and_b32 v11, 0xffff0000, v204
v_lshlrev_b32 v12, 16, v205
v_and_b32 v13, 0xffff0000, v205
v_lshlrev_b32 v14, 16, v206
v_and_b32 v15, 0xffff0000, v206
v_lshlrev_b32 v16, 16, v207
v_and_b32 v17, 0xffff0000, v207
v_pk_add_f32 v[104:105], v[104:105], v[10:11]
v_pk_add_f32 v[106:107], v[106:107], v[12:13]
v_pk_add_f32 v[108:109], v[108:109], v[14:15]
v_pk_add_f32 v[110:111], v[110:111], v[16:17]
s_waitcnt vmcnt(13)
v_lshlrev_b32 v10, 16, v208
v_and_b32 v11, 0xffff0000, v208
v_lshlrev_b32 v12, 16, v209
v_and_b32 v13, 0xffff0000, v209
v_lshlrev_b32 v14, 16, v210
v_and_b32 v15, 0xffff0000, v210
v_lshlrev_b32 v16, 16, v211
v_and_b32 v17, 0xffff0000, v211
v_pk_add_f32 v[104:105], v[104:105], v[10:11]
v_pk_add_f32 v[106:107], v[106:107], v[12:13]
v_pk_add_f32 v[108:109], v[108:109], v[14:15]
v_pk_add_f32 v[110:111], v[110:111], v[16:17]
s_waitcnt vmcnt(12)
v_lshlrev_b32 v10, 16, v212
v_and_b32 v11, 0xffff0000, v212
v_lshlrev_b32 v12, 16, v213
v_and_b32 v13, 0xffff0000, v213
v_lshlrev_b32 v14, 16, v214
v_and_b32 v15, 0xffff0000, v214
v_lshlrev_b32 v16, 16, v215
v_and_b32 v17, 0xffff0000, v215
v_pk_add_f32 v[104:105], v[104:105], v[10:11]
v_pk_add_f32 v[106:107], v[106:107], v[12:13]
v_pk_add_f32 v[108:109], v[108:109], v[14:15]
v_pk_add_f32 v[110:111], v[110:111], v[16:17]
s_waitcnt vmcnt(11)
v_lshlrev_b32 v10, 16, v216
v_and_b32 v11, 0xffff0000, v216
v_lshlrev_b32 v12, 16, v217
v_and_b32 v13, 0xffff0000, v217
v_lshlrev_b32 v14, 16, v218
v_and_b32 v15, 0xffff0000, v218
v_lshlrev_b32 v16, 16, v219
v_and_b32 v17, 0xffff0000, v219
v_pk_add_f32 v[104:105], v[104:105], v[10:11]
v_pk_add_f32 v[106:107], v[106:107], v[12:13]
v_pk_add_f32 v[108:109], v[108:109], v[14:15]
v_pk_add_f32 v[110:111], v[110:111], v[16:17]
s_waitcnt vmcnt(10)
v_lshlrev_b32 v10, 16, v220
v_and_b32 v11, 0xffff0000, v220
v_lshlrev_b32 v12, 16, v221
v_and_b32 v13, 0xffff0000, v221
v_lshlrev_b32 v14, 16, v222
v_and_b32 v15, 0xffff0000, v222
v_lshlrev_b32 v16, 16, v223
v_and_b32 v17, 0xffff0000, v223
v_pk_add_f32 v[104:105], v[104:105], v[10:11]
v_pk_add_f32 v[106:107], v[106:107], v[12:13]
v_pk_add_f32 v[108:109], v[108:109], v[14:15]
v_pk_add_f32 v[110:111], v[110:111], v[16:17]
s_waitcnt vmcnt(9)
v_lshlrev_b32 v10, 16, v224
v_and_b32 v11, 0xffff0000, v224
v_lshlrev_b32 v12, 16, v225
v_and_b32 v13, 0xffff0000, v225
v_lshlrev_b32 v14, 16, v226
v_and_b32 v15, 0xffff0000, v226
v_lshlrev_b32 v16, 16, v227
v_and_b32 v17, 0xffff0000, v227
v_pk_add_f32 v[104:105], v[104:105], v[10:11]
v_pk_add_f32 v[106:107], v[106:107], v[12:13]
v_pk_add_f32 v[108:109], v[108:109], v[14:15]
v_pk_add_f32 v[110:111], v[110:111], v[16:17]
s_waitcnt vmcnt(8)
v_lshlrev_b32 v10, 16, v228
v_and_b32 v11, 0xffff0000, v228
v_lshlrev_b32 v12, 16, v229
v_and_b32 v13, 0xffff0000, v229
v_lshlrev_b32 v14, 16, v230
v_and_b32 v15, 0xffff0000, v230
v_lshlrev_b32 v16, 16, v231
v_and_b32 v17, 0xffff0000, v231
v_pk_add_f32 v[104:105], v[104:105], v[10:11]
v_pk_add_f32 v[106:107], v[106:107], v[12:13]
v_pk_add_f32 v[108:109], v[108:109], v[14:15]
v_pk_add_f32 v[110:111], v[110:111], v[16:17]
s_waitcnt vmcnt(7)
v_lshlrev_b32 v10, 16, v232
v_and_b32 v11, 0xffff0000, v232
v_lshlrev_b32 v12, 16, v233
v_and_b32 v13, 0xffff0000, v233
v_lshlrev_b32 v14, 16, v234
v_and_b32 v15, 0xffff0000, v234
v_lshlrev_b32 v16, 16, v235
v_and_b32 v17, 0xffff0000, v235
v_pk_add_f32 v[104:105], v[104:105], v[10:11]
v_pk_add_f32 v[106:107], v[106:107], v[12:13]
v_pk_add_f32 v[108:109], v[108:109], v[14:15]
v_pk_add_f32 v[110:111], v[110:111], v[16:17]
s_waitcnt vmcnt(6)
v_lshlrev_b32 v10, 16, v236
v_and_b32 v11, 0xffff0000, v236
v_lshlrev_b32 v12, 16, v237
v_and_b32 v13, 0xffff0000, v237
v_lshlrev_b32 v14, 16, v238
v_and_b32 v15, 0xffff0000, v238
v_lshlrev_b32 v16, 16, v239
v_and_b32 v17, 0xffff0000, v239
v_pk_add_f32 v[104:105], v[104:105], v[10:11]
v_pk_add_f32 v[106:107], v[106:107], v[12:13]
v_pk_add_f32 v[108:109], v[108:109], v[14:15]
v_pk_add_f32 v[110:111], v[110:111], v[16:17]
s_waitcnt vmcnt(5)
v_lshlrev_b32 v10, 16, v240
v_and_b32 v11, 0xffff0000, v240
v_lshlrev_b32 v12, 16, v241
v_and_b32 v13, 0xffff0000, v241
v_lshlrev_b32 v14, 16, v242
v_and_b32 v15, 0xffff0000, v242
v_lshlrev_b32 v16, 16, v243
v_and_b32 v17, 0xffff0000, v243
v_pk_add_f32 v[104:105], v[104:105], v[10:11]
v_pk_add_f32 v[106:107], v[106:107], v[12:13]
v_pk_add_f32 v[108:109], v[108:109], v[14:15]
v_pk_add_f32 v[110:111], v[110:111], v[16:17]
s_waitcnt vmcnt(4)
v_lshlrev_b32 v10, 16, v244
v_and_b32 v11, 0xffff0000, v244
v_lshlrev_b32 v12, 16, v245
v_and_b32 v13, 0xffff0000, v245
v_lshlrev_b32 v14, 16, v246
v_and_b32 v15, 0xffff0000, v246
v_lshlrev_b32 v16, 16, v247
v_and_b32 v17, 0xffff0000, v247
v_pk_add_f32 v[104:105], v[104:105], v[10:11]
v_pk_add_f32 v[106:107], v[106:107], v[12:13]
v_pk_add_f32 v[108:109], v[108:109], v[14:15]
v_pk_add_f32 v[110:111], v[110:111], v[16:17]
s_waitcnt vmcnt(3)
v_lshlrev_b32 v10, 16, v248
v_and_b32 v11, 0xffff0000, v248
v_lshlrev_b32 v12, 16, v249
v_and_b32 v13, 0xffff0000, v249
v_lshlrev_b32 v14, 16, v250
v_and_b32 v15, 0xffff0000, v250
v_lshlrev_b32 v16, 16, v251
v_and_b32 v17, 0xffff0000, v251
v_pk_add_f32 v[104:105], v[104:105], v[10:11]
v_pk_add_f32 v[106:107], v[106:107], v[12:13]
v_pk_add_f32 v[108:109], v[108:109], v[14:15]
v_pk_add_f32 v[110:111], v[110:111], v[16:17]
s_waitcnt vmcnt(2)
v_lshlrev_b32 v10, 16, v252
v_and_b32 v11, 0xffff0000, v252
v_lshlrev_b32 v12, 16, v253
v_and_b32 v13, 0xffff0000, v253
v_lshlrev_b32 v14, 16, v254
v_and_b32 v15, 0xffff0000, v254
v_lshlrev_b32 v16, 16, v255
v_and_b32 v17, 0xffff0000, v255
v_pk_add_f32 v[104:105], v[104:105], v[10:11]
v_pk_add_f32 v[106:107], v[106:107], v[12:13]
v_pk_add_f32 v[108:109], v[108:109], v[14:15]
v_pk_add_f32 v[110:111], v[110:111], v[16:17]
v_cvt_pk_bf16_f32 v104, v104, v105
v_cvt_pk_bf16_f32 v105, v106, v107
v_cvt_pk_bf16_f32 v106, v108, v109
v_cvt_pk_bf16_f32 v107, v110, v111
buffer_store_dwordx2 v[104:105], v21, s[40:43], s25 offen offset:1344
buffer_store_dwordx2 v[106:107], v21, s[40:43], s25 offen offset:1376
s_add_u32 s25, s25, 1835008
s_add_u32 s26, s26, 14457856
s_add_u32 s33, s33, 1024
s_branch M_r1
PAD_18:
s_cbranch_execz M_tret
M_rA:
s_add_u32 s25, s25, 448
s_add_u32 s26, s26, 7168
s_add_u32 s33, s33, 2048
M_r1:
Lp_9203:
buffer_load_dword v18, v19, s[4:7], s33 offen offset:0 sc1
s_waitcnt vmcnt(0)
v_cmp_gt_u32 vcc, 1, v18
s_cbranch_vccz Lpd_9204
s_sleep 8
s_sub_u32 s101, s101, 1
s_cbranch_scc0 Lp_9203
s_mov_b32 s101, 0
Lpd_9204:
buffer_load_dwordx4 v[128:131], v1, s[4:7], s26 offen sc1
s_add_u32 s26, s26, 14336
buffer_load_dwordx4 v[132:135], v1, s[4:7], s26 offen sc1
s_add_u32 s26, s26, 14336
buffer_load_dwordx4 v[136:139], v1, s[4:7], s26 offen sc1
s_add_u32 s26, s26, 14336
buffer_load_dwordx4 v[140:143], v1, s[4:7], s26 offen sc1
s_add_u32 s26, s26, 14336
buffer_load_dwordx4 v[144:147], v1, s[4:7], s26 offen sc1
s_add_u32 s26, s26, 14336
buffer_load_dwordx4 v[148:151], v1, s[4:7], s26 offen sc1
s_add_u32 s26, s26, 14336
buffer_load_dwordx4 v[152:155], v1, s[4:7], s26 offen sc1
s_add_u32 s26, s26, 14336
buffer_load_dwordx4 v[156:159], v1, s[4:7], s26 offen sc1
s_add_u32 s26, s26, 14336
buffer_load_dwordx4 v[160:163], v1, s[4:7], s26 offen sc1
s_add_u32 s26, s26, 14336
buffer_load_dwordx4 v[164:167], v1, s[4:7], s26 offen sc1
s_add_u32 s26, s26, 14336
buffer_load_dwordx4 v[168:171], v1, s[4:7], s26 offen sc1
s_add_u32 s26, s26, 14336
buffer_load_dwordx4 v[172:175], v1, s[4:7], s26 offen sc1
s_add_u32 s26, s26, 14336
buffer_load_dwordx4 v[176:179], v1, s[4:7], s26 offen sc1
s_add_u32 s26, s26, 14336
buffer_load_dwordx4 v[180:183], v1, s[4:7], s26 offen sc1
s_add_u32 s26, s26, 14336
buffer_load_dwordx4 v[184:187], v1, s[4:7], s26 offen sc1
s_add_u32 s26, s26, 14336
buffer_load_dwordx4 v[188:191], v1, s[4:7], s26 offen sc1
s_waitcnt vmcnt(15)
v_lshlrev_b32 v96, 16, v128
v_and_b32 v97, 0xffff0000, v128
v_lshlrev_b32 v98, 16, v129
v_and_b32 v99, 0xffff0000, v129
v_lshlrev_b32 v100, 16, v130
v_and_b32 v101, 0xffff0000, v130
v_lshlrev_b32 v102, 16, v131
v_and_b32 v103, 0xffff0000, v131
s_waitcnt vmcnt(14)
v_lshlrev_b32 v10, 16, v132
v_and_b32 v11, 0xffff0000, v132
v_lshlrev_b32 v12, 16, v133
v_and_b32 v13, 0xffff0000, v133
v_lshlrev_b32 v14, 16, v134
v_and_b32 v15, 0xffff0000, v134
v_lshlrev_b32 v16, 16, v135
v_and_b32 v17, 0xffff0000, v135
v_pk_add_f32 v[96:97], v[96:97], v[10:11]
v_pk_add_f32 v[98:99], v[98:99], v[12:13]
v_pk_add_f32 v[100:101], v[100:101], v[14:15]
v_pk_add_f32 v[102:103], v[102:103], v[16:17]
s_waitcnt vmcnt(13)
v_lshlrev_b32 v10, 16, v136
v_and_b32 v11, 0xffff0000, v136
v_lshlrev_b32 v12, 16, v137
v_and_b32 v13, 0xffff0000, v137
v_lshlrev_b32 v14, 16, v138
v_and_b32 v15, 0xffff0000, v138
v_lshlrev_b32 v16, 16, v139
v_and_b32 v17, 0xffff0000, v139
v_pk_add_f32 v[96:97], v[96:97], v[10:11]
v_pk_add_f32 v[98:99], v[98:99], v[12:13]
v_pk_add_f32 v[100:101], v[100:101], v[14:15]
v_pk_add_f32 v[102:103], v[102:103], v[16:17]
s_waitcnt vmcnt(12)
v_lshlrev_b32 v10, 16, v140
v_and_b32 v11, 0xffff0000, v140
v_lshlrev_b32 v12, 16, v141
v_and_b32 v13, 0xffff0000, v141
v_lshlrev_b32 v14, 16, v142
v_and_b32 v15, 0xffff0000, v142
v_lshlrev_b32 v16, 16, v143
v_and_b32 v17, 0xffff0000, v143
v_pk_add_f32 v[96:97], v[96:97], v[10:11]
v_pk_add_f32 v[98:99], v[98:99], v[12:13]
v_pk_add_f32 v[100:101], v[100:101], v[14:15]
v_pk_add_f32 v[102:103], v[102:103], v[16:17]
s_waitcnt vmcnt(11)
v_lshlrev_b32 v10, 16, v144
v_and_b32 v11, 0xffff0000, v144
v_lshlrev_b32 v12, 16, v145
v_and_b32 v13, 0xffff0000, v145
v_lshlrev_b32 v14, 16, v146
v_and_b32 v15, 0xffff0000, v146
v_lshlrev_b32 v16, 16, v147
v_and_b32 v17, 0xffff0000, v147
v_pk_add_f32 v[96:97], v[96:97], v[10:11]
v_pk_add_f32 v[98:99], v[98:99], v[12:13]
v_pk_add_f32 v[100:101], v[100:101], v[14:15]
v_pk_add_f32 v[102:103], v[102:103], v[16:17]
s_waitcnt vmcnt(10)
v_lshlrev_b32 v10, 16, v148
v_and_b32 v11, 0xffff0000, v148
v_lshlrev_b32 v12, 16, v149
v_and_b32 v13, 0xffff0000, v149
v_lshlrev_b32 v14, 16, v150
v_and_b32 v15, 0xffff0000, v150
v_lshlrev_b32 v16, 16, v151
v_and_b32 v17, 0xffff0000, v151
v_pk_add_f32 v[96:97], v[96:97], v[10:11]
v_pk_add_f32 v[98:99], v[98:99], v[12:13]
v_pk_add_f32 v[100:101], v[100:101], v[14:15]
v_pk_add_f32 v[102:103], v[102:103], v[16:17]
s_waitcnt vmcnt(9)
v_lshlrev_b32 v10, 16, v152
v_and_b32 v11, 0xffff0000, v152
v_lshlrev_b32 v12, 16, v153
v_and_b32 v13, 0xffff0000, v153
v_lshlrev_b32 v14, 16, v154
v_and_b32 v15, 0xffff0000, v154
v_lshlrev_b32 v16, 16, v155
v_and_b32 v17, 0xffff0000, v155
v_pk_add_f32 v[96:97], v[96:97], v[10:11]
v_pk_add_f32 v[98:99], v[98:99], v[12:13]
v_pk_add_f32 v[100:101], v[100:101], v[14:15]
v_pk_add_f32 v[102:103], v[102:103], v[16:17]
s_waitcnt vmcnt(8)
v_lshlrev_b32 v10, 16, v156
v_and_b32 v11, 0xffff0000, v156
v_lshlrev_b32 v12, 16, v157
v_and_b32 v13, 0xffff0000, v157
v_lshlrev_b32 v14, 16, v158
v_and_b32 v15, 0xffff0000, v158
v_lshlrev_b32 v16, 16, v159
v_and_b32 v17, 0xffff0000, v159
v_pk_add_f32 v[96:97], v[96:97], v[10:11]
v_pk_add_f32 v[98:99], v[98:99], v[12:13]
v_pk_add_f32 v[100:101], v[100:101], v[14:15]
v_pk_add_f32 v[102:103], v[102:103], v[16:17]
s_waitcnt vmcnt(7)
v_lshlrev_b32 v10, 16, v160
v_and_b32 v11, 0xffff0000, v160
v_lshlrev_b32 v12, 16, v161
v_and_b32 v13, 0xffff0000, v161
v_lshlrev_b32 v14, 16, v162
v_and_b32 v15, 0xffff0000, v162
v_lshlrev_b32 v16, 16, v163
v_and_b32 v17, 0xffff0000, v163
v_pk_add_f32 v[96:97], v[96:97], v[10:11]
v_pk_add_f32 v[98:99], v[98:99], v[12:13]
v_pk_add_f32 v[100:101], v[100:101], v[14:15]
v_pk_add_f32 v[102:103], v[102:103], v[16:17]
s_waitcnt vmcnt(6)
v_lshlrev_b32 v10, 16, v164
v_and_b32 v11, 0xffff0000, v164
v_lshlrev_b32 v12, 16, v165
v_and_b32 v13, 0xffff0000, v165
v_lshlrev_b32 v14, 16, v166
v_and_b32 v15, 0xffff0000, v166
v_lshlrev_b32 v16, 16, v167
v_and_b32 v17, 0xffff0000, v167
v_pk_add_f32 v[96:97], v[96:97], v[10:11]
v_pk_add_f32 v[98:99], v[98:99], v[12:13]
v_pk_add_f32 v[100:101], v[100:101], v[14:15]
v_pk_add_f32 v[102:103], v[102:103], v[16:17]
s_waitcnt vmcnt(5)
v_lshlrev_b32 v10, 16, v168
v_and_b32 v11, 0xffff0000, v168
v_lshlrev_b32 v12, 16, v169
v_and_b32 v13, 0xffff0000, v169
v_lshlrev_b32 v14, 16, v170
v_and_b32 v15, 0xffff0000, v170
v_lshlrev_b32 v16, 16, v171
v_and_b32 v17, 0xffff0000, v171
v_pk_add_f32 v[96:97], v[96:97], v[10:11]
v_pk_add_f32 v[98:99], v[98:99], v[12:13]
v_pk_add_f32 v[100:101], v[100:101], v[14:15]
v_pk_add_f32 v[102:103], v[102:103], v[16:17]
s_waitcnt vmcnt(4)
v_lshlrev_b32 v10, 16, v172
v_and_b32 v11, 0xffff0000, v172
v_lshlrev_b32 v12, 16, v173
v_and_b32 v13, 0xffff0000, v173
v_lshlrev_b32 v14, 16, v174
v_and_b32 v15, 0xffff0000, v174
v_lshlrev_b32 v16, 16, v175
v_and_b32 v17, 0xffff0000, v175
v_pk_add_f32 v[96:97], v[96:97], v[10:11]
v_pk_add_f32 v[98:99], v[98:99], v[12:13]
v_pk_add_f32 v[100:101], v[100:101], v[14:15]
v_pk_add_f32 v[102:103], v[102:103], v[16:17]
s_waitcnt vmcnt(3)
v_lshlrev_b32 v10, 16, v176
v_and_b32 v11, 0xffff0000, v176
v_lshlrev_b32 v12, 16, v177
v_and_b32 v13, 0xffff0000, v177
v_lshlrev_b32 v14, 16, v178
v_and_b32 v15, 0xffff0000, v178
v_lshlrev_b32 v16, 16, v179
v_and_b32 v17, 0xffff0000, v179
v_pk_add_f32 v[96:97], v[96:97], v[10:11]
v_pk_add_f32 v[98:99], v[98:99], v[12:13]
v_pk_add_f32 v[100:101], v[100:101], v[14:15]
v_pk_add_f32 v[102:103], v[102:103], v[16:17]
s_waitcnt vmcnt(2)
v_lshlrev_b32 v10, 16, v180
v_and_b32 v11, 0xffff0000, v180
v_lshlrev_b32 v12, 16, v181
v_and_b32 v13, 0xffff0000, v181
v_lshlrev_b32 v14, 16, v182
v_and_b32 v15, 0xffff0000, v182
v_lshlrev_b32 v16, 16, v183
v_and_b32 v17, 0xffff0000, v183
v_pk_add_f32 v[96:97], v[96:97], v[10:11]
v_pk_add_f32 v[98:99], v[98:99], v[12:13]
v_pk_add_f32 v[100:101], v[100:101], v[14:15]
v_pk_add_f32 v[102:103], v[102:103], v[16:17]
s_waitcnt vmcnt(1)
v_lshlrev_b32 v10, 16, v184
v_and_b32 v11, 0xffff0000, v184
v_lshlrev_b32 v12, 16, v185
v_and_b32 v13, 0xffff0000, v185
v_lshlrev_b32 v14, 16, v186
v_and_b32 v15, 0xffff0000, v186
v_lshlrev_b32 v16, 16, v187
v_and_b32 v17, 0xffff0000, v187
v_pk_add_f32 v[96:97], v[96:97], v[10:11]
v_pk_add_f32 v[98:99], v[98:99], v[12:13]
v_pk_add_f32 v[100:101], v[100:101], v[14:15]
v_pk_add_f32 v[102:103], v[102:103], v[16:17]
s_waitcnt vmcnt(0)
v_lshlrev_b32 v10, 16, v188
v_and_b32 v11, 0xffff0000, v188
v_lshlrev_b32 v12, 16, v189
v_and_b32 v13, 0xffff0000, v189
v_lshlrev_b32 v14, 16, v190
v_and_b32 v15, 0xffff0000, v190
v_lshlrev_b32 v16, 16, v191
v_and_b32 v17, 0xffff0000, v191
v_pk_add_f32 v[96:97], v[96:97], v[10:11]
v_pk_add_f32 v[98:99], v[98:99], v[12:13]
v_pk_add_f32 v[100:101], v[100:101], v[14:15]
v_pk_add_f32 v[102:103], v[102:103], v[16:17]
v_cvt_pk_bf16_f32 v96, v96, v97
v_cvt_pk_bf16_f32 v97, v98, v99
v_cvt_pk_bf16_f32 v98, v100, v101
v_cvt_pk_bf16_f32 v99, v102, v103
buffer_store_dwordx2 v[96:97], v21, s[40:43], s25 offen offset:896
buffer_store_dwordx2 v[98:99], v21, s[40:43], s25 offen offset:928
M_fin:
s_endpgm
M_final:
PAD_19:
s_cbranch_execz M_tret
s_mov_b32 s8, s64
s_mov_b32 s9, s65
s_mov_b32 s10, 1835008
s_mov_b32 s11, 0x20000
s_mov_b32 s12, s88
s_mov_b32 s13, s89
s_mov_b32 s14, 3670016
s_mov_b32 s15, 0x20000
s_and_b32 s24, s2, 16
s_add_u32 s24, s24, s20
v_lshrrev_b32 v20, 4, v1
v_and_b32 v21, 15, v20
v_lshrrev_b32 v22, 4, v20
v_mul_u32_u24 v2, 896, v21
v_lshlrev_b32 v9, 1, v2
v_lshl_add_u32 v2, v22, 4, v2
v_lshl_add_u32 v9, v22, 4, v9
s_lshl_b32 s22, s24, 2
s_add_u32 s22, s22, s3
s_mul_i32 s25, s22, 14336
s_lshl_b32 s26, s25, 1
v_lshlrev_b32 v10, 5, v22
v_add3_u32 v10, v10, v21, 16
v_lshlrev_b32 v10, 2, v10
v_min_u32 v11, 380, v10
v_add_u32 v11, 512, v11
s_mov_b32 s27, 94384128
Lfp:
buffer_load_dword v3, v10, s[4:7], s27 offen sc1
buffer_load_dword v4, v11, s[4:7], s27 offen sc1
s_waitcnt vmcnt(0)
v_and_b32 v3, v3, v4
v_cmp_gt_u32 vcc, 1, v3
s_cbranch_vccz Lfpd
s_sleep 2
s_sub_u32 s101, s101, 1
s_cbranch_scc0 Lfp
s_mov_b32 s101, 0
Lfpd:
s_barrier
buffer_store_dword v6, v5, s[4:7], s35 offen sc1
Lfg:
v_lshrrev_b32 v3, 3, v20
v_and_b32 v4, 7, v20
v_lshlrev_b32 v4, 4, v4
v_lshl_add_u32 v3, v3, 12, v4
s_mul_i32 s27, s3, 458752
s_lshl_b32 s22, s24, 7
s_add_u32 s27, s27, s22
s_add_u32 s27, s27, 88080384
s_mul_i32 s28, s3, 14336
s_add_u32 m0, s28, 0
s_nop 0
buffer_load_dwordx4 v3, s[4:7], s27 offen sc1 lds
s_add_u32 s27, s27, 32768
s_add_u32 m0, s28, 1024
s_nop 0
buffer_load_dwordx4 v3, s[4:7], s27 offen sc1 lds
s_add_u32 s27, s27, 32768
s_add_u32 m0, s28, 2048
s_nop 0
buffer_load_dwordx4 v3, s[4:7], s27 offen sc1 lds
s_add_u32 s27, s27, 32768
s_add_u32 m0, s28, 3072
s_nop 0
buffer_load_dwordx4 v3, s[4:7], s27 offen sc1 lds
s_add_u32 s27, s27, 32768
s_add_u32 m0, s28, 4096
s_nop 0
buffer_load_dwordx4 v3, s[4:7], s27 offen sc1 lds
s_add_u32 s27, s27, 32768
s_add_u32 m0, s28, 5120
s_nop 0
buffer_load_dwordx4 v3, s[4:7], s27 offen sc1 lds
s_add_u32 s27, s27, 32768
s_add_u32 m0, s28, 6144
s_nop 0
buffer_load_dwordx4 v3, s[4:7], s27 offen sc1 lds
s_add_u32 s27, s27, 32768
s_add_u32 m0, s28, 7168
s_nop 0
buffer_load_dwordx4 v3, s[4:7], s27 offen sc1 lds
s_add_u32 s27, s27, 32768
s_add_u32 m0, s28, 8192
s_nop 0
buffer_load_dwordx4 v3, s[4:7], s27 offen sc1 lds
s_add_u32 s27, s27, 32768
s_add_u32 m0, s28, 9216
s_nop 0
buffer_load_dwordx4 v3, s[4:7], s27 offen sc1 lds
s_add_u32 s27, s27, 32768
s_add_u32 m0, s28, 10240
s_nop 0
buffer_load_dwordx4 v3, s[4:7], s27 offen sc1 lds
s_add_u32 s27, s27, 32768
s_add_u32 m0, s28, 11264
s_nop 0
buffer_load_dwordx4 v3, s[4:7], s27 offen sc1 lds
s_add_u32 s27, s27, 32768
s_add_u32 m0, s28, 12288
s_nop 0
buffer_load_dwordx4 v3, s[4:7], s27 offen sc1 lds
s_add_u32 s27, s27, 32768
s_add_u32 m0, s28, 13312
s_nop 0
buffer_load_dwordx4 v3, s[4:7], s27 offen sc1 lds
s_add_u32 s27, s27, 32768
buffer_load_dwordx4 v[160:163], v2, s[8:11], s25 offen offset:0
buffer_load_dwordx4 v[164:167], v2, s[8:11], s25 offen offset:64
buffer_load_dwordx4 v[168:171], v2, s[8:11], s25 offen offset:128
buffer_load_dwordx4 v[172:175], v2, s[8:11], s25 offen offset:192
buffer_load_dwordx4 v[176:179], v2, s[8:11], s25 offen offset:256
buffer_load_dwordx4 v[180:183], v2, s[8:11], s25 offen offset:320
buffer_load_dwordx4 v[184:187], v2, s[8:11], s25 offen offset:384
buffer_load_dwordx4 v[188:191], v2, s[8:11], s25 offen offset:448
buffer_load_dwordx4 v[192:195], v2, s[8:11], s25 offen offset:512
buffer_load_dwordx4 v[196:199], v2, s[8:11], s25 offen offset:576
buffer_load_dwordx4 v[200:203], v2, s[8:11], s25 offen offset:640
buffer_load_dwordx4 v[204:207], v2, s[8:11], s25 offen offset:704
buffer_load_dwordx4 v[208:211], v2, s[8:11], s25 offen offset:768
buffer_load_dwordx4 v[212:215], v2, s[8:11], s25 offen offset:832
v_lshrrev_b32 v3, 2, v21
v_lshl_add_u32 v3, v22, 3, v3
v_lshlrev_b32 v3, 7, v3
v_and_b32 v4, 3, v20
v_lshl_add_u32 v3, v4, 3, v3
s_lshl_b32 s22, s3, 5
v_add_u32 v3, s22, v3
s_waitcnt vmcnt(14)
s_barrier
ds_read_b64_tr_b16 v[96:97], v3 offset:0
ds_read_b64_tr_b16 v[98:99], v3 offset:512
ds_read_b64_tr_b16 v[100:101], v3 offset:4096
ds_read_b64_tr_b16 v[102:103], v3 offset:4608
ds_read_b64_tr_b16 v[104:105], v3 offset:8192
ds_read_b64_tr_b16 v[106:107], v3 offset:8704
ds_read_b64_tr_b16 v[108:109], v3 offset:12288
ds_read_b64_tr_b16 v[110:111], v3 offset:12800
ds_read_b64_tr_b16 v[112:113], v3 offset:16384
ds_read_b64_tr_b16 v[114:115], v3 offset:16896
ds_read_b64_tr_b16 v[116:117], v3 offset:20480
ds_read_b64_tr_b16 v[118:119], v3 offset:20992
ds_read_b64_tr_b16 v[120:121], v3 offset:24576
ds_read_b64_tr_b16 v[122:123], v3 offset:25088
s_waitcnt lgkmcnt(0)
ds_read_b64_tr_b16 v[124:125], v3 offset:28672
ds_read_b64_tr_b16 v[126:127], v3 offset:29184
ds_read_b64_tr_b16 v[128:129], v3 offset:32768
ds_read_b64_tr_b16 v[130:131], v3 offset:33280
ds_read_b64_tr_b16 v[132:133], v3 offset:36864
ds_read_b64_tr_b16 v[134:135], v3 offset:37376
ds_read_b64_tr_b16 v[136:137], v3 offset:40960
ds_read_b64_tr_b16 v[138:139], v3 offset:41472
ds_read_b64_tr_b16 v[140:141], v3 offset:45056
ds_read_b64_tr_b16 v[142:143], v3 offset:45568
ds_read_b64_tr_b16 v[144:145], v3 offset:49152
ds_read_b64_tr_b16 v[146:147], v3 offset:49664
ds_read_b64_tr_b16 v[148:149], v3 offset:53248
ds_read_b64_tr_b16 v[150:151], v3 offset:53760
s_waitcnt vmcnt(13)
v_lshlrev_b32 v10, 16, v160
v_and_b32 v11, 0xffff0000, v160
v_lshlrev_b32 v12, 16, v96
v_and_b32 v13, 0xffff0000, v96
v_pk_mul_f32 v[10:11], v[10:11], v[12:13]
v_cvt_pk_bf16_f32 v160, v10, v11
v_lshlrev_b32 v10, 16, v161
v_and_b32 v11, 0xffff0000, v161
v_lshlrev_b32 v12, 16, v97
v_and_b32 v13, 0xffff0000, v97
v_pk_mul_f32 v[10:11], v[10:11], v[12:13]
v_cvt_pk_bf16_f32 v161, v10, v11
v_lshlrev_b32 v10, 16, v162
v_and_b32 v11, 0xffff0000, v162
v_lshlrev_b32 v12, 16, v98
v_and_b32 v13, 0xffff0000, v98
v_pk_mul_f32 v[10:11], v[10:11], v[12:13]
PAD_20:
s_cbranch_execz M_tret
v_cvt_pk_bf16_f32 v162, v10, v11
v_lshlrev_b32 v10, 16, v163
v_and_b32 v11, 0xffff0000, v163
v_lshlrev_b32 v12, 16, v99
v_and_b32 v13, 0xffff0000, v99
v_pk_mul_f32 v[10:11], v[10:11], v[12:13]
v_cvt_pk_bf16_f32 v163, v10, v11
buffer_store_dwordx4 v[160:163], v9, s[12:15], s26 offen offset:0
s_waitcnt vmcnt(13)
v_lshlrev_b32 v10, 16, v164
v_and_b32 v11, 0xffff0000, v164
v_lshlrev_b32 v12, 16, v100
v_and_b32 v13, 0xffff0000, v100
v_pk_mul_f32 v[10:11], v[10:11], v[12:13]
v_cvt_pk_bf16_f32 v164, v10, v11
v_lshlrev_b32 v10, 16, v165
v_and_b32 v11, 0xffff0000, v165
v_lshlrev_b32 v12, 16, v101
v_and_b32 v13, 0xffff0000, v101
v_pk_mul_f32 v[10:11], v[10:11], v[12:13]
v_cvt_pk_bf16_f32 v165, v10, v11
v_lshlrev_b32 v10, 16, v166
v_and_b32 v11, 0xffff0000, v166
v_lshlrev_b32 v12, 16, v102
v_and_b32 v13, 0xffff0000, v102
v_pk_mul_f32 v[10:11], v[10:11], v[12:13]
v_cvt_pk_bf16_f32 v166, v10, v11
v_lshlrev_b32 v10, 16, v167
v_and_b32 v11, 0xffff0000, v167
v_lshlrev_b32 v12, 16, v103
v_and_b32 v13, 0xffff0000, v103
v_pk_mul_f32 v[10:11], v[10:11], v[12:13]
v_cvt_pk_bf16_f32 v167, v10, v11
buffer_store_dwordx4 v[164:167], v9, s[12:15], s26 offen offset:64
s_waitcnt vmcnt(13)
v_lshlrev_b32 v10, 16, v168
v_and_b32 v11, 0xffff0000, v168
v_lshlrev_b32 v12, 16, v104
v_and_b32 v13, 0xffff0000, v104
v_pk_mul_f32 v[10:11], v[10:11], v[12:13]
v_cvt_pk_bf16_f32 v168, v10, v11
v_lshlrev_b32 v10, 16, v169
v_and_b32 v11, 0xffff0000, v169
v_lshlrev_b32 v12, 16, v105
v_and_b32 v13, 0xffff0000, v105
v_pk_mul_f32 v[10:11], v[10:11], v[12:13]
v_cvt_pk_bf16_f32 v169, v10, v11
v_lshlrev_b32 v10, 16, v170
v_and_b32 v11, 0xffff0000, v170
v_lshlrev_b32 v12, 16, v106
v_and_b32 v13, 0xffff0000, v106
v_pk_mul_f32 v[10:11], v[10:11], v[12:13]
v_cvt_pk_bf16_f32 v170, v10, v11
v_lshlrev_b32 v10, 16, v171
v_and_b32 v11, 0xffff0000, v171
v_lshlrev_b32 v12, 16, v107
v_and_b32 v13, 0xffff0000, v107
v_pk_mul_f32 v[10:11], v[10:11], v[12:13]
v_cvt_pk_bf16_f32 v171, v10, v11
buffer_store_dwordx4 v[168:171], v9, s[12:15], s26 offen offset:128
s_waitcnt vmcnt(13)
v_lshlrev_b32 v10, 16, v172
v_and_b32 v11, 0xffff0000, v172
v_lshlrev_b32 v12, 16, v108
v_and_b32 v13, 0xffff0000, v108
v_pk_mul_f32 v[10:11], v[10:11], v[12:13]
v_cvt_pk_bf16_f32 v172, v10, v11
v_lshlrev_b32 v10, 16, v173
v_and_b32 v11, 0xffff0000, v173
v_lshlrev_b32 v12, 16, v109
v_and_b32 v13, 0xffff0000, v109
v_pk_mul_f32 v[10:11], v[10:11], v[12:13]
v_cvt_pk_bf16_f32 v173, v10, v11
v_lshlrev_b32 v10, 16, v174
v_and_b32 v11, 0xffff0000, v174
v_lshlrev_b32 v12, 16, v110
v_and_b32 v13, 0xffff0000, v110
v_pk_mul_f32 v[10:11], v[10:11], v[12:13]
v_cvt_pk_bf16_f32 v174, v10, v11
v_lshlrev_b32 v10, 16, v175
v_and_b32 v11, 0xffff0000, v175
v_lshlrev_b32 v12, 16, v111
v_and_b32 v13, 0xffff0000, v111
v_pk_mul_f32 v[10:11], v[10:11], v[12:13]
v_cvt_pk_bf16_f32 v175, v10, v11
buffer_store_dwordx4 v[172:175], v9, s[12:15], s26 offen offset:192
s_waitcnt vmcnt(13)
v_lshlrev_b32 v10, 16, v176
v_and_b32 v11, 0xffff0000, v176
v_lshlrev_b32 v12, 16, v112
v_and_b32 v13, 0xffff0000, v112
v_pk_mul_f32 v[10:11], v[10:11], v[12:13]
v_cvt_pk_bf16_f32 v176, v10, v11
v_lshlrev_b32 v10, 16, v177
v_and_b32 v11, 0xffff0000, v177
v_lshlrev_b32 v12, 16, v113
v_and_b32 v13, 0xffff0000, v113
v_pk_mul_f32 v[10:11], v[10:11], v[12:13]
v_cvt_pk_bf16_f32 v177, v10, v11
v_lshlrev_b32 v10, 16, v178
v_and_b32 v11, 0xffff0000, v178
v_lshlrev_b32 v12, 16, v114
v_and_b32 v13, 0xffff0000, v114
v_pk_mul_f32 v[10:11], v[10:11], v[12:13]
v_cvt_pk_bf16_f32 v178, v10, v11
v_lshlrev_b32 v10, 16, v179
v_and_b32 v11, 0xffff0000, v179
v_lshlrev_b32 v12, 16, v115
v_and_b32 v13, 0xffff0000, v115
v_pk_mul_f32 v[10:11], v[10:11], v[12:13]
v_cvt_pk_bf16_f32 v179, v10, v11
buffer_store_dwordx4 v[176:179], v9, s[12:15], s26 offen offset:256
s_waitcnt vmcnt(13)
v_lshlrev_b32 v10, 16, v180
v_and_b32 v11, 0xffff0000, v180
v_lshlrev_b32 v12, 16, v116
v_and_b32 v13, 0xffff0000, v116
v_pk_mul_f32 v[10:11], v[10:11], v[12:13]
v_cvt_pk_bf16_f32 v180, v10, v11
v_lshlrev_b32 v10, 16, v181
v_and_b32 v11, 0xffff0000, v181
v_lshlrev_b32 v12, 16, v117
v_and_b32 v13, 0xffff0000, v117
v_pk_mul_f32 v[10:11], v[10:11], v[12:13]
v_cvt_pk_bf16_f32 v181, v10, v11
v_lshlrev_b32 v10, 16, v182
v_and_b32 v11, 0xffff0000, v182
v_lshlrev_b32 v12, 16, v118
v_and_b32 v13, 0xffff0000, v118
v_pk_mul_f32 v[10:11], v[10:11], v[12:13]
v_cvt_pk_bf16_f32 v182, v10, v11
v_lshlrev_b32 v10, 16, v183
v_and_b32 v11, 0xffff0000, v183
v_lshlrev_b32 v12, 16, v119
v_and_b32 v13, 0xffff0000, v119
v_pk_mul_f32 v[10:11], v[10:11], v[12:13]
v_cvt_pk_bf16_f32 v183, v10, v11
buffer_store_dwordx4 v[180:183], v9, s[12:15], s26 offen offset:320
s_waitcnt vmcnt(13)
v_lshlrev_b32 v10, 16, v184
v_and_b32 v11, 0xffff0000, v184
v_lshlrev_b32 v12, 16, v120
v_and_b32 v13, 0xffff0000, v120
v_pk_mul_f32 v[10:11], v[10:11], v[12:13]
v_cvt_pk_bf16_f32 v184, v10, v11
v_lshlrev_b32 v10, 16, v185
v_and_b32 v11, 0xffff0000, v185
v_lshlrev_b32 v12, 16, v121
v_and_b32 v13, 0xffff0000, v121
v_pk_mul_f32 v[10:11], v[10:11], v[12:13]
v_cvt_pk_bf16_f32 v185, v10, v11
v_lshlrev_b32 v10, 16, v186
v_and_b32 v11, 0xffff0000, v186
v_lshlrev_b32 v12, 16, v122
v_and_b32 v13, 0xffff0000, v122
v_pk_mul_f32 v[10:11], v[10:11], v[12:13]
v_cvt_pk_bf16_f32 v186, v10, v11
v_lshlrev_b32 v10, 16, v187
v_and_b32 v11, 0xffff0000, v187
v_lshlrev_b32 v12, 16, v123
v_and_b32 v13, 0xffff0000, v123
v_pk_mul_f32 v[10:11], v[10:11], v[12:13]
v_cvt_pk_bf16_f32 v187, v10, v11
buffer_store_dwordx4 v[184:187], v9, s[12:15], s26 offen offset:384
s_waitcnt lgkmcnt(0)
s_waitcnt vmcnt(13)
v_lshlrev_b32 v10, 16, v188
v_and_b32 v11, 0xffff0000, v188
v_lshlrev_b32 v12, 16, v124
v_and_b32 v13, 0xffff0000, v124
v_pk_mul_f32 v[10:11], v[10:11], v[12:13]
v_cvt_pk_bf16_f32 v188, v10, v11
v_lshlrev_b32 v10, 16, v189
v_and_b32 v11, 0xffff0000, v189
v_lshlrev_b32 v12, 16, v125
v_and_b32 v13, 0xffff0000, v125
v_pk_mul_f32 v[10:11], v[10:11], v[12:13]
v_cvt_pk_bf16_f32 v189, v10, v11
v_lshlrev_b32 v10, 16, v190
v_and_b32 v11, 0xffff0000, v190
v_lshlrev_b32 v12, 16, v126
v_and_b32 v13, 0xffff0000, v126
v_pk_mul_f32 v[10:11], v[10:11], v[12:13]
v_cvt_pk_bf16_f32 v190, v10, v11
v_lshlrev_b32 v10, 16, v191
v_and_b32 v11, 0xffff0000, v191
v_lshlrev_b32 v12, 16, v127
v_and_b32 v13, 0xffff0000, v127
v_pk_mul_f32 v[10:11], v[10:11], v[12:13]
v_cvt_pk_bf16_f32 v191, v10, v11
buffer_store_dwordx4 v[188:191], v9, s[12:15], s26 offen offset:448
s_waitcnt vmcnt(13)
v_lshlrev_b32 v10, 16, v192
v_and_b32 v11, 0xffff0000, v192
v_lshlrev_b32 v12, 16, v128
v_and_b32 v13, 0xffff0000, v128
v_pk_mul_f32 v[10:11], v[10:11], v[12:13]
v_cvt_pk_bf16_f32 v192, v10, v11
v_lshlrev_b32 v10, 16, v193
v_and_b32 v11, 0xffff0000, v193
v_lshlrev_b32 v12, 16, v129
v_and_b32 v13, 0xffff0000, v129
v_pk_mul_f32 v[10:11], v[10:11], v[12:13]
v_cvt_pk_bf16_f32 v193, v10, v11
v_lshlrev_b32 v10, 16, v194
v_and_b32 v11, 0xffff0000, v194
v_lshlrev_b32 v12, 16, v130
v_and_b32 v13, 0xffff0000, v130
v_pk_mul_f32 v[10:11], v[10:11], v[12:13]
v_cvt_pk_bf16_f32 v194, v10, v11
v_lshlrev_b32 v10, 16, v195
v_and_b32 v11, 0xffff0000, v195
v_lshlrev_b32 v12, 16, v131
v_and_b32 v13, 0xffff0000, v131
v_pk_mul_f32 v[10:11], v[10:11], v[12:13]
v_cvt_pk_bf16_f32 v195, v10, v11
buffer_store_dwordx4 v[192:195], v9, s[12:15], s26 offen offset:512
s_waitcnt vmcnt(13)
v_lshlrev_b32 v10, 16, v196
v_and_b32 v11, 0xffff0000, v196
v_lshlrev_b32 v12, 16, v132
v_and_b32 v13, 0xffff0000, v132
v_pk_mul_f32 v[10:11], v[10:11], v[12:13]
v_cvt_pk_bf16_f32 v196, v10, v11
v_lshlrev_b32 v10, 16, v197
v_and_b32 v11, 0xffff0000, v197
v_lshlrev_b32 v12, 16, v133
v_and_b32 v13, 0xffff0000, v133
v_pk_mul_f32 v[10:11], v[10:11], v[12:13]
v_cvt_pk_bf16_f32 v197, v10, v11
v_lshlrev_b32 v10, 16, v198
v_and_b32 v11, 0xffff0000, v198
v_lshlrev_b32 v12, 16, v134
v_and_b32 v13, 0xffff0000, v134
v_pk_mul_f32 v[10:11], v[10:11], v[12:13]
v_cvt_pk_bf16_f32 v198, v10, v11
v_lshlrev_b32 v10, 16, v199
v_and_b32 v11, 0xffff0000, v199
v_lshlrev_b32 v12, 16, v135
v_and_b32 v13, 0xffff0000, v135
v_pk_mul_f32 v[10:11], v[10:11], v[12:13]
v_cvt_pk_bf16_f32 v199, v10, v11
buffer_store_dwordx4 v[196:199], v9, s[12:15], s26 offen offset:576
s_waitcnt vmcnt(13)
v_lshlrev_b32 v10, 16, v200
v_and_b32 v11, 0xffff0000, v200
v_lshlrev_b32 v12, 16, v136
v_and_b32 v13, 0xffff0000, v136
v_pk_mul_f32 v[10:11], v[10:11], v[12:13]
v_cvt_pk_bf16_f32 v200, v10, v11
v_lshlrev_b32 v10, 16, v201
v_and_b32 v11, 0xffff0000, v201
v_lshlrev_b32 v12, 16, v137
v_and_b32 v13, 0xffff0000, v137
v_pk_mul_f32 v[10:11], v[10:11], v[12:13]
v_cvt_pk_bf16_f32 v201, v10, v11
v_lshlrev_b32 v10, 16, v202
v_and_b32 v11, 0xffff0000, v202
v_lshlrev_b32 v12, 16, v138
v_and_b32 v13, 0xffff0000, v138
v_pk_mul_f32 v[10:11], v[10:11], v[12:13]
v_cvt_pk_bf16_f32 v202, v10, v11
v_lshlrev_b32 v10, 16, v203
v_and_b32 v11, 0xffff0000, v203
v_lshlrev_b32 v12, 16, v139
v_and_b32 v13, 0xffff0000, v139
v_pk_mul_f32 v[10:11], v[10:11], v[12:13]
v_cvt_pk_bf16_f32 v203, v10, v11
buffer_store_dwordx4 v[200:203], v9, s[12:15], s26 offen offset:640
s_waitcnt vmcnt(13)
v_lshlrev_b32 v10, 16, v204
v_and_b32 v11, 0xffff0000, v204
v_lshlrev_b32 v12, 16, v140
v_and_b32 v13, 0xffff0000, v140
v_pk_mul_f32 v[10:11], v[10:11], v[12:13]
v_cvt_pk_bf16_f32 v204, v10, v11
v_lshlrev_b32 v10, 16, v205
v_and_b32 v11, 0xffff0000, v205
v_lshlrev_b32 v12, 16, v141
v_and_b32 v13, 0xffff0000, v141
v_pk_mul_f32 v[10:11], v[10:11], v[12:13]
v_cvt_pk_bf16_f32 v205, v10, v11
v_lshlrev_b32 v10, 16, v206
v_and_b32 v11, 0xffff0000, v206
v_lshlrev_b32 v12, 16, v142
v_and_b32 v13, 0xffff0000, v142
v_pk_mul_f32 v[10:11], v[10:11], v[12:13]
v_cvt_pk_bf16_f32 v206, v10, v11
v_lshlrev_b32 v10, 16, v207
v_and_b32 v11, 0xffff0000, v207
v_lshlrev_b32 v12, 16, v143
v_and_b32 v13, 0xffff0000, v143
v_pk_mul_f32 v[10:11], v[10:11], v[12:13]
v_cvt_pk_bf16_f32 v207, v10, v11
buffer_store_dwordx4 v[204:207], v9, s[12:15], s26 offen offset:704
s_waitcnt vmcnt(13)
v_lshlrev_b32 v10, 16, v208
v_and_b32 v11, 0xffff0000, v208
v_lshlrev_b32 v12, 16, v144
v_and_b32 v13, 0xffff0000, v144
v_pk_mul_f32 v[10:11], v[10:11], v[12:13]
v_cvt_pk_bf16_f32 v208, v10, v11
v_lshlrev_b32 v10, 16, v209
v_and_b32 v11, 0xffff0000, v209
v_lshlrev_b32 v12, 16, v145
v_and_b32 v13, 0xffff0000, v145
v_pk_mul_f32 v[10:11], v[10:11], v[12:13]
v_cvt_pk_bf16_f32 v209, v10, v11
v_lshlrev_b32 v10, 16, v210
v_and_b32 v11, 0xffff0000, v210
v_lshlrev_b32 v12, 16, v146
v_and_b32 v13, 0xffff0000, v146
v_pk_mul_f32 v[10:11], v[10:11], v[12:13]
v_cvt_pk_bf16_f32 v210, v10, v11
v_lshlrev_b32 v10, 16, v211
v_and_b32 v11, 0xffff0000, v211
v_lshlrev_b32 v12, 16, v147
v_and_b32 v13, 0xffff0000, v147
v_pk_mul_f32 v[10:11], v[10:11], v[12:13]
v_cvt_pk_bf16_f32 v211, v10, v11
buffer_store_dwordx4 v[208:211], v9, s[12:15], s26 offen offset:768
s_waitcnt vmcnt(13)
v_lshlrev_b32 v10, 16, v212
v_and_b32 v11, 0xffff0000, v212
v_lshlrev_b32 v12, 16, v148
v_and_b32 v13, 0xffff0000, v148
v_pk_mul_f32 v[10:11], v[10:11], v[12:13]
v_cvt_pk_bf16_f32 v212, v10, v11
v_lshlrev_b32 v10, 16, v213
v_and_b32 v11, 0xffff0000, v213
v_lshlrev_b32 v12, 16, v149
v_and_b32 v13, 0xffff0000, v149
v_pk_mul_f32 v[10:11], v[10:11], v[12:13]
v_cvt_pk_bf16_f32 v213, v10, v11
v_lshlrev_b32 v10, 16, v214
v_and_b32 v11, 0xffff0000, v214
v_lshlrev_b32 v12, 16, v150
v_and_b32 v13, 0xffff0000, v150
v_pk_mul_f32 v[10:11], v[10:11], v[12:13]
v_cvt_pk_bf16_f32 v214, v10, v11
v_lshlrev_b32 v10, 16, v215
v_and_b32 v11, 0xffff0000, v215
v_lshlrev_b32 v12, 16, v151
v_and_b32 v13, 0xffff0000, v151
v_pk_mul_f32 v[10:11], v[10:11], v[12:13]
v_cvt_pk_bf16_f32 v215, v10, v11
buffer_store_dwordx4 v[212:215], v9, s[12:15], s26 offen offset:832
s_branch M_fin
M_fend:
M_rslow:
Lp_9251:
buffer_load_dword v18, v19, s[4:7], s33 offen offset:0 sc1
s_waitcnt vmcnt(0)
v_cmp_gt_u32 vcc, 1, v18
s_cbranch_vccz Lpd_9252
s_sleep 8
s_sub_u32 s101, s101, 1
s_cbranch_scc0 Lp_9251
s_mov_b32 s101, 0
Lpd_9252:
s_branch M_rjoin
PAD_21:
s_cbranch_execz PAD_25
M_V:
v_mfma_f32_16x16x32_bf16 v[32:35], a[0:3], a[128:131], 0
s_add_u32 m0, s29, 114688
ds_read_b64_tr_b16 a[136:137], v5 offset:0
v_mfma_f32_16x16x32_bf16 v[32:35], a[4:7], a[132:135], v[32:35]
s_mov_b32 s32, 1024
buffer_load_dwordx4 v16, s[12:15], s27 offen offset:0 lds
v_mfma_f32_16x16x32_bf16 v[36:39], a[8:11], a[128:131], 0
s_mov_b32 s33, 31744
ds_read_b64_tr_b16 a[138:139], v5 offset:2048
v_mfma_f32_16x16x32_bf16 v[36:39], a[12:15], a[132:135], v[36:39]
s_mov_b32 s34, 4294935552
v_mfma_f32_16x16x32_bf16 v[40:43], a[16:19], a[128:131], 0
s_mov_b32 s35, 4294935552
ds_read_b64_tr_b16 a[140:141], v5 offset:16384
v_mfma_f32_16x16x32_bf16 v[40:43], a[20:23], a[132:135], v[40:43]
s_mov_b32 s36, 4294935552
buffer_load_dwordx4 v17, s[12:15], s27 offen offset:1024 lds
v_mfma_f32_16x16x32_bf16 v[44:47], a[24:27], a[128:131], 0
s_mov_b32 s30, 8
ds_read_b64_tr_b16 a[142:143], v5 offset:18432
v_mfma_f32_16x16x32_bf16 v[44:47], a[28:31], a[132:135], v[44:47]
s_mov_b32 s82, 3221225472
v_mfma_f32_16x16x32_bf16 v[48:51], a[32:35], a[128:131], 0
s_mul_hi_u32 s38, s2, 613566757
v_mfma_f32_16x16x32_bf16 v[48:51], a[36:39], a[132:135], v[48:51]
s_mul_i32 s39, s38, 7
buffer_load_dwordx4 v18, s[12:15], s27 offen offset:2048 lds
v_mfma_f32_16x16x32_bf16 v[52:55], a[40:43], a[128:131], 0
s_sub_u32 s39, s2, s39
v_mov_b32 v246, 0
v_mov_b32 v229, 0
v_mfma_f32_16x16x32_bf16 v[52:55], a[44:47], a[132:135], v[52:55]
v_mov_b32 v231, 0
v_mfma_f32_16x16x32_bf16 v[56:59], a[48:51], a[128:131], 0
s_mov_b32 s60, s90
v_mfma_f32_16x16x32_bf16 v[56:59], a[52:55], a[132:135], v[56:59]
s_mov_b32 s61, s91
buffer_load_dwordx4 v19, s[12:15], s27 offen offset:3072 lds
v_mfma_f32_16x16x32_bf16 v[60:63], a[56:59], a[128:131], 0
s_add_u32 s27, s27, 524288
v_mfma_f32_16x16x32_bf16 v[60:63], a[60:63], a[132:135], v[60:63]
s_waitcnt lgkmcnt(0)
s_mov_b32 s62, 256
v_mfma_f32_16x16x32_bf16 v[64:67], a[0:3], a[136:139], 0
s_add_u32 m0, s28, 0
ds_read_b64_tr_b16 a[128:129], v6 offset:0
v_mfma_f32_16x16x32_bf16 v[64:67], a[4:7], a[140:143], v[64:67]
s_mov_b32 s63, 0x20000
buffer_load_dwordx4 v12, s[8:11], s24 offen offset:0 lds
v_mfma_f32_16x16x32_bf16 v[68:71], a[8:11], a[136:139], 0
s_mul_hi_u32 s55, s2, 1431655766
ds_read_b64_tr_b16 a[130:131], v6 offset:2048
v_mfma_f32_16x16x32_bf16 v[68:71], a[12:15], a[140:143], v[68:71]
s_mul_i32 s55, s55, 3
v_mfma_f32_16x16x32_bf16 v[72:75], a[16:19], a[136:139], 0
s_sub_u32 s55, s2, s55
ds_read_b64_tr_b16 a[132:133], v6 offset:16384
v_mfma_f32_16x16x32_bf16 v[72:75], a[20:23], a[140:143], v[72:75]
s_add_u32 s55, s55, 5
buffer_load_dwordx4 v13, s[8:11], s24 offen offset:1024 lds
v_mfma_f32_16x16x32_bf16 v[76:79], a[24:27], a[136:139], 0
s_lshr_b32 s22, s2, 4
ds_read_b64_tr_b16 a[134:135], v6 offset:18432
v_mfma_f32_16x16x32_bf16 v[76:79], a[28:31], a[140:143], v[76:79]
s_lshl_b32 s23, s20, 5
v_mfma_f32_16x16x32_bf16 v[80:83], a[32:35], a[136:139], 0
s_add_u32 s23, s23, s22
v_mfma_f32_16x16x32_bf16 v[80:83], a[36:39], a[140:143], v[80:83]
s_lshl_b32 s23, s23, 2
buffer_load_dwordx4 v14, s[8:11], s24 offen offset:2048 lds
v_mfma_f32_16x16x32_bf16 v[84:87], a[40:43], a[136:139], 0
s_and_b32 s22, s2, 16
v_mfma_f32_16x16x32_bf16 v[84:87], a[44:47], a[140:143], v[84:87]
s_lshl_b32 s22, s22, 7
v_mfma_f32_16x16x32_bf16 v[88:91], a[48:51], a[136:139], 0
s_add_u32 s23, s23, s22
v_mov_b32 v28, 3221225472
v_writelane_b32 v28, s23, 0
v_mfma_f32_16x16x32_bf16 v[88:91], a[52:55], a[140:143], v[88:91]
s_add_u32 s56, s23, 16384
buffer_load_dwordx4 v15, s[8:11], s24 offen offset:3072 lds
v_mfma_f32_16x16x32_bf16 v[92:95], a[56:59], a[136:139], 0
s_add_u32 s24, s24, 128
v_writelane_b32 v28, s56, 1
v_mfma_f32_16x16x32_bf16 v[92:95], a[60:63], a[140:143], v[92:95]
s_waitcnt lgkmcnt(0)
s_add_u32 s56, s23, 4096
v_writelane_b32 v28, s56, 2
v_mfma_f32_16x16x32_bf16 v[96:99], a[0:3], a[128:131], 0
s_add_u32 m0, s28, 4096
ds_read_b64_tr_b16 a[136:137], v7 offset:0
v_mfma_f32_16x16x32_bf16 v[96:99], a[4:7], a[132:135], v[96:99]
s_sub_u32 s37, 15, s21
buffer_load_dwordx4 v12, s[8:11], s25 offen offset:0 lds
v_mfma_f32_16x16x32_bf16 v[100:103], a[8:11], a[128:131], 0
ds_read_b64_tr_b16 a[138:139], v7 offset:2048
v_mfma_f32_16x16x32_bf16 v[100:103], a[12:15], a[132:135], v[100:103]
v_mfma_f32_16x16x32_bf16 v[104:107], a[16:19], a[128:131], 0
ds_read_b64_tr_b16 a[140:141], v7 offset:16384
v_mfma_f32_16x16x32_bf16 v[104:107], a[20:23], a[132:135], v[104:107]
buffer_load_dwordx4 v13, s[8:11], s25 offen offset:1024 lds
v_mfma_f32_16x16x32_bf16 v[108:111], a[24:27], a[128:131], 0
ds_read_b64_tr_b16 a[142:143], v7 offset:18432
v_mfma_f32_16x16x32_bf16 v[108:111], a[28:31], a[132:135], v[108:111]
v_mfma_f32_16x16x32_bf16 v[112:115], a[32:35], a[128:131], 0
v_mfma_f32_16x16x32_bf16 v[112:115], a[36:39], a[132:135], v[112:115]
buffer_load_dwordx4 v14, s[8:11], s25 offen offset:2048 lds
v_mfma_f32_16x16x32_bf16 v[116:119], a[40:43], a[128:131], 0
v_mfma_f32_16x16x32_bf16 v[116:119], a[44:47], a[132:135], v[116:119]
v_mfma_f32_16x16x32_bf16 v[120:123], a[48:51], a[128:131], 0
v_mfma_f32_16x16x32_bf16 v[120:123], a[52:55], a[132:135], v[120:123]
buffer_load_dwordx4 v15, s[8:11], s25 offen offset:3072 lds
v_mfma_f32_16x16x32_bf16 v[124:127], a[56:59], a[128:131], 0
s_add_u32 s25, s25, 128
v_mfma_f32_16x16x32_bf16 v[124:127], a[60:63], a[132:135], v[124:127]
s_waitcnt vmcnt(17) lgkmcnt(0)
s_barrier
v_mfma_f32_16x16x32_bf16 v[128:131], a[0:3], a[136:139], 0
ds_read_b64_tr_b16 a[128:129], v8 offset:0
v_mfma_f32_16x16x32_bf16 v[128:131], a[4:7], a[140:143], v[128:131]
buffer_load_dword v21, v20, s[16:19], s43 offen
v_mfma_f32_16x16x32_bf16 v[132:135], a[8:11], a[136:139], 0
s_add_u32 s43, s43, s47
ds_read_b64_tr_b16 a[130:131], v8 offset:2048
v_mfma_f32_16x16x32_bf16 v[132:135], a[12:15], a[140:143], v[132:135]
s_cmp_ge_u32 s43, s51
v_mfma_f32_16x16x32_bf16 v[136:139], a[16:19], a[136:139], 0
s_cselect_b32 s43, 0, s43
ds_read_b64_tr_b16 a[132:133], v8 offset:16384
v_mfma_f32_16x16x32_bf16 v[136:139], a[20:23], a[140:143], v[136:139]
s_cselect_b32 s51, s42, s51
v_mfma_f32_16x16x32_bf16 v[140:143], a[24:27], a[136:139], 0
s_cselect_b64 s[16:17], s[40:41], s[16:17]
ds_read_b64_tr_b16 a[134:135], v8 offset:18432
v_mfma_f32_16x16x32_bf16 v[140:143], a[28:31], a[140:143], v[140:143]
s_cselect_b32 s18, s42, s18
v_mfma_f32_16x16x32_bf16 v[144:147], a[32:35], a[136:139], 0
s_cselect_b64 s[40:41], s[44:45], s[40:41]
ds_read_b128 a[64:67], v2 offset:32768
v_mfma_f32_16x16x32_bf16 v[144:147], a[36:39], a[140:143], v[144:147]
s_cselect_b32 s42, s46, s42
v_mfma_f32_16x16x32_bf16 v[148:151], a[40:43], a[136:139], 0
s_cselect_b32 s46, 0, s46
ds_read_b128 a[68:71], v3 offset:32768
v_mfma_f32_16x16x32_bf16 v[148:151], a[44:47], a[140:143], v[148:151]
ds_read_b128 a[72:75], v2 offset:34816
v_mfma_f32_16x16x32_bf16 v[152:155], a[48:51], a[136:139], 0
ds_read_b128 a[76:79], v3 offset:34816
v_mfma_f32_16x16x32_bf16 v[152:155], a[52:55], a[140:143], v[152:155]
buffer_load_dword v21, v20, s[16:19], s43 offen
v_mfma_f32_16x16x32_bf16 v[156:159], a[56:59], a[136:139], 0
s_add_u32 s43, s43, s47
ds_read_b128 a[80:83], v2 offset:36864
v_mfma_f32_16x16x32_bf16 v[156:159], a[60:63], a[140:143], v[156:159]
s_waitcnt lgkmcnt(5)
s_cmp_ge_u32 s43, s51
ds_read_b128 a[84:87], v3 offset:36864
v_mfma_f32_16x16x32_bf16 v[160:163], a[0:3], a[128:131], 0
s_cselect_b32 s43, 0, s43
ds_read_b64_tr_b16 a[136:137], v9 offset:0
v_mfma_f32_16x16x32_bf16 v[160:163], a[4:7], a[132:135], v[160:163]
s_cselect_b32 s51, s42, s51
v_mfma_f32_16x16x32_bf16 v[164:167], a[8:11], a[128:131], 0
s_cselect_b64 s[16:17], s[40:41], s[16:17]
ds_read_b64_tr_b16 a[138:139], v9 offset:2048
v_mfma_f32_16x16x32_bf16 v[164:167], a[12:15], a[132:135], v[164:167]
s_cselect_b32 s18, s42, s18
v_mfma_f32_16x16x32_bf16 v[168:171], a[16:19], a[128:131], 0
s_cselect_b64 s[40:41], s[44:45], s[40:41]
ds_read_b64_tr_b16 a[140:141], v9 offset:16384
v_mfma_f32_16x16x32_bf16 v[168:171], a[20:23], a[132:135], v[168:171]
s_cselect_b32 s42, s46, s42
v_mfma_f32_16x16x32_bf16 v[172:175], a[24:27], a[128:131], 0
s_cselect_b32 s46, 0, s46
ds_read_b64_tr_b16 a[142:143], v9 offset:18432
v_mfma_f32_16x16x32_bf16 v[172:175], a[28:31], a[132:135], v[172:175]
s_bitcmp1_b32 s2, 4
s_cselect_b32 s37, s21, s37
s_lshl_b32 s56, s37, 5
v_mfma_f32_16x16x32_bf16 v[176:179], a[32:35], a[128:131], 0
s_add_u32 s56, s56, s20
s_lshl_b32 s56, s56, 2
s_add_u32 s56, s56, 8192
v_mfma_f32_16x16x32_bf16 v[176:179], a[36:39], a[132:135], v[176:179]
v_writelane_b32 v28, s56, 3
v_mfma_f32_16x16x32_bf16 v[180:183], a[40:43], a[128:131], 0
s_add_u32 s56, s56, 2048
ds_read_b128 a[88:91], v2 offset:38912
v_writelane_b32 v28, s56, 6
v_mfma_f32_16x16x32_bf16 v[180:183], a[44:47], a[132:135], v[180:183]
s_lshl_b32 s56, s2, 2
s_add_u32 s56, s56, 12288
ds_read_b128 a[92:95], v3 offset:38912
v_mfma_f32_16x16x32_bf16 v[184:187], a[48:51], a[128:131], 0
s_waitcnt lgkmcnt(2)
ds_read_b128 a[96:99], v2 offset:40960
v_writelane_b32 v28, s56, 4
v_mfma_f32_16x16x32_bf16 v[184:187], a[52:55], a[132:135], v[184:187]
s_lshl_b32 s56, s39, 5
s_add_u32 s56, s56, s38
s_lshl_b32 s56, s56, 2
v_mfma_f32_16x16x32_bf16 v[188:191], a[56:59], a[128:131], 0
s_add_u32 s56, s56, 20480
s_cmp_lt_u32 s2, 224
ds_read_b128 a[100:103], v3 offset:40960
v_mfma_f32_16x16x32_bf16 v[188:191], a[60:63], a[132:135], v[188:191]
s_cselect_b32 s56, s56, 3221225472
ds_read_b128 a[104:107], v2 offset:43008
v_writelane_b32 v28, s56, 7
v_mfma_f32_16x16x32_bf16 v[192:195], a[0:3], a[136:139], 0
s_cmp_eq_u32 s3, 0
s_cselect_b32 s56, 94371840, 3221225472
ds_read_b64_tr_b16 a[128:129], v10 offset:0
v_mfma_f32_16x16x32_bf16 v[192:195], a[4:7], a[140:143], v[192:195]
buffer_store_dword v246, v28, s[4:7], s56 offen sc1
v_mfma_f32_16x16x32_bf16 v[196:199], a[8:11], a[136:139], 0
ds_read_b64_tr_b16 a[130:131], v10 offset:2048
v_mov_b32 v27, 1
v_mfma_f32_16x16x32_bf16 v[196:199], a[12:15], a[140:143], v[196:199]
v_cmp_eq_u32 vcc, 0, v0
v_mov_b32 v26, 3221225472
v_mfma_f32_16x16x32_bf16 v[200:203], a[16:19], a[136:139], 0
s_lshl_b32 s31, s20, 20
s_lshl_b32 s22, s21, 17
ds_read_b64_tr_b16 a[132:133], v10 offset:16384
v_mfma_f32_16x16x32_bf16 v[200:203], a[20:23], a[140:143], v[200:203]
v_cndmask_b32 v26, v26, v246, vcc
v_mfma_f32_16x16x32_bf16 v[204:207], a[24:27], a[136:139], 0
s_add_u32 s31, s31, s22
s_lshr_b32 s22, s3, 1
ds_read_b64_tr_b16 a[134:135], v10 offset:18432
v_mfma_f32_16x16x32_bf16 v[204:207], a[28:31], a[140:143], v[204:207]
s_lshl_b32 s22, s22, 16
s_add_u32 s31, s31, s22
s_and_b32 s22, s3, 1
v_mfma_f32_16x16x32_bf16 v[208:211], a[32:35], a[136:139], 0
s_lshl_b32 s22, s22, 14
s_add_u32 s31, s31, s22
s_add_u32 s31, s31, 16777216
v_mfma_f32_16x16x32_bf16 v[208:211], a[36:39], a[140:143], v[208:211]
v_mfma_f32_16x16x32_bf16 v[212:215], a[40:43], a[136:139], 0
ds_read_b128 a[108:111], v3 offset:43008
v_mfma_f32_16x16x32_bf16 v[212:215], a[44:47], a[140:143], v[212:215]
ds_read_b128 a[112:115], v2 offset:45056
v_mfma_f32_16x16x32_bf16 v[216:219], a[48:51], a[136:139], 0
ds_read_b128 a[116:119], v3 offset:45056
v_mfma_f32_16x16x32_bf16 v[216:219], a[52:55], a[140:143], v[216:219]
v_mfma_f32_16x16x32_bf16 v[220:223], a[56:59], a[136:139], 0
ds_read_b128 a[120:123], v2 offset:47104
v_mfma_f32_16x16x32_bf16 v[220:223], a[60:63], a[140:143], v[220:223]
s_waitcnt lgkmcnt(4)
ds_read_b128 a[124:127], v3 offset:47104
v_mfma_f32_16x16x32_bf16 a[192:195], a[0:3], a[128:131], 0
ds_read_b64_tr_b16 a[136:137], v11 offset:0
v_mfma_f32_16x16x32_bf16 a[192:195], a[4:7], a[132:135], a[192:195]
PAD_22:
s_cbranch_execz PAD_26
v_mfma_f32_16x16x32_bf16 a[196:199], a[8:11], a[128:131], 0
ds_read_b64_tr_b16 a[138:139], v11 offset:2048
v_mfma_f32_16x16x32_bf16 a[196:199], a[12:15], a[132:135], a[196:199]
v_mfma_f32_16x16x32_bf16 a[200:203], a[16:19], a[128:131], 0
ds_read_b64_tr_b16 a[140:141], v11 offset:16384
v_mfma_f32_16x16x32_bf16 a[200:203], a[20:23], a[132:135], a[200:203]
v_mfma_f32_16x16x32_bf16 a[204:207], a[24:27], a[128:131], 0
ds_read_b64_tr_b16 a[142:143], v11 offset:18432
v_mfma_f32_16x16x32_bf16 a[204:207], a[28:31], a[132:135], a[204:207]
v_mfma_f32_16x16x32_bf16 a[208:211], a[32:35], a[128:131], 0
v_mfma_f32_16x16x32_bf16 a[208:211], a[36:39], a[132:135], a[208:211]
v_mfma_f32_16x16x32_bf16 a[212:215], a[40:43], a[128:131], 0
v_mfma_f32_16x16x32_bf16 a[212:215], a[44:47], a[132:135], a[212:215]
v_mfma_f32_16x16x32_bf16 a[216:219], a[48:51], a[128:131], 0
v_mfma_f32_16x16x32_bf16 a[216:219], a[52:55], a[132:135], a[216:219]
v_mfma_f32_16x16x32_bf16 a[220:223], a[56:59], a[128:131], 0
s_waitcnt vmcnt(3) lgkmcnt(0)
v_mfma_f32_16x16x32_bf16 a[220:223], a[60:63], a[132:135], a[220:223]
s_barrier
v_mfma_f32_16x16x32_bf16 a[224:227], a[0:3], a[136:139], 0
s_add_u32 m0, s29, 65536
ds_read_b64_tr_b16 a[128:129], v4 offset:32768
v_mfma_f32_16x16x32_bf16 a[224:227], a[4:7], a[140:143], a[224:227]
buffer_load_dwordx4 v16, s[12:15], s26 offen offset:0 lds
v_mfma_f32_16x16x32_bf16 a[228:231], a[8:11], a[136:139], 0
ds_read_b64_tr_b16 a[130:131], v4 offset:34816
v_mfma_f32_16x16x32_bf16 a[228:231], a[12:15], a[140:143], a[228:231]
v_mfma_f32_16x16x32_bf16 a[232:235], a[16:19], a[136:139], 0
ds_read_b64_tr_b16 a[132:133], v4 offset:49152
v_mfma_f32_16x16x32_bf16 a[232:235], a[20:23], a[140:143], a[232:235]
buffer_load_dwordx4 v17, s[12:15], s26 offen offset:1024 lds
v_mfma_f32_16x16x32_bf16 a[236:239], a[24:27], a[136:139], 0
ds_read_b64_tr_b16 a[134:135], v4 offset:51200
v_mfma_f32_16x16x32_bf16 a[236:239], a[28:31], a[140:143], a[236:239]
v_mfma_f32_16x16x32_bf16 a[240:243], a[32:35], a[136:139], 0
v_mfma_f32_16x16x32_bf16 a[240:243], a[36:39], a[140:143], a[240:243]
buffer_load_dwordx4 v18, s[12:15], s26 offen offset:2048 lds
v_mfma_f32_16x16x32_bf16 a[244:247], a[40:43], a[136:139], 0
v_mfma_f32_16x16x32_bf16 a[244:247], a[44:47], a[140:143], a[244:247]
v_mfma_f32_16x16x32_bf16 a[248:251], a[48:51], a[136:139], 0
v_mfma_f32_16x16x32_bf16 a[248:251], a[52:55], a[140:143], a[248:251]
buffer_load_dwordx4 v19, s[12:15], s26 offen offset:3072 lds
v_mfma_f32_16x16x32_bf16 a[252:255], a[56:59], a[136:139], 0
s_add_u32 s26, s26, 524288
v_mfma_f32_16x16x32_bf16 a[252:255], a[60:63], a[140:143], a[252:255]
s_waitcnt lgkmcnt(0)
Lg_501:
v_mfma_f32_16x16x32_bf16 v[32:35], a[64:67], a[128:131], v[32:35]
s_add_u32 m0, s29, 81920
ds_read_b64_tr_b16 a[136:137], v5 offset:32768
v_mfma_f32_16x16x32_bf16 v[32:35], a[68:71], a[132:135], v[32:35]
buffer_load_dwordx4 v16, s[12:15], s27 offen offset:0 lds
v_mfma_f32_16x16x32_bf16 v[36:39], a[72:75], a[128:131], v[36:39]
ds_read_b64_tr_b16 a[138:139], v5 offset:34816
v_mfma_f32_16x16x32_bf16 v[36:39], a[76:79], a[132:135], v[36:39]
v_mfma_f32_16x16x32_bf16 v[40:43], a[80:83], a[128:131], v[40:43]
ds_read_b64_tr_b16 a[140:141], v5 offset:49152
v_mfma_f32_16x16x32_bf16 v[40:43], a[84:87], a[132:135], v[40:43]
buffer_load_dwordx4 v17, s[12:15], s27 offen offset:1024 lds
v_mfma_f32_16x16x32_bf16 v[44:47], a[88:91], a[128:131], v[44:47]
ds_read_b64_tr_b16 a[142:143], v5 offset:51200
v_mfma_f32_16x16x32_bf16 v[44:47], a[92:95], a[132:135], v[44:47]
v_mfma_f32_16x16x32_bf16 v[48:51], a[96:99], a[128:131], v[48:51]
ds_read_b128 a[0:3], v2 offset:0
v_mfma_f32_16x16x32_bf16 v[48:51], a[100:103], a[132:135], v[48:51]
buffer_load_dwordx4 v18, s[12:15], s27 offen offset:2048 lds
v_mfma_f32_16x16x32_bf16 v[52:55], a[104:107], a[128:131], v[52:55]
ds_read_b128 a[4:7], v3 offset:0
v_mfma_f32_16x16x32_bf16 v[52:55], a[108:111], a[132:135], v[52:55]
v_mfma_f32_16x16x32_bf16 v[56:59], a[112:115], a[128:131], v[56:59]
v_mfma_f32_16x16x32_bf16 v[56:59], a[116:119], a[132:135], v[56:59]
buffer_load_dwordx4 v19, s[12:15], s27 offen offset:3072 lds
v_mfma_f32_16x16x32_bf16 v[60:63], a[120:123], a[128:131], v[60:63]
s_add_u32 s27, s27, 524288
ds_read_b128 a[8:11], v2 offset:2048
v_mfma_f32_16x16x32_bf16 v[60:63], a[124:127], a[132:135], v[60:63]
s_waitcnt lgkmcnt(3)
v_mfma_f32_16x16x32_bf16 v[64:67], a[64:67], a[136:139], v[64:67]
s_add_u32 m0, s28, 32768
ds_read_b64_tr_b16 a[128:129], v6 offset:32768
v_mfma_f32_16x16x32_bf16 v[64:67], a[68:71], a[140:143], v[64:67]
buffer_load_dwordx4 v12, s[8:11], s24 offen offset:0 lds
v_mfma_f32_16x16x32_bf16 v[68:71], a[72:75], a[136:139], v[68:71]
ds_read_b64_tr_b16 a[130:131], v6 offset:34816
v_mfma_f32_16x16x32_bf16 v[68:71], a[76:79], a[140:143], v[68:71]
v_mfma_f32_16x16x32_bf16 v[72:75], a[80:83], a[136:139], v[72:75]
ds_read_b64_tr_b16 a[132:133], v6 offset:49152
v_mfma_f32_16x16x32_bf16 v[72:75], a[84:87], a[140:143], v[72:75]
buffer_load_dwordx4 v13, s[8:11], s24 offen offset:1024 lds
v_mfma_f32_16x16x32_bf16 v[76:79], a[88:91], a[136:139], v[76:79]
ds_read_b64_tr_b16 a[134:135], v6 offset:51200
v_mfma_f32_16x16x32_bf16 v[76:79], a[92:95], a[140:143], v[76:79]
v_mfma_f32_16x16x32_bf16 v[80:83], a[96:99], a[136:139], v[80:83]
ds_read_b128 a[12:15], v3 offset:2048
v_mfma_f32_16x16x32_bf16 v[80:83], a[100:103], a[140:143], v[80:83]
buffer_load_dwordx4 v14, s[8:11], s24 offen offset:2048 lds
v_mfma_f32_16x16x32_bf16 v[84:87], a[104:107], a[136:139], v[84:87]
v_mfma_f32_16x16x32_bf16 v[84:87], a[108:111], a[140:143], v[84:87]
v_mfma_f32_16x16x32_bf16 v[88:91], a[112:115], a[136:139], v[88:91]
ds_read_b128 a[16:19], v2 offset:4096
v_mfma_f32_16x16x32_bf16 v[88:91], a[116:119], a[140:143], v[88:91]
buffer_load_dwordx4 v15, s[8:11], s24 offen offset:3072 lds
v_mfma_f32_16x16x32_bf16 v[92:95], a[120:123], a[136:139], v[92:95]
s_add_u32 s24, s24, 128
ds_read_b128 a[20:23], v3 offset:4096
v_mfma_f32_16x16x32_bf16 v[92:95], a[124:127], a[140:143], v[92:95]
s_waitcnt lgkmcnt(3)
v_mfma_f32_16x16x32_bf16 v[96:99], a[64:67], a[128:131], v[96:99]
s_add_u32 m0, s28, 36864
ds_read_b64_tr_b16 a[136:137], v7 offset:32768
v_mfma_f32_16x16x32_bf16 v[96:99], a[68:71], a[132:135], v[96:99]
buffer_load_dwordx4 v12, s[8:11], s25 offen offset:0 lds
v_mfma_f32_16x16x32_bf16 v[100:103], a[72:75], a[128:131], v[100:103]
ds_read_b64_tr_b16 a[138:139], v7 offset:34816
v_mfma_f32_16x16x32_bf16 v[100:103], a[76:79], a[132:135], v[100:103]
v_mfma_f32_16x16x32_bf16 v[104:107], a[80:83], a[128:131], v[104:107]
ds_read_b64_tr_b16 a[140:141], v7 offset:49152
v_mfma_f32_16x16x32_bf16 v[104:107], a[84:87], a[132:135], v[104:107]
buffer_load_dwordx4 v13, s[8:11], s25 offen offset:1024 lds
v_mfma_f32_16x16x32_bf16 v[108:111], a[88:91], a[128:131], v[108:111]
ds_read_b64_tr_b16 a[142:143], v7 offset:51200
v_mfma_f32_16x16x32_bf16 v[108:111], a[92:95], a[132:135], v[108:111]
v_mfma_f32_16x16x32_bf16 v[112:115], a[96:99], a[128:131], v[112:115]
v_mfma_f32_16x16x32_bf16 v[112:115], a[100:103], a[132:135], v[112:115]
buffer_load_dwordx4 v14, s[8:11], s25 offen offset:2048 lds
v_mfma_f32_16x16x32_bf16 v[116:119], a[104:107], a[128:131], v[116:119]
ds_read_b128 a[24:27], v2 offset:6144
v_mfma_f32_16x16x32_bf16 v[116:119], a[108:111], a[132:135], v[116:119]
v_mfma_f32_16x16x32_bf16 v[120:123], a[112:115], a[128:131], v[120:123]
ds_read_b128 a[28:31], v3 offset:6144
v_mfma_f32_16x16x32_bf16 v[120:123], a[116:119], a[132:135], v[120:123]
buffer_load_dwordx4 v15, s[8:11], s25 offen offset:3072 lds
v_mfma_f32_16x16x32_bf16 v[124:127], a[120:123], a[128:131], v[124:127]
s_add_u32 s25, s25, 128
v_mfma_f32_16x16x32_bf16 v[124:127], a[124:127], a[132:135], v[124:127]
s_waitcnt lgkmcnt(2)
v_mfma_f32_16x16x32_bf16 v[128:131], a[64:67], a[136:139], v[128:131]
ds_read_b64_tr_b16 a[128:129], v8 offset:32768
v_mfma_f32_16x16x32_bf16 v[128:131], a[68:71], a[140:143], v[128:131]
buffer_load_dword v21, v20, s[16:19], s43 offen
v_mfma_f32_16x16x32_bf16 v[132:135], a[72:75], a[136:139], v[132:135]
s_add_u32 s43, s43, s47
ds_read_b64_tr_b16 a[130:131], v8 offset:34816
v_mfma_f32_16x16x32_bf16 v[132:135], a[76:79], a[140:143], v[132:135]
s_cmp_ge_u32 s43, s51
v_mfma_f32_16x16x32_bf16 v[136:139], a[80:83], a[136:139], v[136:139]
s_cselect_b32 s43, 0, s43
ds_read_b64_tr_b16 a[132:133], v8 offset:49152
v_mfma_f32_16x16x32_bf16 v[136:139], a[84:87], a[140:143], v[136:139]
s_cselect_b32 s51, s42, s51
v_mfma_f32_16x16x32_bf16 v[140:143], a[88:91], a[136:139], v[140:143]
s_cselect_b64 s[16:17], s[40:41], s[16:17]
ds_read_b64_tr_b16 a[134:135], v8 offset:51200
v_mfma_f32_16x16x32_bf16 v[140:143], a[92:95], a[140:143], v[140:143]
s_cselect_b32 s18, s42, s18
v_mfma_f32_16x16x32_bf16 v[144:147], a[96:99], a[136:139], v[144:147]
s_cselect_b64 s[40:41], s[44:45], s[40:41]
ds_read_b128 a[32:35], v2 offset:8192
v_mfma_f32_16x16x32_bf16 v[144:147], a[100:103], a[140:143], v[144:147]
s_cselect_b32 s42, s46, s42
v_mfma_f32_16x16x32_bf16 v[148:151], a[104:107], a[136:139], v[148:151]
s_cselect_b32 s46, 0, s46
v_mfma_f32_16x16x32_bf16 v[148:151], a[108:111], a[140:143], v[148:151]
s_cmp_eq_u32 s30, s55
v_mfma_f32_16x16x32_bf16 v[152:155], a[112:115], a[136:139], v[152:155]
s_cselect_b32 s22, 0, 3221225472
ds_read_b128 a[36:39], v3 offset:8192
v_mfma_f32_16x16x32_bf16 v[152:155], a[116:119], a[140:143], v[152:155]
s_sub_u32 s30, s30, 1
buffer_atomic_add v27, v26, s[60:63], s22 offen sc1
v_mfma_f32_16x16x32_bf16 v[156:159], a[120:123], a[136:139], v[156:159]
ds_read_b128 a[40:43], v2 offset:10240
v_mfma_f32_16x16x32_bf16 v[156:159], a[124:127], a[140:143], v[156:159]
s_waitcnt lgkmcnt(3)
v_mfma_f32_16x16x32_bf16 v[160:163], a[64:67], a[128:131], v[160:163]
ds_read_b64_tr_b16 a[136:137], v9 offset:32768
v_mfma_f32_16x16x32_bf16 v[160:163], a[68:71], a[132:135], v[160:163]
v_mfma_f32_16x16x32_bf16 v[164:167], a[72:75], a[128:131], v[164:167]
ds_read_b64_tr_b16 a[138:139], v9 offset:34816
v_mfma_f32_16x16x32_bf16 v[164:167], a[76:79], a[132:135], v[164:167]
v_mfma_f32_16x16x32_bf16 v[168:171], a[80:83], a[128:131], v[168:171]
ds_read_b64_tr_b16 a[140:141], v9 offset:49152
v_mfma_f32_16x16x32_bf16 v[168:171], a[84:87], a[132:135], v[168:171]
v_mfma_f32_16x16x32_bf16 v[172:175], a[88:91], a[128:131], v[172:175]
ds_read_b64_tr_b16 a[142:143], v9 offset:51200
v_mfma_f32_16x16x32_bf16 v[172:175], a[92:95], a[132:135], v[172:175]
v_mfma_f32_16x16x32_bf16 v[176:179], a[96:99], a[128:131], v[176:179]
v_mfma_f32_16x16x32_bf16 v[176:179], a[100:103], a[132:135], v[176:179]
v_mfma_f32_16x16x32_bf16 v[180:183], a[104:107], a[128:131], v[180:183]
ds_read_b128 a[44:47], v3 offset:10240
v_mfma_f32_16x16x32_bf16 v[180:183], a[108:111], a[132:135], v[180:183]
v_mfma_f32_16x16x32_bf16 v[184:187], a[112:115], a[128:131], v[184:187]
ds_read_b128 a[48:51], v2 offset:12288
v_mfma_f32_16x16x32_bf16 v[184:187], a[116:119], a[132:135], v[184:187]
v_mfma_f32_16x16x32_bf16 v[188:191], a[120:123], a[128:131], v[188:191]
v_mfma_f32_16x16x32_bf16 v[188:191], a[124:127], a[132:135], v[188:191]
s_waitcnt lgkmcnt(2)
v_mfma_f32_16x16x32_bf16 v[192:195], a[64:67], a[136:139], v[192:195]
ds_read_b64_tr_b16 a[128:129], v10 offset:32768
v_mfma_f32_16x16x32_bf16 v[192:195], a[68:71], a[140:143], v[192:195]
v_mfma_f32_16x16x32_bf16 v[196:199], a[72:75], a[136:139], v[196:199]
ds_read_b64_tr_b16 a[130:131], v10 offset:34816
v_mfma_f32_16x16x32_bf16 v[196:199], a[76:79], a[140:143], v[196:199]
v_mfma_f32_16x16x32_bf16 v[200:203], a[80:83], a[136:139], v[200:203]
ds_read_b64_tr_b16 a[132:133], v10 offset:49152
v_mfma_f32_16x16x32_bf16 v[200:203], a[84:87], a[140:143], v[200:203]
v_mfma_f32_16x16x32_bf16 v[204:207], a[88:91], a[136:139], v[204:207]
ds_read_b64_tr_b16 a[134:135], v10 offset:51200
v_mfma_f32_16x16x32_bf16 v[204:207], a[92:95], a[140:143], v[204:207]
v_mfma_f32_16x16x32_bf16 v[208:211], a[96:99], a[136:139], v[208:211]
ds_read_b128 a[52:55], v3 offset:12288
v_mfma_f32_16x16x32_bf16 v[208:211], a[100:103], a[140:143], v[208:211]
v_mfma_f32_16x16x32_bf16 v[212:215], a[104:107], a[136:139], v[212:215]
ds_read_b128 a[56:59], v2 offset:14336
v_mfma_f32_16x16x32_bf16 v[212:215], a[108:111], a[140:143], v[212:215]
v_mfma_f32_16x16x32_bf16 v[216:219], a[112:115], a[136:139], v[216:219]
v_mfma_f32_16x16x32_bf16 v[216:219], a[116:119], a[140:143], v[216:219]
v_mfma_f32_16x16x32_bf16 v[220:223], a[120:123], a[136:139], v[220:223]
ds_read_b128 a[60:63], v3 offset:14336
v_mfma_f32_16x16x32_bf16 v[220:223], a[124:127], a[140:143], v[220:223]
s_waitcnt lgkmcnt(3)
v_mfma_f32_16x16x32_bf16 a[192:195], a[64:67], a[128:131], a[192:195]
ds_read_b64_tr_b16 a[136:137], v11 offset:32768
v_mfma_f32_16x16x32_bf16 a[192:195], a[68:71], a[132:135], a[192:195]
v_mfma_f32_16x16x32_bf16 a[196:199], a[72:75], a[128:131], a[196:199]
ds_read_b64_tr_b16 a[138:139], v11 offset:34816
v_mfma_f32_16x16x32_bf16 a[196:199], a[76:79], a[132:135], a[196:199]
v_mfma_f32_16x16x32_bf16 a[200:203], a[80:83], a[128:131], a[200:203]
ds_read_b64_tr_b16 a[140:141], v11 offset:49152
v_mfma_f32_16x16x32_bf16 a[200:203], a[84:87], a[132:135], a[200:203]
v_mfma_f32_16x16x32_bf16 a[204:207], a[88:91], a[128:131], a[204:207]
ds_read_b64_tr_b16 a[142:143], v11 offset:51200
v_mfma_f32_16x16x32_bf16 a[204:207], a[92:95], a[132:135], a[204:207]
v_mfma_f32_16x16x32_bf16 a[208:211], a[96:99], a[128:131], a[208:211]
v_mfma_f32_16x16x32_bf16 a[208:211], a[100:103], a[132:135], a[208:211]
v_mfma_f32_16x16x32_bf16 a[212:215], a[104:107], a[128:131], a[212:215]
v_mfma_f32_16x16x32_bf16 a[212:215], a[108:111], a[132:135], a[212:215]
v_mfma_f32_16x16x32_bf16 a[216:219], a[112:115], a[128:131], a[216:219]
v_mfma_f32_16x16x32_bf16 a[216:219], a[116:119], a[132:135], a[216:219]
v_mfma_f32_16x16x32_bf16 a[220:223], a[120:123], a[128:131], a[220:223]
s_waitcnt vmcnt(2) lgkmcnt(0)
v_mfma_f32_16x16x32_bf16 a[220:223], a[124:127], a[132:135], a[220:223]
s_barrier
v_mfma_f32_16x16x32_bf16 a[224:227], a[64:67], a[136:139], a[224:227]
s_add_u32 m0, s29, 98304
ds_read_b64_tr_b16 a[128:129], v4 offset:0
v_mfma_f32_16x16x32_bf16 a[224:227], a[68:71], a[140:143], a[224:227]
buffer_load_dwordx4 v16, s[12:15], s26 offen offset:0 lds
v_mfma_f32_16x16x32_bf16 a[228:231], a[72:75], a[136:139], a[228:231]
ds_read_b64_tr_b16 a[130:131], v4 offset:2048
v_mfma_f32_16x16x32_bf16 a[228:231], a[76:79], a[140:143], a[228:231]
v_mfma_f32_16x16x32_bf16 a[232:235], a[80:83], a[136:139], a[232:235]
ds_read_b64_tr_b16 a[132:133], v4 offset:16384
v_mfma_f32_16x16x32_bf16 a[232:235], a[84:87], a[140:143], a[232:235]
buffer_load_dwordx4 v17, s[12:15], s26 offen offset:1024 lds
v_mfma_f32_16x16x32_bf16 a[236:239], a[88:91], a[136:139], a[236:239]
ds_read_b64_tr_b16 a[134:135], v4 offset:18432
v_mfma_f32_16x16x32_bf16 a[236:239], a[92:95], a[140:143], a[236:239]
v_mfma_f32_16x16x32_bf16 a[240:243], a[96:99], a[136:139], a[240:243]
v_mfma_f32_16x16x32_bf16 a[240:243], a[100:103], a[140:143], a[240:243]
buffer_load_dwordx4 v18, s[12:15], s26 offen offset:2048 lds
v_mfma_f32_16x16x32_bf16 a[244:247], a[104:107], a[136:139], a[244:247]
v_mfma_f32_16x16x32_bf16 a[244:247], a[108:111], a[140:143], a[244:247]
v_mfma_f32_16x16x32_bf16 a[248:251], a[112:115], a[136:139], a[248:251]
v_mfma_f32_16x16x32_bf16 a[248:251], a[116:119], a[140:143], a[248:251]
buffer_load_dwordx4 v19, s[12:15], s26 offen offset:3072 lds
v_mfma_f32_16x16x32_bf16 a[252:255], a[120:123], a[136:139], a[252:255]
s_add_u32 s26, s26, 524288
v_mfma_f32_16x16x32_bf16 a[252:255], a[124:127], a[140:143], a[252:255]
s_waitcnt lgkmcnt(0)
buffer_store_dword v27, v26, s[4:7], s82 offen sc1
v_mfma_f32_16x16x32_bf16 v[32:35], a[0:3], a[128:131], v[32:35]
s_add_u32 m0, s29, 114688
ds_read_b64_tr_b16 a[136:137], v5 offset:0
v_mfma_f32_16x16x32_bf16 v[32:35], a[4:7], a[132:135], v[32:35]
buffer_load_dwordx4 v16, s[12:15], s27 offen offset:0 lds
v_mfma_f32_16x16x32_bf16 v[36:39], a[8:11], a[128:131], v[36:39]
ds_read_b64_tr_b16 a[138:139], v5 offset:2048
v_mfma_f32_16x16x32_bf16 v[36:39], a[12:15], a[132:135], v[36:39]
v_mfma_f32_16x16x32_bf16 v[40:43], a[16:19], a[128:131], v[40:43]
ds_read_b64_tr_b16 a[140:141], v5 offset:16384
v_mfma_f32_16x16x32_bf16 v[40:43], a[20:23], a[132:135], v[40:43]
buffer_load_dwordx4 v17, s[12:15], s27 offen offset:1024 lds
v_mfma_f32_16x16x32_bf16 v[44:47], a[24:27], a[128:131], v[44:47]
ds_read_b64_tr_b16 a[142:143], v5 offset:18432
v_mfma_f32_16x16x32_bf16 v[44:47], a[28:31], a[132:135], v[44:47]
v_mfma_f32_16x16x32_bf16 v[48:51], a[32:35], a[128:131], v[48:51]
ds_read_b128 a[64:67], v2 offset:32768
v_mfma_f32_16x16x32_bf16 v[48:51], a[36:39], a[132:135], v[48:51]
buffer_load_dwordx4 v18, s[12:15], s27 offen offset:2048 lds
v_mfma_f32_16x16x32_bf16 v[52:55], a[40:43], a[128:131], v[52:55]
ds_read_b128 a[68:71], v3 offset:32768
v_mfma_f32_16x16x32_bf16 v[52:55], a[44:47], a[132:135], v[52:55]
v_mfma_f32_16x16x32_bf16 v[56:59], a[48:51], a[128:131], v[56:59]
v_mfma_f32_16x16x32_bf16 v[56:59], a[52:55], a[132:135], v[56:59]
buffer_load_dwordx4 v19, s[12:15], s27 offen offset:3072 lds
v_mfma_f32_16x16x32_bf16 v[60:63], a[56:59], a[128:131], v[60:63]
s_add_u32 s27, s27, 524288
ds_read_b128 a[72:75], v2 offset:34816
v_mfma_f32_16x16x32_bf16 v[60:63], a[60:63], a[132:135], v[60:63]
s_waitcnt lgkmcnt(3)
v_mfma_f32_16x16x32_bf16 v[64:67], a[0:3], a[136:139], v[64:67]
s_add_u32 m0, s28, 0
ds_read_b64_tr_b16 a[128:129], v6 offset:0
v_mfma_f32_16x16x32_bf16 v[64:67], a[4:7], a[140:143], v[64:67]
buffer_load_dwordx4 v12, s[8:11], s24 offen offset:0 lds
v_mfma_f32_16x16x32_bf16 v[68:71], a[8:11], a[136:139], v[68:71]
ds_read_b64_tr_b16 a[130:131], v6 offset:2048
v_mfma_f32_16x16x32_bf16 v[68:71], a[12:15], a[140:143], v[68:71]
v_mfma_f32_16x16x32_bf16 v[72:75], a[16:19], a[136:139], v[72:75]
ds_read_b64_tr_b16 a[132:133], v6 offset:16384
v_mfma_f32_16x16x32_bf16 v[72:75], a[20:23], a[140:143], v[72:75]
buffer_load_dwordx4 v13, s[8:11], s24 offen offset:1024 lds
v_mfma_f32_16x16x32_bf16 v[76:79], a[24:27], a[136:139], v[76:79]
ds_read_b64_tr_b16 a[134:135], v6 offset:18432
v_mfma_f32_16x16x32_bf16 v[76:79], a[28:31], a[140:143], v[76:79]
v_mfma_f32_16x16x32_bf16 v[80:83], a[32:35], a[136:139], v[80:83]
ds_read_b128 a[76:79], v3 offset:34816
v_mfma_f32_16x16x32_bf16 v[80:83], a[36:39], a[140:143], v[80:83]
buffer_load_dwordx4 v14, s[8:11], s24 offen offset:2048 lds
v_mfma_f32_16x16x32_bf16 v[84:87], a[40:43], a[136:139], v[84:87]
v_mfma_f32_16x16x32_bf16 v[84:87], a[44:47], a[140:143], v[84:87]
v_mfma_f32_16x16x32_bf16 v[88:91], a[48:51], a[136:139], v[88:91]
ds_read_b128 a[80:83], v2 offset:36864
v_mfma_f32_16x16x32_bf16 v[88:91], a[52:55], a[140:143], v[88:91]
buffer_load_dwordx4 v15, s[8:11], s24 offen offset:3072 lds
v_mfma_f32_16x16x32_bf16 v[92:95], a[56:59], a[136:139], v[92:95]
s_add_u32 s24, s24, 128
ds_read_b128 a[84:87], v3 offset:36864
v_mfma_f32_16x16x32_bf16 v[92:95], a[60:63], a[140:143], v[92:95]
s_waitcnt lgkmcnt(3)
v_mfma_f32_16x16x32_bf16 v[96:99], a[0:3], a[128:131], v[96:99]
s_add_u32 m0, s28, 4096
ds_read_b64_tr_b16 a[136:137], v7 offset:0
v_mfma_f32_16x16x32_bf16 v[96:99], a[4:7], a[132:135], v[96:99]
buffer_load_dwordx4 v12, s[8:11], s25 offen offset:0 lds
v_mfma_f32_16x16x32_bf16 v[100:103], a[8:11], a[128:131], v[100:103]
ds_read_b64_tr_b16 a[138:139], v7 offset:2048
v_mfma_f32_16x16x32_bf16 v[100:103], a[12:15], a[132:135], v[100:103]
v_mfma_f32_16x16x32_bf16 v[104:107], a[16:19], a[128:131], v[104:107]
ds_read_b64_tr_b16 a[140:141], v7 offset:16384
v_mfma_f32_16x16x32_bf16 v[104:107], a[20:23], a[132:135], v[104:107]
buffer_load_dwordx4 v13, s[8:11], s25 offen offset:1024 lds
v_mfma_f32_16x16x32_bf16 v[108:111], a[24:27], a[128:131], v[108:111]
ds_read_b64_tr_b16 a[142:143], v7 offset:18432
v_mfma_f32_16x16x32_bf16 v[108:111], a[28:31], a[132:135], v[108:111]
v_mfma_f32_16x16x32_bf16 v[112:115], a[32:35], a[128:131], v[112:115]
v_mfma_f32_16x16x32_bf16 v[112:115], a[36:39], a[132:135], v[112:115]
buffer_load_dwordx4 v14, s[8:11], s25 offen offset:2048 lds
v_mfma_f32_16x16x32_bf16 v[116:119], a[40:43], a[128:131], v[116:119]
ds_read_b128 a[88:91], v2 offset:38912
v_mfma_f32_16x16x32_bf16 v[116:119], a[44:47], a[132:135], v[116:119]
v_mfma_f32_16x16x32_bf16 v[120:123], a[48:51], a[128:131], v[120:123]
ds_read_b128 a[92:95], v3 offset:38912
v_mfma_f32_16x16x32_bf16 v[120:123], a[52:55], a[132:135], v[120:123]
buffer_load_dwordx4 v15, s[8:11], s25 offen offset:3072 lds
v_mfma_f32_16x16x32_bf16 v[124:127], a[56:59], a[128:131], v[124:127]
s_add_u32 s25, s25, 128
v_mfma_f32_16x16x32_bf16 v[124:127], a[60:63], a[132:135], v[124:127]
s_waitcnt lgkmcnt(2)
v_mfma_f32_16x16x32_bf16 v[128:131], a[0:3], a[136:139], v[128:131]
ds_read_b64_tr_b16 a[128:129], v8 offset:0
v_mfma_f32_16x16x32_bf16 v[128:131], a[4:7], a[140:143], v[128:131]
buffer_load_dword v21, v20, s[16:19], s43 offen
v_mfma_f32_16x16x32_bf16 v[132:135], a[8:11], a[136:139], v[132:135]
s_add_u32 s43, s43, s47
ds_read_b64_tr_b16 a[130:131], v8 offset:2048
v_mfma_f32_16x16x32_bf16 v[132:135], a[12:15], a[140:143], v[132:135]
s_cmp_ge_u32 s43, s51
v_mfma_f32_16x16x32_bf16 v[136:139], a[16:19], a[136:139], v[136:139]
s_cselect_b32 s43, 0, s43
ds_read_b64_tr_b16 a[132:133], v8 offset:16384
v_mfma_f32_16x16x32_bf16 v[136:139], a[20:23], a[140:143], v[136:139]
s_cselect_b32 s51, s42, s51
v_mfma_f32_16x16x32_bf16 v[140:143], a[24:27], a[136:139], v[140:143]
s_cselect_b64 s[16:17], s[40:41], s[16:17]
ds_read_b64_tr_b16 a[134:135], v8 offset:18432
v_mfma_f32_16x16x32_bf16 v[140:143], a[28:31], a[140:143], v[140:143]
s_cselect_b32 s18, s42, s18
v_mfma_f32_16x16x32_bf16 v[144:147], a[32:35], a[136:139], v[144:147]
s_cselect_b64 s[40:41], s[44:45], s[40:41]
ds_read_b128 a[96:99], v2 offset:40960
v_mfma_f32_16x16x32_bf16 v[144:147], a[36:39], a[140:143], v[144:147]
s_cselect_b32 s42, s46, s42
v_mfma_f32_16x16x32_bf16 v[148:151], a[40:43], a[136:139], v[148:151]
s_cselect_b32 s46, 0, s46
v_mfma_f32_16x16x32_bf16 v[148:151], a[44:47], a[140:143], v[148:151]
s_cmp_eq_u32 s30, s55
v_mfma_f32_16x16x32_bf16 v[152:155], a[48:51], a[136:139], v[152:155]
s_cselect_b32 s22, 0, 3221225472
ds_read_b128 a[100:103], v3 offset:40960
v_mfma_f32_16x16x32_bf16 v[152:155], a[52:55], a[140:143], v[152:155]
s_sub_u32 s30, s30, 1
buffer_atomic_add v27, v26, s[60:63], s22 offen sc1
v_mfma_f32_16x16x32_bf16 v[156:159], a[56:59], a[136:139], v[156:159]
ds_read_b128 a[104:107], v2 offset:43008
v_mfma_f32_16x16x32_bf16 v[156:159], a[60:63], a[140:143], v[156:159]
s_waitcnt lgkmcnt(3)
v_mfma_f32_16x16x32_bf16 v[160:163], a[0:3], a[128:131], v[160:163]
ds_read_b64_tr_b16 a[136:137], v9 offset:0
v_mfma_f32_16x16x32_bf16 v[160:163], a[4:7], a[132:135], v[160:163]
v_mfma_f32_16x16x32_bf16 v[164:167], a[8:11], a[128:131], v[164:167]
ds_read_b64_tr_b16 a[138:139], v9 offset:2048
v_mfma_f32_16x16x32_bf16 v[164:167], a[12:15], a[132:135], v[164:167]
v_mfma_f32_16x16x32_bf16 v[168:171], a[16:19], a[128:131], v[168:171]
ds_read_b64_tr_b16 a[140:141], v9 offset:16384
v_mfma_f32_16x16x32_bf16 v[168:171], a[20:23], a[132:135], v[168:171]
v_mfma_f32_16x16x32_bf16 v[172:175], a[24:27], a[128:131], v[172:175]
ds_read_b64_tr_b16 a[142:143], v9 offset:18432
v_mfma_f32_16x16x32_bf16 v[172:175], a[28:31], a[132:135], v[172:175]
v_mfma_f32_16x16x32_bf16 v[176:179], a[32:35], a[128:131], v[176:179]
v_mfma_f32_16x16x32_bf16 v[176:179], a[36:39], a[132:135], v[176:179]
v_mfma_f32_16x16x32_bf16 v[180:183], a[40:43], a[128:131], v[180:183]
ds_read_b128 a[108:111], v3 offset:43008
v_mfma_f32_16x16x32_bf16 v[180:183], a[44:47], a[132:135], v[180:183]
v_mfma_f32_16x16x32_bf16 v[184:187], a[48:51], a[128:131], v[184:187]
ds_read_b128 a[112:115], v2 offset:45056
v_mfma_f32_16x16x32_bf16 v[184:187], a[52:55], a[132:135], v[184:187]
v_mfma_f32_16x16x32_bf16 v[188:191], a[56:59], a[128:131], v[188:191]
v_mfma_f32_16x16x32_bf16 v[188:191], a[60:63], a[132:135], v[188:191]
s_waitcnt lgkmcnt(2)
v_mfma_f32_16x16x32_bf16 v[192:195], a[0:3], a[136:139], v[192:195]
ds_read_b64_tr_b16 a[128:129], v10 offset:0
v_mfma_f32_16x16x32_bf16 v[192:195], a[4:7], a[140:143], v[192:195]
v_mfma_f32_16x16x32_bf16 v[196:199], a[8:11], a[136:139], v[196:199]
ds_read_b64_tr_b16 a[130:131], v10 offset:2048
v_mfma_f32_16x16x32_bf16 v[196:199], a[12:15], a[140:143], v[196:199]
v_mfma_f32_16x16x32_bf16 v[200:203], a[16:19], a[136:139], v[200:203]
ds_read_b64_tr_b16 a[132:133], v10 offset:16384
v_mfma_f32_16x16x32_bf16 v[200:203], a[20:23], a[140:143], v[200:203]
v_mfma_f32_16x16x32_bf16 v[204:207], a[24:27], a[136:139], v[204:207]
ds_read_b64_tr_b16 a[134:135], v10 offset:18432
v_mfma_f32_16x16x32_bf16 v[204:207], a[28:31], a[140:143], v[204:207]
v_mfma_f32_16x16x32_bf16 v[208:211], a[32:35], a[136:139], v[208:211]
ds_read_b128 a[116:119], v3 offset:45056
v_mfma_f32_16x16x32_bf16 v[208:211], a[36:39], a[140:143], v[208:211]
v_mfma_f32_16x16x32_bf16 v[212:215], a[40:43], a[136:139], v[212:215]
ds_read_b128 a[120:123], v2 offset:47104
v_mfma_f32_16x16x32_bf16 v[212:215], a[44:47], a[140:143], v[212:215]
v_mfma_f32_16x16x32_bf16 v[216:219], a[48:51], a[136:139], v[216:219]
v_mfma_f32_16x16x32_bf16 v[216:219], a[52:55], a[140:143], v[216:219]
v_mfma_f32_16x16x32_bf16 v[220:223], a[56:59], a[136:139], v[220:223]
ds_read_b128 a[124:127], v3 offset:47104
v_mfma_f32_16x16x32_bf16 v[220:223], a[60:63], a[140:143], v[220:223]
s_waitcnt lgkmcnt(3)
v_mfma_f32_16x16x32_bf16 a[192:195], a[0:3], a[128:131], a[192:195]
ds_read_b64_tr_b16 a[136:137], v11 offset:0
v_mfma_f32_16x16x32_bf16 a[192:195], a[4:7], a[132:135], a[192:195]
v_mfma_f32_16x16x32_bf16 a[196:199], a[8:11], a[128:131], a[196:199]
ds_read_b64_tr_b16 a[138:139], v11 offset:2048
v_mfma_f32_16x16x32_bf16 a[196:199], a[12:15], a[132:135], a[196:199]
v_mfma_f32_16x16x32_bf16 a[200:203], a[16:19], a[128:131], a[200:203]
ds_read_b64_tr_b16 a[140:141], v11 offset:16384
v_mfma_f32_16x16x32_bf16 a[200:203], a[20:23], a[132:135], a[200:203]
v_mfma_f32_16x16x32_bf16 a[204:207], a[24:27], a[128:131], a[204:207]
ds_read_b64_tr_b16 a[142:143], v11 offset:18432
v_mfma_f32_16x16x32_bf16 a[204:207], a[28:31], a[132:135], a[204:207]
v_mfma_f32_16x16x32_bf16 a[208:211], a[32:35], a[128:131], a[208:211]
v_mfma_f32_16x16x32_bf16 a[208:211], a[36:39], a[132:135], a[208:211]
v_mfma_f32_16x16x32_bf16 a[212:215], a[40:43], a[128:131], a[212:215]
v_mfma_f32_16x16x32_bf16 a[212:215], a[44:47], a[132:135], a[212:215]
v_mfma_f32_16x16x32_bf16 a[216:219], a[48:51], a[128:131], a[216:219]
v_mfma_f32_16x16x32_bf16 a[216:219], a[52:55], a[132:135], a[216:219]
v_mfma_f32_16x16x32_bf16 a[220:223], a[56:59], a[128:131], a[220:223]
s_waitcnt vmcnt(2) lgkmcnt(0)
v_mfma_f32_16x16x32_bf16 a[220:223], a[60:63], a[132:135], a[220:223]
s_barrier
v_mfma_f32_16x16x32_bf16 a[224:227], a[0:3], a[136:139], a[224:227]
s_add_u32 m0, s29, 65536
ds_read_b64_tr_b16 a[128:129], v4 offset:32768
v_mfma_f32_16x16x32_bf16 a[224:227], a[4:7], a[140:143], a[224:227]
buffer_load_dwordx4 v16, s[12:15], s26 offen offset:0 lds
v_mfma_f32_16x16x32_bf16 a[228:231], a[8:11], a[136:139], a[228:231]
ds_read_b64_tr_b16 a[130:131], v4 offset:34816
v_mfma_f32_16x16x32_bf16 a[228:231], a[12:15], a[140:143], a[228:231]
v_mfma_f32_16x16x32_bf16 a[232:235], a[16:19], a[136:139], a[232:235]
ds_read_b64_tr_b16 a[132:133], v4 offset:49152
v_mfma_f32_16x16x32_bf16 a[232:235], a[20:23], a[140:143], a[232:235]
buffer_load_dwordx4 v17, s[12:15], s26 offen offset:1024 lds
v_mfma_f32_16x16x32_bf16 a[236:239], a[24:27], a[136:139], a[236:239]
ds_read_b64_tr_b16 a[134:135], v4 offset:51200
v_mfma_f32_16x16x32_bf16 a[236:239], a[28:31], a[140:143], a[236:239]
v_mfma_f32_16x16x32_bf16 a[240:243], a[32:35], a[136:139], a[240:243]
v_mfma_f32_16x16x32_bf16 a[240:243], a[36:39], a[140:143], a[240:243]
buffer_load_dwordx4 v18, s[12:15], s26 offen offset:2048 lds
v_mfma_f32_16x16x32_bf16 a[244:247], a[40:43], a[136:139], a[244:247]
v_mfma_f32_16x16x32_bf16 a[244:247], a[44:47], a[140:143], a[244:247]
v_mfma_f32_16x16x32_bf16 a[248:251], a[48:51], a[136:139], a[248:251]
v_mfma_f32_16x16x32_bf16 a[248:251], a[52:55], a[140:143], a[248:251]
s_waitcnt lgkmcnt(0)
buffer_load_dwordx4 v19, s[12:15], s26 offen offset:3072 lds
v_mfma_f32_16x16x32_bf16 a[252:255], a[56:59], a[136:139], a[252:255]
s_add_u32 s26, s26, 524288
s_bitcmp1_b32 s30, 1
v_mfma_f32_16x16x32_bf16 a[252:255], a[60:63], a[140:143], a[252:255]
s_cbranch_scc1 Lg_501
s_cmp_eq_u32 s30, 0
s_cbranch_scc1 Lg_501t
v_mfma_f32_16x16x32_bf16 v[32:35], a[64:67], a[128:131], v[32:35]
s_add_u32 m0, s29, 81920
ds_read_b64_tr_b16 a[136:137], v5 offset:32768
v_mfma_f32_16x16x32_bf16 v[32:35], a[68:71], a[132:135], v[32:35]
buffer_load_dwordx4 v16, s[12:15], s27 offen offset:0 lds
v_mfma_f32_16x16x32_bf16 v[36:39], a[72:75], a[128:131], v[36:39]
s_lshl_b32 s22, s38, 3
ds_read_b64_tr_b16 a[138:139], v5 offset:34816
v_mfma_f32_16x16x32_bf16 v[36:39], a[76:79], a[132:135], v[36:39]
s_lshl_b32 s23, s39, 5
v_and_b32 v252, 31, v0
v_lshrrev_b32 v253, 5, v0
v_mfma_f32_16x16x32_bf16 v[40:43], a[80:83], a[128:131], v[40:43]
ds_read_b64_tr_b16 a[140:141], v5 offset:49152
v_add_u32 v253, s22, v253
v_mfma_f32_16x16x32_bf16 v[40:43], a[84:87], a[132:135], v[40:43]
buffer_load_dwordx4 v17, s[12:15], s27 offen offset:1024 lds
v_mfma_f32_16x16x32_bf16 v[44:47], a[88:91], a[128:131], v[44:47]
ds_read_b64_tr_b16 a[142:143], v5 offset:51200
v_add_u32 v252, s23, v252
v_mfma_f32_16x16x32_bf16 v[44:47], a[92:95], a[132:135], v[44:47]
v_mul_u32_u24 v254, 7168, v253
v_lshl_add_u32 v254, v252, 2, v254
v_mfma_f32_16x16x32_bf16 v[48:51], a[96:99], a[128:131], v[48:51]
ds_read_b128 a[0:3], v2 offset:0
v_lshlrev_b32 v252, 4, v252
v_mfma_f32_16x16x32_bf16 v[48:51], a[100:103], a[132:135], v[48:51]
buffer_load_dwordx4 v18, s[12:15], s27 offen offset:2048 lds
v_mfma_f32_16x16x32_bf16 v[52:55], a[104:107], a[128:131], v[52:55]
ds_read_b128 a[4:7], v3 offset:0
v_add_u32 v255, 3584, v254
v_mfma_f32_16x16x32_bf16 v[52:55], a[108:111], a[132:135], v[52:55]
v_subrev_u32 v22, 3584, v254
v_subrev_u32 v23, 2688, v254
v_mfma_f32_16x16x32_bf16 v[56:59], a[112:115], a[128:131], v[56:59]
v_subrev_u32 v24, 1792, v254
v_subrev_u32 v25, 896, v254
v_mfma_f32_16x16x32_bf16 v[56:59], a[116:119], a[132:135], v[56:59]
buffer_load_dwordx4 v19, s[12:15], s27 offen offset:3072 lds
v_mfma_f32_16x16x32_bf16 v[60:63], a[120:123], a[128:131], v[60:63]
s_add_u32 s27, s27, 524288
ds_read_b128 a[8:11], v2 offset:2048
v_mfma_f32_16x16x32_bf16 v[60:63], a[124:127], a[132:135], v[60:63]
PAD_23:
s_cbranch_execz PAD_27
s_waitcnt lgkmcnt(3)
v_mfma_f32_16x16x32_bf16 v[64:67], a[64:67], a[136:139], v[64:67]
s_add_u32 m0, s28, 32768
ds_read_b64_tr_b16 a[128:129], v6 offset:32768
v_mfma_f32_16x16x32_bf16 v[64:67], a[68:71], a[140:143], v[64:67]
buffer_load_dwordx4 v12, s[8:11], s24 offen offset:0 lds
v_mfma_f32_16x16x32_bf16 v[68:71], a[72:75], a[136:139], v[68:71]
ds_read_b64_tr_b16 a[130:131], v6 offset:34816
v_mfma_f32_16x16x32_bf16 v[68:71], a[76:79], a[140:143], v[68:71]
v_mfma_f32_16x16x32_bf16 v[72:75], a[80:83], a[136:139], v[72:75]
ds_read_b64_tr_b16 a[132:133], v6 offset:49152
v_mfma_f32_16x16x32_bf16 v[72:75], a[84:87], a[140:143], v[72:75]
buffer_load_dwordx4 v13, s[8:11], s24 offen offset:1024 lds
v_mfma_f32_16x16x32_bf16 v[76:79], a[88:91], a[136:139], v[76:79]
ds_read_b64_tr_b16 a[134:135], v6 offset:51200
v_mfma_f32_16x16x32_bf16 v[76:79], a[92:95], a[140:143], v[76:79]
v_mfma_f32_16x16x32_bf16 v[80:83], a[96:99], a[136:139], v[80:83]
ds_read_b128 a[12:15], v3 offset:2048
v_mfma_f32_16x16x32_bf16 v[80:83], a[100:103], a[140:143], v[80:83]
buffer_load_dwordx4 v14, s[8:11], s24 offen offset:2048 lds
v_mfma_f32_16x16x32_bf16 v[84:87], a[104:107], a[136:139], v[84:87]
v_mfma_f32_16x16x32_bf16 v[84:87], a[108:111], a[140:143], v[84:87]
v_mfma_f32_16x16x32_bf16 v[88:91], a[112:115], a[136:139], v[88:91]
ds_read_b128 a[16:19], v2 offset:4096
v_mfma_f32_16x16x32_bf16 v[88:91], a[116:119], a[140:143], v[88:91]
buffer_load_dwordx4 v15, s[8:11], s24 offen offset:3072 lds
v_mfma_f32_16x16x32_bf16 v[92:95], a[120:123], a[136:139], v[92:95]
s_add_u32 s24, s24, 128
ds_read_b128 a[20:23], v3 offset:4096
v_mfma_f32_16x16x32_bf16 v[92:95], a[124:127], a[140:143], v[92:95]
s_waitcnt lgkmcnt(3)
v_mfma_f32_16x16x32_bf16 v[96:99], a[64:67], a[128:131], v[96:99]
s_add_u32 m0, s28, 36864
ds_read_b64_tr_b16 a[136:137], v7 offset:32768
v_mfma_f32_16x16x32_bf16 v[96:99], a[68:71], a[132:135], v[96:99]
buffer_load_dwordx4 v12, s[8:11], s25 offen offset:0 lds
v_mfma_f32_16x16x32_bf16 v[100:103], a[72:75], a[128:131], v[100:103]
ds_read_b64_tr_b16 a[138:139], v7 offset:34816
v_mfma_f32_16x16x32_bf16 v[100:103], a[76:79], a[132:135], v[100:103]
v_mfma_f32_16x16x32_bf16 v[104:107], a[80:83], a[128:131], v[104:107]
ds_read_b64_tr_b16 a[140:141], v7 offset:49152
v_mfma_f32_16x16x32_bf16 v[104:107], a[84:87], a[132:135], v[104:107]
buffer_load_dwordx4 v13, s[8:11], s25 offen offset:1024 lds
v_mfma_f32_16x16x32_bf16 v[108:111], a[88:91], a[128:131], v[108:111]
ds_read_b64_tr_b16 a[142:143], v7 offset:51200
v_mfma_f32_16x16x32_bf16 v[108:111], a[92:95], a[132:135], v[108:111]
v_mfma_f32_16x16x32_bf16 v[112:115], a[96:99], a[128:131], v[112:115]
v_mfma_f32_16x16x32_bf16 v[112:115], a[100:103], a[132:135], v[112:115]
buffer_load_dwordx4 v14, s[8:11], s25 offen offset:2048 lds
v_mfma_f32_16x16x32_bf16 v[116:119], a[104:107], a[128:131], v[116:119]
ds_read_b128 a[24:27], v2 offset:6144
v_mfma_f32_16x16x32_bf16 v[116:119], a[108:111], a[132:135], v[116:119]
v_mfma_f32_16x16x32_bf16 v[120:123], a[112:115], a[128:131], v[120:123]
ds_read_b128 a[28:31], v3 offset:6144
v_mfma_f32_16x16x32_bf16 v[120:123], a[116:119], a[132:135], v[120:123]
buffer_load_dwordx4 v15, s[8:11], s25 offen offset:3072 lds
v_mfma_f32_16x16x32_bf16 v[124:127], a[120:123], a[128:131], v[124:127]
s_add_u32 s25, s25, 128
v_mfma_f32_16x16x32_bf16 v[124:127], a[124:127], a[132:135], v[124:127]
s_waitcnt lgkmcnt(2)
v_mfma_f32_16x16x32_bf16 v[128:131], a[64:67], a[136:139], v[128:131]
s_mov_b64 s[56:57], s[70:71]
s_mov_b32 s58, 3584
s_mov_b32 s59, 0x20000
ds_read_b64_tr_b16 a[128:129], v8 offset:32768
v_mfma_f32_16x16x32_bf16 v[128:131], a[68:71], a[140:143], v[128:131]
buffer_load_dwordx4 v[248:251], v252, s[56:59], 0 offen
v_mfma_f32_16x16x32_bf16 v[132:135], a[72:75], a[136:139], v[132:135]
s_mov_b64 s[56:57], s[66:67]
s_mov_b32 s58, 1835008
ds_read_b64_tr_b16 a[130:131], v8 offset:34816
v_mfma_f32_16x16x32_bf16 v[132:135], a[76:79], a[140:143], v[132:135]
buffer_load_dword v224, v22, s[56:59], 0 offen nt
v_mfma_f32_16x16x32_bf16 v[136:139], a[80:83], a[136:139], v[136:139]
ds_read_b64_tr_b16 a[132:133], v8 offset:49152
v_mfma_f32_16x16x32_bf16 v[136:139], a[84:87], a[140:143], v[136:139]
buffer_load_dword v225, v23, s[56:59], 0 offen nt
v_mfma_f32_16x16x32_bf16 v[140:143], a[88:91], a[136:139], v[140:143]
ds_read_b64_tr_b16 a[134:135], v8 offset:51200
v_mfma_f32_16x16x32_bf16 v[140:143], a[92:95], a[140:143], v[140:143]
buffer_load_dword v226, v24, s[56:59], 0 offen nt
v_mfma_f32_16x16x32_bf16 v[144:147], a[96:99], a[136:139], v[144:147]
ds_read_b128 a[32:35], v2 offset:8192
v_mfma_f32_16x16x32_bf16 v[144:147], a[100:103], a[140:143], v[144:147]
buffer_load_dword v227, v25, s[56:59], 0 offen nt
v_mfma_f32_16x16x32_bf16 v[148:151], a[104:107], a[136:139], v[148:151]
buffer_load_dword v228, v254, s[56:59], 0 offen offset:0 nt
v_mfma_f32_16x16x32_bf16 v[148:151], a[108:111], a[140:143], v[148:151]
buffer_load_dword v229, v254, s[56:59], 0 offen offset:896 nt
v_mfma_f32_16x16x32_bf16 v[152:155], a[112:115], a[136:139], v[152:155]
ds_read_b128 a[36:39], v3 offset:8192
v_mfma_f32_16x16x32_bf16 v[152:155], a[116:119], a[140:143], v[152:155]
buffer_load_dword v230, v254, s[56:59], 0 offen offset:1792 nt
v_mfma_f32_16x16x32_bf16 v[156:159], a[120:123], a[136:139], v[156:159]
ds_read_b128 a[40:43], v2 offset:10240
v_mfma_f32_16x16x32_bf16 v[156:159], a[124:127], a[140:143], v[156:159]
s_waitcnt lgkmcnt(3)
buffer_load_dword v231, v254, s[56:59], 0 offen offset:2688 nt
v_mfma_f32_16x16x32_bf16 v[160:163], a[64:67], a[128:131], v[160:163]
ds_read_b64_tr_b16 a[136:137], v9 offset:32768
v_mfma_f32_16x16x32_bf16 v[160:163], a[68:71], a[132:135], v[160:163]
buffer_load_dword v232, v255, s[56:59], 0 offen offset:0 nt
v_mfma_f32_16x16x32_bf16 v[164:167], a[72:75], a[128:131], v[164:167]
ds_read_b64_tr_b16 a[138:139], v9 offset:34816
v_mfma_f32_16x16x32_bf16 v[164:167], a[76:79], a[132:135], v[164:167]
buffer_load_dword v233, v255, s[56:59], 0 offen offset:896 nt
v_mfma_f32_16x16x32_bf16 v[168:171], a[80:83], a[128:131], v[168:171]
ds_read_b64_tr_b16 a[140:141], v9 offset:49152
v_mfma_f32_16x16x32_bf16 v[168:171], a[84:87], a[132:135], v[168:171]
buffer_load_dword v234, v255, s[56:59], 0 offen offset:1792 nt
v_mfma_f32_16x16x32_bf16 v[172:175], a[88:91], a[128:131], v[172:175]
ds_read_b64_tr_b16 a[142:143], v9 offset:51200
v_mfma_f32_16x16x32_bf16 v[172:175], a[92:95], a[132:135], v[172:175]
buffer_load_dword v235, v255, s[56:59], 0 offen offset:2688 nt
v_mfma_f32_16x16x32_bf16 v[176:179], a[96:99], a[128:131], v[176:179]
s_mov_b64 s[56:57], s[68:69]
buffer_load_dword v236, v25, s[56:59], 0 offen nt
v_mfma_f32_16x16x32_bf16 v[176:179], a[100:103], a[132:135], v[176:179]
buffer_load_dword v237, v254, s[56:59], 0 offen offset:0 nt
v_mfma_f32_16x16x32_bf16 v[180:183], a[104:107], a[128:131], v[180:183]
ds_read_b128 a[44:47], v3 offset:10240
v_mfma_f32_16x16x32_bf16 v[180:183], a[108:111], a[132:135], v[180:183]
buffer_load_dword v238, v254, s[56:59], 0 offen offset:896 nt
v_mfma_f32_16x16x32_bf16 v[184:187], a[112:115], a[128:131], v[184:187]
ds_read_b128 a[48:51], v2 offset:12288
v_mfma_f32_16x16x32_bf16 v[184:187], a[116:119], a[132:135], v[184:187]
buffer_load_dword v239, v254, s[56:59], 0 offen offset:1792 nt
v_mfma_f32_16x16x32_bf16 v[188:191], a[120:123], a[128:131], v[188:191]
buffer_load_dword v240, v254, s[56:59], 0 offen offset:2688 nt
v_mfma_f32_16x16x32_bf16 v[188:191], a[124:127], a[132:135], v[188:191]
s_waitcnt lgkmcnt(2)
buffer_load_dword v241, v255, s[56:59], 0 offen offset:0 nt
v_mfma_f32_16x16x32_bf16 v[192:195], a[64:67], a[136:139], v[192:195]
ds_read_b64_tr_b16 a[128:129], v10 offset:32768
v_mfma_f32_16x16x32_bf16 v[192:195], a[68:71], a[140:143], v[192:195]
buffer_load_dword v242, v255, s[56:59], 0 offen offset:896 nt
v_mfma_f32_16x16x32_bf16 v[196:199], a[72:75], a[136:139], v[196:199]
ds_read_b64_tr_b16 a[130:131], v10 offset:34816
v_mfma_f32_16x16x32_bf16 v[196:199], a[76:79], a[140:143], v[196:199]
buffer_load_dword v243, v255, s[56:59], 0 offen offset:1792 nt
v_mfma_f32_16x16x32_bf16 v[200:203], a[80:83], a[136:139], v[200:203]
ds_read_b64_tr_b16 a[132:133], v10 offset:49152
v_mfma_f32_16x16x32_bf16 v[200:203], a[84:87], a[140:143], v[200:203]
buffer_load_dword v244, v255, s[56:59], 0 offen offset:2688 nt
v_mfma_f32_16x16x32_bf16 v[204:207], a[88:91], a[136:139], v[204:207]
ds_read_b64_tr_b16 a[134:135], v10 offset:51200
v_mfma_f32_16x16x32_bf16 v[204:207], a[92:95], a[140:143], v[204:207]
v_mfma_f32_16x16x32_bf16 v[208:211], a[96:99], a[136:139], v[208:211]
ds_read_b128 a[52:55], v3 offset:12288
v_mfma_f32_16x16x32_bf16 v[208:211], a[100:103], a[140:143], v[208:211]
v_mfma_f32_16x16x32_bf16 v[212:215], a[104:107], a[136:139], v[212:215]
ds_read_b128 a[56:59], v2 offset:14336
v_mfma_f32_16x16x32_bf16 v[212:215], a[108:111], a[140:143], v[212:215]
v_mfma_f32_16x16x32_bf16 v[216:219], a[112:115], a[136:139], v[216:219]
v_mfma_f32_16x16x32_bf16 v[216:219], a[116:119], a[140:143], v[216:219]
v_mfma_f32_16x16x32_bf16 v[220:223], a[120:123], a[136:139], v[220:223]
ds_read_b128 a[60:63], v3 offset:14336
v_mfma_f32_16x16x32_bf16 v[220:223], a[124:127], a[140:143], v[220:223]
s_waitcnt lgkmcnt(3)
v_mfma_f32_16x16x32_bf16 a[192:195], a[64:67], a[128:131], a[192:195]
ds_read_b64_tr_b16 a[136:137], v11 offset:32768
v_mfma_f32_16x16x32_bf16 a[192:195], a[68:71], a[132:135], a[192:195]
v_mfma_f32_16x16x32_bf16 a[196:199], a[72:75], a[128:131], a[196:199]
ds_read_b64_tr_b16 a[138:139], v11 offset:34816
v_mfma_f32_16x16x32_bf16 a[196:199], a[76:79], a[132:135], a[196:199]
v_mfma_f32_16x16x32_bf16 a[200:203], a[80:83], a[128:131], a[200:203]
ds_read_b64_tr_b16 a[140:141], v11 offset:49152
v_mfma_f32_16x16x32_bf16 a[200:203], a[84:87], a[132:135], a[200:203]
v_mfma_f32_16x16x32_bf16 a[204:207], a[88:91], a[128:131], a[204:207]
ds_read_b64_tr_b16 a[142:143], v11 offset:51200
v_mfma_f32_16x16x32_bf16 a[204:207], a[92:95], a[132:135], a[204:207]
v_mfma_f32_16x16x32_bf16 a[208:211], a[96:99], a[128:131], a[208:211]
v_mfma_f32_16x16x32_bf16 a[208:211], a[100:103], a[132:135], a[208:211]
v_mfma_f32_16x16x32_bf16 a[212:215], a[104:107], a[128:131], a[212:215]
v_mfma_f32_16x16x32_bf16 a[212:215], a[108:111], a[132:135], a[212:215]
v_mfma_f32_16x16x32_bf16 a[216:219], a[112:115], a[128:131], a[216:219]
v_mfma_f32_16x16x32_bf16 a[216:219], a[116:119], a[132:135], a[216:219]
v_mfma_f32_16x16x32_bf16 a[220:223], a[120:123], a[128:131], a[220:223]
s_waitcnt vmcnt(22) lgkmcnt(0)
v_mfma_f32_16x16x32_bf16 a[220:223], a[124:127], a[132:135], a[220:223]
s_barrier
v_mfma_f32_16x16x32_bf16 a[224:227], a[64:67], a[136:139], a[224:227]
s_add_u32 m0, s29, 98304
ds_read_b64_tr_b16 a[128:129], v4 offset:0
v_mfma_f32_16x16x32_bf16 a[224:227], a[68:71], a[140:143], a[224:227]
buffer_load_dwordx4 v16, s[12:15], s26 offen offset:0 lds
v_mfma_f32_16x16x32_bf16 a[228:231], a[72:75], a[136:139], a[228:231]
ds_read_b64_tr_b16 a[130:131], v4 offset:2048
v_mfma_f32_16x16x32_bf16 a[228:231], a[76:79], a[140:143], a[228:231]
v_mfma_f32_16x16x32_bf16 a[232:235], a[80:83], a[136:139], a[232:235]
ds_read_b64_tr_b16 a[132:133], v4 offset:16384
v_mfma_f32_16x16x32_bf16 a[232:235], a[84:87], a[140:143], a[232:235]
buffer_load_dwordx4 v17, s[12:15], s26 offen offset:1024 lds
v_mfma_f32_16x16x32_bf16 a[236:239], a[88:91], a[136:139], a[236:239]
ds_read_b64_tr_b16 a[134:135], v4 offset:18432
v_mfma_f32_16x16x32_bf16 a[236:239], a[92:95], a[140:143], a[236:239]
v_mfma_f32_16x16x32_bf16 a[240:243], a[96:99], a[136:139], a[240:243]
v_mfma_f32_16x16x32_bf16 a[240:243], a[100:103], a[140:143], a[240:243]
buffer_load_dwordx4 v18, s[12:15], s26 offen offset:2048 lds
v_mfma_f32_16x16x32_bf16 a[244:247], a[104:107], a[136:139], a[244:247]
v_mfma_f32_16x16x32_bf16 a[244:247], a[108:111], a[140:143], a[244:247]
v_mfma_f32_16x16x32_bf16 a[248:251], a[112:115], a[136:139], a[248:251]
v_mfma_f32_16x16x32_bf16 a[248:251], a[116:119], a[140:143], a[248:251]
buffer_load_dwordx4 v19, s[12:15], s26 offen offset:3072 lds
v_mfma_f32_16x16x32_bf16 a[252:255], a[120:123], a[136:139], a[252:255]
s_add_u32 s26, s26, 524288
v_mfma_f32_16x16x32_bf16 a[252:255], a[124:127], a[140:143], a[252:255]
s_waitcnt lgkmcnt(0)
v_mfma_f32_16x16x32_bf16 v[32:35], a[0:3], a[128:131], v[32:35]
s_add_u32 m0, s29, 114688
ds_read_b64_tr_b16 a[136:137], v5 offset:0
v_mfma_f32_16x16x32_bf16 v[32:35], a[4:7], a[132:135], v[32:35]
buffer_load_dwordx4 v16, s[12:15], s27 offen offset:0 lds
v_mfma_f32_16x16x32_bf16 v[36:39], a[8:11], a[128:131], v[36:39]
ds_read_b64_tr_b16 a[138:139], v5 offset:2048
v_mfma_f32_16x16x32_bf16 v[36:39], a[12:15], a[132:135], v[36:39]
v_mfma_f32_16x16x32_bf16 v[40:43], a[16:19], a[128:131], v[40:43]
ds_read_b64_tr_b16 a[140:141], v5 offset:16384
v_mfma_f32_16x16x32_bf16 v[40:43], a[20:23], a[132:135], v[40:43]
buffer_load_dwordx4 v17, s[12:15], s27 offen offset:1024 lds
v_mfma_f32_16x16x32_bf16 v[44:47], a[24:27], a[128:131], v[44:47]
ds_read_b64_tr_b16 a[142:143], v5 offset:18432
v_mfma_f32_16x16x32_bf16 v[44:47], a[28:31], a[132:135], v[44:47]
v_mfma_f32_16x16x32_bf16 v[48:51], a[32:35], a[128:131], v[48:51]
ds_read_b128 a[64:67], v2 offset:32768
v_mfma_f32_16x16x32_bf16 v[48:51], a[36:39], a[132:135], v[48:51]
buffer_load_dwordx4 v18, s[12:15], s27 offen offset:2048 lds
v_mfma_f32_16x16x32_bf16 v[52:55], a[40:43], a[128:131], v[52:55]
ds_read_b128 a[68:71], v3 offset:32768
v_mfma_f32_16x16x32_bf16 v[52:55], a[44:47], a[132:135], v[52:55]
v_mfma_f32_16x16x32_bf16 v[56:59], a[48:51], a[128:131], v[56:59]
v_mfma_f32_16x16x32_bf16 v[56:59], a[52:55], a[132:135], v[56:59]
buffer_load_dwordx4 v19, s[12:15], s27 offen offset:3072 lds
v_mfma_f32_16x16x32_bf16 v[60:63], a[56:59], a[128:131], v[60:63]
s_add_u32 s27, s27, 524288
ds_read_b128 a[72:75], v2 offset:34816
v_mfma_f32_16x16x32_bf16 v[60:63], a[60:63], a[132:135], v[60:63]
s_waitcnt lgkmcnt(3)
v_mfma_f32_16x16x32_bf16 v[64:67], a[0:3], a[136:139], v[64:67]
s_add_u32 m0, s28, 0
ds_read_b64_tr_b16 a[128:129], v6 offset:0
v_mfma_f32_16x16x32_bf16 v[64:67], a[4:7], a[140:143], v[64:67]
buffer_load_dwordx4 v12, s[8:11], s24 offen offset:0 lds
v_mfma_f32_16x16x32_bf16 v[68:71], a[8:11], a[136:139], v[68:71]
ds_read_b64_tr_b16 a[130:131], v6 offset:2048
v_mfma_f32_16x16x32_bf16 v[68:71], a[12:15], a[140:143], v[68:71]
v_mfma_f32_16x16x32_bf16 v[72:75], a[16:19], a[136:139], v[72:75]
ds_read_b64_tr_b16 a[132:133], v6 offset:16384
v_mfma_f32_16x16x32_bf16 v[72:75], a[20:23], a[140:143], v[72:75]
buffer_load_dwordx4 v13, s[8:11], s24 offen offset:1024 lds
v_mfma_f32_16x16x32_bf16 v[76:79], a[24:27], a[136:139], v[76:79]
ds_read_b64_tr_b16 a[134:135], v6 offset:18432
v_mfma_f32_16x16x32_bf16 v[76:79], a[28:31], a[140:143], v[76:79]
v_mfma_f32_16x16x32_bf16 v[80:83], a[32:35], a[136:139], v[80:83]
ds_read_b128 a[76:79], v3 offset:34816
v_mfma_f32_16x16x32_bf16 v[80:83], a[36:39], a[140:143], v[80:83]
buffer_load_dwordx4 v14, s[8:11], s24 offen offset:2048 lds
v_mfma_f32_16x16x32_bf16 v[84:87], a[40:43], a[136:139], v[84:87]
v_mfma_f32_16x16x32_bf16 v[84:87], a[44:47], a[140:143], v[84:87]
v_mfma_f32_16x16x32_bf16 v[88:91], a[48:51], a[136:139], v[88:91]
ds_read_b128 a[80:83], v2 offset:36864
v_mfma_f32_16x16x32_bf16 v[88:91], a[52:55], a[140:143], v[88:91]
buffer_load_dwordx4 v15, s[8:11], s24 offen offset:3072 lds
v_mfma_f32_16x16x32_bf16 v[92:95], a[56:59], a[136:139], v[92:95]
s_add_u32 s24, s24, 128
ds_read_b128 a[84:87], v3 offset:36864
v_mfma_f32_16x16x32_bf16 v[92:95], a[60:63], a[140:143], v[92:95]
s_waitcnt lgkmcnt(3)
v_mfma_f32_16x16x32_bf16 v[96:99], a[0:3], a[128:131], v[96:99]
s_add_u32 m0, s28, 4096
ds_read_b64_tr_b16 a[136:137], v7 offset:0
v_mfma_f32_16x16x32_bf16 v[96:99], a[4:7], a[132:135], v[96:99]
buffer_load_dwordx4 v12, s[8:11], s25 offen offset:0 lds
v_mfma_f32_16x16x32_bf16 v[100:103], a[8:11], a[128:131], v[100:103]
ds_read_b64_tr_b16 a[138:139], v7 offset:2048
v_mfma_f32_16x16x32_bf16 v[100:103], a[12:15], a[132:135], v[100:103]
v_mfma_f32_16x16x32_bf16 v[104:107], a[16:19], a[128:131], v[104:107]
ds_read_b64_tr_b16 a[140:141], v7 offset:16384
v_mfma_f32_16x16x32_bf16 v[104:107], a[20:23], a[132:135], v[104:107]
buffer_load_dwordx4 v13, s[8:11], s25 offen offset:1024 lds
v_mfma_f32_16x16x32_bf16 v[108:111], a[24:27], a[128:131], v[108:111]
ds_read_b64_tr_b16 a[142:143], v7 offset:18432
v_mfma_f32_16x16x32_bf16 v[108:111], a[28:31], a[132:135], v[108:111]
v_mfma_f32_16x16x32_bf16 v[112:115], a[32:35], a[128:131], v[112:115]
v_mfma_f32_16x16x32_bf16 v[112:115], a[36:39], a[132:135], v[112:115]
buffer_load_dwordx4 v14, s[8:11], s25 offen offset:2048 lds
v_mfma_f32_16x16x32_bf16 v[116:119], a[40:43], a[128:131], v[116:119]
ds_read_b128 a[88:91], v2 offset:38912
v_mfma_f32_16x16x32_bf16 v[116:119], a[44:47], a[132:135], v[116:119]
v_mfma_f32_16x16x32_bf16 v[120:123], a[48:51], a[128:131], v[120:123]
ds_read_b128 a[92:95], v3 offset:38912
v_mfma_f32_16x16x32_bf16 v[120:123], a[52:55], a[132:135], v[120:123]
buffer_load_dwordx4 v15, s[8:11], s25 offen offset:3072 lds
v_mfma_f32_16x16x32_bf16 v[124:127], a[56:59], a[128:131], v[124:127]
s_add_u32 s25, s25, 128
v_mfma_f32_16x16x32_bf16 v[124:127], a[60:63], a[132:135], v[124:127]
s_waitcnt lgkmcnt(2)
v_mfma_f32_16x16x32_bf16 v[128:131], a[0:3], a[136:139], v[128:131]
ds_read_b64_tr_b16 a[128:129], v8 offset:0
v_mfma_f32_16x16x32_bf16 v[128:131], a[4:7], a[140:143], v[128:131]
buffer_load_dword v21, v20, s[16:19], s43 offen
v_mfma_f32_16x16x32_bf16 v[132:135], a[8:11], a[136:139], v[132:135]
s_add_u32 s43, s43, s47
ds_read_b64_tr_b16 a[130:131], v8 offset:2048
v_mfma_f32_16x16x32_bf16 v[132:135], a[12:15], a[140:143], v[132:135]
s_cmp_ge_u32 s43, s51
v_mfma_f32_16x16x32_bf16 v[136:139], a[16:19], a[136:139], v[136:139]
s_cselect_b32 s43, 0, s43
ds_read_b64_tr_b16 a[132:133], v8 offset:16384
v_mfma_f32_16x16x32_bf16 v[136:139], a[20:23], a[140:143], v[136:139]
s_cselect_b32 s51, s42, s51
v_mfma_f32_16x16x32_bf16 v[140:143], a[24:27], a[136:139], v[140:143]
s_cselect_b64 s[16:17], s[40:41], s[16:17]
ds_read_b64_tr_b16 a[134:135], v8 offset:18432
v_mfma_f32_16x16x32_bf16 v[140:143], a[28:31], a[140:143], v[140:143]
s_cselect_b32 s18, s42, s18
v_mfma_f32_16x16x32_bf16 v[144:147], a[32:35], a[136:139], v[144:147]
s_cselect_b64 s[40:41], s[44:45], s[40:41]
ds_read_b128 a[96:99], v2 offset:40960
v_mfma_f32_16x16x32_bf16 v[144:147], a[36:39], a[140:143], v[144:147]
s_cselect_b32 s42, s46, s42
v_mfma_f32_16x16x32_bf16 v[148:151], a[40:43], a[136:139], v[148:151]
s_cselect_b32 s46, 0, s46
v_mfma_f32_16x16x32_bf16 v[148:151], a[44:47], a[140:143], v[148:151]
s_lshl_b32 s59, s39, 5
v_mfma_f32_16x16x32_bf16 v[152:155], a[48:51], a[136:139], v[152:155]
s_add_u32 s59, s59, s38
ds_read_b128 a[100:103], v3 offset:40960
v_mfma_f32_16x16x32_bf16 v[152:155], a[52:55], a[140:143], v[152:155]
s_lshl_b32 s59, s59, 2
v_mfma_f32_16x16x32_bf16 v[156:159], a[56:59], a[136:139], v[156:159]
s_add_u32 s59, s59, 94392320
ds_read_b128 a[104:107], v2 offset:43008
v_mfma_f32_16x16x32_bf16 v[156:159], a[60:63], a[140:143], v[156:159]
s_waitcnt lgkmcnt(3)
s_cmp_lt_u32 s2, 224
v_mfma_f32_16x16x32_bf16 v[160:163], a[0:3], a[128:131], v[160:163]
s_cselect_b32 s59, s59, 3221225472
ds_read_b64_tr_b16 a[136:137], v9 offset:0
v_mfma_f32_16x16x32_bf16 v[160:163], a[4:7], a[132:135], v[160:163]
s_mov_b32 s58, 0xffff0000
v_mfma_f32_16x16x32_bf16 v[164:167], a[8:11], a[128:131], v[164:167]
ds_read_b64_tr_b16 a[138:139], v9 offset:2048
v_mfma_f32_16x16x32_bf16 v[164:167], a[12:15], a[132:135], v[164:167]
buffer_load_dword v21, v20, s[16:19], s43 offen
v_mfma_f32_16x16x32_bf16 v[168:171], a[16:19], a[128:131], v[168:171]
s_add_u32 s43, s43, s47
ds_read_b64_tr_b16 a[140:141], v9 offset:16384
v_mfma_f32_16x16x32_bf16 v[168:171], a[20:23], a[132:135], v[168:171]
s_cmp_ge_u32 s43, s51
v_mfma_f32_16x16x32_bf16 v[172:175], a[24:27], a[128:131], v[172:175]
s_cselect_b32 s43, 0, s43
ds_read_b64_tr_b16 a[142:143], v9 offset:18432
v_mfma_f32_16x16x32_bf16 v[172:175], a[28:31], a[132:135], v[172:175]
s_cselect_b32 s51, s42, s51
v_mfma_f32_16x16x32_bf16 v[176:179], a[32:35], a[128:131], v[176:179]
s_cselect_b64 s[16:17], s[40:41], s[16:17]
v_mfma_f32_16x16x32_bf16 v[176:179], a[36:39], a[132:135], v[176:179]
s_cselect_b32 s18, s42, s18
v_mfma_f32_16x16x32_bf16 v[180:183], a[40:43], a[128:131], v[180:183]
s_cselect_b64 s[40:41], s[44:45], s[40:41]
ds_read_b128 a[108:111], v3 offset:43008
v_mfma_f32_16x16x32_bf16 v[180:183], a[44:47], a[132:135], v[180:183]
s_cselect_b32 s42, s46, s42
v_mfma_f32_16x16x32_bf16 v[184:187], a[48:51], a[128:131], v[184:187]
s_cselect_b32 s46, 0, s46
ds_read_b128 a[112:115], v2 offset:45056
v_mfma_f32_16x16x32_bf16 v[184:187], a[52:55], a[132:135], v[184:187]
v_mfma_f32_16x16x32_bf16 v[188:191], a[56:59], a[128:131], v[188:191]
v_mfma_f32_16x16x32_bf16 v[188:191], a[60:63], a[132:135], v[188:191]
s_waitcnt lgkmcnt(2)
v_mfma_f32_16x16x32_bf16 v[192:195], a[0:3], a[136:139], v[192:195]
ds_read_b64_tr_b16 a[128:129], v10 offset:0
v_mfma_f32_16x16x32_bf16 v[192:195], a[4:7], a[140:143], v[192:195]
v_mfma_f32_16x16x32_bf16 v[196:199], a[8:11], a[136:139], v[196:199]
ds_read_b64_tr_b16 a[130:131], v10 offset:2048
v_mfma_f32_16x16x32_bf16 v[196:199], a[12:15], a[140:143], v[196:199]
v_mfma_f32_16x16x32_bf16 v[200:203], a[16:19], a[136:139], v[200:203]
ds_read_b64_tr_b16 a[132:133], v10 offset:16384
v_mfma_f32_16x16x32_bf16 v[200:203], a[20:23], a[140:143], v[200:203]
v_mfma_f32_16x16x32_bf16 v[204:207], a[24:27], a[136:139], v[204:207]
ds_read_b64_tr_b16 a[134:135], v10 offset:18432
v_mfma_f32_16x16x32_bf16 v[204:207], a[28:31], a[140:143], v[204:207]
v_mfma_f32_16x16x32_bf16 v[208:211], a[32:35], a[136:139], v[208:211]
ds_read_b128 a[116:119], v3 offset:45056
v_mfma_f32_16x16x32_bf16 v[208:211], a[36:39], a[140:143], v[208:211]
v_mfma_f32_16x16x32_bf16 v[212:215], a[40:43], a[136:139], v[212:215]
ds_read_b128 a[120:123], v2 offset:47104
v_and_b32 v252, 31, v0
v_mfma_f32_16x16x32_bf16 v[212:215], a[44:47], a[140:143], v[212:215]
v_lshrrev_b32 v253, 5, v0
v_xor_b32 v253, v253, v252
v_mfma_f32_16x16x32_bf16 v[216:219], a[48:51], a[136:139], v[216:219]
v_and_b32 v253, 7, v253
v_lshlrev_b32 v252, 8, v252
v_mfma_f32_16x16x32_bf16 v[216:219], a[52:55], a[140:143], v[216:219]
v_lshl_add_u32 v252, v253, 4, v252
v_add_u32 v252, 147456, v252
v_mfma_f32_16x16x32_bf16 v[220:223], a[56:59], a[136:139], v[220:223]
ds_read_b128 a[124:127], v3 offset:47104
v_mfma_f32_16x16x32_bf16 v[220:223], a[60:63], a[140:143], v[220:223]
s_waitcnt lgkmcnt(3)
v_mfma_f32_16x16x32_bf16 a[192:195], a[0:3], a[128:131], a[192:195]
ds_read_b64_tr_b16 a[136:137], v11 offset:0
v_mfma_f32_16x16x32_bf16 a[192:195], a[4:7], a[132:135], a[192:195]
v_mfma_f32_16x16x32_bf16 a[196:199], a[8:11], a[128:131], a[196:199]
ds_read_b64_tr_b16 a[138:139], v11 offset:2048
v_mfma_f32_16x16x32_bf16 a[196:199], a[12:15], a[132:135], a[196:199]
v_mfma_f32_16x16x32_bf16 a[200:203], a[16:19], a[128:131], a[200:203]
ds_read_b64_tr_b16 a[140:141], v11 offset:16384
v_mfma_f32_16x16x32_bf16 a[200:203], a[20:23], a[132:135], a[200:203]
v_mfma_f32_16x16x32_bf16 a[204:207], a[24:27], a[128:131], a[204:207]
ds_read_b64_tr_b16 a[142:143], v11 offset:18432
v_mfma_f32_16x16x32_bf16 a[204:207], a[28:31], a[132:135], a[204:207]
v_mfma_f32_16x16x32_bf16 a[208:211], a[32:35], a[128:131], a[208:211]
v_mfma_f32_16x16x32_bf16 a[208:211], a[36:39], a[132:135], a[208:211]
v_mfma_f32_16x16x32_bf16 a[212:215], a[40:43], a[128:131], a[212:215]
v_mfma_f32_16x16x32_bf16 a[212:215], a[44:47], a[132:135], a[212:215]
v_mfma_f32_16x16x32_bf16 a[216:219], a[48:51], a[128:131], a[216:219]
v_mfma_f32_16x16x32_bf16 a[216:219], a[52:55], a[132:135], a[216:219]
v_mfma_f32_16x16x32_bf16 a[220:223], a[56:59], a[128:131], a[220:223]
s_waitcnt vmcnt(2) lgkmcnt(0)
v_mfma_f32_16x16x32_bf16 a[220:223], a[60:63], a[132:135], a[220:223]
s_barrier
v_mfma_f32_16x16x32_bf16 a[224:227], a[0:3], a[136:139], a[224:227]
s_add_u32 m0, s29, 65536
ds_read_b64_tr_b16 a[128:129], v4 offset:32768
v_lshlrev_b32 v28, 16, v248
v_mfma_f32_16x16x32_bf16 a[224:227], a[4:7], a[140:143], a[224:227]
buffer_load_dwordx4 v16, s[12:15], s26 offen offset:0 lds
v_mfma_f32_16x16x32_bf16 a[228:231], a[8:11], a[136:139], a[228:231]
ds_read_b64_tr_b16 a[130:131], v4 offset:34816
v_and_b32 v29, s58, v248
v_mfma_f32_16x16x32_bf16 a[228:231], a[12:15], a[140:143], a[228:231]
v_lshlrev_b32 v30, 16, v249
v_and_b32 v253, s58, v249
v_mfma_f32_16x16x32_bf16 a[232:235], a[16:19], a[136:139], a[232:235]
ds_read_b64_tr_b16 a[132:133], v4 offset:49152
v_lshlrev_b32 v22, 16, v224
v_mfma_f32_16x16x32_bf16 a[232:235], a[20:23], a[140:143], a[232:235]
buffer_load_dwordx4 v17, s[12:15], s26 offen offset:1024 lds
v_mfma_f32_16x16x32_bf16 a[236:239], a[24:27], a[136:139], a[236:239]
ds_read_b64_tr_b16 a[134:135], v4 offset:51200
v_lshlrev_b32 v23, 16, v225
v_mfma_f32_16x16x32_bf16 a[236:239], a[28:31], a[140:143], a[236:239]
v_lshlrev_b32 v24, 16, v226
v_mul_f32 v254, v22, v253
v_mfma_f32_16x16x32_bf16 a[240:243], a[32:35], a[136:139], a[240:243]
v_lshlrev_b32 v25, 16, v227
v_lshlrev_b32 v247, 16, v236
v_mfma_f32_16x16x32_bf16 a[240:243], a[36:39], a[140:143], a[240:243]
buffer_load_dwordx4 v18, s[12:15], s26 offen offset:2048 lds
v_mfma_f32_16x16x32_bf16 a[244:247], a[40:43], a[136:139], a[244:247]
v_fmac_f32 v254, v23, v30
v_fmac_f32 v254, v24, v29
v_mfma_f32_16x16x32_bf16 a[244:247], a[44:47], a[140:143], a[244:247]
v_fmac_f32 v254, v25, v28
v_mul_f32 v254, v254, v247
v_mfma_f32_16x16x32_bf16 a[248:251], a[48:51], a[136:139], a[248:251]
v_mul_f32 v255, v23, v253
v_lshlrev_b32 v22, 16, v228
v_mfma_f32_16x16x32_bf16 a[248:251], a[52:55], a[140:143], a[248:251]
buffer_load_dwordx4 v19, s[12:15], s26 offen offset:3072 lds
v_mfma_f32_16x16x32_bf16 a[252:255], a[56:59], a[136:139], a[252:255]
s_add_u32 s26, s26, 524288
v_lshlrev_b32 v247, 16, v237
v_fmac_f32 v255, v24, v30
v_mfma_f32_16x16x32_bf16 a[252:255], a[60:63], a[140:143], a[252:255]
s_waitcnt lgkmcnt(0)
v_fmac_f32 v255, v25, v29
v_fmac_f32 v255, v22, v28
v_mfma_f32_16x16x32_bf16 v[32:35], a[64:67], a[128:131], v[32:35]
s_add_u32 m0, s29, 81920
ds_read_b64_tr_b16 a[136:137], v5 offset:32768
v_mul_f32 v255, v255, v247
v_mfma_f32_16x16x32_bf16 v[32:35], a[68:71], a[132:135], v[32:35]
buffer_load_dwordx4 v16, s[12:15], s27 offen offset:0 lds
v_mfma_f32_16x16x32_bf16 v[36:39], a[72:75], a[128:131], v[36:39]
ds_read_b64_tr_b16 a[138:139], v5 offset:34816
v_cvt_pk_bf16_f32 v246, v254, v255
v_mfma_f32_16x16x32_bf16 v[36:39], a[76:79], a[132:135], v[36:39]
v_accvgpr_write_b32 a180, v246
v_mul_f32 v254, v24, v253
v_mfma_f32_16x16x32_bf16 v[40:43], a[80:83], a[128:131], v[40:43]
ds_read_b64_tr_b16 a[140:141], v5 offset:49152
v_lshlrev_b32 v23, 16, v229
v_mfma_f32_16x16x32_bf16 v[40:43], a[84:87], a[132:135], v[40:43]
buffer_load_dwordx4 v17, s[12:15], s27 offen offset:1024 lds
v_mfma_f32_16x16x32_bf16 v[44:47], a[88:91], a[128:131], v[44:47]
ds_read_b64_tr_b16 a[142:143], v5 offset:51200
v_lshlrev_b32 v247, 16, v238
v_mfma_f32_16x16x32_bf16 v[44:47], a[92:95], a[132:135], v[44:47]
v_fmac_f32 v254, v25, v30
v_fmac_f32 v254, v22, v29
v_fmac_f32 v254, v23, v28
v_mfma_f32_16x16x32_bf16 v[48:51], a[96:99], a[128:131], v[48:51]
ds_read_b128 a[0:3], v2 offset:0
v_mul_f32 v254, v254, v247
v_mfma_f32_16x16x32_bf16 v[48:51], a[100:103], a[132:135], v[48:51]
buffer_load_dwordx4 v18, s[12:15], s27 offen offset:2048 lds
v_mfma_f32_16x16x32_bf16 v[52:55], a[104:107], a[128:131], v[52:55]
ds_read_b128 a[4:7], v3 offset:0
v_cvt_pk_bf16_f32 v246, v255, v254
v_mfma_f32_16x16x32_bf16 v[52:55], a[108:111], a[132:135], v[52:55]
v_accvgpr_write_b32 a176, v246
v_mul_f32 v255, v25, v253
v_mfma_f32_16x16x32_bf16 v[56:59], a[112:115], a[128:131], v[56:59]
v_lshlrev_b32 v24, 16, v230
v_lshlrev_b32 v247, 16, v239
v_mfma_f32_16x16x32_bf16 v[56:59], a[116:119], a[132:135], v[56:59]
buffer_load_dwordx4 v19, s[12:15], s27 offen offset:3072 lds
v_mfma_f32_16x16x32_bf16 v[60:63], a[120:123], a[128:131], v[60:63]
s_add_u32 s27, s27, 524288
ds_read_b128 a[8:11], v2 offset:2048
v_fmac_f32 v255, v22, v30
v_mfma_f32_16x16x32_bf16 v[60:63], a[124:127], a[132:135], v[60:63]
s_waitcnt lgkmcnt(3)
v_fmac_f32 v255, v23, v29
v_fmac_f32 v255, v24, v28
v_mul_f32 v255, v255, v247
v_mfma_f32_16x16x32_bf16 v[64:67], a[64:67], a[136:139], v[64:67]
s_add_u32 m0, s28, 32768
ds_read_b64_tr_b16 a[128:129], v6 offset:32768
v_cvt_pk_bf16_f32 v246, v254, v255
v_mfma_f32_16x16x32_bf16 v[64:67], a[68:71], a[140:143], v[64:67]
buffer_load_dwordx4 v12, s[8:11], s24 offen offset:0 lds
v_mfma_f32_16x16x32_bf16 v[68:71], a[72:75], a[136:139], v[68:71]
ds_read_b64_tr_b16 a[130:131], v6 offset:34816
v_accvgpr_write_b32 a181, v246
v_mfma_f32_16x16x32_bf16 v[68:71], a[76:79], a[140:143], v[68:71]
v_mul_f32 v254, v22, v253
v_lshlrev_b32 v25, 16, v231
v_mfma_f32_16x16x32_bf16 v[72:75], a[80:83], a[136:139], v[72:75]
ds_read_b64_tr_b16 a[132:133], v6 offset:49152
v_lshlrev_b32 v247, 16, v240
v_mfma_f32_16x16x32_bf16 v[72:75], a[84:87], a[140:143], v[72:75]
buffer_load_dwordx4 v13, s[8:11], s24 offen offset:1024 lds
v_mfma_f32_16x16x32_bf16 v[76:79], a[88:91], a[136:139], v[76:79]
ds_read_b64_tr_b16 a[134:135], v6 offset:51200
v_fmac_f32 v254, v23, v30
v_fmac_f32 v254, v24, v29
v_mfma_f32_16x16x32_bf16 v[76:79], a[92:95], a[140:143], v[76:79]
v_fmac_f32 v254, v25, v28
v_mul_f32 v254, v254, v247
v_mfma_f32_16x16x32_bf16 v[80:83], a[96:99], a[136:139], v[80:83]
ds_read_b128 a[12:15], v3 offset:2048
v_cvt_pk_bf16_f32 v246, v255, v254
v_mfma_f32_16x16x32_bf16 v[80:83], a[100:103], a[140:143], v[80:83]
buffer_load_dwordx4 v14, s[8:11], s24 offen offset:2048 lds
v_mfma_f32_16x16x32_bf16 v[84:87], a[104:107], a[136:139], v[84:87]
v_accvgpr_write_b32 a177, v246
v_mul_f32 v255, v23, v253
v_mfma_f32_16x16x32_bf16 v[84:87], a[108:111], a[140:143], v[84:87]
v_lshlrev_b32 v22, 16, v232
v_lshlrev_b32 v247, 16, v241
v_mfma_f32_16x16x32_bf16 v[88:91], a[112:115], a[136:139], v[88:91]
ds_read_b128 a[16:19], v2 offset:4096
v_fmac_f32 v255, v24, v30
v_mfma_f32_16x16x32_bf16 v[88:91], a[116:119], a[140:143], v[88:91]
PAD_24:
s_cbranch_execz PAD_28
buffer_load_dwordx4 v15, s[8:11], s24 offen offset:3072 lds
v_mfma_f32_16x16x32_bf16 v[92:95], a[120:123], a[136:139], v[92:95]
s_add_u32 s24, s24, 128
ds_read_b128 a[20:23], v3 offset:4096
v_fmac_f32 v255, v25, v29
v_fmac_f32 v255, v22, v28
v_mfma_f32_16x16x32_bf16 v[92:95], a[124:127], a[140:143], v[92:95]
s_waitcnt lgkmcnt(3)
v_mul_f32 v255, v255, v247
v_cvt_pk_bf16_f32 v246, v254, v255
v_mfma_f32_16x16x32_bf16 v[96:99], a[64:67], a[128:131], v[96:99]
s_add_u32 m0, s28, 36864
ds_read_b64_tr_b16 a[136:137], v7 offset:32768
v_accvgpr_write_b32 a182, v246
v_mfma_f32_16x16x32_bf16 v[96:99], a[68:71], a[132:135], v[96:99]
buffer_load_dwordx4 v12, s[8:11], s25 offen offset:0 lds
v_mfma_f32_16x16x32_bf16 v[100:103], a[72:75], a[128:131], v[100:103]
ds_read_b64_tr_b16 a[138:139], v7 offset:34816
v_mul_f32 v254, v24, v253
v_mfma_f32_16x16x32_bf16 v[100:103], a[76:79], a[132:135], v[100:103]
v_lshlrev_b32 v23, 16, v233
v_lshlrev_b32 v247, 16, v242
v_mfma_f32_16x16x32_bf16 v[104:107], a[80:83], a[128:131], v[104:107]
ds_read_b64_tr_b16 a[140:141], v7 offset:49152
v_fmac_f32 v254, v25, v30
v_mfma_f32_16x16x32_bf16 v[104:107], a[84:87], a[132:135], v[104:107]
buffer_load_dwordx4 v13, s[8:11], s25 offen offset:1024 lds
v_fmac_f32 v254, v22, v29
v_mfma_f32_16x16x32_bf16 v[108:111], a[88:91], a[128:131], v[108:111]
ds_read_b64_tr_b16 a[142:143], v7 offset:51200
v_fmac_f32 v254, v23, v28
v_mfma_f32_16x16x32_bf16 v[108:111], a[92:95], a[132:135], v[108:111]
v_mul_f32 v254, v254, v247
v_cvt_pk_bf16_f32 v246, v255, v254
v_mfma_f32_16x16x32_bf16 v[112:115], a[96:99], a[128:131], v[112:115]
v_accvgpr_write_b32 a178, v246
v_mul_f32 v255, v25, v253
v_mfma_f32_16x16x32_bf16 v[112:115], a[100:103], a[132:135], v[112:115]
buffer_load_dwordx4 v14, s[8:11], s25 offen offset:2048 lds
v_mfma_f32_16x16x32_bf16 v[116:119], a[104:107], a[128:131], v[116:119]
ds_read_b128 a[24:27], v2 offset:6144
v_lshlrev_b32 v24, 16, v234
v_mfma_f32_16x16x32_bf16 v[116:119], a[108:111], a[132:135], v[116:119]
v_lshlrev_b32 v247, 16, v243
v_fmac_f32 v255, v22, v30
v_mfma_f32_16x16x32_bf16 v[120:123], a[112:115], a[128:131], v[120:123]
ds_read_b128 a[28:31], v3 offset:6144
v_fmac_f32 v255, v23, v29
v_mfma_f32_16x16x32_bf16 v[120:123], a[116:119], a[132:135], v[120:123]
buffer_load_dwordx4 v15, s[8:11], s25 offen offset:3072 lds
v_fmac_f32 v255, v24, v28
v_mfma_f32_16x16x32_bf16 v[124:127], a[120:123], a[128:131], v[124:127]
s_add_u32 s25, s25, 128
v_mul_f32 v255, v255, v247
v_cvt_pk_bf16_f32 v246, v254, v255
v_mfma_f32_16x16x32_bf16 v[124:127], a[124:127], a[132:135], v[124:127]
s_waitcnt lgkmcnt(2)
v_accvgpr_write_b32 a183, v246
v_mul_f32 v254, v22, v253
v_mfma_f32_16x16x32_bf16 v[128:131], a[64:67], a[136:139], v[128:131]
ds_read_b64_tr_b16 a[128:129], v8 offset:32768
v_lshlrev_b32 v25, 16, v235
v_mfma_f32_16x16x32_bf16 v[128:131], a[68:71], a[140:143], v[128:131]
buffer_load_dword v21, v20, s[16:19], s43 offen
v_mfma_f32_16x16x32_bf16 v[132:135], a[72:75], a[136:139], v[132:135]
s_add_u32 s43, s43, s47
ds_read_b64_tr_b16 a[130:131], v8 offset:34816
v_lshlrev_b32 v247, 16, v244
v_mfma_f32_16x16x32_bf16 v[132:135], a[76:79], a[140:143], v[132:135]
s_cmp_ge_u32 s43, s51
v_fmac_f32 v254, v23, v30
v_fmac_f32 v254, v24, v29
v_mfma_f32_16x16x32_bf16 v[136:139], a[80:83], a[136:139], v[136:139]
s_cselect_b32 s43, 0, s43
ds_read_b64_tr_b16 a[132:133], v8 offset:49152
v_fmac_f32 v254, v25, v28
v_mul_f32 v254, v254, v247
v_mfma_f32_16x16x32_bf16 v[136:139], a[84:87], a[140:143], v[136:139]
s_cselect_b32 s51, s42, s51
v_cvt_pk_bf16_f32 v246, v255, v254
v_accvgpr_write_b32 a179, v246
v_mfma_f32_16x16x32_bf16 v[140:143], a[88:91], a[136:139], v[140:143]
s_cselect_b64 s[16:17], s[40:41], s[16:17]
ds_read_b64_tr_b16 a[134:135], v8 offset:51200
v_lshlrev_b32 v28, 16, v250
v_mfma_f32_16x16x32_bf16 v[140:143], a[92:95], a[140:143], v[140:143]
s_cselect_b32 s18, s42, s18
v_and_b32 v29, s58, v250
v_lshlrev_b32 v30, 16, v251
v_mfma_f32_16x16x32_bf16 v[144:147], a[96:99], a[136:139], v[144:147]
s_cselect_b64 s[40:41], s[44:45], s[40:41]
ds_read_b128 a[32:35], v2 offset:8192
v_and_b32 v253, s58, v251
v_mfma_f32_16x16x32_bf16 v[144:147], a[100:103], a[140:143], v[144:147]
s_cselect_b32 s42, s46, s42
v_and_b32 v22, s58, v224
v_and_b32 v23, s58, v225
v_mfma_f32_16x16x32_bf16 v[148:151], a[104:107], a[136:139], v[148:151]
s_cselect_b32 s46, 0, s46
v_and_b32 v24, s58, v226
v_mul_f32 v254, v22, v253
v_mfma_f32_16x16x32_bf16 v[148:151], a[108:111], a[140:143], v[148:151]
buffer_load_dword v245, off, s[60:63], 0 sc1
v_mfma_f32_16x16x32_bf16 v[152:155], a[112:115], a[136:139], v[152:155]
ds_read_b128 a[36:39], v3 offset:8192
v_and_b32 v25, s58, v227
v_and_b32 v247, s58, v236
v_mfma_f32_16x16x32_bf16 v[152:155], a[116:119], a[140:143], v[152:155]
v_fmac_f32 v254, v23, v30
v_fmac_f32 v254, v24, v29
v_mfma_f32_16x16x32_bf16 v[156:159], a[120:123], a[136:139], v[156:159]
ds_read_b128 a[40:43], v2 offset:10240
v_fmac_f32 v254, v25, v28
v_mfma_f32_16x16x32_bf16 v[156:159], a[124:127], a[140:143], v[156:159]
s_waitcnt lgkmcnt(3)
v_mul_f32 v254, v254, v247
v_mul_f32 v255, v23, v253
v_mfma_f32_16x16x32_bf16 v[160:163], a[64:67], a[128:131], v[160:163]
ds_read_b64_tr_b16 a[136:137], v9 offset:32768
v_and_b32 v22, s58, v228
v_mfma_f32_16x16x32_bf16 v[160:163], a[68:71], a[132:135], v[160:163]
v_and_b32 v247, s58, v237
v_fmac_f32 v255, v24, v30
v_mfma_f32_16x16x32_bf16 v[164:167], a[72:75], a[128:131], v[164:167]
ds_read_b64_tr_b16 a[138:139], v9 offset:34816
v_fmac_f32 v255, v25, v29
v_mfma_f32_16x16x32_bf16 v[164:167], a[76:79], a[132:135], v[164:167]
v_fmac_f32 v255, v22, v28
v_mul_f32 v255, v255, v247
v_mfma_f32_16x16x32_bf16 v[168:171], a[80:83], a[128:131], v[168:171]
ds_read_b64_tr_b16 a[140:141], v9 offset:49152
v_cvt_pk_bf16_f32 v246, v254, v255
v_accvgpr_write_b32 a188, v246
v_mfma_f32_16x16x32_bf16 v[168:171], a[84:87], a[132:135], v[168:171]
v_mul_f32 v254, v24, v253
v_and_b32 v23, s58, v229
v_mfma_f32_16x16x32_bf16 v[172:175], a[88:91], a[128:131], v[172:175]
ds_read_b64_tr_b16 a[142:143], v9 offset:51200
v_and_b32 v247, s58, v238
v_mfma_f32_16x16x32_bf16 v[172:175], a[92:95], a[132:135], v[172:175]
v_fmac_f32 v254, v25, v30
v_fmac_f32 v254, v22, v29
v_mfma_f32_16x16x32_bf16 v[176:179], a[96:99], a[128:131], v[176:179]
v_fmac_f32 v254, v23, v28
v_mul_f32 v254, v254, v247
v_mfma_f32_16x16x32_bf16 v[176:179], a[100:103], a[132:135], v[176:179]
v_cvt_pk_bf16_f32 v246, v255, v254
v_accvgpr_write_b32 a184, v246
v_mfma_f32_16x16x32_bf16 v[180:183], a[104:107], a[128:131], v[180:183]
ds_read_b128 a[44:47], v3 offset:10240
v_mul_f32 v255, v25, v253
v_mfma_f32_16x16x32_bf16 v[180:183], a[108:111], a[132:135], v[180:183]
v_and_b32 v24, s58, v230
v_and_b32 v247, s58, v239
v_fmac_f32 v255, v22, v30
v_mfma_f32_16x16x32_bf16 v[184:187], a[112:115], a[128:131], v[184:187]
ds_read_b128 a[48:51], v2 offset:12288
v_fmac_f32 v255, v23, v29
v_mfma_f32_16x16x32_bf16 v[184:187], a[116:119], a[132:135], v[184:187]
v_fmac_f32 v255, v24, v28
v_mul_f32 v255, v255, v247
v_mfma_f32_16x16x32_bf16 v[188:191], a[120:123], a[128:131], v[188:191]
v_cvt_pk_bf16_f32 v246, v254, v255
v_accvgpr_write_b32 a189, v246
v_mfma_f32_16x16x32_bf16 v[188:191], a[124:127], a[132:135], v[188:191]
s_waitcnt lgkmcnt(2)
v_mul_f32 v254, v22, v253
v_and_b32 v25, s58, v231
v_mfma_f32_16x16x32_bf16 v[192:195], a[64:67], a[136:139], v[192:195]
ds_read_b64_tr_b16 a[128:129], v10 offset:32768
v_and_b32 v247, s58, v240
v_mfma_f32_16x16x32_bf16 v[192:195], a[68:71], a[140:143], v[192:195]
v_fmac_f32 v254, v23, v30
v_fmac_f32 v254, v24, v29
v_mfma_f32_16x16x32_bf16 v[196:199], a[72:75], a[136:139], v[196:199]
ds_read_b64_tr_b16 a[130:131], v10 offset:34816
v_fmac_f32 v254, v25, v28
v_mfma_f32_16x16x32_bf16 v[196:199], a[76:79], a[140:143], v[196:199]
v_mul_f32 v254, v254, v247
v_cvt_pk_bf16_f32 v246, v255, v254
v_accvgpr_write_b32 a185, v246
v_mfma_f32_16x16x32_bf16 v[200:203], a[80:83], a[136:139], v[200:203]
s_lshr_b32 s22, s3, 1
ds_read_b64_tr_b16 a[132:133], v10 offset:49152
v_mul_f32 v255, v23, v253
v_mfma_f32_16x16x32_bf16 v[200:203], a[84:87], a[140:143], v[200:203]
s_mul_i32 s22, s22, 2097152
v_and_b32 v22, s58, v232
v_and_b32 v247, s58, v241
v_mfma_f32_16x16x32_bf16 v[204:207], a[88:91], a[136:139], v[204:207]
s_and_b32 s23, s3, 1
ds_read_b64_tr_b16 a[134:135], v10 offset:51200
v_fmac_f32 v255, v24, v30
v_mfma_f32_16x16x32_bf16 v[204:207], a[92:95], a[140:143], v[204:207]
s_lshl_b32 s23, s23, 5
v_fmac_f32 v255, v25, v29
v_fmac_f32 v255, v22, v28
v_mfma_f32_16x16x32_bf16 v[208:211], a[96:99], a[136:139], v[208:211]
s_lshl_b32 s56, s39, 6
ds_read_b128 a[52:55], v3 offset:12288
v_mul_f32 v255, v255, v247
v_mfma_f32_16x16x32_bf16 v[208:211], a[100:103], a[140:143], v[208:211]
s_add_u32 s23, s23, s56
v_cvt_pk_bf16_f32 v246, v254, v255
v_accvgpr_write_b32 a190, v246
v_mfma_f32_16x16x32_bf16 v[212:215], a[104:107], a[136:139], v[212:215]
s_mul_i32 s23, s23, 4224
ds_read_b128 a[56:59], v2 offset:14336
v_mul_f32 v254, v24, v253
v_and_b32 v23, s58, v233
v_mfma_f32_16x16x32_bf16 v[212:215], a[108:111], a[140:143], v[212:215]
s_add_u32 s22, s22, s23
v_and_b32 v247, s58, v242
v_fmac_f32 v254, v25, v30
v_mfma_f32_16x16x32_bf16 v[216:219], a[112:115], a[136:139], v[216:219]
s_add_u32 s57, s22, 83886200
v_fmac_f32 v254, v22, v29
v_fmac_f32 v254, v23, v28
v_mfma_f32_16x16x32_bf16 v[216:219], a[116:119], a[140:143], v[216:219]
s_lshl_b32 s23, s38, 7
v_mul_f32 v254, v254, v247
v_cvt_pk_bf16_f32 v246, v255, v254
v_mfma_f32_16x16x32_bf16 v[220:223], a[120:123], a[136:139], v[220:223]
s_add_u32 s22, s22, s23
ds_read_b128 a[60:63], v3 offset:14336
v_accvgpr_write_b32 a186, v246
v_mfma_f32_16x16x32_bf16 v[220:223], a[124:127], a[140:143], v[220:223]
s_waitcnt lgkmcnt(3)
s_add_u32 s56, s22, 83886208
v_mul_f32 v255, v25, v253
v_and_b32 v24, s58, v234
v_mfma_f32_16x16x32_bf16 a[192:195], a[64:67], a[128:131], a[192:195]
s_cmp_lt_u32 s2, 224
ds_read_b64_tr_b16 a[136:137], v11 offset:32768
v_and_b32 v247, s58, v243
v_mfma_f32_16x16x32_bf16 a[192:195], a[68:71], a[132:135], a[192:195]
s_cselect_b32 s56, s56, 3221225472
v_fmac_f32 v255, v22, v30
v_fmac_f32 v255, v23, v29
v_mfma_f32_16x16x32_bf16 a[196:199], a[72:75], a[128:131], a[196:199]
s_cmp_eq_u32 s38, 0
ds_read_b64_tr_b16 a[138:139], v11 offset:34816
v_fmac_f32 v255, v24, v28
v_mul_f32 v255, v255, v247
v_mfma_f32_16x16x32_bf16 a[196:199], a[76:79], a[132:135], a[196:199]
s_cselect_b32 s57, s57, 3221225472
v_cvt_pk_bf16_f32 v246, v254, v255
v_accvgpr_write_b32 a191, v246
v_mfma_f32_16x16x32_bf16 a[200:203], a[80:83], a[128:131], a[200:203]
ds_read_b64_tr_b16 a[140:141], v11 offset:49152
v_mul_f32 v254, v22, v253
v_mfma_f32_16x16x32_bf16 a[200:203], a[84:87], a[132:135], a[200:203]
v_and_b32 v25, s58, v235
v_and_b32 v247, s58, v244
v_mfma_f32_16x16x32_bf16 a[204:207], a[88:91], a[128:131], a[204:207]
ds_read_b64_tr_b16 a[142:143], v11 offset:51200
v_fmac_f32 v254, v23, v30
v_mfma_f32_16x16x32_bf16 a[204:207], a[92:95], a[132:135], a[204:207]
ds_write_b128 v252, a[176:179] offset:0
v_fmac_f32 v254, v24, v29
v_mfma_f32_16x16x32_bf16 a[208:211], a[96:99], a[128:131], a[208:211]
v_fmac_f32 v254, v25, v28
v_mul_f32 v254, v254, v247
v_mfma_f32_16x16x32_bf16 a[208:211], a[100:103], a[132:135], a[208:211]
ds_write_b128 v252, a[180:183] offset:8192
v_cvt_pk_bf16_f32 v246, v255, v254
v_accvgpr_write_b32 a187, v246
v_mfma_f32_16x16x32_bf16 a[212:215], a[104:107], a[128:131], a[212:215]
v_mfma_f32_16x16x32_bf16 a[212:215], a[108:111], a[132:135], a[212:215]
ds_write_b128 v252, a[184:187] offset:128
v_mfma_f32_16x16x32_bf16 a[216:219], a[112:115], a[128:131], a[216:219]
v_mfma_f32_16x16x32_bf16 a[216:219], a[116:119], a[132:135], a[216:219]
ds_write_b128 v252, a[188:191] offset:8320
v_mfma_f32_16x16x32_bf16 a[220:223], a[120:123], a[128:131], a[220:223]
s_waitcnt vmcnt(2) lgkmcnt(0)
v_mfma_f32_16x16x32_bf16 a[220:223], a[124:127], a[132:135], a[220:223]
s_barrier
v_mfma_f32_16x16x32_bf16 a[224:227], a[64:67], a[136:139], a[224:227]
s_add_u32 m0, s29, 98304
ds_read_b64_tr_b16 a[128:129], v4 offset:0
v_lshrrev_b32 v22, 8, v1
v_mfma_f32_16x16x32_bf16 a[224:227], a[68:71], a[140:143], a[224:227]
buffer_load_dwordx4 v16, s[12:15], s26 offen offset:0 lds
v_mfma_f32_16x16x32_bf16 a[228:231], a[72:75], a[136:139], a[228:231]
ds_read_b64_tr_b16 a[130:131], v4 offset:2048
v_lshlrev_b32 v22, 4, v22
v_mfma_f32_16x16x32_bf16 a[228:231], a[76:79], a[140:143], a[228:231]
v_xor_b32 v22, v22, v1
v_add_u32 v22, s29, v22
v_mfma_f32_16x16x32_bf16 a[232:235], a[80:83], a[136:139], a[232:235]
ds_read_b64_tr_b16 a[132:133], v4 offset:16384
v_add_u32 v22, 147456, v22
v_mfma_f32_16x16x32_bf16 a[232:235], a[84:87], a[140:143], a[232:235]
buffer_load_dwordx4 v17, s[12:15], s26 offen offset:1024 lds
v_mfma_f32_16x16x32_bf16 a[236:239], a[88:91], a[136:139], a[236:239]
ds_read_b64_tr_b16 a[134:135], v4 offset:18432
v_xor_b32 v23, 64, v22
v_mfma_f32_16x16x32_bf16 a[236:239], a[92:95], a[140:143], a[236:239]
v_lshrrev_b32 v224, 7, v1
v_mul_u32_u24 v224, 4224, v224
v_mfma_f32_16x16x32_bf16 a[240:243], a[96:99], a[136:139], a[240:243]
v_and_b32 v225, 0x70, v1
v_add_u32 v224, v224, v225
v_mfma_f32_16x16x32_bf16 a[240:243], a[100:103], a[140:143], a[240:243]
buffer_load_dwordx4 v18, s[12:15], s26 offen offset:2048 lds
v_mfma_f32_16x16x32_bf16 a[244:247], a[104:107], a[136:139], a[244:247]
v_bfe_u32 v225, v1, 4, 5
v_mul_u32_u24 v225, 4224, v225
v_mfma_f32_16x16x32_bf16 a[244:247], a[108:111], a[140:143], a[244:247]
v_mov_b32 v226, 0
v_mov_b32 v227, 0
v_mfma_f32_16x16x32_bf16 a[248:251], a[112:115], a[136:139], a[248:251]
v_mfma_f32_16x16x32_bf16 a[248:251], a[116:119], a[140:143], a[248:251]
buffer_load_dwordx4 v19, s[12:15], s26 offen offset:3072 lds
v_mfma_f32_16x16x32_bf16 a[252:255], a[120:123], a[136:139], a[252:255]
s_add_u32 s26, s26, 524288
v_mfma_f32_16x16x32_bf16 a[252:255], a[124:127], a[140:143], a[252:255]
s_waitcnt lgkmcnt(0)
v_mfma_f32_16x16x32_bf16 v[32:35], a[0:3], a[128:131], v[32:35]
s_add_u32 m0, s29, 114688
ds_read_b64_tr_b16 a[136:137], v5 offset:0
v_mfma_f32_16x16x32_bf16 v[32:35], a[4:7], a[132:135], v[32:35]
buffer_load_dwordx4 v16, s[12:15], s27 offen offset:0 lds
v_mfma_f32_16x16x32_bf16 v[36:39], a[8:11], a[128:131], v[36:39]
s_mul_i32 s52, s20, 7
ds_read_b64_tr_b16 a[138:139], v5 offset:2048
v_mfma_f32_16x16x32_bf16 v[36:39], a[12:15], a[132:135], v[36:39]
s_add_u32 s52, s52, s21
buffer_store_dwordx2 v[226:227], v225, s[4:7], s57 offen sc1
v_mfma_f32_16x16x32_bf16 v[40:43], a[16:19], a[128:131], v[40:43]
s_lshl_b32 s53, s52, 2
ds_read_b64_tr_b16 a[140:141], v5 offset:16384
v_mfma_f32_16x16x32_bf16 v[40:43], a[20:23], a[132:135], v[40:43]
s_add_u32 s53, s53, s3
buffer_load_dwordx4 v17, s[12:15], s27 offen offset:1024 lds
v_mfma_f32_16x16x32_bf16 v[44:47], a[24:27], a[128:131], v[44:47]
s_lshl_b32 s49, s53, 12
ds_read_b64_tr_b16 a[142:143], v5 offset:18432
v_mfma_f32_16x16x32_bf16 v[44:47], a[28:31], a[132:135], v[44:47]
s_mul_i32 s53, s53, 4224
v_mfma_f32_16x16x32_bf16 v[48:51], a[32:35], a[128:131], v[48:51]
s_add_u32 s53, s53, 83886080
ds_read_b128 a[64:67], v2 offset:32768
v_mfma_f32_16x16x32_bf16 v[48:51], a[36:39], a[132:135], v[48:51]
s_lshr_b32 s52, s52, 4
buffer_load_dwordx4 v18, s[12:15], s27 offen offset:2048 lds
v_mfma_f32_16x16x32_bf16 v[52:55], a[40:43], a[128:131], v[52:55]
s_min_u32 s52, s52, 6
ds_read_b128 a[68:71], v3 offset:32768
v_mfma_f32_16x16x32_bf16 v[52:55], a[44:47], a[132:135], v[52:55]
s_lshl_b32 s52, s52, 7
ds_read_b128 a[176:179], v22 offset:0
v_mfma_f32_16x16x32_bf16 v[56:59], a[48:51], a[128:131], v[56:59]
s_add_u32 s52, s52, 94392320
ds_read_b128 a[180:183], v23 offset:1024
v_mfma_f32_16x16x32_bf16 v[56:59], a[52:55], a[132:135], v[56:59]
buffer_load_dwordx4 v19, s[12:15], s27 offen offset:3072 lds
v_mfma_f32_16x16x32_bf16 v[60:63], a[56:59], a[128:131], v[60:63]
s_add_u32 s27, s27, 524288
ds_read_b128 a[72:75], v2 offset:34816
v_mfma_f32_16x16x32_bf16 v[60:63], a[60:63], a[132:135], v[60:63]
s_waitcnt lgkmcnt(5)
ds_read_b128 a[184:187], v22 offset:2048
v_mfma_f32_16x16x32_bf16 v[64:67], a[0:3], a[136:139], v[64:67]
s_add_u32 m0, s28, 0
ds_read_b64_tr_b16 a[128:129], v6 offset:0
v_mfma_f32_16x16x32_bf16 v[64:67], a[4:7], a[140:143], v[64:67]
buffer_load_dwordx4 v12, s[8:11], s24 offen offset:0 lds
v_mfma_f32_16x16x32_bf16 v[68:71], a[8:11], a[136:139], v[68:71]
ds_read_b64_tr_b16 a[130:131], v6 offset:2048
v_mfma_f32_16x16x32_bf16 v[68:71], a[12:15], a[140:143], v[68:71]
ds_read_b128 a[188:191], v23 offset:3072
v_mfma_f32_16x16x32_bf16 v[72:75], a[16:19], a[136:139], v[72:75]
ds_read_b64_tr_b16 a[132:133], v6 offset:16384
v_bfe_u32 v231, v1, 4, 5
v_mfma_f32_16x16x32_bf16 v[72:75], a[20:23], a[140:143], v[72:75]
buffer_load_dwordx4 v13, s[8:11], s24 offen offset:1024 lds
v_mfma_f32_16x16x32_bf16 v[76:79], a[24:27], a[136:139], v[76:79]
ds_read_b64_tr_b16 a[134:135], v6 offset:18432
v_lshlrev_b32 v231, 2, v231
v_mfma_f32_16x16x32_bf16 v[76:79], a[28:31], a[140:143], v[76:79]
v_lshlrev_b32 v229, 3, v1
v_min_u32 v229, 4096, v229
v_mfma_f32_16x16x32_bf16 v[80:83], a[32:35], a[136:139], v[80:83]
ds_read_b128 a[76:79], v3 offset:34816
v_mfma_f32_16x16x32_bf16 v[80:83], a[36:39], a[140:143], v[80:83]
buffer_load_dwordx4 v14, s[8:11], s24 offen offset:2048 lds
v_mfma_f32_16x16x32_bf16 v[84:87], a[40:43], a[136:139], v[84:87]
v_mfma_f32_16x16x32_bf16 v[84:87], a[44:47], a[140:143], v[84:87]
v_mfma_f32_16x16x32_bf16 v[88:91], a[48:51], a[136:139], v[88:91]
ds_read_b128 a[80:83], v2 offset:36864
v_mfma_f32_16x16x32_bf16 v[88:91], a[52:55], a[140:143], v[88:91]
buffer_load_dwordx4 v15, s[8:11], s24 offen offset:3072 lds
v_mfma_f32_16x16x32_bf16 v[92:95], a[56:59], a[136:139], v[92:95]
s_add_u32 s24, s24, 128
ds_read_b128 a[84:87], v3 offset:36864
v_mfma_f32_16x16x32_bf16 v[92:95], a[60:63], a[140:143], v[92:95]
s_waitcnt lgkmcnt(3)
v_mfma_f32_16x16x32_bf16 v[96:99], a[0:3], a[128:131], v[96:99]
s_add_u32 m0, s28, 4096
ds_read_b64_tr_b16 a[136:137], v7 offset:0
v_mfma_f32_16x16x32_bf16 v[96:99], a[4:7], a[132:135], v[96:99]
buffer_load_dwordx4 v12, s[8:11], s25 offen offset:0 lds
v_mfma_f32_16x16x32_bf16 v[100:103], a[8:11], a[128:131], v[100:103]
ds_read_b64_tr_b16 a[138:139], v7 offset:2048
v_mfma_f32_16x16x32_bf16 v[100:103], a[12:15], a[132:135], v[100:103]
v_mfma_f32_16x16x32_bf16 v[104:107], a[16:19], a[128:131], v[104:107]
ds_read_b64_tr_b16 a[140:141], v7 offset:16384
v_mfma_f32_16x16x32_bf16 v[104:107], a[20:23], a[132:135], v[104:107]
buffer_load_dwordx4 v13, s[8:11], s25 offen offset:1024 lds
v_mfma_f32_16x16x32_bf16 v[108:111], a[24:27], a[128:131], v[108:111]
ds_read_b64_tr_b16 a[142:143], v7 offset:18432
v_mfma_f32_16x16x32_bf16 v[108:111], a[28:31], a[132:135], v[108:111]
v_mfma_f32_16x16x32_bf16 v[112:115], a[32:35], a[128:131], v[112:115]
v_mfma_f32_16x16x32_bf16 v[112:115], a[36:39], a[132:135], v[112:115]
buffer_load_dwordx4 v14, s[8:11], s25 offen offset:2048 lds
v_mfma_f32_16x16x32_bf16 v[116:119], a[40:43], a[128:131], v[116:119]
ds_read_b128 a[88:91], v2 offset:38912
v_mfma_f32_16x16x32_bf16 v[116:119], a[44:47], a[132:135], v[116:119]
v_mfma_f32_16x16x32_bf16 v[120:123], a[48:51], a[128:131], v[120:123]
ds_read_b128 a[92:95], v3 offset:38912
v_mfma_f32_16x16x32_bf16 v[120:123], a[52:55], a[132:135], v[120:123]
buffer_load_dwordx4 v15, s[8:11], s25 offen offset:3072 lds
v_mfma_f32_16x16x32_bf16 v[124:127], a[56:59], a[128:131], v[124:127]
s_add_u32 s25, s25, 128
v_mfma_f32_16x16x32_bf16 v[124:127], a[60:63], a[132:135], v[124:127]
s_waitcnt lgkmcnt(2)
v_mfma_f32_16x16x32_bf16 v[128:131], a[0:3], a[136:139], v[128:131]
ds_read_b64_tr_b16 a[128:129], v8 offset:0
v_mfma_f32_16x16x32_bf16 v[128:131], a[4:7], a[140:143], v[128:131]
buffer_store_dwordx4 a[176:179], v224, s[4:7], s56 offen sc1
v_mfma_f32_16x16x32_bf16 v[132:135], a[8:11], a[136:139], v[132:135]
s_add_u32 s56, s56, 33792
ds_read_b64_tr_b16 a[130:131], v8 offset:2048
v_mfma_f32_16x16x32_bf16 v[132:135], a[12:15], a[140:143], v[132:135]
v_mfma_f32_16x16x32_bf16 v[136:139], a[16:19], a[136:139], v[136:139]
ds_read_b64_tr_b16 a[132:133], v8 offset:16384
v_mfma_f32_16x16x32_bf16 v[136:139], a[20:23], a[140:143], v[136:139]
v_mfma_f32_16x16x32_bf16 v[140:143], a[24:27], a[136:139], v[140:143]
s_cmp_lt_u32 s21, 7
ds_read_b64_tr_b16 a[134:135], v8 offset:18432
v_mfma_f32_16x16x32_bf16 v[140:143], a[28:31], a[140:143], v[140:143]
s_cselect_b32 s53, s53, 3221225472
v_mfma_f32_16x16x32_bf16 v[144:147], a[32:35], a[136:139], v[144:147]
s_cselect_b32 s49, s49, 3221225472
ds_read_b128 a[96:99], v2 offset:40960
v_mfma_f32_16x16x32_bf16 v[144:147], a[36:39], a[140:143], v[144:147]
s_add_u32 s48, s53, 2097152
v_mfma_f32_16x16x32_bf16 v[148:151], a[40:43], a[136:139], v[148:151]
v_mfma_f32_16x16x32_bf16 v[148:151], a[44:47], a[140:143], v[148:151]
v_mfma_f32_16x16x32_bf16 v[152:155], a[48:51], a[136:139], v[152:155]
ds_read_b128 a[100:103], v3 offset:40960
v_mfma_f32_16x16x32_bf16 v[152:155], a[52:55], a[140:143], v[152:155]
v_mfma_f32_16x16x32_bf16 v[156:159], a[56:59], a[136:139], v[156:159]
ds_read_b128 a[104:107], v2 offset:43008
v_mfma_f32_16x16x32_bf16 v[156:159], a[60:63], a[140:143], v[156:159]
s_waitcnt lgkmcnt(3)
v_mfma_f32_16x16x32_bf16 v[160:163], a[0:3], a[128:131], v[160:163]
ds_read_b64_tr_b16 a[136:137], v9 offset:0
v_mfma_f32_16x16x32_bf16 v[160:163], a[4:7], a[132:135], v[160:163]
v_mfma_f32_16x16x32_bf16 v[164:167], a[8:11], a[128:131], v[164:167]
ds_read_b64_tr_b16 a[138:139], v9 offset:2048
v_mfma_f32_16x16x32_bf16 v[164:167], a[12:15], a[132:135], v[164:167]
buffer_store_dwordx4 a[180:183], v224, s[4:7], s56 offen sc1
v_mfma_f32_16x16x32_bf16 v[168:171], a[16:19], a[128:131], v[168:171]
s_add_u32 s56, s56, 33792
ds_read_b64_tr_b16 a[140:141], v9 offset:16384
v_mfma_f32_16x16x32_bf16 v[168:171], a[20:23], a[132:135], v[168:171]
v_mfma_f32_16x16x32_bf16 v[172:175], a[24:27], a[128:131], v[172:175]
ds_read_b64_tr_b16 a[142:143], v9 offset:18432
v_mfma_f32_16x16x32_bf16 v[172:175], a[28:31], a[132:135], v[172:175]
v_mfma_f32_16x16x32_bf16 v[176:179], a[32:35], a[128:131], v[176:179]
v_mfma_f32_16x16x32_bf16 v[176:179], a[36:39], a[132:135], v[176:179]
v_mfma_f32_16x16x32_bf16 v[180:183], a[40:43], a[128:131], v[180:183]
ds_read_b128 a[108:111], v3 offset:43008
v_mfma_f32_16x16x32_bf16 v[180:183], a[44:47], a[132:135], v[180:183]
v_mfma_f32_16x16x32_bf16 v[184:187], a[48:51], a[128:131], v[184:187]
ds_read_b128 a[112:115], v2 offset:45056
v_mfma_f32_16x16x32_bf16 v[184:187], a[52:55], a[132:135], v[184:187]
v_mfma_f32_16x16x32_bf16 v[188:191], a[56:59], a[128:131], v[188:191]
v_mfma_f32_16x16x32_bf16 v[188:191], a[60:63], a[132:135], v[188:191]
s_waitcnt lgkmcnt(2)
v_mfma_f32_16x16x32_bf16 v[192:195], a[0:3], a[136:139], v[192:195]
ds_read_b64_tr_b16 a[128:129], v10 offset:0
v_mfma_f32_16x16x32_bf16 v[192:195], a[4:7], a[140:143], v[192:195]
v_mfma_f32_16x16x32_bf16 v[196:199], a[8:11], a[136:139], v[196:199]
ds_read_b64_tr_b16 a[130:131], v10 offset:2048
v_mfma_f32_16x16x32_bf16 v[196:199], a[12:15], a[140:143], v[196:199]
v_mfma_f32_16x16x32_bf16 v[200:203], a[16:19], a[136:139], v[200:203]
ds_read_b64_tr_b16 a[132:133], v10 offset:16384
v_mfma_f32_16x16x32_bf16 v[200:203], a[20:23], a[140:143], v[200:203]
buffer_store_dwordx4 a[184:187], v224, s[4:7], s56 offen sc1
v_mfma_f32_16x16x32_bf16 v[204:207], a[24:27], a[136:139], v[204:207]
s_add_u32 s56, s56, 33792
ds_read_b64_tr_b16 a[134:135], v10 offset:18432
v_mfma_f32_16x16x32_bf16 v[204:207], a[28:31], a[140:143], v[204:207]
v_mfma_f32_16x16x32_bf16 v[208:211], a[32:35], a[136:139], v[208:211]
ds_read_b128 a[116:119], v3 offset:45056
v_mfma_f32_16x16x32_bf16 v[208:211], a[36:39], a[140:143], v[208:211]
v_mfma_f32_16x16x32_bf16 v[212:215], a[40:43], a[136:139], v[212:215]
ds_read_b128 a[120:123], v2 offset:47104
v_mfma_f32_16x16x32_bf16 v[212:215], a[44:47], a[140:143], v[212:215]
v_mfma_f32_16x16x32_bf16 v[216:219], a[48:51], a[136:139], v[216:219]
v_mfma_f32_16x16x32_bf16 v[216:219], a[52:55], a[140:143], v[216:219]
v_mfma_f32_16x16x32_bf16 v[220:223], a[56:59], a[136:139], v[220:223]
ds_read_b128 a[124:127], v3 offset:47104
v_mfma_f32_16x16x32_bf16 v[220:223], a[60:63], a[140:143], v[220:223]
s_waitcnt lgkmcnt(3)
v_mfma_f32_16x16x32_bf16 a[192:195], a[0:3], a[128:131], a[192:195]
ds_read_b64_tr_b16 a[136:137], v11 offset:0
v_mfma_f32_16x16x32_bf16 a[192:195], a[4:7], a[132:135], a[192:195]
v_mfma_f32_16x16x32_bf16 a[196:199], a[8:11], a[128:131], a[196:199]
ds_read_b64_tr_b16 a[138:139], v11 offset:2048
v_mfma_f32_16x16x32_bf16 a[196:199], a[12:15], a[132:135], a[196:199]
v_mfma_f32_16x16x32_bf16 a[200:203], a[16:19], a[128:131], a[200:203]
ds_read_b64_tr_b16 a[140:141], v11 offset:16384
v_mfma_f32_16x16x32_bf16 a[200:203], a[20:23], a[132:135], a[200:203]
v_mfma_f32_16x16x32_bf16 a[204:207], a[24:27], a[128:131], a[204:207]
ds_read_b64_tr_b16 a[142:143], v11 offset:18432
v_mfma_f32_16x16x32_bf16 a[204:207], a[28:31], a[132:135], a[204:207]
buffer_store_dwordx4 a[188:191], v224, s[4:7], s56 offen sc1
v_mfma_f32_16x16x32_bf16 a[208:211], a[32:35], a[128:131], a[208:211]
s_add_u32 s56, s56, 33792
v_mfma_f32_16x16x32_bf16 a[208:211], a[36:39], a[132:135], a[208:211]
v_mfma_f32_16x16x32_bf16 a[212:215], a[40:43], a[128:131], a[212:215]
v_mfma_f32_16x16x32_bf16 a[212:215], a[44:47], a[132:135], a[212:215]
v_mfma_f32_16x16x32_bf16 a[216:219], a[48:51], a[128:131], a[216:219]
v_mfma_f32_16x16x32_bf16 a[216:219], a[52:55], a[132:135], a[216:219]
v_mfma_f32_16x16x32_bf16 a[220:223], a[56:59], a[128:131], a[220:223]
s_waitcnt vmcnt(4) lgkmcnt(0)
v_mfma_f32_16x16x32_bf16 a[220:223], a[60:63], a[132:135], a[220:223]
s_barrier
v_mfma_f32_16x16x32_bf16 a[224:227], a[0:3], a[136:139], a[224:227]
s_add_u32 m0, s29, 65536
ds_read_b64_tr_b16 a[128:129], v4 offset:32768
v_mfma_f32_16x16x32_bf16 a[224:227], a[4:7], a[140:143], a[224:227]
buffer_load_dwordx4 v16, s[12:15], s26 offen offset:0 lds
v_mfma_f32_16x16x32_bf16 a[228:231], a[8:11], a[136:139], a[228:231]
ds_read_b64_tr_b16 a[130:131], v4 offset:34816
v_cmp_gt_u32 vcc, 0x100, v245
v_mfma_f32_16x16x32_bf16 a[228:231], a[12:15], a[140:143], a[228:231]
v_mfma_f32_16x16x32_bf16 a[232:235], a[16:19], a[136:139], a[232:235]
ds_read_b64_tr_b16 a[132:133], v4 offset:49152
v_mfma_f32_16x16x32_bf16 a[232:235], a[20:23], a[140:143], a[232:235]
buffer_load_dwordx4 v17, s[12:15], s26 offen offset:1024 lds
v_mfma_f32_16x16x32_bf16 a[236:239], a[24:27], a[136:139], a[236:239]
ds_read_b64_tr_b16 a[134:135], v4 offset:51200
v_mfma_f32_16x16x32_bf16 a[236:239], a[28:31], a[140:143], a[236:239]
v_mfma_f32_16x16x32_bf16 a[240:243], a[32:35], a[136:139], a[240:243]
v_mfma_f32_16x16x32_bf16 a[240:243], a[36:39], a[140:143], a[240:243]
buffer_load_dwordx4 v18, s[12:15], s26 offen offset:2048 lds
v_mfma_f32_16x16x32_bf16 a[244:247], a[40:43], a[136:139], a[244:247]
v_mfma_f32_16x16x32_bf16 a[244:247], a[44:47], a[140:143], a[244:247]
v_mfma_f32_16x16x32_bf16 a[248:251], a[48:51], a[136:139], a[248:251]
v_mfma_f32_16x16x32_bf16 a[248:251], a[52:55], a[140:143], a[248:251]
buffer_load_dwordx4 v19, s[12:15], s26 offen offset:3072 lds
v_mfma_f32_16x16x32_bf16 a[252:255], a[56:59], a[136:139], a[252:255]
s_add_u32 s26, s26, 524288
v_mfma_f32_16x16x32_bf16 a[252:255], a[60:63], a[140:143], a[252:255]
s_waitcnt lgkmcnt(0)
s_mov_b32 s82, s59
s_cbranch_vccnz M_cntspinV
s_branch Lg_501
PAD_25:
s_cbranch_execz PAD_29
Lg_501t:
buffer_load_dword v230, v231, s[4:7], s52 offen sc1
v_mfma_f32_16x16x32_bf16 v[32:35], a[64:67], a[128:131], v[32:35]
s_add_u32 m0, s29, 81920
ds_read_b64_tr_b16 a[136:137], v5 offset:32768
v_mfma_f32_16x16x32_bf16 v[32:35], a[68:71], a[132:135], v[32:35]
buffer_load_dwordx4 v16, s[12:15], s27 offen offset:0 lds
v_mfma_f32_16x16x32_bf16 v[36:39], a[72:75], a[128:131], v[36:39]
s_and_b32 s44, s3, 1
ds_read_b64_tr_b16 a[138:139], v5 offset:34816
v_mfma_f32_16x16x32_bf16 v[36:39], a[76:79], a[132:135], v[36:39]
s_lshl_b32 s44, s44, 8
v_mfma_f32_16x16x32_bf16 v[40:43], a[80:83], a[128:131], v[40:43]
s_lshl_b32 s45, s3, 7
ds_read_b64_tr_b16 a[140:141], v5 offset:49152
v_mfma_f32_16x16x32_bf16 v[40:43], a[84:87], a[132:135], v[40:43]
s_xor_b32 s44, s44, s45
buffer_load_dwordx4 v17, s[12:15], s27 offen offset:1024 lds
v_mfma_f32_16x16x32_bf16 v[44:47], a[88:91], a[128:131], v[44:47]
s_xor_b32 s44, s44, 196608
ds_read_b64_tr_b16 a[142:143], v5 offset:51200
v_mfma_f32_16x16x32_bf16 v[44:47], a[92:95], a[132:135], v[44:47]
v_mfma_f32_16x16x32_bf16 v[48:51], a[96:99], a[128:131], v[48:51]
ds_read_b128 a[0:3], v2 offset:0
v_mfma_f32_16x16x32_bf16 v[48:51], a[100:103], a[132:135], v[48:51]
buffer_load_dwordx4 v18, s[12:15], s27 offen offset:2048 lds
v_mfma_f32_16x16x32_bf16 v[52:55], a[104:107], a[128:131], v[52:55]
ds_read_b128 a[4:7], v3 offset:0
v_mfma_f32_16x16x32_bf16 v[52:55], a[108:111], a[132:135], v[52:55]
PAD_26:
s_cbranch_execz PAD_30
v_mfma_f32_16x16x32_bf16 v[56:59], a[112:115], a[128:131], v[56:59]
v_mfma_f32_16x16x32_bf16 v[56:59], a[116:119], a[132:135], v[56:59]
buffer_load_dwordx4 v19, s[12:15], s27 offen offset:3072 lds
v_mfma_f32_16x16x32_bf16 v[60:63], a[120:123], a[128:131], v[60:63]
s_add_u32 s27, s27, 524288
ds_read_b128 a[8:11], v2 offset:2048
v_mfma_f32_16x16x32_bf16 v[60:63], a[124:127], a[132:135], v[60:63]
s_waitcnt lgkmcnt(3)
v_mfma_f32_16x16x32_bf16 v[64:67], a[64:67], a[136:139], v[64:67]
s_add_u32 m0, s28, 32768
ds_read_b64_tr_b16 a[128:129], v6 offset:32768
v_mfma_f32_16x16x32_bf16 v[64:67], a[68:71], a[140:143], v[64:67]
buffer_load_dwordx4 v12, s[8:11], s24 offen offset:0 lds
v_mfma_f32_16x16x32_bf16 v[68:71], a[72:75], a[136:139], v[68:71]
ds_read_b64_tr_b16 a[130:131], v6 offset:34816
v_mfma_f32_16x16x32_bf16 v[68:71], a[76:79], a[140:143], v[68:71]
v_mfma_f32_16x16x32_bf16 v[72:75], a[80:83], a[136:139], v[72:75]
s_mov_b64 s[56:57], s[72:73]
ds_read_b64_tr_b16 a[132:133], v6 offset:49152
v_mfma_f32_16x16x32_bf16 v[72:75], a[84:87], a[140:143], v[72:75]
s_mov_b32 s58, 1835008
buffer_load_dwordx4 v13, s[8:11], s24 offen offset:1024 lds
v_mfma_f32_16x16x32_bf16 v[76:79], a[88:91], a[136:139], v[76:79]
s_mov_b32 s59, 0x20000
ds_read_b64_tr_b16 a[134:135], v6 offset:51200
v_mfma_f32_16x16x32_bf16 v[76:79], a[92:95], a[140:143], v[76:79]
v_mfma_f32_16x16x32_bf16 v[80:83], a[96:99], a[136:139], v[80:83]
ds_read_b128 a[12:15], v3 offset:2048
v_mfma_f32_16x16x32_bf16 v[80:83], a[100:103], a[140:143], v[80:83]
buffer_load_dwordx4 v14, s[8:11], s24 offen offset:2048 lds
v_mfma_f32_16x16x32_bf16 v[84:87], a[104:107], a[136:139], v[84:87]
v_mfma_f32_16x16x32_bf16 v[84:87], a[108:111], a[140:143], v[84:87]
v_mfma_f32_16x16x32_bf16 v[88:91], a[112:115], a[136:139], v[88:91]
ds_read_b128 a[16:19], v2 offset:4096
v_mfma_f32_16x16x32_bf16 v[88:91], a[116:119], a[140:143], v[88:91]
buffer_load_dwordx4 v15, s[8:11], s24 offen offset:3072 lds
v_mfma_f32_16x16x32_bf16 v[92:95], a[120:123], a[136:139], v[92:95]
s_add_u32 s24, s24, 128
ds_read_b128 a[20:23], v3 offset:4096
v_mfma_f32_16x16x32_bf16 v[92:95], a[124:127], a[140:143], v[92:95]
s_waitcnt lgkmcnt(3)
v_mfma_f32_16x16x32_bf16 v[96:99], a[64:67], a[128:131], v[96:99]
s_add_u32 m0, s28, 36864
ds_read_b64_tr_b16 a[136:137], v7 offset:32768
v_mfma_f32_16x16x32_bf16 v[96:99], a[68:71], a[132:135], v[96:99]
buffer_load_dwordx4 v12, s[8:11], s25 offen offset:0 lds
v_mfma_f32_16x16x32_bf16 v[100:103], a[72:75], a[128:131], v[100:103]
ds_read_b64_tr_b16 a[138:139], v7 offset:34816
v_mfma_f32_16x16x32_bf16 v[100:103], a[76:79], a[132:135], v[100:103]
v_mfma_f32_16x16x32_bf16 v[104:107], a[80:83], a[128:131], v[104:107]
ds_read_b64_tr_b16 a[140:141], v7 offset:49152
v_mfma_f32_16x16x32_bf16 v[104:107], a[84:87], a[132:135], v[104:107]
buffer_load_dwordx4 v13, s[8:11], s25 offen offset:1024 lds
v_mfma_f32_16x16x32_bf16 v[108:111], a[88:91], a[128:131], v[108:111]
ds_read_b64_tr_b16 a[142:143], v7 offset:51200
v_mfma_f32_16x16x32_bf16 v[108:111], a[92:95], a[132:135], v[108:111]
v_mfma_f32_16x16x32_bf16 v[112:115], a[96:99], a[128:131], v[112:115]
v_mfma_f32_16x16x32_bf16 v[112:115], a[100:103], a[132:135], v[112:115]
buffer_load_dwordx4 v14, s[8:11], s25 offen offset:2048 lds
v_mfma_f32_16x16x32_bf16 v[116:119], a[104:107], a[128:131], v[116:119]
ds_read_b128 a[24:27], v2 offset:6144
v_mfma_f32_16x16x32_bf16 v[116:119], a[108:111], a[132:135], v[116:119]
v_mfma_f32_16x16x32_bf16 v[120:123], a[112:115], a[128:131], v[120:123]
ds_read_b128 a[28:31], v3 offset:6144
v_mfma_f32_16x16x32_bf16 v[120:123], a[116:119], a[132:135], v[120:123]
buffer_load_dwordx4 v15, s[8:11], s25 offen offset:3072 lds
v_mfma_f32_16x16x32_bf16 v[124:127], a[120:123], a[128:131], v[124:127]
s_add_u32 s25, s25, 128
s_waitcnt vmcnt(12)
v_mfma_f32_16x16x32_bf16 v[124:127], a[124:127], a[132:135], v[124:127]
s_waitcnt lgkmcnt(2)
v_cmp_gt_u32 vcc, 1, v230
v_mfma_f32_16x16x32_bf16 v[128:131], a[64:67], a[136:139], v[128:131]
s_cbranch_vccnz M_ppspinV
M_ppokV:
ds_read_b64_tr_b16 a[128:129], v8 offset:32768
v_mfma_f32_16x16x32_bf16 v[128:131], a[68:71], a[140:143], v[128:131]
buffer_load_dword v230, v229, s[4:7], s53 offen sc1
v_mfma_f32_16x16x32_bf16 v[132:135], a[72:75], a[136:139], v[132:135]
s_mov_b64 s[8:9], s[76:77]
ds_read_b64_tr_b16 a[130:131], v8 offset:34816
v_mfma_f32_16x16x32_bf16 v[132:135], a[76:79], a[140:143], v[132:135]
s_mov_b32 s10, 1835008
buffer_load_dword v230, v229, s[4:7], s48 offen sc1
v_mfma_f32_16x16x32_bf16 v[136:139], a[80:83], a[136:139], v[136:139]
s_lshl_b32 s24, s37, 2
ds_read_b64_tr_b16 a[132:133], v8 offset:49152
v_mfma_f32_16x16x32_bf16 v[136:139], a[84:87], a[140:143], v[136:139]
s_add_u32 s24, s24, s3
buffer_load_dword v230, v229, s[56:59], s49 offen
v_mfma_f32_16x16x32_bf16 v[140:143], a[88:91], a[136:139], v[140:143]
s_mul_i32 s24, s24, 28672
ds_read_b64_tr_b16 a[134:135], v8 offset:51200
v_mfma_f32_16x16x32_bf16 v[140:143], a[92:95], a[140:143], v[140:143]
s_mov_b32 s28, s29
buffer_load_dword v21, v20, s[16:19], s43 offen
v_mfma_f32_16x16x32_bf16 v[144:147], a[96:99], a[136:139], v[144:147]
ds_read_b128 a[32:35], v2 offset:8192
v_mfma_f32_16x16x32_bf16 v[144:147], a[100:103], a[140:143], v[144:147]
v_mfma_f32_16x16x32_bf16 v[148:151], a[104:107], a[136:139], v[148:151]
v_mfma_f32_16x16x32_bf16 v[148:151], a[108:111], a[140:143], v[148:151]
v_mfma_f32_16x16x32_bf16 v[152:155], a[112:115], a[136:139], v[152:155]
ds_read_b128 a[36:39], v3 offset:8192
v_lshrrev_b32 v28, 7, v1
v_mfma_f32_16x16x32_bf16 v[152:155], a[116:119], a[140:143], v[152:155]
v_lshrrev_b32 v29, 1, v28
v_lshlrev_b32 v29, 4, v29
v_mfma_f32_16x16x32_bf16 v[156:159], a[120:123], a[136:139], v[156:159]
ds_read_b128 a[40:43], v2 offset:10240
v_and_b32 v30, 0x70, v1
v_mfma_f32_16x16x32_bf16 v[156:159], a[124:127], a[140:143], v[156:159]
s_waitcnt lgkmcnt(3)
v_xor_b32 v29, v29, v30
v_mul_u32_u24 v28, 896, v28
v_mfma_f32_16x16x32_bf16 v[160:163], a[64:67], a[128:131], v[160:163]
ds_read_b64_tr_b16 a[136:137], v9 offset:32768
v_add_u32 v12, v28, v29
v_mfma_f32_16x16x32_bf16 v[160:163], a[68:71], a[132:135], v[160:163]
v_xor_b32 v29, 64, v29
v_add_u32 v28, v28, v29
v_mfma_f32_16x16x32_bf16 v[164:167], a[72:75], a[128:131], v[164:167]
ds_read_b64_tr_b16 a[138:139], v9 offset:34816
v_add_u32 v13, 6144, v28
v_mfma_f32_16x16x32_bf16 v[164:167], a[76:79], a[132:135], v[164:167]
v_add_u32 v14, 12288, v12
v_add_u32 v15, 18432, v28
v_mfma_f32_16x16x32_bf16 v[168:171], a[80:83], a[128:131], v[168:171]
ds_read_b64_tr_b16 a[140:141], v9 offset:49152
v_xor_b32 v22, s44, v4
v_mfma_f32_16x16x32_bf16 v[168:171], a[84:87], a[132:135], v[168:171]
v_xor_b32 v23, 32, v22
v_xor_b32 v24, 64, v22
v_mfma_f32_16x16x32_bf16 v[172:175], a[88:91], a[128:131], v[172:175]
ds_read_b64_tr_b16 a[142:143], v9 offset:51200
v_xor_b32 v25, 96, v22
v_mfma_f32_16x16x32_bf16 v[172:175], a[92:95], a[132:135], v[172:175]
v_mfma_f32_16x16x32_bf16 v[176:179], a[96:99], a[128:131], v[176:179]
v_mfma_f32_16x16x32_bf16 v[176:179], a[100:103], a[132:135], v[176:179]
v_mfma_f32_16x16x32_bf16 v[180:183], a[104:107], a[128:131], v[180:183]
ds_read_b128 a[44:47], v3 offset:10240
v_mfma_f32_16x16x32_bf16 v[180:183], a[108:111], a[132:135], v[180:183]
v_mfma_f32_16x16x32_bf16 v[184:187], a[112:115], a[128:131], v[184:187]
ds_read_b128 a[48:51], v2 offset:12288
v_mfma_f32_16x16x32_bf16 v[184:187], a[116:119], a[132:135], v[184:187]
v_mfma_f32_16x16x32_bf16 v[188:191], a[120:123], a[128:131], v[188:191]
v_mfma_f32_16x16x32_bf16 v[188:191], a[124:127], a[132:135], v[188:191]
s_waitcnt lgkmcnt(2)
v_mfma_f32_16x16x32_bf16 v[192:195], a[64:67], a[136:139], v[192:195]
ds_read_b64_tr_b16 a[128:129], v10 offset:32768
v_mfma_f32_16x16x32_bf16 v[192:195], a[68:71], a[140:143], v[192:195]
v_mfma_f32_16x16x32_bf16 v[196:199], a[72:75], a[136:139], v[196:199]
ds_read_b64_tr_b16 a[130:131], v10 offset:34816
v_mfma_f32_16x16x32_bf16 v[196:199], a[76:79], a[140:143], v[196:199]
v_mfma_f32_16x16x32_bf16 v[200:203], a[80:83], a[136:139], v[200:203]
ds_read_b64_tr_b16 a[132:133], v10 offset:49152
v_mfma_f32_16x16x32_bf16 v[200:203], a[84:87], a[140:143], v[200:203]
v_mfma_f32_16x16x32_bf16 v[204:207], a[88:91], a[136:139], v[204:207]
ds_read_b64_tr_b16 a[134:135], v10 offset:51200
v_mfma_f32_16x16x32_bf16 v[204:207], a[92:95], a[140:143], v[204:207]
v_mfma_f32_16x16x32_bf16 v[208:211], a[96:99], a[136:139], v[208:211]
ds_read_b128 a[52:55], v3 offset:12288
v_mfma_f32_16x16x32_bf16 v[208:211], a[100:103], a[140:143], v[208:211]
v_mfma_f32_16x16x32_bf16 v[212:215], a[104:107], a[136:139], v[212:215]
ds_read_b128 a[56:59], v2 offset:14336
v_mfma_f32_16x16x32_bf16 v[212:215], a[108:111], a[140:143], v[212:215]
v_mfma_f32_16x16x32_bf16 v[216:219], a[112:115], a[136:139], v[216:219]
v_mfma_f32_16x16x32_bf16 v[216:219], a[116:119], a[140:143], v[216:219]
v_mfma_f32_16x16x32_bf16 v[220:223], a[120:123], a[136:139], v[220:223]
ds_read_b128 a[60:63], v3 offset:14336
v_mfma_f32_16x16x32_bf16 v[220:223], a[124:127], a[140:143], v[220:223]
s_waitcnt lgkmcnt(3)
v_mfma_f32_16x16x32_bf16 a[192:195], a[64:67], a[128:131], a[192:195]
ds_read_b64_tr_b16 a[136:137], v11 offset:32768
v_mfma_f32_16x16x32_bf16 a[192:195], a[68:71], a[132:135], a[192:195]
v_mfma_f32_16x16x32_bf16 a[196:199], a[72:75], a[128:131], a[196:199]
ds_read_b64_tr_b16 a[138:139], v11 offset:34816
v_mfma_f32_16x16x32_bf16 a[196:199], a[76:79], a[132:135], a[196:199]
v_mfma_f32_16x16x32_bf16 a[200:203], a[80:83], a[128:131], a[200:203]
ds_read_b64_tr_b16 a[140:141], v11 offset:49152
v_mfma_f32_16x16x32_bf16 a[200:203], a[84:87], a[132:135], a[200:203]
v_mfma_f32_16x16x32_bf16 a[204:207], a[88:91], a[128:131], a[204:207]
ds_read_b64_tr_b16 a[142:143], v11 offset:51200
v_mfma_f32_16x16x32_bf16 a[204:207], a[92:95], a[132:135], a[204:207]
v_mfma_f32_16x16x32_bf16 a[208:211], a[96:99], a[128:131], a[208:211]
v_mfma_f32_16x16x32_bf16 a[208:211], a[100:103], a[132:135], a[208:211]
v_mfma_f32_16x16x32_bf16 a[212:215], a[104:107], a[128:131], a[212:215]
v_mfma_f32_16x16x32_bf16 a[212:215], a[108:111], a[132:135], a[212:215]
v_mfma_f32_16x16x32_bf16 a[216:219], a[112:115], a[128:131], a[216:219]
v_mfma_f32_16x16x32_bf16 a[216:219], a[116:119], a[132:135], a[216:219]
v_mfma_f32_16x16x32_bf16 a[220:223], a[120:123], a[128:131], a[220:223]
s_waitcnt vmcnt(4) lgkmcnt(0)
v_mfma_f32_16x16x32_bf16 a[220:223], a[124:127], a[132:135], a[220:223]
s_barrier
v_mfma_f32_16x16x32_bf16 a[224:227], a[64:67], a[136:139], a[224:227]
s_add_u32 m0, s29, 98304
ds_read_b64_tr_b16 a[128:129], v4 offset:0
v_mfma_f32_16x16x32_bf16 a[224:227], a[68:71], a[140:143], a[224:227]
buffer_load_dwordx4 v16, s[12:15], s26 offen offset:0 lds
v_mfma_f32_16x16x32_bf16 a[228:231], a[72:75], a[136:139], a[228:231]
ds_read_b64_tr_b16 a[130:131], v4 offset:2048
v_mfma_f32_16x16x32_bf16 a[228:231], a[76:79], a[140:143], a[228:231]
v_mfma_f32_16x16x32_bf16 a[232:235], a[80:83], a[136:139], a[232:235]
ds_read_b64_tr_b16 a[132:133], v4 offset:16384
v_mfma_f32_16x16x32_bf16 a[232:235], a[84:87], a[140:143], a[232:235]
buffer_load_dwordx4 v17, s[12:15], s26 offen offset:1024 lds
v_mfma_f32_16x16x32_bf16 a[236:239], a[88:91], a[136:139], a[236:239]
ds_read_b64_tr_b16 a[134:135], v4 offset:18432
v_mfma_f32_16x16x32_bf16 a[236:239], a[92:95], a[140:143], a[236:239]
v_mfma_f32_16x16x32_bf16 a[240:243], a[96:99], a[136:139], a[240:243]
v_mfma_f32_16x16x32_bf16 a[240:243], a[100:103], a[140:143], a[240:243]
buffer_load_dwordx4 v18, s[12:15], s26 offen offset:2048 lds
v_mfma_f32_16x16x32_bf16 a[244:247], a[104:107], a[136:139], a[244:247]
v_mfma_f32_16x16x32_bf16 a[244:247], a[108:111], a[140:143], a[244:247]
v_mfma_f32_16x16x32_bf16 a[248:251], a[112:115], a[136:139], a[248:251]
v_mfma_f32_16x16x32_bf16 a[248:251], a[116:119], a[140:143], a[248:251]
buffer_load_dwordx4 v19, s[12:15], s26 offen offset:3072 lds
v_mfma_f32_16x16x32_bf16 a[252:255], a[120:123], a[136:139], a[252:255]
s_add_u32 s26, s26, 524288
v_mfma_f32_16x16x32_bf16 a[252:255], a[124:127], a[140:143], a[252:255]
s_waitcnt lgkmcnt(0)
v_mfma_f32_16x16x32_bf16 v[32:35], a[0:3], a[128:131], v[32:35]
s_add_u32 m0, s29, 114688
ds_read_b64_tr_b16 a[136:137], v5 offset:0
v_mfma_f32_16x16x32_bf16 v[32:35], a[4:7], a[132:135], v[32:35]
buffer_load_dwordx4 v16, s[12:15], s27 offen offset:0 lds
v_mfma_f32_16x16x32_bf16 v[36:39], a[8:11], a[128:131], v[36:39]
ds_read_b64_tr_b16 a[138:139], v5 offset:2048
v_mfma_f32_16x16x32_bf16 v[36:39], a[12:15], a[132:135], v[36:39]
v_mfma_f32_16x16x32_bf16 v[40:43], a[16:19], a[128:131], v[40:43]
ds_read_b64_tr_b16 a[140:141], v5 offset:16384
v_mfma_f32_16x16x32_bf16 v[40:43], a[20:23], a[132:135], v[40:43]
buffer_load_dwordx4 v17, s[12:15], s27 offen offset:1024 lds
v_mfma_f32_16x16x32_bf16 v[44:47], a[24:27], a[128:131], v[44:47]
ds_read_b64_tr_b16 a[142:143], v5 offset:18432
v_mfma_f32_16x16x32_bf16 v[44:47], a[28:31], a[132:135], v[44:47]
v_mfma_f32_16x16x32_bf16 v[48:51], a[32:35], a[128:131], v[48:51]
ds_read_b128 a[64:67], v2 offset:32768
v_mfma_f32_16x16x32_bf16 v[48:51], a[36:39], a[132:135], v[48:51]
buffer_load_dwordx4 v18, s[12:15], s27 offen offset:2048 lds
v_mfma_f32_16x16x32_bf16 v[52:55], a[40:43], a[128:131], v[52:55]
ds_read_b128 a[68:71], v3 offset:32768
v_mfma_f32_16x16x32_bf16 v[52:55], a[44:47], a[132:135], v[52:55]
v_mfma_f32_16x16x32_bf16 v[56:59], a[48:51], a[128:131], v[56:59]
v_mfma_f32_16x16x32_bf16 v[56:59], a[52:55], a[132:135], v[56:59]
buffer_load_dwordx4 v19, s[12:15], s27 offen offset:3072 lds
v_mfma_f32_16x16x32_bf16 v[60:63], a[56:59], a[128:131], v[60:63]
s_add_u32 s27, s27, 524288
ds_read_b128 a[72:75], v2 offset:34816
v_mfma_f32_16x16x32_bf16 v[60:63], a[60:63], a[132:135], v[60:63]
s_waitcnt lgkmcnt(3)
v_mfma_f32_16x16x32_bf16 v[64:67], a[0:3], a[136:139], v[64:67]
s_add_u32 m0, s28, 0
ds_read_b64_tr_b16 a[128:129], v6 offset:0
v_mfma_f32_16x16x32_bf16 v[64:67], a[4:7], a[140:143], v[64:67]
buffer_load_dwordx4 v12, s[8:11], s24 offen offset:0 lds
v_mfma_f32_16x16x32_bf16 v[68:71], a[8:11], a[136:139], v[68:71]
ds_read_b64_tr_b16 a[130:131], v6 offset:2048
v_mfma_f32_16x16x32_bf16 v[68:71], a[12:15], a[140:143], v[68:71]
v_mfma_f32_16x16x32_bf16 v[72:75], a[16:19], a[136:139], v[72:75]
ds_read_b64_tr_b16 a[132:133], v6 offset:16384
v_mfma_f32_16x16x32_bf16 v[72:75], a[20:23], a[140:143], v[72:75]
buffer_load_dwordx4 v13, s[8:11], s24 offen offset:1024 lds
v_mfma_f32_16x16x32_bf16 v[76:79], a[24:27], a[136:139], v[76:79]
ds_read_b64_tr_b16 a[134:135], v6 offset:18432
v_mfma_f32_16x16x32_bf16 v[76:79], a[28:31], a[140:143], v[76:79]
v_mfma_f32_16x16x32_bf16 v[80:83], a[32:35], a[136:139], v[80:83]
ds_read_b128 a[76:79], v3 offset:34816
v_mfma_f32_16x16x32_bf16 v[80:83], a[36:39], a[140:143], v[80:83]
buffer_load_dwordx4 v14, s[8:11], s24 offen offset:2048 lds
v_mfma_f32_16x16x32_bf16 v[84:87], a[40:43], a[136:139], v[84:87]
v_mfma_f32_16x16x32_bf16 v[84:87], a[44:47], a[140:143], v[84:87]
v_mfma_f32_16x16x32_bf16 v[88:91], a[48:51], a[136:139], v[88:91]
ds_read_b128 a[80:83], v2 offset:36864
v_mfma_f32_16x16x32_bf16 v[88:91], a[52:55], a[140:143], v[88:91]
buffer_load_dwordx4 v15, s[8:11], s24 offen offset:3072 lds
v_mfma_f32_16x16x32_bf16 v[92:95], a[56:59], a[136:139], v[92:95]
s_add_u32 s24, s24, 128
ds_read_b128 a[84:87], v3 offset:36864
v_mfma_f32_16x16x32_bf16 v[92:95], a[60:63], a[140:143], v[92:95]
s_waitcnt lgkmcnt(3)
s_mov_b64 s[12:13], s[80:81]
v_mfma_f32_16x16x32_bf16 v[96:99], a[0:3], a[128:131], v[96:99]
s_mov_b32 s14, 3670016
s_add_u32 m0, s28, 16384
ds_read_b64_tr_b16 a[136:137], v7 offset:0
v_mfma_f32_16x16x32_bf16 v[96:99], a[4:7], a[132:135], v[96:99]
buffer_load_dwordx4 v12, s[8:11], s24 offen offset:0 lds
v_mfma_f32_16x16x32_bf16 v[100:103], a[8:11], a[128:131], v[100:103]
ds_read_b64_tr_b16 a[138:139], v7 offset:2048
v_mfma_f32_16x16x32_bf16 v[100:103], a[12:15], a[132:135], v[100:103]
v_mfma_f32_16x16x32_bf16 v[104:107], a[16:19], a[128:131], v[104:107]
ds_read_b64_tr_b16 a[140:141], v7 offset:16384
v_mfma_f32_16x16x32_bf16 v[104:107], a[20:23], a[132:135], v[104:107]
buffer_load_dwordx4 v13, s[8:11], s24 offen offset:1024 lds
v_mfma_f32_16x16x32_bf16 v[108:111], a[24:27], a[128:131], v[108:111]
ds_read_b64_tr_b16 a[142:143], v7 offset:18432
v_mfma_f32_16x16x32_bf16 v[108:111], a[28:31], a[132:135], v[108:111]
v_mfma_f32_16x16x32_bf16 v[112:115], a[32:35], a[128:131], v[112:115]
v_mfma_f32_16x16x32_bf16 v[112:115], a[36:39], a[132:135], v[112:115]
buffer_load_dwordx4 v14, s[8:11], s24 offen offset:2048 lds
v_mfma_f32_16x16x32_bf16 v[116:119], a[40:43], a[128:131], v[116:119]
ds_read_b128 a[88:91], v2 offset:38912
v_mfma_f32_16x16x32_bf16 v[116:119], a[44:47], a[132:135], v[116:119]
v_mfma_f32_16x16x32_bf16 v[120:123], a[48:51], a[128:131], v[120:123]
ds_read_b128 a[92:95], v3 offset:38912
v_mfma_f32_16x16x32_bf16 v[120:123], a[52:55], a[132:135], v[120:123]
buffer_load_dwordx4 v15, s[8:11], s24 offen offset:3072 lds
v_mfma_f32_16x16x32_bf16 v[124:127], a[56:59], a[128:131], v[124:127]
s_add_u32 s24, s24, 128
v_mfma_f32_16x16x32_bf16 v[124:127], a[60:63], a[132:135], v[124:127]
s_waitcnt lgkmcnt(2)
s_sub_u32 s26, s26, 8388608
v_mfma_f32_16x16x32_bf16 v[128:131], a[0:3], a[136:139], v[128:131]
s_sub_u32 s27, s27, 8388608
s_add_u32 m0, s29, 131072
ds_read_b64_tr_b16 a[128:129], v8 offset:0
v_mfma_f32_16x16x32_bf16 v[128:131], a[4:7], a[140:143], v[128:131]
buffer_load_dwordx4 v16, s[12:15], s26 offen offset:0 lds
v_mfma_f32_16x16x32_bf16 v[132:135], a[8:11], a[136:139], v[132:135]
ds_read_b64_tr_b16 a[130:131], v8 offset:2048
v_mfma_f32_16x16x32_bf16 v[132:135], a[12:15], a[140:143], v[132:135]
v_mfma_f32_16x16x32_bf16 v[136:139], a[16:19], a[136:139], v[136:139]
ds_read_b64_tr_b16 a[132:133], v8 offset:16384
v_mfma_f32_16x16x32_bf16 v[136:139], a[20:23], a[140:143], v[136:139]
buffer_load_dwordx4 v17, s[12:15], s26 offen offset:1024 lds
v_mfma_f32_16x16x32_bf16 v[140:143], a[24:27], a[136:139], v[140:143]
ds_read_b64_tr_b16 a[134:135], v8 offset:18432
v_mfma_f32_16x16x32_bf16 v[140:143], a[28:31], a[140:143], v[140:143]
v_mfma_f32_16x16x32_bf16 v[144:147], a[32:35], a[136:139], v[144:147]
ds_read_b128 a[96:99], v2 offset:40960
v_mfma_f32_16x16x32_bf16 v[144:147], a[36:39], a[140:143], v[144:147]
buffer_load_dwordx4 v18, s[12:15], s26 offen offset:2048 lds
v_mfma_f32_16x16x32_bf16 v[148:151], a[40:43], a[136:139], v[148:151]
v_mfma_f32_16x16x32_bf16 v[148:151], a[44:47], a[140:143], v[148:151]
v_mfma_f32_16x16x32_bf16 v[152:155], a[48:51], a[136:139], v[152:155]
ds_read_b128 a[100:103], v3 offset:40960
v_mfma_f32_16x16x32_bf16 v[152:155], a[52:55], a[140:143], v[152:155]
buffer_load_dwordx4 v19, s[12:15], s26 offen offset:3072 lds
v_mfma_f32_16x16x32_bf16 v[156:159], a[56:59], a[136:139], v[156:159]
s_add_u32 s26, s26, 524288
ds_read_b128 a[104:107], v2 offset:43008
v_mfma_f32_16x16x32_bf16 v[156:159], a[60:63], a[140:143], v[156:159]
s_waitcnt lgkmcnt(3)
v_mfma_f32_16x16x32_bf16 v[160:163], a[0:3], a[128:131], v[160:163]
s_add_u32 m0, s29, 147456
ds_read_b64_tr_b16 a[136:137], v9 offset:0
v_mfma_f32_16x16x32_bf16 v[160:163], a[4:7], a[132:135], v[160:163]
buffer_load_dwordx4 v16, s[12:15], s27 offen offset:0 lds
v_mfma_f32_16x16x32_bf16 v[164:167], a[8:11], a[128:131], v[164:167]
ds_read_b64_tr_b16 a[138:139], v9 offset:2048
v_mfma_f32_16x16x32_bf16 v[164:167], a[12:15], a[132:135], v[164:167]
v_mfma_f32_16x16x32_bf16 v[168:171], a[16:19], a[128:131], v[168:171]
ds_read_b64_tr_b16 a[140:141], v9 offset:16384
v_mfma_f32_16x16x32_bf16 v[168:171], a[20:23], a[132:135], v[168:171]
buffer_load_dwordx4 v17, s[12:15], s27 offen offset:1024 lds
v_mfma_f32_16x16x32_bf16 v[172:175], a[24:27], a[128:131], v[172:175]
ds_read_b64_tr_b16 a[142:143], v9 offset:18432
v_mfma_f32_16x16x32_bf16 v[172:175], a[28:31], a[132:135], v[172:175]
v_mfma_f32_16x16x32_bf16 v[176:179], a[32:35], a[128:131], v[176:179]
v_mfma_f32_16x16x32_bf16 v[176:179], a[36:39], a[132:135], v[176:179]
buffer_load_dwordx4 v18, s[12:15], s27 offen offset:2048 lds
v_mfma_f32_16x16x32_bf16 v[180:183], a[40:43], a[128:131], v[180:183]
ds_read_b128 a[108:111], v3 offset:43008
v_mfma_f32_16x16x32_bf16 v[180:183], a[44:47], a[132:135], v[180:183]
v_mfma_f32_16x16x32_bf16 v[184:187], a[48:51], a[128:131], v[184:187]
ds_read_b128 a[112:115], v2 offset:45056
v_mfma_f32_16x16x32_bf16 v[184:187], a[52:55], a[132:135], v[184:187]
buffer_load_dwordx4 v19, s[12:15], s27 offen offset:3072 lds
v_mfma_f32_16x16x32_bf16 v[188:191], a[56:59], a[128:131], v[188:191]
s_add_u32 s27, s27, 524288
v_mfma_f32_16x16x32_bf16 v[188:191], a[60:63], a[132:135], v[188:191]
s_waitcnt lgkmcnt(2)
v_mfma_f32_16x16x32_bf16 v[192:195], a[0:3], a[136:139], v[192:195]
ds_read_b64_tr_b16 a[128:129], v10 offset:0
v_mfma_f32_16x16x32_bf16 v[192:195], a[4:7], a[140:143], v[192:195]
v_mfma_f32_16x16x32_bf16 v[196:199], a[8:11], a[136:139], v[196:199]
ds_read_b64_tr_b16 a[130:131], v10 offset:2048
v_mfma_f32_16x16x32_bf16 v[196:199], a[12:15], a[140:143], v[196:199]
v_mfma_f32_16x16x32_bf16 v[200:203], a[16:19], a[136:139], v[200:203]
ds_read_b64_tr_b16 a[132:133], v10 offset:16384
v_mfma_f32_16x16x32_bf16 v[200:203], a[20:23], a[140:143], v[200:203]
v_mfma_f32_16x16x32_bf16 v[204:207], a[24:27], a[136:139], v[204:207]
ds_read_b64_tr_b16 a[134:135], v10 offset:18432
v_mfma_f32_16x16x32_bf16 v[204:207], a[28:31], a[140:143], v[204:207]
v_mfma_f32_16x16x32_bf16 v[208:211], a[32:35], a[136:139], v[208:211]
ds_read_b128 a[116:119], v3 offset:45056
v_mfma_f32_16x16x32_bf16 v[208:211], a[36:39], a[140:143], v[208:211]
v_mfma_f32_16x16x32_bf16 v[212:215], a[40:43], a[136:139], v[212:215]
ds_read_b128 a[120:123], v2 offset:47104
v_mfma_f32_16x16x32_bf16 v[212:215], a[44:47], a[140:143], v[212:215]
v_mfma_f32_16x16x32_bf16 v[216:219], a[48:51], a[136:139], v[216:219]
v_mfma_f32_16x16x32_bf16 v[216:219], a[52:55], a[140:143], v[216:219]
v_mfma_f32_16x16x32_bf16 v[220:223], a[56:59], a[136:139], v[220:223]
ds_read_b128 a[124:127], v3 offset:47104
v_mfma_f32_16x16x32_bf16 v[220:223], a[60:63], a[140:143], v[220:223]
s_waitcnt lgkmcnt(3)
v_mfma_f32_16x16x32_bf16 a[192:195], a[0:3], a[128:131], a[192:195]
ds_read_b64_tr_b16 a[136:137], v11 offset:0
v_mfma_f32_16x16x32_bf16 a[192:195], a[4:7], a[132:135], a[192:195]
v_mfma_f32_16x16x32_bf16 a[196:199], a[8:11], a[128:131], a[196:199]
ds_read_b64_tr_b16 a[138:139], v11 offset:2048
v_mfma_f32_16x16x32_bf16 a[196:199], a[12:15], a[132:135], a[196:199]
v_mfma_f32_16x16x32_bf16 a[200:203], a[16:19], a[128:131], a[200:203]
ds_read_b64_tr_b16 a[140:141], v11 offset:16384
v_mfma_f32_16x16x32_bf16 a[200:203], a[20:23], a[132:135], a[200:203]
v_mfma_f32_16x16x32_bf16 a[204:207], a[24:27], a[128:131], a[204:207]
ds_read_b64_tr_b16 a[142:143], v11 offset:18432
v_mfma_f32_16x16x32_bf16 a[204:207], a[28:31], a[132:135], a[204:207]
v_mfma_f32_16x16x32_bf16 a[208:211], a[32:35], a[128:131], a[208:211]
v_mfma_f32_16x16x32_bf16 a[208:211], a[36:39], a[132:135], a[208:211]
v_mfma_f32_16x16x32_bf16 a[212:215], a[40:43], a[128:131], a[212:215]
v_mfma_f32_16x16x32_bf16 a[212:215], a[44:47], a[132:135], a[212:215]
v_mfma_f32_16x16x32_bf16 a[216:219], a[48:51], a[128:131], a[216:219]
v_mfma_f32_16x16x32_bf16 a[216:219], a[52:55], a[132:135], a[216:219]
v_mfma_f32_16x16x32_bf16 a[220:223], a[56:59], a[128:131], a[220:223]
s_waitcnt vmcnt(12) lgkmcnt(0)
v_mfma_f32_16x16x32_bf16 a[220:223], a[60:63], a[132:135], a[220:223]
s_barrier
v_mfma_f32_16x16x32_bf16 a[224:227], a[0:3], a[136:139], a[224:227]
s_add_u32 m0, s28, 32768
ds_read_b64_tr_b16 a[128:129], v4 offset:32768
v_mfma_f32_16x16x32_bf16 a[224:227], a[4:7], a[140:143], a[224:227]
s_lshr_b32 s22, s3, 1
buffer_load_dwordx4 v12, s[8:11], s24 offen offset:0 lds
v_mfma_f32_16x16x32_bf16 a[228:231], a[8:11], a[136:139], a[228:231]
s_lshl_b32 s22, s22, 14
ds_read_b64_tr_b16 a[130:131], v4 offset:34816
v_subrev_u32 v2, s22, v2
v_mfma_f32_16x16x32_bf16 a[228:231], a[12:15], a[140:143], a[228:231]
v_subrev_u32 v3, s22, v3
v_mfma_f32_16x16x32_bf16 a[232:235], a[16:19], a[136:139], a[232:235]
ds_read_b64_tr_b16 a[132:133], v4 offset:49152
v_mfma_f32_16x16x32_bf16 a[232:235], a[20:23], a[140:143], a[232:235]
buffer_load_dwordx4 v13, s[8:11], s24 offen offset:1024 lds
v_mfma_f32_16x16x32_bf16 a[236:239], a[24:27], a[136:139], a[236:239]
ds_read_b64_tr_b16 a[134:135], v4 offset:51200
v_mfma_f32_16x16x32_bf16 a[236:239], a[28:31], a[140:143], a[236:239]
v_mfma_f32_16x16x32_bf16 a[240:243], a[32:35], a[136:139], a[240:243]
v_mfma_f32_16x16x32_bf16 a[240:243], a[36:39], a[140:143], a[240:243]
buffer_load_dwordx4 v14, s[8:11], s24 offen offset:2048 lds
v_mfma_f32_16x16x32_bf16 a[244:247], a[40:43], a[136:139], a[244:247]
v_mfma_f32_16x16x32_bf16 a[244:247], a[44:47], a[140:143], a[244:247]
v_mfma_f32_16x16x32_bf16 a[248:251], a[48:51], a[136:139], a[248:251]
v_mfma_f32_16x16x32_bf16 a[248:251], a[52:55], a[140:143], a[248:251]
buffer_load_dwordx4 v15, s[8:11], s24 offen offset:3072 lds
v_mfma_f32_16x16x32_bf16 a[252:255], a[56:59], a[136:139], a[252:255]
s_add_u32 s24, s24, 128
v_mfma_f32_16x16x32_bf16 a[252:255], a[60:63], a[140:143], a[252:255]
s_waitcnt lgkmcnt(0)
v_mfma_f32_16x16x32_bf16 v[32:35], a[64:67], a[128:131], v[32:35]
s_add_u32 m0, s29, 65536
ds_read_b64_tr_b16 a[136:137], v5 offset:32768
v_mfma_f32_16x16x32_bf16 v[32:35], a[68:71], a[132:135], v[32:35]
buffer_load_dwordx4 v16, s[12:15], s26 offen offset:0 lds
v_mfma_f32_16x16x32_bf16 v[36:39], a[72:75], a[128:131], v[36:39]
ds_read_b64_tr_b16 a[138:139], v5 offset:34816
v_mfma_f32_16x16x32_bf16 v[36:39], a[76:79], a[132:135], v[36:39]
v_mfma_f32_16x16x32_bf16 v[40:43], a[80:83], a[128:131], v[40:43]
ds_read_b64_tr_b16 a[140:141], v5 offset:49152
v_mfma_f32_16x16x32_bf16 v[40:43], a[84:87], a[132:135], v[40:43]
buffer_load_dwordx4 v17, s[12:15], s26 offen offset:1024 lds
v_mfma_f32_16x16x32_bf16 v[44:47], a[88:91], a[128:131], v[44:47]
ds_read_b64_tr_b16 a[142:143], v5 offset:51200
v_mfma_f32_16x16x32_bf16 v[44:47], a[92:95], a[132:135], v[44:47]
v_mfma_f32_16x16x32_bf16 v[48:51], a[96:99], a[128:131], v[48:51]
ds_read_b128 a[0:3], v2 offset:0
v_cvt_pk_bf16_f32 v32, v32, v33
v_mfma_f32_16x16x32_bf16 v[48:51], a[100:103], a[132:135], v[48:51]
buffer_load_dwordx4 v18, s[12:15], s26 offen offset:2048 lds
v_mfma_f32_16x16x32_bf16 v[52:55], a[104:107], a[128:131], v[52:55]
ds_read_b128 a[4:7], v3 offset:0
v_cvt_pk_bf16_f32 v33, v34, v35
v_mfma_f32_16x16x32_bf16 v[52:55], a[108:111], a[132:135], v[52:55]
v_cvt_pk_bf16_f32 v34, v36, v37
v_cvt_pk_bf16_f32 v35, v38, v39
v_mfma_f32_16x16x32_bf16 v[56:59], a[112:115], a[128:131], v[56:59]
v_cvt_pk_bf16_f32 v40, v40, v41
v_cvt_pk_bf16_f32 v41, v42, v43
v_mfma_f32_16x16x32_bf16 v[56:59], a[116:119], a[132:135], v[56:59]
buffer_load_dwordx4 v19, s[12:15], s26 offen offset:3072 lds
v_mfma_f32_16x16x32_bf16 v[60:63], a[120:123], a[128:131], v[60:63]
s_add_u32 s26, s26, 524288
ds_read_b128 a[8:11], v2 offset:2048
v_cvt_pk_bf16_f32 v42, v44, v45
v_mfma_f32_16x16x32_bf16 v[60:63], a[124:127], a[132:135], v[60:63]
s_waitcnt lgkmcnt(3)
v_cvt_pk_bf16_f32 v43, v46, v47
v_mfma_f32_16x16x32_bf16 v[64:67], a[64:67], a[136:139], v[64:67]
s_add_u32 m0, s29, 81920
ds_read_b64_tr_b16 a[128:129], v6 offset:32768
v_cvt_pk_bf16_f32 v48, v48, v49
v_mfma_f32_16x16x32_bf16 v[64:67], a[68:71], a[140:143], v[64:67]
buffer_load_dwordx4 v16, s[12:15], s27 offen offset:0 lds
v_mfma_f32_16x16x32_bf16 v[68:71], a[72:75], a[136:139], v[68:71]
ds_read_b64_tr_b16 a[130:131], v6 offset:34816
v_cvt_pk_bf16_f32 v49, v50, v51
v_mfma_f32_16x16x32_bf16 v[68:71], a[76:79], a[140:143], v[68:71]
v_cvt_pk_bf16_f32 v50, v52, v53
v_cvt_pk_bf16_f32 v51, v54, v55
v_mfma_f32_16x16x32_bf16 v[72:75], a[80:83], a[136:139], v[72:75]
ds_read_b64_tr_b16 a[132:133], v6 offset:49152
v_cvt_pk_bf16_f32 v56, v56, v57
v_mfma_f32_16x16x32_bf16 v[72:75], a[84:87], a[140:143], v[72:75]
buffer_load_dwordx4 v17, s[12:15], s27 offen offset:1024 lds
v_mfma_f32_16x16x32_bf16 v[76:79], a[88:91], a[136:139], v[76:79]
ds_read_b64_tr_b16 a[134:135], v6 offset:51200
v_cvt_pk_bf16_f32 v57, v58, v59
v_mfma_f32_16x16x32_bf16 v[76:79], a[92:95], a[140:143], v[76:79]
v_cvt_pk_bf16_f32 v58, v60, v61
v_cvt_pk_bf16_f32 v59, v62, v63
v_mfma_f32_16x16x32_bf16 v[80:83], a[96:99], a[136:139], v[80:83]
ds_read_b128 a[12:15], v3 offset:2048
v_cvt_pk_bf16_f32 v64, v64, v65
v_mfma_f32_16x16x32_bf16 v[80:83], a[100:103], a[140:143], v[80:83]
buffer_load_dwordx4 v18, s[12:15], s27 offen offset:2048 lds
v_mfma_f32_16x16x32_bf16 v[84:87], a[104:107], a[136:139], v[84:87]
v_cvt_pk_bf16_f32 v65, v66, v67
v_cvt_pk_bf16_f32 v66, v68, v69
v_mfma_f32_16x16x32_bf16 v[84:87], a[108:111], a[140:143], v[84:87]
v_cvt_pk_bf16_f32 v67, v70, v71
v_mfma_f32_16x16x32_bf16 v[88:91], a[112:115], a[136:139], v[88:91]
ds_read_b128 a[16:19], v2 offset:4096
v_cvt_pk_bf16_f32 v72, v72, v73
v_mfma_f32_16x16x32_bf16 v[88:91], a[116:119], a[140:143], v[88:91]
buffer_load_dwordx4 v19, s[12:15], s27 offen offset:3072 lds
v_mfma_f32_16x16x32_bf16 v[92:95], a[120:123], a[136:139], v[92:95]
s_add_u32 s27, s27, 524288
ds_read_b128 a[20:23], v3 offset:4096
v_cvt_pk_bf16_f32 v73, v74, v75
v_mfma_f32_16x16x32_bf16 v[92:95], a[124:127], a[140:143], v[92:95]
s_waitcnt lgkmcnt(3)
v_cvt_pk_bf16_f32 v74, v76, v77
v_cvt_pk_bf16_f32 v75, v78, v79
v_mfma_f32_16x16x32_bf16 v[96:99], a[64:67], a[128:131], v[96:99]
s_add_u32 m0, s28, 49152
ds_read_b64_tr_b16 a[136:137], v7 offset:32768
v_cvt_pk_bf16_f32 v80, v80, v81
v_mfma_f32_16x16x32_bf16 v[96:99], a[68:71], a[132:135], v[96:99]
PAD_27:
s_cbranch_execz PAD_31
buffer_load_dwordx4 v12, s[8:11], s24 offen offset:0 lds
v_mfma_f32_16x16x32_bf16 v[100:103], a[72:75], a[128:131], v[100:103]
ds_read_b64_tr_b16 a[138:139], v7 offset:34816
v_cvt_pk_bf16_f32 v81, v82, v83
v_mfma_f32_16x16x32_bf16 v[100:103], a[76:79], a[132:135], v[100:103]
v_cvt_pk_bf16_f32 v82, v84, v85
v_cvt_pk_bf16_f32 v83, v86, v87
v_mfma_f32_16x16x32_bf16 v[104:107], a[80:83], a[128:131], v[104:107]
ds_read_b64_tr_b16 a[140:141], v7 offset:49152
v_cvt_pk_bf16_f32 v88, v88, v89
v_mfma_f32_16x16x32_bf16 v[104:107], a[84:87], a[132:135], v[104:107]
buffer_load_dwordx4 v13, s[8:11], s24 offen offset:1024 lds
v_mfma_f32_16x16x32_bf16 v[108:111], a[88:91], a[128:131], v[108:111]
ds_read_b64_tr_b16 a[142:143], v7 offset:51200
v_cvt_pk_bf16_f32 v89, v90, v91
v_mfma_f32_16x16x32_bf16 v[108:111], a[92:95], a[132:135], v[108:111]
v_cvt_pk_bf16_f32 v90, v92, v93
v_cvt_pk_bf16_f32 v91, v94, v95
v_mfma_f32_16x16x32_bf16 v[112:115], a[96:99], a[128:131], v[112:115]
v_cvt_pk_bf16_f32 v96, v96, v97
v_cvt_pk_bf16_f32 v97, v98, v99
v_mfma_f32_16x16x32_bf16 v[112:115], a[100:103], a[132:135], v[112:115]
buffer_load_dwordx4 v14, s[8:11], s24 offen offset:2048 lds
v_mfma_f32_16x16x32_bf16 v[116:119], a[104:107], a[128:131], v[116:119]
ds_read_b128 a[24:27], v2 offset:6144
v_cvt_pk_bf16_f32 v98, v100, v101
v_mfma_f32_16x16x32_bf16 v[116:119], a[108:111], a[132:135], v[116:119]
buffer_store_dwordx4 v[32:35], v1, s[4:7], s31 offen sc1
v_mfma_f32_16x16x32_bf16 v[120:123], a[112:115], a[128:131], v[120:123]
s_add_u32 s31, s31, s32
ds_read_b128 a[28:31], v3 offset:6144
v_cvt_pk_bf16_f32 v99, v102, v103
v_mfma_f32_16x16x32_bf16 v[120:123], a[116:119], a[132:135], v[120:123]
buffer_load_dwordx4 v15, s[8:11], s24 offen offset:3072 lds
v_mfma_f32_16x16x32_bf16 v[124:127], a[120:123], a[128:131], v[124:127]
s_add_u32 s24, s24, 128
v_cvt_pk_bf16_f32 v104, v104, v105
v_cvt_pk_bf16_f32 v105, v106, v107
v_mfma_f32_16x16x32_bf16 v[124:127], a[124:127], a[132:135], v[124:127]
s_waitcnt lgkmcnt(2)
v_cvt_pk_bf16_f32 v106, v108, v109
v_cvt_pk_bf16_f32 v107, v110, v111
v_mfma_f32_16x16x32_bf16 v[128:131], a[64:67], a[136:139], v[128:131]
ds_read_b64_tr_b16 a[128:129], v8 offset:32768
v_cvt_pk_bf16_f32 v112, v112, v113
v_mfma_f32_16x16x32_bf16 v[128:131], a[68:71], a[140:143], v[128:131]
v_cvt_pk_bf16_f32 v113, v114, v115
v_cvt_pk_bf16_f32 v114, v116, v117
v_mfma_f32_16x16x32_bf16 v[132:135], a[72:75], a[136:139], v[132:135]
ds_read_b64_tr_b16 a[130:131], v8 offset:34816
v_cvt_pk_bf16_f32 v115, v118, v119
v_mfma_f32_16x16x32_bf16 v[132:135], a[76:79], a[140:143], v[132:135]
buffer_store_dwordx4 v[40:43], v1, s[4:7], s31 offen sc1
v_mfma_f32_16x16x32_bf16 v[136:139], a[80:83], a[136:139], v[136:139]
s_add_u32 s31, s31, s33
ds_read_b64_tr_b16 a[132:133], v8 offset:49152
v_cvt_pk_bf16_f32 v120, v120, v121
v_mfma_f32_16x16x32_bf16 v[136:139], a[84:87], a[140:143], v[136:139]
v_cvt_pk_bf16_f32 v121, v122, v123
v_cvt_pk_bf16_f32 v122, v124, v125
v_mfma_f32_16x16x32_bf16 v[140:143], a[88:91], a[136:139], v[140:143]
ds_read_b64_tr_b16 a[134:135], v8 offset:51200
v_cvt_pk_bf16_f32 v123, v126, v127
v_mfma_f32_16x16x32_bf16 v[140:143], a[92:95], a[140:143], v[140:143]
v_mfma_f32_16x16x32_bf16 v[144:147], a[96:99], a[136:139], v[144:147]
ds_read_b128 a[32:35], v2 offset:8192
v_cvt_pk_bf16_f32 v128, v128, v129
v_mfma_f32_16x16x32_bf16 v[144:147], a[100:103], a[140:143], v[144:147]
v_cvt_pk_bf16_f32 v129, v130, v131
v_cvt_pk_bf16_f32 v130, v132, v133
v_mfma_f32_16x16x32_bf16 v[148:151], a[104:107], a[136:139], v[148:151]
v_cvt_pk_bf16_f32 v131, v134, v135
v_mfma_f32_16x16x32_bf16 v[148:151], a[108:111], a[140:143], v[148:151]
v_mfma_f32_16x16x32_bf16 v[152:155], a[112:115], a[136:139], v[152:155]
ds_read_b128 a[36:39], v3 offset:8192
v_cvt_pk_bf16_f32 v136, v136, v137
v_mfma_f32_16x16x32_bf16 v[152:155], a[116:119], a[140:143], v[152:155]
v_cvt_pk_bf16_f32 v137, v138, v139
v_cvt_pk_bf16_f32 v138, v140, v141
v_mfma_f32_16x16x32_bf16 v[156:159], a[120:123], a[136:139], v[156:159]
ds_read_b128 a[40:43], v2 offset:10240
v_cvt_pk_bf16_f32 v139, v142, v143
v_mfma_f32_16x16x32_bf16 v[156:159], a[124:127], a[140:143], v[156:159]
s_waitcnt lgkmcnt(3)
buffer_store_dwordx4 v[48:51], v1, s[4:7], s31 offen sc1
v_mfma_f32_16x16x32_bf16 v[160:163], a[64:67], a[128:131], v[160:163]
s_add_u32 s31, s31, s32
ds_read_b64_tr_b16 a[136:137], v9 offset:32768
v_cvt_pk_bf16_f32 v144, v144, v145
v_mfma_f32_16x16x32_bf16 v[160:163], a[68:71], a[132:135], v[160:163]
v_cvt_pk_bf16_f32 v145, v146, v147
v_cvt_pk_bf16_f32 v146, v148, v149
v_mfma_f32_16x16x32_bf16 v[164:167], a[72:75], a[128:131], v[164:167]
ds_read_b64_tr_b16 a[138:139], v9 offset:34816
v_cvt_pk_bf16_f32 v147, v150, v151
v_mfma_f32_16x16x32_bf16 v[164:167], a[76:79], a[132:135], v[164:167]
v_mfma_f32_16x16x32_bf16 v[168:171], a[80:83], a[128:131], v[168:171]
ds_read_b64_tr_b16 a[140:141], v9 offset:49152
v_cvt_pk_bf16_f32 v152, v152, v153
v_mfma_f32_16x16x32_bf16 v[168:171], a[84:87], a[132:135], v[168:171]
v_cvt_pk_bf16_f32 v153, v154, v155
v_cvt_pk_bf16_f32 v154, v156, v157
v_mfma_f32_16x16x32_bf16 v[172:175], a[88:91], a[128:131], v[172:175]
ds_read_b64_tr_b16 a[142:143], v9 offset:51200
v_cvt_pk_bf16_f32 v155, v158, v159
v_mfma_f32_16x16x32_bf16 v[172:175], a[92:95], a[132:135], v[172:175]
v_mfma_f32_16x16x32_bf16 v[176:179], a[96:99], a[128:131], v[176:179]
buffer_store_dwordx4 v[56:59], v1, s[4:7], s31 offen sc1
v_mfma_f32_16x16x32_bf16 v[176:179], a[100:103], a[132:135], v[176:179]
s_add_u32 s31, s31, s34
v_cvt_pk_bf16_f32 v160, v160, v161
v_cvt_pk_bf16_f32 v161, v162, v163
v_mfma_f32_16x16x32_bf16 v[180:183], a[104:107], a[128:131], v[180:183]
ds_read_b128 a[44:47], v3 offset:10240
v_cvt_pk_bf16_f32 v162, v164, v165
v_mfma_f32_16x16x32_bf16 v[180:183], a[108:111], a[132:135], v[180:183]
v_cvt_pk_bf16_f32 v163, v166, v167
v_mfma_f32_16x16x32_bf16 v[184:187], a[112:115], a[128:131], v[184:187]
ds_read_b128 a[48:51], v2 offset:12288
v_cvt_pk_bf16_f32 v168, v168, v169
v_mfma_f32_16x16x32_bf16 v[184:187], a[116:119], a[132:135], v[184:187]
v_cvt_pk_bf16_f32 v169, v170, v171
v_cvt_pk_bf16_f32 v170, v172, v173
v_mfma_f32_16x16x32_bf16 v[188:191], a[120:123], a[128:131], v[188:191]
v_cvt_pk_bf16_f32 v171, v174, v175
v_mfma_f32_16x16x32_bf16 v[188:191], a[124:127], a[132:135], v[188:191]
s_waitcnt lgkmcnt(2)
v_mfma_f32_16x16x32_bf16 v[192:195], a[64:67], a[136:139], v[192:195]
ds_read_b64_tr_b16 a[128:129], v10 offset:32768
v_cvt_pk_bf16_f32 v176, v176, v177
v_mfma_f32_16x16x32_bf16 v[192:195], a[68:71], a[140:143], v[192:195]
v_cvt_pk_bf16_f32 v177, v178, v179
v_cvt_pk_bf16_f32 v178, v180, v181
v_mfma_f32_16x16x32_bf16 v[196:199], a[72:75], a[136:139], v[196:199]
ds_read_b64_tr_b16 a[130:131], v10 offset:34816
v_cvt_pk_bf16_f32 v179, v182, v183
v_mfma_f32_16x16x32_bf16 v[196:199], a[76:79], a[140:143], v[196:199]
buffer_store_dwordx4 v[64:67], v1, s[4:7], s31 offen sc1
v_mfma_f32_16x16x32_bf16 v[200:203], a[80:83], a[136:139], v[200:203]
s_add_u32 s31, s31, s32
ds_read_b64_tr_b16 a[132:133], v10 offset:49152
v_cvt_pk_bf16_f32 v184, v184, v185
v_mfma_f32_16x16x32_bf16 v[200:203], a[84:87], a[140:143], v[200:203]
v_cvt_pk_bf16_f32 v185, v186, v187
v_cvt_pk_bf16_f32 v186, v188, v189
v_mfma_f32_16x16x32_bf16 v[204:207], a[88:91], a[136:139], v[204:207]
ds_read_b64_tr_b16 a[134:135], v10 offset:51200
v_cvt_pk_bf16_f32 v187, v190, v191
v_mfma_f32_16x16x32_bf16 v[204:207], a[92:95], a[140:143], v[204:207]
v_mfma_f32_16x16x32_bf16 v[208:211], a[96:99], a[136:139], v[208:211]
ds_read_b128 a[52:55], v3 offset:12288
v_cvt_pk_bf16_f32 v192, v192, v193
v_mfma_f32_16x16x32_bf16 v[208:211], a[100:103], a[140:143], v[208:211]
v_cvt_pk_bf16_f32 v193, v194, v195
v_cvt_pk_bf16_f32 v194, v196, v197
v_mfma_f32_16x16x32_bf16 v[212:215], a[104:107], a[136:139], v[212:215]
ds_read_b128 a[56:59], v2 offset:14336
v_cvt_pk_bf16_f32 v195, v198, v199
v_mfma_f32_16x16x32_bf16 v[212:215], a[108:111], a[140:143], v[212:215]
v_mfma_f32_16x16x32_bf16 v[216:219], a[112:115], a[136:139], v[216:219]
v_cvt_pk_bf16_f32 v200, v200, v201
v_cvt_pk_bf16_f32 v201, v202, v203
v_mfma_f32_16x16x32_bf16 v[216:219], a[116:119], a[140:143], v[216:219]
buffer_store_dwordx4 v[72:75], v1, s[4:7], s31 offen sc1
v_mfma_f32_16x16x32_bf16 v[220:223], a[120:123], a[136:139], v[220:223]
s_add_u32 s31, s31, s33
ds_read_b128 a[60:63], v3 offset:14336
v_cvt_pk_bf16_f32 v202, v204, v205
v_mfma_f32_16x16x32_bf16 v[220:223], a[124:127], a[140:143], v[220:223]
s_waitcnt lgkmcnt(3)
v_cvt_pk_bf16_f32 v203, v206, v207
v_mfma_f32_16x16x32_bf16 a[192:195], a[64:67], a[128:131], a[192:195]
ds_read_b64_tr_b16 a[136:137], v11 offset:32768
v_cvt_pk_bf16_f32 v208, v208, v209
v_mfma_f32_16x16x32_bf16 a[192:195], a[68:71], a[132:135], a[192:195]
v_cvt_pk_bf16_f32 v209, v210, v211
v_cvt_pk_bf16_f32 v210, v212, v213
v_mfma_f32_16x16x32_bf16 a[196:199], a[72:75], a[128:131], a[196:199]
ds_read_b64_tr_b16 a[138:139], v11 offset:34816
v_cvt_pk_bf16_f32 v211, v214, v215
v_mfma_f32_16x16x32_bf16 a[196:199], a[76:79], a[132:135], a[196:199]
v_mfma_f32_16x16x32_bf16 a[200:203], a[80:83], a[128:131], a[200:203]
ds_read_b64_tr_b16 a[140:141], v11 offset:49152
v_cvt_pk_bf16_f32 v216, v216, v217
v_mfma_f32_16x16x32_bf16 a[200:203], a[84:87], a[132:135], a[200:203]
v_cvt_pk_bf16_f32 v217, v218, v219
v_cvt_pk_bf16_f32 v218, v220, v221
v_mfma_f32_16x16x32_bf16 a[204:207], a[88:91], a[128:131], a[204:207]
ds_read_b64_tr_b16 a[142:143], v11 offset:51200
v_cvt_pk_bf16_f32 v219, v222, v223
v_mfma_f32_16x16x32_bf16 a[204:207], a[92:95], a[132:135], a[204:207]
v_mfma_f32_16x16x32_bf16 a[208:211], a[96:99], a[128:131], a[208:211]
buffer_store_dwordx4 v[80:83], v1, s[4:7], s31 offen sc1
v_mfma_f32_16x16x32_bf16 a[208:211], a[100:103], a[132:135], a[208:211]
s_add_u32 s31, s31, s32
v_mfma_f32_16x16x32_bf16 a[212:215], a[104:107], a[128:131], a[212:215]
v_mfma_f32_16x16x32_bf16 a[212:215], a[108:111], a[132:135], a[212:215]
v_mfma_f32_16x16x32_bf16 a[216:219], a[112:115], a[128:131], a[216:219]
v_mfma_f32_16x16x32_bf16 a[216:219], a[116:119], a[132:135], a[216:219]
v_mfma_f32_16x16x32_bf16 a[220:223], a[120:123], a[128:131], a[220:223]
s_waitcnt vmcnt(23) lgkmcnt(0)
v_mfma_f32_16x16x32_bf16 a[220:223], a[124:127], a[132:135], a[220:223]
s_barrier
v_mfma_f32_16x16x32_bf16 a[224:227], a[64:67], a[136:139], a[224:227]
s_add_u32 m0, s29, 98304
ds_read_b64_tr_b16 a[128:129], v22 offset:0
v_mfma_f32_16x16x32_bf16 a[224:227], a[68:71], a[140:143], a[224:227]
buffer_load_dwordx4 v16, s[12:15], s26 offen offset:0 lds
v_mfma_f32_16x16x32_bf16 a[228:231], a[72:75], a[136:139], a[228:231]
ds_read_b64_tr_b16 a[130:131], v22 offset:2048
v_mfma_f32_16x16x32_bf16 a[228:231], a[76:79], a[140:143], a[228:231]
buffer_store_dwordx4 v[88:91], v1, s[4:7], s31 offen sc1
v_mfma_f32_16x16x32_bf16 a[232:235], a[80:83], a[136:139], a[232:235]
s_add_u32 s31, s31, s35
ds_read_b64_tr_b16 a[132:133], v22 offset:16384
v_mfma_f32_16x16x32_bf16 a[232:235], a[84:87], a[140:143], a[232:235]
buffer_load_dwordx4 v17, s[12:15], s26 offen offset:1024 lds
v_mfma_f32_16x16x32_bf16 a[236:239], a[88:91], a[136:139], a[236:239]
ds_read_b64_tr_b16 a[134:135], v22 offset:18432
v_add_u32 v22, 4294901760, v22
v_mfma_f32_16x16x32_bf16 a[236:239], a[92:95], a[140:143], a[236:239]
v_mfma_f32_16x16x32_bf16 a[240:243], a[96:99], a[136:139], a[240:243]
v_mfma_f32_16x16x32_bf16 a[240:243], a[100:103], a[140:143], a[240:243]
buffer_load_dwordx4 v18, s[12:15], s26 offen offset:2048 lds
v_mfma_f32_16x16x32_bf16 a[244:247], a[104:107], a[136:139], a[244:247]
v_mfma_f32_16x16x32_bf16 a[244:247], a[108:111], a[140:143], a[244:247]
v_mfma_f32_16x16x32_bf16 a[248:251], a[112:115], a[136:139], a[248:251]
v_mfma_f32_16x16x32_bf16 a[248:251], a[116:119], a[140:143], a[248:251]
buffer_load_dwordx4 v19, s[12:15], s26 offen offset:3072 lds
v_mfma_f32_16x16x32_bf16 a[252:255], a[120:123], a[136:139], a[252:255]
s_add_u32 s26, s26, 524288
v_mfma_f32_16x16x32_bf16 a[252:255], a[124:127], a[140:143], a[252:255]
s_waitcnt lgkmcnt(0)
s_cmp_ge_u32 s21, 7
s_cbranch_scc1 M_Q
M_conv:
v_mfma_f32_16x16x32_bf16 v[36:39], a[128:131], a[0:3], 0
s_add_u32 m0, s29, 114688
ds_read_b64_tr_b16 a[136:137], v23 offset:0
v_mfma_f32_16x16x32_bf16 v[36:39], a[132:135], a[4:7], v[36:39]
buffer_load_dwordx4 v16, s[12:15], s27 offen offset:0 lds
v_mfma_f32_16x16x32_bf16 v[44:47], a[128:131], a[8:11], 0
ds_read_b64_tr_b16 a[138:139], v23 offset:2048
v_mfma_f32_16x16x32_bf16 v[44:47], a[132:135], a[12:15], v[44:47]
ds_read_b128 a[64:67], v2 offset:16384
ds_read_b128 a[68:71], v3 offset:16384
v_mfma_f32_16x16x32_bf16 v[52:55], a[128:131], a[16:19], 0
ds_read_b64_tr_b16 a[140:141], v23 offset:16384
v_mfma_f32_16x16x32_bf16 v[52:55], a[132:135], a[20:23], v[52:55]
buffer_load_dwordx4 v17, s[12:15], s27 offen offset:1024 lds
v_mfma_f32_16x16x32_bf16 v[60:63], a[128:131], a[24:27], 0
ds_read_b64_tr_b16 a[142:143], v23 offset:18432
v_add_u32 v23, 4294901760, v23
v_mfma_f32_16x16x32_bf16 v[60:63], a[132:135], a[28:31], v[60:63]
buffer_store_dwordx4 v[96:99], v1, s[4:7], s31 offen sc1
v_mfma_f32_16x16x32_bf16 v[68:71], a[128:131], a[32:35], 0
s_add_u32 s31, s31, s32
ds_read_b128 a[72:75], v2 offset:18432
v_mfma_f32_16x16x32_bf16 v[68:71], a[132:135], a[36:39], v[68:71]
buffer_load_dwordx4 v18, s[12:15], s27 offen offset:2048 lds
v_mfma_f32_16x16x32_bf16 v[76:79], a[128:131], a[40:43], 0
ds_read_b128 a[76:79], v3 offset:18432
v_mfma_f32_16x16x32_bf16 v[76:79], a[132:135], a[44:47], v[76:79]
ds_read_b128 a[80:83], v2 offset:20480
v_mfma_f32_16x16x32_bf16 v[84:87], a[128:131], a[48:51], 0
ds_read_b128 a[84:87], v3 offset:20480
v_mfma_f32_16x16x32_bf16 v[84:87], a[132:135], a[52:55], v[84:87]
buffer_load_dwordx4 v19, s[12:15], s27 offen offset:3072 lds
v_mfma_f32_16x16x32_bf16 v[92:95], a[128:131], a[56:59], 0
s_add_u32 s27, s27, 524288
ds_read_b128 a[88:91], v2 offset:22528
v_mfma_f32_16x16x32_bf16 v[92:95], a[132:135], a[60:63], v[92:95]
s_waitcnt lgkmcnt(5)
buffer_store_dwordx4 v[104:107], v1, s[4:7], s31 offen sc1
v_mfma_f32_16x16x32_bf16 v[100:103], a[136:139], a[0:3], 0
s_add_u32 m0, s28, 0
ds_read_b64_tr_b16 a[128:129], v24 offset:0
v_mfma_f32_16x16x32_bf16 v[100:103], a[140:143], a[4:7], v[100:103]
s_add_u32 s31, s31, s33
buffer_load_dwordx4 v12, s[8:11], s24 offen offset:0 lds
v_mfma_f32_16x16x32_bf16 v[108:111], a[136:139], a[8:11], 0
ds_read_b64_tr_b16 a[130:131], v24 offset:2048
v_mfma_f32_16x16x32_bf16 v[108:111], a[140:143], a[12:15], v[108:111]
ds_read_b128 a[92:95], v3 offset:22528
v_mfma_f32_16x16x32_bf16 v[116:119], a[136:139], a[16:19], 0
ds_read_b64_tr_b16 a[132:133], v24 offset:16384
v_mfma_f32_16x16x32_bf16 v[116:119], a[140:143], a[20:23], v[116:119]
buffer_load_dwordx4 v13, s[8:11], s24 offen offset:1024 lds
v_mfma_f32_16x16x32_bf16 v[124:127], a[136:139], a[24:27], 0
ds_read_b64_tr_b16 a[134:135], v24 offset:18432
v_add_u32 v24, 4294901760, v24
v_mfma_f32_16x16x32_bf16 v[124:127], a[140:143], a[28:31], v[124:127]
v_mfma_f32_16x16x32_bf16 v[132:135], a[136:139], a[32:35], 0
ds_read_b128 a[96:99], v2 offset:24576
v_mfma_f32_16x16x32_bf16 v[132:135], a[140:143], a[36:39], v[132:135]
buffer_load_dwordx4 v14, s[8:11], s24 offen offset:2048 lds
v_mfma_f32_16x16x32_bf16 v[140:143], a[136:139], a[40:43], 0
ds_read_b128 a[100:103], v3 offset:24576
v_mfma_f32_16x16x32_bf16 v[140:143], a[140:143], a[44:47], v[140:143]
ds_read_b128 a[104:107], v2 offset:26624
v_mfma_f32_16x16x32_bf16 v[148:151], a[136:139], a[48:51], 0
ds_read_b128 a[108:111], v3 offset:26624
v_mfma_f32_16x16x32_bf16 v[148:151], a[140:143], a[52:55], v[148:151]
buffer_load_dwordx4 v15, s[8:11], s24 offen offset:3072 lds
v_mfma_f32_16x16x32_bf16 v[156:159], a[136:139], a[56:59], 0
s_add_u32 s24, s24, 128
ds_read_b128 a[112:115], v2 offset:28672
v_mfma_f32_16x16x32_bf16 v[156:159], a[140:143], a[60:63], v[156:159]
s_waitcnt lgkmcnt(5)
buffer_store_dwordx4 v[112:115], v1, s[4:7], s31 offen sc1
v_mfma_f32_16x16x32_bf16 v[164:167], a[128:131], a[0:3], 0
s_add_u32 s31, s31, s32
ds_read_b64_tr_b16 a[136:137], v25 offset:0
v_mfma_f32_16x16x32_bf16 v[164:167], a[132:135], a[4:7], v[164:167]
v_mfma_f32_16x16x32_bf16 v[172:175], a[128:131], a[8:11], 0
ds_read_b64_tr_b16 a[138:139], v25 offset:2048
v_mfma_f32_16x16x32_bf16 v[172:175], a[132:135], a[12:15], v[172:175]
ds_read_b128 a[116:119], v3 offset:28672
v_mfma_f32_16x16x32_bf16 v[180:183], a[128:131], a[16:19], 0
ds_read_b64_tr_b16 a[140:141], v25 offset:16384
v_mfma_f32_16x16x32_bf16 v[180:183], a[132:135], a[20:23], v[180:183]
v_mfma_f32_16x16x32_bf16 v[188:191], a[128:131], a[24:27], 0
ds_read_b64_tr_b16 a[142:143], v25 offset:18432
v_add_u32 v25, 4294901760, v25
v_mfma_f32_16x16x32_bf16 v[188:191], a[132:135], a[28:31], v[188:191]
v_mfma_f32_16x16x32_bf16 v[196:199], a[128:131], a[32:35], 0
ds_read_b128 a[120:123], v2 offset:30720
v_mfma_f32_16x16x32_bf16 v[196:199], a[132:135], a[36:39], v[196:199]
v_mfma_f32_16x16x32_bf16 v[204:207], a[128:131], a[40:43], 0
ds_read_b128 a[124:127], v3 offset:30720
v_mfma_f32_16x16x32_bf16 v[204:207], a[132:135], a[44:47], v[204:207]
v_mfma_f32_16x16x32_bf16 v[212:215], a[128:131], a[48:51], 0
v_mfma_f32_16x16x32_bf16 v[212:215], a[132:135], a[52:55], v[212:215]
buffer_store_dwordx4 v[120:123], v1, s[4:7], s31 offen sc1
v_mfma_f32_16x16x32_bf16 v[220:223], a[128:131], a[56:59], 0
s_add_u32 s31, s31, s34
v_mfma_f32_16x16x32_bf16 v[220:223], a[132:135], a[60:63], v[220:223]
s_waitcnt vmcnt(28) lgkmcnt(0)
s_barrier
v_mfma_f32_16x16x32_bf16 v[224:227], a[136:139], a[0:3], 0
s_add_u32 m0, s29, 131072
ds_read_b64_tr_b16 a[128:129], v22 offset:0
v_mfma_f32_16x16x32_bf16 v[224:227], a[140:143], a[4:7], v[224:227]
buffer_load_dwordx4 v16, s[12:15], s26 offen offset:0 lds
v_mfma_f32_16x16x32_bf16 v[228:231], a[136:139], a[8:11], 0
ds_read_b64_tr_b16 a[130:131], v22 offset:2048
v_mfma_f32_16x16x32_bf16 v[228:231], a[140:143], a[12:15], v[228:231]
v_mfma_f32_16x16x32_bf16 v[232:235], a[136:139], a[16:19], 0
ds_read_b64_tr_b16 a[132:133], v22 offset:16384
v_mfma_f32_16x16x32_bf16 v[232:235], a[140:143], a[20:23], v[232:235]
buffer_load_dwordx4 v17, s[12:15], s26 offen offset:1024 lds
v_mfma_f32_16x16x32_bf16 v[236:239], a[136:139], a[24:27], 0
ds_read_b64_tr_b16 a[134:135], v22 offset:18432
v_add_u32 v22, 32768, v22
v_mfma_f32_16x16x32_bf16 v[236:239], a[140:143], a[28:31], v[236:239]
v_mfma_f32_16x16x32_bf16 v[240:243], a[136:139], a[32:35], 0
v_mfma_f32_16x16x32_bf16 v[240:243], a[140:143], a[36:39], v[240:243]
buffer_load_dwordx4 v18, s[12:15], s26 offen offset:2048 lds
v_mfma_f32_16x16x32_bf16 v[244:247], a[136:139], a[40:43], 0
v_mfma_f32_16x16x32_bf16 v[244:247], a[140:143], a[44:47], v[244:247]
v_mfma_f32_16x16x32_bf16 v[248:251], a[136:139], a[48:51], 0
v_mfma_f32_16x16x32_bf16 v[248:251], a[140:143], a[52:55], v[248:251]
buffer_load_dwordx4 v19, s[12:15], s26 offen offset:3072 lds
v_mfma_f32_16x16x32_bf16 v[252:255], a[136:139], a[56:59], 0
s_add_u32 s26, s26, 524288
v_mfma_f32_16x16x32_bf16 v[252:255], a[140:143], a[60:63], v[252:255]
s_waitcnt lgkmcnt(0)
v_mfma_f32_16x16x32_bf16 v[36:39], a[128:131], a[64:67], v[36:39]
s_add_u32 m0, s29, 147456
ds_read_b64_tr_b16 a[136:137], v23 offset:0
v_mfma_f32_16x16x32_bf16 v[36:39], a[132:135], a[68:71], v[36:39]
buffer_load_dwordx4 v16, s[12:15], s27 offen offset:0 lds
v_mfma_f32_16x16x32_bf16 v[44:47], a[128:131], a[72:75], v[44:47]
ds_read_b64_tr_b16 a[138:139], v23 offset:2048
v_mfma_f32_16x16x32_bf16 v[44:47], a[132:135], a[76:79], v[44:47]
ds_read_b128 a[0:3], v2 offset:32768
ds_read_b128 a[4:7], v3 offset:32768
v_mfma_f32_16x16x32_bf16 v[52:55], a[128:131], a[80:83], v[52:55]
ds_read_b64_tr_b16 a[140:141], v23 offset:16384
v_mfma_f32_16x16x32_bf16 v[52:55], a[132:135], a[84:87], v[52:55]
buffer_load_dwordx4 v17, s[12:15], s27 offen offset:1024 lds
v_mfma_f32_16x16x32_bf16 v[60:63], a[128:131], a[88:91], v[60:63]
ds_read_b64_tr_b16 a[142:143], v23 offset:18432
v_add_u32 v23, 32768, v23
v_mfma_f32_16x16x32_bf16 v[60:63], a[132:135], a[92:95], v[60:63]
buffer_store_dwordx4 v[128:131], v1, s[4:7], s31 offen sc1
v_mfma_f32_16x16x32_bf16 v[68:71], a[128:131], a[96:99], v[68:71]
s_add_u32 s31, s31, s32
ds_read_b128 a[8:11], v2 offset:34816
v_accvgpr_read_b32 v32, a192
v_mfma_f32_16x16x32_bf16 v[68:71], a[132:135], a[100:103], v[68:71]
buffer_load_dwordx4 v18, s[12:15], s27 offen offset:2048 lds
v_mfma_f32_16x16x32_bf16 v[76:79], a[128:131], a[104:107], v[76:79]
ds_read_b128 a[12:15], v3 offset:34816
v_accvgpr_read_b32 v33, a193
v_mfma_f32_16x16x32_bf16 v[76:79], a[132:135], a[108:111], v[76:79]
ds_read_b128 a[16:19], v2 offset:36864
v_accvgpr_read_b32 v34, a194
v_mfma_f32_16x16x32_bf16 v[84:87], a[128:131], a[112:115], v[84:87]
ds_read_b128 a[20:23], v3 offset:36864
v_accvgpr_read_b32 v35, a195
v_mfma_f32_16x16x32_bf16 v[84:87], a[132:135], a[116:119], v[84:87]
buffer_load_dwordx4 v19, s[12:15], s27 offen offset:3072 lds
v_mfma_f32_16x16x32_bf16 v[92:95], a[128:131], a[120:123], v[92:95]
s_add_u32 s27, s27, 524288
ds_read_b128 a[24:27], v2 offset:38912
v_accvgpr_read_b32 v96, a196
v_mfma_f32_16x16x32_bf16 v[92:95], a[132:135], a[124:127], v[92:95]
s_waitcnt lgkmcnt(5)
buffer_store_dwordx4 v[136:139], v1, s[4:7], s31 offen sc1
v_mfma_f32_16x16x32_bf16 v[100:103], a[136:139], a[64:67], v[100:103]
s_add_u32 m0, s28, 16384
ds_read_b64_tr_b16 a[128:129], v24 offset:0
v_accvgpr_read_b32 v97, a197
v_mfma_f32_16x16x32_bf16 v[100:103], a[140:143], a[68:71], v[100:103]
s_add_u32 s31, s31, s33
buffer_load_dwordx4 v12, s[8:11], s24 offen offset:0 lds
v_mfma_f32_16x16x32_bf16 v[108:111], a[136:139], a[72:75], v[108:111]
ds_read_b64_tr_b16 a[130:131], v24 offset:2048
v_accvgpr_read_b32 v98, a198
v_mfma_f32_16x16x32_bf16 v[108:111], a[140:143], a[76:79], v[108:111]
ds_read_b128 a[28:31], v3 offset:38912
v_accvgpr_read_b32 v99, a199
v_mfma_f32_16x16x32_bf16 v[116:119], a[136:139], a[80:83], v[116:119]
ds_read_b64_tr_b16 a[132:133], v24 offset:16384
v_cvt_pk_bf16_f32 v32, v32, v33
v_mfma_f32_16x16x32_bf16 v[116:119], a[140:143], a[84:87], v[116:119]
buffer_load_dwordx4 v13, s[8:11], s24 offen offset:1024 lds
v_mfma_f32_16x16x32_bf16 v[124:127], a[136:139], a[88:91], v[124:127]
ds_read_b64_tr_b16 a[134:135], v24 offset:18432
v_add_u32 v24, 32768, v24
v_mfma_f32_16x16x32_bf16 v[124:127], a[140:143], a[92:95], v[124:127]
v_cvt_pk_bf16_f32 v33, v34, v35
v_cvt_pk_bf16_f32 v34, v96, v97
v_mfma_f32_16x16x32_bf16 v[132:135], a[136:139], a[96:99], v[132:135]
ds_read_b128 a[32:35], v2 offset:40960
v_cvt_pk_bf16_f32 v35, v98, v99
v_mfma_f32_16x16x32_bf16 v[132:135], a[140:143], a[100:103], v[132:135]
buffer_load_dwordx4 v14, s[8:11], s24 offen offset:2048 lds
v_mfma_f32_16x16x32_bf16 v[140:143], a[136:139], a[104:107], v[140:143]
ds_read_b128 a[36:39], v3 offset:40960
v_accvgpr_read_b32 v40, a200
v_mfma_f32_16x16x32_bf16 v[140:143], a[140:143], a[108:111], v[140:143]
ds_read_b128 a[40:43], v2 offset:43008
v_accvgpr_read_b32 v41, a201
v_mfma_f32_16x16x32_bf16 v[148:151], a[136:139], a[112:115], v[148:151]
ds_read_b128 a[44:47], v3 offset:43008
v_accvgpr_read_b32 v42, a202
v_mfma_f32_16x16x32_bf16 v[148:151], a[140:143], a[116:119], v[148:151]
buffer_load_dwordx4 v15, s[8:11], s24 offen offset:3072 lds
v_mfma_f32_16x16x32_bf16 v[156:159], a[136:139], a[120:123], v[156:159]
s_add_u32 s24, s24, 128
ds_read_b128 a[48:51], v2 offset:45056
v_accvgpr_read_b32 v43, a203
v_mfma_f32_16x16x32_bf16 v[156:159], a[140:143], a[124:127], v[156:159]
s_waitcnt lgkmcnt(5)
buffer_store_dwordx4 v[144:147], v1, s[4:7], s31 offen sc1
v_mfma_f32_16x16x32_bf16 v[164:167], a[128:131], a[64:67], v[164:167]
s_add_u32 s31, s31, s32
ds_read_b64_tr_b16 a[136:137], v25 offset:0
v_accvgpr_read_b32 v96, a204
v_mfma_f32_16x16x32_bf16 v[164:167], a[132:135], a[68:71], v[164:167]
v_accvgpr_read_b32 v97, a205
v_accvgpr_read_b32 v98, a206
v_mfma_f32_16x16x32_bf16 v[172:175], a[128:131], a[72:75], v[172:175]
ds_read_b64_tr_b16 a[138:139], v25 offset:2048
v_accvgpr_read_b32 v99, a207
v_mfma_f32_16x16x32_bf16 v[172:175], a[132:135], a[76:79], v[172:175]
ds_read_b128 a[52:55], v3 offset:45056
v_cvt_pk_bf16_f32 v40, v40, v41
v_mfma_f32_16x16x32_bf16 v[180:183], a[128:131], a[80:83], v[180:183]
ds_read_b64_tr_b16 a[140:141], v25 offset:16384
v_cvt_pk_bf16_f32 v41, v42, v43
v_mfma_f32_16x16x32_bf16 v[180:183], a[132:135], a[84:87], v[180:183]
v_cvt_pk_bf16_f32 v42, v96, v97
v_cvt_pk_bf16_f32 v43, v98, v99
v_mfma_f32_16x16x32_bf16 v[188:191], a[128:131], a[88:91], v[188:191]
ds_read_b64_tr_b16 a[142:143], v25 offset:18432
v_add_u32 v25, 32768, v25
v_mfma_f32_16x16x32_bf16 v[188:191], a[132:135], a[92:95], v[188:191]
v_accvgpr_read_b32 v48, a208
v_accvgpr_read_b32 v49, a209
v_mfma_f32_16x16x32_bf16 v[196:199], a[128:131], a[96:99], v[196:199]
ds_read_b128 a[56:59], v2 offset:47104
v_accvgpr_read_b32 v50, a210
v_mfma_f32_16x16x32_bf16 v[196:199], a[132:135], a[100:103], v[196:199]
v_accvgpr_read_b32 v51, a211
v_accvgpr_read_b32 v96, a212
v_mfma_f32_16x16x32_bf16 v[204:207], a[128:131], a[104:107], v[204:207]
ds_read_b128 a[60:63], v3 offset:47104
v_accvgpr_read_b32 v97, a213
v_mfma_f32_16x16x32_bf16 v[204:207], a[132:135], a[108:111], v[204:207]
v_accvgpr_read_b32 v98, a214
v_accvgpr_read_b32 v99, a215
v_mfma_f32_16x16x32_bf16 v[212:215], a[128:131], a[112:115], v[212:215]
v_cvt_pk_bf16_f32 v48, v48, v49
v_cvt_pk_bf16_f32 v49, v50, v51
v_mfma_f32_16x16x32_bf16 v[212:215], a[132:135], a[116:119], v[212:215]
buffer_store_dwordx4 v[152:155], v1, s[4:7], s31 offen sc1
v_mfma_f32_16x16x32_bf16 v[220:223], a[128:131], a[120:123], v[220:223]
s_add_u32 s31, s31, s36
v_cvt_pk_bf16_f32 v50, v96, v97
v_cvt_pk_bf16_f32 v51, v98, v99
v_mfma_f32_16x16x32_bf16 v[220:223], a[132:135], a[124:127], v[220:223]
s_waitcnt vmcnt(23) lgkmcnt(0)
s_barrier
v_accvgpr_read_b32 v56, a216
v_mfma_f32_16x16x32_bf16 v[224:227], a[136:139], a[64:67], v[224:227]
s_add_u32 m0, s29, 65536
ds_read_b64_tr_b16 a[128:129], v22 offset:0
v_accvgpr_read_b32 v57, a217
v_mfma_f32_16x16x32_bf16 v[224:227], a[140:143], a[68:71], v[224:227]
buffer_load_dwordx4 v16, s[12:15], s26 offen offset:0 lds
v_mfma_f32_16x16x32_bf16 v[228:231], a[136:139], a[72:75], v[228:231]
ds_read_b64_tr_b16 a[130:131], v22 offset:2048
v_accvgpr_read_b32 v58, a218
v_mfma_f32_16x16x32_bf16 v[228:231], a[140:143], a[76:79], v[228:231]
v_accvgpr_read_b32 v59, a219
v_accvgpr_read_b32 v96, a220
v_mfma_f32_16x16x32_bf16 v[232:235], a[136:139], a[80:83], v[232:235]
ds_read_b64_tr_b16 a[132:133], v22 offset:16384
v_accvgpr_read_b32 v97, a221
v_mfma_f32_16x16x32_bf16 v[232:235], a[140:143], a[84:87], v[232:235]
buffer_load_dwordx4 v17, s[12:15], s26 offen offset:1024 lds
v_mfma_f32_16x16x32_bf16 v[236:239], a[136:139], a[88:91], v[236:239]
ds_read_b64_tr_b16 a[134:135], v22 offset:18432
v_add_u32 v22, 32768, v22
v_mfma_f32_16x16x32_bf16 v[236:239], a[140:143], a[92:95], v[236:239]
PAD_28:
s_cbranch_execz M_tret
v_accvgpr_read_b32 v98, a222
v_accvgpr_read_b32 v99, a223
v_mfma_f32_16x16x32_bf16 v[240:243], a[136:139], a[96:99], v[240:243]
v_cvt_pk_bf16_f32 v56, v56, v57
v_cvt_pk_bf16_f32 v57, v58, v59
v_mfma_f32_16x16x32_bf16 v[240:243], a[140:143], a[100:103], v[240:243]
buffer_load_dwordx4 v18, s[12:15], s26 offen offset:2048 lds
v_mfma_f32_16x16x32_bf16 v[244:247], a[136:139], a[104:107], v[244:247]
v_cvt_pk_bf16_f32 v58, v96, v97
v_cvt_pk_bf16_f32 v59, v98, v99
v_mfma_f32_16x16x32_bf16 v[244:247], a[140:143], a[108:111], v[244:247]
v_accvgpr_read_b32 v64, a224
v_accvgpr_read_b32 v65, a225
v_mfma_f32_16x16x32_bf16 v[248:251], a[136:139], a[112:115], v[248:251]
v_accvgpr_read_b32 v66, a226
v_accvgpr_read_b32 v67, a227
v_mfma_f32_16x16x32_bf16 v[248:251], a[140:143], a[116:119], v[248:251]
buffer_load_dwordx4 v19, s[12:15], s26 offen offset:3072 lds
v_mfma_f32_16x16x32_bf16 v[252:255], a[136:139], a[120:123], v[252:255]
s_add_u32 s26, s26, 524288
v_accvgpr_read_b32 v96, a228
v_accvgpr_read_b32 v97, a229
v_mfma_f32_16x16x32_bf16 v[252:255], a[140:143], a[124:127], v[252:255]
s_waitcnt lgkmcnt(0)
v_accvgpr_read_b32 v98, a230
v_accvgpr_read_b32 v99, a231
v_mfma_f32_16x16x32_bf16 v[36:39], a[128:131], a[0:3], v[36:39]
s_add_u32 m0, s29, 81920
ds_read_b64_tr_b16 a[136:137], v23 offset:0
v_cvt_pk_bf16_f32 v64, v64, v65
v_mfma_f32_16x16x32_bf16 v[36:39], a[132:135], a[4:7], v[36:39]
buffer_load_dwordx4 v16, s[12:15], s27 offen offset:0 lds
v_mfma_f32_16x16x32_bf16 v[44:47], a[128:131], a[8:11], v[44:47]
ds_read_b64_tr_b16 a[138:139], v23 offset:2048
v_cvt_pk_bf16_f32 v65, v66, v67
v_mfma_f32_16x16x32_bf16 v[44:47], a[132:135], a[12:15], v[44:47]
ds_read_b128 a[64:67], v2 offset:49152
ds_read_b128 a[68:71], v3 offset:49152
v_mfma_f32_16x16x32_bf16 v[52:55], a[128:131], a[16:19], v[52:55]
ds_read_b64_tr_b16 a[140:141], v23 offset:16384
v_cvt_pk_bf16_f32 v66, v96, v97
v_mfma_f32_16x16x32_bf16 v[52:55], a[132:135], a[20:23], v[52:55]
buffer_load_dwordx4 v17, s[12:15], s27 offen offset:1024 lds
v_mfma_f32_16x16x32_bf16 v[60:63], a[128:131], a[24:27], v[60:63]
ds_read_b64_tr_b16 a[142:143], v23 offset:18432
v_add_u32 v23, 32768, v23
v_mfma_f32_16x16x32_bf16 v[60:63], a[132:135], a[28:31], v[60:63]
buffer_store_dwordx4 v[160:163], v1, s[4:7], s31 offen sc1
v_mfma_f32_16x16x32_bf16 v[68:71], a[128:131], a[32:35], v[68:71]
s_add_u32 s31, s31, s32
ds_read_b128 a[72:75], v2 offset:51200
v_cvt_pk_bf16_f32 v67, v98, v99
v_mfma_f32_16x16x32_bf16 v[68:71], a[132:135], a[36:39], v[68:71]
buffer_load_dwordx4 v18, s[12:15], s27 offen offset:2048 lds
v_mfma_f32_16x16x32_bf16 v[76:79], a[128:131], a[40:43], v[76:79]
ds_read_b128 a[76:79], v3 offset:51200
v_accvgpr_read_b32 v72, a232
v_mfma_f32_16x16x32_bf16 v[76:79], a[132:135], a[44:47], v[76:79]
ds_read_b128 a[80:83], v2 offset:53248
v_accvgpr_read_b32 v73, a233
v_mfma_f32_16x16x32_bf16 v[84:87], a[128:131], a[48:51], v[84:87]
ds_read_b128 a[84:87], v3 offset:53248
v_accvgpr_read_b32 v74, a234
v_mfma_f32_16x16x32_bf16 v[84:87], a[132:135], a[52:55], v[84:87]
buffer_load_dwordx4 v19, s[12:15], s27 offen offset:3072 lds
v_mfma_f32_16x16x32_bf16 v[92:95], a[128:131], a[56:59], v[92:95]
s_add_u32 s27, s27, 524288
ds_read_b128 a[88:91], v2 offset:55296
v_accvgpr_read_b32 v75, a235
v_mfma_f32_16x16x32_bf16 v[92:95], a[132:135], a[60:63], v[92:95]
s_waitcnt lgkmcnt(5)
buffer_store_dwordx4 v[168:171], v1, s[4:7], s31 offen sc1
v_mfma_f32_16x16x32_bf16 v[100:103], a[136:139], a[0:3], v[100:103]
s_add_u32 m0, s28, 32768
ds_read_b64_tr_b16 a[128:129], v24 offset:0
v_accvgpr_read_b32 v96, a236
v_mfma_f32_16x16x32_bf16 v[100:103], a[140:143], a[4:7], v[100:103]
s_add_u32 s31, s31, s33
buffer_load_dwordx4 v12, s[8:11], s24 offen offset:0 lds
v_mfma_f32_16x16x32_bf16 v[108:111], a[136:139], a[8:11], v[108:111]
ds_read_b64_tr_b16 a[130:131], v24 offset:2048
v_accvgpr_read_b32 v97, a237
v_mfma_f32_16x16x32_bf16 v[108:111], a[140:143], a[12:15], v[108:111]
ds_read_b128 a[92:95], v3 offset:55296
v_accvgpr_read_b32 v98, a238
v_mfma_f32_16x16x32_bf16 v[116:119], a[136:139], a[16:19], v[116:119]
ds_read_b64_tr_b16 a[132:133], v24 offset:16384
v_accvgpr_read_b32 v99, a239
v_mfma_f32_16x16x32_bf16 v[116:119], a[140:143], a[20:23], v[116:119]
buffer_load_dwordx4 v13, s[8:11], s24 offen offset:1024 lds
v_mfma_f32_16x16x32_bf16 v[124:127], a[136:139], a[24:27], v[124:127]
ds_read_b64_tr_b16 a[134:135], v24 offset:18432
v_add_u32 v24, 32768, v24
v_mfma_f32_16x16x32_bf16 v[124:127], a[140:143], a[28:31], v[124:127]
v_cvt_pk_bf16_f32 v72, v72, v73
v_cvt_pk_bf16_f32 v73, v74, v75
v_mfma_f32_16x16x32_bf16 v[132:135], a[136:139], a[32:35], v[132:135]
ds_read_b128 a[96:99], v2 offset:57344
v_cvt_pk_bf16_f32 v74, v96, v97
v_mfma_f32_16x16x32_bf16 v[132:135], a[140:143], a[36:39], v[132:135]
buffer_load_dwordx4 v14, s[8:11], s24 offen offset:2048 lds
v_mfma_f32_16x16x32_bf16 v[140:143], a[136:139], a[40:43], v[140:143]
ds_read_b128 a[100:103], v3 offset:57344
v_cvt_pk_bf16_f32 v75, v98, v99
v_mfma_f32_16x16x32_bf16 v[140:143], a[140:143], a[44:47], v[140:143]
ds_read_b128 a[104:107], v2 offset:59392
v_accvgpr_read_b32 v80, a240
v_mfma_f32_16x16x32_bf16 v[148:151], a[136:139], a[48:51], v[148:151]
ds_read_b128 a[108:111], v3 offset:59392
v_accvgpr_read_b32 v81, a241
v_mfma_f32_16x16x32_bf16 v[148:151], a[140:143], a[52:55], v[148:151]
buffer_load_dwordx4 v15, s[8:11], s24 offen offset:3072 lds
v_mfma_f32_16x16x32_bf16 v[156:159], a[136:139], a[56:59], v[156:159]
s_add_u32 s24, s24, 128
ds_read_b128 a[112:115], v2 offset:61440
v_accvgpr_read_b32 v82, a242
v_mfma_f32_16x16x32_bf16 v[156:159], a[140:143], a[60:63], v[156:159]
s_waitcnt lgkmcnt(5)
buffer_store_dwordx4 v[176:179], v1, s[4:7], s31 offen sc1
v_mfma_f32_16x16x32_bf16 v[164:167], a[128:131], a[0:3], v[164:167]
s_add_u32 s31, s31, s32
ds_read_b64_tr_b16 a[136:137], v25 offset:0
v_accvgpr_read_b32 v83, a243
v_mfma_f32_16x16x32_bf16 v[164:167], a[132:135], a[4:7], v[164:167]
v_accvgpr_read_b32 v96, a244
v_accvgpr_read_b32 v97, a245
v_mfma_f32_16x16x32_bf16 v[172:175], a[128:131], a[8:11], v[172:175]
ds_read_b64_tr_b16 a[138:139], v25 offset:2048
v_accvgpr_read_b32 v98, a246
v_mfma_f32_16x16x32_bf16 v[172:175], a[132:135], a[12:15], v[172:175]
ds_read_b128 a[116:119], v3 offset:61440
v_accvgpr_read_b32 v99, a247
v_mfma_f32_16x16x32_bf16 v[180:183], a[128:131], a[16:19], v[180:183]
ds_read_b64_tr_b16 a[140:141], v25 offset:16384
v_cvt_pk_bf16_f32 v80, v80, v81
v_mfma_f32_16x16x32_bf16 v[180:183], a[132:135], a[20:23], v[180:183]
buffer_store_dwordx4 v[184:187], v1, s[4:7], s31 offen sc1
v_mfma_f32_16x16x32_bf16 v[188:191], a[128:131], a[24:27], v[188:191]
s_add_u32 s31, s31, s34
ds_read_b64_tr_b16 a[142:143], v25 offset:18432
v_add_u32 v25, 32768, v25
v_mfma_f32_16x16x32_bf16 v[188:191], a[132:135], a[28:31], v[188:191]
v_cvt_pk_bf16_f32 v81, v82, v83
v_cvt_pk_bf16_f32 v82, v96, v97
v_mfma_f32_16x16x32_bf16 v[196:199], a[128:131], a[32:35], v[196:199]
ds_read_b128 a[120:123], v2 offset:63488
v_cvt_pk_bf16_f32 v83, v98, v99
v_mfma_f32_16x16x32_bf16 v[196:199], a[132:135], a[36:39], v[196:199]
v_accvgpr_read_b32 v88, a248
v_accvgpr_read_b32 v89, a249
v_mfma_f32_16x16x32_bf16 v[204:207], a[128:131], a[40:43], v[204:207]
ds_read_b128 a[124:127], v3 offset:63488
v_accvgpr_read_b32 v90, a250
v_mfma_f32_16x16x32_bf16 v[204:207], a[132:135], a[44:47], v[204:207]
v_accvgpr_read_b32 v91, a251
v_accvgpr_read_b32 v96, a252
v_mfma_f32_16x16x32_bf16 v[212:215], a[128:131], a[48:51], v[212:215]
v_accvgpr_read_b32 v97, a253
v_accvgpr_read_b32 v98, a254
v_mfma_f32_16x16x32_bf16 v[212:215], a[132:135], a[52:55], v[212:215]
v_accvgpr_read_b32 v99, a255
v_cvt_pk_bf16_f32 v88, v88, v89
v_mfma_f32_16x16x32_bf16 v[220:223], a[128:131], a[56:59], v[220:223]
v_cvt_pk_bf16_f32 v89, v90, v91
v_cvt_pk_bf16_f32 v90, v96, v97
v_mfma_f32_16x16x32_bf16 v[220:223], a[132:135], a[60:63], v[220:223]
s_waitcnt vmcnt(23) lgkmcnt(0)
s_barrier
v_cvt_pk_bf16_f32 v91, v98, v99
v_mfma_f32_16x16x32_bf16 v[224:227], a[136:139], a[0:3], v[224:227]
s_add_u32 m0, s29, 98304
ds_read_b64_tr_b16 a[128:129], v22 offset:0
v_mfma_f32_16x16x32_bf16 v[224:227], a[140:143], a[4:7], v[224:227]
buffer_load_dwordx4 v16, s[12:15], s26 offen offset:0 lds
v_mfma_f32_16x16x32_bf16 v[228:231], a[136:139], a[8:11], v[228:231]
ds_read_b64_tr_b16 a[130:131], v22 offset:2048
v_mfma_f32_16x16x32_bf16 v[228:231], a[140:143], a[12:15], v[228:231]
buffer_store_dwordx4 v[192:195], v1, s[4:7], s31 offen sc1
v_mfma_f32_16x16x32_bf16 v[232:235], a[136:139], a[16:19], v[232:235]
s_add_u32 s31, s31, s32
ds_read_b64_tr_b16 a[132:133], v22 offset:16384
v_mfma_f32_16x16x32_bf16 v[232:235], a[140:143], a[20:23], v[232:235]
buffer_load_dwordx4 v17, s[12:15], s26 offen offset:1024 lds
v_mfma_f32_16x16x32_bf16 v[236:239], a[136:139], a[24:27], v[236:239]
ds_read_b64_tr_b16 a[134:135], v22 offset:18432
v_add_u32 v22, 4294901760, v22
v_mfma_f32_16x16x32_bf16 v[236:239], a[140:143], a[28:31], v[236:239]
v_mfma_f32_16x16x32_bf16 v[240:243], a[136:139], a[32:35], v[240:243]
v_mfma_f32_16x16x32_bf16 v[240:243], a[140:143], a[36:39], v[240:243]
buffer_load_dwordx4 v18, s[12:15], s26 offen offset:2048 lds
v_mfma_f32_16x16x32_bf16 v[244:247], a[136:139], a[40:43], v[244:247]
v_mfma_f32_16x16x32_bf16 v[244:247], a[140:143], a[44:47], v[244:247]
v_mfma_f32_16x16x32_bf16 v[248:251], a[136:139], a[48:51], v[248:251]
v_mfma_f32_16x16x32_bf16 v[248:251], a[140:143], a[52:55], v[248:251]
buffer_load_dwordx4 v19, s[12:15], s26 offen offset:3072 lds
v_mfma_f32_16x16x32_bf16 v[252:255], a[136:139], a[56:59], v[252:255]
s_add_u32 s26, s26, 524288
v_mfma_f32_16x16x32_bf16 v[252:255], a[140:143], a[60:63], v[252:255]
s_waitcnt lgkmcnt(0)
v_mfma_f32_16x16x32_bf16 v[36:39], a[128:131], a[64:67], v[36:39]
s_add_u32 m0, s29, 114688
ds_read_b64_tr_b16 a[136:137], v23 offset:0
v_mfma_f32_16x16x32_bf16 v[36:39], a[132:135], a[68:71], v[36:39]
buffer_load_dwordx4 v16, s[12:15], s27 offen offset:0 lds
v_mfma_f32_16x16x32_bf16 v[44:47], a[128:131], a[72:75], v[44:47]
ds_read_b64_tr_b16 a[138:139], v23 offset:2048
v_mfma_f32_16x16x32_bf16 v[44:47], a[132:135], a[76:79], v[44:47]
ds_read_b128 a[0:3], v2 offset:0
ds_read_b128 a[4:7], v3 offset:0
v_mfma_f32_16x16x32_bf16 v[52:55], a[128:131], a[80:83], v[52:55]
ds_read_b64_tr_b16 a[140:141], v23 offset:16384
v_mfma_f32_16x16x32_bf16 v[52:55], a[132:135], a[84:87], v[52:55]
buffer_load_dwordx4 v17, s[12:15], s27 offen offset:1024 lds
v_mfma_f32_16x16x32_bf16 v[60:63], a[128:131], a[88:91], v[60:63]
ds_read_b64_tr_b16 a[142:143], v23 offset:18432
v_add_u32 v23, 4294901760, v23
v_mfma_f32_16x16x32_bf16 v[60:63], a[132:135], a[92:95], v[60:63]
buffer_store_dwordx4 v[200:203], v1, s[4:7], s31 offen sc1
v_mfma_f32_16x16x32_bf16 v[68:71], a[128:131], a[96:99], v[68:71]
s_add_u32 s31, s31, s33
ds_read_b128 a[8:11], v2 offset:2048
v_mfma_f32_16x16x32_bf16 v[68:71], a[132:135], a[100:103], v[68:71]
buffer_load_dwordx4 v18, s[12:15], s27 offen offset:2048 lds
v_mfma_f32_16x16x32_bf16 v[76:79], a[128:131], a[104:107], v[76:79]
ds_read_b128 a[12:15], v3 offset:2048
v_mfma_f32_16x16x32_bf16 v[76:79], a[132:135], a[108:111], v[76:79]
ds_read_b128 a[16:19], v2 offset:4096
v_mfma_f32_16x16x32_bf16 v[84:87], a[128:131], a[112:115], v[84:87]
ds_read_b128 a[20:23], v3 offset:4096
v_mfma_f32_16x16x32_bf16 v[84:87], a[132:135], a[116:119], v[84:87]
buffer_load_dwordx4 v19, s[12:15], s27 offen offset:3072 lds
v_mfma_f32_16x16x32_bf16 v[92:95], a[128:131], a[120:123], v[92:95]
s_add_u32 s27, s27, 524288
ds_read_b128 a[24:27], v2 offset:6144
v_mfma_f32_16x16x32_bf16 v[92:95], a[132:135], a[124:127], v[92:95]
s_waitcnt lgkmcnt(5)
buffer_store_dwordx4 v[208:211], v1, s[4:7], s31 offen sc1
v_mfma_f32_16x16x32_bf16 v[100:103], a[136:139], a[64:67], v[100:103]
s_add_u32 s31, s31, s32
ds_read_b64_tr_b16 a[128:129], v24 offset:0
v_mfma_f32_16x16x32_bf16 v[100:103], a[140:143], a[68:71], v[100:103]
v_mfma_f32_16x16x32_bf16 v[108:111], a[136:139], a[72:75], v[108:111]
ds_read_b64_tr_b16 a[130:131], v24 offset:2048
v_mfma_f32_16x16x32_bf16 v[108:111], a[140:143], a[76:79], v[108:111]
ds_read_b128 a[28:31], v3 offset:6144
v_mfma_f32_16x16x32_bf16 v[116:119], a[136:139], a[80:83], v[116:119]
ds_read_b64_tr_b16 a[132:133], v24 offset:16384
v_mfma_f32_16x16x32_bf16 v[116:119], a[140:143], a[84:87], v[116:119]
v_mfma_f32_16x16x32_bf16 v[124:127], a[136:139], a[88:91], v[124:127]
ds_read_b64_tr_b16 a[134:135], v24 offset:18432
v_add_u32 v24, 4294901760, v24
v_mfma_f32_16x16x32_bf16 v[124:127], a[140:143], a[92:95], v[124:127]
v_mfma_f32_16x16x32_bf16 v[132:135], a[136:139], a[96:99], v[132:135]
ds_read_b128 a[32:35], v2 offset:8192
v_mfma_f32_16x16x32_bf16 v[132:135], a[140:143], a[100:103], v[132:135]
buffer_store_dwordx4 v[216:219], v1, s[4:7], s31 offen sc1
v_mfma_f32_16x16x32_bf16 v[140:143], a[136:139], a[104:107], v[140:143]
s_add_u32 s31, s31, s35
ds_read_b128 a[36:39], v3 offset:8192
v_mfma_f32_16x16x32_bf16 v[140:143], a[140:143], a[108:111], v[140:143]
ds_read_b128 a[40:43], v2 offset:10240
v_mfma_f32_16x16x32_bf16 v[148:151], a[136:139], a[112:115], v[148:151]
ds_read_b128 a[44:47], v3 offset:10240
v_mfma_f32_16x16x32_bf16 v[148:151], a[140:143], a[116:119], v[148:151]
v_mfma_f32_16x16x32_bf16 v[156:159], a[136:139], a[120:123], v[156:159]
ds_read_b128 a[48:51], v2 offset:12288
v_mfma_f32_16x16x32_bf16 v[156:159], a[140:143], a[124:127], v[156:159]
s_waitcnt lgkmcnt(5)
v_mfma_f32_16x16x32_bf16 v[164:167], a[128:131], a[64:67], v[164:167]
ds_read_b64_tr_b16 a[136:137], v25 offset:0
v_mfma_f32_16x16x32_bf16 v[164:167], a[132:135], a[68:71], v[164:167]
v_mfma_f32_16x16x32_bf16 v[172:175], a[128:131], a[72:75], v[172:175]
ds_read_b64_tr_b16 a[138:139], v25 offset:2048
v_mfma_f32_16x16x32_bf16 v[172:175], a[132:135], a[76:79], v[172:175]
ds_read_b128 a[52:55], v3 offset:12288
v_mfma_f32_16x16x32_bf16 v[180:183], a[128:131], a[80:83], v[180:183]
ds_read_b64_tr_b16 a[140:141], v25 offset:16384
v_mfma_f32_16x16x32_bf16 v[180:183], a[132:135], a[84:87], v[180:183]
buffer_store_dwordx4 v[32:35], v1, s[4:7], s31 offen sc1
v_mfma_f32_16x16x32_bf16 v[188:191], a[128:131], a[88:91], v[188:191]
s_add_u32 s31, s31, s32
ds_read_b64_tr_b16 a[142:143], v25 offset:18432
v_add_u32 v25, 4294901760, v25
v_mfma_f32_16x16x32_bf16 v[188:191], a[132:135], a[92:95], v[188:191]
v_mfma_f32_16x16x32_bf16 v[196:199], a[128:131], a[96:99], v[196:199]
ds_read_b128 a[56:59], v2 offset:14336
v_mfma_f32_16x16x32_bf16 v[196:199], a[132:135], a[100:103], v[196:199]
v_mfma_f32_16x16x32_bf16 v[204:207], a[128:131], a[104:107], v[204:207]
ds_read_b128 a[60:63], v3 offset:14336
v_mfma_f32_16x16x32_bf16 v[204:207], a[132:135], a[108:111], v[204:207]
v_mfma_f32_16x16x32_bf16 v[212:215], a[128:131], a[112:115], v[212:215]
v_mfma_f32_16x16x32_bf16 v[212:215], a[132:135], a[116:119], v[212:215]
v_mfma_f32_16x16x32_bf16 v[220:223], a[128:131], a[120:123], v[220:223]
v_mfma_f32_16x16x32_bf16 v[220:223], a[132:135], a[124:127], v[220:223]
s_waitcnt vmcnt(20) lgkmcnt(0)
s_barrier
v_mfma_f32_16x16x32_bf16 v[224:227], a[136:139], a[64:67], v[224:227]
s_add_u32 m0, s29, 131072
ds_read_b64_tr_b16 a[128:129], v22 offset:0
v_mfma_f32_16x16x32_bf16 v[224:227], a[140:143], a[68:71], v[224:227]
buffer_load_dwordx4 v16, s[12:15], s26 offen offset:0 lds
v_mfma_f32_16x16x32_bf16 v[228:231], a[136:139], a[72:75], v[228:231]
ds_read_b64_tr_b16 a[130:131], v22 offset:2048
v_mfma_f32_16x16x32_bf16 v[228:231], a[140:143], a[76:79], v[228:231]
buffer_store_dwordx4 v[40:43], v1, s[4:7], s31 offen sc1
v_mfma_f32_16x16x32_bf16 v[232:235], a[136:139], a[80:83], v[232:235]
s_add_u32 s31, s31, s33
ds_read_b64_tr_b16 a[132:133], v22 offset:16384
v_mfma_f32_16x16x32_bf16 v[232:235], a[140:143], a[84:87], v[232:235]
buffer_load_dwordx4 v17, s[12:15], s26 offen offset:1024 lds
v_mfma_f32_16x16x32_bf16 v[236:239], a[136:139], a[88:91], v[236:239]
ds_read_b64_tr_b16 a[134:135], v22 offset:18432
v_add_u32 v22, 32768, v22
v_mfma_f32_16x16x32_bf16 v[236:239], a[140:143], a[92:95], v[236:239]
v_mfma_f32_16x16x32_bf16 v[240:243], a[136:139], a[96:99], v[240:243]
v_mfma_f32_16x16x32_bf16 v[240:243], a[140:143], a[100:103], v[240:243]
buffer_load_dwordx4 v18, s[12:15], s26 offen offset:2048 lds
v_mfma_f32_16x16x32_bf16 v[244:247], a[136:139], a[104:107], v[244:247]
v_mfma_f32_16x16x32_bf16 v[244:247], a[140:143], a[108:111], v[244:247]
v_mfma_f32_16x16x32_bf16 v[248:251], a[136:139], a[112:115], v[248:251]
v_mfma_f32_16x16x32_bf16 v[248:251], a[140:143], a[116:119], v[248:251]
buffer_load_dwordx4 v19, s[12:15], s26 offen offset:3072 lds
v_mfma_f32_16x16x32_bf16 v[252:255], a[136:139], a[120:123], v[252:255]
s_add_u32 s26, s26, 524288
v_mfma_f32_16x16x32_bf16 v[252:255], a[140:143], a[124:127], v[252:255]
s_waitcnt lgkmcnt(0)
v_mfma_f32_16x16x32_bf16 v[36:39], a[128:131], a[0:3], v[36:39]
s_add_u32 m0, s29, 147456
ds_read_b64_tr_b16 a[136:137], v23 offset:0
v_mfma_f32_16x16x32_bf16 v[36:39], a[132:135], a[4:7], v[36:39]
buffer_load_dwordx4 v16, s[12:15], s27 offen offset:0 lds
v_mfma_f32_16x16x32_bf16 v[44:47], a[128:131], a[8:11], v[44:47]
s_lshl_b32 s22, s20, 7
ds_read_b64_tr_b16 a[138:139], v23 offset:2048
v_bfe_u32 v20, v1, 4, 3
v_mfma_f32_16x16x32_bf16 v[44:47], a[132:135], a[12:15], v[44:47]
s_add_u32 s70, s22, 94371840
ds_read_b128 a[64:67], v2 offset:16384
ds_read_b128 a[68:71], v3 offset:16384
v_mfma_f32_16x16x32_bf16 v[52:55], a[128:131], a[16:19], v[52:55]
s_lshr_b32 s22, s2, 4
ds_read_b64_tr_b16 a[140:141], v23 offset:16384
v_lshlrev_b32 v20, 3, v20
v_mfma_f32_16x16x32_bf16 v[52:55], a[132:135], a[20:23], v[52:55]
s_lshl_b32 s22, s22, 2
buffer_load_dwordx4 v17, s[12:15], s27 offen offset:1024 lds
v_mfma_f32_16x16x32_bf16 v[60:63], a[128:131], a[24:27], v[60:63]
s_add_u32 s66, s70, s22
ds_read_b64_tr_b16 a[142:143], v23 offset:18432
v_add_u32 v23, 32768, v23
v_mfma_f32_16x16x32_bf16 v[60:63], a[132:135], a[28:31], v[60:63]
s_and_b32 s22, s2, 16
buffer_store_dwordx4 v[48:51], v1, s[4:7], s31 offen sc1
v_mfma_f32_16x16x32_bf16 v[68:71], a[128:131], a[32:35], v[68:71]
s_add_u32 s31, s31, s32
ds_read_b128 a[72:75], v2 offset:18432
v_add_u32 v15, 2052, v20
v_mfma_f32_16x16x32_bf16 v[68:71], a[132:135], a[36:39], v[68:71]
s_lshl_b32 s22, s22, 7
buffer_load_dwordx4 v18, s[12:15], s27 offen offset:2048 lds
v_mfma_f32_16x16x32_bf16 v[76:79], a[128:131], a[40:43], v[76:79]
s_add_u32 s66, s66, s22
ds_read_b128 a[76:79], v3 offset:18432
v_mfma_f32_16x16x32_bf16 v[76:79], a[132:135], a[44:47], v[76:79]
s_lshl_b32 s67, s20, 20
ds_read_b128 a[80:83], v2 offset:20480
v_mfma_f32_16x16x32_bf16 v[84:87], a[128:131], a[48:51], v[84:87]
s_lshl_b32 s22, s37, 16
ds_read_b128 a[84:87], v3 offset:20480
v_mfma_f32_16x16x32_bf16 v[84:87], a[132:135], a[52:55], v[84:87]
s_add_u32 s67, s67, s22
buffer_load_dwordx4 v19, s[12:15], s27 offen offset:3072 lds
v_mfma_f32_16x16x32_bf16 v[92:95], a[128:131], a[56:59], v[92:95]
s_waitcnt lgkmcnt(5)
s_add_u32 s27, s27, 524288
ds_read_b128 a[88:91], v2 offset:22528
v_mfma_f32_16x16x32_bf16 v[92:95], a[132:135], a[60:63], v[92:95]
s_lshl_b32 s22, s3, 11
buffer_store_dwordx4 v[56:59], v1, s[4:7], s31 offen sc1
v_mfma_f32_16x16x32_bf16 v[100:103], a[136:139], a[0:3], v[100:103]
s_waitcnt lgkmcnt(5)
s_add_u32 s31, s31, s34
ds_read_b64_tr_b16 a[128:129], v24 offset:0
v_mfma_f32_16x16x32_bf16 v[100:103], a[140:143], a[4:7], v[100:103]
s_add_u32 s67, s67, s22
v_mfma_f32_16x16x32_bf16 v[108:111], a[136:139], a[8:11], v[108:111]
s_add_u32 s67, s67, 33554432
ds_read_b64_tr_b16 a[130:131], v24 offset:2048
v_mfma_f32_16x16x32_bf16 v[108:111], a[140:143], a[12:15], v[108:111]
s_mov_b32 s68, 1035512379
ds_read_b128 a[92:95], v3 offset:22528
v_mfma_f32_16x16x32_bf16 v[116:119], a[136:139], a[16:19], v[116:119]
s_mov_b32 s69, 1035512379
ds_read_b64_tr_b16 a[132:133], v24 offset:16384
v_mfma_f32_16x16x32_bf16 v[116:119], a[140:143], a[20:23], v[116:119]
buffer_store_dwordx4 v[64:67], v1, s[4:7], s31 offen sc1
v_mfma_f32_16x16x32_bf16 v[124:127], a[136:139], a[24:27], v[124:127]
s_add_u32 s31, s31, s32
ds_read_b64_tr_b16 a[134:135], v24 offset:18432
v_add_u32 v24, 32768, v24
v_mfma_f32_16x16x32_bf16 v[124:127], a[140:143], a[28:31], v[124:127]
v_mfma_f32_16x16x32_bf16 v[132:135], a[136:139], a[32:35], v[132:135]
ds_read_b128 a[96:99], v2 offset:24576
v_mfma_f32_16x16x32_bf16 v[132:135], a[140:143], a[36:39], v[132:135]
v_mfma_f32_16x16x32_bf16 v[140:143], a[136:139], a[40:43], v[140:143]
ds_read_b128 a[100:103], v3 offset:24576
v_mfma_f32_16x16x32_bf16 v[140:143], a[140:143], a[44:47], v[140:143]
ds_read_b128 a[104:107], v2 offset:26624
v_mfma_f32_16x16x32_bf16 v[148:151], a[136:139], a[48:51], v[148:151]
ds_read_b128 a[108:111], v3 offset:26624
v_mfma_f32_16x16x32_bf16 v[148:151], a[140:143], a[52:55], v[148:151]
v_mfma_f32_16x16x32_bf16 v[156:159], a[136:139], a[56:59], v[156:159]
ds_read_b128 a[112:115], v2 offset:28672
v_mfma_f32_16x16x32_bf16 v[156:159], a[140:143], a[60:63], v[156:159]
s_waitcnt lgkmcnt(5)
buffer_store_dwordx4 v[72:75], v1, s[4:7], s31 offen sc1
v_mfma_f32_16x16x32_bf16 v[164:167], a[128:131], a[0:3], v[164:167]
s_add_u32 s31, s31, s33
ds_read_b64_tr_b16 a[136:137], v25 offset:0
v_mfma_f32_16x16x32_bf16 v[164:167], a[132:135], a[4:7], v[164:167]
v_mfma_f32_16x16x32_bf16 v[172:175], a[128:131], a[8:11], v[172:175]
ds_read_b64_tr_b16 a[138:139], v25 offset:2048
v_mfma_f32_16x16x32_bf16 v[172:175], a[132:135], a[12:15], v[172:175]
ds_read_b128 a[116:119], v3 offset:28672
v_mfma_f32_16x16x32_bf16 v[180:183], a[128:131], a[16:19], v[180:183]
ds_read_b64_tr_b16 a[140:141], v25 offset:16384
v_mfma_f32_16x16x32_bf16 v[180:183], a[132:135], a[20:23], v[180:183]
v_mfma_f32_16x16x32_bf16 v[188:191], a[128:131], a[24:27], v[188:191]
ds_read_b64_tr_b16 a[142:143], v25 offset:18432
v_add_u32 v25, 32768, v25
v_mfma_f32_16x16x32_bf16 v[188:191], a[132:135], a[28:31], v[188:191]
v_mfma_f32_16x16x32_bf16 v[196:199], a[128:131], a[32:35], v[196:199]
ds_read_b128 a[120:123], v2 offset:30720
v_mfma_f32_16x16x32_bf16 v[196:199], a[132:135], a[36:39], v[196:199]
buffer_store_dwordx4 v[80:83], v1, s[4:7], s31 offen sc1
v_mfma_f32_16x16x32_bf16 v[204:207], a[128:131], a[40:43], v[204:207]
s_add_u32 s31, s31, s32
ds_read_b128 a[124:127], v3 offset:30720
v_mfma_f32_16x16x32_bf16 v[204:207], a[132:135], a[44:47], v[204:207]
v_mfma_f32_16x16x32_bf16 v[212:215], a[128:131], a[48:51], v[212:215]
v_mfma_f32_16x16x32_bf16 v[212:215], a[132:135], a[52:55], v[212:215]
v_mfma_f32_16x16x32_bf16 v[220:223], a[128:131], a[56:59], v[220:223]
v_mfma_f32_16x16x32_bf16 v[220:223], a[132:135], a[60:63], v[220:223]
s_waitcnt vmcnt(17) lgkmcnt(0)
s_barrier
v_mfma_f32_16x16x32_bf16 v[224:227], a[136:139], a[0:3], v[224:227]
ds_read_b64_tr_b16 a[128:129], v22 offset:0
v_mfma_f32_16x16x32_bf16 v[224:227], a[140:143], a[4:7], v[224:227]
v_mfma_f32_16x16x32_bf16 v[228:231], a[136:139], a[8:11], v[228:231]
ds_read_b64_tr_b16 a[130:131], v22 offset:2048
v_mfma_f32_16x16x32_bf16 v[228:231], a[140:143], a[12:15], v[228:231]
buffer_store_dwordx4 v[88:91], v1, s[4:7], s31 offen sc1
v_mfma_f32_16x16x32_bf16 v[232:235], a[136:139], a[16:19], v[232:235]
ds_read_b64_tr_b16 a[132:133], v22 offset:16384
v_mfma_f32_16x16x32_bf16 v[232:235], a[140:143], a[20:23], v[232:235]
v_mfma_f32_16x16x32_bf16 v[236:239], a[136:139], a[24:27], v[236:239]
ds_read_b64_tr_b16 a[134:135], v22 offset:18432
v_add_u32 v22, 32768, v22
v_mfma_f32_16x16x32_bf16 v[236:239], a[140:143], a[28:31], v[236:239]
v_mfma_f32_16x16x32_bf16 v[240:243], a[136:139], a[32:35], v[240:243]
v_mfma_f32_16x16x32_bf16 v[240:243], a[140:143], a[36:39], v[240:243]
v_mfma_f32_16x16x32_bf16 v[244:247], a[136:139], a[40:43], v[244:247]
v_mfma_f32_16x16x32_bf16 v[244:247], a[140:143], a[44:47], v[244:247]
v_mfma_f32_16x16x32_bf16 v[248:251], a[136:139], a[48:51], v[248:251]
v_mfma_f32_16x16x32_bf16 v[248:251], a[140:143], a[52:55], v[248:251]
v_mfma_f32_16x16x32_bf16 v[252:255], a[136:139], a[56:59], v[252:255]
v_mfma_f32_16x16x32_bf16 v[252:255], a[140:143], a[60:63], v[252:255]
s_waitcnt lgkmcnt(0)
v_mfma_f32_16x16x32_bf16 v[36:39], a[128:131], a[64:67], v[36:39]
ds_read_b64_tr_b16 a[136:137], v23 offset:0
v_and_b32 v14, 128, v1
v_mfma_f32_16x16x32_bf16 v[36:39], a[132:135], a[68:71], v[36:39]
v_mul_u32_u24 v14, 2, v14
v_add_u32 v20, v14, v20
v_mfma_f32_16x16x32_bf16 v[44:47], a[128:131], a[72:75], v[44:47]
s_mul_i32 s85, s20, 7
ds_read_b64_tr_b16 a[138:139], v23 offset:2048
v_add_u32 v15, v14, v15
v_mfma_f32_16x16x32_bf16 v[44:47], a[132:135], a[76:79], v[44:47]
s_add_u32 s85, s85, s21
ds_read_b128 a[0:3], v2 offset:32768
ds_read_b128 a[4:7], v3 offset:32768
v_mfma_f32_16x16x32_bf16 v[52:55], a[128:131], a[80:83], v[52:55]
s_lshl_b32 s85, s85, 2
ds_read_b64_tr_b16 a[140:141], v23 offset:16384
v_mfma_f32_16x16x32_bf16 v[52:55], a[132:135], a[84:87], v[52:55]
s_add_u32 s85, s85, s3
v_mfma_f32_16x16x32_bf16 v[60:63], a[128:131], a[88:91], v[60:63]
s_mul_i32 s82, s85, 4224
ds_read_b64_tr_b16 a[142:143], v23 offset:18432
v_add_u32 v23, 32768, v23
v_mfma_f32_16x16x32_bf16 v[60:63], a[132:135], a[92:95], v[60:63]
s_add_u32 s82, s82, 83886208
v_mfma_f32_16x16x32_bf16 v[68:71], a[128:131], a[96:99], v[68:71]
s_lshl_b32 s83, s85, 12
ds_read_b128 a[8:11], v2 offset:34816
v_mfma_f32_16x16x32_bf16 v[68:71], a[132:135], a[100:103], v[68:71]
s_mul_i32 s84, s3, 21248
v_mfma_f32_16x16x32_bf16 v[76:79], a[128:131], a[104:107], v[76:79]
s_add_u32 s84, s84, 46080
ds_read_b128 a[12:15], v3 offset:34816
v_mfma_f32_16x16x32_bf16 v[76:79], a[132:135], a[108:111], v[76:79]
s_mov_b64 s[60:61], s[72:73]
ds_read_b128 a[16:19], v2 offset:36864
v_mfma_f32_16x16x32_bf16 v[84:87], a[128:131], a[112:115], v[84:87]
s_mov_b32 s62, 1835008
ds_read_b128 a[20:23], v3 offset:36864
v_mfma_f32_16x16x32_bf16 v[84:87], a[132:135], a[116:119], v[84:87]
v_mfma_f32_16x16x32_bf16 v[92:95], a[128:131], a[120:123], v[92:95]
ds_read_b128 a[24:27], v2 offset:38912
v_mfma_f32_16x16x32_bf16 v[92:95], a[132:135], a[124:127], v[92:95]
s_waitcnt lgkmcnt(5)
v_mfma_f32_16x16x32_bf16 v[100:103], a[136:139], a[64:67], v[100:103]
ds_read_b64_tr_b16 a[128:129], v24 offset:0
v_mfma_f32_16x16x32_bf16 v[100:103], a[140:143], a[68:71], v[100:103]
v_mfma_f32_16x16x32_bf16 v[108:111], a[136:139], a[72:75], v[108:111]
ds_read_b64_tr_b16 a[130:131], v24 offset:2048
v_mfma_f32_16x16x32_bf16 v[108:111], a[140:143], a[76:79], v[108:111]
ds_read_b128 a[28:31], v3 offset:38912
v_mfma_f32_16x16x32_bf16 v[116:119], a[136:139], a[80:83], v[116:119]
ds_read_b64_tr_b16 a[132:133], v24 offset:16384
v_mfma_f32_16x16x32_bf16 v[116:119], a[140:143], a[84:87], v[116:119]
v_mfma_f32_16x16x32_bf16 v[124:127], a[136:139], a[88:91], v[124:127]
ds_read_b64_tr_b16 a[134:135], v24 offset:18432
v_add_u32 v24, 32768, v24
v_mfma_f32_16x16x32_bf16 v[124:127], a[140:143], a[92:95], v[124:127]
v_mfma_f32_16x16x32_bf16 v[132:135], a[136:139], a[96:99], v[132:135]
ds_read_b128 a[32:35], v2 offset:40960
v_mfma_f32_16x16x32_bf16 v[132:135], a[140:143], a[100:103], v[132:135]
v_mfma_f32_16x16x32_bf16 v[140:143], a[136:139], a[104:107], v[140:143]
ds_read_b128 a[36:39], v3 offset:40960
v_mfma_f32_16x16x32_bf16 v[140:143], a[140:143], a[108:111], v[140:143]
ds_read_b128 a[40:43], v2 offset:43008
v_mfma_f32_16x16x32_bf16 v[148:151], a[136:139], a[112:115], v[148:151]
ds_read_b128 a[44:47], v3 offset:43008
v_mfma_f32_16x16x32_bf16 v[148:151], a[140:143], a[116:119], v[148:151]
v_mfma_f32_16x16x32_bf16 v[156:159], a[136:139], a[120:123], v[156:159]
s_andn2_b32 s31, s70, 256
ds_read_b128 a[48:51], v2 offset:45056
v_mfma_f32_16x16x32_bf16 v[156:159], a[140:143], a[124:127], v[156:159]
s_waitcnt lgkmcnt(5)
v_mfma_f32_16x16x32_bf16 v[164:167], a[128:131], a[64:67], v[164:167]
ds_read_b64_tr_b16 a[136:137], v25 offset:0
v_mfma_f32_16x16x32_bf16 v[164:167], a[132:135], a[68:71], v[164:167]
PAD_29:
s_cbranch_execz M_tret
v_mfma_f32_16x16x32_bf16 v[172:175], a[128:131], a[72:75], v[172:175]
ds_read_b64_tr_b16 a[138:139], v25 offset:2048
v_mfma_f32_16x16x32_bf16 v[172:175], a[132:135], a[76:79], v[172:175]
ds_read_b128 a[52:55], v3 offset:45056
v_mfma_f32_16x16x32_bf16 v[180:183], a[128:131], a[80:83], v[180:183]
ds_read_b64_tr_b16 a[140:141], v25 offset:16384
v_mfma_f32_16x16x32_bf16 v[180:183], a[132:135], a[84:87], v[180:183]
v_mfma_f32_16x16x32_bf16 v[188:191], a[128:131], a[88:91], v[188:191]
ds_read_b64_tr_b16 a[142:143], v25 offset:18432
v_add_u32 v25, 32768, v25
v_mfma_f32_16x16x32_bf16 v[188:191], a[132:135], a[92:95], v[188:191]
v_mfma_f32_16x16x32_bf16 v[196:199], a[128:131], a[96:99], v[196:199]
ds_read_b128 a[56:59], v2 offset:47104
v_mfma_f32_16x16x32_bf16 v[196:199], a[132:135], a[100:103], v[196:199]
v_mfma_f32_16x16x32_bf16 v[204:207], a[128:131], a[104:107], v[204:207]
ds_read_b128 a[60:63], v3 offset:47104
v_mfma_f32_16x16x32_bf16 v[204:207], a[132:135], a[108:111], v[204:207]
v_mfma_f32_16x16x32_bf16 v[212:215], a[128:131], a[112:115], v[212:215]
v_mfma_f32_16x16x32_bf16 v[212:215], a[132:135], a[116:119], v[212:215]
v_mfma_f32_16x16x32_bf16 v[220:223], a[128:131], a[120:123], v[220:223]
v_mfma_f32_16x16x32_bf16 v[220:223], a[132:135], a[124:127], v[220:223]
s_waitcnt vmcnt(0) lgkmcnt(0)
s_barrier
v_mfma_f32_16x16x32_bf16 v[224:227], a[136:139], a[64:67], v[224:227]
ds_read_b64_tr_b16 a[128:129], v22 offset:0
v_mfma_f32_16x16x32_bf16 v[224:227], a[140:143], a[68:71], v[224:227]
buffer_store_dword v27, v26, s[4:7], s66 offen sc1
v_mfma_f32_16x16x32_bf16 v[228:231], a[136:139], a[72:75], v[228:231]
ds_read_b64_tr_b16 a[130:131], v22 offset:2048
v_mfma_f32_16x16x32_bf16 v[228:231], a[140:143], a[76:79], v[228:231]
v_mfma_f32_16x16x32_bf16 v[232:235], a[136:139], a[80:83], v[232:235]
ds_read_b64_tr_b16 a[132:133], v22 offset:16384
v_mfma_f32_16x16x32_bf16 v[232:235], a[140:143], a[84:87], v[232:235]
v_mfma_f32_16x16x32_bf16 v[236:239], a[136:139], a[88:91], v[236:239]
ds_read_b64_tr_b16 a[134:135], v22 offset:18432
v_mfma_f32_16x16x32_bf16 v[236:239], a[140:143], a[92:95], v[236:239]
v_mfma_f32_16x16x32_bf16 v[240:243], a[136:139], a[96:99], v[240:243]
v_mfma_f32_16x16x32_bf16 v[240:243], a[140:143], a[100:103], v[240:243]
v_mfma_f32_16x16x32_bf16 v[244:247], a[136:139], a[104:107], v[244:247]
v_mfma_f32_16x16x32_bf16 v[244:247], a[140:143], a[108:111], v[244:247]
v_mfma_f32_16x16x32_bf16 v[248:251], a[136:139], a[112:115], v[248:251]
v_mfma_f32_16x16x32_bf16 v[248:251], a[140:143], a[116:119], v[248:251]
v_mfma_f32_16x16x32_bf16 v[252:255], a[136:139], a[120:123], v[252:255]
v_mfma_f32_16x16x32_bf16 v[252:255], a[140:143], a[124:127], v[252:255]
s_waitcnt lgkmcnt(0)
v_mfma_f32_16x16x32_bf16 v[36:39], a[128:131], a[0:3], v[36:39]
s_add_u32 m0, s84, 17152
ds_read_b64_tr_b16 a[136:137], v23 offset:0
v_lshrrev_b32 v9, 4, v1
v_mfma_f32_16x16x32_bf16 v[36:39], a[132:135], a[4:7], v[36:39]
buffer_load_dwordx4 v1, s[60:63], s83 offen offset:0 lds
v_mfma_f32_16x16x32_bf16 v[44:47], a[128:131], a[8:11], v[44:47]
ds_read_b64_tr_b16 a[138:139], v23 offset:2048
v_and_b32 v10, 15, v9
v_mfma_f32_16x16x32_bf16 v[44:47], a[132:135], a[12:15], v[44:47]
buffer_load_dwordx4 v1, s[60:63], s83 offen offset:1024 lds
v_mfma_f32_16x16x32_bf16 v[52:55], a[128:131], a[16:19], v[52:55]
ds_read_b64_tr_b16 a[140:141], v23 offset:16384
v_lshrrev_b32 v11, 4, v9
v_mfma_f32_16x16x32_bf16 v[52:55], a[132:135], a[20:23], v[52:55]
buffer_load_dwordx4 v1, s[60:63], s83 offen offset:2048 lds
v_mfma_f32_16x16x32_bf16 v[60:63], a[128:131], a[24:27], v[60:63]
ds_read_b64_tr_b16 a[142:143], v23 offset:18432
v_lshrrev_b32 v12, 2, v10
v_mfma_f32_16x16x32_bf16 v[60:63], a[132:135], a[28:31], v[60:63]
buffer_load_dwordx4 v1, s[60:63], s83 offen offset:3072 lds
v_mfma_f32_16x16x32_bf16 v[68:71], a[128:131], a[32:35], v[68:71]
s_add_u32 m0, s84, 64
v_mul_u32_u24 v12, 4160, v12
v_and_b32 v13, 3, v9
v_mfma_f32_16x16x32_bf16 v[68:71], a[132:135], a[36:39], v[68:71]
buffer_load_dwordx4 v1, s[4:7], s82 offen offset:0 sc1 lds
v_mfma_f32_16x16x32_bf16 v[76:79], a[128:131], a[40:43], v[76:79]
buffer_load_dwordx4 v1, s[4:7], s82 offen offset:1024 sc1 lds
v_mfma_f32_16x16x32_bf16 v[76:79], a[132:135], a[44:47], v[76:79]
buffer_load_dwordx4 v1, s[4:7], s82 offen offset:2048 sc1 lds
v_mfma_f32_16x16x32_bf16 v[84:87], a[128:131], a[48:51], v[84:87]
buffer_load_dwordx4 v1, s[4:7], s82 offen offset:3072 sc1 lds
v_mfma_f32_16x16x32_bf16 v[84:87], a[132:135], a[52:55], v[84:87]
s_add_u32 s82, s82, 2097152
v_lshl_add_u32 v12, v13, 3, v12
v_lshlrev_b32 v13, 4, v11
v_mfma_f32_16x16x32_bf16 v[92:95], a[128:131], a[56:59], v[92:95]
s_add_u32 m0, s84, 4224
v_sub_u32 v12, v12, v13
v_add_u32 v12, 88, v12
v_mfma_f32_16x16x32_bf16 v[92:95], a[132:135], a[60:63], v[92:95]
s_waitcnt lgkmcnt(0)
buffer_load_dwordx4 v1, s[4:7], s82 offen offset:0 sc1 lds
v_mfma_f32_16x16x32_bf16 v[100:103], a[136:139], a[0:3], v[100:103]
ds_read_b64_tr_b16 a[128:129], v24 offset:0
v_add_u32 v16, s84, v12
v_mfma_f32_16x16x32_bf16 v[100:103], a[140:143], a[4:7], v[100:103]
buffer_load_dwordx4 v1, s[4:7], s82 offen offset:1024 sc1 lds
v_mfma_f32_16x16x32_bf16 v[108:111], a[136:139], a[8:11], v[108:111]
ds_read_b64_tr_b16 a[130:131], v24 offset:2048
v_lshl_add_u32 v12, v10, 5, v13
v_mfma_f32_16x16x32_bf16 v[108:111], a[140:143], a[12:15], v[108:111]
buffer_load_dwordx4 v1, s[4:7], s82 offen offset:2048 sc1 lds
v_mfma_f32_16x16x32_bf16 v[116:119], a[136:139], a[16:19], v[116:119]
ds_read_b64_tr_b16 a[132:133], v24 offset:16384
v_add_u32 v12, 16672, v12
v_mfma_f32_16x16x32_bf16 v[116:119], a[140:143], a[20:23], v[116:119]
buffer_load_dwordx4 v1, s[4:7], s82 offen offset:3072 sc1 lds
v_mfma_f32_16x16x32_bf16 v[124:127], a[136:139], a[24:27], v[124:127]
s_add_u32 s82, s82, 4292870140
ds_read_b64_tr_b16 a[134:135], v24 offset:18432
v_add_u32 v17, s84, v12
v_mfma_f32_16x16x32_bf16 v[124:127], a[140:143], a[28:31], v[124:127]
s_add_u32 m0, s84, 8384
v_lshlrev_b32 v12, 5, v10
v_lshl_add_u32 v8, v11, 3, v12
v_mfma_f32_16x16x32_bf16 v[132:135], a[136:139], a[32:35], v[132:135]
buffer_load_dwordx4 v1, s[4:7], s82 offen offset:0 sc1 lds
v_mfma_f32_16x16x32_bf16 v[132:135], a[140:143], a[36:39], v[132:135]
buffer_load_dwordx4 v1, s[4:7], s82 offen offset:1024 sc1 lds
v_mfma_f32_16x16x32_bf16 v[140:143], a[136:139], a[40:43], v[140:143]
buffer_load_dwordx4 v1, s[4:7], s82 offen offset:2048 sc1 lds
v_mfma_f32_16x16x32_bf16 v[140:143], a[140:143], a[44:47], v[140:143]
buffer_load_dwordx4 v1, s[4:7], s82 offen offset:3072 sc1 lds
v_mfma_f32_16x16x32_bf16 v[148:151], a[136:139], a[48:51], v[148:151]
s_add_u32 s82, s82, 2097152
v_add3_u32 v18, s84, 64, v8
v_mov_b32 v19, 0
v_mfma_f32_16x16x32_bf16 v[148:151], a[140:143], a[52:55], v[148:151]
s_add_u32 m0, s84, 12544
v_mov_b32 v12, 0
v_mov_b32 v13, 0
v_mfma_f32_16x16x32_bf16 v[156:159], a[136:139], a[56:59], v[156:159]
buffer_load_dwordx4 v1, s[4:7], s82 offen offset:0 sc1 lds
v_mfma_f32_16x16x32_bf16 v[156:159], a[140:143], a[60:63], v[156:159]
s_waitcnt lgkmcnt(0)
buffer_load_dwordx4 v1, s[4:7], s82 offen offset:1024 sc1 lds
v_mfma_f32_16x16x32_bf16 v[164:167], a[128:131], a[0:3], v[164:167]
ds_read_b64_tr_b16 a[136:137], v25 offset:0
v_lshl_add_u32 v14, v9, 3, s84
v_mfma_f32_16x16x32_bf16 v[164:167], a[132:135], a[4:7], v[164:167]
buffer_load_dwordx4 v1, s[4:7], s82 offen offset:2048 sc1 lds
v_mfma_f32_16x16x32_bf16 v[172:175], a[128:131], a[8:11], v[172:175]
ds_read_b64_tr_b16 a[138:139], v25 offset:2048
v_mfma_f32_16x16x32_bf16 v[172:175], a[132:135], a[12:15], v[172:175]
buffer_load_dwordx4 v1, s[4:7], s82 offen offset:3072 sc1 lds
v_mfma_f32_16x16x32_bf16 v[180:183], a[128:131], a[16:19], v[180:183]
ds_read_b64_tr_b16 a[140:141], v25 offset:16384
v_mfma_f32_16x16x32_bf16 v[180:183], a[132:135], a[20:23], v[180:183]
ds_write_b64 v14, v[12:13] offset:16640
v_mul_u32_u24 v14, 4160, v11
v_mfma_f32_16x16x32_bf16 v[188:191], a[128:131], a[24:27], v[188:191]
ds_read_b64_tr_b16 a[142:143], v25 offset:18432
v_lshl_add_u32 v14, v10, 2, v14
v_mfma_f32_16x16x32_bf16 v[188:191], a[132:135], a[28:31], v[188:191]
v_add_u32 v14, s84, v14
v_mfma_f32_16x16x32_bf16 v[196:199], a[128:131], a[32:35], v[196:199]
ds_write_b32 v14, v12
v_lshrrev_b32 v30, 6, v0
v_mfma_f32_16x16x32_bf16 v[196:199], a[132:135], a[36:39], v[196:199]
v_lshl_add_u32 v28, v30, 11, v1
v_add_u32 v29, 0x20000, v28
v_mfma_f32_16x16x32_bf16 v[204:207], a[128:131], a[40:43], v[204:207]
v_lshl_add_u32 v30, v30, 13, v1
v_add_u32 v31, 0x20000, v30
v_mfma_f32_16x16x32_bf16 v[204:207], a[132:135], a[44:47], v[204:207]
v_mul_f32 v36, s68, v36
v_mul_f32 v37, s68, v37
v_mfma_f32_16x16x32_bf16 v[212:215], a[128:131], a[48:51], v[212:215]
v_mul_f32 v38, s68, v38
v_mul_f32 v39, s68, v39
v_mfma_f32_16x16x32_bf16 v[212:215], a[132:135], a[52:55], v[212:215]
v_mul_f32 v100, s68, v100
v_mul_f32 v101, s68, v101
v_mfma_f32_16x16x32_bf16 v[220:223], a[128:131], a[56:59], v[220:223]
v_mul_f32 v102, s68, v102
v_mul_f32 v103, s68, v103
v_mfma_f32_16x16x32_bf16 v[220:223], a[132:135], a[60:63], v[220:223]
s_waitcnt lgkmcnt(0)
s_waitcnt lgkmcnt(0)
s_barrier
v_mfma_f32_16x16x32_bf16 v[224:227], a[136:139], a[0:3], v[224:227]
v_cvt_pk_bf16_f32 v36, v36, v37
v_cvt_pk_bf16_f32 v37, v38, v39
v_mfma_f32_16x16x32_bf16 v[224:227], a[140:143], a[4:7], v[224:227]
v_cvt_pk_bf16_f32 v38, v100, v101
v_cvt_pk_bf16_f32 v39, v102, v103
v_mfma_f32_16x16x32_bf16 v[228:231], a[136:139], a[8:11], v[228:231]
v_mul_f32 v44, s68, v44
v_mul_f32 v45, s68, v45
v_mfma_f32_16x16x32_bf16 v[228:231], a[140:143], a[12:15], v[228:231]
v_mul_f32 v46, s68, v46
v_mul_f32 v47, s68, v47
v_mfma_f32_16x16x32_bf16 v[232:235], a[136:139], a[16:19], v[232:235]
v_mul_f32 v108, s68, v108
v_mul_f32 v109, s68, v109
v_mfma_f32_16x16x32_bf16 v[232:235], a[140:143], a[20:23], v[232:235]
v_mul_f32 v110, s68, v110
v_mul_f32 v111, s68, v111
v_mfma_f32_16x16x32_bf16 v[236:239], a[136:139], a[24:27], v[236:239]
v_cvt_pk_bf16_f32 v44, v44, v45
v_cvt_pk_bf16_f32 v45, v46, v47
v_mfma_f32_16x16x32_bf16 v[236:239], a[140:143], a[28:31], v[236:239]
v_cvt_pk_bf16_f32 v46, v108, v109
v_cvt_pk_bf16_f32 v47, v110, v111
v_mfma_f32_16x16x32_bf16 v[240:243], a[136:139], a[32:35], v[240:243]
v_mul_f32 v52, s68, v52
v_mul_f32 v53, s68, v53
v_mfma_f32_16x16x32_bf16 v[240:243], a[140:143], a[36:39], v[240:243]
v_mul_f32 v54, s68, v54
v_mul_f32 v55, s68, v55
v_mfma_f32_16x16x32_bf16 v[244:247], a[136:139], a[40:43], v[244:247]
v_mul_f32 v116, s68, v116
v_mul_f32 v117, s68, v117
v_mfma_f32_16x16x32_bf16 v[244:247], a[140:143], a[44:47], v[244:247]
v_mul_f32 v118, s68, v118
v_mul_f32 v119, s68, v119
v_mfma_f32_16x16x32_bf16 v[248:251], a[136:139], a[48:51], v[248:251]
v_cvt_pk_bf16_f32 v52, v52, v53
v_cvt_pk_bf16_f32 v53, v54, v55
v_mfma_f32_16x16x32_bf16 v[248:251], a[140:143], a[52:55], v[248:251]
v_cvt_pk_bf16_f32 v54, v116, v117
v_cvt_pk_bf16_f32 v55, v118, v119
v_mfma_f32_16x16x32_bf16 v[252:255], a[136:139], a[56:59], v[252:255]
v_mfma_f32_16x16x32_bf16 v[252:255], a[140:143], a[60:63], v[252:255]
s_mov_b64 s[60:61], s[74:75]
s_mov_b32 s62, 896
s_lshl_b32 s79, s85, 1
buffer_load_short_d16_hi v19, off, s[60:63], s79
s_lshl_b32 s83, s85, 12
s_add_u32 s83, s83, 88080384
ds_write_b128 v28, v[36:39] offset:0
ds_write_b128 v28, v[44:47] offset:8192
ds_write_b128 v28, v[52:55] offset:16384
v_pk_mul_f32 v[60:61], v[60:61], s[68:69]
v_pk_mul_f32 v[62:63], v[62:63], s[68:69]
v_pk_mul_f32 v[124:125], v[124:125], s[68:69]
v_pk_mul_f32 v[126:127], v[126:127], s[68:69]
v_cvt_pk_bf16_f32 v60, v60, v61
v_cvt_pk_bf16_f32 v61, v62, v63
v_cvt_pk_bf16_f32 v62, v124, v125
v_cvt_pk_bf16_f32 v63, v126, v127
ds_write_b128 v28, v[60:63] offset:24576
v_pk_mul_f32 v[68:69], v[68:69], s[68:69]
v_pk_mul_f32 v[70:71], v[70:71], s[68:69]
v_pk_mul_f32 v[132:133], v[132:133], s[68:69]
v_pk_mul_f32 v[134:135], v[134:135], s[68:69]
v_cvt_pk_bf16_f32 v68, v68, v69
v_cvt_pk_bf16_f32 v69, v70, v71
v_cvt_pk_bf16_f32 v70, v132, v133
v_cvt_pk_bf16_f32 v71, v134, v135
ds_write_b128 v29, v[68:71] offset:0
v_pk_mul_f32 v[76:77], v[76:77], s[68:69]
v_pk_mul_f32 v[78:79], v[78:79], s[68:69]
v_pk_mul_f32 v[140:141], v[140:141], s[68:69]
v_pk_mul_f32 v[142:143], v[142:143], s[68:69]
v_cvt_pk_bf16_f32 v76, v76, v77
v_cvt_pk_bf16_f32 v77, v78, v79
v_cvt_pk_bf16_f32 v78, v140, v141
v_cvt_pk_bf16_f32 v79, v142, v143
ds_write_b128 v29, v[76:79] offset:8192
v_pk_mul_f32 v[84:85], v[84:85], s[68:69]
v_pk_mul_f32 v[86:87], v[86:87], s[68:69]
v_pk_mul_f32 v[148:149], v[148:149], s[68:69]
v_pk_mul_f32 v[150:151], v[150:151], s[68:69]
v_cvt_pk_bf16_f32 v84, v84, v85
v_cvt_pk_bf16_f32 v85, v86, v87
v_cvt_pk_bf16_f32 v86, v148, v149
v_cvt_pk_bf16_f32 v87, v150, v151
ds_write_b128 v29, v[84:87] offset:16384
v_pk_mul_f32 v[92:93], v[92:93], s[68:69]
v_pk_mul_f32 v[94:95], v[94:95], s[68:69]
v_pk_mul_f32 v[156:157], v[156:157], s[68:69]
v_pk_mul_f32 v[158:159], v[158:159], s[68:69]
v_cvt_pk_bf16_f32 v92, v92, v93
v_cvt_pk_bf16_f32 v93, v94, v95
v_cvt_pk_bf16_f32 v94, v156, v157
v_cvt_pk_bf16_f32 v95, v158, v159
ds_write_b128 v29, v[92:95] offset:24576
v_pk_mul_f32 v[164:165], v[164:165], s[68:69]
v_pk_mul_f32 v[166:167], v[166:167], s[68:69]
v_pk_mul_f32 v[224:225], v[224:225], s[68:69]
v_pk_mul_f32 v[226:227], v[226:227], s[68:69]
v_cvt_pk_bf16_f32 v164, v164, v165
v_cvt_pk_bf16_f32 v165, v166, v167
v_cvt_pk_bf16_f32 v166, v224, v225
v_cvt_pk_bf16_f32 v167, v226, v227
ds_write_b128 v28, v[164:167] offset:1024
v_pk_mul_f32 v[172:173], v[172:173], s[68:69]
v_pk_mul_f32 v[174:175], v[174:175], s[68:69]
v_pk_mul_f32 v[228:229], v[228:229], s[68:69]
v_pk_mul_f32 v[230:231], v[230:231], s[68:69]
v_cvt_pk_bf16_f32 v172, v172, v173
v_cvt_pk_bf16_f32 v173, v174, v175
v_cvt_pk_bf16_f32 v174, v228, v229
v_cvt_pk_bf16_f32 v175, v230, v231
ds_write_b128 v28, v[172:175] offset:9216
v_pk_mul_f32 v[180:181], v[180:181], s[68:69]
v_pk_mul_f32 v[182:183], v[182:183], s[68:69]
v_pk_mul_f32 v[232:233], v[232:233], s[68:69]
v_pk_mul_f32 v[234:235], v[234:235], s[68:69]
v_cvt_pk_bf16_f32 v180, v180, v181
v_cvt_pk_bf16_f32 v181, v182, v183
v_cvt_pk_bf16_f32 v182, v232, v233
v_cvt_pk_bf16_f32 v183, v234, v235
ds_write_b128 v28, v[180:183] offset:17408
v_pk_mul_f32 v[188:189], v[188:189], s[68:69]
v_pk_mul_f32 v[190:191], v[190:191], s[68:69]
v_pk_mul_f32 v[236:237], v[236:237], s[68:69]
v_pk_mul_f32 v[238:239], v[238:239], s[68:69]
v_cvt_pk_bf16_f32 v188, v188, v189
v_cvt_pk_bf16_f32 v189, v190, v191
v_cvt_pk_bf16_f32 v190, v236, v237
v_cvt_pk_bf16_f32 v191, v238, v239
ds_write_b128 v28, v[188:191] offset:25600
v_pk_mul_f32 v[196:197], v[196:197], s[68:69]
v_pk_mul_f32 v[198:199], v[198:199], s[68:69]
v_pk_mul_f32 v[240:241], v[240:241], s[68:69]
v_pk_mul_f32 v[242:243], v[242:243], s[68:69]
v_cvt_pk_bf16_f32 v196, v196, v197
v_cvt_pk_bf16_f32 v197, v198, v199
v_cvt_pk_bf16_f32 v198, v240, v241
v_cvt_pk_bf16_f32 v199, v242, v243
ds_write_b128 v29, v[196:199] offset:1024
v_pk_mul_f32 v[204:205], v[204:205], s[68:69]
v_pk_mul_f32 v[206:207], v[206:207], s[68:69]
v_pk_mul_f32 v[244:245], v[244:245], s[68:69]
v_pk_mul_f32 v[246:247], v[246:247], s[68:69]
v_cvt_pk_bf16_f32 v204, v204, v205
v_cvt_pk_bf16_f32 v205, v206, v207
v_cvt_pk_bf16_f32 v206, v244, v245
v_cvt_pk_bf16_f32 v207, v246, v247
ds_write_b128 v29, v[204:207] offset:9216
v_pk_mul_f32 v[212:213], v[212:213], s[68:69]
v_pk_mul_f32 v[214:215], v[214:215], s[68:69]
v_pk_mul_f32 v[248:249], v[248:249], s[68:69]
v_pk_mul_f32 v[250:251], v[250:251], s[68:69]
v_cvt_pk_bf16_f32 v212, v212, v213
v_cvt_pk_bf16_f32 v213, v214, v215
v_cvt_pk_bf16_f32 v214, v248, v249
v_cvt_pk_bf16_f32 v215, v250, v251
ds_write_b128 v29, v[212:215] offset:17408
v_pk_mul_f32 v[220:221], v[220:221], s[68:69]
v_pk_mul_f32 v[222:223], v[222:223], s[68:69]
v_pk_mul_f32 v[252:253], v[252:253], s[68:69]
v_pk_mul_f32 v[254:255], v[254:255], s[68:69]
v_cvt_pk_bf16_f32 v220, v220, v221
v_cvt_pk_bf16_f32 v221, v222, v223
v_cvt_pk_bf16_f32 v222, v252, v253
v_cvt_pk_bf16_f32 v223, v254, v255
ds_write_b128 v29, v[220:223] offset:25600
s_waitcnt vmcnt(1) lgkmcnt(0)
s_barrier
buffer_load_dword v21, v20, s[4:7], s31 offen sc1
ds_read_b64_tr_b16 a[64:65], v16 offset:8
ds_read_b64_tr_b16 a[66:67], v16 offset:0
ds_read_b128 a[96:99], v17 offset:448
ds_read_b64_tr_b16 a[68:69], v16 offset:520
ds_read_b64_tr_b16 a[70:71], v16 offset:512
ds_read_b128 a[100:103], v17 offset:960
ds_read_b64_tr_b16 a[72:73], v16 offset:1032
ds_read_b64_tr_b16 a[74:75], v16 offset:1024
ds_read_b128 a[104:107], v17 offset:1472
ds_read_b64_tr_b16 a[76:77], v16 offset:1544
ds_read_b64_tr_b16 a[78:79], v16 offset:1536
ds_read_b128 a[108:111], v17 offset:1984
ds_read_b64_tr_b16 a[80:81], v16 offset:2056
ds_read_b64_tr_b16 a[82:83], v16 offset:2048
ds_read_b128 a[112:115], v17 offset:2496
ds_read_b64_tr_b16 a[84:85], v16 offset:2568
ds_read_b64_tr_b16 a[86:87], v16 offset:2560
ds_read_b128 a[116:119], v17 offset:3008
ds_read_b64_tr_b16 a[88:89], v16 offset:3080
ds_read_b64_tr_b16 a[90:91], v16 offset:3072
ds_read_b128 a[120:123], v17 offset:3520
ds_read_b64_tr_b16 a[92:93], v16 offset:3592
ds_read_b64_tr_b16 a[94:95], v16 offset:3584
ds_read_b128 a[124:127], v17 offset:4032
s_waitcnt lgkmcnt(15)
v_mfma_f32_16x16x32_bf16 v[96:99], a[64:67], a[96:99], 0
s_waitcnt lgkmcnt(12)
s_lshl_b32 s18, s3, 13
ds_read_b64_tr_b16 a[128:129], v16 offset:72
v_mov_b32 v24, 0
v_mfma_f32_16x16x32_bf16 v[100:103], a[64:67], a[100:103], 0
s_lshl_b32 s30, s20, 20
ds_read_b64_tr_b16 a[130:131], v16 offset:64
v_lshrrev_b32 v3, 6, v0
v_mfma_f32_16x16x32_bf16 v[100:103], a[68:71], a[96:99], v[100:103]
s_add_u32 s30, s30, s18
ds_read_b128 a[160:163], v17 offset:384
v_and_b32 v4, 63, v0
v_mfma_f32_16x16x32_bf16 v[104:107], a[64:67], a[104:107], 0
s_lshl_b32 s22, s21, 1
ds_read_b128 a[192:195], v30 offset:0
v_add_u32 v2, 0x10000, v1
v_mfma_f32_16x16x32_bf16 v[104:107], a[68:71], a[100:103], v[104:107]
s_and_b32 s84, s2, 1
ds_read_b64_tr_b16 a[132:133], v16 offset:584
v_and_b32 v5, 15, v4
v_mfma_f32_16x16x32_bf16 v[104:107], a[72:75], a[96:99], v[104:107]
s_mul_i32 s84, s84, 0
ds_read_b64_tr_b16 a[134:135], v16 offset:576
v_lshrrev_b32 v6, 4, v4
v_mfma_f32_16x16x32_bf16 v[108:111], a[64:67], a[108:111], 0
s_add_u32 s84, s84, 2386092
ds_read_b128 a[164:167], v17 offset:896
v_lshlrev_b32 v6, 2, v6
v_mfma_f32_16x16x32_bf16 v[108:111], a[68:71], a[104:107], v[108:111]
s_lshl_b32 s85, s21, 2
ds_read_b128 a[196:199], v30 offset:1024
v_sub_u32 v5, v5, v6
v_mfma_f32_16x16x32_bf16 v[108:111], a[72:75], a[100:103], v[108:111]
s_lshr_b32 s85, s84, s85
ds_read_b64_tr_b16 a[136:137], v16 offset:1096
v_lshl_add_u32 v5, v3, 4, v5
v_mfma_f32_16x16x32_bf16 v[108:111], a[76:79], a[96:99], v[108:111]
s_waitcnt lgkmcnt(8)
s_and_b32 s9, s85, 15
ds_read_b64_tr_b16 a[138:139], v16 offset:1088
v_cmp_gt_i32 s[32:33], 0, v5
v_mfma_f32_16x16x32_bf16 v[112:115], a[64:67], a[112:115], 0
s_and_b32 s84, s85, 1
ds_read_b128 a[168:171], v17 offset:1408
v_cmp_gt_i32 s[34:35], 1, v5
v_mfma_f32_16x16x32_bf16 v[112:115], a[68:71], a[108:111], v[112:115]
s_lshl_b32 s84, s84, 17
ds_read_b128 a[200:203], v30 offset:2048
v_cmp_gt_i32 s[36:37], 2, v5
v_mfma_f32_16x16x32_bf16 v[112:115], a[72:75], a[104:107], v[112:115]
s_add_u32 s84, s84, s18
ds_read_b64_tr_b16 a[140:141], v16 offset:1608
v_cmp_gt_i32 s[38:39], 3, v5
v_mfma_f32_16x16x32_bf16 v[112:115], a[76:79], a[100:103], v[112:115]
s_xor_b32 s85, s84, 0x20000
ds_read_b64_tr_b16 a[142:143], v16 offset:1600
v_cmp_gt_i32 s[40:41], 16, v5
v_mfma_f32_16x16x32_bf16 v[112:115], a[80:83], a[96:99], v[112:115]
s_sub_u32 s29, 15, s21
ds_read_b128 a[172:175], v17 offset:1920
v_cmp_gt_i32 s[42:43], 17, v5
v_mfma_f32_16x16x32_bf16 v[116:119], a[64:67], a[116:119], 0
s_xor_b32 s8, s30, 2097152
ds_read_b128 a[204:207], v30 offset:3072
v_cmp_gt_i32 s[44:45], 18, v5
v_mfma_f32_16x16x32_bf16 v[116:119], a[68:71], a[112:115], v[116:119]
s_add_u32 s11, s22, 2
ds_read_b64_tr_b16 a[144:145], v16 offset:2120
v_cmp_gt_i32 s[46:47], 19, v5
v_mfma_f32_16x16x32_bf16 v[116:119], a[72:75], a[108:111], v[116:119]
s_add_u32 s14, s30, 16777216
ds_read_b64_tr_b16 a[146:147], v16 offset:2112
v_cmp_gt_i32 s[48:49], 32, v5
v_mfma_f32_16x16x32_bf16 v[116:119], a[76:79], a[104:107], v[116:119]
s_lshr_b32 s19, s9, 1
ds_read_b128 a[176:179], v17 offset:2432
v_cmp_gt_i32 s[50:51], 33, v5
v_mfma_f32_16x16x32_bf16 v[116:119], a[80:83], a[100:103], v[116:119]
s_cmp_lg_u32 s9, 0
ds_read_b128 a[208:211], v30 offset:4096
v_cmp_gt_i32 s[52:53], 34, v5
v_mfma_f32_16x16x32_bf16 v[116:119], a[84:87], a[96:99], v[116:119]
s_cselect_b32 s10, s30, 3221225472
ds_read_b64_tr_b16 a[148:149], v16 offset:2632
v_cmp_gt_i32 s[54:55], 35, v5
v_mfma_f32_16x16x32_bf16 v[120:123], a[64:67], a[120:123], 0
s_cselect_b32 s8, s8, s30
ds_read_b64_tr_b16 a[150:151], v16 offset:2624
v_cmp_gt_i32 s[56:57], 48, v5
v_mfma_f32_16x16x32_bf16 v[120:123], a[68:71], a[116:119], v[120:123]
s_cselect_b32 s14, s14, 3221225472
ds_read_b128 a[180:183], v17 offset:2944
v_cmp_gt_i32 s[58:59], 49, v5
v_mfma_f32_16x16x32_bf16 v[120:123], a[72:75], a[112:115], v[120:123]
s_cselect_b32 s9, s9, s11
ds_read_b128 a[212:215], v30 offset:5120
v_cmp_gt_i32 s[60:61], 50, v5
v_mfma_f32_16x16x32_bf16 v[120:123], a[76:79], a[108:111], v[120:123]
s_cselect_b32 s19, s19, s21
ds_read_b64_tr_b16 a[152:153], v16 offset:3144
v_cmp_gt_i32 s[62:63], 51, v5
v_mfma_f32_16x16x32_bf16 v[120:123], a[80:83], a[104:107], v[120:123]
s_cselect_b32 s29, s29, s21
ds_read_b64_tr_b16 a[154:155], v16 offset:3136
v_mov_b32 v7, 0xff800000
v_mfma_f32_16x16x32_bf16 v[120:123], a[84:87], a[100:103], v[120:123]
s_cselect_b32 s24, 2, 0
ds_read_b128 a[184:187], v17 offset:3456
v_mov_b32 v6, 1
v_mfma_f32_16x16x32_bf16 v[120:123], a[88:91], a[96:99], v[120:123]
s_add_u32 s12, s8, 16777216
ds_read_b128 a[216:219], v30 offset:6144
v_mov_b32 v5, v26
v_mfma_f32_16x16x32_bf16 v[124:127], a[64:67], a[124:127], 0
s_mov_b32 s13, s9
ds_read_b64_tr_b16 a[156:157], v16 offset:3656
v_add_u32 v4, 0x20000, v1
v_mfma_f32_16x16x32_bf16 v[124:127], a[68:71], a[120:123], v[124:127]
s_mov_b32 s15, s11
ds_read_b64_tr_b16 a[158:159], v16 offset:3648
v_mfma_f32_16x16x32_bf16 v[124:127], a[72:75], a[116:119], v[124:127]
s_mov_b32 s25, 1266679808
ds_read_b128 a[188:191], v17 offset:3968
v_mfma_f32_16x16x32_bf16 v[124:127], a[76:79], a[112:115], v[124:127]
s_lshl_b32 s22, s21, 3
ds_read_b128 a[220:223], v30 offset:7168
v_mfma_f32_16x16x32_bf16 v[124:127], a[80:83], a[108:111], v[124:127]
s_xor_b32 s28, s70, 0
ds_read_b128 a[224:227], v31 offset:0
v_mfma_f32_16x16x32_bf16 v[124:127], a[84:87], a[104:107], v[124:127]
s_add_u32 s28, s28, s22
ds_read_b128 a[228:231], v31 offset:1024
v_mfma_f32_16x16x32_bf16 v[124:127], a[88:91], a[100:103], v[124:127]
s_add_u32 s28, s28, 6148
ds_read_b128 a[232:235], v31 offset:2048
v_mfma_f32_16x16x32_bf16 v[124:127], a[92:95], a[96:99], v[124:127]
s_waitcnt lgkmcnt(8)
s_lshl_b32 s26, s21, 16
ds_read_b128 a[236:239], v31 offset:3072
v_mfma_f32_16x16x32_bf16 v[96:99], a[128:131], a[160:163], v[96:99]
s_add_u32 s26, s26, s30
ds_read_b64_tr_b16 a[64:65], v16 offset:136
v_mfma_f32_16x16x32_bf16 v[100:103], a[128:131], a[164:167], v[100:103]
s_add_u32 s26, s26, 33554432
ds_read_b64_tr_b16 a[66:67], v16 offset:128
v_mfma_f32_16x16x32_bf16 v[100:103], a[132:135], a[160:163], v[100:103]
s_xor_b32 s76, s20, 2
ds_read_b128 a[96:99], v17 offset:320
v_mfma_f32_16x16x32_bf16 v[104:107], a[128:131], a[168:171], v[104:107]
s_lshl_b32 s76, s76, 3
ds_read_b128 a[240:243], v31 offset:4096
v_mfma_f32_16x16x32_bf16 v[104:107], a[132:135], a[164:167], v[104:107]
s_add_u32 s76, s76, s21
ds_read_b64_tr_b16 a[68:69], v16 offset:648
v_mfma_f32_16x16x32_bf16 v[104:107], a[136:139], a[160:163], v[104:107]
s_lshl_b32 s76, s76, 2
ds_read_b64_tr_b16 a[70:71], v16 offset:640
v_mfma_f32_16x16x32_bf16 v[108:111], a[128:131], a[172:175], v[108:111]
s_add_u32 s76, s76, s3
ds_read_b128 a[100:103], v17 offset:832
v_mfma_f32_16x16x32_bf16 v[108:111], a[132:135], a[168:171], v[108:111]
s_lshl_b32 s27, s76, 10
ds_read_b128 a[244:247], v31 offset:5120
v_mfma_f32_16x16x32_bf16 v[108:111], a[136:139], a[164:167], v[108:111]
s_add_u32 s27, s27, 75497472
ds_read_b64_tr_b16 a[72:73], v16 offset:1160
v_mfma_f32_16x16x32_bf16 v[108:111], a[140:143], a[160:163], v[108:111]
s_lshl_b32 s76, s76, 14
ds_read_b64_tr_b16 a[74:75], v16 offset:1152
v_mfma_f32_16x16x32_bf16 v[112:115], a[128:131], a[176:179], v[112:115]
s_add_u32 s76, s76, 67108864
ds_read_b128 a[104:107], v17 offset:1344
v_mfma_f32_16x16x32_bf16 v[112:115], a[132:135], a[172:175], v[112:115]
s_lshl_b32 s81, s20, 2
ds_read_b128 a[248:251], v31 offset:6144
v_mfma_f32_16x16x32_bf16 v[112:115], a[136:139], a[168:171], v[112:115]
s_add_u32 s81, s81, s3
ds_read_b64_tr_b16 a[76:77], v16 offset:1672
v_mfma_f32_16x16x32_bf16 v[112:115], a[140:143], a[164:167], v[112:115]
s_mul_i32 s81, s81, 57344
ds_read_b64_tr_b16 a[78:79], v16 offset:1664
v_mfma_f32_16x16x32_bf16 v[112:115], a[144:147], a[160:163], v[112:115]
PAD_30:
s_cbranch_execz M_tret
s_cmp_eq_u32 s24, 1
ds_read_b128 a[108:111], v17 offset:1856
v_mfma_f32_16x16x32_bf16 v[116:119], a[128:131], a[180:183], v[116:119]
s_cselect_b32 s80, s28, s70
ds_read_b128 a[252:255], v31 offset:7168
v_mfma_f32_16x16x32_bf16 v[116:119], a[132:135], a[176:179], v[116:119]
s_add_u32 s77, s76, 8192
ds_read_b64_tr_b16 a[80:81], v16 offset:2184
v_mfma_f32_16x16x32_bf16 v[116:119], a[136:139], a[172:175], v[116:119]
s_lshl_b32 s71, s2, 2
ds_read_b64_tr_b16 a[82:83], v16 offset:2176
v_mfma_f32_16x16x32_bf16 v[116:119], a[140:143], a[168:171], v[116:119]
s_add_u32 s71, s71, 94384128
ds_read_b128 a[112:115], v17 offset:2368
v_mfma_f32_16x16x32_bf16 v[116:119], a[144:147], a[164:167], v[116:119]
s_lshl_b32 s78, s29, 16
v_mfma_f32_16x16x32_bf16 v[116:119], a[148:151], a[160:163], v[116:119]
s_add_u32 s78, s78, s8
ds_read_b64_tr_b16 a[84:85], v16 offset:2696
v_mfma_f32_16x16x32_bf16 v[120:123], a[128:131], a[184:187], v[120:123]
s_add_u32 s78, s78, 33554432
ds_read_b64_tr_b16 a[86:87], v16 offset:2688
v_mfma_f32_16x16x32_bf16 v[120:123], a[132:135], a[180:183], v[120:123]
s_cmp_eq_u32 s24, 0
ds_read_b128 a[116:119], v17 offset:2880
v_mfma_f32_16x16x32_bf16 v[120:123], a[136:139], a[176:179], v[120:123]
s_cselect_b32 s78, 3221225472, s78
v_mfma_f32_16x16x32_bf16 v[120:123], a[140:143], a[172:175], v[120:123]
s_lshl_b32 s22, s21, 3
ds_read_b64_tr_b16 a[88:89], v16 offset:3208
v_mfma_f32_16x16x32_bf16 v[120:123], a[144:147], a[168:171], v[120:123]
s_add_u32 s22, s22, 16384
ds_read_b64_tr_b16 a[90:91], v16 offset:3200
v_mfma_f32_16x16x32_bf16 v[120:123], a[148:151], a[164:167], v[120:123]
s_andn2_b32 s23, 256, s70
ds_read_b128 a[120:123], v17 offset:3392
v_mfma_f32_16x16x32_bf16 v[120:123], a[152:155], a[160:163], v[120:123]
s_waitcnt lgkmcnt(6)
s_add_u32 s22, s22, s23
v_mfma_f32_16x16x32_bf16 v[124:127], a[128:131], a[188:191], v[124:127]
s_waitcnt vmcnt(0) lgkmcnt(9)
s_barrier
ds_read_b64_tr_b16 a[92:93], v16 offset:3720
v_writelane_b32 v15, s22, 63
v_cmp_gt_u32 vcc, 1, v21
v_mfma_f32_16x16x32_bf16 v[124:127], a[132:135], a[184:187], v[124:127]
s_cbranch_vccnz M_kspin2
M_kok2:
ds_read_b64_tr_b16 a[94:95], v16 offset:3712
v_mov_b32 v25, 0
v_mfma_f32_16x16x32_bf16 v[124:127], a[136:139], a[180:183], v[124:127]
s_mov_b32 m0, s84
ds_read_b128 a[124:127], v17 offset:3904
v_mov_b32 v128, 0
v_mfma_f32_16x16x32_bf16 v[124:127], a[140:143], a[176:179], v[124:127]
buffer_load_dwordx4 v1, s[4:7], s8 offen offset:0 sc1 lds
v_mfma_f32_16x16x32_bf16 v[124:127], a[144:147], a[172:175], v[124:127]
buffer_load_dwordx4 v1, s[4:7], s8 offen offset:1024 sc1 lds
v_mfma_f32_16x16x32_bf16 v[124:127], a[148:151], a[168:171], v[124:127]
buffer_load_dwordx4 v1, s[4:7], s8 offen offset:2048 sc1 lds
v_mfma_f32_16x16x32_bf16 v[124:127], a[152:155], a[164:167], v[124:127]
buffer_load_dwordx4 v1, s[4:7], s8 offen offset:3072 sc1 lds
v_mfma_f32_16x16x32_bf16 v[124:127], a[156:159], a[160:163], v[124:127]
s_add_u32 s8, s8, 4096
v_mov_b32 v129, 0
v_mov_b32 v130, 0
v_mfma_f32_16x16x32_bf16 v[96:99], a[64:67], a[96:99], v[96:99]
s_add_u32 m0, s84, 4096
ds_read_b64_tr_b16 a[128:129], v16 offset:200
v_mov_b32 v131, 0
v_mfma_f32_16x16x32_bf16 v[100:103], a[64:67], a[100:103], v[100:103]
ds_read_b64_tr_b16 a[130:131], v16 offset:192
v_mov_b32 v132, 0
v_mfma_f32_16x16x32_bf16 v[100:103], a[68:71], a[96:99], v[100:103]
ds_read_b128 a[160:163], v17 offset:256
v_mov_b32 v133, 0
v_mfma_f32_16x16x32_bf16 v[104:107], a[64:67], a[104:107], v[104:107]
buffer_load_dwordx4 v1, s[4:7], s8 offen offset:0 sc1 lds
v_mfma_f32_16x16x32_bf16 v[104:107], a[68:71], a[100:103], v[104:107]
ds_read_b64_tr_b16 a[132:133], v16 offset:712
v_mov_b32 v134, 0
v_mfma_f32_16x16x32_bf16 v[104:107], a[72:75], a[96:99], v[104:107]
ds_read_b64_tr_b16 a[134:135], v16 offset:704
v_mov_b32 v135, 0
v_mfma_f32_16x16x32_bf16 v[108:111], a[64:67], a[108:111], v[108:111]
ds_read_b128 a[164:167], v17 offset:768
v_mov_b32 v136, 0
v_mfma_f32_16x16x32_bf16 v[108:111], a[68:71], a[104:107], v[108:111]
buffer_load_dwordx4 v1, s[4:7], s8 offen offset:1024 sc1 lds
v_mfma_f32_16x16x32_bf16 v[108:111], a[72:75], a[100:103], v[108:111]
ds_read_b64_tr_b16 a[136:137], v16 offset:1224
v_mov_b32 v137, 0
v_mfma_f32_16x16x32_bf16 v[108:111], a[76:79], a[96:99], v[108:111]
ds_read_b64_tr_b16 a[138:139], v16 offset:1216
v_mov_b32 v138, 0
v_mfma_f32_16x16x32_bf16 v[112:115], a[64:67], a[112:115], v[112:115]
ds_read_b128 a[168:171], v17 offset:1280
v_mov_b32 v139, 0
v_mfma_f32_16x16x32_bf16 v[112:115], a[68:71], a[108:111], v[112:115]
buffer_load_dwordx4 v1, s[4:7], s8 offen offset:2048 sc1 lds
v_mfma_f32_16x16x32_bf16 v[112:115], a[72:75], a[104:107], v[112:115]
ds_read_b64_tr_b16 a[140:141], v16 offset:1736
v_mov_b32 v140, 0
v_mfma_f32_16x16x32_bf16 v[112:115], a[76:79], a[100:103], v[112:115]
ds_read_b64_tr_b16 a[142:143], v16 offset:1728
v_mov_b32 v141, 0
v_mfma_f32_16x16x32_bf16 v[112:115], a[80:83], a[96:99], v[112:115]
s_waitcnt lgkmcnt(6)
ds_read_b128 a[172:175], v17 offset:1792
v_mov_b32 v142, 0
v_mfma_f32_16x16x32_bf16 v[116:119], a[64:67], a[116:119], v[116:119]
buffer_load_dwordx4 v1, s[4:7], s8 offen offset:3072 sc1 lds
v_mfma_f32_16x16x32_bf16 v[116:119], a[68:71], a[112:115], v[116:119]
s_add_u32 s8, s8, 28672
ds_read_b64_tr_b16 a[144:145], v16 offset:2248
v_mov_b32 v143, 0
v_mfma_f32_16x16x32_bf16 v[116:119], a[72:75], a[108:111], v[116:119]
s_sub_u32 s9, s9, 1
ds_read_b64_tr_b16 a[146:147], v16 offset:2240
v_mov_b32 v144, 0
v_mfma_f32_16x16x32_bf16 v[116:119], a[76:79], a[104:107], v[116:119]
s_cmp_eq_u32 s9, 0
ds_read_b128 a[176:179], v17 offset:2304
v_mov_b32 v145, 0
v_mfma_f32_16x16x32_bf16 v[116:119], a[80:83], a[100:103], v[116:119]
s_cselect_b32 s8, s10, s8
v_mov_b32 v146, 0
v_mov_b32 v147, 0
v_mfma_f32_16x16x32_bf16 v[116:119], a[84:87], a[96:99], v[116:119]
s_cselect_b32 s9, s11, s9
ds_read_b64_tr_b16 a[148:149], v16 offset:2760
v_mov_b32 v148, 0
v_mfma_f32_16x16x32_bf16 v[120:123], a[64:67], a[120:123], v[120:123]
s_cselect_b32 s10, 3221225472, s10
ds_read_b64_tr_b16 a[150:151], v16 offset:2752
v_mov_b32 v149, 0
v_mfma_f32_16x16x32_bf16 v[120:123], a[68:71], a[116:119], v[120:123]
s_mov_b32 m0, s85
ds_read_b128 a[180:183], v17 offset:2816
v_mov_b32 v150, 0
v_mfma_f32_16x16x32_bf16 v[120:123], a[72:75], a[112:115], v[120:123]
buffer_load_dwordx4 v1, s[4:7], s8 offen offset:0 sc1 lds
v_mfma_f32_16x16x32_bf16 v[120:123], a[76:79], a[108:111], v[120:123]
ds_read_b64_tr_b16 a[152:153], v16 offset:3272
v_mov_b32 v151, 0
v_mfma_f32_16x16x32_bf16 v[120:123], a[80:83], a[104:107], v[120:123]
ds_read_b64_tr_b16 a[154:155], v16 offset:3264
v_mov_b32 v152, 0
v_mfma_f32_16x16x32_bf16 v[120:123], a[84:87], a[100:103], v[120:123]
ds_read_b128 a[184:187], v17 offset:3328
v_mov_b32 v153, 0
v_mfma_f32_16x16x32_bf16 v[120:123], a[88:91], a[96:99], v[120:123]
buffer_load_dwordx4 v1, s[4:7], s8 offen offset:1024 sc1 lds
v_mfma_f32_16x16x32_bf16 v[124:127], a[64:67], a[124:127], v[124:127]
ds_read_b64_tr_b16 a[156:157], v16 offset:3784
v_mov_b32 v154, 0
v_mfma_f32_16x16x32_bf16 v[124:127], a[68:71], a[120:123], v[124:127]
ds_read_b64_tr_b16 a[158:159], v16 offset:3776
v_mov_b32 v155, 0
v_mfma_f32_16x16x32_bf16 v[124:127], a[72:75], a[116:119], v[124:127]
ds_read_b128 a[188:191], v17 offset:3840
v_mov_b32 v156, 0
v_mfma_f32_16x16x32_bf16 v[124:127], a[76:79], a[112:115], v[124:127]
buffer_load_dwordx4 v1, s[4:7], s8 offen offset:2048 sc1 lds
v_mfma_f32_16x16x32_bf16 v[124:127], a[80:83], a[108:111], v[124:127]
buffer_load_dwordx4 v1, s[4:7], s8 offen offset:3072 sc1 lds
v_mfma_f32_16x16x32_bf16 v[124:127], a[84:87], a[104:107], v[124:127]
s_add_u32 s8, s8, 4096
v_mov_b32 v157, 0
v_mov_b32 v158, 0
v_mfma_f32_16x16x32_bf16 v[124:127], a[88:91], a[100:103], v[124:127]
s_add_u32 m0, s85, 4096
v_mov_b32 v159, 0
v_mov_b32 v160, 0
v_mfma_f32_16x16x32_bf16 v[124:127], a[92:95], a[96:99], v[124:127]
buffer_load_dwordx4 v1, s[4:7], s8 offen offset:0 sc1 lds
v_mfma_f32_16x16x32_bf16 v[96:99], a[128:131], a[160:163], v[96:99]
s_waitcnt lgkmcnt(3)
ds_read_b64_tr_b16 a[64:65], v16 offset:264
v_mov_b32 v161, 0
v_mfma_f32_16x16x32_bf16 v[100:103], a[128:131], a[164:167], v[100:103]
ds_read_b64_tr_b16 a[66:67], v16 offset:256
v_mov_b32 v162, 0
v_mfma_f32_16x16x32_bf16 v[100:103], a[132:135], a[160:163], v[100:103]
ds_read_b128 a[96:99], v17 offset:192
v_mov_b32 v163, 0
v_mfma_f32_16x16x32_bf16 v[104:107], a[128:131], a[168:171], v[104:107]
buffer_load_dwordx4 v1, s[4:7], s8 offen offset:1024 sc1 lds
v_mfma_f32_16x16x32_bf16 v[104:107], a[132:135], a[164:167], v[104:107]
ds_read_b64_tr_b16 a[68:69], v16 offset:776
v_mov_b32 v164, 0
v_mfma_f32_16x16x32_bf16 v[104:107], a[136:139], a[160:163], v[104:107]
ds_read_b64_tr_b16 a[70:71], v16 offset:768
v_mov_b32 v165, 0
v_mfma_f32_16x16x32_bf16 v[108:111], a[128:131], a[172:175], v[108:111]
ds_read_b128 a[100:103], v17 offset:704
v_mov_b32 v166, 0
v_mfma_f32_16x16x32_bf16 v[108:111], a[132:135], a[168:171], v[108:111]
buffer_load_dwordx4 v1, s[4:7], s8 offen offset:2048 sc1 lds
v_mfma_f32_16x16x32_bf16 v[108:111], a[136:139], a[164:167], v[108:111]
ds_read_b64_tr_b16 a[72:73], v16 offset:1288
v_mov_b32 v167, 0
v_mfma_f32_16x16x32_bf16 v[108:111], a[140:143], a[160:163], v[108:111]
ds_read_b64_tr_b16 a[74:75], v16 offset:1280
v_mov_b32 v168, 0
v_mfma_f32_16x16x32_bf16 v[112:115], a[128:131], a[176:179], v[112:115]
ds_read_b128 a[104:107], v17 offset:1216
v_mov_b32 v169, 0
v_mfma_f32_16x16x32_bf16 v[112:115], a[132:135], a[172:175], v[112:115]
buffer_load_dwordx4 v1, s[4:7], s8 offen offset:3072 sc1 lds
v_mfma_f32_16x16x32_bf16 v[112:115], a[136:139], a[168:171], v[112:115]
s_add_u32 s8, s8, 28672
ds_read_b64_tr_b16 a[76:77], v16 offset:1800
v_mov_b32 v170, 0
v_mfma_f32_16x16x32_bf16 v[112:115], a[140:143], a[164:167], v[112:115]
s_sub_u32 s9, s9, 1
ds_read_b64_tr_b16 a[78:79], v16 offset:1792
v_mov_b32 v171, 0
v_mfma_f32_16x16x32_bf16 v[112:115], a[144:147], a[160:163], v[112:115]
s_cmp_eq_u32 s9, 0
ds_read_b128 a[108:111], v17 offset:1728
v_mov_b32 v172, 0
v_mfma_f32_16x16x32_bf16 v[116:119], a[128:131], a[180:183], v[116:119]
s_cselect_b32 s8, s10, s8
buffer_load_dword v14, v15, s[4:7], s31 offen sc1
v_mfma_f32_16x16x32_bf16 v[116:119], a[132:135], a[176:179], v[116:119]
s_cselect_b32 s9, s11, s9
ds_read_b64_tr_b16 a[80:81], v16 offset:2312
v_mov_b32 v173, 0
v_mfma_f32_16x16x32_bf16 v[116:119], a[136:139], a[172:175], v[116:119]
s_cselect_b32 s10, 3221225472, s10
ds_read_b64_tr_b16 a[82:83], v16 offset:2304
v_mov_b32 v174, 0
v_mfma_f32_16x16x32_bf16 v[116:119], a[140:143], a[168:171], v[116:119]
ds_read_b128 a[112:115], v17 offset:2240
v_mov_b32 v175, 0
v_mfma_f32_16x16x32_bf16 v[116:119], a[144:147], a[164:167], v[116:119]
v_mov_b32 v176, 0
v_mov_b32 v177, 0
v_mfma_f32_16x16x32_bf16 v[116:119], a[148:151], a[160:163], v[116:119]
ds_read_b64_tr_b16 a[84:85], v16 offset:2824
v_mov_b32 v178, 0
v_mfma_f32_16x16x32_bf16 v[120:123], a[128:131], a[184:187], v[120:123]
ds_read_b64_tr_b16 a[86:87], v16 offset:2816
v_mov_b32 v179, 0
v_mfma_f32_16x16x32_bf16 v[120:123], a[132:135], a[180:183], v[120:123]
ds_read_b128 a[116:119], v17 offset:2752
v_mov_b32 v180, 0
v_mfma_f32_16x16x32_bf16 v[120:123], a[136:139], a[176:179], v[120:123]
v_mov_b32 v181, 0
v_mov_b32 v182, 0
v_mfma_f32_16x16x32_bf16 v[120:123], a[140:143], a[172:175], v[120:123]
ds_read_b64_tr_b16 a[88:89], v16 offset:3336
v_mov_b32 v183, 0
v_mfma_f32_16x16x32_bf16 v[120:123], a[144:147], a[168:171], v[120:123]
ds_read_b64_tr_b16 a[90:91], v16 offset:3328
v_mov_b32 v184, 0
v_mfma_f32_16x16x32_bf16 v[120:123], a[148:151], a[164:167], v[120:123]
ds_read_b128 a[120:123], v17 offset:3264
v_mov_b32 v185, 0
v_mfma_f32_16x16x32_bf16 v[120:123], a[152:155], a[160:163], v[120:123]
s_waitcnt lgkmcnt(6)
v_mov_b32 v186, 0
v_mov_b32 v187, 0
v_mfma_f32_16x16x32_bf16 v[124:127], a[128:131], a[188:191], v[124:127]
ds_read_b64_tr_b16 a[92:93], v16 offset:3848
v_mov_b32 v188, 0
v_mfma_f32_16x16x32_bf16 v[124:127], a[132:135], a[184:187], v[124:127]
ds_read_b64_tr_b16 a[94:95], v16 offset:3840
v_mov_b32 v189, 0
v_mfma_f32_16x16x32_bf16 v[124:127], a[136:139], a[180:183], v[124:127]
ds_read_b128 a[124:127], v17 offset:3776
v_mov_b32 v190, 0
v_mfma_f32_16x16x32_bf16 v[124:127], a[140:143], a[176:179], v[124:127]
v_mov_b32 v191, 0
v_mov_b32 v192, 0
v_mfma_f32_16x16x32_bf16 v[124:127], a[144:147], a[172:175], v[124:127]
v_mov_b32 v193, 0
v_mov_b32 v194, 0
v_mfma_f32_16x16x32_bf16 v[124:127], a[148:151], a[168:171], v[124:127]
v_mov_b32 v195, 0
v_mov_b32 v196, 0
v_mfma_f32_16x16x32_bf16 v[124:127], a[152:155], a[164:167], v[124:127]
v_mov_b32 v197, 0
v_mov_b32 v198, 0
v_mfma_f32_16x16x32_bf16 v[124:127], a[156:159], a[160:163], v[124:127]
v_mov_b32 v199, 0
v_mov_b32 v200, 0
s_waitcnt vmcnt(0)
v_cmp_gt_u32 vcc, 1, v14
s_cbranch_vccnz M_cspin
M_cok:
v_mfma_f32_16x16x32_bf16 v[96:99], a[64:67], a[96:99], v[96:99]
s_add_u32 s22, s78, 0
ds_read_b64_tr_b16 a[128:129], v16 offset:328
v_mov_b32 v201, 0
v_mfma_f32_16x16x32_bf16 v[100:103], a[64:67], a[100:103], v[100:103]
ds_read_b64_tr_b16 a[130:131], v16 offset:320
v_mov_b32 v202, 0
v_mfma_f32_16x16x32_bf16 v[100:103], a[68:71], a[96:99], v[100:103]
ds_read_b128 a[160:163], v17 offset:128
v_mov_b32 v203, 0
v_mfma_f32_16x16x32_bf16 v[104:107], a[64:67], a[104:107], v[104:107]
buffer_load_dwordx4 a[0:3], v1, s[4:7], s22 offen offset:0 sc1
v_mfma_f32_16x16x32_bf16 v[104:107], a[68:71], a[100:103], v[104:107]
ds_read_b64_tr_b16 a[132:133], v16 offset:840
v_mov_b32 v204, 0
v_mfma_f32_16x16x32_bf16 v[104:107], a[72:75], a[96:99], v[104:107]
ds_read_b64_tr_b16 a[134:135], v16 offset:832
v_mov_b32 v205, 0
v_mfma_f32_16x16x32_bf16 v[108:111], a[64:67], a[108:111], v[108:111]
ds_read_b128 a[164:167], v17 offset:640
v_mov_b32 v206, 0
v_mfma_f32_16x16x32_bf16 v[108:111], a[68:71], a[104:107], v[108:111]
buffer_load_dwordx4 a[4:7], v1, s[4:7], s22 offen offset:1024 sc1
v_mfma_f32_16x16x32_bf16 v[108:111], a[72:75], a[100:103], v[108:111]
ds_read_b64_tr_b16 a[136:137], v16 offset:1352
v_mov_b32 v207, 0
v_mfma_f32_16x16x32_bf16 v[108:111], a[76:79], a[96:99], v[108:111]
ds_read_b64_tr_b16 a[138:139], v16 offset:1344
v_mov_b32 v208, 0
v_mfma_f32_16x16x32_bf16 v[112:115], a[64:67], a[112:115], v[112:115]
ds_read_b128 a[168:171], v17 offset:1152
v_mov_b32 v209, 0
v_mfma_f32_16x16x32_bf16 v[112:115], a[68:71], a[108:111], v[112:115]
buffer_load_dwordx4 a[8:11], v1, s[4:7], s22 offen offset:2048 sc1
v_mfma_f32_16x16x32_bf16 v[112:115], a[72:75], a[104:107], v[112:115]
ds_read_b64_tr_b16 a[140:141], v16 offset:1864
v_mov_b32 v210, 0
v_mfma_f32_16x16x32_bf16 v[112:115], a[76:79], a[100:103], v[112:115]
ds_read_b64_tr_b16 a[142:143], v16 offset:1856
v_mov_b32 v211, 0
v_mfma_f32_16x16x32_bf16 v[112:115], a[80:83], a[96:99], v[112:115]
s_waitcnt lgkmcnt(6)
ds_read_b128 a[172:175], v17 offset:1664
v_mov_b32 v212, 0
v_mfma_f32_16x16x32_bf16 v[116:119], a[64:67], a[116:119], v[116:119]
buffer_load_dwordx4 a[12:15], v1, s[4:7], s22 offen offset:3072 sc1
v_mfma_f32_16x16x32_bf16 v[116:119], a[68:71], a[112:115], v[116:119]
s_add_u32 s22, s78, 4096
ds_read_b64_tr_b16 a[144:145], v16 offset:2376
v_mov_b32 v213, 0
v_mfma_f32_16x16x32_bf16 v[116:119], a[72:75], a[108:111], v[116:119]
ds_read_b64_tr_b16 a[146:147], v16 offset:2368
v_mov_b32 v214, 0
v_mfma_f32_16x16x32_bf16 v[116:119], a[76:79], a[104:107], v[116:119]
ds_read_b128 a[176:179], v17 offset:2176
v_mov_b32 v215, 0
v_mfma_f32_16x16x32_bf16 v[116:119], a[80:83], a[100:103], v[116:119]
buffer_load_dwordx4 a[16:19], v1, s[4:7], s22 offen offset:0 sc1
v_mfma_f32_16x16x32_bf16 v[116:119], a[84:87], a[96:99], v[116:119]
ds_read_b64_tr_b16 a[148:149], v16 offset:2888
v_mov_b32 v216, 0
v_mfma_f32_16x16x32_bf16 v[120:123], a[64:67], a[120:123], v[120:123]
ds_read_b64_tr_b16 a[150:151], v16 offset:2880
v_mov_b32 v217, 0
v_mfma_f32_16x16x32_bf16 v[120:123], a[68:71], a[116:119], v[120:123]
ds_read_b128 a[180:183], v17 offset:2688
v_mov_b32 v218, 0
v_mfma_f32_16x16x32_bf16 v[120:123], a[72:75], a[112:115], v[120:123]
buffer_load_dwordx4 a[20:23], v1, s[4:7], s22 offen offset:1024 sc1
v_mfma_f32_16x16x32_bf16 v[120:123], a[76:79], a[108:111], v[120:123]
ds_read_b64_tr_b16 a[152:153], v16 offset:3400
v_mov_b32 v219, 0
v_mfma_f32_16x16x32_bf16 v[120:123], a[80:83], a[104:107], v[120:123]
ds_read_b64_tr_b16 a[154:155], v16 offset:3392
v_mov_b32 v220, 0
v_mfma_f32_16x16x32_bf16 v[120:123], a[84:87], a[100:103], v[120:123]
ds_read_b128 a[184:187], v17 offset:3200
v_mov_b32 v221, 0
v_mfma_f32_16x16x32_bf16 v[120:123], a[88:91], a[96:99], v[120:123]
buffer_load_dwordx4 a[24:27], v1, s[4:7], s22 offen offset:2048 sc1
v_mfma_f32_16x16x32_bf16 v[124:127], a[64:67], a[124:127], v[124:127]
ds_read_b64_tr_b16 a[156:157], v16 offset:3912
v_mov_b32 v222, 0
v_mfma_f32_16x16x32_bf16 v[124:127], a[68:71], a[120:123], v[124:127]
ds_read_b64_tr_b16 a[158:159], v16 offset:3904
v_mov_b32 v223, 0
v_mfma_f32_16x16x32_bf16 v[124:127], a[72:75], a[116:119], v[124:127]
ds_read_b128 a[188:191], v17 offset:3712
v_mov_b32 v224, 0
v_mfma_f32_16x16x32_bf16 v[124:127], a[76:79], a[112:115], v[124:127]
buffer_load_dwordx4 a[28:31], v1, s[4:7], s22 offen offset:3072 sc1
v_mfma_f32_16x16x32_bf16 v[124:127], a[80:83], a[108:111], v[124:127]
s_add_u32 s22, s78, 32768
buffer_load_dwordx4 a[32:35], v1, s[4:7], s22 offen offset:0 sc1
v_mfma_f32_16x16x32_bf16 v[124:127], a[84:87], a[104:107], v[124:127]
buffer_load_dwordx4 a[36:39], v1, s[4:7], s22 offen offset:1024 sc1
v_mfma_f32_16x16x32_bf16 v[124:127], a[88:91], a[100:103], v[124:127]
buffer_load_dwordx4 a[40:43], v1, s[4:7], s22 offen offset:2048 sc1
v_mfma_f32_16x16x32_bf16 v[124:127], a[92:95], a[96:99], v[124:127]
s_waitcnt lgkmcnt(3)
buffer_load_dwordx4 a[44:47], v1, s[4:7], s22 offen offset:3072 sc1
v_mfma_f32_16x16x32_bf16 v[96:99], a[128:131], a[160:163], v[96:99]
s_add_u32 s22, s78, 36864
ds_read_b64_tr_b16 a[64:65], v16 offset:392
v_mov_b32 v225, 0
v_mfma_f32_16x16x32_bf16 v[100:103], a[128:131], a[164:167], v[100:103]
ds_read_b64_tr_b16 a[66:67], v16 offset:384
v_mov_b32 v226, 0
v_mfma_f32_16x16x32_bf16 v[100:103], a[132:135], a[160:163], v[100:103]
ds_read_b128 a[96:99], v17 offset:64
v_mov_b32 v227, 0
v_mfma_f32_16x16x32_bf16 v[104:107], a[128:131], a[168:171], v[104:107]
ds_read_b64 v[36:37], v18 offset:0
v_mov_b32 v228, 0
v_mfma_f32_16x16x32_bf16 v[104:107], a[132:135], a[164:167], v[104:107]
ds_read_b64_tr_b16 a[68:69], v16 offset:904
v_mov_b32 v229, 0
v_mfma_f32_16x16x32_bf16 v[104:107], a[136:139], a[160:163], v[104:107]
ds_read_b64_tr_b16 a[70:71], v16 offset:896
v_mov_b32 v230, 0
v_mfma_f32_16x16x32_bf16 v[108:111], a[128:131], a[172:175], v[108:111]
ds_read_b128 a[100:103], v17 offset:576
v_mov_b32 v231, 0
v_mfma_f32_16x16x32_bf16 v[108:111], a[132:135], a[168:171], v[108:111]
ds_read_b64 v[38:39], v18 offset:512
v_mov_b32 v232, 0
v_mfma_f32_16x16x32_bf16 v[108:111], a[136:139], a[164:167], v[108:111]
ds_read_b64_tr_b16 a[72:73], v16 offset:1416
v_mov_b32 v233, 0
v_mfma_f32_16x16x32_bf16 v[108:111], a[140:143], a[160:163], v[108:111]
ds_read_b64_tr_b16 a[74:75], v16 offset:1408
v_mov_b32 v234, 0
v_mfma_f32_16x16x32_bf16 v[112:115], a[128:131], a[176:179], v[112:115]
ds_read_b128 a[104:107], v17 offset:1088
v_mov_b32 v235, 0
v_mfma_f32_16x16x32_bf16 v[112:115], a[132:135], a[172:175], v[112:115]
ds_read_b64 v[44:45], v18 offset:1024
v_mov_b32 v236, 0
v_mfma_f32_16x16x32_bf16 v[112:115], a[136:139], a[168:171], v[112:115]
ds_read_b64_tr_b16 a[76:77], v16 offset:1928
v_mov_b32 v237, 0
v_mfma_f32_16x16x32_bf16 v[112:115], a[140:143], a[164:167], v[112:115]
ds_read_b64_tr_b16 a[78:79], v16 offset:1920
v_mov_b32 v238, 0
v_mfma_f32_16x16x32_bf16 v[112:115], a[144:147], a[160:163], v[112:115]
ds_read_b128 a[108:111], v17 offset:1600
v_mov_b32 v239, 0
v_mfma_f32_16x16x32_bf16 v[116:119], a[128:131], a[180:183], v[116:119]
ds_read_b64 v[46:47], v18 offset:1536
v_mov_b32 v240, 0
v_mfma_f32_16x16x32_bf16 v[116:119], a[132:135], a[176:179], v[116:119]
ds_read_b64_tr_b16 a[80:81], v16 offset:2440
v_mov_b32 v241, 0
v_mfma_f32_16x16x32_bf16 v[116:119], a[136:139], a[172:175], v[116:119]
ds_read_b64_tr_b16 a[82:83], v16 offset:2432
v_mov_b32 v242, 0
v_mfma_f32_16x16x32_bf16 v[116:119], a[140:143], a[168:171], v[116:119]
ds_read_b128 a[112:115], v17 offset:2112
v_mov_b32 v243, 0
v_mfma_f32_16x16x32_bf16 v[116:119], a[144:147], a[164:167], v[116:119]
ds_read_b64 v[52:53], v18 offset:2048
v_mov_b32 v244, 0
v_mfma_f32_16x16x32_bf16 v[116:119], a[148:151], a[160:163], v[116:119]
ds_read_b64_tr_b16 a[84:85], v16 offset:2952
v_mov_b32 v245, 0
v_mfma_f32_16x16x32_bf16 v[120:123], a[128:131], a[184:187], v[120:123]
ds_read_b64_tr_b16 a[86:87], v16 offset:2944
v_mov_b32 v246, 0
v_mfma_f32_16x16x32_bf16 v[120:123], a[132:135], a[180:183], v[120:123]
ds_read_b128 a[116:119], v17 offset:2624
v_mov_b32 v247, 0
v_mfma_f32_16x16x32_bf16 v[120:123], a[136:139], a[176:179], v[120:123]
ds_read_b64 v[54:55], v18 offset:2560
v_mov_b32 v248, 0
v_mfma_f32_16x16x32_bf16 v[120:123], a[140:143], a[172:175], v[120:123]
ds_read_b64_tr_b16 a[88:89], v16 offset:3464
v_mov_b32 v249, 0
v_mfma_f32_16x16x32_bf16 v[120:123], a[144:147], a[168:171], v[120:123]
ds_read_b64_tr_b16 a[90:91], v16 offset:3456
v_mov_b32 v250, 0
v_mfma_f32_16x16x32_bf16 v[120:123], a[148:151], a[164:167], v[120:123]
ds_read_b128 a[120:123], v17 offset:3136
v_mov_b32 v251, 0
v_mfma_f32_16x16x32_bf16 v[120:123], a[152:155], a[160:163], v[120:123]
s_waitcnt lgkmcnt(8)
ds_read_b64 v[60:61], v18 offset:3072
v_mov_b32 v252, 0
v_mfma_f32_16x16x32_bf16 v[124:127], a[128:131], a[188:191], v[124:127]
ds_read_b64_tr_b16 a[92:93], v16 offset:3976
v_mov_b32 v253, 0
v_mfma_f32_16x16x32_bf16 v[124:127], a[132:135], a[184:187], v[124:127]
ds_read_b64_tr_b16 a[94:95], v16 offset:3968
v_mov_b32 v254, 0
v_mfma_f32_16x16x32_bf16 v[124:127], a[136:139], a[180:183], v[124:127]
ds_read_b128 a[124:127], v17 offset:3648
v_mov_b32 v255, 0
v_mfma_f32_16x16x32_bf16 v[124:127], a[140:143], a[176:179], v[124:127]
ds_read_b64 v[62:63], v18 offset:3584
v_mfma_f32_16x16x32_bf16 v[124:127], a[144:147], a[172:175], v[124:127]
buffer_load_dwordx4 a[48:51], v1, s[4:7], s22 offen offset:0 sc1
v_mfma_f32_16x16x32_bf16 v[124:127], a[148:151], a[168:171], v[124:127]
buffer_load_dwordx4 a[52:55], v1, s[4:7], s22 offen offset:1024 sc1
v_mfma_f32_16x16x32_bf16 v[124:127], a[152:155], a[164:167], v[124:127]
buffer_load_dwordx4 a[56:59], v1, s[4:7], s22 offen offset:2048 sc1
v_mfma_f32_16x16x32_bf16 v[124:127], a[156:159], a[160:163], v[124:127]
buffer_load_dwordx4 a[60:63], v1, s[4:7], s22 offen offset:3072 sc1
v_mfma_f32_16x16x32_bf16 v[96:99], a[64:67], a[96:99], v[96:99]
ds_read_b64_tr_b16 a[128:129], v16 offset:456
v_mfma_f32_16x16x32_bf16 v[100:103], a[64:67], a[100:103], v[100:103]
ds_read_b64_tr_b16 a[130:131], v16 offset:448
v_mfma_f32_16x16x32_bf16 v[100:103], a[68:71], a[96:99], v[100:103]
ds_read_b128 a[160:163], v17 offset:0
v_mfma_f32_16x16x32_bf16 v[104:107], a[64:67], a[104:107], v[104:107]
v_mfma_f32_16x16x32_bf16 v[104:107], a[68:71], a[100:103], v[104:107]
ds_read_b64_tr_b16 a[132:133], v16 offset:968
v_mfma_f32_16x16x32_bf16 v[104:107], a[72:75], a[96:99], v[104:107]
ds_read_b64_tr_b16 a[134:135], v16 offset:960
v_mfma_f32_16x16x32_bf16 v[108:111], a[64:67], a[108:111], v[108:111]
ds_read_b128 a[164:167], v17 offset:512
v_mfma_f32_16x16x32_bf16 v[108:111], a[68:71], a[104:107], v[108:111]
v_mfma_f32_16x16x32_bf16 v[108:111], a[72:75], a[100:103], v[108:111]
ds_read_b64_tr_b16 a[136:137], v16 offset:1480
v_mfma_f32_16x16x32_bf16 v[108:111], a[76:79], a[96:99], v[108:111]
ds_read_b64_tr_b16 a[138:139], v16 offset:1472
v_mfma_f32_16x16x32_bf16 v[112:115], a[64:67], a[112:115], v[112:115]
ds_read_b128 a[168:171], v17 offset:1024
v_mfma_f32_16x16x32_bf16 v[112:115], a[68:71], a[108:111], v[112:115]
v_mfma_f32_16x16x32_bf16 v[112:115], a[72:75], a[104:107], v[112:115]
ds_read_b64_tr_b16 a[140:141], v16 offset:1992
v_mfma_f32_16x16x32_bf16 v[112:115], a[76:79], a[100:103], v[112:115]
ds_read_b64_tr_b16 a[142:143], v16 offset:1984
v_mfma_f32_16x16x32_bf16 v[112:115], a[80:83], a[96:99], v[112:115]
s_waitcnt lgkmcnt(6)
ds_read_b128 a[172:175], v17 offset:1536
v_mfma_f32_16x16x32_bf16 v[116:119], a[64:67], a[116:119], v[116:119]
v_mfma_f32_16x16x32_bf16 v[116:119], a[68:71], a[112:115], v[116:119]
ds_read_b64_tr_b16 a[144:145], v16 offset:2504
v_mfma_f32_16x16x32_bf16 v[116:119], a[72:75], a[108:111], v[116:119]
ds_read_b64_tr_b16 a[146:147], v16 offset:2496
v_mfma_f32_16x16x32_bf16 v[116:119], a[76:79], a[104:107], v[116:119]
ds_read_b128 a[176:179], v17 offset:2048
v_mfma_f32_16x16x32_bf16 v[116:119], a[80:83], a[100:103], v[116:119]
v_mfma_f32_16x16x32_bf16 v[116:119], a[84:87], a[96:99], v[116:119]
ds_read_b64_tr_b16 a[148:149], v16 offset:3016
v_mfma_f32_16x16x32_bf16 v[120:123], a[64:67], a[120:123], v[120:123]
ds_read_b64_tr_b16 a[150:151], v16 offset:3008
v_mfma_f32_16x16x32_bf16 v[120:123], a[68:71], a[116:119], v[120:123]
ds_read_b128 a[180:183], v17 offset:2560
v_mfma_f32_16x16x32_bf16 v[120:123], a[72:75], a[112:115], v[120:123]
v_mfma_f32_16x16x32_bf16 v[120:123], a[76:79], a[108:111], v[120:123]
ds_read_b64_tr_b16 a[152:153], v16 offset:3528
v_mfma_f32_16x16x32_bf16 v[120:123], a[80:83], a[104:107], v[120:123]
ds_read_b64_tr_b16 a[154:155], v16 offset:3520
v_mfma_f32_16x16x32_bf16 v[120:123], a[84:87], a[100:103], v[120:123]
ds_read_b128 a[184:187], v17 offset:3072
v_mfma_f32_16x16x32_bf16 v[120:123], a[88:91], a[96:99], v[120:123]
v_mfma_f32_16x16x32_bf16 v[124:127], a[64:67], a[124:127], v[124:127]
ds_read_b64_tr_b16 a[156:157], v16 offset:4040
v_mfma_f32_16x16x32_bf16 v[124:127], a[68:71], a[120:123], v[124:127]
ds_read_b64_tr_b16 a[158:159], v16 offset:4032
v_mfma_f32_16x16x32_bf16 v[124:127], a[72:75], a[116:119], v[124:127]
ds_read_b128 a[188:191], v17 offset:3584
v_mfma_f32_16x16x32_bf16 v[124:127], a[76:79], a[112:115], v[124:127]
v_mfma_f32_16x16x32_bf16 v[124:127], a[80:83], a[108:111], v[124:127]
v_mfma_f32_16x16x32_bf16 v[124:127], a[84:87], a[104:107], v[124:127]
v_mfma_f32_16x16x32_bf16 v[124:127], a[88:91], a[100:103], v[124:127]
v_mfma_f32_16x16x32_bf16 v[124:127], a[92:95], a[96:99], v[124:127]
v_mfma_f32_16x16x32_bf16 v[96:99], a[128:131], a[160:163], v[96:99]
s_waitcnt lgkmcnt(3)
v_mfma_f32_16x16x32_bf16 v[100:103], a[128:131], a[164:167], v[100:103]
v_mfma_f32_16x16x32_bf16 v[100:103], a[132:135], a[160:163], v[100:103]
v_mfma_f32_16x16x32_bf16 v[104:107], a[128:131], a[168:171], v[104:107]
v_mfma_f32_16x16x32_bf16 v[104:107], a[132:135], a[164:167], v[104:107]
v_mfma_f32_16x16x32_bf16 v[104:107], a[136:139], a[160:163], v[104:107]
v_mfma_f32_16x16x32_bf16 v[108:111], a[128:131], a[172:175], v[108:111]
v_mfma_f32_16x16x32_bf16 v[108:111], a[132:135], a[168:171], v[108:111]
v_mfma_f32_16x16x32_bf16 v[108:111], a[136:139], a[164:167], v[108:111]
v_lshlrev_b32 v10, 16, v36
v_fmac_f32 v96, v19, v10
v_mfma_f32_16x16x32_bf16 v[108:111], a[140:143], a[160:163], v[108:111]
v_and_b32 v11, 0xffff0000, v36
v_fmac_f32 v97, v19, v11
v_mfma_f32_16x16x32_bf16 v[112:115], a[128:131], a[176:179], v[112:115]
v_lshlrev_b32 v12, 16, v37
v_fmac_f32 v98, v19, v12
v_mfma_f32_16x16x32_bf16 v[112:115], a[132:135], a[172:175], v[112:115]
v_and_b32 v13, 0xffff0000, v37
v_fmac_f32 v99, v19, v13
v_mfma_f32_16x16x32_bf16 v[112:115], a[136:139], a[168:171], v[112:115]
v_cvt_pk_bf16_f32 v96, v96, v97
v_cvt_pk_bf16_f32 v97, v98, v99
v_mfma_f32_16x16x32_bf16 v[112:115], a[140:143], a[164:167], v[112:115]
buffer_store_dwordx2 v[96:97], v8, s[4:7], s83 offen offset:0 sc1
v_mfma_f32_16x16x32_bf16 v[112:115], a[144:147], a[160:163], v[112:115]
v_lshlrev_b32 v10, 16, v38
v_fmac_f32 v100, v19, v10
v_mfma_f32_16x16x32_bf16 v[116:119], a[128:131], a[180:183], v[116:119]
v_and_b32 v11, 0xffff0000, v38
v_fmac_f32 v101, v19, v11
v_mfma_f32_16x16x32_bf16 v[116:119], a[132:135], a[176:179], v[116:119]
v_lshlrev_b32 v12, 16, v39
v_fmac_f32 v102, v19, v12
v_mfma_f32_16x16x32_bf16 v[116:119], a[136:139], a[172:175], v[116:119]
v_and_b32 v13, 0xffff0000, v39
v_fmac_f32 v103, v19, v13
v_mfma_f32_16x16x32_bf16 v[116:119], a[140:143], a[168:171], v[116:119]
v_cvt_pk_bf16_f32 v100, v100, v101
v_cvt_pk_bf16_f32 v101, v102, v103
v_mfma_f32_16x16x32_bf16 v[116:119], a[144:147], a[164:167], v[116:119]
buffer_store_dwordx2 v[100:101], v8, s[4:7], s83 offen offset:512 sc1
v_mfma_f32_16x16x32_bf16 v[116:119], a[148:151], a[160:163], v[116:119]
PAD_31:
s_cbranch_execz M_tret
v_lshlrev_b32 v10, 16, v44
v_fmac_f32 v104, v19, v10
v_mfma_f32_16x16x32_bf16 v[120:123], a[128:131], a[184:187], v[120:123]
v_and_b32 v11, 0xffff0000, v44
v_fmac_f32 v105, v19, v11
v_mfma_f32_16x16x32_bf16 v[120:123], a[132:135], a[180:183], v[120:123]
v_lshlrev_b32 v12, 16, v45
v_fmac_f32 v106, v19, v12
v_mfma_f32_16x16x32_bf16 v[120:123], a[136:139], a[176:179], v[120:123]
v_and_b32 v13, 0xffff0000, v45
v_fmac_f32 v107, v19, v13
v_mfma_f32_16x16x32_bf16 v[120:123], a[140:143], a[172:175], v[120:123]
v_cvt_pk_bf16_f32 v104, v104, v105
v_cvt_pk_bf16_f32 v105, v106, v107
v_mfma_f32_16x16x32_bf16 v[120:123], a[144:147], a[168:171], v[120:123]
buffer_store_dwordx2 v[104:105], v8, s[4:7], s83 offen offset:1024 sc1
v_mfma_f32_16x16x32_bf16 v[120:123], a[148:151], a[164:167], v[120:123]
v_lshlrev_b32 v10, 16, v46
v_fmac_f32 v108, v19, v10
v_mfma_f32_16x16x32_bf16 v[120:123], a[152:155], a[160:163], v[120:123]
s_waitcnt lgkmcnt(0)
v_and_b32 v11, 0xffff0000, v46
v_fmac_f32 v109, v19, v11
v_mfma_f32_16x16x32_bf16 v[124:127], a[128:131], a[188:191], v[124:127]
v_lshlrev_b32 v12, 16, v47
v_fmac_f32 v110, v19, v12
v_mfma_f32_16x16x32_bf16 v[124:127], a[132:135], a[184:187], v[124:127]
v_and_b32 v13, 0xffff0000, v47
v_fmac_f32 v111, v19, v13
v_mfma_f32_16x16x32_bf16 v[124:127], a[136:139], a[180:183], v[124:127]
v_cvt_pk_bf16_f32 v108, v108, v109
v_cvt_pk_bf16_f32 v109, v110, v111
v_mfma_f32_16x16x32_bf16 v[124:127], a[140:143], a[176:179], v[124:127]
buffer_store_dwordx2 v[108:109], v8, s[4:7], s83 offen offset:1536 sc1
v_mfma_f32_16x16x32_bf16 v[124:127], a[144:147], a[172:175], v[124:127]
v_lshlrev_b32 v10, 16, v52
v_fmac_f32 v112, v19, v10
v_mfma_f32_16x16x32_bf16 v[124:127], a[148:151], a[168:171], v[124:127]
v_and_b32 v11, 0xffff0000, v52
v_fmac_f32 v113, v19, v11
v_mfma_f32_16x16x32_bf16 v[124:127], a[152:155], a[164:167], v[124:127]
v_lshlrev_b32 v12, 16, v53
v_fmac_f32 v114, v19, v12
v_mfma_f32_16x16x32_bf16 v[124:127], a[156:159], a[160:163], v[124:127]
v_and_b32 v13, 0xffff0000, v53
v_fmac_f32 v115, v19, v13
v_cvt_pk_bf16_f32 v112, v112, v113
v_cvt_pk_bf16_f32 v113, v114, v115
buffer_store_dwordx2 v[112:113], v8, s[4:7], s83 offen offset:2048 sc1
v_lshlrev_b32 v10, 16, v54
v_fmac_f32 v116, v19, v10
v_and_b32 v11, 0xffff0000, v54
v_fmac_f32 v117, v19, v11
v_lshlrev_b32 v12, 16, v55
v_fmac_f32 v118, v19, v12
v_and_b32 v13, 0xffff0000, v55
v_fmac_f32 v119, v19, v13
v_cvt_pk_bf16_f32 v116, v116, v117
v_cvt_pk_bf16_f32 v117, v118, v119
buffer_store_dwordx2 v[116:117], v8, s[4:7], s83 offen offset:2560 sc1
v_lshlrev_b32 v10, 16, v60
v_fmac_f32 v120, v19, v10
v_and_b32 v11, 0xffff0000, v60
v_fmac_f32 v121, v19, v11
v_lshlrev_b32 v12, 16, v61
v_fmac_f32 v122, v19, v12
v_and_b32 v13, 0xffff0000, v61
v_fmac_f32 v123, v19, v13
v_cvt_pk_bf16_f32 v120, v120, v121
v_cvt_pk_bf16_f32 v121, v122, v123
buffer_store_dwordx2 v[120:121], v8, s[4:7], s83 offen offset:3072 sc1
v_lshlrev_b32 v10, 16, v62
v_fmac_f32 v124, v19, v10
v_and_b32 v11, 0xffff0000, v62
v_fmac_f32 v125, v19, v11
v_lshlrev_b32 v12, 16, v63
v_fmac_f32 v126, v19, v12
v_and_b32 v13, 0xffff0000, v63
v_fmac_f32 v127, v19, v13
v_cvt_pk_bf16_f32 v124, v124, v125
v_cvt_pk_bf16_f32 v125, v126, v127
buffer_store_dwordx2 v[124:125], v8, s[4:7], s83 offen offset:3584 sc1
v_lshrrev_b32 v8, 7, v1
v_and_b32 v9, 6, v8
v_lshlrev_b32 v9, 4, v9
v_and_b32 v10, 0x70, v1
v_xor_b32 v9, v9, v10
v_mul_u32_u24 v8, 896, v8
v_add_u32 v8, v8, v9
v_accvgpr_write_b32 a184, v8
v_add_u32 v8, 6144, v8
v_accvgpr_write_b32 a185, v8
v_add_u32 v8, 6144, v8
v_accvgpr_write_b32 a186, v8
v_add_u32 v8, 6144, v8
v_accvgpr_write_b32 a187, v8
v_lshrrev_b32 v8, 6, v1
v_bfe_u32 v9, v1, 7, 2
v_lshlrev_b32 v9, 5, v9
v_lshl_add_u32 v8, v8, 7, v9
v_bfe_u32 v9, v1, 4, 2
v_lshl_add_u32 v8, v9, 3, v8
v_add_u32 v8, 32768, v8
v_accvgpr_write_b32 a188, v8
v_xor_b32 v9, 32, v8
v_accvgpr_write_b32 a189, v9
v_xor_b32 v9, 64, v8
v_accvgpr_write_b32 a190, v9
v_xor_b32 v9, 96, v8
v_accvgpr_write_b32 a191, v9
s_branch M_t2B
M_t2Br:
s_waitcnt vmcnt(8)
s_barrier
s_cmp_lg_u32 s24, 0
s_cbranch_scc1 K2_item
v_accvgpr_mov_b32 a0, a192
v_accvgpr_mov_b32 a1, a193
v_accvgpr_mov_b32 a2, a194
v_accvgpr_mov_b32 a3, a195
v_accvgpr_mov_b32 a4, a196
v_accvgpr_mov_b32 a5, a197
v_accvgpr_mov_b32 a6, a198
v_accvgpr_mov_b32 a7, a199
v_accvgpr_mov_b32 a8, a200
v_accvgpr_mov_b32 a9, a201
v_accvgpr_mov_b32 a10, a202
v_accvgpr_mov_b32 a11, a203
v_accvgpr_mov_b32 a12, a204
v_accvgpr_mov_b32 a13, a205
v_accvgpr_mov_b32 a14, a206
v_accvgpr_mov_b32 a15, a207
v_accvgpr_mov_b32 a16, a208
v_accvgpr_mov_b32 a17, a209
v_accvgpr_mov_b32 a18, a210
v_accvgpr_mov_b32 a19, a211
v_accvgpr_mov_b32 a20, a212
v_accvgpr_mov_b32 a21, a213
v_accvgpr_mov_b32 a22, a214
v_accvgpr_mov_b32 a23, a215
v_accvgpr_mov_b32 a24, a216
v_accvgpr_mov_b32 a25, a217
v_accvgpr_mov_b32 a26, a218
v_accvgpr_mov_b32 a27, a219
v_accvgpr_mov_b32 a28, a220
v_accvgpr_mov_b32 a29, a221
v_accvgpr_mov_b32 a30, a222
v_accvgpr_mov_b32 a31, a223
v_accvgpr_mov_b32 a32, a224
v_accvgpr_mov_b32 a33, a225
v_accvgpr_mov_b32 a34, a226
v_accvgpr_mov_b32 a35, a227
v_accvgpr_mov_b32 a36, a228
v_accvgpr_mov_b32 a37, a229
v_accvgpr_mov_b32 a38, a230
v_accvgpr_mov_b32 a39, a231
v_accvgpr_mov_b32 a40, a232
v_accvgpr_mov_b32 a41, a233
v_accvgpr_mov_b32 a42, a234
v_accvgpr_mov_b32 a43, a235
v_accvgpr_mov_b32 a44, a236
v_accvgpr_mov_b32 a45, a237
v_accvgpr_mov_b32 a46, a238
v_accvgpr_mov_b32 a47, a239
v_accvgpr_mov_b32 a48, a240
v_accvgpr_mov_b32 a49, a241
v_accvgpr_mov_b32 a50, a242
v_accvgpr_mov_b32 a51, a243
v_accvgpr_mov_b32 a52, a244
v_accvgpr_mov_b32 a53, a245
v_accvgpr_mov_b32 a54, a246
v_accvgpr_mov_b32 a55, a247
v_accvgpr_mov_b32 a56, a248
v_accvgpr_mov_b32 a57, a249
v_accvgpr_mov_b32 a58, a250
v_accvgpr_mov_b32 a59, a251
v_accvgpr_mov_b32 a60, a252
v_accvgpr_mov_b32 a61, a253
v_accvgpr_mov_b32 a62, a254
v_accvgpr_mov_b32 a63, a255
s_branch K2_item
M_cend:
M_cspin:
Lp_16:
buffer_load_dword v14, v15, s[4:7], s31 offen sc1
s_waitcnt vmcnt(0)
v_cmp_gt_u32 vcc, 1, v14
s_cbranch_vccz Lpd_17
s_sleep 8
s_sub_u32 s101, s101, 1
s_cbranch_scc0 Lp_16
s_mov_b32 s101, 0
Lpd_17:
s_branch M_cok
M_kspin:
Lp_18:
buffer_load_dword v21, v20, s[4:7], s70 offen sc1
s_waitcnt vmcnt(0)
v_cmp_gt_u32 vcc, 1, v21
s_cbranch_vccz Lpd_19
s_sleep 8
s_sub_u32 s101, s101, 1
s_cbranch_scc0 Lp_18
s_mov_b32 s101, 0
Lpd_19:
s_branch M_kok
M_kspin2:
Lp_20:
buffer_load_dword v21, v20, s[4:7], s31 offen sc1
s_waitcnt vmcnt(0)
v_cmp_gt_u32 vcc, 1, v21
s_cbranch_vccz Lpd_21
s_sleep 8
s_sub_u32 s101, s101, 1
s_cbranch_scc0 Lp_20
s_mov_b32 s101, 0
Lpd_21:
s_branch M_kok2
M_vspin:
Lp_22:
buffer_load_dword v21, v15, s[4:7], s70 offen sc1
s_waitcnt vmcnt(0)
v_cmp_gt_u32 vcc, 1, v21
s_cbranch_vccz Lpd_23
s_sleep 8
s_sub_u32 s101, s101, 1
s_cbranch_scc0 Lp_22
s_mov_b32 s101, 0
Lpd_23:
s_branch M_vok
PAD_32:
s_cbranch_execz M_tret
K2_plain:
v_mfma_f32_16x16x32_bf16 v[128:131], a[64:67], v[96:99], v[128:131]
s_waitcnt lgkmcnt(6)
ds_read_b128 a[96:99], v2 offset:8192
v_add_f32 v24, v24, v26
v_mfma_f32_16x16x32_bf16 v[128:131], a[68:71], v[100:103], v[128:131]
s_waitcnt lgkmcnt(5)
v_mfma_f32_16x16x32_bf16 v[132:135], a[68:71], v[108:111], v[132:135]
s_mov_b64 s[36:37], s[86:87]
ds_read_b128 a[100:103], v2 offset:9216
v_add_f32 v25, v25, v27
v_mfma_f32_16x16x32_bf16 v[132:135], a[64:67], v[104:107], v[132:135]
s_mov_b32 s38, 3670016
v_exp_f32 v8, v68
v_mfma_f32_16x16x32_bf16 v[136:139], a[72:75], v[96:99], v[136:139]
s_mov_b32 s39, 0x20000
ds_read_b128 a[104:107], v2 offset:10240
v_accvgpr_read_b32 v112, a184
v_mfma_f32_16x16x32_bf16 v[136:139], a[76:79], v[100:103], v[136:139]
v_accvgpr_read_b32 v113, a185
v_accvgpr_read_b32 v114, a186
v_mfma_f32_16x16x32_bf16 v[140:143], a[76:79], v[108:111], v[140:143]
ds_read_b128 a[108:111], v2 offset:11264
v_accvgpr_read_b32 v115, a187
v_mfma_f32_16x16x32_bf16 v[140:143], a[72:75], v[104:107], v[140:143]
s_waitcnt lgkmcnt(5)
v_accvgpr_read_b32 v116, a188
v_accvgpr_read_b32 v117, a189
v_mfma_f32_16x16x32_bf16 v[144:147], a[80:83], v[96:99], v[144:147]
ds_read_b128 a[112:115], v2 offset:12288
v_accvgpr_read_b32 v118, a190
v_mfma_f32_16x16x32_bf16 v[144:147], a[84:87], v[100:103], v[144:147]
v_accvgpr_read_b32 v119, a191
v_mfma_f32_16x16x32_bf16 v[148:151], a[84:87], v[108:111], v[148:151]
s_add_u32 m0, s18, 32768
ds_read_b128 a[116:119], v2 offset:13312
v_cvt_pk_bf16_f32 v128, v128, v129
v_mfma_f32_16x16x32_bf16 v[148:151], a[80:83], v[104:107], v[148:151]
buffer_load_dwordx4 v112, s[36:39], s81 offen offset:0 lds
v_mfma_f32_16x16x32_bf16 v[152:155], a[88:91], v[96:99], v[152:155]
s_waitcnt lgkmcnt(4)
ds_read_b128 a[120:123], v2 offset:14336
v_cvt_pk_bf16_f32 v129, v130, v131
v_mfma_f32_16x16x32_bf16 v[152:155], a[92:95], v[100:103], v[152:155]
v_exp_f32 v9, v69
v_mfma_f32_16x16x32_bf16 v[156:159], a[92:95], v[108:111], v[156:159]
ds_read_b128 a[124:127], v2 offset:15360
v_add_f32 v27, v8, v9
v_mfma_f32_16x16x32_bf16 v[156:159], a[88:91], v[104:107], v[156:159]
buffer_load_dwordx4 v113, s[36:39], s81 offen offset:1024 lds
v_mfma_f32_16x16x32_bf16 v[160:163], a[96:99], v[96:99], v[160:163]
ds_read_b128 a[64:67], v2 offset:16384
v_cvt_pk_bf16_f32 v120, v8, v9
v_mfma_f32_16x16x32_bf16 v[160:163], a[100:103], v[100:103], v[160:163]
v_exp_f32 v10, v70
v_mfma_f32_16x16x32_bf16 v[164:167], a[100:103], v[108:111], v[164:167]
ds_read_b128 a[68:71], v2 offset:17408
v_add_f32 v27, v27, v10
v_mfma_f32_16x16x32_bf16 v[164:167], a[96:99], v[104:107], v[164:167]
s_waitcnt lgkmcnt(4)
buffer_load_dwordx4 v114, s[36:39], s81 offen offset:2048 lds
v_mfma_f32_16x16x32_bf16 v[168:171], a[104:107], v[96:99], v[168:171]
ds_read_b128 a[72:75], v2 offset:18432
v_cvt_pk_bf16_f32 v130, v136, v137
v_mfma_f32_16x16x32_bf16 v[168:171], a[108:111], v[100:103], v[168:171]
v_exp_f32 v11, v71
v_mfma_f32_16x16x32_bf16 v[172:175], a[108:111], v[108:111], v[172:175]
ds_read_b128 a[76:79], v2 offset:19456
v_add_f32 v27, v27, v11
v_mfma_f32_16x16x32_bf16 v[172:175], a[104:107], v[104:107], v[172:175]
buffer_load_dwordx4 v115, s[36:39], s81 offen offset:3072 lds
v_mfma_f32_16x16x32_bf16 v[176:179], a[112:115], v[96:99], v[176:179]
ds_read_b128 a[80:83], v2 offset:20480
v_cvt_pk_bf16_f32 v121, v10, v11
v_mfma_f32_16x16x32_bf16 v[176:179], a[116:119], v[100:103], v[176:179]
s_waitcnt lgkmcnt(4)
v_exp_f32 v12, v76
v_mfma_f32_16x16x32_bf16 v[180:183], a[116:119], v[108:111], v[180:183]
s_add_u32 s81, s81, 28672
ds_read_b128 a[84:87], v2 offset:21504
v_add_f32 v27, v27, v12
v_mfma_f32_16x16x32_bf16 v[180:183], a[112:115], v[104:107], v[180:183]
s_add_u32 m0, s18, 36864
v_exp_f32 v13, v77
v_mfma_f32_16x16x32_bf16 v[184:187], a[120:123], v[96:99], v[184:187]
ds_read_b128 a[88:91], v2 offset:22528
v_add_f32 v27, v27, v13
v_mfma_f32_16x16x32_bf16 v[184:187], a[124:127], v[100:103], v[184:187]
buffer_load_dwordx4 v112, s[36:39], s81 offen offset:0 lds
v_mfma_f32_16x16x32_bf16 v[188:191], a[124:127], v[108:111], v[188:191]
ds_read_b128 a[92:95], v2 offset:23552
v_cvt_pk_bf16_f32 v122, v12, v13
v_mfma_f32_16x16x32_bf16 v[188:191], a[120:123], v[104:107], v[188:191]
v_exp_f32 v14, v78
v_mfma_f32_16x16x32_bf16 v[192:195], a[64:67], v[96:99], v[192:195]
s_waitcnt lgkmcnt(4)
ds_read_b128 a[96:99], v2 offset:24576
v_add_f32 v27, v27, v14
v_mfma_f32_16x16x32_bf16 v[192:195], a[68:71], v[100:103], v[192:195]
buffer_load_dwordx4 v113, s[36:39], s81 offen offset:1024 lds
v_mfma_f32_16x16x32_bf16 v[196:199], a[68:71], v[108:111], v[196:199]
ds_read_b128 a[100:103], v2 offset:25600
v_cvt_pk_bf16_f32 v131, v138, v139
v_mfma_f32_16x16x32_bf16 v[196:199], a[64:67], v[104:107], v[196:199]
v_exp_f32 v15, v79
v_mfma_f32_16x16x32_bf16 v[200:203], a[72:75], v[96:99], v[200:203]
ds_read_b128 a[104:107], v2 offset:26624
v_add_f32 v27, v27, v15
v_mfma_f32_16x16x32_bf16 v[200:203], a[76:79], v[100:103], v[200:203]
buffer_load_dwordx4 v114, s[36:39], s81 offen offset:2048 lds
v_mfma_f32_16x16x32_bf16 v[204:207], a[76:79], v[108:111], v[204:207]
ds_read_b128 a[108:111], v2 offset:27648
v_cvt_pk_bf16_f32 v123, v14, v15
v_mfma_f32_16x16x32_bf16 v[204:207], a[72:75], v[104:107], v[204:207]
s_waitcnt lgkmcnt(4)
v_exp_f32 v8, v84
v_mfma_f32_16x16x32_bf16 v[208:211], a[80:83], v[96:99], v[208:211]
ds_read_b128 a[112:115], v2 offset:28672
v_add_f32 v27, v27, v8
v_mfma_f32_16x16x32_bf16 v[208:211], a[84:87], v[100:103], v[208:211]
buffer_load_dwordx4 v115, s[36:39], s81 offen offset:3072 lds
v_mfma_f32_16x16x32_bf16 v[212:215], a[84:87], v[108:111], v[212:215]
ds_read_b128 a[116:119], v2 offset:29696
v_cvt_pk_bf16_f32 v144, v144, v145
v_mfma_f32_16x16x32_bf16 v[212:215], a[80:83], v[104:107], v[212:215]
v_exp_f32 v9, v85
v_mfma_f32_16x16x32_bf16 v[216:219], a[88:91], v[96:99], v[216:219]
s_sub_u32 s81, s81, 28544
ds_read_b128 a[120:123], v2 offset:30720
v_add_f32 v27, v27, v9
v_mfma_f32_16x16x32_bf16 v[216:219], a[92:95], v[100:103], v[216:219]
v_exp_f32 v10, v86
v_mfma_f32_16x16x32_bf16 v[220:223], a[92:95], v[108:111], v[220:223]
s_waitcnt vmcnt(8) lgkmcnt(4)
ds_read_b128 a[124:127], v2 offset:31744
v_cvt_pk_bf16_f32 v124, v8, v9
v_mfma_f32_16x16x32_bf16 v[220:223], a[88:91], v[104:107], v[220:223]
s_barrier
v_mfma_f32_16x16x32_bf16 v[224:227], a[96:99], v[96:99], v[224:227]
ds_read_b128 a[64:67], v1 offset:0
v_add_f32 v27, v27, v10
v_mfma_f32_16x16x32_bf16 v[224:227], a[100:103], v[100:103], v[224:227]
v_exp_f32 v11, v87
v_mfma_f32_16x16x32_bf16 v[228:231], a[100:103], v[108:111], v[228:231]
ds_read_b128 a[68:71], v1 offset:1024
v_add_f32 v27, v27, v11
v_mfma_f32_16x16x32_bf16 v[228:231], a[96:99], v[104:107], v[228:231]
v_exp_f32 v12, v92
v_mfma_f32_16x16x32_bf16 v[232:235], a[104:107], v[96:99], v[232:235]
s_waitcnt lgkmcnt(4)
ds_read_b128 a[72:75], v1 offset:2048
v_cvt_pk_bf16_f32 v125, v10, v11
v_mfma_f32_16x16x32_bf16 v[232:235], a[108:111], v[100:103], v[232:235]
v_exp_f32 v13, v93
v_mfma_f32_16x16x32_bf16 v[236:239], a[108:111], v[108:111], v[236:239]
ds_read_b128 a[76:79], v1 offset:3072
v_add_f32 v27, v27, v12
v_mfma_f32_16x16x32_bf16 v[236:239], a[104:107], v[104:107], v[236:239]
v_exp_f32 v14, v94
v_mfma_f32_16x16x32_bf16 v[240:243], a[112:115], v[96:99], v[240:243]
ds_read_b128 a[80:83], v1 offset:4096
v_add_f32 v27, v27, v13
v_mfma_f32_16x16x32_bf16 v[240:243], a[116:119], v[100:103], v[240:243]
v_exp_f32 v15, v95
v_mfma_f32_16x16x32_bf16 v[244:247], a[116:119], v[108:111], v[244:247]
ds_read_b128 a[84:87], v1 offset:5120
v_cvt_pk_bf16_f32 v126, v12, v13
v_mfma_f32_16x16x32_bf16 v[244:247], a[112:115], v[104:107], v[244:247]
s_waitcnt lgkmcnt(4)
v_add_f32 v27, v27, v14
v_add_f32 v27, v27, v15
v_mfma_f32_16x16x32_bf16 v[248:251], a[120:123], v[96:99], v[248:251]
ds_read_b128 a[88:91], v1 offset:6144
v_cvt_pk_bf16_f32 v127, v14, v15
v_mfma_f32_16x16x32_bf16 v[248:251], a[124:127], v[100:103], v[248:251]
v_cmp_nge_f32 vcc, s25, v27
v_cvt_pk_bf16_f32 v145, v146, v147
v_mfma_f32_16x16x32_bf16 v[252:255], a[124:127], v[108:111], v[252:255]
ds_read_b128 a[92:95], v1 offset:7168
v_cvt_pk_bf16_f32 v146, v152, v153
v_mfma_f32_16x16x32_bf16 v[252:255], a[120:123], v[104:107], v[252:255]
s_waitcnt lgkmcnt(2)
v_cvt_pk_bf16_f32 v147, v154, v155
v_cvt_pk_bf16_f32 v160, v160, v161
s_cbranch_vccnz Lstub_12
Lback_13:
v_mfma_f32_16x16x32_bf16 v[132:135], a[64:67], v[120:123], v[132:135]
s_lshl_b32 s8, s29, 3
ds_read_b128 a[96:99], v1 offset:8192
v_add_f32 v25, v25, v27
v_mfma_f32_16x16x32_bf16 v[132:135], a[68:71], v[124:127], v[132:135]
s_add_u32 s8, s8, s3
ds_read_b128 a[100:103], v1 offset:9216
v_cvt_pk_bf16_f32 v161, v162, v163
v_mfma_f32_16x16x32_bf16 v[140:143], a[72:75], v[120:123], v[140:143]
s_lshl_b32 s8, s8, 4
ds_read_b128 a[104:107], v1 offset:10240
v_cvt_pk_bf16_f32 v162, v168, v169
v_mfma_f32_16x16x32_bf16 v[140:143], a[76:79], v[124:127], v[140:143]
s_add_u32 s8, s8, s20
ds_read_b128 a[108:111], v1 offset:11264
v_cvt_pk_bf16_f32 v163, v170, v171
v_mfma_f32_16x16x32_bf16 v[148:151], a[80:83], v[120:123], v[148:151]
s_mul_i32 s8, s8, 14336
ds_read_b128 a[112:115], v1 offset:12288
v_cvt_pk_bf16_f32 v176, v176, v177
v_mfma_f32_16x16x32_bf16 v[148:151], a[84:87], v[124:127], v[148:151]
s_waitcnt lgkmcnt(5)
s_add_u32 s8, s8, 104857600
ds_read_b128 a[116:119], v1 offset:13312
v_cvt_pk_bf16_f32 v177, v178, v179
v_mfma_f32_16x16x32_bf16 v[156:159], a[88:91], v[120:123], v[156:159]
s_add_u32 s12, s8, 917504
ds_read_b128 a[120:123], v1 offset:14336
v_cvt_pk_bf16_f32 v178, v184, v185
v_mfma_f32_16x16x32_bf16 v[156:159], a[92:95], v[124:127], v[156:159]
s_waitcnt lgkmcnt(6)
ds_read_b128 a[124:127], v1 offset:15360
v_cvt_pk_bf16_f32 v179, v186, v187
v_mfma_f32_16x16x32_bf16 v[164:167], a[96:99], v[120:123], v[164:167]
s_waitcnt lgkmcnt(6)
ds_read_b128 a[64:67], v1 offset:16384
v_cvt_pk_bf16_f32 v192, v192, v193
v_mfma_f32_16x16x32_bf16 v[164:167], a[100:103], v[124:127], v[164:167]
s_waitcnt lgkmcnt(6)
ds_read_b128 a[68:71], v1 offset:17408
v_cvt_pk_bf16_f32 v193, v194, v195
v_mfma_f32_16x16x32_bf16 v[172:175], a[104:107], v[120:123], v[172:175]
s_waitcnt lgkmcnt(6)
ds_read_b128 a[72:75], v1 offset:18432
v_cvt_pk_bf16_f32 v194, v200, v201
v_mfma_f32_16x16x32_bf16 v[172:175], a[108:111], v[124:127], v[172:175]
s_waitcnt lgkmcnt(6)
ds_read_b128 a[76:79], v1 offset:19456
v_cvt_pk_bf16_f32 v195, v202, v203
v_mfma_f32_16x16x32_bf16 v[180:183], a[112:115], v[120:123], v[180:183]
s_waitcnt lgkmcnt(6)
ds_read_b128 a[80:83], v1 offset:20480
v_cvt_pk_bf16_f32 v208, v208, v209
v_mfma_f32_16x16x32_bf16 v[180:183], a[116:119], v[124:127], v[180:183]
s_waitcnt lgkmcnt(6)
ds_read_b128 a[84:87], v1 offset:21504
v_cvt_pk_bf16_f32 v209, v210, v211
v_mfma_f32_16x16x32_bf16 v[188:191], a[120:123], v[120:123], v[188:191]
s_waitcnt lgkmcnt(6)
ds_read_b128 a[88:91], v1 offset:22528
v_cvt_pk_bf16_f32 v210, v216, v217
v_mfma_f32_16x16x32_bf16 v[188:191], a[124:127], v[124:127], v[188:191]
s_waitcnt lgkmcnt(6)
ds_read_b128 a[92:95], v1 offset:23552
v_cvt_pk_bf16_f32 v211, v218, v219
v_mfma_f32_16x16x32_bf16 v[196:199], a[64:67], v[120:123], v[196:199]
s_waitcnt lgkmcnt(6)
ds_read_b128 a[96:99], v1 offset:24576
v_cvt_pk_bf16_f32 v224, v224, v225
v_mfma_f32_16x16x32_bf16 v[196:199], a[68:71], v[124:127], v[196:199]
s_waitcnt lgkmcnt(6)
ds_read_b128 a[100:103], v1 offset:25600
v_cvt_pk_bf16_f32 v225, v226, v227
v_mfma_f32_16x16x32_bf16 v[204:207], a[72:75], v[120:123], v[204:207]
s_waitcnt lgkmcnt(6)
ds_read_b128 a[104:107], v1 offset:26624
v_cvt_pk_bf16_f32 v226, v232, v233
v_mfma_f32_16x16x32_bf16 v[204:207], a[76:79], v[124:127], v[204:207]
s_waitcnt lgkmcnt(6)
ds_read_b128 a[108:111], v1 offset:27648
v_cvt_pk_bf16_f32 v227, v234, v235
v_mfma_f32_16x16x32_bf16 v[212:215], a[80:83], v[120:123], v[212:215]
s_waitcnt lgkmcnt(6)
ds_read_b128 a[112:115], v1 offset:28672
v_cvt_pk_bf16_f32 v240, v240, v241
v_mfma_f32_16x16x32_bf16 v[212:215], a[84:87], v[124:127], v[212:215]
s_waitcnt lgkmcnt(5)
ds_read_b128 a[116:119], v1 offset:29696
v_cvt_pk_bf16_f32 v241, v242, v243
v_mfma_f32_16x16x32_bf16 v[220:223], a[88:91], v[120:123], v[220:223]
s_add_u32 m0, s18, 98304
ds_read_b128 a[120:123], v1 offset:30720
v_cvt_pk_bf16_f32 v242, v248, v249
v_mfma_f32_16x16x32_bf16 v[220:223], a[92:95], v[124:127], v[220:223]
s_waitcnt lgkmcnt(6)
ds_read_b128 a[124:127], v1 offset:31744
v_cvt_pk_bf16_f32 v243, v250, v251
v_mfma_f32_16x16x32_bf16 v[228:231], a[96:99], v[120:123], v[228:231]
s_waitcnt lgkmcnt(6)
buffer_load_dwordx4 v112, s[36:39], s81 offen offset:0 lds
v_mfma_f32_16x16x32_bf16 v[228:231], a[100:103], v[124:127], v[228:231]
s_waitcnt lgkmcnt(5)
buffer_load_dwordx4 v113, s[36:39], s81 offen offset:1024 lds
v_mfma_f32_16x16x32_bf16 v[236:239], a[104:107], v[120:123], v[236:239]
s_waitcnt lgkmcnt(4)
buffer_load_dwordx4 v114, s[36:39], s81 offen offset:2048 lds
v_mfma_f32_16x16x32_bf16 v[236:239], a[108:111], v[124:127], v[236:239]
s_waitcnt lgkmcnt(1)
buffer_load_dwordx4 v115, s[36:39], s81 offen offset:3072 lds
v_mfma_f32_16x16x32_bf16 v[244:247], a[112:115], v[120:123], v[244:247]
s_add_u32 s81, s81, 28672
v_cvt_pk_bf16_f32 v132, v132, v133
v_cvt_pk_bf16_f32 v133, v134, v135
v_mfma_f32_16x16x32_bf16 v[244:247], a[116:119], v[124:127], v[244:247]
s_add_u32 m0, s18, 102400
v_cvt_pk_bf16_f32 v134, v140, v141
v_cvt_pk_bf16_f32 v135, v142, v143
v_mfma_f32_16x16x32_bf16 v[252:255], a[120:123], v[120:123], v[252:255]
s_waitcnt lgkmcnt(0)
buffer_load_dwordx4 v112, s[36:39], s81 offen offset:0 lds
v_mfma_f32_16x16x32_bf16 v[252:255], a[124:127], v[124:127], v[252:255]
buffer_load_dwordx4 v113, s[36:39], s81 offen offset:1024 lds
buffer_load_dwordx4 v114, s[36:39], s81 offen offset:2048 lds
buffer_load_dwordx4 v115, s[36:39], s81 offen offset:3072 lds
s_sub_u32 s81, s81, 28544
s_add_u32 m0, s18, 131072
s_nop 0
buffer_load_dwordx4 v112, s[36:39], s81 offen offset:0 lds
v_cvt_pk_bf16_f32 v148, v148, v149
v_cvt_pk_bf16_f32 v149, v150, v151
v_cvt_pk_bf16_f32 v150, v156, v157
v_cvt_pk_bf16_f32 v151, v158, v159
buffer_load_dwordx4 v113, s[36:39], s81 offen offset:1024 lds
v_cvt_pk_bf16_f32 v164, v164, v165
v_cvt_pk_bf16_f32 v165, v166, v167
v_cvt_pk_bf16_f32 v166, v172, v173
v_cvt_pk_bf16_f32 v167, v174, v175
buffer_load_dwordx4 v114, s[36:39], s81 offen offset:2048 lds
v_cvt_pk_bf16_f32 v180, v180, v181
v_cvt_pk_bf16_f32 v181, v182, v183
v_cvt_pk_bf16_f32 v182, v188, v189
v_cvt_pk_bf16_f32 v183, v190, v191
buffer_load_dwordx4 v115, s[36:39], s81 offen offset:3072 lds
v_cvt_pk_bf16_f32 v196, v196, v197
v_cvt_pk_bf16_f32 v197, v198, v199
v_cvt_pk_bf16_f32 v198, v204, v205
v_cvt_pk_bf16_f32 v199, v206, v207
s_add_u32 s81, s81, 28672
s_add_u32 m0, s18, 135168
s_nop 0
buffer_load_dwordx4 v112, s[36:39], s81 offen offset:0 lds
v_cvt_pk_bf16_f32 v212, v212, v213
v_cvt_pk_bf16_f32 v213, v214, v215
v_cvt_pk_bf16_f32 v214, v220, v221
v_cvt_pk_bf16_f32 v215, v222, v223
buffer_load_dwordx4 v113, s[36:39], s81 offen offset:1024 lds
v_cvt_pk_bf16_f32 v228, v228, v229
v_cvt_pk_bf16_f32 v229, v230, v231
v_cvt_pk_bf16_f32 v230, v236, v237
v_cvt_pk_bf16_f32 v231, v238, v239
buffer_load_dwordx4 v114, s[36:39], s81 offen offset:2048 lds
v_cvt_pk_bf16_f32 v244, v244, v245
v_cvt_pk_bf16_f32 v245, v246, v247
v_cvt_pk_bf16_f32 v246, v252, v253
v_cvt_pk_bf16_f32 v247, v254, v255
buffer_load_dwordx4 v115, s[36:39], s81 offen offset:3072 lds
s_sub_u32 s81, s81, 28544
s_branch K2_done
K2_cfix:
s_nop 7
v_max_f32 v12, 0, v8
v_exp_f32 v13, -v12
v_sub_f32 v8, v8, v12
v_mul_f32 v24, v24, v13
v_mul_f32 v128, v128, v13
v_mul_f32 v129, v129, v13
v_mul_f32 v130, v130, v13
v_mul_f32 v131, v131, v13
v_mul_f32 v136, v136, v13
v_mul_f32 v137, v137, v13
v_mul_f32 v138, v138, v13
v_mul_f32 v139, v139, v13
v_mul_f32 v144, v144, v13
v_mul_f32 v145, v145, v13
v_mul_f32 v146, v146, v13
v_mul_f32 v147, v147, v13
v_mul_f32 v152, v152, v13
v_mul_f32 v153, v153, v13
v_mul_f32 v154, v154, v13
v_mul_f32 v155, v155, v13
v_mul_f32 v160, v160, v13
v_mul_f32 v161, v161, v13
v_mul_f32 v162, v162, v13
v_mul_f32 v163, v163, v13
v_mul_f32 v168, v168, v13
v_mul_f32 v169, v169, v13
v_mul_f32 v170, v170, v13
v_mul_f32 v171, v171, v13
v_mul_f32 v176, v176, v13
v_mul_f32 v177, v177, v13
v_mul_f32 v178, v178, v13
v_mul_f32 v179, v179, v13
v_mul_f32 v184, v184, v13
v_mul_f32 v185, v185, v13
v_mul_f32 v186, v186, v13
v_mul_f32 v187, v187, v13
v_mul_f32 v192, v192, v13
v_mul_f32 v193, v193, v13
v_mul_f32 v194, v194, v13
v_mul_f32 v195, v195, v13
v_mul_f32 v200, v200, v13
v_mul_f32 v201, v201, v13
v_mul_f32 v202, v202, v13
v_mul_f32 v203, v203, v13
v_mul_f32 v208, v208, v13
v_mul_f32 v209, v209, v13
v_mul_f32 v210, v210, v13
v_mul_f32 v211, v211, v13
v_mul_f32 v216, v216, v13
v_mul_f32 v217, v217, v13
v_mul_f32 v218, v218, v13
v_mul_f32 v219, v219, v13
v_mul_f32 v224, v224, v13
v_mul_f32 v225, v225, v13
v_mul_f32 v226, v226, v13
v_mul_f32 v227, v227, v13
v_mul_f32 v232, v232, v13
v_mul_f32 v233, v233, v13
v_mul_f32 v234, v234, v13
v_mul_f32 v235, v235, v13
v_mul_f32 v240, v240, v13
v_mul_f32 v241, v241, v13
v_mul_f32 v242, v242, v13
v_mul_f32 v243, v243, v13
v_mul_f32 v248, v248, v13
v_mul_f32 v249, v249, v13
v_mul_f32 v250, v250, v13
v_mul_f32 v251, v251, v13
v_max_f32 v12, 0, v10
v_exp_f32 v13, -v12
v_sub_f32 v10, v10, v12
v_mul_f32 v25, v25, v13
v_mul_f32 v132, v132, v13
v_mul_f32 v133, v133, v13
v_mul_f32 v134, v134, v13
v_mul_f32 v135, v135, v13
v_mul_f32 v140, v140, v13
v_mul_f32 v141, v141, v13
v_mul_f32 v142, v142, v13
v_mul_f32 v143, v143, v13
v_mul_f32 v148, v148, v13
v_mul_f32 v149, v149, v13
v_mul_f32 v150, v150, v13
v_mul_f32 v151, v151, v13
v_mul_f32 v156, v156, v13
v_mul_f32 v157, v157, v13
v_mul_f32 v158, v158, v13
v_mul_f32 v159, v159, v13
v_mul_f32 v164, v164, v13
v_mul_f32 v165, v165, v13
v_mul_f32 v166, v166, v13
v_mul_f32 v167, v167, v13
v_mul_f32 v172, v172, v13
v_mul_f32 v173, v173, v13
v_mul_f32 v174, v174, v13
v_mul_f32 v175, v175, v13
v_mul_f32 v180, v180, v13
v_mul_f32 v181, v181, v13
v_mul_f32 v182, v182, v13
v_mul_f32 v183, v183, v13
v_mul_f32 v188, v188, v13
v_mul_f32 v189, v189, v13
v_mul_f32 v190, v190, v13
v_mul_f32 v191, v191, v13
v_mul_f32 v196, v196, v13
v_mul_f32 v197, v197, v13
v_mul_f32 v198, v198, v13
v_mul_f32 v199, v199, v13
v_mul_f32 v204, v204, v13
v_mul_f32 v205, v205, v13
v_mul_f32 v206, v206, v13
v_mul_f32 v207, v207, v13
v_mul_f32 v212, v212, v13
v_mul_f32 v213, v213, v13
v_mul_f32 v214, v214, v13
v_mul_f32 v215, v215, v13
v_mul_f32 v220, v220, v13
v_mul_f32 v221, v221, v13
v_mul_f32 v222, v222, v13
v_mul_f32 v223, v223, v13
v_mul_f32 v228, v228, v13
v_mul_f32 v229, v229, v13
v_mul_f32 v230, v230, v13
v_mul_f32 v231, v231, v13
v_mul_f32 v236, v236, v13
v_mul_f32 v237, v237, v13
v_mul_f32 v238, v238, v13
v_mul_f32 v239, v239, v13
v_mul_f32 v244, v244, v13
v_mul_f32 v245, v245, v13
v_mul_f32 v246, v246, v13
v_mul_f32 v247, v247, v13
v_mul_f32 v252, v252, v13
v_mul_f32 v253, v253, v13
v_mul_f32 v254, v254, v13
v_mul_f32 v255, v255, v13
s_branch K2_cok
K2_tspin:
Lp_9101:
buffer_load_dword v3, off, s[4:7], s80 sc1
s_waitcnt vmcnt(0)
v_cmp_gt_u32 vcc, 1, v3
s_cbranch_vccz Lpd_9102
s_sleep 8
s_sub_u32 s101, s101, 1
s_cbranch_scc0 Lp_9101
s_mov_b32 s101, 0
Lpd_9102:
s_branch K2_tok
K2_p0d:
ds_read_b128 a[64:67], v1 offset:0
ds_read_b128 a[68:71], v1 offset:1024
ds_read_b128 a[72:75], v1 offset:2048
ds_read_b128 a[76:79], v1 offset:3072
ds_read_b128 a[80:83], v1 offset:4096
ds_read_b128 a[84:87], v1 offset:5120
ds_read_b128 a[88:91], v1 offset:6144
ds_read_b128 a[92:95], v1 offset:7168
v_cndmask_b32 v32, 0, v7, s[32:33]
v_cndmask_b32 v33, 0, v7, s[34:35]
v_cndmask_b32 v34, 0, v7, s[36:37]
v_cndmask_b32 v35, 0, v7, s[38:39]
v_cndmask_b32 v40, 0, v7, s[40:41]
v_cndmask_b32 v41, 0, v7, s[42:43]
v_cndmask_b32 v42, 0, v7, s[44:45]
v_cndmask_b32 v43, 0, v7, s[46:47]
s_waitcnt lgkmcnt(7)
v_mfma_f32_16x16x32_bf16 v[32:35], a[64:67], a[0:3], v[32:35]
s_waitcnt lgkmcnt(6)
s_add_u32 m0, s18, 65536
ds_read_b128 a[96:99], v1 offset:8192
v_mfma_f32_16x16x32_bf16 v[32:35], a[68:71], a[4:7], v[32:35]
s_waitcnt lgkmcnt(6)
buffer_load_dwordx4 v1, s[4:7], s12 offen offset:0 sc1 lds
v_mfma_f32_16x16x32_bf16 v[32:35], a[72:75], a[8:11], v[32:35]
s_waitcnt lgkmcnt(5)
ds_read_b128 a[100:103], v1 offset:9216
v_mfma_f32_16x16x32_bf16 v[32:35], a[76:79], a[12:15], v[32:35]
s_waitcnt lgkmcnt(5)
buffer_load_dwordx4 v1, s[4:7], s12 offen offset:1024 sc1 lds
v_mfma_f32_16x16x32_bf16 v[32:35], a[80:83], a[16:19], v[32:35]
s_waitcnt lgkmcnt(4)
ds_read_b128 a[104:107], v1 offset:10240
v_mfma_f32_16x16x32_bf16 v[32:35], a[84:87], a[20:23], v[32:35]
s_waitcnt lgkmcnt(4)
buffer_load_dwordx4 v1, s[4:7], s12 offen offset:2048 sc1 lds
v_mfma_f32_16x16x32_bf16 v[32:35], a[88:91], a[24:27], v[32:35]
s_waitcnt lgkmcnt(3)
ds_read_b128 a[108:111], v1 offset:11264
v_mfma_f32_16x16x32_bf16 v[32:35], a[92:95], a[28:31], v[32:35]
buffer_load_dwordx4 v1, s[4:7], s12 offen offset:3072 sc1 lds
v_mfma_f32_16x16x32_bf16 v[36:39], a[64:67], a[32:35], 0
s_add_u32 s12, s12, 4096
s_add_u32 m0, s18, 69632
ds_read_b128 a[112:115], v1 offset:12288
v_mfma_f32_16x16x32_bf16 v[36:39], a[68:71], a[36:39], v[36:39]
buffer_load_dwordx4 v1, s[4:7], s12 offen offset:0 sc1 lds
v_mfma_f32_16x16x32_bf16 v[36:39], a[72:75], a[40:43], v[36:39]
ds_read_b128 a[116:119], v1 offset:13312
v_mfma_f32_16x16x32_bf16 v[36:39], a[76:79], a[44:47], v[36:39]
buffer_load_dwordx4 v1, s[4:7], s12 offen offset:1024 sc1 lds
v_mfma_f32_16x16x32_bf16 v[36:39], a[80:83], a[48:51], v[36:39]
ds_read_b128 a[120:123], v1 offset:14336
v_max3_f32 v28, v32, v33, v34
v_mfma_f32_16x16x32_bf16 v[36:39], a[84:87], a[52:55], v[36:39]
buffer_load_dwordx4 v1, s[4:7], s12 offen offset:2048 sc1 lds
v_mfma_f32_16x16x32_bf16 v[36:39], a[88:91], a[56:59], v[36:39]
ds_read_b128 a[124:127], v1 offset:15360
v_max_f32 v28, v28, v35
v_mfma_f32_16x16x32_bf16 v[36:39], a[92:95], a[60:63], v[36:39]
s_waitcnt lgkmcnt(4)
buffer_load_dwordx4 v1, s[4:7], s12 offen offset:3072 sc1 lds
v_mfma_f32_16x16x32_bf16 v[40:43], a[96:99], a[0:3], v[40:43]
s_add_u32 s12, s12, 28672
ds_read_b128 a[64:67], v1 offset:16384
v_mov_b32 v30, v28
v_mfma_f32_16x16x32_bf16 v[40:43], a[100:103], a[4:7], v[40:43]
s_waitcnt lgkmcnt(2)
s_sub_u32 s13, s13, 1
v_mfma_f32_16x16x32_bf16 v[40:43], a[104:107], a[8:11], v[40:43]
s_cmp_eq_u32 s13, 0
ds_read_b128 a[68:71], v1 offset:17408
v_permlane16_swap_b32 v28, v30
v_mfma_f32_16x16x32_bf16 v[40:43], a[108:111], a[12:15], v[40:43]
s_cselect_b32 s12, s14, s12
v_max_f32 v28, v28, v30
v_mov_b32 v30, v28
v_mfma_f32_16x16x32_bf16 v[40:43], a[112:115], a[16:19], v[40:43]
s_cselect_b32 s13, s15, s13
ds_read_b128 a[72:75], v1 offset:18432
v_max3_f32 v29, v36, v37, v38
v_mfma_f32_16x16x32_bf16 v[40:43], a[116:119], a[20:23], v[40:43]
s_cselect_b32 s14, 3221225472, s14
v_permlane32_swap_b32 v28, v30
v_max_f32 v28, v28, v30
v_mfma_f32_16x16x32_bf16 v[40:43], a[120:123], a[24:27], v[40:43]
s_waitcnt lgkmcnt(3)
ds_read_b128 a[76:79], v1 offset:19456
v_sub_f32 v16, 0, v28
v_mfma_f32_16x16x32_bf16 v[40:43], a[124:127], a[28:31], v[40:43]
v_sub_f32 v17, 0, v28
v_sub_f32 v18, 0, v28
v_mfma_f32_16x16x32_bf16 v[44:47], a[96:99], a[32:35], 0
ds_read_b128 a[80:83], v1 offset:20480
v_sub_f32 v19, 0, v28
v_mfma_f32_16x16x32_bf16 v[44:47], a[100:103], a[36:39], v[44:47]
v_max_f32 v29, v29, v39
v_mov_b32 v31, v29
v_cndmask_b32 v48, v16, v7, s[48:49]
v_mfma_f32_16x16x32_bf16 v[44:47], a[104:107], a[40:43], v[44:47]
ds_read_b128 a[84:87], v1 offset:21504
v_cndmask_b32 v49, v16, v7, s[50:51]
v_mfma_f32_16x16x32_bf16 v[44:47], a[108:111], a[44:47], v[44:47]
v_permlane16_swap_b32 v29, v31
v_max_f32 v29, v29, v31
v_cndmask_b32 v50, v16, v7, s[52:53]
v_mfma_f32_16x16x32_bf16 v[44:47], a[112:115], a[48:51], v[44:47]
ds_read_b128 a[88:91], v1 offset:22528
v_mov_b32 v31, v29
v_cndmask_b32 v51, v16, v7, s[54:55]
v_mfma_f32_16x16x32_bf16 v[44:47], a[116:119], a[52:55], v[44:47]
v_cndmask_b32 v56, v16, v7, s[56:57]
v_cndmask_b32 v57, v16, v7, s[58:59]
v_mfma_f32_16x16x32_bf16 v[44:47], a[120:123], a[56:59], v[44:47]
ds_read_b128 a[92:95], v1 offset:23552
v_permlane32_swap_b32 v29, v31
v_mfma_f32_16x16x32_bf16 v[44:47], a[124:127], a[60:63], v[44:47]
s_waitcnt lgkmcnt(4)
v_max_f32 v29, v29, v31
v_sub_f32 v20, 0, v29
v_mfma_f32_16x16x32_bf16 v[48:51], a[64:67], a[0:3], v[48:51]
ds_read_b128 a[96:99], v1 offset:24576
v_sub_f32 v21, 0, v29
v_mfma_f32_16x16x32_bf16 v[48:51], a[68:71], a[4:7], v[48:51]
v_sub_f32 v22, 0, v29
v_sub_f32 v23, 0, v29
v_mfma_f32_16x16x32_bf16 v[48:51], a[72:75], a[8:11], v[48:51]
ds_read_b128 a[100:103], v1 offset:25600
v_cndmask_b32 v58, v16, v7, s[60:61]
v_mfma_f32_16x16x32_bf16 v[48:51], a[76:79], a[12:15], v[48:51]
s_waitcnt lgkmcnt(4)
v_cndmask_b32 v59, v16, v7, s[62:63]
v_mfma_f32_16x16x32_bf16 v[48:51], a[80:83], a[16:19], v[48:51]
ds_read_b128 a[104:107], v1 offset:26624
v_mfma_f32_16x16x32_bf16 v[48:51], a[84:87], a[20:23], v[48:51]
s_waitcnt lgkmcnt(4)
v_add_f32 v32, v32, v16
v_add_f32 v33, v33, v16
v_add_f32 v34, v34, v16
v_add_f32 v35, v35, v16
v_mfma_f32_16x16x32_bf16 v[48:51], a[88:91], a[24:27], v[48:51]
s_waitcnt lgkmcnt(3)
ds_read_b128 a[108:111], v1 offset:27648
v_add_f32 v36, v36, v20
v_add_f32 v37, v37, v20
v_add_f32 v38, v38, v20
v_add_f32 v39, v39, v20
v_mfma_f32_16x16x32_bf16 v[48:51], a[92:95], a[28:31], v[48:51]
v_add_f32 v40, v40, v16
v_add_f32 v41, v41, v16
v_add_f32 v42, v42, v16
v_add_f32 v43, v43, v16
v_mfma_f32_16x16x32_bf16 v[52:55], a[64:67], a[32:35], v[20:23]
ds_read_b128 a[112:115], v1 offset:28672
v_add_f32 v44, v44, v20
v_add_f32 v45, v45, v20
v_add_f32 v46, v46, v20
v_add_f32 v47, v47, v20
v_mfma_f32_16x16x32_bf16 v[52:55], a[68:71], a[36:39], v[52:55]
v_exp_f32 v8, v32
v_mfma_f32_16x16x32_bf16 v[52:55], a[72:75], a[40:43], v[52:55]
ds_read_b128 a[116:119], v1 offset:29696
v_exp_f32 v9, v33
v_mfma_f32_16x16x32_bf16 v[52:55], a[76:79], a[44:47], v[52:55]
v_exp_f32 v10, v34
v_add_f32 v26, v8, v9
v_cvt_pk_bf16_f32 v96, v8, v9
v_mfma_f32_16x16x32_bf16 v[52:55], a[80:83], a[48:51], v[52:55]
ds_read_b128 a[120:123], v1 offset:30720
v_exp_f32 v11, v35
v_add_f32 v26, v26, v10
v_mfma_f32_16x16x32_bf16 v[52:55], a[84:87], a[52:55], v[52:55]
v_exp_f32 v12, v36
v_add_f32 v26, v26, v11
v_cvt_pk_bf16_f32 v97, v10, v11
v_mfma_f32_16x16x32_bf16 v[52:55], a[88:91], a[56:59], v[52:55]
s_waitcnt vmcnt(8) lgkmcnt(4)
ds_read_b128 a[124:127], v1 offset:31744
v_exp_f32 v13, v37
v_mfma_f32_16x16x32_bf16 v[52:55], a[92:95], a[60:63], v[52:55]
s_barrier
v_mfma_f32_16x16x32_bf16 v[56:59], a[96:99], a[0:3], v[56:59]
ds_read_b128 a[64:67], v4 offset:0
v_exp_f32 v14, v38
v_mfma_f32_16x16x32_bf16 v[56:59], a[100:103], a[4:7], v[56:59]
buffer_store_dword v6, v5, s[4:7], s71 offen sc1
v_mfma_f32_16x16x32_bf16 v[56:59], a[104:107], a[8:11], v[56:59]
s_waitcnt lgkmcnt(4)
ds_read_b128 a[68:71], v4 offset:1024
v_add_f32 v27, v12, v13
v_cvt_pk_bf16_f32 v104, v12, v13
v_add_f32 v27, v27, v14
v_mfma_f32_16x16x32_bf16 v[56:59], a[108:111], a[12:15], v[56:59]
v_exp_f32 v15, v39
v_mfma_f32_16x16x32_bf16 v[56:59], a[112:115], a[16:19], v[56:59]
s_waitcnt lgkmcnt(4)
ds_read_b128 a[72:75], v4 offset:2048
v_exp_f32 v8, v40
v_add_f32 v27, v27, v15
v_cvt_pk_bf16_f32 v105, v14, v15
v_mfma_f32_16x16x32_bf16 v[56:59], a[116:119], a[20:23], v[56:59]
s_waitcnt lgkmcnt(4)
v_exp_f32 v9, v41
v_add_f32 v26, v26, v8
v_mfma_f32_16x16x32_bf16 v[56:59], a[120:123], a[24:27], v[56:59]
s_waitcnt lgkmcnt(3)
ds_read_b128 a[76:79], v4 offset:3072
v_exp_f32 v10, v42
v_add_f32 v26, v26, v9
v_cvt_pk_bf16_f32 v98, v8, v9
v_mfma_f32_16x16x32_bf16 v[56:59], a[124:127], a[28:31], v[56:59]
v_exp_f32 v11, v43
v_add_f32 v26, v26, v10
v_mfma_f32_16x16x32_bf16 v[60:63], a[96:99], a[32:35], v[20:23]
ds_read_b128 a[80:83], v4 offset:4096
v_exp_f32 v12, v44
v_mfma_f32_16x16x32_bf16 v[60:63], a[100:103], a[36:39], v[60:63]
v_exp_f32 v13, v45
v_mfma_f32_16x16x32_bf16 v[60:63], a[104:107], a[40:43], v[60:63]
ds_read_b128 a[84:87], v4 offset:5120
v_exp_f32 v14, v46
v_mfma_f32_16x16x32_bf16 v[60:63], a[108:111], a[44:47], v[60:63]
v_exp_f32 v15, v47
v_mfma_f32_16x16x32_bf16 v[60:63], a[112:115], a[48:51], v[60:63]
ds_read_b128 a[88:91], v4 offset:6144
v_add_f32 v26, v26, v11
v_cvt_pk_bf16_f32 v99, v10, v11
v_mfma_f32_16x16x32_bf16 v[60:63], a[116:119], a[52:55], v[60:63]
v_add_f32 v27, v27, v12
v_add_f32 v27, v27, v13
v_cvt_pk_bf16_f32 v106, v12, v13
v_mfma_f32_16x16x32_bf16 v[60:63], a[120:123], a[56:59], v[60:63]
s_waitcnt lgkmcnt(7)
s_barrier
ds_read_b128 a[92:95], v4 offset:7168
v_mfma_f32_16x16x32_bf16 v[60:63], a[124:127], a[60:63], v[60:63]
s_waitcnt lgkmcnt(4)
v_add_f32 v27, v27, v14
v_add_f32 v27, v27, v15
v_cvt_pk_bf16_f32 v107, v14, v15
s_branch K2_dx1
PAD_33:
s_cbranch_execz M_tret
K2_ntail:
v_mfma_f32_16x16x32_bf16 v[128:131], a[64:67], v[96:99], v[128:131]
s_add_u32 m0, s18, 98304
ds_read_b128 a[96:99], v2 offset:8192
v_add_f32 v24, v24, v26
v_mfma_f32_16x16x32_bf16 v[128:131], a[68:71], v[100:103], v[128:131]
buffer_load_dwordx4 v1, s[4:7], s12 offen offset:0 sc1 lds
v_mfma_f32_16x16x32_bf16 v[132:135], a[68:71], v[108:111], v[132:135]
ds_read_b128 a[100:103], v2 offset:9216
v_add_f32 v25, v25, v27
v_mfma_f32_16x16x32_bf16 v[132:135], a[64:67], v[104:107], v[132:135]
buffer_load_dwordx4 v1, s[4:7], s12 offen offset:1024 sc1 lds
v_mfma_f32_16x16x32_bf16 v[136:139], a[72:75], v[96:99], v[136:139]
ds_read_b128 a[104:107], v2 offset:10240
v_exp_f32 v8, v64
v_mfma_f32_16x16x32_bf16 v[136:139], a[76:79], v[100:103], v[136:139]
buffer_load_dwordx4 v1, s[4:7], s12 offen offset:2048 sc1 lds
v_mfma_f32_16x16x32_bf16 v[140:143], a[76:79], v[108:111], v[140:143]
ds_read_b128 a[108:111], v2 offset:11264
v_mfma_f32_16x16x32_bf16 v[140:143], a[72:75], v[104:107], v[140:143]
s_waitcnt lgkmcnt(4)
buffer_load_dwordx4 v1, s[4:7], s12 offen offset:3072 sc1 lds
v_mfma_f32_16x16x32_bf16 v[144:147], a[80:83], v[96:99], v[144:147]
s_add_u32 s12, s12, 4096
s_add_u32 m0, s18, 102400
ds_read_b128 a[112:115], v2 offset:12288
v_mfma_f32_16x16x32_bf16 v[144:147], a[84:87], v[100:103], v[144:147]
buffer_load_dwordx4 v1, s[4:7], s12 offen offset:0 sc1 lds
v_mfma_f32_16x16x32_bf16 v[148:151], a[84:87], v[108:111], v[148:151]
ds_read_b128 a[116:119], v2 offset:13312
v_exp_f32 v9, v65
v_mfma_f32_16x16x32_bf16 v[148:151], a[80:83], v[104:107], v[148:151]
buffer_load_dwordx4 v1, s[4:7], s12 offen offset:1024 sc1 lds
v_mfma_f32_16x16x32_bf16 v[152:155], a[88:91], v[96:99], v[152:155]
ds_read_b128 a[120:123], v2 offset:14336
v_add_f32 v26, v8, v9
v_cvt_pk_bf16_f32 v112, v8, v9
v_mfma_f32_16x16x32_bf16 v[152:155], a[92:95], v[100:103], v[152:155]
buffer_load_dwordx4 v1, s[4:7], s12 offen offset:2048 sc1 lds
v_mfma_f32_16x16x32_bf16 v[156:159], a[92:95], v[108:111], v[156:159]
ds_read_b128 a[124:127], v2 offset:15360
v_exp_f32 v10, v66
v_mfma_f32_16x16x32_bf16 v[156:159], a[88:91], v[104:107], v[156:159]
s_waitcnt lgkmcnt(4)
buffer_load_dwordx4 v1, s[4:7], s12 offen offset:3072 sc1 lds
v_mfma_f32_16x16x32_bf16 v[160:163], a[96:99], v[96:99], v[160:163]
s_add_u32 s12, s12, 28672
ds_read_b128 a[64:67], v2 offset:16384
v_add_f32 v26, v26, v10
v_mfma_f32_16x16x32_bf16 v[160:163], a[100:103], v[100:103], v[160:163]
s_sub_u32 s13, s13, 1
v_exp_f32 v11, v67
v_mfma_f32_16x16x32_bf16 v[164:167], a[100:103], v[108:111], v[164:167]
s_cmp_eq_u32 s13, 0
ds_read_b128 a[68:71], v2 offset:17408
v_exp_f32 v12, v68
v_mfma_f32_16x16x32_bf16 v[164:167], a[96:99], v[104:107], v[164:167]
s_cselect_b32 s12, s14, s12
v_exp_f32 v13, v69
v_mfma_f32_16x16x32_bf16 v[168:171], a[104:107], v[96:99], v[168:171]
s_cselect_b32 s13, s15, s13
ds_read_b128 a[72:75], v2 offset:18432
v_add_f32 v26, v26, v11
v_cvt_pk_bf16_f32 v113, v10, v11
v_mfma_f32_16x16x32_bf16 v[168:171], a[108:111], v[100:103], v[168:171]
s_cselect_b32 s14, 3221225472, s14
v_exp_f32 v14, v70
v_mfma_f32_16x16x32_bf16 v[172:175], a[108:111], v[108:111], v[172:175]
ds_read_b128 a[76:79], v2 offset:19456
v_exp_f32 v15, v71
v_mfma_f32_16x16x32_bf16 v[172:175], a[104:107], v[104:107], v[172:175]
s_waitcnt lgkmcnt(4)
v_exp_f32 v8, v72
v_mfma_f32_16x16x32_bf16 v[176:179], a[112:115], v[96:99], v[176:179]
ds_read_b128 a[80:83], v2 offset:20480
v_add_f32 v27, v12, v13
v_cvt_pk_bf16_f32 v120, v12, v13
v_add_f32 v27, v27, v14
v_add_f32 v27, v27, v15
v_cvt_pk_bf16_f32 v121, v14, v15
v_mfma_f32_16x16x32_bf16 v[176:179], a[116:119], v[100:103], v[176:179]
v_exp_f32 v9, v73
v_mfma_f32_16x16x32_bf16 v[180:183], a[116:119], v[108:111], v[180:183]
ds_read_b128 a[84:87], v2 offset:21504
v_exp_f32 v10, v74
v_mfma_f32_16x16x32_bf16 v[180:183], a[112:115], v[104:107], v[180:183]
v_exp_f32 v11, v75
v_mfma_f32_16x16x32_bf16 v[184:187], a[120:123], v[96:99], v[184:187]
ds_read_b128 a[88:91], v2 offset:22528
v_add_f32 v26, v26, v8
v_mfma_f32_16x16x32_bf16 v[184:187], a[124:127], v[100:103], v[184:187]
v_exp_f32 v12, v76
v_mfma_f32_16x16x32_bf16 v[188:191], a[124:127], v[108:111], v[188:191]
ds_read_b128 a[92:95], v2 offset:23552
v_add_f32 v26, v26, v9
v_cvt_pk_bf16_f32 v114, v8, v9
v_add_f32 v26, v26, v10
v_add_f32 v26, v26, v11
v_cvt_pk_bf16_f32 v115, v10, v11
v_mfma_f32_16x16x32_bf16 v[188:191], a[120:123], v[104:107], v[188:191]
s_waitcnt lgkmcnt(4)
v_exp_f32 v13, v77
v_mfma_f32_16x16x32_bf16 v[192:195], a[64:67], v[96:99], v[192:195]
ds_read_b128 a[96:99], v2 offset:24576
v_exp_f32 v14, v78
v_mfma_f32_16x16x32_bf16 v[192:195], a[68:71], v[100:103], v[192:195]
v_exp_f32 v15, v79
v_mfma_f32_16x16x32_bf16 v[196:199], a[68:71], v[108:111], v[196:199]
ds_read_b128 a[100:103], v2 offset:25600
v_add_f32 v27, v27, v12
v_add_f32 v27, v27, v13
v_cvt_pk_bf16_f32 v122, v12, v13
v_add_f32 v27, v27, v14
v_mfma_f32_16x16x32_bf16 v[196:199], a[64:67], v[104:107], v[196:199]
v_exp_f32 v8, v80
v_mfma_f32_16x16x32_bf16 v[200:203], a[72:75], v[96:99], v[200:203]
ds_read_b128 a[104:107], v2 offset:26624
v_exp_f32 v9, v81
v_mfma_f32_16x16x32_bf16 v[200:203], a[76:79], v[100:103], v[200:203]
v_exp_f32 v10, v82
v_mfma_f32_16x16x32_bf16 v[204:207], a[76:79], v[108:111], v[204:207]
ds_read_b128 a[108:111], v2 offset:27648
v_add_f32 v27, v27, v15
v_cvt_pk_bf16_f32 v123, v14, v15
v_add_f32 v26, v26, v8
v_add_f32 v26, v26, v9
v_cvt_pk_bf16_f32 v116, v8, v9
v_mfma_f32_16x16x32_bf16 v[204:207], a[72:75], v[104:107], v[204:207]
s_waitcnt lgkmcnt(4)
v_exp_f32 v11, v83
v_mfma_f32_16x16x32_bf16 v[208:211], a[80:83], v[96:99], v[208:211]
ds_read_b128 a[112:115], v2 offset:28672
v_exp_f32 v12, v84
v_mfma_f32_16x16x32_bf16 v[208:211], a[84:87], v[100:103], v[208:211]
v_exp_f32 v13, v85
v_mfma_f32_16x16x32_bf16 v[212:215], a[84:87], v[108:111], v[212:215]
ds_read_b128 a[116:119], v2 offset:29696
v_add_f32 v26, v26, v10
v_add_f32 v26, v26, v11
v_cvt_pk_bf16_f32 v117, v10, v11
v_add_f32 v27, v27, v12
v_mfma_f32_16x16x32_bf16 v[212:215], a[80:83], v[104:107], v[212:215]
v_exp_f32 v14, v86
v_mfma_f32_16x16x32_bf16 v[216:219], a[88:91], v[96:99], v[216:219]
ds_read_b128 a[120:123], v2 offset:30720
v_exp_f32 v15, v87
v_mfma_f32_16x16x32_bf16 v[216:219], a[92:95], v[100:103], v[216:219]
v_exp_f32 v8, v88
v_mfma_f32_16x16x32_bf16 v[220:223], a[92:95], v[108:111], v[220:223]
s_waitcnt vmcnt(0) lgkmcnt(4)
ds_read_b128 a[124:127], v2 offset:31744
v_add_f32 v27, v27, v13
v_cvt_pk_bf16_f32 v124, v12, v13
v_add_f32 v27, v27, v14
v_add_f32 v27, v27, v15
v_cvt_pk_bf16_f32 v125, v14, v15
v_mfma_f32_16x16x32_bf16 v[220:223], a[88:91], v[104:107], v[220:223]
s_barrier
v_mfma_f32_16x16x32_bf16 v[224:227], a[96:99], v[96:99], v[224:227]
ds_read_b128 a[64:67], v2 offset:32768
v_exp_f32 v9, v89
v_mfma_f32_16x16x32_bf16 v[224:227], a[100:103], v[100:103], v[224:227]
v_exp_f32 v10, v90
v_mfma_f32_16x16x32_bf16 v[228:231], a[100:103], v[108:111], v[228:231]
ds_read_b128 a[68:71], v2 offset:33792
v_add_f32 v26, v26, v8
v_add_f32 v26, v26, v9
v_cvt_pk_bf16_f32 v118, v8, v9
v_mfma_f32_16x16x32_bf16 v[228:231], a[96:99], v[104:107], v[228:231]
v_exp_f32 v11, v91
v_mfma_f32_16x16x32_bf16 v[232:235], a[104:107], v[96:99], v[232:235]
s_waitcnt lgkmcnt(4)
ds_read_b128 a[72:75], v2 offset:34816
v_exp_f32 v12, v92
v_mfma_f32_16x16x32_bf16 v[232:235], a[108:111], v[100:103], v[232:235]
v_exp_f32 v13, v93
v_mfma_f32_16x16x32_bf16 v[236:239], a[108:111], v[108:111], v[236:239]
ds_read_b128 a[76:79], v2 offset:35840
v_add_f32 v26, v26, v10
v_mfma_f32_16x16x32_bf16 v[236:239], a[104:107], v[104:107], v[236:239]
v_exp_f32 v14, v94
v_mfma_f32_16x16x32_bf16 v[240:243], a[112:115], v[96:99], v[240:243]
ds_read_b128 a[80:83], v2 offset:36864
v_add_f32 v26, v26, v11
v_cvt_pk_bf16_f32 v119, v10, v11
v_add_f32 v27, v27, v12
v_mfma_f32_16x16x32_bf16 v[240:243], a[116:119], v[100:103], v[240:243]
v_exp_f32 v15, v95
v_mfma_f32_16x16x32_bf16 v[244:247], a[116:119], v[108:111], v[244:247]
ds_read_b128 a[84:87], v2 offset:37888
v_add_f32 v27, v27, v13
v_cvt_pk_bf16_f32 v126, v12, v13
v_mfma_f32_16x16x32_bf16 v[244:247], a[112:115], v[104:107], v[244:247]
s_waitcnt lgkmcnt(4)
v_add_f32 v27, v27, v14
v_add_f32 v27, v27, v15
v_mfma_f32_16x16x32_bf16 v[248:251], a[120:123], v[96:99], v[248:251]
ds_read_b128 a[88:91], v2 offset:38912
v_cvt_pk_bf16_f32 v127, v14, v15
v_mfma_f32_16x16x32_bf16 v[248:251], a[124:127], v[100:103], v[248:251]
v_add_f32 v28, v26, v27
v_cmp_nge_f32 vcc, s25, v28
v_mfma_f32_16x16x32_bf16 v[252:255], a[124:127], v[108:111], v[252:255]
ds_read_b128 a[92:95], v2 offset:39936
v_mfma_f32_16x16x32_bf16 v[252:255], a[120:123], v[104:107], v[252:255]
s_cbranch_vccnz Lstub_14
Lback_15:
v_mfma_f32_16x16x32_bf16 v[128:131], a[64:67], v[112:115], v[128:131]
s_add_u32 m0, s18, 131072
ds_read_b128 a[96:99], v2 offset:40960
v_add_f32 v24, v24, v26
v_mfma_f32_16x16x32_bf16 v[128:131], a[68:71], v[116:119], v[128:131]
buffer_load_dwordx4 v1, s[4:7], s8 offen offset:0 sc1 lds
v_mfma_f32_16x16x32_bf16 v[132:135], a[68:71], v[124:127], v[132:135]
ds_read_b128 a[100:103], v2 offset:41984
v_add_f32 v25, v25, v27
v_mfma_f32_16x16x32_bf16 v[132:135], a[64:67], v[120:123], v[132:135]
s_waitcnt lgkmcnt(4)
buffer_load_dwordx4 v1, s[4:7], s8 offen offset:1024 sc1 lds
v_mfma_f32_16x16x32_bf16 v[136:139], a[72:75], v[112:115], v[136:139]
ds_read_b128 a[104:107], v2 offset:43008
v_mov_b32 v8, v16
v_mfma_f32_16x16x32_bf16 v[136:139], a[76:79], v[116:119], v[136:139]
buffer_load_dwordx4 v1, s[4:7], s8 offen offset:2048 sc1 lds
v_mfma_f32_16x16x32_bf16 v[140:143], a[76:79], v[124:127], v[140:143]
ds_read_b128 a[108:111], v2 offset:44032
v_mov_b32 v9, v24
v_mfma_f32_16x16x32_bf16 v[140:143], a[72:75], v[120:123], v[140:143]
buffer_load_dwordx4 v1, s[4:7], s8 offen offset:3072 sc1 lds
v_mfma_f32_16x16x32_bf16 v[144:147], a[80:83], v[112:115], v[144:147]
s_add_u32 s8, s8, 4096
s_add_u32 m0, s18, 135168
ds_read_b128 a[112:115], v2 offset:45056
v_mfma_f32_16x16x32_bf16 v[144:147], a[84:87], v[116:119], v[144:147]
buffer_load_dwordx4 v1, s[4:7], s8 offen offset:0 sc1 lds
v_mfma_f32_16x16x32_bf16 v[148:151], a[84:87], v[124:127], v[148:151]
ds_read_b128 a[116:119], v2 offset:46080
v_mov_b32 v10, v20
v_mfma_f32_16x16x32_bf16 v[148:151], a[80:83], v[120:123], v[148:151]
s_waitcnt lgkmcnt(4)
buffer_load_dwordx4 v1, s[4:7], s8 offen offset:1024 sc1 lds
v_mfma_f32_16x16x32_bf16 v[152:155], a[88:91], v[112:115], v[152:155]
ds_read_b128 a[120:123], v2 offset:47104
v_mov_b32 v11, v25
v_mfma_f32_16x16x32_bf16 v[152:155], a[92:95], v[116:119], v[152:155]
buffer_load_dwordx4 v1, s[4:7], s8 offen offset:2048 sc1 lds
v_mfma_f32_16x16x32_bf16 v[156:159], a[92:95], v[124:127], v[156:159]
ds_read_b128 a[124:127], v2 offset:48128
v_cvt_pk_bf16_f32 v128, v128, v129
v_mfma_f32_16x16x32_bf16 v[156:159], a[88:91], v[120:123], v[156:159]
s_waitcnt lgkmcnt(4)
buffer_load_dwordx4 v1, s[4:7], s8 offen offset:3072 sc1 lds
v_mfma_f32_16x16x32_bf16 v[160:163], a[96:99], v[112:115], v[160:163]
s_add_u32 s8, s8, 28672
ds_read_b128 a[64:67], v2 offset:49152
v_cvt_pk_bf16_f32 v129, v130, v131
v_mfma_f32_16x16x32_bf16 v[160:163], a[100:103], v[116:119], v[160:163]
s_sub_u32 s9, s9, 1
buffer_store_dwordx4 v[8:11], v1, s[4:7], s27 offen sc1
v_mfma_f32_16x16x32_bf16 v[164:167], a[100:103], v[124:127], v[164:167]
s_cmp_eq_u32 s9, 0
ds_read_b128 a[68:71], v2 offset:50176
v_cvt_pk_bf16_f32 v130, v136, v137
v_mfma_f32_16x16x32_bf16 v[164:167], a[96:99], v[120:123], v[164:167]
s_cselect_b32 s8, s10, s8
v_cvt_pk_bf16_f32 v131, v138, v139
v_accvgpr_mov_b32 a0, a192
v_mfma_f32_16x16x32_bf16 v[168:171], a[104:107], v[112:115], v[168:171]
s_cselect_b32 s9, s11, s9
ds_read_b128 a[72:75], v2 offset:51200
v_accvgpr_mov_b32 a1, a193
v_mfma_f32_16x16x32_bf16 v[168:171], a[108:111], v[116:119], v[168:171]
s_cselect_b32 s10, 3221225472, s10
buffer_store_dwordx4 v[128:131], v1, s[4:7], s76 offen offset:0 sc1
v_mfma_f32_16x16x32_bf16 v[172:175], a[108:111], v[124:127], v[172:175]
ds_read_b128 a[76:79], v2 offset:52224
v_cvt_pk_bf16_f32 v132, v132, v133
v_mfma_f32_16x16x32_bf16 v[172:175], a[104:107], v[120:123], v[172:175]
s_waitcnt lgkmcnt(4)
v_cvt_pk_bf16_f32 v133, v134, v135
v_cvt_pk_bf16_f32 v134, v140, v141
v_mfma_f32_16x16x32_bf16 v[176:179], a[112:115], v[112:115], v[176:179]
ds_read_b128 a[80:83], v2 offset:53248
v_cvt_pk_bf16_f32 v135, v142, v143
v_mfma_f32_16x16x32_bf16 v[176:179], a[116:119], v[116:119], v[176:179]
buffer_store_dwordx4 v[132:135], v1, s[4:7], s77 offen offset:0 sc1
v_mfma_f32_16x16x32_bf16 v[180:183], a[116:119], v[124:127], v[180:183]
ds_read_b128 a[84:87], v2 offset:54272
v_cvt_pk_bf16_f32 v144, v144, v145
v_mfma_f32_16x16x32_bf16 v[180:183], a[112:115], v[120:123], v[180:183]
v_cvt_pk_bf16_f32 v145, v146, v147
v_cvt_pk_bf16_f32 v146, v152, v153
v_mfma_f32_16x16x32_bf16 v[184:187], a[120:123], v[112:115], v[184:187]
ds_read_b128 a[88:91], v2 offset:55296
v_cvt_pk_bf16_f32 v147, v154, v155
v_mfma_f32_16x16x32_bf16 v[184:187], a[124:127], v[116:119], v[184:187]
buffer_store_dwordx4 v[144:147], v1, s[4:7], s76 offen offset:1024 sc1
v_mfma_f32_16x16x32_bf16 v[188:191], a[124:127], v[124:127], v[188:191]
ds_read_b128 a[92:95], v2 offset:56320
v_cvt_pk_bf16_f32 v148, v148, v149
v_mfma_f32_16x16x32_bf16 v[188:191], a[120:123], v[120:123], v[188:191]
s_waitcnt lgkmcnt(4)
v_cvt_pk_bf16_f32 v149, v150, v151
v_cvt_pk_bf16_f32 v150, v156, v157
v_mfma_f32_16x16x32_bf16 v[192:195], a[64:67], v[112:115], v[192:195]
ds_read_b128 a[96:99], v2 offset:57344
v_cvt_pk_bf16_f32 v151, v158, v159
v_mfma_f32_16x16x32_bf16 v[192:195], a[68:71], v[116:119], v[192:195]
buffer_store_dwordx4 v[148:151], v1, s[4:7], s77 offen offset:1024 sc1
v_mfma_f32_16x16x32_bf16 v[196:199], a[68:71], v[124:127], v[196:199]
ds_read_b128 a[100:103], v2 offset:58368
v_cvt_pk_bf16_f32 v160, v160, v161
v_mfma_f32_16x16x32_bf16 v[196:199], a[64:67], v[120:123], v[196:199]
v_cvt_pk_bf16_f32 v161, v162, v163
v_cvt_pk_bf16_f32 v162, v168, v169
v_mfma_f32_16x16x32_bf16 v[200:203], a[72:75], v[112:115], v[200:203]
ds_read_b128 a[104:107], v2 offset:59392
v_cvt_pk_bf16_f32 v163, v170, v171
v_mfma_f32_16x16x32_bf16 v[200:203], a[76:79], v[116:119], v[200:203]
buffer_store_dwordx4 v[160:163], v1, s[4:7], s76 offen offset:2048 sc1
v_mfma_f32_16x16x32_bf16 v[204:207], a[76:79], v[124:127], v[204:207]
ds_read_b128 a[108:111], v2 offset:60416
v_cvt_pk_bf16_f32 v164, v164, v165
v_mfma_f32_16x16x32_bf16 v[204:207], a[72:75], v[120:123], v[204:207]
s_waitcnt lgkmcnt(4)
v_cvt_pk_bf16_f32 v165, v166, v167
v_cvt_pk_bf16_f32 v166, v172, v173
v_mfma_f32_16x16x32_bf16 v[208:211], a[80:83], v[112:115], v[208:211]
ds_read_b128 a[112:115], v2 offset:61440
v_cvt_pk_bf16_f32 v167, v174, v175
v_mfma_f32_16x16x32_bf16 v[208:211], a[84:87], v[116:119], v[208:211]
buffer_store_dwordx4 v[164:167], v1, s[4:7], s77 offen offset:2048 sc1
v_mfma_f32_16x16x32_bf16 v[212:215], a[84:87], v[124:127], v[212:215]
ds_read_b128 a[116:119], v2 offset:62464
v_cvt_pk_bf16_f32 v176, v176, v177
v_mfma_f32_16x16x32_bf16 v[212:215], a[80:83], v[120:123], v[212:215]
v_cvt_pk_bf16_f32 v177, v178, v179
v_cvt_pk_bf16_f32 v178, v184, v185
v_mfma_f32_16x16x32_bf16 v[216:219], a[88:91], v[112:115], v[216:219]
ds_read_b128 a[120:123], v2 offset:63488
v_cvt_pk_bf16_f32 v179, v186, v187
v_mfma_f32_16x16x32_bf16 v[216:219], a[92:95], v[116:119], v[216:219]
buffer_store_dwordx4 v[176:179], v1, s[4:7], s76 offen offset:3072 sc1
v_mfma_f32_16x16x32_bf16 v[220:223], a[92:95], v[124:127], v[220:223]
ds_read_b128 a[124:127], v2 offset:64512
v_cvt_pk_bf16_f32 v180, v180, v181
v_mfma_f32_16x16x32_bf16 v[220:223], a[88:91], v[120:123], v[220:223]
s_waitcnt lgkmcnt(4)
v_cvt_pk_bf16_f32 v181, v182, v183
v_cvt_pk_bf16_f32 v182, v188, v189
v_mfma_f32_16x16x32_bf16 v[224:227], a[96:99], v[112:115], v[224:227]
v_cvt_pk_bf16_f32 v183, v190, v191
v_accvgpr_mov_b32 a2, a194
v_mfma_f32_16x16x32_bf16 v[224:227], a[100:103], v[116:119], v[224:227]
PAD_34:
s_cbranch_execz M_tret
buffer_store_dwordx4 v[180:183], v1, s[4:7], s77 offen offset:3072 sc1
v_mfma_f32_16x16x32_bf16 v[228:231], a[100:103], v[124:127], v[228:231]
s_add_u32 s76, s76, 4096
v_accvgpr_mov_b32 a3, a195
v_accvgpr_mov_b32 a4, a196
v_mfma_f32_16x16x32_bf16 v[228:231], a[96:99], v[120:123], v[228:231]
s_add_u32 s77, s77, 4096
v_cvt_pk_bf16_f32 v192, v192, v193
v_cvt_pk_bf16_f32 v193, v194, v195
v_mfma_f32_16x16x32_bf16 v[232:235], a[104:107], v[112:115], v[232:235]
v_cvt_pk_bf16_f32 v194, v200, v201
v_cvt_pk_bf16_f32 v195, v202, v203
v_mfma_f32_16x16x32_bf16 v[232:235], a[108:111], v[116:119], v[232:235]
buffer_store_dwordx4 v[192:195], v1, s[4:7], s76 offen offset:0 sc1
v_mfma_f32_16x16x32_bf16 v[236:239], a[108:111], v[124:127], v[236:239]
v_cvt_pk_bf16_f32 v196, v196, v197
v_cvt_pk_bf16_f32 v197, v198, v199
v_mfma_f32_16x16x32_bf16 v[236:239], a[104:107], v[120:123], v[236:239]
s_waitcnt lgkmcnt(0)
v_cvt_pk_bf16_f32 v198, v204, v205
v_cvt_pk_bf16_f32 v199, v206, v207
v_mfma_f32_16x16x32_bf16 v[240:243], a[112:115], v[112:115], v[240:243]
buffer_store_dwordx4 v[196:199], v1, s[4:7], s77 offen offset:0 sc1
v_mfma_f32_16x16x32_bf16 v[240:243], a[116:119], v[116:119], v[240:243]
v_cvt_pk_bf16_f32 v208, v208, v209
v_cvt_pk_bf16_f32 v209, v210, v211
v_mfma_f32_16x16x32_bf16 v[244:247], a[116:119], v[124:127], v[244:247]
v_cvt_pk_bf16_f32 v210, v216, v217
v_cvt_pk_bf16_f32 v211, v218, v219
v_mfma_f32_16x16x32_bf16 v[244:247], a[112:115], v[120:123], v[244:247]
buffer_store_dwordx4 v[208:211], v1, s[4:7], s76 offen offset:1024 sc1
v_mfma_f32_16x16x32_bf16 v[248:251], a[120:123], v[112:115], v[248:251]
v_cvt_pk_bf16_f32 v212, v212, v213
v_cvt_pk_bf16_f32 v213, v214, v215
v_mfma_f32_16x16x32_bf16 v[248:251], a[124:127], v[116:119], v[248:251]
v_cvt_pk_bf16_f32 v214, v220, v221
v_cvt_pk_bf16_f32 v215, v222, v223
v_mfma_f32_16x16x32_bf16 v[252:255], a[124:127], v[124:127], v[252:255]
buffer_store_dwordx4 v[212:215], v1, s[4:7], s77 offen offset:1024 sc1
v_mfma_f32_16x16x32_bf16 v[252:255], a[120:123], v[120:123], v[252:255]
v_cvt_pk_bf16_f32 v224, v224, v225
v_cvt_pk_bf16_f32 v225, v226, v227
v_accvgpr_mov_b32 a5, a197
v_accvgpr_mov_b32 a6, a198
v_accvgpr_mov_b32 a7, a199
v_accvgpr_mov_b32 a8, a200
v_accvgpr_mov_b32 a9, a201
v_accvgpr_mov_b32 a10, a202
v_accvgpr_mov_b32 a11, a203
v_accvgpr_mov_b32 a12, a204
v_cvt_pk_bf16_f32 v226, v232, v233
v_cvt_pk_bf16_f32 v227, v234, v235
buffer_store_dwordx4 v[224:227], v1, s[4:7], s76 offen offset:2048 sc1
v_cvt_pk_bf16_f32 v228, v228, v229
v_cvt_pk_bf16_f32 v229, v230, v231
v_cvt_pk_bf16_f32 v230, v236, v237
v_cvt_pk_bf16_f32 v231, v238, v239
buffer_store_dwordx4 v[228:231], v1, s[4:7], s77 offen offset:2048 sc1
v_cvt_pk_bf16_f32 v240, v240, v241
v_cvt_pk_bf16_f32 v241, v242, v243
v_cvt_pk_bf16_f32 v242, v248, v249
v_cvt_pk_bf16_f32 v243, v250, v251
buffer_store_dwordx4 v[240:243], v1, s[4:7], s76 offen offset:3072 sc1
v_cvt_pk_bf16_f32 v244, v244, v245
v_cvt_pk_bf16_f32 v245, v246, v247
v_cvt_pk_bf16_f32 v246, v252, v253
v_cvt_pk_bf16_f32 v247, v254, v255
buffer_store_dwordx4 v[244:247], v1, s[4:7], s77 offen offset:3072 sc1
v_accvgpr_mov_b32 a13, a205
v_accvgpr_mov_b32 a14, a206
v_accvgpr_mov_b32 a15, a207
v_accvgpr_mov_b32 a16, a208
v_accvgpr_mov_b32 a17, a209
v_accvgpr_mov_b32 a18, a210
v_accvgpr_mov_b32 a19, a211
v_accvgpr_mov_b32 a20, a212
v_accvgpr_mov_b32 a21, a213
v_accvgpr_mov_b32 a22, a214
v_accvgpr_mov_b32 a23, a215
v_accvgpr_mov_b32 a24, a216
v_accvgpr_mov_b32 a25, a217
v_accvgpr_mov_b32 a26, a218
v_accvgpr_mov_b32 a27, a219
v_accvgpr_mov_b32 a28, a220
v_accvgpr_mov_b32 a29, a221
v_accvgpr_mov_b32 a30, a222
v_accvgpr_mov_b32 a31, a223
v_accvgpr_mov_b32 a32, a224
v_accvgpr_mov_b32 a33, a225
v_accvgpr_mov_b32 a34, a226
v_accvgpr_mov_b32 a35, a227
v_accvgpr_mov_b32 a36, a228
v_accvgpr_mov_b32 a37, a229
v_accvgpr_mov_b32 a38, a230
v_accvgpr_mov_b32 a39, a231
v_accvgpr_mov_b32 a40, a232
v_accvgpr_mov_b32 a41, a233
v_accvgpr_mov_b32 a42, a234
v_accvgpr_mov_b32 a43, a235
v_accvgpr_mov_b32 a44, a236
v_accvgpr_mov_b32 a45, a237
v_accvgpr_mov_b32 a46, a238
v_accvgpr_mov_b32 a47, a239
v_accvgpr_mov_b32 a48, a240
v_accvgpr_mov_b32 a49, a241
v_accvgpr_mov_b32 a50, a242
v_accvgpr_mov_b32 a51, a243
v_accvgpr_mov_b32 a52, a244
v_accvgpr_mov_b32 a53, a245
v_accvgpr_mov_b32 a54, a246
v_accvgpr_mov_b32 a55, a247
v_accvgpr_mov_b32 a56, a248
v_accvgpr_mov_b32 a57, a249
v_accvgpr_mov_b32 a58, a250
v_accvgpr_mov_b32 a59, a251
v_accvgpr_mov_b32 a60, a252
v_accvgpr_mov_b32 a61, a253
v_accvgpr_mov_b32 a62, a254
v_accvgpr_mov_b32 a63, a255
s_mov_b32 s24, 0
s_mov_b32 s29, s21
s_mov_b32 s19, s21
v_mov_b64 v[128:129], 0
v_mov_b64 v[130:131], 0
v_mov_b64 v[132:133], 0
v_mov_b64 v[134:135], 0
v_mov_b64 v[136:137], 0
v_mov_b64 v[138:139], 0
v_mov_b64 v[140:141], 0
v_mov_b64 v[142:143], 0
v_mov_b64 v[144:145], 0
v_mov_b64 v[146:147], 0
v_mov_b64 v[148:149], 0
v_mov_b64 v[150:151], 0
v_mov_b64 v[152:153], 0
v_mov_b64 v[154:155], 0
v_mov_b64 v[156:157], 0
v_mov_b64 v[158:159], 0
v_mov_b64 v[160:161], 0
v_mov_b64 v[162:163], 0
v_mov_b64 v[164:165], 0
v_mov_b64 v[166:167], 0
v_mov_b64 v[168:169], 0
v_mov_b64 v[170:171], 0
v_mov_b64 v[172:173], 0
v_mov_b64 v[174:175], 0
v_mov_b64 v[176:177], 0
v_mov_b64 v[178:179], 0
v_mov_b64 v[180:181], 0
v_mov_b64 v[182:183], 0
v_mov_b64 v[184:185], 0
v_mov_b64 v[186:187], 0
v_mov_b64 v[188:189], 0
v_mov_b64 v[190:191], 0
v_mov_b64 v[192:193], 0
v_mov_b64 v[194:195], 0
v_mov_b64 v[196:197], 0
v_mov_b64 v[198:199], 0
v_mov_b64 v[200:201], 0
v_mov_b64 v[202:203], 0
v_mov_b64 v[204:205], 0
v_mov_b64 v[206:207], 0
v_mov_b64 v[208:209], 0
v_mov_b64 v[210:211], 0
v_mov_b64 v[212:213], 0
v_mov_b64 v[214:215], 0
v_mov_b64 v[216:217], 0
v_mov_b64 v[218:219], 0
v_mov_b64 v[220:221], 0
v_mov_b64 v[222:223], 0
v_mov_b64 v[224:225], 0
v_mov_b64 v[226:227], 0
v_mov_b64 v[228:229], 0
v_mov_b64 v[230:231], 0
v_mov_b64 v[232:233], 0
v_mov_b64 v[234:235], 0
v_mov_b64 v[236:237], 0
v_mov_b64 v[238:239], 0
v_mov_b64 v[240:241], 0
v_mov_b64 v[242:243], 0
v_mov_b64 v[244:245], 0
v_mov_b64 v[246:247], 0
v_mov_b64 v[248:249], 0
v_mov_b64 v[250:251], 0
v_mov_b64 v[252:253], 0
v_mov_b64 v[254:255], 0
v_mov_b64 v[24:25], 0
s_mov_b32 s71, s28
s_mov_b32 s84, 0
s_barrier
s_branch K2_item
K2_nend:
Lstub_2:
s_call_b64 s[16:17], K2_slow1
s_branch Lback_3
Lstub_4:
s_call_b64 s[16:17], K2_slow0
s_branch Lback_5
Lstub_6:
s_call_b64 s[16:17], K2_slow1
s_branch Lback_7
Lstub_8:
s_call_b64 s[16:17], K2_slow0
s_branch Lback_9
Lstub_10:
s_call_b64 s[16:17], K2_slow2
s_branch Lback_11
Lstub_12:
s_call_b64 s[16:17], K2_slow2
s_branch Lback_13
Lstub_14:
s_call_b64 s[16:17], K2_slow1
s_branch Lback_15
K2_slow0:
s_nop 7
s_nop 7
v_max3_f32 v8, v32, v33, 0
v_max3_f32 v8, v34, v35, v8
v_max3_f32 v8, v40, v41, v8
v_max3_f32 v8, v42, v43, v8
v_max3_f32 v8, v48, v49, v8
v_max3_f32 v8, v50, v51, v8
v_max3_f32 v8, v56, v57, v8
v_max3_f32 v8, v58, v59, v8
v_mov_b32 v9, v8
s_nop 1
v_permlane16_swap_b32 v8, v9
v_max_f32 v8, v8, v9
v_mov_b32 v9, v8
s_nop 1
v_permlane32_swap_b32 v8, v9
v_max_f32 v8, v8, v9
v_exp_f32 v9, -v8
v_sub_f32 v16, v16, v8
v_sub_f32 v17, v17, v8
v_sub_f32 v18, v18, v8
v_sub_f32 v19, v19, v8
v_mul_f32 v24, v24, v9
v_mul_f32 v128, v128, v9
v_mul_f32 v129, v129, v9
v_mul_f32 v130, v130, v9
v_mul_f32 v131, v131, v9
v_mul_f32 v136, v136, v9
v_mul_f32 v137, v137, v9
v_mul_f32 v138, v138, v9
v_mul_f32 v139, v139, v9
v_mul_f32 v144, v144, v9
v_mul_f32 v145, v145, v9
v_mul_f32 v146, v146, v9
v_mul_f32 v147, v147, v9
v_mul_f32 v152, v152, v9
v_mul_f32 v153, v153, v9
v_mul_f32 v154, v154, v9
v_mul_f32 v155, v155, v9
v_mul_f32 v160, v160, v9
v_mul_f32 v161, v161, v9
v_mul_f32 v162, v162, v9
v_mul_f32 v163, v163, v9
v_mul_f32 v168, v168, v9
v_mul_f32 v169, v169, v9
v_mul_f32 v170, v170, v9
v_mul_f32 v171, v171, v9
v_mul_f32 v176, v176, v9
v_mul_f32 v177, v177, v9
v_mul_f32 v178, v178, v9
v_mul_f32 v179, v179, v9
v_mul_f32 v184, v184, v9
v_mul_f32 v185, v185, v9
v_mul_f32 v186, v186, v9
v_mul_f32 v187, v187, v9
v_mul_f32 v192, v192, v9
v_mul_f32 v193, v193, v9
v_mul_f32 v194, v194, v9
v_mul_f32 v195, v195, v9
v_mul_f32 v200, v200, v9
v_mul_f32 v201, v201, v9
v_mul_f32 v202, v202, v9
v_mul_f32 v203, v203, v9
v_mul_f32 v208, v208, v9
v_mul_f32 v209, v209, v9
v_mul_f32 v210, v210, v9
v_mul_f32 v211, v211, v9
v_mul_f32 v216, v216, v9
v_mul_f32 v217, v217, v9
v_mul_f32 v218, v218, v9
v_mul_f32 v219, v219, v9
v_mul_f32 v224, v224, v9
v_mul_f32 v225, v225, v9
v_mul_f32 v226, v226, v9
v_mul_f32 v227, v227, v9
v_mul_f32 v232, v232, v9
v_mul_f32 v233, v233, v9
v_mul_f32 v234, v234, v9
v_mul_f32 v235, v235, v9
v_mul_f32 v240, v240, v9
v_mul_f32 v241, v241, v9
v_mul_f32 v242, v242, v9
v_mul_f32 v243, v243, v9
v_mul_f32 v248, v248, v9
v_mul_f32 v249, v249, v9
v_mul_f32 v250, v250, v9
v_mul_f32 v251, v251, v9
v_sub_f32 v32, v32, v8
v_sub_f32 v33, v33, v8
v_sub_f32 v34, v34, v8
v_sub_f32 v35, v35, v8
v_sub_f32 v40, v40, v8
v_sub_f32 v41, v41, v8
v_sub_f32 v42, v42, v8
v_sub_f32 v43, v43, v8
v_sub_f32 v48, v48, v8
v_sub_f32 v49, v49, v8
v_sub_f32 v50, v50, v8
v_sub_f32 v51, v51, v8
v_sub_f32 v56, v56, v8
v_sub_f32 v57, v57, v8
v_sub_f32 v58, v58, v8
v_sub_f32 v59, v59, v8
v_sub_f32 v64, v64, v8
v_sub_f32 v65, v65, v8
v_sub_f32 v66, v66, v8
v_sub_f32 v67, v67, v8
v_sub_f32 v72, v72, v8
v_sub_f32 v73, v73, v8
v_sub_f32 v74, v74, v8
v_sub_f32 v75, v75, v8
v_sub_f32 v80, v80, v8
v_sub_f32 v81, v81, v8
v_sub_f32 v82, v82, v8
v_sub_f32 v83, v83, v8
v_sub_f32 v88, v88, v8
v_sub_f32 v89, v89, v8
v_sub_f32 v90, v90, v8
v_sub_f32 v91, v91, v8
v_max3_f32 v8, v36, v37, 0
v_max3_f32 v8, v38, v39, v8
v_max3_f32 v8, v44, v45, v8
v_max3_f32 v8, v46, v47, v8
v_max3_f32 v8, v52, v53, v8
v_max3_f32 v8, v54, v55, v8
v_max3_f32 v8, v60, v61, v8
v_max3_f32 v8, v62, v63, v8
v_mov_b32 v9, v8
s_nop 1
v_permlane16_swap_b32 v8, v9
v_max_f32 v8, v8, v9
v_mov_b32 v9, v8
s_nop 1
v_permlane32_swap_b32 v8, v9
v_max_f32 v8, v8, v9
v_exp_f32 v9, -v8
v_sub_f32 v20, v20, v8
v_sub_f32 v21, v21, v8
v_sub_f32 v22, v22, v8
v_sub_f32 v23, v23, v8
v_mul_f32 v25, v25, v9
v_mul_f32 v132, v132, v9
v_mul_f32 v133, v133, v9
v_mul_f32 v134, v134, v9
v_mul_f32 v135, v135, v9
v_mul_f32 v140, v140, v9
v_mul_f32 v141, v141, v9
v_mul_f32 v142, v142, v9
v_mul_f32 v143, v143, v9
v_mul_f32 v148, v148, v9
v_mul_f32 v149, v149, v9
v_mul_f32 v150, v150, v9
v_mul_f32 v151, v151, v9
v_mul_f32 v156, v156, v9
v_mul_f32 v157, v157, v9
v_mul_f32 v158, v158, v9
v_mul_f32 v159, v159, v9
v_mul_f32 v164, v164, v9
v_mul_f32 v165, v165, v9
v_mul_f32 v166, v166, v9
v_mul_f32 v167, v167, v9
v_mul_f32 v172, v172, v9
v_mul_f32 v173, v173, v9
v_mul_f32 v174, v174, v9
v_mul_f32 v175, v175, v9
v_mul_f32 v180, v180, v9
v_mul_f32 v181, v181, v9
v_mul_f32 v182, v182, v9
v_mul_f32 v183, v183, v9
v_mul_f32 v188, v188, v9
v_mul_f32 v189, v189, v9
v_mul_f32 v190, v190, v9
v_mul_f32 v191, v191, v9
v_mul_f32 v196, v196, v9
v_mul_f32 v197, v197, v9
v_mul_f32 v198, v198, v9
v_mul_f32 v199, v199, v9
v_mul_f32 v204, v204, v9
v_mul_f32 v205, v205, v9
v_mul_f32 v206, v206, v9
v_mul_f32 v207, v207, v9
v_mul_f32 v212, v212, v9
v_mul_f32 v213, v213, v9
v_mul_f32 v214, v214, v9
v_mul_f32 v215, v215, v9
v_mul_f32 v220, v220, v9
v_mul_f32 v221, v221, v9
v_mul_f32 v222, v222, v9
v_mul_f32 v223, v223, v9
v_mul_f32 v228, v228, v9
v_mul_f32 v229, v229, v9
v_mul_f32 v230, v230, v9
v_mul_f32 v231, v231, v9
v_mul_f32 v236, v236, v9
v_mul_f32 v237, v237, v9
v_mul_f32 v238, v238, v9
v_mul_f32 v239, v239, v9
v_mul_f32 v244, v244, v9
v_mul_f32 v245, v245, v9
v_mul_f32 v246, v246, v9
v_mul_f32 v247, v247, v9
v_mul_f32 v252, v252, v9
v_mul_f32 v253, v253, v9
v_mul_f32 v254, v254, v9
v_mul_f32 v255, v255, v9
v_sub_f32 v36, v36, v8
v_sub_f32 v37, v37, v8
v_sub_f32 v38, v38, v8
v_sub_f32 v39, v39, v8
v_sub_f32 v44, v44, v8
v_sub_f32 v45, v45, v8
v_sub_f32 v46, v46, v8
v_sub_f32 v47, v47, v8
v_sub_f32 v52, v52, v8
v_sub_f32 v53, v53, v8
v_sub_f32 v54, v54, v8
v_sub_f32 v55, v55, v8
v_sub_f32 v60, v60, v8
v_sub_f32 v61, v61, v8
v_sub_f32 v62, v62, v8
v_sub_f32 v63, v63, v8
v_sub_f32 v68, v68, v8
v_sub_f32 v69, v69, v8
v_sub_f32 v70, v70, v8
v_sub_f32 v71, v71, v8
v_sub_f32 v76, v76, v8
v_sub_f32 v77, v77, v8
v_sub_f32 v78, v78, v8
v_sub_f32 v79, v79, v8
v_sub_f32 v84, v84, v8
v_sub_f32 v85, v85, v8
v_sub_f32 v86, v86, v8
v_sub_f32 v87, v87, v8
v_sub_f32 v92, v92, v8
v_sub_f32 v93, v93, v8
v_sub_f32 v94, v94, v8
v_sub_f32 v95, v95, v8
v_exp_f32 v8, v32
v_exp_f32 v9, v33
v_exp_f32 v10, v34
v_exp_f32 v11, v35
s_nop 0
v_add_f32 v26, v8, v9
v_cvt_pk_bf16_f32 v96, v8, v9
v_add_f32 v26, v26, v10
v_add_f32 v26, v26, v11
v_cvt_pk_bf16_f32 v97, v10, v11
v_exp_f32 v12, v36
v_exp_f32 v13, v37
v_exp_f32 v14, v38
v_exp_f32 v15, v39
s_nop 0
v_add_f32 v27, v12, v13
v_cvt_pk_bf16_f32 v104, v12, v13
v_add_f32 v27, v27, v14
v_add_f32 v27, v27, v15
v_cvt_pk_bf16_f32 v105, v14, v15
v_exp_f32 v8, v40
v_exp_f32 v9, v41
v_exp_f32 v10, v42
v_exp_f32 v11, v43
s_nop 0
v_add_f32 v26, v26, v8
v_add_f32 v26, v26, v9
v_cvt_pk_bf16_f32 v98, v8, v9
v_add_f32 v26, v26, v10
v_add_f32 v26, v26, v11
v_cvt_pk_bf16_f32 v99, v10, v11
v_exp_f32 v12, v44
v_exp_f32 v13, v45
v_exp_f32 v14, v46
v_exp_f32 v15, v47
s_nop 0
v_add_f32 v27, v27, v12
v_add_f32 v27, v27, v13
v_cvt_pk_bf16_f32 v106, v12, v13
v_add_f32 v27, v27, v14
v_add_f32 v27, v27, v15
v_cvt_pk_bf16_f32 v107, v14, v15
v_exp_f32 v8, v48
v_exp_f32 v9, v49
v_exp_f32 v10, v50
v_exp_f32 v11, v51
s_nop 0
v_add_f32 v26, v26, v8
v_add_f32 v26, v26, v9
v_cvt_pk_bf16_f32 v100, v8, v9
v_add_f32 v26, v26, v10
v_add_f32 v26, v26, v11
v_cvt_pk_bf16_f32 v101, v10, v11
v_exp_f32 v12, v52
v_exp_f32 v13, v53
v_exp_f32 v14, v54
v_exp_f32 v15, v55
s_nop 0
v_add_f32 v27, v27, v12
v_add_f32 v27, v27, v13
v_cvt_pk_bf16_f32 v108, v12, v13
v_add_f32 v27, v27, v14
v_add_f32 v27, v27, v15
v_cvt_pk_bf16_f32 v109, v14, v15
v_exp_f32 v8, v56
v_exp_f32 v9, v57
v_exp_f32 v10, v58
v_exp_f32 v11, v59
s_nop 0
v_add_f32 v26, v26, v8
v_add_f32 v26, v26, v9
v_cvt_pk_bf16_f32 v102, v8, v9
v_add_f32 v26, v26, v10
v_add_f32 v26, v26, v11
v_cvt_pk_bf16_f32 v103, v10, v11
v_exp_f32 v12, v60
v_exp_f32 v13, v61
v_exp_f32 v14, v62
v_exp_f32 v15, v63
s_nop 0
v_add_f32 v27, v27, v12
v_add_f32 v27, v27, v13
v_cvt_pk_bf16_f32 v110, v12, v13
v_add_f32 v27, v27, v14
v_add_f32 v27, v27, v15
v_cvt_pk_bf16_f32 v111, v14, v15
s_nop 1
s_setpc_b64 s[16:17]
K2_slow1:
s_nop 7
s_nop 7
v_max3_f32 v8, v64, v65, 0
v_max3_f32 v8, v66, v67, v8
v_max3_f32 v8, v72, v73, v8
v_max3_f32 v8, v74, v75, v8
v_max3_f32 v8, v80, v81, v8
v_max3_f32 v8, v82, v83, v8
v_max3_f32 v8, v88, v89, v8
v_max3_f32 v8, v90, v91, v8
v_mov_b32 v9, v8
s_nop 1
v_permlane16_swap_b32 v8, v9
v_max_f32 v8, v8, v9
v_mov_b32 v9, v8
s_nop 1
v_permlane32_swap_b32 v8, v9
v_max_f32 v8, v8, v9
v_exp_f32 v9, -v8
v_sub_f32 v16, v16, v8
v_sub_f32 v17, v17, v8
v_sub_f32 v18, v18, v8
v_sub_f32 v19, v19, v8
v_mul_f32 v24, v24, v9
v_mul_f32 v128, v128, v9
v_mul_f32 v129, v129, v9
v_mul_f32 v130, v130, v9
v_mul_f32 v131, v131, v9
v_mul_f32 v136, v136, v9
v_mul_f32 v137, v137, v9
v_mul_f32 v138, v138, v9
v_mul_f32 v139, v139, v9
v_mul_f32 v144, v144, v9
v_mul_f32 v145, v145, v9
v_mul_f32 v146, v146, v9
v_mul_f32 v147, v147, v9
v_mul_f32 v152, v152, v9
v_mul_f32 v153, v153, v9
v_mul_f32 v154, v154, v9
v_mul_f32 v155, v155, v9
v_mul_f32 v160, v160, v9
v_mul_f32 v161, v161, v9
v_mul_f32 v162, v162, v9
v_mul_f32 v163, v163, v9
v_mul_f32 v168, v168, v9
v_mul_f32 v169, v169, v9
v_mul_f32 v170, v170, v9
v_mul_f32 v171, v171, v9
v_mul_f32 v176, v176, v9
v_mul_f32 v177, v177, v9
v_mul_f32 v178, v178, v9
v_mul_f32 v179, v179, v9
v_mul_f32 v184, v184, v9
v_mul_f32 v185, v185, v9
v_mul_f32 v186, v186, v9
v_mul_f32 v187, v187, v9
v_mul_f32 v192, v192, v9
v_mul_f32 v193, v193, v9
v_mul_f32 v194, v194, v9
v_mul_f32 v195, v195, v9
v_mul_f32 v200, v200, v9
v_mul_f32 v201, v201, v9
v_mul_f32 v202, v202, v9
v_mul_f32 v203, v203, v9
v_mul_f32 v208, v208, v9
v_mul_f32 v209, v209, v9
v_mul_f32 v210, v210, v9
v_mul_f32 v211, v211, v9
v_mul_f32 v216, v216, v9
v_mul_f32 v217, v217, v9
v_mul_f32 v218, v218, v9
v_mul_f32 v219, v219, v9
v_mul_f32 v224, v224, v9
v_mul_f32 v225, v225, v9
v_mul_f32 v226, v226, v9
v_mul_f32 v227, v227, v9
v_mul_f32 v232, v232, v9
v_mul_f32 v233, v233, v9
v_mul_f32 v234, v234, v9
v_mul_f32 v235, v235, v9
v_mul_f32 v240, v240, v9
v_mul_f32 v241, v241, v9
v_mul_f32 v242, v242, v9
v_mul_f32 v243, v243, v9
v_mul_f32 v248, v248, v9
v_mul_f32 v249, v249, v9
v_mul_f32 v250, v250, v9
v_mul_f32 v251, v251, v9
v_sub_f32 v32, v32, v8
v_sub_f32 v33, v33, v8
v_sub_f32 v34, v34, v8
v_sub_f32 v35, v35, v8
v_sub_f32 v40, v40, v8
v_sub_f32 v41, v41, v8
v_sub_f32 v42, v42, v8
v_sub_f32 v43, v43, v8
v_sub_f32 v48, v48, v8
v_sub_f32 v49, v49, v8
v_sub_f32 v50, v50, v8
v_sub_f32 v51, v51, v8
v_sub_f32 v56, v56, v8
v_sub_f32 v57, v57, v8
v_sub_f32 v58, v58, v8
v_sub_f32 v59, v59, v8
v_sub_f32 v64, v64, v8
v_sub_f32 v65, v65, v8
v_sub_f32 v66, v66, v8
v_sub_f32 v67, v67, v8
v_sub_f32 v72, v72, v8
v_sub_f32 v73, v73, v8
v_sub_f32 v74, v74, v8
v_sub_f32 v75, v75, v8
v_sub_f32 v80, v80, v8
v_sub_f32 v81, v81, v8
v_sub_f32 v82, v82, v8
v_sub_f32 v83, v83, v8
v_sub_f32 v88, v88, v8
v_sub_f32 v89, v89, v8
v_sub_f32 v90, v90, v8
v_sub_f32 v91, v91, v8
v_max3_f32 v8, v68, v69, 0
v_max3_f32 v8, v70, v71, v8
v_max3_f32 v8, v76, v77, v8
v_max3_f32 v8, v78, v79, v8
v_max3_f32 v8, v84, v85, v8
v_max3_f32 v8, v86, v87, v8
v_max3_f32 v8, v92, v93, v8
v_max3_f32 v8, v94, v95, v8
v_mov_b32 v9, v8
s_nop 1
v_permlane16_swap_b32 v8, v9
v_max_f32 v8, v8, v9
v_mov_b32 v9, v8
s_nop 1
v_permlane32_swap_b32 v8, v9
v_max_f32 v8, v8, v9
v_exp_f32 v9, -v8
v_sub_f32 v20, v20, v8
v_sub_f32 v21, v21, v8
v_sub_f32 v22, v22, v8
v_sub_f32 v23, v23, v8
v_mul_f32 v25, v25, v9
v_mul_f32 v132, v132, v9
v_mul_f32 v133, v133, v9
v_mul_f32 v134, v134, v9
v_mul_f32 v135, v135, v9
v_mul_f32 v140, v140, v9
v_mul_f32 v141, v141, v9
v_mul_f32 v142, v142, v9
v_mul_f32 v143, v143, v9
v_mul_f32 v148, v148, v9
v_mul_f32 v149, v149, v9
v_mul_f32 v150, v150, v9
v_mul_f32 v151, v151, v9
v_mul_f32 v156, v156, v9
v_mul_f32 v157, v157, v9
v_mul_f32 v158, v158, v9
v_mul_f32 v159, v159, v9
v_mul_f32 v164, v164, v9
v_mul_f32 v165, v165, v9
v_mul_f32 v166, v166, v9
v_mul_f32 v167, v167, v9
v_mul_f32 v172, v172, v9
v_mul_f32 v173, v173, v9
v_mul_f32 v174, v174, v9
v_mul_f32 v175, v175, v9
v_mul_f32 v180, v180, v9
v_mul_f32 v181, v181, v9
v_mul_f32 v182, v182, v9
v_mul_f32 v183, v183, v9
v_mul_f32 v188, v188, v9
v_mul_f32 v189, v189, v9
v_mul_f32 v190, v190, v9
v_mul_f32 v191, v191, v9
v_mul_f32 v196, v196, v9
v_mul_f32 v197, v197, v9
v_mul_f32 v198, v198, v9
v_mul_f32 v199, v199, v9
v_mul_f32 v204, v204, v9
v_mul_f32 v205, v205, v9
v_mul_f32 v206, v206, v9
v_mul_f32 v207, v207, v9
v_mul_f32 v212, v212, v9
v_mul_f32 v213, v213, v9
v_mul_f32 v214, v214, v9
v_mul_f32 v215, v215, v9
v_mul_f32 v220, v220, v9
v_mul_f32 v221, v221, v9
v_mul_f32 v222, v222, v9
v_mul_f32 v223, v223, v9
v_mul_f32 v228, v228, v9
v_mul_f32 v229, v229, v9
v_mul_f32 v230, v230, v9
v_mul_f32 v231, v231, v9
v_mul_f32 v236, v236, v9
v_mul_f32 v237, v237, v9
v_mul_f32 v238, v238, v9
v_mul_f32 v239, v239, v9
v_mul_f32 v244, v244, v9
v_mul_f32 v245, v245, v9
v_mul_f32 v246, v246, v9
v_mul_f32 v247, v247, v9
v_mul_f32 v252, v252, v9
v_mul_f32 v253, v253, v9
v_mul_f32 v254, v254, v9
v_mul_f32 v255, v255, v9
v_sub_f32 v36, v36, v8
v_sub_f32 v37, v37, v8
v_sub_f32 v38, v38, v8
v_sub_f32 v39, v39, v8
v_sub_f32 v44, v44, v8
v_sub_f32 v45, v45, v8
v_sub_f32 v46, v46, v8
v_sub_f32 v47, v47, v8
v_sub_f32 v52, v52, v8
v_sub_f32 v53, v53, v8
v_sub_f32 v54, v54, v8
v_sub_f32 v55, v55, v8
v_sub_f32 v60, v60, v8
v_sub_f32 v61, v61, v8
v_sub_f32 v62, v62, v8
v_sub_f32 v63, v63, v8
v_sub_f32 v68, v68, v8
v_sub_f32 v69, v69, v8
v_sub_f32 v70, v70, v8
v_sub_f32 v71, v71, v8
v_sub_f32 v76, v76, v8
v_sub_f32 v77, v77, v8
v_sub_f32 v78, v78, v8
v_sub_f32 v79, v79, v8
v_sub_f32 v84, v84, v8
v_sub_f32 v85, v85, v8
v_sub_f32 v86, v86, v8
v_sub_f32 v87, v87, v8
v_sub_f32 v92, v92, v8
v_sub_f32 v93, v93, v8
v_sub_f32 v94, v94, v8
v_sub_f32 v95, v95, v8
v_exp_f32 v8, v64
v_exp_f32 v9, v65
v_exp_f32 v10, v66
v_exp_f32 v11, v67
s_nop 0
v_add_f32 v26, v8, v9
v_cvt_pk_bf16_f32 v112, v8, v9
v_add_f32 v26, v26, v10
v_add_f32 v26, v26, v11
v_cvt_pk_bf16_f32 v113, v10, v11
v_exp_f32 v12, v68
v_exp_f32 v13, v69
v_exp_f32 v14, v70
v_exp_f32 v15, v71
s_nop 0
v_add_f32 v27, v12, v13
v_cvt_pk_bf16_f32 v120, v12, v13
v_add_f32 v27, v27, v14
v_add_f32 v27, v27, v15
v_cvt_pk_bf16_f32 v121, v14, v15
v_exp_f32 v8, v72
v_exp_f32 v9, v73
v_exp_f32 v10, v74
v_exp_f32 v11, v75
s_nop 0
v_add_f32 v26, v26, v8
v_add_f32 v26, v26, v9
v_cvt_pk_bf16_f32 v114, v8, v9
v_add_f32 v26, v26, v10
v_add_f32 v26, v26, v11
v_cvt_pk_bf16_f32 v115, v10, v11
v_exp_f32 v12, v76
v_exp_f32 v13, v77
v_exp_f32 v14, v78
v_exp_f32 v15, v79
s_nop 0
v_add_f32 v27, v27, v12
v_add_f32 v27, v27, v13
v_cvt_pk_bf16_f32 v122, v12, v13
v_add_f32 v27, v27, v14
v_add_f32 v27, v27, v15
v_cvt_pk_bf16_f32 v123, v14, v15
v_exp_f32 v8, v80
v_exp_f32 v9, v81
v_exp_f32 v10, v82
v_exp_f32 v11, v83
s_nop 0
v_add_f32 v26, v26, v8
v_add_f32 v26, v26, v9
v_cvt_pk_bf16_f32 v116, v8, v9
v_add_f32 v26, v26, v10
v_add_f32 v26, v26, v11
v_cvt_pk_bf16_f32 v117, v10, v11
v_exp_f32 v12, v84
v_exp_f32 v13, v85
v_exp_f32 v14, v86
v_exp_f32 v15, v87
s_nop 0
v_add_f32 v27, v27, v12
v_add_f32 v27, v27, v13
v_cvt_pk_bf16_f32 v124, v12, v13
v_add_f32 v27, v27, v14
v_add_f32 v27, v27, v15
v_cvt_pk_bf16_f32 v125, v14, v15
v_exp_f32 v8, v88
v_exp_f32 v9, v89
v_exp_f32 v10, v90
v_exp_f32 v11, v91
s_nop 0
v_add_f32 v26, v26, v8
v_add_f32 v26, v26, v9
v_cvt_pk_bf16_f32 v118, v8, v9
v_add_f32 v26, v26, v10
v_add_f32 v26, v26, v11
v_cvt_pk_bf16_f32 v119, v10, v11
v_exp_f32 v12, v92
v_exp_f32 v13, v93
v_exp_f32 v14, v94
v_exp_f32 v15, v95
s_nop 0
v_add_f32 v27, v27, v12
v_add_f32 v27, v27, v13
v_cvt_pk_bf16_f32 v126, v12, v13
v_add_f32 v27, v27, v14
v_add_f32 v27, v27, v15
v_cvt_pk_bf16_f32 v127, v14, v15
s_nop 1
s_setpc_b64 s[16:17]
K2_slow2:
s_nop 7
s_nop 7
v_max3_f32 v8, v68, v69, 0
v_max3_f32 v8, v70, v71, v8
v_max3_f32 v8, v76, v77, v8
v_max3_f32 v8, v78, v79, v8
v_max3_f32 v8, v84, v85, v8
v_max3_f32 v8, v86, v87, v8
v_max3_f32 v8, v92, v93, v8
v_max3_f32 v8, v94, v95, v8
v_mov_b32 v9, v8
s_nop 1
v_permlane16_swap_b32 v8, v9
v_max_f32 v8, v8, v9
v_mov_b32 v9, v8
s_nop 1
v_permlane32_swap_b32 v8, v9
v_max_f32 v8, v8, v9
v_exp_f32 v9, -v8
v_sub_f32 v20, v20, v8
v_sub_f32 v21, v21, v8
v_sub_f32 v22, v22, v8
v_sub_f32 v23, v23, v8
v_mul_f32 v25, v25, v9
v_mul_f32 v132, v132, v9
v_mul_f32 v133, v133, v9
v_mul_f32 v134, v134, v9
v_mul_f32 v135, v135, v9
v_mul_f32 v140, v140, v9
v_mul_f32 v141, v141, v9
v_mul_f32 v142, v142, v9
v_mul_f32 v143, v143, v9
v_mul_f32 v148, v148, v9
v_mul_f32 v149, v149, v9
v_mul_f32 v150, v150, v9
v_mul_f32 v151, v151, v9
v_mul_f32 v156, v156, v9
v_mul_f32 v157, v157, v9
v_mul_f32 v158, v158, v9
v_mul_f32 v159, v159, v9
v_mul_f32 v164, v164, v9
v_mul_f32 v165, v165, v9
v_mul_f32 v166, v166, v9
v_mul_f32 v167, v167, v9
v_mul_f32 v172, v172, v9
v_mul_f32 v173, v173, v9
v_mul_f32 v174, v174, v9
v_mul_f32 v175, v175, v9
v_mul_f32 v180, v180, v9
v_mul_f32 v181, v181, v9
v_mul_f32 v182, v182, v9
v_mul_f32 v183, v183, v9
v_mul_f32 v188, v188, v9
v_mul_f32 v189, v189, v9
v_mul_f32 v190, v190, v9
v_mul_f32 v191, v191, v9
v_mul_f32 v196, v196, v9
v_mul_f32 v197, v197, v9
v_mul_f32 v198, v198, v9
v_mul_f32 v199, v199, v9
v_mul_f32 v204, v204, v9
v_mul_f32 v205, v205, v9
v_mul_f32 v206, v206, v9
v_mul_f32 v207, v207, v9
v_mul_f32 v212, v212, v9
v_mul_f32 v213, v213, v9
v_mul_f32 v214, v214, v9
v_mul_f32 v215, v215, v9
v_mul_f32 v220, v220, v9
v_mul_f32 v221, v221, v9
v_mul_f32 v222, v222, v9
v_mul_f32 v223, v223, v9
v_mul_f32 v228, v228, v9
v_mul_f32 v229, v229, v9
v_mul_f32 v230, v230, v9
v_mul_f32 v231, v231, v9
v_mul_f32 v236, v236, v9
v_mul_f32 v237, v237, v9
v_mul_f32 v238, v238, v9
v_mul_f32 v239, v239, v9
v_mul_f32 v244, v244, v9
v_mul_f32 v245, v245, v9
v_mul_f32 v246, v246, v9
v_mul_f32 v247, v247, v9
v_mul_f32 v252, v252, v9
v_mul_f32 v253, v253, v9
v_mul_f32 v254, v254, v9
v_mul_f32 v255, v255, v9
v_sub_f32 v68, v68, v8
v_sub_f32 v69, v69, v8
v_sub_f32 v70, v70, v8
v_sub_f32 v71, v71, v8
v_sub_f32 v76, v76, v8
v_sub_f32 v77, v77, v8
v_sub_f32 v78, v78, v8
v_sub_f32 v79, v79, v8
v_sub_f32 v84, v84, v8
v_sub_f32 v85, v85, v8
v_sub_f32 v86, v86, v8
v_sub_f32 v87, v87, v8
v_sub_f32 v92, v92, v8
v_sub_f32 v93, v93, v8
v_sub_f32 v94, v94, v8
v_sub_f32 v95, v95, v8
v_exp_f32 v8, v68
v_exp_f32 v9, v69
v_exp_f32 v10, v70
v_exp_f32 v11, v71
s_nop 0
v_add_f32 v27, v8, v9
v_cvt_pk_bf16_f32 v120, v8, v9
v_add_f32 v27, v27, v10
v_add_f32 v27, v27, v11
v_cvt_pk_bf16_f32 v121, v10, v11
v_exp_f32 v12, v76
v_exp_f32 v13, v77
v_exp_f32 v14, v78
v_exp_f32 v15, v79
s_nop 0
v_add_f32 v27, v27, v12
v_add_f32 v27, v27, v13
v_cvt_pk_bf16_f32 v122, v12, v13
v_add_f32 v27, v27, v14
v_add_f32 v27, v27, v15
v_cvt_pk_bf16_f32 v123, v14, v15
v_exp_f32 v8, v84
v_exp_f32 v9, v85
v_exp_f32 v10, v86
v_exp_f32 v11, v87
s_nop 0
v_add_f32 v27, v27, v8
v_add_f32 v27, v27, v9
v_cvt_pk_bf16_f32 v124, v8, v9
v_add_f32 v27, v27, v10
v_add_f32 v27, v27, v11
v_cvt_pk_bf16_f32 v125, v10, v11
v_exp_f32 v12, v92
v_exp_f32 v13, v93
v_exp_f32 v14, v94
v_exp_f32 v15, v95
s_nop 0
v_add_f32 v27, v27, v12
v_add_f32 v27, v27, v13
v_cvt_pk_bf16_f32 v126, v12, v13
v_add_f32 v27, v27, v14
v_add_f32 v27, v27, v15
v_cvt_pk_bf16_f32 v127, v14, v15
s_nop 1
s_setpc_b64 s[16:17]
M_cntspinK:
Lp_9801:
buffer_load_dword v245, off, s[60:63], 0 sc1
s_waitcnt vmcnt(0)
v_cmp_gt_u32 vcc, 0x100, v245
s_cbranch_vccz Lpd_9802
s_sleep 8
s_sub_u32 s101, s101, 1
s_cbranch_scc0 Lp_9801
s_mov_b32 s101, 0
Lpd_9802:
s_branch Lg_1
M_ppspinK:
Lp_9803:
buffer_load_dword v230, v231, s[4:7], s52 offen sc1
s_waitcnt vmcnt(0)
v_cmp_gt_u32 vcc, 1, v230
s_cbranch_vccz Lpd_9804
s_sleep 8
s_sub_u32 s101, s101, 1
s_cbranch_scc0 Lp_9803
s_mov_b32 s101, 0
Lpd_9804:
s_branch M_ppokK
M_cntspinV:
Lp_9805:
buffer_load_dword v245, off, s[60:63], 0 sc1
s_waitcnt vmcnt(0)
v_cmp_gt_u32 vcc, 0x100, v245
s_cbranch_vccz Lpd_9806
s_sleep 8
s_sub_u32 s101, s101, 1
s_cbranch_scc0 Lp_9805
s_mov_b32 s101, 0
Lpd_9806:
s_branch Lg_501
M_ppspinV:
Lp_9807:
buffer_load_dword v230, v231, s[4:7], s52 offen sc1
s_waitcnt vmcnt(0)
v_cmp_gt_u32 vcc, 1, v230
s_cbranch_vccz Lpd_9808
s_sleep 8
s_sub_u32 s101, s101, 1
s_cbranch_scc0 Lp_9807
s_mov_b32 s101, 0
Lpd_9808:
s_branch M_ppokV
M_end:
s_endpgm
.section .rodata,"a"
.p2align 6
.amdhsa_kernel concat_heads__ssm_conv_h3__compressed_kv_cla__prompt_kernel
  .amdhsa_next_free_vgpr 512
  .amdhsa_next_free_sgpr 102
  .amdhsa_accum_offset 256
  .amdhsa_group_segment_fixed_size 0
  .amdhsa_kernarg_size 120
  .amdhsa_user_sgpr_count 2
  .amdhsa_user_sgpr_kernarg_segment_ptr 1
  .amdhsa_system_sgpr_workgroup_id_x 1
  .amdhsa_float_denorm_mode_32 3
  .amdhsa_float_denorm_mode_16_64 3
  .amdhsa_ieee_mode 0
  .amdhsa_dx10_clamp 0
.end_amdhsa_kernel
```

```asm
; @launch grid=(256,1,1) block=(256,1,1) lds=163840
.amdgcn_target "amdgcn-amd-amdhsa--gfx950"
.text
.globl concat_heads__ssm_conv_h3__compressed_kv_cla__prompt_kernel
.p2align 8
.type concat_heads__ssm_conv_h3__compressed_kv_cla__prompt_kernel,@function
concat_heads__ssm_conv_h3__compressed_kv_cla__prompt_kernel:
s_cmp_ge_u32 s2, 256
s_cbranch_scc1 M_end
s_load_dwordx16 s[64:79], s[0:1], 0
s_load_dwordx8 s[80:87], s[0:1], 64
s_load_dwordx4 s[88:91], s[0:1], 96
s_load_dwordx2 s[92:93], s[0:1], 112
s_getpc_b64 s[58:59]
M_pc:
s_lshr_b32 s22, s2, 3
s_lshl_b32 s22, s22, 5
v_and_b32 v26, 31, v0
v_add_u32 v26, s22, v26
v_lshlrev_b32 v26, 7, v26
v_min_u32 v26, M_end-M_pc, v26
v_mov_b32 v27, s59
v_add_co_u32 v26, vcc, s58, v26
s_nop 1
v_addc_co_u32 v27, vcc, 0, v27, vcc
global_load_dword v21, v[26:27], off
v_lshrrev_b32 v28, 6, v0
v_and_b32 v29, 63, v0
v_lshlrev_b32 v1, 4, v29
v_readfirstlane_b32 s3, v28
s_lshr_b32 s21, s2, 5
v_lshrrev_b32 v26, 7, v1
v_lshrrev_b32 v27, 1, v26
v_lshlrev_b32 v27, 4, v27
v_and_b32 v28, 0x70, v1
v_xor_b32 v27, v27, v28
v_mul_u32_u24 v26, 2048, v26
v_add_u32 v12, v26, v27
v_xor_b32 v27, 64, v27
v_add_u32 v26, v26, v27
v_add_u32 v13, 15360, v26
v_add_u32 v14, 30720, v12
v_add_u32 v15, 46080, v26
s_lshl_b32 s28, s3, 13
s_lshl_b32 s24, s21, 19
s_lshl_b32 s22, s3, 17
s_add_u32 s24, s24, s22
s_add_u32 s25, s24, 65536
s_mov_b32 s10, 4194304
s_mov_b32 s11, 0x20000
s_and_b32 s20, s2, 7
s_lshl_b32 s20, s20, 1
s_bfe_u32 s22, s2, 0x10003
s_add_u32 s20, s20, s22
v_lshrrev_b32 v26, 5, v29
v_and_b32 v27, 31, v29
s_and_b32 s22, s3, 1
s_lshl_b32 s22, s22, 2
v_or_b32 v28, s22, v26
v_lshlrev_b32 v28, 1, v28
v_xor_b32 v27, v27, v28
v_lshlrev_b32 v27, 4, v27
v_lshl_add_u32 v16, v26, 13, v27
v_xor_b32 v26, 64, v16
v_add_u32 v17, 15360, v26
v_add_u32 v18, 30720, v16
v_add_u32 v19, 46080, v26
s_lshl_b32 s29, s3, 12
s_lshl_b32 s26, s3, 16
s_lshl_b32 s22, s20, 9
s_add_u32 s26, s26, s22
s_add_u32 s27, s26, 262144
s_mov_b32 s14, 8388608
s_mov_b32 s15, 0x20000
s_mov_b32 s101, 0x40000
v_and_b32 v30, 15, v29
v_lshrrev_b32 v31, 4, v29
v_lshrrev_b32 v26, 1, v30
v_xor_b32 v26, v31, v26
v_lshlrev_b32 v26, 4, v26
v_lshl_add_u32 v2, v30, 7, v26
s_lshr_b32 s22, s3, 1
s_lshl_b32 s22, s22, 14
v_add_u32 v2, s22, v2
v_xor_b32 v3, 64, v2
v_lshrrev_b32 v26, 2, v30
v_and_b32 v27, 1, v31
v_lshl_or_b32 v27, v27, 2, v26
v_lshl_add_u32 v26, v31, 3, v26
v_lshlrev_b32 v26, 9, v26
v_lshl_add_u32 v26, v27, 5, v26
v_and_b32 v27, 3, v29
v_lshl_add_u32 v26, v27, 3, v26
s_and_b32 s22, s3, 1
s_lshl_b32 s22, s22, 8
s_add_u32 s22, s22, 0x10000
v_xor_b32 v4, s22, v26
v_xor_b32 v5, 32, v4
v_xor_b32 v6, 64, v4
v_xor_b32 v7, 96, v4
v_xor_b32 v8, 128, v4
v_xor_b32 v9, 160, v4
v_xor_b32 v10, 192, v4
v_xor_b32 v11, 224, v4
s_mov_b32 s19, 0x20000
s_cmp_eq_u32 s3, 2
s_cbranch_scc1 M_pf2
s_cmp_lg_u32 s3, 0
s_cbranch_scc1 M_pf3
s_mov_b32 s18, 8388608
s_mov_b32 s51, 8388608
s_mov_b32 s47, 524288
s_mov_b32 s43, 524288
s_lshl_b32 s22, s21, 16
s_lshl_b32 s23, s20, 9
s_add_u32 s22, s22, s23
v_bfe_u32 v26, v29, 2, 3
v_lshl_add_u32 v26, v26, 13, s22
v_and_b32 v27, 3, v29
v_lshl_add_u32 v20, v27, 7, v26
v_lshrrev_b32 v27, 5, v29
v_lshl_add_u32 v22, v27, 19, v20
s_mov_b32 s47, 655360
s_mov_b32 s43, 262144
v_add_u32 v22, 262144, v22
s_mul_i32 s22, s21, 81920
s_add_u32 s22, s22, s23
v_lshrrev_b32 v26, 2, v29
v_lshl_add_u32 v26, v26, 13, s22
v_and_b32 v27, 3, v29
v_lshl_add_u32 v20, v27, 7, v26
v_cmp_gt_u32 vcc, 40, v29
s_branch M_pfd
M_pf2:
s_mov_b32 s18, 4194304
s_mov_b32 s51, 2048
s_mov_b32 s47, 256
s_mov_b32 s43, 0
s_lshl_b32 s22, s2, 14
v_bfe_u32 v26, v29, 1, 3
v_lshl_add_u32 v26, v26, 11, s22
v_and_b32 v27, 1, v29
v_lshl_add_u32 v20, v27, 7, v26
v_bfe_u32 v27, v29, 4, 1
v_lshl_add_u32 v22, v27, 8, v20
v_cmp_gt_u32 vcc, 16, v29
s_branch M_pfd
M_pf3:
s_mov_b32 s18, 0
s_mov_b32 s51, 2752512
s_mov_b32 s47, 688128
s_mov_b32 s43, 0
s_mul_i32 s22, s2, 2688
v_lshl_add_u32 v20, v29, 7, s22
v_mov_b32 v22, v20
v_cmp_gt_u32 vcc, 21, v29
M_pfd:
v_mov_b32 v26, 3221225472
s_nop 0
v_cndmask_b32 v20, v26, v20, vcc
s_bitcmp1_b32 s2, 4
s_waitcnt lgkmcnt(0)
s_mov_b64 s[8:9], s[78:79]
s_cselect_b64 s[12:13], s[84:85], s[82:83]
s_add_u32 m0, s28, 0
s_nop 0
buffer_load_dwordx4 v12, s[8:11], s24 offen offset:0 lds
buffer_load_dwordx4 v13, s[8:11], s24 offen offset:1024 lds
buffer_load_dwordx4 v14, s[8:11], s24 offen offset:2048 lds
buffer_load_dwordx4 v15, s[8:11], s24 offen offset:3072 lds
s_add_u32 s24, s24, 128
s_add_u32 m0, s28, 4096
s_nop 0
buffer_load_dwordx4 v12, s[8:11], s25 offen offset:0 lds
buffer_load_dwordx4 v13, s[8:11], s25 offen offset:1024 lds
buffer_load_dwordx4 v14, s[8:11], s25 offen offset:2048 lds
buffer_load_dwordx4 v15, s[8:11], s25 offen offset:3072 lds
s_add_u32 s25, s25, 128
s_add_u32 m0, s29, 65536
s_nop 0
buffer_load_dwordx4 v16, s[12:15], s26 offen offset:0 lds
buffer_load_dwordx4 v17, s[12:15], s26 offen offset:1024 lds
buffer_load_dwordx4 v18, s[12:15], s26 offen offset:2048 lds
buffer_load_dwordx4 v19, s[12:15], s26 offen offset:3072 lds
s_add_u32 s26, s26, 524288
s_add_u32 m0, s29, 81920
s_nop 0
buffer_load_dwordx4 v16, s[12:15], s27 offen offset:0 lds
buffer_load_dwordx4 v17, s[12:15], s27 offen offset:1024 lds
buffer_load_dwordx4 v18, s[12:15], s27 offen offset:2048 lds
buffer_load_dwordx4 v19, s[12:15], s27 offen offset:3072 lds
s_add_u32 s27, s27, 524288
s_mov_b64 exec, 0
s_bfe_u32 s22, s2, 0x10004
s_lshl_b32 s22, s22, 2
s_add_u32 s22, s22, s3
s_cmp_lg_u32 s22, 0
s_cbranch_scc1 M_tw1
s_call_b64 s[98:99], PAD_0
s_call_b64 s[98:99], PAD_8
s_branch M_td
M_tw1:
s_cmp_lg_u32 s22, 1
s_cbranch_scc1 M_tw2
s_call_b64 s[98:99], PAD_1
s_call_b64 s[98:99], PAD_9
s_branch M_td
M_tw2:
s_cmp_lg_u32 s22, 2
s_cbranch_scc1 M_tw3
s_call_b64 s[98:99], PAD_2
s_call_b64 s[98:99], PAD_6
s_call_b64 s[98:99], PAD_10
s_branch M_td
M_tw3:
s_cmp_lg_u32 s22, 3
s_cbranch_scc1 M_tw4
s_call_b64 s[98:99], PAD_3
s_call_b64 s[98:99], PAD_7
s_call_b64 s[98:99], PAD_11
s_branch M_td
M_tw4:
s_cmp_lg_u32 s22, 4
s_cbranch_scc1 M_tw5
s_call_b64 s[98:99], PAD_22
s_branch M_td
M_tw5:
s_cmp_lg_u32 s22, 5
s_cbranch_scc1 M_tw6
s_call_b64 s[98:99], PAD_23
s_branch M_td
M_tw6:
s_cmp_lg_u32 s22, 6
s_cbranch_scc1 M_tw7
s_call_b64 s[98:99], PAD_24
s_branch M_td
M_tw7:
s_call_b64 s[98:99], PAD_21
M_td:
s_mov_b64 exec, -1
s_add_u32 m0, s28, 32768
s_nop 0
buffer_load_dwordx4 v12, s[8:11], s24 offen offset:0 lds
buffer_load_dwordx4 v13, s[8:11], s24 offen offset:1024 lds
buffer_load_dwordx4 v14, s[8:11], s24 offen offset:2048 lds
buffer_load_dwordx4 v15, s[8:11], s24 offen offset:3072 lds
s_add_u32 s24, s24, 128
s_add_u32 m0, s28, 36864
s_nop 0
buffer_load_dwordx4 v12, s[8:11], s25 offen offset:0 lds
buffer_load_dwordx4 v13, s[8:11], s25 offen offset:1024 lds
buffer_load_dwordx4 v14, s[8:11], s25 offen offset:2048 lds
buffer_load_dwordx4 v15, s[8:11], s25 offen offset:3072 lds
s_add_u32 s25, s25, 128
s_cmp_eq_u32 s3, 0
s_cselect_b64 s[16:17], s[12:13], s[8:9]
buffer_load_dword v21, v22, s[16:19], s43 offen
s_add_u32 s43, s43, s47
s_add_u32 s43, s43, s47
s_mov_b32 s4, s92
s_mov_b32 s5, s93
s_mov_b32 s6, 268435456
s_mov_b32 s7, 0x20000
s_cmp_eq_u32 s3, 3
s_cselect_b64 s[40:41], s[76:77], s[80:81]
s_cselect_b32 s42, 1835008, 0
s_cmp_eq_u32 s3, 1
s_cselect_b32 s42, 3670016, s42
s_cmp_eq_u32 s3, 3
s_cselect_b64 s[44:45], s[86:87], s[72:73]
s_cselect_b32 s46, 3670016, 0
s_cmp_eq_u32 s3, 1
s_cselect_b32 s46, 1835008, s46
s_cmp_eq_u32 s3, 2
s_cselect_b64 s[40:41], s[64:65], s[40:41]
s_cselect_b32 s42, 1835008, s42
s_waitcnt vmcnt(17)
s_barrier
ds_read_b128 a[0:3], v2 offset:0
ds_read_b128 a[4:7], v3 offset:0
ds_read_b128 a[8:11], v2 offset:2048
ds_read_b128 a[12:15], v3 offset:2048
ds_read_b128 a[16:19], v2 offset:4096
ds_read_b128 a[20:23], v3 offset:4096
ds_read_b128 a[24:27], v2 offset:6144
ds_read_b128 a[28:31], v3 offset:6144
ds_read_b128 a[32:35], v2 offset:8192
ds_read_b128 a[36:39], v3 offset:8192
ds_read_b128 a[40:43], v2 offset:10240
ds_read_b128 a[44:47], v3 offset:10240
ds_read_b128 a[48:51], v2 offset:12288
ds_read_b128 a[52:55], v3 offset:12288
ds_read_b128 a[56:59], v2 offset:14336
ds_read_b128 a[60:63], v3 offset:14336
s_waitcnt vmcnt(9) lgkmcnt(0)
s_barrier
ds_read_b64_tr_b16 a[128:129], v4 offset:0
ds_read_b64_tr_b16 a[130:131], v4 offset:2048
ds_read_b64_tr_b16 a[132:133], v4 offset:16384
ds_read_b64_tr_b16 a[134:135], v4 offset:18432
s_waitcnt lgkmcnt(0)
s_bitcmp1_b32 s2, 4
s_cbranch_scc1 M_V
s_branch M_K
M_t2B:
s_mov_b64 exec, 0
s_cmp_lg_u32 s3, 0
s_cbranch_scc1 M_uw1
s_call_b64 s[98:99], PAD_32
s_call_b64 s[98:99], PAD_16
s_branch M_ud
M_uw1:
s_cmp_lg_u32 s3, 1
s_cbranch_scc1 M_uw2
s_call_b64 s[98:99], PAD_9
s_call_b64 s[98:99], PAD_33
s_call_b64 s[98:99], PAD_13
s_branch M_ud
M_uw2:
s_cmp_lg_u32 s3, 2
s_cbranch_scc1 M_uw3
s_call_b64 s[98:99], PAD_10
s_call_b64 s[98:99], PAD_34
s_call_b64 s[98:99], PAD_14
s_branch M_ud
M_uw3:
s_call_b64 s[98:99], PAD_11
s_call_b64 s[98:99], PAD_15
M_ud:
s_mov_b64 exec, -1
s_branch M_t2Br
M_t2A:
s_mov_b64 exec, 0
s_lshl_b32 s22, s24, 2
s_add_u32 s22, s22, s3
s_cmp_lg_u32 s22, 0
s_cbranch_scc1 M_vw1
s_call_b64 s[98:99], PAD_32
s_call_b64 s[98:99], PAD_16
s_branch M_vd
M_vw1:
s_cmp_lg_u32 s22, 1
s_cbranch_scc1 M_vw2
s_call_b64 s[98:99], PAD_13
s_branch M_vd
M_vw2:
s_cmp_lg_u32 s22, 2
s_cbranch_scc1 M_vw3
s_call_b64 s[98:99], PAD_14
s_call_b64 s[98:99], PAD_19
s_branch M_vd
M_vw3:
s_cmp_lg_u32 s22, 3
s_cbranch_scc1 M_vw4
s_call_b64 s[98:99], PAD_15
s_call_b64 s[98:99], PAD_20
s_branch M_vd
M_vw4:
s_cmp_lg_u32 s22, 4
s_cbranch_scc1 M_vw5
s_call_b64 s[98:99], PAD_12
s_call_b64 s[98:99], PAD_16
s_branch M_vd
M_vw5:
s_cmp_lg_u32 s22, 5
s_cbranch_scc1 M_vw6
s_call_b64 s[98:99], PAD_13
s_branch M_vd
M_vw6:
s_cmp_lg_u32 s22, 6
s_cbranch_scc1 M_vw7
s_call_b64 s[98:99], PAD_14
s_branch M_vd
M_vw7:
s_call_b64 s[98:99], PAD_15
M_vd:
s_mov_b64 exec, -1
s_branch M_t2Ar
M_tret:
s_setpc_b64 s[98:99]
.p2align 12
PAD_0:
s_cbranch_execz PAD_4
M_K:
v_mfma_f32_16x16x32_bf16 v[32:35], a[128:131], a[0:3], 0
s_add_u32 m0, s29, 98304
ds_read_b64_tr_b16 a[136:137], v5 offset:0
v_mfma_f32_16x16x32_bf16 v[32:35], a[132:135], a[4:7], v[32:35]
s_mov_b32 s32, 8192
buffer_load_dwordx4 v16, s[12:15], s26 offen offset:0 lds
v_mfma_f32_16x16x32_bf16 v[40:43], a[128:131], a[8:11], 0
s_mov_b32 s33, 8192
ds_read_b64_tr_b16 a[138:139], v5 offset:2048
v_mfma_f32_16x16x32_bf16 v[40:43], a[132:135], a[12:15], v[40:43]
s_mov_b32 s34, 8192
v_mfma_f32_16x16x32_bf16 v[48:51], a[128:131], a[16:19], 0
s_mov_b32 s35, 4294910976
ds_read_b64_tr_b16 a[140:141], v5 offset:16384
v_mfma_f32_16x16x32_bf16 v[48:51], a[132:135], a[20:23], v[48:51]
s_mov_b32 s36, 4294910976
buffer_load_dwordx4 v17, s[12:15], s26 offen offset:1024 lds
v_mfma_f32_16x16x32_bf16 v[56:59], a[128:131], a[24:27], 0
s_mov_b32 s30, 8
ds_read_b64_tr_b16 a[142:143], v5 offset:18432
v_mfma_f32_16x16x32_bf16 v[56:59], a[132:135], a[28:31], v[56:59]
s_mov_b32 s82, 3221225472
v_mfma_f32_16x16x32_bf16 v[64:67], a[128:131], a[32:35], 0
s_mul_hi_u32 s38, s2, 613566757
v_mfma_f32_16x16x32_bf16 v[64:67], a[132:135], a[36:39], v[64:67]
s_mul_i32 s39, s38, 7
buffer_load_dwordx4 v18, s[12:15], s26 offen offset:2048 lds
v_mfma_f32_16x16x32_bf16 v[72:75], a[128:131], a[40:43], 0
s_sub_u32 s39, s2, s39
v_mov_b32 v246, 0
v_mov_b32 v229, 0
v_mfma_f32_16x16x32_bf16 v[72:75], a[132:135], a[44:47], v[72:75]
v_mov_b32 v231, 0
v_mfma_f32_16x16x32_bf16 v[80:83], a[128:131], a[48:51], 0
s_mov_b32 s60, s90
v_mfma_f32_16x16x32_bf16 v[80:83], a[132:135], a[52:55], v[80:83]
s_mov_b32 s61, s91
buffer_load_dwordx4 v19, s[12:15], s26 offen offset:3072 lds
v_mfma_f32_16x16x32_bf16 v[88:91], a[128:131], a[56:59], 0
s_add_u32 s26, s26, 524288
v_mfma_f32_16x16x32_bf16 v[88:91], a[132:135], a[60:63], v[88:91]
s_waitcnt lgkmcnt(0)
s_mov_b32 s62, 256
v_mfma_f32_16x16x32_bf16 v[36:39], a[136:139], a[0:3], 0
s_add_u32 m0, s29, 114688
ds_read_b64_tr_b16 a[128:129], v6 offset:0
v_mfma_f32_16x16x32_bf16 v[36:39], a[140:143], a[4:7], v[36:39]
s_mov_b32 s63, 0x20000
buffer_load_dwordx4 v16, s[12:15], s27 offen offset:0 lds
v_mfma_f32_16x16x32_bf16 v[44:47], a[136:139], a[8:11], 0
s_mul_hi_u32 s55, s2, 1431655766
ds_read_b64_tr_b16 a[130:131], v6 offset:2048
v_mfma_f32_16x16x32_bf16 v[44:47], a[140:143], a[12:15], v[44:47]
s_mul_i32 s55, s55, 3
v_mfma_f32_16x16x32_bf16 v[52:55], a[136:139], a[16:19], 0
s_sub_u32 s55, s2, s55
ds_read_b64_tr_b16 a[132:133], v6 offset:16384
v_mfma_f32_16x16x32_bf16 v[52:55], a[140:143], a[20:23], v[52:55]
s_add_u32 s55, s55, 5
buffer_load_dwordx4 v17, s[12:15], s27 offen offset:1024 lds
v_mfma_f32_16x16x32_bf16 v[60:63], a[136:139], a[24:27], 0
s_lshr_b32 s22, s2, 4
ds_read_b64_tr_b16 a[134:135], v6 offset:18432
v_mfma_f32_16x16x32_bf16 v[60:63], a[140:143], a[28:31], v[60:63]
s_lshl_b32 s23, s20, 5
v_mfma_f32_16x16x32_bf16 v[68:71], a[136:139], a[32:35], 0
s_add_u32 s23, s23, s22
v_mfma_f32_16x16x32_bf16 v[68:71], a[140:143], a[36:39], v[68:71]
s_lshl_b32 s23, s23, 2
buffer_load_dwordx4 v18, s[12:15], s27 offen offset:2048 lds
v_mfma_f32_16x16x32_bf16 v[76:79], a[136:139], a[40:43], 0
s_and_b32 s22, s2, 16
v_mfma_f32_16x16x32_bf16 v[76:79], a[140:143], a[44:47], v[76:79]
s_lshl_b32 s22, s22, 7
v_mfma_f32_16x16x32_bf16 v[84:87], a[136:139], a[48:51], 0
s_add_u32 s23, s23, s22
v_mov_b32 v28, 3221225472
v_writelane_b32 v28, s23, 0
v_mfma_f32_16x16x32_bf16 v[84:87], a[140:143], a[52:55], v[84:87]
s_add_u32 s56, s23, 16384
buffer_load_dwordx4 v19, s[12:15], s27 offen offset:3072 lds
v_mfma_f32_16x16x32_bf16 v[92:95], a[136:139], a[56:59], 0
s_add_u32 s27, s27, 524288
v_writelane_b32 v28, s56, 1
v_mfma_f32_16x16x32_bf16 v[92:95], a[140:143], a[60:63], v[92:95]
s_waitcnt lgkmcnt(0)
s_add_u32 s56, s23, 4096
v_writelane_b32 v28, s56, 2
v_mfma_f32_16x16x32_bf16 v[96:99], a[128:131], a[0:3], 0
s_add_u32 m0, s28, 0
ds_read_b64_tr_b16 a[136:137], v7 offset:0
v_mfma_f32_16x16x32_bf16 v[96:99], a[132:135], a[4:7], v[96:99]
s_sub_u32 s37, 15, s21
buffer_load_dwordx4 v12, s[8:11], s24 offen offset:0 lds
v_mfma_f32_16x16x32_bf16 v[104:107], a[128:131], a[8:11], 0
ds_read_b64_tr_b16 a[138:139], v7 offset:2048
v_mfma_f32_16x16x32_bf16 v[104:107], a[132:135], a[12:15], v[104:107]
v_mfma_f32_16x16x32_bf16 v[112:115], a[128:131], a[16:19], 0
ds_read_b64_tr_b16 a[140:141], v7 offset:16384
v_mfma_f32_16x16x32_bf16 v[112:115], a[132:135], a[20:23], v[112:115]
buffer_load_dwordx4 v13, s[8:11], s24 offen offset:1024 lds
v_mfma_f32_16x16x32_bf16 v[120:123], a[128:131], a[24:27], 0
ds_read_b64_tr_b16 a[142:143], v7 offset:18432
v_mfma_f32_16x16x32_bf16 v[120:123], a[132:135], a[28:31], v[120:123]
v_mfma_f32_16x16x32_bf16 v[128:131], a[128:131], a[32:35], 0
v_mfma_f32_16x16x32_bf16 v[128:131], a[132:135], a[36:39], v[128:131]
buffer_load_dwordx4 v14, s[8:11], s24 offen offset:2048 lds
v_mfma_f32_16x16x32_bf16 v[136:139], a[128:131], a[40:43], 0
v_mfma_f32_16x16x32_bf16 v[136:139], a[132:135], a[44:47], v[136:139]
v_mfma_f32_16x16x32_bf16 v[144:147], a[128:131], a[48:51], 0
v_mfma_f32_16x16x32_bf16 v[144:147], a[132:135], a[52:55], v[144:147]
buffer_load_dwordx4 v15, s[8:11], s24 offen offset:3072 lds
v_mfma_f32_16x16x32_bf16 v[152:155], a[128:131], a[56:59], 0
s_add_u32 s24, s24, 128
v_mfma_f32_16x16x32_bf16 v[152:155], a[132:135], a[60:63], v[152:155]
s_waitcnt vmcnt(13) lgkmcnt(0)
s_barrier
v_mfma_f32_16x16x32_bf16 v[100:103], a[136:139], a[0:3], 0
s_add_u32 m0, s28, 4096
ds_read_b64_tr_b16 a[128:129], v8 offset:0
v_mfma_f32_16x16x32_bf16 v[100:103], a[140:143], a[4:7], v[100:103]
buffer_load_dwordx4 v12, s[8:11], s25 offen offset:0 lds
v_mfma_f32_16x16x32_bf16 v[108:111], a[136:139], a[8:11], 0
ds_read_b64_tr_b16 a[130:131], v8 offset:2048
v_mfma_f32_16x16x32_bf16 v[108:111], a[140:143], a[12:15], v[108:111]
v_mfma_f32_16x16x32_bf16 v[116:119], a[136:139], a[16:19], 0
ds_read_b64_tr_b16 a[132:133], v8 offset:16384
v_mfma_f32_16x16x32_bf16 v[116:119], a[140:143], a[20:23], v[116:119]
buffer_load_dwordx4 v13, s[8:11], s25 offen offset:1024 lds
v_mfma_f32_16x16x32_bf16 v[124:127], a[136:139], a[24:27], 0
ds_read_b64_tr_b16 a[134:135], v8 offset:18432
v_mfma_f32_16x16x32_bf16 v[124:127], a[140:143], a[28:31], v[124:127]
v_mfma_f32_16x16x32_bf16 v[132:135], a[136:139], a[32:35], 0
ds_read_b128 a[64:67], v2 offset:32768
v_mfma_f32_16x16x32_bf16 v[132:135], a[140:143], a[36:39], v[132:135]
buffer_load_dwordx4 v14, s[8:11], s25 offen offset:2048 lds
v_mfma_f32_16x16x32_bf16 v[140:143], a[136:139], a[40:43], 0
ds_read_b128 a[68:71], v3 offset:32768
v_mfma_f32_16x16x32_bf16 v[140:143], a[140:143], a[44:47], v[140:143]
ds_read_b128 a[72:75], v2 offset:34816
v_mfma_f32_16x16x32_bf16 v[148:151], a[136:139], a[48:51], 0
ds_read_b128 a[76:79], v3 offset:34816
v_mfma_f32_16x16x32_bf16 v[148:151], a[140:143], a[52:55], v[148:151]
buffer_load_dwordx4 v15, s[8:11], s25 offen offset:3072 lds
v_mfma_f32_16x16x32_bf16 v[156:159], a[136:139], a[56:59], 0
s_add_u32 s25, s25, 128
ds_read_b128 a[80:83], v2 offset:36864
v_mfma_f32_16x16x32_bf16 v[156:159], a[140:143], a[60:63], v[156:159]
s_waitcnt lgkmcnt(5)
ds_read_b128 a[84:87], v3 offset:36864
v_mfma_f32_16x16x32_bf16 v[160:163], a[128:131], a[0:3], 0
ds_read_b64_tr_b16 a[136:137], v9 offset:0
v_mfma_f32_16x16x32_bf16 v[160:163], a[132:135], a[4:7], v[160:163]
buffer_load_dword v21, v20, s[16:19], s43 offen
v_mfma_f32_16x16x32_bf16 v[168:171], a[128:131], a[8:11], 0
s_add_u32 s43, s43, s47
ds_read_b64_tr_b16 a[138:139], v9 offset:2048
v_mfma_f32_16x16x32_bf16 v[168:171], a[132:135], a[12:15], v[168:171]
s_cmp_ge_u32 s43, s51
v_mfma_f32_16x16x32_bf16 v[176:179], a[128:131], a[16:19], 0
s_cselect_b32 s43, 0, s43
ds_read_b64_tr_b16 a[140:141], v9 offset:16384
v_mfma_f32_16x16x32_bf16 v[176:179], a[132:135], a[20:23], v[176:179]
s_cselect_b32 s51, s42, s51
v_mfma_f32_16x16x32_bf16 v[184:187], a[128:131], a[24:27], 0
s_cselect_b64 s[16:17], s[40:41], s[16:17]
ds_read_b64_tr_b16 a[142:143], v9 offset:18432
v_mfma_f32_16x16x32_bf16 v[184:187], a[132:135], a[28:31], v[184:187]
s_cselect_b32 s18, s42, s18
v_mfma_f32_16x16x32_bf16 v[192:195], a[128:131], a[32:35], 0
s_cselect_b64 s[40:41], s[44:45], s[40:41]
v_mfma_f32_16x16x32_bf16 v[192:195], a[132:135], a[36:39], v[192:195]
s_cselect_b32 s42, s46, s42
v_mfma_f32_16x16x32_bf16 v[200:203], a[128:131], a[40:43], 0
s_waitcnt lgkmcnt(2)
s_cselect_b32 s46, 0, s46
ds_read_b128 a[88:91], v2 offset:38912
v_mfma_f32_16x16x32_bf16 v[200:203], a[132:135], a[44:47], v[200:203]
s_bitcmp1_b32 s2, 4
s_cselect_b32 s37, s21, s37
ds_read_b128 a[92:95], v3 offset:38912
v_mfma_f32_16x16x32_bf16 v[208:211], a[128:131], a[48:51], 0
s_lshl_b32 s56, s37, 5
s_add_u32 s56, s56, s20
ds_read_b128 a[96:99], v2 offset:40960
v_mfma_f32_16x16x32_bf16 v[208:211], a[132:135], a[52:55], v[208:211]
s_lshl_b32 s56, s56, 2
s_add_u32 s56, s56, 8192
v_writelane_b32 v28, s56, 3
v_mfma_f32_16x16x32_bf16 v[216:219], a[128:131], a[56:59], 0
s_add_u32 s56, s56, 2048
ds_read_b128 a[100:103], v3 offset:40960
v_writelane_b32 v28, s56, 6
v_mfma_f32_16x16x32_bf16 v[216:219], a[132:135], a[60:63], v[216:219]
s_lshl_b32 s56, s2, 2
s_add_u32 s56, s56, 12288
ds_read_b128 a[104:107], v2 offset:43008
v_mfma_f32_16x16x32_bf16 v[164:167], a[136:139], a[0:3], 0
s_waitcnt lgkmcnt(5)
ds_read_b64_tr_b16 a[128:129], v10 offset:0
v_writelane_b32 v28, s56, 4
v_mfma_f32_16x16x32_bf16 v[164:167], a[140:143], a[4:7], v[164:167]
s_lshl_b32 s56, s39, 5
s_add_u32 s56, s56, s38
s_lshl_b32 s56, s56, 2
v_mfma_f32_16x16x32_bf16 v[172:175], a[136:139], a[8:11], 0
s_add_u32 s56, s56, 20480
s_cmp_lt_u32 s2, 224
ds_read_b64_tr_b16 a[130:131], v10 offset:2048
v_mfma_f32_16x16x32_bf16 v[172:175], a[140:143], a[12:15], v[172:175]
s_cselect_b32 s56, s56, 3221225472
v_writelane_b32 v28, s56, 7
v_mfma_f32_16x16x32_bf16 v[180:183], a[136:139], a[16:19], 0
s_cmp_eq_u32 s3, 0
s_cselect_b32 s56, 94371840, 3221225472
ds_read_b64_tr_b16 a[132:133], v10 offset:16384
v_mfma_f32_16x16x32_bf16 v[180:183], a[140:143], a[20:23], v[180:183]
buffer_store_dword v246, v28, s[4:7], s56 offen sc1
v_mfma_f32_16x16x32_bf16 v[188:191], a[136:139], a[24:27], 0
ds_read_b64_tr_b16 a[134:135], v10 offset:18432
v_mov_b32 v27, 1
v_mfma_f32_16x16x32_bf16 v[188:191], a[140:143], a[28:31], v[188:191]
v_cmp_eq_u32 vcc, 0, v0
v_mov_b32 v26, 3221225472
v_mfma_f32_16x16x32_bf16 v[196:199], a[136:139], a[32:35], 0
s_lshl_b32 s31, s20, 20
s_lshl_b32 s22, s21, 17
v_cndmask_b32 v26, v26, v246, vcc
v_mfma_f32_16x16x32_bf16 v[196:199], a[140:143], a[36:39], v[196:199]
s_add_u32 s31, s31, s22
s_lshr_b32 s22, s3, 1
s_lshl_b32 s22, s22, 16
v_mfma_f32_16x16x32_bf16 v[204:207], a[136:139], a[40:43], 0
s_add_u32 s31, s31, s22
s_and_b32 s22, s3, 1
ds_read_b128 a[108:111], v3 offset:43008
v_mfma_f32_16x16x32_bf16 v[204:207], a[140:143], a[44:47], v[204:207]
s_lshl_b32 s22, s22, 12
s_add_u32 s31, s31, s22
ds_read_b128 a[112:115], v2 offset:45056
v_mfma_f32_16x16x32_bf16 v[212:215], a[136:139], a[48:51], 0
ds_read_b128 a[116:119], v3 offset:45056
v_mfma_f32_16x16x32_bf16 v[212:215], a[140:143], a[52:55], v[212:215]
v_mfma_f32_16x16x32_bf16 v[220:223], a[136:139], a[56:59], 0
ds_read_b128 a[120:123], v2 offset:47104
v_mfma_f32_16x16x32_bf16 v[220:223], a[140:143], a[60:63], v[220:223]
s_waitcnt lgkmcnt(4)
ds_read_b128 a[124:127], v3 offset:47104
v_mfma_f32_16x16x32_bf16 a[192:195], a[128:131], a[0:3], 0
ds_read_b64_tr_b16 a[136:137], v11 offset:0
v_mfma_f32_16x16x32_bf16 a[192:195], a[132:135], a[4:7], a[192:195]
v_mfma_f32_16x16x32_bf16 a[200:203], a[128:131], a[8:11], 0
ds_read_b64_tr_b16 a[138:139], v11 offset:2048
v_mfma_f32_16x16x32_bf16 a[200:203], a[132:135], a[12:15], a[200:203]
v_mfma_f32_16x16x32_bf16 a[208:211], a[128:131], a[16:19], 0
ds_read_b64_tr_b16 a[140:141], v11 offset:16384
v_mfma_f32_16x16x32_bf16 a[208:211], a[132:135], a[20:23], a[208:211]
v_mfma_f32_16x16x32_bf16 a[216:219], a[128:131], a[24:27], 0
ds_read_b64_tr_b16 a[142:143], v11 offset:18432
v_mfma_f32_16x16x32_bf16 a[216:219], a[132:135], a[28:31], a[216:219]
v_mfma_f32_16x16x32_bf16 a[224:227], a[128:131], a[32:35], 0
v_mfma_f32_16x16x32_bf16 a[224:227], a[132:135], a[36:39], a[224:227]
v_mfma_f32_16x16x32_bf16 a[232:235], a[128:131], a[40:43], 0
v_mfma_f32_16x16x32_bf16 a[232:235], a[132:135], a[44:47], a[232:235]
v_mfma_f32_16x16x32_bf16 a[240:243], a[128:131], a[48:51], 0
v_mfma_f32_16x16x32_bf16 a[240:243], a[132:135], a[52:55], a[240:243]
v_mfma_f32_16x16x32_bf16 a[248:251], a[128:131], a[56:59], 0
s_waitcnt vmcnt(2) lgkmcnt(0)
v_mfma_f32_16x16x32_bf16 a[248:251], a[132:135], a[60:63], a[248:251]
s_barrier
v_mfma_f32_16x16x32_bf16 a[196:199], a[136:139], a[0:3], 0
s_add_u32 m0, s29, 65536
ds_read_b64_tr_b16 a[128:129], v4 offset:32768
v_mfma_f32_16x16x32_bf16 a[196:199], a[140:143], a[4:7], a[196:199]
buffer_load_dwordx4 v16, s[12:15], s26 offen offset:0 lds
v_mfma_f32_16x16x32_bf16 a[204:207], a[136:139], a[8:11], 0
ds_read_b64_tr_b16 a[130:131], v4 offset:34816
v_mfma_f32_16x16x32_bf16 a[204:207], a[140:143], a[12:15], a[204:207]
v_mfma_f32_16x16x32_bf16 a[212:215], a[136:139], a[16:19], 0
ds_read_b64_tr_b16 a[132:133], v4 offset:49152
v_mfma_f32_16x16x32_bf16 a[212:215], a[140:143], a[20:23], a[212:215]
buffer_load_dwordx4 v17, s[12:15], s26 offen offset:1024 lds
v_mfma_f32_16x16x32_bf16 a[220:223], a[136:139], a[24:27], 0
ds_read_b64_tr_b16 a[134:135], v4 offset:51200
v_mfma_f32_16x16x32_bf16 a[220:223], a[140:143], a[28:31], a[220:223]
v_mfma_f32_16x16x32_bf16 a[228:231], a[136:139], a[32:35], 0
v_mfma_f32_16x16x32_bf16 a[228:231], a[140:143], a[36:39], a[228:231]
buffer_load_dwordx4 v18, s[12:15], s26 offen offset:2048 lds
v_mfma_f32_16x16x32_bf16 a[236:239], a[136:139], a[40:43], 0
v_mfma_f32_16x16x32_bf16 a[236:239], a[140:143], a[44:47], a[236:239]
v_mfma_f32_16x16x32_bf16 a[244:247], a[136:139], a[48:51], 0
v_mfma_f32_16x16x32_bf16 a[244:247], a[140:143], a[52:55], a[244:247]
buffer_load_dwordx4 v19, s[12:15], s26 offen offset:3072 lds
v_mfma_f32_16x16x32_bf16 a[252:255], a[136:139], a[56:59], 0
s_add_u32 s26, s26, 524288
v_mfma_f32_16x16x32_bf16 a[252:255], a[140:143], a[60:63], a[252:255]
s_waitcnt lgkmcnt(0)
Lg_1:
v_mfma_f32_16x16x32_bf16 v[32:35], a[128:131], a[64:67], v[32:35]
s_add_u32 m0, s29, 81920
ds_read_b64_tr_b16 a[136:137], v5 offset:32768
v_mfma_f32_16x16x32_bf16 v[32:35], a[132:135], a[68:71], v[32:35]
buffer_load_dwordx4 v16, s[12:15], s27 offen offset:0 lds
v_mfma_f32_16x16x32_bf16 v[40:43], a[128:131], a[72:75], v[40:43]
ds_read_b64_tr_b16 a[138:139], v5 offset:34816
v_mfma_f32_16x16x32_bf16 v[40:43], a[132:135], a[76:79], v[40:43]
v_mfma_f32_16x16x32_bf16 v[48:51], a[128:131], a[80:83], v[48:51]
ds_read_b64_tr_b16 a[140:141], v5 offset:49152
v_mfma_f32_16x16x32_bf16 v[48:51], a[132:135], a[84:87], v[48:51]
buffer_load_dwordx4 v17, s[12:15], s27 offen offset:1024 lds
v_mfma_f32_16x16x32_bf16 v[56:59], a[128:131], a[88:91], v[56:59]
ds_read_b64_tr_b16 a[142:143], v5 offset:51200
v_mfma_f32_16x16x32_bf16 v[56:59], a[132:135], a[92:95], v[56:59]
v_mfma_f32_16x16x32_bf16 v[64:67], a[128:131], a[96:99], v[64:67]
ds_read_b128 a[0:3], v2 offset:0
v_mfma_f32_16x16x32_bf16 v[64:67], a[132:135], a[100:103], v[64:67]
buffer_load_dwordx4 v18, s[12:15], s27 offen offset:2048 lds
v_mfma_f32_16x16x32_bf16 v[72:75], a[128:131], a[104:107], v[72:75]
ds_read_b128 a[4:7], v3 offset:0
v_mfma_f32_16x16x32_bf16 v[72:75], a[132:135], a[108:111], v[72:75]
v_mfma_f32_16x16x32_bf16 v[80:83], a[128:131], a[112:115], v[80:83]
v_mfma_f32_16x16x32_bf16 v[80:83], a[132:135], a[116:119], v[80:83]
buffer_load_dwordx4 v19, s[12:15], s27 offen offset:3072 lds
v_mfma_f32_16x16x32_bf16 v[88:91], a[128:131], a[120:123], v[88:91]
s_add_u32 s27, s27, 524288
ds_read_b128 a[8:11], v2 offset:2048
v_mfma_f32_16x16x32_bf16 v[88:91], a[132:135], a[124:127], v[88:91]
s_waitcnt lgkmcnt(3)
v_mfma_f32_16x16x32_bf16 v[36:39], a[136:139], a[64:67], v[36:39]
s_add_u32 m0, s28, 32768
ds_read_b64_tr_b16 a[128:129], v6 offset:32768
v_mfma_f32_16x16x32_bf16 v[36:39], a[140:143], a[68:71], v[36:39]
buffer_load_dwordx4 v12, s[8:11], s24 offen offset:0 lds
v_mfma_f32_16x16x32_bf16 v[44:47], a[136:139], a[72:75], v[44:47]
ds_read_b64_tr_b16 a[130:131], v6 offset:34816
v_mfma_f32_16x16x32_bf16 v[44:47], a[140:143], a[76:79], v[44:47]
v_mfma_f32_16x16x32_bf16 v[52:55], a[136:139], a[80:83], v[52:55]
ds_read_b64_tr_b16 a[132:133], v6 offset:49152
v_mfma_f32_16x16x32_bf16 v[52:55], a[140:143], a[84:87], v[52:55]
buffer_load_dwordx4 v13, s[8:11], s24 offen offset:1024 lds
v_mfma_f32_16x16x32_bf16 v[60:63], a[136:139], a[88:91], v[60:63]
ds_read_b64_tr_b16 a[134:135], v6 offset:51200
v_mfma_f32_16x16x32_bf16 v[60:63], a[140:143], a[92:95], v[60:63]
v_mfma_f32_16x16x32_bf16 v[68:71], a[136:139], a[96:99], v[68:71]
ds_read_b128 a[12:15], v3 offset:2048
v_mfma_f32_16x16x32_bf16 v[68:71], a[140:143], a[100:103], v[68:71]
buffer_load_dwordx4 v14, s[8:11], s24 offen offset:2048 lds
v_mfma_f32_16x16x32_bf16 v[76:79], a[136:139], a[104:107], v[76:79]
v_mfma_f32_16x16x32_bf16 v[76:79], a[140:143], a[108:111], v[76:79]
v_mfma_f32_16x16x32_bf16 v[84:87], a[136:139], a[112:115], v[84:87]
ds_read_b128 a[16:19], v2 offset:4096
v_mfma_f32_16x16x32_bf16 v[84:87], a[140:143], a[116:119], v[84:87]
buffer_load_dwordx4 v15, s[8:11], s24 offen offset:3072 lds
v_mfma_f32_16x16x32_bf16 v[92:95], a[136:139], a[120:123], v[92:95]
s_add_u32 s24, s24, 128
ds_read_b128 a[20:23], v3 offset:4096
v_mfma_f32_16x16x32_bf16 v[92:95], a[140:143], a[124:127], v[92:95]
s_waitcnt lgkmcnt(3)
v_mfma_f32_16x16x32_bf16 v[96:99], a[128:131], a[64:67], v[96:99]
s_add_u32 m0, s28, 36864
ds_read_b64_tr_b16 a[136:137], v7 offset:32768
v_mfma_f32_16x16x32_bf16 v[96:99], a[132:135], a[68:71], v[96:99]
buffer_load_dwordx4 v12, s[8:11], s25 offen offset:0 lds
v_mfma_f32_16x16x32_bf16 v[104:107], a[128:131], a[72:75], v[104:107]
ds_read_b64_tr_b16 a[138:139], v7 offset:34816
v_mfma_f32_16x16x32_bf16 v[104:107], a[132:135], a[76:79], v[104:107]
v_mfma_f32_16x16x32_bf16 v[112:115], a[128:131], a[80:83], v[112:115]
ds_read_b64_tr_b16 a[140:141], v7 offset:49152
v_mfma_f32_16x16x32_bf16 v[112:115], a[132:135], a[84:87], v[112:115]
buffer_load_dwordx4 v13, s[8:11], s25 offen offset:1024 lds
v_mfma_f32_16x16x32_bf16 v[120:123], a[128:131], a[88:91], v[120:123]
ds_read_b64_tr_b16 a[142:143], v7 offset:51200
v_mfma_f32_16x16x32_bf16 v[120:123], a[132:135], a[92:95], v[120:123]
v_mfma_f32_16x16x32_bf16 v[128:131], a[128:131], a[96:99], v[128:131]
v_mfma_f32_16x16x32_bf16 v[128:131], a[132:135], a[100:103], v[128:131]
buffer_load_dwordx4 v14, s[8:11], s25 offen offset:2048 lds
v_mfma_f32_16x16x32_bf16 v[136:139], a[128:131], a[104:107], v[136:139]
ds_read_b128 a[24:27], v2 offset:6144
v_mfma_f32_16x16x32_bf16 v[136:139], a[132:135], a[108:111], v[136:139]
v_mfma_f32_16x16x32_bf16 v[144:147], a[128:131], a[112:115], v[144:147]
ds_read_b128 a[28:31], v3 offset:6144
v_mfma_f32_16x16x32_bf16 v[144:147], a[132:135], a[116:119], v[144:147]
buffer_load_dwordx4 v15, s[8:11], s25 offen offset:3072 lds
v_mfma_f32_16x16x32_bf16 v[152:155], a[128:131], a[120:123], v[152:155]
s_add_u32 s25, s25, 128
v_mfma_f32_16x16x32_bf16 v[152:155], a[132:135], a[124:127], v[152:155]
s_waitcnt lgkmcnt(2)
v_mfma_f32_16x16x32_bf16 v[100:103], a[136:139], a[64:67], v[100:103]
ds_read_b64_tr_b16 a[128:129], v8 offset:32768
v_mfma_f32_16x16x32_bf16 v[100:103], a[140:143], a[68:71], v[100:103]
buffer_load_dword v21, v20, s[16:19], s43 offen
v_mfma_f32_16x16x32_bf16 v[108:111], a[136:139], a[72:75], v[108:111]
s_add_u32 s43, s43, s47
ds_read_b64_tr_b16 a[130:131], v8 offset:34816
v_mfma_f32_16x16x32_bf16 v[108:111], a[140:143], a[76:79], v[108:111]
s_cmp_ge_u32 s43, s51
v_mfma_f32_16x16x32_bf16 v[116:119], a[136:139], a[80:83], v[116:119]
s_cselect_b32 s43, 0, s43
ds_read_b64_tr_b16 a[132:133], v8 offset:49152
v_mfma_f32_16x16x32_bf16 v[116:119], a[140:143], a[84:87], v[116:119]
s_cselect_b32 s51, s42, s51
v_mfma_f32_16x16x32_bf16 v[124:127], a[136:139], a[88:91], v[124:127]
s_cselect_b64 s[16:17], s[40:41], s[16:17]
ds_read_b64_tr_b16 a[134:135], v8 offset:51200
v_mfma_f32_16x16x32_bf16 v[124:127], a[140:143], a[92:95], v[124:127]
s_cselect_b32 s18, s42, s18
v_mfma_f32_16x16x32_bf16 v[132:135], a[136:139], a[96:99], v[132:135]
s_cselect_b64 s[40:41], s[44:45], s[40:41]
ds_read_b128 a[32:35], v2 offset:8192
v_mfma_f32_16x16x32_bf16 v[132:135], a[140:143], a[100:103], v[132:135]
s_cselect_b32 s42, s46, s42
v_mfma_f32_16x16x32_bf16 v[140:143], a[136:139], a[104:107], v[140:143]
s_cselect_b32 s46, 0, s46
v_mfma_f32_16x16x32_bf16 v[140:143], a[140:143], a[108:111], v[140:143]
s_cmp_eq_u32 s30, s55
v_mfma_f32_16x16x32_bf16 v[148:151], a[136:139], a[112:115], v[148:151]
s_cselect_b32 s22, 0, 3221225472
ds_read_b128 a[36:39], v3 offset:8192
v_mfma_f32_16x16x32_bf16 v[148:151], a[140:143], a[116:119], v[148:151]
s_sub_u32 s30, s30, 1
buffer_atomic_add v27, v26, s[60:63], s22 offen sc1
v_mfma_f32_16x16x32_bf16 v[156:159], a[136:139], a[120:123], v[156:159]
ds_read_b128 a[40:43], v2 offset:10240
v_mfma_f32_16x16x32_bf16 v[156:159], a[140:143], a[124:127], v[156:159]
s_waitcnt lgkmcnt(3)
v_mfma_f32_16x16x32_bf16 v[160:163], a[128:131], a[64:67], v[160:163]
ds_read_b64_tr_b16 a[136:137], v9 offset:32768
v_mfma_f32_16x16x32_bf16 v[160:163], a[132:135], a[68:71], v[160:163]
v_mfma_f32_16x16x32_bf16 v[168:171], a[128:131], a[72:75], v[168:171]
ds_read_b64_tr_b16 a[138:139], v9 offset:34816
v_mfma_f32_16x16x32_bf16 v[168:171], a[132:135], a[76:79], v[168:171]
v_mfma_f32_16x16x32_bf16 v[176:179], a[128:131], a[80:83], v[176:179]
ds_read_b64_tr_b16 a[140:141], v9 offset:49152
v_mfma_f32_16x16x32_bf16 v[176:179], a[132:135], a[84:87], v[176:179]
v_mfma_f32_16x16x32_bf16 v[184:187], a[128:131], a[88:91], v[184:187]
ds_read_b64_tr_b16 a[142:143], v9 offset:51200
v_mfma_f32_16x16x32_bf16 v[184:187], a[132:135], a[92:95], v[184:187]
v_mfma_f32_16x16x32_bf16 v[192:195], a[128:131], a[96:99], v[192:195]
v_mfma_f32_16x16x32_bf16 v[192:195], a[132:135], a[100:103], v[192:195]
v_mfma_f32_16x16x32_bf16 v[200:203], a[128:131], a[104:107], v[200:203]
ds_read_b128 a[44:47], v3 offset:10240
v_mfma_f32_16x16x32_bf16 v[200:203], a[132:135], a[108:111], v[200:203]
v_mfma_f32_16x16x32_bf16 v[208:211], a[128:131], a[112:115], v[208:211]
ds_read_b128 a[48:51], v2 offset:12288
v_mfma_f32_16x16x32_bf16 v[208:211], a[132:135], a[116:119], v[208:211]
v_mfma_f32_16x16x32_bf16 v[216:219], a[128:131], a[120:123], v[216:219]
v_mfma_f32_16x16x32_bf16 v[216:219], a[132:135], a[124:127], v[216:219]
s_waitcnt lgkmcnt(2)
v_mfma_f32_16x16x32_bf16 v[164:167], a[136:139], a[64:67], v[164:167]
ds_read_b64_tr_b16 a[128:129], v10 offset:32768
v_mfma_f32_16x16x32_bf16 v[164:167], a[140:143], a[68:71], v[164:167]
v_mfma_f32_16x16x32_bf16 v[172:175], a[136:139], a[72:75], v[172:175]
ds_read_b64_tr_b16 a[130:131], v10 offset:34816
v_mfma_f32_16x16x32_bf16 v[172:175], a[140:143], a[76:79], v[172:175]
v_mfma_f32_16x16x32_bf16 v[180:183], a[136:139], a[80:83], v[180:183]
ds_read_b64_tr_b16 a[132:133], v10 offset:49152
v_mfma_f32_16x16x32_bf16 v[180:183], a[140:143], a[84:87], v[180:183]
v_mfma_f32_16x16x32_bf16 v[188:191], a[136:139], a[88:91], v[188:191]
ds_read_b64_tr_b16 a[134:135], v10 offset:51200
v_mfma_f32_16x16x32_bf16 v[188:191], a[140:143], a[92:95], v[188:191]
v_mfma_f32_16x16x32_bf16 v[196:199], a[136:139], a[96:99], v[196:199]
ds_read_b128 a[52:55], v3 offset:12288
v_mfma_f32_16x16x32_bf16 v[196:199], a[140:143], a[100:103], v[196:199]
v_mfma_f32_16x16x32_bf16 v[204:207], a[136:139], a[104:107], v[204:207]
ds_read_b128 a[56:59], v2 offset:14336
v_mfma_f32_16x16x32_bf16 v[204:207], a[140:143], a[108:111], v[204:207]
v_mfma_f32_16x16x32_bf16 v[212:215], a[136:139], a[112:115], v[212:215]
v_mfma_f32_16x16x32_bf16 v[212:215], a[140:143], a[116:119], v[212:215]
v_mfma_f32_16x16x32_bf16 v[220:223], a[136:139], a[120:123], v[220:223]
ds_read_b128 a[60:63], v3 offset:14336
v_mfma_f32_16x16x32_bf16 v[220:223], a[140:143], a[124:127], v[220:223]
s_waitcnt lgkmcnt(3)
v_mfma_f32_16x16x32_bf16 a[192:195], a[128:131], a[64:67], a[192:195]
ds_read_b64_tr_b16 a[136:137], v11 offset:32768
v_mfma_f32_16x16x32_bf16 a[192:195], a[132:135], a[68:71], a[192:195]
v_mfma_f32_16x16x32_bf16 a[200:203], a[128:131], a[72:75], a[200:203]
ds_read_b64_tr_b16 a[138:139], v11 offset:34816
v_mfma_f32_16x16x32_bf16 a[200:203], a[132:135], a[76:79], a[200:203]
v_mfma_f32_16x16x32_bf16 a[208:211], a[128:131], a[80:83], a[208:211]
ds_read_b64_tr_b16 a[140:141], v11 offset:49152
v_mfma_f32_16x16x32_bf16 a[208:211], a[132:135], a[84:87], a[208:211]
v_mfma_f32_16x16x32_bf16 a[216:219], a[128:131], a[88:91], a[216:219]
ds_read_b64_tr_b16 a[142:143], v11 offset:51200
v_mfma_f32_16x16x32_bf16 a[216:219], a[132:135], a[92:95], a[216:219]
v_mfma_f32_16x16x32_bf16 a[224:227], a[128:131], a[96:99], a[224:227]
v_mfma_f32_16x16x32_bf16 a[224:227], a[132:135], a[100:103], a[224:227]
v_mfma_f32_16x16x32_bf16 a[232:235], a[128:131], a[104:107], a[232:235]
v_mfma_f32_16x16x32_bf16 a[232:235], a[132:135], a[108:111], a[232:235]
v_mfma_f32_16x16x32_bf16 a[240:243], a[128:131], a[112:115], a[240:243]
v_mfma_f32_16x16x32_bf16 a[240:243], a[132:135], a[116:119], a[240:243]
v_mfma_f32_16x16x32_bf16 a[248:251], a[128:131], a[120:123], a[248:251]
s_waitcnt vmcnt(2) lgkmcnt(0)
v_mfma_f32_16x16x32_bf16 a[248:251], a[132:135], a[124:127], a[248:251]
s_barrier
v_mfma_f32_16x16x32_bf16 a[196:199], a[136:139], a[64:67], a[196:199]
s_add_u32 m0, s29, 98304
ds_read_b64_tr_b16 a[128:129], v4 offset:0
v_mfma_f32_16x16x32_bf16 a[196:199], a[140:143], a[68:71], a[196:199]
buffer_load_dwordx4 v16, s[12:15], s26 offen offset:0 lds
v_mfma_f32_16x16x32_bf16 a[204:207], a[136:139], a[72:75], a[204:207]
ds_read_b64_tr_b16 a[130:131], v4 offset:2048
v_mfma_f32_16x16x32_bf16 a[204:207], a[140:143], a[76:79], a[204:207]
v_mfma_f32_16x16x32_bf16 a[212:215], a[136:139], a[80:83], a[212:215]
ds_read_b64_tr_b16 a[132:133], v4 offset:16384
v_mfma_f32_16x16x32_bf16 a[212:215], a[140:143], a[84:87], a[212:215]
buffer_load_dwordx4 v17, s[12:15], s26 offen offset:1024 lds
v_mfma_f32_16x16x32_bf16 a[220:223], a[136:139], a[88:91], a[220:223]
ds_read_b64_tr_b16 a[134:135], v4 offset:18432
v_mfma_f32_16x16x32_bf16 a[220:223], a[140:143], a[92:95], a[220:223]
v_mfma_f32_16x16x32_bf16 a[228:231], a[136:139], a[96:99], a[228:231]
v_mfma_f32_16x16x32_bf16 a[228:231], a[140:143], a[100:103], a[228:231]
buffer_load_dwordx4 v18, s[12:15], s26 offen offset:2048 lds
v_mfma_f32_16x16x32_bf16 a[236:239], a[136:139], a[104:107], a[236:239]
v_mfma_f32_16x16x32_bf16 a[236:239], a[140:143], a[108:111], a[236:239]
v_mfma_f32_16x16x32_bf16 a[244:247], a[136:139], a[112:115], a[244:247]
v_mfma_f32_16x16x32_bf16 a[244:247], a[140:143], a[116:119], a[244:247]
buffer_load_dwordx4 v19, s[12:15], s26 offen offset:3072 lds
v_mfma_f32_16x16x32_bf16 a[252:255], a[136:139], a[120:123], a[252:255]
s_add_u32 s26, s26, 524288
v_mfma_f32_16x16x32_bf16 a[252:255], a[140:143], a[124:127], a[252:255]
s_waitcnt lgkmcnt(0)
buffer_store_dword v27, v26, s[4:7], s82 offen sc1
v_mfma_f32_16x16x32_bf16 v[32:35], a[128:131], a[0:3], v[32:35]
s_add_u32 m0, s29, 114688
ds_read_b64_tr_b16 a[136:137], v5 offset:0
v_mfma_f32_16x16x32_bf16 v[32:35], a[132:135], a[4:7], v[32:35]
buffer_load_dwordx4 v16, s[12:15], s27 offen offset:0 lds
v_mfma_f32_16x16x32_bf16 v[40:43], a[128:131], a[8:11], v[40:43]
ds_read_b64_tr_b16 a[138:139], v5 offset:2048
v_mfma_f32_16x16x32_bf16 v[40:43], a[132:135], a[12:15], v[40:43]
v_mfma_f32_16x16x32_bf16 v[48:51], a[128:131], a[16:19], v[48:51]
ds_read_b64_tr_b16 a[140:141], v5 offset:16384
v_mfma_f32_16x16x32_bf16 v[48:51], a[132:135], a[20:23], v[48:51]
buffer_load_dwordx4 v17, s[12:15], s27 offen offset:1024 lds
v_mfma_f32_16x16x32_bf16 v[56:59], a[128:131], a[24:27], v[56:59]
ds_read_b64_tr_b16 a[142:143], v5 offset:18432
v_mfma_f32_16x16x32_bf16 v[56:59], a[132:135], a[28:31], v[56:59]
v_mfma_f32_16x16x32_bf16 v[64:67], a[128:131], a[32:35], v[64:67]
ds_read_b128 a[64:67], v2 offset:32768
v_mfma_f32_16x16x32_bf16 v[64:67], a[132:135], a[36:39], v[64:67]
buffer_load_dwordx4 v18, s[12:15], s27 offen offset:2048 lds
v_mfma_f32_16x16x32_bf16 v[72:75], a[128:131], a[40:43], v[72:75]
ds_read_b128 a[68:71], v3 offset:32768
v_mfma_f32_16x16x32_bf16 v[72:75], a[132:135], a[44:47], v[72:75]
v_mfma_f32_16x16x32_bf16 v[80:83], a[128:131], a[48:51], v[80:83]
v_mfma_f32_16x16x32_bf16 v[80:83], a[132:135], a[52:55], v[80:83]
buffer_load_dwordx4 v19, s[12:15], s27 offen offset:3072 lds
v_mfma_f32_16x16x32_bf16 v[88:91], a[128:131], a[56:59], v[88:91]
s_add_u32 s27, s27, 524288
ds_read_b128 a[72:75], v2 offset:34816
v_mfma_f32_16x16x32_bf16 v[88:91], a[132:135], a[60:63], v[88:91]
s_waitcnt lgkmcnt(3)
v_mfma_f32_16x16x32_bf16 v[36:39], a[136:139], a[0:3], v[36:39]
s_add_u32 m0, s28, 0
ds_read_b64_tr_b16 a[128:129], v6 offset:0
v_mfma_f32_16x16x32_bf16 v[36:39], a[140:143], a[4:7], v[36:39]
buffer_load_dwordx4 v12, s[8:11], s24 offen offset:0 lds
v_mfma_f32_16x16x32_bf16 v[44:47], a[136:139], a[8:11], v[44:47]
ds_read_b64_tr_b16 a[130:131], v6 offset:2048
v_mfma_f32_16x16x32_bf16 v[44:47], a[140:143], a[12:15], v[44:47]
PAD_1:
s_cbranch_execz PAD_5
v_mfma_f32_16x16x32_bf16 v[52:55], a[136:139], a[16:19], v[52:55]
ds_read_b64_tr_b16 a[132:133], v6 offset:16384
v_mfma_f32_16x16x32_bf16 v[52:55], a[140:143], a[20:23], v[52:55]
buffer_load_dwordx4 v13, s[8:11], s24 offen offset:1024 lds
v_mfma_f32_16x16x32_bf16 v[60:63], a[136:139], a[24:27], v[60:63]
ds_read_b64_tr_b16 a[134:135], v6 offset:18432
v_mfma_f32_16x16x32_bf16 v[60:63], a[140:143], a[28:31], v[60:63]
v_mfma_f32_16x16x32_bf16 v[68:71], a[136:139], a[32:35], v[68:71]
ds_read_b128 a[76:79], v3 offset:34816
v_mfma_f32_16x16x32_bf16 v[68:71], a[140:143], a[36:39], v[68:71]
buffer_load_dwordx4 v14, s[8:11], s24 offen offset:2048 lds
v_mfma_f32_16x16x32_bf16 v[76:79], a[136:139], a[40:43], v[76:79]
v_mfma_f32_16x16x32_bf16 v[76:79], a[140:143], a[44:47], v[76:79]
v_mfma_f32_16x16x32_bf16 v[84:87], a[136:139], a[48:51], v[84:87]
ds_read_b128 a[80:83], v2 offset:36864
v_mfma_f32_16x16x32_bf16 v[84:87], a[140:143], a[52:55], v[84:87]
buffer_load_dwordx4 v15, s[8:11], s24 offen offset:3072 lds
v_mfma_f32_16x16x32_bf16 v[92:95], a[136:139], a[56:59], v[92:95]
s_add_u32 s24, s24, 128
ds_read_b128 a[84:87], v3 offset:36864
v_mfma_f32_16x16x32_bf16 v[92:95], a[140:143], a[60:63], v[92:95]
s_waitcnt lgkmcnt(3)
v_mfma_f32_16x16x32_bf16 v[96:99], a[128:131], a[0:3], v[96:99]
s_add_u32 m0, s28, 4096
ds_read_b64_tr_b16 a[136:137], v7 offset:0
v_mfma_f32_16x16x32_bf16 v[96:99], a[132:135], a[4:7], v[96:99]
buffer_load_dwordx4 v12, s[8:11], s25 offen offset:0 lds
v_mfma_f32_16x16x32_bf16 v[104:107], a[128:131], a[8:11], v[104:107]
ds_read_b64_tr_b16 a[138:139], v7 offset:2048
v_mfma_f32_16x16x32_bf16 v[104:107], a[132:135], a[12:15], v[104:107]
v_mfma_f32_16x16x32_bf16 v[112:115], a[128:131], a[16:19], v[112:115]
ds_read_b64_tr_b16 a[140:141], v7 offset:16384
v_mfma_f32_16x16x32_bf16 v[112:115], a[132:135], a[20:23], v[112:115]
buffer_load_dwordx4 v13, s[8:11], s25 offen offset:1024 lds
v_mfma_f32_16x16x32_bf16 v[120:123], a[128:131], a[24:27], v[120:123]
ds_read_b64_tr_b16 a[142:143], v7 offset:18432
v_mfma_f32_16x16x32_bf16 v[120:123], a[132:135], a[28:31], v[120:123]
v_mfma_f32_16x16x32_bf16 v[128:131], a[128:131], a[32:35], v[128:131]
v_mfma_f32_16x16x32_bf16 v[128:131], a[132:135], a[36:39], v[128:131]
buffer_load_dwordx4 v14, s[8:11], s25 offen offset:2048 lds
v_mfma_f32_16x16x32_bf16 v[136:139], a[128:131], a[40:43], v[136:139]
ds_read_b128 a[88:91], v2 offset:38912
v_mfma_f32_16x16x32_bf16 v[136:139], a[132:135], a[44:47], v[136:139]
v_mfma_f32_16x16x32_bf16 v[144:147], a[128:131], a[48:51], v[144:147]
ds_read_b128 a[92:95], v3 offset:38912
v_mfma_f32_16x16x32_bf16 v[144:147], a[132:135], a[52:55], v[144:147]
buffer_load_dwordx4 v15, s[8:11], s25 offen offset:3072 lds
v_mfma_f32_16x16x32_bf16 v[152:155], a[128:131], a[56:59], v[152:155]
s_add_u32 s25, s25, 128
v_mfma_f32_16x16x32_bf16 v[152:155], a[132:135], a[60:63], v[152:155]
s_waitcnt lgkmcnt(2)
v_mfma_f32_16x16x32_bf16 v[100:103], a[136:139], a[0:3], v[100:103]
ds_read_b64_tr_b16 a[128:129], v8 offset:0
v_mfma_f32_16x16x32_bf16 v[100:103], a[140:143], a[4:7], v[100:103]
buffer_load_dword v21, v20, s[16:19], s43 offen
v_mfma_f32_16x16x32_bf16 v[108:111], a[136:139], a[8:11], v[108:111]
s_add_u32 s43, s43, s47
ds_read_b64_tr_b16 a[130:131], v8 offset:2048
v_mfma_f32_16x16x32_bf16 v[108:111], a[140:143], a[12:15], v[108:111]
s_cmp_ge_u32 s43, s51
v_mfma_f32_16x16x32_bf16 v[116:119], a[136:139], a[16:19], v[116:119]
s_cselect_b32 s43, 0, s43
ds_read_b64_tr_b16 a[132:133], v8 offset:16384
v_mfma_f32_16x16x32_bf16 v[116:119], a[140:143], a[20:23], v[116:119]
s_cselect_b32 s51, s42, s51
v_mfma_f32_16x16x32_bf16 v[124:127], a[136:139], a[24:27], v[124:127]
s_cselect_b64 s[16:17], s[40:41], s[16:17]
ds_read_b64_tr_b16 a[134:135], v8 offset:18432
v_mfma_f32_16x16x32_bf16 v[124:127], a[140:143], a[28:31], v[124:127]
s_cselect_b32 s18, s42, s18
v_mfma_f32_16x16x32_bf16 v[132:135], a[136:139], a[32:35], v[132:135]
s_cselect_b64 s[40:41], s[44:45], s[40:41]
ds_read_b128 a[96:99], v2 offset:40960
v_mfma_f32_16x16x32_bf16 v[132:135], a[140:143], a[36:39], v[132:135]
s_cselect_b32 s42, s46, s42
v_mfma_f32_16x16x32_bf16 v[140:143], a[136:139], a[40:43], v[140:143]
s_cselect_b32 s46, 0, s46
v_mfma_f32_16x16x32_bf16 v[140:143], a[140:143], a[44:47], v[140:143]
s_cmp_eq_u32 s30, s55
v_mfma_f32_16x16x32_bf16 v[148:151], a[136:139], a[48:51], v[148:151]
s_cselect_b32 s22, 0, 3221225472
ds_read_b128 a[100:103], v3 offset:40960
v_mfma_f32_16x16x32_bf16 v[148:151], a[140:143], a[52:55], v[148:151]
s_sub_u32 s30, s30, 1
buffer_atomic_add v27, v26, s[60:63], s22 offen sc1
v_mfma_f32_16x16x32_bf16 v[156:159], a[136:139], a[56:59], v[156:159]
ds_read_b128 a[104:107], v2 offset:43008
v_mfma_f32_16x16x32_bf16 v[156:159], a[140:143], a[60:63], v[156:159]
s_waitcnt lgkmcnt(3)
v_mfma_f32_16x16x32_bf16 v[160:163], a[128:131], a[0:3], v[160:163]
ds_read_b64_tr_b16 a[136:137], v9 offset:0
v_mfma_f32_16x16x32_bf16 v[160:163], a[132:135], a[4:7], v[160:163]
v_mfma_f32_16x16x32_bf16 v[168:171], a[128:131], a[8:11], v[168:171]
ds_read_b64_tr_b16 a[138:139], v9 offset:2048
v_mfma_f32_16x16x32_bf16 v[168:171], a[132:135], a[12:15], v[168:171]
v_mfma_f32_16x16x32_bf16 v[176:179], a[128:131], a[16:19], v[176:179]
ds_read_b64_tr_b16 a[140:141], v9 offset:16384
v_mfma_f32_16x16x32_bf16 v[176:179], a[132:135], a[20:23], v[176:179]
v_mfma_f32_16x16x32_bf16 v[184:187], a[128:131], a[24:27], v[184:187]
ds_read_b64_tr_b16 a[142:143], v9 offset:18432
v_mfma_f32_16x16x32_bf16 v[184:187], a[132:135], a[28:31], v[184:187]
v_mfma_f32_16x16x32_bf16 v[192:195], a[128:131], a[32:35], v[192:195]
v_mfma_f32_16x16x32_bf16 v[192:195], a[132:135], a[36:39], v[192:195]
v_mfma_f32_16x16x32_bf16 v[200:203], a[128:131], a[40:43], v[200:203]
ds_read_b128 a[108:111], v3 offset:43008
v_mfma_f32_16x16x32_bf16 v[200:203], a[132:135], a[44:47], v[200:203]
v_mfma_f32_16x16x32_bf16 v[208:211], a[128:131], a[48:51], v[208:211]
ds_read_b128 a[112:115], v2 offset:45056
v_mfma_f32_16x16x32_bf16 v[208:211], a[132:135], a[52:55], v[208:211]
v_mfma_f32_16x16x32_bf16 v[216:219], a[128:131], a[56:59], v[216:219]
v_mfma_f32_16x16x32_bf16 v[216:219], a[132:135], a[60:63], v[216:219]
s_waitcnt lgkmcnt(2)
v_mfma_f32_16x16x32_bf16 v[164:167], a[136:139], a[0:3], v[164:167]
ds_read_b64_tr_b16 a[128:129], v10 offset:0
v_mfma_f32_16x16x32_bf16 v[164:167], a[140:143], a[4:7], v[164:167]
v_mfma_f32_16x16x32_bf16 v[172:175], a[136:139], a[8:11], v[172:175]
ds_read_b64_tr_b16 a[130:131], v10 offset:2048
v_mfma_f32_16x16x32_bf16 v[172:175], a[140:143], a[12:15], v[172:175]
v_mfma_f32_16x16x32_bf16 v[180:183], a[136:139], a[16:19], v[180:183]
ds_read_b64_tr_b16 a[132:133], v10 offset:16384
v_mfma_f32_16x16x32_bf16 v[180:183], a[140:143], a[20:23], v[180:183]
v_mfma_f32_16x16x32_bf16 v[188:191], a[136:139], a[24:27], v[188:191]
ds_read_b64_tr_b16 a[134:135], v10 offset:18432
v_mfma_f32_16x16x32_bf16 v[188:191], a[140:143], a[28:31], v[188:191]
v_mfma_f32_16x16x32_bf16 v[196:199], a[136:139], a[32:35], v[196:199]
ds_read_b128 a[116:119], v3 offset:45056
v_mfma_f32_16x16x32_bf16 v[196:199], a[140:143], a[36:39], v[196:199]
v_mfma_f32_16x16x32_bf16 v[204:207], a[136:139], a[40:43], v[204:207]
ds_read_b128 a[120:123], v2 offset:47104
v_mfma_f32_16x16x32_bf16 v[204:207], a[140:143], a[44:47], v[204:207]
v_mfma_f32_16x16x32_bf16 v[212:215], a[136:139], a[48:51], v[212:215]
v_mfma_f32_16x16x32_bf16 v[212:215], a[140:143], a[52:55], v[212:215]
v_mfma_f32_16x16x32_bf16 v[220:223], a[136:139], a[56:59], v[220:223]
ds_read_b128 a[124:127], v3 offset:47104
v_mfma_f32_16x16x32_bf16 v[220:223], a[140:143], a[60:63], v[220:223]
s_waitcnt lgkmcnt(3)
v_mfma_f32_16x16x32_bf16 a[192:195], a[128:131], a[0:3], a[192:195]
ds_read_b64_tr_b16 a[136:137], v11 offset:0
v_mfma_f32_16x16x32_bf16 a[192:195], a[132:135], a[4:7], a[192:195]
v_mfma_f32_16x16x32_bf16 a[200:203], a[128:131], a[8:11], a[200:203]
ds_read_b64_tr_b16 a[138:139], v11 offset:2048
v_mfma_f32_16x16x32_bf16 a[200:203], a[132:135], a[12:15], a[200:203]
v_mfma_f32_16x16x32_bf16 a[208:211], a[128:131], a[16:19], a[208:211]
ds_read_b64_tr_b16 a[140:141], v11 offset:16384
v_mfma_f32_16x16x32_bf16 a[208:211], a[132:135], a[20:23], a[208:211]
v_mfma_f32_16x16x32_bf16 a[216:219], a[128:131], a[24:27], a[216:219]
ds_read_b64_tr_b16 a[142:143], v11 offset:18432
v_mfma_f32_16x16x32_bf16 a[216:219], a[132:135], a[28:31], a[216:219]
v_mfma_f32_16x16x32_bf16 a[224:227], a[128:131], a[32:35], a[224:227]
v_mfma_f32_16x16x32_bf16 a[224:227], a[132:135], a[36:39], a[224:227]
v_mfma_f32_16x16x32_bf16 a[232:235], a[128:131], a[40:43], a[232:235]
v_mfma_f32_16x16x32_bf16 a[232:235], a[132:135], a[44:47], a[232:235]
v_mfma_f32_16x16x32_bf16 a[240:243], a[128:131], a[48:51], a[240:243]
v_mfma_f32_16x16x32_bf16 a[240:243], a[132:135], a[52:55], a[240:243]
v_mfma_f32_16x16x32_bf16 a[248:251], a[128:131], a[56:59], a[248:251]
s_waitcnt vmcnt(2) lgkmcnt(0)
v_mfma_f32_16x16x32_bf16 a[248:251], a[132:135], a[60:63], a[248:251]
s_barrier
v_mfma_f32_16x16x32_bf16 a[196:199], a[136:139], a[0:3], a[196:199]
s_add_u32 m0, s29, 65536
ds_read_b64_tr_b16 a[128:129], v4 offset:32768
v_mfma_f32_16x16x32_bf16 a[196:199], a[140:143], a[4:7], a[196:199]
buffer_load_dwordx4 v16, s[12:15], s26 offen offset:0 lds
v_mfma_f32_16x16x32_bf16 a[204:207], a[136:139], a[8:11], a[204:207]
ds_read_b64_tr_b16 a[130:131], v4 offset:34816
v_mfma_f32_16x16x32_bf16 a[204:207], a[140:143], a[12:15], a[204:207]
v_mfma_f32_16x16x32_bf16 a[212:215], a[136:139], a[16:19], a[212:215]
ds_read_b64_tr_b16 a[132:133], v4 offset:49152
v_mfma_f32_16x16x32_bf16 a[212:215], a[140:143], a[20:23], a[212:215]
buffer_load_dwordx4 v17, s[12:15], s26 offen offset:1024 lds
v_mfma_f32_16x16x32_bf16 a[220:223], a[136:139], a[24:27], a[220:223]
ds_read_b64_tr_b16 a[134:135], v4 offset:51200
v_mfma_f32_16x16x32_bf16 a[220:223], a[140:143], a[28:31], a[220:223]
v_mfma_f32_16x16x32_bf16 a[228:231], a[136:139], a[32:35], a[228:231]
v_mfma_f32_16x16x32_bf16 a[228:231], a[140:143], a[36:39], a[228:231]
buffer_load_dwordx4 v18, s[12:15], s26 offen offset:2048 lds
v_mfma_f32_16x16x32_bf16 a[236:239], a[136:139], a[40:43], a[236:239]
v_mfma_f32_16x16x32_bf16 a[236:239], a[140:143], a[44:47], a[236:239]
v_mfma_f32_16x16x32_bf16 a[244:247], a[136:139], a[48:51], a[244:247]
v_mfma_f32_16x16x32_bf16 a[244:247], a[140:143], a[52:55], a[244:247]
s_waitcnt lgkmcnt(0)
buffer_load_dwordx4 v19, s[12:15], s26 offen offset:3072 lds
v_mfma_f32_16x16x32_bf16 a[252:255], a[136:139], a[56:59], a[252:255]
s_add_u32 s26, s26, 524288
s_bitcmp1_b32 s30, 1
v_mfma_f32_16x16x32_bf16 a[252:255], a[140:143], a[60:63], a[252:255]
s_cbranch_scc1 Lg_1
s_cmp_eq_u32 s30, 0
s_cbranch_scc1 Lg_1t
v_mfma_f32_16x16x32_bf16 v[32:35], a[128:131], a[64:67], v[32:35]
s_add_u32 m0, s29, 81920
ds_read_b64_tr_b16 a[136:137], v5 offset:32768
v_mfma_f32_16x16x32_bf16 v[32:35], a[132:135], a[68:71], v[32:35]
buffer_load_dwordx4 v16, s[12:15], s27 offen offset:0 lds
v_mfma_f32_16x16x32_bf16 v[40:43], a[128:131], a[72:75], v[40:43]
s_lshl_b32 s22, s38, 3
ds_read_b64_tr_b16 a[138:139], v5 offset:34816
v_mfma_f32_16x16x32_bf16 v[40:43], a[132:135], a[76:79], v[40:43]
s_lshl_b32 s23, s39, 5
v_and_b32 v252, 31, v0
v_lshrrev_b32 v253, 5, v0
v_mfma_f32_16x16x32_bf16 v[48:51], a[128:131], a[80:83], v[48:51]
ds_read_b64_tr_b16 a[140:141], v5 offset:49152
v_add_u32 v253, s22, v253
v_mfma_f32_16x16x32_bf16 v[48:51], a[132:135], a[84:87], v[48:51]
buffer_load_dwordx4 v17, s[12:15], s27 offen offset:1024 lds
v_mfma_f32_16x16x32_bf16 v[56:59], a[128:131], a[88:91], v[56:59]
ds_read_b64_tr_b16 a[142:143], v5 offset:51200
v_add_u32 v252, s23, v252
v_mfma_f32_16x16x32_bf16 v[56:59], a[132:135], a[92:95], v[56:59]
v_mul_u32_u24 v254, 7168, v253
v_lshl_add_u32 v254, v252, 2, v254
v_mfma_f32_16x16x32_bf16 v[64:67], a[128:131], a[96:99], v[64:67]
ds_read_b128 a[0:3], v2 offset:0
v_lshlrev_b32 v252, 4, v252
v_mfma_f32_16x16x32_bf16 v[64:67], a[132:135], a[100:103], v[64:67]
buffer_load_dwordx4 v18, s[12:15], s27 offen offset:2048 lds
v_mfma_f32_16x16x32_bf16 v[72:75], a[128:131], a[104:107], v[72:75]
ds_read_b128 a[4:7], v3 offset:0
v_add_u32 v255, 3584, v254
v_mfma_f32_16x16x32_bf16 v[72:75], a[132:135], a[108:111], v[72:75]
v_subrev_u32 v22, 3584, v254
v_subrev_u32 v23, 2688, v254
v_mfma_f32_16x16x32_bf16 v[80:83], a[128:131], a[112:115], v[80:83]
v_subrev_u32 v24, 1792, v254
v_subrev_u32 v25, 896, v254
v_mfma_f32_16x16x32_bf16 v[80:83], a[132:135], a[116:119], v[80:83]
buffer_load_dwordx4 v19, s[12:15], s27 offen offset:3072 lds
v_mfma_f32_16x16x32_bf16 v[88:91], a[128:131], a[120:123], v[88:91]
s_add_u32 s27, s27, 524288
ds_read_b128 a[8:11], v2 offset:2048
v_mfma_f32_16x16x32_bf16 v[88:91], a[132:135], a[124:127], v[88:91]
s_waitcnt lgkmcnt(3)
v_mfma_f32_16x16x32_bf16 v[36:39], a[136:139], a[64:67], v[36:39]
s_add_u32 m0, s28, 32768
ds_read_b64_tr_b16 a[128:129], v6 offset:32768
v_mfma_f32_16x16x32_bf16 v[36:39], a[140:143], a[68:71], v[36:39]
buffer_load_dwordx4 v12, s[8:11], s24 offen offset:0 lds
v_mfma_f32_16x16x32_bf16 v[44:47], a[136:139], a[72:75], v[44:47]
ds_read_b64_tr_b16 a[130:131], v6 offset:34816
v_mfma_f32_16x16x32_bf16 v[44:47], a[140:143], a[76:79], v[44:47]
v_mfma_f32_16x16x32_bf16 v[52:55], a[136:139], a[80:83], v[52:55]
ds_read_b64_tr_b16 a[132:133], v6 offset:49152
v_mfma_f32_16x16x32_bf16 v[52:55], a[140:143], a[84:87], v[52:55]
buffer_load_dwordx4 v13, s[8:11], s24 offen offset:1024 lds
v_mfma_f32_16x16x32_bf16 v[60:63], a[136:139], a[88:91], v[60:63]
ds_read_b64_tr_b16 a[134:135], v6 offset:51200
v_mfma_f32_16x16x32_bf16 v[60:63], a[140:143], a[92:95], v[60:63]
v_mfma_f32_16x16x32_bf16 v[68:71], a[136:139], a[96:99], v[68:71]
ds_read_b128 a[12:15], v3 offset:2048
v_mfma_f32_16x16x32_bf16 v[68:71], a[140:143], a[100:103], v[68:71]
buffer_load_dwordx4 v14, s[8:11], s24 offen offset:2048 lds
v_mfma_f32_16x16x32_bf16 v[76:79], a[136:139], a[104:107], v[76:79]
v_mfma_f32_16x16x32_bf16 v[76:79], a[140:143], a[108:111], v[76:79]
v_mfma_f32_16x16x32_bf16 v[84:87], a[136:139], a[112:115], v[84:87]
ds_read_b128 a[16:19], v2 offset:4096
v_mfma_f32_16x16x32_bf16 v[84:87], a[140:143], a[116:119], v[84:87]
buffer_load_dwordx4 v15, s[8:11], s24 offen offset:3072 lds
v_mfma_f32_16x16x32_bf16 v[92:95], a[136:139], a[120:123], v[92:95]
s_add_u32 s24, s24, 128
ds_read_b128 a[20:23], v3 offset:4096
v_mfma_f32_16x16x32_bf16 v[92:95], a[140:143], a[124:127], v[92:95]
s_waitcnt lgkmcnt(3)
v_mfma_f32_16x16x32_bf16 v[96:99], a[128:131], a[64:67], v[96:99]
s_add_u32 m0, s28, 36864
ds_read_b64_tr_b16 a[136:137], v7 offset:32768
v_mfma_f32_16x16x32_bf16 v[96:99], a[132:135], a[68:71], v[96:99]
buffer_load_dwordx4 v12, s[8:11], s25 offen offset:0 lds
v_mfma_f32_16x16x32_bf16 v[104:107], a[128:131], a[72:75], v[104:107]
ds_read_b64_tr_b16 a[138:139], v7 offset:34816
v_mfma_f32_16x16x32_bf16 v[104:107], a[132:135], a[76:79], v[104:107]
v_mfma_f32_16x16x32_bf16 v[112:115], a[128:131], a[80:83], v[112:115]
ds_read_b64_tr_b16 a[140:141], v7 offset:49152
v_mfma_f32_16x16x32_bf16 v[112:115], a[132:135], a[84:87], v[112:115]
buffer_load_dwordx4 v13, s[8:11], s25 offen offset:1024 lds
v_mfma_f32_16x16x32_bf16 v[120:123], a[128:131], a[88:91], v[120:123]
ds_read_b64_tr_b16 a[142:143], v7 offset:51200
v_mfma_f32_16x16x32_bf16 v[120:123], a[132:135], a[92:95], v[120:123]
v_mfma_f32_16x16x32_bf16 v[128:131], a[128:131], a[96:99], v[128:131]
v_mfma_f32_16x16x32_bf16 v[128:131], a[132:135], a[100:103], v[128:131]
buffer_load_dwordx4 v14, s[8:11], s25 offen offset:2048 lds
v_mfma_f32_16x16x32_bf16 v[136:139], a[128:131], a[104:107], v[136:139]
ds_read_b128 a[24:27], v2 offset:6144
v_mfma_f32_16x16x32_bf16 v[136:139], a[132:135], a[108:111], v[136:139]
v_mfma_f32_16x16x32_bf16 v[144:147], a[128:131], a[112:115], v[144:147]
ds_read_b128 a[28:31], v3 offset:6144
v_mfma_f32_16x16x32_bf16 v[144:147], a[132:135], a[116:119], v[144:147]
buffer_load_dwordx4 v15, s[8:11], s25 offen offset:3072 lds
v_mfma_f32_16x16x32_bf16 v[152:155], a[128:131], a[120:123], v[152:155]
s_add_u32 s25, s25, 128
v_mfma_f32_16x16x32_bf16 v[152:155], a[132:135], a[124:127], v[152:155]
s_waitcnt lgkmcnt(2)
v_mfma_f32_16x16x32_bf16 v[100:103], a[136:139], a[64:67], v[100:103]
s_mov_b64 s[56:57], s[70:71]
s_mov_b32 s58, 3584
s_mov_b32 s59, 0x20000
ds_read_b64_tr_b16 a[128:129], v8 offset:32768
v_mfma_f32_16x16x32_bf16 v[100:103], a[140:143], a[68:71], v[100:103]
buffer_load_dwordx4 v[248:251], v252, s[56:59], 0 offen
v_mfma_f32_16x16x32_bf16 v[108:111], a[136:139], a[72:75], v[108:111]
s_mov_b64 s[56:57], s[66:67]
s_mov_b32 s58, 1835008
ds_read_b64_tr_b16 a[130:131], v8 offset:34816
v_mfma_f32_16x16x32_bf16 v[108:111], a[140:143], a[76:79], v[108:111]
buffer_load_dword v224, v22, s[56:59], 0 offen nt
v_mfma_f32_16x16x32_bf16 v[116:119], a[136:139], a[80:83], v[116:119]
ds_read_b64_tr_b16 a[132:133], v8 offset:49152
v_mfma_f32_16x16x32_bf16 v[116:119], a[140:143], a[84:87], v[116:119]
buffer_load_dword v225, v23, s[56:59], 0 offen nt
v_mfma_f32_16x16x32_bf16 v[124:127], a[136:139], a[88:91], v[124:127]
ds_read_b64_tr_b16 a[134:135], v8 offset:51200
v_mfma_f32_16x16x32_bf16 v[124:127], a[140:143], a[92:95], v[124:127]
buffer_load_dword v226, v24, s[56:59], 0 offen nt
v_mfma_f32_16x16x32_bf16 v[132:135], a[136:139], a[96:99], v[132:135]
ds_read_b128 a[32:35], v2 offset:8192
v_mfma_f32_16x16x32_bf16 v[132:135], a[140:143], a[100:103], v[132:135]
buffer_load_dword v227, v25, s[56:59], 0 offen nt
v_mfma_f32_16x16x32_bf16 v[140:143], a[136:139], a[104:107], v[140:143]
buffer_load_dword v228, v254, s[56:59], 0 offen offset:0 nt
v_mfma_f32_16x16x32_bf16 v[140:143], a[140:143], a[108:111], v[140:143]
buffer_load_dword v229, v254, s[56:59], 0 offen offset:896 nt
v_mfma_f32_16x16x32_bf16 v[148:151], a[136:139], a[112:115], v[148:151]
ds_read_b128 a[36:39], v3 offset:8192
v_mfma_f32_16x16x32_bf16 v[148:151], a[140:143], a[116:119], v[148:151]
buffer_load_dword v230, v254, s[56:59], 0 offen offset:1792 nt
v_mfma_f32_16x16x32_bf16 v[156:159], a[136:139], a[120:123], v[156:159]
ds_read_b128 a[40:43], v2 offset:10240
v_mfma_f32_16x16x32_bf16 v[156:159], a[140:143], a[124:127], v[156:159]
s_waitcnt lgkmcnt(3)
buffer_load_dword v231, v254, s[56:59], 0 offen offset:2688 nt
v_mfma_f32_16x16x32_bf16 v[160:163], a[128:131], a[64:67], v[160:163]
ds_read_b64_tr_b16 a[136:137], v9 offset:32768
v_mfma_f32_16x16x32_bf16 v[160:163], a[132:135], a[68:71], v[160:163]
buffer_load_dword v232, v255, s[56:59], 0 offen offset:0 nt
v_mfma_f32_16x16x32_bf16 v[168:171], a[128:131], a[72:75], v[168:171]
ds_read_b64_tr_b16 a[138:139], v9 offset:34816
v_mfma_f32_16x16x32_bf16 v[168:171], a[132:135], a[76:79], v[168:171]
buffer_load_dword v233, v255, s[56:59], 0 offen offset:896 nt
v_mfma_f32_16x16x32_bf16 v[176:179], a[128:131], a[80:83], v[176:179]
ds_read_b64_tr_b16 a[140:141], v9 offset:49152
v_mfma_f32_16x16x32_bf16 v[176:179], a[132:135], a[84:87], v[176:179]
buffer_load_dword v234, v255, s[56:59], 0 offen offset:1792 nt
v_mfma_f32_16x16x32_bf16 v[184:187], a[128:131], a[88:91], v[184:187]
ds_read_b64_tr_b16 a[142:143], v9 offset:51200
v_mfma_f32_16x16x32_bf16 v[184:187], a[132:135], a[92:95], v[184:187]
buffer_load_dword v235, v255, s[56:59], 0 offen offset:2688 nt
v_mfma_f32_16x16x32_bf16 v[192:195], a[128:131], a[96:99], v[192:195]
s_mov_b64 s[56:57], s[68:69]
buffer_load_dword v236, v25, s[56:59], 0 offen nt
v_mfma_f32_16x16x32_bf16 v[192:195], a[132:135], a[100:103], v[192:195]
buffer_load_dword v237, v254, s[56:59], 0 offen offset:0 nt
v_mfma_f32_16x16x32_bf16 v[200:203], a[128:131], a[104:107], v[200:203]
ds_read_b128 a[44:47], v3 offset:10240
v_mfma_f32_16x16x32_bf16 v[200:203], a[132:135], a[108:111], v[200:203]
buffer_load_dword v238, v254, s[56:59], 0 offen offset:896 nt
v_mfma_f32_16x16x32_bf16 v[208:211], a[128:131], a[112:115], v[208:211]
ds_read_b128 a[48:51], v2 offset:12288
v_mfma_f32_16x16x32_bf16 v[208:211], a[132:135], a[116:119], v[208:211]
buffer_load_dword v239, v254, s[56:59], 0 offen offset:1792 nt
v_mfma_f32_16x16x32_bf16 v[216:219], a[128:131], a[120:123], v[216:219]
buffer_load_dword v240, v254, s[56:59], 0 offen offset:2688 nt
v_mfma_f32_16x16x32_bf16 v[216:219], a[132:135], a[124:127], v[216:219]
s_waitcnt lgkmcnt(2)
buffer_load_dword v241, v255, s[56:59], 0 offen offset:0 nt
v_mfma_f32_16x16x32_bf16 v[164:167], a[136:139], a[64:67], v[164:167]
ds_read_b64_tr_b16 a[128:129], v10 offset:32768
v_mfma_f32_16x16x32_bf16 v[164:167], a[140:143], a[68:71], v[164:167]
buffer_load_dword v242, v255, s[56:59], 0 offen offset:896 nt
v_mfma_f32_16x16x32_bf16 v[172:175], a[136:139], a[72:75], v[172:175]
ds_read_b64_tr_b16 a[130:131], v10 offset:34816
v_mfma_f32_16x16x32_bf16 v[172:175], a[140:143], a[76:79], v[172:175]
buffer_load_dword v243, v255, s[56:59], 0 offen offset:1792 nt
v_mfma_f32_16x16x32_bf16 v[180:183], a[136:139], a[80:83], v[180:183]
ds_read_b64_tr_b16 a[132:133], v10 offset:49152
v_mfma_f32_16x16x32_bf16 v[180:183], a[140:143], a[84:87], v[180:183]
buffer_load_dword v244, v255, s[56:59], 0 offen offset:2688 nt
v_mfma_f32_16x16x32_bf16 v[188:191], a[136:139], a[88:91], v[188:191]
ds_read_b64_tr_b16 a[134:135], v10 offset:51200
v_mfma_f32_16x16x32_bf16 v[188:191], a[140:143], a[92:95], v[188:191]
v_mfma_f32_16x16x32_bf16 v[196:199], a[136:139], a[96:99], v[196:199]
ds_read_b128 a[52:55], v3 offset:12288
v_mfma_f32_16x16x32_bf16 v[196:199], a[140:143], a[100:103], v[196:199]
v_mfma_f32_16x16x32_bf16 v[204:207], a[136:139], a[104:107], v[204:207]
ds_read_b128 a[56:59], v2 offset:14336
v_mfma_f32_16x16x32_bf16 v[204:207], a[140:143], a[108:111], v[204:207]
v_mfma_f32_16x16x32_bf16 v[212:215], a[136:139], a[112:115], v[212:215]
v_mfma_f32_16x16x32_bf16 v[212:215], a[140:143], a[116:119], v[212:215]
v_mfma_f32_16x16x32_bf16 v[220:223], a[136:139], a[120:123], v[220:223]
ds_read_b128 a[60:63], v3 offset:14336
v_mfma_f32_16x16x32_bf16 v[220:223], a[140:143], a[124:127], v[220:223]
s_waitcnt lgkmcnt(3)
v_mfma_f32_16x16x32_bf16 a[192:195], a[128:131], a[64:67], a[192:195]
ds_read_b64_tr_b16 a[136:137], v11 offset:32768
v_mfma_f32_16x16x32_bf16 a[192:195], a[132:135], a[68:71], a[192:195]
v_mfma_f32_16x16x32_bf16 a[200:203], a[128:131], a[72:75], a[200:203]
ds_read_b64_tr_b16 a[138:139], v11 offset:34816
v_mfma_f32_16x16x32_bf16 a[200:203], a[132:135], a[76:79], a[200:203]
v_mfma_f32_16x16x32_bf16 a[208:211], a[128:131], a[80:83], a[208:211]
ds_read_b64_tr_b16 a[140:141], v11 offset:49152
v_mfma_f32_16x16x32_bf16 a[208:211], a[132:135], a[84:87], a[208:211]
v_mfma_f32_16x16x32_bf16 a[216:219], a[128:131], a[88:91], a[216:219]
ds_read_b64_tr_b16 a[142:143], v11 offset:51200
v_mfma_f32_16x16x32_bf16 a[216:219], a[132:135], a[92:95], a[216:219]
v_mfma_f32_16x16x32_bf16 a[224:227], a[128:131], a[96:99], a[224:227]
v_mfma_f32_16x16x32_bf16 a[224:227], a[132:135], a[100:103], a[224:227]
v_mfma_f32_16x16x32_bf16 a[232:235], a[128:131], a[104:107], a[232:235]
v_mfma_f32_16x16x32_bf16 a[232:235], a[132:135], a[108:111], a[232:235]
v_mfma_f32_16x16x32_bf16 a[240:243], a[128:131], a[112:115], a[240:243]
v_mfma_f32_16x16x32_bf16 a[240:243], a[132:135], a[116:119], a[240:243]
v_mfma_f32_16x16x32_bf16 a[248:251], a[128:131], a[120:123], a[248:251]
s_waitcnt vmcnt(22) lgkmcnt(0)
v_mfma_f32_16x16x32_bf16 a[248:251], a[132:135], a[124:127], a[248:251]
s_barrier
v_mfma_f32_16x16x32_bf16 a[196:199], a[136:139], a[64:67], a[196:199]
s_add_u32 m0, s29, 98304
ds_read_b64_tr_b16 a[128:129], v4 offset:0
v_mfma_f32_16x16x32_bf16 a[196:199], a[140:143], a[68:71], a[196:199]
buffer_load_dwordx4 v16, s[12:15], s26 offen offset:0 lds
v_mfma_f32_16x16x32_bf16 a[204:207], a[136:139], a[72:75], a[204:207]
ds_read_b64_tr_b16 a[130:131], v4 offset:2048
v_mfma_f32_16x16x32_bf16 a[204:207], a[140:143], a[76:79], a[204:207]
v_mfma_f32_16x16x32_bf16 a[212:215], a[136:139], a[80:83], a[212:215]
ds_read_b64_tr_b16 a[132:133], v4 offset:16384
v_mfma_f32_16x16x32_bf16 a[212:215], a[140:143], a[84:87], a[212:215]
buffer_load_dwordx4 v17, s[12:15], s26 offen offset:1024 lds
v_mfma_f32_16x16x32_bf16 a[220:223], a[136:139], a[88:91], a[220:223]
ds_read_b64_tr_b16 a[134:135], v4 offset:18432
v_mfma_f32_16x16x32_bf16 a[220:223], a[140:143], a[92:95], a[220:223]
v_mfma_f32_16x16x32_bf16 a[228:231], a[136:139], a[96:99], a[228:231]
v_mfma_f32_16x16x32_bf16 a[228:231], a[140:143], a[100:103], a[228:231]
buffer_load_dwordx4 v18, s[12:15], s26 offen offset:2048 lds
v_mfma_f32_16x16x32_bf16 a[236:239], a[136:139], a[104:107], a[236:239]
v_mfma_f32_16x16x32_bf16 a[236:239], a[140:143], a[108:111], a[236:239]
v_mfma_f32_16x16x32_bf16 a[244:247], a[136:139], a[112:115], a[244:247]
v_mfma_f32_16x16x32_bf16 a[244:247], a[140:143], a[116:119], a[244:247]
buffer_load_dwordx4 v19, s[12:15], s26 offen offset:3072 lds
v_mfma_f32_16x16x32_bf16 a[252:255], a[136:139], a[120:123], a[252:255]
s_add_u32 s26, s26, 524288
v_mfma_f32_16x16x32_bf16 a[252:255], a[140:143], a[124:127], a[252:255]
s_waitcnt lgkmcnt(0)
v_mfma_f32_16x16x32_bf16 v[32:35], a[128:131], a[0:3], v[32:35]
s_add_u32 m0, s29, 114688
ds_read_b64_tr_b16 a[136:137], v5 offset:0
v_mfma_f32_16x16x32_bf16 v[32:35], a[132:135], a[4:7], v[32:35]
buffer_load_dwordx4 v16, s[12:15], s27 offen offset:0 lds
v_mfma_f32_16x16x32_bf16 v[40:43], a[128:131], a[8:11], v[40:43]
ds_read_b64_tr_b16 a[138:139], v5 offset:2048
v_mfma_f32_16x16x32_bf16 v[40:43], a[132:135], a[12:15], v[40:43]
v_mfma_f32_16x16x32_bf16 v[48:51], a[128:131], a[16:19], v[48:51]
ds_read_b64_tr_b16 a[140:141], v5 offset:16384
v_mfma_f32_16x16x32_bf16 v[48:51], a[132:135], a[20:23], v[48:51]
buffer_load_dwordx4 v17, s[12:15], s27 offen offset:1024 lds
v_mfma_f32_16x16x32_bf16 v[56:59], a[128:131], a[24:27], v[56:59]
ds_read_b64_tr_b16 a[142:143], v5 offset:18432
v_mfma_f32_16x16x32_bf16 v[56:59], a[132:135], a[28:31], v[56:59]
v_mfma_f32_16x16x32_bf16 v[64:67], a[128:131], a[32:35], v[64:67]
ds_read_b128 a[64:67], v2 offset:32768
v_mfma_f32_16x16x32_bf16 v[64:67], a[132:135], a[36:39], v[64:67]
buffer_load_dwordx4 v18, s[12:15], s27 offen offset:2048 lds
v_mfma_f32_16x16x32_bf16 v[72:75], a[128:131], a[40:43], v[72:75]
ds_read_b128 a[68:71], v3 offset:32768
v_mfma_f32_16x16x32_bf16 v[72:75], a[132:135], a[44:47], v[72:75]
v_mfma_f32_16x16x32_bf16 v[80:83], a[128:131], a[48:51], v[80:83]
v_mfma_f32_16x16x32_bf16 v[80:83], a[132:135], a[52:55], v[80:83]
buffer_load_dwordx4 v19, s[12:15], s27 offen offset:3072 lds
v_mfma_f32_16x16x32_bf16 v[88:91], a[128:131], a[56:59], v[88:91]
s_add_u32 s27, s27, 524288
ds_read_b128 a[72:75], v2 offset:34816
v_mfma_f32_16x16x32_bf16 v[88:91], a[132:135], a[60:63], v[88:91]
s_waitcnt lgkmcnt(3)
v_mfma_f32_16x16x32_bf16 v[36:39], a[136:139], a[0:3], v[36:39]
s_add_u32 m0, s28, 0
ds_read_b64_tr_b16 a[128:129], v6 offset:0
v_mfma_f32_16x16x32_bf16 v[36:39], a[140:143], a[4:7], v[36:39]
buffer_load_dwordx4 v12, s[8:11], s24 offen offset:0 lds
v_mfma_f32_16x16x32_bf16 v[44:47], a[136:139], a[8:11], v[44:47]
ds_read_b64_tr_b16 a[130:131], v6 offset:2048
v_mfma_f32_16x16x32_bf16 v[44:47], a[140:143], a[12:15], v[44:47]
v_mfma_f32_16x16x32_bf16 v[52:55], a[136:139], a[16:19], v[52:55]
ds_read_b64_tr_b16 a[132:133], v6 offset:16384
v_mfma_f32_16x16x32_bf16 v[52:55], a[140:143], a[20:23], v[52:55]
buffer_load_dwordx4 v13, s[8:11], s24 offen offset:1024 lds
v_mfma_f32_16x16x32_bf16 v[60:63], a[136:139], a[24:27], v[60:63]
ds_read_b64_tr_b16 a[134:135], v6 offset:18432
v_mfma_f32_16x16x32_bf16 v[60:63], a[140:143], a[28:31], v[60:63]
v_mfma_f32_16x16x32_bf16 v[68:71], a[136:139], a[32:35], v[68:71]
ds_read_b128 a[76:79], v3 offset:34816
v_mfma_f32_16x16x32_bf16 v[68:71], a[140:143], a[36:39], v[68:71]
buffer_load_dwordx4 v14, s[8:11], s24 offen offset:2048 lds
v_mfma_f32_16x16x32_bf16 v[76:79], a[136:139], a[40:43], v[76:79]
v_mfma_f32_16x16x32_bf16 v[76:79], a[140:143], a[44:47], v[76:79]
v_mfma_f32_16x16x32_bf16 v[84:87], a[136:139], a[48:51], v[84:87]
ds_read_b128 a[80:83], v2 offset:36864
v_mfma_f32_16x16x32_bf16 v[84:87], a[140:143], a[52:55], v[84:87]
buffer_load_dwordx4 v15, s[8:11], s24 offen offset:3072 lds
v_mfma_f32_16x16x32_bf16 v[92:95], a[136:139], a[56:59], v[92:95]
s_add_u32 s24, s24, 128
ds_read_b128 a[84:87], v3 offset:36864
v_mfma_f32_16x16x32_bf16 v[92:95], a[140:143], a[60:63], v[92:95]
s_waitcnt lgkmcnt(3)
v_mfma_f32_16x16x32_bf16 v[96:99], a[128:131], a[0:3], v[96:99]
s_add_u32 m0, s28, 4096
ds_read_b64_tr_b16 a[136:137], v7 offset:0
v_mfma_f32_16x16x32_bf16 v[96:99], a[132:135], a[4:7], v[96:99]
buffer_load_dwordx4 v12, s[8:11], s25 offen offset:0 lds
v_mfma_f32_16x16x32_bf16 v[104:107], a[128:131], a[8:11], v[104:107]
ds_read_b64_tr_b16 a[138:139], v7 offset:2048
v_mfma_f32_16x16x32_bf16 v[104:107], a[132:135], a[12:15], v[104:107]
v_mfma_f32_16x16x32_bf16 v[112:115], a[128:131], a[16:19], v[112:115]
ds_read_b64_tr_b16 a[140:141], v7 offset:16384
v_mfma_f32_16x16x32_bf16 v[112:115], a[132:135], a[20:23], v[112:115]
buffer_load_dwordx4 v13, s[8:11], s25 offen offset:1024 lds
v_mfma_f32_16x16x32_bf16 v[120:123], a[128:131], a[24:27], v[120:123]
ds_read_b64_tr_b16 a[142:143], v7 offset:18432
v_mfma_f32_16x16x32_bf16 v[120:123], a[132:135], a[28:31], v[120:123]
v_mfma_f32_16x16x32_bf16 v[128:131], a[128:131], a[32:35], v[128:131]
v_mfma_f32_16x16x32_bf16 v[128:131], a[132:135], a[36:39], v[128:131]
buffer_load_dwordx4 v14, s[8:11], s25 offen offset:2048 lds
v_mfma_f32_16x16x32_bf16 v[136:139], a[128:131], a[40:43], v[136:139]
ds_read_b128 a[88:91], v2 offset:38912
v_mfma_f32_16x16x32_bf16 v[136:139], a[132:135], a[44:47], v[136:139]
v_mfma_f32_16x16x32_bf16 v[144:147], a[128:131], a[48:51], v[144:147]
ds_read_b128 a[92:95], v3 offset:38912
v_mfma_f32_16x16x32_bf16 v[144:147], a[132:135], a[52:55], v[144:147]
buffer_load_dwordx4 v15, s[8:11], s25 offen offset:3072 lds
v_mfma_f32_16x16x32_bf16 v[152:155], a[128:131], a[56:59], v[152:155]
s_add_u32 s25, s25, 128
v_mfma_f32_16x16x32_bf16 v[152:155], a[132:135], a[60:63], v[152:155]
s_waitcnt lgkmcnt(2)
v_mfma_f32_16x16x32_bf16 v[100:103], a[136:139], a[0:3], v[100:103]
ds_read_b64_tr_b16 a[128:129], v8 offset:0
v_mfma_f32_16x16x32_bf16 v[100:103], a[140:143], a[4:7], v[100:103]
buffer_load_dword v21, v20, s[16:19], s43 offen
v_mfma_f32_16x16x32_bf16 v[108:111], a[136:139], a[8:11], v[108:111]
s_add_u32 s43, s43, s47
ds_read_b64_tr_b16 a[130:131], v8 offset:2048
v_mfma_f32_16x16x32_bf16 v[108:111], a[140:143], a[12:15], v[108:111]
PAD_2:
s_cbranch_execz M_tret
s_cmp_ge_u32 s43, s51
v_mfma_f32_16x16x32_bf16 v[116:119], a[136:139], a[16:19], v[116:119]
s_cselect_b32 s43, 0, s43
ds_read_b64_tr_b16 a[132:133], v8 offset:16384
v_mfma_f32_16x16x32_bf16 v[116:119], a[140:143], a[20:23], v[116:119]
s_cselect_b32 s51, s42, s51
v_mfma_f32_16x16x32_bf16 v[124:127], a[136:139], a[24:27], v[124:127]
s_cselect_b64 s[16:17], s[40:41], s[16:17]
ds_read_b64_tr_b16 a[134:135], v8 offset:18432
v_mfma_f32_16x16x32_bf16 v[124:127], a[140:143], a[28:31], v[124:127]
s_cselect_b32 s18, s42, s18
v_mfma_f32_16x16x32_bf16 v[132:135], a[136:139], a[32:35], v[132:135]
s_cselect_b64 s[40:41], s[44:45], s[40:41]
ds_read_b128 a[96:99], v2 offset:40960
v_mfma_f32_16x16x32_bf16 v[132:135], a[140:143], a[36:39], v[132:135]
s_cselect_b32 s42, s46, s42
v_mfma_f32_16x16x32_bf16 v[140:143], a[136:139], a[40:43], v[140:143]
s_cselect_b32 s46, 0, s46
v_mfma_f32_16x16x32_bf16 v[140:143], a[140:143], a[44:47], v[140:143]
s_lshl_b32 s59, s39, 5
v_mfma_f32_16x16x32_bf16 v[148:151], a[136:139], a[48:51], v[148:151]
s_add_u32 s59, s59, s38
ds_read_b128 a[100:103], v3 offset:40960
v_mfma_f32_16x16x32_bf16 v[148:151], a[140:143], a[52:55], v[148:151]
s_lshl_b32 s59, s59, 2
v_mfma_f32_16x16x32_bf16 v[156:159], a[136:139], a[56:59], v[156:159]
s_add_u32 s59, s59, 94392320
ds_read_b128 a[104:107], v2 offset:43008
v_mfma_f32_16x16x32_bf16 v[156:159], a[140:143], a[60:63], v[156:159]
s_waitcnt lgkmcnt(3)
s_cmp_lt_u32 s2, 224
v_mfma_f32_16x16x32_bf16 v[160:163], a[128:131], a[0:3], v[160:163]
s_cselect_b32 s59, s59, 3221225472
ds_read_b64_tr_b16 a[136:137], v9 offset:0
v_mfma_f32_16x16x32_bf16 v[160:163], a[132:135], a[4:7], v[160:163]
s_mov_b32 s58, 0xffff0000
v_mfma_f32_16x16x32_bf16 v[168:171], a[128:131], a[8:11], v[168:171]
s_cmp_lt_u32 s3, 1
ds_read_b64_tr_b16 a[138:139], v9 offset:2048
v_mfma_f32_16x16x32_bf16 v[168:171], a[132:135], a[12:15], v[168:171]
s_cselect_b32 s54, 0, 3221225472
v_mfma_f32_16x16x32_bf16 v[176:179], a[128:131], a[16:19], v[176:179]
s_cselect_b32 s50, 0x100, 0
ds_read_b64_tr_b16 a[140:141], v9 offset:16384
v_mfma_f32_16x16x32_bf16 v[176:179], a[132:135], a[20:23], v[176:179]
buffer_load_dword v21, v20, s[16:19], s43 offen
v_mfma_f32_16x16x32_bf16 v[184:187], a[128:131], a[24:27], v[184:187]
s_add_u32 s43, s43, s47
ds_read_b64_tr_b16 a[142:143], v9 offset:18432
v_mfma_f32_16x16x32_bf16 v[184:187], a[132:135], a[28:31], v[184:187]
s_cmp_ge_u32 s43, s51
v_mfma_f32_16x16x32_bf16 v[192:195], a[128:131], a[32:35], v[192:195]
s_cselect_b32 s43, 0, s43
v_mfma_f32_16x16x32_bf16 v[192:195], a[132:135], a[36:39], v[192:195]
s_cselect_b32 s51, s42, s51
v_mfma_f32_16x16x32_bf16 v[200:203], a[128:131], a[40:43], v[200:203]
s_cselect_b64 s[16:17], s[40:41], s[16:17]
ds_read_b128 a[108:111], v3 offset:43008
v_mfma_f32_16x16x32_bf16 v[200:203], a[132:135], a[44:47], v[200:203]
s_cselect_b32 s18, s42, s18
v_mfma_f32_16x16x32_bf16 v[208:211], a[128:131], a[48:51], v[208:211]
s_cselect_b64 s[40:41], s[44:45], s[40:41]
ds_read_b128 a[112:115], v2 offset:45056
v_mfma_f32_16x16x32_bf16 v[208:211], a[132:135], a[52:55], v[208:211]
s_cselect_b32 s42, s46, s42
v_mfma_f32_16x16x32_bf16 v[216:219], a[128:131], a[56:59], v[216:219]
s_cselect_b32 s46, 0, s46
v_mfma_f32_16x16x32_bf16 v[216:219], a[132:135], a[60:63], v[216:219]
s_waitcnt lgkmcnt(2)
v_mfma_f32_16x16x32_bf16 v[164:167], a[136:139], a[0:3], v[164:167]
ds_read_b64_tr_b16 a[128:129], v10 offset:0
v_mfma_f32_16x16x32_bf16 v[164:167], a[140:143], a[4:7], v[164:167]
v_mfma_f32_16x16x32_bf16 v[172:175], a[136:139], a[8:11], v[172:175]
ds_read_b64_tr_b16 a[130:131], v10 offset:2048
v_mfma_f32_16x16x32_bf16 v[172:175], a[140:143], a[12:15], v[172:175]
v_mfma_f32_16x16x32_bf16 v[180:183], a[136:139], a[16:19], v[180:183]
ds_read_b64_tr_b16 a[132:133], v10 offset:16384
v_mfma_f32_16x16x32_bf16 v[180:183], a[140:143], a[20:23], v[180:183]
v_mfma_f32_16x16x32_bf16 v[188:191], a[136:139], a[24:27], v[188:191]
ds_read_b64_tr_b16 a[134:135], v10 offset:18432
v_mfma_f32_16x16x32_bf16 v[188:191], a[140:143], a[28:31], v[188:191]
v_mfma_f32_16x16x32_bf16 v[196:199], a[136:139], a[32:35], v[196:199]
ds_read_b128 a[116:119], v3 offset:45056
v_mfma_f32_16x16x32_bf16 v[196:199], a[140:143], a[36:39], v[196:199]
v_mfma_f32_16x16x32_bf16 v[204:207], a[136:139], a[40:43], v[204:207]
ds_read_b128 a[120:123], v2 offset:47104
v_and_b32 v252, 31, v0
v_mfma_f32_16x16x32_bf16 v[204:207], a[140:143], a[44:47], v[204:207]
v_lshrrev_b32 v253, 5, v0
v_xor_b32 v253, v253, v252
v_mfma_f32_16x16x32_bf16 v[212:215], a[136:139], a[48:51], v[212:215]
v_and_b32 v253, 7, v253
v_lshlrev_b32 v252, 8, v252
v_mfma_f32_16x16x32_bf16 v[212:215], a[140:143], a[52:55], v[212:215]
v_lshl_add_u32 v252, v253, 4, v252
v_add_u32 v252, 147456, v252
v_mfma_f32_16x16x32_bf16 v[220:223], a[136:139], a[56:59], v[220:223]
ds_read_b128 a[124:127], v3 offset:47104
v_mfma_f32_16x16x32_bf16 v[220:223], a[140:143], a[60:63], v[220:223]
s_waitcnt lgkmcnt(3)
v_mfma_f32_16x16x32_bf16 a[192:195], a[128:131], a[0:3], a[192:195]
ds_read_b64_tr_b16 a[136:137], v11 offset:0
v_mfma_f32_16x16x32_bf16 a[192:195], a[132:135], a[4:7], a[192:195]
v_mfma_f32_16x16x32_bf16 a[200:203], a[128:131], a[8:11], a[200:203]
ds_read_b64_tr_b16 a[138:139], v11 offset:2048
v_mfma_f32_16x16x32_bf16 a[200:203], a[132:135], a[12:15], a[200:203]
v_mfma_f32_16x16x32_bf16 a[208:211], a[128:131], a[16:19], a[208:211]
ds_read_b64_tr_b16 a[140:141], v11 offset:16384
v_mfma_f32_16x16x32_bf16 a[208:211], a[132:135], a[20:23], a[208:211]
v_mfma_f32_16x16x32_bf16 a[216:219], a[128:131], a[24:27], a[216:219]
ds_read_b64_tr_b16 a[142:143], v11 offset:18432
v_mfma_f32_16x16x32_bf16 a[216:219], a[132:135], a[28:31], a[216:219]
v_mfma_f32_16x16x32_bf16 a[224:227], a[128:131], a[32:35], a[224:227]
v_mfma_f32_16x16x32_bf16 a[224:227], a[132:135], a[36:39], a[224:227]
v_mfma_f32_16x16x32_bf16 a[232:235], a[128:131], a[40:43], a[232:235]
v_mfma_f32_16x16x32_bf16 a[232:235], a[132:135], a[44:47], a[232:235]
v_mfma_f32_16x16x32_bf16 a[240:243], a[128:131], a[48:51], a[240:243]
v_mfma_f32_16x16x32_bf16 a[240:243], a[132:135], a[52:55], a[240:243]
v_mfma_f32_16x16x32_bf16 a[248:251], a[128:131], a[56:59], a[248:251]
s_waitcnt vmcnt(2) lgkmcnt(0)
v_mfma_f32_16x16x32_bf16 a[248:251], a[132:135], a[60:63], a[248:251]
s_barrier
v_mfma_f32_16x16x32_bf16 a[196:199], a[136:139], a[0:3], a[196:199]
s_add_u32 m0, s29, 65536
ds_read_b64_tr_b16 a[128:129], v4 offset:32768
v_lshlrev_b32 v28, 16, v248
v_mfma_f32_16x16x32_bf16 a[196:199], a[140:143], a[4:7], a[196:199]
buffer_load_dwordx4 v16, s[12:15], s26 offen offset:0 lds
v_mfma_f32_16x16x32_bf16 a[204:207], a[136:139], a[8:11], a[204:207]
ds_read_b64_tr_b16 a[130:131], v4 offset:34816
v_and_b32 v29, s58, v248
v_mfma_f32_16x16x32_bf16 a[204:207], a[140:143], a[12:15], a[204:207]
v_lshlrev_b32 v30, 16, v249
v_and_b32 v253, s58, v249
v_mfma_f32_16x16x32_bf16 a[212:215], a[136:139], a[16:19], a[212:215]
ds_read_b64_tr_b16 a[132:133], v4 offset:49152
v_lshlrev_b32 v22, 16, v224
v_mfma_f32_16x16x32_bf16 a[212:215], a[140:143], a[20:23], a[212:215]
buffer_load_dwordx4 v17, s[12:15], s26 offen offset:1024 lds
v_mfma_f32_16x16x32_bf16 a[220:223], a[136:139], a[24:27], a[220:223]
ds_read_b64_tr_b16 a[134:135], v4 offset:51200
v_lshlrev_b32 v23, 16, v225
v_mfma_f32_16x16x32_bf16 a[220:223], a[140:143], a[28:31], a[220:223]
v_lshlrev_b32 v24, 16, v226
v_mul_f32 v254, v22, v253
v_mfma_f32_16x16x32_bf16 a[228:231], a[136:139], a[32:35], a[228:231]
v_lshlrev_b32 v25, 16, v227
v_lshlrev_b32 v247, 16, v236
v_mfma_f32_16x16x32_bf16 a[228:231], a[140:143], a[36:39], a[228:231]
buffer_load_dwordx4 v18, s[12:15], s26 offen offset:2048 lds
v_mfma_f32_16x16x32_bf16 a[236:239], a[136:139], a[40:43], a[236:239]
v_fmac_f32 v254, v23, v30
v_fmac_f32 v254, v24, v29
v_mfma_f32_16x16x32_bf16 a[236:239], a[140:143], a[44:47], a[236:239]
v_fmac_f32 v254, v25, v28
v_mul_f32 v254, v254, v247
v_mfma_f32_16x16x32_bf16 a[244:247], a[136:139], a[48:51], a[244:247]
v_mul_f32 v255, v23, v253
v_lshlrev_b32 v22, 16, v228
v_mfma_f32_16x16x32_bf16 a[244:247], a[140:143], a[52:55], a[244:247]
buffer_load_dwordx4 v19, s[12:15], s26 offen offset:3072 lds
v_mfma_f32_16x16x32_bf16 a[252:255], a[136:139], a[56:59], a[252:255]
s_add_u32 s26, s26, 524288
v_lshlrev_b32 v247, 16, v237
v_fmac_f32 v255, v24, v30
v_mfma_f32_16x16x32_bf16 a[252:255], a[140:143], a[60:63], a[252:255]
s_waitcnt lgkmcnt(0)
v_fmac_f32 v255, v25, v29
v_fmac_f32 v255, v22, v28
v_mfma_f32_16x16x32_bf16 v[32:35], a[128:131], a[64:67], v[32:35]
s_add_u32 m0, s29, 81920
ds_read_b64_tr_b16 a[136:137], v5 offset:32768
v_mul_f32 v255, v255, v247
v_mfma_f32_16x16x32_bf16 v[32:35], a[132:135], a[68:71], v[32:35]
buffer_load_dwordx4 v16, s[12:15], s27 offen offset:0 lds
v_mfma_f32_16x16x32_bf16 v[40:43], a[128:131], a[72:75], v[40:43]
ds_read_b64_tr_b16 a[138:139], v5 offset:34816
v_cvt_pk_bf16_f32 v246, v254, v255
v_mfma_f32_16x16x32_bf16 v[40:43], a[132:135], a[76:79], v[40:43]
v_accvgpr_write_b32 a180, v246
v_mul_f32 v254, v24, v253
v_mfma_f32_16x16x32_bf16 v[48:51], a[128:131], a[80:83], v[48:51]
ds_read_b64_tr_b16 a[140:141], v5 offset:49152
v_lshlrev_b32 v23, 16, v229
v_mfma_f32_16x16x32_bf16 v[48:51], a[132:135], a[84:87], v[48:51]
buffer_load_dwordx4 v17, s[12:15], s27 offen offset:1024 lds
v_mfma_f32_16x16x32_bf16 v[56:59], a[128:131], a[88:91], v[56:59]
ds_read_b64_tr_b16 a[142:143], v5 offset:51200
v_lshlrev_b32 v247, 16, v238
v_mfma_f32_16x16x32_bf16 v[56:59], a[132:135], a[92:95], v[56:59]
v_fmac_f32 v254, v25, v30
v_fmac_f32 v254, v22, v29
v_fmac_f32 v254, v23, v28
v_mfma_f32_16x16x32_bf16 v[64:67], a[128:131], a[96:99], v[64:67]
ds_read_b128 a[0:3], v2 offset:0
v_mul_f32 v254, v254, v247
v_mfma_f32_16x16x32_bf16 v[64:67], a[132:135], a[100:103], v[64:67]
buffer_load_dwordx4 v18, s[12:15], s27 offen offset:2048 lds
v_mfma_f32_16x16x32_bf16 v[72:75], a[128:131], a[104:107], v[72:75]
ds_read_b128 a[4:7], v3 offset:0
v_cvt_pk_bf16_f32 v246, v255, v254
v_mfma_f32_16x16x32_bf16 v[72:75], a[132:135], a[108:111], v[72:75]
v_accvgpr_write_b32 a176, v246
v_mul_f32 v255, v25, v253
v_mfma_f32_16x16x32_bf16 v[80:83], a[128:131], a[112:115], v[80:83]
v_lshlrev_b32 v24, 16, v230
v_lshlrev_b32 v247, 16, v239
v_mfma_f32_16x16x32_bf16 v[80:83], a[132:135], a[116:119], v[80:83]
buffer_load_dwordx4 v19, s[12:15], s27 offen offset:3072 lds
v_mfma_f32_16x16x32_bf16 v[88:91], a[128:131], a[120:123], v[88:91]
s_add_u32 s27, s27, 524288
ds_read_b128 a[8:11], v2 offset:2048
v_fmac_f32 v255, v22, v30
v_mfma_f32_16x16x32_bf16 v[88:91], a[132:135], a[124:127], v[88:91]
s_waitcnt lgkmcnt(3)
v_fmac_f32 v255, v23, v29
v_fmac_f32 v255, v24, v28
v_mul_f32 v255, v255, v247
v_mfma_f32_16x16x32_bf16 v[36:39], a[136:139], a[64:67], v[36:39]
s_add_u32 m0, s28, 32768
ds_read_b64_tr_b16 a[128:129], v6 offset:32768
v_cvt_pk_bf16_f32 v246, v254, v255
v_mfma_f32_16x16x32_bf16 v[36:39], a[140:143], a[68:71], v[36:39]
buffer_load_dwordx4 v12, s[8:11], s24 offen offset:0 lds
v_mfma_f32_16x16x32_bf16 v[44:47], a[136:139], a[72:75], v[44:47]
ds_read_b64_tr_b16 a[130:131], v6 offset:34816
v_accvgpr_write_b32 a181, v246
v_mfma_f32_16x16x32_bf16 v[44:47], a[140:143], a[76:79], v[44:47]
v_mul_f32 v254, v22, v253
v_lshlrev_b32 v25, 16, v231
v_mfma_f32_16x16x32_bf16 v[52:55], a[136:139], a[80:83], v[52:55]
ds_read_b64_tr_b16 a[132:133], v6 offset:49152
v_lshlrev_b32 v247, 16, v240
v_mfma_f32_16x16x32_bf16 v[52:55], a[140:143], a[84:87], v[52:55]
buffer_load_dwordx4 v13, s[8:11], s24 offen offset:1024 lds
v_mfma_f32_16x16x32_bf16 v[60:63], a[136:139], a[88:91], v[60:63]
ds_read_b64_tr_b16 a[134:135], v6 offset:51200
v_fmac_f32 v254, v23, v30
v_fmac_f32 v254, v24, v29
v_mfma_f32_16x16x32_bf16 v[60:63], a[140:143], a[92:95], v[60:63]
v_fmac_f32 v254, v25, v28
v_mul_f32 v254, v254, v247
v_mfma_f32_16x16x32_bf16 v[68:71], a[136:139], a[96:99], v[68:71]
ds_read_b128 a[12:15], v3 offset:2048
v_cvt_pk_bf16_f32 v246, v255, v254
v_mfma_f32_16x16x32_bf16 v[68:71], a[140:143], a[100:103], v[68:71]
buffer_load_dwordx4 v14, s[8:11], s24 offen offset:2048 lds
v_mfma_f32_16x16x32_bf16 v[76:79], a[136:139], a[104:107], v[76:79]
v_accvgpr_write_b32 a177, v246
v_mul_f32 v255, v23, v253
v_mfma_f32_16x16x32_bf16 v[76:79], a[140:143], a[108:111], v[76:79]
v_lshlrev_b32 v22, 16, v232
v_lshlrev_b32 v247, 16, v241
v_mfma_f32_16x16x32_bf16 v[84:87], a[136:139], a[112:115], v[84:87]
ds_read_b128 a[16:19], v2 offset:4096
v_fmac_f32 v255, v24, v30
v_mfma_f32_16x16x32_bf16 v[84:87], a[140:143], a[116:119], v[84:87]
buffer_load_dwordx4 v15, s[8:11], s24 offen offset:3072 lds
v_mfma_f32_16x16x32_bf16 v[92:95], a[136:139], a[120:123], v[92:95]
s_add_u32 s24, s24, 128
ds_read_b128 a[20:23], v3 offset:4096
v_fmac_f32 v255, v25, v29
v_fmac_f32 v255, v22, v28
v_mfma_f32_16x16x32_bf16 v[92:95], a[140:143], a[124:127], v[92:95]
s_waitcnt lgkmcnt(3)
v_mul_f32 v255, v255, v247
v_cvt_pk_bf16_f32 v246, v254, v255
v_mfma_f32_16x16x32_bf16 v[96:99], a[128:131], a[64:67], v[96:99]
s_add_u32 m0, s28, 36864
ds_read_b64_tr_b16 a[136:137], v7 offset:32768
v_accvgpr_write_b32 a182, v246
v_mfma_f32_16x16x32_bf16 v[96:99], a[132:135], a[68:71], v[96:99]
buffer_load_dwordx4 v12, s[8:11], s25 offen offset:0 lds
v_mfma_f32_16x16x32_bf16 v[104:107], a[128:131], a[72:75], v[104:107]
ds_read_b64_tr_b16 a[138:139], v7 offset:34816
v_mul_f32 v254, v24, v253
v_mfma_f32_16x16x32_bf16 v[104:107], a[132:135], a[76:79], v[104:107]
v_lshlrev_b32 v23, 16, v233
v_lshlrev_b32 v247, 16, v242
v_mfma_f32_16x16x32_bf16 v[112:115], a[128:131], a[80:83], v[112:115]
ds_read_b64_tr_b16 a[140:141], v7 offset:49152
v_fmac_f32 v254, v25, v30
v_mfma_f32_16x16x32_bf16 v[112:115], a[132:135], a[84:87], v[112:115]
buffer_load_dwordx4 v13, s[8:11], s25 offen offset:1024 lds
v_fmac_f32 v254, v22, v29
v_mfma_f32_16x16x32_bf16 v[120:123], a[128:131], a[88:91], v[120:123]
ds_read_b64_tr_b16 a[142:143], v7 offset:51200
v_fmac_f32 v254, v23, v28
v_mfma_f32_16x16x32_bf16 v[120:123], a[132:135], a[92:95], v[120:123]
v_mul_f32 v254, v254, v247
v_cvt_pk_bf16_f32 v246, v255, v254
v_mfma_f32_16x16x32_bf16 v[128:131], a[128:131], a[96:99], v[128:131]
v_accvgpr_write_b32 a178, v246
v_mul_f32 v255, v25, v253
v_mfma_f32_16x16x32_bf16 v[128:131], a[132:135], a[100:103], v[128:131]
buffer_load_dwordx4 v14, s[8:11], s25 offen offset:2048 lds
v_mfma_f32_16x16x32_bf16 v[136:139], a[128:131], a[104:107], v[136:139]
ds_read_b128 a[24:27], v2 offset:6144
v_lshlrev_b32 v24, 16, v234
v_mfma_f32_16x16x32_bf16 v[136:139], a[132:135], a[108:111], v[136:139]
v_lshlrev_b32 v247, 16, v243
v_fmac_f32 v255, v22, v30
v_mfma_f32_16x16x32_bf16 v[144:147], a[128:131], a[112:115], v[144:147]
ds_read_b128 a[28:31], v3 offset:6144
v_fmac_f32 v255, v23, v29
v_mfma_f32_16x16x32_bf16 v[144:147], a[132:135], a[116:119], v[144:147]
buffer_load_dwordx4 v15, s[8:11], s25 offen offset:3072 lds
v_fmac_f32 v255, v24, v28
v_mfma_f32_16x16x32_bf16 v[152:155], a[128:131], a[120:123], v[152:155]
s_add_u32 s25, s25, 128
v_mul_f32 v255, v255, v247
v_cvt_pk_bf16_f32 v246, v254, v255
v_mfma_f32_16x16x32_bf16 v[152:155], a[132:135], a[124:127], v[152:155]
s_waitcnt lgkmcnt(2)
v_accvgpr_write_b32 a183, v246
v_mul_f32 v254, v22, v253
v_mfma_f32_16x16x32_bf16 v[100:103], a[136:139], a[64:67], v[100:103]
ds_read_b64_tr_b16 a[128:129], v8 offset:32768
v_lshlrev_b32 v25, 16, v235
v_mfma_f32_16x16x32_bf16 v[100:103], a[140:143], a[68:71], v[100:103]
buffer_load_dword v21, v20, s[16:19], s43 offen
v_mfma_f32_16x16x32_bf16 v[108:111], a[136:139], a[72:75], v[108:111]
s_add_u32 s43, s43, s47
ds_read_b64_tr_b16 a[130:131], v8 offset:34816
v_lshlrev_b32 v247, 16, v244
v_mfma_f32_16x16x32_bf16 v[108:111], a[140:143], a[76:79], v[108:111]
s_cmp_ge_u32 s43, s51
v_fmac_f32 v254, v23, v30
v_fmac_f32 v254, v24, v29
v_mfma_f32_16x16x32_bf16 v[116:119], a[136:139], a[80:83], v[116:119]
s_cselect_b32 s43, 0, s43
ds_read_b64_tr_b16 a[132:133], v8 offset:49152
v_fmac_f32 v254, v25, v28
v_mul_f32 v254, v254, v247
v_mfma_f32_16x16x32_bf16 v[116:119], a[140:143], a[84:87], v[116:119]
s_cselect_b32 s51, s42, s51
v_cvt_pk_bf16_f32 v246, v255, v254
v_accvgpr_write_b32 a179, v246
v_mfma_f32_16x16x32_bf16 v[124:127], a[136:139], a[88:91], v[124:127]
s_cselect_b64 s[16:17], s[40:41], s[16:17]
ds_read_b64_tr_b16 a[134:135], v8 offset:51200
v_lshlrev_b32 v28, 16, v250
v_mfma_f32_16x16x32_bf16 v[124:127], a[140:143], a[92:95], v[124:127]
s_cselect_b32 s18, s42, s18
v_and_b32 v29, s58, v250
v_lshlrev_b32 v30, 16, v251
v_mfma_f32_16x16x32_bf16 v[132:135], a[136:139], a[96:99], v[132:135]
s_cselect_b64 s[40:41], s[44:45], s[40:41]
ds_read_b128 a[32:35], v2 offset:8192
v_and_b32 v253, s58, v251
v_mfma_f32_16x16x32_bf16 v[132:135], a[140:143], a[100:103], v[132:135]
s_cselect_b32 s42, s46, s42
v_and_b32 v22, s58, v224
v_and_b32 v23, s58, v225
v_mfma_f32_16x16x32_bf16 v[140:143], a[136:139], a[104:107], v[140:143]
s_cselect_b32 s46, 0, s46
v_and_b32 v24, s58, v226
v_mul_f32 v254, v22, v253
v_mfma_f32_16x16x32_bf16 v[140:143], a[140:143], a[108:111], v[140:143]
buffer_load_dword v245, off, s[60:63], s54 sc1
v_mfma_f32_16x16x32_bf16 v[148:151], a[136:139], a[112:115], v[148:151]
ds_read_b128 a[36:39], v3 offset:8192
v_and_b32 v25, s58, v227
v_and_b32 v247, s58, v236
v_mfma_f32_16x16x32_bf16 v[148:151], a[140:143], a[116:119], v[148:151]
v_fmac_f32 v254, v23, v30
v_fmac_f32 v254, v24, v29
v_mfma_f32_16x16x32_bf16 v[156:159], a[136:139], a[120:123], v[156:159]
ds_read_b128 a[40:43], v2 offset:10240
v_fmac_f32 v254, v25, v28
v_mfma_f32_16x16x32_bf16 v[156:159], a[140:143], a[124:127], v[156:159]
s_waitcnt lgkmcnt(3)
v_mul_f32 v254, v254, v247
v_mul_f32 v255, v23, v253
v_mfma_f32_16x16x32_bf16 v[160:163], a[128:131], a[64:67], v[160:163]
ds_read_b64_tr_b16 a[136:137], v9 offset:32768
v_and_b32 v22, s58, v228
v_mfma_f32_16x16x32_bf16 v[160:163], a[132:135], a[68:71], v[160:163]
v_and_b32 v247, s58, v237
v_fmac_f32 v255, v24, v30
v_mfma_f32_16x16x32_bf16 v[168:171], a[128:131], a[72:75], v[168:171]
ds_read_b64_tr_b16 a[138:139], v9 offset:34816
v_fmac_f32 v255, v25, v29
v_mfma_f32_16x16x32_bf16 v[168:171], a[132:135], a[76:79], v[168:171]
v_fmac_f32 v255, v22, v28
v_mul_f32 v255, v255, v247
v_mfma_f32_16x16x32_bf16 v[176:179], a[128:131], a[80:83], v[176:179]
ds_read_b64_tr_b16 a[140:141], v9 offset:49152
v_cvt_pk_bf16_f32 v246, v254, v255
v_accvgpr_write_b32 a188, v246
v_mfma_f32_16x16x32_bf16 v[176:179], a[132:135], a[84:87], v[176:179]
v_mul_f32 v254, v24, v253
v_and_b32 v23, s58, v229
v_mfma_f32_16x16x32_bf16 v[184:187], a[128:131], a[88:91], v[184:187]
ds_read_b64_tr_b16 a[142:143], v9 offset:51200
v_and_b32 v247, s58, v238
v_mfma_f32_16x16x32_bf16 v[184:187], a[132:135], a[92:95], v[184:187]
v_fmac_f32 v254, v25, v30
v_fmac_f32 v254, v22, v29
v_mfma_f32_16x16x32_bf16 v[192:195], a[128:131], a[96:99], v[192:195]
v_fmac_f32 v254, v23, v28
v_mul_f32 v254, v254, v247
v_mfma_f32_16x16x32_bf16 v[192:195], a[132:135], a[100:103], v[192:195]
v_cvt_pk_bf16_f32 v246, v255, v254
v_accvgpr_write_b32 a184, v246
v_mfma_f32_16x16x32_bf16 v[200:203], a[128:131], a[104:107], v[200:203]
ds_read_b128 a[44:47], v3 offset:10240
v_mul_f32 v255, v25, v253
v_mfma_f32_16x16x32_bf16 v[200:203], a[132:135], a[108:111], v[200:203]
v_and_b32 v24, s58, v230
v_and_b32 v247, s58, v239
v_fmac_f32 v255, v22, v30
v_mfma_f32_16x16x32_bf16 v[208:211], a[128:131], a[112:115], v[208:211]
ds_read_b128 a[48:51], v2 offset:12288
v_fmac_f32 v255, v23, v29
v_mfma_f32_16x16x32_bf16 v[208:211], a[132:135], a[116:119], v[208:211]
v_fmac_f32 v255, v24, v28
v_mul_f32 v255, v255, v247
v_mfma_f32_16x16x32_bf16 v[216:219], a[128:131], a[120:123], v[216:219]
v_cvt_pk_bf16_f32 v246, v254, v255
v_accvgpr_write_b32 a189, v246
v_mfma_f32_16x16x32_bf16 v[216:219], a[132:135], a[124:127], v[216:219]
s_waitcnt lgkmcnt(2)
v_mul_f32 v254, v22, v253
v_and_b32 v25, s58, v231
v_mfma_f32_16x16x32_bf16 v[164:167], a[136:139], a[64:67], v[164:167]
ds_read_b64_tr_b16 a[128:129], v10 offset:32768
v_and_b32 v247, s58, v240
v_mfma_f32_16x16x32_bf16 v[164:167], a[140:143], a[68:71], v[164:167]
v_fmac_f32 v254, v23, v30
v_fmac_f32 v254, v24, v29
v_mfma_f32_16x16x32_bf16 v[172:175], a[136:139], a[72:75], v[172:175]
ds_read_b64_tr_b16 a[130:131], v10 offset:34816
v_fmac_f32 v254, v25, v28
v_mfma_f32_16x16x32_bf16 v[172:175], a[140:143], a[76:79], v[172:175]
v_mul_f32 v254, v254, v247
v_cvt_pk_bf16_f32 v246, v255, v254
v_accvgpr_write_b32 a185, v246
v_mfma_f32_16x16x32_bf16 v[180:183], a[136:139], a[80:83], v[180:183]
s_lshr_b32 s22, s3, 1
ds_read_b64_tr_b16 a[132:133], v10 offset:49152
v_mul_f32 v255, v23, v253
v_mfma_f32_16x16x32_bf16 v[180:183], a[140:143], a[84:87], v[180:183]
s_mul_i32 s22, s22, 2097152
v_and_b32 v22, s58, v232
v_and_b32 v247, s58, v241
v_mfma_f32_16x16x32_bf16 v[188:191], a[136:139], a[88:91], v[188:191]
s_and_b32 s23, s3, 1
ds_read_b64_tr_b16 a[134:135], v10 offset:51200
v_fmac_f32 v255, v24, v30
v_mfma_f32_16x16x32_bf16 v[188:191], a[140:143], a[92:95], v[188:191]
s_lshl_b32 s23, s23, 5
v_fmac_f32 v255, v25, v29
v_fmac_f32 v255, v22, v28
v_mfma_f32_16x16x32_bf16 v[196:199], a[136:139], a[96:99], v[196:199]
s_lshl_b32 s56, s39, 6
ds_read_b128 a[52:55], v3 offset:12288
v_mul_f32 v255, v255, v247
v_mfma_f32_16x16x32_bf16 v[196:199], a[140:143], a[100:103], v[196:199]
s_add_u32 s23, s23, s56
v_cvt_pk_bf16_f32 v246, v254, v255
v_accvgpr_write_b32 a190, v246
v_mfma_f32_16x16x32_bf16 v[204:207], a[136:139], a[104:107], v[204:207]
s_mul_i32 s23, s23, 4224
ds_read_b128 a[56:59], v2 offset:14336
v_mul_f32 v254, v24, v253
v_and_b32 v23, s58, v233
v_mfma_f32_16x16x32_bf16 v[204:207], a[140:143], a[108:111], v[204:207]
s_add_u32 s22, s22, s23
v_and_b32 v247, s58, v242
v_fmac_f32 v254, v25, v30
v_mfma_f32_16x16x32_bf16 v[212:215], a[136:139], a[112:115], v[212:215]
s_add_u32 s57, s22, 83886200
v_fmac_f32 v254, v22, v29
v_fmac_f32 v254, v23, v28
v_mfma_f32_16x16x32_bf16 v[212:215], a[140:143], a[116:119], v[212:215]
s_lshl_b32 s23, s38, 7
v_mul_f32 v254, v254, v247
v_cvt_pk_bf16_f32 v246, v255, v254
v_mfma_f32_16x16x32_bf16 v[220:223], a[136:139], a[120:123], v[220:223]
s_add_u32 s22, s22, s23
ds_read_b128 a[60:63], v3 offset:14336
v_accvgpr_write_b32 a186, v246
v_mfma_f32_16x16x32_bf16 v[220:223], a[140:143], a[124:127], v[220:223]
s_waitcnt lgkmcnt(3)
s_add_u32 s56, s22, 83886208
v_mul_f32 v255, v25, v253
v_and_b32 v24, s58, v234
v_mfma_f32_16x16x32_bf16 a[192:195], a[128:131], a[64:67], a[192:195]
s_cmp_lt_u32 s2, 224
ds_read_b64_tr_b16 a[136:137], v11 offset:32768
v_and_b32 v247, s58, v243
v_mfma_f32_16x16x32_bf16 a[192:195], a[132:135], a[68:71], a[192:195]
s_cselect_b32 s56, s56, 3221225472
v_fmac_f32 v255, v22, v30
v_fmac_f32 v255, v23, v29
v_mfma_f32_16x16x32_bf16 a[200:203], a[128:131], a[72:75], a[200:203]
s_cmp_eq_u32 s38, 0
ds_read_b64_tr_b16 a[138:139], v11 offset:34816
v_fmac_f32 v255, v24, v28
v_mul_f32 v255, v255, v247
v_mfma_f32_16x16x32_bf16 a[200:203], a[132:135], a[76:79], a[200:203]
s_cselect_b32 s57, s57, 3221225472
v_cvt_pk_bf16_f32 v246, v254, v255
v_accvgpr_write_b32 a191, v246
v_mfma_f32_16x16x32_bf16 a[208:211], a[128:131], a[80:83], a[208:211]
ds_read_b64_tr_b16 a[140:141], v11 offset:49152
v_mul_f32 v254, v22, v253
v_mfma_f32_16x16x32_bf16 a[208:211], a[132:135], a[84:87], a[208:211]
v_and_b32 v25, s58, v235
v_and_b32 v247, s58, v244
v_mfma_f32_16x16x32_bf16 a[216:219], a[128:131], a[88:91], a[216:219]
ds_read_b64_tr_b16 a[142:143], v11 offset:51200
v_fmac_f32 v254, v23, v30
v_mfma_f32_16x16x32_bf16 a[216:219], a[132:135], a[92:95], a[216:219]
ds_write_b128 v252, a[176:179] offset:0
v_fmac_f32 v254, v24, v29
v_mfma_f32_16x16x32_bf16 a[224:227], a[128:131], a[96:99], a[224:227]
v_fmac_f32 v254, v25, v28
v_mul_f32 v254, v254, v247
v_mfma_f32_16x16x32_bf16 a[224:227], a[132:135], a[100:103], a[224:227]
ds_write_b128 v252, a[180:183] offset:8192
v_cvt_pk_bf16_f32 v246, v255, v254
v_accvgpr_write_b32 a187, v246
v_mfma_f32_16x16x32_bf16 a[232:235], a[128:131], a[104:107], a[232:235]
v_mfma_f32_16x16x32_bf16 a[232:235], a[132:135], a[108:111], a[232:235]
ds_write_b128 v252, a[184:187] offset:128
v_mfma_f32_16x16x32_bf16 a[240:243], a[128:131], a[112:115], a[240:243]
v_mfma_f32_16x16x32_bf16 a[240:243], a[132:135], a[116:119], a[240:243]
ds_write_b128 v252, a[188:191] offset:8320
v_mfma_f32_16x16x32_bf16 a[248:251], a[128:131], a[120:123], a[248:251]
s_waitcnt vmcnt(2) lgkmcnt(0)
v_mfma_f32_16x16x32_bf16 a[248:251], a[132:135], a[124:127], a[248:251]
s_barrier
v_mfma_f32_16x16x32_bf16 a[196:199], a[136:139], a[64:67], a[196:199]
s_add_u32 m0, s29, 98304
ds_read_b64_tr_b16 a[128:129], v4 offset:0
v_lshrrev_b32 v22, 8, v1
v_mfma_f32_16x16x32_bf16 a[196:199], a[140:143], a[68:71], a[196:199]
buffer_load_dwordx4 v16, s[12:15], s26 offen offset:0 lds
v_mfma_f32_16x16x32_bf16 a[204:207], a[136:139], a[72:75], a[204:207]
ds_read_b64_tr_b16 a[130:131], v4 offset:2048
v_lshlrev_b32 v22, 4, v22
v_mfma_f32_16x16x32_bf16 a[204:207], a[140:143], a[76:79], a[204:207]
v_xor_b32 v22, v22, v1
v_add_u32 v22, s29, v22
v_mfma_f32_16x16x32_bf16 a[212:215], a[136:139], a[80:83], a[212:215]
ds_read_b64_tr_b16 a[132:133], v4 offset:16384
v_add_u32 v22, 147456, v22
v_mfma_f32_16x16x32_bf16 a[212:215], a[140:143], a[84:87], a[212:215]
buffer_load_dwordx4 v17, s[12:15], s26 offen offset:1024 lds
v_mfma_f32_16x16x32_bf16 a[220:223], a[136:139], a[88:91], a[220:223]
ds_read_b64_tr_b16 a[134:135], v4 offset:18432
v_xor_b32 v23, 64, v22
v_mfma_f32_16x16x32_bf16 a[220:223], a[140:143], a[92:95], a[220:223]
v_lshrrev_b32 v224, 7, v1
v_mul_u32_u24 v224, 4224, v224
v_mfma_f32_16x16x32_bf16 a[228:231], a[136:139], a[96:99], a[228:231]
v_and_b32 v225, 0x70, v1
v_add_u32 v224, v224, v225
v_mfma_f32_16x16x32_bf16 a[228:231], a[140:143], a[100:103], a[228:231]
buffer_load_dwordx4 v18, s[12:15], s26 offen offset:2048 lds
v_mfma_f32_16x16x32_bf16 a[236:239], a[136:139], a[104:107], a[236:239]
v_bfe_u32 v225, v1, 4, 5
v_mul_u32_u24 v225, 4224, v225
v_mfma_f32_16x16x32_bf16 a[236:239], a[140:143], a[108:111], a[236:239]
v_mov_b32 v226, 0
v_mov_b32 v227, 0
v_mfma_f32_16x16x32_bf16 a[244:247], a[136:139], a[112:115], a[244:247]
v_mfma_f32_16x16x32_bf16 a[244:247], a[140:143], a[116:119], a[244:247]
buffer_load_dwordx4 v19, s[12:15], s26 offen offset:3072 lds
v_mfma_f32_16x16x32_bf16 a[252:255], a[136:139], a[120:123], a[252:255]
s_add_u32 s26, s26, 524288
v_mfma_f32_16x16x32_bf16 a[252:255], a[140:143], a[124:127], a[252:255]
s_waitcnt lgkmcnt(0)
v_mfma_f32_16x16x32_bf16 v[32:35], a[128:131], a[0:3], v[32:35]
s_add_u32 m0, s29, 114688
ds_read_b64_tr_b16 a[136:137], v5 offset:0
v_mfma_f32_16x16x32_bf16 v[32:35], a[132:135], a[4:7], v[32:35]
buffer_load_dwordx4 v16, s[12:15], s27 offen offset:0 lds
v_mfma_f32_16x16x32_bf16 v[40:43], a[128:131], a[8:11], v[40:43]
s_mul_i32 s52, s20, 7
ds_read_b64_tr_b16 a[138:139], v5 offset:2048
v_mfma_f32_16x16x32_bf16 v[40:43], a[132:135], a[12:15], v[40:43]
s_add_u32 s52, s52, s21
buffer_store_dwordx2 v[226:227], v225, s[4:7], s57 offen sc1
v_mfma_f32_16x16x32_bf16 v[48:51], a[128:131], a[16:19], v[48:51]
s_lshl_b32 s53, s52, 2
ds_read_b64_tr_b16 a[140:141], v5 offset:16384
v_mfma_f32_16x16x32_bf16 v[48:51], a[132:135], a[20:23], v[48:51]
s_add_u32 s53, s53, s3
buffer_load_dwordx4 v17, s[12:15], s27 offen offset:1024 lds
v_mfma_f32_16x16x32_bf16 v[56:59], a[128:131], a[24:27], v[56:59]
s_lshl_b32 s49, s53, 12
ds_read_b64_tr_b16 a[142:143], v5 offset:18432
v_mfma_f32_16x16x32_bf16 v[56:59], a[132:135], a[28:31], v[56:59]
s_mul_i32 s53, s53, 4224
v_mfma_f32_16x16x32_bf16 v[64:67], a[128:131], a[32:35], v[64:67]
s_add_u32 s53, s53, 83886080
ds_read_b128 a[64:67], v2 offset:32768
v_mfma_f32_16x16x32_bf16 v[64:67], a[132:135], a[36:39], v[64:67]
s_lshr_b32 s52, s52, 4
buffer_load_dwordx4 v18, s[12:15], s27 offen offset:2048 lds
v_mfma_f32_16x16x32_bf16 v[72:75], a[128:131], a[40:43], v[72:75]
s_min_u32 s52, s52, 6
ds_read_b128 a[68:71], v3 offset:32768
v_mfma_f32_16x16x32_bf16 v[72:75], a[132:135], a[44:47], v[72:75]
s_lshl_b32 s52, s52, 7
ds_read_b128 a[176:179], v22 offset:0
v_mfma_f32_16x16x32_bf16 v[80:83], a[128:131], a[48:51], v[80:83]
s_add_u32 s52, s52, 94392320
ds_read_b128 a[180:183], v23 offset:1024
v_mfma_f32_16x16x32_bf16 v[80:83], a[132:135], a[52:55], v[80:83]
buffer_load_dwordx4 v19, s[12:15], s27 offen offset:3072 lds
v_mfma_f32_16x16x32_bf16 v[88:91], a[128:131], a[56:59], v[88:91]
s_add_u32 s27, s27, 524288
ds_read_b128 a[72:75], v2 offset:34816
v_mfma_f32_16x16x32_bf16 v[88:91], a[132:135], a[60:63], v[88:91]
PAD_3:
s_cbranch_execz M_tret
s_waitcnt lgkmcnt(5)
ds_read_b128 a[184:187], v22 offset:2048
v_mfma_f32_16x16x32_bf16 v[36:39], a[136:139], a[0:3], v[36:39]
s_add_u32 m0, s28, 0
ds_read_b64_tr_b16 a[128:129], v6 offset:0
v_mfma_f32_16x16x32_bf16 v[36:39], a[140:143], a[4:7], v[36:39]
buffer_load_dwordx4 v12, s[8:11], s24 offen offset:0 lds
v_mfma_f32_16x16x32_bf16 v[44:47], a[136:139], a[8:11], v[44:47]
ds_read_b64_tr_b16 a[130:131], v6 offset:2048
v_mfma_f32_16x16x32_bf16 v[44:47], a[140:143], a[12:15], v[44:47]
ds_read_b128 a[188:191], v23 offset:3072
v_mfma_f32_16x16x32_bf16 v[52:55], a[136:139], a[16:19], v[52:55]
ds_read_b64_tr_b16 a[132:133], v6 offset:16384
v_bfe_u32 v231, v1, 4, 5
v_mfma_f32_16x16x32_bf16 v[52:55], a[140:143], a[20:23], v[52:55]
buffer_load_dwordx4 v13, s[8:11], s24 offen offset:1024 lds
v_mfma_f32_16x16x32_bf16 v[60:63], a[136:139], a[24:27], v[60:63]
ds_read_b64_tr_b16 a[134:135], v6 offset:18432
v_lshlrev_b32 v231, 2, v231
v_mfma_f32_16x16x32_bf16 v[60:63], a[140:143], a[28:31], v[60:63]
v_lshlrev_b32 v229, 3, v1
v_min_u32 v229, 4096, v229
v_mfma_f32_16x16x32_bf16 v[68:71], a[136:139], a[32:35], v[68:71]
ds_read_b128 a[76:79], v3 offset:34816
v_mfma_f32_16x16x32_bf16 v[68:71], a[140:143], a[36:39], v[68:71]
buffer_load_dwordx4 v14, s[8:11], s24 offen offset:2048 lds
v_mfma_f32_16x16x32_bf16 v[76:79], a[136:139], a[40:43], v[76:79]
v_mfma_f32_16x16x32_bf16 v[76:79], a[140:143], a[44:47], v[76:79]
v_mfma_f32_16x16x32_bf16 v[84:87], a[136:139], a[48:51], v[84:87]
ds_read_b128 a[80:83], v2 offset:36864
v_mfma_f32_16x16x32_bf16 v[84:87], a[140:143], a[52:55], v[84:87]
buffer_load_dwordx4 v15, s[8:11], s24 offen offset:3072 lds
v_mfma_f32_16x16x32_bf16 v[92:95], a[136:139], a[56:59], v[92:95]
s_add_u32 s24, s24, 128
ds_read_b128 a[84:87], v3 offset:36864
v_mfma_f32_16x16x32_bf16 v[92:95], a[140:143], a[60:63], v[92:95]
s_waitcnt lgkmcnt(3)
v_mfma_f32_16x16x32_bf16 v[96:99], a[128:131], a[0:3], v[96:99]
s_add_u32 m0, s28, 4096
ds_read_b64_tr_b16 a[136:137], v7 offset:0
v_mfma_f32_16x16x32_bf16 v[96:99], a[132:135], a[4:7], v[96:99]
buffer_load_dwordx4 v12, s[8:11], s25 offen offset:0 lds
v_mfma_f32_16x16x32_bf16 v[104:107], a[128:131], a[8:11], v[104:107]
ds_read_b64_tr_b16 a[138:139], v7 offset:2048
v_mfma_f32_16x16x32_bf16 v[104:107], a[132:135], a[12:15], v[104:107]
v_mfma_f32_16x16x32_bf16 v[112:115], a[128:131], a[16:19], v[112:115]
ds_read_b64_tr_b16 a[140:141], v7 offset:16384
v_mfma_f32_16x16x32_bf16 v[112:115], a[132:135], a[20:23], v[112:115]
buffer_load_dwordx4 v13, s[8:11], s25 offen offset:1024 lds
v_mfma_f32_16x16x32_bf16 v[120:123], a[128:131], a[24:27], v[120:123]
ds_read_b64_tr_b16 a[142:143], v7 offset:18432
v_mfma_f32_16x16x32_bf16 v[120:123], a[132:135], a[28:31], v[120:123]
v_mfma_f32_16x16x32_bf16 v[128:131], a[128:131], a[32:35], v[128:131]
v_mfma_f32_16x16x32_bf16 v[128:131], a[132:135], a[36:39], v[128:131]
buffer_load_dwordx4 v14, s[8:11], s25 offen offset:2048 lds
v_mfma_f32_16x16x32_bf16 v[136:139], a[128:131], a[40:43], v[136:139]
ds_read_b128 a[88:91], v2 offset:38912
v_mfma_f32_16x16x32_bf16 v[136:139], a[132:135], a[44:47], v[136:139]
v_mfma_f32_16x16x32_bf16 v[144:147], a[128:131], a[48:51], v[144:147]
ds_read_b128 a[92:95], v3 offset:38912
v_mfma_f32_16x16x32_bf16 v[144:147], a[132:135], a[52:55], v[144:147]
buffer_load_dwordx4 v15, s[8:11], s25 offen offset:3072 lds
v_mfma_f32_16x16x32_bf16 v[152:155], a[128:131], a[56:59], v[152:155]
s_add_u32 s25, s25, 128
v_mfma_f32_16x16x32_bf16 v[152:155], a[132:135], a[60:63], v[152:155]
s_waitcnt lgkmcnt(2)
v_mfma_f32_16x16x32_bf16 v[100:103], a[136:139], a[0:3], v[100:103]
ds_read_b64_tr_b16 a[128:129], v8 offset:0
v_mfma_f32_16x16x32_bf16 v[100:103], a[140:143], a[4:7], v[100:103]
buffer_store_dwordx4 a[176:179], v224, s[4:7], s56 offen sc1
v_mfma_f32_16x16x32_bf16 v[108:111], a[136:139], a[8:11], v[108:111]
s_add_u32 s56, s56, 33792
ds_read_b64_tr_b16 a[130:131], v8 offset:2048
v_mfma_f32_16x16x32_bf16 v[108:111], a[140:143], a[12:15], v[108:111]
v_mfma_f32_16x16x32_bf16 v[116:119], a[136:139], a[16:19], v[116:119]
ds_read_b64_tr_b16 a[132:133], v8 offset:16384
v_mfma_f32_16x16x32_bf16 v[116:119], a[140:143], a[20:23], v[116:119]
v_mfma_f32_16x16x32_bf16 v[124:127], a[136:139], a[24:27], v[124:127]
s_cmp_lt_u32 s21, 0
ds_read_b64_tr_b16 a[134:135], v8 offset:18432
v_mfma_f32_16x16x32_bf16 v[124:127], a[140:143], a[28:31], v[124:127]
s_cselect_b32 s53, s53, 3221225472
v_mfma_f32_16x16x32_bf16 v[132:135], a[136:139], a[32:35], v[132:135]
s_cselect_b32 s49, s49, 3221225472
ds_read_b128 a[96:99], v2 offset:40960
v_mfma_f32_16x16x32_bf16 v[132:135], a[140:143], a[36:39], v[132:135]
s_add_u32 s48, s53, 2097152
v_mfma_f32_16x16x32_bf16 v[140:143], a[136:139], a[40:43], v[140:143]
v_mfma_f32_16x16x32_bf16 v[140:143], a[140:143], a[44:47], v[140:143]
v_mfma_f32_16x16x32_bf16 v[148:151], a[136:139], a[48:51], v[148:151]
ds_read_b128 a[100:103], v3 offset:40960
v_mfma_f32_16x16x32_bf16 v[148:151], a[140:143], a[52:55], v[148:151]
v_mfma_f32_16x16x32_bf16 v[156:159], a[136:139], a[56:59], v[156:159]
ds_read_b128 a[104:107], v2 offset:43008
v_mfma_f32_16x16x32_bf16 v[156:159], a[140:143], a[60:63], v[156:159]
s_waitcnt lgkmcnt(3)
v_mfma_f32_16x16x32_bf16 v[160:163], a[128:131], a[0:3], v[160:163]
ds_read_b64_tr_b16 a[136:137], v9 offset:0
v_mfma_f32_16x16x32_bf16 v[160:163], a[132:135], a[4:7], v[160:163]
v_mfma_f32_16x16x32_bf16 v[168:171], a[128:131], a[8:11], v[168:171]
ds_read_b64_tr_b16 a[138:139], v9 offset:2048
v_mfma_f32_16x16x32_bf16 v[168:171], a[132:135], a[12:15], v[168:171]
buffer_store_dwordx4 a[180:183], v224, s[4:7], s56 offen sc1
v_mfma_f32_16x16x32_bf16 v[176:179], a[128:131], a[16:19], v[176:179]
s_add_u32 s56, s56, 33792
ds_read_b64_tr_b16 a[140:141], v9 offset:16384
v_mfma_f32_16x16x32_bf16 v[176:179], a[132:135], a[20:23], v[176:179]
v_mfma_f32_16x16x32_bf16 v[184:187], a[128:131], a[24:27], v[184:187]
ds_read_b64_tr_b16 a[142:143], v9 offset:18432
v_mfma_f32_16x16x32_bf16 v[184:187], a[132:135], a[28:31], v[184:187]
v_mfma_f32_16x16x32_bf16 v[192:195], a[128:131], a[32:35], v[192:195]
v_mfma_f32_16x16x32_bf16 v[192:195], a[132:135], a[36:39], v[192:195]
v_mfma_f32_16x16x32_bf16 v[200:203], a[128:131], a[40:43], v[200:203]
ds_read_b128 a[108:111], v3 offset:43008
v_mfma_f32_16x16x32_bf16 v[200:203], a[132:135], a[44:47], v[200:203]
v_mfma_f32_16x16x32_bf16 v[208:211], a[128:131], a[48:51], v[208:211]
ds_read_b128 a[112:115], v2 offset:45056
v_mfma_f32_16x16x32_bf16 v[208:211], a[132:135], a[52:55], v[208:211]
v_mfma_f32_16x16x32_bf16 v[216:219], a[128:131], a[56:59], v[216:219]
v_mfma_f32_16x16x32_bf16 v[216:219], a[132:135], a[60:63], v[216:219]
s_waitcnt lgkmcnt(2)
v_mfma_f32_16x16x32_bf16 v[164:167], a[136:139], a[0:3], v[164:167]
ds_read_b64_tr_b16 a[128:129], v10 offset:0
v_mfma_f32_16x16x32_bf16 v[164:167], a[140:143], a[4:7], v[164:167]
v_mfma_f32_16x16x32_bf16 v[172:175], a[136:139], a[8:11], v[172:175]
ds_read_b64_tr_b16 a[130:131], v10 offset:2048
v_mfma_f32_16x16x32_bf16 v[172:175], a[140:143], a[12:15], v[172:175]
v_mfma_f32_16x16x32_bf16 v[180:183], a[136:139], a[16:19], v[180:183]
ds_read_b64_tr_b16 a[132:133], v10 offset:16384
v_mfma_f32_16x16x32_bf16 v[180:183], a[140:143], a[20:23], v[180:183]
buffer_store_dwordx4 a[184:187], v224, s[4:7], s56 offen sc1
v_mfma_f32_16x16x32_bf16 v[188:191], a[136:139], a[24:27], v[188:191]
s_add_u32 s56, s56, 33792
ds_read_b64_tr_b16 a[134:135], v10 offset:18432
v_mfma_f32_16x16x32_bf16 v[188:191], a[140:143], a[28:31], v[188:191]
v_mfma_f32_16x16x32_bf16 v[196:199], a[136:139], a[32:35], v[196:199]
ds_read_b128 a[116:119], v3 offset:45056
v_mfma_f32_16x16x32_bf16 v[196:199], a[140:143], a[36:39], v[196:199]
v_mfma_f32_16x16x32_bf16 v[204:207], a[136:139], a[40:43], v[204:207]
ds_read_b128 a[120:123], v2 offset:47104
v_mfma_f32_16x16x32_bf16 v[204:207], a[140:143], a[44:47], v[204:207]
v_mfma_f32_16x16x32_bf16 v[212:215], a[136:139], a[48:51], v[212:215]
v_mfma_f32_16x16x32_bf16 v[212:215], a[140:143], a[52:55], v[212:215]
v_mfma_f32_16x16x32_bf16 v[220:223], a[136:139], a[56:59], v[220:223]
ds_read_b128 a[124:127], v3 offset:47104
v_mfma_f32_16x16x32_bf16 v[220:223], a[140:143], a[60:63], v[220:223]
s_waitcnt lgkmcnt(3)
v_mfma_f32_16x16x32_bf16 a[192:195], a[128:131], a[0:3], a[192:195]
ds_read_b64_tr_b16 a[136:137], v11 offset:0
v_mfma_f32_16x16x32_bf16 a[192:195], a[132:135], a[4:7], a[192:195]
v_mfma_f32_16x16x32_bf16 a[200:203], a[128:131], a[8:11], a[200:203]
ds_read_b64_tr_b16 a[138:139], v11 offset:2048
v_mfma_f32_16x16x32_bf16 a[200:203], a[132:135], a[12:15], a[200:203]
v_mfma_f32_16x16x32_bf16 a[208:211], a[128:131], a[16:19], a[208:211]
ds_read_b64_tr_b16 a[140:141], v11 offset:16384
v_mfma_f32_16x16x32_bf16 a[208:211], a[132:135], a[20:23], a[208:211]
v_mfma_f32_16x16x32_bf16 a[216:219], a[128:131], a[24:27], a[216:219]
ds_read_b64_tr_b16 a[142:143], v11 offset:18432
v_mfma_f32_16x16x32_bf16 a[216:219], a[132:135], a[28:31], a[216:219]
buffer_store_dwordx4 a[188:191], v224, s[4:7], s56 offen sc1
v_mfma_f32_16x16x32_bf16 a[224:227], a[128:131], a[32:35], a[224:227]
s_add_u32 s56, s56, 33792
v_mfma_f32_16x16x32_bf16 a[224:227], a[132:135], a[36:39], a[224:227]
v_mfma_f32_16x16x32_bf16 a[232:235], a[128:131], a[40:43], a[232:235]
v_mfma_f32_16x16x32_bf16 a[232:235], a[132:135], a[44:47], a[232:235]
v_mfma_f32_16x16x32_bf16 a[240:243], a[128:131], a[48:51], a[240:243]
v_mfma_f32_16x16x32_bf16 a[240:243], a[132:135], a[52:55], a[240:243]
v_mfma_f32_16x16x32_bf16 a[248:251], a[128:131], a[56:59], a[248:251]
s_waitcnt vmcnt(4) lgkmcnt(0)
v_mfma_f32_16x16x32_bf16 a[248:251], a[132:135], a[60:63], a[248:251]
s_barrier
v_mfma_f32_16x16x32_bf16 a[196:199], a[136:139], a[0:3], a[196:199]
s_add_u32 m0, s29, 65536
ds_read_b64_tr_b16 a[128:129], v4 offset:32768
v_mfma_f32_16x16x32_bf16 a[196:199], a[140:143], a[4:7], a[196:199]
buffer_load_dwordx4 v16, s[12:15], s26 offen offset:0 lds
v_mfma_f32_16x16x32_bf16 a[204:207], a[136:139], a[8:11], a[204:207]
ds_read_b64_tr_b16 a[130:131], v4 offset:34816
v_cmp_gt_u32 vcc, s50, v245
v_mfma_f32_16x16x32_bf16 a[204:207], a[140:143], a[12:15], a[204:207]
v_mfma_f32_16x16x32_bf16 a[212:215], a[136:139], a[16:19], a[212:215]
ds_read_b64_tr_b16 a[132:133], v4 offset:49152
v_mfma_f32_16x16x32_bf16 a[212:215], a[140:143], a[20:23], a[212:215]
buffer_load_dwordx4 v17, s[12:15], s26 offen offset:1024 lds
v_mfma_f32_16x16x32_bf16 a[220:223], a[136:139], a[24:27], a[220:223]
ds_read_b64_tr_b16 a[134:135], v4 offset:51200
v_mfma_f32_16x16x32_bf16 a[220:223], a[140:143], a[28:31], a[220:223]
v_mfma_f32_16x16x32_bf16 a[228:231], a[136:139], a[32:35], a[228:231]
v_mfma_f32_16x16x32_bf16 a[228:231], a[140:143], a[36:39], a[228:231]
buffer_load_dwordx4 v18, s[12:15], s26 offen offset:2048 lds
v_mfma_f32_16x16x32_bf16 a[236:239], a[136:139], a[40:43], a[236:239]
v_mfma_f32_16x16x32_bf16 a[236:239], a[140:143], a[44:47], a[236:239]
v_mfma_f32_16x16x32_bf16 a[244:247], a[136:139], a[48:51], a[244:247]
v_mfma_f32_16x16x32_bf16 a[244:247], a[140:143], a[52:55], a[244:247]
buffer_load_dwordx4 v19, s[12:15], s26 offen offset:3072 lds
v_mfma_f32_16x16x32_bf16 a[252:255], a[136:139], a[56:59], a[252:255]
s_add_u32 s26, s26, 524288
v_mfma_f32_16x16x32_bf16 a[252:255], a[140:143], a[60:63], a[252:255]
s_waitcnt lgkmcnt(0)
s_mov_b32 s82, s59
s_cbranch_vccnz M_cntspinK
s_branch Lg_1
PAD_4:
s_cbranch_execz M_tret
Lg_1t:
v_mfma_f32_16x16x32_bf16 v[32:35], a[128:131], a[64:67], v[32:35]
s_add_u32 m0, s29, 81920
ds_read_b64_tr_b16 a[136:137], v5 offset:32768
v_mfma_f32_16x16x32_bf16 v[32:35], a[132:135], a[68:71], v[32:35]
buffer_load_dwordx4 v16, s[12:15], s27 offen offset:0 lds
v_mfma_f32_16x16x32_bf16 v[40:43], a[128:131], a[72:75], v[40:43]
s_and_b32 s44, s3, 1
ds_read_b64_tr_b16 a[138:139], v5 offset:34816
v_mfma_f32_16x16x32_bf16 v[40:43], a[132:135], a[76:79], v[40:43]
s_lshl_b32 s44, s44, 8
v_mfma_f32_16x16x32_bf16 v[48:51], a[128:131], a[80:83], v[48:51]
s_lshl_b32 s45, s3, 7
ds_read_b64_tr_b16 a[140:141], v5 offset:49152
v_mfma_f32_16x16x32_bf16 v[48:51], a[132:135], a[84:87], v[48:51]
s_xor_b32 s44, s44, s45
buffer_load_dwordx4 v17, s[12:15], s27 offen offset:1024 lds
v_mfma_f32_16x16x32_bf16 v[56:59], a[128:131], a[88:91], v[56:59]
s_xor_b32 s44, s44, 196608
ds_read_b64_tr_b16 a[142:143], v5 offset:51200
v_mfma_f32_16x16x32_bf16 v[56:59], a[132:135], a[92:95], v[56:59]
v_mfma_f32_16x16x32_bf16 v[64:67], a[128:131], a[96:99], v[64:67]
ds_read_b128 a[0:3], v2 offset:0
v_mfma_f32_16x16x32_bf16 v[64:67], a[132:135], a[100:103], v[64:67]
buffer_load_dwordx4 v18, s[12:15], s27 offen offset:2048 lds
v_mfma_f32_16x16x32_bf16 v[72:75], a[128:131], a[104:107], v[72:75]
ds_read_b128 a[4:7], v3 offset:0
v_mfma_f32_16x16x32_bf16 v[72:75], a[132:135], a[108:111], v[72:75]
v_mfma_f32_16x16x32_bf16 v[80:83], a[128:131], a[112:115], v[80:83]
v_mfma_f32_16x16x32_bf16 v[80:83], a[132:135], a[116:119], v[80:83]
buffer_load_dwordx4 v19, s[12:15], s27 offen offset:3072 lds
v_mfma_f32_16x16x32_bf16 v[88:91], a[128:131], a[120:123], v[88:91]
s_add_u32 s27, s27, 524288
ds_read_b128 a[8:11], v2 offset:2048
v_mfma_f32_16x16x32_bf16 v[88:91], a[132:135], a[124:127], v[88:91]
s_waitcnt lgkmcnt(3)
v_mfma_f32_16x16x32_bf16 v[36:39], a[136:139], a[64:67], v[36:39]
s_add_u32 m0, s28, 32768
ds_read_b64_tr_b16 a[128:129], v6 offset:32768
v_mfma_f32_16x16x32_bf16 v[36:39], a[140:143], a[68:71], v[36:39]
buffer_load_dwordx4 v12, s[8:11], s24 offen offset:0 lds
v_mfma_f32_16x16x32_bf16 v[44:47], a[136:139], a[72:75], v[44:47]
ds_read_b64_tr_b16 a[130:131], v6 offset:34816
v_mfma_f32_16x16x32_bf16 v[44:47], a[140:143], a[76:79], v[44:47]
v_mfma_f32_16x16x32_bf16 v[52:55], a[136:139], a[80:83], v[52:55]
s_mov_b64 s[56:57], s[72:73]
ds_read_b64_tr_b16 a[132:133], v6 offset:49152
v_mfma_f32_16x16x32_bf16 v[52:55], a[140:143], a[84:87], v[52:55]
s_mov_b32 s58, 1835008
buffer_load_dwordx4 v13, s[8:11], s24 offen offset:1024 lds
v_mfma_f32_16x16x32_bf16 v[60:63], a[136:139], a[88:91], v[60:63]
s_mov_b32 s59, 0x20000
ds_read_b64_tr_b16 a[134:135], v6 offset:51200
v_mfma_f32_16x16x32_bf16 v[60:63], a[140:143], a[92:95], v[60:63]
v_mfma_f32_16x16x32_bf16 v[68:71], a[136:139], a[96:99], v[68:71]
ds_read_b128 a[12:15], v3 offset:2048
v_mfma_f32_16x16x32_bf16 v[68:71], a[140:143], a[100:103], v[68:71]
buffer_load_dwordx4 v14, s[8:11], s24 offen offset:2048 lds
v_mfma_f32_16x16x32_bf16 v[76:79], a[136:139], a[104:107], v[76:79]
v_mfma_f32_16x16x32_bf16 v[76:79], a[140:143], a[108:111], v[76:79]
v_mfma_f32_16x16x32_bf16 v[84:87], a[136:139], a[112:115], v[84:87]
ds_read_b128 a[16:19], v2 offset:4096
v_mfma_f32_16x16x32_bf16 v[84:87], a[140:143], a[116:119], v[84:87]
buffer_load_dwordx4 v15, s[8:11], s24 offen offset:3072 lds
v_mfma_f32_16x16x32_bf16 v[92:95], a[136:139], a[120:123], v[92:95]
s_add_u32 s24, s24, 128
ds_read_b128 a[20:23], v3 offset:4096
v_mfma_f32_16x16x32_bf16 v[92:95], a[140:143], a[124:127], v[92:95]
s_waitcnt lgkmcnt(3)
v_mfma_f32_16x16x32_bf16 v[96:99], a[128:131], a[64:67], v[96:99]
s_add_u32 m0, s28, 36864
ds_read_b64_tr_b16 a[136:137], v7 offset:32768
v_mfma_f32_16x16x32_bf16 v[96:99], a[132:135], a[68:71], v[96:99]
buffer_load_dwordx4 v12, s[8:11], s25 offen offset:0 lds
v_mfma_f32_16x16x32_bf16 v[104:107], a[128:131], a[72:75], v[104:107]
ds_read_b64_tr_b16 a[138:139], v7 offset:34816
v_mfma_f32_16x16x32_bf16 v[104:107], a[132:135], a[76:79], v[104:107]
v_mfma_f32_16x16x32_bf16 v[112:115], a[128:131], a[80:83], v[112:115]
ds_read_b64_tr_b16 a[140:141], v7 offset:49152
v_mfma_f32_16x16x32_bf16 v[112:115], a[132:135], a[84:87], v[112:115]
buffer_load_dwordx4 v13, s[8:11], s25 offen offset:1024 lds
v_mfma_f32_16x16x32_bf16 v[120:123], a[128:131], a[88:91], v[120:123]
ds_read_b64_tr_b16 a[142:143], v7 offset:51200
v_mfma_f32_16x16x32_bf16 v[120:123], a[132:135], a[92:95], v[120:123]
v_mfma_f32_16x16x32_bf16 v[128:131], a[128:131], a[96:99], v[128:131]
v_mfma_f32_16x16x32_bf16 v[128:131], a[132:135], a[100:103], v[128:131]
buffer_load_dwordx4 v14, s[8:11], s25 offen offset:2048 lds
v_mfma_f32_16x16x32_bf16 v[136:139], a[128:131], a[104:107], v[136:139]
ds_read_b128 a[24:27], v2 offset:6144
v_mfma_f32_16x16x32_bf16 v[136:139], a[132:135], a[108:111], v[136:139]
v_mfma_f32_16x16x32_bf16 v[144:147], a[128:131], a[112:115], v[144:147]
ds_read_b128 a[28:31], v3 offset:6144
v_mfma_f32_16x16x32_bf16 v[144:147], a[132:135], a[116:119], v[144:147]
buffer_load_dwordx4 v15, s[8:11], s25 offen offset:3072 lds
v_mfma_f32_16x16x32_bf16 v[152:155], a[128:131], a[120:123], v[152:155]
s_add_u32 s25, s25, 128
v_mfma_f32_16x16x32_bf16 v[152:155], a[132:135], a[124:127], v[152:155]
s_waitcnt lgkmcnt(2)
v_mfma_f32_16x16x32_bf16 v[100:103], a[136:139], a[64:67], v[100:103]
ds_read_b64_tr_b16 a[128:129], v8 offset:32768
v_mfma_f32_16x16x32_bf16 v[100:103], a[140:143], a[68:71], v[100:103]
buffer_load_dword v21, v20, s[16:19], s43 offen
v_mfma_f32_16x16x32_bf16 v[108:111], a[136:139], a[72:75], v[108:111]
s_mov_b64 s[8:9], s[76:77]
ds_read_b64_tr_b16 a[130:131], v8 offset:34816
v_mfma_f32_16x16x32_bf16 v[108:111], a[140:143], a[76:79], v[108:111]
s_mov_b32 s10, 1835008
buffer_load_dword v21, v20, s[16:19], s43 offen offset:256
v_mfma_f32_16x16x32_bf16 v[116:119], a[136:139], a[80:83], v[116:119]
s_lshl_b32 s24, s37, 2
ds_read_b64_tr_b16 a[132:133], v8 offset:49152
v_mfma_f32_16x16x32_bf16 v[116:119], a[140:143], a[84:87], v[116:119]
s_add_u32 s24, s24, s3
v_mfma_f32_16x16x32_bf16 v[124:127], a[136:139], a[88:91], v[124:127]
s_mul_i32 s24, s24, 28672
ds_read_b64_tr_b16 a[134:135], v8 offset:51200
v_mfma_f32_16x16x32_bf16 v[124:127], a[140:143], a[92:95], v[124:127]
s_mov_b32 s28, s29
v_mfma_f32_16x16x32_bf16 v[132:135], a[136:139], a[96:99], v[132:135]
ds_read_b128 a[32:35], v2 offset:8192
v_mfma_f32_16x16x32_bf16 v[132:135], a[140:143], a[100:103], v[132:135]
v_mfma_f32_16x16x32_bf16 v[140:143], a[136:139], a[104:107], v[140:143]
v_mfma_f32_16x16x32_bf16 v[140:143], a[140:143], a[108:111], v[140:143]
v_mfma_f32_16x16x32_bf16 v[148:151], a[136:139], a[112:115], v[148:151]
ds_read_b128 a[36:39], v3 offset:8192
v_lshrrev_b32 v28, 7, v1
v_mfma_f32_16x16x32_bf16 v[148:151], a[140:143], a[116:119], v[148:151]
v_lshrrev_b32 v29, 1, v28
v_lshlrev_b32 v29, 4, v29
v_mfma_f32_16x16x32_bf16 v[156:159], a[136:139], a[120:123], v[156:159]
ds_read_b128 a[40:43], v2 offset:10240
v_and_b32 v30, 0x70, v1
v_mfma_f32_16x16x32_bf16 v[156:159], a[140:143], a[124:127], v[156:159]
s_waitcnt lgkmcnt(3)
v_xor_b32 v29, v29, v30
v_mul_u32_u24 v28, 896, v28
v_mfma_f32_16x16x32_bf16 v[160:163], a[128:131], a[64:67], v[160:163]
ds_read_b64_tr_b16 a[136:137], v9 offset:32768
v_add_u32 v12, v28, v29
v_mfma_f32_16x16x32_bf16 v[160:163], a[132:135], a[68:71], v[160:163]
v_xor_b32 v29, 64, v29
v_add_u32 v28, v28, v29
v_mfma_f32_16x16x32_bf16 v[168:171], a[128:131], a[72:75], v[168:171]
ds_read_b64_tr_b16 a[138:139], v9 offset:34816
v_add_u32 v13, 6144, v28
v_mfma_f32_16x16x32_bf16 v[168:171], a[132:135], a[76:79], v[168:171]
v_add_u32 v14, 12288, v12
v_add_u32 v15, 18432, v28
v_mfma_f32_16x16x32_bf16 v[176:179], a[128:131], a[80:83], v[176:179]
ds_read_b64_tr_b16 a[140:141], v9 offset:49152
v_xor_b32 v22, s44, v4
v_mfma_f32_16x16x32_bf16 v[176:179], a[132:135], a[84:87], v[176:179]
v_xor_b32 v23, 32, v22
v_xor_b32 v24, 64, v22
v_mfma_f32_16x16x32_bf16 v[184:187], a[128:131], a[88:91], v[184:187]
ds_read_b64_tr_b16 a[142:143], v9 offset:51200
v_xor_b32 v25, 96, v22
v_mfma_f32_16x16x32_bf16 v[184:187], a[132:135], a[92:95], v[184:187]
v_mfma_f32_16x16x32_bf16 v[192:195], a[128:131], a[96:99], v[192:195]
v_mfma_f32_16x16x32_bf16 v[192:195], a[132:135], a[100:103], v[192:195]
v_mfma_f32_16x16x32_bf16 v[200:203], a[128:131], a[104:107], v[200:203]
ds_read_b128 a[44:47], v3 offset:10240
v_mfma_f32_16x16x32_bf16 v[200:203], a[132:135], a[108:111], v[200:203]
v_mfma_f32_16x16x32_bf16 v[208:211], a[128:131], a[112:115], v[208:211]
ds_read_b128 a[48:51], v2 offset:12288
v_mfma_f32_16x16x32_bf16 v[208:211], a[132:135], a[116:119], v[208:211]
v_mfma_f32_16x16x32_bf16 v[216:219], a[128:131], a[120:123], v[216:219]
v_mfma_f32_16x16x32_bf16 v[216:219], a[132:135], a[124:127], v[216:219]
s_waitcnt lgkmcnt(2)
v_mfma_f32_16x16x32_bf16 v[164:167], a[136:139], a[64:67], v[164:167]
ds_read_b64_tr_b16 a[128:129], v10 offset:32768
v_mfma_f32_16x16x32_bf16 v[164:167], a[140:143], a[68:71], v[164:167]
v_mfma_f32_16x16x32_bf16 v[172:175], a[136:139], a[72:75], v[172:175]
ds_read_b64_tr_b16 a[130:131], v10 offset:34816
v_mfma_f32_16x16x32_bf16 v[172:175], a[140:143], a[76:79], v[172:175]
v_mfma_f32_16x16x32_bf16 v[180:183], a[136:139], a[80:83], v[180:183]
ds_read_b64_tr_b16 a[132:133], v10 offset:49152
v_mfma_f32_16x16x32_bf16 v[180:183], a[140:143], a[84:87], v[180:183]
v_mfma_f32_16x16x32_bf16 v[188:191], a[136:139], a[88:91], v[188:191]
ds_read_b64_tr_b16 a[134:135], v10 offset:51200
v_mfma_f32_16x16x32_bf16 v[188:191], a[140:143], a[92:95], v[188:191]
v_mfma_f32_16x16x32_bf16 v[196:199], a[136:139], a[96:99], v[196:199]
ds_read_b128 a[52:55], v3 offset:12288
v_mfma_f32_16x16x32_bf16 v[196:199], a[140:143], a[100:103], v[196:199]
v_mfma_f32_16x16x32_bf16 v[204:207], a[136:139], a[104:107], v[204:207]
ds_read_b128 a[56:59], v2 offset:14336
v_mfma_f32_16x16x32_bf16 v[204:207], a[140:143], a[108:111], v[204:207]
v_mfma_f32_16x16x32_bf16 v[212:215], a[136:139], a[112:115], v[212:215]
v_mfma_f32_16x16x32_bf16 v[212:215], a[140:143], a[116:119], v[212:215]
v_mfma_f32_16x16x32_bf16 v[220:223], a[136:139], a[120:123], v[220:223]
ds_read_b128 a[60:63], v3 offset:14336
v_mfma_f32_16x16x32_bf16 v[220:223], a[140:143], a[124:127], v[220:223]
s_waitcnt lgkmcnt(3)
v_mfma_f32_16x16x32_bf16 a[192:195], a[128:131], a[64:67], a[192:195]
ds_read_b64_tr_b16 a[136:137], v11 offset:32768
v_mfma_f32_16x16x32_bf16 a[192:195], a[132:135], a[68:71], a[192:195]
v_mfma_f32_16x16x32_bf16 a[200:203], a[128:131], a[72:75], a[200:203]
ds_read_b64_tr_b16 a[138:139], v11 offset:34816
v_mfma_f32_16x16x32_bf16 a[200:203], a[132:135], a[76:79], a[200:203]
v_mfma_f32_16x16x32_bf16 a[208:211], a[128:131], a[80:83], a[208:211]
ds_read_b64_tr_b16 a[140:141], v11 offset:49152
v_mfma_f32_16x16x32_bf16 a[208:211], a[132:135], a[84:87], a[208:211]
v_mfma_f32_16x16x32_bf16 a[216:219], a[128:131], a[88:91], a[216:219]
ds_read_b64_tr_b16 a[142:143], v11 offset:51200
v_mfma_f32_16x16x32_bf16 a[216:219], a[132:135], a[92:95], a[216:219]
v_mfma_f32_16x16x32_bf16 a[224:227], a[128:131], a[96:99], a[224:227]
v_mfma_f32_16x16x32_bf16 a[224:227], a[132:135], a[100:103], a[224:227]
v_mfma_f32_16x16x32_bf16 a[232:235], a[128:131], a[104:107], a[232:235]
v_mfma_f32_16x16x32_bf16 a[232:235], a[132:135], a[108:111], a[232:235]
v_mfma_f32_16x16x32_bf16 a[240:243], a[128:131], a[112:115], a[240:243]
v_mfma_f32_16x16x32_bf16 a[240:243], a[132:135], a[116:119], a[240:243]
v_mfma_f32_16x16x32_bf16 a[248:251], a[128:131], a[120:123], a[248:251]
s_waitcnt vmcnt(2) lgkmcnt(0)
v_mfma_f32_16x16x32_bf16 a[248:251], a[132:135], a[124:127], a[248:251]
s_barrier
v_mfma_f32_16x16x32_bf16 a[196:199], a[136:139], a[64:67], a[196:199]
s_add_u32 m0, s29, 98304
ds_read_b64_tr_b16 a[128:129], v4 offset:0
v_mfma_f32_16x16x32_bf16 a[196:199], a[140:143], a[68:71], a[196:199]
buffer_load_dwordx4 v16, s[12:15], s26 offen offset:0 lds
v_mfma_f32_16x16x32_bf16 a[204:207], a[136:139], a[72:75], a[204:207]
ds_read_b64_tr_b16 a[130:131], v4 offset:2048
v_mfma_f32_16x16x32_bf16 a[204:207], a[140:143], a[76:79], a[204:207]
v_mfma_f32_16x16x32_bf16 a[212:215], a[136:139], a[80:83], a[212:215]
ds_read_b64_tr_b16 a[132:133], v4 offset:16384
v_mfma_f32_16x16x32_bf16 a[212:215], a[140:143], a[84:87], a[212:215]
buffer_load_dwordx4 v17, s[12:15], s26 offen offset:1024 lds
v_mfma_f32_16x16x32_bf16 a[220:223], a[136:139], a[88:91], a[220:223]
ds_read_b64_tr_b16 a[134:135], v4 offset:18432
v_mfma_f32_16x16x32_bf16 a[220:223], a[140:143], a[92:95], a[220:223]
v_mfma_f32_16x16x32_bf16 a[228:231], a[136:139], a[96:99], a[228:231]
v_mfma_f32_16x16x32_bf16 a[228:231], a[140:143], a[100:103], a[228:231]
buffer_load_dwordx4 v18, s[12:15], s26 offen offset:2048 lds
v_mfma_f32_16x16x32_bf16 a[236:239], a[136:139], a[104:107], a[236:239]
v_mfma_f32_16x16x32_bf16 a[236:239], a[140:143], a[108:111], a[236:239]
v_mfma_f32_16x16x32_bf16 a[244:247], a[136:139], a[112:115], a[244:247]
v_mfma_f32_16x16x32_bf16 a[244:247], a[140:143], a[116:119], a[244:247]
buffer_load_dwordx4 v19, s[12:15], s26 offen offset:3072 lds
v_mfma_f32_16x16x32_bf16 a[252:255], a[136:139], a[120:123], a[252:255]
s_add_u32 s26, s26, 524288
v_mfma_f32_16x16x32_bf16 a[252:255], a[140:143], a[124:127], a[252:255]
s_waitcnt lgkmcnt(0)
v_mfma_f32_16x16x32_bf16 v[32:35], a[128:131], a[0:3], v[32:35]
s_add_u32 m0, s29, 114688
ds_read_b64_tr_b16 a[136:137], v5 offset:0
v_mfma_f32_16x16x32_bf16 v[32:35], a[132:135], a[4:7], v[32:35]
buffer_load_dwordx4 v16, s[12:15], s27 offen offset:0 lds
v_mfma_f32_16x16x32_bf16 v[40:43], a[128:131], a[8:11], v[40:43]
ds_read_b64_tr_b16 a[138:139], v5 offset:2048
v_mfma_f32_16x16x32_bf16 v[40:43], a[132:135], a[12:15], v[40:43]
v_mfma_f32_16x16x32_bf16 v[48:51], a[128:131], a[16:19], v[48:51]
ds_read_b64_tr_b16 a[140:141], v5 offset:16384
v_mfma_f32_16x16x32_bf16 v[48:51], a[132:135], a[20:23], v[48:51]
buffer_load_dwordx4 v17, s[12:15], s27 offen offset:1024 lds
v_mfma_f32_16x16x32_bf16 v[56:59], a[128:131], a[24:27], v[56:59]
ds_read_b64_tr_b16 a[142:143], v5 offset:18432
v_mfma_f32_16x16x32_bf16 v[56:59], a[132:135], a[28:31], v[56:59]
v_mfma_f32_16x16x32_bf16 v[64:67], a[128:131], a[32:35], v[64:67]
ds_read_b128 a[64:67], v2 offset:32768
v_mfma_f32_16x16x32_bf16 v[64:67], a[132:135], a[36:39], v[64:67]
buffer_load_dwordx4 v18, s[12:15], s27 offen offset:2048 lds
v_mfma_f32_16x16x32_bf16 v[72:75], a[128:131], a[40:43], v[72:75]
ds_read_b128 a[68:71], v3 offset:32768
v_mfma_f32_16x16x32_bf16 v[72:75], a[132:135], a[44:47], v[72:75]
v_mfma_f32_16x16x32_bf16 v[80:83], a[128:131], a[48:51], v[80:83]
v_mfma_f32_16x16x32_bf16 v[80:83], a[132:135], a[52:55], v[80:83]
buffer_load_dwordx4 v19, s[12:15], s27 offen offset:3072 lds
v_mfma_f32_16x16x32_bf16 v[88:91], a[128:131], a[56:59], v[88:91]
s_add_u32 s27, s27, 524288
ds_read_b128 a[72:75], v2 offset:34816
v_mfma_f32_16x16x32_bf16 v[88:91], a[132:135], a[60:63], v[88:91]
s_waitcnt lgkmcnt(3)
v_mfma_f32_16x16x32_bf16 v[36:39], a[136:139], a[0:3], v[36:39]
s_add_u32 m0, s28, 0
ds_read_b64_tr_b16 a[128:129], v6 offset:0
v_mfma_f32_16x16x32_bf16 v[36:39], a[140:143], a[4:7], v[36:39]
buffer_load_dwordx4 v12, s[8:11], s24 offen offset:0 lds
v_mfma_f32_16x16x32_bf16 v[44:47], a[136:139], a[8:11], v[44:47]
ds_read_b64_tr_b16 a[130:131], v6 offset:2048
v_mfma_f32_16x16x32_bf16 v[44:47], a[140:143], a[12:15], v[44:47]
v_mfma_f32_16x16x32_bf16 v[52:55], a[136:139], a[16:19], v[52:55]
ds_read_b64_tr_b16 a[132:133], v6 offset:16384
v_mfma_f32_16x16x32_bf16 v[52:55], a[140:143], a[20:23], v[52:55]
buffer_load_dwordx4 v13, s[8:11], s24 offen offset:1024 lds
v_mfma_f32_16x16x32_bf16 v[60:63], a[136:139], a[24:27], v[60:63]
ds_read_b64_tr_b16 a[134:135], v6 offset:18432
v_mfma_f32_16x16x32_bf16 v[60:63], a[140:143], a[28:31], v[60:63]
v_mfma_f32_16x16x32_bf16 v[68:71], a[136:139], a[32:35], v[68:71]
ds_read_b128 a[76:79], v3 offset:34816
v_mfma_f32_16x16x32_bf16 v[68:71], a[140:143], a[36:39], v[68:71]
buffer_load_dwordx4 v14, s[8:11], s24 offen offset:2048 lds
v_mfma_f32_16x16x32_bf16 v[76:79], a[136:139], a[40:43], v[76:79]
v_mfma_f32_16x16x32_bf16 v[76:79], a[140:143], a[44:47], v[76:79]
v_mfma_f32_16x16x32_bf16 v[84:87], a[136:139], a[48:51], v[84:87]
ds_read_b128 a[80:83], v2 offset:36864
v_mfma_f32_16x16x32_bf16 v[84:87], a[140:143], a[52:55], v[84:87]
buffer_load_dwordx4 v15, s[8:11], s24 offen offset:3072 lds
v_mfma_f32_16x16x32_bf16 v[92:95], a[136:139], a[56:59], v[92:95]
s_add_u32 s24, s24, 128
ds_read_b128 a[84:87], v3 offset:36864
v_mfma_f32_16x16x32_bf16 v[92:95], a[140:143], a[60:63], v[92:95]
s_waitcnt lgkmcnt(3)
s_mov_b64 s[12:13], s[80:81]
v_mfma_f32_16x16x32_bf16 v[96:99], a[128:131], a[0:3], v[96:99]
s_mov_b32 s14, 3670016
s_add_u32 m0, s28, 16384
ds_read_b64_tr_b16 a[136:137], v7 offset:0
v_mfma_f32_16x16x32_bf16 v[96:99], a[132:135], a[4:7], v[96:99]
buffer_load_dwordx4 v12, s[8:11], s24 offen offset:0 lds
v_mfma_f32_16x16x32_bf16 v[104:107], a[128:131], a[8:11], v[104:107]
ds_read_b64_tr_b16 a[138:139], v7 offset:2048
v_mfma_f32_16x16x32_bf16 v[104:107], a[132:135], a[12:15], v[104:107]
v_mfma_f32_16x16x32_bf16 v[112:115], a[128:131], a[16:19], v[112:115]
ds_read_b64_tr_b16 a[140:141], v7 offset:16384
v_mfma_f32_16x16x32_bf16 v[112:115], a[132:135], a[20:23], v[112:115]
buffer_load_dwordx4 v13, s[8:11], s24 offen offset:1024 lds
v_mfma_f32_16x16x32_bf16 v[120:123], a[128:131], a[24:27], v[120:123]
ds_read_b64_tr_b16 a[142:143], v7 offset:18432
v_mfma_f32_16x16x32_bf16 v[120:123], a[132:135], a[28:31], v[120:123]
v_mfma_f32_16x16x32_bf16 v[128:131], a[128:131], a[32:35], v[128:131]
v_mfma_f32_16x16x32_bf16 v[128:131], a[132:135], a[36:39], v[128:131]
buffer_load_dwordx4 v14, s[8:11], s24 offen offset:2048 lds
v_mfma_f32_16x16x32_bf16 v[136:139], a[128:131], a[40:43], v[136:139]
ds_read_b128 a[88:91], v2 offset:38912
v_mfma_f32_16x16x32_bf16 v[136:139], a[132:135], a[44:47], v[136:139]
v_mfma_f32_16x16x32_bf16 v[144:147], a[128:131], a[48:51], v[144:147]
ds_read_b128 a[92:95], v3 offset:38912
v_mfma_f32_16x16x32_bf16 v[144:147], a[132:135], a[52:55], v[144:147]
buffer_load_dwordx4 v15, s[8:11], s24 offen offset:3072 lds
v_mfma_f32_16x16x32_bf16 v[152:155], a[128:131], a[56:59], v[152:155]
s_add_u32 s24, s24, 128
v_mfma_f32_16x16x32_bf16 v[152:155], a[132:135], a[60:63], v[152:155]
s_waitcnt lgkmcnt(2)
s_sub_u32 s26, s26, 8388608
v_mfma_f32_16x16x32_bf16 v[100:103], a[136:139], a[0:3], v[100:103]
s_sub_u32 s27, s27, 8388608
s_add_u32 m0, s29, 131072
ds_read_b64_tr_b16 a[128:129], v8 offset:0
v_mfma_f32_16x16x32_bf16 v[100:103], a[140:143], a[4:7], v[100:103]
buffer_load_dwordx4 v16, s[12:15], s26 offen offset:0 lds
v_mfma_f32_16x16x32_bf16 v[108:111], a[136:139], a[8:11], v[108:111]
PAD_5:
s_cbranch_execz M_tret
ds_read_b64_tr_b16 a[130:131], v8 offset:2048
v_mfma_f32_16x16x32_bf16 v[108:111], a[140:143], a[12:15], v[108:111]
v_mfma_f32_16x16x32_bf16 v[116:119], a[136:139], a[16:19], v[116:119]
ds_read_b64_tr_b16 a[132:133], v8 offset:16384
v_mfma_f32_16x16x32_bf16 v[116:119], a[140:143], a[20:23], v[116:119]
buffer_load_dwordx4 v17, s[12:15], s26 offen offset:1024 lds
v_mfma_f32_16x16x32_bf16 v[124:127], a[136:139], a[24:27], v[124:127]
ds_read_b64_tr_b16 a[134:135], v8 offset:18432
v_mfma_f32_16x16x32_bf16 v[124:127], a[140:143], a[28:31], v[124:127]
v_mfma_f32_16x16x32_bf16 v[132:135], a[136:139], a[32:35], v[132:135]
ds_read_b128 a[96:99], v2 offset:40960
v_mfma_f32_16x16x32_bf16 v[132:135], a[140:143], a[36:39], v[132:135]
buffer_load_dwordx4 v18, s[12:15], s26 offen offset:2048 lds
v_mfma_f32_16x16x32_bf16 v[140:143], a[136:139], a[40:43], v[140:143]
v_mfma_f32_16x16x32_bf16 v[140:143], a[140:143], a[44:47], v[140:143]
v_mfma_f32_16x16x32_bf16 v[148:151], a[136:139], a[48:51], v[148:151]
ds_read_b128 a[100:103], v3 offset:40960
v_mfma_f32_16x16x32_bf16 v[148:151], a[140:143], a[52:55], v[148:151]
buffer_load_dwordx4 v19, s[12:15], s26 offen offset:3072 lds
v_mfma_f32_16x16x32_bf16 v[156:159], a[136:139], a[56:59], v[156:159]
s_add_u32 s26, s26, 524288
ds_read_b128 a[104:107], v2 offset:43008
v_mfma_f32_16x16x32_bf16 v[156:159], a[140:143], a[60:63], v[156:159]
s_waitcnt lgkmcnt(3)
v_mfma_f32_16x16x32_bf16 v[160:163], a[128:131], a[0:3], v[160:163]
s_add_u32 m0, s29, 147456
ds_read_b64_tr_b16 a[136:137], v9 offset:0
v_mfma_f32_16x16x32_bf16 v[160:163], a[132:135], a[4:7], v[160:163]
buffer_load_dwordx4 v16, s[12:15], s27 offen offset:0 lds
v_mfma_f32_16x16x32_bf16 v[168:171], a[128:131], a[8:11], v[168:171]
ds_read_b64_tr_b16 a[138:139], v9 offset:2048
v_mfma_f32_16x16x32_bf16 v[168:171], a[132:135], a[12:15], v[168:171]
v_mfma_f32_16x16x32_bf16 v[176:179], a[128:131], a[16:19], v[176:179]
ds_read_b64_tr_b16 a[140:141], v9 offset:16384
v_mfma_f32_16x16x32_bf16 v[176:179], a[132:135], a[20:23], v[176:179]
buffer_load_dwordx4 v17, s[12:15], s27 offen offset:1024 lds
v_mfma_f32_16x16x32_bf16 v[184:187], a[128:131], a[24:27], v[184:187]
ds_read_b64_tr_b16 a[142:143], v9 offset:18432
v_mfma_f32_16x16x32_bf16 v[184:187], a[132:135], a[28:31], v[184:187]
v_mfma_f32_16x16x32_bf16 v[192:195], a[128:131], a[32:35], v[192:195]
v_mfma_f32_16x16x32_bf16 v[192:195], a[132:135], a[36:39], v[192:195]
buffer_load_dwordx4 v18, s[12:15], s27 offen offset:2048 lds
v_mfma_f32_16x16x32_bf16 v[200:203], a[128:131], a[40:43], v[200:203]
ds_read_b128 a[108:111], v3 offset:43008
v_mfma_f32_16x16x32_bf16 v[200:203], a[132:135], a[44:47], v[200:203]
v_mfma_f32_16x16x32_bf16 v[208:211], a[128:131], a[48:51], v[208:211]
ds_read_b128 a[112:115], v2 offset:45056
v_mfma_f32_16x16x32_bf16 v[208:211], a[132:135], a[52:55], v[208:211]
buffer_load_dwordx4 v19, s[12:15], s27 offen offset:3072 lds
v_mfma_f32_16x16x32_bf16 v[216:219], a[128:131], a[56:59], v[216:219]
s_add_u32 s27, s27, 524288
v_mfma_f32_16x16x32_bf16 v[216:219], a[132:135], a[60:63], v[216:219]
s_waitcnt lgkmcnt(2)
v_mfma_f32_16x16x32_bf16 v[164:167], a[136:139], a[0:3], v[164:167]
ds_read_b64_tr_b16 a[128:129], v10 offset:0
v_mfma_f32_16x16x32_bf16 v[164:167], a[140:143], a[4:7], v[164:167]
v_mfma_f32_16x16x32_bf16 v[172:175], a[136:139], a[8:11], v[172:175]
ds_read_b64_tr_b16 a[130:131], v10 offset:2048
v_mfma_f32_16x16x32_bf16 v[172:175], a[140:143], a[12:15], v[172:175]
v_mfma_f32_16x16x32_bf16 v[180:183], a[136:139], a[16:19], v[180:183]
ds_read_b64_tr_b16 a[132:133], v10 offset:16384
v_mfma_f32_16x16x32_bf16 v[180:183], a[140:143], a[20:23], v[180:183]
v_mfma_f32_16x16x32_bf16 v[188:191], a[136:139], a[24:27], v[188:191]
ds_read_b64_tr_b16 a[134:135], v10 offset:18432
v_mfma_f32_16x16x32_bf16 v[188:191], a[140:143], a[28:31], v[188:191]
v_mfma_f32_16x16x32_bf16 v[196:199], a[136:139], a[32:35], v[196:199]
ds_read_b128 a[116:119], v3 offset:45056
v_mfma_f32_16x16x32_bf16 v[196:199], a[140:143], a[36:39], v[196:199]
v_mfma_f32_16x16x32_bf16 v[204:207], a[136:139], a[40:43], v[204:207]
ds_read_b128 a[120:123], v2 offset:47104
v_mfma_f32_16x16x32_bf16 v[204:207], a[140:143], a[44:47], v[204:207]
v_mfma_f32_16x16x32_bf16 v[212:215], a[136:139], a[48:51], v[212:215]
v_mfma_f32_16x16x32_bf16 v[212:215], a[140:143], a[52:55], v[212:215]
v_mfma_f32_16x16x32_bf16 v[220:223], a[136:139], a[56:59], v[220:223]
ds_read_b128 a[124:127], v3 offset:47104
v_mfma_f32_16x16x32_bf16 v[220:223], a[140:143], a[60:63], v[220:223]
s_waitcnt lgkmcnt(3)
v_mfma_f32_16x16x32_bf16 a[192:195], a[128:131], a[0:3], a[192:195]
ds_read_b64_tr_b16 a[136:137], v11 offset:0
v_mfma_f32_16x16x32_bf16 a[192:195], a[132:135], a[4:7], a[192:195]
v_mfma_f32_16x16x32_bf16 a[200:203], a[128:131], a[8:11], a[200:203]
ds_read_b64_tr_b16 a[138:139], v11 offset:2048
v_mfma_f32_16x16x32_bf16 a[200:203], a[132:135], a[12:15], a[200:203]
v_mfma_f32_16x16x32_bf16 a[208:211], a[128:131], a[16:19], a[208:211]
ds_read_b64_tr_b16 a[140:141], v11 offset:16384
v_mfma_f32_16x16x32_bf16 a[208:211], a[132:135], a[20:23], a[208:211]
v_mfma_f32_16x16x32_bf16 a[216:219], a[128:131], a[24:27], a[216:219]
ds_read_b64_tr_b16 a[142:143], v11 offset:18432
v_mfma_f32_16x16x32_bf16 a[216:219], a[132:135], a[28:31], a[216:219]
v_mfma_f32_16x16x32_bf16 a[224:227], a[128:131], a[32:35], a[224:227]
v_mfma_f32_16x16x32_bf16 a[224:227], a[132:135], a[36:39], a[224:227]
v_mfma_f32_16x16x32_bf16 a[232:235], a[128:131], a[40:43], a[232:235]
v_mfma_f32_16x16x32_bf16 a[232:235], a[132:135], a[44:47], a[232:235]
v_mfma_f32_16x16x32_bf16 a[240:243], a[128:131], a[48:51], a[240:243]
v_mfma_f32_16x16x32_bf16 a[240:243], a[132:135], a[52:55], a[240:243]
v_mfma_f32_16x16x32_bf16 a[248:251], a[128:131], a[56:59], a[248:251]
s_waitcnt vmcnt(12) lgkmcnt(0)
v_mfma_f32_16x16x32_bf16 a[248:251], a[132:135], a[60:63], a[248:251]
s_barrier
v_mfma_f32_16x16x32_bf16 a[196:199], a[136:139], a[0:3], a[196:199]
s_add_u32 m0, s28, 32768
ds_read_b64_tr_b16 a[128:129], v4 offset:32768
v_mfma_f32_16x16x32_bf16 a[196:199], a[140:143], a[4:7], a[196:199]
s_lshr_b32 s22, s3, 1
buffer_load_dwordx4 v12, s[8:11], s24 offen offset:0 lds
v_mfma_f32_16x16x32_bf16 a[204:207], a[136:139], a[8:11], a[204:207]
s_lshl_b32 s22, s22, 14
ds_read_b64_tr_b16 a[130:131], v4 offset:34816
v_subrev_u32 v2, s22, v2
v_mfma_f32_16x16x32_bf16 a[204:207], a[140:143], a[12:15], a[204:207]
v_subrev_u32 v3, s22, v3
v_mfma_f32_16x16x32_bf16 a[212:215], a[136:139], a[16:19], a[212:215]
ds_read_b64_tr_b16 a[132:133], v4 offset:49152
v_mfma_f32_16x16x32_bf16 a[212:215], a[140:143], a[20:23], a[212:215]
buffer_load_dwordx4 v13, s[8:11], s24 offen offset:1024 lds
v_mfma_f32_16x16x32_bf16 a[220:223], a[136:139], a[24:27], a[220:223]
ds_read_b64_tr_b16 a[134:135], v4 offset:51200
v_mfma_f32_16x16x32_bf16 a[220:223], a[140:143], a[28:31], a[220:223]
v_mfma_f32_16x16x32_bf16 a[228:231], a[136:139], a[32:35], a[228:231]
v_mfma_f32_16x16x32_bf16 a[228:231], a[140:143], a[36:39], a[228:231]
buffer_load_dwordx4 v14, s[8:11], s24 offen offset:2048 lds
v_mfma_f32_16x16x32_bf16 a[236:239], a[136:139], a[40:43], a[236:239]
v_mfma_f32_16x16x32_bf16 a[236:239], a[140:143], a[44:47], a[236:239]
v_mfma_f32_16x16x32_bf16 a[244:247], a[136:139], a[48:51], a[244:247]
v_mfma_f32_16x16x32_bf16 a[244:247], a[140:143], a[52:55], a[244:247]
buffer_load_dwordx4 v15, s[8:11], s24 offen offset:3072 lds
v_mfma_f32_16x16x32_bf16 a[252:255], a[136:139], a[56:59], a[252:255]
s_add_u32 s24, s24, 128
v_mfma_f32_16x16x32_bf16 a[252:255], a[140:143], a[60:63], a[252:255]
s_waitcnt lgkmcnt(0)
v_mfma_f32_16x16x32_bf16 v[32:35], a[128:131], a[64:67], v[32:35]
s_add_u32 m0, s29, 65536
ds_read_b64_tr_b16 a[136:137], v5 offset:32768
v_mfma_f32_16x16x32_bf16 v[32:35], a[132:135], a[68:71], v[32:35]
buffer_load_dwordx4 v16, s[12:15], s26 offen offset:0 lds
v_mfma_f32_16x16x32_bf16 v[40:43], a[128:131], a[72:75], v[40:43]
ds_read_b64_tr_b16 a[138:139], v5 offset:34816
v_mfma_f32_16x16x32_bf16 v[40:43], a[132:135], a[76:79], v[40:43]
v_mfma_f32_16x16x32_bf16 v[48:51], a[128:131], a[80:83], v[48:51]
ds_read_b64_tr_b16 a[140:141], v5 offset:49152
v_mfma_f32_16x16x32_bf16 v[48:51], a[132:135], a[84:87], v[48:51]
buffer_load_dwordx4 v17, s[12:15], s26 offen offset:1024 lds
v_mfma_f32_16x16x32_bf16 v[56:59], a[128:131], a[88:91], v[56:59]
ds_read_b64_tr_b16 a[142:143], v5 offset:51200
v_mfma_f32_16x16x32_bf16 v[56:59], a[132:135], a[92:95], v[56:59]
v_mfma_f32_16x16x32_bf16 v[64:67], a[128:131], a[96:99], v[64:67]
ds_read_b128 a[0:3], v2 offset:0
v_mfma_f32_16x16x32_bf16 v[64:67], a[132:135], a[100:103], v[64:67]
buffer_load_dwordx4 v18, s[12:15], s26 offen offset:2048 lds
v_mfma_f32_16x16x32_bf16 v[72:75], a[128:131], a[104:107], v[72:75]
ds_read_b128 a[4:7], v3 offset:0
v_mfma_f32_16x16x32_bf16 v[72:75], a[132:135], a[108:111], v[72:75]
v_mfma_f32_16x16x32_bf16 v[80:83], a[128:131], a[112:115], v[80:83]
v_mfma_f32_16x16x32_bf16 v[80:83], a[132:135], a[116:119], v[80:83]
buffer_load_dwordx4 v19, s[12:15], s26 offen offset:3072 lds
v_mfma_f32_16x16x32_bf16 v[88:91], a[128:131], a[120:123], v[88:91]
s_add_u32 s26, s26, 524288
ds_read_b128 a[8:11], v2 offset:2048
v_mfma_f32_16x16x32_bf16 v[88:91], a[132:135], a[124:127], v[88:91]
s_waitcnt lgkmcnt(3)
v_mfma_f32_16x16x32_bf16 v[36:39], a[136:139], a[64:67], v[36:39]
s_add_u32 m0, s29, 81920
ds_read_b64_tr_b16 a[128:129], v6 offset:32768
v_mfma_f32_16x16x32_bf16 v[36:39], a[140:143], a[68:71], v[36:39]
buffer_load_dwordx4 v16, s[12:15], s27 offen offset:0 lds
v_mfma_f32_16x16x32_bf16 v[44:47], a[136:139], a[72:75], v[44:47]
ds_read_b64_tr_b16 a[130:131], v6 offset:34816
v_mfma_f32_16x16x32_bf16 v[44:47], a[140:143], a[76:79], v[44:47]
v_mfma_f32_16x16x32_bf16 v[52:55], a[136:139], a[80:83], v[52:55]
ds_read_b64_tr_b16 a[132:133], v6 offset:49152
v_mfma_f32_16x16x32_bf16 v[52:55], a[140:143], a[84:87], v[52:55]
buffer_load_dwordx4 v17, s[12:15], s27 offen offset:1024 lds
v_mfma_f32_16x16x32_bf16 v[60:63], a[136:139], a[88:91], v[60:63]
ds_read_b64_tr_b16 a[134:135], v6 offset:51200
v_cvt_pk_bf16_f32 v32, v32, v33
v_mfma_f32_16x16x32_bf16 v[60:63], a[140:143], a[92:95], v[60:63]
v_cvt_pk_bf16_f32 v33, v34, v35
v_cvt_pk_bf16_f32 v34, v36, v37
v_mfma_f32_16x16x32_bf16 v[68:71], a[136:139], a[96:99], v[68:71]
ds_read_b128 a[12:15], v3 offset:2048
v_cvt_pk_bf16_f32 v35, v38, v39
v_mfma_f32_16x16x32_bf16 v[68:71], a[140:143], a[100:103], v[68:71]
buffer_load_dwordx4 v18, s[12:15], s27 offen offset:2048 lds
v_mfma_f32_16x16x32_bf16 v[76:79], a[136:139], a[104:107], v[76:79]
v_cvt_pk_bf16_f32 v40, v40, v41
v_cvt_pk_bf16_f32 v41, v42, v43
v_mfma_f32_16x16x32_bf16 v[76:79], a[140:143], a[108:111], v[76:79]
v_cvt_pk_bf16_f32 v42, v44, v45
v_cvt_pk_bf16_f32 v43, v46, v47
v_mfma_f32_16x16x32_bf16 v[84:87], a[136:139], a[112:115], v[84:87]
ds_read_b128 a[16:19], v2 offset:4096
v_cvt_pk_bf16_f32 v48, v48, v49
v_mfma_f32_16x16x32_bf16 v[84:87], a[140:143], a[116:119], v[84:87]
buffer_load_dwordx4 v19, s[12:15], s27 offen offset:3072 lds
v_mfma_f32_16x16x32_bf16 v[92:95], a[136:139], a[120:123], v[92:95]
s_add_u32 s27, s27, 524288
ds_read_b128 a[20:23], v3 offset:4096
v_cvt_pk_bf16_f32 v49, v50, v51
v_mfma_f32_16x16x32_bf16 v[92:95], a[140:143], a[124:127], v[92:95]
s_waitcnt lgkmcnt(3)
v_cvt_pk_bf16_f32 v50, v52, v53
v_cvt_pk_bf16_f32 v51, v54, v55
v_mfma_f32_16x16x32_bf16 v[96:99], a[128:131], a[64:67], v[96:99]
s_add_u32 m0, s28, 49152
ds_read_b64_tr_b16 a[136:137], v7 offset:32768
v_cvt_pk_bf16_f32 v56, v56, v57
v_mfma_f32_16x16x32_bf16 v[96:99], a[132:135], a[68:71], v[96:99]
buffer_load_dwordx4 v12, s[8:11], s24 offen offset:0 lds
v_mfma_f32_16x16x32_bf16 v[104:107], a[128:131], a[72:75], v[104:107]
ds_read_b64_tr_b16 a[138:139], v7 offset:34816
v_cvt_pk_bf16_f32 v57, v58, v59
v_mfma_f32_16x16x32_bf16 v[104:107], a[132:135], a[76:79], v[104:107]
v_cvt_pk_bf16_f32 v58, v60, v61
v_cvt_pk_bf16_f32 v59, v62, v63
v_mfma_f32_16x16x32_bf16 v[112:115], a[128:131], a[80:83], v[112:115]
ds_read_b64_tr_b16 a[140:141], v7 offset:49152
v_cvt_pk_bf16_f32 v64, v64, v65
v_mfma_f32_16x16x32_bf16 v[112:115], a[132:135], a[84:87], v[112:115]
buffer_load_dwordx4 v13, s[8:11], s24 offen offset:1024 lds
v_mfma_f32_16x16x32_bf16 v[120:123], a[128:131], a[88:91], v[120:123]
ds_read_b64_tr_b16 a[142:143], v7 offset:51200
v_cvt_pk_bf16_f32 v65, v66, v67
v_mfma_f32_16x16x32_bf16 v[120:123], a[132:135], a[92:95], v[120:123]
v_cvt_pk_bf16_f32 v66, v68, v69
v_cvt_pk_bf16_f32 v67, v70, v71
v_mfma_f32_16x16x32_bf16 v[128:131], a[128:131], a[96:99], v[128:131]
v_cvt_pk_bf16_f32 v72, v72, v73
v_cvt_pk_bf16_f32 v73, v74, v75
v_mfma_f32_16x16x32_bf16 v[128:131], a[132:135], a[100:103], v[128:131]
buffer_load_dwordx4 v14, s[8:11], s24 offen offset:2048 lds
v_mfma_f32_16x16x32_bf16 v[136:139], a[128:131], a[104:107], v[136:139]
ds_read_b128 a[24:27], v2 offset:6144
v_cvt_pk_bf16_f32 v74, v76, v77
v_mfma_f32_16x16x32_bf16 v[136:139], a[132:135], a[108:111], v[136:139]
buffer_store_dwordx4 v[32:35], v1, s[4:7], s31 offen sc1
v_mfma_f32_16x16x32_bf16 v[144:147], a[128:131], a[112:115], v[144:147]
s_add_u32 s31, s31, s32
ds_read_b128 a[28:31], v3 offset:6144
v_cvt_pk_bf16_f32 v75, v78, v79
v_mfma_f32_16x16x32_bf16 v[144:147], a[132:135], a[116:119], v[144:147]
buffer_load_dwordx4 v15, s[8:11], s24 offen offset:3072 lds
v_mfma_f32_16x16x32_bf16 v[152:155], a[128:131], a[120:123], v[152:155]
s_add_u32 s24, s24, 128
v_cvt_pk_bf16_f32 v80, v80, v81
v_cvt_pk_bf16_f32 v81, v82, v83
v_mfma_f32_16x16x32_bf16 v[152:155], a[132:135], a[124:127], v[152:155]
s_waitcnt lgkmcnt(2)
v_cvt_pk_bf16_f32 v82, v84, v85
v_cvt_pk_bf16_f32 v83, v86, v87
v_mfma_f32_16x16x32_bf16 v[100:103], a[136:139], a[64:67], v[100:103]
ds_read_b64_tr_b16 a[128:129], v8 offset:32768
v_cvt_pk_bf16_f32 v88, v88, v89
v_mfma_f32_16x16x32_bf16 v[100:103], a[140:143], a[68:71], v[100:103]
v_cvt_pk_bf16_f32 v89, v90, v91
v_cvt_pk_bf16_f32 v90, v92, v93
v_mfma_f32_16x16x32_bf16 v[108:111], a[136:139], a[72:75], v[108:111]
ds_read_b64_tr_b16 a[130:131], v8 offset:34816
v_cvt_pk_bf16_f32 v91, v94, v95
v_mfma_f32_16x16x32_bf16 v[108:111], a[140:143], a[76:79], v[108:111]
buffer_store_dwordx4 v[40:43], v1, s[4:7], s31 offen sc1
v_mfma_f32_16x16x32_bf16 v[116:119], a[136:139], a[80:83], v[116:119]
s_add_u32 s31, s31, s33
ds_read_b64_tr_b16 a[132:133], v8 offset:49152
v_mfma_f32_16x16x32_bf16 v[116:119], a[140:143], a[84:87], v[116:119]
v_mfma_f32_16x16x32_bf16 v[124:127], a[136:139], a[88:91], v[124:127]
ds_read_b64_tr_b16 a[134:135], v8 offset:51200
v_cvt_pk_bf16_f32 v96, v96, v97
v_mfma_f32_16x16x32_bf16 v[124:127], a[140:143], a[92:95], v[124:127]
v_cvt_pk_bf16_f32 v97, v98, v99
v_cvt_pk_bf16_f32 v98, v100, v101
v_mfma_f32_16x16x32_bf16 v[132:135], a[136:139], a[96:99], v[132:135]
ds_read_b128 a[32:35], v2 offset:8192
v_cvt_pk_bf16_f32 v99, v102, v103
v_mfma_f32_16x16x32_bf16 v[132:135], a[140:143], a[100:103], v[132:135]
v_cvt_pk_bf16_f32 v104, v104, v105
v_cvt_pk_bf16_f32 v105, v106, v107
v_mfma_f32_16x16x32_bf16 v[140:143], a[136:139], a[104:107], v[140:143]
v_cvt_pk_bf16_f32 v106, v108, v109
v_cvt_pk_bf16_f32 v107, v110, v111
v_mfma_f32_16x16x32_bf16 v[140:143], a[140:143], a[108:111], v[140:143]
v_cvt_pk_bf16_f32 v112, v112, v113
v_cvt_pk_bf16_f32 v113, v114, v115
v_mfma_f32_16x16x32_bf16 v[148:151], a[136:139], a[112:115], v[148:151]
ds_read_b128 a[36:39], v3 offset:8192
v_cvt_pk_bf16_f32 v114, v116, v117
v_mfma_f32_16x16x32_bf16 v[148:151], a[140:143], a[116:119], v[148:151]
v_cvt_pk_bf16_f32 v115, v118, v119
v_cvt_pk_bf16_f32 v120, v120, v121
v_mfma_f32_16x16x32_bf16 v[156:159], a[136:139], a[120:123], v[156:159]
ds_read_b128 a[40:43], v2 offset:10240
v_cvt_pk_bf16_f32 v121, v122, v123
v_mfma_f32_16x16x32_bf16 v[156:159], a[140:143], a[124:127], v[156:159]
s_waitcnt lgkmcnt(3)
buffer_store_dwordx4 v[48:51], v1, s[4:7], s31 offen sc1
v_mfma_f32_16x16x32_bf16 v[160:163], a[128:131], a[64:67], v[160:163]
s_add_u32 s31, s31, s32
ds_read_b64_tr_b16 a[136:137], v9 offset:32768
v_cvt_pk_bf16_f32 v122, v124, v125
v_mfma_f32_16x16x32_bf16 v[160:163], a[132:135], a[68:71], v[160:163]
v_cvt_pk_bf16_f32 v123, v126, v127
v_cvt_pk_bf16_f32 v128, v128, v129
v_mfma_f32_16x16x32_bf16 v[168:171], a[128:131], a[72:75], v[168:171]
ds_read_b64_tr_b16 a[138:139], v9 offset:34816
v_cvt_pk_bf16_f32 v129, v130, v131
v_mfma_f32_16x16x32_bf16 v[168:171], a[132:135], a[76:79], v[168:171]
v_cvt_pk_bf16_f32 v130, v132, v133
v_cvt_pk_bf16_f32 v131, v134, v135
v_mfma_f32_16x16x32_bf16 v[176:179], a[128:131], a[80:83], v[176:179]
ds_read_b64_tr_b16 a[140:141], v9 offset:49152
v_cvt_pk_bf16_f32 v136, v136, v137
v_mfma_f32_16x16x32_bf16 v[176:179], a[132:135], a[84:87], v[176:179]
v_cvt_pk_bf16_f32 v137, v138, v139
v_cvt_pk_bf16_f32 v138, v140, v141
v_mfma_f32_16x16x32_bf16 v[184:187], a[128:131], a[88:91], v[184:187]
ds_read_b64_tr_b16 a[142:143], v9 offset:51200
v_cvt_pk_bf16_f32 v139, v142, v143
v_mfma_f32_16x16x32_bf16 v[184:187], a[132:135], a[92:95], v[184:187]
v_cvt_pk_bf16_f32 v144, v144, v145
v_cvt_pk_bf16_f32 v145, v146, v147
v_mfma_f32_16x16x32_bf16 v[192:195], a[128:131], a[96:99], v[192:195]
buffer_store_dwordx4 v[56:59], v1, s[4:7], s31 offen sc1
v_mfma_f32_16x16x32_bf16 v[192:195], a[132:135], a[100:103], v[192:195]
s_add_u32 s31, s31, s34
v_cvt_pk_bf16_f32 v146, v148, v149
v_cvt_pk_bf16_f32 v147, v150, v151
v_mfma_f32_16x16x32_bf16 v[200:203], a[128:131], a[104:107], v[200:203]
ds_read_b128 a[44:47], v3 offset:10240
v_cvt_pk_bf16_f32 v152, v152, v153
v_mfma_f32_16x16x32_bf16 v[200:203], a[132:135], a[108:111], v[200:203]
v_cvt_pk_bf16_f32 v153, v154, v155
v_cvt_pk_bf16_f32 v154, v156, v157
v_mfma_f32_16x16x32_bf16 v[208:211], a[128:131], a[112:115], v[208:211]
ds_read_b128 a[48:51], v2 offset:12288
v_cvt_pk_bf16_f32 v155, v158, v159
v_mfma_f32_16x16x32_bf16 v[208:211], a[132:135], a[116:119], v[208:211]
v_mfma_f32_16x16x32_bf16 v[216:219], a[128:131], a[120:123], v[216:219]
v_mfma_f32_16x16x32_bf16 v[216:219], a[132:135], a[124:127], v[216:219]
s_waitcnt lgkmcnt(2)
v_mfma_f32_16x16x32_bf16 v[164:167], a[136:139], a[64:67], v[164:167]
ds_read_b64_tr_b16 a[128:129], v10 offset:32768
v_mfma_f32_16x16x32_bf16 v[164:167], a[140:143], a[68:71], v[164:167]
v_mfma_f32_16x16x32_bf16 v[172:175], a[136:139], a[72:75], v[172:175]
ds_read_b64_tr_b16 a[130:131], v10 offset:34816
v_mfma_f32_16x16x32_bf16 v[172:175], a[140:143], a[76:79], v[172:175]
buffer_store_dwordx4 v[64:67], v1, s[4:7], s31 offen sc1
v_mfma_f32_16x16x32_bf16 v[180:183], a[136:139], a[80:83], v[180:183]
s_add_u32 s31, s31, s32
ds_read_b64_tr_b16 a[132:133], v10 offset:49152
v_mfma_f32_16x16x32_bf16 v[180:183], a[140:143], a[84:87], v[180:183]
v_mfma_f32_16x16x32_bf16 v[188:191], a[136:139], a[88:91], v[188:191]
ds_read_b64_tr_b16 a[134:135], v10 offset:51200
v_cvt_pk_bf16_f32 v160, v160, v161
v_mfma_f32_16x16x32_bf16 v[188:191], a[140:143], a[92:95], v[188:191]
v_cvt_pk_bf16_f32 v161, v162, v163
v_cvt_pk_bf16_f32 v162, v164, v165
v_mfma_f32_16x16x32_bf16 v[196:199], a[136:139], a[96:99], v[196:199]
ds_read_b128 a[52:55], v3 offset:12288
v_cvt_pk_bf16_f32 v163, v166, v167
v_mfma_f32_16x16x32_bf16 v[196:199], a[140:143], a[100:103], v[196:199]
v_cvt_pk_bf16_f32 v168, v168, v169
v_cvt_pk_bf16_f32 v169, v170, v171
v_mfma_f32_16x16x32_bf16 v[204:207], a[136:139], a[104:107], v[204:207]
ds_read_b128 a[56:59], v2 offset:14336
v_cvt_pk_bf16_f32 v170, v172, v173
v_mfma_f32_16x16x32_bf16 v[204:207], a[140:143], a[108:111], v[204:207]
v_cvt_pk_bf16_f32 v171, v174, v175
v_cvt_pk_bf16_f32 v176, v176, v177
v_mfma_f32_16x16x32_bf16 v[212:215], a[136:139], a[112:115], v[212:215]
v_cvt_pk_bf16_f32 v177, v178, v179
v_cvt_pk_bf16_f32 v178, v180, v181
v_mfma_f32_16x16x32_bf16 v[212:215], a[140:143], a[116:119], v[212:215]
buffer_store_dwordx4 v[72:75], v1, s[4:7], s31 offen sc1
v_mfma_f32_16x16x32_bf16 v[220:223], a[136:139], a[120:123], v[220:223]
s_add_u32 s31, s31, s33
ds_read_b128 a[60:63], v3 offset:14336
v_cvt_pk_bf16_f32 v179, v182, v183
v_mfma_f32_16x16x32_bf16 v[220:223], a[140:143], a[124:127], v[220:223]
s_waitcnt lgkmcnt(3)
v_cvt_pk_bf16_f32 v184, v184, v185
v_cvt_pk_bf16_f32 v185, v186, v187
v_mfma_f32_16x16x32_bf16 a[192:195], a[128:131], a[64:67], a[192:195]
ds_read_b64_tr_b16 a[136:137], v11 offset:32768
v_cvt_pk_bf16_f32 v186, v188, v189
v_mfma_f32_16x16x32_bf16 a[192:195], a[132:135], a[68:71], a[192:195]
v_cvt_pk_bf16_f32 v187, v190, v191
v_cvt_pk_bf16_f32 v192, v192, v193
v_mfma_f32_16x16x32_bf16 a[200:203], a[128:131], a[72:75], a[200:203]
ds_read_b64_tr_b16 a[138:139], v11 offset:34816
v_cvt_pk_bf16_f32 v193, v194, v195
v_mfma_f32_16x16x32_bf16 a[200:203], a[132:135], a[76:79], a[200:203]
v_cvt_pk_bf16_f32 v194, v196, v197
v_cvt_pk_bf16_f32 v195, v198, v199
v_mfma_f32_16x16x32_bf16 a[208:211], a[128:131], a[80:83], a[208:211]
ds_read_b64_tr_b16 a[140:141], v11 offset:49152
v_cvt_pk_bf16_f32 v200, v200, v201
v_mfma_f32_16x16x32_bf16 a[208:211], a[132:135], a[84:87], a[208:211]
v_cvt_pk_bf16_f32 v201, v202, v203
v_cvt_pk_bf16_f32 v202, v204, v205
v_mfma_f32_16x16x32_bf16 a[216:219], a[128:131], a[88:91], a[216:219]
ds_read_b64_tr_b16 a[142:143], v11 offset:51200
v_cvt_pk_bf16_f32 v203, v206, v207
v_mfma_f32_16x16x32_bf16 a[216:219], a[132:135], a[92:95], a[216:219]
v_cvt_pk_bf16_f32 v208, v208, v209
v_cvt_pk_bf16_f32 v209, v210, v211
v_mfma_f32_16x16x32_bf16 a[224:227], a[128:131], a[96:99], a[224:227]
buffer_store_dwordx4 v[80:83], v1, s[4:7], s31 offen sc1
v_mfma_f32_16x16x32_bf16 a[224:227], a[132:135], a[100:103], a[224:227]
s_add_u32 s31, s31, s32
v_cvt_pk_bf16_f32 v210, v212, v213
v_cvt_pk_bf16_f32 v211, v214, v215
v_mfma_f32_16x16x32_bf16 a[232:235], a[128:131], a[104:107], a[232:235]
v_cvt_pk_bf16_f32 v216, v216, v217
v_cvt_pk_bf16_f32 v217, v218, v219
v_mfma_f32_16x16x32_bf16 a[232:235], a[132:135], a[108:111], a[232:235]
v_cvt_pk_bf16_f32 v218, v220, v221
v_cvt_pk_bf16_f32 v219, v222, v223
v_mfma_f32_16x16x32_bf16 a[240:243], a[128:131], a[112:115], a[240:243]
v_mfma_f32_16x16x32_bf16 a[240:243], a[132:135], a[116:119], a[240:243]
v_mfma_f32_16x16x32_bf16 a[248:251], a[128:131], a[120:123], a[248:251]
s_waitcnt vmcnt(23) lgkmcnt(0)
v_mfma_f32_16x16x32_bf16 a[248:251], a[132:135], a[124:127], a[248:251]
s_barrier
v_mfma_f32_16x16x32_bf16 a[196:199], a[136:139], a[64:67], a[196:199]
s_add_u32 m0, s29, 98304
ds_read_b64_tr_b16 a[128:129], v22 offset:0
v_mfma_f32_16x16x32_bf16 a[196:199], a[140:143], a[68:71], a[196:199]
buffer_load_dwordx4 v16, s[12:15], s26 offen offset:0 lds
v_mfma_f32_16x16x32_bf16 a[204:207], a[136:139], a[72:75], a[204:207]
ds_read_b64_tr_b16 a[130:131], v22 offset:2048
v_mfma_f32_16x16x32_bf16 a[204:207], a[140:143], a[76:79], a[204:207]
buffer_store_dwordx4 v[88:91], v1, s[4:7], s31 offen sc1
v_mfma_f32_16x16x32_bf16 a[212:215], a[136:139], a[80:83], a[212:215]
s_add_u32 s31, s31, s35
ds_read_b64_tr_b16 a[132:133], v22 offset:16384
v_mfma_f32_16x16x32_bf16 a[212:215], a[140:143], a[84:87], a[212:215]
buffer_load_dwordx4 v17, s[12:15], s26 offen offset:1024 lds
v_mfma_f32_16x16x32_bf16 a[220:223], a[136:139], a[88:91], a[220:223]
ds_read_b64_tr_b16 a[134:135], v22 offset:18432
v_add_u32 v22, 4294901760, v22
v_mfma_f32_16x16x32_bf16 a[220:223], a[140:143], a[92:95], a[220:223]
v_mfma_f32_16x16x32_bf16 a[228:231], a[136:139], a[96:99], a[228:231]
v_mfma_f32_16x16x32_bf16 a[228:231], a[140:143], a[100:103], a[228:231]
buffer_load_dwordx4 v18, s[12:15], s26 offen offset:2048 lds
v_mfma_f32_16x16x32_bf16 a[236:239], a[136:139], a[104:107], a[236:239]
v_mfma_f32_16x16x32_bf16 a[236:239], a[140:143], a[108:111], a[236:239]
v_mfma_f32_16x16x32_bf16 a[244:247], a[136:139], a[112:115], a[244:247]
v_mfma_f32_16x16x32_bf16 a[244:247], a[140:143], a[116:119], a[244:247]
buffer_load_dwordx4 v19, s[12:15], s26 offen offset:3072 lds
v_mfma_f32_16x16x32_bf16 a[252:255], a[136:139], a[120:123], a[252:255]
s_add_u32 s26, s26, 524288
v_mfma_f32_16x16x32_bf16 a[252:255], a[140:143], a[124:127], a[252:255]
s_waitcnt lgkmcnt(0)
M_Q:
v_mfma_f32_16x16x32_bf16 v[36:39], a[128:131], a[0:3], 0
s_add_u32 m0, s29, 114688
ds_read_b64_tr_b16 a[136:137], v23 offset:0
v_mfma_f32_16x16x32_bf16 v[36:39], a[132:135], a[4:7], v[36:39]
buffer_load_dwordx4 v16, s[12:15], s27 offen offset:0 lds
v_mfma_f32_16x16x32_bf16 v[44:47], a[128:131], a[8:11], 0
ds_read_b64_tr_b16 a[138:139], v23 offset:2048
v_mfma_f32_16x16x32_bf16 v[44:47], a[132:135], a[12:15], v[44:47]
ds_read_b128 a[64:67], v2 offset:16384
ds_read_b128 a[68:71], v3 offset:16384
v_mfma_f32_16x16x32_bf16 v[52:55], a[128:131], a[16:19], 0
ds_read_b64_tr_b16 a[140:141], v23 offset:16384
v_mfma_f32_16x16x32_bf16 v[52:55], a[132:135], a[20:23], v[52:55]
buffer_load_dwordx4 v17, s[12:15], s27 offen offset:1024 lds
v_mfma_f32_16x16x32_bf16 v[60:63], a[128:131], a[24:27], 0
ds_read_b64_tr_b16 a[142:143], v23 offset:18432
v_add_u32 v23, 4294901760, v23
v_mfma_f32_16x16x32_bf16 v[60:63], a[132:135], a[28:31], v[60:63]
buffer_store_dwordx4 v[96:99], v1, s[4:7], s31 offen sc1
v_mfma_f32_16x16x32_bf16 v[68:71], a[128:131], a[32:35], 0
s_add_u32 s31, s31, s32
ds_read_b128 a[72:75], v2 offset:18432
v_mfma_f32_16x16x32_bf16 v[68:71], a[132:135], a[36:39], v[68:71]
buffer_load_dwordx4 v18, s[12:15], s27 offen offset:2048 lds
v_mfma_f32_16x16x32_bf16 v[76:79], a[128:131], a[40:43], 0
ds_read_b128 a[76:79], v3 offset:18432
v_mfma_f32_16x16x32_bf16 v[76:79], a[132:135], a[44:47], v[76:79]
ds_read_b128 a[80:83], v2 offset:20480
v_mfma_f32_16x16x32_bf16 v[84:87], a[128:131], a[48:51], 0
ds_read_b128 a[84:87], v3 offset:20480
v_mfma_f32_16x16x32_bf16 v[84:87], a[132:135], a[52:55], v[84:87]
buffer_load_dwordx4 v19, s[12:15], s27 offen offset:3072 lds
v_mfma_f32_16x16x32_bf16 v[92:95], a[128:131], a[56:59], 0
s_add_u32 s27, s27, 524288
ds_read_b128 a[88:91], v2 offset:22528
v_mfma_f32_16x16x32_bf16 v[92:95], a[132:135], a[60:63], v[92:95]
s_waitcnt lgkmcnt(5)
buffer_store_dwordx4 v[104:107], v1, s[4:7], s31 offen sc1
v_mfma_f32_16x16x32_bf16 v[100:103], a[136:139], a[0:3], 0
s_add_u32 m0, s28, 0
ds_read_b64_tr_b16 a[128:129], v24 offset:0
v_mfma_f32_16x16x32_bf16 v[100:103], a[140:143], a[4:7], v[100:103]
s_add_u32 s31, s31, s33
buffer_load_dwordx4 v12, s[8:11], s24 offen offset:0 lds
v_mfma_f32_16x16x32_bf16 v[108:111], a[136:139], a[8:11], 0
ds_read_b64_tr_b16 a[130:131], v24 offset:2048
v_mfma_f32_16x16x32_bf16 v[108:111], a[140:143], a[12:15], v[108:111]
ds_read_b128 a[92:95], v3 offset:22528
v_mfma_f32_16x16x32_bf16 v[116:119], a[136:139], a[16:19], 0
ds_read_b64_tr_b16 a[132:133], v24 offset:16384
v_mfma_f32_16x16x32_bf16 v[116:119], a[140:143], a[20:23], v[116:119]
buffer_load_dwordx4 v13, s[8:11], s24 offen offset:1024 lds
v_mfma_f32_16x16x32_bf16 v[124:127], a[136:139], a[24:27], 0
ds_read_b64_tr_b16 a[134:135], v24 offset:18432
v_add_u32 v24, 4294901760, v24
v_mfma_f32_16x16x32_bf16 v[124:127], a[140:143], a[28:31], v[124:127]
v_mfma_f32_16x16x32_bf16 v[132:135], a[136:139], a[32:35], 0
ds_read_b128 a[96:99], v2 offset:24576
v_mfma_f32_16x16x32_bf16 v[132:135], a[140:143], a[36:39], v[132:135]
buffer_load_dwordx4 v14, s[8:11], s24 offen offset:2048 lds
v_mfma_f32_16x16x32_bf16 v[140:143], a[136:139], a[40:43], 0
ds_read_b128 a[100:103], v3 offset:24576
v_mfma_f32_16x16x32_bf16 v[140:143], a[140:143], a[44:47], v[140:143]
ds_read_b128 a[104:107], v2 offset:26624
v_mfma_f32_16x16x32_bf16 v[148:151], a[136:139], a[48:51], 0
ds_read_b128 a[108:111], v3 offset:26624
v_mfma_f32_16x16x32_bf16 v[148:151], a[140:143], a[52:55], v[148:151]
buffer_load_dwordx4 v15, s[8:11], s24 offen offset:3072 lds
v_mfma_f32_16x16x32_bf16 v[156:159], a[136:139], a[56:59], 0
PAD_6:
s_cbranch_execz M_tret
s_add_u32 s24, s24, 128
ds_read_b128 a[112:115], v2 offset:28672
v_mfma_f32_16x16x32_bf16 v[156:159], a[140:143], a[60:63], v[156:159]
s_waitcnt lgkmcnt(5)
buffer_store_dwordx4 v[112:115], v1, s[4:7], s31 offen sc1
v_mfma_f32_16x16x32_bf16 v[164:167], a[128:131], a[0:3], 0
s_add_u32 s31, s31, s32
ds_read_b64_tr_b16 a[136:137], v25 offset:0
v_mfma_f32_16x16x32_bf16 v[164:167], a[132:135], a[4:7], v[164:167]
v_mfma_f32_16x16x32_bf16 v[172:175], a[128:131], a[8:11], 0
ds_read_b64_tr_b16 a[138:139], v25 offset:2048
v_mfma_f32_16x16x32_bf16 v[172:175], a[132:135], a[12:15], v[172:175]
ds_read_b128 a[116:119], v3 offset:28672
v_mfma_f32_16x16x32_bf16 v[180:183], a[128:131], a[16:19], 0
ds_read_b64_tr_b16 a[140:141], v25 offset:16384
v_mfma_f32_16x16x32_bf16 v[180:183], a[132:135], a[20:23], v[180:183]
v_mfma_f32_16x16x32_bf16 v[188:191], a[128:131], a[24:27], 0
ds_read_b64_tr_b16 a[142:143], v25 offset:18432
v_add_u32 v25, 4294901760, v25
v_mfma_f32_16x16x32_bf16 v[188:191], a[132:135], a[28:31], v[188:191]
v_mfma_f32_16x16x32_bf16 v[196:199], a[128:131], a[32:35], 0
ds_read_b128 a[120:123], v2 offset:30720
v_mfma_f32_16x16x32_bf16 v[196:199], a[132:135], a[36:39], v[196:199]
v_mfma_f32_16x16x32_bf16 v[204:207], a[128:131], a[40:43], 0
ds_read_b128 a[124:127], v3 offset:30720
v_mfma_f32_16x16x32_bf16 v[204:207], a[132:135], a[44:47], v[204:207]
v_mfma_f32_16x16x32_bf16 v[212:215], a[128:131], a[48:51], 0
v_mfma_f32_16x16x32_bf16 v[212:215], a[132:135], a[52:55], v[212:215]
buffer_store_dwordx4 v[120:123], v1, s[4:7], s31 offen sc1
v_mfma_f32_16x16x32_bf16 v[220:223], a[128:131], a[56:59], 0
s_add_u32 s31, s31, s34
v_mfma_f32_16x16x32_bf16 v[220:223], a[132:135], a[60:63], v[220:223]
s_waitcnt vmcnt(28) lgkmcnt(0)
s_barrier
v_mfma_f32_16x16x32_bf16 v[224:227], a[136:139], a[0:3], 0
s_add_u32 m0, s29, 131072
ds_read_b64_tr_b16 a[128:129], v22 offset:0
v_mfma_f32_16x16x32_bf16 v[224:227], a[140:143], a[4:7], v[224:227]
buffer_load_dwordx4 v16, s[12:15], s26 offen offset:0 lds
v_mfma_f32_16x16x32_bf16 v[228:231], a[136:139], a[8:11], 0
ds_read_b64_tr_b16 a[130:131], v22 offset:2048
v_mfma_f32_16x16x32_bf16 v[228:231], a[140:143], a[12:15], v[228:231]
v_mfma_f32_16x16x32_bf16 v[232:235], a[136:139], a[16:19], 0
ds_read_b64_tr_b16 a[132:133], v22 offset:16384
v_mfma_f32_16x16x32_bf16 v[232:235], a[140:143], a[20:23], v[232:235]
buffer_load_dwordx4 v17, s[12:15], s26 offen offset:1024 lds
v_mfma_f32_16x16x32_bf16 v[236:239], a[136:139], a[24:27], 0
ds_read_b64_tr_b16 a[134:135], v22 offset:18432
v_add_u32 v22, 32768, v22
v_mfma_f32_16x16x32_bf16 v[236:239], a[140:143], a[28:31], v[236:239]
v_mfma_f32_16x16x32_bf16 v[240:243], a[136:139], a[32:35], 0
v_mfma_f32_16x16x32_bf16 v[240:243], a[140:143], a[36:39], v[240:243]
buffer_load_dwordx4 v18, s[12:15], s26 offen offset:2048 lds
v_mfma_f32_16x16x32_bf16 v[244:247], a[136:139], a[40:43], 0
v_mfma_f32_16x16x32_bf16 v[244:247], a[140:143], a[44:47], v[244:247]
v_mfma_f32_16x16x32_bf16 v[248:251], a[136:139], a[48:51], 0
v_mfma_f32_16x16x32_bf16 v[248:251], a[140:143], a[52:55], v[248:251]
buffer_load_dwordx4 v19, s[12:15], s26 offen offset:3072 lds
v_mfma_f32_16x16x32_bf16 v[252:255], a[136:139], a[56:59], 0
s_add_u32 s26, s26, 524288
v_mfma_f32_16x16x32_bf16 v[252:255], a[140:143], a[60:63], v[252:255]
s_waitcnt lgkmcnt(0)
v_mfma_f32_16x16x32_bf16 v[36:39], a[128:131], a[64:67], v[36:39]
s_add_u32 m0, s29, 147456
ds_read_b64_tr_b16 a[136:137], v23 offset:0
v_mfma_f32_16x16x32_bf16 v[36:39], a[132:135], a[68:71], v[36:39]
buffer_load_dwordx4 v16, s[12:15], s27 offen offset:0 lds
v_mfma_f32_16x16x32_bf16 v[44:47], a[128:131], a[72:75], v[44:47]
ds_read_b64_tr_b16 a[138:139], v23 offset:2048
v_mfma_f32_16x16x32_bf16 v[44:47], a[132:135], a[76:79], v[44:47]
ds_read_b128 a[0:3], v2 offset:32768
ds_read_b128 a[4:7], v3 offset:32768
v_mfma_f32_16x16x32_bf16 v[52:55], a[128:131], a[80:83], v[52:55]
ds_read_b64_tr_b16 a[140:141], v23 offset:16384
v_mfma_f32_16x16x32_bf16 v[52:55], a[132:135], a[84:87], v[52:55]
buffer_load_dwordx4 v17, s[12:15], s27 offen offset:1024 lds
v_mfma_f32_16x16x32_bf16 v[60:63], a[128:131], a[88:91], v[60:63]
ds_read_b64_tr_b16 a[142:143], v23 offset:18432
v_add_u32 v23, 32768, v23
v_mfma_f32_16x16x32_bf16 v[60:63], a[132:135], a[92:95], v[60:63]
buffer_store_dwordx4 v[128:131], v1, s[4:7], s31 offen sc1
v_mfma_f32_16x16x32_bf16 v[68:71], a[128:131], a[96:99], v[68:71]
s_add_u32 s31, s31, s32
ds_read_b128 a[8:11], v2 offset:34816
v_accvgpr_read_b32 v32, a192
v_mfma_f32_16x16x32_bf16 v[68:71], a[132:135], a[100:103], v[68:71]
buffer_load_dwordx4 v18, s[12:15], s27 offen offset:2048 lds
v_mfma_f32_16x16x32_bf16 v[76:79], a[128:131], a[104:107], v[76:79]
ds_read_b128 a[12:15], v3 offset:34816
v_accvgpr_read_b32 v33, a193
v_mfma_f32_16x16x32_bf16 v[76:79], a[132:135], a[108:111], v[76:79]
ds_read_b128 a[16:19], v2 offset:36864
v_accvgpr_read_b32 v34, a194
v_mfma_f32_16x16x32_bf16 v[84:87], a[128:131], a[112:115], v[84:87]
ds_read_b128 a[20:23], v3 offset:36864
v_accvgpr_read_b32 v35, a195
v_mfma_f32_16x16x32_bf16 v[84:87], a[132:135], a[116:119], v[84:87]
buffer_load_dwordx4 v19, s[12:15], s27 offen offset:3072 lds
v_mfma_f32_16x16x32_bf16 v[92:95], a[128:131], a[120:123], v[92:95]
s_add_u32 s27, s27, 524288
ds_read_b128 a[24:27], v2 offset:38912
v_accvgpr_read_b32 v96, a196
v_mfma_f32_16x16x32_bf16 v[92:95], a[132:135], a[124:127], v[92:95]
s_waitcnt lgkmcnt(5)
buffer_store_dwordx4 v[136:139], v1, s[4:7], s31 offen sc1
v_mfma_f32_16x16x32_bf16 v[100:103], a[136:139], a[64:67], v[100:103]
s_add_u32 m0, s28, 16384
ds_read_b64_tr_b16 a[128:129], v24 offset:0
v_accvgpr_read_b32 v97, a197
v_mfma_f32_16x16x32_bf16 v[100:103], a[140:143], a[68:71], v[100:103]
s_add_u32 s31, s31, s33
buffer_load_dwordx4 v12, s[8:11], s24 offen offset:0 lds
v_mfma_f32_16x16x32_bf16 v[108:111], a[136:139], a[72:75], v[108:111]
ds_read_b64_tr_b16 a[130:131], v24 offset:2048
v_accvgpr_read_b32 v98, a198
v_mfma_f32_16x16x32_bf16 v[108:111], a[140:143], a[76:79], v[108:111]
ds_read_b128 a[28:31], v3 offset:38912
v_accvgpr_read_b32 v99, a199
v_mfma_f32_16x16x32_bf16 v[116:119], a[136:139], a[80:83], v[116:119]
ds_read_b64_tr_b16 a[132:133], v24 offset:16384
v_cvt_pk_bf16_f32 v32, v32, v33
v_mfma_f32_16x16x32_bf16 v[116:119], a[140:143], a[84:87], v[116:119]
buffer_load_dwordx4 v13, s[8:11], s24 offen offset:1024 lds
v_mfma_f32_16x16x32_bf16 v[124:127], a[136:139], a[88:91], v[124:127]
ds_read_b64_tr_b16 a[134:135], v24 offset:18432
v_add_u32 v24, 32768, v24
v_mfma_f32_16x16x32_bf16 v[124:127], a[140:143], a[92:95], v[124:127]
v_cvt_pk_bf16_f32 v33, v34, v35
v_cvt_pk_bf16_f32 v34, v96, v97
v_mfma_f32_16x16x32_bf16 v[132:135], a[136:139], a[96:99], v[132:135]
ds_read_b128 a[32:35], v2 offset:40960
v_cvt_pk_bf16_f32 v35, v98, v99
v_mfma_f32_16x16x32_bf16 v[132:135], a[140:143], a[100:103], v[132:135]
buffer_load_dwordx4 v14, s[8:11], s24 offen offset:2048 lds
v_mfma_f32_16x16x32_bf16 v[140:143], a[136:139], a[104:107], v[140:143]
ds_read_b128 a[36:39], v3 offset:40960
v_accvgpr_read_b32 v40, a200
v_mfma_f32_16x16x32_bf16 v[140:143], a[140:143], a[108:111], v[140:143]
ds_read_b128 a[40:43], v2 offset:43008
v_accvgpr_read_b32 v41, a201
v_mfma_f32_16x16x32_bf16 v[148:151], a[136:139], a[112:115], v[148:151]
ds_read_b128 a[44:47], v3 offset:43008
v_accvgpr_read_b32 v42, a202
v_mfma_f32_16x16x32_bf16 v[148:151], a[140:143], a[116:119], v[148:151]
buffer_load_dwordx4 v15, s[8:11], s24 offen offset:3072 lds
v_mfma_f32_16x16x32_bf16 v[156:159], a[136:139], a[120:123], v[156:159]
s_add_u32 s24, s24, 128
ds_read_b128 a[48:51], v2 offset:45056
v_accvgpr_read_b32 v43, a203
v_mfma_f32_16x16x32_bf16 v[156:159], a[140:143], a[124:127], v[156:159]
s_waitcnt lgkmcnt(5)
buffer_store_dwordx4 v[144:147], v1, s[4:7], s31 offen sc1
v_mfma_f32_16x16x32_bf16 v[164:167], a[128:131], a[64:67], v[164:167]
s_add_u32 s31, s31, s32
ds_read_b64_tr_b16 a[136:137], v25 offset:0
v_accvgpr_read_b32 v96, a204
v_mfma_f32_16x16x32_bf16 v[164:167], a[132:135], a[68:71], v[164:167]
v_accvgpr_read_b32 v97, a205
v_accvgpr_read_b32 v98, a206
v_mfma_f32_16x16x32_bf16 v[172:175], a[128:131], a[72:75], v[172:175]
ds_read_b64_tr_b16 a[138:139], v25 offset:2048
v_accvgpr_read_b32 v99, a207
v_mfma_f32_16x16x32_bf16 v[172:175], a[132:135], a[76:79], v[172:175]
ds_read_b128 a[52:55], v3 offset:45056
v_cvt_pk_bf16_f32 v40, v40, v41
v_mfma_f32_16x16x32_bf16 v[180:183], a[128:131], a[80:83], v[180:183]
ds_read_b64_tr_b16 a[140:141], v25 offset:16384
v_cvt_pk_bf16_f32 v41, v42, v43
v_mfma_f32_16x16x32_bf16 v[180:183], a[132:135], a[84:87], v[180:183]
v_cvt_pk_bf16_f32 v42, v96, v97
v_cvt_pk_bf16_f32 v43, v98, v99
v_mfma_f32_16x16x32_bf16 v[188:191], a[128:131], a[88:91], v[188:191]
ds_read_b64_tr_b16 a[142:143], v25 offset:18432
v_add_u32 v25, 32768, v25
v_mfma_f32_16x16x32_bf16 v[188:191], a[132:135], a[92:95], v[188:191]
v_accvgpr_read_b32 v48, a208
v_accvgpr_read_b32 v49, a209
v_mfma_f32_16x16x32_bf16 v[196:199], a[128:131], a[96:99], v[196:199]
ds_read_b128 a[56:59], v2 offset:47104
v_accvgpr_read_b32 v50, a210
v_mfma_f32_16x16x32_bf16 v[196:199], a[132:135], a[100:103], v[196:199]
v_accvgpr_read_b32 v51, a211
v_accvgpr_read_b32 v96, a212
v_mfma_f32_16x16x32_bf16 v[204:207], a[128:131], a[104:107], v[204:207]
ds_read_b128 a[60:63], v3 offset:47104
v_accvgpr_read_b32 v97, a213
v_mfma_f32_16x16x32_bf16 v[204:207], a[132:135], a[108:111], v[204:207]
v_accvgpr_read_b32 v98, a214
v_accvgpr_read_b32 v99, a215
v_mfma_f32_16x16x32_bf16 v[212:215], a[128:131], a[112:115], v[212:215]
v_cvt_pk_bf16_f32 v48, v48, v49
v_cvt_pk_bf16_f32 v49, v50, v51
v_mfma_f32_16x16x32_bf16 v[212:215], a[132:135], a[116:119], v[212:215]
buffer_store_dwordx4 v[152:155], v1, s[4:7], s31 offen sc1
v_mfma_f32_16x16x32_bf16 v[220:223], a[128:131], a[120:123], v[220:223]
s_add_u32 s31, s31, s36
v_cvt_pk_bf16_f32 v50, v96, v97
v_cvt_pk_bf16_f32 v51, v98, v99
v_mfma_f32_16x16x32_bf16 v[220:223], a[132:135], a[124:127], v[220:223]
s_waitcnt vmcnt(23) lgkmcnt(0)
s_barrier
v_accvgpr_read_b32 v56, a216
v_mfma_f32_16x16x32_bf16 v[224:227], a[136:139], a[64:67], v[224:227]
s_add_u32 m0, s29, 65536
ds_read_b64_tr_b16 a[128:129], v22 offset:0
v_accvgpr_read_b32 v57, a217
v_mfma_f32_16x16x32_bf16 v[224:227], a[140:143], a[68:71], v[224:227]
buffer_load_dwordx4 v16, s[12:15], s26 offen offset:0 lds
v_mfma_f32_16x16x32_bf16 v[228:231], a[136:139], a[72:75], v[228:231]
ds_read_b64_tr_b16 a[130:131], v22 offset:2048
v_accvgpr_read_b32 v58, a218
v_mfma_f32_16x16x32_bf16 v[228:231], a[140:143], a[76:79], v[228:231]
v_accvgpr_read_b32 v59, a219
v_accvgpr_read_b32 v96, a220
v_mfma_f32_16x16x32_bf16 v[232:235], a[136:139], a[80:83], v[232:235]
ds_read_b64_tr_b16 a[132:133], v22 offset:16384
v_accvgpr_read_b32 v97, a221
v_mfma_f32_16x16x32_bf16 v[232:235], a[140:143], a[84:87], v[232:235]
buffer_load_dwordx4 v17, s[12:15], s26 offen offset:1024 lds
v_mfma_f32_16x16x32_bf16 v[236:239], a[136:139], a[88:91], v[236:239]
ds_read_b64_tr_b16 a[134:135], v22 offset:18432
v_add_u32 v22, 32768, v22
v_mfma_f32_16x16x32_bf16 v[236:239], a[140:143], a[92:95], v[236:239]
v_accvgpr_read_b32 v98, a222
v_accvgpr_read_b32 v99, a223
v_mfma_f32_16x16x32_bf16 v[240:243], a[136:139], a[96:99], v[240:243]
v_cvt_pk_bf16_f32 v56, v56, v57
v_cvt_pk_bf16_f32 v57, v58, v59
v_mfma_f32_16x16x32_bf16 v[240:243], a[140:143], a[100:103], v[240:243]
buffer_load_dwordx4 v18, s[12:15], s26 offen offset:2048 lds
v_mfma_f32_16x16x32_bf16 v[244:247], a[136:139], a[104:107], v[244:247]
v_cvt_pk_bf16_f32 v58, v96, v97
v_cvt_pk_bf16_f32 v59, v98, v99
v_mfma_f32_16x16x32_bf16 v[244:247], a[140:143], a[108:111], v[244:247]
v_accvgpr_read_b32 v64, a224
v_accvgpr_read_b32 v65, a225
v_mfma_f32_16x16x32_bf16 v[248:251], a[136:139], a[112:115], v[248:251]
v_accvgpr_read_b32 v66, a226
v_accvgpr_read_b32 v67, a227
v_mfma_f32_16x16x32_bf16 v[248:251], a[140:143], a[116:119], v[248:251]
buffer_load_dwordx4 v19, s[12:15], s26 offen offset:3072 lds
v_mfma_f32_16x16x32_bf16 v[252:255], a[136:139], a[120:123], v[252:255]
s_add_u32 s26, s26, 524288
v_accvgpr_read_b32 v96, a228
v_accvgpr_read_b32 v97, a229
v_mfma_f32_16x16x32_bf16 v[252:255], a[140:143], a[124:127], v[252:255]
s_waitcnt lgkmcnt(0)
v_accvgpr_read_b32 v98, a230
v_accvgpr_read_b32 v99, a231
v_mfma_f32_16x16x32_bf16 v[36:39], a[128:131], a[0:3], v[36:39]
s_add_u32 m0, s29, 81920
ds_read_b64_tr_b16 a[136:137], v23 offset:0
v_cvt_pk_bf16_f32 v64, v64, v65
v_mfma_f32_16x16x32_bf16 v[36:39], a[132:135], a[4:7], v[36:39]
buffer_load_dwordx4 v16, s[12:15], s27 offen offset:0 lds
v_mfma_f32_16x16x32_bf16 v[44:47], a[128:131], a[8:11], v[44:47]
ds_read_b64_tr_b16 a[138:139], v23 offset:2048
v_cvt_pk_bf16_f32 v65, v66, v67
v_mfma_f32_16x16x32_bf16 v[44:47], a[132:135], a[12:15], v[44:47]
ds_read_b128 a[64:67], v2 offset:49152
ds_read_b128 a[68:71], v3 offset:49152
v_mfma_f32_16x16x32_bf16 v[52:55], a[128:131], a[16:19], v[52:55]
ds_read_b64_tr_b16 a[140:141], v23 offset:16384
v_cvt_pk_bf16_f32 v66, v96, v97
v_mfma_f32_16x16x32_bf16 v[52:55], a[132:135], a[20:23], v[52:55]
buffer_load_dwordx4 v17, s[12:15], s27 offen offset:1024 lds
v_mfma_f32_16x16x32_bf16 v[60:63], a[128:131], a[24:27], v[60:63]
ds_read_b64_tr_b16 a[142:143], v23 offset:18432
v_add_u32 v23, 32768, v23
v_mfma_f32_16x16x32_bf16 v[60:63], a[132:135], a[28:31], v[60:63]
buffer_store_dwordx4 v[160:163], v1, s[4:7], s31 offen sc1
v_mfma_f32_16x16x32_bf16 v[68:71], a[128:131], a[32:35], v[68:71]
s_add_u32 s31, s31, s32
ds_read_b128 a[72:75], v2 offset:51200
v_cvt_pk_bf16_f32 v67, v98, v99
v_mfma_f32_16x16x32_bf16 v[68:71], a[132:135], a[36:39], v[68:71]
buffer_load_dwordx4 v18, s[12:15], s27 offen offset:2048 lds
v_mfma_f32_16x16x32_bf16 v[76:79], a[128:131], a[40:43], v[76:79]
ds_read_b128 a[76:79], v3 offset:51200
v_accvgpr_read_b32 v72, a232
v_mfma_f32_16x16x32_bf16 v[76:79], a[132:135], a[44:47], v[76:79]
ds_read_b128 a[80:83], v2 offset:53248
v_accvgpr_read_b32 v73, a233
v_mfma_f32_16x16x32_bf16 v[84:87], a[128:131], a[48:51], v[84:87]
ds_read_b128 a[84:87], v3 offset:53248
v_accvgpr_read_b32 v74, a234
v_mfma_f32_16x16x32_bf16 v[84:87], a[132:135], a[52:55], v[84:87]
buffer_load_dwordx4 v19, s[12:15], s27 offen offset:3072 lds
v_mfma_f32_16x16x32_bf16 v[92:95], a[128:131], a[56:59], v[92:95]
s_add_u32 s27, s27, 524288
ds_read_b128 a[88:91], v2 offset:55296
v_accvgpr_read_b32 v75, a235
v_mfma_f32_16x16x32_bf16 v[92:95], a[132:135], a[60:63], v[92:95]
s_waitcnt lgkmcnt(5)
buffer_store_dwordx4 v[168:171], v1, s[4:7], s31 offen sc1
v_mfma_f32_16x16x32_bf16 v[100:103], a[136:139], a[0:3], v[100:103]
s_add_u32 m0, s28, 32768
ds_read_b64_tr_b16 a[128:129], v24 offset:0
v_accvgpr_read_b32 v96, a236
v_mfma_f32_16x16x32_bf16 v[100:103], a[140:143], a[4:7], v[100:103]
s_add_u32 s31, s31, s33
buffer_load_dwordx4 v12, s[8:11], s24 offen offset:0 lds
v_mfma_f32_16x16x32_bf16 v[108:111], a[136:139], a[8:11], v[108:111]
ds_read_b64_tr_b16 a[130:131], v24 offset:2048
v_accvgpr_read_b32 v97, a237
v_mfma_f32_16x16x32_bf16 v[108:111], a[140:143], a[12:15], v[108:111]
ds_read_b128 a[92:95], v3 offset:55296
v_accvgpr_read_b32 v98, a238
v_mfma_f32_16x16x32_bf16 v[116:119], a[136:139], a[16:19], v[116:119]
ds_read_b64_tr_b16 a[132:133], v24 offset:16384
v_accvgpr_read_b32 v99, a239
v_mfma_f32_16x16x32_bf16 v[116:119], a[140:143], a[20:23], v[116:119]
buffer_load_dwordx4 v13, s[8:11], s24 offen offset:1024 lds
v_mfma_f32_16x16x32_bf16 v[124:127], a[136:139], a[24:27], v[124:127]
ds_read_b64_tr_b16 a[134:135], v24 offset:18432
v_add_u32 v24, 32768, v24
v_mfma_f32_16x16x32_bf16 v[124:127], a[140:143], a[28:31], v[124:127]
v_cvt_pk_bf16_f32 v72, v72, v73
v_cvt_pk_bf16_f32 v73, v74, v75
v_mfma_f32_16x16x32_bf16 v[132:135], a[136:139], a[32:35], v[132:135]
ds_read_b128 a[96:99], v2 offset:57344
v_cvt_pk_bf16_f32 v74, v96, v97
v_mfma_f32_16x16x32_bf16 v[132:135], a[140:143], a[36:39], v[132:135]
buffer_load_dwordx4 v14, s[8:11], s24 offen offset:2048 lds
v_mfma_f32_16x16x32_bf16 v[140:143], a[136:139], a[40:43], v[140:143]
ds_read_b128 a[100:103], v3 offset:57344
v_cvt_pk_bf16_f32 v75, v98, v99
v_mfma_f32_16x16x32_bf16 v[140:143], a[140:143], a[44:47], v[140:143]
ds_read_b128 a[104:107], v2 offset:59392
v_accvgpr_read_b32 v80, a240
v_mfma_f32_16x16x32_bf16 v[148:151], a[136:139], a[48:51], v[148:151]
ds_read_b128 a[108:111], v3 offset:59392
v_accvgpr_read_b32 v81, a241
v_mfma_f32_16x16x32_bf16 v[148:151], a[140:143], a[52:55], v[148:151]
buffer_load_dwordx4 v15, s[8:11], s24 offen offset:3072 lds
v_mfma_f32_16x16x32_bf16 v[156:159], a[136:139], a[56:59], v[156:159]
s_add_u32 s24, s24, 128
ds_read_b128 a[112:115], v2 offset:61440
v_accvgpr_read_b32 v82, a242
v_mfma_f32_16x16x32_bf16 v[156:159], a[140:143], a[60:63], v[156:159]
s_waitcnt lgkmcnt(5)
buffer_store_dwordx4 v[176:179], v1, s[4:7], s31 offen sc1
v_mfma_f32_16x16x32_bf16 v[164:167], a[128:131], a[0:3], v[164:167]
s_add_u32 s31, s31, s32
ds_read_b64_tr_b16 a[136:137], v25 offset:0
v_accvgpr_read_b32 v83, a243
v_mfma_f32_16x16x32_bf16 v[164:167], a[132:135], a[4:7], v[164:167]
v_accvgpr_read_b32 v96, a244
v_accvgpr_read_b32 v97, a245
v_mfma_f32_16x16x32_bf16 v[172:175], a[128:131], a[8:11], v[172:175]
ds_read_b64_tr_b16 a[138:139], v25 offset:2048
v_accvgpr_read_b32 v98, a246
v_mfma_f32_16x16x32_bf16 v[172:175], a[132:135], a[12:15], v[172:175]
ds_read_b128 a[116:119], v3 offset:61440
v_accvgpr_read_b32 v99, a247
v_mfma_f32_16x16x32_bf16 v[180:183], a[128:131], a[16:19], v[180:183]
ds_read_b64_tr_b16 a[140:141], v25 offset:16384
v_cvt_pk_bf16_f32 v80, v80, v81
v_mfma_f32_16x16x32_bf16 v[180:183], a[132:135], a[20:23], v[180:183]
buffer_store_dwordx4 v[184:187], v1, s[4:7], s31 offen sc1
v_mfma_f32_16x16x32_bf16 v[188:191], a[128:131], a[24:27], v[188:191]
s_add_u32 s31, s31, s34
ds_read_b64_tr_b16 a[142:143], v25 offset:18432
v_add_u32 v25, 32768, v25
v_mfma_f32_16x16x32_bf16 v[188:191], a[132:135], a[28:31], v[188:191]
v_cvt_pk_bf16_f32 v81, v82, v83
v_cvt_pk_bf16_f32 v82, v96, v97
v_mfma_f32_16x16x32_bf16 v[196:199], a[128:131], a[32:35], v[196:199]
ds_read_b128 a[120:123], v2 offset:63488
v_cvt_pk_bf16_f32 v83, v98, v99
v_mfma_f32_16x16x32_bf16 v[196:199], a[132:135], a[36:39], v[196:199]
v_accvgpr_read_b32 v88, a248
v_accvgpr_read_b32 v89, a249
v_mfma_f32_16x16x32_bf16 v[204:207], a[128:131], a[40:43], v[204:207]
ds_read_b128 a[124:127], v3 offset:63488
v_accvgpr_read_b32 v90, a250
v_mfma_f32_16x16x32_bf16 v[204:207], a[132:135], a[44:47], v[204:207]
v_accvgpr_read_b32 v91, a251
v_accvgpr_read_b32 v96, a252
v_mfma_f32_16x16x32_bf16 v[212:215], a[128:131], a[48:51], v[212:215]
v_accvgpr_read_b32 v97, a253
v_accvgpr_read_b32 v98, a254
v_mfma_f32_16x16x32_bf16 v[212:215], a[132:135], a[52:55], v[212:215]
v_accvgpr_read_b32 v99, a255
v_cvt_pk_bf16_f32 v88, v88, v89
v_mfma_f32_16x16x32_bf16 v[220:223], a[128:131], a[56:59], v[220:223]
v_cvt_pk_bf16_f32 v89, v90, v91
v_cvt_pk_bf16_f32 v90, v96, v97
v_mfma_f32_16x16x32_bf16 v[220:223], a[132:135], a[60:63], v[220:223]
s_waitcnt vmcnt(23) lgkmcnt(0)
s_barrier
v_cvt_pk_bf16_f32 v91, v98, v99
v_mfma_f32_16x16x32_bf16 v[224:227], a[136:139], a[0:3], v[224:227]
s_add_u32 m0, s29, 98304
ds_read_b64_tr_b16 a[128:129], v22 offset:0
v_mfma_f32_16x16x32_bf16 v[224:227], a[140:143], a[4:7], v[224:227]
buffer_load_dwordx4 v16, s[12:15], s26 offen offset:0 lds
v_mfma_f32_16x16x32_bf16 v[228:231], a[136:139], a[8:11], v[228:231]
ds_read_b64_tr_b16 a[130:131], v22 offset:2048
v_mfma_f32_16x16x32_bf16 v[228:231], a[140:143], a[12:15], v[228:231]
buffer_store_dwordx4 v[192:195], v1, s[4:7], s31 offen sc1
v_mfma_f32_16x16x32_bf16 v[232:235], a[136:139], a[16:19], v[232:235]
s_add_u32 s31, s31, s32
ds_read_b64_tr_b16 a[132:133], v22 offset:16384
v_mfma_f32_16x16x32_bf16 v[232:235], a[140:143], a[20:23], v[232:235]
buffer_load_dwordx4 v17, s[12:15], s26 offen offset:1024 lds
v_mfma_f32_16x16x32_bf16 v[236:239], a[136:139], a[24:27], v[236:239]
ds_read_b64_tr_b16 a[134:135], v22 offset:18432
v_add_u32 v22, 4294901760, v22
v_mfma_f32_16x16x32_bf16 v[236:239], a[140:143], a[28:31], v[236:239]
v_mfma_f32_16x16x32_bf16 v[240:243], a[136:139], a[32:35], v[240:243]
v_mfma_f32_16x16x32_bf16 v[240:243], a[140:143], a[36:39], v[240:243]
buffer_load_dwordx4 v18, s[12:15], s26 offen offset:2048 lds
v_mfma_f32_16x16x32_bf16 v[244:247], a[136:139], a[40:43], v[244:247]
v_mfma_f32_16x16x32_bf16 v[244:247], a[140:143], a[44:47], v[244:247]
v_mfma_f32_16x16x32_bf16 v[248:251], a[136:139], a[48:51], v[248:251]
v_mfma_f32_16x16x32_bf16 v[248:251], a[140:143], a[52:55], v[248:251]
buffer_load_dwordx4 v19, s[12:15], s26 offen offset:3072 lds
v_mfma_f32_16x16x32_bf16 v[252:255], a[136:139], a[56:59], v[252:255]
s_add_u32 s26, s26, 524288
v_mfma_f32_16x16x32_bf16 v[252:255], a[140:143], a[60:63], v[252:255]
s_waitcnt lgkmcnt(0)
v_mfma_f32_16x16x32_bf16 v[36:39], a[128:131], a[64:67], v[36:39]
s_add_u32 m0, s29, 114688
ds_read_b64_tr_b16 a[136:137], v23 offset:0
v_mfma_f32_16x16x32_bf16 v[36:39], a[132:135], a[68:71], v[36:39]
buffer_load_dwordx4 v16, s[12:15], s27 offen offset:0 lds
v_mfma_f32_16x16x32_bf16 v[44:47], a[128:131], a[72:75], v[44:47]
ds_read_b64_tr_b16 a[138:139], v23 offset:2048
v_mfma_f32_16x16x32_bf16 v[44:47], a[132:135], a[76:79], v[44:47]
ds_read_b128 a[0:3], v2 offset:0
ds_read_b128 a[4:7], v3 offset:0
v_mfma_f32_16x16x32_bf16 v[52:55], a[128:131], a[80:83], v[52:55]
ds_read_b64_tr_b16 a[140:141], v23 offset:16384
v_mfma_f32_16x16x32_bf16 v[52:55], a[132:135], a[84:87], v[52:55]
buffer_load_dwordx4 v17, s[12:15], s27 offen offset:1024 lds
v_mfma_f32_16x16x32_bf16 v[60:63], a[128:131], a[88:91], v[60:63]
ds_read_b64_tr_b16 a[142:143], v23 offset:18432
v_add_u32 v23, 4294901760, v23
v_mfma_f32_16x16x32_bf16 v[60:63], a[132:135], a[92:95], v[60:63]
buffer_store_dwordx4 v[200:203], v1, s[4:7], s31 offen sc1
v_mfma_f32_16x16x32_bf16 v[68:71], a[128:131], a[96:99], v[68:71]
s_add_u32 s31, s31, s33
ds_read_b128 a[8:11], v2 offset:2048
v_mfma_f32_16x16x32_bf16 v[68:71], a[132:135], a[100:103], v[68:71]
buffer_load_dwordx4 v18, s[12:15], s27 offen offset:2048 lds
v_mfma_f32_16x16x32_bf16 v[76:79], a[128:131], a[104:107], v[76:79]
ds_read_b128 a[12:15], v3 offset:2048
v_mfma_f32_16x16x32_bf16 v[76:79], a[132:135], a[108:111], v[76:79]
ds_read_b128 a[16:19], v2 offset:4096
v_mfma_f32_16x16x32_bf16 v[84:87], a[128:131], a[112:115], v[84:87]
ds_read_b128 a[20:23], v3 offset:4096
v_mfma_f32_16x16x32_bf16 v[84:87], a[132:135], a[116:119], v[84:87]
buffer_load_dwordx4 v19, s[12:15], s27 offen offset:3072 lds
v_mfma_f32_16x16x32_bf16 v[92:95], a[128:131], a[120:123], v[92:95]
s_add_u32 s27, s27, 524288
ds_read_b128 a[24:27], v2 offset:6144
v_mfma_f32_16x16x32_bf16 v[92:95], a[132:135], a[124:127], v[92:95]
s_waitcnt lgkmcnt(5)
buffer_store_dwordx4 v[208:211], v1, s[4:7], s31 offen sc1
v_mfma_f32_16x16x32_bf16 v[100:103], a[136:139], a[64:67], v[100:103]
s_add_u32 s31, s31, s32
ds_read_b64_tr_b16 a[128:129], v24 offset:0
v_mfma_f32_16x16x32_bf16 v[100:103], a[140:143], a[68:71], v[100:103]
v_mfma_f32_16x16x32_bf16 v[108:111], a[136:139], a[72:75], v[108:111]
ds_read_b64_tr_b16 a[130:131], v24 offset:2048
v_mfma_f32_16x16x32_bf16 v[108:111], a[140:143], a[76:79], v[108:111]
ds_read_b128 a[28:31], v3 offset:6144
v_mfma_f32_16x16x32_bf16 v[116:119], a[136:139], a[80:83], v[116:119]
ds_read_b64_tr_b16 a[132:133], v24 offset:16384
v_mfma_f32_16x16x32_bf16 v[116:119], a[140:143], a[84:87], v[116:119]
v_mfma_f32_16x16x32_bf16 v[124:127], a[136:139], a[88:91], v[124:127]
ds_read_b64_tr_b16 a[134:135], v24 offset:18432
v_add_u32 v24, 4294901760, v24
v_mfma_f32_16x16x32_bf16 v[124:127], a[140:143], a[92:95], v[124:127]
v_mfma_f32_16x16x32_bf16 v[132:135], a[136:139], a[96:99], v[132:135]
ds_read_b128 a[32:35], v2 offset:8192
v_mfma_f32_16x16x32_bf16 v[132:135], a[140:143], a[100:103], v[132:135]
buffer_store_dwordx4 v[216:219], v1, s[4:7], s31 offen sc1
v_mfma_f32_16x16x32_bf16 v[140:143], a[136:139], a[104:107], v[140:143]
s_add_u32 s31, s31, s35
ds_read_b128 a[36:39], v3 offset:8192
v_mfma_f32_16x16x32_bf16 v[140:143], a[140:143], a[108:111], v[140:143]
ds_read_b128 a[40:43], v2 offset:10240
v_mfma_f32_16x16x32_bf16 v[148:151], a[136:139], a[112:115], v[148:151]
ds_read_b128 a[44:47], v3 offset:10240
v_mfma_f32_16x16x32_bf16 v[148:151], a[140:143], a[116:119], v[148:151]
v_mfma_f32_16x16x32_bf16 v[156:159], a[136:139], a[120:123], v[156:159]
ds_read_b128 a[48:51], v2 offset:12288
v_mfma_f32_16x16x32_bf16 v[156:159], a[140:143], a[124:127], v[156:159]
s_waitcnt lgkmcnt(5)
v_mfma_f32_16x16x32_bf16 v[164:167], a[128:131], a[64:67], v[164:167]
ds_read_b64_tr_b16 a[136:137], v25 offset:0
v_mfma_f32_16x16x32_bf16 v[164:167], a[132:135], a[68:71], v[164:167]
v_mfma_f32_16x16x32_bf16 v[172:175], a[128:131], a[72:75], v[172:175]
ds_read_b64_tr_b16 a[138:139], v25 offset:2048
v_mfma_f32_16x16x32_bf16 v[172:175], a[132:135], a[76:79], v[172:175]
ds_read_b128 a[52:55], v3 offset:12288
v_mfma_f32_16x16x32_bf16 v[180:183], a[128:131], a[80:83], v[180:183]
ds_read_b64_tr_b16 a[140:141], v25 offset:16384
v_mfma_f32_16x16x32_bf16 v[180:183], a[132:135], a[84:87], v[180:183]
buffer_store_dwordx4 v[32:35], v1, s[4:7], s31 offen sc1
v_mfma_f32_16x16x32_bf16 v[188:191], a[128:131], a[88:91], v[188:191]
s_add_u32 s31, s31, s32
ds_read_b64_tr_b16 a[142:143], v25 offset:18432
v_add_u32 v25, 4294901760, v25
v_mfma_f32_16x16x32_bf16 v[188:191], a[132:135], a[92:95], v[188:191]
v_mfma_f32_16x16x32_bf16 v[196:199], a[128:131], a[96:99], v[196:199]
ds_read_b128 a[56:59], v2 offset:14336
v_mfma_f32_16x16x32_bf16 v[196:199], a[132:135], a[100:103], v[196:199]
v_mfma_f32_16x16x32_bf16 v[204:207], a[128:131], a[104:107], v[204:207]
ds_read_b128 a[60:63], v3 offset:14336
v_mfma_f32_16x16x32_bf16 v[204:207], a[132:135], a[108:111], v[204:207]
v_mfma_f32_16x16x32_bf16 v[212:215], a[128:131], a[112:115], v[212:215]
v_mfma_f32_16x16x32_bf16 v[212:215], a[132:135], a[116:119], v[212:215]
v_mfma_f32_16x16x32_bf16 v[220:223], a[128:131], a[120:123], v[220:223]
v_mfma_f32_16x16x32_bf16 v[220:223], a[132:135], a[124:127], v[220:223]
s_waitcnt vmcnt(20) lgkmcnt(0)
s_barrier
v_mfma_f32_16x16x32_bf16 v[224:227], a[136:139], a[64:67], v[224:227]
s_add_u32 m0, s29, 131072
ds_read_b64_tr_b16 a[128:129], v22 offset:0
v_mfma_f32_16x16x32_bf16 v[224:227], a[140:143], a[68:71], v[224:227]
buffer_load_dwordx4 v16, s[12:15], s26 offen offset:0 lds
v_mfma_f32_16x16x32_bf16 v[228:231], a[136:139], a[72:75], v[228:231]
ds_read_b64_tr_b16 a[130:131], v22 offset:2048
v_mfma_f32_16x16x32_bf16 v[228:231], a[140:143], a[76:79], v[228:231]
buffer_store_dwordx4 v[40:43], v1, s[4:7], s31 offen sc1
v_mfma_f32_16x16x32_bf16 v[232:235], a[136:139], a[80:83], v[232:235]
PAD_7:
s_cbranch_execz M_tret
s_add_u32 s31, s31, s33
ds_read_b64_tr_b16 a[132:133], v22 offset:16384
v_mfma_f32_16x16x32_bf16 v[232:235], a[140:143], a[84:87], v[232:235]
buffer_load_dwordx4 v17, s[12:15], s26 offen offset:1024 lds
v_mfma_f32_16x16x32_bf16 v[236:239], a[136:139], a[88:91], v[236:239]
ds_read_b64_tr_b16 a[134:135], v22 offset:18432
v_add_u32 v22, 32768, v22
v_mfma_f32_16x16x32_bf16 v[236:239], a[140:143], a[92:95], v[236:239]
v_mfma_f32_16x16x32_bf16 v[240:243], a[136:139], a[96:99], v[240:243]
v_mfma_f32_16x16x32_bf16 v[240:243], a[140:143], a[100:103], v[240:243]
buffer_load_dwordx4 v18, s[12:15], s26 offen offset:2048 lds
v_mfma_f32_16x16x32_bf16 v[244:247], a[136:139], a[104:107], v[244:247]
v_mfma_f32_16x16x32_bf16 v[244:247], a[140:143], a[108:111], v[244:247]
v_mfma_f32_16x16x32_bf16 v[248:251], a[136:139], a[112:115], v[248:251]
v_mfma_f32_16x16x32_bf16 v[248:251], a[140:143], a[116:119], v[248:251]
buffer_load_dwordx4 v19, s[12:15], s26 offen offset:3072 lds
v_mfma_f32_16x16x32_bf16 v[252:255], a[136:139], a[120:123], v[252:255]
s_add_u32 s26, s26, 524288
v_mfma_f32_16x16x32_bf16 v[252:255], a[140:143], a[124:127], v[252:255]
s_waitcnt lgkmcnt(0)
v_mfma_f32_16x16x32_bf16 v[36:39], a[128:131], a[0:3], v[36:39]
s_add_u32 m0, s29, 147456
ds_read_b64_tr_b16 a[136:137], v23 offset:0
v_mfma_f32_16x16x32_bf16 v[36:39], a[132:135], a[4:7], v[36:39]
buffer_load_dwordx4 v16, s[12:15], s27 offen offset:0 lds
v_mfma_f32_16x16x32_bf16 v[44:47], a[128:131], a[8:11], v[44:47]
s_lshl_b32 s22, s20, 7
ds_read_b64_tr_b16 a[138:139], v23 offset:2048
v_bfe_u32 v20, v1, 4, 3
v_mfma_f32_16x16x32_bf16 v[44:47], a[132:135], a[12:15], v[44:47]
s_add_u32 s70, s22, 94371840
ds_read_b128 a[64:67], v2 offset:16384
ds_read_b128 a[68:71], v3 offset:16384
v_mfma_f32_16x16x32_bf16 v[52:55], a[128:131], a[16:19], v[52:55]
s_lshr_b32 s22, s2, 4
ds_read_b64_tr_b16 a[140:141], v23 offset:16384
v_lshlrev_b32 v20, 3, v20
v_mfma_f32_16x16x32_bf16 v[52:55], a[132:135], a[20:23], v[52:55]
s_lshl_b32 s22, s22, 2
buffer_load_dwordx4 v17, s[12:15], s27 offen offset:1024 lds
v_mfma_f32_16x16x32_bf16 v[60:63], a[128:131], a[24:27], v[60:63]
s_add_u32 s66, s70, s22
ds_read_b64_tr_b16 a[142:143], v23 offset:18432
v_add_u32 v23, 32768, v23
v_mfma_f32_16x16x32_bf16 v[60:63], a[132:135], a[28:31], v[60:63]
s_and_b32 s22, s2, 16
buffer_store_dwordx4 v[48:51], v1, s[4:7], s31 offen sc1
v_mfma_f32_16x16x32_bf16 v[68:71], a[128:131], a[32:35], v[68:71]
s_add_u32 s31, s31, s32
ds_read_b128 a[72:75], v2 offset:18432
v_add_u32 v15, 2052, v20
v_mfma_f32_16x16x32_bf16 v[68:71], a[132:135], a[36:39], v[68:71]
s_lshl_b32 s22, s22, 7
buffer_load_dwordx4 v18, s[12:15], s27 offen offset:2048 lds
v_mfma_f32_16x16x32_bf16 v[76:79], a[128:131], a[40:43], v[76:79]
s_add_u32 s66, s66, s22
ds_read_b128 a[76:79], v3 offset:18432
v_mfma_f32_16x16x32_bf16 v[76:79], a[132:135], a[44:47], v[76:79]
s_lshl_b32 s67, s20, 20
ds_read_b128 a[80:83], v2 offset:20480
v_mfma_f32_16x16x32_bf16 v[84:87], a[128:131], a[48:51], v[84:87]
s_lshl_b32 s22, s37, 16
ds_read_b128 a[84:87], v3 offset:20480
v_mfma_f32_16x16x32_bf16 v[84:87], a[132:135], a[52:55], v[84:87]
s_add_u32 s67, s67, s22
buffer_load_dwordx4 v19, s[12:15], s27 offen offset:3072 lds
v_mfma_f32_16x16x32_bf16 v[92:95], a[128:131], a[56:59], v[92:95]
s_waitcnt lgkmcnt(5)
s_add_u32 s27, s27, 524288
ds_read_b128 a[88:91], v2 offset:22528
v_mfma_f32_16x16x32_bf16 v[92:95], a[132:135], a[60:63], v[92:95]
s_lshl_b32 s22, s3, 11
buffer_store_dwordx4 v[56:59], v1, s[4:7], s31 offen sc1
v_mfma_f32_16x16x32_bf16 v[100:103], a[136:139], a[0:3], v[100:103]
s_waitcnt lgkmcnt(5)
s_add_u32 s31, s31, s34
ds_read_b64_tr_b16 a[128:129], v24 offset:0
v_mfma_f32_16x16x32_bf16 v[100:103], a[140:143], a[4:7], v[100:103]
s_add_u32 s67, s67, s22
v_mfma_f32_16x16x32_bf16 v[108:111], a[136:139], a[8:11], v[108:111]
s_add_u32 s67, s67, 33554432
ds_read_b64_tr_b16 a[130:131], v24 offset:2048
v_mfma_f32_16x16x32_bf16 v[108:111], a[140:143], a[12:15], v[108:111]
s_mov_b32 s68, 1035512379
ds_read_b128 a[92:95], v3 offset:22528
v_mfma_f32_16x16x32_bf16 v[116:119], a[136:139], a[16:19], v[116:119]
s_mov_b32 s69, 1035512379
ds_read_b64_tr_b16 a[132:133], v24 offset:16384
v_mfma_f32_16x16x32_bf16 v[116:119], a[140:143], a[20:23], v[116:119]
buffer_store_dwordx4 v[64:67], v1, s[4:7], s31 offen sc1
v_mfma_f32_16x16x32_bf16 v[124:127], a[136:139], a[24:27], v[124:127]
s_add_u32 s31, s31, s32
ds_read_b64_tr_b16 a[134:135], v24 offset:18432
v_add_u32 v24, 32768, v24
v_mfma_f32_16x16x32_bf16 v[124:127], a[140:143], a[28:31], v[124:127]
v_mfma_f32_16x16x32_bf16 v[132:135], a[136:139], a[32:35], v[132:135]
ds_read_b128 a[96:99], v2 offset:24576
v_mfma_f32_16x16x32_bf16 v[132:135], a[140:143], a[36:39], v[132:135]
v_mfma_f32_16x16x32_bf16 v[140:143], a[136:139], a[40:43], v[140:143]
ds_read_b128 a[100:103], v3 offset:24576
v_mfma_f32_16x16x32_bf16 v[140:143], a[140:143], a[44:47], v[140:143]
ds_read_b128 a[104:107], v2 offset:26624
v_mfma_f32_16x16x32_bf16 v[148:151], a[136:139], a[48:51], v[148:151]
ds_read_b128 a[108:111], v3 offset:26624
v_mfma_f32_16x16x32_bf16 v[148:151], a[140:143], a[52:55], v[148:151]
v_mfma_f32_16x16x32_bf16 v[156:159], a[136:139], a[56:59], v[156:159]
ds_read_b128 a[112:115], v2 offset:28672
v_mfma_f32_16x16x32_bf16 v[156:159], a[140:143], a[60:63], v[156:159]
s_waitcnt lgkmcnt(5)
buffer_store_dwordx4 v[72:75], v1, s[4:7], s31 offen sc1
v_mfma_f32_16x16x32_bf16 v[164:167], a[128:131], a[0:3], v[164:167]
s_add_u32 s31, s31, s33
ds_read_b64_tr_b16 a[136:137], v25 offset:0
v_mfma_f32_16x16x32_bf16 v[164:167], a[132:135], a[4:7], v[164:167]
v_mfma_f32_16x16x32_bf16 v[172:175], a[128:131], a[8:11], v[172:175]
ds_read_b64_tr_b16 a[138:139], v25 offset:2048
v_mfma_f32_16x16x32_bf16 v[172:175], a[132:135], a[12:15], v[172:175]
ds_read_b128 a[116:119], v3 offset:28672
v_mfma_f32_16x16x32_bf16 v[180:183], a[128:131], a[16:19], v[180:183]
ds_read_b64_tr_b16 a[140:141], v25 offset:16384
v_mfma_f32_16x16x32_bf16 v[180:183], a[132:135], a[20:23], v[180:183]
v_mfma_f32_16x16x32_bf16 v[188:191], a[128:131], a[24:27], v[188:191]
ds_read_b64_tr_b16 a[142:143], v25 offset:18432
v_add_u32 v25, 32768, v25
v_mfma_f32_16x16x32_bf16 v[188:191], a[132:135], a[28:31], v[188:191]
v_mfma_f32_16x16x32_bf16 v[196:199], a[128:131], a[32:35], v[196:199]
ds_read_b128 a[120:123], v2 offset:30720
v_mfma_f32_16x16x32_bf16 v[196:199], a[132:135], a[36:39], v[196:199]
buffer_store_dwordx4 v[80:83], v1, s[4:7], s31 offen sc1
v_mfma_f32_16x16x32_bf16 v[204:207], a[128:131], a[40:43], v[204:207]
s_add_u32 s31, s31, s32
ds_read_b128 a[124:127], v3 offset:30720
v_mfma_f32_16x16x32_bf16 v[204:207], a[132:135], a[44:47], v[204:207]
v_mfma_f32_16x16x32_bf16 v[212:215], a[128:131], a[48:51], v[212:215]
v_mfma_f32_16x16x32_bf16 v[212:215], a[132:135], a[52:55], v[212:215]
v_mfma_f32_16x16x32_bf16 v[220:223], a[128:131], a[56:59], v[220:223]
v_mfma_f32_16x16x32_bf16 v[220:223], a[132:135], a[60:63], v[220:223]
s_waitcnt vmcnt(17) lgkmcnt(0)
s_barrier
v_mfma_f32_16x16x32_bf16 v[224:227], a[136:139], a[0:3], v[224:227]
ds_read_b64_tr_b16 a[128:129], v22 offset:0
v_mfma_f32_16x16x32_bf16 v[224:227], a[140:143], a[4:7], v[224:227]
v_mfma_f32_16x16x32_bf16 v[228:231], a[136:139], a[8:11], v[228:231]
ds_read_b64_tr_b16 a[130:131], v22 offset:2048
v_mfma_f32_16x16x32_bf16 v[228:231], a[140:143], a[12:15], v[228:231]
buffer_store_dwordx4 v[88:91], v1, s[4:7], s31 offen sc1
v_mfma_f32_16x16x32_bf16 v[232:235], a[136:139], a[16:19], v[232:235]
ds_read_b64_tr_b16 a[132:133], v22 offset:16384
v_mfma_f32_16x16x32_bf16 v[232:235], a[140:143], a[20:23], v[232:235]
v_mfma_f32_16x16x32_bf16 v[236:239], a[136:139], a[24:27], v[236:239]
ds_read_b64_tr_b16 a[134:135], v22 offset:18432
v_add_u32 v22, 32768, v22
v_mfma_f32_16x16x32_bf16 v[236:239], a[140:143], a[28:31], v[236:239]
v_mfma_f32_16x16x32_bf16 v[240:243], a[136:139], a[32:35], v[240:243]
v_mfma_f32_16x16x32_bf16 v[240:243], a[140:143], a[36:39], v[240:243]
v_mfma_f32_16x16x32_bf16 v[244:247], a[136:139], a[40:43], v[244:247]
v_mfma_f32_16x16x32_bf16 v[244:247], a[140:143], a[44:47], v[244:247]
v_mfma_f32_16x16x32_bf16 v[248:251], a[136:139], a[48:51], v[248:251]
v_mfma_f32_16x16x32_bf16 v[248:251], a[140:143], a[52:55], v[248:251]
v_mfma_f32_16x16x32_bf16 v[252:255], a[136:139], a[56:59], v[252:255]
v_mfma_f32_16x16x32_bf16 v[252:255], a[140:143], a[60:63], v[252:255]
s_waitcnt lgkmcnt(0)
v_mfma_f32_16x16x32_bf16 v[36:39], a[128:131], a[64:67], v[36:39]
ds_read_b64_tr_b16 a[136:137], v23 offset:0
v_mfma_f32_16x16x32_bf16 v[36:39], a[132:135], a[68:71], v[36:39]
v_mfma_f32_16x16x32_bf16 v[44:47], a[128:131], a[72:75], v[44:47]
ds_read_b64_tr_b16 a[138:139], v23 offset:2048
v_mfma_f32_16x16x32_bf16 v[44:47], a[132:135], a[76:79], v[44:47]
ds_read_b128 a[0:3], v2 offset:32768
ds_read_b128 a[4:7], v3 offset:32768
v_mfma_f32_16x16x32_bf16 v[52:55], a[128:131], a[80:83], v[52:55]
ds_read_b64_tr_b16 a[140:141], v23 offset:16384
v_mfma_f32_16x16x32_bf16 v[52:55], a[132:135], a[84:87], v[52:55]
v_mfma_f32_16x16x32_bf16 v[60:63], a[128:131], a[88:91], v[60:63]
ds_read_b64_tr_b16 a[142:143], v23 offset:18432
v_add_u32 v23, 32768, v23
v_mfma_f32_16x16x32_bf16 v[60:63], a[132:135], a[92:95], v[60:63]
v_mfma_f32_16x16x32_bf16 v[68:71], a[128:131], a[96:99], v[68:71]
ds_read_b128 a[8:11], v2 offset:34816
v_mfma_f32_16x16x32_bf16 v[68:71], a[132:135], a[100:103], v[68:71]
v_mfma_f32_16x16x32_bf16 v[76:79], a[128:131], a[104:107], v[76:79]
ds_read_b128 a[12:15], v3 offset:34816
v_mfma_f32_16x16x32_bf16 v[76:79], a[132:135], a[108:111], v[76:79]
ds_read_b128 a[16:19], v2 offset:36864
v_mfma_f32_16x16x32_bf16 v[84:87], a[128:131], a[112:115], v[84:87]
ds_read_b128 a[20:23], v3 offset:36864
v_mfma_f32_16x16x32_bf16 v[84:87], a[132:135], a[116:119], v[84:87]
v_mfma_f32_16x16x32_bf16 v[92:95], a[128:131], a[120:123], v[92:95]
ds_read_b128 a[24:27], v2 offset:38912
v_mfma_f32_16x16x32_bf16 v[92:95], a[132:135], a[124:127], v[92:95]
s_waitcnt lgkmcnt(5)
v_mfma_f32_16x16x32_bf16 v[100:103], a[136:139], a[64:67], v[100:103]
ds_read_b64_tr_b16 a[128:129], v24 offset:0
v_mfma_f32_16x16x32_bf16 v[100:103], a[140:143], a[68:71], v[100:103]
v_mfma_f32_16x16x32_bf16 v[108:111], a[136:139], a[72:75], v[108:111]
ds_read_b64_tr_b16 a[130:131], v24 offset:2048
v_mfma_f32_16x16x32_bf16 v[108:111], a[140:143], a[76:79], v[108:111]
ds_read_b128 a[28:31], v3 offset:38912
v_mfma_f32_16x16x32_bf16 v[116:119], a[136:139], a[80:83], v[116:119]
ds_read_b64_tr_b16 a[132:133], v24 offset:16384
v_mfma_f32_16x16x32_bf16 v[116:119], a[140:143], a[84:87], v[116:119]
v_mfma_f32_16x16x32_bf16 v[124:127], a[136:139], a[88:91], v[124:127]
ds_read_b64_tr_b16 a[134:135], v24 offset:18432
v_add_u32 v24, 32768, v24
v_mfma_f32_16x16x32_bf16 v[124:127], a[140:143], a[92:95], v[124:127]
v_mfma_f32_16x16x32_bf16 v[132:135], a[136:139], a[96:99], v[132:135]
ds_read_b128 a[32:35], v2 offset:40960
v_mfma_f32_16x16x32_bf16 v[132:135], a[140:143], a[100:103], v[132:135]
v_mfma_f32_16x16x32_bf16 v[140:143], a[136:139], a[104:107], v[140:143]
ds_read_b128 a[36:39], v3 offset:40960
v_mfma_f32_16x16x32_bf16 v[140:143], a[140:143], a[108:111], v[140:143]
ds_read_b128 a[40:43], v2 offset:43008
v_mfma_f32_16x16x32_bf16 v[148:151], a[136:139], a[112:115], v[148:151]
ds_read_b128 a[44:47], v3 offset:43008
v_mfma_f32_16x16x32_bf16 v[148:151], a[140:143], a[116:119], v[148:151]
v_mfma_f32_16x16x32_bf16 v[156:159], a[136:139], a[120:123], v[156:159]
ds_read_b128 a[48:51], v2 offset:45056
v_mfma_f32_16x16x32_bf16 v[156:159], a[140:143], a[124:127], v[156:159]
s_waitcnt lgkmcnt(5)
v_mfma_f32_16x16x32_bf16 v[164:167], a[128:131], a[64:67], v[164:167]
ds_read_b64_tr_b16 a[136:137], v25 offset:0
v_mfma_f32_16x16x32_bf16 v[164:167], a[132:135], a[68:71], v[164:167]
v_mfma_f32_16x16x32_bf16 v[172:175], a[128:131], a[72:75], v[172:175]
ds_read_b64_tr_b16 a[138:139], v25 offset:2048
v_mfma_f32_16x16x32_bf16 v[172:175], a[132:135], a[76:79], v[172:175]
ds_read_b128 a[52:55], v3 offset:45056
v_mfma_f32_16x16x32_bf16 v[180:183], a[128:131], a[80:83], v[180:183]
ds_read_b64_tr_b16 a[140:141], v25 offset:16384
v_mfma_f32_16x16x32_bf16 v[180:183], a[132:135], a[84:87], v[180:183]
v_mfma_f32_16x16x32_bf16 v[188:191], a[128:131], a[88:91], v[188:191]
ds_read_b64_tr_b16 a[142:143], v25 offset:18432
v_add_u32 v25, 32768, v25
v_mfma_f32_16x16x32_bf16 v[188:191], a[132:135], a[92:95], v[188:191]
v_mfma_f32_16x16x32_bf16 v[196:199], a[128:131], a[96:99], v[196:199]
ds_read_b128 a[56:59], v2 offset:47104
v_mfma_f32_16x16x32_bf16 v[196:199], a[132:135], a[100:103], v[196:199]
v_mfma_f32_16x16x32_bf16 v[204:207], a[128:131], a[104:107], v[204:207]
ds_read_b128 a[60:63], v3 offset:47104
v_mfma_f32_16x16x32_bf16 v[204:207], a[132:135], a[108:111], v[204:207]
v_mfma_f32_16x16x32_bf16 v[212:215], a[128:131], a[112:115], v[212:215]
v_mfma_f32_16x16x32_bf16 v[212:215], a[132:135], a[116:119], v[212:215]
v_mfma_f32_16x16x32_bf16 v[220:223], a[128:131], a[120:123], v[220:223]
v_mfma_f32_16x16x32_bf16 v[220:223], a[132:135], a[124:127], v[220:223]
s_waitcnt vmcnt(0) lgkmcnt(0)
s_barrier
v_mfma_f32_16x16x32_bf16 v[224:227], a[136:139], a[64:67], v[224:227]
ds_read_b64_tr_b16 a[128:129], v22 offset:0
v_mfma_f32_16x16x32_bf16 v[224:227], a[140:143], a[68:71], v[224:227]
buffer_store_dword v27, v26, s[4:7], s66 offen sc1
v_mfma_f32_16x16x32_bf16 v[228:231], a[136:139], a[72:75], v[228:231]
ds_read_b64_tr_b16 a[130:131], v22 offset:2048
v_mfma_f32_16x16x32_bf16 v[228:231], a[140:143], a[76:79], v[228:231]
v_mfma_f32_16x16x32_bf16 v[232:235], a[136:139], a[80:83], v[232:235]
ds_read_b64_tr_b16 a[132:133], v22 offset:16384
v_mfma_f32_16x16x32_bf16 v[232:235], a[140:143], a[84:87], v[232:235]
v_mfma_f32_16x16x32_bf16 v[236:239], a[136:139], a[88:91], v[236:239]
ds_read_b64_tr_b16 a[134:135], v22 offset:18432
v_mfma_f32_16x16x32_bf16 v[236:239], a[140:143], a[92:95], v[236:239]
v_mfma_f32_16x16x32_bf16 v[240:243], a[136:139], a[96:99], v[240:243]
v_mfma_f32_16x16x32_bf16 v[240:243], a[140:143], a[100:103], v[240:243]
v_mfma_f32_16x16x32_bf16 v[244:247], a[136:139], a[104:107], v[244:247]
v_mfma_f32_16x16x32_bf16 v[244:247], a[140:143], a[108:111], v[244:247]
v_mfma_f32_16x16x32_bf16 v[248:251], a[136:139], a[112:115], v[248:251]
v_mfma_f32_16x16x32_bf16 v[248:251], a[140:143], a[116:119], v[248:251]
v_mfma_f32_16x16x32_bf16 v[252:255], a[136:139], a[120:123], v[252:255]
v_mfma_f32_16x16x32_bf16 v[252:255], a[140:143], a[124:127], v[252:255]
s_waitcnt lgkmcnt(0)
v_mfma_f32_16x16x32_bf16 v[36:39], a[128:131], a[0:3], v[36:39]
s_lshl_b32 s18, s3, 13
ds_read_b64_tr_b16 a[136:137], v23 offset:0
v_lshrrev_b32 v28, 6, v0
v_mfma_f32_16x16x32_bf16 v[36:39], a[132:135], a[4:7], v[36:39]
s_lshl_b32 s30, s20, 20
v_lshl_add_u32 v28, v28, 11, v1
v_add_u32 v28, 65536, v28
v_mfma_f32_16x16x32_bf16 v[44:47], a[128:131], a[8:11], v[44:47]
s_add_u32 s30, s30, s18
ds_read_b64_tr_b16 a[138:139], v23 offset:2048
v_lshrrev_b32 v3, 6, v0
v_mfma_f32_16x16x32_bf16 v[44:47], a[132:135], a[12:15], v[44:47]
s_lshl_b32 s22, s21, 1
v_and_b32 v4, 63, v0
v_add_u32 v2, 0x10000, v1
v_mfma_f32_16x16x32_bf16 v[52:55], a[128:131], a[16:19], v[52:55]
s_and_b32 s84, s2, 1
ds_read_b64_tr_b16 a[140:141], v23 offset:16384
v_and_b32 v5, 15, v4
v_mfma_f32_16x16x32_bf16 v[52:55], a[132:135], a[20:23], v[52:55]
s_mul_i32 s84, s84, 0
v_lshrrev_b32 v6, 4, v4
v_lshlrev_b32 v6, 2, v6
v_mfma_f32_16x16x32_bf16 v[60:63], a[128:131], a[24:27], v[60:63]
s_add_u32 s84, s84, 2386092
ds_read_b64_tr_b16 a[142:143], v23 offset:18432
v_sub_u32 v5, v5, v6
v_mfma_f32_16x16x32_bf16 v[60:63], a[132:135], a[28:31], v[60:63]
s_lshl_b32 s85, s21, 2
v_lshl_add_u32 v5, v3, 4, v5
v_cmp_gt_i32 s[32:33], 0, v5
v_mfma_f32_16x16x32_bf16 v[68:71], a[128:131], a[32:35], v[68:71]
s_lshr_b32 s85, s84, s85
v_cmp_gt_i32 s[34:35], 1, v5
v_cmp_gt_i32 s[36:37], 2, v5
v_mfma_f32_16x16x32_bf16 v[68:71], a[132:135], a[36:39], v[68:71]
s_and_b32 s9, s85, 15
v_cmp_gt_i32 s[38:39], 3, v5
v_cmp_gt_i32 s[40:41], 16, v5
v_mfma_f32_16x16x32_bf16 v[76:79], a[128:131], a[40:43], v[76:79]
s_and_b32 s84, s85, 1
v_cmp_gt_i32 s[42:43], 17, v5
v_cmp_gt_i32 s[44:45], 18, v5
v_mfma_f32_16x16x32_bf16 v[76:79], a[132:135], a[44:47], v[76:79]
s_lshl_b32 s84, s84, 17
v_cmp_gt_i32 s[46:47], 19, v5
v_cmp_gt_i32 s[48:49], 32, v5
v_mfma_f32_16x16x32_bf16 v[84:87], a[128:131], a[48:51], v[84:87]
s_add_u32 s84, s84, s18
v_cmp_gt_i32 s[50:51], 33, v5
v_cmp_gt_i32 s[52:53], 34, v5
v_mfma_f32_16x16x32_bf16 v[84:87], a[132:135], a[52:55], v[84:87]
s_xor_b32 s85, s84, 0x20000
v_cmp_gt_i32 s[54:55], 35, v5
v_cmp_gt_i32 s[56:57], 48, v5
v_mfma_f32_16x16x32_bf16 v[92:95], a[128:131], a[56:59], v[92:95]
s_sub_u32 s29, 15, s21
v_cmp_gt_i32 s[58:59], 49, v5
v_cmp_gt_i32 s[60:61], 50, v5
v_mfma_f32_16x16x32_bf16 v[92:95], a[132:135], a[60:63], v[92:95]
s_waitcnt lgkmcnt(0)
v_cmp_gt_i32 s[62:63], 51, v5
v_mov_b32 v7, 0xff800000
v_mfma_f32_16x16x32_bf16 v[100:103], a[136:139], a[0:3], v[100:103]
s_cmp_lg_u32 s9, 0
ds_read_b64_tr_b16 a[128:129], v24 offset:0
v_mov_b32 v6, 1
v_mfma_f32_16x16x32_bf16 v[100:103], a[140:143], a[4:7], v[100:103]
s_cselect_b32 s24, 1, 0
v_mov_b32 v5, v26
v_add_u32 v4, 0x20000, v1
v_mfma_f32_16x16x32_bf16 v[108:111], a[136:139], a[8:11], v[108:111]
s_cselect_b32 s67, s67, 3221225472
ds_read_b64_tr_b16 a[130:131], v24 offset:2048
v_mfma_f32_16x16x32_bf16 v[108:111], a[140:143], a[12:15], v[108:111]
s_lshl_b32 s8, s9, 15
v_mfma_f32_16x16x32_bf16 v[116:119], a[136:139], a[16:19], v[116:119]
s_add_u32 s8, s8, s30
ds_read_b64_tr_b16 a[132:133], v24 offset:16384
v_mfma_f32_16x16x32_bf16 v[116:119], a[140:143], a[20:23], v[116:119]
s_add_u32 s9, s9, s22
v_mfma_f32_16x16x32_bf16 v[124:127], a[136:139], a[24:27], v[124:127]
s_sub_u32 s9, 32, s9
ds_read_b64_tr_b16 a[134:135], v24 offset:18432
v_mul_f32 v36, s68, v36
v_mfma_f32_16x16x32_bf16 v[124:127], a[140:143], a[28:31], v[124:127]
s_bitcmp1_b32 s2, 4
v_mul_f32 v37, s68, v37
v_mul_f32 v38, s68, v38
v_mfma_f32_16x16x32_bf16 v[132:135], a[136:139], a[32:35], v[132:135]
s_cselect_b32 s9, 16, s9
v_mul_f32 v39, s68, v39
v_mul_f32 v100, s68, v100
v_mfma_f32_16x16x32_bf16 v[132:135], a[140:143], a[36:39], v[132:135]
s_cselect_b32 s29, 7, s29
v_mul_f32 v101, s68, v101
v_mul_f32 v102, s68, v102
v_mfma_f32_16x16x32_bf16 v[140:143], a[136:139], a[40:43], v[140:143]
s_mov_b32 s10, 3221225472
v_mul_f32 v103, s68, v103
v_cvt_pk_bf16_f32 v36, v36, v37
v_mfma_f32_16x16x32_bf16 v[140:143], a[140:143], a[44:47], v[140:143]
s_mov_b32 s14, 3221225472
v_cvt_pk_bf16_f32 v37, v38, v39
v_cvt_pk_bf16_f32 v38, v100, v101
v_mfma_f32_16x16x32_bf16 v[148:151], a[136:139], a[48:51], v[148:151]
s_mov_b32 s11, 0
v_cvt_pk_bf16_f32 v39, v102, v103
v_mul_f32 v44, s68, v44
v_mfma_f32_16x16x32_bf16 v[148:151], a[140:143], a[52:55], v[148:151]
s_lshr_b32 s19, s9, 1
ds_write_b128 v28, v[36:39] offset:0
v_mul_f32 v45, s68, v45
v_mfma_f32_16x16x32_bf16 v[156:159], a[136:139], a[56:59], v[156:159]
s_sub_u32 s19, s19, 1
s_add_u32 s23, s67, 0
buffer_store_dwordx4 v[36:39], v1, s[4:7], s23 offen offset:0 sc1
v_mfma_f32_16x16x32_bf16 v[156:159], a[140:143], a[60:63], v[156:159]
s_waitcnt lgkmcnt(1)
v_mul_f32 v46, s68, v46
v_mul_f32 v47, s68, v47
v_mfma_f32_16x16x32_bf16 v[164:167], a[128:131], a[0:3], v[164:167]
s_add_u32 s12, s8, 16777216
ds_read_b64_tr_b16 a[136:137], v25 offset:0
v_mul_f32 v108, s68, v108
v_mfma_f32_16x16x32_bf16 v[164:167], a[132:135], a[4:7], v[164:167]
s_mov_b32 s13, s9
v_mul_f32 v109, s68, v109
v_mul_f32 v110, s68, v110
v_mfma_f32_16x16x32_bf16 v[172:175], a[128:131], a[8:11], v[172:175]
s_mov_b32 s15, s11
ds_read_b64_tr_b16 a[138:139], v25 offset:2048
v_mul_f32 v111, s68, v111
v_mfma_f32_16x16x32_bf16 v[172:175], a[132:135], a[12:15], v[172:175]
v_cvt_pk_bf16_f32 v44, v44, v45
v_cvt_pk_bf16_f32 v45, v46, v47
v_mfma_f32_16x16x32_bf16 v[180:183], a[128:131], a[16:19], v[180:183]
ds_read_b64_tr_b16 a[140:141], v25 offset:16384
v_cvt_pk_bf16_f32 v46, v108, v109
v_mfma_f32_16x16x32_bf16 v[180:183], a[132:135], a[20:23], v[180:183]
v_cvt_pk_bf16_f32 v47, v110, v111
v_mul_f32 v52, s68, v52
v_mfma_f32_16x16x32_bf16 v[188:191], a[128:131], a[24:27], v[188:191]
ds_read_b64_tr_b16 a[142:143], v25 offset:18432
v_mul_f32 v53, s68, v53
v_mfma_f32_16x16x32_bf16 v[188:191], a[132:135], a[28:31], v[188:191]
ds_write_b128 v28, v[44:47] offset:8192
v_mul_f32 v54, s68, v54
v_mfma_f32_16x16x32_bf16 v[196:199], a[128:131], a[32:35], v[196:199]
s_add_u32 s23, s67, 8192
buffer_store_dwordx4 v[44:47], v1, s[4:7], s23 offen offset:0 sc1
v_mfma_f32_16x16x32_bf16 v[196:199], a[132:135], a[36:39], v[196:199]
v_mul_f32 v55, s68, v55
v_mul_f32 v116, s68, v116
v_mfma_f32_16x16x32_bf16 v[204:207], a[128:131], a[40:43], v[204:207]
v_mul_f32 v117, s68, v117
v_mul_f32 v118, s68, v118
v_mfma_f32_16x16x32_bf16 v[204:207], a[132:135], a[44:47], v[204:207]
v_mul_f32 v119, s68, v119
v_cvt_pk_bf16_f32 v52, v52, v53
v_mfma_f32_16x16x32_bf16 v[212:215], a[128:131], a[48:51], v[212:215]
v_cvt_pk_bf16_f32 v53, v54, v55
v_cvt_pk_bf16_f32 v54, v116, v117
v_mfma_f32_16x16x32_bf16 v[212:215], a[132:135], a[52:55], v[212:215]
v_cvt_pk_bf16_f32 v55, v118, v119
v_mul_f32 v60, s68, v60
v_mfma_f32_16x16x32_bf16 v[220:223], a[128:131], a[56:59], v[220:223]
ds_write_b128 v28, v[52:55] offset:16384
v_mul_f32 v61, s68, v61
v_mfma_f32_16x16x32_bf16 v[220:223], a[132:135], a[60:63], v[220:223]
s_waitcnt lgkmcnt(0)
s_waitcnt lgkmcnt(0)
s_barrier
v_mfma_f32_16x16x32_bf16 v[224:227], a[136:139], a[0:3], v[224:227]
s_add_u32 s23, s67, 16384
buffer_store_dwordx4 v[52:55], v1, s[4:7], s23 offen offset:0 sc1
v_mfma_f32_16x16x32_bf16 v[224:227], a[140:143], a[4:7], v[224:227]
v_mul_f32 v62, s68, v62
v_mul_f32 v63, s68, v63
v_mfma_f32_16x16x32_bf16 v[228:231], a[136:139], a[8:11], v[228:231]
v_mul_f32 v124, s68, v124
v_mul_f32 v125, s68, v125
v_mfma_f32_16x16x32_bf16 v[228:231], a[140:143], a[12:15], v[228:231]
v_mul_f32 v126, s68, v126
v_mul_f32 v127, s68, v127
v_mfma_f32_16x16x32_bf16 v[232:235], a[136:139], a[16:19], v[232:235]
v_cvt_pk_bf16_f32 v60, v60, v61
v_cvt_pk_bf16_f32 v61, v62, v63
v_mfma_f32_16x16x32_bf16 v[232:235], a[140:143], a[20:23], v[232:235]
v_cvt_pk_bf16_f32 v62, v124, v125
v_cvt_pk_bf16_f32 v63, v126, v127
v_mfma_f32_16x16x32_bf16 v[236:239], a[136:139], a[24:27], v[236:239]
ds_write_b128 v28, v[60:63] offset:24576
v_mul_f32 v68, s68, v68
v_mfma_f32_16x16x32_bf16 v[236:239], a[140:143], a[28:31], v[236:239]
s_add_u32 s23, s67, 24576
buffer_store_dwordx4 v[60:63], v1, s[4:7], s23 offen offset:0 sc1
v_mfma_f32_16x16x32_bf16 v[240:243], a[136:139], a[32:35], v[240:243]
v_mul_f32 v69, s68, v69
v_mul_f32 v70, s68, v70
v_mfma_f32_16x16x32_bf16 v[240:243], a[140:143], a[36:39], v[240:243]
v_mul_f32 v71, s68, v71
v_mul_f32 v132, s68, v132
v_mfma_f32_16x16x32_bf16 v[244:247], a[136:139], a[40:43], v[244:247]
v_mul_f32 v133, s68, v133
v_mul_f32 v134, s68, v134
v_mfma_f32_16x16x32_bf16 v[244:247], a[140:143], a[44:47], v[244:247]
v_mul_f32 v135, s68, v135
v_cvt_pk_bf16_f32 v68, v68, v69
v_mfma_f32_16x16x32_bf16 v[248:251], a[136:139], a[48:51], v[248:251]
v_cvt_pk_bf16_f32 v69, v70, v71
v_cvt_pk_bf16_f32 v70, v132, v133
v_mfma_f32_16x16x32_bf16 v[248:251], a[140:143], a[52:55], v[248:251]
v_cvt_pk_bf16_f32 v71, v134, v135
v_mfma_f32_16x16x32_bf16 v[252:255], a[136:139], a[56:59], v[252:255]
ds_write_b128 v28, v[68:71] offset:32768
v_mfma_f32_16x16x32_bf16 v[252:255], a[140:143], a[60:63], v[252:255]
s_add_u32 s23, s67, 32768
buffer_store_dwordx4 v[68:71], v1, s[4:7], s23 offen offset:0 sc1
buffer_load_dword v21, v20, s[4:7], s70 offen sc1
v_pk_mul_f32 v[76:77], v[76:77], s[68:69]
v_pk_mul_f32 v[78:79], v[78:79], s[68:69]
v_pk_mul_f32 v[140:141], v[140:141], s[68:69]
v_pk_mul_f32 v[142:143], v[142:143], s[68:69]
v_cvt_pk_bf16_f32 v76, v76, v77
v_cvt_pk_bf16_f32 v77, v78, v79
v_cvt_pk_bf16_f32 v78, v140, v141
v_cvt_pk_bf16_f32 v79, v142, v143
ds_write_b128 v28, v[76:79] offset:40960
s_add_u32 s23, s67, 40960
buffer_store_dwordx4 v[76:79], v1, s[4:7], s23 offen offset:0 sc1
v_pk_mul_f32 v[84:85], v[84:85], s[68:69]
v_pk_mul_f32 v[86:87], v[86:87], s[68:69]
v_pk_mul_f32 v[148:149], v[148:149], s[68:69]
v_pk_mul_f32 v[150:151], v[150:151], s[68:69]
v_cvt_pk_bf16_f32 v84, v84, v85
v_cvt_pk_bf16_f32 v85, v86, v87
v_cvt_pk_bf16_f32 v86, v148, v149
v_cvt_pk_bf16_f32 v87, v150, v151
ds_write_b128 v28, v[84:87] offset:49152
s_add_u32 s23, s67, 49152
buffer_store_dwordx4 v[84:87], v1, s[4:7], s23 offen offset:0 sc1
v_pk_mul_f32 v[92:93], v[92:93], s[68:69]
v_pk_mul_f32 v[94:95], v[94:95], s[68:69]
v_pk_mul_f32 v[156:157], v[156:157], s[68:69]
v_pk_mul_f32 v[158:159], v[158:159], s[68:69]
v_cvt_pk_bf16_f32 v92, v92, v93
v_cvt_pk_bf16_f32 v93, v94, v95
v_cvt_pk_bf16_f32 v94, v156, v157
v_cvt_pk_bf16_f32 v95, v158, v159
ds_write_b128 v28, v[92:95] offset:57344
s_add_u32 s23, s67, 57344
buffer_store_dwordx4 v[92:95], v1, s[4:7], s23 offen offset:0 sc1
v_pk_mul_f32 v[164:165], v[164:165], s[68:69]
v_pk_mul_f32 v[166:167], v[166:167], s[68:69]
v_pk_mul_f32 v[224:225], v[224:225], s[68:69]
v_pk_mul_f32 v[226:227], v[226:227], s[68:69]
v_cvt_pk_bf16_f32 v164, v164, v165
v_cvt_pk_bf16_f32 v165, v166, v167
v_cvt_pk_bf16_f32 v166, v224, v225
v_cvt_pk_bf16_f32 v167, v226, v227
ds_write_b128 v28, v[164:167] offset:1024
s_add_u32 s23, s67, 0
buffer_store_dwordx4 v[164:167], v1, s[4:7], s23 offen offset:1024 sc1
v_pk_mul_f32 v[172:173], v[172:173], s[68:69]
v_pk_mul_f32 v[174:175], v[174:175], s[68:69]
v_pk_mul_f32 v[228:229], v[228:229], s[68:69]
v_pk_mul_f32 v[230:231], v[230:231], s[68:69]
v_cvt_pk_bf16_f32 v172, v172, v173
v_cvt_pk_bf16_f32 v173, v174, v175
v_cvt_pk_bf16_f32 v174, v228, v229
v_cvt_pk_bf16_f32 v175, v230, v231
ds_write_b128 v28, v[172:175] offset:9216
s_add_u32 s23, s67, 8192
buffer_store_dwordx4 v[172:175], v1, s[4:7], s23 offen offset:1024 sc1
v_pk_mul_f32 v[180:181], v[180:181], s[68:69]
v_pk_mul_f32 v[182:183], v[182:183], s[68:69]
v_pk_mul_f32 v[232:233], v[232:233], s[68:69]
v_pk_mul_f32 v[234:235], v[234:235], s[68:69]
v_cvt_pk_bf16_f32 v180, v180, v181
v_cvt_pk_bf16_f32 v181, v182, v183
v_cvt_pk_bf16_f32 v182, v232, v233
v_cvt_pk_bf16_f32 v183, v234, v235
ds_write_b128 v28, v[180:183] offset:17408
s_add_u32 s23, s67, 16384
buffer_store_dwordx4 v[180:183], v1, s[4:7], s23 offen offset:1024 sc1
v_pk_mul_f32 v[188:189], v[188:189], s[68:69]
v_pk_mul_f32 v[190:191], v[190:191], s[68:69]
v_pk_mul_f32 v[236:237], v[236:237], s[68:69]
v_pk_mul_f32 v[238:239], v[238:239], s[68:69]
v_cvt_pk_bf16_f32 v188, v188, v189
v_cvt_pk_bf16_f32 v189, v190, v191
v_cvt_pk_bf16_f32 v190, v236, v237
v_cvt_pk_bf16_f32 v191, v238, v239
ds_write_b128 v28, v[188:191] offset:25600
s_add_u32 s23, s67, 24576
buffer_store_dwordx4 v[188:191], v1, s[4:7], s23 offen offset:1024 sc1
v_pk_mul_f32 v[196:197], v[196:197], s[68:69]
v_pk_mul_f32 v[198:199], v[198:199], s[68:69]
v_pk_mul_f32 v[240:241], v[240:241], s[68:69]
v_pk_mul_f32 v[242:243], v[242:243], s[68:69]
PAD_8:
s_cbranch_execz M_tret
v_cvt_pk_bf16_f32 v196, v196, v197
v_cvt_pk_bf16_f32 v197, v198, v199
v_cvt_pk_bf16_f32 v198, v240, v241
v_cvt_pk_bf16_f32 v199, v242, v243
ds_write_b128 v28, v[196:199] offset:33792
s_add_u32 s23, s67, 32768
buffer_store_dwordx4 v[196:199], v1, s[4:7], s23 offen offset:1024 sc1
v_pk_mul_f32 v[204:205], v[204:205], s[68:69]
v_pk_mul_f32 v[206:207], v[206:207], s[68:69]
v_pk_mul_f32 v[244:245], v[244:245], s[68:69]
v_pk_mul_f32 v[246:247], v[246:247], s[68:69]
v_cvt_pk_bf16_f32 v204, v204, v205
v_cvt_pk_bf16_f32 v205, v206, v207
v_cvt_pk_bf16_f32 v206, v244, v245
v_cvt_pk_bf16_f32 v207, v246, v247
ds_write_b128 v28, v[204:207] offset:41984
s_add_u32 s23, s67, 40960
buffer_store_dwordx4 v[204:207], v1, s[4:7], s23 offen offset:1024 sc1
v_pk_mul_f32 v[212:213], v[212:213], s[68:69]
v_pk_mul_f32 v[214:215], v[214:215], s[68:69]
v_pk_mul_f32 v[248:249], v[248:249], s[68:69]
v_pk_mul_f32 v[250:251], v[250:251], s[68:69]
v_cvt_pk_bf16_f32 v212, v212, v213
v_cvt_pk_bf16_f32 v213, v214, v215
v_cvt_pk_bf16_f32 v214, v248, v249
v_cvt_pk_bf16_f32 v215, v250, v251
ds_write_b128 v28, v[212:215] offset:50176
s_add_u32 s23, s67, 49152
buffer_store_dwordx4 v[212:215], v1, s[4:7], s23 offen offset:1024 sc1
v_pk_mul_f32 v[220:221], v[220:221], s[68:69]
v_pk_mul_f32 v[222:223], v[222:223], s[68:69]
v_pk_mul_f32 v[252:253], v[252:253], s[68:69]
v_pk_mul_f32 v[254:255], v[254:255], s[68:69]
v_cvt_pk_bf16_f32 v220, v220, v221
v_cvt_pk_bf16_f32 v221, v222, v223
v_cvt_pk_bf16_f32 v222, v252, v253
v_cvt_pk_bf16_f32 v223, v254, v255
ds_write_b128 v28, v[220:223] offset:58368
s_add_u32 s23, s67, 57344
buffer_store_dwordx4 v[220:223], v1, s[4:7], s23 offen offset:1024 sc1
s_waitcnt vmcnt(11)
v_cmp_gt_u32 vcc, 1, v21
s_cbranch_vccnz M_kspin
M_kok:
buffer_load_dword v21, v15, s[4:7], s70 offen sc1
s_mov_b32 m0, s84
s_nop 0
buffer_load_dwordx4 v1, s[4:7], s8 offen offset:0 sc1 lds
buffer_load_dwordx4 v1, s[4:7], s8 offen offset:1024 sc1 lds
buffer_load_dwordx4 v1, s[4:7], s8 offen offset:2048 sc1 lds
buffer_load_dwordx4 v1, s[4:7], s8 offen offset:3072 sc1 lds
s_add_u32 s8, s8, 4096
s_add_u32 m0, s84, 4096
s_nop 0
buffer_load_dwordx4 v1, s[4:7], s8 offen offset:0 sc1 lds
buffer_load_dwordx4 v1, s[4:7], s8 offen offset:1024 sc1 lds
buffer_load_dwordx4 v1, s[4:7], s8 offen offset:2048 sc1 lds
buffer_load_dwordx4 v1, s[4:7], s8 offen offset:3072 sc1 lds
s_add_u32 s8, s8, 28672
s_sub_u32 s9, s9, 1
s_cmp_eq_u32 s9, 0
s_cselect_b32 s8, s10, s8
s_cselect_b32 s9, s11, s9
s_cselect_b32 s10, 3221225472, s10
v_add_u32 v28, s18, v2
s_waitcnt lgkmcnt(0)
s_barrier
ds_read_b128 a[0:3], v28 offset:0
ds_read_b128 a[4:7], v28 offset:1024
ds_read_b128 a[8:11], v28 offset:2048
ds_read_b128 a[12:15], v28 offset:3072
ds_read_b128 a[16:19], v28 offset:4096
ds_read_b128 a[20:23], v28 offset:5120
ds_read_b128 a[24:27], v28 offset:6144
ds_read_b128 a[28:31], v28 offset:7168
ds_read_b128 a[32:35], v28 offset:32768
ds_read_b128 a[36:39], v28 offset:33792
ds_read_b128 a[40:43], v28 offset:34816
ds_read_b128 a[44:47], v28 offset:35840
ds_read_b128 a[48:51], v28 offset:36864
ds_read_b128 a[52:55], v28 offset:37888
ds_read_b128 a[56:59], v28 offset:38912
ds_read_b128 a[60:63], v28 offset:39936
s_mov_b32 m0, s85
s_nop 0
buffer_load_dwordx4 v1, s[4:7], s8 offen offset:0 sc1 lds
buffer_load_dwordx4 v1, s[4:7], s8 offen offset:1024 sc1 lds
buffer_load_dwordx4 v1, s[4:7], s8 offen offset:2048 sc1 lds
buffer_load_dwordx4 v1, s[4:7], s8 offen offset:3072 sc1 lds
s_add_u32 s8, s8, 4096
s_add_u32 m0, s85, 4096
s_nop 0
buffer_load_dwordx4 v1, s[4:7], s8 offen offset:0 sc1 lds
buffer_load_dwordx4 v1, s[4:7], s8 offen offset:1024 sc1 lds
buffer_load_dwordx4 v1, s[4:7], s8 offen offset:2048 sc1 lds
buffer_load_dwordx4 v1, s[4:7], s8 offen offset:3072 sc1 lds
s_add_u32 s8, s8, 28672
s_sub_u32 s9, s9, 1
s_cmp_eq_u32 s9, 0
s_cselect_b32 s8, s10, s8
s_cselect_b32 s9, s11, s9
s_cselect_b32 s10, 3221225472, s10
s_mov_b32 s25, 1266679808
s_lshl_b32 s22, s21, 3
s_xor_b32 s28, s70, 256
s_add_u32 s28, s28, s22
s_add_u32 s28, s28, 6148
s_lshl_b32 s26, s21, 16
s_add_u32 s26, s26, s30
s_add_u32 s26, s26, 33554432
s_xor_b32 s76, s20, 0
s_lshl_b32 s76, s76, 3
s_add_u32 s76, s76, s21
s_lshl_b32 s76, s76, 2
s_add_u32 s76, s76, s3
s_lshl_b32 s27, s76, 10
s_add_u32 s27, s27, 75497472
s_lshl_b32 s76, s76, 14
s_add_u32 s76, s76, 67108864
s_lshl_b32 s81, s20, 2
s_add_u32 s81, s81, s3
s_mul_i32 s81, s81, 57344
s_cmp_eq_u32 s24, 1
s_cselect_b32 s80, s28, s70
s_add_u32 s77, s76, 8192
v_lshrrev_b32 v8, 7, v1
v_and_b32 v9, 6, v8
v_lshlrev_b32 v9, 4, v9
v_and_b32 v10, 0x70, v1
v_xor_b32 v9, v9, v10
v_mul_u32_u24 v8, 896, v8
v_add_u32 v8, v8, v9
v_accvgpr_write_b32 a184, v8
v_add_u32 v8, 6144, v8
v_accvgpr_write_b32 a185, v8
v_add_u32 v8, 6144, v8
v_accvgpr_write_b32 a186, v8
v_add_u32 v8, 6144, v8
v_accvgpr_write_b32 a187, v8
v_lshrrev_b32 v8, 6, v1
v_bfe_u32 v9, v1, 7, 2
v_lshlrev_b32 v9, 5, v9
v_lshl_add_u32 v8, v8, 7, v9
v_bfe_u32 v9, v1, 4, 2
v_lshl_add_u32 v8, v9, 3, v8
v_add_u32 v8, 32768, v8
v_accvgpr_write_b32 a188, v8
v_xor_b32 v9, 32, v8
v_accvgpr_write_b32 a189, v9
v_xor_b32 v9, 64, v8
v_accvgpr_write_b32 a190, v9
v_xor_b32 v9, 96, v8
v_accvgpr_write_b32 a191, v9
s_add_u32 s22, s66, 16384
s_mov_b32 s71, 3221225472
s_waitcnt vmcnt(17)
s_barrier
buffer_store_dword v6, v5, s[4:7], s22 offen sc1
v_mov_b64 v[128:129], 0
v_mov_b64 v[130:131], 0
v_mov_b64 v[132:133], 0
v_mov_b64 v[134:135], 0
v_mov_b64 v[136:137], 0
v_mov_b64 v[138:139], 0
v_mov_b64 v[140:141], 0
v_mov_b64 v[142:143], 0
v_mov_b64 v[144:145], 0
v_mov_b64 v[146:147], 0
v_mov_b64 v[148:149], 0
v_mov_b64 v[150:151], 0
v_mov_b64 v[152:153], 0
v_mov_b64 v[154:155], 0
v_mov_b64 v[156:157], 0
v_mov_b64 v[158:159], 0
v_mov_b64 v[160:161], 0
v_mov_b64 v[162:163], 0
v_mov_b64 v[164:165], 0
v_mov_b64 v[166:167], 0
v_mov_b64 v[168:169], 0
v_mov_b64 v[170:171], 0
v_mov_b64 v[172:173], 0
v_mov_b64 v[174:175], 0
v_mov_b64 v[176:177], 0
v_mov_b64 v[178:179], 0
v_mov_b64 v[180:181], 0
v_mov_b64 v[182:183], 0
v_mov_b64 v[184:185], 0
v_mov_b64 v[186:187], 0
v_mov_b64 v[188:189], 0
v_mov_b64 v[190:191], 0
v_mov_b64 v[192:193], 0
v_mov_b64 v[194:195], 0
v_mov_b64 v[196:197], 0
v_mov_b64 v[198:199], 0
v_mov_b64 v[200:201], 0
v_mov_b64 v[202:203], 0
v_mov_b64 v[204:205], 0
v_mov_b64 v[206:207], 0
v_mov_b64 v[208:209], 0
v_mov_b64 v[210:211], 0
v_mov_b64 v[212:213], 0
v_mov_b64 v[214:215], 0
v_mov_b64 v[216:217], 0
v_mov_b64 v[218:219], 0
v_mov_b64 v[220:221], 0
v_mov_b64 v[222:223], 0
v_mov_b64 v[224:225], 0
v_mov_b64 v[226:227], 0
v_mov_b64 v[228:229], 0
v_mov_b64 v[230:231], 0
v_mov_b64 v[232:233], 0
v_mov_b64 v[234:235], 0
v_mov_b64 v[236:237], 0
v_mov_b64 v[238:239], 0
v_mov_b64 v[240:241], 0
v_mov_b64 v[242:243], 0
v_mov_b64 v[244:245], 0
v_mov_b64 v[246:247], 0
v_mov_b64 v[248:249], 0
v_mov_b64 v[250:251], 0
v_mov_b64 v[252:253], 0
v_mov_b64 v[254:255], 0
v_mov_b64 v[24:25], 0
s_cmp_eq_u32 s24, 9
s_cbranch_scc1 M_t2A
M_t2Ar:
s_waitcnt vmcnt(9) lgkmcnt(0)
v_cmp_gt_u32 vcc, 1, v21
s_cbranch_vccnz M_vspin
M_vok:
s_barrier
K2_item:
PAD_9:
s_cbranch_execz M_tret
s_cmp_eq_u32 s19, 0
s_cbranch_scc1 K2_p0d
ds_read_b128 a[64:67], v1 offset:0
ds_read_b128 a[68:71], v1 offset:1024
ds_read_b128 a[72:75], v1 offset:2048
ds_read_b128 a[76:79], v1 offset:3072
ds_read_b128 a[80:83], v1 offset:4096
ds_read_b128 a[84:87], v1 offset:5120
ds_read_b128 a[88:91], v1 offset:6144
ds_read_b128 a[92:95], v1 offset:7168
s_waitcnt lgkmcnt(7)
v_mfma_f32_16x16x32_bf16 v[32:35], a[64:67], a[0:3], 0
s_waitcnt lgkmcnt(6)
s_add_u32 m0, s18, 65536
ds_read_b128 a[96:99], v1 offset:8192
v_mfma_f32_16x16x32_bf16 v[32:35], a[68:71], a[4:7], v[32:35]
s_waitcnt lgkmcnt(6)
buffer_load_dwordx4 v1, s[4:7], s12 offen offset:0 sc1 lds
v_mfma_f32_16x16x32_bf16 v[32:35], a[72:75], a[8:11], v[32:35]
s_waitcnt lgkmcnt(5)
ds_read_b128 a[100:103], v1 offset:9216
v_mfma_f32_16x16x32_bf16 v[32:35], a[76:79], a[12:15], v[32:35]
s_waitcnt lgkmcnt(5)
buffer_load_dwordx4 v1, s[4:7], s12 offen offset:1024 sc1 lds
v_mfma_f32_16x16x32_bf16 v[32:35], a[80:83], a[16:19], v[32:35]
s_waitcnt lgkmcnt(4)
ds_read_b128 a[104:107], v1 offset:10240
v_mfma_f32_16x16x32_bf16 v[32:35], a[84:87], a[20:23], v[32:35]
s_waitcnt lgkmcnt(4)
buffer_load_dwordx4 v1, s[4:7], s12 offen offset:2048 sc1 lds
v_mfma_f32_16x16x32_bf16 v[32:35], a[88:91], a[24:27], v[32:35]
s_waitcnt lgkmcnt(3)
ds_read_b128 a[108:111], v1 offset:11264
v_mfma_f32_16x16x32_bf16 v[32:35], a[92:95], a[28:31], v[32:35]
buffer_load_dwordx4 v1, s[4:7], s12 offen offset:3072 sc1 lds
v_mfma_f32_16x16x32_bf16 v[36:39], a[64:67], a[32:35], 0
s_add_u32 s12, s12, 4096
s_add_u32 m0, s18, 69632
ds_read_b128 a[112:115], v1 offset:12288
v_mfma_f32_16x16x32_bf16 v[36:39], a[68:71], a[36:39], v[36:39]
buffer_load_dwordx4 v1, s[4:7], s12 offen offset:0 sc1 lds
v_mfma_f32_16x16x32_bf16 v[36:39], a[72:75], a[40:43], v[36:39]
ds_read_b128 a[116:119], v1 offset:13312
v_mfma_f32_16x16x32_bf16 v[36:39], a[76:79], a[44:47], v[36:39]
buffer_load_dwordx4 v1, s[4:7], s12 offen offset:1024 sc1 lds
v_mfma_f32_16x16x32_bf16 v[36:39], a[80:83], a[48:51], v[36:39]
ds_read_b128 a[120:123], v1 offset:14336
v_max3_f32 v28, v32, v33, v34
v_mfma_f32_16x16x32_bf16 v[36:39], a[84:87], a[52:55], v[36:39]
buffer_load_dwordx4 v1, s[4:7], s12 offen offset:2048 sc1 lds
v_mfma_f32_16x16x32_bf16 v[36:39], a[88:91], a[56:59], v[36:39]
ds_read_b128 a[124:127], v1 offset:15360
v_max_f32 v28, v28, v35
v_mfma_f32_16x16x32_bf16 v[36:39], a[92:95], a[60:63], v[36:39]
s_waitcnt lgkmcnt(4)
buffer_load_dwordx4 v1, s[4:7], s12 offen offset:3072 sc1 lds
v_mfma_f32_16x16x32_bf16 v[40:43], a[96:99], a[0:3], 0
s_add_u32 s12, s12, 28672
ds_read_b128 a[64:67], v1 offset:16384
v_mov_b32 v30, v28
v_mfma_f32_16x16x32_bf16 v[40:43], a[100:103], a[4:7], v[40:43]
s_waitcnt lgkmcnt(2)
s_sub_u32 s13, s13, 1
v_mfma_f32_16x16x32_bf16 v[40:43], a[104:107], a[8:11], v[40:43]
s_cmp_eq_u32 s13, 0
ds_read_b128 a[68:71], v1 offset:17408
v_permlane16_swap_b32 v28, v30
v_mfma_f32_16x16x32_bf16 v[40:43], a[108:111], a[12:15], v[40:43]
s_cselect_b32 s12, s14, s12
v_max_f32 v28, v28, v30
v_mov_b32 v30, v28
v_mfma_f32_16x16x32_bf16 v[40:43], a[112:115], a[16:19], v[40:43]
s_cselect_b32 s13, s15, s13
ds_read_b128 a[72:75], v1 offset:18432
v_max3_f32 v29, v36, v37, v38
v_mfma_f32_16x16x32_bf16 v[40:43], a[116:119], a[20:23], v[40:43]
s_cselect_b32 s14, 3221225472, s14
v_permlane32_swap_b32 v28, v30
v_max_f32 v28, v28, v30
v_mfma_f32_16x16x32_bf16 v[40:43], a[120:123], a[24:27], v[40:43]
s_waitcnt lgkmcnt(3)
ds_read_b128 a[76:79], v1 offset:19456
v_sub_f32 v16, 0, v28
v_mfma_f32_16x16x32_bf16 v[40:43], a[124:127], a[28:31], v[40:43]
v_sub_f32 v17, 0, v28
v_sub_f32 v18, 0, v28
v_mfma_f32_16x16x32_bf16 v[44:47], a[96:99], a[32:35], 0
ds_read_b128 a[80:83], v1 offset:20480
v_sub_f32 v19, 0, v28
v_mfma_f32_16x16x32_bf16 v[44:47], a[100:103], a[36:39], v[44:47]
v_max_f32 v29, v29, v39
v_mov_b32 v31, v29
v_mfma_f32_16x16x32_bf16 v[44:47], a[104:107], a[40:43], v[44:47]
ds_read_b128 a[84:87], v1 offset:21504
v_mfma_f32_16x16x32_bf16 v[44:47], a[108:111], a[44:47], v[44:47]
v_permlane16_swap_b32 v29, v31
v_max_f32 v29, v29, v31
v_mfma_f32_16x16x32_bf16 v[44:47], a[112:115], a[48:51], v[44:47]
ds_read_b128 a[88:91], v1 offset:22528
v_mov_b32 v31, v29
v_mfma_f32_16x16x32_bf16 v[44:47], a[116:119], a[52:55], v[44:47]
v_mfma_f32_16x16x32_bf16 v[44:47], a[120:123], a[56:59], v[44:47]
ds_read_b128 a[92:95], v1 offset:23552
v_permlane32_swap_b32 v29, v31
v_mfma_f32_16x16x32_bf16 v[44:47], a[124:127], a[60:63], v[44:47]
s_waitcnt lgkmcnt(4)
v_max_f32 v29, v29, v31
v_sub_f32 v20, 0, v29
v_mfma_f32_16x16x32_bf16 v[48:51], a[64:67], a[0:3], v[16:19]
ds_read_b128 a[96:99], v1 offset:24576
v_sub_f32 v21, 0, v29
v_mfma_f32_16x16x32_bf16 v[48:51], a[68:71], a[4:7], v[48:51]
v_sub_f32 v22, 0, v29
v_sub_f32 v23, 0, v29
v_mfma_f32_16x16x32_bf16 v[48:51], a[72:75], a[8:11], v[48:51]
ds_read_b128 a[100:103], v1 offset:25600
v_mfma_f32_16x16x32_bf16 v[48:51], a[76:79], a[12:15], v[48:51]
s_waitcnt lgkmcnt(4)
v_mfma_f32_16x16x32_bf16 v[48:51], a[80:83], a[16:19], v[48:51]
ds_read_b128 a[104:107], v1 offset:26624
v_mfma_f32_16x16x32_bf16 v[48:51], a[84:87], a[20:23], v[48:51]
s_waitcnt lgkmcnt(4)
v_add_f32 v32, v32, v16
v_add_f32 v33, v33, v16
v_add_f32 v34, v34, v16
v_add_f32 v35, v35, v16
v_mfma_f32_16x16x32_bf16 v[48:51], a[88:91], a[24:27], v[48:51]
s_waitcnt lgkmcnt(3)
ds_read_b128 a[108:111], v1 offset:27648
v_add_f32 v36, v36, v20
v_add_f32 v37, v37, v20
v_add_f32 v38, v38, v20
v_add_f32 v39, v39, v20
v_mfma_f32_16x16x32_bf16 v[48:51], a[92:95], a[28:31], v[48:51]
v_add_f32 v40, v40, v16
v_add_f32 v41, v41, v16
v_add_f32 v42, v42, v16
v_add_f32 v43, v43, v16
v_mfma_f32_16x16x32_bf16 v[52:55], a[64:67], a[32:35], v[20:23]
ds_read_b128 a[112:115], v1 offset:28672
v_add_f32 v44, v44, v20
v_add_f32 v45, v45, v20
v_add_f32 v46, v46, v20
v_add_f32 v47, v47, v20
v_mfma_f32_16x16x32_bf16 v[52:55], a[68:71], a[36:39], v[52:55]
v_exp_f32 v8, v32
v_mfma_f32_16x16x32_bf16 v[52:55], a[72:75], a[40:43], v[52:55]
ds_read_b128 a[116:119], v1 offset:29696
v_exp_f32 v9, v33
v_mfma_f32_16x16x32_bf16 v[52:55], a[76:79], a[44:47], v[52:55]
v_exp_f32 v10, v34
v_add_f32 v26, v8, v9
v_cvt_pk_bf16_f32 v96, v8, v9
v_mfma_f32_16x16x32_bf16 v[52:55], a[80:83], a[48:51], v[52:55]
ds_read_b128 a[120:123], v1 offset:30720
v_exp_f32 v11, v35
v_add_f32 v26, v26, v10
v_mfma_f32_16x16x32_bf16 v[52:55], a[84:87], a[52:55], v[52:55]
v_exp_f32 v12, v36
v_add_f32 v26, v26, v11
v_cvt_pk_bf16_f32 v97, v10, v11
v_mfma_f32_16x16x32_bf16 v[52:55], a[88:91], a[56:59], v[52:55]
s_waitcnt vmcnt(8) lgkmcnt(4)
ds_read_b128 a[124:127], v1 offset:31744
v_exp_f32 v13, v37
v_mfma_f32_16x16x32_bf16 v[52:55], a[92:95], a[60:63], v[52:55]
s_barrier
v_mfma_f32_16x16x32_bf16 v[56:59], a[96:99], a[0:3], v[16:19]
ds_read_b128 a[64:67], v4 offset:0
v_exp_f32 v14, v38
v_mfma_f32_16x16x32_bf16 v[56:59], a[100:103], a[4:7], v[56:59]
buffer_store_dword v6, v5, s[4:7], s71 offen sc1
v_mfma_f32_16x16x32_bf16 v[56:59], a[104:107], a[8:11], v[56:59]
s_waitcnt lgkmcnt(4)
ds_read_b128 a[68:71], v4 offset:1024
v_add_f32 v27, v12, v13
v_cvt_pk_bf16_f32 v104, v12, v13
v_add_f32 v27, v27, v14
v_mfma_f32_16x16x32_bf16 v[56:59], a[108:111], a[12:15], v[56:59]
v_exp_f32 v15, v39
v_mfma_f32_16x16x32_bf16 v[56:59], a[112:115], a[16:19], v[56:59]
s_waitcnt lgkmcnt(4)
ds_read_b128 a[72:75], v4 offset:2048
v_exp_f32 v8, v40
v_add_f32 v27, v27, v15
v_cvt_pk_bf16_f32 v105, v14, v15
v_mfma_f32_16x16x32_bf16 v[56:59], a[116:119], a[20:23], v[56:59]
s_waitcnt lgkmcnt(4)
v_exp_f32 v9, v41
v_add_f32 v26, v26, v8
v_mfma_f32_16x16x32_bf16 v[56:59], a[120:123], a[24:27], v[56:59]
s_waitcnt lgkmcnt(3)
ds_read_b128 a[76:79], v4 offset:3072
v_exp_f32 v10, v42
v_add_f32 v26, v26, v9
v_cvt_pk_bf16_f32 v98, v8, v9
v_mfma_f32_16x16x32_bf16 v[56:59], a[124:127], a[28:31], v[56:59]
v_exp_f32 v11, v43
v_add_f32 v26, v26, v10
v_mfma_f32_16x16x32_bf16 v[60:63], a[96:99], a[32:35], v[20:23]
ds_read_b128 a[80:83], v4 offset:4096
v_exp_f32 v12, v44
v_mfma_f32_16x16x32_bf16 v[60:63], a[100:103], a[36:39], v[60:63]
v_exp_f32 v13, v45
v_mfma_f32_16x16x32_bf16 v[60:63], a[104:107], a[40:43], v[60:63]
ds_read_b128 a[84:87], v4 offset:5120
v_exp_f32 v14, v46
v_mfma_f32_16x16x32_bf16 v[60:63], a[108:111], a[44:47], v[60:63]
v_exp_f32 v15, v47
v_mfma_f32_16x16x32_bf16 v[60:63], a[112:115], a[48:51], v[60:63]
ds_read_b128 a[88:91], v4 offset:6144
v_add_f32 v26, v26, v11
v_cvt_pk_bf16_f32 v99, v10, v11
v_mfma_f32_16x16x32_bf16 v[60:63], a[116:119], a[52:55], v[60:63]
v_add_f32 v27, v27, v12
v_add_f32 v27, v27, v13
v_cvt_pk_bf16_f32 v106, v12, v13
v_mfma_f32_16x16x32_bf16 v[60:63], a[120:123], a[56:59], v[60:63]
s_waitcnt lgkmcnt(7)
s_barrier
ds_read_b128 a[92:95], v4 offset:7168
v_mfma_f32_16x16x32_bf16 v[60:63], a[124:127], a[60:63], v[60:63]
s_waitcnt lgkmcnt(4)
v_add_f32 v27, v27, v14
v_add_f32 v27, v27, v15
v_cvt_pk_bf16_f32 v107, v14, v15
K2_x1:
v_mfma_f32_16x16x32_bf16 v[64:67], a[64:67], a[0:3], v[16:19]
s_add_u32 m0, s18, 0
ds_read_b128 a[96:99], v4 offset:8192
v_mfma_f32_16x16x32_bf16 v[64:67], a[68:71], a[4:7], v[64:67]
s_waitcnt lgkmcnt(4)
buffer_load_dwordx4 v1, s[4:7], s8 offen offset:0 sc1 lds
v_mfma_f32_16x16x32_bf16 v[64:67], a[72:75], a[8:11], v[64:67]
ds_read_b128 a[100:103], v4 offset:9216
v_mfma_f32_16x16x32_bf16 v[64:67], a[76:79], a[12:15], v[64:67]
s_waitcnt lgkmcnt(4)
v_exp_f32 v8, v48
v_mfma_f32_16x16x32_bf16 v[64:67], a[80:83], a[16:19], v[64:67]
ds_read_b128 a[104:107], v4 offset:10240
v_add_f32 v26, v26, v8
v_mfma_f32_16x16x32_bf16 v[64:67], a[84:87], a[20:23], v[64:67]
s_waitcnt lgkmcnt(4)
buffer_load_dwordx4 v1, s[4:7], s8 offen offset:1024 sc1 lds
v_mfma_f32_16x16x32_bf16 v[64:67], a[88:91], a[24:27], v[64:67]
s_waitcnt lgkmcnt(3)
ds_read_b128 a[108:111], v4 offset:11264
v_mfma_f32_16x16x32_bf16 v[64:67], a[92:95], a[28:31], v[64:67]
v_exp_f32 v9, v49
v_mfma_f32_16x16x32_bf16 v[68:71], a[64:67], a[32:35], v[20:23]
ds_read_b128 a[112:115], v4 offset:12288
v_add_f32 v26, v26, v9
v_mfma_f32_16x16x32_bf16 v[68:71], a[68:71], a[36:39], v[68:71]
buffer_load_dwordx4 v1, s[4:7], s8 offen offset:2048 sc1 lds
v_mfma_f32_16x16x32_bf16 v[68:71], a[72:75], a[40:43], v[68:71]
ds_read_b128 a[116:119], v4 offset:13312
v_cvt_pk_bf16_f32 v100, v8, v9
v_mfma_f32_16x16x32_bf16 v[68:71], a[76:79], a[44:47], v[68:71]
v_exp_f32 v10, v50
v_mfma_f32_16x16x32_bf16 v[68:71], a[80:83], a[48:51], v[68:71]
ds_read_b128 a[120:123], v4 offset:14336
v_add_f32 v26, v26, v10
v_mfma_f32_16x16x32_bf16 v[68:71], a[84:87], a[52:55], v[68:71]
buffer_load_dwordx4 v1, s[4:7], s8 offen offset:3072 sc1 lds
v_mfma_f32_16x16x32_bf16 v[68:71], a[88:91], a[56:59], v[68:71]
s_add_u32 s8, s8, 4096
ds_read_b128 a[124:127], v4 offset:15360
v_mfma_f32_16x16x32_bf16 v[68:71], a[92:95], a[60:63], v[68:71]
s_waitcnt lgkmcnt(4)
v_exp_f32 v11, v51
v_mfma_f32_16x16x32_bf16 v[72:75], a[96:99], a[0:3], v[16:19]
s_add_u32 m0, s18, 4096
ds_read_b128 a[64:67], v4 offset:16384
v_add_f32 v26, v26, v11
v_mfma_f32_16x16x32_bf16 v[72:75], a[100:103], a[4:7], v[72:75]
buffer_load_dwordx4 v1, s[4:7], s8 offen offset:0 sc1 lds
v_mfma_f32_16x16x32_bf16 v[72:75], a[104:107], a[8:11], v[72:75]
ds_read_b128 a[68:71], v4 offset:17408
v_cvt_pk_bf16_f32 v101, v10, v11
v_mfma_f32_16x16x32_bf16 v[72:75], a[108:111], a[12:15], v[72:75]
s_waitcnt lgkmcnt(4)
v_mfma_f32_16x16x32_bf16 v[72:75], a[112:115], a[16:19], v[72:75]
ds_read_b128 a[72:75], v4 offset:18432
v_mfma_f32_16x16x32_bf16 v[72:75], a[116:119], a[20:23], v[72:75]
s_waitcnt lgkmcnt(4)
buffer_load_dwordx4 v1, s[4:7], s8 offen offset:1024 sc1 lds
v_mfma_f32_16x16x32_bf16 v[72:75], a[120:123], a[24:27], v[72:75]
s_waitcnt lgkmcnt(3)
ds_read_b128 a[76:79], v4 offset:19456
v_mfma_f32_16x16x32_bf16 v[72:75], a[124:127], a[28:31], v[72:75]
v_exp_f32 v12, v52
v_mfma_f32_16x16x32_bf16 v[76:79], a[96:99], a[32:35], v[20:23]
ds_read_b128 a[80:83], v4 offset:20480
v_add_f32 v27, v27, v12
v_mfma_f32_16x16x32_bf16 v[76:79], a[100:103], a[36:39], v[76:79]
buffer_load_dwordx4 v1, s[4:7], s8 offen offset:2048 sc1 lds
v_mfma_f32_16x16x32_bf16 v[76:79], a[104:107], a[40:43], v[76:79]
ds_read_b128 a[84:87], v4 offset:21504
v_mfma_f32_16x16x32_bf16 v[76:79], a[108:111], a[44:47], v[76:79]
v_exp_f32 v13, v53
v_mfma_f32_16x16x32_bf16 v[76:79], a[112:115], a[48:51], v[76:79]
ds_read_b128 a[88:91], v4 offset:22528
v_add_f32 v27, v27, v13
v_mfma_f32_16x16x32_bf16 v[76:79], a[116:119], a[52:55], v[76:79]
s_waitcnt lgkmcnt(3)
buffer_load_dwordx4 v1, s[4:7], s8 offen offset:3072 sc1 lds
v_mfma_f32_16x16x32_bf16 v[76:79], a[120:123], a[56:59], v[76:79]
s_add_u32 s8, s8, 28672
ds_read_b128 a[92:95], v4 offset:23552
v_cvt_pk_bf16_f32 v108, v12, v13
v_mfma_f32_16x16x32_bf16 v[76:79], a[124:127], a[60:63], v[76:79]
s_sub_u32 s9, s9, 1
v_exp_f32 v14, v54
v_mfma_f32_16x16x32_bf16 v[80:83], a[64:67], a[0:3], v[16:19]
s_cmp_eq_u32 s9, 0
ds_read_b128 a[96:99], v4 offset:24576
v_add_f32 v27, v27, v14
v_mfma_f32_16x16x32_bf16 v[80:83], a[68:71], a[4:7], v[80:83]
s_cselect_b32 s8, s10, s8
v_exp_f32 v15, v55
v_mfma_f32_16x16x32_bf16 v[80:83], a[72:75], a[8:11], v[80:83]
s_cselect_b32 s9, s11, s9
ds_read_b128 a[100:103], v4 offset:25600
v_add_f32 v27, v27, v15
v_mfma_f32_16x16x32_bf16 v[80:83], a[76:79], a[12:15], v[80:83]
s_waitcnt lgkmcnt(4)
s_cselect_b32 s10, 3221225472, s10
v_cvt_pk_bf16_f32 v109, v14, v15
v_mfma_f32_16x16x32_bf16 v[80:83], a[80:83], a[16:19], v[80:83]
ds_read_b128 a[104:107], v4 offset:26624
v_mfma_f32_16x16x32_bf16 v[80:83], a[84:87], a[20:23], v[80:83]
s_waitcnt lgkmcnt(4)
v_exp_f32 v8, v56
v_mfma_f32_16x16x32_bf16 v[80:83], a[88:91], a[24:27], v[80:83]
s_waitcnt lgkmcnt(3)
ds_read_b128 a[108:111], v4 offset:27648
v_add_f32 v26, v26, v8
v_mfma_f32_16x16x32_bf16 v[80:83], a[92:95], a[28:31], v[80:83]
v_exp_f32 v9, v57
v_mfma_f32_16x16x32_bf16 v[84:87], a[64:67], a[32:35], v[20:23]
ds_read_b128 a[112:115], v4 offset:28672
v_add_f32 v26, v26, v9
v_mfma_f32_16x16x32_bf16 v[84:87], a[68:71], a[36:39], v[84:87]
v_exp_f32 v10, v58
v_mfma_f32_16x16x32_bf16 v[84:87], a[72:75], a[40:43], v[84:87]
ds_read_b128 a[116:119], v4 offset:29696
v_cvt_pk_bf16_f32 v102, v8, v9
v_mfma_f32_16x16x32_bf16 v[84:87], a[76:79], a[44:47], v[84:87]
v_exp_f32 v11, v59
v_mfma_f32_16x16x32_bf16 v[84:87], a[80:83], a[48:51], v[84:87]
ds_read_b128 a[120:123], v4 offset:30720
v_add_f32 v26, v26, v10
v_mfma_f32_16x16x32_bf16 v[84:87], a[84:87], a[52:55], v[84:87]
v_add_f32 v26, v26, v11
v_cvt_pk_bf16_f32 v103, v10, v11
v_mfma_f32_16x16x32_bf16 v[84:87], a[88:91], a[56:59], v[84:87]
s_waitcnt vmcnt(8) lgkmcnt(4)
ds_read_b128 a[124:127], v4 offset:31744
v_mfma_f32_16x16x32_bf16 v[84:87], a[92:95], a[60:63], v[84:87]
s_barrier
v_mfma_f32_16x16x32_bf16 v[88:91], a[96:99], a[0:3], v[16:19]
ds_read_b128 a[64:67], v2 offset:0
v_mfma_f32_16x16x32_bf16 v[88:91], a[100:103], a[4:7], v[88:91]
v_exp_f32 v12, v60
v_mfma_f32_16x16x32_bf16 v[88:91], a[104:107], a[8:11], v[88:91]
s_waitcnt lgkmcnt(4)
ds_read_b128 a[68:71], v2 offset:1024
v_add_f32 v27, v27, v12
v_mfma_f32_16x16x32_bf16 v[88:91], a[108:111], a[12:15], v[88:91]
v_exp_f32 v13, v61
v_mfma_f32_16x16x32_bf16 v[88:91], a[112:115], a[16:19], v[88:91]
s_waitcnt lgkmcnt(4)
ds_read_b128 a[72:75], v2 offset:2048
v_add_f32 v27, v27, v13
v_mfma_f32_16x16x32_bf16 v[88:91], a[116:119], a[20:23], v[88:91]
s_waitcnt lgkmcnt(4)
v_exp_f32 v14, v62
v_mfma_f32_16x16x32_bf16 v[88:91], a[120:123], a[24:27], v[88:91]
s_waitcnt lgkmcnt(3)
ds_read_b128 a[76:79], v2 offset:3072
v_cvt_pk_bf16_f32 v110, v12, v13
v_mfma_f32_16x16x32_bf16 v[88:91], a[124:127], a[28:31], v[88:91]
v_exp_f32 v15, v63
v_mfma_f32_16x16x32_bf16 v[92:95], a[96:99], a[32:35], v[20:23]
s_sub_u32 s19, s19, 1
ds_read_b128 a[80:83], v2 offset:4096
v_add_f32 v27, v27, v14
v_mfma_f32_16x16x32_bf16 v[92:95], a[100:103], a[36:39], v[92:95]
v_add_f32 v27, v27, v15
v_cvt_pk_bf16_f32 v111, v14, v15
v_mfma_f32_16x16x32_bf16 v[92:95], a[104:107], a[40:43], v[92:95]
ds_read_b128 a[84:87], v2 offset:5120
v_add_f32 v28, v26, v27
v_mfma_f32_16x16x32_bf16 v[92:95], a[108:111], a[44:47], v[92:95]
v_cmp_nge_f32 vcc, s25, v28
v_mfma_f32_16x16x32_bf16 v[92:95], a[112:115], a[48:51], v[92:95]
s_cmp_eq_u64 vcc, 0
ds_read_b128 a[88:91], v2 offset:6144
v_mfma_f32_16x16x32_bf16 v[92:95], a[116:119], a[52:55], v[92:95]
s_cselect_b32 s22, s19, 0
v_mfma_f32_16x16x32_bf16 v[92:95], a[120:123], a[56:59], v[92:95]
s_cmp_eq_u32 s22, 0
ds_read_b128 a[92:95], v2 offset:7168
v_mfma_f32_16x16x32_bf16 v[92:95], a[124:127], a[60:63], v[92:95]
s_waitcnt lgkmcnt(4)
s_cbranch_scc1 K2_xexit
K2_loop:
v_mfma_f32_16x16x32_bf16 v[128:131], a[64:67], v[96:99], v[128:131]
s_add_u32 m0, s18, 98304
ds_read_b128 a[96:99], v2 offset:8192
v_add_f32 v24, v24, v26
v_mfma_f32_16x16x32_bf16 v[128:131], a[68:71], v[100:103], v[128:131]
buffer_load_dwordx4 v1, s[4:7], s12 offen offset:0 sc1 lds
v_mfma_f32_16x16x32_bf16 v[132:135], a[68:71], v[108:111], v[132:135]
ds_read_b128 a[100:103], v2 offset:9216
v_add_f32 v25, v25, v27
v_mfma_f32_16x16x32_bf16 v[132:135], a[64:67], v[104:107], v[132:135]
v_exp_f32 v8, v64
v_mfma_f32_16x16x32_bf16 v[136:139], a[72:75], v[96:99], v[136:139]
ds_read_b128 a[104:107], v2 offset:10240
v_mfma_f32_16x16x32_bf16 v[136:139], a[76:79], v[100:103], v[136:139]
buffer_load_dwordx4 v1, s[4:7], s12 offen offset:1024 sc1 lds
v_mfma_f32_16x16x32_bf16 v[140:143], a[76:79], v[108:111], v[140:143]
ds_read_b128 a[108:111], v2 offset:11264
v_mfma_f32_16x16x32_bf16 v[140:143], a[72:75], v[104:107], v[140:143]
s_waitcnt lgkmcnt(4)
v_exp_f32 v9, v65
v_mfma_f32_16x16x32_bf16 v[144:147], a[80:83], v[96:99], v[144:147]
ds_read_b128 a[112:115], v2 offset:12288
v_add_f32 v26, v8, v9
v_mfma_f32_16x16x32_bf16 v[144:147], a[84:87], v[100:103], v[144:147]
PAD_10:
s_cbranch_execz M_tret
buffer_load_dwordx4 v1, s[4:7], s12 offen offset:2048 sc1 lds
v_mfma_f32_16x16x32_bf16 v[148:151], a[84:87], v[108:111], v[148:151]
ds_read_b128 a[116:119], v2 offset:13312
v_cvt_pk_bf16_f32 v112, v8, v9
v_mfma_f32_16x16x32_bf16 v[148:151], a[80:83], v[104:107], v[148:151]
v_exp_f32 v10, v66
v_mfma_f32_16x16x32_bf16 v[152:155], a[88:91], v[96:99], v[152:155]
ds_read_b128 a[120:123], v2 offset:14336
v_add_f32 v26, v26, v10
v_mfma_f32_16x16x32_bf16 v[152:155], a[92:95], v[100:103], v[152:155]
buffer_load_dwordx4 v1, s[4:7], s12 offen offset:3072 sc1 lds
v_mfma_f32_16x16x32_bf16 v[156:159], a[92:95], v[108:111], v[156:159]
s_add_u32 s12, s12, 4096
ds_read_b128 a[124:127], v2 offset:15360
v_mfma_f32_16x16x32_bf16 v[156:159], a[88:91], v[104:107], v[156:159]
s_waitcnt lgkmcnt(4)
v_exp_f32 v11, v67
v_mfma_f32_16x16x32_bf16 v[160:163], a[96:99], v[96:99], v[160:163]
s_add_u32 m0, s18, 102400
ds_read_b128 a[64:67], v2 offset:16384
v_add_f32 v26, v26, v11
v_mfma_f32_16x16x32_bf16 v[160:163], a[100:103], v[100:103], v[160:163]
buffer_load_dwordx4 v1, s[4:7], s12 offen offset:0 sc1 lds
v_mfma_f32_16x16x32_bf16 v[164:167], a[100:103], v[108:111], v[164:167]
ds_read_b128 a[68:71], v2 offset:17408
v_cvt_pk_bf16_f32 v113, v10, v11
v_mfma_f32_16x16x32_bf16 v[164:167], a[96:99], v[104:107], v[164:167]
v_mfma_f32_16x16x32_bf16 v[168:171], a[104:107], v[96:99], v[168:171]
ds_read_b128 a[72:75], v2 offset:18432
v_mfma_f32_16x16x32_bf16 v[168:171], a[108:111], v[100:103], v[168:171]
buffer_load_dwordx4 v1, s[4:7], s12 offen offset:1024 sc1 lds
v_mfma_f32_16x16x32_bf16 v[172:175], a[108:111], v[108:111], v[172:175]
ds_read_b128 a[76:79], v2 offset:19456
v_mfma_f32_16x16x32_bf16 v[172:175], a[104:107], v[104:107], v[172:175]
s_waitcnt lgkmcnt(4)
v_exp_f32 v12, v68
v_mfma_f32_16x16x32_bf16 v[176:179], a[112:115], v[96:99], v[176:179]
ds_read_b128 a[80:83], v2 offset:20480
v_mfma_f32_16x16x32_bf16 v[176:179], a[116:119], v[100:103], v[176:179]
buffer_load_dwordx4 v1, s[4:7], s12 offen offset:2048 sc1 lds
v_mfma_f32_16x16x32_bf16 v[180:183], a[116:119], v[108:111], v[180:183]
ds_read_b128 a[84:87], v2 offset:21504
v_mfma_f32_16x16x32_bf16 v[180:183], a[112:115], v[104:107], v[180:183]
v_exp_f32 v13, v69
v_mfma_f32_16x16x32_bf16 v[184:187], a[120:123], v[96:99], v[184:187]
ds_read_b128 a[88:91], v2 offset:22528
v_add_f32 v27, v12, v13
v_mfma_f32_16x16x32_bf16 v[184:187], a[124:127], v[100:103], v[184:187]
s_waitcnt lgkmcnt(4)
buffer_load_dwordx4 v1, s[4:7], s12 offen offset:3072 sc1 lds
v_mfma_f32_16x16x32_bf16 v[188:191], a[124:127], v[108:111], v[188:191]
s_add_u32 s12, s12, 28672
ds_read_b128 a[92:95], v2 offset:23552
v_cvt_pk_bf16_f32 v120, v12, v13
v_mfma_f32_16x16x32_bf16 v[188:191], a[120:123], v[104:107], v[188:191]
s_sub_u32 s13, s13, 1
v_exp_f32 v14, v70
v_mfma_f32_16x16x32_bf16 v[192:195], a[64:67], v[96:99], v[192:195]
s_cmp_eq_u32 s13, 0
ds_read_b128 a[96:99], v2 offset:24576
v_add_f32 v27, v27, v14
v_mfma_f32_16x16x32_bf16 v[192:195], a[68:71], v[100:103], v[192:195]
s_cselect_b32 s12, s14, s12
v_mfma_f32_16x16x32_bf16 v[196:199], a[68:71], v[108:111], v[196:199]
s_cselect_b32 s13, s15, s13
ds_read_b128 a[100:103], v2 offset:25600
v_mfma_f32_16x16x32_bf16 v[196:199], a[64:67], v[104:107], v[196:199]
s_cselect_b32 s14, 3221225472, s14
v_exp_f32 v15, v71
v_mfma_f32_16x16x32_bf16 v[200:203], a[72:75], v[96:99], v[200:203]
s_waitcnt lgkmcnt(4)
ds_read_b128 a[104:107], v2 offset:26624
v_add_f32 v27, v27, v15
v_mfma_f32_16x16x32_bf16 v[200:203], a[76:79], v[100:103], v[200:203]
v_exp_f32 v8, v72
v_mfma_f32_16x16x32_bf16 v[204:207], a[76:79], v[108:111], v[204:207]
ds_read_b128 a[108:111], v2 offset:27648
v_cvt_pk_bf16_f32 v121, v14, v15
v_mfma_f32_16x16x32_bf16 v[204:207], a[72:75], v[104:107], v[204:207]
v_exp_f32 v9, v73
v_mfma_f32_16x16x32_bf16 v[208:211], a[80:83], v[96:99], v[208:211]
ds_read_b128 a[112:115], v2 offset:28672
v_add_f32 v26, v26, v8
v_mfma_f32_16x16x32_bf16 v[208:211], a[84:87], v[100:103], v[208:211]
v_add_f32 v26, v26, v9
v_cvt_pk_bf16_f32 v114, v8, v9
v_mfma_f32_16x16x32_bf16 v[212:215], a[84:87], v[108:111], v[212:215]
ds_read_b128 a[116:119], v2 offset:29696
v_mfma_f32_16x16x32_bf16 v[212:215], a[80:83], v[104:107], v[212:215]
s_waitcnt lgkmcnt(4)
v_exp_f32 v10, v74
v_mfma_f32_16x16x32_bf16 v[216:219], a[88:91], v[96:99], v[216:219]
ds_read_b128 a[120:123], v2 offset:30720
v_add_f32 v26, v26, v10
v_mfma_f32_16x16x32_bf16 v[216:219], a[92:95], v[100:103], v[216:219]
v_exp_f32 v11, v75
v_mfma_f32_16x16x32_bf16 v[220:223], a[92:95], v[108:111], v[220:223]
s_waitcnt vmcnt(8)
ds_read_b128 a[124:127], v2 offset:31744
v_add_f32 v26, v26, v11
v_mfma_f32_16x16x32_bf16 v[220:223], a[88:91], v[104:107], v[220:223]
s_barrier
v_mfma_f32_16x16x32_bf16 v[224:227], a[96:99], v[96:99], v[224:227]
ds_read_b128 a[64:67], v1 offset:0
v_cvt_pk_bf16_f32 v115, v10, v11
v_mfma_f32_16x16x32_bf16 v[224:227], a[100:103], v[100:103], v[224:227]
v_exp_f32 v12, v76
v_mfma_f32_16x16x32_bf16 v[228:231], a[100:103], v[108:111], v[228:231]
ds_read_b128 a[68:71], v1 offset:1024
v_add_f32 v27, v27, v12
v_mfma_f32_16x16x32_bf16 v[228:231], a[96:99], v[104:107], v[228:231]
s_waitcnt lgkmcnt(4)
v_mfma_f32_16x16x32_bf16 v[232:235], a[104:107], v[96:99], v[232:235]
ds_read_b128 a[72:75], v1 offset:2048
v_mfma_f32_16x16x32_bf16 v[232:235], a[108:111], v[100:103], v[232:235]
v_exp_f32 v13, v77
v_mfma_f32_16x16x32_bf16 v[236:239], a[108:111], v[108:111], v[236:239]
ds_read_b128 a[76:79], v1 offset:3072
v_add_f32 v27, v27, v13
v_mfma_f32_16x16x32_bf16 v[236:239], a[104:107], v[104:107], v[236:239]
v_exp_f32 v14, v78
v_mfma_f32_16x16x32_bf16 v[240:243], a[112:115], v[96:99], v[240:243]
ds_read_b128 a[80:83], v1 offset:4096
v_cvt_pk_bf16_f32 v122, v12, v13
v_mfma_f32_16x16x32_bf16 v[240:243], a[116:119], v[100:103], v[240:243]
v_exp_f32 v15, v79
v_mfma_f32_16x16x32_bf16 v[244:247], a[116:119], v[108:111], v[244:247]
ds_read_b128 a[84:87], v1 offset:5120
v_add_f32 v27, v27, v14
v_mfma_f32_16x16x32_bf16 v[244:247], a[112:115], v[104:107], v[244:247]
s_waitcnt lgkmcnt(4)
v_add_f32 v27, v27, v15
v_cvt_pk_bf16_f32 v123, v14, v15
v_mfma_f32_16x16x32_bf16 v[248:251], a[120:123], v[96:99], v[248:251]
ds_read_b128 a[88:91], v1 offset:6144
v_mfma_f32_16x16x32_bf16 v[248:251], a[124:127], v[100:103], v[248:251]
v_mfma_f32_16x16x32_bf16 v[252:255], a[124:127], v[108:111], v[252:255]
ds_read_b128 a[92:95], v1 offset:7168
v_mfma_f32_16x16x32_bf16 v[252:255], a[120:123], v[104:107], v[252:255]
K2_x0:
v_mfma_f32_16x16x32_bf16 v[32:35], a[64:67], a[0:3], v[16:19]
s_add_u32 m0, s18, 131072
ds_read_b128 a[96:99], v1 offset:8192
v_mfma_f32_16x16x32_bf16 v[32:35], a[68:71], a[4:7], v[32:35]
s_waitcnt lgkmcnt(4)
buffer_load_dwordx4 v1, s[4:7], s8 offen offset:0 sc1 lds
v_mfma_f32_16x16x32_bf16 v[32:35], a[72:75], a[8:11], v[32:35]
ds_read_b128 a[100:103], v1 offset:9216
v_mfma_f32_16x16x32_bf16 v[32:35], a[76:79], a[12:15], v[32:35]
v_exp_f32 v8, v80
v_mfma_f32_16x16x32_bf16 v[32:35], a[80:83], a[16:19], v[32:35]
s_waitcnt lgkmcnt(4)
ds_read_b128 a[104:107], v1 offset:10240
v_add_f32 v26, v26, v8
v_mfma_f32_16x16x32_bf16 v[32:35], a[84:87], a[20:23], v[32:35]
s_waitcnt lgkmcnt(4)
buffer_load_dwordx4 v1, s[4:7], s8 offen offset:1024 sc1 lds
v_mfma_f32_16x16x32_bf16 v[32:35], a[88:91], a[24:27], v[32:35]
s_waitcnt lgkmcnt(3)
ds_read_b128 a[108:111], v1 offset:11264
v_mfma_f32_16x16x32_bf16 v[32:35], a[92:95], a[28:31], v[32:35]
v_exp_f32 v9, v81
v_mfma_f32_16x16x32_bf16 v[36:39], a[64:67], a[32:35], v[20:23]
ds_read_b128 a[112:115], v1 offset:12288
v_add_f32 v26, v26, v9
v_mfma_f32_16x16x32_bf16 v[36:39], a[68:71], a[36:39], v[36:39]
buffer_load_dwordx4 v1, s[4:7], s8 offen offset:2048 sc1 lds
v_mfma_f32_16x16x32_bf16 v[36:39], a[72:75], a[40:43], v[36:39]
ds_read_b128 a[116:119], v1 offset:13312
v_cvt_pk_bf16_f32 v116, v8, v9
v_mfma_f32_16x16x32_bf16 v[36:39], a[76:79], a[44:47], v[36:39]
v_exp_f32 v10, v82
v_mfma_f32_16x16x32_bf16 v[36:39], a[80:83], a[48:51], v[36:39]
ds_read_b128 a[120:123], v1 offset:14336
v_add_f32 v26, v26, v10
v_mfma_f32_16x16x32_bf16 v[36:39], a[84:87], a[52:55], v[36:39]
buffer_load_dwordx4 v1, s[4:7], s8 offen offset:3072 sc1 lds
v_mfma_f32_16x16x32_bf16 v[36:39], a[88:91], a[56:59], v[36:39]
s_add_u32 s8, s8, 4096
ds_read_b128 a[124:127], v1 offset:15360
v_mfma_f32_16x16x32_bf16 v[36:39], a[92:95], a[60:63], v[36:39]
s_waitcnt lgkmcnt(4)
v_exp_f32 v11, v83
v_mfma_f32_16x16x32_bf16 v[40:43], a[96:99], a[0:3], v[16:19]
s_add_u32 m0, s18, 135168
ds_read_b128 a[64:67], v1 offset:16384
v_add_f32 v26, v26, v11
v_mfma_f32_16x16x32_bf16 v[40:43], a[100:103], a[4:7], v[40:43]
buffer_load_dwordx4 v1, s[4:7], s8 offen offset:0 sc1 lds
v_mfma_f32_16x16x32_bf16 v[40:43], a[104:107], a[8:11], v[40:43]
ds_read_b128 a[68:71], v1 offset:17408
v_cvt_pk_bf16_f32 v117, v10, v11
v_mfma_f32_16x16x32_bf16 v[40:43], a[108:111], a[12:15], v[40:43]
s_waitcnt lgkmcnt(4)
v_mfma_f32_16x16x32_bf16 v[40:43], a[112:115], a[16:19], v[40:43]
ds_read_b128 a[72:75], v1 offset:18432
v_mfma_f32_16x16x32_bf16 v[40:43], a[116:119], a[20:23], v[40:43]
s_waitcnt lgkmcnt(4)
buffer_load_dwordx4 v1, s[4:7], s8 offen offset:1024 sc1 lds
v_mfma_f32_16x16x32_bf16 v[40:43], a[120:123], a[24:27], v[40:43]
s_waitcnt lgkmcnt(3)
ds_read_b128 a[76:79], v1 offset:19456
v_mfma_f32_16x16x32_bf16 v[40:43], a[124:127], a[28:31], v[40:43]
v_exp_f32 v12, v84
v_mfma_f32_16x16x32_bf16 v[44:47], a[96:99], a[32:35], v[20:23]
ds_read_b128 a[80:83], v1 offset:20480
v_add_f32 v27, v27, v12
v_mfma_f32_16x16x32_bf16 v[44:47], a[100:103], a[36:39], v[44:47]
buffer_load_dwordx4 v1, s[4:7], s8 offen offset:2048 sc1 lds
v_mfma_f32_16x16x32_bf16 v[44:47], a[104:107], a[40:43], v[44:47]
ds_read_b128 a[84:87], v1 offset:21504
v_mfma_f32_16x16x32_bf16 v[44:47], a[108:111], a[44:47], v[44:47]
v_exp_f32 v13, v85
v_mfma_f32_16x16x32_bf16 v[44:47], a[112:115], a[48:51], v[44:47]
ds_read_b128 a[88:91], v1 offset:22528
v_add_f32 v27, v27, v13
v_mfma_f32_16x16x32_bf16 v[44:47], a[116:119], a[52:55], v[44:47]
s_waitcnt lgkmcnt(3)
buffer_load_dwordx4 v1, s[4:7], s8 offen offset:3072 sc1 lds
v_mfma_f32_16x16x32_bf16 v[44:47], a[120:123], a[56:59], v[44:47]
s_add_u32 s8, s8, 28672
ds_read_b128 a[92:95], v1 offset:23552
v_cvt_pk_bf16_f32 v124, v12, v13
v_mfma_f32_16x16x32_bf16 v[44:47], a[124:127], a[60:63], v[44:47]
s_sub_u32 s9, s9, 1
v_exp_f32 v14, v86
v_mfma_f32_16x16x32_bf16 v[48:51], a[64:67], a[0:3], v[16:19]
s_cmp_eq_u32 s9, 0
ds_read_b128 a[96:99], v1 offset:24576
v_add_f32 v27, v27, v14
v_mfma_f32_16x16x32_bf16 v[48:51], a[68:71], a[4:7], v[48:51]
s_cselect_b32 s8, s10, s8
v_exp_f32 v15, v87
v_mfma_f32_16x16x32_bf16 v[48:51], a[72:75], a[8:11], v[48:51]
s_cselect_b32 s9, s11, s9
ds_read_b128 a[100:103], v1 offset:25600
v_add_f32 v27, v27, v15
v_mfma_f32_16x16x32_bf16 v[48:51], a[76:79], a[12:15], v[48:51]
s_waitcnt lgkmcnt(4)
s_cselect_b32 s10, 3221225472, s10
v_cvt_pk_bf16_f32 v125, v14, v15
v_mfma_f32_16x16x32_bf16 v[48:51], a[80:83], a[16:19], v[48:51]
ds_read_b128 a[104:107], v1 offset:26624
v_mfma_f32_16x16x32_bf16 v[48:51], a[84:87], a[20:23], v[48:51]
s_waitcnt lgkmcnt(4)
v_exp_f32 v8, v88
v_mfma_f32_16x16x32_bf16 v[48:51], a[88:91], a[24:27], v[48:51]
s_waitcnt lgkmcnt(3)
ds_read_b128 a[108:111], v1 offset:27648
v_add_f32 v26, v26, v8
v_mfma_f32_16x16x32_bf16 v[48:51], a[92:95], a[28:31], v[48:51]
v_exp_f32 v9, v89
v_mfma_f32_16x16x32_bf16 v[52:55], a[64:67], a[32:35], v[20:23]
ds_read_b128 a[112:115], v1 offset:28672
v_add_f32 v26, v26, v9
v_mfma_f32_16x16x32_bf16 v[52:55], a[68:71], a[36:39], v[52:55]
v_exp_f32 v10, v90
v_mfma_f32_16x16x32_bf16 v[52:55], a[72:75], a[40:43], v[52:55]
ds_read_b128 a[116:119], v1 offset:29696
v_cvt_pk_bf16_f32 v118, v8, v9
v_mfma_f32_16x16x32_bf16 v[52:55], a[76:79], a[44:47], v[52:55]
v_exp_f32 v11, v91
v_mfma_f32_16x16x32_bf16 v[52:55], a[80:83], a[48:51], v[52:55]
ds_read_b128 a[120:123], v1 offset:30720
v_add_f32 v26, v26, v10
v_mfma_f32_16x16x32_bf16 v[52:55], a[84:87], a[52:55], v[52:55]
v_add_f32 v26, v26, v11
v_cvt_pk_bf16_f32 v119, v10, v11
v_mfma_f32_16x16x32_bf16 v[52:55], a[88:91], a[56:59], v[52:55]
s_waitcnt vmcnt(8) lgkmcnt(4)
ds_read_b128 a[124:127], v1 offset:31744
v_mfma_f32_16x16x32_bf16 v[52:55], a[92:95], a[60:63], v[52:55]
s_barrier
v_mfma_f32_16x16x32_bf16 v[56:59], a[96:99], a[0:3], v[16:19]
ds_read_b128 a[64:67], v2 offset:32768
v_mfma_f32_16x16x32_bf16 v[56:59], a[100:103], a[4:7], v[56:59]
v_exp_f32 v12, v92
v_mfma_f32_16x16x32_bf16 v[56:59], a[104:107], a[8:11], v[56:59]
s_waitcnt lgkmcnt(4)
ds_read_b128 a[68:71], v2 offset:33792
v_add_f32 v27, v27, v12
v_mfma_f32_16x16x32_bf16 v[56:59], a[108:111], a[12:15], v[56:59]
v_exp_f32 v13, v93
v_mfma_f32_16x16x32_bf16 v[56:59], a[112:115], a[16:19], v[56:59]
s_waitcnt lgkmcnt(4)
ds_read_b128 a[72:75], v2 offset:34816
v_add_f32 v27, v27, v13
v_mfma_f32_16x16x32_bf16 v[56:59], a[116:119], a[20:23], v[56:59]
s_waitcnt lgkmcnt(4)
v_exp_f32 v14, v94
v_mfma_f32_16x16x32_bf16 v[56:59], a[120:123], a[24:27], v[56:59]
s_waitcnt lgkmcnt(3)
ds_read_b128 a[76:79], v2 offset:35840
v_cvt_pk_bf16_f32 v126, v12, v13
v_mfma_f32_16x16x32_bf16 v[56:59], a[124:127], a[28:31], v[56:59]
v_exp_f32 v15, v95
v_mfma_f32_16x16x32_bf16 v[60:63], a[96:99], a[32:35], v[20:23]
ds_read_b128 a[80:83], v2 offset:36864
v_add_f32 v27, v27, v14
v_mfma_f32_16x16x32_bf16 v[60:63], a[100:103], a[36:39], v[60:63]
v_add_f32 v27, v27, v15
v_cvt_pk_bf16_f32 v127, v14, v15
v_mfma_f32_16x16x32_bf16 v[60:63], a[104:107], a[40:43], v[60:63]
ds_read_b128 a[84:87], v2 offset:37888
v_add_f32 v28, v26, v27
v_mfma_f32_16x16x32_bf16 v[60:63], a[108:111], a[44:47], v[60:63]
v_cmp_nge_f32 vcc, s25, v28
v_mfma_f32_16x16x32_bf16 v[60:63], a[112:115], a[48:51], v[60:63]
ds_read_b128 a[88:91], v2 offset:38912
v_mfma_f32_16x16x32_bf16 v[60:63], a[116:119], a[52:55], v[60:63]
v_mfma_f32_16x16x32_bf16 v[60:63], a[120:123], a[56:59], v[60:63]
ds_read_b128 a[92:95], v2 offset:39936
v_mfma_f32_16x16x32_bf16 v[60:63], a[124:127], a[60:63], v[60:63]
s_waitcnt lgkmcnt(4)
s_cbranch_vccnz Lstub_2
Lback_3:
v_mfma_f32_16x16x32_bf16 v[128:131], a[64:67], v[112:115], v[128:131]
s_add_u32 m0, s18, 65536
ds_read_b128 a[96:99], v2 offset:40960
v_add_f32 v24, v24, v26
v_mfma_f32_16x16x32_bf16 v[128:131], a[68:71], v[116:119], v[128:131]
buffer_load_dwordx4 v1, s[4:7], s12 offen offset:0 sc1 lds
v_mfma_f32_16x16x32_bf16 v[132:135], a[68:71], v[124:127], v[132:135]
ds_read_b128 a[100:103], v2 offset:41984
v_add_f32 v25, v25, v27
v_mfma_f32_16x16x32_bf16 v[132:135], a[64:67], v[120:123], v[132:135]
v_exp_f32 v8, v32
v_mfma_f32_16x16x32_bf16 v[136:139], a[72:75], v[112:115], v[136:139]
ds_read_b128 a[104:107], v2 offset:43008
v_mfma_f32_16x16x32_bf16 v[136:139], a[76:79], v[116:119], v[136:139]
buffer_load_dwordx4 v1, s[4:7], s12 offen offset:1024 sc1 lds
v_mfma_f32_16x16x32_bf16 v[140:143], a[76:79], v[124:127], v[140:143]
ds_read_b128 a[108:111], v2 offset:44032
v_mfma_f32_16x16x32_bf16 v[140:143], a[72:75], v[120:123], v[140:143]
s_waitcnt lgkmcnt(4)
v_exp_f32 v9, v33
v_mfma_f32_16x16x32_bf16 v[144:147], a[80:83], v[112:115], v[144:147]
ds_read_b128 a[112:115], v2 offset:45056
v_add_f32 v26, v8, v9
v_mfma_f32_16x16x32_bf16 v[144:147], a[84:87], v[116:119], v[144:147]
buffer_load_dwordx4 v1, s[4:7], s12 offen offset:2048 sc1 lds
v_mfma_f32_16x16x32_bf16 v[148:151], a[84:87], v[124:127], v[148:151]
ds_read_b128 a[116:119], v2 offset:46080
v_cvt_pk_bf16_f32 v96, v8, v9
v_mfma_f32_16x16x32_bf16 v[148:151], a[80:83], v[120:123], v[148:151]
v_exp_f32 v10, v34
v_mfma_f32_16x16x32_bf16 v[152:155], a[88:91], v[112:115], v[152:155]
ds_read_b128 a[120:123], v2 offset:47104
v_add_f32 v26, v26, v10
v_mfma_f32_16x16x32_bf16 v[152:155], a[92:95], v[116:119], v[152:155]
buffer_load_dwordx4 v1, s[4:7], s12 offen offset:3072 sc1 lds
v_mfma_f32_16x16x32_bf16 v[156:159], a[92:95], v[124:127], v[156:159]
s_add_u32 s12, s12, 4096
ds_read_b128 a[124:127], v2 offset:48128
v_mfma_f32_16x16x32_bf16 v[156:159], a[88:91], v[120:123], v[156:159]
s_waitcnt lgkmcnt(4)
v_exp_f32 v11, v35
v_mfma_f32_16x16x32_bf16 v[160:163], a[96:99], v[112:115], v[160:163]
s_add_u32 m0, s18, 69632
ds_read_b128 a[64:67], v2 offset:49152
v_add_f32 v26, v26, v11
v_mfma_f32_16x16x32_bf16 v[160:163], a[100:103], v[116:119], v[160:163]
buffer_load_dwordx4 v1, s[4:7], s12 offen offset:0 sc1 lds
v_mfma_f32_16x16x32_bf16 v[164:167], a[100:103], v[124:127], v[164:167]
ds_read_b128 a[68:71], v2 offset:50176
v_cvt_pk_bf16_f32 v97, v10, v11
v_mfma_f32_16x16x32_bf16 v[164:167], a[96:99], v[120:123], v[164:167]
v_mfma_f32_16x16x32_bf16 v[168:171], a[104:107], v[112:115], v[168:171]
ds_read_b128 a[72:75], v2 offset:51200
v_mfma_f32_16x16x32_bf16 v[168:171], a[108:111], v[116:119], v[168:171]
buffer_load_dwordx4 v1, s[4:7], s12 offen offset:1024 sc1 lds
v_mfma_f32_16x16x32_bf16 v[172:175], a[108:111], v[124:127], v[172:175]
ds_read_b128 a[76:79], v2 offset:52224
v_mfma_f32_16x16x32_bf16 v[172:175], a[104:107], v[120:123], v[172:175]
s_waitcnt lgkmcnt(4)
v_exp_f32 v12, v36
v_mfma_f32_16x16x32_bf16 v[176:179], a[112:115], v[112:115], v[176:179]
ds_read_b128 a[80:83], v2 offset:53248
v_mfma_f32_16x16x32_bf16 v[176:179], a[116:119], v[116:119], v[176:179]
buffer_load_dwordx4 v1, s[4:7], s12 offen offset:2048 sc1 lds
v_mfma_f32_16x16x32_bf16 v[180:183], a[116:119], v[124:127], v[180:183]
ds_read_b128 a[84:87], v2 offset:54272
v_mfma_f32_16x16x32_bf16 v[180:183], a[112:115], v[120:123], v[180:183]
v_exp_f32 v13, v37
v_mfma_f32_16x16x32_bf16 v[184:187], a[120:123], v[112:115], v[184:187]
ds_read_b128 a[88:91], v2 offset:55296
v_add_f32 v27, v12, v13
v_mfma_f32_16x16x32_bf16 v[184:187], a[124:127], v[116:119], v[184:187]
s_waitcnt lgkmcnt(4)
buffer_load_dwordx4 v1, s[4:7], s12 offen offset:3072 sc1 lds
v_mfma_f32_16x16x32_bf16 v[188:191], a[124:127], v[124:127], v[188:191]
s_add_u32 s12, s12, 28672
ds_read_b128 a[92:95], v2 offset:56320
v_cvt_pk_bf16_f32 v104, v12, v13
v_mfma_f32_16x16x32_bf16 v[188:191], a[120:123], v[120:123], v[188:191]
s_sub_u32 s13, s13, 1
v_exp_f32 v14, v38
v_mfma_f32_16x16x32_bf16 v[192:195], a[64:67], v[112:115], v[192:195]
s_cmp_eq_u32 s13, 0
ds_read_b128 a[96:99], v2 offset:57344
v_add_f32 v27, v27, v14
v_mfma_f32_16x16x32_bf16 v[192:195], a[68:71], v[116:119], v[192:195]
s_cselect_b32 s12, s14, s12
v_mfma_f32_16x16x32_bf16 v[196:199], a[68:71], v[124:127], v[196:199]
s_cselect_b32 s13, s15, s13
ds_read_b128 a[100:103], v2 offset:58368
v_mfma_f32_16x16x32_bf16 v[196:199], a[64:67], v[120:123], v[196:199]
s_cselect_b32 s14, 3221225472, s14
v_exp_f32 v15, v39
v_mfma_f32_16x16x32_bf16 v[200:203], a[72:75], v[112:115], v[200:203]
s_waitcnt lgkmcnt(4)
ds_read_b128 a[104:107], v2 offset:59392
v_add_f32 v27, v27, v15
v_mfma_f32_16x16x32_bf16 v[200:203], a[76:79], v[116:119], v[200:203]
v_exp_f32 v8, v40
v_mfma_f32_16x16x32_bf16 v[204:207], a[76:79], v[124:127], v[204:207]
ds_read_b128 a[108:111], v2 offset:60416
v_cvt_pk_bf16_f32 v105, v14, v15
v_mfma_f32_16x16x32_bf16 v[204:207], a[72:75], v[120:123], v[204:207]
v_exp_f32 v9, v41
v_mfma_f32_16x16x32_bf16 v[208:211], a[80:83], v[112:115], v[208:211]
ds_read_b128 a[112:115], v2 offset:61440
v_add_f32 v26, v26, v8
v_mfma_f32_16x16x32_bf16 v[208:211], a[84:87], v[116:119], v[208:211]
v_add_f32 v26, v26, v9
v_cvt_pk_bf16_f32 v98, v8, v9
v_mfma_f32_16x16x32_bf16 v[212:215], a[84:87], v[124:127], v[212:215]
ds_read_b128 a[116:119], v2 offset:62464
v_mfma_f32_16x16x32_bf16 v[212:215], a[80:83], v[120:123], v[212:215]
s_waitcnt lgkmcnt(4)
v_exp_f32 v10, v42
v_mfma_f32_16x16x32_bf16 v[216:219], a[88:91], v[112:115], v[216:219]
ds_read_b128 a[120:123], v2 offset:63488
v_add_f32 v26, v26, v10
v_mfma_f32_16x16x32_bf16 v[216:219], a[92:95], v[116:119], v[216:219]
v_exp_f32 v11, v43
v_mfma_f32_16x16x32_bf16 v[220:223], a[92:95], v[124:127], v[220:223]
s_waitcnt vmcnt(8)
ds_read_b128 a[124:127], v2 offset:64512
v_add_f32 v26, v26, v11
v_mfma_f32_16x16x32_bf16 v[220:223], a[88:91], v[120:123], v[220:223]
s_barrier
v_mfma_f32_16x16x32_bf16 v[224:227], a[96:99], v[112:115], v[224:227]
ds_read_b128 a[64:67], v4 offset:0
v_cvt_pk_bf16_f32 v99, v10, v11
v_mfma_f32_16x16x32_bf16 v[224:227], a[100:103], v[116:119], v[224:227]
v_exp_f32 v12, v44
v_mfma_f32_16x16x32_bf16 v[228:231], a[100:103], v[124:127], v[228:231]
ds_read_b128 a[68:71], v4 offset:1024
v_add_f32 v27, v27, v12
v_mfma_f32_16x16x32_bf16 v[228:231], a[96:99], v[120:123], v[228:231]
s_waitcnt lgkmcnt(4)
v_mfma_f32_16x16x32_bf16 v[232:235], a[104:107], v[112:115], v[232:235]
ds_read_b128 a[72:75], v4 offset:2048
v_mfma_f32_16x16x32_bf16 v[232:235], a[108:111], v[116:119], v[232:235]
v_exp_f32 v13, v45
v_mfma_f32_16x16x32_bf16 v[236:239], a[108:111], v[124:127], v[236:239]
ds_read_b128 a[76:79], v4 offset:3072
v_add_f32 v27, v27, v13
v_mfma_f32_16x16x32_bf16 v[236:239], a[104:107], v[120:123], v[236:239]
v_exp_f32 v14, v46
v_mfma_f32_16x16x32_bf16 v[240:243], a[112:115], v[112:115], v[240:243]
ds_read_b128 a[80:83], v4 offset:4096
v_cvt_pk_bf16_f32 v106, v12, v13
v_mfma_f32_16x16x32_bf16 v[240:243], a[116:119], v[116:119], v[240:243]
v_exp_f32 v15, v47
v_mfma_f32_16x16x32_bf16 v[244:247], a[116:119], v[124:127], v[244:247]
ds_read_b128 a[84:87], v4 offset:5120
v_add_f32 v27, v27, v14
v_mfma_f32_16x16x32_bf16 v[244:247], a[112:115], v[120:123], v[244:247]
s_waitcnt lgkmcnt(4)
v_add_f32 v27, v27, v15
v_cvt_pk_bf16_f32 v107, v14, v15
v_mfma_f32_16x16x32_bf16 v[248:251], a[120:123], v[112:115], v[248:251]
ds_read_b128 a[88:91], v4 offset:6144
v_mfma_f32_16x16x32_bf16 v[248:251], a[124:127], v[116:119], v[248:251]
v_mfma_f32_16x16x32_bf16 v[252:255], a[124:127], v[124:127], v[252:255]
s_waitcnt lgkmcnt(5)
ds_read_b128 a[92:95], v4 offset:7168
v_mfma_f32_16x16x32_bf16 v[252:255], a[120:123], v[120:123], v[252:255]
s_branch K2_x1
K2_xexit:
s_cbranch_vccnz Lstub_4
Lback_5:
s_cmp_lg_u32 s19, 0
s_cbranch_scc1 K2_loop
s_cmp_eq_u32 s24, 2
s_cbranch_scc1 K2_ntail
v_mfma_f32_16x16x32_bf16 v[128:131], a[64:67], v[96:99], v[128:131]
s_add_u32 m0, s18, 98304
ds_read_b128 a[96:99], v2 offset:8192
v_add_f32 v24, v24, v26
v_mfma_f32_16x16x32_bf16 v[128:131], a[68:71], v[100:103], v[128:131]
buffer_load_dwordx4 v1, s[4:7], s12 offen offset:0 sc1 lds
v_mfma_f32_16x16x32_bf16 v[132:135], a[68:71], v[108:111], v[132:135]
ds_read_b128 a[100:103], v2 offset:9216
v_add_f32 v25, v25, v27
v_mfma_f32_16x16x32_bf16 v[132:135], a[64:67], v[104:107], v[132:135]
v_exp_f32 v8, v64
v_mfma_f32_16x16x32_bf16 v[136:139], a[72:75], v[96:99], v[136:139]
ds_read_b128 a[104:107], v2 offset:10240
v_mfma_f32_16x16x32_bf16 v[136:139], a[76:79], v[100:103], v[136:139]
buffer_load_dwordx4 v1, s[4:7], s12 offen offset:1024 sc1 lds
v_mfma_f32_16x16x32_bf16 v[140:143], a[76:79], v[108:111], v[140:143]
ds_read_b128 a[108:111], v2 offset:11264
v_mfma_f32_16x16x32_bf16 v[140:143], a[72:75], v[104:107], v[140:143]
s_waitcnt lgkmcnt(4)
v_exp_f32 v9, v65
v_mfma_f32_16x16x32_bf16 v[144:147], a[80:83], v[96:99], v[144:147]
ds_read_b128 a[112:115], v2 offset:12288
v_add_f32 v26, v8, v9
v_mfma_f32_16x16x32_bf16 v[144:147], a[84:87], v[100:103], v[144:147]
buffer_load_dwordx4 v1, s[4:7], s12 offen offset:2048 sc1 lds
v_mfma_f32_16x16x32_bf16 v[148:151], a[84:87], v[108:111], v[148:151]
ds_read_b128 a[116:119], v2 offset:13312
v_cvt_pk_bf16_f32 v112, v8, v9
v_mfma_f32_16x16x32_bf16 v[148:151], a[80:83], v[104:107], v[148:151]
v_exp_f32 v10, v66
v_mfma_f32_16x16x32_bf16 v[152:155], a[88:91], v[96:99], v[152:155]
ds_read_b128 a[120:123], v2 offset:14336
v_add_f32 v26, v26, v10
v_mfma_f32_16x16x32_bf16 v[152:155], a[92:95], v[100:103], v[152:155]
buffer_load_dwordx4 v1, s[4:7], s12 offen offset:3072 sc1 lds
v_mfma_f32_16x16x32_bf16 v[156:159], a[92:95], v[108:111], v[156:159]
s_add_u32 s12, s12, 4096
ds_read_b128 a[124:127], v2 offset:15360
v_mfma_f32_16x16x32_bf16 v[156:159], a[88:91], v[104:107], v[156:159]
s_waitcnt lgkmcnt(4)
v_exp_f32 v11, v67
v_mfma_f32_16x16x32_bf16 v[160:163], a[96:99], v[96:99], v[160:163]
s_add_u32 m0, s18, 102400
ds_read_b128 a[64:67], v2 offset:16384
v_add_f32 v26, v26, v11
v_mfma_f32_16x16x32_bf16 v[160:163], a[100:103], v[100:103], v[160:163]
buffer_load_dwordx4 v1, s[4:7], s12 offen offset:0 sc1 lds
v_mfma_f32_16x16x32_bf16 v[164:167], a[100:103], v[108:111], v[164:167]
ds_read_b128 a[68:71], v2 offset:17408
v_cvt_pk_bf16_f32 v113, v10, v11
v_mfma_f32_16x16x32_bf16 v[164:167], a[96:99], v[104:107], v[164:167]
v_mfma_f32_16x16x32_bf16 v[168:171], a[104:107], v[96:99], v[168:171]
ds_read_b128 a[72:75], v2 offset:18432
v_mfma_f32_16x16x32_bf16 v[168:171], a[108:111], v[100:103], v[168:171]
buffer_load_dwordx4 v1, s[4:7], s12 offen offset:1024 sc1 lds
v_mfma_f32_16x16x32_bf16 v[172:175], a[108:111], v[108:111], v[172:175]
ds_read_b128 a[76:79], v2 offset:19456
v_mfma_f32_16x16x32_bf16 v[172:175], a[104:107], v[104:107], v[172:175]
s_waitcnt lgkmcnt(4)
v_exp_f32 v12, v68
v_mfma_f32_16x16x32_bf16 v[176:179], a[112:115], v[96:99], v[176:179]
ds_read_b128 a[80:83], v2 offset:20480
v_mfma_f32_16x16x32_bf16 v[176:179], a[116:119], v[100:103], v[176:179]
buffer_load_dwordx4 v1, s[4:7], s12 offen offset:2048 sc1 lds
v_mfma_f32_16x16x32_bf16 v[180:183], a[116:119], v[108:111], v[180:183]
ds_read_b128 a[84:87], v2 offset:21504
v_mfma_f32_16x16x32_bf16 v[180:183], a[112:115], v[104:107], v[180:183]
v_exp_f32 v13, v69
v_mfma_f32_16x16x32_bf16 v[184:187], a[120:123], v[96:99], v[184:187]
ds_read_b128 a[88:91], v2 offset:22528
v_add_f32 v27, v12, v13
v_mfma_f32_16x16x32_bf16 v[184:187], a[124:127], v[100:103], v[184:187]
s_waitcnt lgkmcnt(4)
buffer_load_dwordx4 v1, s[4:7], s12 offen offset:3072 sc1 lds
v_mfma_f32_16x16x32_bf16 v[188:191], a[124:127], v[108:111], v[188:191]
s_add_u32 s12, s12, 28672
ds_read_b128 a[92:95], v2 offset:23552
v_cvt_pk_bf16_f32 v120, v12, v13
v_mfma_f32_16x16x32_bf16 v[188:191], a[120:123], v[104:107], v[188:191]
s_sub_u32 s13, s13, 1
v_exp_f32 v14, v70
v_mfma_f32_16x16x32_bf16 v[192:195], a[64:67], v[96:99], v[192:195]
s_cmp_eq_u32 s13, 0
ds_read_b128 a[96:99], v2 offset:24576
v_add_f32 v27, v27, v14
v_mfma_f32_16x16x32_bf16 v[192:195], a[68:71], v[100:103], v[192:195]
s_cselect_b32 s12, s14, s12
v_mfma_f32_16x16x32_bf16 v[196:199], a[68:71], v[108:111], v[196:199]
s_cselect_b32 s13, s15, s13
ds_read_b128 a[100:103], v2 offset:25600
v_mfma_f32_16x16x32_bf16 v[196:199], a[64:67], v[104:107], v[196:199]
s_cselect_b32 s14, 3221225472, s14
v_exp_f32 v15, v71
v_mfma_f32_16x16x32_bf16 v[200:203], a[72:75], v[96:99], v[200:203]
s_waitcnt lgkmcnt(4)
ds_read_b128 a[104:107], v2 offset:26624
v_add_f32 v27, v27, v15
v_mfma_f32_16x16x32_bf16 v[200:203], a[76:79], v[100:103], v[200:203]
v_exp_f32 v8, v72
v_mfma_f32_16x16x32_bf16 v[204:207], a[76:79], v[108:111], v[204:207]
ds_read_b128 a[108:111], v2 offset:27648
v_cvt_pk_bf16_f32 v121, v14, v15
v_mfma_f32_16x16x32_bf16 v[204:207], a[72:75], v[104:107], v[204:207]
v_exp_f32 v9, v73
v_mfma_f32_16x16x32_bf16 v[208:211], a[80:83], v[96:99], v[208:211]
ds_read_b128 a[112:115], v2 offset:28672
v_add_f32 v26, v26, v8
v_mfma_f32_16x16x32_bf16 v[208:211], a[84:87], v[100:103], v[208:211]
v_add_f32 v26, v26, v9
v_cvt_pk_bf16_f32 v114, v8, v9
v_mfma_f32_16x16x32_bf16 v[212:215], a[84:87], v[108:111], v[212:215]
ds_read_b128 a[116:119], v2 offset:29696
v_mfma_f32_16x16x32_bf16 v[212:215], a[80:83], v[104:107], v[212:215]
s_waitcnt lgkmcnt(4)
v_exp_f32 v10, v74
v_mfma_f32_16x16x32_bf16 v[216:219], a[88:91], v[96:99], v[216:219]
ds_read_b128 a[120:123], v2 offset:30720
v_add_f32 v26, v26, v10
v_mfma_f32_16x16x32_bf16 v[216:219], a[92:95], v[100:103], v[216:219]
v_exp_f32 v11, v75
v_mfma_f32_16x16x32_bf16 v[220:223], a[92:95], v[108:111], v[220:223]
s_waitcnt vmcnt(8)
ds_read_b128 a[124:127], v2 offset:31744
v_add_f32 v26, v26, v11
v_mfma_f32_16x16x32_bf16 v[220:223], a[88:91], v[104:107], v[220:223]
PAD_11:
s_cbranch_execz M_tret
s_barrier
v_mfma_f32_16x16x32_bf16 v[224:227], a[96:99], v[96:99], v[224:227]
ds_read_b128 a[64:67], v1 offset:0
v_cvt_pk_bf16_f32 v115, v10, v11
v_mfma_f32_16x16x32_bf16 v[224:227], a[100:103], v[100:103], v[224:227]
v_exp_f32 v12, v76
v_mfma_f32_16x16x32_bf16 v[228:231], a[100:103], v[108:111], v[228:231]
ds_read_b128 a[68:71], v1 offset:1024
v_add_f32 v27, v27, v12
v_mfma_f32_16x16x32_bf16 v[228:231], a[96:99], v[104:107], v[228:231]
s_waitcnt lgkmcnt(4)
v_mfma_f32_16x16x32_bf16 v[232:235], a[104:107], v[96:99], v[232:235]
ds_read_b128 a[72:75], v1 offset:2048
v_mfma_f32_16x16x32_bf16 v[232:235], a[108:111], v[100:103], v[232:235]
v_exp_f32 v13, v77
v_mfma_f32_16x16x32_bf16 v[236:239], a[108:111], v[108:111], v[236:239]
ds_read_b128 a[76:79], v1 offset:3072
v_add_f32 v27, v27, v13
v_mfma_f32_16x16x32_bf16 v[236:239], a[104:107], v[104:107], v[236:239]
v_exp_f32 v14, v78
v_mfma_f32_16x16x32_bf16 v[240:243], a[112:115], v[96:99], v[240:243]
ds_read_b128 a[80:83], v1 offset:4096
v_cvt_pk_bf16_f32 v122, v12, v13
v_mfma_f32_16x16x32_bf16 v[240:243], a[116:119], v[100:103], v[240:243]
v_exp_f32 v15, v79
v_mfma_f32_16x16x32_bf16 v[244:247], a[116:119], v[108:111], v[244:247]
ds_read_b128 a[84:87], v1 offset:5120
v_add_f32 v27, v27, v14
v_mfma_f32_16x16x32_bf16 v[244:247], a[112:115], v[104:107], v[244:247]
s_waitcnt lgkmcnt(4)
v_add_f32 v27, v27, v15
v_cvt_pk_bf16_f32 v123, v14, v15
v_mfma_f32_16x16x32_bf16 v[248:251], a[120:123], v[96:99], v[248:251]
ds_read_b128 a[88:91], v1 offset:6144
v_mfma_f32_16x16x32_bf16 v[248:251], a[124:127], v[100:103], v[248:251]
v_mfma_f32_16x16x32_bf16 v[252:255], a[124:127], v[108:111], v[252:255]
ds_read_b128 a[92:95], v1 offset:7168
v_mfma_f32_16x16x32_bf16 v[252:255], a[120:123], v[104:107], v[252:255]
v_cndmask_b32 v32, v16, v7, s[32:33]
v_cndmask_b32 v33, v16, v7, s[34:35]
v_cndmask_b32 v34, v16, v7, s[36:37]
v_cndmask_b32 v35, v16, v7, s[38:39]
s_nop 1
v_mfma_f32_16x16x32_bf16 v[32:35], a[64:67], a[0:3], v[32:35]
s_add_u32 m0, s18, 131072
ds_read_b128 a[96:99], v1 offset:8192
v_cndmask_b32 v40, v16, v7, s[40:41]
v_mfma_f32_16x16x32_bf16 v[32:35], a[68:71], a[4:7], v[32:35]
s_waitcnt lgkmcnt(4)
buffer_load_dwordx4 v1, s[4:7], s8 offen offset:0 sc1 lds
v_mfma_f32_16x16x32_bf16 v[32:35], a[72:75], a[8:11], v[32:35]
ds_read_b128 a[100:103], v1 offset:9216
v_cndmask_b32 v41, v16, v7, s[42:43]
v_mfma_f32_16x16x32_bf16 v[32:35], a[76:79], a[12:15], v[32:35]
v_cndmask_b32 v42, v16, v7, s[44:45]
v_cndmask_b32 v43, v16, v7, s[46:47]
v_mfma_f32_16x16x32_bf16 v[32:35], a[80:83], a[16:19], v[32:35]
s_waitcnt lgkmcnt(4)
ds_read_b128 a[104:107], v1 offset:10240
v_mfma_f32_16x16x32_bf16 v[32:35], a[84:87], a[20:23], v[32:35]
s_waitcnt lgkmcnt(4)
buffer_load_dwordx4 v1, s[4:7], s8 offen offset:1024 sc1 lds
v_mfma_f32_16x16x32_bf16 v[32:35], a[88:91], a[24:27], v[32:35]
s_waitcnt lgkmcnt(3)
ds_read_b128 a[108:111], v1 offset:11264
v_mfma_f32_16x16x32_bf16 v[32:35], a[92:95], a[28:31], v[32:35]
v_exp_f32 v8, v80
v_mfma_f32_16x16x32_bf16 v[36:39], a[64:67], a[32:35], v[20:23]
ds_read_b128 a[112:115], v1 offset:12288
v_add_f32 v26, v26, v8
v_mfma_f32_16x16x32_bf16 v[36:39], a[68:71], a[36:39], v[36:39]
buffer_load_dwordx4 v1, s[4:7], s8 offen offset:2048 sc1 lds
v_mfma_f32_16x16x32_bf16 v[36:39], a[72:75], a[40:43], v[36:39]
ds_read_b128 a[116:119], v1 offset:13312
v_mfma_f32_16x16x32_bf16 v[36:39], a[76:79], a[44:47], v[36:39]
v_exp_f32 v9, v81
v_mfma_f32_16x16x32_bf16 v[36:39], a[80:83], a[48:51], v[36:39]
ds_read_b128 a[120:123], v1 offset:14336
v_add_f32 v26, v26, v9
v_mfma_f32_16x16x32_bf16 v[36:39], a[84:87], a[52:55], v[36:39]
buffer_load_dwordx4 v1, s[4:7], s8 offen offset:3072 sc1 lds
v_mfma_f32_16x16x32_bf16 v[36:39], a[88:91], a[56:59], v[36:39]
s_add_u32 s8, s8, 4096
ds_read_b128 a[124:127], v1 offset:15360
v_cvt_pk_bf16_f32 v116, v8, v9
v_mfma_f32_16x16x32_bf16 v[36:39], a[92:95], a[60:63], v[36:39]
s_waitcnt lgkmcnt(4)
v_exp_f32 v10, v82
v_mfma_f32_16x16x32_bf16 v[40:43], a[96:99], a[0:3], v[40:43]
s_add_u32 m0, s18, 135168
ds_read_b128 a[64:67], v1 offset:16384
v_cndmask_b32 v48, v16, v7, s[48:49]
v_mfma_f32_16x16x32_bf16 v[40:43], a[100:103], a[4:7], v[40:43]
buffer_load_dwordx4 v1, s[4:7], s8 offen offset:0 sc1 lds
v_mfma_f32_16x16x32_bf16 v[40:43], a[104:107], a[8:11], v[40:43]
ds_read_b128 a[68:71], v1 offset:17408
v_cndmask_b32 v49, v16, v7, s[50:51]
v_mfma_f32_16x16x32_bf16 v[40:43], a[108:111], a[12:15], v[40:43]
s_waitcnt lgkmcnt(4)
v_cndmask_b32 v50, v16, v7, s[52:53]
v_cndmask_b32 v51, v16, v7, s[54:55]
v_mfma_f32_16x16x32_bf16 v[40:43], a[112:115], a[16:19], v[40:43]
ds_read_b128 a[72:75], v1 offset:18432
v_add_f32 v26, v26, v10
v_mfma_f32_16x16x32_bf16 v[40:43], a[116:119], a[20:23], v[40:43]
s_waitcnt lgkmcnt(4)
buffer_load_dwordx4 v1, s[4:7], s8 offen offset:1024 sc1 lds
v_mfma_f32_16x16x32_bf16 v[40:43], a[120:123], a[24:27], v[40:43]
s_waitcnt lgkmcnt(3)
ds_read_b128 a[76:79], v1 offset:19456
v_mfma_f32_16x16x32_bf16 v[40:43], a[124:127], a[28:31], v[40:43]
v_exp_f32 v11, v83
v_mfma_f32_16x16x32_bf16 v[44:47], a[96:99], a[32:35], v[20:23]
ds_read_b128 a[80:83], v1 offset:20480
v_add_f32 v26, v26, v11
v_mfma_f32_16x16x32_bf16 v[44:47], a[100:103], a[36:39], v[44:47]
buffer_load_dwordx4 v1, s[4:7], s8 offen offset:2048 sc1 lds
v_mfma_f32_16x16x32_bf16 v[44:47], a[104:107], a[40:43], v[44:47]
ds_read_b128 a[84:87], v1 offset:21504
v_cvt_pk_bf16_f32 v117, v10, v11
v_mfma_f32_16x16x32_bf16 v[44:47], a[108:111], a[44:47], v[44:47]
v_exp_f32 v12, v84
v_mfma_f32_16x16x32_bf16 v[44:47], a[112:115], a[48:51], v[44:47]
ds_read_b128 a[88:91], v1 offset:22528
v_add_f32 v27, v27, v12
v_mfma_f32_16x16x32_bf16 v[44:47], a[116:119], a[52:55], v[44:47]
buffer_load_dwordx4 v1, s[4:7], s8 offen offset:3072 sc1 lds
v_mfma_f32_16x16x32_bf16 v[44:47], a[120:123], a[56:59], v[44:47]
s_waitcnt lgkmcnt(2)
s_add_u32 s8, s8, 28672
ds_read_b128 a[92:95], v1 offset:23552
v_mfma_f32_16x16x32_bf16 v[44:47], a[124:127], a[60:63], v[44:47]
s_sub_u32 s9, s9, 1
v_exp_f32 v13, v85
v_mfma_f32_16x16x32_bf16 v[48:51], a[64:67], a[0:3], v[48:51]
s_cmp_eq_u32 s9, 0
ds_read_b128 a[96:99], v1 offset:24576
v_cndmask_b32 v56, v16, v7, s[56:57]
v_mfma_f32_16x16x32_bf16 v[48:51], a[68:71], a[4:7], v[48:51]
s_cselect_b32 s8, s10, s8
v_cndmask_b32 v57, v16, v7, s[58:59]
v_cndmask_b32 v58, v16, v7, s[60:61]
v_mfma_f32_16x16x32_bf16 v[48:51], a[72:75], a[8:11], v[48:51]
s_cselect_b32 s9, s11, s9
ds_read_b128 a[100:103], v1 offset:25600
v_cndmask_b32 v59, v16, v7, s[62:63]
v_mfma_f32_16x16x32_bf16 v[48:51], a[76:79], a[12:15], v[48:51]
s_cselect_b32 s10, 3221225472, s10
v_exp_f32 v14, v86
v_mfma_f32_16x16x32_bf16 v[48:51], a[80:83], a[16:19], v[48:51]
s_waitcnt lgkmcnt(4)
ds_read_b128 a[104:107], v1 offset:26624
v_add_f32 v27, v27, v13
v_cvt_pk_bf16_f32 v124, v12, v13
v_mfma_f32_16x16x32_bf16 v[48:51], a[84:87], a[20:23], v[48:51]
s_waitcnt lgkmcnt(4)
v_exp_f32 v15, v87
v_mfma_f32_16x16x32_bf16 v[48:51], a[88:91], a[24:27], v[48:51]
s_waitcnt lgkmcnt(3)
ds_read_b128 a[108:111], v1 offset:27648
v_add_f32 v27, v27, v14
v_mfma_f32_16x16x32_bf16 v[48:51], a[92:95], a[28:31], v[48:51]
v_exp_f32 v8, v88
v_mfma_f32_16x16x32_bf16 v[52:55], a[64:67], a[32:35], v[20:23]
ds_read_b128 a[112:115], v1 offset:28672
v_add_f32 v27, v27, v15
v_mfma_f32_16x16x32_bf16 v[52:55], a[68:71], a[36:39], v[52:55]
v_exp_f32 v9, v89
v_mfma_f32_16x16x32_bf16 v[52:55], a[72:75], a[40:43], v[52:55]
ds_read_b128 a[116:119], v1 offset:29696
v_cvt_pk_bf16_f32 v125, v14, v15
v_mfma_f32_16x16x32_bf16 v[52:55], a[76:79], a[44:47], v[52:55]
v_exp_f32 v10, v90
v_mfma_f32_16x16x32_bf16 v[52:55], a[80:83], a[48:51], v[52:55]
ds_read_b128 a[120:123], v1 offset:30720
v_add_f32 v26, v26, v8
v_mfma_f32_16x16x32_bf16 v[52:55], a[84:87], a[52:55], v[52:55]
v_exp_f32 v11, v91
v_mfma_f32_16x16x32_bf16 v[52:55], a[88:91], a[56:59], v[52:55]
s_waitcnt vmcnt(8) lgkmcnt(4)
ds_read_b128 a[124:127], v1 offset:31744
v_add_f32 v26, v26, v9
v_cvt_pk_bf16_f32 v118, v8, v9
v_mfma_f32_16x16x32_bf16 v[52:55], a[92:95], a[60:63], v[52:55]
s_barrier
v_mfma_f32_16x16x32_bf16 v[56:59], a[96:99], a[0:3], v[56:59]
ds_read_b128 a[64:67], v2 offset:32768
v_add_f32 v26, v26, v10
v_mfma_f32_16x16x32_bf16 v[56:59], a[100:103], a[4:7], v[56:59]
v_exp_f32 v12, v92
v_mfma_f32_16x16x32_bf16 v[56:59], a[104:107], a[8:11], v[56:59]
s_waitcnt lgkmcnt(4)
ds_read_b128 a[68:71], v2 offset:33792
v_add_f32 v26, v26, v11
v_cvt_pk_bf16_f32 v119, v10, v11
v_mfma_f32_16x16x32_bf16 v[56:59], a[108:111], a[12:15], v[56:59]
v_exp_f32 v13, v93
v_mfma_f32_16x16x32_bf16 v[56:59], a[112:115], a[16:19], v[56:59]
s_waitcnt lgkmcnt(4)
ds_read_b128 a[72:75], v2 offset:34816
v_add_f32 v27, v27, v12
v_mfma_f32_16x16x32_bf16 v[56:59], a[116:119], a[20:23], v[56:59]
s_waitcnt lgkmcnt(4)
v_exp_f32 v14, v94
v_mfma_f32_16x16x32_bf16 v[56:59], a[120:123], a[24:27], v[56:59]
s_waitcnt lgkmcnt(3)
ds_read_b128 a[76:79], v2 offset:35840
v_add_f32 v27, v27, v13
v_mfma_f32_16x16x32_bf16 v[56:59], a[124:127], a[28:31], v[56:59]
v_exp_f32 v15, v95
v_mfma_f32_16x16x32_bf16 v[60:63], a[96:99], a[32:35], v[20:23]
ds_read_b128 a[80:83], v2 offset:36864
v_cvt_pk_bf16_f32 v126, v12, v13
v_mfma_f32_16x16x32_bf16 v[60:63], a[100:103], a[36:39], v[60:63]
v_add_f32 v27, v27, v14
v_add_f32 v27, v27, v15
v_mfma_f32_16x16x32_bf16 v[60:63], a[104:107], a[40:43], v[60:63]
ds_read_b128 a[84:87], v2 offset:37888
v_cvt_pk_bf16_f32 v127, v14, v15
v_mfma_f32_16x16x32_bf16 v[60:63], a[108:111], a[44:47], v[60:63]
v_add_f32 v28, v26, v27
v_cmp_nge_f32 vcc, s25, v28
v_mfma_f32_16x16x32_bf16 v[60:63], a[112:115], a[48:51], v[60:63]
ds_read_b128 a[88:91], v2 offset:38912
v_mfma_f32_16x16x32_bf16 v[60:63], a[116:119], a[52:55], v[60:63]
v_mfma_f32_16x16x32_bf16 v[60:63], a[120:123], a[56:59], v[60:63]
ds_read_b128 a[92:95], v2 offset:39936
v_mfma_f32_16x16x32_bf16 v[60:63], a[124:127], a[60:63], v[60:63]
s_waitcnt lgkmcnt(4)
s_cbranch_vccnz Lstub_6
Lback_7:
v_mfma_f32_16x16x32_bf16 v[128:131], a[64:67], v[112:115], v[128:131]
s_add_u32 m0, s18, 65536
ds_read_b128 a[96:99], v2 offset:40960
v_add_f32 v24, v24, v26
v_mfma_f32_16x16x32_bf16 v[128:131], a[68:71], v[116:119], v[128:131]
buffer_load_dwordx4 v1, s[4:7], s12 offen offset:0 sc1 lds
v_mfma_f32_16x16x32_bf16 v[132:135], a[68:71], v[124:127], v[132:135]
ds_read_b128 a[100:103], v2 offset:41984
v_add_f32 v25, v25, v27
v_mfma_f32_16x16x32_bf16 v[132:135], a[64:67], v[120:123], v[132:135]
v_exp_f32 v8, v32
v_mfma_f32_16x16x32_bf16 v[136:139], a[72:75], v[112:115], v[136:139]
ds_read_b128 a[104:107], v2 offset:43008
v_mfma_f32_16x16x32_bf16 v[136:139], a[76:79], v[116:119], v[136:139]
buffer_load_dwordx4 v1, s[4:7], s12 offen offset:1024 sc1 lds
v_mfma_f32_16x16x32_bf16 v[140:143], a[76:79], v[124:127], v[140:143]
ds_read_b128 a[108:111], v2 offset:44032
v_mfma_f32_16x16x32_bf16 v[140:143], a[72:75], v[120:123], v[140:143]
s_waitcnt lgkmcnt(4)
v_exp_f32 v9, v33
v_mfma_f32_16x16x32_bf16 v[144:147], a[80:83], v[112:115], v[144:147]
ds_read_b128 a[112:115], v2 offset:45056
v_add_f32 v26, v8, v9
v_mfma_f32_16x16x32_bf16 v[144:147], a[84:87], v[116:119], v[144:147]
buffer_load_dwordx4 v1, s[4:7], s12 offen offset:2048 sc1 lds
v_mfma_f32_16x16x32_bf16 v[148:151], a[84:87], v[124:127], v[148:151]
ds_read_b128 a[116:119], v2 offset:46080
v_cvt_pk_bf16_f32 v96, v8, v9
v_mfma_f32_16x16x32_bf16 v[148:151], a[80:83], v[120:123], v[148:151]
v_exp_f32 v10, v34
v_mfma_f32_16x16x32_bf16 v[152:155], a[88:91], v[112:115], v[152:155]
ds_read_b128 a[120:123], v2 offset:47104
v_add_f32 v26, v26, v10
v_mfma_f32_16x16x32_bf16 v[152:155], a[92:95], v[116:119], v[152:155]
buffer_load_dwordx4 v1, s[4:7], s12 offen offset:3072 sc1 lds
v_mfma_f32_16x16x32_bf16 v[156:159], a[92:95], v[124:127], v[156:159]
s_add_u32 s12, s12, 4096
ds_read_b128 a[124:127], v2 offset:48128
v_mfma_f32_16x16x32_bf16 v[156:159], a[88:91], v[120:123], v[156:159]
s_waitcnt lgkmcnt(4)
v_exp_f32 v11, v35
v_mfma_f32_16x16x32_bf16 v[160:163], a[96:99], v[112:115], v[160:163]
s_add_u32 m0, s18, 69632
ds_read_b128 a[64:67], v2 offset:49152
v_add_f32 v26, v26, v11
v_mfma_f32_16x16x32_bf16 v[160:163], a[100:103], v[116:119], v[160:163]
buffer_load_dwordx4 v1, s[4:7], s12 offen offset:0 sc1 lds
v_mfma_f32_16x16x32_bf16 v[164:167], a[100:103], v[124:127], v[164:167]
ds_read_b128 a[68:71], v2 offset:50176
v_cvt_pk_bf16_f32 v97, v10, v11
v_mfma_f32_16x16x32_bf16 v[164:167], a[96:99], v[120:123], v[164:167]
v_mfma_f32_16x16x32_bf16 v[168:171], a[104:107], v[112:115], v[168:171]
ds_read_b128 a[72:75], v2 offset:51200
v_mfma_f32_16x16x32_bf16 v[168:171], a[108:111], v[116:119], v[168:171]
buffer_load_dwordx4 v1, s[4:7], s12 offen offset:1024 sc1 lds
v_mfma_f32_16x16x32_bf16 v[172:175], a[108:111], v[124:127], v[172:175]
ds_read_b128 a[76:79], v2 offset:52224
v_mfma_f32_16x16x32_bf16 v[172:175], a[104:107], v[120:123], v[172:175]
s_waitcnt lgkmcnt(4)
v_exp_f32 v12, v36
v_mfma_f32_16x16x32_bf16 v[176:179], a[112:115], v[112:115], v[176:179]
ds_read_b128 a[80:83], v2 offset:53248
v_mfma_f32_16x16x32_bf16 v[176:179], a[116:119], v[116:119], v[176:179]
buffer_load_dwordx4 v1, s[4:7], s12 offen offset:2048 sc1 lds
v_mfma_f32_16x16x32_bf16 v[180:183], a[116:119], v[124:127], v[180:183]
ds_read_b128 a[84:87], v2 offset:54272
v_mfma_f32_16x16x32_bf16 v[180:183], a[112:115], v[120:123], v[180:183]
v_exp_f32 v13, v37
v_mfma_f32_16x16x32_bf16 v[184:187], a[120:123], v[112:115], v[184:187]
ds_read_b128 a[88:91], v2 offset:55296
v_add_f32 v27, v12, v13
v_mfma_f32_16x16x32_bf16 v[184:187], a[124:127], v[116:119], v[184:187]
s_waitcnt lgkmcnt(4)
buffer_load_dwordx4 v1, s[4:7], s12 offen offset:3072 sc1 lds
v_mfma_f32_16x16x32_bf16 v[188:191], a[124:127], v[124:127], v[188:191]
s_add_u32 s12, s12, 28672
ds_read_b128 a[92:95], v2 offset:56320
v_cvt_pk_bf16_f32 v104, v12, v13
v_mfma_f32_16x16x32_bf16 v[188:191], a[120:123], v[120:123], v[188:191]
s_sub_u32 s13, s13, 1
v_exp_f32 v14, v38
v_mfma_f32_16x16x32_bf16 v[192:195], a[64:67], v[112:115], v[192:195]
s_cmp_eq_u32 s13, 0
ds_read_b128 a[96:99], v2 offset:57344
v_add_f32 v27, v27, v14
v_mfma_f32_16x16x32_bf16 v[192:195], a[68:71], v[116:119], v[192:195]
s_cselect_b32 s12, s14, s12
v_exp_f32 v15, v39
v_mfma_f32_16x16x32_bf16 v[196:199], a[68:71], v[124:127], v[196:199]
s_cselect_b32 s13, s15, s13
ds_read_b128 a[100:103], v2 offset:58368
v_add_f32 v27, v27, v15
v_mfma_f32_16x16x32_bf16 v[196:199], a[64:67], v[120:123], v[196:199]
s_cselect_b32 s14, 3221225472, s14
v_cvt_pk_bf16_f32 v105, v14, v15
v_mfma_f32_16x16x32_bf16 v[200:203], a[72:75], v[112:115], v[200:203]
s_waitcnt lgkmcnt(4)
ds_read_b128 a[104:107], v2 offset:59392
v_mfma_f32_16x16x32_bf16 v[200:203], a[76:79], v[116:119], v[200:203]
buffer_load_dword v3, off, s[4:7], s80 sc1
v_mfma_f32_16x16x32_bf16 v[204:207], a[76:79], v[124:127], v[204:207]
ds_read_b128 a[108:111], v2 offset:60416
v_mfma_f32_16x16x32_bf16 v[204:207], a[72:75], v[120:123], v[204:207]
v_exp_f32 v8, v40
v_mfma_f32_16x16x32_bf16 v[208:211], a[80:83], v[112:115], v[208:211]
ds_read_b128 a[112:115], v2 offset:61440
v_add_f32 v26, v26, v8
v_mfma_f32_16x16x32_bf16 v[208:211], a[84:87], v[116:119], v[208:211]
v_exp_f32 v9, v41
v_mfma_f32_16x16x32_bf16 v[212:215], a[84:87], v[124:127], v[212:215]
ds_read_b128 a[116:119], v2 offset:62464
v_add_f32 v26, v26, v9
v_mfma_f32_16x16x32_bf16 v[212:215], a[80:83], v[120:123], v[212:215]
s_waitcnt lgkmcnt(4)
v_exp_f32 v10, v42
v_mfma_f32_16x16x32_bf16 v[216:219], a[88:91], v[112:115], v[216:219]
ds_read_b128 a[120:123], v2 offset:63488
v_cvt_pk_bf16_f32 v98, v8, v9
v_mfma_f32_16x16x32_bf16 v[216:219], a[92:95], v[116:119], v[216:219]
v_exp_f32 v11, v43
v_mfma_f32_16x16x32_bf16 v[220:223], a[92:95], v[124:127], v[220:223]
s_waitcnt vmcnt(9)
ds_read_b128 a[124:127], v2 offset:64512
v_add_f32 v26, v26, v10
v_mfma_f32_16x16x32_bf16 v[220:223], a[88:91], v[120:123], v[220:223]
s_barrier
v_mfma_f32_16x16x32_bf16 v[224:227], a[96:99], v[112:115], v[224:227]
ds_read_b128 a[64:67], v4 offset:0
v_add_f32 v26, v26, v11
v_mfma_f32_16x16x32_bf16 v[224:227], a[100:103], v[116:119], v[224:227]
v_cvt_pk_bf16_f32 v99, v10, v11
v_mfma_f32_16x16x32_bf16 v[228:231], a[100:103], v[124:127], v[228:231]
ds_read_b128 a[68:71], v4 offset:1024
v_mfma_f32_16x16x32_bf16 v[228:231], a[96:99], v[120:123], v[228:231]
s_waitcnt lgkmcnt(4)
v_exp_f32 v12, v44
v_mfma_f32_16x16x32_bf16 v[232:235], a[104:107], v[112:115], v[232:235]
ds_read_b128 a[72:75], v4 offset:2048
v_add_f32 v27, v27, v12
v_mfma_f32_16x16x32_bf16 v[232:235], a[108:111], v[116:119], v[232:235]
v_exp_f32 v13, v45
v_mfma_f32_16x16x32_bf16 v[236:239], a[108:111], v[124:127], v[236:239]
ds_read_b128 a[76:79], v4 offset:3072
v_add_f32 v27, v27, v13
v_mfma_f32_16x16x32_bf16 v[236:239], a[104:107], v[120:123], v[236:239]
v_exp_f32 v14, v46
v_mfma_f32_16x16x32_bf16 v[240:243], a[112:115], v[112:115], v[240:243]
ds_read_b128 a[80:83], v4 offset:4096
v_cvt_pk_bf16_f32 v106, v12, v13
v_mfma_f32_16x16x32_bf16 v[240:243], a[116:119], v[116:119], v[240:243]
v_exp_f32 v15, v47
v_mfma_f32_16x16x32_bf16 v[244:247], a[116:119], v[124:127], v[244:247]
ds_read_b128 a[84:87], v4 offset:5120
v_add_f32 v27, v27, v14
v_mfma_f32_16x16x32_bf16 v[244:247], a[112:115], v[120:123], v[244:247]
s_waitcnt lgkmcnt(4)
v_add_f32 v27, v27, v15
v_cvt_pk_bf16_f32 v107, v14, v15
v_mfma_f32_16x16x32_bf16 v[248:251], a[120:123], v[112:115], v[248:251]
ds_read_b128 a[88:91], v4 offset:6144
v_mfma_f32_16x16x32_bf16 v[248:251], a[124:127], v[116:119], v[248:251]
v_mfma_f32_16x16x32_bf16 v[252:255], a[124:127], v[124:127], v[252:255]
ds_read_b128 a[92:95], v4 offset:7168
v_mfma_f32_16x16x32_bf16 v[252:255], a[120:123], v[120:123], v[252:255]
K2_dx1:
v_cndmask_b32 v68, v20, v7, s[32:33]
v_cndmask_b32 v69, v20, v7, s[34:35]
v_cndmask_b32 v70, v20, v7, s[36:37]
v_cndmask_b32 v71, v20, v7, s[38:39]
s_nop 1
v_mfma_f32_16x16x32_bf16 v[68:71], a[64:67], a[32:35], v[68:71]
s_add_u32 m0, s18, 0
ds_read_b128 a[96:99], v4 offset:8192
v_cndmask_b32 v76, v20, v7, s[40:41]
v_cndmask_b32 v79, v20, v7, s[46:47]
v_mfma_f32_16x16x32_bf16 v[68:71], a[68:71], a[36:39], v[68:71]
s_waitcnt lgkmcnt(4)
ds_read_b128 a[100:103], v4 offset:9216
buffer_load_dwordx4 v1, s[4:7], s12 offen offset:0 sc1 lds
v_mfma_f32_16x16x32_bf16 v[68:71], a[72:75], a[40:43], v[68:71]
ds_read_b128 a[104:107], v4 offset:10240
v_cndmask_b32 v77, v20, v7, s[42:43]
v_mfma_f32_16x16x32_bf16 v[68:71], a[76:79], a[44:47], v[68:71]
ds_read_b128 a[108:111], v4 offset:11264
buffer_load_dwordx4 v1, s[4:7], s12 offen offset:1024 sc1 lds
v_mfma_f32_16x16x32_bf16 v[68:71], a[80:83], a[48:51], v[68:71]
s_waitcnt lgkmcnt(6)
ds_read_b128 a[112:115], v4 offset:12288
v_cndmask_b32 v78, v20, v7, s[44:45]
v_mfma_f32_16x16x32_bf16 v[68:71], a[84:87], a[52:55], v[68:71]
s_waitcnt lgkmcnt(6)
ds_read_b128 a[116:119], v4 offset:13312
buffer_load_dwordx4 v1, s[4:7], s12 offen offset:2048 sc1 lds
v_mfma_f32_16x16x32_bf16 v[68:71], a[88:91], a[56:59], v[68:71]
s_waitcnt lgkmcnt(6)
ds_read_b128 a[120:123], v4 offset:14336
v_exp_f32 v8, v48
v_exp_f32 v9, v49
v_exp_f32 v10, v50
v_mfma_f32_16x16x32_bf16 v[68:71], a[92:95], a[60:63], v[68:71]
s_waitcnt lgkmcnt(5)
ds_read_b128 a[124:127], v4 offset:15360
buffer_load_dwordx4 v1, s[4:7], s12 offen offset:3072 sc1 lds
v_add_f32 v26, v26, v8
v_add_f32 v26, v26, v9
v_cvt_pk_bf16_f32 v100, v8, v9
v_add_f32 v26, v26, v10
v_mfma_f32_16x16x32_bf16 v[76:79], a[96:99], a[32:35], v[76:79]
s_add_u32 s12, s12, 4096
s_add_u32 m0, s18, 4096
ds_read_b128 a[64:67], v4 offset:16384
v_cndmask_b32 v86, v20, v7, s[52:53]
v_cndmask_b32 v87, v20, v7, s[54:55]
v_mfma_f32_16x16x32_bf16 v[76:79], a[100:103], a[36:39], v[76:79]
s_waitcnt lgkmcnt(6)
ds_read_b128 a[68:71], v4 offset:17408
buffer_load_dwordx4 v1, s[4:7], s12 offen offset:0 sc1 lds
v_mfma_f32_16x16x32_bf16 v[76:79], a[104:107], a[40:43], v[76:79]
s_waitcnt lgkmcnt(6)
ds_read_b128 a[72:75], v4 offset:18432
v_cndmask_b32 v84, v20, v7, s[48:49]
v_mfma_f32_16x16x32_bf16 v[76:79], a[108:111], a[44:47], v[76:79]
s_waitcnt lgkmcnt(6)
ds_read_b128 a[76:79], v4 offset:19456
buffer_load_dwordx4 v1, s[4:7], s12 offen offset:1024 sc1 lds
v_mfma_f32_16x16x32_bf16 v[76:79], a[112:115], a[48:51], v[76:79]
s_waitcnt lgkmcnt(6)
ds_read_b128 a[80:83], v4 offset:20480
v_cndmask_b32 v85, v20, v7, s[50:51]
v_mfma_f32_16x16x32_bf16 v[76:79], a[116:119], a[52:55], v[76:79]
s_waitcnt lgkmcnt(6)
ds_read_b128 a[84:87], v4 offset:21504
buffer_load_dwordx4 v1, s[4:7], s12 offen offset:2048 sc1 lds
v_mfma_f32_16x16x32_bf16 v[76:79], a[120:123], a[56:59], v[76:79]
s_waitcnt lgkmcnt(6)
ds_read_b128 a[88:91], v4 offset:22528
v_exp_f32 v11, v51
v_exp_f32 v12, v52
v_mfma_f32_16x16x32_bf16 v[76:79], a[124:127], a[60:63], v[76:79]
s_waitcnt lgkmcnt(1)
ds_read_b128 a[92:95], v4 offset:23552
buffer_load_dwordx4 v1, s[4:7], s12 offen offset:3072 sc1 lds
v_add_f32 v26, v26, v11
v_cvt_pk_bf16_f32 v101, v10, v11
v_add_f32 v27, v27, v12
v_mfma_f32_16x16x32_bf16 v[84:87], a[64:67], a[32:35], v[84:87]
s_add_u32 s12, s12, 28672
ds_read_b128 a[96:99], v4 offset:24576
v_cndmask_b32 v92, v20, v7, s[56:57]
v_mfma_f32_16x16x32_bf16 v[84:87], a[68:71], a[36:39], v[84:87]
s_sub_u32 s13, s13, 1
ds_read_b128 a[100:103], v4 offset:25600
v_cndmask_b32 v93, v20, v7, s[58:59]
v_mfma_f32_16x16x32_bf16 v[84:87], a[72:75], a[40:43], v[84:87]
s_cmp_eq_u32 s13, 0
ds_read_b128 a[104:107], v4 offset:26624
v_cndmask_b32 v94, v20, v7, s[60:61]
v_mfma_f32_16x16x32_bf16 v[84:87], a[76:79], a[44:47], v[84:87]
s_cselect_b32 s12, s14, s12
ds_read_b128 a[108:111], v4 offset:27648
v_cndmask_b32 v95, v20, v7, s[62:63]
v_mfma_f32_16x16x32_bf16 v[84:87], a[80:83], a[48:51], v[84:87]
s_cselect_b32 s13, s15, s13
ds_read_b128 a[112:115], v4 offset:28672
v_exp_f32 v13, v53
v_exp_f32 v14, v54
v_mfma_f32_16x16x32_bf16 v[84:87], a[84:87], a[52:55], v[84:87]
s_waitcnt lgkmcnt(6)
s_cselect_b32 s14, 3221225472, s14
ds_read_b128 a[116:119], v4 offset:29696
v_exp_f32 v15, v55
v_exp_f32 v8, v56
v_exp_f32 v9, v57
v_add_f32 v27, v27, v13
v_cvt_pk_bf16_f32 v108, v12, v13
v_add_f32 v27, v27, v14
v_mfma_f32_16x16x32_bf16 v[84:87], a[88:91], a[56:59], v[84:87]
s_waitcnt lgkmcnt(6)
ds_read_b128 a[120:123], v4 offset:30720
v_exp_f32 v10, v58
v_exp_f32 v11, v59
v_add_f32 v27, v27, v15
v_cvt_pk_bf16_f32 v109, v14, v15
v_mfma_f32_16x16x32_bf16 v[84:87], a[92:95], a[60:63], v[84:87]
s_waitcnt vmcnt(8) lgkmcnt(6)
s_barrier
ds_read_b128 a[124:127], v4 offset:31744
v_mfma_f32_16x16x32_bf16 v[92:95], a[96:99], a[32:35], v[92:95]
s_waitcnt lgkmcnt(6)
ds_read_b128 a[64:67], v2 offset:0
v_exp_f32 v12, v60
v_exp_f32 v13, v61
v_mfma_f32_16x16x32_bf16 v[92:95], a[100:103], a[36:39], v[92:95]
s_waitcnt lgkmcnt(6)
ds_read_b128 a[68:71], v2 offset:1024
v_exp_f32 v14, v62
v_exp_f32 v15, v63
v_mfma_f32_16x16x32_bf16 v[92:95], a[104:107], a[40:43], v[92:95]
s_waitcnt lgkmcnt(6)
ds_read_b128 a[72:75], v2 offset:2048
v_add_f32 v26, v26, v8
v_add_f32 v26, v26, v9
v_cvt_pk_bf16_f32 v102, v8, v9
v_mfma_f32_16x16x32_bf16 v[92:95], a[108:111], a[44:47], v[92:95]
s_waitcnt lgkmcnt(6)
ds_read_b128 a[76:79], v2 offset:3072
v_add_f32 v26, v26, v10
v_add_f32 v26, v26, v11
v_cvt_pk_bf16_f32 v103, v10, v11
v_mfma_f32_16x16x32_bf16 v[92:95], a[112:115], a[48:51], v[92:95]
s_waitcnt lgkmcnt(6)
ds_read_b128 a[80:83], v2 offset:4096
v_add_f32 v27, v27, v12
v_mfma_f32_16x16x32_bf16 v[92:95], a[116:119], a[52:55], v[92:95]
s_waitcnt lgkmcnt(6)
ds_read_b128 a[84:87], v2 offset:5120
v_add_f32 v27, v27, v13
v_cvt_pk_bf16_f32 v110, v12, v13
v_mfma_f32_16x16x32_bf16 v[92:95], a[120:123], a[56:59], v[92:95]
s_waitcnt lgkmcnt(6)
ds_read_b128 a[88:91], v2 offset:6144
v_add_f32 v27, v27, v14
v_add_f32 v27, v27, v15
v_cvt_pk_bf16_f32 v111, v14, v15
v_mfma_f32_16x16x32_bf16 v[92:95], a[124:127], a[60:63], v[92:95]
s_waitcnt lgkmcnt(6)
ds_read_b128 a[92:95], v2 offset:7168
v_add_f32 v28, v26, v27
v_cmp_nge_f32 vcc, s25, v28
s_cbranch_vccnz Lstub_8
Lback_9:
s_cmp_lg_u32 s24, 1
s_cbranch_scc1 K2_plain
v_cmp_gt_u32 vcc, 1, v3
s_cbranch_vccnz K2_tspin
K2_tok:
v_mfma_f32_16x16x32_bf16 v[128:131], a[64:67], v[96:99], v[128:131]
s_waitcnt lgkmcnt(6)
ds_read_b128 a[96:99], v2 offset:8192
v_add_f32 v24, v24, v26
v_mfma_f32_16x16x32_bf16 v[128:131], a[68:71], v[100:103], v[128:131]
buffer_load_dwordx4 v[28:31], v1, s[4:7], s27 offen sc1
v_mfma_f32_16x16x32_bf16 v[132:135], a[68:71], v[108:111], v[132:135]
ds_read_b128 a[100:103], v2 offset:9216
v_add_f32 v25, v25, v27
v_mfma_f32_16x16x32_bf16 v[132:135], a[64:67], v[104:107], v[132:135]
s_waitcnt lgkmcnt(6)
v_exp_f32 v8, v68
v_mfma_f32_16x16x32_bf16 v[136:139], a[72:75], v[96:99], v[136:139]
s_add_u32 s22, s76, 0
ds_read_b128 a[104:107], v2 offset:10240
v_exp_f32 v9, v69
v_mfma_f32_16x16x32_bf16 v[136:139], a[76:79], v[100:103], v[136:139]
buffer_load_dwordx4 v[32:35], v1, s[4:7], s22 offen offset:0 sc1
v_mfma_f32_16x16x32_bf16 v[140:143], a[76:79], v[108:111], v[140:143]
ds_read_b128 a[108:111], v2 offset:11264
v_add_f32 v27, v8, v9
v_mfma_f32_16x16x32_bf16 v[140:143], a[72:75], v[104:107], v[140:143]
s_waitcnt lgkmcnt(5)
v_exp_f32 v10, v70
v_mfma_f32_16x16x32_bf16 v[144:147], a[80:83], v[96:99], v[144:147]
ds_read_b128 a[112:115], v2 offset:12288
v_cvt_pk_bf16_f32 v120, v8, v9
v_mfma_f32_16x16x32_bf16 v[144:147], a[84:87], v[100:103], v[144:147]
buffer_load_dwordx4 v[36:39], v1, s[4:7], s22 offen offset:1024 sc1
v_mfma_f32_16x16x32_bf16 v[148:151], a[84:87], v[108:111], v[148:151]
ds_read_b128 a[116:119], v2 offset:13312
v_add_f32 v27, v27, v10
v_mfma_f32_16x16x32_bf16 v[148:151], a[80:83], v[104:107], v[148:151]
v_exp_f32 v11, v71
v_mfma_f32_16x16x32_bf16 v[152:155], a[88:91], v[96:99], v[152:155]
s_waitcnt lgkmcnt(4)
ds_read_b128 a[120:123], v2 offset:14336
v_add_f32 v27, v27, v11
v_mfma_f32_16x16x32_bf16 v[152:155], a[92:95], v[100:103], v[152:155]
buffer_load_dwordx4 v[40:43], v1, s[4:7], s22 offen offset:2048 sc1
v_mfma_f32_16x16x32_bf16 v[156:159], a[92:95], v[108:111], v[156:159]
ds_read_b128 a[124:127], v2 offset:15360
v_cvt_pk_bf16_f32 v121, v10, v11
v_mfma_f32_16x16x32_bf16 v[156:159], a[88:91], v[104:107], v[156:159]
v_exp_f32 v12, v76
v_mfma_f32_16x16x32_bf16 v[160:163], a[96:99], v[96:99], v[160:163]
ds_read_b128 a[64:67], v2 offset:16384
v_add_f32 v27, v27, v12
v_mfma_f32_16x16x32_bf16 v[160:163], a[100:103], v[100:103], v[160:163]
buffer_load_dwordx4 v[44:47], v1, s[4:7], s22 offen offset:3072 sc1
v_mfma_f32_16x16x32_bf16 v[164:167], a[100:103], v[108:111], v[164:167]
PAD_12:
s_cbranch_execz M_tret
ds_read_b128 a[68:71], v2 offset:17408
v_mfma_f32_16x16x32_bf16 v[164:167], a[96:99], v[104:107], v[164:167]
s_waitcnt lgkmcnt(4)
v_exp_f32 v13, v77
v_mfma_f32_16x16x32_bf16 v[168:171], a[104:107], v[96:99], v[168:171]
s_add_u32 s22, s76, 4096
ds_read_b128 a[72:75], v2 offset:18432
v_add_f32 v27, v27, v13
v_mfma_f32_16x16x32_bf16 v[168:171], a[108:111], v[100:103], v[168:171]
buffer_load_dwordx4 v[48:51], v1, s[4:7], s22 offen offset:0 sc1
v_mfma_f32_16x16x32_bf16 v[172:175], a[108:111], v[108:111], v[172:175]
ds_read_b128 a[76:79], v2 offset:19456
v_exp_f32 v14, v78
v_mfma_f32_16x16x32_bf16 v[172:175], a[104:107], v[104:107], v[172:175]
v_exp_f32 v15, v79
v_mfma_f32_16x16x32_bf16 v[176:179], a[112:115], v[96:99], v[176:179]
ds_read_b128 a[80:83], v2 offset:20480
v_cvt_pk_bf16_f32 v122, v12, v13
v_mfma_f32_16x16x32_bf16 v[176:179], a[116:119], v[100:103], v[176:179]
buffer_load_dwordx4 v[52:55], v1, s[4:7], s22 offen offset:1024 sc1
v_mfma_f32_16x16x32_bf16 v[180:183], a[116:119], v[108:111], v[180:183]
ds_read_b128 a[84:87], v2 offset:21504
v_add_f32 v27, v27, v14
v_mfma_f32_16x16x32_bf16 v[180:183], a[112:115], v[104:107], v[180:183]
s_waitcnt lgkmcnt(4)
v_exp_f32 v8, v84
v_mfma_f32_16x16x32_bf16 v[184:187], a[120:123], v[96:99], v[184:187]
ds_read_b128 a[88:91], v2 offset:22528
v_add_f32 v27, v27, v15
v_cvt_pk_bf16_f32 v123, v14, v15
v_mfma_f32_16x16x32_bf16 v[184:187], a[124:127], v[100:103], v[184:187]
buffer_load_dwordx4 v[56:59], v1, s[4:7], s22 offen offset:2048 sc1
v_mfma_f32_16x16x32_bf16 v[188:191], a[124:127], v[108:111], v[188:191]
ds_read_b128 a[92:95], v2 offset:23552
v_add_f32 v27, v27, v8
v_mfma_f32_16x16x32_bf16 v[188:191], a[120:123], v[104:107], v[188:191]
v_exp_f32 v9, v85
v_mfma_f32_16x16x32_bf16 v[192:195], a[64:67], v[96:99], v[192:195]
ds_read_b128 a[96:99], v2 offset:24576
v_add_f32 v27, v27, v9
v_mfma_f32_16x16x32_bf16 v[192:195], a[68:71], v[100:103], v[192:195]
buffer_load_dwordx4 v[60:63], v1, s[4:7], s22 offen offset:3072 sc1
v_mfma_f32_16x16x32_bf16 v[196:199], a[68:71], v[108:111], v[196:199]
ds_read_b128 a[100:103], v2 offset:25600
v_cvt_pk_bf16_f32 v124, v8, v9
v_mfma_f32_16x16x32_bf16 v[196:199], a[64:67], v[104:107], v[196:199]
s_waitcnt lgkmcnt(4)
v_exp_f32 v10, v86
v_mfma_f32_16x16x32_bf16 v[200:203], a[72:75], v[96:99], v[200:203]
s_add_u32 s22, s76, 8192
ds_read_b128 a[104:107], v2 offset:26624
v_add_f32 v27, v27, v10
v_mfma_f32_16x16x32_bf16 v[200:203], a[76:79], v[100:103], v[200:203]
buffer_load_dwordx4 a[32:35], v1, s[4:7], s22 offen offset:0 sc1
v_mfma_f32_16x16x32_bf16 v[204:207], a[76:79], v[108:111], v[204:207]
ds_read_b128 a[108:111], v2 offset:27648
v_mfma_f32_16x16x32_bf16 v[204:207], a[72:75], v[104:107], v[204:207]
v_exp_f32 v11, v87
v_mfma_f32_16x16x32_bf16 v[208:211], a[80:83], v[96:99], v[208:211]
ds_read_b128 a[112:115], v2 offset:28672
v_exp_f32 v12, v92
v_mfma_f32_16x16x32_bf16 v[208:211], a[84:87], v[100:103], v[208:211]
buffer_load_dwordx4 a[36:39], v1, s[4:7], s22 offen offset:1024 sc1
v_mfma_f32_16x16x32_bf16 v[212:215], a[84:87], v[108:111], v[212:215]
ds_read_b128 a[116:119], v2 offset:29696
v_add_f32 v27, v27, v11
v_mfma_f32_16x16x32_bf16 v[212:215], a[80:83], v[104:107], v[212:215]
s_waitcnt lgkmcnt(4)
v_exp_f32 v13, v93
v_mfma_f32_16x16x32_bf16 v[216:219], a[88:91], v[96:99], v[216:219]
ds_read_b128 a[120:123], v2 offset:30720
v_cvt_pk_bf16_f32 v125, v10, v11
v_add_f32 v27, v27, v12
v_mfma_f32_16x16x32_bf16 v[216:219], a[92:95], v[100:103], v[216:219]
buffer_load_dwordx4 a[40:43], v1, s[4:7], s22 offen offset:2048 sc1
v_mfma_f32_16x16x32_bf16 v[220:223], a[92:95], v[108:111], v[220:223]
s_waitcnt vmcnt(12)
ds_read_b128 a[124:127], v2 offset:31744
v_add_f32 v27, v27, v13
v_mfma_f32_16x16x32_bf16 v[220:223], a[88:91], v[104:107], v[220:223]
s_barrier
v_mfma_f32_16x16x32_bf16 v[224:227], a[96:99], v[96:99], v[224:227]
ds_read_b128 a[64:67], v1 offset:0
v_cvt_pk_bf16_f32 v126, v12, v13
v_mfma_f32_16x16x32_bf16 v[224:227], a[100:103], v[100:103], v[224:227]
buffer_load_dwordx4 a[44:47], v1, s[4:7], s22 offen offset:3072 sc1
v_mfma_f32_16x16x32_bf16 v[228:231], a[100:103], v[108:111], v[228:231]
ds_read_b128 a[68:71], v1 offset:1024
v_mfma_f32_16x16x32_bf16 v[228:231], a[96:99], v[104:107], v[228:231]
s_waitcnt lgkmcnt(4)
v_exp_f32 v14, v94
v_mfma_f32_16x16x32_bf16 v[232:235], a[104:107], v[96:99], v[232:235]
s_add_u32 s22, s76, 12288
ds_read_b128 a[72:75], v1 offset:2048
v_add_f32 v27, v27, v14
v_mfma_f32_16x16x32_bf16 v[232:235], a[108:111], v[100:103], v[232:235]
buffer_load_dwordx4 a[48:51], v1, s[4:7], s22 offen offset:0 sc1
v_mfma_f32_16x16x32_bf16 v[236:239], a[108:111], v[108:111], v[236:239]
ds_read_b128 a[76:79], v1 offset:3072
v_mfma_f32_16x16x32_bf16 v[236:239], a[104:107], v[104:107], v[236:239]
v_exp_f32 v15, v95
v_mfma_f32_16x16x32_bf16 v[240:243], a[112:115], v[96:99], v[240:243]
ds_read_b128 a[80:83], v1 offset:4096
v_add_f32 v27, v27, v15
v_mfma_f32_16x16x32_bf16 v[240:243], a[116:119], v[100:103], v[240:243]
buffer_load_dwordx4 a[52:55], v1, s[4:7], s22 offen offset:1024 sc1
v_mfma_f32_16x16x32_bf16 v[244:247], a[116:119], v[108:111], v[244:247]
ds_read_b128 a[84:87], v1 offset:5120
v_cvt_pk_bf16_f32 v127, v14, v15
v_mfma_f32_16x16x32_bf16 v[244:247], a[112:115], v[104:107], v[244:247]
s_waitcnt lgkmcnt(4)
v_cmp_nge_f32 vcc, s25, v27
v_mfma_f32_16x16x32_bf16 v[248:251], a[120:123], v[96:99], v[248:251]
ds_read_b128 a[88:91], v1 offset:6144
v_mfma_f32_16x16x32_bf16 v[248:251], a[124:127], v[100:103], v[248:251]
buffer_load_dwordx4 a[56:59], v1, s[4:7], s22 offen offset:2048 sc1
v_mfma_f32_16x16x32_bf16 v[252:255], a[124:127], v[108:111], v[252:255]
ds_read_b128 a[92:95], v1 offset:7168
v_mfma_f32_16x16x32_bf16 v[252:255], a[120:123], v[104:107], v[252:255]
s_waitcnt lgkmcnt(2)
buffer_load_dwordx4 a[60:63], v1, s[4:7], s22 offen offset:3072 sc1
s_cbranch_vccnz Lstub_10
Lback_11:
v_mfma_f32_16x16x32_bf16 v[132:135], a[64:67], v[120:123], v[132:135]
s_mov_b64 s[36:37], s[86:87]
ds_read_b128 a[96:99], v1 offset:8192
v_add_f32 v25, v25, v27
v_mfma_f32_16x16x32_bf16 v[132:135], a[68:71], v[124:127], v[132:135]
s_mov_b32 s38, 3670016
ds_read_b128 a[100:103], v1 offset:9216
v_accvgpr_read_b32 v112, a184
v_mfma_f32_16x16x32_bf16 v[140:143], a[72:75], v[120:123], v[140:143]
s_mov_b32 s39, 0x20000
ds_read_b128 a[104:107], v1 offset:10240
v_accvgpr_read_b32 v113, a185
v_mfma_f32_16x16x32_bf16 v[140:143], a[76:79], v[124:127], v[140:143]
s_lshl_b32 s8, s29, 3
ds_read_b128 a[108:111], v1 offset:11264
v_accvgpr_read_b32 v114, a186
v_mfma_f32_16x16x32_bf16 v[148:151], a[80:83], v[120:123], v[148:151]
s_add_u32 s8, s8, s3
ds_read_b128 a[112:115], v1 offset:12288
v_accvgpr_read_b32 v115, a187
v_mfma_f32_16x16x32_bf16 v[148:151], a[84:87], v[124:127], v[148:151]
s_waitcnt lgkmcnt(3)
s_lshl_b32 s8, s8, 4
ds_read_b128 a[116:119], v1 offset:13312
v_accvgpr_read_b32 v116, a188
v_mfma_f32_16x16x32_bf16 v[156:159], a[88:91], v[120:123], v[156:159]
s_add_u32 s8, s8, s20
ds_read_b128 a[120:123], v1 offset:14336
v_accvgpr_read_b32 v117, a189
v_mfma_f32_16x16x32_bf16 v[156:159], a[92:95], v[124:127], v[156:159]
s_mul_i32 s8, s8, 14336
ds_read_b128 a[124:127], v1 offset:15360
v_accvgpr_read_b32 v118, a190
v_mfma_f32_16x16x32_bf16 v[164:167], a[96:99], v[120:123], v[164:167]
s_add_u32 s8, s8, 104857600
ds_read_b128 a[64:67], v1 offset:16384
v_accvgpr_read_b32 v119, a191
v_mfma_f32_16x16x32_bf16 v[164:167], a[100:103], v[124:127], v[164:167]
s_waitcnt lgkmcnt(6)
s_add_u32 s12, s8, 917504
ds_read_b128 a[68:71], v1 offset:17408
v_mfma_f32_16x16x32_bf16 v[172:175], a[104:107], v[120:123], v[172:175]
s_waitcnt lgkmcnt(6)
ds_read_b128 a[72:75], v1 offset:18432
v_mfma_f32_16x16x32_bf16 v[172:175], a[108:111], v[124:127], v[172:175]
s_waitcnt lgkmcnt(6)
ds_read_b128 a[76:79], v1 offset:19456
v_mfma_f32_16x16x32_bf16 v[180:183], a[112:115], v[120:123], v[180:183]
s_waitcnt lgkmcnt(6)
ds_read_b128 a[80:83], v1 offset:20480
v_mfma_f32_16x16x32_bf16 v[180:183], a[116:119], v[124:127], v[180:183]
s_waitcnt lgkmcnt(6)
ds_read_b128 a[84:87], v1 offset:21504
v_mfma_f32_16x16x32_bf16 v[188:191], a[120:123], v[120:123], v[188:191]
s_waitcnt lgkmcnt(6)
ds_read_b128 a[88:91], v1 offset:22528
v_mfma_f32_16x16x32_bf16 v[188:191], a[124:127], v[124:127], v[188:191]
s_waitcnt lgkmcnt(6)
ds_read_b128 a[92:95], v1 offset:23552
v_mfma_f32_16x16x32_bf16 v[196:199], a[64:67], v[120:123], v[196:199]
s_waitcnt lgkmcnt(6)
ds_read_b128 a[96:99], v1 offset:24576
v_mfma_f32_16x16x32_bf16 v[196:199], a[68:71], v[124:127], v[196:199]
s_waitcnt lgkmcnt(6)
ds_read_b128 a[100:103], v1 offset:25600
v_mfma_f32_16x16x32_bf16 v[204:207], a[72:75], v[120:123], v[204:207]
s_waitcnt lgkmcnt(6)
ds_read_b128 a[104:107], v1 offset:26624
v_mfma_f32_16x16x32_bf16 v[204:207], a[76:79], v[124:127], v[204:207]
s_waitcnt lgkmcnt(6)
ds_read_b128 a[108:111], v1 offset:27648
v_mfma_f32_16x16x32_bf16 v[212:215], a[80:83], v[120:123], v[212:215]
s_waitcnt lgkmcnt(6)
ds_read_b128 a[112:115], v1 offset:28672
v_mfma_f32_16x16x32_bf16 v[212:215], a[84:87], v[124:127], v[212:215]
s_waitcnt lgkmcnt(6)
ds_read_b128 a[116:119], v1 offset:29696
v_mfma_f32_16x16x32_bf16 v[220:223], a[88:91], v[120:123], v[220:223]
s_waitcnt lgkmcnt(6)
s_add_u32 m0, s18, 32768
ds_read_b128 a[120:123], v1 offset:30720
v_mfma_f32_16x16x32_bf16 v[220:223], a[92:95], v[124:127], v[220:223]
s_waitcnt lgkmcnt(6)
ds_read_b128 a[124:127], v1 offset:31744
v_mfma_f32_16x16x32_bf16 v[228:231], a[96:99], v[120:123], v[228:231]
s_waitcnt lgkmcnt(6)
buffer_load_dwordx4 v112, s[36:39], s81 offen offset:0 lds
v_mfma_f32_16x16x32_bf16 v[228:231], a[100:103], v[124:127], v[228:231]
s_waitcnt lgkmcnt(5)
buffer_load_dwordx4 v113, s[36:39], s81 offen offset:1024 lds
v_mfma_f32_16x16x32_bf16 v[236:239], a[104:107], v[120:123], v[236:239]
s_waitcnt lgkmcnt(4)
buffer_load_dwordx4 v114, s[36:39], s81 offen offset:2048 lds
v_mfma_f32_16x16x32_bf16 v[236:239], a[108:111], v[124:127], v[236:239]
s_waitcnt lgkmcnt(3)
buffer_load_dwordx4 v115, s[36:39], s81 offen offset:3072 lds
v_mfma_f32_16x16x32_bf16 v[244:247], a[112:115], v[120:123], v[244:247]
s_waitcnt lgkmcnt(2)
s_add_u32 s81, s81, 28672
v_mfma_f32_16x16x32_bf16 v[244:247], a[116:119], v[124:127], v[244:247]
s_waitcnt lgkmcnt(1)
s_add_u32 m0, s18, 36864
v_mfma_f32_16x16x32_bf16 v[252:255], a[120:123], v[120:123], v[252:255]
s_waitcnt lgkmcnt(0)
buffer_load_dwordx4 v112, s[36:39], s81 offen offset:0 lds
v_mfma_f32_16x16x32_bf16 v[252:255], a[124:127], v[124:127], v[252:255]
buffer_load_dwordx4 v113, s[36:39], s81 offen offset:1024 lds
buffer_load_dwordx4 v114, s[36:39], s81 offen offset:2048 lds
buffer_load_dwordx4 v115, s[36:39], s81 offen offset:3072 lds
s_sub_u32 s81, s81, 28544
s_waitcnt vmcnt(8)
v_sub_f32 v8, v16, v28
v_sub_f32 v10, v20, v30
v_max_f32 v9, v8, v10
v_cmp_lt_f32 vcc, 1114636288, v9
s_cbranch_vccnz K2_cfix
K2_cok:
v_exp_f32 v8, v8
v_exp_f32 v10, v10
s_nop 0
v_mov_b32 v9, v8
v_mov_b32 v11, v10
v_fmac_f32 v24, v8, v29
v_fmac_f32 v25, v10, v31
s_mov_b32 s23, 0xffff0000
v_lshlrev_b32 v64, 16, v32
v_and_b32 v65, s23, v32
v_lshlrev_b32 v66, 16, v33
v_and_b32 v67, s23, v33
v_lshlrev_b32 v68, 16, v34
v_and_b32 v69, s23, v34
v_lshlrev_b32 v70, 16, v35
v_and_b32 v71, s23, v35
v_pk_fma_f32 v[128:129], v[64:65], v[8:9], v[128:129]
v_pk_fma_f32 v[130:131], v[66:67], v[8:9], v[130:131]
v_pk_fma_f32 v[136:137], v[68:69], v[8:9], v[136:137]
v_pk_fma_f32 v[138:139], v[70:71], v[8:9], v[138:139]
v_cvt_pk_bf16_f32 v128, v128, v129
v_cvt_pk_bf16_f32 v129, v130, v131
v_cvt_pk_bf16_f32 v130, v136, v137
v_cvt_pk_bf16_f32 v131, v138, v139
s_add_u32 m0, s18, 98304
s_nop 0
buffer_load_dwordx4 v112, s[36:39], s81 offen offset:0 lds
v_lshlrev_b32 v64, 16, v36
v_and_b32 v65, s23, v36
v_lshlrev_b32 v66, 16, v37
v_and_b32 v67, s23, v37
v_lshlrev_b32 v68, 16, v38
v_and_b32 v69, s23, v38
v_lshlrev_b32 v70, 16, v39
v_and_b32 v71, s23, v39
v_pk_fma_f32 v[144:145], v[64:65], v[8:9], v[144:145]
v_pk_fma_f32 v[146:147], v[66:67], v[8:9], v[146:147]
v_pk_fma_f32 v[152:153], v[68:69], v[8:9], v[152:153]
v_pk_fma_f32 v[154:155], v[70:71], v[8:9], v[154:155]
v_cvt_pk_bf16_f32 v144, v144, v145
v_cvt_pk_bf16_f32 v145, v146, v147
v_cvt_pk_bf16_f32 v146, v152, v153
v_cvt_pk_bf16_f32 v147, v154, v155
buffer_load_dwordx4 v113, s[36:39], s81 offen offset:1024 lds
v_lshlrev_b32 v64, 16, v40
v_and_b32 v65, s23, v40
v_lshlrev_b32 v66, 16, v41
v_and_b32 v67, s23, v41
v_lshlrev_b32 v68, 16, v42
v_and_b32 v69, s23, v42
v_lshlrev_b32 v70, 16, v43
v_and_b32 v71, s23, v43
v_pk_fma_f32 v[160:161], v[64:65], v[8:9], v[160:161]
v_pk_fma_f32 v[162:163], v[66:67], v[8:9], v[162:163]
v_pk_fma_f32 v[168:169], v[68:69], v[8:9], v[168:169]
v_pk_fma_f32 v[170:171], v[70:71], v[8:9], v[170:171]
v_cvt_pk_bf16_f32 v160, v160, v161
v_cvt_pk_bf16_f32 v161, v162, v163
v_cvt_pk_bf16_f32 v162, v168, v169
v_cvt_pk_bf16_f32 v163, v170, v171
buffer_load_dwordx4 v114, s[36:39], s81 offen offset:2048 lds
v_lshlrev_b32 v64, 16, v44
v_and_b32 v65, s23, v44
v_lshlrev_b32 v66, 16, v45
v_and_b32 v67, s23, v45
v_lshlrev_b32 v68, 16, v46
v_and_b32 v69, s23, v46
v_lshlrev_b32 v70, 16, v47
v_and_b32 v71, s23, v47
v_pk_fma_f32 v[176:177], v[64:65], v[8:9], v[176:177]
v_pk_fma_f32 v[178:179], v[66:67], v[8:9], v[178:179]
v_pk_fma_f32 v[184:185], v[68:69], v[8:9], v[184:185]
v_pk_fma_f32 v[186:187], v[70:71], v[8:9], v[186:187]
v_cvt_pk_bf16_f32 v176, v176, v177
v_cvt_pk_bf16_f32 v177, v178, v179
v_cvt_pk_bf16_f32 v178, v184, v185
v_cvt_pk_bf16_f32 v179, v186, v187
buffer_load_dwordx4 v115, s[36:39], s81 offen offset:3072 lds
v_lshlrev_b32 v64, 16, v48
v_and_b32 v65, s23, v48
v_lshlrev_b32 v66, 16, v49
v_and_b32 v67, s23, v49
v_lshlrev_b32 v68, 16, v50
v_and_b32 v69, s23, v50
v_lshlrev_b32 v70, 16, v51
v_and_b32 v71, s23, v51
v_pk_fma_f32 v[192:193], v[64:65], v[8:9], v[192:193]
v_pk_fma_f32 v[194:195], v[66:67], v[8:9], v[194:195]
v_pk_fma_f32 v[200:201], v[68:69], v[8:9], v[200:201]
v_pk_fma_f32 v[202:203], v[70:71], v[8:9], v[202:203]
v_cvt_pk_bf16_f32 v192, v192, v193
v_cvt_pk_bf16_f32 v193, v194, v195
v_cvt_pk_bf16_f32 v194, v200, v201
v_cvt_pk_bf16_f32 v195, v202, v203
s_add_u32 s81, s81, 28672
s_add_u32 m0, s18, 102400
s_nop 0
buffer_load_dwordx4 v112, s[36:39], s81 offen offset:0 lds
v_lshlrev_b32 v64, 16, v52
v_and_b32 v65, s23, v52
v_lshlrev_b32 v66, 16, v53
v_and_b32 v67, s23, v53
v_lshlrev_b32 v68, 16, v54
v_and_b32 v69, s23, v54
v_lshlrev_b32 v70, 16, v55
v_and_b32 v71, s23, v55
v_pk_fma_f32 v[208:209], v[64:65], v[8:9], v[208:209]
v_pk_fma_f32 v[210:211], v[66:67], v[8:9], v[210:211]
v_pk_fma_f32 v[216:217], v[68:69], v[8:9], v[216:217]
v_pk_fma_f32 v[218:219], v[70:71], v[8:9], v[218:219]
v_cvt_pk_bf16_f32 v208, v208, v209
v_cvt_pk_bf16_f32 v209, v210, v211
v_cvt_pk_bf16_f32 v210, v216, v217
v_cvt_pk_bf16_f32 v211, v218, v219
buffer_load_dwordx4 v113, s[36:39], s81 offen offset:1024 lds
v_lshlrev_b32 v64, 16, v56
v_and_b32 v65, s23, v56
v_lshlrev_b32 v66, 16, v57
v_and_b32 v67, s23, v57
v_lshlrev_b32 v68, 16, v58
v_and_b32 v69, s23, v58
v_lshlrev_b32 v70, 16, v59
v_and_b32 v71, s23, v59
v_pk_fma_f32 v[224:225], v[64:65], v[8:9], v[224:225]
v_pk_fma_f32 v[226:227], v[66:67], v[8:9], v[226:227]
v_pk_fma_f32 v[232:233], v[68:69], v[8:9], v[232:233]
v_pk_fma_f32 v[234:235], v[70:71], v[8:9], v[234:235]
v_cvt_pk_bf16_f32 v224, v224, v225
v_cvt_pk_bf16_f32 v225, v226, v227
v_cvt_pk_bf16_f32 v226, v232, v233
v_cvt_pk_bf16_f32 v227, v234, v235
buffer_load_dwordx4 v114, s[36:39], s81 offen offset:2048 lds
v_lshlrev_b32 v64, 16, v60
v_and_b32 v65, s23, v60
v_lshlrev_b32 v66, 16, v61
v_and_b32 v67, s23, v61
v_lshlrev_b32 v68, 16, v62
v_and_b32 v69, s23, v62
v_lshlrev_b32 v70, 16, v63
v_and_b32 v71, s23, v63
v_pk_fma_f32 v[240:241], v[64:65], v[8:9], v[240:241]
v_pk_fma_f32 v[242:243], v[66:67], v[8:9], v[242:243]
v_pk_fma_f32 v[248:249], v[68:69], v[8:9], v[248:249]
v_pk_fma_f32 v[250:251], v[70:71], v[8:9], v[250:251]
v_cvt_pk_bf16_f32 v240, v240, v241
v_cvt_pk_bf16_f32 v241, v242, v243
v_cvt_pk_bf16_f32 v242, v248, v249
v_cvt_pk_bf16_f32 v243, v250, v251
buffer_load_dwordx4 v115, s[36:39], s81 offen offset:3072 lds
v_accvgpr_read_b32 v32, a32
v_accvgpr_read_b32 v33, a33
v_accvgpr_read_b32 v34, a34
v_accvgpr_read_b32 v35, a35
v_lshlrev_b32 v64, 16, v32
v_and_b32 v65, s23, v32
v_lshlrev_b32 v66, 16, v33
v_and_b32 v67, s23, v33
v_lshlrev_b32 v68, 16, v34
v_and_b32 v69, s23, v34
v_lshlrev_b32 v70, 16, v35
v_and_b32 v71, s23, v35
v_pk_fma_f32 v[132:133], v[64:65], v[10:11], v[132:133]
v_pk_fma_f32 v[134:135], v[66:67], v[10:11], v[134:135]
v_pk_fma_f32 v[140:141], v[68:69], v[10:11], v[140:141]
v_pk_fma_f32 v[142:143], v[70:71], v[10:11], v[142:143]
v_cvt_pk_bf16_f32 v132, v132, v133
v_cvt_pk_bf16_f32 v133, v134, v135
v_cvt_pk_bf16_f32 v134, v140, v141
v_cvt_pk_bf16_f32 v135, v142, v143
s_sub_u32 s81, s81, 28544
s_add_u32 m0, s18, 131072
s_nop 0
buffer_load_dwordx4 v112, s[36:39], s81 offen offset:0 lds
v_accvgpr_read_b32 v36, a36
v_accvgpr_read_b32 v37, a37
v_accvgpr_read_b32 v38, a38
v_accvgpr_read_b32 v39, a39
v_lshlrev_b32 v64, 16, v36
v_and_b32 v65, s23, v36
v_lshlrev_b32 v66, 16, v37
v_and_b32 v67, s23, v37
v_lshlrev_b32 v68, 16, v38
v_and_b32 v69, s23, v38
v_lshlrev_b32 v70, 16, v39
v_and_b32 v71, s23, v39
v_pk_fma_f32 v[148:149], v[64:65], v[10:11], v[148:149]
v_pk_fma_f32 v[150:151], v[66:67], v[10:11], v[150:151]
v_pk_fma_f32 v[156:157], v[68:69], v[10:11], v[156:157]
v_pk_fma_f32 v[158:159], v[70:71], v[10:11], v[158:159]
v_cvt_pk_bf16_f32 v148, v148, v149
v_cvt_pk_bf16_f32 v149, v150, v151
v_cvt_pk_bf16_f32 v150, v156, v157
v_cvt_pk_bf16_f32 v151, v158, v159
buffer_load_dwordx4 v113, s[36:39], s81 offen offset:1024 lds
v_accvgpr_read_b32 v40, a40
v_accvgpr_read_b32 v41, a41
v_accvgpr_read_b32 v42, a42
v_accvgpr_read_b32 v43, a43
v_lshlrev_b32 v64, 16, v40
v_and_b32 v65, s23, v40
v_lshlrev_b32 v66, 16, v41
v_and_b32 v67, s23, v41
v_lshlrev_b32 v68, 16, v42
v_and_b32 v69, s23, v42
v_lshlrev_b32 v70, 16, v43
v_and_b32 v71, s23, v43
v_pk_fma_f32 v[164:165], v[64:65], v[10:11], v[164:165]
v_pk_fma_f32 v[166:167], v[66:67], v[10:11], v[166:167]
v_pk_fma_f32 v[172:173], v[68:69], v[10:11], v[172:173]
v_pk_fma_f32 v[174:175], v[70:71], v[10:11], v[174:175]
v_cvt_pk_bf16_f32 v164, v164, v165
v_cvt_pk_bf16_f32 v165, v166, v167
v_cvt_pk_bf16_f32 v166, v172, v173
v_cvt_pk_bf16_f32 v167, v174, v175
buffer_load_dwordx4 v114, s[36:39], s81 offen offset:2048 lds
v_accvgpr_read_b32 v44, a44
v_accvgpr_read_b32 v45, a45
v_accvgpr_read_b32 v46, a46
v_accvgpr_read_b32 v47, a47
v_lshlrev_b32 v64, 16, v44
v_and_b32 v65, s23, v44
v_lshlrev_b32 v66, 16, v45
v_and_b32 v67, s23, v45
v_lshlrev_b32 v68, 16, v46
v_and_b32 v69, s23, v46
v_lshlrev_b32 v70, 16, v47
v_and_b32 v71, s23, v47
v_pk_fma_f32 v[180:181], v[64:65], v[10:11], v[180:181]
v_pk_fma_f32 v[182:183], v[66:67], v[10:11], v[182:183]
v_pk_fma_f32 v[188:189], v[68:69], v[10:11], v[188:189]
v_pk_fma_f32 v[190:191], v[70:71], v[10:11], v[190:191]
v_cvt_pk_bf16_f32 v180, v180, v181
v_cvt_pk_bf16_f32 v181, v182, v183
v_cvt_pk_bf16_f32 v182, v188, v189
v_cvt_pk_bf16_f32 v183, v190, v191
buffer_load_dwordx4 v115, s[36:39], s81 offen offset:3072 lds
v_accvgpr_read_b32 v48, a48
v_accvgpr_read_b32 v49, a49
v_accvgpr_read_b32 v50, a50
v_accvgpr_read_b32 v51, a51
v_lshlrev_b32 v64, 16, v48
v_and_b32 v65, s23, v48
v_lshlrev_b32 v66, 16, v49
v_and_b32 v67, s23, v49
v_lshlrev_b32 v68, 16, v50
v_and_b32 v69, s23, v50
v_lshlrev_b32 v70, 16, v51
v_and_b32 v71, s23, v51
v_pk_fma_f32 v[196:197], v[64:65], v[10:11], v[196:197]
v_pk_fma_f32 v[198:199], v[66:67], v[10:11], v[198:199]
v_pk_fma_f32 v[204:205], v[68:69], v[10:11], v[204:205]
v_pk_fma_f32 v[206:207], v[70:71], v[10:11], v[206:207]
v_cvt_pk_bf16_f32 v196, v196, v197
v_cvt_pk_bf16_f32 v197, v198, v199
v_cvt_pk_bf16_f32 v198, v204, v205
v_cvt_pk_bf16_f32 v199, v206, v207
s_add_u32 s81, s81, 28672
s_add_u32 m0, s18, 135168
s_nop 0
buffer_load_dwordx4 v112, s[36:39], s81 offen offset:0 lds
v_accvgpr_read_b32 v52, a52
v_accvgpr_read_b32 v53, a53
v_accvgpr_read_b32 v54, a54
v_accvgpr_read_b32 v55, a55
v_lshlrev_b32 v64, 16, v52
v_and_b32 v65, s23, v52
v_lshlrev_b32 v66, 16, v53
v_and_b32 v67, s23, v53
v_lshlrev_b32 v68, 16, v54
v_and_b32 v69, s23, v54
v_lshlrev_b32 v70, 16, v55
v_and_b32 v71, s23, v55
v_pk_fma_f32 v[212:213], v[64:65], v[10:11], v[212:213]
v_pk_fma_f32 v[214:215], v[66:67], v[10:11], v[214:215]
v_pk_fma_f32 v[220:221], v[68:69], v[10:11], v[220:221]
v_pk_fma_f32 v[222:223], v[70:71], v[10:11], v[222:223]
v_cvt_pk_bf16_f32 v212, v212, v213
v_cvt_pk_bf16_f32 v213, v214, v215
v_cvt_pk_bf16_f32 v214, v220, v221
v_cvt_pk_bf16_f32 v215, v222, v223
buffer_load_dwordx4 v113, s[36:39], s81 offen offset:1024 lds
v_accvgpr_read_b32 v56, a56
v_accvgpr_read_b32 v57, a57
v_accvgpr_read_b32 v58, a58
v_accvgpr_read_b32 v59, a59
v_lshlrev_b32 v64, 16, v56
v_and_b32 v65, s23, v56
v_lshlrev_b32 v66, 16, v57
v_and_b32 v67, s23, v57
v_lshlrev_b32 v68, 16, v58
v_and_b32 v69, s23, v58
v_lshlrev_b32 v70, 16, v59
v_and_b32 v71, s23, v59
v_pk_fma_f32 v[228:229], v[64:65], v[10:11], v[228:229]
v_pk_fma_f32 v[230:231], v[66:67], v[10:11], v[230:231]
v_pk_fma_f32 v[236:237], v[68:69], v[10:11], v[236:237]
v_pk_fma_f32 v[238:239], v[70:71], v[10:11], v[238:239]
v_cvt_pk_bf16_f32 v228, v228, v229
v_cvt_pk_bf16_f32 v229, v230, v231
v_cvt_pk_bf16_f32 v230, v236, v237
v_cvt_pk_bf16_f32 v231, v238, v239
buffer_load_dwordx4 v114, s[36:39], s81 offen offset:2048 lds
v_accvgpr_read_b32 v60, a60
v_accvgpr_read_b32 v61, a61
v_accvgpr_read_b32 v62, a62
v_accvgpr_read_b32 v63, a63
v_lshlrev_b32 v64, 16, v60
v_and_b32 v65, s23, v60
v_lshlrev_b32 v66, 16, v61
v_and_b32 v67, s23, v61
v_lshlrev_b32 v68, 16, v62
v_and_b32 v69, s23, v62
v_lshlrev_b32 v70, 16, v63
v_and_b32 v71, s23, v63
v_pk_fma_f32 v[244:245], v[64:65], v[10:11], v[244:245]
v_pk_fma_f32 v[246:247], v[66:67], v[10:11], v[246:247]
v_pk_fma_f32 v[252:253], v[68:69], v[10:11], v[252:253]
v_pk_fma_f32 v[254:255], v[70:71], v[10:11], v[254:255]
v_cvt_pk_bf16_f32 v244, v244, v245
v_cvt_pk_bf16_f32 v245, v246, v247
v_cvt_pk_bf16_f32 v246, v252, v253
v_cvt_pk_bf16_f32 v247, v254, v255
buffer_load_dwordx4 v115, s[36:39], s81 offen offset:3072 lds
s_sub_u32 s81, s81, 28544
K2_done:
PAD_13:
s_cbranch_execz PAD_17
s_waitcnt vmcnt(16)
s_barrier
ds_read_b64_tr_b16 a[64:65], v116 offset:0
ds_read_b64_tr_b16 a[66:67], v116 offset:2048
ds_read_b64_tr_b16 a[68:69], v116 offset:4096
ds_read_b64_tr_b16 a[70:71], v116 offset:6144
ds_read_b64_tr_b16 a[72:73], v116 offset:8192
ds_read_b64_tr_b16 a[74:75], v116 offset:10240
ds_read_b64_tr_b16 a[76:77], v116 offset:12288
ds_read_b64_tr_b16 a[78:79], v116 offset:14336
ds_read_b64_tr_b16 a[80:81], v116 offset:16384
ds_read_b64_tr_b16 a[82:83], v116 offset:18432
ds_read_b64_tr_b16 a[84:85], v116 offset:20480
ds_read_b64_tr_b16 a[86:87], v116 offset:22528
ds_read_b64_tr_b16 a[88:89], v116 offset:24576
ds_read_b64_tr_b16 a[90:91], v116 offset:26624
ds_read_b64_tr_b16 a[92:93], v116 offset:28672
ds_read_b64_tr_b16 a[94:95], v116 offset:30720
v_add_u32 v116, 65536, v116
s_waitcnt lgkmcnt(14)
v_mfma_f32_16x16x32_bf16 v[32:35], a[64:67], v[128:131], 0
s_waitcnt lgkmcnt(12)
s_add_u32 m0, s18, 65536
ds_read_b64_tr_b16 a[96:97], v117 offset:0
v_mov_b32 v28, v24
v_mfma_f32_16x16x32_bf16 v[32:35], a[68:71], v[144:147], v[32:35]
s_waitcnt lgkmcnt(11)
buffer_load_dwordx4 v112, s[36:39], s81 offen offset:0 lds
ds_read_b64_tr_b16 a[98:99], v117 offset:2048
v_mfma_f32_16x16x32_bf16 v[32:35], a[72:75], v[160:163], v[32:35]
s_waitcnt lgkmcnt(10)
ds_read_b64_tr_b16 a[100:101], v117 offset:4096
v_permlane16_swap_b32 v24, v28
v_mfma_f32_16x16x32_bf16 v[32:35], a[76:79], v[176:179], v[32:35]
s_waitcnt lgkmcnt(9)
ds_read_b64_tr_b16 a[102:103], v117 offset:6144
v_add_f32 v24, v24, v28
v_mfma_f32_16x16x32_bf16 v[32:35], a[80:83], v[192:195], v[32:35]
s_waitcnt lgkmcnt(8)
buffer_load_dwordx4 v113, s[36:39], s81 offen offset:1024 lds
ds_read_b64_tr_b16 a[104:105], v117 offset:8192
v_mfma_f32_16x16x32_bf16 v[32:35], a[84:87], v[208:211], v[32:35]
s_waitcnt lgkmcnt(7)
ds_read_b64_tr_b16 a[106:107], v117 offset:10240
v_mov_b32 v28, v24
v_mfma_f32_16x16x32_bf16 v[32:35], a[88:91], v[224:227], v[32:35]
s_waitcnt lgkmcnt(6)
ds_read_b64_tr_b16 a[108:109], v117 offset:12288
v_lshrrev_b32 v20, 4, v1
v_mfma_f32_16x16x32_bf16 v[32:35], a[92:95], v[240:243], v[32:35]
buffer_load_dwordx4 v114, s[36:39], s81 offen offset:2048 lds
ds_read_b64_tr_b16 a[110:111], v117 offset:14336
v_mfma_f32_16x16x32_bf16 v[36:39], a[64:67], v[132:135], 0
ds_read_b64_tr_b16 a[112:113], v117 offset:16384
v_permlane32_swap_b32 v24, v28
v_mfma_f32_16x16x32_bf16 v[36:39], a[68:71], v[148:151], v[36:39]
PAD_14:
s_cbranch_execz PAD_18
ds_read_b64_tr_b16 a[114:115], v117 offset:18432
v_add_f32 v24, v24, v28
v_mfma_f32_16x16x32_bf16 v[36:39], a[72:75], v[164:167], v[36:39]
buffer_load_dwordx4 v115, s[36:39], s81 offen offset:3072 lds
ds_read_b64_tr_b16 a[116:117], v117 offset:20480
v_mfma_f32_16x16x32_bf16 v[36:39], a[76:79], v[180:183], v[36:39]
ds_read_b64_tr_b16 a[118:119], v117 offset:22528
v_mov_b32 v29, v25
v_mfma_f32_16x16x32_bf16 v[36:39], a[80:83], v[196:199], v[36:39]
s_add_u32 s81, s81, 28672
s_add_u32 m0, s18, 69632
ds_read_b64_tr_b16 a[120:121], v117 offset:24576
v_mfma_f32_16x16x32_bf16 v[36:39], a[84:87], v[212:215], v[36:39]
buffer_load_dwordx4 v112, s[36:39], s81 offen offset:0 lds
ds_read_b64_tr_b16 a[122:123], v117 offset:26624
v_mfma_f32_16x16x32_bf16 v[36:39], a[88:91], v[228:231], v[36:39]
ds_read_b64_tr_b16 a[124:125], v117 offset:28672
v_permlane16_swap_b32 v25, v29
v_mfma_f32_16x16x32_bf16 v[36:39], a[92:95], v[244:247], v[36:39]
s_waitcnt lgkmcnt(8)
ds_read_b64_tr_b16 a[126:127], v117 offset:30720
v_add_u32 v117, 65536, v117
v_mfma_f32_16x16x32_bf16 v[40:43], a[96:99], v[128:131], 0
buffer_load_dwordx4 v113, s[36:39], s81 offen offset:1024 lds
ds_read_b64_tr_b16 a[64:65], v118 offset:0
v_mfma_f32_16x16x32_bf16 v[40:43], a[100:103], v[144:147], v[40:43]
ds_read_b64_tr_b16 a[66:67], v118 offset:2048
v_add_f32 v25, v25, v29
v_mfma_f32_16x16x32_bf16 v[40:43], a[104:107], v[160:163], v[40:43]
s_waitcnt lgkmcnt(8)
ds_read_b64_tr_b16 a[68:69], v118 offset:4096
v_mov_b32 v29, v25
v_mfma_f32_16x16x32_bf16 v[40:43], a[108:111], v[176:179], v[40:43]
buffer_load_dwordx4 v114, s[36:39], s81 offen offset:2048 lds
ds_read_b64_tr_b16 a[70:71], v118 offset:6144
v_mfma_f32_16x16x32_bf16 v[40:43], a[112:115], v[192:195], v[40:43]
s_waitcnt lgkmcnt(8)
ds_read_b64_tr_b16 a[72:73], v118 offset:8192
v_permlane32_swap_b32 v25, v29
v_mfma_f32_16x16x32_bf16 v[40:43], a[116:119], v[208:211], v[40:43]
s_waitcnt lgkmcnt(7)
ds_read_b64_tr_b16 a[74:75], v118 offset:10240
v_add_f32 v25, v25, v29
v_mfma_f32_16x16x32_bf16 v[40:43], a[120:123], v[224:227], v[40:43]
s_waitcnt lgkmcnt(6)
buffer_load_dwordx4 v115, s[36:39], s81 offen offset:3072 lds
ds_read_b64_tr_b16 a[76:77], v118 offset:12288
v_mfma_f32_16x16x32_bf16 v[40:43], a[124:127], v[240:243], v[40:43]
ds_read_b64_tr_b16 a[78:79], v118 offset:14336
v_rcp_f32 v24, v24
v_mfma_f32_16x16x32_bf16 v[44:47], a[96:99], v[132:135], 0
s_sub_u32 s81, s81, 28544
s_add_u32 m0, s18, 0
ds_read_b64_tr_b16 a[80:81], v118 offset:16384
v_mfma_f32_16x16x32_bf16 v[44:47], a[100:103], v[148:151], v[44:47]
buffer_load_dwordx4 v112, s[36:39], s81 offen offset:0 lds
ds_read_b64_tr_b16 a[82:83], v118 offset:18432
v_mfma_f32_16x16x32_bf16 v[44:47], a[104:107], v[164:167], v[44:47]
ds_read_b64_tr_b16 a[84:85], v118 offset:20480
v_rcp_f32 v25, v25
v_mfma_f32_16x16x32_bf16 v[44:47], a[108:111], v[180:183], v[44:47]
ds_read_b64_tr_b16 a[86:87], v118 offset:22528
v_and_b32 v19, 15, v20
v_mfma_f32_16x16x32_bf16 v[44:47], a[112:115], v[196:199], v[44:47]
buffer_load_dwordx4 v113, s[36:39], s81 offen offset:1024 lds
ds_read_b64_tr_b16 a[88:89], v118 offset:24576
v_mfma_f32_16x16x32_bf16 v[44:47], a[116:119], v[212:215], v[44:47]
ds_read_b64_tr_b16 a[90:91], v118 offset:26624
v_mul_f32 v32, v32, v24
v_mfma_f32_16x16x32_bf16 v[44:47], a[120:123], v[228:231], v[44:47]
ds_read_b64_tr_b16 a[92:93], v118 offset:28672
v_mul_f32 v33, v33, v24
v_mfma_f32_16x16x32_bf16 v[44:47], a[124:127], v[244:247], v[44:47]
s_waitcnt lgkmcnt(8)
ds_read_b64_tr_b16 a[94:95], v118 offset:30720
v_add_u32 v118, 65536, v118
v_mfma_f32_16x16x32_bf16 v[48:51], a[64:67], v[128:131], 0
buffer_load_dwordx4 v114, s[36:39], s81 offen offset:2048 lds
ds_read_b64_tr_b16 a[96:97], v119 offset:0
v_mfma_f32_16x16x32_bf16 v[48:51], a[68:71], v[144:147], v[48:51]
ds_read_b64_tr_b16 a[98:99], v119 offset:2048
v_mul_f32 v34, v34, v24
v_mfma_f32_16x16x32_bf16 v[48:51], a[72:75], v[160:163], v[48:51]
s_waitcnt lgkmcnt(8)
ds_read_b64_tr_b16 a[100:101], v119 offset:4096
v_mul_f32 v35, v35, v24
v_mfma_f32_16x16x32_bf16 v[48:51], a[76:79], v[176:179], v[48:51]
buffer_load_dwordx4 v115, s[36:39], s81 offen offset:3072 lds
ds_read_b64_tr_b16 a[102:103], v119 offset:6144
v_mfma_f32_16x16x32_bf16 v[48:51], a[80:83], v[192:195], v[48:51]
s_waitcnt lgkmcnt(6)
ds_read_b64_tr_b16 a[104:105], v119 offset:8192
v_mul_f32 v40, v40, v24
v_mfma_f32_16x16x32_bf16 v[48:51], a[84:87], v[208:211], v[48:51]
s_add_u32 s81, s81, 28672
s_add_u32 m0, s18, 4096
ds_read_b64_tr_b16 a[106:107], v119 offset:10240
v_mfma_f32_16x16x32_bf16 v[48:51], a[88:91], v[224:227], v[48:51]
s_waitcnt lgkmcnt(6)
buffer_load_dwordx4 v112, s[36:39], s81 offen offset:0 lds
ds_read_b64_tr_b16 a[108:109], v119 offset:12288
v_mfma_f32_16x16x32_bf16 v[48:51], a[92:95], v[240:243], v[48:51]
ds_read_b64_tr_b16 a[110:111], v119 offset:14336
v_mul_f32 v41, v41, v24
v_mfma_f32_16x16x32_bf16 v[52:55], a[64:67], v[132:135], 0
ds_read_b64_tr_b16 a[112:113], v119 offset:16384
v_mul_f32 v42, v42, v24
v_mfma_f32_16x16x32_bf16 v[52:55], a[68:71], v[148:151], v[52:55]
buffer_load_dwordx4 v113, s[36:39], s81 offen offset:1024 lds
ds_read_b64_tr_b16 a[114:115], v119 offset:18432
v_mfma_f32_16x16x32_bf16 v[52:55], a[72:75], v[164:167], v[52:55]
ds_read_b64_tr_b16 a[116:117], v119 offset:20480
v_mul_f32 v43, v43, v24
v_mfma_f32_16x16x32_bf16 v[52:55], a[76:79], v[180:183], v[52:55]
ds_read_b64_tr_b16 a[118:119], v119 offset:22528
v_cvt_pk_bf16_f32 v32, v32, v33
v_mfma_f32_16x16x32_bf16 v[52:55], a[80:83], v[196:199], v[52:55]
buffer_load_dwordx4 v114, s[36:39], s81 offen offset:2048 lds
ds_read_b64_tr_b16 a[120:121], v119 offset:24576
v_mfma_f32_16x16x32_bf16 v[52:55], a[84:87], v[212:215], v[52:55]
ds_read_b64_tr_b16 a[122:123], v119 offset:26624
v_cvt_pk_bf16_f32 v33, v34, v35
v_mfma_f32_16x16x32_bf16 v[52:55], a[88:91], v[228:231], v[52:55]
ds_read_b64_tr_b16 a[124:125], v119 offset:28672
ds_read_b64_tr_b16 a[126:127], v119 offset:30720
v_mfma_f32_16x16x32_bf16 v[52:55], a[92:95], v[244:247], v[52:55]
s_waitcnt vmcnt(23) lgkmcnt(9)
s_barrier
v_add_u32 v119, 65536, v119
v_mfma_f32_16x16x32_bf16 v[56:59], a[96:99], v[128:131], 0
buffer_load_dwordx4 v115, s[36:39], s81 offen offset:3072 lds
ds_read_b64_tr_b16 a[64:65], v116 offset:0
v_mfma_f32_16x16x32_bf16 v[56:59], a[100:103], v[144:147], v[56:59]
s_waitcnt lgkmcnt(8)
ds_read_b64_tr_b16 a[66:67], v116 offset:2048
v_cvt_pk_bf16_f32 v34, v40, v41
v_mfma_f32_16x16x32_bf16 v[56:59], a[104:107], v[160:163], v[56:59]
s_sub_u32 s81, s81, 28544
ds_read_b64_tr_b16 a[68:69], v116 offset:4096
v_cvt_pk_bf16_f32 v35, v42, v43
v_mfma_f32_16x16x32_bf16 v[56:59], a[108:111], v[176:179], v[56:59]
s_waitcnt lgkmcnt(8)
buffer_store_dwordx4 v[32:35], v1, s[4:7], s8 offen offset:0 sc1
ds_read_b64_tr_b16 a[70:71], v116 offset:6144
v_mfma_f32_16x16x32_bf16 v[56:59], a[112:115], v[192:195], v[56:59]
s_waitcnt lgkmcnt(8)
ds_read_b64_tr_b16 a[72:73], v116 offset:8192
v_mul_f32 v36, v36, v25
v_mfma_f32_16x16x32_bf16 v[56:59], a[116:119], v[208:211], v[56:59]
s_waitcnt lgkmcnt(7)
ds_read_b64_tr_b16 a[74:75], v116 offset:10240
v_mul_f32 v37, v37, v25
v_mfma_f32_16x16x32_bf16 v[56:59], a[120:123], v[224:227], v[56:59]
s_waitcnt lgkmcnt(6)
ds_read_b64_tr_b16 a[76:77], v116 offset:12288
v_mul_f32 v38, v38, v25
v_mfma_f32_16x16x32_bf16 v[56:59], a[124:127], v[240:243], v[56:59]
ds_read_b64_tr_b16 a[78:79], v116 offset:14336
v_mul_f32 v39, v39, v25
v_mfma_f32_16x16x32_bf16 v[60:63], a[96:99], v[132:135], 0
ds_read_b64_tr_b16 a[80:81], v116 offset:16384
v_mul_f32 v44, v44, v25
v_mfma_f32_16x16x32_bf16 v[60:63], a[100:103], v[148:151], v[60:63]
ds_read_b64_tr_b16 a[82:83], v116 offset:18432
v_mul_f32 v45, v45, v25
v_mfma_f32_16x16x32_bf16 v[60:63], a[104:107], v[164:167], v[60:63]
ds_read_b64_tr_b16 a[84:85], v116 offset:20480
v_mul_f32 v46, v46, v25
v_mfma_f32_16x16x32_bf16 v[60:63], a[108:111], v[180:183], v[60:63]
ds_read_b64_tr_b16 a[86:87], v116 offset:22528
v_mul_f32 v47, v47, v25
v_mfma_f32_16x16x32_bf16 v[60:63], a[112:115], v[196:199], v[60:63]
ds_read_b64_tr_b16 a[88:89], v116 offset:24576
v_cvt_pk_bf16_f32 v36, v36, v37
v_mfma_f32_16x16x32_bf16 v[60:63], a[116:119], v[212:215], v[60:63]
ds_read_b64_tr_b16 a[90:91], v116 offset:26624
v_cvt_pk_bf16_f32 v37, v38, v39
v_mfma_f32_16x16x32_bf16 v[60:63], a[120:123], v[228:231], v[60:63]
ds_read_b64_tr_b16 a[92:93], v116 offset:28672
v_cvt_pk_bf16_f32 v38, v44, v45
v_mfma_f32_16x16x32_bf16 v[60:63], a[124:127], v[244:247], v[60:63]
s_waitcnt lgkmcnt(3)
ds_read_b64_tr_b16 a[94:95], v116 offset:30720
v_add_u32 v116, 32768, v116
v_mfma_f32_16x16x32_bf16 v[64:67], a[64:67], v[128:131], 0
s_lshl_b32 s34, s29, 5
ds_read_b64_tr_b16 a[96:97], v117 offset:0
v_cvt_pk_bf16_f32 v39, v46, v47
v_mfma_f32_16x16x32_bf16 v[64:67], a[68:71], v[144:147], v[64:67]
s_add_u32 s34, s34, s20
buffer_store_dwordx4 v[36:39], v1, s[4:7], s12 offen offset:0 sc1
ds_read_b64_tr_b16 a[98:99], v117 offset:2048
v_mfma_f32_16x16x32_bf16 v[64:67], a[72:75], v[160:163], v[64:67]
s_lshl_b32 s34, s34, 2
ds_read_b64_tr_b16 a[100:101], v117 offset:4096
v_mul_f32 v48, v48, v24
v_mfma_f32_16x16x32_bf16 v[64:67], a[76:79], v[176:179], v[64:67]
s_add_u32 s34, s34, 94380032
ds_read_b64_tr_b16 a[102:103], v117 offset:6144
v_mul_f32 v49, v49, v24
v_mfma_f32_16x16x32_bf16 v[64:67], a[80:83], v[192:195], v[64:67]
s_add_u32 s35, s34, 2048
ds_read_b64_tr_b16 a[104:105], v117 offset:8192
v_mul_f32 v50, v50, v24
v_mfma_f32_16x16x32_bf16 v[64:67], a[84:87], v[208:211], v[64:67]
s_waitcnt lgkmcnt(5)
s_mov_b32 s80, s21
ds_read_b64_tr_b16 a[106:107], v117 offset:10240
v_mul_f32 v51, v51, v24
v_mfma_f32_16x16x32_bf16 v[64:67], a[88:91], v[224:227], v[64:67]
s_and_b32 s79, s2, 16
ds_read_b64_tr_b16 a[108:109], v117 offset:12288
v_mul_f32 v56, v56, v24
v_mfma_f32_16x16x32_bf16 v[64:67], a[92:95], v[240:243], v[64:67]
s_xor_b32 s79, s79, 16
ds_read_b64_tr_b16 a[110:111], v117 offset:14336
v_mul_f32 v57, v57, v24
v_mfma_f32_16x16x32_bf16 v[68:71], a[64:67], v[132:135], 0
s_add_u32 s79, s79, s20
ds_read_b64_tr_b16 a[112:113], v117 offset:16384
v_mul_f32 v58, v58, v24
v_mfma_f32_16x16x32_bf16 v[68:71], a[68:71], v[148:151], v[68:71]
s_lshl_b32 s22, s79, 2
ds_read_b64_tr_b16 a[114:115], v117 offset:18432
v_mul_f32 v59, v59, v24
v_mfma_f32_16x16x32_bf16 v[68:71], a[72:75], v[164:167], v[68:71]
s_add_u32 s22, s22, s3
ds_read_b64_tr_b16 a[116:117], v117 offset:20480
v_cvt_pk_bf16_f32 v48, v48, v49
v_mfma_f32_16x16x32_bf16 v[68:71], a[76:79], v[180:183], v[68:71]
s_mul_i32 s25, s22, 28672
ds_read_b64_tr_b16 a[118:119], v117 offset:22528
v_cvt_pk_bf16_f32 v49, v50, v51
v_mfma_f32_16x16x32_bf16 v[68:71], a[80:83], v[196:199], v[68:71]
s_lshl_b32 s23, s80, 6
ds_read_b64_tr_b16 a[120:121], v117 offset:24576
v_cvt_pk_bf16_f32 v50, v56, v57
v_mfma_f32_16x16x32_bf16 v[68:71], a[84:87], v[212:215], v[68:71]
s_add_u32 s25, s25, s23
ds_read_b64_tr_b16 a[122:123], v117 offset:26624
v_cvt_pk_bf16_f32 v51, v58, v59
v_mfma_f32_16x16x32_bf16 v[68:71], a[88:91], v[228:231], v[68:71]
s_mul_i32 s26, s22, 229376
buffer_store_dwordx4 v[48:51], v1, s[4:7], s8 offen offset:1024 sc1
ds_read_b64_tr_b16 a[124:125], v117 offset:28672
v_mfma_f32_16x16x32_bf16 v[68:71], a[92:95], v[244:247], v[68:71]
s_waitcnt lgkmcnt(3)
s_lshl_b32 s23, s80, 10
ds_read_b64_tr_b16 a[126:127], v117 offset:30720
v_add_u32 v117, 32768, v117
v_mfma_f32_16x16x32_bf16 v[72:75], a[96:99], v[128:131], 0
s_add_u32 s26, s26, s23
ds_read_b64_tr_b16 a[64:65], v118 offset:0
v_mul_f32 v52, v52, v25
v_mfma_f32_16x16x32_bf16 v[72:75], a[100:103], v[144:147], v[72:75]
s_add_u32 s26, s26, 104857600
ds_read_b64_tr_b16 a[66:67], v118 offset:2048
v_mul_f32 v53, v53, v25
v_mfma_f32_16x16x32_bf16 v[72:75], a[104:107], v[160:163], v[72:75]
s_lshr_b32 s22, s79, 1
ds_read_b64_tr_b16 a[68:69], v118 offset:4096
v_mul_f32 v54, v54, v25
v_mfma_f32_16x16x32_bf16 v[72:75], a[108:111], v[176:179], v[72:75]
s_lshl_b32 s22, s22, 7
ds_read_b64_tr_b16 a[70:71], v118 offset:6144
v_mul_f32 v55, v55, v25
v_mfma_f32_16x16x32_bf16 v[72:75], a[112:115], v[192:195], v[72:75]
s_add_u32 s33, s22, 94380032
ds_read_b64_tr_b16 a[72:73], v118 offset:8192
v_mul_f32 v60, v60, v25
v_mfma_f32_16x16x32_bf16 v[72:75], a[116:119], v[208:211], v[72:75]
s_waitcnt lgkmcnt(5)
s_mov_b64 s[40:41], s[88:89]
ds_read_b64_tr_b16 a[74:75], v118 offset:10240
v_mul_f32 v61, v61, v25
v_mfma_f32_16x16x32_bf16 v[72:75], a[120:123], v[224:227], v[72:75]
s_mov_b32 s42, 3670016
ds_read_b64_tr_b16 a[76:77], v118 offset:12288
v_mul_f32 v62, v62, v25
v_mfma_f32_16x16x32_bf16 v[72:75], a[124:127], v[240:243], v[72:75]
s_mov_b32 s43, 0x20000
ds_read_b64_tr_b16 a[78:79], v118 offset:14336
v_mul_f32 v63, v63, v25
v_mfma_f32_16x16x32_bf16 v[76:79], a[96:99], v[132:135], 0
ds_read_b64_tr_b16 a[80:81], v118 offset:16384
v_cvt_pk_bf16_f32 v52, v52, v53
v_mfma_f32_16x16x32_bf16 v[76:79], a[100:103], v[148:151], v[76:79]
ds_read_b64_tr_b16 a[82:83], v118 offset:18432
v_cvt_pk_bf16_f32 v53, v54, v55
v_mfma_f32_16x16x32_bf16 v[76:79], a[104:107], v[164:167], v[76:79]
ds_read_b64_tr_b16 a[84:85], v118 offset:20480
v_cvt_pk_bf16_f32 v54, v60, v61
v_mfma_f32_16x16x32_bf16 v[76:79], a[108:111], v[180:183], v[76:79]
ds_read_b64_tr_b16 a[86:87], v118 offset:22528
v_cvt_pk_bf16_f32 v55, v62, v63
v_mfma_f32_16x16x32_bf16 v[76:79], a[112:115], v[196:199], v[76:79]
buffer_store_dwordx4 v[52:55], v1, s[4:7], s12 offen offset:1024 sc1
ds_read_b64_tr_b16 a[88:89], v118 offset:24576
v_mfma_f32_16x16x32_bf16 v[76:79], a[116:119], v[212:215], v[76:79]
ds_read_b64_tr_b16 a[90:91], v118 offset:26624
v_mfma_f32_16x16x32_bf16 v[76:79], a[120:123], v[228:231], v[76:79]
ds_read_b64_tr_b16 a[92:93], v118 offset:28672
v_mul_f32 v64, v64, v24
v_mfma_f32_16x16x32_bf16 v[76:79], a[124:127], v[244:247], v[76:79]
s_waitcnt lgkmcnt(8)
ds_read_b64_tr_b16 a[94:95], v118 offset:30720
v_add_u32 v118, 32768, v118
v_mfma_f32_16x16x32_bf16 v[80:83], a[64:67], v[128:131], 0
ds_read_b64_tr_b16 a[96:97], v119 offset:0
v_mul_f32 v65, v65, v24
v_mfma_f32_16x16x32_bf16 v[80:83], a[68:71], v[144:147], v[80:83]
ds_read_b64_tr_b16 a[98:99], v119 offset:2048
v_mul_f32 v66, v66, v24
v_mfma_f32_16x16x32_bf16 v[80:83], a[72:75], v[160:163], v[80:83]
s_waitcnt lgkmcnt(8)
ds_read_b64_tr_b16 a[100:101], v119 offset:4096
v_mul_f32 v67, v67, v24
v_mfma_f32_16x16x32_bf16 v[80:83], a[76:79], v[176:179], v[80:83]
ds_read_b64_tr_b16 a[102:103], v119 offset:6144
v_mul_f32 v72, v72, v24
v_mfma_f32_16x16x32_bf16 v[80:83], a[80:83], v[192:195], v[80:83]
s_waitcnt lgkmcnt(8)
ds_read_b64_tr_b16 a[104:105], v119 offset:8192
v_mul_f32 v73, v73, v24
v_mfma_f32_16x16x32_bf16 v[80:83], a[84:87], v[208:211], v[80:83]
s_waitcnt lgkmcnt(7)
ds_read_b64_tr_b16 a[106:107], v119 offset:10240
v_mul_f32 v74, v74, v24
v_mfma_f32_16x16x32_bf16 v[80:83], a[88:91], v[224:227], v[80:83]
s_waitcnt lgkmcnt(6)
ds_read_b64_tr_b16 a[108:109], v119 offset:12288
v_mul_f32 v75, v75, v24
v_mfma_f32_16x16x32_bf16 v[80:83], a[92:95], v[240:243], v[80:83]
ds_read_b64_tr_b16 a[110:111], v119 offset:14336
v_cvt_pk_bf16_f32 v64, v64, v65
v_mfma_f32_16x16x32_bf16 v[84:87], a[64:67], v[132:135], 0
ds_read_b64_tr_b16 a[112:113], v119 offset:16384
v_cvt_pk_bf16_f32 v65, v66, v67
v_mfma_f32_16x16x32_bf16 v[84:87], a[68:71], v[148:151], v[84:87]
ds_read_b64_tr_b16 a[114:115], v119 offset:18432
v_cvt_pk_bf16_f32 v66, v72, v73
v_mfma_f32_16x16x32_bf16 v[84:87], a[72:75], v[164:167], v[84:87]
ds_read_b64_tr_b16 a[116:117], v119 offset:20480
v_cvt_pk_bf16_f32 v67, v74, v75
v_mfma_f32_16x16x32_bf16 v[84:87], a[76:79], v[180:183], v[84:87]
buffer_store_dwordx4 v[64:67], v1, s[4:7], s8 offen offset:2048 sc1
ds_read_b64_tr_b16 a[118:119], v119 offset:22528
v_mfma_f32_16x16x32_bf16 v[84:87], a[80:83], v[196:199], v[84:87]
ds_read_b64_tr_b16 a[120:121], v119 offset:24576
v_mul_f32 v68, v68, v25
v_mfma_f32_16x16x32_bf16 v[84:87], a[84:87], v[212:215], v[84:87]
ds_read_b64_tr_b16 a[122:123], v119 offset:26624
v_mul_f32 v69, v69, v25
v_mfma_f32_16x16x32_bf16 v[84:87], a[88:91], v[228:231], v[84:87]
ds_read_b64_tr_b16 a[124:125], v119 offset:28672
ds_read_b64_tr_b16 a[126:127], v119 offset:30720
v_mfma_f32_16x16x32_bf16 v[84:87], a[92:95], v[244:247], v[84:87]
s_waitcnt vmcnt(21) lgkmcnt(9)
s_barrier
v_add_u32 v119, 32768, v119
v_mfma_f32_16x16x32_bf16 v[88:91], a[96:99], v[128:131], 0
ds_read_b64_tr_b16 a[64:65], v116 offset:0
v_mul_f32 v70, v70, v25
v_mfma_f32_16x16x32_bf16 v[88:91], a[100:103], v[144:147], v[88:91]
ds_read_b64_tr_b16 a[66:67], v116 offset:2048
v_mul_f32 v71, v71, v25
v_mfma_f32_16x16x32_bf16 v[88:91], a[104:107], v[160:163], v[88:91]
s_waitcnt lgkmcnt(8)
ds_read_b64_tr_b16 a[68:69], v116 offset:4096
v_mul_f32 v76, v76, v25
v_mfma_f32_16x16x32_bf16 v[88:91], a[108:111], v[176:179], v[88:91]
ds_read_b64_tr_b16 a[70:71], v116 offset:6144
v_mul_f32 v77, v77, v25
v_mfma_f32_16x16x32_bf16 v[88:91], a[112:115], v[192:195], v[88:91]
s_waitcnt lgkmcnt(8)
ds_read_b64_tr_b16 a[72:73], v116 offset:8192
v_mul_f32 v78, v78, v25
v_mfma_f32_16x16x32_bf16 v[88:91], a[116:119], v[208:211], v[88:91]
s_waitcnt lgkmcnt(7)
ds_read_b64_tr_b16 a[74:75], v116 offset:10240
v_mul_f32 v79, v79, v25
v_mfma_f32_16x16x32_bf16 v[88:91], a[120:123], v[224:227], v[88:91]
s_waitcnt lgkmcnt(6)
ds_read_b64_tr_b16 a[76:77], v116 offset:12288
v_cvt_pk_bf16_f32 v68, v68, v69
v_mfma_f32_16x16x32_bf16 v[88:91], a[124:127], v[240:243], v[88:91]
ds_read_b64_tr_b16 a[78:79], v116 offset:14336
v_cvt_pk_bf16_f32 v69, v70, v71
v_mfma_f32_16x16x32_bf16 v[92:95], a[96:99], v[132:135], 0
ds_read_b64_tr_b16 a[80:81], v116 offset:16384
v_cvt_pk_bf16_f32 v70, v76, v77
v_mfma_f32_16x16x32_bf16 v[92:95], a[100:103], v[148:151], v[92:95]
ds_read_b64_tr_b16 a[82:83], v116 offset:18432
v_cvt_pk_bf16_f32 v71, v78, v79
v_mfma_f32_16x16x32_bf16 v[92:95], a[104:107], v[164:167], v[92:95]
buffer_store_dwordx4 v[68:71], v1, s[4:7], s12 offen offset:2048 sc1
ds_read_b64_tr_b16 a[84:85], v116 offset:20480
v_mfma_f32_16x16x32_bf16 v[92:95], a[108:111], v[180:183], v[92:95]
ds_read_b64_tr_b16 a[86:87], v116 offset:22528
v_mfma_f32_16x16x32_bf16 v[92:95], a[112:115], v[196:199], v[92:95]
ds_read_b64_tr_b16 a[88:89], v116 offset:24576
v_mfma_f32_16x16x32_bf16 v[92:95], a[116:119], v[212:215], v[92:95]
ds_read_b64_tr_b16 a[90:91], v116 offset:26624
v_mfma_f32_16x16x32_bf16 v[92:95], a[120:123], v[228:231], v[92:95]
ds_read_b64_tr_b16 a[92:93], v116 offset:28672
v_mfma_f32_16x16x32_bf16 v[92:95], a[124:127], v[244:247], v[92:95]
s_waitcnt lgkmcnt(8)
ds_read_b64_tr_b16 a[94:95], v116 offset:30720
v_add_u32 v116, 4294901760, v116
v_mfma_f32_16x16x32_bf16 v[32:35], a[64:67], v[128:131], 0
s_add_u32 m0, s18, 32768
ds_read_b64_tr_b16 a[96:97], v117 offset:0
v_mul_f32 v80, v80, v24
v_mfma_f32_16x16x32_bf16 v[32:35], a[68:71], v[144:147], v[32:35]
buffer_load_dwordx4 v112, s[36:39], s81 offen offset:0 lds
ds_read_b64_tr_b16 a[98:99], v117 offset:2048
v_mfma_f32_16x16x32_bf16 v[32:35], a[72:75], v[160:163], v[32:35]
s_waitcnt lgkmcnt(8)
ds_read_b64_tr_b16 a[100:101], v117 offset:4096
v_mul_f32 v81, v81, v24
v_mfma_f32_16x16x32_bf16 v[32:35], a[76:79], v[176:179], v[32:35]
ds_read_b64_tr_b16 a[102:103], v117 offset:6144
v_mul_f32 v82, v82, v24
v_mfma_f32_16x16x32_bf16 v[32:35], a[80:83], v[192:195], v[32:35]
s_waitcnt lgkmcnt(8)
ds_read_b64_tr_b16 a[104:105], v117 offset:8192
v_mul_f32 v83, v83, v24
v_mfma_f32_16x16x32_bf16 v[32:35], a[84:87], v[208:211], v[32:35]
s_waitcnt lgkmcnt(7)
ds_read_b64_tr_b16 a[106:107], v117 offset:10240
v_mul_f32 v88, v88, v24
v_mfma_f32_16x16x32_bf16 v[32:35], a[88:91], v[224:227], v[32:35]
s_waitcnt lgkmcnt(6)
ds_read_b64_tr_b16 a[108:109], v117 offset:12288
v_mul_f32 v89, v89, v24
v_mfma_f32_16x16x32_bf16 v[32:35], a[92:95], v[240:243], v[32:35]
ds_read_b64_tr_b16 a[110:111], v117 offset:14336
v_mul_f32 v90, v90, v24
v_mfma_f32_16x16x32_bf16 v[36:39], a[64:67], v[132:135], 0
buffer_load_dwordx4 v113, s[36:39], s81 offen offset:1024 lds
ds_read_b64_tr_b16 a[112:113], v117 offset:16384
v_mfma_f32_16x16x32_bf16 v[36:39], a[68:71], v[148:151], v[36:39]
ds_read_b64_tr_b16 a[114:115], v117 offset:18432
v_mul_f32 v91, v91, v24
v_mfma_f32_16x16x32_bf16 v[36:39], a[72:75], v[164:167], v[36:39]
ds_read_b64_tr_b16 a[116:117], v117 offset:20480
v_cvt_pk_bf16_f32 v80, v80, v81
v_mfma_f32_16x16x32_bf16 v[36:39], a[76:79], v[180:183], v[36:39]
ds_read_b64_tr_b16 a[118:119], v117 offset:22528
v_cvt_pk_bf16_f32 v81, v82, v83
v_mfma_f32_16x16x32_bf16 v[36:39], a[80:83], v[196:199], v[36:39]
ds_read_b64_tr_b16 a[120:121], v117 offset:24576
v_cvt_pk_bf16_f32 v82, v88, v89
v_mfma_f32_16x16x32_bf16 v[36:39], a[84:87], v[212:215], v[36:39]
ds_read_b64_tr_b16 a[122:123], v117 offset:26624
v_cvt_pk_bf16_f32 v83, v90, v91
v_mfma_f32_16x16x32_bf16 v[36:39], a[88:91], v[228:231], v[36:39]
buffer_store_dwordx4 v[80:83], v1, s[4:7], s8 offen offset:3072 sc1
ds_read_b64_tr_b16 a[124:125], v117 offset:28672
v_mfma_f32_16x16x32_bf16 v[36:39], a[92:95], v[244:247], v[36:39]
s_waitcnt lgkmcnt(8)
ds_read_b64_tr_b16 a[126:127], v117 offset:30720
v_add_u32 v117, 4294901760, v117
v_mfma_f32_16x16x32_bf16 v[40:43], a[96:99], v[128:131], 0
buffer_load_dwordx4 v114, s[36:39], s81 offen offset:2048 lds
ds_read_b64_tr_b16 a[64:65], v118 offset:0
v_mfma_f32_16x16x32_bf16 v[40:43], a[100:103], v[144:147], v[40:43]
ds_read_b64_tr_b16 a[66:67], v118 offset:2048
v_mul_f32 v84, v84, v25
v_mfma_f32_16x16x32_bf16 v[40:43], a[104:107], v[160:163], v[40:43]
s_waitcnt lgkmcnt(8)
ds_read_b64_tr_b16 a[68:69], v118 offset:4096
v_mul_f32 v85, v85, v25
v_mfma_f32_16x16x32_bf16 v[40:43], a[108:111], v[176:179], v[40:43]
ds_read_b64_tr_b16 a[70:71], v118 offset:6144
v_mul_f32 v86, v86, v25
v_mfma_f32_16x16x32_bf16 v[40:43], a[112:115], v[192:195], v[40:43]
s_waitcnt lgkmcnt(8)
ds_read_b64_tr_b16 a[72:73], v118 offset:8192
v_mul_f32 v87, v87, v25
v_mfma_f32_16x16x32_bf16 v[40:43], a[116:119], v[208:211], v[40:43]
s_waitcnt lgkmcnt(7)
ds_read_b64_tr_b16 a[74:75], v118 offset:10240
v_mul_f32 v92, v92, v25
v_mfma_f32_16x16x32_bf16 v[40:43], a[120:123], v[224:227], v[40:43]
s_waitcnt lgkmcnt(6)
ds_read_b64_tr_b16 a[76:77], v118 offset:12288
v_mul_f32 v93, v93, v25
v_mfma_f32_16x16x32_bf16 v[40:43], a[124:127], v[240:243], v[40:43]
buffer_load_dwordx4 v115, s[36:39], s81 offen offset:3072 lds
ds_read_b64_tr_b16 a[78:79], v118 offset:14336
v_mfma_f32_16x16x32_bf16 v[44:47], a[96:99], v[132:135], 0
ds_read_b64_tr_b16 a[80:81], v118 offset:16384
v_mul_f32 v94, v94, v25
v_mfma_f32_16x16x32_bf16 v[44:47], a[100:103], v[148:151], v[44:47]
ds_read_b64_tr_b16 a[82:83], v118 offset:18432
v_mul_f32 v95, v95, v25
v_mfma_f32_16x16x32_bf16 v[44:47], a[104:107], v[164:167], v[44:47]
ds_read_b64_tr_b16 a[84:85], v118 offset:20480
v_cvt_pk_bf16_f32 v84, v84, v85
v_mfma_f32_16x16x32_bf16 v[44:47], a[108:111], v[180:183], v[44:47]
ds_read_b64_tr_b16 a[86:87], v118 offset:22528
v_cvt_pk_bf16_f32 v85, v86, v87
v_mfma_f32_16x16x32_bf16 v[44:47], a[112:115], v[196:199], v[44:47]
ds_read_b64_tr_b16 a[88:89], v118 offset:24576
v_cvt_pk_bf16_f32 v86, v92, v93
v_mfma_f32_16x16x32_bf16 v[44:47], a[116:119], v[212:215], v[44:47]
s_add_u32 s81, s81, 28672
s_add_u32 m0, s18, 36864
ds_read_b64_tr_b16 a[90:91], v118 offset:26624
v_mfma_f32_16x16x32_bf16 v[44:47], a[120:123], v[228:231], v[44:47]
buffer_load_dwordx4 v112, s[36:39], s81 offen offset:0 lds
ds_read_b64_tr_b16 a[92:93], v118 offset:28672
v_mfma_f32_16x16x32_bf16 v[44:47], a[124:127], v[244:247], v[44:47]
s_waitcnt lgkmcnt(8)
ds_read_b64_tr_b16 a[94:95], v118 offset:30720
v_add_u32 v118, 4294901760, v118
v_mfma_f32_16x16x32_bf16 v[48:51], a[64:67], v[128:131], 0
ds_read_b64_tr_b16 a[96:97], v119 offset:0
v_cvt_pk_bf16_f32 v87, v94, v95
v_mfma_f32_16x16x32_bf16 v[48:51], a[68:71], v[144:147], v[48:51]
s_waitcnt lgkmcnt(8)
buffer_store_dwordx4 v[84:87], v1, s[4:7], s12 offen offset:3072 sc1
ds_read_b64_tr_b16 a[98:99], v119 offset:2048
v_mfma_f32_16x16x32_bf16 v[48:51], a[72:75], v[160:163], v[48:51]
s_add_u32 s8, s8, 4096
s_add_u32 s12, s12, 4096
ds_read_b64_tr_b16 a[100:101], v119 offset:4096
v_mfma_f32_16x16x32_bf16 v[48:51], a[76:79], v[176:179], v[48:51]
s_waitcnt lgkmcnt(8)
ds_read_b64_tr_b16 a[102:103], v119 offset:6144
v_mul_f32 v32, v32, v24
v_mfma_f32_16x16x32_bf16 v[48:51], a[80:83], v[192:195], v[48:51]
s_waitcnt lgkmcnt(8)
ds_read_b64_tr_b16 a[104:105], v119 offset:8192
v_mul_f32 v33, v33, v24
v_mfma_f32_16x16x32_bf16 v[48:51], a[84:87], v[208:211], v[48:51]
s_waitcnt lgkmcnt(7)
buffer_load_dwordx4 v113, s[36:39], s81 offen offset:1024 lds
ds_read_b64_tr_b16 a[106:107], v119 offset:10240
v_mfma_f32_16x16x32_bf16 v[48:51], a[88:91], v[224:227], v[48:51]
s_waitcnt lgkmcnt(6)
ds_read_b64_tr_b16 a[108:109], v119 offset:12288
v_mul_f32 v34, v34, v24
v_mfma_f32_16x16x32_bf16 v[48:51], a[92:95], v[240:243], v[48:51]
ds_read_b64_tr_b16 a[110:111], v119 offset:14336
v_mul_f32 v35, v35, v24
v_mfma_f32_16x16x32_bf16 v[52:55], a[64:67], v[132:135], 0
ds_read_b64_tr_b16 a[112:113], v119 offset:16384
v_mul_f32 v40, v40, v24
v_mfma_f32_16x16x32_bf16 v[52:55], a[68:71], v[148:151], v[52:55]
ds_read_b64_tr_b16 a[114:115], v119 offset:18432
v_mul_f32 v41, v41, v24
v_mfma_f32_16x16x32_bf16 v[52:55], a[72:75], v[164:167], v[52:55]
ds_read_b64_tr_b16 a[116:117], v119 offset:20480
v_mul_f32 v42, v42, v24
v_mfma_f32_16x16x32_bf16 v[52:55], a[76:79], v[180:183], v[52:55]
ds_read_b64_tr_b16 a[118:119], v119 offset:22528
v_mul_f32 v43, v43, v24
v_mfma_f32_16x16x32_bf16 v[52:55], a[80:83], v[196:199], v[52:55]
buffer_load_dwordx4 v114, s[36:39], s81 offen offset:2048 lds
ds_read_b64_tr_b16 a[120:121], v119 offset:24576
v_mfma_f32_16x16x32_bf16 v[52:55], a[84:87], v[212:215], v[52:55]
ds_read_b64_tr_b16 a[122:123], v119 offset:26624
v_cvt_pk_bf16_f32 v32, v32, v33
v_mfma_f32_16x16x32_bf16 v[52:55], a[88:91], v[228:231], v[52:55]
ds_read_b64_tr_b16 a[124:125], v119 offset:28672
ds_read_b64_tr_b16 a[126:127], v119 offset:30720
v_mfma_f32_16x16x32_bf16 v[52:55], a[92:95], v[244:247], v[52:55]
s_waitcnt vmcnt(23) lgkmcnt(9)
s_barrier
v_add_u32 v119, 4294901760, v119
v_mfma_f32_16x16x32_bf16 v[56:59], a[96:99], v[128:131], 0
ds_read_b64_tr_b16 a[64:65], v116 offset:0
v_cvt_pk_bf16_f32 v33, v34, v35
v_mfma_f32_16x16x32_bf16 v[56:59], a[100:103], v[144:147], v[56:59]
ds_read_b64_tr_b16 a[66:67], v116 offset:2048
v_cvt_pk_bf16_f32 v34, v40, v41
v_mfma_f32_16x16x32_bf16 v[56:59], a[104:107], v[160:163], v[56:59]
s_waitcnt lgkmcnt(8)
ds_read_b64_tr_b16 a[68:69], v116 offset:4096
v_cvt_pk_bf16_f32 v35, v42, v43
v_mfma_f32_16x16x32_bf16 v[56:59], a[108:111], v[176:179], v[56:59]
buffer_load_dwordx4 v115, s[36:39], s81 offen offset:3072 lds
ds_read_b64_tr_b16 a[70:71], v116 offset:6144
v_mfma_f32_16x16x32_bf16 v[56:59], a[112:115], v[192:195], v[56:59]
s_waitcnt lgkmcnt(8)
buffer_store_dwordx4 v[32:35], v1, s[4:7], s8 offen offset:0 sc1
ds_read_b64_tr_b16 a[72:73], v116 offset:8192
v_mfma_f32_16x16x32_bf16 v[56:59], a[116:119], v[208:211], v[56:59]
PAD_15:
s_cbranch_execz M_tret
s_waitcnt lgkmcnt(7)
ds_read_b64_tr_b16 a[74:75], v116 offset:10240
v_mul_f32 v36, v36, v25
v_mfma_f32_16x16x32_bf16 v[56:59], a[120:123], v[224:227], v[56:59]
s_waitcnt lgkmcnt(6)
ds_read_b64_tr_b16 a[76:77], v116 offset:12288
v_mul_f32 v37, v37, v25
v_mfma_f32_16x16x32_bf16 v[56:59], a[124:127], v[240:243], v[56:59]
ds_read_b64_tr_b16 a[78:79], v116 offset:14336
v_mul_f32 v38, v38, v25
v_mfma_f32_16x16x32_bf16 v[60:63], a[96:99], v[132:135], 0
ds_read_b64_tr_b16 a[80:81], v116 offset:16384
v_mul_f32 v39, v39, v25
v_mfma_f32_16x16x32_bf16 v[60:63], a[100:103], v[148:151], v[60:63]
s_sub_u32 s81, s81, 28544
ds_read_b64_tr_b16 a[82:83], v116 offset:18432
v_mul_f32 v44, v44, v25
v_mfma_f32_16x16x32_bf16 v[60:63], a[104:107], v[164:167], v[60:63]
ds_read_b64_tr_b16 a[84:85], v116 offset:20480
v_mul_f32 v45, v45, v25
v_mfma_f32_16x16x32_bf16 v[60:63], a[108:111], v[180:183], v[60:63]
ds_read_b64_tr_b16 a[86:87], v116 offset:22528
v_mul_f32 v46, v46, v25
v_mfma_f32_16x16x32_bf16 v[60:63], a[112:115], v[196:199], v[60:63]
ds_read_b64_tr_b16 a[88:89], v116 offset:24576
v_mul_f32 v47, v47, v25
v_mfma_f32_16x16x32_bf16 v[60:63], a[116:119], v[212:215], v[60:63]
ds_read_b64_tr_b16 a[90:91], v116 offset:26624
v_cvt_pk_bf16_f32 v36, v36, v37
v_mfma_f32_16x16x32_bf16 v[60:63], a[120:123], v[228:231], v[60:63]
ds_read_b64_tr_b16 a[92:93], v116 offset:28672
v_cvt_pk_bf16_f32 v37, v38, v39
v_mfma_f32_16x16x32_bf16 v[60:63], a[124:127], v[244:247], v[60:63]
s_waitcnt lgkmcnt(8)
ds_read_b64_tr_b16 a[94:95], v116 offset:30720
v_add_u32 v116, 4294901760, v116
v_mfma_f32_16x16x32_bf16 v[64:67], a[64:67], v[128:131], 0
s_add_u32 m0, s18, 98304
ds_read_b64_tr_b16 a[96:97], v117 offset:0
v_cvt_pk_bf16_f32 v38, v44, v45
v_mfma_f32_16x16x32_bf16 v[64:67], a[68:71], v[144:147], v[64:67]
buffer_load_dwordx4 v112, s[36:39], s81 offen offset:0 lds
ds_read_b64_tr_b16 a[98:99], v117 offset:2048
v_mfma_f32_16x16x32_bf16 v[64:67], a[72:75], v[160:163], v[64:67]
s_waitcnt lgkmcnt(8)
ds_read_b64_tr_b16 a[100:101], v117 offset:4096
v_cvt_pk_bf16_f32 v39, v46, v47
v_mfma_f32_16x16x32_bf16 v[64:67], a[76:79], v[176:179], v[64:67]
buffer_store_dwordx4 v[36:39], v1, s[4:7], s12 offen offset:0 sc1
ds_read_b64_tr_b16 a[102:103], v117 offset:6144
v_mfma_f32_16x16x32_bf16 v[64:67], a[80:83], v[192:195], v[64:67]
s_waitcnt lgkmcnt(8)
ds_read_b64_tr_b16 a[104:105], v117 offset:8192
v_mul_f32 v48, v48, v24
v_mfma_f32_16x16x32_bf16 v[64:67], a[84:87], v[208:211], v[64:67]
s_waitcnt lgkmcnt(7)
ds_read_b64_tr_b16 a[106:107], v117 offset:10240
v_mul_f32 v49, v49, v24
v_mfma_f32_16x16x32_bf16 v[64:67], a[88:91], v[224:227], v[64:67]
s_waitcnt lgkmcnt(6)
ds_read_b64_tr_b16 a[108:109], v117 offset:12288
v_mul_f32 v50, v50, v24
v_mfma_f32_16x16x32_bf16 v[64:67], a[92:95], v[240:243], v[64:67]
ds_read_b64_tr_b16 a[110:111], v117 offset:14336
v_mul_f32 v51, v51, v24
v_mfma_f32_16x16x32_bf16 v[68:71], a[64:67], v[132:135], 0
buffer_load_dwordx4 v113, s[36:39], s81 offen offset:1024 lds
ds_read_b64_tr_b16 a[112:113], v117 offset:16384
v_mfma_f32_16x16x32_bf16 v[68:71], a[68:71], v[148:151], v[68:71]
ds_read_b64_tr_b16 a[114:115], v117 offset:18432
v_mul_f32 v56, v56, v24
v_mfma_f32_16x16x32_bf16 v[68:71], a[72:75], v[164:167], v[68:71]
ds_read_b64_tr_b16 a[116:117], v117 offset:20480
v_mul_f32 v57, v57, v24
v_mfma_f32_16x16x32_bf16 v[68:71], a[76:79], v[180:183], v[68:71]
ds_read_b64_tr_b16 a[118:119], v117 offset:22528
v_mul_f32 v58, v58, v24
v_mfma_f32_16x16x32_bf16 v[68:71], a[80:83], v[196:199], v[68:71]
ds_read_b64_tr_b16 a[120:121], v117 offset:24576
v_mul_f32 v59, v59, v24
v_mfma_f32_16x16x32_bf16 v[68:71], a[84:87], v[212:215], v[68:71]
ds_read_b64_tr_b16 a[122:123], v117 offset:26624
v_cvt_pk_bf16_f32 v48, v48, v49
v_mfma_f32_16x16x32_bf16 v[68:71], a[88:91], v[228:231], v[68:71]
ds_read_b64_tr_b16 a[124:125], v117 offset:28672
v_cvt_pk_bf16_f32 v49, v50, v51
v_mfma_f32_16x16x32_bf16 v[68:71], a[92:95], v[244:247], v[68:71]
s_waitcnt lgkmcnt(8)
ds_read_b64_tr_b16 a[126:127], v117 offset:30720
v_add_u32 v117, 4294901760, v117
v_mfma_f32_16x16x32_bf16 v[72:75], a[96:99], v[128:131], 0
buffer_load_dwordx4 v114, s[36:39], s81 offen offset:2048 lds
ds_read_b64_tr_b16 a[64:65], v118 offset:0
v_mfma_f32_16x16x32_bf16 v[72:75], a[100:103], v[144:147], v[72:75]
ds_read_b64_tr_b16 a[66:67], v118 offset:2048
v_cvt_pk_bf16_f32 v50, v56, v57
v_mfma_f32_16x16x32_bf16 v[72:75], a[104:107], v[160:163], v[72:75]
s_waitcnt lgkmcnt(8)
ds_read_b64_tr_b16 a[68:69], v118 offset:4096
v_cvt_pk_bf16_f32 v51, v58, v59
v_mfma_f32_16x16x32_bf16 v[72:75], a[108:111], v[176:179], v[72:75]
buffer_store_dwordx4 v[48:51], v1, s[4:7], s8 offen offset:1024 sc1
ds_read_b64_tr_b16 a[70:71], v118 offset:6144
v_mfma_f32_16x16x32_bf16 v[72:75], a[112:115], v[192:195], v[72:75]
s_waitcnt lgkmcnt(8)
ds_read_b64_tr_b16 a[72:73], v118 offset:8192
v_mul_f32 v52, v52, v25
v_mfma_f32_16x16x32_bf16 v[72:75], a[116:119], v[208:211], v[72:75]
s_waitcnt lgkmcnt(7)
ds_read_b64_tr_b16 a[74:75], v118 offset:10240
v_mul_f32 v53, v53, v25
v_mfma_f32_16x16x32_bf16 v[72:75], a[120:123], v[224:227], v[72:75]
s_waitcnt lgkmcnt(6)
ds_read_b64_tr_b16 a[76:77], v118 offset:12288
v_mul_f32 v54, v54, v25
v_mfma_f32_16x16x32_bf16 v[72:75], a[124:127], v[240:243], v[72:75]
buffer_load_dwordx4 v115, s[36:39], s81 offen offset:3072 lds
ds_read_b64_tr_b16 a[78:79], v118 offset:14336
v_mfma_f32_16x16x32_bf16 v[76:79], a[96:99], v[132:135], 0
ds_read_b64_tr_b16 a[80:81], v118 offset:16384
v_mul_f32 v55, v55, v25
v_mfma_f32_16x16x32_bf16 v[76:79], a[100:103], v[148:151], v[76:79]
ds_read_b64_tr_b16 a[82:83], v118 offset:18432
v_mul_f32 v60, v60, v25
v_mfma_f32_16x16x32_bf16 v[76:79], a[104:107], v[164:167], v[76:79]
ds_read_b64_tr_b16 a[84:85], v118 offset:20480
v_mul_f32 v61, v61, v25
v_mfma_f32_16x16x32_bf16 v[76:79], a[108:111], v[180:183], v[76:79]
ds_read_b64_tr_b16 a[86:87], v118 offset:22528
v_mul_f32 v62, v62, v25
v_mfma_f32_16x16x32_bf16 v[76:79], a[112:115], v[196:199], v[76:79]
ds_read_b64_tr_b16 a[88:89], v118 offset:24576
v_mul_f32 v63, v63, v25
v_mfma_f32_16x16x32_bf16 v[76:79], a[116:119], v[212:215], v[76:79]
s_add_u32 s81, s81, 28672
s_add_u32 m0, s18, 102400
ds_read_b64_tr_b16 a[90:91], v118 offset:26624
v_mfma_f32_16x16x32_bf16 v[76:79], a[120:123], v[228:231], v[76:79]
buffer_load_dwordx4 v112, s[36:39], s81 offen offset:0 lds
ds_read_b64_tr_b16 a[92:93], v118 offset:28672
v_mfma_f32_16x16x32_bf16 v[76:79], a[124:127], v[244:247], v[76:79]
s_waitcnt lgkmcnt(8)
ds_read_b64_tr_b16 a[94:95], v118 offset:30720
v_add_u32 v118, 4294901760, v118
v_mfma_f32_16x16x32_bf16 v[80:83], a[64:67], v[128:131], 0
ds_read_b64_tr_b16 a[96:97], v119 offset:0
v_cvt_pk_bf16_f32 v52, v52, v53
v_mfma_f32_16x16x32_bf16 v[80:83], a[68:71], v[144:147], v[80:83]
ds_read_b64_tr_b16 a[98:99], v119 offset:2048
v_cvt_pk_bf16_f32 v53, v54, v55
v_mfma_f32_16x16x32_bf16 v[80:83], a[72:75], v[160:163], v[80:83]
s_waitcnt lgkmcnt(8)
ds_read_b64_tr_b16 a[100:101], v119 offset:4096
v_cvt_pk_bf16_f32 v54, v60, v61
v_mfma_f32_16x16x32_bf16 v[80:83], a[76:79], v[176:179], v[80:83]
ds_read_b64_tr_b16 a[102:103], v119 offset:6144
v_cvt_pk_bf16_f32 v55, v62, v63
v_mfma_f32_16x16x32_bf16 v[80:83], a[80:83], v[192:195], v[80:83]
s_waitcnt lgkmcnt(8)
buffer_store_dwordx4 v[52:55], v1, s[4:7], s12 offen offset:1024 sc1
ds_read_b64_tr_b16 a[104:105], v119 offset:8192
v_mfma_f32_16x16x32_bf16 v[80:83], a[84:87], v[208:211], v[80:83]
s_waitcnt lgkmcnt(7)
buffer_load_dwordx4 v113, s[36:39], s81 offen offset:1024 lds
ds_read_b64_tr_b16 a[106:107], v119 offset:10240
v_mfma_f32_16x16x32_bf16 v[80:83], a[88:91], v[224:227], v[80:83]
s_waitcnt lgkmcnt(6)
ds_read_b64_tr_b16 a[108:109], v119 offset:12288
v_mul_f32 v64, v64, v24
v_mfma_f32_16x16x32_bf16 v[80:83], a[92:95], v[240:243], v[80:83]
ds_read_b64_tr_b16 a[110:111], v119 offset:14336
v_mul_f32 v65, v65, v24
v_mfma_f32_16x16x32_bf16 v[84:87], a[64:67], v[132:135], 0
ds_read_b64_tr_b16 a[112:113], v119 offset:16384
v_mul_f32 v66, v66, v24
v_mfma_f32_16x16x32_bf16 v[84:87], a[68:71], v[148:151], v[84:87]
ds_read_b64_tr_b16 a[114:115], v119 offset:18432
v_mul_f32 v67, v67, v24
v_mfma_f32_16x16x32_bf16 v[84:87], a[72:75], v[164:167], v[84:87]
ds_read_b64_tr_b16 a[116:117], v119 offset:20480
v_mul_f32 v72, v72, v24
v_mfma_f32_16x16x32_bf16 v[84:87], a[76:79], v[180:183], v[84:87]
ds_read_b64_tr_b16 a[118:119], v119 offset:22528
v_mul_f32 v73, v73, v24
v_mfma_f32_16x16x32_bf16 v[84:87], a[80:83], v[196:199], v[84:87]
buffer_load_dwordx4 v114, s[36:39], s81 offen offset:2048 lds
ds_read_b64_tr_b16 a[120:121], v119 offset:24576
v_mfma_f32_16x16x32_bf16 v[84:87], a[84:87], v[212:215], v[84:87]
ds_read_b64_tr_b16 a[122:123], v119 offset:26624
v_mul_f32 v74, v74, v24
v_mfma_f32_16x16x32_bf16 v[84:87], a[88:91], v[228:231], v[84:87]
ds_read_b64_tr_b16 a[124:125], v119 offset:28672
ds_read_b64_tr_b16 a[126:127], v119 offset:30720
v_mfma_f32_16x16x32_bf16 v[84:87], a[92:95], v[244:247], v[84:87]
s_waitcnt vmcnt(27) lgkmcnt(9)
s_barrier
v_add_u32 v119, 4294901760, v119
v_mfma_f32_16x16x32_bf16 v[88:91], a[96:99], v[128:131], 0
ds_read_b64_tr_b16 a[64:65], v116 offset:0
v_mul_f32 v75, v75, v24
v_mfma_f32_16x16x32_bf16 v[88:91], a[100:103], v[144:147], v[88:91]
ds_read_b64_tr_b16 a[66:67], v116 offset:2048
v_cvt_pk_bf16_f32 v64, v64, v65
v_mfma_f32_16x16x32_bf16 v[88:91], a[104:107], v[160:163], v[88:91]
s_waitcnt lgkmcnt(8)
ds_read_b64_tr_b16 a[68:69], v116 offset:4096
v_cvt_pk_bf16_f32 v65, v66, v67
v_mfma_f32_16x16x32_bf16 v[88:91], a[108:111], v[176:179], v[88:91]
buffer_load_dwordx4 v115, s[36:39], s81 offen offset:3072 lds
ds_read_b64_tr_b16 a[70:71], v116 offset:6144
v_mfma_f32_16x16x32_bf16 v[88:91], a[112:115], v[192:195], v[88:91]
s_waitcnt lgkmcnt(8)
ds_read_b64_tr_b16 a[72:73], v116 offset:8192
v_cvt_pk_bf16_f32 v66, v72, v73
v_mfma_f32_16x16x32_bf16 v[88:91], a[116:119], v[208:211], v[88:91]
s_waitcnt lgkmcnt(7)
ds_read_b64_tr_b16 a[74:75], v116 offset:10240
v_cvt_pk_bf16_f32 v67, v74, v75
v_mfma_f32_16x16x32_bf16 v[88:91], a[120:123], v[224:227], v[88:91]
s_waitcnt lgkmcnt(6)
buffer_store_dwordx4 v[64:67], v1, s[4:7], s8 offen offset:2048 sc1
ds_read_b64_tr_b16 a[76:77], v116 offset:12288
v_mfma_f32_16x16x32_bf16 v[88:91], a[124:127], v[240:243], v[88:91]
ds_read_b64_tr_b16 a[78:79], v116 offset:14336
v_mul_f32 v68, v68, v25
v_mfma_f32_16x16x32_bf16 v[92:95], a[96:99], v[132:135], 0
ds_read_b64_tr_b16 a[80:81], v116 offset:16384
v_mul_f32 v69, v69, v25
v_mfma_f32_16x16x32_bf16 v[92:95], a[100:103], v[148:151], v[92:95]
s_sub_u32 s81, s81, 28544
ds_read_b64_tr_b16 a[82:83], v116 offset:18432
v_mul_f32 v70, v70, v25
v_mfma_f32_16x16x32_bf16 v[92:95], a[104:107], v[164:167], v[92:95]
ds_read_b64_tr_b16 a[84:85], v116 offset:20480
v_mul_f32 v71, v71, v25
v_mfma_f32_16x16x32_bf16 v[92:95], a[108:111], v[180:183], v[92:95]
ds_read_b64_tr_b16 a[86:87], v116 offset:22528
v_mul_f32 v76, v76, v25
v_mfma_f32_16x16x32_bf16 v[92:95], a[112:115], v[196:199], v[92:95]
ds_read_b64_tr_b16 a[88:89], v116 offset:24576
v_mul_f32 v77, v77, v25
v_mfma_f32_16x16x32_bf16 v[92:95], a[116:119], v[212:215], v[92:95]
ds_read_b64_tr_b16 a[90:91], v116 offset:26624
v_mul_f32 v78, v78, v25
v_mfma_f32_16x16x32_bf16 v[92:95], a[120:123], v[228:231], v[92:95]
ds_read_b64_tr_b16 a[92:93], v116 offset:28672
v_mul_f32 v79, v79, v25
v_mfma_f32_16x16x32_bf16 v[92:95], a[124:127], v[244:247], v[92:95]
s_waitcnt lgkmcnt(8)
ds_read_b64_tr_b16 a[94:95], v116 offset:30720
v_add_u32 v116, 32768, v116
v_mfma_f32_16x16x32_bf16 v[32:35], a[64:67], v[128:131], 0
ds_read_b64_tr_b16 a[96:97], v117 offset:0
v_cvt_pk_bf16_f32 v68, v68, v69
v_mfma_f32_16x16x32_bf16 v[32:35], a[68:71], v[144:147], v[32:35]
ds_read_b64_tr_b16 a[98:99], v117 offset:2048
v_cvt_pk_bf16_f32 v69, v70, v71
v_mfma_f32_16x16x32_bf16 v[32:35], a[72:75], v[160:163], v[32:35]
s_waitcnt lgkmcnt(8)
ds_read_b64_tr_b16 a[100:101], v117 offset:4096
v_cvt_pk_bf16_f32 v70, v76, v77
v_mfma_f32_16x16x32_bf16 v[32:35], a[76:79], v[176:179], v[32:35]
ds_read_b64_tr_b16 a[102:103], v117 offset:6144
v_cvt_pk_bf16_f32 v71, v78, v79
v_mfma_f32_16x16x32_bf16 v[32:35], a[80:83], v[192:195], v[32:35]
s_waitcnt lgkmcnt(8)
buffer_store_dwordx4 v[68:71], v1, s[4:7], s12 offen offset:2048 sc1
ds_read_b64_tr_b16 a[104:105], v117 offset:8192
v_mfma_f32_16x16x32_bf16 v[32:35], a[84:87], v[208:211], v[32:35]
s_waitcnt lgkmcnt(7)
ds_read_b64_tr_b16 a[106:107], v117 offset:10240
v_mul_f32 v80, v80, v24
v_mfma_f32_16x16x32_bf16 v[32:35], a[88:91], v[224:227], v[32:35]
s_waitcnt lgkmcnt(6)
ds_read_b64_tr_b16 a[108:109], v117 offset:12288
v_mul_f32 v81, v81, v24
v_mfma_f32_16x16x32_bf16 v[32:35], a[92:95], v[240:243], v[32:35]
ds_read_b64_tr_b16 a[110:111], v117 offset:14336
v_mul_f32 v82, v82, v24
v_mfma_f32_16x16x32_bf16 v[36:39], a[64:67], v[132:135], 0
ds_read_b64_tr_b16 a[112:113], v117 offset:16384
v_mul_f32 v83, v83, v24
v_mfma_f32_16x16x32_bf16 v[36:39], a[68:71], v[148:151], v[36:39]
ds_read_b64_tr_b16 a[114:115], v117 offset:18432
v_mul_f32 v88, v88, v24
v_mfma_f32_16x16x32_bf16 v[36:39], a[72:75], v[164:167], v[36:39]
ds_read_b64_tr_b16 a[116:117], v117 offset:20480
v_mul_f32 v89, v89, v24
v_mfma_f32_16x16x32_bf16 v[36:39], a[76:79], v[180:183], v[36:39]
ds_read_b64_tr_b16 a[118:119], v117 offset:22528
v_mul_f32 v90, v90, v24
v_mfma_f32_16x16x32_bf16 v[36:39], a[80:83], v[196:199], v[36:39]
ds_read_b64_tr_b16 a[120:121], v117 offset:24576
v_mul_f32 v91, v91, v24
v_mfma_f32_16x16x32_bf16 v[36:39], a[84:87], v[212:215], v[36:39]
ds_read_b64_tr_b16 a[122:123], v117 offset:26624
v_cvt_pk_bf16_f32 v80, v80, v81
v_mfma_f32_16x16x32_bf16 v[36:39], a[88:91], v[228:231], v[36:39]
ds_read_b64_tr_b16 a[124:125], v117 offset:28672
v_cvt_pk_bf16_f32 v81, v82, v83
v_mfma_f32_16x16x32_bf16 v[36:39], a[92:95], v[244:247], v[36:39]
s_waitcnt lgkmcnt(8)
ds_read_b64_tr_b16 a[126:127], v117 offset:30720
v_add_u32 v117, 32768, v117
v_mfma_f32_16x16x32_bf16 v[40:43], a[96:99], v[128:131], 0
ds_read_b64_tr_b16 a[64:65], v118 offset:0
v_cvt_pk_bf16_f32 v82, v88, v89
v_mfma_f32_16x16x32_bf16 v[40:43], a[100:103], v[144:147], v[40:43]
ds_read_b64_tr_b16 a[66:67], v118 offset:2048
v_cvt_pk_bf16_f32 v83, v90, v91
v_mfma_f32_16x16x32_bf16 v[40:43], a[104:107], v[160:163], v[40:43]
s_waitcnt lgkmcnt(8)
buffer_store_dwordx4 v[80:83], v1, s[4:7], s8 offen offset:3072 sc1
ds_read_b64_tr_b16 a[68:69], v118 offset:4096
v_mfma_f32_16x16x32_bf16 v[40:43], a[108:111], v[176:179], v[40:43]
ds_read_b64_tr_b16 a[70:71], v118 offset:6144
v_mul_f32 v84, v84, v25
v_mfma_f32_16x16x32_bf16 v[40:43], a[112:115], v[192:195], v[40:43]
s_waitcnt lgkmcnt(8)
ds_read_b64_tr_b16 a[72:73], v118 offset:8192
v_mul_f32 v85, v85, v25
v_mfma_f32_16x16x32_bf16 v[40:43], a[116:119], v[208:211], v[40:43]
s_waitcnt lgkmcnt(7)
ds_read_b64_tr_b16 a[74:75], v118 offset:10240
v_mul_f32 v86, v86, v25
v_mfma_f32_16x16x32_bf16 v[40:43], a[120:123], v[224:227], v[40:43]
s_waitcnt lgkmcnt(6)
ds_read_b64_tr_b16 a[76:77], v118 offset:12288
v_mul_f32 v87, v87, v25
v_mfma_f32_16x16x32_bf16 v[40:43], a[124:127], v[240:243], v[40:43]
ds_read_b64_tr_b16 a[78:79], v118 offset:14336
v_mul_f32 v92, v92, v25
v_mfma_f32_16x16x32_bf16 v[44:47], a[96:99], v[132:135], 0
ds_read_b64_tr_b16 a[80:81], v118 offset:16384
v_mul_f32 v93, v93, v25
v_mfma_f32_16x16x32_bf16 v[44:47], a[100:103], v[148:151], v[44:47]
ds_read_b64_tr_b16 a[82:83], v118 offset:18432
v_mul_f32 v94, v94, v25
v_mfma_f32_16x16x32_bf16 v[44:47], a[104:107], v[164:167], v[44:47]
ds_read_b64_tr_b16 a[84:85], v118 offset:20480
v_mul_f32 v95, v95, v25
v_mfma_f32_16x16x32_bf16 v[44:47], a[108:111], v[180:183], v[44:47]
ds_read_b64_tr_b16 a[86:87], v118 offset:22528
v_cvt_pk_bf16_f32 v84, v84, v85
v_mfma_f32_16x16x32_bf16 v[44:47], a[112:115], v[196:199], v[44:47]
ds_read_b64_tr_b16 a[88:89], v118 offset:24576
v_cvt_pk_bf16_f32 v85, v86, v87
v_mfma_f32_16x16x32_bf16 v[44:47], a[116:119], v[212:215], v[44:47]
ds_read_b64_tr_b16 a[90:91], v118 offset:26624
v_cvt_pk_bf16_f32 v86, v92, v93
v_mfma_f32_16x16x32_bf16 v[44:47], a[120:123], v[228:231], v[44:47]
ds_read_b64_tr_b16 a[92:93], v118 offset:28672
v_cvt_pk_bf16_f32 v87, v94, v95
v_mfma_f32_16x16x32_bf16 v[44:47], a[124:127], v[244:247], v[44:47]
s_waitcnt lgkmcnt(8)
ds_read_b64_tr_b16 a[94:95], v118 offset:30720
v_add_u32 v118, 32768, v118
v_mfma_f32_16x16x32_bf16 v[48:51], a[64:67], v[128:131], 0
buffer_store_dwordx4 v[84:87], v1, s[4:7], s12 offen offset:3072 sc1
ds_read_b64_tr_b16 a[96:97], v119 offset:0
v_mfma_f32_16x16x32_bf16 v[48:51], a[68:71], v[144:147], v[48:51]
s_add_u32 s8, s8, 4096
s_add_u32 s12, s12, 4096
ds_read_b64_tr_b16 a[98:99], v119 offset:2048
v_mfma_f32_16x16x32_bf16 v[48:51], a[72:75], v[160:163], v[48:51]
s_waitcnt lgkmcnt(8)
ds_read_b64_tr_b16 a[100:101], v119 offset:4096
v_mul_f32 v32, v32, v24
v_mfma_f32_16x16x32_bf16 v[48:51], a[76:79], v[176:179], v[48:51]
ds_read_b64_tr_b16 a[102:103], v119 offset:6144
v_mul_f32 v33, v33, v24
v_mfma_f32_16x16x32_bf16 v[48:51], a[80:83], v[192:195], v[48:51]
s_waitcnt lgkmcnt(8)
ds_read_b64_tr_b16 a[104:105], v119 offset:8192
v_mul_f32 v34, v34, v24
v_mfma_f32_16x16x32_bf16 v[48:51], a[84:87], v[208:211], v[48:51]
s_waitcnt lgkmcnt(7)
ds_read_b64_tr_b16 a[106:107], v119 offset:10240
v_mul_f32 v35, v35, v24
v_mfma_f32_16x16x32_bf16 v[48:51], a[88:91], v[224:227], v[48:51]
s_waitcnt lgkmcnt(6)
ds_read_b64_tr_b16 a[108:109], v119 offset:12288
v_mul_f32 v40, v40, v24
v_mfma_f32_16x16x32_bf16 v[48:51], a[92:95], v[240:243], v[48:51]
ds_read_b64_tr_b16 a[110:111], v119 offset:14336
v_mul_f32 v41, v41, v24
v_mfma_f32_16x16x32_bf16 v[52:55], a[64:67], v[132:135], 0
ds_read_b64_tr_b16 a[112:113], v119 offset:16384
v_mul_f32 v42, v42, v24
v_mfma_f32_16x16x32_bf16 v[52:55], a[68:71], v[148:151], v[52:55]
ds_read_b64_tr_b16 a[114:115], v119 offset:18432
v_mul_f32 v43, v43, v24
v_mfma_f32_16x16x32_bf16 v[52:55], a[72:75], v[164:167], v[52:55]
ds_read_b64_tr_b16 a[116:117], v119 offset:20480
v_cvt_pk_bf16_f32 v32, v32, v33
v_mfma_f32_16x16x32_bf16 v[52:55], a[76:79], v[180:183], v[52:55]
ds_read_b64_tr_b16 a[118:119], v119 offset:22528
v_cvt_pk_bf16_f32 v33, v34, v35
v_mfma_f32_16x16x32_bf16 v[52:55], a[80:83], v[196:199], v[52:55]
ds_read_b64_tr_b16 a[120:121], v119 offset:24576
v_cvt_pk_bf16_f32 v34, v40, v41
v_mfma_f32_16x16x32_bf16 v[52:55], a[84:87], v[212:215], v[52:55]
ds_read_b64_tr_b16 a[122:123], v119 offset:26624
v_cvt_pk_bf16_f32 v35, v42, v43
v_mfma_f32_16x16x32_bf16 v[52:55], a[88:91], v[228:231], v[52:55]
ds_read_b64_tr_b16 a[124:125], v119 offset:28672
ds_read_b64_tr_b16 a[126:127], v119 offset:30720
v_mfma_f32_16x16x32_bf16 v[52:55], a[92:95], v[244:247], v[52:55]
s_waitcnt vmcnt(16) lgkmcnt(9)
s_barrier
v_add_u32 v119, 32768, v119
v_mfma_f32_16x16x32_bf16 v[56:59], a[96:99], v[128:131], 0
buffer_store_dwordx4 v[32:35], v1, s[4:7], s8 offen offset:0 sc1
ds_read_b64_tr_b16 a[64:65], v116 offset:0
v_mfma_f32_16x16x32_bf16 v[56:59], a[100:103], v[144:147], v[56:59]
ds_read_b64_tr_b16 a[66:67], v116 offset:2048
v_mul_f32 v36, v36, v25
v_mfma_f32_16x16x32_bf16 v[56:59], a[104:107], v[160:163], v[56:59]
s_waitcnt lgkmcnt(8)
ds_read_b64_tr_b16 a[68:69], v116 offset:4096
v_mul_f32 v37, v37, v25
v_mfma_f32_16x16x32_bf16 v[56:59], a[108:111], v[176:179], v[56:59]
ds_read_b64_tr_b16 a[70:71], v116 offset:6144
v_mul_f32 v38, v38, v25
v_mfma_f32_16x16x32_bf16 v[56:59], a[112:115], v[192:195], v[56:59]
s_waitcnt lgkmcnt(8)
ds_read_b64_tr_b16 a[72:73], v116 offset:8192
v_mul_f32 v39, v39, v25
v_mfma_f32_16x16x32_bf16 v[56:59], a[116:119], v[208:211], v[56:59]
s_waitcnt lgkmcnt(7)
ds_read_b64_tr_b16 a[74:75], v116 offset:10240
v_mul_f32 v44, v44, v25
v_mfma_f32_16x16x32_bf16 v[56:59], a[120:123], v[224:227], v[56:59]
s_waitcnt lgkmcnt(6)
ds_read_b64_tr_b16 a[76:77], v116 offset:12288
v_mul_f32 v45, v45, v25
v_mfma_f32_16x16x32_bf16 v[56:59], a[124:127], v[240:243], v[56:59]
ds_read_b64_tr_b16 a[78:79], v116 offset:14336
v_mul_f32 v46, v46, v25
v_mfma_f32_16x16x32_bf16 v[60:63], a[96:99], v[132:135], 0
ds_read_b64_tr_b16 a[80:81], v116 offset:16384
v_mul_f32 v47, v47, v25
v_mfma_f32_16x16x32_bf16 v[60:63], a[100:103], v[148:151], v[60:63]
ds_read_b64_tr_b16 a[82:83], v116 offset:18432
v_cvt_pk_bf16_f32 v36, v36, v37
v_mfma_f32_16x16x32_bf16 v[60:63], a[104:107], v[164:167], v[60:63]
ds_read_b64_tr_b16 a[84:85], v116 offset:20480
v_cvt_pk_bf16_f32 v37, v38, v39
v_mfma_f32_16x16x32_bf16 v[60:63], a[108:111], v[180:183], v[60:63]
ds_read_b64_tr_b16 a[86:87], v116 offset:22528
v_cvt_pk_bf16_f32 v38, v44, v45
v_mfma_f32_16x16x32_bf16 v[60:63], a[112:115], v[196:199], v[60:63]
ds_read_b64_tr_b16 a[88:89], v116 offset:24576
v_cvt_pk_bf16_f32 v39, v46, v47
v_mfma_f32_16x16x32_bf16 v[60:63], a[116:119], v[212:215], v[60:63]
buffer_store_dwordx4 v[36:39], v1, s[4:7], s12 offen offset:0 sc1
ds_read_b64_tr_b16 a[90:91], v116 offset:26624
v_mfma_f32_16x16x32_bf16 v[60:63], a[120:123], v[228:231], v[60:63]
ds_read_b64_tr_b16 a[92:93], v116 offset:28672
v_mfma_f32_16x16x32_bf16 v[60:63], a[124:127], v[244:247], v[60:63]
s_waitcnt lgkmcnt(8)
ds_read_b64_tr_b16 a[94:95], v116 offset:30720
v_add_u32 v116, 65536, v116
v_mfma_f32_16x16x32_bf16 v[64:67], a[64:67], v[128:131], 0
ds_read_b64_tr_b16 a[96:97], v117 offset:0
v_mul_f32 v48, v48, v24
v_mfma_f32_16x16x32_bf16 v[64:67], a[68:71], v[144:147], v[64:67]
ds_read_b64_tr_b16 a[98:99], v117 offset:2048
v_mul_f32 v49, v49, v24
v_mfma_f32_16x16x32_bf16 v[64:67], a[72:75], v[160:163], v[64:67]
s_waitcnt lgkmcnt(8)
ds_read_b64_tr_b16 a[100:101], v117 offset:4096
v_mul_f32 v50, v50, v24
v_mfma_f32_16x16x32_bf16 v[64:67], a[76:79], v[176:179], v[64:67]
ds_read_b64_tr_b16 a[102:103], v117 offset:6144
v_mul_f32 v51, v51, v24
v_mfma_f32_16x16x32_bf16 v[64:67], a[80:83], v[192:195], v[64:67]
s_waitcnt lgkmcnt(8)
ds_read_b64_tr_b16 a[104:105], v117 offset:8192
v_mul_f32 v56, v56, v24
v_mfma_f32_16x16x32_bf16 v[64:67], a[84:87], v[208:211], v[64:67]
s_waitcnt lgkmcnt(7)
ds_read_b64_tr_b16 a[106:107], v117 offset:10240
v_mul_f32 v57, v57, v24
v_mfma_f32_16x16x32_bf16 v[64:67], a[88:91], v[224:227], v[64:67]
s_waitcnt lgkmcnt(6)
ds_read_b64_tr_b16 a[108:109], v117 offset:12288
v_mul_f32 v58, v58, v24
v_mfma_f32_16x16x32_bf16 v[64:67], a[92:95], v[240:243], v[64:67]
ds_read_b64_tr_b16 a[110:111], v117 offset:14336
v_mul_f32 v59, v59, v24
v_mfma_f32_16x16x32_bf16 v[68:71], a[64:67], v[132:135], 0
ds_read_b64_tr_b16 a[112:113], v117 offset:16384
v_cvt_pk_bf16_f32 v48, v48, v49
v_mfma_f32_16x16x32_bf16 v[68:71], a[68:71], v[148:151], v[68:71]
ds_read_b64_tr_b16 a[114:115], v117 offset:18432
v_cvt_pk_bf16_f32 v49, v50, v51
v_mfma_f32_16x16x32_bf16 v[68:71], a[72:75], v[164:167], v[68:71]
ds_read_b64_tr_b16 a[116:117], v117 offset:20480
v_cvt_pk_bf16_f32 v50, v56, v57
v_mfma_f32_16x16x32_bf16 v[68:71], a[76:79], v[180:183], v[68:71]
ds_read_b64_tr_b16 a[118:119], v117 offset:22528
v_cvt_pk_bf16_f32 v51, v58, v59
v_mfma_f32_16x16x32_bf16 v[68:71], a[80:83], v[196:199], v[68:71]
buffer_store_dwordx4 v[48:51], v1, s[4:7], s8 offen offset:1024 sc1
ds_read_b64_tr_b16 a[120:121], v117 offset:24576
v_mfma_f32_16x16x32_bf16 v[68:71], a[84:87], v[212:215], v[68:71]
ds_read_b64_tr_b16 a[122:123], v117 offset:26624
v_mul_f32 v52, v52, v25
v_mfma_f32_16x16x32_bf16 v[68:71], a[88:91], v[228:231], v[68:71]
ds_read_b64_tr_b16 a[124:125], v117 offset:28672
v_mul_f32 v53, v53, v25
v_mfma_f32_16x16x32_bf16 v[68:71], a[92:95], v[244:247], v[68:71]
s_waitcnt lgkmcnt(8)
ds_read_b64_tr_b16 a[126:127], v117 offset:30720
v_add_u32 v117, 65536, v117
v_mfma_f32_16x16x32_bf16 v[72:75], a[96:99], v[128:131], 0
ds_read_b64_tr_b16 a[64:65], v118 offset:0
v_mul_f32 v54, v54, v25
v_mfma_f32_16x16x32_bf16 v[72:75], a[100:103], v[144:147], v[72:75]
ds_read_b64_tr_b16 a[66:67], v118 offset:2048
v_mul_f32 v55, v55, v25
v_mfma_f32_16x16x32_bf16 v[72:75], a[104:107], v[160:163], v[72:75]
s_waitcnt lgkmcnt(8)
ds_read_b64_tr_b16 a[68:69], v118 offset:4096
v_mul_f32 v60, v60, v25
v_mfma_f32_16x16x32_bf16 v[72:75], a[108:111], v[176:179], v[72:75]
ds_read_b64_tr_b16 a[70:71], v118 offset:6144
v_mul_f32 v61, v61, v25
v_mfma_f32_16x16x32_bf16 v[72:75], a[112:115], v[192:195], v[72:75]
s_waitcnt lgkmcnt(8)
ds_read_b64_tr_b16 a[72:73], v118 offset:8192
v_mul_f32 v62, v62, v25
v_mfma_f32_16x16x32_bf16 v[72:75], a[116:119], v[208:211], v[72:75]
s_waitcnt lgkmcnt(7)
ds_read_b64_tr_b16 a[74:75], v118 offset:10240
v_mul_f32 v63, v63, v25
v_mfma_f32_16x16x32_bf16 v[72:75], a[120:123], v[224:227], v[72:75]
s_waitcnt lgkmcnt(6)
ds_read_b64_tr_b16 a[76:77], v118 offset:12288
v_cvt_pk_bf16_f32 v52, v52, v53
v_mfma_f32_16x16x32_bf16 v[72:75], a[124:127], v[240:243], v[72:75]
ds_read_b64_tr_b16 a[78:79], v118 offset:14336
v_cvt_pk_bf16_f32 v53, v54, v55
v_mfma_f32_16x16x32_bf16 v[76:79], a[96:99], v[132:135], 0
ds_read_b64_tr_b16 a[80:81], v118 offset:16384
v_cvt_pk_bf16_f32 v54, v60, v61
v_mfma_f32_16x16x32_bf16 v[76:79], a[100:103], v[148:151], v[76:79]
ds_read_b64_tr_b16 a[82:83], v118 offset:18432
v_cvt_pk_bf16_f32 v55, v62, v63
v_mfma_f32_16x16x32_bf16 v[76:79], a[104:107], v[164:167], v[76:79]
buffer_store_dwordx4 v[52:55], v1, s[4:7], s12 offen offset:1024 sc1
ds_read_b64_tr_b16 a[84:85], v118 offset:20480
v_mfma_f32_16x16x32_bf16 v[76:79], a[108:111], v[180:183], v[76:79]
ds_read_b64_tr_b16 a[86:87], v118 offset:22528
v_mul_u32_u24 v21, 1792, v19
v_mfma_f32_16x16x32_bf16 v[76:79], a[112:115], v[196:199], v[76:79]
ds_read_b64_tr_b16 a[88:89], v118 offset:24576
v_mul_f32 v64, v64, v24
v_mfma_f32_16x16x32_bf16 v[76:79], a[116:119], v[212:215], v[76:79]
ds_read_b64_tr_b16 a[90:91], v118 offset:26624
v_mul_f32 v65, v65, v24
v_mfma_f32_16x16x32_bf16 v[76:79], a[120:123], v[228:231], v[76:79]
ds_read_b64_tr_b16 a[92:93], v118 offset:28672
v_mul_f32 v66, v66, v24
v_mfma_f32_16x16x32_bf16 v[76:79], a[124:127], v[244:247], v[76:79]
s_waitcnt lgkmcnt(8)
ds_read_b64_tr_b16 a[94:95], v118 offset:30720
v_add_u32 v118, 65536, v118
v_mfma_f32_16x16x32_bf16 v[80:83], a[64:67], v[128:131], 0
ds_read_b64_tr_b16 a[96:97], v119 offset:0
v_mul_f32 v67, v67, v24
v_mfma_f32_16x16x32_bf16 v[80:83], a[68:71], v[144:147], v[80:83]
ds_read_b64_tr_b16 a[98:99], v119 offset:2048
v_mul_f32 v72, v72, v24
v_mfma_f32_16x16x32_bf16 v[80:83], a[72:75], v[160:163], v[80:83]
s_waitcnt lgkmcnt(8)
ds_read_b64_tr_b16 a[100:101], v119 offset:4096
v_mul_f32 v73, v73, v24
v_mfma_f32_16x16x32_bf16 v[80:83], a[76:79], v[176:179], v[80:83]
ds_read_b64_tr_b16 a[102:103], v119 offset:6144
v_mul_f32 v74, v74, v24
v_mfma_f32_16x16x32_bf16 v[80:83], a[80:83], v[192:195], v[80:83]
PAD_16:
s_cbranch_execz M_tret
s_waitcnt lgkmcnt(8)
ds_read_b64_tr_b16 a[104:105], v119 offset:8192
v_mul_f32 v75, v75, v24
v_mfma_f32_16x16x32_bf16 v[80:83], a[84:87], v[208:211], v[80:83]
s_waitcnt lgkmcnt(7)
ds_read_b64_tr_b16 a[106:107], v119 offset:10240
v_cvt_pk_bf16_f32 v64, v64, v65
v_mfma_f32_16x16x32_bf16 v[80:83], a[88:91], v[224:227], v[80:83]
s_waitcnt lgkmcnt(6)
ds_read_b64_tr_b16 a[108:109], v119 offset:12288
v_cvt_pk_bf16_f32 v65, v66, v67
v_mfma_f32_16x16x32_bf16 v[80:83], a[92:95], v[240:243], v[80:83]
ds_read_b64_tr_b16 a[110:111], v119 offset:14336
v_cvt_pk_bf16_f32 v66, v72, v73
v_mfma_f32_16x16x32_bf16 v[84:87], a[64:67], v[132:135], 0
ds_read_b64_tr_b16 a[112:113], v119 offset:16384
v_cvt_pk_bf16_f32 v67, v74, v75
v_mfma_f32_16x16x32_bf16 v[84:87], a[68:71], v[148:151], v[84:87]
buffer_store_dwordx4 v[64:67], v1, s[4:7], s8 offen offset:2048 sc1
ds_read_b64_tr_b16 a[114:115], v119 offset:18432
v_mfma_f32_16x16x32_bf16 v[84:87], a[72:75], v[164:167], v[84:87]
ds_read_b64_tr_b16 a[116:117], v119 offset:20480
v_mul_f32 v68, v68, v25
v_mfma_f32_16x16x32_bf16 v[84:87], a[76:79], v[180:183], v[84:87]
ds_read_b64_tr_b16 a[118:119], v119 offset:22528
v_mul_f32 v69, v69, v25
v_mfma_f32_16x16x32_bf16 v[84:87], a[80:83], v[196:199], v[84:87]
ds_read_b64_tr_b16 a[120:121], v119 offset:24576
v_mul_f32 v70, v70, v25
v_mfma_f32_16x16x32_bf16 v[84:87], a[84:87], v[212:215], v[84:87]
ds_read_b64_tr_b16 a[122:123], v119 offset:26624
v_mul_f32 v71, v71, v25
v_mfma_f32_16x16x32_bf16 v[84:87], a[88:91], v[228:231], v[84:87]
ds_read_b64_tr_b16 a[124:125], v119 offset:28672
ds_read_b64_tr_b16 a[126:127], v119 offset:30720
v_mfma_f32_16x16x32_bf16 v[84:87], a[92:95], v[244:247], v[84:87]
s_waitcnt vmcnt(7) lgkmcnt(9)
s_barrier
v_add_u32 v119, 65536, v119
v_mfma_f32_16x16x32_bf16 v[88:91], a[96:99], v[128:131], 0
ds_read_b64_tr_b16 a[64:65], v116 offset:0
v_mul_f32 v76, v76, v25
v_mfma_f32_16x16x32_bf16 v[88:91], a[100:103], v[144:147], v[88:91]
buffer_store_dword v6, v5, s[4:7], s34 offen sc1
ds_read_b64_tr_b16 a[66:67], v116 offset:2048
v_mfma_f32_16x16x32_bf16 v[88:91], a[104:107], v[160:163], v[88:91]
s_waitcnt lgkmcnt(8)
ds_read_b64_tr_b16 a[68:69], v116 offset:4096
v_mul_f32 v77, v77, v25
v_mfma_f32_16x16x32_bf16 v[88:91], a[108:111], v[176:179], v[88:91]
ds_read_b64_tr_b16 a[70:71], v116 offset:6144
v_mul_f32 v78, v78, v25
v_mfma_f32_16x16x32_bf16 v[88:91], a[112:115], v[192:195], v[88:91]
s_waitcnt lgkmcnt(8)
ds_read_b64_tr_b16 a[72:73], v116 offset:8192
v_mul_f32 v79, v79, v25
v_mfma_f32_16x16x32_bf16 v[88:91], a[116:119], v[208:211], v[88:91]
s_waitcnt lgkmcnt(7)
ds_read_b64_tr_b16 a[74:75], v116 offset:10240
v_cvt_pk_bf16_f32 v68, v68, v69
v_mfma_f32_16x16x32_bf16 v[88:91], a[120:123], v[224:227], v[88:91]
s_waitcnt lgkmcnt(6)
ds_read_b64_tr_b16 a[76:77], v116 offset:12288
v_cvt_pk_bf16_f32 v69, v70, v71
v_mfma_f32_16x16x32_bf16 v[88:91], a[124:127], v[240:243], v[88:91]
ds_read_b64_tr_b16 a[78:79], v116 offset:14336
v_cvt_pk_bf16_f32 v70, v76, v77
v_mfma_f32_16x16x32_bf16 v[92:95], a[96:99], v[132:135], 0
ds_read_b64_tr_b16 a[80:81], v116 offset:16384
v_cvt_pk_bf16_f32 v71, v78, v79
v_mfma_f32_16x16x32_bf16 v[92:95], a[100:103], v[148:151], v[92:95]
buffer_store_dwordx4 v[68:71], v1, s[4:7], s12 offen offset:2048 sc1
ds_read_b64_tr_b16 a[82:83], v116 offset:18432
v_mfma_f32_16x16x32_bf16 v[92:95], a[104:107], v[164:167], v[92:95]
ds_read_b64_tr_b16 a[84:85], v116 offset:20480
v_lshlrev_b32 v19, 2, v19
v_mfma_f32_16x16x32_bf16 v[92:95], a[108:111], v[180:183], v[92:95]
ds_read_b64_tr_b16 a[86:87], v116 offset:22528
v_mfma_f32_16x16x32_bf16 v[92:95], a[112:115], v[196:199], v[92:95]
ds_read_b64_tr_b16 a[88:89], v116 offset:24576
v_mfma_f32_16x16x32_bf16 v[92:95], a[116:119], v[212:215], v[92:95]
ds_read_b64_tr_b16 a[90:91], v116 offset:26624
v_mfma_f32_16x16x32_bf16 v[92:95], a[120:123], v[228:231], v[92:95]
ds_read_b64_tr_b16 a[92:93], v116 offset:28672
v_mfma_f32_16x16x32_bf16 v[92:95], a[124:127], v[244:247], v[92:95]
s_waitcnt lgkmcnt(8)
ds_read_b64_tr_b16 a[94:95], v116 offset:30720
v_mfma_f32_16x16x32_bf16 v[32:35], a[64:67], v[128:131], 0
ds_read_b64_tr_b16 a[96:97], v117 offset:0
v_mul_f32 v80, v80, v24
v_mfma_f32_16x16x32_bf16 v[32:35], a[68:71], v[144:147], v[32:35]
ds_read_b64_tr_b16 a[98:99], v117 offset:2048
v_mul_f32 v81, v81, v24
v_mfma_f32_16x16x32_bf16 v[32:35], a[72:75], v[160:163], v[32:35]
s_waitcnt lgkmcnt(8)
ds_read_b64_tr_b16 a[100:101], v117 offset:4096
v_mul_f32 v82, v82, v24
v_mfma_f32_16x16x32_bf16 v[32:35], a[76:79], v[176:179], v[32:35]
ds_read_b64_tr_b16 a[102:103], v117 offset:6144
v_mul_f32 v83, v83, v24
v_mfma_f32_16x16x32_bf16 v[32:35], a[80:83], v[192:195], v[32:35]
s_waitcnt lgkmcnt(8)
ds_read_b64_tr_b16 a[104:105], v117 offset:8192
v_mul_f32 v88, v88, v24
v_mfma_f32_16x16x32_bf16 v[32:35], a[84:87], v[208:211], v[32:35]
s_waitcnt lgkmcnt(7)
ds_read_b64_tr_b16 a[106:107], v117 offset:10240
v_mul_f32 v89, v89, v24
v_mfma_f32_16x16x32_bf16 v[32:35], a[88:91], v[224:227], v[32:35]
s_waitcnt lgkmcnt(6)
ds_read_b64_tr_b16 a[108:109], v117 offset:12288
v_mul_f32 v90, v90, v24
v_mfma_f32_16x16x32_bf16 v[32:35], a[92:95], v[240:243], v[32:35]
ds_read_b64_tr_b16 a[110:111], v117 offset:14336
v_mul_f32 v91, v91, v24
v_mfma_f32_16x16x32_bf16 v[36:39], a[64:67], v[132:135], 0
ds_read_b64_tr_b16 a[112:113], v117 offset:16384
v_cvt_pk_bf16_f32 v80, v80, v81
v_mfma_f32_16x16x32_bf16 v[36:39], a[68:71], v[148:151], v[36:39]
ds_read_b64_tr_b16 a[114:115], v117 offset:18432
v_cvt_pk_bf16_f32 v81, v82, v83
v_mfma_f32_16x16x32_bf16 v[36:39], a[72:75], v[164:167], v[36:39]
ds_read_b64_tr_b16 a[116:117], v117 offset:20480
v_cvt_pk_bf16_f32 v82, v88, v89
v_mfma_f32_16x16x32_bf16 v[36:39], a[76:79], v[180:183], v[36:39]
ds_read_b64_tr_b16 a[118:119], v117 offset:22528
v_cvt_pk_bf16_f32 v83, v90, v91
v_mfma_f32_16x16x32_bf16 v[36:39], a[80:83], v[196:199], v[36:39]
buffer_store_dwordx4 v[80:83], v1, s[4:7], s8 offen offset:3072 sc1
ds_read_b64_tr_b16 a[120:121], v117 offset:24576
v_mfma_f32_16x16x32_bf16 v[36:39], a[84:87], v[212:215], v[36:39]
ds_read_b64_tr_b16 a[122:123], v117 offset:26624
v_mul_f32 v84, v84, v25
v_mfma_f32_16x16x32_bf16 v[36:39], a[88:91], v[228:231], v[36:39]
ds_read_b64_tr_b16 a[124:125], v117 offset:28672
v_mul_f32 v85, v85, v25
v_mfma_f32_16x16x32_bf16 v[36:39], a[92:95], v[244:247], v[36:39]
s_waitcnt lgkmcnt(8)
ds_read_b64_tr_b16 a[126:127], v117 offset:30720
v_mul_f32 v86, v86, v25
v_mfma_f32_16x16x32_bf16 v[40:43], a[96:99], v[128:131], 0
ds_read_b64_tr_b16 a[64:65], v118 offset:0
v_mul_f32 v87, v87, v25
v_mfma_f32_16x16x32_bf16 v[40:43], a[100:103], v[144:147], v[40:43]
ds_read_b64_tr_b16 a[66:67], v118 offset:2048
v_mul_f32 v92, v92, v25
v_mfma_f32_16x16x32_bf16 v[40:43], a[104:107], v[160:163], v[40:43]
s_waitcnt lgkmcnt(8)
ds_read_b64_tr_b16 a[68:69], v118 offset:4096
v_mul_f32 v93, v93, v25
v_mfma_f32_16x16x32_bf16 v[40:43], a[108:111], v[176:179], v[40:43]
ds_read_b64_tr_b16 a[70:71], v118 offset:6144
v_mul_f32 v94, v94, v25
v_mfma_f32_16x16x32_bf16 v[40:43], a[112:115], v[192:195], v[40:43]
s_waitcnt lgkmcnt(8)
ds_read_b64_tr_b16 a[72:73], v118 offset:8192
v_mul_f32 v95, v95, v25
v_mfma_f32_16x16x32_bf16 v[40:43], a[116:119], v[208:211], v[40:43]
s_waitcnt lgkmcnt(7)
ds_read_b64_tr_b16 a[74:75], v118 offset:10240
v_cvt_pk_bf16_f32 v84, v84, v85
v_mfma_f32_16x16x32_bf16 v[40:43], a[120:123], v[224:227], v[40:43]
s_waitcnt lgkmcnt(6)
ds_read_b64_tr_b16 a[76:77], v118 offset:12288
v_cvt_pk_bf16_f32 v85, v86, v87
v_mfma_f32_16x16x32_bf16 v[40:43], a[124:127], v[240:243], v[40:43]
ds_read_b64_tr_b16 a[78:79], v118 offset:14336
v_cvt_pk_bf16_f32 v86, v92, v93
v_mfma_f32_16x16x32_bf16 v[44:47], a[96:99], v[132:135], 0
ds_read_b64_tr_b16 a[80:81], v118 offset:16384
v_cvt_pk_bf16_f32 v87, v94, v95
v_mfma_f32_16x16x32_bf16 v[44:47], a[100:103], v[148:151], v[44:47]
buffer_store_dwordx4 v[84:87], v1, s[4:7], s12 offen offset:3072 sc1
ds_read_b64_tr_b16 a[82:83], v118 offset:18432
v_mfma_f32_16x16x32_bf16 v[44:47], a[104:107], v[164:167], v[44:47]
s_add_u32 s8, s8, 4096
s_add_u32 s12, s12, 4096
ds_read_b64_tr_b16 a[84:85], v118 offset:20480
v_mfma_f32_16x16x32_bf16 v[44:47], a[108:111], v[180:183], v[44:47]
ds_read_b64_tr_b16 a[86:87], v118 offset:22528
v_lshrrev_b32 v22, 4, v20
v_mfma_f32_16x16x32_bf16 v[44:47], a[112:115], v[196:199], v[44:47]
ds_read_b64_tr_b16 a[88:89], v118 offset:24576
v_mul_f32 v32, v32, v24
v_mfma_f32_16x16x32_bf16 v[44:47], a[116:119], v[212:215], v[44:47]
ds_read_b64_tr_b16 a[90:91], v118 offset:26624
v_mul_f32 v33, v33, v24
v_mfma_f32_16x16x32_bf16 v[44:47], a[120:123], v[228:231], v[44:47]
ds_read_b64_tr_b16 a[92:93], v118 offset:28672
v_mul_f32 v34, v34, v24
v_mfma_f32_16x16x32_bf16 v[44:47], a[124:127], v[244:247], v[44:47]
s_waitcnt lgkmcnt(8)
ds_read_b64_tr_b16 a[94:95], v118 offset:30720
v_mul_f32 v35, v35, v24
v_mfma_f32_16x16x32_bf16 v[48:51], a[64:67], v[128:131], 0
ds_read_b64_tr_b16 a[96:97], v119 offset:0
v_mul_f32 v40, v40, v24
v_mfma_f32_16x16x32_bf16 v[48:51], a[68:71], v[144:147], v[48:51]
ds_read_b64_tr_b16 a[98:99], v119 offset:2048
v_mul_f32 v41, v41, v24
v_mfma_f32_16x16x32_bf16 v[48:51], a[72:75], v[160:163], v[48:51]
s_waitcnt lgkmcnt(8)
ds_read_b64_tr_b16 a[100:101], v119 offset:4096
v_mul_f32 v42, v42, v24
v_mfma_f32_16x16x32_bf16 v[48:51], a[76:79], v[176:179], v[48:51]
ds_read_b64_tr_b16 a[102:103], v119 offset:6144
v_mul_f32 v43, v43, v24
v_mfma_f32_16x16x32_bf16 v[48:51], a[80:83], v[192:195], v[48:51]
s_waitcnt lgkmcnt(8)
ds_read_b64_tr_b16 a[104:105], v119 offset:8192
v_cvt_pk_bf16_f32 v32, v32, v33
v_mfma_f32_16x16x32_bf16 v[48:51], a[84:87], v[208:211], v[48:51]
s_waitcnt lgkmcnt(7)
ds_read_b64_tr_b16 a[106:107], v119 offset:10240
v_cvt_pk_bf16_f32 v33, v34, v35
v_mfma_f32_16x16x32_bf16 v[48:51], a[88:91], v[224:227], v[48:51]
s_waitcnt lgkmcnt(6)
ds_read_b64_tr_b16 a[108:109], v119 offset:12288
v_cvt_pk_bf16_f32 v34, v40, v41
v_mfma_f32_16x16x32_bf16 v[48:51], a[92:95], v[240:243], v[48:51]
ds_read_b64_tr_b16 a[110:111], v119 offset:14336
v_cvt_pk_bf16_f32 v35, v42, v43
v_mfma_f32_16x16x32_bf16 v[52:55], a[64:67], v[132:135], 0
buffer_store_dwordx4 v[32:35], v1, s[4:7], s8 offen offset:0 sc1
ds_read_b64_tr_b16 a[112:113], v119 offset:16384
v_mfma_f32_16x16x32_bf16 v[52:55], a[68:71], v[148:151], v[52:55]
ds_read_b64_tr_b16 a[114:115], v119 offset:18432
v_mul_f32 v36, v36, v25
v_mfma_f32_16x16x32_bf16 v[52:55], a[72:75], v[164:167], v[52:55]
ds_read_b64_tr_b16 a[116:117], v119 offset:20480
v_mul_f32 v37, v37, v25
v_mfma_f32_16x16x32_bf16 v[52:55], a[76:79], v[180:183], v[52:55]
ds_read_b64_tr_b16 a[118:119], v119 offset:22528
v_mul_f32 v38, v38, v25
v_mfma_f32_16x16x32_bf16 v[52:55], a[80:83], v[196:199], v[52:55]
ds_read_b64_tr_b16 a[120:121], v119 offset:24576
v_mul_f32 v39, v39, v25
v_mfma_f32_16x16x32_bf16 v[52:55], a[84:87], v[212:215], v[52:55]
ds_read_b64_tr_b16 a[122:123], v119 offset:26624
v_mul_f32 v44, v44, v25
v_mfma_f32_16x16x32_bf16 v[52:55], a[88:91], v[228:231], v[52:55]
ds_read_b64_tr_b16 a[124:125], v119 offset:28672
ds_read_b64_tr_b16 a[126:127], v119 offset:30720
v_mfma_f32_16x16x32_bf16 v[52:55], a[92:95], v[244:247], v[52:55]
s_waitcnt lgkmcnt(9)
v_mul_f32 v45, v45, v25
v_mul_f32 v46, v46, v25
v_mfma_f32_16x16x32_bf16 v[56:59], a[96:99], v[128:131], 0
v_mul_f32 v47, v47, v25
v_cvt_pk_bf16_f32 v36, v36, v37
v_mfma_f32_16x16x32_bf16 v[56:59], a[100:103], v[144:147], v[56:59]
v_cvt_pk_bf16_f32 v37, v38, v39
v_cvt_pk_bf16_f32 v38, v44, v45
v_mfma_f32_16x16x32_bf16 v[56:59], a[104:107], v[160:163], v[56:59]
s_waitcnt lgkmcnt(6)
v_cvt_pk_bf16_f32 v39, v46, v47
v_lshl_add_u32 v21, v22, 3, v21
v_mfma_f32_16x16x32_bf16 v[56:59], a[108:111], v[176:179], v[56:59]
buffer_store_dwordx4 v[36:39], v1, s[4:7], s12 offen offset:0 sc1
v_mfma_f32_16x16x32_bf16 v[56:59], a[112:115], v[192:195], v[56:59]
s_waitcnt lgkmcnt(4)
v_mfma_f32_16x16x32_bf16 v[56:59], a[116:119], v[208:211], v[56:59]
s_waitcnt lgkmcnt(2)
v_mfma_f32_16x16x32_bf16 v[56:59], a[120:123], v[224:227], v[56:59]
s_waitcnt lgkmcnt(0)
v_mfma_f32_16x16x32_bf16 v[56:59], a[124:127], v[240:243], v[56:59]
v_mfma_f32_16x16x32_bf16 v[60:63], a[96:99], v[132:135], 0
v_mfma_f32_16x16x32_bf16 v[60:63], a[100:103], v[148:151], v[60:63]
v_mfma_f32_16x16x32_bf16 v[60:63], a[104:107], v[164:167], v[60:63]
v_mfma_f32_16x16x32_bf16 v[60:63], a[108:111], v[180:183], v[60:63]
v_mfma_f32_16x16x32_bf16 v[60:63], a[112:115], v[196:199], v[60:63]
buffer_load_dword v18, v19, s[4:7], s33 offen offset:0 sc1
v_mfma_f32_16x16x32_bf16 v[60:63], a[116:119], v[212:215], v[60:63]
v_mfma_f32_16x16x32_bf16 v[60:63], a[120:123], v[228:231], v[60:63]
v_mfma_f32_16x16x32_bf16 v[60:63], a[124:127], v[244:247], v[60:63]
v_mul_f32 v48, v48, v24
v_mul_f32 v49, v49, v24
v_mul_f32 v50, v50, v24
v_mul_f32 v51, v51, v24
v_mul_f32 v56, v56, v24
v_mul_f32 v57, v57, v24
v_mul_f32 v58, v58, v24
v_mul_f32 v59, v59, v24
v_cvt_pk_bf16_f32 v48, v48, v49
v_cvt_pk_bf16_f32 v49, v50, v51
v_cvt_pk_bf16_f32 v50, v56, v57
v_cvt_pk_bf16_f32 v51, v58, v59
buffer_store_dwordx4 v[48:51], v1, s[4:7], s8 offen offset:1024 sc1
v_mul_f32 v52, v52, v25
v_mul_f32 v53, v53, v25
v_mul_f32 v54, v54, v25
v_mul_f32 v55, v55, v25
v_mul_f32 v60, v60, v25
v_mul_f32 v61, v61, v25
v_mul_f32 v62, v62, v25
v_mul_f32 v63, v63, v25
v_cvt_pk_bf16_f32 v52, v52, v53
v_cvt_pk_bf16_f32 v53, v54, v55
v_cvt_pk_bf16_f32 v54, v60, v61
v_cvt_pk_bf16_f32 v55, v62, v63
buffer_store_dwordx4 v[52:55], v1, s[4:7], s12 offen offset:1024 sc1
s_and_b32 s22, s2, 224
s_cmp_eq_u32 s22, 224
s_cbranch_scc1 M_final
s_waitcnt vmcnt(0)
s_barrier
buffer_store_dword v6, v5, s[4:7], s35 offen sc1
s_bitcmp0_b32 s2, 4
s_cbranch_scc1 M_rA
v_cmp_gt_u32 vcc, 1, v18
s_cbranch_vccnz M_rslow
M_rjoin:
buffer_load_dwordx4 v[128:131], v1, s[4:7], s26 offen sc1
s_add_u32 s26, s26, 14336
buffer_load_dwordx4 v[132:135], v1, s[4:7], s26 offen sc1
s_add_u32 s26, s26, 14336
buffer_load_dwordx4 v[136:139], v1, s[4:7], s26 offen sc1
s_add_u32 s26, s26, 14336
buffer_load_dwordx4 v[140:143], v1, s[4:7], s26 offen sc1
s_add_u32 s26, s26, 14336
buffer_load_dwordx4 v[144:147], v1, s[4:7], s26 offen sc1
s_add_u32 s26, s26, 14336
buffer_load_dwordx4 v[148:151], v1, s[4:7], s26 offen sc1
s_add_u32 s26, s26, 14336
buffer_load_dwordx4 v[152:155], v1, s[4:7], s26 offen sc1
s_add_u32 s26, s26, 14336
buffer_load_dwordx4 v[156:159], v1, s[4:7], s26 offen sc1
s_add_u32 s26, s26, 14336
buffer_load_dwordx4 v[160:163], v1, s[4:7], s26 offen sc1
s_add_u32 s26, s26, 14336
buffer_load_dwordx4 v[164:167], v1, s[4:7], s26 offen sc1
s_add_u32 s26, s26, 14336
buffer_load_dwordx4 v[168:171], v1, s[4:7], s26 offen sc1
s_add_u32 s26, s26, 14336
buffer_load_dwordx4 v[172:175], v1, s[4:7], s26 offen sc1
s_add_u32 s26, s26, 14336
buffer_load_dwordx4 v[176:179], v1, s[4:7], s26 offen sc1
s_add_u32 s26, s26, 14336
buffer_load_dwordx4 v[180:183], v1, s[4:7], s26 offen sc1
s_add_u32 s26, s26, 14336
buffer_load_dwordx4 v[184:187], v1, s[4:7], s26 offen sc1
s_add_u32 s26, s26, 14336
buffer_load_dwordx4 v[188:191], v1, s[4:7], s26 offen sc1
Lp_9201:
buffer_load_dword v18, v19, s[4:7], s33 offen offset:2048 sc1
s_waitcnt vmcnt(0)
v_cmp_gt_u32 vcc, 1, v18
s_cbranch_vccz Lpd_9202
s_sleep 8
s_sub_u32 s101, s101, 1
s_cbranch_scc0 Lp_9201
s_mov_b32 s101, 0
Lpd_9202:
s_sub_u32 s26, s26, 207872
buffer_load_dwordx4 v[192:195], v1, s[4:7], s26 offen sc1
s_add_u32 s26, s26, 14336
buffer_load_dwordx4 v[196:199], v1, s[4:7], s26 offen sc1
s_add_u32 s26, s26, 14336
buffer_load_dwordx4 v[200:203], v1, s[4:7], s26 offen sc1
s_add_u32 s26, s26, 14336
buffer_load_dwordx4 v[204:207], v1, s[4:7], s26 offen sc1
s_add_u32 s26, s26, 14336
buffer_load_dwordx4 v[208:211], v1, s[4:7], s26 offen sc1
s_add_u32 s26, s26, 14336
buffer_load_dwordx4 v[212:215], v1, s[4:7], s26 offen sc1
s_add_u32 s26, s26, 14336
buffer_load_dwordx4 v[216:219], v1, s[4:7], s26 offen sc1
s_add_u32 s26, s26, 14336
buffer_load_dwordx4 v[220:223], v1, s[4:7], s26 offen sc1
s_add_u32 s26, s26, 14336
buffer_load_dwordx4 v[224:227], v1, s[4:7], s26 offen sc1
s_add_u32 s26, s26, 14336
buffer_load_dwordx4 v[228:231], v1, s[4:7], s26 offen sc1
s_add_u32 s26, s26, 14336
buffer_load_dwordx4 v[232:235], v1, s[4:7], s26 offen sc1
s_add_u32 s26, s26, 14336
buffer_load_dwordx4 v[236:239], v1, s[4:7], s26 offen sc1
s_add_u32 s26, s26, 14336
buffer_load_dwordx4 v[240:243], v1, s[4:7], s26 offen sc1
s_add_u32 s26, s26, 14336
buffer_load_dwordx4 v[244:247], v1, s[4:7], s26 offen sc1
s_add_u32 s26, s26, 14336
buffer_load_dwordx4 v[248:251], v1, s[4:7], s26 offen sc1
s_add_u32 s26, s26, 14336
buffer_load_dwordx4 v[252:255], v1, s[4:7], s26 offen sc1
v_lshlrev_b32 v96, 16, v128
v_and_b32 v97, 0xffff0000, v128
v_lshlrev_b32 v98, 16, v129
v_and_b32 v99, 0xffff0000, v129
v_lshlrev_b32 v100, 16, v130
v_and_b32 v101, 0xffff0000, v130
v_lshlrev_b32 v102, 16, v131
v_and_b32 v103, 0xffff0000, v131
v_lshlrev_b32 v10, 16, v132
v_and_b32 v11, 0xffff0000, v132
v_lshlrev_b32 v12, 16, v133
v_and_b32 v13, 0xffff0000, v133
v_lshlrev_b32 v14, 16, v134
v_and_b32 v15, 0xffff0000, v134
v_lshlrev_b32 v16, 16, v135
v_and_b32 v17, 0xffff0000, v135
v_pk_add_f32 v[96:97], v[96:97], v[10:11]
v_pk_add_f32 v[98:99], v[98:99], v[12:13]
v_pk_add_f32 v[100:101], v[100:101], v[14:15]
v_pk_add_f32 v[102:103], v[102:103], v[16:17]
v_lshlrev_b32 v10, 16, v136
v_and_b32 v11, 0xffff0000, v136
v_lshlrev_b32 v12, 16, v137
v_and_b32 v13, 0xffff0000, v137
v_lshlrev_b32 v14, 16, v138
v_and_b32 v15, 0xffff0000, v138
v_lshlrev_b32 v16, 16, v139
v_and_b32 v17, 0xffff0000, v139
v_pk_add_f32 v[96:97], v[96:97], v[10:11]
v_pk_add_f32 v[98:99], v[98:99], v[12:13]
v_pk_add_f32 v[100:101], v[100:101], v[14:15]
v_pk_add_f32 v[102:103], v[102:103], v[16:17]
v_lshlrev_b32 v10, 16, v140
v_and_b32 v11, 0xffff0000, v140
v_lshlrev_b32 v12, 16, v141
v_and_b32 v13, 0xffff0000, v141
v_lshlrev_b32 v14, 16, v142
v_and_b32 v15, 0xffff0000, v142
v_lshlrev_b32 v16, 16, v143
v_and_b32 v17, 0xffff0000, v143
v_pk_add_f32 v[96:97], v[96:97], v[10:11]
v_pk_add_f32 v[98:99], v[98:99], v[12:13]
v_pk_add_f32 v[100:101], v[100:101], v[14:15]
v_pk_add_f32 v[102:103], v[102:103], v[16:17]
v_lshlrev_b32 v10, 16, v144
v_and_b32 v11, 0xffff0000, v144
v_lshlrev_b32 v12, 16, v145
v_and_b32 v13, 0xffff0000, v145
v_lshlrev_b32 v14, 16, v146
v_and_b32 v15, 0xffff0000, v146
v_lshlrev_b32 v16, 16, v147
v_and_b32 v17, 0xffff0000, v147
v_pk_add_f32 v[96:97], v[96:97], v[10:11]
v_pk_add_f32 v[98:99], v[98:99], v[12:13]
v_pk_add_f32 v[100:101], v[100:101], v[14:15]
v_pk_add_f32 v[102:103], v[102:103], v[16:17]
v_lshlrev_b32 v10, 16, v148
v_and_b32 v11, 0xffff0000, v148
v_lshlrev_b32 v12, 16, v149
v_and_b32 v13, 0xffff0000, v149
v_lshlrev_b32 v14, 16, v150
v_and_b32 v15, 0xffff0000, v150
v_lshlrev_b32 v16, 16, v151
v_and_b32 v17, 0xffff0000, v151
v_pk_add_f32 v[96:97], v[96:97], v[10:11]
v_pk_add_f32 v[98:99], v[98:99], v[12:13]
v_pk_add_f32 v[100:101], v[100:101], v[14:15]
v_pk_add_f32 v[102:103], v[102:103], v[16:17]
v_lshlrev_b32 v10, 16, v152
v_and_b32 v11, 0xffff0000, v152
v_lshlrev_b32 v12, 16, v153
v_and_b32 v13, 0xffff0000, v153
v_lshlrev_b32 v14, 16, v154
v_and_b32 v15, 0xffff0000, v154
v_lshlrev_b32 v16, 16, v155
v_and_b32 v17, 0xffff0000, v155
v_pk_add_f32 v[96:97], v[96:97], v[10:11]
v_pk_add_f32 v[98:99], v[98:99], v[12:13]
v_pk_add_f32 v[100:101], v[100:101], v[14:15]
v_pk_add_f32 v[102:103], v[102:103], v[16:17]
v_lshlrev_b32 v10, 16, v156
v_and_b32 v11, 0xffff0000, v156
v_lshlrev_b32 v12, 16, v157
v_and_b32 v13, 0xffff0000, v157
v_lshlrev_b32 v14, 16, v158
v_and_b32 v15, 0xffff0000, v158
v_lshlrev_b32 v16, 16, v159
v_and_b32 v17, 0xffff0000, v159
v_pk_add_f32 v[96:97], v[96:97], v[10:11]
v_pk_add_f32 v[98:99], v[98:99], v[12:13]
v_pk_add_f32 v[100:101], v[100:101], v[14:15]
v_pk_add_f32 v[102:103], v[102:103], v[16:17]
v_lshlrev_b32 v10, 16, v160
v_and_b32 v11, 0xffff0000, v160
v_lshlrev_b32 v12, 16, v161
v_and_b32 v13, 0xffff0000, v161
v_lshlrev_b32 v14, 16, v162
v_and_b32 v15, 0xffff0000, v162
v_lshlrev_b32 v16, 16, v163
v_and_b32 v17, 0xffff0000, v163
v_pk_add_f32 v[96:97], v[96:97], v[10:11]
v_pk_add_f32 v[98:99], v[98:99], v[12:13]
v_pk_add_f32 v[100:101], v[100:101], v[14:15]
v_pk_add_f32 v[102:103], v[102:103], v[16:17]
v_lshlrev_b32 v10, 16, v164
v_and_b32 v11, 0xffff0000, v164
v_lshlrev_b32 v12, 16, v165
v_and_b32 v13, 0xffff0000, v165
v_lshlrev_b32 v14, 16, v166
v_and_b32 v15, 0xffff0000, v166
v_lshlrev_b32 v16, 16, v167
v_and_b32 v17, 0xffff0000, v167
v_pk_add_f32 v[96:97], v[96:97], v[10:11]
v_pk_add_f32 v[98:99], v[98:99], v[12:13]
v_pk_add_f32 v[100:101], v[100:101], v[14:15]
v_pk_add_f32 v[102:103], v[102:103], v[16:17]
v_lshlrev_b32 v10, 16, v168
v_and_b32 v11, 0xffff0000, v168
v_lshlrev_b32 v12, 16, v169
v_and_b32 v13, 0xffff0000, v169
v_lshlrev_b32 v14, 16, v170
v_and_b32 v15, 0xffff0000, v170
v_lshlrev_b32 v16, 16, v171
v_and_b32 v17, 0xffff0000, v171
v_pk_add_f32 v[96:97], v[96:97], v[10:11]
v_pk_add_f32 v[98:99], v[98:99], v[12:13]
v_pk_add_f32 v[100:101], v[100:101], v[14:15]
v_pk_add_f32 v[102:103], v[102:103], v[16:17]
v_lshlrev_b32 v10, 16, v172
v_and_b32 v11, 0xffff0000, v172
v_lshlrev_b32 v12, 16, v173
v_and_b32 v13, 0xffff0000, v173
v_lshlrev_b32 v14, 16, v174
v_and_b32 v15, 0xffff0000, v174
v_lshlrev_b32 v16, 16, v175
v_and_b32 v17, 0xffff0000, v175
v_pk_add_f32 v[96:97], v[96:97], v[10:11]
v_pk_add_f32 v[98:99], v[98:99], v[12:13]
v_pk_add_f32 v[100:101], v[100:101], v[14:15]
v_pk_add_f32 v[102:103], v[102:103], v[16:17]
v_lshlrev_b32 v10, 16, v176
v_and_b32 v11, 0xffff0000, v176
v_lshlrev_b32 v12, 16, v177
v_and_b32 v13, 0xffff0000, v177
v_lshlrev_b32 v14, 16, v178
v_and_b32 v15, 0xffff0000, v178
v_lshlrev_b32 v16, 16, v179
v_and_b32 v17, 0xffff0000, v179
v_pk_add_f32 v[96:97], v[96:97], v[10:11]
v_pk_add_f32 v[98:99], v[98:99], v[12:13]
v_pk_add_f32 v[100:101], v[100:101], v[14:15]
v_pk_add_f32 v[102:103], v[102:103], v[16:17]
v_lshlrev_b32 v10, 16, v180
v_and_b32 v11, 0xffff0000, v180
v_lshlrev_b32 v12, 16, v181
v_and_b32 v13, 0xffff0000, v181
v_lshlrev_b32 v14, 16, v182
v_and_b32 v15, 0xffff0000, v182
v_lshlrev_b32 v16, 16, v183
v_and_b32 v17, 0xffff0000, v183
v_pk_add_f32 v[96:97], v[96:97], v[10:11]
v_pk_add_f32 v[98:99], v[98:99], v[12:13]
v_pk_add_f32 v[100:101], v[100:101], v[14:15]
v_pk_add_f32 v[102:103], v[102:103], v[16:17]
v_lshlrev_b32 v10, 16, v184
v_and_b32 v11, 0xffff0000, v184
v_lshlrev_b32 v12, 16, v185
v_and_b32 v13, 0xffff0000, v185
v_lshlrev_b32 v14, 16, v186
v_and_b32 v15, 0xffff0000, v186
v_lshlrev_b32 v16, 16, v187
v_and_b32 v17, 0xffff0000, v187
v_pk_add_f32 v[96:97], v[96:97], v[10:11]
v_pk_add_f32 v[98:99], v[98:99], v[12:13]
v_pk_add_f32 v[100:101], v[100:101], v[14:15]
v_pk_add_f32 v[102:103], v[102:103], v[16:17]
v_lshlrev_b32 v10, 16, v188
v_and_b32 v11, 0xffff0000, v188
v_lshlrev_b32 v12, 16, v189
v_and_b32 v13, 0xffff0000, v189
v_lshlrev_b32 v14, 16, v190
v_and_b32 v15, 0xffff0000, v190
v_lshlrev_b32 v16, 16, v191
v_and_b32 v17, 0xffff0000, v191
v_pk_add_f32 v[96:97], v[96:97], v[10:11]
v_pk_add_f32 v[98:99], v[98:99], v[12:13]
v_pk_add_f32 v[100:101], v[100:101], v[14:15]
v_pk_add_f32 v[102:103], v[102:103], v[16:17]
v_cvt_pk_bf16_f32 v96, v96, v97
v_cvt_pk_bf16_f32 v97, v98, v99
v_cvt_pk_bf16_f32 v98, v100, v101
v_cvt_pk_bf16_f32 v99, v102, v103
buffer_store_dwordx2 v[96:97], v21, s[40:43], s25 offen offset:896
buffer_store_dwordx2 v[98:99], v21, s[40:43], s25 offen offset:928
s_waitcnt vmcnt(17)
v_lshlrev_b32 v104, 16, v192
v_and_b32 v105, 0xffff0000, v192
v_lshlrev_b32 v106, 16, v193
v_and_b32 v107, 0xffff0000, v193
v_lshlrev_b32 v108, 16, v194
v_and_b32 v109, 0xffff0000, v194
v_lshlrev_b32 v110, 16, v195
v_and_b32 v111, 0xffff0000, v195
s_waitcnt vmcnt(16)
v_lshlrev_b32 v10, 16, v196
v_and_b32 v11, 0xffff0000, v196
v_lshlrev_b32 v12, 16, v197
v_and_b32 v13, 0xffff0000, v197
v_lshlrev_b32 v14, 16, v198
v_and_b32 v15, 0xffff0000, v198
v_lshlrev_b32 v16, 16, v199
v_and_b32 v17, 0xffff0000, v199
v_pk_add_f32 v[104:105], v[104:105], v[10:11]
v_pk_add_f32 v[106:107], v[106:107], v[12:13]
v_pk_add_f32 v[108:109], v[108:109], v[14:15]
v_pk_add_f32 v[110:111], v[110:111], v[16:17]
s_waitcnt vmcnt(15)
v_lshlrev_b32 v10, 16, v200
v_and_b32 v11, 0xffff0000, v200
PAD_17:
s_cbranch_execz M_tret
v_lshlrev_b32 v12, 16, v201
v_and_b32 v13, 0xffff0000, v201
v_lshlrev_b32 v14, 16, v202
v_and_b32 v15, 0xffff0000, v202
v_lshlrev_b32 v16, 16, v203
v_and_b32 v17, 0xffff0000, v203
v_pk_add_f32 v[104:105], v[104:105], v[10:11]
v_pk_add_f32 v[106:107], v[106:107], v[12:13]
v_pk_add_f32 v[108:109], v[108:109], v[14:15]
v_pk_add_f32 v[110:111], v[110:111], v[16:17]
s_waitcnt vmcnt(14)
v_lshlrev_b32 v10, 16, v204
v_and_b32 v11, 0xffff0000, v204
v_lshlrev_b32 v12, 16, v205
v_and_b32 v13, 0xffff0000, v205
v_lshlrev_b32 v14, 16, v206
v_and_b32 v15, 0xffff0000, v206
v_lshlrev_b32 v16, 16, v207
v_and_b32 v17, 0xffff0000, v207
v_pk_add_f32 v[104:105], v[104:105], v[10:11]
v_pk_add_f32 v[106:107], v[106:107], v[12:13]
v_pk_add_f32 v[108:109], v[108:109], v[14:15]
v_pk_add_f32 v[110:111], v[110:111], v[16:17]
s_waitcnt vmcnt(13)
v_lshlrev_b32 v10, 16, v208
v_and_b32 v11, 0xffff0000, v208
v_lshlrev_b32 v12, 16, v209
v_and_b32 v13, 0xffff0000, v209
v_lshlrev_b32 v14, 16, v210
v_and_b32 v15, 0xffff0000, v210
v_lshlrev_b32 v16, 16, v211
v_and_b32 v17, 0xffff0000, v211
v_pk_add_f32 v[104:105], v[104:105], v[10:11]
v_pk_add_f32 v[106:107], v[106:107], v[12:13]
v_pk_add_f32 v[108:109], v[108:109], v[14:15]
v_pk_add_f32 v[110:111], v[110:111], v[16:17]
s_waitcnt vmcnt(12)
v_lshlrev_b32 v10, 16, v212
v_and_b32 v11, 0xffff0000, v212
v_lshlrev_b32 v12, 16, v213
v_and_b32 v13, 0xffff0000, v213
v_lshlrev_b32 v14, 16, v214
v_and_b32 v15, 0xffff0000, v214
v_lshlrev_b32 v16, 16, v215
v_and_b32 v17, 0xffff0000, v215
v_pk_add_f32 v[104:105], v[104:105], v[10:11]
v_pk_add_f32 v[106:107], v[106:107], v[12:13]
v_pk_add_f32 v[108:109], v[108:109], v[14:15]
v_pk_add_f32 v[110:111], v[110:111], v[16:17]
s_waitcnt vmcnt(11)
v_lshlrev_b32 v10, 16, v216
v_and_b32 v11, 0xffff0000, v216
v_lshlrev_b32 v12, 16, v217
v_and_b32 v13, 0xffff0000, v217
v_lshlrev_b32 v14, 16, v218
v_and_b32 v15, 0xffff0000, v218
v_lshlrev_b32 v16, 16, v219
v_and_b32 v17, 0xffff0000, v219
v_pk_add_f32 v[104:105], v[104:105], v[10:11]
v_pk_add_f32 v[106:107], v[106:107], v[12:13]
v_pk_add_f32 v[108:109], v[108:109], v[14:15]
v_pk_add_f32 v[110:111], v[110:111], v[16:17]
s_waitcnt vmcnt(10)
v_lshlrev_b32 v10, 16, v220
v_and_b32 v11, 0xffff0000, v220
v_lshlrev_b32 v12, 16, v221
v_and_b32 v13, 0xffff0000, v221
v_lshlrev_b32 v14, 16, v222
v_and_b32 v15, 0xffff0000, v222
v_lshlrev_b32 v16, 16, v223
v_and_b32 v17, 0xffff0000, v223
v_pk_add_f32 v[104:105], v[104:105], v[10:11]
v_pk_add_f32 v[106:107], v[106:107], v[12:13]
v_pk_add_f32 v[108:109], v[108:109], v[14:15]
v_pk_add_f32 v[110:111], v[110:111], v[16:17]
s_waitcnt vmcnt(9)
v_lshlrev_b32 v10, 16, v224
v_and_b32 v11, 0xffff0000, v224
v_lshlrev_b32 v12, 16, v225
v_and_b32 v13, 0xffff0000, v225
v_lshlrev_b32 v14, 16, v226
v_and_b32 v15, 0xffff0000, v226
v_lshlrev_b32 v16, 16, v227
v_and_b32 v17, 0xffff0000, v227
v_pk_add_f32 v[104:105], v[104:105], v[10:11]
v_pk_add_f32 v[106:107], v[106:107], v[12:13]
v_pk_add_f32 v[108:109], v[108:109], v[14:15]
v_pk_add_f32 v[110:111], v[110:111], v[16:17]
s_waitcnt vmcnt(8)
v_lshlrev_b32 v10, 16, v228
v_and_b32 v11, 0xffff0000, v228
v_lshlrev_b32 v12, 16, v229
v_and_b32 v13, 0xffff0000, v229
v_lshlrev_b32 v14, 16, v230
v_and_b32 v15, 0xffff0000, v230
v_lshlrev_b32 v16, 16, v231
v_and_b32 v17, 0xffff0000, v231
v_pk_add_f32 v[104:105], v[104:105], v[10:11]
v_pk_add_f32 v[106:107], v[106:107], v[12:13]
v_pk_add_f32 v[108:109], v[108:109], v[14:15]
v_pk_add_f32 v[110:111], v[110:111], v[16:17]
s_waitcnt vmcnt(7)
v_lshlrev_b32 v10, 16, v232
v_and_b32 v11, 0xffff0000, v232
v_lshlrev_b32 v12, 16, v233
v_and_b32 v13, 0xffff0000, v233
v_lshlrev_b32 v14, 16, v234
v_and_b32 v15, 0xffff0000, v234
v_lshlrev_b32 v16, 16, v235
v_and_b32 v17, 0xffff0000, v235
v_pk_add_f32 v[104:105], v[104:105], v[10:11]
v_pk_add_f32 v[106:107], v[106:107], v[12:13]
v_pk_add_f32 v[108:109], v[108:109], v[14:15]
v_pk_add_f32 v[110:111], v[110:111], v[16:17]
s_waitcnt vmcnt(6)
v_lshlrev_b32 v10, 16, v236
v_and_b32 v11, 0xffff0000, v236
v_lshlrev_b32 v12, 16, v237
v_and_b32 v13, 0xffff0000, v237
v_lshlrev_b32 v14, 16, v238
v_and_b32 v15, 0xffff0000, v238
v_lshlrev_b32 v16, 16, v239
v_and_b32 v17, 0xffff0000, v239
v_pk_add_f32 v[104:105], v[104:105], v[10:11]
v_pk_add_f32 v[106:107], v[106:107], v[12:13]
v_pk_add_f32 v[108:109], v[108:109], v[14:15]
v_pk_add_f32 v[110:111], v[110:111], v[16:17]
s_waitcnt vmcnt(5)
v_lshlrev_b32 v10, 16, v240
v_and_b32 v11, 0xffff0000, v240
v_lshlrev_b32 v12, 16, v241
v_and_b32 v13, 0xffff0000, v241
v_lshlrev_b32 v14, 16, v242
v_and_b32 v15, 0xffff0000, v242
v_lshlrev_b32 v16, 16, v243
v_and_b32 v17, 0xffff0000, v243
v_pk_add_f32 v[104:105], v[104:105], v[10:11]
v_pk_add_f32 v[106:107], v[106:107], v[12:13]
v_pk_add_f32 v[108:109], v[108:109], v[14:15]
v_pk_add_f32 v[110:111], v[110:111], v[16:17]
s_waitcnt vmcnt(4)
v_lshlrev_b32 v10, 16, v244
v_and_b32 v11, 0xffff0000, v244
v_lshlrev_b32 v12, 16, v245
v_and_b32 v13, 0xffff0000, v245
v_lshlrev_b32 v14, 16, v246
v_and_b32 v15, 0xffff0000, v246
v_lshlrev_b32 v16, 16, v247
v_and_b32 v17, 0xffff0000, v247
v_pk_add_f32 v[104:105], v[104:105], v[10:11]
v_pk_add_f32 v[106:107], v[106:107], v[12:13]
v_pk_add_f32 v[108:109], v[108:109], v[14:15]
v_pk_add_f32 v[110:111], v[110:111], v[16:17]
s_waitcnt vmcnt(3)
v_lshlrev_b32 v10, 16, v248
v_and_b32 v11, 0xffff0000, v248
v_lshlrev_b32 v12, 16, v249
v_and_b32 v13, 0xffff0000, v249
v_lshlrev_b32 v14, 16, v250
v_and_b32 v15, 0xffff0000, v250
v_lshlrev_b32 v16, 16, v251
v_and_b32 v17, 0xffff0000, v251
v_pk_add_f32 v[104:105], v[104:105], v[10:11]
v_pk_add_f32 v[106:107], v[106:107], v[12:13]
v_pk_add_f32 v[108:109], v[108:109], v[14:15]
v_pk_add_f32 v[110:111], v[110:111], v[16:17]
s_waitcnt vmcnt(2)
v_lshlrev_b32 v10, 16, v252
v_and_b32 v11, 0xffff0000, v252
v_lshlrev_b32 v12, 16, v253
v_and_b32 v13, 0xffff0000, v253
v_lshlrev_b32 v14, 16, v254
v_and_b32 v15, 0xffff0000, v254
v_lshlrev_b32 v16, 16, v255
v_and_b32 v17, 0xffff0000, v255
v_pk_add_f32 v[104:105], v[104:105], v[10:11]
v_pk_add_f32 v[106:107], v[106:107], v[12:13]
v_pk_add_f32 v[108:109], v[108:109], v[14:15]
v_pk_add_f32 v[110:111], v[110:111], v[16:17]
v_cvt_pk_bf16_f32 v104, v104, v105
v_cvt_pk_bf16_f32 v105, v106, v107
v_cvt_pk_bf16_f32 v106, v108, v109
v_cvt_pk_bf16_f32 v107, v110, v111
buffer_store_dwordx2 v[104:105], v21, s[40:43], s25 offen offset:1344
buffer_store_dwordx2 v[106:107], v21, s[40:43], s25 offen offset:1376
s_add_u32 s25, s25, 1835008
s_add_u32 s26, s26, 14457856
s_add_u32 s33, s33, 1024
s_branch M_r1
PAD_18:
s_cbranch_execz M_tret
M_rA:
s_add_u32 s25, s25, 448
s_add_u32 s26, s26, 7168
s_add_u32 s33, s33, 2048
M_r1:
Lp_9203:
buffer_load_dword v18, v19, s[4:7], s33 offen offset:0 sc1
s_waitcnt vmcnt(0)
v_cmp_gt_u32 vcc, 1, v18
s_cbranch_vccz Lpd_9204
s_sleep 8
s_sub_u32 s101, s101, 1
s_cbranch_scc0 Lp_9203
s_mov_b32 s101, 0
Lpd_9204:
buffer_load_dwordx4 v[128:131], v1, s[4:7], s26 offen sc1
s_add_u32 s26, s26, 14336
buffer_load_dwordx4 v[132:135], v1, s[4:7], s26 offen sc1
s_add_u32 s26, s26, 14336
buffer_load_dwordx4 v[136:139], v1, s[4:7], s26 offen sc1
s_add_u32 s26, s26, 14336
buffer_load_dwordx4 v[140:143], v1, s[4:7], s26 offen sc1
s_add_u32 s26, s26, 14336
buffer_load_dwordx4 v[144:147], v1, s[4:7], s26 offen sc1
s_add_u32 s26, s26, 14336
buffer_load_dwordx4 v[148:151], v1, s[4:7], s26 offen sc1
s_add_u32 s26, s26, 14336
buffer_load_dwordx4 v[152:155], v1, s[4:7], s26 offen sc1
s_add_u32 s26, s26, 14336
buffer_load_dwordx4 v[156:159], v1, s[4:7], s26 offen sc1
s_add_u32 s26, s26, 14336
buffer_load_dwordx4 v[160:163], v1, s[4:7], s26 offen sc1
s_add_u32 s26, s26, 14336
buffer_load_dwordx4 v[164:167], v1, s[4:7], s26 offen sc1
s_add_u32 s26, s26, 14336
buffer_load_dwordx4 v[168:171], v1, s[4:7], s26 offen sc1
s_add_u32 s26, s26, 14336
buffer_load_dwordx4 v[172:175], v1, s[4:7], s26 offen sc1
s_add_u32 s26, s26, 14336
buffer_load_dwordx4 v[176:179], v1, s[4:7], s26 offen sc1
s_add_u32 s26, s26, 14336
buffer_load_dwordx4 v[180:183], v1, s[4:7], s26 offen sc1
s_add_u32 s26, s26, 14336
buffer_load_dwordx4 v[184:187], v1, s[4:7], s26 offen sc1
s_add_u32 s26, s26, 14336
buffer_load_dwordx4 v[188:191], v1, s[4:7], s26 offen sc1
s_waitcnt vmcnt(15)
v_lshlrev_b32 v96, 16, v128
v_and_b32 v97, 0xffff0000, v128
v_lshlrev_b32 v98, 16, v129
v_and_b32 v99, 0xffff0000, v129
v_lshlrev_b32 v100, 16, v130
v_and_b32 v101, 0xffff0000, v130
v_lshlrev_b32 v102, 16, v131
v_and_b32 v103, 0xffff0000, v131
s_waitcnt vmcnt(14)
v_lshlrev_b32 v10, 16, v132
v_and_b32 v11, 0xffff0000, v132
v_lshlrev_b32 v12, 16, v133
v_and_b32 v13, 0xffff0000, v133
v_lshlrev_b32 v14, 16, v134
v_and_b32 v15, 0xffff0000, v134
v_lshlrev_b32 v16, 16, v135
v_and_b32 v17, 0xffff0000, v135
v_pk_add_f32 v[96:97], v[96:97], v[10:11]
v_pk_add_f32 v[98:99], v[98:99], v[12:13]
v_pk_add_f32 v[100:101], v[100:101], v[14:15]
v_pk_add_f32 v[102:103], v[102:103], v[16:17]
s_waitcnt vmcnt(13)
v_lshlrev_b32 v10, 16, v136
v_and_b32 v11, 0xffff0000, v136
v_lshlrev_b32 v12, 16, v137
v_and_b32 v13, 0xffff0000, v137
v_lshlrev_b32 v14, 16, v138
v_and_b32 v15, 0xffff0000, v138
v_lshlrev_b32 v16, 16, v139
v_and_b32 v17, 0xffff0000, v139
v_pk_add_f32 v[96:97], v[96:97], v[10:11]
v_pk_add_f32 v[98:99], v[98:99], v[12:13]
v_pk_add_f32 v[100:101], v[100:101], v[14:15]
v_pk_add_f32 v[102:103], v[102:103], v[16:17]
s_waitcnt vmcnt(12)
v_lshlrev_b32 v10, 16, v140
v_and_b32 v11, 0xffff0000, v140
v_lshlrev_b32 v12, 16, v141
v_and_b32 v13, 0xffff0000, v141
v_lshlrev_b32 v14, 16, v142
v_and_b32 v15, 0xffff0000, v142
v_lshlrev_b32 v16, 16, v143
v_and_b32 v17, 0xffff0000, v143
v_pk_add_f32 v[96:97], v[96:97], v[10:11]
v_pk_add_f32 v[98:99], v[98:99], v[12:13]
v_pk_add_f32 v[100:101], v[100:101], v[14:15]
v_pk_add_f32 v[102:103], v[102:103], v[16:17]
s_waitcnt vmcnt(11)
v_lshlrev_b32 v10, 16, v144
v_and_b32 v11, 0xffff0000, v144
v_lshlrev_b32 v12, 16, v145
v_and_b32 v13, 0xffff0000, v145
v_lshlrev_b32 v14, 16, v146
v_and_b32 v15, 0xffff0000, v146
v_lshlrev_b32 v16, 16, v147
v_and_b32 v17, 0xffff0000, v147
v_pk_add_f32 v[96:97], v[96:97], v[10:11]
v_pk_add_f32 v[98:99], v[98:99], v[12:13]
v_pk_add_f32 v[100:101], v[100:101], v[14:15]
v_pk_add_f32 v[102:103], v[102:103], v[16:17]
s_waitcnt vmcnt(10)
v_lshlrev_b32 v10, 16, v148
v_and_b32 v11, 0xffff0000, v148
v_lshlrev_b32 v12, 16, v149
v_and_b32 v13, 0xffff0000, v149
v_lshlrev_b32 v14, 16, v150
v_and_b32 v15, 0xffff0000, v150
v_lshlrev_b32 v16, 16, v151
v_and_b32 v17, 0xffff0000, v151
v_pk_add_f32 v[96:97], v[96:97], v[10:11]
v_pk_add_f32 v[98:99], v[98:99], v[12:13]
v_pk_add_f32 v[100:101], v[100:101], v[14:15]
v_pk_add_f32 v[102:103], v[102:103], v[16:17]
s_waitcnt vmcnt(9)
v_lshlrev_b32 v10, 16, v152
v_and_b32 v11, 0xffff0000, v152
v_lshlrev_b32 v12, 16, v153
v_and_b32 v13, 0xffff0000, v153
v_lshlrev_b32 v14, 16, v154
v_and_b32 v15, 0xffff0000, v154
v_lshlrev_b32 v16, 16, v155
v_and_b32 v17, 0xffff0000, v155
v_pk_add_f32 v[96:97], v[96:97], v[10:11]
v_pk_add_f32 v[98:99], v[98:99], v[12:13]
v_pk_add_f32 v[100:101], v[100:101], v[14:15]
v_pk_add_f32 v[102:103], v[102:103], v[16:17]
s_waitcnt vmcnt(8)
v_lshlrev_b32 v10, 16, v156
v_and_b32 v11, 0xffff0000, v156
v_lshlrev_b32 v12, 16, v157
v_and_b32 v13, 0xffff0000, v157
v_lshlrev_b32 v14, 16, v158
v_and_b32 v15, 0xffff0000, v158
v_lshlrev_b32 v16, 16, v159
v_and_b32 v17, 0xffff0000, v159
v_pk_add_f32 v[96:97], v[96:97], v[10:11]
v_pk_add_f32 v[98:99], v[98:99], v[12:13]
v_pk_add_f32 v[100:101], v[100:101], v[14:15]
v_pk_add_f32 v[102:103], v[102:103], v[16:17]
s_waitcnt vmcnt(7)
v_lshlrev_b32 v10, 16, v160
v_and_b32 v11, 0xffff0000, v160
v_lshlrev_b32 v12, 16, v161
v_and_b32 v13, 0xffff0000, v161
v_lshlrev_b32 v14, 16, v162
v_and_b32 v15, 0xffff0000, v162
v_lshlrev_b32 v16, 16, v163
v_and_b32 v17, 0xffff0000, v163
v_pk_add_f32 v[96:97], v[96:97], v[10:11]
v_pk_add_f32 v[98:99], v[98:99], v[12:13]
v_pk_add_f32 v[100:101], v[100:101], v[14:15]
v_pk_add_f32 v[102:103], v[102:103], v[16:17]
s_waitcnt vmcnt(6)
v_lshlrev_b32 v10, 16, v164
v_and_b32 v11, 0xffff0000, v164
v_lshlrev_b32 v12, 16, v165
v_and_b32 v13, 0xffff0000, v165
v_lshlrev_b32 v14, 16, v166
v_and_b32 v15, 0xffff0000, v166
v_lshlrev_b32 v16, 16, v167
v_and_b32 v17, 0xffff0000, v167
v_pk_add_f32 v[96:97], v[96:97], v[10:11]
v_pk_add_f32 v[98:99], v[98:99], v[12:13]
v_pk_add_f32 v[100:101], v[100:101], v[14:15]
v_pk_add_f32 v[102:103], v[102:103], v[16:17]
s_waitcnt vmcnt(5)
v_lshlrev_b32 v10, 16, v168
v_and_b32 v11, 0xffff0000, v168
v_lshlrev_b32 v12, 16, v169
v_and_b32 v13, 0xffff0000, v169
v_lshlrev_b32 v14, 16, v170
v_and_b32 v15, 0xffff0000, v170
v_lshlrev_b32 v16, 16, v171
v_and_b32 v17, 0xffff0000, v171
v_pk_add_f32 v[96:97], v[96:97], v[10:11]
v_pk_add_f32 v[98:99], v[98:99], v[12:13]
v_pk_add_f32 v[100:101], v[100:101], v[14:15]
v_pk_add_f32 v[102:103], v[102:103], v[16:17]
s_waitcnt vmcnt(4)
v_lshlrev_b32 v10, 16, v172
v_and_b32 v11, 0xffff0000, v172
v_lshlrev_b32 v12, 16, v173
v_and_b32 v13, 0xffff0000, v173
v_lshlrev_b32 v14, 16, v174
v_and_b32 v15, 0xffff0000, v174
v_lshlrev_b32 v16, 16, v175
v_and_b32 v17, 0xffff0000, v175
v_pk_add_f32 v[96:97], v[96:97], v[10:11]
v_pk_add_f32 v[98:99], v[98:99], v[12:13]
v_pk_add_f32 v[100:101], v[100:101], v[14:15]
v_pk_add_f32 v[102:103], v[102:103], v[16:17]
s_waitcnt vmcnt(3)
v_lshlrev_b32 v10, 16, v176
v_and_b32 v11, 0xffff0000, v176
v_lshlrev_b32 v12, 16, v177
v_and_b32 v13, 0xffff0000, v177
v_lshlrev_b32 v14, 16, v178
v_and_b32 v15, 0xffff0000, v178
v_lshlrev_b32 v16, 16, v179
v_and_b32 v17, 0xffff0000, v179
v_pk_add_f32 v[96:97], v[96:97], v[10:11]
v_pk_add_f32 v[98:99], v[98:99], v[12:13]
v_pk_add_f32 v[100:101], v[100:101], v[14:15]
v_pk_add_f32 v[102:103], v[102:103], v[16:17]
s_waitcnt vmcnt(2)
v_lshlrev_b32 v10, 16, v180
v_and_b32 v11, 0xffff0000, v180
v_lshlrev_b32 v12, 16, v181
v_and_b32 v13, 0xffff0000, v181
v_lshlrev_b32 v14, 16, v182
v_and_b32 v15, 0xffff0000, v182
v_lshlrev_b32 v16, 16, v183
v_and_b32 v17, 0xffff0000, v183
v_pk_add_f32 v[96:97], v[96:97], v[10:11]
v_pk_add_f32 v[98:99], v[98:99], v[12:13]
v_pk_add_f32 v[100:101], v[100:101], v[14:15]
v_pk_add_f32 v[102:103], v[102:103], v[16:17]
s_waitcnt vmcnt(1)
v_lshlrev_b32 v10, 16, v184
v_and_b32 v11, 0xffff0000, v184
v_lshlrev_b32 v12, 16, v185
v_and_b32 v13, 0xffff0000, v185
v_lshlrev_b32 v14, 16, v186
v_and_b32 v15, 0xffff0000, v186
v_lshlrev_b32 v16, 16, v187
v_and_b32 v17, 0xffff0000, v187
v_pk_add_f32 v[96:97], v[96:97], v[10:11]
v_pk_add_f32 v[98:99], v[98:99], v[12:13]
v_pk_add_f32 v[100:101], v[100:101], v[14:15]
v_pk_add_f32 v[102:103], v[102:103], v[16:17]
s_waitcnt vmcnt(0)
v_lshlrev_b32 v10, 16, v188
v_and_b32 v11, 0xffff0000, v188
v_lshlrev_b32 v12, 16, v189
v_and_b32 v13, 0xffff0000, v189
v_lshlrev_b32 v14, 16, v190
v_and_b32 v15, 0xffff0000, v190
v_lshlrev_b32 v16, 16, v191
v_and_b32 v17, 0xffff0000, v191
v_pk_add_f32 v[96:97], v[96:97], v[10:11]
v_pk_add_f32 v[98:99], v[98:99], v[12:13]
v_pk_add_f32 v[100:101], v[100:101], v[14:15]
v_pk_add_f32 v[102:103], v[102:103], v[16:17]
v_cvt_pk_bf16_f32 v96, v96, v97
v_cvt_pk_bf16_f32 v97, v98, v99
v_cvt_pk_bf16_f32 v98, v100, v101
v_cvt_pk_bf16_f32 v99, v102, v103
buffer_store_dwordx2 v[96:97], v21, s[40:43], s25 offen offset:896
buffer_store_dwordx2 v[98:99], v21, s[40:43], s25 offen offset:928
M_fin:
s_endpgm
PAD_19:
s_cbranch_execz M_tret
M_final:
s_mov_b32 s8, s64
s_mov_b32 s9, s65
s_mov_b32 s10, 1835008
s_mov_b32 s11, 0x20000
s_mov_b32 s12, s88
s_mov_b32 s13, s89
s_mov_b32 s14, 3670016
s_mov_b32 s15, 0x20000
s_and_b32 s24, s2, 16
s_add_u32 s24, s24, s20
v_lshrrev_b32 v20, 4, v1
v_and_b32 v21, 15, v20
v_lshrrev_b32 v22, 4, v20
v_mul_u32_u24 v2, 896, v21
v_lshlrev_b32 v9, 1, v2
v_lshl_add_u32 v2, v22, 4, v2
v_lshl_add_u32 v9, v22, 4, v9
s_lshl_b32 s22, s24, 2
s_add_u32 s22, s22, s3
s_mul_i32 s25, s22, 14336
s_lshl_b32 s26, s25, 1
v_lshlrev_b32 v10, 5, v22
v_add3_u32 v10, v10, v21, 16
v_lshlrev_b32 v10, 2, v10
v_min_u32 v11, 380, v10
v_add_u32 v11, 512, v11
s_mov_b32 s27, 94384128
Lfp:
buffer_load_dword v3, v10, s[4:7], s27 offen sc1
buffer_load_dword v4, v11, s[4:7], s27 offen sc1
s_waitcnt vmcnt(0)
v_and_b32 v3, v3, v4
v_cmp_gt_u32 vcc, 1, v3
s_cbranch_vccz Lfpd
s_sleep 2
s_sub_u32 s101, s101, 1
s_cbranch_scc0 Lfp
s_mov_b32 s101, 0
Lfpd:
s_barrier
buffer_store_dword v6, v5, s[4:7], s35 offen sc1
Lfg:
v_lshrrev_b32 v3, 3, v20
v_and_b32 v4, 7, v20
v_lshlrev_b32 v4, 4, v4
v_lshl_add_u32 v3, v3, 12, v4
s_mul_i32 s27, s3, 458752
s_lshl_b32 s22, s24, 7
s_add_u32 s27, s27, s22
s_add_u32 s27, s27, 88080384
s_mul_i32 s28, s3, 14336
s_add_u32 m0, s28, 0
s_nop 0
buffer_load_dwordx4 v3, s[4:7], s27 offen sc1 lds
s_add_u32 s27, s27, 32768
s_add_u32 m0, s28, 1024
s_nop 0
buffer_load_dwordx4 v3, s[4:7], s27 offen sc1 lds
s_add_u32 s27, s27, 32768
s_add_u32 m0, s28, 2048
s_nop 0
buffer_load_dwordx4 v3, s[4:7], s27 offen sc1 lds
s_add_u32 s27, s27, 32768
s_add_u32 m0, s28, 3072
s_nop 0
buffer_load_dwordx4 v3, s[4:7], s27 offen sc1 lds
s_add_u32 s27, s27, 32768
s_add_u32 m0, s28, 4096
s_nop 0
buffer_load_dwordx4 v3, s[4:7], s27 offen sc1 lds
s_add_u32 s27, s27, 32768
s_add_u32 m0, s28, 5120
s_nop 0
buffer_load_dwordx4 v3, s[4:7], s27 offen sc1 lds
s_add_u32 s27, s27, 32768
s_add_u32 m0, s28, 6144
s_nop 0
buffer_load_dwordx4 v3, s[4:7], s27 offen sc1 lds
s_add_u32 s27, s27, 32768
s_add_u32 m0, s28, 7168
s_nop 0
buffer_load_dwordx4 v3, s[4:7], s27 offen sc1 lds
s_add_u32 s27, s27, 32768
s_add_u32 m0, s28, 8192
s_nop 0
buffer_load_dwordx4 v3, s[4:7], s27 offen sc1 lds
s_add_u32 s27, s27, 32768
s_add_u32 m0, s28, 9216
s_nop 0
buffer_load_dwordx4 v3, s[4:7], s27 offen sc1 lds
s_add_u32 s27, s27, 32768
s_add_u32 m0, s28, 10240
s_nop 0
buffer_load_dwordx4 v3, s[4:7], s27 offen sc1 lds
s_add_u32 s27, s27, 32768
s_add_u32 m0, s28, 11264
s_nop 0
buffer_load_dwordx4 v3, s[4:7], s27 offen sc1 lds
s_add_u32 s27, s27, 32768
s_add_u32 m0, s28, 12288
s_nop 0
buffer_load_dwordx4 v3, s[4:7], s27 offen sc1 lds
s_add_u32 s27, s27, 32768
s_add_u32 m0, s28, 13312
s_nop 0
buffer_load_dwordx4 v3, s[4:7], s27 offen sc1 lds
s_add_u32 s27, s27, 32768
buffer_load_dwordx4 v[160:163], v2, s[8:11], s25 offen offset:0
buffer_load_dwordx4 v[164:167], v2, s[8:11], s25 offen offset:64
buffer_load_dwordx4 v[168:171], v2, s[8:11], s25 offen offset:128
buffer_load_dwordx4 v[172:175], v2, s[8:11], s25 offen offset:192
buffer_load_dwordx4 v[176:179], v2, s[8:11], s25 offen offset:256
buffer_load_dwordx4 v[180:183], v2, s[8:11], s25 offen offset:320
buffer_load_dwordx4 v[184:187], v2, s[8:11], s25 offen offset:384
buffer_load_dwordx4 v[188:191], v2, s[8:11], s25 offen offset:448
buffer_load_dwordx4 v[192:195], v2, s[8:11], s25 offen offset:512
buffer_load_dwordx4 v[196:199], v2, s[8:11], s25 offen offset:576
buffer_load_dwordx4 v[200:203], v2, s[8:11], s25 offen offset:640
buffer_load_dwordx4 v[204:207], v2, s[8:11], s25 offen offset:704
buffer_load_dwordx4 v[208:211], v2, s[8:11], s25 offen offset:768
buffer_load_dwordx4 v[212:215], v2, s[8:11], s25 offen offset:832
v_lshrrev_b32 v3, 2, v21
v_lshl_add_u32 v3, v22, 3, v3
v_lshlrev_b32 v3, 7, v3
v_and_b32 v4, 3, v20
v_lshl_add_u32 v3, v4, 3, v3
s_lshl_b32 s22, s3, 5
v_add_u32 v3, s22, v3
s_waitcnt vmcnt(14)
s_barrier
ds_read_b64_tr_b16 v[96:97], v3 offset:0
ds_read_b64_tr_b16 v[98:99], v3 offset:512
ds_read_b64_tr_b16 v[100:101], v3 offset:4096
ds_read_b64_tr_b16 v[102:103], v3 offset:4608
ds_read_b64_tr_b16 v[104:105], v3 offset:8192
ds_read_b64_tr_b16 v[106:107], v3 offset:8704
ds_read_b64_tr_b16 v[108:109], v3 offset:12288
ds_read_b64_tr_b16 v[110:111], v3 offset:12800
ds_read_b64_tr_b16 v[112:113], v3 offset:16384
ds_read_b64_tr_b16 v[114:115], v3 offset:16896
ds_read_b64_tr_b16 v[116:117], v3 offset:20480
ds_read_b64_tr_b16 v[118:119], v3 offset:20992
ds_read_b64_tr_b16 v[120:121], v3 offset:24576
ds_read_b64_tr_b16 v[122:123], v3 offset:25088
s_waitcnt lgkmcnt(0)
ds_read_b64_tr_b16 v[124:125], v3 offset:28672
ds_read_b64_tr_b16 v[126:127], v3 offset:29184
ds_read_b64_tr_b16 v[128:129], v3 offset:32768
ds_read_b64_tr_b16 v[130:131], v3 offset:33280
ds_read_b64_tr_b16 v[132:133], v3 offset:36864
ds_read_b64_tr_b16 v[134:135], v3 offset:37376
ds_read_b64_tr_b16 v[136:137], v3 offset:40960
ds_read_b64_tr_b16 v[138:139], v3 offset:41472
ds_read_b64_tr_b16 v[140:141], v3 offset:45056
ds_read_b64_tr_b16 v[142:143], v3 offset:45568
ds_read_b64_tr_b16 v[144:145], v3 offset:49152
ds_read_b64_tr_b16 v[146:147], v3 offset:49664
ds_read_b64_tr_b16 v[148:149], v3 offset:53248
ds_read_b64_tr_b16 v[150:151], v3 offset:53760
s_waitcnt vmcnt(13)
v_lshlrev_b32 v10, 16, v160
v_and_b32 v11, 0xffff0000, v160
v_lshlrev_b32 v12, 16, v96
v_and_b32 v13, 0xffff0000, v96
v_pk_mul_f32 v[10:11], v[10:11], v[12:13]
v_cvt_pk_bf16_f32 v160, v10, v11
v_lshlrev_b32 v10, 16, v161
v_and_b32 v11, 0xffff0000, v161
v_lshlrev_b32 v12, 16, v97
v_and_b32 v13, 0xffff0000, v97
v_pk_mul_f32 v[10:11], v[10:11], v[12:13]
v_cvt_pk_bf16_f32 v161, v10, v11
v_lshlrev_b32 v10, 16, v162
v_and_b32 v11, 0xffff0000, v162
v_lshlrev_b32 v12, 16, v98
v_and_b32 v13, 0xffff0000, v98
v_pk_mul_f32 v[10:11], v[10:11], v[12:13]
v_cvt_pk_bf16_f32 v162, v10, v11
v_lshlrev_b32 v10, 16, v163
v_and_b32 v11, 0xffff0000, v163
PAD_20:
s_cbranch_execz M_tret
v_lshlrev_b32 v12, 16, v99
v_and_b32 v13, 0xffff0000, v99
v_pk_mul_f32 v[10:11], v[10:11], v[12:13]
v_cvt_pk_bf16_f32 v163, v10, v11
buffer_store_dwordx4 v[160:163], v9, s[12:15], s26 offen offset:0
s_waitcnt vmcnt(13)
v_lshlrev_b32 v10, 16, v164
v_and_b32 v11, 0xffff0000, v164
v_lshlrev_b32 v12, 16, v100
v_and_b32 v13, 0xffff0000, v100
v_pk_mul_f32 v[10:11], v[10:11], v[12:13]
v_cvt_pk_bf16_f32 v164, v10, v11
v_lshlrev_b32 v10, 16, v165
v_and_b32 v11, 0xffff0000, v165
v_lshlrev_b32 v12, 16, v101
v_and_b32 v13, 0xffff0000, v101
v_pk_mul_f32 v[10:11], v[10:11], v[12:13]
v_cvt_pk_bf16_f32 v165, v10, v11
v_lshlrev_b32 v10, 16, v166
v_and_b32 v11, 0xffff0000, v166
v_lshlrev_b32 v12, 16, v102
v_and_b32 v13, 0xffff0000, v102
v_pk_mul_f32 v[10:11], v[10:11], v[12:13]
v_cvt_pk_bf16_f32 v166, v10, v11
v_lshlrev_b32 v10, 16, v167
v_and_b32 v11, 0xffff0000, v167
v_lshlrev_b32 v12, 16, v103
v_and_b32 v13, 0xffff0000, v103
v_pk_mul_f32 v[10:11], v[10:11], v[12:13]
v_cvt_pk_bf16_f32 v167, v10, v11
buffer_store_dwordx4 v[164:167], v9, s[12:15], s26 offen offset:64
s_waitcnt vmcnt(13)
v_lshlrev_b32 v10, 16, v168
v_and_b32 v11, 0xffff0000, v168
v_lshlrev_b32 v12, 16, v104
v_and_b32 v13, 0xffff0000, v104
v_pk_mul_f32 v[10:11], v[10:11], v[12:13]
v_cvt_pk_bf16_f32 v168, v10, v11
v_lshlrev_b32 v10, 16, v169
v_and_b32 v11, 0xffff0000, v169
v_lshlrev_b32 v12, 16, v105
v_and_b32 v13, 0xffff0000, v105
v_pk_mul_f32 v[10:11], v[10:11], v[12:13]
v_cvt_pk_bf16_f32 v169, v10, v11
v_lshlrev_b32 v10, 16, v170
v_and_b32 v11, 0xffff0000, v170
v_lshlrev_b32 v12, 16, v106
v_and_b32 v13, 0xffff0000, v106
v_pk_mul_f32 v[10:11], v[10:11], v[12:13]
v_cvt_pk_bf16_f32 v170, v10, v11
v_lshlrev_b32 v10, 16, v171
v_and_b32 v11, 0xffff0000, v171
v_lshlrev_b32 v12, 16, v107
v_and_b32 v13, 0xffff0000, v107
v_pk_mul_f32 v[10:11], v[10:11], v[12:13]
v_cvt_pk_bf16_f32 v171, v10, v11
buffer_store_dwordx4 v[168:171], v9, s[12:15], s26 offen offset:128
s_waitcnt vmcnt(13)
v_lshlrev_b32 v10, 16, v172
v_and_b32 v11, 0xffff0000, v172
v_lshlrev_b32 v12, 16, v108
v_and_b32 v13, 0xffff0000, v108
v_pk_mul_f32 v[10:11], v[10:11], v[12:13]
v_cvt_pk_bf16_f32 v172, v10, v11
v_lshlrev_b32 v10, 16, v173
v_and_b32 v11, 0xffff0000, v173
v_lshlrev_b32 v12, 16, v109
v_and_b32 v13, 0xffff0000, v109
v_pk_mul_f32 v[10:11], v[10:11], v[12:13]
v_cvt_pk_bf16_f32 v173, v10, v11
v_lshlrev_b32 v10, 16, v174
v_and_b32 v11, 0xffff0000, v174
v_lshlrev_b32 v12, 16, v110
v_and_b32 v13, 0xffff0000, v110
v_pk_mul_f32 v[10:11], v[10:11], v[12:13]
v_cvt_pk_bf16_f32 v174, v10, v11
v_lshlrev_b32 v10, 16, v175
v_and_b32 v11, 0xffff0000, v175
v_lshlrev_b32 v12, 16, v111
v_and_b32 v13, 0xffff0000, v111
v_pk_mul_f32 v[10:11], v[10:11], v[12:13]
v_cvt_pk_bf16_f32 v175, v10, v11
buffer_store_dwordx4 v[172:175], v9, s[12:15], s26 offen offset:192
s_waitcnt vmcnt(13)
v_lshlrev_b32 v10, 16, v176
v_and_b32 v11, 0xffff0000, v176
v_lshlrev_b32 v12, 16, v112
v_and_b32 v13, 0xffff0000, v112
v_pk_mul_f32 v[10:11], v[10:11], v[12:13]
v_cvt_pk_bf16_f32 v176, v10, v11
v_lshlrev_b32 v10, 16, v177
v_and_b32 v11, 0xffff0000, v177
v_lshlrev_b32 v12, 16, v113
v_and_b32 v13, 0xffff0000, v113
v_pk_mul_f32 v[10:11], v[10:11], v[12:13]
v_cvt_pk_bf16_f32 v177, v10, v11
v_lshlrev_b32 v10, 16, v178
v_and_b32 v11, 0xffff0000, v178
v_lshlrev_b32 v12, 16, v114
v_and_b32 v13, 0xffff0000, v114
v_pk_mul_f32 v[10:11], v[10:11], v[12:13]
v_cvt_pk_bf16_f32 v178, v10, v11
v_lshlrev_b32 v10, 16, v179
v_and_b32 v11, 0xffff0000, v179
v_lshlrev_b32 v12, 16, v115
v_and_b32 v13, 0xffff0000, v115
v_pk_mul_f32 v[10:11], v[10:11], v[12:13]
v_cvt_pk_bf16_f32 v179, v10, v11
buffer_store_dwordx4 v[176:179], v9, s[12:15], s26 offen offset:256
s_waitcnt vmcnt(13)
v_lshlrev_b32 v10, 16, v180
v_and_b32 v11, 0xffff0000, v180
v_lshlrev_b32 v12, 16, v116
v_and_b32 v13, 0xffff0000, v116
v_pk_mul_f32 v[10:11], v[10:11], v[12:13]
v_cvt_pk_bf16_f32 v180, v10, v11
v_lshlrev_b32 v10, 16, v181
v_and_b32 v11, 0xffff0000, v181
v_lshlrev_b32 v12, 16, v117
v_and_b32 v13, 0xffff0000, v117
v_pk_mul_f32 v[10:11], v[10:11], v[12:13]
v_cvt_pk_bf16_f32 v181, v10, v11
v_lshlrev_b32 v10, 16, v182
v_and_b32 v11, 0xffff0000, v182
v_lshlrev_b32 v12, 16, v118
v_and_b32 v13, 0xffff0000, v118
v_pk_mul_f32 v[10:11], v[10:11], v[12:13]
v_cvt_pk_bf16_f32 v182, v10, v11
v_lshlrev_b32 v10, 16, v183
v_and_b32 v11, 0xffff0000, v183
v_lshlrev_b32 v12, 16, v119
v_and_b32 v13, 0xffff0000, v119
v_pk_mul_f32 v[10:11], v[10:11], v[12:13]
v_cvt_pk_bf16_f32 v183, v10, v11
buffer_store_dwordx4 v[180:183], v9, s[12:15], s26 offen offset:320
s_waitcnt vmcnt(13)
v_lshlrev_b32 v10, 16, v184
v_and_b32 v11, 0xffff0000, v184
v_lshlrev_b32 v12, 16, v120
v_and_b32 v13, 0xffff0000, v120
v_pk_mul_f32 v[10:11], v[10:11], v[12:13]
v_cvt_pk_bf16_f32 v184, v10, v11
v_lshlrev_b32 v10, 16, v185
v_and_b32 v11, 0xffff0000, v185
v_lshlrev_b32 v12, 16, v121
v_and_b32 v13, 0xffff0000, v121
v_pk_mul_f32 v[10:11], v[10:11], v[12:13]
v_cvt_pk_bf16_f32 v185, v10, v11
v_lshlrev_b32 v10, 16, v186
v_and_b32 v11, 0xffff0000, v186
v_lshlrev_b32 v12, 16, v122
v_and_b32 v13, 0xffff0000, v122
v_pk_mul_f32 v[10:11], v[10:11], v[12:13]
v_cvt_pk_bf16_f32 v186, v10, v11
v_lshlrev_b32 v10, 16, v187
v_and_b32 v11, 0xffff0000, v187
v_lshlrev_b32 v12, 16, v123
v_and_b32 v13, 0xffff0000, v123
v_pk_mul_f32 v[10:11], v[10:11], v[12:13]
v_cvt_pk_bf16_f32 v187, v10, v11
buffer_store_dwordx4 v[184:187], v9, s[12:15], s26 offen offset:384
s_waitcnt lgkmcnt(0)
s_waitcnt vmcnt(13)
v_lshlrev_b32 v10, 16, v188
v_and_b32 v11, 0xffff0000, v188
v_lshlrev_b32 v12, 16, v124
v_and_b32 v13, 0xffff0000, v124
v_pk_mul_f32 v[10:11], v[10:11], v[12:13]
v_cvt_pk_bf16_f32 v188, v10, v11
v_lshlrev_b32 v10, 16, v189
v_and_b32 v11, 0xffff0000, v189
v_lshlrev_b32 v12, 16, v125
v_and_b32 v13, 0xffff0000, v125
v_pk_mul_f32 v[10:11], v[10:11], v[12:13]
v_cvt_pk_bf16_f32 v189, v10, v11
v_lshlrev_b32 v10, 16, v190
v_and_b32 v11, 0xffff0000, v190
v_lshlrev_b32 v12, 16, v126
v_and_b32 v13, 0xffff0000, v126
v_pk_mul_f32 v[10:11], v[10:11], v[12:13]
v_cvt_pk_bf16_f32 v190, v10, v11
v_lshlrev_b32 v10, 16, v191
v_and_b32 v11, 0xffff0000, v191
v_lshlrev_b32 v12, 16, v127
v_and_b32 v13, 0xffff0000, v127
v_pk_mul_f32 v[10:11], v[10:11], v[12:13]
v_cvt_pk_bf16_f32 v191, v10, v11
buffer_store_dwordx4 v[188:191], v9, s[12:15], s26 offen offset:448
s_waitcnt vmcnt(13)
v_lshlrev_b32 v10, 16, v192
v_and_b32 v11, 0xffff0000, v192
v_lshlrev_b32 v12, 16, v128
v_and_b32 v13, 0xffff0000, v128
v_pk_mul_f32 v[10:11], v[10:11], v[12:13]
v_cvt_pk_bf16_f32 v192, v10, v11
v_lshlrev_b32 v10, 16, v193
v_and_b32 v11, 0xffff0000, v193
v_lshlrev_b32 v12, 16, v129
v_and_b32 v13, 0xffff0000, v129
v_pk_mul_f32 v[10:11], v[10:11], v[12:13]
v_cvt_pk_bf16_f32 v193, v10, v11
v_lshlrev_b32 v10, 16, v194
v_and_b32 v11, 0xffff0000, v194
v_lshlrev_b32 v12, 16, v130
v_and_b32 v13, 0xffff0000, v130
v_pk_mul_f32 v[10:11], v[10:11], v[12:13]
v_cvt_pk_bf16_f32 v194, v10, v11
v_lshlrev_b32 v10, 16, v195
v_and_b32 v11, 0xffff0000, v195
v_lshlrev_b32 v12, 16, v131
v_and_b32 v13, 0xffff0000, v131
v_pk_mul_f32 v[10:11], v[10:11], v[12:13]
v_cvt_pk_bf16_f32 v195, v10, v11
buffer_store_dwordx4 v[192:195], v9, s[12:15], s26 offen offset:512
s_waitcnt vmcnt(13)
v_lshlrev_b32 v10, 16, v196
v_and_b32 v11, 0xffff0000, v196
v_lshlrev_b32 v12, 16, v132
v_and_b32 v13, 0xffff0000, v132
v_pk_mul_f32 v[10:11], v[10:11], v[12:13]
v_cvt_pk_bf16_f32 v196, v10, v11
v_lshlrev_b32 v10, 16, v197
v_and_b32 v11, 0xffff0000, v197
v_lshlrev_b32 v12, 16, v133
v_and_b32 v13, 0xffff0000, v133
v_pk_mul_f32 v[10:11], v[10:11], v[12:13]
v_cvt_pk_bf16_f32 v197, v10, v11
v_lshlrev_b32 v10, 16, v198
v_and_b32 v11, 0xffff0000, v198
v_lshlrev_b32 v12, 16, v134
v_and_b32 v13, 0xffff0000, v134
v_pk_mul_f32 v[10:11], v[10:11], v[12:13]
v_cvt_pk_bf16_f32 v198, v10, v11
v_lshlrev_b32 v10, 16, v199
v_and_b32 v11, 0xffff0000, v199
v_lshlrev_b32 v12, 16, v135
v_and_b32 v13, 0xffff0000, v135
v_pk_mul_f32 v[10:11], v[10:11], v[12:13]
v_cvt_pk_bf16_f32 v199, v10, v11
buffer_store_dwordx4 v[196:199], v9, s[12:15], s26 offen offset:576
s_waitcnt vmcnt(13)
v_lshlrev_b32 v10, 16, v200
v_and_b32 v11, 0xffff0000, v200
v_lshlrev_b32 v12, 16, v136
v_and_b32 v13, 0xffff0000, v136
v_pk_mul_f32 v[10:11], v[10:11], v[12:13]
v_cvt_pk_bf16_f32 v200, v10, v11
v_lshlrev_b32 v10, 16, v201
v_and_b32 v11, 0xffff0000, v201
v_lshlrev_b32 v12, 16, v137
v_and_b32 v13, 0xffff0000, v137
v_pk_mul_f32 v[10:11], v[10:11], v[12:13]
v_cvt_pk_bf16_f32 v201, v10, v11
v_lshlrev_b32 v10, 16, v202
v_and_b32 v11, 0xffff0000, v202
v_lshlrev_b32 v12, 16, v138
v_and_b32 v13, 0xffff0000, v138
v_pk_mul_f32 v[10:11], v[10:11], v[12:13]
v_cvt_pk_bf16_f32 v202, v10, v11
v_lshlrev_b32 v10, 16, v203
v_and_b32 v11, 0xffff0000, v203
v_lshlrev_b32 v12, 16, v139
v_and_b32 v13, 0xffff0000, v139
v_pk_mul_f32 v[10:11], v[10:11], v[12:13]
v_cvt_pk_bf16_f32 v203, v10, v11
buffer_store_dwordx4 v[200:203], v9, s[12:15], s26 offen offset:640
s_waitcnt vmcnt(13)
v_lshlrev_b32 v10, 16, v204
v_and_b32 v11, 0xffff0000, v204
v_lshlrev_b32 v12, 16, v140
v_and_b32 v13, 0xffff0000, v140
v_pk_mul_f32 v[10:11], v[10:11], v[12:13]
v_cvt_pk_bf16_f32 v204, v10, v11
v_lshlrev_b32 v10, 16, v205
v_and_b32 v11, 0xffff0000, v205
v_lshlrev_b32 v12, 16, v141
v_and_b32 v13, 0xffff0000, v141
v_pk_mul_f32 v[10:11], v[10:11], v[12:13]
v_cvt_pk_bf16_f32 v205, v10, v11
v_lshlrev_b32 v10, 16, v206
v_and_b32 v11, 0xffff0000, v206
v_lshlrev_b32 v12, 16, v142
v_and_b32 v13, 0xffff0000, v142
v_pk_mul_f32 v[10:11], v[10:11], v[12:13]
v_cvt_pk_bf16_f32 v206, v10, v11
v_lshlrev_b32 v10, 16, v207
v_and_b32 v11, 0xffff0000, v207
v_lshlrev_b32 v12, 16, v143
v_and_b32 v13, 0xffff0000, v143
v_pk_mul_f32 v[10:11], v[10:11], v[12:13]
v_cvt_pk_bf16_f32 v207, v10, v11
buffer_store_dwordx4 v[204:207], v9, s[12:15], s26 offen offset:704
s_waitcnt vmcnt(13)
v_lshlrev_b32 v10, 16, v208
v_and_b32 v11, 0xffff0000, v208
v_lshlrev_b32 v12, 16, v144
v_and_b32 v13, 0xffff0000, v144
v_pk_mul_f32 v[10:11], v[10:11], v[12:13]
v_cvt_pk_bf16_f32 v208, v10, v11
v_lshlrev_b32 v10, 16, v209
v_and_b32 v11, 0xffff0000, v209
v_lshlrev_b32 v12, 16, v145
v_and_b32 v13, 0xffff0000, v145
v_pk_mul_f32 v[10:11], v[10:11], v[12:13]
v_cvt_pk_bf16_f32 v209, v10, v11
v_lshlrev_b32 v10, 16, v210
v_and_b32 v11, 0xffff0000, v210
v_lshlrev_b32 v12, 16, v146
v_and_b32 v13, 0xffff0000, v146
v_pk_mul_f32 v[10:11], v[10:11], v[12:13]
v_cvt_pk_bf16_f32 v210, v10, v11
v_lshlrev_b32 v10, 16, v211
v_and_b32 v11, 0xffff0000, v211
v_lshlrev_b32 v12, 16, v147
v_and_b32 v13, 0xffff0000, v147
v_pk_mul_f32 v[10:11], v[10:11], v[12:13]
v_cvt_pk_bf16_f32 v211, v10, v11
buffer_store_dwordx4 v[208:211], v9, s[12:15], s26 offen offset:768
s_waitcnt vmcnt(13)
v_lshlrev_b32 v10, 16, v212
v_and_b32 v11, 0xffff0000, v212
v_lshlrev_b32 v12, 16, v148
v_and_b32 v13, 0xffff0000, v148
v_pk_mul_f32 v[10:11], v[10:11], v[12:13]
v_cvt_pk_bf16_f32 v212, v10, v11
v_lshlrev_b32 v10, 16, v213
v_and_b32 v11, 0xffff0000, v213
v_lshlrev_b32 v12, 16, v149
v_and_b32 v13, 0xffff0000, v149
v_pk_mul_f32 v[10:11], v[10:11], v[12:13]
v_cvt_pk_bf16_f32 v213, v10, v11
v_lshlrev_b32 v10, 16, v214
v_and_b32 v11, 0xffff0000, v214
v_lshlrev_b32 v12, 16, v150
v_and_b32 v13, 0xffff0000, v150
v_pk_mul_f32 v[10:11], v[10:11], v[12:13]
v_cvt_pk_bf16_f32 v214, v10, v11
v_lshlrev_b32 v10, 16, v215
v_and_b32 v11, 0xffff0000, v215
v_lshlrev_b32 v12, 16, v151
v_and_b32 v13, 0xffff0000, v151
v_pk_mul_f32 v[10:11], v[10:11], v[12:13]
v_cvt_pk_bf16_f32 v215, v10, v11
buffer_store_dwordx4 v[212:215], v9, s[12:15], s26 offen offset:832
s_branch M_fin
M_fend:
M_rslow:
Lp_9251:
buffer_load_dword v18, v19, s[4:7], s33 offen offset:0 sc1
s_waitcnt vmcnt(0)
v_cmp_gt_u32 vcc, 1, v18
s_cbranch_vccz Lpd_9252
s_sleep 8
s_sub_u32 s101, s101, 1
s_cbranch_scc0 Lp_9251
s_mov_b32 s101, 0
Lpd_9252:
s_branch M_rjoin
PAD_21:
s_cbranch_execz PAD_25
M_V:
v_mfma_f32_16x16x32_bf16 v[32:35], a[0:3], a[128:131], 0
s_add_u32 m0, s29, 98304
ds_read_b64_tr_b16 a[136:137], v5 offset:0
v_mfma_f32_16x16x32_bf16 v[32:35], a[4:7], a[132:135], v[32:35]
s_mov_b32 s32, 1024
buffer_load_dwordx4 v16, s[12:15], s26 offen offset:0 lds
v_mfma_f32_16x16x32_bf16 v[36:39], a[8:11], a[128:131], 0
s_mov_b32 s33, 31744
ds_read_b64_tr_b16 a[138:139], v5 offset:2048
v_mfma_f32_16x16x32_bf16 v[36:39], a[12:15], a[132:135], v[36:39]
s_mov_b32 s34, 4294935552
v_mfma_f32_16x16x32_bf16 v[40:43], a[16:19], a[128:131], 0
s_mov_b32 s35, 4294935552
ds_read_b64_tr_b16 a[140:141], v5 offset:16384
v_mfma_f32_16x16x32_bf16 v[40:43], a[20:23], a[132:135], v[40:43]
s_mov_b32 s36, 4294935552
buffer_load_dwordx4 v17, s[12:15], s26 offen offset:1024 lds
v_mfma_f32_16x16x32_bf16 v[44:47], a[24:27], a[128:131], 0
s_mov_b32 s30, 8
ds_read_b64_tr_b16 a[142:143], v5 offset:18432
v_mfma_f32_16x16x32_bf16 v[44:47], a[28:31], a[132:135], v[44:47]
s_mov_b32 s82, 3221225472
v_mfma_f32_16x16x32_bf16 v[48:51], a[32:35], a[128:131], 0
s_mul_hi_u32 s38, s2, 613566757
v_mfma_f32_16x16x32_bf16 v[48:51], a[36:39], a[132:135], v[48:51]
s_mul_i32 s39, s38, 7
buffer_load_dwordx4 v18, s[12:15], s26 offen offset:2048 lds
v_mfma_f32_16x16x32_bf16 v[52:55], a[40:43], a[128:131], 0
s_sub_u32 s39, s2, s39
v_mov_b32 v246, 0
v_mov_b32 v229, 0
v_mfma_f32_16x16x32_bf16 v[52:55], a[44:47], a[132:135], v[52:55]
v_mov_b32 v231, 0
v_mfma_f32_16x16x32_bf16 v[56:59], a[48:51], a[128:131], 0
s_mov_b32 s60, s90
v_mfma_f32_16x16x32_bf16 v[56:59], a[52:55], a[132:135], v[56:59]
s_mov_b32 s61, s91
buffer_load_dwordx4 v19, s[12:15], s26 offen offset:3072 lds
v_mfma_f32_16x16x32_bf16 v[60:63], a[56:59], a[128:131], 0
s_add_u32 s26, s26, 524288
v_mfma_f32_16x16x32_bf16 v[60:63], a[60:63], a[132:135], v[60:63]
s_waitcnt lgkmcnt(0)
s_mov_b32 s62, 256
v_mfma_f32_16x16x32_bf16 v[64:67], a[0:3], a[136:139], 0
s_add_u32 m0, s29, 114688
ds_read_b64_tr_b16 a[128:129], v6 offset:0
v_mfma_f32_16x16x32_bf16 v[64:67], a[4:7], a[140:143], v[64:67]
s_mov_b32 s63, 0x20000
buffer_load_dwordx4 v16, s[12:15], s27 offen offset:0 lds
v_mfma_f32_16x16x32_bf16 v[68:71], a[8:11], a[136:139], 0
s_mul_hi_u32 s55, s2, 1431655766
ds_read_b64_tr_b16 a[130:131], v6 offset:2048
v_mfma_f32_16x16x32_bf16 v[68:71], a[12:15], a[140:143], v[68:71]
s_mul_i32 s55, s55, 3
v_mfma_f32_16x16x32_bf16 v[72:75], a[16:19], a[136:139], 0
s_sub_u32 s55, s2, s55
ds_read_b64_tr_b16 a[132:133], v6 offset:16384
v_mfma_f32_16x16x32_bf16 v[72:75], a[20:23], a[140:143], v[72:75]
s_add_u32 s55, s55, 5
buffer_load_dwordx4 v17, s[12:15], s27 offen offset:1024 lds
v_mfma_f32_16x16x32_bf16 v[76:79], a[24:27], a[136:139], 0
s_lshr_b32 s22, s2, 4
ds_read_b64_tr_b16 a[134:135], v6 offset:18432
v_mfma_f32_16x16x32_bf16 v[76:79], a[28:31], a[140:143], v[76:79]
s_lshl_b32 s23, s20, 5
v_mfma_f32_16x16x32_bf16 v[80:83], a[32:35], a[136:139], 0
s_add_u32 s23, s23, s22
v_mfma_f32_16x16x32_bf16 v[80:83], a[36:39], a[140:143], v[80:83]
s_lshl_b32 s23, s23, 2
buffer_load_dwordx4 v18, s[12:15], s27 offen offset:2048 lds
v_mfma_f32_16x16x32_bf16 v[84:87], a[40:43], a[136:139], 0
s_and_b32 s22, s2, 16
v_mfma_f32_16x16x32_bf16 v[84:87], a[44:47], a[140:143], v[84:87]
s_lshl_b32 s22, s22, 7
v_mfma_f32_16x16x32_bf16 v[88:91], a[48:51], a[136:139], 0
s_add_u32 s23, s23, s22
v_mov_b32 v28, 3221225472
v_writelane_b32 v28, s23, 0
v_mfma_f32_16x16x32_bf16 v[88:91], a[52:55], a[140:143], v[88:91]
s_add_u32 s56, s23, 16384
buffer_load_dwordx4 v19, s[12:15], s27 offen offset:3072 lds
v_mfma_f32_16x16x32_bf16 v[92:95], a[56:59], a[136:139], 0
s_add_u32 s27, s27, 524288
v_writelane_b32 v28, s56, 1
v_mfma_f32_16x16x32_bf16 v[92:95], a[60:63], a[140:143], v[92:95]
s_waitcnt lgkmcnt(0)
s_add_u32 s56, s23, 4096
v_writelane_b32 v28, s56, 2
v_mfma_f32_16x16x32_bf16 v[96:99], a[0:3], a[128:131], 0
s_add_u32 m0, s28, 0
ds_read_b64_tr_b16 a[136:137], v7 offset:0
v_mfma_f32_16x16x32_bf16 v[96:99], a[4:7], a[132:135], v[96:99]
s_sub_u32 s37, 15, s21
buffer_load_dwordx4 v12, s[8:11], s24 offen offset:0 lds
v_mfma_f32_16x16x32_bf16 v[100:103], a[8:11], a[128:131], 0
ds_read_b64_tr_b16 a[138:139], v7 offset:2048
v_mfma_f32_16x16x32_bf16 v[100:103], a[12:15], a[132:135], v[100:103]
v_mfma_f32_16x16x32_bf16 v[104:107], a[16:19], a[128:131], 0
ds_read_b64_tr_b16 a[140:141], v7 offset:16384
v_mfma_f32_16x16x32_bf16 v[104:107], a[20:23], a[132:135], v[104:107]
buffer_load_dwordx4 v13, s[8:11], s24 offen offset:1024 lds
v_mfma_f32_16x16x32_bf16 v[108:111], a[24:27], a[128:131], 0
ds_read_b64_tr_b16 a[142:143], v7 offset:18432
v_mfma_f32_16x16x32_bf16 v[108:111], a[28:31], a[132:135], v[108:111]
v_mfma_f32_16x16x32_bf16 v[112:115], a[32:35], a[128:131], 0
v_mfma_f32_16x16x32_bf16 v[112:115], a[36:39], a[132:135], v[112:115]
buffer_load_dwordx4 v14, s[8:11], s24 offen offset:2048 lds
v_mfma_f32_16x16x32_bf16 v[116:119], a[40:43], a[128:131], 0
v_mfma_f32_16x16x32_bf16 v[116:119], a[44:47], a[132:135], v[116:119]
v_mfma_f32_16x16x32_bf16 v[120:123], a[48:51], a[128:131], 0
v_mfma_f32_16x16x32_bf16 v[120:123], a[52:55], a[132:135], v[120:123]
buffer_load_dwordx4 v15, s[8:11], s24 offen offset:3072 lds
v_mfma_f32_16x16x32_bf16 v[124:127], a[56:59], a[128:131], 0
s_add_u32 s24, s24, 128
v_mfma_f32_16x16x32_bf16 v[124:127], a[60:63], a[132:135], v[124:127]
s_waitcnt vmcnt(13) lgkmcnt(0)
s_barrier
v_mfma_f32_16x16x32_bf16 v[128:131], a[0:3], a[136:139], 0
s_add_u32 m0, s28, 4096
ds_read_b64_tr_b16 a[128:129], v8 offset:0
v_mfma_f32_16x16x32_bf16 v[128:131], a[4:7], a[140:143], v[128:131]
buffer_load_dwordx4 v12, s[8:11], s25 offen offset:0 lds
v_mfma_f32_16x16x32_bf16 v[132:135], a[8:11], a[136:139], 0
ds_read_b64_tr_b16 a[130:131], v8 offset:2048
v_mfma_f32_16x16x32_bf16 v[132:135], a[12:15], a[140:143], v[132:135]
v_mfma_f32_16x16x32_bf16 v[136:139], a[16:19], a[136:139], 0
ds_read_b64_tr_b16 a[132:133], v8 offset:16384
v_mfma_f32_16x16x32_bf16 v[136:139], a[20:23], a[140:143], v[136:139]
buffer_load_dwordx4 v13, s[8:11], s25 offen offset:1024 lds
v_mfma_f32_16x16x32_bf16 v[140:143], a[24:27], a[136:139], 0
ds_read_b64_tr_b16 a[134:135], v8 offset:18432
v_mfma_f32_16x16x32_bf16 v[140:143], a[28:31], a[140:143], v[140:143]
v_mfma_f32_16x16x32_bf16 v[144:147], a[32:35], a[136:139], 0
ds_read_b128 a[64:67], v2 offset:32768
v_mfma_f32_16x16x32_bf16 v[144:147], a[36:39], a[140:143], v[144:147]
buffer_load_dwordx4 v14, s[8:11], s25 offen offset:2048 lds
v_mfma_f32_16x16x32_bf16 v[148:151], a[40:43], a[136:139], 0
ds_read_b128 a[68:71], v3 offset:32768
v_mfma_f32_16x16x32_bf16 v[148:151], a[44:47], a[140:143], v[148:151]
ds_read_b128 a[72:75], v2 offset:34816
v_mfma_f32_16x16x32_bf16 v[152:155], a[48:51], a[136:139], 0
ds_read_b128 a[76:79], v3 offset:34816
v_mfma_f32_16x16x32_bf16 v[152:155], a[52:55], a[140:143], v[152:155]
buffer_load_dwordx4 v15, s[8:11], s25 offen offset:3072 lds
v_mfma_f32_16x16x32_bf16 v[156:159], a[56:59], a[136:139], 0
s_add_u32 s25, s25, 128
ds_read_b128 a[80:83], v2 offset:36864
v_mfma_f32_16x16x32_bf16 v[156:159], a[60:63], a[140:143], v[156:159]
s_waitcnt lgkmcnt(5)
ds_read_b128 a[84:87], v3 offset:36864
v_mfma_f32_16x16x32_bf16 v[160:163], a[0:3], a[128:131], 0
ds_read_b64_tr_b16 a[136:137], v9 offset:0
v_mfma_f32_16x16x32_bf16 v[160:163], a[4:7], a[132:135], v[160:163]
buffer_load_dword v21, v20, s[16:19], s43 offen
v_mfma_f32_16x16x32_bf16 v[164:167], a[8:11], a[128:131], 0
s_add_u32 s43, s43, s47
ds_read_b64_tr_b16 a[138:139], v9 offset:2048
v_mfma_f32_16x16x32_bf16 v[164:167], a[12:15], a[132:135], v[164:167]
s_cmp_ge_u32 s43, s51
v_mfma_f32_16x16x32_bf16 v[168:171], a[16:19], a[128:131], 0
s_cselect_b32 s43, 0, s43
ds_read_b64_tr_b16 a[140:141], v9 offset:16384
v_mfma_f32_16x16x32_bf16 v[168:171], a[20:23], a[132:135], v[168:171]
s_cselect_b32 s51, s42, s51
v_mfma_f32_16x16x32_bf16 v[172:175], a[24:27], a[128:131], 0
s_cselect_b64 s[16:17], s[40:41], s[16:17]
ds_read_b64_tr_b16 a[142:143], v9 offset:18432
v_mfma_f32_16x16x32_bf16 v[172:175], a[28:31], a[132:135], v[172:175]
s_cselect_b32 s18, s42, s18
v_mfma_f32_16x16x32_bf16 v[176:179], a[32:35], a[128:131], 0
s_cselect_b64 s[40:41], s[44:45], s[40:41]
v_mfma_f32_16x16x32_bf16 v[176:179], a[36:39], a[132:135], v[176:179]
s_cselect_b32 s42, s46, s42
v_mfma_f32_16x16x32_bf16 v[180:183], a[40:43], a[128:131], 0
s_waitcnt lgkmcnt(2)
s_cselect_b32 s46, 0, s46
ds_read_b128 a[88:91], v2 offset:38912
v_mfma_f32_16x16x32_bf16 v[180:183], a[44:47], a[132:135], v[180:183]
s_bitcmp1_b32 s2, 4
s_cselect_b32 s37, s21, s37
ds_read_b128 a[92:95], v3 offset:38912
v_mfma_f32_16x16x32_bf16 v[184:187], a[48:51], a[128:131], 0
s_lshl_b32 s56, s37, 5
s_add_u32 s56, s56, s20
ds_read_b128 a[96:99], v2 offset:40960
v_mfma_f32_16x16x32_bf16 v[184:187], a[52:55], a[132:135], v[184:187]
s_lshl_b32 s56, s56, 2
s_add_u32 s56, s56, 8192
v_writelane_b32 v28, s56, 3
v_mfma_f32_16x16x32_bf16 v[188:191], a[56:59], a[128:131], 0
s_add_u32 s56, s56, 2048
ds_read_b128 a[100:103], v3 offset:40960
v_writelane_b32 v28, s56, 6
v_mfma_f32_16x16x32_bf16 v[188:191], a[60:63], a[132:135], v[188:191]
s_lshl_b32 s56, s2, 2
s_add_u32 s56, s56, 12288
ds_read_b128 a[104:107], v2 offset:43008
v_mfma_f32_16x16x32_bf16 v[192:195], a[0:3], a[136:139], 0
s_waitcnt lgkmcnt(5)
ds_read_b64_tr_b16 a[128:129], v10 offset:0
v_writelane_b32 v28, s56, 4
v_mfma_f32_16x16x32_bf16 v[192:195], a[4:7], a[140:143], v[192:195]
s_lshl_b32 s56, s39, 5
s_add_u32 s56, s56, s38
s_lshl_b32 s56, s56, 2
v_mfma_f32_16x16x32_bf16 v[196:199], a[8:11], a[136:139], 0
s_add_u32 s56, s56, 20480
s_cmp_lt_u32 s2, 224
ds_read_b64_tr_b16 a[130:131], v10 offset:2048
v_mfma_f32_16x16x32_bf16 v[196:199], a[12:15], a[140:143], v[196:199]
s_cselect_b32 s56, s56, 3221225472
v_writelane_b32 v28, s56, 7
v_mfma_f32_16x16x32_bf16 v[200:203], a[16:19], a[136:139], 0
s_cmp_eq_u32 s3, 0
s_cselect_b32 s56, 94371840, 3221225472
ds_read_b64_tr_b16 a[132:133], v10 offset:16384
v_mfma_f32_16x16x32_bf16 v[200:203], a[20:23], a[140:143], v[200:203]
buffer_store_dword v246, v28, s[4:7], s56 offen sc1
v_mfma_f32_16x16x32_bf16 v[204:207], a[24:27], a[136:139], 0
ds_read_b64_tr_b16 a[134:135], v10 offset:18432
v_mov_b32 v27, 1
v_mfma_f32_16x16x32_bf16 v[204:207], a[28:31], a[140:143], v[204:207]
v_cmp_eq_u32 vcc, 0, v0
v_mov_b32 v26, 3221225472
v_mfma_f32_16x16x32_bf16 v[208:211], a[32:35], a[136:139], 0
s_lshl_b32 s31, s20, 20
s_lshl_b32 s22, s21, 17
v_cndmask_b32 v26, v26, v246, vcc
v_mfma_f32_16x16x32_bf16 v[208:211], a[36:39], a[140:143], v[208:211]
s_add_u32 s31, s31, s22
s_lshr_b32 s22, s3, 1
s_lshl_b32 s22, s22, 16
v_mfma_f32_16x16x32_bf16 v[212:215], a[40:43], a[136:139], 0
s_add_u32 s31, s31, s22
s_and_b32 s22, s3, 1
ds_read_b128 a[108:111], v3 offset:43008
v_mfma_f32_16x16x32_bf16 v[212:215], a[44:47], a[140:143], v[212:215]
s_lshl_b32 s22, s22, 14
s_add_u32 s31, s31, s22
ds_read_b128 a[112:115], v2 offset:45056
v_mfma_f32_16x16x32_bf16 v[216:219], a[48:51], a[136:139], 0
s_add_u32 s31, s31, 16777216
ds_read_b128 a[116:119], v3 offset:45056
v_mfma_f32_16x16x32_bf16 v[216:219], a[52:55], a[140:143], v[216:219]
v_mfma_f32_16x16x32_bf16 v[220:223], a[56:59], a[136:139], 0
ds_read_b128 a[120:123], v2 offset:47104
v_mfma_f32_16x16x32_bf16 v[220:223], a[60:63], a[140:143], v[220:223]
s_waitcnt lgkmcnt(4)
ds_read_b128 a[124:127], v3 offset:47104
v_mfma_f32_16x16x32_bf16 a[192:195], a[0:3], a[128:131], 0
ds_read_b64_tr_b16 a[136:137], v11 offset:0
v_mfma_f32_16x16x32_bf16 a[192:195], a[4:7], a[132:135], a[192:195]
PAD_22:
s_cbranch_execz PAD_26
v_mfma_f32_16x16x32_bf16 a[196:199], a[8:11], a[128:131], 0
ds_read_b64_tr_b16 a[138:139], v11 offset:2048
v_mfma_f32_16x16x32_bf16 a[196:199], a[12:15], a[132:135], a[196:199]
v_mfma_f32_16x16x32_bf16 a[200:203], a[16:19], a[128:131], 0
ds_read_b64_tr_b16 a[140:141], v11 offset:16384
v_mfma_f32_16x16x32_bf16 a[200:203], a[20:23], a[132:135], a[200:203]
v_mfma_f32_16x16x32_bf16 a[204:207], a[24:27], a[128:131], 0
ds_read_b64_tr_b16 a[142:143], v11 offset:18432
v_mfma_f32_16x16x32_bf16 a[204:207], a[28:31], a[132:135], a[204:207]
v_mfma_f32_16x16x32_bf16 a[208:211], a[32:35], a[128:131], 0
v_mfma_f32_16x16x32_bf16 a[208:211], a[36:39], a[132:135], a[208:211]
v_mfma_f32_16x16x32_bf16 a[212:215], a[40:43], a[128:131], 0
v_mfma_f32_16x16x32_bf16 a[212:215], a[44:47], a[132:135], a[212:215]
v_mfma_f32_16x16x32_bf16 a[216:219], a[48:51], a[128:131], 0
v_mfma_f32_16x16x32_bf16 a[216:219], a[52:55], a[132:135], a[216:219]
v_mfma_f32_16x16x32_bf16 a[220:223], a[56:59], a[128:131], 0
s_waitcnt vmcnt(2) lgkmcnt(0)
v_mfma_f32_16x16x32_bf16 a[220:223], a[60:63], a[132:135], a[220:223]
s_barrier
v_mfma_f32_16x16x32_bf16 a[224:227], a[0:3], a[136:139], 0
s_add_u32 m0, s29, 65536
ds_read_b64_tr_b16 a[128:129], v4 offset:32768
v_mfma_f32_16x16x32_bf16 a[224:227], a[4:7], a[140:143], a[224:227]
buffer_load_dwordx4 v16, s[12:15], s26 offen offset:0 lds
v_mfma_f32_16x16x32_bf16 a[228:231], a[8:11], a[136:139], 0
ds_read_b64_tr_b16 a[130:131], v4 offset:34816
v_mfma_f32_16x16x32_bf16 a[228:231], a[12:15], a[140:143], a[228:231]
v_mfma_f32_16x16x32_bf16 a[232:235], a[16:19], a[136:139], 0
ds_read_b64_tr_b16 a[132:133], v4 offset:49152
v_mfma_f32_16x16x32_bf16 a[232:235], a[20:23], a[140:143], a[232:235]
buffer_load_dwordx4 v17, s[12:15], s26 offen offset:1024 lds
v_mfma_f32_16x16x32_bf16 a[236:239], a[24:27], a[136:139], 0
ds_read_b64_tr_b16 a[134:135], v4 offset:51200
v_mfma_f32_16x16x32_bf16 a[236:239], a[28:31], a[140:143], a[236:239]
v_mfma_f32_16x16x32_bf16 a[240:243], a[32:35], a[136:139], 0
v_mfma_f32_16x16x32_bf16 a[240:243], a[36:39], a[140:143], a[240:243]
buffer_load_dwordx4 v18, s[12:15], s26 offen offset:2048 lds
v_mfma_f32_16x16x32_bf16 a[244:247], a[40:43], a[136:139], 0
v_mfma_f32_16x16x32_bf16 a[244:247], a[44:47], a[140:143], a[244:247]
v_mfma_f32_16x16x32_bf16 a[248:251], a[48:51], a[136:139], 0
v_mfma_f32_16x16x32_bf16 a[248:251], a[52:55], a[140:143], a[248:251]
buffer_load_dwordx4 v19, s[12:15], s26 offen offset:3072 lds
v_mfma_f32_16x16x32_bf16 a[252:255], a[56:59], a[136:139], 0
s_add_u32 s26, s26, 524288
v_mfma_f32_16x16x32_bf16 a[252:255], a[60:63], a[140:143], a[252:255]
s_waitcnt lgkmcnt(0)
Lg_501:
v_mfma_f32_16x16x32_bf16 v[32:35], a[64:67], a[128:131], v[32:35]
s_add_u32 m0, s29, 81920
ds_read_b64_tr_b16 a[136:137], v5 offset:32768
v_mfma_f32_16x16x32_bf16 v[32:35], a[68:71], a[132:135], v[32:35]
buffer_load_dwordx4 v16, s[12:15], s27 offen offset:0 lds
v_mfma_f32_16x16x32_bf16 v[36:39], a[72:75], a[128:131], v[36:39]
ds_read_b64_tr_b16 a[138:139], v5 offset:34816
v_mfma_f32_16x16x32_bf16 v[36:39], a[76:79], a[132:135], v[36:39]
v_mfma_f32_16x16x32_bf16 v[40:43], a[80:83], a[128:131], v[40:43]
ds_read_b64_tr_b16 a[140:141], v5 offset:49152
v_mfma_f32_16x16x32_bf16 v[40:43], a[84:87], a[132:135], v[40:43]
buffer_load_dwordx4 v17, s[12:15], s27 offen offset:1024 lds
v_mfma_f32_16x16x32_bf16 v[44:47], a[88:91], a[128:131], v[44:47]
ds_read_b64_tr_b16 a[142:143], v5 offset:51200
v_mfma_f32_16x16x32_bf16 v[44:47], a[92:95], a[132:135], v[44:47]
v_mfma_f32_16x16x32_bf16 v[48:51], a[96:99], a[128:131], v[48:51]
ds_read_b128 a[0:3], v2 offset:0
v_mfma_f32_16x16x32_bf16 v[48:51], a[100:103], a[132:135], v[48:51]
buffer_load_dwordx4 v18, s[12:15], s27 offen offset:2048 lds
v_mfma_f32_16x16x32_bf16 v[52:55], a[104:107], a[128:131], v[52:55]
ds_read_b128 a[4:7], v3 offset:0
v_mfma_f32_16x16x32_bf16 v[52:55], a[108:111], a[132:135], v[52:55]
v_mfma_f32_16x16x32_bf16 v[56:59], a[112:115], a[128:131], v[56:59]
v_mfma_f32_16x16x32_bf16 v[56:59], a[116:119], a[132:135], v[56:59]
buffer_load_dwordx4 v19, s[12:15], s27 offen offset:3072 lds
v_mfma_f32_16x16x32_bf16 v[60:63], a[120:123], a[128:131], v[60:63]
s_add_u32 s27, s27, 524288
ds_read_b128 a[8:11], v2 offset:2048
v_mfma_f32_16x16x32_bf16 v[60:63], a[124:127], a[132:135], v[60:63]
s_waitcnt lgkmcnt(3)
v_mfma_f32_16x16x32_bf16 v[64:67], a[64:67], a[136:139], v[64:67]
s_add_u32 m0, s28, 32768
ds_read_b64_tr_b16 a[128:129], v6 offset:32768
v_mfma_f32_16x16x32_bf16 v[64:67], a[68:71], a[140:143], v[64:67]
buffer_load_dwordx4 v12, s[8:11], s24 offen offset:0 lds
v_mfma_f32_16x16x32_bf16 v[68:71], a[72:75], a[136:139], v[68:71]
ds_read_b64_tr_b16 a[130:131], v6 offset:34816
v_mfma_f32_16x16x32_bf16 v[68:71], a[76:79], a[140:143], v[68:71]
v_mfma_f32_16x16x32_bf16 v[72:75], a[80:83], a[136:139], v[72:75]
ds_read_b64_tr_b16 a[132:133], v6 offset:49152
v_mfma_f32_16x16x32_bf16 v[72:75], a[84:87], a[140:143], v[72:75]
buffer_load_dwordx4 v13, s[8:11], s24 offen offset:1024 lds
v_mfma_f32_16x16x32_bf16 v[76:79], a[88:91], a[136:139], v[76:79]
ds_read_b64_tr_b16 a[134:135], v6 offset:51200
v_mfma_f32_16x16x32_bf16 v[76:79], a[92:95], a[140:143], v[76:79]
v_mfma_f32_16x16x32_bf16 v[80:83], a[96:99], a[136:139], v[80:83]
ds_read_b128 a[12:15], v3 offset:2048
v_mfma_f32_16x16x32_bf16 v[80:83], a[100:103], a[140:143], v[80:83]
buffer_load_dwordx4 v14, s[8:11], s24 offen offset:2048 lds
v_mfma_f32_16x16x32_bf16 v[84:87], a[104:107], a[136:139], v[84:87]
v_mfma_f32_16x16x32_bf16 v[84:87], a[108:111], a[140:143], v[84:87]
v_mfma_f32_16x16x32_bf16 v[88:91], a[112:115], a[136:139], v[88:91]
ds_read_b128 a[16:19], v2 offset:4096
v_mfma_f32_16x16x32_bf16 v[88:91], a[116:119], a[140:143], v[88:91]
buffer_load_dwordx4 v15, s[8:11], s24 offen offset:3072 lds
v_mfma_f32_16x16x32_bf16 v[92:95], a[120:123], a[136:139], v[92:95]
s_add_u32 s24, s24, 128
ds_read_b128 a[20:23], v3 offset:4096
v_mfma_f32_16x16x32_bf16 v[92:95], a[124:127], a[140:143], v[92:95]
s_waitcnt lgkmcnt(3)
v_mfma_f32_16x16x32_bf16 v[96:99], a[64:67], a[128:131], v[96:99]
s_add_u32 m0, s28, 36864
ds_read_b64_tr_b16 a[136:137], v7 offset:32768
v_mfma_f32_16x16x32_bf16 v[96:99], a[68:71], a[132:135], v[96:99]
buffer_load_dwordx4 v12, s[8:11], s25 offen offset:0 lds
v_mfma_f32_16x16x32_bf16 v[100:103], a[72:75], a[128:131], v[100:103]
ds_read_b64_tr_b16 a[138:139], v7 offset:34816
v_mfma_f32_16x16x32_bf16 v[100:103], a[76:79], a[132:135], v[100:103]
v_mfma_f32_16x16x32_bf16 v[104:107], a[80:83], a[128:131], v[104:107]
ds_read_b64_tr_b16 a[140:141], v7 offset:49152
v_mfma_f32_16x16x32_bf16 v[104:107], a[84:87], a[132:135], v[104:107]
buffer_load_dwordx4 v13, s[8:11], s25 offen offset:1024 lds
v_mfma_f32_16x16x32_bf16 v[108:111], a[88:91], a[128:131], v[108:111]
ds_read_b64_tr_b16 a[142:143], v7 offset:51200
v_mfma_f32_16x16x32_bf16 v[108:111], a[92:95], a[132:135], v[108:111]
v_mfma_f32_16x16x32_bf16 v[112:115], a[96:99], a[128:131], v[112:115]
v_mfma_f32_16x16x32_bf16 v[112:115], a[100:103], a[132:135], v[112:115]
buffer_load_dwordx4 v14, s[8:11], s25 offen offset:2048 lds
v_mfma_f32_16x16x32_bf16 v[116:119], a[104:107], a[128:131], v[116:119]
ds_read_b128 a[24:27], v2 offset:6144
v_mfma_f32_16x16x32_bf16 v[116:119], a[108:111], a[132:135], v[116:119]
v_mfma_f32_16x16x32_bf16 v[120:123], a[112:115], a[128:131], v[120:123]
ds_read_b128 a[28:31], v3 offset:6144
v_mfma_f32_16x16x32_bf16 v[120:123], a[116:119], a[132:135], v[120:123]
buffer_load_dwordx4 v15, s[8:11], s25 offen offset:3072 lds
v_mfma_f32_16x16x32_bf16 v[124:127], a[120:123], a[128:131], v[124:127]
s_add_u32 s25, s25, 128
v_mfma_f32_16x16x32_bf16 v[124:127], a[124:127], a[132:135], v[124:127]
s_waitcnt lgkmcnt(2)
v_mfma_f32_16x16x32_bf16 v[128:131], a[64:67], a[136:139], v[128:131]
ds_read_b64_tr_b16 a[128:129], v8 offset:32768
v_mfma_f32_16x16x32_bf16 v[128:131], a[68:71], a[140:143], v[128:131]
buffer_load_dword v21, v20, s[16:19], s43 offen
v_mfma_f32_16x16x32_bf16 v[132:135], a[72:75], a[136:139], v[132:135]
s_add_u32 s43, s43, s47
ds_read_b64_tr_b16 a[130:131], v8 offset:34816
v_mfma_f32_16x16x32_bf16 v[132:135], a[76:79], a[140:143], v[132:135]
s_cmp_ge_u32 s43, s51
v_mfma_f32_16x16x32_bf16 v[136:139], a[80:83], a[136:139], v[136:139]
s_cselect_b32 s43, 0, s43
ds_read_b64_tr_b16 a[132:133], v8 offset:49152
v_mfma_f32_16x16x32_bf16 v[136:139], a[84:87], a[140:143], v[136:139]
s_cselect_b32 s51, s42, s51
v_mfma_f32_16x16x32_bf16 v[140:143], a[88:91], a[136:139], v[140:143]
s_cselect_b64 s[16:17], s[40:41], s[16:17]
ds_read_b64_tr_b16 a[134:135], v8 offset:51200
v_mfma_f32_16x16x32_bf16 v[140:143], a[92:95], a[140:143], v[140:143]
s_cselect_b32 s18, s42, s18
v_mfma_f32_16x16x32_bf16 v[144:147], a[96:99], a[136:139], v[144:147]
s_cselect_b64 s[40:41], s[44:45], s[40:41]
ds_read_b128 a[32:35], v2 offset:8192
v_mfma_f32_16x16x32_bf16 v[144:147], a[100:103], a[140:143], v[144:147]
s_cselect_b32 s42, s46, s42
v_mfma_f32_16x16x32_bf16 v[148:151], a[104:107], a[136:139], v[148:151]
s_cselect_b32 s46, 0, s46
v_mfma_f32_16x16x32_bf16 v[148:151], a[108:111], a[140:143], v[148:151]
s_cmp_eq_u32 s30, s55
v_mfma_f32_16x16x32_bf16 v[152:155], a[112:115], a[136:139], v[152:155]
s_cselect_b32 s22, 0, 3221225472
ds_read_b128 a[36:39], v3 offset:8192
v_mfma_f32_16x16x32_bf16 v[152:155], a[116:119], a[140:143], v[152:155]
s_sub_u32 s30, s30, 1
buffer_atomic_add v27, v26, s[60:63], s22 offen sc1
v_mfma_f32_16x16x32_bf16 v[156:159], a[120:123], a[136:139], v[156:159]
ds_read_b128 a[40:43], v2 offset:10240
v_mfma_f32_16x16x32_bf16 v[156:159], a[124:127], a[140:143], v[156:159]
s_waitcnt lgkmcnt(3)
v_mfma_f32_16x16x32_bf16 v[160:163], a[64:67], a[128:131], v[160:163]
ds_read_b64_tr_b16 a[136:137], v9 offset:32768
v_mfma_f32_16x16x32_bf16 v[160:163], a[68:71], a[132:135], v[160:163]
v_mfma_f32_16x16x32_bf16 v[164:167], a[72:75], a[128:131], v[164:167]
ds_read_b64_tr_b16 a[138:139], v9 offset:34816
v_mfma_f32_16x16x32_bf16 v[164:167], a[76:79], a[132:135], v[164:167]
v_mfma_f32_16x16x32_bf16 v[168:171], a[80:83], a[128:131], v[168:171]
ds_read_b64_tr_b16 a[140:141], v9 offset:49152
v_mfma_f32_16x16x32_bf16 v[168:171], a[84:87], a[132:135], v[168:171]
v_mfma_f32_16x16x32_bf16 v[172:175], a[88:91], a[128:131], v[172:175]
ds_read_b64_tr_b16 a[142:143], v9 offset:51200
v_mfma_f32_16x16x32_bf16 v[172:175], a[92:95], a[132:135], v[172:175]
v_mfma_f32_16x16x32_bf16 v[176:179], a[96:99], a[128:131], v[176:179]
v_mfma_f32_16x16x32_bf16 v[176:179], a[100:103], a[132:135], v[176:179]
v_mfma_f32_16x16x32_bf16 v[180:183], a[104:107], a[128:131], v[180:183]
ds_read_b128 a[44:47], v3 offset:10240
v_mfma_f32_16x16x32_bf16 v[180:183], a[108:111], a[132:135], v[180:183]
v_mfma_f32_16x16x32_bf16 v[184:187], a[112:115], a[128:131], v[184:187]
ds_read_b128 a[48:51], v2 offset:12288
v_mfma_f32_16x16x32_bf16 v[184:187], a[116:119], a[132:135], v[184:187]
v_mfma_f32_16x16x32_bf16 v[188:191], a[120:123], a[128:131], v[188:191]
v_mfma_f32_16x16x32_bf16 v[188:191], a[124:127], a[132:135], v[188:191]
s_waitcnt lgkmcnt(2)
v_mfma_f32_16x16x32_bf16 v[192:195], a[64:67], a[136:139], v[192:195]
ds_read_b64_tr_b16 a[128:129], v10 offset:32768
v_mfma_f32_16x16x32_bf16 v[192:195], a[68:71], a[140:143], v[192:195]
v_mfma_f32_16x16x32_bf16 v[196:199], a[72:75], a[136:139], v[196:199]
ds_read_b64_tr_b16 a[130:131], v10 offset:34816
v_mfma_f32_16x16x32_bf16 v[196:199], a[76:79], a[140:143], v[196:199]
v_mfma_f32_16x16x32_bf16 v[200:203], a[80:83], a[136:139], v[200:203]
ds_read_b64_tr_b16 a[132:133], v10 offset:49152
v_mfma_f32_16x16x32_bf16 v[200:203], a[84:87], a[140:143], v[200:203]
v_mfma_f32_16x16x32_bf16 v[204:207], a[88:91], a[136:139], v[204:207]
ds_read_b64_tr_b16 a[134:135], v10 offset:51200
v_mfma_f32_16x16x32_bf16 v[204:207], a[92:95], a[140:143], v[204:207]
v_mfma_f32_16x16x32_bf16 v[208:211], a[96:99], a[136:139], v[208:211]
ds_read_b128 a[52:55], v3 offset:12288
v_mfma_f32_16x16x32_bf16 v[208:211], a[100:103], a[140:143], v[208:211]
v_mfma_f32_16x16x32_bf16 v[212:215], a[104:107], a[136:139], v[212:215]
ds_read_b128 a[56:59], v2 offset:14336
v_mfma_f32_16x16x32_bf16 v[212:215], a[108:111], a[140:143], v[212:215]
v_mfma_f32_16x16x32_bf16 v[216:219], a[112:115], a[136:139], v[216:219]
v_mfma_f32_16x16x32_bf16 v[216:219], a[116:119], a[140:143], v[216:219]
v_mfma_f32_16x16x32_bf16 v[220:223], a[120:123], a[136:139], v[220:223]
ds_read_b128 a[60:63], v3 offset:14336
v_mfma_f32_16x16x32_bf16 v[220:223], a[124:127], a[140:143], v[220:223]
s_waitcnt lgkmcnt(3)
v_mfma_f32_16x16x32_bf16 a[192:195], a[64:67], a[128:131], a[192:195]
ds_read_b64_tr_b16 a[136:137], v11 offset:32768
v_mfma_f32_16x16x32_bf16 a[192:195], a[68:71], a[132:135], a[192:195]
v_mfma_f32_16x16x32_bf16 a[196:199], a[72:75], a[128:131], a[196:199]
ds_read_b64_tr_b16 a[138:139], v11 offset:34816
v_mfma_f32_16x16x32_bf16 a[196:199], a[76:79], a[132:135], a[196:199]
v_mfma_f32_16x16x32_bf16 a[200:203], a[80:83], a[128:131], a[200:203]
ds_read_b64_tr_b16 a[140:141], v11 offset:49152
v_mfma_f32_16x16x32_bf16 a[200:203], a[84:87], a[132:135], a[200:203]
v_mfma_f32_16x16x32_bf16 a[204:207], a[88:91], a[128:131], a[204:207]
ds_read_b64_tr_b16 a[142:143], v11 offset:51200
v_mfma_f32_16x16x32_bf16 a[204:207], a[92:95], a[132:135], a[204:207]
v_mfma_f32_16x16x32_bf16 a[208:211], a[96:99], a[128:131], a[208:211]
v_mfma_f32_16x16x32_bf16 a[208:211], a[100:103], a[132:135], a[208:211]
v_mfma_f32_16x16x32_bf16 a[212:215], a[104:107], a[128:131], a[212:215]
v_mfma_f32_16x16x32_bf16 a[212:215], a[108:111], a[132:135], a[212:215]
v_mfma_f32_16x16x32_bf16 a[216:219], a[112:115], a[128:131], a[216:219]
v_mfma_f32_16x16x32_bf16 a[216:219], a[116:119], a[132:135], a[216:219]
v_mfma_f32_16x16x32_bf16 a[220:223], a[120:123], a[128:131], a[220:223]
s_waitcnt vmcnt(2) lgkmcnt(0)
v_mfma_f32_16x16x32_bf16 a[220:223], a[124:127], a[132:135], a[220:223]
s_barrier
v_mfma_f32_16x16x32_bf16 a[224:227], a[64:67], a[136:139], a[224:227]
s_add_u32 m0, s29, 98304
ds_read_b64_tr_b16 a[128:129], v4 offset:0
v_mfma_f32_16x16x32_bf16 a[224:227], a[68:71], a[140:143], a[224:227]
buffer_load_dwordx4 v16, s[12:15], s26 offen offset:0 lds
v_mfma_f32_16x16x32_bf16 a[228:231], a[72:75], a[136:139], a[228:231]
ds_read_b64_tr_b16 a[130:131], v4 offset:2048
v_mfma_f32_16x16x32_bf16 a[228:231], a[76:79], a[140:143], a[228:231]
v_mfma_f32_16x16x32_bf16 a[232:235], a[80:83], a[136:139], a[232:235]
ds_read_b64_tr_b16 a[132:133], v4 offset:16384
v_mfma_f32_16x16x32_bf16 a[232:235], a[84:87], a[140:143], a[232:235]
buffer_load_dwordx4 v17, s[12:15], s26 offen offset:1024 lds
v_mfma_f32_16x16x32_bf16 a[236:239], a[88:91], a[136:139], a[236:239]
ds_read_b64_tr_b16 a[134:135], v4 offset:18432
v_mfma_f32_16x16x32_bf16 a[236:239], a[92:95], a[140:143], a[236:239]
v_mfma_f32_16x16x32_bf16 a[240:243], a[96:99], a[136:139], a[240:243]
v_mfma_f32_16x16x32_bf16 a[240:243], a[100:103], a[140:143], a[240:243]
buffer_load_dwordx4 v18, s[12:15], s26 offen offset:2048 lds
v_mfma_f32_16x16x32_bf16 a[244:247], a[104:107], a[136:139], a[244:247]
v_mfma_f32_16x16x32_bf16 a[244:247], a[108:111], a[140:143], a[244:247]
v_mfma_f32_16x16x32_bf16 a[248:251], a[112:115], a[136:139], a[248:251]
v_mfma_f32_16x16x32_bf16 a[248:251], a[116:119], a[140:143], a[248:251]
buffer_load_dwordx4 v19, s[12:15], s26 offen offset:3072 lds
v_mfma_f32_16x16x32_bf16 a[252:255], a[120:123], a[136:139], a[252:255]
s_add_u32 s26, s26, 524288
v_mfma_f32_16x16x32_bf16 a[252:255], a[124:127], a[140:143], a[252:255]
s_waitcnt lgkmcnt(0)
buffer_store_dword v27, v26, s[4:7], s82 offen sc1
v_mfma_f32_16x16x32_bf16 v[32:35], a[0:3], a[128:131], v[32:35]
s_add_u32 m0, s29, 114688
ds_read_b64_tr_b16 a[136:137], v5 offset:0
v_mfma_f32_16x16x32_bf16 v[32:35], a[4:7], a[132:135], v[32:35]
buffer_load_dwordx4 v16, s[12:15], s27 offen offset:0 lds
v_mfma_f32_16x16x32_bf16 v[36:39], a[8:11], a[128:131], v[36:39]
ds_read_b64_tr_b16 a[138:139], v5 offset:2048
v_mfma_f32_16x16x32_bf16 v[36:39], a[12:15], a[132:135], v[36:39]
v_mfma_f32_16x16x32_bf16 v[40:43], a[16:19], a[128:131], v[40:43]
ds_read_b64_tr_b16 a[140:141], v5 offset:16384
v_mfma_f32_16x16x32_bf16 v[40:43], a[20:23], a[132:135], v[40:43]
buffer_load_dwordx4 v17, s[12:15], s27 offen offset:1024 lds
v_mfma_f32_16x16x32_bf16 v[44:47], a[24:27], a[128:131], v[44:47]
ds_read_b64_tr_b16 a[142:143], v5 offset:18432
v_mfma_f32_16x16x32_bf16 v[44:47], a[28:31], a[132:135], v[44:47]
v_mfma_f32_16x16x32_bf16 v[48:51], a[32:35], a[128:131], v[48:51]
ds_read_b128 a[64:67], v2 offset:32768
v_mfma_f32_16x16x32_bf16 v[48:51], a[36:39], a[132:135], v[48:51]
buffer_load_dwordx4 v18, s[12:15], s27 offen offset:2048 lds
v_mfma_f32_16x16x32_bf16 v[52:55], a[40:43], a[128:131], v[52:55]
ds_read_b128 a[68:71], v3 offset:32768
v_mfma_f32_16x16x32_bf16 v[52:55], a[44:47], a[132:135], v[52:55]
v_mfma_f32_16x16x32_bf16 v[56:59], a[48:51], a[128:131], v[56:59]
v_mfma_f32_16x16x32_bf16 v[56:59], a[52:55], a[132:135], v[56:59]
buffer_load_dwordx4 v19, s[12:15], s27 offen offset:3072 lds
v_mfma_f32_16x16x32_bf16 v[60:63], a[56:59], a[128:131], v[60:63]
s_add_u32 s27, s27, 524288
ds_read_b128 a[72:75], v2 offset:34816
v_mfma_f32_16x16x32_bf16 v[60:63], a[60:63], a[132:135], v[60:63]
s_waitcnt lgkmcnt(3)
v_mfma_f32_16x16x32_bf16 v[64:67], a[0:3], a[136:139], v[64:67]
s_add_u32 m0, s28, 0
ds_read_b64_tr_b16 a[128:129], v6 offset:0
v_mfma_f32_16x16x32_bf16 v[64:67], a[4:7], a[140:143], v[64:67]
buffer_load_dwordx4 v12, s[8:11], s24 offen offset:0 lds
v_mfma_f32_16x16x32_bf16 v[68:71], a[8:11], a[136:139], v[68:71]
ds_read_b64_tr_b16 a[130:131], v6 offset:2048
v_mfma_f32_16x16x32_bf16 v[68:71], a[12:15], a[140:143], v[68:71]
v_mfma_f32_16x16x32_bf16 v[72:75], a[16:19], a[136:139], v[72:75]
ds_read_b64_tr_b16 a[132:133], v6 offset:16384
v_mfma_f32_16x16x32_bf16 v[72:75], a[20:23], a[140:143], v[72:75]
buffer_load_dwordx4 v13, s[8:11], s24 offen offset:1024 lds
v_mfma_f32_16x16x32_bf16 v[76:79], a[24:27], a[136:139], v[76:79]
ds_read_b64_tr_b16 a[134:135], v6 offset:18432
v_mfma_f32_16x16x32_bf16 v[76:79], a[28:31], a[140:143], v[76:79]
v_mfma_f32_16x16x32_bf16 v[80:83], a[32:35], a[136:139], v[80:83]
ds_read_b128 a[76:79], v3 offset:34816
v_mfma_f32_16x16x32_bf16 v[80:83], a[36:39], a[140:143], v[80:83]
buffer_load_dwordx4 v14, s[8:11], s24 offen offset:2048 lds
v_mfma_f32_16x16x32_bf16 v[84:87], a[40:43], a[136:139], v[84:87]
v_mfma_f32_16x16x32_bf16 v[84:87], a[44:47], a[140:143], v[84:87]
v_mfma_f32_16x16x32_bf16 v[88:91], a[48:51], a[136:139], v[88:91]
ds_read_b128 a[80:83], v2 offset:36864
v_mfma_f32_16x16x32_bf16 v[88:91], a[52:55], a[140:143], v[88:91]
buffer_load_dwordx4 v15, s[8:11], s24 offen offset:3072 lds
v_mfma_f32_16x16x32_bf16 v[92:95], a[56:59], a[136:139], v[92:95]
s_add_u32 s24, s24, 128
ds_read_b128 a[84:87], v3 offset:36864
v_mfma_f32_16x16x32_bf16 v[92:95], a[60:63], a[140:143], v[92:95]
s_waitcnt lgkmcnt(3)
v_mfma_f32_16x16x32_bf16 v[96:99], a[0:3], a[128:131], v[96:99]
s_add_u32 m0, s28, 4096
ds_read_b64_tr_b16 a[136:137], v7 offset:0
v_mfma_f32_16x16x32_bf16 v[96:99], a[4:7], a[132:135], v[96:99]
buffer_load_dwordx4 v12, s[8:11], s25 offen offset:0 lds
v_mfma_f32_16x16x32_bf16 v[100:103], a[8:11], a[128:131], v[100:103]
ds_read_b64_tr_b16 a[138:139], v7 offset:2048
v_mfma_f32_16x16x32_bf16 v[100:103], a[12:15], a[132:135], v[100:103]
v_mfma_f32_16x16x32_bf16 v[104:107], a[16:19], a[128:131], v[104:107]
ds_read_b64_tr_b16 a[140:141], v7 offset:16384
v_mfma_f32_16x16x32_bf16 v[104:107], a[20:23], a[132:135], v[104:107]
buffer_load_dwordx4 v13, s[8:11], s25 offen offset:1024 lds
v_mfma_f32_16x16x32_bf16 v[108:111], a[24:27], a[128:131], v[108:111]
ds_read_b64_tr_b16 a[142:143], v7 offset:18432
v_mfma_f32_16x16x32_bf16 v[108:111], a[28:31], a[132:135], v[108:111]
v_mfma_f32_16x16x32_bf16 v[112:115], a[32:35], a[128:131], v[112:115]
v_mfma_f32_16x16x32_bf16 v[112:115], a[36:39], a[132:135], v[112:115]
buffer_load_dwordx4 v14, s[8:11], s25 offen offset:2048 lds
v_mfma_f32_16x16x32_bf16 v[116:119], a[40:43], a[128:131], v[116:119]
ds_read_b128 a[88:91], v2 offset:38912
v_mfma_f32_16x16x32_bf16 v[116:119], a[44:47], a[132:135], v[116:119]
v_mfma_f32_16x16x32_bf16 v[120:123], a[48:51], a[128:131], v[120:123]
ds_read_b128 a[92:95], v3 offset:38912
v_mfma_f32_16x16x32_bf16 v[120:123], a[52:55], a[132:135], v[120:123]
buffer_load_dwordx4 v15, s[8:11], s25 offen offset:3072 lds
v_mfma_f32_16x16x32_bf16 v[124:127], a[56:59], a[128:131], v[124:127]
s_add_u32 s25, s25, 128
v_mfma_f32_16x16x32_bf16 v[124:127], a[60:63], a[132:135], v[124:127]
s_waitcnt lgkmcnt(2)
v_mfma_f32_16x16x32_bf16 v[128:131], a[0:3], a[136:139], v[128:131]
ds_read_b64_tr_b16 a[128:129], v8 offset:0
v_mfma_f32_16x16x32_bf16 v[128:131], a[4:7], a[140:143], v[128:131]
buffer_load_dword v21, v20, s[16:19], s43 offen
v_mfma_f32_16x16x32_bf16 v[132:135], a[8:11], a[136:139], v[132:135]
s_add_u32 s43, s43, s47
ds_read_b64_tr_b16 a[130:131], v8 offset:2048
v_mfma_f32_16x16x32_bf16 v[132:135], a[12:15], a[140:143], v[132:135]
s_cmp_ge_u32 s43, s51
v_mfma_f32_16x16x32_bf16 v[136:139], a[16:19], a[136:139], v[136:139]
s_cselect_b32 s43, 0, s43
ds_read_b64_tr_b16 a[132:133], v8 offset:16384
v_mfma_f32_16x16x32_bf16 v[136:139], a[20:23], a[140:143], v[136:139]
s_cselect_b32 s51, s42, s51
v_mfma_f32_16x16x32_bf16 v[140:143], a[24:27], a[136:139], v[140:143]
s_cselect_b64 s[16:17], s[40:41], s[16:17]
ds_read_b64_tr_b16 a[134:135], v8 offset:18432
v_mfma_f32_16x16x32_bf16 v[140:143], a[28:31], a[140:143], v[140:143]
s_cselect_b32 s18, s42, s18
v_mfma_f32_16x16x32_bf16 v[144:147], a[32:35], a[136:139], v[144:147]
s_cselect_b64 s[40:41], s[44:45], s[40:41]
ds_read_b128 a[96:99], v2 offset:40960
v_mfma_f32_16x16x32_bf16 v[144:147], a[36:39], a[140:143], v[144:147]
s_cselect_b32 s42, s46, s42
v_mfma_f32_16x16x32_bf16 v[148:151], a[40:43], a[136:139], v[148:151]
s_cselect_b32 s46, 0, s46
v_mfma_f32_16x16x32_bf16 v[148:151], a[44:47], a[140:143], v[148:151]
s_cmp_eq_u32 s30, s55
v_mfma_f32_16x16x32_bf16 v[152:155], a[48:51], a[136:139], v[152:155]
s_cselect_b32 s22, 0, 3221225472
ds_read_b128 a[100:103], v3 offset:40960
v_mfma_f32_16x16x32_bf16 v[152:155], a[52:55], a[140:143], v[152:155]
s_sub_u32 s30, s30, 1
buffer_atomic_add v27, v26, s[60:63], s22 offen sc1
v_mfma_f32_16x16x32_bf16 v[156:159], a[56:59], a[136:139], v[156:159]
ds_read_b128 a[104:107], v2 offset:43008
v_mfma_f32_16x16x32_bf16 v[156:159], a[60:63], a[140:143], v[156:159]
s_waitcnt lgkmcnt(3)
v_mfma_f32_16x16x32_bf16 v[160:163], a[0:3], a[128:131], v[160:163]
ds_read_b64_tr_b16 a[136:137], v9 offset:0
v_mfma_f32_16x16x32_bf16 v[160:163], a[4:7], a[132:135], v[160:163]
v_mfma_f32_16x16x32_bf16 v[164:167], a[8:11], a[128:131], v[164:167]
ds_read_b64_tr_b16 a[138:139], v9 offset:2048
v_mfma_f32_16x16x32_bf16 v[164:167], a[12:15], a[132:135], v[164:167]
v_mfma_f32_16x16x32_bf16 v[168:171], a[16:19], a[128:131], v[168:171]
ds_read_b64_tr_b16 a[140:141], v9 offset:16384
v_mfma_f32_16x16x32_bf16 v[168:171], a[20:23], a[132:135], v[168:171]
v_mfma_f32_16x16x32_bf16 v[172:175], a[24:27], a[128:131], v[172:175]
ds_read_b64_tr_b16 a[142:143], v9 offset:18432
v_mfma_f32_16x16x32_bf16 v[172:175], a[28:31], a[132:135], v[172:175]
v_mfma_f32_16x16x32_bf16 v[176:179], a[32:35], a[128:131], v[176:179]
v_mfma_f32_16x16x32_bf16 v[176:179], a[36:39], a[132:135], v[176:179]
v_mfma_f32_16x16x32_bf16 v[180:183], a[40:43], a[128:131], v[180:183]
ds_read_b128 a[108:111], v3 offset:43008
v_mfma_f32_16x16x32_bf16 v[180:183], a[44:47], a[132:135], v[180:183]
v_mfma_f32_16x16x32_bf16 v[184:187], a[48:51], a[128:131], v[184:187]
ds_read_b128 a[112:115], v2 offset:45056
v_mfma_f32_16x16x32_bf16 v[184:187], a[52:55], a[132:135], v[184:187]
v_mfma_f32_16x16x32_bf16 v[188:191], a[56:59], a[128:131], v[188:191]
v_mfma_f32_16x16x32_bf16 v[188:191], a[60:63], a[132:135], v[188:191]
s_waitcnt lgkmcnt(2)
v_mfma_f32_16x16x32_bf16 v[192:195], a[0:3], a[136:139], v[192:195]
ds_read_b64_tr_b16 a[128:129], v10 offset:0
v_mfma_f32_16x16x32_bf16 v[192:195], a[4:7], a[140:143], v[192:195]
v_mfma_f32_16x16x32_bf16 v[196:199], a[8:11], a[136:139], v[196:199]
ds_read_b64_tr_b16 a[130:131], v10 offset:2048
v_mfma_f32_16x16x32_bf16 v[196:199], a[12:15], a[140:143], v[196:199]
v_mfma_f32_16x16x32_bf16 v[200:203], a[16:19], a[136:139], v[200:203]
ds_read_b64_tr_b16 a[132:133], v10 offset:16384
v_mfma_f32_16x16x32_bf16 v[200:203], a[20:23], a[140:143], v[200:203]
v_mfma_f32_16x16x32_bf16 v[204:207], a[24:27], a[136:139], v[204:207]
ds_read_b64_tr_b16 a[134:135], v10 offset:18432
v_mfma_f32_16x16x32_bf16 v[204:207], a[28:31], a[140:143], v[204:207]
v_mfma_f32_16x16x32_bf16 v[208:211], a[32:35], a[136:139], v[208:211]
ds_read_b128 a[116:119], v3 offset:45056
v_mfma_f32_16x16x32_bf16 v[208:211], a[36:39], a[140:143], v[208:211]
v_mfma_f32_16x16x32_bf16 v[212:215], a[40:43], a[136:139], v[212:215]
ds_read_b128 a[120:123], v2 offset:47104
v_mfma_f32_16x16x32_bf16 v[212:215], a[44:47], a[140:143], v[212:215]
v_mfma_f32_16x16x32_bf16 v[216:219], a[48:51], a[136:139], v[216:219]
v_mfma_f32_16x16x32_bf16 v[216:219], a[52:55], a[140:143], v[216:219]
v_mfma_f32_16x16x32_bf16 v[220:223], a[56:59], a[136:139], v[220:223]
ds_read_b128 a[124:127], v3 offset:47104
v_mfma_f32_16x16x32_bf16 v[220:223], a[60:63], a[140:143], v[220:223]
s_waitcnt lgkmcnt(3)
v_mfma_f32_16x16x32_bf16 a[192:195], a[0:3], a[128:131], a[192:195]
ds_read_b64_tr_b16 a[136:137], v11 offset:0
v_mfma_f32_16x16x32_bf16 a[192:195], a[4:7], a[132:135], a[192:195]
v_mfma_f32_16x16x32_bf16 a[196:199], a[8:11], a[128:131], a[196:199]
ds_read_b64_tr_b16 a[138:139], v11 offset:2048
v_mfma_f32_16x16x32_bf16 a[196:199], a[12:15], a[132:135], a[196:199]
v_mfma_f32_16x16x32_bf16 a[200:203], a[16:19], a[128:131], a[200:203]
ds_read_b64_tr_b16 a[140:141], v11 offset:16384
v_mfma_f32_16x16x32_bf16 a[200:203], a[20:23], a[132:135], a[200:203]
v_mfma_f32_16x16x32_bf16 a[204:207], a[24:27], a[128:131], a[204:207]
ds_read_b64_tr_b16 a[142:143], v11 offset:18432
v_mfma_f32_16x16x32_bf16 a[204:207], a[28:31], a[132:135], a[204:207]
v_mfma_f32_16x16x32_bf16 a[208:211], a[32:35], a[128:131], a[208:211]
v_mfma_f32_16x16x32_bf16 a[208:211], a[36:39], a[132:135], a[208:211]
v_mfma_f32_16x16x32_bf16 a[212:215], a[40:43], a[128:131], a[212:215]
v_mfma_f32_16x16x32_bf16 a[212:215], a[44:47], a[132:135], a[212:215]
v_mfma_f32_16x16x32_bf16 a[216:219], a[48:51], a[128:131], a[216:219]
v_mfma_f32_16x16x32_bf16 a[216:219], a[52:55], a[132:135], a[216:219]
v_mfma_f32_16x16x32_bf16 a[220:223], a[56:59], a[128:131], a[220:223]
s_waitcnt vmcnt(2) lgkmcnt(0)
v_mfma_f32_16x16x32_bf16 a[220:223], a[60:63], a[132:135], a[220:223]
s_barrier
v_mfma_f32_16x16x32_bf16 a[224:227], a[0:3], a[136:139], a[224:227]
s_add_u32 m0, s29, 65536
ds_read_b64_tr_b16 a[128:129], v4 offset:32768
v_mfma_f32_16x16x32_bf16 a[224:227], a[4:7], a[140:143], a[224:227]
buffer_load_dwordx4 v16, s[12:15], s26 offen offset:0 lds
v_mfma_f32_16x16x32_bf16 a[228:231], a[8:11], a[136:139], a[228:231]
ds_read_b64_tr_b16 a[130:131], v4 offset:34816
v_mfma_f32_16x16x32_bf16 a[228:231], a[12:15], a[140:143], a[228:231]
v_mfma_f32_16x16x32_bf16 a[232:235], a[16:19], a[136:139], a[232:235]
ds_read_b64_tr_b16 a[132:133], v4 offset:49152
v_mfma_f32_16x16x32_bf16 a[232:235], a[20:23], a[140:143], a[232:235]
buffer_load_dwordx4 v17, s[12:15], s26 offen offset:1024 lds
v_mfma_f32_16x16x32_bf16 a[236:239], a[24:27], a[136:139], a[236:239]
ds_read_b64_tr_b16 a[134:135], v4 offset:51200
v_mfma_f32_16x16x32_bf16 a[236:239], a[28:31], a[140:143], a[236:239]
v_mfma_f32_16x16x32_bf16 a[240:243], a[32:35], a[136:139], a[240:243]
v_mfma_f32_16x16x32_bf16 a[240:243], a[36:39], a[140:143], a[240:243]
buffer_load_dwordx4 v18, s[12:15], s26 offen offset:2048 lds
v_mfma_f32_16x16x32_bf16 a[244:247], a[40:43], a[136:139], a[244:247]
v_mfma_f32_16x16x32_bf16 a[244:247], a[44:47], a[140:143], a[244:247]
v_mfma_f32_16x16x32_bf16 a[248:251], a[48:51], a[136:139], a[248:251]
v_mfma_f32_16x16x32_bf16 a[248:251], a[52:55], a[140:143], a[248:251]
s_waitcnt lgkmcnt(0)
buffer_load_dwordx4 v19, s[12:15], s26 offen offset:3072 lds
v_mfma_f32_16x16x32_bf16 a[252:255], a[56:59], a[136:139], a[252:255]
s_add_u32 s26, s26, 524288
s_bitcmp1_b32 s30, 1
v_mfma_f32_16x16x32_bf16 a[252:255], a[60:63], a[140:143], a[252:255]
s_cbranch_scc1 Lg_501
s_cmp_eq_u32 s30, 0
s_cbranch_scc1 Lg_501t
v_mfma_f32_16x16x32_bf16 v[32:35], a[64:67], a[128:131], v[32:35]
s_add_u32 m0, s29, 81920
ds_read_b64_tr_b16 a[136:137], v5 offset:32768
v_mfma_f32_16x16x32_bf16 v[32:35], a[68:71], a[132:135], v[32:35]
buffer_load_dwordx4 v16, s[12:15], s27 offen offset:0 lds
v_mfma_f32_16x16x32_bf16 v[36:39], a[72:75], a[128:131], v[36:39]
s_lshl_b32 s22, s38, 3
ds_read_b64_tr_b16 a[138:139], v5 offset:34816
v_mfma_f32_16x16x32_bf16 v[36:39], a[76:79], a[132:135], v[36:39]
s_lshl_b32 s23, s39, 5
v_and_b32 v252, 31, v0
v_lshrrev_b32 v253, 5, v0
v_mfma_f32_16x16x32_bf16 v[40:43], a[80:83], a[128:131], v[40:43]
ds_read_b64_tr_b16 a[140:141], v5 offset:49152
v_add_u32 v253, s22, v253
v_mfma_f32_16x16x32_bf16 v[40:43], a[84:87], a[132:135], v[40:43]
buffer_load_dwordx4 v17, s[12:15], s27 offen offset:1024 lds
v_mfma_f32_16x16x32_bf16 v[44:47], a[88:91], a[128:131], v[44:47]
ds_read_b64_tr_b16 a[142:143], v5 offset:51200
v_add_u32 v252, s23, v252
v_mfma_f32_16x16x32_bf16 v[44:47], a[92:95], a[132:135], v[44:47]
v_mul_u32_u24 v254, 7168, v253
v_lshl_add_u32 v254, v252, 2, v254
v_mfma_f32_16x16x32_bf16 v[48:51], a[96:99], a[128:131], v[48:51]
ds_read_b128 a[0:3], v2 offset:0
v_lshlrev_b32 v252, 4, v252
v_mfma_f32_16x16x32_bf16 v[48:51], a[100:103], a[132:135], v[48:51]
buffer_load_dwordx4 v18, s[12:15], s27 offen offset:2048 lds
v_mfma_f32_16x16x32_bf16 v[52:55], a[104:107], a[128:131], v[52:55]
ds_read_b128 a[4:7], v3 offset:0
v_add_u32 v255, 3584, v254
v_mfma_f32_16x16x32_bf16 v[52:55], a[108:111], a[132:135], v[52:55]
v_subrev_u32 v22, 3584, v254
v_subrev_u32 v23, 2688, v254
v_mfma_f32_16x16x32_bf16 v[56:59], a[112:115], a[128:131], v[56:59]
v_subrev_u32 v24, 1792, v254
v_subrev_u32 v25, 896, v254
v_mfma_f32_16x16x32_bf16 v[56:59], a[116:119], a[132:135], v[56:59]
buffer_load_dwordx4 v19, s[12:15], s27 offen offset:3072 lds
v_mfma_f32_16x16x32_bf16 v[60:63], a[120:123], a[128:131], v[60:63]
s_add_u32 s27, s27, 524288
ds_read_b128 a[8:11], v2 offset:2048
v_mfma_f32_16x16x32_bf16 v[60:63], a[124:127], a[132:135], v[60:63]
PAD_23:
s_cbranch_execz PAD_27
s_waitcnt lgkmcnt(3)
v_mfma_f32_16x16x32_bf16 v[64:67], a[64:67], a[136:139], v[64:67]
s_add_u32 m0, s28, 32768
ds_read_b64_tr_b16 a[128:129], v6 offset:32768
v_mfma_f32_16x16x32_bf16 v[64:67], a[68:71], a[140:143], v[64:67]
buffer_load_dwordx4 v12, s[8:11], s24 offen offset:0 lds
v_mfma_f32_16x16x32_bf16 v[68:71], a[72:75], a[136:139], v[68:71]
ds_read_b64_tr_b16 a[130:131], v6 offset:34816
v_mfma_f32_16x16x32_bf16 v[68:71], a[76:79], a[140:143], v[68:71]
v_mfma_f32_16x16x32_bf16 v[72:75], a[80:83], a[136:139], v[72:75]
ds_read_b64_tr_b16 a[132:133], v6 offset:49152
v_mfma_f32_16x16x32_bf16 v[72:75], a[84:87], a[140:143], v[72:75]
buffer_load_dwordx4 v13, s[8:11], s24 offen offset:1024 lds
v_mfma_f32_16x16x32_bf16 v[76:79], a[88:91], a[136:139], v[76:79]
ds_read_b64_tr_b16 a[134:135], v6 offset:51200
v_mfma_f32_16x16x32_bf16 v[76:79], a[92:95], a[140:143], v[76:79]
v_mfma_f32_16x16x32_bf16 v[80:83], a[96:99], a[136:139], v[80:83]
ds_read_b128 a[12:15], v3 offset:2048
v_mfma_f32_16x16x32_bf16 v[80:83], a[100:103], a[140:143], v[80:83]
buffer_load_dwordx4 v14, s[8:11], s24 offen offset:2048 lds
v_mfma_f32_16x16x32_bf16 v[84:87], a[104:107], a[136:139], v[84:87]
v_mfma_f32_16x16x32_bf16 v[84:87], a[108:111], a[140:143], v[84:87]
v_mfma_f32_16x16x32_bf16 v[88:91], a[112:115], a[136:139], v[88:91]
ds_read_b128 a[16:19], v2 offset:4096
v_mfma_f32_16x16x32_bf16 v[88:91], a[116:119], a[140:143], v[88:91]
buffer_load_dwordx4 v15, s[8:11], s24 offen offset:3072 lds
v_mfma_f32_16x16x32_bf16 v[92:95], a[120:123], a[136:139], v[92:95]
s_add_u32 s24, s24, 128
ds_read_b128 a[20:23], v3 offset:4096
v_mfma_f32_16x16x32_bf16 v[92:95], a[124:127], a[140:143], v[92:95]
s_waitcnt lgkmcnt(3)
v_mfma_f32_16x16x32_bf16 v[96:99], a[64:67], a[128:131], v[96:99]
s_add_u32 m0, s28, 36864
ds_read_b64_tr_b16 a[136:137], v7 offset:32768
v_mfma_f32_16x16x32_bf16 v[96:99], a[68:71], a[132:135], v[96:99]
buffer_load_dwordx4 v12, s[8:11], s25 offen offset:0 lds
v_mfma_f32_16x16x32_bf16 v[100:103], a[72:75], a[128:131], v[100:103]
ds_read_b64_tr_b16 a[138:139], v7 offset:34816
v_mfma_f32_16x16x32_bf16 v[100:103], a[76:79], a[132:135], v[100:103]
v_mfma_f32_16x16x32_bf16 v[104:107], a[80:83], a[128:131], v[104:107]
ds_read_b64_tr_b16 a[140:141], v7 offset:49152
v_mfma_f32_16x16x32_bf16 v[104:107], a[84:87], a[132:135], v[104:107]
buffer_load_dwordx4 v13, s[8:11], s25 offen offset:1024 lds
v_mfma_f32_16x16x32_bf16 v[108:111], a[88:91], a[128:131], v[108:111]
ds_read_b64_tr_b16 a[142:143], v7 offset:51200
v_mfma_f32_16x16x32_bf16 v[108:111], a[92:95], a[132:135], v[108:111]
v_mfma_f32_16x16x32_bf16 v[112:115], a[96:99], a[128:131], v[112:115]
v_mfma_f32_16x16x32_bf16 v[112:115], a[100:103], a[132:135], v[112:115]
buffer_load_dwordx4 v14, s[8:11], s25 offen offset:2048 lds
v_mfma_f32_16x16x32_bf16 v[116:119], a[104:107], a[128:131], v[116:119]
ds_read_b128 a[24:27], v2 offset:6144
v_mfma_f32_16x16x32_bf16 v[116:119], a[108:111], a[132:135], v[116:119]
v_mfma_f32_16x16x32_bf16 v[120:123], a[112:115], a[128:131], v[120:123]
ds_read_b128 a[28:31], v3 offset:6144
v_mfma_f32_16x16x32_bf16 v[120:123], a[116:119], a[132:135], v[120:123]
buffer_load_dwordx4 v15, s[8:11], s25 offen offset:3072 lds
v_mfma_f32_16x16x32_bf16 v[124:127], a[120:123], a[128:131], v[124:127]
s_add_u32 s25, s25, 128
v_mfma_f32_16x16x32_bf16 v[124:127], a[124:127], a[132:135], v[124:127]
s_waitcnt lgkmcnt(2)
v_mfma_f32_16x16x32_bf16 v[128:131], a[64:67], a[136:139], v[128:131]
s_mov_b64 s[56:57], s[70:71]
s_mov_b32 s58, 3584
s_mov_b32 s59, 0x20000
ds_read_b64_tr_b16 a[128:129], v8 offset:32768
v_mfma_f32_16x16x32_bf16 v[128:131], a[68:71], a[140:143], v[128:131]
buffer_load_dwordx4 v[248:251], v252, s[56:59], 0 offen
v_mfma_f32_16x16x32_bf16 v[132:135], a[72:75], a[136:139], v[132:135]
s_mov_b64 s[56:57], s[66:67]
s_mov_b32 s58, 1835008
ds_read_b64_tr_b16 a[130:131], v8 offset:34816
v_mfma_f32_16x16x32_bf16 v[132:135], a[76:79], a[140:143], v[132:135]
buffer_load_dword v224, v22, s[56:59], 0 offen nt
v_mfma_f32_16x16x32_bf16 v[136:139], a[80:83], a[136:139], v[136:139]
ds_read_b64_tr_b16 a[132:133], v8 offset:49152
v_mfma_f32_16x16x32_bf16 v[136:139], a[84:87], a[140:143], v[136:139]
buffer_load_dword v225, v23, s[56:59], 0 offen nt
v_mfma_f32_16x16x32_bf16 v[140:143], a[88:91], a[136:139], v[140:143]
ds_read_b64_tr_b16 a[134:135], v8 offset:51200
v_mfma_f32_16x16x32_bf16 v[140:143], a[92:95], a[140:143], v[140:143]
buffer_load_dword v226, v24, s[56:59], 0 offen nt
v_mfma_f32_16x16x32_bf16 v[144:147], a[96:99], a[136:139], v[144:147]
ds_read_b128 a[32:35], v2 offset:8192
v_mfma_f32_16x16x32_bf16 v[144:147], a[100:103], a[140:143], v[144:147]
buffer_load_dword v227, v25, s[56:59], 0 offen nt
v_mfma_f32_16x16x32_bf16 v[148:151], a[104:107], a[136:139], v[148:151]
buffer_load_dword v228, v254, s[56:59], 0 offen offset:0 nt
v_mfma_f32_16x16x32_bf16 v[148:151], a[108:111], a[140:143], v[148:151]
buffer_load_dword v229, v254, s[56:59], 0 offen offset:896 nt
v_mfma_f32_16x16x32_bf16 v[152:155], a[112:115], a[136:139], v[152:155]
ds_read_b128 a[36:39], v3 offset:8192
v_mfma_f32_16x16x32_bf16 v[152:155], a[116:119], a[140:143], v[152:155]
buffer_load_dword v230, v254, s[56:59], 0 offen offset:1792 nt
v_mfma_f32_16x16x32_bf16 v[156:159], a[120:123], a[136:139], v[156:159]
ds_read_b128 a[40:43], v2 offset:10240
v_mfma_f32_16x16x32_bf16 v[156:159], a[124:127], a[140:143], v[156:159]
s_waitcnt lgkmcnt(3)
buffer_load_dword v231, v254, s[56:59], 0 offen offset:2688 nt
v_mfma_f32_16x16x32_bf16 v[160:163], a[64:67], a[128:131], v[160:163]
ds_read_b64_tr_b16 a[136:137], v9 offset:32768
v_mfma_f32_16x16x32_bf16 v[160:163], a[68:71], a[132:135], v[160:163]
buffer_load_dword v232, v255, s[56:59], 0 offen offset:0 nt
v_mfma_f32_16x16x32_bf16 v[164:167], a[72:75], a[128:131], v[164:167]
ds_read_b64_tr_b16 a[138:139], v9 offset:34816
v_mfma_f32_16x16x32_bf16 v[164:167], a[76:79], a[132:135], v[164:167]
buffer_load_dword v233, v255, s[56:59], 0 offen offset:896 nt
v_mfma_f32_16x16x32_bf16 v[168:171], a[80:83], a[128:131], v[168:171]
ds_read_b64_tr_b16 a[140:141], v9 offset:49152
v_mfma_f32_16x16x32_bf16 v[168:171], a[84:87], a[132:135], v[168:171]
buffer_load_dword v234, v255, s[56:59], 0 offen offset:1792 nt
v_mfma_f32_16x16x32_bf16 v[172:175], a[88:91], a[128:131], v[172:175]
ds_read_b64_tr_b16 a[142:143], v9 offset:51200
v_mfma_f32_16x16x32_bf16 v[172:175], a[92:95], a[132:135], v[172:175]
buffer_load_dword v235, v255, s[56:59], 0 offen offset:2688 nt
v_mfma_f32_16x16x32_bf16 v[176:179], a[96:99], a[128:131], v[176:179]
s_mov_b64 s[56:57], s[68:69]
buffer_load_dword v236, v25, s[56:59], 0 offen nt
v_mfma_f32_16x16x32_bf16 v[176:179], a[100:103], a[132:135], v[176:179]
buffer_load_dword v237, v254, s[56:59], 0 offen offset:0 nt
v_mfma_f32_16x16x32_bf16 v[180:183], a[104:107], a[128:131], v[180:183]
ds_read_b128 a[44:47], v3 offset:10240
v_mfma_f32_16x16x32_bf16 v[180:183], a[108:111], a[132:135], v[180:183]
buffer_load_dword v238, v254, s[56:59], 0 offen offset:896 nt
v_mfma_f32_16x16x32_bf16 v[184:187], a[112:115], a[128:131], v[184:187]
ds_read_b128 a[48:51], v2 offset:12288
v_mfma_f32_16x16x32_bf16 v[184:187], a[116:119], a[132:135], v[184:187]
buffer_load_dword v239, v254, s[56:59], 0 offen offset:1792 nt
v_mfma_f32_16x16x32_bf16 v[188:191], a[120:123], a[128:131], v[188:191]
buffer_load_dword v240, v254, s[56:59], 0 offen offset:2688 nt
v_mfma_f32_16x16x32_bf16 v[188:191], a[124:127], a[132:135], v[188:191]
s_waitcnt lgkmcnt(2)
buffer_load_dword v241, v255, s[56:59], 0 offen offset:0 nt
v_mfma_f32_16x16x32_bf16 v[192:195], a[64:67], a[136:139], v[192:195]
ds_read_b64_tr_b16 a[128:129], v10 offset:32768
v_mfma_f32_16x16x32_bf16 v[192:195], a[68:71], a[140:143], v[192:195]
buffer_load_dword v242, v255, s[56:59], 0 offen offset:896 nt
v_mfma_f32_16x16x32_bf16 v[196:199], a[72:75], a[136:139], v[196:199]
ds_read_b64_tr_b16 a[130:131], v10 offset:34816
v_mfma_f32_16x16x32_bf16 v[196:199], a[76:79], a[140:143], v[196:199]
buffer_load_dword v243, v255, s[56:59], 0 offen offset:1792 nt
v_mfma_f32_16x16x32_bf16 v[200:203], a[80:83], a[136:139], v[200:203]
ds_read_b64_tr_b16 a[132:133], v10 offset:49152
v_mfma_f32_16x16x32_bf16 v[200:203], a[84:87], a[140:143], v[200:203]
buffer_load_dword v244, v255, s[56:59], 0 offen offset:2688 nt
v_mfma_f32_16x16x32_bf16 v[204:207], a[88:91], a[136:139], v[204:207]
ds_read_b64_tr_b16 a[134:135], v10 offset:51200
v_mfma_f32_16x16x32_bf16 v[204:207], a[92:95], a[140:143], v[204:207]
v_mfma_f32_16x16x32_bf16 v[208:211], a[96:99], a[136:139], v[208:211]
ds_read_b128 a[52:55], v3 offset:12288
v_mfma_f32_16x16x32_bf16 v[208:211], a[100:103], a[140:143], v[208:211]
v_mfma_f32_16x16x32_bf16 v[212:215], a[104:107], a[136:139], v[212:215]
ds_read_b128 a[56:59], v2 offset:14336
v_mfma_f32_16x16x32_bf16 v[212:215], a[108:111], a[140:143], v[212:215]
v_mfma_f32_16x16x32_bf16 v[216:219], a[112:115], a[136:139], v[216:219]
v_mfma_f32_16x16x32_bf16 v[216:219], a[116:119], a[140:143], v[216:219]
v_mfma_f32_16x16x32_bf16 v[220:223], a[120:123], a[136:139], v[220:223]
ds_read_b128 a[60:63], v3 offset:14336
v_mfma_f32_16x16x32_bf16 v[220:223], a[124:127], a[140:143], v[220:223]
s_waitcnt lgkmcnt(3)
v_mfma_f32_16x16x32_bf16 a[192:195], a[64:67], a[128:131], a[192:195]
ds_read_b64_tr_b16 a[136:137], v11 offset:32768
v_mfma_f32_16x16x32_bf16 a[192:195], a[68:71], a[132:135], a[192:195]
v_mfma_f32_16x16x32_bf16 a[196:199], a[72:75], a[128:131], a[196:199]
ds_read_b64_tr_b16 a[138:139], v11 offset:34816
v_mfma_f32_16x16x32_bf16 a[196:199], a[76:79], a[132:135], a[196:199]
v_mfma_f32_16x16x32_bf16 a[200:203], a[80:83], a[128:131], a[200:203]
ds_read_b64_tr_b16 a[140:141], v11 offset:49152
v_mfma_f32_16x16x32_bf16 a[200:203], a[84:87], a[132:135], a[200:203]
v_mfma_f32_16x16x32_bf16 a[204:207], a[88:91], a[128:131], a[204:207]
ds_read_b64_tr_b16 a[142:143], v11 offset:51200
v_mfma_f32_16x16x32_bf16 a[204:207], a[92:95], a[132:135], a[204:207]
v_mfma_f32_16x16x32_bf16 a[208:211], a[96:99], a[128:131], a[208:211]
v_mfma_f32_16x16x32_bf16 a[208:211], a[100:103], a[132:135], a[208:211]
v_mfma_f32_16x16x32_bf16 a[212:215], a[104:107], a[128:131], a[212:215]
v_mfma_f32_16x16x32_bf16 a[212:215], a[108:111], a[132:135], a[212:215]
v_mfma_f32_16x16x32_bf16 a[216:219], a[112:115], a[128:131], a[216:219]
v_mfma_f32_16x16x32_bf16 a[216:219], a[116:119], a[132:135], a[216:219]
v_mfma_f32_16x16x32_bf16 a[220:223], a[120:123], a[128:131], a[220:223]
s_waitcnt vmcnt(22) lgkmcnt(0)
v_mfma_f32_16x16x32_bf16 a[220:223], a[124:127], a[132:135], a[220:223]
s_barrier
v_mfma_f32_16x16x32_bf16 a[224:227], a[64:67], a[136:139], a[224:227]
s_add_u32 m0, s29, 98304
ds_read_b64_tr_b16 a[128:129], v4 offset:0
v_mfma_f32_16x16x32_bf16 a[224:227], a[68:71], a[140:143], a[224:227]
buffer_load_dwordx4 v16, s[12:15], s26 offen offset:0 lds
v_mfma_f32_16x16x32_bf16 a[228:231], a[72:75], a[136:139], a[228:231]
ds_read_b64_tr_b16 a[130:131], v4 offset:2048
v_mfma_f32_16x16x32_bf16 a[228:231], a[76:79], a[140:143], a[228:231]
v_mfma_f32_16x16x32_bf16 a[232:235], a[80:83], a[136:139], a[232:235]
ds_read_b64_tr_b16 a[132:133], v4 offset:16384
v_mfma_f32_16x16x32_bf16 a[232:235], a[84:87], a[140:143], a[232:235]
buffer_load_dwordx4 v17, s[12:15], s26 offen offset:1024 lds
v_mfma_f32_16x16x32_bf16 a[236:239], a[88:91], a[136:139], a[236:239]
ds_read_b64_tr_b16 a[134:135], v4 offset:18432
v_mfma_f32_16x16x32_bf16 a[236:239], a[92:95], a[140:143], a[236:239]
v_mfma_f32_16x16x32_bf16 a[240:243], a[96:99], a[136:139], a[240:243]
v_mfma_f32_16x16x32_bf16 a[240:243], a[100:103], a[140:143], a[240:243]
buffer_load_dwordx4 v18, s[12:15], s26 offen offset:2048 lds
v_mfma_f32_16x16x32_bf16 a[244:247], a[104:107], a[136:139], a[244:247]
v_mfma_f32_16x16x32_bf16 a[244:247], a[108:111], a[140:143], a[244:247]
v_mfma_f32_16x16x32_bf16 a[248:251], a[112:115], a[136:139], a[248:251]
v_mfma_f32_16x16x32_bf16 a[248:251], a[116:119], a[140:143], a[248:251]
buffer_load_dwordx4 v19, s[12:15], s26 offen offset:3072 lds
v_mfma_f32_16x16x32_bf16 a[252:255], a[120:123], a[136:139], a[252:255]
s_add_u32 s26, s26, 524288
v_mfma_f32_16x16x32_bf16 a[252:255], a[124:127], a[140:143], a[252:255]
s_waitcnt lgkmcnt(0)
v_mfma_f32_16x16x32_bf16 v[32:35], a[0:3], a[128:131], v[32:35]
s_add_u32 m0, s29, 114688
ds_read_b64_tr_b16 a[136:137], v5 offset:0
v_mfma_f32_16x16x32_bf16 v[32:35], a[4:7], a[132:135], v[32:35]
buffer_load_dwordx4 v16, s[12:15], s27 offen offset:0 lds
v_mfma_f32_16x16x32_bf16 v[36:39], a[8:11], a[128:131], v[36:39]
ds_read_b64_tr_b16 a[138:139], v5 offset:2048
v_mfma_f32_16x16x32_bf16 v[36:39], a[12:15], a[132:135], v[36:39]
v_mfma_f32_16x16x32_bf16 v[40:43], a[16:19], a[128:131], v[40:43]
ds_read_b64_tr_b16 a[140:141], v5 offset:16384
v_mfma_f32_16x16x32_bf16 v[40:43], a[20:23], a[132:135], v[40:43]
buffer_load_dwordx4 v17, s[12:15], s27 offen offset:1024 lds
v_mfma_f32_16x16x32_bf16 v[44:47], a[24:27], a[128:131], v[44:47]
ds_read_b64_tr_b16 a[142:143], v5 offset:18432
v_mfma_f32_16x16x32_bf16 v[44:47], a[28:31], a[132:135], v[44:47]
v_mfma_f32_16x16x32_bf16 v[48:51], a[32:35], a[128:131], v[48:51]
ds_read_b128 a[64:67], v2 offset:32768
v_mfma_f32_16x16x32_bf16 v[48:51], a[36:39], a[132:135], v[48:51]
buffer_load_dwordx4 v18, s[12:15], s27 offen offset:2048 lds
v_mfma_f32_16x16x32_bf16 v[52:55], a[40:43], a[128:131], v[52:55]
ds_read_b128 a[68:71], v3 offset:32768
v_mfma_f32_16x16x32_bf16 v[52:55], a[44:47], a[132:135], v[52:55]
v_mfma_f32_16x16x32_bf16 v[56:59], a[48:51], a[128:131], v[56:59]
v_mfma_f32_16x16x32_bf16 v[56:59], a[52:55], a[132:135], v[56:59]
buffer_load_dwordx4 v19, s[12:15], s27 offen offset:3072 lds
v_mfma_f32_16x16x32_bf16 v[60:63], a[56:59], a[128:131], v[60:63]
s_add_u32 s27, s27, 524288
ds_read_b128 a[72:75], v2 offset:34816
v_mfma_f32_16x16x32_bf16 v[60:63], a[60:63], a[132:135], v[60:63]
s_waitcnt lgkmcnt(3)
v_mfma_f32_16x16x32_bf16 v[64:67], a[0:3], a[136:139], v[64:67]
s_add_u32 m0, s28, 0
ds_read_b64_tr_b16 a[128:129], v6 offset:0
v_mfma_f32_16x16x32_bf16 v[64:67], a[4:7], a[140:143], v[64:67]
buffer_load_dwordx4 v12, s[8:11], s24 offen offset:0 lds
v_mfma_f32_16x16x32_bf16 v[68:71], a[8:11], a[136:139], v[68:71]
ds_read_b64_tr_b16 a[130:131], v6 offset:2048
v_mfma_f32_16x16x32_bf16 v[68:71], a[12:15], a[140:143], v[68:71]
v_mfma_f32_16x16x32_bf16 v[72:75], a[16:19], a[136:139], v[72:75]
ds_read_b64_tr_b16 a[132:133], v6 offset:16384
v_mfma_f32_16x16x32_bf16 v[72:75], a[20:23], a[140:143], v[72:75]
buffer_load_dwordx4 v13, s[8:11], s24 offen offset:1024 lds
v_mfma_f32_16x16x32_bf16 v[76:79], a[24:27], a[136:139], v[76:79]
ds_read_b64_tr_b16 a[134:135], v6 offset:18432
v_mfma_f32_16x16x32_bf16 v[76:79], a[28:31], a[140:143], v[76:79]
v_mfma_f32_16x16x32_bf16 v[80:83], a[32:35], a[136:139], v[80:83]
ds_read_b128 a[76:79], v3 offset:34816
v_mfma_f32_16x16x32_bf16 v[80:83], a[36:39], a[140:143], v[80:83]
buffer_load_dwordx4 v14, s[8:11], s24 offen offset:2048 lds
v_mfma_f32_16x16x32_bf16 v[84:87], a[40:43], a[136:139], v[84:87]
v_mfma_f32_16x16x32_bf16 v[84:87], a[44:47], a[140:143], v[84:87]
v_mfma_f32_16x16x32_bf16 v[88:91], a[48:51], a[136:139], v[88:91]
ds_read_b128 a[80:83], v2 offset:36864
v_mfma_f32_16x16x32_bf16 v[88:91], a[52:55], a[140:143], v[88:91]
buffer_load_dwordx4 v15, s[8:11], s24 offen offset:3072 lds
v_mfma_f32_16x16x32_bf16 v[92:95], a[56:59], a[136:139], v[92:95]
s_add_u32 s24, s24, 128
ds_read_b128 a[84:87], v3 offset:36864
v_mfma_f32_16x16x32_bf16 v[92:95], a[60:63], a[140:143], v[92:95]
s_waitcnt lgkmcnt(3)
v_mfma_f32_16x16x32_bf16 v[96:99], a[0:3], a[128:131], v[96:99]
s_add_u32 m0, s28, 4096
ds_read_b64_tr_b16 a[136:137], v7 offset:0
v_mfma_f32_16x16x32_bf16 v[96:99], a[4:7], a[132:135], v[96:99]
buffer_load_dwordx4 v12, s[8:11], s25 offen offset:0 lds
v_mfma_f32_16x16x32_bf16 v[100:103], a[8:11], a[128:131], v[100:103]
ds_read_b64_tr_b16 a[138:139], v7 offset:2048
v_mfma_f32_16x16x32_bf16 v[100:103], a[12:15], a[132:135], v[100:103]
v_mfma_f32_16x16x32_bf16 v[104:107], a[16:19], a[128:131], v[104:107]
ds_read_b64_tr_b16 a[140:141], v7 offset:16384
v_mfma_f32_16x16x32_bf16 v[104:107], a[20:23], a[132:135], v[104:107]
buffer_load_dwordx4 v13, s[8:11], s25 offen offset:1024 lds
v_mfma_f32_16x16x32_bf16 v[108:111], a[24:27], a[128:131], v[108:111]
ds_read_b64_tr_b16 a[142:143], v7 offset:18432
v_mfma_f32_16x16x32_bf16 v[108:111], a[28:31], a[132:135], v[108:111]
v_mfma_f32_16x16x32_bf16 v[112:115], a[32:35], a[128:131], v[112:115]
v_mfma_f32_16x16x32_bf16 v[112:115], a[36:39], a[132:135], v[112:115]
buffer_load_dwordx4 v14, s[8:11], s25 offen offset:2048 lds
v_mfma_f32_16x16x32_bf16 v[116:119], a[40:43], a[128:131], v[116:119]
ds_read_b128 a[88:91], v2 offset:38912
v_mfma_f32_16x16x32_bf16 v[116:119], a[44:47], a[132:135], v[116:119]
v_mfma_f32_16x16x32_bf16 v[120:123], a[48:51], a[128:131], v[120:123]
ds_read_b128 a[92:95], v3 offset:38912
v_mfma_f32_16x16x32_bf16 v[120:123], a[52:55], a[132:135], v[120:123]
buffer_load_dwordx4 v15, s[8:11], s25 offen offset:3072 lds
v_mfma_f32_16x16x32_bf16 v[124:127], a[56:59], a[128:131], v[124:127]
s_add_u32 s25, s25, 128
v_mfma_f32_16x16x32_bf16 v[124:127], a[60:63], a[132:135], v[124:127]
s_waitcnt lgkmcnt(2)
v_mfma_f32_16x16x32_bf16 v[128:131], a[0:3], a[136:139], v[128:131]
ds_read_b64_tr_b16 a[128:129], v8 offset:0
v_mfma_f32_16x16x32_bf16 v[128:131], a[4:7], a[140:143], v[128:131]
buffer_load_dword v21, v20, s[16:19], s43 offen
v_mfma_f32_16x16x32_bf16 v[132:135], a[8:11], a[136:139], v[132:135]
s_add_u32 s43, s43, s47
ds_read_b64_tr_b16 a[130:131], v8 offset:2048
v_mfma_f32_16x16x32_bf16 v[132:135], a[12:15], a[140:143], v[132:135]
s_cmp_ge_u32 s43, s51
v_mfma_f32_16x16x32_bf16 v[136:139], a[16:19], a[136:139], v[136:139]
s_cselect_b32 s43, 0, s43
ds_read_b64_tr_b16 a[132:133], v8 offset:16384
v_mfma_f32_16x16x32_bf16 v[136:139], a[20:23], a[140:143], v[136:139]
s_cselect_b32 s51, s42, s51
v_mfma_f32_16x16x32_bf16 v[140:143], a[24:27], a[136:139], v[140:143]
s_cselect_b64 s[16:17], s[40:41], s[16:17]
ds_read_b64_tr_b16 a[134:135], v8 offset:18432
v_mfma_f32_16x16x32_bf16 v[140:143], a[28:31], a[140:143], v[140:143]
s_cselect_b32 s18, s42, s18
v_mfma_f32_16x16x32_bf16 v[144:147], a[32:35], a[136:139], v[144:147]
s_cselect_b64 s[40:41], s[44:45], s[40:41]
ds_read_b128 a[96:99], v2 offset:40960
v_mfma_f32_16x16x32_bf16 v[144:147], a[36:39], a[140:143], v[144:147]
s_cselect_b32 s42, s46, s42
v_mfma_f32_16x16x32_bf16 v[148:151], a[40:43], a[136:139], v[148:151]
s_cselect_b32 s46, 0, s46
v_mfma_f32_16x16x32_bf16 v[148:151], a[44:47], a[140:143], v[148:151]
s_lshl_b32 s59, s39, 5
v_mfma_f32_16x16x32_bf16 v[152:155], a[48:51], a[136:139], v[152:155]
s_add_u32 s59, s59, s38
ds_read_b128 a[100:103], v3 offset:40960
v_mfma_f32_16x16x32_bf16 v[152:155], a[52:55], a[140:143], v[152:155]
s_lshl_b32 s59, s59, 2
v_mfma_f32_16x16x32_bf16 v[156:159], a[56:59], a[136:139], v[156:159]
s_add_u32 s59, s59, 94392320
ds_read_b128 a[104:107], v2 offset:43008
v_mfma_f32_16x16x32_bf16 v[156:159], a[60:63], a[140:143], v[156:159]
s_waitcnt lgkmcnt(3)
s_cmp_lt_u32 s2, 224
v_mfma_f32_16x16x32_bf16 v[160:163], a[0:3], a[128:131], v[160:163]
s_cselect_b32 s59, s59, 3221225472
ds_read_b64_tr_b16 a[136:137], v9 offset:0
v_mfma_f32_16x16x32_bf16 v[160:163], a[4:7], a[132:135], v[160:163]
s_mov_b32 s58, 0xffff0000
v_mfma_f32_16x16x32_bf16 v[164:167], a[8:11], a[128:131], v[164:167]
s_cmp_lt_u32 s3, 1
ds_read_b64_tr_b16 a[138:139], v9 offset:2048
v_mfma_f32_16x16x32_bf16 v[164:167], a[12:15], a[132:135], v[164:167]
s_cselect_b32 s54, 0, 3221225472
v_mfma_f32_16x16x32_bf16 v[168:171], a[16:19], a[128:131], v[168:171]
s_cselect_b32 s50, 0x100, 0
ds_read_b64_tr_b16 a[140:141], v9 offset:16384
v_mfma_f32_16x16x32_bf16 v[168:171], a[20:23], a[132:135], v[168:171]
buffer_load_dword v21, v20, s[16:19], s43 offen
v_mfma_f32_16x16x32_bf16 v[172:175], a[24:27], a[128:131], v[172:175]
s_add_u32 s43, s43, s47
ds_read_b64_tr_b16 a[142:143], v9 offset:18432
v_mfma_f32_16x16x32_bf16 v[172:175], a[28:31], a[132:135], v[172:175]
s_cmp_ge_u32 s43, s51
v_mfma_f32_16x16x32_bf16 v[176:179], a[32:35], a[128:131], v[176:179]
s_cselect_b32 s43, 0, s43
v_mfma_f32_16x16x32_bf16 v[176:179], a[36:39], a[132:135], v[176:179]
s_cselect_b32 s51, s42, s51
v_mfma_f32_16x16x32_bf16 v[180:183], a[40:43], a[128:131], v[180:183]
s_cselect_b64 s[16:17], s[40:41], s[16:17]
ds_read_b128 a[108:111], v3 offset:43008
v_mfma_f32_16x16x32_bf16 v[180:183], a[44:47], a[132:135], v[180:183]
s_cselect_b32 s18, s42, s18
v_mfma_f32_16x16x32_bf16 v[184:187], a[48:51], a[128:131], v[184:187]
s_cselect_b64 s[40:41], s[44:45], s[40:41]
ds_read_b128 a[112:115], v2 offset:45056
v_mfma_f32_16x16x32_bf16 v[184:187], a[52:55], a[132:135], v[184:187]
s_cselect_b32 s42, s46, s42
v_mfma_f32_16x16x32_bf16 v[188:191], a[56:59], a[128:131], v[188:191]
s_cselect_b32 s46, 0, s46
v_mfma_f32_16x16x32_bf16 v[188:191], a[60:63], a[132:135], v[188:191]
s_waitcnt lgkmcnt(2)
v_mfma_f32_16x16x32_bf16 v[192:195], a[0:3], a[136:139], v[192:195]
ds_read_b64_tr_b16 a[128:129], v10 offset:0
v_mfma_f32_16x16x32_bf16 v[192:195], a[4:7], a[140:143], v[192:195]
v_mfma_f32_16x16x32_bf16 v[196:199], a[8:11], a[136:139], v[196:199]
ds_read_b64_tr_b16 a[130:131], v10 offset:2048
v_mfma_f32_16x16x32_bf16 v[196:199], a[12:15], a[140:143], v[196:199]
v_mfma_f32_16x16x32_bf16 v[200:203], a[16:19], a[136:139], v[200:203]
ds_read_b64_tr_b16 a[132:133], v10 offset:16384
v_mfma_f32_16x16x32_bf16 v[200:203], a[20:23], a[140:143], v[200:203]
v_mfma_f32_16x16x32_bf16 v[204:207], a[24:27], a[136:139], v[204:207]
ds_read_b64_tr_b16 a[134:135], v10 offset:18432
v_mfma_f32_16x16x32_bf16 v[204:207], a[28:31], a[140:143], v[204:207]
v_mfma_f32_16x16x32_bf16 v[208:211], a[32:35], a[136:139], v[208:211]
ds_read_b128 a[116:119], v3 offset:45056
v_mfma_f32_16x16x32_bf16 v[208:211], a[36:39], a[140:143], v[208:211]
v_mfma_f32_16x16x32_bf16 v[212:215], a[40:43], a[136:139], v[212:215]
ds_read_b128 a[120:123], v2 offset:47104
v_and_b32 v252, 31, v0
v_mfma_f32_16x16x32_bf16 v[212:215], a[44:47], a[140:143], v[212:215]
v_lshrrev_b32 v253, 5, v0
v_xor_b32 v253, v253, v252
v_mfma_f32_16x16x32_bf16 v[216:219], a[48:51], a[136:139], v[216:219]
v_and_b32 v253, 7, v253
v_lshlrev_b32 v252, 8, v252
v_mfma_f32_16x16x32_bf16 v[216:219], a[52:55], a[140:143], v[216:219]
v_lshl_add_u32 v252, v253, 4, v252
v_add_u32 v252, 147456, v252
v_mfma_f32_16x16x32_bf16 v[220:223], a[56:59], a[136:139], v[220:223]
ds_read_b128 a[124:127], v3 offset:47104
v_mfma_f32_16x16x32_bf16 v[220:223], a[60:63], a[140:143], v[220:223]
s_waitcnt lgkmcnt(3)
v_mfma_f32_16x16x32_bf16 a[192:195], a[0:3], a[128:131], a[192:195]
ds_read_b64_tr_b16 a[136:137], v11 offset:0
v_mfma_f32_16x16x32_bf16 a[192:195], a[4:7], a[132:135], a[192:195]
v_mfma_f32_16x16x32_bf16 a[196:199], a[8:11], a[128:131], a[196:199]
ds_read_b64_tr_b16 a[138:139], v11 offset:2048
v_mfma_f32_16x16x32_bf16 a[196:199], a[12:15], a[132:135], a[196:199]
v_mfma_f32_16x16x32_bf16 a[200:203], a[16:19], a[128:131], a[200:203]
ds_read_b64_tr_b16 a[140:141], v11 offset:16384
v_mfma_f32_16x16x32_bf16 a[200:203], a[20:23], a[132:135], a[200:203]
v_mfma_f32_16x16x32_bf16 a[204:207], a[24:27], a[128:131], a[204:207]
ds_read_b64_tr_b16 a[142:143], v11 offset:18432
v_mfma_f32_16x16x32_bf16 a[204:207], a[28:31], a[132:135], a[204:207]
v_mfma_f32_16x16x32_bf16 a[208:211], a[32:35], a[128:131], a[208:211]
v_mfma_f32_16x16x32_bf16 a[208:211], a[36:39], a[132:135], a[208:211]
v_mfma_f32_16x16x32_bf16 a[212:215], a[40:43], a[128:131], a[212:215]
v_mfma_f32_16x16x32_bf16 a[212:215], a[44:47], a[132:135], a[212:215]
v_mfma_f32_16x16x32_bf16 a[216:219], a[48:51], a[128:131], a[216:219]
v_mfma_f32_16x16x32_bf16 a[216:219], a[52:55], a[132:135], a[216:219]
v_mfma_f32_16x16x32_bf16 a[220:223], a[56:59], a[128:131], a[220:223]
s_waitcnt vmcnt(2) lgkmcnt(0)
v_mfma_f32_16x16x32_bf16 a[220:223], a[60:63], a[132:135], a[220:223]
s_barrier
v_mfma_f32_16x16x32_bf16 a[224:227], a[0:3], a[136:139], a[224:227]
s_add_u32 m0, s29, 65536
ds_read_b64_tr_b16 a[128:129], v4 offset:32768
v_lshlrev_b32 v28, 16, v248
v_mfma_f32_16x16x32_bf16 a[224:227], a[4:7], a[140:143], a[224:227]
buffer_load_dwordx4 v16, s[12:15], s26 offen offset:0 lds
v_mfma_f32_16x16x32_bf16 a[228:231], a[8:11], a[136:139], a[228:231]
ds_read_b64_tr_b16 a[130:131], v4 offset:34816
v_and_b32 v29, s58, v248
v_mfma_f32_16x16x32_bf16 a[228:231], a[12:15], a[140:143], a[228:231]
v_lshlrev_b32 v30, 16, v249
v_and_b32 v253, s58, v249
v_mfma_f32_16x16x32_bf16 a[232:235], a[16:19], a[136:139], a[232:235]
ds_read_b64_tr_b16 a[132:133], v4 offset:49152
v_lshlrev_b32 v22, 16, v224
v_mfma_f32_16x16x32_bf16 a[232:235], a[20:23], a[140:143], a[232:235]
buffer_load_dwordx4 v17, s[12:15], s26 offen offset:1024 lds
v_mfma_f32_16x16x32_bf16 a[236:239], a[24:27], a[136:139], a[236:239]
ds_read_b64_tr_b16 a[134:135], v4 offset:51200
v_lshlrev_b32 v23, 16, v225
v_mfma_f32_16x16x32_bf16 a[236:239], a[28:31], a[140:143], a[236:239]
v_lshlrev_b32 v24, 16, v226
v_mul_f32 v254, v22, v253
v_mfma_f32_16x16x32_bf16 a[240:243], a[32:35], a[136:139], a[240:243]
v_lshlrev_b32 v25, 16, v227
v_lshlrev_b32 v247, 16, v236
v_mfma_f32_16x16x32_bf16 a[240:243], a[36:39], a[140:143], a[240:243]
buffer_load_dwordx4 v18, s[12:15], s26 offen offset:2048 lds
v_mfma_f32_16x16x32_bf16 a[244:247], a[40:43], a[136:139], a[244:247]
v_fmac_f32 v254, v23, v30
v_fmac_f32 v254, v24, v29
v_mfma_f32_16x16x32_bf16 a[244:247], a[44:47], a[140:143], a[244:247]
v_fmac_f32 v254, v25, v28
v_mul_f32 v254, v254, v247
v_mfma_f32_16x16x32_bf16 a[248:251], a[48:51], a[136:139], a[248:251]
v_mul_f32 v255, v23, v253
v_lshlrev_b32 v22, 16, v228
v_mfma_f32_16x16x32_bf16 a[248:251], a[52:55], a[140:143], a[248:251]
buffer_load_dwordx4 v19, s[12:15], s26 offen offset:3072 lds
v_mfma_f32_16x16x32_bf16 a[252:255], a[56:59], a[136:139], a[252:255]
s_add_u32 s26, s26, 524288
v_lshlrev_b32 v247, 16, v237
v_fmac_f32 v255, v24, v30
v_mfma_f32_16x16x32_bf16 a[252:255], a[60:63], a[140:143], a[252:255]
s_waitcnt lgkmcnt(0)
v_fmac_f32 v255, v25, v29
v_fmac_f32 v255, v22, v28
v_mfma_f32_16x16x32_bf16 v[32:35], a[64:67], a[128:131], v[32:35]
s_add_u32 m0, s29, 81920
ds_read_b64_tr_b16 a[136:137], v5 offset:32768
v_mul_f32 v255, v255, v247
v_mfma_f32_16x16x32_bf16 v[32:35], a[68:71], a[132:135], v[32:35]
buffer_load_dwordx4 v16, s[12:15], s27 offen offset:0 lds
v_mfma_f32_16x16x32_bf16 v[36:39], a[72:75], a[128:131], v[36:39]
ds_read_b64_tr_b16 a[138:139], v5 offset:34816
v_cvt_pk_bf16_f32 v246, v254, v255
v_mfma_f32_16x16x32_bf16 v[36:39], a[76:79], a[132:135], v[36:39]
v_accvgpr_write_b32 a180, v246
v_mul_f32 v254, v24, v253
v_mfma_f32_16x16x32_bf16 v[40:43], a[80:83], a[128:131], v[40:43]
ds_read_b64_tr_b16 a[140:141], v5 offset:49152
v_lshlrev_b32 v23, 16, v229
v_mfma_f32_16x16x32_bf16 v[40:43], a[84:87], a[132:135], v[40:43]
buffer_load_dwordx4 v17, s[12:15], s27 offen offset:1024 lds
v_mfma_f32_16x16x32_bf16 v[44:47], a[88:91], a[128:131], v[44:47]
ds_read_b64_tr_b16 a[142:143], v5 offset:51200
v_lshlrev_b32 v247, 16, v238
v_mfma_f32_16x16x32_bf16 v[44:47], a[92:95], a[132:135], v[44:47]
v_fmac_f32 v254, v25, v30
v_fmac_f32 v254, v22, v29
v_fmac_f32 v254, v23, v28
v_mfma_f32_16x16x32_bf16 v[48:51], a[96:99], a[128:131], v[48:51]
ds_read_b128 a[0:3], v2 offset:0
v_mul_f32 v254, v254, v247
v_mfma_f32_16x16x32_bf16 v[48:51], a[100:103], a[132:135], v[48:51]
buffer_load_dwordx4 v18, s[12:15], s27 offen offset:2048 lds
v_mfma_f32_16x16x32_bf16 v[52:55], a[104:107], a[128:131], v[52:55]
ds_read_b128 a[4:7], v3 offset:0
v_cvt_pk_bf16_f32 v246, v255, v254
v_mfma_f32_16x16x32_bf16 v[52:55], a[108:111], a[132:135], v[52:55]
v_accvgpr_write_b32 a176, v246
v_mul_f32 v255, v25, v253
v_mfma_f32_16x16x32_bf16 v[56:59], a[112:115], a[128:131], v[56:59]
v_lshlrev_b32 v24, 16, v230
v_lshlrev_b32 v247, 16, v239
v_mfma_f32_16x16x32_bf16 v[56:59], a[116:119], a[132:135], v[56:59]
buffer_load_dwordx4 v19, s[12:15], s27 offen offset:3072 lds
v_mfma_f32_16x16x32_bf16 v[60:63], a[120:123], a[128:131], v[60:63]
s_add_u32 s27, s27, 524288
ds_read_b128 a[8:11], v2 offset:2048
v_fmac_f32 v255, v22, v30
v_mfma_f32_16x16x32_bf16 v[60:63], a[124:127], a[132:135], v[60:63]
s_waitcnt lgkmcnt(3)
v_fmac_f32 v255, v23, v29
v_fmac_f32 v255, v24, v28
v_mul_f32 v255, v255, v247
v_mfma_f32_16x16x32_bf16 v[64:67], a[64:67], a[136:139], v[64:67]
s_add_u32 m0, s28, 32768
ds_read_b64_tr_b16 a[128:129], v6 offset:32768
v_cvt_pk_bf16_f32 v246, v254, v255
v_mfma_f32_16x16x32_bf16 v[64:67], a[68:71], a[140:143], v[64:67]
buffer_load_dwordx4 v12, s[8:11], s24 offen offset:0 lds
v_mfma_f32_16x16x32_bf16 v[68:71], a[72:75], a[136:139], v[68:71]
ds_read_b64_tr_b16 a[130:131], v6 offset:34816
v_accvgpr_write_b32 a181, v246
v_mfma_f32_16x16x32_bf16 v[68:71], a[76:79], a[140:143], v[68:71]
v_mul_f32 v254, v22, v253
v_lshlrev_b32 v25, 16, v231
v_mfma_f32_16x16x32_bf16 v[72:75], a[80:83], a[136:139], v[72:75]
ds_read_b64_tr_b16 a[132:133], v6 offset:49152
v_lshlrev_b32 v247, 16, v240
v_mfma_f32_16x16x32_bf16 v[72:75], a[84:87], a[140:143], v[72:75]
buffer_load_dwordx4 v13, s[8:11], s24 offen offset:1024 lds
v_mfma_f32_16x16x32_bf16 v[76:79], a[88:91], a[136:139], v[76:79]
ds_read_b64_tr_b16 a[134:135], v6 offset:51200
v_fmac_f32 v254, v23, v30
v_fmac_f32 v254, v24, v29
v_mfma_f32_16x16x32_bf16 v[76:79], a[92:95], a[140:143], v[76:79]
v_fmac_f32 v254, v25, v28
v_mul_f32 v254, v254, v247
v_mfma_f32_16x16x32_bf16 v[80:83], a[96:99], a[136:139], v[80:83]
ds_read_b128 a[12:15], v3 offset:2048
v_cvt_pk_bf16_f32 v246, v255, v254
v_mfma_f32_16x16x32_bf16 v[80:83], a[100:103], a[140:143], v[80:83]
buffer_load_dwordx4 v14, s[8:11], s24 offen offset:2048 lds
v_mfma_f32_16x16x32_bf16 v[84:87], a[104:107], a[136:139], v[84:87]
v_accvgpr_write_b32 a177, v246
v_mul_f32 v255, v23, v253
v_mfma_f32_16x16x32_bf16 v[84:87], a[108:111], a[140:143], v[84:87]
v_lshlrev_b32 v22, 16, v232
v_lshlrev_b32 v247, 16, v241
v_mfma_f32_16x16x32_bf16 v[88:91], a[112:115], a[136:139], v[88:91]
ds_read_b128 a[16:19], v2 offset:4096
v_fmac_f32 v255, v24, v30
v_mfma_f32_16x16x32_bf16 v[88:91], a[116:119], a[140:143], v[88:91]
PAD_24:
s_cbranch_execz PAD_28
buffer_load_dwordx4 v15, s[8:11], s24 offen offset:3072 lds
v_mfma_f32_16x16x32_bf16 v[92:95], a[120:123], a[136:139], v[92:95]
s_add_u32 s24, s24, 128
ds_read_b128 a[20:23], v3 offset:4096
v_fmac_f32 v255, v25, v29
v_fmac_f32 v255, v22, v28
v_mfma_f32_16x16x32_bf16 v[92:95], a[124:127], a[140:143], v[92:95]
s_waitcnt lgkmcnt(3)
v_mul_f32 v255, v255, v247
v_cvt_pk_bf16_f32 v246, v254, v255
v_mfma_f32_16x16x32_bf16 v[96:99], a[64:67], a[128:131], v[96:99]
s_add_u32 m0, s28, 36864
ds_read_b64_tr_b16 a[136:137], v7 offset:32768
v_accvgpr_write_b32 a182, v246
v_mfma_f32_16x16x32_bf16 v[96:99], a[68:71], a[132:135], v[96:99]
buffer_load_dwordx4 v12, s[8:11], s25 offen offset:0 lds
v_mfma_f32_16x16x32_bf16 v[100:103], a[72:75], a[128:131], v[100:103]
ds_read_b64_tr_b16 a[138:139], v7 offset:34816
v_mul_f32 v254, v24, v253
v_mfma_f32_16x16x32_bf16 v[100:103], a[76:79], a[132:135], v[100:103]
v_lshlrev_b32 v23, 16, v233
v_lshlrev_b32 v247, 16, v242
v_mfma_f32_16x16x32_bf16 v[104:107], a[80:83], a[128:131], v[104:107]
ds_read_b64_tr_b16 a[140:141], v7 offset:49152
v_fmac_f32 v254, v25, v30
v_mfma_f32_16x16x32_bf16 v[104:107], a[84:87], a[132:135], v[104:107]
buffer_load_dwordx4 v13, s[8:11], s25 offen offset:1024 lds
v_fmac_f32 v254, v22, v29
v_mfma_f32_16x16x32_bf16 v[108:111], a[88:91], a[128:131], v[108:111]
ds_read_b64_tr_b16 a[142:143], v7 offset:51200
v_fmac_f32 v254, v23, v28
v_mfma_f32_16x16x32_bf16 v[108:111], a[92:95], a[132:135], v[108:111]
v_mul_f32 v254, v254, v247
v_cvt_pk_bf16_f32 v246, v255, v254
v_mfma_f32_16x16x32_bf16 v[112:115], a[96:99], a[128:131], v[112:115]
v_accvgpr_write_b32 a178, v246
v_mul_f32 v255, v25, v253
v_mfma_f32_16x16x32_bf16 v[112:115], a[100:103], a[132:135], v[112:115]
buffer_load_dwordx4 v14, s[8:11], s25 offen offset:2048 lds
v_mfma_f32_16x16x32_bf16 v[116:119], a[104:107], a[128:131], v[116:119]
ds_read_b128 a[24:27], v2 offset:6144
v_lshlrev_b32 v24, 16, v234
v_mfma_f32_16x16x32_bf16 v[116:119], a[108:111], a[132:135], v[116:119]
v_lshlrev_b32 v247, 16, v243
v_fmac_f32 v255, v22, v30
v_mfma_f32_16x16x32_bf16 v[120:123], a[112:115], a[128:131], v[120:123]
ds_read_b128 a[28:31], v3 offset:6144
v_fmac_f32 v255, v23, v29
v_mfma_f32_16x16x32_bf16 v[120:123], a[116:119], a[132:135], v[120:123]
buffer_load_dwordx4 v15, s[8:11], s25 offen offset:3072 lds
v_fmac_f32 v255, v24, v28
v_mfma_f32_16x16x32_bf16 v[124:127], a[120:123], a[128:131], v[124:127]
s_add_u32 s25, s25, 128
v_mul_f32 v255, v255, v247
v_cvt_pk_bf16_f32 v246, v254, v255
v_mfma_f32_16x16x32_bf16 v[124:127], a[124:127], a[132:135], v[124:127]
s_waitcnt lgkmcnt(2)
v_accvgpr_write_b32 a183, v246
v_mul_f32 v254, v22, v253
v_mfma_f32_16x16x32_bf16 v[128:131], a[64:67], a[136:139], v[128:131]
ds_read_b64_tr_b16 a[128:129], v8 offset:32768
v_lshlrev_b32 v25, 16, v235
v_mfma_f32_16x16x32_bf16 v[128:131], a[68:71], a[140:143], v[128:131]
buffer_load_dword v21, v20, s[16:19], s43 offen
v_mfma_f32_16x16x32_bf16 v[132:135], a[72:75], a[136:139], v[132:135]
s_add_u32 s43, s43, s47
ds_read_b64_tr_b16 a[130:131], v8 offset:34816
v_lshlrev_b32 v247, 16, v244
v_mfma_f32_16x16x32_bf16 v[132:135], a[76:79], a[140:143], v[132:135]
s_cmp_ge_u32 s43, s51
v_fmac_f32 v254, v23, v30
v_fmac_f32 v254, v24, v29
v_mfma_f32_16x16x32_bf16 v[136:139], a[80:83], a[136:139], v[136:139]
s_cselect_b32 s43, 0, s43
ds_read_b64_tr_b16 a[132:133], v8 offset:49152
v_fmac_f32 v254, v25, v28
v_mul_f32 v254, v254, v247
v_mfma_f32_16x16x32_bf16 v[136:139], a[84:87], a[140:143], v[136:139]
s_cselect_b32 s51, s42, s51
v_cvt_pk_bf16_f32 v246, v255, v254
v_accvgpr_write_b32 a179, v246
v_mfma_f32_16x16x32_bf16 v[140:143], a[88:91], a[136:139], v[140:143]
s_cselect_b64 s[16:17], s[40:41], s[16:17]
ds_read_b64_tr_b16 a[134:135], v8 offset:51200
v_lshlrev_b32 v28, 16, v250
v_mfma_f32_16x16x32_bf16 v[140:143], a[92:95], a[140:143], v[140:143]
s_cselect_b32 s18, s42, s18
v_and_b32 v29, s58, v250
v_lshlrev_b32 v30, 16, v251
v_mfma_f32_16x16x32_bf16 v[144:147], a[96:99], a[136:139], v[144:147]
s_cselect_b64 s[40:41], s[44:45], s[40:41]
ds_read_b128 a[32:35], v2 offset:8192
v_and_b32 v253, s58, v251
v_mfma_f32_16x16x32_bf16 v[144:147], a[100:103], a[140:143], v[144:147]
s_cselect_b32 s42, s46, s42
v_and_b32 v22, s58, v224
v_and_b32 v23, s58, v225
v_mfma_f32_16x16x32_bf16 v[148:151], a[104:107], a[136:139], v[148:151]
s_cselect_b32 s46, 0, s46
v_and_b32 v24, s58, v226
v_mul_f32 v254, v22, v253
v_mfma_f32_16x16x32_bf16 v[148:151], a[108:111], a[140:143], v[148:151]
buffer_load_dword v245, off, s[60:63], s54 sc1
v_mfma_f32_16x16x32_bf16 v[152:155], a[112:115], a[136:139], v[152:155]
ds_read_b128 a[36:39], v3 offset:8192
v_and_b32 v25, s58, v227
v_and_b32 v247, s58, v236
v_mfma_f32_16x16x32_bf16 v[152:155], a[116:119], a[140:143], v[152:155]
v_fmac_f32 v254, v23, v30
v_fmac_f32 v254, v24, v29
v_mfma_f32_16x16x32_bf16 v[156:159], a[120:123], a[136:139], v[156:159]
ds_read_b128 a[40:43], v2 offset:10240
v_fmac_f32 v254, v25, v28
v_mfma_f32_16x16x32_bf16 v[156:159], a[124:127], a[140:143], v[156:159]
s_waitcnt lgkmcnt(3)
v_mul_f32 v254, v254, v247
v_mul_f32 v255, v23, v253
v_mfma_f32_16x16x32_bf16 v[160:163], a[64:67], a[128:131], v[160:163]
ds_read_b64_tr_b16 a[136:137], v9 offset:32768
v_and_b32 v22, s58, v228
v_mfma_f32_16x16x32_bf16 v[160:163], a[68:71], a[132:135], v[160:163]
v_and_b32 v247, s58, v237
v_fmac_f32 v255, v24, v30
v_mfma_f32_16x16x32_bf16 v[164:167], a[72:75], a[128:131], v[164:167]
ds_read_b64_tr_b16 a[138:139], v9 offset:34816
v_fmac_f32 v255, v25, v29
v_mfma_f32_16x16x32_bf16 v[164:167], a[76:79], a[132:135], v[164:167]
v_fmac_f32 v255, v22, v28
v_mul_f32 v255, v255, v247
v_mfma_f32_16x16x32_bf16 v[168:171], a[80:83], a[128:131], v[168:171]
ds_read_b64_tr_b16 a[140:141], v9 offset:49152
v_cvt_pk_bf16_f32 v246, v254, v255
v_accvgpr_write_b32 a188, v246
v_mfma_f32_16x16x32_bf16 v[168:171], a[84:87], a[132:135], v[168:171]
v_mul_f32 v254, v24, v253
v_and_b32 v23, s58, v229
v_mfma_f32_16x16x32_bf16 v[172:175], a[88:91], a[128:131], v[172:175]
ds_read_b64_tr_b16 a[142:143], v9 offset:51200
v_and_b32 v247, s58, v238
v_mfma_f32_16x16x32_bf16 v[172:175], a[92:95], a[132:135], v[172:175]
v_fmac_f32 v254, v25, v30
v_fmac_f32 v254, v22, v29
v_mfma_f32_16x16x32_bf16 v[176:179], a[96:99], a[128:131], v[176:179]
v_fmac_f32 v254, v23, v28
v_mul_f32 v254, v254, v247
v_mfma_f32_16x16x32_bf16 v[176:179], a[100:103], a[132:135], v[176:179]
v_cvt_pk_bf16_f32 v246, v255, v254
v_accvgpr_write_b32 a184, v246
v_mfma_f32_16x16x32_bf16 v[180:183], a[104:107], a[128:131], v[180:183]
ds_read_b128 a[44:47], v3 offset:10240
v_mul_f32 v255, v25, v253
v_mfma_f32_16x16x32_bf16 v[180:183], a[108:111], a[132:135], v[180:183]
v_and_b32 v24, s58, v230
v_and_b32 v247, s58, v239
v_fmac_f32 v255, v22, v30
v_mfma_f32_16x16x32_bf16 v[184:187], a[112:115], a[128:131], v[184:187]
ds_read_b128 a[48:51], v2 offset:12288
v_fmac_f32 v255, v23, v29
v_mfma_f32_16x16x32_bf16 v[184:187], a[116:119], a[132:135], v[184:187]
v_fmac_f32 v255, v24, v28
v_mul_f32 v255, v255, v247
v_mfma_f32_16x16x32_bf16 v[188:191], a[120:123], a[128:131], v[188:191]
v_cvt_pk_bf16_f32 v246, v254, v255
v_accvgpr_write_b32 a189, v246
v_mfma_f32_16x16x32_bf16 v[188:191], a[124:127], a[132:135], v[188:191]
s_waitcnt lgkmcnt(2)
v_mul_f32 v254, v22, v253
v_and_b32 v25, s58, v231
v_mfma_f32_16x16x32_bf16 v[192:195], a[64:67], a[136:139], v[192:195]
ds_read_b64_tr_b16 a[128:129], v10 offset:32768
v_and_b32 v247, s58, v240
v_mfma_f32_16x16x32_bf16 v[192:195], a[68:71], a[140:143], v[192:195]
v_fmac_f32 v254, v23, v30
v_fmac_f32 v254, v24, v29
v_mfma_f32_16x16x32_bf16 v[196:199], a[72:75], a[136:139], v[196:199]
ds_read_b64_tr_b16 a[130:131], v10 offset:34816
v_fmac_f32 v254, v25, v28
v_mfma_f32_16x16x32_bf16 v[196:199], a[76:79], a[140:143], v[196:199]
v_mul_f32 v254, v254, v247
v_cvt_pk_bf16_f32 v246, v255, v254
v_accvgpr_write_b32 a185, v246
v_mfma_f32_16x16x32_bf16 v[200:203], a[80:83], a[136:139], v[200:203]
s_lshr_b32 s22, s3, 1
ds_read_b64_tr_b16 a[132:133], v10 offset:49152
v_mul_f32 v255, v23, v253
v_mfma_f32_16x16x32_bf16 v[200:203], a[84:87], a[140:143], v[200:203]
s_mul_i32 s22, s22, 2097152
v_and_b32 v22, s58, v232
v_and_b32 v247, s58, v241
v_mfma_f32_16x16x32_bf16 v[204:207], a[88:91], a[136:139], v[204:207]
s_and_b32 s23, s3, 1
ds_read_b64_tr_b16 a[134:135], v10 offset:51200
v_fmac_f32 v255, v24, v30
v_mfma_f32_16x16x32_bf16 v[204:207], a[92:95], a[140:143], v[204:207]
s_lshl_b32 s23, s23, 5
v_fmac_f32 v255, v25, v29
v_fmac_f32 v255, v22, v28
v_mfma_f32_16x16x32_bf16 v[208:211], a[96:99], a[136:139], v[208:211]
s_lshl_b32 s56, s39, 6
ds_read_b128 a[52:55], v3 offset:12288
v_mul_f32 v255, v255, v247
v_mfma_f32_16x16x32_bf16 v[208:211], a[100:103], a[140:143], v[208:211]
s_add_u32 s23, s23, s56
v_cvt_pk_bf16_f32 v246, v254, v255
v_accvgpr_write_b32 a190, v246
v_mfma_f32_16x16x32_bf16 v[212:215], a[104:107], a[136:139], v[212:215]
s_mul_i32 s23, s23, 4224
ds_read_b128 a[56:59], v2 offset:14336
v_mul_f32 v254, v24, v253
v_and_b32 v23, s58, v233
v_mfma_f32_16x16x32_bf16 v[212:215], a[108:111], a[140:143], v[212:215]
s_add_u32 s22, s22, s23
v_and_b32 v247, s58, v242
v_fmac_f32 v254, v25, v30
v_mfma_f32_16x16x32_bf16 v[216:219], a[112:115], a[136:139], v[216:219]
s_add_u32 s57, s22, 83886200
v_fmac_f32 v254, v22, v29
v_fmac_f32 v254, v23, v28
v_mfma_f32_16x16x32_bf16 v[216:219], a[116:119], a[140:143], v[216:219]
s_lshl_b32 s23, s38, 7
v_mul_f32 v254, v254, v247
v_cvt_pk_bf16_f32 v246, v255, v254
v_mfma_f32_16x16x32_bf16 v[220:223], a[120:123], a[136:139], v[220:223]
s_add_u32 s22, s22, s23
ds_read_b128 a[60:63], v3 offset:14336
v_accvgpr_write_b32 a186, v246
v_mfma_f32_16x16x32_bf16 v[220:223], a[124:127], a[140:143], v[220:223]
s_waitcnt lgkmcnt(3)
s_add_u32 s56, s22, 83886208
v_mul_f32 v255, v25, v253
v_and_b32 v24, s58, v234
v_mfma_f32_16x16x32_bf16 a[192:195], a[64:67], a[128:131], a[192:195]
s_cmp_lt_u32 s2, 224
ds_read_b64_tr_b16 a[136:137], v11 offset:32768
v_and_b32 v247, s58, v243
v_mfma_f32_16x16x32_bf16 a[192:195], a[68:71], a[132:135], a[192:195]
s_cselect_b32 s56, s56, 3221225472
v_fmac_f32 v255, v22, v30
v_fmac_f32 v255, v23, v29
v_mfma_f32_16x16x32_bf16 a[196:199], a[72:75], a[128:131], a[196:199]
s_cmp_eq_u32 s38, 0
ds_read_b64_tr_b16 a[138:139], v11 offset:34816
v_fmac_f32 v255, v24, v28
v_mul_f32 v255, v255, v247
v_mfma_f32_16x16x32_bf16 a[196:199], a[76:79], a[132:135], a[196:199]
s_cselect_b32 s57, s57, 3221225472
v_cvt_pk_bf16_f32 v246, v254, v255
v_accvgpr_write_b32 a191, v246
v_mfma_f32_16x16x32_bf16 a[200:203], a[80:83], a[128:131], a[200:203]
ds_read_b64_tr_b16 a[140:141], v11 offset:49152
v_mul_f32 v254, v22, v253
v_mfma_f32_16x16x32_bf16 a[200:203], a[84:87], a[132:135], a[200:203]
v_and_b32 v25, s58, v235
v_and_b32 v247, s58, v244
v_mfma_f32_16x16x32_bf16 a[204:207], a[88:91], a[128:131], a[204:207]
ds_read_b64_tr_b16 a[142:143], v11 offset:51200
v_fmac_f32 v254, v23, v30
v_mfma_f32_16x16x32_bf16 a[204:207], a[92:95], a[132:135], a[204:207]
ds_write_b128 v252, a[176:179] offset:0
v_fmac_f32 v254, v24, v29
v_mfma_f32_16x16x32_bf16 a[208:211], a[96:99], a[128:131], a[208:211]
v_fmac_f32 v254, v25, v28
v_mul_f32 v254, v254, v247
v_mfma_f32_16x16x32_bf16 a[208:211], a[100:103], a[132:135], a[208:211]
ds_write_b128 v252, a[180:183] offset:8192
v_cvt_pk_bf16_f32 v246, v255, v254
v_accvgpr_write_b32 a187, v246
v_mfma_f32_16x16x32_bf16 a[212:215], a[104:107], a[128:131], a[212:215]
v_mfma_f32_16x16x32_bf16 a[212:215], a[108:111], a[132:135], a[212:215]
ds_write_b128 v252, a[184:187] offset:128
v_mfma_f32_16x16x32_bf16 a[216:219], a[112:115], a[128:131], a[216:219]
v_mfma_f32_16x16x32_bf16 a[216:219], a[116:119], a[132:135], a[216:219]
ds_write_b128 v252, a[188:191] offset:8320
v_mfma_f32_16x16x32_bf16 a[220:223], a[120:123], a[128:131], a[220:223]
s_waitcnt vmcnt(2) lgkmcnt(0)
v_mfma_f32_16x16x32_bf16 a[220:223], a[124:127], a[132:135], a[220:223]
s_barrier
v_mfma_f32_16x16x32_bf16 a[224:227], a[64:67], a[136:139], a[224:227]
s_add_u32 m0, s29, 98304
ds_read_b64_tr_b16 a[128:129], v4 offset:0
v_lshrrev_b32 v22, 8, v1
v_mfma_f32_16x16x32_bf16 a[224:227], a[68:71], a[140:143], a[224:227]
buffer_load_dwordx4 v16, s[12:15], s26 offen offset:0 lds
v_mfma_f32_16x16x32_bf16 a[228:231], a[72:75], a[136:139], a[228:231]
ds_read_b64_tr_b16 a[130:131], v4 offset:2048
v_lshlrev_b32 v22, 4, v22
v_mfma_f32_16x16x32_bf16 a[228:231], a[76:79], a[140:143], a[228:231]
v_xor_b32 v22, v22, v1
v_add_u32 v22, s29, v22
v_mfma_f32_16x16x32_bf16 a[232:235], a[80:83], a[136:139], a[232:235]
ds_read_b64_tr_b16 a[132:133], v4 offset:16384
v_add_u32 v22, 147456, v22
v_mfma_f32_16x16x32_bf16 a[232:235], a[84:87], a[140:143], a[232:235]
buffer_load_dwordx4 v17, s[12:15], s26 offen offset:1024 lds
v_mfma_f32_16x16x32_bf16 a[236:239], a[88:91], a[136:139], a[236:239]
ds_read_b64_tr_b16 a[134:135], v4 offset:18432
v_xor_b32 v23, 64, v22
v_mfma_f32_16x16x32_bf16 a[236:239], a[92:95], a[140:143], a[236:239]
v_lshrrev_b32 v224, 7, v1
v_mul_u32_u24 v224, 4224, v224
v_mfma_f32_16x16x32_bf16 a[240:243], a[96:99], a[136:139], a[240:243]
v_and_b32 v225, 0x70, v1
v_add_u32 v224, v224, v225
v_mfma_f32_16x16x32_bf16 a[240:243], a[100:103], a[140:143], a[240:243]
buffer_load_dwordx4 v18, s[12:15], s26 offen offset:2048 lds
v_mfma_f32_16x16x32_bf16 a[244:247], a[104:107], a[136:139], a[244:247]
v_bfe_u32 v225, v1, 4, 5
v_mul_u32_u24 v225, 4224, v225
v_mfma_f32_16x16x32_bf16 a[244:247], a[108:111], a[140:143], a[244:247]
v_mov_b32 v226, 0
v_mov_b32 v227, 0
v_mfma_f32_16x16x32_bf16 a[248:251], a[112:115], a[136:139], a[248:251]
v_mfma_f32_16x16x32_bf16 a[248:251], a[116:119], a[140:143], a[248:251]
buffer_load_dwordx4 v19, s[12:15], s26 offen offset:3072 lds
v_mfma_f32_16x16x32_bf16 a[252:255], a[120:123], a[136:139], a[252:255]
s_add_u32 s26, s26, 524288
v_mfma_f32_16x16x32_bf16 a[252:255], a[124:127], a[140:143], a[252:255]
s_waitcnt lgkmcnt(0)
v_mfma_f32_16x16x32_bf16 v[32:35], a[0:3], a[128:131], v[32:35]
s_add_u32 m0, s29, 114688
ds_read_b64_tr_b16 a[136:137], v5 offset:0
v_mfma_f32_16x16x32_bf16 v[32:35], a[4:7], a[132:135], v[32:35]
buffer_load_dwordx4 v16, s[12:15], s27 offen offset:0 lds
v_mfma_f32_16x16x32_bf16 v[36:39], a[8:11], a[128:131], v[36:39]
s_mul_i32 s52, s20, 7
ds_read_b64_tr_b16 a[138:139], v5 offset:2048
v_mfma_f32_16x16x32_bf16 v[36:39], a[12:15], a[132:135], v[36:39]
s_add_u32 s52, s52, s21
buffer_store_dwordx2 v[226:227], v225, s[4:7], s57 offen sc1
v_mfma_f32_16x16x32_bf16 v[40:43], a[16:19], a[128:131], v[40:43]
s_lshl_b32 s53, s52, 2
ds_read_b64_tr_b16 a[140:141], v5 offset:16384
v_mfma_f32_16x16x32_bf16 v[40:43], a[20:23], a[132:135], v[40:43]
s_add_u32 s53, s53, s3
buffer_load_dwordx4 v17, s[12:15], s27 offen offset:1024 lds
v_mfma_f32_16x16x32_bf16 v[44:47], a[24:27], a[128:131], v[44:47]
s_lshl_b32 s49, s53, 12
ds_read_b64_tr_b16 a[142:143], v5 offset:18432
v_mfma_f32_16x16x32_bf16 v[44:47], a[28:31], a[132:135], v[44:47]
s_mul_i32 s53, s53, 4224
v_mfma_f32_16x16x32_bf16 v[48:51], a[32:35], a[128:131], v[48:51]
s_add_u32 s53, s53, 83886080
ds_read_b128 a[64:67], v2 offset:32768
v_mfma_f32_16x16x32_bf16 v[48:51], a[36:39], a[132:135], v[48:51]
s_lshr_b32 s52, s52, 4
buffer_load_dwordx4 v18, s[12:15], s27 offen offset:2048 lds
v_mfma_f32_16x16x32_bf16 v[52:55], a[40:43], a[128:131], v[52:55]
s_min_u32 s52, s52, 6
ds_read_b128 a[68:71], v3 offset:32768
v_mfma_f32_16x16x32_bf16 v[52:55], a[44:47], a[132:135], v[52:55]
s_lshl_b32 s52, s52, 7
ds_read_b128 a[176:179], v22 offset:0
v_mfma_f32_16x16x32_bf16 v[56:59], a[48:51], a[128:131], v[56:59]
s_add_u32 s52, s52, 94392320
ds_read_b128 a[180:183], v23 offset:1024
v_mfma_f32_16x16x32_bf16 v[56:59], a[52:55], a[132:135], v[56:59]
buffer_load_dwordx4 v19, s[12:15], s27 offen offset:3072 lds
v_mfma_f32_16x16x32_bf16 v[60:63], a[56:59], a[128:131], v[60:63]
s_add_u32 s27, s27, 524288
ds_read_b128 a[72:75], v2 offset:34816
v_mfma_f32_16x16x32_bf16 v[60:63], a[60:63], a[132:135], v[60:63]
s_waitcnt lgkmcnt(5)
ds_read_b128 a[184:187], v22 offset:2048
v_mfma_f32_16x16x32_bf16 v[64:67], a[0:3], a[136:139], v[64:67]
s_add_u32 m0, s28, 0
ds_read_b64_tr_b16 a[128:129], v6 offset:0
v_mfma_f32_16x16x32_bf16 v[64:67], a[4:7], a[140:143], v[64:67]
buffer_load_dwordx4 v12, s[8:11], s24 offen offset:0 lds
v_mfma_f32_16x16x32_bf16 v[68:71], a[8:11], a[136:139], v[68:71]
ds_read_b64_tr_b16 a[130:131], v6 offset:2048
v_mfma_f32_16x16x32_bf16 v[68:71], a[12:15], a[140:143], v[68:71]
ds_read_b128 a[188:191], v23 offset:3072
v_mfma_f32_16x16x32_bf16 v[72:75], a[16:19], a[136:139], v[72:75]
ds_read_b64_tr_b16 a[132:133], v6 offset:16384
v_bfe_u32 v231, v1, 4, 5
v_mfma_f32_16x16x32_bf16 v[72:75], a[20:23], a[140:143], v[72:75]
buffer_load_dwordx4 v13, s[8:11], s24 offen offset:1024 lds
v_mfma_f32_16x16x32_bf16 v[76:79], a[24:27], a[136:139], v[76:79]
ds_read_b64_tr_b16 a[134:135], v6 offset:18432
v_lshlrev_b32 v231, 2, v231
v_mfma_f32_16x16x32_bf16 v[76:79], a[28:31], a[140:143], v[76:79]
v_lshlrev_b32 v229, 3, v1
v_min_u32 v229, 4096, v229
v_mfma_f32_16x16x32_bf16 v[80:83], a[32:35], a[136:139], v[80:83]
ds_read_b128 a[76:79], v3 offset:34816
v_mfma_f32_16x16x32_bf16 v[80:83], a[36:39], a[140:143], v[80:83]
buffer_load_dwordx4 v14, s[8:11], s24 offen offset:2048 lds
v_mfma_f32_16x16x32_bf16 v[84:87], a[40:43], a[136:139], v[84:87]
v_mfma_f32_16x16x32_bf16 v[84:87], a[44:47], a[140:143], v[84:87]
v_mfma_f32_16x16x32_bf16 v[88:91], a[48:51], a[136:139], v[88:91]
ds_read_b128 a[80:83], v2 offset:36864
v_mfma_f32_16x16x32_bf16 v[88:91], a[52:55], a[140:143], v[88:91]
buffer_load_dwordx4 v15, s[8:11], s24 offen offset:3072 lds
v_mfma_f32_16x16x32_bf16 v[92:95], a[56:59], a[136:139], v[92:95]
s_add_u32 s24, s24, 128
ds_read_b128 a[84:87], v3 offset:36864
v_mfma_f32_16x16x32_bf16 v[92:95], a[60:63], a[140:143], v[92:95]
s_waitcnt lgkmcnt(3)
v_mfma_f32_16x16x32_bf16 v[96:99], a[0:3], a[128:131], v[96:99]
s_add_u32 m0, s28, 4096
ds_read_b64_tr_b16 a[136:137], v7 offset:0
v_mfma_f32_16x16x32_bf16 v[96:99], a[4:7], a[132:135], v[96:99]
buffer_load_dwordx4 v12, s[8:11], s25 offen offset:0 lds
v_mfma_f32_16x16x32_bf16 v[100:103], a[8:11], a[128:131], v[100:103]
ds_read_b64_tr_b16 a[138:139], v7 offset:2048
v_mfma_f32_16x16x32_bf16 v[100:103], a[12:15], a[132:135], v[100:103]
v_mfma_f32_16x16x32_bf16 v[104:107], a[16:19], a[128:131], v[104:107]
ds_read_b64_tr_b16 a[140:141], v7 offset:16384
v_mfma_f32_16x16x32_bf16 v[104:107], a[20:23], a[132:135], v[104:107]
buffer_load_dwordx4 v13, s[8:11], s25 offen offset:1024 lds
v_mfma_f32_16x16x32_bf16 v[108:111], a[24:27], a[128:131], v[108:111]
ds_read_b64_tr_b16 a[142:143], v7 offset:18432
v_mfma_f32_16x16x32_bf16 v[108:111], a[28:31], a[132:135], v[108:111]
v_mfma_f32_16x16x32_bf16 v[112:115], a[32:35], a[128:131], v[112:115]
v_mfma_f32_16x16x32_bf16 v[112:115], a[36:39], a[132:135], v[112:115]
buffer_load_dwordx4 v14, s[8:11], s25 offen offset:2048 lds
v_mfma_f32_16x16x32_bf16 v[116:119], a[40:43], a[128:131], v[116:119]
ds_read_b128 a[88:91], v2 offset:38912
v_mfma_f32_16x16x32_bf16 v[116:119], a[44:47], a[132:135], v[116:119]
v_mfma_f32_16x16x32_bf16 v[120:123], a[48:51], a[128:131], v[120:123]
ds_read_b128 a[92:95], v3 offset:38912
v_mfma_f32_16x16x32_bf16 v[120:123], a[52:55], a[132:135], v[120:123]
buffer_load_dwordx4 v15, s[8:11], s25 offen offset:3072 lds
v_mfma_f32_16x16x32_bf16 v[124:127], a[56:59], a[128:131], v[124:127]
s_add_u32 s25, s25, 128
v_mfma_f32_16x16x32_bf16 v[124:127], a[60:63], a[132:135], v[124:127]
s_waitcnt lgkmcnt(2)
v_mfma_f32_16x16x32_bf16 v[128:131], a[0:3], a[136:139], v[128:131]
ds_read_b64_tr_b16 a[128:129], v8 offset:0
v_mfma_f32_16x16x32_bf16 v[128:131], a[4:7], a[140:143], v[128:131]
buffer_store_dwordx4 a[176:179], v224, s[4:7], s56 offen sc1
v_mfma_f32_16x16x32_bf16 v[132:135], a[8:11], a[136:139], v[132:135]
s_add_u32 s56, s56, 33792
ds_read_b64_tr_b16 a[130:131], v8 offset:2048
v_mfma_f32_16x16x32_bf16 v[132:135], a[12:15], a[140:143], v[132:135]
v_mfma_f32_16x16x32_bf16 v[136:139], a[16:19], a[136:139], v[136:139]
ds_read_b64_tr_b16 a[132:133], v8 offset:16384
v_mfma_f32_16x16x32_bf16 v[136:139], a[20:23], a[140:143], v[136:139]
v_mfma_f32_16x16x32_bf16 v[140:143], a[24:27], a[136:139], v[140:143]
s_cmp_lt_u32 s21, 7
ds_read_b64_tr_b16 a[134:135], v8 offset:18432
v_mfma_f32_16x16x32_bf16 v[140:143], a[28:31], a[140:143], v[140:143]
s_cselect_b32 s53, s53, 3221225472
v_mfma_f32_16x16x32_bf16 v[144:147], a[32:35], a[136:139], v[144:147]
s_cselect_b32 s49, s49, 3221225472
ds_read_b128 a[96:99], v2 offset:40960
v_mfma_f32_16x16x32_bf16 v[144:147], a[36:39], a[140:143], v[144:147]
s_add_u32 s48, s53, 2097152
v_mfma_f32_16x16x32_bf16 v[148:151], a[40:43], a[136:139], v[148:151]
v_mfma_f32_16x16x32_bf16 v[148:151], a[44:47], a[140:143], v[148:151]
v_mfma_f32_16x16x32_bf16 v[152:155], a[48:51], a[136:139], v[152:155]
ds_read_b128 a[100:103], v3 offset:40960
v_mfma_f32_16x16x32_bf16 v[152:155], a[52:55], a[140:143], v[152:155]
v_mfma_f32_16x16x32_bf16 v[156:159], a[56:59], a[136:139], v[156:159]
ds_read_b128 a[104:107], v2 offset:43008
v_mfma_f32_16x16x32_bf16 v[156:159], a[60:63], a[140:143], v[156:159]
s_waitcnt lgkmcnt(3)
v_mfma_f32_16x16x32_bf16 v[160:163], a[0:3], a[128:131], v[160:163]
ds_read_b64_tr_b16 a[136:137], v9 offset:0
v_mfma_f32_16x16x32_bf16 v[160:163], a[4:7], a[132:135], v[160:163]
v_mfma_f32_16x16x32_bf16 v[164:167], a[8:11], a[128:131], v[164:167]
ds_read_b64_tr_b16 a[138:139], v9 offset:2048
v_mfma_f32_16x16x32_bf16 v[164:167], a[12:15], a[132:135], v[164:167]
buffer_store_dwordx4 a[180:183], v224, s[4:7], s56 offen sc1
v_mfma_f32_16x16x32_bf16 v[168:171], a[16:19], a[128:131], v[168:171]
s_add_u32 s56, s56, 33792
ds_read_b64_tr_b16 a[140:141], v9 offset:16384
v_mfma_f32_16x16x32_bf16 v[168:171], a[20:23], a[132:135], v[168:171]
v_mfma_f32_16x16x32_bf16 v[172:175], a[24:27], a[128:131], v[172:175]
ds_read_b64_tr_b16 a[142:143], v9 offset:18432
v_mfma_f32_16x16x32_bf16 v[172:175], a[28:31], a[132:135], v[172:175]
v_mfma_f32_16x16x32_bf16 v[176:179], a[32:35], a[128:131], v[176:179]
v_mfma_f32_16x16x32_bf16 v[176:179], a[36:39], a[132:135], v[176:179]
v_mfma_f32_16x16x32_bf16 v[180:183], a[40:43], a[128:131], v[180:183]
ds_read_b128 a[108:111], v3 offset:43008
v_mfma_f32_16x16x32_bf16 v[180:183], a[44:47], a[132:135], v[180:183]
v_mfma_f32_16x16x32_bf16 v[184:187], a[48:51], a[128:131], v[184:187]
ds_read_b128 a[112:115], v2 offset:45056
v_mfma_f32_16x16x32_bf16 v[184:187], a[52:55], a[132:135], v[184:187]
v_mfma_f32_16x16x32_bf16 v[188:191], a[56:59], a[128:131], v[188:191]
v_mfma_f32_16x16x32_bf16 v[188:191], a[60:63], a[132:135], v[188:191]
s_waitcnt lgkmcnt(2)
v_mfma_f32_16x16x32_bf16 v[192:195], a[0:3], a[136:139], v[192:195]
ds_read_b64_tr_b16 a[128:129], v10 offset:0
v_mfma_f32_16x16x32_bf16 v[192:195], a[4:7], a[140:143], v[192:195]
v_mfma_f32_16x16x32_bf16 v[196:199], a[8:11], a[136:139], v[196:199]
ds_read_b64_tr_b16 a[130:131], v10 offset:2048
v_mfma_f32_16x16x32_bf16 v[196:199], a[12:15], a[140:143], v[196:199]
v_mfma_f32_16x16x32_bf16 v[200:203], a[16:19], a[136:139], v[200:203]
ds_read_b64_tr_b16 a[132:133], v10 offset:16384
v_mfma_f32_16x16x32_bf16 v[200:203], a[20:23], a[140:143], v[200:203]
buffer_store_dwordx4 a[184:187], v224, s[4:7], s56 offen sc1
v_mfma_f32_16x16x32_bf16 v[204:207], a[24:27], a[136:139], v[204:207]
s_add_u32 s56, s56, 33792
ds_read_b64_tr_b16 a[134:135], v10 offset:18432
v_mfma_f32_16x16x32_bf16 v[204:207], a[28:31], a[140:143], v[204:207]
v_mfma_f32_16x16x32_bf16 v[208:211], a[32:35], a[136:139], v[208:211]
ds_read_b128 a[116:119], v3 offset:45056
v_mfma_f32_16x16x32_bf16 v[208:211], a[36:39], a[140:143], v[208:211]
v_mfma_f32_16x16x32_bf16 v[212:215], a[40:43], a[136:139], v[212:215]
ds_read_b128 a[120:123], v2 offset:47104
v_mfma_f32_16x16x32_bf16 v[212:215], a[44:47], a[140:143], v[212:215]
v_mfma_f32_16x16x32_bf16 v[216:219], a[48:51], a[136:139], v[216:219]
v_mfma_f32_16x16x32_bf16 v[216:219], a[52:55], a[140:143], v[216:219]
v_mfma_f32_16x16x32_bf16 v[220:223], a[56:59], a[136:139], v[220:223]
ds_read_b128 a[124:127], v3 offset:47104
v_mfma_f32_16x16x32_bf16 v[220:223], a[60:63], a[140:143], v[220:223]
s_waitcnt lgkmcnt(3)
v_mfma_f32_16x16x32_bf16 a[192:195], a[0:3], a[128:131], a[192:195]
ds_read_b64_tr_b16 a[136:137], v11 offset:0
v_mfma_f32_16x16x32_bf16 a[192:195], a[4:7], a[132:135], a[192:195]
v_mfma_f32_16x16x32_bf16 a[196:199], a[8:11], a[128:131], a[196:199]
ds_read_b64_tr_b16 a[138:139], v11 offset:2048
v_mfma_f32_16x16x32_bf16 a[196:199], a[12:15], a[132:135], a[196:199]
v_mfma_f32_16x16x32_bf16 a[200:203], a[16:19], a[128:131], a[200:203]
ds_read_b64_tr_b16 a[140:141], v11 offset:16384
v_mfma_f32_16x16x32_bf16 a[200:203], a[20:23], a[132:135], a[200:203]
v_mfma_f32_16x16x32_bf16 a[204:207], a[24:27], a[128:131], a[204:207]
ds_read_b64_tr_b16 a[142:143], v11 offset:18432
v_mfma_f32_16x16x32_bf16 a[204:207], a[28:31], a[132:135], a[204:207]
buffer_store_dwordx4 a[188:191], v224, s[4:7], s56 offen sc1
v_mfma_f32_16x16x32_bf16 a[208:211], a[32:35], a[128:131], a[208:211]
s_add_u32 s56, s56, 33792
v_mfma_f32_16x16x32_bf16 a[208:211], a[36:39], a[132:135], a[208:211]
v_mfma_f32_16x16x32_bf16 a[212:215], a[40:43], a[128:131], a[212:215]
v_mfma_f32_16x16x32_bf16 a[212:215], a[44:47], a[132:135], a[212:215]
v_mfma_f32_16x16x32_bf16 a[216:219], a[48:51], a[128:131], a[216:219]
v_mfma_f32_16x16x32_bf16 a[216:219], a[52:55], a[132:135], a[216:219]
v_mfma_f32_16x16x32_bf16 a[220:223], a[56:59], a[128:131], a[220:223]
s_waitcnt vmcnt(4) lgkmcnt(0)
v_mfma_f32_16x16x32_bf16 a[220:223], a[60:63], a[132:135], a[220:223]
s_barrier
v_mfma_f32_16x16x32_bf16 a[224:227], a[0:3], a[136:139], a[224:227]
s_add_u32 m0, s29, 65536
ds_read_b64_tr_b16 a[128:129], v4 offset:32768
v_mfma_f32_16x16x32_bf16 a[224:227], a[4:7], a[140:143], a[224:227]
buffer_load_dwordx4 v16, s[12:15], s26 offen offset:0 lds
v_mfma_f32_16x16x32_bf16 a[228:231], a[8:11], a[136:139], a[228:231]
ds_read_b64_tr_b16 a[130:131], v4 offset:34816
v_cmp_gt_u32 vcc, s50, v245
v_mfma_f32_16x16x32_bf16 a[228:231], a[12:15], a[140:143], a[228:231]
v_mfma_f32_16x16x32_bf16 a[232:235], a[16:19], a[136:139], a[232:235]
ds_read_b64_tr_b16 a[132:133], v4 offset:49152
v_mfma_f32_16x16x32_bf16 a[232:235], a[20:23], a[140:143], a[232:235]
buffer_load_dwordx4 v17, s[12:15], s26 offen offset:1024 lds
v_mfma_f32_16x16x32_bf16 a[236:239], a[24:27], a[136:139], a[236:239]
ds_read_b64_tr_b16 a[134:135], v4 offset:51200
v_mfma_f32_16x16x32_bf16 a[236:239], a[28:31], a[140:143], a[236:239]
v_mfma_f32_16x16x32_bf16 a[240:243], a[32:35], a[136:139], a[240:243]
v_mfma_f32_16x16x32_bf16 a[240:243], a[36:39], a[140:143], a[240:243]
buffer_load_dwordx4 v18, s[12:15], s26 offen offset:2048 lds
v_mfma_f32_16x16x32_bf16 a[244:247], a[40:43], a[136:139], a[244:247]
v_mfma_f32_16x16x32_bf16 a[244:247], a[44:47], a[140:143], a[244:247]
v_mfma_f32_16x16x32_bf16 a[248:251], a[48:51], a[136:139], a[248:251]
v_mfma_f32_16x16x32_bf16 a[248:251], a[52:55], a[140:143], a[248:251]
buffer_load_dwordx4 v19, s[12:15], s26 offen offset:3072 lds
v_mfma_f32_16x16x32_bf16 a[252:255], a[56:59], a[136:139], a[252:255]
s_add_u32 s26, s26, 524288
v_mfma_f32_16x16x32_bf16 a[252:255], a[60:63], a[140:143], a[252:255]
s_waitcnt lgkmcnt(0)
s_mov_b32 s82, s59
s_cbranch_vccnz M_cntspinV
s_branch Lg_501
PAD_25:
s_cbranch_execz PAD_29
Lg_501t:
buffer_load_dword v230, v231, s[4:7], s52 offen sc1
v_mfma_f32_16x16x32_bf16 v[32:35], a[64:67], a[128:131], v[32:35]
s_add_u32 m0, s29, 81920
ds_read_b64_tr_b16 a[136:137], v5 offset:32768
v_mfma_f32_16x16x32_bf16 v[32:35], a[68:71], a[132:135], v[32:35]
buffer_load_dwordx4 v16, s[12:15], s27 offen offset:0 lds
v_mfma_f32_16x16x32_bf16 v[36:39], a[72:75], a[128:131], v[36:39]
s_and_b32 s44, s3, 1
ds_read_b64_tr_b16 a[138:139], v5 offset:34816
v_mfma_f32_16x16x32_bf16 v[36:39], a[76:79], a[132:135], v[36:39]
s_lshl_b32 s44, s44, 8
v_mfma_f32_16x16x32_bf16 v[40:43], a[80:83], a[128:131], v[40:43]
s_lshl_b32 s45, s3, 7
ds_read_b64_tr_b16 a[140:141], v5 offset:49152
v_mfma_f32_16x16x32_bf16 v[40:43], a[84:87], a[132:135], v[40:43]
s_xor_b32 s44, s44, s45
buffer_load_dwordx4 v17, s[12:15], s27 offen offset:1024 lds
v_mfma_f32_16x16x32_bf16 v[44:47], a[88:91], a[128:131], v[44:47]
s_xor_b32 s44, s44, 196608
ds_read_b64_tr_b16 a[142:143], v5 offset:51200
v_mfma_f32_16x16x32_bf16 v[44:47], a[92:95], a[132:135], v[44:47]
v_mfma_f32_16x16x32_bf16 v[48:51], a[96:99], a[128:131], v[48:51]
ds_read_b128 a[0:3], v2 offset:0
v_mfma_f32_16x16x32_bf16 v[48:51], a[100:103], a[132:135], v[48:51]
buffer_load_dwordx4 v18, s[12:15], s27 offen offset:2048 lds
v_mfma_f32_16x16x32_bf16 v[52:55], a[104:107], a[128:131], v[52:55]
ds_read_b128 a[4:7], v3 offset:0
v_mfma_f32_16x16x32_bf16 v[52:55], a[108:111], a[132:135], v[52:55]
PAD_26:
s_cbranch_execz PAD_30
v_mfma_f32_16x16x32_bf16 v[56:59], a[112:115], a[128:131], v[56:59]
v_mfma_f32_16x16x32_bf16 v[56:59], a[116:119], a[132:135], v[56:59]
buffer_load_dwordx4 v19, s[12:15], s27 offen offset:3072 lds
v_mfma_f32_16x16x32_bf16 v[60:63], a[120:123], a[128:131], v[60:63]
s_add_u32 s27, s27, 524288
ds_read_b128 a[8:11], v2 offset:2048
v_mfma_f32_16x16x32_bf16 v[60:63], a[124:127], a[132:135], v[60:63]
s_waitcnt lgkmcnt(3)
v_mfma_f32_16x16x32_bf16 v[64:67], a[64:67], a[136:139], v[64:67]
s_add_u32 m0, s28, 32768
ds_read_b64_tr_b16 a[128:129], v6 offset:32768
v_mfma_f32_16x16x32_bf16 v[64:67], a[68:71], a[140:143], v[64:67]
buffer_load_dwordx4 v12, s[8:11], s24 offen offset:0 lds
v_mfma_f32_16x16x32_bf16 v[68:71], a[72:75], a[136:139], v[68:71]
ds_read_b64_tr_b16 a[130:131], v6 offset:34816
v_mfma_f32_16x16x32_bf16 v[68:71], a[76:79], a[140:143], v[68:71]
v_mfma_f32_16x16x32_bf16 v[72:75], a[80:83], a[136:139], v[72:75]
s_mov_b64 s[56:57], s[72:73]
ds_read_b64_tr_b16 a[132:133], v6 offset:49152
v_mfma_f32_16x16x32_bf16 v[72:75], a[84:87], a[140:143], v[72:75]
s_mov_b32 s58, 1835008
buffer_load_dwordx4 v13, s[8:11], s24 offen offset:1024 lds
v_mfma_f32_16x16x32_bf16 v[76:79], a[88:91], a[136:139], v[76:79]
s_mov_b32 s59, 0x20000
ds_read_b64_tr_b16 a[134:135], v6 offset:51200
v_mfma_f32_16x16x32_bf16 v[76:79], a[92:95], a[140:143], v[76:79]
v_mfma_f32_16x16x32_bf16 v[80:83], a[96:99], a[136:139], v[80:83]
ds_read_b128 a[12:15], v3 offset:2048
v_mfma_f32_16x16x32_bf16 v[80:83], a[100:103], a[140:143], v[80:83]
buffer_load_dwordx4 v14, s[8:11], s24 offen offset:2048 lds
v_mfma_f32_16x16x32_bf16 v[84:87], a[104:107], a[136:139], v[84:87]
v_mfma_f32_16x16x32_bf16 v[84:87], a[108:111], a[140:143], v[84:87]
v_mfma_f32_16x16x32_bf16 v[88:91], a[112:115], a[136:139], v[88:91]
ds_read_b128 a[16:19], v2 offset:4096
v_mfma_f32_16x16x32_bf16 v[88:91], a[116:119], a[140:143], v[88:91]
buffer_load_dwordx4 v15, s[8:11], s24 offen offset:3072 lds
v_mfma_f32_16x16x32_bf16 v[92:95], a[120:123], a[136:139], v[92:95]
s_add_u32 s24, s24, 128
ds_read_b128 a[20:23], v3 offset:4096
v_mfma_f32_16x16x32_bf16 v[92:95], a[124:127], a[140:143], v[92:95]
s_waitcnt lgkmcnt(3)
v_mfma_f32_16x16x32_bf16 v[96:99], a[64:67], a[128:131], v[96:99]
s_add_u32 m0, s28, 36864
ds_read_b64_tr_b16 a[136:137], v7 offset:32768
v_mfma_f32_16x16x32_bf16 v[96:99], a[68:71], a[132:135], v[96:99]
buffer_load_dwordx4 v12, s[8:11], s25 offen offset:0 lds
v_mfma_f32_16x16x32_bf16 v[100:103], a[72:75], a[128:131], v[100:103]
ds_read_b64_tr_b16 a[138:139], v7 offset:34816
v_mfma_f32_16x16x32_bf16 v[100:103], a[76:79], a[132:135], v[100:103]
v_mfma_f32_16x16x32_bf16 v[104:107], a[80:83], a[128:131], v[104:107]
ds_read_b64_tr_b16 a[140:141], v7 offset:49152
v_mfma_f32_16x16x32_bf16 v[104:107], a[84:87], a[132:135], v[104:107]
buffer_load_dwordx4 v13, s[8:11], s25 offen offset:1024 lds
v_mfma_f32_16x16x32_bf16 v[108:111], a[88:91], a[128:131], v[108:111]
ds_read_b64_tr_b16 a[142:143], v7 offset:51200
v_mfma_f32_16x16x32_bf16 v[108:111], a[92:95], a[132:135], v[108:111]
v_mfma_f32_16x16x32_bf16 v[112:115], a[96:99], a[128:131], v[112:115]
v_mfma_f32_16x16x32_bf16 v[112:115], a[100:103], a[132:135], v[112:115]
buffer_load_dwordx4 v14, s[8:11], s25 offen offset:2048 lds
v_mfma_f32_16x16x32_bf16 v[116:119], a[104:107], a[128:131], v[116:119]
ds_read_b128 a[24:27], v2 offset:6144
v_mfma_f32_16x16x32_bf16 v[116:119], a[108:111], a[132:135], v[116:119]
v_mfma_f32_16x16x32_bf16 v[120:123], a[112:115], a[128:131], v[120:123]
ds_read_b128 a[28:31], v3 offset:6144
v_mfma_f32_16x16x32_bf16 v[120:123], a[116:119], a[132:135], v[120:123]
buffer_load_dwordx4 v15, s[8:11], s25 offen offset:3072 lds
v_mfma_f32_16x16x32_bf16 v[124:127], a[120:123], a[128:131], v[124:127]
s_add_u32 s25, s25, 128
s_waitcnt vmcnt(12)
v_mfma_f32_16x16x32_bf16 v[124:127], a[124:127], a[132:135], v[124:127]
s_waitcnt lgkmcnt(2)
v_cmp_gt_u32 vcc, 1, v230
v_mfma_f32_16x16x32_bf16 v[128:131], a[64:67], a[136:139], v[128:131]
s_cbranch_vccnz M_ppspinV
M_ppokV:
ds_read_b64_tr_b16 a[128:129], v8 offset:32768
v_mfma_f32_16x16x32_bf16 v[128:131], a[68:71], a[140:143], v[128:131]
buffer_load_dword v230, v229, s[4:7], s53 offen sc1
v_mfma_f32_16x16x32_bf16 v[132:135], a[72:75], a[136:139], v[132:135]
s_mov_b64 s[8:9], s[76:77]
ds_read_b64_tr_b16 a[130:131], v8 offset:34816
v_mfma_f32_16x16x32_bf16 v[132:135], a[76:79], a[140:143], v[132:135]
s_mov_b32 s10, 1835008
buffer_load_dword v230, v229, s[4:7], s48 offen sc1
v_mfma_f32_16x16x32_bf16 v[136:139], a[80:83], a[136:139], v[136:139]
s_lshl_b32 s24, s37, 2
ds_read_b64_tr_b16 a[132:133], v8 offset:49152
v_mfma_f32_16x16x32_bf16 v[136:139], a[84:87], a[140:143], v[136:139]
s_add_u32 s24, s24, s3
buffer_load_dword v230, v229, s[56:59], s49 offen
v_mfma_f32_16x16x32_bf16 v[140:143], a[88:91], a[136:139], v[140:143]
s_mul_i32 s24, s24, 28672
ds_read_b64_tr_b16 a[134:135], v8 offset:51200
v_mfma_f32_16x16x32_bf16 v[140:143], a[92:95], a[140:143], v[140:143]
s_mov_b32 s28, s29
buffer_load_dword v21, v20, s[16:19], s43 offen
v_mfma_f32_16x16x32_bf16 v[144:147], a[96:99], a[136:139], v[144:147]
ds_read_b128 a[32:35], v2 offset:8192
v_mfma_f32_16x16x32_bf16 v[144:147], a[100:103], a[140:143], v[144:147]
buffer_load_dword v21, v20, s[16:19], s43 offen offset:256
v_mfma_f32_16x16x32_bf16 v[148:151], a[104:107], a[136:139], v[148:151]
v_mfma_f32_16x16x32_bf16 v[148:151], a[108:111], a[140:143], v[148:151]
v_mfma_f32_16x16x32_bf16 v[152:155], a[112:115], a[136:139], v[152:155]
ds_read_b128 a[36:39], v3 offset:8192
v_lshrrev_b32 v28, 7, v1
v_mfma_f32_16x16x32_bf16 v[152:155], a[116:119], a[140:143], v[152:155]
v_lshrrev_b32 v29, 1, v28
v_lshlrev_b32 v29, 4, v29
v_mfma_f32_16x16x32_bf16 v[156:159], a[120:123], a[136:139], v[156:159]
ds_read_b128 a[40:43], v2 offset:10240
v_and_b32 v30, 0x70, v1
v_mfma_f32_16x16x32_bf16 v[156:159], a[124:127], a[140:143], v[156:159]
s_waitcnt lgkmcnt(3)
v_xor_b32 v29, v29, v30
v_mul_u32_u24 v28, 896, v28
v_mfma_f32_16x16x32_bf16 v[160:163], a[64:67], a[128:131], v[160:163]
ds_read_b64_tr_b16 a[136:137], v9 offset:32768
v_add_u32 v12, v28, v29
v_mfma_f32_16x16x32_bf16 v[160:163], a[68:71], a[132:135], v[160:163]
v_xor_b32 v29, 64, v29
v_add_u32 v28, v28, v29
v_mfma_f32_16x16x32_bf16 v[164:167], a[72:75], a[128:131], v[164:167]
ds_read_b64_tr_b16 a[138:139], v9 offset:34816
v_add_u32 v13, 6144, v28
v_mfma_f32_16x16x32_bf16 v[164:167], a[76:79], a[132:135], v[164:167]
v_add_u32 v14, 12288, v12
v_add_u32 v15, 18432, v28
v_mfma_f32_16x16x32_bf16 v[168:171], a[80:83], a[128:131], v[168:171]
ds_read_b64_tr_b16 a[140:141], v9 offset:49152
v_xor_b32 v22, s44, v4
v_mfma_f32_16x16x32_bf16 v[168:171], a[84:87], a[132:135], v[168:171]
v_xor_b32 v23, 32, v22
v_xor_b32 v24, 64, v22
v_mfma_f32_16x16x32_bf16 v[172:175], a[88:91], a[128:131], v[172:175]
ds_read_b64_tr_b16 a[142:143], v9 offset:51200
v_xor_b32 v25, 96, v22
v_mfma_f32_16x16x32_bf16 v[172:175], a[92:95], a[132:135], v[172:175]
v_mfma_f32_16x16x32_bf16 v[176:179], a[96:99], a[128:131], v[176:179]
v_mfma_f32_16x16x32_bf16 v[176:179], a[100:103], a[132:135], v[176:179]
v_mfma_f32_16x16x32_bf16 v[180:183], a[104:107], a[128:131], v[180:183]
ds_read_b128 a[44:47], v3 offset:10240
v_mfma_f32_16x16x32_bf16 v[180:183], a[108:111], a[132:135], v[180:183]
v_mfma_f32_16x16x32_bf16 v[184:187], a[112:115], a[128:131], v[184:187]
ds_read_b128 a[48:51], v2 offset:12288
v_mfma_f32_16x16x32_bf16 v[184:187], a[116:119], a[132:135], v[184:187]
v_mfma_f32_16x16x32_bf16 v[188:191], a[120:123], a[128:131], v[188:191]
v_mfma_f32_16x16x32_bf16 v[188:191], a[124:127], a[132:135], v[188:191]
s_waitcnt lgkmcnt(2)
v_mfma_f32_16x16x32_bf16 v[192:195], a[64:67], a[136:139], v[192:195]
ds_read_b64_tr_b16 a[128:129], v10 offset:32768
v_mfma_f32_16x16x32_bf16 v[192:195], a[68:71], a[140:143], v[192:195]
v_mfma_f32_16x16x32_bf16 v[196:199], a[72:75], a[136:139], v[196:199]
ds_read_b64_tr_b16 a[130:131], v10 offset:34816
v_mfma_f32_16x16x32_bf16 v[196:199], a[76:79], a[140:143], v[196:199]
v_mfma_f32_16x16x32_bf16 v[200:203], a[80:83], a[136:139], v[200:203]
ds_read_b64_tr_b16 a[132:133], v10 offset:49152
v_mfma_f32_16x16x32_bf16 v[200:203], a[84:87], a[140:143], v[200:203]
v_mfma_f32_16x16x32_bf16 v[204:207], a[88:91], a[136:139], v[204:207]
ds_read_b64_tr_b16 a[134:135], v10 offset:51200
v_mfma_f32_16x16x32_bf16 v[204:207], a[92:95], a[140:143], v[204:207]
v_mfma_f32_16x16x32_bf16 v[208:211], a[96:99], a[136:139], v[208:211]
ds_read_b128 a[52:55], v3 offset:12288
v_mfma_f32_16x16x32_bf16 v[208:211], a[100:103], a[140:143], v[208:211]
v_mfma_f32_16x16x32_bf16 v[212:215], a[104:107], a[136:139], v[212:215]
ds_read_b128 a[56:59], v2 offset:14336
v_mfma_f32_16x16x32_bf16 v[212:215], a[108:111], a[140:143], v[212:215]
v_mfma_f32_16x16x32_bf16 v[216:219], a[112:115], a[136:139], v[216:219]
v_mfma_f32_16x16x32_bf16 v[216:219], a[116:119], a[140:143], v[216:219]
v_mfma_f32_16x16x32_bf16 v[220:223], a[120:123], a[136:139], v[220:223]
ds_read_b128 a[60:63], v3 offset:14336
v_mfma_f32_16x16x32_bf16 v[220:223], a[124:127], a[140:143], v[220:223]
s_waitcnt lgkmcnt(3)
v_mfma_f32_16x16x32_bf16 a[192:195], a[64:67], a[128:131], a[192:195]
ds_read_b64_tr_b16 a[136:137], v11 offset:32768
v_mfma_f32_16x16x32_bf16 a[192:195], a[68:71], a[132:135], a[192:195]
v_mfma_f32_16x16x32_bf16 a[196:199], a[72:75], a[128:131], a[196:199]
ds_read_b64_tr_b16 a[138:139], v11 offset:34816
v_mfma_f32_16x16x32_bf16 a[196:199], a[76:79], a[132:135], a[196:199]
v_mfma_f32_16x16x32_bf16 a[200:203], a[80:83], a[128:131], a[200:203]
ds_read_b64_tr_b16 a[140:141], v11 offset:49152
v_mfma_f32_16x16x32_bf16 a[200:203], a[84:87], a[132:135], a[200:203]
v_mfma_f32_16x16x32_bf16 a[204:207], a[88:91], a[128:131], a[204:207]
ds_read_b64_tr_b16 a[142:143], v11 offset:51200
v_mfma_f32_16x16x32_bf16 a[204:207], a[92:95], a[132:135], a[204:207]
v_mfma_f32_16x16x32_bf16 a[208:211], a[96:99], a[128:131], a[208:211]
v_mfma_f32_16x16x32_bf16 a[208:211], a[100:103], a[132:135], a[208:211]
v_mfma_f32_16x16x32_bf16 a[212:215], a[104:107], a[128:131], a[212:215]
v_mfma_f32_16x16x32_bf16 a[212:215], a[108:111], a[132:135], a[212:215]
v_mfma_f32_16x16x32_bf16 a[216:219], a[112:115], a[128:131], a[216:219]
v_mfma_f32_16x16x32_bf16 a[216:219], a[116:119], a[132:135], a[216:219]
v_mfma_f32_16x16x32_bf16 a[220:223], a[120:123], a[128:131], a[220:223]
s_waitcnt vmcnt(5) lgkmcnt(0)
v_mfma_f32_16x16x32_bf16 a[220:223], a[124:127], a[132:135], a[220:223]
s_barrier
v_mfma_f32_16x16x32_bf16 a[224:227], a[64:67], a[136:139], a[224:227]
s_add_u32 m0, s29, 98304
ds_read_b64_tr_b16 a[128:129], v4 offset:0
v_mfma_f32_16x16x32_bf16 a[224:227], a[68:71], a[140:143], a[224:227]
buffer_load_dwordx4 v16, s[12:15], s26 offen offset:0 lds
v_mfma_f32_16x16x32_bf16 a[228:231], a[72:75], a[136:139], a[228:231]
ds_read_b64_tr_b16 a[130:131], v4 offset:2048
v_mfma_f32_16x16x32_bf16 a[228:231], a[76:79], a[140:143], a[228:231]
v_mfma_f32_16x16x32_bf16 a[232:235], a[80:83], a[136:139], a[232:235]
ds_read_b64_tr_b16 a[132:133], v4 offset:16384
v_mfma_f32_16x16x32_bf16 a[232:235], a[84:87], a[140:143], a[232:235]
buffer_load_dwordx4 v17, s[12:15], s26 offen offset:1024 lds
v_mfma_f32_16x16x32_bf16 a[236:239], a[88:91], a[136:139], a[236:239]
ds_read_b64_tr_b16 a[134:135], v4 offset:18432
v_mfma_f32_16x16x32_bf16 a[236:239], a[92:95], a[140:143], a[236:239]
v_mfma_f32_16x16x32_bf16 a[240:243], a[96:99], a[136:139], a[240:243]
v_mfma_f32_16x16x32_bf16 a[240:243], a[100:103], a[140:143], a[240:243]
buffer_load_dwordx4 v18, s[12:15], s26 offen offset:2048 lds
v_mfma_f32_16x16x32_bf16 a[244:247], a[104:107], a[136:139], a[244:247]
v_mfma_f32_16x16x32_bf16 a[244:247], a[108:111], a[140:143], a[244:247]
v_mfma_f32_16x16x32_bf16 a[248:251], a[112:115], a[136:139], a[248:251]
v_mfma_f32_16x16x32_bf16 a[248:251], a[116:119], a[140:143], a[248:251]
buffer_load_dwordx4 v19, s[12:15], s26 offen offset:3072 lds
v_mfma_f32_16x16x32_bf16 a[252:255], a[120:123], a[136:139], a[252:255]
s_add_u32 s26, s26, 524288
v_mfma_f32_16x16x32_bf16 a[252:255], a[124:127], a[140:143], a[252:255]
s_waitcnt lgkmcnt(0)
v_mfma_f32_16x16x32_bf16 v[32:35], a[0:3], a[128:131], v[32:35]
s_add_u32 m0, s29, 114688
ds_read_b64_tr_b16 a[136:137], v5 offset:0
v_mfma_f32_16x16x32_bf16 v[32:35], a[4:7], a[132:135], v[32:35]
buffer_load_dwordx4 v16, s[12:15], s27 offen offset:0 lds
v_mfma_f32_16x16x32_bf16 v[36:39], a[8:11], a[128:131], v[36:39]
ds_read_b64_tr_b16 a[138:139], v5 offset:2048
v_mfma_f32_16x16x32_bf16 v[36:39], a[12:15], a[132:135], v[36:39]
v_mfma_f32_16x16x32_bf16 v[40:43], a[16:19], a[128:131], v[40:43]
ds_read_b64_tr_b16 a[140:141], v5 offset:16384
v_mfma_f32_16x16x32_bf16 v[40:43], a[20:23], a[132:135], v[40:43]
buffer_load_dwordx4 v17, s[12:15], s27 offen offset:1024 lds
v_mfma_f32_16x16x32_bf16 v[44:47], a[24:27], a[128:131], v[44:47]
ds_read_b64_tr_b16 a[142:143], v5 offset:18432
v_mfma_f32_16x16x32_bf16 v[44:47], a[28:31], a[132:135], v[44:47]
v_mfma_f32_16x16x32_bf16 v[48:51], a[32:35], a[128:131], v[48:51]
ds_read_b128 a[64:67], v2 offset:32768
v_mfma_f32_16x16x32_bf16 v[48:51], a[36:39], a[132:135], v[48:51]
buffer_load_dwordx4 v18, s[12:15], s27 offen offset:2048 lds
v_mfma_f32_16x16x32_bf16 v[52:55], a[40:43], a[128:131], v[52:55]
ds_read_b128 a[68:71], v3 offset:32768
v_mfma_f32_16x16x32_bf16 v[52:55], a[44:47], a[132:135], v[52:55]
v_mfma_f32_16x16x32_bf16 v[56:59], a[48:51], a[128:131], v[56:59]
v_mfma_f32_16x16x32_bf16 v[56:59], a[52:55], a[132:135], v[56:59]
buffer_load_dwordx4 v19, s[12:15], s27 offen offset:3072 lds
v_mfma_f32_16x16x32_bf16 v[60:63], a[56:59], a[128:131], v[60:63]
s_add_u32 s27, s27, 524288
ds_read_b128 a[72:75], v2 offset:34816
v_mfma_f32_16x16x32_bf16 v[60:63], a[60:63], a[132:135], v[60:63]
s_waitcnt lgkmcnt(3)
v_mfma_f32_16x16x32_bf16 v[64:67], a[0:3], a[136:139], v[64:67]
s_add_u32 m0, s28, 0
ds_read_b64_tr_b16 a[128:129], v6 offset:0
v_mfma_f32_16x16x32_bf16 v[64:67], a[4:7], a[140:143], v[64:67]
buffer_load_dwordx4 v12, s[8:11], s24 offen offset:0 lds
v_mfma_f32_16x16x32_bf16 v[68:71], a[8:11], a[136:139], v[68:71]
ds_read_b64_tr_b16 a[130:131], v6 offset:2048
v_mfma_f32_16x16x32_bf16 v[68:71], a[12:15], a[140:143], v[68:71]
v_mfma_f32_16x16x32_bf16 v[72:75], a[16:19], a[136:139], v[72:75]
ds_read_b64_tr_b16 a[132:133], v6 offset:16384
v_mfma_f32_16x16x32_bf16 v[72:75], a[20:23], a[140:143], v[72:75]
buffer_load_dwordx4 v13, s[8:11], s24 offen offset:1024 lds
v_mfma_f32_16x16x32_bf16 v[76:79], a[24:27], a[136:139], v[76:79]
ds_read_b64_tr_b16 a[134:135], v6 offset:18432
v_mfma_f32_16x16x32_bf16 v[76:79], a[28:31], a[140:143], v[76:79]
v_mfma_f32_16x16x32_bf16 v[80:83], a[32:35], a[136:139], v[80:83]
ds_read_b128 a[76:79], v3 offset:34816
v_mfma_f32_16x16x32_bf16 v[80:83], a[36:39], a[140:143], v[80:83]
buffer_load_dwordx4 v14, s[8:11], s24 offen offset:2048 lds
v_mfma_f32_16x16x32_bf16 v[84:87], a[40:43], a[136:139], v[84:87]
v_mfma_f32_16x16x32_bf16 v[84:87], a[44:47], a[140:143], v[84:87]
v_mfma_f32_16x16x32_bf16 v[88:91], a[48:51], a[136:139], v[88:91]
ds_read_b128 a[80:83], v2 offset:36864
v_mfma_f32_16x16x32_bf16 v[88:91], a[52:55], a[140:143], v[88:91]
buffer_load_dwordx4 v15, s[8:11], s24 offen offset:3072 lds
v_mfma_f32_16x16x32_bf16 v[92:95], a[56:59], a[136:139], v[92:95]
s_add_u32 s24, s24, 128
ds_read_b128 a[84:87], v3 offset:36864
v_mfma_f32_16x16x32_bf16 v[92:95], a[60:63], a[140:143], v[92:95]
s_waitcnt lgkmcnt(3)
s_mov_b64 s[12:13], s[80:81]
v_mfma_f32_16x16x32_bf16 v[96:99], a[0:3], a[128:131], v[96:99]
s_mov_b32 s14, 3670016
s_add_u32 m0, s28, 16384
ds_read_b64_tr_b16 a[136:137], v7 offset:0
v_mfma_f32_16x16x32_bf16 v[96:99], a[4:7], a[132:135], v[96:99]
buffer_load_dwordx4 v12, s[8:11], s24 offen offset:0 lds
v_mfma_f32_16x16x32_bf16 v[100:103], a[8:11], a[128:131], v[100:103]
ds_read_b64_tr_b16 a[138:139], v7 offset:2048
v_mfma_f32_16x16x32_bf16 v[100:103], a[12:15], a[132:135], v[100:103]
v_mfma_f32_16x16x32_bf16 v[104:107], a[16:19], a[128:131], v[104:107]
ds_read_b64_tr_b16 a[140:141], v7 offset:16384
v_mfma_f32_16x16x32_bf16 v[104:107], a[20:23], a[132:135], v[104:107]
buffer_load_dwordx4 v13, s[8:11], s24 offen offset:1024 lds
v_mfma_f32_16x16x32_bf16 v[108:111], a[24:27], a[128:131], v[108:111]
ds_read_b64_tr_b16 a[142:143], v7 offset:18432
v_mfma_f32_16x16x32_bf16 v[108:111], a[28:31], a[132:135], v[108:111]
v_mfma_f32_16x16x32_bf16 v[112:115], a[32:35], a[128:131], v[112:115]
v_mfma_f32_16x16x32_bf16 v[112:115], a[36:39], a[132:135], v[112:115]
buffer_load_dwordx4 v14, s[8:11], s24 offen offset:2048 lds
v_mfma_f32_16x16x32_bf16 v[116:119], a[40:43], a[128:131], v[116:119]
ds_read_b128 a[88:91], v2 offset:38912
v_mfma_f32_16x16x32_bf16 v[116:119], a[44:47], a[132:135], v[116:119]
v_mfma_f32_16x16x32_bf16 v[120:123], a[48:51], a[128:131], v[120:123]
ds_read_b128 a[92:95], v3 offset:38912
v_mfma_f32_16x16x32_bf16 v[120:123], a[52:55], a[132:135], v[120:123]
buffer_load_dwordx4 v15, s[8:11], s24 offen offset:3072 lds
v_mfma_f32_16x16x32_bf16 v[124:127], a[56:59], a[128:131], v[124:127]
s_add_u32 s24, s24, 128
v_mfma_f32_16x16x32_bf16 v[124:127], a[60:63], a[132:135], v[124:127]
s_waitcnt lgkmcnt(2)
s_sub_u32 s26, s26, 8388608
v_mfma_f32_16x16x32_bf16 v[128:131], a[0:3], a[136:139], v[128:131]
s_sub_u32 s27, s27, 8388608
s_add_u32 m0, s29, 131072
ds_read_b64_tr_b16 a[128:129], v8 offset:0
v_mfma_f32_16x16x32_bf16 v[128:131], a[4:7], a[140:143], v[128:131]
buffer_load_dwordx4 v16, s[12:15], s26 offen offset:0 lds
v_mfma_f32_16x16x32_bf16 v[132:135], a[8:11], a[136:139], v[132:135]
ds_read_b64_tr_b16 a[130:131], v8 offset:2048
v_mfma_f32_16x16x32_bf16 v[132:135], a[12:15], a[140:143], v[132:135]
v_mfma_f32_16x16x32_bf16 v[136:139], a[16:19], a[136:139], v[136:139]
ds_read_b64_tr_b16 a[132:133], v8 offset:16384
v_mfma_f32_16x16x32_bf16 v[136:139], a[20:23], a[140:143], v[136:139]
buffer_load_dwordx4 v17, s[12:15], s26 offen offset:1024 lds
v_mfma_f32_16x16x32_bf16 v[140:143], a[24:27], a[136:139], v[140:143]
ds_read_b64_tr_b16 a[134:135], v8 offset:18432
v_mfma_f32_16x16x32_bf16 v[140:143], a[28:31], a[140:143], v[140:143]
v_mfma_f32_16x16x32_bf16 v[144:147], a[32:35], a[136:139], v[144:147]
ds_read_b128 a[96:99], v2 offset:40960
v_mfma_f32_16x16x32_bf16 v[144:147], a[36:39], a[140:143], v[144:147]
buffer_load_dwordx4 v18, s[12:15], s26 offen offset:2048 lds
v_mfma_f32_16x16x32_bf16 v[148:151], a[40:43], a[136:139], v[148:151]
v_mfma_f32_16x16x32_bf16 v[148:151], a[44:47], a[140:143], v[148:151]
v_mfma_f32_16x16x32_bf16 v[152:155], a[48:51], a[136:139], v[152:155]
ds_read_b128 a[100:103], v3 offset:40960
v_mfma_f32_16x16x32_bf16 v[152:155], a[52:55], a[140:143], v[152:155]
buffer_load_dwordx4 v19, s[12:15], s26 offen offset:3072 lds
v_mfma_f32_16x16x32_bf16 v[156:159], a[56:59], a[136:139], v[156:159]
s_add_u32 s26, s26, 524288
ds_read_b128 a[104:107], v2 offset:43008
v_mfma_f32_16x16x32_bf16 v[156:159], a[60:63], a[140:143], v[156:159]
s_waitcnt lgkmcnt(3)
v_mfma_f32_16x16x32_bf16 v[160:163], a[0:3], a[128:131], v[160:163]
s_add_u32 m0, s29, 147456
ds_read_b64_tr_b16 a[136:137], v9 offset:0
v_mfma_f32_16x16x32_bf16 v[160:163], a[4:7], a[132:135], v[160:163]
buffer_load_dwordx4 v16, s[12:15], s27 offen offset:0 lds
v_mfma_f32_16x16x32_bf16 v[164:167], a[8:11], a[128:131], v[164:167]
ds_read_b64_tr_b16 a[138:139], v9 offset:2048
v_mfma_f32_16x16x32_bf16 v[164:167], a[12:15], a[132:135], v[164:167]
v_mfma_f32_16x16x32_bf16 v[168:171], a[16:19], a[128:131], v[168:171]
ds_read_b64_tr_b16 a[140:141], v9 offset:16384
v_mfma_f32_16x16x32_bf16 v[168:171], a[20:23], a[132:135], v[168:171]
buffer_load_dwordx4 v17, s[12:15], s27 offen offset:1024 lds
v_mfma_f32_16x16x32_bf16 v[172:175], a[24:27], a[128:131], v[172:175]
ds_read_b64_tr_b16 a[142:143], v9 offset:18432
v_mfma_f32_16x16x32_bf16 v[172:175], a[28:31], a[132:135], v[172:175]
v_mfma_f32_16x16x32_bf16 v[176:179], a[32:35], a[128:131], v[176:179]
v_mfma_f32_16x16x32_bf16 v[176:179], a[36:39], a[132:135], v[176:179]
buffer_load_dwordx4 v18, s[12:15], s27 offen offset:2048 lds
v_mfma_f32_16x16x32_bf16 v[180:183], a[40:43], a[128:131], v[180:183]
ds_read_b128 a[108:111], v3 offset:43008
v_mfma_f32_16x16x32_bf16 v[180:183], a[44:47], a[132:135], v[180:183]
v_mfma_f32_16x16x32_bf16 v[184:187], a[48:51], a[128:131], v[184:187]
ds_read_b128 a[112:115], v2 offset:45056
v_mfma_f32_16x16x32_bf16 v[184:187], a[52:55], a[132:135], v[184:187]
buffer_load_dwordx4 v19, s[12:15], s27 offen offset:3072 lds
v_mfma_f32_16x16x32_bf16 v[188:191], a[56:59], a[128:131], v[188:191]
s_add_u32 s27, s27, 524288
v_mfma_f32_16x16x32_bf16 v[188:191], a[60:63], a[132:135], v[188:191]
s_waitcnt lgkmcnt(2)
v_mfma_f32_16x16x32_bf16 v[192:195], a[0:3], a[136:139], v[192:195]
ds_read_b64_tr_b16 a[128:129], v10 offset:0
v_mfma_f32_16x16x32_bf16 v[192:195], a[4:7], a[140:143], v[192:195]
v_mfma_f32_16x16x32_bf16 v[196:199], a[8:11], a[136:139], v[196:199]
ds_read_b64_tr_b16 a[130:131], v10 offset:2048
v_mfma_f32_16x16x32_bf16 v[196:199], a[12:15], a[140:143], v[196:199]
v_mfma_f32_16x16x32_bf16 v[200:203], a[16:19], a[136:139], v[200:203]
ds_read_b64_tr_b16 a[132:133], v10 offset:16384
v_mfma_f32_16x16x32_bf16 v[200:203], a[20:23], a[140:143], v[200:203]
v_mfma_f32_16x16x32_bf16 v[204:207], a[24:27], a[136:139], v[204:207]
ds_read_b64_tr_b16 a[134:135], v10 offset:18432
v_mfma_f32_16x16x32_bf16 v[204:207], a[28:31], a[140:143], v[204:207]
v_mfma_f32_16x16x32_bf16 v[208:211], a[32:35], a[136:139], v[208:211]
ds_read_b128 a[116:119], v3 offset:45056
v_mfma_f32_16x16x32_bf16 v[208:211], a[36:39], a[140:143], v[208:211]
v_mfma_f32_16x16x32_bf16 v[212:215], a[40:43], a[136:139], v[212:215]
ds_read_b128 a[120:123], v2 offset:47104
v_mfma_f32_16x16x32_bf16 v[212:215], a[44:47], a[140:143], v[212:215]
v_mfma_f32_16x16x32_bf16 v[216:219], a[48:51], a[136:139], v[216:219]
v_mfma_f32_16x16x32_bf16 v[216:219], a[52:55], a[140:143], v[216:219]
v_mfma_f32_16x16x32_bf16 v[220:223], a[56:59], a[136:139], v[220:223]
ds_read_b128 a[124:127], v3 offset:47104
v_mfma_f32_16x16x32_bf16 v[220:223], a[60:63], a[140:143], v[220:223]
s_waitcnt lgkmcnt(3)
v_mfma_f32_16x16x32_bf16 a[192:195], a[0:3], a[128:131], a[192:195]
ds_read_b64_tr_b16 a[136:137], v11 offset:0
v_mfma_f32_16x16x32_bf16 a[192:195], a[4:7], a[132:135], a[192:195]
v_mfma_f32_16x16x32_bf16 a[196:199], a[8:11], a[128:131], a[196:199]
ds_read_b64_tr_b16 a[138:139], v11 offset:2048
v_mfma_f32_16x16x32_bf16 a[196:199], a[12:15], a[132:135], a[196:199]
v_mfma_f32_16x16x32_bf16 a[200:203], a[16:19], a[128:131], a[200:203]
ds_read_b64_tr_b16 a[140:141], v11 offset:16384
v_mfma_f32_16x16x32_bf16 a[200:203], a[20:23], a[132:135], a[200:203]
v_mfma_f32_16x16x32_bf16 a[204:207], a[24:27], a[128:131], a[204:207]
ds_read_b64_tr_b16 a[142:143], v11 offset:18432
v_mfma_f32_16x16x32_bf16 a[204:207], a[28:31], a[132:135], a[204:207]
v_mfma_f32_16x16x32_bf16 a[208:211], a[32:35], a[128:131], a[208:211]
v_mfma_f32_16x16x32_bf16 a[208:211], a[36:39], a[132:135], a[208:211]
v_mfma_f32_16x16x32_bf16 a[212:215], a[40:43], a[128:131], a[212:215]
v_mfma_f32_16x16x32_bf16 a[212:215], a[44:47], a[132:135], a[212:215]
v_mfma_f32_16x16x32_bf16 a[216:219], a[48:51], a[128:131], a[216:219]
v_mfma_f32_16x16x32_bf16 a[216:219], a[52:55], a[132:135], a[216:219]
v_mfma_f32_16x16x32_bf16 a[220:223], a[56:59], a[128:131], a[220:223]
s_waitcnt vmcnt(12) lgkmcnt(0)
v_mfma_f32_16x16x32_bf16 a[220:223], a[60:63], a[132:135], a[220:223]
s_barrier
v_mfma_f32_16x16x32_bf16 a[224:227], a[0:3], a[136:139], a[224:227]
s_add_u32 m0, s28, 32768
ds_read_b64_tr_b16 a[128:129], v4 offset:32768
v_mfma_f32_16x16x32_bf16 a[224:227], a[4:7], a[140:143], a[224:227]
s_lshr_b32 s22, s3, 1
buffer_load_dwordx4 v12, s[8:11], s24 offen offset:0 lds
v_mfma_f32_16x16x32_bf16 a[228:231], a[8:11], a[136:139], a[228:231]
s_lshl_b32 s22, s22, 14
ds_read_b64_tr_b16 a[130:131], v4 offset:34816
v_subrev_u32 v2, s22, v2
v_mfma_f32_16x16x32_bf16 a[228:231], a[12:15], a[140:143], a[228:231]
v_subrev_u32 v3, s22, v3
v_mfma_f32_16x16x32_bf16 a[232:235], a[16:19], a[136:139], a[232:235]
ds_read_b64_tr_b16 a[132:133], v4 offset:49152
v_mfma_f32_16x16x32_bf16 a[232:235], a[20:23], a[140:143], a[232:235]
buffer_load_dwordx4 v13, s[8:11], s24 offen offset:1024 lds
v_mfma_f32_16x16x32_bf16 a[236:239], a[24:27], a[136:139], a[236:239]
ds_read_b64_tr_b16 a[134:135], v4 offset:51200
v_mfma_f32_16x16x32_bf16 a[236:239], a[28:31], a[140:143], a[236:239]
v_mfma_f32_16x16x32_bf16 a[240:243], a[32:35], a[136:139], a[240:243]
v_mfma_f32_16x16x32_bf16 a[240:243], a[36:39], a[140:143], a[240:243]
buffer_load_dwordx4 v14, s[8:11], s24 offen offset:2048 lds
v_mfma_f32_16x16x32_bf16 a[244:247], a[40:43], a[136:139], a[244:247]
v_mfma_f32_16x16x32_bf16 a[244:247], a[44:47], a[140:143], a[244:247]
v_mfma_f32_16x16x32_bf16 a[248:251], a[48:51], a[136:139], a[248:251]
v_mfma_f32_16x16x32_bf16 a[248:251], a[52:55], a[140:143], a[248:251]
buffer_load_dwordx4 v15, s[8:11], s24 offen offset:3072 lds
v_mfma_f32_16x16x32_bf16 a[252:255], a[56:59], a[136:139], a[252:255]
s_add_u32 s24, s24, 128
v_mfma_f32_16x16x32_bf16 a[252:255], a[60:63], a[140:143], a[252:255]
s_waitcnt lgkmcnt(0)
v_mfma_f32_16x16x32_bf16 v[32:35], a[64:67], a[128:131], v[32:35]
s_add_u32 m0, s29, 65536
ds_read_b64_tr_b16 a[136:137], v5 offset:32768
v_mfma_f32_16x16x32_bf16 v[32:35], a[68:71], a[132:135], v[32:35]
buffer_load_dwordx4 v16, s[12:15], s26 offen offset:0 lds
v_mfma_f32_16x16x32_bf16 v[36:39], a[72:75], a[128:131], v[36:39]
ds_read_b64_tr_b16 a[138:139], v5 offset:34816
v_mfma_f32_16x16x32_bf16 v[36:39], a[76:79], a[132:135], v[36:39]
v_mfma_f32_16x16x32_bf16 v[40:43], a[80:83], a[128:131], v[40:43]
ds_read_b64_tr_b16 a[140:141], v5 offset:49152
v_mfma_f32_16x16x32_bf16 v[40:43], a[84:87], a[132:135], v[40:43]
buffer_load_dwordx4 v17, s[12:15], s26 offen offset:1024 lds
v_mfma_f32_16x16x32_bf16 v[44:47], a[88:91], a[128:131], v[44:47]
ds_read_b64_tr_b16 a[142:143], v5 offset:51200
v_mfma_f32_16x16x32_bf16 v[44:47], a[92:95], a[132:135], v[44:47]
v_mfma_f32_16x16x32_bf16 v[48:51], a[96:99], a[128:131], v[48:51]
ds_read_b128 a[0:3], v2 offset:0
v_cvt_pk_bf16_f32 v32, v32, v33
v_mfma_f32_16x16x32_bf16 v[48:51], a[100:103], a[132:135], v[48:51]
buffer_load_dwordx4 v18, s[12:15], s26 offen offset:2048 lds
v_mfma_f32_16x16x32_bf16 v[52:55], a[104:107], a[128:131], v[52:55]
ds_read_b128 a[4:7], v3 offset:0
v_cvt_pk_bf16_f32 v33, v34, v35
v_mfma_f32_16x16x32_bf16 v[52:55], a[108:111], a[132:135], v[52:55]
v_cvt_pk_bf16_f32 v34, v36, v37
v_cvt_pk_bf16_f32 v35, v38, v39
v_mfma_f32_16x16x32_bf16 v[56:59], a[112:115], a[128:131], v[56:59]
v_cvt_pk_bf16_f32 v40, v40, v41
v_cvt_pk_bf16_f32 v41, v42, v43
v_mfma_f32_16x16x32_bf16 v[56:59], a[116:119], a[132:135], v[56:59]
buffer_load_dwordx4 v19, s[12:15], s26 offen offset:3072 lds
v_mfma_f32_16x16x32_bf16 v[60:63], a[120:123], a[128:131], v[60:63]
s_add_u32 s26, s26, 524288
ds_read_b128 a[8:11], v2 offset:2048
v_cvt_pk_bf16_f32 v42, v44, v45
v_mfma_f32_16x16x32_bf16 v[60:63], a[124:127], a[132:135], v[60:63]
s_waitcnt lgkmcnt(3)
v_cvt_pk_bf16_f32 v43, v46, v47
v_mfma_f32_16x16x32_bf16 v[64:67], a[64:67], a[136:139], v[64:67]
s_add_u32 m0, s29, 81920
ds_read_b64_tr_b16 a[128:129], v6 offset:32768
v_cvt_pk_bf16_f32 v48, v48, v49
v_mfma_f32_16x16x32_bf16 v[64:67], a[68:71], a[140:143], v[64:67]
buffer_load_dwordx4 v16, s[12:15], s27 offen offset:0 lds
v_mfma_f32_16x16x32_bf16 v[68:71], a[72:75], a[136:139], v[68:71]
ds_read_b64_tr_b16 a[130:131], v6 offset:34816
v_cvt_pk_bf16_f32 v49, v50, v51
v_mfma_f32_16x16x32_bf16 v[68:71], a[76:79], a[140:143], v[68:71]
v_cvt_pk_bf16_f32 v50, v52, v53
v_cvt_pk_bf16_f32 v51, v54, v55
v_mfma_f32_16x16x32_bf16 v[72:75], a[80:83], a[136:139], v[72:75]
ds_read_b64_tr_b16 a[132:133], v6 offset:49152
v_cvt_pk_bf16_f32 v56, v56, v57
v_mfma_f32_16x16x32_bf16 v[72:75], a[84:87], a[140:143], v[72:75]
buffer_load_dwordx4 v17, s[12:15], s27 offen offset:1024 lds
v_mfma_f32_16x16x32_bf16 v[76:79], a[88:91], a[136:139], v[76:79]
ds_read_b64_tr_b16 a[134:135], v6 offset:51200
v_cvt_pk_bf16_f32 v57, v58, v59
v_mfma_f32_16x16x32_bf16 v[76:79], a[92:95], a[140:143], v[76:79]
v_cvt_pk_bf16_f32 v58, v60, v61
v_cvt_pk_bf16_f32 v59, v62, v63
v_mfma_f32_16x16x32_bf16 v[80:83], a[96:99], a[136:139], v[80:83]
ds_read_b128 a[12:15], v3 offset:2048
v_cvt_pk_bf16_f32 v64, v64, v65
v_mfma_f32_16x16x32_bf16 v[80:83], a[100:103], a[140:143], v[80:83]
buffer_load_dwordx4 v18, s[12:15], s27 offen offset:2048 lds
v_mfma_f32_16x16x32_bf16 v[84:87], a[104:107], a[136:139], v[84:87]
v_cvt_pk_bf16_f32 v65, v66, v67
v_cvt_pk_bf16_f32 v66, v68, v69
v_mfma_f32_16x16x32_bf16 v[84:87], a[108:111], a[140:143], v[84:87]
v_cvt_pk_bf16_f32 v67, v70, v71
v_mfma_f32_16x16x32_bf16 v[88:91], a[112:115], a[136:139], v[88:91]
ds_read_b128 a[16:19], v2 offset:4096
v_cvt_pk_bf16_f32 v72, v72, v73
v_mfma_f32_16x16x32_bf16 v[88:91], a[116:119], a[140:143], v[88:91]
buffer_load_dwordx4 v19, s[12:15], s27 offen offset:3072 lds
v_mfma_f32_16x16x32_bf16 v[92:95], a[120:123], a[136:139], v[92:95]
s_add_u32 s27, s27, 524288
ds_read_b128 a[20:23], v3 offset:4096
v_cvt_pk_bf16_f32 v73, v74, v75
v_mfma_f32_16x16x32_bf16 v[92:95], a[124:127], a[140:143], v[92:95]
s_waitcnt lgkmcnt(3)
v_cvt_pk_bf16_f32 v74, v76, v77
v_cvt_pk_bf16_f32 v75, v78, v79
v_mfma_f32_16x16x32_bf16 v[96:99], a[64:67], a[128:131], v[96:99]
s_add_u32 m0, s28, 49152
ds_read_b64_tr_b16 a[136:137], v7 offset:32768
v_cvt_pk_bf16_f32 v80, v80, v81
v_mfma_f32_16x16x32_bf16 v[96:99], a[68:71], a[132:135], v[96:99]
PAD_27:
s_cbranch_execz PAD_31
buffer_load_dwordx4 v12, s[8:11], s24 offen offset:0 lds
v_mfma_f32_16x16x32_bf16 v[100:103], a[72:75], a[128:131], v[100:103]
ds_read_b64_tr_b16 a[138:139], v7 offset:34816
v_cvt_pk_bf16_f32 v81, v82, v83
v_mfma_f32_16x16x32_bf16 v[100:103], a[76:79], a[132:135], v[100:103]
v_cvt_pk_bf16_f32 v82, v84, v85
v_cvt_pk_bf16_f32 v83, v86, v87
v_mfma_f32_16x16x32_bf16 v[104:107], a[80:83], a[128:131], v[104:107]
ds_read_b64_tr_b16 a[140:141], v7 offset:49152
v_cvt_pk_bf16_f32 v88, v88, v89
v_mfma_f32_16x16x32_bf16 v[104:107], a[84:87], a[132:135], v[104:107]
buffer_load_dwordx4 v13, s[8:11], s24 offen offset:1024 lds
v_mfma_f32_16x16x32_bf16 v[108:111], a[88:91], a[128:131], v[108:111]
ds_read_b64_tr_b16 a[142:143], v7 offset:51200
v_cvt_pk_bf16_f32 v89, v90, v91
v_mfma_f32_16x16x32_bf16 v[108:111], a[92:95], a[132:135], v[108:111]
v_cvt_pk_bf16_f32 v90, v92, v93
v_cvt_pk_bf16_f32 v91, v94, v95
v_mfma_f32_16x16x32_bf16 v[112:115], a[96:99], a[128:131], v[112:115]
v_cvt_pk_bf16_f32 v96, v96, v97
v_cvt_pk_bf16_f32 v97, v98, v99
v_mfma_f32_16x16x32_bf16 v[112:115], a[100:103], a[132:135], v[112:115]
buffer_load_dwordx4 v14, s[8:11], s24 offen offset:2048 lds
v_mfma_f32_16x16x32_bf16 v[116:119], a[104:107], a[128:131], v[116:119]
ds_read_b128 a[24:27], v2 offset:6144
v_cvt_pk_bf16_f32 v98, v100, v101
v_mfma_f32_16x16x32_bf16 v[116:119], a[108:111], a[132:135], v[116:119]
buffer_store_dwordx4 v[32:35], v1, s[4:7], s31 offen sc1
v_mfma_f32_16x16x32_bf16 v[120:123], a[112:115], a[128:131], v[120:123]
s_add_u32 s31, s31, s32
ds_read_b128 a[28:31], v3 offset:6144
v_cvt_pk_bf16_f32 v99, v102, v103
v_mfma_f32_16x16x32_bf16 v[120:123], a[116:119], a[132:135], v[120:123]
buffer_load_dwordx4 v15, s[8:11], s24 offen offset:3072 lds
v_mfma_f32_16x16x32_bf16 v[124:127], a[120:123], a[128:131], v[124:127]
s_add_u32 s24, s24, 128
v_cvt_pk_bf16_f32 v104, v104, v105
v_cvt_pk_bf16_f32 v105, v106, v107
v_mfma_f32_16x16x32_bf16 v[124:127], a[124:127], a[132:135], v[124:127]
s_waitcnt lgkmcnt(2)
v_cvt_pk_bf16_f32 v106, v108, v109
v_cvt_pk_bf16_f32 v107, v110, v111
v_mfma_f32_16x16x32_bf16 v[128:131], a[64:67], a[136:139], v[128:131]
ds_read_b64_tr_b16 a[128:129], v8 offset:32768
v_cvt_pk_bf16_f32 v112, v112, v113
v_mfma_f32_16x16x32_bf16 v[128:131], a[68:71], a[140:143], v[128:131]
v_cvt_pk_bf16_f32 v113, v114, v115
v_cvt_pk_bf16_f32 v114, v116, v117
v_mfma_f32_16x16x32_bf16 v[132:135], a[72:75], a[136:139], v[132:135]
ds_read_b64_tr_b16 a[130:131], v8 offset:34816
v_cvt_pk_bf16_f32 v115, v118, v119
v_mfma_f32_16x16x32_bf16 v[132:135], a[76:79], a[140:143], v[132:135]
buffer_store_dwordx4 v[40:43], v1, s[4:7], s31 offen sc1
v_mfma_f32_16x16x32_bf16 v[136:139], a[80:83], a[136:139], v[136:139]
s_add_u32 s31, s31, s33
ds_read_b64_tr_b16 a[132:133], v8 offset:49152
v_cvt_pk_bf16_f32 v120, v120, v121
v_mfma_f32_16x16x32_bf16 v[136:139], a[84:87], a[140:143], v[136:139]
v_cvt_pk_bf16_f32 v121, v122, v123
v_cvt_pk_bf16_f32 v122, v124, v125
v_mfma_f32_16x16x32_bf16 v[140:143], a[88:91], a[136:139], v[140:143]
ds_read_b64_tr_b16 a[134:135], v8 offset:51200
v_cvt_pk_bf16_f32 v123, v126, v127
v_mfma_f32_16x16x32_bf16 v[140:143], a[92:95], a[140:143], v[140:143]
v_mfma_f32_16x16x32_bf16 v[144:147], a[96:99], a[136:139], v[144:147]
ds_read_b128 a[32:35], v2 offset:8192
v_cvt_pk_bf16_f32 v128, v128, v129
v_mfma_f32_16x16x32_bf16 v[144:147], a[100:103], a[140:143], v[144:147]
v_cvt_pk_bf16_f32 v129, v130, v131
v_cvt_pk_bf16_f32 v130, v132, v133
v_mfma_f32_16x16x32_bf16 v[148:151], a[104:107], a[136:139], v[148:151]
v_cvt_pk_bf16_f32 v131, v134, v135
v_mfma_f32_16x16x32_bf16 v[148:151], a[108:111], a[140:143], v[148:151]
v_mfma_f32_16x16x32_bf16 v[152:155], a[112:115], a[136:139], v[152:155]
ds_read_b128 a[36:39], v3 offset:8192
v_cvt_pk_bf16_f32 v136, v136, v137
v_mfma_f32_16x16x32_bf16 v[152:155], a[116:119], a[140:143], v[152:155]
v_cvt_pk_bf16_f32 v137, v138, v139
v_cvt_pk_bf16_f32 v138, v140, v141
v_mfma_f32_16x16x32_bf16 v[156:159], a[120:123], a[136:139], v[156:159]
ds_read_b128 a[40:43], v2 offset:10240
v_cvt_pk_bf16_f32 v139, v142, v143
v_mfma_f32_16x16x32_bf16 v[156:159], a[124:127], a[140:143], v[156:159]
s_waitcnt lgkmcnt(3)
buffer_store_dwordx4 v[48:51], v1, s[4:7], s31 offen sc1
v_mfma_f32_16x16x32_bf16 v[160:163], a[64:67], a[128:131], v[160:163]
s_add_u32 s31, s31, s32
ds_read_b64_tr_b16 a[136:137], v9 offset:32768
v_cvt_pk_bf16_f32 v144, v144, v145
v_mfma_f32_16x16x32_bf16 v[160:163], a[68:71], a[132:135], v[160:163]
v_cvt_pk_bf16_f32 v145, v146, v147
v_cvt_pk_bf16_f32 v146, v148, v149
v_mfma_f32_16x16x32_bf16 v[164:167], a[72:75], a[128:131], v[164:167]
ds_read_b64_tr_b16 a[138:139], v9 offset:34816
v_cvt_pk_bf16_f32 v147, v150, v151
v_mfma_f32_16x16x32_bf16 v[164:167], a[76:79], a[132:135], v[164:167]
v_mfma_f32_16x16x32_bf16 v[168:171], a[80:83], a[128:131], v[168:171]
ds_read_b64_tr_b16 a[140:141], v9 offset:49152
v_cvt_pk_bf16_f32 v152, v152, v153
v_mfma_f32_16x16x32_bf16 v[168:171], a[84:87], a[132:135], v[168:171]
v_cvt_pk_bf16_f32 v153, v154, v155
v_cvt_pk_bf16_f32 v154, v156, v157
v_mfma_f32_16x16x32_bf16 v[172:175], a[88:91], a[128:131], v[172:175]
ds_read_b64_tr_b16 a[142:143], v9 offset:51200
v_cvt_pk_bf16_f32 v155, v158, v159
v_mfma_f32_16x16x32_bf16 v[172:175], a[92:95], a[132:135], v[172:175]
v_mfma_f32_16x16x32_bf16 v[176:179], a[96:99], a[128:131], v[176:179]
buffer_store_dwordx4 v[56:59], v1, s[4:7], s31 offen sc1
v_mfma_f32_16x16x32_bf16 v[176:179], a[100:103], a[132:135], v[176:179]
s_add_u32 s31, s31, s34
v_cvt_pk_bf16_f32 v160, v160, v161
v_cvt_pk_bf16_f32 v161, v162, v163
v_mfma_f32_16x16x32_bf16 v[180:183], a[104:107], a[128:131], v[180:183]
ds_read_b128 a[44:47], v3 offset:10240
v_cvt_pk_bf16_f32 v162, v164, v165
v_mfma_f32_16x16x32_bf16 v[180:183], a[108:111], a[132:135], v[180:183]
v_cvt_pk_bf16_f32 v163, v166, v167
v_mfma_f32_16x16x32_bf16 v[184:187], a[112:115], a[128:131], v[184:187]
ds_read_b128 a[48:51], v2 offset:12288
v_cvt_pk_bf16_f32 v168, v168, v169
v_mfma_f32_16x16x32_bf16 v[184:187], a[116:119], a[132:135], v[184:187]
v_cvt_pk_bf16_f32 v169, v170, v171
v_cvt_pk_bf16_f32 v170, v172, v173
v_mfma_f32_16x16x32_bf16 v[188:191], a[120:123], a[128:131], v[188:191]
v_cvt_pk_bf16_f32 v171, v174, v175
v_mfma_f32_16x16x32_bf16 v[188:191], a[124:127], a[132:135], v[188:191]
s_waitcnt lgkmcnt(2)
v_mfma_f32_16x16x32_bf16 v[192:195], a[64:67], a[136:139], v[192:195]
ds_read_b64_tr_b16 a[128:129], v10 offset:32768
v_cvt_pk_bf16_f32 v176, v176, v177
v_mfma_f32_16x16x32_bf16 v[192:195], a[68:71], a[140:143], v[192:195]
v_cvt_pk_bf16_f32 v177, v178, v179
v_cvt_pk_bf16_f32 v178, v180, v181
v_mfma_f32_16x16x32_bf16 v[196:199], a[72:75], a[136:139], v[196:199]
ds_read_b64_tr_b16 a[130:131], v10 offset:34816
v_cvt_pk_bf16_f32 v179, v182, v183
v_mfma_f32_16x16x32_bf16 v[196:199], a[76:79], a[140:143], v[196:199]
buffer_store_dwordx4 v[64:67], v1, s[4:7], s31 offen sc1
v_mfma_f32_16x16x32_bf16 v[200:203], a[80:83], a[136:139], v[200:203]
s_add_u32 s31, s31, s32
ds_read_b64_tr_b16 a[132:133], v10 offset:49152
v_cvt_pk_bf16_f32 v184, v184, v185
v_mfma_f32_16x16x32_bf16 v[200:203], a[84:87], a[140:143], v[200:203]
v_cvt_pk_bf16_f32 v185, v186, v187
v_cvt_pk_bf16_f32 v186, v188, v189
v_mfma_f32_16x16x32_bf16 v[204:207], a[88:91], a[136:139], v[204:207]
ds_read_b64_tr_b16 a[134:135], v10 offset:51200
v_cvt_pk_bf16_f32 v187, v190, v191
v_mfma_f32_16x16x32_bf16 v[204:207], a[92:95], a[140:143], v[204:207]
v_mfma_f32_16x16x32_bf16 v[208:211], a[96:99], a[136:139], v[208:211]
ds_read_b128 a[52:55], v3 offset:12288
v_cvt_pk_bf16_f32 v192, v192, v193
v_mfma_f32_16x16x32_bf16 v[208:211], a[100:103], a[140:143], v[208:211]
v_cvt_pk_bf16_f32 v193, v194, v195
v_cvt_pk_bf16_f32 v194, v196, v197
v_mfma_f32_16x16x32_bf16 v[212:215], a[104:107], a[136:139], v[212:215]
ds_read_b128 a[56:59], v2 offset:14336
v_cvt_pk_bf16_f32 v195, v198, v199
v_mfma_f32_16x16x32_bf16 v[212:215], a[108:111], a[140:143], v[212:215]
v_mfma_f32_16x16x32_bf16 v[216:219], a[112:115], a[136:139], v[216:219]
v_cvt_pk_bf16_f32 v200, v200, v201
v_cvt_pk_bf16_f32 v201, v202, v203
v_mfma_f32_16x16x32_bf16 v[216:219], a[116:119], a[140:143], v[216:219]
buffer_store_dwordx4 v[72:75], v1, s[4:7], s31 offen sc1
v_mfma_f32_16x16x32_bf16 v[220:223], a[120:123], a[136:139], v[220:223]
s_add_u32 s31, s31, s33
ds_read_b128 a[60:63], v3 offset:14336
v_cvt_pk_bf16_f32 v202, v204, v205
v_mfma_f32_16x16x32_bf16 v[220:223], a[124:127], a[140:143], v[220:223]
s_waitcnt lgkmcnt(3)
v_cvt_pk_bf16_f32 v203, v206, v207
v_mfma_f32_16x16x32_bf16 a[192:195], a[64:67], a[128:131], a[192:195]
ds_read_b64_tr_b16 a[136:137], v11 offset:32768
v_cvt_pk_bf16_f32 v208, v208, v209
v_mfma_f32_16x16x32_bf16 a[192:195], a[68:71], a[132:135], a[192:195]
v_cvt_pk_bf16_f32 v209, v210, v211
v_cvt_pk_bf16_f32 v210, v212, v213
v_mfma_f32_16x16x32_bf16 a[196:199], a[72:75], a[128:131], a[196:199]
ds_read_b64_tr_b16 a[138:139], v11 offset:34816
v_cvt_pk_bf16_f32 v211, v214, v215
v_mfma_f32_16x16x32_bf16 a[196:199], a[76:79], a[132:135], a[196:199]
v_mfma_f32_16x16x32_bf16 a[200:203], a[80:83], a[128:131], a[200:203]
ds_read_b64_tr_b16 a[140:141], v11 offset:49152
v_cvt_pk_bf16_f32 v216, v216, v217
v_mfma_f32_16x16x32_bf16 a[200:203], a[84:87], a[132:135], a[200:203]
v_cvt_pk_bf16_f32 v217, v218, v219
v_cvt_pk_bf16_f32 v218, v220, v221
v_mfma_f32_16x16x32_bf16 a[204:207], a[88:91], a[128:131], a[204:207]
ds_read_b64_tr_b16 a[142:143], v11 offset:51200
v_cvt_pk_bf16_f32 v219, v222, v223
v_mfma_f32_16x16x32_bf16 a[204:207], a[92:95], a[132:135], a[204:207]
v_mfma_f32_16x16x32_bf16 a[208:211], a[96:99], a[128:131], a[208:211]
buffer_store_dwordx4 v[80:83], v1, s[4:7], s31 offen sc1
v_mfma_f32_16x16x32_bf16 a[208:211], a[100:103], a[132:135], a[208:211]
s_add_u32 s31, s31, s32
v_mfma_f32_16x16x32_bf16 a[212:215], a[104:107], a[128:131], a[212:215]
v_mfma_f32_16x16x32_bf16 a[212:215], a[108:111], a[132:135], a[212:215]
v_mfma_f32_16x16x32_bf16 a[216:219], a[112:115], a[128:131], a[216:219]
v_mfma_f32_16x16x32_bf16 a[216:219], a[116:119], a[132:135], a[216:219]
v_mfma_f32_16x16x32_bf16 a[220:223], a[120:123], a[128:131], a[220:223]
s_waitcnt vmcnt(23) lgkmcnt(0)
v_mfma_f32_16x16x32_bf16 a[220:223], a[124:127], a[132:135], a[220:223]
s_barrier
v_mfma_f32_16x16x32_bf16 a[224:227], a[64:67], a[136:139], a[224:227]
s_add_u32 m0, s29, 98304
ds_read_b64_tr_b16 a[128:129], v22 offset:0
v_mfma_f32_16x16x32_bf16 a[224:227], a[68:71], a[140:143], a[224:227]
buffer_load_dwordx4 v16, s[12:15], s26 offen offset:0 lds
v_mfma_f32_16x16x32_bf16 a[228:231], a[72:75], a[136:139], a[228:231]
ds_read_b64_tr_b16 a[130:131], v22 offset:2048
v_mfma_f32_16x16x32_bf16 a[228:231], a[76:79], a[140:143], a[228:231]
buffer_store_dwordx4 v[88:91], v1, s[4:7], s31 offen sc1
v_mfma_f32_16x16x32_bf16 a[232:235], a[80:83], a[136:139], a[232:235]
s_add_u32 s31, s31, s35
ds_read_b64_tr_b16 a[132:133], v22 offset:16384
v_mfma_f32_16x16x32_bf16 a[232:235], a[84:87], a[140:143], a[232:235]
buffer_load_dwordx4 v17, s[12:15], s26 offen offset:1024 lds
v_mfma_f32_16x16x32_bf16 a[236:239], a[88:91], a[136:139], a[236:239]
ds_read_b64_tr_b16 a[134:135], v22 offset:18432
v_add_u32 v22, 4294901760, v22
v_mfma_f32_16x16x32_bf16 a[236:239], a[92:95], a[140:143], a[236:239]
v_mfma_f32_16x16x32_bf16 a[240:243], a[96:99], a[136:139], a[240:243]
v_mfma_f32_16x16x32_bf16 a[240:243], a[100:103], a[140:143], a[240:243]
buffer_load_dwordx4 v18, s[12:15], s26 offen offset:2048 lds
v_mfma_f32_16x16x32_bf16 a[244:247], a[104:107], a[136:139], a[244:247]
v_mfma_f32_16x16x32_bf16 a[244:247], a[108:111], a[140:143], a[244:247]
v_mfma_f32_16x16x32_bf16 a[248:251], a[112:115], a[136:139], a[248:251]
v_mfma_f32_16x16x32_bf16 a[248:251], a[116:119], a[140:143], a[248:251]
buffer_load_dwordx4 v19, s[12:15], s26 offen offset:3072 lds
v_mfma_f32_16x16x32_bf16 a[252:255], a[120:123], a[136:139], a[252:255]
s_add_u32 s26, s26, 524288
v_mfma_f32_16x16x32_bf16 a[252:255], a[124:127], a[140:143], a[252:255]
s_waitcnt lgkmcnt(0)
s_cmp_ge_u32 s21, 7
s_cbranch_scc1 M_Q
M_conv:
v_mfma_f32_16x16x32_bf16 v[36:39], a[128:131], a[0:3], 0
s_add_u32 m0, s29, 114688
ds_read_b64_tr_b16 a[136:137], v23 offset:0
v_mfma_f32_16x16x32_bf16 v[36:39], a[132:135], a[4:7], v[36:39]
buffer_load_dwordx4 v16, s[12:15], s27 offen offset:0 lds
v_mfma_f32_16x16x32_bf16 v[44:47], a[128:131], a[8:11], 0
ds_read_b64_tr_b16 a[138:139], v23 offset:2048
v_mfma_f32_16x16x32_bf16 v[44:47], a[132:135], a[12:15], v[44:47]
ds_read_b128 a[64:67], v2 offset:16384
ds_read_b128 a[68:71], v3 offset:16384
v_mfma_f32_16x16x32_bf16 v[52:55], a[128:131], a[16:19], 0
ds_read_b64_tr_b16 a[140:141], v23 offset:16384
v_mfma_f32_16x16x32_bf16 v[52:55], a[132:135], a[20:23], v[52:55]
buffer_load_dwordx4 v17, s[12:15], s27 offen offset:1024 lds
v_mfma_f32_16x16x32_bf16 v[60:63], a[128:131], a[24:27], 0
ds_read_b64_tr_b16 a[142:143], v23 offset:18432
v_add_u32 v23, 4294901760, v23
v_mfma_f32_16x16x32_bf16 v[60:63], a[132:135], a[28:31], v[60:63]
buffer_store_dwordx4 v[96:99], v1, s[4:7], s31 offen sc1
v_mfma_f32_16x16x32_bf16 v[68:71], a[128:131], a[32:35], 0
s_add_u32 s31, s31, s32
ds_read_b128 a[72:75], v2 offset:18432
v_mfma_f32_16x16x32_bf16 v[68:71], a[132:135], a[36:39], v[68:71]
buffer_load_dwordx4 v18, s[12:15], s27 offen offset:2048 lds
v_mfma_f32_16x16x32_bf16 v[76:79], a[128:131], a[40:43], 0
ds_read_b128 a[76:79], v3 offset:18432
v_mfma_f32_16x16x32_bf16 v[76:79], a[132:135], a[44:47], v[76:79]
ds_read_b128 a[80:83], v2 offset:20480
v_mfma_f32_16x16x32_bf16 v[84:87], a[128:131], a[48:51], 0
ds_read_b128 a[84:87], v3 offset:20480
v_mfma_f32_16x16x32_bf16 v[84:87], a[132:135], a[52:55], v[84:87]
buffer_load_dwordx4 v19, s[12:15], s27 offen offset:3072 lds
v_mfma_f32_16x16x32_bf16 v[92:95], a[128:131], a[56:59], 0
s_add_u32 s27, s27, 524288
ds_read_b128 a[88:91], v2 offset:22528
v_mfma_f32_16x16x32_bf16 v[92:95], a[132:135], a[60:63], v[92:95]
s_waitcnt lgkmcnt(5)
buffer_store_dwordx4 v[104:107], v1, s[4:7], s31 offen sc1
v_mfma_f32_16x16x32_bf16 v[100:103], a[136:139], a[0:3], 0
s_add_u32 m0, s28, 0
ds_read_b64_tr_b16 a[128:129], v24 offset:0
v_mfma_f32_16x16x32_bf16 v[100:103], a[140:143], a[4:7], v[100:103]
s_add_u32 s31, s31, s33
buffer_load_dwordx4 v12, s[8:11], s24 offen offset:0 lds
v_mfma_f32_16x16x32_bf16 v[108:111], a[136:139], a[8:11], 0
ds_read_b64_tr_b16 a[130:131], v24 offset:2048
v_mfma_f32_16x16x32_bf16 v[108:111], a[140:143], a[12:15], v[108:111]
ds_read_b128 a[92:95], v3 offset:22528
v_mfma_f32_16x16x32_bf16 v[116:119], a[136:139], a[16:19], 0
ds_read_b64_tr_b16 a[132:133], v24 offset:16384
v_mfma_f32_16x16x32_bf16 v[116:119], a[140:143], a[20:23], v[116:119]
buffer_load_dwordx4 v13, s[8:11], s24 offen offset:1024 lds
v_mfma_f32_16x16x32_bf16 v[124:127], a[136:139], a[24:27], 0
ds_read_b64_tr_b16 a[134:135], v24 offset:18432
v_add_u32 v24, 4294901760, v24
v_mfma_f32_16x16x32_bf16 v[124:127], a[140:143], a[28:31], v[124:127]
v_mfma_f32_16x16x32_bf16 v[132:135], a[136:139], a[32:35], 0
ds_read_b128 a[96:99], v2 offset:24576
v_mfma_f32_16x16x32_bf16 v[132:135], a[140:143], a[36:39], v[132:135]
buffer_load_dwordx4 v14, s[8:11], s24 offen offset:2048 lds
v_mfma_f32_16x16x32_bf16 v[140:143], a[136:139], a[40:43], 0
ds_read_b128 a[100:103], v3 offset:24576
v_mfma_f32_16x16x32_bf16 v[140:143], a[140:143], a[44:47], v[140:143]
ds_read_b128 a[104:107], v2 offset:26624
v_mfma_f32_16x16x32_bf16 v[148:151], a[136:139], a[48:51], 0
ds_read_b128 a[108:111], v3 offset:26624
v_mfma_f32_16x16x32_bf16 v[148:151], a[140:143], a[52:55], v[148:151]
buffer_load_dwordx4 v15, s[8:11], s24 offen offset:3072 lds
v_mfma_f32_16x16x32_bf16 v[156:159], a[136:139], a[56:59], 0
s_add_u32 s24, s24, 128
ds_read_b128 a[112:115], v2 offset:28672
v_mfma_f32_16x16x32_bf16 v[156:159], a[140:143], a[60:63], v[156:159]
s_waitcnt lgkmcnt(5)
buffer_store_dwordx4 v[112:115], v1, s[4:7], s31 offen sc1
v_mfma_f32_16x16x32_bf16 v[164:167], a[128:131], a[0:3], 0
s_add_u32 s31, s31, s32
ds_read_b64_tr_b16 a[136:137], v25 offset:0
v_mfma_f32_16x16x32_bf16 v[164:167], a[132:135], a[4:7], v[164:167]
v_mfma_f32_16x16x32_bf16 v[172:175], a[128:131], a[8:11], 0
ds_read_b64_tr_b16 a[138:139], v25 offset:2048
v_mfma_f32_16x16x32_bf16 v[172:175], a[132:135], a[12:15], v[172:175]
ds_read_b128 a[116:119], v3 offset:28672
v_mfma_f32_16x16x32_bf16 v[180:183], a[128:131], a[16:19], 0
ds_read_b64_tr_b16 a[140:141], v25 offset:16384
v_mfma_f32_16x16x32_bf16 v[180:183], a[132:135], a[20:23], v[180:183]
v_mfma_f32_16x16x32_bf16 v[188:191], a[128:131], a[24:27], 0
ds_read_b64_tr_b16 a[142:143], v25 offset:18432
v_add_u32 v25, 4294901760, v25
v_mfma_f32_16x16x32_bf16 v[188:191], a[132:135], a[28:31], v[188:191]
v_mfma_f32_16x16x32_bf16 v[196:199], a[128:131], a[32:35], 0
ds_read_b128 a[120:123], v2 offset:30720
v_mfma_f32_16x16x32_bf16 v[196:199], a[132:135], a[36:39], v[196:199]
v_mfma_f32_16x16x32_bf16 v[204:207], a[128:131], a[40:43], 0
ds_read_b128 a[124:127], v3 offset:30720
v_mfma_f32_16x16x32_bf16 v[204:207], a[132:135], a[44:47], v[204:207]
v_mfma_f32_16x16x32_bf16 v[212:215], a[128:131], a[48:51], 0
v_mfma_f32_16x16x32_bf16 v[212:215], a[132:135], a[52:55], v[212:215]
buffer_store_dwordx4 v[120:123], v1, s[4:7], s31 offen sc1
v_mfma_f32_16x16x32_bf16 v[220:223], a[128:131], a[56:59], 0
s_add_u32 s31, s31, s34
v_mfma_f32_16x16x32_bf16 v[220:223], a[132:135], a[60:63], v[220:223]
s_waitcnt vmcnt(28) lgkmcnt(0)
s_barrier
v_mfma_f32_16x16x32_bf16 v[224:227], a[136:139], a[0:3], 0
s_add_u32 m0, s29, 131072
ds_read_b64_tr_b16 a[128:129], v22 offset:0
v_mfma_f32_16x16x32_bf16 v[224:227], a[140:143], a[4:7], v[224:227]
buffer_load_dwordx4 v16, s[12:15], s26 offen offset:0 lds
v_mfma_f32_16x16x32_bf16 v[228:231], a[136:139], a[8:11], 0
ds_read_b64_tr_b16 a[130:131], v22 offset:2048
v_mfma_f32_16x16x32_bf16 v[228:231], a[140:143], a[12:15], v[228:231]
v_mfma_f32_16x16x32_bf16 v[232:235], a[136:139], a[16:19], 0
ds_read_b64_tr_b16 a[132:133], v22 offset:16384
v_mfma_f32_16x16x32_bf16 v[232:235], a[140:143], a[20:23], v[232:235]
buffer_load_dwordx4 v17, s[12:15], s26 offen offset:1024 lds
v_mfma_f32_16x16x32_bf16 v[236:239], a[136:139], a[24:27], 0
ds_read_b64_tr_b16 a[134:135], v22 offset:18432
v_add_u32 v22, 32768, v22
v_mfma_f32_16x16x32_bf16 v[236:239], a[140:143], a[28:31], v[236:239]
v_mfma_f32_16x16x32_bf16 v[240:243], a[136:139], a[32:35], 0
v_mfma_f32_16x16x32_bf16 v[240:243], a[140:143], a[36:39], v[240:243]
buffer_load_dwordx4 v18, s[12:15], s26 offen offset:2048 lds
v_mfma_f32_16x16x32_bf16 v[244:247], a[136:139], a[40:43], 0
v_mfma_f32_16x16x32_bf16 v[244:247], a[140:143], a[44:47], v[244:247]
v_mfma_f32_16x16x32_bf16 v[248:251], a[136:139], a[48:51], 0
v_mfma_f32_16x16x32_bf16 v[248:251], a[140:143], a[52:55], v[248:251]
buffer_load_dwordx4 v19, s[12:15], s26 offen offset:3072 lds
v_mfma_f32_16x16x32_bf16 v[252:255], a[136:139], a[56:59], 0
s_add_u32 s26, s26, 524288
v_mfma_f32_16x16x32_bf16 v[252:255], a[140:143], a[60:63], v[252:255]
s_waitcnt lgkmcnt(0)
v_mfma_f32_16x16x32_bf16 v[36:39], a[128:131], a[64:67], v[36:39]
s_add_u32 m0, s29, 147456
ds_read_b64_tr_b16 a[136:137], v23 offset:0
v_mfma_f32_16x16x32_bf16 v[36:39], a[132:135], a[68:71], v[36:39]
buffer_load_dwordx4 v16, s[12:15], s27 offen offset:0 lds
v_mfma_f32_16x16x32_bf16 v[44:47], a[128:131], a[72:75], v[44:47]
ds_read_b64_tr_b16 a[138:139], v23 offset:2048
v_mfma_f32_16x16x32_bf16 v[44:47], a[132:135], a[76:79], v[44:47]
ds_read_b128 a[0:3], v2 offset:32768
ds_read_b128 a[4:7], v3 offset:32768
v_mfma_f32_16x16x32_bf16 v[52:55], a[128:131], a[80:83], v[52:55]
ds_read_b64_tr_b16 a[140:141], v23 offset:16384
v_mfma_f32_16x16x32_bf16 v[52:55], a[132:135], a[84:87], v[52:55]
buffer_load_dwordx4 v17, s[12:15], s27 offen offset:1024 lds
v_mfma_f32_16x16x32_bf16 v[60:63], a[128:131], a[88:91], v[60:63]
ds_read_b64_tr_b16 a[142:143], v23 offset:18432
v_add_u32 v23, 32768, v23
v_mfma_f32_16x16x32_bf16 v[60:63], a[132:135], a[92:95], v[60:63]
buffer_store_dwordx4 v[128:131], v1, s[4:7], s31 offen sc1
v_mfma_f32_16x16x32_bf16 v[68:71], a[128:131], a[96:99], v[68:71]
s_add_u32 s31, s31, s32
ds_read_b128 a[8:11], v2 offset:34816
v_accvgpr_read_b32 v32, a192
v_mfma_f32_16x16x32_bf16 v[68:71], a[132:135], a[100:103], v[68:71]
buffer_load_dwordx4 v18, s[12:15], s27 offen offset:2048 lds
v_mfma_f32_16x16x32_bf16 v[76:79], a[128:131], a[104:107], v[76:79]
ds_read_b128 a[12:15], v3 offset:34816
v_accvgpr_read_b32 v33, a193
v_mfma_f32_16x16x32_bf16 v[76:79], a[132:135], a[108:111], v[76:79]
ds_read_b128 a[16:19], v2 offset:36864
v_accvgpr_read_b32 v34, a194
v_mfma_f32_16x16x32_bf16 v[84:87], a[128:131], a[112:115], v[84:87]
ds_read_b128 a[20:23], v3 offset:36864
v_accvgpr_read_b32 v35, a195
v_mfma_f32_16x16x32_bf16 v[84:87], a[132:135], a[116:119], v[84:87]
buffer_load_dwordx4 v19, s[12:15], s27 offen offset:3072 lds
v_mfma_f32_16x16x32_bf16 v[92:95], a[128:131], a[120:123], v[92:95]
s_add_u32 s27, s27, 524288
ds_read_b128 a[24:27], v2 offset:38912
v_accvgpr_read_b32 v96, a196
v_mfma_f32_16x16x32_bf16 v[92:95], a[132:135], a[124:127], v[92:95]
s_waitcnt lgkmcnt(5)
buffer_store_dwordx4 v[136:139], v1, s[4:7], s31 offen sc1
v_mfma_f32_16x16x32_bf16 v[100:103], a[136:139], a[64:67], v[100:103]
s_add_u32 m0, s28, 16384
ds_read_b64_tr_b16 a[128:129], v24 offset:0
v_accvgpr_read_b32 v97, a197
v_mfma_f32_16x16x32_bf16 v[100:103], a[140:143], a[68:71], v[100:103]
s_add_u32 s31, s31, s33
buffer_load_dwordx4 v12, s[8:11], s24 offen offset:0 lds
v_mfma_f32_16x16x32_bf16 v[108:111], a[136:139], a[72:75], v[108:111]
ds_read_b64_tr_b16 a[130:131], v24 offset:2048
v_accvgpr_read_b32 v98, a198
v_mfma_f32_16x16x32_bf16 v[108:111], a[140:143], a[76:79], v[108:111]
ds_read_b128 a[28:31], v3 offset:38912
v_accvgpr_read_b32 v99, a199
v_mfma_f32_16x16x32_bf16 v[116:119], a[136:139], a[80:83], v[116:119]
ds_read_b64_tr_b16 a[132:133], v24 offset:16384
v_cvt_pk_bf16_f32 v32, v32, v33
v_mfma_f32_16x16x32_bf16 v[116:119], a[140:143], a[84:87], v[116:119]
buffer_load_dwordx4 v13, s[8:11], s24 offen offset:1024 lds
v_mfma_f32_16x16x32_bf16 v[124:127], a[136:139], a[88:91], v[124:127]
ds_read_b64_tr_b16 a[134:135], v24 offset:18432
v_add_u32 v24, 32768, v24
v_mfma_f32_16x16x32_bf16 v[124:127], a[140:143], a[92:95], v[124:127]
v_cvt_pk_bf16_f32 v33, v34, v35
v_cvt_pk_bf16_f32 v34, v96, v97
v_mfma_f32_16x16x32_bf16 v[132:135], a[136:139], a[96:99], v[132:135]
ds_read_b128 a[32:35], v2 offset:40960
v_cvt_pk_bf16_f32 v35, v98, v99
v_mfma_f32_16x16x32_bf16 v[132:135], a[140:143], a[100:103], v[132:135]
buffer_load_dwordx4 v14, s[8:11], s24 offen offset:2048 lds
v_mfma_f32_16x16x32_bf16 v[140:143], a[136:139], a[104:107], v[140:143]
ds_read_b128 a[36:39], v3 offset:40960
v_accvgpr_read_b32 v40, a200
v_mfma_f32_16x16x32_bf16 v[140:143], a[140:143], a[108:111], v[140:143]
ds_read_b128 a[40:43], v2 offset:43008
v_accvgpr_read_b32 v41, a201
v_mfma_f32_16x16x32_bf16 v[148:151], a[136:139], a[112:115], v[148:151]
ds_read_b128 a[44:47], v3 offset:43008
v_accvgpr_read_b32 v42, a202
v_mfma_f32_16x16x32_bf16 v[148:151], a[140:143], a[116:119], v[148:151]
buffer_load_dwordx4 v15, s[8:11], s24 offen offset:3072 lds
v_mfma_f32_16x16x32_bf16 v[156:159], a[136:139], a[120:123], v[156:159]
s_add_u32 s24, s24, 128
ds_read_b128 a[48:51], v2 offset:45056
v_accvgpr_read_b32 v43, a203
v_mfma_f32_16x16x32_bf16 v[156:159], a[140:143], a[124:127], v[156:159]
s_waitcnt lgkmcnt(5)
buffer_store_dwordx4 v[144:147], v1, s[4:7], s31 offen sc1
v_mfma_f32_16x16x32_bf16 v[164:167], a[128:131], a[64:67], v[164:167]
s_add_u32 s31, s31, s32
ds_read_b64_tr_b16 a[136:137], v25 offset:0
v_accvgpr_read_b32 v96, a204
v_mfma_f32_16x16x32_bf16 v[164:167], a[132:135], a[68:71], v[164:167]
v_accvgpr_read_b32 v97, a205
v_accvgpr_read_b32 v98, a206
v_mfma_f32_16x16x32_bf16 v[172:175], a[128:131], a[72:75], v[172:175]
ds_read_b64_tr_b16 a[138:139], v25 offset:2048
v_accvgpr_read_b32 v99, a207
v_mfma_f32_16x16x32_bf16 v[172:175], a[132:135], a[76:79], v[172:175]
ds_read_b128 a[52:55], v3 offset:45056
v_cvt_pk_bf16_f32 v40, v40, v41
v_mfma_f32_16x16x32_bf16 v[180:183], a[128:131], a[80:83], v[180:183]
ds_read_b64_tr_b16 a[140:141], v25 offset:16384
v_cvt_pk_bf16_f32 v41, v42, v43
v_mfma_f32_16x16x32_bf16 v[180:183], a[132:135], a[84:87], v[180:183]
v_cvt_pk_bf16_f32 v42, v96, v97
v_cvt_pk_bf16_f32 v43, v98, v99
v_mfma_f32_16x16x32_bf16 v[188:191], a[128:131], a[88:91], v[188:191]
ds_read_b64_tr_b16 a[142:143], v25 offset:18432
v_add_u32 v25, 32768, v25
v_mfma_f32_16x16x32_bf16 v[188:191], a[132:135], a[92:95], v[188:191]
v_accvgpr_read_b32 v48, a208
v_accvgpr_read_b32 v49, a209
v_mfma_f32_16x16x32_bf16 v[196:199], a[128:131], a[96:99], v[196:199]
ds_read_b128 a[56:59], v2 offset:47104
v_accvgpr_read_b32 v50, a210
v_mfma_f32_16x16x32_bf16 v[196:199], a[132:135], a[100:103], v[196:199]
v_accvgpr_read_b32 v51, a211
v_accvgpr_read_b32 v96, a212
v_mfma_f32_16x16x32_bf16 v[204:207], a[128:131], a[104:107], v[204:207]
ds_read_b128 a[60:63], v3 offset:47104
v_accvgpr_read_b32 v97, a213
v_mfma_f32_16x16x32_bf16 v[204:207], a[132:135], a[108:111], v[204:207]
v_accvgpr_read_b32 v98, a214
v_accvgpr_read_b32 v99, a215
v_mfma_f32_16x16x32_bf16 v[212:215], a[128:131], a[112:115], v[212:215]
v_cvt_pk_bf16_f32 v48, v48, v49
v_cvt_pk_bf16_f32 v49, v50, v51
v_mfma_f32_16x16x32_bf16 v[212:215], a[132:135], a[116:119], v[212:215]
buffer_store_dwordx4 v[152:155], v1, s[4:7], s31 offen sc1
v_mfma_f32_16x16x32_bf16 v[220:223], a[128:131], a[120:123], v[220:223]
s_add_u32 s31, s31, s36
v_cvt_pk_bf16_f32 v50, v96, v97
v_cvt_pk_bf16_f32 v51, v98, v99
v_mfma_f32_16x16x32_bf16 v[220:223], a[132:135], a[124:127], v[220:223]
s_waitcnt vmcnt(23) lgkmcnt(0)
s_barrier
v_accvgpr_read_b32 v56, a216
v_mfma_f32_16x16x32_bf16 v[224:227], a[136:139], a[64:67], v[224:227]
s_add_u32 m0, s29, 65536
ds_read_b64_tr_b16 a[128:129], v22 offset:0
v_accvgpr_read_b32 v57, a217
v_mfma_f32_16x16x32_bf16 v[224:227], a[140:143], a[68:71], v[224:227]
buffer_load_dwordx4 v16, s[12:15], s26 offen offset:0 lds
v_mfma_f32_16x16x32_bf16 v[228:231], a[136:139], a[72:75], v[228:231]
ds_read_b64_tr_b16 a[130:131], v22 offset:2048
v_accvgpr_read_b32 v58, a218
v_mfma_f32_16x16x32_bf16 v[228:231], a[140:143], a[76:79], v[228:231]
v_accvgpr_read_b32 v59, a219
v_accvgpr_read_b32 v96, a220
v_mfma_f32_16x16x32_bf16 v[232:235], a[136:139], a[80:83], v[232:235]
ds_read_b64_tr_b16 a[132:133], v22 offset:16384
v_accvgpr_read_b32 v97, a221
v_mfma_f32_16x16x32_bf16 v[232:235], a[140:143], a[84:87], v[232:235]
buffer_load_dwordx4 v17, s[12:15], s26 offen offset:1024 lds
v_mfma_f32_16x16x32_bf16 v[236:239], a[136:139], a[88:91], v[236:239]
PAD_28:
s_cbranch_execz M_tret
ds_read_b64_tr_b16 a[134:135], v22 offset:18432
v_add_u32 v22, 32768, v22
v_mfma_f32_16x16x32_bf16 v[236:239], a[140:143], a[92:95], v[236:239]
v_accvgpr_read_b32 v98, a222
v_accvgpr_read_b32 v99, a223
v_mfma_f32_16x16x32_bf16 v[240:243], a[136:139], a[96:99], v[240:243]
v_cvt_pk_bf16_f32 v56, v56, v57
v_cvt_pk_bf16_f32 v57, v58, v59
v_mfma_f32_16x16x32_bf16 v[240:243], a[140:143], a[100:103], v[240:243]
buffer_load_dwordx4 v18, s[12:15], s26 offen offset:2048 lds
v_mfma_f32_16x16x32_bf16 v[244:247], a[136:139], a[104:107], v[244:247]
v_cvt_pk_bf16_f32 v58, v96, v97
v_cvt_pk_bf16_f32 v59, v98, v99
v_mfma_f32_16x16x32_bf16 v[244:247], a[140:143], a[108:111], v[244:247]
v_accvgpr_read_b32 v64, a224
v_accvgpr_read_b32 v65, a225
v_mfma_f32_16x16x32_bf16 v[248:251], a[136:139], a[112:115], v[248:251]
v_accvgpr_read_b32 v66, a226
v_accvgpr_read_b32 v67, a227
v_mfma_f32_16x16x32_bf16 v[248:251], a[140:143], a[116:119], v[248:251]
buffer_load_dwordx4 v19, s[12:15], s26 offen offset:3072 lds
v_mfma_f32_16x16x32_bf16 v[252:255], a[136:139], a[120:123], v[252:255]
s_add_u32 s26, s26, 524288
v_accvgpr_read_b32 v96, a228
v_accvgpr_read_b32 v97, a229
v_mfma_f32_16x16x32_bf16 v[252:255], a[140:143], a[124:127], v[252:255]
s_waitcnt lgkmcnt(0)
v_accvgpr_read_b32 v98, a230
v_accvgpr_read_b32 v99, a231
v_mfma_f32_16x16x32_bf16 v[36:39], a[128:131], a[0:3], v[36:39]
s_add_u32 m0, s29, 81920
ds_read_b64_tr_b16 a[136:137], v23 offset:0
v_cvt_pk_bf16_f32 v64, v64, v65
v_mfma_f32_16x16x32_bf16 v[36:39], a[132:135], a[4:7], v[36:39]
buffer_load_dwordx4 v16, s[12:15], s27 offen offset:0 lds
v_mfma_f32_16x16x32_bf16 v[44:47], a[128:131], a[8:11], v[44:47]
ds_read_b64_tr_b16 a[138:139], v23 offset:2048
v_cvt_pk_bf16_f32 v65, v66, v67
v_mfma_f32_16x16x32_bf16 v[44:47], a[132:135], a[12:15], v[44:47]
ds_read_b128 a[64:67], v2 offset:49152
ds_read_b128 a[68:71], v3 offset:49152
v_mfma_f32_16x16x32_bf16 v[52:55], a[128:131], a[16:19], v[52:55]
ds_read_b64_tr_b16 a[140:141], v23 offset:16384
v_cvt_pk_bf16_f32 v66, v96, v97
v_mfma_f32_16x16x32_bf16 v[52:55], a[132:135], a[20:23], v[52:55]
buffer_load_dwordx4 v17, s[12:15], s27 offen offset:1024 lds
v_mfma_f32_16x16x32_bf16 v[60:63], a[128:131], a[24:27], v[60:63]
ds_read_b64_tr_b16 a[142:143], v23 offset:18432
v_add_u32 v23, 32768, v23
v_mfma_f32_16x16x32_bf16 v[60:63], a[132:135], a[28:31], v[60:63]
buffer_store_dwordx4 v[160:163], v1, s[4:7], s31 offen sc1
v_mfma_f32_16x16x32_bf16 v[68:71], a[128:131], a[32:35], v[68:71]
s_add_u32 s31, s31, s32
ds_read_b128 a[72:75], v2 offset:51200
v_cvt_pk_bf16_f32 v67, v98, v99
v_mfma_f32_16x16x32_bf16 v[68:71], a[132:135], a[36:39], v[68:71]
buffer_load_dwordx4 v18, s[12:15], s27 offen offset:2048 lds
v_mfma_f32_16x16x32_bf16 v[76:79], a[128:131], a[40:43], v[76:79]
ds_read_b128 a[76:79], v3 offset:51200
v_accvgpr_read_b32 v72, a232
v_mfma_f32_16x16x32_bf16 v[76:79], a[132:135], a[44:47], v[76:79]
ds_read_b128 a[80:83], v2 offset:53248
v_accvgpr_read_b32 v73, a233
v_mfma_f32_16x16x32_bf16 v[84:87], a[128:131], a[48:51], v[84:87]
ds_read_b128 a[84:87], v3 offset:53248
v_accvgpr_read_b32 v74, a234
v_mfma_f32_16x16x32_bf16 v[84:87], a[132:135], a[52:55], v[84:87]
buffer_load_dwordx4 v19, s[12:15], s27 offen offset:3072 lds
v_mfma_f32_16x16x32_bf16 v[92:95], a[128:131], a[56:59], v[92:95]
s_add_u32 s27, s27, 524288
ds_read_b128 a[88:91], v2 offset:55296
v_accvgpr_read_b32 v75, a235
v_mfma_f32_16x16x32_bf16 v[92:95], a[132:135], a[60:63], v[92:95]
s_waitcnt lgkmcnt(5)
buffer_store_dwordx4 v[168:171], v1, s[4:7], s31 offen sc1
v_mfma_f32_16x16x32_bf16 v[100:103], a[136:139], a[0:3], v[100:103]
s_add_u32 m0, s28, 32768
ds_read_b64_tr_b16 a[128:129], v24 offset:0
v_accvgpr_read_b32 v96, a236
v_mfma_f32_16x16x32_bf16 v[100:103], a[140:143], a[4:7], v[100:103]
s_add_u32 s31, s31, s33
buffer_load_dwordx4 v12, s[8:11], s24 offen offset:0 lds
v_mfma_f32_16x16x32_bf16 v[108:111], a[136:139], a[8:11], v[108:111]
ds_read_b64_tr_b16 a[130:131], v24 offset:2048
v_accvgpr_read_b32 v97, a237
v_mfma_f32_16x16x32_bf16 v[108:111], a[140:143], a[12:15], v[108:111]
ds_read_b128 a[92:95], v3 offset:55296
v_accvgpr_read_b32 v98, a238
v_mfma_f32_16x16x32_bf16 v[116:119], a[136:139], a[16:19], v[116:119]
ds_read_b64_tr_b16 a[132:133], v24 offset:16384
v_accvgpr_read_b32 v99, a239
v_mfma_f32_16x16x32_bf16 v[116:119], a[140:143], a[20:23], v[116:119]
buffer_load_dwordx4 v13, s[8:11], s24 offen offset:1024 lds
v_mfma_f32_16x16x32_bf16 v[124:127], a[136:139], a[24:27], v[124:127]
ds_read_b64_tr_b16 a[134:135], v24 offset:18432
v_add_u32 v24, 32768, v24
v_mfma_f32_16x16x32_bf16 v[124:127], a[140:143], a[28:31], v[124:127]
v_cvt_pk_bf16_f32 v72, v72, v73
v_cvt_pk_bf16_f32 v73, v74, v75
v_mfma_f32_16x16x32_bf16 v[132:135], a[136:139], a[32:35], v[132:135]
ds_read_b128 a[96:99], v2 offset:57344
v_cvt_pk_bf16_f32 v74, v96, v97
v_mfma_f32_16x16x32_bf16 v[132:135], a[140:143], a[36:39], v[132:135]
buffer_load_dwordx4 v14, s[8:11], s24 offen offset:2048 lds
v_mfma_f32_16x16x32_bf16 v[140:143], a[136:139], a[40:43], v[140:143]
ds_read_b128 a[100:103], v3 offset:57344
v_cvt_pk_bf16_f32 v75, v98, v99
v_mfma_f32_16x16x32_bf16 v[140:143], a[140:143], a[44:47], v[140:143]
ds_read_b128 a[104:107], v2 offset:59392
v_accvgpr_read_b32 v80, a240
v_mfma_f32_16x16x32_bf16 v[148:151], a[136:139], a[48:51], v[148:151]
ds_read_b128 a[108:111], v3 offset:59392
v_accvgpr_read_b32 v81, a241
v_mfma_f32_16x16x32_bf16 v[148:151], a[140:143], a[52:55], v[148:151]
buffer_load_dwordx4 v15, s[8:11], s24 offen offset:3072 lds
v_mfma_f32_16x16x32_bf16 v[156:159], a[136:139], a[56:59], v[156:159]
s_add_u32 s24, s24, 128
ds_read_b128 a[112:115], v2 offset:61440
v_accvgpr_read_b32 v82, a242
v_mfma_f32_16x16x32_bf16 v[156:159], a[140:143], a[60:63], v[156:159]
s_waitcnt lgkmcnt(5)
buffer_store_dwordx4 v[176:179], v1, s[4:7], s31 offen sc1
v_mfma_f32_16x16x32_bf16 v[164:167], a[128:131], a[0:3], v[164:167]
s_add_u32 s31, s31, s32
ds_read_b64_tr_b16 a[136:137], v25 offset:0
v_accvgpr_read_b32 v83, a243
v_mfma_f32_16x16x32_bf16 v[164:167], a[132:135], a[4:7], v[164:167]
v_accvgpr_read_b32 v96, a244
v_accvgpr_read_b32 v97, a245
v_mfma_f32_16x16x32_bf16 v[172:175], a[128:131], a[8:11], v[172:175]
ds_read_b64_tr_b16 a[138:139], v25 offset:2048
v_accvgpr_read_b32 v98, a246
v_mfma_f32_16x16x32_bf16 v[172:175], a[132:135], a[12:15], v[172:175]
ds_read_b128 a[116:119], v3 offset:61440
v_accvgpr_read_b32 v99, a247
v_mfma_f32_16x16x32_bf16 v[180:183], a[128:131], a[16:19], v[180:183]
ds_read_b64_tr_b16 a[140:141], v25 offset:16384
v_cvt_pk_bf16_f32 v80, v80, v81
v_mfma_f32_16x16x32_bf16 v[180:183], a[132:135], a[20:23], v[180:183]
buffer_store_dwordx4 v[184:187], v1, s[4:7], s31 offen sc1
v_mfma_f32_16x16x32_bf16 v[188:191], a[128:131], a[24:27], v[188:191]
s_add_u32 s31, s31, s34
ds_read_b64_tr_b16 a[142:143], v25 offset:18432
v_add_u32 v25, 32768, v25
v_mfma_f32_16x16x32_bf16 v[188:191], a[132:135], a[28:31], v[188:191]
v_cvt_pk_bf16_f32 v81, v82, v83
v_cvt_pk_bf16_f32 v82, v96, v97
v_mfma_f32_16x16x32_bf16 v[196:199], a[128:131], a[32:35], v[196:199]
ds_read_b128 a[120:123], v2 offset:63488
v_cvt_pk_bf16_f32 v83, v98, v99
v_mfma_f32_16x16x32_bf16 v[196:199], a[132:135], a[36:39], v[196:199]
v_accvgpr_read_b32 v88, a248
v_accvgpr_read_b32 v89, a249
v_mfma_f32_16x16x32_bf16 v[204:207], a[128:131], a[40:43], v[204:207]
ds_read_b128 a[124:127], v3 offset:63488
v_accvgpr_read_b32 v90, a250
v_mfma_f32_16x16x32_bf16 v[204:207], a[132:135], a[44:47], v[204:207]
v_accvgpr_read_b32 v91, a251
v_accvgpr_read_b32 v96, a252
v_mfma_f32_16x16x32_bf16 v[212:215], a[128:131], a[48:51], v[212:215]
v_accvgpr_read_b32 v97, a253
v_accvgpr_read_b32 v98, a254
v_mfma_f32_16x16x32_bf16 v[212:215], a[132:135], a[52:55], v[212:215]
v_accvgpr_read_b32 v99, a255
v_cvt_pk_bf16_f32 v88, v88, v89
v_mfma_f32_16x16x32_bf16 v[220:223], a[128:131], a[56:59], v[220:223]
v_cvt_pk_bf16_f32 v89, v90, v91
v_cvt_pk_bf16_f32 v90, v96, v97
v_mfma_f32_16x16x32_bf16 v[220:223], a[132:135], a[60:63], v[220:223]
s_waitcnt vmcnt(23) lgkmcnt(0)
s_barrier
v_cvt_pk_bf16_f32 v91, v98, v99
v_mfma_f32_16x16x32_bf16 v[224:227], a[136:139], a[0:3], v[224:227]
s_add_u32 m0, s29, 98304
ds_read_b64_tr_b16 a[128:129], v22 offset:0
v_mfma_f32_16x16x32_bf16 v[224:227], a[140:143], a[4:7], v[224:227]
buffer_load_dwordx4 v16, s[12:15], s26 offen offset:0 lds
v_mfma_f32_16x16x32_bf16 v[228:231], a[136:139], a[8:11], v[228:231]
ds_read_b64_tr_b16 a[130:131], v22 offset:2048
v_mfma_f32_16x16x32_bf16 v[228:231], a[140:143], a[12:15], v[228:231]
buffer_store_dwordx4 v[192:195], v1, s[4:7], s31 offen sc1
v_mfma_f32_16x16x32_bf16 v[232:235], a[136:139], a[16:19], v[232:235]
s_add_u32 s31, s31, s32
ds_read_b64_tr_b16 a[132:133], v22 offset:16384
v_mfma_f32_16x16x32_bf16 v[232:235], a[140:143], a[20:23], v[232:235]
buffer_load_dwordx4 v17, s[12:15], s26 offen offset:1024 lds
v_mfma_f32_16x16x32_bf16 v[236:239], a[136:139], a[24:27], v[236:239]
ds_read_b64_tr_b16 a[134:135], v22 offset:18432
v_add_u32 v22, 4294901760, v22
v_mfma_f32_16x16x32_bf16 v[236:239], a[140:143], a[28:31], v[236:239]
v_mfma_f32_16x16x32_bf16 v[240:243], a[136:139], a[32:35], v[240:243]
v_mfma_f32_16x16x32_bf16 v[240:243], a[140:143], a[36:39], v[240:243]
buffer_load_dwordx4 v18, s[12:15], s26 offen offset:2048 lds
v_mfma_f32_16x16x32_bf16 v[244:247], a[136:139], a[40:43], v[244:247]
v_mfma_f32_16x16x32_bf16 v[244:247], a[140:143], a[44:47], v[244:247]
v_mfma_f32_16x16x32_bf16 v[248:251], a[136:139], a[48:51], v[248:251]
v_mfma_f32_16x16x32_bf16 v[248:251], a[140:143], a[52:55], v[248:251]
buffer_load_dwordx4 v19, s[12:15], s26 offen offset:3072 lds
v_mfma_f32_16x16x32_bf16 v[252:255], a[136:139], a[56:59], v[252:255]
s_add_u32 s26, s26, 524288
v_mfma_f32_16x16x32_bf16 v[252:255], a[140:143], a[60:63], v[252:255]
s_waitcnt lgkmcnt(0)
v_mfma_f32_16x16x32_bf16 v[36:39], a[128:131], a[64:67], v[36:39]
s_add_u32 m0, s29, 114688
ds_read_b64_tr_b16 a[136:137], v23 offset:0
v_mfma_f32_16x16x32_bf16 v[36:39], a[132:135], a[68:71], v[36:39]
buffer_load_dwordx4 v16, s[12:15], s27 offen offset:0 lds
v_mfma_f32_16x16x32_bf16 v[44:47], a[128:131], a[72:75], v[44:47]
ds_read_b64_tr_b16 a[138:139], v23 offset:2048
v_mfma_f32_16x16x32_bf16 v[44:47], a[132:135], a[76:79], v[44:47]
ds_read_b128 a[0:3], v2 offset:0
ds_read_b128 a[4:7], v3 offset:0
v_mfma_f32_16x16x32_bf16 v[52:55], a[128:131], a[80:83], v[52:55]
ds_read_b64_tr_b16 a[140:141], v23 offset:16384
v_mfma_f32_16x16x32_bf16 v[52:55], a[132:135], a[84:87], v[52:55]
buffer_load_dwordx4 v17, s[12:15], s27 offen offset:1024 lds
v_mfma_f32_16x16x32_bf16 v[60:63], a[128:131], a[88:91], v[60:63]
ds_read_b64_tr_b16 a[142:143], v23 offset:18432
v_add_u32 v23, 4294901760, v23
v_mfma_f32_16x16x32_bf16 v[60:63], a[132:135], a[92:95], v[60:63]
buffer_store_dwordx4 v[200:203], v1, s[4:7], s31 offen sc1
v_mfma_f32_16x16x32_bf16 v[68:71], a[128:131], a[96:99], v[68:71]
s_add_u32 s31, s31, s33
ds_read_b128 a[8:11], v2 offset:2048
v_mfma_f32_16x16x32_bf16 v[68:71], a[132:135], a[100:103], v[68:71]
buffer_load_dwordx4 v18, s[12:15], s27 offen offset:2048 lds
v_mfma_f32_16x16x32_bf16 v[76:79], a[128:131], a[104:107], v[76:79]
ds_read_b128 a[12:15], v3 offset:2048
v_mfma_f32_16x16x32_bf16 v[76:79], a[132:135], a[108:111], v[76:79]
ds_read_b128 a[16:19], v2 offset:4096
v_mfma_f32_16x16x32_bf16 v[84:87], a[128:131], a[112:115], v[84:87]
ds_read_b128 a[20:23], v3 offset:4096
v_mfma_f32_16x16x32_bf16 v[84:87], a[132:135], a[116:119], v[84:87]
buffer_load_dwordx4 v19, s[12:15], s27 offen offset:3072 lds
v_mfma_f32_16x16x32_bf16 v[92:95], a[128:131], a[120:123], v[92:95]
s_add_u32 s27, s27, 524288
ds_read_b128 a[24:27], v2 offset:6144
v_mfma_f32_16x16x32_bf16 v[92:95], a[132:135], a[124:127], v[92:95]
s_waitcnt lgkmcnt(5)
buffer_store_dwordx4 v[208:211], v1, s[4:7], s31 offen sc1
v_mfma_f32_16x16x32_bf16 v[100:103], a[136:139], a[64:67], v[100:103]
s_add_u32 s31, s31, s32
ds_read_b64_tr_b16 a[128:129], v24 offset:0
v_mfma_f32_16x16x32_bf16 v[100:103], a[140:143], a[68:71], v[100:103]
v_mfma_f32_16x16x32_bf16 v[108:111], a[136:139], a[72:75], v[108:111]
ds_read_b64_tr_b16 a[130:131], v24 offset:2048
v_mfma_f32_16x16x32_bf16 v[108:111], a[140:143], a[76:79], v[108:111]
ds_read_b128 a[28:31], v3 offset:6144
v_mfma_f32_16x16x32_bf16 v[116:119], a[136:139], a[80:83], v[116:119]
ds_read_b64_tr_b16 a[132:133], v24 offset:16384
v_mfma_f32_16x16x32_bf16 v[116:119], a[140:143], a[84:87], v[116:119]
v_mfma_f32_16x16x32_bf16 v[124:127], a[136:139], a[88:91], v[124:127]
ds_read_b64_tr_b16 a[134:135], v24 offset:18432
v_add_u32 v24, 4294901760, v24
v_mfma_f32_16x16x32_bf16 v[124:127], a[140:143], a[92:95], v[124:127]
v_mfma_f32_16x16x32_bf16 v[132:135], a[136:139], a[96:99], v[132:135]
ds_read_b128 a[32:35], v2 offset:8192
v_mfma_f32_16x16x32_bf16 v[132:135], a[140:143], a[100:103], v[132:135]
buffer_store_dwordx4 v[216:219], v1, s[4:7], s31 offen sc1
v_mfma_f32_16x16x32_bf16 v[140:143], a[136:139], a[104:107], v[140:143]
s_add_u32 s31, s31, s35
ds_read_b128 a[36:39], v3 offset:8192
v_mfma_f32_16x16x32_bf16 v[140:143], a[140:143], a[108:111], v[140:143]
ds_read_b128 a[40:43], v2 offset:10240
v_mfma_f32_16x16x32_bf16 v[148:151], a[136:139], a[112:115], v[148:151]
ds_read_b128 a[44:47], v3 offset:10240
v_mfma_f32_16x16x32_bf16 v[148:151], a[140:143], a[116:119], v[148:151]
v_mfma_f32_16x16x32_bf16 v[156:159], a[136:139], a[120:123], v[156:159]
ds_read_b128 a[48:51], v2 offset:12288
v_mfma_f32_16x16x32_bf16 v[156:159], a[140:143], a[124:127], v[156:159]
s_waitcnt lgkmcnt(5)
v_mfma_f32_16x16x32_bf16 v[164:167], a[128:131], a[64:67], v[164:167]
ds_read_b64_tr_b16 a[136:137], v25 offset:0
v_mfma_f32_16x16x32_bf16 v[164:167], a[132:135], a[68:71], v[164:167]
v_mfma_f32_16x16x32_bf16 v[172:175], a[128:131], a[72:75], v[172:175]
ds_read_b64_tr_b16 a[138:139], v25 offset:2048
v_mfma_f32_16x16x32_bf16 v[172:175], a[132:135], a[76:79], v[172:175]
ds_read_b128 a[52:55], v3 offset:12288
v_mfma_f32_16x16x32_bf16 v[180:183], a[128:131], a[80:83], v[180:183]
ds_read_b64_tr_b16 a[140:141], v25 offset:16384
v_mfma_f32_16x16x32_bf16 v[180:183], a[132:135], a[84:87], v[180:183]
buffer_store_dwordx4 v[32:35], v1, s[4:7], s31 offen sc1
v_mfma_f32_16x16x32_bf16 v[188:191], a[128:131], a[88:91], v[188:191]
s_add_u32 s31, s31, s32
ds_read_b64_tr_b16 a[142:143], v25 offset:18432
v_add_u32 v25, 4294901760, v25
v_mfma_f32_16x16x32_bf16 v[188:191], a[132:135], a[92:95], v[188:191]
v_mfma_f32_16x16x32_bf16 v[196:199], a[128:131], a[96:99], v[196:199]
ds_read_b128 a[56:59], v2 offset:14336
v_mfma_f32_16x16x32_bf16 v[196:199], a[132:135], a[100:103], v[196:199]
v_mfma_f32_16x16x32_bf16 v[204:207], a[128:131], a[104:107], v[204:207]
ds_read_b128 a[60:63], v3 offset:14336
v_mfma_f32_16x16x32_bf16 v[204:207], a[132:135], a[108:111], v[204:207]
v_mfma_f32_16x16x32_bf16 v[212:215], a[128:131], a[112:115], v[212:215]
v_mfma_f32_16x16x32_bf16 v[212:215], a[132:135], a[116:119], v[212:215]
v_mfma_f32_16x16x32_bf16 v[220:223], a[128:131], a[120:123], v[220:223]
v_mfma_f32_16x16x32_bf16 v[220:223], a[132:135], a[124:127], v[220:223]
s_waitcnt vmcnt(20) lgkmcnt(0)
s_barrier
v_mfma_f32_16x16x32_bf16 v[224:227], a[136:139], a[64:67], v[224:227]
s_add_u32 m0, s29, 131072
ds_read_b64_tr_b16 a[128:129], v22 offset:0
v_mfma_f32_16x16x32_bf16 v[224:227], a[140:143], a[68:71], v[224:227]
buffer_load_dwordx4 v16, s[12:15], s26 offen offset:0 lds
v_mfma_f32_16x16x32_bf16 v[228:231], a[136:139], a[72:75], v[228:231]
ds_read_b64_tr_b16 a[130:131], v22 offset:2048
v_mfma_f32_16x16x32_bf16 v[228:231], a[140:143], a[76:79], v[228:231]
buffer_store_dwordx4 v[40:43], v1, s[4:7], s31 offen sc1
v_mfma_f32_16x16x32_bf16 v[232:235], a[136:139], a[80:83], v[232:235]
s_add_u32 s31, s31, s33
ds_read_b64_tr_b16 a[132:133], v22 offset:16384
v_mfma_f32_16x16x32_bf16 v[232:235], a[140:143], a[84:87], v[232:235]
buffer_load_dwordx4 v17, s[12:15], s26 offen offset:1024 lds
v_mfma_f32_16x16x32_bf16 v[236:239], a[136:139], a[88:91], v[236:239]
ds_read_b64_tr_b16 a[134:135], v22 offset:18432
v_add_u32 v22, 32768, v22
v_mfma_f32_16x16x32_bf16 v[236:239], a[140:143], a[92:95], v[236:239]
v_mfma_f32_16x16x32_bf16 v[240:243], a[136:139], a[96:99], v[240:243]
v_mfma_f32_16x16x32_bf16 v[240:243], a[140:143], a[100:103], v[240:243]
buffer_load_dwordx4 v18, s[12:15], s26 offen offset:2048 lds
v_mfma_f32_16x16x32_bf16 v[244:247], a[136:139], a[104:107], v[244:247]
v_mfma_f32_16x16x32_bf16 v[244:247], a[140:143], a[108:111], v[244:247]
v_mfma_f32_16x16x32_bf16 v[248:251], a[136:139], a[112:115], v[248:251]
v_mfma_f32_16x16x32_bf16 v[248:251], a[140:143], a[116:119], v[248:251]
buffer_load_dwordx4 v19, s[12:15], s26 offen offset:3072 lds
v_mfma_f32_16x16x32_bf16 v[252:255], a[136:139], a[120:123], v[252:255]
s_add_u32 s26, s26, 524288
v_mfma_f32_16x16x32_bf16 v[252:255], a[140:143], a[124:127], v[252:255]
s_waitcnt lgkmcnt(0)
v_mfma_f32_16x16x32_bf16 v[36:39], a[128:131], a[0:3], v[36:39]
s_add_u32 m0, s29, 147456
ds_read_b64_tr_b16 a[136:137], v23 offset:0
v_mfma_f32_16x16x32_bf16 v[36:39], a[132:135], a[4:7], v[36:39]
buffer_load_dwordx4 v16, s[12:15], s27 offen offset:0 lds
v_mfma_f32_16x16x32_bf16 v[44:47], a[128:131], a[8:11], v[44:47]
s_lshl_b32 s22, s20, 7
ds_read_b64_tr_b16 a[138:139], v23 offset:2048
v_bfe_u32 v20, v1, 4, 3
v_mfma_f32_16x16x32_bf16 v[44:47], a[132:135], a[12:15], v[44:47]
s_add_u32 s70, s22, 94371840
ds_read_b128 a[64:67], v2 offset:16384
ds_read_b128 a[68:71], v3 offset:16384
v_mfma_f32_16x16x32_bf16 v[52:55], a[128:131], a[16:19], v[52:55]
s_lshr_b32 s22, s2, 4
ds_read_b64_tr_b16 a[140:141], v23 offset:16384
v_lshlrev_b32 v20, 3, v20
v_mfma_f32_16x16x32_bf16 v[52:55], a[132:135], a[20:23], v[52:55]
s_lshl_b32 s22, s22, 2
buffer_load_dwordx4 v17, s[12:15], s27 offen offset:1024 lds
v_mfma_f32_16x16x32_bf16 v[60:63], a[128:131], a[24:27], v[60:63]
s_add_u32 s66, s70, s22
ds_read_b64_tr_b16 a[142:143], v23 offset:18432
v_add_u32 v23, 32768, v23
v_mfma_f32_16x16x32_bf16 v[60:63], a[132:135], a[28:31], v[60:63]
s_and_b32 s22, s2, 16
buffer_store_dwordx4 v[48:51], v1, s[4:7], s31 offen sc1
v_mfma_f32_16x16x32_bf16 v[68:71], a[128:131], a[32:35], v[68:71]
s_add_u32 s31, s31, s32
ds_read_b128 a[72:75], v2 offset:18432
v_add_u32 v15, 2052, v20
v_mfma_f32_16x16x32_bf16 v[68:71], a[132:135], a[36:39], v[68:71]
s_lshl_b32 s22, s22, 7
buffer_load_dwordx4 v18, s[12:15], s27 offen offset:2048 lds
v_mfma_f32_16x16x32_bf16 v[76:79], a[128:131], a[40:43], v[76:79]
s_add_u32 s66, s66, s22
ds_read_b128 a[76:79], v3 offset:18432
v_mfma_f32_16x16x32_bf16 v[76:79], a[132:135], a[44:47], v[76:79]
s_lshl_b32 s67, s20, 20
ds_read_b128 a[80:83], v2 offset:20480
v_mfma_f32_16x16x32_bf16 v[84:87], a[128:131], a[48:51], v[84:87]
s_lshl_b32 s22, s37, 16
ds_read_b128 a[84:87], v3 offset:20480
v_mfma_f32_16x16x32_bf16 v[84:87], a[132:135], a[52:55], v[84:87]
s_add_u32 s67, s67, s22
buffer_load_dwordx4 v19, s[12:15], s27 offen offset:3072 lds
v_mfma_f32_16x16x32_bf16 v[92:95], a[128:131], a[56:59], v[92:95]
s_waitcnt lgkmcnt(5)
s_add_u32 s27, s27, 524288
ds_read_b128 a[88:91], v2 offset:22528
v_mfma_f32_16x16x32_bf16 v[92:95], a[132:135], a[60:63], v[92:95]
s_lshl_b32 s22, s3, 11
buffer_store_dwordx4 v[56:59], v1, s[4:7], s31 offen sc1
v_mfma_f32_16x16x32_bf16 v[100:103], a[136:139], a[0:3], v[100:103]
s_waitcnt lgkmcnt(5)
s_add_u32 s31, s31, s34
ds_read_b64_tr_b16 a[128:129], v24 offset:0
v_mfma_f32_16x16x32_bf16 v[100:103], a[140:143], a[4:7], v[100:103]
s_add_u32 s67, s67, s22
v_mfma_f32_16x16x32_bf16 v[108:111], a[136:139], a[8:11], v[108:111]
s_add_u32 s67, s67, 33554432
ds_read_b64_tr_b16 a[130:131], v24 offset:2048
v_mfma_f32_16x16x32_bf16 v[108:111], a[140:143], a[12:15], v[108:111]
s_mov_b32 s68, 1035512379
ds_read_b128 a[92:95], v3 offset:22528
v_mfma_f32_16x16x32_bf16 v[116:119], a[136:139], a[16:19], v[116:119]
s_mov_b32 s69, 1035512379
ds_read_b64_tr_b16 a[132:133], v24 offset:16384
v_mfma_f32_16x16x32_bf16 v[116:119], a[140:143], a[20:23], v[116:119]
buffer_store_dwordx4 v[64:67], v1, s[4:7], s31 offen sc1
v_mfma_f32_16x16x32_bf16 v[124:127], a[136:139], a[24:27], v[124:127]
s_add_u32 s31, s31, s32
ds_read_b64_tr_b16 a[134:135], v24 offset:18432
v_add_u32 v24, 32768, v24
v_mfma_f32_16x16x32_bf16 v[124:127], a[140:143], a[28:31], v[124:127]
v_mfma_f32_16x16x32_bf16 v[132:135], a[136:139], a[32:35], v[132:135]
ds_read_b128 a[96:99], v2 offset:24576
v_mfma_f32_16x16x32_bf16 v[132:135], a[140:143], a[36:39], v[132:135]
v_mfma_f32_16x16x32_bf16 v[140:143], a[136:139], a[40:43], v[140:143]
ds_read_b128 a[100:103], v3 offset:24576
v_mfma_f32_16x16x32_bf16 v[140:143], a[140:143], a[44:47], v[140:143]
ds_read_b128 a[104:107], v2 offset:26624
v_mfma_f32_16x16x32_bf16 v[148:151], a[136:139], a[48:51], v[148:151]
ds_read_b128 a[108:111], v3 offset:26624
v_mfma_f32_16x16x32_bf16 v[148:151], a[140:143], a[52:55], v[148:151]
v_mfma_f32_16x16x32_bf16 v[156:159], a[136:139], a[56:59], v[156:159]
ds_read_b128 a[112:115], v2 offset:28672
v_mfma_f32_16x16x32_bf16 v[156:159], a[140:143], a[60:63], v[156:159]
s_waitcnt lgkmcnt(5)
buffer_store_dwordx4 v[72:75], v1, s[4:7], s31 offen sc1
v_mfma_f32_16x16x32_bf16 v[164:167], a[128:131], a[0:3], v[164:167]
s_add_u32 s31, s31, s33
ds_read_b64_tr_b16 a[136:137], v25 offset:0
v_mfma_f32_16x16x32_bf16 v[164:167], a[132:135], a[4:7], v[164:167]
v_mfma_f32_16x16x32_bf16 v[172:175], a[128:131], a[8:11], v[172:175]
ds_read_b64_tr_b16 a[138:139], v25 offset:2048
v_mfma_f32_16x16x32_bf16 v[172:175], a[132:135], a[12:15], v[172:175]
ds_read_b128 a[116:119], v3 offset:28672
v_mfma_f32_16x16x32_bf16 v[180:183], a[128:131], a[16:19], v[180:183]
ds_read_b64_tr_b16 a[140:141], v25 offset:16384
v_mfma_f32_16x16x32_bf16 v[180:183], a[132:135], a[20:23], v[180:183]
v_mfma_f32_16x16x32_bf16 v[188:191], a[128:131], a[24:27], v[188:191]
ds_read_b64_tr_b16 a[142:143], v25 offset:18432
v_add_u32 v25, 32768, v25
v_mfma_f32_16x16x32_bf16 v[188:191], a[132:135], a[28:31], v[188:191]
v_mfma_f32_16x16x32_bf16 v[196:199], a[128:131], a[32:35], v[196:199]
ds_read_b128 a[120:123], v2 offset:30720
v_mfma_f32_16x16x32_bf16 v[196:199], a[132:135], a[36:39], v[196:199]
buffer_store_dwordx4 v[80:83], v1, s[4:7], s31 offen sc1
v_mfma_f32_16x16x32_bf16 v[204:207], a[128:131], a[40:43], v[204:207]
s_add_u32 s31, s31, s32
ds_read_b128 a[124:127], v3 offset:30720
v_mfma_f32_16x16x32_bf16 v[204:207], a[132:135], a[44:47], v[204:207]
v_mfma_f32_16x16x32_bf16 v[212:215], a[128:131], a[48:51], v[212:215]
v_mfma_f32_16x16x32_bf16 v[212:215], a[132:135], a[52:55], v[212:215]
v_mfma_f32_16x16x32_bf16 v[220:223], a[128:131], a[56:59], v[220:223]
v_mfma_f32_16x16x32_bf16 v[220:223], a[132:135], a[60:63], v[220:223]
s_waitcnt vmcnt(17) lgkmcnt(0)
s_barrier
v_mfma_f32_16x16x32_bf16 v[224:227], a[136:139], a[0:3], v[224:227]
ds_read_b64_tr_b16 a[128:129], v22 offset:0
v_mfma_f32_16x16x32_bf16 v[224:227], a[140:143], a[4:7], v[224:227]
v_mfma_f32_16x16x32_bf16 v[228:231], a[136:139], a[8:11], v[228:231]
ds_read_b64_tr_b16 a[130:131], v22 offset:2048
v_mfma_f32_16x16x32_bf16 v[228:231], a[140:143], a[12:15], v[228:231]
buffer_store_dwordx4 v[88:91], v1, s[4:7], s31 offen sc1
v_mfma_f32_16x16x32_bf16 v[232:235], a[136:139], a[16:19], v[232:235]
ds_read_b64_tr_b16 a[132:133], v22 offset:16384
v_mfma_f32_16x16x32_bf16 v[232:235], a[140:143], a[20:23], v[232:235]
v_mfma_f32_16x16x32_bf16 v[236:239], a[136:139], a[24:27], v[236:239]
ds_read_b64_tr_b16 a[134:135], v22 offset:18432
v_add_u32 v22, 32768, v22
v_mfma_f32_16x16x32_bf16 v[236:239], a[140:143], a[28:31], v[236:239]
v_mfma_f32_16x16x32_bf16 v[240:243], a[136:139], a[32:35], v[240:243]
v_mfma_f32_16x16x32_bf16 v[240:243], a[140:143], a[36:39], v[240:243]
v_mfma_f32_16x16x32_bf16 v[244:247], a[136:139], a[40:43], v[244:247]
v_mfma_f32_16x16x32_bf16 v[244:247], a[140:143], a[44:47], v[244:247]
v_mfma_f32_16x16x32_bf16 v[248:251], a[136:139], a[48:51], v[248:251]
v_mfma_f32_16x16x32_bf16 v[248:251], a[140:143], a[52:55], v[248:251]
v_mfma_f32_16x16x32_bf16 v[252:255], a[136:139], a[56:59], v[252:255]
v_mfma_f32_16x16x32_bf16 v[252:255], a[140:143], a[60:63], v[252:255]
s_waitcnt lgkmcnt(0)
v_mfma_f32_16x16x32_bf16 v[36:39], a[128:131], a[64:67], v[36:39]
ds_read_b64_tr_b16 a[136:137], v23 offset:0
v_and_b32 v14, 128, v1
v_mfma_f32_16x16x32_bf16 v[36:39], a[132:135], a[68:71], v[36:39]
v_mul_u32_u24 v14, 2, v14
v_add_u32 v20, v14, v20
v_mfma_f32_16x16x32_bf16 v[44:47], a[128:131], a[72:75], v[44:47]
s_mul_i32 s85, s20, 7
ds_read_b64_tr_b16 a[138:139], v23 offset:2048
v_add_u32 v15, v14, v15
v_mfma_f32_16x16x32_bf16 v[44:47], a[132:135], a[76:79], v[44:47]
s_add_u32 s85, s85, s21
ds_read_b128 a[0:3], v2 offset:32768
ds_read_b128 a[4:7], v3 offset:32768
v_mfma_f32_16x16x32_bf16 v[52:55], a[128:131], a[80:83], v[52:55]
s_lshl_b32 s85, s85, 2
ds_read_b64_tr_b16 a[140:141], v23 offset:16384
v_mfma_f32_16x16x32_bf16 v[52:55], a[132:135], a[84:87], v[52:55]
s_add_u32 s85, s85, s3
v_mfma_f32_16x16x32_bf16 v[60:63], a[128:131], a[88:91], v[60:63]
s_mul_i32 s82, s85, 4224
ds_read_b64_tr_b16 a[142:143], v23 offset:18432
v_add_u32 v23, 32768, v23
v_mfma_f32_16x16x32_bf16 v[60:63], a[132:135], a[92:95], v[60:63]
s_add_u32 s82, s82, 83886208
v_mfma_f32_16x16x32_bf16 v[68:71], a[128:131], a[96:99], v[68:71]
s_lshl_b32 s83, s85, 12
ds_read_b128 a[8:11], v2 offset:34816
v_mfma_f32_16x16x32_bf16 v[68:71], a[132:135], a[100:103], v[68:71]
s_mul_i32 s84, s3, 21248
v_mfma_f32_16x16x32_bf16 v[76:79], a[128:131], a[104:107], v[76:79]
s_add_u32 s84, s84, 46080
ds_read_b128 a[12:15], v3 offset:34816
v_mfma_f32_16x16x32_bf16 v[76:79], a[132:135], a[108:111], v[76:79]
s_mov_b64 s[60:61], s[72:73]
ds_read_b128 a[16:19], v2 offset:36864
v_mfma_f32_16x16x32_bf16 v[84:87], a[128:131], a[112:115], v[84:87]
s_mov_b32 s62, 1835008
ds_read_b128 a[20:23], v3 offset:36864
v_mfma_f32_16x16x32_bf16 v[84:87], a[132:135], a[116:119], v[84:87]
v_mfma_f32_16x16x32_bf16 v[92:95], a[128:131], a[120:123], v[92:95]
ds_read_b128 a[24:27], v2 offset:38912
v_mfma_f32_16x16x32_bf16 v[92:95], a[132:135], a[124:127], v[92:95]
s_waitcnt lgkmcnt(5)
v_mfma_f32_16x16x32_bf16 v[100:103], a[136:139], a[64:67], v[100:103]
ds_read_b64_tr_b16 a[128:129], v24 offset:0
v_mfma_f32_16x16x32_bf16 v[100:103], a[140:143], a[68:71], v[100:103]
v_mfma_f32_16x16x32_bf16 v[108:111], a[136:139], a[72:75], v[108:111]
ds_read_b64_tr_b16 a[130:131], v24 offset:2048
v_mfma_f32_16x16x32_bf16 v[108:111], a[140:143], a[76:79], v[108:111]
ds_read_b128 a[28:31], v3 offset:38912
v_mfma_f32_16x16x32_bf16 v[116:119], a[136:139], a[80:83], v[116:119]
ds_read_b64_tr_b16 a[132:133], v24 offset:16384
v_mfma_f32_16x16x32_bf16 v[116:119], a[140:143], a[84:87], v[116:119]
v_mfma_f32_16x16x32_bf16 v[124:127], a[136:139], a[88:91], v[124:127]
ds_read_b64_tr_b16 a[134:135], v24 offset:18432
v_add_u32 v24, 32768, v24
v_mfma_f32_16x16x32_bf16 v[124:127], a[140:143], a[92:95], v[124:127]
v_mfma_f32_16x16x32_bf16 v[132:135], a[136:139], a[96:99], v[132:135]
ds_read_b128 a[32:35], v2 offset:40960
v_mfma_f32_16x16x32_bf16 v[132:135], a[140:143], a[100:103], v[132:135]
v_mfma_f32_16x16x32_bf16 v[140:143], a[136:139], a[104:107], v[140:143]
ds_read_b128 a[36:39], v3 offset:40960
v_mfma_f32_16x16x32_bf16 v[140:143], a[140:143], a[108:111], v[140:143]
ds_read_b128 a[40:43], v2 offset:43008
v_mfma_f32_16x16x32_bf16 v[148:151], a[136:139], a[112:115], v[148:151]
ds_read_b128 a[44:47], v3 offset:43008
v_mfma_f32_16x16x32_bf16 v[148:151], a[140:143], a[116:119], v[148:151]
PAD_29:
s_cbranch_execz M_tret
v_mfma_f32_16x16x32_bf16 v[156:159], a[136:139], a[120:123], v[156:159]
s_andn2_b32 s31, s70, 256
ds_read_b128 a[48:51], v2 offset:45056
v_mfma_f32_16x16x32_bf16 v[156:159], a[140:143], a[124:127], v[156:159]
s_waitcnt lgkmcnt(5)
v_mfma_f32_16x16x32_bf16 v[164:167], a[128:131], a[64:67], v[164:167]
ds_read_b64_tr_b16 a[136:137], v25 offset:0
v_mfma_f32_16x16x32_bf16 v[164:167], a[132:135], a[68:71], v[164:167]
v_mfma_f32_16x16x32_bf16 v[172:175], a[128:131], a[72:75], v[172:175]
ds_read_b64_tr_b16 a[138:139], v25 offset:2048
v_mfma_f32_16x16x32_bf16 v[172:175], a[132:135], a[76:79], v[172:175]
ds_read_b128 a[52:55], v3 offset:45056
v_mfma_f32_16x16x32_bf16 v[180:183], a[128:131], a[80:83], v[180:183]
ds_read_b64_tr_b16 a[140:141], v25 offset:16384
v_mfma_f32_16x16x32_bf16 v[180:183], a[132:135], a[84:87], v[180:183]
v_mfma_f32_16x16x32_bf16 v[188:191], a[128:131], a[88:91], v[188:191]
ds_read_b64_tr_b16 a[142:143], v25 offset:18432
v_add_u32 v25, 32768, v25
v_mfma_f32_16x16x32_bf16 v[188:191], a[132:135], a[92:95], v[188:191]
v_mfma_f32_16x16x32_bf16 v[196:199], a[128:131], a[96:99], v[196:199]
ds_read_b128 a[56:59], v2 offset:47104
v_mfma_f32_16x16x32_bf16 v[196:199], a[132:135], a[100:103], v[196:199]
v_mfma_f32_16x16x32_bf16 v[204:207], a[128:131], a[104:107], v[204:207]
ds_read_b128 a[60:63], v3 offset:47104
v_mfma_f32_16x16x32_bf16 v[204:207], a[132:135], a[108:111], v[204:207]
v_mfma_f32_16x16x32_bf16 v[212:215], a[128:131], a[112:115], v[212:215]
v_mfma_f32_16x16x32_bf16 v[212:215], a[132:135], a[116:119], v[212:215]
v_mfma_f32_16x16x32_bf16 v[220:223], a[128:131], a[120:123], v[220:223]
v_mfma_f32_16x16x32_bf16 v[220:223], a[132:135], a[124:127], v[220:223]
s_waitcnt vmcnt(0) lgkmcnt(0)
s_barrier
v_mfma_f32_16x16x32_bf16 v[224:227], a[136:139], a[64:67], v[224:227]
ds_read_b64_tr_b16 a[128:129], v22 offset:0
v_mfma_f32_16x16x32_bf16 v[224:227], a[140:143], a[68:71], v[224:227]
buffer_store_dword v27, v26, s[4:7], s66 offen sc1
v_mfma_f32_16x16x32_bf16 v[228:231], a[136:139], a[72:75], v[228:231]
ds_read_b64_tr_b16 a[130:131], v22 offset:2048
v_mfma_f32_16x16x32_bf16 v[228:231], a[140:143], a[76:79], v[228:231]
v_mfma_f32_16x16x32_bf16 v[232:235], a[136:139], a[80:83], v[232:235]
ds_read_b64_tr_b16 a[132:133], v22 offset:16384
v_mfma_f32_16x16x32_bf16 v[232:235], a[140:143], a[84:87], v[232:235]
v_mfma_f32_16x16x32_bf16 v[236:239], a[136:139], a[88:91], v[236:239]
ds_read_b64_tr_b16 a[134:135], v22 offset:18432
v_mfma_f32_16x16x32_bf16 v[236:239], a[140:143], a[92:95], v[236:239]
v_mfma_f32_16x16x32_bf16 v[240:243], a[136:139], a[96:99], v[240:243]
v_mfma_f32_16x16x32_bf16 v[240:243], a[140:143], a[100:103], v[240:243]
v_mfma_f32_16x16x32_bf16 v[244:247], a[136:139], a[104:107], v[244:247]
v_mfma_f32_16x16x32_bf16 v[244:247], a[140:143], a[108:111], v[244:247]
v_mfma_f32_16x16x32_bf16 v[248:251], a[136:139], a[112:115], v[248:251]
v_mfma_f32_16x16x32_bf16 v[248:251], a[140:143], a[116:119], v[248:251]
v_mfma_f32_16x16x32_bf16 v[252:255], a[136:139], a[120:123], v[252:255]
v_mfma_f32_16x16x32_bf16 v[252:255], a[140:143], a[124:127], v[252:255]
s_waitcnt lgkmcnt(0)
v_mfma_f32_16x16x32_bf16 v[36:39], a[128:131], a[0:3], v[36:39]
s_add_u32 m0, s84, 17152
ds_read_b64_tr_b16 a[136:137], v23 offset:0
v_lshrrev_b32 v9, 4, v1
v_mfma_f32_16x16x32_bf16 v[36:39], a[132:135], a[4:7], v[36:39]
buffer_load_dwordx4 v1, s[60:63], s83 offen offset:0 lds
v_mfma_f32_16x16x32_bf16 v[44:47], a[128:131], a[8:11], v[44:47]
ds_read_b64_tr_b16 a[138:139], v23 offset:2048
v_and_b32 v10, 15, v9
v_mfma_f32_16x16x32_bf16 v[44:47], a[132:135], a[12:15], v[44:47]
buffer_load_dwordx4 v1, s[60:63], s83 offen offset:1024 lds
v_mfma_f32_16x16x32_bf16 v[52:55], a[128:131], a[16:19], v[52:55]
ds_read_b64_tr_b16 a[140:141], v23 offset:16384
v_lshrrev_b32 v11, 4, v9
v_mfma_f32_16x16x32_bf16 v[52:55], a[132:135], a[20:23], v[52:55]
buffer_load_dwordx4 v1, s[60:63], s83 offen offset:2048 lds
v_mfma_f32_16x16x32_bf16 v[60:63], a[128:131], a[24:27], v[60:63]
ds_read_b64_tr_b16 a[142:143], v23 offset:18432
v_lshrrev_b32 v12, 2, v10
v_mfma_f32_16x16x32_bf16 v[60:63], a[132:135], a[28:31], v[60:63]
buffer_load_dwordx4 v1, s[60:63], s83 offen offset:3072 lds
v_mfma_f32_16x16x32_bf16 v[68:71], a[128:131], a[32:35], v[68:71]
s_add_u32 m0, s84, 64
v_mul_u32_u24 v12, 4160, v12
v_and_b32 v13, 3, v9
v_mfma_f32_16x16x32_bf16 v[68:71], a[132:135], a[36:39], v[68:71]
buffer_load_dwordx4 v1, s[4:7], s82 offen offset:0 sc1 lds
v_mfma_f32_16x16x32_bf16 v[76:79], a[128:131], a[40:43], v[76:79]
buffer_load_dwordx4 v1, s[4:7], s82 offen offset:1024 sc1 lds
v_mfma_f32_16x16x32_bf16 v[76:79], a[132:135], a[44:47], v[76:79]
buffer_load_dwordx4 v1, s[4:7], s82 offen offset:2048 sc1 lds
v_mfma_f32_16x16x32_bf16 v[84:87], a[128:131], a[48:51], v[84:87]
buffer_load_dwordx4 v1, s[4:7], s82 offen offset:3072 sc1 lds
v_mfma_f32_16x16x32_bf16 v[84:87], a[132:135], a[52:55], v[84:87]
s_add_u32 s82, s82, 2097152
v_lshl_add_u32 v12, v13, 3, v12
v_lshlrev_b32 v13, 4, v11
v_mfma_f32_16x16x32_bf16 v[92:95], a[128:131], a[56:59], v[92:95]
s_add_u32 m0, s84, 4224
v_sub_u32 v12, v12, v13
v_add_u32 v12, 88, v12
v_mfma_f32_16x16x32_bf16 v[92:95], a[132:135], a[60:63], v[92:95]
s_waitcnt lgkmcnt(0)
buffer_load_dwordx4 v1, s[4:7], s82 offen offset:0 sc1 lds
v_mfma_f32_16x16x32_bf16 v[100:103], a[136:139], a[0:3], v[100:103]
ds_read_b64_tr_b16 a[128:129], v24 offset:0
v_add_u32 v16, s84, v12
v_mfma_f32_16x16x32_bf16 v[100:103], a[140:143], a[4:7], v[100:103]
buffer_load_dwordx4 v1, s[4:7], s82 offen offset:1024 sc1 lds
v_mfma_f32_16x16x32_bf16 v[108:111], a[136:139], a[8:11], v[108:111]
ds_read_b64_tr_b16 a[130:131], v24 offset:2048
v_lshl_add_u32 v12, v10, 5, v13
v_mfma_f32_16x16x32_bf16 v[108:111], a[140:143], a[12:15], v[108:111]
buffer_load_dwordx4 v1, s[4:7], s82 offen offset:2048 sc1 lds
v_mfma_f32_16x16x32_bf16 v[116:119], a[136:139], a[16:19], v[116:119]
ds_read_b64_tr_b16 a[132:133], v24 offset:16384
v_add_u32 v12, 16672, v12
v_mfma_f32_16x16x32_bf16 v[116:119], a[140:143], a[20:23], v[116:119]
buffer_load_dwordx4 v1, s[4:7], s82 offen offset:3072 sc1 lds
v_mfma_f32_16x16x32_bf16 v[124:127], a[136:139], a[24:27], v[124:127]
s_add_u32 s82, s82, 4292870140
ds_read_b64_tr_b16 a[134:135], v24 offset:18432
v_add_u32 v17, s84, v12
v_mfma_f32_16x16x32_bf16 v[124:127], a[140:143], a[28:31], v[124:127]
s_add_u32 m0, s84, 8384
v_lshlrev_b32 v12, 5, v10
v_lshl_add_u32 v8, v11, 3, v12
v_mfma_f32_16x16x32_bf16 v[132:135], a[136:139], a[32:35], v[132:135]
buffer_load_dwordx4 v1, s[4:7], s82 offen offset:0 sc1 lds
v_mfma_f32_16x16x32_bf16 v[132:135], a[140:143], a[36:39], v[132:135]
buffer_load_dwordx4 v1, s[4:7], s82 offen offset:1024 sc1 lds
v_mfma_f32_16x16x32_bf16 v[140:143], a[136:139], a[40:43], v[140:143]
buffer_load_dwordx4 v1, s[4:7], s82 offen offset:2048 sc1 lds
v_mfma_f32_16x16x32_bf16 v[140:143], a[140:143], a[44:47], v[140:143]
buffer_load_dwordx4 v1, s[4:7], s82 offen offset:3072 sc1 lds
v_mfma_f32_16x16x32_bf16 v[148:151], a[136:139], a[48:51], v[148:151]
s_add_u32 s82, s82, 2097152
v_add3_u32 v18, s84, 64, v8
v_mov_b32 v19, 0
v_mfma_f32_16x16x32_bf16 v[148:151], a[140:143], a[52:55], v[148:151]
s_add_u32 m0, s84, 12544
v_mov_b32 v12, 0
v_mov_b32 v13, 0
v_mfma_f32_16x16x32_bf16 v[156:159], a[136:139], a[56:59], v[156:159]
buffer_load_dwordx4 v1, s[4:7], s82 offen offset:0 sc1 lds
v_mfma_f32_16x16x32_bf16 v[156:159], a[140:143], a[60:63], v[156:159]
s_waitcnt lgkmcnt(0)
buffer_load_dwordx4 v1, s[4:7], s82 offen offset:1024 sc1 lds
v_mfma_f32_16x16x32_bf16 v[164:167], a[128:131], a[0:3], v[164:167]
ds_read_b64_tr_b16 a[136:137], v25 offset:0
v_lshl_add_u32 v14, v9, 3, s84
v_mfma_f32_16x16x32_bf16 v[164:167], a[132:135], a[4:7], v[164:167]
buffer_load_dwordx4 v1, s[4:7], s82 offen offset:2048 sc1 lds
v_mfma_f32_16x16x32_bf16 v[172:175], a[128:131], a[8:11], v[172:175]
ds_read_b64_tr_b16 a[138:139], v25 offset:2048
v_mfma_f32_16x16x32_bf16 v[172:175], a[132:135], a[12:15], v[172:175]
buffer_load_dwordx4 v1, s[4:7], s82 offen offset:3072 sc1 lds
v_mfma_f32_16x16x32_bf16 v[180:183], a[128:131], a[16:19], v[180:183]
ds_read_b64_tr_b16 a[140:141], v25 offset:16384
v_mfma_f32_16x16x32_bf16 v[180:183], a[132:135], a[20:23], v[180:183]
ds_write_b64 v14, v[12:13] offset:16640
v_mul_u32_u24 v14, 4160, v11
v_mfma_f32_16x16x32_bf16 v[188:191], a[128:131], a[24:27], v[188:191]
ds_read_b64_tr_b16 a[142:143], v25 offset:18432
v_lshl_add_u32 v14, v10, 2, v14
v_mfma_f32_16x16x32_bf16 v[188:191], a[132:135], a[28:31], v[188:191]
v_add_u32 v14, s84, v14
v_mfma_f32_16x16x32_bf16 v[196:199], a[128:131], a[32:35], v[196:199]
ds_write_b32 v14, v12
v_lshrrev_b32 v30, 6, v0
v_mfma_f32_16x16x32_bf16 v[196:199], a[132:135], a[36:39], v[196:199]
v_lshl_add_u32 v28, v30, 11, v1
v_add_u32 v29, 0x20000, v28
v_mfma_f32_16x16x32_bf16 v[204:207], a[128:131], a[40:43], v[204:207]
v_lshl_add_u32 v30, v30, 13, v1
v_add_u32 v31, 0x20000, v30
v_mfma_f32_16x16x32_bf16 v[204:207], a[132:135], a[44:47], v[204:207]
v_mul_f32 v36, s68, v36
v_mul_f32 v37, s68, v37
v_mfma_f32_16x16x32_bf16 v[212:215], a[128:131], a[48:51], v[212:215]
v_mul_f32 v38, s68, v38
v_mul_f32 v39, s68, v39
v_mfma_f32_16x16x32_bf16 v[212:215], a[132:135], a[52:55], v[212:215]
v_mul_f32 v100, s68, v100
v_mul_f32 v101, s68, v101
v_mfma_f32_16x16x32_bf16 v[220:223], a[128:131], a[56:59], v[220:223]
v_mul_f32 v102, s68, v102
v_mul_f32 v103, s68, v103
v_mfma_f32_16x16x32_bf16 v[220:223], a[132:135], a[60:63], v[220:223]
s_waitcnt lgkmcnt(0)
s_waitcnt lgkmcnt(0)
s_barrier
v_mfma_f32_16x16x32_bf16 v[224:227], a[136:139], a[0:3], v[224:227]
v_cvt_pk_bf16_f32 v36, v36, v37
v_cvt_pk_bf16_f32 v37, v38, v39
v_mfma_f32_16x16x32_bf16 v[224:227], a[140:143], a[4:7], v[224:227]
v_cvt_pk_bf16_f32 v38, v100, v101
v_cvt_pk_bf16_f32 v39, v102, v103
v_mfma_f32_16x16x32_bf16 v[228:231], a[136:139], a[8:11], v[228:231]
v_mul_f32 v44, s68, v44
v_mul_f32 v45, s68, v45
v_mfma_f32_16x16x32_bf16 v[228:231], a[140:143], a[12:15], v[228:231]
v_mul_f32 v46, s68, v46
v_mul_f32 v47, s68, v47
v_mfma_f32_16x16x32_bf16 v[232:235], a[136:139], a[16:19], v[232:235]
v_mul_f32 v108, s68, v108
v_mul_f32 v109, s68, v109
v_mfma_f32_16x16x32_bf16 v[232:235], a[140:143], a[20:23], v[232:235]
v_mul_f32 v110, s68, v110
v_mul_f32 v111, s68, v111
v_mfma_f32_16x16x32_bf16 v[236:239], a[136:139], a[24:27], v[236:239]
v_cvt_pk_bf16_f32 v44, v44, v45
v_cvt_pk_bf16_f32 v45, v46, v47
v_mfma_f32_16x16x32_bf16 v[236:239], a[140:143], a[28:31], v[236:239]
v_cvt_pk_bf16_f32 v46, v108, v109
v_cvt_pk_bf16_f32 v47, v110, v111
v_mfma_f32_16x16x32_bf16 v[240:243], a[136:139], a[32:35], v[240:243]
v_mul_f32 v52, s68, v52
v_mul_f32 v53, s68, v53
v_mfma_f32_16x16x32_bf16 v[240:243], a[140:143], a[36:39], v[240:243]
v_mul_f32 v54, s68, v54
v_mul_f32 v55, s68, v55
v_mfma_f32_16x16x32_bf16 v[244:247], a[136:139], a[40:43], v[244:247]
v_mul_f32 v116, s68, v116
v_mul_f32 v117, s68, v117
v_mfma_f32_16x16x32_bf16 v[244:247], a[140:143], a[44:47], v[244:247]
v_mul_f32 v118, s68, v118
v_mul_f32 v119, s68, v119
v_mfma_f32_16x16x32_bf16 v[248:251], a[136:139], a[48:51], v[248:251]
v_cvt_pk_bf16_f32 v52, v52, v53
v_cvt_pk_bf16_f32 v53, v54, v55
v_mfma_f32_16x16x32_bf16 v[248:251], a[140:143], a[52:55], v[248:251]
v_cvt_pk_bf16_f32 v54, v116, v117
v_cvt_pk_bf16_f32 v55, v118, v119
v_mfma_f32_16x16x32_bf16 v[252:255], a[136:139], a[56:59], v[252:255]
v_mfma_f32_16x16x32_bf16 v[252:255], a[140:143], a[60:63], v[252:255]
s_mov_b64 s[60:61], s[74:75]
s_mov_b32 s62, 896
s_lshl_b32 s79, s85, 1
buffer_load_short_d16_hi v19, off, s[60:63], s79
s_lshl_b32 s83, s85, 12
s_add_u32 s83, s83, 88080384
ds_write_b128 v28, v[36:39] offset:0
ds_write_b128 v28, v[44:47] offset:8192
ds_write_b128 v28, v[52:55] offset:16384
v_pk_mul_f32 v[60:61], v[60:61], s[68:69]
v_pk_mul_f32 v[62:63], v[62:63], s[68:69]
v_pk_mul_f32 v[124:125], v[124:125], s[68:69]
v_pk_mul_f32 v[126:127], v[126:127], s[68:69]
v_cvt_pk_bf16_f32 v60, v60, v61
v_cvt_pk_bf16_f32 v61, v62, v63
v_cvt_pk_bf16_f32 v62, v124, v125
v_cvt_pk_bf16_f32 v63, v126, v127
ds_write_b128 v28, v[60:63] offset:24576
v_pk_mul_f32 v[68:69], v[68:69], s[68:69]
v_pk_mul_f32 v[70:71], v[70:71], s[68:69]
v_pk_mul_f32 v[132:133], v[132:133], s[68:69]
v_pk_mul_f32 v[134:135], v[134:135], s[68:69]
v_cvt_pk_bf16_f32 v68, v68, v69
v_cvt_pk_bf16_f32 v69, v70, v71
v_cvt_pk_bf16_f32 v70, v132, v133
v_cvt_pk_bf16_f32 v71, v134, v135
ds_write_b128 v29, v[68:71] offset:0
v_pk_mul_f32 v[76:77], v[76:77], s[68:69]
v_pk_mul_f32 v[78:79], v[78:79], s[68:69]
v_pk_mul_f32 v[140:141], v[140:141], s[68:69]
v_pk_mul_f32 v[142:143], v[142:143], s[68:69]
v_cvt_pk_bf16_f32 v76, v76, v77
v_cvt_pk_bf16_f32 v77, v78, v79
v_cvt_pk_bf16_f32 v78, v140, v141
v_cvt_pk_bf16_f32 v79, v142, v143
ds_write_b128 v29, v[76:79] offset:8192
v_pk_mul_f32 v[84:85], v[84:85], s[68:69]
v_pk_mul_f32 v[86:87], v[86:87], s[68:69]
v_pk_mul_f32 v[148:149], v[148:149], s[68:69]
v_pk_mul_f32 v[150:151], v[150:151], s[68:69]
v_cvt_pk_bf16_f32 v84, v84, v85
v_cvt_pk_bf16_f32 v85, v86, v87
v_cvt_pk_bf16_f32 v86, v148, v149
v_cvt_pk_bf16_f32 v87, v150, v151
ds_write_b128 v29, v[84:87] offset:16384
v_pk_mul_f32 v[92:93], v[92:93], s[68:69]
v_pk_mul_f32 v[94:95], v[94:95], s[68:69]
v_pk_mul_f32 v[156:157], v[156:157], s[68:69]
v_pk_mul_f32 v[158:159], v[158:159], s[68:69]
v_cvt_pk_bf16_f32 v92, v92, v93
v_cvt_pk_bf16_f32 v93, v94, v95
v_cvt_pk_bf16_f32 v94, v156, v157
v_cvt_pk_bf16_f32 v95, v158, v159
ds_write_b128 v29, v[92:95] offset:24576
v_pk_mul_f32 v[164:165], v[164:165], s[68:69]
v_pk_mul_f32 v[166:167], v[166:167], s[68:69]
v_pk_mul_f32 v[224:225], v[224:225], s[68:69]
v_pk_mul_f32 v[226:227], v[226:227], s[68:69]
v_cvt_pk_bf16_f32 v164, v164, v165
v_cvt_pk_bf16_f32 v165, v166, v167
v_cvt_pk_bf16_f32 v166, v224, v225
v_cvt_pk_bf16_f32 v167, v226, v227
ds_write_b128 v28, v[164:167] offset:1024
v_pk_mul_f32 v[172:173], v[172:173], s[68:69]
v_pk_mul_f32 v[174:175], v[174:175], s[68:69]
v_pk_mul_f32 v[228:229], v[228:229], s[68:69]
v_pk_mul_f32 v[230:231], v[230:231], s[68:69]
v_cvt_pk_bf16_f32 v172, v172, v173
v_cvt_pk_bf16_f32 v173, v174, v175
v_cvt_pk_bf16_f32 v174, v228, v229
v_cvt_pk_bf16_f32 v175, v230, v231
ds_write_b128 v28, v[172:175] offset:9216
v_pk_mul_f32 v[180:181], v[180:181], s[68:69]
v_pk_mul_f32 v[182:183], v[182:183], s[68:69]
v_pk_mul_f32 v[232:233], v[232:233], s[68:69]
v_pk_mul_f32 v[234:235], v[234:235], s[68:69]
v_cvt_pk_bf16_f32 v180, v180, v181
v_cvt_pk_bf16_f32 v181, v182, v183
v_cvt_pk_bf16_f32 v182, v232, v233
v_cvt_pk_bf16_f32 v183, v234, v235
ds_write_b128 v28, v[180:183] offset:17408
v_pk_mul_f32 v[188:189], v[188:189], s[68:69]
v_pk_mul_f32 v[190:191], v[190:191], s[68:69]
v_pk_mul_f32 v[236:237], v[236:237], s[68:69]
v_pk_mul_f32 v[238:239], v[238:239], s[68:69]
v_cvt_pk_bf16_f32 v188, v188, v189
v_cvt_pk_bf16_f32 v189, v190, v191
v_cvt_pk_bf16_f32 v190, v236, v237
v_cvt_pk_bf16_f32 v191, v238, v239
ds_write_b128 v28, v[188:191] offset:25600
v_pk_mul_f32 v[196:197], v[196:197], s[68:69]
v_pk_mul_f32 v[198:199], v[198:199], s[68:69]
v_pk_mul_f32 v[240:241], v[240:241], s[68:69]
v_pk_mul_f32 v[242:243], v[242:243], s[68:69]
v_cvt_pk_bf16_f32 v196, v196, v197
v_cvt_pk_bf16_f32 v197, v198, v199
v_cvt_pk_bf16_f32 v198, v240, v241
v_cvt_pk_bf16_f32 v199, v242, v243
ds_write_b128 v29, v[196:199] offset:1024
v_pk_mul_f32 v[204:205], v[204:205], s[68:69]
v_pk_mul_f32 v[206:207], v[206:207], s[68:69]
v_pk_mul_f32 v[244:245], v[244:245], s[68:69]
v_pk_mul_f32 v[246:247], v[246:247], s[68:69]
v_cvt_pk_bf16_f32 v204, v204, v205
v_cvt_pk_bf16_f32 v205, v206, v207
v_cvt_pk_bf16_f32 v206, v244, v245
v_cvt_pk_bf16_f32 v207, v246, v247
ds_write_b128 v29, v[204:207] offset:9216
v_pk_mul_f32 v[212:213], v[212:213], s[68:69]
v_pk_mul_f32 v[214:215], v[214:215], s[68:69]
v_pk_mul_f32 v[248:249], v[248:249], s[68:69]
v_pk_mul_f32 v[250:251], v[250:251], s[68:69]
v_cvt_pk_bf16_f32 v212, v212, v213
v_cvt_pk_bf16_f32 v213, v214, v215
v_cvt_pk_bf16_f32 v214, v248, v249
v_cvt_pk_bf16_f32 v215, v250, v251
ds_write_b128 v29, v[212:215] offset:17408
v_pk_mul_f32 v[220:221], v[220:221], s[68:69]
v_pk_mul_f32 v[222:223], v[222:223], s[68:69]
v_pk_mul_f32 v[252:253], v[252:253], s[68:69]
v_pk_mul_f32 v[254:255], v[254:255], s[68:69]
v_cvt_pk_bf16_f32 v220, v220, v221
v_cvt_pk_bf16_f32 v221, v222, v223
v_cvt_pk_bf16_f32 v222, v252, v253
v_cvt_pk_bf16_f32 v223, v254, v255
ds_write_b128 v29, v[220:223] offset:25600
s_waitcnt vmcnt(1) lgkmcnt(0)
s_barrier
buffer_load_dword v21, v20, s[4:7], s31 offen sc1
ds_read_b64_tr_b16 a[64:65], v16 offset:8
ds_read_b64_tr_b16 a[66:67], v16 offset:0
ds_read_b128 a[96:99], v17 offset:448
ds_read_b64_tr_b16 a[68:69], v16 offset:520
ds_read_b64_tr_b16 a[70:71], v16 offset:512
ds_read_b128 a[100:103], v17 offset:960
ds_read_b64_tr_b16 a[72:73], v16 offset:1032
ds_read_b64_tr_b16 a[74:75], v16 offset:1024
ds_read_b128 a[104:107], v17 offset:1472
ds_read_b64_tr_b16 a[76:77], v16 offset:1544
ds_read_b64_tr_b16 a[78:79], v16 offset:1536
ds_read_b128 a[108:111], v17 offset:1984
ds_read_b64_tr_b16 a[80:81], v16 offset:2056
ds_read_b64_tr_b16 a[82:83], v16 offset:2048
ds_read_b128 a[112:115], v17 offset:2496
ds_read_b64_tr_b16 a[84:85], v16 offset:2568
ds_read_b64_tr_b16 a[86:87], v16 offset:2560
ds_read_b128 a[116:119], v17 offset:3008
ds_read_b64_tr_b16 a[88:89], v16 offset:3080
ds_read_b64_tr_b16 a[90:91], v16 offset:3072
ds_read_b128 a[120:123], v17 offset:3520
ds_read_b64_tr_b16 a[92:93], v16 offset:3592
ds_read_b64_tr_b16 a[94:95], v16 offset:3584
ds_read_b128 a[124:127], v17 offset:4032
s_waitcnt lgkmcnt(15)
v_mfma_f32_16x16x32_bf16 v[96:99], a[64:67], a[96:99], 0
s_waitcnt lgkmcnt(12)
s_lshl_b32 s18, s3, 13
ds_read_b64_tr_b16 a[128:129], v16 offset:72
v_mov_b32 v24, 0
v_mfma_f32_16x16x32_bf16 v[100:103], a[64:67], a[100:103], 0
s_lshl_b32 s30, s20, 20
ds_read_b64_tr_b16 a[130:131], v16 offset:64
v_lshrrev_b32 v3, 6, v0
v_mfma_f32_16x16x32_bf16 v[100:103], a[68:71], a[96:99], v[100:103]
s_add_u32 s30, s30, s18
ds_read_b128 a[160:163], v17 offset:384
v_and_b32 v4, 63, v0
v_mfma_f32_16x16x32_bf16 v[104:107], a[64:67], a[104:107], 0
s_lshl_b32 s22, s21, 1
ds_read_b128 a[192:195], v30 offset:0
v_add_u32 v2, 0x10000, v1
v_mfma_f32_16x16x32_bf16 v[104:107], a[68:71], a[100:103], v[104:107]
s_and_b32 s84, s2, 1
ds_read_b64_tr_b16 a[132:133], v16 offset:584
v_and_b32 v5, 15, v4
v_mfma_f32_16x16x32_bf16 v[104:107], a[72:75], a[96:99], v[104:107]
s_mul_i32 s84, s84, 0
ds_read_b64_tr_b16 a[134:135], v16 offset:576
v_lshrrev_b32 v6, 4, v4
v_mfma_f32_16x16x32_bf16 v[108:111], a[64:67], a[108:111], 0
s_add_u32 s84, s84, 2386092
ds_read_b128 a[164:167], v17 offset:896
v_lshlrev_b32 v6, 2, v6
v_mfma_f32_16x16x32_bf16 v[108:111], a[68:71], a[104:107], v[108:111]
s_lshl_b32 s85, s21, 2
ds_read_b128 a[196:199], v30 offset:1024
v_sub_u32 v5, v5, v6
v_mfma_f32_16x16x32_bf16 v[108:111], a[72:75], a[100:103], v[108:111]
s_lshr_b32 s85, s84, s85
ds_read_b64_tr_b16 a[136:137], v16 offset:1096
v_lshl_add_u32 v5, v3, 4, v5
v_mfma_f32_16x16x32_bf16 v[108:111], a[76:79], a[96:99], v[108:111]
s_waitcnt lgkmcnt(8)
s_and_b32 s9, s85, 15
ds_read_b64_tr_b16 a[138:139], v16 offset:1088
v_cmp_gt_i32 s[32:33], 0, v5
v_mfma_f32_16x16x32_bf16 v[112:115], a[64:67], a[112:115], 0
s_and_b32 s84, s85, 1
ds_read_b128 a[168:171], v17 offset:1408
v_cmp_gt_i32 s[34:35], 1, v5
v_mfma_f32_16x16x32_bf16 v[112:115], a[68:71], a[108:111], v[112:115]
s_lshl_b32 s84, s84, 17
ds_read_b128 a[200:203], v30 offset:2048
v_cmp_gt_i32 s[36:37], 2, v5
v_mfma_f32_16x16x32_bf16 v[112:115], a[72:75], a[104:107], v[112:115]
s_add_u32 s84, s84, s18
ds_read_b64_tr_b16 a[140:141], v16 offset:1608
v_cmp_gt_i32 s[38:39], 3, v5
v_mfma_f32_16x16x32_bf16 v[112:115], a[76:79], a[100:103], v[112:115]
s_xor_b32 s85, s84, 0x20000
ds_read_b64_tr_b16 a[142:143], v16 offset:1600
v_cmp_gt_i32 s[40:41], 16, v5
v_mfma_f32_16x16x32_bf16 v[112:115], a[80:83], a[96:99], v[112:115]
s_sub_u32 s29, 15, s21
ds_read_b128 a[172:175], v17 offset:1920
v_cmp_gt_i32 s[42:43], 17, v5
v_mfma_f32_16x16x32_bf16 v[116:119], a[64:67], a[116:119], 0
s_xor_b32 s8, s30, 2097152
ds_read_b128 a[204:207], v30 offset:3072
v_cmp_gt_i32 s[44:45], 18, v5
v_mfma_f32_16x16x32_bf16 v[116:119], a[68:71], a[112:115], v[116:119]
s_add_u32 s11, s22, 2
ds_read_b64_tr_b16 a[144:145], v16 offset:2120
v_cmp_gt_i32 s[46:47], 19, v5
v_mfma_f32_16x16x32_bf16 v[116:119], a[72:75], a[108:111], v[116:119]
s_add_u32 s14, s30, 16777216
ds_read_b64_tr_b16 a[146:147], v16 offset:2112
v_cmp_gt_i32 s[48:49], 32, v5
v_mfma_f32_16x16x32_bf16 v[116:119], a[76:79], a[104:107], v[116:119]
s_lshr_b32 s19, s9, 1
ds_read_b128 a[176:179], v17 offset:2432
v_cmp_gt_i32 s[50:51], 33, v5
v_mfma_f32_16x16x32_bf16 v[116:119], a[80:83], a[100:103], v[116:119]
s_cmp_lg_u32 s9, 0
ds_read_b128 a[208:211], v30 offset:4096
v_cmp_gt_i32 s[52:53], 34, v5
v_mfma_f32_16x16x32_bf16 v[116:119], a[84:87], a[96:99], v[116:119]
s_cselect_b32 s10, s30, 3221225472
ds_read_b64_tr_b16 a[148:149], v16 offset:2632
v_cmp_gt_i32 s[54:55], 35, v5
v_mfma_f32_16x16x32_bf16 v[120:123], a[64:67], a[120:123], 0
s_cselect_b32 s8, s8, s30
ds_read_b64_tr_b16 a[150:151], v16 offset:2624
v_cmp_gt_i32 s[56:57], 48, v5
v_mfma_f32_16x16x32_bf16 v[120:123], a[68:71], a[116:119], v[120:123]
s_cselect_b32 s14, s14, 3221225472
ds_read_b128 a[180:183], v17 offset:2944
v_cmp_gt_i32 s[58:59], 49, v5
v_mfma_f32_16x16x32_bf16 v[120:123], a[72:75], a[112:115], v[120:123]
s_cselect_b32 s9, s9, s11
ds_read_b128 a[212:215], v30 offset:5120
v_cmp_gt_i32 s[60:61], 50, v5
v_mfma_f32_16x16x32_bf16 v[120:123], a[76:79], a[108:111], v[120:123]
s_cselect_b32 s19, s19, s21
ds_read_b64_tr_b16 a[152:153], v16 offset:3144
v_cmp_gt_i32 s[62:63], 51, v5
v_mfma_f32_16x16x32_bf16 v[120:123], a[80:83], a[104:107], v[120:123]
s_cselect_b32 s29, s29, s21
ds_read_b64_tr_b16 a[154:155], v16 offset:3136
v_mov_b32 v7, 0xff800000
v_mfma_f32_16x16x32_bf16 v[120:123], a[84:87], a[100:103], v[120:123]
s_cselect_b32 s24, 2, 0
ds_read_b128 a[184:187], v17 offset:3456
v_mov_b32 v6, 1
v_mfma_f32_16x16x32_bf16 v[120:123], a[88:91], a[96:99], v[120:123]
s_add_u32 s12, s8, 16777216
ds_read_b128 a[216:219], v30 offset:6144
v_mov_b32 v5, v26
v_mfma_f32_16x16x32_bf16 v[124:127], a[64:67], a[124:127], 0
s_mov_b32 s13, s9
ds_read_b64_tr_b16 a[156:157], v16 offset:3656
v_add_u32 v4, 0x20000, v1
v_mfma_f32_16x16x32_bf16 v[124:127], a[68:71], a[120:123], v[124:127]
s_mov_b32 s15, s11
ds_read_b64_tr_b16 a[158:159], v16 offset:3648
v_mfma_f32_16x16x32_bf16 v[124:127], a[72:75], a[116:119], v[124:127]
s_mov_b32 s25, 1266679808
ds_read_b128 a[188:191], v17 offset:3968
v_mfma_f32_16x16x32_bf16 v[124:127], a[76:79], a[112:115], v[124:127]
s_lshl_b32 s22, s21, 3
ds_read_b128 a[220:223], v30 offset:7168
v_mfma_f32_16x16x32_bf16 v[124:127], a[80:83], a[108:111], v[124:127]
s_xor_b32 s28, s70, 0
ds_read_b128 a[224:227], v31 offset:0
v_mfma_f32_16x16x32_bf16 v[124:127], a[84:87], a[104:107], v[124:127]
s_add_u32 s28, s28, s22
ds_read_b128 a[228:231], v31 offset:1024
v_mfma_f32_16x16x32_bf16 v[124:127], a[88:91], a[100:103], v[124:127]
s_add_u32 s28, s28, 6148
ds_read_b128 a[232:235], v31 offset:2048
v_mfma_f32_16x16x32_bf16 v[124:127], a[92:95], a[96:99], v[124:127]
s_waitcnt lgkmcnt(8)
s_lshl_b32 s26, s21, 16
ds_read_b128 a[236:239], v31 offset:3072
v_mfma_f32_16x16x32_bf16 v[96:99], a[128:131], a[160:163], v[96:99]
s_add_u32 s26, s26, s30
ds_read_b64_tr_b16 a[64:65], v16 offset:136
v_mfma_f32_16x16x32_bf16 v[100:103], a[128:131], a[164:167], v[100:103]
s_add_u32 s26, s26, 33554432
ds_read_b64_tr_b16 a[66:67], v16 offset:128
v_mfma_f32_16x16x32_bf16 v[100:103], a[132:135], a[160:163], v[100:103]
s_xor_b32 s76, s20, 2
ds_read_b128 a[96:99], v17 offset:320
v_mfma_f32_16x16x32_bf16 v[104:107], a[128:131], a[168:171], v[104:107]
s_lshl_b32 s76, s76, 3
ds_read_b128 a[240:243], v31 offset:4096
v_mfma_f32_16x16x32_bf16 v[104:107], a[132:135], a[164:167], v[104:107]
s_add_u32 s76, s76, s21
ds_read_b64_tr_b16 a[68:69], v16 offset:648
v_mfma_f32_16x16x32_bf16 v[104:107], a[136:139], a[160:163], v[104:107]
s_lshl_b32 s76, s76, 2
ds_read_b64_tr_b16 a[70:71], v16 offset:640
v_mfma_f32_16x16x32_bf16 v[108:111], a[128:131], a[172:175], v[108:111]
s_add_u32 s76, s76, s3
ds_read_b128 a[100:103], v17 offset:832
v_mfma_f32_16x16x32_bf16 v[108:111], a[132:135], a[168:171], v[108:111]
s_lshl_b32 s27, s76, 10
ds_read_b128 a[244:247], v31 offset:5120
v_mfma_f32_16x16x32_bf16 v[108:111], a[136:139], a[164:167], v[108:111]
s_add_u32 s27, s27, 75497472
ds_read_b64_tr_b16 a[72:73], v16 offset:1160
v_mfma_f32_16x16x32_bf16 v[108:111], a[140:143], a[160:163], v[108:111]
s_lshl_b32 s76, s76, 14
ds_read_b64_tr_b16 a[74:75], v16 offset:1152
v_mfma_f32_16x16x32_bf16 v[112:115], a[128:131], a[176:179], v[112:115]
s_add_u32 s76, s76, 67108864
ds_read_b128 a[104:107], v17 offset:1344
v_mfma_f32_16x16x32_bf16 v[112:115], a[132:135], a[172:175], v[112:115]
s_lshl_b32 s81, s20, 2
ds_read_b128 a[248:251], v31 offset:6144
v_mfma_f32_16x16x32_bf16 v[112:115], a[136:139], a[168:171], v[112:115]
s_add_u32 s81, s81, s3
ds_read_b64_tr_b16 a[76:77], v16 offset:1672
v_mfma_f32_16x16x32_bf16 v[112:115], a[140:143], a[164:167], v[112:115]
s_mul_i32 s81, s81, 57344
ds_read_b64_tr_b16 a[78:79], v16 offset:1664
v_mfma_f32_16x16x32_bf16 v[112:115], a[144:147], a[160:163], v[112:115]
PAD_30:
s_cbranch_execz M_tret
s_cmp_eq_u32 s24, 1
ds_read_b128 a[108:111], v17 offset:1856
v_mfma_f32_16x16x32_bf16 v[116:119], a[128:131], a[180:183], v[116:119]
s_cselect_b32 s80, s28, s70
ds_read_b128 a[252:255], v31 offset:7168
v_mfma_f32_16x16x32_bf16 v[116:119], a[132:135], a[176:179], v[116:119]
s_add_u32 s77, s76, 8192
ds_read_b64_tr_b16 a[80:81], v16 offset:2184
v_mfma_f32_16x16x32_bf16 v[116:119], a[136:139], a[172:175], v[116:119]
s_lshl_b32 s71, s2, 2
ds_read_b64_tr_b16 a[82:83], v16 offset:2176
v_mfma_f32_16x16x32_bf16 v[116:119], a[140:143], a[168:171], v[116:119]
s_add_u32 s71, s71, 94384128
ds_read_b128 a[112:115], v17 offset:2368
v_mfma_f32_16x16x32_bf16 v[116:119], a[144:147], a[164:167], v[116:119]
s_lshl_b32 s78, s29, 16
v_mfma_f32_16x16x32_bf16 v[116:119], a[148:151], a[160:163], v[116:119]
s_add_u32 s78, s78, s8
ds_read_b64_tr_b16 a[84:85], v16 offset:2696
v_mfma_f32_16x16x32_bf16 v[120:123], a[128:131], a[184:187], v[120:123]
s_add_u32 s78, s78, 33554432
ds_read_b64_tr_b16 a[86:87], v16 offset:2688
v_mfma_f32_16x16x32_bf16 v[120:123], a[132:135], a[180:183], v[120:123]
s_cmp_eq_u32 s24, 0
ds_read_b128 a[116:119], v17 offset:2880
v_mfma_f32_16x16x32_bf16 v[120:123], a[136:139], a[176:179], v[120:123]
s_cselect_b32 s78, 3221225472, s78
v_mfma_f32_16x16x32_bf16 v[120:123], a[140:143], a[172:175], v[120:123]
s_lshl_b32 s22, s21, 3
ds_read_b64_tr_b16 a[88:89], v16 offset:3208
v_mfma_f32_16x16x32_bf16 v[120:123], a[144:147], a[168:171], v[120:123]
s_add_u32 s22, s22, 16384
ds_read_b64_tr_b16 a[90:91], v16 offset:3200
v_mfma_f32_16x16x32_bf16 v[120:123], a[148:151], a[164:167], v[120:123]
s_andn2_b32 s23, 256, s70
ds_read_b128 a[120:123], v17 offset:3392
v_mfma_f32_16x16x32_bf16 v[120:123], a[152:155], a[160:163], v[120:123]
s_waitcnt lgkmcnt(6)
s_add_u32 s22, s22, s23
v_mfma_f32_16x16x32_bf16 v[124:127], a[128:131], a[188:191], v[124:127]
s_waitcnt vmcnt(0) lgkmcnt(9)
s_barrier
ds_read_b64_tr_b16 a[92:93], v16 offset:3720
v_writelane_b32 v15, s22, 63
v_cmp_gt_u32 vcc, 1, v21
v_mfma_f32_16x16x32_bf16 v[124:127], a[132:135], a[184:187], v[124:127]
s_cbranch_vccnz M_kspin2
M_kok2:
ds_read_b64_tr_b16 a[94:95], v16 offset:3712
v_mov_b32 v25, 0
v_mfma_f32_16x16x32_bf16 v[124:127], a[136:139], a[180:183], v[124:127]
s_mov_b32 m0, s84
ds_read_b128 a[124:127], v17 offset:3904
v_mov_b32 v128, 0
v_mfma_f32_16x16x32_bf16 v[124:127], a[140:143], a[176:179], v[124:127]
buffer_load_dwordx4 v1, s[4:7], s8 offen offset:0 sc1 lds
v_mfma_f32_16x16x32_bf16 v[124:127], a[144:147], a[172:175], v[124:127]
buffer_load_dwordx4 v1, s[4:7], s8 offen offset:1024 sc1 lds
v_mfma_f32_16x16x32_bf16 v[124:127], a[148:151], a[168:171], v[124:127]
buffer_load_dwordx4 v1, s[4:7], s8 offen offset:2048 sc1 lds
v_mfma_f32_16x16x32_bf16 v[124:127], a[152:155], a[164:167], v[124:127]
buffer_load_dwordx4 v1, s[4:7], s8 offen offset:3072 sc1 lds
v_mfma_f32_16x16x32_bf16 v[124:127], a[156:159], a[160:163], v[124:127]
s_add_u32 s8, s8, 4096
v_mov_b32 v129, 0
v_mov_b32 v130, 0
v_mfma_f32_16x16x32_bf16 v[96:99], a[64:67], a[96:99], v[96:99]
s_add_u32 m0, s84, 4096
ds_read_b64_tr_b16 a[128:129], v16 offset:200
v_mov_b32 v131, 0
v_mfma_f32_16x16x32_bf16 v[100:103], a[64:67], a[100:103], v[100:103]
ds_read_b64_tr_b16 a[130:131], v16 offset:192
v_mov_b32 v132, 0
v_mfma_f32_16x16x32_bf16 v[100:103], a[68:71], a[96:99], v[100:103]
ds_read_b128 a[160:163], v17 offset:256
v_mov_b32 v133, 0
v_mfma_f32_16x16x32_bf16 v[104:107], a[64:67], a[104:107], v[104:107]
buffer_load_dwordx4 v1, s[4:7], s8 offen offset:0 sc1 lds
v_mfma_f32_16x16x32_bf16 v[104:107], a[68:71], a[100:103], v[104:107]
ds_read_b64_tr_b16 a[132:133], v16 offset:712
v_mov_b32 v134, 0
v_mfma_f32_16x16x32_bf16 v[104:107], a[72:75], a[96:99], v[104:107]
ds_read_b64_tr_b16 a[134:135], v16 offset:704
v_mov_b32 v135, 0
v_mfma_f32_16x16x32_bf16 v[108:111], a[64:67], a[108:111], v[108:111]
ds_read_b128 a[164:167], v17 offset:768
v_mov_b32 v136, 0
v_mfma_f32_16x16x32_bf16 v[108:111], a[68:71], a[104:107], v[108:111]
buffer_load_dwordx4 v1, s[4:7], s8 offen offset:1024 sc1 lds
v_mfma_f32_16x16x32_bf16 v[108:111], a[72:75], a[100:103], v[108:111]
ds_read_b64_tr_b16 a[136:137], v16 offset:1224
v_mov_b32 v137, 0
v_mfma_f32_16x16x32_bf16 v[108:111], a[76:79], a[96:99], v[108:111]
ds_read_b64_tr_b16 a[138:139], v16 offset:1216
v_mov_b32 v138, 0
v_mfma_f32_16x16x32_bf16 v[112:115], a[64:67], a[112:115], v[112:115]
ds_read_b128 a[168:171], v17 offset:1280
v_mov_b32 v139, 0
v_mfma_f32_16x16x32_bf16 v[112:115], a[68:71], a[108:111], v[112:115]
buffer_load_dwordx4 v1, s[4:7], s8 offen offset:2048 sc1 lds
v_mfma_f32_16x16x32_bf16 v[112:115], a[72:75], a[104:107], v[112:115]
ds_read_b64_tr_b16 a[140:141], v16 offset:1736
v_mov_b32 v140, 0
v_mfma_f32_16x16x32_bf16 v[112:115], a[76:79], a[100:103], v[112:115]
ds_read_b64_tr_b16 a[142:143], v16 offset:1728
v_mov_b32 v141, 0
v_mfma_f32_16x16x32_bf16 v[112:115], a[80:83], a[96:99], v[112:115]
s_waitcnt lgkmcnt(6)
ds_read_b128 a[172:175], v17 offset:1792
v_mov_b32 v142, 0
v_mfma_f32_16x16x32_bf16 v[116:119], a[64:67], a[116:119], v[116:119]
buffer_load_dwordx4 v1, s[4:7], s8 offen offset:3072 sc1 lds
v_mfma_f32_16x16x32_bf16 v[116:119], a[68:71], a[112:115], v[116:119]
s_add_u32 s8, s8, 28672
ds_read_b64_tr_b16 a[144:145], v16 offset:2248
v_mov_b32 v143, 0
v_mfma_f32_16x16x32_bf16 v[116:119], a[72:75], a[108:111], v[116:119]
s_sub_u32 s9, s9, 1
ds_read_b64_tr_b16 a[146:147], v16 offset:2240
v_mov_b32 v144, 0
v_mfma_f32_16x16x32_bf16 v[116:119], a[76:79], a[104:107], v[116:119]
s_cmp_eq_u32 s9, 0
ds_read_b128 a[176:179], v17 offset:2304
v_mov_b32 v145, 0
v_mfma_f32_16x16x32_bf16 v[116:119], a[80:83], a[100:103], v[116:119]
s_cselect_b32 s8, s10, s8
v_mov_b32 v146, 0
v_mov_b32 v147, 0
v_mfma_f32_16x16x32_bf16 v[116:119], a[84:87], a[96:99], v[116:119]
s_cselect_b32 s9, s11, s9
ds_read_b64_tr_b16 a[148:149], v16 offset:2760
v_mov_b32 v148, 0
v_mfma_f32_16x16x32_bf16 v[120:123], a[64:67], a[120:123], v[120:123]
s_cselect_b32 s10, 3221225472, s10
ds_read_b64_tr_b16 a[150:151], v16 offset:2752
v_mov_b32 v149, 0
v_mfma_f32_16x16x32_bf16 v[120:123], a[68:71], a[116:119], v[120:123]
s_mov_b32 m0, s85
ds_read_b128 a[180:183], v17 offset:2816
v_mov_b32 v150, 0
v_mfma_f32_16x16x32_bf16 v[120:123], a[72:75], a[112:115], v[120:123]
buffer_load_dwordx4 v1, s[4:7], s8 offen offset:0 sc1 lds
v_mfma_f32_16x16x32_bf16 v[120:123], a[76:79], a[108:111], v[120:123]
ds_read_b64_tr_b16 a[152:153], v16 offset:3272
v_mov_b32 v151, 0
v_mfma_f32_16x16x32_bf16 v[120:123], a[80:83], a[104:107], v[120:123]
ds_read_b64_tr_b16 a[154:155], v16 offset:3264
v_mov_b32 v152, 0
v_mfma_f32_16x16x32_bf16 v[120:123], a[84:87], a[100:103], v[120:123]
ds_read_b128 a[184:187], v17 offset:3328
v_mov_b32 v153, 0
v_mfma_f32_16x16x32_bf16 v[120:123], a[88:91], a[96:99], v[120:123]
buffer_load_dwordx4 v1, s[4:7], s8 offen offset:1024 sc1 lds
v_mfma_f32_16x16x32_bf16 v[124:127], a[64:67], a[124:127], v[124:127]
ds_read_b64_tr_b16 a[156:157], v16 offset:3784
v_mov_b32 v154, 0
v_mfma_f32_16x16x32_bf16 v[124:127], a[68:71], a[120:123], v[124:127]
ds_read_b64_tr_b16 a[158:159], v16 offset:3776
v_mov_b32 v155, 0
v_mfma_f32_16x16x32_bf16 v[124:127], a[72:75], a[116:119], v[124:127]
ds_read_b128 a[188:191], v17 offset:3840
v_mov_b32 v156, 0
v_mfma_f32_16x16x32_bf16 v[124:127], a[76:79], a[112:115], v[124:127]
buffer_load_dwordx4 v1, s[4:7], s8 offen offset:2048 sc1 lds
v_mfma_f32_16x16x32_bf16 v[124:127], a[80:83], a[108:111], v[124:127]
buffer_load_dwordx4 v1, s[4:7], s8 offen offset:3072 sc1 lds
v_mfma_f32_16x16x32_bf16 v[124:127], a[84:87], a[104:107], v[124:127]
s_add_u32 s8, s8, 4096
v_mov_b32 v157, 0
v_mov_b32 v158, 0
v_mfma_f32_16x16x32_bf16 v[124:127], a[88:91], a[100:103], v[124:127]
s_add_u32 m0, s85, 4096
v_mov_b32 v159, 0
v_mov_b32 v160, 0
v_mfma_f32_16x16x32_bf16 v[124:127], a[92:95], a[96:99], v[124:127]
buffer_load_dwordx4 v1, s[4:7], s8 offen offset:0 sc1 lds
v_mfma_f32_16x16x32_bf16 v[96:99], a[128:131], a[160:163], v[96:99]
s_waitcnt lgkmcnt(3)
ds_read_b64_tr_b16 a[64:65], v16 offset:264
v_mov_b32 v161, 0
v_mfma_f32_16x16x32_bf16 v[100:103], a[128:131], a[164:167], v[100:103]
ds_read_b64_tr_b16 a[66:67], v16 offset:256
v_mov_b32 v162, 0
v_mfma_f32_16x16x32_bf16 v[100:103], a[132:135], a[160:163], v[100:103]
ds_read_b128 a[96:99], v17 offset:192
v_mov_b32 v163, 0
v_mfma_f32_16x16x32_bf16 v[104:107], a[128:131], a[168:171], v[104:107]
buffer_load_dwordx4 v1, s[4:7], s8 offen offset:1024 sc1 lds
v_mfma_f32_16x16x32_bf16 v[104:107], a[132:135], a[164:167], v[104:107]
ds_read_b64_tr_b16 a[68:69], v16 offset:776
v_mov_b32 v164, 0
v_mfma_f32_16x16x32_bf16 v[104:107], a[136:139], a[160:163], v[104:107]
ds_read_b64_tr_b16 a[70:71], v16 offset:768
v_mov_b32 v165, 0
v_mfma_f32_16x16x32_bf16 v[108:111], a[128:131], a[172:175], v[108:111]
ds_read_b128 a[100:103], v17 offset:704
v_mov_b32 v166, 0
v_mfma_f32_16x16x32_bf16 v[108:111], a[132:135], a[168:171], v[108:111]
buffer_load_dwordx4 v1, s[4:7], s8 offen offset:2048 sc1 lds
v_mfma_f32_16x16x32_bf16 v[108:111], a[136:139], a[164:167], v[108:111]
ds_read_b64_tr_b16 a[72:73], v16 offset:1288
v_mov_b32 v167, 0
v_mfma_f32_16x16x32_bf16 v[108:111], a[140:143], a[160:163], v[108:111]
ds_read_b64_tr_b16 a[74:75], v16 offset:1280
v_mov_b32 v168, 0
v_mfma_f32_16x16x32_bf16 v[112:115], a[128:131], a[176:179], v[112:115]
ds_read_b128 a[104:107], v17 offset:1216
v_mov_b32 v169, 0
v_mfma_f32_16x16x32_bf16 v[112:115], a[132:135], a[172:175], v[112:115]
buffer_load_dwordx4 v1, s[4:7], s8 offen offset:3072 sc1 lds
v_mfma_f32_16x16x32_bf16 v[112:115], a[136:139], a[168:171], v[112:115]
s_add_u32 s8, s8, 28672
ds_read_b64_tr_b16 a[76:77], v16 offset:1800
v_mov_b32 v170, 0
v_mfma_f32_16x16x32_bf16 v[112:115], a[140:143], a[164:167], v[112:115]
s_sub_u32 s9, s9, 1
ds_read_b64_tr_b16 a[78:79], v16 offset:1792
v_mov_b32 v171, 0
v_mfma_f32_16x16x32_bf16 v[112:115], a[144:147], a[160:163], v[112:115]
s_cmp_eq_u32 s9, 0
ds_read_b128 a[108:111], v17 offset:1728
v_mov_b32 v172, 0
v_mfma_f32_16x16x32_bf16 v[116:119], a[128:131], a[180:183], v[116:119]
s_cselect_b32 s8, s10, s8
buffer_load_dword v14, v15, s[4:7], s31 offen sc1
v_mfma_f32_16x16x32_bf16 v[116:119], a[132:135], a[176:179], v[116:119]
s_cselect_b32 s9, s11, s9
ds_read_b64_tr_b16 a[80:81], v16 offset:2312
v_mov_b32 v173, 0
v_mfma_f32_16x16x32_bf16 v[116:119], a[136:139], a[172:175], v[116:119]
s_cselect_b32 s10, 3221225472, s10
ds_read_b64_tr_b16 a[82:83], v16 offset:2304
v_mov_b32 v174, 0
v_mfma_f32_16x16x32_bf16 v[116:119], a[140:143], a[168:171], v[116:119]
ds_read_b128 a[112:115], v17 offset:2240
v_mov_b32 v175, 0
v_mfma_f32_16x16x32_bf16 v[116:119], a[144:147], a[164:167], v[116:119]
v_mov_b32 v176, 0
v_mov_b32 v177, 0
v_mfma_f32_16x16x32_bf16 v[116:119], a[148:151], a[160:163], v[116:119]
ds_read_b64_tr_b16 a[84:85], v16 offset:2824
v_mov_b32 v178, 0
v_mfma_f32_16x16x32_bf16 v[120:123], a[128:131], a[184:187], v[120:123]
ds_read_b64_tr_b16 a[86:87], v16 offset:2816
v_mov_b32 v179, 0
v_mfma_f32_16x16x32_bf16 v[120:123], a[132:135], a[180:183], v[120:123]
ds_read_b128 a[116:119], v17 offset:2752
v_mov_b32 v180, 0
v_mfma_f32_16x16x32_bf16 v[120:123], a[136:139], a[176:179], v[120:123]
v_mov_b32 v181, 0
v_mov_b32 v182, 0
v_mfma_f32_16x16x32_bf16 v[120:123], a[140:143], a[172:175], v[120:123]
ds_read_b64_tr_b16 a[88:89], v16 offset:3336
v_mov_b32 v183, 0
v_mfma_f32_16x16x32_bf16 v[120:123], a[144:147], a[168:171], v[120:123]
ds_read_b64_tr_b16 a[90:91], v16 offset:3328
v_mov_b32 v184, 0
v_mfma_f32_16x16x32_bf16 v[120:123], a[148:151], a[164:167], v[120:123]
ds_read_b128 a[120:123], v17 offset:3264
v_mov_b32 v185, 0
v_mfma_f32_16x16x32_bf16 v[120:123], a[152:155], a[160:163], v[120:123]
s_waitcnt lgkmcnt(6)
v_mov_b32 v186, 0
v_mov_b32 v187, 0
v_mfma_f32_16x16x32_bf16 v[124:127], a[128:131], a[188:191], v[124:127]
ds_read_b64_tr_b16 a[92:93], v16 offset:3848
v_mov_b32 v188, 0
v_mfma_f32_16x16x32_bf16 v[124:127], a[132:135], a[184:187], v[124:127]
ds_read_b64_tr_b16 a[94:95], v16 offset:3840
v_mov_b32 v189, 0
v_mfma_f32_16x16x32_bf16 v[124:127], a[136:139], a[180:183], v[124:127]
ds_read_b128 a[124:127], v17 offset:3776
v_mov_b32 v190, 0
v_mfma_f32_16x16x32_bf16 v[124:127], a[140:143], a[176:179], v[124:127]
v_mov_b32 v191, 0
v_mov_b32 v192, 0
v_mfma_f32_16x16x32_bf16 v[124:127], a[144:147], a[172:175], v[124:127]
v_mov_b32 v193, 0
v_mov_b32 v194, 0
v_mfma_f32_16x16x32_bf16 v[124:127], a[148:151], a[168:171], v[124:127]
v_mov_b32 v195, 0
v_mov_b32 v196, 0
v_mfma_f32_16x16x32_bf16 v[124:127], a[152:155], a[164:167], v[124:127]
v_mov_b32 v197, 0
v_mov_b32 v198, 0
v_mfma_f32_16x16x32_bf16 v[124:127], a[156:159], a[160:163], v[124:127]
v_mov_b32 v199, 0
v_mov_b32 v200, 0
s_waitcnt vmcnt(0)
v_cmp_gt_u32 vcc, 1, v14
s_cbranch_vccnz M_cspin
M_cok:
v_mfma_f32_16x16x32_bf16 v[96:99], a[64:67], a[96:99], v[96:99]
s_add_u32 s22, s78, 0
ds_read_b64_tr_b16 a[128:129], v16 offset:328
v_mov_b32 v201, 0
v_mfma_f32_16x16x32_bf16 v[100:103], a[64:67], a[100:103], v[100:103]
ds_read_b64_tr_b16 a[130:131], v16 offset:320
v_mov_b32 v202, 0
v_mfma_f32_16x16x32_bf16 v[100:103], a[68:71], a[96:99], v[100:103]
ds_read_b128 a[160:163], v17 offset:128
v_mov_b32 v203, 0
v_mfma_f32_16x16x32_bf16 v[104:107], a[64:67], a[104:107], v[104:107]
buffer_load_dwordx4 a[0:3], v1, s[4:7], s22 offen offset:0 sc1
v_mfma_f32_16x16x32_bf16 v[104:107], a[68:71], a[100:103], v[104:107]
ds_read_b64_tr_b16 a[132:133], v16 offset:840
v_mov_b32 v204, 0
v_mfma_f32_16x16x32_bf16 v[104:107], a[72:75], a[96:99], v[104:107]
ds_read_b64_tr_b16 a[134:135], v16 offset:832
v_mov_b32 v205, 0
v_mfma_f32_16x16x32_bf16 v[108:111], a[64:67], a[108:111], v[108:111]
ds_read_b128 a[164:167], v17 offset:640
v_mov_b32 v206, 0
v_mfma_f32_16x16x32_bf16 v[108:111], a[68:71], a[104:107], v[108:111]
buffer_load_dwordx4 a[4:7], v1, s[4:7], s22 offen offset:1024 sc1
v_mfma_f32_16x16x32_bf16 v[108:111], a[72:75], a[100:103], v[108:111]
ds_read_b64_tr_b16 a[136:137], v16 offset:1352
v_mov_b32 v207, 0
v_mfma_f32_16x16x32_bf16 v[108:111], a[76:79], a[96:99], v[108:111]
ds_read_b64_tr_b16 a[138:139], v16 offset:1344
v_mov_b32 v208, 0
v_mfma_f32_16x16x32_bf16 v[112:115], a[64:67], a[112:115], v[112:115]
ds_read_b128 a[168:171], v17 offset:1152
v_mov_b32 v209, 0
v_mfma_f32_16x16x32_bf16 v[112:115], a[68:71], a[108:111], v[112:115]
buffer_load_dwordx4 a[8:11], v1, s[4:7], s22 offen offset:2048 sc1
v_mfma_f32_16x16x32_bf16 v[112:115], a[72:75], a[104:107], v[112:115]
ds_read_b64_tr_b16 a[140:141], v16 offset:1864
v_mov_b32 v210, 0
v_mfma_f32_16x16x32_bf16 v[112:115], a[76:79], a[100:103], v[112:115]
ds_read_b64_tr_b16 a[142:143], v16 offset:1856
v_mov_b32 v211, 0
v_mfma_f32_16x16x32_bf16 v[112:115], a[80:83], a[96:99], v[112:115]
s_waitcnt lgkmcnt(6)
ds_read_b128 a[172:175], v17 offset:1664
v_mov_b32 v212, 0
v_mfma_f32_16x16x32_bf16 v[116:119], a[64:67], a[116:119], v[116:119]
buffer_load_dwordx4 a[12:15], v1, s[4:7], s22 offen offset:3072 sc1
v_mfma_f32_16x16x32_bf16 v[116:119], a[68:71], a[112:115], v[116:119]
s_add_u32 s22, s78, 4096
ds_read_b64_tr_b16 a[144:145], v16 offset:2376
v_mov_b32 v213, 0
v_mfma_f32_16x16x32_bf16 v[116:119], a[72:75], a[108:111], v[116:119]
ds_read_b64_tr_b16 a[146:147], v16 offset:2368
v_mov_b32 v214, 0
v_mfma_f32_16x16x32_bf16 v[116:119], a[76:79], a[104:107], v[116:119]
ds_read_b128 a[176:179], v17 offset:2176
v_mov_b32 v215, 0
v_mfma_f32_16x16x32_bf16 v[116:119], a[80:83], a[100:103], v[116:119]
buffer_load_dwordx4 a[16:19], v1, s[4:7], s22 offen offset:0 sc1
v_mfma_f32_16x16x32_bf16 v[116:119], a[84:87], a[96:99], v[116:119]
ds_read_b64_tr_b16 a[148:149], v16 offset:2888
v_mov_b32 v216, 0
v_mfma_f32_16x16x32_bf16 v[120:123], a[64:67], a[120:123], v[120:123]
ds_read_b64_tr_b16 a[150:151], v16 offset:2880
v_mov_b32 v217, 0
v_mfma_f32_16x16x32_bf16 v[120:123], a[68:71], a[116:119], v[120:123]
ds_read_b128 a[180:183], v17 offset:2688
v_mov_b32 v218, 0
v_mfma_f32_16x16x32_bf16 v[120:123], a[72:75], a[112:115], v[120:123]
buffer_load_dwordx4 a[20:23], v1, s[4:7], s22 offen offset:1024 sc1
v_mfma_f32_16x16x32_bf16 v[120:123], a[76:79], a[108:111], v[120:123]
ds_read_b64_tr_b16 a[152:153], v16 offset:3400
v_mov_b32 v219, 0
v_mfma_f32_16x16x32_bf16 v[120:123], a[80:83], a[104:107], v[120:123]
ds_read_b64_tr_b16 a[154:155], v16 offset:3392
v_mov_b32 v220, 0
v_mfma_f32_16x16x32_bf16 v[120:123], a[84:87], a[100:103], v[120:123]
ds_read_b128 a[184:187], v17 offset:3200
v_mov_b32 v221, 0
v_mfma_f32_16x16x32_bf16 v[120:123], a[88:91], a[96:99], v[120:123]
buffer_load_dwordx4 a[24:27], v1, s[4:7], s22 offen offset:2048 sc1
v_mfma_f32_16x16x32_bf16 v[124:127], a[64:67], a[124:127], v[124:127]
ds_read_b64_tr_b16 a[156:157], v16 offset:3912
v_mov_b32 v222, 0
v_mfma_f32_16x16x32_bf16 v[124:127], a[68:71], a[120:123], v[124:127]
ds_read_b64_tr_b16 a[158:159], v16 offset:3904
v_mov_b32 v223, 0
v_mfma_f32_16x16x32_bf16 v[124:127], a[72:75], a[116:119], v[124:127]
ds_read_b128 a[188:191], v17 offset:3712
v_mov_b32 v224, 0
v_mfma_f32_16x16x32_bf16 v[124:127], a[76:79], a[112:115], v[124:127]
buffer_load_dwordx4 a[28:31], v1, s[4:7], s22 offen offset:3072 sc1
v_mfma_f32_16x16x32_bf16 v[124:127], a[80:83], a[108:111], v[124:127]
s_add_u32 s22, s78, 32768
buffer_load_dwordx4 a[32:35], v1, s[4:7], s22 offen offset:0 sc1
v_mfma_f32_16x16x32_bf16 v[124:127], a[84:87], a[104:107], v[124:127]
buffer_load_dwordx4 a[36:39], v1, s[4:7], s22 offen offset:1024 sc1
v_mfma_f32_16x16x32_bf16 v[124:127], a[88:91], a[100:103], v[124:127]
buffer_load_dwordx4 a[40:43], v1, s[4:7], s22 offen offset:2048 sc1
v_mfma_f32_16x16x32_bf16 v[124:127], a[92:95], a[96:99], v[124:127]
s_waitcnt lgkmcnt(3)
buffer_load_dwordx4 a[44:47], v1, s[4:7], s22 offen offset:3072 sc1
v_mfma_f32_16x16x32_bf16 v[96:99], a[128:131], a[160:163], v[96:99]
s_add_u32 s22, s78, 36864
ds_read_b64_tr_b16 a[64:65], v16 offset:392
v_mov_b32 v225, 0
v_mfma_f32_16x16x32_bf16 v[100:103], a[128:131], a[164:167], v[100:103]
ds_read_b64_tr_b16 a[66:67], v16 offset:384
v_mov_b32 v226, 0
v_mfma_f32_16x16x32_bf16 v[100:103], a[132:135], a[160:163], v[100:103]
ds_read_b128 a[96:99], v17 offset:64
v_mov_b32 v227, 0
v_mfma_f32_16x16x32_bf16 v[104:107], a[128:131], a[168:171], v[104:107]
ds_read_b64 v[36:37], v18 offset:0
v_mov_b32 v228, 0
v_mfma_f32_16x16x32_bf16 v[104:107], a[132:135], a[164:167], v[104:107]
ds_read_b64_tr_b16 a[68:69], v16 offset:904
v_mov_b32 v229, 0
v_mfma_f32_16x16x32_bf16 v[104:107], a[136:139], a[160:163], v[104:107]
ds_read_b64_tr_b16 a[70:71], v16 offset:896
v_mov_b32 v230, 0
v_mfma_f32_16x16x32_bf16 v[108:111], a[128:131], a[172:175], v[108:111]
ds_read_b128 a[100:103], v17 offset:576
v_mov_b32 v231, 0
v_mfma_f32_16x16x32_bf16 v[108:111], a[132:135], a[168:171], v[108:111]
ds_read_b64 v[38:39], v18 offset:512
v_mov_b32 v232, 0
v_mfma_f32_16x16x32_bf16 v[108:111], a[136:139], a[164:167], v[108:111]
ds_read_b64_tr_b16 a[72:73], v16 offset:1416
v_mov_b32 v233, 0
v_mfma_f32_16x16x32_bf16 v[108:111], a[140:143], a[160:163], v[108:111]
ds_read_b64_tr_b16 a[74:75], v16 offset:1408
v_mov_b32 v234, 0
v_mfma_f32_16x16x32_bf16 v[112:115], a[128:131], a[176:179], v[112:115]
ds_read_b128 a[104:107], v17 offset:1088
v_mov_b32 v235, 0
v_mfma_f32_16x16x32_bf16 v[112:115], a[132:135], a[172:175], v[112:115]
ds_read_b64 v[44:45], v18 offset:1024
v_mov_b32 v236, 0
v_mfma_f32_16x16x32_bf16 v[112:115], a[136:139], a[168:171], v[112:115]
ds_read_b64_tr_b16 a[76:77], v16 offset:1928
v_mov_b32 v237, 0
v_mfma_f32_16x16x32_bf16 v[112:115], a[140:143], a[164:167], v[112:115]
ds_read_b64_tr_b16 a[78:79], v16 offset:1920
v_mov_b32 v238, 0
v_mfma_f32_16x16x32_bf16 v[112:115], a[144:147], a[160:163], v[112:115]
ds_read_b128 a[108:111], v17 offset:1600
v_mov_b32 v239, 0
v_mfma_f32_16x16x32_bf16 v[116:119], a[128:131], a[180:183], v[116:119]
ds_read_b64 v[46:47], v18 offset:1536
v_mov_b32 v240, 0
v_mfma_f32_16x16x32_bf16 v[116:119], a[132:135], a[176:179], v[116:119]
ds_read_b64_tr_b16 a[80:81], v16 offset:2440
v_mov_b32 v241, 0
v_mfma_f32_16x16x32_bf16 v[116:119], a[136:139], a[172:175], v[116:119]
ds_read_b64_tr_b16 a[82:83], v16 offset:2432
v_mov_b32 v242, 0
v_mfma_f32_16x16x32_bf16 v[116:119], a[140:143], a[168:171], v[116:119]
ds_read_b128 a[112:115], v17 offset:2112
v_mov_b32 v243, 0
v_mfma_f32_16x16x32_bf16 v[116:119], a[144:147], a[164:167], v[116:119]
ds_read_b64 v[52:53], v18 offset:2048
v_mov_b32 v244, 0
v_mfma_f32_16x16x32_bf16 v[116:119], a[148:151], a[160:163], v[116:119]
ds_read_b64_tr_b16 a[84:85], v16 offset:2952
v_mov_b32 v245, 0
v_mfma_f32_16x16x32_bf16 v[120:123], a[128:131], a[184:187], v[120:123]
ds_read_b64_tr_b16 a[86:87], v16 offset:2944
v_mov_b32 v246, 0
v_mfma_f32_16x16x32_bf16 v[120:123], a[132:135], a[180:183], v[120:123]
ds_read_b128 a[116:119], v17 offset:2624
v_mov_b32 v247, 0
v_mfma_f32_16x16x32_bf16 v[120:123], a[136:139], a[176:179], v[120:123]
ds_read_b64 v[54:55], v18 offset:2560
v_mov_b32 v248, 0
v_mfma_f32_16x16x32_bf16 v[120:123], a[140:143], a[172:175], v[120:123]
ds_read_b64_tr_b16 a[88:89], v16 offset:3464
v_mov_b32 v249, 0
v_mfma_f32_16x16x32_bf16 v[120:123], a[144:147], a[168:171], v[120:123]
ds_read_b64_tr_b16 a[90:91], v16 offset:3456
v_mov_b32 v250, 0
v_mfma_f32_16x16x32_bf16 v[120:123], a[148:151], a[164:167], v[120:123]
ds_read_b128 a[120:123], v17 offset:3136
v_mov_b32 v251, 0
v_mfma_f32_16x16x32_bf16 v[120:123], a[152:155], a[160:163], v[120:123]
s_waitcnt lgkmcnt(8)
ds_read_b64 v[60:61], v18 offset:3072
v_mov_b32 v252, 0
v_mfma_f32_16x16x32_bf16 v[124:127], a[128:131], a[188:191], v[124:127]
ds_read_b64_tr_b16 a[92:93], v16 offset:3976
v_mov_b32 v253, 0
v_mfma_f32_16x16x32_bf16 v[124:127], a[132:135], a[184:187], v[124:127]
ds_read_b64_tr_b16 a[94:95], v16 offset:3968
v_mov_b32 v254, 0
v_mfma_f32_16x16x32_bf16 v[124:127], a[136:139], a[180:183], v[124:127]
ds_read_b128 a[124:127], v17 offset:3648
v_mov_b32 v255, 0
v_mfma_f32_16x16x32_bf16 v[124:127], a[140:143], a[176:179], v[124:127]
ds_read_b64 v[62:63], v18 offset:3584
v_mfma_f32_16x16x32_bf16 v[124:127], a[144:147], a[172:175], v[124:127]
buffer_load_dwordx4 a[48:51], v1, s[4:7], s22 offen offset:0 sc1
v_mfma_f32_16x16x32_bf16 v[124:127], a[148:151], a[168:171], v[124:127]
buffer_load_dwordx4 a[52:55], v1, s[4:7], s22 offen offset:1024 sc1
v_mfma_f32_16x16x32_bf16 v[124:127], a[152:155], a[164:167], v[124:127]
buffer_load_dwordx4 a[56:59], v1, s[4:7], s22 offen offset:2048 sc1
v_mfma_f32_16x16x32_bf16 v[124:127], a[156:159], a[160:163], v[124:127]
buffer_load_dwordx4 a[60:63], v1, s[4:7], s22 offen offset:3072 sc1
v_mfma_f32_16x16x32_bf16 v[96:99], a[64:67], a[96:99], v[96:99]
ds_read_b64_tr_b16 a[128:129], v16 offset:456
v_mfma_f32_16x16x32_bf16 v[100:103], a[64:67], a[100:103], v[100:103]
ds_read_b64_tr_b16 a[130:131], v16 offset:448
v_mfma_f32_16x16x32_bf16 v[100:103], a[68:71], a[96:99], v[100:103]
ds_read_b128 a[160:163], v17 offset:0
v_mfma_f32_16x16x32_bf16 v[104:107], a[64:67], a[104:107], v[104:107]
v_mfma_f32_16x16x32_bf16 v[104:107], a[68:71], a[100:103], v[104:107]
ds_read_b64_tr_b16 a[132:133], v16 offset:968
v_mfma_f32_16x16x32_bf16 v[104:107], a[72:75], a[96:99], v[104:107]
ds_read_b64_tr_b16 a[134:135], v16 offset:960
v_mfma_f32_16x16x32_bf16 v[108:111], a[64:67], a[108:111], v[108:111]
ds_read_b128 a[164:167], v17 offset:512
v_mfma_f32_16x16x32_bf16 v[108:111], a[68:71], a[104:107], v[108:111]
v_mfma_f32_16x16x32_bf16 v[108:111], a[72:75], a[100:103], v[108:111]
ds_read_b64_tr_b16 a[136:137], v16 offset:1480
v_mfma_f32_16x16x32_bf16 v[108:111], a[76:79], a[96:99], v[108:111]
ds_read_b64_tr_b16 a[138:139], v16 offset:1472
v_mfma_f32_16x16x32_bf16 v[112:115], a[64:67], a[112:115], v[112:115]
ds_read_b128 a[168:171], v17 offset:1024
v_mfma_f32_16x16x32_bf16 v[112:115], a[68:71], a[108:111], v[112:115]
v_mfma_f32_16x16x32_bf16 v[112:115], a[72:75], a[104:107], v[112:115]
ds_read_b64_tr_b16 a[140:141], v16 offset:1992
v_mfma_f32_16x16x32_bf16 v[112:115], a[76:79], a[100:103], v[112:115]
ds_read_b64_tr_b16 a[142:143], v16 offset:1984
v_mfma_f32_16x16x32_bf16 v[112:115], a[80:83], a[96:99], v[112:115]
s_waitcnt lgkmcnt(6)
ds_read_b128 a[172:175], v17 offset:1536
v_mfma_f32_16x16x32_bf16 v[116:119], a[64:67], a[116:119], v[116:119]
v_mfma_f32_16x16x32_bf16 v[116:119], a[68:71], a[112:115], v[116:119]
ds_read_b64_tr_b16 a[144:145], v16 offset:2504
v_mfma_f32_16x16x32_bf16 v[116:119], a[72:75], a[108:111], v[116:119]
ds_read_b64_tr_b16 a[146:147], v16 offset:2496
v_mfma_f32_16x16x32_bf16 v[116:119], a[76:79], a[104:107], v[116:119]
ds_read_b128 a[176:179], v17 offset:2048
v_mfma_f32_16x16x32_bf16 v[116:119], a[80:83], a[100:103], v[116:119]
v_mfma_f32_16x16x32_bf16 v[116:119], a[84:87], a[96:99], v[116:119]
ds_read_b64_tr_b16 a[148:149], v16 offset:3016
v_mfma_f32_16x16x32_bf16 v[120:123], a[64:67], a[120:123], v[120:123]
ds_read_b64_tr_b16 a[150:151], v16 offset:3008
v_mfma_f32_16x16x32_bf16 v[120:123], a[68:71], a[116:119], v[120:123]
ds_read_b128 a[180:183], v17 offset:2560
v_mfma_f32_16x16x32_bf16 v[120:123], a[72:75], a[112:115], v[120:123]
v_mfma_f32_16x16x32_bf16 v[120:123], a[76:79], a[108:111], v[120:123]
ds_read_b64_tr_b16 a[152:153], v16 offset:3528
v_mfma_f32_16x16x32_bf16 v[120:123], a[80:83], a[104:107], v[120:123]
ds_read_b64_tr_b16 a[154:155], v16 offset:3520
v_mfma_f32_16x16x32_bf16 v[120:123], a[84:87], a[100:103], v[120:123]
ds_read_b128 a[184:187], v17 offset:3072
v_mfma_f32_16x16x32_bf16 v[120:123], a[88:91], a[96:99], v[120:123]
v_mfma_f32_16x16x32_bf16 v[124:127], a[64:67], a[124:127], v[124:127]
ds_read_b64_tr_b16 a[156:157], v16 offset:4040
v_mfma_f32_16x16x32_bf16 v[124:127], a[68:71], a[120:123], v[124:127]
ds_read_b64_tr_b16 a[158:159], v16 offset:4032
v_mfma_f32_16x16x32_bf16 v[124:127], a[72:75], a[116:119], v[124:127]
ds_read_b128 a[188:191], v17 offset:3584
v_mfma_f32_16x16x32_bf16 v[124:127], a[76:79], a[112:115], v[124:127]
v_mfma_f32_16x16x32_bf16 v[124:127], a[80:83], a[108:111], v[124:127]
v_mfma_f32_16x16x32_bf16 v[124:127], a[84:87], a[104:107], v[124:127]
v_mfma_f32_16x16x32_bf16 v[124:127], a[88:91], a[100:103], v[124:127]
v_mfma_f32_16x16x32_bf16 v[124:127], a[92:95], a[96:99], v[124:127]
v_mfma_f32_16x16x32_bf16 v[96:99], a[128:131], a[160:163], v[96:99]
s_waitcnt lgkmcnt(3)
v_mfma_f32_16x16x32_bf16 v[100:103], a[128:131], a[164:167], v[100:103]
v_mfma_f32_16x16x32_bf16 v[100:103], a[132:135], a[160:163], v[100:103]
v_mfma_f32_16x16x32_bf16 v[104:107], a[128:131], a[168:171], v[104:107]
v_mfma_f32_16x16x32_bf16 v[104:107], a[132:135], a[164:167], v[104:107]
v_mfma_f32_16x16x32_bf16 v[104:107], a[136:139], a[160:163], v[104:107]
v_mfma_f32_16x16x32_bf16 v[108:111], a[128:131], a[172:175], v[108:111]
v_mfma_f32_16x16x32_bf16 v[108:111], a[132:135], a[168:171], v[108:111]
v_mfma_f32_16x16x32_bf16 v[108:111], a[136:139], a[164:167], v[108:111]
v_lshlrev_b32 v10, 16, v36
v_fmac_f32 v96, v19, v10
v_mfma_f32_16x16x32_bf16 v[108:111], a[140:143], a[160:163], v[108:111]
v_and_b32 v11, 0xffff0000, v36
v_fmac_f32 v97, v19, v11
v_mfma_f32_16x16x32_bf16 v[112:115], a[128:131], a[176:179], v[112:115]
v_lshlrev_b32 v12, 16, v37
v_fmac_f32 v98, v19, v12
v_mfma_f32_16x16x32_bf16 v[112:115], a[132:135], a[172:175], v[112:115]
v_and_b32 v13, 0xffff0000, v37
v_fmac_f32 v99, v19, v13
v_mfma_f32_16x16x32_bf16 v[112:115], a[136:139], a[168:171], v[112:115]
v_cvt_pk_bf16_f32 v96, v96, v97
v_cvt_pk_bf16_f32 v97, v98, v99
v_mfma_f32_16x16x32_bf16 v[112:115], a[140:143], a[164:167], v[112:115]
buffer_store_dwordx2 v[96:97], v8, s[4:7], s83 offen offset:0 sc1
v_mfma_f32_16x16x32_bf16 v[112:115], a[144:147], a[160:163], v[112:115]
v_lshlrev_b32 v10, 16, v38
v_fmac_f32 v100, v19, v10
v_mfma_f32_16x16x32_bf16 v[116:119], a[128:131], a[180:183], v[116:119]
v_and_b32 v11, 0xffff0000, v38
v_fmac_f32 v101, v19, v11
v_mfma_f32_16x16x32_bf16 v[116:119], a[132:135], a[176:179], v[116:119]
v_lshlrev_b32 v12, 16, v39
v_fmac_f32 v102, v19, v12
v_mfma_f32_16x16x32_bf16 v[116:119], a[136:139], a[172:175], v[116:119]
v_and_b32 v13, 0xffff0000, v39
v_fmac_f32 v103, v19, v13
v_mfma_f32_16x16x32_bf16 v[116:119], a[140:143], a[168:171], v[116:119]
v_cvt_pk_bf16_f32 v100, v100, v101
v_cvt_pk_bf16_f32 v101, v102, v103
v_mfma_f32_16x16x32_bf16 v[116:119], a[144:147], a[164:167], v[116:119]
buffer_store_dwordx2 v[100:101], v8, s[4:7], s83 offen offset:512 sc1
v_mfma_f32_16x16x32_bf16 v[116:119], a[148:151], a[160:163], v[116:119]
PAD_31:
s_cbranch_execz M_tret
v_lshlrev_b32 v10, 16, v44
v_fmac_f32 v104, v19, v10
v_mfma_f32_16x16x32_bf16 v[120:123], a[128:131], a[184:187], v[120:123]
v_and_b32 v11, 0xffff0000, v44
v_fmac_f32 v105, v19, v11
v_mfma_f32_16x16x32_bf16 v[120:123], a[132:135], a[180:183], v[120:123]
v_lshlrev_b32 v12, 16, v45
v_fmac_f32 v106, v19, v12
v_mfma_f32_16x16x32_bf16 v[120:123], a[136:139], a[176:179], v[120:123]
v_and_b32 v13, 0xffff0000, v45
v_fmac_f32 v107, v19, v13
v_mfma_f32_16x16x32_bf16 v[120:123], a[140:143], a[172:175], v[120:123]
v_cvt_pk_bf16_f32 v104, v104, v105
v_cvt_pk_bf16_f32 v105, v106, v107
v_mfma_f32_16x16x32_bf16 v[120:123], a[144:147], a[168:171], v[120:123]
buffer_store_dwordx2 v[104:105], v8, s[4:7], s83 offen offset:1024 sc1
v_mfma_f32_16x16x32_bf16 v[120:123], a[148:151], a[164:167], v[120:123]
v_lshlrev_b32 v10, 16, v46
v_fmac_f32 v108, v19, v10
v_mfma_f32_16x16x32_bf16 v[120:123], a[152:155], a[160:163], v[120:123]
s_waitcnt lgkmcnt(0)
v_and_b32 v11, 0xffff0000, v46
v_fmac_f32 v109, v19, v11
v_mfma_f32_16x16x32_bf16 v[124:127], a[128:131], a[188:191], v[124:127]
v_lshlrev_b32 v12, 16, v47
v_fmac_f32 v110, v19, v12
v_mfma_f32_16x16x32_bf16 v[124:127], a[132:135], a[184:187], v[124:127]
v_and_b32 v13, 0xffff0000, v47
v_fmac_f32 v111, v19, v13
v_mfma_f32_16x16x32_bf16 v[124:127], a[136:139], a[180:183], v[124:127]
v_cvt_pk_bf16_f32 v108, v108, v109
v_cvt_pk_bf16_f32 v109, v110, v111
v_mfma_f32_16x16x32_bf16 v[124:127], a[140:143], a[176:179], v[124:127]
buffer_store_dwordx2 v[108:109], v8, s[4:7], s83 offen offset:1536 sc1
v_mfma_f32_16x16x32_bf16 v[124:127], a[144:147], a[172:175], v[124:127]
v_lshlrev_b32 v10, 16, v52
v_fmac_f32 v112, v19, v10
v_mfma_f32_16x16x32_bf16 v[124:127], a[148:151], a[168:171], v[124:127]
v_and_b32 v11, 0xffff0000, v52
v_fmac_f32 v113, v19, v11
v_mfma_f32_16x16x32_bf16 v[124:127], a[152:155], a[164:167], v[124:127]
v_lshlrev_b32 v12, 16, v53
v_fmac_f32 v114, v19, v12
v_mfma_f32_16x16x32_bf16 v[124:127], a[156:159], a[160:163], v[124:127]
v_and_b32 v13, 0xffff0000, v53
v_fmac_f32 v115, v19, v13
v_cvt_pk_bf16_f32 v112, v112, v113
v_cvt_pk_bf16_f32 v113, v114, v115
buffer_store_dwordx2 v[112:113], v8, s[4:7], s83 offen offset:2048 sc1
v_lshlrev_b32 v10, 16, v54
v_fmac_f32 v116, v19, v10
v_and_b32 v11, 0xffff0000, v54
v_fmac_f32 v117, v19, v11
v_lshlrev_b32 v12, 16, v55
v_fmac_f32 v118, v19, v12
v_and_b32 v13, 0xffff0000, v55
v_fmac_f32 v119, v19, v13
v_cvt_pk_bf16_f32 v116, v116, v117
v_cvt_pk_bf16_f32 v117, v118, v119
buffer_store_dwordx2 v[116:117], v8, s[4:7], s83 offen offset:2560 sc1
v_lshlrev_b32 v10, 16, v60
v_fmac_f32 v120, v19, v10
v_and_b32 v11, 0xffff0000, v60
v_fmac_f32 v121, v19, v11
v_lshlrev_b32 v12, 16, v61
v_fmac_f32 v122, v19, v12
v_and_b32 v13, 0xffff0000, v61
v_fmac_f32 v123, v19, v13
v_cvt_pk_bf16_f32 v120, v120, v121
v_cvt_pk_bf16_f32 v121, v122, v123
buffer_store_dwordx2 v[120:121], v8, s[4:7], s83 offen offset:3072 sc1
v_lshlrev_b32 v10, 16, v62
v_fmac_f32 v124, v19, v10
v_and_b32 v11, 0xffff0000, v62
v_fmac_f32 v125, v19, v11
v_lshlrev_b32 v12, 16, v63
v_fmac_f32 v126, v19, v12
v_and_b32 v13, 0xffff0000, v63
v_fmac_f32 v127, v19, v13
v_cvt_pk_bf16_f32 v124, v124, v125
v_cvt_pk_bf16_f32 v125, v126, v127
buffer_store_dwordx2 v[124:125], v8, s[4:7], s83 offen offset:3584 sc1
v_lshrrev_b32 v8, 7, v1
v_and_b32 v9, 6, v8
v_lshlrev_b32 v9, 4, v9
v_and_b32 v10, 0x70, v1
v_xor_b32 v9, v9, v10
v_mul_u32_u24 v8, 896, v8
v_add_u32 v8, v8, v9
v_accvgpr_write_b32 a184, v8
v_add_u32 v8, 6144, v8
v_accvgpr_write_b32 a185, v8
v_add_u32 v8, 6144, v8
v_accvgpr_write_b32 a186, v8
v_add_u32 v8, 6144, v8
v_accvgpr_write_b32 a187, v8
v_lshrrev_b32 v8, 6, v1
v_bfe_u32 v9, v1, 7, 2
v_lshlrev_b32 v9, 5, v9
v_lshl_add_u32 v8, v8, 7, v9
v_bfe_u32 v9, v1, 4, 2
v_lshl_add_u32 v8, v9, 3, v8
v_add_u32 v8, 32768, v8
v_accvgpr_write_b32 a188, v8
v_xor_b32 v9, 32, v8
v_accvgpr_write_b32 a189, v9
v_xor_b32 v9, 64, v8
v_accvgpr_write_b32 a190, v9
v_xor_b32 v9, 96, v8
v_accvgpr_write_b32 a191, v9
s_branch M_t2B
M_t2Br:
s_waitcnt vmcnt(8)
s_barrier
s_cmp_lg_u32 s24, 0
s_cbranch_scc1 K2_item
v_accvgpr_mov_b32 a0, a192
v_accvgpr_mov_b32 a1, a193
v_accvgpr_mov_b32 a2, a194
v_accvgpr_mov_b32 a3, a195
v_accvgpr_mov_b32 a4, a196
v_accvgpr_mov_b32 a5, a197
v_accvgpr_mov_b32 a6, a198
v_accvgpr_mov_b32 a7, a199
v_accvgpr_mov_b32 a8, a200
v_accvgpr_mov_b32 a9, a201
v_accvgpr_mov_b32 a10, a202
v_accvgpr_mov_b32 a11, a203
v_accvgpr_mov_b32 a12, a204
v_accvgpr_mov_b32 a13, a205
v_accvgpr_mov_b32 a14, a206
v_accvgpr_mov_b32 a15, a207
v_accvgpr_mov_b32 a16, a208
v_accvgpr_mov_b32 a17, a209
v_accvgpr_mov_b32 a18, a210
v_accvgpr_mov_b32 a19, a211
v_accvgpr_mov_b32 a20, a212
v_accvgpr_mov_b32 a21, a213
v_accvgpr_mov_b32 a22, a214
v_accvgpr_mov_b32 a23, a215
v_accvgpr_mov_b32 a24, a216
v_accvgpr_mov_b32 a25, a217
v_accvgpr_mov_b32 a26, a218
v_accvgpr_mov_b32 a27, a219
v_accvgpr_mov_b32 a28, a220
v_accvgpr_mov_b32 a29, a221
v_accvgpr_mov_b32 a30, a222
v_accvgpr_mov_b32 a31, a223
v_accvgpr_mov_b32 a32, a224
v_accvgpr_mov_b32 a33, a225
v_accvgpr_mov_b32 a34, a226
v_accvgpr_mov_b32 a35, a227
v_accvgpr_mov_b32 a36, a228
v_accvgpr_mov_b32 a37, a229
v_accvgpr_mov_b32 a38, a230
v_accvgpr_mov_b32 a39, a231
v_accvgpr_mov_b32 a40, a232
v_accvgpr_mov_b32 a41, a233
v_accvgpr_mov_b32 a42, a234
v_accvgpr_mov_b32 a43, a235
v_accvgpr_mov_b32 a44, a236
v_accvgpr_mov_b32 a45, a237
v_accvgpr_mov_b32 a46, a238
v_accvgpr_mov_b32 a47, a239
v_accvgpr_mov_b32 a48, a240
v_accvgpr_mov_b32 a49, a241
v_accvgpr_mov_b32 a50, a242
v_accvgpr_mov_b32 a51, a243
v_accvgpr_mov_b32 a52, a244
v_accvgpr_mov_b32 a53, a245
v_accvgpr_mov_b32 a54, a246
v_accvgpr_mov_b32 a55, a247
v_accvgpr_mov_b32 a56, a248
v_accvgpr_mov_b32 a57, a249
v_accvgpr_mov_b32 a58, a250
v_accvgpr_mov_b32 a59, a251
v_accvgpr_mov_b32 a60, a252
v_accvgpr_mov_b32 a61, a253
v_accvgpr_mov_b32 a62, a254
v_accvgpr_mov_b32 a63, a255
s_branch K2_item
M_cend:
M_cspin:
Lp_16:
buffer_load_dword v14, v15, s[4:7], s31 offen sc1
s_waitcnt vmcnt(0)
v_cmp_gt_u32 vcc, 1, v14
s_cbranch_vccz Lpd_17
s_sleep 8
s_sub_u32 s101, s101, 1
s_cbranch_scc0 Lp_16
s_mov_b32 s101, 0
Lpd_17:
s_branch M_cok
M_kspin:
Lp_18:
buffer_load_dword v21, v20, s[4:7], s70 offen sc1
s_waitcnt vmcnt(0)
v_cmp_gt_u32 vcc, 1, v21
s_cbranch_vccz Lpd_19
s_sleep 8
s_sub_u32 s101, s101, 1
s_cbranch_scc0 Lp_18
s_mov_b32 s101, 0
Lpd_19:
s_branch M_kok
M_kspin2:
Lp_20:
buffer_load_dword v21, v20, s[4:7], s31 offen sc1
s_waitcnt vmcnt(0)
v_cmp_gt_u32 vcc, 1, v21
s_cbranch_vccz Lpd_21
s_sleep 8
s_sub_u32 s101, s101, 1
s_cbranch_scc0 Lp_20
s_mov_b32 s101, 0
Lpd_21:
s_branch M_kok2
M_vspin:
Lp_22:
buffer_load_dword v21, v15, s[4:7], s70 offen sc1
s_waitcnt vmcnt(0)
v_cmp_gt_u32 vcc, 1, v21
s_cbranch_vccz Lpd_23
s_sleep 8
s_sub_u32 s101, s101, 1
s_cbranch_scc0 Lp_22
s_mov_b32 s101, 0
Lpd_23:
s_branch M_vok
PAD_32:
s_cbranch_execz M_tret
K2_plain:
v_mfma_f32_16x16x32_bf16 v[128:131], a[64:67], v[96:99], v[128:131]
s_waitcnt lgkmcnt(6)
ds_read_b128 a[96:99], v2 offset:8192
v_add_f32 v24, v24, v26
v_mfma_f32_16x16x32_bf16 v[128:131], a[68:71], v[100:103], v[128:131]
s_waitcnt lgkmcnt(5)
v_mfma_f32_16x16x32_bf16 v[132:135], a[68:71], v[108:111], v[132:135]
s_mov_b64 s[36:37], s[86:87]
ds_read_b128 a[100:103], v2 offset:9216
v_add_f32 v25, v25, v27
v_mfma_f32_16x16x32_bf16 v[132:135], a[64:67], v[104:107], v[132:135]
s_mov_b32 s38, 3670016
v_exp_f32 v8, v68
v_mfma_f32_16x16x32_bf16 v[136:139], a[72:75], v[96:99], v[136:139]
s_mov_b32 s39, 0x20000
ds_read_b128 a[104:107], v2 offset:10240
v_accvgpr_read_b32 v112, a184
v_mfma_f32_16x16x32_bf16 v[136:139], a[76:79], v[100:103], v[136:139]
v_accvgpr_read_b32 v113, a185
v_accvgpr_read_b32 v114, a186
v_mfma_f32_16x16x32_bf16 v[140:143], a[76:79], v[108:111], v[140:143]
ds_read_b128 a[108:111], v2 offset:11264
v_accvgpr_read_b32 v115, a187
v_mfma_f32_16x16x32_bf16 v[140:143], a[72:75], v[104:107], v[140:143]
s_waitcnt lgkmcnt(5)
v_accvgpr_read_b32 v116, a188
v_accvgpr_read_b32 v117, a189
v_mfma_f32_16x16x32_bf16 v[144:147], a[80:83], v[96:99], v[144:147]
ds_read_b128 a[112:115], v2 offset:12288
v_accvgpr_read_b32 v118, a190
v_mfma_f32_16x16x32_bf16 v[144:147], a[84:87], v[100:103], v[144:147]
v_accvgpr_read_b32 v119, a191
v_mfma_f32_16x16x32_bf16 v[148:151], a[84:87], v[108:111], v[148:151]
s_add_u32 m0, s18, 32768
ds_read_b128 a[116:119], v2 offset:13312
v_cvt_pk_bf16_f32 v128, v128, v129
v_mfma_f32_16x16x32_bf16 v[148:151], a[80:83], v[104:107], v[148:151]
buffer_load_dwordx4 v112, s[36:39], s81 offen offset:0 lds
v_mfma_f32_16x16x32_bf16 v[152:155], a[88:91], v[96:99], v[152:155]
s_waitcnt lgkmcnt(4)
ds_read_b128 a[120:123], v2 offset:14336
v_cvt_pk_bf16_f32 v129, v130, v131
v_mfma_f32_16x16x32_bf16 v[152:155], a[92:95], v[100:103], v[152:155]
v_exp_f32 v9, v69
v_mfma_f32_16x16x32_bf16 v[156:159], a[92:95], v[108:111], v[156:159]
ds_read_b128 a[124:127], v2 offset:15360
v_add_f32 v27, v8, v9
v_mfma_f32_16x16x32_bf16 v[156:159], a[88:91], v[104:107], v[156:159]
buffer_load_dwordx4 v113, s[36:39], s81 offen offset:1024 lds
v_mfma_f32_16x16x32_bf16 v[160:163], a[96:99], v[96:99], v[160:163]
ds_read_b128 a[64:67], v2 offset:16384
v_cvt_pk_bf16_f32 v120, v8, v9
v_mfma_f32_16x16x32_bf16 v[160:163], a[100:103], v[100:103], v[160:163]
v_exp_f32 v10, v70
v_mfma_f32_16x16x32_bf16 v[164:167], a[100:103], v[108:111], v[164:167]
ds_read_b128 a[68:71], v2 offset:17408
v_add_f32 v27, v27, v10
v_mfma_f32_16x16x32_bf16 v[164:167], a[96:99], v[104:107], v[164:167]
s_waitcnt lgkmcnt(4)
buffer_load_dwordx4 v114, s[36:39], s81 offen offset:2048 lds
v_mfma_f32_16x16x32_bf16 v[168:171], a[104:107], v[96:99], v[168:171]
ds_read_b128 a[72:75], v2 offset:18432
v_cvt_pk_bf16_f32 v130, v136, v137
v_mfma_f32_16x16x32_bf16 v[168:171], a[108:111], v[100:103], v[168:171]
v_exp_f32 v11, v71
v_mfma_f32_16x16x32_bf16 v[172:175], a[108:111], v[108:111], v[172:175]
ds_read_b128 a[76:79], v2 offset:19456
v_add_f32 v27, v27, v11
v_mfma_f32_16x16x32_bf16 v[172:175], a[104:107], v[104:107], v[172:175]
buffer_load_dwordx4 v115, s[36:39], s81 offen offset:3072 lds
v_mfma_f32_16x16x32_bf16 v[176:179], a[112:115], v[96:99], v[176:179]
ds_read_b128 a[80:83], v2 offset:20480
v_cvt_pk_bf16_f32 v121, v10, v11
v_mfma_f32_16x16x32_bf16 v[176:179], a[116:119], v[100:103], v[176:179]
s_waitcnt lgkmcnt(4)
v_exp_f32 v12, v76
v_mfma_f32_16x16x32_bf16 v[180:183], a[116:119], v[108:111], v[180:183]
s_add_u32 s81, s81, 28672
ds_read_b128 a[84:87], v2 offset:21504
v_add_f32 v27, v27, v12
v_mfma_f32_16x16x32_bf16 v[180:183], a[112:115], v[104:107], v[180:183]
s_add_u32 m0, s18, 36864
v_exp_f32 v13, v77
v_mfma_f32_16x16x32_bf16 v[184:187], a[120:123], v[96:99], v[184:187]
ds_read_b128 a[88:91], v2 offset:22528
v_add_f32 v27, v27, v13
v_mfma_f32_16x16x32_bf16 v[184:187], a[124:127], v[100:103], v[184:187]
buffer_load_dwordx4 v112, s[36:39], s81 offen offset:0 lds
v_mfma_f32_16x16x32_bf16 v[188:191], a[124:127], v[108:111], v[188:191]
ds_read_b128 a[92:95], v2 offset:23552
v_cvt_pk_bf16_f32 v122, v12, v13
v_mfma_f32_16x16x32_bf16 v[188:191], a[120:123], v[104:107], v[188:191]
v_exp_f32 v14, v78
v_mfma_f32_16x16x32_bf16 v[192:195], a[64:67], v[96:99], v[192:195]
s_waitcnt lgkmcnt(4)
ds_read_b128 a[96:99], v2 offset:24576
v_add_f32 v27, v27, v14
v_mfma_f32_16x16x32_bf16 v[192:195], a[68:71], v[100:103], v[192:195]
buffer_load_dwordx4 v113, s[36:39], s81 offen offset:1024 lds
v_mfma_f32_16x16x32_bf16 v[196:199], a[68:71], v[108:111], v[196:199]
ds_read_b128 a[100:103], v2 offset:25600
v_cvt_pk_bf16_f32 v131, v138, v139
v_mfma_f32_16x16x32_bf16 v[196:199], a[64:67], v[104:107], v[196:199]
v_exp_f32 v15, v79
v_mfma_f32_16x16x32_bf16 v[200:203], a[72:75], v[96:99], v[200:203]
ds_read_b128 a[104:107], v2 offset:26624
v_add_f32 v27, v27, v15
v_mfma_f32_16x16x32_bf16 v[200:203], a[76:79], v[100:103], v[200:203]
buffer_load_dwordx4 v114, s[36:39], s81 offen offset:2048 lds
v_mfma_f32_16x16x32_bf16 v[204:207], a[76:79], v[108:111], v[204:207]
ds_read_b128 a[108:111], v2 offset:27648
v_cvt_pk_bf16_f32 v123, v14, v15
v_mfma_f32_16x16x32_bf16 v[204:207], a[72:75], v[104:107], v[204:207]
s_waitcnt lgkmcnt(4)
v_exp_f32 v8, v84
v_mfma_f32_16x16x32_bf16 v[208:211], a[80:83], v[96:99], v[208:211]
ds_read_b128 a[112:115], v2 offset:28672
v_add_f32 v27, v27, v8
v_mfma_f32_16x16x32_bf16 v[208:211], a[84:87], v[100:103], v[208:211]
buffer_load_dwordx4 v115, s[36:39], s81 offen offset:3072 lds
v_mfma_f32_16x16x32_bf16 v[212:215], a[84:87], v[108:111], v[212:215]
ds_read_b128 a[116:119], v2 offset:29696
v_cvt_pk_bf16_f32 v144, v144, v145
v_mfma_f32_16x16x32_bf16 v[212:215], a[80:83], v[104:107], v[212:215]
v_exp_f32 v9, v85
v_mfma_f32_16x16x32_bf16 v[216:219], a[88:91], v[96:99], v[216:219]
s_sub_u32 s81, s81, 28544
ds_read_b128 a[120:123], v2 offset:30720
v_add_f32 v27, v27, v9
v_mfma_f32_16x16x32_bf16 v[216:219], a[92:95], v[100:103], v[216:219]
v_exp_f32 v10, v86
v_mfma_f32_16x16x32_bf16 v[220:223], a[92:95], v[108:111], v[220:223]
s_waitcnt vmcnt(8) lgkmcnt(4)
ds_read_b128 a[124:127], v2 offset:31744
v_cvt_pk_bf16_f32 v124, v8, v9
v_mfma_f32_16x16x32_bf16 v[220:223], a[88:91], v[104:107], v[220:223]
s_barrier
v_mfma_f32_16x16x32_bf16 v[224:227], a[96:99], v[96:99], v[224:227]
ds_read_b128 a[64:67], v1 offset:0
v_add_f32 v27, v27, v10
v_mfma_f32_16x16x32_bf16 v[224:227], a[100:103], v[100:103], v[224:227]
v_exp_f32 v11, v87
v_mfma_f32_16x16x32_bf16 v[228:231], a[100:103], v[108:111], v[228:231]
ds_read_b128 a[68:71], v1 offset:1024
v_add_f32 v27, v27, v11
v_mfma_f32_16x16x32_bf16 v[228:231], a[96:99], v[104:107], v[228:231]
v_exp_f32 v12, v92
v_mfma_f32_16x16x32_bf16 v[232:235], a[104:107], v[96:99], v[232:235]
s_waitcnt lgkmcnt(4)
ds_read_b128 a[72:75], v1 offset:2048
v_cvt_pk_bf16_f32 v125, v10, v11
v_mfma_f32_16x16x32_bf16 v[232:235], a[108:111], v[100:103], v[232:235]
v_exp_f32 v13, v93
v_mfma_f32_16x16x32_bf16 v[236:239], a[108:111], v[108:111], v[236:239]
ds_read_b128 a[76:79], v1 offset:3072
v_add_f32 v27, v27, v12
v_mfma_f32_16x16x32_bf16 v[236:239], a[104:107], v[104:107], v[236:239]
v_exp_f32 v14, v94
v_mfma_f32_16x16x32_bf16 v[240:243], a[112:115], v[96:99], v[240:243]
ds_read_b128 a[80:83], v1 offset:4096
v_add_f32 v27, v27, v13
v_mfma_f32_16x16x32_bf16 v[240:243], a[116:119], v[100:103], v[240:243]
v_exp_f32 v15, v95
v_mfma_f32_16x16x32_bf16 v[244:247], a[116:119], v[108:111], v[244:247]
ds_read_b128 a[84:87], v1 offset:5120
v_cvt_pk_bf16_f32 v126, v12, v13
v_mfma_f32_16x16x32_bf16 v[244:247], a[112:115], v[104:107], v[244:247]
s_waitcnt lgkmcnt(4)
v_add_f32 v27, v27, v14
v_add_f32 v27, v27, v15
v_mfma_f32_16x16x32_bf16 v[248:251], a[120:123], v[96:99], v[248:251]
ds_read_b128 a[88:91], v1 offset:6144
v_cvt_pk_bf16_f32 v127, v14, v15
v_mfma_f32_16x16x32_bf16 v[248:251], a[124:127], v[100:103], v[248:251]
v_cmp_nge_f32 vcc, s25, v27
v_cvt_pk_bf16_f32 v145, v146, v147
v_mfma_f32_16x16x32_bf16 v[252:255], a[124:127], v[108:111], v[252:255]
ds_read_b128 a[92:95], v1 offset:7168
v_cvt_pk_bf16_f32 v146, v152, v153
v_mfma_f32_16x16x32_bf16 v[252:255], a[120:123], v[104:107], v[252:255]
s_waitcnt lgkmcnt(2)
v_cvt_pk_bf16_f32 v147, v154, v155
v_cvt_pk_bf16_f32 v160, v160, v161
s_cbranch_vccnz Lstub_12
Lback_13:
v_mfma_f32_16x16x32_bf16 v[132:135], a[64:67], v[120:123], v[132:135]
s_lshl_b32 s8, s29, 3
ds_read_b128 a[96:99], v1 offset:8192
v_add_f32 v25, v25, v27
v_mfma_f32_16x16x32_bf16 v[132:135], a[68:71], v[124:127], v[132:135]
s_add_u32 s8, s8, s3
ds_read_b128 a[100:103], v1 offset:9216
v_cvt_pk_bf16_f32 v161, v162, v163
v_mfma_f32_16x16x32_bf16 v[140:143], a[72:75], v[120:123], v[140:143]
s_lshl_b32 s8, s8, 4
ds_read_b128 a[104:107], v1 offset:10240
v_cvt_pk_bf16_f32 v162, v168, v169
v_mfma_f32_16x16x32_bf16 v[140:143], a[76:79], v[124:127], v[140:143]
s_add_u32 s8, s8, s20
ds_read_b128 a[108:111], v1 offset:11264
v_cvt_pk_bf16_f32 v163, v170, v171
v_mfma_f32_16x16x32_bf16 v[148:151], a[80:83], v[120:123], v[148:151]
s_mul_i32 s8, s8, 14336
ds_read_b128 a[112:115], v1 offset:12288
v_cvt_pk_bf16_f32 v176, v176, v177
v_mfma_f32_16x16x32_bf16 v[148:151], a[84:87], v[124:127], v[148:151]
s_waitcnt lgkmcnt(5)
s_add_u32 s8, s8, 104857600
ds_read_b128 a[116:119], v1 offset:13312
v_cvt_pk_bf16_f32 v177, v178, v179
v_mfma_f32_16x16x32_bf16 v[156:159], a[88:91], v[120:123], v[156:159]
s_add_u32 s12, s8, 917504
ds_read_b128 a[120:123], v1 offset:14336
v_cvt_pk_bf16_f32 v178, v184, v185
v_mfma_f32_16x16x32_bf16 v[156:159], a[92:95], v[124:127], v[156:159]
s_waitcnt lgkmcnt(6)
ds_read_b128 a[124:127], v1 offset:15360
v_cvt_pk_bf16_f32 v179, v186, v187
v_mfma_f32_16x16x32_bf16 v[164:167], a[96:99], v[120:123], v[164:167]
s_waitcnt lgkmcnt(6)
ds_read_b128 a[64:67], v1 offset:16384
v_cvt_pk_bf16_f32 v192, v192, v193
v_mfma_f32_16x16x32_bf16 v[164:167], a[100:103], v[124:127], v[164:167]
s_waitcnt lgkmcnt(6)
ds_read_b128 a[68:71], v1 offset:17408
v_cvt_pk_bf16_f32 v193, v194, v195
v_mfma_f32_16x16x32_bf16 v[172:175], a[104:107], v[120:123], v[172:175]
s_waitcnt lgkmcnt(6)
ds_read_b128 a[72:75], v1 offset:18432
v_cvt_pk_bf16_f32 v194, v200, v201
v_mfma_f32_16x16x32_bf16 v[172:175], a[108:111], v[124:127], v[172:175]
s_waitcnt lgkmcnt(6)
ds_read_b128 a[76:79], v1 offset:19456
v_cvt_pk_bf16_f32 v195, v202, v203
v_mfma_f32_16x16x32_bf16 v[180:183], a[112:115], v[120:123], v[180:183]
s_waitcnt lgkmcnt(6)
ds_read_b128 a[80:83], v1 offset:20480
v_cvt_pk_bf16_f32 v208, v208, v209
v_mfma_f32_16x16x32_bf16 v[180:183], a[116:119], v[124:127], v[180:183]
s_waitcnt lgkmcnt(6)
ds_read_b128 a[84:87], v1 offset:21504
v_cvt_pk_bf16_f32 v209, v210, v211
v_mfma_f32_16x16x32_bf16 v[188:191], a[120:123], v[120:123], v[188:191]
s_waitcnt lgkmcnt(6)
ds_read_b128 a[88:91], v1 offset:22528
v_cvt_pk_bf16_f32 v210, v216, v217
v_mfma_f32_16x16x32_bf16 v[188:191], a[124:127], v[124:127], v[188:191]
s_waitcnt lgkmcnt(6)
ds_read_b128 a[92:95], v1 offset:23552
v_cvt_pk_bf16_f32 v211, v218, v219
v_mfma_f32_16x16x32_bf16 v[196:199], a[64:67], v[120:123], v[196:199]
s_waitcnt lgkmcnt(6)
ds_read_b128 a[96:99], v1 offset:24576
v_cvt_pk_bf16_f32 v224, v224, v225
v_mfma_f32_16x16x32_bf16 v[196:199], a[68:71], v[124:127], v[196:199]
s_waitcnt lgkmcnt(6)
ds_read_b128 a[100:103], v1 offset:25600
v_cvt_pk_bf16_f32 v225, v226, v227
v_mfma_f32_16x16x32_bf16 v[204:207], a[72:75], v[120:123], v[204:207]
s_waitcnt lgkmcnt(6)
ds_read_b128 a[104:107], v1 offset:26624
v_cvt_pk_bf16_f32 v226, v232, v233
v_mfma_f32_16x16x32_bf16 v[204:207], a[76:79], v[124:127], v[204:207]
s_waitcnt lgkmcnt(6)
ds_read_b128 a[108:111], v1 offset:27648
v_cvt_pk_bf16_f32 v227, v234, v235
v_mfma_f32_16x16x32_bf16 v[212:215], a[80:83], v[120:123], v[212:215]
s_waitcnt lgkmcnt(6)
ds_read_b128 a[112:115], v1 offset:28672
v_cvt_pk_bf16_f32 v240, v240, v241
v_mfma_f32_16x16x32_bf16 v[212:215], a[84:87], v[124:127], v[212:215]
s_waitcnt lgkmcnt(5)
ds_read_b128 a[116:119], v1 offset:29696
v_cvt_pk_bf16_f32 v241, v242, v243
v_mfma_f32_16x16x32_bf16 v[220:223], a[88:91], v[120:123], v[220:223]
s_add_u32 m0, s18, 98304
ds_read_b128 a[120:123], v1 offset:30720
v_cvt_pk_bf16_f32 v242, v248, v249
v_mfma_f32_16x16x32_bf16 v[220:223], a[92:95], v[124:127], v[220:223]
s_waitcnt lgkmcnt(6)
ds_read_b128 a[124:127], v1 offset:31744
v_cvt_pk_bf16_f32 v243, v250, v251
v_mfma_f32_16x16x32_bf16 v[228:231], a[96:99], v[120:123], v[228:231]
s_waitcnt lgkmcnt(6)
buffer_load_dwordx4 v112, s[36:39], s81 offen offset:0 lds
v_mfma_f32_16x16x32_bf16 v[228:231], a[100:103], v[124:127], v[228:231]
s_waitcnt lgkmcnt(5)
buffer_load_dwordx4 v113, s[36:39], s81 offen offset:1024 lds
v_mfma_f32_16x16x32_bf16 v[236:239], a[104:107], v[120:123], v[236:239]
s_waitcnt lgkmcnt(4)
buffer_load_dwordx4 v114, s[36:39], s81 offen offset:2048 lds
v_mfma_f32_16x16x32_bf16 v[236:239], a[108:111], v[124:127], v[236:239]
s_waitcnt lgkmcnt(1)
buffer_load_dwordx4 v115, s[36:39], s81 offen offset:3072 lds
v_mfma_f32_16x16x32_bf16 v[244:247], a[112:115], v[120:123], v[244:247]
s_add_u32 s81, s81, 28672
v_cvt_pk_bf16_f32 v132, v132, v133
v_cvt_pk_bf16_f32 v133, v134, v135
v_mfma_f32_16x16x32_bf16 v[244:247], a[116:119], v[124:127], v[244:247]
s_add_u32 m0, s18, 102400
v_cvt_pk_bf16_f32 v134, v140, v141
v_cvt_pk_bf16_f32 v135, v142, v143
v_mfma_f32_16x16x32_bf16 v[252:255], a[120:123], v[120:123], v[252:255]
s_waitcnt lgkmcnt(0)
buffer_load_dwordx4 v112, s[36:39], s81 offen offset:0 lds
v_mfma_f32_16x16x32_bf16 v[252:255], a[124:127], v[124:127], v[252:255]
buffer_load_dwordx4 v113, s[36:39], s81 offen offset:1024 lds
buffer_load_dwordx4 v114, s[36:39], s81 offen offset:2048 lds
buffer_load_dwordx4 v115, s[36:39], s81 offen offset:3072 lds
s_sub_u32 s81, s81, 28544
s_add_u32 m0, s18, 131072
s_nop 0
buffer_load_dwordx4 v112, s[36:39], s81 offen offset:0 lds
v_cvt_pk_bf16_f32 v148, v148, v149
v_cvt_pk_bf16_f32 v149, v150, v151
v_cvt_pk_bf16_f32 v150, v156, v157
v_cvt_pk_bf16_f32 v151, v158, v159
buffer_load_dwordx4 v113, s[36:39], s81 offen offset:1024 lds
v_cvt_pk_bf16_f32 v164, v164, v165
v_cvt_pk_bf16_f32 v165, v166, v167
v_cvt_pk_bf16_f32 v166, v172, v173
v_cvt_pk_bf16_f32 v167, v174, v175
buffer_load_dwordx4 v114, s[36:39], s81 offen offset:2048 lds
v_cvt_pk_bf16_f32 v180, v180, v181
v_cvt_pk_bf16_f32 v181, v182, v183
v_cvt_pk_bf16_f32 v182, v188, v189
v_cvt_pk_bf16_f32 v183, v190, v191
buffer_load_dwordx4 v115, s[36:39], s81 offen offset:3072 lds
v_cvt_pk_bf16_f32 v196, v196, v197
v_cvt_pk_bf16_f32 v197, v198, v199
v_cvt_pk_bf16_f32 v198, v204, v205
v_cvt_pk_bf16_f32 v199, v206, v207
s_add_u32 s81, s81, 28672
s_add_u32 m0, s18, 135168
s_nop 0
buffer_load_dwordx4 v112, s[36:39], s81 offen offset:0 lds
v_cvt_pk_bf16_f32 v212, v212, v213
v_cvt_pk_bf16_f32 v213, v214, v215
v_cvt_pk_bf16_f32 v214, v220, v221
v_cvt_pk_bf16_f32 v215, v222, v223
buffer_load_dwordx4 v113, s[36:39], s81 offen offset:1024 lds
v_cvt_pk_bf16_f32 v228, v228, v229
v_cvt_pk_bf16_f32 v229, v230, v231
v_cvt_pk_bf16_f32 v230, v236, v237
v_cvt_pk_bf16_f32 v231, v238, v239
buffer_load_dwordx4 v114, s[36:39], s81 offen offset:2048 lds
v_cvt_pk_bf16_f32 v244, v244, v245
v_cvt_pk_bf16_f32 v245, v246, v247
v_cvt_pk_bf16_f32 v246, v252, v253
v_cvt_pk_bf16_f32 v247, v254, v255
buffer_load_dwordx4 v115, s[36:39], s81 offen offset:3072 lds
s_sub_u32 s81, s81, 28544
s_branch K2_done
K2_cfix:
s_nop 7
v_max_f32 v12, 0, v8
v_exp_f32 v13, -v12
v_sub_f32 v8, v8, v12
v_mul_f32 v24, v24, v13
v_mul_f32 v128, v128, v13
v_mul_f32 v129, v129, v13
v_mul_f32 v130, v130, v13
v_mul_f32 v131, v131, v13
v_mul_f32 v136, v136, v13
v_mul_f32 v137, v137, v13
v_mul_f32 v138, v138, v13
v_mul_f32 v139, v139, v13
v_mul_f32 v144, v144, v13
v_mul_f32 v145, v145, v13
v_mul_f32 v146, v146, v13
v_mul_f32 v147, v147, v13
v_mul_f32 v152, v152, v13
v_mul_f32 v153, v153, v13
v_mul_f32 v154, v154, v13
v_mul_f32 v155, v155, v13
v_mul_f32 v160, v160, v13
v_mul_f32 v161, v161, v13
v_mul_f32 v162, v162, v13
v_mul_f32 v163, v163, v13
v_mul_f32 v168, v168, v13
v_mul_f32 v169, v169, v13
v_mul_f32 v170, v170, v13
v_mul_f32 v171, v171, v13
v_mul_f32 v176, v176, v13
v_mul_f32 v177, v177, v13
v_mul_f32 v178, v178, v13
v_mul_f32 v179, v179, v13
v_mul_f32 v184, v184, v13
v_mul_f32 v185, v185, v13
v_mul_f32 v186, v186, v13
v_mul_f32 v187, v187, v13
v_mul_f32 v192, v192, v13
v_mul_f32 v193, v193, v13
v_mul_f32 v194, v194, v13
v_mul_f32 v195, v195, v13
v_mul_f32 v200, v200, v13
v_mul_f32 v201, v201, v13
v_mul_f32 v202, v202, v13
v_mul_f32 v203, v203, v13
v_mul_f32 v208, v208, v13
v_mul_f32 v209, v209, v13
v_mul_f32 v210, v210, v13
v_mul_f32 v211, v211, v13
v_mul_f32 v216, v216, v13
v_mul_f32 v217, v217, v13
v_mul_f32 v218, v218, v13
v_mul_f32 v219, v219, v13
v_mul_f32 v224, v224, v13
v_mul_f32 v225, v225, v13
v_mul_f32 v226, v226, v13
v_mul_f32 v227, v227, v13
v_mul_f32 v232, v232, v13
v_mul_f32 v233, v233, v13
v_mul_f32 v234, v234, v13
v_mul_f32 v235, v235, v13
v_mul_f32 v240, v240, v13
v_mul_f32 v241, v241, v13
v_mul_f32 v242, v242, v13
v_mul_f32 v243, v243, v13
v_mul_f32 v248, v248, v13
v_mul_f32 v249, v249, v13
v_mul_f32 v250, v250, v13
v_mul_f32 v251, v251, v13
v_max_f32 v12, 0, v10
v_exp_f32 v13, -v12
v_sub_f32 v10, v10, v12
v_mul_f32 v25, v25, v13
v_mul_f32 v132, v132, v13
v_mul_f32 v133, v133, v13
v_mul_f32 v134, v134, v13
v_mul_f32 v135, v135, v13
v_mul_f32 v140, v140, v13
v_mul_f32 v141, v141, v13
v_mul_f32 v142, v142, v13
v_mul_f32 v143, v143, v13
v_mul_f32 v148, v148, v13
v_mul_f32 v149, v149, v13
v_mul_f32 v150, v150, v13
v_mul_f32 v151, v151, v13
v_mul_f32 v156, v156, v13
v_mul_f32 v157, v157, v13
v_mul_f32 v158, v158, v13
v_mul_f32 v159, v159, v13
v_mul_f32 v164, v164, v13
v_mul_f32 v165, v165, v13
v_mul_f32 v166, v166, v13
v_mul_f32 v167, v167, v13
v_mul_f32 v172, v172, v13
v_mul_f32 v173, v173, v13
v_mul_f32 v174, v174, v13
v_mul_f32 v175, v175, v13
v_mul_f32 v180, v180, v13
v_mul_f32 v181, v181, v13
v_mul_f32 v182, v182, v13
v_mul_f32 v183, v183, v13
v_mul_f32 v188, v188, v13
v_mul_f32 v189, v189, v13
v_mul_f32 v190, v190, v13
v_mul_f32 v191, v191, v13
v_mul_f32 v196, v196, v13
v_mul_f32 v197, v197, v13
v_mul_f32 v198, v198, v13
v_mul_f32 v199, v199, v13
v_mul_f32 v204, v204, v13
v_mul_f32 v205, v205, v13
v_mul_f32 v206, v206, v13
v_mul_f32 v207, v207, v13
v_mul_f32 v212, v212, v13
v_mul_f32 v213, v213, v13
v_mul_f32 v214, v214, v13
v_mul_f32 v215, v215, v13
v_mul_f32 v220, v220, v13
v_mul_f32 v221, v221, v13
v_mul_f32 v222, v222, v13
v_mul_f32 v223, v223, v13
v_mul_f32 v228, v228, v13
v_mul_f32 v229, v229, v13
v_mul_f32 v230, v230, v13
v_mul_f32 v231, v231, v13
v_mul_f32 v236, v236, v13
v_mul_f32 v237, v237, v13
v_mul_f32 v238, v238, v13
v_mul_f32 v239, v239, v13
v_mul_f32 v244, v244, v13
v_mul_f32 v245, v245, v13
v_mul_f32 v246, v246, v13
v_mul_f32 v247, v247, v13
v_mul_f32 v252, v252, v13
v_mul_f32 v253, v253, v13
v_mul_f32 v254, v254, v13
v_mul_f32 v255, v255, v13
s_branch K2_cok
K2_tspin:
Lp_9101:
buffer_load_dword v3, off, s[4:7], s80 sc1
s_waitcnt vmcnt(0)
v_cmp_gt_u32 vcc, 1, v3
s_cbranch_vccz Lpd_9102
s_sleep 8
s_sub_u32 s101, s101, 1
s_cbranch_scc0 Lp_9101
s_mov_b32 s101, 0
Lpd_9102:
s_branch K2_tok
K2_p0d:
ds_read_b128 a[64:67], v1 offset:0
ds_read_b128 a[68:71], v1 offset:1024
ds_read_b128 a[72:75], v1 offset:2048
ds_read_b128 a[76:79], v1 offset:3072
ds_read_b128 a[80:83], v1 offset:4096
ds_read_b128 a[84:87], v1 offset:5120
ds_read_b128 a[88:91], v1 offset:6144
ds_read_b128 a[92:95], v1 offset:7168
v_cndmask_b32 v32, 0, v7, s[32:33]
v_cndmask_b32 v33, 0, v7, s[34:35]
v_cndmask_b32 v34, 0, v7, s[36:37]
v_cndmask_b32 v35, 0, v7, s[38:39]
v_cndmask_b32 v40, 0, v7, s[40:41]
v_cndmask_b32 v41, 0, v7, s[42:43]
v_cndmask_b32 v42, 0, v7, s[44:45]
v_cndmask_b32 v43, 0, v7, s[46:47]
s_waitcnt lgkmcnt(7)
v_mfma_f32_16x16x32_bf16 v[32:35], a[64:67], a[0:3], v[32:35]
s_waitcnt lgkmcnt(6)
s_add_u32 m0, s18, 65536
ds_read_b128 a[96:99], v1 offset:8192
v_mfma_f32_16x16x32_bf16 v[32:35], a[68:71], a[4:7], v[32:35]
s_waitcnt lgkmcnt(6)
buffer_load_dwordx4 v1, s[4:7], s12 offen offset:0 sc1 lds
v_mfma_f32_16x16x32_bf16 v[32:35], a[72:75], a[8:11], v[32:35]
s_waitcnt lgkmcnt(5)
ds_read_b128 a[100:103], v1 offset:9216
v_mfma_f32_16x16x32_bf16 v[32:35], a[76:79], a[12:15], v[32:35]
s_waitcnt lgkmcnt(5)
buffer_load_dwordx4 v1, s[4:7], s12 offen offset:1024 sc1 lds
v_mfma_f32_16x16x32_bf16 v[32:35], a[80:83], a[16:19], v[32:35]
s_waitcnt lgkmcnt(4)
ds_read_b128 a[104:107], v1 offset:10240
v_mfma_f32_16x16x32_bf16 v[32:35], a[84:87], a[20:23], v[32:35]
s_waitcnt lgkmcnt(4)
buffer_load_dwordx4 v1, s[4:7], s12 offen offset:2048 sc1 lds
v_mfma_f32_16x16x32_bf16 v[32:35], a[88:91], a[24:27], v[32:35]
s_waitcnt lgkmcnt(3)
ds_read_b128 a[108:111], v1 offset:11264
v_mfma_f32_16x16x32_bf16 v[32:35], a[92:95], a[28:31], v[32:35]
buffer_load_dwordx4 v1, s[4:7], s12 offen offset:3072 sc1 lds
v_mfma_f32_16x16x32_bf16 v[36:39], a[64:67], a[32:35], 0
s_add_u32 s12, s12, 4096
s_add_u32 m0, s18, 69632
ds_read_b128 a[112:115], v1 offset:12288
v_mfma_f32_16x16x32_bf16 v[36:39], a[68:71], a[36:39], v[36:39]
buffer_load_dwordx4 v1, s[4:7], s12 offen offset:0 sc1 lds
v_mfma_f32_16x16x32_bf16 v[36:39], a[72:75], a[40:43], v[36:39]
ds_read_b128 a[116:119], v1 offset:13312
v_mfma_f32_16x16x32_bf16 v[36:39], a[76:79], a[44:47], v[36:39]
buffer_load_dwordx4 v1, s[4:7], s12 offen offset:1024 sc1 lds
v_mfma_f32_16x16x32_bf16 v[36:39], a[80:83], a[48:51], v[36:39]
ds_read_b128 a[120:123], v1 offset:14336
v_max3_f32 v28, v32, v33, v34
v_mfma_f32_16x16x32_bf16 v[36:39], a[84:87], a[52:55], v[36:39]
buffer_load_dwordx4 v1, s[4:7], s12 offen offset:2048 sc1 lds
v_mfma_f32_16x16x32_bf16 v[36:39], a[88:91], a[56:59], v[36:39]
ds_read_b128 a[124:127], v1 offset:15360
v_max_f32 v28, v28, v35
v_mfma_f32_16x16x32_bf16 v[36:39], a[92:95], a[60:63], v[36:39]
s_waitcnt lgkmcnt(4)
buffer_load_dwordx4 v1, s[4:7], s12 offen offset:3072 sc1 lds
v_mfma_f32_16x16x32_bf16 v[40:43], a[96:99], a[0:3], v[40:43]
s_add_u32 s12, s12, 28672
ds_read_b128 a[64:67], v1 offset:16384
v_mov_b32 v30, v28
v_mfma_f32_16x16x32_bf16 v[40:43], a[100:103], a[4:7], v[40:43]
s_waitcnt lgkmcnt(2)
s_sub_u32 s13, s13, 1
v_mfma_f32_16x16x32_bf16 v[40:43], a[104:107], a[8:11], v[40:43]
s_cmp_eq_u32 s13, 0
ds_read_b128 a[68:71], v1 offset:17408
v_permlane16_swap_b32 v28, v30
v_mfma_f32_16x16x32_bf16 v[40:43], a[108:111], a[12:15], v[40:43]
s_cselect_b32 s12, s14, s12
v_max_f32 v28, v28, v30
v_mov_b32 v30, v28
v_mfma_f32_16x16x32_bf16 v[40:43], a[112:115], a[16:19], v[40:43]
s_cselect_b32 s13, s15, s13
ds_read_b128 a[72:75], v1 offset:18432
v_max3_f32 v29, v36, v37, v38
v_mfma_f32_16x16x32_bf16 v[40:43], a[116:119], a[20:23], v[40:43]
s_cselect_b32 s14, 3221225472, s14
v_permlane32_swap_b32 v28, v30
v_max_f32 v28, v28, v30
v_mfma_f32_16x16x32_bf16 v[40:43], a[120:123], a[24:27], v[40:43]
s_waitcnt lgkmcnt(3)
ds_read_b128 a[76:79], v1 offset:19456
v_sub_f32 v16, 0, v28
v_mfma_f32_16x16x32_bf16 v[40:43], a[124:127], a[28:31], v[40:43]
v_sub_f32 v17, 0, v28
v_sub_f32 v18, 0, v28
v_mfma_f32_16x16x32_bf16 v[44:47], a[96:99], a[32:35], 0
ds_read_b128 a[80:83], v1 offset:20480
v_sub_f32 v19, 0, v28
v_mfma_f32_16x16x32_bf16 v[44:47], a[100:103], a[36:39], v[44:47]
v_max_f32 v29, v29, v39
v_mov_b32 v31, v29
v_cndmask_b32 v48, v16, v7, s[48:49]
v_mfma_f32_16x16x32_bf16 v[44:47], a[104:107], a[40:43], v[44:47]
ds_read_b128 a[84:87], v1 offset:21504
v_cndmask_b32 v49, v16, v7, s[50:51]
v_mfma_f32_16x16x32_bf16 v[44:47], a[108:111], a[44:47], v[44:47]
v_permlane16_swap_b32 v29, v31
v_max_f32 v29, v29, v31
v_cndmask_b32 v50, v16, v7, s[52:53]
v_mfma_f32_16x16x32_bf16 v[44:47], a[112:115], a[48:51], v[44:47]
ds_read_b128 a[88:91], v1 offset:22528
v_mov_b32 v31, v29
v_cndmask_b32 v51, v16, v7, s[54:55]
v_mfma_f32_16x16x32_bf16 v[44:47], a[116:119], a[52:55], v[44:47]
v_cndmask_b32 v56, v16, v7, s[56:57]
v_cndmask_b32 v57, v16, v7, s[58:59]
v_mfma_f32_16x16x32_bf16 v[44:47], a[120:123], a[56:59], v[44:47]
ds_read_b128 a[92:95], v1 offset:23552
v_permlane32_swap_b32 v29, v31
v_mfma_f32_16x16x32_bf16 v[44:47], a[124:127], a[60:63], v[44:47]
s_waitcnt lgkmcnt(4)
v_max_f32 v29, v29, v31
v_sub_f32 v20, 0, v29
v_mfma_f32_16x16x32_bf16 v[48:51], a[64:67], a[0:3], v[48:51]
ds_read_b128 a[96:99], v1 offset:24576
v_sub_f32 v21, 0, v29
v_mfma_f32_16x16x32_bf16 v[48:51], a[68:71], a[4:7], v[48:51]
v_sub_f32 v22, 0, v29
v_sub_f32 v23, 0, v29
v_mfma_f32_16x16x32_bf16 v[48:51], a[72:75], a[8:11], v[48:51]
ds_read_b128 a[100:103], v1 offset:25600
v_cndmask_b32 v58, v16, v7, s[60:61]
v_mfma_f32_16x16x32_bf16 v[48:51], a[76:79], a[12:15], v[48:51]
s_waitcnt lgkmcnt(4)
v_cndmask_b32 v59, v16, v7, s[62:63]
v_mfma_f32_16x16x32_bf16 v[48:51], a[80:83], a[16:19], v[48:51]
ds_read_b128 a[104:107], v1 offset:26624
v_mfma_f32_16x16x32_bf16 v[48:51], a[84:87], a[20:23], v[48:51]
s_waitcnt lgkmcnt(4)
v_add_f32 v32, v32, v16
v_add_f32 v33, v33, v16
v_add_f32 v34, v34, v16
v_add_f32 v35, v35, v16
v_mfma_f32_16x16x32_bf16 v[48:51], a[88:91], a[24:27], v[48:51]
s_waitcnt lgkmcnt(3)
ds_read_b128 a[108:111], v1 offset:27648
v_add_f32 v36, v36, v20
v_add_f32 v37, v37, v20
v_add_f32 v38, v38, v20
v_add_f32 v39, v39, v20
v_mfma_f32_16x16x32_bf16 v[48:51], a[92:95], a[28:31], v[48:51]
v_add_f32 v40, v40, v16
v_add_f32 v41, v41, v16
v_add_f32 v42, v42, v16
v_add_f32 v43, v43, v16
v_mfma_f32_16x16x32_bf16 v[52:55], a[64:67], a[32:35], v[20:23]
ds_read_b128 a[112:115], v1 offset:28672
v_add_f32 v44, v44, v20
v_add_f32 v45, v45, v20
v_add_f32 v46, v46, v20
v_add_f32 v47, v47, v20
v_mfma_f32_16x16x32_bf16 v[52:55], a[68:71], a[36:39], v[52:55]
v_exp_f32 v8, v32
v_mfma_f32_16x16x32_bf16 v[52:55], a[72:75], a[40:43], v[52:55]
ds_read_b128 a[116:119], v1 offset:29696
v_exp_f32 v9, v33
v_mfma_f32_16x16x32_bf16 v[52:55], a[76:79], a[44:47], v[52:55]
v_exp_f32 v10, v34
v_add_f32 v26, v8, v9
v_cvt_pk_bf16_f32 v96, v8, v9
v_mfma_f32_16x16x32_bf16 v[52:55], a[80:83], a[48:51], v[52:55]
ds_read_b128 a[120:123], v1 offset:30720
v_exp_f32 v11, v35
v_add_f32 v26, v26, v10
v_mfma_f32_16x16x32_bf16 v[52:55], a[84:87], a[52:55], v[52:55]
v_exp_f32 v12, v36
v_add_f32 v26, v26, v11
v_cvt_pk_bf16_f32 v97, v10, v11
v_mfma_f32_16x16x32_bf16 v[52:55], a[88:91], a[56:59], v[52:55]
s_waitcnt vmcnt(8) lgkmcnt(4)
ds_read_b128 a[124:127], v1 offset:31744
v_exp_f32 v13, v37
v_mfma_f32_16x16x32_bf16 v[52:55], a[92:95], a[60:63], v[52:55]
s_barrier
v_mfma_f32_16x16x32_bf16 v[56:59], a[96:99], a[0:3], v[56:59]
ds_read_b128 a[64:67], v4 offset:0
v_exp_f32 v14, v38
v_mfma_f32_16x16x32_bf16 v[56:59], a[100:103], a[4:7], v[56:59]
buffer_store_dword v6, v5, s[4:7], s71 offen sc1
v_mfma_f32_16x16x32_bf16 v[56:59], a[104:107], a[8:11], v[56:59]
s_waitcnt lgkmcnt(4)
ds_read_b128 a[68:71], v4 offset:1024
v_add_f32 v27, v12, v13
v_cvt_pk_bf16_f32 v104, v12, v13
v_add_f32 v27, v27, v14
v_mfma_f32_16x16x32_bf16 v[56:59], a[108:111], a[12:15], v[56:59]
v_exp_f32 v15, v39
v_mfma_f32_16x16x32_bf16 v[56:59], a[112:115], a[16:19], v[56:59]
s_waitcnt lgkmcnt(4)
ds_read_b128 a[72:75], v4 offset:2048
v_exp_f32 v8, v40
v_add_f32 v27, v27, v15
v_cvt_pk_bf16_f32 v105, v14, v15
v_mfma_f32_16x16x32_bf16 v[56:59], a[116:119], a[20:23], v[56:59]
s_waitcnt lgkmcnt(4)
v_exp_f32 v9, v41
v_add_f32 v26, v26, v8
v_mfma_f32_16x16x32_bf16 v[56:59], a[120:123], a[24:27], v[56:59]
s_waitcnt lgkmcnt(3)
ds_read_b128 a[76:79], v4 offset:3072
v_exp_f32 v10, v42
v_add_f32 v26, v26, v9
v_cvt_pk_bf16_f32 v98, v8, v9
v_mfma_f32_16x16x32_bf16 v[56:59], a[124:127], a[28:31], v[56:59]
v_exp_f32 v11, v43
v_add_f32 v26, v26, v10
v_mfma_f32_16x16x32_bf16 v[60:63], a[96:99], a[32:35], v[20:23]
ds_read_b128 a[80:83], v4 offset:4096
v_exp_f32 v12, v44
v_mfma_f32_16x16x32_bf16 v[60:63], a[100:103], a[36:39], v[60:63]
v_exp_f32 v13, v45
v_mfma_f32_16x16x32_bf16 v[60:63], a[104:107], a[40:43], v[60:63]
ds_read_b128 a[84:87], v4 offset:5120
v_exp_f32 v14, v46
v_mfma_f32_16x16x32_bf16 v[60:63], a[108:111], a[44:47], v[60:63]
v_exp_f32 v15, v47
v_mfma_f32_16x16x32_bf16 v[60:63], a[112:115], a[48:51], v[60:63]
ds_read_b128 a[88:91], v4 offset:6144
v_add_f32 v26, v26, v11
v_cvt_pk_bf16_f32 v99, v10, v11
v_mfma_f32_16x16x32_bf16 v[60:63], a[116:119], a[52:55], v[60:63]
v_add_f32 v27, v27, v12
v_add_f32 v27, v27, v13
v_cvt_pk_bf16_f32 v106, v12, v13
v_mfma_f32_16x16x32_bf16 v[60:63], a[120:123], a[56:59], v[60:63]
s_waitcnt lgkmcnt(7)
s_barrier
ds_read_b128 a[92:95], v4 offset:7168
v_mfma_f32_16x16x32_bf16 v[60:63], a[124:127], a[60:63], v[60:63]
s_waitcnt lgkmcnt(4)
v_add_f32 v27, v27, v14
v_add_f32 v27, v27, v15
v_cvt_pk_bf16_f32 v107, v14, v15
s_branch K2_dx1
PAD_33:
s_cbranch_execz M_tret
K2_ntail:
v_mfma_f32_16x16x32_bf16 v[128:131], a[64:67], v[96:99], v[128:131]
s_add_u32 m0, s18, 98304
ds_read_b128 a[96:99], v2 offset:8192
v_add_f32 v24, v24, v26
v_mfma_f32_16x16x32_bf16 v[128:131], a[68:71], v[100:103], v[128:131]
buffer_load_dwordx4 v1, s[4:7], s12 offen offset:0 sc1 lds
v_mfma_f32_16x16x32_bf16 v[132:135], a[68:71], v[108:111], v[132:135]
ds_read_b128 a[100:103], v2 offset:9216
v_add_f32 v25, v25, v27
v_mfma_f32_16x16x32_bf16 v[132:135], a[64:67], v[104:107], v[132:135]
buffer_load_dwordx4 v1, s[4:7], s12 offen offset:1024 sc1 lds
v_mfma_f32_16x16x32_bf16 v[136:139], a[72:75], v[96:99], v[136:139]
ds_read_b128 a[104:107], v2 offset:10240
v_exp_f32 v8, v64
v_mfma_f32_16x16x32_bf16 v[136:139], a[76:79], v[100:103], v[136:139]
buffer_load_dwordx4 v1, s[4:7], s12 offen offset:2048 sc1 lds
v_mfma_f32_16x16x32_bf16 v[140:143], a[76:79], v[108:111], v[140:143]
ds_read_b128 a[108:111], v2 offset:11264
v_mfma_f32_16x16x32_bf16 v[140:143], a[72:75], v[104:107], v[140:143]
s_waitcnt lgkmcnt(4)
buffer_load_dwordx4 v1, s[4:7], s12 offen offset:3072 sc1 lds
v_mfma_f32_16x16x32_bf16 v[144:147], a[80:83], v[96:99], v[144:147]
s_add_u32 s12, s12, 4096
s_add_u32 m0, s18, 102400
ds_read_b128 a[112:115], v2 offset:12288
v_mfma_f32_16x16x32_bf16 v[144:147], a[84:87], v[100:103], v[144:147]
buffer_load_dwordx4 v1, s[4:7], s12 offen offset:0 sc1 lds
v_mfma_f32_16x16x32_bf16 v[148:151], a[84:87], v[108:111], v[148:151]
ds_read_b128 a[116:119], v2 offset:13312
v_exp_f32 v9, v65
v_mfma_f32_16x16x32_bf16 v[148:151], a[80:83], v[104:107], v[148:151]
buffer_load_dwordx4 v1, s[4:7], s12 offen offset:1024 sc1 lds
v_mfma_f32_16x16x32_bf16 v[152:155], a[88:91], v[96:99], v[152:155]
ds_read_b128 a[120:123], v2 offset:14336
v_add_f32 v26, v8, v9
v_cvt_pk_bf16_f32 v112, v8, v9
v_mfma_f32_16x16x32_bf16 v[152:155], a[92:95], v[100:103], v[152:155]
buffer_load_dwordx4 v1, s[4:7], s12 offen offset:2048 sc1 lds
v_mfma_f32_16x16x32_bf16 v[156:159], a[92:95], v[108:111], v[156:159]
ds_read_b128 a[124:127], v2 offset:15360
v_exp_f32 v10, v66
v_mfma_f32_16x16x32_bf16 v[156:159], a[88:91], v[104:107], v[156:159]
s_waitcnt lgkmcnt(4)
buffer_load_dwordx4 v1, s[4:7], s12 offen offset:3072 sc1 lds
v_mfma_f32_16x16x32_bf16 v[160:163], a[96:99], v[96:99], v[160:163]
s_add_u32 s12, s12, 28672
ds_read_b128 a[64:67], v2 offset:16384
v_add_f32 v26, v26, v10
v_mfma_f32_16x16x32_bf16 v[160:163], a[100:103], v[100:103], v[160:163]
s_sub_u32 s13, s13, 1
v_exp_f32 v11, v67
v_mfma_f32_16x16x32_bf16 v[164:167], a[100:103], v[108:111], v[164:167]
s_cmp_eq_u32 s13, 0
ds_read_b128 a[68:71], v2 offset:17408
v_exp_f32 v12, v68
v_mfma_f32_16x16x32_bf16 v[164:167], a[96:99], v[104:107], v[164:167]
s_cselect_b32 s12, s14, s12
v_exp_f32 v13, v69
v_mfma_f32_16x16x32_bf16 v[168:171], a[104:107], v[96:99], v[168:171]
s_cselect_b32 s13, s15, s13
ds_read_b128 a[72:75], v2 offset:18432
v_add_f32 v26, v26, v11
v_cvt_pk_bf16_f32 v113, v10, v11
v_mfma_f32_16x16x32_bf16 v[168:171], a[108:111], v[100:103], v[168:171]
s_cselect_b32 s14, 3221225472, s14
v_exp_f32 v14, v70
v_mfma_f32_16x16x32_bf16 v[172:175], a[108:111], v[108:111], v[172:175]
ds_read_b128 a[76:79], v2 offset:19456
v_exp_f32 v15, v71
v_mfma_f32_16x16x32_bf16 v[172:175], a[104:107], v[104:107], v[172:175]
s_waitcnt lgkmcnt(4)
v_exp_f32 v8, v72
v_mfma_f32_16x16x32_bf16 v[176:179], a[112:115], v[96:99], v[176:179]
ds_read_b128 a[80:83], v2 offset:20480
v_add_f32 v27, v12, v13
v_cvt_pk_bf16_f32 v120, v12, v13
v_add_f32 v27, v27, v14
v_add_f32 v27, v27, v15
v_cvt_pk_bf16_f32 v121, v14, v15
v_mfma_f32_16x16x32_bf16 v[176:179], a[116:119], v[100:103], v[176:179]
v_exp_f32 v9, v73
v_mfma_f32_16x16x32_bf16 v[180:183], a[116:119], v[108:111], v[180:183]
ds_read_b128 a[84:87], v2 offset:21504
v_exp_f32 v10, v74
v_mfma_f32_16x16x32_bf16 v[180:183], a[112:115], v[104:107], v[180:183]
v_exp_f32 v11, v75
v_mfma_f32_16x16x32_bf16 v[184:187], a[120:123], v[96:99], v[184:187]
ds_read_b128 a[88:91], v2 offset:22528
v_add_f32 v26, v26, v8
v_mfma_f32_16x16x32_bf16 v[184:187], a[124:127], v[100:103], v[184:187]
v_exp_f32 v12, v76
v_mfma_f32_16x16x32_bf16 v[188:191], a[124:127], v[108:111], v[188:191]
ds_read_b128 a[92:95], v2 offset:23552
v_add_f32 v26, v26, v9
v_cvt_pk_bf16_f32 v114, v8, v9
v_add_f32 v26, v26, v10
v_add_f32 v26, v26, v11
v_cvt_pk_bf16_f32 v115, v10, v11
v_mfma_f32_16x16x32_bf16 v[188:191], a[120:123], v[104:107], v[188:191]
s_waitcnt lgkmcnt(4)
v_exp_f32 v13, v77
v_mfma_f32_16x16x32_bf16 v[192:195], a[64:67], v[96:99], v[192:195]
ds_read_b128 a[96:99], v2 offset:24576
v_exp_f32 v14, v78
v_mfma_f32_16x16x32_bf16 v[192:195], a[68:71], v[100:103], v[192:195]
v_exp_f32 v15, v79
v_mfma_f32_16x16x32_bf16 v[196:199], a[68:71], v[108:111], v[196:199]
ds_read_b128 a[100:103], v2 offset:25600
v_add_f32 v27, v27, v12
v_add_f32 v27, v27, v13
v_cvt_pk_bf16_f32 v122, v12, v13
v_add_f32 v27, v27, v14
v_mfma_f32_16x16x32_bf16 v[196:199], a[64:67], v[104:107], v[196:199]
v_exp_f32 v8, v80
v_mfma_f32_16x16x32_bf16 v[200:203], a[72:75], v[96:99], v[200:203]
ds_read_b128 a[104:107], v2 offset:26624
v_exp_f32 v9, v81
v_mfma_f32_16x16x32_bf16 v[200:203], a[76:79], v[100:103], v[200:203]
v_exp_f32 v10, v82
v_mfma_f32_16x16x32_bf16 v[204:207], a[76:79], v[108:111], v[204:207]
ds_read_b128 a[108:111], v2 offset:27648
v_add_f32 v27, v27, v15
v_cvt_pk_bf16_f32 v123, v14, v15
v_add_f32 v26, v26, v8
v_add_f32 v26, v26, v9
v_cvt_pk_bf16_f32 v116, v8, v9
v_mfma_f32_16x16x32_bf16 v[204:207], a[72:75], v[104:107], v[204:207]
s_waitcnt lgkmcnt(4)
v_exp_f32 v11, v83
v_mfma_f32_16x16x32_bf16 v[208:211], a[80:83], v[96:99], v[208:211]
ds_read_b128 a[112:115], v2 offset:28672
v_exp_f32 v12, v84
v_mfma_f32_16x16x32_bf16 v[208:211], a[84:87], v[100:103], v[208:211]
v_exp_f32 v13, v85
v_mfma_f32_16x16x32_bf16 v[212:215], a[84:87], v[108:111], v[212:215]
ds_read_b128 a[116:119], v2 offset:29696
v_add_f32 v26, v26, v10
v_add_f32 v26, v26, v11
v_cvt_pk_bf16_f32 v117, v10, v11
v_add_f32 v27, v27, v12
v_mfma_f32_16x16x32_bf16 v[212:215], a[80:83], v[104:107], v[212:215]
v_exp_f32 v14, v86
v_mfma_f32_16x16x32_bf16 v[216:219], a[88:91], v[96:99], v[216:219]
ds_read_b128 a[120:123], v2 offset:30720
v_exp_f32 v15, v87
v_mfma_f32_16x16x32_bf16 v[216:219], a[92:95], v[100:103], v[216:219]
v_exp_f32 v8, v88
v_mfma_f32_16x16x32_bf16 v[220:223], a[92:95], v[108:111], v[220:223]
s_waitcnt vmcnt(0) lgkmcnt(4)
ds_read_b128 a[124:127], v2 offset:31744
v_add_f32 v27, v27, v13
v_cvt_pk_bf16_f32 v124, v12, v13
v_add_f32 v27, v27, v14
v_add_f32 v27, v27, v15
v_cvt_pk_bf16_f32 v125, v14, v15
v_mfma_f32_16x16x32_bf16 v[220:223], a[88:91], v[104:107], v[220:223]
s_barrier
v_mfma_f32_16x16x32_bf16 v[224:227], a[96:99], v[96:99], v[224:227]
ds_read_b128 a[64:67], v2 offset:32768
v_exp_f32 v9, v89
v_mfma_f32_16x16x32_bf16 v[224:227], a[100:103], v[100:103], v[224:227]
v_exp_f32 v10, v90
v_mfma_f32_16x16x32_bf16 v[228:231], a[100:103], v[108:111], v[228:231]
ds_read_b128 a[68:71], v2 offset:33792
v_add_f32 v26, v26, v8
v_add_f32 v26, v26, v9
v_cvt_pk_bf16_f32 v118, v8, v9
v_mfma_f32_16x16x32_bf16 v[228:231], a[96:99], v[104:107], v[228:231]
v_exp_f32 v11, v91
v_mfma_f32_16x16x32_bf16 v[232:235], a[104:107], v[96:99], v[232:235]
s_waitcnt lgkmcnt(4)
ds_read_b128 a[72:75], v2 offset:34816
v_exp_f32 v12, v92
v_mfma_f32_16x16x32_bf16 v[232:235], a[108:111], v[100:103], v[232:235]
v_exp_f32 v13, v93
v_mfma_f32_16x16x32_bf16 v[236:239], a[108:111], v[108:111], v[236:239]
ds_read_b128 a[76:79], v2 offset:35840
v_add_f32 v26, v26, v10
v_mfma_f32_16x16x32_bf16 v[236:239], a[104:107], v[104:107], v[236:239]
v_exp_f32 v14, v94
v_mfma_f32_16x16x32_bf16 v[240:243], a[112:115], v[96:99], v[240:243]
ds_read_b128 a[80:83], v2 offset:36864
v_add_f32 v26, v26, v11
v_cvt_pk_bf16_f32 v119, v10, v11
v_add_f32 v27, v27, v12
v_mfma_f32_16x16x32_bf16 v[240:243], a[116:119], v[100:103], v[240:243]
v_exp_f32 v15, v95
v_mfma_f32_16x16x32_bf16 v[244:247], a[116:119], v[108:111], v[244:247]
ds_read_b128 a[84:87], v2 offset:37888
v_add_f32 v27, v27, v13
v_cvt_pk_bf16_f32 v126, v12, v13
v_mfma_f32_16x16x32_bf16 v[244:247], a[112:115], v[104:107], v[244:247]
s_waitcnt lgkmcnt(4)
v_add_f32 v27, v27, v14
v_add_f32 v27, v27, v15
v_mfma_f32_16x16x32_bf16 v[248:251], a[120:123], v[96:99], v[248:251]
ds_read_b128 a[88:91], v2 offset:38912
v_cvt_pk_bf16_f32 v127, v14, v15
v_mfma_f32_16x16x32_bf16 v[248:251], a[124:127], v[100:103], v[248:251]
v_add_f32 v28, v26, v27
v_cmp_nge_f32 vcc, s25, v28
v_mfma_f32_16x16x32_bf16 v[252:255], a[124:127], v[108:111], v[252:255]
ds_read_b128 a[92:95], v2 offset:39936
v_mfma_f32_16x16x32_bf16 v[252:255], a[120:123], v[104:107], v[252:255]
s_cbranch_vccnz Lstub_14
Lback_15:
v_mfma_f32_16x16x32_bf16 v[128:131], a[64:67], v[112:115], v[128:131]
s_add_u32 m0, s18, 131072
ds_read_b128 a[96:99], v2 offset:40960
v_add_f32 v24, v24, v26
v_mfma_f32_16x16x32_bf16 v[128:131], a[68:71], v[116:119], v[128:131]
buffer_load_dwordx4 v1, s[4:7], s8 offen offset:0 sc1 lds
v_mfma_f32_16x16x32_bf16 v[132:135], a[68:71], v[124:127], v[132:135]
ds_read_b128 a[100:103], v2 offset:41984
v_add_f32 v25, v25, v27
v_mfma_f32_16x16x32_bf16 v[132:135], a[64:67], v[120:123], v[132:135]
s_waitcnt lgkmcnt(4)
buffer_load_dwordx4 v1, s[4:7], s8 offen offset:1024 sc1 lds
v_mfma_f32_16x16x32_bf16 v[136:139], a[72:75], v[112:115], v[136:139]
ds_read_b128 a[104:107], v2 offset:43008
v_mov_b32 v8, v16
v_mfma_f32_16x16x32_bf16 v[136:139], a[76:79], v[116:119], v[136:139]
buffer_load_dwordx4 v1, s[4:7], s8 offen offset:2048 sc1 lds
v_mfma_f32_16x16x32_bf16 v[140:143], a[76:79], v[124:127], v[140:143]
ds_read_b128 a[108:111], v2 offset:44032
v_mov_b32 v9, v24
v_mfma_f32_16x16x32_bf16 v[140:143], a[72:75], v[120:123], v[140:143]
buffer_load_dwordx4 v1, s[4:7], s8 offen offset:3072 sc1 lds
v_mfma_f32_16x16x32_bf16 v[144:147], a[80:83], v[112:115], v[144:147]
s_add_u32 s8, s8, 4096
s_add_u32 m0, s18, 135168
ds_read_b128 a[112:115], v2 offset:45056
v_mfma_f32_16x16x32_bf16 v[144:147], a[84:87], v[116:119], v[144:147]
buffer_load_dwordx4 v1, s[4:7], s8 offen offset:0 sc1 lds
v_mfma_f32_16x16x32_bf16 v[148:151], a[84:87], v[124:127], v[148:151]
ds_read_b128 a[116:119], v2 offset:46080
v_mov_b32 v10, v20
v_mfma_f32_16x16x32_bf16 v[148:151], a[80:83], v[120:123], v[148:151]
s_waitcnt lgkmcnt(4)
buffer_load_dwordx4 v1, s[4:7], s8 offen offset:1024 sc1 lds
v_mfma_f32_16x16x32_bf16 v[152:155], a[88:91], v[112:115], v[152:155]
ds_read_b128 a[120:123], v2 offset:47104
v_mov_b32 v11, v25
v_mfma_f32_16x16x32_bf16 v[152:155], a[92:95], v[116:119], v[152:155]
buffer_load_dwordx4 v1, s[4:7], s8 offen offset:2048 sc1 lds
v_mfma_f32_16x16x32_bf16 v[156:159], a[92:95], v[124:127], v[156:159]
ds_read_b128 a[124:127], v2 offset:48128
v_cvt_pk_bf16_f32 v128, v128, v129
v_mfma_f32_16x16x32_bf16 v[156:159], a[88:91], v[120:123], v[156:159]
s_waitcnt lgkmcnt(4)
buffer_load_dwordx4 v1, s[4:7], s8 offen offset:3072 sc1 lds
v_mfma_f32_16x16x32_bf16 v[160:163], a[96:99], v[112:115], v[160:163]
s_add_u32 s8, s8, 28672
ds_read_b128 a[64:67], v2 offset:49152
v_cvt_pk_bf16_f32 v129, v130, v131
v_mfma_f32_16x16x32_bf16 v[160:163], a[100:103], v[116:119], v[160:163]
s_sub_u32 s9, s9, 1
buffer_store_dwordx4 v[8:11], v1, s[4:7], s27 offen sc1
v_mfma_f32_16x16x32_bf16 v[164:167], a[100:103], v[124:127], v[164:167]
s_cmp_eq_u32 s9, 0
ds_read_b128 a[68:71], v2 offset:50176
v_cvt_pk_bf16_f32 v130, v136, v137
v_mfma_f32_16x16x32_bf16 v[164:167], a[96:99], v[120:123], v[164:167]
s_cselect_b32 s8, s10, s8
v_cvt_pk_bf16_f32 v131, v138, v139
v_accvgpr_mov_b32 a0, a192
v_mfma_f32_16x16x32_bf16 v[168:171], a[104:107], v[112:115], v[168:171]
s_cselect_b32 s9, s11, s9
ds_read_b128 a[72:75], v2 offset:51200
v_accvgpr_mov_b32 a1, a193
v_mfma_f32_16x16x32_bf16 v[168:171], a[108:111], v[116:119], v[168:171]
s_cselect_b32 s10, 3221225472, s10
buffer_store_dwordx4 v[128:131], v1, s[4:7], s76 offen offset:0 sc1
v_mfma_f32_16x16x32_bf16 v[172:175], a[108:111], v[124:127], v[172:175]
ds_read_b128 a[76:79], v2 offset:52224
v_cvt_pk_bf16_f32 v132, v132, v133
v_mfma_f32_16x16x32_bf16 v[172:175], a[104:107], v[120:123], v[172:175]
s_waitcnt lgkmcnt(4)
v_cvt_pk_bf16_f32 v133, v134, v135
v_cvt_pk_bf16_f32 v134, v140, v141
v_mfma_f32_16x16x32_bf16 v[176:179], a[112:115], v[112:115], v[176:179]
ds_read_b128 a[80:83], v2 offset:53248
v_cvt_pk_bf16_f32 v135, v142, v143
v_mfma_f32_16x16x32_bf16 v[176:179], a[116:119], v[116:119], v[176:179]
buffer_store_dwordx4 v[132:135], v1, s[4:7], s77 offen offset:0 sc1
v_mfma_f32_16x16x32_bf16 v[180:183], a[116:119], v[124:127], v[180:183]
ds_read_b128 a[84:87], v2 offset:54272
v_cvt_pk_bf16_f32 v144, v144, v145
v_mfma_f32_16x16x32_bf16 v[180:183], a[112:115], v[120:123], v[180:183]
v_cvt_pk_bf16_f32 v145, v146, v147
v_cvt_pk_bf16_f32 v146, v152, v153
v_mfma_f32_16x16x32_bf16 v[184:187], a[120:123], v[112:115], v[184:187]
ds_read_b128 a[88:91], v2 offset:55296
v_cvt_pk_bf16_f32 v147, v154, v155
v_mfma_f32_16x16x32_bf16 v[184:187], a[124:127], v[116:119], v[184:187]
buffer_store_dwordx4 v[144:147], v1, s[4:7], s76 offen offset:1024 sc1
v_mfma_f32_16x16x32_bf16 v[188:191], a[124:127], v[124:127], v[188:191]
ds_read_b128 a[92:95], v2 offset:56320
v_cvt_pk_bf16_f32 v148, v148, v149
v_mfma_f32_16x16x32_bf16 v[188:191], a[120:123], v[120:123], v[188:191]
s_waitcnt lgkmcnt(4)
v_cvt_pk_bf16_f32 v149, v150, v151
v_cvt_pk_bf16_f32 v150, v156, v157
v_mfma_f32_16x16x32_bf16 v[192:195], a[64:67], v[112:115], v[192:195]
ds_read_b128 a[96:99], v2 offset:57344
v_cvt_pk_bf16_f32 v151, v158, v159
v_mfma_f32_16x16x32_bf16 v[192:195], a[68:71], v[116:119], v[192:195]
buffer_store_dwordx4 v[148:151], v1, s[4:7], s77 offen offset:1024 sc1
v_mfma_f32_16x16x32_bf16 v[196:199], a[68:71], v[124:127], v[196:199]
ds_read_b128 a[100:103], v2 offset:58368
v_cvt_pk_bf16_f32 v160, v160, v161
v_mfma_f32_16x16x32_bf16 v[196:199], a[64:67], v[120:123], v[196:199]
v_cvt_pk_bf16_f32 v161, v162, v163
v_cvt_pk_bf16_f32 v162, v168, v169
v_mfma_f32_16x16x32_bf16 v[200:203], a[72:75], v[112:115], v[200:203]
ds_read_b128 a[104:107], v2 offset:59392
v_cvt_pk_bf16_f32 v163, v170, v171
v_mfma_f32_16x16x32_bf16 v[200:203], a[76:79], v[116:119], v[200:203]
buffer_store_dwordx4 v[160:163], v1, s[4:7], s76 offen offset:2048 sc1
v_mfma_f32_16x16x32_bf16 v[204:207], a[76:79], v[124:127], v[204:207]
ds_read_b128 a[108:111], v2 offset:60416
v_cvt_pk_bf16_f32 v164, v164, v165
v_mfma_f32_16x16x32_bf16 v[204:207], a[72:75], v[120:123], v[204:207]
s_waitcnt lgkmcnt(4)
v_cvt_pk_bf16_f32 v165, v166, v167
v_cvt_pk_bf16_f32 v166, v172, v173
v_mfma_f32_16x16x32_bf16 v[208:211], a[80:83], v[112:115], v[208:211]
ds_read_b128 a[112:115], v2 offset:61440
v_cvt_pk_bf16_f32 v167, v174, v175
v_mfma_f32_16x16x32_bf16 v[208:211], a[84:87], v[116:119], v[208:211]
buffer_store_dwordx4 v[164:167], v1, s[4:7], s77 offen offset:2048 sc1
v_mfma_f32_16x16x32_bf16 v[212:215], a[84:87], v[124:127], v[212:215]
ds_read_b128 a[116:119], v2 offset:62464
v_cvt_pk_bf16_f32 v176, v176, v177
v_mfma_f32_16x16x32_bf16 v[212:215], a[80:83], v[120:123], v[212:215]
v_cvt_pk_bf16_f32 v177, v178, v179
v_cvt_pk_bf16_f32 v178, v184, v185
v_mfma_f32_16x16x32_bf16 v[216:219], a[88:91], v[112:115], v[216:219]
ds_read_b128 a[120:123], v2 offset:63488
v_cvt_pk_bf16_f32 v179, v186, v187
v_mfma_f32_16x16x32_bf16 v[216:219], a[92:95], v[116:119], v[216:219]
buffer_store_dwordx4 v[176:179], v1, s[4:7], s76 offen offset:3072 sc1
v_mfma_f32_16x16x32_bf16 v[220:223], a[92:95], v[124:127], v[220:223]
ds_read_b128 a[124:127], v2 offset:64512
v_cvt_pk_bf16_f32 v180, v180, v181
v_mfma_f32_16x16x32_bf16 v[220:223], a[88:91], v[120:123], v[220:223]
s_waitcnt lgkmcnt(4)
v_cvt_pk_bf16_f32 v181, v182, v183
v_cvt_pk_bf16_f32 v182, v188, v189
v_mfma_f32_16x16x32_bf16 v[224:227], a[96:99], v[112:115], v[224:227]
v_cvt_pk_bf16_f32 v183, v190, v191
v_accvgpr_mov_b32 a2, a194
v_mfma_f32_16x16x32_bf16 v[224:227], a[100:103], v[116:119], v[224:227]
PAD_34:
s_cbranch_execz M_tret
buffer_store_dwordx4 v[180:183], v1, s[4:7], s77 offen offset:3072 sc1
v_mfma_f32_16x16x32_bf16 v[228:231], a[100:103], v[124:127], v[228:231]
s_add_u32 s76, s76, 4096
v_accvgpr_mov_b32 a3, a195
v_accvgpr_mov_b32 a4, a196
v_mfma_f32_16x16x32_bf16 v[228:231], a[96:99], v[120:123], v[228:231]
s_add_u32 s77, s77, 4096
v_cvt_pk_bf16_f32 v192, v192, v193
v_cvt_pk_bf16_f32 v193, v194, v195
v_mfma_f32_16x16x32_bf16 v[232:235], a[104:107], v[112:115], v[232:235]
v_cvt_pk_bf16_f32 v194, v200, v201
v_cvt_pk_bf16_f32 v195, v202, v203
v_mfma_f32_16x16x32_bf16 v[232:235], a[108:111], v[116:119], v[232:235]
buffer_store_dwordx4 v[192:195], v1, s[4:7], s76 offen offset:0 sc1
v_mfma_f32_16x16x32_bf16 v[236:239], a[108:111], v[124:127], v[236:239]
v_cvt_pk_bf16_f32 v196, v196, v197
v_cvt_pk_bf16_f32 v197, v198, v199
v_mfma_f32_16x16x32_bf16 v[236:239], a[104:107], v[120:123], v[236:239]
s_waitcnt lgkmcnt(0)
v_cvt_pk_bf16_f32 v198, v204, v205
v_cvt_pk_bf16_f32 v199, v206, v207
v_mfma_f32_16x16x32_bf16 v[240:243], a[112:115], v[112:115], v[240:243]
buffer_store_dwordx4 v[196:199], v1, s[4:7], s77 offen offset:0 sc1
v_mfma_f32_16x16x32_bf16 v[240:243], a[116:119], v[116:119], v[240:243]
v_cvt_pk_bf16_f32 v208, v208, v209
v_cvt_pk_bf16_f32 v209, v210, v211
v_mfma_f32_16x16x32_bf16 v[244:247], a[116:119], v[124:127], v[244:247]
v_cvt_pk_bf16_f32 v210, v216, v217
v_cvt_pk_bf16_f32 v211, v218, v219
v_mfma_f32_16x16x32_bf16 v[244:247], a[112:115], v[120:123], v[244:247]
buffer_store_dwordx4 v[208:211], v1, s[4:7], s76 offen offset:1024 sc1
v_mfma_f32_16x16x32_bf16 v[248:251], a[120:123], v[112:115], v[248:251]
v_cvt_pk_bf16_f32 v212, v212, v213
v_cvt_pk_bf16_f32 v213, v214, v215
v_mfma_f32_16x16x32_bf16 v[248:251], a[124:127], v[116:119], v[248:251]
v_cvt_pk_bf16_f32 v214, v220, v221
v_cvt_pk_bf16_f32 v215, v222, v223
v_mfma_f32_16x16x32_bf16 v[252:255], a[124:127], v[124:127], v[252:255]
buffer_store_dwordx4 v[212:215], v1, s[4:7], s77 offen offset:1024 sc1
v_mfma_f32_16x16x32_bf16 v[252:255], a[120:123], v[120:123], v[252:255]
v_cvt_pk_bf16_f32 v224, v224, v225
v_cvt_pk_bf16_f32 v225, v226, v227
v_accvgpr_mov_b32 a5, a197
v_accvgpr_mov_b32 a6, a198
v_accvgpr_mov_b32 a7, a199
v_accvgpr_mov_b32 a8, a200
v_accvgpr_mov_b32 a9, a201
v_accvgpr_mov_b32 a10, a202
v_accvgpr_mov_b32 a11, a203
v_accvgpr_mov_b32 a12, a204
v_cvt_pk_bf16_f32 v226, v232, v233
v_cvt_pk_bf16_f32 v227, v234, v235
buffer_store_dwordx4 v[224:227], v1, s[4:7], s76 offen offset:2048 sc1
v_cvt_pk_bf16_f32 v228, v228, v229
v_cvt_pk_bf16_f32 v229, v230, v231
v_cvt_pk_bf16_f32 v230, v236, v237
v_cvt_pk_bf16_f32 v231, v238, v239
buffer_store_dwordx4 v[228:231], v1, s[4:7], s77 offen offset:2048 sc1
v_cvt_pk_bf16_f32 v240, v240, v241
v_cvt_pk_bf16_f32 v241, v242, v243
v_cvt_pk_bf16_f32 v242, v248, v249
v_cvt_pk_bf16_f32 v243, v250, v251
buffer_store_dwordx4 v[240:243], v1, s[4:7], s76 offen offset:3072 sc1
v_cvt_pk_bf16_f32 v244, v244, v245
v_cvt_pk_bf16_f32 v245, v246, v247
v_cvt_pk_bf16_f32 v246, v252, v253
v_cvt_pk_bf16_f32 v247, v254, v255
buffer_store_dwordx4 v[244:247], v1, s[4:7], s77 offen offset:3072 sc1
v_accvgpr_mov_b32 a13, a205
v_accvgpr_mov_b32 a14, a206
v_accvgpr_mov_b32 a15, a207
v_accvgpr_mov_b32 a16, a208
v_accvgpr_mov_b32 a17, a209
v_accvgpr_mov_b32 a18, a210
v_accvgpr_mov_b32 a19, a211
v_accvgpr_mov_b32 a20, a212
v_accvgpr_mov_b32 a21, a213
v_accvgpr_mov_b32 a22, a214
v_accvgpr_mov_b32 a23, a215
v_accvgpr_mov_b32 a24, a216
v_accvgpr_mov_b32 a25, a217
v_accvgpr_mov_b32 a26, a218
v_accvgpr_mov_b32 a27, a219
v_accvgpr_mov_b32 a28, a220
v_accvgpr_mov_b32 a29, a221
v_accvgpr_mov_b32 a30, a222
v_accvgpr_mov_b32 a31, a223
v_accvgpr_mov_b32 a32, a224
v_accvgpr_mov_b32 a33, a225
v_accvgpr_mov_b32 a34, a226
v_accvgpr_mov_b32 a35, a227
v_accvgpr_mov_b32 a36, a228
v_accvgpr_mov_b32 a37, a229
v_accvgpr_mov_b32 a38, a230
v_accvgpr_mov_b32 a39, a231
v_accvgpr_mov_b32 a40, a232
v_accvgpr_mov_b32 a41, a233
v_accvgpr_mov_b32 a42, a234
v_accvgpr_mov_b32 a43, a235
v_accvgpr_mov_b32 a44, a236
v_accvgpr_mov_b32 a45, a237
v_accvgpr_mov_b32 a46, a238
v_accvgpr_mov_b32 a47, a239
v_accvgpr_mov_b32 a48, a240
v_accvgpr_mov_b32 a49, a241
v_accvgpr_mov_b32 a50, a242
v_accvgpr_mov_b32 a51, a243
v_accvgpr_mov_b32 a52, a244
v_accvgpr_mov_b32 a53, a245
v_accvgpr_mov_b32 a54, a246
v_accvgpr_mov_b32 a55, a247
v_accvgpr_mov_b32 a56, a248
v_accvgpr_mov_b32 a57, a249
v_accvgpr_mov_b32 a58, a250
v_accvgpr_mov_b32 a59, a251
v_accvgpr_mov_b32 a60, a252
v_accvgpr_mov_b32 a61, a253
v_accvgpr_mov_b32 a62, a254
v_accvgpr_mov_b32 a63, a255
s_mov_b32 s24, 0
s_mov_b32 s29, s21
s_mov_b32 s19, s21
v_mov_b64 v[128:129], 0
v_mov_b64 v[130:131], 0
v_mov_b64 v[132:133], 0
v_mov_b64 v[134:135], 0
v_mov_b64 v[136:137], 0
v_mov_b64 v[138:139], 0
v_mov_b64 v[140:141], 0
v_mov_b64 v[142:143], 0
v_mov_b64 v[144:145], 0
v_mov_b64 v[146:147], 0
v_mov_b64 v[148:149], 0
v_mov_b64 v[150:151], 0
v_mov_b64 v[152:153], 0
v_mov_b64 v[154:155], 0
v_mov_b64 v[156:157], 0
v_mov_b64 v[158:159], 0
v_mov_b64 v[160:161], 0
v_mov_b64 v[162:163], 0
v_mov_b64 v[164:165], 0
v_mov_b64 v[166:167], 0
v_mov_b64 v[168:169], 0
v_mov_b64 v[170:171], 0
v_mov_b64 v[172:173], 0
v_mov_b64 v[174:175], 0
v_mov_b64 v[176:177], 0
v_mov_b64 v[178:179], 0
v_mov_b64 v[180:181], 0
v_mov_b64 v[182:183], 0
v_mov_b64 v[184:185], 0
v_mov_b64 v[186:187], 0
v_mov_b64 v[188:189], 0
v_mov_b64 v[190:191], 0
v_mov_b64 v[192:193], 0
v_mov_b64 v[194:195], 0
v_mov_b64 v[196:197], 0
v_mov_b64 v[198:199], 0
v_mov_b64 v[200:201], 0
v_mov_b64 v[202:203], 0
v_mov_b64 v[204:205], 0
v_mov_b64 v[206:207], 0
v_mov_b64 v[208:209], 0
v_mov_b64 v[210:211], 0
v_mov_b64 v[212:213], 0
v_mov_b64 v[214:215], 0
v_mov_b64 v[216:217], 0
v_mov_b64 v[218:219], 0
v_mov_b64 v[220:221], 0
v_mov_b64 v[222:223], 0
v_mov_b64 v[224:225], 0
v_mov_b64 v[226:227], 0
v_mov_b64 v[228:229], 0
v_mov_b64 v[230:231], 0
v_mov_b64 v[232:233], 0
v_mov_b64 v[234:235], 0
v_mov_b64 v[236:237], 0
v_mov_b64 v[238:239], 0
v_mov_b64 v[240:241], 0
v_mov_b64 v[242:243], 0
v_mov_b64 v[244:245], 0
v_mov_b64 v[246:247], 0
v_mov_b64 v[248:249], 0
v_mov_b64 v[250:251], 0
v_mov_b64 v[252:253], 0
v_mov_b64 v[254:255], 0
v_mov_b64 v[24:25], 0
s_mov_b32 s71, s28
s_mov_b32 s84, 0
s_barrier
s_branch K2_item
K2_nend:
Lstub_2:
s_call_b64 s[16:17], K2_slow1
s_branch Lback_3
Lstub_4:
s_call_b64 s[16:17], K2_slow0
s_branch Lback_5
Lstub_6:
s_call_b64 s[16:17], K2_slow1
s_branch Lback_7
Lstub_8:
s_call_b64 s[16:17], K2_slow0
s_branch Lback_9
Lstub_10:
s_call_b64 s[16:17], K2_slow2
s_branch Lback_11
Lstub_12:
s_call_b64 s[16:17], K2_slow2
s_branch Lback_13
Lstub_14:
s_call_b64 s[16:17], K2_slow1
s_branch Lback_15
K2_slow0:
s_nop 7
s_nop 7
v_max3_f32 v8, v32, v33, 0
v_max3_f32 v8, v34, v35, v8
v_max3_f32 v8, v40, v41, v8
v_max3_f32 v8, v42, v43, v8
v_max3_f32 v8, v48, v49, v8
v_max3_f32 v8, v50, v51, v8
v_max3_f32 v8, v56, v57, v8
v_max3_f32 v8, v58, v59, v8
v_mov_b32 v9, v8
s_nop 1
v_permlane16_swap_b32 v8, v9
v_max_f32 v8, v8, v9
v_mov_b32 v9, v8
s_nop 1
v_permlane32_swap_b32 v8, v9
v_max_f32 v8, v8, v9
v_exp_f32 v9, -v8
v_sub_f32 v16, v16, v8
v_sub_f32 v17, v17, v8
v_sub_f32 v18, v18, v8
v_sub_f32 v19, v19, v8
v_mul_f32 v24, v24, v9
v_mul_f32 v128, v128, v9
v_mul_f32 v129, v129, v9
v_mul_f32 v130, v130, v9
v_mul_f32 v131, v131, v9
v_mul_f32 v136, v136, v9
v_mul_f32 v137, v137, v9
v_mul_f32 v138, v138, v9
v_mul_f32 v139, v139, v9
v_mul_f32 v144, v144, v9
v_mul_f32 v145, v145, v9
v_mul_f32 v146, v146, v9
v_mul_f32 v147, v147, v9
v_mul_f32 v152, v152, v9
v_mul_f32 v153, v153, v9
v_mul_f32 v154, v154, v9
v_mul_f32 v155, v155, v9
v_mul_f32 v160, v160, v9
v_mul_f32 v161, v161, v9
v_mul_f32 v162, v162, v9
v_mul_f32 v163, v163, v9
v_mul_f32 v168, v168, v9
v_mul_f32 v169, v169, v9
v_mul_f32 v170, v170, v9
v_mul_f32 v171, v171, v9
v_mul_f32 v176, v176, v9
v_mul_f32 v177, v177, v9
v_mul_f32 v178, v178, v9
v_mul_f32 v179, v179, v9
v_mul_f32 v184, v184, v9
v_mul_f32 v185, v185, v9
v_mul_f32 v186, v186, v9
v_mul_f32 v187, v187, v9
v_mul_f32 v192, v192, v9
v_mul_f32 v193, v193, v9
v_mul_f32 v194, v194, v9
v_mul_f32 v195, v195, v9
v_mul_f32 v200, v200, v9
v_mul_f32 v201, v201, v9
v_mul_f32 v202, v202, v9
v_mul_f32 v203, v203, v9
v_mul_f32 v208, v208, v9
v_mul_f32 v209, v209, v9
v_mul_f32 v210, v210, v9
v_mul_f32 v211, v211, v9
v_mul_f32 v216, v216, v9
v_mul_f32 v217, v217, v9
v_mul_f32 v218, v218, v9
v_mul_f32 v219, v219, v9
v_mul_f32 v224, v224, v9
v_mul_f32 v225, v225, v9
v_mul_f32 v226, v226, v9
v_mul_f32 v227, v227, v9
v_mul_f32 v232, v232, v9
v_mul_f32 v233, v233, v9
v_mul_f32 v234, v234, v9
v_mul_f32 v235, v235, v9
v_mul_f32 v240, v240, v9
v_mul_f32 v241, v241, v9
v_mul_f32 v242, v242, v9
v_mul_f32 v243, v243, v9
v_mul_f32 v248, v248, v9
v_mul_f32 v249, v249, v9
v_mul_f32 v250, v250, v9
v_mul_f32 v251, v251, v9
v_sub_f32 v32, v32, v8
v_sub_f32 v33, v33, v8
v_sub_f32 v34, v34, v8
v_sub_f32 v35, v35, v8
v_sub_f32 v40, v40, v8
v_sub_f32 v41, v41, v8
v_sub_f32 v42, v42, v8
v_sub_f32 v43, v43, v8
v_sub_f32 v48, v48, v8
v_sub_f32 v49, v49, v8
v_sub_f32 v50, v50, v8
v_sub_f32 v51, v51, v8
v_sub_f32 v56, v56, v8
v_sub_f32 v57, v57, v8
v_sub_f32 v58, v58, v8
v_sub_f32 v59, v59, v8
v_sub_f32 v64, v64, v8
v_sub_f32 v65, v65, v8
v_sub_f32 v66, v66, v8
v_sub_f32 v67, v67, v8
v_sub_f32 v72, v72, v8
v_sub_f32 v73, v73, v8
v_sub_f32 v74, v74, v8
v_sub_f32 v75, v75, v8
v_sub_f32 v80, v80, v8
v_sub_f32 v81, v81, v8
v_sub_f32 v82, v82, v8
v_sub_f32 v83, v83, v8
v_sub_f32 v88, v88, v8
v_sub_f32 v89, v89, v8
v_sub_f32 v90, v90, v8
v_sub_f32 v91, v91, v8
v_max3_f32 v8, v36, v37, 0
v_max3_f32 v8, v38, v39, v8
v_max3_f32 v8, v44, v45, v8
v_max3_f32 v8, v46, v47, v8
v_max3_f32 v8, v52, v53, v8
v_max3_f32 v8, v54, v55, v8
v_max3_f32 v8, v60, v61, v8
v_max3_f32 v8, v62, v63, v8
v_mov_b32 v9, v8
s_nop 1
v_permlane16_swap_b32 v8, v9
v_max_f32 v8, v8, v9
v_mov_b32 v9, v8
s_nop 1
v_permlane32_swap_b32 v8, v9
v_max_f32 v8, v8, v9
v_exp_f32 v9, -v8
v_sub_f32 v20, v20, v8
v_sub_f32 v21, v21, v8
v_sub_f32 v22, v22, v8
v_sub_f32 v23, v23, v8
v_mul_f32 v25, v25, v9
v_mul_f32 v132, v132, v9
v_mul_f32 v133, v133, v9
v_mul_f32 v134, v134, v9
v_mul_f32 v135, v135, v9
v_mul_f32 v140, v140, v9
v_mul_f32 v141, v141, v9
v_mul_f32 v142, v142, v9
v_mul_f32 v143, v143, v9
v_mul_f32 v148, v148, v9
v_mul_f32 v149, v149, v9
v_mul_f32 v150, v150, v9
v_mul_f32 v151, v151, v9
v_mul_f32 v156, v156, v9
v_mul_f32 v157, v157, v9
v_mul_f32 v158, v158, v9
v_mul_f32 v159, v159, v9
v_mul_f32 v164, v164, v9
v_mul_f32 v165, v165, v9
v_mul_f32 v166, v166, v9
v_mul_f32 v167, v167, v9
v_mul_f32 v172, v172, v9
v_mul_f32 v173, v173, v9
v_mul_f32 v174, v174, v9
v_mul_f32 v175, v175, v9
v_mul_f32 v180, v180, v9
v_mul_f32 v181, v181, v9
v_mul_f32 v182, v182, v9
v_mul_f32 v183, v183, v9
v_mul_f32 v188, v188, v9
v_mul_f32 v189, v189, v9
v_mul_f32 v190, v190, v9
v_mul_f32 v191, v191, v9
v_mul_f32 v196, v196, v9
v_mul_f32 v197, v197, v9
v_mul_f32 v198, v198, v9
v_mul_f32 v199, v199, v9
v_mul_f32 v204, v204, v9
v_mul_f32 v205, v205, v9
v_mul_f32 v206, v206, v9
v_mul_f32 v207, v207, v9
v_mul_f32 v212, v212, v9
v_mul_f32 v213, v213, v9
v_mul_f32 v214, v214, v9
v_mul_f32 v215, v215, v9
v_mul_f32 v220, v220, v9
v_mul_f32 v221, v221, v9
v_mul_f32 v222, v222, v9
v_mul_f32 v223, v223, v9
v_mul_f32 v228, v228, v9
v_mul_f32 v229, v229, v9
v_mul_f32 v230, v230, v9
v_mul_f32 v231, v231, v9
v_mul_f32 v236, v236, v9
v_mul_f32 v237, v237, v9
v_mul_f32 v238, v238, v9
v_mul_f32 v239, v239, v9
v_mul_f32 v244, v244, v9
v_mul_f32 v245, v245, v9
v_mul_f32 v246, v246, v9
v_mul_f32 v247, v247, v9
v_mul_f32 v252, v252, v9
v_mul_f32 v253, v253, v9
v_mul_f32 v254, v254, v9
v_mul_f32 v255, v255, v9
v_sub_f32 v36, v36, v8
v_sub_f32 v37, v37, v8
v_sub_f32 v38, v38, v8
v_sub_f32 v39, v39, v8
v_sub_f32 v44, v44, v8
v_sub_f32 v45, v45, v8
v_sub_f32 v46, v46, v8
v_sub_f32 v47, v47, v8
v_sub_f32 v52, v52, v8
v_sub_f32 v53, v53, v8
v_sub_f32 v54, v54, v8
v_sub_f32 v55, v55, v8
v_sub_f32 v60, v60, v8
v_sub_f32 v61, v61, v8
v_sub_f32 v62, v62, v8
v_sub_f32 v63, v63, v8
v_sub_f32 v68, v68, v8
v_sub_f32 v69, v69, v8
v_sub_f32 v70, v70, v8
v_sub_f32 v71, v71, v8
v_sub_f32 v76, v76, v8
v_sub_f32 v77, v77, v8
v_sub_f32 v78, v78, v8
v_sub_f32 v79, v79, v8
v_sub_f32 v84, v84, v8
v_sub_f32 v85, v85, v8
v_sub_f32 v86, v86, v8
v_sub_f32 v87, v87, v8
v_sub_f32 v92, v92, v8
v_sub_f32 v93, v93, v8
v_sub_f32 v94, v94, v8
v_sub_f32 v95, v95, v8
v_exp_f32 v8, v32
v_exp_f32 v9, v33
v_exp_f32 v10, v34
v_exp_f32 v11, v35
s_nop 0
v_add_f32 v26, v8, v9
v_cvt_pk_bf16_f32 v96, v8, v9
v_add_f32 v26, v26, v10
v_add_f32 v26, v26, v11
v_cvt_pk_bf16_f32 v97, v10, v11
v_exp_f32 v12, v36
v_exp_f32 v13, v37
v_exp_f32 v14, v38
v_exp_f32 v15, v39
s_nop 0
v_add_f32 v27, v12, v13
v_cvt_pk_bf16_f32 v104, v12, v13
v_add_f32 v27, v27, v14
v_add_f32 v27, v27, v15
v_cvt_pk_bf16_f32 v105, v14, v15
v_exp_f32 v8, v40
v_exp_f32 v9, v41
v_exp_f32 v10, v42
v_exp_f32 v11, v43
s_nop 0
v_add_f32 v26, v26, v8
v_add_f32 v26, v26, v9
v_cvt_pk_bf16_f32 v98, v8, v9
v_add_f32 v26, v26, v10
v_add_f32 v26, v26, v11
v_cvt_pk_bf16_f32 v99, v10, v11
v_exp_f32 v12, v44
v_exp_f32 v13, v45
v_exp_f32 v14, v46
v_exp_f32 v15, v47
s_nop 0
v_add_f32 v27, v27, v12
v_add_f32 v27, v27, v13
v_cvt_pk_bf16_f32 v106, v12, v13
v_add_f32 v27, v27, v14
v_add_f32 v27, v27, v15
v_cvt_pk_bf16_f32 v107, v14, v15
v_exp_f32 v8, v48
v_exp_f32 v9, v49
v_exp_f32 v10, v50
v_exp_f32 v11, v51
s_nop 0
v_add_f32 v26, v26, v8
v_add_f32 v26, v26, v9
v_cvt_pk_bf16_f32 v100, v8, v9
v_add_f32 v26, v26, v10
v_add_f32 v26, v26, v11
v_cvt_pk_bf16_f32 v101, v10, v11
v_exp_f32 v12, v52
v_exp_f32 v13, v53
v_exp_f32 v14, v54
v_exp_f32 v15, v55
s_nop 0
v_add_f32 v27, v27, v12
v_add_f32 v27, v27, v13
v_cvt_pk_bf16_f32 v108, v12, v13
v_add_f32 v27, v27, v14
v_add_f32 v27, v27, v15
v_cvt_pk_bf16_f32 v109, v14, v15
v_exp_f32 v8, v56
v_exp_f32 v9, v57
v_exp_f32 v10, v58
v_exp_f32 v11, v59
s_nop 0
v_add_f32 v26, v26, v8
v_add_f32 v26, v26, v9
v_cvt_pk_bf16_f32 v102, v8, v9
v_add_f32 v26, v26, v10
v_add_f32 v26, v26, v11
v_cvt_pk_bf16_f32 v103, v10, v11
v_exp_f32 v12, v60
v_exp_f32 v13, v61
v_exp_f32 v14, v62
v_exp_f32 v15, v63
s_nop 0
v_add_f32 v27, v27, v12
v_add_f32 v27, v27, v13
v_cvt_pk_bf16_f32 v110, v12, v13
v_add_f32 v27, v27, v14
v_add_f32 v27, v27, v15
v_cvt_pk_bf16_f32 v111, v14, v15
s_nop 1
s_setpc_b64 s[16:17]
K2_slow1:
s_nop 7
s_nop 7
v_max3_f32 v8, v64, v65, 0
v_max3_f32 v8, v66, v67, v8
v_max3_f32 v8, v72, v73, v8
v_max3_f32 v8, v74, v75, v8
v_max3_f32 v8, v80, v81, v8
v_max3_f32 v8, v82, v83, v8
v_max3_f32 v8, v88, v89, v8
v_max3_f32 v8, v90, v91, v8
v_mov_b32 v9, v8
s_nop 1
v_permlane16_swap_b32 v8, v9
v_max_f32 v8, v8, v9
v_mov_b32 v9, v8
s_nop 1
v_permlane32_swap_b32 v8, v9
v_max_f32 v8, v8, v9
v_exp_f32 v9, -v8
v_sub_f32 v16, v16, v8
v_sub_f32 v17, v17, v8
v_sub_f32 v18, v18, v8
v_sub_f32 v19, v19, v8
v_mul_f32 v24, v24, v9
v_mul_f32 v128, v128, v9
v_mul_f32 v129, v129, v9
v_mul_f32 v130, v130, v9
v_mul_f32 v131, v131, v9
v_mul_f32 v136, v136, v9
v_mul_f32 v137, v137, v9
v_mul_f32 v138, v138, v9
v_mul_f32 v139, v139, v9
v_mul_f32 v144, v144, v9
v_mul_f32 v145, v145, v9
v_mul_f32 v146, v146, v9
v_mul_f32 v147, v147, v9
v_mul_f32 v152, v152, v9
v_mul_f32 v153, v153, v9
v_mul_f32 v154, v154, v9
v_mul_f32 v155, v155, v9
v_mul_f32 v160, v160, v9
v_mul_f32 v161, v161, v9
v_mul_f32 v162, v162, v9
v_mul_f32 v163, v163, v9
v_mul_f32 v168, v168, v9
v_mul_f32 v169, v169, v9
v_mul_f32 v170, v170, v9
v_mul_f32 v171, v171, v9
v_mul_f32 v176, v176, v9
v_mul_f32 v177, v177, v9
v_mul_f32 v178, v178, v9
v_mul_f32 v179, v179, v9
v_mul_f32 v184, v184, v9
v_mul_f32 v185, v185, v9
v_mul_f32 v186, v186, v9
v_mul_f32 v187, v187, v9
v_mul_f32 v192, v192, v9
v_mul_f32 v193, v193, v9
v_mul_f32 v194, v194, v9
v_mul_f32 v195, v195, v9
v_mul_f32 v200, v200, v9
v_mul_f32 v201, v201, v9
v_mul_f32 v202, v202, v9
v_mul_f32 v203, v203, v9
v_mul_f32 v208, v208, v9
v_mul_f32 v209, v209, v9
v_mul_f32 v210, v210, v9
v_mul_f32 v211, v211, v9
v_mul_f32 v216, v216, v9
v_mul_f32 v217, v217, v9
v_mul_f32 v218, v218, v9
v_mul_f32 v219, v219, v9
v_mul_f32 v224, v224, v9
v_mul_f32 v225, v225, v9
v_mul_f32 v226, v226, v9
v_mul_f32 v227, v227, v9
v_mul_f32 v232, v232, v9
v_mul_f32 v233, v233, v9
v_mul_f32 v234, v234, v9
v_mul_f32 v235, v235, v9
v_mul_f32 v240, v240, v9
v_mul_f32 v241, v241, v9
v_mul_f32 v242, v242, v9
v_mul_f32 v243, v243, v9
v_mul_f32 v248, v248, v9
v_mul_f32 v249, v249, v9
v_mul_f32 v250, v250, v9
v_mul_f32 v251, v251, v9
v_sub_f32 v32, v32, v8
v_sub_f32 v33, v33, v8
v_sub_f32 v34, v34, v8
v_sub_f32 v35, v35, v8
v_sub_f32 v40, v40, v8
v_sub_f32 v41, v41, v8
v_sub_f32 v42, v42, v8
v_sub_f32 v43, v43, v8
v_sub_f32 v48, v48, v8
v_sub_f32 v49, v49, v8
v_sub_f32 v50, v50, v8
v_sub_f32 v51, v51, v8
v_sub_f32 v56, v56, v8
v_sub_f32 v57, v57, v8
v_sub_f32 v58, v58, v8
v_sub_f32 v59, v59, v8
v_sub_f32 v64, v64, v8
v_sub_f32 v65, v65, v8
v_sub_f32 v66, v66, v8
v_sub_f32 v67, v67, v8
v_sub_f32 v72, v72, v8
v_sub_f32 v73, v73, v8
v_sub_f32 v74, v74, v8
v_sub_f32 v75, v75, v8
v_sub_f32 v80, v80, v8
v_sub_f32 v81, v81, v8
v_sub_f32 v82, v82, v8
v_sub_f32 v83, v83, v8
v_sub_f32 v88, v88, v8
v_sub_f32 v89, v89, v8
v_sub_f32 v90, v90, v8
v_sub_f32 v91, v91, v8
v_max3_f32 v8, v68, v69, 0
v_max3_f32 v8, v70, v71, v8
v_max3_f32 v8, v76, v77, v8
v_max3_f32 v8, v78, v79, v8
v_max3_f32 v8, v84, v85, v8
v_max3_f32 v8, v86, v87, v8
v_max3_f32 v8, v92, v93, v8
v_max3_f32 v8, v94, v95, v8
v_mov_b32 v9, v8
s_nop 1
v_permlane16_swap_b32 v8, v9
v_max_f32 v8, v8, v9
v_mov_b32 v9, v8
s_nop 1
v_permlane32_swap_b32 v8, v9
v_max_f32 v8, v8, v9
v_exp_f32 v9, -v8
v_sub_f32 v20, v20, v8
v_sub_f32 v21, v21, v8
v_sub_f32 v22, v22, v8
v_sub_f32 v23, v23, v8
v_mul_f32 v25, v25, v9
v_mul_f32 v132, v132, v9
v_mul_f32 v133, v133, v9
v_mul_f32 v134, v134, v9
v_mul_f32 v135, v135, v9
v_mul_f32 v140, v140, v9
v_mul_f32 v141, v141, v9
v_mul_f32 v142, v142, v9
v_mul_f32 v143, v143, v9
v_mul_f32 v148, v148, v9
v_mul_f32 v149, v149, v9
v_mul_f32 v150, v150, v9
v_mul_f32 v151, v151, v9
v_mul_f32 v156, v156, v9
v_mul_f32 v157, v157, v9
v_mul_f32 v158, v158, v9
v_mul_f32 v159, v159, v9
v_mul_f32 v164, v164, v9
v_mul_f32 v165, v165, v9
v_mul_f32 v166, v166, v9
v_mul_f32 v167, v167, v9
v_mul_f32 v172, v172, v9
v_mul_f32 v173, v173, v9
v_mul_f32 v174, v174, v9
v_mul_f32 v175, v175, v9
v_mul_f32 v180, v180, v9
v_mul_f32 v181, v181, v9
v_mul_f32 v182, v182, v9
v_mul_f32 v183, v183, v9
v_mul_f32 v188, v188, v9
v_mul_f32 v189, v189, v9
v_mul_f32 v190, v190, v9
v_mul_f32 v191, v191, v9
v_mul_f32 v196, v196, v9
v_mul_f32 v197, v197, v9
v_mul_f32 v198, v198, v9
v_mul_f32 v199, v199, v9
v_mul_f32 v204, v204, v9
v_mul_f32 v205, v205, v9
v_mul_f32 v206, v206, v9
v_mul_f32 v207, v207, v9
v_mul_f32 v212, v212, v9
v_mul_f32 v213, v213, v9
v_mul_f32 v214, v214, v9
v_mul_f32 v215, v215, v9
v_mul_f32 v220, v220, v9
v_mul_f32 v221, v221, v9
v_mul_f32 v222, v222, v9
v_mul_f32 v223, v223, v9
v_mul_f32 v228, v228, v9
v_mul_f32 v229, v229, v9
v_mul_f32 v230, v230, v9
v_mul_f32 v231, v231, v9
v_mul_f32 v236, v236, v9
v_mul_f32 v237, v237, v9
v_mul_f32 v238, v238, v9
v_mul_f32 v239, v239, v9
v_mul_f32 v244, v244, v9
v_mul_f32 v245, v245, v9
v_mul_f32 v246, v246, v9
v_mul_f32 v247, v247, v9
v_mul_f32 v252, v252, v9
v_mul_f32 v253, v253, v9
v_mul_f32 v254, v254, v9
v_mul_f32 v255, v255, v9
v_sub_f32 v36, v36, v8
v_sub_f32 v37, v37, v8
v_sub_f32 v38, v38, v8
v_sub_f32 v39, v39, v8
v_sub_f32 v44, v44, v8
v_sub_f32 v45, v45, v8
v_sub_f32 v46, v46, v8
v_sub_f32 v47, v47, v8
v_sub_f32 v52, v52, v8
v_sub_f32 v53, v53, v8
v_sub_f32 v54, v54, v8
v_sub_f32 v55, v55, v8
v_sub_f32 v60, v60, v8
v_sub_f32 v61, v61, v8
v_sub_f32 v62, v62, v8
v_sub_f32 v63, v63, v8
v_sub_f32 v68, v68, v8
v_sub_f32 v69, v69, v8
v_sub_f32 v70, v70, v8
v_sub_f32 v71, v71, v8
v_sub_f32 v76, v76, v8
v_sub_f32 v77, v77, v8
v_sub_f32 v78, v78, v8
v_sub_f32 v79, v79, v8
v_sub_f32 v84, v84, v8
v_sub_f32 v85, v85, v8
v_sub_f32 v86, v86, v8
v_sub_f32 v87, v87, v8
v_sub_f32 v92, v92, v8
v_sub_f32 v93, v93, v8
v_sub_f32 v94, v94, v8
v_sub_f32 v95, v95, v8
v_exp_f32 v8, v64
v_exp_f32 v9, v65
v_exp_f32 v10, v66
v_exp_f32 v11, v67
s_nop 0
v_add_f32 v26, v8, v9
v_cvt_pk_bf16_f32 v112, v8, v9
v_add_f32 v26, v26, v10
v_add_f32 v26, v26, v11
v_cvt_pk_bf16_f32 v113, v10, v11
v_exp_f32 v12, v68
v_exp_f32 v13, v69
v_exp_f32 v14, v70
v_exp_f32 v15, v71
s_nop 0
v_add_f32 v27, v12, v13
v_cvt_pk_bf16_f32 v120, v12, v13
v_add_f32 v27, v27, v14
v_add_f32 v27, v27, v15
v_cvt_pk_bf16_f32 v121, v14, v15
v_exp_f32 v8, v72
v_exp_f32 v9, v73
v_exp_f32 v10, v74
v_exp_f32 v11, v75
s_nop 0
v_add_f32 v26, v26, v8
v_add_f32 v26, v26, v9
v_cvt_pk_bf16_f32 v114, v8, v9
v_add_f32 v26, v26, v10
v_add_f32 v26, v26, v11
v_cvt_pk_bf16_f32 v115, v10, v11
v_exp_f32 v12, v76
v_exp_f32 v13, v77
v_exp_f32 v14, v78
v_exp_f32 v15, v79
s_nop 0
v_add_f32 v27, v27, v12
v_add_f32 v27, v27, v13
v_cvt_pk_bf16_f32 v122, v12, v13
v_add_f32 v27, v27, v14
v_add_f32 v27, v27, v15
v_cvt_pk_bf16_f32 v123, v14, v15
v_exp_f32 v8, v80
v_exp_f32 v9, v81
v_exp_f32 v10, v82
v_exp_f32 v11, v83
s_nop 0
v_add_f32 v26, v26, v8
v_add_f32 v26, v26, v9
v_cvt_pk_bf16_f32 v116, v8, v9
v_add_f32 v26, v26, v10
v_add_f32 v26, v26, v11
v_cvt_pk_bf16_f32 v117, v10, v11
v_exp_f32 v12, v84
v_exp_f32 v13, v85
v_exp_f32 v14, v86
v_exp_f32 v15, v87
s_nop 0
v_add_f32 v27, v27, v12
v_add_f32 v27, v27, v13
v_cvt_pk_bf16_f32 v124, v12, v13
v_add_f32 v27, v27, v14
v_add_f32 v27, v27, v15
v_cvt_pk_bf16_f32 v125, v14, v15
v_exp_f32 v8, v88
v_exp_f32 v9, v89
v_exp_f32 v10, v90
v_exp_f32 v11, v91
s_nop 0
v_add_f32 v26, v26, v8
v_add_f32 v26, v26, v9
v_cvt_pk_bf16_f32 v118, v8, v9
v_add_f32 v26, v26, v10
v_add_f32 v26, v26, v11
v_cvt_pk_bf16_f32 v119, v10, v11
v_exp_f32 v12, v92
v_exp_f32 v13, v93
v_exp_f32 v14, v94
v_exp_f32 v15, v95
s_nop 0
v_add_f32 v27, v27, v12
v_add_f32 v27, v27, v13
v_cvt_pk_bf16_f32 v126, v12, v13
v_add_f32 v27, v27, v14
v_add_f32 v27, v27, v15
v_cvt_pk_bf16_f32 v127, v14, v15
s_nop 1
s_setpc_b64 s[16:17]
K2_slow2:
s_nop 7
s_nop 7
v_max3_f32 v8, v68, v69, 0
v_max3_f32 v8, v70, v71, v8
v_max3_f32 v8, v76, v77, v8
v_max3_f32 v8, v78, v79, v8
v_max3_f32 v8, v84, v85, v8
v_max3_f32 v8, v86, v87, v8
v_max3_f32 v8, v92, v93, v8
v_max3_f32 v8, v94, v95, v8
v_mov_b32 v9, v8
s_nop 1
v_permlane16_swap_b32 v8, v9
v_max_f32 v8, v8, v9
v_mov_b32 v9, v8
s_nop 1
v_permlane32_swap_b32 v8, v9
v_max_f32 v8, v8, v9
v_exp_f32 v9, -v8
v_sub_f32 v20, v20, v8
v_sub_f32 v21, v21, v8
v_sub_f32 v22, v22, v8
v_sub_f32 v23, v23, v8
v_mul_f32 v25, v25, v9
v_mul_f32 v132, v132, v9
v_mul_f32 v133, v133, v9
v_mul_f32 v134, v134, v9
v_mul_f32 v135, v135, v9
v_mul_f32 v140, v140, v9
v_mul_f32 v141, v141, v9
v_mul_f32 v142, v142, v9
v_mul_f32 v143, v143, v9
v_mul_f32 v148, v148, v9
v_mul_f32 v149, v149, v9
v_mul_f32 v150, v150, v9
v_mul_f32 v151, v151, v9
v_mul_f32 v156, v156, v9
v_mul_f32 v157, v157, v9
v_mul_f32 v158, v158, v9
v_mul_f32 v159, v159, v9
v_mul_f32 v164, v164, v9
v_mul_f32 v165, v165, v9
v_mul_f32 v166, v166, v9
v_mul_f32 v167, v167, v9
v_mul_f32 v172, v172, v9
v_mul_f32 v173, v173, v9
v_mul_f32 v174, v174, v9
v_mul_f32 v175, v175, v9
v_mul_f32 v180, v180, v9
v_mul_f32 v181, v181, v9
v_mul_f32 v182, v182, v9
v_mul_f32 v183, v183, v9
v_mul_f32 v188, v188, v9
v_mul_f32 v189, v189, v9
v_mul_f32 v190, v190, v9
v_mul_f32 v191, v191, v9
v_mul_f32 v196, v196, v9
v_mul_f32 v197, v197, v9
v_mul_f32 v198, v198, v9
v_mul_f32 v199, v199, v9
v_mul_f32 v204, v204, v9
v_mul_f32 v205, v205, v9
v_mul_f32 v206, v206, v9
v_mul_f32 v207, v207, v9
v_mul_f32 v212, v212, v9
v_mul_f32 v213, v213, v9
v_mul_f32 v214, v214, v9
v_mul_f32 v215, v215, v9
v_mul_f32 v220, v220, v9
v_mul_f32 v221, v221, v9
v_mul_f32 v222, v222, v9
v_mul_f32 v223, v223, v9
v_mul_f32 v228, v228, v9
v_mul_f32 v229, v229, v9
v_mul_f32 v230, v230, v9
v_mul_f32 v231, v231, v9
v_mul_f32 v236, v236, v9
v_mul_f32 v237, v237, v9
v_mul_f32 v238, v238, v9
v_mul_f32 v239, v239, v9
v_mul_f32 v244, v244, v9
v_mul_f32 v245, v245, v9
v_mul_f32 v246, v246, v9
v_mul_f32 v247, v247, v9
v_mul_f32 v252, v252, v9
v_mul_f32 v253, v253, v9
v_mul_f32 v254, v254, v9
v_mul_f32 v255, v255, v9
v_sub_f32 v68, v68, v8
v_sub_f32 v69, v69, v8
v_sub_f32 v70, v70, v8
v_sub_f32 v71, v71, v8
v_sub_f32 v76, v76, v8
v_sub_f32 v77, v77, v8
v_sub_f32 v78, v78, v8
v_sub_f32 v79, v79, v8
v_sub_f32 v84, v84, v8
v_sub_f32 v85, v85, v8
v_sub_f32 v86, v86, v8
v_sub_f32 v87, v87, v8
v_sub_f32 v92, v92, v8
v_sub_f32 v93, v93, v8
v_sub_f32 v94, v94, v8
v_sub_f32 v95, v95, v8
v_exp_f32 v8, v68
v_exp_f32 v9, v69
v_exp_f32 v10, v70
v_exp_f32 v11, v71
s_nop 0
v_add_f32 v27, v8, v9
v_cvt_pk_bf16_f32 v120, v8, v9
v_add_f32 v27, v27, v10
v_add_f32 v27, v27, v11
v_cvt_pk_bf16_f32 v121, v10, v11
v_exp_f32 v12, v76
v_exp_f32 v13, v77
v_exp_f32 v14, v78
v_exp_f32 v15, v79
s_nop 0
v_add_f32 v27, v27, v12
v_add_f32 v27, v27, v13
v_cvt_pk_bf16_f32 v122, v12, v13
v_add_f32 v27, v27, v14
v_add_f32 v27, v27, v15
v_cvt_pk_bf16_f32 v123, v14, v15
v_exp_f32 v8, v84
v_exp_f32 v9, v85
v_exp_f32 v10, v86
v_exp_f32 v11, v87
s_nop 0
v_add_f32 v27, v27, v8
v_add_f32 v27, v27, v9
v_cvt_pk_bf16_f32 v124, v8, v9
v_add_f32 v27, v27, v10
v_add_f32 v27, v27, v11
v_cvt_pk_bf16_f32 v125, v10, v11
v_exp_f32 v12, v92
v_exp_f32 v13, v93
v_exp_f32 v14, v94
v_exp_f32 v15, v95
s_nop 0
v_add_f32 v27, v27, v12
v_add_f32 v27, v27, v13
v_cvt_pk_bf16_f32 v126, v12, v13
v_add_f32 v27, v27, v14
v_add_f32 v27, v27, v15
v_cvt_pk_bf16_f32 v127, v14, v15
s_nop 1
s_setpc_b64 s[16:17]
M_cntspinK:
Lp_9801:
buffer_load_dword v245, off, s[60:63], s54 sc1
s_waitcnt vmcnt(0)
v_cmp_gt_u32 vcc, s50, v245
s_cbranch_vccz Lpd_9802
s_sleep 8
s_sub_u32 s101, s101, 1
s_cbranch_scc0 Lp_9801
s_mov_b32 s101, 0
Lpd_9802:
s_branch Lg_1
M_cntspinV:
Lp_9803:
buffer_load_dword v245, off, s[60:63], s54 sc1
s_waitcnt vmcnt(0)
v_cmp_gt_u32 vcc, s50, v245
s_cbranch_vccz Lpd_9804
s_sleep 8
s_sub_u32 s101, s101, 1
s_cbranch_scc0 Lp_9803
s_mov_b32 s101, 0
Lpd_9804:
s_branch Lg_501
M_ppspinV:
Lp_9805:
buffer_load_dword v230, v231, s[4:7], s52 offen sc1
s_waitcnt vmcnt(0)
v_cmp_gt_u32 vcc, 1, v230
s_cbranch_vccz Lpd_9806
s_sleep 8
s_sub_u32 s101, s101, 1
s_cbranch_scc0 Lp_9805
s_mov_b32 s101, 0
Lpd_9806:
s_branch M_ppokV
M_end:
s_endpgm
.section .rodata,"a"
.p2align 6
.amdhsa_kernel concat_heads__ssm_conv_h3__compressed_kv_cla__prompt_kernel
  .amdhsa_next_free_vgpr 512
  .amdhsa_next_free_sgpr 102
  .amdhsa_accum_offset 256
  .amdhsa_group_segment_fixed_size 0
  .amdhsa_kernarg_size 120
  .amdhsa_user_sgpr_count 2
  .amdhsa_user_sgpr_kernarg_segment_ptr 1
  .amdhsa_system_sgpr_workgroup_id_x 1
  .amdhsa_float_denorm_mode_32 3
  .amdhsa_float_denorm_mode_16_64 3
  .amdhsa_ieee_mode 0
  .amdhsa_dx10_clamp 0
.end_amdhsa_kernel
```

```asm
; @launch grid=(256,1,1) block=(256,1,1) lds=163840
.amdgcn_target "amdgcn-amd-amdhsa--gfx950"
.text
.globl concat_heads__ssm_conv_h3__compressed_kv_cla__prompt_kernel
.p2align 8
.type concat_heads__ssm_conv_h3__compressed_kv_cla__prompt_kernel,@function
concat_heads__ssm_conv_h3__compressed_kv_cla__prompt_kernel:
s_cmp_ge_u32 s2, 256
s_cbranch_scc1 M_end
s_load_dwordx16 s[64:79], s[0:1], 0
s_load_dwordx8 s[80:87], s[0:1], 64
s_load_dwordx4 s[88:91], s[0:1], 96
s_load_dwordx2 s[92:93], s[0:1], 112
s_getpc_b64 s[58:59]
M_pc:
s_lshr_b32 s22, s2, 3
s_lshl_b32 s22, s22, 5
v_and_b32 v26, 31, v0
v_add_u32 v26, s22, v26
v_lshlrev_b32 v26, 7, v26
v_min_u32 v26, M_end-M_pc, v26
v_mov_b32 v27, s59
v_add_co_u32 v26, vcc, s58, v26
s_nop 1
v_addc_co_u32 v27, vcc, 0, v27, vcc
global_load_dword v21, v[26:27], off
v_lshrrev_b32 v28, 6, v0
v_and_b32 v29, 63, v0
v_lshlrev_b32 v1, 4, v29
v_readfirstlane_b32 s3, v28
s_lshr_b32 s21, s2, 5
v_lshrrev_b32 v26, 7, v1
v_lshrrev_b32 v27, 1, v26
v_lshlrev_b32 v27, 4, v27
v_and_b32 v28, 0x70, v1
v_xor_b32 v27, v27, v28
v_mul_u32_u24 v26, 2048, v26
v_add_u32 v12, v26, v27
v_xor_b32 v27, 64, v27
v_add_u32 v26, v26, v27
v_add_u32 v13, 15360, v26
v_add_u32 v14, 30720, v12
v_add_u32 v15, 46080, v26
s_lshl_b32 s28, s3, 13
s_lshl_b32 s24, s21, 19
s_lshl_b32 s22, s3, 17
s_add_u32 s24, s24, s22
s_add_u32 s25, s24, 65536
s_mov_b32 s10, 4194304
s_mov_b32 s11, 0x20000
s_and_b32 s20, s2, 7
s_lshl_b32 s20, s20, 1
s_bfe_u32 s22, s2, 0x10003
s_add_u32 s20, s20, s22
v_lshrrev_b32 v26, 5, v29
v_and_b32 v27, 31, v29
s_and_b32 s22, s3, 1
s_lshl_b32 s22, s22, 2
v_or_b32 v28, s22, v26
v_lshlrev_b32 v28, 1, v28
v_xor_b32 v27, v27, v28
v_lshlrev_b32 v27, 4, v27
v_lshl_add_u32 v16, v26, 13, v27
v_xor_b32 v26, 64, v16
v_add_u32 v17, 15360, v26
v_add_u32 v18, 30720, v16
v_add_u32 v19, 46080, v26
s_lshl_b32 s29, s3, 12
s_lshl_b32 s26, s3, 16
s_lshl_b32 s22, s20, 9
s_add_u32 s26, s26, s22
s_add_u32 s27, s26, 262144
s_mov_b32 s14, 8388608
s_mov_b32 s15, 0x20000
s_mov_b32 s101, 0x40000
v_and_b32 v30, 15, v29
v_lshrrev_b32 v31, 4, v29
v_lshrrev_b32 v26, 1, v30
v_xor_b32 v26, v31, v26
v_lshlrev_b32 v26, 4, v26
v_lshl_add_u32 v2, v30, 7, v26
s_lshr_b32 s22, s3, 1
s_lshl_b32 s22, s22, 14
v_add_u32 v2, s22, v2
v_xor_b32 v3, 64, v2
v_lshrrev_b32 v26, 2, v30
v_and_b32 v27, 1, v31
v_lshl_or_b32 v27, v27, 2, v26
v_lshl_add_u32 v26, v31, 3, v26
v_lshlrev_b32 v26, 9, v26
v_lshl_add_u32 v26, v27, 5, v26
v_and_b32 v27, 3, v29
v_lshl_add_u32 v26, v27, 3, v26
s_and_b32 s22, s3, 1
s_lshl_b32 s22, s22, 8
s_add_u32 s22, s22, 0x10000
v_xor_b32 v4, s22, v26
v_xor_b32 v5, 32, v4
v_xor_b32 v6, 64, v4
v_xor_b32 v7, 96, v4
v_xor_b32 v8, 128, v4
v_xor_b32 v9, 160, v4
v_xor_b32 v10, 192, v4
v_xor_b32 v11, 224, v4
s_mov_b32 s19, 0x20000
s_cmp_eq_u32 s3, 2
s_cbranch_scc1 M_pf2
s_cmp_lg_u32 s3, 0
s_cbranch_scc1 M_pf3
s_mov_b32 s18, 8388608
s_mov_b32 s51, 8388608
s_mov_b32 s47, 524288
s_mov_b32 s43, 524288
s_lshl_b32 s22, s21, 16
s_lshl_b32 s23, s20, 9
s_add_u32 s22, s22, s23
v_bfe_u32 v26, v29, 2, 3
v_lshl_add_u32 v26, v26, 13, s22
v_and_b32 v27, 3, v29
v_lshl_add_u32 v20, v27, 7, v26
v_lshrrev_b32 v27, 5, v29
v_lshl_add_u32 v22, v27, 19, v20
s_mov_b32 s47, 655360
s_mov_b32 s43, 262144
v_add_u32 v22, 262144, v22
s_mul_i32 s22, s21, 81920
s_add_u32 s22, s22, s23
v_lshrrev_b32 v26, 2, v29
v_lshl_add_u32 v26, v26, 13, s22
v_and_b32 v27, 3, v29
v_lshl_add_u32 v20, v27, 7, v26
v_cmp_gt_u32 vcc, 40, v29
s_branch M_pfd
M_pf2:
s_mov_b32 s18, 4194304
s_mov_b32 s51, 2048
s_mov_b32 s47, 256
s_mov_b32 s43, 0
s_lshl_b32 s22, s2, 14
v_bfe_u32 v26, v29, 1, 3
v_lshl_add_u32 v26, v26, 11, s22
v_and_b32 v27, 1, v29
v_lshl_add_u32 v20, v27, 7, v26
v_bfe_u32 v27, v29, 4, 1
v_lshl_add_u32 v22, v27, 8, v20
v_cmp_gt_u32 vcc, 16, v29
s_branch M_pfd
M_pf3:
s_mov_b32 s18, 0
s_mov_b32 s51, 2752512
s_mov_b32 s47, 688128
s_mov_b32 s43, 0
s_mul_i32 s22, s2, 2688
v_lshl_add_u32 v20, v29, 7, s22
v_mov_b32 v22, v20
v_cmp_gt_u32 vcc, 21, v29
M_pfd:
v_mov_b32 v26, 3221225472
s_nop 0
v_cndmask_b32 v20, v26, v20, vcc
s_bitcmp1_b32 s2, 4
s_waitcnt lgkmcnt(0)
s_mov_b64 s[8:9], s[78:79]
s_cselect_b64 s[12:13], s[84:85], s[82:83]
s_add_u32 m0, s28, 0
s_nop 0
buffer_load_dwordx4 v12, s[8:11], s24 offen offset:0 lds
buffer_load_dwordx4 v13, s[8:11], s24 offen offset:1024 lds
buffer_load_dwordx4 v14, s[8:11], s24 offen offset:2048 lds
buffer_load_dwordx4 v15, s[8:11], s24 offen offset:3072 lds
s_add_u32 s24, s24, 128
s_add_u32 m0, s28, 4096
s_nop 0
buffer_load_dwordx4 v12, s[8:11], s25 offen offset:0 lds
buffer_load_dwordx4 v13, s[8:11], s25 offen offset:1024 lds
buffer_load_dwordx4 v14, s[8:11], s25 offen offset:2048 lds
buffer_load_dwordx4 v15, s[8:11], s25 offen offset:3072 lds
s_add_u32 s25, s25, 128
s_add_u32 m0, s29, 65536
s_nop 0
buffer_load_dwordx4 v16, s[12:15], s26 offen offset:0 lds
buffer_load_dwordx4 v17, s[12:15], s26 offen offset:1024 lds
buffer_load_dwordx4 v18, s[12:15], s26 offen offset:2048 lds
buffer_load_dwordx4 v19, s[12:15], s26 offen offset:3072 lds
s_add_u32 s26, s26, 524288
s_add_u32 m0, s29, 81920
s_nop 0
buffer_load_dwordx4 v16, s[12:15], s27 offen offset:0 lds
buffer_load_dwordx4 v17, s[12:15], s27 offen offset:1024 lds
buffer_load_dwordx4 v18, s[12:15], s27 offen offset:2048 lds
buffer_load_dwordx4 v19, s[12:15], s27 offen offset:3072 lds
s_add_u32 s27, s27, 524288
s_mov_b64 exec, 0
s_bfe_u32 s22, s2, 0x10004
s_lshl_b32 s22, s22, 2
s_add_u32 s22, s22, s3
s_cmp_lg_u32 s22, 0
s_cbranch_scc1 M_tw1
s_call_b64 s[98:99], PAD_0
s_call_b64 s[98:99], PAD_8
s_branch M_td
M_tw1:
s_cmp_lg_u32 s22, 1
s_cbranch_scc1 M_tw2
s_call_b64 s[98:99], PAD_1
s_call_b64 s[98:99], PAD_9
s_branch M_td
M_tw2:
s_cmp_lg_u32 s22, 2
s_cbranch_scc1 M_tw3
s_call_b64 s[98:99], PAD_2
s_call_b64 s[98:99], PAD_6
s_call_b64 s[98:99], PAD_10
s_branch M_td
M_tw3:
s_cmp_lg_u32 s22, 3
s_cbranch_scc1 M_tw4
s_call_b64 s[98:99], PAD_3
s_call_b64 s[98:99], PAD_7
s_call_b64 s[98:99], PAD_11
s_branch M_td
M_tw4:
s_cmp_lg_u32 s22, 4
s_cbranch_scc1 M_tw5
s_call_b64 s[98:99], PAD_22
s_branch M_td
M_tw5:
s_cmp_lg_u32 s22, 5
s_cbranch_scc1 M_tw6
s_call_b64 s[98:99], PAD_23
s_branch M_td
M_tw6:
s_cmp_lg_u32 s22, 6
s_cbranch_scc1 M_tw7
s_call_b64 s[98:99], PAD_24
s_branch M_td
M_tw7:
s_call_b64 s[98:99], PAD_21
M_td:
s_mov_b64 exec, -1
s_add_u32 m0, s28, 32768
s_nop 0
buffer_load_dwordx4 v12, s[8:11], s24 offen offset:0 lds
buffer_load_dwordx4 v13, s[8:11], s24 offen offset:1024 lds
buffer_load_dwordx4 v14, s[8:11], s24 offen offset:2048 lds
buffer_load_dwordx4 v15, s[8:11], s24 offen offset:3072 lds
s_add_u32 s24, s24, 128
s_add_u32 m0, s28, 36864
s_nop 0
buffer_load_dwordx4 v12, s[8:11], s25 offen offset:0 lds
buffer_load_dwordx4 v13, s[8:11], s25 offen offset:1024 lds
buffer_load_dwordx4 v14, s[8:11], s25 offen offset:2048 lds
buffer_load_dwordx4 v15, s[8:11], s25 offen offset:3072 lds
s_add_u32 s25, s25, 128
s_cmp_eq_u32 s3, 0
s_cselect_b64 s[16:17], s[12:13], s[8:9]
buffer_load_dword v21, v22, s[16:19], s43 offen
s_add_u32 s43, s43, s47
s_add_u32 s43, s43, s47
s_mov_b32 s4, s92
s_mov_b32 s5, s93
s_mov_b32 s6, 268435456
s_mov_b32 s7, 0x20000
s_cmp_eq_u32 s3, 3
s_cselect_b64 s[40:41], s[76:77], s[80:81]
s_cselect_b32 s42, 1835008, 0
s_cmp_eq_u32 s3, 1
s_cselect_b32 s42, 3670016, s42
s_cmp_eq_u32 s3, 3
s_cselect_b64 s[44:45], s[86:87], s[72:73]
s_cselect_b32 s46, 3670016, 0
s_cmp_eq_u32 s3, 1
s_cselect_b32 s46, 1835008, s46
s_cmp_eq_u32 s3, 2
s_cselect_b64 s[40:41], s[64:65], s[40:41]
s_cselect_b32 s42, 1835008, s42
s_waitcnt vmcnt(17)
s_barrier
ds_read_b128 a[0:3], v2 offset:0
ds_read_b128 a[4:7], v3 offset:0
ds_read_b128 a[8:11], v2 offset:2048
ds_read_b128 a[12:15], v3 offset:2048
ds_read_b128 a[16:19], v2 offset:4096
ds_read_b128 a[20:23], v3 offset:4096
ds_read_b128 a[24:27], v2 offset:6144
ds_read_b128 a[28:31], v3 offset:6144
ds_read_b128 a[32:35], v2 offset:8192
ds_read_b128 a[36:39], v3 offset:8192
ds_read_b128 a[40:43], v2 offset:10240
ds_read_b128 a[44:47], v3 offset:10240
ds_read_b128 a[48:51], v2 offset:12288
ds_read_b128 a[52:55], v3 offset:12288
ds_read_b128 a[56:59], v2 offset:14336
ds_read_b128 a[60:63], v3 offset:14336
s_waitcnt vmcnt(9) lgkmcnt(0)
s_barrier
ds_read_b64_tr_b16 a[128:129], v4 offset:0
ds_read_b64_tr_b16 a[130:131], v4 offset:2048
ds_read_b64_tr_b16 a[132:133], v4 offset:16384
ds_read_b64_tr_b16 a[134:135], v4 offset:18432
s_waitcnt lgkmcnt(0)
s_bitcmp1_b32 s2, 4
s_cbranch_scc1 M_V
s_branch M_K
M_t2B:
s_mov_b64 exec, 0
s_cmp_lg_u32 s3, 0
s_cbranch_scc1 M_uw1
s_call_b64 s[98:99], PAD_32
s_call_b64 s[98:99], PAD_16
s_branch M_ud
M_uw1:
s_cmp_lg_u32 s3, 1
s_cbranch_scc1 M_uw2
s_call_b64 s[98:99], PAD_9
s_call_b64 s[98:99], PAD_33
s_call_b64 s[98:99], PAD_13
s_branch M_ud
M_uw2:
s_cmp_lg_u32 s3, 2
s_cbranch_scc1 M_uw3
s_call_b64 s[98:99], PAD_10
s_call_b64 s[98:99], PAD_34
s_call_b64 s[98:99], PAD_14
s_branch M_ud
M_uw3:
s_call_b64 s[98:99], PAD_11
s_call_b64 s[98:99], PAD_15
M_ud:
s_mov_b64 exec, -1
s_branch M_t2Br
M_t2A:
s_mov_b64 exec, 0
s_lshl_b32 s22, s24, 2
s_add_u32 s22, s22, s3
s_cmp_lg_u32 s22, 0
s_cbranch_scc1 M_vw1
s_call_b64 s[98:99], PAD_32
s_call_b64 s[98:99], PAD_16
s_branch M_vd
M_vw1:
s_cmp_lg_u32 s22, 1
s_cbranch_scc1 M_vw2
s_call_b64 s[98:99], PAD_13
s_branch M_vd
M_vw2:
s_cmp_lg_u32 s22, 2
s_cbranch_scc1 M_vw3
s_call_b64 s[98:99], PAD_14
s_call_b64 s[98:99], PAD_19
s_branch M_vd
M_vw3:
s_cmp_lg_u32 s22, 3
s_cbranch_scc1 M_vw4
s_call_b64 s[98:99], PAD_15
s_call_b64 s[98:99], PAD_20
s_branch M_vd
M_vw4:
s_cmp_lg_u32 s22, 4
s_cbranch_scc1 M_vw5
s_call_b64 s[98:99], PAD_12
s_call_b64 s[98:99], PAD_16
s_branch M_vd
M_vw5:
s_cmp_lg_u32 s22, 5
s_cbranch_scc1 M_vw6
s_call_b64 s[98:99], PAD_13
s_branch M_vd
M_vw6:
s_cmp_lg_u32 s22, 6
s_cbranch_scc1 M_vw7
s_call_b64 s[98:99], PAD_14
s_branch M_vd
M_vw7:
s_call_b64 s[98:99], PAD_15
M_vd:
s_mov_b64 exec, -1
s_branch M_t2Ar
M_tret:
s_setpc_b64 s[98:99]
.p2align 12
PAD_0:
s_cbranch_execz PAD_4
M_K:
v_mfma_f32_16x16x32_bf16 v[32:35], a[128:131], a[0:3], 0
s_add_u32 m0, s29, 98304
ds_read_b64_tr_b16 a[136:137], v5 offset:0
v_mfma_f32_16x16x32_bf16 v[32:35], a[132:135], a[4:7], v[32:35]
s_mov_b32 s32, 8192
buffer_load_dwordx4 v16, s[12:15], s26 offen offset:0 lds
v_mfma_f32_16x16x32_bf16 v[40:43], a[128:131], a[8:11], 0
s_mov_b32 s33, 8192
ds_read_b64_tr_b16 a[138:139], v5 offset:2048
v_mfma_f32_16x16x32_bf16 v[40:43], a[132:135], a[12:15], v[40:43]
s_mov_b32 s34, 8192
v_mfma_f32_16x16x32_bf16 v[48:51], a[128:131], a[16:19], 0
s_mov_b32 s35, 4294910976
ds_read_b64_tr_b16 a[140:141], v5 offset:16384
v_mfma_f32_16x16x32_bf16 v[48:51], a[132:135], a[20:23], v[48:51]
s_mov_b32 s36, 4294910976
buffer_load_dwordx4 v17, s[12:15], s26 offen offset:1024 lds
v_mfma_f32_16x16x32_bf16 v[56:59], a[128:131], a[24:27], 0
s_mov_b32 s30, 8
ds_read_b64_tr_b16 a[142:143], v5 offset:18432
v_mfma_f32_16x16x32_bf16 v[56:59], a[132:135], a[28:31], v[56:59]
s_mov_b32 s82, 3221225472
v_mfma_f32_16x16x32_bf16 v[64:67], a[128:131], a[32:35], 0
s_mul_hi_u32 s38, s2, 613566757
v_mfma_f32_16x16x32_bf16 v[64:67], a[132:135], a[36:39], v[64:67]
s_mul_i32 s39, s38, 7
buffer_load_dwordx4 v18, s[12:15], s26 offen offset:2048 lds
v_mfma_f32_16x16x32_bf16 v[72:75], a[128:131], a[40:43], 0
s_sub_u32 s39, s2, s39
v_mov_b32 v246, 0
v_mov_b32 v229, 0
v_mfma_f32_16x16x32_bf16 v[72:75], a[132:135], a[44:47], v[72:75]
v_mov_b32 v231, 0
v_mfma_f32_16x16x32_bf16 v[80:83], a[128:131], a[48:51], 0
s_mov_b32 s60, s90
v_mfma_f32_16x16x32_bf16 v[80:83], a[132:135], a[52:55], v[80:83]
s_mov_b32 s61, s91
buffer_load_dwordx4 v19, s[12:15], s26 offen offset:3072 lds
v_mfma_f32_16x16x32_bf16 v[88:91], a[128:131], a[56:59], 0
s_add_u32 s26, s26, 524288
v_mfma_f32_16x16x32_bf16 v[88:91], a[132:135], a[60:63], v[88:91]
s_waitcnt lgkmcnt(0)
s_mov_b32 s62, 256
v_mfma_f32_16x16x32_bf16 v[36:39], a[136:139], a[0:3], 0
s_add_u32 m0, s29, 114688
ds_read_b64_tr_b16 a[128:129], v6 offset:0
v_mfma_f32_16x16x32_bf16 v[36:39], a[140:143], a[4:7], v[36:39]
s_mov_b32 s63, 0x20000
buffer_load_dwordx4 v16, s[12:15], s27 offen offset:0 lds
v_mfma_f32_16x16x32_bf16 v[44:47], a[136:139], a[8:11], 0
s_mul_hi_u32 s55, s2, 1431655766
ds_read_b64_tr_b16 a[130:131], v6 offset:2048
v_mfma_f32_16x16x32_bf16 v[44:47], a[140:143], a[12:15], v[44:47]
s_mul_i32 s55, s55, 3
v_mfma_f32_16x16x32_bf16 v[52:55], a[136:139], a[16:19], 0
s_sub_u32 s55, s2, s55
ds_read_b64_tr_b16 a[132:133], v6 offset:16384
v_mfma_f32_16x16x32_bf16 v[52:55], a[140:143], a[20:23], v[52:55]
s_add_u32 s55, s55, 5
buffer_load_dwordx4 v17, s[12:15], s27 offen offset:1024 lds
v_mfma_f32_16x16x32_bf16 v[60:63], a[136:139], a[24:27], 0
s_lshr_b32 s22, s2, 4
ds_read_b64_tr_b16 a[134:135], v6 offset:18432
v_mfma_f32_16x16x32_bf16 v[60:63], a[140:143], a[28:31], v[60:63]
s_lshl_b32 s23, s20, 5
v_mfma_f32_16x16x32_bf16 v[68:71], a[136:139], a[32:35], 0
s_add_u32 s23, s23, s22
v_mfma_f32_16x16x32_bf16 v[68:71], a[140:143], a[36:39], v[68:71]
s_lshl_b32 s23, s23, 2
buffer_load_dwordx4 v18, s[12:15], s27 offen offset:2048 lds
v_mfma_f32_16x16x32_bf16 v[76:79], a[136:139], a[40:43], 0
s_and_b32 s22, s2, 16
v_mfma_f32_16x16x32_bf16 v[76:79], a[140:143], a[44:47], v[76:79]
s_lshl_b32 s22, s22, 7
v_mfma_f32_16x16x32_bf16 v[84:87], a[136:139], a[48:51], 0
s_add_u32 s23, s23, s22
v_mov_b32 v28, 3221225472
v_writelane_b32 v28, s23, 0
v_mfma_f32_16x16x32_bf16 v[84:87], a[140:143], a[52:55], v[84:87]
s_add_u32 s56, s23, 16384
buffer_load_dwordx4 v19, s[12:15], s27 offen offset:3072 lds
v_mfma_f32_16x16x32_bf16 v[92:95], a[136:139], a[56:59], 0
s_add_u32 s27, s27, 524288
v_writelane_b32 v28, s56, 1
v_mfma_f32_16x16x32_bf16 v[92:95], a[140:143], a[60:63], v[92:95]
s_waitcnt lgkmcnt(0)
s_add_u32 s56, s23, 4096
v_writelane_b32 v28, s56, 2
v_mfma_f32_16x16x32_bf16 v[96:99], a[128:131], a[0:3], 0
s_add_u32 m0, s28, 0
ds_read_b64_tr_b16 a[136:137], v7 offset:0
v_mfma_f32_16x16x32_bf16 v[96:99], a[132:135], a[4:7], v[96:99]
s_sub_u32 s37, 15, s21
buffer_load_dwordx4 v12, s[8:11], s24 offen offset:0 lds
v_mfma_f32_16x16x32_bf16 v[104:107], a[128:131], a[8:11], 0
ds_read_b64_tr_b16 a[138:139], v7 offset:2048
v_mfma_f32_16x16x32_bf16 v[104:107], a[132:135], a[12:15], v[104:107]
v_mfma_f32_16x16x32_bf16 v[112:115], a[128:131], a[16:19], 0
ds_read_b64_tr_b16 a[140:141], v7 offset:16384
v_mfma_f32_16x16x32_bf16 v[112:115], a[132:135], a[20:23], v[112:115]
buffer_load_dwordx4 v13, s[8:11], s24 offen offset:1024 lds
v_mfma_f32_16x16x32_bf16 v[120:123], a[128:131], a[24:27], 0
ds_read_b64_tr_b16 a[142:143], v7 offset:18432
v_mfma_f32_16x16x32_bf16 v[120:123], a[132:135], a[28:31], v[120:123]
v_mfma_f32_16x16x32_bf16 v[128:131], a[128:131], a[32:35], 0
v_mfma_f32_16x16x32_bf16 v[128:131], a[132:135], a[36:39], v[128:131]
buffer_load_dwordx4 v14, s[8:11], s24 offen offset:2048 lds
v_mfma_f32_16x16x32_bf16 v[136:139], a[128:131], a[40:43], 0
v_mfma_f32_16x16x32_bf16 v[136:139], a[132:135], a[44:47], v[136:139]
v_mfma_f32_16x16x32_bf16 v[144:147], a[128:131], a[48:51], 0
v_mfma_f32_16x16x32_bf16 v[144:147], a[132:135], a[52:55], v[144:147]
buffer_load_dwordx4 v15, s[8:11], s24 offen offset:3072 lds
v_mfma_f32_16x16x32_bf16 v[152:155], a[128:131], a[56:59], 0
s_add_u32 s24, s24, 128
v_mfma_f32_16x16x32_bf16 v[152:155], a[132:135], a[60:63], v[152:155]
s_waitcnt vmcnt(13) lgkmcnt(0)
s_barrier
v_mfma_f32_16x16x32_bf16 v[100:103], a[136:139], a[0:3], 0
s_add_u32 m0, s28, 4096
ds_read_b64_tr_b16 a[128:129], v8 offset:0
v_mfma_f32_16x16x32_bf16 v[100:103], a[140:143], a[4:7], v[100:103]
buffer_load_dwordx4 v12, s[8:11], s25 offen offset:0 lds
v_mfma_f32_16x16x32_bf16 v[108:111], a[136:139], a[8:11], 0
ds_read_b64_tr_b16 a[130:131], v8 offset:2048
v_mfma_f32_16x16x32_bf16 v[108:111], a[140:143], a[12:15], v[108:111]
v_mfma_f32_16x16x32_bf16 v[116:119], a[136:139], a[16:19], 0
ds_read_b64_tr_b16 a[132:133], v8 offset:16384
v_mfma_f32_16x16x32_bf16 v[116:119], a[140:143], a[20:23], v[116:119]
buffer_load_dwordx4 v13, s[8:11], s25 offen offset:1024 lds
v_mfma_f32_16x16x32_bf16 v[124:127], a[136:139], a[24:27], 0
ds_read_b64_tr_b16 a[134:135], v8 offset:18432
v_mfma_f32_16x16x32_bf16 v[124:127], a[140:143], a[28:31], v[124:127]
v_mfma_f32_16x16x32_bf16 v[132:135], a[136:139], a[32:35], 0
ds_read_b128 a[64:67], v2 offset:32768
v_mfma_f32_16x16x32_bf16 v[132:135], a[140:143], a[36:39], v[132:135]
buffer_load_dwordx4 v14, s[8:11], s25 offen offset:2048 lds
v_mfma_f32_16x16x32_bf16 v[140:143], a[136:139], a[40:43], 0
ds_read_b128 a[68:71], v3 offset:32768
v_mfma_f32_16x16x32_bf16 v[140:143], a[140:143], a[44:47], v[140:143]
ds_read_b128 a[72:75], v2 offset:34816
v_mfma_f32_16x16x32_bf16 v[148:151], a[136:139], a[48:51], 0
ds_read_b128 a[76:79], v3 offset:34816
v_mfma_f32_16x16x32_bf16 v[148:151], a[140:143], a[52:55], v[148:151]
buffer_load_dwordx4 v15, s[8:11], s25 offen offset:3072 lds
v_mfma_f32_16x16x32_bf16 v[156:159], a[136:139], a[56:59], 0
s_add_u32 s25, s25, 128
ds_read_b128 a[80:83], v2 offset:36864
v_mfma_f32_16x16x32_bf16 v[156:159], a[140:143], a[60:63], v[156:159]
s_waitcnt lgkmcnt(5)
ds_read_b128 a[84:87], v3 offset:36864
v_mfma_f32_16x16x32_bf16 v[160:163], a[128:131], a[0:3], 0
ds_read_b64_tr_b16 a[136:137], v9 offset:0
v_mfma_f32_16x16x32_bf16 v[160:163], a[132:135], a[4:7], v[160:163]
buffer_load_dword v21, v20, s[16:19], s43 offen
v_mfma_f32_16x16x32_bf16 v[168:171], a[128:131], a[8:11], 0
s_add_u32 s43, s43, s47
ds_read_b64_tr_b16 a[138:139], v9 offset:2048
v_mfma_f32_16x16x32_bf16 v[168:171], a[132:135], a[12:15], v[168:171]
s_cmp_ge_u32 s43, s51
v_mfma_f32_16x16x32_bf16 v[176:179], a[128:131], a[16:19], 0
s_cselect_b32 s43, 0, s43
ds_read_b64_tr_b16 a[140:141], v9 offset:16384
v_mfma_f32_16x16x32_bf16 v[176:179], a[132:135], a[20:23], v[176:179]
s_cselect_b32 s51, s42, s51
v_mfma_f32_16x16x32_bf16 v[184:187], a[128:131], a[24:27], 0
s_cselect_b64 s[16:17], s[40:41], s[16:17]
ds_read_b64_tr_b16 a[142:143], v9 offset:18432
v_mfma_f32_16x16x32_bf16 v[184:187], a[132:135], a[28:31], v[184:187]
s_cselect_b32 s18, s42, s18
v_mfma_f32_16x16x32_bf16 v[192:195], a[128:131], a[32:35], 0
s_cselect_b64 s[40:41], s[44:45], s[40:41]
v_mfma_f32_16x16x32_bf16 v[192:195], a[132:135], a[36:39], v[192:195]
s_cselect_b32 s42, s46, s42
v_mfma_f32_16x16x32_bf16 v[200:203], a[128:131], a[40:43], 0
s_waitcnt lgkmcnt(2)
s_cselect_b32 s46, 0, s46
ds_read_b128 a[88:91], v2 offset:38912
v_mfma_f32_16x16x32_bf16 v[200:203], a[132:135], a[44:47], v[200:203]
s_bitcmp1_b32 s2, 4
s_cselect_b32 s37, s21, s37
ds_read_b128 a[92:95], v3 offset:38912
v_mfma_f32_16x16x32_bf16 v[208:211], a[128:131], a[48:51], 0
s_lshl_b32 s56, s37, 5
s_add_u32 s56, s56, s20
ds_read_b128 a[96:99], v2 offset:40960
v_mfma_f32_16x16x32_bf16 v[208:211], a[132:135], a[52:55], v[208:211]
s_lshl_b32 s56, s56, 2
s_add_u32 s56, s56, 8192
v_writelane_b32 v28, s56, 3
v_mfma_f32_16x16x32_bf16 v[216:219], a[128:131], a[56:59], 0
s_add_u32 s56, s56, 2048
ds_read_b128 a[100:103], v3 offset:40960
v_writelane_b32 v28, s56, 6
v_mfma_f32_16x16x32_bf16 v[216:219], a[132:135], a[60:63], v[216:219]
s_add_u32 s56, s56, 4096
ds_read_b128 a[104:107], v2 offset:43008
v_writelane_b32 v28, s56, 5
v_mfma_f32_16x16x32_bf16 v[164:167], a[136:139], a[0:3], 0
s_waitcnt lgkmcnt(5)
s_lshl_b32 s56, s2, 2
s_add_u32 s56, s56, 12288
ds_read_b64_tr_b16 a[128:129], v10 offset:0
v_mfma_f32_16x16x32_bf16 v[164:167], a[140:143], a[4:7], v[164:167]
v_writelane_b32 v28, s56, 4
v_mfma_f32_16x16x32_bf16 v[172:175], a[136:139], a[8:11], 0
s_lshl_b32 s56, s39, 5
s_add_u32 s56, s56, s38
ds_read_b64_tr_b16 a[130:131], v10 offset:2048
v_mfma_f32_16x16x32_bf16 v[172:175], a[140:143], a[12:15], v[172:175]
s_lshl_b32 s56, s56, 2
s_add_u32 s56, s56, 20480
s_cmp_lt_u32 s2, 224
v_mfma_f32_16x16x32_bf16 v[180:183], a[136:139], a[16:19], 0
s_cselect_b32 s56, s56, 3221225472
ds_read_b64_tr_b16 a[132:133], v10 offset:16384
v_writelane_b32 v28, s56, 7
v_mfma_f32_16x16x32_bf16 v[180:183], a[140:143], a[20:23], v[180:183]
s_cmp_eq_u32 s3, 0
s_cselect_b32 s56, 94371840, 3221225472
v_mfma_f32_16x16x32_bf16 v[188:191], a[136:139], a[24:27], 0
ds_read_b64_tr_b16 a[134:135], v10 offset:18432
v_mfma_f32_16x16x32_bf16 v[188:191], a[140:143], a[28:31], v[188:191]
buffer_store_dword v246, v28, s[4:7], s56 offen sc1
v_mfma_f32_16x16x32_bf16 v[196:199], a[136:139], a[32:35], 0
v_mov_b32 v27, 1
v_cmp_eq_u32 vcc, 0, v0
v_mfma_f32_16x16x32_bf16 v[196:199], a[140:143], a[36:39], v[196:199]
v_mov_b32 v26, 3221225472
v_mfma_f32_16x16x32_bf16 v[204:207], a[136:139], a[40:43], 0
s_lshl_b32 s31, s20, 20
s_lshl_b32 s22, s21, 17
ds_read_b128 a[108:111], v3 offset:43008
v_mfma_f32_16x16x32_bf16 v[204:207], a[140:143], a[44:47], v[204:207]
ds_read_b128 a[112:115], v2 offset:45056
v_cndmask_b32 v26, v26, v246, vcc
v_mfma_f32_16x16x32_bf16 v[212:215], a[136:139], a[48:51], 0
s_add_u32 s31, s31, s22
s_lshr_b32 s22, s3, 1
ds_read_b128 a[116:119], v3 offset:45056
v_mfma_f32_16x16x32_bf16 v[212:215], a[140:143], a[52:55], v[212:215]
s_lshl_b32 s22, s22, 16
s_add_u32 s31, s31, s22
s_and_b32 s22, s3, 1
v_mfma_f32_16x16x32_bf16 v[220:223], a[136:139], a[56:59], 0
s_lshl_b32 s22, s22, 12
s_add_u32 s31, s31, s22
ds_read_b128 a[120:123], v2 offset:47104
v_mfma_f32_16x16x32_bf16 v[220:223], a[140:143], a[60:63], v[220:223]
s_waitcnt lgkmcnt(4)
ds_read_b128 a[124:127], v3 offset:47104
v_mfma_f32_16x16x32_bf16 a[192:195], a[128:131], a[0:3], 0
ds_read_b64_tr_b16 a[136:137], v11 offset:0
v_mfma_f32_16x16x32_bf16 a[192:195], a[132:135], a[4:7], a[192:195]
v_mfma_f32_16x16x32_bf16 a[200:203], a[128:131], a[8:11], 0
ds_read_b64_tr_b16 a[138:139], v11 offset:2048
v_mfma_f32_16x16x32_bf16 a[200:203], a[132:135], a[12:15], a[200:203]
v_mfma_f32_16x16x32_bf16 a[208:211], a[128:131], a[16:19], 0
ds_read_b64_tr_b16 a[140:141], v11 offset:16384
v_mfma_f32_16x16x32_bf16 a[208:211], a[132:135], a[20:23], a[208:211]
v_mfma_f32_16x16x32_bf16 a[216:219], a[128:131], a[24:27], 0
ds_read_b64_tr_b16 a[142:143], v11 offset:18432
v_mfma_f32_16x16x32_bf16 a[216:219], a[132:135], a[28:31], a[216:219]
v_mfma_f32_16x16x32_bf16 a[224:227], a[128:131], a[32:35], 0
v_mfma_f32_16x16x32_bf16 a[224:227], a[132:135], a[36:39], a[224:227]
v_mfma_f32_16x16x32_bf16 a[232:235], a[128:131], a[40:43], 0
v_mfma_f32_16x16x32_bf16 a[232:235], a[132:135], a[44:47], a[232:235]
v_mfma_f32_16x16x32_bf16 a[240:243], a[128:131], a[48:51], 0
v_mfma_f32_16x16x32_bf16 a[240:243], a[132:135], a[52:55], a[240:243]
v_mfma_f32_16x16x32_bf16 a[248:251], a[128:131], a[56:59], 0
s_waitcnt vmcnt(2) lgkmcnt(0)
v_mfma_f32_16x16x32_bf16 a[248:251], a[132:135], a[60:63], a[248:251]
s_barrier
v_mfma_f32_16x16x32_bf16 a[196:199], a[136:139], a[0:3], 0
s_add_u32 m0, s29, 65536
ds_read_b64_tr_b16 a[128:129], v4 offset:32768
v_mfma_f32_16x16x32_bf16 a[196:199], a[140:143], a[4:7], a[196:199]
buffer_load_dwordx4 v16, s[12:15], s26 offen offset:0 lds
v_mfma_f32_16x16x32_bf16 a[204:207], a[136:139], a[8:11], 0
ds_read_b64_tr_b16 a[130:131], v4 offset:34816
v_mfma_f32_16x16x32_bf16 a[204:207], a[140:143], a[12:15], a[204:207]
v_mfma_f32_16x16x32_bf16 a[212:215], a[136:139], a[16:19], 0
ds_read_b64_tr_b16 a[132:133], v4 offset:49152
v_mfma_f32_16x16x32_bf16 a[212:215], a[140:143], a[20:23], a[212:215]
buffer_load_dwordx4 v17, s[12:15], s26 offen offset:1024 lds
v_mfma_f32_16x16x32_bf16 a[220:223], a[136:139], a[24:27], 0
ds_read_b64_tr_b16 a[134:135], v4 offset:51200
v_mfma_f32_16x16x32_bf16 a[220:223], a[140:143], a[28:31], a[220:223]
v_mfma_f32_16x16x32_bf16 a[228:231], a[136:139], a[32:35], 0
v_mfma_f32_16x16x32_bf16 a[228:231], a[140:143], a[36:39], a[228:231]
buffer_load_dwordx4 v18, s[12:15], s26 offen offset:2048 lds
v_mfma_f32_16x16x32_bf16 a[236:239], a[136:139], a[40:43], 0
v_mfma_f32_16x16x32_bf16 a[236:239], a[140:143], a[44:47], a[236:239]
v_mfma_f32_16x16x32_bf16 a[244:247], a[136:139], a[48:51], 0
v_mfma_f32_16x16x32_bf16 a[244:247], a[140:143], a[52:55], a[244:247]
buffer_load_dwordx4 v19, s[12:15], s26 offen offset:3072 lds
v_mfma_f32_16x16x32_bf16 a[252:255], a[136:139], a[56:59], 0
s_add_u32 s26, s26, 524288
v_mfma_f32_16x16x32_bf16 a[252:255], a[140:143], a[60:63], a[252:255]
s_waitcnt lgkmcnt(0)
Lg_1:
v_mfma_f32_16x16x32_bf16 v[32:35], a[128:131], a[64:67], v[32:35]
s_add_u32 m0, s29, 81920
ds_read_b64_tr_b16 a[136:137], v5 offset:32768
v_mfma_f32_16x16x32_bf16 v[32:35], a[132:135], a[68:71], v[32:35]
buffer_load_dwordx4 v16, s[12:15], s27 offen offset:0 lds
v_mfma_f32_16x16x32_bf16 v[40:43], a[128:131], a[72:75], v[40:43]
ds_read_b64_tr_b16 a[138:139], v5 offset:34816
v_mfma_f32_16x16x32_bf16 v[40:43], a[132:135], a[76:79], v[40:43]
v_mfma_f32_16x16x32_bf16 v[48:51], a[128:131], a[80:83], v[48:51]
ds_read_b64_tr_b16 a[140:141], v5 offset:49152
v_mfma_f32_16x16x32_bf16 v[48:51], a[132:135], a[84:87], v[48:51]
buffer_load_dwordx4 v17, s[12:15], s27 offen offset:1024 lds
v_mfma_f32_16x16x32_bf16 v[56:59], a[128:131], a[88:91], v[56:59]
ds_read_b64_tr_b16 a[142:143], v5 offset:51200
v_mfma_f32_16x16x32_bf16 v[56:59], a[132:135], a[92:95], v[56:59]
v_mfma_f32_16x16x32_bf16 v[64:67], a[128:131], a[96:99], v[64:67]
ds_read_b128 a[0:3], v2 offset:0
v_mfma_f32_16x16x32_bf16 v[64:67], a[132:135], a[100:103], v[64:67]
buffer_load_dwordx4 v18, s[12:15], s27 offen offset:2048 lds
v_mfma_f32_16x16x32_bf16 v[72:75], a[128:131], a[104:107], v[72:75]
ds_read_b128 a[4:7], v3 offset:0
v_mfma_f32_16x16x32_bf16 v[72:75], a[132:135], a[108:111], v[72:75]
v_mfma_f32_16x16x32_bf16 v[80:83], a[128:131], a[112:115], v[80:83]
v_mfma_f32_16x16x32_bf16 v[80:83], a[132:135], a[116:119], v[80:83]
buffer_load_dwordx4 v19, s[12:15], s27 offen offset:3072 lds
v_mfma_f32_16x16x32_bf16 v[88:91], a[128:131], a[120:123], v[88:91]
s_add_u32 s27, s27, 524288
ds_read_b128 a[8:11], v2 offset:2048
v_mfma_f32_16x16x32_bf16 v[88:91], a[132:135], a[124:127], v[88:91]
s_waitcnt lgkmcnt(3)
v_mfma_f32_16x16x32_bf16 v[36:39], a[136:139], a[64:67], v[36:39]
s_add_u32 m0, s28, 32768
ds_read_b64_tr_b16 a[128:129], v6 offset:32768
v_mfma_f32_16x16x32_bf16 v[36:39], a[140:143], a[68:71], v[36:39]
buffer_load_dwordx4 v12, s[8:11], s24 offen offset:0 lds
v_mfma_f32_16x16x32_bf16 v[44:47], a[136:139], a[72:75], v[44:47]
ds_read_b64_tr_b16 a[130:131], v6 offset:34816
v_mfma_f32_16x16x32_bf16 v[44:47], a[140:143], a[76:79], v[44:47]
v_mfma_f32_16x16x32_bf16 v[52:55], a[136:139], a[80:83], v[52:55]
ds_read_b64_tr_b16 a[132:133], v6 offset:49152
v_mfma_f32_16x16x32_bf16 v[52:55], a[140:143], a[84:87], v[52:55]
buffer_load_dwordx4 v13, s[8:11], s24 offen offset:1024 lds
v_mfma_f32_16x16x32_bf16 v[60:63], a[136:139], a[88:91], v[60:63]
ds_read_b64_tr_b16 a[134:135], v6 offset:51200
v_mfma_f32_16x16x32_bf16 v[60:63], a[140:143], a[92:95], v[60:63]
v_mfma_f32_16x16x32_bf16 v[68:71], a[136:139], a[96:99], v[68:71]
ds_read_b128 a[12:15], v3 offset:2048
v_mfma_f32_16x16x32_bf16 v[68:71], a[140:143], a[100:103], v[68:71]
buffer_load_dwordx4 v14, s[8:11], s24 offen offset:2048 lds
v_mfma_f32_16x16x32_bf16 v[76:79], a[136:139], a[104:107], v[76:79]
v_mfma_f32_16x16x32_bf16 v[76:79], a[140:143], a[108:111], v[76:79]
v_mfma_f32_16x16x32_bf16 v[84:87], a[136:139], a[112:115], v[84:87]
ds_read_b128 a[16:19], v2 offset:4096
v_mfma_f32_16x16x32_bf16 v[84:87], a[140:143], a[116:119], v[84:87]
buffer_load_dwordx4 v15, s[8:11], s24 offen offset:3072 lds
v_mfma_f32_16x16x32_bf16 v[92:95], a[136:139], a[120:123], v[92:95]
s_add_u32 s24, s24, 128
ds_read_b128 a[20:23], v3 offset:4096
v_mfma_f32_16x16x32_bf16 v[92:95], a[140:143], a[124:127], v[92:95]
s_waitcnt lgkmcnt(3)
v_mfma_f32_16x16x32_bf16 v[96:99], a[128:131], a[64:67], v[96:99]
s_add_u32 m0, s28, 36864
ds_read_b64_tr_b16 a[136:137], v7 offset:32768
v_mfma_f32_16x16x32_bf16 v[96:99], a[132:135], a[68:71], v[96:99]
buffer_load_dwordx4 v12, s[8:11], s25 offen offset:0 lds
v_mfma_f32_16x16x32_bf16 v[104:107], a[128:131], a[72:75], v[104:107]
ds_read_b64_tr_b16 a[138:139], v7 offset:34816
v_mfma_f32_16x16x32_bf16 v[104:107], a[132:135], a[76:79], v[104:107]
v_mfma_f32_16x16x32_bf16 v[112:115], a[128:131], a[80:83], v[112:115]
ds_read_b64_tr_b16 a[140:141], v7 offset:49152
v_mfma_f32_16x16x32_bf16 v[112:115], a[132:135], a[84:87], v[112:115]
buffer_load_dwordx4 v13, s[8:11], s25 offen offset:1024 lds
v_mfma_f32_16x16x32_bf16 v[120:123], a[128:131], a[88:91], v[120:123]
ds_read_b64_tr_b16 a[142:143], v7 offset:51200
v_mfma_f32_16x16x32_bf16 v[120:123], a[132:135], a[92:95], v[120:123]
v_mfma_f32_16x16x32_bf16 v[128:131], a[128:131], a[96:99], v[128:131]
v_mfma_f32_16x16x32_bf16 v[128:131], a[132:135], a[100:103], v[128:131]
buffer_load_dwordx4 v14, s[8:11], s25 offen offset:2048 lds
v_mfma_f32_16x16x32_bf16 v[136:139], a[128:131], a[104:107], v[136:139]
ds_read_b128 a[24:27], v2 offset:6144
v_mfma_f32_16x16x32_bf16 v[136:139], a[132:135], a[108:111], v[136:139]
v_mfma_f32_16x16x32_bf16 v[144:147], a[128:131], a[112:115], v[144:147]
ds_read_b128 a[28:31], v3 offset:6144
v_mfma_f32_16x16x32_bf16 v[144:147], a[132:135], a[116:119], v[144:147]
buffer_load_dwordx4 v15, s[8:11], s25 offen offset:3072 lds
v_mfma_f32_16x16x32_bf16 v[152:155], a[128:131], a[120:123], v[152:155]
s_add_u32 s25, s25, 128
v_mfma_f32_16x16x32_bf16 v[152:155], a[132:135], a[124:127], v[152:155]
s_waitcnt lgkmcnt(2)
v_mfma_f32_16x16x32_bf16 v[100:103], a[136:139], a[64:67], v[100:103]
ds_read_b64_tr_b16 a[128:129], v8 offset:32768
v_mfma_f32_16x16x32_bf16 v[100:103], a[140:143], a[68:71], v[100:103]
buffer_load_dword v21, v20, s[16:19], s43 offen
v_mfma_f32_16x16x32_bf16 v[108:111], a[136:139], a[72:75], v[108:111]
s_add_u32 s43, s43, s47
ds_read_b64_tr_b16 a[130:131], v8 offset:34816
v_mfma_f32_16x16x32_bf16 v[108:111], a[140:143], a[76:79], v[108:111]
s_cmp_ge_u32 s43, s51
v_mfma_f32_16x16x32_bf16 v[116:119], a[136:139], a[80:83], v[116:119]
s_cselect_b32 s43, 0, s43
ds_read_b64_tr_b16 a[132:133], v8 offset:49152
v_mfma_f32_16x16x32_bf16 v[116:119], a[140:143], a[84:87], v[116:119]
s_cselect_b32 s51, s42, s51
v_mfma_f32_16x16x32_bf16 v[124:127], a[136:139], a[88:91], v[124:127]
s_cselect_b64 s[16:17], s[40:41], s[16:17]
ds_read_b64_tr_b16 a[134:135], v8 offset:51200
v_mfma_f32_16x16x32_bf16 v[124:127], a[140:143], a[92:95], v[124:127]
s_cselect_b32 s18, s42, s18
v_mfma_f32_16x16x32_bf16 v[132:135], a[136:139], a[96:99], v[132:135]
s_cselect_b64 s[40:41], s[44:45], s[40:41]
ds_read_b128 a[32:35], v2 offset:8192
v_mfma_f32_16x16x32_bf16 v[132:135], a[140:143], a[100:103], v[132:135]
s_cselect_b32 s42, s46, s42
v_mfma_f32_16x16x32_bf16 v[140:143], a[136:139], a[104:107], v[140:143]
s_cselect_b32 s46, 0, s46
v_mfma_f32_16x16x32_bf16 v[140:143], a[140:143], a[108:111], v[140:143]
s_cmp_eq_u32 s30, s55
v_mfma_f32_16x16x32_bf16 v[148:151], a[136:139], a[112:115], v[148:151]
s_cselect_b32 s22, 0, 3221225472
ds_read_b128 a[36:39], v3 offset:8192
v_mfma_f32_16x16x32_bf16 v[148:151], a[140:143], a[116:119], v[148:151]
s_sub_u32 s30, s30, 1
buffer_atomic_add v27, v26, s[60:63], s22 offen sc1
v_mfma_f32_16x16x32_bf16 v[156:159], a[136:139], a[120:123], v[156:159]
ds_read_b128 a[40:43], v2 offset:10240
v_mfma_f32_16x16x32_bf16 v[156:159], a[140:143], a[124:127], v[156:159]
s_waitcnt lgkmcnt(3)
v_mfma_f32_16x16x32_bf16 v[160:163], a[128:131], a[64:67], v[160:163]
ds_read_b64_tr_b16 a[136:137], v9 offset:32768
v_mfma_f32_16x16x32_bf16 v[160:163], a[132:135], a[68:71], v[160:163]
v_mfma_f32_16x16x32_bf16 v[168:171], a[128:131], a[72:75], v[168:171]
ds_read_b64_tr_b16 a[138:139], v9 offset:34816
v_mfma_f32_16x16x32_bf16 v[168:171], a[132:135], a[76:79], v[168:171]
v_mfma_f32_16x16x32_bf16 v[176:179], a[128:131], a[80:83], v[176:179]
ds_read_b64_tr_b16 a[140:141], v9 offset:49152
v_mfma_f32_16x16x32_bf16 v[176:179], a[132:135], a[84:87], v[176:179]
v_mfma_f32_16x16x32_bf16 v[184:187], a[128:131], a[88:91], v[184:187]
ds_read_b64_tr_b16 a[142:143], v9 offset:51200
v_mfma_f32_16x16x32_bf16 v[184:187], a[132:135], a[92:95], v[184:187]
v_mfma_f32_16x16x32_bf16 v[192:195], a[128:131], a[96:99], v[192:195]
v_mfma_f32_16x16x32_bf16 v[192:195], a[132:135], a[100:103], v[192:195]
v_mfma_f32_16x16x32_bf16 v[200:203], a[128:131], a[104:107], v[200:203]
ds_read_b128 a[44:47], v3 offset:10240
v_mfma_f32_16x16x32_bf16 v[200:203], a[132:135], a[108:111], v[200:203]
v_mfma_f32_16x16x32_bf16 v[208:211], a[128:131], a[112:115], v[208:211]
ds_read_b128 a[48:51], v2 offset:12288
v_mfma_f32_16x16x32_bf16 v[208:211], a[132:135], a[116:119], v[208:211]
v_mfma_f32_16x16x32_bf16 v[216:219], a[128:131], a[120:123], v[216:219]
v_mfma_f32_16x16x32_bf16 v[216:219], a[132:135], a[124:127], v[216:219]
s_waitcnt lgkmcnt(2)
v_mfma_f32_16x16x32_bf16 v[164:167], a[136:139], a[64:67], v[164:167]
ds_read_b64_tr_b16 a[128:129], v10 offset:32768
v_mfma_f32_16x16x32_bf16 v[164:167], a[140:143], a[68:71], v[164:167]
v_mfma_f32_16x16x32_bf16 v[172:175], a[136:139], a[72:75], v[172:175]
ds_read_b64_tr_b16 a[130:131], v10 offset:34816
v_mfma_f32_16x16x32_bf16 v[172:175], a[140:143], a[76:79], v[172:175]
v_mfma_f32_16x16x32_bf16 v[180:183], a[136:139], a[80:83], v[180:183]
ds_read_b64_tr_b16 a[132:133], v10 offset:49152
v_mfma_f32_16x16x32_bf16 v[180:183], a[140:143], a[84:87], v[180:183]
v_mfma_f32_16x16x32_bf16 v[188:191], a[136:139], a[88:91], v[188:191]
ds_read_b64_tr_b16 a[134:135], v10 offset:51200
v_mfma_f32_16x16x32_bf16 v[188:191], a[140:143], a[92:95], v[188:191]
v_mfma_f32_16x16x32_bf16 v[196:199], a[136:139], a[96:99], v[196:199]
ds_read_b128 a[52:55], v3 offset:12288
v_mfma_f32_16x16x32_bf16 v[196:199], a[140:143], a[100:103], v[196:199]
v_mfma_f32_16x16x32_bf16 v[204:207], a[136:139], a[104:107], v[204:207]
ds_read_b128 a[56:59], v2 offset:14336
v_mfma_f32_16x16x32_bf16 v[204:207], a[140:143], a[108:111], v[204:207]
v_mfma_f32_16x16x32_bf16 v[212:215], a[136:139], a[112:115], v[212:215]
v_mfma_f32_16x16x32_bf16 v[212:215], a[140:143], a[116:119], v[212:215]
v_mfma_f32_16x16x32_bf16 v[220:223], a[136:139], a[120:123], v[220:223]
ds_read_b128 a[60:63], v3 offset:14336
v_mfma_f32_16x16x32_bf16 v[220:223], a[140:143], a[124:127], v[220:223]
s_waitcnt lgkmcnt(3)
v_mfma_f32_16x16x32_bf16 a[192:195], a[128:131], a[64:67], a[192:195]
ds_read_b64_tr_b16 a[136:137], v11 offset:32768
v_mfma_f32_16x16x32_bf16 a[192:195], a[132:135], a[68:71], a[192:195]
v_mfma_f32_16x16x32_bf16 a[200:203], a[128:131], a[72:75], a[200:203]
ds_read_b64_tr_b16 a[138:139], v11 offset:34816
v_mfma_f32_16x16x32_bf16 a[200:203], a[132:135], a[76:79], a[200:203]
v_mfma_f32_16x16x32_bf16 a[208:211], a[128:131], a[80:83], a[208:211]
ds_read_b64_tr_b16 a[140:141], v11 offset:49152
v_mfma_f32_16x16x32_bf16 a[208:211], a[132:135], a[84:87], a[208:211]
v_mfma_f32_16x16x32_bf16 a[216:219], a[128:131], a[88:91], a[216:219]
ds_read_b64_tr_b16 a[142:143], v11 offset:51200
v_mfma_f32_16x16x32_bf16 a[216:219], a[132:135], a[92:95], a[216:219]
v_mfma_f32_16x16x32_bf16 a[224:227], a[128:131], a[96:99], a[224:227]
v_mfma_f32_16x16x32_bf16 a[224:227], a[132:135], a[100:103], a[224:227]
v_mfma_f32_16x16x32_bf16 a[232:235], a[128:131], a[104:107], a[232:235]
v_mfma_f32_16x16x32_bf16 a[232:235], a[132:135], a[108:111], a[232:235]
v_mfma_f32_16x16x32_bf16 a[240:243], a[128:131], a[112:115], a[240:243]
v_mfma_f32_16x16x32_bf16 a[240:243], a[132:135], a[116:119], a[240:243]
v_mfma_f32_16x16x32_bf16 a[248:251], a[128:131], a[120:123], a[248:251]
s_waitcnt vmcnt(2) lgkmcnt(0)
v_mfma_f32_16x16x32_bf16 a[248:251], a[132:135], a[124:127], a[248:251]
s_barrier
v_mfma_f32_16x16x32_bf16 a[196:199], a[136:139], a[64:67], a[196:199]
s_add_u32 m0, s29, 98304
ds_read_b64_tr_b16 a[128:129], v4 offset:0
v_mfma_f32_16x16x32_bf16 a[196:199], a[140:143], a[68:71], a[196:199]
buffer_load_dwordx4 v16, s[12:15], s26 offen offset:0 lds
v_mfma_f32_16x16x32_bf16 a[204:207], a[136:139], a[72:75], a[204:207]
ds_read_b64_tr_b16 a[130:131], v4 offset:2048
v_mfma_f32_16x16x32_bf16 a[204:207], a[140:143], a[76:79], a[204:207]
v_mfma_f32_16x16x32_bf16 a[212:215], a[136:139], a[80:83], a[212:215]
ds_read_b64_tr_b16 a[132:133], v4 offset:16384
v_mfma_f32_16x16x32_bf16 a[212:215], a[140:143], a[84:87], a[212:215]
buffer_load_dwordx4 v17, s[12:15], s26 offen offset:1024 lds
v_mfma_f32_16x16x32_bf16 a[220:223], a[136:139], a[88:91], a[220:223]
ds_read_b64_tr_b16 a[134:135], v4 offset:18432
v_mfma_f32_16x16x32_bf16 a[220:223], a[140:143], a[92:95], a[220:223]
v_mfma_f32_16x16x32_bf16 a[228:231], a[136:139], a[96:99], a[228:231]
v_mfma_f32_16x16x32_bf16 a[228:231], a[140:143], a[100:103], a[228:231]
buffer_load_dwordx4 v18, s[12:15], s26 offen offset:2048 lds
v_mfma_f32_16x16x32_bf16 a[236:239], a[136:139], a[104:107], a[236:239]
v_mfma_f32_16x16x32_bf16 a[236:239], a[140:143], a[108:111], a[236:239]
v_mfma_f32_16x16x32_bf16 a[244:247], a[136:139], a[112:115], a[244:247]
v_mfma_f32_16x16x32_bf16 a[244:247], a[140:143], a[116:119], a[244:247]
buffer_load_dwordx4 v19, s[12:15], s26 offen offset:3072 lds
v_mfma_f32_16x16x32_bf16 a[252:255], a[136:139], a[120:123], a[252:255]
s_add_u32 s26, s26, 524288
v_mfma_f32_16x16x32_bf16 a[252:255], a[140:143], a[124:127], a[252:255]
s_waitcnt lgkmcnt(0)
buffer_store_dword v27, v26, s[4:7], s82 offen sc1
v_mfma_f32_16x16x32_bf16 v[32:35], a[128:131], a[0:3], v[32:35]
s_add_u32 m0, s29, 114688
ds_read_b64_tr_b16 a[136:137], v5 offset:0
v_mfma_f32_16x16x32_bf16 v[32:35], a[132:135], a[4:7], v[32:35]
buffer_load_dwordx4 v16, s[12:15], s27 offen offset:0 lds
v_mfma_f32_16x16x32_bf16 v[40:43], a[128:131], a[8:11], v[40:43]
ds_read_b64_tr_b16 a[138:139], v5 offset:2048
v_mfma_f32_16x16x32_bf16 v[40:43], a[132:135], a[12:15], v[40:43]
v_mfma_f32_16x16x32_bf16 v[48:51], a[128:131], a[16:19], v[48:51]
ds_read_b64_tr_b16 a[140:141], v5 offset:16384
v_mfma_f32_16x16x32_bf16 v[48:51], a[132:135], a[20:23], v[48:51]
buffer_load_dwordx4 v17, s[12:15], s27 offen offset:1024 lds
v_mfma_f32_16x16x32_bf16 v[56:59], a[128:131], a[24:27], v[56:59]
ds_read_b64_tr_b16 a[142:143], v5 offset:18432
v_mfma_f32_16x16x32_bf16 v[56:59], a[132:135], a[28:31], v[56:59]
v_mfma_f32_16x16x32_bf16 v[64:67], a[128:131], a[32:35], v[64:67]
ds_read_b128 a[64:67], v2 offset:32768
v_mfma_f32_16x16x32_bf16 v[64:67], a[132:135], a[36:39], v[64:67]
buffer_load_dwordx4 v18, s[12:15], s27 offen offset:2048 lds
v_mfma_f32_16x16x32_bf16 v[72:75], a[128:131], a[40:43], v[72:75]
ds_read_b128 a[68:71], v3 offset:32768
v_mfma_f32_16x16x32_bf16 v[72:75], a[132:135], a[44:47], v[72:75]
v_mfma_f32_16x16x32_bf16 v[80:83], a[128:131], a[48:51], v[80:83]
v_mfma_f32_16x16x32_bf16 v[80:83], a[132:135], a[52:55], v[80:83]
buffer_load_dwordx4 v19, s[12:15], s27 offen offset:3072 lds
v_mfma_f32_16x16x32_bf16 v[88:91], a[128:131], a[56:59], v[88:91]
s_add_u32 s27, s27, 524288
ds_read_b128 a[72:75], v2 offset:34816
v_mfma_f32_16x16x32_bf16 v[88:91], a[132:135], a[60:63], v[88:91]
s_waitcnt lgkmcnt(3)
v_mfma_f32_16x16x32_bf16 v[36:39], a[136:139], a[0:3], v[36:39]
s_add_u32 m0, s28, 0
ds_read_b64_tr_b16 a[128:129], v6 offset:0
v_mfma_f32_16x16x32_bf16 v[36:39], a[140:143], a[4:7], v[36:39]
buffer_load_dwordx4 v12, s[8:11], s24 offen offset:0 lds
v_mfma_f32_16x16x32_bf16 v[44:47], a[136:139], a[8:11], v[44:47]
ds_read_b64_tr_b16 a[130:131], v6 offset:2048
v_mfma_f32_16x16x32_bf16 v[44:47], a[140:143], a[12:15], v[44:47]
PAD_1:
s_cbranch_execz PAD_5
v_mfma_f32_16x16x32_bf16 v[52:55], a[136:139], a[16:19], v[52:55]
ds_read_b64_tr_b16 a[132:133], v6 offset:16384
v_mfma_f32_16x16x32_bf16 v[52:55], a[140:143], a[20:23], v[52:55]
buffer_load_dwordx4 v13, s[8:11], s24 offen offset:1024 lds
v_mfma_f32_16x16x32_bf16 v[60:63], a[136:139], a[24:27], v[60:63]
ds_read_b64_tr_b16 a[134:135], v6 offset:18432
v_mfma_f32_16x16x32_bf16 v[60:63], a[140:143], a[28:31], v[60:63]
v_mfma_f32_16x16x32_bf16 v[68:71], a[136:139], a[32:35], v[68:71]
ds_read_b128 a[76:79], v3 offset:34816
v_mfma_f32_16x16x32_bf16 v[68:71], a[140:143], a[36:39], v[68:71]
buffer_load_dwordx4 v14, s[8:11], s24 offen offset:2048 lds
v_mfma_f32_16x16x32_bf16 v[76:79], a[136:139], a[40:43], v[76:79]
v_mfma_f32_16x16x32_bf16 v[76:79], a[140:143], a[44:47], v[76:79]
v_mfma_f32_16x16x32_bf16 v[84:87], a[136:139], a[48:51], v[84:87]
ds_read_b128 a[80:83], v2 offset:36864
v_mfma_f32_16x16x32_bf16 v[84:87], a[140:143], a[52:55], v[84:87]
buffer_load_dwordx4 v15, s[8:11], s24 offen offset:3072 lds
v_mfma_f32_16x16x32_bf16 v[92:95], a[136:139], a[56:59], v[92:95]
s_add_u32 s24, s24, 128
ds_read_b128 a[84:87], v3 offset:36864
v_mfma_f32_16x16x32_bf16 v[92:95], a[140:143], a[60:63], v[92:95]
s_waitcnt lgkmcnt(3)
v_mfma_f32_16x16x32_bf16 v[96:99], a[128:131], a[0:3], v[96:99]
s_add_u32 m0, s28, 4096
ds_read_b64_tr_b16 a[136:137], v7 offset:0
v_mfma_f32_16x16x32_bf16 v[96:99], a[132:135], a[4:7], v[96:99]
buffer_load_dwordx4 v12, s[8:11], s25 offen offset:0 lds
v_mfma_f32_16x16x32_bf16 v[104:107], a[128:131], a[8:11], v[104:107]
ds_read_b64_tr_b16 a[138:139], v7 offset:2048
v_mfma_f32_16x16x32_bf16 v[104:107], a[132:135], a[12:15], v[104:107]
v_mfma_f32_16x16x32_bf16 v[112:115], a[128:131], a[16:19], v[112:115]
ds_read_b64_tr_b16 a[140:141], v7 offset:16384
v_mfma_f32_16x16x32_bf16 v[112:115], a[132:135], a[20:23], v[112:115]
buffer_load_dwordx4 v13, s[8:11], s25 offen offset:1024 lds
v_mfma_f32_16x16x32_bf16 v[120:123], a[128:131], a[24:27], v[120:123]
ds_read_b64_tr_b16 a[142:143], v7 offset:18432
v_mfma_f32_16x16x32_bf16 v[120:123], a[132:135], a[28:31], v[120:123]
v_mfma_f32_16x16x32_bf16 v[128:131], a[128:131], a[32:35], v[128:131]
v_mfma_f32_16x16x32_bf16 v[128:131], a[132:135], a[36:39], v[128:131]
buffer_load_dwordx4 v14, s[8:11], s25 offen offset:2048 lds
v_mfma_f32_16x16x32_bf16 v[136:139], a[128:131], a[40:43], v[136:139]
ds_read_b128 a[88:91], v2 offset:38912
v_mfma_f32_16x16x32_bf16 v[136:139], a[132:135], a[44:47], v[136:139]
v_mfma_f32_16x16x32_bf16 v[144:147], a[128:131], a[48:51], v[144:147]
ds_read_b128 a[92:95], v3 offset:38912
v_mfma_f32_16x16x32_bf16 v[144:147], a[132:135], a[52:55], v[144:147]
buffer_load_dwordx4 v15, s[8:11], s25 offen offset:3072 lds
v_mfma_f32_16x16x32_bf16 v[152:155], a[128:131], a[56:59], v[152:155]
s_add_u32 s25, s25, 128
v_mfma_f32_16x16x32_bf16 v[152:155], a[132:135], a[60:63], v[152:155]
s_waitcnt lgkmcnt(2)
v_mfma_f32_16x16x32_bf16 v[100:103], a[136:139], a[0:3], v[100:103]
ds_read_b64_tr_b16 a[128:129], v8 offset:0
v_mfma_f32_16x16x32_bf16 v[100:103], a[140:143], a[4:7], v[100:103]
buffer_load_dword v21, v20, s[16:19], s43 offen
v_mfma_f32_16x16x32_bf16 v[108:111], a[136:139], a[8:11], v[108:111]
s_add_u32 s43, s43, s47
ds_read_b64_tr_b16 a[130:131], v8 offset:2048
v_mfma_f32_16x16x32_bf16 v[108:111], a[140:143], a[12:15], v[108:111]
s_cmp_ge_u32 s43, s51
v_mfma_f32_16x16x32_bf16 v[116:119], a[136:139], a[16:19], v[116:119]
s_cselect_b32 s43, 0, s43
ds_read_b64_tr_b16 a[132:133], v8 offset:16384
v_mfma_f32_16x16x32_bf16 v[116:119], a[140:143], a[20:23], v[116:119]
s_cselect_b32 s51, s42, s51
v_mfma_f32_16x16x32_bf16 v[124:127], a[136:139], a[24:27], v[124:127]
s_cselect_b64 s[16:17], s[40:41], s[16:17]
ds_read_b64_tr_b16 a[134:135], v8 offset:18432
v_mfma_f32_16x16x32_bf16 v[124:127], a[140:143], a[28:31], v[124:127]
s_cselect_b32 s18, s42, s18
v_mfma_f32_16x16x32_bf16 v[132:135], a[136:139], a[32:35], v[132:135]
s_cselect_b64 s[40:41], s[44:45], s[40:41]
ds_read_b128 a[96:99], v2 offset:40960
v_mfma_f32_16x16x32_bf16 v[132:135], a[140:143], a[36:39], v[132:135]
s_cselect_b32 s42, s46, s42
v_mfma_f32_16x16x32_bf16 v[140:143], a[136:139], a[40:43], v[140:143]
s_cselect_b32 s46, 0, s46
v_mfma_f32_16x16x32_bf16 v[140:143], a[140:143], a[44:47], v[140:143]
s_cmp_eq_u32 s30, s55
v_mfma_f32_16x16x32_bf16 v[148:151], a[136:139], a[48:51], v[148:151]
s_cselect_b32 s22, 0, 3221225472
ds_read_b128 a[100:103], v3 offset:40960
v_mfma_f32_16x16x32_bf16 v[148:151], a[140:143], a[52:55], v[148:151]
s_sub_u32 s30, s30, 1
buffer_atomic_add v27, v26, s[60:63], s22 offen sc1
v_mfma_f32_16x16x32_bf16 v[156:159], a[136:139], a[56:59], v[156:159]
ds_read_b128 a[104:107], v2 offset:43008
v_mfma_f32_16x16x32_bf16 v[156:159], a[140:143], a[60:63], v[156:159]
s_waitcnt lgkmcnt(3)
v_mfma_f32_16x16x32_bf16 v[160:163], a[128:131], a[0:3], v[160:163]
ds_read_b64_tr_b16 a[136:137], v9 offset:0
v_mfma_f32_16x16x32_bf16 v[160:163], a[132:135], a[4:7], v[160:163]
v_mfma_f32_16x16x32_bf16 v[168:171], a[128:131], a[8:11], v[168:171]
ds_read_b64_tr_b16 a[138:139], v9 offset:2048
v_mfma_f32_16x16x32_bf16 v[168:171], a[132:135], a[12:15], v[168:171]
v_mfma_f32_16x16x32_bf16 v[176:179], a[128:131], a[16:19], v[176:179]
ds_read_b64_tr_b16 a[140:141], v9 offset:16384
v_mfma_f32_16x16x32_bf16 v[176:179], a[132:135], a[20:23], v[176:179]
v_mfma_f32_16x16x32_bf16 v[184:187], a[128:131], a[24:27], v[184:187]
ds_read_b64_tr_b16 a[142:143], v9 offset:18432
v_mfma_f32_16x16x32_bf16 v[184:187], a[132:135], a[28:31], v[184:187]
v_mfma_f32_16x16x32_bf16 v[192:195], a[128:131], a[32:35], v[192:195]
v_mfma_f32_16x16x32_bf16 v[192:195], a[132:135], a[36:39], v[192:195]
v_mfma_f32_16x16x32_bf16 v[200:203], a[128:131], a[40:43], v[200:203]
ds_read_b128 a[108:111], v3 offset:43008
v_mfma_f32_16x16x32_bf16 v[200:203], a[132:135], a[44:47], v[200:203]
v_mfma_f32_16x16x32_bf16 v[208:211], a[128:131], a[48:51], v[208:211]
ds_read_b128 a[112:115], v2 offset:45056
v_mfma_f32_16x16x32_bf16 v[208:211], a[132:135], a[52:55], v[208:211]
v_mfma_f32_16x16x32_bf16 v[216:219], a[128:131], a[56:59], v[216:219]
v_mfma_f32_16x16x32_bf16 v[216:219], a[132:135], a[60:63], v[216:219]
s_waitcnt lgkmcnt(2)
v_mfma_f32_16x16x32_bf16 v[164:167], a[136:139], a[0:3], v[164:167]
ds_read_b64_tr_b16 a[128:129], v10 offset:0
v_mfma_f32_16x16x32_bf16 v[164:167], a[140:143], a[4:7], v[164:167]
v_mfma_f32_16x16x32_bf16 v[172:175], a[136:139], a[8:11], v[172:175]
ds_read_b64_tr_b16 a[130:131], v10 offset:2048
v_mfma_f32_16x16x32_bf16 v[172:175], a[140:143], a[12:15], v[172:175]
v_mfma_f32_16x16x32_bf16 v[180:183], a[136:139], a[16:19], v[180:183]
ds_read_b64_tr_b16 a[132:133], v10 offset:16384
v_mfma_f32_16x16x32_bf16 v[180:183], a[140:143], a[20:23], v[180:183]
v_mfma_f32_16x16x32_bf16 v[188:191], a[136:139], a[24:27], v[188:191]
ds_read_b64_tr_b16 a[134:135], v10 offset:18432
v_mfma_f32_16x16x32_bf16 v[188:191], a[140:143], a[28:31], v[188:191]
v_mfma_f32_16x16x32_bf16 v[196:199], a[136:139], a[32:35], v[196:199]
ds_read_b128 a[116:119], v3 offset:45056
v_mfma_f32_16x16x32_bf16 v[196:199], a[140:143], a[36:39], v[196:199]
v_mfma_f32_16x16x32_bf16 v[204:207], a[136:139], a[40:43], v[204:207]
ds_read_b128 a[120:123], v2 offset:47104
v_mfma_f32_16x16x32_bf16 v[204:207], a[140:143], a[44:47], v[204:207]
v_mfma_f32_16x16x32_bf16 v[212:215], a[136:139], a[48:51], v[212:215]
v_mfma_f32_16x16x32_bf16 v[212:215], a[140:143], a[52:55], v[212:215]
v_mfma_f32_16x16x32_bf16 v[220:223], a[136:139], a[56:59], v[220:223]
ds_read_b128 a[124:127], v3 offset:47104
v_mfma_f32_16x16x32_bf16 v[220:223], a[140:143], a[60:63], v[220:223]
s_waitcnt lgkmcnt(3)
v_mfma_f32_16x16x32_bf16 a[192:195], a[128:131], a[0:3], a[192:195]
ds_read_b64_tr_b16 a[136:137], v11 offset:0
v_mfma_f32_16x16x32_bf16 a[192:195], a[132:135], a[4:7], a[192:195]
v_mfma_f32_16x16x32_bf16 a[200:203], a[128:131], a[8:11], a[200:203]
ds_read_b64_tr_b16 a[138:139], v11 offset:2048
v_mfma_f32_16x16x32_bf16 a[200:203], a[132:135], a[12:15], a[200:203]
v_mfma_f32_16x16x32_bf16 a[208:211], a[128:131], a[16:19], a[208:211]
ds_read_b64_tr_b16 a[140:141], v11 offset:16384
v_mfma_f32_16x16x32_bf16 a[208:211], a[132:135], a[20:23], a[208:211]
v_mfma_f32_16x16x32_bf16 a[216:219], a[128:131], a[24:27], a[216:219]
ds_read_b64_tr_b16 a[142:143], v11 offset:18432
v_mfma_f32_16x16x32_bf16 a[216:219], a[132:135], a[28:31], a[216:219]
v_mfma_f32_16x16x32_bf16 a[224:227], a[128:131], a[32:35], a[224:227]
v_mfma_f32_16x16x32_bf16 a[224:227], a[132:135], a[36:39], a[224:227]
v_mfma_f32_16x16x32_bf16 a[232:235], a[128:131], a[40:43], a[232:235]
v_mfma_f32_16x16x32_bf16 a[232:235], a[132:135], a[44:47], a[232:235]
v_mfma_f32_16x16x32_bf16 a[240:243], a[128:131], a[48:51], a[240:243]
v_mfma_f32_16x16x32_bf16 a[240:243], a[132:135], a[52:55], a[240:243]
v_mfma_f32_16x16x32_bf16 a[248:251], a[128:131], a[56:59], a[248:251]
s_waitcnt vmcnt(2) lgkmcnt(0)
v_mfma_f32_16x16x32_bf16 a[248:251], a[132:135], a[60:63], a[248:251]
s_barrier
v_mfma_f32_16x16x32_bf16 a[196:199], a[136:139], a[0:3], a[196:199]
s_add_u32 m0, s29, 65536
ds_read_b64_tr_b16 a[128:129], v4 offset:32768
v_mfma_f32_16x16x32_bf16 a[196:199], a[140:143], a[4:7], a[196:199]
buffer_load_dwordx4 v16, s[12:15], s26 offen offset:0 lds
v_mfma_f32_16x16x32_bf16 a[204:207], a[136:139], a[8:11], a[204:207]
ds_read_b64_tr_b16 a[130:131], v4 offset:34816
v_mfma_f32_16x16x32_bf16 a[204:207], a[140:143], a[12:15], a[204:207]
v_mfma_f32_16x16x32_bf16 a[212:215], a[136:139], a[16:19], a[212:215]
ds_read_b64_tr_b16 a[132:133], v4 offset:49152
v_mfma_f32_16x16x32_bf16 a[212:215], a[140:143], a[20:23], a[212:215]
buffer_load_dwordx4 v17, s[12:15], s26 offen offset:1024 lds
v_mfma_f32_16x16x32_bf16 a[220:223], a[136:139], a[24:27], a[220:223]
ds_read_b64_tr_b16 a[134:135], v4 offset:51200
v_mfma_f32_16x16x32_bf16 a[220:223], a[140:143], a[28:31], a[220:223]
v_mfma_f32_16x16x32_bf16 a[228:231], a[136:139], a[32:35], a[228:231]
v_mfma_f32_16x16x32_bf16 a[228:231], a[140:143], a[36:39], a[228:231]
buffer_load_dwordx4 v18, s[12:15], s26 offen offset:2048 lds
v_mfma_f32_16x16x32_bf16 a[236:239], a[136:139], a[40:43], a[236:239]
v_mfma_f32_16x16x32_bf16 a[236:239], a[140:143], a[44:47], a[236:239]
v_mfma_f32_16x16x32_bf16 a[244:247], a[136:139], a[48:51], a[244:247]
v_mfma_f32_16x16x32_bf16 a[244:247], a[140:143], a[52:55], a[244:247]
s_waitcnt lgkmcnt(0)
buffer_load_dwordx4 v19, s[12:15], s26 offen offset:3072 lds
v_mfma_f32_16x16x32_bf16 a[252:255], a[136:139], a[56:59], a[252:255]
s_add_u32 s26, s26, 524288
s_bitcmp1_b32 s30, 1
v_mfma_f32_16x16x32_bf16 a[252:255], a[140:143], a[60:63], a[252:255]
s_cbranch_scc1 Lg_1
s_cmp_eq_u32 s30, 0
s_cbranch_scc1 Lg_1t
v_mfma_f32_16x16x32_bf16 v[32:35], a[128:131], a[64:67], v[32:35]
s_add_u32 m0, s29, 81920
ds_read_b64_tr_b16 a[136:137], v5 offset:32768
v_mfma_f32_16x16x32_bf16 v[32:35], a[132:135], a[68:71], v[32:35]
buffer_load_dwordx4 v16, s[12:15], s27 offen offset:0 lds
v_mfma_f32_16x16x32_bf16 v[40:43], a[128:131], a[72:75], v[40:43]
s_lshl_b32 s22, s38, 3
ds_read_b64_tr_b16 a[138:139], v5 offset:34816
v_mfma_f32_16x16x32_bf16 v[40:43], a[132:135], a[76:79], v[40:43]
s_lshl_b32 s23, s39, 5
v_and_b32 v252, 31, v0
v_lshrrev_b32 v253, 5, v0
v_mfma_f32_16x16x32_bf16 v[48:51], a[128:131], a[80:83], v[48:51]
ds_read_b64_tr_b16 a[140:141], v5 offset:49152
v_add_u32 v253, s22, v253
v_mfma_f32_16x16x32_bf16 v[48:51], a[132:135], a[84:87], v[48:51]
buffer_load_dwordx4 v17, s[12:15], s27 offen offset:1024 lds
v_mfma_f32_16x16x32_bf16 v[56:59], a[128:131], a[88:91], v[56:59]
ds_read_b64_tr_b16 a[142:143], v5 offset:51200
v_add_u32 v252, s23, v252
v_mfma_f32_16x16x32_bf16 v[56:59], a[132:135], a[92:95], v[56:59]
v_mul_u32_u24 v254, 7168, v253
v_lshl_add_u32 v254, v252, 2, v254
v_mfma_f32_16x16x32_bf16 v[64:67], a[128:131], a[96:99], v[64:67]
ds_read_b128 a[0:3], v2 offset:0
v_lshlrev_b32 v252, 4, v252
v_mfma_f32_16x16x32_bf16 v[64:67], a[132:135], a[100:103], v[64:67]
buffer_load_dwordx4 v18, s[12:15], s27 offen offset:2048 lds
v_mfma_f32_16x16x32_bf16 v[72:75], a[128:131], a[104:107], v[72:75]
ds_read_b128 a[4:7], v3 offset:0
v_add_u32 v255, 3584, v254
v_mfma_f32_16x16x32_bf16 v[72:75], a[132:135], a[108:111], v[72:75]
v_subrev_u32 v22, 3584, v254
v_subrev_u32 v23, 2688, v254
v_mfma_f32_16x16x32_bf16 v[80:83], a[128:131], a[112:115], v[80:83]
v_subrev_u32 v24, 1792, v254
v_subrev_u32 v25, 896, v254
v_mfma_f32_16x16x32_bf16 v[80:83], a[132:135], a[116:119], v[80:83]
buffer_load_dwordx4 v19, s[12:15], s27 offen offset:3072 lds
v_mfma_f32_16x16x32_bf16 v[88:91], a[128:131], a[120:123], v[88:91]
s_add_u32 s27, s27, 524288
ds_read_b128 a[8:11], v2 offset:2048
v_mfma_f32_16x16x32_bf16 v[88:91], a[132:135], a[124:127], v[88:91]
s_waitcnt lgkmcnt(3)
v_mfma_f32_16x16x32_bf16 v[36:39], a[136:139], a[64:67], v[36:39]
s_add_u32 m0, s28, 32768
ds_read_b64_tr_b16 a[128:129], v6 offset:32768
v_mfma_f32_16x16x32_bf16 v[36:39], a[140:143], a[68:71], v[36:39]
buffer_load_dwordx4 v12, s[8:11], s24 offen offset:0 lds
v_mfma_f32_16x16x32_bf16 v[44:47], a[136:139], a[72:75], v[44:47]
ds_read_b64_tr_b16 a[130:131], v6 offset:34816
v_mfma_f32_16x16x32_bf16 v[44:47], a[140:143], a[76:79], v[44:47]
v_mfma_f32_16x16x32_bf16 v[52:55], a[136:139], a[80:83], v[52:55]
ds_read_b64_tr_b16 a[132:133], v6 offset:49152
v_mfma_f32_16x16x32_bf16 v[52:55], a[140:143], a[84:87], v[52:55]
buffer_load_dwordx4 v13, s[8:11], s24 offen offset:1024 lds
v_mfma_f32_16x16x32_bf16 v[60:63], a[136:139], a[88:91], v[60:63]
ds_read_b64_tr_b16 a[134:135], v6 offset:51200
v_mfma_f32_16x16x32_bf16 v[60:63], a[140:143], a[92:95], v[60:63]
v_mfma_f32_16x16x32_bf16 v[68:71], a[136:139], a[96:99], v[68:71]
ds_read_b128 a[12:15], v3 offset:2048
v_mfma_f32_16x16x32_bf16 v[68:71], a[140:143], a[100:103], v[68:71]
buffer_load_dwordx4 v14, s[8:11], s24 offen offset:2048 lds
v_mfma_f32_16x16x32_bf16 v[76:79], a[136:139], a[104:107], v[76:79]
v_mfma_f32_16x16x32_bf16 v[76:79], a[140:143], a[108:111], v[76:79]
v_mfma_f32_16x16x32_bf16 v[84:87], a[136:139], a[112:115], v[84:87]
ds_read_b128 a[16:19], v2 offset:4096
v_mfma_f32_16x16x32_bf16 v[84:87], a[140:143], a[116:119], v[84:87]
buffer_load_dwordx4 v15, s[8:11], s24 offen offset:3072 lds
v_mfma_f32_16x16x32_bf16 v[92:95], a[136:139], a[120:123], v[92:95]
s_add_u32 s24, s24, 128
ds_read_b128 a[20:23], v3 offset:4096
v_mfma_f32_16x16x32_bf16 v[92:95], a[140:143], a[124:127], v[92:95]
s_waitcnt lgkmcnt(3)
v_mfma_f32_16x16x32_bf16 v[96:99], a[128:131], a[64:67], v[96:99]
s_add_u32 m0, s28, 36864
ds_read_b64_tr_b16 a[136:137], v7 offset:32768
v_mfma_f32_16x16x32_bf16 v[96:99], a[132:135], a[68:71], v[96:99]
buffer_load_dwordx4 v12, s[8:11], s25 offen offset:0 lds
v_mfma_f32_16x16x32_bf16 v[104:107], a[128:131], a[72:75], v[104:107]
ds_read_b64_tr_b16 a[138:139], v7 offset:34816
v_mfma_f32_16x16x32_bf16 v[104:107], a[132:135], a[76:79], v[104:107]
v_mfma_f32_16x16x32_bf16 v[112:115], a[128:131], a[80:83], v[112:115]
ds_read_b64_tr_b16 a[140:141], v7 offset:49152
v_mfma_f32_16x16x32_bf16 v[112:115], a[132:135], a[84:87], v[112:115]
buffer_load_dwordx4 v13, s[8:11], s25 offen offset:1024 lds
v_mfma_f32_16x16x32_bf16 v[120:123], a[128:131], a[88:91], v[120:123]
ds_read_b64_tr_b16 a[142:143], v7 offset:51200
v_mfma_f32_16x16x32_bf16 v[120:123], a[132:135], a[92:95], v[120:123]
v_mfma_f32_16x16x32_bf16 v[128:131], a[128:131], a[96:99], v[128:131]
v_mfma_f32_16x16x32_bf16 v[128:131], a[132:135], a[100:103], v[128:131]
buffer_load_dwordx4 v14, s[8:11], s25 offen offset:2048 lds
v_mfma_f32_16x16x32_bf16 v[136:139], a[128:131], a[104:107], v[136:139]
ds_read_b128 a[24:27], v2 offset:6144
v_mfma_f32_16x16x32_bf16 v[136:139], a[132:135], a[108:111], v[136:139]
v_mfma_f32_16x16x32_bf16 v[144:147], a[128:131], a[112:115], v[144:147]
ds_read_b128 a[28:31], v3 offset:6144
v_mfma_f32_16x16x32_bf16 v[144:147], a[132:135], a[116:119], v[144:147]
buffer_load_dwordx4 v15, s[8:11], s25 offen offset:3072 lds
v_mfma_f32_16x16x32_bf16 v[152:155], a[128:131], a[120:123], v[152:155]
s_add_u32 s25, s25, 128
v_mfma_f32_16x16x32_bf16 v[152:155], a[132:135], a[124:127], v[152:155]
s_waitcnt lgkmcnt(2)
v_mfma_f32_16x16x32_bf16 v[100:103], a[136:139], a[64:67], v[100:103]
s_mov_b64 s[56:57], s[70:71]
s_mov_b32 s58, 3584
s_mov_b32 s59, 0x20000
ds_read_b64_tr_b16 a[128:129], v8 offset:32768
v_mfma_f32_16x16x32_bf16 v[100:103], a[140:143], a[68:71], v[100:103]
buffer_load_dwordx4 v[248:251], v252, s[56:59], 0 offen
v_mfma_f32_16x16x32_bf16 v[108:111], a[136:139], a[72:75], v[108:111]
s_mov_b64 s[56:57], s[66:67]
s_mov_b32 s58, 1835008
ds_read_b64_tr_b16 a[130:131], v8 offset:34816
v_mfma_f32_16x16x32_bf16 v[108:111], a[140:143], a[76:79], v[108:111]
buffer_load_dword v224, v22, s[56:59], 0 offen nt
v_mfma_f32_16x16x32_bf16 v[116:119], a[136:139], a[80:83], v[116:119]
ds_read_b64_tr_b16 a[132:133], v8 offset:49152
v_mfma_f32_16x16x32_bf16 v[116:119], a[140:143], a[84:87], v[116:119]
buffer_load_dword v225, v23, s[56:59], 0 offen nt
v_mfma_f32_16x16x32_bf16 v[124:127], a[136:139], a[88:91], v[124:127]
ds_read_b64_tr_b16 a[134:135], v8 offset:51200
v_mfma_f32_16x16x32_bf16 v[124:127], a[140:143], a[92:95], v[124:127]
buffer_load_dword v226, v24, s[56:59], 0 offen nt
v_mfma_f32_16x16x32_bf16 v[132:135], a[136:139], a[96:99], v[132:135]
ds_read_b128 a[32:35], v2 offset:8192
v_mfma_f32_16x16x32_bf16 v[132:135], a[140:143], a[100:103], v[132:135]
buffer_load_dword v227, v25, s[56:59], 0 offen nt
v_mfma_f32_16x16x32_bf16 v[140:143], a[136:139], a[104:107], v[140:143]
buffer_load_dword v228, v254, s[56:59], 0 offen offset:0 nt
v_mfma_f32_16x16x32_bf16 v[140:143], a[140:143], a[108:111], v[140:143]
buffer_load_dword v229, v254, s[56:59], 0 offen offset:896 nt
v_mfma_f32_16x16x32_bf16 v[148:151], a[136:139], a[112:115], v[148:151]
ds_read_b128 a[36:39], v3 offset:8192
v_mfma_f32_16x16x32_bf16 v[148:151], a[140:143], a[116:119], v[148:151]
buffer_load_dword v230, v254, s[56:59], 0 offen offset:1792 nt
v_mfma_f32_16x16x32_bf16 v[156:159], a[136:139], a[120:123], v[156:159]
ds_read_b128 a[40:43], v2 offset:10240
v_mfma_f32_16x16x32_bf16 v[156:159], a[140:143], a[124:127], v[156:159]
s_waitcnt lgkmcnt(3)
buffer_load_dword v231, v254, s[56:59], 0 offen offset:2688 nt
v_mfma_f32_16x16x32_bf16 v[160:163], a[128:131], a[64:67], v[160:163]
ds_read_b64_tr_b16 a[136:137], v9 offset:32768
v_mfma_f32_16x16x32_bf16 v[160:163], a[132:135], a[68:71], v[160:163]
buffer_load_dword v232, v255, s[56:59], 0 offen offset:0 nt
v_mfma_f32_16x16x32_bf16 v[168:171], a[128:131], a[72:75], v[168:171]
ds_read_b64_tr_b16 a[138:139], v9 offset:34816
v_mfma_f32_16x16x32_bf16 v[168:171], a[132:135], a[76:79], v[168:171]
buffer_load_dword v233, v255, s[56:59], 0 offen offset:896 nt
v_mfma_f32_16x16x32_bf16 v[176:179], a[128:131], a[80:83], v[176:179]
ds_read_b64_tr_b16 a[140:141], v9 offset:49152
v_mfma_f32_16x16x32_bf16 v[176:179], a[132:135], a[84:87], v[176:179]
buffer_load_dword v234, v255, s[56:59], 0 offen offset:1792 nt
v_mfma_f32_16x16x32_bf16 v[184:187], a[128:131], a[88:91], v[184:187]
ds_read_b64_tr_b16 a[142:143], v9 offset:51200
v_mfma_f32_16x16x32_bf16 v[184:187], a[132:135], a[92:95], v[184:187]
buffer_load_dword v235, v255, s[56:59], 0 offen offset:2688 nt
v_mfma_f32_16x16x32_bf16 v[192:195], a[128:131], a[96:99], v[192:195]
s_mov_b64 s[56:57], s[68:69]
buffer_load_dword v236, v25, s[56:59], 0 offen nt
v_mfma_f32_16x16x32_bf16 v[192:195], a[132:135], a[100:103], v[192:195]
buffer_load_dword v237, v254, s[56:59], 0 offen offset:0 nt
v_mfma_f32_16x16x32_bf16 v[200:203], a[128:131], a[104:107], v[200:203]
ds_read_b128 a[44:47], v3 offset:10240
v_mfma_f32_16x16x32_bf16 v[200:203], a[132:135], a[108:111], v[200:203]
buffer_load_dword v238, v254, s[56:59], 0 offen offset:896 nt
v_mfma_f32_16x16x32_bf16 v[208:211], a[128:131], a[112:115], v[208:211]
ds_read_b128 a[48:51], v2 offset:12288
v_mfma_f32_16x16x32_bf16 v[208:211], a[132:135], a[116:119], v[208:211]
buffer_load_dword v239, v254, s[56:59], 0 offen offset:1792 nt
v_mfma_f32_16x16x32_bf16 v[216:219], a[128:131], a[120:123], v[216:219]
buffer_load_dword v240, v254, s[56:59], 0 offen offset:2688 nt
v_mfma_f32_16x16x32_bf16 v[216:219], a[132:135], a[124:127], v[216:219]
s_waitcnt lgkmcnt(2)
buffer_load_dword v241, v255, s[56:59], 0 offen offset:0 nt
v_mfma_f32_16x16x32_bf16 v[164:167], a[136:139], a[64:67], v[164:167]
ds_read_b64_tr_b16 a[128:129], v10 offset:32768
v_mfma_f32_16x16x32_bf16 v[164:167], a[140:143], a[68:71], v[164:167]
buffer_load_dword v242, v255, s[56:59], 0 offen offset:896 nt
v_mfma_f32_16x16x32_bf16 v[172:175], a[136:139], a[72:75], v[172:175]
ds_read_b64_tr_b16 a[130:131], v10 offset:34816
v_mfma_f32_16x16x32_bf16 v[172:175], a[140:143], a[76:79], v[172:175]
buffer_load_dword v243, v255, s[56:59], 0 offen offset:1792 nt
v_mfma_f32_16x16x32_bf16 v[180:183], a[136:139], a[80:83], v[180:183]
ds_read_b64_tr_b16 a[132:133], v10 offset:49152
v_mfma_f32_16x16x32_bf16 v[180:183], a[140:143], a[84:87], v[180:183]
buffer_load_dword v244, v255, s[56:59], 0 offen offset:2688 nt
v_mfma_f32_16x16x32_bf16 v[188:191], a[136:139], a[88:91], v[188:191]
ds_read_b64_tr_b16 a[134:135], v10 offset:51200
v_mfma_f32_16x16x32_bf16 v[188:191], a[140:143], a[92:95], v[188:191]
v_mfma_f32_16x16x32_bf16 v[196:199], a[136:139], a[96:99], v[196:199]
ds_read_b128 a[52:55], v3 offset:12288
v_mfma_f32_16x16x32_bf16 v[196:199], a[140:143], a[100:103], v[196:199]
v_mfma_f32_16x16x32_bf16 v[204:207], a[136:139], a[104:107], v[204:207]
ds_read_b128 a[56:59], v2 offset:14336
v_mfma_f32_16x16x32_bf16 v[204:207], a[140:143], a[108:111], v[204:207]
v_mfma_f32_16x16x32_bf16 v[212:215], a[136:139], a[112:115], v[212:215]
v_mfma_f32_16x16x32_bf16 v[212:215], a[140:143], a[116:119], v[212:215]
v_mfma_f32_16x16x32_bf16 v[220:223], a[136:139], a[120:123], v[220:223]
ds_read_b128 a[60:63], v3 offset:14336
v_mfma_f32_16x16x32_bf16 v[220:223], a[140:143], a[124:127], v[220:223]
s_waitcnt lgkmcnt(3)
v_mfma_f32_16x16x32_bf16 a[192:195], a[128:131], a[64:67], a[192:195]
ds_read_b64_tr_b16 a[136:137], v11 offset:32768
v_mfma_f32_16x16x32_bf16 a[192:195], a[132:135], a[68:71], a[192:195]
v_mfma_f32_16x16x32_bf16 a[200:203], a[128:131], a[72:75], a[200:203]
ds_read_b64_tr_b16 a[138:139], v11 offset:34816
v_mfma_f32_16x16x32_bf16 a[200:203], a[132:135], a[76:79], a[200:203]
v_mfma_f32_16x16x32_bf16 a[208:211], a[128:131], a[80:83], a[208:211]
ds_read_b64_tr_b16 a[140:141], v11 offset:49152
v_mfma_f32_16x16x32_bf16 a[208:211], a[132:135], a[84:87], a[208:211]
v_mfma_f32_16x16x32_bf16 a[216:219], a[128:131], a[88:91], a[216:219]
ds_read_b64_tr_b16 a[142:143], v11 offset:51200
v_mfma_f32_16x16x32_bf16 a[216:219], a[132:135], a[92:95], a[216:219]
v_mfma_f32_16x16x32_bf16 a[224:227], a[128:131], a[96:99], a[224:227]
v_mfma_f32_16x16x32_bf16 a[224:227], a[132:135], a[100:103], a[224:227]
v_mfma_f32_16x16x32_bf16 a[232:235], a[128:131], a[104:107], a[232:235]
v_mfma_f32_16x16x32_bf16 a[232:235], a[132:135], a[108:111], a[232:235]
v_mfma_f32_16x16x32_bf16 a[240:243], a[128:131], a[112:115], a[240:243]
v_mfma_f32_16x16x32_bf16 a[240:243], a[132:135], a[116:119], a[240:243]
v_mfma_f32_16x16x32_bf16 a[248:251], a[128:131], a[120:123], a[248:251]
s_waitcnt vmcnt(22) lgkmcnt(0)
v_mfma_f32_16x16x32_bf16 a[248:251], a[132:135], a[124:127], a[248:251]
s_barrier
v_mfma_f32_16x16x32_bf16 a[196:199], a[136:139], a[64:67], a[196:199]
s_add_u32 m0, s29, 98304
ds_read_b64_tr_b16 a[128:129], v4 offset:0
v_mfma_f32_16x16x32_bf16 a[196:199], a[140:143], a[68:71], a[196:199]
buffer_load_dwordx4 v16, s[12:15], s26 offen offset:0 lds
v_mfma_f32_16x16x32_bf16 a[204:207], a[136:139], a[72:75], a[204:207]
ds_read_b64_tr_b16 a[130:131], v4 offset:2048
v_mfma_f32_16x16x32_bf16 a[204:207], a[140:143], a[76:79], a[204:207]
v_mfma_f32_16x16x32_bf16 a[212:215], a[136:139], a[80:83], a[212:215]
ds_read_b64_tr_b16 a[132:133], v4 offset:16384
v_mfma_f32_16x16x32_bf16 a[212:215], a[140:143], a[84:87], a[212:215]
buffer_load_dwordx4 v17, s[12:15], s26 offen offset:1024 lds
v_mfma_f32_16x16x32_bf16 a[220:223], a[136:139], a[88:91], a[220:223]
ds_read_b64_tr_b16 a[134:135], v4 offset:18432
v_mfma_f32_16x16x32_bf16 a[220:223], a[140:143], a[92:95], a[220:223]
v_mfma_f32_16x16x32_bf16 a[228:231], a[136:139], a[96:99], a[228:231]
v_mfma_f32_16x16x32_bf16 a[228:231], a[140:143], a[100:103], a[228:231]
buffer_load_dwordx4 v18, s[12:15], s26 offen offset:2048 lds
v_mfma_f32_16x16x32_bf16 a[236:239], a[136:139], a[104:107], a[236:239]
v_mfma_f32_16x16x32_bf16 a[236:239], a[140:143], a[108:111], a[236:239]
v_mfma_f32_16x16x32_bf16 a[244:247], a[136:139], a[112:115], a[244:247]
v_mfma_f32_16x16x32_bf16 a[244:247], a[140:143], a[116:119], a[244:247]
buffer_load_dwordx4 v19, s[12:15], s26 offen offset:3072 lds
v_mfma_f32_16x16x32_bf16 a[252:255], a[136:139], a[120:123], a[252:255]
s_add_u32 s26, s26, 524288
v_mfma_f32_16x16x32_bf16 a[252:255], a[140:143], a[124:127], a[252:255]
s_waitcnt lgkmcnt(0)
v_mfma_f32_16x16x32_bf16 v[32:35], a[128:131], a[0:3], v[32:35]
s_add_u32 m0, s29, 114688
ds_read_b64_tr_b16 a[136:137], v5 offset:0
v_mfma_f32_16x16x32_bf16 v[32:35], a[132:135], a[4:7], v[32:35]
buffer_load_dwordx4 v16, s[12:15], s27 offen offset:0 lds
v_mfma_f32_16x16x32_bf16 v[40:43], a[128:131], a[8:11], v[40:43]
ds_read_b64_tr_b16 a[138:139], v5 offset:2048
v_mfma_f32_16x16x32_bf16 v[40:43], a[132:135], a[12:15], v[40:43]
v_mfma_f32_16x16x32_bf16 v[48:51], a[128:131], a[16:19], v[48:51]
ds_read_b64_tr_b16 a[140:141], v5 offset:16384
v_mfma_f32_16x16x32_bf16 v[48:51], a[132:135], a[20:23], v[48:51]
buffer_load_dwordx4 v17, s[12:15], s27 offen offset:1024 lds
v_mfma_f32_16x16x32_bf16 v[56:59], a[128:131], a[24:27], v[56:59]
ds_read_b64_tr_b16 a[142:143], v5 offset:18432
v_mfma_f32_16x16x32_bf16 v[56:59], a[132:135], a[28:31], v[56:59]
v_mfma_f32_16x16x32_bf16 v[64:67], a[128:131], a[32:35], v[64:67]
ds_read_b128 a[64:67], v2 offset:32768
v_mfma_f32_16x16x32_bf16 v[64:67], a[132:135], a[36:39], v[64:67]
buffer_load_dwordx4 v18, s[12:15], s27 offen offset:2048 lds
v_mfma_f32_16x16x32_bf16 v[72:75], a[128:131], a[40:43], v[72:75]
ds_read_b128 a[68:71], v3 offset:32768
v_mfma_f32_16x16x32_bf16 v[72:75], a[132:135], a[44:47], v[72:75]
v_mfma_f32_16x16x32_bf16 v[80:83], a[128:131], a[48:51], v[80:83]
v_mfma_f32_16x16x32_bf16 v[80:83], a[132:135], a[52:55], v[80:83]
buffer_load_dwordx4 v19, s[12:15], s27 offen offset:3072 lds
v_mfma_f32_16x16x32_bf16 v[88:91], a[128:131], a[56:59], v[88:91]
s_add_u32 s27, s27, 524288
ds_read_b128 a[72:75], v2 offset:34816
v_mfma_f32_16x16x32_bf16 v[88:91], a[132:135], a[60:63], v[88:91]
s_waitcnt lgkmcnt(3)
v_mfma_f32_16x16x32_bf16 v[36:39], a[136:139], a[0:3], v[36:39]
s_add_u32 m0, s28, 0
ds_read_b64_tr_b16 a[128:129], v6 offset:0
v_mfma_f32_16x16x32_bf16 v[36:39], a[140:143], a[4:7], v[36:39]
buffer_load_dwordx4 v12, s[8:11], s24 offen offset:0 lds
v_mfma_f32_16x16x32_bf16 v[44:47], a[136:139], a[8:11], v[44:47]
ds_read_b64_tr_b16 a[130:131], v6 offset:2048
v_mfma_f32_16x16x32_bf16 v[44:47], a[140:143], a[12:15], v[44:47]
v_mfma_f32_16x16x32_bf16 v[52:55], a[136:139], a[16:19], v[52:55]
ds_read_b64_tr_b16 a[132:133], v6 offset:16384
v_mfma_f32_16x16x32_bf16 v[52:55], a[140:143], a[20:23], v[52:55]
buffer_load_dwordx4 v13, s[8:11], s24 offen offset:1024 lds
v_mfma_f32_16x16x32_bf16 v[60:63], a[136:139], a[24:27], v[60:63]
ds_read_b64_tr_b16 a[134:135], v6 offset:18432
v_mfma_f32_16x16x32_bf16 v[60:63], a[140:143], a[28:31], v[60:63]
v_mfma_f32_16x16x32_bf16 v[68:71], a[136:139], a[32:35], v[68:71]
ds_read_b128 a[76:79], v3 offset:34816
v_mfma_f32_16x16x32_bf16 v[68:71], a[140:143], a[36:39], v[68:71]
buffer_load_dwordx4 v14, s[8:11], s24 offen offset:2048 lds
v_mfma_f32_16x16x32_bf16 v[76:79], a[136:139], a[40:43], v[76:79]
v_mfma_f32_16x16x32_bf16 v[76:79], a[140:143], a[44:47], v[76:79]
v_mfma_f32_16x16x32_bf16 v[84:87], a[136:139], a[48:51], v[84:87]
ds_read_b128 a[80:83], v2 offset:36864
v_mfma_f32_16x16x32_bf16 v[84:87], a[140:143], a[52:55], v[84:87]
buffer_load_dwordx4 v15, s[8:11], s24 offen offset:3072 lds
v_mfma_f32_16x16x32_bf16 v[92:95], a[136:139], a[56:59], v[92:95]
s_add_u32 s24, s24, 128
ds_read_b128 a[84:87], v3 offset:36864
v_mfma_f32_16x16x32_bf16 v[92:95], a[140:143], a[60:63], v[92:95]
s_waitcnt lgkmcnt(3)
v_mfma_f32_16x16x32_bf16 v[96:99], a[128:131], a[0:3], v[96:99]
s_add_u32 m0, s28, 4096
ds_read_b64_tr_b16 a[136:137], v7 offset:0
v_mfma_f32_16x16x32_bf16 v[96:99], a[132:135], a[4:7], v[96:99]
buffer_load_dwordx4 v12, s[8:11], s25 offen offset:0 lds
v_mfma_f32_16x16x32_bf16 v[104:107], a[128:131], a[8:11], v[104:107]
ds_read_b64_tr_b16 a[138:139], v7 offset:2048
v_mfma_f32_16x16x32_bf16 v[104:107], a[132:135], a[12:15], v[104:107]
v_mfma_f32_16x16x32_bf16 v[112:115], a[128:131], a[16:19], v[112:115]
ds_read_b64_tr_b16 a[140:141], v7 offset:16384
v_mfma_f32_16x16x32_bf16 v[112:115], a[132:135], a[20:23], v[112:115]
buffer_load_dwordx4 v13, s[8:11], s25 offen offset:1024 lds
v_mfma_f32_16x16x32_bf16 v[120:123], a[128:131], a[24:27], v[120:123]
ds_read_b64_tr_b16 a[142:143], v7 offset:18432
v_mfma_f32_16x16x32_bf16 v[120:123], a[132:135], a[28:31], v[120:123]
v_mfma_f32_16x16x32_bf16 v[128:131], a[128:131], a[32:35], v[128:131]
v_mfma_f32_16x16x32_bf16 v[128:131], a[132:135], a[36:39], v[128:131]
buffer_load_dwordx4 v14, s[8:11], s25 offen offset:2048 lds
v_mfma_f32_16x16x32_bf16 v[136:139], a[128:131], a[40:43], v[136:139]
ds_read_b128 a[88:91], v2 offset:38912
v_mfma_f32_16x16x32_bf16 v[136:139], a[132:135], a[44:47], v[136:139]
v_mfma_f32_16x16x32_bf16 v[144:147], a[128:131], a[48:51], v[144:147]
ds_read_b128 a[92:95], v3 offset:38912
v_mfma_f32_16x16x32_bf16 v[144:147], a[132:135], a[52:55], v[144:147]
buffer_load_dwordx4 v15, s[8:11], s25 offen offset:3072 lds
v_mfma_f32_16x16x32_bf16 v[152:155], a[128:131], a[56:59], v[152:155]
s_add_u32 s25, s25, 128
v_mfma_f32_16x16x32_bf16 v[152:155], a[132:135], a[60:63], v[152:155]
s_waitcnt lgkmcnt(2)
v_mfma_f32_16x16x32_bf16 v[100:103], a[136:139], a[0:3], v[100:103]
PAD_2:
s_cbranch_execz M_tret
ds_read_b64_tr_b16 a[128:129], v8 offset:0
v_mfma_f32_16x16x32_bf16 v[100:103], a[140:143], a[4:7], v[100:103]
buffer_load_dword v21, v20, s[16:19], s43 offen
v_mfma_f32_16x16x32_bf16 v[108:111], a[136:139], a[8:11], v[108:111]
s_add_u32 s43, s43, s47
ds_read_b64_tr_b16 a[130:131], v8 offset:2048
v_mfma_f32_16x16x32_bf16 v[108:111], a[140:143], a[12:15], v[108:111]
s_cmp_ge_u32 s43, s51
v_mfma_f32_16x16x32_bf16 v[116:119], a[136:139], a[16:19], v[116:119]
s_cselect_b32 s43, 0, s43
ds_read_b64_tr_b16 a[132:133], v8 offset:16384
v_mfma_f32_16x16x32_bf16 v[116:119], a[140:143], a[20:23], v[116:119]
s_cselect_b32 s51, s42, s51
v_mfma_f32_16x16x32_bf16 v[124:127], a[136:139], a[24:27], v[124:127]
s_cselect_b64 s[16:17], s[40:41], s[16:17]
ds_read_b64_tr_b16 a[134:135], v8 offset:18432
v_mfma_f32_16x16x32_bf16 v[124:127], a[140:143], a[28:31], v[124:127]
s_cselect_b32 s18, s42, s18
v_mfma_f32_16x16x32_bf16 v[132:135], a[136:139], a[32:35], v[132:135]
s_cselect_b64 s[40:41], s[44:45], s[40:41]
ds_read_b128 a[96:99], v2 offset:40960
v_mfma_f32_16x16x32_bf16 v[132:135], a[140:143], a[36:39], v[132:135]
s_cselect_b32 s42, s46, s42
v_mfma_f32_16x16x32_bf16 v[140:143], a[136:139], a[40:43], v[140:143]
s_cselect_b32 s46, 0, s46
v_mfma_f32_16x16x32_bf16 v[140:143], a[140:143], a[44:47], v[140:143]
s_lshl_b32 s59, s39, 5
v_mfma_f32_16x16x32_bf16 v[148:151], a[136:139], a[48:51], v[148:151]
s_add_u32 s59, s59, s38
ds_read_b128 a[100:103], v3 offset:40960
v_mfma_f32_16x16x32_bf16 v[148:151], a[140:143], a[52:55], v[148:151]
s_lshl_b32 s59, s59, 2
v_mfma_f32_16x16x32_bf16 v[156:159], a[136:139], a[56:59], v[156:159]
s_add_u32 s59, s59, 94392320
ds_read_b128 a[104:107], v2 offset:43008
v_mfma_f32_16x16x32_bf16 v[156:159], a[140:143], a[60:63], v[156:159]
s_waitcnt lgkmcnt(3)
s_cmp_lt_u32 s2, 224
v_mfma_f32_16x16x32_bf16 v[160:163], a[128:131], a[0:3], v[160:163]
s_cselect_b32 s59, s59, 3221225472
ds_read_b64_tr_b16 a[136:137], v9 offset:0
v_mfma_f32_16x16x32_bf16 v[160:163], a[132:135], a[4:7], v[160:163]
s_mov_b32 s58, 0xffff0000
v_mfma_f32_16x16x32_bf16 v[168:171], a[128:131], a[8:11], v[168:171]
s_cmp_lt_u32 s3, 1
ds_read_b64_tr_b16 a[138:139], v9 offset:2048
v_mfma_f32_16x16x32_bf16 v[168:171], a[132:135], a[12:15], v[168:171]
s_cselect_b32 s54, 0, 3221225472
v_mfma_f32_16x16x32_bf16 v[176:179], a[128:131], a[16:19], v[176:179]
s_cselect_b32 s50, 0x100, 0
ds_read_b64_tr_b16 a[140:141], v9 offset:16384
v_mfma_f32_16x16x32_bf16 v[176:179], a[132:135], a[20:23], v[176:179]
buffer_load_dword v21, v20, s[16:19], s43 offen
v_mfma_f32_16x16x32_bf16 v[184:187], a[128:131], a[24:27], v[184:187]
s_add_u32 s43, s43, s47
ds_read_b64_tr_b16 a[142:143], v9 offset:18432
v_mfma_f32_16x16x32_bf16 v[184:187], a[132:135], a[28:31], v[184:187]
s_cmp_ge_u32 s43, s51
v_mfma_f32_16x16x32_bf16 v[192:195], a[128:131], a[32:35], v[192:195]
s_cselect_b32 s43, 0, s43
v_mfma_f32_16x16x32_bf16 v[192:195], a[132:135], a[36:39], v[192:195]
s_cselect_b32 s51, s42, s51
v_mfma_f32_16x16x32_bf16 v[200:203], a[128:131], a[40:43], v[200:203]
s_cselect_b64 s[16:17], s[40:41], s[16:17]
ds_read_b128 a[108:111], v3 offset:43008
v_mfma_f32_16x16x32_bf16 v[200:203], a[132:135], a[44:47], v[200:203]
s_cselect_b32 s18, s42, s18
v_mfma_f32_16x16x32_bf16 v[208:211], a[128:131], a[48:51], v[208:211]
s_cselect_b64 s[40:41], s[44:45], s[40:41]
ds_read_b128 a[112:115], v2 offset:45056
v_mfma_f32_16x16x32_bf16 v[208:211], a[132:135], a[52:55], v[208:211]
s_cselect_b32 s42, s46, s42
v_mfma_f32_16x16x32_bf16 v[216:219], a[128:131], a[56:59], v[216:219]
s_cselect_b32 s46, 0, s46
v_mfma_f32_16x16x32_bf16 v[216:219], a[132:135], a[60:63], v[216:219]
s_waitcnt lgkmcnt(2)
v_mfma_f32_16x16x32_bf16 v[164:167], a[136:139], a[0:3], v[164:167]
ds_read_b64_tr_b16 a[128:129], v10 offset:0
v_mfma_f32_16x16x32_bf16 v[164:167], a[140:143], a[4:7], v[164:167]
v_mfma_f32_16x16x32_bf16 v[172:175], a[136:139], a[8:11], v[172:175]
ds_read_b64_tr_b16 a[130:131], v10 offset:2048
v_mfma_f32_16x16x32_bf16 v[172:175], a[140:143], a[12:15], v[172:175]
v_mfma_f32_16x16x32_bf16 v[180:183], a[136:139], a[16:19], v[180:183]
ds_read_b64_tr_b16 a[132:133], v10 offset:16384
v_mfma_f32_16x16x32_bf16 v[180:183], a[140:143], a[20:23], v[180:183]
v_mfma_f32_16x16x32_bf16 v[188:191], a[136:139], a[24:27], v[188:191]
ds_read_b64_tr_b16 a[134:135], v10 offset:18432
v_mfma_f32_16x16x32_bf16 v[188:191], a[140:143], a[28:31], v[188:191]
v_mfma_f32_16x16x32_bf16 v[196:199], a[136:139], a[32:35], v[196:199]
ds_read_b128 a[116:119], v3 offset:45056
v_mfma_f32_16x16x32_bf16 v[196:199], a[140:143], a[36:39], v[196:199]
v_mfma_f32_16x16x32_bf16 v[204:207], a[136:139], a[40:43], v[204:207]
ds_read_b128 a[120:123], v2 offset:47104
v_and_b32 v252, 31, v0
v_mfma_f32_16x16x32_bf16 v[204:207], a[140:143], a[44:47], v[204:207]
v_lshrrev_b32 v253, 5, v0
v_xor_b32 v253, v253, v252
v_mfma_f32_16x16x32_bf16 v[212:215], a[136:139], a[48:51], v[212:215]
v_and_b32 v253, 7, v253
v_lshlrev_b32 v252, 8, v252
v_mfma_f32_16x16x32_bf16 v[212:215], a[140:143], a[52:55], v[212:215]
v_lshl_add_u32 v252, v253, 4, v252
v_add_u32 v252, 147456, v252
v_mfma_f32_16x16x32_bf16 v[220:223], a[136:139], a[56:59], v[220:223]
ds_read_b128 a[124:127], v3 offset:47104
v_mfma_f32_16x16x32_bf16 v[220:223], a[140:143], a[60:63], v[220:223]
s_waitcnt lgkmcnt(3)
v_mfma_f32_16x16x32_bf16 a[192:195], a[128:131], a[0:3], a[192:195]
ds_read_b64_tr_b16 a[136:137], v11 offset:0
v_mfma_f32_16x16x32_bf16 a[192:195], a[132:135], a[4:7], a[192:195]
v_mfma_f32_16x16x32_bf16 a[200:203], a[128:131], a[8:11], a[200:203]
ds_read_b64_tr_b16 a[138:139], v11 offset:2048
v_mfma_f32_16x16x32_bf16 a[200:203], a[132:135], a[12:15], a[200:203]
v_mfma_f32_16x16x32_bf16 a[208:211], a[128:131], a[16:19], a[208:211]
ds_read_b64_tr_b16 a[140:141], v11 offset:16384
v_mfma_f32_16x16x32_bf16 a[208:211], a[132:135], a[20:23], a[208:211]
v_mfma_f32_16x16x32_bf16 a[216:219], a[128:131], a[24:27], a[216:219]
ds_read_b64_tr_b16 a[142:143], v11 offset:18432
v_mfma_f32_16x16x32_bf16 a[216:219], a[132:135], a[28:31], a[216:219]
v_mfma_f32_16x16x32_bf16 a[224:227], a[128:131], a[32:35], a[224:227]
v_mfma_f32_16x16x32_bf16 a[224:227], a[132:135], a[36:39], a[224:227]
v_mfma_f32_16x16x32_bf16 a[232:235], a[128:131], a[40:43], a[232:235]
v_mfma_f32_16x16x32_bf16 a[232:235], a[132:135], a[44:47], a[232:235]
v_mfma_f32_16x16x32_bf16 a[240:243], a[128:131], a[48:51], a[240:243]
v_mfma_f32_16x16x32_bf16 a[240:243], a[132:135], a[52:55], a[240:243]
v_mfma_f32_16x16x32_bf16 a[248:251], a[128:131], a[56:59], a[248:251]
s_waitcnt vmcnt(2) lgkmcnt(0)
v_mfma_f32_16x16x32_bf16 a[248:251], a[132:135], a[60:63], a[248:251]
s_barrier
v_mfma_f32_16x16x32_bf16 a[196:199], a[136:139], a[0:3], a[196:199]
s_add_u32 m0, s29, 65536
ds_read_b64_tr_b16 a[128:129], v4 offset:32768
v_lshlrev_b32 v28, 16, v248
v_mfma_f32_16x16x32_bf16 a[196:199], a[140:143], a[4:7], a[196:199]
buffer_load_dwordx4 v16, s[12:15], s26 offen offset:0 lds
v_mfma_f32_16x16x32_bf16 a[204:207], a[136:139], a[8:11], a[204:207]
ds_read_b64_tr_b16 a[130:131], v4 offset:34816
v_and_b32 v29, s58, v248
v_mfma_f32_16x16x32_bf16 a[204:207], a[140:143], a[12:15], a[204:207]
v_lshlrev_b32 v30, 16, v249
v_and_b32 v253, s58, v249
v_mfma_f32_16x16x32_bf16 a[212:215], a[136:139], a[16:19], a[212:215]
ds_read_b64_tr_b16 a[132:133], v4 offset:49152
v_lshlrev_b32 v22, 16, v224
v_mfma_f32_16x16x32_bf16 a[212:215], a[140:143], a[20:23], a[212:215]
buffer_load_dwordx4 v17, s[12:15], s26 offen offset:1024 lds
v_mfma_f32_16x16x32_bf16 a[220:223], a[136:139], a[24:27], a[220:223]
ds_read_b64_tr_b16 a[134:135], v4 offset:51200
v_lshlrev_b32 v23, 16, v225
v_mfma_f32_16x16x32_bf16 a[220:223], a[140:143], a[28:31], a[220:223]
v_lshlrev_b32 v24, 16, v226
v_mul_f32 v254, v22, v253
v_mfma_f32_16x16x32_bf16 a[228:231], a[136:139], a[32:35], a[228:231]
v_lshlrev_b32 v25, 16, v227
v_lshlrev_b32 v247, 16, v236
v_mfma_f32_16x16x32_bf16 a[228:231], a[140:143], a[36:39], a[228:231]
buffer_load_dwordx4 v18, s[12:15], s26 offen offset:2048 lds
v_mfma_f32_16x16x32_bf16 a[236:239], a[136:139], a[40:43], a[236:239]
v_fmac_f32 v254, v23, v30
v_fmac_f32 v254, v24, v29
v_mfma_f32_16x16x32_bf16 a[236:239], a[140:143], a[44:47], a[236:239]
v_fmac_f32 v254, v25, v28
v_mul_f32 v254, v254, v247
v_mfma_f32_16x16x32_bf16 a[244:247], a[136:139], a[48:51], a[244:247]
v_mul_f32 v255, v23, v253
v_lshlrev_b32 v22, 16, v228
v_mfma_f32_16x16x32_bf16 a[244:247], a[140:143], a[52:55], a[244:247]
buffer_load_dwordx4 v19, s[12:15], s26 offen offset:3072 lds
v_mfma_f32_16x16x32_bf16 a[252:255], a[136:139], a[56:59], a[252:255]
s_add_u32 s26, s26, 524288
v_lshlrev_b32 v247, 16, v237
v_fmac_f32 v255, v24, v30
v_mfma_f32_16x16x32_bf16 a[252:255], a[140:143], a[60:63], a[252:255]
s_waitcnt lgkmcnt(0)
v_fmac_f32 v255, v25, v29
v_fmac_f32 v255, v22, v28
v_mfma_f32_16x16x32_bf16 v[32:35], a[128:131], a[64:67], v[32:35]
s_add_u32 m0, s29, 81920
ds_read_b64_tr_b16 a[136:137], v5 offset:32768
v_mul_f32 v255, v255, v247
v_mfma_f32_16x16x32_bf16 v[32:35], a[132:135], a[68:71], v[32:35]
buffer_load_dwordx4 v16, s[12:15], s27 offen offset:0 lds
v_mfma_f32_16x16x32_bf16 v[40:43], a[128:131], a[72:75], v[40:43]
ds_read_b64_tr_b16 a[138:139], v5 offset:34816
v_cvt_pk_bf16_f32 v246, v254, v255
v_mfma_f32_16x16x32_bf16 v[40:43], a[132:135], a[76:79], v[40:43]
v_accvgpr_write_b32 a180, v246
v_mul_f32 v254, v24, v253
v_mfma_f32_16x16x32_bf16 v[48:51], a[128:131], a[80:83], v[48:51]
ds_read_b64_tr_b16 a[140:141], v5 offset:49152
v_lshlrev_b32 v23, 16, v229
v_mfma_f32_16x16x32_bf16 v[48:51], a[132:135], a[84:87], v[48:51]
buffer_load_dwordx4 v17, s[12:15], s27 offen offset:1024 lds
v_mfma_f32_16x16x32_bf16 v[56:59], a[128:131], a[88:91], v[56:59]
ds_read_b64_tr_b16 a[142:143], v5 offset:51200
v_lshlrev_b32 v247, 16, v238
v_mfma_f32_16x16x32_bf16 v[56:59], a[132:135], a[92:95], v[56:59]
v_fmac_f32 v254, v25, v30
v_fmac_f32 v254, v22, v29
v_fmac_f32 v254, v23, v28
v_mfma_f32_16x16x32_bf16 v[64:67], a[128:131], a[96:99], v[64:67]
ds_read_b128 a[0:3], v2 offset:0
v_mul_f32 v254, v254, v247
v_mfma_f32_16x16x32_bf16 v[64:67], a[132:135], a[100:103], v[64:67]
buffer_load_dwordx4 v18, s[12:15], s27 offen offset:2048 lds
v_mfma_f32_16x16x32_bf16 v[72:75], a[128:131], a[104:107], v[72:75]
ds_read_b128 a[4:7], v3 offset:0
v_cvt_pk_bf16_f32 v246, v255, v254
v_mfma_f32_16x16x32_bf16 v[72:75], a[132:135], a[108:111], v[72:75]
v_accvgpr_write_b32 a176, v246
v_mul_f32 v255, v25, v253
v_mfma_f32_16x16x32_bf16 v[80:83], a[128:131], a[112:115], v[80:83]
v_lshlrev_b32 v24, 16, v230
v_lshlrev_b32 v247, 16, v239
v_mfma_f32_16x16x32_bf16 v[80:83], a[132:135], a[116:119], v[80:83]
buffer_load_dwordx4 v19, s[12:15], s27 offen offset:3072 lds
v_mfma_f32_16x16x32_bf16 v[88:91], a[128:131], a[120:123], v[88:91]
s_add_u32 s27, s27, 524288
ds_read_b128 a[8:11], v2 offset:2048
v_fmac_f32 v255, v22, v30
v_mfma_f32_16x16x32_bf16 v[88:91], a[132:135], a[124:127], v[88:91]
s_waitcnt lgkmcnt(3)
v_fmac_f32 v255, v23, v29
v_fmac_f32 v255, v24, v28
v_mul_f32 v255, v255, v247
v_mfma_f32_16x16x32_bf16 v[36:39], a[136:139], a[64:67], v[36:39]
s_add_u32 m0, s28, 32768
ds_read_b64_tr_b16 a[128:129], v6 offset:32768
v_cvt_pk_bf16_f32 v246, v254, v255
v_mfma_f32_16x16x32_bf16 v[36:39], a[140:143], a[68:71], v[36:39]
buffer_load_dwordx4 v12, s[8:11], s24 offen offset:0 lds
v_mfma_f32_16x16x32_bf16 v[44:47], a[136:139], a[72:75], v[44:47]
ds_read_b64_tr_b16 a[130:131], v6 offset:34816
v_accvgpr_write_b32 a181, v246
v_mfma_f32_16x16x32_bf16 v[44:47], a[140:143], a[76:79], v[44:47]
v_mul_f32 v254, v22, v253
v_lshlrev_b32 v25, 16, v231
v_mfma_f32_16x16x32_bf16 v[52:55], a[136:139], a[80:83], v[52:55]
ds_read_b64_tr_b16 a[132:133], v6 offset:49152
v_lshlrev_b32 v247, 16, v240
v_mfma_f32_16x16x32_bf16 v[52:55], a[140:143], a[84:87], v[52:55]
buffer_load_dwordx4 v13, s[8:11], s24 offen offset:1024 lds
v_mfma_f32_16x16x32_bf16 v[60:63], a[136:139], a[88:91], v[60:63]
ds_read_b64_tr_b16 a[134:135], v6 offset:51200
v_fmac_f32 v254, v23, v30
v_fmac_f32 v254, v24, v29
v_mfma_f32_16x16x32_bf16 v[60:63], a[140:143], a[92:95], v[60:63]
v_fmac_f32 v254, v25, v28
v_mul_f32 v254, v254, v247
v_mfma_f32_16x16x32_bf16 v[68:71], a[136:139], a[96:99], v[68:71]
ds_read_b128 a[12:15], v3 offset:2048
v_cvt_pk_bf16_f32 v246, v255, v254
v_mfma_f32_16x16x32_bf16 v[68:71], a[140:143], a[100:103], v[68:71]
buffer_load_dwordx4 v14, s[8:11], s24 offen offset:2048 lds
v_mfma_f32_16x16x32_bf16 v[76:79], a[136:139], a[104:107], v[76:79]
v_accvgpr_write_b32 a177, v246
v_mul_f32 v255, v23, v253
v_mfma_f32_16x16x32_bf16 v[76:79], a[140:143], a[108:111], v[76:79]
v_lshlrev_b32 v22, 16, v232
v_lshlrev_b32 v247, 16, v241
v_mfma_f32_16x16x32_bf16 v[84:87], a[136:139], a[112:115], v[84:87]
ds_read_b128 a[16:19], v2 offset:4096
v_fmac_f32 v255, v24, v30
v_mfma_f32_16x16x32_bf16 v[84:87], a[140:143], a[116:119], v[84:87]
buffer_load_dwordx4 v15, s[8:11], s24 offen offset:3072 lds
v_mfma_f32_16x16x32_bf16 v[92:95], a[136:139], a[120:123], v[92:95]
s_add_u32 s24, s24, 128
ds_read_b128 a[20:23], v3 offset:4096
v_fmac_f32 v255, v25, v29
v_fmac_f32 v255, v22, v28
v_mfma_f32_16x16x32_bf16 v[92:95], a[140:143], a[124:127], v[92:95]
s_waitcnt lgkmcnt(3)
v_mul_f32 v255, v255, v247
v_cvt_pk_bf16_f32 v246, v254, v255
v_mfma_f32_16x16x32_bf16 v[96:99], a[128:131], a[64:67], v[96:99]
s_add_u32 m0, s28, 36864
ds_read_b64_tr_b16 a[136:137], v7 offset:32768
v_accvgpr_write_b32 a182, v246
v_mfma_f32_16x16x32_bf16 v[96:99], a[132:135], a[68:71], v[96:99]
buffer_load_dwordx4 v12, s[8:11], s25 offen offset:0 lds
v_mfma_f32_16x16x32_bf16 v[104:107], a[128:131], a[72:75], v[104:107]
ds_read_b64_tr_b16 a[138:139], v7 offset:34816
v_mul_f32 v254, v24, v253
v_mfma_f32_16x16x32_bf16 v[104:107], a[132:135], a[76:79], v[104:107]
v_lshlrev_b32 v23, 16, v233
v_lshlrev_b32 v247, 16, v242
v_mfma_f32_16x16x32_bf16 v[112:115], a[128:131], a[80:83], v[112:115]
ds_read_b64_tr_b16 a[140:141], v7 offset:49152
v_fmac_f32 v254, v25, v30
v_mfma_f32_16x16x32_bf16 v[112:115], a[132:135], a[84:87], v[112:115]
buffer_load_dwordx4 v13, s[8:11], s25 offen offset:1024 lds
v_fmac_f32 v254, v22, v29
v_mfma_f32_16x16x32_bf16 v[120:123], a[128:131], a[88:91], v[120:123]
ds_read_b64_tr_b16 a[142:143], v7 offset:51200
v_fmac_f32 v254, v23, v28
v_mfma_f32_16x16x32_bf16 v[120:123], a[132:135], a[92:95], v[120:123]
v_mul_f32 v254, v254, v247
v_cvt_pk_bf16_f32 v246, v255, v254
v_mfma_f32_16x16x32_bf16 v[128:131], a[128:131], a[96:99], v[128:131]
v_accvgpr_write_b32 a178, v246
v_mul_f32 v255, v25, v253
v_mfma_f32_16x16x32_bf16 v[128:131], a[132:135], a[100:103], v[128:131]
buffer_load_dwordx4 v14, s[8:11], s25 offen offset:2048 lds
v_mfma_f32_16x16x32_bf16 v[136:139], a[128:131], a[104:107], v[136:139]
ds_read_b128 a[24:27], v2 offset:6144
v_lshlrev_b32 v24, 16, v234
v_mfma_f32_16x16x32_bf16 v[136:139], a[132:135], a[108:111], v[136:139]
v_lshlrev_b32 v247, 16, v243
v_fmac_f32 v255, v22, v30
v_mfma_f32_16x16x32_bf16 v[144:147], a[128:131], a[112:115], v[144:147]
ds_read_b128 a[28:31], v3 offset:6144
v_fmac_f32 v255, v23, v29
v_mfma_f32_16x16x32_bf16 v[144:147], a[132:135], a[116:119], v[144:147]
buffer_load_dwordx4 v15, s[8:11], s25 offen offset:3072 lds
v_fmac_f32 v255, v24, v28
v_mfma_f32_16x16x32_bf16 v[152:155], a[128:131], a[120:123], v[152:155]
s_add_u32 s25, s25, 128
v_mul_f32 v255, v255, v247
v_cvt_pk_bf16_f32 v246, v254, v255
v_mfma_f32_16x16x32_bf16 v[152:155], a[132:135], a[124:127], v[152:155]
s_waitcnt lgkmcnt(2)
v_accvgpr_write_b32 a183, v246
v_mul_f32 v254, v22, v253
v_mfma_f32_16x16x32_bf16 v[100:103], a[136:139], a[64:67], v[100:103]
ds_read_b64_tr_b16 a[128:129], v8 offset:32768
v_lshlrev_b32 v25, 16, v235
v_mfma_f32_16x16x32_bf16 v[100:103], a[140:143], a[68:71], v[100:103]
buffer_load_dword v21, v20, s[16:19], s43 offen
v_mfma_f32_16x16x32_bf16 v[108:111], a[136:139], a[72:75], v[108:111]
s_add_u32 s43, s43, s47
ds_read_b64_tr_b16 a[130:131], v8 offset:34816
v_lshlrev_b32 v247, 16, v244
v_mfma_f32_16x16x32_bf16 v[108:111], a[140:143], a[76:79], v[108:111]
s_cmp_ge_u32 s43, s51
v_fmac_f32 v254, v23, v30
v_fmac_f32 v254, v24, v29
v_mfma_f32_16x16x32_bf16 v[116:119], a[136:139], a[80:83], v[116:119]
s_cselect_b32 s43, 0, s43
ds_read_b64_tr_b16 a[132:133], v8 offset:49152
v_fmac_f32 v254, v25, v28
v_mul_f32 v254, v254, v247
v_mfma_f32_16x16x32_bf16 v[116:119], a[140:143], a[84:87], v[116:119]
s_cselect_b32 s51, s42, s51
v_cvt_pk_bf16_f32 v246, v255, v254
v_accvgpr_write_b32 a179, v246
v_mfma_f32_16x16x32_bf16 v[124:127], a[136:139], a[88:91], v[124:127]
s_cselect_b64 s[16:17], s[40:41], s[16:17]
ds_read_b64_tr_b16 a[134:135], v8 offset:51200
v_lshlrev_b32 v28, 16, v250
v_mfma_f32_16x16x32_bf16 v[124:127], a[140:143], a[92:95], v[124:127]
s_cselect_b32 s18, s42, s18
v_and_b32 v29, s58, v250
v_lshlrev_b32 v30, 16, v251
v_mfma_f32_16x16x32_bf16 v[132:135], a[136:139], a[96:99], v[132:135]
s_cselect_b64 s[40:41], s[44:45], s[40:41]
ds_read_b128 a[32:35], v2 offset:8192
v_and_b32 v253, s58, v251
v_mfma_f32_16x16x32_bf16 v[132:135], a[140:143], a[100:103], v[132:135]
s_cselect_b32 s42, s46, s42
v_and_b32 v22, s58, v224
v_and_b32 v23, s58, v225
v_mfma_f32_16x16x32_bf16 v[140:143], a[136:139], a[104:107], v[140:143]
s_cselect_b32 s46, 0, s46
v_and_b32 v24, s58, v226
v_mul_f32 v254, v22, v253
v_mfma_f32_16x16x32_bf16 v[140:143], a[140:143], a[108:111], v[140:143]
buffer_load_dword v245, off, s[60:63], s54 sc1
v_mfma_f32_16x16x32_bf16 v[148:151], a[136:139], a[112:115], v[148:151]
ds_read_b128 a[36:39], v3 offset:8192
v_and_b32 v25, s58, v227
v_and_b32 v247, s58, v236
v_mfma_f32_16x16x32_bf16 v[148:151], a[140:143], a[116:119], v[148:151]
v_fmac_f32 v254, v23, v30
v_fmac_f32 v254, v24, v29
v_mfma_f32_16x16x32_bf16 v[156:159], a[136:139], a[120:123], v[156:159]
ds_read_b128 a[40:43], v2 offset:10240
v_fmac_f32 v254, v25, v28
v_mfma_f32_16x16x32_bf16 v[156:159], a[140:143], a[124:127], v[156:159]
s_waitcnt lgkmcnt(3)
v_mul_f32 v254, v254, v247
v_mul_f32 v255, v23, v253
v_mfma_f32_16x16x32_bf16 v[160:163], a[128:131], a[64:67], v[160:163]
ds_read_b64_tr_b16 a[136:137], v9 offset:32768
v_and_b32 v22, s58, v228
v_mfma_f32_16x16x32_bf16 v[160:163], a[132:135], a[68:71], v[160:163]
v_and_b32 v247, s58, v237
v_fmac_f32 v255, v24, v30
v_mfma_f32_16x16x32_bf16 v[168:171], a[128:131], a[72:75], v[168:171]
ds_read_b64_tr_b16 a[138:139], v9 offset:34816
v_fmac_f32 v255, v25, v29
v_mfma_f32_16x16x32_bf16 v[168:171], a[132:135], a[76:79], v[168:171]
v_fmac_f32 v255, v22, v28
v_mul_f32 v255, v255, v247
v_mfma_f32_16x16x32_bf16 v[176:179], a[128:131], a[80:83], v[176:179]
ds_read_b64_tr_b16 a[140:141], v9 offset:49152
v_cvt_pk_bf16_f32 v246, v254, v255
v_accvgpr_write_b32 a188, v246
v_mfma_f32_16x16x32_bf16 v[176:179], a[132:135], a[84:87], v[176:179]
v_mul_f32 v254, v24, v253
v_and_b32 v23, s58, v229
v_mfma_f32_16x16x32_bf16 v[184:187], a[128:131], a[88:91], v[184:187]
ds_read_b64_tr_b16 a[142:143], v9 offset:51200
v_and_b32 v247, s58, v238
v_mfma_f32_16x16x32_bf16 v[184:187], a[132:135], a[92:95], v[184:187]
v_fmac_f32 v254, v25, v30
v_fmac_f32 v254, v22, v29
v_mfma_f32_16x16x32_bf16 v[192:195], a[128:131], a[96:99], v[192:195]
v_fmac_f32 v254, v23, v28
v_mul_f32 v254, v254, v247
v_mfma_f32_16x16x32_bf16 v[192:195], a[132:135], a[100:103], v[192:195]
v_cvt_pk_bf16_f32 v246, v255, v254
v_accvgpr_write_b32 a184, v246
v_mfma_f32_16x16x32_bf16 v[200:203], a[128:131], a[104:107], v[200:203]
ds_read_b128 a[44:47], v3 offset:10240
v_mul_f32 v255, v25, v253
v_mfma_f32_16x16x32_bf16 v[200:203], a[132:135], a[108:111], v[200:203]
v_and_b32 v24, s58, v230
v_and_b32 v247, s58, v239
v_fmac_f32 v255, v22, v30
v_mfma_f32_16x16x32_bf16 v[208:211], a[128:131], a[112:115], v[208:211]
ds_read_b128 a[48:51], v2 offset:12288
v_fmac_f32 v255, v23, v29
v_mfma_f32_16x16x32_bf16 v[208:211], a[132:135], a[116:119], v[208:211]
v_fmac_f32 v255, v24, v28
v_mul_f32 v255, v255, v247
v_mfma_f32_16x16x32_bf16 v[216:219], a[128:131], a[120:123], v[216:219]
v_cvt_pk_bf16_f32 v246, v254, v255
v_accvgpr_write_b32 a189, v246
v_mfma_f32_16x16x32_bf16 v[216:219], a[132:135], a[124:127], v[216:219]
s_waitcnt lgkmcnt(2)
v_mul_f32 v254, v22, v253
v_and_b32 v25, s58, v231
v_mfma_f32_16x16x32_bf16 v[164:167], a[136:139], a[64:67], v[164:167]
ds_read_b64_tr_b16 a[128:129], v10 offset:32768
v_and_b32 v247, s58, v240
v_mfma_f32_16x16x32_bf16 v[164:167], a[140:143], a[68:71], v[164:167]
v_fmac_f32 v254, v23, v30
v_fmac_f32 v254, v24, v29
v_mfma_f32_16x16x32_bf16 v[172:175], a[136:139], a[72:75], v[172:175]
ds_read_b64_tr_b16 a[130:131], v10 offset:34816
v_fmac_f32 v254, v25, v28
v_mfma_f32_16x16x32_bf16 v[172:175], a[140:143], a[76:79], v[172:175]
v_mul_f32 v254, v254, v247
v_cvt_pk_bf16_f32 v246, v255, v254
v_accvgpr_write_b32 a185, v246
v_mfma_f32_16x16x32_bf16 v[180:183], a[136:139], a[80:83], v[180:183]
s_lshr_b32 s22, s3, 1
ds_read_b64_tr_b16 a[132:133], v10 offset:49152
v_mul_f32 v255, v23, v253
v_mfma_f32_16x16x32_bf16 v[180:183], a[140:143], a[84:87], v[180:183]
s_mul_i32 s22, s22, 2097152
v_and_b32 v22, s58, v232
v_and_b32 v247, s58, v241
v_mfma_f32_16x16x32_bf16 v[188:191], a[136:139], a[88:91], v[188:191]
s_and_b32 s23, s3, 1
ds_read_b64_tr_b16 a[134:135], v10 offset:51200
v_fmac_f32 v255, v24, v30
v_mfma_f32_16x16x32_bf16 v[188:191], a[140:143], a[92:95], v[188:191]
s_lshl_b32 s23, s23, 5
v_fmac_f32 v255, v25, v29
v_fmac_f32 v255, v22, v28
v_mfma_f32_16x16x32_bf16 v[196:199], a[136:139], a[96:99], v[196:199]
s_lshl_b32 s56, s39, 6
ds_read_b128 a[52:55], v3 offset:12288
v_mul_f32 v255, v255, v247
v_mfma_f32_16x16x32_bf16 v[196:199], a[140:143], a[100:103], v[196:199]
s_add_u32 s23, s23, s56
v_cvt_pk_bf16_f32 v246, v254, v255
v_accvgpr_write_b32 a190, v246
v_mfma_f32_16x16x32_bf16 v[204:207], a[136:139], a[104:107], v[204:207]
s_mul_i32 s23, s23, 4224
ds_read_b128 a[56:59], v2 offset:14336
v_mul_f32 v254, v24, v253
v_and_b32 v23, s58, v233
v_mfma_f32_16x16x32_bf16 v[204:207], a[140:143], a[108:111], v[204:207]
s_add_u32 s22, s22, s23
v_and_b32 v247, s58, v242
v_fmac_f32 v254, v25, v30
v_mfma_f32_16x16x32_bf16 v[212:215], a[136:139], a[112:115], v[212:215]
s_add_u32 s57, s22, 83886200
v_fmac_f32 v254, v22, v29
v_fmac_f32 v254, v23, v28
v_mfma_f32_16x16x32_bf16 v[212:215], a[140:143], a[116:119], v[212:215]
s_lshl_b32 s23, s38, 7
v_mul_f32 v254, v254, v247
v_cvt_pk_bf16_f32 v246, v255, v254
v_mfma_f32_16x16x32_bf16 v[220:223], a[136:139], a[120:123], v[220:223]
s_add_u32 s22, s22, s23
ds_read_b128 a[60:63], v3 offset:14336
v_accvgpr_write_b32 a186, v246
v_mfma_f32_16x16x32_bf16 v[220:223], a[140:143], a[124:127], v[220:223]
s_waitcnt lgkmcnt(3)
s_add_u32 s56, s22, 83886208
v_mul_f32 v255, v25, v253
v_and_b32 v24, s58, v234
v_mfma_f32_16x16x32_bf16 a[192:195], a[128:131], a[64:67], a[192:195]
s_cmp_lt_u32 s2, 224
ds_read_b64_tr_b16 a[136:137], v11 offset:32768
v_and_b32 v247, s58, v243
v_mfma_f32_16x16x32_bf16 a[192:195], a[132:135], a[68:71], a[192:195]
s_cselect_b32 s56, s56, 3221225472
v_fmac_f32 v255, v22, v30
v_fmac_f32 v255, v23, v29
v_mfma_f32_16x16x32_bf16 a[200:203], a[128:131], a[72:75], a[200:203]
s_cmp_eq_u32 s38, 0
ds_read_b64_tr_b16 a[138:139], v11 offset:34816
v_fmac_f32 v255, v24, v28
v_mul_f32 v255, v255, v247
v_mfma_f32_16x16x32_bf16 a[200:203], a[132:135], a[76:79], a[200:203]
s_cselect_b32 s57, s57, 3221225472
v_cvt_pk_bf16_f32 v246, v254, v255
v_accvgpr_write_b32 a191, v246
v_mfma_f32_16x16x32_bf16 a[208:211], a[128:131], a[80:83], a[208:211]
ds_read_b64_tr_b16 a[140:141], v11 offset:49152
v_mul_f32 v254, v22, v253
v_mfma_f32_16x16x32_bf16 a[208:211], a[132:135], a[84:87], a[208:211]
v_and_b32 v25, s58, v235
v_and_b32 v247, s58, v244
v_mfma_f32_16x16x32_bf16 a[216:219], a[128:131], a[88:91], a[216:219]
ds_read_b64_tr_b16 a[142:143], v11 offset:51200
v_fmac_f32 v254, v23, v30
v_mfma_f32_16x16x32_bf16 a[216:219], a[132:135], a[92:95], a[216:219]
ds_write_b128 v252, a[176:179] offset:0
v_fmac_f32 v254, v24, v29
v_mfma_f32_16x16x32_bf16 a[224:227], a[128:131], a[96:99], a[224:227]
v_fmac_f32 v254, v25, v28
v_mul_f32 v254, v254, v247
v_mfma_f32_16x16x32_bf16 a[224:227], a[132:135], a[100:103], a[224:227]
ds_write_b128 v252, a[180:183] offset:8192
v_cvt_pk_bf16_f32 v246, v255, v254
v_accvgpr_write_b32 a187, v246
v_mfma_f32_16x16x32_bf16 a[232:235], a[128:131], a[104:107], a[232:235]
v_mfma_f32_16x16x32_bf16 a[232:235], a[132:135], a[108:111], a[232:235]
ds_write_b128 v252, a[184:187] offset:128
v_mfma_f32_16x16x32_bf16 a[240:243], a[128:131], a[112:115], a[240:243]
v_mfma_f32_16x16x32_bf16 a[240:243], a[132:135], a[116:119], a[240:243]
ds_write_b128 v252, a[188:191] offset:8320
v_mfma_f32_16x16x32_bf16 a[248:251], a[128:131], a[120:123], a[248:251]
s_waitcnt vmcnt(2) lgkmcnt(0)
v_mfma_f32_16x16x32_bf16 a[248:251], a[132:135], a[124:127], a[248:251]
s_barrier
v_mfma_f32_16x16x32_bf16 a[196:199], a[136:139], a[64:67], a[196:199]
s_add_u32 m0, s29, 98304
ds_read_b64_tr_b16 a[128:129], v4 offset:0
v_lshrrev_b32 v22, 8, v1
v_mfma_f32_16x16x32_bf16 a[196:199], a[140:143], a[68:71], a[196:199]
buffer_load_dwordx4 v16, s[12:15], s26 offen offset:0 lds
v_mfma_f32_16x16x32_bf16 a[204:207], a[136:139], a[72:75], a[204:207]
ds_read_b64_tr_b16 a[130:131], v4 offset:2048
v_lshlrev_b32 v22, 4, v22
v_mfma_f32_16x16x32_bf16 a[204:207], a[140:143], a[76:79], a[204:207]
v_xor_b32 v22, v22, v1
v_add_u32 v22, s29, v22
v_mfma_f32_16x16x32_bf16 a[212:215], a[136:139], a[80:83], a[212:215]
ds_read_b64_tr_b16 a[132:133], v4 offset:16384
v_add_u32 v22, 147456, v22
v_mfma_f32_16x16x32_bf16 a[212:215], a[140:143], a[84:87], a[212:215]
buffer_load_dwordx4 v17, s[12:15], s26 offen offset:1024 lds
v_mfma_f32_16x16x32_bf16 a[220:223], a[136:139], a[88:91], a[220:223]
ds_read_b64_tr_b16 a[134:135], v4 offset:18432
v_xor_b32 v23, 64, v22
v_mfma_f32_16x16x32_bf16 a[220:223], a[140:143], a[92:95], a[220:223]
v_lshrrev_b32 v224, 7, v1
v_mul_u32_u24 v224, 4224, v224
v_mfma_f32_16x16x32_bf16 a[228:231], a[136:139], a[96:99], a[228:231]
v_and_b32 v225, 0x70, v1
v_add_u32 v224, v224, v225
v_mfma_f32_16x16x32_bf16 a[228:231], a[140:143], a[100:103], a[228:231]
buffer_load_dwordx4 v18, s[12:15], s26 offen offset:2048 lds
v_mfma_f32_16x16x32_bf16 a[236:239], a[136:139], a[104:107], a[236:239]
v_bfe_u32 v225, v1, 4, 5
v_mul_u32_u24 v225, 4224, v225
v_mfma_f32_16x16x32_bf16 a[236:239], a[140:143], a[108:111], a[236:239]
v_mov_b32 v226, 0
v_mov_b32 v227, 0
v_mfma_f32_16x16x32_bf16 a[244:247], a[136:139], a[112:115], a[244:247]
v_mfma_f32_16x16x32_bf16 a[244:247], a[140:143], a[116:119], a[244:247]
buffer_load_dwordx4 v19, s[12:15], s26 offen offset:3072 lds
v_mfma_f32_16x16x32_bf16 a[252:255], a[136:139], a[120:123], a[252:255]
s_add_u32 s26, s26, 524288
v_mfma_f32_16x16x32_bf16 a[252:255], a[140:143], a[124:127], a[252:255]
s_waitcnt lgkmcnt(0)
v_mfma_f32_16x16x32_bf16 v[32:35], a[128:131], a[0:3], v[32:35]
s_add_u32 m0, s29, 114688
ds_read_b64_tr_b16 a[136:137], v5 offset:0
v_mfma_f32_16x16x32_bf16 v[32:35], a[132:135], a[4:7], v[32:35]
buffer_load_dwordx4 v16, s[12:15], s27 offen offset:0 lds
v_mfma_f32_16x16x32_bf16 v[40:43], a[128:131], a[8:11], v[40:43]
s_mul_i32 s52, s20, 7
ds_read_b64_tr_b16 a[138:139], v5 offset:2048
v_mfma_f32_16x16x32_bf16 v[40:43], a[132:135], a[12:15], v[40:43]
s_add_u32 s52, s52, s21
buffer_store_dwordx2 v[226:227], v225, s[4:7], s57 offen sc1
v_mfma_f32_16x16x32_bf16 v[48:51], a[128:131], a[16:19], v[48:51]
s_lshl_b32 s53, s52, 2
ds_read_b64_tr_b16 a[140:141], v5 offset:16384
v_mfma_f32_16x16x32_bf16 v[48:51], a[132:135], a[20:23], v[48:51]
s_add_u32 s53, s53, s3
buffer_load_dwordx4 v17, s[12:15], s27 offen offset:1024 lds
v_mfma_f32_16x16x32_bf16 v[56:59], a[128:131], a[24:27], v[56:59]
s_lshl_b32 s49, s53, 12
ds_read_b64_tr_b16 a[142:143], v5 offset:18432
v_mfma_f32_16x16x32_bf16 v[56:59], a[132:135], a[28:31], v[56:59]
s_mul_i32 s53, s53, 4224
v_mfma_f32_16x16x32_bf16 v[64:67], a[128:131], a[32:35], v[64:67]
s_add_u32 s53, s53, 83886080
ds_read_b128 a[64:67], v2 offset:32768
v_mfma_f32_16x16x32_bf16 v[64:67], a[132:135], a[36:39], v[64:67]
s_lshr_b32 s52, s52, 4
buffer_load_dwordx4 v18, s[12:15], s27 offen offset:2048 lds
v_mfma_f32_16x16x32_bf16 v[72:75], a[128:131], a[40:43], v[72:75]
s_min_u32 s52, s52, 6
ds_read_b128 a[68:71], v3 offset:32768
v_mfma_f32_16x16x32_bf16 v[72:75], a[132:135], a[44:47], v[72:75]
s_lshl_b32 s52, s52, 7
ds_read_b128 a[176:179], v22 offset:0
v_mfma_f32_16x16x32_bf16 v[80:83], a[128:131], a[48:51], v[80:83]
s_add_u32 s52, s52, 94392320
ds_read_b128 a[180:183], v23 offset:1024
v_mfma_f32_16x16x32_bf16 v[80:83], a[132:135], a[52:55], v[80:83]
buffer_load_dwordx4 v19, s[12:15], s27 offen offset:3072 lds
v_mfma_f32_16x16x32_bf16 v[88:91], a[128:131], a[56:59], v[88:91]
PAD_3:
s_cbranch_execz M_tret
s_add_u32 s27, s27, 524288
ds_read_b128 a[72:75], v2 offset:34816
v_mfma_f32_16x16x32_bf16 v[88:91], a[132:135], a[60:63], v[88:91]
s_waitcnt lgkmcnt(5)
ds_read_b128 a[184:187], v22 offset:2048
v_mfma_f32_16x16x32_bf16 v[36:39], a[136:139], a[0:3], v[36:39]
s_add_u32 m0, s28, 0
ds_read_b64_tr_b16 a[128:129], v6 offset:0
v_mfma_f32_16x16x32_bf16 v[36:39], a[140:143], a[4:7], v[36:39]
buffer_load_dwordx4 v12, s[8:11], s24 offen offset:0 lds
v_mfma_f32_16x16x32_bf16 v[44:47], a[136:139], a[8:11], v[44:47]
ds_read_b64_tr_b16 a[130:131], v6 offset:2048
v_mfma_f32_16x16x32_bf16 v[44:47], a[140:143], a[12:15], v[44:47]
ds_read_b128 a[188:191], v23 offset:3072
v_mfma_f32_16x16x32_bf16 v[52:55], a[136:139], a[16:19], v[52:55]
ds_read_b64_tr_b16 a[132:133], v6 offset:16384
v_bfe_u32 v231, v1, 4, 5
v_mfma_f32_16x16x32_bf16 v[52:55], a[140:143], a[20:23], v[52:55]
buffer_load_dwordx4 v13, s[8:11], s24 offen offset:1024 lds
v_mfma_f32_16x16x32_bf16 v[60:63], a[136:139], a[24:27], v[60:63]
ds_read_b64_tr_b16 a[134:135], v6 offset:18432
v_lshlrev_b32 v231, 2, v231
v_mfma_f32_16x16x32_bf16 v[60:63], a[140:143], a[28:31], v[60:63]
v_lshlrev_b32 v229, 3, v1
v_min_u32 v229, 4096, v229
v_mfma_f32_16x16x32_bf16 v[68:71], a[136:139], a[32:35], v[68:71]
ds_read_b128 a[76:79], v3 offset:34816
v_mfma_f32_16x16x32_bf16 v[68:71], a[140:143], a[36:39], v[68:71]
buffer_load_dwordx4 v14, s[8:11], s24 offen offset:2048 lds
v_mfma_f32_16x16x32_bf16 v[76:79], a[136:139], a[40:43], v[76:79]
v_mfma_f32_16x16x32_bf16 v[76:79], a[140:143], a[44:47], v[76:79]
v_mfma_f32_16x16x32_bf16 v[84:87], a[136:139], a[48:51], v[84:87]
ds_read_b128 a[80:83], v2 offset:36864
v_mfma_f32_16x16x32_bf16 v[84:87], a[140:143], a[52:55], v[84:87]
buffer_load_dwordx4 v15, s[8:11], s24 offen offset:3072 lds
v_mfma_f32_16x16x32_bf16 v[92:95], a[136:139], a[56:59], v[92:95]
s_add_u32 s24, s24, 128
ds_read_b128 a[84:87], v3 offset:36864
v_mfma_f32_16x16x32_bf16 v[92:95], a[140:143], a[60:63], v[92:95]
s_waitcnt lgkmcnt(3)
v_mfma_f32_16x16x32_bf16 v[96:99], a[128:131], a[0:3], v[96:99]
s_add_u32 m0, s28, 4096
ds_read_b64_tr_b16 a[136:137], v7 offset:0
v_mfma_f32_16x16x32_bf16 v[96:99], a[132:135], a[4:7], v[96:99]
buffer_load_dwordx4 v12, s[8:11], s25 offen offset:0 lds
v_mfma_f32_16x16x32_bf16 v[104:107], a[128:131], a[8:11], v[104:107]
ds_read_b64_tr_b16 a[138:139], v7 offset:2048
v_mfma_f32_16x16x32_bf16 v[104:107], a[132:135], a[12:15], v[104:107]
v_mfma_f32_16x16x32_bf16 v[112:115], a[128:131], a[16:19], v[112:115]
ds_read_b64_tr_b16 a[140:141], v7 offset:16384
v_mfma_f32_16x16x32_bf16 v[112:115], a[132:135], a[20:23], v[112:115]
buffer_load_dwordx4 v13, s[8:11], s25 offen offset:1024 lds
v_mfma_f32_16x16x32_bf16 v[120:123], a[128:131], a[24:27], v[120:123]
ds_read_b64_tr_b16 a[142:143], v7 offset:18432
v_mfma_f32_16x16x32_bf16 v[120:123], a[132:135], a[28:31], v[120:123]
v_mfma_f32_16x16x32_bf16 v[128:131], a[128:131], a[32:35], v[128:131]
v_mfma_f32_16x16x32_bf16 v[128:131], a[132:135], a[36:39], v[128:131]
buffer_load_dwordx4 v14, s[8:11], s25 offen offset:2048 lds
v_mfma_f32_16x16x32_bf16 v[136:139], a[128:131], a[40:43], v[136:139]
ds_read_b128 a[88:91], v2 offset:38912
v_mfma_f32_16x16x32_bf16 v[136:139], a[132:135], a[44:47], v[136:139]
v_mfma_f32_16x16x32_bf16 v[144:147], a[128:131], a[48:51], v[144:147]
ds_read_b128 a[92:95], v3 offset:38912
v_mfma_f32_16x16x32_bf16 v[144:147], a[132:135], a[52:55], v[144:147]
buffer_load_dwordx4 v15, s[8:11], s25 offen offset:3072 lds
v_mfma_f32_16x16x32_bf16 v[152:155], a[128:131], a[56:59], v[152:155]
s_add_u32 s25, s25, 128
v_mfma_f32_16x16x32_bf16 v[152:155], a[132:135], a[60:63], v[152:155]
s_waitcnt lgkmcnt(2)
v_mfma_f32_16x16x32_bf16 v[100:103], a[136:139], a[0:3], v[100:103]
ds_read_b64_tr_b16 a[128:129], v8 offset:0
v_mfma_f32_16x16x32_bf16 v[100:103], a[140:143], a[4:7], v[100:103]
buffer_store_dwordx4 a[176:179], v224, s[4:7], s56 offen sc1
v_mfma_f32_16x16x32_bf16 v[108:111], a[136:139], a[8:11], v[108:111]
s_add_u32 s56, s56, 33792
ds_read_b64_tr_b16 a[130:131], v8 offset:2048
v_mfma_f32_16x16x32_bf16 v[108:111], a[140:143], a[12:15], v[108:111]
v_mfma_f32_16x16x32_bf16 v[116:119], a[136:139], a[16:19], v[116:119]
ds_read_b64_tr_b16 a[132:133], v8 offset:16384
v_mfma_f32_16x16x32_bf16 v[116:119], a[140:143], a[20:23], v[116:119]
v_mfma_f32_16x16x32_bf16 v[124:127], a[136:139], a[24:27], v[124:127]
s_cmp_lt_u32 s21, 0
ds_read_b64_tr_b16 a[134:135], v8 offset:18432
v_mfma_f32_16x16x32_bf16 v[124:127], a[140:143], a[28:31], v[124:127]
s_cselect_b32 s53, s53, 3221225472
v_mfma_f32_16x16x32_bf16 v[132:135], a[136:139], a[32:35], v[132:135]
s_cselect_b32 s49, s49, 3221225472
ds_read_b128 a[96:99], v2 offset:40960
v_mfma_f32_16x16x32_bf16 v[132:135], a[140:143], a[36:39], v[132:135]
s_add_u32 s48, s53, 2097152
v_mfma_f32_16x16x32_bf16 v[140:143], a[136:139], a[40:43], v[140:143]
v_mfma_f32_16x16x32_bf16 v[140:143], a[140:143], a[44:47], v[140:143]
v_mfma_f32_16x16x32_bf16 v[148:151], a[136:139], a[48:51], v[148:151]
ds_read_b128 a[100:103], v3 offset:40960
v_mfma_f32_16x16x32_bf16 v[148:151], a[140:143], a[52:55], v[148:151]
v_mfma_f32_16x16x32_bf16 v[156:159], a[136:139], a[56:59], v[156:159]
ds_read_b128 a[104:107], v2 offset:43008
v_mfma_f32_16x16x32_bf16 v[156:159], a[140:143], a[60:63], v[156:159]
s_waitcnt lgkmcnt(3)
v_mfma_f32_16x16x32_bf16 v[160:163], a[128:131], a[0:3], v[160:163]
ds_read_b64_tr_b16 a[136:137], v9 offset:0
v_mfma_f32_16x16x32_bf16 v[160:163], a[132:135], a[4:7], v[160:163]
v_mfma_f32_16x16x32_bf16 v[168:171], a[128:131], a[8:11], v[168:171]
ds_read_b64_tr_b16 a[138:139], v9 offset:2048
v_mfma_f32_16x16x32_bf16 v[168:171], a[132:135], a[12:15], v[168:171]
buffer_store_dwordx4 a[180:183], v224, s[4:7], s56 offen sc1
v_mfma_f32_16x16x32_bf16 v[176:179], a[128:131], a[16:19], v[176:179]
s_add_u32 s56, s56, 33792
ds_read_b64_tr_b16 a[140:141], v9 offset:16384
v_mfma_f32_16x16x32_bf16 v[176:179], a[132:135], a[20:23], v[176:179]
v_mfma_f32_16x16x32_bf16 v[184:187], a[128:131], a[24:27], v[184:187]
ds_read_b64_tr_b16 a[142:143], v9 offset:18432
v_mfma_f32_16x16x32_bf16 v[184:187], a[132:135], a[28:31], v[184:187]
v_mfma_f32_16x16x32_bf16 v[192:195], a[128:131], a[32:35], v[192:195]
v_mfma_f32_16x16x32_bf16 v[192:195], a[132:135], a[36:39], v[192:195]
v_mfma_f32_16x16x32_bf16 v[200:203], a[128:131], a[40:43], v[200:203]
ds_read_b128 a[108:111], v3 offset:43008
v_mfma_f32_16x16x32_bf16 v[200:203], a[132:135], a[44:47], v[200:203]
v_mfma_f32_16x16x32_bf16 v[208:211], a[128:131], a[48:51], v[208:211]
ds_read_b128 a[112:115], v2 offset:45056
v_mfma_f32_16x16x32_bf16 v[208:211], a[132:135], a[52:55], v[208:211]
v_mfma_f32_16x16x32_bf16 v[216:219], a[128:131], a[56:59], v[216:219]
v_mfma_f32_16x16x32_bf16 v[216:219], a[132:135], a[60:63], v[216:219]
s_waitcnt lgkmcnt(2)
v_mfma_f32_16x16x32_bf16 v[164:167], a[136:139], a[0:3], v[164:167]
ds_read_b64_tr_b16 a[128:129], v10 offset:0
v_mfma_f32_16x16x32_bf16 v[164:167], a[140:143], a[4:7], v[164:167]
v_mfma_f32_16x16x32_bf16 v[172:175], a[136:139], a[8:11], v[172:175]
ds_read_b64_tr_b16 a[130:131], v10 offset:2048
v_mfma_f32_16x16x32_bf16 v[172:175], a[140:143], a[12:15], v[172:175]
v_mfma_f32_16x16x32_bf16 v[180:183], a[136:139], a[16:19], v[180:183]
ds_read_b64_tr_b16 a[132:133], v10 offset:16384
v_mfma_f32_16x16x32_bf16 v[180:183], a[140:143], a[20:23], v[180:183]
buffer_store_dwordx4 a[184:187], v224, s[4:7], s56 offen sc1
v_mfma_f32_16x16x32_bf16 v[188:191], a[136:139], a[24:27], v[188:191]
s_add_u32 s56, s56, 33792
ds_read_b64_tr_b16 a[134:135], v10 offset:18432
v_mfma_f32_16x16x32_bf16 v[188:191], a[140:143], a[28:31], v[188:191]
v_mfma_f32_16x16x32_bf16 v[196:199], a[136:139], a[32:35], v[196:199]
ds_read_b128 a[116:119], v3 offset:45056
v_mfma_f32_16x16x32_bf16 v[196:199], a[140:143], a[36:39], v[196:199]
v_mfma_f32_16x16x32_bf16 v[204:207], a[136:139], a[40:43], v[204:207]
ds_read_b128 a[120:123], v2 offset:47104
v_mfma_f32_16x16x32_bf16 v[204:207], a[140:143], a[44:47], v[204:207]
v_mfma_f32_16x16x32_bf16 v[212:215], a[136:139], a[48:51], v[212:215]
v_mfma_f32_16x16x32_bf16 v[212:215], a[140:143], a[52:55], v[212:215]
v_mfma_f32_16x16x32_bf16 v[220:223], a[136:139], a[56:59], v[220:223]
ds_read_b128 a[124:127], v3 offset:47104
v_mfma_f32_16x16x32_bf16 v[220:223], a[140:143], a[60:63], v[220:223]
s_waitcnt lgkmcnt(3)
v_mfma_f32_16x16x32_bf16 a[192:195], a[128:131], a[0:3], a[192:195]
ds_read_b64_tr_b16 a[136:137], v11 offset:0
v_mfma_f32_16x16x32_bf16 a[192:195], a[132:135], a[4:7], a[192:195]
v_mfma_f32_16x16x32_bf16 a[200:203], a[128:131], a[8:11], a[200:203]
ds_read_b64_tr_b16 a[138:139], v11 offset:2048
v_mfma_f32_16x16x32_bf16 a[200:203], a[132:135], a[12:15], a[200:203]
v_mfma_f32_16x16x32_bf16 a[208:211], a[128:131], a[16:19], a[208:211]
ds_read_b64_tr_b16 a[140:141], v11 offset:16384
v_mfma_f32_16x16x32_bf16 a[208:211], a[132:135], a[20:23], a[208:211]
v_mfma_f32_16x16x32_bf16 a[216:219], a[128:131], a[24:27], a[216:219]
ds_read_b64_tr_b16 a[142:143], v11 offset:18432
v_mfma_f32_16x16x32_bf16 a[216:219], a[132:135], a[28:31], a[216:219]
buffer_store_dwordx4 a[188:191], v224, s[4:7], s56 offen sc1
v_mfma_f32_16x16x32_bf16 a[224:227], a[128:131], a[32:35], a[224:227]
s_add_u32 s56, s56, 33792
v_mfma_f32_16x16x32_bf16 a[224:227], a[132:135], a[36:39], a[224:227]
v_mfma_f32_16x16x32_bf16 a[232:235], a[128:131], a[40:43], a[232:235]
v_mfma_f32_16x16x32_bf16 a[232:235], a[132:135], a[44:47], a[232:235]
v_mfma_f32_16x16x32_bf16 a[240:243], a[128:131], a[48:51], a[240:243]
v_mfma_f32_16x16x32_bf16 a[240:243], a[132:135], a[52:55], a[240:243]
v_mfma_f32_16x16x32_bf16 a[248:251], a[128:131], a[56:59], a[248:251]
s_waitcnt vmcnt(4) lgkmcnt(0)
v_mfma_f32_16x16x32_bf16 a[248:251], a[132:135], a[60:63], a[248:251]
s_barrier
v_mfma_f32_16x16x32_bf16 a[196:199], a[136:139], a[0:3], a[196:199]
s_add_u32 m0, s29, 65536
ds_read_b64_tr_b16 a[128:129], v4 offset:32768
v_mfma_f32_16x16x32_bf16 a[196:199], a[140:143], a[4:7], a[196:199]
buffer_load_dwordx4 v16, s[12:15], s26 offen offset:0 lds
v_mfma_f32_16x16x32_bf16 a[204:207], a[136:139], a[8:11], a[204:207]
ds_read_b64_tr_b16 a[130:131], v4 offset:34816
v_cmp_gt_u32 vcc, s50, v245
v_mfma_f32_16x16x32_bf16 a[204:207], a[140:143], a[12:15], a[204:207]
v_mfma_f32_16x16x32_bf16 a[212:215], a[136:139], a[16:19], a[212:215]
ds_read_b64_tr_b16 a[132:133], v4 offset:49152
v_mfma_f32_16x16x32_bf16 a[212:215], a[140:143], a[20:23], a[212:215]
buffer_load_dwordx4 v17, s[12:15], s26 offen offset:1024 lds
v_mfma_f32_16x16x32_bf16 a[220:223], a[136:139], a[24:27], a[220:223]
ds_read_b64_tr_b16 a[134:135], v4 offset:51200
v_mfma_f32_16x16x32_bf16 a[220:223], a[140:143], a[28:31], a[220:223]
v_mfma_f32_16x16x32_bf16 a[228:231], a[136:139], a[32:35], a[228:231]
v_mfma_f32_16x16x32_bf16 a[228:231], a[140:143], a[36:39], a[228:231]
buffer_load_dwordx4 v18, s[12:15], s26 offen offset:2048 lds
v_mfma_f32_16x16x32_bf16 a[236:239], a[136:139], a[40:43], a[236:239]
v_mfma_f32_16x16x32_bf16 a[236:239], a[140:143], a[44:47], a[236:239]
v_mfma_f32_16x16x32_bf16 a[244:247], a[136:139], a[48:51], a[244:247]
v_mfma_f32_16x16x32_bf16 a[244:247], a[140:143], a[52:55], a[244:247]
buffer_load_dwordx4 v19, s[12:15], s26 offen offset:3072 lds
v_mfma_f32_16x16x32_bf16 a[252:255], a[136:139], a[56:59], a[252:255]
s_add_u32 s26, s26, 524288
v_mfma_f32_16x16x32_bf16 a[252:255], a[140:143], a[60:63], a[252:255]
s_waitcnt lgkmcnt(0)
s_mov_b32 s82, s59
s_cbranch_vccnz M_cntspinK
s_branch Lg_1
PAD_4:
s_cbranch_execz M_tret
Lg_1t:
v_mfma_f32_16x16x32_bf16 v[32:35], a[128:131], a[64:67], v[32:35]
s_add_u32 m0, s29, 81920
ds_read_b64_tr_b16 a[136:137], v5 offset:32768
v_mfma_f32_16x16x32_bf16 v[32:35], a[132:135], a[68:71], v[32:35]
buffer_load_dwordx4 v16, s[12:15], s27 offen offset:0 lds
v_mfma_f32_16x16x32_bf16 v[40:43], a[128:131], a[72:75], v[40:43]
s_and_b32 s44, s3, 1
ds_read_b64_tr_b16 a[138:139], v5 offset:34816
v_mfma_f32_16x16x32_bf16 v[40:43], a[132:135], a[76:79], v[40:43]
s_lshl_b32 s44, s44, 8
v_mfma_f32_16x16x32_bf16 v[48:51], a[128:131], a[80:83], v[48:51]
s_lshl_b32 s45, s3, 7
ds_read_b64_tr_b16 a[140:141], v5 offset:49152
v_mfma_f32_16x16x32_bf16 v[48:51], a[132:135], a[84:87], v[48:51]
s_xor_b32 s44, s44, s45
buffer_load_dwordx4 v17, s[12:15], s27 offen offset:1024 lds
v_mfma_f32_16x16x32_bf16 v[56:59], a[128:131], a[88:91], v[56:59]
s_xor_b32 s44, s44, 196608
ds_read_b64_tr_b16 a[142:143], v5 offset:51200
v_mfma_f32_16x16x32_bf16 v[56:59], a[132:135], a[92:95], v[56:59]
v_mfma_f32_16x16x32_bf16 v[64:67], a[128:131], a[96:99], v[64:67]
ds_read_b128 a[0:3], v2 offset:0
v_mfma_f32_16x16x32_bf16 v[64:67], a[132:135], a[100:103], v[64:67]
buffer_load_dwordx4 v18, s[12:15], s27 offen offset:2048 lds
v_mfma_f32_16x16x32_bf16 v[72:75], a[128:131], a[104:107], v[72:75]
ds_read_b128 a[4:7], v3 offset:0
v_mfma_f32_16x16x32_bf16 v[72:75], a[132:135], a[108:111], v[72:75]
v_mfma_f32_16x16x32_bf16 v[80:83], a[128:131], a[112:115], v[80:83]
v_mfma_f32_16x16x32_bf16 v[80:83], a[132:135], a[116:119], v[80:83]
buffer_load_dwordx4 v19, s[12:15], s27 offen offset:3072 lds
v_mfma_f32_16x16x32_bf16 v[88:91], a[128:131], a[120:123], v[88:91]
s_add_u32 s27, s27, 524288
ds_read_b128 a[8:11], v2 offset:2048
v_mfma_f32_16x16x32_bf16 v[88:91], a[132:135], a[124:127], v[88:91]
s_waitcnt lgkmcnt(3)
v_mfma_f32_16x16x32_bf16 v[36:39], a[136:139], a[64:67], v[36:39]
s_add_u32 m0, s28, 32768
ds_read_b64_tr_b16 a[128:129], v6 offset:32768
v_mfma_f32_16x16x32_bf16 v[36:39], a[140:143], a[68:71], v[36:39]
buffer_load_dwordx4 v12, s[8:11], s24 offen offset:0 lds
v_mfma_f32_16x16x32_bf16 v[44:47], a[136:139], a[72:75], v[44:47]
ds_read_b64_tr_b16 a[130:131], v6 offset:34816
v_mfma_f32_16x16x32_bf16 v[44:47], a[140:143], a[76:79], v[44:47]
v_mfma_f32_16x16x32_bf16 v[52:55], a[136:139], a[80:83], v[52:55]
s_mov_b64 s[56:57], s[72:73]
ds_read_b64_tr_b16 a[132:133], v6 offset:49152
v_mfma_f32_16x16x32_bf16 v[52:55], a[140:143], a[84:87], v[52:55]
s_mov_b32 s58, 1835008
buffer_load_dwordx4 v13, s[8:11], s24 offen offset:1024 lds
v_mfma_f32_16x16x32_bf16 v[60:63], a[136:139], a[88:91], v[60:63]
s_mov_b32 s59, 0x20000
ds_read_b64_tr_b16 a[134:135], v6 offset:51200
v_mfma_f32_16x16x32_bf16 v[60:63], a[140:143], a[92:95], v[60:63]
v_mfma_f32_16x16x32_bf16 v[68:71], a[136:139], a[96:99], v[68:71]
ds_read_b128 a[12:15], v3 offset:2048
v_mfma_f32_16x16x32_bf16 v[68:71], a[140:143], a[100:103], v[68:71]
buffer_load_dwordx4 v14, s[8:11], s24 offen offset:2048 lds
v_mfma_f32_16x16x32_bf16 v[76:79], a[136:139], a[104:107], v[76:79]
v_mfma_f32_16x16x32_bf16 v[76:79], a[140:143], a[108:111], v[76:79]
v_mfma_f32_16x16x32_bf16 v[84:87], a[136:139], a[112:115], v[84:87]
ds_read_b128 a[16:19], v2 offset:4096
v_mfma_f32_16x16x32_bf16 v[84:87], a[140:143], a[116:119], v[84:87]
buffer_load_dwordx4 v15, s[8:11], s24 offen offset:3072 lds
v_mfma_f32_16x16x32_bf16 v[92:95], a[136:139], a[120:123], v[92:95]
s_add_u32 s24, s24, 128
ds_read_b128 a[20:23], v3 offset:4096
v_mfma_f32_16x16x32_bf16 v[92:95], a[140:143], a[124:127], v[92:95]
s_waitcnt lgkmcnt(3)
v_mfma_f32_16x16x32_bf16 v[96:99], a[128:131], a[64:67], v[96:99]
s_add_u32 m0, s28, 36864
ds_read_b64_tr_b16 a[136:137], v7 offset:32768
v_mfma_f32_16x16x32_bf16 v[96:99], a[132:135], a[68:71], v[96:99]
buffer_load_dwordx4 v12, s[8:11], s25 offen offset:0 lds
v_mfma_f32_16x16x32_bf16 v[104:107], a[128:131], a[72:75], v[104:107]
ds_read_b64_tr_b16 a[138:139], v7 offset:34816
v_mfma_f32_16x16x32_bf16 v[104:107], a[132:135], a[76:79], v[104:107]
v_mfma_f32_16x16x32_bf16 v[112:115], a[128:131], a[80:83], v[112:115]
ds_read_b64_tr_b16 a[140:141], v7 offset:49152
v_mfma_f32_16x16x32_bf16 v[112:115], a[132:135], a[84:87], v[112:115]
buffer_load_dwordx4 v13, s[8:11], s25 offen offset:1024 lds
v_mfma_f32_16x16x32_bf16 v[120:123], a[128:131], a[88:91], v[120:123]
ds_read_b64_tr_b16 a[142:143], v7 offset:51200
v_mfma_f32_16x16x32_bf16 v[120:123], a[132:135], a[92:95], v[120:123]
v_mfma_f32_16x16x32_bf16 v[128:131], a[128:131], a[96:99], v[128:131]
v_mfma_f32_16x16x32_bf16 v[128:131], a[132:135], a[100:103], v[128:131]
buffer_load_dwordx4 v14, s[8:11], s25 offen offset:2048 lds
v_mfma_f32_16x16x32_bf16 v[136:139], a[128:131], a[104:107], v[136:139]
ds_read_b128 a[24:27], v2 offset:6144
v_mfma_f32_16x16x32_bf16 v[136:139], a[132:135], a[108:111], v[136:139]
v_mfma_f32_16x16x32_bf16 v[144:147], a[128:131], a[112:115], v[144:147]
ds_read_b128 a[28:31], v3 offset:6144
v_mfma_f32_16x16x32_bf16 v[144:147], a[132:135], a[116:119], v[144:147]
buffer_load_dwordx4 v15, s[8:11], s25 offen offset:3072 lds
v_mfma_f32_16x16x32_bf16 v[152:155], a[128:131], a[120:123], v[152:155]
s_add_u32 s25, s25, 128
v_mfma_f32_16x16x32_bf16 v[152:155], a[132:135], a[124:127], v[152:155]
s_waitcnt lgkmcnt(2)
v_mfma_f32_16x16x32_bf16 v[100:103], a[136:139], a[64:67], v[100:103]
ds_read_b64_tr_b16 a[128:129], v8 offset:32768
v_mfma_f32_16x16x32_bf16 v[100:103], a[140:143], a[68:71], v[100:103]
buffer_load_dword v21, v20, s[16:19], s43 offen
v_mfma_f32_16x16x32_bf16 v[108:111], a[136:139], a[72:75], v[108:111]
s_mov_b64 s[8:9], s[76:77]
ds_read_b64_tr_b16 a[130:131], v8 offset:34816
v_mfma_f32_16x16x32_bf16 v[108:111], a[140:143], a[76:79], v[108:111]
s_mov_b32 s10, 1835008
buffer_load_dword v21, v20, s[16:19], s43 offen offset:256
v_mfma_f32_16x16x32_bf16 v[116:119], a[136:139], a[80:83], v[116:119]
s_lshl_b32 s24, s37, 2
ds_read_b64_tr_b16 a[132:133], v8 offset:49152
v_mfma_f32_16x16x32_bf16 v[116:119], a[140:143], a[84:87], v[116:119]
s_add_u32 s24, s24, s3
v_mfma_f32_16x16x32_bf16 v[124:127], a[136:139], a[88:91], v[124:127]
s_mul_i32 s24, s24, 28672
ds_read_b64_tr_b16 a[134:135], v8 offset:51200
v_mfma_f32_16x16x32_bf16 v[124:127], a[140:143], a[92:95], v[124:127]
s_mov_b32 s28, s29
v_mfma_f32_16x16x32_bf16 v[132:135], a[136:139], a[96:99], v[132:135]
ds_read_b128 a[32:35], v2 offset:8192
v_mfma_f32_16x16x32_bf16 v[132:135], a[140:143], a[100:103], v[132:135]
v_mfma_f32_16x16x32_bf16 v[140:143], a[136:139], a[104:107], v[140:143]
v_mfma_f32_16x16x32_bf16 v[140:143], a[140:143], a[108:111], v[140:143]
v_mfma_f32_16x16x32_bf16 v[148:151], a[136:139], a[112:115], v[148:151]
ds_read_b128 a[36:39], v3 offset:8192
v_lshrrev_b32 v28, 7, v1
v_mfma_f32_16x16x32_bf16 v[148:151], a[140:143], a[116:119], v[148:151]
v_lshrrev_b32 v29, 1, v28
v_lshlrev_b32 v29, 4, v29
v_mfma_f32_16x16x32_bf16 v[156:159], a[136:139], a[120:123], v[156:159]
ds_read_b128 a[40:43], v2 offset:10240
v_and_b32 v30, 0x70, v1
v_mfma_f32_16x16x32_bf16 v[156:159], a[140:143], a[124:127], v[156:159]
s_waitcnt lgkmcnt(3)
v_xor_b32 v29, v29, v30
v_mul_u32_u24 v28, 896, v28
v_mfma_f32_16x16x32_bf16 v[160:163], a[128:131], a[64:67], v[160:163]
ds_read_b64_tr_b16 a[136:137], v9 offset:32768
v_add_u32 v12, v28, v29
v_mfma_f32_16x16x32_bf16 v[160:163], a[132:135], a[68:71], v[160:163]
v_xor_b32 v29, 64, v29
v_add_u32 v28, v28, v29
v_mfma_f32_16x16x32_bf16 v[168:171], a[128:131], a[72:75], v[168:171]
ds_read_b64_tr_b16 a[138:139], v9 offset:34816
v_add_u32 v13, 6144, v28
v_mfma_f32_16x16x32_bf16 v[168:171], a[132:135], a[76:79], v[168:171]
v_add_u32 v14, 12288, v12
v_add_u32 v15, 18432, v28
v_mfma_f32_16x16x32_bf16 v[176:179], a[128:131], a[80:83], v[176:179]
ds_read_b64_tr_b16 a[140:141], v9 offset:49152
v_xor_b32 v22, s44, v4
v_mfma_f32_16x16x32_bf16 v[176:179], a[132:135], a[84:87], v[176:179]
v_xor_b32 v23, 32, v22
v_xor_b32 v24, 64, v22
v_mfma_f32_16x16x32_bf16 v[184:187], a[128:131], a[88:91], v[184:187]
ds_read_b64_tr_b16 a[142:143], v9 offset:51200
v_xor_b32 v25, 96, v22
v_mfma_f32_16x16x32_bf16 v[184:187], a[132:135], a[92:95], v[184:187]
v_mfma_f32_16x16x32_bf16 v[192:195], a[128:131], a[96:99], v[192:195]
v_mfma_f32_16x16x32_bf16 v[192:195], a[132:135], a[100:103], v[192:195]
v_mfma_f32_16x16x32_bf16 v[200:203], a[128:131], a[104:107], v[200:203]
ds_read_b128 a[44:47], v3 offset:10240
v_mfma_f32_16x16x32_bf16 v[200:203], a[132:135], a[108:111], v[200:203]
v_mfma_f32_16x16x32_bf16 v[208:211], a[128:131], a[112:115], v[208:211]
ds_read_b128 a[48:51], v2 offset:12288
v_mfma_f32_16x16x32_bf16 v[208:211], a[132:135], a[116:119], v[208:211]
v_mfma_f32_16x16x32_bf16 v[216:219], a[128:131], a[120:123], v[216:219]
v_mfma_f32_16x16x32_bf16 v[216:219], a[132:135], a[124:127], v[216:219]
s_waitcnt lgkmcnt(2)
v_mfma_f32_16x16x32_bf16 v[164:167], a[136:139], a[64:67], v[164:167]
ds_read_b64_tr_b16 a[128:129], v10 offset:32768
v_mfma_f32_16x16x32_bf16 v[164:167], a[140:143], a[68:71], v[164:167]
v_mfma_f32_16x16x32_bf16 v[172:175], a[136:139], a[72:75], v[172:175]
ds_read_b64_tr_b16 a[130:131], v10 offset:34816
v_mfma_f32_16x16x32_bf16 v[172:175], a[140:143], a[76:79], v[172:175]
v_mfma_f32_16x16x32_bf16 v[180:183], a[136:139], a[80:83], v[180:183]
ds_read_b64_tr_b16 a[132:133], v10 offset:49152
v_mfma_f32_16x16x32_bf16 v[180:183], a[140:143], a[84:87], v[180:183]
v_mfma_f32_16x16x32_bf16 v[188:191], a[136:139], a[88:91], v[188:191]
ds_read_b64_tr_b16 a[134:135], v10 offset:51200
v_mfma_f32_16x16x32_bf16 v[188:191], a[140:143], a[92:95], v[188:191]
v_mfma_f32_16x16x32_bf16 v[196:199], a[136:139], a[96:99], v[196:199]
ds_read_b128 a[52:55], v3 offset:12288
v_mfma_f32_16x16x32_bf16 v[196:199], a[140:143], a[100:103], v[196:199]
v_mfma_f32_16x16x32_bf16 v[204:207], a[136:139], a[104:107], v[204:207]
ds_read_b128 a[56:59], v2 offset:14336
v_mfma_f32_16x16x32_bf16 v[204:207], a[140:143], a[108:111], v[204:207]
v_mfma_f32_16x16x32_bf16 v[212:215], a[136:139], a[112:115], v[212:215]
v_mfma_f32_16x16x32_bf16 v[212:215], a[140:143], a[116:119], v[212:215]
v_mfma_f32_16x16x32_bf16 v[220:223], a[136:139], a[120:123], v[220:223]
ds_read_b128 a[60:63], v3 offset:14336
v_mfma_f32_16x16x32_bf16 v[220:223], a[140:143], a[124:127], v[220:223]
s_waitcnt lgkmcnt(3)
v_mfma_f32_16x16x32_bf16 a[192:195], a[128:131], a[64:67], a[192:195]
ds_read_b64_tr_b16 a[136:137], v11 offset:32768
v_mfma_f32_16x16x32_bf16 a[192:195], a[132:135], a[68:71], a[192:195]
v_mfma_f32_16x16x32_bf16 a[200:203], a[128:131], a[72:75], a[200:203]
ds_read_b64_tr_b16 a[138:139], v11 offset:34816
v_mfma_f32_16x16x32_bf16 a[200:203], a[132:135], a[76:79], a[200:203]
v_mfma_f32_16x16x32_bf16 a[208:211], a[128:131], a[80:83], a[208:211]
ds_read_b64_tr_b16 a[140:141], v11 offset:49152
v_mfma_f32_16x16x32_bf16 a[208:211], a[132:135], a[84:87], a[208:211]
v_mfma_f32_16x16x32_bf16 a[216:219], a[128:131], a[88:91], a[216:219]
ds_read_b64_tr_b16 a[142:143], v11 offset:51200
v_mfma_f32_16x16x32_bf16 a[216:219], a[132:135], a[92:95], a[216:219]
v_mfma_f32_16x16x32_bf16 a[224:227], a[128:131], a[96:99], a[224:227]
v_mfma_f32_16x16x32_bf16 a[224:227], a[132:135], a[100:103], a[224:227]
v_mfma_f32_16x16x32_bf16 a[232:235], a[128:131], a[104:107], a[232:235]
v_mfma_f32_16x16x32_bf16 a[232:235], a[132:135], a[108:111], a[232:235]
v_mfma_f32_16x16x32_bf16 a[240:243], a[128:131], a[112:115], a[240:243]
v_mfma_f32_16x16x32_bf16 a[240:243], a[132:135], a[116:119], a[240:243]
v_mfma_f32_16x16x32_bf16 a[248:251], a[128:131], a[120:123], a[248:251]
s_waitcnt vmcnt(2) lgkmcnt(0)
v_mfma_f32_16x16x32_bf16 a[248:251], a[132:135], a[124:127], a[248:251]
s_barrier
v_mfma_f32_16x16x32_bf16 a[196:199], a[136:139], a[64:67], a[196:199]
s_add_u32 m0, s29, 98304
ds_read_b64_tr_b16 a[128:129], v4 offset:0
v_mfma_f32_16x16x32_bf16 a[196:199], a[140:143], a[68:71], a[196:199]
buffer_load_dwordx4 v16, s[12:15], s26 offen offset:0 lds
v_mfma_f32_16x16x32_bf16 a[204:207], a[136:139], a[72:75], a[204:207]
ds_read_b64_tr_b16 a[130:131], v4 offset:2048
v_mfma_f32_16x16x32_bf16 a[204:207], a[140:143], a[76:79], a[204:207]
v_mfma_f32_16x16x32_bf16 a[212:215], a[136:139], a[80:83], a[212:215]
ds_read_b64_tr_b16 a[132:133], v4 offset:16384
v_mfma_f32_16x16x32_bf16 a[212:215], a[140:143], a[84:87], a[212:215]
buffer_load_dwordx4 v17, s[12:15], s26 offen offset:1024 lds
v_mfma_f32_16x16x32_bf16 a[220:223], a[136:139], a[88:91], a[220:223]
ds_read_b64_tr_b16 a[134:135], v4 offset:18432
v_mfma_f32_16x16x32_bf16 a[220:223], a[140:143], a[92:95], a[220:223]
v_mfma_f32_16x16x32_bf16 a[228:231], a[136:139], a[96:99], a[228:231]
v_mfma_f32_16x16x32_bf16 a[228:231], a[140:143], a[100:103], a[228:231]
buffer_load_dwordx4 v18, s[12:15], s26 offen offset:2048 lds
v_mfma_f32_16x16x32_bf16 a[236:239], a[136:139], a[104:107], a[236:239]
v_mfma_f32_16x16x32_bf16 a[236:239], a[140:143], a[108:111], a[236:239]
v_mfma_f32_16x16x32_bf16 a[244:247], a[136:139], a[112:115], a[244:247]
v_mfma_f32_16x16x32_bf16 a[244:247], a[140:143], a[116:119], a[244:247]
buffer_load_dwordx4 v19, s[12:15], s26 offen offset:3072 lds
v_mfma_f32_16x16x32_bf16 a[252:255], a[136:139], a[120:123], a[252:255]
s_add_u32 s26, s26, 524288
v_mfma_f32_16x16x32_bf16 a[252:255], a[140:143], a[124:127], a[252:255]
s_waitcnt lgkmcnt(0)
v_mfma_f32_16x16x32_bf16 v[32:35], a[128:131], a[0:3], v[32:35]
s_add_u32 m0, s29, 114688
ds_read_b64_tr_b16 a[136:137], v5 offset:0
v_mfma_f32_16x16x32_bf16 v[32:35], a[132:135], a[4:7], v[32:35]
buffer_load_dwordx4 v16, s[12:15], s27 offen offset:0 lds
v_mfma_f32_16x16x32_bf16 v[40:43], a[128:131], a[8:11], v[40:43]
ds_read_b64_tr_b16 a[138:139], v5 offset:2048
v_mfma_f32_16x16x32_bf16 v[40:43], a[132:135], a[12:15], v[40:43]
v_mfma_f32_16x16x32_bf16 v[48:51], a[128:131], a[16:19], v[48:51]
ds_read_b64_tr_b16 a[140:141], v5 offset:16384
v_mfma_f32_16x16x32_bf16 v[48:51], a[132:135], a[20:23], v[48:51]
buffer_load_dwordx4 v17, s[12:15], s27 offen offset:1024 lds
v_mfma_f32_16x16x32_bf16 v[56:59], a[128:131], a[24:27], v[56:59]
ds_read_b64_tr_b16 a[142:143], v5 offset:18432
v_mfma_f32_16x16x32_bf16 v[56:59], a[132:135], a[28:31], v[56:59]
v_mfma_f32_16x16x32_bf16 v[64:67], a[128:131], a[32:35], v[64:67]
ds_read_b128 a[64:67], v2 offset:32768
v_mfma_f32_16x16x32_bf16 v[64:67], a[132:135], a[36:39], v[64:67]
buffer_load_dwordx4 v18, s[12:15], s27 offen offset:2048 lds
v_mfma_f32_16x16x32_bf16 v[72:75], a[128:131], a[40:43], v[72:75]
ds_read_b128 a[68:71], v3 offset:32768
v_mfma_f32_16x16x32_bf16 v[72:75], a[132:135], a[44:47], v[72:75]
v_mfma_f32_16x16x32_bf16 v[80:83], a[128:131], a[48:51], v[80:83]
v_mfma_f32_16x16x32_bf16 v[80:83], a[132:135], a[52:55], v[80:83]
buffer_load_dwordx4 v19, s[12:15], s27 offen offset:3072 lds
v_mfma_f32_16x16x32_bf16 v[88:91], a[128:131], a[56:59], v[88:91]
s_add_u32 s27, s27, 524288
ds_read_b128 a[72:75], v2 offset:34816
v_mfma_f32_16x16x32_bf16 v[88:91], a[132:135], a[60:63], v[88:91]
s_waitcnt lgkmcnt(3)
v_mfma_f32_16x16x32_bf16 v[36:39], a[136:139], a[0:3], v[36:39]
s_add_u32 m0, s28, 0
ds_read_b64_tr_b16 a[128:129], v6 offset:0
v_mfma_f32_16x16x32_bf16 v[36:39], a[140:143], a[4:7], v[36:39]
buffer_load_dwordx4 v12, s[8:11], s24 offen offset:0 lds
v_mfma_f32_16x16x32_bf16 v[44:47], a[136:139], a[8:11], v[44:47]
ds_read_b64_tr_b16 a[130:131], v6 offset:2048
v_mfma_f32_16x16x32_bf16 v[44:47], a[140:143], a[12:15], v[44:47]
v_mfma_f32_16x16x32_bf16 v[52:55], a[136:139], a[16:19], v[52:55]
ds_read_b64_tr_b16 a[132:133], v6 offset:16384
v_mfma_f32_16x16x32_bf16 v[52:55], a[140:143], a[20:23], v[52:55]
buffer_load_dwordx4 v13, s[8:11], s24 offen offset:1024 lds
v_mfma_f32_16x16x32_bf16 v[60:63], a[136:139], a[24:27], v[60:63]
ds_read_b64_tr_b16 a[134:135], v6 offset:18432
v_mfma_f32_16x16x32_bf16 v[60:63], a[140:143], a[28:31], v[60:63]
v_mfma_f32_16x16x32_bf16 v[68:71], a[136:139], a[32:35], v[68:71]
ds_read_b128 a[76:79], v3 offset:34816
v_mfma_f32_16x16x32_bf16 v[68:71], a[140:143], a[36:39], v[68:71]
buffer_load_dwordx4 v14, s[8:11], s24 offen offset:2048 lds
v_mfma_f32_16x16x32_bf16 v[76:79], a[136:139], a[40:43], v[76:79]
v_mfma_f32_16x16x32_bf16 v[76:79], a[140:143], a[44:47], v[76:79]
v_mfma_f32_16x16x32_bf16 v[84:87], a[136:139], a[48:51], v[84:87]
ds_read_b128 a[80:83], v2 offset:36864
v_mfma_f32_16x16x32_bf16 v[84:87], a[140:143], a[52:55], v[84:87]
buffer_load_dwordx4 v15, s[8:11], s24 offen offset:3072 lds
v_mfma_f32_16x16x32_bf16 v[92:95], a[136:139], a[56:59], v[92:95]
s_add_u32 s24, s24, 128
ds_read_b128 a[84:87], v3 offset:36864
v_mfma_f32_16x16x32_bf16 v[92:95], a[140:143], a[60:63], v[92:95]
s_waitcnt lgkmcnt(3)
s_mov_b64 s[12:13], s[80:81]
v_mfma_f32_16x16x32_bf16 v[96:99], a[128:131], a[0:3], v[96:99]
s_mov_b32 s14, 3670016
s_add_u32 m0, s28, 16384
ds_read_b64_tr_b16 a[136:137], v7 offset:0
v_mfma_f32_16x16x32_bf16 v[96:99], a[132:135], a[4:7], v[96:99]
buffer_load_dwordx4 v12, s[8:11], s24 offen offset:0 lds
v_mfma_f32_16x16x32_bf16 v[104:107], a[128:131], a[8:11], v[104:107]
ds_read_b64_tr_b16 a[138:139], v7 offset:2048
v_mfma_f32_16x16x32_bf16 v[104:107], a[132:135], a[12:15], v[104:107]
v_mfma_f32_16x16x32_bf16 v[112:115], a[128:131], a[16:19], v[112:115]
ds_read_b64_tr_b16 a[140:141], v7 offset:16384
v_mfma_f32_16x16x32_bf16 v[112:115], a[132:135], a[20:23], v[112:115]
buffer_load_dwordx4 v13, s[8:11], s24 offen offset:1024 lds
v_mfma_f32_16x16x32_bf16 v[120:123], a[128:131], a[24:27], v[120:123]
ds_read_b64_tr_b16 a[142:143], v7 offset:18432
v_mfma_f32_16x16x32_bf16 v[120:123], a[132:135], a[28:31], v[120:123]
v_mfma_f32_16x16x32_bf16 v[128:131], a[128:131], a[32:35], v[128:131]
v_mfma_f32_16x16x32_bf16 v[128:131], a[132:135], a[36:39], v[128:131]
buffer_load_dwordx4 v14, s[8:11], s24 offen offset:2048 lds
v_mfma_f32_16x16x32_bf16 v[136:139], a[128:131], a[40:43], v[136:139]
ds_read_b128 a[88:91], v2 offset:38912
v_mfma_f32_16x16x32_bf16 v[136:139], a[132:135], a[44:47], v[136:139]
v_mfma_f32_16x16x32_bf16 v[144:147], a[128:131], a[48:51], v[144:147]
ds_read_b128 a[92:95], v3 offset:38912
v_mfma_f32_16x16x32_bf16 v[144:147], a[132:135], a[52:55], v[144:147]
buffer_load_dwordx4 v15, s[8:11], s24 offen offset:3072 lds
v_mfma_f32_16x16x32_bf16 v[152:155], a[128:131], a[56:59], v[152:155]
s_add_u32 s24, s24, 128
v_mfma_f32_16x16x32_bf16 v[152:155], a[132:135], a[60:63], v[152:155]
s_waitcnt lgkmcnt(2)
s_sub_u32 s26, s26, 8388608
v_mfma_f32_16x16x32_bf16 v[100:103], a[136:139], a[0:3], v[100:103]
s_sub_u32 s27, s27, 8388608
s_add_u32 m0, s29, 131072
ds_read_b64_tr_b16 a[128:129], v8 offset:0
v_mfma_f32_16x16x32_bf16 v[100:103], a[140:143], a[4:7], v[100:103]
PAD_5:
s_cbranch_execz M_tret
buffer_load_dwordx4 v16, s[12:15], s26 offen offset:0 lds
v_mfma_f32_16x16x32_bf16 v[108:111], a[136:139], a[8:11], v[108:111]
ds_read_b64_tr_b16 a[130:131], v8 offset:2048
v_mfma_f32_16x16x32_bf16 v[108:111], a[140:143], a[12:15], v[108:111]
v_mfma_f32_16x16x32_bf16 v[116:119], a[136:139], a[16:19], v[116:119]
ds_read_b64_tr_b16 a[132:133], v8 offset:16384
v_mfma_f32_16x16x32_bf16 v[116:119], a[140:143], a[20:23], v[116:119]
buffer_load_dwordx4 v17, s[12:15], s26 offen offset:1024 lds
v_mfma_f32_16x16x32_bf16 v[124:127], a[136:139], a[24:27], v[124:127]
ds_read_b64_tr_b16 a[134:135], v8 offset:18432
v_mfma_f32_16x16x32_bf16 v[124:127], a[140:143], a[28:31], v[124:127]
v_mfma_f32_16x16x32_bf16 v[132:135], a[136:139], a[32:35], v[132:135]
ds_read_b128 a[96:99], v2 offset:40960
v_mfma_f32_16x16x32_bf16 v[132:135], a[140:143], a[36:39], v[132:135]
buffer_load_dwordx4 v18, s[12:15], s26 offen offset:2048 lds
v_mfma_f32_16x16x32_bf16 v[140:143], a[136:139], a[40:43], v[140:143]
v_mfma_f32_16x16x32_bf16 v[140:143], a[140:143], a[44:47], v[140:143]
v_mfma_f32_16x16x32_bf16 v[148:151], a[136:139], a[48:51], v[148:151]
ds_read_b128 a[100:103], v3 offset:40960
v_mfma_f32_16x16x32_bf16 v[148:151], a[140:143], a[52:55], v[148:151]
buffer_load_dwordx4 v19, s[12:15], s26 offen offset:3072 lds
v_mfma_f32_16x16x32_bf16 v[156:159], a[136:139], a[56:59], v[156:159]
s_add_u32 s26, s26, 524288
ds_read_b128 a[104:107], v2 offset:43008
v_mfma_f32_16x16x32_bf16 v[156:159], a[140:143], a[60:63], v[156:159]
s_waitcnt lgkmcnt(3)
v_mfma_f32_16x16x32_bf16 v[160:163], a[128:131], a[0:3], v[160:163]
s_add_u32 m0, s29, 147456
ds_read_b64_tr_b16 a[136:137], v9 offset:0
v_mfma_f32_16x16x32_bf16 v[160:163], a[132:135], a[4:7], v[160:163]
buffer_load_dwordx4 v16, s[12:15], s27 offen offset:0 lds
v_mfma_f32_16x16x32_bf16 v[168:171], a[128:131], a[8:11], v[168:171]
ds_read_b64_tr_b16 a[138:139], v9 offset:2048
v_mfma_f32_16x16x32_bf16 v[168:171], a[132:135], a[12:15], v[168:171]
v_mfma_f32_16x16x32_bf16 v[176:179], a[128:131], a[16:19], v[176:179]
ds_read_b64_tr_b16 a[140:141], v9 offset:16384
v_mfma_f32_16x16x32_bf16 v[176:179], a[132:135], a[20:23], v[176:179]
buffer_load_dwordx4 v17, s[12:15], s27 offen offset:1024 lds
v_mfma_f32_16x16x32_bf16 v[184:187], a[128:131], a[24:27], v[184:187]
ds_read_b64_tr_b16 a[142:143], v9 offset:18432
v_mfma_f32_16x16x32_bf16 v[184:187], a[132:135], a[28:31], v[184:187]
v_mfma_f32_16x16x32_bf16 v[192:195], a[128:131], a[32:35], v[192:195]
v_mfma_f32_16x16x32_bf16 v[192:195], a[132:135], a[36:39], v[192:195]
buffer_load_dwordx4 v18, s[12:15], s27 offen offset:2048 lds
v_mfma_f32_16x16x32_bf16 v[200:203], a[128:131], a[40:43], v[200:203]
ds_read_b128 a[108:111], v3 offset:43008
v_mfma_f32_16x16x32_bf16 v[200:203], a[132:135], a[44:47], v[200:203]
v_mfma_f32_16x16x32_bf16 v[208:211], a[128:131], a[48:51], v[208:211]
ds_read_b128 a[112:115], v2 offset:45056
v_mfma_f32_16x16x32_bf16 v[208:211], a[132:135], a[52:55], v[208:211]
buffer_load_dwordx4 v19, s[12:15], s27 offen offset:3072 lds
v_mfma_f32_16x16x32_bf16 v[216:219], a[128:131], a[56:59], v[216:219]
s_add_u32 s27, s27, 524288
v_mfma_f32_16x16x32_bf16 v[216:219], a[132:135], a[60:63], v[216:219]
s_waitcnt lgkmcnt(2)
v_mfma_f32_16x16x32_bf16 v[164:167], a[136:139], a[0:3], v[164:167]
ds_read_b64_tr_b16 a[128:129], v10 offset:0
v_mfma_f32_16x16x32_bf16 v[164:167], a[140:143], a[4:7], v[164:167]
v_mfma_f32_16x16x32_bf16 v[172:175], a[136:139], a[8:11], v[172:175]
ds_read_b64_tr_b16 a[130:131], v10 offset:2048
v_mfma_f32_16x16x32_bf16 v[172:175], a[140:143], a[12:15], v[172:175]
v_mfma_f32_16x16x32_bf16 v[180:183], a[136:139], a[16:19], v[180:183]
ds_read_b64_tr_b16 a[132:133], v10 offset:16384
v_mfma_f32_16x16x32_bf16 v[180:183], a[140:143], a[20:23], v[180:183]
v_mfma_f32_16x16x32_bf16 v[188:191], a[136:139], a[24:27], v[188:191]
ds_read_b64_tr_b16 a[134:135], v10 offset:18432
v_mfma_f32_16x16x32_bf16 v[188:191], a[140:143], a[28:31], v[188:191]
v_mfma_f32_16x16x32_bf16 v[196:199], a[136:139], a[32:35], v[196:199]
ds_read_b128 a[116:119], v3 offset:45056
v_mfma_f32_16x16x32_bf16 v[196:199], a[140:143], a[36:39], v[196:199]
v_mfma_f32_16x16x32_bf16 v[204:207], a[136:139], a[40:43], v[204:207]
ds_read_b128 a[120:123], v2 offset:47104
v_mfma_f32_16x16x32_bf16 v[204:207], a[140:143], a[44:47], v[204:207]
v_mfma_f32_16x16x32_bf16 v[212:215], a[136:139], a[48:51], v[212:215]
v_mfma_f32_16x16x32_bf16 v[212:215], a[140:143], a[52:55], v[212:215]
v_mfma_f32_16x16x32_bf16 v[220:223], a[136:139], a[56:59], v[220:223]
ds_read_b128 a[124:127], v3 offset:47104
v_mfma_f32_16x16x32_bf16 v[220:223], a[140:143], a[60:63], v[220:223]
s_waitcnt lgkmcnt(3)
v_mfma_f32_16x16x32_bf16 a[192:195], a[128:131], a[0:3], a[192:195]
ds_read_b64_tr_b16 a[136:137], v11 offset:0
v_mfma_f32_16x16x32_bf16 a[192:195], a[132:135], a[4:7], a[192:195]
v_mfma_f32_16x16x32_bf16 a[200:203], a[128:131], a[8:11], a[200:203]
ds_read_b64_tr_b16 a[138:139], v11 offset:2048
v_mfma_f32_16x16x32_bf16 a[200:203], a[132:135], a[12:15], a[200:203]
v_mfma_f32_16x16x32_bf16 a[208:211], a[128:131], a[16:19], a[208:211]
ds_read_b64_tr_b16 a[140:141], v11 offset:16384
v_mfma_f32_16x16x32_bf16 a[208:211], a[132:135], a[20:23], a[208:211]
v_mfma_f32_16x16x32_bf16 a[216:219], a[128:131], a[24:27], a[216:219]
ds_read_b64_tr_b16 a[142:143], v11 offset:18432
v_mfma_f32_16x16x32_bf16 a[216:219], a[132:135], a[28:31], a[216:219]
v_mfma_f32_16x16x32_bf16 a[224:227], a[128:131], a[32:35], a[224:227]
v_mfma_f32_16x16x32_bf16 a[224:227], a[132:135], a[36:39], a[224:227]
v_mfma_f32_16x16x32_bf16 a[232:235], a[128:131], a[40:43], a[232:235]
v_mfma_f32_16x16x32_bf16 a[232:235], a[132:135], a[44:47], a[232:235]
v_mfma_f32_16x16x32_bf16 a[240:243], a[128:131], a[48:51], a[240:243]
v_mfma_f32_16x16x32_bf16 a[240:243], a[132:135], a[52:55], a[240:243]
v_mfma_f32_16x16x32_bf16 a[248:251], a[128:131], a[56:59], a[248:251]
s_waitcnt vmcnt(12) lgkmcnt(0)
v_mfma_f32_16x16x32_bf16 a[248:251], a[132:135], a[60:63], a[248:251]
s_barrier
v_mfma_f32_16x16x32_bf16 a[196:199], a[136:139], a[0:3], a[196:199]
s_add_u32 m0, s28, 32768
ds_read_b64_tr_b16 a[128:129], v4 offset:32768
v_mfma_f32_16x16x32_bf16 a[196:199], a[140:143], a[4:7], a[196:199]
s_lshr_b32 s22, s3, 1
buffer_load_dwordx4 v12, s[8:11], s24 offen offset:0 lds
v_mfma_f32_16x16x32_bf16 a[204:207], a[136:139], a[8:11], a[204:207]
s_lshl_b32 s22, s22, 14
ds_read_b64_tr_b16 a[130:131], v4 offset:34816
v_subrev_u32 v2, s22, v2
v_mfma_f32_16x16x32_bf16 a[204:207], a[140:143], a[12:15], a[204:207]
v_subrev_u32 v3, s22, v3
v_mfma_f32_16x16x32_bf16 a[212:215], a[136:139], a[16:19], a[212:215]
ds_read_b64_tr_b16 a[132:133], v4 offset:49152
v_mfma_f32_16x16x32_bf16 a[212:215], a[140:143], a[20:23], a[212:215]
buffer_load_dwordx4 v13, s[8:11], s24 offen offset:1024 lds
v_mfma_f32_16x16x32_bf16 a[220:223], a[136:139], a[24:27], a[220:223]
ds_read_b64_tr_b16 a[134:135], v4 offset:51200
v_mfma_f32_16x16x32_bf16 a[220:223], a[140:143], a[28:31], a[220:223]
v_mfma_f32_16x16x32_bf16 a[228:231], a[136:139], a[32:35], a[228:231]
v_mfma_f32_16x16x32_bf16 a[228:231], a[140:143], a[36:39], a[228:231]
buffer_load_dwordx4 v14, s[8:11], s24 offen offset:2048 lds
v_mfma_f32_16x16x32_bf16 a[236:239], a[136:139], a[40:43], a[236:239]
v_mfma_f32_16x16x32_bf16 a[236:239], a[140:143], a[44:47], a[236:239]
v_mfma_f32_16x16x32_bf16 a[244:247], a[136:139], a[48:51], a[244:247]
v_mfma_f32_16x16x32_bf16 a[244:247], a[140:143], a[52:55], a[244:247]
buffer_load_dwordx4 v15, s[8:11], s24 offen offset:3072 lds
v_mfma_f32_16x16x32_bf16 a[252:255], a[136:139], a[56:59], a[252:255]
s_add_u32 s24, s24, 128
v_mfma_f32_16x16x32_bf16 a[252:255], a[140:143], a[60:63], a[252:255]
s_waitcnt lgkmcnt(0)
v_mfma_f32_16x16x32_bf16 v[32:35], a[128:131], a[64:67], v[32:35]
s_add_u32 m0, s29, 65536
ds_read_b64_tr_b16 a[136:137], v5 offset:32768
v_mfma_f32_16x16x32_bf16 v[32:35], a[132:135], a[68:71], v[32:35]
buffer_load_dwordx4 v16, s[12:15], s26 offen offset:0 lds
v_mfma_f32_16x16x32_bf16 v[40:43], a[128:131], a[72:75], v[40:43]
ds_read_b64_tr_b16 a[138:139], v5 offset:34816
v_mfma_f32_16x16x32_bf16 v[40:43], a[132:135], a[76:79], v[40:43]
v_mfma_f32_16x16x32_bf16 v[48:51], a[128:131], a[80:83], v[48:51]
ds_read_b64_tr_b16 a[140:141], v5 offset:49152
v_mfma_f32_16x16x32_bf16 v[48:51], a[132:135], a[84:87], v[48:51]
buffer_load_dwordx4 v17, s[12:15], s26 offen offset:1024 lds
v_mfma_f32_16x16x32_bf16 v[56:59], a[128:131], a[88:91], v[56:59]
ds_read_b64_tr_b16 a[142:143], v5 offset:51200
v_mfma_f32_16x16x32_bf16 v[56:59], a[132:135], a[92:95], v[56:59]
v_mfma_f32_16x16x32_bf16 v[64:67], a[128:131], a[96:99], v[64:67]
ds_read_b128 a[0:3], v2 offset:0
v_mfma_f32_16x16x32_bf16 v[64:67], a[132:135], a[100:103], v[64:67]
buffer_load_dwordx4 v18, s[12:15], s26 offen offset:2048 lds
v_mfma_f32_16x16x32_bf16 v[72:75], a[128:131], a[104:107], v[72:75]
ds_read_b128 a[4:7], v3 offset:0
v_mfma_f32_16x16x32_bf16 v[72:75], a[132:135], a[108:111], v[72:75]
v_mfma_f32_16x16x32_bf16 v[80:83], a[128:131], a[112:115], v[80:83]
v_mfma_f32_16x16x32_bf16 v[80:83], a[132:135], a[116:119], v[80:83]
buffer_load_dwordx4 v19, s[12:15], s26 offen offset:3072 lds
v_mfma_f32_16x16x32_bf16 v[88:91], a[128:131], a[120:123], v[88:91]
s_add_u32 s26, s26, 524288
ds_read_b128 a[8:11], v2 offset:2048
v_mfma_f32_16x16x32_bf16 v[88:91], a[132:135], a[124:127], v[88:91]
s_waitcnt lgkmcnt(3)
v_mfma_f32_16x16x32_bf16 v[36:39], a[136:139], a[64:67], v[36:39]
s_add_u32 m0, s29, 81920
ds_read_b64_tr_b16 a[128:129], v6 offset:32768
v_mfma_f32_16x16x32_bf16 v[36:39], a[140:143], a[68:71], v[36:39]
buffer_load_dwordx4 v16, s[12:15], s27 offen offset:0 lds
v_mfma_f32_16x16x32_bf16 v[44:47], a[136:139], a[72:75], v[44:47]
ds_read_b64_tr_b16 a[130:131], v6 offset:34816
v_mfma_f32_16x16x32_bf16 v[44:47], a[140:143], a[76:79], v[44:47]
v_mfma_f32_16x16x32_bf16 v[52:55], a[136:139], a[80:83], v[52:55]
ds_read_b64_tr_b16 a[132:133], v6 offset:49152
v_mfma_f32_16x16x32_bf16 v[52:55], a[140:143], a[84:87], v[52:55]
buffer_load_dwordx4 v17, s[12:15], s27 offen offset:1024 lds
v_mfma_f32_16x16x32_bf16 v[60:63], a[136:139], a[88:91], v[60:63]
ds_read_b64_tr_b16 a[134:135], v6 offset:51200
v_cvt_pk_bf16_f32 v32, v32, v33
v_mfma_f32_16x16x32_bf16 v[60:63], a[140:143], a[92:95], v[60:63]
v_cvt_pk_bf16_f32 v33, v34, v35
v_cvt_pk_bf16_f32 v34, v36, v37
v_mfma_f32_16x16x32_bf16 v[68:71], a[136:139], a[96:99], v[68:71]
ds_read_b128 a[12:15], v3 offset:2048
v_cvt_pk_bf16_f32 v35, v38, v39
v_mfma_f32_16x16x32_bf16 v[68:71], a[140:143], a[100:103], v[68:71]
buffer_load_dwordx4 v18, s[12:15], s27 offen offset:2048 lds
v_mfma_f32_16x16x32_bf16 v[76:79], a[136:139], a[104:107], v[76:79]
v_cvt_pk_bf16_f32 v40, v40, v41
v_cvt_pk_bf16_f32 v41, v42, v43
v_mfma_f32_16x16x32_bf16 v[76:79], a[140:143], a[108:111], v[76:79]
v_cvt_pk_bf16_f32 v42, v44, v45
v_cvt_pk_bf16_f32 v43, v46, v47
v_mfma_f32_16x16x32_bf16 v[84:87], a[136:139], a[112:115], v[84:87]
ds_read_b128 a[16:19], v2 offset:4096
v_cvt_pk_bf16_f32 v48, v48, v49
v_mfma_f32_16x16x32_bf16 v[84:87], a[140:143], a[116:119], v[84:87]
buffer_load_dwordx4 v19, s[12:15], s27 offen offset:3072 lds
v_mfma_f32_16x16x32_bf16 v[92:95], a[136:139], a[120:123], v[92:95]
s_add_u32 s27, s27, 524288
ds_read_b128 a[20:23], v3 offset:4096
v_cvt_pk_bf16_f32 v49, v50, v51
v_mfma_f32_16x16x32_bf16 v[92:95], a[140:143], a[124:127], v[92:95]
s_waitcnt lgkmcnt(3)
v_cvt_pk_bf16_f32 v50, v52, v53
v_cvt_pk_bf16_f32 v51, v54, v55
v_mfma_f32_16x16x32_bf16 v[96:99], a[128:131], a[64:67], v[96:99]
s_add_u32 m0, s28, 49152
ds_read_b64_tr_b16 a[136:137], v7 offset:32768
v_cvt_pk_bf16_f32 v56, v56, v57
v_mfma_f32_16x16x32_bf16 v[96:99], a[132:135], a[68:71], v[96:99]
buffer_load_dwordx4 v12, s[8:11], s24 offen offset:0 lds
v_mfma_f32_16x16x32_bf16 v[104:107], a[128:131], a[72:75], v[104:107]
ds_read_b64_tr_b16 a[138:139], v7 offset:34816
v_cvt_pk_bf16_f32 v57, v58, v59
v_mfma_f32_16x16x32_bf16 v[104:107], a[132:135], a[76:79], v[104:107]
v_cvt_pk_bf16_f32 v58, v60, v61
v_cvt_pk_bf16_f32 v59, v62, v63
v_mfma_f32_16x16x32_bf16 v[112:115], a[128:131], a[80:83], v[112:115]
ds_read_b64_tr_b16 a[140:141], v7 offset:49152
v_cvt_pk_bf16_f32 v64, v64, v65
v_mfma_f32_16x16x32_bf16 v[112:115], a[132:135], a[84:87], v[112:115]
buffer_load_dwordx4 v13, s[8:11], s24 offen offset:1024 lds
v_mfma_f32_16x16x32_bf16 v[120:123], a[128:131], a[88:91], v[120:123]
ds_read_b64_tr_b16 a[142:143], v7 offset:51200
v_cvt_pk_bf16_f32 v65, v66, v67
v_mfma_f32_16x16x32_bf16 v[120:123], a[132:135], a[92:95], v[120:123]
v_cvt_pk_bf16_f32 v66, v68, v69
v_cvt_pk_bf16_f32 v67, v70, v71
v_mfma_f32_16x16x32_bf16 v[128:131], a[128:131], a[96:99], v[128:131]
v_cvt_pk_bf16_f32 v72, v72, v73
v_cvt_pk_bf16_f32 v73, v74, v75
v_mfma_f32_16x16x32_bf16 v[128:131], a[132:135], a[100:103], v[128:131]
buffer_load_dwordx4 v14, s[8:11], s24 offen offset:2048 lds
v_mfma_f32_16x16x32_bf16 v[136:139], a[128:131], a[104:107], v[136:139]
ds_read_b128 a[24:27], v2 offset:6144
v_cvt_pk_bf16_f32 v74, v76, v77
v_mfma_f32_16x16x32_bf16 v[136:139], a[132:135], a[108:111], v[136:139]
buffer_store_dwordx4 v[32:35], v1, s[4:7], s31 offen sc1
v_mfma_f32_16x16x32_bf16 v[144:147], a[128:131], a[112:115], v[144:147]
s_add_u32 s31, s31, s32
ds_read_b128 a[28:31], v3 offset:6144
v_cvt_pk_bf16_f32 v75, v78, v79
v_mfma_f32_16x16x32_bf16 v[144:147], a[132:135], a[116:119], v[144:147]
buffer_load_dwordx4 v15, s[8:11], s24 offen offset:3072 lds
v_mfma_f32_16x16x32_bf16 v[152:155], a[128:131], a[120:123], v[152:155]
s_add_u32 s24, s24, 128
v_cvt_pk_bf16_f32 v80, v80, v81
v_cvt_pk_bf16_f32 v81, v82, v83
v_mfma_f32_16x16x32_bf16 v[152:155], a[132:135], a[124:127], v[152:155]
s_waitcnt lgkmcnt(2)
v_cvt_pk_bf16_f32 v82, v84, v85
v_cvt_pk_bf16_f32 v83, v86, v87
v_mfma_f32_16x16x32_bf16 v[100:103], a[136:139], a[64:67], v[100:103]
ds_read_b64_tr_b16 a[128:129], v8 offset:32768
v_cvt_pk_bf16_f32 v88, v88, v89
v_mfma_f32_16x16x32_bf16 v[100:103], a[140:143], a[68:71], v[100:103]
v_cvt_pk_bf16_f32 v89, v90, v91
v_cvt_pk_bf16_f32 v90, v92, v93
v_mfma_f32_16x16x32_bf16 v[108:111], a[136:139], a[72:75], v[108:111]
ds_read_b64_tr_b16 a[130:131], v8 offset:34816
v_cvt_pk_bf16_f32 v91, v94, v95
v_mfma_f32_16x16x32_bf16 v[108:111], a[140:143], a[76:79], v[108:111]
buffer_store_dwordx4 v[40:43], v1, s[4:7], s31 offen sc1
v_mfma_f32_16x16x32_bf16 v[116:119], a[136:139], a[80:83], v[116:119]
s_add_u32 s31, s31, s33
ds_read_b64_tr_b16 a[132:133], v8 offset:49152
v_mfma_f32_16x16x32_bf16 v[116:119], a[140:143], a[84:87], v[116:119]
v_mfma_f32_16x16x32_bf16 v[124:127], a[136:139], a[88:91], v[124:127]
ds_read_b64_tr_b16 a[134:135], v8 offset:51200
v_cvt_pk_bf16_f32 v96, v96, v97
v_mfma_f32_16x16x32_bf16 v[124:127], a[140:143], a[92:95], v[124:127]
v_cvt_pk_bf16_f32 v97, v98, v99
v_cvt_pk_bf16_f32 v98, v100, v101
v_mfma_f32_16x16x32_bf16 v[132:135], a[136:139], a[96:99], v[132:135]
ds_read_b128 a[32:35], v2 offset:8192
v_cvt_pk_bf16_f32 v99, v102, v103
v_mfma_f32_16x16x32_bf16 v[132:135], a[140:143], a[100:103], v[132:135]
v_cvt_pk_bf16_f32 v104, v104, v105
v_cvt_pk_bf16_f32 v105, v106, v107
v_mfma_f32_16x16x32_bf16 v[140:143], a[136:139], a[104:107], v[140:143]
v_cvt_pk_bf16_f32 v106, v108, v109
v_cvt_pk_bf16_f32 v107, v110, v111
v_mfma_f32_16x16x32_bf16 v[140:143], a[140:143], a[108:111], v[140:143]
v_cvt_pk_bf16_f32 v112, v112, v113
v_cvt_pk_bf16_f32 v113, v114, v115
v_mfma_f32_16x16x32_bf16 v[148:151], a[136:139], a[112:115], v[148:151]
ds_read_b128 a[36:39], v3 offset:8192
v_cvt_pk_bf16_f32 v114, v116, v117
v_mfma_f32_16x16x32_bf16 v[148:151], a[140:143], a[116:119], v[148:151]
v_cvt_pk_bf16_f32 v115, v118, v119
v_cvt_pk_bf16_f32 v120, v120, v121
v_mfma_f32_16x16x32_bf16 v[156:159], a[136:139], a[120:123], v[156:159]
ds_read_b128 a[40:43], v2 offset:10240
v_cvt_pk_bf16_f32 v121, v122, v123
v_mfma_f32_16x16x32_bf16 v[156:159], a[140:143], a[124:127], v[156:159]
s_waitcnt lgkmcnt(3)
buffer_store_dwordx4 v[48:51], v1, s[4:7], s31 offen sc1
v_mfma_f32_16x16x32_bf16 v[160:163], a[128:131], a[64:67], v[160:163]
s_add_u32 s31, s31, s32
ds_read_b64_tr_b16 a[136:137], v9 offset:32768
v_cvt_pk_bf16_f32 v122, v124, v125
v_mfma_f32_16x16x32_bf16 v[160:163], a[132:135], a[68:71], v[160:163]
v_cvt_pk_bf16_f32 v123, v126, v127
v_cvt_pk_bf16_f32 v128, v128, v129
v_mfma_f32_16x16x32_bf16 v[168:171], a[128:131], a[72:75], v[168:171]
ds_read_b64_tr_b16 a[138:139], v9 offset:34816
v_cvt_pk_bf16_f32 v129, v130, v131
v_mfma_f32_16x16x32_bf16 v[168:171], a[132:135], a[76:79], v[168:171]
v_cvt_pk_bf16_f32 v130, v132, v133
v_cvt_pk_bf16_f32 v131, v134, v135
v_mfma_f32_16x16x32_bf16 v[176:179], a[128:131], a[80:83], v[176:179]
ds_read_b64_tr_b16 a[140:141], v9 offset:49152
v_cvt_pk_bf16_f32 v136, v136, v137
v_mfma_f32_16x16x32_bf16 v[176:179], a[132:135], a[84:87], v[176:179]
v_cvt_pk_bf16_f32 v137, v138, v139
v_cvt_pk_bf16_f32 v138, v140, v141
v_mfma_f32_16x16x32_bf16 v[184:187], a[128:131], a[88:91], v[184:187]
ds_read_b64_tr_b16 a[142:143], v9 offset:51200
v_cvt_pk_bf16_f32 v139, v142, v143
v_mfma_f32_16x16x32_bf16 v[184:187], a[132:135], a[92:95], v[184:187]
v_cvt_pk_bf16_f32 v144, v144, v145
v_cvt_pk_bf16_f32 v145, v146, v147
v_mfma_f32_16x16x32_bf16 v[192:195], a[128:131], a[96:99], v[192:195]
buffer_store_dwordx4 v[56:59], v1, s[4:7], s31 offen sc1
v_mfma_f32_16x16x32_bf16 v[192:195], a[132:135], a[100:103], v[192:195]
s_add_u32 s31, s31, s34
v_cvt_pk_bf16_f32 v146, v148, v149
v_cvt_pk_bf16_f32 v147, v150, v151
v_mfma_f32_16x16x32_bf16 v[200:203], a[128:131], a[104:107], v[200:203]
ds_read_b128 a[44:47], v3 offset:10240
v_cvt_pk_bf16_f32 v152, v152, v153
v_mfma_f32_16x16x32_bf16 v[200:203], a[132:135], a[108:111], v[200:203]
v_cvt_pk_bf16_f32 v153, v154, v155
v_cvt_pk_bf16_f32 v154, v156, v157
v_mfma_f32_16x16x32_bf16 v[208:211], a[128:131], a[112:115], v[208:211]
ds_read_b128 a[48:51], v2 offset:12288
v_cvt_pk_bf16_f32 v155, v158, v159
v_mfma_f32_16x16x32_bf16 v[208:211], a[132:135], a[116:119], v[208:211]
v_mfma_f32_16x16x32_bf16 v[216:219], a[128:131], a[120:123], v[216:219]
v_mfma_f32_16x16x32_bf16 v[216:219], a[132:135], a[124:127], v[216:219]
s_waitcnt lgkmcnt(2)
v_mfma_f32_16x16x32_bf16 v[164:167], a[136:139], a[64:67], v[164:167]
ds_read_b64_tr_b16 a[128:129], v10 offset:32768
v_mfma_f32_16x16x32_bf16 v[164:167], a[140:143], a[68:71], v[164:167]
v_mfma_f32_16x16x32_bf16 v[172:175], a[136:139], a[72:75], v[172:175]
ds_read_b64_tr_b16 a[130:131], v10 offset:34816
v_mfma_f32_16x16x32_bf16 v[172:175], a[140:143], a[76:79], v[172:175]
buffer_store_dwordx4 v[64:67], v1, s[4:7], s31 offen sc1
v_mfma_f32_16x16x32_bf16 v[180:183], a[136:139], a[80:83], v[180:183]
s_add_u32 s31, s31, s32
ds_read_b64_tr_b16 a[132:133], v10 offset:49152
v_mfma_f32_16x16x32_bf16 v[180:183], a[140:143], a[84:87], v[180:183]
v_mfma_f32_16x16x32_bf16 v[188:191], a[136:139], a[88:91], v[188:191]
ds_read_b64_tr_b16 a[134:135], v10 offset:51200
v_cvt_pk_bf16_f32 v160, v160, v161
v_mfma_f32_16x16x32_bf16 v[188:191], a[140:143], a[92:95], v[188:191]
v_cvt_pk_bf16_f32 v161, v162, v163
v_cvt_pk_bf16_f32 v162, v164, v165
v_mfma_f32_16x16x32_bf16 v[196:199], a[136:139], a[96:99], v[196:199]
ds_read_b128 a[52:55], v3 offset:12288
v_cvt_pk_bf16_f32 v163, v166, v167
v_mfma_f32_16x16x32_bf16 v[196:199], a[140:143], a[100:103], v[196:199]
v_cvt_pk_bf16_f32 v168, v168, v169
v_cvt_pk_bf16_f32 v169, v170, v171
v_mfma_f32_16x16x32_bf16 v[204:207], a[136:139], a[104:107], v[204:207]
ds_read_b128 a[56:59], v2 offset:14336
v_cvt_pk_bf16_f32 v170, v172, v173
v_mfma_f32_16x16x32_bf16 v[204:207], a[140:143], a[108:111], v[204:207]
v_cvt_pk_bf16_f32 v171, v174, v175
v_cvt_pk_bf16_f32 v176, v176, v177
v_mfma_f32_16x16x32_bf16 v[212:215], a[136:139], a[112:115], v[212:215]
v_cvt_pk_bf16_f32 v177, v178, v179
v_cvt_pk_bf16_f32 v178, v180, v181
v_mfma_f32_16x16x32_bf16 v[212:215], a[140:143], a[116:119], v[212:215]
buffer_store_dwordx4 v[72:75], v1, s[4:7], s31 offen sc1
v_mfma_f32_16x16x32_bf16 v[220:223], a[136:139], a[120:123], v[220:223]
s_add_u32 s31, s31, s33
ds_read_b128 a[60:63], v3 offset:14336
v_cvt_pk_bf16_f32 v179, v182, v183
v_mfma_f32_16x16x32_bf16 v[220:223], a[140:143], a[124:127], v[220:223]
s_waitcnt lgkmcnt(3)
v_cvt_pk_bf16_f32 v184, v184, v185
v_cvt_pk_bf16_f32 v185, v186, v187
v_mfma_f32_16x16x32_bf16 a[192:195], a[128:131], a[64:67], a[192:195]
ds_read_b64_tr_b16 a[136:137], v11 offset:32768
v_cvt_pk_bf16_f32 v186, v188, v189
v_mfma_f32_16x16x32_bf16 a[192:195], a[132:135], a[68:71], a[192:195]
v_cvt_pk_bf16_f32 v187, v190, v191
v_cvt_pk_bf16_f32 v192, v192, v193
v_mfma_f32_16x16x32_bf16 a[200:203], a[128:131], a[72:75], a[200:203]
ds_read_b64_tr_b16 a[138:139], v11 offset:34816
v_cvt_pk_bf16_f32 v193, v194, v195
v_mfma_f32_16x16x32_bf16 a[200:203], a[132:135], a[76:79], a[200:203]
v_cvt_pk_bf16_f32 v194, v196, v197
v_cvt_pk_bf16_f32 v195, v198, v199
v_mfma_f32_16x16x32_bf16 a[208:211], a[128:131], a[80:83], a[208:211]
ds_read_b64_tr_b16 a[140:141], v11 offset:49152
v_cvt_pk_bf16_f32 v200, v200, v201
v_mfma_f32_16x16x32_bf16 a[208:211], a[132:135], a[84:87], a[208:211]
v_cvt_pk_bf16_f32 v201, v202, v203
v_cvt_pk_bf16_f32 v202, v204, v205
v_mfma_f32_16x16x32_bf16 a[216:219], a[128:131], a[88:91], a[216:219]
ds_read_b64_tr_b16 a[142:143], v11 offset:51200
v_cvt_pk_bf16_f32 v203, v206, v207
v_mfma_f32_16x16x32_bf16 a[216:219], a[132:135], a[92:95], a[216:219]
v_cvt_pk_bf16_f32 v208, v208, v209
v_cvt_pk_bf16_f32 v209, v210, v211
v_mfma_f32_16x16x32_bf16 a[224:227], a[128:131], a[96:99], a[224:227]
buffer_store_dwordx4 v[80:83], v1, s[4:7], s31 offen sc1
v_mfma_f32_16x16x32_bf16 a[224:227], a[132:135], a[100:103], a[224:227]
s_add_u32 s31, s31, s32
v_cvt_pk_bf16_f32 v210, v212, v213
v_cvt_pk_bf16_f32 v211, v214, v215
v_mfma_f32_16x16x32_bf16 a[232:235], a[128:131], a[104:107], a[232:235]
v_cvt_pk_bf16_f32 v216, v216, v217
v_cvt_pk_bf16_f32 v217, v218, v219
v_mfma_f32_16x16x32_bf16 a[232:235], a[132:135], a[108:111], a[232:235]
v_cvt_pk_bf16_f32 v218, v220, v221
v_cvt_pk_bf16_f32 v219, v222, v223
v_mfma_f32_16x16x32_bf16 a[240:243], a[128:131], a[112:115], a[240:243]
v_mfma_f32_16x16x32_bf16 a[240:243], a[132:135], a[116:119], a[240:243]
v_mfma_f32_16x16x32_bf16 a[248:251], a[128:131], a[120:123], a[248:251]
s_waitcnt vmcnt(23) lgkmcnt(0)
v_mfma_f32_16x16x32_bf16 a[248:251], a[132:135], a[124:127], a[248:251]
s_barrier
v_mfma_f32_16x16x32_bf16 a[196:199], a[136:139], a[64:67], a[196:199]
s_add_u32 m0, s29, 98304
ds_read_b64_tr_b16 a[128:129], v22 offset:0
v_mfma_f32_16x16x32_bf16 a[196:199], a[140:143], a[68:71], a[196:199]
buffer_load_dwordx4 v16, s[12:15], s26 offen offset:0 lds
v_mfma_f32_16x16x32_bf16 a[204:207], a[136:139], a[72:75], a[204:207]
ds_read_b64_tr_b16 a[130:131], v22 offset:2048
v_mfma_f32_16x16x32_bf16 a[204:207], a[140:143], a[76:79], a[204:207]
buffer_store_dwordx4 v[88:91], v1, s[4:7], s31 offen sc1
v_mfma_f32_16x16x32_bf16 a[212:215], a[136:139], a[80:83], a[212:215]
s_add_u32 s31, s31, s35
ds_read_b64_tr_b16 a[132:133], v22 offset:16384
v_mfma_f32_16x16x32_bf16 a[212:215], a[140:143], a[84:87], a[212:215]
buffer_load_dwordx4 v17, s[12:15], s26 offen offset:1024 lds
v_mfma_f32_16x16x32_bf16 a[220:223], a[136:139], a[88:91], a[220:223]
ds_read_b64_tr_b16 a[134:135], v22 offset:18432
v_add_u32 v22, 4294901760, v22
v_mfma_f32_16x16x32_bf16 a[220:223], a[140:143], a[92:95], a[220:223]
v_mfma_f32_16x16x32_bf16 a[228:231], a[136:139], a[96:99], a[228:231]
v_mfma_f32_16x16x32_bf16 a[228:231], a[140:143], a[100:103], a[228:231]
buffer_load_dwordx4 v18, s[12:15], s26 offen offset:2048 lds
v_mfma_f32_16x16x32_bf16 a[236:239], a[136:139], a[104:107], a[236:239]
v_mfma_f32_16x16x32_bf16 a[236:239], a[140:143], a[108:111], a[236:239]
v_mfma_f32_16x16x32_bf16 a[244:247], a[136:139], a[112:115], a[244:247]
v_mfma_f32_16x16x32_bf16 a[244:247], a[140:143], a[116:119], a[244:247]
buffer_load_dwordx4 v19, s[12:15], s26 offen offset:3072 lds
v_mfma_f32_16x16x32_bf16 a[252:255], a[136:139], a[120:123], a[252:255]
s_add_u32 s26, s26, 524288
v_mfma_f32_16x16x32_bf16 a[252:255], a[140:143], a[124:127], a[252:255]
s_waitcnt lgkmcnt(0)
M_Q:
v_mfma_f32_16x16x32_bf16 v[36:39], a[128:131], a[0:3], 0
s_add_u32 m0, s29, 114688
ds_read_b64_tr_b16 a[136:137], v23 offset:0
v_mfma_f32_16x16x32_bf16 v[36:39], a[132:135], a[4:7], v[36:39]
buffer_load_dwordx4 v16, s[12:15], s27 offen offset:0 lds
v_mfma_f32_16x16x32_bf16 v[44:47], a[128:131], a[8:11], 0
ds_read_b64_tr_b16 a[138:139], v23 offset:2048
v_mfma_f32_16x16x32_bf16 v[44:47], a[132:135], a[12:15], v[44:47]
ds_read_b128 a[64:67], v2 offset:16384
ds_read_b128 a[68:71], v3 offset:16384
v_mfma_f32_16x16x32_bf16 v[52:55], a[128:131], a[16:19], 0
ds_read_b64_tr_b16 a[140:141], v23 offset:16384
v_mfma_f32_16x16x32_bf16 v[52:55], a[132:135], a[20:23], v[52:55]
buffer_load_dwordx4 v17, s[12:15], s27 offen offset:1024 lds
v_mfma_f32_16x16x32_bf16 v[60:63], a[128:131], a[24:27], 0
ds_read_b64_tr_b16 a[142:143], v23 offset:18432
v_add_u32 v23, 4294901760, v23
v_mfma_f32_16x16x32_bf16 v[60:63], a[132:135], a[28:31], v[60:63]
buffer_store_dwordx4 v[96:99], v1, s[4:7], s31 offen sc1
v_mfma_f32_16x16x32_bf16 v[68:71], a[128:131], a[32:35], 0
s_add_u32 s31, s31, s32
ds_read_b128 a[72:75], v2 offset:18432
v_mfma_f32_16x16x32_bf16 v[68:71], a[132:135], a[36:39], v[68:71]
buffer_load_dwordx4 v18, s[12:15], s27 offen offset:2048 lds
v_mfma_f32_16x16x32_bf16 v[76:79], a[128:131], a[40:43], 0
ds_read_b128 a[76:79], v3 offset:18432
v_mfma_f32_16x16x32_bf16 v[76:79], a[132:135], a[44:47], v[76:79]
ds_read_b128 a[80:83], v2 offset:20480
v_mfma_f32_16x16x32_bf16 v[84:87], a[128:131], a[48:51], 0
ds_read_b128 a[84:87], v3 offset:20480
v_mfma_f32_16x16x32_bf16 v[84:87], a[132:135], a[52:55], v[84:87]
buffer_load_dwordx4 v19, s[12:15], s27 offen offset:3072 lds
v_mfma_f32_16x16x32_bf16 v[92:95], a[128:131], a[56:59], 0
s_add_u32 s27, s27, 524288
ds_read_b128 a[88:91], v2 offset:22528
v_mfma_f32_16x16x32_bf16 v[92:95], a[132:135], a[60:63], v[92:95]
s_waitcnt lgkmcnt(5)
buffer_store_dwordx4 v[104:107], v1, s[4:7], s31 offen sc1
v_mfma_f32_16x16x32_bf16 v[100:103], a[136:139], a[0:3], 0
s_add_u32 m0, s28, 0
ds_read_b64_tr_b16 a[128:129], v24 offset:0
v_mfma_f32_16x16x32_bf16 v[100:103], a[140:143], a[4:7], v[100:103]
s_add_u32 s31, s31, s33
buffer_load_dwordx4 v12, s[8:11], s24 offen offset:0 lds
v_mfma_f32_16x16x32_bf16 v[108:111], a[136:139], a[8:11], 0
ds_read_b64_tr_b16 a[130:131], v24 offset:2048
v_mfma_f32_16x16x32_bf16 v[108:111], a[140:143], a[12:15], v[108:111]
ds_read_b128 a[92:95], v3 offset:22528
v_mfma_f32_16x16x32_bf16 v[116:119], a[136:139], a[16:19], 0
ds_read_b64_tr_b16 a[132:133], v24 offset:16384
v_mfma_f32_16x16x32_bf16 v[116:119], a[140:143], a[20:23], v[116:119]
buffer_load_dwordx4 v13, s[8:11], s24 offen offset:1024 lds
v_mfma_f32_16x16x32_bf16 v[124:127], a[136:139], a[24:27], 0
ds_read_b64_tr_b16 a[134:135], v24 offset:18432
v_add_u32 v24, 4294901760, v24
v_mfma_f32_16x16x32_bf16 v[124:127], a[140:143], a[28:31], v[124:127]
v_mfma_f32_16x16x32_bf16 v[132:135], a[136:139], a[32:35], 0
ds_read_b128 a[96:99], v2 offset:24576
v_mfma_f32_16x16x32_bf16 v[132:135], a[140:143], a[36:39], v[132:135]
buffer_load_dwordx4 v14, s[8:11], s24 offen offset:2048 lds
v_mfma_f32_16x16x32_bf16 v[140:143], a[136:139], a[40:43], 0
ds_read_b128 a[100:103], v3 offset:24576
v_mfma_f32_16x16x32_bf16 v[140:143], a[140:143], a[44:47], v[140:143]
ds_read_b128 a[104:107], v2 offset:26624
v_mfma_f32_16x16x32_bf16 v[148:151], a[136:139], a[48:51], 0
ds_read_b128 a[108:111], v3 offset:26624
v_mfma_f32_16x16x32_bf16 v[148:151], a[140:143], a[52:55], v[148:151]
PAD_6:
s_cbranch_execz M_tret
buffer_load_dwordx4 v15, s[8:11], s24 offen offset:3072 lds
v_mfma_f32_16x16x32_bf16 v[156:159], a[136:139], a[56:59], 0
s_add_u32 s24, s24, 128
ds_read_b128 a[112:115], v2 offset:28672
v_mfma_f32_16x16x32_bf16 v[156:159], a[140:143], a[60:63], v[156:159]
s_waitcnt lgkmcnt(5)
buffer_store_dwordx4 v[112:115], v1, s[4:7], s31 offen sc1
v_mfma_f32_16x16x32_bf16 v[164:167], a[128:131], a[0:3], 0
s_add_u32 s31, s31, s32
ds_read_b64_tr_b16 a[136:137], v25 offset:0
v_mfma_f32_16x16x32_bf16 v[164:167], a[132:135], a[4:7], v[164:167]
v_mfma_f32_16x16x32_bf16 v[172:175], a[128:131], a[8:11], 0
ds_read_b64_tr_b16 a[138:139], v25 offset:2048
v_mfma_f32_16x16x32_bf16 v[172:175], a[132:135], a[12:15], v[172:175]
ds_read_b128 a[116:119], v3 offset:28672
v_mfma_f32_16x16x32_bf16 v[180:183], a[128:131], a[16:19], 0
ds_read_b64_tr_b16 a[140:141], v25 offset:16384
v_mfma_f32_16x16x32_bf16 v[180:183], a[132:135], a[20:23], v[180:183]
v_mfma_f32_16x16x32_bf16 v[188:191], a[128:131], a[24:27], 0
ds_read_b64_tr_b16 a[142:143], v25 offset:18432
v_add_u32 v25, 4294901760, v25
v_mfma_f32_16x16x32_bf16 v[188:191], a[132:135], a[28:31], v[188:191]
v_mfma_f32_16x16x32_bf16 v[196:199], a[128:131], a[32:35], 0
ds_read_b128 a[120:123], v2 offset:30720
v_mfma_f32_16x16x32_bf16 v[196:199], a[132:135], a[36:39], v[196:199]
v_mfma_f32_16x16x32_bf16 v[204:207], a[128:131], a[40:43], 0
ds_read_b128 a[124:127], v3 offset:30720
v_mfma_f32_16x16x32_bf16 v[204:207], a[132:135], a[44:47], v[204:207]
v_mfma_f32_16x16x32_bf16 v[212:215], a[128:131], a[48:51], 0
v_mfma_f32_16x16x32_bf16 v[212:215], a[132:135], a[52:55], v[212:215]
buffer_store_dwordx4 v[120:123], v1, s[4:7], s31 offen sc1
v_mfma_f32_16x16x32_bf16 v[220:223], a[128:131], a[56:59], 0
s_add_u32 s31, s31, s34
v_mfma_f32_16x16x32_bf16 v[220:223], a[132:135], a[60:63], v[220:223]
s_waitcnt vmcnt(28) lgkmcnt(0)
s_barrier
v_mfma_f32_16x16x32_bf16 v[224:227], a[136:139], a[0:3], 0
s_add_u32 m0, s29, 131072
ds_read_b64_tr_b16 a[128:129], v22 offset:0
v_mfma_f32_16x16x32_bf16 v[224:227], a[140:143], a[4:7], v[224:227]
buffer_load_dwordx4 v16, s[12:15], s26 offen offset:0 lds
v_mfma_f32_16x16x32_bf16 v[228:231], a[136:139], a[8:11], 0
ds_read_b64_tr_b16 a[130:131], v22 offset:2048
v_mfma_f32_16x16x32_bf16 v[228:231], a[140:143], a[12:15], v[228:231]
v_mfma_f32_16x16x32_bf16 v[232:235], a[136:139], a[16:19], 0
ds_read_b64_tr_b16 a[132:133], v22 offset:16384
v_mfma_f32_16x16x32_bf16 v[232:235], a[140:143], a[20:23], v[232:235]
buffer_load_dwordx4 v17, s[12:15], s26 offen offset:1024 lds
v_mfma_f32_16x16x32_bf16 v[236:239], a[136:139], a[24:27], 0
ds_read_b64_tr_b16 a[134:135], v22 offset:18432
v_add_u32 v22, 32768, v22
v_mfma_f32_16x16x32_bf16 v[236:239], a[140:143], a[28:31], v[236:239]
v_mfma_f32_16x16x32_bf16 v[240:243], a[136:139], a[32:35], 0
v_mfma_f32_16x16x32_bf16 v[240:243], a[140:143], a[36:39], v[240:243]
buffer_load_dwordx4 v18, s[12:15], s26 offen offset:2048 lds
v_mfma_f32_16x16x32_bf16 v[244:247], a[136:139], a[40:43], 0
v_mfma_f32_16x16x32_bf16 v[244:247], a[140:143], a[44:47], v[244:247]
v_mfma_f32_16x16x32_bf16 v[248:251], a[136:139], a[48:51], 0
v_mfma_f32_16x16x32_bf16 v[248:251], a[140:143], a[52:55], v[248:251]
buffer_load_dwordx4 v19, s[12:15], s26 offen offset:3072 lds
v_mfma_f32_16x16x32_bf16 v[252:255], a[136:139], a[56:59], 0
s_add_u32 s26, s26, 524288
v_mfma_f32_16x16x32_bf16 v[252:255], a[140:143], a[60:63], v[252:255]
s_waitcnt lgkmcnt(0)
v_mfma_f32_16x16x32_bf16 v[36:39], a[128:131], a[64:67], v[36:39]
s_add_u32 m0, s29, 147456
ds_read_b64_tr_b16 a[136:137], v23 offset:0
v_mfma_f32_16x16x32_bf16 v[36:39], a[132:135], a[68:71], v[36:39]
buffer_load_dwordx4 v16, s[12:15], s27 offen offset:0 lds
v_mfma_f32_16x16x32_bf16 v[44:47], a[128:131], a[72:75], v[44:47]
ds_read_b64_tr_b16 a[138:139], v23 offset:2048
v_mfma_f32_16x16x32_bf16 v[44:47], a[132:135], a[76:79], v[44:47]
ds_read_b128 a[0:3], v2 offset:32768
ds_read_b128 a[4:7], v3 offset:32768
v_mfma_f32_16x16x32_bf16 v[52:55], a[128:131], a[80:83], v[52:55]
ds_read_b64_tr_b16 a[140:141], v23 offset:16384
v_mfma_f32_16x16x32_bf16 v[52:55], a[132:135], a[84:87], v[52:55]
buffer_load_dwordx4 v17, s[12:15], s27 offen offset:1024 lds
v_mfma_f32_16x16x32_bf16 v[60:63], a[128:131], a[88:91], v[60:63]
ds_read_b64_tr_b16 a[142:143], v23 offset:18432
v_add_u32 v23, 32768, v23
v_mfma_f32_16x16x32_bf16 v[60:63], a[132:135], a[92:95], v[60:63]
buffer_store_dwordx4 v[128:131], v1, s[4:7], s31 offen sc1
v_mfma_f32_16x16x32_bf16 v[68:71], a[128:131], a[96:99], v[68:71]
s_add_u32 s31, s31, s32
ds_read_b128 a[8:11], v2 offset:34816
v_accvgpr_read_b32 v32, a192
v_mfma_f32_16x16x32_bf16 v[68:71], a[132:135], a[100:103], v[68:71]
buffer_load_dwordx4 v18, s[12:15], s27 offen offset:2048 lds
v_mfma_f32_16x16x32_bf16 v[76:79], a[128:131], a[104:107], v[76:79]
ds_read_b128 a[12:15], v3 offset:34816
v_accvgpr_read_b32 v33, a193
v_mfma_f32_16x16x32_bf16 v[76:79], a[132:135], a[108:111], v[76:79]
ds_read_b128 a[16:19], v2 offset:36864
v_accvgpr_read_b32 v34, a194
v_mfma_f32_16x16x32_bf16 v[84:87], a[128:131], a[112:115], v[84:87]
ds_read_b128 a[20:23], v3 offset:36864
v_accvgpr_read_b32 v35, a195
v_mfma_f32_16x16x32_bf16 v[84:87], a[132:135], a[116:119], v[84:87]
buffer_load_dwordx4 v19, s[12:15], s27 offen offset:3072 lds
v_mfma_f32_16x16x32_bf16 v[92:95], a[128:131], a[120:123], v[92:95]
s_add_u32 s27, s27, 524288
ds_read_b128 a[24:27], v2 offset:38912
v_accvgpr_read_b32 v96, a196
v_mfma_f32_16x16x32_bf16 v[92:95], a[132:135], a[124:127], v[92:95]
s_waitcnt lgkmcnt(5)
buffer_store_dwordx4 v[136:139], v1, s[4:7], s31 offen sc1
v_mfma_f32_16x16x32_bf16 v[100:103], a[136:139], a[64:67], v[100:103]
s_add_u32 m0, s28, 16384
ds_read_b64_tr_b16 a[128:129], v24 offset:0
v_accvgpr_read_b32 v97, a197
v_mfma_f32_16x16x32_bf16 v[100:103], a[140:143], a[68:71], v[100:103]
s_add_u32 s31, s31, s33
buffer_load_dwordx4 v12, s[8:11], s24 offen offset:0 lds
v_mfma_f32_16x16x32_bf16 v[108:111], a[136:139], a[72:75], v[108:111]
ds_read_b64_tr_b16 a[130:131], v24 offset:2048
v_accvgpr_read_b32 v98, a198
v_mfma_f32_16x16x32_bf16 v[108:111], a[140:143], a[76:79], v[108:111]
ds_read_b128 a[28:31], v3 offset:38912
v_accvgpr_read_b32 v99, a199
v_mfma_f32_16x16x32_bf16 v[116:119], a[136:139], a[80:83], v[116:119]
ds_read_b64_tr_b16 a[132:133], v24 offset:16384
v_cvt_pk_bf16_f32 v32, v32, v33
v_mfma_f32_16x16x32_bf16 v[116:119], a[140:143], a[84:87], v[116:119]
buffer_load_dwordx4 v13, s[8:11], s24 offen offset:1024 lds
v_mfma_f32_16x16x32_bf16 v[124:127], a[136:139], a[88:91], v[124:127]
ds_read_b64_tr_b16 a[134:135], v24 offset:18432
v_add_u32 v24, 32768, v24
v_mfma_f32_16x16x32_bf16 v[124:127], a[140:143], a[92:95], v[124:127]
v_cvt_pk_bf16_f32 v33, v34, v35
v_cvt_pk_bf16_f32 v34, v96, v97
v_mfma_f32_16x16x32_bf16 v[132:135], a[136:139], a[96:99], v[132:135]
ds_read_b128 a[32:35], v2 offset:40960
v_cvt_pk_bf16_f32 v35, v98, v99
v_mfma_f32_16x16x32_bf16 v[132:135], a[140:143], a[100:103], v[132:135]
buffer_load_dwordx4 v14, s[8:11], s24 offen offset:2048 lds
v_mfma_f32_16x16x32_bf16 v[140:143], a[136:139], a[104:107], v[140:143]
ds_read_b128 a[36:39], v3 offset:40960
v_accvgpr_read_b32 v40, a200
v_mfma_f32_16x16x32_bf16 v[140:143], a[140:143], a[108:111], v[140:143]
ds_read_b128 a[40:43], v2 offset:43008
v_accvgpr_read_b32 v41, a201
v_mfma_f32_16x16x32_bf16 v[148:151], a[136:139], a[112:115], v[148:151]
ds_read_b128 a[44:47], v3 offset:43008
v_accvgpr_read_b32 v42, a202
v_mfma_f32_16x16x32_bf16 v[148:151], a[140:143], a[116:119], v[148:151]
buffer_load_dwordx4 v15, s[8:11], s24 offen offset:3072 lds
v_mfma_f32_16x16x32_bf16 v[156:159], a[136:139], a[120:123], v[156:159]
s_add_u32 s24, s24, 128
ds_read_b128 a[48:51], v2 offset:45056
v_accvgpr_read_b32 v43, a203
v_mfma_f32_16x16x32_bf16 v[156:159], a[140:143], a[124:127], v[156:159]
s_waitcnt lgkmcnt(5)
buffer_store_dwordx4 v[144:147], v1, s[4:7], s31 offen sc1
v_mfma_f32_16x16x32_bf16 v[164:167], a[128:131], a[64:67], v[164:167]
s_add_u32 s31, s31, s32
ds_read_b64_tr_b16 a[136:137], v25 offset:0
v_accvgpr_read_b32 v96, a204
v_mfma_f32_16x16x32_bf16 v[164:167], a[132:135], a[68:71], v[164:167]
v_accvgpr_read_b32 v97, a205
v_accvgpr_read_b32 v98, a206
v_mfma_f32_16x16x32_bf16 v[172:175], a[128:131], a[72:75], v[172:175]
ds_read_b64_tr_b16 a[138:139], v25 offset:2048
v_accvgpr_read_b32 v99, a207
v_mfma_f32_16x16x32_bf16 v[172:175], a[132:135], a[76:79], v[172:175]
ds_read_b128 a[52:55], v3 offset:45056
v_cvt_pk_bf16_f32 v40, v40, v41
v_mfma_f32_16x16x32_bf16 v[180:183], a[128:131], a[80:83], v[180:183]
ds_read_b64_tr_b16 a[140:141], v25 offset:16384
v_cvt_pk_bf16_f32 v41, v42, v43
v_mfma_f32_16x16x32_bf16 v[180:183], a[132:135], a[84:87], v[180:183]
v_cvt_pk_bf16_f32 v42, v96, v97
v_cvt_pk_bf16_f32 v43, v98, v99
v_mfma_f32_16x16x32_bf16 v[188:191], a[128:131], a[88:91], v[188:191]
ds_read_b64_tr_b16 a[142:143], v25 offset:18432
v_add_u32 v25, 32768, v25
v_mfma_f32_16x16x32_bf16 v[188:191], a[132:135], a[92:95], v[188:191]
v_accvgpr_read_b32 v48, a208
v_accvgpr_read_b32 v49, a209
v_mfma_f32_16x16x32_bf16 v[196:199], a[128:131], a[96:99], v[196:199]
ds_read_b128 a[56:59], v2 offset:47104
v_accvgpr_read_b32 v50, a210
v_mfma_f32_16x16x32_bf16 v[196:199], a[132:135], a[100:103], v[196:199]
v_accvgpr_read_b32 v51, a211
v_accvgpr_read_b32 v96, a212
v_mfma_f32_16x16x32_bf16 v[204:207], a[128:131], a[104:107], v[204:207]
ds_read_b128 a[60:63], v3 offset:47104
v_accvgpr_read_b32 v97, a213
v_mfma_f32_16x16x32_bf16 v[204:207], a[132:135], a[108:111], v[204:207]
v_accvgpr_read_b32 v98, a214
v_accvgpr_read_b32 v99, a215
v_mfma_f32_16x16x32_bf16 v[212:215], a[128:131], a[112:115], v[212:215]
v_cvt_pk_bf16_f32 v48, v48, v49
v_cvt_pk_bf16_f32 v49, v50, v51
v_mfma_f32_16x16x32_bf16 v[212:215], a[132:135], a[116:119], v[212:215]
buffer_store_dwordx4 v[152:155], v1, s[4:7], s31 offen sc1
v_mfma_f32_16x16x32_bf16 v[220:223], a[128:131], a[120:123], v[220:223]
s_add_u32 s31, s31, s36
v_cvt_pk_bf16_f32 v50, v96, v97
v_cvt_pk_bf16_f32 v51, v98, v99
v_mfma_f32_16x16x32_bf16 v[220:223], a[132:135], a[124:127], v[220:223]
s_waitcnt vmcnt(23) lgkmcnt(0)
s_barrier
v_accvgpr_read_b32 v56, a216
v_mfma_f32_16x16x32_bf16 v[224:227], a[136:139], a[64:67], v[224:227]
s_add_u32 m0, s29, 65536
ds_read_b64_tr_b16 a[128:129], v22 offset:0
v_accvgpr_read_b32 v57, a217
v_mfma_f32_16x16x32_bf16 v[224:227], a[140:143], a[68:71], v[224:227]
buffer_load_dwordx4 v16, s[12:15], s26 offen offset:0 lds
v_mfma_f32_16x16x32_bf16 v[228:231], a[136:139], a[72:75], v[228:231]
ds_read_b64_tr_b16 a[130:131], v22 offset:2048
v_accvgpr_read_b32 v58, a218
v_mfma_f32_16x16x32_bf16 v[228:231], a[140:143], a[76:79], v[228:231]
v_accvgpr_read_b32 v59, a219
v_accvgpr_read_b32 v96, a220
v_mfma_f32_16x16x32_bf16 v[232:235], a[136:139], a[80:83], v[232:235]
ds_read_b64_tr_b16 a[132:133], v22 offset:16384
v_accvgpr_read_b32 v97, a221
v_mfma_f32_16x16x32_bf16 v[232:235], a[140:143], a[84:87], v[232:235]
buffer_load_dwordx4 v17, s[12:15], s26 offen offset:1024 lds
v_mfma_f32_16x16x32_bf16 v[236:239], a[136:139], a[88:91], v[236:239]
ds_read_b64_tr_b16 a[134:135], v22 offset:18432
v_add_u32 v22, 32768, v22
v_mfma_f32_16x16x32_bf16 v[236:239], a[140:143], a[92:95], v[236:239]
v_accvgpr_read_b32 v98, a222
v_accvgpr_read_b32 v99, a223
v_mfma_f32_16x16x32_bf16 v[240:243], a[136:139], a[96:99], v[240:243]
v_cvt_pk_bf16_f32 v56, v56, v57
v_cvt_pk_bf16_f32 v57, v58, v59
v_mfma_f32_16x16x32_bf16 v[240:243], a[140:143], a[100:103], v[240:243]
buffer_load_dwordx4 v18, s[12:15], s26 offen offset:2048 lds
v_mfma_f32_16x16x32_bf16 v[244:247], a[136:139], a[104:107], v[244:247]
v_cvt_pk_bf16_f32 v58, v96, v97
v_cvt_pk_bf16_f32 v59, v98, v99
v_mfma_f32_16x16x32_bf16 v[244:247], a[140:143], a[108:111], v[244:247]
v_accvgpr_read_b32 v64, a224
v_accvgpr_read_b32 v65, a225
v_mfma_f32_16x16x32_bf16 v[248:251], a[136:139], a[112:115], v[248:251]
v_accvgpr_read_b32 v66, a226
v_accvgpr_read_b32 v67, a227
v_mfma_f32_16x16x32_bf16 v[248:251], a[140:143], a[116:119], v[248:251]
buffer_load_dwordx4 v19, s[12:15], s26 offen offset:3072 lds
v_mfma_f32_16x16x32_bf16 v[252:255], a[136:139], a[120:123], v[252:255]
s_add_u32 s26, s26, 524288
v_accvgpr_read_b32 v96, a228
v_accvgpr_read_b32 v97, a229
v_mfma_f32_16x16x32_bf16 v[252:255], a[140:143], a[124:127], v[252:255]
s_waitcnt lgkmcnt(0)
v_accvgpr_read_b32 v98, a230
v_accvgpr_read_b32 v99, a231
v_mfma_f32_16x16x32_bf16 v[36:39], a[128:131], a[0:3], v[36:39]
s_add_u32 m0, s29, 81920
ds_read_b64_tr_b16 a[136:137], v23 offset:0
v_cvt_pk_bf16_f32 v64, v64, v65
v_mfma_f32_16x16x32_bf16 v[36:39], a[132:135], a[4:7], v[36:39]
buffer_load_dwordx4 v16, s[12:15], s27 offen offset:0 lds
v_mfma_f32_16x16x32_bf16 v[44:47], a[128:131], a[8:11], v[44:47]
ds_read_b64_tr_b16 a[138:139], v23 offset:2048
v_cvt_pk_bf16_f32 v65, v66, v67
v_mfma_f32_16x16x32_bf16 v[44:47], a[132:135], a[12:15], v[44:47]
ds_read_b128 a[64:67], v2 offset:49152
ds_read_b128 a[68:71], v3 offset:49152
v_mfma_f32_16x16x32_bf16 v[52:55], a[128:131], a[16:19], v[52:55]
ds_read_b64_tr_b16 a[140:141], v23 offset:16384
v_cvt_pk_bf16_f32 v66, v96, v97
v_mfma_f32_16x16x32_bf16 v[52:55], a[132:135], a[20:23], v[52:55]
buffer_load_dwordx4 v17, s[12:15], s27 offen offset:1024 lds
v_mfma_f32_16x16x32_bf16 v[60:63], a[128:131], a[24:27], v[60:63]
ds_read_b64_tr_b16 a[142:143], v23 offset:18432
v_add_u32 v23, 32768, v23
v_mfma_f32_16x16x32_bf16 v[60:63], a[132:135], a[28:31], v[60:63]
buffer_store_dwordx4 v[160:163], v1, s[4:7], s31 offen sc1
v_mfma_f32_16x16x32_bf16 v[68:71], a[128:131], a[32:35], v[68:71]
s_add_u32 s31, s31, s32
ds_read_b128 a[72:75], v2 offset:51200
v_cvt_pk_bf16_f32 v67, v98, v99
v_mfma_f32_16x16x32_bf16 v[68:71], a[132:135], a[36:39], v[68:71]
buffer_load_dwordx4 v18, s[12:15], s27 offen offset:2048 lds
v_mfma_f32_16x16x32_bf16 v[76:79], a[128:131], a[40:43], v[76:79]
ds_read_b128 a[76:79], v3 offset:51200
v_accvgpr_read_b32 v72, a232
v_mfma_f32_16x16x32_bf16 v[76:79], a[132:135], a[44:47], v[76:79]
ds_read_b128 a[80:83], v2 offset:53248
v_accvgpr_read_b32 v73, a233
v_mfma_f32_16x16x32_bf16 v[84:87], a[128:131], a[48:51], v[84:87]
ds_read_b128 a[84:87], v3 offset:53248
v_accvgpr_read_b32 v74, a234
v_mfma_f32_16x16x32_bf16 v[84:87], a[132:135], a[52:55], v[84:87]
buffer_load_dwordx4 v19, s[12:15], s27 offen offset:3072 lds
v_mfma_f32_16x16x32_bf16 v[92:95], a[128:131], a[56:59], v[92:95]
s_add_u32 s27, s27, 524288
ds_read_b128 a[88:91], v2 offset:55296
v_accvgpr_read_b32 v75, a235
v_mfma_f32_16x16x32_bf16 v[92:95], a[132:135], a[60:63], v[92:95]
s_waitcnt lgkmcnt(5)
buffer_store_dwordx4 v[168:171], v1, s[4:7], s31 offen sc1
v_mfma_f32_16x16x32_bf16 v[100:103], a[136:139], a[0:3], v[100:103]
s_add_u32 m0, s28, 32768
ds_read_b64_tr_b16 a[128:129], v24 offset:0
v_accvgpr_read_b32 v96, a236
v_mfma_f32_16x16x32_bf16 v[100:103], a[140:143], a[4:7], v[100:103]
s_add_u32 s31, s31, s33
buffer_load_dwordx4 v12, s[8:11], s24 offen offset:0 lds
v_mfma_f32_16x16x32_bf16 v[108:111], a[136:139], a[8:11], v[108:111]
ds_read_b64_tr_b16 a[130:131], v24 offset:2048
v_accvgpr_read_b32 v97, a237
v_mfma_f32_16x16x32_bf16 v[108:111], a[140:143], a[12:15], v[108:111]
ds_read_b128 a[92:95], v3 offset:55296
v_accvgpr_read_b32 v98, a238
v_mfma_f32_16x16x32_bf16 v[116:119], a[136:139], a[16:19], v[116:119]
ds_read_b64_tr_b16 a[132:133], v24 offset:16384
v_accvgpr_read_b32 v99, a239
v_mfma_f32_16x16x32_bf16 v[116:119], a[140:143], a[20:23], v[116:119]
buffer_load_dwordx4 v13, s[8:11], s24 offen offset:1024 lds
v_mfma_f32_16x16x32_bf16 v[124:127], a[136:139], a[24:27], v[124:127]
ds_read_b64_tr_b16 a[134:135], v24 offset:18432
v_add_u32 v24, 32768, v24
v_mfma_f32_16x16x32_bf16 v[124:127], a[140:143], a[28:31], v[124:127]
v_cvt_pk_bf16_f32 v72, v72, v73
v_cvt_pk_bf16_f32 v73, v74, v75
v_mfma_f32_16x16x32_bf16 v[132:135], a[136:139], a[32:35], v[132:135]
ds_read_b128 a[96:99], v2 offset:57344
v_cvt_pk_bf16_f32 v74, v96, v97
v_mfma_f32_16x16x32_bf16 v[132:135], a[140:143], a[36:39], v[132:135]
buffer_load_dwordx4 v14, s[8:11], s24 offen offset:2048 lds
v_mfma_f32_16x16x32_bf16 v[140:143], a[136:139], a[40:43], v[140:143]
ds_read_b128 a[100:103], v3 offset:57344
v_cvt_pk_bf16_f32 v75, v98, v99
v_mfma_f32_16x16x32_bf16 v[140:143], a[140:143], a[44:47], v[140:143]
ds_read_b128 a[104:107], v2 offset:59392
v_accvgpr_read_b32 v80, a240
v_mfma_f32_16x16x32_bf16 v[148:151], a[136:139], a[48:51], v[148:151]
ds_read_b128 a[108:111], v3 offset:59392
v_accvgpr_read_b32 v81, a241
v_mfma_f32_16x16x32_bf16 v[148:151], a[140:143], a[52:55], v[148:151]
buffer_load_dwordx4 v15, s[8:11], s24 offen offset:3072 lds
v_mfma_f32_16x16x32_bf16 v[156:159], a[136:139], a[56:59], v[156:159]
s_add_u32 s24, s24, 128
ds_read_b128 a[112:115], v2 offset:61440
v_accvgpr_read_b32 v82, a242
v_mfma_f32_16x16x32_bf16 v[156:159], a[140:143], a[60:63], v[156:159]
s_waitcnt lgkmcnt(5)
buffer_store_dwordx4 v[176:179], v1, s[4:7], s31 offen sc1
v_mfma_f32_16x16x32_bf16 v[164:167], a[128:131], a[0:3], v[164:167]
s_add_u32 s31, s31, s32
ds_read_b64_tr_b16 a[136:137], v25 offset:0
v_accvgpr_read_b32 v83, a243
v_mfma_f32_16x16x32_bf16 v[164:167], a[132:135], a[4:7], v[164:167]
v_accvgpr_read_b32 v96, a244
v_accvgpr_read_b32 v97, a245
v_mfma_f32_16x16x32_bf16 v[172:175], a[128:131], a[8:11], v[172:175]
ds_read_b64_tr_b16 a[138:139], v25 offset:2048
v_accvgpr_read_b32 v98, a246
v_mfma_f32_16x16x32_bf16 v[172:175], a[132:135], a[12:15], v[172:175]
ds_read_b128 a[116:119], v3 offset:61440
v_accvgpr_read_b32 v99, a247
v_mfma_f32_16x16x32_bf16 v[180:183], a[128:131], a[16:19], v[180:183]
ds_read_b64_tr_b16 a[140:141], v25 offset:16384
v_cvt_pk_bf16_f32 v80, v80, v81
v_mfma_f32_16x16x32_bf16 v[180:183], a[132:135], a[20:23], v[180:183]
buffer_store_dwordx4 v[184:187], v1, s[4:7], s31 offen sc1
v_mfma_f32_16x16x32_bf16 v[188:191], a[128:131], a[24:27], v[188:191]
s_add_u32 s31, s31, s34
ds_read_b64_tr_b16 a[142:143], v25 offset:18432
v_add_u32 v25, 32768, v25
v_mfma_f32_16x16x32_bf16 v[188:191], a[132:135], a[28:31], v[188:191]
v_cvt_pk_bf16_f32 v81, v82, v83
v_cvt_pk_bf16_f32 v82, v96, v97
v_mfma_f32_16x16x32_bf16 v[196:199], a[128:131], a[32:35], v[196:199]
ds_read_b128 a[120:123], v2 offset:63488
v_cvt_pk_bf16_f32 v83, v98, v99
v_mfma_f32_16x16x32_bf16 v[196:199], a[132:135], a[36:39], v[196:199]
v_accvgpr_read_b32 v88, a248
v_accvgpr_read_b32 v89, a249
v_mfma_f32_16x16x32_bf16 v[204:207], a[128:131], a[40:43], v[204:207]
ds_read_b128 a[124:127], v3 offset:63488
v_accvgpr_read_b32 v90, a250
v_mfma_f32_16x16x32_bf16 v[204:207], a[132:135], a[44:47], v[204:207]
v_accvgpr_read_b32 v91, a251
v_accvgpr_read_b32 v96, a252
v_mfma_f32_16x16x32_bf16 v[212:215], a[128:131], a[48:51], v[212:215]
v_accvgpr_read_b32 v97, a253
v_accvgpr_read_b32 v98, a254
v_mfma_f32_16x16x32_bf16 v[212:215], a[132:135], a[52:55], v[212:215]
v_accvgpr_read_b32 v99, a255
v_cvt_pk_bf16_f32 v88, v88, v89
v_mfma_f32_16x16x32_bf16 v[220:223], a[128:131], a[56:59], v[220:223]
v_cvt_pk_bf16_f32 v89, v90, v91
v_cvt_pk_bf16_f32 v90, v96, v97
v_mfma_f32_16x16x32_bf16 v[220:223], a[132:135], a[60:63], v[220:223]
s_waitcnt vmcnt(23) lgkmcnt(0)
s_barrier
v_cvt_pk_bf16_f32 v91, v98, v99
v_mfma_f32_16x16x32_bf16 v[224:227], a[136:139], a[0:3], v[224:227]
s_add_u32 m0, s29, 98304
ds_read_b64_tr_b16 a[128:129], v22 offset:0
v_mfma_f32_16x16x32_bf16 v[224:227], a[140:143], a[4:7], v[224:227]
buffer_load_dwordx4 v16, s[12:15], s26 offen offset:0 lds
v_mfma_f32_16x16x32_bf16 v[228:231], a[136:139], a[8:11], v[228:231]
ds_read_b64_tr_b16 a[130:131], v22 offset:2048
v_mfma_f32_16x16x32_bf16 v[228:231], a[140:143], a[12:15], v[228:231]
buffer_store_dwordx4 v[192:195], v1, s[4:7], s31 offen sc1
v_mfma_f32_16x16x32_bf16 v[232:235], a[136:139], a[16:19], v[232:235]
s_add_u32 s31, s31, s32
ds_read_b64_tr_b16 a[132:133], v22 offset:16384
v_mfma_f32_16x16x32_bf16 v[232:235], a[140:143], a[20:23], v[232:235]
buffer_load_dwordx4 v17, s[12:15], s26 offen offset:1024 lds
v_mfma_f32_16x16x32_bf16 v[236:239], a[136:139], a[24:27], v[236:239]
ds_read_b64_tr_b16 a[134:135], v22 offset:18432
v_add_u32 v22, 4294901760, v22
v_mfma_f32_16x16x32_bf16 v[236:239], a[140:143], a[28:31], v[236:239]
v_mfma_f32_16x16x32_bf16 v[240:243], a[136:139], a[32:35], v[240:243]
v_mfma_f32_16x16x32_bf16 v[240:243], a[140:143], a[36:39], v[240:243]
buffer_load_dwordx4 v18, s[12:15], s26 offen offset:2048 lds
v_mfma_f32_16x16x32_bf16 v[244:247], a[136:139], a[40:43], v[244:247]
v_mfma_f32_16x16x32_bf16 v[244:247], a[140:143], a[44:47], v[244:247]
v_mfma_f32_16x16x32_bf16 v[248:251], a[136:139], a[48:51], v[248:251]
v_mfma_f32_16x16x32_bf16 v[248:251], a[140:143], a[52:55], v[248:251]
buffer_load_dwordx4 v19, s[12:15], s26 offen offset:3072 lds
v_mfma_f32_16x16x32_bf16 v[252:255], a[136:139], a[56:59], v[252:255]
s_add_u32 s26, s26, 524288
v_mfma_f32_16x16x32_bf16 v[252:255], a[140:143], a[60:63], v[252:255]
s_waitcnt lgkmcnt(0)
v_mfma_f32_16x16x32_bf16 v[36:39], a[128:131], a[64:67], v[36:39]
s_add_u32 m0, s29, 114688
ds_read_b64_tr_b16 a[136:137], v23 offset:0
v_mfma_f32_16x16x32_bf16 v[36:39], a[132:135], a[68:71], v[36:39]
buffer_load_dwordx4 v16, s[12:15], s27 offen offset:0 lds
v_mfma_f32_16x16x32_bf16 v[44:47], a[128:131], a[72:75], v[44:47]
ds_read_b64_tr_b16 a[138:139], v23 offset:2048
v_mfma_f32_16x16x32_bf16 v[44:47], a[132:135], a[76:79], v[44:47]
ds_read_b128 a[0:3], v2 offset:0
ds_read_b128 a[4:7], v3 offset:0
v_mfma_f32_16x16x32_bf16 v[52:55], a[128:131], a[80:83], v[52:55]
ds_read_b64_tr_b16 a[140:141], v23 offset:16384
v_mfma_f32_16x16x32_bf16 v[52:55], a[132:135], a[84:87], v[52:55]
buffer_load_dwordx4 v17, s[12:15], s27 offen offset:1024 lds
v_mfma_f32_16x16x32_bf16 v[60:63], a[128:131], a[88:91], v[60:63]
ds_read_b64_tr_b16 a[142:143], v23 offset:18432
v_add_u32 v23, 4294901760, v23
v_mfma_f32_16x16x32_bf16 v[60:63], a[132:135], a[92:95], v[60:63]
buffer_store_dwordx4 v[200:203], v1, s[4:7], s31 offen sc1
v_mfma_f32_16x16x32_bf16 v[68:71], a[128:131], a[96:99], v[68:71]
s_add_u32 s31, s31, s33
ds_read_b128 a[8:11], v2 offset:2048
v_mfma_f32_16x16x32_bf16 v[68:71], a[132:135], a[100:103], v[68:71]
buffer_load_dwordx4 v18, s[12:15], s27 offen offset:2048 lds
v_mfma_f32_16x16x32_bf16 v[76:79], a[128:131], a[104:107], v[76:79]
ds_read_b128 a[12:15], v3 offset:2048
v_mfma_f32_16x16x32_bf16 v[76:79], a[132:135], a[108:111], v[76:79]
ds_read_b128 a[16:19], v2 offset:4096
v_mfma_f32_16x16x32_bf16 v[84:87], a[128:131], a[112:115], v[84:87]
ds_read_b128 a[20:23], v3 offset:4096
v_mfma_f32_16x16x32_bf16 v[84:87], a[132:135], a[116:119], v[84:87]
buffer_load_dwordx4 v19, s[12:15], s27 offen offset:3072 lds
v_mfma_f32_16x16x32_bf16 v[92:95], a[128:131], a[120:123], v[92:95]
s_add_u32 s27, s27, 524288
ds_read_b128 a[24:27], v2 offset:6144
v_mfma_f32_16x16x32_bf16 v[92:95], a[132:135], a[124:127], v[92:95]
s_waitcnt lgkmcnt(5)
buffer_store_dwordx4 v[208:211], v1, s[4:7], s31 offen sc1
v_mfma_f32_16x16x32_bf16 v[100:103], a[136:139], a[64:67], v[100:103]
s_add_u32 s31, s31, s32
ds_read_b64_tr_b16 a[128:129], v24 offset:0
v_mfma_f32_16x16x32_bf16 v[100:103], a[140:143], a[68:71], v[100:103]
v_mfma_f32_16x16x32_bf16 v[108:111], a[136:139], a[72:75], v[108:111]
ds_read_b64_tr_b16 a[130:131], v24 offset:2048
v_mfma_f32_16x16x32_bf16 v[108:111], a[140:143], a[76:79], v[108:111]
ds_read_b128 a[28:31], v3 offset:6144
v_mfma_f32_16x16x32_bf16 v[116:119], a[136:139], a[80:83], v[116:119]
ds_read_b64_tr_b16 a[132:133], v24 offset:16384
v_mfma_f32_16x16x32_bf16 v[116:119], a[140:143], a[84:87], v[116:119]
v_mfma_f32_16x16x32_bf16 v[124:127], a[136:139], a[88:91], v[124:127]
ds_read_b64_tr_b16 a[134:135], v24 offset:18432
v_add_u32 v24, 4294901760, v24
v_mfma_f32_16x16x32_bf16 v[124:127], a[140:143], a[92:95], v[124:127]
v_mfma_f32_16x16x32_bf16 v[132:135], a[136:139], a[96:99], v[132:135]
ds_read_b128 a[32:35], v2 offset:8192
v_mfma_f32_16x16x32_bf16 v[132:135], a[140:143], a[100:103], v[132:135]
buffer_store_dwordx4 v[216:219], v1, s[4:7], s31 offen sc1
v_mfma_f32_16x16x32_bf16 v[140:143], a[136:139], a[104:107], v[140:143]
s_add_u32 s31, s31, s35
ds_read_b128 a[36:39], v3 offset:8192
v_mfma_f32_16x16x32_bf16 v[140:143], a[140:143], a[108:111], v[140:143]
ds_read_b128 a[40:43], v2 offset:10240
v_mfma_f32_16x16x32_bf16 v[148:151], a[136:139], a[112:115], v[148:151]
ds_read_b128 a[44:47], v3 offset:10240
v_mfma_f32_16x16x32_bf16 v[148:151], a[140:143], a[116:119], v[148:151]
v_mfma_f32_16x16x32_bf16 v[156:159], a[136:139], a[120:123], v[156:159]
ds_read_b128 a[48:51], v2 offset:12288
v_mfma_f32_16x16x32_bf16 v[156:159], a[140:143], a[124:127], v[156:159]
s_waitcnt lgkmcnt(5)
v_mfma_f32_16x16x32_bf16 v[164:167], a[128:131], a[64:67], v[164:167]
ds_read_b64_tr_b16 a[136:137], v25 offset:0
v_mfma_f32_16x16x32_bf16 v[164:167], a[132:135], a[68:71], v[164:167]
v_mfma_f32_16x16x32_bf16 v[172:175], a[128:131], a[72:75], v[172:175]
ds_read_b64_tr_b16 a[138:139], v25 offset:2048
v_mfma_f32_16x16x32_bf16 v[172:175], a[132:135], a[76:79], v[172:175]
ds_read_b128 a[52:55], v3 offset:12288
v_mfma_f32_16x16x32_bf16 v[180:183], a[128:131], a[80:83], v[180:183]
ds_read_b64_tr_b16 a[140:141], v25 offset:16384
v_mfma_f32_16x16x32_bf16 v[180:183], a[132:135], a[84:87], v[180:183]
buffer_store_dwordx4 v[32:35], v1, s[4:7], s31 offen sc1
v_mfma_f32_16x16x32_bf16 v[188:191], a[128:131], a[88:91], v[188:191]
s_add_u32 s31, s31, s32
ds_read_b64_tr_b16 a[142:143], v25 offset:18432
v_add_u32 v25, 4294901760, v25
v_mfma_f32_16x16x32_bf16 v[188:191], a[132:135], a[92:95], v[188:191]
v_mfma_f32_16x16x32_bf16 v[196:199], a[128:131], a[96:99], v[196:199]
ds_read_b128 a[56:59], v2 offset:14336
v_mfma_f32_16x16x32_bf16 v[196:199], a[132:135], a[100:103], v[196:199]
v_mfma_f32_16x16x32_bf16 v[204:207], a[128:131], a[104:107], v[204:207]
ds_read_b128 a[60:63], v3 offset:14336
v_mfma_f32_16x16x32_bf16 v[204:207], a[132:135], a[108:111], v[204:207]
v_mfma_f32_16x16x32_bf16 v[212:215], a[128:131], a[112:115], v[212:215]
v_mfma_f32_16x16x32_bf16 v[212:215], a[132:135], a[116:119], v[212:215]
v_mfma_f32_16x16x32_bf16 v[220:223], a[128:131], a[120:123], v[220:223]
v_mfma_f32_16x16x32_bf16 v[220:223], a[132:135], a[124:127], v[220:223]
s_waitcnt vmcnt(20) lgkmcnt(0)
s_barrier
v_mfma_f32_16x16x32_bf16 v[224:227], a[136:139], a[64:67], v[224:227]
s_add_u32 m0, s29, 131072
ds_read_b64_tr_b16 a[128:129], v22 offset:0
v_mfma_f32_16x16x32_bf16 v[224:227], a[140:143], a[68:71], v[224:227]
buffer_load_dwordx4 v16, s[12:15], s26 offen offset:0 lds
v_mfma_f32_16x16x32_bf16 v[228:231], a[136:139], a[72:75], v[228:231]
ds_read_b64_tr_b16 a[130:131], v22 offset:2048
v_mfma_f32_16x16x32_bf16 v[228:231], a[140:143], a[76:79], v[228:231]
PAD_7:
s_cbranch_execz M_tret
buffer_store_dwordx4 v[40:43], v1, s[4:7], s31 offen sc1
v_mfma_f32_16x16x32_bf16 v[232:235], a[136:139], a[80:83], v[232:235]
s_add_u32 s31, s31, s33
ds_read_b64_tr_b16 a[132:133], v22 offset:16384
v_mfma_f32_16x16x32_bf16 v[232:235], a[140:143], a[84:87], v[232:235]
buffer_load_dwordx4 v17, s[12:15], s26 offen offset:1024 lds
v_mfma_f32_16x16x32_bf16 v[236:239], a[136:139], a[88:91], v[236:239]
ds_read_b64_tr_b16 a[134:135], v22 offset:18432
v_add_u32 v22, 32768, v22
v_mfma_f32_16x16x32_bf16 v[236:239], a[140:143], a[92:95], v[236:239]
v_mfma_f32_16x16x32_bf16 v[240:243], a[136:139], a[96:99], v[240:243]
v_mfma_f32_16x16x32_bf16 v[240:243], a[140:143], a[100:103], v[240:243]
buffer_load_dwordx4 v18, s[12:15], s26 offen offset:2048 lds
v_mfma_f32_16x16x32_bf16 v[244:247], a[136:139], a[104:107], v[244:247]
v_mfma_f32_16x16x32_bf16 v[244:247], a[140:143], a[108:111], v[244:247]
v_mfma_f32_16x16x32_bf16 v[248:251], a[136:139], a[112:115], v[248:251]
v_mfma_f32_16x16x32_bf16 v[248:251], a[140:143], a[116:119], v[248:251]
buffer_load_dwordx4 v19, s[12:15], s26 offen offset:3072 lds
v_mfma_f32_16x16x32_bf16 v[252:255], a[136:139], a[120:123], v[252:255]
s_add_u32 s26, s26, 524288
v_mfma_f32_16x16x32_bf16 v[252:255], a[140:143], a[124:127], v[252:255]
s_waitcnt lgkmcnt(0)
v_mfma_f32_16x16x32_bf16 v[36:39], a[128:131], a[0:3], v[36:39]
s_add_u32 m0, s29, 147456
ds_read_b64_tr_b16 a[136:137], v23 offset:0
v_mfma_f32_16x16x32_bf16 v[36:39], a[132:135], a[4:7], v[36:39]
buffer_load_dwordx4 v16, s[12:15], s27 offen offset:0 lds
v_mfma_f32_16x16x32_bf16 v[44:47], a[128:131], a[8:11], v[44:47]
s_lshl_b32 s22, s20, 7
ds_read_b64_tr_b16 a[138:139], v23 offset:2048
v_bfe_u32 v20, v1, 4, 3
v_mfma_f32_16x16x32_bf16 v[44:47], a[132:135], a[12:15], v[44:47]
s_add_u32 s70, s22, 94371840
ds_read_b128 a[64:67], v2 offset:16384
ds_read_b128 a[68:71], v3 offset:16384
v_mfma_f32_16x16x32_bf16 v[52:55], a[128:131], a[16:19], v[52:55]
s_lshr_b32 s22, s2, 4
ds_read_b64_tr_b16 a[140:141], v23 offset:16384
v_lshlrev_b32 v20, 3, v20
v_mfma_f32_16x16x32_bf16 v[52:55], a[132:135], a[20:23], v[52:55]
s_lshl_b32 s22, s22, 2
buffer_load_dwordx4 v17, s[12:15], s27 offen offset:1024 lds
v_mfma_f32_16x16x32_bf16 v[60:63], a[128:131], a[24:27], v[60:63]
s_add_u32 s66, s70, s22
ds_read_b64_tr_b16 a[142:143], v23 offset:18432
v_add_u32 v23, 32768, v23
v_mfma_f32_16x16x32_bf16 v[60:63], a[132:135], a[28:31], v[60:63]
s_and_b32 s22, s2, 16
buffer_store_dwordx4 v[48:51], v1, s[4:7], s31 offen sc1
v_mfma_f32_16x16x32_bf16 v[68:71], a[128:131], a[32:35], v[68:71]
s_add_u32 s31, s31, s32
ds_read_b128 a[72:75], v2 offset:18432
v_add_u32 v15, 2052, v20
v_mfma_f32_16x16x32_bf16 v[68:71], a[132:135], a[36:39], v[68:71]
s_lshl_b32 s22, s22, 7
buffer_load_dwordx4 v18, s[12:15], s27 offen offset:2048 lds
v_mfma_f32_16x16x32_bf16 v[76:79], a[128:131], a[40:43], v[76:79]
s_add_u32 s66, s66, s22
ds_read_b128 a[76:79], v3 offset:18432
v_mfma_f32_16x16x32_bf16 v[76:79], a[132:135], a[44:47], v[76:79]
s_lshl_b32 s67, s20, 20
ds_read_b128 a[80:83], v2 offset:20480
v_mfma_f32_16x16x32_bf16 v[84:87], a[128:131], a[48:51], v[84:87]
s_lshl_b32 s22, s37, 16
ds_read_b128 a[84:87], v3 offset:20480
v_mfma_f32_16x16x32_bf16 v[84:87], a[132:135], a[52:55], v[84:87]
s_add_u32 s67, s67, s22
buffer_load_dwordx4 v19, s[12:15], s27 offen offset:3072 lds
v_mfma_f32_16x16x32_bf16 v[92:95], a[128:131], a[56:59], v[92:95]
s_waitcnt lgkmcnt(5)
s_add_u32 s27, s27, 524288
ds_read_b128 a[88:91], v2 offset:22528
v_mfma_f32_16x16x32_bf16 v[92:95], a[132:135], a[60:63], v[92:95]
s_lshl_b32 s22, s3, 11
buffer_store_dwordx4 v[56:59], v1, s[4:7], s31 offen sc1
v_mfma_f32_16x16x32_bf16 v[100:103], a[136:139], a[0:3], v[100:103]
s_waitcnt lgkmcnt(5)
s_add_u32 s31, s31, s34
ds_read_b64_tr_b16 a[128:129], v24 offset:0
v_mfma_f32_16x16x32_bf16 v[100:103], a[140:143], a[4:7], v[100:103]
s_add_u32 s67, s67, s22
v_mfma_f32_16x16x32_bf16 v[108:111], a[136:139], a[8:11], v[108:111]
s_add_u32 s67, s67, 33554432
ds_read_b64_tr_b16 a[130:131], v24 offset:2048
v_mfma_f32_16x16x32_bf16 v[108:111], a[140:143], a[12:15], v[108:111]
s_mov_b32 s68, 1035512379
ds_read_b128 a[92:95], v3 offset:22528
v_mfma_f32_16x16x32_bf16 v[116:119], a[136:139], a[16:19], v[116:119]
s_mov_b32 s69, 1035512379
ds_read_b64_tr_b16 a[132:133], v24 offset:16384
v_mfma_f32_16x16x32_bf16 v[116:119], a[140:143], a[20:23], v[116:119]
buffer_store_dwordx4 v[64:67], v1, s[4:7], s31 offen sc1
v_mfma_f32_16x16x32_bf16 v[124:127], a[136:139], a[24:27], v[124:127]
s_add_u32 s31, s31, s32
ds_read_b64_tr_b16 a[134:135], v24 offset:18432
v_add_u32 v24, 32768, v24
v_mfma_f32_16x16x32_bf16 v[124:127], a[140:143], a[28:31], v[124:127]
v_mfma_f32_16x16x32_bf16 v[132:135], a[136:139], a[32:35], v[132:135]
ds_read_b128 a[96:99], v2 offset:24576
v_mfma_f32_16x16x32_bf16 v[132:135], a[140:143], a[36:39], v[132:135]
v_mfma_f32_16x16x32_bf16 v[140:143], a[136:139], a[40:43], v[140:143]
ds_read_b128 a[100:103], v3 offset:24576
v_mfma_f32_16x16x32_bf16 v[140:143], a[140:143], a[44:47], v[140:143]
ds_read_b128 a[104:107], v2 offset:26624
v_mfma_f32_16x16x32_bf16 v[148:151], a[136:139], a[48:51], v[148:151]
ds_read_b128 a[108:111], v3 offset:26624
v_mfma_f32_16x16x32_bf16 v[148:151], a[140:143], a[52:55], v[148:151]
v_mfma_f32_16x16x32_bf16 v[156:159], a[136:139], a[56:59], v[156:159]
ds_read_b128 a[112:115], v2 offset:28672
v_mfma_f32_16x16x32_bf16 v[156:159], a[140:143], a[60:63], v[156:159]
s_waitcnt lgkmcnt(5)
buffer_store_dwordx4 v[72:75], v1, s[4:7], s31 offen sc1
v_mfma_f32_16x16x32_bf16 v[164:167], a[128:131], a[0:3], v[164:167]
s_add_u32 s31, s31, s33
ds_read_b64_tr_b16 a[136:137], v25 offset:0
v_mfma_f32_16x16x32_bf16 v[164:167], a[132:135], a[4:7], v[164:167]
v_mfma_f32_16x16x32_bf16 v[172:175], a[128:131], a[8:11], v[172:175]
ds_read_b64_tr_b16 a[138:139], v25 offset:2048
v_mfma_f32_16x16x32_bf16 v[172:175], a[132:135], a[12:15], v[172:175]
ds_read_b128 a[116:119], v3 offset:28672
v_mfma_f32_16x16x32_bf16 v[180:183], a[128:131], a[16:19], v[180:183]
ds_read_b64_tr_b16 a[140:141], v25 offset:16384
v_mfma_f32_16x16x32_bf16 v[180:183], a[132:135], a[20:23], v[180:183]
v_mfma_f32_16x16x32_bf16 v[188:191], a[128:131], a[24:27], v[188:191]
ds_read_b64_tr_b16 a[142:143], v25 offset:18432
v_add_u32 v25, 32768, v25
v_mfma_f32_16x16x32_bf16 v[188:191], a[132:135], a[28:31], v[188:191]
v_mfma_f32_16x16x32_bf16 v[196:199], a[128:131], a[32:35], v[196:199]
ds_read_b128 a[120:123], v2 offset:30720
v_mfma_f32_16x16x32_bf16 v[196:199], a[132:135], a[36:39], v[196:199]
buffer_store_dwordx4 v[80:83], v1, s[4:7], s31 offen sc1
v_mfma_f32_16x16x32_bf16 v[204:207], a[128:131], a[40:43], v[204:207]
s_add_u32 s31, s31, s32
ds_read_b128 a[124:127], v3 offset:30720
v_mfma_f32_16x16x32_bf16 v[204:207], a[132:135], a[44:47], v[204:207]
v_mfma_f32_16x16x32_bf16 v[212:215], a[128:131], a[48:51], v[212:215]
v_mfma_f32_16x16x32_bf16 v[212:215], a[132:135], a[52:55], v[212:215]
v_mfma_f32_16x16x32_bf16 v[220:223], a[128:131], a[56:59], v[220:223]
v_mfma_f32_16x16x32_bf16 v[220:223], a[132:135], a[60:63], v[220:223]
s_waitcnt vmcnt(17) lgkmcnt(0)
s_barrier
v_mfma_f32_16x16x32_bf16 v[224:227], a[136:139], a[0:3], v[224:227]
ds_read_b64_tr_b16 a[128:129], v22 offset:0
v_mfma_f32_16x16x32_bf16 v[224:227], a[140:143], a[4:7], v[224:227]
v_mfma_f32_16x16x32_bf16 v[228:231], a[136:139], a[8:11], v[228:231]
ds_read_b64_tr_b16 a[130:131], v22 offset:2048
v_mfma_f32_16x16x32_bf16 v[228:231], a[140:143], a[12:15], v[228:231]
buffer_store_dwordx4 v[88:91], v1, s[4:7], s31 offen sc1
v_mfma_f32_16x16x32_bf16 v[232:235], a[136:139], a[16:19], v[232:235]
ds_read_b64_tr_b16 a[132:133], v22 offset:16384
v_mfma_f32_16x16x32_bf16 v[232:235], a[140:143], a[20:23], v[232:235]
v_mfma_f32_16x16x32_bf16 v[236:239], a[136:139], a[24:27], v[236:239]
ds_read_b64_tr_b16 a[134:135], v22 offset:18432
v_add_u32 v22, 32768, v22
v_mfma_f32_16x16x32_bf16 v[236:239], a[140:143], a[28:31], v[236:239]
v_mfma_f32_16x16x32_bf16 v[240:243], a[136:139], a[32:35], v[240:243]
v_mfma_f32_16x16x32_bf16 v[240:243], a[140:143], a[36:39], v[240:243]
v_mfma_f32_16x16x32_bf16 v[244:247], a[136:139], a[40:43], v[244:247]
v_mfma_f32_16x16x32_bf16 v[244:247], a[140:143], a[44:47], v[244:247]
v_mfma_f32_16x16x32_bf16 v[248:251], a[136:139], a[48:51], v[248:251]
v_mfma_f32_16x16x32_bf16 v[248:251], a[140:143], a[52:55], v[248:251]
v_mfma_f32_16x16x32_bf16 v[252:255], a[136:139], a[56:59], v[252:255]
v_mfma_f32_16x16x32_bf16 v[252:255], a[140:143], a[60:63], v[252:255]
s_waitcnt lgkmcnt(0)
v_mfma_f32_16x16x32_bf16 v[36:39], a[128:131], a[64:67], v[36:39]
ds_read_b64_tr_b16 a[136:137], v23 offset:0
v_mfma_f32_16x16x32_bf16 v[36:39], a[132:135], a[68:71], v[36:39]
v_mfma_f32_16x16x32_bf16 v[44:47], a[128:131], a[72:75], v[44:47]
ds_read_b64_tr_b16 a[138:139], v23 offset:2048
v_mfma_f32_16x16x32_bf16 v[44:47], a[132:135], a[76:79], v[44:47]
ds_read_b128 a[0:3], v2 offset:32768
ds_read_b128 a[4:7], v3 offset:32768
v_mfma_f32_16x16x32_bf16 v[52:55], a[128:131], a[80:83], v[52:55]
ds_read_b64_tr_b16 a[140:141], v23 offset:16384
v_mfma_f32_16x16x32_bf16 v[52:55], a[132:135], a[84:87], v[52:55]
v_mfma_f32_16x16x32_bf16 v[60:63], a[128:131], a[88:91], v[60:63]
ds_read_b64_tr_b16 a[142:143], v23 offset:18432
v_add_u32 v23, 32768, v23
v_mfma_f32_16x16x32_bf16 v[60:63], a[132:135], a[92:95], v[60:63]
v_mfma_f32_16x16x32_bf16 v[68:71], a[128:131], a[96:99], v[68:71]
ds_read_b128 a[8:11], v2 offset:34816
v_mfma_f32_16x16x32_bf16 v[68:71], a[132:135], a[100:103], v[68:71]
v_mfma_f32_16x16x32_bf16 v[76:79], a[128:131], a[104:107], v[76:79]
ds_read_b128 a[12:15], v3 offset:34816
v_mfma_f32_16x16x32_bf16 v[76:79], a[132:135], a[108:111], v[76:79]
ds_read_b128 a[16:19], v2 offset:36864
v_mfma_f32_16x16x32_bf16 v[84:87], a[128:131], a[112:115], v[84:87]
ds_read_b128 a[20:23], v3 offset:36864
v_mfma_f32_16x16x32_bf16 v[84:87], a[132:135], a[116:119], v[84:87]
v_mfma_f32_16x16x32_bf16 v[92:95], a[128:131], a[120:123], v[92:95]
ds_read_b128 a[24:27], v2 offset:38912
v_mfma_f32_16x16x32_bf16 v[92:95], a[132:135], a[124:127], v[92:95]
s_waitcnt lgkmcnt(5)
v_mfma_f32_16x16x32_bf16 v[100:103], a[136:139], a[64:67], v[100:103]
ds_read_b64_tr_b16 a[128:129], v24 offset:0
v_mfma_f32_16x16x32_bf16 v[100:103], a[140:143], a[68:71], v[100:103]
v_mfma_f32_16x16x32_bf16 v[108:111], a[136:139], a[72:75], v[108:111]
ds_read_b64_tr_b16 a[130:131], v24 offset:2048
v_mfma_f32_16x16x32_bf16 v[108:111], a[140:143], a[76:79], v[108:111]
ds_read_b128 a[28:31], v3 offset:38912
v_mfma_f32_16x16x32_bf16 v[116:119], a[136:139], a[80:83], v[116:119]
ds_read_b64_tr_b16 a[132:133], v24 offset:16384
v_mfma_f32_16x16x32_bf16 v[116:119], a[140:143], a[84:87], v[116:119]
v_mfma_f32_16x16x32_bf16 v[124:127], a[136:139], a[88:91], v[124:127]
ds_read_b64_tr_b16 a[134:135], v24 offset:18432
v_add_u32 v24, 32768, v24
v_mfma_f32_16x16x32_bf16 v[124:127], a[140:143], a[92:95], v[124:127]
v_mfma_f32_16x16x32_bf16 v[132:135], a[136:139], a[96:99], v[132:135]
ds_read_b128 a[32:35], v2 offset:40960
v_mfma_f32_16x16x32_bf16 v[132:135], a[140:143], a[100:103], v[132:135]
v_mfma_f32_16x16x32_bf16 v[140:143], a[136:139], a[104:107], v[140:143]
ds_read_b128 a[36:39], v3 offset:40960
v_mfma_f32_16x16x32_bf16 v[140:143], a[140:143], a[108:111], v[140:143]
ds_read_b128 a[40:43], v2 offset:43008
v_mfma_f32_16x16x32_bf16 v[148:151], a[136:139], a[112:115], v[148:151]
ds_read_b128 a[44:47], v3 offset:43008
v_mfma_f32_16x16x32_bf16 v[148:151], a[140:143], a[116:119], v[148:151]
v_mfma_f32_16x16x32_bf16 v[156:159], a[136:139], a[120:123], v[156:159]
ds_read_b128 a[48:51], v2 offset:45056
v_mfma_f32_16x16x32_bf16 v[156:159], a[140:143], a[124:127], v[156:159]
s_waitcnt lgkmcnt(5)
v_mfma_f32_16x16x32_bf16 v[164:167], a[128:131], a[64:67], v[164:167]
ds_read_b64_tr_b16 a[136:137], v25 offset:0
v_mfma_f32_16x16x32_bf16 v[164:167], a[132:135], a[68:71], v[164:167]
v_mfma_f32_16x16x32_bf16 v[172:175], a[128:131], a[72:75], v[172:175]
ds_read_b64_tr_b16 a[138:139], v25 offset:2048
v_mfma_f32_16x16x32_bf16 v[172:175], a[132:135], a[76:79], v[172:175]
ds_read_b128 a[52:55], v3 offset:45056
v_mfma_f32_16x16x32_bf16 v[180:183], a[128:131], a[80:83], v[180:183]
ds_read_b64_tr_b16 a[140:141], v25 offset:16384
v_mfma_f32_16x16x32_bf16 v[180:183], a[132:135], a[84:87], v[180:183]
v_mfma_f32_16x16x32_bf16 v[188:191], a[128:131], a[88:91], v[188:191]
ds_read_b64_tr_b16 a[142:143], v25 offset:18432
v_add_u32 v25, 32768, v25
v_mfma_f32_16x16x32_bf16 v[188:191], a[132:135], a[92:95], v[188:191]
v_mfma_f32_16x16x32_bf16 v[196:199], a[128:131], a[96:99], v[196:199]
ds_read_b128 a[56:59], v2 offset:47104
v_mfma_f32_16x16x32_bf16 v[196:199], a[132:135], a[100:103], v[196:199]
v_mfma_f32_16x16x32_bf16 v[204:207], a[128:131], a[104:107], v[204:207]
ds_read_b128 a[60:63], v3 offset:47104
v_mfma_f32_16x16x32_bf16 v[204:207], a[132:135], a[108:111], v[204:207]
v_mfma_f32_16x16x32_bf16 v[212:215], a[128:131], a[112:115], v[212:215]
v_mfma_f32_16x16x32_bf16 v[212:215], a[132:135], a[116:119], v[212:215]
v_mfma_f32_16x16x32_bf16 v[220:223], a[128:131], a[120:123], v[220:223]
v_mfma_f32_16x16x32_bf16 v[220:223], a[132:135], a[124:127], v[220:223]
s_waitcnt vmcnt(0) lgkmcnt(0)
s_barrier
v_mfma_f32_16x16x32_bf16 v[224:227], a[136:139], a[64:67], v[224:227]
ds_read_b64_tr_b16 a[128:129], v22 offset:0
v_mfma_f32_16x16x32_bf16 v[224:227], a[140:143], a[68:71], v[224:227]
buffer_store_dword v27, v26, s[4:7], s66 offen sc1
v_mfma_f32_16x16x32_bf16 v[228:231], a[136:139], a[72:75], v[228:231]
ds_read_b64_tr_b16 a[130:131], v22 offset:2048
v_mfma_f32_16x16x32_bf16 v[228:231], a[140:143], a[76:79], v[228:231]
v_mfma_f32_16x16x32_bf16 v[232:235], a[136:139], a[80:83], v[232:235]
ds_read_b64_tr_b16 a[132:133], v22 offset:16384
v_mfma_f32_16x16x32_bf16 v[232:235], a[140:143], a[84:87], v[232:235]
v_mfma_f32_16x16x32_bf16 v[236:239], a[136:139], a[88:91], v[236:239]
ds_read_b64_tr_b16 a[134:135], v22 offset:18432
v_mfma_f32_16x16x32_bf16 v[236:239], a[140:143], a[92:95], v[236:239]
v_mfma_f32_16x16x32_bf16 v[240:243], a[136:139], a[96:99], v[240:243]
v_mfma_f32_16x16x32_bf16 v[240:243], a[140:143], a[100:103], v[240:243]
v_mfma_f32_16x16x32_bf16 v[244:247], a[136:139], a[104:107], v[244:247]
v_mfma_f32_16x16x32_bf16 v[244:247], a[140:143], a[108:111], v[244:247]
v_mfma_f32_16x16x32_bf16 v[248:251], a[136:139], a[112:115], v[248:251]
v_mfma_f32_16x16x32_bf16 v[248:251], a[140:143], a[116:119], v[248:251]
v_mfma_f32_16x16x32_bf16 v[252:255], a[136:139], a[120:123], v[252:255]
v_mfma_f32_16x16x32_bf16 v[252:255], a[140:143], a[124:127], v[252:255]
s_waitcnt lgkmcnt(0)
v_mfma_f32_16x16x32_bf16 v[36:39], a[128:131], a[0:3], v[36:39]
s_lshl_b32 s18, s3, 13
ds_read_b64_tr_b16 a[136:137], v23 offset:0
v_lshrrev_b32 v28, 6, v0
v_mfma_f32_16x16x32_bf16 v[36:39], a[132:135], a[4:7], v[36:39]
s_lshl_b32 s30, s20, 20
v_lshl_add_u32 v28, v28, 11, v1
v_add_u32 v28, 65536, v28
v_mfma_f32_16x16x32_bf16 v[44:47], a[128:131], a[8:11], v[44:47]
s_add_u32 s30, s30, s18
ds_read_b64_tr_b16 a[138:139], v23 offset:2048
v_lshrrev_b32 v3, 6, v0
v_mfma_f32_16x16x32_bf16 v[44:47], a[132:135], a[12:15], v[44:47]
s_lshl_b32 s22, s21, 1
v_and_b32 v4, 63, v0
v_add_u32 v2, 0x10000, v1
v_mfma_f32_16x16x32_bf16 v[52:55], a[128:131], a[16:19], v[52:55]
s_and_b32 s84, s2, 1
ds_read_b64_tr_b16 a[140:141], v23 offset:16384
v_and_b32 v5, 15, v4
v_mfma_f32_16x16x32_bf16 v[52:55], a[132:135], a[20:23], v[52:55]
s_mul_i32 s84, s84, 0
v_lshrrev_b32 v6, 4, v4
v_lshlrev_b32 v6, 2, v6
v_mfma_f32_16x16x32_bf16 v[60:63], a[128:131], a[24:27], v[60:63]
s_add_u32 s84, s84, 2386092
ds_read_b64_tr_b16 a[142:143], v23 offset:18432
v_sub_u32 v5, v5, v6
v_mfma_f32_16x16x32_bf16 v[60:63], a[132:135], a[28:31], v[60:63]
s_lshl_b32 s85, s21, 2
v_lshl_add_u32 v5, v3, 4, v5
v_cmp_gt_i32 s[32:33], 0, v5
v_mfma_f32_16x16x32_bf16 v[68:71], a[128:131], a[32:35], v[68:71]
s_lshr_b32 s85, s84, s85
v_cmp_gt_i32 s[34:35], 1, v5
v_cmp_gt_i32 s[36:37], 2, v5
v_mfma_f32_16x16x32_bf16 v[68:71], a[132:135], a[36:39], v[68:71]
s_and_b32 s9, s85, 15
v_cmp_gt_i32 s[38:39], 3, v5
v_cmp_gt_i32 s[40:41], 16, v5
v_mfma_f32_16x16x32_bf16 v[76:79], a[128:131], a[40:43], v[76:79]
s_and_b32 s84, s85, 1
v_cmp_gt_i32 s[42:43], 17, v5
v_cmp_gt_i32 s[44:45], 18, v5
v_mfma_f32_16x16x32_bf16 v[76:79], a[132:135], a[44:47], v[76:79]
s_lshl_b32 s84, s84, 17
v_cmp_gt_i32 s[46:47], 19, v5
v_cmp_gt_i32 s[48:49], 32, v5
v_mfma_f32_16x16x32_bf16 v[84:87], a[128:131], a[48:51], v[84:87]
s_add_u32 s84, s84, s18
v_cmp_gt_i32 s[50:51], 33, v5
v_cmp_gt_i32 s[52:53], 34, v5
v_mfma_f32_16x16x32_bf16 v[84:87], a[132:135], a[52:55], v[84:87]
s_xor_b32 s85, s84, 0x20000
v_cmp_gt_i32 s[54:55], 35, v5
v_cmp_gt_i32 s[56:57], 48, v5
v_mfma_f32_16x16x32_bf16 v[92:95], a[128:131], a[56:59], v[92:95]
s_sub_u32 s29, 15, s21
v_cmp_gt_i32 s[58:59], 49, v5
v_cmp_gt_i32 s[60:61], 50, v5
v_mfma_f32_16x16x32_bf16 v[92:95], a[132:135], a[60:63], v[92:95]
s_waitcnt lgkmcnt(0)
v_cmp_gt_i32 s[62:63], 51, v5
v_mov_b32 v7, 0xff800000
v_mfma_f32_16x16x32_bf16 v[100:103], a[136:139], a[0:3], v[100:103]
s_cmp_lg_u32 s9, 0
ds_read_b64_tr_b16 a[128:129], v24 offset:0
v_mov_b32 v6, 1
v_mfma_f32_16x16x32_bf16 v[100:103], a[140:143], a[4:7], v[100:103]
s_cselect_b32 s24, 1, 0
v_mov_b32 v5, v26
v_add_u32 v4, 0x20000, v1
v_mfma_f32_16x16x32_bf16 v[108:111], a[136:139], a[8:11], v[108:111]
s_cselect_b32 s67, s67, 3221225472
ds_read_b64_tr_b16 a[130:131], v24 offset:2048
v_mfma_f32_16x16x32_bf16 v[108:111], a[140:143], a[12:15], v[108:111]
s_lshl_b32 s8, s9, 15
v_mfma_f32_16x16x32_bf16 v[116:119], a[136:139], a[16:19], v[116:119]
s_add_u32 s8, s8, s30
ds_read_b64_tr_b16 a[132:133], v24 offset:16384
v_mfma_f32_16x16x32_bf16 v[116:119], a[140:143], a[20:23], v[116:119]
s_add_u32 s9, s9, s22
v_mfma_f32_16x16x32_bf16 v[124:127], a[136:139], a[24:27], v[124:127]
s_sub_u32 s9, 32, s9
ds_read_b64_tr_b16 a[134:135], v24 offset:18432
v_mul_f32 v36, s68, v36
v_mfma_f32_16x16x32_bf16 v[124:127], a[140:143], a[28:31], v[124:127]
s_bitcmp1_b32 s2, 4
v_mul_f32 v37, s68, v37
v_mul_f32 v38, s68, v38
v_mfma_f32_16x16x32_bf16 v[132:135], a[136:139], a[32:35], v[132:135]
s_cselect_b32 s9, 16, s9
v_mul_f32 v39, s68, v39
v_mul_f32 v100, s68, v100
v_mfma_f32_16x16x32_bf16 v[132:135], a[140:143], a[36:39], v[132:135]
s_cselect_b32 s29, 7, s29
v_mul_f32 v101, s68, v101
v_mul_f32 v102, s68, v102
v_mfma_f32_16x16x32_bf16 v[140:143], a[136:139], a[40:43], v[140:143]
s_mov_b32 s10, 3221225472
v_mul_f32 v103, s68, v103
v_cvt_pk_bf16_f32 v36, v36, v37
v_mfma_f32_16x16x32_bf16 v[140:143], a[140:143], a[44:47], v[140:143]
s_mov_b32 s14, 3221225472
v_cvt_pk_bf16_f32 v37, v38, v39
v_cvt_pk_bf16_f32 v38, v100, v101
v_mfma_f32_16x16x32_bf16 v[148:151], a[136:139], a[48:51], v[148:151]
s_mov_b32 s11, 0
v_cvt_pk_bf16_f32 v39, v102, v103
v_mul_f32 v44, s68, v44
v_mfma_f32_16x16x32_bf16 v[148:151], a[140:143], a[52:55], v[148:151]
s_lshr_b32 s19, s9, 1
ds_write_b128 v28, v[36:39] offset:0
v_mul_f32 v45, s68, v45
v_mfma_f32_16x16x32_bf16 v[156:159], a[136:139], a[56:59], v[156:159]
s_sub_u32 s19, s19, 1
s_add_u32 s23, s67, 0
buffer_store_dwordx4 v[36:39], v1, s[4:7], s23 offen offset:0 sc1
v_mfma_f32_16x16x32_bf16 v[156:159], a[140:143], a[60:63], v[156:159]
s_waitcnt lgkmcnt(1)
v_mul_f32 v46, s68, v46
v_mul_f32 v47, s68, v47
v_mfma_f32_16x16x32_bf16 v[164:167], a[128:131], a[0:3], v[164:167]
s_add_u32 s12, s8, 16777216
ds_read_b64_tr_b16 a[136:137], v25 offset:0
v_mul_f32 v108, s68, v108
v_mfma_f32_16x16x32_bf16 v[164:167], a[132:135], a[4:7], v[164:167]
s_mov_b32 s13, s9
v_mul_f32 v109, s68, v109
v_mul_f32 v110, s68, v110
v_mfma_f32_16x16x32_bf16 v[172:175], a[128:131], a[8:11], v[172:175]
s_mov_b32 s15, s11
ds_read_b64_tr_b16 a[138:139], v25 offset:2048
v_mul_f32 v111, s68, v111
v_mfma_f32_16x16x32_bf16 v[172:175], a[132:135], a[12:15], v[172:175]
v_cvt_pk_bf16_f32 v44, v44, v45
v_cvt_pk_bf16_f32 v45, v46, v47
v_mfma_f32_16x16x32_bf16 v[180:183], a[128:131], a[16:19], v[180:183]
ds_read_b64_tr_b16 a[140:141], v25 offset:16384
v_cvt_pk_bf16_f32 v46, v108, v109
v_mfma_f32_16x16x32_bf16 v[180:183], a[132:135], a[20:23], v[180:183]
v_cvt_pk_bf16_f32 v47, v110, v111
v_mul_f32 v52, s68, v52
v_mfma_f32_16x16x32_bf16 v[188:191], a[128:131], a[24:27], v[188:191]
ds_read_b64_tr_b16 a[142:143], v25 offset:18432
v_mul_f32 v53, s68, v53
v_mfma_f32_16x16x32_bf16 v[188:191], a[132:135], a[28:31], v[188:191]
ds_write_b128 v28, v[44:47] offset:8192
v_mul_f32 v54, s68, v54
v_mfma_f32_16x16x32_bf16 v[196:199], a[128:131], a[32:35], v[196:199]
s_add_u32 s23, s67, 8192
buffer_store_dwordx4 v[44:47], v1, s[4:7], s23 offen offset:0 sc1
v_mfma_f32_16x16x32_bf16 v[196:199], a[132:135], a[36:39], v[196:199]
v_mul_f32 v55, s68, v55
v_mul_f32 v116, s68, v116
v_mfma_f32_16x16x32_bf16 v[204:207], a[128:131], a[40:43], v[204:207]
v_mul_f32 v117, s68, v117
v_mul_f32 v118, s68, v118
v_mfma_f32_16x16x32_bf16 v[204:207], a[132:135], a[44:47], v[204:207]
v_mul_f32 v119, s68, v119
v_cvt_pk_bf16_f32 v52, v52, v53
v_mfma_f32_16x16x32_bf16 v[212:215], a[128:131], a[48:51], v[212:215]
v_cvt_pk_bf16_f32 v53, v54, v55
v_cvt_pk_bf16_f32 v54, v116, v117
v_mfma_f32_16x16x32_bf16 v[212:215], a[132:135], a[52:55], v[212:215]
v_cvt_pk_bf16_f32 v55, v118, v119
v_mul_f32 v60, s68, v60
v_mfma_f32_16x16x32_bf16 v[220:223], a[128:131], a[56:59], v[220:223]
ds_write_b128 v28, v[52:55] offset:16384
v_mul_f32 v61, s68, v61
v_mfma_f32_16x16x32_bf16 v[220:223], a[132:135], a[60:63], v[220:223]
s_waitcnt lgkmcnt(0)
s_waitcnt lgkmcnt(0)
s_barrier
v_mfma_f32_16x16x32_bf16 v[224:227], a[136:139], a[0:3], v[224:227]
s_add_u32 s23, s67, 16384
buffer_store_dwordx4 v[52:55], v1, s[4:7], s23 offen offset:0 sc1
v_mfma_f32_16x16x32_bf16 v[224:227], a[140:143], a[4:7], v[224:227]
v_mul_f32 v62, s68, v62
v_mul_f32 v63, s68, v63
v_mfma_f32_16x16x32_bf16 v[228:231], a[136:139], a[8:11], v[228:231]
v_mul_f32 v124, s68, v124
v_mul_f32 v125, s68, v125
v_mfma_f32_16x16x32_bf16 v[228:231], a[140:143], a[12:15], v[228:231]
v_mul_f32 v126, s68, v126
v_mul_f32 v127, s68, v127
v_mfma_f32_16x16x32_bf16 v[232:235], a[136:139], a[16:19], v[232:235]
v_cvt_pk_bf16_f32 v60, v60, v61
v_cvt_pk_bf16_f32 v61, v62, v63
v_mfma_f32_16x16x32_bf16 v[232:235], a[140:143], a[20:23], v[232:235]
v_cvt_pk_bf16_f32 v62, v124, v125
v_cvt_pk_bf16_f32 v63, v126, v127
v_mfma_f32_16x16x32_bf16 v[236:239], a[136:139], a[24:27], v[236:239]
ds_write_b128 v28, v[60:63] offset:24576
v_mul_f32 v68, s68, v68
v_mfma_f32_16x16x32_bf16 v[236:239], a[140:143], a[28:31], v[236:239]
s_add_u32 s23, s67, 24576
buffer_store_dwordx4 v[60:63], v1, s[4:7], s23 offen offset:0 sc1
v_mfma_f32_16x16x32_bf16 v[240:243], a[136:139], a[32:35], v[240:243]
v_mul_f32 v69, s68, v69
v_mul_f32 v70, s68, v70
v_mfma_f32_16x16x32_bf16 v[240:243], a[140:143], a[36:39], v[240:243]
v_mul_f32 v71, s68, v71
v_mul_f32 v132, s68, v132
v_mfma_f32_16x16x32_bf16 v[244:247], a[136:139], a[40:43], v[244:247]
v_mul_f32 v133, s68, v133
v_mul_f32 v134, s68, v134
v_mfma_f32_16x16x32_bf16 v[244:247], a[140:143], a[44:47], v[244:247]
v_mul_f32 v135, s68, v135
v_cvt_pk_bf16_f32 v68, v68, v69
v_mfma_f32_16x16x32_bf16 v[248:251], a[136:139], a[48:51], v[248:251]
v_cvt_pk_bf16_f32 v69, v70, v71
v_cvt_pk_bf16_f32 v70, v132, v133
v_mfma_f32_16x16x32_bf16 v[248:251], a[140:143], a[52:55], v[248:251]
v_cvt_pk_bf16_f32 v71, v134, v135
v_mfma_f32_16x16x32_bf16 v[252:255], a[136:139], a[56:59], v[252:255]
ds_write_b128 v28, v[68:71] offset:32768
v_mfma_f32_16x16x32_bf16 v[252:255], a[140:143], a[60:63], v[252:255]
s_add_u32 s23, s67, 32768
buffer_store_dwordx4 v[68:71], v1, s[4:7], s23 offen offset:0 sc1
buffer_load_dword v21, v20, s[4:7], s70 offen sc1
v_pk_mul_f32 v[76:77], v[76:77], s[68:69]
v_pk_mul_f32 v[78:79], v[78:79], s[68:69]
v_pk_mul_f32 v[140:141], v[140:141], s[68:69]
v_pk_mul_f32 v[142:143], v[142:143], s[68:69]
v_cvt_pk_bf16_f32 v76, v76, v77
v_cvt_pk_bf16_f32 v77, v78, v79
v_cvt_pk_bf16_f32 v78, v140, v141
v_cvt_pk_bf16_f32 v79, v142, v143
ds_write_b128 v28, v[76:79] offset:40960
s_add_u32 s23, s67, 40960
buffer_store_dwordx4 v[76:79], v1, s[4:7], s23 offen offset:0 sc1
v_pk_mul_f32 v[84:85], v[84:85], s[68:69]
v_pk_mul_f32 v[86:87], v[86:87], s[68:69]
v_pk_mul_f32 v[148:149], v[148:149], s[68:69]
v_pk_mul_f32 v[150:151], v[150:151], s[68:69]
v_cvt_pk_bf16_f32 v84, v84, v85
v_cvt_pk_bf16_f32 v85, v86, v87
v_cvt_pk_bf16_f32 v86, v148, v149
v_cvt_pk_bf16_f32 v87, v150, v151
ds_write_b128 v28, v[84:87] offset:49152
s_add_u32 s23, s67, 49152
buffer_store_dwordx4 v[84:87], v1, s[4:7], s23 offen offset:0 sc1
v_pk_mul_f32 v[92:93], v[92:93], s[68:69]
v_pk_mul_f32 v[94:95], v[94:95], s[68:69]
v_pk_mul_f32 v[156:157], v[156:157], s[68:69]
v_pk_mul_f32 v[158:159], v[158:159], s[68:69]
v_cvt_pk_bf16_f32 v92, v92, v93
v_cvt_pk_bf16_f32 v93, v94, v95
v_cvt_pk_bf16_f32 v94, v156, v157
v_cvt_pk_bf16_f32 v95, v158, v159
ds_write_b128 v28, v[92:95] offset:57344
s_add_u32 s23, s67, 57344
buffer_store_dwordx4 v[92:95], v1, s[4:7], s23 offen offset:0 sc1
v_pk_mul_f32 v[164:165], v[164:165], s[68:69]
v_pk_mul_f32 v[166:167], v[166:167], s[68:69]
v_pk_mul_f32 v[224:225], v[224:225], s[68:69]
v_pk_mul_f32 v[226:227], v[226:227], s[68:69]
v_cvt_pk_bf16_f32 v164, v164, v165
v_cvt_pk_bf16_f32 v165, v166, v167
v_cvt_pk_bf16_f32 v166, v224, v225
v_cvt_pk_bf16_f32 v167, v226, v227
ds_write_b128 v28, v[164:167] offset:1024
s_add_u32 s23, s67, 0
buffer_store_dwordx4 v[164:167], v1, s[4:7], s23 offen offset:1024 sc1
v_pk_mul_f32 v[172:173], v[172:173], s[68:69]
v_pk_mul_f32 v[174:175], v[174:175], s[68:69]
v_pk_mul_f32 v[228:229], v[228:229], s[68:69]
v_pk_mul_f32 v[230:231], v[230:231], s[68:69]
v_cvt_pk_bf16_f32 v172, v172, v173
v_cvt_pk_bf16_f32 v173, v174, v175
v_cvt_pk_bf16_f32 v174, v228, v229
v_cvt_pk_bf16_f32 v175, v230, v231
ds_write_b128 v28, v[172:175] offset:9216
s_add_u32 s23, s67, 8192
buffer_store_dwordx4 v[172:175], v1, s[4:7], s23 offen offset:1024 sc1
v_pk_mul_f32 v[180:181], v[180:181], s[68:69]
v_pk_mul_f32 v[182:183], v[182:183], s[68:69]
v_pk_mul_f32 v[232:233], v[232:233], s[68:69]
v_pk_mul_f32 v[234:235], v[234:235], s[68:69]
v_cvt_pk_bf16_f32 v180, v180, v181
v_cvt_pk_bf16_f32 v181, v182, v183
v_cvt_pk_bf16_f32 v182, v232, v233
v_cvt_pk_bf16_f32 v183, v234, v235
ds_write_b128 v28, v[180:183] offset:17408
s_add_u32 s23, s67, 16384
buffer_store_dwordx4 v[180:183], v1, s[4:7], s23 offen offset:1024 sc1
v_pk_mul_f32 v[188:189], v[188:189], s[68:69]
v_pk_mul_f32 v[190:191], v[190:191], s[68:69]
v_pk_mul_f32 v[236:237], v[236:237], s[68:69]
v_pk_mul_f32 v[238:239], v[238:239], s[68:69]
v_cvt_pk_bf16_f32 v188, v188, v189
v_cvt_pk_bf16_f32 v189, v190, v191
v_cvt_pk_bf16_f32 v190, v236, v237
v_cvt_pk_bf16_f32 v191, v238, v239
ds_write_b128 v28, v[188:191] offset:25600
s_add_u32 s23, s67, 24576
buffer_store_dwordx4 v[188:191], v1, s[4:7], s23 offen offset:1024 sc1
v_pk_mul_f32 v[196:197], v[196:197], s[68:69]
v_pk_mul_f32 v[198:199], v[198:199], s[68:69]
PAD_8:
s_cbranch_execz M_tret
v_pk_mul_f32 v[240:241], v[240:241], s[68:69]
v_pk_mul_f32 v[242:243], v[242:243], s[68:69]
v_cvt_pk_bf16_f32 v196, v196, v197
v_cvt_pk_bf16_f32 v197, v198, v199
v_cvt_pk_bf16_f32 v198, v240, v241
v_cvt_pk_bf16_f32 v199, v242, v243
ds_write_b128 v28, v[196:199] offset:33792
s_add_u32 s23, s67, 32768
buffer_store_dwordx4 v[196:199], v1, s[4:7], s23 offen offset:1024 sc1
v_pk_mul_f32 v[204:205], v[204:205], s[68:69]
v_pk_mul_f32 v[206:207], v[206:207], s[68:69]
v_pk_mul_f32 v[244:245], v[244:245], s[68:69]
v_pk_mul_f32 v[246:247], v[246:247], s[68:69]
v_cvt_pk_bf16_f32 v204, v204, v205
v_cvt_pk_bf16_f32 v205, v206, v207
v_cvt_pk_bf16_f32 v206, v244, v245
v_cvt_pk_bf16_f32 v207, v246, v247
ds_write_b128 v28, v[204:207] offset:41984
s_add_u32 s23, s67, 40960
buffer_store_dwordx4 v[204:207], v1, s[4:7], s23 offen offset:1024 sc1
v_pk_mul_f32 v[212:213], v[212:213], s[68:69]
v_pk_mul_f32 v[214:215], v[214:215], s[68:69]
v_pk_mul_f32 v[248:249], v[248:249], s[68:69]
v_pk_mul_f32 v[250:251], v[250:251], s[68:69]
v_cvt_pk_bf16_f32 v212, v212, v213
v_cvt_pk_bf16_f32 v213, v214, v215
v_cvt_pk_bf16_f32 v214, v248, v249
v_cvt_pk_bf16_f32 v215, v250, v251
ds_write_b128 v28, v[212:215] offset:50176
s_add_u32 s23, s67, 49152
buffer_store_dwordx4 v[212:215], v1, s[4:7], s23 offen offset:1024 sc1
v_pk_mul_f32 v[220:221], v[220:221], s[68:69]
v_pk_mul_f32 v[222:223], v[222:223], s[68:69]
v_pk_mul_f32 v[252:253], v[252:253], s[68:69]
v_pk_mul_f32 v[254:255], v[254:255], s[68:69]
v_cvt_pk_bf16_f32 v220, v220, v221
v_cvt_pk_bf16_f32 v221, v222, v223
v_cvt_pk_bf16_f32 v222, v252, v253
v_cvt_pk_bf16_f32 v223, v254, v255
ds_write_b128 v28, v[220:223] offset:58368
s_add_u32 s23, s67, 57344
buffer_store_dwordx4 v[220:223], v1, s[4:7], s23 offen offset:1024 sc1
s_waitcnt vmcnt(11)
v_cmp_gt_u32 vcc, 1, v21
s_cbranch_vccnz M_kspin
M_kok:
buffer_load_dword v21, v15, s[4:7], s70 offen sc1
s_mov_b32 m0, s84
s_nop 0
buffer_load_dwordx4 v1, s[4:7], s8 offen offset:0 sc1 lds
buffer_load_dwordx4 v1, s[4:7], s8 offen offset:1024 sc1 lds
buffer_load_dwordx4 v1, s[4:7], s8 offen offset:2048 sc1 lds
buffer_load_dwordx4 v1, s[4:7], s8 offen offset:3072 sc1 lds
s_add_u32 s8, s8, 4096
s_add_u32 m0, s84, 4096
s_nop 0
buffer_load_dwordx4 v1, s[4:7], s8 offen offset:0 sc1 lds
buffer_load_dwordx4 v1, s[4:7], s8 offen offset:1024 sc1 lds
buffer_load_dwordx4 v1, s[4:7], s8 offen offset:2048 sc1 lds
buffer_load_dwordx4 v1, s[4:7], s8 offen offset:3072 sc1 lds
s_add_u32 s8, s8, 28672
s_sub_u32 s9, s9, 1
s_cmp_eq_u32 s9, 0
s_cselect_b32 s8, s10, s8
s_cselect_b32 s9, s11, s9
s_cselect_b32 s10, 3221225472, s10
v_add_u32 v28, s18, v2
s_waitcnt lgkmcnt(0)
s_barrier
ds_read_b128 a[0:3], v28 offset:0
ds_read_b128 a[4:7], v28 offset:1024
ds_read_b128 a[8:11], v28 offset:2048
ds_read_b128 a[12:15], v28 offset:3072
ds_read_b128 a[16:19], v28 offset:4096
ds_read_b128 a[20:23], v28 offset:5120
ds_read_b128 a[24:27], v28 offset:6144
ds_read_b128 a[28:31], v28 offset:7168
ds_read_b128 a[32:35], v28 offset:32768
ds_read_b128 a[36:39], v28 offset:33792
ds_read_b128 a[40:43], v28 offset:34816
ds_read_b128 a[44:47], v28 offset:35840
ds_read_b128 a[48:51], v28 offset:36864
ds_read_b128 a[52:55], v28 offset:37888
ds_read_b128 a[56:59], v28 offset:38912
ds_read_b128 a[60:63], v28 offset:39936
s_mov_b32 m0, s85
s_nop 0
buffer_load_dwordx4 v1, s[4:7], s8 offen offset:0 sc1 lds
buffer_load_dwordx4 v1, s[4:7], s8 offen offset:1024 sc1 lds
buffer_load_dwordx4 v1, s[4:7], s8 offen offset:2048 sc1 lds
buffer_load_dwordx4 v1, s[4:7], s8 offen offset:3072 sc1 lds
s_add_u32 s8, s8, 4096
s_add_u32 m0, s85, 4096
s_nop 0
buffer_load_dwordx4 v1, s[4:7], s8 offen offset:0 sc1 lds
buffer_load_dwordx4 v1, s[4:7], s8 offen offset:1024 sc1 lds
buffer_load_dwordx4 v1, s[4:7], s8 offen offset:2048 sc1 lds
buffer_load_dwordx4 v1, s[4:7], s8 offen offset:3072 sc1 lds
s_add_u32 s8, s8, 28672
s_sub_u32 s9, s9, 1
s_cmp_eq_u32 s9, 0
s_cselect_b32 s8, s10, s8
s_cselect_b32 s9, s11, s9
s_cselect_b32 s10, 3221225472, s10
s_mov_b32 s25, 1266679808
s_lshl_b32 s22, s21, 3
s_xor_b32 s28, s70, 256
s_add_u32 s28, s28, s22
s_add_u32 s28, s28, 6148
s_lshl_b32 s26, s21, 16
s_add_u32 s26, s26, s30
s_add_u32 s26, s26, 33554432
s_xor_b32 s76, s20, 0
s_lshl_b32 s76, s76, 3
s_add_u32 s76, s76, s21
s_lshl_b32 s76, s76, 2
s_add_u32 s76, s76, s3
s_lshl_b32 s27, s76, 10
s_add_u32 s27, s27, 75497472
s_lshl_b32 s76, s76, 14
s_add_u32 s76, s76, 67108864
s_lshl_b32 s81, s20, 2
s_add_u32 s81, s81, s3
s_mul_i32 s81, s81, 57344
s_cmp_eq_u32 s24, 1
s_cselect_b32 s80, s28, s70
s_add_u32 s77, s76, 8192
v_lshrrev_b32 v8, 7, v1
v_and_b32 v9, 6, v8
v_lshlrev_b32 v9, 4, v9
v_and_b32 v10, 0x70, v1
v_xor_b32 v9, v9, v10
v_mul_u32_u24 v8, 896, v8
v_add_u32 v8, v8, v9
v_accvgpr_write_b32 a184, v8
v_add_u32 v8, 6144, v8
v_accvgpr_write_b32 a185, v8
v_add_u32 v8, 6144, v8
v_accvgpr_write_b32 a186, v8
v_add_u32 v8, 6144, v8
v_accvgpr_write_b32 a187, v8
v_lshrrev_b32 v8, 6, v1
v_bfe_u32 v9, v1, 7, 2
v_lshlrev_b32 v9, 5, v9
v_lshl_add_u32 v8, v8, 7, v9
v_bfe_u32 v9, v1, 4, 2
v_lshl_add_u32 v8, v9, 3, v8
v_add_u32 v8, 32768, v8
v_accvgpr_write_b32 a188, v8
v_xor_b32 v9, 32, v8
v_accvgpr_write_b32 a189, v9
v_xor_b32 v9, 64, v8
v_accvgpr_write_b32 a190, v9
v_xor_b32 v9, 96, v8
v_accvgpr_write_b32 a191, v9
s_add_u32 s22, s66, 16384
s_mov_b32 s71, 3221225472
s_waitcnt vmcnt(17)
s_barrier
buffer_store_dword v6, v5, s[4:7], s22 offen sc1
v_mov_b64 v[128:129], 0
v_mov_b64 v[130:131], 0
v_mov_b64 v[132:133], 0
v_mov_b64 v[134:135], 0
v_mov_b64 v[136:137], 0
v_mov_b64 v[138:139], 0
v_mov_b64 v[140:141], 0
v_mov_b64 v[142:143], 0
v_mov_b64 v[144:145], 0
v_mov_b64 v[146:147], 0
v_mov_b64 v[148:149], 0
v_mov_b64 v[150:151], 0
v_mov_b64 v[152:153], 0
v_mov_b64 v[154:155], 0
v_mov_b64 v[156:157], 0
v_mov_b64 v[158:159], 0
v_mov_b64 v[160:161], 0
v_mov_b64 v[162:163], 0
v_mov_b64 v[164:165], 0
v_mov_b64 v[166:167], 0
v_mov_b64 v[168:169], 0
v_mov_b64 v[170:171], 0
v_mov_b64 v[172:173], 0
v_mov_b64 v[174:175], 0
v_mov_b64 v[176:177], 0
v_mov_b64 v[178:179], 0
v_mov_b64 v[180:181], 0
v_mov_b64 v[182:183], 0
v_mov_b64 v[184:185], 0
v_mov_b64 v[186:187], 0
v_mov_b64 v[188:189], 0
v_mov_b64 v[190:191], 0
v_mov_b64 v[192:193], 0
v_mov_b64 v[194:195], 0
v_mov_b64 v[196:197], 0
v_mov_b64 v[198:199], 0
v_mov_b64 v[200:201], 0
v_mov_b64 v[202:203], 0
v_mov_b64 v[204:205], 0
v_mov_b64 v[206:207], 0
v_mov_b64 v[208:209], 0
v_mov_b64 v[210:211], 0
v_mov_b64 v[212:213], 0
v_mov_b64 v[214:215], 0
v_mov_b64 v[216:217], 0
v_mov_b64 v[218:219], 0
v_mov_b64 v[220:221], 0
v_mov_b64 v[222:223], 0
v_mov_b64 v[224:225], 0
v_mov_b64 v[226:227], 0
v_mov_b64 v[228:229], 0
v_mov_b64 v[230:231], 0
v_mov_b64 v[232:233], 0
v_mov_b64 v[234:235], 0
v_mov_b64 v[236:237], 0
v_mov_b64 v[238:239], 0
v_mov_b64 v[240:241], 0
v_mov_b64 v[242:243], 0
v_mov_b64 v[244:245], 0
v_mov_b64 v[246:247], 0
v_mov_b64 v[248:249], 0
v_mov_b64 v[250:251], 0
v_mov_b64 v[252:253], 0
v_mov_b64 v[254:255], 0
v_mov_b64 v[24:25], 0
s_cmp_eq_u32 s24, 9
s_cbranch_scc1 M_t2A
M_t2Ar:
s_waitcnt vmcnt(9) lgkmcnt(0)
v_cmp_gt_u32 vcc, 1, v21
s_cbranch_vccnz M_vspin
M_vok:
s_barrier
K2_item:
PAD_9:
s_cbranch_execz M_tret
s_cmp_eq_u32 s19, 0
s_cbranch_scc1 K2_p0d
ds_read_b128 a[64:67], v1 offset:0
ds_read_b128 a[68:71], v1 offset:1024
ds_read_b128 a[72:75], v1 offset:2048
ds_read_b128 a[76:79], v1 offset:3072
ds_read_b128 a[80:83], v1 offset:4096
ds_read_b128 a[84:87], v1 offset:5120
ds_read_b128 a[88:91], v1 offset:6144
ds_read_b128 a[92:95], v1 offset:7168
s_waitcnt lgkmcnt(7)
v_mfma_f32_16x16x32_bf16 v[32:35], a[64:67], a[0:3], 0
s_waitcnt lgkmcnt(6)
s_add_u32 m0, s18, 65536
ds_read_b128 a[96:99], v1 offset:8192
v_mfma_f32_16x16x32_bf16 v[32:35], a[68:71], a[4:7], v[32:35]
s_waitcnt lgkmcnt(6)
buffer_load_dwordx4 v1, s[4:7], s12 offen offset:0 sc1 lds
v_mfma_f32_16x16x32_bf16 v[32:35], a[72:75], a[8:11], v[32:35]
s_waitcnt lgkmcnt(5)
ds_read_b128 a[100:103], v1 offset:9216
v_mfma_f32_16x16x32_bf16 v[32:35], a[76:79], a[12:15], v[32:35]
s_waitcnt lgkmcnt(5)
buffer_load_dwordx4 v1, s[4:7], s12 offen offset:1024 sc1 lds
v_mfma_f32_16x16x32_bf16 v[32:35], a[80:83], a[16:19], v[32:35]
s_waitcnt lgkmcnt(4)
ds_read_b128 a[104:107], v1 offset:10240
v_mfma_f32_16x16x32_bf16 v[32:35], a[84:87], a[20:23], v[32:35]
s_waitcnt lgkmcnt(4)
buffer_load_dwordx4 v1, s[4:7], s12 offen offset:2048 sc1 lds
v_mfma_f32_16x16x32_bf16 v[32:35], a[88:91], a[24:27], v[32:35]
s_waitcnt lgkmcnt(3)
ds_read_b128 a[108:111], v1 offset:11264
v_mfma_f32_16x16x32_bf16 v[32:35], a[92:95], a[28:31], v[32:35]
buffer_load_dwordx4 v1, s[4:7], s12 offen offset:3072 sc1 lds
v_mfma_f32_16x16x32_bf16 v[36:39], a[64:67], a[32:35], 0
s_add_u32 s12, s12, 4096
s_add_u32 m0, s18, 69632
ds_read_b128 a[112:115], v1 offset:12288
v_mfma_f32_16x16x32_bf16 v[36:39], a[68:71], a[36:39], v[36:39]
buffer_load_dwordx4 v1, s[4:7], s12 offen offset:0 sc1 lds
v_mfma_f32_16x16x32_bf16 v[36:39], a[72:75], a[40:43], v[36:39]
ds_read_b128 a[116:119], v1 offset:13312
v_mfma_f32_16x16x32_bf16 v[36:39], a[76:79], a[44:47], v[36:39]
buffer_load_dwordx4 v1, s[4:7], s12 offen offset:1024 sc1 lds
v_mfma_f32_16x16x32_bf16 v[36:39], a[80:83], a[48:51], v[36:39]
ds_read_b128 a[120:123], v1 offset:14336
v_max3_f32 v28, v32, v33, v34
v_mfma_f32_16x16x32_bf16 v[36:39], a[84:87], a[52:55], v[36:39]
buffer_load_dwordx4 v1, s[4:7], s12 offen offset:2048 sc1 lds
v_mfma_f32_16x16x32_bf16 v[36:39], a[88:91], a[56:59], v[36:39]
ds_read_b128 a[124:127], v1 offset:15360
v_max_f32 v28, v28, v35
v_mfma_f32_16x16x32_bf16 v[36:39], a[92:95], a[60:63], v[36:39]
s_waitcnt lgkmcnt(4)
buffer_load_dwordx4 v1, s[4:7], s12 offen offset:3072 sc1 lds
v_mfma_f32_16x16x32_bf16 v[40:43], a[96:99], a[0:3], 0
s_add_u32 s12, s12, 28672
ds_read_b128 a[64:67], v1 offset:16384
v_mov_b32 v30, v28
v_mfma_f32_16x16x32_bf16 v[40:43], a[100:103], a[4:7], v[40:43]
s_waitcnt lgkmcnt(2)
s_sub_u32 s13, s13, 1
v_mfma_f32_16x16x32_bf16 v[40:43], a[104:107], a[8:11], v[40:43]
s_cmp_eq_u32 s13, 0
ds_read_b128 a[68:71], v1 offset:17408
v_permlane16_swap_b32 v28, v30
v_mfma_f32_16x16x32_bf16 v[40:43], a[108:111], a[12:15], v[40:43]
s_cselect_b32 s12, s14, s12
v_max_f32 v28, v28, v30
v_mov_b32 v30, v28
v_mfma_f32_16x16x32_bf16 v[40:43], a[112:115], a[16:19], v[40:43]
s_cselect_b32 s13, s15, s13
ds_read_b128 a[72:75], v1 offset:18432
v_max3_f32 v29, v36, v37, v38
v_mfma_f32_16x16x32_bf16 v[40:43], a[116:119], a[20:23], v[40:43]
s_cselect_b32 s14, 3221225472, s14
v_permlane32_swap_b32 v28, v30
v_max_f32 v28, v28, v30
v_mfma_f32_16x16x32_bf16 v[40:43], a[120:123], a[24:27], v[40:43]
s_waitcnt lgkmcnt(3)
ds_read_b128 a[76:79], v1 offset:19456
v_sub_f32 v16, 0, v28
v_mfma_f32_16x16x32_bf16 v[40:43], a[124:127], a[28:31], v[40:43]
v_sub_f32 v17, 0, v28
v_sub_f32 v18, 0, v28
v_mfma_f32_16x16x32_bf16 v[44:47], a[96:99], a[32:35], 0
ds_read_b128 a[80:83], v1 offset:20480
v_sub_f32 v19, 0, v28
v_mfma_f32_16x16x32_bf16 v[44:47], a[100:103], a[36:39], v[44:47]
v_max_f32 v29, v29, v39
v_mov_b32 v31, v29
v_mfma_f32_16x16x32_bf16 v[44:47], a[104:107], a[40:43], v[44:47]
ds_read_b128 a[84:87], v1 offset:21504
v_mfma_f32_16x16x32_bf16 v[44:47], a[108:111], a[44:47], v[44:47]
v_permlane16_swap_b32 v29, v31
v_max_f32 v29, v29, v31
v_mfma_f32_16x16x32_bf16 v[44:47], a[112:115], a[48:51], v[44:47]
ds_read_b128 a[88:91], v1 offset:22528
v_mov_b32 v31, v29
v_mfma_f32_16x16x32_bf16 v[44:47], a[116:119], a[52:55], v[44:47]
v_mfma_f32_16x16x32_bf16 v[44:47], a[120:123], a[56:59], v[44:47]
ds_read_b128 a[92:95], v1 offset:23552
v_permlane32_swap_b32 v29, v31
v_mfma_f32_16x16x32_bf16 v[44:47], a[124:127], a[60:63], v[44:47]
s_waitcnt lgkmcnt(4)
v_max_f32 v29, v29, v31
v_sub_f32 v20, 0, v29
v_mfma_f32_16x16x32_bf16 v[48:51], a[64:67], a[0:3], v[16:19]
ds_read_b128 a[96:99], v1 offset:24576
v_sub_f32 v21, 0, v29
v_mfma_f32_16x16x32_bf16 v[48:51], a[68:71], a[4:7], v[48:51]
v_sub_f32 v22, 0, v29
v_sub_f32 v23, 0, v29
v_mfma_f32_16x16x32_bf16 v[48:51], a[72:75], a[8:11], v[48:51]
ds_read_b128 a[100:103], v1 offset:25600
v_mfma_f32_16x16x32_bf16 v[48:51], a[76:79], a[12:15], v[48:51]
s_waitcnt lgkmcnt(4)
v_mfma_f32_16x16x32_bf16 v[48:51], a[80:83], a[16:19], v[48:51]
ds_read_b128 a[104:107], v1 offset:26624
v_mfma_f32_16x16x32_bf16 v[48:51], a[84:87], a[20:23], v[48:51]
s_waitcnt lgkmcnt(4)
v_add_f32 v32, v32, v16
v_add_f32 v33, v33, v16
v_add_f32 v34, v34, v16
v_add_f32 v35, v35, v16
v_mfma_f32_16x16x32_bf16 v[48:51], a[88:91], a[24:27], v[48:51]
s_waitcnt lgkmcnt(3)
ds_read_b128 a[108:111], v1 offset:27648
v_add_f32 v36, v36, v20
v_add_f32 v37, v37, v20
v_add_f32 v38, v38, v20
v_add_f32 v39, v39, v20
v_mfma_f32_16x16x32_bf16 v[48:51], a[92:95], a[28:31], v[48:51]
v_add_f32 v40, v40, v16
v_add_f32 v41, v41, v16
v_add_f32 v42, v42, v16
v_add_f32 v43, v43, v16
v_mfma_f32_16x16x32_bf16 v[52:55], a[64:67], a[32:35], v[20:23]
ds_read_b128 a[112:115], v1 offset:28672
v_add_f32 v44, v44, v20
v_add_f32 v45, v45, v20
v_add_f32 v46, v46, v20
v_add_f32 v47, v47, v20
v_mfma_f32_16x16x32_bf16 v[52:55], a[68:71], a[36:39], v[52:55]
v_exp_f32 v8, v32
v_mfma_f32_16x16x32_bf16 v[52:55], a[72:75], a[40:43], v[52:55]
ds_read_b128 a[116:119], v1 offset:29696
v_exp_f32 v9, v33
v_mfma_f32_16x16x32_bf16 v[52:55], a[76:79], a[44:47], v[52:55]
v_exp_f32 v10, v34
v_add_f32 v26, v8, v9
v_cvt_pk_bf16_f32 v96, v8, v9
v_mfma_f32_16x16x32_bf16 v[52:55], a[80:83], a[48:51], v[52:55]
ds_read_b128 a[120:123], v1 offset:30720
v_exp_f32 v11, v35
v_add_f32 v26, v26, v10
v_mfma_f32_16x16x32_bf16 v[52:55], a[84:87], a[52:55], v[52:55]
v_exp_f32 v12, v36
v_add_f32 v26, v26, v11
v_cvt_pk_bf16_f32 v97, v10, v11
v_mfma_f32_16x16x32_bf16 v[52:55], a[88:91], a[56:59], v[52:55]
s_waitcnt vmcnt(8) lgkmcnt(4)
ds_read_b128 a[124:127], v1 offset:31744
v_exp_f32 v13, v37
v_mfma_f32_16x16x32_bf16 v[52:55], a[92:95], a[60:63], v[52:55]
s_barrier
v_mfma_f32_16x16x32_bf16 v[56:59], a[96:99], a[0:3], v[16:19]
ds_read_b128 a[64:67], v4 offset:0
v_exp_f32 v14, v38
v_mfma_f32_16x16x32_bf16 v[56:59], a[100:103], a[4:7], v[56:59]
buffer_store_dword v6, v5, s[4:7], s71 offen sc1
v_mfma_f32_16x16x32_bf16 v[56:59], a[104:107], a[8:11], v[56:59]
s_waitcnt lgkmcnt(4)
ds_read_b128 a[68:71], v4 offset:1024
v_add_f32 v27, v12, v13
v_cvt_pk_bf16_f32 v104, v12, v13
v_add_f32 v27, v27, v14
v_mfma_f32_16x16x32_bf16 v[56:59], a[108:111], a[12:15], v[56:59]
v_exp_f32 v15, v39
v_mfma_f32_16x16x32_bf16 v[56:59], a[112:115], a[16:19], v[56:59]
s_waitcnt lgkmcnt(4)
ds_read_b128 a[72:75], v4 offset:2048
v_exp_f32 v8, v40
v_add_f32 v27, v27, v15
v_cvt_pk_bf16_f32 v105, v14, v15
v_mfma_f32_16x16x32_bf16 v[56:59], a[116:119], a[20:23], v[56:59]
s_waitcnt lgkmcnt(4)
v_exp_f32 v9, v41
v_add_f32 v26, v26, v8
v_mfma_f32_16x16x32_bf16 v[56:59], a[120:123], a[24:27], v[56:59]
s_waitcnt lgkmcnt(3)
ds_read_b128 a[76:79], v4 offset:3072
v_exp_f32 v10, v42
v_add_f32 v26, v26, v9
v_cvt_pk_bf16_f32 v98, v8, v9
v_mfma_f32_16x16x32_bf16 v[56:59], a[124:127], a[28:31], v[56:59]
v_exp_f32 v11, v43
v_add_f32 v26, v26, v10
v_mfma_f32_16x16x32_bf16 v[60:63], a[96:99], a[32:35], v[20:23]
ds_read_b128 a[80:83], v4 offset:4096
v_exp_f32 v12, v44
v_mfma_f32_16x16x32_bf16 v[60:63], a[100:103], a[36:39], v[60:63]
v_exp_f32 v13, v45
v_mfma_f32_16x16x32_bf16 v[60:63], a[104:107], a[40:43], v[60:63]
ds_read_b128 a[84:87], v4 offset:5120
v_exp_f32 v14, v46
v_mfma_f32_16x16x32_bf16 v[60:63], a[108:111], a[44:47], v[60:63]
v_exp_f32 v15, v47
v_mfma_f32_16x16x32_bf16 v[60:63], a[112:115], a[48:51], v[60:63]
ds_read_b128 a[88:91], v4 offset:6144
v_add_f32 v26, v26, v11
v_cvt_pk_bf16_f32 v99, v10, v11
v_mfma_f32_16x16x32_bf16 v[60:63], a[116:119], a[52:55], v[60:63]
v_add_f32 v27, v27, v12
v_add_f32 v27, v27, v13
v_cvt_pk_bf16_f32 v106, v12, v13
v_mfma_f32_16x16x32_bf16 v[60:63], a[120:123], a[56:59], v[60:63]
s_waitcnt lgkmcnt(7)
s_barrier
ds_read_b128 a[92:95], v4 offset:7168
v_mfma_f32_16x16x32_bf16 v[60:63], a[124:127], a[60:63], v[60:63]
s_waitcnt lgkmcnt(4)
v_add_f32 v27, v27, v14
v_add_f32 v27, v27, v15
v_cvt_pk_bf16_f32 v107, v14, v15
K2_x1:
v_mfma_f32_16x16x32_bf16 v[64:67], a[64:67], a[0:3], v[16:19]
s_add_u32 m0, s18, 0
ds_read_b128 a[96:99], v4 offset:8192
v_mfma_f32_16x16x32_bf16 v[64:67], a[68:71], a[4:7], v[64:67]
s_waitcnt lgkmcnt(4)
buffer_load_dwordx4 v1, s[4:7], s8 offen offset:0 sc1 lds
v_mfma_f32_16x16x32_bf16 v[64:67], a[72:75], a[8:11], v[64:67]
ds_read_b128 a[100:103], v4 offset:9216
v_mfma_f32_16x16x32_bf16 v[64:67], a[76:79], a[12:15], v[64:67]
s_waitcnt lgkmcnt(4)
v_exp_f32 v8, v48
v_mfma_f32_16x16x32_bf16 v[64:67], a[80:83], a[16:19], v[64:67]
ds_read_b128 a[104:107], v4 offset:10240
v_add_f32 v26, v26, v8
v_mfma_f32_16x16x32_bf16 v[64:67], a[84:87], a[20:23], v[64:67]
s_waitcnt lgkmcnt(4)
buffer_load_dwordx4 v1, s[4:7], s8 offen offset:1024 sc1 lds
v_mfma_f32_16x16x32_bf16 v[64:67], a[88:91], a[24:27], v[64:67]
s_waitcnt lgkmcnt(3)
ds_read_b128 a[108:111], v4 offset:11264
v_mfma_f32_16x16x32_bf16 v[64:67], a[92:95], a[28:31], v[64:67]
v_exp_f32 v9, v49
v_mfma_f32_16x16x32_bf16 v[68:71], a[64:67], a[32:35], v[20:23]
ds_read_b128 a[112:115], v4 offset:12288
v_add_f32 v26, v26, v9
v_mfma_f32_16x16x32_bf16 v[68:71], a[68:71], a[36:39], v[68:71]
buffer_load_dwordx4 v1, s[4:7], s8 offen offset:2048 sc1 lds
v_mfma_f32_16x16x32_bf16 v[68:71], a[72:75], a[40:43], v[68:71]
ds_read_b128 a[116:119], v4 offset:13312
v_cvt_pk_bf16_f32 v100, v8, v9
v_mfma_f32_16x16x32_bf16 v[68:71], a[76:79], a[44:47], v[68:71]
v_exp_f32 v10, v50
v_mfma_f32_16x16x32_bf16 v[68:71], a[80:83], a[48:51], v[68:71]
ds_read_b128 a[120:123], v4 offset:14336
v_add_f32 v26, v26, v10
v_mfma_f32_16x16x32_bf16 v[68:71], a[84:87], a[52:55], v[68:71]
buffer_load_dwordx4 v1, s[4:7], s8 offen offset:3072 sc1 lds
v_mfma_f32_16x16x32_bf16 v[68:71], a[88:91], a[56:59], v[68:71]
s_add_u32 s8, s8, 4096
ds_read_b128 a[124:127], v4 offset:15360
v_mfma_f32_16x16x32_bf16 v[68:71], a[92:95], a[60:63], v[68:71]
s_waitcnt lgkmcnt(4)
v_exp_f32 v11, v51
v_mfma_f32_16x16x32_bf16 v[72:75], a[96:99], a[0:3], v[16:19]
s_add_u32 m0, s18, 4096
ds_read_b128 a[64:67], v4 offset:16384
v_add_f32 v26, v26, v11
v_mfma_f32_16x16x32_bf16 v[72:75], a[100:103], a[4:7], v[72:75]
buffer_load_dwordx4 v1, s[4:7], s8 offen offset:0 sc1 lds
v_mfma_f32_16x16x32_bf16 v[72:75], a[104:107], a[8:11], v[72:75]
ds_read_b128 a[68:71], v4 offset:17408
v_cvt_pk_bf16_f32 v101, v10, v11
v_mfma_f32_16x16x32_bf16 v[72:75], a[108:111], a[12:15], v[72:75]
s_waitcnt lgkmcnt(4)
v_mfma_f32_16x16x32_bf16 v[72:75], a[112:115], a[16:19], v[72:75]
ds_read_b128 a[72:75], v4 offset:18432
v_mfma_f32_16x16x32_bf16 v[72:75], a[116:119], a[20:23], v[72:75]
s_waitcnt lgkmcnt(4)
buffer_load_dwordx4 v1, s[4:7], s8 offen offset:1024 sc1 lds
v_mfma_f32_16x16x32_bf16 v[72:75], a[120:123], a[24:27], v[72:75]
s_waitcnt lgkmcnt(3)
ds_read_b128 a[76:79], v4 offset:19456
v_mfma_f32_16x16x32_bf16 v[72:75], a[124:127], a[28:31], v[72:75]
v_exp_f32 v12, v52
v_mfma_f32_16x16x32_bf16 v[76:79], a[96:99], a[32:35], v[20:23]
ds_read_b128 a[80:83], v4 offset:20480
v_add_f32 v27, v27, v12
v_mfma_f32_16x16x32_bf16 v[76:79], a[100:103], a[36:39], v[76:79]
buffer_load_dwordx4 v1, s[4:7], s8 offen offset:2048 sc1 lds
v_mfma_f32_16x16x32_bf16 v[76:79], a[104:107], a[40:43], v[76:79]
ds_read_b128 a[84:87], v4 offset:21504
v_mfma_f32_16x16x32_bf16 v[76:79], a[108:111], a[44:47], v[76:79]
v_exp_f32 v13, v53
v_mfma_f32_16x16x32_bf16 v[76:79], a[112:115], a[48:51], v[76:79]
ds_read_b128 a[88:91], v4 offset:22528
v_add_f32 v27, v27, v13
v_mfma_f32_16x16x32_bf16 v[76:79], a[116:119], a[52:55], v[76:79]
s_waitcnt lgkmcnt(3)
buffer_load_dwordx4 v1, s[4:7], s8 offen offset:3072 sc1 lds
v_mfma_f32_16x16x32_bf16 v[76:79], a[120:123], a[56:59], v[76:79]
s_add_u32 s8, s8, 28672
ds_read_b128 a[92:95], v4 offset:23552
v_cvt_pk_bf16_f32 v108, v12, v13
v_mfma_f32_16x16x32_bf16 v[76:79], a[124:127], a[60:63], v[76:79]
s_sub_u32 s9, s9, 1
v_exp_f32 v14, v54
v_mfma_f32_16x16x32_bf16 v[80:83], a[64:67], a[0:3], v[16:19]
s_cmp_eq_u32 s9, 0
ds_read_b128 a[96:99], v4 offset:24576
v_add_f32 v27, v27, v14
v_mfma_f32_16x16x32_bf16 v[80:83], a[68:71], a[4:7], v[80:83]
s_cselect_b32 s8, s10, s8
v_exp_f32 v15, v55
v_mfma_f32_16x16x32_bf16 v[80:83], a[72:75], a[8:11], v[80:83]
s_cselect_b32 s9, s11, s9
ds_read_b128 a[100:103], v4 offset:25600
v_add_f32 v27, v27, v15
v_mfma_f32_16x16x32_bf16 v[80:83], a[76:79], a[12:15], v[80:83]
s_waitcnt lgkmcnt(4)
s_cselect_b32 s10, 3221225472, s10
v_cvt_pk_bf16_f32 v109, v14, v15
v_mfma_f32_16x16x32_bf16 v[80:83], a[80:83], a[16:19], v[80:83]
ds_read_b128 a[104:107], v4 offset:26624
v_mfma_f32_16x16x32_bf16 v[80:83], a[84:87], a[20:23], v[80:83]
s_waitcnt lgkmcnt(4)
v_exp_f32 v8, v56
v_mfma_f32_16x16x32_bf16 v[80:83], a[88:91], a[24:27], v[80:83]
s_waitcnt lgkmcnt(3)
ds_read_b128 a[108:111], v4 offset:27648
v_add_f32 v26, v26, v8
v_mfma_f32_16x16x32_bf16 v[80:83], a[92:95], a[28:31], v[80:83]
v_exp_f32 v9, v57
v_mfma_f32_16x16x32_bf16 v[84:87], a[64:67], a[32:35], v[20:23]
ds_read_b128 a[112:115], v4 offset:28672
v_add_f32 v26, v26, v9
v_mfma_f32_16x16x32_bf16 v[84:87], a[68:71], a[36:39], v[84:87]
v_exp_f32 v10, v58
v_mfma_f32_16x16x32_bf16 v[84:87], a[72:75], a[40:43], v[84:87]
ds_read_b128 a[116:119], v4 offset:29696
v_cvt_pk_bf16_f32 v102, v8, v9
v_mfma_f32_16x16x32_bf16 v[84:87], a[76:79], a[44:47], v[84:87]
v_exp_f32 v11, v59
v_mfma_f32_16x16x32_bf16 v[84:87], a[80:83], a[48:51], v[84:87]
ds_read_b128 a[120:123], v4 offset:30720
v_add_f32 v26, v26, v10
v_mfma_f32_16x16x32_bf16 v[84:87], a[84:87], a[52:55], v[84:87]
v_add_f32 v26, v26, v11
v_cvt_pk_bf16_f32 v103, v10, v11
v_mfma_f32_16x16x32_bf16 v[84:87], a[88:91], a[56:59], v[84:87]
s_waitcnt vmcnt(8) lgkmcnt(4)
ds_read_b128 a[124:127], v4 offset:31744
v_mfma_f32_16x16x32_bf16 v[84:87], a[92:95], a[60:63], v[84:87]
s_barrier
v_mfma_f32_16x16x32_bf16 v[88:91], a[96:99], a[0:3], v[16:19]
ds_read_b128 a[64:67], v2 offset:0
v_mfma_f32_16x16x32_bf16 v[88:91], a[100:103], a[4:7], v[88:91]
v_exp_f32 v12, v60
v_mfma_f32_16x16x32_bf16 v[88:91], a[104:107], a[8:11], v[88:91]
s_waitcnt lgkmcnt(4)
ds_read_b128 a[68:71], v2 offset:1024
v_add_f32 v27, v27, v12
v_mfma_f32_16x16x32_bf16 v[88:91], a[108:111], a[12:15], v[88:91]
v_exp_f32 v13, v61
v_mfma_f32_16x16x32_bf16 v[88:91], a[112:115], a[16:19], v[88:91]
s_waitcnt lgkmcnt(4)
ds_read_b128 a[72:75], v2 offset:2048
v_add_f32 v27, v27, v13
v_mfma_f32_16x16x32_bf16 v[88:91], a[116:119], a[20:23], v[88:91]
s_waitcnt lgkmcnt(4)
v_exp_f32 v14, v62
v_mfma_f32_16x16x32_bf16 v[88:91], a[120:123], a[24:27], v[88:91]
s_waitcnt lgkmcnt(3)
ds_read_b128 a[76:79], v2 offset:3072
v_cvt_pk_bf16_f32 v110, v12, v13
v_mfma_f32_16x16x32_bf16 v[88:91], a[124:127], a[28:31], v[88:91]
v_exp_f32 v15, v63
v_mfma_f32_16x16x32_bf16 v[92:95], a[96:99], a[32:35], v[20:23]
s_sub_u32 s19, s19, 1
ds_read_b128 a[80:83], v2 offset:4096
v_add_f32 v27, v27, v14
v_mfma_f32_16x16x32_bf16 v[92:95], a[100:103], a[36:39], v[92:95]
v_add_f32 v27, v27, v15
v_cvt_pk_bf16_f32 v111, v14, v15
v_mfma_f32_16x16x32_bf16 v[92:95], a[104:107], a[40:43], v[92:95]
ds_read_b128 a[84:87], v2 offset:5120
v_add_f32 v28, v26, v27
v_mfma_f32_16x16x32_bf16 v[92:95], a[108:111], a[44:47], v[92:95]
v_cmp_nge_f32 vcc, s25, v28
v_mfma_f32_16x16x32_bf16 v[92:95], a[112:115], a[48:51], v[92:95]
s_cmp_eq_u64 vcc, 0
ds_read_b128 a[88:91], v2 offset:6144
v_mfma_f32_16x16x32_bf16 v[92:95], a[116:119], a[52:55], v[92:95]
s_cselect_b32 s22, s19, 0
v_mfma_f32_16x16x32_bf16 v[92:95], a[120:123], a[56:59], v[92:95]
s_cmp_eq_u32 s22, 0
ds_read_b128 a[92:95], v2 offset:7168
v_mfma_f32_16x16x32_bf16 v[92:95], a[124:127], a[60:63], v[92:95]
s_waitcnt lgkmcnt(4)
s_cbranch_scc1 K2_xexit
K2_loop:
v_mfma_f32_16x16x32_bf16 v[128:131], a[64:67], v[96:99], v[128:131]
s_add_u32 m0, s18, 98304
ds_read_b128 a[96:99], v2 offset:8192
v_add_f32 v24, v24, v26
v_mfma_f32_16x16x32_bf16 v[128:131], a[68:71], v[100:103], v[128:131]
buffer_load_dwordx4 v1, s[4:7], s12 offen offset:0 sc1 lds
v_mfma_f32_16x16x32_bf16 v[132:135], a[68:71], v[108:111], v[132:135]
ds_read_b128 a[100:103], v2 offset:9216
v_add_f32 v25, v25, v27
v_mfma_f32_16x16x32_bf16 v[132:135], a[64:67], v[104:107], v[132:135]
v_exp_f32 v8, v64
v_mfma_f32_16x16x32_bf16 v[136:139], a[72:75], v[96:99], v[136:139]
ds_read_b128 a[104:107], v2 offset:10240
v_mfma_f32_16x16x32_bf16 v[136:139], a[76:79], v[100:103], v[136:139]
buffer_load_dwordx4 v1, s[4:7], s12 offen offset:1024 sc1 lds
v_mfma_f32_16x16x32_bf16 v[140:143], a[76:79], v[108:111], v[140:143]
ds_read_b128 a[108:111], v2 offset:11264
v_mfma_f32_16x16x32_bf16 v[140:143], a[72:75], v[104:107], v[140:143]
s_waitcnt lgkmcnt(4)
v_exp_f32 v9, v65
v_mfma_f32_16x16x32_bf16 v[144:147], a[80:83], v[96:99], v[144:147]
PAD_10:
s_cbranch_execz M_tret
ds_read_b128 a[112:115], v2 offset:12288
v_add_f32 v26, v8, v9
v_mfma_f32_16x16x32_bf16 v[144:147], a[84:87], v[100:103], v[144:147]
buffer_load_dwordx4 v1, s[4:7], s12 offen offset:2048 sc1 lds
v_mfma_f32_16x16x32_bf16 v[148:151], a[84:87], v[108:111], v[148:151]
ds_read_b128 a[116:119], v2 offset:13312
v_cvt_pk_bf16_f32 v112, v8, v9
v_mfma_f32_16x16x32_bf16 v[148:151], a[80:83], v[104:107], v[148:151]
v_exp_f32 v10, v66
v_mfma_f32_16x16x32_bf16 v[152:155], a[88:91], v[96:99], v[152:155]
ds_read_b128 a[120:123], v2 offset:14336
v_add_f32 v26, v26, v10
v_mfma_f32_16x16x32_bf16 v[152:155], a[92:95], v[100:103], v[152:155]
buffer_load_dwordx4 v1, s[4:7], s12 offen offset:3072 sc1 lds
v_mfma_f32_16x16x32_bf16 v[156:159], a[92:95], v[108:111], v[156:159]
s_add_u32 s12, s12, 4096
ds_read_b128 a[124:127], v2 offset:15360
v_mfma_f32_16x16x32_bf16 v[156:159], a[88:91], v[104:107], v[156:159]
s_waitcnt lgkmcnt(4)
v_exp_f32 v11, v67
v_mfma_f32_16x16x32_bf16 v[160:163], a[96:99], v[96:99], v[160:163]
s_add_u32 m0, s18, 102400
ds_read_b128 a[64:67], v2 offset:16384
v_add_f32 v26, v26, v11
v_mfma_f32_16x16x32_bf16 v[160:163], a[100:103], v[100:103], v[160:163]
buffer_load_dwordx4 v1, s[4:7], s12 offen offset:0 sc1 lds
v_mfma_f32_16x16x32_bf16 v[164:167], a[100:103], v[108:111], v[164:167]
ds_read_b128 a[68:71], v2 offset:17408
v_cvt_pk_bf16_f32 v113, v10, v11
v_mfma_f32_16x16x32_bf16 v[164:167], a[96:99], v[104:107], v[164:167]
v_mfma_f32_16x16x32_bf16 v[168:171], a[104:107], v[96:99], v[168:171]
ds_read_b128 a[72:75], v2 offset:18432
v_mfma_f32_16x16x32_bf16 v[168:171], a[108:111], v[100:103], v[168:171]
buffer_load_dwordx4 v1, s[4:7], s12 offen offset:1024 sc1 lds
v_mfma_f32_16x16x32_bf16 v[172:175], a[108:111], v[108:111], v[172:175]
ds_read_b128 a[76:79], v2 offset:19456
v_mfma_f32_16x16x32_bf16 v[172:175], a[104:107], v[104:107], v[172:175]
s_waitcnt lgkmcnt(4)
v_exp_f32 v12, v68
v_mfma_f32_16x16x32_bf16 v[176:179], a[112:115], v[96:99], v[176:179]
ds_read_b128 a[80:83], v2 offset:20480
v_mfma_f32_16x16x32_bf16 v[176:179], a[116:119], v[100:103], v[176:179]
buffer_load_dwordx4 v1, s[4:7], s12 offen offset:2048 sc1 lds
v_mfma_f32_16x16x32_bf16 v[180:183], a[116:119], v[108:111], v[180:183]
ds_read_b128 a[84:87], v2 offset:21504
v_mfma_f32_16x16x32_bf16 v[180:183], a[112:115], v[104:107], v[180:183]
v_exp_f32 v13, v69
v_mfma_f32_16x16x32_bf16 v[184:187], a[120:123], v[96:99], v[184:187]
ds_read_b128 a[88:91], v2 offset:22528
v_add_f32 v27, v12, v13
v_mfma_f32_16x16x32_bf16 v[184:187], a[124:127], v[100:103], v[184:187]
s_waitcnt lgkmcnt(4)
buffer_load_dwordx4 v1, s[4:7], s12 offen offset:3072 sc1 lds
v_mfma_f32_16x16x32_bf16 v[188:191], a[124:127], v[108:111], v[188:191]
s_add_u32 s12, s12, 28672
ds_read_b128 a[92:95], v2 offset:23552
v_cvt_pk_bf16_f32 v120, v12, v13
v_mfma_f32_16x16x32_bf16 v[188:191], a[120:123], v[104:107], v[188:191]
s_sub_u32 s13, s13, 1
v_exp_f32 v14, v70
v_mfma_f32_16x16x32_bf16 v[192:195], a[64:67], v[96:99], v[192:195]
s_cmp_eq_u32 s13, 0
ds_read_b128 a[96:99], v2 offset:24576
v_add_f32 v27, v27, v14
v_mfma_f32_16x16x32_bf16 v[192:195], a[68:71], v[100:103], v[192:195]
s_cselect_b32 s12, s14, s12
v_mfma_f32_16x16x32_bf16 v[196:199], a[68:71], v[108:111], v[196:199]
s_cselect_b32 s13, s15, s13
ds_read_b128 a[100:103], v2 offset:25600
v_mfma_f32_16x16x32_bf16 v[196:199], a[64:67], v[104:107], v[196:199]
s_cselect_b32 s14, 3221225472, s14
v_exp_f32 v15, v71
v_mfma_f32_16x16x32_bf16 v[200:203], a[72:75], v[96:99], v[200:203]
s_waitcnt lgkmcnt(4)
ds_read_b128 a[104:107], v2 offset:26624
v_add_f32 v27, v27, v15
v_mfma_f32_16x16x32_bf16 v[200:203], a[76:79], v[100:103], v[200:203]
v_exp_f32 v8, v72
v_mfma_f32_16x16x32_bf16 v[204:207], a[76:79], v[108:111], v[204:207]
ds_read_b128 a[108:111], v2 offset:27648
v_cvt_pk_bf16_f32 v121, v14, v15
v_mfma_f32_16x16x32_bf16 v[204:207], a[72:75], v[104:107], v[204:207]
v_exp_f32 v9, v73
v_mfma_f32_16x16x32_bf16 v[208:211], a[80:83], v[96:99], v[208:211]
ds_read_b128 a[112:115], v2 offset:28672
v_add_f32 v26, v26, v8
v_mfma_f32_16x16x32_bf16 v[208:211], a[84:87], v[100:103], v[208:211]
v_add_f32 v26, v26, v9
v_cvt_pk_bf16_f32 v114, v8, v9
v_mfma_f32_16x16x32_bf16 v[212:215], a[84:87], v[108:111], v[212:215]
ds_read_b128 a[116:119], v2 offset:29696
v_mfma_f32_16x16x32_bf16 v[212:215], a[80:83], v[104:107], v[212:215]
s_waitcnt lgkmcnt(4)
v_exp_f32 v10, v74
v_mfma_f32_16x16x32_bf16 v[216:219], a[88:91], v[96:99], v[216:219]
ds_read_b128 a[120:123], v2 offset:30720
v_add_f32 v26, v26, v10
v_mfma_f32_16x16x32_bf16 v[216:219], a[92:95], v[100:103], v[216:219]
v_exp_f32 v11, v75
v_mfma_f32_16x16x32_bf16 v[220:223], a[92:95], v[108:111], v[220:223]
s_waitcnt vmcnt(8)
ds_read_b128 a[124:127], v2 offset:31744
v_add_f32 v26, v26, v11
v_mfma_f32_16x16x32_bf16 v[220:223], a[88:91], v[104:107], v[220:223]
s_barrier
v_mfma_f32_16x16x32_bf16 v[224:227], a[96:99], v[96:99], v[224:227]
ds_read_b128 a[64:67], v1 offset:0
v_cvt_pk_bf16_f32 v115, v10, v11
v_mfma_f32_16x16x32_bf16 v[224:227], a[100:103], v[100:103], v[224:227]
v_exp_f32 v12, v76
v_mfma_f32_16x16x32_bf16 v[228:231], a[100:103], v[108:111], v[228:231]
ds_read_b128 a[68:71], v1 offset:1024
v_add_f32 v27, v27, v12
v_mfma_f32_16x16x32_bf16 v[228:231], a[96:99], v[104:107], v[228:231]
s_waitcnt lgkmcnt(4)
v_mfma_f32_16x16x32_bf16 v[232:235], a[104:107], v[96:99], v[232:235]
ds_read_b128 a[72:75], v1 offset:2048
v_mfma_f32_16x16x32_bf16 v[232:235], a[108:111], v[100:103], v[232:235]
v_exp_f32 v13, v77
v_mfma_f32_16x16x32_bf16 v[236:239], a[108:111], v[108:111], v[236:239]
ds_read_b128 a[76:79], v1 offset:3072
v_add_f32 v27, v27, v13
v_mfma_f32_16x16x32_bf16 v[236:239], a[104:107], v[104:107], v[236:239]
v_exp_f32 v14, v78
v_mfma_f32_16x16x32_bf16 v[240:243], a[112:115], v[96:99], v[240:243]
ds_read_b128 a[80:83], v1 offset:4096
v_cvt_pk_bf16_f32 v122, v12, v13
v_mfma_f32_16x16x32_bf16 v[240:243], a[116:119], v[100:103], v[240:243]
v_exp_f32 v15, v79
v_mfma_f32_16x16x32_bf16 v[244:247], a[116:119], v[108:111], v[244:247]
ds_read_b128 a[84:87], v1 offset:5120
v_add_f32 v27, v27, v14
v_mfma_f32_16x16x32_bf16 v[244:247], a[112:115], v[104:107], v[244:247]
s_waitcnt lgkmcnt(4)
v_add_f32 v27, v27, v15
v_cvt_pk_bf16_f32 v123, v14, v15
v_mfma_f32_16x16x32_bf16 v[248:251], a[120:123], v[96:99], v[248:251]
ds_read_b128 a[88:91], v1 offset:6144
v_mfma_f32_16x16x32_bf16 v[248:251], a[124:127], v[100:103], v[248:251]
v_mfma_f32_16x16x32_bf16 v[252:255], a[124:127], v[108:111], v[252:255]
ds_read_b128 a[92:95], v1 offset:7168
v_mfma_f32_16x16x32_bf16 v[252:255], a[120:123], v[104:107], v[252:255]
K2_x0:
v_mfma_f32_16x16x32_bf16 v[32:35], a[64:67], a[0:3], v[16:19]
s_add_u32 m0, s18, 131072
ds_read_b128 a[96:99], v1 offset:8192
v_mfma_f32_16x16x32_bf16 v[32:35], a[68:71], a[4:7], v[32:35]
s_waitcnt lgkmcnt(4)
buffer_load_dwordx4 v1, s[4:7], s8 offen offset:0 sc1 lds
v_mfma_f32_16x16x32_bf16 v[32:35], a[72:75], a[8:11], v[32:35]
ds_read_b128 a[100:103], v1 offset:9216
v_mfma_f32_16x16x32_bf16 v[32:35], a[76:79], a[12:15], v[32:35]
v_exp_f32 v8, v80
v_mfma_f32_16x16x32_bf16 v[32:35], a[80:83], a[16:19], v[32:35]
s_waitcnt lgkmcnt(4)
ds_read_b128 a[104:107], v1 offset:10240
v_add_f32 v26, v26, v8
v_mfma_f32_16x16x32_bf16 v[32:35], a[84:87], a[20:23], v[32:35]
s_waitcnt lgkmcnt(4)
buffer_load_dwordx4 v1, s[4:7], s8 offen offset:1024 sc1 lds
v_mfma_f32_16x16x32_bf16 v[32:35], a[88:91], a[24:27], v[32:35]
s_waitcnt lgkmcnt(3)
ds_read_b128 a[108:111], v1 offset:11264
v_mfma_f32_16x16x32_bf16 v[32:35], a[92:95], a[28:31], v[32:35]
v_exp_f32 v9, v81
v_mfma_f32_16x16x32_bf16 v[36:39], a[64:67], a[32:35], v[20:23]
ds_read_b128 a[112:115], v1 offset:12288
v_add_f32 v26, v26, v9
v_mfma_f32_16x16x32_bf16 v[36:39], a[68:71], a[36:39], v[36:39]
buffer_load_dwordx4 v1, s[4:7], s8 offen offset:2048 sc1 lds
v_mfma_f32_16x16x32_bf16 v[36:39], a[72:75], a[40:43], v[36:39]
ds_read_b128 a[116:119], v1 offset:13312
v_cvt_pk_bf16_f32 v116, v8, v9
v_mfma_f32_16x16x32_bf16 v[36:39], a[76:79], a[44:47], v[36:39]
v_exp_f32 v10, v82
v_mfma_f32_16x16x32_bf16 v[36:39], a[80:83], a[48:51], v[36:39]
ds_read_b128 a[120:123], v1 offset:14336
v_add_f32 v26, v26, v10
v_mfma_f32_16x16x32_bf16 v[36:39], a[84:87], a[52:55], v[36:39]
buffer_load_dwordx4 v1, s[4:7], s8 offen offset:3072 sc1 lds
v_mfma_f32_16x16x32_bf16 v[36:39], a[88:91], a[56:59], v[36:39]
s_add_u32 s8, s8, 4096
ds_read_b128 a[124:127], v1 offset:15360
v_mfma_f32_16x16x32_bf16 v[36:39], a[92:95], a[60:63], v[36:39]
s_waitcnt lgkmcnt(4)
v_exp_f32 v11, v83
v_mfma_f32_16x16x32_bf16 v[40:43], a[96:99], a[0:3], v[16:19]
s_add_u32 m0, s18, 135168
ds_read_b128 a[64:67], v1 offset:16384
v_add_f32 v26, v26, v11
v_mfma_f32_16x16x32_bf16 v[40:43], a[100:103], a[4:7], v[40:43]
buffer_load_dwordx4 v1, s[4:7], s8 offen offset:0 sc1 lds
v_mfma_f32_16x16x32_bf16 v[40:43], a[104:107], a[8:11], v[40:43]
ds_read_b128 a[68:71], v1 offset:17408
v_cvt_pk_bf16_f32 v117, v10, v11
v_mfma_f32_16x16x32_bf16 v[40:43], a[108:111], a[12:15], v[40:43]
s_waitcnt lgkmcnt(4)
v_mfma_f32_16x16x32_bf16 v[40:43], a[112:115], a[16:19], v[40:43]
ds_read_b128 a[72:75], v1 offset:18432
v_mfma_f32_16x16x32_bf16 v[40:43], a[116:119], a[20:23], v[40:43]
s_waitcnt lgkmcnt(4)
buffer_load_dwordx4 v1, s[4:7], s8 offen offset:1024 sc1 lds
v_mfma_f32_16x16x32_bf16 v[40:43], a[120:123], a[24:27], v[40:43]
s_waitcnt lgkmcnt(3)
ds_read_b128 a[76:79], v1 offset:19456
v_mfma_f32_16x16x32_bf16 v[40:43], a[124:127], a[28:31], v[40:43]
v_exp_f32 v12, v84
v_mfma_f32_16x16x32_bf16 v[44:47], a[96:99], a[32:35], v[20:23]
ds_read_b128 a[80:83], v1 offset:20480
v_add_f32 v27, v27, v12
v_mfma_f32_16x16x32_bf16 v[44:47], a[100:103], a[36:39], v[44:47]
buffer_load_dwordx4 v1, s[4:7], s8 offen offset:2048 sc1 lds
v_mfma_f32_16x16x32_bf16 v[44:47], a[104:107], a[40:43], v[44:47]
ds_read_b128 a[84:87], v1 offset:21504
v_mfma_f32_16x16x32_bf16 v[44:47], a[108:111], a[44:47], v[44:47]
v_exp_f32 v13, v85
v_mfma_f32_16x16x32_bf16 v[44:47], a[112:115], a[48:51], v[44:47]
ds_read_b128 a[88:91], v1 offset:22528
v_add_f32 v27, v27, v13
v_mfma_f32_16x16x32_bf16 v[44:47], a[116:119], a[52:55], v[44:47]
s_waitcnt lgkmcnt(3)
buffer_load_dwordx4 v1, s[4:7], s8 offen offset:3072 sc1 lds
v_mfma_f32_16x16x32_bf16 v[44:47], a[120:123], a[56:59], v[44:47]
s_add_u32 s8, s8, 28672
ds_read_b128 a[92:95], v1 offset:23552
v_cvt_pk_bf16_f32 v124, v12, v13
v_mfma_f32_16x16x32_bf16 v[44:47], a[124:127], a[60:63], v[44:47]
s_sub_u32 s9, s9, 1
v_exp_f32 v14, v86
v_mfma_f32_16x16x32_bf16 v[48:51], a[64:67], a[0:3], v[16:19]
s_cmp_eq_u32 s9, 0
ds_read_b128 a[96:99], v1 offset:24576
v_add_f32 v27, v27, v14
v_mfma_f32_16x16x32_bf16 v[48:51], a[68:71], a[4:7], v[48:51]
s_cselect_b32 s8, s10, s8
v_exp_f32 v15, v87
v_mfma_f32_16x16x32_bf16 v[48:51], a[72:75], a[8:11], v[48:51]
s_cselect_b32 s9, s11, s9
ds_read_b128 a[100:103], v1 offset:25600
v_add_f32 v27, v27, v15
v_mfma_f32_16x16x32_bf16 v[48:51], a[76:79], a[12:15], v[48:51]
s_waitcnt lgkmcnt(4)
s_cselect_b32 s10, 3221225472, s10
v_cvt_pk_bf16_f32 v125, v14, v15
v_mfma_f32_16x16x32_bf16 v[48:51], a[80:83], a[16:19], v[48:51]
ds_read_b128 a[104:107], v1 offset:26624
v_mfma_f32_16x16x32_bf16 v[48:51], a[84:87], a[20:23], v[48:51]
s_waitcnt lgkmcnt(4)
v_exp_f32 v8, v88
v_mfma_f32_16x16x32_bf16 v[48:51], a[88:91], a[24:27], v[48:51]
s_waitcnt lgkmcnt(3)
ds_read_b128 a[108:111], v1 offset:27648
v_add_f32 v26, v26, v8
v_mfma_f32_16x16x32_bf16 v[48:51], a[92:95], a[28:31], v[48:51]
v_exp_f32 v9, v89
v_mfma_f32_16x16x32_bf16 v[52:55], a[64:67], a[32:35], v[20:23]
ds_read_b128 a[112:115], v1 offset:28672
v_add_f32 v26, v26, v9
v_mfma_f32_16x16x32_bf16 v[52:55], a[68:71], a[36:39], v[52:55]
v_exp_f32 v10, v90
v_mfma_f32_16x16x32_bf16 v[52:55], a[72:75], a[40:43], v[52:55]
ds_read_b128 a[116:119], v1 offset:29696
v_cvt_pk_bf16_f32 v118, v8, v9
v_mfma_f32_16x16x32_bf16 v[52:55], a[76:79], a[44:47], v[52:55]
v_exp_f32 v11, v91
v_mfma_f32_16x16x32_bf16 v[52:55], a[80:83], a[48:51], v[52:55]
ds_read_b128 a[120:123], v1 offset:30720
v_add_f32 v26, v26, v10
v_mfma_f32_16x16x32_bf16 v[52:55], a[84:87], a[52:55], v[52:55]
v_add_f32 v26, v26, v11
v_cvt_pk_bf16_f32 v119, v10, v11
v_mfma_f32_16x16x32_bf16 v[52:55], a[88:91], a[56:59], v[52:55]
s_waitcnt vmcnt(8) lgkmcnt(4)
ds_read_b128 a[124:127], v1 offset:31744
v_mfma_f32_16x16x32_bf16 v[52:55], a[92:95], a[60:63], v[52:55]
s_barrier
v_mfma_f32_16x16x32_bf16 v[56:59], a[96:99], a[0:3], v[16:19]
ds_read_b128 a[64:67], v2 offset:32768
v_mfma_f32_16x16x32_bf16 v[56:59], a[100:103], a[4:7], v[56:59]
v_exp_f32 v12, v92
v_mfma_f32_16x16x32_bf16 v[56:59], a[104:107], a[8:11], v[56:59]
s_waitcnt lgkmcnt(4)
ds_read_b128 a[68:71], v2 offset:33792
v_add_f32 v27, v27, v12
v_mfma_f32_16x16x32_bf16 v[56:59], a[108:111], a[12:15], v[56:59]
v_exp_f32 v13, v93
v_mfma_f32_16x16x32_bf16 v[56:59], a[112:115], a[16:19], v[56:59]
s_waitcnt lgkmcnt(4)
ds_read_b128 a[72:75], v2 offset:34816
v_add_f32 v27, v27, v13
v_mfma_f32_16x16x32_bf16 v[56:59], a[116:119], a[20:23], v[56:59]
s_waitcnt lgkmcnt(4)
v_exp_f32 v14, v94
v_mfma_f32_16x16x32_bf16 v[56:59], a[120:123], a[24:27], v[56:59]
s_waitcnt lgkmcnt(3)
ds_read_b128 a[76:79], v2 offset:35840
v_cvt_pk_bf16_f32 v126, v12, v13
v_mfma_f32_16x16x32_bf16 v[56:59], a[124:127], a[28:31], v[56:59]
v_exp_f32 v15, v95
v_mfma_f32_16x16x32_bf16 v[60:63], a[96:99], a[32:35], v[20:23]
ds_read_b128 a[80:83], v2 offset:36864
v_add_f32 v27, v27, v14
v_mfma_f32_16x16x32_bf16 v[60:63], a[100:103], a[36:39], v[60:63]
v_add_f32 v27, v27, v15
v_cvt_pk_bf16_f32 v127, v14, v15
v_mfma_f32_16x16x32_bf16 v[60:63], a[104:107], a[40:43], v[60:63]
ds_read_b128 a[84:87], v2 offset:37888
v_add_f32 v28, v26, v27
v_mfma_f32_16x16x32_bf16 v[60:63], a[108:111], a[44:47], v[60:63]
v_cmp_nge_f32 vcc, s25, v28
v_mfma_f32_16x16x32_bf16 v[60:63], a[112:115], a[48:51], v[60:63]
ds_read_b128 a[88:91], v2 offset:38912
v_mfma_f32_16x16x32_bf16 v[60:63], a[116:119], a[52:55], v[60:63]
v_mfma_f32_16x16x32_bf16 v[60:63], a[120:123], a[56:59], v[60:63]
ds_read_b128 a[92:95], v2 offset:39936
v_mfma_f32_16x16x32_bf16 v[60:63], a[124:127], a[60:63], v[60:63]
s_waitcnt lgkmcnt(4)
s_cbranch_vccnz Lstub_2
Lback_3:
v_mfma_f32_16x16x32_bf16 v[128:131], a[64:67], v[112:115], v[128:131]
s_add_u32 m0, s18, 65536
ds_read_b128 a[96:99], v2 offset:40960
v_add_f32 v24, v24, v26
v_mfma_f32_16x16x32_bf16 v[128:131], a[68:71], v[116:119], v[128:131]
buffer_load_dwordx4 v1, s[4:7], s12 offen offset:0 sc1 lds
v_mfma_f32_16x16x32_bf16 v[132:135], a[68:71], v[124:127], v[132:135]
ds_read_b128 a[100:103], v2 offset:41984
v_add_f32 v25, v25, v27
v_mfma_f32_16x16x32_bf16 v[132:135], a[64:67], v[120:123], v[132:135]
v_exp_f32 v8, v32
v_mfma_f32_16x16x32_bf16 v[136:139], a[72:75], v[112:115], v[136:139]
ds_read_b128 a[104:107], v2 offset:43008
v_mfma_f32_16x16x32_bf16 v[136:139], a[76:79], v[116:119], v[136:139]
buffer_load_dwordx4 v1, s[4:7], s12 offen offset:1024 sc1 lds
v_mfma_f32_16x16x32_bf16 v[140:143], a[76:79], v[124:127], v[140:143]
ds_read_b128 a[108:111], v2 offset:44032
v_mfma_f32_16x16x32_bf16 v[140:143], a[72:75], v[120:123], v[140:143]
s_waitcnt lgkmcnt(4)
v_exp_f32 v9, v33
v_mfma_f32_16x16x32_bf16 v[144:147], a[80:83], v[112:115], v[144:147]
ds_read_b128 a[112:115], v2 offset:45056
v_add_f32 v26, v8, v9
v_mfma_f32_16x16x32_bf16 v[144:147], a[84:87], v[116:119], v[144:147]
buffer_load_dwordx4 v1, s[4:7], s12 offen offset:2048 sc1 lds
v_mfma_f32_16x16x32_bf16 v[148:151], a[84:87], v[124:127], v[148:151]
ds_read_b128 a[116:119], v2 offset:46080
v_cvt_pk_bf16_f32 v96, v8, v9
v_mfma_f32_16x16x32_bf16 v[148:151], a[80:83], v[120:123], v[148:151]
v_exp_f32 v10, v34
v_mfma_f32_16x16x32_bf16 v[152:155], a[88:91], v[112:115], v[152:155]
ds_read_b128 a[120:123], v2 offset:47104
v_add_f32 v26, v26, v10
v_mfma_f32_16x16x32_bf16 v[152:155], a[92:95], v[116:119], v[152:155]
buffer_load_dwordx4 v1, s[4:7], s12 offen offset:3072 sc1 lds
v_mfma_f32_16x16x32_bf16 v[156:159], a[92:95], v[124:127], v[156:159]
s_add_u32 s12, s12, 4096
ds_read_b128 a[124:127], v2 offset:48128
v_mfma_f32_16x16x32_bf16 v[156:159], a[88:91], v[120:123], v[156:159]
s_waitcnt lgkmcnt(4)
v_exp_f32 v11, v35
v_mfma_f32_16x16x32_bf16 v[160:163], a[96:99], v[112:115], v[160:163]
s_add_u32 m0, s18, 69632
ds_read_b128 a[64:67], v2 offset:49152
v_add_f32 v26, v26, v11
v_mfma_f32_16x16x32_bf16 v[160:163], a[100:103], v[116:119], v[160:163]
buffer_load_dwordx4 v1, s[4:7], s12 offen offset:0 sc1 lds
v_mfma_f32_16x16x32_bf16 v[164:167], a[100:103], v[124:127], v[164:167]
ds_read_b128 a[68:71], v2 offset:50176
v_cvt_pk_bf16_f32 v97, v10, v11
v_mfma_f32_16x16x32_bf16 v[164:167], a[96:99], v[120:123], v[164:167]
v_mfma_f32_16x16x32_bf16 v[168:171], a[104:107], v[112:115], v[168:171]
ds_read_b128 a[72:75], v2 offset:51200
v_mfma_f32_16x16x32_bf16 v[168:171], a[108:111], v[116:119], v[168:171]
buffer_load_dwordx4 v1, s[4:7], s12 offen offset:1024 sc1 lds
v_mfma_f32_16x16x32_bf16 v[172:175], a[108:111], v[124:127], v[172:175]
ds_read_b128 a[76:79], v2 offset:52224
v_mfma_f32_16x16x32_bf16 v[172:175], a[104:107], v[120:123], v[172:175]
s_waitcnt lgkmcnt(4)
v_exp_f32 v12, v36
v_mfma_f32_16x16x32_bf16 v[176:179], a[112:115], v[112:115], v[176:179]
ds_read_b128 a[80:83], v2 offset:53248
v_mfma_f32_16x16x32_bf16 v[176:179], a[116:119], v[116:119], v[176:179]
buffer_load_dwordx4 v1, s[4:7], s12 offen offset:2048 sc1 lds
v_mfma_f32_16x16x32_bf16 v[180:183], a[116:119], v[124:127], v[180:183]
ds_read_b128 a[84:87], v2 offset:54272
v_mfma_f32_16x16x32_bf16 v[180:183], a[112:115], v[120:123], v[180:183]
v_exp_f32 v13, v37
v_mfma_f32_16x16x32_bf16 v[184:187], a[120:123], v[112:115], v[184:187]
ds_read_b128 a[88:91], v2 offset:55296
v_add_f32 v27, v12, v13
v_mfma_f32_16x16x32_bf16 v[184:187], a[124:127], v[116:119], v[184:187]
s_waitcnt lgkmcnt(4)
buffer_load_dwordx4 v1, s[4:7], s12 offen offset:3072 sc1 lds
v_mfma_f32_16x16x32_bf16 v[188:191], a[124:127], v[124:127], v[188:191]
s_add_u32 s12, s12, 28672
ds_read_b128 a[92:95], v2 offset:56320
v_cvt_pk_bf16_f32 v104, v12, v13
v_mfma_f32_16x16x32_bf16 v[188:191], a[120:123], v[120:123], v[188:191]
s_sub_u32 s13, s13, 1
v_exp_f32 v14, v38
v_mfma_f32_16x16x32_bf16 v[192:195], a[64:67], v[112:115], v[192:195]
s_cmp_eq_u32 s13, 0
ds_read_b128 a[96:99], v2 offset:57344
v_add_f32 v27, v27, v14
v_mfma_f32_16x16x32_bf16 v[192:195], a[68:71], v[116:119], v[192:195]
s_cselect_b32 s12, s14, s12
v_mfma_f32_16x16x32_bf16 v[196:199], a[68:71], v[124:127], v[196:199]
s_cselect_b32 s13, s15, s13
ds_read_b128 a[100:103], v2 offset:58368
v_mfma_f32_16x16x32_bf16 v[196:199], a[64:67], v[120:123], v[196:199]
s_cselect_b32 s14, 3221225472, s14
v_exp_f32 v15, v39
v_mfma_f32_16x16x32_bf16 v[200:203], a[72:75], v[112:115], v[200:203]
s_waitcnt lgkmcnt(4)
ds_read_b128 a[104:107], v2 offset:59392
v_add_f32 v27, v27, v15
v_mfma_f32_16x16x32_bf16 v[200:203], a[76:79], v[116:119], v[200:203]
v_exp_f32 v8, v40
v_mfma_f32_16x16x32_bf16 v[204:207], a[76:79], v[124:127], v[204:207]
ds_read_b128 a[108:111], v2 offset:60416
v_cvt_pk_bf16_f32 v105, v14, v15
v_mfma_f32_16x16x32_bf16 v[204:207], a[72:75], v[120:123], v[204:207]
v_exp_f32 v9, v41
v_mfma_f32_16x16x32_bf16 v[208:211], a[80:83], v[112:115], v[208:211]
ds_read_b128 a[112:115], v2 offset:61440
v_add_f32 v26, v26, v8
v_mfma_f32_16x16x32_bf16 v[208:211], a[84:87], v[116:119], v[208:211]
v_add_f32 v26, v26, v9
v_cvt_pk_bf16_f32 v98, v8, v9
v_mfma_f32_16x16x32_bf16 v[212:215], a[84:87], v[124:127], v[212:215]
ds_read_b128 a[116:119], v2 offset:62464
v_mfma_f32_16x16x32_bf16 v[212:215], a[80:83], v[120:123], v[212:215]
s_waitcnt lgkmcnt(4)
v_exp_f32 v10, v42
v_mfma_f32_16x16x32_bf16 v[216:219], a[88:91], v[112:115], v[216:219]
ds_read_b128 a[120:123], v2 offset:63488
v_add_f32 v26, v26, v10
v_mfma_f32_16x16x32_bf16 v[216:219], a[92:95], v[116:119], v[216:219]
v_exp_f32 v11, v43
v_mfma_f32_16x16x32_bf16 v[220:223], a[92:95], v[124:127], v[220:223]
s_waitcnt vmcnt(8)
ds_read_b128 a[124:127], v2 offset:64512
v_add_f32 v26, v26, v11
v_mfma_f32_16x16x32_bf16 v[220:223], a[88:91], v[120:123], v[220:223]
s_barrier
v_mfma_f32_16x16x32_bf16 v[224:227], a[96:99], v[112:115], v[224:227]
ds_read_b128 a[64:67], v4 offset:0
v_cvt_pk_bf16_f32 v99, v10, v11
v_mfma_f32_16x16x32_bf16 v[224:227], a[100:103], v[116:119], v[224:227]
v_exp_f32 v12, v44
v_mfma_f32_16x16x32_bf16 v[228:231], a[100:103], v[124:127], v[228:231]
ds_read_b128 a[68:71], v4 offset:1024
v_add_f32 v27, v27, v12
v_mfma_f32_16x16x32_bf16 v[228:231], a[96:99], v[120:123], v[228:231]
s_waitcnt lgkmcnt(4)
v_mfma_f32_16x16x32_bf16 v[232:235], a[104:107], v[112:115], v[232:235]
ds_read_b128 a[72:75], v4 offset:2048
v_mfma_f32_16x16x32_bf16 v[232:235], a[108:111], v[116:119], v[232:235]
v_exp_f32 v13, v45
v_mfma_f32_16x16x32_bf16 v[236:239], a[108:111], v[124:127], v[236:239]
ds_read_b128 a[76:79], v4 offset:3072
v_add_f32 v27, v27, v13
v_mfma_f32_16x16x32_bf16 v[236:239], a[104:107], v[120:123], v[236:239]
v_exp_f32 v14, v46
v_mfma_f32_16x16x32_bf16 v[240:243], a[112:115], v[112:115], v[240:243]
ds_read_b128 a[80:83], v4 offset:4096
v_cvt_pk_bf16_f32 v106, v12, v13
v_mfma_f32_16x16x32_bf16 v[240:243], a[116:119], v[116:119], v[240:243]
v_exp_f32 v15, v47
v_mfma_f32_16x16x32_bf16 v[244:247], a[116:119], v[124:127], v[244:247]
ds_read_b128 a[84:87], v4 offset:5120
v_add_f32 v27, v27, v14
v_mfma_f32_16x16x32_bf16 v[244:247], a[112:115], v[120:123], v[244:247]
s_waitcnt lgkmcnt(4)
v_add_f32 v27, v27, v15
v_cvt_pk_bf16_f32 v107, v14, v15
v_mfma_f32_16x16x32_bf16 v[248:251], a[120:123], v[112:115], v[248:251]
ds_read_b128 a[88:91], v4 offset:6144
v_mfma_f32_16x16x32_bf16 v[248:251], a[124:127], v[116:119], v[248:251]
v_mfma_f32_16x16x32_bf16 v[252:255], a[124:127], v[124:127], v[252:255]
s_waitcnt lgkmcnt(5)
ds_read_b128 a[92:95], v4 offset:7168
v_mfma_f32_16x16x32_bf16 v[252:255], a[120:123], v[120:123], v[252:255]
s_branch K2_x1
K2_xexit:
s_cbranch_vccnz Lstub_4
Lback_5:
s_cmp_lg_u32 s19, 0
s_cbranch_scc1 K2_loop
s_cmp_eq_u32 s24, 2
s_cbranch_scc1 K2_ntail
v_mfma_f32_16x16x32_bf16 v[128:131], a[64:67], v[96:99], v[128:131]
s_add_u32 m0, s18, 98304
ds_read_b128 a[96:99], v2 offset:8192
v_add_f32 v24, v24, v26
v_mfma_f32_16x16x32_bf16 v[128:131], a[68:71], v[100:103], v[128:131]
buffer_load_dwordx4 v1, s[4:7], s12 offen offset:0 sc1 lds
v_mfma_f32_16x16x32_bf16 v[132:135], a[68:71], v[108:111], v[132:135]
ds_read_b128 a[100:103], v2 offset:9216
v_add_f32 v25, v25, v27
v_mfma_f32_16x16x32_bf16 v[132:135], a[64:67], v[104:107], v[132:135]
v_exp_f32 v8, v64
v_mfma_f32_16x16x32_bf16 v[136:139], a[72:75], v[96:99], v[136:139]
ds_read_b128 a[104:107], v2 offset:10240
v_mfma_f32_16x16x32_bf16 v[136:139], a[76:79], v[100:103], v[136:139]
buffer_load_dwordx4 v1, s[4:7], s12 offen offset:1024 sc1 lds
v_mfma_f32_16x16x32_bf16 v[140:143], a[76:79], v[108:111], v[140:143]
ds_read_b128 a[108:111], v2 offset:11264
v_mfma_f32_16x16x32_bf16 v[140:143], a[72:75], v[104:107], v[140:143]
s_waitcnt lgkmcnt(4)
v_exp_f32 v9, v65
v_mfma_f32_16x16x32_bf16 v[144:147], a[80:83], v[96:99], v[144:147]
ds_read_b128 a[112:115], v2 offset:12288
v_add_f32 v26, v8, v9
v_mfma_f32_16x16x32_bf16 v[144:147], a[84:87], v[100:103], v[144:147]
buffer_load_dwordx4 v1, s[4:7], s12 offen offset:2048 sc1 lds
v_mfma_f32_16x16x32_bf16 v[148:151], a[84:87], v[108:111], v[148:151]
ds_read_b128 a[116:119], v2 offset:13312
v_cvt_pk_bf16_f32 v112, v8, v9
v_mfma_f32_16x16x32_bf16 v[148:151], a[80:83], v[104:107], v[148:151]
v_exp_f32 v10, v66
v_mfma_f32_16x16x32_bf16 v[152:155], a[88:91], v[96:99], v[152:155]
ds_read_b128 a[120:123], v2 offset:14336
v_add_f32 v26, v26, v10
v_mfma_f32_16x16x32_bf16 v[152:155], a[92:95], v[100:103], v[152:155]
buffer_load_dwordx4 v1, s[4:7], s12 offen offset:3072 sc1 lds
v_mfma_f32_16x16x32_bf16 v[156:159], a[92:95], v[108:111], v[156:159]
s_add_u32 s12, s12, 4096
ds_read_b128 a[124:127], v2 offset:15360
v_mfma_f32_16x16x32_bf16 v[156:159], a[88:91], v[104:107], v[156:159]
s_waitcnt lgkmcnt(4)
v_exp_f32 v11, v67
v_mfma_f32_16x16x32_bf16 v[160:163], a[96:99], v[96:99], v[160:163]
s_add_u32 m0, s18, 102400
ds_read_b128 a[64:67], v2 offset:16384
v_add_f32 v26, v26, v11
v_mfma_f32_16x16x32_bf16 v[160:163], a[100:103], v[100:103], v[160:163]
buffer_load_dwordx4 v1, s[4:7], s12 offen offset:0 sc1 lds
v_mfma_f32_16x16x32_bf16 v[164:167], a[100:103], v[108:111], v[164:167]
ds_read_b128 a[68:71], v2 offset:17408
v_cvt_pk_bf16_f32 v113, v10, v11
v_mfma_f32_16x16x32_bf16 v[164:167], a[96:99], v[104:107], v[164:167]
v_mfma_f32_16x16x32_bf16 v[168:171], a[104:107], v[96:99], v[168:171]
ds_read_b128 a[72:75], v2 offset:18432
v_mfma_f32_16x16x32_bf16 v[168:171], a[108:111], v[100:103], v[168:171]
buffer_load_dwordx4 v1, s[4:7], s12 offen offset:1024 sc1 lds
v_mfma_f32_16x16x32_bf16 v[172:175], a[108:111], v[108:111], v[172:175]
ds_read_b128 a[76:79], v2 offset:19456
v_mfma_f32_16x16x32_bf16 v[172:175], a[104:107], v[104:107], v[172:175]
s_waitcnt lgkmcnt(4)
v_exp_f32 v12, v68
v_mfma_f32_16x16x32_bf16 v[176:179], a[112:115], v[96:99], v[176:179]
ds_read_b128 a[80:83], v2 offset:20480
v_mfma_f32_16x16x32_bf16 v[176:179], a[116:119], v[100:103], v[176:179]
buffer_load_dwordx4 v1, s[4:7], s12 offen offset:2048 sc1 lds
v_mfma_f32_16x16x32_bf16 v[180:183], a[116:119], v[108:111], v[180:183]
ds_read_b128 a[84:87], v2 offset:21504
v_mfma_f32_16x16x32_bf16 v[180:183], a[112:115], v[104:107], v[180:183]
v_exp_f32 v13, v69
v_mfma_f32_16x16x32_bf16 v[184:187], a[120:123], v[96:99], v[184:187]
ds_read_b128 a[88:91], v2 offset:22528
v_add_f32 v27, v12, v13
v_mfma_f32_16x16x32_bf16 v[184:187], a[124:127], v[100:103], v[184:187]
s_waitcnt lgkmcnt(4)
buffer_load_dwordx4 v1, s[4:7], s12 offen offset:3072 sc1 lds
v_mfma_f32_16x16x32_bf16 v[188:191], a[124:127], v[108:111], v[188:191]
s_add_u32 s12, s12, 28672
ds_read_b128 a[92:95], v2 offset:23552
v_cvt_pk_bf16_f32 v120, v12, v13
v_mfma_f32_16x16x32_bf16 v[188:191], a[120:123], v[104:107], v[188:191]
s_sub_u32 s13, s13, 1
v_exp_f32 v14, v70
v_mfma_f32_16x16x32_bf16 v[192:195], a[64:67], v[96:99], v[192:195]
s_cmp_eq_u32 s13, 0
ds_read_b128 a[96:99], v2 offset:24576
v_add_f32 v27, v27, v14
v_mfma_f32_16x16x32_bf16 v[192:195], a[68:71], v[100:103], v[192:195]
s_cselect_b32 s12, s14, s12
v_mfma_f32_16x16x32_bf16 v[196:199], a[68:71], v[108:111], v[196:199]
s_cselect_b32 s13, s15, s13
ds_read_b128 a[100:103], v2 offset:25600
v_mfma_f32_16x16x32_bf16 v[196:199], a[64:67], v[104:107], v[196:199]
s_cselect_b32 s14, 3221225472, s14
v_exp_f32 v15, v71
v_mfma_f32_16x16x32_bf16 v[200:203], a[72:75], v[96:99], v[200:203]
s_waitcnt lgkmcnt(4)
ds_read_b128 a[104:107], v2 offset:26624
v_add_f32 v27, v27, v15
v_mfma_f32_16x16x32_bf16 v[200:203], a[76:79], v[100:103], v[200:203]
v_exp_f32 v8, v72
v_mfma_f32_16x16x32_bf16 v[204:207], a[76:79], v[108:111], v[204:207]
ds_read_b128 a[108:111], v2 offset:27648
v_cvt_pk_bf16_f32 v121, v14, v15
v_mfma_f32_16x16x32_bf16 v[204:207], a[72:75], v[104:107], v[204:207]
v_exp_f32 v9, v73
v_mfma_f32_16x16x32_bf16 v[208:211], a[80:83], v[96:99], v[208:211]
ds_read_b128 a[112:115], v2 offset:28672
v_add_f32 v26, v26, v8
v_mfma_f32_16x16x32_bf16 v[208:211], a[84:87], v[100:103], v[208:211]
v_add_f32 v26, v26, v9
v_cvt_pk_bf16_f32 v114, v8, v9
v_mfma_f32_16x16x32_bf16 v[212:215], a[84:87], v[108:111], v[212:215]
ds_read_b128 a[116:119], v2 offset:29696
v_mfma_f32_16x16x32_bf16 v[212:215], a[80:83], v[104:107], v[212:215]
s_waitcnt lgkmcnt(4)
v_exp_f32 v10, v74
v_mfma_f32_16x16x32_bf16 v[216:219], a[88:91], v[96:99], v[216:219]
ds_read_b128 a[120:123], v2 offset:30720
v_add_f32 v26, v26, v10
v_mfma_f32_16x16x32_bf16 v[216:219], a[92:95], v[100:103], v[216:219]
v_exp_f32 v11, v75
v_mfma_f32_16x16x32_bf16 v[220:223], a[92:95], v[108:111], v[220:223]
s_waitcnt vmcnt(8)
ds_read_b128 a[124:127], v2 offset:31744
v_add_f32 v26, v26, v11
v_mfma_f32_16x16x32_bf16 v[220:223], a[88:91], v[104:107], v[220:223]
PAD_11:
s_cbranch_execz M_tret
s_barrier
v_mfma_f32_16x16x32_bf16 v[224:227], a[96:99], v[96:99], v[224:227]
ds_read_b128 a[64:67], v1 offset:0
v_cvt_pk_bf16_f32 v115, v10, v11
v_mfma_f32_16x16x32_bf16 v[224:227], a[100:103], v[100:103], v[224:227]
v_exp_f32 v12, v76
v_mfma_f32_16x16x32_bf16 v[228:231], a[100:103], v[108:111], v[228:231]
ds_read_b128 a[68:71], v1 offset:1024
v_add_f32 v27, v27, v12
v_mfma_f32_16x16x32_bf16 v[228:231], a[96:99], v[104:107], v[228:231]
s_waitcnt lgkmcnt(4)
v_mfma_f32_16x16x32_bf16 v[232:235], a[104:107], v[96:99], v[232:235]
ds_read_b128 a[72:75], v1 offset:2048
v_mfma_f32_16x16x32_bf16 v[232:235], a[108:111], v[100:103], v[232:235]
v_exp_f32 v13, v77
v_mfma_f32_16x16x32_bf16 v[236:239], a[108:111], v[108:111], v[236:239]
ds_read_b128 a[76:79], v1 offset:3072
v_add_f32 v27, v27, v13
v_mfma_f32_16x16x32_bf16 v[236:239], a[104:107], v[104:107], v[236:239]
v_exp_f32 v14, v78
v_mfma_f32_16x16x32_bf16 v[240:243], a[112:115], v[96:99], v[240:243]
ds_read_b128 a[80:83], v1 offset:4096
v_cvt_pk_bf16_f32 v122, v12, v13
v_mfma_f32_16x16x32_bf16 v[240:243], a[116:119], v[100:103], v[240:243]
v_exp_f32 v15, v79
v_mfma_f32_16x16x32_bf16 v[244:247], a[116:119], v[108:111], v[244:247]
ds_read_b128 a[84:87], v1 offset:5120
v_add_f32 v27, v27, v14
v_mfma_f32_16x16x32_bf16 v[244:247], a[112:115], v[104:107], v[244:247]
s_waitcnt lgkmcnt(4)
v_add_f32 v27, v27, v15
v_cvt_pk_bf16_f32 v123, v14, v15
v_mfma_f32_16x16x32_bf16 v[248:251], a[120:123], v[96:99], v[248:251]
ds_read_b128 a[88:91], v1 offset:6144
v_mfma_f32_16x16x32_bf16 v[248:251], a[124:127], v[100:103], v[248:251]
v_mfma_f32_16x16x32_bf16 v[252:255], a[124:127], v[108:111], v[252:255]
ds_read_b128 a[92:95], v1 offset:7168
v_mfma_f32_16x16x32_bf16 v[252:255], a[120:123], v[104:107], v[252:255]
v_cndmask_b32 v32, v16, v7, s[32:33]
v_cndmask_b32 v33, v16, v7, s[34:35]
v_cndmask_b32 v34, v16, v7, s[36:37]
v_cndmask_b32 v35, v16, v7, s[38:39]
s_nop 1
v_mfma_f32_16x16x32_bf16 v[32:35], a[64:67], a[0:3], v[32:35]
s_add_u32 m0, s18, 131072
ds_read_b128 a[96:99], v1 offset:8192
v_cndmask_b32 v40, v16, v7, s[40:41]
v_mfma_f32_16x16x32_bf16 v[32:35], a[68:71], a[4:7], v[32:35]
s_waitcnt lgkmcnt(4)
buffer_load_dwordx4 v1, s[4:7], s8 offen offset:0 sc1 lds
v_mfma_f32_16x16x32_bf16 v[32:35], a[72:75], a[8:11], v[32:35]
ds_read_b128 a[100:103], v1 offset:9216
v_cndmask_b32 v41, v16, v7, s[42:43]
v_mfma_f32_16x16x32_bf16 v[32:35], a[76:79], a[12:15], v[32:35]
v_cndmask_b32 v42, v16, v7, s[44:45]
v_cndmask_b32 v43, v16, v7, s[46:47]
v_mfma_f32_16x16x32_bf16 v[32:35], a[80:83], a[16:19], v[32:35]
s_waitcnt lgkmcnt(4)
ds_read_b128 a[104:107], v1 offset:10240
v_mfma_f32_16x16x32_bf16 v[32:35], a[84:87], a[20:23], v[32:35]
s_waitcnt lgkmcnt(4)
buffer_load_dwordx4 v1, s[4:7], s8 offen offset:1024 sc1 lds
v_mfma_f32_16x16x32_bf16 v[32:35], a[88:91], a[24:27], v[32:35]
s_waitcnt lgkmcnt(3)
ds_read_b128 a[108:111], v1 offset:11264
v_mfma_f32_16x16x32_bf16 v[32:35], a[92:95], a[28:31], v[32:35]
v_exp_f32 v8, v80
v_mfma_f32_16x16x32_bf16 v[36:39], a[64:67], a[32:35], v[20:23]
ds_read_b128 a[112:115], v1 offset:12288
v_add_f32 v26, v26, v8
v_mfma_f32_16x16x32_bf16 v[36:39], a[68:71], a[36:39], v[36:39]
buffer_load_dwordx4 v1, s[4:7], s8 offen offset:2048 sc1 lds
v_mfma_f32_16x16x32_bf16 v[36:39], a[72:75], a[40:43], v[36:39]
ds_read_b128 a[116:119], v1 offset:13312
v_mfma_f32_16x16x32_bf16 v[36:39], a[76:79], a[44:47], v[36:39]
v_exp_f32 v9, v81
v_mfma_f32_16x16x32_bf16 v[36:39], a[80:83], a[48:51], v[36:39]
ds_read_b128 a[120:123], v1 offset:14336
v_add_f32 v26, v26, v9
v_mfma_f32_16x16x32_bf16 v[36:39], a[84:87], a[52:55], v[36:39]
buffer_load_dwordx4 v1, s[4:7], s8 offen offset:3072 sc1 lds
v_mfma_f32_16x16x32_bf16 v[36:39], a[88:91], a[56:59], v[36:39]
s_add_u32 s8, s8, 4096
ds_read_b128 a[124:127], v1 offset:15360
v_cvt_pk_bf16_f32 v116, v8, v9
v_mfma_f32_16x16x32_bf16 v[36:39], a[92:95], a[60:63], v[36:39]
s_waitcnt lgkmcnt(4)
v_exp_f32 v10, v82
v_mfma_f32_16x16x32_bf16 v[40:43], a[96:99], a[0:3], v[40:43]
s_add_u32 m0, s18, 135168
ds_read_b128 a[64:67], v1 offset:16384
v_cndmask_b32 v48, v16, v7, s[48:49]
v_mfma_f32_16x16x32_bf16 v[40:43], a[100:103], a[4:7], v[40:43]
buffer_load_dwordx4 v1, s[4:7], s8 offen offset:0 sc1 lds
v_mfma_f32_16x16x32_bf16 v[40:43], a[104:107], a[8:11], v[40:43]
ds_read_b128 a[68:71], v1 offset:17408
v_cndmask_b32 v49, v16, v7, s[50:51]
v_mfma_f32_16x16x32_bf16 v[40:43], a[108:111], a[12:15], v[40:43]
s_waitcnt lgkmcnt(4)
v_cndmask_b32 v50, v16, v7, s[52:53]
v_cndmask_b32 v51, v16, v7, s[54:55]
v_mfma_f32_16x16x32_bf16 v[40:43], a[112:115], a[16:19], v[40:43]
ds_read_b128 a[72:75], v1 offset:18432
v_add_f32 v26, v26, v10
v_mfma_f32_16x16x32_bf16 v[40:43], a[116:119], a[20:23], v[40:43]
s_waitcnt lgkmcnt(4)
buffer_load_dwordx4 v1, s[4:7], s8 offen offset:1024 sc1 lds
v_mfma_f32_16x16x32_bf16 v[40:43], a[120:123], a[24:27], v[40:43]
s_waitcnt lgkmcnt(3)
ds_read_b128 a[76:79], v1 offset:19456
v_mfma_f32_16x16x32_bf16 v[40:43], a[124:127], a[28:31], v[40:43]
v_exp_f32 v11, v83
v_mfma_f32_16x16x32_bf16 v[44:47], a[96:99], a[32:35], v[20:23]
ds_read_b128 a[80:83], v1 offset:20480
v_add_f32 v26, v26, v11
v_mfma_f32_16x16x32_bf16 v[44:47], a[100:103], a[36:39], v[44:47]
buffer_load_dwordx4 v1, s[4:7], s8 offen offset:2048 sc1 lds
v_mfma_f32_16x16x32_bf16 v[44:47], a[104:107], a[40:43], v[44:47]
ds_read_b128 a[84:87], v1 offset:21504
v_cvt_pk_bf16_f32 v117, v10, v11
v_mfma_f32_16x16x32_bf16 v[44:47], a[108:111], a[44:47], v[44:47]
v_exp_f32 v12, v84
v_mfma_f32_16x16x32_bf16 v[44:47], a[112:115], a[48:51], v[44:47]
ds_read_b128 a[88:91], v1 offset:22528
v_add_f32 v27, v27, v12
v_mfma_f32_16x16x32_bf16 v[44:47], a[116:119], a[52:55], v[44:47]
buffer_load_dwordx4 v1, s[4:7], s8 offen offset:3072 sc1 lds
v_mfma_f32_16x16x32_bf16 v[44:47], a[120:123], a[56:59], v[44:47]
s_waitcnt lgkmcnt(2)
s_add_u32 s8, s8, 28672
ds_read_b128 a[92:95], v1 offset:23552
v_mfma_f32_16x16x32_bf16 v[44:47], a[124:127], a[60:63], v[44:47]
s_sub_u32 s9, s9, 1
v_exp_f32 v13, v85
v_mfma_f32_16x16x32_bf16 v[48:51], a[64:67], a[0:3], v[48:51]
s_cmp_eq_u32 s9, 0
ds_read_b128 a[96:99], v1 offset:24576
v_cndmask_b32 v56, v16, v7, s[56:57]
v_mfma_f32_16x16x32_bf16 v[48:51], a[68:71], a[4:7], v[48:51]
s_cselect_b32 s8, s10, s8
v_cndmask_b32 v57, v16, v7, s[58:59]
v_cndmask_b32 v58, v16, v7, s[60:61]
v_mfma_f32_16x16x32_bf16 v[48:51], a[72:75], a[8:11], v[48:51]
s_cselect_b32 s9, s11, s9
ds_read_b128 a[100:103], v1 offset:25600
v_cndmask_b32 v59, v16, v7, s[62:63]
v_mfma_f32_16x16x32_bf16 v[48:51], a[76:79], a[12:15], v[48:51]
s_cselect_b32 s10, 3221225472, s10
v_exp_f32 v14, v86
v_mfma_f32_16x16x32_bf16 v[48:51], a[80:83], a[16:19], v[48:51]
s_waitcnt lgkmcnt(4)
ds_read_b128 a[104:107], v1 offset:26624
v_add_f32 v27, v27, v13
v_cvt_pk_bf16_f32 v124, v12, v13
v_mfma_f32_16x16x32_bf16 v[48:51], a[84:87], a[20:23], v[48:51]
s_waitcnt lgkmcnt(4)
v_exp_f32 v15, v87
v_mfma_f32_16x16x32_bf16 v[48:51], a[88:91], a[24:27], v[48:51]
s_waitcnt lgkmcnt(3)
ds_read_b128 a[108:111], v1 offset:27648
v_add_f32 v27, v27, v14
v_mfma_f32_16x16x32_bf16 v[48:51], a[92:95], a[28:31], v[48:51]
v_exp_f32 v8, v88
v_mfma_f32_16x16x32_bf16 v[52:55], a[64:67], a[32:35], v[20:23]
ds_read_b128 a[112:115], v1 offset:28672
v_add_f32 v27, v27, v15
v_mfma_f32_16x16x32_bf16 v[52:55], a[68:71], a[36:39], v[52:55]
v_exp_f32 v9, v89
v_mfma_f32_16x16x32_bf16 v[52:55], a[72:75], a[40:43], v[52:55]
ds_read_b128 a[116:119], v1 offset:29696
v_cvt_pk_bf16_f32 v125, v14, v15
v_mfma_f32_16x16x32_bf16 v[52:55], a[76:79], a[44:47], v[52:55]
v_exp_f32 v10, v90
v_mfma_f32_16x16x32_bf16 v[52:55], a[80:83], a[48:51], v[52:55]
ds_read_b128 a[120:123], v1 offset:30720
v_add_f32 v26, v26, v8
v_mfma_f32_16x16x32_bf16 v[52:55], a[84:87], a[52:55], v[52:55]
v_exp_f32 v11, v91
v_mfma_f32_16x16x32_bf16 v[52:55], a[88:91], a[56:59], v[52:55]
s_waitcnt vmcnt(8) lgkmcnt(4)
ds_read_b128 a[124:127], v1 offset:31744
v_add_f32 v26, v26, v9
v_cvt_pk_bf16_f32 v118, v8, v9
v_mfma_f32_16x16x32_bf16 v[52:55], a[92:95], a[60:63], v[52:55]
s_barrier
v_mfma_f32_16x16x32_bf16 v[56:59], a[96:99], a[0:3], v[56:59]
ds_read_b128 a[64:67], v2 offset:32768
v_add_f32 v26, v26, v10
v_mfma_f32_16x16x32_bf16 v[56:59], a[100:103], a[4:7], v[56:59]
v_exp_f32 v12, v92
v_mfma_f32_16x16x32_bf16 v[56:59], a[104:107], a[8:11], v[56:59]
s_waitcnt lgkmcnt(4)
ds_read_b128 a[68:71], v2 offset:33792
v_add_f32 v26, v26, v11
v_cvt_pk_bf16_f32 v119, v10, v11
v_mfma_f32_16x16x32_bf16 v[56:59], a[108:111], a[12:15], v[56:59]
v_exp_f32 v13, v93
v_mfma_f32_16x16x32_bf16 v[56:59], a[112:115], a[16:19], v[56:59]
s_waitcnt lgkmcnt(4)
ds_read_b128 a[72:75], v2 offset:34816
v_add_f32 v27, v27, v12
v_mfma_f32_16x16x32_bf16 v[56:59], a[116:119], a[20:23], v[56:59]
s_waitcnt lgkmcnt(4)
v_exp_f32 v14, v94
v_mfma_f32_16x16x32_bf16 v[56:59], a[120:123], a[24:27], v[56:59]
s_waitcnt lgkmcnt(3)
ds_read_b128 a[76:79], v2 offset:35840
v_add_f32 v27, v27, v13
v_mfma_f32_16x16x32_bf16 v[56:59], a[124:127], a[28:31], v[56:59]
v_exp_f32 v15, v95
v_mfma_f32_16x16x32_bf16 v[60:63], a[96:99], a[32:35], v[20:23]
ds_read_b128 a[80:83], v2 offset:36864
v_cvt_pk_bf16_f32 v126, v12, v13
v_mfma_f32_16x16x32_bf16 v[60:63], a[100:103], a[36:39], v[60:63]
v_add_f32 v27, v27, v14
v_add_f32 v27, v27, v15
v_mfma_f32_16x16x32_bf16 v[60:63], a[104:107], a[40:43], v[60:63]
ds_read_b128 a[84:87], v2 offset:37888
v_cvt_pk_bf16_f32 v127, v14, v15
v_mfma_f32_16x16x32_bf16 v[60:63], a[108:111], a[44:47], v[60:63]
v_add_f32 v28, v26, v27
v_cmp_nge_f32 vcc, s25, v28
v_mfma_f32_16x16x32_bf16 v[60:63], a[112:115], a[48:51], v[60:63]
ds_read_b128 a[88:91], v2 offset:38912
v_mfma_f32_16x16x32_bf16 v[60:63], a[116:119], a[52:55], v[60:63]
v_mfma_f32_16x16x32_bf16 v[60:63], a[120:123], a[56:59], v[60:63]
ds_read_b128 a[92:95], v2 offset:39936
v_mfma_f32_16x16x32_bf16 v[60:63], a[124:127], a[60:63], v[60:63]
s_waitcnt lgkmcnt(4)
s_cbranch_vccnz Lstub_6
Lback_7:
v_mfma_f32_16x16x32_bf16 v[128:131], a[64:67], v[112:115], v[128:131]
s_add_u32 m0, s18, 65536
ds_read_b128 a[96:99], v2 offset:40960
v_add_f32 v24, v24, v26
v_mfma_f32_16x16x32_bf16 v[128:131], a[68:71], v[116:119], v[128:131]
buffer_load_dwordx4 v1, s[4:7], s12 offen offset:0 sc1 lds
v_mfma_f32_16x16x32_bf16 v[132:135], a[68:71], v[124:127], v[132:135]
ds_read_b128 a[100:103], v2 offset:41984
v_add_f32 v25, v25, v27
v_mfma_f32_16x16x32_bf16 v[132:135], a[64:67], v[120:123], v[132:135]
v_exp_f32 v8, v32
v_mfma_f32_16x16x32_bf16 v[136:139], a[72:75], v[112:115], v[136:139]
ds_read_b128 a[104:107], v2 offset:43008
v_mfma_f32_16x16x32_bf16 v[136:139], a[76:79], v[116:119], v[136:139]
buffer_load_dwordx4 v1, s[4:7], s12 offen offset:1024 sc1 lds
v_mfma_f32_16x16x32_bf16 v[140:143], a[76:79], v[124:127], v[140:143]
ds_read_b128 a[108:111], v2 offset:44032
v_mfma_f32_16x16x32_bf16 v[140:143], a[72:75], v[120:123], v[140:143]
s_waitcnt lgkmcnt(4)
v_exp_f32 v9, v33
v_mfma_f32_16x16x32_bf16 v[144:147], a[80:83], v[112:115], v[144:147]
ds_read_b128 a[112:115], v2 offset:45056
v_add_f32 v26, v8, v9
v_mfma_f32_16x16x32_bf16 v[144:147], a[84:87], v[116:119], v[144:147]
buffer_load_dwordx4 v1, s[4:7], s12 offen offset:2048 sc1 lds
v_mfma_f32_16x16x32_bf16 v[148:151], a[84:87], v[124:127], v[148:151]
ds_read_b128 a[116:119], v2 offset:46080
v_cvt_pk_bf16_f32 v96, v8, v9
v_mfma_f32_16x16x32_bf16 v[148:151], a[80:83], v[120:123], v[148:151]
v_exp_f32 v10, v34
v_mfma_f32_16x16x32_bf16 v[152:155], a[88:91], v[112:115], v[152:155]
ds_read_b128 a[120:123], v2 offset:47104
v_add_f32 v26, v26, v10
v_mfma_f32_16x16x32_bf16 v[152:155], a[92:95], v[116:119], v[152:155]
buffer_load_dwordx4 v1, s[4:7], s12 offen offset:3072 sc1 lds
v_mfma_f32_16x16x32_bf16 v[156:159], a[92:95], v[124:127], v[156:159]
s_add_u32 s12, s12, 4096
ds_read_b128 a[124:127], v2 offset:48128
v_mfma_f32_16x16x32_bf16 v[156:159], a[88:91], v[120:123], v[156:159]
s_waitcnt lgkmcnt(4)
v_exp_f32 v11, v35
v_mfma_f32_16x16x32_bf16 v[160:163], a[96:99], v[112:115], v[160:163]
s_add_u32 m0, s18, 69632
ds_read_b128 a[64:67], v2 offset:49152
v_add_f32 v26, v26, v11
v_mfma_f32_16x16x32_bf16 v[160:163], a[100:103], v[116:119], v[160:163]
buffer_load_dwordx4 v1, s[4:7], s12 offen offset:0 sc1 lds
v_mfma_f32_16x16x32_bf16 v[164:167], a[100:103], v[124:127], v[164:167]
ds_read_b128 a[68:71], v2 offset:50176
v_cvt_pk_bf16_f32 v97, v10, v11
v_mfma_f32_16x16x32_bf16 v[164:167], a[96:99], v[120:123], v[164:167]
v_mfma_f32_16x16x32_bf16 v[168:171], a[104:107], v[112:115], v[168:171]
ds_read_b128 a[72:75], v2 offset:51200
v_mfma_f32_16x16x32_bf16 v[168:171], a[108:111], v[116:119], v[168:171]
buffer_load_dwordx4 v1, s[4:7], s12 offen offset:1024 sc1 lds
v_mfma_f32_16x16x32_bf16 v[172:175], a[108:111], v[124:127], v[172:175]
ds_read_b128 a[76:79], v2 offset:52224
v_mfma_f32_16x16x32_bf16 v[172:175], a[104:107], v[120:123], v[172:175]
s_waitcnt lgkmcnt(4)
v_exp_f32 v12, v36
v_mfma_f32_16x16x32_bf16 v[176:179], a[112:115], v[112:115], v[176:179]
ds_read_b128 a[80:83], v2 offset:53248
v_mfma_f32_16x16x32_bf16 v[176:179], a[116:119], v[116:119], v[176:179]
buffer_load_dwordx4 v1, s[4:7], s12 offen offset:2048 sc1 lds
v_mfma_f32_16x16x32_bf16 v[180:183], a[116:119], v[124:127], v[180:183]
ds_read_b128 a[84:87], v2 offset:54272
v_mfma_f32_16x16x32_bf16 v[180:183], a[112:115], v[120:123], v[180:183]
v_exp_f32 v13, v37
v_mfma_f32_16x16x32_bf16 v[184:187], a[120:123], v[112:115], v[184:187]
ds_read_b128 a[88:91], v2 offset:55296
v_add_f32 v27, v12, v13
v_mfma_f32_16x16x32_bf16 v[184:187], a[124:127], v[116:119], v[184:187]
s_waitcnt lgkmcnt(4)
buffer_load_dwordx4 v1, s[4:7], s12 offen offset:3072 sc1 lds
v_mfma_f32_16x16x32_bf16 v[188:191], a[124:127], v[124:127], v[188:191]
s_add_u32 s12, s12, 28672
ds_read_b128 a[92:95], v2 offset:56320
v_cvt_pk_bf16_f32 v104, v12, v13
v_mfma_f32_16x16x32_bf16 v[188:191], a[120:123], v[120:123], v[188:191]
s_sub_u32 s13, s13, 1
v_exp_f32 v14, v38
v_mfma_f32_16x16x32_bf16 v[192:195], a[64:67], v[112:115], v[192:195]
s_cmp_eq_u32 s13, 0
ds_read_b128 a[96:99], v2 offset:57344
v_add_f32 v27, v27, v14
v_mfma_f32_16x16x32_bf16 v[192:195], a[68:71], v[116:119], v[192:195]
s_cselect_b32 s12, s14, s12
v_exp_f32 v15, v39
v_mfma_f32_16x16x32_bf16 v[196:199], a[68:71], v[124:127], v[196:199]
s_cselect_b32 s13, s15, s13
ds_read_b128 a[100:103], v2 offset:58368
v_add_f32 v27, v27, v15
v_mfma_f32_16x16x32_bf16 v[196:199], a[64:67], v[120:123], v[196:199]
s_cselect_b32 s14, 3221225472, s14
v_cvt_pk_bf16_f32 v105, v14, v15
v_mfma_f32_16x16x32_bf16 v[200:203], a[72:75], v[112:115], v[200:203]
s_waitcnt lgkmcnt(4)
ds_read_b128 a[104:107], v2 offset:59392
v_mfma_f32_16x16x32_bf16 v[200:203], a[76:79], v[116:119], v[200:203]
buffer_load_dword v3, off, s[4:7], s80 sc1
v_mfma_f32_16x16x32_bf16 v[204:207], a[76:79], v[124:127], v[204:207]
ds_read_b128 a[108:111], v2 offset:60416
v_mfma_f32_16x16x32_bf16 v[204:207], a[72:75], v[120:123], v[204:207]
v_exp_f32 v8, v40
v_mfma_f32_16x16x32_bf16 v[208:211], a[80:83], v[112:115], v[208:211]
ds_read_b128 a[112:115], v2 offset:61440
v_add_f32 v26, v26, v8
v_mfma_f32_16x16x32_bf16 v[208:211], a[84:87], v[116:119], v[208:211]
v_exp_f32 v9, v41
v_mfma_f32_16x16x32_bf16 v[212:215], a[84:87], v[124:127], v[212:215]
ds_read_b128 a[116:119], v2 offset:62464
v_add_f32 v26, v26, v9
v_mfma_f32_16x16x32_bf16 v[212:215], a[80:83], v[120:123], v[212:215]
s_waitcnt lgkmcnt(4)
v_exp_f32 v10, v42
v_mfma_f32_16x16x32_bf16 v[216:219], a[88:91], v[112:115], v[216:219]
ds_read_b128 a[120:123], v2 offset:63488
v_cvt_pk_bf16_f32 v98, v8, v9
v_mfma_f32_16x16x32_bf16 v[216:219], a[92:95], v[116:119], v[216:219]
v_exp_f32 v11, v43
v_mfma_f32_16x16x32_bf16 v[220:223], a[92:95], v[124:127], v[220:223]
s_waitcnt vmcnt(9)
ds_read_b128 a[124:127], v2 offset:64512
v_add_f32 v26, v26, v10
v_mfma_f32_16x16x32_bf16 v[220:223], a[88:91], v[120:123], v[220:223]
s_barrier
v_mfma_f32_16x16x32_bf16 v[224:227], a[96:99], v[112:115], v[224:227]
ds_read_b128 a[64:67], v4 offset:0
v_add_f32 v26, v26, v11
v_mfma_f32_16x16x32_bf16 v[224:227], a[100:103], v[116:119], v[224:227]
v_cvt_pk_bf16_f32 v99, v10, v11
v_mfma_f32_16x16x32_bf16 v[228:231], a[100:103], v[124:127], v[228:231]
ds_read_b128 a[68:71], v4 offset:1024
v_mfma_f32_16x16x32_bf16 v[228:231], a[96:99], v[120:123], v[228:231]
s_waitcnt lgkmcnt(4)
v_exp_f32 v12, v44
v_mfma_f32_16x16x32_bf16 v[232:235], a[104:107], v[112:115], v[232:235]
ds_read_b128 a[72:75], v4 offset:2048
v_add_f32 v27, v27, v12
v_mfma_f32_16x16x32_bf16 v[232:235], a[108:111], v[116:119], v[232:235]
v_exp_f32 v13, v45
v_mfma_f32_16x16x32_bf16 v[236:239], a[108:111], v[124:127], v[236:239]
ds_read_b128 a[76:79], v4 offset:3072
v_add_f32 v27, v27, v13
v_mfma_f32_16x16x32_bf16 v[236:239], a[104:107], v[120:123], v[236:239]
v_exp_f32 v14, v46
v_mfma_f32_16x16x32_bf16 v[240:243], a[112:115], v[112:115], v[240:243]
ds_read_b128 a[80:83], v4 offset:4096
v_cvt_pk_bf16_f32 v106, v12, v13
v_mfma_f32_16x16x32_bf16 v[240:243], a[116:119], v[116:119], v[240:243]
v_exp_f32 v15, v47
v_mfma_f32_16x16x32_bf16 v[244:247], a[116:119], v[124:127], v[244:247]
ds_read_b128 a[84:87], v4 offset:5120
v_add_f32 v27, v27, v14
v_mfma_f32_16x16x32_bf16 v[244:247], a[112:115], v[120:123], v[244:247]
s_waitcnt lgkmcnt(4)
v_add_f32 v27, v27, v15
v_cvt_pk_bf16_f32 v107, v14, v15
v_mfma_f32_16x16x32_bf16 v[248:251], a[120:123], v[112:115], v[248:251]
ds_read_b128 a[88:91], v4 offset:6144
v_mfma_f32_16x16x32_bf16 v[248:251], a[124:127], v[116:119], v[248:251]
v_mfma_f32_16x16x32_bf16 v[252:255], a[124:127], v[124:127], v[252:255]
ds_read_b128 a[92:95], v4 offset:7168
v_mfma_f32_16x16x32_bf16 v[252:255], a[120:123], v[120:123], v[252:255]
K2_dx1:
v_cndmask_b32 v68, v20, v7, s[32:33]
v_cndmask_b32 v69, v20, v7, s[34:35]
v_cndmask_b32 v70, v20, v7, s[36:37]
v_cndmask_b32 v71, v20, v7, s[38:39]
s_nop 1
v_mfma_f32_16x16x32_bf16 v[68:71], a[64:67], a[32:35], v[68:71]
s_add_u32 m0, s18, 0
ds_read_b128 a[96:99], v4 offset:8192
v_cndmask_b32 v76, v20, v7, s[40:41]
v_cndmask_b32 v79, v20, v7, s[46:47]
v_mfma_f32_16x16x32_bf16 v[68:71], a[68:71], a[36:39], v[68:71]
s_waitcnt lgkmcnt(4)
ds_read_b128 a[100:103], v4 offset:9216
buffer_load_dwordx4 v1, s[4:7], s12 offen offset:0 sc1 lds
v_mfma_f32_16x16x32_bf16 v[68:71], a[72:75], a[40:43], v[68:71]
ds_read_b128 a[104:107], v4 offset:10240
v_cndmask_b32 v77, v20, v7, s[42:43]
v_mfma_f32_16x16x32_bf16 v[68:71], a[76:79], a[44:47], v[68:71]
ds_read_b128 a[108:111], v4 offset:11264
buffer_load_dwordx4 v1, s[4:7], s12 offen offset:1024 sc1 lds
v_mfma_f32_16x16x32_bf16 v[68:71], a[80:83], a[48:51], v[68:71]
s_waitcnt lgkmcnt(6)
ds_read_b128 a[112:115], v4 offset:12288
v_cndmask_b32 v78, v20, v7, s[44:45]
v_mfma_f32_16x16x32_bf16 v[68:71], a[84:87], a[52:55], v[68:71]
s_waitcnt lgkmcnt(6)
ds_read_b128 a[116:119], v4 offset:13312
buffer_load_dwordx4 v1, s[4:7], s12 offen offset:2048 sc1 lds
v_mfma_f32_16x16x32_bf16 v[68:71], a[88:91], a[56:59], v[68:71]
s_waitcnt lgkmcnt(6)
ds_read_b128 a[120:123], v4 offset:14336
v_exp_f32 v8, v48
v_exp_f32 v9, v49
v_exp_f32 v10, v50
v_mfma_f32_16x16x32_bf16 v[68:71], a[92:95], a[60:63], v[68:71]
s_waitcnt lgkmcnt(5)
ds_read_b128 a[124:127], v4 offset:15360
buffer_load_dwordx4 v1, s[4:7], s12 offen offset:3072 sc1 lds
v_add_f32 v26, v26, v8
v_add_f32 v26, v26, v9
v_cvt_pk_bf16_f32 v100, v8, v9
v_add_f32 v26, v26, v10
v_mfma_f32_16x16x32_bf16 v[76:79], a[96:99], a[32:35], v[76:79]
s_add_u32 s12, s12, 4096
s_add_u32 m0, s18, 4096
ds_read_b128 a[64:67], v4 offset:16384
v_cndmask_b32 v86, v20, v7, s[52:53]
v_cndmask_b32 v87, v20, v7, s[54:55]
v_mfma_f32_16x16x32_bf16 v[76:79], a[100:103], a[36:39], v[76:79]
s_waitcnt lgkmcnt(6)
ds_read_b128 a[68:71], v4 offset:17408
buffer_load_dwordx4 v1, s[4:7], s12 offen offset:0 sc1 lds
v_mfma_f32_16x16x32_bf16 v[76:79], a[104:107], a[40:43], v[76:79]
s_waitcnt lgkmcnt(6)
ds_read_b128 a[72:75], v4 offset:18432
v_cndmask_b32 v84, v20, v7, s[48:49]
v_mfma_f32_16x16x32_bf16 v[76:79], a[108:111], a[44:47], v[76:79]
s_waitcnt lgkmcnt(6)
ds_read_b128 a[76:79], v4 offset:19456
buffer_load_dwordx4 v1, s[4:7], s12 offen offset:1024 sc1 lds
v_mfma_f32_16x16x32_bf16 v[76:79], a[112:115], a[48:51], v[76:79]
s_waitcnt lgkmcnt(6)
ds_read_b128 a[80:83], v4 offset:20480
v_cndmask_b32 v85, v20, v7, s[50:51]
v_mfma_f32_16x16x32_bf16 v[76:79], a[116:119], a[52:55], v[76:79]
s_waitcnt lgkmcnt(6)
ds_read_b128 a[84:87], v4 offset:21504
buffer_load_dwordx4 v1, s[4:7], s12 offen offset:2048 sc1 lds
v_mfma_f32_16x16x32_bf16 v[76:79], a[120:123], a[56:59], v[76:79]
s_waitcnt lgkmcnt(6)
ds_read_b128 a[88:91], v4 offset:22528
v_exp_f32 v11, v51
v_exp_f32 v12, v52
v_mfma_f32_16x16x32_bf16 v[76:79], a[124:127], a[60:63], v[76:79]
s_waitcnt lgkmcnt(1)
ds_read_b128 a[92:95], v4 offset:23552
buffer_load_dwordx4 v1, s[4:7], s12 offen offset:3072 sc1 lds
v_add_f32 v26, v26, v11
v_cvt_pk_bf16_f32 v101, v10, v11
v_add_f32 v27, v27, v12
v_mfma_f32_16x16x32_bf16 v[84:87], a[64:67], a[32:35], v[84:87]
s_add_u32 s12, s12, 28672
ds_read_b128 a[96:99], v4 offset:24576
v_cndmask_b32 v92, v20, v7, s[56:57]
v_mfma_f32_16x16x32_bf16 v[84:87], a[68:71], a[36:39], v[84:87]
s_sub_u32 s13, s13, 1
ds_read_b128 a[100:103], v4 offset:25600
v_cndmask_b32 v93, v20, v7, s[58:59]
v_mfma_f32_16x16x32_bf16 v[84:87], a[72:75], a[40:43], v[84:87]
s_cmp_eq_u32 s13, 0
ds_read_b128 a[104:107], v4 offset:26624
v_cndmask_b32 v94, v20, v7, s[60:61]
v_mfma_f32_16x16x32_bf16 v[84:87], a[76:79], a[44:47], v[84:87]
s_cselect_b32 s12, s14, s12
ds_read_b128 a[108:111], v4 offset:27648
v_cndmask_b32 v95, v20, v7, s[62:63]
v_mfma_f32_16x16x32_bf16 v[84:87], a[80:83], a[48:51], v[84:87]
s_cselect_b32 s13, s15, s13
ds_read_b128 a[112:115], v4 offset:28672
v_exp_f32 v13, v53
v_exp_f32 v14, v54
v_mfma_f32_16x16x32_bf16 v[84:87], a[84:87], a[52:55], v[84:87]
s_waitcnt lgkmcnt(6)
s_cselect_b32 s14, 3221225472, s14
ds_read_b128 a[116:119], v4 offset:29696
v_exp_f32 v15, v55
v_exp_f32 v8, v56
v_exp_f32 v9, v57
v_add_f32 v27, v27, v13
v_cvt_pk_bf16_f32 v108, v12, v13
v_add_f32 v27, v27, v14
v_mfma_f32_16x16x32_bf16 v[84:87], a[88:91], a[56:59], v[84:87]
s_waitcnt lgkmcnt(6)
ds_read_b128 a[120:123], v4 offset:30720
v_exp_f32 v10, v58
v_exp_f32 v11, v59
v_add_f32 v27, v27, v15
v_cvt_pk_bf16_f32 v109, v14, v15
v_mfma_f32_16x16x32_bf16 v[84:87], a[92:95], a[60:63], v[84:87]
s_waitcnt vmcnt(8) lgkmcnt(6)
s_barrier
ds_read_b128 a[124:127], v4 offset:31744
v_mfma_f32_16x16x32_bf16 v[92:95], a[96:99], a[32:35], v[92:95]
s_waitcnt lgkmcnt(6)
ds_read_b128 a[64:67], v2 offset:0
v_exp_f32 v12, v60
v_exp_f32 v13, v61
v_mfma_f32_16x16x32_bf16 v[92:95], a[100:103], a[36:39], v[92:95]
s_waitcnt lgkmcnt(6)
ds_read_b128 a[68:71], v2 offset:1024
v_exp_f32 v14, v62
v_exp_f32 v15, v63
v_mfma_f32_16x16x32_bf16 v[92:95], a[104:107], a[40:43], v[92:95]
s_waitcnt lgkmcnt(6)
ds_read_b128 a[72:75], v2 offset:2048
v_add_f32 v26, v26, v8
v_add_f32 v26, v26, v9
v_cvt_pk_bf16_f32 v102, v8, v9
v_mfma_f32_16x16x32_bf16 v[92:95], a[108:111], a[44:47], v[92:95]
s_waitcnt lgkmcnt(6)
ds_read_b128 a[76:79], v2 offset:3072
v_add_f32 v26, v26, v10
v_add_f32 v26, v26, v11
v_cvt_pk_bf16_f32 v103, v10, v11
v_mfma_f32_16x16x32_bf16 v[92:95], a[112:115], a[48:51], v[92:95]
s_waitcnt lgkmcnt(6)
ds_read_b128 a[80:83], v2 offset:4096
v_add_f32 v27, v27, v12
v_mfma_f32_16x16x32_bf16 v[92:95], a[116:119], a[52:55], v[92:95]
s_waitcnt lgkmcnt(6)
ds_read_b128 a[84:87], v2 offset:5120
v_add_f32 v27, v27, v13
v_cvt_pk_bf16_f32 v110, v12, v13
v_mfma_f32_16x16x32_bf16 v[92:95], a[120:123], a[56:59], v[92:95]
s_waitcnt lgkmcnt(6)
ds_read_b128 a[88:91], v2 offset:6144
v_add_f32 v27, v27, v14
v_add_f32 v27, v27, v15
v_cvt_pk_bf16_f32 v111, v14, v15
v_mfma_f32_16x16x32_bf16 v[92:95], a[124:127], a[60:63], v[92:95]
s_waitcnt lgkmcnt(6)
ds_read_b128 a[92:95], v2 offset:7168
v_add_f32 v28, v26, v27
v_cmp_nge_f32 vcc, s25, v28
s_cbranch_vccnz Lstub_8
Lback_9:
s_cmp_lg_u32 s24, 1
s_cbranch_scc1 K2_plain
v_cmp_gt_u32 vcc, 1, v3
s_cbranch_vccnz K2_tspin
K2_tok:
v_mfma_f32_16x16x32_bf16 v[128:131], a[64:67], v[96:99], v[128:131]
s_waitcnt lgkmcnt(6)
ds_read_b128 a[96:99], v2 offset:8192
v_add_f32 v24, v24, v26
v_mfma_f32_16x16x32_bf16 v[128:131], a[68:71], v[100:103], v[128:131]
buffer_load_dwordx4 v[28:31], v1, s[4:7], s27 offen sc1
v_mfma_f32_16x16x32_bf16 v[132:135], a[68:71], v[108:111], v[132:135]
ds_read_b128 a[100:103], v2 offset:9216
v_add_f32 v25, v25, v27
v_mfma_f32_16x16x32_bf16 v[132:135], a[64:67], v[104:107], v[132:135]
s_waitcnt lgkmcnt(6)
v_exp_f32 v8, v68
v_mfma_f32_16x16x32_bf16 v[136:139], a[72:75], v[96:99], v[136:139]
s_add_u32 s22, s76, 0
ds_read_b128 a[104:107], v2 offset:10240
v_exp_f32 v9, v69
v_mfma_f32_16x16x32_bf16 v[136:139], a[76:79], v[100:103], v[136:139]
buffer_load_dwordx4 v[32:35], v1, s[4:7], s22 offen offset:0 sc1
v_mfma_f32_16x16x32_bf16 v[140:143], a[76:79], v[108:111], v[140:143]
ds_read_b128 a[108:111], v2 offset:11264
v_add_f32 v27, v8, v9
v_mfma_f32_16x16x32_bf16 v[140:143], a[72:75], v[104:107], v[140:143]
s_waitcnt lgkmcnt(5)
v_exp_f32 v10, v70
v_mfma_f32_16x16x32_bf16 v[144:147], a[80:83], v[96:99], v[144:147]
ds_read_b128 a[112:115], v2 offset:12288
v_cvt_pk_bf16_f32 v120, v8, v9
v_mfma_f32_16x16x32_bf16 v[144:147], a[84:87], v[100:103], v[144:147]
buffer_load_dwordx4 v[36:39], v1, s[4:7], s22 offen offset:1024 sc1
v_mfma_f32_16x16x32_bf16 v[148:151], a[84:87], v[108:111], v[148:151]
ds_read_b128 a[116:119], v2 offset:13312
v_add_f32 v27, v27, v10
v_mfma_f32_16x16x32_bf16 v[148:151], a[80:83], v[104:107], v[148:151]
v_exp_f32 v11, v71
v_mfma_f32_16x16x32_bf16 v[152:155], a[88:91], v[96:99], v[152:155]
s_waitcnt lgkmcnt(4)
ds_read_b128 a[120:123], v2 offset:14336
v_add_f32 v27, v27, v11
v_mfma_f32_16x16x32_bf16 v[152:155], a[92:95], v[100:103], v[152:155]
buffer_load_dwordx4 v[40:43], v1, s[4:7], s22 offen offset:2048 sc1
v_mfma_f32_16x16x32_bf16 v[156:159], a[92:95], v[108:111], v[156:159]
ds_read_b128 a[124:127], v2 offset:15360
v_cvt_pk_bf16_f32 v121, v10, v11
v_mfma_f32_16x16x32_bf16 v[156:159], a[88:91], v[104:107], v[156:159]
v_exp_f32 v12, v76
v_mfma_f32_16x16x32_bf16 v[160:163], a[96:99], v[96:99], v[160:163]
ds_read_b128 a[64:67], v2 offset:16384
v_add_f32 v27, v27, v12
v_mfma_f32_16x16x32_bf16 v[160:163], a[100:103], v[100:103], v[160:163]
buffer_load_dwordx4 v[44:47], v1, s[4:7], s22 offen offset:3072 sc1
v_mfma_f32_16x16x32_bf16 v[164:167], a[100:103], v[108:111], v[164:167]
PAD_12:
s_cbranch_execz M_tret
ds_read_b128 a[68:71], v2 offset:17408
v_mfma_f32_16x16x32_bf16 v[164:167], a[96:99], v[104:107], v[164:167]
s_waitcnt lgkmcnt(4)
v_exp_f32 v13, v77
v_mfma_f32_16x16x32_bf16 v[168:171], a[104:107], v[96:99], v[168:171]
s_add_u32 s22, s76, 4096
ds_read_b128 a[72:75], v2 offset:18432
v_add_f32 v27, v27, v13
v_mfma_f32_16x16x32_bf16 v[168:171], a[108:111], v[100:103], v[168:171]
buffer_load_dwordx4 v[48:51], v1, s[4:7], s22 offen offset:0 sc1
v_mfma_f32_16x16x32_bf16 v[172:175], a[108:111], v[108:111], v[172:175]
ds_read_b128 a[76:79], v2 offset:19456
v_exp_f32 v14, v78
v_mfma_f32_16x16x32_bf16 v[172:175], a[104:107], v[104:107], v[172:175]
v_exp_f32 v15, v79
v_mfma_f32_16x16x32_bf16 v[176:179], a[112:115], v[96:99], v[176:179]
ds_read_b128 a[80:83], v2 offset:20480
v_cvt_pk_bf16_f32 v122, v12, v13
v_mfma_f32_16x16x32_bf16 v[176:179], a[116:119], v[100:103], v[176:179]
buffer_load_dwordx4 v[52:55], v1, s[4:7], s22 offen offset:1024 sc1
v_mfma_f32_16x16x32_bf16 v[180:183], a[116:119], v[108:111], v[180:183]
ds_read_b128 a[84:87], v2 offset:21504
v_add_f32 v27, v27, v14
v_mfma_f32_16x16x32_bf16 v[180:183], a[112:115], v[104:107], v[180:183]
s_waitcnt lgkmcnt(4)
v_exp_f32 v8, v84
v_mfma_f32_16x16x32_bf16 v[184:187], a[120:123], v[96:99], v[184:187]
ds_read_b128 a[88:91], v2 offset:22528
v_add_f32 v27, v27, v15
v_cvt_pk_bf16_f32 v123, v14, v15
v_mfma_f32_16x16x32_bf16 v[184:187], a[124:127], v[100:103], v[184:187]
buffer_load_dwordx4 v[56:59], v1, s[4:7], s22 offen offset:2048 sc1
v_mfma_f32_16x16x32_bf16 v[188:191], a[124:127], v[108:111], v[188:191]
ds_read_b128 a[92:95], v2 offset:23552
v_add_f32 v27, v27, v8
v_mfma_f32_16x16x32_bf16 v[188:191], a[120:123], v[104:107], v[188:191]
v_exp_f32 v9, v85
v_mfma_f32_16x16x32_bf16 v[192:195], a[64:67], v[96:99], v[192:195]
ds_read_b128 a[96:99], v2 offset:24576
v_add_f32 v27, v27, v9
v_mfma_f32_16x16x32_bf16 v[192:195], a[68:71], v[100:103], v[192:195]
buffer_load_dwordx4 v[60:63], v1, s[4:7], s22 offen offset:3072 sc1
v_mfma_f32_16x16x32_bf16 v[196:199], a[68:71], v[108:111], v[196:199]
ds_read_b128 a[100:103], v2 offset:25600
v_cvt_pk_bf16_f32 v124, v8, v9
v_mfma_f32_16x16x32_bf16 v[196:199], a[64:67], v[104:107], v[196:199]
s_waitcnt lgkmcnt(4)
v_exp_f32 v10, v86
v_mfma_f32_16x16x32_bf16 v[200:203], a[72:75], v[96:99], v[200:203]
s_add_u32 s22, s76, 8192
ds_read_b128 a[104:107], v2 offset:26624
v_add_f32 v27, v27, v10
v_mfma_f32_16x16x32_bf16 v[200:203], a[76:79], v[100:103], v[200:203]
buffer_load_dwordx4 a[32:35], v1, s[4:7], s22 offen offset:0 sc1
v_mfma_f32_16x16x32_bf16 v[204:207], a[76:79], v[108:111], v[204:207]
ds_read_b128 a[108:111], v2 offset:27648
v_mfma_f32_16x16x32_bf16 v[204:207], a[72:75], v[104:107], v[204:207]
v_exp_f32 v11, v87
v_mfma_f32_16x16x32_bf16 v[208:211], a[80:83], v[96:99], v[208:211]
ds_read_b128 a[112:115], v2 offset:28672
v_exp_f32 v12, v92
v_mfma_f32_16x16x32_bf16 v[208:211], a[84:87], v[100:103], v[208:211]
buffer_load_dwordx4 a[36:39], v1, s[4:7], s22 offen offset:1024 sc1
v_mfma_f32_16x16x32_bf16 v[212:215], a[84:87], v[108:111], v[212:215]
ds_read_b128 a[116:119], v2 offset:29696
v_add_f32 v27, v27, v11
v_mfma_f32_16x16x32_bf16 v[212:215], a[80:83], v[104:107], v[212:215]
s_waitcnt lgkmcnt(4)
v_exp_f32 v13, v93
v_mfma_f32_16x16x32_bf16 v[216:219], a[88:91], v[96:99], v[216:219]
ds_read_b128 a[120:123], v2 offset:30720
v_cvt_pk_bf16_f32 v125, v10, v11
v_add_f32 v27, v27, v12
v_mfma_f32_16x16x32_bf16 v[216:219], a[92:95], v[100:103], v[216:219]
buffer_load_dwordx4 a[40:43], v1, s[4:7], s22 offen offset:2048 sc1
v_mfma_f32_16x16x32_bf16 v[220:223], a[92:95], v[108:111], v[220:223]
s_waitcnt vmcnt(12)
ds_read_b128 a[124:127], v2 offset:31744
v_add_f32 v27, v27, v13
v_mfma_f32_16x16x32_bf16 v[220:223], a[88:91], v[104:107], v[220:223]
s_barrier
v_mfma_f32_16x16x32_bf16 v[224:227], a[96:99], v[96:99], v[224:227]
ds_read_b128 a[64:67], v1 offset:0
v_cvt_pk_bf16_f32 v126, v12, v13
v_mfma_f32_16x16x32_bf16 v[224:227], a[100:103], v[100:103], v[224:227]
buffer_load_dwordx4 a[44:47], v1, s[4:7], s22 offen offset:3072 sc1
v_mfma_f32_16x16x32_bf16 v[228:231], a[100:103], v[108:111], v[228:231]
ds_read_b128 a[68:71], v1 offset:1024
v_mfma_f32_16x16x32_bf16 v[228:231], a[96:99], v[104:107], v[228:231]
s_waitcnt lgkmcnt(4)
v_exp_f32 v14, v94
v_mfma_f32_16x16x32_bf16 v[232:235], a[104:107], v[96:99], v[232:235]
s_add_u32 s22, s76, 12288
ds_read_b128 a[72:75], v1 offset:2048
v_add_f32 v27, v27, v14
v_mfma_f32_16x16x32_bf16 v[232:235], a[108:111], v[100:103], v[232:235]
buffer_load_dwordx4 a[48:51], v1, s[4:7], s22 offen offset:0 sc1
v_mfma_f32_16x16x32_bf16 v[236:239], a[108:111], v[108:111], v[236:239]
ds_read_b128 a[76:79], v1 offset:3072
v_mfma_f32_16x16x32_bf16 v[236:239], a[104:107], v[104:107], v[236:239]
v_exp_f32 v15, v95
v_mfma_f32_16x16x32_bf16 v[240:243], a[112:115], v[96:99], v[240:243]
ds_read_b128 a[80:83], v1 offset:4096
v_add_f32 v27, v27, v15
v_mfma_f32_16x16x32_bf16 v[240:243], a[116:119], v[100:103], v[240:243]
buffer_load_dwordx4 a[52:55], v1, s[4:7], s22 offen offset:1024 sc1
v_mfma_f32_16x16x32_bf16 v[244:247], a[116:119], v[108:111], v[244:247]
ds_read_b128 a[84:87], v1 offset:5120
v_cvt_pk_bf16_f32 v127, v14, v15
v_mfma_f32_16x16x32_bf16 v[244:247], a[112:115], v[104:107], v[244:247]
s_waitcnt lgkmcnt(4)
v_cmp_nge_f32 vcc, s25, v27
v_mfma_f32_16x16x32_bf16 v[248:251], a[120:123], v[96:99], v[248:251]
ds_read_b128 a[88:91], v1 offset:6144
v_mfma_f32_16x16x32_bf16 v[248:251], a[124:127], v[100:103], v[248:251]
buffer_load_dwordx4 a[56:59], v1, s[4:7], s22 offen offset:2048 sc1
v_mfma_f32_16x16x32_bf16 v[252:255], a[124:127], v[108:111], v[252:255]
ds_read_b128 a[92:95], v1 offset:7168
v_mfma_f32_16x16x32_bf16 v[252:255], a[120:123], v[104:107], v[252:255]
s_waitcnt lgkmcnt(2)
buffer_load_dwordx4 a[60:63], v1, s[4:7], s22 offen offset:3072 sc1
s_cbranch_vccnz Lstub_10
Lback_11:
v_mfma_f32_16x16x32_bf16 v[132:135], a[64:67], v[120:123], v[132:135]
s_mov_b64 s[36:37], s[86:87]
ds_read_b128 a[96:99], v1 offset:8192
v_add_f32 v25, v25, v27
v_mfma_f32_16x16x32_bf16 v[132:135], a[68:71], v[124:127], v[132:135]
s_mov_b32 s38, 3670016
ds_read_b128 a[100:103], v1 offset:9216
v_accvgpr_read_b32 v112, a184
v_mfma_f32_16x16x32_bf16 v[140:143], a[72:75], v[120:123], v[140:143]
s_mov_b32 s39, 0x20000
ds_read_b128 a[104:107], v1 offset:10240
v_accvgpr_read_b32 v113, a185
v_mfma_f32_16x16x32_bf16 v[140:143], a[76:79], v[124:127], v[140:143]
s_lshl_b32 s8, s29, 3
ds_read_b128 a[108:111], v1 offset:11264
v_accvgpr_read_b32 v114, a186
v_mfma_f32_16x16x32_bf16 v[148:151], a[80:83], v[120:123], v[148:151]
s_add_u32 s8, s8, s3
ds_read_b128 a[112:115], v1 offset:12288
v_accvgpr_read_b32 v115, a187
v_mfma_f32_16x16x32_bf16 v[148:151], a[84:87], v[124:127], v[148:151]
s_waitcnt lgkmcnt(3)
s_lshl_b32 s8, s8, 4
ds_read_b128 a[116:119], v1 offset:13312
v_accvgpr_read_b32 v116, a188
v_mfma_f32_16x16x32_bf16 v[156:159], a[88:91], v[120:123], v[156:159]
s_add_u32 s8, s8, s20
ds_read_b128 a[120:123], v1 offset:14336
v_accvgpr_read_b32 v117, a189
v_mfma_f32_16x16x32_bf16 v[156:159], a[92:95], v[124:127], v[156:159]
s_mul_i32 s8, s8, 14336
ds_read_b128 a[124:127], v1 offset:15360
v_accvgpr_read_b32 v118, a190
v_mfma_f32_16x16x32_bf16 v[164:167], a[96:99], v[120:123], v[164:167]
s_add_u32 s8, s8, 104857600
ds_read_b128 a[64:67], v1 offset:16384
v_accvgpr_read_b32 v119, a191
v_mfma_f32_16x16x32_bf16 v[164:167], a[100:103], v[124:127], v[164:167]
s_waitcnt lgkmcnt(6)
s_add_u32 s12, s8, 917504
ds_read_b128 a[68:71], v1 offset:17408
v_mfma_f32_16x16x32_bf16 v[172:175], a[104:107], v[120:123], v[172:175]
s_waitcnt lgkmcnt(6)
ds_read_b128 a[72:75], v1 offset:18432
v_mfma_f32_16x16x32_bf16 v[172:175], a[108:111], v[124:127], v[172:175]
s_waitcnt lgkmcnt(6)
ds_read_b128 a[76:79], v1 offset:19456
v_mfma_f32_16x16x32_bf16 v[180:183], a[112:115], v[120:123], v[180:183]
s_waitcnt lgkmcnt(6)
ds_read_b128 a[80:83], v1 offset:20480
v_mfma_f32_16x16x32_bf16 v[180:183], a[116:119], v[124:127], v[180:183]
s_waitcnt lgkmcnt(6)
ds_read_b128 a[84:87], v1 offset:21504
v_mfma_f32_16x16x32_bf16 v[188:191], a[120:123], v[120:123], v[188:191]
s_waitcnt lgkmcnt(6)
ds_read_b128 a[88:91], v1 offset:22528
v_mfma_f32_16x16x32_bf16 v[188:191], a[124:127], v[124:127], v[188:191]
s_waitcnt lgkmcnt(6)
ds_read_b128 a[92:95], v1 offset:23552
v_mfma_f32_16x16x32_bf16 v[196:199], a[64:67], v[120:123], v[196:199]
s_waitcnt lgkmcnt(6)
ds_read_b128 a[96:99], v1 offset:24576
v_mfma_f32_16x16x32_bf16 v[196:199], a[68:71], v[124:127], v[196:199]
s_waitcnt lgkmcnt(6)
ds_read_b128 a[100:103], v1 offset:25600
v_mfma_f32_16x16x32_bf16 v[204:207], a[72:75], v[120:123], v[204:207]
s_waitcnt lgkmcnt(6)
ds_read_b128 a[104:107], v1 offset:26624
v_mfma_f32_16x16x32_bf16 v[204:207], a[76:79], v[124:127], v[204:207]
s_waitcnt lgkmcnt(6)
ds_read_b128 a[108:111], v1 offset:27648
v_mfma_f32_16x16x32_bf16 v[212:215], a[80:83], v[120:123], v[212:215]
s_waitcnt lgkmcnt(6)
ds_read_b128 a[112:115], v1 offset:28672
v_mfma_f32_16x16x32_bf16 v[212:215], a[84:87], v[124:127], v[212:215]
s_waitcnt lgkmcnt(6)
ds_read_b128 a[116:119], v1 offset:29696
v_mfma_f32_16x16x32_bf16 v[220:223], a[88:91], v[120:123], v[220:223]
s_waitcnt lgkmcnt(6)
s_add_u32 m0, s18, 32768
ds_read_b128 a[120:123], v1 offset:30720
v_mfma_f32_16x16x32_bf16 v[220:223], a[92:95], v[124:127], v[220:223]
s_waitcnt lgkmcnt(6)
ds_read_b128 a[124:127], v1 offset:31744
v_mfma_f32_16x16x32_bf16 v[228:231], a[96:99], v[120:123], v[228:231]
s_waitcnt lgkmcnt(6)
buffer_load_dwordx4 v112, s[36:39], s81 offen offset:0 lds
v_mfma_f32_16x16x32_bf16 v[228:231], a[100:103], v[124:127], v[228:231]
s_waitcnt lgkmcnt(5)
buffer_load_dwordx4 v113, s[36:39], s81 offen offset:1024 lds
v_mfma_f32_16x16x32_bf16 v[236:239], a[104:107], v[120:123], v[236:239]
s_waitcnt lgkmcnt(4)
buffer_load_dwordx4 v114, s[36:39], s81 offen offset:2048 lds
v_mfma_f32_16x16x32_bf16 v[236:239], a[108:111], v[124:127], v[236:239]
s_waitcnt lgkmcnt(3)
buffer_load_dwordx4 v115, s[36:39], s81 offen offset:3072 lds
v_mfma_f32_16x16x32_bf16 v[244:247], a[112:115], v[120:123], v[244:247]
s_waitcnt lgkmcnt(2)
s_add_u32 s81, s81, 28672
v_mfma_f32_16x16x32_bf16 v[244:247], a[116:119], v[124:127], v[244:247]
s_waitcnt lgkmcnt(1)
s_add_u32 m0, s18, 36864
v_mfma_f32_16x16x32_bf16 v[252:255], a[120:123], v[120:123], v[252:255]
s_waitcnt lgkmcnt(0)
buffer_load_dwordx4 v112, s[36:39], s81 offen offset:0 lds
v_mfma_f32_16x16x32_bf16 v[252:255], a[124:127], v[124:127], v[252:255]
buffer_load_dwordx4 v113, s[36:39], s81 offen offset:1024 lds
buffer_load_dwordx4 v114, s[36:39], s81 offen offset:2048 lds
buffer_load_dwordx4 v115, s[36:39], s81 offen offset:3072 lds
s_sub_u32 s81, s81, 28544
s_waitcnt vmcnt(8)
v_sub_f32 v8, v16, v28
v_sub_f32 v10, v20, v30
v_max_f32 v9, v8, v10
v_cmp_lt_f32 vcc, 1114636288, v9
s_cbranch_vccnz K2_cfix
K2_cok:
v_exp_f32 v8, v8
v_exp_f32 v10, v10
s_nop 0
v_mov_b32 v9, v8
v_mov_b32 v11, v10
v_fmac_f32 v24, v8, v29
v_fmac_f32 v25, v10, v31
s_mov_b32 s23, 0xffff0000
v_lshlrev_b32 v64, 16, v32
v_and_b32 v65, s23, v32
v_lshlrev_b32 v66, 16, v33
v_and_b32 v67, s23, v33
v_lshlrev_b32 v68, 16, v34
v_and_b32 v69, s23, v34
v_lshlrev_b32 v70, 16, v35
v_and_b32 v71, s23, v35
v_pk_fma_f32 v[128:129], v[64:65], v[8:9], v[128:129]
v_pk_fma_f32 v[130:131], v[66:67], v[8:9], v[130:131]
v_pk_fma_f32 v[136:137], v[68:69], v[8:9], v[136:137]
v_pk_fma_f32 v[138:139], v[70:71], v[8:9], v[138:139]
v_cvt_pk_bf16_f32 v128, v128, v129
v_cvt_pk_bf16_f32 v129, v130, v131
v_cvt_pk_bf16_f32 v130, v136, v137
v_cvt_pk_bf16_f32 v131, v138, v139
s_add_u32 m0, s18, 98304
s_nop 0
buffer_load_dwordx4 v112, s[36:39], s81 offen offset:0 lds
v_lshlrev_b32 v64, 16, v36
v_and_b32 v65, s23, v36
v_lshlrev_b32 v66, 16, v37
v_and_b32 v67, s23, v37
v_lshlrev_b32 v68, 16, v38
v_and_b32 v69, s23, v38
v_lshlrev_b32 v70, 16, v39
v_and_b32 v71, s23, v39
v_pk_fma_f32 v[144:145], v[64:65], v[8:9], v[144:145]
v_pk_fma_f32 v[146:147], v[66:67], v[8:9], v[146:147]
v_pk_fma_f32 v[152:153], v[68:69], v[8:9], v[152:153]
v_pk_fma_f32 v[154:155], v[70:71], v[8:9], v[154:155]
v_cvt_pk_bf16_f32 v144, v144, v145
v_cvt_pk_bf16_f32 v145, v146, v147
v_cvt_pk_bf16_f32 v146, v152, v153
v_cvt_pk_bf16_f32 v147, v154, v155
buffer_load_dwordx4 v113, s[36:39], s81 offen offset:1024 lds
v_lshlrev_b32 v64, 16, v40
v_and_b32 v65, s23, v40
v_lshlrev_b32 v66, 16, v41
v_and_b32 v67, s23, v41
v_lshlrev_b32 v68, 16, v42
v_and_b32 v69, s23, v42
v_lshlrev_b32 v70, 16, v43
v_and_b32 v71, s23, v43
v_pk_fma_f32 v[160:161], v[64:65], v[8:9], v[160:161]
v_pk_fma_f32 v[162:163], v[66:67], v[8:9], v[162:163]
v_pk_fma_f32 v[168:169], v[68:69], v[8:9], v[168:169]
v_pk_fma_f32 v[170:171], v[70:71], v[8:9], v[170:171]
v_cvt_pk_bf16_f32 v160, v160, v161
v_cvt_pk_bf16_f32 v161, v162, v163
v_cvt_pk_bf16_f32 v162, v168, v169
v_cvt_pk_bf16_f32 v163, v170, v171
buffer_load_dwordx4 v114, s[36:39], s81 offen offset:2048 lds
v_lshlrev_b32 v64, 16, v44
v_and_b32 v65, s23, v44
v_lshlrev_b32 v66, 16, v45
v_and_b32 v67, s23, v45
v_lshlrev_b32 v68, 16, v46
v_and_b32 v69, s23, v46
v_lshlrev_b32 v70, 16, v47
v_and_b32 v71, s23, v47
v_pk_fma_f32 v[176:177], v[64:65], v[8:9], v[176:177]
v_pk_fma_f32 v[178:179], v[66:67], v[8:9], v[178:179]
v_pk_fma_f32 v[184:185], v[68:69], v[8:9], v[184:185]
v_pk_fma_f32 v[186:187], v[70:71], v[8:9], v[186:187]
v_cvt_pk_bf16_f32 v176, v176, v177
v_cvt_pk_bf16_f32 v177, v178, v179
v_cvt_pk_bf16_f32 v178, v184, v185
v_cvt_pk_bf16_f32 v179, v186, v187
buffer_load_dwordx4 v115, s[36:39], s81 offen offset:3072 lds
v_lshlrev_b32 v64, 16, v48
v_and_b32 v65, s23, v48
v_lshlrev_b32 v66, 16, v49
v_and_b32 v67, s23, v49
v_lshlrev_b32 v68, 16, v50
v_and_b32 v69, s23, v50
v_lshlrev_b32 v70, 16, v51
v_and_b32 v71, s23, v51
v_pk_fma_f32 v[192:193], v[64:65], v[8:9], v[192:193]
v_pk_fma_f32 v[194:195], v[66:67], v[8:9], v[194:195]
v_pk_fma_f32 v[200:201], v[68:69], v[8:9], v[200:201]
v_pk_fma_f32 v[202:203], v[70:71], v[8:9], v[202:203]
v_cvt_pk_bf16_f32 v192, v192, v193
v_cvt_pk_bf16_f32 v193, v194, v195
v_cvt_pk_bf16_f32 v194, v200, v201
v_cvt_pk_bf16_f32 v195, v202, v203
s_add_u32 s81, s81, 28672
s_add_u32 m0, s18, 102400
s_nop 0
buffer_load_dwordx4 v112, s[36:39], s81 offen offset:0 lds
v_lshlrev_b32 v64, 16, v52
v_and_b32 v65, s23, v52
v_lshlrev_b32 v66, 16, v53
v_and_b32 v67, s23, v53
v_lshlrev_b32 v68, 16, v54
v_and_b32 v69, s23, v54
v_lshlrev_b32 v70, 16, v55
v_and_b32 v71, s23, v55
v_pk_fma_f32 v[208:209], v[64:65], v[8:9], v[208:209]
v_pk_fma_f32 v[210:211], v[66:67], v[8:9], v[210:211]
v_pk_fma_f32 v[216:217], v[68:69], v[8:9], v[216:217]
v_pk_fma_f32 v[218:219], v[70:71], v[8:9], v[218:219]
v_cvt_pk_bf16_f32 v208, v208, v209
v_cvt_pk_bf16_f32 v209, v210, v211
v_cvt_pk_bf16_f32 v210, v216, v217
v_cvt_pk_bf16_f32 v211, v218, v219
buffer_load_dwordx4 v113, s[36:39], s81 offen offset:1024 lds
v_lshlrev_b32 v64, 16, v56
v_and_b32 v65, s23, v56
v_lshlrev_b32 v66, 16, v57
v_and_b32 v67, s23, v57
v_lshlrev_b32 v68, 16, v58
v_and_b32 v69, s23, v58
v_lshlrev_b32 v70, 16, v59
v_and_b32 v71, s23, v59
v_pk_fma_f32 v[224:225], v[64:65], v[8:9], v[224:225]
v_pk_fma_f32 v[226:227], v[66:67], v[8:9], v[226:227]
v_pk_fma_f32 v[232:233], v[68:69], v[8:9], v[232:233]
v_pk_fma_f32 v[234:235], v[70:71], v[8:9], v[234:235]
v_cvt_pk_bf16_f32 v224, v224, v225
v_cvt_pk_bf16_f32 v225, v226, v227
v_cvt_pk_bf16_f32 v226, v232, v233
v_cvt_pk_bf16_f32 v227, v234, v235
buffer_load_dwordx4 v114, s[36:39], s81 offen offset:2048 lds
v_lshlrev_b32 v64, 16, v60
v_and_b32 v65, s23, v60
v_lshlrev_b32 v66, 16, v61
v_and_b32 v67, s23, v61
v_lshlrev_b32 v68, 16, v62
v_and_b32 v69, s23, v62
v_lshlrev_b32 v70, 16, v63
v_and_b32 v71, s23, v63
v_pk_fma_f32 v[240:241], v[64:65], v[8:9], v[240:241]
v_pk_fma_f32 v[242:243], v[66:67], v[8:9], v[242:243]
v_pk_fma_f32 v[248:249], v[68:69], v[8:9], v[248:249]
v_pk_fma_f32 v[250:251], v[70:71], v[8:9], v[250:251]
v_cvt_pk_bf16_f32 v240, v240, v241
v_cvt_pk_bf16_f32 v241, v242, v243
v_cvt_pk_bf16_f32 v242, v248, v249
v_cvt_pk_bf16_f32 v243, v250, v251
buffer_load_dwordx4 v115, s[36:39], s81 offen offset:3072 lds
v_accvgpr_read_b32 v32, a32
v_accvgpr_read_b32 v33, a33
v_accvgpr_read_b32 v34, a34
v_accvgpr_read_b32 v35, a35
v_lshlrev_b32 v64, 16, v32
v_and_b32 v65, s23, v32
v_lshlrev_b32 v66, 16, v33
v_and_b32 v67, s23, v33
v_lshlrev_b32 v68, 16, v34
v_and_b32 v69, s23, v34
v_lshlrev_b32 v70, 16, v35
v_and_b32 v71, s23, v35
v_pk_fma_f32 v[132:133], v[64:65], v[10:11], v[132:133]
v_pk_fma_f32 v[134:135], v[66:67], v[10:11], v[134:135]
v_pk_fma_f32 v[140:141], v[68:69], v[10:11], v[140:141]
v_pk_fma_f32 v[142:143], v[70:71], v[10:11], v[142:143]
v_cvt_pk_bf16_f32 v132, v132, v133
v_cvt_pk_bf16_f32 v133, v134, v135
v_cvt_pk_bf16_f32 v134, v140, v141
v_cvt_pk_bf16_f32 v135, v142, v143
s_sub_u32 s81, s81, 28544
s_add_u32 m0, s18, 131072
s_nop 0
buffer_load_dwordx4 v112, s[36:39], s81 offen offset:0 lds
v_accvgpr_read_b32 v36, a36
v_accvgpr_read_b32 v37, a37
v_accvgpr_read_b32 v38, a38
v_accvgpr_read_b32 v39, a39
v_lshlrev_b32 v64, 16, v36
v_and_b32 v65, s23, v36
v_lshlrev_b32 v66, 16, v37
v_and_b32 v67, s23, v37
v_lshlrev_b32 v68, 16, v38
v_and_b32 v69, s23, v38
v_lshlrev_b32 v70, 16, v39
v_and_b32 v71, s23, v39
v_pk_fma_f32 v[148:149], v[64:65], v[10:11], v[148:149]
v_pk_fma_f32 v[150:151], v[66:67], v[10:11], v[150:151]
v_pk_fma_f32 v[156:157], v[68:69], v[10:11], v[156:157]
v_pk_fma_f32 v[158:159], v[70:71], v[10:11], v[158:159]
v_cvt_pk_bf16_f32 v148, v148, v149
v_cvt_pk_bf16_f32 v149, v150, v151
v_cvt_pk_bf16_f32 v150, v156, v157
v_cvt_pk_bf16_f32 v151, v158, v159
buffer_load_dwordx4 v113, s[36:39], s81 offen offset:1024 lds
v_accvgpr_read_b32 v40, a40
v_accvgpr_read_b32 v41, a41
v_accvgpr_read_b32 v42, a42
v_accvgpr_read_b32 v43, a43
v_lshlrev_b32 v64, 16, v40
v_and_b32 v65, s23, v40
v_lshlrev_b32 v66, 16, v41
v_and_b32 v67, s23, v41
v_lshlrev_b32 v68, 16, v42
v_and_b32 v69, s23, v42
v_lshlrev_b32 v70, 16, v43
v_and_b32 v71, s23, v43
v_pk_fma_f32 v[164:165], v[64:65], v[10:11], v[164:165]
v_pk_fma_f32 v[166:167], v[66:67], v[10:11], v[166:167]
v_pk_fma_f32 v[172:173], v[68:69], v[10:11], v[172:173]
v_pk_fma_f32 v[174:175], v[70:71], v[10:11], v[174:175]
v_cvt_pk_bf16_f32 v164, v164, v165
v_cvt_pk_bf16_f32 v165, v166, v167
v_cvt_pk_bf16_f32 v166, v172, v173
v_cvt_pk_bf16_f32 v167, v174, v175
buffer_load_dwordx4 v114, s[36:39], s81 offen offset:2048 lds
v_accvgpr_read_b32 v44, a44
v_accvgpr_read_b32 v45, a45
v_accvgpr_read_b32 v46, a46
v_accvgpr_read_b32 v47, a47
v_lshlrev_b32 v64, 16, v44
v_and_b32 v65, s23, v44
v_lshlrev_b32 v66, 16, v45
v_and_b32 v67, s23, v45
v_lshlrev_b32 v68, 16, v46
v_and_b32 v69, s23, v46
v_lshlrev_b32 v70, 16, v47
v_and_b32 v71, s23, v47
v_pk_fma_f32 v[180:181], v[64:65], v[10:11], v[180:181]
v_pk_fma_f32 v[182:183], v[66:67], v[10:11], v[182:183]
v_pk_fma_f32 v[188:189], v[68:69], v[10:11], v[188:189]
v_pk_fma_f32 v[190:191], v[70:71], v[10:11], v[190:191]
v_cvt_pk_bf16_f32 v180, v180, v181
v_cvt_pk_bf16_f32 v181, v182, v183
v_cvt_pk_bf16_f32 v182, v188, v189
v_cvt_pk_bf16_f32 v183, v190, v191
buffer_load_dwordx4 v115, s[36:39], s81 offen offset:3072 lds
v_accvgpr_read_b32 v48, a48
v_accvgpr_read_b32 v49, a49
v_accvgpr_read_b32 v50, a50
v_accvgpr_read_b32 v51, a51
v_lshlrev_b32 v64, 16, v48
v_and_b32 v65, s23, v48
v_lshlrev_b32 v66, 16, v49
v_and_b32 v67, s23, v49
v_lshlrev_b32 v68, 16, v50
v_and_b32 v69, s23, v50
v_lshlrev_b32 v70, 16, v51
v_and_b32 v71, s23, v51
v_pk_fma_f32 v[196:197], v[64:65], v[10:11], v[196:197]
v_pk_fma_f32 v[198:199], v[66:67], v[10:11], v[198:199]
v_pk_fma_f32 v[204:205], v[68:69], v[10:11], v[204:205]
v_pk_fma_f32 v[206:207], v[70:71], v[10:11], v[206:207]
v_cvt_pk_bf16_f32 v196, v196, v197
v_cvt_pk_bf16_f32 v197, v198, v199
v_cvt_pk_bf16_f32 v198, v204, v205
v_cvt_pk_bf16_f32 v199, v206, v207
s_add_u32 s81, s81, 28672
s_add_u32 m0, s18, 135168
s_nop 0
buffer_load_dwordx4 v112, s[36:39], s81 offen offset:0 lds
v_accvgpr_read_b32 v52, a52
v_accvgpr_read_b32 v53, a53
v_accvgpr_read_b32 v54, a54
v_accvgpr_read_b32 v55, a55
v_lshlrev_b32 v64, 16, v52
v_and_b32 v65, s23, v52
v_lshlrev_b32 v66, 16, v53
v_and_b32 v67, s23, v53
v_lshlrev_b32 v68, 16, v54
v_and_b32 v69, s23, v54
v_lshlrev_b32 v70, 16, v55
v_and_b32 v71, s23, v55
v_pk_fma_f32 v[212:213], v[64:65], v[10:11], v[212:213]
v_pk_fma_f32 v[214:215], v[66:67], v[10:11], v[214:215]
v_pk_fma_f32 v[220:221], v[68:69], v[10:11], v[220:221]
v_pk_fma_f32 v[222:223], v[70:71], v[10:11], v[222:223]
v_cvt_pk_bf16_f32 v212, v212, v213
v_cvt_pk_bf16_f32 v213, v214, v215
v_cvt_pk_bf16_f32 v214, v220, v221
v_cvt_pk_bf16_f32 v215, v222, v223
buffer_load_dwordx4 v113, s[36:39], s81 offen offset:1024 lds
v_accvgpr_read_b32 v56, a56
v_accvgpr_read_b32 v57, a57
v_accvgpr_read_b32 v58, a58
v_accvgpr_read_b32 v59, a59
v_lshlrev_b32 v64, 16, v56
v_and_b32 v65, s23, v56
v_lshlrev_b32 v66, 16, v57
v_and_b32 v67, s23, v57
v_lshlrev_b32 v68, 16, v58
v_and_b32 v69, s23, v58
v_lshlrev_b32 v70, 16, v59
v_and_b32 v71, s23, v59
v_pk_fma_f32 v[228:229], v[64:65], v[10:11], v[228:229]
v_pk_fma_f32 v[230:231], v[66:67], v[10:11], v[230:231]
v_pk_fma_f32 v[236:237], v[68:69], v[10:11], v[236:237]
v_pk_fma_f32 v[238:239], v[70:71], v[10:11], v[238:239]
v_cvt_pk_bf16_f32 v228, v228, v229
v_cvt_pk_bf16_f32 v229, v230, v231
v_cvt_pk_bf16_f32 v230, v236, v237
v_cvt_pk_bf16_f32 v231, v238, v239
buffer_load_dwordx4 v114, s[36:39], s81 offen offset:2048 lds
v_accvgpr_read_b32 v60, a60
v_accvgpr_read_b32 v61, a61
v_accvgpr_read_b32 v62, a62
v_accvgpr_read_b32 v63, a63
v_lshlrev_b32 v64, 16, v60
v_and_b32 v65, s23, v60
v_lshlrev_b32 v66, 16, v61
v_and_b32 v67, s23, v61
v_lshlrev_b32 v68, 16, v62
v_and_b32 v69, s23, v62
v_lshlrev_b32 v70, 16, v63
v_and_b32 v71, s23, v63
v_pk_fma_f32 v[244:245], v[64:65], v[10:11], v[244:245]
v_pk_fma_f32 v[246:247], v[66:67], v[10:11], v[246:247]
v_pk_fma_f32 v[252:253], v[68:69], v[10:11], v[252:253]
v_pk_fma_f32 v[254:255], v[70:71], v[10:11], v[254:255]
v_cvt_pk_bf16_f32 v244, v244, v245
v_cvt_pk_bf16_f32 v245, v246, v247
v_cvt_pk_bf16_f32 v246, v252, v253
v_cvt_pk_bf16_f32 v247, v254, v255
buffer_load_dwordx4 v115, s[36:39], s81 offen offset:3072 lds
s_sub_u32 s81, s81, 28544
K2_done:
PAD_13:
s_cbranch_execz PAD_17
s_waitcnt vmcnt(16)
s_barrier
ds_read_b64_tr_b16 a[64:65], v116 offset:0
ds_read_b64_tr_b16 a[66:67], v116 offset:2048
ds_read_b64_tr_b16 a[68:69], v116 offset:4096
ds_read_b64_tr_b16 a[70:71], v116 offset:6144
ds_read_b64_tr_b16 a[72:73], v116 offset:8192
ds_read_b64_tr_b16 a[74:75], v116 offset:10240
ds_read_b64_tr_b16 a[76:77], v116 offset:12288
ds_read_b64_tr_b16 a[78:79], v116 offset:14336
ds_read_b64_tr_b16 a[80:81], v116 offset:16384
ds_read_b64_tr_b16 a[82:83], v116 offset:18432
ds_read_b64_tr_b16 a[84:85], v116 offset:20480
ds_read_b64_tr_b16 a[86:87], v116 offset:22528
ds_read_b64_tr_b16 a[88:89], v116 offset:24576
ds_read_b64_tr_b16 a[90:91], v116 offset:26624
ds_read_b64_tr_b16 a[92:93], v116 offset:28672
ds_read_b64_tr_b16 a[94:95], v116 offset:30720
v_add_u32 v116, 65536, v116
s_waitcnt lgkmcnt(14)
v_mfma_f32_16x16x32_bf16 v[32:35], a[64:67], v[128:131], 0
s_waitcnt lgkmcnt(12)
s_add_u32 m0, s18, 65536
ds_read_b64_tr_b16 a[96:97], v117 offset:0
v_mov_b32 v28, v24
v_mfma_f32_16x16x32_bf16 v[32:35], a[68:71], v[144:147], v[32:35]
s_waitcnt lgkmcnt(11)
buffer_load_dwordx4 v112, s[36:39], s81 offen offset:0 lds
ds_read_b64_tr_b16 a[98:99], v117 offset:2048
v_mfma_f32_16x16x32_bf16 v[32:35], a[72:75], v[160:163], v[32:35]
s_waitcnt lgkmcnt(10)
ds_read_b64_tr_b16 a[100:101], v117 offset:4096
v_permlane16_swap_b32 v24, v28
v_mfma_f32_16x16x32_bf16 v[32:35], a[76:79], v[176:179], v[32:35]
s_waitcnt lgkmcnt(9)
ds_read_b64_tr_b16 a[102:103], v117 offset:6144
v_add_f32 v24, v24, v28
v_mfma_f32_16x16x32_bf16 v[32:35], a[80:83], v[192:195], v[32:35]
s_waitcnt lgkmcnt(8)
buffer_load_dwordx4 v113, s[36:39], s81 offen offset:1024 lds
ds_read_b64_tr_b16 a[104:105], v117 offset:8192
v_mfma_f32_16x16x32_bf16 v[32:35], a[84:87], v[208:211], v[32:35]
s_waitcnt lgkmcnt(7)
ds_read_b64_tr_b16 a[106:107], v117 offset:10240
v_mov_b32 v28, v24
v_mfma_f32_16x16x32_bf16 v[32:35], a[88:91], v[224:227], v[32:35]
s_waitcnt lgkmcnt(6)
ds_read_b64_tr_b16 a[108:109], v117 offset:12288
v_lshrrev_b32 v20, 4, v1
v_mfma_f32_16x16x32_bf16 v[32:35], a[92:95], v[240:243], v[32:35]
buffer_load_dwordx4 v114, s[36:39], s81 offen offset:2048 lds
ds_read_b64_tr_b16 a[110:111], v117 offset:14336
v_mfma_f32_16x16x32_bf16 v[36:39], a[64:67], v[132:135], 0
PAD_14:
s_cbranch_execz PAD_18
ds_read_b64_tr_b16 a[112:113], v117 offset:16384
v_permlane32_swap_b32 v24, v28
v_mfma_f32_16x16x32_bf16 v[36:39], a[68:71], v[148:151], v[36:39]
ds_read_b64_tr_b16 a[114:115], v117 offset:18432
v_add_f32 v24, v24, v28
v_mfma_f32_16x16x32_bf16 v[36:39], a[72:75], v[164:167], v[36:39]
buffer_load_dwordx4 v115, s[36:39], s81 offen offset:3072 lds
ds_read_b64_tr_b16 a[116:117], v117 offset:20480
v_mfma_f32_16x16x32_bf16 v[36:39], a[76:79], v[180:183], v[36:39]
ds_read_b64_tr_b16 a[118:119], v117 offset:22528
v_mov_b32 v29, v25
v_mfma_f32_16x16x32_bf16 v[36:39], a[80:83], v[196:199], v[36:39]
s_add_u32 s81, s81, 28672
s_add_u32 m0, s18, 69632
ds_read_b64_tr_b16 a[120:121], v117 offset:24576
v_mfma_f32_16x16x32_bf16 v[36:39], a[84:87], v[212:215], v[36:39]
buffer_load_dwordx4 v112, s[36:39], s81 offen offset:0 lds
ds_read_b64_tr_b16 a[122:123], v117 offset:26624
v_mfma_f32_16x16x32_bf16 v[36:39], a[88:91], v[228:231], v[36:39]
ds_read_b64_tr_b16 a[124:125], v117 offset:28672
v_permlane16_swap_b32 v25, v29
v_mfma_f32_16x16x32_bf16 v[36:39], a[92:95], v[244:247], v[36:39]
s_waitcnt lgkmcnt(8)
ds_read_b64_tr_b16 a[126:127], v117 offset:30720
v_add_u32 v117, 65536, v117
v_mfma_f32_16x16x32_bf16 v[40:43], a[96:99], v[128:131], 0
buffer_load_dwordx4 v113, s[36:39], s81 offen offset:1024 lds
ds_read_b64_tr_b16 a[64:65], v118 offset:0
v_mfma_f32_16x16x32_bf16 v[40:43], a[100:103], v[144:147], v[40:43]
ds_read_b64_tr_b16 a[66:67], v118 offset:2048
v_add_f32 v25, v25, v29
v_mfma_f32_16x16x32_bf16 v[40:43], a[104:107], v[160:163], v[40:43]
s_waitcnt lgkmcnt(8)
ds_read_b64_tr_b16 a[68:69], v118 offset:4096
v_mov_b32 v29, v25
v_mfma_f32_16x16x32_bf16 v[40:43], a[108:111], v[176:179], v[40:43]
buffer_load_dwordx4 v114, s[36:39], s81 offen offset:2048 lds
ds_read_b64_tr_b16 a[70:71], v118 offset:6144
v_mfma_f32_16x16x32_bf16 v[40:43], a[112:115], v[192:195], v[40:43]
s_waitcnt lgkmcnt(8)
ds_read_b64_tr_b16 a[72:73], v118 offset:8192
v_permlane32_swap_b32 v25, v29
v_mfma_f32_16x16x32_bf16 v[40:43], a[116:119], v[208:211], v[40:43]
s_waitcnt lgkmcnt(7)
ds_read_b64_tr_b16 a[74:75], v118 offset:10240
v_add_f32 v25, v25, v29
v_mfma_f32_16x16x32_bf16 v[40:43], a[120:123], v[224:227], v[40:43]
s_waitcnt lgkmcnt(6)
buffer_load_dwordx4 v115, s[36:39], s81 offen offset:3072 lds
ds_read_b64_tr_b16 a[76:77], v118 offset:12288
v_mfma_f32_16x16x32_bf16 v[40:43], a[124:127], v[240:243], v[40:43]
ds_read_b64_tr_b16 a[78:79], v118 offset:14336
v_rcp_f32 v24, v24
v_mfma_f32_16x16x32_bf16 v[44:47], a[96:99], v[132:135], 0
s_sub_u32 s81, s81, 28544
s_add_u32 m0, s18, 0
ds_read_b64_tr_b16 a[80:81], v118 offset:16384
v_mfma_f32_16x16x32_bf16 v[44:47], a[100:103], v[148:151], v[44:47]
buffer_load_dwordx4 v112, s[36:39], s81 offen offset:0 lds
ds_read_b64_tr_b16 a[82:83], v118 offset:18432
v_mfma_f32_16x16x32_bf16 v[44:47], a[104:107], v[164:167], v[44:47]
ds_read_b64_tr_b16 a[84:85], v118 offset:20480
v_rcp_f32 v25, v25
v_mfma_f32_16x16x32_bf16 v[44:47], a[108:111], v[180:183], v[44:47]
ds_read_b64_tr_b16 a[86:87], v118 offset:22528
v_and_b32 v19, 15, v20
v_mfma_f32_16x16x32_bf16 v[44:47], a[112:115], v[196:199], v[44:47]
buffer_load_dwordx4 v113, s[36:39], s81 offen offset:1024 lds
ds_read_b64_tr_b16 a[88:89], v118 offset:24576
v_mfma_f32_16x16x32_bf16 v[44:47], a[116:119], v[212:215], v[44:47]
ds_read_b64_tr_b16 a[90:91], v118 offset:26624
v_mul_f32 v32, v32, v24
v_mfma_f32_16x16x32_bf16 v[44:47], a[120:123], v[228:231], v[44:47]
ds_read_b64_tr_b16 a[92:93], v118 offset:28672
v_mul_f32 v33, v33, v24
v_mfma_f32_16x16x32_bf16 v[44:47], a[124:127], v[244:247], v[44:47]
s_waitcnt lgkmcnt(8)
ds_read_b64_tr_b16 a[94:95], v118 offset:30720
v_add_u32 v118, 65536, v118
v_mfma_f32_16x16x32_bf16 v[48:51], a[64:67], v[128:131], 0
buffer_load_dwordx4 v114, s[36:39], s81 offen offset:2048 lds
ds_read_b64_tr_b16 a[96:97], v119 offset:0
v_mfma_f32_16x16x32_bf16 v[48:51], a[68:71], v[144:147], v[48:51]
ds_read_b64_tr_b16 a[98:99], v119 offset:2048
v_mul_f32 v34, v34, v24
v_mfma_f32_16x16x32_bf16 v[48:51], a[72:75], v[160:163], v[48:51]
s_waitcnt lgkmcnt(8)
ds_read_b64_tr_b16 a[100:101], v119 offset:4096
v_mul_f32 v35, v35, v24
v_mfma_f32_16x16x32_bf16 v[48:51], a[76:79], v[176:179], v[48:51]
buffer_load_dwordx4 v115, s[36:39], s81 offen offset:3072 lds
ds_read_b64_tr_b16 a[102:103], v119 offset:6144
v_mfma_f32_16x16x32_bf16 v[48:51], a[80:83], v[192:195], v[48:51]
s_waitcnt lgkmcnt(6)
ds_read_b64_tr_b16 a[104:105], v119 offset:8192
v_mul_f32 v40, v40, v24
v_mfma_f32_16x16x32_bf16 v[48:51], a[84:87], v[208:211], v[48:51]
s_add_u32 s81, s81, 28672
s_add_u32 m0, s18, 4096
ds_read_b64_tr_b16 a[106:107], v119 offset:10240
v_mfma_f32_16x16x32_bf16 v[48:51], a[88:91], v[224:227], v[48:51]
s_waitcnt lgkmcnt(6)
buffer_load_dwordx4 v112, s[36:39], s81 offen offset:0 lds
ds_read_b64_tr_b16 a[108:109], v119 offset:12288
v_mfma_f32_16x16x32_bf16 v[48:51], a[92:95], v[240:243], v[48:51]
ds_read_b64_tr_b16 a[110:111], v119 offset:14336
v_mul_f32 v41, v41, v24
v_mfma_f32_16x16x32_bf16 v[52:55], a[64:67], v[132:135], 0
ds_read_b64_tr_b16 a[112:113], v119 offset:16384
v_mul_f32 v42, v42, v24
v_mfma_f32_16x16x32_bf16 v[52:55], a[68:71], v[148:151], v[52:55]
buffer_load_dwordx4 v113, s[36:39], s81 offen offset:1024 lds
ds_read_b64_tr_b16 a[114:115], v119 offset:18432
v_mfma_f32_16x16x32_bf16 v[52:55], a[72:75], v[164:167], v[52:55]
ds_read_b64_tr_b16 a[116:117], v119 offset:20480
v_mul_f32 v43, v43, v24
v_mfma_f32_16x16x32_bf16 v[52:55], a[76:79], v[180:183], v[52:55]
ds_read_b64_tr_b16 a[118:119], v119 offset:22528
v_cvt_pk_bf16_f32 v32, v32, v33
v_mfma_f32_16x16x32_bf16 v[52:55], a[80:83], v[196:199], v[52:55]
buffer_load_dwordx4 v114, s[36:39], s81 offen offset:2048 lds
ds_read_b64_tr_b16 a[120:121], v119 offset:24576
v_mfma_f32_16x16x32_bf16 v[52:55], a[84:87], v[212:215], v[52:55]
ds_read_b64_tr_b16 a[122:123], v119 offset:26624
v_cvt_pk_bf16_f32 v33, v34, v35
v_mfma_f32_16x16x32_bf16 v[52:55], a[88:91], v[228:231], v[52:55]
ds_read_b64_tr_b16 a[124:125], v119 offset:28672
ds_read_b64_tr_b16 a[126:127], v119 offset:30720
v_mfma_f32_16x16x32_bf16 v[52:55], a[92:95], v[244:247], v[52:55]
s_waitcnt vmcnt(23) lgkmcnt(9)
s_barrier
v_add_u32 v119, 65536, v119
v_mfma_f32_16x16x32_bf16 v[56:59], a[96:99], v[128:131], 0
buffer_load_dwordx4 v115, s[36:39], s81 offen offset:3072 lds
ds_read_b64_tr_b16 a[64:65], v116 offset:0
v_mfma_f32_16x16x32_bf16 v[56:59], a[100:103], v[144:147], v[56:59]
s_waitcnt lgkmcnt(8)
ds_read_b64_tr_b16 a[66:67], v116 offset:2048
v_cvt_pk_bf16_f32 v34, v40, v41
v_mfma_f32_16x16x32_bf16 v[56:59], a[104:107], v[160:163], v[56:59]
s_sub_u32 s81, s81, 28544
ds_read_b64_tr_b16 a[68:69], v116 offset:4096
v_cvt_pk_bf16_f32 v35, v42, v43
v_mfma_f32_16x16x32_bf16 v[56:59], a[108:111], v[176:179], v[56:59]
s_waitcnt lgkmcnt(8)
buffer_store_dwordx4 v[32:35], v1, s[4:7], s8 offen offset:0 sc1
ds_read_b64_tr_b16 a[70:71], v116 offset:6144
v_mfma_f32_16x16x32_bf16 v[56:59], a[112:115], v[192:195], v[56:59]
s_waitcnt lgkmcnt(8)
ds_read_b64_tr_b16 a[72:73], v116 offset:8192
v_mul_f32 v36, v36, v25
v_mfma_f32_16x16x32_bf16 v[56:59], a[116:119], v[208:211], v[56:59]
s_waitcnt lgkmcnt(7)
ds_read_b64_tr_b16 a[74:75], v116 offset:10240
v_mul_f32 v37, v37, v25
v_mfma_f32_16x16x32_bf16 v[56:59], a[120:123], v[224:227], v[56:59]
s_waitcnt lgkmcnt(6)
ds_read_b64_tr_b16 a[76:77], v116 offset:12288
v_mul_f32 v38, v38, v25
v_mfma_f32_16x16x32_bf16 v[56:59], a[124:127], v[240:243], v[56:59]
ds_read_b64_tr_b16 a[78:79], v116 offset:14336
v_mul_f32 v39, v39, v25
v_mfma_f32_16x16x32_bf16 v[60:63], a[96:99], v[132:135], 0
ds_read_b64_tr_b16 a[80:81], v116 offset:16384
v_mul_f32 v44, v44, v25
v_mfma_f32_16x16x32_bf16 v[60:63], a[100:103], v[148:151], v[60:63]
ds_read_b64_tr_b16 a[82:83], v116 offset:18432
v_mul_f32 v45, v45, v25
v_mfma_f32_16x16x32_bf16 v[60:63], a[104:107], v[164:167], v[60:63]
ds_read_b64_tr_b16 a[84:85], v116 offset:20480
v_mul_f32 v46, v46, v25
v_mfma_f32_16x16x32_bf16 v[60:63], a[108:111], v[180:183], v[60:63]
ds_read_b64_tr_b16 a[86:87], v116 offset:22528
v_mul_f32 v47, v47, v25
v_mfma_f32_16x16x32_bf16 v[60:63], a[112:115], v[196:199], v[60:63]
ds_read_b64_tr_b16 a[88:89], v116 offset:24576
v_cvt_pk_bf16_f32 v36, v36, v37
v_mfma_f32_16x16x32_bf16 v[60:63], a[116:119], v[212:215], v[60:63]
ds_read_b64_tr_b16 a[90:91], v116 offset:26624
v_cvt_pk_bf16_f32 v37, v38, v39
v_mfma_f32_16x16x32_bf16 v[60:63], a[120:123], v[228:231], v[60:63]
ds_read_b64_tr_b16 a[92:93], v116 offset:28672
v_cvt_pk_bf16_f32 v38, v44, v45
v_mfma_f32_16x16x32_bf16 v[60:63], a[124:127], v[244:247], v[60:63]
s_waitcnt lgkmcnt(3)
ds_read_b64_tr_b16 a[94:95], v116 offset:30720
v_add_u32 v116, 32768, v116
v_mfma_f32_16x16x32_bf16 v[64:67], a[64:67], v[128:131], 0
s_lshl_b32 s34, s29, 5
ds_read_b64_tr_b16 a[96:97], v117 offset:0
v_cvt_pk_bf16_f32 v39, v46, v47
v_mfma_f32_16x16x32_bf16 v[64:67], a[68:71], v[144:147], v[64:67]
s_add_u32 s34, s34, s20
buffer_store_dwordx4 v[36:39], v1, s[4:7], s12 offen offset:0 sc1
ds_read_b64_tr_b16 a[98:99], v117 offset:2048
v_mfma_f32_16x16x32_bf16 v[64:67], a[72:75], v[160:163], v[64:67]
s_lshl_b32 s34, s34, 2
ds_read_b64_tr_b16 a[100:101], v117 offset:4096
v_mul_f32 v48, v48, v24
v_mfma_f32_16x16x32_bf16 v[64:67], a[76:79], v[176:179], v[64:67]
s_add_u32 s34, s34, 94380032
ds_read_b64_tr_b16 a[102:103], v117 offset:6144
v_mul_f32 v49, v49, v24
v_mfma_f32_16x16x32_bf16 v[64:67], a[80:83], v[192:195], v[64:67]
s_add_u32 s35, s34, 2048
ds_read_b64_tr_b16 a[104:105], v117 offset:8192
v_mul_f32 v50, v50, v24
v_mfma_f32_16x16x32_bf16 v[64:67], a[84:87], v[208:211], v[64:67]
s_waitcnt lgkmcnt(5)
s_add_u32 s44, s34, 6144
ds_read_b64_tr_b16 a[106:107], v117 offset:10240
v_mul_f32 v51, v51, v24
v_mfma_f32_16x16x32_bf16 v[64:67], a[88:91], v[224:227], v[64:67]
s_min_u32 s80, s21, 6
ds_read_b64_tr_b16 a[108:109], v117 offset:12288
v_mul_f32 v56, v56, v24
v_mfma_f32_16x16x32_bf16 v[64:67], a[92:95], v[240:243], v[64:67]
s_add_u32 s79, s2, 0
ds_read_b64_tr_b16 a[110:111], v117 offset:14336
v_mul_f32 v57, v57, v24
v_mfma_f32_16x16x32_bf16 v[68:71], a[64:67], v[132:135], 0
s_lshr_b32 s79, s79, 4
ds_read_b64_tr_b16 a[112:113], v117 offset:16384
v_mul_f32 v58, v58, v24
v_mfma_f32_16x16x32_bf16 v[68:71], a[68:71], v[148:151], v[68:71]
s_or_b32 s79, s79, s2
ds_read_b64_tr_b16 a[114:115], v117 offset:18432
v_mul_f32 v59, v59, v24
v_mfma_f32_16x16x32_bf16 v[68:71], a[72:75], v[164:167], v[68:71]
s_andn2_b32 s79, 16, s79
ds_read_b64_tr_b16 a[116:117], v117 offset:20480
v_cvt_pk_bf16_f32 v48, v48, v49
v_mfma_f32_16x16x32_bf16 v[68:71], a[76:79], v[180:183], v[68:71]
s_add_u32 s79, s79, s20
ds_read_b64_tr_b16 a[118:119], v117 offset:22528
v_cvt_pk_bf16_f32 v49, v50, v51
v_mfma_f32_16x16x32_bf16 v[68:71], a[80:83], v[196:199], v[68:71]
s_lshl_b32 s22, s79, 2
ds_read_b64_tr_b16 a[120:121], v117 offset:24576
v_cvt_pk_bf16_f32 v50, v56, v57
v_mfma_f32_16x16x32_bf16 v[68:71], a[84:87], v[212:215], v[68:71]
s_add_u32 s22, s22, s3
ds_read_b64_tr_b16 a[122:123], v117 offset:26624
v_cvt_pk_bf16_f32 v51, v58, v59
v_mfma_f32_16x16x32_bf16 v[68:71], a[88:91], v[228:231], v[68:71]
s_mul_i32 s25, s22, 28672
buffer_store_dwordx4 v[48:51], v1, s[4:7], s8 offen offset:1024 sc1
ds_read_b64_tr_b16 a[124:125], v117 offset:28672
v_mfma_f32_16x16x32_bf16 v[68:71], a[92:95], v[244:247], v[68:71]
s_waitcnt lgkmcnt(3)
s_lshl_b32 s23, s80, 6
ds_read_b64_tr_b16 a[126:127], v117 offset:30720
v_add_u32 v117, 32768, v117
v_mfma_f32_16x16x32_bf16 v[72:75], a[96:99], v[128:131], 0
s_add_u32 s25, s25, s23
ds_read_b64_tr_b16 a[64:65], v118 offset:0
v_mul_f32 v52, v52, v25
v_mfma_f32_16x16x32_bf16 v[72:75], a[100:103], v[144:147], v[72:75]
s_mul_i32 s26, s22, 229376
ds_read_b64_tr_b16 a[66:67], v118 offset:2048
v_mul_f32 v53, v53, v25
v_mfma_f32_16x16x32_bf16 v[72:75], a[104:107], v[160:163], v[72:75]
s_lshl_b32 s23, s80, 10
ds_read_b64_tr_b16 a[68:69], v118 offset:4096
v_mul_f32 v54, v54, v25
v_mfma_f32_16x16x32_bf16 v[72:75], a[108:111], v[176:179], v[72:75]
s_add_u32 s26, s26, s23
ds_read_b64_tr_b16 a[70:71], v118 offset:6144
v_mul_f32 v55, v55, v25
v_mfma_f32_16x16x32_bf16 v[72:75], a[112:115], v[192:195], v[72:75]
s_add_u32 s26, s26, 104857600
ds_read_b64_tr_b16 a[72:73], v118 offset:8192
v_mul_f32 v60, v60, v25
v_mfma_f32_16x16x32_bf16 v[72:75], a[116:119], v[208:211], v[72:75]
s_waitcnt lgkmcnt(5)
s_lshr_b32 s22, s79, 1
ds_read_b64_tr_b16 a[74:75], v118 offset:10240
v_mul_f32 v61, v61, v25
v_mfma_f32_16x16x32_bf16 v[72:75], a[120:123], v[224:227], v[72:75]
s_lshl_b32 s22, s22, 7
ds_read_b64_tr_b16 a[76:77], v118 offset:12288
v_mul_f32 v62, v62, v25
v_mfma_f32_16x16x32_bf16 v[72:75], a[124:127], v[240:243], v[72:75]
s_add_u32 s33, s22, 94380032
ds_read_b64_tr_b16 a[78:79], v118 offset:14336
v_mul_f32 v63, v63, v25
v_mfma_f32_16x16x32_bf16 v[76:79], a[96:99], v[132:135], 0
s_mov_b64 s[40:41], s[88:89]
ds_read_b64_tr_b16 a[80:81], v118 offset:16384
v_cvt_pk_bf16_f32 v52, v52, v53
v_mfma_f32_16x16x32_bf16 v[76:79], a[100:103], v[148:151], v[76:79]
s_mov_b32 s42, 3670016
ds_read_b64_tr_b16 a[82:83], v118 offset:18432
v_cvt_pk_bf16_f32 v53, v54, v55
v_mfma_f32_16x16x32_bf16 v[76:79], a[104:107], v[164:167], v[76:79]
s_mov_b32 s43, 0x20000
ds_read_b64_tr_b16 a[84:85], v118 offset:20480
v_cvt_pk_bf16_f32 v54, v60, v61
v_mfma_f32_16x16x32_bf16 v[76:79], a[108:111], v[180:183], v[76:79]
ds_read_b64_tr_b16 a[86:87], v118 offset:22528
v_cvt_pk_bf16_f32 v55, v62, v63
v_mfma_f32_16x16x32_bf16 v[76:79], a[112:115], v[196:199], v[76:79]
buffer_store_dwordx4 v[52:55], v1, s[4:7], s12 offen offset:1024 sc1
ds_read_b64_tr_b16 a[88:89], v118 offset:24576
v_mfma_f32_16x16x32_bf16 v[76:79], a[116:119], v[212:215], v[76:79]
ds_read_b64_tr_b16 a[90:91], v118 offset:26624
v_mfma_f32_16x16x32_bf16 v[76:79], a[120:123], v[228:231], v[76:79]
ds_read_b64_tr_b16 a[92:93], v118 offset:28672
v_mul_f32 v64, v64, v24
v_mfma_f32_16x16x32_bf16 v[76:79], a[124:127], v[244:247], v[76:79]
s_waitcnt lgkmcnt(8)
ds_read_b64_tr_b16 a[94:95], v118 offset:30720
v_add_u32 v118, 32768, v118
v_mfma_f32_16x16x32_bf16 v[80:83], a[64:67], v[128:131], 0
ds_read_b64_tr_b16 a[96:97], v119 offset:0
v_mul_f32 v65, v65, v24
v_mfma_f32_16x16x32_bf16 v[80:83], a[68:71], v[144:147], v[80:83]
ds_read_b64_tr_b16 a[98:99], v119 offset:2048
v_mul_f32 v66, v66, v24
v_mfma_f32_16x16x32_bf16 v[80:83], a[72:75], v[160:163], v[80:83]
s_waitcnt lgkmcnt(8)
ds_read_b64_tr_b16 a[100:101], v119 offset:4096
v_mul_f32 v67, v67, v24
v_mfma_f32_16x16x32_bf16 v[80:83], a[76:79], v[176:179], v[80:83]
ds_read_b64_tr_b16 a[102:103], v119 offset:6144
v_mul_f32 v72, v72, v24
v_mfma_f32_16x16x32_bf16 v[80:83], a[80:83], v[192:195], v[80:83]
s_waitcnt lgkmcnt(8)
ds_read_b64_tr_b16 a[104:105], v119 offset:8192
v_mul_f32 v73, v73, v24
v_mfma_f32_16x16x32_bf16 v[80:83], a[84:87], v[208:211], v[80:83]
s_waitcnt lgkmcnt(7)
ds_read_b64_tr_b16 a[106:107], v119 offset:10240
v_mul_f32 v74, v74, v24
v_mfma_f32_16x16x32_bf16 v[80:83], a[88:91], v[224:227], v[80:83]
s_waitcnt lgkmcnt(6)
ds_read_b64_tr_b16 a[108:109], v119 offset:12288
v_mul_f32 v75, v75, v24
v_mfma_f32_16x16x32_bf16 v[80:83], a[92:95], v[240:243], v[80:83]
ds_read_b64_tr_b16 a[110:111], v119 offset:14336
v_cvt_pk_bf16_f32 v64, v64, v65
v_mfma_f32_16x16x32_bf16 v[84:87], a[64:67], v[132:135], 0
ds_read_b64_tr_b16 a[112:113], v119 offset:16384
v_cvt_pk_bf16_f32 v65, v66, v67
v_mfma_f32_16x16x32_bf16 v[84:87], a[68:71], v[148:151], v[84:87]
ds_read_b64_tr_b16 a[114:115], v119 offset:18432
v_cvt_pk_bf16_f32 v66, v72, v73
v_mfma_f32_16x16x32_bf16 v[84:87], a[72:75], v[164:167], v[84:87]
ds_read_b64_tr_b16 a[116:117], v119 offset:20480
v_cvt_pk_bf16_f32 v67, v74, v75
v_mfma_f32_16x16x32_bf16 v[84:87], a[76:79], v[180:183], v[84:87]
buffer_store_dwordx4 v[64:67], v1, s[4:7], s8 offen offset:2048 sc1
ds_read_b64_tr_b16 a[118:119], v119 offset:22528
v_mfma_f32_16x16x32_bf16 v[84:87], a[80:83], v[196:199], v[84:87]
ds_read_b64_tr_b16 a[120:121], v119 offset:24576
v_mul_f32 v68, v68, v25
v_mfma_f32_16x16x32_bf16 v[84:87], a[84:87], v[212:215], v[84:87]
ds_read_b64_tr_b16 a[122:123], v119 offset:26624
v_mul_f32 v69, v69, v25
v_mfma_f32_16x16x32_bf16 v[84:87], a[88:91], v[228:231], v[84:87]
ds_read_b64_tr_b16 a[124:125], v119 offset:28672
ds_read_b64_tr_b16 a[126:127], v119 offset:30720
v_mfma_f32_16x16x32_bf16 v[84:87], a[92:95], v[244:247], v[84:87]
s_waitcnt vmcnt(21) lgkmcnt(9)
s_barrier
v_add_u32 v119, 32768, v119
v_mfma_f32_16x16x32_bf16 v[88:91], a[96:99], v[128:131], 0
ds_read_b64_tr_b16 a[64:65], v116 offset:0
v_mul_f32 v70, v70, v25
v_mfma_f32_16x16x32_bf16 v[88:91], a[100:103], v[144:147], v[88:91]
ds_read_b64_tr_b16 a[66:67], v116 offset:2048
v_mul_f32 v71, v71, v25
v_mfma_f32_16x16x32_bf16 v[88:91], a[104:107], v[160:163], v[88:91]
s_waitcnt lgkmcnt(8)
ds_read_b64_tr_b16 a[68:69], v116 offset:4096
v_mul_f32 v76, v76, v25
v_mfma_f32_16x16x32_bf16 v[88:91], a[108:111], v[176:179], v[88:91]
ds_read_b64_tr_b16 a[70:71], v116 offset:6144
v_mul_f32 v77, v77, v25
v_mfma_f32_16x16x32_bf16 v[88:91], a[112:115], v[192:195], v[88:91]
s_waitcnt lgkmcnt(8)
ds_read_b64_tr_b16 a[72:73], v116 offset:8192
v_mul_f32 v78, v78, v25
v_mfma_f32_16x16x32_bf16 v[88:91], a[116:119], v[208:211], v[88:91]
s_waitcnt lgkmcnt(7)
ds_read_b64_tr_b16 a[74:75], v116 offset:10240
v_mul_f32 v79, v79, v25
v_mfma_f32_16x16x32_bf16 v[88:91], a[120:123], v[224:227], v[88:91]
s_waitcnt lgkmcnt(6)
ds_read_b64_tr_b16 a[76:77], v116 offset:12288
v_cvt_pk_bf16_f32 v68, v68, v69
v_mfma_f32_16x16x32_bf16 v[88:91], a[124:127], v[240:243], v[88:91]
ds_read_b64_tr_b16 a[78:79], v116 offset:14336
v_cvt_pk_bf16_f32 v69, v70, v71
v_mfma_f32_16x16x32_bf16 v[92:95], a[96:99], v[132:135], 0
ds_read_b64_tr_b16 a[80:81], v116 offset:16384
v_cvt_pk_bf16_f32 v70, v76, v77
v_mfma_f32_16x16x32_bf16 v[92:95], a[100:103], v[148:151], v[92:95]
ds_read_b64_tr_b16 a[82:83], v116 offset:18432
v_cvt_pk_bf16_f32 v71, v78, v79
v_mfma_f32_16x16x32_bf16 v[92:95], a[104:107], v[164:167], v[92:95]
buffer_store_dwordx4 v[68:71], v1, s[4:7], s12 offen offset:2048 sc1
ds_read_b64_tr_b16 a[84:85], v116 offset:20480
v_mfma_f32_16x16x32_bf16 v[92:95], a[108:111], v[180:183], v[92:95]
ds_read_b64_tr_b16 a[86:87], v116 offset:22528
v_mfma_f32_16x16x32_bf16 v[92:95], a[112:115], v[196:199], v[92:95]
ds_read_b64_tr_b16 a[88:89], v116 offset:24576
v_mfma_f32_16x16x32_bf16 v[92:95], a[116:119], v[212:215], v[92:95]
ds_read_b64_tr_b16 a[90:91], v116 offset:26624
v_mfma_f32_16x16x32_bf16 v[92:95], a[120:123], v[228:231], v[92:95]
ds_read_b64_tr_b16 a[92:93], v116 offset:28672
v_mfma_f32_16x16x32_bf16 v[92:95], a[124:127], v[244:247], v[92:95]
s_waitcnt lgkmcnt(8)
ds_read_b64_tr_b16 a[94:95], v116 offset:30720
v_add_u32 v116, 4294901760, v116
v_mfma_f32_16x16x32_bf16 v[32:35], a[64:67], v[128:131], 0
s_add_u32 m0, s18, 32768
ds_read_b64_tr_b16 a[96:97], v117 offset:0
v_mul_f32 v80, v80, v24
v_mfma_f32_16x16x32_bf16 v[32:35], a[68:71], v[144:147], v[32:35]
buffer_load_dwordx4 v112, s[36:39], s81 offen offset:0 lds
ds_read_b64_tr_b16 a[98:99], v117 offset:2048
v_mfma_f32_16x16x32_bf16 v[32:35], a[72:75], v[160:163], v[32:35]
s_waitcnt lgkmcnt(8)
ds_read_b64_tr_b16 a[100:101], v117 offset:4096
v_mul_f32 v81, v81, v24
v_mfma_f32_16x16x32_bf16 v[32:35], a[76:79], v[176:179], v[32:35]
ds_read_b64_tr_b16 a[102:103], v117 offset:6144
v_mul_f32 v82, v82, v24
v_mfma_f32_16x16x32_bf16 v[32:35], a[80:83], v[192:195], v[32:35]
s_waitcnt lgkmcnt(8)
ds_read_b64_tr_b16 a[104:105], v117 offset:8192
v_mul_f32 v83, v83, v24
v_mfma_f32_16x16x32_bf16 v[32:35], a[84:87], v[208:211], v[32:35]
s_waitcnt lgkmcnt(7)
ds_read_b64_tr_b16 a[106:107], v117 offset:10240
v_mul_f32 v88, v88, v24
v_mfma_f32_16x16x32_bf16 v[32:35], a[88:91], v[224:227], v[32:35]
s_waitcnt lgkmcnt(6)
ds_read_b64_tr_b16 a[108:109], v117 offset:12288
v_mul_f32 v89, v89, v24
v_mfma_f32_16x16x32_bf16 v[32:35], a[92:95], v[240:243], v[32:35]
ds_read_b64_tr_b16 a[110:111], v117 offset:14336
v_mul_f32 v90, v90, v24
v_mfma_f32_16x16x32_bf16 v[36:39], a[64:67], v[132:135], 0
buffer_load_dwordx4 v113, s[36:39], s81 offen offset:1024 lds
ds_read_b64_tr_b16 a[112:113], v117 offset:16384
v_mfma_f32_16x16x32_bf16 v[36:39], a[68:71], v[148:151], v[36:39]
ds_read_b64_tr_b16 a[114:115], v117 offset:18432
v_mul_f32 v91, v91, v24
v_mfma_f32_16x16x32_bf16 v[36:39], a[72:75], v[164:167], v[36:39]
ds_read_b64_tr_b16 a[116:117], v117 offset:20480
v_cvt_pk_bf16_f32 v80, v80, v81
v_mfma_f32_16x16x32_bf16 v[36:39], a[76:79], v[180:183], v[36:39]
ds_read_b64_tr_b16 a[118:119], v117 offset:22528
v_cvt_pk_bf16_f32 v81, v82, v83
v_mfma_f32_16x16x32_bf16 v[36:39], a[80:83], v[196:199], v[36:39]
ds_read_b64_tr_b16 a[120:121], v117 offset:24576
v_cvt_pk_bf16_f32 v82, v88, v89
v_mfma_f32_16x16x32_bf16 v[36:39], a[84:87], v[212:215], v[36:39]
ds_read_b64_tr_b16 a[122:123], v117 offset:26624
v_cvt_pk_bf16_f32 v83, v90, v91
v_mfma_f32_16x16x32_bf16 v[36:39], a[88:91], v[228:231], v[36:39]
buffer_store_dwordx4 v[80:83], v1, s[4:7], s8 offen offset:3072 sc1
ds_read_b64_tr_b16 a[124:125], v117 offset:28672
v_mfma_f32_16x16x32_bf16 v[36:39], a[92:95], v[244:247], v[36:39]
s_waitcnt lgkmcnt(8)
ds_read_b64_tr_b16 a[126:127], v117 offset:30720
v_add_u32 v117, 4294901760, v117
v_mfma_f32_16x16x32_bf16 v[40:43], a[96:99], v[128:131], 0
buffer_load_dwordx4 v114, s[36:39], s81 offen offset:2048 lds
ds_read_b64_tr_b16 a[64:65], v118 offset:0
v_mfma_f32_16x16x32_bf16 v[40:43], a[100:103], v[144:147], v[40:43]
ds_read_b64_tr_b16 a[66:67], v118 offset:2048
v_mul_f32 v84, v84, v25
v_mfma_f32_16x16x32_bf16 v[40:43], a[104:107], v[160:163], v[40:43]
s_waitcnt lgkmcnt(8)
ds_read_b64_tr_b16 a[68:69], v118 offset:4096
v_mul_f32 v85, v85, v25
v_mfma_f32_16x16x32_bf16 v[40:43], a[108:111], v[176:179], v[40:43]
ds_read_b64_tr_b16 a[70:71], v118 offset:6144
v_mul_f32 v86, v86, v25
v_mfma_f32_16x16x32_bf16 v[40:43], a[112:115], v[192:195], v[40:43]
s_waitcnt lgkmcnt(8)
ds_read_b64_tr_b16 a[72:73], v118 offset:8192
v_mul_f32 v87, v87, v25
v_mfma_f32_16x16x32_bf16 v[40:43], a[116:119], v[208:211], v[40:43]
s_waitcnt lgkmcnt(7)
ds_read_b64_tr_b16 a[74:75], v118 offset:10240
v_mul_f32 v92, v92, v25
v_mfma_f32_16x16x32_bf16 v[40:43], a[120:123], v[224:227], v[40:43]
s_waitcnt lgkmcnt(6)
ds_read_b64_tr_b16 a[76:77], v118 offset:12288
v_mul_f32 v93, v93, v25
v_mfma_f32_16x16x32_bf16 v[40:43], a[124:127], v[240:243], v[40:43]
buffer_load_dwordx4 v115, s[36:39], s81 offen offset:3072 lds
ds_read_b64_tr_b16 a[78:79], v118 offset:14336
v_mfma_f32_16x16x32_bf16 v[44:47], a[96:99], v[132:135], 0
ds_read_b64_tr_b16 a[80:81], v118 offset:16384
v_mul_f32 v94, v94, v25
v_mfma_f32_16x16x32_bf16 v[44:47], a[100:103], v[148:151], v[44:47]
ds_read_b64_tr_b16 a[82:83], v118 offset:18432
v_mul_f32 v95, v95, v25
v_mfma_f32_16x16x32_bf16 v[44:47], a[104:107], v[164:167], v[44:47]
ds_read_b64_tr_b16 a[84:85], v118 offset:20480
v_cvt_pk_bf16_f32 v84, v84, v85
v_mfma_f32_16x16x32_bf16 v[44:47], a[108:111], v[180:183], v[44:47]
ds_read_b64_tr_b16 a[86:87], v118 offset:22528
v_cvt_pk_bf16_f32 v85, v86, v87
v_mfma_f32_16x16x32_bf16 v[44:47], a[112:115], v[196:199], v[44:47]
ds_read_b64_tr_b16 a[88:89], v118 offset:24576
v_cvt_pk_bf16_f32 v86, v92, v93
v_mfma_f32_16x16x32_bf16 v[44:47], a[116:119], v[212:215], v[44:47]
s_add_u32 s81, s81, 28672
s_add_u32 m0, s18, 36864
ds_read_b64_tr_b16 a[90:91], v118 offset:26624
v_mfma_f32_16x16x32_bf16 v[44:47], a[120:123], v[228:231], v[44:47]
buffer_load_dwordx4 v112, s[36:39], s81 offen offset:0 lds
ds_read_b64_tr_b16 a[92:93], v118 offset:28672
v_mfma_f32_16x16x32_bf16 v[44:47], a[124:127], v[244:247], v[44:47]
s_waitcnt lgkmcnt(8)
ds_read_b64_tr_b16 a[94:95], v118 offset:30720
v_add_u32 v118, 4294901760, v118
v_mfma_f32_16x16x32_bf16 v[48:51], a[64:67], v[128:131], 0
ds_read_b64_tr_b16 a[96:97], v119 offset:0
v_cvt_pk_bf16_f32 v87, v94, v95
v_mfma_f32_16x16x32_bf16 v[48:51], a[68:71], v[144:147], v[48:51]
s_waitcnt lgkmcnt(8)
buffer_store_dwordx4 v[84:87], v1, s[4:7], s12 offen offset:3072 sc1
ds_read_b64_tr_b16 a[98:99], v119 offset:2048
v_mfma_f32_16x16x32_bf16 v[48:51], a[72:75], v[160:163], v[48:51]
s_add_u32 s8, s8, 4096
s_add_u32 s12, s12, 4096
ds_read_b64_tr_b16 a[100:101], v119 offset:4096
v_mfma_f32_16x16x32_bf16 v[48:51], a[76:79], v[176:179], v[48:51]
s_waitcnt lgkmcnt(8)
ds_read_b64_tr_b16 a[102:103], v119 offset:6144
v_mul_f32 v32, v32, v24
v_mfma_f32_16x16x32_bf16 v[48:51], a[80:83], v[192:195], v[48:51]
s_waitcnt lgkmcnt(8)
ds_read_b64_tr_b16 a[104:105], v119 offset:8192
v_mul_f32 v33, v33, v24
v_mfma_f32_16x16x32_bf16 v[48:51], a[84:87], v[208:211], v[48:51]
s_waitcnt lgkmcnt(7)
buffer_load_dwordx4 v113, s[36:39], s81 offen offset:1024 lds
ds_read_b64_tr_b16 a[106:107], v119 offset:10240
v_mfma_f32_16x16x32_bf16 v[48:51], a[88:91], v[224:227], v[48:51]
s_waitcnt lgkmcnt(6)
ds_read_b64_tr_b16 a[108:109], v119 offset:12288
v_mul_f32 v34, v34, v24
v_mfma_f32_16x16x32_bf16 v[48:51], a[92:95], v[240:243], v[48:51]
ds_read_b64_tr_b16 a[110:111], v119 offset:14336
v_mul_f32 v35, v35, v24
v_mfma_f32_16x16x32_bf16 v[52:55], a[64:67], v[132:135], 0
ds_read_b64_tr_b16 a[112:113], v119 offset:16384
v_mul_f32 v40, v40, v24
v_mfma_f32_16x16x32_bf16 v[52:55], a[68:71], v[148:151], v[52:55]
ds_read_b64_tr_b16 a[114:115], v119 offset:18432
v_mul_f32 v41, v41, v24
v_mfma_f32_16x16x32_bf16 v[52:55], a[72:75], v[164:167], v[52:55]
ds_read_b64_tr_b16 a[116:117], v119 offset:20480
v_mul_f32 v42, v42, v24
v_mfma_f32_16x16x32_bf16 v[52:55], a[76:79], v[180:183], v[52:55]
ds_read_b64_tr_b16 a[118:119], v119 offset:22528
v_mul_f32 v43, v43, v24
v_mfma_f32_16x16x32_bf16 v[52:55], a[80:83], v[196:199], v[52:55]
buffer_load_dwordx4 v114, s[36:39], s81 offen offset:2048 lds
ds_read_b64_tr_b16 a[120:121], v119 offset:24576
v_mfma_f32_16x16x32_bf16 v[52:55], a[84:87], v[212:215], v[52:55]
ds_read_b64_tr_b16 a[122:123], v119 offset:26624
v_cvt_pk_bf16_f32 v32, v32, v33
v_mfma_f32_16x16x32_bf16 v[52:55], a[88:91], v[228:231], v[52:55]
ds_read_b64_tr_b16 a[124:125], v119 offset:28672
ds_read_b64_tr_b16 a[126:127], v119 offset:30720
v_mfma_f32_16x16x32_bf16 v[52:55], a[92:95], v[244:247], v[52:55]
s_waitcnt vmcnt(23) lgkmcnt(9)
s_barrier
v_add_u32 v119, 4294901760, v119
v_mfma_f32_16x16x32_bf16 v[56:59], a[96:99], v[128:131], 0
ds_read_b64_tr_b16 a[64:65], v116 offset:0
v_cvt_pk_bf16_f32 v33, v34, v35
v_mfma_f32_16x16x32_bf16 v[56:59], a[100:103], v[144:147], v[56:59]
ds_read_b64_tr_b16 a[66:67], v116 offset:2048
v_cvt_pk_bf16_f32 v34, v40, v41
v_mfma_f32_16x16x32_bf16 v[56:59], a[104:107], v[160:163], v[56:59]
s_waitcnt lgkmcnt(8)
ds_read_b64_tr_b16 a[68:69], v116 offset:4096
v_cvt_pk_bf16_f32 v35, v42, v43
v_mfma_f32_16x16x32_bf16 v[56:59], a[108:111], v[176:179], v[56:59]
PAD_15:
s_cbranch_execz M_tret
buffer_load_dwordx4 v115, s[36:39], s81 offen offset:3072 lds
ds_read_b64_tr_b16 a[70:71], v116 offset:6144
v_mfma_f32_16x16x32_bf16 v[56:59], a[112:115], v[192:195], v[56:59]
s_waitcnt lgkmcnt(8)
buffer_store_dwordx4 v[32:35], v1, s[4:7], s8 offen offset:0 sc1
ds_read_b64_tr_b16 a[72:73], v116 offset:8192
v_mfma_f32_16x16x32_bf16 v[56:59], a[116:119], v[208:211], v[56:59]
s_waitcnt lgkmcnt(7)
ds_read_b64_tr_b16 a[74:75], v116 offset:10240
v_mul_f32 v36, v36, v25
v_mfma_f32_16x16x32_bf16 v[56:59], a[120:123], v[224:227], v[56:59]
s_waitcnt lgkmcnt(6)
ds_read_b64_tr_b16 a[76:77], v116 offset:12288
v_mul_f32 v37, v37, v25
v_mfma_f32_16x16x32_bf16 v[56:59], a[124:127], v[240:243], v[56:59]
ds_read_b64_tr_b16 a[78:79], v116 offset:14336
v_mul_f32 v38, v38, v25
v_mfma_f32_16x16x32_bf16 v[60:63], a[96:99], v[132:135], 0
ds_read_b64_tr_b16 a[80:81], v116 offset:16384
v_mul_f32 v39, v39, v25
v_mfma_f32_16x16x32_bf16 v[60:63], a[100:103], v[148:151], v[60:63]
s_sub_u32 s81, s81, 28544
ds_read_b64_tr_b16 a[82:83], v116 offset:18432
v_mul_f32 v44, v44, v25
v_mfma_f32_16x16x32_bf16 v[60:63], a[104:107], v[164:167], v[60:63]
ds_read_b64_tr_b16 a[84:85], v116 offset:20480
v_mul_f32 v45, v45, v25
v_mfma_f32_16x16x32_bf16 v[60:63], a[108:111], v[180:183], v[60:63]
ds_read_b64_tr_b16 a[86:87], v116 offset:22528
v_mul_f32 v46, v46, v25
v_mfma_f32_16x16x32_bf16 v[60:63], a[112:115], v[196:199], v[60:63]
ds_read_b64_tr_b16 a[88:89], v116 offset:24576
v_mul_f32 v47, v47, v25
v_mfma_f32_16x16x32_bf16 v[60:63], a[116:119], v[212:215], v[60:63]
ds_read_b64_tr_b16 a[90:91], v116 offset:26624
v_cvt_pk_bf16_f32 v36, v36, v37
v_mfma_f32_16x16x32_bf16 v[60:63], a[120:123], v[228:231], v[60:63]
ds_read_b64_tr_b16 a[92:93], v116 offset:28672
v_cvt_pk_bf16_f32 v37, v38, v39
v_mfma_f32_16x16x32_bf16 v[60:63], a[124:127], v[244:247], v[60:63]
s_waitcnt lgkmcnt(8)
ds_read_b64_tr_b16 a[94:95], v116 offset:30720
v_add_u32 v116, 4294901760, v116
v_mfma_f32_16x16x32_bf16 v[64:67], a[64:67], v[128:131], 0
s_add_u32 m0, s18, 98304
ds_read_b64_tr_b16 a[96:97], v117 offset:0
v_cvt_pk_bf16_f32 v38, v44, v45
v_mfma_f32_16x16x32_bf16 v[64:67], a[68:71], v[144:147], v[64:67]
buffer_load_dwordx4 v112, s[36:39], s81 offen offset:0 lds
ds_read_b64_tr_b16 a[98:99], v117 offset:2048
v_mfma_f32_16x16x32_bf16 v[64:67], a[72:75], v[160:163], v[64:67]
s_waitcnt lgkmcnt(8)
ds_read_b64_tr_b16 a[100:101], v117 offset:4096
v_cvt_pk_bf16_f32 v39, v46, v47
v_mfma_f32_16x16x32_bf16 v[64:67], a[76:79], v[176:179], v[64:67]
buffer_store_dwordx4 v[36:39], v1, s[4:7], s12 offen offset:0 sc1
ds_read_b64_tr_b16 a[102:103], v117 offset:6144
v_mfma_f32_16x16x32_bf16 v[64:67], a[80:83], v[192:195], v[64:67]
s_waitcnt lgkmcnt(8)
ds_read_b64_tr_b16 a[104:105], v117 offset:8192
v_mul_f32 v48, v48, v24
v_mfma_f32_16x16x32_bf16 v[64:67], a[84:87], v[208:211], v[64:67]
s_waitcnt lgkmcnt(7)
ds_read_b64_tr_b16 a[106:107], v117 offset:10240
v_mul_f32 v49, v49, v24
v_mfma_f32_16x16x32_bf16 v[64:67], a[88:91], v[224:227], v[64:67]
s_waitcnt lgkmcnt(6)
ds_read_b64_tr_b16 a[108:109], v117 offset:12288
v_mul_f32 v50, v50, v24
v_mfma_f32_16x16x32_bf16 v[64:67], a[92:95], v[240:243], v[64:67]
ds_read_b64_tr_b16 a[110:111], v117 offset:14336
v_mul_f32 v51, v51, v24
v_mfma_f32_16x16x32_bf16 v[68:71], a[64:67], v[132:135], 0
buffer_load_dwordx4 v113, s[36:39], s81 offen offset:1024 lds
ds_read_b64_tr_b16 a[112:113], v117 offset:16384
v_mfma_f32_16x16x32_bf16 v[68:71], a[68:71], v[148:151], v[68:71]
ds_read_b64_tr_b16 a[114:115], v117 offset:18432
v_mul_f32 v56, v56, v24
v_mfma_f32_16x16x32_bf16 v[68:71], a[72:75], v[164:167], v[68:71]
ds_read_b64_tr_b16 a[116:117], v117 offset:20480
v_mul_f32 v57, v57, v24
v_mfma_f32_16x16x32_bf16 v[68:71], a[76:79], v[180:183], v[68:71]
ds_read_b64_tr_b16 a[118:119], v117 offset:22528
v_mul_f32 v58, v58, v24
v_mfma_f32_16x16x32_bf16 v[68:71], a[80:83], v[196:199], v[68:71]
ds_read_b64_tr_b16 a[120:121], v117 offset:24576
v_mul_f32 v59, v59, v24
v_mfma_f32_16x16x32_bf16 v[68:71], a[84:87], v[212:215], v[68:71]
ds_read_b64_tr_b16 a[122:123], v117 offset:26624
v_cvt_pk_bf16_f32 v48, v48, v49
v_mfma_f32_16x16x32_bf16 v[68:71], a[88:91], v[228:231], v[68:71]
ds_read_b64_tr_b16 a[124:125], v117 offset:28672
v_cvt_pk_bf16_f32 v49, v50, v51
v_mfma_f32_16x16x32_bf16 v[68:71], a[92:95], v[244:247], v[68:71]
s_waitcnt lgkmcnt(8)
ds_read_b64_tr_b16 a[126:127], v117 offset:30720
v_add_u32 v117, 4294901760, v117
v_mfma_f32_16x16x32_bf16 v[72:75], a[96:99], v[128:131], 0
buffer_load_dwordx4 v114, s[36:39], s81 offen offset:2048 lds
ds_read_b64_tr_b16 a[64:65], v118 offset:0
v_mfma_f32_16x16x32_bf16 v[72:75], a[100:103], v[144:147], v[72:75]
ds_read_b64_tr_b16 a[66:67], v118 offset:2048
v_cvt_pk_bf16_f32 v50, v56, v57
v_mfma_f32_16x16x32_bf16 v[72:75], a[104:107], v[160:163], v[72:75]
s_waitcnt lgkmcnt(8)
ds_read_b64_tr_b16 a[68:69], v118 offset:4096
v_cvt_pk_bf16_f32 v51, v58, v59
v_mfma_f32_16x16x32_bf16 v[72:75], a[108:111], v[176:179], v[72:75]
buffer_store_dwordx4 v[48:51], v1, s[4:7], s8 offen offset:1024 sc1
ds_read_b64_tr_b16 a[70:71], v118 offset:6144
v_mfma_f32_16x16x32_bf16 v[72:75], a[112:115], v[192:195], v[72:75]
s_waitcnt lgkmcnt(8)
ds_read_b64_tr_b16 a[72:73], v118 offset:8192
v_mul_f32 v52, v52, v25
v_mfma_f32_16x16x32_bf16 v[72:75], a[116:119], v[208:211], v[72:75]
s_waitcnt lgkmcnt(7)
ds_read_b64_tr_b16 a[74:75], v118 offset:10240
v_mul_f32 v53, v53, v25
v_mfma_f32_16x16x32_bf16 v[72:75], a[120:123], v[224:227], v[72:75]
s_waitcnt lgkmcnt(6)
ds_read_b64_tr_b16 a[76:77], v118 offset:12288
v_mul_f32 v54, v54, v25
v_mfma_f32_16x16x32_bf16 v[72:75], a[124:127], v[240:243], v[72:75]
buffer_load_dwordx4 v115, s[36:39], s81 offen offset:3072 lds
ds_read_b64_tr_b16 a[78:79], v118 offset:14336
v_mfma_f32_16x16x32_bf16 v[76:79], a[96:99], v[132:135], 0
ds_read_b64_tr_b16 a[80:81], v118 offset:16384
v_mul_f32 v55, v55, v25
v_mfma_f32_16x16x32_bf16 v[76:79], a[100:103], v[148:151], v[76:79]
ds_read_b64_tr_b16 a[82:83], v118 offset:18432
v_mul_f32 v60, v60, v25
v_mfma_f32_16x16x32_bf16 v[76:79], a[104:107], v[164:167], v[76:79]
ds_read_b64_tr_b16 a[84:85], v118 offset:20480
v_mul_f32 v61, v61, v25
v_mfma_f32_16x16x32_bf16 v[76:79], a[108:111], v[180:183], v[76:79]
ds_read_b64_tr_b16 a[86:87], v118 offset:22528
v_mul_f32 v62, v62, v25
v_mfma_f32_16x16x32_bf16 v[76:79], a[112:115], v[196:199], v[76:79]
ds_read_b64_tr_b16 a[88:89], v118 offset:24576
v_mul_f32 v63, v63, v25
v_mfma_f32_16x16x32_bf16 v[76:79], a[116:119], v[212:215], v[76:79]
s_add_u32 s81, s81, 28672
s_add_u32 m0, s18, 102400
ds_read_b64_tr_b16 a[90:91], v118 offset:26624
v_mfma_f32_16x16x32_bf16 v[76:79], a[120:123], v[228:231], v[76:79]
buffer_load_dwordx4 v112, s[36:39], s81 offen offset:0 lds
ds_read_b64_tr_b16 a[92:93], v118 offset:28672
v_mfma_f32_16x16x32_bf16 v[76:79], a[124:127], v[244:247], v[76:79]
s_waitcnt lgkmcnt(8)
ds_read_b64_tr_b16 a[94:95], v118 offset:30720
v_add_u32 v118, 4294901760, v118
v_mfma_f32_16x16x32_bf16 v[80:83], a[64:67], v[128:131], 0
ds_read_b64_tr_b16 a[96:97], v119 offset:0
v_cvt_pk_bf16_f32 v52, v52, v53
v_mfma_f32_16x16x32_bf16 v[80:83], a[68:71], v[144:147], v[80:83]
ds_read_b64_tr_b16 a[98:99], v119 offset:2048
v_cvt_pk_bf16_f32 v53, v54, v55
v_mfma_f32_16x16x32_bf16 v[80:83], a[72:75], v[160:163], v[80:83]
s_waitcnt lgkmcnt(8)
ds_read_b64_tr_b16 a[100:101], v119 offset:4096
v_cvt_pk_bf16_f32 v54, v60, v61
v_mfma_f32_16x16x32_bf16 v[80:83], a[76:79], v[176:179], v[80:83]
ds_read_b64_tr_b16 a[102:103], v119 offset:6144
v_cvt_pk_bf16_f32 v55, v62, v63
v_mfma_f32_16x16x32_bf16 v[80:83], a[80:83], v[192:195], v[80:83]
s_waitcnt lgkmcnt(8)
buffer_store_dwordx4 v[52:55], v1, s[4:7], s12 offen offset:1024 sc1
ds_read_b64_tr_b16 a[104:105], v119 offset:8192
v_mfma_f32_16x16x32_bf16 v[80:83], a[84:87], v[208:211], v[80:83]
s_waitcnt lgkmcnt(7)
buffer_load_dwordx4 v113, s[36:39], s81 offen offset:1024 lds
ds_read_b64_tr_b16 a[106:107], v119 offset:10240
v_mfma_f32_16x16x32_bf16 v[80:83], a[88:91], v[224:227], v[80:83]
s_waitcnt lgkmcnt(6)
ds_read_b64_tr_b16 a[108:109], v119 offset:12288
v_mul_f32 v64, v64, v24
v_mfma_f32_16x16x32_bf16 v[80:83], a[92:95], v[240:243], v[80:83]
ds_read_b64_tr_b16 a[110:111], v119 offset:14336
v_mul_f32 v65, v65, v24
v_mfma_f32_16x16x32_bf16 v[84:87], a[64:67], v[132:135], 0
ds_read_b64_tr_b16 a[112:113], v119 offset:16384
v_mul_f32 v66, v66, v24
v_mfma_f32_16x16x32_bf16 v[84:87], a[68:71], v[148:151], v[84:87]
ds_read_b64_tr_b16 a[114:115], v119 offset:18432
v_mul_f32 v67, v67, v24
v_mfma_f32_16x16x32_bf16 v[84:87], a[72:75], v[164:167], v[84:87]
ds_read_b64_tr_b16 a[116:117], v119 offset:20480
v_mul_f32 v72, v72, v24
v_mfma_f32_16x16x32_bf16 v[84:87], a[76:79], v[180:183], v[84:87]
ds_read_b64_tr_b16 a[118:119], v119 offset:22528
v_mul_f32 v73, v73, v24
v_mfma_f32_16x16x32_bf16 v[84:87], a[80:83], v[196:199], v[84:87]
buffer_load_dwordx4 v114, s[36:39], s81 offen offset:2048 lds
ds_read_b64_tr_b16 a[120:121], v119 offset:24576
v_mfma_f32_16x16x32_bf16 v[84:87], a[84:87], v[212:215], v[84:87]
ds_read_b64_tr_b16 a[122:123], v119 offset:26624
v_mul_f32 v74, v74, v24
v_mfma_f32_16x16x32_bf16 v[84:87], a[88:91], v[228:231], v[84:87]
ds_read_b64_tr_b16 a[124:125], v119 offset:28672
ds_read_b64_tr_b16 a[126:127], v119 offset:30720
v_mfma_f32_16x16x32_bf16 v[84:87], a[92:95], v[244:247], v[84:87]
s_waitcnt vmcnt(27) lgkmcnt(9)
s_barrier
v_add_u32 v119, 4294901760, v119
v_mfma_f32_16x16x32_bf16 v[88:91], a[96:99], v[128:131], 0
ds_read_b64_tr_b16 a[64:65], v116 offset:0
v_mul_f32 v75, v75, v24
v_mfma_f32_16x16x32_bf16 v[88:91], a[100:103], v[144:147], v[88:91]
ds_read_b64_tr_b16 a[66:67], v116 offset:2048
v_cvt_pk_bf16_f32 v64, v64, v65
v_mfma_f32_16x16x32_bf16 v[88:91], a[104:107], v[160:163], v[88:91]
s_waitcnt lgkmcnt(8)
ds_read_b64_tr_b16 a[68:69], v116 offset:4096
v_cvt_pk_bf16_f32 v65, v66, v67
v_mfma_f32_16x16x32_bf16 v[88:91], a[108:111], v[176:179], v[88:91]
buffer_load_dwordx4 v115, s[36:39], s81 offen offset:3072 lds
ds_read_b64_tr_b16 a[70:71], v116 offset:6144
v_mfma_f32_16x16x32_bf16 v[88:91], a[112:115], v[192:195], v[88:91]
s_waitcnt lgkmcnt(8)
ds_read_b64_tr_b16 a[72:73], v116 offset:8192
v_cvt_pk_bf16_f32 v66, v72, v73
v_mfma_f32_16x16x32_bf16 v[88:91], a[116:119], v[208:211], v[88:91]
s_waitcnt lgkmcnt(7)
ds_read_b64_tr_b16 a[74:75], v116 offset:10240
v_cvt_pk_bf16_f32 v67, v74, v75
v_mfma_f32_16x16x32_bf16 v[88:91], a[120:123], v[224:227], v[88:91]
s_waitcnt lgkmcnt(6)
buffer_store_dwordx4 v[64:67], v1, s[4:7], s8 offen offset:2048 sc1
ds_read_b64_tr_b16 a[76:77], v116 offset:12288
v_mfma_f32_16x16x32_bf16 v[88:91], a[124:127], v[240:243], v[88:91]
ds_read_b64_tr_b16 a[78:79], v116 offset:14336
v_mul_f32 v68, v68, v25
v_mfma_f32_16x16x32_bf16 v[92:95], a[96:99], v[132:135], 0
ds_read_b64_tr_b16 a[80:81], v116 offset:16384
v_mul_f32 v69, v69, v25
v_mfma_f32_16x16x32_bf16 v[92:95], a[100:103], v[148:151], v[92:95]
s_sub_u32 s81, s81, 28544
ds_read_b64_tr_b16 a[82:83], v116 offset:18432
v_mul_f32 v70, v70, v25
v_mfma_f32_16x16x32_bf16 v[92:95], a[104:107], v[164:167], v[92:95]
ds_read_b64_tr_b16 a[84:85], v116 offset:20480
v_mul_f32 v71, v71, v25
v_mfma_f32_16x16x32_bf16 v[92:95], a[108:111], v[180:183], v[92:95]
ds_read_b64_tr_b16 a[86:87], v116 offset:22528
v_mul_f32 v76, v76, v25
v_mfma_f32_16x16x32_bf16 v[92:95], a[112:115], v[196:199], v[92:95]
ds_read_b64_tr_b16 a[88:89], v116 offset:24576
v_mul_f32 v77, v77, v25
v_mfma_f32_16x16x32_bf16 v[92:95], a[116:119], v[212:215], v[92:95]
ds_read_b64_tr_b16 a[90:91], v116 offset:26624
v_mul_f32 v78, v78, v25
v_mfma_f32_16x16x32_bf16 v[92:95], a[120:123], v[228:231], v[92:95]
ds_read_b64_tr_b16 a[92:93], v116 offset:28672
v_mul_f32 v79, v79, v25
v_mfma_f32_16x16x32_bf16 v[92:95], a[124:127], v[244:247], v[92:95]
s_waitcnt lgkmcnt(8)
ds_read_b64_tr_b16 a[94:95], v116 offset:30720
v_add_u32 v116, 32768, v116
v_mfma_f32_16x16x32_bf16 v[32:35], a[64:67], v[128:131], 0
ds_read_b64_tr_b16 a[96:97], v117 offset:0
v_cvt_pk_bf16_f32 v68, v68, v69
v_mfma_f32_16x16x32_bf16 v[32:35], a[68:71], v[144:147], v[32:35]
ds_read_b64_tr_b16 a[98:99], v117 offset:2048
v_cvt_pk_bf16_f32 v69, v70, v71
v_mfma_f32_16x16x32_bf16 v[32:35], a[72:75], v[160:163], v[32:35]
s_waitcnt lgkmcnt(8)
ds_read_b64_tr_b16 a[100:101], v117 offset:4096
v_cvt_pk_bf16_f32 v70, v76, v77
v_mfma_f32_16x16x32_bf16 v[32:35], a[76:79], v[176:179], v[32:35]
ds_read_b64_tr_b16 a[102:103], v117 offset:6144
v_cvt_pk_bf16_f32 v71, v78, v79
v_mfma_f32_16x16x32_bf16 v[32:35], a[80:83], v[192:195], v[32:35]
s_waitcnt lgkmcnt(8)
buffer_store_dwordx4 v[68:71], v1, s[4:7], s12 offen offset:2048 sc1
ds_read_b64_tr_b16 a[104:105], v117 offset:8192
v_mfma_f32_16x16x32_bf16 v[32:35], a[84:87], v[208:211], v[32:35]
s_waitcnt lgkmcnt(7)
ds_read_b64_tr_b16 a[106:107], v117 offset:10240
v_mul_f32 v80, v80, v24
v_mfma_f32_16x16x32_bf16 v[32:35], a[88:91], v[224:227], v[32:35]
s_waitcnt lgkmcnt(6)
ds_read_b64_tr_b16 a[108:109], v117 offset:12288
v_mul_f32 v81, v81, v24
v_mfma_f32_16x16x32_bf16 v[32:35], a[92:95], v[240:243], v[32:35]
ds_read_b64_tr_b16 a[110:111], v117 offset:14336
v_mul_f32 v82, v82, v24
v_mfma_f32_16x16x32_bf16 v[36:39], a[64:67], v[132:135], 0
ds_read_b64_tr_b16 a[112:113], v117 offset:16384
v_mul_f32 v83, v83, v24
v_mfma_f32_16x16x32_bf16 v[36:39], a[68:71], v[148:151], v[36:39]
ds_read_b64_tr_b16 a[114:115], v117 offset:18432
v_mul_f32 v88, v88, v24
v_mfma_f32_16x16x32_bf16 v[36:39], a[72:75], v[164:167], v[36:39]
ds_read_b64_tr_b16 a[116:117], v117 offset:20480
v_mul_f32 v89, v89, v24
v_mfma_f32_16x16x32_bf16 v[36:39], a[76:79], v[180:183], v[36:39]
ds_read_b64_tr_b16 a[118:119], v117 offset:22528
v_mul_f32 v90, v90, v24
v_mfma_f32_16x16x32_bf16 v[36:39], a[80:83], v[196:199], v[36:39]
ds_read_b64_tr_b16 a[120:121], v117 offset:24576
v_mul_f32 v91, v91, v24
v_mfma_f32_16x16x32_bf16 v[36:39], a[84:87], v[212:215], v[36:39]
ds_read_b64_tr_b16 a[122:123], v117 offset:26624
v_cvt_pk_bf16_f32 v80, v80, v81
v_mfma_f32_16x16x32_bf16 v[36:39], a[88:91], v[228:231], v[36:39]
ds_read_b64_tr_b16 a[124:125], v117 offset:28672
v_cvt_pk_bf16_f32 v81, v82, v83
v_mfma_f32_16x16x32_bf16 v[36:39], a[92:95], v[244:247], v[36:39]
s_waitcnt lgkmcnt(8)
ds_read_b64_tr_b16 a[126:127], v117 offset:30720
v_add_u32 v117, 32768, v117
v_mfma_f32_16x16x32_bf16 v[40:43], a[96:99], v[128:131], 0
ds_read_b64_tr_b16 a[64:65], v118 offset:0
v_cvt_pk_bf16_f32 v82, v88, v89
v_mfma_f32_16x16x32_bf16 v[40:43], a[100:103], v[144:147], v[40:43]
ds_read_b64_tr_b16 a[66:67], v118 offset:2048
v_cvt_pk_bf16_f32 v83, v90, v91
v_mfma_f32_16x16x32_bf16 v[40:43], a[104:107], v[160:163], v[40:43]
s_waitcnt lgkmcnt(8)
buffer_store_dwordx4 v[80:83], v1, s[4:7], s8 offen offset:3072 sc1
ds_read_b64_tr_b16 a[68:69], v118 offset:4096
v_mfma_f32_16x16x32_bf16 v[40:43], a[108:111], v[176:179], v[40:43]
ds_read_b64_tr_b16 a[70:71], v118 offset:6144
v_mul_f32 v84, v84, v25
v_mfma_f32_16x16x32_bf16 v[40:43], a[112:115], v[192:195], v[40:43]
s_waitcnt lgkmcnt(8)
ds_read_b64_tr_b16 a[72:73], v118 offset:8192
v_mul_f32 v85, v85, v25
v_mfma_f32_16x16x32_bf16 v[40:43], a[116:119], v[208:211], v[40:43]
s_waitcnt lgkmcnt(7)
ds_read_b64_tr_b16 a[74:75], v118 offset:10240
v_mul_f32 v86, v86, v25
v_mfma_f32_16x16x32_bf16 v[40:43], a[120:123], v[224:227], v[40:43]
s_waitcnt lgkmcnt(6)
ds_read_b64_tr_b16 a[76:77], v118 offset:12288
v_mul_f32 v87, v87, v25
v_mfma_f32_16x16x32_bf16 v[40:43], a[124:127], v[240:243], v[40:43]
ds_read_b64_tr_b16 a[78:79], v118 offset:14336
v_mul_f32 v92, v92, v25
v_mfma_f32_16x16x32_bf16 v[44:47], a[96:99], v[132:135], 0
ds_read_b64_tr_b16 a[80:81], v118 offset:16384
v_mul_f32 v93, v93, v25
v_mfma_f32_16x16x32_bf16 v[44:47], a[100:103], v[148:151], v[44:47]
ds_read_b64_tr_b16 a[82:83], v118 offset:18432
v_mul_f32 v94, v94, v25
v_mfma_f32_16x16x32_bf16 v[44:47], a[104:107], v[164:167], v[44:47]
ds_read_b64_tr_b16 a[84:85], v118 offset:20480
v_mul_f32 v95, v95, v25
v_mfma_f32_16x16x32_bf16 v[44:47], a[108:111], v[180:183], v[44:47]
ds_read_b64_tr_b16 a[86:87], v118 offset:22528
v_cvt_pk_bf16_f32 v84, v84, v85
v_mfma_f32_16x16x32_bf16 v[44:47], a[112:115], v[196:199], v[44:47]
ds_read_b64_tr_b16 a[88:89], v118 offset:24576
v_cvt_pk_bf16_f32 v85, v86, v87
v_mfma_f32_16x16x32_bf16 v[44:47], a[116:119], v[212:215], v[44:47]
ds_read_b64_tr_b16 a[90:91], v118 offset:26624
v_cvt_pk_bf16_f32 v86, v92, v93
v_mfma_f32_16x16x32_bf16 v[44:47], a[120:123], v[228:231], v[44:47]
ds_read_b64_tr_b16 a[92:93], v118 offset:28672
v_cvt_pk_bf16_f32 v87, v94, v95
v_mfma_f32_16x16x32_bf16 v[44:47], a[124:127], v[244:247], v[44:47]
s_waitcnt lgkmcnt(8)
ds_read_b64_tr_b16 a[94:95], v118 offset:30720
v_add_u32 v118, 32768, v118
v_mfma_f32_16x16x32_bf16 v[48:51], a[64:67], v[128:131], 0
buffer_store_dwordx4 v[84:87], v1, s[4:7], s12 offen offset:3072 sc1
ds_read_b64_tr_b16 a[96:97], v119 offset:0
v_mfma_f32_16x16x32_bf16 v[48:51], a[68:71], v[144:147], v[48:51]
s_add_u32 s8, s8, 4096
s_add_u32 s12, s12, 4096
ds_read_b64_tr_b16 a[98:99], v119 offset:2048
v_mfma_f32_16x16x32_bf16 v[48:51], a[72:75], v[160:163], v[48:51]
s_waitcnt lgkmcnt(8)
ds_read_b64_tr_b16 a[100:101], v119 offset:4096
v_mul_f32 v32, v32, v24
v_mfma_f32_16x16x32_bf16 v[48:51], a[76:79], v[176:179], v[48:51]
ds_read_b64_tr_b16 a[102:103], v119 offset:6144
v_mul_f32 v33, v33, v24
v_mfma_f32_16x16x32_bf16 v[48:51], a[80:83], v[192:195], v[48:51]
s_waitcnt lgkmcnt(8)
ds_read_b64_tr_b16 a[104:105], v119 offset:8192
v_mul_f32 v34, v34, v24
v_mfma_f32_16x16x32_bf16 v[48:51], a[84:87], v[208:211], v[48:51]
s_waitcnt lgkmcnt(7)
ds_read_b64_tr_b16 a[106:107], v119 offset:10240
v_mul_f32 v35, v35, v24
v_mfma_f32_16x16x32_bf16 v[48:51], a[88:91], v[224:227], v[48:51]
s_waitcnt lgkmcnt(6)
ds_read_b64_tr_b16 a[108:109], v119 offset:12288
v_mul_f32 v40, v40, v24
v_mfma_f32_16x16x32_bf16 v[48:51], a[92:95], v[240:243], v[48:51]
ds_read_b64_tr_b16 a[110:111], v119 offset:14336
v_mul_f32 v41, v41, v24
v_mfma_f32_16x16x32_bf16 v[52:55], a[64:67], v[132:135], 0
ds_read_b64_tr_b16 a[112:113], v119 offset:16384
v_mul_f32 v42, v42, v24
v_mfma_f32_16x16x32_bf16 v[52:55], a[68:71], v[148:151], v[52:55]
ds_read_b64_tr_b16 a[114:115], v119 offset:18432
v_mul_f32 v43, v43, v24
v_mfma_f32_16x16x32_bf16 v[52:55], a[72:75], v[164:167], v[52:55]
ds_read_b64_tr_b16 a[116:117], v119 offset:20480
v_cvt_pk_bf16_f32 v32, v32, v33
v_mfma_f32_16x16x32_bf16 v[52:55], a[76:79], v[180:183], v[52:55]
ds_read_b64_tr_b16 a[118:119], v119 offset:22528
v_cvt_pk_bf16_f32 v33, v34, v35
v_mfma_f32_16x16x32_bf16 v[52:55], a[80:83], v[196:199], v[52:55]
ds_read_b64_tr_b16 a[120:121], v119 offset:24576
v_cvt_pk_bf16_f32 v34, v40, v41
v_mfma_f32_16x16x32_bf16 v[52:55], a[84:87], v[212:215], v[52:55]
ds_read_b64_tr_b16 a[122:123], v119 offset:26624
v_cvt_pk_bf16_f32 v35, v42, v43
v_mfma_f32_16x16x32_bf16 v[52:55], a[88:91], v[228:231], v[52:55]
ds_read_b64_tr_b16 a[124:125], v119 offset:28672
ds_read_b64_tr_b16 a[126:127], v119 offset:30720
v_mfma_f32_16x16x32_bf16 v[52:55], a[92:95], v[244:247], v[52:55]
s_waitcnt vmcnt(16) lgkmcnt(9)
s_barrier
v_add_u32 v119, 32768, v119
v_mfma_f32_16x16x32_bf16 v[56:59], a[96:99], v[128:131], 0
buffer_store_dwordx4 v[32:35], v1, s[4:7], s8 offen offset:0 sc1
ds_read_b64_tr_b16 a[64:65], v116 offset:0
v_mfma_f32_16x16x32_bf16 v[56:59], a[100:103], v[144:147], v[56:59]
ds_read_b64_tr_b16 a[66:67], v116 offset:2048
v_mul_f32 v36, v36, v25
v_mfma_f32_16x16x32_bf16 v[56:59], a[104:107], v[160:163], v[56:59]
s_waitcnt lgkmcnt(8)
ds_read_b64_tr_b16 a[68:69], v116 offset:4096
v_mul_f32 v37, v37, v25
v_mfma_f32_16x16x32_bf16 v[56:59], a[108:111], v[176:179], v[56:59]
ds_read_b64_tr_b16 a[70:71], v116 offset:6144
v_mul_f32 v38, v38, v25
v_mfma_f32_16x16x32_bf16 v[56:59], a[112:115], v[192:195], v[56:59]
s_waitcnt lgkmcnt(8)
ds_read_b64_tr_b16 a[72:73], v116 offset:8192
v_mul_f32 v39, v39, v25
v_mfma_f32_16x16x32_bf16 v[56:59], a[116:119], v[208:211], v[56:59]
s_waitcnt lgkmcnt(7)
ds_read_b64_tr_b16 a[74:75], v116 offset:10240
v_mul_f32 v44, v44, v25
v_mfma_f32_16x16x32_bf16 v[56:59], a[120:123], v[224:227], v[56:59]
s_waitcnt lgkmcnt(6)
ds_read_b64_tr_b16 a[76:77], v116 offset:12288
v_mul_f32 v45, v45, v25
v_mfma_f32_16x16x32_bf16 v[56:59], a[124:127], v[240:243], v[56:59]
ds_read_b64_tr_b16 a[78:79], v116 offset:14336
v_mul_f32 v46, v46, v25
v_mfma_f32_16x16x32_bf16 v[60:63], a[96:99], v[132:135], 0
ds_read_b64_tr_b16 a[80:81], v116 offset:16384
v_mul_f32 v47, v47, v25
v_mfma_f32_16x16x32_bf16 v[60:63], a[100:103], v[148:151], v[60:63]
ds_read_b64_tr_b16 a[82:83], v116 offset:18432
v_cvt_pk_bf16_f32 v36, v36, v37
v_mfma_f32_16x16x32_bf16 v[60:63], a[104:107], v[164:167], v[60:63]
ds_read_b64_tr_b16 a[84:85], v116 offset:20480
v_cvt_pk_bf16_f32 v37, v38, v39
v_mfma_f32_16x16x32_bf16 v[60:63], a[108:111], v[180:183], v[60:63]
ds_read_b64_tr_b16 a[86:87], v116 offset:22528
v_cvt_pk_bf16_f32 v38, v44, v45
v_mfma_f32_16x16x32_bf16 v[60:63], a[112:115], v[196:199], v[60:63]
ds_read_b64_tr_b16 a[88:89], v116 offset:24576
v_cvt_pk_bf16_f32 v39, v46, v47
v_mfma_f32_16x16x32_bf16 v[60:63], a[116:119], v[212:215], v[60:63]
buffer_store_dwordx4 v[36:39], v1, s[4:7], s12 offen offset:0 sc1
ds_read_b64_tr_b16 a[90:91], v116 offset:26624
v_mfma_f32_16x16x32_bf16 v[60:63], a[120:123], v[228:231], v[60:63]
ds_read_b64_tr_b16 a[92:93], v116 offset:28672
v_mfma_f32_16x16x32_bf16 v[60:63], a[124:127], v[244:247], v[60:63]
s_waitcnt lgkmcnt(8)
ds_read_b64_tr_b16 a[94:95], v116 offset:30720
v_add_u32 v116, 65536, v116
v_mfma_f32_16x16x32_bf16 v[64:67], a[64:67], v[128:131], 0
ds_read_b64_tr_b16 a[96:97], v117 offset:0
v_mul_f32 v48, v48, v24
v_mfma_f32_16x16x32_bf16 v[64:67], a[68:71], v[144:147], v[64:67]
ds_read_b64_tr_b16 a[98:99], v117 offset:2048
v_mul_f32 v49, v49, v24
v_mfma_f32_16x16x32_bf16 v[64:67], a[72:75], v[160:163], v[64:67]
s_waitcnt lgkmcnt(8)
ds_read_b64_tr_b16 a[100:101], v117 offset:4096
v_mul_f32 v50, v50, v24
v_mfma_f32_16x16x32_bf16 v[64:67], a[76:79], v[176:179], v[64:67]
ds_read_b64_tr_b16 a[102:103], v117 offset:6144
v_mul_f32 v51, v51, v24
v_mfma_f32_16x16x32_bf16 v[64:67], a[80:83], v[192:195], v[64:67]
s_waitcnt lgkmcnt(8)
ds_read_b64_tr_b16 a[104:105], v117 offset:8192
v_mul_f32 v56, v56, v24
v_mfma_f32_16x16x32_bf16 v[64:67], a[84:87], v[208:211], v[64:67]
s_waitcnt lgkmcnt(7)
ds_read_b64_tr_b16 a[106:107], v117 offset:10240
v_mul_f32 v57, v57, v24
v_mfma_f32_16x16x32_bf16 v[64:67], a[88:91], v[224:227], v[64:67]
s_waitcnt lgkmcnt(6)
ds_read_b64_tr_b16 a[108:109], v117 offset:12288
v_mul_f32 v58, v58, v24
v_mfma_f32_16x16x32_bf16 v[64:67], a[92:95], v[240:243], v[64:67]
ds_read_b64_tr_b16 a[110:111], v117 offset:14336
v_mul_f32 v59, v59, v24
v_mfma_f32_16x16x32_bf16 v[68:71], a[64:67], v[132:135], 0
ds_read_b64_tr_b16 a[112:113], v117 offset:16384
v_cvt_pk_bf16_f32 v48, v48, v49
v_mfma_f32_16x16x32_bf16 v[68:71], a[68:71], v[148:151], v[68:71]
ds_read_b64_tr_b16 a[114:115], v117 offset:18432
v_cvt_pk_bf16_f32 v49, v50, v51
v_mfma_f32_16x16x32_bf16 v[68:71], a[72:75], v[164:167], v[68:71]
ds_read_b64_tr_b16 a[116:117], v117 offset:20480
v_cvt_pk_bf16_f32 v50, v56, v57
v_mfma_f32_16x16x32_bf16 v[68:71], a[76:79], v[180:183], v[68:71]
ds_read_b64_tr_b16 a[118:119], v117 offset:22528
v_cvt_pk_bf16_f32 v51, v58, v59
v_mfma_f32_16x16x32_bf16 v[68:71], a[80:83], v[196:199], v[68:71]
buffer_store_dwordx4 v[48:51], v1, s[4:7], s8 offen offset:1024 sc1
ds_read_b64_tr_b16 a[120:121], v117 offset:24576
v_mfma_f32_16x16x32_bf16 v[68:71], a[84:87], v[212:215], v[68:71]
ds_read_b64_tr_b16 a[122:123], v117 offset:26624
v_mul_f32 v52, v52, v25
v_mfma_f32_16x16x32_bf16 v[68:71], a[88:91], v[228:231], v[68:71]
ds_read_b64_tr_b16 a[124:125], v117 offset:28672
v_mul_f32 v53, v53, v25
v_mfma_f32_16x16x32_bf16 v[68:71], a[92:95], v[244:247], v[68:71]
s_waitcnt lgkmcnt(8)
ds_read_b64_tr_b16 a[126:127], v117 offset:30720
v_add_u32 v117, 65536, v117
v_mfma_f32_16x16x32_bf16 v[72:75], a[96:99], v[128:131], 0
ds_read_b64_tr_b16 a[64:65], v118 offset:0
v_mul_f32 v54, v54, v25
v_mfma_f32_16x16x32_bf16 v[72:75], a[100:103], v[144:147], v[72:75]
ds_read_b64_tr_b16 a[66:67], v118 offset:2048
v_mul_f32 v55, v55, v25
v_mfma_f32_16x16x32_bf16 v[72:75], a[104:107], v[160:163], v[72:75]
s_waitcnt lgkmcnt(8)
ds_read_b64_tr_b16 a[68:69], v118 offset:4096
v_mul_f32 v60, v60, v25
v_mfma_f32_16x16x32_bf16 v[72:75], a[108:111], v[176:179], v[72:75]
ds_read_b64_tr_b16 a[70:71], v118 offset:6144
v_mul_f32 v61, v61, v25
v_mfma_f32_16x16x32_bf16 v[72:75], a[112:115], v[192:195], v[72:75]
s_waitcnt lgkmcnt(8)
ds_read_b64_tr_b16 a[72:73], v118 offset:8192
v_mul_f32 v62, v62, v25
v_mfma_f32_16x16x32_bf16 v[72:75], a[116:119], v[208:211], v[72:75]
s_waitcnt lgkmcnt(7)
ds_read_b64_tr_b16 a[74:75], v118 offset:10240
v_mul_f32 v63, v63, v25
v_mfma_f32_16x16x32_bf16 v[72:75], a[120:123], v[224:227], v[72:75]
s_waitcnt lgkmcnt(6)
ds_read_b64_tr_b16 a[76:77], v118 offset:12288
v_cvt_pk_bf16_f32 v52, v52, v53
v_mfma_f32_16x16x32_bf16 v[72:75], a[124:127], v[240:243], v[72:75]
ds_read_b64_tr_b16 a[78:79], v118 offset:14336
v_cvt_pk_bf16_f32 v53, v54, v55
v_mfma_f32_16x16x32_bf16 v[76:79], a[96:99], v[132:135], 0
ds_read_b64_tr_b16 a[80:81], v118 offset:16384
v_cvt_pk_bf16_f32 v54, v60, v61
v_mfma_f32_16x16x32_bf16 v[76:79], a[100:103], v[148:151], v[76:79]
ds_read_b64_tr_b16 a[82:83], v118 offset:18432
v_cvt_pk_bf16_f32 v55, v62, v63
v_mfma_f32_16x16x32_bf16 v[76:79], a[104:107], v[164:167], v[76:79]
buffer_store_dwordx4 v[52:55], v1, s[4:7], s12 offen offset:1024 sc1
ds_read_b64_tr_b16 a[84:85], v118 offset:20480
v_mfma_f32_16x16x32_bf16 v[76:79], a[108:111], v[180:183], v[76:79]
ds_read_b64_tr_b16 a[86:87], v118 offset:22528
v_mul_u32_u24 v21, 1792, v19
v_mfma_f32_16x16x32_bf16 v[76:79], a[112:115], v[196:199], v[76:79]
ds_read_b64_tr_b16 a[88:89], v118 offset:24576
v_mul_f32 v64, v64, v24
v_mfma_f32_16x16x32_bf16 v[76:79], a[116:119], v[212:215], v[76:79]
ds_read_b64_tr_b16 a[90:91], v118 offset:26624
v_mul_f32 v65, v65, v24
v_mfma_f32_16x16x32_bf16 v[76:79], a[120:123], v[228:231], v[76:79]
ds_read_b64_tr_b16 a[92:93], v118 offset:28672
v_mul_f32 v66, v66, v24
v_mfma_f32_16x16x32_bf16 v[76:79], a[124:127], v[244:247], v[76:79]
s_waitcnt lgkmcnt(8)
ds_read_b64_tr_b16 a[94:95], v118 offset:30720
v_add_u32 v118, 65536, v118
v_mfma_f32_16x16x32_bf16 v[80:83], a[64:67], v[128:131], 0
ds_read_b64_tr_b16 a[96:97], v119 offset:0
v_mul_f32 v67, v67, v24
v_mfma_f32_16x16x32_bf16 v[80:83], a[68:71], v[144:147], v[80:83]
ds_read_b64_tr_b16 a[98:99], v119 offset:2048
v_mul_f32 v72, v72, v24
v_mfma_f32_16x16x32_bf16 v[80:83], a[72:75], v[160:163], v[80:83]
s_waitcnt lgkmcnt(8)
ds_read_b64_tr_b16 a[100:101], v119 offset:4096
v_mul_f32 v73, v73, v24
v_mfma_f32_16x16x32_bf16 v[80:83], a[76:79], v[176:179], v[80:83]
PAD_16:
s_cbranch_execz M_tret
ds_read_b64_tr_b16 a[102:103], v119 offset:6144
v_mul_f32 v74, v74, v24
v_mfma_f32_16x16x32_bf16 v[80:83], a[80:83], v[192:195], v[80:83]
s_waitcnt lgkmcnt(8)
ds_read_b64_tr_b16 a[104:105], v119 offset:8192
v_mul_f32 v75, v75, v24
v_mfma_f32_16x16x32_bf16 v[80:83], a[84:87], v[208:211], v[80:83]
s_waitcnt lgkmcnt(7)
ds_read_b64_tr_b16 a[106:107], v119 offset:10240
v_cvt_pk_bf16_f32 v64, v64, v65
v_mfma_f32_16x16x32_bf16 v[80:83], a[88:91], v[224:227], v[80:83]
s_waitcnt lgkmcnt(6)
ds_read_b64_tr_b16 a[108:109], v119 offset:12288
v_cvt_pk_bf16_f32 v65, v66, v67
v_mfma_f32_16x16x32_bf16 v[80:83], a[92:95], v[240:243], v[80:83]
ds_read_b64_tr_b16 a[110:111], v119 offset:14336
v_cvt_pk_bf16_f32 v66, v72, v73
v_mfma_f32_16x16x32_bf16 v[84:87], a[64:67], v[132:135], 0
ds_read_b64_tr_b16 a[112:113], v119 offset:16384
v_cvt_pk_bf16_f32 v67, v74, v75
v_mfma_f32_16x16x32_bf16 v[84:87], a[68:71], v[148:151], v[84:87]
buffer_store_dwordx4 v[64:67], v1, s[4:7], s8 offen offset:2048 sc1
ds_read_b64_tr_b16 a[114:115], v119 offset:18432
v_mfma_f32_16x16x32_bf16 v[84:87], a[72:75], v[164:167], v[84:87]
ds_read_b64_tr_b16 a[116:117], v119 offset:20480
v_mul_f32 v68, v68, v25
v_mfma_f32_16x16x32_bf16 v[84:87], a[76:79], v[180:183], v[84:87]
ds_read_b64_tr_b16 a[118:119], v119 offset:22528
v_mul_f32 v69, v69, v25
v_mfma_f32_16x16x32_bf16 v[84:87], a[80:83], v[196:199], v[84:87]
ds_read_b64_tr_b16 a[120:121], v119 offset:24576
v_mul_f32 v70, v70, v25
v_mfma_f32_16x16x32_bf16 v[84:87], a[84:87], v[212:215], v[84:87]
ds_read_b64_tr_b16 a[122:123], v119 offset:26624
v_mul_f32 v71, v71, v25
v_mfma_f32_16x16x32_bf16 v[84:87], a[88:91], v[228:231], v[84:87]
ds_read_b64_tr_b16 a[124:125], v119 offset:28672
ds_read_b64_tr_b16 a[126:127], v119 offset:30720
v_mfma_f32_16x16x32_bf16 v[84:87], a[92:95], v[244:247], v[84:87]
s_waitcnt vmcnt(7) lgkmcnt(9)
s_barrier
v_add_u32 v119, 65536, v119
v_mfma_f32_16x16x32_bf16 v[88:91], a[96:99], v[128:131], 0
ds_read_b64_tr_b16 a[64:65], v116 offset:0
v_mul_f32 v76, v76, v25
v_mfma_f32_16x16x32_bf16 v[88:91], a[100:103], v[144:147], v[88:91]
buffer_store_dword v6, v5, s[4:7], s34 offen sc1
ds_read_b64_tr_b16 a[66:67], v116 offset:2048
v_mfma_f32_16x16x32_bf16 v[88:91], a[104:107], v[160:163], v[88:91]
s_waitcnt lgkmcnt(8)
ds_read_b64_tr_b16 a[68:69], v116 offset:4096
v_mul_f32 v77, v77, v25
v_mfma_f32_16x16x32_bf16 v[88:91], a[108:111], v[176:179], v[88:91]
ds_read_b64_tr_b16 a[70:71], v116 offset:6144
v_mul_f32 v78, v78, v25
v_mfma_f32_16x16x32_bf16 v[88:91], a[112:115], v[192:195], v[88:91]
s_waitcnt lgkmcnt(8)
ds_read_b64_tr_b16 a[72:73], v116 offset:8192
v_mul_f32 v79, v79, v25
v_mfma_f32_16x16x32_bf16 v[88:91], a[116:119], v[208:211], v[88:91]
s_waitcnt lgkmcnt(7)
ds_read_b64_tr_b16 a[74:75], v116 offset:10240
v_cvt_pk_bf16_f32 v68, v68, v69
v_mfma_f32_16x16x32_bf16 v[88:91], a[120:123], v[224:227], v[88:91]
s_waitcnt lgkmcnt(6)
ds_read_b64_tr_b16 a[76:77], v116 offset:12288
v_cvt_pk_bf16_f32 v69, v70, v71
v_mfma_f32_16x16x32_bf16 v[88:91], a[124:127], v[240:243], v[88:91]
ds_read_b64_tr_b16 a[78:79], v116 offset:14336
v_cvt_pk_bf16_f32 v70, v76, v77
v_mfma_f32_16x16x32_bf16 v[92:95], a[96:99], v[132:135], 0
ds_read_b64_tr_b16 a[80:81], v116 offset:16384
v_cvt_pk_bf16_f32 v71, v78, v79
v_mfma_f32_16x16x32_bf16 v[92:95], a[100:103], v[148:151], v[92:95]
buffer_store_dwordx4 v[68:71], v1, s[4:7], s12 offen offset:2048 sc1
ds_read_b64_tr_b16 a[82:83], v116 offset:18432
v_mfma_f32_16x16x32_bf16 v[92:95], a[104:107], v[164:167], v[92:95]
ds_read_b64_tr_b16 a[84:85], v116 offset:20480
v_lshlrev_b32 v19, 2, v19
v_mfma_f32_16x16x32_bf16 v[92:95], a[108:111], v[180:183], v[92:95]
ds_read_b64_tr_b16 a[86:87], v116 offset:22528
v_mfma_f32_16x16x32_bf16 v[92:95], a[112:115], v[196:199], v[92:95]
ds_read_b64_tr_b16 a[88:89], v116 offset:24576
v_mfma_f32_16x16x32_bf16 v[92:95], a[116:119], v[212:215], v[92:95]
ds_read_b64_tr_b16 a[90:91], v116 offset:26624
v_mfma_f32_16x16x32_bf16 v[92:95], a[120:123], v[228:231], v[92:95]
ds_read_b64_tr_b16 a[92:93], v116 offset:28672
v_mfma_f32_16x16x32_bf16 v[92:95], a[124:127], v[244:247], v[92:95]
s_waitcnt lgkmcnt(8)
ds_read_b64_tr_b16 a[94:95], v116 offset:30720
v_mfma_f32_16x16x32_bf16 v[32:35], a[64:67], v[128:131], 0
ds_read_b64_tr_b16 a[96:97], v117 offset:0
v_mul_f32 v80, v80, v24
v_mfma_f32_16x16x32_bf16 v[32:35], a[68:71], v[144:147], v[32:35]
ds_read_b64_tr_b16 a[98:99], v117 offset:2048
v_mul_f32 v81, v81, v24
v_mfma_f32_16x16x32_bf16 v[32:35], a[72:75], v[160:163], v[32:35]
s_waitcnt lgkmcnt(8)
ds_read_b64_tr_b16 a[100:101], v117 offset:4096
v_mul_f32 v82, v82, v24
v_mfma_f32_16x16x32_bf16 v[32:35], a[76:79], v[176:179], v[32:35]
ds_read_b64_tr_b16 a[102:103], v117 offset:6144
v_mul_f32 v83, v83, v24
v_mfma_f32_16x16x32_bf16 v[32:35], a[80:83], v[192:195], v[32:35]
s_waitcnt lgkmcnt(8)
ds_read_b64_tr_b16 a[104:105], v117 offset:8192
v_mul_f32 v88, v88, v24
v_mfma_f32_16x16x32_bf16 v[32:35], a[84:87], v[208:211], v[32:35]
s_waitcnt lgkmcnt(7)
ds_read_b64_tr_b16 a[106:107], v117 offset:10240
v_mul_f32 v89, v89, v24
v_mfma_f32_16x16x32_bf16 v[32:35], a[88:91], v[224:227], v[32:35]
s_waitcnt lgkmcnt(6)
ds_read_b64_tr_b16 a[108:109], v117 offset:12288
v_mul_f32 v90, v90, v24
v_mfma_f32_16x16x32_bf16 v[32:35], a[92:95], v[240:243], v[32:35]
ds_read_b64_tr_b16 a[110:111], v117 offset:14336
v_mul_f32 v91, v91, v24
v_mfma_f32_16x16x32_bf16 v[36:39], a[64:67], v[132:135], 0
ds_read_b64_tr_b16 a[112:113], v117 offset:16384
v_cvt_pk_bf16_f32 v80, v80, v81
v_mfma_f32_16x16x32_bf16 v[36:39], a[68:71], v[148:151], v[36:39]
ds_read_b64_tr_b16 a[114:115], v117 offset:18432
v_cvt_pk_bf16_f32 v81, v82, v83
v_mfma_f32_16x16x32_bf16 v[36:39], a[72:75], v[164:167], v[36:39]
ds_read_b64_tr_b16 a[116:117], v117 offset:20480
v_cvt_pk_bf16_f32 v82, v88, v89
v_mfma_f32_16x16x32_bf16 v[36:39], a[76:79], v[180:183], v[36:39]
ds_read_b64_tr_b16 a[118:119], v117 offset:22528
v_cvt_pk_bf16_f32 v83, v90, v91
v_mfma_f32_16x16x32_bf16 v[36:39], a[80:83], v[196:199], v[36:39]
buffer_store_dwordx4 v[80:83], v1, s[4:7], s8 offen offset:3072 sc1
ds_read_b64_tr_b16 a[120:121], v117 offset:24576
v_mfma_f32_16x16x32_bf16 v[36:39], a[84:87], v[212:215], v[36:39]
ds_read_b64_tr_b16 a[122:123], v117 offset:26624
v_mul_f32 v84, v84, v25
v_mfma_f32_16x16x32_bf16 v[36:39], a[88:91], v[228:231], v[36:39]
ds_read_b64_tr_b16 a[124:125], v117 offset:28672
v_mul_f32 v85, v85, v25
v_mfma_f32_16x16x32_bf16 v[36:39], a[92:95], v[244:247], v[36:39]
s_waitcnt lgkmcnt(8)
ds_read_b64_tr_b16 a[126:127], v117 offset:30720
v_mul_f32 v86, v86, v25
v_mfma_f32_16x16x32_bf16 v[40:43], a[96:99], v[128:131], 0
ds_read_b64_tr_b16 a[64:65], v118 offset:0
v_mul_f32 v87, v87, v25
v_mfma_f32_16x16x32_bf16 v[40:43], a[100:103], v[144:147], v[40:43]
ds_read_b64_tr_b16 a[66:67], v118 offset:2048
v_mul_f32 v92, v92, v25
v_mfma_f32_16x16x32_bf16 v[40:43], a[104:107], v[160:163], v[40:43]
s_waitcnt lgkmcnt(8)
ds_read_b64_tr_b16 a[68:69], v118 offset:4096
v_mul_f32 v93, v93, v25
v_mfma_f32_16x16x32_bf16 v[40:43], a[108:111], v[176:179], v[40:43]
ds_read_b64_tr_b16 a[70:71], v118 offset:6144
v_mul_f32 v94, v94, v25
v_mfma_f32_16x16x32_bf16 v[40:43], a[112:115], v[192:195], v[40:43]
s_waitcnt lgkmcnt(8)
ds_read_b64_tr_b16 a[72:73], v118 offset:8192
v_mul_f32 v95, v95, v25
v_mfma_f32_16x16x32_bf16 v[40:43], a[116:119], v[208:211], v[40:43]
s_waitcnt lgkmcnt(7)
ds_read_b64_tr_b16 a[74:75], v118 offset:10240
v_cvt_pk_bf16_f32 v84, v84, v85
v_mfma_f32_16x16x32_bf16 v[40:43], a[120:123], v[224:227], v[40:43]
s_waitcnt lgkmcnt(6)
ds_read_b64_tr_b16 a[76:77], v118 offset:12288
v_cvt_pk_bf16_f32 v85, v86, v87
v_mfma_f32_16x16x32_bf16 v[40:43], a[124:127], v[240:243], v[40:43]
ds_read_b64_tr_b16 a[78:79], v118 offset:14336
v_cvt_pk_bf16_f32 v86, v92, v93
v_mfma_f32_16x16x32_bf16 v[44:47], a[96:99], v[132:135], 0
ds_read_b64_tr_b16 a[80:81], v118 offset:16384
v_cvt_pk_bf16_f32 v87, v94, v95
v_mfma_f32_16x16x32_bf16 v[44:47], a[100:103], v[148:151], v[44:47]
buffer_store_dwordx4 v[84:87], v1, s[4:7], s12 offen offset:3072 sc1
ds_read_b64_tr_b16 a[82:83], v118 offset:18432
v_mfma_f32_16x16x32_bf16 v[44:47], a[104:107], v[164:167], v[44:47]
s_add_u32 s8, s8, 4096
s_add_u32 s12, s12, 4096
ds_read_b64_tr_b16 a[84:85], v118 offset:20480
v_mfma_f32_16x16x32_bf16 v[44:47], a[108:111], v[180:183], v[44:47]
ds_read_b64_tr_b16 a[86:87], v118 offset:22528
v_lshrrev_b32 v22, 4, v20
v_mfma_f32_16x16x32_bf16 v[44:47], a[112:115], v[196:199], v[44:47]
ds_read_b64_tr_b16 a[88:89], v118 offset:24576
v_mul_f32 v32, v32, v24
v_mfma_f32_16x16x32_bf16 v[44:47], a[116:119], v[212:215], v[44:47]
ds_read_b64_tr_b16 a[90:91], v118 offset:26624
v_mul_f32 v33, v33, v24
v_mfma_f32_16x16x32_bf16 v[44:47], a[120:123], v[228:231], v[44:47]
ds_read_b64_tr_b16 a[92:93], v118 offset:28672
v_mul_f32 v34, v34, v24
v_mfma_f32_16x16x32_bf16 v[44:47], a[124:127], v[244:247], v[44:47]
s_waitcnt lgkmcnt(8)
ds_read_b64_tr_b16 a[94:95], v118 offset:30720
v_mul_f32 v35, v35, v24
v_mfma_f32_16x16x32_bf16 v[48:51], a[64:67], v[128:131], 0
ds_read_b64_tr_b16 a[96:97], v119 offset:0
v_mul_f32 v40, v40, v24
v_mfma_f32_16x16x32_bf16 v[48:51], a[68:71], v[144:147], v[48:51]
ds_read_b64_tr_b16 a[98:99], v119 offset:2048
v_mul_f32 v41, v41, v24
v_mfma_f32_16x16x32_bf16 v[48:51], a[72:75], v[160:163], v[48:51]
s_waitcnt lgkmcnt(8)
ds_read_b64_tr_b16 a[100:101], v119 offset:4096
v_mul_f32 v42, v42, v24
v_mfma_f32_16x16x32_bf16 v[48:51], a[76:79], v[176:179], v[48:51]
ds_read_b64_tr_b16 a[102:103], v119 offset:6144
v_mul_f32 v43, v43, v24
v_mfma_f32_16x16x32_bf16 v[48:51], a[80:83], v[192:195], v[48:51]
s_waitcnt lgkmcnt(8)
ds_read_b64_tr_b16 a[104:105], v119 offset:8192
v_cvt_pk_bf16_f32 v32, v32, v33
v_mfma_f32_16x16x32_bf16 v[48:51], a[84:87], v[208:211], v[48:51]
s_waitcnt lgkmcnt(7)
ds_read_b64_tr_b16 a[106:107], v119 offset:10240
v_cvt_pk_bf16_f32 v33, v34, v35
v_mfma_f32_16x16x32_bf16 v[48:51], a[88:91], v[224:227], v[48:51]
s_waitcnt lgkmcnt(6)
ds_read_b64_tr_b16 a[108:109], v119 offset:12288
v_cvt_pk_bf16_f32 v34, v40, v41
v_mfma_f32_16x16x32_bf16 v[48:51], a[92:95], v[240:243], v[48:51]
ds_read_b64_tr_b16 a[110:111], v119 offset:14336
v_cvt_pk_bf16_f32 v35, v42, v43
v_mfma_f32_16x16x32_bf16 v[52:55], a[64:67], v[132:135], 0
buffer_store_dwordx4 v[32:35], v1, s[4:7], s8 offen offset:0 sc1
ds_read_b64_tr_b16 a[112:113], v119 offset:16384
v_mfma_f32_16x16x32_bf16 v[52:55], a[68:71], v[148:151], v[52:55]
ds_read_b64_tr_b16 a[114:115], v119 offset:18432
v_mul_f32 v36, v36, v25
v_mfma_f32_16x16x32_bf16 v[52:55], a[72:75], v[164:167], v[52:55]
ds_read_b64_tr_b16 a[116:117], v119 offset:20480
v_mul_f32 v37, v37, v25
v_mfma_f32_16x16x32_bf16 v[52:55], a[76:79], v[180:183], v[52:55]
ds_read_b64_tr_b16 a[118:119], v119 offset:22528
v_mul_f32 v38, v38, v25
v_mfma_f32_16x16x32_bf16 v[52:55], a[80:83], v[196:199], v[52:55]
ds_read_b64_tr_b16 a[120:121], v119 offset:24576
v_mul_f32 v39, v39, v25
v_mfma_f32_16x16x32_bf16 v[52:55], a[84:87], v[212:215], v[52:55]
ds_read_b64_tr_b16 a[122:123], v119 offset:26624
v_mul_f32 v44, v44, v25
v_mfma_f32_16x16x32_bf16 v[52:55], a[88:91], v[228:231], v[52:55]
ds_read_b64_tr_b16 a[124:125], v119 offset:28672
ds_read_b64_tr_b16 a[126:127], v119 offset:30720
v_mfma_f32_16x16x32_bf16 v[52:55], a[92:95], v[244:247], v[52:55]
s_waitcnt lgkmcnt(9)
v_mul_f32 v45, v45, v25
v_mul_f32 v46, v46, v25
v_mfma_f32_16x16x32_bf16 v[56:59], a[96:99], v[128:131], 0
v_mul_f32 v47, v47, v25
v_cvt_pk_bf16_f32 v36, v36, v37
v_mfma_f32_16x16x32_bf16 v[56:59], a[100:103], v[144:147], v[56:59]
v_cvt_pk_bf16_f32 v37, v38, v39
v_cvt_pk_bf16_f32 v38, v44, v45
v_mfma_f32_16x16x32_bf16 v[56:59], a[104:107], v[160:163], v[56:59]
s_waitcnt lgkmcnt(6)
v_cvt_pk_bf16_f32 v39, v46, v47
v_lshl_add_u32 v21, v22, 3, v21
v_mfma_f32_16x16x32_bf16 v[56:59], a[108:111], v[176:179], v[56:59]
buffer_store_dwordx4 v[36:39], v1, s[4:7], s12 offen offset:0 sc1
v_mfma_f32_16x16x32_bf16 v[56:59], a[112:115], v[192:195], v[56:59]
s_waitcnt lgkmcnt(4)
v_mfma_f32_16x16x32_bf16 v[56:59], a[116:119], v[208:211], v[56:59]
s_waitcnt lgkmcnt(2)
v_mfma_f32_16x16x32_bf16 v[56:59], a[120:123], v[224:227], v[56:59]
s_waitcnt lgkmcnt(0)
v_mfma_f32_16x16x32_bf16 v[56:59], a[124:127], v[240:243], v[56:59]
v_mfma_f32_16x16x32_bf16 v[60:63], a[96:99], v[132:135], 0
v_mfma_f32_16x16x32_bf16 v[60:63], a[100:103], v[148:151], v[60:63]
v_mfma_f32_16x16x32_bf16 v[60:63], a[104:107], v[164:167], v[60:63]
v_mfma_f32_16x16x32_bf16 v[60:63], a[108:111], v[180:183], v[60:63]
v_mfma_f32_16x16x32_bf16 v[60:63], a[112:115], v[196:199], v[60:63]
buffer_load_dword v18, v19, s[4:7], s33 offen offset:0 sc1
v_mfma_f32_16x16x32_bf16 v[60:63], a[116:119], v[212:215], v[60:63]
v_mfma_f32_16x16x32_bf16 v[60:63], a[120:123], v[228:231], v[60:63]
v_mfma_f32_16x16x32_bf16 v[60:63], a[124:127], v[244:247], v[60:63]
v_mul_f32 v48, v48, v24
v_mul_f32 v49, v49, v24
v_mul_f32 v50, v50, v24
v_mul_f32 v51, v51, v24
v_mul_f32 v56, v56, v24
v_mul_f32 v57, v57, v24
v_mul_f32 v58, v58, v24
v_mul_f32 v59, v59, v24
v_cvt_pk_bf16_f32 v48, v48, v49
v_cvt_pk_bf16_f32 v49, v50, v51
v_cvt_pk_bf16_f32 v50, v56, v57
v_cvt_pk_bf16_f32 v51, v58, v59
buffer_store_dwordx4 v[48:51], v1, s[4:7], s8 offen offset:1024 sc1
v_mul_f32 v52, v52, v25
v_mul_f32 v53, v53, v25
v_mul_f32 v54, v54, v25
v_mul_f32 v55, v55, v25
v_mul_f32 v60, v60, v25
v_mul_f32 v61, v61, v25
v_mul_f32 v62, v62, v25
v_mul_f32 v63, v63, v25
v_cvt_pk_bf16_f32 v52, v52, v53
v_cvt_pk_bf16_f32 v53, v54, v55
v_cvt_pk_bf16_f32 v54, v60, v61
v_cvt_pk_bf16_f32 v55, v62, v63
buffer_store_dwordx4 v[52:55], v1, s[4:7], s12 offen offset:1024 sc1
s_and_b32 s22, s2, 224
s_cmp_eq_u32 s22, 224
s_cbranch_scc1 M_final
s_waitcnt vmcnt(0)
s_barrier
buffer_store_dword v6, v5, s[4:7], s35 offen sc1
s_bitcmp1_b32 s79, 4
s_cbranch_scc1 M_rA
v_cmp_gt_u32 vcc, 1, v18
s_cbranch_vccnz M_rslow
M_rjoin:
buffer_load_dwordx4 v[128:131], v1, s[4:7], s26 offen sc1
s_add_u32 s26, s26, 14336
buffer_load_dwordx4 v[132:135], v1, s[4:7], s26 offen sc1
s_add_u32 s26, s26, 14336
buffer_load_dwordx4 v[136:139], v1, s[4:7], s26 offen sc1
s_add_u32 s26, s26, 14336
buffer_load_dwordx4 v[140:143], v1, s[4:7], s26 offen sc1
s_add_u32 s26, s26, 14336
buffer_load_dwordx4 v[144:147], v1, s[4:7], s26 offen sc1
s_add_u32 s26, s26, 14336
buffer_load_dwordx4 v[148:151], v1, s[4:7], s26 offen sc1
s_add_u32 s26, s26, 14336
buffer_load_dwordx4 v[152:155], v1, s[4:7], s26 offen sc1
s_add_u32 s26, s26, 14336
buffer_load_dwordx4 v[156:159], v1, s[4:7], s26 offen sc1
s_add_u32 s26, s26, 14336
buffer_load_dwordx4 v[160:163], v1, s[4:7], s26 offen sc1
s_add_u32 s26, s26, 14336
buffer_load_dwordx4 v[164:167], v1, s[4:7], s26 offen sc1
s_add_u32 s26, s26, 14336
buffer_load_dwordx4 v[168:171], v1, s[4:7], s26 offen sc1
s_add_u32 s26, s26, 14336
buffer_load_dwordx4 v[172:175], v1, s[4:7], s26 offen sc1
s_add_u32 s26, s26, 14336
buffer_load_dwordx4 v[176:179], v1, s[4:7], s26 offen sc1
s_add_u32 s26, s26, 14336
buffer_load_dwordx4 v[180:183], v1, s[4:7], s26 offen sc1
s_add_u32 s26, s26, 14336
buffer_load_dwordx4 v[184:187], v1, s[4:7], s26 offen sc1
s_add_u32 s26, s26, 14336
buffer_load_dwordx4 v[188:191], v1, s[4:7], s26 offen sc1
Lp_9201:
buffer_load_dword v18, v19, s[4:7], s33 offen offset:2048 sc1
s_waitcnt vmcnt(0)
v_cmp_gt_u32 vcc, 1, v18
s_cbranch_vccz Lpd_9202
s_sleep 8
s_sub_u32 s101, s101, 1
s_cbranch_scc0 Lp_9201
s_mov_b32 s101, 0
Lpd_9202:
s_sub_u32 s26, s26, 207872
buffer_load_dwordx4 v[192:195], v1, s[4:7], s26 offen sc1
s_add_u32 s26, s26, 14336
buffer_load_dwordx4 v[196:199], v1, s[4:7], s26 offen sc1
s_add_u32 s26, s26, 14336
buffer_load_dwordx4 v[200:203], v1, s[4:7], s26 offen sc1
s_add_u32 s26, s26, 14336
buffer_load_dwordx4 v[204:207], v1, s[4:7], s26 offen sc1
s_add_u32 s26, s26, 14336
buffer_load_dwordx4 v[208:211], v1, s[4:7], s26 offen sc1
s_add_u32 s26, s26, 14336
buffer_load_dwordx4 v[212:215], v1, s[4:7], s26 offen sc1
s_add_u32 s26, s26, 14336
buffer_load_dwordx4 v[216:219], v1, s[4:7], s26 offen sc1
s_add_u32 s26, s26, 14336
buffer_load_dwordx4 v[220:223], v1, s[4:7], s26 offen sc1
s_add_u32 s26, s26, 14336
buffer_load_dwordx4 v[224:227], v1, s[4:7], s26 offen sc1
s_add_u32 s26, s26, 14336
buffer_load_dwordx4 v[228:231], v1, s[4:7], s26 offen sc1
s_add_u32 s26, s26, 14336
buffer_load_dwordx4 v[232:235], v1, s[4:7], s26 offen sc1
s_add_u32 s26, s26, 14336
buffer_load_dwordx4 v[236:239], v1, s[4:7], s26 offen sc1
s_add_u32 s26, s26, 14336
buffer_load_dwordx4 v[240:243], v1, s[4:7], s26 offen sc1
s_add_u32 s26, s26, 14336
buffer_load_dwordx4 v[244:247], v1, s[4:7], s26 offen sc1
s_add_u32 s26, s26, 14336
buffer_load_dwordx4 v[248:251], v1, s[4:7], s26 offen sc1
s_add_u32 s26, s26, 14336
buffer_load_dwordx4 v[252:255], v1, s[4:7], s26 offen sc1
v_lshlrev_b32 v96, 16, v128
v_and_b32 v97, 0xffff0000, v128
v_lshlrev_b32 v98, 16, v129
v_and_b32 v99, 0xffff0000, v129
v_lshlrev_b32 v100, 16, v130
v_and_b32 v101, 0xffff0000, v130
v_lshlrev_b32 v102, 16, v131
v_and_b32 v103, 0xffff0000, v131
v_lshlrev_b32 v10, 16, v132
v_and_b32 v11, 0xffff0000, v132
v_lshlrev_b32 v12, 16, v133
v_and_b32 v13, 0xffff0000, v133
v_lshlrev_b32 v14, 16, v134
v_and_b32 v15, 0xffff0000, v134
v_lshlrev_b32 v16, 16, v135
v_and_b32 v17, 0xffff0000, v135
v_pk_add_f32 v[96:97], v[96:97], v[10:11]
v_pk_add_f32 v[98:99], v[98:99], v[12:13]
v_pk_add_f32 v[100:101], v[100:101], v[14:15]
v_pk_add_f32 v[102:103], v[102:103], v[16:17]
v_lshlrev_b32 v10, 16, v136
v_and_b32 v11, 0xffff0000, v136
v_lshlrev_b32 v12, 16, v137
v_and_b32 v13, 0xffff0000, v137
v_lshlrev_b32 v14, 16, v138
v_and_b32 v15, 0xffff0000, v138
v_lshlrev_b32 v16, 16, v139
v_and_b32 v17, 0xffff0000, v139
v_pk_add_f32 v[96:97], v[96:97], v[10:11]
v_pk_add_f32 v[98:99], v[98:99], v[12:13]
v_pk_add_f32 v[100:101], v[100:101], v[14:15]
v_pk_add_f32 v[102:103], v[102:103], v[16:17]
v_lshlrev_b32 v10, 16, v140
v_and_b32 v11, 0xffff0000, v140
v_lshlrev_b32 v12, 16, v141
v_and_b32 v13, 0xffff0000, v141
v_lshlrev_b32 v14, 16, v142
v_and_b32 v15, 0xffff0000, v142
v_lshlrev_b32 v16, 16, v143
v_and_b32 v17, 0xffff0000, v143
v_pk_add_f32 v[96:97], v[96:97], v[10:11]
v_pk_add_f32 v[98:99], v[98:99], v[12:13]
v_pk_add_f32 v[100:101], v[100:101], v[14:15]
v_pk_add_f32 v[102:103], v[102:103], v[16:17]
v_lshlrev_b32 v10, 16, v144
v_and_b32 v11, 0xffff0000, v144
v_lshlrev_b32 v12, 16, v145
v_and_b32 v13, 0xffff0000, v145
v_lshlrev_b32 v14, 16, v146
v_and_b32 v15, 0xffff0000, v146
v_lshlrev_b32 v16, 16, v147
v_and_b32 v17, 0xffff0000, v147
v_pk_add_f32 v[96:97], v[96:97], v[10:11]
v_pk_add_f32 v[98:99], v[98:99], v[12:13]
v_pk_add_f32 v[100:101], v[100:101], v[14:15]
v_pk_add_f32 v[102:103], v[102:103], v[16:17]
v_lshlrev_b32 v10, 16, v148
v_and_b32 v11, 0xffff0000, v148
v_lshlrev_b32 v12, 16, v149
v_and_b32 v13, 0xffff0000, v149
v_lshlrev_b32 v14, 16, v150
v_and_b32 v15, 0xffff0000, v150
v_lshlrev_b32 v16, 16, v151
v_and_b32 v17, 0xffff0000, v151
v_pk_add_f32 v[96:97], v[96:97], v[10:11]
v_pk_add_f32 v[98:99], v[98:99], v[12:13]
v_pk_add_f32 v[100:101], v[100:101], v[14:15]
v_pk_add_f32 v[102:103], v[102:103], v[16:17]
v_lshlrev_b32 v10, 16, v152
v_and_b32 v11, 0xffff0000, v152
v_lshlrev_b32 v12, 16, v153
v_and_b32 v13, 0xffff0000, v153
v_lshlrev_b32 v14, 16, v154
v_and_b32 v15, 0xffff0000, v154
v_lshlrev_b32 v16, 16, v155
v_and_b32 v17, 0xffff0000, v155
v_pk_add_f32 v[96:97], v[96:97], v[10:11]
v_pk_add_f32 v[98:99], v[98:99], v[12:13]
v_pk_add_f32 v[100:101], v[100:101], v[14:15]
v_pk_add_f32 v[102:103], v[102:103], v[16:17]
v_lshlrev_b32 v10, 16, v156
v_and_b32 v11, 0xffff0000, v156
v_lshlrev_b32 v12, 16, v157
v_and_b32 v13, 0xffff0000, v157
v_lshlrev_b32 v14, 16, v158
v_and_b32 v15, 0xffff0000, v158
v_lshlrev_b32 v16, 16, v159
v_and_b32 v17, 0xffff0000, v159
v_pk_add_f32 v[96:97], v[96:97], v[10:11]
v_pk_add_f32 v[98:99], v[98:99], v[12:13]
v_pk_add_f32 v[100:101], v[100:101], v[14:15]
v_pk_add_f32 v[102:103], v[102:103], v[16:17]
v_lshlrev_b32 v10, 16, v160
v_and_b32 v11, 0xffff0000, v160
v_lshlrev_b32 v12, 16, v161
v_and_b32 v13, 0xffff0000, v161
v_lshlrev_b32 v14, 16, v162
v_and_b32 v15, 0xffff0000, v162
v_lshlrev_b32 v16, 16, v163
v_and_b32 v17, 0xffff0000, v163
v_pk_add_f32 v[96:97], v[96:97], v[10:11]
v_pk_add_f32 v[98:99], v[98:99], v[12:13]
v_pk_add_f32 v[100:101], v[100:101], v[14:15]
v_pk_add_f32 v[102:103], v[102:103], v[16:17]
v_lshlrev_b32 v10, 16, v164
v_and_b32 v11, 0xffff0000, v164
v_lshlrev_b32 v12, 16, v165
v_and_b32 v13, 0xffff0000, v165
v_lshlrev_b32 v14, 16, v166
v_and_b32 v15, 0xffff0000, v166
v_lshlrev_b32 v16, 16, v167
v_and_b32 v17, 0xffff0000, v167
v_pk_add_f32 v[96:97], v[96:97], v[10:11]
v_pk_add_f32 v[98:99], v[98:99], v[12:13]
v_pk_add_f32 v[100:101], v[100:101], v[14:15]
v_pk_add_f32 v[102:103], v[102:103], v[16:17]
v_lshlrev_b32 v10, 16, v168
v_and_b32 v11, 0xffff0000, v168
v_lshlrev_b32 v12, 16, v169
v_and_b32 v13, 0xffff0000, v169
v_lshlrev_b32 v14, 16, v170
v_and_b32 v15, 0xffff0000, v170
v_lshlrev_b32 v16, 16, v171
v_and_b32 v17, 0xffff0000, v171
v_pk_add_f32 v[96:97], v[96:97], v[10:11]
v_pk_add_f32 v[98:99], v[98:99], v[12:13]
v_pk_add_f32 v[100:101], v[100:101], v[14:15]
v_pk_add_f32 v[102:103], v[102:103], v[16:17]
v_lshlrev_b32 v10, 16, v172
v_and_b32 v11, 0xffff0000, v172
v_lshlrev_b32 v12, 16, v173
v_and_b32 v13, 0xffff0000, v173
v_lshlrev_b32 v14, 16, v174
v_and_b32 v15, 0xffff0000, v174
v_lshlrev_b32 v16, 16, v175
v_and_b32 v17, 0xffff0000, v175
v_pk_add_f32 v[96:97], v[96:97], v[10:11]
v_pk_add_f32 v[98:99], v[98:99], v[12:13]
v_pk_add_f32 v[100:101], v[100:101], v[14:15]
v_pk_add_f32 v[102:103], v[102:103], v[16:17]
v_lshlrev_b32 v10, 16, v176
v_and_b32 v11, 0xffff0000, v176
v_lshlrev_b32 v12, 16, v177
v_and_b32 v13, 0xffff0000, v177
v_lshlrev_b32 v14, 16, v178
v_and_b32 v15, 0xffff0000, v178
v_lshlrev_b32 v16, 16, v179
v_and_b32 v17, 0xffff0000, v179
v_pk_add_f32 v[96:97], v[96:97], v[10:11]
v_pk_add_f32 v[98:99], v[98:99], v[12:13]
v_pk_add_f32 v[100:101], v[100:101], v[14:15]
v_pk_add_f32 v[102:103], v[102:103], v[16:17]
v_lshlrev_b32 v10, 16, v180
v_and_b32 v11, 0xffff0000, v180
v_lshlrev_b32 v12, 16, v181
v_and_b32 v13, 0xffff0000, v181
v_lshlrev_b32 v14, 16, v182
v_and_b32 v15, 0xffff0000, v182
v_lshlrev_b32 v16, 16, v183
v_and_b32 v17, 0xffff0000, v183
v_pk_add_f32 v[96:97], v[96:97], v[10:11]
v_pk_add_f32 v[98:99], v[98:99], v[12:13]
v_pk_add_f32 v[100:101], v[100:101], v[14:15]
v_pk_add_f32 v[102:103], v[102:103], v[16:17]
v_lshlrev_b32 v10, 16, v184
v_and_b32 v11, 0xffff0000, v184
v_lshlrev_b32 v12, 16, v185
v_and_b32 v13, 0xffff0000, v185
v_lshlrev_b32 v14, 16, v186
v_and_b32 v15, 0xffff0000, v186
v_lshlrev_b32 v16, 16, v187
v_and_b32 v17, 0xffff0000, v187
v_pk_add_f32 v[96:97], v[96:97], v[10:11]
v_pk_add_f32 v[98:99], v[98:99], v[12:13]
v_pk_add_f32 v[100:101], v[100:101], v[14:15]
v_pk_add_f32 v[102:103], v[102:103], v[16:17]
v_lshlrev_b32 v10, 16, v188
v_and_b32 v11, 0xffff0000, v188
v_lshlrev_b32 v12, 16, v189
v_and_b32 v13, 0xffff0000, v189
v_lshlrev_b32 v14, 16, v190
v_and_b32 v15, 0xffff0000, v190
v_lshlrev_b32 v16, 16, v191
v_and_b32 v17, 0xffff0000, v191
v_pk_add_f32 v[96:97], v[96:97], v[10:11]
v_pk_add_f32 v[98:99], v[98:99], v[12:13]
v_pk_add_f32 v[100:101], v[100:101], v[14:15]
v_pk_add_f32 v[102:103], v[102:103], v[16:17]
v_cvt_pk_bf16_f32 v96, v96, v97
v_cvt_pk_bf16_f32 v97, v98, v99
v_cvt_pk_bf16_f32 v98, v100, v101
v_cvt_pk_bf16_f32 v99, v102, v103
buffer_store_dwordx2 v[96:97], v21, s[40:43], s25 offen offset:896
buffer_store_dwordx2 v[98:99], v21, s[40:43], s25 offen offset:928
s_waitcnt vmcnt(17)
v_lshlrev_b32 v104, 16, v192
v_and_b32 v105, 0xffff0000, v192
v_lshlrev_b32 v106, 16, v193
v_and_b32 v107, 0xffff0000, v193
v_lshlrev_b32 v108, 16, v194
v_and_b32 v109, 0xffff0000, v194
v_lshlrev_b32 v110, 16, v195
v_and_b32 v111, 0xffff0000, v195
s_waitcnt vmcnt(16)
v_lshlrev_b32 v10, 16, v196
v_and_b32 v11, 0xffff0000, v196
v_lshlrev_b32 v12, 16, v197
v_and_b32 v13, 0xffff0000, v197
v_lshlrev_b32 v14, 16, v198
v_and_b32 v15, 0xffff0000, v198
v_lshlrev_b32 v16, 16, v199
v_and_b32 v17, 0xffff0000, v199
v_pk_add_f32 v[104:105], v[104:105], v[10:11]
v_pk_add_f32 v[106:107], v[106:107], v[12:13]
PAD_17:
s_cbranch_execz M_tret
v_pk_add_f32 v[108:109], v[108:109], v[14:15]
v_pk_add_f32 v[110:111], v[110:111], v[16:17]
s_waitcnt vmcnt(15)
v_lshlrev_b32 v10, 16, v200
v_and_b32 v11, 0xffff0000, v200
v_lshlrev_b32 v12, 16, v201
v_and_b32 v13, 0xffff0000, v201
v_lshlrev_b32 v14, 16, v202
v_and_b32 v15, 0xffff0000, v202
v_lshlrev_b32 v16, 16, v203
v_and_b32 v17, 0xffff0000, v203
v_pk_add_f32 v[104:105], v[104:105], v[10:11]
v_pk_add_f32 v[106:107], v[106:107], v[12:13]
v_pk_add_f32 v[108:109], v[108:109], v[14:15]
v_pk_add_f32 v[110:111], v[110:111], v[16:17]
s_waitcnt vmcnt(14)
v_lshlrev_b32 v10, 16, v204
v_and_b32 v11, 0xffff0000, v204
v_lshlrev_b32 v12, 16, v205
v_and_b32 v13, 0xffff0000, v205
v_lshlrev_b32 v14, 16, v206
v_and_b32 v15, 0xffff0000, v206
v_lshlrev_b32 v16, 16, v207
v_and_b32 v17, 0xffff0000, v207
v_pk_add_f32 v[104:105], v[104:105], v[10:11]
v_pk_add_f32 v[106:107], v[106:107], v[12:13]
v_pk_add_f32 v[108:109], v[108:109], v[14:15]
v_pk_add_f32 v[110:111], v[110:111], v[16:17]
s_waitcnt vmcnt(13)
v_lshlrev_b32 v10, 16, v208
v_and_b32 v11, 0xffff0000, v208
v_lshlrev_b32 v12, 16, v209
v_and_b32 v13, 0xffff0000, v209
v_lshlrev_b32 v14, 16, v210
v_and_b32 v15, 0xffff0000, v210
v_lshlrev_b32 v16, 16, v211
v_and_b32 v17, 0xffff0000, v211
v_pk_add_f32 v[104:105], v[104:105], v[10:11]
v_pk_add_f32 v[106:107], v[106:107], v[12:13]
v_pk_add_f32 v[108:109], v[108:109], v[14:15]
v_pk_add_f32 v[110:111], v[110:111], v[16:17]
s_waitcnt vmcnt(12)
v_lshlrev_b32 v10, 16, v212
v_and_b32 v11, 0xffff0000, v212
v_lshlrev_b32 v12, 16, v213
v_and_b32 v13, 0xffff0000, v213
v_lshlrev_b32 v14, 16, v214
v_and_b32 v15, 0xffff0000, v214
v_lshlrev_b32 v16, 16, v215
v_and_b32 v17, 0xffff0000, v215
v_pk_add_f32 v[104:105], v[104:105], v[10:11]
v_pk_add_f32 v[106:107], v[106:107], v[12:13]
v_pk_add_f32 v[108:109], v[108:109], v[14:15]
v_pk_add_f32 v[110:111], v[110:111], v[16:17]
s_waitcnt vmcnt(11)
v_lshlrev_b32 v10, 16, v216
v_and_b32 v11, 0xffff0000, v216
v_lshlrev_b32 v12, 16, v217
v_and_b32 v13, 0xffff0000, v217
v_lshlrev_b32 v14, 16, v218
v_and_b32 v15, 0xffff0000, v218
v_lshlrev_b32 v16, 16, v219
v_and_b32 v17, 0xffff0000, v219
v_pk_add_f32 v[104:105], v[104:105], v[10:11]
v_pk_add_f32 v[106:107], v[106:107], v[12:13]
v_pk_add_f32 v[108:109], v[108:109], v[14:15]
v_pk_add_f32 v[110:111], v[110:111], v[16:17]
s_waitcnt vmcnt(10)
v_lshlrev_b32 v10, 16, v220
v_and_b32 v11, 0xffff0000, v220
v_lshlrev_b32 v12, 16, v221
v_and_b32 v13, 0xffff0000, v221
v_lshlrev_b32 v14, 16, v222
v_and_b32 v15, 0xffff0000, v222
v_lshlrev_b32 v16, 16, v223
v_and_b32 v17, 0xffff0000, v223
v_pk_add_f32 v[104:105], v[104:105], v[10:11]
v_pk_add_f32 v[106:107], v[106:107], v[12:13]
v_pk_add_f32 v[108:109], v[108:109], v[14:15]
v_pk_add_f32 v[110:111], v[110:111], v[16:17]
s_waitcnt vmcnt(9)
v_lshlrev_b32 v10, 16, v224
v_and_b32 v11, 0xffff0000, v224
v_lshlrev_b32 v12, 16, v225
v_and_b32 v13, 0xffff0000, v225
v_lshlrev_b32 v14, 16, v226
v_and_b32 v15, 0xffff0000, v226
v_lshlrev_b32 v16, 16, v227
v_and_b32 v17, 0xffff0000, v227
v_pk_add_f32 v[104:105], v[104:105], v[10:11]
v_pk_add_f32 v[106:107], v[106:107], v[12:13]
v_pk_add_f32 v[108:109], v[108:109], v[14:15]
v_pk_add_f32 v[110:111], v[110:111], v[16:17]
s_waitcnt vmcnt(8)
v_lshlrev_b32 v10, 16, v228
v_and_b32 v11, 0xffff0000, v228
v_lshlrev_b32 v12, 16, v229
v_and_b32 v13, 0xffff0000, v229
v_lshlrev_b32 v14, 16, v230
v_and_b32 v15, 0xffff0000, v230
v_lshlrev_b32 v16, 16, v231
v_and_b32 v17, 0xffff0000, v231
v_pk_add_f32 v[104:105], v[104:105], v[10:11]
v_pk_add_f32 v[106:107], v[106:107], v[12:13]
v_pk_add_f32 v[108:109], v[108:109], v[14:15]
v_pk_add_f32 v[110:111], v[110:111], v[16:17]
s_waitcnt vmcnt(7)
v_lshlrev_b32 v10, 16, v232
v_and_b32 v11, 0xffff0000, v232
v_lshlrev_b32 v12, 16, v233
v_and_b32 v13, 0xffff0000, v233
v_lshlrev_b32 v14, 16, v234
v_and_b32 v15, 0xffff0000, v234
v_lshlrev_b32 v16, 16, v235
v_and_b32 v17, 0xffff0000, v235
v_pk_add_f32 v[104:105], v[104:105], v[10:11]
v_pk_add_f32 v[106:107], v[106:107], v[12:13]
v_pk_add_f32 v[108:109], v[108:109], v[14:15]
v_pk_add_f32 v[110:111], v[110:111], v[16:17]
s_waitcnt vmcnt(6)
v_lshlrev_b32 v10, 16, v236
v_and_b32 v11, 0xffff0000, v236
v_lshlrev_b32 v12, 16, v237
v_and_b32 v13, 0xffff0000, v237
v_lshlrev_b32 v14, 16, v238
v_and_b32 v15, 0xffff0000, v238
v_lshlrev_b32 v16, 16, v239
v_and_b32 v17, 0xffff0000, v239
v_pk_add_f32 v[104:105], v[104:105], v[10:11]
v_pk_add_f32 v[106:107], v[106:107], v[12:13]
v_pk_add_f32 v[108:109], v[108:109], v[14:15]
v_pk_add_f32 v[110:111], v[110:111], v[16:17]
s_waitcnt vmcnt(5)
v_lshlrev_b32 v10, 16, v240
v_and_b32 v11, 0xffff0000, v240
v_lshlrev_b32 v12, 16, v241
v_and_b32 v13, 0xffff0000, v241
v_lshlrev_b32 v14, 16, v242
v_and_b32 v15, 0xffff0000, v242
v_lshlrev_b32 v16, 16, v243
v_and_b32 v17, 0xffff0000, v243
v_pk_add_f32 v[104:105], v[104:105], v[10:11]
v_pk_add_f32 v[106:107], v[106:107], v[12:13]
v_pk_add_f32 v[108:109], v[108:109], v[14:15]
v_pk_add_f32 v[110:111], v[110:111], v[16:17]
s_waitcnt vmcnt(4)
v_lshlrev_b32 v10, 16, v244
v_and_b32 v11, 0xffff0000, v244
v_lshlrev_b32 v12, 16, v245
v_and_b32 v13, 0xffff0000, v245
v_lshlrev_b32 v14, 16, v246
v_and_b32 v15, 0xffff0000, v246
v_lshlrev_b32 v16, 16, v247
v_and_b32 v17, 0xffff0000, v247
v_pk_add_f32 v[104:105], v[104:105], v[10:11]
v_pk_add_f32 v[106:107], v[106:107], v[12:13]
v_pk_add_f32 v[108:109], v[108:109], v[14:15]
v_pk_add_f32 v[110:111], v[110:111], v[16:17]
s_waitcnt vmcnt(3)
v_lshlrev_b32 v10, 16, v248
v_and_b32 v11, 0xffff0000, v248
v_lshlrev_b32 v12, 16, v249
v_and_b32 v13, 0xffff0000, v249
v_lshlrev_b32 v14, 16, v250
v_and_b32 v15, 0xffff0000, v250
v_lshlrev_b32 v16, 16, v251
v_and_b32 v17, 0xffff0000, v251
v_pk_add_f32 v[104:105], v[104:105], v[10:11]
v_pk_add_f32 v[106:107], v[106:107], v[12:13]
v_pk_add_f32 v[108:109], v[108:109], v[14:15]
v_pk_add_f32 v[110:111], v[110:111], v[16:17]
s_waitcnt vmcnt(2)
v_lshlrev_b32 v10, 16, v252
v_and_b32 v11, 0xffff0000, v252
v_lshlrev_b32 v12, 16, v253
v_and_b32 v13, 0xffff0000, v253
v_lshlrev_b32 v14, 16, v254
v_and_b32 v15, 0xffff0000, v254
v_lshlrev_b32 v16, 16, v255
v_and_b32 v17, 0xffff0000, v255
v_pk_add_f32 v[104:105], v[104:105], v[10:11]
v_pk_add_f32 v[106:107], v[106:107], v[12:13]
v_pk_add_f32 v[108:109], v[108:109], v[14:15]
v_pk_add_f32 v[110:111], v[110:111], v[16:17]
v_cvt_pk_bf16_f32 v104, v104, v105
v_cvt_pk_bf16_f32 v105, v106, v107
v_cvt_pk_bf16_f32 v106, v108, v109
v_cvt_pk_bf16_f32 v107, v110, v111
buffer_store_dwordx2 v[104:105], v21, s[40:43], s25 offen offset:1344
buffer_store_dwordx2 v[106:107], v21, s[40:43], s25 offen offset:1376
s_add_u32 s25, s25, 1835008
s_add_u32 s26, s26, 14457856
s_add_u32 s33, s33, 1024
s_branch M_r1
M_rA:
PAD_18:
s_cbranch_execz M_tret
s_add_u32 s25, s25, 448
s_add_u32 s26, s26, 7168
s_add_u32 s33, s33, 2048
M_r1:
Lp_9203:
buffer_load_dword v18, v19, s[4:7], s33 offen offset:0 sc1
s_waitcnt vmcnt(0)
v_cmp_gt_u32 vcc, 1, v18
s_cbranch_vccz Lpd_9204
s_sleep 8
s_sub_u32 s101, s101, 1
s_cbranch_scc0 Lp_9203
s_mov_b32 s101, 0
Lpd_9204:
buffer_load_dwordx4 v[128:131], v1, s[4:7], s26 offen sc1
s_add_u32 s26, s26, 14336
buffer_load_dwordx4 v[132:135], v1, s[4:7], s26 offen sc1
s_add_u32 s26, s26, 14336
buffer_load_dwordx4 v[136:139], v1, s[4:7], s26 offen sc1
s_add_u32 s26, s26, 14336
buffer_load_dwordx4 v[140:143], v1, s[4:7], s26 offen sc1
s_add_u32 s26, s26, 14336
buffer_load_dwordx4 v[144:147], v1, s[4:7], s26 offen sc1
s_add_u32 s26, s26, 14336
buffer_load_dwordx4 v[148:151], v1, s[4:7], s26 offen sc1
s_add_u32 s26, s26, 14336
buffer_load_dwordx4 v[152:155], v1, s[4:7], s26 offen sc1
s_add_u32 s26, s26, 14336
buffer_load_dwordx4 v[156:159], v1, s[4:7], s26 offen sc1
s_add_u32 s26, s26, 14336
buffer_load_dwordx4 v[160:163], v1, s[4:7], s26 offen sc1
s_add_u32 s26, s26, 14336
buffer_load_dwordx4 v[164:167], v1, s[4:7], s26 offen sc1
s_add_u32 s26, s26, 14336
buffer_load_dwordx4 v[168:171], v1, s[4:7], s26 offen sc1
s_add_u32 s26, s26, 14336
buffer_load_dwordx4 v[172:175], v1, s[4:7], s26 offen sc1
s_add_u32 s26, s26, 14336
buffer_load_dwordx4 v[176:179], v1, s[4:7], s26 offen sc1
s_add_u32 s26, s26, 14336
buffer_load_dwordx4 v[180:183], v1, s[4:7], s26 offen sc1
s_add_u32 s26, s26, 14336
buffer_load_dwordx4 v[184:187], v1, s[4:7], s26 offen sc1
s_add_u32 s26, s26, 14336
buffer_load_dwordx4 v[188:191], v1, s[4:7], s26 offen sc1
s_waitcnt vmcnt(15)
v_lshlrev_b32 v96, 16, v128
v_and_b32 v97, 0xffff0000, v128
v_lshlrev_b32 v98, 16, v129
v_and_b32 v99, 0xffff0000, v129
v_lshlrev_b32 v100, 16, v130
v_and_b32 v101, 0xffff0000, v130
v_lshlrev_b32 v102, 16, v131
v_and_b32 v103, 0xffff0000, v131
s_waitcnt vmcnt(14)
v_lshlrev_b32 v10, 16, v132
v_and_b32 v11, 0xffff0000, v132
v_lshlrev_b32 v12, 16, v133
v_and_b32 v13, 0xffff0000, v133
v_lshlrev_b32 v14, 16, v134
v_and_b32 v15, 0xffff0000, v134
v_lshlrev_b32 v16, 16, v135
v_and_b32 v17, 0xffff0000, v135
v_pk_add_f32 v[96:97], v[96:97], v[10:11]
v_pk_add_f32 v[98:99], v[98:99], v[12:13]
v_pk_add_f32 v[100:101], v[100:101], v[14:15]
v_pk_add_f32 v[102:103], v[102:103], v[16:17]
s_waitcnt vmcnt(13)
v_lshlrev_b32 v10, 16, v136
v_and_b32 v11, 0xffff0000, v136
v_lshlrev_b32 v12, 16, v137
v_and_b32 v13, 0xffff0000, v137
v_lshlrev_b32 v14, 16, v138
v_and_b32 v15, 0xffff0000, v138
v_lshlrev_b32 v16, 16, v139
v_and_b32 v17, 0xffff0000, v139
v_pk_add_f32 v[96:97], v[96:97], v[10:11]
v_pk_add_f32 v[98:99], v[98:99], v[12:13]
v_pk_add_f32 v[100:101], v[100:101], v[14:15]
v_pk_add_f32 v[102:103], v[102:103], v[16:17]
s_waitcnt vmcnt(12)
v_lshlrev_b32 v10, 16, v140
v_and_b32 v11, 0xffff0000, v140
v_lshlrev_b32 v12, 16, v141
v_and_b32 v13, 0xffff0000, v141
v_lshlrev_b32 v14, 16, v142
v_and_b32 v15, 0xffff0000, v142
v_lshlrev_b32 v16, 16, v143
v_and_b32 v17, 0xffff0000, v143
v_pk_add_f32 v[96:97], v[96:97], v[10:11]
v_pk_add_f32 v[98:99], v[98:99], v[12:13]
v_pk_add_f32 v[100:101], v[100:101], v[14:15]
v_pk_add_f32 v[102:103], v[102:103], v[16:17]
s_waitcnt vmcnt(11)
v_lshlrev_b32 v10, 16, v144
v_and_b32 v11, 0xffff0000, v144
v_lshlrev_b32 v12, 16, v145
v_and_b32 v13, 0xffff0000, v145
v_lshlrev_b32 v14, 16, v146
v_and_b32 v15, 0xffff0000, v146
v_lshlrev_b32 v16, 16, v147
v_and_b32 v17, 0xffff0000, v147
v_pk_add_f32 v[96:97], v[96:97], v[10:11]
v_pk_add_f32 v[98:99], v[98:99], v[12:13]
v_pk_add_f32 v[100:101], v[100:101], v[14:15]
v_pk_add_f32 v[102:103], v[102:103], v[16:17]
s_waitcnt vmcnt(10)
v_lshlrev_b32 v10, 16, v148
v_and_b32 v11, 0xffff0000, v148
v_lshlrev_b32 v12, 16, v149
v_and_b32 v13, 0xffff0000, v149
v_lshlrev_b32 v14, 16, v150
v_and_b32 v15, 0xffff0000, v150
v_lshlrev_b32 v16, 16, v151
v_and_b32 v17, 0xffff0000, v151
v_pk_add_f32 v[96:97], v[96:97], v[10:11]
v_pk_add_f32 v[98:99], v[98:99], v[12:13]
v_pk_add_f32 v[100:101], v[100:101], v[14:15]
v_pk_add_f32 v[102:103], v[102:103], v[16:17]
s_waitcnt vmcnt(9)
v_lshlrev_b32 v10, 16, v152
v_and_b32 v11, 0xffff0000, v152
v_lshlrev_b32 v12, 16, v153
v_and_b32 v13, 0xffff0000, v153
v_lshlrev_b32 v14, 16, v154
v_and_b32 v15, 0xffff0000, v154
v_lshlrev_b32 v16, 16, v155
v_and_b32 v17, 0xffff0000, v155
v_pk_add_f32 v[96:97], v[96:97], v[10:11]
v_pk_add_f32 v[98:99], v[98:99], v[12:13]
v_pk_add_f32 v[100:101], v[100:101], v[14:15]
v_pk_add_f32 v[102:103], v[102:103], v[16:17]
s_waitcnt vmcnt(8)
v_lshlrev_b32 v10, 16, v156
v_and_b32 v11, 0xffff0000, v156
v_lshlrev_b32 v12, 16, v157
v_and_b32 v13, 0xffff0000, v157
v_lshlrev_b32 v14, 16, v158
v_and_b32 v15, 0xffff0000, v158
v_lshlrev_b32 v16, 16, v159
v_and_b32 v17, 0xffff0000, v159
v_pk_add_f32 v[96:97], v[96:97], v[10:11]
v_pk_add_f32 v[98:99], v[98:99], v[12:13]
v_pk_add_f32 v[100:101], v[100:101], v[14:15]
v_pk_add_f32 v[102:103], v[102:103], v[16:17]
s_waitcnt vmcnt(7)
v_lshlrev_b32 v10, 16, v160
v_and_b32 v11, 0xffff0000, v160
v_lshlrev_b32 v12, 16, v161
v_and_b32 v13, 0xffff0000, v161
v_lshlrev_b32 v14, 16, v162
v_and_b32 v15, 0xffff0000, v162
v_lshlrev_b32 v16, 16, v163
v_and_b32 v17, 0xffff0000, v163
v_pk_add_f32 v[96:97], v[96:97], v[10:11]
v_pk_add_f32 v[98:99], v[98:99], v[12:13]
v_pk_add_f32 v[100:101], v[100:101], v[14:15]
v_pk_add_f32 v[102:103], v[102:103], v[16:17]
s_waitcnt vmcnt(6)
v_lshlrev_b32 v10, 16, v164
v_and_b32 v11, 0xffff0000, v164
v_lshlrev_b32 v12, 16, v165
v_and_b32 v13, 0xffff0000, v165
v_lshlrev_b32 v14, 16, v166
v_and_b32 v15, 0xffff0000, v166
v_lshlrev_b32 v16, 16, v167
v_and_b32 v17, 0xffff0000, v167
v_pk_add_f32 v[96:97], v[96:97], v[10:11]
v_pk_add_f32 v[98:99], v[98:99], v[12:13]
v_pk_add_f32 v[100:101], v[100:101], v[14:15]
v_pk_add_f32 v[102:103], v[102:103], v[16:17]
s_waitcnt vmcnt(5)
v_lshlrev_b32 v10, 16, v168
v_and_b32 v11, 0xffff0000, v168
v_lshlrev_b32 v12, 16, v169
v_and_b32 v13, 0xffff0000, v169
v_lshlrev_b32 v14, 16, v170
v_and_b32 v15, 0xffff0000, v170
v_lshlrev_b32 v16, 16, v171
v_and_b32 v17, 0xffff0000, v171
v_pk_add_f32 v[96:97], v[96:97], v[10:11]
v_pk_add_f32 v[98:99], v[98:99], v[12:13]
v_pk_add_f32 v[100:101], v[100:101], v[14:15]
v_pk_add_f32 v[102:103], v[102:103], v[16:17]
s_waitcnt vmcnt(4)
v_lshlrev_b32 v10, 16, v172
v_and_b32 v11, 0xffff0000, v172
v_lshlrev_b32 v12, 16, v173
v_and_b32 v13, 0xffff0000, v173
v_lshlrev_b32 v14, 16, v174
v_and_b32 v15, 0xffff0000, v174
v_lshlrev_b32 v16, 16, v175
v_and_b32 v17, 0xffff0000, v175
v_pk_add_f32 v[96:97], v[96:97], v[10:11]
v_pk_add_f32 v[98:99], v[98:99], v[12:13]
v_pk_add_f32 v[100:101], v[100:101], v[14:15]
v_pk_add_f32 v[102:103], v[102:103], v[16:17]
s_waitcnt vmcnt(3)
v_lshlrev_b32 v10, 16, v176
v_and_b32 v11, 0xffff0000, v176
v_lshlrev_b32 v12, 16, v177
v_and_b32 v13, 0xffff0000, v177
v_lshlrev_b32 v14, 16, v178
v_and_b32 v15, 0xffff0000, v178
v_lshlrev_b32 v16, 16, v179
v_and_b32 v17, 0xffff0000, v179
v_pk_add_f32 v[96:97], v[96:97], v[10:11]
v_pk_add_f32 v[98:99], v[98:99], v[12:13]
v_pk_add_f32 v[100:101], v[100:101], v[14:15]
v_pk_add_f32 v[102:103], v[102:103], v[16:17]
s_waitcnt vmcnt(2)
v_lshlrev_b32 v10, 16, v180
v_and_b32 v11, 0xffff0000, v180
v_lshlrev_b32 v12, 16, v181
v_and_b32 v13, 0xffff0000, v181
v_lshlrev_b32 v14, 16, v182
v_and_b32 v15, 0xffff0000, v182
v_lshlrev_b32 v16, 16, v183
v_and_b32 v17, 0xffff0000, v183
v_pk_add_f32 v[96:97], v[96:97], v[10:11]
v_pk_add_f32 v[98:99], v[98:99], v[12:13]
v_pk_add_f32 v[100:101], v[100:101], v[14:15]
v_pk_add_f32 v[102:103], v[102:103], v[16:17]
s_waitcnt vmcnt(1)
v_lshlrev_b32 v10, 16, v184
v_and_b32 v11, 0xffff0000, v184
v_lshlrev_b32 v12, 16, v185
v_and_b32 v13, 0xffff0000, v185
v_lshlrev_b32 v14, 16, v186
v_and_b32 v15, 0xffff0000, v186
v_lshlrev_b32 v16, 16, v187
v_and_b32 v17, 0xffff0000, v187
v_pk_add_f32 v[96:97], v[96:97], v[10:11]
v_pk_add_f32 v[98:99], v[98:99], v[12:13]
v_pk_add_f32 v[100:101], v[100:101], v[14:15]
v_pk_add_f32 v[102:103], v[102:103], v[16:17]
s_waitcnt vmcnt(0)
v_lshlrev_b32 v10, 16, v188
v_and_b32 v11, 0xffff0000, v188
v_lshlrev_b32 v12, 16, v189
v_and_b32 v13, 0xffff0000, v189
v_lshlrev_b32 v14, 16, v190
v_and_b32 v15, 0xffff0000, v190
v_lshlrev_b32 v16, 16, v191
v_and_b32 v17, 0xffff0000, v191
v_pk_add_f32 v[96:97], v[96:97], v[10:11]
v_pk_add_f32 v[98:99], v[98:99], v[12:13]
v_pk_add_f32 v[100:101], v[100:101], v[14:15]
v_pk_add_f32 v[102:103], v[102:103], v[16:17]
v_cvt_pk_bf16_f32 v96, v96, v97
v_cvt_pk_bf16_f32 v97, v98, v99
v_cvt_pk_bf16_f32 v98, v100, v101
v_cvt_pk_bf16_f32 v99, v102, v103
buffer_store_dwordx2 v[96:97], v21, s[40:43], s25 offen offset:896
buffer_store_dwordx2 v[98:99], v21, s[40:43], s25 offen offset:928
M_fin:
s_endpgm
PAD_19:
s_cbranch_execz M_tret
M_final:
s_mov_b32 s8, s64
s_mov_b32 s9, s65
s_mov_b32 s10, 1835008
s_mov_b32 s11, 0x20000
s_mov_b32 s12, s88
s_mov_b32 s13, s89
s_mov_b32 s14, 3670016
s_mov_b32 s15, 0x20000
s_lshr_b32 s24, s2, 0
s_and_b32 s24, s24, 16
s_add_u32 s24, s24, s20
v_lshrrev_b32 v20, 4, v1
v_and_b32 v21, 15, v20
v_lshrrev_b32 v22, 4, v20
v_mul_u32_u24 v2, 896, v21
v_lshlrev_b32 v9, 1, v2
v_lshl_add_u32 v2, v22, 4, v2
v_lshl_add_u32 v9, v22, 4, v9
s_lshl_b32 s22, s24, 2
s_add_u32 s22, s22, s3
s_mul_i32 s25, s22, 14336
s_lshl_b32 s26, s25, 1
v_lshlrev_b32 v10, 5, v22
v_add3_u32 v10, v10, v21, 16
v_lshlrev_b32 v10, 2, v10
v_min_u32 v11, 380, v10
v_add_u32 v11, 512, v11
s_mov_b32 s27, 94384128
Lfp:
buffer_load_dword v3, v10, s[4:7], s27 offen sc1
buffer_load_dword v4, v11, s[4:7], s27 offen sc1
s_waitcnt vmcnt(0)
v_and_b32 v3, v3, v4
v_cmp_gt_u32 vcc, 1, v3
s_cbranch_vccz Lfpd
s_sleep 2
s_sub_u32 s101, s101, 1
s_cbranch_scc0 Lfp
s_mov_b32 s101, 0
Lfpd:
s_barrier
buffer_store_dword v6, v5, s[4:7], s35 offen sc1
Lfg:
v_lshrrev_b32 v3, 3, v20
v_and_b32 v4, 7, v20
v_lshlrev_b32 v4, 4, v4
v_lshl_add_u32 v3, v3, 12, v4
s_mul_i32 s27, s3, 458752
s_lshl_b32 s22, s24, 7
s_add_u32 s27, s27, s22
s_add_u32 s27, s27, 88080384
s_mul_i32 s28, s3, 14336
s_add_u32 m0, s28, 0
s_nop 0
buffer_load_dwordx4 v3, s[4:7], s27 offen sc1 lds
s_add_u32 s27, s27, 32768
s_add_u32 m0, s28, 1024
s_nop 0
buffer_load_dwordx4 v3, s[4:7], s27 offen sc1 lds
s_add_u32 s27, s27, 32768
s_add_u32 m0, s28, 2048
s_nop 0
buffer_load_dwordx4 v3, s[4:7], s27 offen sc1 lds
s_add_u32 s27, s27, 32768
s_add_u32 m0, s28, 3072
s_nop 0
buffer_load_dwordx4 v3, s[4:7], s27 offen sc1 lds
s_add_u32 s27, s27, 32768
s_add_u32 m0, s28, 4096
s_nop 0
buffer_load_dwordx4 v3, s[4:7], s27 offen sc1 lds
s_add_u32 s27, s27, 32768
s_add_u32 m0, s28, 5120
s_nop 0
buffer_load_dwordx4 v3, s[4:7], s27 offen sc1 lds
s_add_u32 s27, s27, 32768
s_add_u32 m0, s28, 6144
s_nop 0
buffer_load_dwordx4 v3, s[4:7], s27 offen sc1 lds
s_add_u32 s27, s27, 32768
s_add_u32 m0, s28, 7168
s_nop 0
buffer_load_dwordx4 v3, s[4:7], s27 offen sc1 lds
s_add_u32 s27, s27, 32768
s_add_u32 m0, s28, 8192
s_nop 0
buffer_load_dwordx4 v3, s[4:7], s27 offen sc1 lds
s_add_u32 s27, s27, 32768
s_add_u32 m0, s28, 9216
s_nop 0
buffer_load_dwordx4 v3, s[4:7], s27 offen sc1 lds
s_add_u32 s27, s27, 32768
s_add_u32 m0, s28, 10240
s_nop 0
buffer_load_dwordx4 v3, s[4:7], s27 offen sc1 lds
s_add_u32 s27, s27, 32768
s_add_u32 m0, s28, 11264
s_nop 0
buffer_load_dwordx4 v3, s[4:7], s27 offen sc1 lds
s_add_u32 s27, s27, 32768
s_add_u32 m0, s28, 12288
s_nop 0
buffer_load_dwordx4 v3, s[4:7], s27 offen sc1 lds
s_add_u32 s27, s27, 32768
s_add_u32 m0, s28, 13312
s_nop 0
buffer_load_dwordx4 v3, s[4:7], s27 offen sc1 lds
s_add_u32 s27, s27, 32768
buffer_load_dwordx4 v[160:163], v2, s[8:11], s25 offen offset:0
buffer_load_dwordx4 v[164:167], v2, s[8:11], s25 offen offset:64
buffer_load_dwordx4 v[168:171], v2, s[8:11], s25 offen offset:128
buffer_load_dwordx4 v[172:175], v2, s[8:11], s25 offen offset:192
buffer_load_dwordx4 v[176:179], v2, s[8:11], s25 offen offset:256
buffer_load_dwordx4 v[180:183], v2, s[8:11], s25 offen offset:320
buffer_load_dwordx4 v[184:187], v2, s[8:11], s25 offen offset:384
buffer_load_dwordx4 v[188:191], v2, s[8:11], s25 offen offset:448
buffer_load_dwordx4 v[192:195], v2, s[8:11], s25 offen offset:512
buffer_load_dwordx4 v[196:199], v2, s[8:11], s25 offen offset:576
buffer_load_dwordx4 v[200:203], v2, s[8:11], s25 offen offset:640
buffer_load_dwordx4 v[204:207], v2, s[8:11], s25 offen offset:704
buffer_load_dwordx4 v[208:211], v2, s[8:11], s25 offen offset:768
buffer_load_dwordx4 v[212:215], v2, s[8:11], s25 offen offset:832
v_lshrrev_b32 v3, 2, v21
v_lshl_add_u32 v3, v22, 3, v3
v_lshlrev_b32 v3, 7, v3
v_and_b32 v4, 3, v20
v_lshl_add_u32 v3, v4, 3, v3
s_lshl_b32 s22, s3, 5
v_add_u32 v3, s22, v3
s_waitcnt vmcnt(14)
s_barrier
ds_read_b64_tr_b16 v[96:97], v3 offset:0
ds_read_b64_tr_b16 v[98:99], v3 offset:512
ds_read_b64_tr_b16 v[100:101], v3 offset:4096
ds_read_b64_tr_b16 v[102:103], v3 offset:4608
ds_read_b64_tr_b16 v[104:105], v3 offset:8192
ds_read_b64_tr_b16 v[106:107], v3 offset:8704
ds_read_b64_tr_b16 v[108:109], v3 offset:12288
ds_read_b64_tr_b16 v[110:111], v3 offset:12800
ds_read_b64_tr_b16 v[112:113], v3 offset:16384
ds_read_b64_tr_b16 v[114:115], v3 offset:16896
ds_read_b64_tr_b16 v[116:117], v3 offset:20480
ds_read_b64_tr_b16 v[118:119], v3 offset:20992
ds_read_b64_tr_b16 v[120:121], v3 offset:24576
ds_read_b64_tr_b16 v[122:123], v3 offset:25088
s_waitcnt lgkmcnt(0)
ds_read_b64_tr_b16 v[124:125], v3 offset:28672
ds_read_b64_tr_b16 v[126:127], v3 offset:29184
ds_read_b64_tr_b16 v[128:129], v3 offset:32768
ds_read_b64_tr_b16 v[130:131], v3 offset:33280
ds_read_b64_tr_b16 v[132:133], v3 offset:36864
ds_read_b64_tr_b16 v[134:135], v3 offset:37376
ds_read_b64_tr_b16 v[136:137], v3 offset:40960
ds_read_b64_tr_b16 v[138:139], v3 offset:41472
ds_read_b64_tr_b16 v[140:141], v3 offset:45056
ds_read_b64_tr_b16 v[142:143], v3 offset:45568
ds_read_b64_tr_b16 v[144:145], v3 offset:49152
ds_read_b64_tr_b16 v[146:147], v3 offset:49664
ds_read_b64_tr_b16 v[148:149], v3 offset:53248
ds_read_b64_tr_b16 v[150:151], v3 offset:53760
s_waitcnt vmcnt(13)
v_lshlrev_b32 v10, 16, v160
v_and_b32 v11, 0xffff0000, v160
v_lshlrev_b32 v12, 16, v96
v_and_b32 v13, 0xffff0000, v96
v_pk_mul_f32 v[10:11], v[10:11], v[12:13]
v_cvt_pk_bf16_f32 v160, v10, v11
v_lshlrev_b32 v10, 16, v161
v_and_b32 v11, 0xffff0000, v161
v_lshlrev_b32 v12, 16, v97
v_and_b32 v13, 0xffff0000, v97
v_pk_mul_f32 v[10:11], v[10:11], v[12:13]
v_cvt_pk_bf16_f32 v161, v10, v11
v_lshlrev_b32 v10, 16, v162
v_and_b32 v11, 0xffff0000, v162
PAD_20:
s_cbranch_execz M_tret
v_lshlrev_b32 v12, 16, v98
v_and_b32 v13, 0xffff0000, v98
v_pk_mul_f32 v[10:11], v[10:11], v[12:13]
v_cvt_pk_bf16_f32 v162, v10, v11
v_lshlrev_b32 v10, 16, v163
v_and_b32 v11, 0xffff0000, v163
v_lshlrev_b32 v12, 16, v99
v_and_b32 v13, 0xffff0000, v99
v_pk_mul_f32 v[10:11], v[10:11], v[12:13]
v_cvt_pk_bf16_f32 v163, v10, v11
buffer_store_dwordx4 v[160:163], v9, s[12:15], s26 offen offset:0
s_waitcnt vmcnt(13)
v_lshlrev_b32 v10, 16, v164
v_and_b32 v11, 0xffff0000, v164
v_lshlrev_b32 v12, 16, v100
v_and_b32 v13, 0xffff0000, v100
v_pk_mul_f32 v[10:11], v[10:11], v[12:13]
v_cvt_pk_bf16_f32 v164, v10, v11
v_lshlrev_b32 v10, 16, v165
v_and_b32 v11, 0xffff0000, v165
v_lshlrev_b32 v12, 16, v101
v_and_b32 v13, 0xffff0000, v101
v_pk_mul_f32 v[10:11], v[10:11], v[12:13]
v_cvt_pk_bf16_f32 v165, v10, v11
v_lshlrev_b32 v10, 16, v166
v_and_b32 v11, 0xffff0000, v166
v_lshlrev_b32 v12, 16, v102
v_and_b32 v13, 0xffff0000, v102
v_pk_mul_f32 v[10:11], v[10:11], v[12:13]
v_cvt_pk_bf16_f32 v166, v10, v11
v_lshlrev_b32 v10, 16, v167
v_and_b32 v11, 0xffff0000, v167
v_lshlrev_b32 v12, 16, v103
v_and_b32 v13, 0xffff0000, v103
v_pk_mul_f32 v[10:11], v[10:11], v[12:13]
v_cvt_pk_bf16_f32 v167, v10, v11
buffer_store_dwordx4 v[164:167], v9, s[12:15], s26 offen offset:64
s_waitcnt vmcnt(13)
v_lshlrev_b32 v10, 16, v168
v_and_b32 v11, 0xffff0000, v168
v_lshlrev_b32 v12, 16, v104
v_and_b32 v13, 0xffff0000, v104
v_pk_mul_f32 v[10:11], v[10:11], v[12:13]
v_cvt_pk_bf16_f32 v168, v10, v11
v_lshlrev_b32 v10, 16, v169
v_and_b32 v11, 0xffff0000, v169
v_lshlrev_b32 v12, 16, v105
v_and_b32 v13, 0xffff0000, v105
v_pk_mul_f32 v[10:11], v[10:11], v[12:13]
v_cvt_pk_bf16_f32 v169, v10, v11
v_lshlrev_b32 v10, 16, v170
v_and_b32 v11, 0xffff0000, v170
v_lshlrev_b32 v12, 16, v106
v_and_b32 v13, 0xffff0000, v106
v_pk_mul_f32 v[10:11], v[10:11], v[12:13]
v_cvt_pk_bf16_f32 v170, v10, v11
v_lshlrev_b32 v10, 16, v171
v_and_b32 v11, 0xffff0000, v171
v_lshlrev_b32 v12, 16, v107
v_and_b32 v13, 0xffff0000, v107
v_pk_mul_f32 v[10:11], v[10:11], v[12:13]
v_cvt_pk_bf16_f32 v171, v10, v11
buffer_store_dwordx4 v[168:171], v9, s[12:15], s26 offen offset:128
s_waitcnt vmcnt(13)
v_lshlrev_b32 v10, 16, v172
v_and_b32 v11, 0xffff0000, v172
v_lshlrev_b32 v12, 16, v108
v_and_b32 v13, 0xffff0000, v108
v_pk_mul_f32 v[10:11], v[10:11], v[12:13]
v_cvt_pk_bf16_f32 v172, v10, v11
v_lshlrev_b32 v10, 16, v173
v_and_b32 v11, 0xffff0000, v173
v_lshlrev_b32 v12, 16, v109
v_and_b32 v13, 0xffff0000, v109
v_pk_mul_f32 v[10:11], v[10:11], v[12:13]
v_cvt_pk_bf16_f32 v173, v10, v11
v_lshlrev_b32 v10, 16, v174
v_and_b32 v11, 0xffff0000, v174
v_lshlrev_b32 v12, 16, v110
v_and_b32 v13, 0xffff0000, v110
v_pk_mul_f32 v[10:11], v[10:11], v[12:13]
v_cvt_pk_bf16_f32 v174, v10, v11
v_lshlrev_b32 v10, 16, v175
v_and_b32 v11, 0xffff0000, v175
v_lshlrev_b32 v12, 16, v111
v_and_b32 v13, 0xffff0000, v111
v_pk_mul_f32 v[10:11], v[10:11], v[12:13]
v_cvt_pk_bf16_f32 v175, v10, v11
buffer_store_dwordx4 v[172:175], v9, s[12:15], s26 offen offset:192
s_waitcnt vmcnt(13)
v_lshlrev_b32 v10, 16, v176
v_and_b32 v11, 0xffff0000, v176
v_lshlrev_b32 v12, 16, v112
v_and_b32 v13, 0xffff0000, v112
v_pk_mul_f32 v[10:11], v[10:11], v[12:13]
v_cvt_pk_bf16_f32 v176, v10, v11
v_lshlrev_b32 v10, 16, v177
v_and_b32 v11, 0xffff0000, v177
v_lshlrev_b32 v12, 16, v113
v_and_b32 v13, 0xffff0000, v113
v_pk_mul_f32 v[10:11], v[10:11], v[12:13]
v_cvt_pk_bf16_f32 v177, v10, v11
v_lshlrev_b32 v10, 16, v178
v_and_b32 v11, 0xffff0000, v178
v_lshlrev_b32 v12, 16, v114
v_and_b32 v13, 0xffff0000, v114
v_pk_mul_f32 v[10:11], v[10:11], v[12:13]
v_cvt_pk_bf16_f32 v178, v10, v11
v_lshlrev_b32 v10, 16, v179
v_and_b32 v11, 0xffff0000, v179
v_lshlrev_b32 v12, 16, v115
v_and_b32 v13, 0xffff0000, v115
v_pk_mul_f32 v[10:11], v[10:11], v[12:13]
v_cvt_pk_bf16_f32 v179, v10, v11
buffer_store_dwordx4 v[176:179], v9, s[12:15], s26 offen offset:256
s_waitcnt vmcnt(13)
v_lshlrev_b32 v10, 16, v180
v_and_b32 v11, 0xffff0000, v180
v_lshlrev_b32 v12, 16, v116
v_and_b32 v13, 0xffff0000, v116
v_pk_mul_f32 v[10:11], v[10:11], v[12:13]
v_cvt_pk_bf16_f32 v180, v10, v11
v_lshlrev_b32 v10, 16, v181
v_and_b32 v11, 0xffff0000, v181
v_lshlrev_b32 v12, 16, v117
v_and_b32 v13, 0xffff0000, v117
v_pk_mul_f32 v[10:11], v[10:11], v[12:13]
v_cvt_pk_bf16_f32 v181, v10, v11
v_lshlrev_b32 v10, 16, v182
v_and_b32 v11, 0xffff0000, v182
v_lshlrev_b32 v12, 16, v118
v_and_b32 v13, 0xffff0000, v118
v_pk_mul_f32 v[10:11], v[10:11], v[12:13]
v_cvt_pk_bf16_f32 v182, v10, v11
v_lshlrev_b32 v10, 16, v183
v_and_b32 v11, 0xffff0000, v183
v_lshlrev_b32 v12, 16, v119
v_and_b32 v13, 0xffff0000, v119
v_pk_mul_f32 v[10:11], v[10:11], v[12:13]
v_cvt_pk_bf16_f32 v183, v10, v11
buffer_store_dwordx4 v[180:183], v9, s[12:15], s26 offen offset:320
s_waitcnt vmcnt(13)
v_lshlrev_b32 v10, 16, v184
v_and_b32 v11, 0xffff0000, v184
v_lshlrev_b32 v12, 16, v120
v_and_b32 v13, 0xffff0000, v120
v_pk_mul_f32 v[10:11], v[10:11], v[12:13]
v_cvt_pk_bf16_f32 v184, v10, v11
v_lshlrev_b32 v10, 16, v185
v_and_b32 v11, 0xffff0000, v185
v_lshlrev_b32 v12, 16, v121
v_and_b32 v13, 0xffff0000, v121
v_pk_mul_f32 v[10:11], v[10:11], v[12:13]
v_cvt_pk_bf16_f32 v185, v10, v11
v_lshlrev_b32 v10, 16, v186
v_and_b32 v11, 0xffff0000, v186
v_lshlrev_b32 v12, 16, v122
v_and_b32 v13, 0xffff0000, v122
v_pk_mul_f32 v[10:11], v[10:11], v[12:13]
v_cvt_pk_bf16_f32 v186, v10, v11
v_lshlrev_b32 v10, 16, v187
v_and_b32 v11, 0xffff0000, v187
v_lshlrev_b32 v12, 16, v123
v_and_b32 v13, 0xffff0000, v123
v_pk_mul_f32 v[10:11], v[10:11], v[12:13]
v_cvt_pk_bf16_f32 v187, v10, v11
buffer_store_dwordx4 v[184:187], v9, s[12:15], s26 offen offset:384
s_waitcnt lgkmcnt(0)
s_waitcnt vmcnt(13)
v_lshlrev_b32 v10, 16, v188
v_and_b32 v11, 0xffff0000, v188
v_lshlrev_b32 v12, 16, v124
v_and_b32 v13, 0xffff0000, v124
v_pk_mul_f32 v[10:11], v[10:11], v[12:13]
v_cvt_pk_bf16_f32 v188, v10, v11
v_lshlrev_b32 v10, 16, v189
v_and_b32 v11, 0xffff0000, v189
v_lshlrev_b32 v12, 16, v125
v_and_b32 v13, 0xffff0000, v125
v_pk_mul_f32 v[10:11], v[10:11], v[12:13]
v_cvt_pk_bf16_f32 v189, v10, v11
v_lshlrev_b32 v10, 16, v190
v_and_b32 v11, 0xffff0000, v190
v_lshlrev_b32 v12, 16, v126
v_and_b32 v13, 0xffff0000, v126
v_pk_mul_f32 v[10:11], v[10:11], v[12:13]
v_cvt_pk_bf16_f32 v190, v10, v11
v_lshlrev_b32 v10, 16, v191
v_and_b32 v11, 0xffff0000, v191
v_lshlrev_b32 v12, 16, v127
v_and_b32 v13, 0xffff0000, v127
v_pk_mul_f32 v[10:11], v[10:11], v[12:13]
v_cvt_pk_bf16_f32 v191, v10, v11
buffer_store_dwordx4 v[188:191], v9, s[12:15], s26 offen offset:448
s_waitcnt vmcnt(13)
v_lshlrev_b32 v10, 16, v192
v_and_b32 v11, 0xffff0000, v192
v_lshlrev_b32 v12, 16, v128
v_and_b32 v13, 0xffff0000, v128
v_pk_mul_f32 v[10:11], v[10:11], v[12:13]
v_cvt_pk_bf16_f32 v192, v10, v11
v_lshlrev_b32 v10, 16, v193
v_and_b32 v11, 0xffff0000, v193
v_lshlrev_b32 v12, 16, v129
v_and_b32 v13, 0xffff0000, v129
v_pk_mul_f32 v[10:11], v[10:11], v[12:13]
v_cvt_pk_bf16_f32 v193, v10, v11
v_lshlrev_b32 v10, 16, v194
v_and_b32 v11, 0xffff0000, v194
v_lshlrev_b32 v12, 16, v130
v_and_b32 v13, 0xffff0000, v130
v_pk_mul_f32 v[10:11], v[10:11], v[12:13]
v_cvt_pk_bf16_f32 v194, v10, v11
v_lshlrev_b32 v10, 16, v195
v_and_b32 v11, 0xffff0000, v195
v_lshlrev_b32 v12, 16, v131
v_and_b32 v13, 0xffff0000, v131
v_pk_mul_f32 v[10:11], v[10:11], v[12:13]
v_cvt_pk_bf16_f32 v195, v10, v11
buffer_store_dwordx4 v[192:195], v9, s[12:15], s26 offen offset:512
s_waitcnt vmcnt(13)
v_lshlrev_b32 v10, 16, v196
v_and_b32 v11, 0xffff0000, v196
v_lshlrev_b32 v12, 16, v132
v_and_b32 v13, 0xffff0000, v132
v_pk_mul_f32 v[10:11], v[10:11], v[12:13]
v_cvt_pk_bf16_f32 v196, v10, v11
v_lshlrev_b32 v10, 16, v197
v_and_b32 v11, 0xffff0000, v197
v_lshlrev_b32 v12, 16, v133
v_and_b32 v13, 0xffff0000, v133
v_pk_mul_f32 v[10:11], v[10:11], v[12:13]
v_cvt_pk_bf16_f32 v197, v10, v11
v_lshlrev_b32 v10, 16, v198
v_and_b32 v11, 0xffff0000, v198
v_lshlrev_b32 v12, 16, v134
v_and_b32 v13, 0xffff0000, v134
v_pk_mul_f32 v[10:11], v[10:11], v[12:13]
v_cvt_pk_bf16_f32 v198, v10, v11
v_lshlrev_b32 v10, 16, v199
v_and_b32 v11, 0xffff0000, v199
v_lshlrev_b32 v12, 16, v135
v_and_b32 v13, 0xffff0000, v135
v_pk_mul_f32 v[10:11], v[10:11], v[12:13]
v_cvt_pk_bf16_f32 v199, v10, v11
buffer_store_dwordx4 v[196:199], v9, s[12:15], s26 offen offset:576
s_waitcnt vmcnt(13)
v_lshlrev_b32 v10, 16, v200
v_and_b32 v11, 0xffff0000, v200
v_lshlrev_b32 v12, 16, v136
v_and_b32 v13, 0xffff0000, v136
v_pk_mul_f32 v[10:11], v[10:11], v[12:13]
v_cvt_pk_bf16_f32 v200, v10, v11
v_lshlrev_b32 v10, 16, v201
v_and_b32 v11, 0xffff0000, v201
v_lshlrev_b32 v12, 16, v137
v_and_b32 v13, 0xffff0000, v137
v_pk_mul_f32 v[10:11], v[10:11], v[12:13]
v_cvt_pk_bf16_f32 v201, v10, v11
v_lshlrev_b32 v10, 16, v202
v_and_b32 v11, 0xffff0000, v202
v_lshlrev_b32 v12, 16, v138
v_and_b32 v13, 0xffff0000, v138
v_pk_mul_f32 v[10:11], v[10:11], v[12:13]
v_cvt_pk_bf16_f32 v202, v10, v11
v_lshlrev_b32 v10, 16, v203
v_and_b32 v11, 0xffff0000, v203
v_lshlrev_b32 v12, 16, v139
v_and_b32 v13, 0xffff0000, v139
v_pk_mul_f32 v[10:11], v[10:11], v[12:13]
v_cvt_pk_bf16_f32 v203, v10, v11
buffer_store_dwordx4 v[200:203], v9, s[12:15], s26 offen offset:640
s_waitcnt vmcnt(13)
v_lshlrev_b32 v10, 16, v204
v_and_b32 v11, 0xffff0000, v204
v_lshlrev_b32 v12, 16, v140
v_and_b32 v13, 0xffff0000, v140
v_pk_mul_f32 v[10:11], v[10:11], v[12:13]
v_cvt_pk_bf16_f32 v204, v10, v11
v_lshlrev_b32 v10, 16, v205
v_and_b32 v11, 0xffff0000, v205
v_lshlrev_b32 v12, 16, v141
v_and_b32 v13, 0xffff0000, v141
v_pk_mul_f32 v[10:11], v[10:11], v[12:13]
v_cvt_pk_bf16_f32 v205, v10, v11
v_lshlrev_b32 v10, 16, v206
v_and_b32 v11, 0xffff0000, v206
v_lshlrev_b32 v12, 16, v142
v_and_b32 v13, 0xffff0000, v142
v_pk_mul_f32 v[10:11], v[10:11], v[12:13]
v_cvt_pk_bf16_f32 v206, v10, v11
v_lshlrev_b32 v10, 16, v207
v_and_b32 v11, 0xffff0000, v207
v_lshlrev_b32 v12, 16, v143
v_and_b32 v13, 0xffff0000, v143
v_pk_mul_f32 v[10:11], v[10:11], v[12:13]
v_cvt_pk_bf16_f32 v207, v10, v11
buffer_store_dwordx4 v[204:207], v9, s[12:15], s26 offen offset:704
s_waitcnt vmcnt(13)
v_lshlrev_b32 v10, 16, v208
v_and_b32 v11, 0xffff0000, v208
v_lshlrev_b32 v12, 16, v144
v_and_b32 v13, 0xffff0000, v144
v_pk_mul_f32 v[10:11], v[10:11], v[12:13]
v_cvt_pk_bf16_f32 v208, v10, v11
v_lshlrev_b32 v10, 16, v209
v_and_b32 v11, 0xffff0000, v209
v_lshlrev_b32 v12, 16, v145
v_and_b32 v13, 0xffff0000, v145
v_pk_mul_f32 v[10:11], v[10:11], v[12:13]
v_cvt_pk_bf16_f32 v209, v10, v11
v_lshlrev_b32 v10, 16, v210
v_and_b32 v11, 0xffff0000, v210
v_lshlrev_b32 v12, 16, v146
v_and_b32 v13, 0xffff0000, v146
v_pk_mul_f32 v[10:11], v[10:11], v[12:13]
v_cvt_pk_bf16_f32 v210, v10, v11
v_lshlrev_b32 v10, 16, v211
v_and_b32 v11, 0xffff0000, v211
v_lshlrev_b32 v12, 16, v147
v_and_b32 v13, 0xffff0000, v147
v_pk_mul_f32 v[10:11], v[10:11], v[12:13]
v_cvt_pk_bf16_f32 v211, v10, v11
buffer_store_dwordx4 v[208:211], v9, s[12:15], s26 offen offset:768
s_waitcnt vmcnt(13)
v_lshlrev_b32 v10, 16, v212
v_and_b32 v11, 0xffff0000, v212
v_lshlrev_b32 v12, 16, v148
v_and_b32 v13, 0xffff0000, v148
v_pk_mul_f32 v[10:11], v[10:11], v[12:13]
v_cvt_pk_bf16_f32 v212, v10, v11
v_lshlrev_b32 v10, 16, v213
v_and_b32 v11, 0xffff0000, v213
v_lshlrev_b32 v12, 16, v149
v_and_b32 v13, 0xffff0000, v149
v_pk_mul_f32 v[10:11], v[10:11], v[12:13]
v_cvt_pk_bf16_f32 v213, v10, v11
v_lshlrev_b32 v10, 16, v214
v_and_b32 v11, 0xffff0000, v214
v_lshlrev_b32 v12, 16, v150
v_and_b32 v13, 0xffff0000, v150
v_pk_mul_f32 v[10:11], v[10:11], v[12:13]
v_cvt_pk_bf16_f32 v214, v10, v11
v_lshlrev_b32 v10, 16, v215
v_and_b32 v11, 0xffff0000, v215
v_lshlrev_b32 v12, 16, v151
v_and_b32 v13, 0xffff0000, v151
v_pk_mul_f32 v[10:11], v[10:11], v[12:13]
v_cvt_pk_bf16_f32 v215, v10, v11
buffer_store_dwordx4 v[212:215], v9, s[12:15], s26 offen offset:832
s_branch M_fin
M_fend:
M_rslow:
Lp_9251:
buffer_load_dword v18, v19, s[4:7], s33 offen offset:0 sc1
s_waitcnt vmcnt(0)
v_cmp_gt_u32 vcc, 1, v18
s_cbranch_vccz Lpd_9252
s_sleep 8
s_sub_u32 s101, s101, 1
s_cbranch_scc0 Lp_9251
s_mov_b32 s101, 0
Lpd_9252:
s_branch M_rjoin
M_V:
PAD_21:
s_cbranch_execz PAD_25
v_mfma_f32_16x16x32_bf16 v[32:35], a[0:3], a[128:131], 0
s_add_u32 m0, s29, 98304
ds_read_b64_tr_b16 a[136:137], v5 offset:0
v_mfma_f32_16x16x32_bf16 v[32:35], a[4:7], a[132:135], v[32:35]
s_mov_b32 s32, 1024
buffer_load_dwordx4 v16, s[12:15], s26 offen offset:0 lds
v_mfma_f32_16x16x32_bf16 v[36:39], a[8:11], a[128:131], 0
s_mov_b32 s33, 31744
ds_read_b64_tr_b16 a[138:139], v5 offset:2048
v_mfma_f32_16x16x32_bf16 v[36:39], a[12:15], a[132:135], v[36:39]
s_mov_b32 s34, 4294935552
v_mfma_f32_16x16x32_bf16 v[40:43], a[16:19], a[128:131], 0
s_mov_b32 s35, 4294935552
ds_read_b64_tr_b16 a[140:141], v5 offset:16384
v_mfma_f32_16x16x32_bf16 v[40:43], a[20:23], a[132:135], v[40:43]
s_mov_b32 s36, 4294935552
buffer_load_dwordx4 v17, s[12:15], s26 offen offset:1024 lds
v_mfma_f32_16x16x32_bf16 v[44:47], a[24:27], a[128:131], 0
s_mov_b32 s30, 8
ds_read_b64_tr_b16 a[142:143], v5 offset:18432
v_mfma_f32_16x16x32_bf16 v[44:47], a[28:31], a[132:135], v[44:47]
s_mov_b32 s82, 3221225472
v_mfma_f32_16x16x32_bf16 v[48:51], a[32:35], a[128:131], 0
s_mul_hi_u32 s38, s2, 613566757
v_mfma_f32_16x16x32_bf16 v[48:51], a[36:39], a[132:135], v[48:51]
s_mul_i32 s39, s38, 7
buffer_load_dwordx4 v18, s[12:15], s26 offen offset:2048 lds
v_mfma_f32_16x16x32_bf16 v[52:55], a[40:43], a[128:131], 0
s_sub_u32 s39, s2, s39
v_mov_b32 v246, 0
v_mov_b32 v229, 0
v_mfma_f32_16x16x32_bf16 v[52:55], a[44:47], a[132:135], v[52:55]
v_mov_b32 v231, 0
v_mfma_f32_16x16x32_bf16 v[56:59], a[48:51], a[128:131], 0
s_mov_b32 s60, s90
v_mfma_f32_16x16x32_bf16 v[56:59], a[52:55], a[132:135], v[56:59]
s_mov_b32 s61, s91
buffer_load_dwordx4 v19, s[12:15], s26 offen offset:3072 lds
v_mfma_f32_16x16x32_bf16 v[60:63], a[56:59], a[128:131], 0
s_add_u32 s26, s26, 524288
v_mfma_f32_16x16x32_bf16 v[60:63], a[60:63], a[132:135], v[60:63]
s_waitcnt lgkmcnt(0)
s_mov_b32 s62, 256
v_mfma_f32_16x16x32_bf16 v[64:67], a[0:3], a[136:139], 0
s_add_u32 m0, s29, 114688
ds_read_b64_tr_b16 a[128:129], v6 offset:0
v_mfma_f32_16x16x32_bf16 v[64:67], a[4:7], a[140:143], v[64:67]
s_mov_b32 s63, 0x20000
buffer_load_dwordx4 v16, s[12:15], s27 offen offset:0 lds
v_mfma_f32_16x16x32_bf16 v[68:71], a[8:11], a[136:139], 0
s_mul_hi_u32 s55, s2, 1431655766
ds_read_b64_tr_b16 a[130:131], v6 offset:2048
v_mfma_f32_16x16x32_bf16 v[68:71], a[12:15], a[140:143], v[68:71]
s_mul_i32 s55, s55, 3
v_mfma_f32_16x16x32_bf16 v[72:75], a[16:19], a[136:139], 0
s_sub_u32 s55, s2, s55
ds_read_b64_tr_b16 a[132:133], v6 offset:16384
v_mfma_f32_16x16x32_bf16 v[72:75], a[20:23], a[140:143], v[72:75]
s_add_u32 s55, s55, 5
buffer_load_dwordx4 v17, s[12:15], s27 offen offset:1024 lds
v_mfma_f32_16x16x32_bf16 v[76:79], a[24:27], a[136:139], 0
s_lshr_b32 s22, s2, 4
ds_read_b64_tr_b16 a[134:135], v6 offset:18432
v_mfma_f32_16x16x32_bf16 v[76:79], a[28:31], a[140:143], v[76:79]
s_lshl_b32 s23, s20, 5
v_mfma_f32_16x16x32_bf16 v[80:83], a[32:35], a[136:139], 0
s_add_u32 s23, s23, s22
v_mfma_f32_16x16x32_bf16 v[80:83], a[36:39], a[140:143], v[80:83]
s_lshl_b32 s23, s23, 2
buffer_load_dwordx4 v18, s[12:15], s27 offen offset:2048 lds
v_mfma_f32_16x16x32_bf16 v[84:87], a[40:43], a[136:139], 0
s_and_b32 s22, s2, 16
v_mfma_f32_16x16x32_bf16 v[84:87], a[44:47], a[140:143], v[84:87]
s_lshl_b32 s22, s22, 7
v_mfma_f32_16x16x32_bf16 v[88:91], a[48:51], a[136:139], 0
s_add_u32 s23, s23, s22
v_mov_b32 v28, 3221225472
v_writelane_b32 v28, s23, 0
v_mfma_f32_16x16x32_bf16 v[88:91], a[52:55], a[140:143], v[88:91]
s_add_u32 s56, s23, 16384
buffer_load_dwordx4 v19, s[12:15], s27 offen offset:3072 lds
v_mfma_f32_16x16x32_bf16 v[92:95], a[56:59], a[136:139], 0
s_add_u32 s27, s27, 524288
v_writelane_b32 v28, s56, 1
v_mfma_f32_16x16x32_bf16 v[92:95], a[60:63], a[140:143], v[92:95]
s_waitcnt lgkmcnt(0)
s_add_u32 s56, s23, 4096
v_writelane_b32 v28, s56, 2
v_mfma_f32_16x16x32_bf16 v[96:99], a[0:3], a[128:131], 0
s_add_u32 m0, s28, 0
ds_read_b64_tr_b16 a[136:137], v7 offset:0
v_mfma_f32_16x16x32_bf16 v[96:99], a[4:7], a[132:135], v[96:99]
s_sub_u32 s37, 15, s21
buffer_load_dwordx4 v12, s[8:11], s24 offen offset:0 lds
v_mfma_f32_16x16x32_bf16 v[100:103], a[8:11], a[128:131], 0
ds_read_b64_tr_b16 a[138:139], v7 offset:2048
v_mfma_f32_16x16x32_bf16 v[100:103], a[12:15], a[132:135], v[100:103]
v_mfma_f32_16x16x32_bf16 v[104:107], a[16:19], a[128:131], 0
ds_read_b64_tr_b16 a[140:141], v7 offset:16384
v_mfma_f32_16x16x32_bf16 v[104:107], a[20:23], a[132:135], v[104:107]
buffer_load_dwordx4 v13, s[8:11], s24 offen offset:1024 lds
v_mfma_f32_16x16x32_bf16 v[108:111], a[24:27], a[128:131], 0
ds_read_b64_tr_b16 a[142:143], v7 offset:18432
v_mfma_f32_16x16x32_bf16 v[108:111], a[28:31], a[132:135], v[108:111]
v_mfma_f32_16x16x32_bf16 v[112:115], a[32:35], a[128:131], 0
v_mfma_f32_16x16x32_bf16 v[112:115], a[36:39], a[132:135], v[112:115]
buffer_load_dwordx4 v14, s[8:11], s24 offen offset:2048 lds
v_mfma_f32_16x16x32_bf16 v[116:119], a[40:43], a[128:131], 0
v_mfma_f32_16x16x32_bf16 v[116:119], a[44:47], a[132:135], v[116:119]
v_mfma_f32_16x16x32_bf16 v[120:123], a[48:51], a[128:131], 0
v_mfma_f32_16x16x32_bf16 v[120:123], a[52:55], a[132:135], v[120:123]
buffer_load_dwordx4 v15, s[8:11], s24 offen offset:3072 lds
v_mfma_f32_16x16x32_bf16 v[124:127], a[56:59], a[128:131], 0
s_add_u32 s24, s24, 128
v_mfma_f32_16x16x32_bf16 v[124:127], a[60:63], a[132:135], v[124:127]
s_waitcnt vmcnt(13) lgkmcnt(0)
s_barrier
v_mfma_f32_16x16x32_bf16 v[128:131], a[0:3], a[136:139], 0
s_add_u32 m0, s28, 4096
ds_read_b64_tr_b16 a[128:129], v8 offset:0
v_mfma_f32_16x16x32_bf16 v[128:131], a[4:7], a[140:143], v[128:131]
buffer_load_dwordx4 v12, s[8:11], s25 offen offset:0 lds
v_mfma_f32_16x16x32_bf16 v[132:135], a[8:11], a[136:139], 0
ds_read_b64_tr_b16 a[130:131], v8 offset:2048
v_mfma_f32_16x16x32_bf16 v[132:135], a[12:15], a[140:143], v[132:135]
v_mfma_f32_16x16x32_bf16 v[136:139], a[16:19], a[136:139], 0
ds_read_b64_tr_b16 a[132:133], v8 offset:16384
v_mfma_f32_16x16x32_bf16 v[136:139], a[20:23], a[140:143], v[136:139]
buffer_load_dwordx4 v13, s[8:11], s25 offen offset:1024 lds
v_mfma_f32_16x16x32_bf16 v[140:143], a[24:27], a[136:139], 0
ds_read_b64_tr_b16 a[134:135], v8 offset:18432
v_mfma_f32_16x16x32_bf16 v[140:143], a[28:31], a[140:143], v[140:143]
v_mfma_f32_16x16x32_bf16 v[144:147], a[32:35], a[136:139], 0
ds_read_b128 a[64:67], v2 offset:32768
v_mfma_f32_16x16x32_bf16 v[144:147], a[36:39], a[140:143], v[144:147]
buffer_load_dwordx4 v14, s[8:11], s25 offen offset:2048 lds
v_mfma_f32_16x16x32_bf16 v[148:151], a[40:43], a[136:139], 0
ds_read_b128 a[68:71], v3 offset:32768
v_mfma_f32_16x16x32_bf16 v[148:151], a[44:47], a[140:143], v[148:151]
ds_read_b128 a[72:75], v2 offset:34816
v_mfma_f32_16x16x32_bf16 v[152:155], a[48:51], a[136:139], 0
ds_read_b128 a[76:79], v3 offset:34816
v_mfma_f32_16x16x32_bf16 v[152:155], a[52:55], a[140:143], v[152:155]
buffer_load_dwordx4 v15, s[8:11], s25 offen offset:3072 lds
v_mfma_f32_16x16x32_bf16 v[156:159], a[56:59], a[136:139], 0
s_add_u32 s25, s25, 128
ds_read_b128 a[80:83], v2 offset:36864
v_mfma_f32_16x16x32_bf16 v[156:159], a[60:63], a[140:143], v[156:159]
s_waitcnt lgkmcnt(5)
ds_read_b128 a[84:87], v3 offset:36864
v_mfma_f32_16x16x32_bf16 v[160:163], a[0:3], a[128:131], 0
ds_read_b64_tr_b16 a[136:137], v9 offset:0
v_mfma_f32_16x16x32_bf16 v[160:163], a[4:7], a[132:135], v[160:163]
buffer_load_dword v21, v20, s[16:19], s43 offen
v_mfma_f32_16x16x32_bf16 v[164:167], a[8:11], a[128:131], 0
s_add_u32 s43, s43, s47
ds_read_b64_tr_b16 a[138:139], v9 offset:2048
v_mfma_f32_16x16x32_bf16 v[164:167], a[12:15], a[132:135], v[164:167]
s_cmp_ge_u32 s43, s51
v_mfma_f32_16x16x32_bf16 v[168:171], a[16:19], a[128:131], 0
s_cselect_b32 s43, 0, s43
ds_read_b64_tr_b16 a[140:141], v9 offset:16384
v_mfma_f32_16x16x32_bf16 v[168:171], a[20:23], a[132:135], v[168:171]
s_cselect_b32 s51, s42, s51
v_mfma_f32_16x16x32_bf16 v[172:175], a[24:27], a[128:131], 0
s_cselect_b64 s[16:17], s[40:41], s[16:17]
ds_read_b64_tr_b16 a[142:143], v9 offset:18432
v_mfma_f32_16x16x32_bf16 v[172:175], a[28:31], a[132:135], v[172:175]
s_cselect_b32 s18, s42, s18
v_mfma_f32_16x16x32_bf16 v[176:179], a[32:35], a[128:131], 0
s_cselect_b64 s[40:41], s[44:45], s[40:41]
v_mfma_f32_16x16x32_bf16 v[176:179], a[36:39], a[132:135], v[176:179]
s_cselect_b32 s42, s46, s42
v_mfma_f32_16x16x32_bf16 v[180:183], a[40:43], a[128:131], 0
s_waitcnt lgkmcnt(2)
s_cselect_b32 s46, 0, s46
ds_read_b128 a[88:91], v2 offset:38912
v_mfma_f32_16x16x32_bf16 v[180:183], a[44:47], a[132:135], v[180:183]
s_bitcmp1_b32 s2, 4
s_cselect_b32 s37, s21, s37
ds_read_b128 a[92:95], v3 offset:38912
v_mfma_f32_16x16x32_bf16 v[184:187], a[48:51], a[128:131], 0
s_lshl_b32 s56, s37, 5
s_add_u32 s56, s56, s20
ds_read_b128 a[96:99], v2 offset:40960
v_mfma_f32_16x16x32_bf16 v[184:187], a[52:55], a[132:135], v[184:187]
s_lshl_b32 s56, s56, 2
s_add_u32 s56, s56, 8192
v_writelane_b32 v28, s56, 3
v_mfma_f32_16x16x32_bf16 v[188:191], a[56:59], a[128:131], 0
s_add_u32 s56, s56, 2048
ds_read_b128 a[100:103], v3 offset:40960
v_writelane_b32 v28, s56, 6
v_mfma_f32_16x16x32_bf16 v[188:191], a[60:63], a[132:135], v[188:191]
s_add_u32 s56, s56, 4096
ds_read_b128 a[104:107], v2 offset:43008
v_writelane_b32 v28, s56, 5
v_mfma_f32_16x16x32_bf16 v[192:195], a[0:3], a[136:139], 0
s_waitcnt lgkmcnt(5)
s_lshl_b32 s56, s2, 2
s_add_u32 s56, s56, 12288
ds_read_b64_tr_b16 a[128:129], v10 offset:0
v_mfma_f32_16x16x32_bf16 v[192:195], a[4:7], a[140:143], v[192:195]
v_writelane_b32 v28, s56, 4
v_mfma_f32_16x16x32_bf16 v[196:199], a[8:11], a[136:139], 0
s_lshl_b32 s56, s39, 5
s_add_u32 s56, s56, s38
ds_read_b64_tr_b16 a[130:131], v10 offset:2048
v_mfma_f32_16x16x32_bf16 v[196:199], a[12:15], a[140:143], v[196:199]
s_lshl_b32 s56, s56, 2
s_add_u32 s56, s56, 20480
s_cmp_lt_u32 s2, 224
v_mfma_f32_16x16x32_bf16 v[200:203], a[16:19], a[136:139], 0
s_cselect_b32 s56, s56, 3221225472
ds_read_b64_tr_b16 a[132:133], v10 offset:16384
v_writelane_b32 v28, s56, 7
v_mfma_f32_16x16x32_bf16 v[200:203], a[20:23], a[140:143], v[200:203]
s_cmp_eq_u32 s3, 0
s_cselect_b32 s56, 94371840, 3221225472
v_mfma_f32_16x16x32_bf16 v[204:207], a[24:27], a[136:139], 0
ds_read_b64_tr_b16 a[134:135], v10 offset:18432
v_mfma_f32_16x16x32_bf16 v[204:207], a[28:31], a[140:143], v[204:207]
buffer_store_dword v246, v28, s[4:7], s56 offen sc1
v_mfma_f32_16x16x32_bf16 v[208:211], a[32:35], a[136:139], 0
v_mov_b32 v27, 1
v_cmp_eq_u32 vcc, 0, v0
v_mfma_f32_16x16x32_bf16 v[208:211], a[36:39], a[140:143], v[208:211]
v_mov_b32 v26, 3221225472
v_mfma_f32_16x16x32_bf16 v[212:215], a[40:43], a[136:139], 0
s_lshl_b32 s31, s20, 20
s_lshl_b32 s22, s21, 17
ds_read_b128 a[108:111], v3 offset:43008
v_mfma_f32_16x16x32_bf16 v[212:215], a[44:47], a[140:143], v[212:215]
ds_read_b128 a[112:115], v2 offset:45056
v_cndmask_b32 v26, v26, v246, vcc
v_mfma_f32_16x16x32_bf16 v[216:219], a[48:51], a[136:139], 0
s_add_u32 s31, s31, s22
s_lshr_b32 s22, s3, 1
ds_read_b128 a[116:119], v3 offset:45056
v_mfma_f32_16x16x32_bf16 v[216:219], a[52:55], a[140:143], v[216:219]
s_lshl_b32 s22, s22, 16
s_add_u32 s31, s31, s22
s_and_b32 s22, s3, 1
v_mfma_f32_16x16x32_bf16 v[220:223], a[56:59], a[136:139], 0
s_lshl_b32 s22, s22, 14
s_add_u32 s31, s31, s22
ds_read_b128 a[120:123], v2 offset:47104
v_mfma_f32_16x16x32_bf16 v[220:223], a[60:63], a[140:143], v[220:223]
s_waitcnt lgkmcnt(4)
s_add_u32 s31, s31, 16777216
ds_read_b128 a[124:127], v3 offset:47104
v_mfma_f32_16x16x32_bf16 a[192:195], a[0:3], a[128:131], 0
ds_read_b64_tr_b16 a[136:137], v11 offset:0
v_mfma_f32_16x16x32_bf16 a[192:195], a[4:7], a[132:135], a[192:195]
PAD_22:
s_cbranch_execz PAD_26
v_mfma_f32_16x16x32_bf16 a[196:199], a[8:11], a[128:131], 0
ds_read_b64_tr_b16 a[138:139], v11 offset:2048
v_mfma_f32_16x16x32_bf16 a[196:199], a[12:15], a[132:135], a[196:199]
v_mfma_f32_16x16x32_bf16 a[200:203], a[16:19], a[128:131], 0
ds_read_b64_tr_b16 a[140:141], v11 offset:16384
v_mfma_f32_16x16x32_bf16 a[200:203], a[20:23], a[132:135], a[200:203]
v_mfma_f32_16x16x32_bf16 a[204:207], a[24:27], a[128:131], 0
ds_read_b64_tr_b16 a[142:143], v11 offset:18432
v_mfma_f32_16x16x32_bf16 a[204:207], a[28:31], a[132:135], a[204:207]
v_mfma_f32_16x16x32_bf16 a[208:211], a[32:35], a[128:131], 0
v_mfma_f32_16x16x32_bf16 a[208:211], a[36:39], a[132:135], a[208:211]
v_mfma_f32_16x16x32_bf16 a[212:215], a[40:43], a[128:131], 0
v_mfma_f32_16x16x32_bf16 a[212:215], a[44:47], a[132:135], a[212:215]
v_mfma_f32_16x16x32_bf16 a[216:219], a[48:51], a[128:131], 0
v_mfma_f32_16x16x32_bf16 a[216:219], a[52:55], a[132:135], a[216:219]
v_mfma_f32_16x16x32_bf16 a[220:223], a[56:59], a[128:131], 0
s_waitcnt vmcnt(2) lgkmcnt(0)
v_mfma_f32_16x16x32_bf16 a[220:223], a[60:63], a[132:135], a[220:223]
s_barrier
v_mfma_f32_16x16x32_bf16 a[224:227], a[0:3], a[136:139], 0
s_add_u32 m0, s29, 65536
ds_read_b64_tr_b16 a[128:129], v4 offset:32768
v_mfma_f32_16x16x32_bf16 a[224:227], a[4:7], a[140:143], a[224:227]
buffer_load_dwordx4 v16, s[12:15], s26 offen offset:0 lds
v_mfma_f32_16x16x32_bf16 a[228:231], a[8:11], a[136:139], 0
ds_read_b64_tr_b16 a[130:131], v4 offset:34816
v_mfma_f32_16x16x32_bf16 a[228:231], a[12:15], a[140:143], a[228:231]
v_mfma_f32_16x16x32_bf16 a[232:235], a[16:19], a[136:139], 0
ds_read_b64_tr_b16 a[132:133], v4 offset:49152
v_mfma_f32_16x16x32_bf16 a[232:235], a[20:23], a[140:143], a[232:235]
buffer_load_dwordx4 v17, s[12:15], s26 offen offset:1024 lds
v_mfma_f32_16x16x32_bf16 a[236:239], a[24:27], a[136:139], 0
ds_read_b64_tr_b16 a[134:135], v4 offset:51200
v_mfma_f32_16x16x32_bf16 a[236:239], a[28:31], a[140:143], a[236:239]
v_mfma_f32_16x16x32_bf16 a[240:243], a[32:35], a[136:139], 0
v_mfma_f32_16x16x32_bf16 a[240:243], a[36:39], a[140:143], a[240:243]
buffer_load_dwordx4 v18, s[12:15], s26 offen offset:2048 lds
v_mfma_f32_16x16x32_bf16 a[244:247], a[40:43], a[136:139], 0
v_mfma_f32_16x16x32_bf16 a[244:247], a[44:47], a[140:143], a[244:247]
v_mfma_f32_16x16x32_bf16 a[248:251], a[48:51], a[136:139], 0
v_mfma_f32_16x16x32_bf16 a[248:251], a[52:55], a[140:143], a[248:251]
buffer_load_dwordx4 v19, s[12:15], s26 offen offset:3072 lds
v_mfma_f32_16x16x32_bf16 a[252:255], a[56:59], a[136:139], 0
s_add_u32 s26, s26, 524288
v_mfma_f32_16x16x32_bf16 a[252:255], a[60:63], a[140:143], a[252:255]
s_waitcnt lgkmcnt(0)
Lg_501:
v_mfma_f32_16x16x32_bf16 v[32:35], a[64:67], a[128:131], v[32:35]
s_add_u32 m0, s29, 81920
ds_read_b64_tr_b16 a[136:137], v5 offset:32768
v_mfma_f32_16x16x32_bf16 v[32:35], a[68:71], a[132:135], v[32:35]
buffer_load_dwordx4 v16, s[12:15], s27 offen offset:0 lds
v_mfma_f32_16x16x32_bf16 v[36:39], a[72:75], a[128:131], v[36:39]
ds_read_b64_tr_b16 a[138:139], v5 offset:34816
v_mfma_f32_16x16x32_bf16 v[36:39], a[76:79], a[132:135], v[36:39]
v_mfma_f32_16x16x32_bf16 v[40:43], a[80:83], a[128:131], v[40:43]
ds_read_b64_tr_b16 a[140:141], v5 offset:49152
v_mfma_f32_16x16x32_bf16 v[40:43], a[84:87], a[132:135], v[40:43]
buffer_load_dwordx4 v17, s[12:15], s27 offen offset:1024 lds
v_mfma_f32_16x16x32_bf16 v[44:47], a[88:91], a[128:131], v[44:47]
ds_read_b64_tr_b16 a[142:143], v5 offset:51200
v_mfma_f32_16x16x32_bf16 v[44:47], a[92:95], a[132:135], v[44:47]
v_mfma_f32_16x16x32_bf16 v[48:51], a[96:99], a[128:131], v[48:51]
ds_read_b128 a[0:3], v2 offset:0
v_mfma_f32_16x16x32_bf16 v[48:51], a[100:103], a[132:135], v[48:51]
buffer_load_dwordx4 v18, s[12:15], s27 offen offset:2048 lds
v_mfma_f32_16x16x32_bf16 v[52:55], a[104:107], a[128:131], v[52:55]
ds_read_b128 a[4:7], v3 offset:0
v_mfma_f32_16x16x32_bf16 v[52:55], a[108:111], a[132:135], v[52:55]
v_mfma_f32_16x16x32_bf16 v[56:59], a[112:115], a[128:131], v[56:59]
v_mfma_f32_16x16x32_bf16 v[56:59], a[116:119], a[132:135], v[56:59]
buffer_load_dwordx4 v19, s[12:15], s27 offen offset:3072 lds
v_mfma_f32_16x16x32_bf16 v[60:63], a[120:123], a[128:131], v[60:63]
s_add_u32 s27, s27, 524288
ds_read_b128 a[8:11], v2 offset:2048
v_mfma_f32_16x16x32_bf16 v[60:63], a[124:127], a[132:135], v[60:63]
s_waitcnt lgkmcnt(3)
v_mfma_f32_16x16x32_bf16 v[64:67], a[64:67], a[136:139], v[64:67]
s_add_u32 m0, s28, 32768
ds_read_b64_tr_b16 a[128:129], v6 offset:32768
v_mfma_f32_16x16x32_bf16 v[64:67], a[68:71], a[140:143], v[64:67]
buffer_load_dwordx4 v12, s[8:11], s24 offen offset:0 lds
v_mfma_f32_16x16x32_bf16 v[68:71], a[72:75], a[136:139], v[68:71]
ds_read_b64_tr_b16 a[130:131], v6 offset:34816
v_mfma_f32_16x16x32_bf16 v[68:71], a[76:79], a[140:143], v[68:71]
v_mfma_f32_16x16x32_bf16 v[72:75], a[80:83], a[136:139], v[72:75]
ds_read_b64_tr_b16 a[132:133], v6 offset:49152
v_mfma_f32_16x16x32_bf16 v[72:75], a[84:87], a[140:143], v[72:75]
buffer_load_dwordx4 v13, s[8:11], s24 offen offset:1024 lds
v_mfma_f32_16x16x32_bf16 v[76:79], a[88:91], a[136:139], v[76:79]
ds_read_b64_tr_b16 a[134:135], v6 offset:51200
v_mfma_f32_16x16x32_bf16 v[76:79], a[92:95], a[140:143], v[76:79]
v_mfma_f32_16x16x32_bf16 v[80:83], a[96:99], a[136:139], v[80:83]
ds_read_b128 a[12:15], v3 offset:2048
v_mfma_f32_16x16x32_bf16 v[80:83], a[100:103], a[140:143], v[80:83]
buffer_load_dwordx4 v14, s[8:11], s24 offen offset:2048 lds
v_mfma_f32_16x16x32_bf16 v[84:87], a[104:107], a[136:139], v[84:87]
v_mfma_f32_16x16x32_bf16 v[84:87], a[108:111], a[140:143], v[84:87]
v_mfma_f32_16x16x32_bf16 v[88:91], a[112:115], a[136:139], v[88:91]
ds_read_b128 a[16:19], v2 offset:4096
v_mfma_f32_16x16x32_bf16 v[88:91], a[116:119], a[140:143], v[88:91]
buffer_load_dwordx4 v15, s[8:11], s24 offen offset:3072 lds
v_mfma_f32_16x16x32_bf16 v[92:95], a[120:123], a[136:139], v[92:95]
s_add_u32 s24, s24, 128
ds_read_b128 a[20:23], v3 offset:4096
v_mfma_f32_16x16x32_bf16 v[92:95], a[124:127], a[140:143], v[92:95]
s_waitcnt lgkmcnt(3)
v_mfma_f32_16x16x32_bf16 v[96:99], a[64:67], a[128:131], v[96:99]
s_add_u32 m0, s28, 36864
ds_read_b64_tr_b16 a[136:137], v7 offset:32768
v_mfma_f32_16x16x32_bf16 v[96:99], a[68:71], a[132:135], v[96:99]
buffer_load_dwordx4 v12, s[8:11], s25 offen offset:0 lds
v_mfma_f32_16x16x32_bf16 v[100:103], a[72:75], a[128:131], v[100:103]
ds_read_b64_tr_b16 a[138:139], v7 offset:34816
v_mfma_f32_16x16x32_bf16 v[100:103], a[76:79], a[132:135], v[100:103]
v_mfma_f32_16x16x32_bf16 v[104:107], a[80:83], a[128:131], v[104:107]
ds_read_b64_tr_b16 a[140:141], v7 offset:49152
v_mfma_f32_16x16x32_bf16 v[104:107], a[84:87], a[132:135], v[104:107]
buffer_load_dwordx4 v13, s[8:11], s25 offen offset:1024 lds
v_mfma_f32_16x16x32_bf16 v[108:111], a[88:91], a[128:131], v[108:111]
ds_read_b64_tr_b16 a[142:143], v7 offset:51200
v_mfma_f32_16x16x32_bf16 v[108:111], a[92:95], a[132:135], v[108:111]
v_mfma_f32_16x16x32_bf16 v[112:115], a[96:99], a[128:131], v[112:115]
v_mfma_f32_16x16x32_bf16 v[112:115], a[100:103], a[132:135], v[112:115]
buffer_load_dwordx4 v14, s[8:11], s25 offen offset:2048 lds
v_mfma_f32_16x16x32_bf16 v[116:119], a[104:107], a[128:131], v[116:119]
ds_read_b128 a[24:27], v2 offset:6144
v_mfma_f32_16x16x32_bf16 v[116:119], a[108:111], a[132:135], v[116:119]
v_mfma_f32_16x16x32_bf16 v[120:123], a[112:115], a[128:131], v[120:123]
ds_read_b128 a[28:31], v3 offset:6144
v_mfma_f32_16x16x32_bf16 v[120:123], a[116:119], a[132:135], v[120:123]
buffer_load_dwordx4 v15, s[8:11], s25 offen offset:3072 lds
v_mfma_f32_16x16x32_bf16 v[124:127], a[120:123], a[128:131], v[124:127]
s_add_u32 s25, s25, 128
v_mfma_f32_16x16x32_bf16 v[124:127], a[124:127], a[132:135], v[124:127]
s_waitcnt lgkmcnt(2)
v_mfma_f32_16x16x32_bf16 v[128:131], a[64:67], a[136:139], v[128:131]
ds_read_b64_tr_b16 a[128:129], v8 offset:32768
v_mfma_f32_16x16x32_bf16 v[128:131], a[68:71], a[140:143], v[128:131]
buffer_load_dword v21, v20, s[16:19], s43 offen
v_mfma_f32_16x16x32_bf16 v[132:135], a[72:75], a[136:139], v[132:135]
s_add_u32 s43, s43, s47
ds_read_b64_tr_b16 a[130:131], v8 offset:34816
v_mfma_f32_16x16x32_bf16 v[132:135], a[76:79], a[140:143], v[132:135]
s_cmp_ge_u32 s43, s51
v_mfma_f32_16x16x32_bf16 v[136:139], a[80:83], a[136:139], v[136:139]
s_cselect_b32 s43, 0, s43
ds_read_b64_tr_b16 a[132:133], v8 offset:49152
v_mfma_f32_16x16x32_bf16 v[136:139], a[84:87], a[140:143], v[136:139]
s_cselect_b32 s51, s42, s51
v_mfma_f32_16x16x32_bf16 v[140:143], a[88:91], a[136:139], v[140:143]
s_cselect_b64 s[16:17], s[40:41], s[16:17]
ds_read_b64_tr_b16 a[134:135], v8 offset:51200
v_mfma_f32_16x16x32_bf16 v[140:143], a[92:95], a[140:143], v[140:143]
s_cselect_b32 s18, s42, s18
v_mfma_f32_16x16x32_bf16 v[144:147], a[96:99], a[136:139], v[144:147]
s_cselect_b64 s[40:41], s[44:45], s[40:41]
ds_read_b128 a[32:35], v2 offset:8192
v_mfma_f32_16x16x32_bf16 v[144:147], a[100:103], a[140:143], v[144:147]
s_cselect_b32 s42, s46, s42
v_mfma_f32_16x16x32_bf16 v[148:151], a[104:107], a[136:139], v[148:151]
s_cselect_b32 s46, 0, s46
v_mfma_f32_16x16x32_bf16 v[148:151], a[108:111], a[140:143], v[148:151]
s_cmp_eq_u32 s30, s55
v_mfma_f32_16x16x32_bf16 v[152:155], a[112:115], a[136:139], v[152:155]
s_cselect_b32 s22, 0, 3221225472
ds_read_b128 a[36:39], v3 offset:8192
v_mfma_f32_16x16x32_bf16 v[152:155], a[116:119], a[140:143], v[152:155]
s_sub_u32 s30, s30, 1
buffer_atomic_add v27, v26, s[60:63], s22 offen sc1
v_mfma_f32_16x16x32_bf16 v[156:159], a[120:123], a[136:139], v[156:159]
ds_read_b128 a[40:43], v2 offset:10240
v_mfma_f32_16x16x32_bf16 v[156:159], a[124:127], a[140:143], v[156:159]
s_waitcnt lgkmcnt(3)
v_mfma_f32_16x16x32_bf16 v[160:163], a[64:67], a[128:131], v[160:163]
ds_read_b64_tr_b16 a[136:137], v9 offset:32768
v_mfma_f32_16x16x32_bf16 v[160:163], a[68:71], a[132:135], v[160:163]
v_mfma_f32_16x16x32_bf16 v[164:167], a[72:75], a[128:131], v[164:167]
ds_read_b64_tr_b16 a[138:139], v9 offset:34816
v_mfma_f32_16x16x32_bf16 v[164:167], a[76:79], a[132:135], v[164:167]
v_mfma_f32_16x16x32_bf16 v[168:171], a[80:83], a[128:131], v[168:171]
ds_read_b64_tr_b16 a[140:141], v9 offset:49152
v_mfma_f32_16x16x32_bf16 v[168:171], a[84:87], a[132:135], v[168:171]
v_mfma_f32_16x16x32_bf16 v[172:175], a[88:91], a[128:131], v[172:175]
ds_read_b64_tr_b16 a[142:143], v9 offset:51200
v_mfma_f32_16x16x32_bf16 v[172:175], a[92:95], a[132:135], v[172:175]
v_mfma_f32_16x16x32_bf16 v[176:179], a[96:99], a[128:131], v[176:179]
v_mfma_f32_16x16x32_bf16 v[176:179], a[100:103], a[132:135], v[176:179]
v_mfma_f32_16x16x32_bf16 v[180:183], a[104:107], a[128:131], v[180:183]
ds_read_b128 a[44:47], v3 offset:10240
v_mfma_f32_16x16x32_bf16 v[180:183], a[108:111], a[132:135], v[180:183]
v_mfma_f32_16x16x32_bf16 v[184:187], a[112:115], a[128:131], v[184:187]
ds_read_b128 a[48:51], v2 offset:12288
v_mfma_f32_16x16x32_bf16 v[184:187], a[116:119], a[132:135], v[184:187]
v_mfma_f32_16x16x32_bf16 v[188:191], a[120:123], a[128:131], v[188:191]
v_mfma_f32_16x16x32_bf16 v[188:191], a[124:127], a[132:135], v[188:191]
s_waitcnt lgkmcnt(2)
v_mfma_f32_16x16x32_bf16 v[192:195], a[64:67], a[136:139], v[192:195]
ds_read_b64_tr_b16 a[128:129], v10 offset:32768
v_mfma_f32_16x16x32_bf16 v[192:195], a[68:71], a[140:143], v[192:195]
v_mfma_f32_16x16x32_bf16 v[196:199], a[72:75], a[136:139], v[196:199]
ds_read_b64_tr_b16 a[130:131], v10 offset:34816
v_mfma_f32_16x16x32_bf16 v[196:199], a[76:79], a[140:143], v[196:199]
v_mfma_f32_16x16x32_bf16 v[200:203], a[80:83], a[136:139], v[200:203]
ds_read_b64_tr_b16 a[132:133], v10 offset:49152
v_mfma_f32_16x16x32_bf16 v[200:203], a[84:87], a[140:143], v[200:203]
v_mfma_f32_16x16x32_bf16 v[204:207], a[88:91], a[136:139], v[204:207]
ds_read_b64_tr_b16 a[134:135], v10 offset:51200
v_mfma_f32_16x16x32_bf16 v[204:207], a[92:95], a[140:143], v[204:207]
v_mfma_f32_16x16x32_bf16 v[208:211], a[96:99], a[136:139], v[208:211]
ds_read_b128 a[52:55], v3 offset:12288
v_mfma_f32_16x16x32_bf16 v[208:211], a[100:103], a[140:143], v[208:211]
v_mfma_f32_16x16x32_bf16 v[212:215], a[104:107], a[136:139], v[212:215]
ds_read_b128 a[56:59], v2 offset:14336
v_mfma_f32_16x16x32_bf16 v[212:215], a[108:111], a[140:143], v[212:215]
v_mfma_f32_16x16x32_bf16 v[216:219], a[112:115], a[136:139], v[216:219]
v_mfma_f32_16x16x32_bf16 v[216:219], a[116:119], a[140:143], v[216:219]
v_mfma_f32_16x16x32_bf16 v[220:223], a[120:123], a[136:139], v[220:223]
ds_read_b128 a[60:63], v3 offset:14336
v_mfma_f32_16x16x32_bf16 v[220:223], a[124:127], a[140:143], v[220:223]
s_waitcnt lgkmcnt(3)
v_mfma_f32_16x16x32_bf16 a[192:195], a[64:67], a[128:131], a[192:195]
ds_read_b64_tr_b16 a[136:137], v11 offset:32768
v_mfma_f32_16x16x32_bf16 a[192:195], a[68:71], a[132:135], a[192:195]
v_mfma_f32_16x16x32_bf16 a[196:199], a[72:75], a[128:131], a[196:199]
ds_read_b64_tr_b16 a[138:139], v11 offset:34816
v_mfma_f32_16x16x32_bf16 a[196:199], a[76:79], a[132:135], a[196:199]
v_mfma_f32_16x16x32_bf16 a[200:203], a[80:83], a[128:131], a[200:203]
ds_read_b64_tr_b16 a[140:141], v11 offset:49152
v_mfma_f32_16x16x32_bf16 a[200:203], a[84:87], a[132:135], a[200:203]
v_mfma_f32_16x16x32_bf16 a[204:207], a[88:91], a[128:131], a[204:207]
ds_read_b64_tr_b16 a[142:143], v11 offset:51200
v_mfma_f32_16x16x32_bf16 a[204:207], a[92:95], a[132:135], a[204:207]
v_mfma_f32_16x16x32_bf16 a[208:211], a[96:99], a[128:131], a[208:211]
v_mfma_f32_16x16x32_bf16 a[208:211], a[100:103], a[132:135], a[208:211]
v_mfma_f32_16x16x32_bf16 a[212:215], a[104:107], a[128:131], a[212:215]
v_mfma_f32_16x16x32_bf16 a[212:215], a[108:111], a[132:135], a[212:215]
v_mfma_f32_16x16x32_bf16 a[216:219], a[112:115], a[128:131], a[216:219]
v_mfma_f32_16x16x32_bf16 a[216:219], a[116:119], a[132:135], a[216:219]
v_mfma_f32_16x16x32_bf16 a[220:223], a[120:123], a[128:131], a[220:223]
s_waitcnt vmcnt(2) lgkmcnt(0)
v_mfma_f32_16x16x32_bf16 a[220:223], a[124:127], a[132:135], a[220:223]
s_barrier
v_mfma_f32_16x16x32_bf16 a[224:227], a[64:67], a[136:139], a[224:227]
s_add_u32 m0, s29, 98304
ds_read_b64_tr_b16 a[128:129], v4 offset:0
v_mfma_f32_16x16x32_bf16 a[224:227], a[68:71], a[140:143], a[224:227]
buffer_load_dwordx4 v16, s[12:15], s26 offen offset:0 lds
v_mfma_f32_16x16x32_bf16 a[228:231], a[72:75], a[136:139], a[228:231]
ds_read_b64_tr_b16 a[130:131], v4 offset:2048
v_mfma_f32_16x16x32_bf16 a[228:231], a[76:79], a[140:143], a[228:231]
v_mfma_f32_16x16x32_bf16 a[232:235], a[80:83], a[136:139], a[232:235]
ds_read_b64_tr_b16 a[132:133], v4 offset:16384
v_mfma_f32_16x16x32_bf16 a[232:235], a[84:87], a[140:143], a[232:235]
buffer_load_dwordx4 v17, s[12:15], s26 offen offset:1024 lds
v_mfma_f32_16x16x32_bf16 a[236:239], a[88:91], a[136:139], a[236:239]
ds_read_b64_tr_b16 a[134:135], v4 offset:18432
v_mfma_f32_16x16x32_bf16 a[236:239], a[92:95], a[140:143], a[236:239]
v_mfma_f32_16x16x32_bf16 a[240:243], a[96:99], a[136:139], a[240:243]
v_mfma_f32_16x16x32_bf16 a[240:243], a[100:103], a[140:143], a[240:243]
buffer_load_dwordx4 v18, s[12:15], s26 offen offset:2048 lds
v_mfma_f32_16x16x32_bf16 a[244:247], a[104:107], a[136:139], a[244:247]
v_mfma_f32_16x16x32_bf16 a[244:247], a[108:111], a[140:143], a[244:247]
v_mfma_f32_16x16x32_bf16 a[248:251], a[112:115], a[136:139], a[248:251]
v_mfma_f32_16x16x32_bf16 a[248:251], a[116:119], a[140:143], a[248:251]
buffer_load_dwordx4 v19, s[12:15], s26 offen offset:3072 lds
v_mfma_f32_16x16x32_bf16 a[252:255], a[120:123], a[136:139], a[252:255]
s_add_u32 s26, s26, 524288
v_mfma_f32_16x16x32_bf16 a[252:255], a[124:127], a[140:143], a[252:255]
s_waitcnt lgkmcnt(0)
buffer_store_dword v27, v26, s[4:7], s82 offen sc1
v_mfma_f32_16x16x32_bf16 v[32:35], a[0:3], a[128:131], v[32:35]
s_add_u32 m0, s29, 114688
ds_read_b64_tr_b16 a[136:137], v5 offset:0
v_mfma_f32_16x16x32_bf16 v[32:35], a[4:7], a[132:135], v[32:35]
buffer_load_dwordx4 v16, s[12:15], s27 offen offset:0 lds
v_mfma_f32_16x16x32_bf16 v[36:39], a[8:11], a[128:131], v[36:39]
ds_read_b64_tr_b16 a[138:139], v5 offset:2048
v_mfma_f32_16x16x32_bf16 v[36:39], a[12:15], a[132:135], v[36:39]
v_mfma_f32_16x16x32_bf16 v[40:43], a[16:19], a[128:131], v[40:43]
ds_read_b64_tr_b16 a[140:141], v5 offset:16384
v_mfma_f32_16x16x32_bf16 v[40:43], a[20:23], a[132:135], v[40:43]
buffer_load_dwordx4 v17, s[12:15], s27 offen offset:1024 lds
v_mfma_f32_16x16x32_bf16 v[44:47], a[24:27], a[128:131], v[44:47]
ds_read_b64_tr_b16 a[142:143], v5 offset:18432
v_mfma_f32_16x16x32_bf16 v[44:47], a[28:31], a[132:135], v[44:47]
v_mfma_f32_16x16x32_bf16 v[48:51], a[32:35], a[128:131], v[48:51]
ds_read_b128 a[64:67], v2 offset:32768
v_mfma_f32_16x16x32_bf16 v[48:51], a[36:39], a[132:135], v[48:51]
buffer_load_dwordx4 v18, s[12:15], s27 offen offset:2048 lds
v_mfma_f32_16x16x32_bf16 v[52:55], a[40:43], a[128:131], v[52:55]
ds_read_b128 a[68:71], v3 offset:32768
v_mfma_f32_16x16x32_bf16 v[52:55], a[44:47], a[132:135], v[52:55]
v_mfma_f32_16x16x32_bf16 v[56:59], a[48:51], a[128:131], v[56:59]
v_mfma_f32_16x16x32_bf16 v[56:59], a[52:55], a[132:135], v[56:59]
buffer_load_dwordx4 v19, s[12:15], s27 offen offset:3072 lds
v_mfma_f32_16x16x32_bf16 v[60:63], a[56:59], a[128:131], v[60:63]
s_add_u32 s27, s27, 524288
ds_read_b128 a[72:75], v2 offset:34816
v_mfma_f32_16x16x32_bf16 v[60:63], a[60:63], a[132:135], v[60:63]
s_waitcnt lgkmcnt(3)
v_mfma_f32_16x16x32_bf16 v[64:67], a[0:3], a[136:139], v[64:67]
s_add_u32 m0, s28, 0
ds_read_b64_tr_b16 a[128:129], v6 offset:0
v_mfma_f32_16x16x32_bf16 v[64:67], a[4:7], a[140:143], v[64:67]
buffer_load_dwordx4 v12, s[8:11], s24 offen offset:0 lds
v_mfma_f32_16x16x32_bf16 v[68:71], a[8:11], a[136:139], v[68:71]
ds_read_b64_tr_b16 a[130:131], v6 offset:2048
v_mfma_f32_16x16x32_bf16 v[68:71], a[12:15], a[140:143], v[68:71]
v_mfma_f32_16x16x32_bf16 v[72:75], a[16:19], a[136:139], v[72:75]
ds_read_b64_tr_b16 a[132:133], v6 offset:16384
v_mfma_f32_16x16x32_bf16 v[72:75], a[20:23], a[140:143], v[72:75]
buffer_load_dwordx4 v13, s[8:11], s24 offen offset:1024 lds
v_mfma_f32_16x16x32_bf16 v[76:79], a[24:27], a[136:139], v[76:79]
ds_read_b64_tr_b16 a[134:135], v6 offset:18432
v_mfma_f32_16x16x32_bf16 v[76:79], a[28:31], a[140:143], v[76:79]
v_mfma_f32_16x16x32_bf16 v[80:83], a[32:35], a[136:139], v[80:83]
ds_read_b128 a[76:79], v3 offset:34816
v_mfma_f32_16x16x32_bf16 v[80:83], a[36:39], a[140:143], v[80:83]
buffer_load_dwordx4 v14, s[8:11], s24 offen offset:2048 lds
v_mfma_f32_16x16x32_bf16 v[84:87], a[40:43], a[136:139], v[84:87]
v_mfma_f32_16x16x32_bf16 v[84:87], a[44:47], a[140:143], v[84:87]
v_mfma_f32_16x16x32_bf16 v[88:91], a[48:51], a[136:139], v[88:91]
ds_read_b128 a[80:83], v2 offset:36864
v_mfma_f32_16x16x32_bf16 v[88:91], a[52:55], a[140:143], v[88:91]
buffer_load_dwordx4 v15, s[8:11], s24 offen offset:3072 lds
v_mfma_f32_16x16x32_bf16 v[92:95], a[56:59], a[136:139], v[92:95]
s_add_u32 s24, s24, 128
ds_read_b128 a[84:87], v3 offset:36864
v_mfma_f32_16x16x32_bf16 v[92:95], a[60:63], a[140:143], v[92:95]
s_waitcnt lgkmcnt(3)
v_mfma_f32_16x16x32_bf16 v[96:99], a[0:3], a[128:131], v[96:99]
s_add_u32 m0, s28, 4096
ds_read_b64_tr_b16 a[136:137], v7 offset:0
v_mfma_f32_16x16x32_bf16 v[96:99], a[4:7], a[132:135], v[96:99]
buffer_load_dwordx4 v12, s[8:11], s25 offen offset:0 lds
v_mfma_f32_16x16x32_bf16 v[100:103], a[8:11], a[128:131], v[100:103]
ds_read_b64_tr_b16 a[138:139], v7 offset:2048
v_mfma_f32_16x16x32_bf16 v[100:103], a[12:15], a[132:135], v[100:103]
v_mfma_f32_16x16x32_bf16 v[104:107], a[16:19], a[128:131], v[104:107]
ds_read_b64_tr_b16 a[140:141], v7 offset:16384
v_mfma_f32_16x16x32_bf16 v[104:107], a[20:23], a[132:135], v[104:107]
buffer_load_dwordx4 v13, s[8:11], s25 offen offset:1024 lds
v_mfma_f32_16x16x32_bf16 v[108:111], a[24:27], a[128:131], v[108:111]
ds_read_b64_tr_b16 a[142:143], v7 offset:18432
v_mfma_f32_16x16x32_bf16 v[108:111], a[28:31], a[132:135], v[108:111]
v_mfma_f32_16x16x32_bf16 v[112:115], a[32:35], a[128:131], v[112:115]
v_mfma_f32_16x16x32_bf16 v[112:115], a[36:39], a[132:135], v[112:115]
buffer_load_dwordx4 v14, s[8:11], s25 offen offset:2048 lds
v_mfma_f32_16x16x32_bf16 v[116:119], a[40:43], a[128:131], v[116:119]
ds_read_b128 a[88:91], v2 offset:38912
v_mfma_f32_16x16x32_bf16 v[116:119], a[44:47], a[132:135], v[116:119]
v_mfma_f32_16x16x32_bf16 v[120:123], a[48:51], a[128:131], v[120:123]
ds_read_b128 a[92:95], v3 offset:38912
v_mfma_f32_16x16x32_bf16 v[120:123], a[52:55], a[132:135], v[120:123]
buffer_load_dwordx4 v15, s[8:11], s25 offen offset:3072 lds
v_mfma_f32_16x16x32_bf16 v[124:127], a[56:59], a[128:131], v[124:127]
s_add_u32 s25, s25, 128
v_mfma_f32_16x16x32_bf16 v[124:127], a[60:63], a[132:135], v[124:127]
s_waitcnt lgkmcnt(2)
v_mfma_f32_16x16x32_bf16 v[128:131], a[0:3], a[136:139], v[128:131]
ds_read_b64_tr_b16 a[128:129], v8 offset:0
v_mfma_f32_16x16x32_bf16 v[128:131], a[4:7], a[140:143], v[128:131]
buffer_load_dword v21, v20, s[16:19], s43 offen
v_mfma_f32_16x16x32_bf16 v[132:135], a[8:11], a[136:139], v[132:135]
s_add_u32 s43, s43, s47
ds_read_b64_tr_b16 a[130:131], v8 offset:2048
v_mfma_f32_16x16x32_bf16 v[132:135], a[12:15], a[140:143], v[132:135]
s_cmp_ge_u32 s43, s51
v_mfma_f32_16x16x32_bf16 v[136:139], a[16:19], a[136:139], v[136:139]
s_cselect_b32 s43, 0, s43
ds_read_b64_tr_b16 a[132:133], v8 offset:16384
v_mfma_f32_16x16x32_bf16 v[136:139], a[20:23], a[140:143], v[136:139]
s_cselect_b32 s51, s42, s51
v_mfma_f32_16x16x32_bf16 v[140:143], a[24:27], a[136:139], v[140:143]
s_cselect_b64 s[16:17], s[40:41], s[16:17]
ds_read_b64_tr_b16 a[134:135], v8 offset:18432
v_mfma_f32_16x16x32_bf16 v[140:143], a[28:31], a[140:143], v[140:143]
s_cselect_b32 s18, s42, s18
v_mfma_f32_16x16x32_bf16 v[144:147], a[32:35], a[136:139], v[144:147]
s_cselect_b64 s[40:41], s[44:45], s[40:41]
ds_read_b128 a[96:99], v2 offset:40960
v_mfma_f32_16x16x32_bf16 v[144:147], a[36:39], a[140:143], v[144:147]
s_cselect_b32 s42, s46, s42
v_mfma_f32_16x16x32_bf16 v[148:151], a[40:43], a[136:139], v[148:151]
s_cselect_b32 s46, 0, s46
v_mfma_f32_16x16x32_bf16 v[148:151], a[44:47], a[140:143], v[148:151]
s_cmp_eq_u32 s30, s55
v_mfma_f32_16x16x32_bf16 v[152:155], a[48:51], a[136:139], v[152:155]
s_cselect_b32 s22, 0, 3221225472
ds_read_b128 a[100:103], v3 offset:40960
v_mfma_f32_16x16x32_bf16 v[152:155], a[52:55], a[140:143], v[152:155]
s_sub_u32 s30, s30, 1
buffer_atomic_add v27, v26, s[60:63], s22 offen sc1
v_mfma_f32_16x16x32_bf16 v[156:159], a[56:59], a[136:139], v[156:159]
ds_read_b128 a[104:107], v2 offset:43008
v_mfma_f32_16x16x32_bf16 v[156:159], a[60:63], a[140:143], v[156:159]
s_waitcnt lgkmcnt(3)
v_mfma_f32_16x16x32_bf16 v[160:163], a[0:3], a[128:131], v[160:163]
ds_read_b64_tr_b16 a[136:137], v9 offset:0
v_mfma_f32_16x16x32_bf16 v[160:163], a[4:7], a[132:135], v[160:163]
v_mfma_f32_16x16x32_bf16 v[164:167], a[8:11], a[128:131], v[164:167]
ds_read_b64_tr_b16 a[138:139], v9 offset:2048
v_mfma_f32_16x16x32_bf16 v[164:167], a[12:15], a[132:135], v[164:167]
v_mfma_f32_16x16x32_bf16 v[168:171], a[16:19], a[128:131], v[168:171]
ds_read_b64_tr_b16 a[140:141], v9 offset:16384
v_mfma_f32_16x16x32_bf16 v[168:171], a[20:23], a[132:135], v[168:171]
v_mfma_f32_16x16x32_bf16 v[172:175], a[24:27], a[128:131], v[172:175]
ds_read_b64_tr_b16 a[142:143], v9 offset:18432
v_mfma_f32_16x16x32_bf16 v[172:175], a[28:31], a[132:135], v[172:175]
v_mfma_f32_16x16x32_bf16 v[176:179], a[32:35], a[128:131], v[176:179]
v_mfma_f32_16x16x32_bf16 v[176:179], a[36:39], a[132:135], v[176:179]
v_mfma_f32_16x16x32_bf16 v[180:183], a[40:43], a[128:131], v[180:183]
ds_read_b128 a[108:111], v3 offset:43008
v_mfma_f32_16x16x32_bf16 v[180:183], a[44:47], a[132:135], v[180:183]
v_mfma_f32_16x16x32_bf16 v[184:187], a[48:51], a[128:131], v[184:187]
ds_read_b128 a[112:115], v2 offset:45056
v_mfma_f32_16x16x32_bf16 v[184:187], a[52:55], a[132:135], v[184:187]
v_mfma_f32_16x16x32_bf16 v[188:191], a[56:59], a[128:131], v[188:191]
v_mfma_f32_16x16x32_bf16 v[188:191], a[60:63], a[132:135], v[188:191]
s_waitcnt lgkmcnt(2)
v_mfma_f32_16x16x32_bf16 v[192:195], a[0:3], a[136:139], v[192:195]
ds_read_b64_tr_b16 a[128:129], v10 offset:0
v_mfma_f32_16x16x32_bf16 v[192:195], a[4:7], a[140:143], v[192:195]
v_mfma_f32_16x16x32_bf16 v[196:199], a[8:11], a[136:139], v[196:199]
ds_read_b64_tr_b16 a[130:131], v10 offset:2048
v_mfma_f32_16x16x32_bf16 v[196:199], a[12:15], a[140:143], v[196:199]
v_mfma_f32_16x16x32_bf16 v[200:203], a[16:19], a[136:139], v[200:203]
ds_read_b64_tr_b16 a[132:133], v10 offset:16384
v_mfma_f32_16x16x32_bf16 v[200:203], a[20:23], a[140:143], v[200:203]
v_mfma_f32_16x16x32_bf16 v[204:207], a[24:27], a[136:139], v[204:207]
ds_read_b64_tr_b16 a[134:135], v10 offset:18432
v_mfma_f32_16x16x32_bf16 v[204:207], a[28:31], a[140:143], v[204:207]
v_mfma_f32_16x16x32_bf16 v[208:211], a[32:35], a[136:139], v[208:211]
ds_read_b128 a[116:119], v3 offset:45056
v_mfma_f32_16x16x32_bf16 v[208:211], a[36:39], a[140:143], v[208:211]
v_mfma_f32_16x16x32_bf16 v[212:215], a[40:43], a[136:139], v[212:215]
ds_read_b128 a[120:123], v2 offset:47104
v_mfma_f32_16x16x32_bf16 v[212:215], a[44:47], a[140:143], v[212:215]
v_mfma_f32_16x16x32_bf16 v[216:219], a[48:51], a[136:139], v[216:219]
v_mfma_f32_16x16x32_bf16 v[216:219], a[52:55], a[140:143], v[216:219]
v_mfma_f32_16x16x32_bf16 v[220:223], a[56:59], a[136:139], v[220:223]
ds_read_b128 a[124:127], v3 offset:47104
v_mfma_f32_16x16x32_bf16 v[220:223], a[60:63], a[140:143], v[220:223]
s_waitcnt lgkmcnt(3)
v_mfma_f32_16x16x32_bf16 a[192:195], a[0:3], a[128:131], a[192:195]
ds_read_b64_tr_b16 a[136:137], v11 offset:0
v_mfma_f32_16x16x32_bf16 a[192:195], a[4:7], a[132:135], a[192:195]
v_mfma_f32_16x16x32_bf16 a[196:199], a[8:11], a[128:131], a[196:199]
ds_read_b64_tr_b16 a[138:139], v11 offset:2048
v_mfma_f32_16x16x32_bf16 a[196:199], a[12:15], a[132:135], a[196:199]
v_mfma_f32_16x16x32_bf16 a[200:203], a[16:19], a[128:131], a[200:203]
ds_read_b64_tr_b16 a[140:141], v11 offset:16384
v_mfma_f32_16x16x32_bf16 a[200:203], a[20:23], a[132:135], a[200:203]
v_mfma_f32_16x16x32_bf16 a[204:207], a[24:27], a[128:131], a[204:207]
ds_read_b64_tr_b16 a[142:143], v11 offset:18432
v_mfma_f32_16x16x32_bf16 a[204:207], a[28:31], a[132:135], a[204:207]
v_mfma_f32_16x16x32_bf16 a[208:211], a[32:35], a[128:131], a[208:211]
v_mfma_f32_16x16x32_bf16 a[208:211], a[36:39], a[132:135], a[208:211]
v_mfma_f32_16x16x32_bf16 a[212:215], a[40:43], a[128:131], a[212:215]
v_mfma_f32_16x16x32_bf16 a[212:215], a[44:47], a[132:135], a[212:215]
v_mfma_f32_16x16x32_bf16 a[216:219], a[48:51], a[128:131], a[216:219]
v_mfma_f32_16x16x32_bf16 a[216:219], a[52:55], a[132:135], a[216:219]
v_mfma_f32_16x16x32_bf16 a[220:223], a[56:59], a[128:131], a[220:223]
s_waitcnt vmcnt(2) lgkmcnt(0)
v_mfma_f32_16x16x32_bf16 a[220:223], a[60:63], a[132:135], a[220:223]
s_barrier
v_mfma_f32_16x16x32_bf16 a[224:227], a[0:3], a[136:139], a[224:227]
s_add_u32 m0, s29, 65536
ds_read_b64_tr_b16 a[128:129], v4 offset:32768
v_mfma_f32_16x16x32_bf16 a[224:227], a[4:7], a[140:143], a[224:227]
buffer_load_dwordx4 v16, s[12:15], s26 offen offset:0 lds
v_mfma_f32_16x16x32_bf16 a[228:231], a[8:11], a[136:139], a[228:231]
ds_read_b64_tr_b16 a[130:131], v4 offset:34816
v_mfma_f32_16x16x32_bf16 a[228:231], a[12:15], a[140:143], a[228:231]
v_mfma_f32_16x16x32_bf16 a[232:235], a[16:19], a[136:139], a[232:235]
ds_read_b64_tr_b16 a[132:133], v4 offset:49152
v_mfma_f32_16x16x32_bf16 a[232:235], a[20:23], a[140:143], a[232:235]
buffer_load_dwordx4 v17, s[12:15], s26 offen offset:1024 lds
v_mfma_f32_16x16x32_bf16 a[236:239], a[24:27], a[136:139], a[236:239]
ds_read_b64_tr_b16 a[134:135], v4 offset:51200
v_mfma_f32_16x16x32_bf16 a[236:239], a[28:31], a[140:143], a[236:239]
v_mfma_f32_16x16x32_bf16 a[240:243], a[32:35], a[136:139], a[240:243]
v_mfma_f32_16x16x32_bf16 a[240:243], a[36:39], a[140:143], a[240:243]
buffer_load_dwordx4 v18, s[12:15], s26 offen offset:2048 lds
v_mfma_f32_16x16x32_bf16 a[244:247], a[40:43], a[136:139], a[244:247]
v_mfma_f32_16x16x32_bf16 a[244:247], a[44:47], a[140:143], a[244:247]
v_mfma_f32_16x16x32_bf16 a[248:251], a[48:51], a[136:139], a[248:251]
v_mfma_f32_16x16x32_bf16 a[248:251], a[52:55], a[140:143], a[248:251]
s_waitcnt lgkmcnt(0)
buffer_load_dwordx4 v19, s[12:15], s26 offen offset:3072 lds
v_mfma_f32_16x16x32_bf16 a[252:255], a[56:59], a[136:139], a[252:255]
s_add_u32 s26, s26, 524288
s_bitcmp1_b32 s30, 1
v_mfma_f32_16x16x32_bf16 a[252:255], a[60:63], a[140:143], a[252:255]
s_cbranch_scc1 Lg_501
s_cmp_eq_u32 s30, 0
s_cbranch_scc1 Lg_501t
v_mfma_f32_16x16x32_bf16 v[32:35], a[64:67], a[128:131], v[32:35]
s_add_u32 m0, s29, 81920
ds_read_b64_tr_b16 a[136:137], v5 offset:32768
v_mfma_f32_16x16x32_bf16 v[32:35], a[68:71], a[132:135], v[32:35]
buffer_load_dwordx4 v16, s[12:15], s27 offen offset:0 lds
v_mfma_f32_16x16x32_bf16 v[36:39], a[72:75], a[128:131], v[36:39]
s_lshl_b32 s22, s38, 3
ds_read_b64_tr_b16 a[138:139], v5 offset:34816
v_mfma_f32_16x16x32_bf16 v[36:39], a[76:79], a[132:135], v[36:39]
s_lshl_b32 s23, s39, 5
v_and_b32 v252, 31, v0
v_lshrrev_b32 v253, 5, v0
v_mfma_f32_16x16x32_bf16 v[40:43], a[80:83], a[128:131], v[40:43]
ds_read_b64_tr_b16 a[140:141], v5 offset:49152
v_add_u32 v253, s22, v253
v_mfma_f32_16x16x32_bf16 v[40:43], a[84:87], a[132:135], v[40:43]
buffer_load_dwordx4 v17, s[12:15], s27 offen offset:1024 lds
v_mfma_f32_16x16x32_bf16 v[44:47], a[88:91], a[128:131], v[44:47]
ds_read_b64_tr_b16 a[142:143], v5 offset:51200
v_add_u32 v252, s23, v252
v_mfma_f32_16x16x32_bf16 v[44:47], a[92:95], a[132:135], v[44:47]
v_mul_u32_u24 v254, 7168, v253
v_lshl_add_u32 v254, v252, 2, v254
v_mfma_f32_16x16x32_bf16 v[48:51], a[96:99], a[128:131], v[48:51]
ds_read_b128 a[0:3], v2 offset:0
v_lshlrev_b32 v252, 4, v252
v_mfma_f32_16x16x32_bf16 v[48:51], a[100:103], a[132:135], v[48:51]
buffer_load_dwordx4 v18, s[12:15], s27 offen offset:2048 lds
v_mfma_f32_16x16x32_bf16 v[52:55], a[104:107], a[128:131], v[52:55]
ds_read_b128 a[4:7], v3 offset:0
v_add_u32 v255, 3584, v254
v_mfma_f32_16x16x32_bf16 v[52:55], a[108:111], a[132:135], v[52:55]
v_subrev_u32 v22, 3584, v254
v_subrev_u32 v23, 2688, v254
v_mfma_f32_16x16x32_bf16 v[56:59], a[112:115], a[128:131], v[56:59]
v_subrev_u32 v24, 1792, v254
v_subrev_u32 v25, 896, v254
v_mfma_f32_16x16x32_bf16 v[56:59], a[116:119], a[132:135], v[56:59]
buffer_load_dwordx4 v19, s[12:15], s27 offen offset:3072 lds
v_mfma_f32_16x16x32_bf16 v[60:63], a[120:123], a[128:131], v[60:63]
s_add_u32 s27, s27, 524288
ds_read_b128 a[8:11], v2 offset:2048
v_mfma_f32_16x16x32_bf16 v[60:63], a[124:127], a[132:135], v[60:63]
PAD_23:
s_cbranch_execz PAD_27
s_waitcnt lgkmcnt(3)
v_mfma_f32_16x16x32_bf16 v[64:67], a[64:67], a[136:139], v[64:67]
s_add_u32 m0, s28, 32768
ds_read_b64_tr_b16 a[128:129], v6 offset:32768
v_mfma_f32_16x16x32_bf16 v[64:67], a[68:71], a[140:143], v[64:67]
buffer_load_dwordx4 v12, s[8:11], s24 offen offset:0 lds
v_mfma_f32_16x16x32_bf16 v[68:71], a[72:75], a[136:139], v[68:71]
ds_read_b64_tr_b16 a[130:131], v6 offset:34816
v_mfma_f32_16x16x32_bf16 v[68:71], a[76:79], a[140:143], v[68:71]
v_mfma_f32_16x16x32_bf16 v[72:75], a[80:83], a[136:139], v[72:75]
ds_read_b64_tr_b16 a[132:133], v6 offset:49152
v_mfma_f32_16x16x32_bf16 v[72:75], a[84:87], a[140:143], v[72:75]
buffer_load_dwordx4 v13, s[8:11], s24 offen offset:1024 lds
v_mfma_f32_16x16x32_bf16 v[76:79], a[88:91], a[136:139], v[76:79]
ds_read_b64_tr_b16 a[134:135], v6 offset:51200
v_mfma_f32_16x16x32_bf16 v[76:79], a[92:95], a[140:143], v[76:79]
v_mfma_f32_16x16x32_bf16 v[80:83], a[96:99], a[136:139], v[80:83]
ds_read_b128 a[12:15], v3 offset:2048
v_mfma_f32_16x16x32_bf16 v[80:83], a[100:103], a[140:143], v[80:83]
buffer_load_dwordx4 v14, s[8:11], s24 offen offset:2048 lds
v_mfma_f32_16x16x32_bf16 v[84:87], a[104:107], a[136:139], v[84:87]
v_mfma_f32_16x16x32_bf16 v[84:87], a[108:111], a[140:143], v[84:87]
v_mfma_f32_16x16x32_bf16 v[88:91], a[112:115], a[136:139], v[88:91]
ds_read_b128 a[16:19], v2 offset:4096
v_mfma_f32_16x16x32_bf16 v[88:91], a[116:119], a[140:143], v[88:91]
buffer_load_dwordx4 v15, s[8:11], s24 offen offset:3072 lds
v_mfma_f32_16x16x32_bf16 v[92:95], a[120:123], a[136:139], v[92:95]
s_add_u32 s24, s24, 128
ds_read_b128 a[20:23], v3 offset:4096
v_mfma_f32_16x16x32_bf16 v[92:95], a[124:127], a[140:143], v[92:95]
s_waitcnt lgkmcnt(3)
v_mfma_f32_16x16x32_bf16 v[96:99], a[64:67], a[128:131], v[96:99]
s_add_u32 m0, s28, 36864
ds_read_b64_tr_b16 a[136:137], v7 offset:32768
v_mfma_f32_16x16x32_bf16 v[96:99], a[68:71], a[132:135], v[96:99]
buffer_load_dwordx4 v12, s[8:11], s25 offen offset:0 lds
v_mfma_f32_16x16x32_bf16 v[100:103], a[72:75], a[128:131], v[100:103]
ds_read_b64_tr_b16 a[138:139], v7 offset:34816
v_mfma_f32_16x16x32_bf16 v[100:103], a[76:79], a[132:135], v[100:103]
v_mfma_f32_16x16x32_bf16 v[104:107], a[80:83], a[128:131], v[104:107]
ds_read_b64_tr_b16 a[140:141], v7 offset:49152
v_mfma_f32_16x16x32_bf16 v[104:107], a[84:87], a[132:135], v[104:107]
buffer_load_dwordx4 v13, s[8:11], s25 offen offset:1024 lds
v_mfma_f32_16x16x32_bf16 v[108:111], a[88:91], a[128:131], v[108:111]
ds_read_b64_tr_b16 a[142:143], v7 offset:51200
v_mfma_f32_16x16x32_bf16 v[108:111], a[92:95], a[132:135], v[108:111]
v_mfma_f32_16x16x32_bf16 v[112:115], a[96:99], a[128:131], v[112:115]
v_mfma_f32_16x16x32_bf16 v[112:115], a[100:103], a[132:135], v[112:115]
buffer_load_dwordx4 v14, s[8:11], s25 offen offset:2048 lds
v_mfma_f32_16x16x32_bf16 v[116:119], a[104:107], a[128:131], v[116:119]
ds_read_b128 a[24:27], v2 offset:6144
v_mfma_f32_16x16x32_bf16 v[116:119], a[108:111], a[132:135], v[116:119]
v_mfma_f32_16x16x32_bf16 v[120:123], a[112:115], a[128:131], v[120:123]
ds_read_b128 a[28:31], v3 offset:6144
v_mfma_f32_16x16x32_bf16 v[120:123], a[116:119], a[132:135], v[120:123]
buffer_load_dwordx4 v15, s[8:11], s25 offen offset:3072 lds
v_mfma_f32_16x16x32_bf16 v[124:127], a[120:123], a[128:131], v[124:127]
s_add_u32 s25, s25, 128
v_mfma_f32_16x16x32_bf16 v[124:127], a[124:127], a[132:135], v[124:127]
s_waitcnt lgkmcnt(2)
v_mfma_f32_16x16x32_bf16 v[128:131], a[64:67], a[136:139], v[128:131]
s_mov_b64 s[56:57], s[70:71]
s_mov_b32 s58, 3584
s_mov_b32 s59, 0x20000
ds_read_b64_tr_b16 a[128:129], v8 offset:32768
v_mfma_f32_16x16x32_bf16 v[128:131], a[68:71], a[140:143], v[128:131]
buffer_load_dwordx4 v[248:251], v252, s[56:59], 0 offen
v_mfma_f32_16x16x32_bf16 v[132:135], a[72:75], a[136:139], v[132:135]
s_mov_b64 s[56:57], s[66:67]
s_mov_b32 s58, 1835008
ds_read_b64_tr_b16 a[130:131], v8 offset:34816
v_mfma_f32_16x16x32_bf16 v[132:135], a[76:79], a[140:143], v[132:135]
buffer_load_dword v224, v22, s[56:59], 0 offen nt
v_mfma_f32_16x16x32_bf16 v[136:139], a[80:83], a[136:139], v[136:139]
ds_read_b64_tr_b16 a[132:133], v8 offset:49152
v_mfma_f32_16x16x32_bf16 v[136:139], a[84:87], a[140:143], v[136:139]
buffer_load_dword v225, v23, s[56:59], 0 offen nt
v_mfma_f32_16x16x32_bf16 v[140:143], a[88:91], a[136:139], v[140:143]
ds_read_b64_tr_b16 a[134:135], v8 offset:51200
v_mfma_f32_16x16x32_bf16 v[140:143], a[92:95], a[140:143], v[140:143]
buffer_load_dword v226, v24, s[56:59], 0 offen nt
v_mfma_f32_16x16x32_bf16 v[144:147], a[96:99], a[136:139], v[144:147]
ds_read_b128 a[32:35], v2 offset:8192
v_mfma_f32_16x16x32_bf16 v[144:147], a[100:103], a[140:143], v[144:147]
buffer_load_dword v227, v25, s[56:59], 0 offen nt
v_mfma_f32_16x16x32_bf16 v[148:151], a[104:107], a[136:139], v[148:151]
buffer_load_dword v228, v254, s[56:59], 0 offen offset:0 nt
v_mfma_f32_16x16x32_bf16 v[148:151], a[108:111], a[140:143], v[148:151]
buffer_load_dword v229, v254, s[56:59], 0 offen offset:896 nt
v_mfma_f32_16x16x32_bf16 v[152:155], a[112:115], a[136:139], v[152:155]
ds_read_b128 a[36:39], v3 offset:8192
v_mfma_f32_16x16x32_bf16 v[152:155], a[116:119], a[140:143], v[152:155]
buffer_load_dword v230, v254, s[56:59], 0 offen offset:1792 nt
v_mfma_f32_16x16x32_bf16 v[156:159], a[120:123], a[136:139], v[156:159]
ds_read_b128 a[40:43], v2 offset:10240
v_mfma_f32_16x16x32_bf16 v[156:159], a[124:127], a[140:143], v[156:159]
s_waitcnt lgkmcnt(3)
buffer_load_dword v231, v254, s[56:59], 0 offen offset:2688 nt
v_mfma_f32_16x16x32_bf16 v[160:163], a[64:67], a[128:131], v[160:163]
ds_read_b64_tr_b16 a[136:137], v9 offset:32768
v_mfma_f32_16x16x32_bf16 v[160:163], a[68:71], a[132:135], v[160:163]
buffer_load_dword v232, v255, s[56:59], 0 offen offset:0 nt
v_mfma_f32_16x16x32_bf16 v[164:167], a[72:75], a[128:131], v[164:167]
ds_read_b64_tr_b16 a[138:139], v9 offset:34816
v_mfma_f32_16x16x32_bf16 v[164:167], a[76:79], a[132:135], v[164:167]
buffer_load_dword v233, v255, s[56:59], 0 offen offset:896 nt
v_mfma_f32_16x16x32_bf16 v[168:171], a[80:83], a[128:131], v[168:171]
ds_read_b64_tr_b16 a[140:141], v9 offset:49152
v_mfma_f32_16x16x32_bf16 v[168:171], a[84:87], a[132:135], v[168:171]
buffer_load_dword v234, v255, s[56:59], 0 offen offset:1792 nt
v_mfma_f32_16x16x32_bf16 v[172:175], a[88:91], a[128:131], v[172:175]
ds_read_b64_tr_b16 a[142:143], v9 offset:51200
v_mfma_f32_16x16x32_bf16 v[172:175], a[92:95], a[132:135], v[172:175]
buffer_load_dword v235, v255, s[56:59], 0 offen offset:2688 nt
v_mfma_f32_16x16x32_bf16 v[176:179], a[96:99], a[128:131], v[176:179]
s_mov_b64 s[56:57], s[68:69]
buffer_load_dword v236, v25, s[56:59], 0 offen nt
v_mfma_f32_16x16x32_bf16 v[176:179], a[100:103], a[132:135], v[176:179]
buffer_load_dword v237, v254, s[56:59], 0 offen offset:0 nt
v_mfma_f32_16x16x32_bf16 v[180:183], a[104:107], a[128:131], v[180:183]
ds_read_b128 a[44:47], v3 offset:10240
v_mfma_f32_16x16x32_bf16 v[180:183], a[108:111], a[132:135], v[180:183]
buffer_load_dword v238, v254, s[56:59], 0 offen offset:896 nt
v_mfma_f32_16x16x32_bf16 v[184:187], a[112:115], a[128:131], v[184:187]
ds_read_b128 a[48:51], v2 offset:12288
v_mfma_f32_16x16x32_bf16 v[184:187], a[116:119], a[132:135], v[184:187]
buffer_load_dword v239, v254, s[56:59], 0 offen offset:1792 nt
v_mfma_f32_16x16x32_bf16 v[188:191], a[120:123], a[128:131], v[188:191]
buffer_load_dword v240, v254, s[56:59], 0 offen offset:2688 nt
v_mfma_f32_16x16x32_bf16 v[188:191], a[124:127], a[132:135], v[188:191]
s_waitcnt lgkmcnt(2)
buffer_load_dword v241, v255, s[56:59], 0 offen offset:0 nt
v_mfma_f32_16x16x32_bf16 v[192:195], a[64:67], a[136:139], v[192:195]
ds_read_b64_tr_b16 a[128:129], v10 offset:32768
v_mfma_f32_16x16x32_bf16 v[192:195], a[68:71], a[140:143], v[192:195]
buffer_load_dword v242, v255, s[56:59], 0 offen offset:896 nt
v_mfma_f32_16x16x32_bf16 v[196:199], a[72:75], a[136:139], v[196:199]
ds_read_b64_tr_b16 a[130:131], v10 offset:34816
v_mfma_f32_16x16x32_bf16 v[196:199], a[76:79], a[140:143], v[196:199]
buffer_load_dword v243, v255, s[56:59], 0 offen offset:1792 nt
v_mfma_f32_16x16x32_bf16 v[200:203], a[80:83], a[136:139], v[200:203]
ds_read_b64_tr_b16 a[132:133], v10 offset:49152
v_mfma_f32_16x16x32_bf16 v[200:203], a[84:87], a[140:143], v[200:203]
buffer_load_dword v244, v255, s[56:59], 0 offen offset:2688 nt
v_mfma_f32_16x16x32_bf16 v[204:207], a[88:91], a[136:139], v[204:207]
ds_read_b64_tr_b16 a[134:135], v10 offset:51200
v_mfma_f32_16x16x32_bf16 v[204:207], a[92:95], a[140:143], v[204:207]
v_mfma_f32_16x16x32_bf16 v[208:211], a[96:99], a[136:139], v[208:211]
ds_read_b128 a[52:55], v3 offset:12288
v_mfma_f32_16x16x32_bf16 v[208:211], a[100:103], a[140:143], v[208:211]
v_mfma_f32_16x16x32_bf16 v[212:215], a[104:107], a[136:139], v[212:215]
ds_read_b128 a[56:59], v2 offset:14336
v_mfma_f32_16x16x32_bf16 v[212:215], a[108:111], a[140:143], v[212:215]
v_mfma_f32_16x16x32_bf16 v[216:219], a[112:115], a[136:139], v[216:219]
v_mfma_f32_16x16x32_bf16 v[216:219], a[116:119], a[140:143], v[216:219]
v_mfma_f32_16x16x32_bf16 v[220:223], a[120:123], a[136:139], v[220:223]
ds_read_b128 a[60:63], v3 offset:14336
v_mfma_f32_16x16x32_bf16 v[220:223], a[124:127], a[140:143], v[220:223]
s_waitcnt lgkmcnt(3)
v_mfma_f32_16x16x32_bf16 a[192:195], a[64:67], a[128:131], a[192:195]
ds_read_b64_tr_b16 a[136:137], v11 offset:32768
v_mfma_f32_16x16x32_bf16 a[192:195], a[68:71], a[132:135], a[192:195]
v_mfma_f32_16x16x32_bf16 a[196:199], a[72:75], a[128:131], a[196:199]
ds_read_b64_tr_b16 a[138:139], v11 offset:34816
v_mfma_f32_16x16x32_bf16 a[196:199], a[76:79], a[132:135], a[196:199]
v_mfma_f32_16x16x32_bf16 a[200:203], a[80:83], a[128:131], a[200:203]
ds_read_b64_tr_b16 a[140:141], v11 offset:49152
v_mfma_f32_16x16x32_bf16 a[200:203], a[84:87], a[132:135], a[200:203]
v_mfma_f32_16x16x32_bf16 a[204:207], a[88:91], a[128:131], a[204:207]
ds_read_b64_tr_b16 a[142:143], v11 offset:51200
v_mfma_f32_16x16x32_bf16 a[204:207], a[92:95], a[132:135], a[204:207]
v_mfma_f32_16x16x32_bf16 a[208:211], a[96:99], a[128:131], a[208:211]
v_mfma_f32_16x16x32_bf16 a[208:211], a[100:103], a[132:135], a[208:211]
v_mfma_f32_16x16x32_bf16 a[212:215], a[104:107], a[128:131], a[212:215]
v_mfma_f32_16x16x32_bf16 a[212:215], a[108:111], a[132:135], a[212:215]
v_mfma_f32_16x16x32_bf16 a[216:219], a[112:115], a[128:131], a[216:219]
v_mfma_f32_16x16x32_bf16 a[216:219], a[116:119], a[132:135], a[216:219]
v_mfma_f32_16x16x32_bf16 a[220:223], a[120:123], a[128:131], a[220:223]
s_waitcnt vmcnt(22) lgkmcnt(0)
v_mfma_f32_16x16x32_bf16 a[220:223], a[124:127], a[132:135], a[220:223]
s_barrier
v_mfma_f32_16x16x32_bf16 a[224:227], a[64:67], a[136:139], a[224:227]
s_add_u32 m0, s29, 98304
ds_read_b64_tr_b16 a[128:129], v4 offset:0
v_mfma_f32_16x16x32_bf16 a[224:227], a[68:71], a[140:143], a[224:227]
buffer_load_dwordx4 v16, s[12:15], s26 offen offset:0 lds
v_mfma_f32_16x16x32_bf16 a[228:231], a[72:75], a[136:139], a[228:231]
ds_read_b64_tr_b16 a[130:131], v4 offset:2048
v_mfma_f32_16x16x32_bf16 a[228:231], a[76:79], a[140:143], a[228:231]
v_mfma_f32_16x16x32_bf16 a[232:235], a[80:83], a[136:139], a[232:235]
ds_read_b64_tr_b16 a[132:133], v4 offset:16384
v_mfma_f32_16x16x32_bf16 a[232:235], a[84:87], a[140:143], a[232:235]
buffer_load_dwordx4 v17, s[12:15], s26 offen offset:1024 lds
v_mfma_f32_16x16x32_bf16 a[236:239], a[88:91], a[136:139], a[236:239]
ds_read_b64_tr_b16 a[134:135], v4 offset:18432
v_mfma_f32_16x16x32_bf16 a[236:239], a[92:95], a[140:143], a[236:239]
v_mfma_f32_16x16x32_bf16 a[240:243], a[96:99], a[136:139], a[240:243]
v_mfma_f32_16x16x32_bf16 a[240:243], a[100:103], a[140:143], a[240:243]
buffer_load_dwordx4 v18, s[12:15], s26 offen offset:2048 lds
v_mfma_f32_16x16x32_bf16 a[244:247], a[104:107], a[136:139], a[244:247]
v_mfma_f32_16x16x32_bf16 a[244:247], a[108:111], a[140:143], a[244:247]
v_mfma_f32_16x16x32_bf16 a[248:251], a[112:115], a[136:139], a[248:251]
v_mfma_f32_16x16x32_bf16 a[248:251], a[116:119], a[140:143], a[248:251]
buffer_load_dwordx4 v19, s[12:15], s26 offen offset:3072 lds
v_mfma_f32_16x16x32_bf16 a[252:255], a[120:123], a[136:139], a[252:255]
s_add_u32 s26, s26, 524288
v_mfma_f32_16x16x32_bf16 a[252:255], a[124:127], a[140:143], a[252:255]
s_waitcnt lgkmcnt(0)
v_mfma_f32_16x16x32_bf16 v[32:35], a[0:3], a[128:131], v[32:35]
s_add_u32 m0, s29, 114688
ds_read_b64_tr_b16 a[136:137], v5 offset:0
v_mfma_f32_16x16x32_bf16 v[32:35], a[4:7], a[132:135], v[32:35]
buffer_load_dwordx4 v16, s[12:15], s27 offen offset:0 lds
v_mfma_f32_16x16x32_bf16 v[36:39], a[8:11], a[128:131], v[36:39]
ds_read_b64_tr_b16 a[138:139], v5 offset:2048
v_mfma_f32_16x16x32_bf16 v[36:39], a[12:15], a[132:135], v[36:39]
v_mfma_f32_16x16x32_bf16 v[40:43], a[16:19], a[128:131], v[40:43]
ds_read_b64_tr_b16 a[140:141], v5 offset:16384
v_mfma_f32_16x16x32_bf16 v[40:43], a[20:23], a[132:135], v[40:43]
buffer_load_dwordx4 v17, s[12:15], s27 offen offset:1024 lds
v_mfma_f32_16x16x32_bf16 v[44:47], a[24:27], a[128:131], v[44:47]
ds_read_b64_tr_b16 a[142:143], v5 offset:18432
v_mfma_f32_16x16x32_bf16 v[44:47], a[28:31], a[132:135], v[44:47]
v_mfma_f32_16x16x32_bf16 v[48:51], a[32:35], a[128:131], v[48:51]
ds_read_b128 a[64:67], v2 offset:32768
v_mfma_f32_16x16x32_bf16 v[48:51], a[36:39], a[132:135], v[48:51]
buffer_load_dwordx4 v18, s[12:15], s27 offen offset:2048 lds
v_mfma_f32_16x16x32_bf16 v[52:55], a[40:43], a[128:131], v[52:55]
ds_read_b128 a[68:71], v3 offset:32768
v_mfma_f32_16x16x32_bf16 v[52:55], a[44:47], a[132:135], v[52:55]
v_mfma_f32_16x16x32_bf16 v[56:59], a[48:51], a[128:131], v[56:59]
v_mfma_f32_16x16x32_bf16 v[56:59], a[52:55], a[132:135], v[56:59]
buffer_load_dwordx4 v19, s[12:15], s27 offen offset:3072 lds
v_mfma_f32_16x16x32_bf16 v[60:63], a[56:59], a[128:131], v[60:63]
s_add_u32 s27, s27, 524288
ds_read_b128 a[72:75], v2 offset:34816
v_mfma_f32_16x16x32_bf16 v[60:63], a[60:63], a[132:135], v[60:63]
s_waitcnt lgkmcnt(3)
v_mfma_f32_16x16x32_bf16 v[64:67], a[0:3], a[136:139], v[64:67]
s_add_u32 m0, s28, 0
ds_read_b64_tr_b16 a[128:129], v6 offset:0
v_mfma_f32_16x16x32_bf16 v[64:67], a[4:7], a[140:143], v[64:67]
buffer_load_dwordx4 v12, s[8:11], s24 offen offset:0 lds
v_mfma_f32_16x16x32_bf16 v[68:71], a[8:11], a[136:139], v[68:71]
ds_read_b64_tr_b16 a[130:131], v6 offset:2048
v_mfma_f32_16x16x32_bf16 v[68:71], a[12:15], a[140:143], v[68:71]
v_mfma_f32_16x16x32_bf16 v[72:75], a[16:19], a[136:139], v[72:75]
ds_read_b64_tr_b16 a[132:133], v6 offset:16384
v_mfma_f32_16x16x32_bf16 v[72:75], a[20:23], a[140:143], v[72:75]
buffer_load_dwordx4 v13, s[8:11], s24 offen offset:1024 lds
v_mfma_f32_16x16x32_bf16 v[76:79], a[24:27], a[136:139], v[76:79]
ds_read_b64_tr_b16 a[134:135], v6 offset:18432
v_mfma_f32_16x16x32_bf16 v[76:79], a[28:31], a[140:143], v[76:79]
v_mfma_f32_16x16x32_bf16 v[80:83], a[32:35], a[136:139], v[80:83]
ds_read_b128 a[76:79], v3 offset:34816
v_mfma_f32_16x16x32_bf16 v[80:83], a[36:39], a[140:143], v[80:83]
buffer_load_dwordx4 v14, s[8:11], s24 offen offset:2048 lds
v_mfma_f32_16x16x32_bf16 v[84:87], a[40:43], a[136:139], v[84:87]
v_mfma_f32_16x16x32_bf16 v[84:87], a[44:47], a[140:143], v[84:87]
v_mfma_f32_16x16x32_bf16 v[88:91], a[48:51], a[136:139], v[88:91]
ds_read_b128 a[80:83], v2 offset:36864
v_mfma_f32_16x16x32_bf16 v[88:91], a[52:55], a[140:143], v[88:91]
buffer_load_dwordx4 v15, s[8:11], s24 offen offset:3072 lds
v_mfma_f32_16x16x32_bf16 v[92:95], a[56:59], a[136:139], v[92:95]
s_add_u32 s24, s24, 128
ds_read_b128 a[84:87], v3 offset:36864
v_mfma_f32_16x16x32_bf16 v[92:95], a[60:63], a[140:143], v[92:95]
s_waitcnt lgkmcnt(3)
v_mfma_f32_16x16x32_bf16 v[96:99], a[0:3], a[128:131], v[96:99]
s_add_u32 m0, s28, 4096
ds_read_b64_tr_b16 a[136:137], v7 offset:0
v_mfma_f32_16x16x32_bf16 v[96:99], a[4:7], a[132:135], v[96:99]
buffer_load_dwordx4 v12, s[8:11], s25 offen offset:0 lds
v_mfma_f32_16x16x32_bf16 v[100:103], a[8:11], a[128:131], v[100:103]
ds_read_b64_tr_b16 a[138:139], v7 offset:2048
v_mfma_f32_16x16x32_bf16 v[100:103], a[12:15], a[132:135], v[100:103]
v_mfma_f32_16x16x32_bf16 v[104:107], a[16:19], a[128:131], v[104:107]
ds_read_b64_tr_b16 a[140:141], v7 offset:16384
v_mfma_f32_16x16x32_bf16 v[104:107], a[20:23], a[132:135], v[104:107]
buffer_load_dwordx4 v13, s[8:11], s25 offen offset:1024 lds
v_mfma_f32_16x16x32_bf16 v[108:111], a[24:27], a[128:131], v[108:111]
ds_read_b64_tr_b16 a[142:143], v7 offset:18432
v_mfma_f32_16x16x32_bf16 v[108:111], a[28:31], a[132:135], v[108:111]
v_mfma_f32_16x16x32_bf16 v[112:115], a[32:35], a[128:131], v[112:115]
v_mfma_f32_16x16x32_bf16 v[112:115], a[36:39], a[132:135], v[112:115]
buffer_load_dwordx4 v14, s[8:11], s25 offen offset:2048 lds
v_mfma_f32_16x16x32_bf16 v[116:119], a[40:43], a[128:131], v[116:119]
ds_read_b128 a[88:91], v2 offset:38912
v_mfma_f32_16x16x32_bf16 v[116:119], a[44:47], a[132:135], v[116:119]
v_mfma_f32_16x16x32_bf16 v[120:123], a[48:51], a[128:131], v[120:123]
ds_read_b128 a[92:95], v3 offset:38912
v_mfma_f32_16x16x32_bf16 v[120:123], a[52:55], a[132:135], v[120:123]
buffer_load_dwordx4 v15, s[8:11], s25 offen offset:3072 lds
v_mfma_f32_16x16x32_bf16 v[124:127], a[56:59], a[128:131], v[124:127]
s_add_u32 s25, s25, 128
v_mfma_f32_16x16x32_bf16 v[124:127], a[60:63], a[132:135], v[124:127]
s_waitcnt lgkmcnt(2)
v_mfma_f32_16x16x32_bf16 v[128:131], a[0:3], a[136:139], v[128:131]
ds_read_b64_tr_b16 a[128:129], v8 offset:0
v_mfma_f32_16x16x32_bf16 v[128:131], a[4:7], a[140:143], v[128:131]
buffer_load_dword v21, v20, s[16:19], s43 offen
v_mfma_f32_16x16x32_bf16 v[132:135], a[8:11], a[136:139], v[132:135]
s_add_u32 s43, s43, s47
ds_read_b64_tr_b16 a[130:131], v8 offset:2048
v_mfma_f32_16x16x32_bf16 v[132:135], a[12:15], a[140:143], v[132:135]
s_cmp_ge_u32 s43, s51
v_mfma_f32_16x16x32_bf16 v[136:139], a[16:19], a[136:139], v[136:139]
s_cselect_b32 s43, 0, s43
ds_read_b64_tr_b16 a[132:133], v8 offset:16384
v_mfma_f32_16x16x32_bf16 v[136:139], a[20:23], a[140:143], v[136:139]
s_cselect_b32 s51, s42, s51
v_mfma_f32_16x16x32_bf16 v[140:143], a[24:27], a[136:139], v[140:143]
s_cselect_b64 s[16:17], s[40:41], s[16:17]
ds_read_b64_tr_b16 a[134:135], v8 offset:18432
v_mfma_f32_16x16x32_bf16 v[140:143], a[28:31], a[140:143], v[140:143]
s_cselect_b32 s18, s42, s18
v_mfma_f32_16x16x32_bf16 v[144:147], a[32:35], a[136:139], v[144:147]
s_cselect_b64 s[40:41], s[44:45], s[40:41]
ds_read_b128 a[96:99], v2 offset:40960
v_mfma_f32_16x16x32_bf16 v[144:147], a[36:39], a[140:143], v[144:147]
s_cselect_b32 s42, s46, s42
v_mfma_f32_16x16x32_bf16 v[148:151], a[40:43], a[136:139], v[148:151]
s_cselect_b32 s46, 0, s46
v_mfma_f32_16x16x32_bf16 v[148:151], a[44:47], a[140:143], v[148:151]
s_lshl_b32 s59, s39, 5
v_mfma_f32_16x16x32_bf16 v[152:155], a[48:51], a[136:139], v[152:155]
s_add_u32 s59, s59, s38
ds_read_b128 a[100:103], v3 offset:40960
v_mfma_f32_16x16x32_bf16 v[152:155], a[52:55], a[140:143], v[152:155]
s_lshl_b32 s59, s59, 2
v_mfma_f32_16x16x32_bf16 v[156:159], a[56:59], a[136:139], v[156:159]
s_add_u32 s59, s59, 94392320
ds_read_b128 a[104:107], v2 offset:43008
v_mfma_f32_16x16x32_bf16 v[156:159], a[60:63], a[140:143], v[156:159]
s_waitcnt lgkmcnt(3)
s_cmp_lt_u32 s2, 224
v_mfma_f32_16x16x32_bf16 v[160:163], a[0:3], a[128:131], v[160:163]
s_cselect_b32 s59, s59, 3221225472
ds_read_b64_tr_b16 a[136:137], v9 offset:0
v_mfma_f32_16x16x32_bf16 v[160:163], a[4:7], a[132:135], v[160:163]
s_mov_b32 s58, 0xffff0000
v_mfma_f32_16x16x32_bf16 v[164:167], a[8:11], a[128:131], v[164:167]
s_cmp_lt_u32 s3, 1
ds_read_b64_tr_b16 a[138:139], v9 offset:2048
v_mfma_f32_16x16x32_bf16 v[164:167], a[12:15], a[132:135], v[164:167]
s_cselect_b32 s54, 0, 3221225472
v_mfma_f32_16x16x32_bf16 v[168:171], a[16:19], a[128:131], v[168:171]
s_cselect_b32 s50, 0x100, 0
ds_read_b64_tr_b16 a[140:141], v9 offset:16384
v_mfma_f32_16x16x32_bf16 v[168:171], a[20:23], a[132:135], v[168:171]
buffer_load_dword v21, v20, s[16:19], s43 offen
v_mfma_f32_16x16x32_bf16 v[172:175], a[24:27], a[128:131], v[172:175]
s_add_u32 s43, s43, s47
ds_read_b64_tr_b16 a[142:143], v9 offset:18432
v_mfma_f32_16x16x32_bf16 v[172:175], a[28:31], a[132:135], v[172:175]
s_cmp_ge_u32 s43, s51
v_mfma_f32_16x16x32_bf16 v[176:179], a[32:35], a[128:131], v[176:179]
s_cselect_b32 s43, 0, s43
v_mfma_f32_16x16x32_bf16 v[176:179], a[36:39], a[132:135], v[176:179]
s_cselect_b32 s51, s42, s51
v_mfma_f32_16x16x32_bf16 v[180:183], a[40:43], a[128:131], v[180:183]
s_cselect_b64 s[16:17], s[40:41], s[16:17]
ds_read_b128 a[108:111], v3 offset:43008
v_mfma_f32_16x16x32_bf16 v[180:183], a[44:47], a[132:135], v[180:183]
s_cselect_b32 s18, s42, s18
v_mfma_f32_16x16x32_bf16 v[184:187], a[48:51], a[128:131], v[184:187]
s_cselect_b64 s[40:41], s[44:45], s[40:41]
ds_read_b128 a[112:115], v2 offset:45056
v_mfma_f32_16x16x32_bf16 v[184:187], a[52:55], a[132:135], v[184:187]
s_cselect_b32 s42, s46, s42
v_mfma_f32_16x16x32_bf16 v[188:191], a[56:59], a[128:131], v[188:191]
s_cselect_b32 s46, 0, s46
v_mfma_f32_16x16x32_bf16 v[188:191], a[60:63], a[132:135], v[188:191]
s_waitcnt lgkmcnt(2)
v_mfma_f32_16x16x32_bf16 v[192:195], a[0:3], a[136:139], v[192:195]
ds_read_b64_tr_b16 a[128:129], v10 offset:0
v_mfma_f32_16x16x32_bf16 v[192:195], a[4:7], a[140:143], v[192:195]
v_mfma_f32_16x16x32_bf16 v[196:199], a[8:11], a[136:139], v[196:199]
ds_read_b64_tr_b16 a[130:131], v10 offset:2048
v_mfma_f32_16x16x32_bf16 v[196:199], a[12:15], a[140:143], v[196:199]
v_mfma_f32_16x16x32_bf16 v[200:203], a[16:19], a[136:139], v[200:203]
ds_read_b64_tr_b16 a[132:133], v10 offset:16384
v_mfma_f32_16x16x32_bf16 v[200:203], a[20:23], a[140:143], v[200:203]
v_mfma_f32_16x16x32_bf16 v[204:207], a[24:27], a[136:139], v[204:207]
ds_read_b64_tr_b16 a[134:135], v10 offset:18432
v_mfma_f32_16x16x32_bf16 v[204:207], a[28:31], a[140:143], v[204:207]
v_mfma_f32_16x16x32_bf16 v[208:211], a[32:35], a[136:139], v[208:211]
ds_read_b128 a[116:119], v3 offset:45056
v_mfma_f32_16x16x32_bf16 v[208:211], a[36:39], a[140:143], v[208:211]
v_mfma_f32_16x16x32_bf16 v[212:215], a[40:43], a[136:139], v[212:215]
ds_read_b128 a[120:123], v2 offset:47104
v_and_b32 v252, 31, v0
v_mfma_f32_16x16x32_bf16 v[212:215], a[44:47], a[140:143], v[212:215]
v_lshrrev_b32 v253, 5, v0
v_xor_b32 v253, v253, v252
v_mfma_f32_16x16x32_bf16 v[216:219], a[48:51], a[136:139], v[216:219]
v_and_b32 v253, 7, v253
v_lshlrev_b32 v252, 8, v252
v_mfma_f32_16x16x32_bf16 v[216:219], a[52:55], a[140:143], v[216:219]
v_lshl_add_u32 v252, v253, 4, v252
v_add_u32 v252, 147456, v252
v_mfma_f32_16x16x32_bf16 v[220:223], a[56:59], a[136:139], v[220:223]
ds_read_b128 a[124:127], v3 offset:47104
v_mfma_f32_16x16x32_bf16 v[220:223], a[60:63], a[140:143], v[220:223]
s_waitcnt lgkmcnt(3)
v_mfma_f32_16x16x32_bf16 a[192:195], a[0:3], a[128:131], a[192:195]
ds_read_b64_tr_b16 a[136:137], v11 offset:0
v_mfma_f32_16x16x32_bf16 a[192:195], a[4:7], a[132:135], a[192:195]
v_mfma_f32_16x16x32_bf16 a[196:199], a[8:11], a[128:131], a[196:199]
ds_read_b64_tr_b16 a[138:139], v11 offset:2048
v_mfma_f32_16x16x32_bf16 a[196:199], a[12:15], a[132:135], a[196:199]
v_mfma_f32_16x16x32_bf16 a[200:203], a[16:19], a[128:131], a[200:203]
ds_read_b64_tr_b16 a[140:141], v11 offset:16384
v_mfma_f32_16x16x32_bf16 a[200:203], a[20:23], a[132:135], a[200:203]
v_mfma_f32_16x16x32_bf16 a[204:207], a[24:27], a[128:131], a[204:207]
ds_read_b64_tr_b16 a[142:143], v11 offset:18432
v_mfma_f32_16x16x32_bf16 a[204:207], a[28:31], a[132:135], a[204:207]
v_mfma_f32_16x16x32_bf16 a[208:211], a[32:35], a[128:131], a[208:211]
v_mfma_f32_16x16x32_bf16 a[208:211], a[36:39], a[132:135], a[208:211]
v_mfma_f32_16x16x32_bf16 a[212:215], a[40:43], a[128:131], a[212:215]
v_mfma_f32_16x16x32_bf16 a[212:215], a[44:47], a[132:135], a[212:215]
v_mfma_f32_16x16x32_bf16 a[216:219], a[48:51], a[128:131], a[216:219]
v_mfma_f32_16x16x32_bf16 a[216:219], a[52:55], a[132:135], a[216:219]
v_mfma_f32_16x16x32_bf16 a[220:223], a[56:59], a[128:131], a[220:223]
s_waitcnt vmcnt(2) lgkmcnt(0)
v_mfma_f32_16x16x32_bf16 a[220:223], a[60:63], a[132:135], a[220:223]
s_barrier
v_mfma_f32_16x16x32_bf16 a[224:227], a[0:3], a[136:139], a[224:227]
s_add_u32 m0, s29, 65536
ds_read_b64_tr_b16 a[128:129], v4 offset:32768
v_lshlrev_b32 v28, 16, v248
v_mfma_f32_16x16x32_bf16 a[224:227], a[4:7], a[140:143], a[224:227]
buffer_load_dwordx4 v16, s[12:15], s26 offen offset:0 lds
v_mfma_f32_16x16x32_bf16 a[228:231], a[8:11], a[136:139], a[228:231]
ds_read_b64_tr_b16 a[130:131], v4 offset:34816
v_and_b32 v29, s58, v248
v_mfma_f32_16x16x32_bf16 a[228:231], a[12:15], a[140:143], a[228:231]
v_lshlrev_b32 v30, 16, v249
v_and_b32 v253, s58, v249
v_mfma_f32_16x16x32_bf16 a[232:235], a[16:19], a[136:139], a[232:235]
ds_read_b64_tr_b16 a[132:133], v4 offset:49152
v_lshlrev_b32 v22, 16, v224
v_mfma_f32_16x16x32_bf16 a[232:235], a[20:23], a[140:143], a[232:235]
buffer_load_dwordx4 v17, s[12:15], s26 offen offset:1024 lds
v_mfma_f32_16x16x32_bf16 a[236:239], a[24:27], a[136:139], a[236:239]
ds_read_b64_tr_b16 a[134:135], v4 offset:51200
v_lshlrev_b32 v23, 16, v225
v_mfma_f32_16x16x32_bf16 a[236:239], a[28:31], a[140:143], a[236:239]
v_lshlrev_b32 v24, 16, v226
v_mul_f32 v254, v22, v253
v_mfma_f32_16x16x32_bf16 a[240:243], a[32:35], a[136:139], a[240:243]
v_lshlrev_b32 v25, 16, v227
v_lshlrev_b32 v247, 16, v236
v_mfma_f32_16x16x32_bf16 a[240:243], a[36:39], a[140:143], a[240:243]
buffer_load_dwordx4 v18, s[12:15], s26 offen offset:2048 lds
v_mfma_f32_16x16x32_bf16 a[244:247], a[40:43], a[136:139], a[244:247]
v_fmac_f32 v254, v23, v30
v_fmac_f32 v254, v24, v29
v_mfma_f32_16x16x32_bf16 a[244:247], a[44:47], a[140:143], a[244:247]
v_fmac_f32 v254, v25, v28
v_mul_f32 v254, v254, v247
v_mfma_f32_16x16x32_bf16 a[248:251], a[48:51], a[136:139], a[248:251]
v_mul_f32 v255, v23, v253
v_lshlrev_b32 v22, 16, v228
v_mfma_f32_16x16x32_bf16 a[248:251], a[52:55], a[140:143], a[248:251]
buffer_load_dwordx4 v19, s[12:15], s26 offen offset:3072 lds
v_mfma_f32_16x16x32_bf16 a[252:255], a[56:59], a[136:139], a[252:255]
s_add_u32 s26, s26, 524288
v_lshlrev_b32 v247, 16, v237
v_fmac_f32 v255, v24, v30
v_mfma_f32_16x16x32_bf16 a[252:255], a[60:63], a[140:143], a[252:255]
s_waitcnt lgkmcnt(0)
v_fmac_f32 v255, v25, v29
v_fmac_f32 v255, v22, v28
v_mfma_f32_16x16x32_bf16 v[32:35], a[64:67], a[128:131], v[32:35]
s_add_u32 m0, s29, 81920
ds_read_b64_tr_b16 a[136:137], v5 offset:32768
v_mul_f32 v255, v255, v247
v_mfma_f32_16x16x32_bf16 v[32:35], a[68:71], a[132:135], v[32:35]
buffer_load_dwordx4 v16, s[12:15], s27 offen offset:0 lds
v_mfma_f32_16x16x32_bf16 v[36:39], a[72:75], a[128:131], v[36:39]
ds_read_b64_tr_b16 a[138:139], v5 offset:34816
v_cvt_pk_bf16_f32 v246, v254, v255
v_mfma_f32_16x16x32_bf16 v[36:39], a[76:79], a[132:135], v[36:39]
v_accvgpr_write_b32 a180, v246
v_mul_f32 v254, v24, v253
v_mfma_f32_16x16x32_bf16 v[40:43], a[80:83], a[128:131], v[40:43]
ds_read_b64_tr_b16 a[140:141], v5 offset:49152
v_lshlrev_b32 v23, 16, v229
v_mfma_f32_16x16x32_bf16 v[40:43], a[84:87], a[132:135], v[40:43]
buffer_load_dwordx4 v17, s[12:15], s27 offen offset:1024 lds
v_mfma_f32_16x16x32_bf16 v[44:47], a[88:91], a[128:131], v[44:47]
ds_read_b64_tr_b16 a[142:143], v5 offset:51200
v_lshlrev_b32 v247, 16, v238
v_mfma_f32_16x16x32_bf16 v[44:47], a[92:95], a[132:135], v[44:47]
v_fmac_f32 v254, v25, v30
v_fmac_f32 v254, v22, v29
v_fmac_f32 v254, v23, v28
v_mfma_f32_16x16x32_bf16 v[48:51], a[96:99], a[128:131], v[48:51]
ds_read_b128 a[0:3], v2 offset:0
v_mul_f32 v254, v254, v247
v_mfma_f32_16x16x32_bf16 v[48:51], a[100:103], a[132:135], v[48:51]
buffer_load_dwordx4 v18, s[12:15], s27 offen offset:2048 lds
v_mfma_f32_16x16x32_bf16 v[52:55], a[104:107], a[128:131], v[52:55]
ds_read_b128 a[4:7], v3 offset:0
v_cvt_pk_bf16_f32 v246, v255, v254
v_mfma_f32_16x16x32_bf16 v[52:55], a[108:111], a[132:135], v[52:55]
v_accvgpr_write_b32 a176, v246
v_mul_f32 v255, v25, v253
v_mfma_f32_16x16x32_bf16 v[56:59], a[112:115], a[128:131], v[56:59]
v_lshlrev_b32 v24, 16, v230
v_lshlrev_b32 v247, 16, v239
v_mfma_f32_16x16x32_bf16 v[56:59], a[116:119], a[132:135], v[56:59]
buffer_load_dwordx4 v19, s[12:15], s27 offen offset:3072 lds
v_mfma_f32_16x16x32_bf16 v[60:63], a[120:123], a[128:131], v[60:63]
s_add_u32 s27, s27, 524288
ds_read_b128 a[8:11], v2 offset:2048
v_fmac_f32 v255, v22, v30
v_mfma_f32_16x16x32_bf16 v[60:63], a[124:127], a[132:135], v[60:63]
s_waitcnt lgkmcnt(3)
v_fmac_f32 v255, v23, v29
v_fmac_f32 v255, v24, v28
v_mul_f32 v255, v255, v247
v_mfma_f32_16x16x32_bf16 v[64:67], a[64:67], a[136:139], v[64:67]
s_add_u32 m0, s28, 32768
ds_read_b64_tr_b16 a[128:129], v6 offset:32768
v_cvt_pk_bf16_f32 v246, v254, v255
v_mfma_f32_16x16x32_bf16 v[64:67], a[68:71], a[140:143], v[64:67]
buffer_load_dwordx4 v12, s[8:11], s24 offen offset:0 lds
v_mfma_f32_16x16x32_bf16 v[68:71], a[72:75], a[136:139], v[68:71]
ds_read_b64_tr_b16 a[130:131], v6 offset:34816
v_accvgpr_write_b32 a181, v246
v_mfma_f32_16x16x32_bf16 v[68:71], a[76:79], a[140:143], v[68:71]
v_mul_f32 v254, v22, v253
v_lshlrev_b32 v25, 16, v231
v_mfma_f32_16x16x32_bf16 v[72:75], a[80:83], a[136:139], v[72:75]
ds_read_b64_tr_b16 a[132:133], v6 offset:49152
v_lshlrev_b32 v247, 16, v240
v_mfma_f32_16x16x32_bf16 v[72:75], a[84:87], a[140:143], v[72:75]
buffer_load_dwordx4 v13, s[8:11], s24 offen offset:1024 lds
v_mfma_f32_16x16x32_bf16 v[76:79], a[88:91], a[136:139], v[76:79]
ds_read_b64_tr_b16 a[134:135], v6 offset:51200
v_fmac_f32 v254, v23, v30
v_fmac_f32 v254, v24, v29
v_mfma_f32_16x16x32_bf16 v[76:79], a[92:95], a[140:143], v[76:79]
v_fmac_f32 v254, v25, v28
v_mul_f32 v254, v254, v247
v_mfma_f32_16x16x32_bf16 v[80:83], a[96:99], a[136:139], v[80:83]
ds_read_b128 a[12:15], v3 offset:2048
v_cvt_pk_bf16_f32 v246, v255, v254
v_mfma_f32_16x16x32_bf16 v[80:83], a[100:103], a[140:143], v[80:83]
buffer_load_dwordx4 v14, s[8:11], s24 offen offset:2048 lds
v_mfma_f32_16x16x32_bf16 v[84:87], a[104:107], a[136:139], v[84:87]
PAD_24:
s_cbranch_execz PAD_28
v_accvgpr_write_b32 a177, v246
v_mul_f32 v255, v23, v253
v_mfma_f32_16x16x32_bf16 v[84:87], a[108:111], a[140:143], v[84:87]
v_lshlrev_b32 v22, 16, v232
v_lshlrev_b32 v247, 16, v241
v_mfma_f32_16x16x32_bf16 v[88:91], a[112:115], a[136:139], v[88:91]
ds_read_b128 a[16:19], v2 offset:4096
v_fmac_f32 v255, v24, v30
v_mfma_f32_16x16x32_bf16 v[88:91], a[116:119], a[140:143], v[88:91]
buffer_load_dwordx4 v15, s[8:11], s24 offen offset:3072 lds
v_mfma_f32_16x16x32_bf16 v[92:95], a[120:123], a[136:139], v[92:95]
s_add_u32 s24, s24, 128
ds_read_b128 a[20:23], v3 offset:4096
v_fmac_f32 v255, v25, v29
v_fmac_f32 v255, v22, v28
v_mfma_f32_16x16x32_bf16 v[92:95], a[124:127], a[140:143], v[92:95]
s_waitcnt lgkmcnt(3)
v_mul_f32 v255, v255, v247
v_cvt_pk_bf16_f32 v246, v254, v255
v_mfma_f32_16x16x32_bf16 v[96:99], a[64:67], a[128:131], v[96:99]
s_add_u32 m0, s28, 36864
ds_read_b64_tr_b16 a[136:137], v7 offset:32768
v_accvgpr_write_b32 a182, v246
v_mfma_f32_16x16x32_bf16 v[96:99], a[68:71], a[132:135], v[96:99]
buffer_load_dwordx4 v12, s[8:11], s25 offen offset:0 lds
v_mfma_f32_16x16x32_bf16 v[100:103], a[72:75], a[128:131], v[100:103]
ds_read_b64_tr_b16 a[138:139], v7 offset:34816
v_mul_f32 v254, v24, v253
v_mfma_f32_16x16x32_bf16 v[100:103], a[76:79], a[132:135], v[100:103]
v_lshlrev_b32 v23, 16, v233
v_lshlrev_b32 v247, 16, v242
v_mfma_f32_16x16x32_bf16 v[104:107], a[80:83], a[128:131], v[104:107]
ds_read_b64_tr_b16 a[140:141], v7 offset:49152
v_fmac_f32 v254, v25, v30
v_mfma_f32_16x16x32_bf16 v[104:107], a[84:87], a[132:135], v[104:107]
buffer_load_dwordx4 v13, s[8:11], s25 offen offset:1024 lds
v_fmac_f32 v254, v22, v29
v_mfma_f32_16x16x32_bf16 v[108:111], a[88:91], a[128:131], v[108:111]
ds_read_b64_tr_b16 a[142:143], v7 offset:51200
v_fmac_f32 v254, v23, v28
v_mfma_f32_16x16x32_bf16 v[108:111], a[92:95], a[132:135], v[108:111]
v_mul_f32 v254, v254, v247
v_cvt_pk_bf16_f32 v246, v255, v254
v_mfma_f32_16x16x32_bf16 v[112:115], a[96:99], a[128:131], v[112:115]
v_accvgpr_write_b32 a178, v246
v_mul_f32 v255, v25, v253
v_mfma_f32_16x16x32_bf16 v[112:115], a[100:103], a[132:135], v[112:115]
buffer_load_dwordx4 v14, s[8:11], s25 offen offset:2048 lds
v_mfma_f32_16x16x32_bf16 v[116:119], a[104:107], a[128:131], v[116:119]
ds_read_b128 a[24:27], v2 offset:6144
v_lshlrev_b32 v24, 16, v234
v_mfma_f32_16x16x32_bf16 v[116:119], a[108:111], a[132:135], v[116:119]
v_lshlrev_b32 v247, 16, v243
v_fmac_f32 v255, v22, v30
v_mfma_f32_16x16x32_bf16 v[120:123], a[112:115], a[128:131], v[120:123]
ds_read_b128 a[28:31], v3 offset:6144
v_fmac_f32 v255, v23, v29
v_mfma_f32_16x16x32_bf16 v[120:123], a[116:119], a[132:135], v[120:123]
buffer_load_dwordx4 v15, s[8:11], s25 offen offset:3072 lds
v_fmac_f32 v255, v24, v28
v_mfma_f32_16x16x32_bf16 v[124:127], a[120:123], a[128:131], v[124:127]
s_add_u32 s25, s25, 128
v_mul_f32 v255, v255, v247
v_cvt_pk_bf16_f32 v246, v254, v255
v_mfma_f32_16x16x32_bf16 v[124:127], a[124:127], a[132:135], v[124:127]
s_waitcnt lgkmcnt(2)
v_accvgpr_write_b32 a183, v246
v_mul_f32 v254, v22, v253
v_mfma_f32_16x16x32_bf16 v[128:131], a[64:67], a[136:139], v[128:131]
ds_read_b64_tr_b16 a[128:129], v8 offset:32768
v_lshlrev_b32 v25, 16, v235
v_mfma_f32_16x16x32_bf16 v[128:131], a[68:71], a[140:143], v[128:131]
buffer_load_dword v21, v20, s[16:19], s43 offen
v_mfma_f32_16x16x32_bf16 v[132:135], a[72:75], a[136:139], v[132:135]
s_add_u32 s43, s43, s47
ds_read_b64_tr_b16 a[130:131], v8 offset:34816
v_lshlrev_b32 v247, 16, v244
v_mfma_f32_16x16x32_bf16 v[132:135], a[76:79], a[140:143], v[132:135]
s_cmp_ge_u32 s43, s51
v_fmac_f32 v254, v23, v30
v_fmac_f32 v254, v24, v29
v_mfma_f32_16x16x32_bf16 v[136:139], a[80:83], a[136:139], v[136:139]
s_cselect_b32 s43, 0, s43
ds_read_b64_tr_b16 a[132:133], v8 offset:49152
v_fmac_f32 v254, v25, v28
v_mul_f32 v254, v254, v247
v_mfma_f32_16x16x32_bf16 v[136:139], a[84:87], a[140:143], v[136:139]
s_cselect_b32 s51, s42, s51
v_cvt_pk_bf16_f32 v246, v255, v254
v_accvgpr_write_b32 a179, v246
v_mfma_f32_16x16x32_bf16 v[140:143], a[88:91], a[136:139], v[140:143]
s_cselect_b64 s[16:17], s[40:41], s[16:17]
ds_read_b64_tr_b16 a[134:135], v8 offset:51200
v_lshlrev_b32 v28, 16, v250
v_mfma_f32_16x16x32_bf16 v[140:143], a[92:95], a[140:143], v[140:143]
s_cselect_b32 s18, s42, s18
v_and_b32 v29, s58, v250
v_lshlrev_b32 v30, 16, v251
v_mfma_f32_16x16x32_bf16 v[144:147], a[96:99], a[136:139], v[144:147]
s_cselect_b64 s[40:41], s[44:45], s[40:41]
ds_read_b128 a[32:35], v2 offset:8192
v_and_b32 v253, s58, v251
v_mfma_f32_16x16x32_bf16 v[144:147], a[100:103], a[140:143], v[144:147]
s_cselect_b32 s42, s46, s42
v_and_b32 v22, s58, v224
v_and_b32 v23, s58, v225
v_mfma_f32_16x16x32_bf16 v[148:151], a[104:107], a[136:139], v[148:151]
s_cselect_b32 s46, 0, s46
v_and_b32 v24, s58, v226
v_mul_f32 v254, v22, v253
v_mfma_f32_16x16x32_bf16 v[148:151], a[108:111], a[140:143], v[148:151]
buffer_load_dword v245, off, s[60:63], s54 sc1
v_mfma_f32_16x16x32_bf16 v[152:155], a[112:115], a[136:139], v[152:155]
ds_read_b128 a[36:39], v3 offset:8192
v_and_b32 v25, s58, v227
v_and_b32 v247, s58, v236
v_mfma_f32_16x16x32_bf16 v[152:155], a[116:119], a[140:143], v[152:155]
v_fmac_f32 v254, v23, v30
v_fmac_f32 v254, v24, v29
v_mfma_f32_16x16x32_bf16 v[156:159], a[120:123], a[136:139], v[156:159]
ds_read_b128 a[40:43], v2 offset:10240
v_fmac_f32 v254, v25, v28
v_mfma_f32_16x16x32_bf16 v[156:159], a[124:127], a[140:143], v[156:159]
s_waitcnt lgkmcnt(3)
v_mul_f32 v254, v254, v247
v_mul_f32 v255, v23, v253
v_mfma_f32_16x16x32_bf16 v[160:163], a[64:67], a[128:131], v[160:163]
ds_read_b64_tr_b16 a[136:137], v9 offset:32768
v_and_b32 v22, s58, v228
v_mfma_f32_16x16x32_bf16 v[160:163], a[68:71], a[132:135], v[160:163]
v_and_b32 v247, s58, v237
v_fmac_f32 v255, v24, v30
v_mfma_f32_16x16x32_bf16 v[164:167], a[72:75], a[128:131], v[164:167]
ds_read_b64_tr_b16 a[138:139], v9 offset:34816
v_fmac_f32 v255, v25, v29
v_mfma_f32_16x16x32_bf16 v[164:167], a[76:79], a[132:135], v[164:167]
v_fmac_f32 v255, v22, v28
v_mul_f32 v255, v255, v247
v_mfma_f32_16x16x32_bf16 v[168:171], a[80:83], a[128:131], v[168:171]
ds_read_b64_tr_b16 a[140:141], v9 offset:49152
v_cvt_pk_bf16_f32 v246, v254, v255
v_accvgpr_write_b32 a188, v246
v_mfma_f32_16x16x32_bf16 v[168:171], a[84:87], a[132:135], v[168:171]
v_mul_f32 v254, v24, v253
v_and_b32 v23, s58, v229
v_mfma_f32_16x16x32_bf16 v[172:175], a[88:91], a[128:131], v[172:175]
ds_read_b64_tr_b16 a[142:143], v9 offset:51200
v_and_b32 v247, s58, v238
v_mfma_f32_16x16x32_bf16 v[172:175], a[92:95], a[132:135], v[172:175]
v_fmac_f32 v254, v25, v30
v_fmac_f32 v254, v22, v29
v_mfma_f32_16x16x32_bf16 v[176:179], a[96:99], a[128:131], v[176:179]
v_fmac_f32 v254, v23, v28
v_mul_f32 v254, v254, v247
v_mfma_f32_16x16x32_bf16 v[176:179], a[100:103], a[132:135], v[176:179]
v_cvt_pk_bf16_f32 v246, v255, v254
v_accvgpr_write_b32 a184, v246
v_mfma_f32_16x16x32_bf16 v[180:183], a[104:107], a[128:131], v[180:183]
ds_read_b128 a[44:47], v3 offset:10240
v_mul_f32 v255, v25, v253
v_mfma_f32_16x16x32_bf16 v[180:183], a[108:111], a[132:135], v[180:183]
v_and_b32 v24, s58, v230
v_and_b32 v247, s58, v239
v_fmac_f32 v255, v22, v30
v_mfma_f32_16x16x32_bf16 v[184:187], a[112:115], a[128:131], v[184:187]
ds_read_b128 a[48:51], v2 offset:12288
v_fmac_f32 v255, v23, v29
v_mfma_f32_16x16x32_bf16 v[184:187], a[116:119], a[132:135], v[184:187]
v_fmac_f32 v255, v24, v28
v_mul_f32 v255, v255, v247
v_mfma_f32_16x16x32_bf16 v[188:191], a[120:123], a[128:131], v[188:191]
v_cvt_pk_bf16_f32 v246, v254, v255
v_accvgpr_write_b32 a189, v246
v_mfma_f32_16x16x32_bf16 v[188:191], a[124:127], a[132:135], v[188:191]
s_waitcnt lgkmcnt(2)
v_mul_f32 v254, v22, v253
v_and_b32 v25, s58, v231
v_mfma_f32_16x16x32_bf16 v[192:195], a[64:67], a[136:139], v[192:195]
ds_read_b64_tr_b16 a[128:129], v10 offset:32768
v_and_b32 v247, s58, v240
v_mfma_f32_16x16x32_bf16 v[192:195], a[68:71], a[140:143], v[192:195]
v_fmac_f32 v254, v23, v30
v_fmac_f32 v254, v24, v29
v_mfma_f32_16x16x32_bf16 v[196:199], a[72:75], a[136:139], v[196:199]
ds_read_b64_tr_b16 a[130:131], v10 offset:34816
v_fmac_f32 v254, v25, v28
v_mfma_f32_16x16x32_bf16 v[196:199], a[76:79], a[140:143], v[196:199]
v_mul_f32 v254, v254, v247
v_cvt_pk_bf16_f32 v246, v255, v254
v_accvgpr_write_b32 a185, v246
v_mfma_f32_16x16x32_bf16 v[200:203], a[80:83], a[136:139], v[200:203]
s_lshr_b32 s22, s3, 1
ds_read_b64_tr_b16 a[132:133], v10 offset:49152
v_mul_f32 v255, v23, v253
v_mfma_f32_16x16x32_bf16 v[200:203], a[84:87], a[140:143], v[200:203]
s_mul_i32 s22, s22, 2097152
v_and_b32 v22, s58, v232
v_and_b32 v247, s58, v241
v_mfma_f32_16x16x32_bf16 v[204:207], a[88:91], a[136:139], v[204:207]
s_and_b32 s23, s3, 1
ds_read_b64_tr_b16 a[134:135], v10 offset:51200
v_fmac_f32 v255, v24, v30
v_mfma_f32_16x16x32_bf16 v[204:207], a[92:95], a[140:143], v[204:207]
s_lshl_b32 s23, s23, 5
v_fmac_f32 v255, v25, v29
v_fmac_f32 v255, v22, v28
v_mfma_f32_16x16x32_bf16 v[208:211], a[96:99], a[136:139], v[208:211]
s_lshl_b32 s56, s39, 6
ds_read_b128 a[52:55], v3 offset:12288
v_mul_f32 v255, v255, v247
v_mfma_f32_16x16x32_bf16 v[208:211], a[100:103], a[140:143], v[208:211]
s_add_u32 s23, s23, s56
v_cvt_pk_bf16_f32 v246, v254, v255
v_accvgpr_write_b32 a190, v246
v_mfma_f32_16x16x32_bf16 v[212:215], a[104:107], a[136:139], v[212:215]
s_mul_i32 s23, s23, 4224
ds_read_b128 a[56:59], v2 offset:14336
v_mul_f32 v254, v24, v253
v_and_b32 v23, s58, v233
v_mfma_f32_16x16x32_bf16 v[212:215], a[108:111], a[140:143], v[212:215]
s_add_u32 s22, s22, s23
v_and_b32 v247, s58, v242
v_fmac_f32 v254, v25, v30
v_mfma_f32_16x16x32_bf16 v[216:219], a[112:115], a[136:139], v[216:219]
s_add_u32 s57, s22, 83886200
v_fmac_f32 v254, v22, v29
v_fmac_f32 v254, v23, v28
v_mfma_f32_16x16x32_bf16 v[216:219], a[116:119], a[140:143], v[216:219]
s_lshl_b32 s23, s38, 7
v_mul_f32 v254, v254, v247
v_cvt_pk_bf16_f32 v246, v255, v254
v_mfma_f32_16x16x32_bf16 v[220:223], a[120:123], a[136:139], v[220:223]
s_add_u32 s22, s22, s23
ds_read_b128 a[60:63], v3 offset:14336
v_accvgpr_write_b32 a186, v246
v_mfma_f32_16x16x32_bf16 v[220:223], a[124:127], a[140:143], v[220:223]
s_waitcnt lgkmcnt(3)
s_add_u32 s56, s22, 83886208
v_mul_f32 v255, v25, v253
v_and_b32 v24, s58, v234
v_mfma_f32_16x16x32_bf16 a[192:195], a[64:67], a[128:131], a[192:195]
s_cmp_lt_u32 s2, 224
ds_read_b64_tr_b16 a[136:137], v11 offset:32768
v_and_b32 v247, s58, v243
v_mfma_f32_16x16x32_bf16 a[192:195], a[68:71], a[132:135], a[192:195]
s_cselect_b32 s56, s56, 3221225472
v_fmac_f32 v255, v22, v30
v_fmac_f32 v255, v23, v29
v_mfma_f32_16x16x32_bf16 a[196:199], a[72:75], a[128:131], a[196:199]
s_cmp_eq_u32 s38, 0
ds_read_b64_tr_b16 a[138:139], v11 offset:34816
v_fmac_f32 v255, v24, v28
v_mul_f32 v255, v255, v247
v_mfma_f32_16x16x32_bf16 a[196:199], a[76:79], a[132:135], a[196:199]
s_cselect_b32 s57, s57, 3221225472
v_cvt_pk_bf16_f32 v246, v254, v255
v_accvgpr_write_b32 a191, v246
v_mfma_f32_16x16x32_bf16 a[200:203], a[80:83], a[128:131], a[200:203]
ds_read_b64_tr_b16 a[140:141], v11 offset:49152
v_mul_f32 v254, v22, v253
v_mfma_f32_16x16x32_bf16 a[200:203], a[84:87], a[132:135], a[200:203]
v_and_b32 v25, s58, v235
v_and_b32 v247, s58, v244
v_mfma_f32_16x16x32_bf16 a[204:207], a[88:91], a[128:131], a[204:207]
ds_read_b64_tr_b16 a[142:143], v11 offset:51200
v_fmac_f32 v254, v23, v30
v_mfma_f32_16x16x32_bf16 a[204:207], a[92:95], a[132:135], a[204:207]
ds_write_b128 v252, a[176:179] offset:0
v_fmac_f32 v254, v24, v29
v_mfma_f32_16x16x32_bf16 a[208:211], a[96:99], a[128:131], a[208:211]
v_fmac_f32 v254, v25, v28
v_mul_f32 v254, v254, v247
v_mfma_f32_16x16x32_bf16 a[208:211], a[100:103], a[132:135], a[208:211]
ds_write_b128 v252, a[180:183] offset:8192
v_cvt_pk_bf16_f32 v246, v255, v254
v_accvgpr_write_b32 a187, v246
v_mfma_f32_16x16x32_bf16 a[212:215], a[104:107], a[128:131], a[212:215]
v_mfma_f32_16x16x32_bf16 a[212:215], a[108:111], a[132:135], a[212:215]
ds_write_b128 v252, a[184:187] offset:128
v_mfma_f32_16x16x32_bf16 a[216:219], a[112:115], a[128:131], a[216:219]
v_mfma_f32_16x16x32_bf16 a[216:219], a[116:119], a[132:135], a[216:219]
ds_write_b128 v252, a[188:191] offset:8320
v_mfma_f32_16x16x32_bf16 a[220:223], a[120:123], a[128:131], a[220:223]
s_waitcnt vmcnt(2) lgkmcnt(0)
v_mfma_f32_16x16x32_bf16 a[220:223], a[124:127], a[132:135], a[220:223]
s_barrier
v_mfma_f32_16x16x32_bf16 a[224:227], a[64:67], a[136:139], a[224:227]
s_add_u32 m0, s29, 98304
ds_read_b64_tr_b16 a[128:129], v4 offset:0
v_lshrrev_b32 v22, 8, v1
v_mfma_f32_16x16x32_bf16 a[224:227], a[68:71], a[140:143], a[224:227]
buffer_load_dwordx4 v16, s[12:15], s26 offen offset:0 lds
v_mfma_f32_16x16x32_bf16 a[228:231], a[72:75], a[136:139], a[228:231]
ds_read_b64_tr_b16 a[130:131], v4 offset:2048
v_lshlrev_b32 v22, 4, v22
v_mfma_f32_16x16x32_bf16 a[228:231], a[76:79], a[140:143], a[228:231]
v_xor_b32 v22, v22, v1
v_add_u32 v22, s29, v22
v_mfma_f32_16x16x32_bf16 a[232:235], a[80:83], a[136:139], a[232:235]
ds_read_b64_tr_b16 a[132:133], v4 offset:16384
v_add_u32 v22, 147456, v22
v_mfma_f32_16x16x32_bf16 a[232:235], a[84:87], a[140:143], a[232:235]
buffer_load_dwordx4 v17, s[12:15], s26 offen offset:1024 lds
v_mfma_f32_16x16x32_bf16 a[236:239], a[88:91], a[136:139], a[236:239]
ds_read_b64_tr_b16 a[134:135], v4 offset:18432
v_xor_b32 v23, 64, v22
v_mfma_f32_16x16x32_bf16 a[236:239], a[92:95], a[140:143], a[236:239]
v_lshrrev_b32 v224, 7, v1
v_mul_u32_u24 v224, 4224, v224
v_mfma_f32_16x16x32_bf16 a[240:243], a[96:99], a[136:139], a[240:243]
v_and_b32 v225, 0x70, v1
v_add_u32 v224, v224, v225
v_mfma_f32_16x16x32_bf16 a[240:243], a[100:103], a[140:143], a[240:243]
buffer_load_dwordx4 v18, s[12:15], s26 offen offset:2048 lds
v_mfma_f32_16x16x32_bf16 a[244:247], a[104:107], a[136:139], a[244:247]
v_bfe_u32 v225, v1, 4, 5
v_mul_u32_u24 v225, 4224, v225
v_mfma_f32_16x16x32_bf16 a[244:247], a[108:111], a[140:143], a[244:247]
v_mov_b32 v226, 0
v_mov_b32 v227, 0
v_mfma_f32_16x16x32_bf16 a[248:251], a[112:115], a[136:139], a[248:251]
v_mfma_f32_16x16x32_bf16 a[248:251], a[116:119], a[140:143], a[248:251]
buffer_load_dwordx4 v19, s[12:15], s26 offen offset:3072 lds
v_mfma_f32_16x16x32_bf16 a[252:255], a[120:123], a[136:139], a[252:255]
s_add_u32 s26, s26, 524288
v_mfma_f32_16x16x32_bf16 a[252:255], a[124:127], a[140:143], a[252:255]
s_waitcnt lgkmcnt(0)
v_mfma_f32_16x16x32_bf16 v[32:35], a[0:3], a[128:131], v[32:35]
s_add_u32 m0, s29, 114688
ds_read_b64_tr_b16 a[136:137], v5 offset:0
v_mfma_f32_16x16x32_bf16 v[32:35], a[4:7], a[132:135], v[32:35]
buffer_load_dwordx4 v16, s[12:15], s27 offen offset:0 lds
v_mfma_f32_16x16x32_bf16 v[36:39], a[8:11], a[128:131], v[36:39]
s_mul_i32 s52, s20, 7
ds_read_b64_tr_b16 a[138:139], v5 offset:2048
v_mfma_f32_16x16x32_bf16 v[36:39], a[12:15], a[132:135], v[36:39]
s_add_u32 s52, s52, s21
buffer_store_dwordx2 v[226:227], v225, s[4:7], s57 offen sc1
v_mfma_f32_16x16x32_bf16 v[40:43], a[16:19], a[128:131], v[40:43]
s_lshl_b32 s53, s52, 2
ds_read_b64_tr_b16 a[140:141], v5 offset:16384
v_mfma_f32_16x16x32_bf16 v[40:43], a[20:23], a[132:135], v[40:43]
s_add_u32 s53, s53, s3
buffer_load_dwordx4 v17, s[12:15], s27 offen offset:1024 lds
v_mfma_f32_16x16x32_bf16 v[44:47], a[24:27], a[128:131], v[44:47]
s_lshl_b32 s49, s53, 12
ds_read_b64_tr_b16 a[142:143], v5 offset:18432
v_mfma_f32_16x16x32_bf16 v[44:47], a[28:31], a[132:135], v[44:47]
s_mul_i32 s53, s53, 4224
v_mfma_f32_16x16x32_bf16 v[48:51], a[32:35], a[128:131], v[48:51]
s_add_u32 s53, s53, 83886080
ds_read_b128 a[64:67], v2 offset:32768
v_mfma_f32_16x16x32_bf16 v[48:51], a[36:39], a[132:135], v[48:51]
s_lshr_b32 s52, s52, 4
buffer_load_dwordx4 v18, s[12:15], s27 offen offset:2048 lds
v_mfma_f32_16x16x32_bf16 v[52:55], a[40:43], a[128:131], v[52:55]
s_min_u32 s52, s52, 6
ds_read_b128 a[68:71], v3 offset:32768
v_mfma_f32_16x16x32_bf16 v[52:55], a[44:47], a[132:135], v[52:55]
s_lshl_b32 s52, s52, 7
ds_read_b128 a[176:179], v22 offset:0
v_mfma_f32_16x16x32_bf16 v[56:59], a[48:51], a[128:131], v[56:59]
s_add_u32 s52, s52, 94392320
ds_read_b128 a[180:183], v23 offset:1024
v_mfma_f32_16x16x32_bf16 v[56:59], a[52:55], a[132:135], v[56:59]
buffer_load_dwordx4 v19, s[12:15], s27 offen offset:3072 lds
v_mfma_f32_16x16x32_bf16 v[60:63], a[56:59], a[128:131], v[60:63]
s_add_u32 s27, s27, 524288
ds_read_b128 a[72:75], v2 offset:34816
v_mfma_f32_16x16x32_bf16 v[60:63], a[60:63], a[132:135], v[60:63]
s_waitcnt lgkmcnt(5)
ds_read_b128 a[184:187], v22 offset:2048
v_mfma_f32_16x16x32_bf16 v[64:67], a[0:3], a[136:139], v[64:67]
s_add_u32 m0, s28, 0
ds_read_b64_tr_b16 a[128:129], v6 offset:0
v_mfma_f32_16x16x32_bf16 v[64:67], a[4:7], a[140:143], v[64:67]
buffer_load_dwordx4 v12, s[8:11], s24 offen offset:0 lds
v_mfma_f32_16x16x32_bf16 v[68:71], a[8:11], a[136:139], v[68:71]
ds_read_b64_tr_b16 a[130:131], v6 offset:2048
v_mfma_f32_16x16x32_bf16 v[68:71], a[12:15], a[140:143], v[68:71]
ds_read_b128 a[188:191], v23 offset:3072
v_mfma_f32_16x16x32_bf16 v[72:75], a[16:19], a[136:139], v[72:75]
ds_read_b64_tr_b16 a[132:133], v6 offset:16384
v_bfe_u32 v231, v1, 4, 5
v_mfma_f32_16x16x32_bf16 v[72:75], a[20:23], a[140:143], v[72:75]
buffer_load_dwordx4 v13, s[8:11], s24 offen offset:1024 lds
v_mfma_f32_16x16x32_bf16 v[76:79], a[24:27], a[136:139], v[76:79]
ds_read_b64_tr_b16 a[134:135], v6 offset:18432
v_lshlrev_b32 v231, 2, v231
v_mfma_f32_16x16x32_bf16 v[76:79], a[28:31], a[140:143], v[76:79]
v_lshlrev_b32 v229, 3, v1
v_min_u32 v229, 4096, v229
v_mfma_f32_16x16x32_bf16 v[80:83], a[32:35], a[136:139], v[80:83]
ds_read_b128 a[76:79], v3 offset:34816
v_mfma_f32_16x16x32_bf16 v[80:83], a[36:39], a[140:143], v[80:83]
buffer_load_dwordx4 v14, s[8:11], s24 offen offset:2048 lds
v_mfma_f32_16x16x32_bf16 v[84:87], a[40:43], a[136:139], v[84:87]
v_mfma_f32_16x16x32_bf16 v[84:87], a[44:47], a[140:143], v[84:87]
v_mfma_f32_16x16x32_bf16 v[88:91], a[48:51], a[136:139], v[88:91]
ds_read_b128 a[80:83], v2 offset:36864
v_mfma_f32_16x16x32_bf16 v[88:91], a[52:55], a[140:143], v[88:91]
buffer_load_dwordx4 v15, s[8:11], s24 offen offset:3072 lds
v_mfma_f32_16x16x32_bf16 v[92:95], a[56:59], a[136:139], v[92:95]
s_add_u32 s24, s24, 128
ds_read_b128 a[84:87], v3 offset:36864
v_mfma_f32_16x16x32_bf16 v[92:95], a[60:63], a[140:143], v[92:95]
s_waitcnt lgkmcnt(3)
v_mfma_f32_16x16x32_bf16 v[96:99], a[0:3], a[128:131], v[96:99]
s_add_u32 m0, s28, 4096
ds_read_b64_tr_b16 a[136:137], v7 offset:0
v_mfma_f32_16x16x32_bf16 v[96:99], a[4:7], a[132:135], v[96:99]
buffer_load_dwordx4 v12, s[8:11], s25 offen offset:0 lds
v_mfma_f32_16x16x32_bf16 v[100:103], a[8:11], a[128:131], v[100:103]
ds_read_b64_tr_b16 a[138:139], v7 offset:2048
v_mfma_f32_16x16x32_bf16 v[100:103], a[12:15], a[132:135], v[100:103]
v_mfma_f32_16x16x32_bf16 v[104:107], a[16:19], a[128:131], v[104:107]
ds_read_b64_tr_b16 a[140:141], v7 offset:16384
v_mfma_f32_16x16x32_bf16 v[104:107], a[20:23], a[132:135], v[104:107]
buffer_load_dwordx4 v13, s[8:11], s25 offen offset:1024 lds
v_mfma_f32_16x16x32_bf16 v[108:111], a[24:27], a[128:131], v[108:111]
ds_read_b64_tr_b16 a[142:143], v7 offset:18432
v_mfma_f32_16x16x32_bf16 v[108:111], a[28:31], a[132:135], v[108:111]
v_mfma_f32_16x16x32_bf16 v[112:115], a[32:35], a[128:131], v[112:115]
v_mfma_f32_16x16x32_bf16 v[112:115], a[36:39], a[132:135], v[112:115]
buffer_load_dwordx4 v14, s[8:11], s25 offen offset:2048 lds
v_mfma_f32_16x16x32_bf16 v[116:119], a[40:43], a[128:131], v[116:119]
ds_read_b128 a[88:91], v2 offset:38912
v_mfma_f32_16x16x32_bf16 v[116:119], a[44:47], a[132:135], v[116:119]
v_mfma_f32_16x16x32_bf16 v[120:123], a[48:51], a[128:131], v[120:123]
ds_read_b128 a[92:95], v3 offset:38912
v_mfma_f32_16x16x32_bf16 v[120:123], a[52:55], a[132:135], v[120:123]
buffer_load_dwordx4 v15, s[8:11], s25 offen offset:3072 lds
v_mfma_f32_16x16x32_bf16 v[124:127], a[56:59], a[128:131], v[124:127]
s_add_u32 s25, s25, 128
v_mfma_f32_16x16x32_bf16 v[124:127], a[60:63], a[132:135], v[124:127]
s_waitcnt lgkmcnt(2)
v_mfma_f32_16x16x32_bf16 v[128:131], a[0:3], a[136:139], v[128:131]
ds_read_b64_tr_b16 a[128:129], v8 offset:0
v_mfma_f32_16x16x32_bf16 v[128:131], a[4:7], a[140:143], v[128:131]
buffer_store_dwordx4 a[176:179], v224, s[4:7], s56 offen sc1
v_mfma_f32_16x16x32_bf16 v[132:135], a[8:11], a[136:139], v[132:135]
s_add_u32 s56, s56, 33792
ds_read_b64_tr_b16 a[130:131], v8 offset:2048
v_mfma_f32_16x16x32_bf16 v[132:135], a[12:15], a[140:143], v[132:135]
v_mfma_f32_16x16x32_bf16 v[136:139], a[16:19], a[136:139], v[136:139]
ds_read_b64_tr_b16 a[132:133], v8 offset:16384
v_mfma_f32_16x16x32_bf16 v[136:139], a[20:23], a[140:143], v[136:139]
v_mfma_f32_16x16x32_bf16 v[140:143], a[24:27], a[136:139], v[140:143]
s_cmp_lt_u32 s21, 7
ds_read_b64_tr_b16 a[134:135], v8 offset:18432
v_mfma_f32_16x16x32_bf16 v[140:143], a[28:31], a[140:143], v[140:143]
s_cselect_b32 s53, s53, 3221225472
v_mfma_f32_16x16x32_bf16 v[144:147], a[32:35], a[136:139], v[144:147]
s_cselect_b32 s49, s49, 3221225472
ds_read_b128 a[96:99], v2 offset:40960
v_mfma_f32_16x16x32_bf16 v[144:147], a[36:39], a[140:143], v[144:147]
s_add_u32 s48, s53, 2097152
v_mfma_f32_16x16x32_bf16 v[148:151], a[40:43], a[136:139], v[148:151]
v_mfma_f32_16x16x32_bf16 v[148:151], a[44:47], a[140:143], v[148:151]
v_mfma_f32_16x16x32_bf16 v[152:155], a[48:51], a[136:139], v[152:155]
ds_read_b128 a[100:103], v3 offset:40960
v_mfma_f32_16x16x32_bf16 v[152:155], a[52:55], a[140:143], v[152:155]
v_mfma_f32_16x16x32_bf16 v[156:159], a[56:59], a[136:139], v[156:159]
ds_read_b128 a[104:107], v2 offset:43008
v_mfma_f32_16x16x32_bf16 v[156:159], a[60:63], a[140:143], v[156:159]
s_waitcnt lgkmcnt(3)
v_mfma_f32_16x16x32_bf16 v[160:163], a[0:3], a[128:131], v[160:163]
ds_read_b64_tr_b16 a[136:137], v9 offset:0
v_mfma_f32_16x16x32_bf16 v[160:163], a[4:7], a[132:135], v[160:163]
v_mfma_f32_16x16x32_bf16 v[164:167], a[8:11], a[128:131], v[164:167]
ds_read_b64_tr_b16 a[138:139], v9 offset:2048
v_mfma_f32_16x16x32_bf16 v[164:167], a[12:15], a[132:135], v[164:167]
buffer_store_dwordx4 a[180:183], v224, s[4:7], s56 offen sc1
v_mfma_f32_16x16x32_bf16 v[168:171], a[16:19], a[128:131], v[168:171]
s_add_u32 s56, s56, 33792
ds_read_b64_tr_b16 a[140:141], v9 offset:16384
v_mfma_f32_16x16x32_bf16 v[168:171], a[20:23], a[132:135], v[168:171]
v_mfma_f32_16x16x32_bf16 v[172:175], a[24:27], a[128:131], v[172:175]
ds_read_b64_tr_b16 a[142:143], v9 offset:18432
v_mfma_f32_16x16x32_bf16 v[172:175], a[28:31], a[132:135], v[172:175]
v_mfma_f32_16x16x32_bf16 v[176:179], a[32:35], a[128:131], v[176:179]
v_mfma_f32_16x16x32_bf16 v[176:179], a[36:39], a[132:135], v[176:179]
v_mfma_f32_16x16x32_bf16 v[180:183], a[40:43], a[128:131], v[180:183]
ds_read_b128 a[108:111], v3 offset:43008
v_mfma_f32_16x16x32_bf16 v[180:183], a[44:47], a[132:135], v[180:183]
v_mfma_f32_16x16x32_bf16 v[184:187], a[48:51], a[128:131], v[184:187]
ds_read_b128 a[112:115], v2 offset:45056
v_mfma_f32_16x16x32_bf16 v[184:187], a[52:55], a[132:135], v[184:187]
v_mfma_f32_16x16x32_bf16 v[188:191], a[56:59], a[128:131], v[188:191]
v_mfma_f32_16x16x32_bf16 v[188:191], a[60:63], a[132:135], v[188:191]
s_waitcnt lgkmcnt(2)
v_mfma_f32_16x16x32_bf16 v[192:195], a[0:3], a[136:139], v[192:195]
ds_read_b64_tr_b16 a[128:129], v10 offset:0
v_mfma_f32_16x16x32_bf16 v[192:195], a[4:7], a[140:143], v[192:195]
v_mfma_f32_16x16x32_bf16 v[196:199], a[8:11], a[136:139], v[196:199]
ds_read_b64_tr_b16 a[130:131], v10 offset:2048
v_mfma_f32_16x16x32_bf16 v[196:199], a[12:15], a[140:143], v[196:199]
v_mfma_f32_16x16x32_bf16 v[200:203], a[16:19], a[136:139], v[200:203]
ds_read_b64_tr_b16 a[132:133], v10 offset:16384
v_mfma_f32_16x16x32_bf16 v[200:203], a[20:23], a[140:143], v[200:203]
buffer_store_dwordx4 a[184:187], v224, s[4:7], s56 offen sc1
v_mfma_f32_16x16x32_bf16 v[204:207], a[24:27], a[136:139], v[204:207]
s_add_u32 s56, s56, 33792
ds_read_b64_tr_b16 a[134:135], v10 offset:18432
v_mfma_f32_16x16x32_bf16 v[204:207], a[28:31], a[140:143], v[204:207]
v_mfma_f32_16x16x32_bf16 v[208:211], a[32:35], a[136:139], v[208:211]
ds_read_b128 a[116:119], v3 offset:45056
v_mfma_f32_16x16x32_bf16 v[208:211], a[36:39], a[140:143], v[208:211]
v_mfma_f32_16x16x32_bf16 v[212:215], a[40:43], a[136:139], v[212:215]
ds_read_b128 a[120:123], v2 offset:47104
v_mfma_f32_16x16x32_bf16 v[212:215], a[44:47], a[140:143], v[212:215]
v_mfma_f32_16x16x32_bf16 v[216:219], a[48:51], a[136:139], v[216:219]
v_mfma_f32_16x16x32_bf16 v[216:219], a[52:55], a[140:143], v[216:219]
v_mfma_f32_16x16x32_bf16 v[220:223], a[56:59], a[136:139], v[220:223]
ds_read_b128 a[124:127], v3 offset:47104
v_mfma_f32_16x16x32_bf16 v[220:223], a[60:63], a[140:143], v[220:223]
s_waitcnt lgkmcnt(3)
v_mfma_f32_16x16x32_bf16 a[192:195], a[0:3], a[128:131], a[192:195]
ds_read_b64_tr_b16 a[136:137], v11 offset:0
v_mfma_f32_16x16x32_bf16 a[192:195], a[4:7], a[132:135], a[192:195]
v_mfma_f32_16x16x32_bf16 a[196:199], a[8:11], a[128:131], a[196:199]
ds_read_b64_tr_b16 a[138:139], v11 offset:2048
v_mfma_f32_16x16x32_bf16 a[196:199], a[12:15], a[132:135], a[196:199]
v_mfma_f32_16x16x32_bf16 a[200:203], a[16:19], a[128:131], a[200:203]
ds_read_b64_tr_b16 a[140:141], v11 offset:16384
v_mfma_f32_16x16x32_bf16 a[200:203], a[20:23], a[132:135], a[200:203]
v_mfma_f32_16x16x32_bf16 a[204:207], a[24:27], a[128:131], a[204:207]
ds_read_b64_tr_b16 a[142:143], v11 offset:18432
v_mfma_f32_16x16x32_bf16 a[204:207], a[28:31], a[132:135], a[204:207]
buffer_store_dwordx4 a[188:191], v224, s[4:7], s56 offen sc1
v_mfma_f32_16x16x32_bf16 a[208:211], a[32:35], a[128:131], a[208:211]
s_add_u32 s56, s56, 33792
v_mfma_f32_16x16x32_bf16 a[208:211], a[36:39], a[132:135], a[208:211]
v_mfma_f32_16x16x32_bf16 a[212:215], a[40:43], a[128:131], a[212:215]
v_mfma_f32_16x16x32_bf16 a[212:215], a[44:47], a[132:135], a[212:215]
v_mfma_f32_16x16x32_bf16 a[216:219], a[48:51], a[128:131], a[216:219]
v_mfma_f32_16x16x32_bf16 a[216:219], a[52:55], a[132:135], a[216:219]
v_mfma_f32_16x16x32_bf16 a[220:223], a[56:59], a[128:131], a[220:223]
s_waitcnt vmcnt(4) lgkmcnt(0)
v_mfma_f32_16x16x32_bf16 a[220:223], a[60:63], a[132:135], a[220:223]
s_barrier
v_mfma_f32_16x16x32_bf16 a[224:227], a[0:3], a[136:139], a[224:227]
s_add_u32 m0, s29, 65536
ds_read_b64_tr_b16 a[128:129], v4 offset:32768
v_mfma_f32_16x16x32_bf16 a[224:227], a[4:7], a[140:143], a[224:227]
buffer_load_dwordx4 v16, s[12:15], s26 offen offset:0 lds
v_mfma_f32_16x16x32_bf16 a[228:231], a[8:11], a[136:139], a[228:231]
ds_read_b64_tr_b16 a[130:131], v4 offset:34816
v_cmp_gt_u32 vcc, s50, v245
v_mfma_f32_16x16x32_bf16 a[228:231], a[12:15], a[140:143], a[228:231]
v_mfma_f32_16x16x32_bf16 a[232:235], a[16:19], a[136:139], a[232:235]
ds_read_b64_tr_b16 a[132:133], v4 offset:49152
v_mfma_f32_16x16x32_bf16 a[232:235], a[20:23], a[140:143], a[232:235]
buffer_load_dwordx4 v17, s[12:15], s26 offen offset:1024 lds
v_mfma_f32_16x16x32_bf16 a[236:239], a[24:27], a[136:139], a[236:239]
ds_read_b64_tr_b16 a[134:135], v4 offset:51200
v_mfma_f32_16x16x32_bf16 a[236:239], a[28:31], a[140:143], a[236:239]
v_mfma_f32_16x16x32_bf16 a[240:243], a[32:35], a[136:139], a[240:243]
v_mfma_f32_16x16x32_bf16 a[240:243], a[36:39], a[140:143], a[240:243]
buffer_load_dwordx4 v18, s[12:15], s26 offen offset:2048 lds
v_mfma_f32_16x16x32_bf16 a[244:247], a[40:43], a[136:139], a[244:247]
v_mfma_f32_16x16x32_bf16 a[244:247], a[44:47], a[140:143], a[244:247]
v_mfma_f32_16x16x32_bf16 a[248:251], a[48:51], a[136:139], a[248:251]
v_mfma_f32_16x16x32_bf16 a[248:251], a[52:55], a[140:143], a[248:251]
buffer_load_dwordx4 v19, s[12:15], s26 offen offset:3072 lds
v_mfma_f32_16x16x32_bf16 a[252:255], a[56:59], a[136:139], a[252:255]
s_add_u32 s26, s26, 524288
v_mfma_f32_16x16x32_bf16 a[252:255], a[60:63], a[140:143], a[252:255]
s_waitcnt lgkmcnt(0)
s_mov_b32 s82, s59
s_cbranch_vccnz M_cntspinV
s_branch Lg_501
PAD_25:
s_cbranch_execz PAD_29
Lg_501t:
buffer_load_dword v230, v231, s[4:7], s52 offen sc1
v_mfma_f32_16x16x32_bf16 v[32:35], a[64:67], a[128:131], v[32:35]
s_add_u32 m0, s29, 81920
ds_read_b64_tr_b16 a[136:137], v5 offset:32768
v_mfma_f32_16x16x32_bf16 v[32:35], a[68:71], a[132:135], v[32:35]
buffer_load_dwordx4 v16, s[12:15], s27 offen offset:0 lds
v_mfma_f32_16x16x32_bf16 v[36:39], a[72:75], a[128:131], v[36:39]
s_and_b32 s44, s3, 1
ds_read_b64_tr_b16 a[138:139], v5 offset:34816
v_mfma_f32_16x16x32_bf16 v[36:39], a[76:79], a[132:135], v[36:39]
s_lshl_b32 s44, s44, 8
v_mfma_f32_16x16x32_bf16 v[40:43], a[80:83], a[128:131], v[40:43]
s_lshl_b32 s45, s3, 7
ds_read_b64_tr_b16 a[140:141], v5 offset:49152
v_mfma_f32_16x16x32_bf16 v[40:43], a[84:87], a[132:135], v[40:43]
s_xor_b32 s44, s44, s45
buffer_load_dwordx4 v17, s[12:15], s27 offen offset:1024 lds
v_mfma_f32_16x16x32_bf16 v[44:47], a[88:91], a[128:131], v[44:47]
s_xor_b32 s44, s44, 196608
ds_read_b64_tr_b16 a[142:143], v5 offset:51200
v_mfma_f32_16x16x32_bf16 v[44:47], a[92:95], a[132:135], v[44:47]
PAD_26:
s_cbranch_execz PAD_30
v_mfma_f32_16x16x32_bf16 v[48:51], a[96:99], a[128:131], v[48:51]
ds_read_b128 a[0:3], v2 offset:0
v_mfma_f32_16x16x32_bf16 v[48:51], a[100:103], a[132:135], v[48:51]
buffer_load_dwordx4 v18, s[12:15], s27 offen offset:2048 lds
v_mfma_f32_16x16x32_bf16 v[52:55], a[104:107], a[128:131], v[52:55]
ds_read_b128 a[4:7], v3 offset:0
v_mfma_f32_16x16x32_bf16 v[52:55], a[108:111], a[132:135], v[52:55]
v_mfma_f32_16x16x32_bf16 v[56:59], a[112:115], a[128:131], v[56:59]
v_mfma_f32_16x16x32_bf16 v[56:59], a[116:119], a[132:135], v[56:59]
buffer_load_dwordx4 v19, s[12:15], s27 offen offset:3072 lds
v_mfma_f32_16x16x32_bf16 v[60:63], a[120:123], a[128:131], v[60:63]
s_add_u32 s27, s27, 524288
ds_read_b128 a[8:11], v2 offset:2048
v_mfma_f32_16x16x32_bf16 v[60:63], a[124:127], a[132:135], v[60:63]
s_waitcnt lgkmcnt(3)
v_mfma_f32_16x16x32_bf16 v[64:67], a[64:67], a[136:139], v[64:67]
s_add_u32 m0, s28, 32768
ds_read_b64_tr_b16 a[128:129], v6 offset:32768
v_mfma_f32_16x16x32_bf16 v[64:67], a[68:71], a[140:143], v[64:67]
buffer_load_dwordx4 v12, s[8:11], s24 offen offset:0 lds
v_mfma_f32_16x16x32_bf16 v[68:71], a[72:75], a[136:139], v[68:71]
ds_read_b64_tr_b16 a[130:131], v6 offset:34816
v_mfma_f32_16x16x32_bf16 v[68:71], a[76:79], a[140:143], v[68:71]
v_mfma_f32_16x16x32_bf16 v[72:75], a[80:83], a[136:139], v[72:75]
s_mov_b64 s[56:57], s[72:73]
ds_read_b64_tr_b16 a[132:133], v6 offset:49152
v_mfma_f32_16x16x32_bf16 v[72:75], a[84:87], a[140:143], v[72:75]
s_mov_b32 s58, 1835008
buffer_load_dwordx4 v13, s[8:11], s24 offen offset:1024 lds
v_mfma_f32_16x16x32_bf16 v[76:79], a[88:91], a[136:139], v[76:79]
s_mov_b32 s59, 0x20000
ds_read_b64_tr_b16 a[134:135], v6 offset:51200
v_mfma_f32_16x16x32_bf16 v[76:79], a[92:95], a[140:143], v[76:79]
v_mfma_f32_16x16x32_bf16 v[80:83], a[96:99], a[136:139], v[80:83]
ds_read_b128 a[12:15], v3 offset:2048
v_mfma_f32_16x16x32_bf16 v[80:83], a[100:103], a[140:143], v[80:83]
buffer_load_dwordx4 v14, s[8:11], s24 offen offset:2048 lds
v_mfma_f32_16x16x32_bf16 v[84:87], a[104:107], a[136:139], v[84:87]
v_mfma_f32_16x16x32_bf16 v[84:87], a[108:111], a[140:143], v[84:87]
v_mfma_f32_16x16x32_bf16 v[88:91], a[112:115], a[136:139], v[88:91]
ds_read_b128 a[16:19], v2 offset:4096
v_mfma_f32_16x16x32_bf16 v[88:91], a[116:119], a[140:143], v[88:91]
buffer_load_dwordx4 v15, s[8:11], s24 offen offset:3072 lds
v_mfma_f32_16x16x32_bf16 v[92:95], a[120:123], a[136:139], v[92:95]
s_add_u32 s24, s24, 128
ds_read_b128 a[20:23], v3 offset:4096
v_mfma_f32_16x16x32_bf16 v[92:95], a[124:127], a[140:143], v[92:95]
s_waitcnt lgkmcnt(3)
v_mfma_f32_16x16x32_bf16 v[96:99], a[64:67], a[128:131], v[96:99]
s_add_u32 m0, s28, 36864
ds_read_b64_tr_b16 a[136:137], v7 offset:32768
v_mfma_f32_16x16x32_bf16 v[96:99], a[68:71], a[132:135], v[96:99]
buffer_load_dwordx4 v12, s[8:11], s25 offen offset:0 lds
v_mfma_f32_16x16x32_bf16 v[100:103], a[72:75], a[128:131], v[100:103]
ds_read_b64_tr_b16 a[138:139], v7 offset:34816
v_mfma_f32_16x16x32_bf16 v[100:103], a[76:79], a[132:135], v[100:103]
v_mfma_f32_16x16x32_bf16 v[104:107], a[80:83], a[128:131], v[104:107]
ds_read_b64_tr_b16 a[140:141], v7 offset:49152
v_mfma_f32_16x16x32_bf16 v[104:107], a[84:87], a[132:135], v[104:107]
buffer_load_dwordx4 v13, s[8:11], s25 offen offset:1024 lds
v_mfma_f32_16x16x32_bf16 v[108:111], a[88:91], a[128:131], v[108:111]
ds_read_b64_tr_b16 a[142:143], v7 offset:51200
v_mfma_f32_16x16x32_bf16 v[108:111], a[92:95], a[132:135], v[108:111]
v_mfma_f32_16x16x32_bf16 v[112:115], a[96:99], a[128:131], v[112:115]
v_mfma_f32_16x16x32_bf16 v[112:115], a[100:103], a[132:135], v[112:115]
buffer_load_dwordx4 v14, s[8:11], s25 offen offset:2048 lds
v_mfma_f32_16x16x32_bf16 v[116:119], a[104:107], a[128:131], v[116:119]
ds_read_b128 a[24:27], v2 offset:6144
v_mfma_f32_16x16x32_bf16 v[116:119], a[108:111], a[132:135], v[116:119]
v_mfma_f32_16x16x32_bf16 v[120:123], a[112:115], a[128:131], v[120:123]
ds_read_b128 a[28:31], v3 offset:6144
v_mfma_f32_16x16x32_bf16 v[120:123], a[116:119], a[132:135], v[120:123]
buffer_load_dwordx4 v15, s[8:11], s25 offen offset:3072 lds
v_mfma_f32_16x16x32_bf16 v[124:127], a[120:123], a[128:131], v[124:127]
s_add_u32 s25, s25, 128
s_waitcnt vmcnt(12)
v_mfma_f32_16x16x32_bf16 v[124:127], a[124:127], a[132:135], v[124:127]
s_waitcnt lgkmcnt(2)
v_cmp_gt_u32 vcc, 1, v230
v_mfma_f32_16x16x32_bf16 v[128:131], a[64:67], a[136:139], v[128:131]
s_cbranch_vccnz M_ppspinV
M_ppokV:
ds_read_b64_tr_b16 a[128:129], v8 offset:32768
v_mfma_f32_16x16x32_bf16 v[128:131], a[68:71], a[140:143], v[128:131]
buffer_load_dword v230, v229, s[4:7], s53 offen sc1
v_mfma_f32_16x16x32_bf16 v[132:135], a[72:75], a[136:139], v[132:135]
s_mov_b64 s[8:9], s[76:77]
ds_read_b64_tr_b16 a[130:131], v8 offset:34816
v_mfma_f32_16x16x32_bf16 v[132:135], a[76:79], a[140:143], v[132:135]
s_mov_b32 s10, 1835008
buffer_load_dword v230, v229, s[4:7], s48 offen sc1
v_mfma_f32_16x16x32_bf16 v[136:139], a[80:83], a[136:139], v[136:139]
s_lshl_b32 s24, s37, 2
ds_read_b64_tr_b16 a[132:133], v8 offset:49152
v_mfma_f32_16x16x32_bf16 v[136:139], a[84:87], a[140:143], v[136:139]
s_add_u32 s24, s24, s3
buffer_load_dword v230, v229, s[56:59], s49 offen
v_mfma_f32_16x16x32_bf16 v[140:143], a[88:91], a[136:139], v[140:143]
s_mul_i32 s24, s24, 28672
ds_read_b64_tr_b16 a[134:135], v8 offset:51200
v_mfma_f32_16x16x32_bf16 v[140:143], a[92:95], a[140:143], v[140:143]
s_mov_b32 s28, s29
buffer_load_dword v21, v20, s[16:19], s43 offen
v_mfma_f32_16x16x32_bf16 v[144:147], a[96:99], a[136:139], v[144:147]
ds_read_b128 a[32:35], v2 offset:8192
v_mfma_f32_16x16x32_bf16 v[144:147], a[100:103], a[140:143], v[144:147]
buffer_load_dword v21, v20, s[16:19], s43 offen offset:256
v_mfma_f32_16x16x32_bf16 v[148:151], a[104:107], a[136:139], v[148:151]
v_mfma_f32_16x16x32_bf16 v[148:151], a[108:111], a[140:143], v[148:151]
v_mfma_f32_16x16x32_bf16 v[152:155], a[112:115], a[136:139], v[152:155]
ds_read_b128 a[36:39], v3 offset:8192
v_lshrrev_b32 v28, 7, v1
v_mfma_f32_16x16x32_bf16 v[152:155], a[116:119], a[140:143], v[152:155]
v_lshrrev_b32 v29, 1, v28
v_lshlrev_b32 v29, 4, v29
v_mfma_f32_16x16x32_bf16 v[156:159], a[120:123], a[136:139], v[156:159]
ds_read_b128 a[40:43], v2 offset:10240
v_and_b32 v30, 0x70, v1
v_mfma_f32_16x16x32_bf16 v[156:159], a[124:127], a[140:143], v[156:159]
s_waitcnt lgkmcnt(3)
v_xor_b32 v29, v29, v30
v_mul_u32_u24 v28, 896, v28
v_mfma_f32_16x16x32_bf16 v[160:163], a[64:67], a[128:131], v[160:163]
ds_read_b64_tr_b16 a[136:137], v9 offset:32768
v_add_u32 v12, v28, v29
v_mfma_f32_16x16x32_bf16 v[160:163], a[68:71], a[132:135], v[160:163]
v_xor_b32 v29, 64, v29
v_add_u32 v28, v28, v29
v_mfma_f32_16x16x32_bf16 v[164:167], a[72:75], a[128:131], v[164:167]
ds_read_b64_tr_b16 a[138:139], v9 offset:34816
v_add_u32 v13, 6144, v28
v_mfma_f32_16x16x32_bf16 v[164:167], a[76:79], a[132:135], v[164:167]
v_add_u32 v14, 12288, v12
v_add_u32 v15, 18432, v28
v_mfma_f32_16x16x32_bf16 v[168:171], a[80:83], a[128:131], v[168:171]
ds_read_b64_tr_b16 a[140:141], v9 offset:49152
v_xor_b32 v22, s44, v4
v_mfma_f32_16x16x32_bf16 v[168:171], a[84:87], a[132:135], v[168:171]
v_xor_b32 v23, 32, v22
v_xor_b32 v24, 64, v22
v_mfma_f32_16x16x32_bf16 v[172:175], a[88:91], a[128:131], v[172:175]
ds_read_b64_tr_b16 a[142:143], v9 offset:51200
v_xor_b32 v25, 96, v22
v_mfma_f32_16x16x32_bf16 v[172:175], a[92:95], a[132:135], v[172:175]
v_mfma_f32_16x16x32_bf16 v[176:179], a[96:99], a[128:131], v[176:179]
v_mfma_f32_16x16x32_bf16 v[176:179], a[100:103], a[132:135], v[176:179]
v_mfma_f32_16x16x32_bf16 v[180:183], a[104:107], a[128:131], v[180:183]
ds_read_b128 a[44:47], v3 offset:10240
v_mfma_f32_16x16x32_bf16 v[180:183], a[108:111], a[132:135], v[180:183]
v_mfma_f32_16x16x32_bf16 v[184:187], a[112:115], a[128:131], v[184:187]
ds_read_b128 a[48:51], v2 offset:12288
v_mfma_f32_16x16x32_bf16 v[184:187], a[116:119], a[132:135], v[184:187]
v_mfma_f32_16x16x32_bf16 v[188:191], a[120:123], a[128:131], v[188:191]
v_mfma_f32_16x16x32_bf16 v[188:191], a[124:127], a[132:135], v[188:191]
s_waitcnt lgkmcnt(2)
v_mfma_f32_16x16x32_bf16 v[192:195], a[64:67], a[136:139], v[192:195]
ds_read_b64_tr_b16 a[128:129], v10 offset:32768
v_mfma_f32_16x16x32_bf16 v[192:195], a[68:71], a[140:143], v[192:195]
v_mfma_f32_16x16x32_bf16 v[196:199], a[72:75], a[136:139], v[196:199]
ds_read_b64_tr_b16 a[130:131], v10 offset:34816
v_mfma_f32_16x16x32_bf16 v[196:199], a[76:79], a[140:143], v[196:199]
v_mfma_f32_16x16x32_bf16 v[200:203], a[80:83], a[136:139], v[200:203]
ds_read_b64_tr_b16 a[132:133], v10 offset:49152
v_mfma_f32_16x16x32_bf16 v[200:203], a[84:87], a[140:143], v[200:203]
v_mfma_f32_16x16x32_bf16 v[204:207], a[88:91], a[136:139], v[204:207]
ds_read_b64_tr_b16 a[134:135], v10 offset:51200
v_mfma_f32_16x16x32_bf16 v[204:207], a[92:95], a[140:143], v[204:207]
v_mfma_f32_16x16x32_bf16 v[208:211], a[96:99], a[136:139], v[208:211]
ds_read_b128 a[52:55], v3 offset:12288
v_mfma_f32_16x16x32_bf16 v[208:211], a[100:103], a[140:143], v[208:211]
v_mfma_f32_16x16x32_bf16 v[212:215], a[104:107], a[136:139], v[212:215]
ds_read_b128 a[56:59], v2 offset:14336
v_mfma_f32_16x16x32_bf16 v[212:215], a[108:111], a[140:143], v[212:215]
v_mfma_f32_16x16x32_bf16 v[216:219], a[112:115], a[136:139], v[216:219]
v_mfma_f32_16x16x32_bf16 v[216:219], a[116:119], a[140:143], v[216:219]
v_mfma_f32_16x16x32_bf16 v[220:223], a[120:123], a[136:139], v[220:223]
ds_read_b128 a[60:63], v3 offset:14336
v_mfma_f32_16x16x32_bf16 v[220:223], a[124:127], a[140:143], v[220:223]
s_waitcnt lgkmcnt(3)
v_mfma_f32_16x16x32_bf16 a[192:195], a[64:67], a[128:131], a[192:195]
ds_read_b64_tr_b16 a[136:137], v11 offset:32768
v_mfma_f32_16x16x32_bf16 a[192:195], a[68:71], a[132:135], a[192:195]
v_mfma_f32_16x16x32_bf16 a[196:199], a[72:75], a[128:131], a[196:199]
ds_read_b64_tr_b16 a[138:139], v11 offset:34816
v_mfma_f32_16x16x32_bf16 a[196:199], a[76:79], a[132:135], a[196:199]
v_mfma_f32_16x16x32_bf16 a[200:203], a[80:83], a[128:131], a[200:203]
ds_read_b64_tr_b16 a[140:141], v11 offset:49152
v_mfma_f32_16x16x32_bf16 a[200:203], a[84:87], a[132:135], a[200:203]
v_mfma_f32_16x16x32_bf16 a[204:207], a[88:91], a[128:131], a[204:207]
ds_read_b64_tr_b16 a[142:143], v11 offset:51200
v_mfma_f32_16x16x32_bf16 a[204:207], a[92:95], a[132:135], a[204:207]
v_mfma_f32_16x16x32_bf16 a[208:211], a[96:99], a[128:131], a[208:211]
v_mfma_f32_16x16x32_bf16 a[208:211], a[100:103], a[132:135], a[208:211]
v_mfma_f32_16x16x32_bf16 a[212:215], a[104:107], a[128:131], a[212:215]
v_mfma_f32_16x16x32_bf16 a[212:215], a[108:111], a[132:135], a[212:215]
v_mfma_f32_16x16x32_bf16 a[216:219], a[112:115], a[128:131], a[216:219]
v_mfma_f32_16x16x32_bf16 a[216:219], a[116:119], a[132:135], a[216:219]
v_mfma_f32_16x16x32_bf16 a[220:223], a[120:123], a[128:131], a[220:223]
s_waitcnt vmcnt(5) lgkmcnt(0)
v_mfma_f32_16x16x32_bf16 a[220:223], a[124:127], a[132:135], a[220:223]
s_barrier
v_mfma_f32_16x16x32_bf16 a[224:227], a[64:67], a[136:139], a[224:227]
s_add_u32 m0, s29, 98304
ds_read_b64_tr_b16 a[128:129], v4 offset:0
v_mfma_f32_16x16x32_bf16 a[224:227], a[68:71], a[140:143], a[224:227]
buffer_load_dwordx4 v16, s[12:15], s26 offen offset:0 lds
v_mfma_f32_16x16x32_bf16 a[228:231], a[72:75], a[136:139], a[228:231]
ds_read_b64_tr_b16 a[130:131], v4 offset:2048
v_mfma_f32_16x16x32_bf16 a[228:231], a[76:79], a[140:143], a[228:231]
v_mfma_f32_16x16x32_bf16 a[232:235], a[80:83], a[136:139], a[232:235]
ds_read_b64_tr_b16 a[132:133], v4 offset:16384
v_mfma_f32_16x16x32_bf16 a[232:235], a[84:87], a[140:143], a[232:235]
buffer_load_dwordx4 v17, s[12:15], s26 offen offset:1024 lds
v_mfma_f32_16x16x32_bf16 a[236:239], a[88:91], a[136:139], a[236:239]
ds_read_b64_tr_b16 a[134:135], v4 offset:18432
v_mfma_f32_16x16x32_bf16 a[236:239], a[92:95], a[140:143], a[236:239]
v_mfma_f32_16x16x32_bf16 a[240:243], a[96:99], a[136:139], a[240:243]
v_mfma_f32_16x16x32_bf16 a[240:243], a[100:103], a[140:143], a[240:243]
buffer_load_dwordx4 v18, s[12:15], s26 offen offset:2048 lds
v_mfma_f32_16x16x32_bf16 a[244:247], a[104:107], a[136:139], a[244:247]
v_mfma_f32_16x16x32_bf16 a[244:247], a[108:111], a[140:143], a[244:247]
v_mfma_f32_16x16x32_bf16 a[248:251], a[112:115], a[136:139], a[248:251]
v_mfma_f32_16x16x32_bf16 a[248:251], a[116:119], a[140:143], a[248:251]
buffer_load_dwordx4 v19, s[12:15], s26 offen offset:3072 lds
v_mfma_f32_16x16x32_bf16 a[252:255], a[120:123], a[136:139], a[252:255]
s_add_u32 s26, s26, 524288
v_mfma_f32_16x16x32_bf16 a[252:255], a[124:127], a[140:143], a[252:255]
s_waitcnt lgkmcnt(0)
v_mfma_f32_16x16x32_bf16 v[32:35], a[0:3], a[128:131], v[32:35]
s_add_u32 m0, s29, 114688
ds_read_b64_tr_b16 a[136:137], v5 offset:0
v_mfma_f32_16x16x32_bf16 v[32:35], a[4:7], a[132:135], v[32:35]
buffer_load_dwordx4 v16, s[12:15], s27 offen offset:0 lds
v_mfma_f32_16x16x32_bf16 v[36:39], a[8:11], a[128:131], v[36:39]
ds_read_b64_tr_b16 a[138:139], v5 offset:2048
v_mfma_f32_16x16x32_bf16 v[36:39], a[12:15], a[132:135], v[36:39]
v_mfma_f32_16x16x32_bf16 v[40:43], a[16:19], a[128:131], v[40:43]
ds_read_b64_tr_b16 a[140:141], v5 offset:16384
v_mfma_f32_16x16x32_bf16 v[40:43], a[20:23], a[132:135], v[40:43]
buffer_load_dwordx4 v17, s[12:15], s27 offen offset:1024 lds
v_mfma_f32_16x16x32_bf16 v[44:47], a[24:27], a[128:131], v[44:47]
ds_read_b64_tr_b16 a[142:143], v5 offset:18432
v_mfma_f32_16x16x32_bf16 v[44:47], a[28:31], a[132:135], v[44:47]
v_mfma_f32_16x16x32_bf16 v[48:51], a[32:35], a[128:131], v[48:51]
ds_read_b128 a[64:67], v2 offset:32768
v_mfma_f32_16x16x32_bf16 v[48:51], a[36:39], a[132:135], v[48:51]
buffer_load_dwordx4 v18, s[12:15], s27 offen offset:2048 lds
v_mfma_f32_16x16x32_bf16 v[52:55], a[40:43], a[128:131], v[52:55]
ds_read_b128 a[68:71], v3 offset:32768
v_mfma_f32_16x16x32_bf16 v[52:55], a[44:47], a[132:135], v[52:55]
v_mfma_f32_16x16x32_bf16 v[56:59], a[48:51], a[128:131], v[56:59]
v_mfma_f32_16x16x32_bf16 v[56:59], a[52:55], a[132:135], v[56:59]
buffer_load_dwordx4 v19, s[12:15], s27 offen offset:3072 lds
v_mfma_f32_16x16x32_bf16 v[60:63], a[56:59], a[128:131], v[60:63]
s_add_u32 s27, s27, 524288
ds_read_b128 a[72:75], v2 offset:34816
v_mfma_f32_16x16x32_bf16 v[60:63], a[60:63], a[132:135], v[60:63]
s_waitcnt lgkmcnt(3)
v_mfma_f32_16x16x32_bf16 v[64:67], a[0:3], a[136:139], v[64:67]
s_add_u32 m0, s28, 0
ds_read_b64_tr_b16 a[128:129], v6 offset:0
v_mfma_f32_16x16x32_bf16 v[64:67], a[4:7], a[140:143], v[64:67]
buffer_load_dwordx4 v12, s[8:11], s24 offen offset:0 lds
v_mfma_f32_16x16x32_bf16 v[68:71], a[8:11], a[136:139], v[68:71]
ds_read_b64_tr_b16 a[130:131], v6 offset:2048
v_mfma_f32_16x16x32_bf16 v[68:71], a[12:15], a[140:143], v[68:71]
v_mfma_f32_16x16x32_bf16 v[72:75], a[16:19], a[136:139], v[72:75]
ds_read_b64_tr_b16 a[132:133], v6 offset:16384
v_mfma_f32_16x16x32_bf16 v[72:75], a[20:23], a[140:143], v[72:75]
buffer_load_dwordx4 v13, s[8:11], s24 offen offset:1024 lds
v_mfma_f32_16x16x32_bf16 v[76:79], a[24:27], a[136:139], v[76:79]
ds_read_b64_tr_b16 a[134:135], v6 offset:18432
v_mfma_f32_16x16x32_bf16 v[76:79], a[28:31], a[140:143], v[76:79]
v_mfma_f32_16x16x32_bf16 v[80:83], a[32:35], a[136:139], v[80:83]
ds_read_b128 a[76:79], v3 offset:34816
v_mfma_f32_16x16x32_bf16 v[80:83], a[36:39], a[140:143], v[80:83]
buffer_load_dwordx4 v14, s[8:11], s24 offen offset:2048 lds
v_mfma_f32_16x16x32_bf16 v[84:87], a[40:43], a[136:139], v[84:87]
v_mfma_f32_16x16x32_bf16 v[84:87], a[44:47], a[140:143], v[84:87]
v_mfma_f32_16x16x32_bf16 v[88:91], a[48:51], a[136:139], v[88:91]
ds_read_b128 a[80:83], v2 offset:36864
v_mfma_f32_16x16x32_bf16 v[88:91], a[52:55], a[140:143], v[88:91]
buffer_load_dwordx4 v15, s[8:11], s24 offen offset:3072 lds
v_mfma_f32_16x16x32_bf16 v[92:95], a[56:59], a[136:139], v[92:95]
s_add_u32 s24, s24, 128
ds_read_b128 a[84:87], v3 offset:36864
v_mfma_f32_16x16x32_bf16 v[92:95], a[60:63], a[140:143], v[92:95]
s_waitcnt lgkmcnt(3)
s_mov_b64 s[12:13], s[80:81]
v_mfma_f32_16x16x32_bf16 v[96:99], a[0:3], a[128:131], v[96:99]
s_mov_b32 s14, 3670016
s_add_u32 m0, s28, 16384
ds_read_b64_tr_b16 a[136:137], v7 offset:0
v_mfma_f32_16x16x32_bf16 v[96:99], a[4:7], a[132:135], v[96:99]
buffer_load_dwordx4 v12, s[8:11], s24 offen offset:0 lds
v_mfma_f32_16x16x32_bf16 v[100:103], a[8:11], a[128:131], v[100:103]
ds_read_b64_tr_b16 a[138:139], v7 offset:2048
v_mfma_f32_16x16x32_bf16 v[100:103], a[12:15], a[132:135], v[100:103]
v_mfma_f32_16x16x32_bf16 v[104:107], a[16:19], a[128:131], v[104:107]
ds_read_b64_tr_b16 a[140:141], v7 offset:16384
v_mfma_f32_16x16x32_bf16 v[104:107], a[20:23], a[132:135], v[104:107]
buffer_load_dwordx4 v13, s[8:11], s24 offen offset:1024 lds
v_mfma_f32_16x16x32_bf16 v[108:111], a[24:27], a[128:131], v[108:111]
ds_read_b64_tr_b16 a[142:143], v7 offset:18432
v_mfma_f32_16x16x32_bf16 v[108:111], a[28:31], a[132:135], v[108:111]
v_mfma_f32_16x16x32_bf16 v[112:115], a[32:35], a[128:131], v[112:115]
v_mfma_f32_16x16x32_bf16 v[112:115], a[36:39], a[132:135], v[112:115]
buffer_load_dwordx4 v14, s[8:11], s24 offen offset:2048 lds
v_mfma_f32_16x16x32_bf16 v[116:119], a[40:43], a[128:131], v[116:119]
ds_read_b128 a[88:91], v2 offset:38912
v_mfma_f32_16x16x32_bf16 v[116:119], a[44:47], a[132:135], v[116:119]
v_mfma_f32_16x16x32_bf16 v[120:123], a[48:51], a[128:131], v[120:123]
ds_read_b128 a[92:95], v3 offset:38912
v_mfma_f32_16x16x32_bf16 v[120:123], a[52:55], a[132:135], v[120:123]
buffer_load_dwordx4 v15, s[8:11], s24 offen offset:3072 lds
v_mfma_f32_16x16x32_bf16 v[124:127], a[56:59], a[128:131], v[124:127]
s_add_u32 s24, s24, 128
v_mfma_f32_16x16x32_bf16 v[124:127], a[60:63], a[132:135], v[124:127]
s_waitcnt lgkmcnt(2)
s_sub_u32 s26, s26, 8388608
v_mfma_f32_16x16x32_bf16 v[128:131], a[0:3], a[136:139], v[128:131]
s_sub_u32 s27, s27, 8388608
s_add_u32 m0, s29, 131072
ds_read_b64_tr_b16 a[128:129], v8 offset:0
v_mfma_f32_16x16x32_bf16 v[128:131], a[4:7], a[140:143], v[128:131]
buffer_load_dwordx4 v16, s[12:15], s26 offen offset:0 lds
v_mfma_f32_16x16x32_bf16 v[132:135], a[8:11], a[136:139], v[132:135]
ds_read_b64_tr_b16 a[130:131], v8 offset:2048
v_mfma_f32_16x16x32_bf16 v[132:135], a[12:15], a[140:143], v[132:135]
v_mfma_f32_16x16x32_bf16 v[136:139], a[16:19], a[136:139], v[136:139]
ds_read_b64_tr_b16 a[132:133], v8 offset:16384
v_mfma_f32_16x16x32_bf16 v[136:139], a[20:23], a[140:143], v[136:139]
buffer_load_dwordx4 v17, s[12:15], s26 offen offset:1024 lds
v_mfma_f32_16x16x32_bf16 v[140:143], a[24:27], a[136:139], v[140:143]
ds_read_b64_tr_b16 a[134:135], v8 offset:18432
v_mfma_f32_16x16x32_bf16 v[140:143], a[28:31], a[140:143], v[140:143]
v_mfma_f32_16x16x32_bf16 v[144:147], a[32:35], a[136:139], v[144:147]
ds_read_b128 a[96:99], v2 offset:40960
v_mfma_f32_16x16x32_bf16 v[144:147], a[36:39], a[140:143], v[144:147]
buffer_load_dwordx4 v18, s[12:15], s26 offen offset:2048 lds
v_mfma_f32_16x16x32_bf16 v[148:151], a[40:43], a[136:139], v[148:151]
v_mfma_f32_16x16x32_bf16 v[148:151], a[44:47], a[140:143], v[148:151]
v_mfma_f32_16x16x32_bf16 v[152:155], a[48:51], a[136:139], v[152:155]
ds_read_b128 a[100:103], v3 offset:40960
v_mfma_f32_16x16x32_bf16 v[152:155], a[52:55], a[140:143], v[152:155]
buffer_load_dwordx4 v19, s[12:15], s26 offen offset:3072 lds
v_mfma_f32_16x16x32_bf16 v[156:159], a[56:59], a[136:139], v[156:159]
s_add_u32 s26, s26, 524288
ds_read_b128 a[104:107], v2 offset:43008
v_mfma_f32_16x16x32_bf16 v[156:159], a[60:63], a[140:143], v[156:159]
s_waitcnt lgkmcnt(3)
v_mfma_f32_16x16x32_bf16 v[160:163], a[0:3], a[128:131], v[160:163]
s_add_u32 m0, s29, 147456
ds_read_b64_tr_b16 a[136:137], v9 offset:0
v_mfma_f32_16x16x32_bf16 v[160:163], a[4:7], a[132:135], v[160:163]
buffer_load_dwordx4 v16, s[12:15], s27 offen offset:0 lds
v_mfma_f32_16x16x32_bf16 v[164:167], a[8:11], a[128:131], v[164:167]
ds_read_b64_tr_b16 a[138:139], v9 offset:2048
v_mfma_f32_16x16x32_bf16 v[164:167], a[12:15], a[132:135], v[164:167]
v_mfma_f32_16x16x32_bf16 v[168:171], a[16:19], a[128:131], v[168:171]
ds_read_b64_tr_b16 a[140:141], v9 offset:16384
v_mfma_f32_16x16x32_bf16 v[168:171], a[20:23], a[132:135], v[168:171]
buffer_load_dwordx4 v17, s[12:15], s27 offen offset:1024 lds
v_mfma_f32_16x16x32_bf16 v[172:175], a[24:27], a[128:131], v[172:175]
ds_read_b64_tr_b16 a[142:143], v9 offset:18432
v_mfma_f32_16x16x32_bf16 v[172:175], a[28:31], a[132:135], v[172:175]
v_mfma_f32_16x16x32_bf16 v[176:179], a[32:35], a[128:131], v[176:179]
v_mfma_f32_16x16x32_bf16 v[176:179], a[36:39], a[132:135], v[176:179]
buffer_load_dwordx4 v18, s[12:15], s27 offen offset:2048 lds
v_mfma_f32_16x16x32_bf16 v[180:183], a[40:43], a[128:131], v[180:183]
ds_read_b128 a[108:111], v3 offset:43008
v_mfma_f32_16x16x32_bf16 v[180:183], a[44:47], a[132:135], v[180:183]
v_mfma_f32_16x16x32_bf16 v[184:187], a[48:51], a[128:131], v[184:187]
ds_read_b128 a[112:115], v2 offset:45056
v_mfma_f32_16x16x32_bf16 v[184:187], a[52:55], a[132:135], v[184:187]
buffer_load_dwordx4 v19, s[12:15], s27 offen offset:3072 lds
v_mfma_f32_16x16x32_bf16 v[188:191], a[56:59], a[128:131], v[188:191]
s_add_u32 s27, s27, 524288
v_mfma_f32_16x16x32_bf16 v[188:191], a[60:63], a[132:135], v[188:191]
s_waitcnt lgkmcnt(2)
v_mfma_f32_16x16x32_bf16 v[192:195], a[0:3], a[136:139], v[192:195]
ds_read_b64_tr_b16 a[128:129], v10 offset:0
v_mfma_f32_16x16x32_bf16 v[192:195], a[4:7], a[140:143], v[192:195]
v_mfma_f32_16x16x32_bf16 v[196:199], a[8:11], a[136:139], v[196:199]
ds_read_b64_tr_b16 a[130:131], v10 offset:2048
v_mfma_f32_16x16x32_bf16 v[196:199], a[12:15], a[140:143], v[196:199]
v_mfma_f32_16x16x32_bf16 v[200:203], a[16:19], a[136:139], v[200:203]
ds_read_b64_tr_b16 a[132:133], v10 offset:16384
v_mfma_f32_16x16x32_bf16 v[200:203], a[20:23], a[140:143], v[200:203]
v_mfma_f32_16x16x32_bf16 v[204:207], a[24:27], a[136:139], v[204:207]
ds_read_b64_tr_b16 a[134:135], v10 offset:18432
v_mfma_f32_16x16x32_bf16 v[204:207], a[28:31], a[140:143], v[204:207]
v_mfma_f32_16x16x32_bf16 v[208:211], a[32:35], a[136:139], v[208:211]
ds_read_b128 a[116:119], v3 offset:45056
v_mfma_f32_16x16x32_bf16 v[208:211], a[36:39], a[140:143], v[208:211]
v_mfma_f32_16x16x32_bf16 v[212:215], a[40:43], a[136:139], v[212:215]
ds_read_b128 a[120:123], v2 offset:47104
v_mfma_f32_16x16x32_bf16 v[212:215], a[44:47], a[140:143], v[212:215]
v_mfma_f32_16x16x32_bf16 v[216:219], a[48:51], a[136:139], v[216:219]
v_mfma_f32_16x16x32_bf16 v[216:219], a[52:55], a[140:143], v[216:219]
v_mfma_f32_16x16x32_bf16 v[220:223], a[56:59], a[136:139], v[220:223]
ds_read_b128 a[124:127], v3 offset:47104
v_mfma_f32_16x16x32_bf16 v[220:223], a[60:63], a[140:143], v[220:223]
s_waitcnt lgkmcnt(3)
v_mfma_f32_16x16x32_bf16 a[192:195], a[0:3], a[128:131], a[192:195]
ds_read_b64_tr_b16 a[136:137], v11 offset:0
v_mfma_f32_16x16x32_bf16 a[192:195], a[4:7], a[132:135], a[192:195]
v_mfma_f32_16x16x32_bf16 a[196:199], a[8:11], a[128:131], a[196:199]
ds_read_b64_tr_b16 a[138:139], v11 offset:2048
v_mfma_f32_16x16x32_bf16 a[196:199], a[12:15], a[132:135], a[196:199]
v_mfma_f32_16x16x32_bf16 a[200:203], a[16:19], a[128:131], a[200:203]
ds_read_b64_tr_b16 a[140:141], v11 offset:16384
v_mfma_f32_16x16x32_bf16 a[200:203], a[20:23], a[132:135], a[200:203]
v_mfma_f32_16x16x32_bf16 a[204:207], a[24:27], a[128:131], a[204:207]
ds_read_b64_tr_b16 a[142:143], v11 offset:18432
v_mfma_f32_16x16x32_bf16 a[204:207], a[28:31], a[132:135], a[204:207]
v_mfma_f32_16x16x32_bf16 a[208:211], a[32:35], a[128:131], a[208:211]
v_mfma_f32_16x16x32_bf16 a[208:211], a[36:39], a[132:135], a[208:211]
v_mfma_f32_16x16x32_bf16 a[212:215], a[40:43], a[128:131], a[212:215]
v_mfma_f32_16x16x32_bf16 a[212:215], a[44:47], a[132:135], a[212:215]
v_mfma_f32_16x16x32_bf16 a[216:219], a[48:51], a[128:131], a[216:219]
v_mfma_f32_16x16x32_bf16 a[216:219], a[52:55], a[132:135], a[216:219]
v_mfma_f32_16x16x32_bf16 a[220:223], a[56:59], a[128:131], a[220:223]
s_waitcnt vmcnt(12) lgkmcnt(0)
v_mfma_f32_16x16x32_bf16 a[220:223], a[60:63], a[132:135], a[220:223]
s_barrier
v_mfma_f32_16x16x32_bf16 a[224:227], a[0:3], a[136:139], a[224:227]
s_add_u32 m0, s28, 32768
ds_read_b64_tr_b16 a[128:129], v4 offset:32768
v_mfma_f32_16x16x32_bf16 a[224:227], a[4:7], a[140:143], a[224:227]
s_lshr_b32 s22, s3, 1
buffer_load_dwordx4 v12, s[8:11], s24 offen offset:0 lds
v_mfma_f32_16x16x32_bf16 a[228:231], a[8:11], a[136:139], a[228:231]
s_lshl_b32 s22, s22, 14
ds_read_b64_tr_b16 a[130:131], v4 offset:34816
v_subrev_u32 v2, s22, v2
v_mfma_f32_16x16x32_bf16 a[228:231], a[12:15], a[140:143], a[228:231]
v_subrev_u32 v3, s22, v3
v_mfma_f32_16x16x32_bf16 a[232:235], a[16:19], a[136:139], a[232:235]
ds_read_b64_tr_b16 a[132:133], v4 offset:49152
v_mfma_f32_16x16x32_bf16 a[232:235], a[20:23], a[140:143], a[232:235]
buffer_load_dwordx4 v13, s[8:11], s24 offen offset:1024 lds
v_mfma_f32_16x16x32_bf16 a[236:239], a[24:27], a[136:139], a[236:239]
ds_read_b64_tr_b16 a[134:135], v4 offset:51200
v_mfma_f32_16x16x32_bf16 a[236:239], a[28:31], a[140:143], a[236:239]
v_mfma_f32_16x16x32_bf16 a[240:243], a[32:35], a[136:139], a[240:243]
v_mfma_f32_16x16x32_bf16 a[240:243], a[36:39], a[140:143], a[240:243]
buffer_load_dwordx4 v14, s[8:11], s24 offen offset:2048 lds
v_mfma_f32_16x16x32_bf16 a[244:247], a[40:43], a[136:139], a[244:247]
v_mfma_f32_16x16x32_bf16 a[244:247], a[44:47], a[140:143], a[244:247]
v_mfma_f32_16x16x32_bf16 a[248:251], a[48:51], a[136:139], a[248:251]
v_mfma_f32_16x16x32_bf16 a[248:251], a[52:55], a[140:143], a[248:251]
buffer_load_dwordx4 v15, s[8:11], s24 offen offset:3072 lds
v_mfma_f32_16x16x32_bf16 a[252:255], a[56:59], a[136:139], a[252:255]
s_add_u32 s24, s24, 128
v_mfma_f32_16x16x32_bf16 a[252:255], a[60:63], a[140:143], a[252:255]
s_waitcnt lgkmcnt(0)
v_mfma_f32_16x16x32_bf16 v[32:35], a[64:67], a[128:131], v[32:35]
s_add_u32 m0, s29, 65536
ds_read_b64_tr_b16 a[136:137], v5 offset:32768
v_mfma_f32_16x16x32_bf16 v[32:35], a[68:71], a[132:135], v[32:35]
buffer_load_dwordx4 v16, s[12:15], s26 offen offset:0 lds
v_mfma_f32_16x16x32_bf16 v[36:39], a[72:75], a[128:131], v[36:39]
ds_read_b64_tr_b16 a[138:139], v5 offset:34816
v_mfma_f32_16x16x32_bf16 v[36:39], a[76:79], a[132:135], v[36:39]
v_mfma_f32_16x16x32_bf16 v[40:43], a[80:83], a[128:131], v[40:43]
ds_read_b64_tr_b16 a[140:141], v5 offset:49152
v_mfma_f32_16x16x32_bf16 v[40:43], a[84:87], a[132:135], v[40:43]
buffer_load_dwordx4 v17, s[12:15], s26 offen offset:1024 lds
v_mfma_f32_16x16x32_bf16 v[44:47], a[88:91], a[128:131], v[44:47]
ds_read_b64_tr_b16 a[142:143], v5 offset:51200
v_mfma_f32_16x16x32_bf16 v[44:47], a[92:95], a[132:135], v[44:47]
v_mfma_f32_16x16x32_bf16 v[48:51], a[96:99], a[128:131], v[48:51]
ds_read_b128 a[0:3], v2 offset:0
v_cvt_pk_bf16_f32 v32, v32, v33
v_mfma_f32_16x16x32_bf16 v[48:51], a[100:103], a[132:135], v[48:51]
buffer_load_dwordx4 v18, s[12:15], s26 offen offset:2048 lds
v_mfma_f32_16x16x32_bf16 v[52:55], a[104:107], a[128:131], v[52:55]
ds_read_b128 a[4:7], v3 offset:0
v_cvt_pk_bf16_f32 v33, v34, v35
v_mfma_f32_16x16x32_bf16 v[52:55], a[108:111], a[132:135], v[52:55]
v_cvt_pk_bf16_f32 v34, v36, v37
v_cvt_pk_bf16_f32 v35, v38, v39
v_mfma_f32_16x16x32_bf16 v[56:59], a[112:115], a[128:131], v[56:59]
v_cvt_pk_bf16_f32 v40, v40, v41
v_cvt_pk_bf16_f32 v41, v42, v43
v_mfma_f32_16x16x32_bf16 v[56:59], a[116:119], a[132:135], v[56:59]
buffer_load_dwordx4 v19, s[12:15], s26 offen offset:3072 lds
v_mfma_f32_16x16x32_bf16 v[60:63], a[120:123], a[128:131], v[60:63]
s_add_u32 s26, s26, 524288
ds_read_b128 a[8:11], v2 offset:2048
v_cvt_pk_bf16_f32 v42, v44, v45
v_mfma_f32_16x16x32_bf16 v[60:63], a[124:127], a[132:135], v[60:63]
s_waitcnt lgkmcnt(3)
v_cvt_pk_bf16_f32 v43, v46, v47
v_mfma_f32_16x16x32_bf16 v[64:67], a[64:67], a[136:139], v[64:67]
s_add_u32 m0, s29, 81920
ds_read_b64_tr_b16 a[128:129], v6 offset:32768
v_cvt_pk_bf16_f32 v48, v48, v49
v_mfma_f32_16x16x32_bf16 v[64:67], a[68:71], a[140:143], v[64:67]
buffer_load_dwordx4 v16, s[12:15], s27 offen offset:0 lds
v_mfma_f32_16x16x32_bf16 v[68:71], a[72:75], a[136:139], v[68:71]
ds_read_b64_tr_b16 a[130:131], v6 offset:34816
v_cvt_pk_bf16_f32 v49, v50, v51
v_mfma_f32_16x16x32_bf16 v[68:71], a[76:79], a[140:143], v[68:71]
v_cvt_pk_bf16_f32 v50, v52, v53
v_cvt_pk_bf16_f32 v51, v54, v55
v_mfma_f32_16x16x32_bf16 v[72:75], a[80:83], a[136:139], v[72:75]
ds_read_b64_tr_b16 a[132:133], v6 offset:49152
v_cvt_pk_bf16_f32 v56, v56, v57
v_mfma_f32_16x16x32_bf16 v[72:75], a[84:87], a[140:143], v[72:75]
buffer_load_dwordx4 v17, s[12:15], s27 offen offset:1024 lds
v_mfma_f32_16x16x32_bf16 v[76:79], a[88:91], a[136:139], v[76:79]
ds_read_b64_tr_b16 a[134:135], v6 offset:51200
v_cvt_pk_bf16_f32 v57, v58, v59
v_mfma_f32_16x16x32_bf16 v[76:79], a[92:95], a[140:143], v[76:79]
v_cvt_pk_bf16_f32 v58, v60, v61
v_cvt_pk_bf16_f32 v59, v62, v63
v_mfma_f32_16x16x32_bf16 v[80:83], a[96:99], a[136:139], v[80:83]
ds_read_b128 a[12:15], v3 offset:2048
v_cvt_pk_bf16_f32 v64, v64, v65
v_mfma_f32_16x16x32_bf16 v[80:83], a[100:103], a[140:143], v[80:83]
buffer_load_dwordx4 v18, s[12:15], s27 offen offset:2048 lds
v_mfma_f32_16x16x32_bf16 v[84:87], a[104:107], a[136:139], v[84:87]
v_cvt_pk_bf16_f32 v65, v66, v67
v_cvt_pk_bf16_f32 v66, v68, v69
v_mfma_f32_16x16x32_bf16 v[84:87], a[108:111], a[140:143], v[84:87]
v_cvt_pk_bf16_f32 v67, v70, v71
v_mfma_f32_16x16x32_bf16 v[88:91], a[112:115], a[136:139], v[88:91]
ds_read_b128 a[16:19], v2 offset:4096
v_cvt_pk_bf16_f32 v72, v72, v73
v_mfma_f32_16x16x32_bf16 v[88:91], a[116:119], a[140:143], v[88:91]
buffer_load_dwordx4 v19, s[12:15], s27 offen offset:3072 lds
v_mfma_f32_16x16x32_bf16 v[92:95], a[120:123], a[136:139], v[92:95]
PAD_27:
s_cbranch_execz PAD_31
s_add_u32 s27, s27, 524288
ds_read_b128 a[20:23], v3 offset:4096
v_cvt_pk_bf16_f32 v73, v74, v75
v_mfma_f32_16x16x32_bf16 v[92:95], a[124:127], a[140:143], v[92:95]
s_waitcnt lgkmcnt(3)
v_cvt_pk_bf16_f32 v74, v76, v77
v_cvt_pk_bf16_f32 v75, v78, v79
v_mfma_f32_16x16x32_bf16 v[96:99], a[64:67], a[128:131], v[96:99]
s_add_u32 m0, s28, 49152
ds_read_b64_tr_b16 a[136:137], v7 offset:32768
v_cvt_pk_bf16_f32 v80, v80, v81
v_mfma_f32_16x16x32_bf16 v[96:99], a[68:71], a[132:135], v[96:99]
buffer_load_dwordx4 v12, s[8:11], s24 offen offset:0 lds
v_mfma_f32_16x16x32_bf16 v[100:103], a[72:75], a[128:131], v[100:103]
ds_read_b64_tr_b16 a[138:139], v7 offset:34816
v_cvt_pk_bf16_f32 v81, v82, v83
v_mfma_f32_16x16x32_bf16 v[100:103], a[76:79], a[132:135], v[100:103]
v_cvt_pk_bf16_f32 v82, v84, v85
v_cvt_pk_bf16_f32 v83, v86, v87
v_mfma_f32_16x16x32_bf16 v[104:107], a[80:83], a[128:131], v[104:107]
ds_read_b64_tr_b16 a[140:141], v7 offset:49152
v_cvt_pk_bf16_f32 v88, v88, v89
v_mfma_f32_16x16x32_bf16 v[104:107], a[84:87], a[132:135], v[104:107]
buffer_load_dwordx4 v13, s[8:11], s24 offen offset:1024 lds
v_mfma_f32_16x16x32_bf16 v[108:111], a[88:91], a[128:131], v[108:111]
ds_read_b64_tr_b16 a[142:143], v7 offset:51200
v_cvt_pk_bf16_f32 v89, v90, v91
v_mfma_f32_16x16x32_bf16 v[108:111], a[92:95], a[132:135], v[108:111]
v_cvt_pk_bf16_f32 v90, v92, v93
v_cvt_pk_bf16_f32 v91, v94, v95
v_mfma_f32_16x16x32_bf16 v[112:115], a[96:99], a[128:131], v[112:115]
v_cvt_pk_bf16_f32 v96, v96, v97
v_cvt_pk_bf16_f32 v97, v98, v99
v_mfma_f32_16x16x32_bf16 v[112:115], a[100:103], a[132:135], v[112:115]
buffer_load_dwordx4 v14, s[8:11], s24 offen offset:2048 lds
v_mfma_f32_16x16x32_bf16 v[116:119], a[104:107], a[128:131], v[116:119]
ds_read_b128 a[24:27], v2 offset:6144
v_cvt_pk_bf16_f32 v98, v100, v101
v_mfma_f32_16x16x32_bf16 v[116:119], a[108:111], a[132:135], v[116:119]
buffer_store_dwordx4 v[32:35], v1, s[4:7], s31 offen sc1
v_mfma_f32_16x16x32_bf16 v[120:123], a[112:115], a[128:131], v[120:123]
s_add_u32 s31, s31, s32
ds_read_b128 a[28:31], v3 offset:6144
v_cvt_pk_bf16_f32 v99, v102, v103
v_mfma_f32_16x16x32_bf16 v[120:123], a[116:119], a[132:135], v[120:123]
buffer_load_dwordx4 v15, s[8:11], s24 offen offset:3072 lds
v_mfma_f32_16x16x32_bf16 v[124:127], a[120:123], a[128:131], v[124:127]
s_add_u32 s24, s24, 128
v_cvt_pk_bf16_f32 v104, v104, v105
v_cvt_pk_bf16_f32 v105, v106, v107
v_mfma_f32_16x16x32_bf16 v[124:127], a[124:127], a[132:135], v[124:127]
s_waitcnt lgkmcnt(2)
v_cvt_pk_bf16_f32 v106, v108, v109
v_cvt_pk_bf16_f32 v107, v110, v111
v_mfma_f32_16x16x32_bf16 v[128:131], a[64:67], a[136:139], v[128:131]
ds_read_b64_tr_b16 a[128:129], v8 offset:32768
v_cvt_pk_bf16_f32 v112, v112, v113
v_mfma_f32_16x16x32_bf16 v[128:131], a[68:71], a[140:143], v[128:131]
v_cvt_pk_bf16_f32 v113, v114, v115
v_cvt_pk_bf16_f32 v114, v116, v117
v_mfma_f32_16x16x32_bf16 v[132:135], a[72:75], a[136:139], v[132:135]
ds_read_b64_tr_b16 a[130:131], v8 offset:34816
v_cvt_pk_bf16_f32 v115, v118, v119
v_mfma_f32_16x16x32_bf16 v[132:135], a[76:79], a[140:143], v[132:135]
buffer_store_dwordx4 v[40:43], v1, s[4:7], s31 offen sc1
v_mfma_f32_16x16x32_bf16 v[136:139], a[80:83], a[136:139], v[136:139]
s_add_u32 s31, s31, s33
ds_read_b64_tr_b16 a[132:133], v8 offset:49152
v_cvt_pk_bf16_f32 v120, v120, v121
v_mfma_f32_16x16x32_bf16 v[136:139], a[84:87], a[140:143], v[136:139]
v_cvt_pk_bf16_f32 v121, v122, v123
v_cvt_pk_bf16_f32 v122, v124, v125
v_mfma_f32_16x16x32_bf16 v[140:143], a[88:91], a[136:139], v[140:143]
ds_read_b64_tr_b16 a[134:135], v8 offset:51200
v_cvt_pk_bf16_f32 v123, v126, v127
v_mfma_f32_16x16x32_bf16 v[140:143], a[92:95], a[140:143], v[140:143]
v_mfma_f32_16x16x32_bf16 v[144:147], a[96:99], a[136:139], v[144:147]
ds_read_b128 a[32:35], v2 offset:8192
v_cvt_pk_bf16_f32 v128, v128, v129
v_mfma_f32_16x16x32_bf16 v[144:147], a[100:103], a[140:143], v[144:147]
v_cvt_pk_bf16_f32 v129, v130, v131
v_cvt_pk_bf16_f32 v130, v132, v133
v_mfma_f32_16x16x32_bf16 v[148:151], a[104:107], a[136:139], v[148:151]
v_cvt_pk_bf16_f32 v131, v134, v135
v_mfma_f32_16x16x32_bf16 v[148:151], a[108:111], a[140:143], v[148:151]
v_mfma_f32_16x16x32_bf16 v[152:155], a[112:115], a[136:139], v[152:155]
ds_read_b128 a[36:39], v3 offset:8192
v_cvt_pk_bf16_f32 v136, v136, v137
v_mfma_f32_16x16x32_bf16 v[152:155], a[116:119], a[140:143], v[152:155]
v_cvt_pk_bf16_f32 v137, v138, v139
v_cvt_pk_bf16_f32 v138, v140, v141
v_mfma_f32_16x16x32_bf16 v[156:159], a[120:123], a[136:139], v[156:159]
ds_read_b128 a[40:43], v2 offset:10240
v_cvt_pk_bf16_f32 v139, v142, v143
v_mfma_f32_16x16x32_bf16 v[156:159], a[124:127], a[140:143], v[156:159]
s_waitcnt lgkmcnt(3)
buffer_store_dwordx4 v[48:51], v1, s[4:7], s31 offen sc1
v_mfma_f32_16x16x32_bf16 v[160:163], a[64:67], a[128:131], v[160:163]
s_add_u32 s31, s31, s32
ds_read_b64_tr_b16 a[136:137], v9 offset:32768
v_cvt_pk_bf16_f32 v144, v144, v145
v_mfma_f32_16x16x32_bf16 v[160:163], a[68:71], a[132:135], v[160:163]
v_cvt_pk_bf16_f32 v145, v146, v147
v_cvt_pk_bf16_f32 v146, v148, v149
v_mfma_f32_16x16x32_bf16 v[164:167], a[72:75], a[128:131], v[164:167]
ds_read_b64_tr_b16 a[138:139], v9 offset:34816
v_cvt_pk_bf16_f32 v147, v150, v151
v_mfma_f32_16x16x32_bf16 v[164:167], a[76:79], a[132:135], v[164:167]
v_mfma_f32_16x16x32_bf16 v[168:171], a[80:83], a[128:131], v[168:171]
ds_read_b64_tr_b16 a[140:141], v9 offset:49152
v_cvt_pk_bf16_f32 v152, v152, v153
v_mfma_f32_16x16x32_bf16 v[168:171], a[84:87], a[132:135], v[168:171]
v_cvt_pk_bf16_f32 v153, v154, v155
v_cvt_pk_bf16_f32 v154, v156, v157
v_mfma_f32_16x16x32_bf16 v[172:175], a[88:91], a[128:131], v[172:175]
ds_read_b64_tr_b16 a[142:143], v9 offset:51200
v_cvt_pk_bf16_f32 v155, v158, v159
v_mfma_f32_16x16x32_bf16 v[172:175], a[92:95], a[132:135], v[172:175]
v_mfma_f32_16x16x32_bf16 v[176:179], a[96:99], a[128:131], v[176:179]
buffer_store_dwordx4 v[56:59], v1, s[4:7], s31 offen sc1
v_mfma_f32_16x16x32_bf16 v[176:179], a[100:103], a[132:135], v[176:179]
s_add_u32 s31, s31, s34
v_cvt_pk_bf16_f32 v160, v160, v161
v_cvt_pk_bf16_f32 v161, v162, v163
v_mfma_f32_16x16x32_bf16 v[180:183], a[104:107], a[128:131], v[180:183]
ds_read_b128 a[44:47], v3 offset:10240
v_cvt_pk_bf16_f32 v162, v164, v165
v_mfma_f32_16x16x32_bf16 v[180:183], a[108:111], a[132:135], v[180:183]
v_cvt_pk_bf16_f32 v163, v166, v167
v_mfma_f32_16x16x32_bf16 v[184:187], a[112:115], a[128:131], v[184:187]
ds_read_b128 a[48:51], v2 offset:12288
v_cvt_pk_bf16_f32 v168, v168, v169
v_mfma_f32_16x16x32_bf16 v[184:187], a[116:119], a[132:135], v[184:187]
v_cvt_pk_bf16_f32 v169, v170, v171
v_cvt_pk_bf16_f32 v170, v172, v173
v_mfma_f32_16x16x32_bf16 v[188:191], a[120:123], a[128:131], v[188:191]
v_cvt_pk_bf16_f32 v171, v174, v175
v_mfma_f32_16x16x32_bf16 v[188:191], a[124:127], a[132:135], v[188:191]
s_waitcnt lgkmcnt(2)
v_mfma_f32_16x16x32_bf16 v[192:195], a[64:67], a[136:139], v[192:195]
ds_read_b64_tr_b16 a[128:129], v10 offset:32768
v_cvt_pk_bf16_f32 v176, v176, v177
v_mfma_f32_16x16x32_bf16 v[192:195], a[68:71], a[140:143], v[192:195]
v_cvt_pk_bf16_f32 v177, v178, v179
v_cvt_pk_bf16_f32 v178, v180, v181
v_mfma_f32_16x16x32_bf16 v[196:199], a[72:75], a[136:139], v[196:199]
ds_read_b64_tr_b16 a[130:131], v10 offset:34816
v_cvt_pk_bf16_f32 v179, v182, v183
v_mfma_f32_16x16x32_bf16 v[196:199], a[76:79], a[140:143], v[196:199]
buffer_store_dwordx4 v[64:67], v1, s[4:7], s31 offen sc1
v_mfma_f32_16x16x32_bf16 v[200:203], a[80:83], a[136:139], v[200:203]
s_add_u32 s31, s31, s32
ds_read_b64_tr_b16 a[132:133], v10 offset:49152
v_cvt_pk_bf16_f32 v184, v184, v185
v_mfma_f32_16x16x32_bf16 v[200:203], a[84:87], a[140:143], v[200:203]
v_cvt_pk_bf16_f32 v185, v186, v187
v_cvt_pk_bf16_f32 v186, v188, v189
v_mfma_f32_16x16x32_bf16 v[204:207], a[88:91], a[136:139], v[204:207]
ds_read_b64_tr_b16 a[134:135], v10 offset:51200
v_cvt_pk_bf16_f32 v187, v190, v191
v_mfma_f32_16x16x32_bf16 v[204:207], a[92:95], a[140:143], v[204:207]
v_mfma_f32_16x16x32_bf16 v[208:211], a[96:99], a[136:139], v[208:211]
ds_read_b128 a[52:55], v3 offset:12288
v_cvt_pk_bf16_f32 v192, v192, v193
v_mfma_f32_16x16x32_bf16 v[208:211], a[100:103], a[140:143], v[208:211]
v_cvt_pk_bf16_f32 v193, v194, v195
v_cvt_pk_bf16_f32 v194, v196, v197
v_mfma_f32_16x16x32_bf16 v[212:215], a[104:107], a[136:139], v[212:215]
ds_read_b128 a[56:59], v2 offset:14336
v_cvt_pk_bf16_f32 v195, v198, v199
v_mfma_f32_16x16x32_bf16 v[212:215], a[108:111], a[140:143], v[212:215]
v_mfma_f32_16x16x32_bf16 v[216:219], a[112:115], a[136:139], v[216:219]
v_cvt_pk_bf16_f32 v200, v200, v201
v_cvt_pk_bf16_f32 v201, v202, v203
v_mfma_f32_16x16x32_bf16 v[216:219], a[116:119], a[140:143], v[216:219]
buffer_store_dwordx4 v[72:75], v1, s[4:7], s31 offen sc1
v_mfma_f32_16x16x32_bf16 v[220:223], a[120:123], a[136:139], v[220:223]
s_add_u32 s31, s31, s33
ds_read_b128 a[60:63], v3 offset:14336
v_cvt_pk_bf16_f32 v202, v204, v205
v_mfma_f32_16x16x32_bf16 v[220:223], a[124:127], a[140:143], v[220:223]
s_waitcnt lgkmcnt(3)
v_cvt_pk_bf16_f32 v203, v206, v207
v_mfma_f32_16x16x32_bf16 a[192:195], a[64:67], a[128:131], a[192:195]
ds_read_b64_tr_b16 a[136:137], v11 offset:32768
v_cvt_pk_bf16_f32 v208, v208, v209
v_mfma_f32_16x16x32_bf16 a[192:195], a[68:71], a[132:135], a[192:195]
v_cvt_pk_bf16_f32 v209, v210, v211
v_cvt_pk_bf16_f32 v210, v212, v213
v_mfma_f32_16x16x32_bf16 a[196:199], a[72:75], a[128:131], a[196:199]
ds_read_b64_tr_b16 a[138:139], v11 offset:34816
v_cvt_pk_bf16_f32 v211, v214, v215
v_mfma_f32_16x16x32_bf16 a[196:199], a[76:79], a[132:135], a[196:199]
v_mfma_f32_16x16x32_bf16 a[200:203], a[80:83], a[128:131], a[200:203]
ds_read_b64_tr_b16 a[140:141], v11 offset:49152
v_cvt_pk_bf16_f32 v216, v216, v217
v_mfma_f32_16x16x32_bf16 a[200:203], a[84:87], a[132:135], a[200:203]
v_cvt_pk_bf16_f32 v217, v218, v219
v_cvt_pk_bf16_f32 v218, v220, v221
v_mfma_f32_16x16x32_bf16 a[204:207], a[88:91], a[128:131], a[204:207]
ds_read_b64_tr_b16 a[142:143], v11 offset:51200
v_cvt_pk_bf16_f32 v219, v222, v223
v_mfma_f32_16x16x32_bf16 a[204:207], a[92:95], a[132:135], a[204:207]
v_mfma_f32_16x16x32_bf16 a[208:211], a[96:99], a[128:131], a[208:211]
buffer_store_dwordx4 v[80:83], v1, s[4:7], s31 offen sc1
v_mfma_f32_16x16x32_bf16 a[208:211], a[100:103], a[132:135], a[208:211]
s_add_u32 s31, s31, s32
v_mfma_f32_16x16x32_bf16 a[212:215], a[104:107], a[128:131], a[212:215]
v_mfma_f32_16x16x32_bf16 a[212:215], a[108:111], a[132:135], a[212:215]
v_mfma_f32_16x16x32_bf16 a[216:219], a[112:115], a[128:131], a[216:219]
v_mfma_f32_16x16x32_bf16 a[216:219], a[116:119], a[132:135], a[216:219]
v_mfma_f32_16x16x32_bf16 a[220:223], a[120:123], a[128:131], a[220:223]
s_waitcnt vmcnt(23) lgkmcnt(0)
v_mfma_f32_16x16x32_bf16 a[220:223], a[124:127], a[132:135], a[220:223]
s_barrier
v_mfma_f32_16x16x32_bf16 a[224:227], a[64:67], a[136:139], a[224:227]
s_add_u32 m0, s29, 98304
ds_read_b64_tr_b16 a[128:129], v22 offset:0
v_mfma_f32_16x16x32_bf16 a[224:227], a[68:71], a[140:143], a[224:227]
buffer_load_dwordx4 v16, s[12:15], s26 offen offset:0 lds
v_mfma_f32_16x16x32_bf16 a[228:231], a[72:75], a[136:139], a[228:231]
ds_read_b64_tr_b16 a[130:131], v22 offset:2048
v_mfma_f32_16x16x32_bf16 a[228:231], a[76:79], a[140:143], a[228:231]
buffer_store_dwordx4 v[88:91], v1, s[4:7], s31 offen sc1
v_mfma_f32_16x16x32_bf16 a[232:235], a[80:83], a[136:139], a[232:235]
s_add_u32 s31, s31, s35
ds_read_b64_tr_b16 a[132:133], v22 offset:16384
v_mfma_f32_16x16x32_bf16 a[232:235], a[84:87], a[140:143], a[232:235]
buffer_load_dwordx4 v17, s[12:15], s26 offen offset:1024 lds
v_mfma_f32_16x16x32_bf16 a[236:239], a[88:91], a[136:139], a[236:239]
ds_read_b64_tr_b16 a[134:135], v22 offset:18432
v_add_u32 v22, 4294901760, v22
v_mfma_f32_16x16x32_bf16 a[236:239], a[92:95], a[140:143], a[236:239]
v_mfma_f32_16x16x32_bf16 a[240:243], a[96:99], a[136:139], a[240:243]
v_mfma_f32_16x16x32_bf16 a[240:243], a[100:103], a[140:143], a[240:243]
buffer_load_dwordx4 v18, s[12:15], s26 offen offset:2048 lds
v_mfma_f32_16x16x32_bf16 a[244:247], a[104:107], a[136:139], a[244:247]
v_mfma_f32_16x16x32_bf16 a[244:247], a[108:111], a[140:143], a[244:247]
v_mfma_f32_16x16x32_bf16 a[248:251], a[112:115], a[136:139], a[248:251]
v_mfma_f32_16x16x32_bf16 a[248:251], a[116:119], a[140:143], a[248:251]
buffer_load_dwordx4 v19, s[12:15], s26 offen offset:3072 lds
v_mfma_f32_16x16x32_bf16 a[252:255], a[120:123], a[136:139], a[252:255]
s_add_u32 s26, s26, 524288
v_mfma_f32_16x16x32_bf16 a[252:255], a[124:127], a[140:143], a[252:255]
s_waitcnt lgkmcnt(0)
s_cmp_ge_u32 s21, 7
s_cbranch_scc1 M_Q
M_conv:
v_mfma_f32_16x16x32_bf16 v[36:39], a[128:131], a[0:3], 0
s_add_u32 m0, s29, 114688
ds_read_b64_tr_b16 a[136:137], v23 offset:0
v_mfma_f32_16x16x32_bf16 v[36:39], a[132:135], a[4:7], v[36:39]
buffer_load_dwordx4 v16, s[12:15], s27 offen offset:0 lds
v_mfma_f32_16x16x32_bf16 v[44:47], a[128:131], a[8:11], 0
ds_read_b64_tr_b16 a[138:139], v23 offset:2048
v_mfma_f32_16x16x32_bf16 v[44:47], a[132:135], a[12:15], v[44:47]
ds_read_b128 a[64:67], v2 offset:16384
ds_read_b128 a[68:71], v3 offset:16384
v_mfma_f32_16x16x32_bf16 v[52:55], a[128:131], a[16:19], 0
ds_read_b64_tr_b16 a[140:141], v23 offset:16384
v_mfma_f32_16x16x32_bf16 v[52:55], a[132:135], a[20:23], v[52:55]
buffer_load_dwordx4 v17, s[12:15], s27 offen offset:1024 lds
v_mfma_f32_16x16x32_bf16 v[60:63], a[128:131], a[24:27], 0
ds_read_b64_tr_b16 a[142:143], v23 offset:18432
v_add_u32 v23, 4294901760, v23
v_mfma_f32_16x16x32_bf16 v[60:63], a[132:135], a[28:31], v[60:63]
buffer_store_dwordx4 v[96:99], v1, s[4:7], s31 offen sc1
v_mfma_f32_16x16x32_bf16 v[68:71], a[128:131], a[32:35], 0
s_add_u32 s31, s31, s32
ds_read_b128 a[72:75], v2 offset:18432
v_mfma_f32_16x16x32_bf16 v[68:71], a[132:135], a[36:39], v[68:71]
buffer_load_dwordx4 v18, s[12:15], s27 offen offset:2048 lds
v_mfma_f32_16x16x32_bf16 v[76:79], a[128:131], a[40:43], 0
ds_read_b128 a[76:79], v3 offset:18432
v_mfma_f32_16x16x32_bf16 v[76:79], a[132:135], a[44:47], v[76:79]
ds_read_b128 a[80:83], v2 offset:20480
v_mfma_f32_16x16x32_bf16 v[84:87], a[128:131], a[48:51], 0
ds_read_b128 a[84:87], v3 offset:20480
v_mfma_f32_16x16x32_bf16 v[84:87], a[132:135], a[52:55], v[84:87]
buffer_load_dwordx4 v19, s[12:15], s27 offen offset:3072 lds
v_mfma_f32_16x16x32_bf16 v[92:95], a[128:131], a[56:59], 0
s_add_u32 s27, s27, 524288
ds_read_b128 a[88:91], v2 offset:22528
v_mfma_f32_16x16x32_bf16 v[92:95], a[132:135], a[60:63], v[92:95]
s_waitcnt lgkmcnt(5)
buffer_store_dwordx4 v[104:107], v1, s[4:7], s31 offen sc1
v_mfma_f32_16x16x32_bf16 v[100:103], a[136:139], a[0:3], 0
s_add_u32 m0, s28, 0
ds_read_b64_tr_b16 a[128:129], v24 offset:0
v_mfma_f32_16x16x32_bf16 v[100:103], a[140:143], a[4:7], v[100:103]
s_add_u32 s31, s31, s33
buffer_load_dwordx4 v12, s[8:11], s24 offen offset:0 lds
v_mfma_f32_16x16x32_bf16 v[108:111], a[136:139], a[8:11], 0
ds_read_b64_tr_b16 a[130:131], v24 offset:2048
v_mfma_f32_16x16x32_bf16 v[108:111], a[140:143], a[12:15], v[108:111]
ds_read_b128 a[92:95], v3 offset:22528
v_mfma_f32_16x16x32_bf16 v[116:119], a[136:139], a[16:19], 0
ds_read_b64_tr_b16 a[132:133], v24 offset:16384
v_mfma_f32_16x16x32_bf16 v[116:119], a[140:143], a[20:23], v[116:119]
buffer_load_dwordx4 v13, s[8:11], s24 offen offset:1024 lds
v_mfma_f32_16x16x32_bf16 v[124:127], a[136:139], a[24:27], 0
ds_read_b64_tr_b16 a[134:135], v24 offset:18432
v_add_u32 v24, 4294901760, v24
v_mfma_f32_16x16x32_bf16 v[124:127], a[140:143], a[28:31], v[124:127]
v_mfma_f32_16x16x32_bf16 v[132:135], a[136:139], a[32:35], 0
ds_read_b128 a[96:99], v2 offset:24576
v_mfma_f32_16x16x32_bf16 v[132:135], a[140:143], a[36:39], v[132:135]
buffer_load_dwordx4 v14, s[8:11], s24 offen offset:2048 lds
v_mfma_f32_16x16x32_bf16 v[140:143], a[136:139], a[40:43], 0
ds_read_b128 a[100:103], v3 offset:24576
v_mfma_f32_16x16x32_bf16 v[140:143], a[140:143], a[44:47], v[140:143]
ds_read_b128 a[104:107], v2 offset:26624
v_mfma_f32_16x16x32_bf16 v[148:151], a[136:139], a[48:51], 0
ds_read_b128 a[108:111], v3 offset:26624
v_mfma_f32_16x16x32_bf16 v[148:151], a[140:143], a[52:55], v[148:151]
buffer_load_dwordx4 v15, s[8:11], s24 offen offset:3072 lds
v_mfma_f32_16x16x32_bf16 v[156:159], a[136:139], a[56:59], 0
s_add_u32 s24, s24, 128
ds_read_b128 a[112:115], v2 offset:28672
v_mfma_f32_16x16x32_bf16 v[156:159], a[140:143], a[60:63], v[156:159]
s_waitcnt lgkmcnt(5)
buffer_store_dwordx4 v[112:115], v1, s[4:7], s31 offen sc1
v_mfma_f32_16x16x32_bf16 v[164:167], a[128:131], a[0:3], 0
s_add_u32 s31, s31, s32
ds_read_b64_tr_b16 a[136:137], v25 offset:0
v_mfma_f32_16x16x32_bf16 v[164:167], a[132:135], a[4:7], v[164:167]
v_mfma_f32_16x16x32_bf16 v[172:175], a[128:131], a[8:11], 0
ds_read_b64_tr_b16 a[138:139], v25 offset:2048
v_mfma_f32_16x16x32_bf16 v[172:175], a[132:135], a[12:15], v[172:175]
ds_read_b128 a[116:119], v3 offset:28672
v_mfma_f32_16x16x32_bf16 v[180:183], a[128:131], a[16:19], 0
ds_read_b64_tr_b16 a[140:141], v25 offset:16384
v_mfma_f32_16x16x32_bf16 v[180:183], a[132:135], a[20:23], v[180:183]
v_mfma_f32_16x16x32_bf16 v[188:191], a[128:131], a[24:27], 0
ds_read_b64_tr_b16 a[142:143], v25 offset:18432
v_add_u32 v25, 4294901760, v25
v_mfma_f32_16x16x32_bf16 v[188:191], a[132:135], a[28:31], v[188:191]
v_mfma_f32_16x16x32_bf16 v[196:199], a[128:131], a[32:35], 0
ds_read_b128 a[120:123], v2 offset:30720
v_mfma_f32_16x16x32_bf16 v[196:199], a[132:135], a[36:39], v[196:199]
v_mfma_f32_16x16x32_bf16 v[204:207], a[128:131], a[40:43], 0
ds_read_b128 a[124:127], v3 offset:30720
v_mfma_f32_16x16x32_bf16 v[204:207], a[132:135], a[44:47], v[204:207]
v_mfma_f32_16x16x32_bf16 v[212:215], a[128:131], a[48:51], 0
v_mfma_f32_16x16x32_bf16 v[212:215], a[132:135], a[52:55], v[212:215]
buffer_store_dwordx4 v[120:123], v1, s[4:7], s31 offen sc1
v_mfma_f32_16x16x32_bf16 v[220:223], a[128:131], a[56:59], 0
s_add_u32 s31, s31, s34
v_mfma_f32_16x16x32_bf16 v[220:223], a[132:135], a[60:63], v[220:223]
s_waitcnt vmcnt(28) lgkmcnt(0)
s_barrier
v_mfma_f32_16x16x32_bf16 v[224:227], a[136:139], a[0:3], 0
s_add_u32 m0, s29, 131072
ds_read_b64_tr_b16 a[128:129], v22 offset:0
v_mfma_f32_16x16x32_bf16 v[224:227], a[140:143], a[4:7], v[224:227]
buffer_load_dwordx4 v16, s[12:15], s26 offen offset:0 lds
v_mfma_f32_16x16x32_bf16 v[228:231], a[136:139], a[8:11], 0
ds_read_b64_tr_b16 a[130:131], v22 offset:2048
v_mfma_f32_16x16x32_bf16 v[228:231], a[140:143], a[12:15], v[228:231]
v_mfma_f32_16x16x32_bf16 v[232:235], a[136:139], a[16:19], 0
ds_read_b64_tr_b16 a[132:133], v22 offset:16384
v_mfma_f32_16x16x32_bf16 v[232:235], a[140:143], a[20:23], v[232:235]
buffer_load_dwordx4 v17, s[12:15], s26 offen offset:1024 lds
v_mfma_f32_16x16x32_bf16 v[236:239], a[136:139], a[24:27], 0
ds_read_b64_tr_b16 a[134:135], v22 offset:18432
v_add_u32 v22, 32768, v22
v_mfma_f32_16x16x32_bf16 v[236:239], a[140:143], a[28:31], v[236:239]
v_mfma_f32_16x16x32_bf16 v[240:243], a[136:139], a[32:35], 0
v_mfma_f32_16x16x32_bf16 v[240:243], a[140:143], a[36:39], v[240:243]
buffer_load_dwordx4 v18, s[12:15], s26 offen offset:2048 lds
v_mfma_f32_16x16x32_bf16 v[244:247], a[136:139], a[40:43], 0
v_mfma_f32_16x16x32_bf16 v[244:247], a[140:143], a[44:47], v[244:247]
v_mfma_f32_16x16x32_bf16 v[248:251], a[136:139], a[48:51], 0
v_mfma_f32_16x16x32_bf16 v[248:251], a[140:143], a[52:55], v[248:251]
buffer_load_dwordx4 v19, s[12:15], s26 offen offset:3072 lds
v_mfma_f32_16x16x32_bf16 v[252:255], a[136:139], a[56:59], 0
s_add_u32 s26, s26, 524288
v_mfma_f32_16x16x32_bf16 v[252:255], a[140:143], a[60:63], v[252:255]
s_waitcnt lgkmcnt(0)
v_mfma_f32_16x16x32_bf16 v[36:39], a[128:131], a[64:67], v[36:39]
s_add_u32 m0, s29, 147456
ds_read_b64_tr_b16 a[136:137], v23 offset:0
v_mfma_f32_16x16x32_bf16 v[36:39], a[132:135], a[68:71], v[36:39]
buffer_load_dwordx4 v16, s[12:15], s27 offen offset:0 lds
v_mfma_f32_16x16x32_bf16 v[44:47], a[128:131], a[72:75], v[44:47]
ds_read_b64_tr_b16 a[138:139], v23 offset:2048
v_mfma_f32_16x16x32_bf16 v[44:47], a[132:135], a[76:79], v[44:47]
ds_read_b128 a[0:3], v2 offset:32768
ds_read_b128 a[4:7], v3 offset:32768
v_mfma_f32_16x16x32_bf16 v[52:55], a[128:131], a[80:83], v[52:55]
ds_read_b64_tr_b16 a[140:141], v23 offset:16384
v_mfma_f32_16x16x32_bf16 v[52:55], a[132:135], a[84:87], v[52:55]
buffer_load_dwordx4 v17, s[12:15], s27 offen offset:1024 lds
v_mfma_f32_16x16x32_bf16 v[60:63], a[128:131], a[88:91], v[60:63]
ds_read_b64_tr_b16 a[142:143], v23 offset:18432
v_add_u32 v23, 32768, v23
v_mfma_f32_16x16x32_bf16 v[60:63], a[132:135], a[92:95], v[60:63]
buffer_store_dwordx4 v[128:131], v1, s[4:7], s31 offen sc1
v_mfma_f32_16x16x32_bf16 v[68:71], a[128:131], a[96:99], v[68:71]
s_add_u32 s31, s31, s32
ds_read_b128 a[8:11], v2 offset:34816
v_accvgpr_read_b32 v32, a192
v_mfma_f32_16x16x32_bf16 v[68:71], a[132:135], a[100:103], v[68:71]
buffer_load_dwordx4 v18, s[12:15], s27 offen offset:2048 lds
v_mfma_f32_16x16x32_bf16 v[76:79], a[128:131], a[104:107], v[76:79]
ds_read_b128 a[12:15], v3 offset:34816
v_accvgpr_read_b32 v33, a193
v_mfma_f32_16x16x32_bf16 v[76:79], a[132:135], a[108:111], v[76:79]
ds_read_b128 a[16:19], v2 offset:36864
v_accvgpr_read_b32 v34, a194
v_mfma_f32_16x16x32_bf16 v[84:87], a[128:131], a[112:115], v[84:87]
ds_read_b128 a[20:23], v3 offset:36864
v_accvgpr_read_b32 v35, a195
v_mfma_f32_16x16x32_bf16 v[84:87], a[132:135], a[116:119], v[84:87]
buffer_load_dwordx4 v19, s[12:15], s27 offen offset:3072 lds
v_mfma_f32_16x16x32_bf16 v[92:95], a[128:131], a[120:123], v[92:95]
s_add_u32 s27, s27, 524288
ds_read_b128 a[24:27], v2 offset:38912
v_accvgpr_read_b32 v96, a196
v_mfma_f32_16x16x32_bf16 v[92:95], a[132:135], a[124:127], v[92:95]
s_waitcnt lgkmcnt(5)
buffer_store_dwordx4 v[136:139], v1, s[4:7], s31 offen sc1
v_mfma_f32_16x16x32_bf16 v[100:103], a[136:139], a[64:67], v[100:103]
s_add_u32 m0, s28, 16384
ds_read_b64_tr_b16 a[128:129], v24 offset:0
v_accvgpr_read_b32 v97, a197
v_mfma_f32_16x16x32_bf16 v[100:103], a[140:143], a[68:71], v[100:103]
s_add_u32 s31, s31, s33
buffer_load_dwordx4 v12, s[8:11], s24 offen offset:0 lds
v_mfma_f32_16x16x32_bf16 v[108:111], a[136:139], a[72:75], v[108:111]
ds_read_b64_tr_b16 a[130:131], v24 offset:2048
v_accvgpr_read_b32 v98, a198
v_mfma_f32_16x16x32_bf16 v[108:111], a[140:143], a[76:79], v[108:111]
ds_read_b128 a[28:31], v3 offset:38912
v_accvgpr_read_b32 v99, a199
v_mfma_f32_16x16x32_bf16 v[116:119], a[136:139], a[80:83], v[116:119]
ds_read_b64_tr_b16 a[132:133], v24 offset:16384
v_cvt_pk_bf16_f32 v32, v32, v33
v_mfma_f32_16x16x32_bf16 v[116:119], a[140:143], a[84:87], v[116:119]
buffer_load_dwordx4 v13, s[8:11], s24 offen offset:1024 lds
v_mfma_f32_16x16x32_bf16 v[124:127], a[136:139], a[88:91], v[124:127]
ds_read_b64_tr_b16 a[134:135], v24 offset:18432
v_add_u32 v24, 32768, v24
v_mfma_f32_16x16x32_bf16 v[124:127], a[140:143], a[92:95], v[124:127]
v_cvt_pk_bf16_f32 v33, v34, v35
v_cvt_pk_bf16_f32 v34, v96, v97
v_mfma_f32_16x16x32_bf16 v[132:135], a[136:139], a[96:99], v[132:135]
ds_read_b128 a[32:35], v2 offset:40960
v_cvt_pk_bf16_f32 v35, v98, v99
v_mfma_f32_16x16x32_bf16 v[132:135], a[140:143], a[100:103], v[132:135]
buffer_load_dwordx4 v14, s[8:11], s24 offen offset:2048 lds
v_mfma_f32_16x16x32_bf16 v[140:143], a[136:139], a[104:107], v[140:143]
ds_read_b128 a[36:39], v3 offset:40960
v_accvgpr_read_b32 v40, a200
v_mfma_f32_16x16x32_bf16 v[140:143], a[140:143], a[108:111], v[140:143]
ds_read_b128 a[40:43], v2 offset:43008
v_accvgpr_read_b32 v41, a201
v_mfma_f32_16x16x32_bf16 v[148:151], a[136:139], a[112:115], v[148:151]
ds_read_b128 a[44:47], v3 offset:43008
v_accvgpr_read_b32 v42, a202
v_mfma_f32_16x16x32_bf16 v[148:151], a[140:143], a[116:119], v[148:151]
buffer_load_dwordx4 v15, s[8:11], s24 offen offset:3072 lds
v_mfma_f32_16x16x32_bf16 v[156:159], a[136:139], a[120:123], v[156:159]
s_add_u32 s24, s24, 128
ds_read_b128 a[48:51], v2 offset:45056
v_accvgpr_read_b32 v43, a203
v_mfma_f32_16x16x32_bf16 v[156:159], a[140:143], a[124:127], v[156:159]
s_waitcnt lgkmcnt(5)
buffer_store_dwordx4 v[144:147], v1, s[4:7], s31 offen sc1
v_mfma_f32_16x16x32_bf16 v[164:167], a[128:131], a[64:67], v[164:167]
s_add_u32 s31, s31, s32
ds_read_b64_tr_b16 a[136:137], v25 offset:0
v_accvgpr_read_b32 v96, a204
v_mfma_f32_16x16x32_bf16 v[164:167], a[132:135], a[68:71], v[164:167]
v_accvgpr_read_b32 v97, a205
v_accvgpr_read_b32 v98, a206
v_mfma_f32_16x16x32_bf16 v[172:175], a[128:131], a[72:75], v[172:175]
ds_read_b64_tr_b16 a[138:139], v25 offset:2048
v_accvgpr_read_b32 v99, a207
v_mfma_f32_16x16x32_bf16 v[172:175], a[132:135], a[76:79], v[172:175]
ds_read_b128 a[52:55], v3 offset:45056
v_cvt_pk_bf16_f32 v40, v40, v41
v_mfma_f32_16x16x32_bf16 v[180:183], a[128:131], a[80:83], v[180:183]
ds_read_b64_tr_b16 a[140:141], v25 offset:16384
v_cvt_pk_bf16_f32 v41, v42, v43
v_mfma_f32_16x16x32_bf16 v[180:183], a[132:135], a[84:87], v[180:183]
v_cvt_pk_bf16_f32 v42, v96, v97
v_cvt_pk_bf16_f32 v43, v98, v99
v_mfma_f32_16x16x32_bf16 v[188:191], a[128:131], a[88:91], v[188:191]
ds_read_b64_tr_b16 a[142:143], v25 offset:18432
v_add_u32 v25, 32768, v25
v_mfma_f32_16x16x32_bf16 v[188:191], a[132:135], a[92:95], v[188:191]
v_accvgpr_read_b32 v48, a208
v_accvgpr_read_b32 v49, a209
v_mfma_f32_16x16x32_bf16 v[196:199], a[128:131], a[96:99], v[196:199]
ds_read_b128 a[56:59], v2 offset:47104
v_accvgpr_read_b32 v50, a210
v_mfma_f32_16x16x32_bf16 v[196:199], a[132:135], a[100:103], v[196:199]
v_accvgpr_read_b32 v51, a211
v_accvgpr_read_b32 v96, a212
v_mfma_f32_16x16x32_bf16 v[204:207], a[128:131], a[104:107], v[204:207]
ds_read_b128 a[60:63], v3 offset:47104
v_accvgpr_read_b32 v97, a213
v_mfma_f32_16x16x32_bf16 v[204:207], a[132:135], a[108:111], v[204:207]
v_accvgpr_read_b32 v98, a214
v_accvgpr_read_b32 v99, a215
v_mfma_f32_16x16x32_bf16 v[212:215], a[128:131], a[112:115], v[212:215]
v_cvt_pk_bf16_f32 v48, v48, v49
v_cvt_pk_bf16_f32 v49, v50, v51
v_mfma_f32_16x16x32_bf16 v[212:215], a[132:135], a[116:119], v[212:215]
buffer_store_dwordx4 v[152:155], v1, s[4:7], s31 offen sc1
v_mfma_f32_16x16x32_bf16 v[220:223], a[128:131], a[120:123], v[220:223]
s_add_u32 s31, s31, s36
v_cvt_pk_bf16_f32 v50, v96, v97
v_cvt_pk_bf16_f32 v51, v98, v99
v_mfma_f32_16x16x32_bf16 v[220:223], a[132:135], a[124:127], v[220:223]
s_waitcnt vmcnt(23) lgkmcnt(0)
s_barrier
v_accvgpr_read_b32 v56, a216
v_mfma_f32_16x16x32_bf16 v[224:227], a[136:139], a[64:67], v[224:227]
s_add_u32 m0, s29, 65536
ds_read_b64_tr_b16 a[128:129], v22 offset:0
v_accvgpr_read_b32 v57, a217
v_mfma_f32_16x16x32_bf16 v[224:227], a[140:143], a[68:71], v[224:227]
buffer_load_dwordx4 v16, s[12:15], s26 offen offset:0 lds
v_mfma_f32_16x16x32_bf16 v[228:231], a[136:139], a[72:75], v[228:231]
ds_read_b64_tr_b16 a[130:131], v22 offset:2048
v_accvgpr_read_b32 v58, a218
v_mfma_f32_16x16x32_bf16 v[228:231], a[140:143], a[76:79], v[228:231]
v_accvgpr_read_b32 v59, a219
v_accvgpr_read_b32 v96, a220
v_mfma_f32_16x16x32_bf16 v[232:235], a[136:139], a[80:83], v[232:235]
PAD_28:
s_cbranch_execz M_tret
ds_read_b64_tr_b16 a[132:133], v22 offset:16384
v_accvgpr_read_b32 v97, a221
v_mfma_f32_16x16x32_bf16 v[232:235], a[140:143], a[84:87], v[232:235]
buffer_load_dwordx4 v17, s[12:15], s26 offen offset:1024 lds
v_mfma_f32_16x16x32_bf16 v[236:239], a[136:139], a[88:91], v[236:239]
ds_read_b64_tr_b16 a[134:135], v22 offset:18432
v_add_u32 v22, 32768, v22
v_mfma_f32_16x16x32_bf16 v[236:239], a[140:143], a[92:95], v[236:239]
v_accvgpr_read_b32 v98, a222
v_accvgpr_read_b32 v99, a223
v_mfma_f32_16x16x32_bf16 v[240:243], a[136:139], a[96:99], v[240:243]
v_cvt_pk_bf16_f32 v56, v56, v57
v_cvt_pk_bf16_f32 v57, v58, v59
v_mfma_f32_16x16x32_bf16 v[240:243], a[140:143], a[100:103], v[240:243]
buffer_load_dwordx4 v18, s[12:15], s26 offen offset:2048 lds
v_mfma_f32_16x16x32_bf16 v[244:247], a[136:139], a[104:107], v[244:247]
v_cvt_pk_bf16_f32 v58, v96, v97
v_cvt_pk_bf16_f32 v59, v98, v99
v_mfma_f32_16x16x32_bf16 v[244:247], a[140:143], a[108:111], v[244:247]
v_accvgpr_read_b32 v64, a224
v_accvgpr_read_b32 v65, a225
v_mfma_f32_16x16x32_bf16 v[248:251], a[136:139], a[112:115], v[248:251]
v_accvgpr_read_b32 v66, a226
v_accvgpr_read_b32 v67, a227
v_mfma_f32_16x16x32_bf16 v[248:251], a[140:143], a[116:119], v[248:251]
buffer_load_dwordx4 v19, s[12:15], s26 offen offset:3072 lds
v_mfma_f32_16x16x32_bf16 v[252:255], a[136:139], a[120:123], v[252:255]
s_add_u32 s26, s26, 524288
v_accvgpr_read_b32 v96, a228
v_accvgpr_read_b32 v97, a229
v_mfma_f32_16x16x32_bf16 v[252:255], a[140:143], a[124:127], v[252:255]
s_waitcnt lgkmcnt(0)
v_accvgpr_read_b32 v98, a230
v_accvgpr_read_b32 v99, a231
v_mfma_f32_16x16x32_bf16 v[36:39], a[128:131], a[0:3], v[36:39]
s_add_u32 m0, s29, 81920
ds_read_b64_tr_b16 a[136:137], v23 offset:0
v_cvt_pk_bf16_f32 v64, v64, v65
v_mfma_f32_16x16x32_bf16 v[36:39], a[132:135], a[4:7], v[36:39]
buffer_load_dwordx4 v16, s[12:15], s27 offen offset:0 lds
v_mfma_f32_16x16x32_bf16 v[44:47], a[128:131], a[8:11], v[44:47]
ds_read_b64_tr_b16 a[138:139], v23 offset:2048
v_cvt_pk_bf16_f32 v65, v66, v67
v_mfma_f32_16x16x32_bf16 v[44:47], a[132:135], a[12:15], v[44:47]
ds_read_b128 a[64:67], v2 offset:49152
ds_read_b128 a[68:71], v3 offset:49152
v_mfma_f32_16x16x32_bf16 v[52:55], a[128:131], a[16:19], v[52:55]
ds_read_b64_tr_b16 a[140:141], v23 offset:16384
v_cvt_pk_bf16_f32 v66, v96, v97
v_mfma_f32_16x16x32_bf16 v[52:55], a[132:135], a[20:23], v[52:55]
buffer_load_dwordx4 v17, s[12:15], s27 offen offset:1024 lds
v_mfma_f32_16x16x32_bf16 v[60:63], a[128:131], a[24:27], v[60:63]
ds_read_b64_tr_b16 a[142:143], v23 offset:18432
v_add_u32 v23, 32768, v23
v_mfma_f32_16x16x32_bf16 v[60:63], a[132:135], a[28:31], v[60:63]
buffer_store_dwordx4 v[160:163], v1, s[4:7], s31 offen sc1
v_mfma_f32_16x16x32_bf16 v[68:71], a[128:131], a[32:35], v[68:71]
s_add_u32 s31, s31, s32
ds_read_b128 a[72:75], v2 offset:51200
v_cvt_pk_bf16_f32 v67, v98, v99
v_mfma_f32_16x16x32_bf16 v[68:71], a[132:135], a[36:39], v[68:71]
buffer_load_dwordx4 v18, s[12:15], s27 offen offset:2048 lds
v_mfma_f32_16x16x32_bf16 v[76:79], a[128:131], a[40:43], v[76:79]
ds_read_b128 a[76:79], v3 offset:51200
v_accvgpr_read_b32 v72, a232
v_mfma_f32_16x16x32_bf16 v[76:79], a[132:135], a[44:47], v[76:79]
ds_read_b128 a[80:83], v2 offset:53248
v_accvgpr_read_b32 v73, a233
v_mfma_f32_16x16x32_bf16 v[84:87], a[128:131], a[48:51], v[84:87]
ds_read_b128 a[84:87], v3 offset:53248
v_accvgpr_read_b32 v74, a234
v_mfma_f32_16x16x32_bf16 v[84:87], a[132:135], a[52:55], v[84:87]
buffer_load_dwordx4 v19, s[12:15], s27 offen offset:3072 lds
v_mfma_f32_16x16x32_bf16 v[92:95], a[128:131], a[56:59], v[92:95]
s_add_u32 s27, s27, 524288
ds_read_b128 a[88:91], v2 offset:55296
v_accvgpr_read_b32 v75, a235
v_mfma_f32_16x16x32_bf16 v[92:95], a[132:135], a[60:63], v[92:95]
s_waitcnt lgkmcnt(5)
buffer_store_dwordx4 v[168:171], v1, s[4:7], s31 offen sc1
v_mfma_f32_16x16x32_bf16 v[100:103], a[136:139], a[0:3], v[100:103]
s_add_u32 m0, s28, 32768
ds_read_b64_tr_b16 a[128:129], v24 offset:0
v_accvgpr_read_b32 v96, a236
v_mfma_f32_16x16x32_bf16 v[100:103], a[140:143], a[4:7], v[100:103]
s_add_u32 s31, s31, s33
buffer_load_dwordx4 v12, s[8:11], s24 offen offset:0 lds
v_mfma_f32_16x16x32_bf16 v[108:111], a[136:139], a[8:11], v[108:111]
ds_read_b64_tr_b16 a[130:131], v24 offset:2048
v_accvgpr_read_b32 v97, a237
v_mfma_f32_16x16x32_bf16 v[108:111], a[140:143], a[12:15], v[108:111]
ds_read_b128 a[92:95], v3 offset:55296
v_accvgpr_read_b32 v98, a238
v_mfma_f32_16x16x32_bf16 v[116:119], a[136:139], a[16:19], v[116:119]
ds_read_b64_tr_b16 a[132:133], v24 offset:16384
v_accvgpr_read_b32 v99, a239
v_mfma_f32_16x16x32_bf16 v[116:119], a[140:143], a[20:23], v[116:119]
buffer_load_dwordx4 v13, s[8:11], s24 offen offset:1024 lds
v_mfma_f32_16x16x32_bf16 v[124:127], a[136:139], a[24:27], v[124:127]
ds_read_b64_tr_b16 a[134:135], v24 offset:18432
v_add_u32 v24, 32768, v24
v_mfma_f32_16x16x32_bf16 v[124:127], a[140:143], a[28:31], v[124:127]
v_cvt_pk_bf16_f32 v72, v72, v73
v_cvt_pk_bf16_f32 v73, v74, v75
v_mfma_f32_16x16x32_bf16 v[132:135], a[136:139], a[32:35], v[132:135]
ds_read_b128 a[96:99], v2 offset:57344
v_cvt_pk_bf16_f32 v74, v96, v97
v_mfma_f32_16x16x32_bf16 v[132:135], a[140:143], a[36:39], v[132:135]
buffer_load_dwordx4 v14, s[8:11], s24 offen offset:2048 lds
v_mfma_f32_16x16x32_bf16 v[140:143], a[136:139], a[40:43], v[140:143]
ds_read_b128 a[100:103], v3 offset:57344
v_cvt_pk_bf16_f32 v75, v98, v99
v_mfma_f32_16x16x32_bf16 v[140:143], a[140:143], a[44:47], v[140:143]
ds_read_b128 a[104:107], v2 offset:59392
v_accvgpr_read_b32 v80, a240
v_mfma_f32_16x16x32_bf16 v[148:151], a[136:139], a[48:51], v[148:151]
ds_read_b128 a[108:111], v3 offset:59392
v_accvgpr_read_b32 v81, a241
v_mfma_f32_16x16x32_bf16 v[148:151], a[140:143], a[52:55], v[148:151]
buffer_load_dwordx4 v15, s[8:11], s24 offen offset:3072 lds
v_mfma_f32_16x16x32_bf16 v[156:159], a[136:139], a[56:59], v[156:159]
s_add_u32 s24, s24, 128
ds_read_b128 a[112:115], v2 offset:61440
v_accvgpr_read_b32 v82, a242
v_mfma_f32_16x16x32_bf16 v[156:159], a[140:143], a[60:63], v[156:159]
s_waitcnt lgkmcnt(5)
buffer_store_dwordx4 v[176:179], v1, s[4:7], s31 offen sc1
v_mfma_f32_16x16x32_bf16 v[164:167], a[128:131], a[0:3], v[164:167]
s_add_u32 s31, s31, s32
ds_read_b64_tr_b16 a[136:137], v25 offset:0
v_accvgpr_read_b32 v83, a243
v_mfma_f32_16x16x32_bf16 v[164:167], a[132:135], a[4:7], v[164:167]
v_accvgpr_read_b32 v96, a244
v_accvgpr_read_b32 v97, a245
v_mfma_f32_16x16x32_bf16 v[172:175], a[128:131], a[8:11], v[172:175]
ds_read_b64_tr_b16 a[138:139], v25 offset:2048
v_accvgpr_read_b32 v98, a246
v_mfma_f32_16x16x32_bf16 v[172:175], a[132:135], a[12:15], v[172:175]
ds_read_b128 a[116:119], v3 offset:61440
v_accvgpr_read_b32 v99, a247
v_mfma_f32_16x16x32_bf16 v[180:183], a[128:131], a[16:19], v[180:183]
ds_read_b64_tr_b16 a[140:141], v25 offset:16384
v_cvt_pk_bf16_f32 v80, v80, v81
v_mfma_f32_16x16x32_bf16 v[180:183], a[132:135], a[20:23], v[180:183]
buffer_store_dwordx4 v[184:187], v1, s[4:7], s31 offen sc1
v_mfma_f32_16x16x32_bf16 v[188:191], a[128:131], a[24:27], v[188:191]
s_add_u32 s31, s31, s34
ds_read_b64_tr_b16 a[142:143], v25 offset:18432
v_add_u32 v25, 32768, v25
v_mfma_f32_16x16x32_bf16 v[188:191], a[132:135], a[28:31], v[188:191]
v_cvt_pk_bf16_f32 v81, v82, v83
v_cvt_pk_bf16_f32 v82, v96, v97
v_mfma_f32_16x16x32_bf16 v[196:199], a[128:131], a[32:35], v[196:199]
ds_read_b128 a[120:123], v2 offset:63488
v_cvt_pk_bf16_f32 v83, v98, v99
v_mfma_f32_16x16x32_bf16 v[196:199], a[132:135], a[36:39], v[196:199]
v_accvgpr_read_b32 v88, a248
v_accvgpr_read_b32 v89, a249
v_mfma_f32_16x16x32_bf16 v[204:207], a[128:131], a[40:43], v[204:207]
ds_read_b128 a[124:127], v3 offset:63488
v_accvgpr_read_b32 v90, a250
v_mfma_f32_16x16x32_bf16 v[204:207], a[132:135], a[44:47], v[204:207]
v_accvgpr_read_b32 v91, a251
v_accvgpr_read_b32 v96, a252
v_mfma_f32_16x16x32_bf16 v[212:215], a[128:131], a[48:51], v[212:215]
v_accvgpr_read_b32 v97, a253
v_accvgpr_read_b32 v98, a254
v_mfma_f32_16x16x32_bf16 v[212:215], a[132:135], a[52:55], v[212:215]
v_accvgpr_read_b32 v99, a255
v_cvt_pk_bf16_f32 v88, v88, v89
v_mfma_f32_16x16x32_bf16 v[220:223], a[128:131], a[56:59], v[220:223]
v_cvt_pk_bf16_f32 v89, v90, v91
v_cvt_pk_bf16_f32 v90, v96, v97
v_mfma_f32_16x16x32_bf16 v[220:223], a[132:135], a[60:63], v[220:223]
s_waitcnt vmcnt(23) lgkmcnt(0)
s_barrier
v_cvt_pk_bf16_f32 v91, v98, v99
v_mfma_f32_16x16x32_bf16 v[224:227], a[136:139], a[0:3], v[224:227]
s_add_u32 m0, s29, 98304
ds_read_b64_tr_b16 a[128:129], v22 offset:0
v_mfma_f32_16x16x32_bf16 v[224:227], a[140:143], a[4:7], v[224:227]
buffer_load_dwordx4 v16, s[12:15], s26 offen offset:0 lds
v_mfma_f32_16x16x32_bf16 v[228:231], a[136:139], a[8:11], v[228:231]
ds_read_b64_tr_b16 a[130:131], v22 offset:2048
v_mfma_f32_16x16x32_bf16 v[228:231], a[140:143], a[12:15], v[228:231]
buffer_store_dwordx4 v[192:195], v1, s[4:7], s31 offen sc1
v_mfma_f32_16x16x32_bf16 v[232:235], a[136:139], a[16:19], v[232:235]
s_add_u32 s31, s31, s32
ds_read_b64_tr_b16 a[132:133], v22 offset:16384
v_mfma_f32_16x16x32_bf16 v[232:235], a[140:143], a[20:23], v[232:235]
buffer_load_dwordx4 v17, s[12:15], s26 offen offset:1024 lds
v_mfma_f32_16x16x32_bf16 v[236:239], a[136:139], a[24:27], v[236:239]
ds_read_b64_tr_b16 a[134:135], v22 offset:18432
v_add_u32 v22, 4294901760, v22
v_mfma_f32_16x16x32_bf16 v[236:239], a[140:143], a[28:31], v[236:239]
v_mfma_f32_16x16x32_bf16 v[240:243], a[136:139], a[32:35], v[240:243]
v_mfma_f32_16x16x32_bf16 v[240:243], a[140:143], a[36:39], v[240:243]
buffer_load_dwordx4 v18, s[12:15], s26 offen offset:2048 lds
v_mfma_f32_16x16x32_bf16 v[244:247], a[136:139], a[40:43], v[244:247]
v_mfma_f32_16x16x32_bf16 v[244:247], a[140:143], a[44:47], v[244:247]
v_mfma_f32_16x16x32_bf16 v[248:251], a[136:139], a[48:51], v[248:251]
v_mfma_f32_16x16x32_bf16 v[248:251], a[140:143], a[52:55], v[248:251]
buffer_load_dwordx4 v19, s[12:15], s26 offen offset:3072 lds
v_mfma_f32_16x16x32_bf16 v[252:255], a[136:139], a[56:59], v[252:255]
s_add_u32 s26, s26, 524288
v_mfma_f32_16x16x32_bf16 v[252:255], a[140:143], a[60:63], v[252:255]
s_waitcnt lgkmcnt(0)
v_mfma_f32_16x16x32_bf16 v[36:39], a[128:131], a[64:67], v[36:39]
s_add_u32 m0, s29, 114688
ds_read_b64_tr_b16 a[136:137], v23 offset:0
v_mfma_f32_16x16x32_bf16 v[36:39], a[132:135], a[68:71], v[36:39]
buffer_load_dwordx4 v16, s[12:15], s27 offen offset:0 lds
v_mfma_f32_16x16x32_bf16 v[44:47], a[128:131], a[72:75], v[44:47]
ds_read_b64_tr_b16 a[138:139], v23 offset:2048
v_mfma_f32_16x16x32_bf16 v[44:47], a[132:135], a[76:79], v[44:47]
ds_read_b128 a[0:3], v2 offset:0
ds_read_b128 a[4:7], v3 offset:0
v_mfma_f32_16x16x32_bf16 v[52:55], a[128:131], a[80:83], v[52:55]
ds_read_b64_tr_b16 a[140:141], v23 offset:16384
v_mfma_f32_16x16x32_bf16 v[52:55], a[132:135], a[84:87], v[52:55]
buffer_load_dwordx4 v17, s[12:15], s27 offen offset:1024 lds
v_mfma_f32_16x16x32_bf16 v[60:63], a[128:131], a[88:91], v[60:63]
ds_read_b64_tr_b16 a[142:143], v23 offset:18432
v_add_u32 v23, 4294901760, v23
v_mfma_f32_16x16x32_bf16 v[60:63], a[132:135], a[92:95], v[60:63]
buffer_store_dwordx4 v[200:203], v1, s[4:7], s31 offen sc1
v_mfma_f32_16x16x32_bf16 v[68:71], a[128:131], a[96:99], v[68:71]
s_add_u32 s31, s31, s33
ds_read_b128 a[8:11], v2 offset:2048
v_mfma_f32_16x16x32_bf16 v[68:71], a[132:135], a[100:103], v[68:71]
buffer_load_dwordx4 v18, s[12:15], s27 offen offset:2048 lds
v_mfma_f32_16x16x32_bf16 v[76:79], a[128:131], a[104:107], v[76:79]
ds_read_b128 a[12:15], v3 offset:2048
v_mfma_f32_16x16x32_bf16 v[76:79], a[132:135], a[108:111], v[76:79]
ds_read_b128 a[16:19], v2 offset:4096
v_mfma_f32_16x16x32_bf16 v[84:87], a[128:131], a[112:115], v[84:87]
ds_read_b128 a[20:23], v3 offset:4096
v_mfma_f32_16x16x32_bf16 v[84:87], a[132:135], a[116:119], v[84:87]
buffer_load_dwordx4 v19, s[12:15], s27 offen offset:3072 lds
v_mfma_f32_16x16x32_bf16 v[92:95], a[128:131], a[120:123], v[92:95]
s_add_u32 s27, s27, 524288
ds_read_b128 a[24:27], v2 offset:6144
v_mfma_f32_16x16x32_bf16 v[92:95], a[132:135], a[124:127], v[92:95]
s_waitcnt lgkmcnt(5)
buffer_store_dwordx4 v[208:211], v1, s[4:7], s31 offen sc1
v_mfma_f32_16x16x32_bf16 v[100:103], a[136:139], a[64:67], v[100:103]
s_add_u32 s31, s31, s32
ds_read_b64_tr_b16 a[128:129], v24 offset:0
v_mfma_f32_16x16x32_bf16 v[100:103], a[140:143], a[68:71], v[100:103]
v_mfma_f32_16x16x32_bf16 v[108:111], a[136:139], a[72:75], v[108:111]
ds_read_b64_tr_b16 a[130:131], v24 offset:2048
v_mfma_f32_16x16x32_bf16 v[108:111], a[140:143], a[76:79], v[108:111]
ds_read_b128 a[28:31], v3 offset:6144
v_mfma_f32_16x16x32_bf16 v[116:119], a[136:139], a[80:83], v[116:119]
ds_read_b64_tr_b16 a[132:133], v24 offset:16384
v_mfma_f32_16x16x32_bf16 v[116:119], a[140:143], a[84:87], v[116:119]
v_mfma_f32_16x16x32_bf16 v[124:127], a[136:139], a[88:91], v[124:127]
ds_read_b64_tr_b16 a[134:135], v24 offset:18432
v_add_u32 v24, 4294901760, v24
v_mfma_f32_16x16x32_bf16 v[124:127], a[140:143], a[92:95], v[124:127]
v_mfma_f32_16x16x32_bf16 v[132:135], a[136:139], a[96:99], v[132:135]
ds_read_b128 a[32:35], v2 offset:8192
v_mfma_f32_16x16x32_bf16 v[132:135], a[140:143], a[100:103], v[132:135]
buffer_store_dwordx4 v[216:219], v1, s[4:7], s31 offen sc1
v_mfma_f32_16x16x32_bf16 v[140:143], a[136:139], a[104:107], v[140:143]
s_add_u32 s31, s31, s35
ds_read_b128 a[36:39], v3 offset:8192
v_mfma_f32_16x16x32_bf16 v[140:143], a[140:143], a[108:111], v[140:143]
ds_read_b128 a[40:43], v2 offset:10240
v_mfma_f32_16x16x32_bf16 v[148:151], a[136:139], a[112:115], v[148:151]
ds_read_b128 a[44:47], v3 offset:10240
v_mfma_f32_16x16x32_bf16 v[148:151], a[140:143], a[116:119], v[148:151]
v_mfma_f32_16x16x32_bf16 v[156:159], a[136:139], a[120:123], v[156:159]
ds_read_b128 a[48:51], v2 offset:12288
v_mfma_f32_16x16x32_bf16 v[156:159], a[140:143], a[124:127], v[156:159]
s_waitcnt lgkmcnt(5)
v_mfma_f32_16x16x32_bf16 v[164:167], a[128:131], a[64:67], v[164:167]
ds_read_b64_tr_b16 a[136:137], v25 offset:0
v_mfma_f32_16x16x32_bf16 v[164:167], a[132:135], a[68:71], v[164:167]
v_mfma_f32_16x16x32_bf16 v[172:175], a[128:131], a[72:75], v[172:175]
ds_read_b64_tr_b16 a[138:139], v25 offset:2048
v_mfma_f32_16x16x32_bf16 v[172:175], a[132:135], a[76:79], v[172:175]
ds_read_b128 a[52:55], v3 offset:12288
v_mfma_f32_16x16x32_bf16 v[180:183], a[128:131], a[80:83], v[180:183]
ds_read_b64_tr_b16 a[140:141], v25 offset:16384
v_mfma_f32_16x16x32_bf16 v[180:183], a[132:135], a[84:87], v[180:183]
buffer_store_dwordx4 v[32:35], v1, s[4:7], s31 offen sc1
v_mfma_f32_16x16x32_bf16 v[188:191], a[128:131], a[88:91], v[188:191]
s_add_u32 s31, s31, s32
ds_read_b64_tr_b16 a[142:143], v25 offset:18432
v_add_u32 v25, 4294901760, v25
v_mfma_f32_16x16x32_bf16 v[188:191], a[132:135], a[92:95], v[188:191]
v_mfma_f32_16x16x32_bf16 v[196:199], a[128:131], a[96:99], v[196:199]
ds_read_b128 a[56:59], v2 offset:14336
v_mfma_f32_16x16x32_bf16 v[196:199], a[132:135], a[100:103], v[196:199]
v_mfma_f32_16x16x32_bf16 v[204:207], a[128:131], a[104:107], v[204:207]
ds_read_b128 a[60:63], v3 offset:14336
v_mfma_f32_16x16x32_bf16 v[204:207], a[132:135], a[108:111], v[204:207]
v_mfma_f32_16x16x32_bf16 v[212:215], a[128:131], a[112:115], v[212:215]
v_mfma_f32_16x16x32_bf16 v[212:215], a[132:135], a[116:119], v[212:215]
v_mfma_f32_16x16x32_bf16 v[220:223], a[128:131], a[120:123], v[220:223]
v_mfma_f32_16x16x32_bf16 v[220:223], a[132:135], a[124:127], v[220:223]
s_waitcnt vmcnt(20) lgkmcnt(0)
s_barrier
v_mfma_f32_16x16x32_bf16 v[224:227], a[136:139], a[64:67], v[224:227]
s_add_u32 m0, s29, 131072
ds_read_b64_tr_b16 a[128:129], v22 offset:0
v_mfma_f32_16x16x32_bf16 v[224:227], a[140:143], a[68:71], v[224:227]
buffer_load_dwordx4 v16, s[12:15], s26 offen offset:0 lds
v_mfma_f32_16x16x32_bf16 v[228:231], a[136:139], a[72:75], v[228:231]
ds_read_b64_tr_b16 a[130:131], v22 offset:2048
v_mfma_f32_16x16x32_bf16 v[228:231], a[140:143], a[76:79], v[228:231]
buffer_store_dwordx4 v[40:43], v1, s[4:7], s31 offen sc1
v_mfma_f32_16x16x32_bf16 v[232:235], a[136:139], a[80:83], v[232:235]
s_add_u32 s31, s31, s33
ds_read_b64_tr_b16 a[132:133], v22 offset:16384
v_mfma_f32_16x16x32_bf16 v[232:235], a[140:143], a[84:87], v[232:235]
buffer_load_dwordx4 v17, s[12:15], s26 offen offset:1024 lds
v_mfma_f32_16x16x32_bf16 v[236:239], a[136:139], a[88:91], v[236:239]
ds_read_b64_tr_b16 a[134:135], v22 offset:18432
v_add_u32 v22, 32768, v22
v_mfma_f32_16x16x32_bf16 v[236:239], a[140:143], a[92:95], v[236:239]
v_mfma_f32_16x16x32_bf16 v[240:243], a[136:139], a[96:99], v[240:243]
v_mfma_f32_16x16x32_bf16 v[240:243], a[140:143], a[100:103], v[240:243]
buffer_load_dwordx4 v18, s[12:15], s26 offen offset:2048 lds
v_mfma_f32_16x16x32_bf16 v[244:247], a[136:139], a[104:107], v[244:247]
v_mfma_f32_16x16x32_bf16 v[244:247], a[140:143], a[108:111], v[244:247]
v_mfma_f32_16x16x32_bf16 v[248:251], a[136:139], a[112:115], v[248:251]
v_mfma_f32_16x16x32_bf16 v[248:251], a[140:143], a[116:119], v[248:251]
buffer_load_dwordx4 v19, s[12:15], s26 offen offset:3072 lds
v_mfma_f32_16x16x32_bf16 v[252:255], a[136:139], a[120:123], v[252:255]
s_add_u32 s26, s26, 524288
v_mfma_f32_16x16x32_bf16 v[252:255], a[140:143], a[124:127], v[252:255]
s_waitcnt lgkmcnt(0)
v_mfma_f32_16x16x32_bf16 v[36:39], a[128:131], a[0:3], v[36:39]
s_add_u32 m0, s29, 147456
ds_read_b64_tr_b16 a[136:137], v23 offset:0
v_mfma_f32_16x16x32_bf16 v[36:39], a[132:135], a[4:7], v[36:39]
buffer_load_dwordx4 v16, s[12:15], s27 offen offset:0 lds
v_mfma_f32_16x16x32_bf16 v[44:47], a[128:131], a[8:11], v[44:47]
s_lshl_b32 s22, s20, 7
ds_read_b64_tr_b16 a[138:139], v23 offset:2048
v_bfe_u32 v20, v1, 4, 3
v_mfma_f32_16x16x32_bf16 v[44:47], a[132:135], a[12:15], v[44:47]
s_add_u32 s70, s22, 94371840
ds_read_b128 a[64:67], v2 offset:16384
ds_read_b128 a[68:71], v3 offset:16384
v_mfma_f32_16x16x32_bf16 v[52:55], a[128:131], a[16:19], v[52:55]
s_lshr_b32 s22, s2, 4
ds_read_b64_tr_b16 a[140:141], v23 offset:16384
v_lshlrev_b32 v20, 3, v20
v_mfma_f32_16x16x32_bf16 v[52:55], a[132:135], a[20:23], v[52:55]
s_lshl_b32 s22, s22, 2
buffer_load_dwordx4 v17, s[12:15], s27 offen offset:1024 lds
v_mfma_f32_16x16x32_bf16 v[60:63], a[128:131], a[24:27], v[60:63]
s_add_u32 s66, s70, s22
ds_read_b64_tr_b16 a[142:143], v23 offset:18432
v_add_u32 v23, 32768, v23
v_mfma_f32_16x16x32_bf16 v[60:63], a[132:135], a[28:31], v[60:63]
s_and_b32 s22, s2, 16
buffer_store_dwordx4 v[48:51], v1, s[4:7], s31 offen sc1
v_mfma_f32_16x16x32_bf16 v[68:71], a[128:131], a[32:35], v[68:71]
s_add_u32 s31, s31, s32
ds_read_b128 a[72:75], v2 offset:18432
v_add_u32 v15, 2052, v20
v_mfma_f32_16x16x32_bf16 v[68:71], a[132:135], a[36:39], v[68:71]
s_lshl_b32 s22, s22, 7
buffer_load_dwordx4 v18, s[12:15], s27 offen offset:2048 lds
v_mfma_f32_16x16x32_bf16 v[76:79], a[128:131], a[40:43], v[76:79]
s_add_u32 s66, s66, s22
ds_read_b128 a[76:79], v3 offset:18432
v_mfma_f32_16x16x32_bf16 v[76:79], a[132:135], a[44:47], v[76:79]
s_lshl_b32 s67, s20, 20
ds_read_b128 a[80:83], v2 offset:20480
v_mfma_f32_16x16x32_bf16 v[84:87], a[128:131], a[48:51], v[84:87]
s_lshl_b32 s22, s37, 16
ds_read_b128 a[84:87], v3 offset:20480
v_mfma_f32_16x16x32_bf16 v[84:87], a[132:135], a[52:55], v[84:87]
s_add_u32 s67, s67, s22
buffer_load_dwordx4 v19, s[12:15], s27 offen offset:3072 lds
v_mfma_f32_16x16x32_bf16 v[92:95], a[128:131], a[56:59], v[92:95]
s_waitcnt lgkmcnt(5)
s_add_u32 s27, s27, 524288
ds_read_b128 a[88:91], v2 offset:22528
v_mfma_f32_16x16x32_bf16 v[92:95], a[132:135], a[60:63], v[92:95]
s_lshl_b32 s22, s3, 11
buffer_store_dwordx4 v[56:59], v1, s[4:7], s31 offen sc1
v_mfma_f32_16x16x32_bf16 v[100:103], a[136:139], a[0:3], v[100:103]
s_waitcnt lgkmcnt(5)
s_add_u32 s31, s31, s34
ds_read_b64_tr_b16 a[128:129], v24 offset:0
v_mfma_f32_16x16x32_bf16 v[100:103], a[140:143], a[4:7], v[100:103]
s_add_u32 s67, s67, s22
v_mfma_f32_16x16x32_bf16 v[108:111], a[136:139], a[8:11], v[108:111]
s_add_u32 s67, s67, 33554432
ds_read_b64_tr_b16 a[130:131], v24 offset:2048
v_mfma_f32_16x16x32_bf16 v[108:111], a[140:143], a[12:15], v[108:111]
s_mov_b32 s68, 1035512379
ds_read_b128 a[92:95], v3 offset:22528
v_mfma_f32_16x16x32_bf16 v[116:119], a[136:139], a[16:19], v[116:119]
s_mov_b32 s69, 1035512379
ds_read_b64_tr_b16 a[132:133], v24 offset:16384
v_mfma_f32_16x16x32_bf16 v[116:119], a[140:143], a[20:23], v[116:119]
buffer_store_dwordx4 v[64:67], v1, s[4:7], s31 offen sc1
v_mfma_f32_16x16x32_bf16 v[124:127], a[136:139], a[24:27], v[124:127]
s_add_u32 s31, s31, s32
ds_read_b64_tr_b16 a[134:135], v24 offset:18432
v_add_u32 v24, 32768, v24
v_mfma_f32_16x16x32_bf16 v[124:127], a[140:143], a[28:31], v[124:127]
v_mfma_f32_16x16x32_bf16 v[132:135], a[136:139], a[32:35], v[132:135]
ds_read_b128 a[96:99], v2 offset:24576
v_mfma_f32_16x16x32_bf16 v[132:135], a[140:143], a[36:39], v[132:135]
v_mfma_f32_16x16x32_bf16 v[140:143], a[136:139], a[40:43], v[140:143]
ds_read_b128 a[100:103], v3 offset:24576
v_mfma_f32_16x16x32_bf16 v[140:143], a[140:143], a[44:47], v[140:143]
ds_read_b128 a[104:107], v2 offset:26624
v_mfma_f32_16x16x32_bf16 v[148:151], a[136:139], a[48:51], v[148:151]
ds_read_b128 a[108:111], v3 offset:26624
v_mfma_f32_16x16x32_bf16 v[148:151], a[140:143], a[52:55], v[148:151]
v_mfma_f32_16x16x32_bf16 v[156:159], a[136:139], a[56:59], v[156:159]
ds_read_b128 a[112:115], v2 offset:28672
v_mfma_f32_16x16x32_bf16 v[156:159], a[140:143], a[60:63], v[156:159]
s_waitcnt lgkmcnt(5)
buffer_store_dwordx4 v[72:75], v1, s[4:7], s31 offen sc1
v_mfma_f32_16x16x32_bf16 v[164:167], a[128:131], a[0:3], v[164:167]
s_add_u32 s31, s31, s33
ds_read_b64_tr_b16 a[136:137], v25 offset:0
v_mfma_f32_16x16x32_bf16 v[164:167], a[132:135], a[4:7], v[164:167]
v_mfma_f32_16x16x32_bf16 v[172:175], a[128:131], a[8:11], v[172:175]
ds_read_b64_tr_b16 a[138:139], v25 offset:2048
v_mfma_f32_16x16x32_bf16 v[172:175], a[132:135], a[12:15], v[172:175]
ds_read_b128 a[116:119], v3 offset:28672
v_mfma_f32_16x16x32_bf16 v[180:183], a[128:131], a[16:19], v[180:183]
ds_read_b64_tr_b16 a[140:141], v25 offset:16384
v_mfma_f32_16x16x32_bf16 v[180:183], a[132:135], a[20:23], v[180:183]
v_mfma_f32_16x16x32_bf16 v[188:191], a[128:131], a[24:27], v[188:191]
ds_read_b64_tr_b16 a[142:143], v25 offset:18432
v_add_u32 v25, 32768, v25
v_mfma_f32_16x16x32_bf16 v[188:191], a[132:135], a[28:31], v[188:191]
v_mfma_f32_16x16x32_bf16 v[196:199], a[128:131], a[32:35], v[196:199]
ds_read_b128 a[120:123], v2 offset:30720
v_mfma_f32_16x16x32_bf16 v[196:199], a[132:135], a[36:39], v[196:199]
buffer_store_dwordx4 v[80:83], v1, s[4:7], s31 offen sc1
v_mfma_f32_16x16x32_bf16 v[204:207], a[128:131], a[40:43], v[204:207]
s_add_u32 s31, s31, s32
ds_read_b128 a[124:127], v3 offset:30720
v_mfma_f32_16x16x32_bf16 v[204:207], a[132:135], a[44:47], v[204:207]
v_mfma_f32_16x16x32_bf16 v[212:215], a[128:131], a[48:51], v[212:215]
v_mfma_f32_16x16x32_bf16 v[212:215], a[132:135], a[52:55], v[212:215]
v_mfma_f32_16x16x32_bf16 v[220:223], a[128:131], a[56:59], v[220:223]
v_mfma_f32_16x16x32_bf16 v[220:223], a[132:135], a[60:63], v[220:223]
s_waitcnt vmcnt(17) lgkmcnt(0)
s_barrier
v_mfma_f32_16x16x32_bf16 v[224:227], a[136:139], a[0:3], v[224:227]
ds_read_b64_tr_b16 a[128:129], v22 offset:0
v_mfma_f32_16x16x32_bf16 v[224:227], a[140:143], a[4:7], v[224:227]
v_mfma_f32_16x16x32_bf16 v[228:231], a[136:139], a[8:11], v[228:231]
ds_read_b64_tr_b16 a[130:131], v22 offset:2048
v_mfma_f32_16x16x32_bf16 v[228:231], a[140:143], a[12:15], v[228:231]
buffer_store_dwordx4 v[88:91], v1, s[4:7], s31 offen sc1
v_mfma_f32_16x16x32_bf16 v[232:235], a[136:139], a[16:19], v[232:235]
ds_read_b64_tr_b16 a[132:133], v22 offset:16384
v_mfma_f32_16x16x32_bf16 v[232:235], a[140:143], a[20:23], v[232:235]
v_mfma_f32_16x16x32_bf16 v[236:239], a[136:139], a[24:27], v[236:239]
ds_read_b64_tr_b16 a[134:135], v22 offset:18432
v_add_u32 v22, 32768, v22
v_mfma_f32_16x16x32_bf16 v[236:239], a[140:143], a[28:31], v[236:239]
v_mfma_f32_16x16x32_bf16 v[240:243], a[136:139], a[32:35], v[240:243]
v_mfma_f32_16x16x32_bf16 v[240:243], a[140:143], a[36:39], v[240:243]
v_mfma_f32_16x16x32_bf16 v[244:247], a[136:139], a[40:43], v[244:247]
v_mfma_f32_16x16x32_bf16 v[244:247], a[140:143], a[44:47], v[244:247]
v_mfma_f32_16x16x32_bf16 v[248:251], a[136:139], a[48:51], v[248:251]
v_mfma_f32_16x16x32_bf16 v[248:251], a[140:143], a[52:55], v[248:251]
v_mfma_f32_16x16x32_bf16 v[252:255], a[136:139], a[56:59], v[252:255]
v_mfma_f32_16x16x32_bf16 v[252:255], a[140:143], a[60:63], v[252:255]
s_waitcnt lgkmcnt(0)
v_mfma_f32_16x16x32_bf16 v[36:39], a[128:131], a[64:67], v[36:39]
ds_read_b64_tr_b16 a[136:137], v23 offset:0
v_and_b32 v14, 128, v1
v_mfma_f32_16x16x32_bf16 v[36:39], a[132:135], a[68:71], v[36:39]
v_mul_u32_u24 v14, 2, v14
v_add_u32 v20, v14, v20
v_mfma_f32_16x16x32_bf16 v[44:47], a[128:131], a[72:75], v[44:47]
s_mul_i32 s85, s20, 7
ds_read_b64_tr_b16 a[138:139], v23 offset:2048
v_add_u32 v15, v14, v15
v_mfma_f32_16x16x32_bf16 v[44:47], a[132:135], a[76:79], v[44:47]
s_add_u32 s85, s85, s21
ds_read_b128 a[0:3], v2 offset:32768
ds_read_b128 a[4:7], v3 offset:32768
v_mfma_f32_16x16x32_bf16 v[52:55], a[128:131], a[80:83], v[52:55]
s_lshl_b32 s85, s85, 2
ds_read_b64_tr_b16 a[140:141], v23 offset:16384
v_mfma_f32_16x16x32_bf16 v[52:55], a[132:135], a[84:87], v[52:55]
s_add_u32 s85, s85, s3
v_mfma_f32_16x16x32_bf16 v[60:63], a[128:131], a[88:91], v[60:63]
s_mul_i32 s82, s85, 4224
ds_read_b64_tr_b16 a[142:143], v23 offset:18432
v_add_u32 v23, 32768, v23
v_mfma_f32_16x16x32_bf16 v[60:63], a[132:135], a[92:95], v[60:63]
s_add_u32 s82, s82, 83886208
v_mfma_f32_16x16x32_bf16 v[68:71], a[128:131], a[96:99], v[68:71]
s_lshl_b32 s83, s85, 12
ds_read_b128 a[8:11], v2 offset:34816
v_mfma_f32_16x16x32_bf16 v[68:71], a[132:135], a[100:103], v[68:71]
s_mul_i32 s84, s3, 21248
v_mfma_f32_16x16x32_bf16 v[76:79], a[128:131], a[104:107], v[76:79]
s_add_u32 s84, s84, 46080
ds_read_b128 a[12:15], v3 offset:34816
v_mfma_f32_16x16x32_bf16 v[76:79], a[132:135], a[108:111], v[76:79]
s_mov_b64 s[60:61], s[72:73]
ds_read_b128 a[16:19], v2 offset:36864
v_mfma_f32_16x16x32_bf16 v[84:87], a[128:131], a[112:115], v[84:87]
s_mov_b32 s62, 1835008
ds_read_b128 a[20:23], v3 offset:36864
v_mfma_f32_16x16x32_bf16 v[84:87], a[132:135], a[116:119], v[84:87]
v_mfma_f32_16x16x32_bf16 v[92:95], a[128:131], a[120:123], v[92:95]
ds_read_b128 a[24:27], v2 offset:38912
v_mfma_f32_16x16x32_bf16 v[92:95], a[132:135], a[124:127], v[92:95]
s_waitcnt lgkmcnt(5)
v_mfma_f32_16x16x32_bf16 v[100:103], a[136:139], a[64:67], v[100:103]
ds_read_b64_tr_b16 a[128:129], v24 offset:0
v_mfma_f32_16x16x32_bf16 v[100:103], a[140:143], a[68:71], v[100:103]
v_mfma_f32_16x16x32_bf16 v[108:111], a[136:139], a[72:75], v[108:111]
ds_read_b64_tr_b16 a[130:131], v24 offset:2048
v_mfma_f32_16x16x32_bf16 v[108:111], a[140:143], a[76:79], v[108:111]
ds_read_b128 a[28:31], v3 offset:38912
v_mfma_f32_16x16x32_bf16 v[116:119], a[136:139], a[80:83], v[116:119]
ds_read_b64_tr_b16 a[132:133], v24 offset:16384
v_mfma_f32_16x16x32_bf16 v[116:119], a[140:143], a[84:87], v[116:119]
v_mfma_f32_16x16x32_bf16 v[124:127], a[136:139], a[88:91], v[124:127]
ds_read_b64_tr_b16 a[134:135], v24 offset:18432
v_add_u32 v24, 32768, v24
v_mfma_f32_16x16x32_bf16 v[124:127], a[140:143], a[92:95], v[124:127]
v_mfma_f32_16x16x32_bf16 v[132:135], a[136:139], a[96:99], v[132:135]
ds_read_b128 a[32:35], v2 offset:40960
v_mfma_f32_16x16x32_bf16 v[132:135], a[140:143], a[100:103], v[132:135]
v_mfma_f32_16x16x32_bf16 v[140:143], a[136:139], a[104:107], v[140:143]
ds_read_b128 a[36:39], v3 offset:40960
v_mfma_f32_16x16x32_bf16 v[140:143], a[140:143], a[108:111], v[140:143]
ds_read_b128 a[40:43], v2 offset:43008
v_mfma_f32_16x16x32_bf16 v[148:151], a[136:139], a[112:115], v[148:151]
ds_read_b128 a[44:47], v3 offset:43008
v_mfma_f32_16x16x32_bf16 v[148:151], a[140:143], a[116:119], v[148:151]
PAD_29:
s_cbranch_execz M_tret
v_mfma_f32_16x16x32_bf16 v[156:159], a[136:139], a[120:123], v[156:159]
s_andn2_b32 s31, s70, 256
ds_read_b128 a[48:51], v2 offset:45056
v_mfma_f32_16x16x32_bf16 v[156:159], a[140:143], a[124:127], v[156:159]
s_waitcnt lgkmcnt(5)
v_mfma_f32_16x16x32_bf16 v[164:167], a[128:131], a[64:67], v[164:167]
ds_read_b64_tr_b16 a[136:137], v25 offset:0
v_mfma_f32_16x16x32_bf16 v[164:167], a[132:135], a[68:71], v[164:167]
v_mfma_f32_16x16x32_bf16 v[172:175], a[128:131], a[72:75], v[172:175]
ds_read_b64_tr_b16 a[138:139], v25 offset:2048
v_mfma_f32_16x16x32_bf16 v[172:175], a[132:135], a[76:79], v[172:175]
ds_read_b128 a[52:55], v3 offset:45056
v_mfma_f32_16x16x32_bf16 v[180:183], a[128:131], a[80:83], v[180:183]
ds_read_b64_tr_b16 a[140:141], v25 offset:16384
v_mfma_f32_16x16x32_bf16 v[180:183], a[132:135], a[84:87], v[180:183]
v_mfma_f32_16x16x32_bf16 v[188:191], a[128:131], a[88:91], v[188:191]
ds_read_b64_tr_b16 a[142:143], v25 offset:18432
v_add_u32 v25, 32768, v25
v_mfma_f32_16x16x32_bf16 v[188:191], a[132:135], a[92:95], v[188:191]
v_mfma_f32_16x16x32_bf16 v[196:199], a[128:131], a[96:99], v[196:199]
ds_read_b128 a[56:59], v2 offset:47104
v_mfma_f32_16x16x32_bf16 v[196:199], a[132:135], a[100:103], v[196:199]
v_mfma_f32_16x16x32_bf16 v[204:207], a[128:131], a[104:107], v[204:207]
ds_read_b128 a[60:63], v3 offset:47104
v_mfma_f32_16x16x32_bf16 v[204:207], a[132:135], a[108:111], v[204:207]
v_mfma_f32_16x16x32_bf16 v[212:215], a[128:131], a[112:115], v[212:215]
v_mfma_f32_16x16x32_bf16 v[212:215], a[132:135], a[116:119], v[212:215]
v_mfma_f32_16x16x32_bf16 v[220:223], a[128:131], a[120:123], v[220:223]
v_mfma_f32_16x16x32_bf16 v[220:223], a[132:135], a[124:127], v[220:223]
s_waitcnt vmcnt(0) lgkmcnt(0)
s_barrier
v_mfma_f32_16x16x32_bf16 v[224:227], a[136:139], a[64:67], v[224:227]
ds_read_b64_tr_b16 a[128:129], v22 offset:0
v_mfma_f32_16x16x32_bf16 v[224:227], a[140:143], a[68:71], v[224:227]
buffer_store_dword v27, v26, s[4:7], s66 offen sc1
v_mfma_f32_16x16x32_bf16 v[228:231], a[136:139], a[72:75], v[228:231]
ds_read_b64_tr_b16 a[130:131], v22 offset:2048
v_mfma_f32_16x16x32_bf16 v[228:231], a[140:143], a[76:79], v[228:231]
v_mfma_f32_16x16x32_bf16 v[232:235], a[136:139], a[80:83], v[232:235]
ds_read_b64_tr_b16 a[132:133], v22 offset:16384
v_mfma_f32_16x16x32_bf16 v[232:235], a[140:143], a[84:87], v[232:235]
v_mfma_f32_16x16x32_bf16 v[236:239], a[136:139], a[88:91], v[236:239]
ds_read_b64_tr_b16 a[134:135], v22 offset:18432
v_mfma_f32_16x16x32_bf16 v[236:239], a[140:143], a[92:95], v[236:239]
v_mfma_f32_16x16x32_bf16 v[240:243], a[136:139], a[96:99], v[240:243]
v_mfma_f32_16x16x32_bf16 v[240:243], a[140:143], a[100:103], v[240:243]
v_mfma_f32_16x16x32_bf16 v[244:247], a[136:139], a[104:107], v[244:247]
v_mfma_f32_16x16x32_bf16 v[244:247], a[140:143], a[108:111], v[244:247]
v_mfma_f32_16x16x32_bf16 v[248:251], a[136:139], a[112:115], v[248:251]
v_mfma_f32_16x16x32_bf16 v[248:251], a[140:143], a[116:119], v[248:251]
v_mfma_f32_16x16x32_bf16 v[252:255], a[136:139], a[120:123], v[252:255]
v_mfma_f32_16x16x32_bf16 v[252:255], a[140:143], a[124:127], v[252:255]
s_waitcnt lgkmcnt(0)
v_mfma_f32_16x16x32_bf16 v[36:39], a[128:131], a[0:3], v[36:39]
s_add_u32 m0, s84, 17152
ds_read_b64_tr_b16 a[136:137], v23 offset:0
v_lshrrev_b32 v9, 4, v1
v_mfma_f32_16x16x32_bf16 v[36:39], a[132:135], a[4:7], v[36:39]
buffer_load_dwordx4 v1, s[60:63], s83 offen offset:0 lds
v_mfma_f32_16x16x32_bf16 v[44:47], a[128:131], a[8:11], v[44:47]
ds_read_b64_tr_b16 a[138:139], v23 offset:2048
v_and_b32 v10, 15, v9
v_mfma_f32_16x16x32_bf16 v[44:47], a[132:135], a[12:15], v[44:47]
buffer_load_dwordx4 v1, s[60:63], s83 offen offset:1024 lds
v_mfma_f32_16x16x32_bf16 v[52:55], a[128:131], a[16:19], v[52:55]
ds_read_b64_tr_b16 a[140:141], v23 offset:16384
v_lshrrev_b32 v11, 4, v9
v_mfma_f32_16x16x32_bf16 v[52:55], a[132:135], a[20:23], v[52:55]
buffer_load_dwordx4 v1, s[60:63], s83 offen offset:2048 lds
v_mfma_f32_16x16x32_bf16 v[60:63], a[128:131], a[24:27], v[60:63]
ds_read_b64_tr_b16 a[142:143], v23 offset:18432
v_lshrrev_b32 v12, 2, v10
v_mfma_f32_16x16x32_bf16 v[60:63], a[132:135], a[28:31], v[60:63]
buffer_load_dwordx4 v1, s[60:63], s83 offen offset:3072 lds
v_mfma_f32_16x16x32_bf16 v[68:71], a[128:131], a[32:35], v[68:71]
s_add_u32 m0, s84, 64
v_mul_u32_u24 v12, 4160, v12
v_and_b32 v13, 3, v9
v_mfma_f32_16x16x32_bf16 v[68:71], a[132:135], a[36:39], v[68:71]
buffer_load_dwordx4 v1, s[4:7], s82 offen offset:0 sc1 lds
v_mfma_f32_16x16x32_bf16 v[76:79], a[128:131], a[40:43], v[76:79]
buffer_load_dwordx4 v1, s[4:7], s82 offen offset:1024 sc1 lds
v_mfma_f32_16x16x32_bf16 v[76:79], a[132:135], a[44:47], v[76:79]
buffer_load_dwordx4 v1, s[4:7], s82 offen offset:2048 sc1 lds
v_mfma_f32_16x16x32_bf16 v[84:87], a[128:131], a[48:51], v[84:87]
buffer_load_dwordx4 v1, s[4:7], s82 offen offset:3072 sc1 lds
v_mfma_f32_16x16x32_bf16 v[84:87], a[132:135], a[52:55], v[84:87]
s_add_u32 s82, s82, 2097152
v_lshl_add_u32 v12, v13, 3, v12
v_lshlrev_b32 v13, 4, v11
v_mfma_f32_16x16x32_bf16 v[92:95], a[128:131], a[56:59], v[92:95]
s_add_u32 m0, s84, 4224
v_sub_u32 v12, v12, v13
v_add_u32 v12, 88, v12
v_mfma_f32_16x16x32_bf16 v[92:95], a[132:135], a[60:63], v[92:95]
s_waitcnt lgkmcnt(0)
buffer_load_dwordx4 v1, s[4:7], s82 offen offset:0 sc1 lds
v_mfma_f32_16x16x32_bf16 v[100:103], a[136:139], a[0:3], v[100:103]
ds_read_b64_tr_b16 a[128:129], v24 offset:0
v_add_u32 v16, s84, v12
v_mfma_f32_16x16x32_bf16 v[100:103], a[140:143], a[4:7], v[100:103]
buffer_load_dwordx4 v1, s[4:7], s82 offen offset:1024 sc1 lds
v_mfma_f32_16x16x32_bf16 v[108:111], a[136:139], a[8:11], v[108:111]
ds_read_b64_tr_b16 a[130:131], v24 offset:2048
v_lshl_add_u32 v12, v10, 5, v13
v_mfma_f32_16x16x32_bf16 v[108:111], a[140:143], a[12:15], v[108:111]
buffer_load_dwordx4 v1, s[4:7], s82 offen offset:2048 sc1 lds
v_mfma_f32_16x16x32_bf16 v[116:119], a[136:139], a[16:19], v[116:119]
ds_read_b64_tr_b16 a[132:133], v24 offset:16384
v_add_u32 v12, 16672, v12
v_mfma_f32_16x16x32_bf16 v[116:119], a[140:143], a[20:23], v[116:119]
buffer_load_dwordx4 v1, s[4:7], s82 offen offset:3072 sc1 lds
v_mfma_f32_16x16x32_bf16 v[124:127], a[136:139], a[24:27], v[124:127]
s_add_u32 s82, s82, 4292870140
ds_read_b64_tr_b16 a[134:135], v24 offset:18432
v_add_u32 v17, s84, v12
v_mfma_f32_16x16x32_bf16 v[124:127], a[140:143], a[28:31], v[124:127]
s_add_u32 m0, s84, 8384
v_lshlrev_b32 v12, 5, v10
v_lshl_add_u32 v8, v11, 3, v12
v_mfma_f32_16x16x32_bf16 v[132:135], a[136:139], a[32:35], v[132:135]
buffer_load_dwordx4 v1, s[4:7], s82 offen offset:0 sc1 lds
v_mfma_f32_16x16x32_bf16 v[132:135], a[140:143], a[36:39], v[132:135]
buffer_load_dwordx4 v1, s[4:7], s82 offen offset:1024 sc1 lds
v_mfma_f32_16x16x32_bf16 v[140:143], a[136:139], a[40:43], v[140:143]
buffer_load_dwordx4 v1, s[4:7], s82 offen offset:2048 sc1 lds
v_mfma_f32_16x16x32_bf16 v[140:143], a[140:143], a[44:47], v[140:143]
buffer_load_dwordx4 v1, s[4:7], s82 offen offset:3072 sc1 lds
v_mfma_f32_16x16x32_bf16 v[148:151], a[136:139], a[48:51], v[148:151]
s_add_u32 s82, s82, 2097152
v_add3_u32 v18, s84, 64, v8
v_mov_b32 v19, 0
v_mfma_f32_16x16x32_bf16 v[148:151], a[140:143], a[52:55], v[148:151]
s_add_u32 m0, s84, 12544
v_mov_b32 v12, 0
v_mov_b32 v13, 0
v_mfma_f32_16x16x32_bf16 v[156:159], a[136:139], a[56:59], v[156:159]
buffer_load_dwordx4 v1, s[4:7], s82 offen offset:0 sc1 lds
v_mfma_f32_16x16x32_bf16 v[156:159], a[140:143], a[60:63], v[156:159]
s_waitcnt lgkmcnt(0)
buffer_load_dwordx4 v1, s[4:7], s82 offen offset:1024 sc1 lds
v_mfma_f32_16x16x32_bf16 v[164:167], a[128:131], a[0:3], v[164:167]
ds_read_b64_tr_b16 a[136:137], v25 offset:0
v_lshl_add_u32 v14, v9, 3, s84
v_mfma_f32_16x16x32_bf16 v[164:167], a[132:135], a[4:7], v[164:167]
buffer_load_dwordx4 v1, s[4:7], s82 offen offset:2048 sc1 lds
v_mfma_f32_16x16x32_bf16 v[172:175], a[128:131], a[8:11], v[172:175]
ds_read_b64_tr_b16 a[138:139], v25 offset:2048
v_mfma_f32_16x16x32_bf16 v[172:175], a[132:135], a[12:15], v[172:175]
buffer_load_dwordx4 v1, s[4:7], s82 offen offset:3072 sc1 lds
v_mfma_f32_16x16x32_bf16 v[180:183], a[128:131], a[16:19], v[180:183]
ds_read_b64_tr_b16 a[140:141], v25 offset:16384
v_mfma_f32_16x16x32_bf16 v[180:183], a[132:135], a[20:23], v[180:183]
ds_write_b64 v14, v[12:13] offset:16640
v_mul_u32_u24 v14, 4160, v11
v_mfma_f32_16x16x32_bf16 v[188:191], a[128:131], a[24:27], v[188:191]
ds_read_b64_tr_b16 a[142:143], v25 offset:18432
v_lshl_add_u32 v14, v10, 2, v14
v_mfma_f32_16x16x32_bf16 v[188:191], a[132:135], a[28:31], v[188:191]
v_add_u32 v14, s84, v14
v_mfma_f32_16x16x32_bf16 v[196:199], a[128:131], a[32:35], v[196:199]
ds_write_b32 v14, v12
v_lshrrev_b32 v30, 6, v0
v_mfma_f32_16x16x32_bf16 v[196:199], a[132:135], a[36:39], v[196:199]
v_lshl_add_u32 v28, v30, 11, v1
v_add_u32 v29, 0x20000, v28
v_mfma_f32_16x16x32_bf16 v[204:207], a[128:131], a[40:43], v[204:207]
v_lshl_add_u32 v30, v30, 13, v1
v_add_u32 v31, 0x20000, v30
v_mfma_f32_16x16x32_bf16 v[204:207], a[132:135], a[44:47], v[204:207]
v_mul_f32 v36, s68, v36
v_mul_f32 v37, s68, v37
v_mfma_f32_16x16x32_bf16 v[212:215], a[128:131], a[48:51], v[212:215]
v_mul_f32 v38, s68, v38
v_mul_f32 v39, s68, v39
v_mfma_f32_16x16x32_bf16 v[212:215], a[132:135], a[52:55], v[212:215]
v_mul_f32 v100, s68, v100
v_mul_f32 v101, s68, v101
v_mfma_f32_16x16x32_bf16 v[220:223], a[128:131], a[56:59], v[220:223]
v_mul_f32 v102, s68, v102
v_mul_f32 v103, s68, v103
v_mfma_f32_16x16x32_bf16 v[220:223], a[132:135], a[60:63], v[220:223]
s_waitcnt lgkmcnt(0)
s_waitcnt lgkmcnt(0)
s_barrier
v_mfma_f32_16x16x32_bf16 v[224:227], a[136:139], a[0:3], v[224:227]
v_cvt_pk_bf16_f32 v36, v36, v37
v_cvt_pk_bf16_f32 v37, v38, v39
v_mfma_f32_16x16x32_bf16 v[224:227], a[140:143], a[4:7], v[224:227]
v_cvt_pk_bf16_f32 v38, v100, v101
v_cvt_pk_bf16_f32 v39, v102, v103
v_mfma_f32_16x16x32_bf16 v[228:231], a[136:139], a[8:11], v[228:231]
v_mul_f32 v44, s68, v44
v_mul_f32 v45, s68, v45
v_mfma_f32_16x16x32_bf16 v[228:231], a[140:143], a[12:15], v[228:231]
v_mul_f32 v46, s68, v46
v_mul_f32 v47, s68, v47
v_mfma_f32_16x16x32_bf16 v[232:235], a[136:139], a[16:19], v[232:235]
v_mul_f32 v108, s68, v108
v_mul_f32 v109, s68, v109
v_mfma_f32_16x16x32_bf16 v[232:235], a[140:143], a[20:23], v[232:235]
v_mul_f32 v110, s68, v110
v_mul_f32 v111, s68, v111
v_mfma_f32_16x16x32_bf16 v[236:239], a[136:139], a[24:27], v[236:239]
v_cvt_pk_bf16_f32 v44, v44, v45
v_cvt_pk_bf16_f32 v45, v46, v47
v_mfma_f32_16x16x32_bf16 v[236:239], a[140:143], a[28:31], v[236:239]
v_cvt_pk_bf16_f32 v46, v108, v109
v_cvt_pk_bf16_f32 v47, v110, v111
v_mfma_f32_16x16x32_bf16 v[240:243], a[136:139], a[32:35], v[240:243]
v_mul_f32 v52, s68, v52
v_mul_f32 v53, s68, v53
v_mfma_f32_16x16x32_bf16 v[240:243], a[140:143], a[36:39], v[240:243]
v_mul_f32 v54, s68, v54
v_mul_f32 v55, s68, v55
v_mfma_f32_16x16x32_bf16 v[244:247], a[136:139], a[40:43], v[244:247]
v_mul_f32 v116, s68, v116
v_mul_f32 v117, s68, v117
v_mfma_f32_16x16x32_bf16 v[244:247], a[140:143], a[44:47], v[244:247]
v_mul_f32 v118, s68, v118
v_mul_f32 v119, s68, v119
v_mfma_f32_16x16x32_bf16 v[248:251], a[136:139], a[48:51], v[248:251]
v_cvt_pk_bf16_f32 v52, v52, v53
v_cvt_pk_bf16_f32 v53, v54, v55
v_mfma_f32_16x16x32_bf16 v[248:251], a[140:143], a[52:55], v[248:251]
v_cvt_pk_bf16_f32 v54, v116, v117
v_cvt_pk_bf16_f32 v55, v118, v119
v_mfma_f32_16x16x32_bf16 v[252:255], a[136:139], a[56:59], v[252:255]
v_mfma_f32_16x16x32_bf16 v[252:255], a[140:143], a[60:63], v[252:255]
s_mov_b64 s[60:61], s[74:75]
s_mov_b32 s62, 896
s_lshl_b32 s79, s85, 1
buffer_load_short_d16_hi v19, off, s[60:63], s79
s_lshl_b32 s83, s85, 12
s_add_u32 s83, s83, 88080384
ds_write_b128 v28, v[36:39] offset:0
ds_write_b128 v28, v[44:47] offset:8192
ds_write_b128 v28, v[52:55] offset:16384
v_pk_mul_f32 v[60:61], v[60:61], s[68:69]
v_pk_mul_f32 v[62:63], v[62:63], s[68:69]
v_pk_mul_f32 v[124:125], v[124:125], s[68:69]
v_pk_mul_f32 v[126:127], v[126:127], s[68:69]
v_cvt_pk_bf16_f32 v60, v60, v61
v_cvt_pk_bf16_f32 v61, v62, v63
v_cvt_pk_bf16_f32 v62, v124, v125
v_cvt_pk_bf16_f32 v63, v126, v127
ds_write_b128 v28, v[60:63] offset:24576
v_pk_mul_f32 v[68:69], v[68:69], s[68:69]
v_pk_mul_f32 v[70:71], v[70:71], s[68:69]
v_pk_mul_f32 v[132:133], v[132:133], s[68:69]
v_pk_mul_f32 v[134:135], v[134:135], s[68:69]
v_cvt_pk_bf16_f32 v68, v68, v69
v_cvt_pk_bf16_f32 v69, v70, v71
v_cvt_pk_bf16_f32 v70, v132, v133
v_cvt_pk_bf16_f32 v71, v134, v135
ds_write_b128 v29, v[68:71] offset:0
v_pk_mul_f32 v[76:77], v[76:77], s[68:69]
v_pk_mul_f32 v[78:79], v[78:79], s[68:69]
v_pk_mul_f32 v[140:141], v[140:141], s[68:69]
v_pk_mul_f32 v[142:143], v[142:143], s[68:69]
v_cvt_pk_bf16_f32 v76, v76, v77
v_cvt_pk_bf16_f32 v77, v78, v79
v_cvt_pk_bf16_f32 v78, v140, v141
v_cvt_pk_bf16_f32 v79, v142, v143
ds_write_b128 v29, v[76:79] offset:8192
v_pk_mul_f32 v[84:85], v[84:85], s[68:69]
v_pk_mul_f32 v[86:87], v[86:87], s[68:69]
v_pk_mul_f32 v[148:149], v[148:149], s[68:69]
v_pk_mul_f32 v[150:151], v[150:151], s[68:69]
v_cvt_pk_bf16_f32 v84, v84, v85
v_cvt_pk_bf16_f32 v85, v86, v87
v_cvt_pk_bf16_f32 v86, v148, v149
v_cvt_pk_bf16_f32 v87, v150, v151
ds_write_b128 v29, v[84:87] offset:16384
v_pk_mul_f32 v[92:93], v[92:93], s[68:69]
v_pk_mul_f32 v[94:95], v[94:95], s[68:69]
v_pk_mul_f32 v[156:157], v[156:157], s[68:69]
v_pk_mul_f32 v[158:159], v[158:159], s[68:69]
v_cvt_pk_bf16_f32 v92, v92, v93
v_cvt_pk_bf16_f32 v93, v94, v95
v_cvt_pk_bf16_f32 v94, v156, v157
v_cvt_pk_bf16_f32 v95, v158, v159
ds_write_b128 v29, v[92:95] offset:24576
v_pk_mul_f32 v[164:165], v[164:165], s[68:69]
v_pk_mul_f32 v[166:167], v[166:167], s[68:69]
v_pk_mul_f32 v[224:225], v[224:225], s[68:69]
v_pk_mul_f32 v[226:227], v[226:227], s[68:69]
v_cvt_pk_bf16_f32 v164, v164, v165
v_cvt_pk_bf16_f32 v165, v166, v167
v_cvt_pk_bf16_f32 v166, v224, v225
v_cvt_pk_bf16_f32 v167, v226, v227
ds_write_b128 v28, v[164:167] offset:1024
v_pk_mul_f32 v[172:173], v[172:173], s[68:69]
v_pk_mul_f32 v[174:175], v[174:175], s[68:69]
v_pk_mul_f32 v[228:229], v[228:229], s[68:69]
v_pk_mul_f32 v[230:231], v[230:231], s[68:69]
v_cvt_pk_bf16_f32 v172, v172, v173
v_cvt_pk_bf16_f32 v173, v174, v175
v_cvt_pk_bf16_f32 v174, v228, v229
v_cvt_pk_bf16_f32 v175, v230, v231
ds_write_b128 v28, v[172:175] offset:9216
v_pk_mul_f32 v[180:181], v[180:181], s[68:69]
v_pk_mul_f32 v[182:183], v[182:183], s[68:69]
v_pk_mul_f32 v[232:233], v[232:233], s[68:69]
v_pk_mul_f32 v[234:235], v[234:235], s[68:69]
v_cvt_pk_bf16_f32 v180, v180, v181
v_cvt_pk_bf16_f32 v181, v182, v183
v_cvt_pk_bf16_f32 v182, v232, v233
v_cvt_pk_bf16_f32 v183, v234, v235
ds_write_b128 v28, v[180:183] offset:17408
v_pk_mul_f32 v[188:189], v[188:189], s[68:69]
v_pk_mul_f32 v[190:191], v[190:191], s[68:69]
v_pk_mul_f32 v[236:237], v[236:237], s[68:69]
v_pk_mul_f32 v[238:239], v[238:239], s[68:69]
v_cvt_pk_bf16_f32 v188, v188, v189
v_cvt_pk_bf16_f32 v189, v190, v191
v_cvt_pk_bf16_f32 v190, v236, v237
v_cvt_pk_bf16_f32 v191, v238, v239
ds_write_b128 v28, v[188:191] offset:25600
v_pk_mul_f32 v[196:197], v[196:197], s[68:69]
v_pk_mul_f32 v[198:199], v[198:199], s[68:69]
v_pk_mul_f32 v[240:241], v[240:241], s[68:69]
v_pk_mul_f32 v[242:243], v[242:243], s[68:69]
v_cvt_pk_bf16_f32 v196, v196, v197
v_cvt_pk_bf16_f32 v197, v198, v199
v_cvt_pk_bf16_f32 v198, v240, v241
v_cvt_pk_bf16_f32 v199, v242, v243
ds_write_b128 v29, v[196:199] offset:1024
v_pk_mul_f32 v[204:205], v[204:205], s[68:69]
v_pk_mul_f32 v[206:207], v[206:207], s[68:69]
v_pk_mul_f32 v[244:245], v[244:245], s[68:69]
v_pk_mul_f32 v[246:247], v[246:247], s[68:69]
v_cvt_pk_bf16_f32 v204, v204, v205
v_cvt_pk_bf16_f32 v205, v206, v207
v_cvt_pk_bf16_f32 v206, v244, v245
v_cvt_pk_bf16_f32 v207, v246, v247
ds_write_b128 v29, v[204:207] offset:9216
v_pk_mul_f32 v[212:213], v[212:213], s[68:69]
v_pk_mul_f32 v[214:215], v[214:215], s[68:69]
v_pk_mul_f32 v[248:249], v[248:249], s[68:69]
v_pk_mul_f32 v[250:251], v[250:251], s[68:69]
v_cvt_pk_bf16_f32 v212, v212, v213
v_cvt_pk_bf16_f32 v213, v214, v215
v_cvt_pk_bf16_f32 v214, v248, v249
v_cvt_pk_bf16_f32 v215, v250, v251
ds_write_b128 v29, v[212:215] offset:17408
v_pk_mul_f32 v[220:221], v[220:221], s[68:69]
v_pk_mul_f32 v[222:223], v[222:223], s[68:69]
v_pk_mul_f32 v[252:253], v[252:253], s[68:69]
v_pk_mul_f32 v[254:255], v[254:255], s[68:69]
v_cvt_pk_bf16_f32 v220, v220, v221
v_cvt_pk_bf16_f32 v221, v222, v223
v_cvt_pk_bf16_f32 v222, v252, v253
v_cvt_pk_bf16_f32 v223, v254, v255
ds_write_b128 v29, v[220:223] offset:25600
s_waitcnt vmcnt(1) lgkmcnt(0)
s_barrier
buffer_load_dword v21, v20, s[4:7], s31 offen sc1
ds_read_b64_tr_b16 a[64:65], v16 offset:8
ds_read_b64_tr_b16 a[66:67], v16 offset:0
ds_read_b128 a[96:99], v17 offset:448
ds_read_b64_tr_b16 a[68:69], v16 offset:520
ds_read_b64_tr_b16 a[70:71], v16 offset:512
ds_read_b128 a[100:103], v17 offset:960
ds_read_b64_tr_b16 a[72:73], v16 offset:1032
ds_read_b64_tr_b16 a[74:75], v16 offset:1024
ds_read_b128 a[104:107], v17 offset:1472
ds_read_b64_tr_b16 a[76:77], v16 offset:1544
ds_read_b64_tr_b16 a[78:79], v16 offset:1536
ds_read_b128 a[108:111], v17 offset:1984
ds_read_b64_tr_b16 a[80:81], v16 offset:2056
ds_read_b64_tr_b16 a[82:83], v16 offset:2048
ds_read_b128 a[112:115], v17 offset:2496
ds_read_b64_tr_b16 a[84:85], v16 offset:2568
ds_read_b64_tr_b16 a[86:87], v16 offset:2560
ds_read_b128 a[116:119], v17 offset:3008
ds_read_b64_tr_b16 a[88:89], v16 offset:3080
ds_read_b64_tr_b16 a[90:91], v16 offset:3072
ds_read_b128 a[120:123], v17 offset:3520
ds_read_b64_tr_b16 a[92:93], v16 offset:3592
ds_read_b64_tr_b16 a[94:95], v16 offset:3584
ds_read_b128 a[124:127], v17 offset:4032
s_waitcnt lgkmcnt(15)
v_mfma_f32_16x16x32_bf16 v[96:99], a[64:67], a[96:99], 0
s_waitcnt lgkmcnt(12)
s_lshl_b32 s18, s3, 13
ds_read_b64_tr_b16 a[128:129], v16 offset:72
v_mov_b32 v24, 0
v_mfma_f32_16x16x32_bf16 v[100:103], a[64:67], a[100:103], 0
s_lshl_b32 s30, s20, 20
ds_read_b64_tr_b16 a[130:131], v16 offset:64
v_lshrrev_b32 v3, 6, v0
v_mfma_f32_16x16x32_bf16 v[100:103], a[68:71], a[96:99], v[100:103]
s_add_u32 s30, s30, s18
ds_read_b128 a[160:163], v17 offset:384
v_and_b32 v4, 63, v0
v_mfma_f32_16x16x32_bf16 v[104:107], a[64:67], a[104:107], 0
s_lshl_b32 s22, s21, 1
ds_read_b128 a[192:195], v30 offset:0
v_add_u32 v2, 0x10000, v1
v_mfma_f32_16x16x32_bf16 v[104:107], a[68:71], a[100:103], v[104:107]
s_and_b32 s84, s2, 1
ds_read_b64_tr_b16 a[132:133], v16 offset:584
v_and_b32 v5, 15, v4
v_mfma_f32_16x16x32_bf16 v[104:107], a[72:75], a[96:99], v[104:107]
s_mul_i32 s84, s84, 0
ds_read_b64_tr_b16 a[134:135], v16 offset:576
v_lshrrev_b32 v6, 4, v4
v_mfma_f32_16x16x32_bf16 v[108:111], a[64:67], a[108:111], 0
s_add_u32 s84, s84, 2386092
ds_read_b128 a[164:167], v17 offset:896
v_lshlrev_b32 v6, 2, v6
v_mfma_f32_16x16x32_bf16 v[108:111], a[68:71], a[104:107], v[108:111]
s_lshl_b32 s85, s21, 2
ds_read_b128 a[196:199], v30 offset:1024
v_sub_u32 v5, v5, v6
v_mfma_f32_16x16x32_bf16 v[108:111], a[72:75], a[100:103], v[108:111]
s_lshr_b32 s85, s84, s85
ds_read_b64_tr_b16 a[136:137], v16 offset:1096
v_lshl_add_u32 v5, v3, 4, v5
v_mfma_f32_16x16x32_bf16 v[108:111], a[76:79], a[96:99], v[108:111]
s_waitcnt lgkmcnt(8)
s_and_b32 s9, s85, 15
ds_read_b64_tr_b16 a[138:139], v16 offset:1088
v_cmp_gt_i32 s[32:33], 0, v5
v_mfma_f32_16x16x32_bf16 v[112:115], a[64:67], a[112:115], 0
s_and_b32 s84, s85, 1
ds_read_b128 a[168:171], v17 offset:1408
v_cmp_gt_i32 s[34:35], 1, v5
v_mfma_f32_16x16x32_bf16 v[112:115], a[68:71], a[108:111], v[112:115]
s_lshl_b32 s84, s84, 17
ds_read_b128 a[200:203], v30 offset:2048
v_cmp_gt_i32 s[36:37], 2, v5
v_mfma_f32_16x16x32_bf16 v[112:115], a[72:75], a[104:107], v[112:115]
s_add_u32 s84, s84, s18
ds_read_b64_tr_b16 a[140:141], v16 offset:1608
v_cmp_gt_i32 s[38:39], 3, v5
v_mfma_f32_16x16x32_bf16 v[112:115], a[76:79], a[100:103], v[112:115]
s_xor_b32 s85, s84, 0x20000
ds_read_b64_tr_b16 a[142:143], v16 offset:1600
v_cmp_gt_i32 s[40:41], 16, v5
v_mfma_f32_16x16x32_bf16 v[112:115], a[80:83], a[96:99], v[112:115]
s_sub_u32 s29, 15, s21
ds_read_b128 a[172:175], v17 offset:1920
v_cmp_gt_i32 s[42:43], 17, v5
v_mfma_f32_16x16x32_bf16 v[116:119], a[64:67], a[116:119], 0
s_xor_b32 s8, s30, 2097152
ds_read_b128 a[204:207], v30 offset:3072
v_cmp_gt_i32 s[44:45], 18, v5
v_mfma_f32_16x16x32_bf16 v[116:119], a[68:71], a[112:115], v[116:119]
s_add_u32 s11, s22, 2
ds_read_b64_tr_b16 a[144:145], v16 offset:2120
v_cmp_gt_i32 s[46:47], 19, v5
v_mfma_f32_16x16x32_bf16 v[116:119], a[72:75], a[108:111], v[116:119]
s_add_u32 s14, s30, 16777216
ds_read_b64_tr_b16 a[146:147], v16 offset:2112
v_cmp_gt_i32 s[48:49], 32, v5
v_mfma_f32_16x16x32_bf16 v[116:119], a[76:79], a[104:107], v[116:119]
s_lshr_b32 s19, s9, 1
ds_read_b128 a[176:179], v17 offset:2432
v_cmp_gt_i32 s[50:51], 33, v5
v_mfma_f32_16x16x32_bf16 v[116:119], a[80:83], a[100:103], v[116:119]
s_cmp_lg_u32 s9, 0
ds_read_b128 a[208:211], v30 offset:4096
v_cmp_gt_i32 s[52:53], 34, v5
v_mfma_f32_16x16x32_bf16 v[116:119], a[84:87], a[96:99], v[116:119]
s_cselect_b32 s10, s30, 3221225472
ds_read_b64_tr_b16 a[148:149], v16 offset:2632
v_cmp_gt_i32 s[54:55], 35, v5
v_mfma_f32_16x16x32_bf16 v[120:123], a[64:67], a[120:123], 0
s_cselect_b32 s8, s8, s30
ds_read_b64_tr_b16 a[150:151], v16 offset:2624
v_cmp_gt_i32 s[56:57], 48, v5
v_mfma_f32_16x16x32_bf16 v[120:123], a[68:71], a[116:119], v[120:123]
s_cselect_b32 s14, s14, 3221225472
ds_read_b128 a[180:183], v17 offset:2944
v_cmp_gt_i32 s[58:59], 49, v5
v_mfma_f32_16x16x32_bf16 v[120:123], a[72:75], a[112:115], v[120:123]
s_cselect_b32 s9, s9, s11
ds_read_b128 a[212:215], v30 offset:5120
v_cmp_gt_i32 s[60:61], 50, v5
v_mfma_f32_16x16x32_bf16 v[120:123], a[76:79], a[108:111], v[120:123]
s_cselect_b32 s19, s19, s21
ds_read_b64_tr_b16 a[152:153], v16 offset:3144
v_cmp_gt_i32 s[62:63], 51, v5
v_mfma_f32_16x16x32_bf16 v[120:123], a[80:83], a[104:107], v[120:123]
s_cselect_b32 s29, s29, s21
ds_read_b64_tr_b16 a[154:155], v16 offset:3136
v_mov_b32 v7, 0xff800000
v_mfma_f32_16x16x32_bf16 v[120:123], a[84:87], a[100:103], v[120:123]
s_cselect_b32 s24, 2, 0
ds_read_b128 a[184:187], v17 offset:3456
v_mov_b32 v6, 1
v_mfma_f32_16x16x32_bf16 v[120:123], a[88:91], a[96:99], v[120:123]
s_add_u32 s12, s8, 16777216
ds_read_b128 a[216:219], v30 offset:6144
v_mov_b32 v5, v26
v_mfma_f32_16x16x32_bf16 v[124:127], a[64:67], a[124:127], 0
s_mov_b32 s13, s9
ds_read_b64_tr_b16 a[156:157], v16 offset:3656
v_add_u32 v4, 0x20000, v1
v_mfma_f32_16x16x32_bf16 v[124:127], a[68:71], a[120:123], v[124:127]
s_mov_b32 s15, s11
ds_read_b64_tr_b16 a[158:159], v16 offset:3648
v_mfma_f32_16x16x32_bf16 v[124:127], a[72:75], a[116:119], v[124:127]
s_mov_b32 s25, 1266679808
ds_read_b128 a[188:191], v17 offset:3968
v_mfma_f32_16x16x32_bf16 v[124:127], a[76:79], a[112:115], v[124:127]
s_lshl_b32 s22, s21, 3
ds_read_b128 a[220:223], v30 offset:7168
v_mfma_f32_16x16x32_bf16 v[124:127], a[80:83], a[108:111], v[124:127]
s_xor_b32 s28, s70, 0
ds_read_b128 a[224:227], v31 offset:0
v_mfma_f32_16x16x32_bf16 v[124:127], a[84:87], a[104:107], v[124:127]
s_add_u32 s28, s28, s22
ds_read_b128 a[228:231], v31 offset:1024
v_mfma_f32_16x16x32_bf16 v[124:127], a[88:91], a[100:103], v[124:127]
s_add_u32 s28, s28, 6148
ds_read_b128 a[232:235], v31 offset:2048
v_mfma_f32_16x16x32_bf16 v[124:127], a[92:95], a[96:99], v[124:127]
s_waitcnt lgkmcnt(8)
s_lshl_b32 s26, s21, 16
ds_read_b128 a[236:239], v31 offset:3072
v_mfma_f32_16x16x32_bf16 v[96:99], a[128:131], a[160:163], v[96:99]
s_add_u32 s26, s26, s30
ds_read_b64_tr_b16 a[64:65], v16 offset:136
v_mfma_f32_16x16x32_bf16 v[100:103], a[128:131], a[164:167], v[100:103]
s_add_u32 s26, s26, 33554432
ds_read_b64_tr_b16 a[66:67], v16 offset:128
v_mfma_f32_16x16x32_bf16 v[100:103], a[132:135], a[160:163], v[100:103]
s_xor_b32 s76, s20, 2
ds_read_b128 a[96:99], v17 offset:320
v_mfma_f32_16x16x32_bf16 v[104:107], a[128:131], a[168:171], v[104:107]
s_lshl_b32 s76, s76, 3
ds_read_b128 a[240:243], v31 offset:4096
v_mfma_f32_16x16x32_bf16 v[104:107], a[132:135], a[164:167], v[104:107]
s_add_u32 s76, s76, s21
ds_read_b64_tr_b16 a[68:69], v16 offset:648
v_mfma_f32_16x16x32_bf16 v[104:107], a[136:139], a[160:163], v[104:107]
s_lshl_b32 s76, s76, 2
ds_read_b64_tr_b16 a[70:71], v16 offset:640
v_mfma_f32_16x16x32_bf16 v[108:111], a[128:131], a[172:175], v[108:111]
s_add_u32 s76, s76, s3
ds_read_b128 a[100:103], v17 offset:832
v_mfma_f32_16x16x32_bf16 v[108:111], a[132:135], a[168:171], v[108:111]
s_lshl_b32 s27, s76, 10
ds_read_b128 a[244:247], v31 offset:5120
v_mfma_f32_16x16x32_bf16 v[108:111], a[136:139], a[164:167], v[108:111]
s_add_u32 s27, s27, 75497472
ds_read_b64_tr_b16 a[72:73], v16 offset:1160
v_mfma_f32_16x16x32_bf16 v[108:111], a[140:143], a[160:163], v[108:111]
s_lshl_b32 s76, s76, 14
ds_read_b64_tr_b16 a[74:75], v16 offset:1152
v_mfma_f32_16x16x32_bf16 v[112:115], a[128:131], a[176:179], v[112:115]
s_add_u32 s76, s76, 67108864
ds_read_b128 a[104:107], v17 offset:1344
v_mfma_f32_16x16x32_bf16 v[112:115], a[132:135], a[172:175], v[112:115]
PAD_30:
s_cbranch_execz M_tret
s_lshl_b32 s81, s20, 2
ds_read_b128 a[248:251], v31 offset:6144
v_mfma_f32_16x16x32_bf16 v[112:115], a[136:139], a[168:171], v[112:115]
s_add_u32 s81, s81, s3
ds_read_b64_tr_b16 a[76:77], v16 offset:1672
v_mfma_f32_16x16x32_bf16 v[112:115], a[140:143], a[164:167], v[112:115]
s_mul_i32 s81, s81, 57344
ds_read_b64_tr_b16 a[78:79], v16 offset:1664
v_mfma_f32_16x16x32_bf16 v[112:115], a[144:147], a[160:163], v[112:115]
s_cmp_eq_u32 s24, 1
ds_read_b128 a[108:111], v17 offset:1856
v_mfma_f32_16x16x32_bf16 v[116:119], a[128:131], a[180:183], v[116:119]
s_cselect_b32 s80, s28, s70
ds_read_b128 a[252:255], v31 offset:7168
v_mfma_f32_16x16x32_bf16 v[116:119], a[132:135], a[176:179], v[116:119]
s_add_u32 s77, s76, 8192
ds_read_b64_tr_b16 a[80:81], v16 offset:2184
v_mfma_f32_16x16x32_bf16 v[116:119], a[136:139], a[172:175], v[116:119]
s_lshl_b32 s71, s2, 2
ds_read_b64_tr_b16 a[82:83], v16 offset:2176
v_mfma_f32_16x16x32_bf16 v[116:119], a[140:143], a[168:171], v[116:119]
s_add_u32 s71, s71, 94384128
ds_read_b128 a[112:115], v17 offset:2368
v_mfma_f32_16x16x32_bf16 v[116:119], a[144:147], a[164:167], v[116:119]
s_lshl_b32 s78, s29, 16
v_mfma_f32_16x16x32_bf16 v[116:119], a[148:151], a[160:163], v[116:119]
s_add_u32 s78, s78, s8
ds_read_b64_tr_b16 a[84:85], v16 offset:2696
v_mfma_f32_16x16x32_bf16 v[120:123], a[128:131], a[184:187], v[120:123]
s_add_u32 s78, s78, 33554432
ds_read_b64_tr_b16 a[86:87], v16 offset:2688
v_mfma_f32_16x16x32_bf16 v[120:123], a[132:135], a[180:183], v[120:123]
s_cmp_eq_u32 s24, 0
ds_read_b128 a[116:119], v17 offset:2880
v_mfma_f32_16x16x32_bf16 v[120:123], a[136:139], a[176:179], v[120:123]
s_cselect_b32 s78, 3221225472, s78
v_mfma_f32_16x16x32_bf16 v[120:123], a[140:143], a[172:175], v[120:123]
s_lshl_b32 s22, s21, 3
ds_read_b64_tr_b16 a[88:89], v16 offset:3208
v_mfma_f32_16x16x32_bf16 v[120:123], a[144:147], a[168:171], v[120:123]
s_add_u32 s22, s22, 16384
ds_read_b64_tr_b16 a[90:91], v16 offset:3200
v_mfma_f32_16x16x32_bf16 v[120:123], a[148:151], a[164:167], v[120:123]
s_andn2_b32 s23, 256, s70
ds_read_b128 a[120:123], v17 offset:3392
v_mfma_f32_16x16x32_bf16 v[120:123], a[152:155], a[160:163], v[120:123]
s_waitcnt lgkmcnt(6)
s_add_u32 s22, s22, s23
v_mfma_f32_16x16x32_bf16 v[124:127], a[128:131], a[188:191], v[124:127]
s_waitcnt vmcnt(0) lgkmcnt(9)
s_barrier
ds_read_b64_tr_b16 a[92:93], v16 offset:3720
v_writelane_b32 v15, s22, 63
v_cmp_gt_u32 vcc, 1, v21
v_mfma_f32_16x16x32_bf16 v[124:127], a[132:135], a[184:187], v[124:127]
s_cbranch_vccnz M_kspin2
M_kok2:
ds_read_b64_tr_b16 a[94:95], v16 offset:3712
v_mov_b32 v25, 0
v_mfma_f32_16x16x32_bf16 v[124:127], a[136:139], a[180:183], v[124:127]
s_mov_b32 m0, s84
ds_read_b128 a[124:127], v17 offset:3904
v_mov_b32 v128, 0
v_mfma_f32_16x16x32_bf16 v[124:127], a[140:143], a[176:179], v[124:127]
buffer_load_dwordx4 v1, s[4:7], s8 offen offset:0 sc1 lds
v_mfma_f32_16x16x32_bf16 v[124:127], a[144:147], a[172:175], v[124:127]
buffer_load_dwordx4 v1, s[4:7], s8 offen offset:1024 sc1 lds
v_mfma_f32_16x16x32_bf16 v[124:127], a[148:151], a[168:171], v[124:127]
buffer_load_dwordx4 v1, s[4:7], s8 offen offset:2048 sc1 lds
v_mfma_f32_16x16x32_bf16 v[124:127], a[152:155], a[164:167], v[124:127]
buffer_load_dwordx4 v1, s[4:7], s8 offen offset:3072 sc1 lds
v_mfma_f32_16x16x32_bf16 v[124:127], a[156:159], a[160:163], v[124:127]
s_add_u32 s8, s8, 4096
v_mov_b32 v129, 0
v_mov_b32 v130, 0
v_mfma_f32_16x16x32_bf16 v[96:99], a[64:67], a[96:99], v[96:99]
s_add_u32 m0, s84, 4096
ds_read_b64_tr_b16 a[128:129], v16 offset:200
v_mov_b32 v131, 0
v_mfma_f32_16x16x32_bf16 v[100:103], a[64:67], a[100:103], v[100:103]
ds_read_b64_tr_b16 a[130:131], v16 offset:192
v_mov_b32 v132, 0
v_mfma_f32_16x16x32_bf16 v[100:103], a[68:71], a[96:99], v[100:103]
ds_read_b128 a[160:163], v17 offset:256
v_mov_b32 v133, 0
v_mfma_f32_16x16x32_bf16 v[104:107], a[64:67], a[104:107], v[104:107]
buffer_load_dwordx4 v1, s[4:7], s8 offen offset:0 sc1 lds
v_mfma_f32_16x16x32_bf16 v[104:107], a[68:71], a[100:103], v[104:107]
ds_read_b64_tr_b16 a[132:133], v16 offset:712
v_mov_b32 v134, 0
v_mfma_f32_16x16x32_bf16 v[104:107], a[72:75], a[96:99], v[104:107]
ds_read_b64_tr_b16 a[134:135], v16 offset:704
v_mov_b32 v135, 0
v_mfma_f32_16x16x32_bf16 v[108:111], a[64:67], a[108:111], v[108:111]
ds_read_b128 a[164:167], v17 offset:768
v_mov_b32 v136, 0
v_mfma_f32_16x16x32_bf16 v[108:111], a[68:71], a[104:107], v[108:111]
buffer_load_dwordx4 v1, s[4:7], s8 offen offset:1024 sc1 lds
v_mfma_f32_16x16x32_bf16 v[108:111], a[72:75], a[100:103], v[108:111]
ds_read_b64_tr_b16 a[136:137], v16 offset:1224
v_mov_b32 v137, 0
v_mfma_f32_16x16x32_bf16 v[108:111], a[76:79], a[96:99], v[108:111]
ds_read_b64_tr_b16 a[138:139], v16 offset:1216
v_mov_b32 v138, 0
v_mfma_f32_16x16x32_bf16 v[112:115], a[64:67], a[112:115], v[112:115]
ds_read_b128 a[168:171], v17 offset:1280
v_mov_b32 v139, 0
v_mfma_f32_16x16x32_bf16 v[112:115], a[68:71], a[108:111], v[112:115]
buffer_load_dwordx4 v1, s[4:7], s8 offen offset:2048 sc1 lds
v_mfma_f32_16x16x32_bf16 v[112:115], a[72:75], a[104:107], v[112:115]
ds_read_b64_tr_b16 a[140:141], v16 offset:1736
v_mov_b32 v140, 0
v_mfma_f32_16x16x32_bf16 v[112:115], a[76:79], a[100:103], v[112:115]
ds_read_b64_tr_b16 a[142:143], v16 offset:1728
v_mov_b32 v141, 0
v_mfma_f32_16x16x32_bf16 v[112:115], a[80:83], a[96:99], v[112:115]
s_waitcnt lgkmcnt(6)
ds_read_b128 a[172:175], v17 offset:1792
v_mov_b32 v142, 0
v_mfma_f32_16x16x32_bf16 v[116:119], a[64:67], a[116:119], v[116:119]
buffer_load_dwordx4 v1, s[4:7], s8 offen offset:3072 sc1 lds
v_mfma_f32_16x16x32_bf16 v[116:119], a[68:71], a[112:115], v[116:119]
s_add_u32 s8, s8, 28672
ds_read_b64_tr_b16 a[144:145], v16 offset:2248
v_mov_b32 v143, 0
v_mfma_f32_16x16x32_bf16 v[116:119], a[72:75], a[108:111], v[116:119]
s_sub_u32 s9, s9, 1
ds_read_b64_tr_b16 a[146:147], v16 offset:2240
v_mov_b32 v144, 0
v_mfma_f32_16x16x32_bf16 v[116:119], a[76:79], a[104:107], v[116:119]
s_cmp_eq_u32 s9, 0
ds_read_b128 a[176:179], v17 offset:2304
v_mov_b32 v145, 0
v_mfma_f32_16x16x32_bf16 v[116:119], a[80:83], a[100:103], v[116:119]
s_cselect_b32 s8, s10, s8
v_mov_b32 v146, 0
v_mov_b32 v147, 0
v_mfma_f32_16x16x32_bf16 v[116:119], a[84:87], a[96:99], v[116:119]
s_cselect_b32 s9, s11, s9
ds_read_b64_tr_b16 a[148:149], v16 offset:2760
v_mov_b32 v148, 0
v_mfma_f32_16x16x32_bf16 v[120:123], a[64:67], a[120:123], v[120:123]
s_cselect_b32 s10, 3221225472, s10
ds_read_b64_tr_b16 a[150:151], v16 offset:2752
v_mov_b32 v149, 0
v_mfma_f32_16x16x32_bf16 v[120:123], a[68:71], a[116:119], v[120:123]
s_mov_b32 m0, s85
ds_read_b128 a[180:183], v17 offset:2816
v_mov_b32 v150, 0
v_mfma_f32_16x16x32_bf16 v[120:123], a[72:75], a[112:115], v[120:123]
buffer_load_dwordx4 v1, s[4:7], s8 offen offset:0 sc1 lds
v_mfma_f32_16x16x32_bf16 v[120:123], a[76:79], a[108:111], v[120:123]
ds_read_b64_tr_b16 a[152:153], v16 offset:3272
v_mov_b32 v151, 0
v_mfma_f32_16x16x32_bf16 v[120:123], a[80:83], a[104:107], v[120:123]
ds_read_b64_tr_b16 a[154:155], v16 offset:3264
v_mov_b32 v152, 0
v_mfma_f32_16x16x32_bf16 v[120:123], a[84:87], a[100:103], v[120:123]
ds_read_b128 a[184:187], v17 offset:3328
v_mov_b32 v153, 0
v_mfma_f32_16x16x32_bf16 v[120:123], a[88:91], a[96:99], v[120:123]
buffer_load_dwordx4 v1, s[4:7], s8 offen offset:1024 sc1 lds
v_mfma_f32_16x16x32_bf16 v[124:127], a[64:67], a[124:127], v[124:127]
ds_read_b64_tr_b16 a[156:157], v16 offset:3784
v_mov_b32 v154, 0
v_mfma_f32_16x16x32_bf16 v[124:127], a[68:71], a[120:123], v[124:127]
ds_read_b64_tr_b16 a[158:159], v16 offset:3776
v_mov_b32 v155, 0
v_mfma_f32_16x16x32_bf16 v[124:127], a[72:75], a[116:119], v[124:127]
ds_read_b128 a[188:191], v17 offset:3840
v_mov_b32 v156, 0
v_mfma_f32_16x16x32_bf16 v[124:127], a[76:79], a[112:115], v[124:127]
buffer_load_dwordx4 v1, s[4:7], s8 offen offset:2048 sc1 lds
v_mfma_f32_16x16x32_bf16 v[124:127], a[80:83], a[108:111], v[124:127]
buffer_load_dwordx4 v1, s[4:7], s8 offen offset:3072 sc1 lds
v_mfma_f32_16x16x32_bf16 v[124:127], a[84:87], a[104:107], v[124:127]
s_add_u32 s8, s8, 4096
v_mov_b32 v157, 0
v_mov_b32 v158, 0
v_mfma_f32_16x16x32_bf16 v[124:127], a[88:91], a[100:103], v[124:127]
s_add_u32 m0, s85, 4096
v_mov_b32 v159, 0
v_mov_b32 v160, 0
v_mfma_f32_16x16x32_bf16 v[124:127], a[92:95], a[96:99], v[124:127]
buffer_load_dwordx4 v1, s[4:7], s8 offen offset:0 sc1 lds
v_mfma_f32_16x16x32_bf16 v[96:99], a[128:131], a[160:163], v[96:99]
s_waitcnt lgkmcnt(3)
ds_read_b64_tr_b16 a[64:65], v16 offset:264
v_mov_b32 v161, 0
v_mfma_f32_16x16x32_bf16 v[100:103], a[128:131], a[164:167], v[100:103]
ds_read_b64_tr_b16 a[66:67], v16 offset:256
v_mov_b32 v162, 0
v_mfma_f32_16x16x32_bf16 v[100:103], a[132:135], a[160:163], v[100:103]
ds_read_b128 a[96:99], v17 offset:192
v_mov_b32 v163, 0
v_mfma_f32_16x16x32_bf16 v[104:107], a[128:131], a[168:171], v[104:107]
buffer_load_dwordx4 v1, s[4:7], s8 offen offset:1024 sc1 lds
v_mfma_f32_16x16x32_bf16 v[104:107], a[132:135], a[164:167], v[104:107]
ds_read_b64_tr_b16 a[68:69], v16 offset:776
v_mov_b32 v164, 0
v_mfma_f32_16x16x32_bf16 v[104:107], a[136:139], a[160:163], v[104:107]
ds_read_b64_tr_b16 a[70:71], v16 offset:768
v_mov_b32 v165, 0
v_mfma_f32_16x16x32_bf16 v[108:111], a[128:131], a[172:175], v[108:111]
ds_read_b128 a[100:103], v17 offset:704
v_mov_b32 v166, 0
v_mfma_f32_16x16x32_bf16 v[108:111], a[132:135], a[168:171], v[108:111]
buffer_load_dwordx4 v1, s[4:7], s8 offen offset:2048 sc1 lds
v_mfma_f32_16x16x32_bf16 v[108:111], a[136:139], a[164:167], v[108:111]
ds_read_b64_tr_b16 a[72:73], v16 offset:1288
v_mov_b32 v167, 0
v_mfma_f32_16x16x32_bf16 v[108:111], a[140:143], a[160:163], v[108:111]
ds_read_b64_tr_b16 a[74:75], v16 offset:1280
v_mov_b32 v168, 0
v_mfma_f32_16x16x32_bf16 v[112:115], a[128:131], a[176:179], v[112:115]
ds_read_b128 a[104:107], v17 offset:1216
v_mov_b32 v169, 0
v_mfma_f32_16x16x32_bf16 v[112:115], a[132:135], a[172:175], v[112:115]
buffer_load_dwordx4 v1, s[4:7], s8 offen offset:3072 sc1 lds
v_mfma_f32_16x16x32_bf16 v[112:115], a[136:139], a[168:171], v[112:115]
s_add_u32 s8, s8, 28672
ds_read_b64_tr_b16 a[76:77], v16 offset:1800
v_mov_b32 v170, 0
v_mfma_f32_16x16x32_bf16 v[112:115], a[140:143], a[164:167], v[112:115]
s_sub_u32 s9, s9, 1
ds_read_b64_tr_b16 a[78:79], v16 offset:1792
v_mov_b32 v171, 0
v_mfma_f32_16x16x32_bf16 v[112:115], a[144:147], a[160:163], v[112:115]
s_cmp_eq_u32 s9, 0
ds_read_b128 a[108:111], v17 offset:1728
v_mov_b32 v172, 0
v_mfma_f32_16x16x32_bf16 v[116:119], a[128:131], a[180:183], v[116:119]
s_cselect_b32 s8, s10, s8
buffer_load_dword v14, v15, s[4:7], s31 offen sc1
v_mfma_f32_16x16x32_bf16 v[116:119], a[132:135], a[176:179], v[116:119]
s_cselect_b32 s9, s11, s9
ds_read_b64_tr_b16 a[80:81], v16 offset:2312
v_mov_b32 v173, 0
v_mfma_f32_16x16x32_bf16 v[116:119], a[136:139], a[172:175], v[116:119]
s_cselect_b32 s10, 3221225472, s10
ds_read_b64_tr_b16 a[82:83], v16 offset:2304
v_mov_b32 v174, 0
v_mfma_f32_16x16x32_bf16 v[116:119], a[140:143], a[168:171], v[116:119]
ds_read_b128 a[112:115], v17 offset:2240
v_mov_b32 v175, 0
v_mfma_f32_16x16x32_bf16 v[116:119], a[144:147], a[164:167], v[116:119]
v_mov_b32 v176, 0
v_mov_b32 v177, 0
v_mfma_f32_16x16x32_bf16 v[116:119], a[148:151], a[160:163], v[116:119]
ds_read_b64_tr_b16 a[84:85], v16 offset:2824
v_mov_b32 v178, 0
v_mfma_f32_16x16x32_bf16 v[120:123], a[128:131], a[184:187], v[120:123]
ds_read_b64_tr_b16 a[86:87], v16 offset:2816
v_mov_b32 v179, 0
v_mfma_f32_16x16x32_bf16 v[120:123], a[132:135], a[180:183], v[120:123]
ds_read_b128 a[116:119], v17 offset:2752
v_mov_b32 v180, 0
v_mfma_f32_16x16x32_bf16 v[120:123], a[136:139], a[176:179], v[120:123]
v_mov_b32 v181, 0
v_mov_b32 v182, 0
v_mfma_f32_16x16x32_bf16 v[120:123], a[140:143], a[172:175], v[120:123]
ds_read_b64_tr_b16 a[88:89], v16 offset:3336
v_mov_b32 v183, 0
v_mfma_f32_16x16x32_bf16 v[120:123], a[144:147], a[168:171], v[120:123]
ds_read_b64_tr_b16 a[90:91], v16 offset:3328
v_mov_b32 v184, 0
v_mfma_f32_16x16x32_bf16 v[120:123], a[148:151], a[164:167], v[120:123]
ds_read_b128 a[120:123], v17 offset:3264
v_mov_b32 v185, 0
v_mfma_f32_16x16x32_bf16 v[120:123], a[152:155], a[160:163], v[120:123]
s_waitcnt lgkmcnt(6)
v_mov_b32 v186, 0
v_mov_b32 v187, 0
v_mfma_f32_16x16x32_bf16 v[124:127], a[128:131], a[188:191], v[124:127]
ds_read_b64_tr_b16 a[92:93], v16 offset:3848
v_mov_b32 v188, 0
v_mfma_f32_16x16x32_bf16 v[124:127], a[132:135], a[184:187], v[124:127]
ds_read_b64_tr_b16 a[94:95], v16 offset:3840
v_mov_b32 v189, 0
v_mfma_f32_16x16x32_bf16 v[124:127], a[136:139], a[180:183], v[124:127]
ds_read_b128 a[124:127], v17 offset:3776
v_mov_b32 v190, 0
v_mfma_f32_16x16x32_bf16 v[124:127], a[140:143], a[176:179], v[124:127]
v_mov_b32 v191, 0
v_mov_b32 v192, 0
v_mfma_f32_16x16x32_bf16 v[124:127], a[144:147], a[172:175], v[124:127]
v_mov_b32 v193, 0
v_mov_b32 v194, 0
v_mfma_f32_16x16x32_bf16 v[124:127], a[148:151], a[168:171], v[124:127]
v_mov_b32 v195, 0
v_mov_b32 v196, 0
v_mfma_f32_16x16x32_bf16 v[124:127], a[152:155], a[164:167], v[124:127]
v_mov_b32 v197, 0
v_mov_b32 v198, 0
v_mfma_f32_16x16x32_bf16 v[124:127], a[156:159], a[160:163], v[124:127]
v_mov_b32 v199, 0
v_mov_b32 v200, 0
s_waitcnt vmcnt(0)
v_cmp_gt_u32 vcc, 1, v14
s_cbranch_vccnz M_cspin
M_cok:
v_mfma_f32_16x16x32_bf16 v[96:99], a[64:67], a[96:99], v[96:99]
s_add_u32 s22, s78, 0
ds_read_b64_tr_b16 a[128:129], v16 offset:328
v_mov_b32 v201, 0
v_mfma_f32_16x16x32_bf16 v[100:103], a[64:67], a[100:103], v[100:103]
ds_read_b64_tr_b16 a[130:131], v16 offset:320
v_mov_b32 v202, 0
v_mfma_f32_16x16x32_bf16 v[100:103], a[68:71], a[96:99], v[100:103]
ds_read_b128 a[160:163], v17 offset:128
v_mov_b32 v203, 0
v_mfma_f32_16x16x32_bf16 v[104:107], a[64:67], a[104:107], v[104:107]
buffer_load_dwordx4 a[0:3], v1, s[4:7], s22 offen offset:0 sc1
v_mfma_f32_16x16x32_bf16 v[104:107], a[68:71], a[100:103], v[104:107]
ds_read_b64_tr_b16 a[132:133], v16 offset:840
v_mov_b32 v204, 0
v_mfma_f32_16x16x32_bf16 v[104:107], a[72:75], a[96:99], v[104:107]
ds_read_b64_tr_b16 a[134:135], v16 offset:832
v_mov_b32 v205, 0
v_mfma_f32_16x16x32_bf16 v[108:111], a[64:67], a[108:111], v[108:111]
ds_read_b128 a[164:167], v17 offset:640
v_mov_b32 v206, 0
v_mfma_f32_16x16x32_bf16 v[108:111], a[68:71], a[104:107], v[108:111]
buffer_load_dwordx4 a[4:7], v1, s[4:7], s22 offen offset:1024 sc1
v_mfma_f32_16x16x32_bf16 v[108:111], a[72:75], a[100:103], v[108:111]
ds_read_b64_tr_b16 a[136:137], v16 offset:1352
v_mov_b32 v207, 0
v_mfma_f32_16x16x32_bf16 v[108:111], a[76:79], a[96:99], v[108:111]
ds_read_b64_tr_b16 a[138:139], v16 offset:1344
v_mov_b32 v208, 0
v_mfma_f32_16x16x32_bf16 v[112:115], a[64:67], a[112:115], v[112:115]
ds_read_b128 a[168:171], v17 offset:1152
v_mov_b32 v209, 0
v_mfma_f32_16x16x32_bf16 v[112:115], a[68:71], a[108:111], v[112:115]
buffer_load_dwordx4 a[8:11], v1, s[4:7], s22 offen offset:2048 sc1
v_mfma_f32_16x16x32_bf16 v[112:115], a[72:75], a[104:107], v[112:115]
ds_read_b64_tr_b16 a[140:141], v16 offset:1864
v_mov_b32 v210, 0
v_mfma_f32_16x16x32_bf16 v[112:115], a[76:79], a[100:103], v[112:115]
ds_read_b64_tr_b16 a[142:143], v16 offset:1856
v_mov_b32 v211, 0
v_mfma_f32_16x16x32_bf16 v[112:115], a[80:83], a[96:99], v[112:115]
s_waitcnt lgkmcnt(6)
ds_read_b128 a[172:175], v17 offset:1664
v_mov_b32 v212, 0
v_mfma_f32_16x16x32_bf16 v[116:119], a[64:67], a[116:119], v[116:119]
buffer_load_dwordx4 a[12:15], v1, s[4:7], s22 offen offset:3072 sc1
v_mfma_f32_16x16x32_bf16 v[116:119], a[68:71], a[112:115], v[116:119]
s_add_u32 s22, s78, 4096
ds_read_b64_tr_b16 a[144:145], v16 offset:2376
v_mov_b32 v213, 0
v_mfma_f32_16x16x32_bf16 v[116:119], a[72:75], a[108:111], v[116:119]
ds_read_b64_tr_b16 a[146:147], v16 offset:2368
v_mov_b32 v214, 0
v_mfma_f32_16x16x32_bf16 v[116:119], a[76:79], a[104:107], v[116:119]
ds_read_b128 a[176:179], v17 offset:2176
v_mov_b32 v215, 0
v_mfma_f32_16x16x32_bf16 v[116:119], a[80:83], a[100:103], v[116:119]
buffer_load_dwordx4 a[16:19], v1, s[4:7], s22 offen offset:0 sc1
v_mfma_f32_16x16x32_bf16 v[116:119], a[84:87], a[96:99], v[116:119]
ds_read_b64_tr_b16 a[148:149], v16 offset:2888
v_mov_b32 v216, 0
v_mfma_f32_16x16x32_bf16 v[120:123], a[64:67], a[120:123], v[120:123]
ds_read_b64_tr_b16 a[150:151], v16 offset:2880
v_mov_b32 v217, 0
v_mfma_f32_16x16x32_bf16 v[120:123], a[68:71], a[116:119], v[120:123]
ds_read_b128 a[180:183], v17 offset:2688
v_mov_b32 v218, 0
v_mfma_f32_16x16x32_bf16 v[120:123], a[72:75], a[112:115], v[120:123]
buffer_load_dwordx4 a[20:23], v1, s[4:7], s22 offen offset:1024 sc1
v_mfma_f32_16x16x32_bf16 v[120:123], a[76:79], a[108:111], v[120:123]
ds_read_b64_tr_b16 a[152:153], v16 offset:3400
v_mov_b32 v219, 0
v_mfma_f32_16x16x32_bf16 v[120:123], a[80:83], a[104:107], v[120:123]
ds_read_b64_tr_b16 a[154:155], v16 offset:3392
v_mov_b32 v220, 0
v_mfma_f32_16x16x32_bf16 v[120:123], a[84:87], a[100:103], v[120:123]
ds_read_b128 a[184:187], v17 offset:3200
v_mov_b32 v221, 0
v_mfma_f32_16x16x32_bf16 v[120:123], a[88:91], a[96:99], v[120:123]
buffer_load_dwordx4 a[24:27], v1, s[4:7], s22 offen offset:2048 sc1
v_mfma_f32_16x16x32_bf16 v[124:127], a[64:67], a[124:127], v[124:127]
ds_read_b64_tr_b16 a[156:157], v16 offset:3912
v_mov_b32 v222, 0
v_mfma_f32_16x16x32_bf16 v[124:127], a[68:71], a[120:123], v[124:127]
ds_read_b64_tr_b16 a[158:159], v16 offset:3904
v_mov_b32 v223, 0
v_mfma_f32_16x16x32_bf16 v[124:127], a[72:75], a[116:119], v[124:127]
ds_read_b128 a[188:191], v17 offset:3712
v_mov_b32 v224, 0
v_mfma_f32_16x16x32_bf16 v[124:127], a[76:79], a[112:115], v[124:127]
buffer_load_dwordx4 a[28:31], v1, s[4:7], s22 offen offset:3072 sc1
v_mfma_f32_16x16x32_bf16 v[124:127], a[80:83], a[108:111], v[124:127]
s_add_u32 s22, s78, 32768
buffer_load_dwordx4 a[32:35], v1, s[4:7], s22 offen offset:0 sc1
v_mfma_f32_16x16x32_bf16 v[124:127], a[84:87], a[104:107], v[124:127]
buffer_load_dwordx4 a[36:39], v1, s[4:7], s22 offen offset:1024 sc1
v_mfma_f32_16x16x32_bf16 v[124:127], a[88:91], a[100:103], v[124:127]
buffer_load_dwordx4 a[40:43], v1, s[4:7], s22 offen offset:2048 sc1
v_mfma_f32_16x16x32_bf16 v[124:127], a[92:95], a[96:99], v[124:127]
s_waitcnt lgkmcnt(3)
buffer_load_dwordx4 a[44:47], v1, s[4:7], s22 offen offset:3072 sc1
v_mfma_f32_16x16x32_bf16 v[96:99], a[128:131], a[160:163], v[96:99]
s_add_u32 s22, s78, 36864
ds_read_b64_tr_b16 a[64:65], v16 offset:392
v_mov_b32 v225, 0
v_mfma_f32_16x16x32_bf16 v[100:103], a[128:131], a[164:167], v[100:103]
ds_read_b64_tr_b16 a[66:67], v16 offset:384
v_mov_b32 v226, 0
v_mfma_f32_16x16x32_bf16 v[100:103], a[132:135], a[160:163], v[100:103]
ds_read_b128 a[96:99], v17 offset:64
v_mov_b32 v227, 0
v_mfma_f32_16x16x32_bf16 v[104:107], a[128:131], a[168:171], v[104:107]
ds_read_b64 v[36:37], v18 offset:0
v_mov_b32 v228, 0
v_mfma_f32_16x16x32_bf16 v[104:107], a[132:135], a[164:167], v[104:107]
ds_read_b64_tr_b16 a[68:69], v16 offset:904
v_mov_b32 v229, 0
v_mfma_f32_16x16x32_bf16 v[104:107], a[136:139], a[160:163], v[104:107]
ds_read_b64_tr_b16 a[70:71], v16 offset:896
v_mov_b32 v230, 0
v_mfma_f32_16x16x32_bf16 v[108:111], a[128:131], a[172:175], v[108:111]
ds_read_b128 a[100:103], v17 offset:576
v_mov_b32 v231, 0
v_mfma_f32_16x16x32_bf16 v[108:111], a[132:135], a[168:171], v[108:111]
ds_read_b64 v[38:39], v18 offset:512
v_mov_b32 v232, 0
v_mfma_f32_16x16x32_bf16 v[108:111], a[136:139], a[164:167], v[108:111]
ds_read_b64_tr_b16 a[72:73], v16 offset:1416
v_mov_b32 v233, 0
v_mfma_f32_16x16x32_bf16 v[108:111], a[140:143], a[160:163], v[108:111]
ds_read_b64_tr_b16 a[74:75], v16 offset:1408
v_mov_b32 v234, 0
v_mfma_f32_16x16x32_bf16 v[112:115], a[128:131], a[176:179], v[112:115]
ds_read_b128 a[104:107], v17 offset:1088
v_mov_b32 v235, 0
v_mfma_f32_16x16x32_bf16 v[112:115], a[132:135], a[172:175], v[112:115]
ds_read_b64 v[44:45], v18 offset:1024
v_mov_b32 v236, 0
v_mfma_f32_16x16x32_bf16 v[112:115], a[136:139], a[168:171], v[112:115]
ds_read_b64_tr_b16 a[76:77], v16 offset:1928
v_mov_b32 v237, 0
v_mfma_f32_16x16x32_bf16 v[112:115], a[140:143], a[164:167], v[112:115]
ds_read_b64_tr_b16 a[78:79], v16 offset:1920
v_mov_b32 v238, 0
v_mfma_f32_16x16x32_bf16 v[112:115], a[144:147], a[160:163], v[112:115]
ds_read_b128 a[108:111], v17 offset:1600
v_mov_b32 v239, 0
v_mfma_f32_16x16x32_bf16 v[116:119], a[128:131], a[180:183], v[116:119]
ds_read_b64 v[46:47], v18 offset:1536
v_mov_b32 v240, 0
v_mfma_f32_16x16x32_bf16 v[116:119], a[132:135], a[176:179], v[116:119]
ds_read_b64_tr_b16 a[80:81], v16 offset:2440
v_mov_b32 v241, 0
v_mfma_f32_16x16x32_bf16 v[116:119], a[136:139], a[172:175], v[116:119]
ds_read_b64_tr_b16 a[82:83], v16 offset:2432
v_mov_b32 v242, 0
v_mfma_f32_16x16x32_bf16 v[116:119], a[140:143], a[168:171], v[116:119]
ds_read_b128 a[112:115], v17 offset:2112
v_mov_b32 v243, 0
v_mfma_f32_16x16x32_bf16 v[116:119], a[144:147], a[164:167], v[116:119]
ds_read_b64 v[52:53], v18 offset:2048
v_mov_b32 v244, 0
v_mfma_f32_16x16x32_bf16 v[116:119], a[148:151], a[160:163], v[116:119]
ds_read_b64_tr_b16 a[84:85], v16 offset:2952
v_mov_b32 v245, 0
v_mfma_f32_16x16x32_bf16 v[120:123], a[128:131], a[184:187], v[120:123]
ds_read_b64_tr_b16 a[86:87], v16 offset:2944
v_mov_b32 v246, 0
v_mfma_f32_16x16x32_bf16 v[120:123], a[132:135], a[180:183], v[120:123]
ds_read_b128 a[116:119], v17 offset:2624
v_mov_b32 v247, 0
v_mfma_f32_16x16x32_bf16 v[120:123], a[136:139], a[176:179], v[120:123]
ds_read_b64 v[54:55], v18 offset:2560
v_mov_b32 v248, 0
v_mfma_f32_16x16x32_bf16 v[120:123], a[140:143], a[172:175], v[120:123]
ds_read_b64_tr_b16 a[88:89], v16 offset:3464
v_mov_b32 v249, 0
v_mfma_f32_16x16x32_bf16 v[120:123], a[144:147], a[168:171], v[120:123]
ds_read_b64_tr_b16 a[90:91], v16 offset:3456
v_mov_b32 v250, 0
v_mfma_f32_16x16x32_bf16 v[120:123], a[148:151], a[164:167], v[120:123]
ds_read_b128 a[120:123], v17 offset:3136
v_mov_b32 v251, 0
v_mfma_f32_16x16x32_bf16 v[120:123], a[152:155], a[160:163], v[120:123]
s_waitcnt lgkmcnt(8)
ds_read_b64 v[60:61], v18 offset:3072
v_mov_b32 v252, 0
v_mfma_f32_16x16x32_bf16 v[124:127], a[128:131], a[188:191], v[124:127]
ds_read_b64_tr_b16 a[92:93], v16 offset:3976
v_mov_b32 v253, 0
v_mfma_f32_16x16x32_bf16 v[124:127], a[132:135], a[184:187], v[124:127]
ds_read_b64_tr_b16 a[94:95], v16 offset:3968
v_mov_b32 v254, 0
v_mfma_f32_16x16x32_bf16 v[124:127], a[136:139], a[180:183], v[124:127]
ds_read_b128 a[124:127], v17 offset:3648
v_mov_b32 v255, 0
v_mfma_f32_16x16x32_bf16 v[124:127], a[140:143], a[176:179], v[124:127]
ds_read_b64 v[62:63], v18 offset:3584
v_mfma_f32_16x16x32_bf16 v[124:127], a[144:147], a[172:175], v[124:127]
buffer_load_dwordx4 a[48:51], v1, s[4:7], s22 offen offset:0 sc1
v_mfma_f32_16x16x32_bf16 v[124:127], a[148:151], a[168:171], v[124:127]
buffer_load_dwordx4 a[52:55], v1, s[4:7], s22 offen offset:1024 sc1
v_mfma_f32_16x16x32_bf16 v[124:127], a[152:155], a[164:167], v[124:127]
buffer_load_dwordx4 a[56:59], v1, s[4:7], s22 offen offset:2048 sc1
v_mfma_f32_16x16x32_bf16 v[124:127], a[156:159], a[160:163], v[124:127]
buffer_load_dwordx4 a[60:63], v1, s[4:7], s22 offen offset:3072 sc1
v_mfma_f32_16x16x32_bf16 v[96:99], a[64:67], a[96:99], v[96:99]
ds_read_b64_tr_b16 a[128:129], v16 offset:456
v_mfma_f32_16x16x32_bf16 v[100:103], a[64:67], a[100:103], v[100:103]
ds_read_b64_tr_b16 a[130:131], v16 offset:448
v_mfma_f32_16x16x32_bf16 v[100:103], a[68:71], a[96:99], v[100:103]
ds_read_b128 a[160:163], v17 offset:0
v_mfma_f32_16x16x32_bf16 v[104:107], a[64:67], a[104:107], v[104:107]
v_mfma_f32_16x16x32_bf16 v[104:107], a[68:71], a[100:103], v[104:107]
ds_read_b64_tr_b16 a[132:133], v16 offset:968
v_mfma_f32_16x16x32_bf16 v[104:107], a[72:75], a[96:99], v[104:107]
ds_read_b64_tr_b16 a[134:135], v16 offset:960
v_mfma_f32_16x16x32_bf16 v[108:111], a[64:67], a[108:111], v[108:111]
ds_read_b128 a[164:167], v17 offset:512
v_mfma_f32_16x16x32_bf16 v[108:111], a[68:71], a[104:107], v[108:111]
v_mfma_f32_16x16x32_bf16 v[108:111], a[72:75], a[100:103], v[108:111]
ds_read_b64_tr_b16 a[136:137], v16 offset:1480
v_mfma_f32_16x16x32_bf16 v[108:111], a[76:79], a[96:99], v[108:111]
ds_read_b64_tr_b16 a[138:139], v16 offset:1472
v_mfma_f32_16x16x32_bf16 v[112:115], a[64:67], a[112:115], v[112:115]
ds_read_b128 a[168:171], v17 offset:1024
v_mfma_f32_16x16x32_bf16 v[112:115], a[68:71], a[108:111], v[112:115]
v_mfma_f32_16x16x32_bf16 v[112:115], a[72:75], a[104:107], v[112:115]
ds_read_b64_tr_b16 a[140:141], v16 offset:1992
v_mfma_f32_16x16x32_bf16 v[112:115], a[76:79], a[100:103], v[112:115]
ds_read_b64_tr_b16 a[142:143], v16 offset:1984
v_mfma_f32_16x16x32_bf16 v[112:115], a[80:83], a[96:99], v[112:115]
s_waitcnt lgkmcnt(6)
ds_read_b128 a[172:175], v17 offset:1536
v_mfma_f32_16x16x32_bf16 v[116:119], a[64:67], a[116:119], v[116:119]
v_mfma_f32_16x16x32_bf16 v[116:119], a[68:71], a[112:115], v[116:119]
ds_read_b64_tr_b16 a[144:145], v16 offset:2504
v_mfma_f32_16x16x32_bf16 v[116:119], a[72:75], a[108:111], v[116:119]
ds_read_b64_tr_b16 a[146:147], v16 offset:2496
v_mfma_f32_16x16x32_bf16 v[116:119], a[76:79], a[104:107], v[116:119]
ds_read_b128 a[176:179], v17 offset:2048
v_mfma_f32_16x16x32_bf16 v[116:119], a[80:83], a[100:103], v[116:119]
v_mfma_f32_16x16x32_bf16 v[116:119], a[84:87], a[96:99], v[116:119]
ds_read_b64_tr_b16 a[148:149], v16 offset:3016
v_mfma_f32_16x16x32_bf16 v[120:123], a[64:67], a[120:123], v[120:123]
ds_read_b64_tr_b16 a[150:151], v16 offset:3008
v_mfma_f32_16x16x32_bf16 v[120:123], a[68:71], a[116:119], v[120:123]
ds_read_b128 a[180:183], v17 offset:2560
v_mfma_f32_16x16x32_bf16 v[120:123], a[72:75], a[112:115], v[120:123]
v_mfma_f32_16x16x32_bf16 v[120:123], a[76:79], a[108:111], v[120:123]
ds_read_b64_tr_b16 a[152:153], v16 offset:3528
v_mfma_f32_16x16x32_bf16 v[120:123], a[80:83], a[104:107], v[120:123]
ds_read_b64_tr_b16 a[154:155], v16 offset:3520
v_mfma_f32_16x16x32_bf16 v[120:123], a[84:87], a[100:103], v[120:123]
ds_read_b128 a[184:187], v17 offset:3072
v_mfma_f32_16x16x32_bf16 v[120:123], a[88:91], a[96:99], v[120:123]
v_mfma_f32_16x16x32_bf16 v[124:127], a[64:67], a[124:127], v[124:127]
ds_read_b64_tr_b16 a[156:157], v16 offset:4040
v_mfma_f32_16x16x32_bf16 v[124:127], a[68:71], a[120:123], v[124:127]
ds_read_b64_tr_b16 a[158:159], v16 offset:4032
v_mfma_f32_16x16x32_bf16 v[124:127], a[72:75], a[116:119], v[124:127]
ds_read_b128 a[188:191], v17 offset:3584
v_mfma_f32_16x16x32_bf16 v[124:127], a[76:79], a[112:115], v[124:127]
v_mfma_f32_16x16x32_bf16 v[124:127], a[80:83], a[108:111], v[124:127]
v_mfma_f32_16x16x32_bf16 v[124:127], a[84:87], a[104:107], v[124:127]
v_mfma_f32_16x16x32_bf16 v[124:127], a[88:91], a[100:103], v[124:127]
v_mfma_f32_16x16x32_bf16 v[124:127], a[92:95], a[96:99], v[124:127]
v_mfma_f32_16x16x32_bf16 v[96:99], a[128:131], a[160:163], v[96:99]
s_waitcnt lgkmcnt(3)
v_mfma_f32_16x16x32_bf16 v[100:103], a[128:131], a[164:167], v[100:103]
v_mfma_f32_16x16x32_bf16 v[100:103], a[132:135], a[160:163], v[100:103]
v_mfma_f32_16x16x32_bf16 v[104:107], a[128:131], a[168:171], v[104:107]
v_mfma_f32_16x16x32_bf16 v[104:107], a[132:135], a[164:167], v[104:107]
v_mfma_f32_16x16x32_bf16 v[104:107], a[136:139], a[160:163], v[104:107]
v_mfma_f32_16x16x32_bf16 v[108:111], a[128:131], a[172:175], v[108:111]
v_mfma_f32_16x16x32_bf16 v[108:111], a[132:135], a[168:171], v[108:111]
v_mfma_f32_16x16x32_bf16 v[108:111], a[136:139], a[164:167], v[108:111]
v_lshlrev_b32 v10, 16, v36
v_fmac_f32 v96, v19, v10
v_mfma_f32_16x16x32_bf16 v[108:111], a[140:143], a[160:163], v[108:111]
v_and_b32 v11, 0xffff0000, v36
v_fmac_f32 v97, v19, v11
v_mfma_f32_16x16x32_bf16 v[112:115], a[128:131], a[176:179], v[112:115]
v_lshlrev_b32 v12, 16, v37
v_fmac_f32 v98, v19, v12
v_mfma_f32_16x16x32_bf16 v[112:115], a[132:135], a[172:175], v[112:115]
v_and_b32 v13, 0xffff0000, v37
v_fmac_f32 v99, v19, v13
v_mfma_f32_16x16x32_bf16 v[112:115], a[136:139], a[168:171], v[112:115]
v_cvt_pk_bf16_f32 v96, v96, v97
v_cvt_pk_bf16_f32 v97, v98, v99
v_mfma_f32_16x16x32_bf16 v[112:115], a[140:143], a[164:167], v[112:115]
buffer_store_dwordx2 v[96:97], v8, s[4:7], s83 offen offset:0 sc1
v_mfma_f32_16x16x32_bf16 v[112:115], a[144:147], a[160:163], v[112:115]
v_lshlrev_b32 v10, 16, v38
v_fmac_f32 v100, v19, v10
v_mfma_f32_16x16x32_bf16 v[116:119], a[128:131], a[180:183], v[116:119]
v_and_b32 v11, 0xffff0000, v38
v_fmac_f32 v101, v19, v11
v_mfma_f32_16x16x32_bf16 v[116:119], a[132:135], a[176:179], v[116:119]
v_lshlrev_b32 v12, 16, v39
v_fmac_f32 v102, v19, v12
v_mfma_f32_16x16x32_bf16 v[116:119], a[136:139], a[172:175], v[116:119]
PAD_31:
s_cbranch_execz M_tret
v_and_b32 v13, 0xffff0000, v39
v_fmac_f32 v103, v19, v13
v_mfma_f32_16x16x32_bf16 v[116:119], a[140:143], a[168:171], v[116:119]
v_cvt_pk_bf16_f32 v100, v100, v101
v_cvt_pk_bf16_f32 v101, v102, v103
v_mfma_f32_16x16x32_bf16 v[116:119], a[144:147], a[164:167], v[116:119]
buffer_store_dwordx2 v[100:101], v8, s[4:7], s83 offen offset:512 sc1
v_mfma_f32_16x16x32_bf16 v[116:119], a[148:151], a[160:163], v[116:119]
v_lshlrev_b32 v10, 16, v44
v_fmac_f32 v104, v19, v10
v_mfma_f32_16x16x32_bf16 v[120:123], a[128:131], a[184:187], v[120:123]
v_and_b32 v11, 0xffff0000, v44
v_fmac_f32 v105, v19, v11
v_mfma_f32_16x16x32_bf16 v[120:123], a[132:135], a[180:183], v[120:123]
v_lshlrev_b32 v12, 16, v45
v_fmac_f32 v106, v19, v12
v_mfma_f32_16x16x32_bf16 v[120:123], a[136:139], a[176:179], v[120:123]
v_and_b32 v13, 0xffff0000, v45
v_fmac_f32 v107, v19, v13
v_mfma_f32_16x16x32_bf16 v[120:123], a[140:143], a[172:175], v[120:123]
v_cvt_pk_bf16_f32 v104, v104, v105
v_cvt_pk_bf16_f32 v105, v106, v107
v_mfma_f32_16x16x32_bf16 v[120:123], a[144:147], a[168:171], v[120:123]
buffer_store_dwordx2 v[104:105], v8, s[4:7], s83 offen offset:1024 sc1
v_mfma_f32_16x16x32_bf16 v[120:123], a[148:151], a[164:167], v[120:123]
v_lshlrev_b32 v10, 16, v46
v_fmac_f32 v108, v19, v10
v_mfma_f32_16x16x32_bf16 v[120:123], a[152:155], a[160:163], v[120:123]
s_waitcnt lgkmcnt(0)
v_and_b32 v11, 0xffff0000, v46
v_fmac_f32 v109, v19, v11
v_mfma_f32_16x16x32_bf16 v[124:127], a[128:131], a[188:191], v[124:127]
v_lshlrev_b32 v12, 16, v47
v_fmac_f32 v110, v19, v12
v_mfma_f32_16x16x32_bf16 v[124:127], a[132:135], a[184:187], v[124:127]
v_and_b32 v13, 0xffff0000, v47
v_fmac_f32 v111, v19, v13
v_mfma_f32_16x16x32_bf16 v[124:127], a[136:139], a[180:183], v[124:127]
v_cvt_pk_bf16_f32 v108, v108, v109
v_cvt_pk_bf16_f32 v109, v110, v111
v_mfma_f32_16x16x32_bf16 v[124:127], a[140:143], a[176:179], v[124:127]
buffer_store_dwordx2 v[108:109], v8, s[4:7], s83 offen offset:1536 sc1
v_mfma_f32_16x16x32_bf16 v[124:127], a[144:147], a[172:175], v[124:127]
v_lshlrev_b32 v10, 16, v52
v_fmac_f32 v112, v19, v10
v_mfma_f32_16x16x32_bf16 v[124:127], a[148:151], a[168:171], v[124:127]
v_and_b32 v11, 0xffff0000, v52
v_fmac_f32 v113, v19, v11
v_mfma_f32_16x16x32_bf16 v[124:127], a[152:155], a[164:167], v[124:127]
v_lshlrev_b32 v12, 16, v53
v_fmac_f32 v114, v19, v12
v_mfma_f32_16x16x32_bf16 v[124:127], a[156:159], a[160:163], v[124:127]
v_and_b32 v13, 0xffff0000, v53
v_fmac_f32 v115, v19, v13
v_cvt_pk_bf16_f32 v112, v112, v113
v_cvt_pk_bf16_f32 v113, v114, v115
buffer_store_dwordx2 v[112:113], v8, s[4:7], s83 offen offset:2048 sc1
v_lshlrev_b32 v10, 16, v54
v_fmac_f32 v116, v19, v10
v_and_b32 v11, 0xffff0000, v54
v_fmac_f32 v117, v19, v11
v_lshlrev_b32 v12, 16, v55
v_fmac_f32 v118, v19, v12
v_and_b32 v13, 0xffff0000, v55
v_fmac_f32 v119, v19, v13
v_cvt_pk_bf16_f32 v116, v116, v117
v_cvt_pk_bf16_f32 v117, v118, v119
buffer_store_dwordx2 v[116:117], v8, s[4:7], s83 offen offset:2560 sc1
v_lshlrev_b32 v10, 16, v60
v_fmac_f32 v120, v19, v10
v_and_b32 v11, 0xffff0000, v60
v_fmac_f32 v121, v19, v11
v_lshlrev_b32 v12, 16, v61
v_fmac_f32 v122, v19, v12
v_and_b32 v13, 0xffff0000, v61
v_fmac_f32 v123, v19, v13
v_cvt_pk_bf16_f32 v120, v120, v121
v_cvt_pk_bf16_f32 v121, v122, v123
buffer_store_dwordx2 v[120:121], v8, s[4:7], s83 offen offset:3072 sc1
v_lshlrev_b32 v10, 16, v62
v_fmac_f32 v124, v19, v10
v_and_b32 v11, 0xffff0000, v62
v_fmac_f32 v125, v19, v11
v_lshlrev_b32 v12, 16, v63
v_fmac_f32 v126, v19, v12
v_and_b32 v13, 0xffff0000, v63
v_fmac_f32 v127, v19, v13
v_cvt_pk_bf16_f32 v124, v124, v125
v_cvt_pk_bf16_f32 v125, v126, v127
buffer_store_dwordx2 v[124:125], v8, s[4:7], s83 offen offset:3584 sc1
v_lshrrev_b32 v8, 7, v1
v_and_b32 v9, 6, v8
v_lshlrev_b32 v9, 4, v9
v_and_b32 v10, 0x70, v1
v_xor_b32 v9, v9, v10
v_mul_u32_u24 v8, 896, v8
v_add_u32 v8, v8, v9
v_accvgpr_write_b32 a184, v8
v_add_u32 v8, 6144, v8
v_accvgpr_write_b32 a185, v8
v_add_u32 v8, 6144, v8
v_accvgpr_write_b32 a186, v8
v_add_u32 v8, 6144, v8
v_accvgpr_write_b32 a187, v8
v_lshrrev_b32 v8, 6, v1
v_bfe_u32 v9, v1, 7, 2
v_lshlrev_b32 v9, 5, v9
v_lshl_add_u32 v8, v8, 7, v9
v_bfe_u32 v9, v1, 4, 2
v_lshl_add_u32 v8, v9, 3, v8
v_add_u32 v8, 32768, v8
v_accvgpr_write_b32 a188, v8
v_xor_b32 v9, 32, v8
v_accvgpr_write_b32 a189, v9
v_xor_b32 v9, 64, v8
v_accvgpr_write_b32 a190, v9
v_xor_b32 v9, 96, v8
v_accvgpr_write_b32 a191, v9
s_branch M_t2B
M_t2Br:
s_waitcnt vmcnt(8)
s_barrier
s_cmp_lg_u32 s24, 0
s_cbranch_scc1 K2_item
v_accvgpr_mov_b32 a0, a192
v_accvgpr_mov_b32 a1, a193
v_accvgpr_mov_b32 a2, a194
v_accvgpr_mov_b32 a3, a195
v_accvgpr_mov_b32 a4, a196
v_accvgpr_mov_b32 a5, a197
v_accvgpr_mov_b32 a6, a198
v_accvgpr_mov_b32 a7, a199
v_accvgpr_mov_b32 a8, a200
v_accvgpr_mov_b32 a9, a201
v_accvgpr_mov_b32 a10, a202
v_accvgpr_mov_b32 a11, a203
v_accvgpr_mov_b32 a12, a204
v_accvgpr_mov_b32 a13, a205
v_accvgpr_mov_b32 a14, a206
v_accvgpr_mov_b32 a15, a207
v_accvgpr_mov_b32 a16, a208
v_accvgpr_mov_b32 a17, a209
v_accvgpr_mov_b32 a18, a210
v_accvgpr_mov_b32 a19, a211
v_accvgpr_mov_b32 a20, a212
v_accvgpr_mov_b32 a21, a213
v_accvgpr_mov_b32 a22, a214
v_accvgpr_mov_b32 a23, a215
v_accvgpr_mov_b32 a24, a216
v_accvgpr_mov_b32 a25, a217
v_accvgpr_mov_b32 a26, a218
v_accvgpr_mov_b32 a27, a219
v_accvgpr_mov_b32 a28, a220
v_accvgpr_mov_b32 a29, a221
v_accvgpr_mov_b32 a30, a222
v_accvgpr_mov_b32 a31, a223
v_accvgpr_mov_b32 a32, a224
v_accvgpr_mov_b32 a33, a225
v_accvgpr_mov_b32 a34, a226
v_accvgpr_mov_b32 a35, a227
v_accvgpr_mov_b32 a36, a228
v_accvgpr_mov_b32 a37, a229
v_accvgpr_mov_b32 a38, a230
v_accvgpr_mov_b32 a39, a231
v_accvgpr_mov_b32 a40, a232
v_accvgpr_mov_b32 a41, a233
v_accvgpr_mov_b32 a42, a234
v_accvgpr_mov_b32 a43, a235
v_accvgpr_mov_b32 a44, a236
v_accvgpr_mov_b32 a45, a237
v_accvgpr_mov_b32 a46, a238
v_accvgpr_mov_b32 a47, a239
v_accvgpr_mov_b32 a48, a240
v_accvgpr_mov_b32 a49, a241
v_accvgpr_mov_b32 a50, a242
v_accvgpr_mov_b32 a51, a243
v_accvgpr_mov_b32 a52, a244
v_accvgpr_mov_b32 a53, a245
v_accvgpr_mov_b32 a54, a246
v_accvgpr_mov_b32 a55, a247
v_accvgpr_mov_b32 a56, a248
v_accvgpr_mov_b32 a57, a249
v_accvgpr_mov_b32 a58, a250
v_accvgpr_mov_b32 a59, a251
v_accvgpr_mov_b32 a60, a252
v_accvgpr_mov_b32 a61, a253
v_accvgpr_mov_b32 a62, a254
v_accvgpr_mov_b32 a63, a255
s_branch K2_item
M_cend:
M_cspin:
Lp_16:
buffer_load_dword v14, v15, s[4:7], s31 offen sc1
s_waitcnt vmcnt(0)
v_cmp_gt_u32 vcc, 1, v14
s_cbranch_vccz Lpd_17
s_sleep 8
s_sub_u32 s101, s101, 1
s_cbranch_scc0 Lp_16
s_mov_b32 s101, 0
Lpd_17:
s_branch M_cok
M_kspin:
Lp_18:
buffer_load_dword v21, v20, s[4:7], s70 offen sc1
s_waitcnt vmcnt(0)
v_cmp_gt_u32 vcc, 1, v21
s_cbranch_vccz Lpd_19
s_sleep 8
s_sub_u32 s101, s101, 1
s_cbranch_scc0 Lp_18
s_mov_b32 s101, 0
Lpd_19:
s_branch M_kok
M_kspin2:
Lp_20:
buffer_load_dword v21, v20, s[4:7], s31 offen sc1
s_waitcnt vmcnt(0)
v_cmp_gt_u32 vcc, 1, v21
s_cbranch_vccz Lpd_21
s_sleep 8
s_sub_u32 s101, s101, 1
s_cbranch_scc0 Lp_20
s_mov_b32 s101, 0
Lpd_21:
s_branch M_kok2
M_vspin:
Lp_22:
buffer_load_dword v21, v15, s[4:7], s70 offen sc1
s_waitcnt vmcnt(0)
v_cmp_gt_u32 vcc, 1, v21
s_cbranch_vccz Lpd_23
s_sleep 8
s_sub_u32 s101, s101, 1
s_cbranch_scc0 Lp_22
s_mov_b32 s101, 0
Lpd_23:
s_branch M_vok
PAD_32:
s_cbranch_execz M_tret
K2_plain:
v_mfma_f32_16x16x32_bf16 v[128:131], a[64:67], v[96:99], v[128:131]
s_waitcnt lgkmcnt(6)
ds_read_b128 a[96:99], v2 offset:8192
v_add_f32 v24, v24, v26
v_mfma_f32_16x16x32_bf16 v[128:131], a[68:71], v[100:103], v[128:131]
s_waitcnt lgkmcnt(5)
v_mfma_f32_16x16x32_bf16 v[132:135], a[68:71], v[108:111], v[132:135]
s_mov_b64 s[36:37], s[86:87]
ds_read_b128 a[100:103], v2 offset:9216
v_add_f32 v25, v25, v27
v_mfma_f32_16x16x32_bf16 v[132:135], a[64:67], v[104:107], v[132:135]
s_mov_b32 s38, 3670016
v_exp_f32 v8, v68
v_mfma_f32_16x16x32_bf16 v[136:139], a[72:75], v[96:99], v[136:139]
s_mov_b32 s39, 0x20000
ds_read_b128 a[104:107], v2 offset:10240
v_accvgpr_read_b32 v112, a184
v_mfma_f32_16x16x32_bf16 v[136:139], a[76:79], v[100:103], v[136:139]
v_accvgpr_read_b32 v113, a185
v_accvgpr_read_b32 v114, a186
v_mfma_f32_16x16x32_bf16 v[140:143], a[76:79], v[108:111], v[140:143]
ds_read_b128 a[108:111], v2 offset:11264
v_accvgpr_read_b32 v115, a187
v_mfma_f32_16x16x32_bf16 v[140:143], a[72:75], v[104:107], v[140:143]
s_waitcnt lgkmcnt(5)
v_accvgpr_read_b32 v116, a188
v_accvgpr_read_b32 v117, a189
v_mfma_f32_16x16x32_bf16 v[144:147], a[80:83], v[96:99], v[144:147]
ds_read_b128 a[112:115], v2 offset:12288
v_accvgpr_read_b32 v118, a190
v_mfma_f32_16x16x32_bf16 v[144:147], a[84:87], v[100:103], v[144:147]
v_accvgpr_read_b32 v119, a191
v_mfma_f32_16x16x32_bf16 v[148:151], a[84:87], v[108:111], v[148:151]
s_add_u32 m0, s18, 32768
ds_read_b128 a[116:119], v2 offset:13312
v_cvt_pk_bf16_f32 v128, v128, v129
v_mfma_f32_16x16x32_bf16 v[148:151], a[80:83], v[104:107], v[148:151]
buffer_load_dwordx4 v112, s[36:39], s81 offen offset:0 lds
v_mfma_f32_16x16x32_bf16 v[152:155], a[88:91], v[96:99], v[152:155]
s_waitcnt lgkmcnt(4)
ds_read_b128 a[120:123], v2 offset:14336
v_cvt_pk_bf16_f32 v129, v130, v131
v_mfma_f32_16x16x32_bf16 v[152:155], a[92:95], v[100:103], v[152:155]
v_exp_f32 v9, v69
v_mfma_f32_16x16x32_bf16 v[156:159], a[92:95], v[108:111], v[156:159]
ds_read_b128 a[124:127], v2 offset:15360
v_add_f32 v27, v8, v9
v_mfma_f32_16x16x32_bf16 v[156:159], a[88:91], v[104:107], v[156:159]
buffer_load_dwordx4 v113, s[36:39], s81 offen offset:1024 lds
v_mfma_f32_16x16x32_bf16 v[160:163], a[96:99], v[96:99], v[160:163]
ds_read_b128 a[64:67], v2 offset:16384
v_cvt_pk_bf16_f32 v120, v8, v9
v_mfma_f32_16x16x32_bf16 v[160:163], a[100:103], v[100:103], v[160:163]
v_exp_f32 v10, v70
v_mfma_f32_16x16x32_bf16 v[164:167], a[100:103], v[108:111], v[164:167]
ds_read_b128 a[68:71], v2 offset:17408
v_add_f32 v27, v27, v10
v_mfma_f32_16x16x32_bf16 v[164:167], a[96:99], v[104:107], v[164:167]
s_waitcnt lgkmcnt(4)
buffer_load_dwordx4 v114, s[36:39], s81 offen offset:2048 lds
v_mfma_f32_16x16x32_bf16 v[168:171], a[104:107], v[96:99], v[168:171]
ds_read_b128 a[72:75], v2 offset:18432
v_cvt_pk_bf16_f32 v130, v136, v137
v_mfma_f32_16x16x32_bf16 v[168:171], a[108:111], v[100:103], v[168:171]
v_exp_f32 v11, v71
v_mfma_f32_16x16x32_bf16 v[172:175], a[108:111], v[108:111], v[172:175]
ds_read_b128 a[76:79], v2 offset:19456
v_add_f32 v27, v27, v11
v_mfma_f32_16x16x32_bf16 v[172:175], a[104:107], v[104:107], v[172:175]
buffer_load_dwordx4 v115, s[36:39], s81 offen offset:3072 lds
v_mfma_f32_16x16x32_bf16 v[176:179], a[112:115], v[96:99], v[176:179]
ds_read_b128 a[80:83], v2 offset:20480
v_cvt_pk_bf16_f32 v121, v10, v11
v_mfma_f32_16x16x32_bf16 v[176:179], a[116:119], v[100:103], v[176:179]
s_waitcnt lgkmcnt(4)
v_exp_f32 v12, v76
v_mfma_f32_16x16x32_bf16 v[180:183], a[116:119], v[108:111], v[180:183]
s_add_u32 s81, s81, 28672
ds_read_b128 a[84:87], v2 offset:21504
v_add_f32 v27, v27, v12
v_mfma_f32_16x16x32_bf16 v[180:183], a[112:115], v[104:107], v[180:183]
s_add_u32 m0, s18, 36864
v_exp_f32 v13, v77
v_mfma_f32_16x16x32_bf16 v[184:187], a[120:123], v[96:99], v[184:187]
ds_read_b128 a[88:91], v2 offset:22528
v_add_f32 v27, v27, v13
v_mfma_f32_16x16x32_bf16 v[184:187], a[124:127], v[100:103], v[184:187]
buffer_load_dwordx4 v112, s[36:39], s81 offen offset:0 lds
v_mfma_f32_16x16x32_bf16 v[188:191], a[124:127], v[108:111], v[188:191]
ds_read_b128 a[92:95], v2 offset:23552
v_cvt_pk_bf16_f32 v122, v12, v13
v_mfma_f32_16x16x32_bf16 v[188:191], a[120:123], v[104:107], v[188:191]
v_exp_f32 v14, v78
v_mfma_f32_16x16x32_bf16 v[192:195], a[64:67], v[96:99], v[192:195]
s_waitcnt lgkmcnt(4)
ds_read_b128 a[96:99], v2 offset:24576
v_add_f32 v27, v27, v14
v_mfma_f32_16x16x32_bf16 v[192:195], a[68:71], v[100:103], v[192:195]
buffer_load_dwordx4 v113, s[36:39], s81 offen offset:1024 lds
v_mfma_f32_16x16x32_bf16 v[196:199], a[68:71], v[108:111], v[196:199]
ds_read_b128 a[100:103], v2 offset:25600
v_cvt_pk_bf16_f32 v131, v138, v139
v_mfma_f32_16x16x32_bf16 v[196:199], a[64:67], v[104:107], v[196:199]
v_exp_f32 v15, v79
v_mfma_f32_16x16x32_bf16 v[200:203], a[72:75], v[96:99], v[200:203]
ds_read_b128 a[104:107], v2 offset:26624
v_add_f32 v27, v27, v15
v_mfma_f32_16x16x32_bf16 v[200:203], a[76:79], v[100:103], v[200:203]
buffer_load_dwordx4 v114, s[36:39], s81 offen offset:2048 lds
v_mfma_f32_16x16x32_bf16 v[204:207], a[76:79], v[108:111], v[204:207]
ds_read_b128 a[108:111], v2 offset:27648
v_cvt_pk_bf16_f32 v123, v14, v15
v_mfma_f32_16x16x32_bf16 v[204:207], a[72:75], v[104:107], v[204:207]
s_waitcnt lgkmcnt(4)
v_exp_f32 v8, v84
v_mfma_f32_16x16x32_bf16 v[208:211], a[80:83], v[96:99], v[208:211]
ds_read_b128 a[112:115], v2 offset:28672
v_add_f32 v27, v27, v8
v_mfma_f32_16x16x32_bf16 v[208:211], a[84:87], v[100:103], v[208:211]
buffer_load_dwordx4 v115, s[36:39], s81 offen offset:3072 lds
v_mfma_f32_16x16x32_bf16 v[212:215], a[84:87], v[108:111], v[212:215]
ds_read_b128 a[116:119], v2 offset:29696
v_cvt_pk_bf16_f32 v144, v144, v145
v_mfma_f32_16x16x32_bf16 v[212:215], a[80:83], v[104:107], v[212:215]
v_exp_f32 v9, v85
v_mfma_f32_16x16x32_bf16 v[216:219], a[88:91], v[96:99], v[216:219]
s_sub_u32 s81, s81, 28544
ds_read_b128 a[120:123], v2 offset:30720
v_add_f32 v27, v27, v9
v_mfma_f32_16x16x32_bf16 v[216:219], a[92:95], v[100:103], v[216:219]
v_exp_f32 v10, v86
v_mfma_f32_16x16x32_bf16 v[220:223], a[92:95], v[108:111], v[220:223]
s_waitcnt vmcnt(8) lgkmcnt(4)
ds_read_b128 a[124:127], v2 offset:31744
v_cvt_pk_bf16_f32 v124, v8, v9
v_mfma_f32_16x16x32_bf16 v[220:223], a[88:91], v[104:107], v[220:223]
s_barrier
v_mfma_f32_16x16x32_bf16 v[224:227], a[96:99], v[96:99], v[224:227]
ds_read_b128 a[64:67], v1 offset:0
v_add_f32 v27, v27, v10
v_mfma_f32_16x16x32_bf16 v[224:227], a[100:103], v[100:103], v[224:227]
v_exp_f32 v11, v87
v_mfma_f32_16x16x32_bf16 v[228:231], a[100:103], v[108:111], v[228:231]
ds_read_b128 a[68:71], v1 offset:1024
v_add_f32 v27, v27, v11
v_mfma_f32_16x16x32_bf16 v[228:231], a[96:99], v[104:107], v[228:231]
v_exp_f32 v12, v92
v_mfma_f32_16x16x32_bf16 v[232:235], a[104:107], v[96:99], v[232:235]
s_waitcnt lgkmcnt(4)
ds_read_b128 a[72:75], v1 offset:2048
v_cvt_pk_bf16_f32 v125, v10, v11
v_mfma_f32_16x16x32_bf16 v[232:235], a[108:111], v[100:103], v[232:235]
v_exp_f32 v13, v93
v_mfma_f32_16x16x32_bf16 v[236:239], a[108:111], v[108:111], v[236:239]
ds_read_b128 a[76:79], v1 offset:3072
v_add_f32 v27, v27, v12
v_mfma_f32_16x16x32_bf16 v[236:239], a[104:107], v[104:107], v[236:239]
v_exp_f32 v14, v94
v_mfma_f32_16x16x32_bf16 v[240:243], a[112:115], v[96:99], v[240:243]
ds_read_b128 a[80:83], v1 offset:4096
v_add_f32 v27, v27, v13
v_mfma_f32_16x16x32_bf16 v[240:243], a[116:119], v[100:103], v[240:243]
v_exp_f32 v15, v95
v_mfma_f32_16x16x32_bf16 v[244:247], a[116:119], v[108:111], v[244:247]
ds_read_b128 a[84:87], v1 offset:5120
v_cvt_pk_bf16_f32 v126, v12, v13
v_mfma_f32_16x16x32_bf16 v[244:247], a[112:115], v[104:107], v[244:247]
s_waitcnt lgkmcnt(4)
v_add_f32 v27, v27, v14
v_add_f32 v27, v27, v15
v_mfma_f32_16x16x32_bf16 v[248:251], a[120:123], v[96:99], v[248:251]
ds_read_b128 a[88:91], v1 offset:6144
v_cvt_pk_bf16_f32 v127, v14, v15
v_mfma_f32_16x16x32_bf16 v[248:251], a[124:127], v[100:103], v[248:251]
v_cmp_nge_f32 vcc, s25, v27
v_cvt_pk_bf16_f32 v145, v146, v147
v_mfma_f32_16x16x32_bf16 v[252:255], a[124:127], v[108:111], v[252:255]
ds_read_b128 a[92:95], v1 offset:7168
v_cvt_pk_bf16_f32 v146, v152, v153
v_mfma_f32_16x16x32_bf16 v[252:255], a[120:123], v[104:107], v[252:255]
s_waitcnt lgkmcnt(2)
v_cvt_pk_bf16_f32 v147, v154, v155
v_cvt_pk_bf16_f32 v160, v160, v161
s_cbranch_vccnz Lstub_12
Lback_13:
v_mfma_f32_16x16x32_bf16 v[132:135], a[64:67], v[120:123], v[132:135]
s_lshl_b32 s8, s29, 3
ds_read_b128 a[96:99], v1 offset:8192
v_add_f32 v25, v25, v27
v_mfma_f32_16x16x32_bf16 v[132:135], a[68:71], v[124:127], v[132:135]
s_add_u32 s8, s8, s3
ds_read_b128 a[100:103], v1 offset:9216
v_cvt_pk_bf16_f32 v161, v162, v163
v_mfma_f32_16x16x32_bf16 v[140:143], a[72:75], v[120:123], v[140:143]
s_lshl_b32 s8, s8, 4
ds_read_b128 a[104:107], v1 offset:10240
v_cvt_pk_bf16_f32 v162, v168, v169
v_mfma_f32_16x16x32_bf16 v[140:143], a[76:79], v[124:127], v[140:143]
s_add_u32 s8, s8, s20
ds_read_b128 a[108:111], v1 offset:11264
v_cvt_pk_bf16_f32 v163, v170, v171
v_mfma_f32_16x16x32_bf16 v[148:151], a[80:83], v[120:123], v[148:151]
s_mul_i32 s8, s8, 14336
ds_read_b128 a[112:115], v1 offset:12288
v_cvt_pk_bf16_f32 v176, v176, v177
v_mfma_f32_16x16x32_bf16 v[148:151], a[84:87], v[124:127], v[148:151]
s_waitcnt lgkmcnt(5)
s_add_u32 s8, s8, 104857600
ds_read_b128 a[116:119], v1 offset:13312
v_cvt_pk_bf16_f32 v177, v178, v179
v_mfma_f32_16x16x32_bf16 v[156:159], a[88:91], v[120:123], v[156:159]
s_add_u32 s12, s8, 917504
ds_read_b128 a[120:123], v1 offset:14336
v_cvt_pk_bf16_f32 v178, v184, v185
v_mfma_f32_16x16x32_bf16 v[156:159], a[92:95], v[124:127], v[156:159]
s_waitcnt lgkmcnt(6)
ds_read_b128 a[124:127], v1 offset:15360
v_cvt_pk_bf16_f32 v179, v186, v187
v_mfma_f32_16x16x32_bf16 v[164:167], a[96:99], v[120:123], v[164:167]
s_waitcnt lgkmcnt(6)
ds_read_b128 a[64:67], v1 offset:16384
v_cvt_pk_bf16_f32 v192, v192, v193
v_mfma_f32_16x16x32_bf16 v[164:167], a[100:103], v[124:127], v[164:167]
s_waitcnt lgkmcnt(6)
ds_read_b128 a[68:71], v1 offset:17408
v_cvt_pk_bf16_f32 v193, v194, v195
v_mfma_f32_16x16x32_bf16 v[172:175], a[104:107], v[120:123], v[172:175]
s_waitcnt lgkmcnt(6)
ds_read_b128 a[72:75], v1 offset:18432
v_cvt_pk_bf16_f32 v194, v200, v201
v_mfma_f32_16x16x32_bf16 v[172:175], a[108:111], v[124:127], v[172:175]
s_waitcnt lgkmcnt(6)
ds_read_b128 a[76:79], v1 offset:19456
v_cvt_pk_bf16_f32 v195, v202, v203
v_mfma_f32_16x16x32_bf16 v[180:183], a[112:115], v[120:123], v[180:183]
s_waitcnt lgkmcnt(6)
ds_read_b128 a[80:83], v1 offset:20480
v_cvt_pk_bf16_f32 v208, v208, v209
v_mfma_f32_16x16x32_bf16 v[180:183], a[116:119], v[124:127], v[180:183]
s_waitcnt lgkmcnt(6)
ds_read_b128 a[84:87], v1 offset:21504
v_cvt_pk_bf16_f32 v209, v210, v211
v_mfma_f32_16x16x32_bf16 v[188:191], a[120:123], v[120:123], v[188:191]
s_waitcnt lgkmcnt(6)
ds_read_b128 a[88:91], v1 offset:22528
v_cvt_pk_bf16_f32 v210, v216, v217
v_mfma_f32_16x16x32_bf16 v[188:191], a[124:127], v[124:127], v[188:191]
s_waitcnt lgkmcnt(6)
ds_read_b128 a[92:95], v1 offset:23552
v_cvt_pk_bf16_f32 v211, v218, v219
v_mfma_f32_16x16x32_bf16 v[196:199], a[64:67], v[120:123], v[196:199]
s_waitcnt lgkmcnt(6)
ds_read_b128 a[96:99], v1 offset:24576
v_cvt_pk_bf16_f32 v224, v224, v225
v_mfma_f32_16x16x32_bf16 v[196:199], a[68:71], v[124:127], v[196:199]
s_waitcnt lgkmcnt(6)
ds_read_b128 a[100:103], v1 offset:25600
v_cvt_pk_bf16_f32 v225, v226, v227
v_mfma_f32_16x16x32_bf16 v[204:207], a[72:75], v[120:123], v[204:207]
s_waitcnt lgkmcnt(6)
ds_read_b128 a[104:107], v1 offset:26624
v_cvt_pk_bf16_f32 v226, v232, v233
v_mfma_f32_16x16x32_bf16 v[204:207], a[76:79], v[124:127], v[204:207]
s_waitcnt lgkmcnt(6)
ds_read_b128 a[108:111], v1 offset:27648
v_cvt_pk_bf16_f32 v227, v234, v235
v_mfma_f32_16x16x32_bf16 v[212:215], a[80:83], v[120:123], v[212:215]
s_waitcnt lgkmcnt(6)
ds_read_b128 a[112:115], v1 offset:28672
v_cvt_pk_bf16_f32 v240, v240, v241
v_mfma_f32_16x16x32_bf16 v[212:215], a[84:87], v[124:127], v[212:215]
s_waitcnt lgkmcnt(5)
ds_read_b128 a[116:119], v1 offset:29696
v_cvt_pk_bf16_f32 v241, v242, v243
v_mfma_f32_16x16x32_bf16 v[220:223], a[88:91], v[120:123], v[220:223]
s_add_u32 m0, s18, 98304
ds_read_b128 a[120:123], v1 offset:30720
v_cvt_pk_bf16_f32 v242, v248, v249
v_mfma_f32_16x16x32_bf16 v[220:223], a[92:95], v[124:127], v[220:223]
s_waitcnt lgkmcnt(6)
ds_read_b128 a[124:127], v1 offset:31744
v_cvt_pk_bf16_f32 v243, v250, v251
v_mfma_f32_16x16x32_bf16 v[228:231], a[96:99], v[120:123], v[228:231]
s_waitcnt lgkmcnt(6)
buffer_load_dwordx4 v112, s[36:39], s81 offen offset:0 lds
v_mfma_f32_16x16x32_bf16 v[228:231], a[100:103], v[124:127], v[228:231]
s_waitcnt lgkmcnt(5)
buffer_load_dwordx4 v113, s[36:39], s81 offen offset:1024 lds
v_mfma_f32_16x16x32_bf16 v[236:239], a[104:107], v[120:123], v[236:239]
s_waitcnt lgkmcnt(4)
buffer_load_dwordx4 v114, s[36:39], s81 offen offset:2048 lds
v_mfma_f32_16x16x32_bf16 v[236:239], a[108:111], v[124:127], v[236:239]
s_waitcnt lgkmcnt(1)
buffer_load_dwordx4 v115, s[36:39], s81 offen offset:3072 lds
v_mfma_f32_16x16x32_bf16 v[244:247], a[112:115], v[120:123], v[244:247]
s_add_u32 s81, s81, 28672
v_cvt_pk_bf16_f32 v132, v132, v133
v_cvt_pk_bf16_f32 v133, v134, v135
v_mfma_f32_16x16x32_bf16 v[244:247], a[116:119], v[124:127], v[244:247]
s_add_u32 m0, s18, 102400
v_cvt_pk_bf16_f32 v134, v140, v141
v_cvt_pk_bf16_f32 v135, v142, v143
v_mfma_f32_16x16x32_bf16 v[252:255], a[120:123], v[120:123], v[252:255]
s_waitcnt lgkmcnt(0)
buffer_load_dwordx4 v112, s[36:39], s81 offen offset:0 lds
v_mfma_f32_16x16x32_bf16 v[252:255], a[124:127], v[124:127], v[252:255]
buffer_load_dwordx4 v113, s[36:39], s81 offen offset:1024 lds
buffer_load_dwordx4 v114, s[36:39], s81 offen offset:2048 lds
buffer_load_dwordx4 v115, s[36:39], s81 offen offset:3072 lds
s_sub_u32 s81, s81, 28544
s_add_u32 m0, s18, 131072
s_nop 0
buffer_load_dwordx4 v112, s[36:39], s81 offen offset:0 lds
v_cvt_pk_bf16_f32 v148, v148, v149
v_cvt_pk_bf16_f32 v149, v150, v151
v_cvt_pk_bf16_f32 v150, v156, v157
v_cvt_pk_bf16_f32 v151, v158, v159
buffer_load_dwordx4 v113, s[36:39], s81 offen offset:1024 lds
v_cvt_pk_bf16_f32 v164, v164, v165
v_cvt_pk_bf16_f32 v165, v166, v167
v_cvt_pk_bf16_f32 v166, v172, v173
v_cvt_pk_bf16_f32 v167, v174, v175
buffer_load_dwordx4 v114, s[36:39], s81 offen offset:2048 lds
v_cvt_pk_bf16_f32 v180, v180, v181
v_cvt_pk_bf16_f32 v181, v182, v183
v_cvt_pk_bf16_f32 v182, v188, v189
v_cvt_pk_bf16_f32 v183, v190, v191
buffer_load_dwordx4 v115, s[36:39], s81 offen offset:3072 lds
v_cvt_pk_bf16_f32 v196, v196, v197
v_cvt_pk_bf16_f32 v197, v198, v199
v_cvt_pk_bf16_f32 v198, v204, v205
v_cvt_pk_bf16_f32 v199, v206, v207
s_add_u32 s81, s81, 28672
s_add_u32 m0, s18, 135168
s_nop 0
buffer_load_dwordx4 v112, s[36:39], s81 offen offset:0 lds
v_cvt_pk_bf16_f32 v212, v212, v213
v_cvt_pk_bf16_f32 v213, v214, v215
v_cvt_pk_bf16_f32 v214, v220, v221
v_cvt_pk_bf16_f32 v215, v222, v223
buffer_load_dwordx4 v113, s[36:39], s81 offen offset:1024 lds
v_cvt_pk_bf16_f32 v228, v228, v229
v_cvt_pk_bf16_f32 v229, v230, v231
v_cvt_pk_bf16_f32 v230, v236, v237
v_cvt_pk_bf16_f32 v231, v238, v239
buffer_load_dwordx4 v114, s[36:39], s81 offen offset:2048 lds
v_cvt_pk_bf16_f32 v244, v244, v245
v_cvt_pk_bf16_f32 v245, v246, v247
v_cvt_pk_bf16_f32 v246, v252, v253
v_cvt_pk_bf16_f32 v247, v254, v255
buffer_load_dwordx4 v115, s[36:39], s81 offen offset:3072 lds
s_sub_u32 s81, s81, 28544
s_branch K2_done
K2_cfix:
s_nop 7
v_max_f32 v12, 0, v8
v_exp_f32 v13, -v12
v_sub_f32 v8, v8, v12
v_mul_f32 v24, v24, v13
v_mul_f32 v128, v128, v13
v_mul_f32 v129, v129, v13
v_mul_f32 v130, v130, v13
v_mul_f32 v131, v131, v13
v_mul_f32 v136, v136, v13
v_mul_f32 v137, v137, v13
v_mul_f32 v138, v138, v13
v_mul_f32 v139, v139, v13
v_mul_f32 v144, v144, v13
v_mul_f32 v145, v145, v13
v_mul_f32 v146, v146, v13
v_mul_f32 v147, v147, v13
v_mul_f32 v152, v152, v13
v_mul_f32 v153, v153, v13
v_mul_f32 v154, v154, v13
v_mul_f32 v155, v155, v13
v_mul_f32 v160, v160, v13
v_mul_f32 v161, v161, v13
v_mul_f32 v162, v162, v13
v_mul_f32 v163, v163, v13
v_mul_f32 v168, v168, v13
v_mul_f32 v169, v169, v13
v_mul_f32 v170, v170, v13
v_mul_f32 v171, v171, v13
v_mul_f32 v176, v176, v13
v_mul_f32 v177, v177, v13
v_mul_f32 v178, v178, v13
v_mul_f32 v179, v179, v13
v_mul_f32 v184, v184, v13
v_mul_f32 v185, v185, v13
v_mul_f32 v186, v186, v13
v_mul_f32 v187, v187, v13
v_mul_f32 v192, v192, v13
v_mul_f32 v193, v193, v13
v_mul_f32 v194, v194, v13
v_mul_f32 v195, v195, v13
v_mul_f32 v200, v200, v13
v_mul_f32 v201, v201, v13
v_mul_f32 v202, v202, v13
v_mul_f32 v203, v203, v13
v_mul_f32 v208, v208, v13
v_mul_f32 v209, v209, v13
v_mul_f32 v210, v210, v13
v_mul_f32 v211, v211, v13
v_mul_f32 v216, v216, v13
v_mul_f32 v217, v217, v13
v_mul_f32 v218, v218, v13
v_mul_f32 v219, v219, v13
v_mul_f32 v224, v224, v13
v_mul_f32 v225, v225, v13
v_mul_f32 v226, v226, v13
v_mul_f32 v227, v227, v13
v_mul_f32 v232, v232, v13
v_mul_f32 v233, v233, v13
v_mul_f32 v234, v234, v13
v_mul_f32 v235, v235, v13
v_mul_f32 v240, v240, v13
v_mul_f32 v241, v241, v13
v_mul_f32 v242, v242, v13
v_mul_f32 v243, v243, v13
v_mul_f32 v248, v248, v13
v_mul_f32 v249, v249, v13
v_mul_f32 v250, v250, v13
v_mul_f32 v251, v251, v13
v_max_f32 v12, 0, v10
v_exp_f32 v13, -v12
v_sub_f32 v10, v10, v12
v_mul_f32 v25, v25, v13
v_mul_f32 v132, v132, v13
v_mul_f32 v133, v133, v13
v_mul_f32 v134, v134, v13
v_mul_f32 v135, v135, v13
v_mul_f32 v140, v140, v13
v_mul_f32 v141, v141, v13
v_mul_f32 v142, v142, v13
v_mul_f32 v143, v143, v13
v_mul_f32 v148, v148, v13
v_mul_f32 v149, v149, v13
v_mul_f32 v150, v150, v13
v_mul_f32 v151, v151, v13
v_mul_f32 v156, v156, v13
v_mul_f32 v157, v157, v13
v_mul_f32 v158, v158, v13
v_mul_f32 v159, v159, v13
v_mul_f32 v164, v164, v13
v_mul_f32 v165, v165, v13
v_mul_f32 v166, v166, v13
v_mul_f32 v167, v167, v13
v_mul_f32 v172, v172, v13
v_mul_f32 v173, v173, v13
v_mul_f32 v174, v174, v13
v_mul_f32 v175, v175, v13
v_mul_f32 v180, v180, v13
v_mul_f32 v181, v181, v13
v_mul_f32 v182, v182, v13
v_mul_f32 v183, v183, v13
v_mul_f32 v188, v188, v13
v_mul_f32 v189, v189, v13
v_mul_f32 v190, v190, v13
v_mul_f32 v191, v191, v13
v_mul_f32 v196, v196, v13
v_mul_f32 v197, v197, v13
v_mul_f32 v198, v198, v13
v_mul_f32 v199, v199, v13
v_mul_f32 v204, v204, v13
v_mul_f32 v205, v205, v13
v_mul_f32 v206, v206, v13
v_mul_f32 v207, v207, v13
v_mul_f32 v212, v212, v13
v_mul_f32 v213, v213, v13
v_mul_f32 v214, v214, v13
v_mul_f32 v215, v215, v13
v_mul_f32 v220, v220, v13
v_mul_f32 v221, v221, v13
v_mul_f32 v222, v222, v13
v_mul_f32 v223, v223, v13
v_mul_f32 v228, v228, v13
v_mul_f32 v229, v229, v13
v_mul_f32 v230, v230, v13
v_mul_f32 v231, v231, v13
v_mul_f32 v236, v236, v13
v_mul_f32 v237, v237, v13
v_mul_f32 v238, v238, v13
v_mul_f32 v239, v239, v13
v_mul_f32 v244, v244, v13
v_mul_f32 v245, v245, v13
v_mul_f32 v246, v246, v13
v_mul_f32 v247, v247, v13
v_mul_f32 v252, v252, v13
v_mul_f32 v253, v253, v13
v_mul_f32 v254, v254, v13
v_mul_f32 v255, v255, v13
s_branch K2_cok
K2_tspin:
Lp_9101:
buffer_load_dword v3, off, s[4:7], s80 sc1
s_waitcnt vmcnt(0)
v_cmp_gt_u32 vcc, 1, v3
s_cbranch_vccz Lpd_9102
s_sleep 8
s_sub_u32 s101, s101, 1
s_cbranch_scc0 Lp_9101
s_mov_b32 s101, 0
Lpd_9102:
s_branch K2_tok
K2_p0d:
ds_read_b128 a[64:67], v1 offset:0
ds_read_b128 a[68:71], v1 offset:1024
ds_read_b128 a[72:75], v1 offset:2048
ds_read_b128 a[76:79], v1 offset:3072
ds_read_b128 a[80:83], v1 offset:4096
ds_read_b128 a[84:87], v1 offset:5120
ds_read_b128 a[88:91], v1 offset:6144
ds_read_b128 a[92:95], v1 offset:7168
v_cndmask_b32 v32, 0, v7, s[32:33]
v_cndmask_b32 v33, 0, v7, s[34:35]
v_cndmask_b32 v34, 0, v7, s[36:37]
v_cndmask_b32 v35, 0, v7, s[38:39]
v_cndmask_b32 v40, 0, v7, s[40:41]
v_cndmask_b32 v41, 0, v7, s[42:43]
v_cndmask_b32 v42, 0, v7, s[44:45]
v_cndmask_b32 v43, 0, v7, s[46:47]
s_waitcnt lgkmcnt(7)
v_mfma_f32_16x16x32_bf16 v[32:35], a[64:67], a[0:3], v[32:35]
s_waitcnt lgkmcnt(6)
s_add_u32 m0, s18, 65536
ds_read_b128 a[96:99], v1 offset:8192
v_mfma_f32_16x16x32_bf16 v[32:35], a[68:71], a[4:7], v[32:35]
s_waitcnt lgkmcnt(6)
buffer_load_dwordx4 v1, s[4:7], s12 offen offset:0 sc1 lds
v_mfma_f32_16x16x32_bf16 v[32:35], a[72:75], a[8:11], v[32:35]
s_waitcnt lgkmcnt(5)
ds_read_b128 a[100:103], v1 offset:9216
v_mfma_f32_16x16x32_bf16 v[32:35], a[76:79], a[12:15], v[32:35]
s_waitcnt lgkmcnt(5)
buffer_load_dwordx4 v1, s[4:7], s12 offen offset:1024 sc1 lds
v_mfma_f32_16x16x32_bf16 v[32:35], a[80:83], a[16:19], v[32:35]
s_waitcnt lgkmcnt(4)
ds_read_b128 a[104:107], v1 offset:10240
v_mfma_f32_16x16x32_bf16 v[32:35], a[84:87], a[20:23], v[32:35]
s_waitcnt lgkmcnt(4)
buffer_load_dwordx4 v1, s[4:7], s12 offen offset:2048 sc1 lds
v_mfma_f32_16x16x32_bf16 v[32:35], a[88:91], a[24:27], v[32:35]
s_waitcnt lgkmcnt(3)
ds_read_b128 a[108:111], v1 offset:11264
v_mfma_f32_16x16x32_bf16 v[32:35], a[92:95], a[28:31], v[32:35]
buffer_load_dwordx4 v1, s[4:7], s12 offen offset:3072 sc1 lds
v_mfma_f32_16x16x32_bf16 v[36:39], a[64:67], a[32:35], 0
s_add_u32 s12, s12, 4096
s_add_u32 m0, s18, 69632
ds_read_b128 a[112:115], v1 offset:12288
v_mfma_f32_16x16x32_bf16 v[36:39], a[68:71], a[36:39], v[36:39]
buffer_load_dwordx4 v1, s[4:7], s12 offen offset:0 sc1 lds
v_mfma_f32_16x16x32_bf16 v[36:39], a[72:75], a[40:43], v[36:39]
ds_read_b128 a[116:119], v1 offset:13312
v_mfma_f32_16x16x32_bf16 v[36:39], a[76:79], a[44:47], v[36:39]
buffer_load_dwordx4 v1, s[4:7], s12 offen offset:1024 sc1 lds
v_mfma_f32_16x16x32_bf16 v[36:39], a[80:83], a[48:51], v[36:39]
ds_read_b128 a[120:123], v1 offset:14336
v_max3_f32 v28, v32, v33, v34
v_mfma_f32_16x16x32_bf16 v[36:39], a[84:87], a[52:55], v[36:39]
buffer_load_dwordx4 v1, s[4:7], s12 offen offset:2048 sc1 lds
v_mfma_f32_16x16x32_bf16 v[36:39], a[88:91], a[56:59], v[36:39]
ds_read_b128 a[124:127], v1 offset:15360
v_max_f32 v28, v28, v35
v_mfma_f32_16x16x32_bf16 v[36:39], a[92:95], a[60:63], v[36:39]
s_waitcnt lgkmcnt(4)
buffer_load_dwordx4 v1, s[4:7], s12 offen offset:3072 sc1 lds
v_mfma_f32_16x16x32_bf16 v[40:43], a[96:99], a[0:3], v[40:43]
s_add_u32 s12, s12, 28672
ds_read_b128 a[64:67], v1 offset:16384
v_mov_b32 v30, v28
v_mfma_f32_16x16x32_bf16 v[40:43], a[100:103], a[4:7], v[40:43]
s_waitcnt lgkmcnt(2)
s_sub_u32 s13, s13, 1
v_mfma_f32_16x16x32_bf16 v[40:43], a[104:107], a[8:11], v[40:43]
s_cmp_eq_u32 s13, 0
ds_read_b128 a[68:71], v1 offset:17408
v_permlane16_swap_b32 v28, v30
v_mfma_f32_16x16x32_bf16 v[40:43], a[108:111], a[12:15], v[40:43]
s_cselect_b32 s12, s14, s12
v_max_f32 v28, v28, v30
v_mov_b32 v30, v28
v_mfma_f32_16x16x32_bf16 v[40:43], a[112:115], a[16:19], v[40:43]
s_cselect_b32 s13, s15, s13
ds_read_b128 a[72:75], v1 offset:18432
v_max3_f32 v29, v36, v37, v38
v_mfma_f32_16x16x32_bf16 v[40:43], a[116:119], a[20:23], v[40:43]
s_cselect_b32 s14, 3221225472, s14
v_permlane32_swap_b32 v28, v30
v_max_f32 v28, v28, v30
v_mfma_f32_16x16x32_bf16 v[40:43], a[120:123], a[24:27], v[40:43]
s_waitcnt lgkmcnt(3)
ds_read_b128 a[76:79], v1 offset:19456
v_sub_f32 v16, 0, v28
v_mfma_f32_16x16x32_bf16 v[40:43], a[124:127], a[28:31], v[40:43]
v_sub_f32 v17, 0, v28
v_sub_f32 v18, 0, v28
v_mfma_f32_16x16x32_bf16 v[44:47], a[96:99], a[32:35], 0
ds_read_b128 a[80:83], v1 offset:20480
v_sub_f32 v19, 0, v28
v_mfma_f32_16x16x32_bf16 v[44:47], a[100:103], a[36:39], v[44:47]
v_max_f32 v29, v29, v39
v_mov_b32 v31, v29
v_cndmask_b32 v48, v16, v7, s[48:49]
v_mfma_f32_16x16x32_bf16 v[44:47], a[104:107], a[40:43], v[44:47]
ds_read_b128 a[84:87], v1 offset:21504
v_cndmask_b32 v49, v16, v7, s[50:51]
v_mfma_f32_16x16x32_bf16 v[44:47], a[108:111], a[44:47], v[44:47]
v_permlane16_swap_b32 v29, v31
v_max_f32 v29, v29, v31
v_cndmask_b32 v50, v16, v7, s[52:53]
v_mfma_f32_16x16x32_bf16 v[44:47], a[112:115], a[48:51], v[44:47]
ds_read_b128 a[88:91], v1 offset:22528
v_mov_b32 v31, v29
v_cndmask_b32 v51, v16, v7, s[54:55]
v_mfma_f32_16x16x32_bf16 v[44:47], a[116:119], a[52:55], v[44:47]
v_cndmask_b32 v56, v16, v7, s[56:57]
v_cndmask_b32 v57, v16, v7, s[58:59]
v_mfma_f32_16x16x32_bf16 v[44:47], a[120:123], a[56:59], v[44:47]
ds_read_b128 a[92:95], v1 offset:23552
v_permlane32_swap_b32 v29, v31
v_mfma_f32_16x16x32_bf16 v[44:47], a[124:127], a[60:63], v[44:47]
s_waitcnt lgkmcnt(4)
v_max_f32 v29, v29, v31
v_sub_f32 v20, 0, v29
v_mfma_f32_16x16x32_bf16 v[48:51], a[64:67], a[0:3], v[48:51]
ds_read_b128 a[96:99], v1 offset:24576
v_sub_f32 v21, 0, v29
v_mfma_f32_16x16x32_bf16 v[48:51], a[68:71], a[4:7], v[48:51]
v_sub_f32 v22, 0, v29
v_sub_f32 v23, 0, v29
v_mfma_f32_16x16x32_bf16 v[48:51], a[72:75], a[8:11], v[48:51]
ds_read_b128 a[100:103], v1 offset:25600
v_cndmask_b32 v58, v16, v7, s[60:61]
v_mfma_f32_16x16x32_bf16 v[48:51], a[76:79], a[12:15], v[48:51]
s_waitcnt lgkmcnt(4)
v_cndmask_b32 v59, v16, v7, s[62:63]
v_mfma_f32_16x16x32_bf16 v[48:51], a[80:83], a[16:19], v[48:51]
ds_read_b128 a[104:107], v1 offset:26624
v_mfma_f32_16x16x32_bf16 v[48:51], a[84:87], a[20:23], v[48:51]
s_waitcnt lgkmcnt(4)
v_add_f32 v32, v32, v16
v_add_f32 v33, v33, v16
v_add_f32 v34, v34, v16
v_add_f32 v35, v35, v16
v_mfma_f32_16x16x32_bf16 v[48:51], a[88:91], a[24:27], v[48:51]
s_waitcnt lgkmcnt(3)
ds_read_b128 a[108:111], v1 offset:27648
v_add_f32 v36, v36, v20
v_add_f32 v37, v37, v20
v_add_f32 v38, v38, v20
v_add_f32 v39, v39, v20
v_mfma_f32_16x16x32_bf16 v[48:51], a[92:95], a[28:31], v[48:51]
v_add_f32 v40, v40, v16
v_add_f32 v41, v41, v16
v_add_f32 v42, v42, v16
v_add_f32 v43, v43, v16
v_mfma_f32_16x16x32_bf16 v[52:55], a[64:67], a[32:35], v[20:23]
ds_read_b128 a[112:115], v1 offset:28672
v_add_f32 v44, v44, v20
v_add_f32 v45, v45, v20
v_add_f32 v46, v46, v20
v_add_f32 v47, v47, v20
v_mfma_f32_16x16x32_bf16 v[52:55], a[68:71], a[36:39], v[52:55]
v_exp_f32 v8, v32
v_mfma_f32_16x16x32_bf16 v[52:55], a[72:75], a[40:43], v[52:55]
ds_read_b128 a[116:119], v1 offset:29696
v_exp_f32 v9, v33
v_mfma_f32_16x16x32_bf16 v[52:55], a[76:79], a[44:47], v[52:55]
v_exp_f32 v10, v34
v_add_f32 v26, v8, v9
v_cvt_pk_bf16_f32 v96, v8, v9
v_mfma_f32_16x16x32_bf16 v[52:55], a[80:83], a[48:51], v[52:55]
ds_read_b128 a[120:123], v1 offset:30720
v_exp_f32 v11, v35
v_add_f32 v26, v26, v10
v_mfma_f32_16x16x32_bf16 v[52:55], a[84:87], a[52:55], v[52:55]
v_exp_f32 v12, v36
v_add_f32 v26, v26, v11
v_cvt_pk_bf16_f32 v97, v10, v11
v_mfma_f32_16x16x32_bf16 v[52:55], a[88:91], a[56:59], v[52:55]
s_waitcnt vmcnt(8) lgkmcnt(4)
ds_read_b128 a[124:127], v1 offset:31744
v_exp_f32 v13, v37
v_mfma_f32_16x16x32_bf16 v[52:55], a[92:95], a[60:63], v[52:55]
s_barrier
v_mfma_f32_16x16x32_bf16 v[56:59], a[96:99], a[0:3], v[56:59]
ds_read_b128 a[64:67], v4 offset:0
v_exp_f32 v14, v38
v_mfma_f32_16x16x32_bf16 v[56:59], a[100:103], a[4:7], v[56:59]
buffer_store_dword v6, v5, s[4:7], s71 offen sc1
v_mfma_f32_16x16x32_bf16 v[56:59], a[104:107], a[8:11], v[56:59]
s_waitcnt lgkmcnt(4)
ds_read_b128 a[68:71], v4 offset:1024
v_add_f32 v27, v12, v13
v_cvt_pk_bf16_f32 v104, v12, v13
v_add_f32 v27, v27, v14
v_mfma_f32_16x16x32_bf16 v[56:59], a[108:111], a[12:15], v[56:59]
v_exp_f32 v15, v39
v_mfma_f32_16x16x32_bf16 v[56:59], a[112:115], a[16:19], v[56:59]
s_waitcnt lgkmcnt(4)
ds_read_b128 a[72:75], v4 offset:2048
v_exp_f32 v8, v40
v_add_f32 v27, v27, v15
v_cvt_pk_bf16_f32 v105, v14, v15
v_mfma_f32_16x16x32_bf16 v[56:59], a[116:119], a[20:23], v[56:59]
s_waitcnt lgkmcnt(4)
v_exp_f32 v9, v41
v_add_f32 v26, v26, v8
v_mfma_f32_16x16x32_bf16 v[56:59], a[120:123], a[24:27], v[56:59]
s_waitcnt lgkmcnt(3)
ds_read_b128 a[76:79], v4 offset:3072
v_exp_f32 v10, v42
v_add_f32 v26, v26, v9
v_cvt_pk_bf16_f32 v98, v8, v9
v_mfma_f32_16x16x32_bf16 v[56:59], a[124:127], a[28:31], v[56:59]
v_exp_f32 v11, v43
v_add_f32 v26, v26, v10
v_mfma_f32_16x16x32_bf16 v[60:63], a[96:99], a[32:35], v[20:23]
ds_read_b128 a[80:83], v4 offset:4096
v_exp_f32 v12, v44
v_mfma_f32_16x16x32_bf16 v[60:63], a[100:103], a[36:39], v[60:63]
v_exp_f32 v13, v45
v_mfma_f32_16x16x32_bf16 v[60:63], a[104:107], a[40:43], v[60:63]
ds_read_b128 a[84:87], v4 offset:5120
v_exp_f32 v14, v46
v_mfma_f32_16x16x32_bf16 v[60:63], a[108:111], a[44:47], v[60:63]
v_exp_f32 v15, v47
v_mfma_f32_16x16x32_bf16 v[60:63], a[112:115], a[48:51], v[60:63]
ds_read_b128 a[88:91], v4 offset:6144
v_add_f32 v26, v26, v11
v_cvt_pk_bf16_f32 v99, v10, v11
v_mfma_f32_16x16x32_bf16 v[60:63], a[116:119], a[52:55], v[60:63]
v_add_f32 v27, v27, v12
v_add_f32 v27, v27, v13
v_cvt_pk_bf16_f32 v106, v12, v13
v_mfma_f32_16x16x32_bf16 v[60:63], a[120:123], a[56:59], v[60:63]
s_waitcnt lgkmcnt(7)
s_barrier
ds_read_b128 a[92:95], v4 offset:7168
v_mfma_f32_16x16x32_bf16 v[60:63], a[124:127], a[60:63], v[60:63]
s_waitcnt lgkmcnt(4)
v_add_f32 v27, v27, v14
v_add_f32 v27, v27, v15
v_cvt_pk_bf16_f32 v107, v14, v15
s_branch K2_dx1
PAD_33:
s_cbranch_execz M_tret
K2_ntail:
v_mfma_f32_16x16x32_bf16 v[128:131], a[64:67], v[96:99], v[128:131]
s_add_u32 m0, s18, 98304
ds_read_b128 a[96:99], v2 offset:8192
v_add_f32 v24, v24, v26
v_mfma_f32_16x16x32_bf16 v[128:131], a[68:71], v[100:103], v[128:131]
buffer_load_dwordx4 v1, s[4:7], s12 offen offset:0 sc1 lds
v_mfma_f32_16x16x32_bf16 v[132:135], a[68:71], v[108:111], v[132:135]
ds_read_b128 a[100:103], v2 offset:9216
v_add_f32 v25, v25, v27
v_mfma_f32_16x16x32_bf16 v[132:135], a[64:67], v[104:107], v[132:135]
buffer_load_dwordx4 v1, s[4:7], s12 offen offset:1024 sc1 lds
v_mfma_f32_16x16x32_bf16 v[136:139], a[72:75], v[96:99], v[136:139]
ds_read_b128 a[104:107], v2 offset:10240
v_exp_f32 v8, v64
v_mfma_f32_16x16x32_bf16 v[136:139], a[76:79], v[100:103], v[136:139]
buffer_load_dwordx4 v1, s[4:7], s12 offen offset:2048 sc1 lds
v_mfma_f32_16x16x32_bf16 v[140:143], a[76:79], v[108:111], v[140:143]
ds_read_b128 a[108:111], v2 offset:11264
v_mfma_f32_16x16x32_bf16 v[140:143], a[72:75], v[104:107], v[140:143]
s_waitcnt lgkmcnt(4)
buffer_load_dwordx4 v1, s[4:7], s12 offen offset:3072 sc1 lds
v_mfma_f32_16x16x32_bf16 v[144:147], a[80:83], v[96:99], v[144:147]
s_add_u32 s12, s12, 4096
s_add_u32 m0, s18, 102400
ds_read_b128 a[112:115], v2 offset:12288
v_mfma_f32_16x16x32_bf16 v[144:147], a[84:87], v[100:103], v[144:147]
buffer_load_dwordx4 v1, s[4:7], s12 offen offset:0 sc1 lds
v_mfma_f32_16x16x32_bf16 v[148:151], a[84:87], v[108:111], v[148:151]
ds_read_b128 a[116:119], v2 offset:13312
v_exp_f32 v9, v65
v_mfma_f32_16x16x32_bf16 v[148:151], a[80:83], v[104:107], v[148:151]
buffer_load_dwordx4 v1, s[4:7], s12 offen offset:1024 sc1 lds
v_mfma_f32_16x16x32_bf16 v[152:155], a[88:91], v[96:99], v[152:155]
ds_read_b128 a[120:123], v2 offset:14336
v_add_f32 v26, v8, v9
v_cvt_pk_bf16_f32 v112, v8, v9
v_mfma_f32_16x16x32_bf16 v[152:155], a[92:95], v[100:103], v[152:155]
buffer_load_dwordx4 v1, s[4:7], s12 offen offset:2048 sc1 lds
v_mfma_f32_16x16x32_bf16 v[156:159], a[92:95], v[108:111], v[156:159]
ds_read_b128 a[124:127], v2 offset:15360
v_exp_f32 v10, v66
v_mfma_f32_16x16x32_bf16 v[156:159], a[88:91], v[104:107], v[156:159]
s_waitcnt lgkmcnt(4)
buffer_load_dwordx4 v1, s[4:7], s12 offen offset:3072 sc1 lds
v_mfma_f32_16x16x32_bf16 v[160:163], a[96:99], v[96:99], v[160:163]
s_add_u32 s12, s12, 28672
ds_read_b128 a[64:67], v2 offset:16384
v_add_f32 v26, v26, v10
v_mfma_f32_16x16x32_bf16 v[160:163], a[100:103], v[100:103], v[160:163]
s_sub_u32 s13, s13, 1
v_exp_f32 v11, v67
v_mfma_f32_16x16x32_bf16 v[164:167], a[100:103], v[108:111], v[164:167]
s_cmp_eq_u32 s13, 0
ds_read_b128 a[68:71], v2 offset:17408
v_exp_f32 v12, v68
v_mfma_f32_16x16x32_bf16 v[164:167], a[96:99], v[104:107], v[164:167]
s_cselect_b32 s12, s14, s12
v_exp_f32 v13, v69
v_mfma_f32_16x16x32_bf16 v[168:171], a[104:107], v[96:99], v[168:171]
s_cselect_b32 s13, s15, s13
ds_read_b128 a[72:75], v2 offset:18432
v_add_f32 v26, v26, v11
v_cvt_pk_bf16_f32 v113, v10, v11
v_mfma_f32_16x16x32_bf16 v[168:171], a[108:111], v[100:103], v[168:171]
s_cselect_b32 s14, 3221225472, s14
v_exp_f32 v14, v70
v_mfma_f32_16x16x32_bf16 v[172:175], a[108:111], v[108:111], v[172:175]
ds_read_b128 a[76:79], v2 offset:19456
v_exp_f32 v15, v71
v_mfma_f32_16x16x32_bf16 v[172:175], a[104:107], v[104:107], v[172:175]
s_waitcnt lgkmcnt(4)
v_exp_f32 v8, v72
v_mfma_f32_16x16x32_bf16 v[176:179], a[112:115], v[96:99], v[176:179]
ds_read_b128 a[80:83], v2 offset:20480
v_add_f32 v27, v12, v13
v_cvt_pk_bf16_f32 v120, v12, v13
v_add_f32 v27, v27, v14
v_add_f32 v27, v27, v15
v_cvt_pk_bf16_f32 v121, v14, v15
v_mfma_f32_16x16x32_bf16 v[176:179], a[116:119], v[100:103], v[176:179]
v_exp_f32 v9, v73
v_mfma_f32_16x16x32_bf16 v[180:183], a[116:119], v[108:111], v[180:183]
ds_read_b128 a[84:87], v2 offset:21504
v_exp_f32 v10, v74
v_mfma_f32_16x16x32_bf16 v[180:183], a[112:115], v[104:107], v[180:183]
v_exp_f32 v11, v75
v_mfma_f32_16x16x32_bf16 v[184:187], a[120:123], v[96:99], v[184:187]
ds_read_b128 a[88:91], v2 offset:22528
v_add_f32 v26, v26, v8
v_mfma_f32_16x16x32_bf16 v[184:187], a[124:127], v[100:103], v[184:187]
v_exp_f32 v12, v76
v_mfma_f32_16x16x32_bf16 v[188:191], a[124:127], v[108:111], v[188:191]
ds_read_b128 a[92:95], v2 offset:23552
v_add_f32 v26, v26, v9
v_cvt_pk_bf16_f32 v114, v8, v9
v_add_f32 v26, v26, v10
v_add_f32 v26, v26, v11
v_cvt_pk_bf16_f32 v115, v10, v11
v_mfma_f32_16x16x32_bf16 v[188:191], a[120:123], v[104:107], v[188:191]
s_waitcnt lgkmcnt(4)
v_exp_f32 v13, v77
v_mfma_f32_16x16x32_bf16 v[192:195], a[64:67], v[96:99], v[192:195]
ds_read_b128 a[96:99], v2 offset:24576
v_exp_f32 v14, v78
v_mfma_f32_16x16x32_bf16 v[192:195], a[68:71], v[100:103], v[192:195]
v_exp_f32 v15, v79
v_mfma_f32_16x16x32_bf16 v[196:199], a[68:71], v[108:111], v[196:199]
ds_read_b128 a[100:103], v2 offset:25600
v_add_f32 v27, v27, v12
v_add_f32 v27, v27, v13
v_cvt_pk_bf16_f32 v122, v12, v13
v_add_f32 v27, v27, v14
v_mfma_f32_16x16x32_bf16 v[196:199], a[64:67], v[104:107], v[196:199]
v_exp_f32 v8, v80
v_mfma_f32_16x16x32_bf16 v[200:203], a[72:75], v[96:99], v[200:203]
ds_read_b128 a[104:107], v2 offset:26624
v_exp_f32 v9, v81
v_mfma_f32_16x16x32_bf16 v[200:203], a[76:79], v[100:103], v[200:203]
v_exp_f32 v10, v82
v_mfma_f32_16x16x32_bf16 v[204:207], a[76:79], v[108:111], v[204:207]
ds_read_b128 a[108:111], v2 offset:27648
v_add_f32 v27, v27, v15
v_cvt_pk_bf16_f32 v123, v14, v15
v_add_f32 v26, v26, v8
v_add_f32 v26, v26, v9
v_cvt_pk_bf16_f32 v116, v8, v9
v_mfma_f32_16x16x32_bf16 v[204:207], a[72:75], v[104:107], v[204:207]
s_waitcnt lgkmcnt(4)
v_exp_f32 v11, v83
v_mfma_f32_16x16x32_bf16 v[208:211], a[80:83], v[96:99], v[208:211]
ds_read_b128 a[112:115], v2 offset:28672
v_exp_f32 v12, v84
v_mfma_f32_16x16x32_bf16 v[208:211], a[84:87], v[100:103], v[208:211]
v_exp_f32 v13, v85
v_mfma_f32_16x16x32_bf16 v[212:215], a[84:87], v[108:111], v[212:215]
ds_read_b128 a[116:119], v2 offset:29696
v_add_f32 v26, v26, v10
v_add_f32 v26, v26, v11
v_cvt_pk_bf16_f32 v117, v10, v11
v_add_f32 v27, v27, v12
v_mfma_f32_16x16x32_bf16 v[212:215], a[80:83], v[104:107], v[212:215]
v_exp_f32 v14, v86
v_mfma_f32_16x16x32_bf16 v[216:219], a[88:91], v[96:99], v[216:219]
ds_read_b128 a[120:123], v2 offset:30720
v_exp_f32 v15, v87
v_mfma_f32_16x16x32_bf16 v[216:219], a[92:95], v[100:103], v[216:219]
v_exp_f32 v8, v88
v_mfma_f32_16x16x32_bf16 v[220:223], a[92:95], v[108:111], v[220:223]
s_waitcnt vmcnt(0) lgkmcnt(4)
ds_read_b128 a[124:127], v2 offset:31744
v_add_f32 v27, v27, v13
v_cvt_pk_bf16_f32 v124, v12, v13
v_add_f32 v27, v27, v14
v_add_f32 v27, v27, v15
v_cvt_pk_bf16_f32 v125, v14, v15
v_mfma_f32_16x16x32_bf16 v[220:223], a[88:91], v[104:107], v[220:223]
s_barrier
v_mfma_f32_16x16x32_bf16 v[224:227], a[96:99], v[96:99], v[224:227]
ds_read_b128 a[64:67], v2 offset:32768
v_exp_f32 v9, v89
v_mfma_f32_16x16x32_bf16 v[224:227], a[100:103], v[100:103], v[224:227]
v_exp_f32 v10, v90
v_mfma_f32_16x16x32_bf16 v[228:231], a[100:103], v[108:111], v[228:231]
ds_read_b128 a[68:71], v2 offset:33792
v_add_f32 v26, v26, v8
v_add_f32 v26, v26, v9
v_cvt_pk_bf16_f32 v118, v8, v9
v_mfma_f32_16x16x32_bf16 v[228:231], a[96:99], v[104:107], v[228:231]
v_exp_f32 v11, v91
v_mfma_f32_16x16x32_bf16 v[232:235], a[104:107], v[96:99], v[232:235]
s_waitcnt lgkmcnt(4)
ds_read_b128 a[72:75], v2 offset:34816
v_exp_f32 v12, v92
v_mfma_f32_16x16x32_bf16 v[232:235], a[108:111], v[100:103], v[232:235]
v_exp_f32 v13, v93
v_mfma_f32_16x16x32_bf16 v[236:239], a[108:111], v[108:111], v[236:239]
ds_read_b128 a[76:79], v2 offset:35840
v_add_f32 v26, v26, v10
v_mfma_f32_16x16x32_bf16 v[236:239], a[104:107], v[104:107], v[236:239]
v_exp_f32 v14, v94
v_mfma_f32_16x16x32_bf16 v[240:243], a[112:115], v[96:99], v[240:243]
ds_read_b128 a[80:83], v2 offset:36864
v_add_f32 v26, v26, v11
v_cvt_pk_bf16_f32 v119, v10, v11
v_add_f32 v27, v27, v12
v_mfma_f32_16x16x32_bf16 v[240:243], a[116:119], v[100:103], v[240:243]
v_exp_f32 v15, v95
v_mfma_f32_16x16x32_bf16 v[244:247], a[116:119], v[108:111], v[244:247]
ds_read_b128 a[84:87], v2 offset:37888
v_add_f32 v27, v27, v13
v_cvt_pk_bf16_f32 v126, v12, v13
v_mfma_f32_16x16x32_bf16 v[244:247], a[112:115], v[104:107], v[244:247]
s_waitcnt lgkmcnt(4)
v_add_f32 v27, v27, v14
v_add_f32 v27, v27, v15
v_mfma_f32_16x16x32_bf16 v[248:251], a[120:123], v[96:99], v[248:251]
ds_read_b128 a[88:91], v2 offset:38912
v_cvt_pk_bf16_f32 v127, v14, v15
v_mfma_f32_16x16x32_bf16 v[248:251], a[124:127], v[100:103], v[248:251]
v_add_f32 v28, v26, v27
v_cmp_nge_f32 vcc, s25, v28
v_mfma_f32_16x16x32_bf16 v[252:255], a[124:127], v[108:111], v[252:255]
ds_read_b128 a[92:95], v2 offset:39936
v_mfma_f32_16x16x32_bf16 v[252:255], a[120:123], v[104:107], v[252:255]
s_cbranch_vccnz Lstub_14
Lback_15:
v_mfma_f32_16x16x32_bf16 v[128:131], a[64:67], v[112:115], v[128:131]
s_add_u32 m0, s18, 131072
ds_read_b128 a[96:99], v2 offset:40960
v_add_f32 v24, v24, v26
v_mfma_f32_16x16x32_bf16 v[128:131], a[68:71], v[116:119], v[128:131]
buffer_load_dwordx4 v1, s[4:7], s8 offen offset:0 sc1 lds
v_mfma_f32_16x16x32_bf16 v[132:135], a[68:71], v[124:127], v[132:135]
ds_read_b128 a[100:103], v2 offset:41984
v_add_f32 v25, v25, v27
v_mfma_f32_16x16x32_bf16 v[132:135], a[64:67], v[120:123], v[132:135]
s_waitcnt lgkmcnt(4)
buffer_load_dwordx4 v1, s[4:7], s8 offen offset:1024 sc1 lds
v_mfma_f32_16x16x32_bf16 v[136:139], a[72:75], v[112:115], v[136:139]
ds_read_b128 a[104:107], v2 offset:43008
v_mov_b32 v8, v16
v_mfma_f32_16x16x32_bf16 v[136:139], a[76:79], v[116:119], v[136:139]
buffer_load_dwordx4 v1, s[4:7], s8 offen offset:2048 sc1 lds
v_mfma_f32_16x16x32_bf16 v[140:143], a[76:79], v[124:127], v[140:143]
ds_read_b128 a[108:111], v2 offset:44032
v_mov_b32 v9, v24
v_mfma_f32_16x16x32_bf16 v[140:143], a[72:75], v[120:123], v[140:143]
buffer_load_dwordx4 v1, s[4:7], s8 offen offset:3072 sc1 lds
v_mfma_f32_16x16x32_bf16 v[144:147], a[80:83], v[112:115], v[144:147]
s_add_u32 s8, s8, 4096
s_add_u32 m0, s18, 135168
ds_read_b128 a[112:115], v2 offset:45056
v_mfma_f32_16x16x32_bf16 v[144:147], a[84:87], v[116:119], v[144:147]
buffer_load_dwordx4 v1, s[4:7], s8 offen offset:0 sc1 lds
v_mfma_f32_16x16x32_bf16 v[148:151], a[84:87], v[124:127], v[148:151]
ds_read_b128 a[116:119], v2 offset:46080
v_mov_b32 v10, v20
v_mfma_f32_16x16x32_bf16 v[148:151], a[80:83], v[120:123], v[148:151]
s_waitcnt lgkmcnt(4)
buffer_load_dwordx4 v1, s[4:7], s8 offen offset:1024 sc1 lds
v_mfma_f32_16x16x32_bf16 v[152:155], a[88:91], v[112:115], v[152:155]
ds_read_b128 a[120:123], v2 offset:47104
v_mov_b32 v11, v25
v_mfma_f32_16x16x32_bf16 v[152:155], a[92:95], v[116:119], v[152:155]
buffer_load_dwordx4 v1, s[4:7], s8 offen offset:2048 sc1 lds
v_mfma_f32_16x16x32_bf16 v[156:159], a[92:95], v[124:127], v[156:159]
ds_read_b128 a[124:127], v2 offset:48128
v_cvt_pk_bf16_f32 v128, v128, v129
v_mfma_f32_16x16x32_bf16 v[156:159], a[88:91], v[120:123], v[156:159]
s_waitcnt lgkmcnt(4)
buffer_load_dwordx4 v1, s[4:7], s8 offen offset:3072 sc1 lds
v_mfma_f32_16x16x32_bf16 v[160:163], a[96:99], v[112:115], v[160:163]
s_add_u32 s8, s8, 28672
ds_read_b128 a[64:67], v2 offset:49152
v_cvt_pk_bf16_f32 v129, v130, v131
v_mfma_f32_16x16x32_bf16 v[160:163], a[100:103], v[116:119], v[160:163]
s_sub_u32 s9, s9, 1
buffer_store_dwordx4 v[8:11], v1, s[4:7], s27 offen sc1
v_mfma_f32_16x16x32_bf16 v[164:167], a[100:103], v[124:127], v[164:167]
s_cmp_eq_u32 s9, 0
ds_read_b128 a[68:71], v2 offset:50176
v_cvt_pk_bf16_f32 v130, v136, v137
v_mfma_f32_16x16x32_bf16 v[164:167], a[96:99], v[120:123], v[164:167]
s_cselect_b32 s8, s10, s8
v_cvt_pk_bf16_f32 v131, v138, v139
v_accvgpr_mov_b32 a0, a192
v_mfma_f32_16x16x32_bf16 v[168:171], a[104:107], v[112:115], v[168:171]
s_cselect_b32 s9, s11, s9
ds_read_b128 a[72:75], v2 offset:51200
v_accvgpr_mov_b32 a1, a193
v_mfma_f32_16x16x32_bf16 v[168:171], a[108:111], v[116:119], v[168:171]
s_cselect_b32 s10, 3221225472, s10
buffer_store_dwordx4 v[128:131], v1, s[4:7], s76 offen offset:0 sc1
v_mfma_f32_16x16x32_bf16 v[172:175], a[108:111], v[124:127], v[172:175]
ds_read_b128 a[76:79], v2 offset:52224
v_cvt_pk_bf16_f32 v132, v132, v133
v_mfma_f32_16x16x32_bf16 v[172:175], a[104:107], v[120:123], v[172:175]
s_waitcnt lgkmcnt(4)
v_cvt_pk_bf16_f32 v133, v134, v135
v_cvt_pk_bf16_f32 v134, v140, v141
v_mfma_f32_16x16x32_bf16 v[176:179], a[112:115], v[112:115], v[176:179]
ds_read_b128 a[80:83], v2 offset:53248
v_cvt_pk_bf16_f32 v135, v142, v143
v_mfma_f32_16x16x32_bf16 v[176:179], a[116:119], v[116:119], v[176:179]
buffer_store_dwordx4 v[132:135], v1, s[4:7], s77 offen offset:0 sc1
v_mfma_f32_16x16x32_bf16 v[180:183], a[116:119], v[124:127], v[180:183]
ds_read_b128 a[84:87], v2 offset:54272
v_cvt_pk_bf16_f32 v144, v144, v145
v_mfma_f32_16x16x32_bf16 v[180:183], a[112:115], v[120:123], v[180:183]
v_cvt_pk_bf16_f32 v145, v146, v147
v_cvt_pk_bf16_f32 v146, v152, v153
v_mfma_f32_16x16x32_bf16 v[184:187], a[120:123], v[112:115], v[184:187]
ds_read_b128 a[88:91], v2 offset:55296
v_cvt_pk_bf16_f32 v147, v154, v155
v_mfma_f32_16x16x32_bf16 v[184:187], a[124:127], v[116:119], v[184:187]
buffer_store_dwordx4 v[144:147], v1, s[4:7], s76 offen offset:1024 sc1
v_mfma_f32_16x16x32_bf16 v[188:191], a[124:127], v[124:127], v[188:191]
ds_read_b128 a[92:95], v2 offset:56320
v_cvt_pk_bf16_f32 v148, v148, v149
v_mfma_f32_16x16x32_bf16 v[188:191], a[120:123], v[120:123], v[188:191]
s_waitcnt lgkmcnt(4)
v_cvt_pk_bf16_f32 v149, v150, v151
v_cvt_pk_bf16_f32 v150, v156, v157
v_mfma_f32_16x16x32_bf16 v[192:195], a[64:67], v[112:115], v[192:195]
ds_read_b128 a[96:99], v2 offset:57344
v_cvt_pk_bf16_f32 v151, v158, v159
v_mfma_f32_16x16x32_bf16 v[192:195], a[68:71], v[116:119], v[192:195]
buffer_store_dwordx4 v[148:151], v1, s[4:7], s77 offen offset:1024 sc1
v_mfma_f32_16x16x32_bf16 v[196:199], a[68:71], v[124:127], v[196:199]
ds_read_b128 a[100:103], v2 offset:58368
v_cvt_pk_bf16_f32 v160, v160, v161
v_mfma_f32_16x16x32_bf16 v[196:199], a[64:67], v[120:123], v[196:199]
v_cvt_pk_bf16_f32 v161, v162, v163
v_cvt_pk_bf16_f32 v162, v168, v169
v_mfma_f32_16x16x32_bf16 v[200:203], a[72:75], v[112:115], v[200:203]
ds_read_b128 a[104:107], v2 offset:59392
v_cvt_pk_bf16_f32 v163, v170, v171
v_mfma_f32_16x16x32_bf16 v[200:203], a[76:79], v[116:119], v[200:203]
buffer_store_dwordx4 v[160:163], v1, s[4:7], s76 offen offset:2048 sc1
v_mfma_f32_16x16x32_bf16 v[204:207], a[76:79], v[124:127], v[204:207]
ds_read_b128 a[108:111], v2 offset:60416
v_cvt_pk_bf16_f32 v164, v164, v165
v_mfma_f32_16x16x32_bf16 v[204:207], a[72:75], v[120:123], v[204:207]
s_waitcnt lgkmcnt(4)
v_cvt_pk_bf16_f32 v165, v166, v167
v_cvt_pk_bf16_f32 v166, v172, v173
v_mfma_f32_16x16x32_bf16 v[208:211], a[80:83], v[112:115], v[208:211]
ds_read_b128 a[112:115], v2 offset:61440
v_cvt_pk_bf16_f32 v167, v174, v175
v_mfma_f32_16x16x32_bf16 v[208:211], a[84:87], v[116:119], v[208:211]
buffer_store_dwordx4 v[164:167], v1, s[4:7], s77 offen offset:2048 sc1
v_mfma_f32_16x16x32_bf16 v[212:215], a[84:87], v[124:127], v[212:215]
ds_read_b128 a[116:119], v2 offset:62464
v_cvt_pk_bf16_f32 v176, v176, v177
v_mfma_f32_16x16x32_bf16 v[212:215], a[80:83], v[120:123], v[212:215]
v_cvt_pk_bf16_f32 v177, v178, v179
v_cvt_pk_bf16_f32 v178, v184, v185
v_mfma_f32_16x16x32_bf16 v[216:219], a[88:91], v[112:115], v[216:219]
ds_read_b128 a[120:123], v2 offset:63488
v_cvt_pk_bf16_f32 v179, v186, v187
v_mfma_f32_16x16x32_bf16 v[216:219], a[92:95], v[116:119], v[216:219]
buffer_store_dwordx4 v[176:179], v1, s[4:7], s76 offen offset:3072 sc1
v_mfma_f32_16x16x32_bf16 v[220:223], a[92:95], v[124:127], v[220:223]
ds_read_b128 a[124:127], v2 offset:64512
v_cvt_pk_bf16_f32 v180, v180, v181
v_mfma_f32_16x16x32_bf16 v[220:223], a[88:91], v[120:123], v[220:223]
s_waitcnt lgkmcnt(4)
v_cvt_pk_bf16_f32 v181, v182, v183
v_cvt_pk_bf16_f32 v182, v188, v189
v_mfma_f32_16x16x32_bf16 v[224:227], a[96:99], v[112:115], v[224:227]
PAD_34:
s_cbranch_execz M_tret
v_cvt_pk_bf16_f32 v183, v190, v191
v_accvgpr_mov_b32 a2, a194
v_mfma_f32_16x16x32_bf16 v[224:227], a[100:103], v[116:119], v[224:227]
buffer_store_dwordx4 v[180:183], v1, s[4:7], s77 offen offset:3072 sc1
v_mfma_f32_16x16x32_bf16 v[228:231], a[100:103], v[124:127], v[228:231]
s_add_u32 s76, s76, 4096
v_accvgpr_mov_b32 a3, a195
v_accvgpr_mov_b32 a4, a196
v_mfma_f32_16x16x32_bf16 v[228:231], a[96:99], v[120:123], v[228:231]
s_add_u32 s77, s77, 4096
v_cvt_pk_bf16_f32 v192, v192, v193
v_cvt_pk_bf16_f32 v193, v194, v195
v_mfma_f32_16x16x32_bf16 v[232:235], a[104:107], v[112:115], v[232:235]
v_cvt_pk_bf16_f32 v194, v200, v201
v_cvt_pk_bf16_f32 v195, v202, v203
v_mfma_f32_16x16x32_bf16 v[232:235], a[108:111], v[116:119], v[232:235]
buffer_store_dwordx4 v[192:195], v1, s[4:7], s76 offen offset:0 sc1
v_mfma_f32_16x16x32_bf16 v[236:239], a[108:111], v[124:127], v[236:239]
v_cvt_pk_bf16_f32 v196, v196, v197
v_cvt_pk_bf16_f32 v197, v198, v199
v_mfma_f32_16x16x32_bf16 v[236:239], a[104:107], v[120:123], v[236:239]
s_waitcnt lgkmcnt(0)
v_cvt_pk_bf16_f32 v198, v204, v205
v_cvt_pk_bf16_f32 v199, v206, v207
v_mfma_f32_16x16x32_bf16 v[240:243], a[112:115], v[112:115], v[240:243]
buffer_store_dwordx4 v[196:199], v1, s[4:7], s77 offen offset:0 sc1
v_mfma_f32_16x16x32_bf16 v[240:243], a[116:119], v[116:119], v[240:243]
v_cvt_pk_bf16_f32 v208, v208, v209
v_cvt_pk_bf16_f32 v209, v210, v211
v_mfma_f32_16x16x32_bf16 v[244:247], a[116:119], v[124:127], v[244:247]
v_cvt_pk_bf16_f32 v210, v216, v217
v_cvt_pk_bf16_f32 v211, v218, v219
v_mfma_f32_16x16x32_bf16 v[244:247], a[112:115], v[120:123], v[244:247]
buffer_store_dwordx4 v[208:211], v1, s[4:7], s76 offen offset:1024 sc1
v_mfma_f32_16x16x32_bf16 v[248:251], a[120:123], v[112:115], v[248:251]
v_cvt_pk_bf16_f32 v212, v212, v213
v_cvt_pk_bf16_f32 v213, v214, v215
v_mfma_f32_16x16x32_bf16 v[248:251], a[124:127], v[116:119], v[248:251]
v_cvt_pk_bf16_f32 v214, v220, v221
v_cvt_pk_bf16_f32 v215, v222, v223
v_mfma_f32_16x16x32_bf16 v[252:255], a[124:127], v[124:127], v[252:255]
buffer_store_dwordx4 v[212:215], v1, s[4:7], s77 offen offset:1024 sc1
v_mfma_f32_16x16x32_bf16 v[252:255], a[120:123], v[120:123], v[252:255]
v_cvt_pk_bf16_f32 v224, v224, v225
v_cvt_pk_bf16_f32 v225, v226, v227
v_accvgpr_mov_b32 a5, a197
v_accvgpr_mov_b32 a6, a198
v_accvgpr_mov_b32 a7, a199
v_accvgpr_mov_b32 a8, a200
v_accvgpr_mov_b32 a9, a201
v_accvgpr_mov_b32 a10, a202
v_accvgpr_mov_b32 a11, a203
v_accvgpr_mov_b32 a12, a204
v_cvt_pk_bf16_f32 v226, v232, v233
v_cvt_pk_bf16_f32 v227, v234, v235
buffer_store_dwordx4 v[224:227], v1, s[4:7], s76 offen offset:2048 sc1
v_cvt_pk_bf16_f32 v228, v228, v229
v_cvt_pk_bf16_f32 v229, v230, v231
v_cvt_pk_bf16_f32 v230, v236, v237
v_cvt_pk_bf16_f32 v231, v238, v239
buffer_store_dwordx4 v[228:231], v1, s[4:7], s77 offen offset:2048 sc1
v_cvt_pk_bf16_f32 v240, v240, v241
v_cvt_pk_bf16_f32 v241, v242, v243
v_cvt_pk_bf16_f32 v242, v248, v249
v_cvt_pk_bf16_f32 v243, v250, v251
buffer_store_dwordx4 v[240:243], v1, s[4:7], s76 offen offset:3072 sc1
v_cvt_pk_bf16_f32 v244, v244, v245
v_cvt_pk_bf16_f32 v245, v246, v247
v_cvt_pk_bf16_f32 v246, v252, v253
v_cvt_pk_bf16_f32 v247, v254, v255
buffer_store_dwordx4 v[244:247], v1, s[4:7], s77 offen offset:3072 sc1
v_accvgpr_mov_b32 a13, a205
v_accvgpr_mov_b32 a14, a206
v_accvgpr_mov_b32 a15, a207
v_accvgpr_mov_b32 a16, a208
v_accvgpr_mov_b32 a17, a209
v_accvgpr_mov_b32 a18, a210
v_accvgpr_mov_b32 a19, a211
v_accvgpr_mov_b32 a20, a212
v_accvgpr_mov_b32 a21, a213
v_accvgpr_mov_b32 a22, a214
v_accvgpr_mov_b32 a23, a215
v_accvgpr_mov_b32 a24, a216
v_accvgpr_mov_b32 a25, a217
v_accvgpr_mov_b32 a26, a218
v_accvgpr_mov_b32 a27, a219
v_accvgpr_mov_b32 a28, a220
v_accvgpr_mov_b32 a29, a221
v_accvgpr_mov_b32 a30, a222
v_accvgpr_mov_b32 a31, a223
v_accvgpr_mov_b32 a32, a224
v_accvgpr_mov_b32 a33, a225
v_accvgpr_mov_b32 a34, a226
v_accvgpr_mov_b32 a35, a227
v_accvgpr_mov_b32 a36, a228
v_accvgpr_mov_b32 a37, a229
v_accvgpr_mov_b32 a38, a230
v_accvgpr_mov_b32 a39, a231
v_accvgpr_mov_b32 a40, a232
v_accvgpr_mov_b32 a41, a233
v_accvgpr_mov_b32 a42, a234
v_accvgpr_mov_b32 a43, a235
v_accvgpr_mov_b32 a44, a236
v_accvgpr_mov_b32 a45, a237
v_accvgpr_mov_b32 a46, a238
v_accvgpr_mov_b32 a47, a239
v_accvgpr_mov_b32 a48, a240
v_accvgpr_mov_b32 a49, a241
v_accvgpr_mov_b32 a50, a242
v_accvgpr_mov_b32 a51, a243
v_accvgpr_mov_b32 a52, a244
v_accvgpr_mov_b32 a53, a245
v_accvgpr_mov_b32 a54, a246
v_accvgpr_mov_b32 a55, a247
v_accvgpr_mov_b32 a56, a248
v_accvgpr_mov_b32 a57, a249
v_accvgpr_mov_b32 a58, a250
v_accvgpr_mov_b32 a59, a251
v_accvgpr_mov_b32 a60, a252
v_accvgpr_mov_b32 a61, a253
v_accvgpr_mov_b32 a62, a254
v_accvgpr_mov_b32 a63, a255
s_mov_b32 s24, 0
s_mov_b32 s29, s21
s_mov_b32 s19, s21
v_mov_b64 v[128:129], 0
v_mov_b64 v[130:131], 0
v_mov_b64 v[132:133], 0
v_mov_b64 v[134:135], 0
v_mov_b64 v[136:137], 0
v_mov_b64 v[138:139], 0
v_mov_b64 v[140:141], 0
v_mov_b64 v[142:143], 0
v_mov_b64 v[144:145], 0
v_mov_b64 v[146:147], 0
v_mov_b64 v[148:149], 0
v_mov_b64 v[150:151], 0
v_mov_b64 v[152:153], 0
v_mov_b64 v[154:155], 0
v_mov_b64 v[156:157], 0
v_mov_b64 v[158:159], 0
v_mov_b64 v[160:161], 0
v_mov_b64 v[162:163], 0
v_mov_b64 v[164:165], 0
v_mov_b64 v[166:167], 0
v_mov_b64 v[168:169], 0
v_mov_b64 v[170:171], 0
v_mov_b64 v[172:173], 0
v_mov_b64 v[174:175], 0
v_mov_b64 v[176:177], 0
v_mov_b64 v[178:179], 0
v_mov_b64 v[180:181], 0
v_mov_b64 v[182:183], 0
v_mov_b64 v[184:185], 0
v_mov_b64 v[186:187], 0
v_mov_b64 v[188:189], 0
v_mov_b64 v[190:191], 0
v_mov_b64 v[192:193], 0
v_mov_b64 v[194:195], 0
v_mov_b64 v[196:197], 0
v_mov_b64 v[198:199], 0
v_mov_b64 v[200:201], 0
v_mov_b64 v[202:203], 0
v_mov_b64 v[204:205], 0
v_mov_b64 v[206:207], 0
v_mov_b64 v[208:209], 0
v_mov_b64 v[210:211], 0
v_mov_b64 v[212:213], 0
v_mov_b64 v[214:215], 0
v_mov_b64 v[216:217], 0
v_mov_b64 v[218:219], 0
v_mov_b64 v[220:221], 0
v_mov_b64 v[222:223], 0
v_mov_b64 v[224:225], 0
v_mov_b64 v[226:227], 0
v_mov_b64 v[228:229], 0
v_mov_b64 v[230:231], 0
v_mov_b64 v[232:233], 0
v_mov_b64 v[234:235], 0
v_mov_b64 v[236:237], 0
v_mov_b64 v[238:239], 0
v_mov_b64 v[240:241], 0
v_mov_b64 v[242:243], 0
v_mov_b64 v[244:245], 0
v_mov_b64 v[246:247], 0
v_mov_b64 v[248:249], 0
v_mov_b64 v[250:251], 0
v_mov_b64 v[252:253], 0
v_mov_b64 v[254:255], 0
v_mov_b64 v[24:25], 0
s_mov_b32 s71, s28
s_mov_b32 s84, 0
s_barrier
s_branch K2_item
K2_nend:
Lstub_2:
s_call_b64 s[16:17], K2_slow1
s_branch Lback_3
Lstub_4:
s_call_b64 s[16:17], K2_slow0
s_branch Lback_5
Lstub_6:
s_call_b64 s[16:17], K2_slow1
s_branch Lback_7
Lstub_8:
s_call_b64 s[16:17], K2_slow0
s_branch Lback_9
Lstub_10:
s_call_b64 s[16:17], K2_slow2
s_branch Lback_11
Lstub_12:
s_call_b64 s[16:17], K2_slow2
s_branch Lback_13
Lstub_14:
s_call_b64 s[16:17], K2_slow1
s_branch Lback_15
K2_slow0:
s_nop 7
s_nop 7
v_max3_f32 v8, v32, v33, 0
v_max3_f32 v8, v34, v35, v8
v_max3_f32 v8, v40, v41, v8
v_max3_f32 v8, v42, v43, v8
v_max3_f32 v8, v48, v49, v8
v_max3_f32 v8, v50, v51, v8
v_max3_f32 v8, v56, v57, v8
v_max3_f32 v8, v58, v59, v8
v_mov_b32 v9, v8
s_nop 1
v_permlane16_swap_b32 v8, v9
v_max_f32 v8, v8, v9
v_mov_b32 v9, v8
s_nop 1
v_permlane32_swap_b32 v8, v9
v_max_f32 v8, v8, v9
v_exp_f32 v9, -v8
v_sub_f32 v16, v16, v8
v_sub_f32 v17, v17, v8
v_sub_f32 v18, v18, v8
v_sub_f32 v19, v19, v8
v_mul_f32 v24, v24, v9
v_mul_f32 v128, v128, v9
v_mul_f32 v129, v129, v9
v_mul_f32 v130, v130, v9
v_mul_f32 v131, v131, v9
v_mul_f32 v136, v136, v9
v_mul_f32 v137, v137, v9
v_mul_f32 v138, v138, v9
v_mul_f32 v139, v139, v9
v_mul_f32 v144, v144, v9
v_mul_f32 v145, v145, v9
v_mul_f32 v146, v146, v9
v_mul_f32 v147, v147, v9
v_mul_f32 v152, v152, v9
v_mul_f32 v153, v153, v9
v_mul_f32 v154, v154, v9
v_mul_f32 v155, v155, v9
v_mul_f32 v160, v160, v9
v_mul_f32 v161, v161, v9
v_mul_f32 v162, v162, v9
v_mul_f32 v163, v163, v9
v_mul_f32 v168, v168, v9
v_mul_f32 v169, v169, v9
v_mul_f32 v170, v170, v9
v_mul_f32 v171, v171, v9
v_mul_f32 v176, v176, v9
v_mul_f32 v177, v177, v9
v_mul_f32 v178, v178, v9
v_mul_f32 v179, v179, v9
v_mul_f32 v184, v184, v9
v_mul_f32 v185, v185, v9
v_mul_f32 v186, v186, v9
v_mul_f32 v187, v187, v9
v_mul_f32 v192, v192, v9
v_mul_f32 v193, v193, v9
v_mul_f32 v194, v194, v9
v_mul_f32 v195, v195, v9
v_mul_f32 v200, v200, v9
v_mul_f32 v201, v201, v9
v_mul_f32 v202, v202, v9
v_mul_f32 v203, v203, v9
v_mul_f32 v208, v208, v9
v_mul_f32 v209, v209, v9
v_mul_f32 v210, v210, v9
v_mul_f32 v211, v211, v9
v_mul_f32 v216, v216, v9
v_mul_f32 v217, v217, v9
v_mul_f32 v218, v218, v9
v_mul_f32 v219, v219, v9
v_mul_f32 v224, v224, v9
v_mul_f32 v225, v225, v9
v_mul_f32 v226, v226, v9
v_mul_f32 v227, v227, v9
v_mul_f32 v232, v232, v9
v_mul_f32 v233, v233, v9
v_mul_f32 v234, v234, v9
v_mul_f32 v235, v235, v9
v_mul_f32 v240, v240, v9
v_mul_f32 v241, v241, v9
v_mul_f32 v242, v242, v9
v_mul_f32 v243, v243, v9
v_mul_f32 v248, v248, v9
v_mul_f32 v249, v249, v9
v_mul_f32 v250, v250, v9
v_mul_f32 v251, v251, v9
v_sub_f32 v32, v32, v8
v_sub_f32 v33, v33, v8
v_sub_f32 v34, v34, v8
v_sub_f32 v35, v35, v8
v_sub_f32 v40, v40, v8
v_sub_f32 v41, v41, v8
v_sub_f32 v42, v42, v8
v_sub_f32 v43, v43, v8
v_sub_f32 v48, v48, v8
v_sub_f32 v49, v49, v8
v_sub_f32 v50, v50, v8
v_sub_f32 v51, v51, v8
v_sub_f32 v56, v56, v8
v_sub_f32 v57, v57, v8
v_sub_f32 v58, v58, v8
v_sub_f32 v59, v59, v8
v_sub_f32 v64, v64, v8
v_sub_f32 v65, v65, v8
v_sub_f32 v66, v66, v8
v_sub_f32 v67, v67, v8
v_sub_f32 v72, v72, v8
v_sub_f32 v73, v73, v8
v_sub_f32 v74, v74, v8
v_sub_f32 v75, v75, v8
v_sub_f32 v80, v80, v8
v_sub_f32 v81, v81, v8
v_sub_f32 v82, v82, v8
v_sub_f32 v83, v83, v8
v_sub_f32 v88, v88, v8
v_sub_f32 v89, v89, v8
v_sub_f32 v90, v90, v8
v_sub_f32 v91, v91, v8
v_max3_f32 v8, v36, v37, 0
v_max3_f32 v8, v38, v39, v8
v_max3_f32 v8, v44, v45, v8
v_max3_f32 v8, v46, v47, v8
v_max3_f32 v8, v52, v53, v8
v_max3_f32 v8, v54, v55, v8
v_max3_f32 v8, v60, v61, v8
v_max3_f32 v8, v62, v63, v8
v_mov_b32 v9, v8
s_nop 1
v_permlane16_swap_b32 v8, v9
v_max_f32 v8, v8, v9
v_mov_b32 v9, v8
s_nop 1
v_permlane32_swap_b32 v8, v9
v_max_f32 v8, v8, v9
v_exp_f32 v9, -v8
v_sub_f32 v20, v20, v8
v_sub_f32 v21, v21, v8
v_sub_f32 v22, v22, v8
v_sub_f32 v23, v23, v8
v_mul_f32 v25, v25, v9
v_mul_f32 v132, v132, v9
v_mul_f32 v133, v133, v9
v_mul_f32 v134, v134, v9
v_mul_f32 v135, v135, v9
v_mul_f32 v140, v140, v9
v_mul_f32 v141, v141, v9
v_mul_f32 v142, v142, v9
v_mul_f32 v143, v143, v9
v_mul_f32 v148, v148, v9
v_mul_f32 v149, v149, v9
v_mul_f32 v150, v150, v9
v_mul_f32 v151, v151, v9
v_mul_f32 v156, v156, v9
v_mul_f32 v157, v157, v9
v_mul_f32 v158, v158, v9
v_mul_f32 v159, v159, v9
v_mul_f32 v164, v164, v9
v_mul_f32 v165, v165, v9
v_mul_f32 v166, v166, v9
v_mul_f32 v167, v167, v9
v_mul_f32 v172, v172, v9
v_mul_f32 v173, v173, v9
v_mul_f32 v174, v174, v9
v_mul_f32 v175, v175, v9
v_mul_f32 v180, v180, v9
v_mul_f32 v181, v181, v9
v_mul_f32 v182, v182, v9
v_mul_f32 v183, v183, v9
v_mul_f32 v188, v188, v9
v_mul_f32 v189, v189, v9
v_mul_f32 v190, v190, v9
v_mul_f32 v191, v191, v9
v_mul_f32 v196, v196, v9
v_mul_f32 v197, v197, v9
v_mul_f32 v198, v198, v9
v_mul_f32 v199, v199, v9
v_mul_f32 v204, v204, v9
v_mul_f32 v205, v205, v9
v_mul_f32 v206, v206, v9
v_mul_f32 v207, v207, v9
v_mul_f32 v212, v212, v9
v_mul_f32 v213, v213, v9
v_mul_f32 v214, v214, v9
v_mul_f32 v215, v215, v9
v_mul_f32 v220, v220, v9
v_mul_f32 v221, v221, v9
v_mul_f32 v222, v222, v9
v_mul_f32 v223, v223, v9
v_mul_f32 v228, v228, v9
v_mul_f32 v229, v229, v9
v_mul_f32 v230, v230, v9
v_mul_f32 v231, v231, v9
v_mul_f32 v236, v236, v9
v_mul_f32 v237, v237, v9
v_mul_f32 v238, v238, v9
v_mul_f32 v239, v239, v9
v_mul_f32 v244, v244, v9
v_mul_f32 v245, v245, v9
v_mul_f32 v246, v246, v9
v_mul_f32 v247, v247, v9
v_mul_f32 v252, v252, v9
v_mul_f32 v253, v253, v9
v_mul_f32 v254, v254, v9
v_mul_f32 v255, v255, v9
v_sub_f32 v36, v36, v8
v_sub_f32 v37, v37, v8
v_sub_f32 v38, v38, v8
v_sub_f32 v39, v39, v8
v_sub_f32 v44, v44, v8
v_sub_f32 v45, v45, v8
v_sub_f32 v46, v46, v8
v_sub_f32 v47, v47, v8
v_sub_f32 v52, v52, v8
v_sub_f32 v53, v53, v8
v_sub_f32 v54, v54, v8
v_sub_f32 v55, v55, v8
v_sub_f32 v60, v60, v8
v_sub_f32 v61, v61, v8
v_sub_f32 v62, v62, v8
v_sub_f32 v63, v63, v8
v_sub_f32 v68, v68, v8
v_sub_f32 v69, v69, v8
v_sub_f32 v70, v70, v8
v_sub_f32 v71, v71, v8
v_sub_f32 v76, v76, v8
v_sub_f32 v77, v77, v8
v_sub_f32 v78, v78, v8
v_sub_f32 v79, v79, v8
v_sub_f32 v84, v84, v8
v_sub_f32 v85, v85, v8
v_sub_f32 v86, v86, v8
v_sub_f32 v87, v87, v8
v_sub_f32 v92, v92, v8
v_sub_f32 v93, v93, v8
v_sub_f32 v94, v94, v8
v_sub_f32 v95, v95, v8
v_exp_f32 v8, v32
v_exp_f32 v9, v33
v_exp_f32 v10, v34
v_exp_f32 v11, v35
s_nop 0
v_add_f32 v26, v8, v9
v_cvt_pk_bf16_f32 v96, v8, v9
v_add_f32 v26, v26, v10
v_add_f32 v26, v26, v11
v_cvt_pk_bf16_f32 v97, v10, v11
v_exp_f32 v12, v36
v_exp_f32 v13, v37
v_exp_f32 v14, v38
v_exp_f32 v15, v39
s_nop 0
v_add_f32 v27, v12, v13
v_cvt_pk_bf16_f32 v104, v12, v13
v_add_f32 v27, v27, v14
v_add_f32 v27, v27, v15
v_cvt_pk_bf16_f32 v105, v14, v15
v_exp_f32 v8, v40
v_exp_f32 v9, v41
v_exp_f32 v10, v42
v_exp_f32 v11, v43
s_nop 0
v_add_f32 v26, v26, v8
v_add_f32 v26, v26, v9
v_cvt_pk_bf16_f32 v98, v8, v9
v_add_f32 v26, v26, v10
v_add_f32 v26, v26, v11
v_cvt_pk_bf16_f32 v99, v10, v11
v_exp_f32 v12, v44
v_exp_f32 v13, v45
v_exp_f32 v14, v46
v_exp_f32 v15, v47
s_nop 0
v_add_f32 v27, v27, v12
v_add_f32 v27, v27, v13
v_cvt_pk_bf16_f32 v106, v12, v13
v_add_f32 v27, v27, v14
v_add_f32 v27, v27, v15
v_cvt_pk_bf16_f32 v107, v14, v15
v_exp_f32 v8, v48
v_exp_f32 v9, v49
v_exp_f32 v10, v50
v_exp_f32 v11, v51
s_nop 0
v_add_f32 v26, v26, v8
v_add_f32 v26, v26, v9
v_cvt_pk_bf16_f32 v100, v8, v9
v_add_f32 v26, v26, v10
v_add_f32 v26, v26, v11
v_cvt_pk_bf16_f32 v101, v10, v11
v_exp_f32 v12, v52
v_exp_f32 v13, v53
v_exp_f32 v14, v54
v_exp_f32 v15, v55
s_nop 0
v_add_f32 v27, v27, v12
v_add_f32 v27, v27, v13
v_cvt_pk_bf16_f32 v108, v12, v13
v_add_f32 v27, v27, v14
v_add_f32 v27, v27, v15
v_cvt_pk_bf16_f32 v109, v14, v15
v_exp_f32 v8, v56
v_exp_f32 v9, v57
v_exp_f32 v10, v58
v_exp_f32 v11, v59
s_nop 0
v_add_f32 v26, v26, v8
v_add_f32 v26, v26, v9
v_cvt_pk_bf16_f32 v102, v8, v9
v_add_f32 v26, v26, v10
v_add_f32 v26, v26, v11
v_cvt_pk_bf16_f32 v103, v10, v11
v_exp_f32 v12, v60
v_exp_f32 v13, v61
v_exp_f32 v14, v62
v_exp_f32 v15, v63
s_nop 0
v_add_f32 v27, v27, v12
v_add_f32 v27, v27, v13
v_cvt_pk_bf16_f32 v110, v12, v13
v_add_f32 v27, v27, v14
v_add_f32 v27, v27, v15
v_cvt_pk_bf16_f32 v111, v14, v15
s_nop 1
s_setpc_b64 s[16:17]
K2_slow1:
s_nop 7
s_nop 7
v_max3_f32 v8, v64, v65, 0
v_max3_f32 v8, v66, v67, v8
v_max3_f32 v8, v72, v73, v8
v_max3_f32 v8, v74, v75, v8
v_max3_f32 v8, v80, v81, v8
v_max3_f32 v8, v82, v83, v8
v_max3_f32 v8, v88, v89, v8
v_max3_f32 v8, v90, v91, v8
v_mov_b32 v9, v8
s_nop 1
v_permlane16_swap_b32 v8, v9
v_max_f32 v8, v8, v9
v_mov_b32 v9, v8
s_nop 1
v_permlane32_swap_b32 v8, v9
v_max_f32 v8, v8, v9
v_exp_f32 v9, -v8
v_sub_f32 v16, v16, v8
v_sub_f32 v17, v17, v8
v_sub_f32 v18, v18, v8
v_sub_f32 v19, v19, v8
v_mul_f32 v24, v24, v9
v_mul_f32 v128, v128, v9
v_mul_f32 v129, v129, v9
v_mul_f32 v130, v130, v9
v_mul_f32 v131, v131, v9
v_mul_f32 v136, v136, v9
v_mul_f32 v137, v137, v9
v_mul_f32 v138, v138, v9
v_mul_f32 v139, v139, v9
v_mul_f32 v144, v144, v9
v_mul_f32 v145, v145, v9
v_mul_f32 v146, v146, v9
v_mul_f32 v147, v147, v9
v_mul_f32 v152, v152, v9
v_mul_f32 v153, v153, v9
v_mul_f32 v154, v154, v9
v_mul_f32 v155, v155, v9
v_mul_f32 v160, v160, v9
v_mul_f32 v161, v161, v9
v_mul_f32 v162, v162, v9
v_mul_f32 v163, v163, v9
v_mul_f32 v168, v168, v9
v_mul_f32 v169, v169, v9
v_mul_f32 v170, v170, v9
v_mul_f32 v171, v171, v9
v_mul_f32 v176, v176, v9
v_mul_f32 v177, v177, v9
v_mul_f32 v178, v178, v9
v_mul_f32 v179, v179, v9
v_mul_f32 v184, v184, v9
v_mul_f32 v185, v185, v9
v_mul_f32 v186, v186, v9
v_mul_f32 v187, v187, v9
v_mul_f32 v192, v192, v9
v_mul_f32 v193, v193, v9
v_mul_f32 v194, v194, v9
v_mul_f32 v195, v195, v9
v_mul_f32 v200, v200, v9
v_mul_f32 v201, v201, v9
v_mul_f32 v202, v202, v9
v_mul_f32 v203, v203, v9
v_mul_f32 v208, v208, v9
v_mul_f32 v209, v209, v9
v_mul_f32 v210, v210, v9
v_mul_f32 v211, v211, v9
v_mul_f32 v216, v216, v9
v_mul_f32 v217, v217, v9
v_mul_f32 v218, v218, v9
v_mul_f32 v219, v219, v9
v_mul_f32 v224, v224, v9
v_mul_f32 v225, v225, v9
v_mul_f32 v226, v226, v9
v_mul_f32 v227, v227, v9
v_mul_f32 v232, v232, v9
v_mul_f32 v233, v233, v9
v_mul_f32 v234, v234, v9
v_mul_f32 v235, v235, v9
v_mul_f32 v240, v240, v9
v_mul_f32 v241, v241, v9
v_mul_f32 v242, v242, v9
v_mul_f32 v243, v243, v9
v_mul_f32 v248, v248, v9
v_mul_f32 v249, v249, v9
v_mul_f32 v250, v250, v9
v_mul_f32 v251, v251, v9
v_sub_f32 v32, v32, v8
v_sub_f32 v33, v33, v8
v_sub_f32 v34, v34, v8
v_sub_f32 v35, v35, v8
v_sub_f32 v40, v40, v8
v_sub_f32 v41, v41, v8
v_sub_f32 v42, v42, v8
v_sub_f32 v43, v43, v8
v_sub_f32 v48, v48, v8
v_sub_f32 v49, v49, v8
v_sub_f32 v50, v50, v8
v_sub_f32 v51, v51, v8
v_sub_f32 v56, v56, v8
v_sub_f32 v57, v57, v8
v_sub_f32 v58, v58, v8
v_sub_f32 v59, v59, v8
v_sub_f32 v64, v64, v8
v_sub_f32 v65, v65, v8
v_sub_f32 v66, v66, v8
v_sub_f32 v67, v67, v8
v_sub_f32 v72, v72, v8
v_sub_f32 v73, v73, v8
v_sub_f32 v74, v74, v8
v_sub_f32 v75, v75, v8
v_sub_f32 v80, v80, v8
v_sub_f32 v81, v81, v8
v_sub_f32 v82, v82, v8
v_sub_f32 v83, v83, v8
v_sub_f32 v88, v88, v8
v_sub_f32 v89, v89, v8
v_sub_f32 v90, v90, v8
v_sub_f32 v91, v91, v8
v_max3_f32 v8, v68, v69, 0
v_max3_f32 v8, v70, v71, v8
v_max3_f32 v8, v76, v77, v8
v_max3_f32 v8, v78, v79, v8
v_max3_f32 v8, v84, v85, v8
v_max3_f32 v8, v86, v87, v8
v_max3_f32 v8, v92, v93, v8
v_max3_f32 v8, v94, v95, v8
v_mov_b32 v9, v8
s_nop 1
v_permlane16_swap_b32 v8, v9
v_max_f32 v8, v8, v9
v_mov_b32 v9, v8
s_nop 1
v_permlane32_swap_b32 v8, v9
v_max_f32 v8, v8, v9
v_exp_f32 v9, -v8
v_sub_f32 v20, v20, v8
v_sub_f32 v21, v21, v8
v_sub_f32 v22, v22, v8
v_sub_f32 v23, v23, v8
v_mul_f32 v25, v25, v9
v_mul_f32 v132, v132, v9
v_mul_f32 v133, v133, v9
v_mul_f32 v134, v134, v9
v_mul_f32 v135, v135, v9
v_mul_f32 v140, v140, v9
v_mul_f32 v141, v141, v9
v_mul_f32 v142, v142, v9
v_mul_f32 v143, v143, v9
v_mul_f32 v148, v148, v9
v_mul_f32 v149, v149, v9
v_mul_f32 v150, v150, v9
v_mul_f32 v151, v151, v9
v_mul_f32 v156, v156, v9
v_mul_f32 v157, v157, v9
v_mul_f32 v158, v158, v9
v_mul_f32 v159, v159, v9
v_mul_f32 v164, v164, v9
v_mul_f32 v165, v165, v9
v_mul_f32 v166, v166, v9
v_mul_f32 v167, v167, v9
v_mul_f32 v172, v172, v9
v_mul_f32 v173, v173, v9
v_mul_f32 v174, v174, v9
v_mul_f32 v175, v175, v9
v_mul_f32 v180, v180, v9
v_mul_f32 v181, v181, v9
v_mul_f32 v182, v182, v9
v_mul_f32 v183, v183, v9
v_mul_f32 v188, v188, v9
v_mul_f32 v189, v189, v9
v_mul_f32 v190, v190, v9
v_mul_f32 v191, v191, v9
v_mul_f32 v196, v196, v9
v_mul_f32 v197, v197, v9
v_mul_f32 v198, v198, v9
v_mul_f32 v199, v199, v9
v_mul_f32 v204, v204, v9
v_mul_f32 v205, v205, v9
v_mul_f32 v206, v206, v9
v_mul_f32 v207, v207, v9
v_mul_f32 v212, v212, v9
v_mul_f32 v213, v213, v9
v_mul_f32 v214, v214, v9
v_mul_f32 v215, v215, v9
v_mul_f32 v220, v220, v9
v_mul_f32 v221, v221, v9
v_mul_f32 v222, v222, v9
v_mul_f32 v223, v223, v9
v_mul_f32 v228, v228, v9
v_mul_f32 v229, v229, v9
v_mul_f32 v230, v230, v9
v_mul_f32 v231, v231, v9
v_mul_f32 v236, v236, v9
v_mul_f32 v237, v237, v9
v_mul_f32 v238, v238, v9
v_mul_f32 v239, v239, v9
v_mul_f32 v244, v244, v9
v_mul_f32 v245, v245, v9
v_mul_f32 v246, v246, v9
v_mul_f32 v247, v247, v9
v_mul_f32 v252, v252, v9
v_mul_f32 v253, v253, v9
v_mul_f32 v254, v254, v9
v_mul_f32 v255, v255, v9
v_sub_f32 v36, v36, v8
v_sub_f32 v37, v37, v8
v_sub_f32 v38, v38, v8
v_sub_f32 v39, v39, v8
v_sub_f32 v44, v44, v8
v_sub_f32 v45, v45, v8
v_sub_f32 v46, v46, v8
v_sub_f32 v47, v47, v8
v_sub_f32 v52, v52, v8
v_sub_f32 v53, v53, v8
v_sub_f32 v54, v54, v8
v_sub_f32 v55, v55, v8
v_sub_f32 v60, v60, v8
v_sub_f32 v61, v61, v8
v_sub_f32 v62, v62, v8
v_sub_f32 v63, v63, v8
v_sub_f32 v68, v68, v8
v_sub_f32 v69, v69, v8
v_sub_f32 v70, v70, v8
v_sub_f32 v71, v71, v8
v_sub_f32 v76, v76, v8
v_sub_f32 v77, v77, v8
v_sub_f32 v78, v78, v8
v_sub_f32 v79, v79, v8
v_sub_f32 v84, v84, v8
v_sub_f32 v85, v85, v8
v_sub_f32 v86, v86, v8
v_sub_f32 v87, v87, v8
v_sub_f32 v92, v92, v8
v_sub_f32 v93, v93, v8
v_sub_f32 v94, v94, v8
v_sub_f32 v95, v95, v8
v_exp_f32 v8, v64
v_exp_f32 v9, v65
v_exp_f32 v10, v66
v_exp_f32 v11, v67
s_nop 0
v_add_f32 v26, v8, v9
v_cvt_pk_bf16_f32 v112, v8, v9
v_add_f32 v26, v26, v10
v_add_f32 v26, v26, v11
v_cvt_pk_bf16_f32 v113, v10, v11
v_exp_f32 v12, v68
v_exp_f32 v13, v69
v_exp_f32 v14, v70
v_exp_f32 v15, v71
s_nop 0
v_add_f32 v27, v12, v13
v_cvt_pk_bf16_f32 v120, v12, v13
v_add_f32 v27, v27, v14
v_add_f32 v27, v27, v15
v_cvt_pk_bf16_f32 v121, v14, v15
v_exp_f32 v8, v72
v_exp_f32 v9, v73
v_exp_f32 v10, v74
v_exp_f32 v11, v75
s_nop 0
v_add_f32 v26, v26, v8
v_add_f32 v26, v26, v9
v_cvt_pk_bf16_f32 v114, v8, v9
v_add_f32 v26, v26, v10
v_add_f32 v26, v26, v11
v_cvt_pk_bf16_f32 v115, v10, v11
v_exp_f32 v12, v76
v_exp_f32 v13, v77
v_exp_f32 v14, v78
v_exp_f32 v15, v79
s_nop 0
v_add_f32 v27, v27, v12
v_add_f32 v27, v27, v13
v_cvt_pk_bf16_f32 v122, v12, v13
v_add_f32 v27, v27, v14
v_add_f32 v27, v27, v15
v_cvt_pk_bf16_f32 v123, v14, v15
v_exp_f32 v8, v80
v_exp_f32 v9, v81
v_exp_f32 v10, v82
v_exp_f32 v11, v83
s_nop 0
v_add_f32 v26, v26, v8
v_add_f32 v26, v26, v9
v_cvt_pk_bf16_f32 v116, v8, v9
v_add_f32 v26, v26, v10
v_add_f32 v26, v26, v11
v_cvt_pk_bf16_f32 v117, v10, v11
v_exp_f32 v12, v84
v_exp_f32 v13, v85
v_exp_f32 v14, v86
v_exp_f32 v15, v87
s_nop 0
v_add_f32 v27, v27, v12
v_add_f32 v27, v27, v13
v_cvt_pk_bf16_f32 v124, v12, v13
v_add_f32 v27, v27, v14
v_add_f32 v27, v27, v15
v_cvt_pk_bf16_f32 v125, v14, v15
v_exp_f32 v8, v88
v_exp_f32 v9, v89
v_exp_f32 v10, v90
v_exp_f32 v11, v91
s_nop 0
v_add_f32 v26, v26, v8
v_add_f32 v26, v26, v9
v_cvt_pk_bf16_f32 v118, v8, v9
v_add_f32 v26, v26, v10
v_add_f32 v26, v26, v11
v_cvt_pk_bf16_f32 v119, v10, v11
v_exp_f32 v12, v92
v_exp_f32 v13, v93
v_exp_f32 v14, v94
v_exp_f32 v15, v95
s_nop 0
v_add_f32 v27, v27, v12
v_add_f32 v27, v27, v13
v_cvt_pk_bf16_f32 v126, v12, v13
v_add_f32 v27, v27, v14
v_add_f32 v27, v27, v15
v_cvt_pk_bf16_f32 v127, v14, v15
s_nop 1
s_setpc_b64 s[16:17]
K2_slow2:
s_nop 7
s_nop 7
v_max3_f32 v8, v68, v69, 0
v_max3_f32 v8, v70, v71, v8
v_max3_f32 v8, v76, v77, v8
v_max3_f32 v8, v78, v79, v8
v_max3_f32 v8, v84, v85, v8
v_max3_f32 v8, v86, v87, v8
v_max3_f32 v8, v92, v93, v8
v_max3_f32 v8, v94, v95, v8
v_mov_b32 v9, v8
s_nop 1
v_permlane16_swap_b32 v8, v9
v_max_f32 v8, v8, v9
v_mov_b32 v9, v8
s_nop 1
v_permlane32_swap_b32 v8, v9
v_max_f32 v8, v8, v9
v_exp_f32 v9, -v8
v_sub_f32 v20, v20, v8
v_sub_f32 v21, v21, v8
v_sub_f32 v22, v22, v8
v_sub_f32 v23, v23, v8
v_mul_f32 v25, v25, v9
v_mul_f32 v132, v132, v9
v_mul_f32 v133, v133, v9
v_mul_f32 v134, v134, v9
v_mul_f32 v135, v135, v9
v_mul_f32 v140, v140, v9
v_mul_f32 v141, v141, v9
v_mul_f32 v142, v142, v9
v_mul_f32 v143, v143, v9
v_mul_f32 v148, v148, v9
v_mul_f32 v149, v149, v9
v_mul_f32 v150, v150, v9
v_mul_f32 v151, v151, v9
v_mul_f32 v156, v156, v9
v_mul_f32 v157, v157, v9
v_mul_f32 v158, v158, v9
v_mul_f32 v159, v159, v9
v_mul_f32 v164, v164, v9
v_mul_f32 v165, v165, v9
v_mul_f32 v166, v166, v9
v_mul_f32 v167, v167, v9
v_mul_f32 v172, v172, v9
v_mul_f32 v173, v173, v9
v_mul_f32 v174, v174, v9
v_mul_f32 v175, v175, v9
v_mul_f32 v180, v180, v9
v_mul_f32 v181, v181, v9
v_mul_f32 v182, v182, v9
v_mul_f32 v183, v183, v9
v_mul_f32 v188, v188, v9
v_mul_f32 v189, v189, v9
v_mul_f32 v190, v190, v9
v_mul_f32 v191, v191, v9
v_mul_f32 v196, v196, v9
v_mul_f32 v197, v197, v9
v_mul_f32 v198, v198, v9
v_mul_f32 v199, v199, v9
v_mul_f32 v204, v204, v9
v_mul_f32 v205, v205, v9
v_mul_f32 v206, v206, v9
v_mul_f32 v207, v207, v9
v_mul_f32 v212, v212, v9
v_mul_f32 v213, v213, v9
v_mul_f32 v214, v214, v9
v_mul_f32 v215, v215, v9
v_mul_f32 v220, v220, v9
v_mul_f32 v221, v221, v9
v_mul_f32 v222, v222, v9
v_mul_f32 v223, v223, v9
v_mul_f32 v228, v228, v9
v_mul_f32 v229, v229, v9
v_mul_f32 v230, v230, v9
v_mul_f32 v231, v231, v9
v_mul_f32 v236, v236, v9
v_mul_f32 v237, v237, v9
v_mul_f32 v238, v238, v9
v_mul_f32 v239, v239, v9
v_mul_f32 v244, v244, v9
v_mul_f32 v245, v245, v9
v_mul_f32 v246, v246, v9
v_mul_f32 v247, v247, v9
v_mul_f32 v252, v252, v9
v_mul_f32 v253, v253, v9
v_mul_f32 v254, v254, v9
v_mul_f32 v255, v255, v9
v_sub_f32 v68, v68, v8
v_sub_f32 v69, v69, v8
v_sub_f32 v70, v70, v8
v_sub_f32 v71, v71, v8
v_sub_f32 v76, v76, v8
v_sub_f32 v77, v77, v8
v_sub_f32 v78, v78, v8
v_sub_f32 v79, v79, v8
v_sub_f32 v84, v84, v8
v_sub_f32 v85, v85, v8
v_sub_f32 v86, v86, v8
v_sub_f32 v87, v87, v8
v_sub_f32 v92, v92, v8
v_sub_f32 v93, v93, v8
v_sub_f32 v94, v94, v8
v_sub_f32 v95, v95, v8
v_exp_f32 v8, v68
v_exp_f32 v9, v69
v_exp_f32 v10, v70
v_exp_f32 v11, v71
s_nop 0
v_add_f32 v27, v8, v9
v_cvt_pk_bf16_f32 v120, v8, v9
v_add_f32 v27, v27, v10
v_add_f32 v27, v27, v11
v_cvt_pk_bf16_f32 v121, v10, v11
v_exp_f32 v12, v76
v_exp_f32 v13, v77
v_exp_f32 v14, v78
v_exp_f32 v15, v79
s_nop 0
v_add_f32 v27, v27, v12
v_add_f32 v27, v27, v13
v_cvt_pk_bf16_f32 v122, v12, v13
v_add_f32 v27, v27, v14
v_add_f32 v27, v27, v15
v_cvt_pk_bf16_f32 v123, v14, v15
v_exp_f32 v8, v84
v_exp_f32 v9, v85
v_exp_f32 v10, v86
v_exp_f32 v11, v87
s_nop 0
v_add_f32 v27, v27, v8
v_add_f32 v27, v27, v9
v_cvt_pk_bf16_f32 v124, v8, v9
v_add_f32 v27, v27, v10
v_add_f32 v27, v27, v11
v_cvt_pk_bf16_f32 v125, v10, v11
v_exp_f32 v12, v92
v_exp_f32 v13, v93
v_exp_f32 v14, v94
v_exp_f32 v15, v95
s_nop 0
v_add_f32 v27, v27, v12
v_add_f32 v27, v27, v13
v_cvt_pk_bf16_f32 v126, v12, v13
v_add_f32 v27, v27, v14
v_add_f32 v27, v27, v15
v_cvt_pk_bf16_f32 v127, v14, v15
s_nop 1
s_setpc_b64 s[16:17]
M_cntspinK:
Lp_9801:
buffer_load_dword v245, off, s[60:63], s54 sc1
s_waitcnt vmcnt(0)
v_cmp_gt_u32 vcc, s50, v245
s_cbranch_vccz Lpd_9802
s_sleep 8
s_sub_u32 s101, s101, 1
s_cbranch_scc0 Lp_9801
s_mov_b32 s101, 0
Lpd_9802:
s_branch Lg_1
M_cntspinV:
Lp_9803:
buffer_load_dword v245, off, s[60:63], s54 sc1
s_waitcnt vmcnt(0)
v_cmp_gt_u32 vcc, s50, v245
s_cbranch_vccz Lpd_9804
s_sleep 8
s_sub_u32 s101, s101, 1
s_cbranch_scc0 Lp_9803
s_mov_b32 s101, 0
Lpd_9804:
s_branch Lg_501
M_ppspinV:
Lp_9805:
buffer_load_dword v230, v231, s[4:7], s52 offen sc1
s_waitcnt vmcnt(0)
v_cmp_gt_u32 vcc, 1, v230
s_cbranch_vccz Lpd_9806
s_sleep 8
s_sub_u32 s101, s101, 1
s_cbranch_scc0 Lp_9805
s_mov_b32 s101, 0
Lpd_9806:
s_branch M_ppokV
M_end:
s_endpgm
.section .rodata,"a"
.p2align 6
.amdhsa_kernel concat_heads__ssm_conv_h3__compressed_kv_cla__prompt_kernel
  .amdhsa_next_free_vgpr 512
  .amdhsa_next_free_sgpr 102
  .amdhsa_accum_offset 256
  .amdhsa_group_segment_fixed_size 0
  .amdhsa_kernarg_size 120
  .amdhsa_user_sgpr_count 2
  .amdhsa_user_sgpr_kernarg_segment_ptr 1
  .amdhsa_system_sgpr_workgroup_id_x 1
  .amdhsa_float_denorm_mode_32 3
  .amdhsa_float_denorm_mode_16_64 3
  .amdhsa_ieee_mode 0
  .amdhsa_dx10_clamp 0
.end_amdhsa_kernel
```

```asm
; @launch grid=(256,1,1) block=(256,1,1) lds=163840
.amdgcn_target "amdgcn-amd-amdhsa--gfx950"
.text
.globl concat_heads__ssm_conv_h3__compressed_kv_cla__prompt_kernel
.p2align 8
.type concat_heads__ssm_conv_h3__compressed_kv_cla__prompt_kernel,@function
concat_heads__ssm_conv_h3__compressed_kv_cla__prompt_kernel:
s_cmp_ge_u32 s2, 256
s_cbranch_scc1 M_end
s_load_dwordx16 s[64:79], s[0:1], 0
s_load_dwordx8 s[80:87], s[0:1], 64
s_load_dwordx4 s[88:91], s[0:1], 96
s_load_dwordx2 s[92:93], s[0:1], 112
s_getpc_b64 s[58:59]
M_pc:
s_lshr_b32 s22, s2, 3
s_lshl_b32 s22, s22, 5
v_and_b32 v26, 31, v0
v_add_u32 v26, s22, v26
v_lshlrev_b32 v26, 7, v26
v_min_u32 v26, M_end-M_pc, v26
v_mov_b32 v27, s59
v_add_co_u32 v26, vcc, s58, v26
s_nop 1
v_addc_co_u32 v27, vcc, 0, v27, vcc
global_load_dword v21, v[26:27], off
v_lshrrev_b32 v28, 6, v0
v_and_b32 v29, 63, v0
v_lshlrev_b32 v1, 4, v29
v_readfirstlane_b32 s3, v28
s_lshr_b32 s21, s2, 5
v_lshrrev_b32 v26, 7, v1
v_lshrrev_b32 v27, 1, v26
v_lshlrev_b32 v27, 4, v27
v_and_b32 v28, 0x70, v1
v_xor_b32 v27, v27, v28
v_mul_u32_u24 v26, 2048, v26
v_add_u32 v12, v26, v27
v_xor_b32 v27, 64, v27
v_add_u32 v26, v26, v27
v_add_u32 v13, 15360, v26
v_add_u32 v14, 30720, v12
v_add_u32 v15, 46080, v26
s_lshl_b32 s28, s3, 13
s_lshl_b32 s24, s21, 19
s_lshl_b32 s22, s3, 17
s_add_u32 s24, s24, s22
s_add_u32 s25, s24, 65536
s_mov_b32 s10, 4194304
s_mov_b32 s11, 0x20000
s_and_b32 s20, s2, 7
s_lshl_b32 s20, s20, 1
s_bfe_u32 s22, s2, 0x10003
s_add_u32 s20, s20, s22
v_lshrrev_b32 v26, 5, v29
v_and_b32 v27, 31, v29
s_and_b32 s22, s3, 1
s_lshl_b32 s22, s22, 2
v_or_b32 v28, s22, v26
v_lshlrev_b32 v28, 1, v28
v_xor_b32 v27, v27, v28
v_lshlrev_b32 v27, 4, v27
v_lshl_add_u32 v16, v26, 13, v27
v_xor_b32 v26, 64, v16
v_add_u32 v17, 15360, v26
v_add_u32 v18, 30720, v16
v_add_u32 v19, 46080, v26
s_lshl_b32 s29, s3, 12
s_lshl_b32 s26, s3, 16
s_lshl_b32 s22, s20, 9
s_add_u32 s26, s26, s22
s_add_u32 s27, s26, 262144
s_mov_b32 s14, 8388608
s_mov_b32 s15, 0x20000
s_mov_b32 s101, 0x40000
v_and_b32 v30, 15, v29
v_lshrrev_b32 v31, 4, v29
v_lshrrev_b32 v26, 1, v30
v_xor_b32 v26, v31, v26
v_lshlrev_b32 v26, 4, v26
v_lshl_add_u32 v2, v30, 7, v26
s_lshr_b32 s22, s3, 1
s_lshl_b32 s22, s22, 14
v_add_u32 v2, s22, v2
v_xor_b32 v3, 64, v2
v_lshrrev_b32 v26, 2, v30
v_and_b32 v27, 1, v31
v_lshl_or_b32 v27, v27, 2, v26
v_lshl_add_u32 v26, v31, 3, v26
v_lshlrev_b32 v26, 9, v26
v_lshl_add_u32 v26, v27, 5, v26
v_and_b32 v27, 3, v29
v_lshl_add_u32 v26, v27, 3, v26
s_and_b32 s22, s3, 1
s_lshl_b32 s22, s22, 8
s_add_u32 s22, s22, 0x10000
v_xor_b32 v4, s22, v26
v_xor_b32 v5, 32, v4
v_xor_b32 v6, 64, v4
v_xor_b32 v7, 96, v4
v_xor_b32 v8, 128, v4
v_xor_b32 v9, 160, v4
v_xor_b32 v10, 192, v4
v_xor_b32 v11, 224, v4
s_mov_b32 s19, 0x20000
s_cmp_eq_u32 s3, 2
s_cbranch_scc1 M_pf2
s_cmp_lg_u32 s3, 0
s_cbranch_scc1 M_pf3
s_mov_b32 s18, 8388608
s_mov_b32 s51, 8388608
s_mov_b32 s47, 524288
s_mov_b32 s43, 524288
s_lshl_b32 s22, s21, 16
s_lshl_b32 s23, s20, 9
s_add_u32 s22, s22, s23
v_bfe_u32 v26, v29, 2, 3
v_lshl_add_u32 v26, v26, 13, s22
v_and_b32 v27, 3, v29
v_lshl_add_u32 v20, v27, 7, v26
v_lshrrev_b32 v27, 5, v29
v_lshl_add_u32 v22, v27, 19, v20
s_mov_b32 s47, 786432
s_mov_b32 s43, 0
v_add_u32 v22, 524288, v22
s_mul_i32 s22, s21, 98304
s_add_u32 s22, s22, s23
v_lshrrev_b32 v26, 2, v29
v_lshl_add_u32 v26, v26, 13, s22
v_and_b32 v27, 3, v29
v_lshl_add_u32 v20, v27, 7, v26
v_cmp_gt_u32 vcc, 48, v29
s_branch M_pfd
M_pf2:
s_mov_b32 s18, 4194304
s_mov_b32 s51, 2048
s_mov_b32 s47, 256
s_mov_b32 s43, 0
s_lshl_b32 s22, s2, 14
v_bfe_u32 v26, v29, 1, 3
v_lshl_add_u32 v26, v26, 11, s22
v_and_b32 v27, 1, v29
v_lshl_add_u32 v20, v27, 7, v26
v_bfe_u32 v27, v29, 4, 1
v_lshl_add_u32 v22, v27, 8, v20
v_cmp_gt_u32 vcc, 16, v29
s_branch M_pfd
M_pf3:
s_mov_b32 s18, 0
s_mov_b32 s51, 2260992
s_mov_b32 s47, 753664
s_mov_b32 s43, 0
s_mul_i32 s22, s2, 2944
v_lshl_add_u32 v20, v29, 7, s22
v_mov_b32 v22, v20
v_cmp_gt_u32 vcc, 23, v29
M_pfd:
v_mov_b32 v26, 3221225472
s_nop 0
v_cndmask_b32 v20, v26, v20, vcc
s_bitcmp1_b32 s2, 4
s_waitcnt lgkmcnt(0)
s_mov_b64 s[8:9], s[78:79]
s_cselect_b64 s[12:13], s[84:85], s[82:83]
s_cmp_eq_u32 s3, 2
s_cselect_b32 s22, 0, 3221225472
buffer_load_dword v21, v20, s[8:11], s22 offen
s_add_u32 m0, s28, 0
s_nop 0
buffer_load_dwordx4 v12, s[8:11], s24 offen offset:0 lds
buffer_load_dwordx4 v13, s[8:11], s24 offen offset:1024 lds
buffer_load_dwordx4 v14, s[8:11], s24 offen offset:2048 lds
buffer_load_dwordx4 v15, s[8:11], s24 offen offset:3072 lds
s_add_u32 s24, s24, 128
s_add_u32 m0, s28, 4096
s_nop 0
buffer_load_dwordx4 v12, s[8:11], s25 offen offset:0 lds
buffer_load_dwordx4 v13, s[8:11], s25 offen offset:1024 lds
buffer_load_dwordx4 v14, s[8:11], s25 offen offset:2048 lds
buffer_load_dwordx4 v15, s[8:11], s25 offen offset:3072 lds
s_add_u32 s25, s25, 128
s_add_u32 m0, s29, 65536
s_nop 0
buffer_load_dwordx4 v16, s[12:15], s26 offen offset:0 lds
buffer_load_dwordx4 v17, s[12:15], s26 offen offset:1024 lds
buffer_load_dwordx4 v18, s[12:15], s26 offen offset:2048 lds
buffer_load_dwordx4 v19, s[12:15], s26 offen offset:3072 lds
s_add_u32 s26, s26, 524288
s_add_u32 m0, s29, 81920
s_nop 0
buffer_load_dwordx4 v16, s[12:15], s27 offen offset:0 lds
buffer_load_dwordx4 v17, s[12:15], s27 offen offset:1024 lds
buffer_load_dwordx4 v18, s[12:15], s27 offen offset:2048 lds
buffer_load_dwordx4 v19, s[12:15], s27 offen offset:3072 lds
s_add_u32 s27, s27, 524288
s_mov_b64 exec, 0
s_bfe_u32 s22, s2, 0x10004
s_lshl_b32 s22, s22, 2
s_add_u32 s22, s22, s3
s_cmp_lg_u32 s22, 0
s_cbranch_scc1 M_tw1
s_call_b64 s[98:99], PAD_0
s_call_b64 s[98:99], PAD_8
s_call_b64 s[98:99], PAD_12
s_call_b64 s[98:99], PAD_16
s_branch M_td
M_tw1:
s_cmp_lg_u32 s22, 1
s_cbranch_scc1 M_tw2
s_call_b64 s[98:99], PAD_1
s_call_b64 s[98:99], PAD_9
s_call_b64 s[98:99], PAD_13
s_branch M_td
M_tw2:
s_cmp_lg_u32 s22, 2
s_cbranch_scc1 M_tw3
s_call_b64 s[98:99], PAD_2
s_call_b64 s[98:99], PAD_6
s_call_b64 s[98:99], PAD_10
s_call_b64 s[98:99], PAD_14
s_branch M_td
M_tw3:
s_cmp_lg_u32 s22, 3
s_cbranch_scc1 M_tw4
s_call_b64 s[98:99], PAD_3
s_call_b64 s[98:99], PAD_7
s_call_b64 s[98:99], PAD_11
s_call_b64 s[98:99], PAD_15
s_branch M_td
M_tw4:
s_cmp_lg_u32 s22, 4
s_cbranch_scc1 M_tw5
s_call_b64 s[98:99], PAD_22
s_branch M_td
M_tw5:
s_cmp_lg_u32 s22, 5
s_cbranch_scc1 M_tw6
s_call_b64 s[98:99], PAD_23
s_branch M_td
M_tw6:
s_cmp_lg_u32 s22, 6
s_cbranch_scc1 M_tw7
s_call_b64 s[98:99], PAD_24
s_branch M_td
M_tw7:
s_call_b64 s[98:99], PAD_21
M_td:
s_mov_b64 exec, -1
s_cmp_eq_u32 s3, 0
s_cselect_b64 s[16:17], s[12:13], s[8:9]
buffer_load_dword v21, v22, s[16:19], s43 offen
s_add_u32 s43, s43, s47
s_add_u32 s43, s43, s47
s_add_u32 m0, s28, 32768
s_nop 0
buffer_load_dwordx4 v12, s[8:11], s24 offen offset:0 lds
buffer_load_dwordx4 v13, s[8:11], s24 offen offset:1024 lds
buffer_load_dwordx4 v14, s[8:11], s24 offen offset:2048 lds
buffer_load_dwordx4 v15, s[8:11], s24 offen offset:3072 lds
s_add_u32 s24, s24, 128
s_add_u32 m0, s28, 36864
s_nop 0
buffer_load_dwordx4 v12, s[8:11], s25 offen offset:0 lds
buffer_load_dwordx4 v13, s[8:11], s25 offen offset:1024 lds
buffer_load_dwordx4 v14, s[8:11], s25 offen offset:2048 lds
buffer_load_dwordx4 v15, s[8:11], s25 offen offset:3072 lds
s_add_u32 s25, s25, 128
s_mov_b32 s4, s92
s_mov_b32 s5, s93
s_mov_b32 s6, 268435456
s_mov_b32 s7, 0x20000
s_cmp_eq_u32 s3, 3
s_cselect_b64 s[40:41], s[76:77], s[80:81]
s_cselect_b32 s42, 1835008, 0
s_cmp_eq_u32 s3, 1
s_cselect_b32 s42, 3670016, s42
s_cmp_eq_u32 s3, 3
s_cselect_b64 s[44:45], s[86:87], s[72:73]
s_cselect_b32 s46, 3670016, 0
s_cmp_eq_u32 s3, 1
s_cselect_b32 s46, 1835008, s46
s_cmp_eq_u32 s3, 2
s_cselect_b64 s[40:41], s[64:65], s[40:41]
s_cselect_b32 s42, 1835008, s42
s_waitcnt vmcnt(17)
s_barrier
ds_read_b128 a[0:3], v2 offset:0
ds_read_b128 a[4:7], v3 offset:0
ds_read_b128 a[8:11], v2 offset:2048
ds_read_b128 a[12:15], v3 offset:2048
ds_read_b128 a[16:19], v2 offset:4096
ds_read_b128 a[20:23], v3 offset:4096
ds_read_b128 a[24:27], v2 offset:6144
ds_read_b128 a[28:31], v3 offset:6144
ds_read_b128 a[32:35], v2 offset:8192
ds_read_b128 a[36:39], v3 offset:8192
ds_read_b128 a[40:43], v2 offset:10240
ds_read_b128 a[44:47], v3 offset:10240
ds_read_b128 a[48:51], v2 offset:12288
ds_read_b128 a[52:55], v3 offset:12288
ds_read_b128 a[56:59], v2 offset:14336
ds_read_b128 a[60:63], v3 offset:14336
s_waitcnt vmcnt(9) lgkmcnt(0)
s_barrier
ds_read_b64_tr_b16 a[128:129], v4 offset:0
ds_read_b64_tr_b16 a[130:131], v4 offset:2048
ds_read_b64_tr_b16 a[132:133], v4 offset:16384
ds_read_b64_tr_b16 a[134:135], v4 offset:18432
s_waitcnt lgkmcnt(0)
s_bitcmp1_b32 s2, 4
s_cbranch_scc1 M_V
s_branch M_K
M_t2B:
s_mov_b64 exec, 0
s_cmp_lg_u32 s3, 0
s_cbranch_scc1 M_uw1
s_call_b64 s[98:99], PAD_32
s_call_b64 s[98:99], PAD_16
s_branch M_ud
M_uw1:
s_cmp_lg_u32 s3, 1
s_cbranch_scc1 M_uw2
s_call_b64 s[98:99], PAD_9
s_call_b64 s[98:99], PAD_33
s_call_b64 s[98:99], PAD_13
s_branch M_ud
M_uw2:
s_cmp_lg_u32 s3, 2
s_cbranch_scc1 M_uw3
s_call_b64 s[98:99], PAD_10
s_call_b64 s[98:99], PAD_34
s_call_b64 s[98:99], PAD_14
s_branch M_ud
M_uw3:
s_call_b64 s[98:99], PAD_11
s_call_b64 s[98:99], PAD_15
M_ud:
s_mov_b64 exec, -1
s_branch M_t2Br
M_t2A:
s_mov_b64 exec, 0
s_lshl_b32 s22, s24, 2
s_add_u32 s22, s22, s3
s_cmp_lg_u32 s22, 0
s_cbranch_scc1 M_vw1
s_call_b64 s[98:99], PAD_32
s_call_b64 s[98:99], PAD_16
s_branch M_vd
M_vw1:
s_cmp_lg_u32 s22, 1
s_cbranch_scc1 M_vw2
s_call_b64 s[98:99], PAD_13
s_branch M_vd
M_vw2:
s_cmp_lg_u32 s22, 2
s_cbranch_scc1 M_vw3
s_call_b64 s[98:99], PAD_14
s_call_b64 s[98:99], PAD_19
s_branch M_vd
M_vw3:
s_cmp_lg_u32 s22, 3
s_cbranch_scc1 M_vw4
s_call_b64 s[98:99], PAD_15
s_call_b64 s[98:99], PAD_20
s_branch M_vd
M_vw4:
s_cmp_lg_u32 s22, 4
s_cbranch_scc1 M_vw5
s_call_b64 s[98:99], PAD_12
s_call_b64 s[98:99], PAD_16
s_branch M_vd
M_vw5:
s_cmp_lg_u32 s22, 5
s_cbranch_scc1 M_vw6
s_call_b64 s[98:99], PAD_13
s_branch M_vd
M_vw6:
s_cmp_lg_u32 s22, 6
s_cbranch_scc1 M_vw7
s_call_b64 s[98:99], PAD_14
s_branch M_vd
M_vw7:
s_call_b64 s[98:99], PAD_15
M_vd:
s_mov_b64 exec, -1
s_branch M_t2Ar
M_tret:
s_setpc_b64 s[98:99]
.p2align 12
PAD_0:
s_cbranch_execz PAD_4
M_K:
v_mfma_f32_16x16x32_bf16 v[32:35], a[128:131], a[0:3], 0
s_add_u32 m0, s29, 98304
ds_read_b64_tr_b16 a[136:137], v5 offset:0
v_mfma_f32_16x16x32_bf16 v[32:35], a[132:135], a[4:7], v[32:35]
s_mov_b32 s32, 8192
buffer_load_dwordx4 v16, s[12:15], s26 offen offset:0 lds
v_mfma_f32_16x16x32_bf16 v[40:43], a[128:131], a[8:11], 0
s_mov_b32 s33, 8192
ds_read_b64_tr_b16 a[138:139], v5 offset:2048
v_mfma_f32_16x16x32_bf16 v[40:43], a[132:135], a[12:15], v[40:43]
s_mov_b32 s34, 8192
v_mfma_f32_16x16x32_bf16 v[48:51], a[128:131], a[16:19], 0
s_mov_b32 s35, 4294910976
ds_read_b64_tr_b16 a[140:141], v5 offset:16384
v_mfma_f32_16x16x32_bf16 v[48:51], a[132:135], a[20:23], v[48:51]
s_mov_b32 s36, 4294910976
buffer_load_dwordx4 v17, s[12:15], s26 offen offset:1024 lds
v_mfma_f32_16x16x32_bf16 v[56:59], a[128:131], a[24:27], 0
s_mov_b32 s30, 8
ds_read_b64_tr_b16 a[142:143], v5 offset:18432
v_mfma_f32_16x16x32_bf16 v[56:59], a[132:135], a[28:31], v[56:59]
s_mov_b32 s82, 3221225472
v_mfma_f32_16x16x32_bf16 v[64:67], a[128:131], a[32:35], 0
s_mul_hi_u32 s38, s2, 613566757
v_mfma_f32_16x16x32_bf16 v[64:67], a[132:135], a[36:39], v[64:67]
s_mul_i32 s39, s38, 7
buffer_load_dwordx4 v18, s[12:15], s26 offen offset:2048 lds
v_mfma_f32_16x16x32_bf16 v[72:75], a[128:131], a[40:43], 0
s_sub_u32 s39, s2, s39
v_mov_b32 v246, 0
v_mov_b32 v229, 0
v_mfma_f32_16x16x32_bf16 v[72:75], a[132:135], a[44:47], v[72:75]
v_mov_b32 v231, 0
v_mfma_f32_16x16x32_bf16 v[80:83], a[128:131], a[48:51], 0
s_mov_b32 s60, s90
v_mfma_f32_16x16x32_bf16 v[80:83], a[132:135], a[52:55], v[80:83]
s_mov_b32 s61, s91
buffer_load_dwordx4 v19, s[12:15], s26 offen offset:3072 lds
v_mfma_f32_16x16x32_bf16 v[88:91], a[128:131], a[56:59], 0
s_add_u32 s26, s26, 524288
v_mfma_f32_16x16x32_bf16 v[88:91], a[132:135], a[60:63], v[88:91]
s_waitcnt lgkmcnt(0)
s_mov_b32 s62, 256
v_mfma_f32_16x16x32_bf16 v[36:39], a[136:139], a[0:3], 0
s_add_u32 m0, s29, 114688
ds_read_b64_tr_b16 a[128:129], v6 offset:0
v_mfma_f32_16x16x32_bf16 v[36:39], a[140:143], a[4:7], v[36:39]
s_mov_b32 s63, 0x20000
buffer_load_dwordx4 v16, s[12:15], s27 offen offset:0 lds
v_mfma_f32_16x16x32_bf16 v[44:47], a[136:139], a[8:11], 0
s_mul_hi_u32 s55, s2, 1431655766
ds_read_b64_tr_b16 a[130:131], v6 offset:2048
v_mfma_f32_16x16x32_bf16 v[44:47], a[140:143], a[12:15], v[44:47]
s_mul_i32 s55, s55, 3
v_mfma_f32_16x16x32_bf16 v[52:55], a[136:139], a[16:19], 0
s_sub_u32 s55, s2, s55
ds_read_b64_tr_b16 a[132:133], v6 offset:16384
v_mfma_f32_16x16x32_bf16 v[52:55], a[140:143], a[20:23], v[52:55]
s_add_u32 s55, s55, 5
buffer_load_dwordx4 v17, s[12:15], s27 offen offset:1024 lds
v_mfma_f32_16x16x32_bf16 v[60:63], a[136:139], a[24:27], 0
s_lshr_b32 s22, s2, 4
ds_read_b64_tr_b16 a[134:135], v6 offset:18432
v_mfma_f32_16x16x32_bf16 v[60:63], a[140:143], a[28:31], v[60:63]
s_lshl_b32 s23, s20, 5
v_mfma_f32_16x16x32_bf16 v[68:71], a[136:139], a[32:35], 0
s_add_u32 s23, s23, s22
v_mfma_f32_16x16x32_bf16 v[68:71], a[140:143], a[36:39], v[68:71]
s_lshl_b32 s23, s23, 2
buffer_load_dwordx4 v18, s[12:15], s27 offen offset:2048 lds
v_mfma_f32_16x16x32_bf16 v[76:79], a[136:139], a[40:43], 0
s_and_b32 s22, s2, 16
v_mfma_f32_16x16x32_bf16 v[76:79], a[140:143], a[44:47], v[76:79]
s_lshl_b32 s22, s22, 7
v_mfma_f32_16x16x32_bf16 v[84:87], a[136:139], a[48:51], 0
s_add_u32 s23, s23, s22
v_mov_b32 v28, 3221225472
v_writelane_b32 v28, s23, 0
v_mfma_f32_16x16x32_bf16 v[84:87], a[140:143], a[52:55], v[84:87]
s_add_u32 s56, s23, 16384
buffer_load_dwordx4 v19, s[12:15], s27 offen offset:3072 lds
v_mfma_f32_16x16x32_bf16 v[92:95], a[136:139], a[56:59], 0
s_add_u32 s27, s27, 524288
v_writelane_b32 v28, s56, 1
v_mfma_f32_16x16x32_bf16 v[92:95], a[140:143], a[60:63], v[92:95]
s_waitcnt lgkmcnt(0)
s_add_u32 s56, s23, 4096
v_writelane_b32 v28, s56, 2
v_mfma_f32_16x16x32_bf16 v[96:99], a[128:131], a[0:3], 0
s_add_u32 m0, s28, 0
ds_read_b64_tr_b16 a[136:137], v7 offset:0
v_mfma_f32_16x16x32_bf16 v[96:99], a[132:135], a[4:7], v[96:99]
s_sub_u32 s37, 15, s21
buffer_load_dwordx4 v12, s[8:11], s24 offen offset:0 lds
v_mfma_f32_16x16x32_bf16 v[104:107], a[128:131], a[8:11], 0
ds_read_b64_tr_b16 a[138:139], v7 offset:2048
v_mfma_f32_16x16x32_bf16 v[104:107], a[132:135], a[12:15], v[104:107]
v_mfma_f32_16x16x32_bf16 v[112:115], a[128:131], a[16:19], 0
ds_read_b64_tr_b16 a[140:141], v7 offset:16384
v_mfma_f32_16x16x32_bf16 v[112:115], a[132:135], a[20:23], v[112:115]
buffer_load_dwordx4 v13, s[8:11], s24 offen offset:1024 lds
v_mfma_f32_16x16x32_bf16 v[120:123], a[128:131], a[24:27], 0
ds_read_b64_tr_b16 a[142:143], v7 offset:18432
v_mfma_f32_16x16x32_bf16 v[120:123], a[132:135], a[28:31], v[120:123]
v_mfma_f32_16x16x32_bf16 v[128:131], a[128:131], a[32:35], 0
v_mfma_f32_16x16x32_bf16 v[128:131], a[132:135], a[36:39], v[128:131]
buffer_load_dwordx4 v14, s[8:11], s24 offen offset:2048 lds
v_mfma_f32_16x16x32_bf16 v[136:139], a[128:131], a[40:43], 0
v_mfma_f32_16x16x32_bf16 v[136:139], a[132:135], a[44:47], v[136:139]
v_mfma_f32_16x16x32_bf16 v[144:147], a[128:131], a[48:51], 0
v_mfma_f32_16x16x32_bf16 v[144:147], a[132:135], a[52:55], v[144:147]
buffer_load_dwordx4 v15, s[8:11], s24 offen offset:3072 lds
v_mfma_f32_16x16x32_bf16 v[152:155], a[128:131], a[56:59], 0
s_add_u32 s24, s24, 128
v_mfma_f32_16x16x32_bf16 v[152:155], a[132:135], a[60:63], v[152:155]
s_waitcnt vmcnt(12) lgkmcnt(0)
s_barrier
v_mfma_f32_16x16x32_bf16 v[100:103], a[136:139], a[0:3], 0
s_add_u32 m0, s28, 4096
ds_read_b64_tr_b16 a[128:129], v8 offset:0
v_mfma_f32_16x16x32_bf16 v[100:103], a[140:143], a[4:7], v[100:103]
buffer_load_dwordx4 v12, s[8:11], s25 offen offset:0 lds
v_mfma_f32_16x16x32_bf16 v[108:111], a[136:139], a[8:11], 0
ds_read_b64_tr_b16 a[130:131], v8 offset:2048
v_mfma_f32_16x16x32_bf16 v[108:111], a[140:143], a[12:15], v[108:111]
v_mfma_f32_16x16x32_bf16 v[116:119], a[136:139], a[16:19], 0
ds_read_b64_tr_b16 a[132:133], v8 offset:16384
v_mfma_f32_16x16x32_bf16 v[116:119], a[140:143], a[20:23], v[116:119]
buffer_load_dwordx4 v13, s[8:11], s25 offen offset:1024 lds
v_mfma_f32_16x16x32_bf16 v[124:127], a[136:139], a[24:27], 0
ds_read_b64_tr_b16 a[134:135], v8 offset:18432
v_mfma_f32_16x16x32_bf16 v[124:127], a[140:143], a[28:31], v[124:127]
v_mfma_f32_16x16x32_bf16 v[132:135], a[136:139], a[32:35], 0
ds_read_b128 a[64:67], v2 offset:32768
v_mfma_f32_16x16x32_bf16 v[132:135], a[140:143], a[36:39], v[132:135]
buffer_load_dwordx4 v14, s[8:11], s25 offen offset:2048 lds
v_mfma_f32_16x16x32_bf16 v[140:143], a[136:139], a[40:43], 0
ds_read_b128 a[68:71], v3 offset:32768
v_mfma_f32_16x16x32_bf16 v[140:143], a[140:143], a[44:47], v[140:143]
ds_read_b128 a[72:75], v2 offset:34816
v_mfma_f32_16x16x32_bf16 v[148:151], a[136:139], a[48:51], 0
ds_read_b128 a[76:79], v3 offset:34816
v_mfma_f32_16x16x32_bf16 v[148:151], a[140:143], a[52:55], v[148:151]
buffer_load_dwordx4 v15, s[8:11], s25 offen offset:3072 lds
v_mfma_f32_16x16x32_bf16 v[156:159], a[136:139], a[56:59], 0
s_add_u32 s25, s25, 128
ds_read_b128 a[80:83], v2 offset:36864
v_mfma_f32_16x16x32_bf16 v[156:159], a[140:143], a[60:63], v[156:159]
s_waitcnt lgkmcnt(5)
ds_read_b128 a[84:87], v3 offset:36864
v_mfma_f32_16x16x32_bf16 v[160:163], a[128:131], a[0:3], 0
s_bitcmp1_b32 s2, 4
s_cselect_b32 s37, s21, s37
ds_read_b64_tr_b16 a[136:137], v9 offset:0
v_mfma_f32_16x16x32_bf16 v[160:163], a[132:135], a[4:7], v[160:163]
s_lshl_b32 s56, s37, 5
s_add_u32 s56, s56, s20
s_lshl_b32 s56, s56, 2
v_mfma_f32_16x16x32_bf16 v[168:171], a[128:131], a[8:11], 0
s_add_u32 s56, s56, 8192
ds_read_b64_tr_b16 a[138:139], v9 offset:2048
v_writelane_b32 v28, s56, 3
v_mfma_f32_16x16x32_bf16 v[168:171], a[132:135], a[12:15], v[168:171]
s_add_u32 s56, s56, 2048
v_writelane_b32 v28, s56, 6
v_mfma_f32_16x16x32_bf16 v[176:179], a[128:131], a[16:19], 0
s_add_u32 s56, s56, 4096
ds_read_b64_tr_b16 a[140:141], v9 offset:16384
v_writelane_b32 v28, s56, 5
v_mfma_f32_16x16x32_bf16 v[176:179], a[132:135], a[20:23], v[176:179]
s_lshl_b32 s56, s2, 2
s_add_u32 s56, s56, 12288
v_writelane_b32 v28, s56, 4
v_mfma_f32_16x16x32_bf16 v[184:187], a[128:131], a[24:27], 0
s_lshl_b32 s56, s39, 5
s_add_u32 s56, s56, s38
ds_read_b64_tr_b16 a[142:143], v9 offset:18432
v_mfma_f32_16x16x32_bf16 v[184:187], a[132:135], a[28:31], v[184:187]
s_lshl_b32 s56, s56, 2
s_add_u32 s56, s56, 20480
s_cmp_lt_u32 s2, 224
v_mfma_f32_16x16x32_bf16 v[192:195], a[128:131], a[32:35], 0
s_cselect_b32 s56, s56, 3221225472
v_writelane_b32 v28, s56, 7
v_mfma_f32_16x16x32_bf16 v[192:195], a[132:135], a[36:39], v[192:195]
s_cmp_eq_u32 s3, 0
s_cselect_b32 s56, 94371840, 3221225472
v_mfma_f32_16x16x32_bf16 v[200:203], a[128:131], a[40:43], 0
ds_read_b128 a[88:91], v2 offset:38912
v_mfma_f32_16x16x32_bf16 v[200:203], a[132:135], a[44:47], v[200:203]
ds_read_b128 a[92:95], v3 offset:38912
v_mfma_f32_16x16x32_bf16 v[208:211], a[128:131], a[48:51], 0
ds_read_b128 a[96:99], v2 offset:40960
v_mfma_f32_16x16x32_bf16 v[208:211], a[132:135], a[52:55], v[208:211]
buffer_store_dword v246, v28, s[4:7], s56 offen sc1
v_mfma_f32_16x16x32_bf16 v[216:219], a[128:131], a[56:59], 0
ds_read_b128 a[100:103], v3 offset:40960
v_mov_b32 v27, 1
v_mfma_f32_16x16x32_bf16 v[216:219], a[132:135], a[60:63], v[216:219]
s_waitcnt lgkmcnt(4)
ds_read_b128 a[104:107], v2 offset:43008
v_cmp_eq_u32 vcc, 0, v0
v_mfma_f32_16x16x32_bf16 v[164:167], a[136:139], a[0:3], 0
ds_read_b64_tr_b16 a[128:129], v10 offset:0
v_mov_b32 v26, 3221225472
v_mfma_f32_16x16x32_bf16 v[164:167], a[140:143], a[4:7], v[164:167]
s_lshl_b32 s31, s20, 20
s_lshl_b32 s22, s21, 17
v_cndmask_b32 v26, v26, v246, vcc
v_mfma_f32_16x16x32_bf16 v[172:175], a[136:139], a[8:11], 0
s_add_u32 s31, s31, s22
s_lshr_b32 s22, s3, 1
ds_read_b64_tr_b16 a[130:131], v10 offset:2048
v_mfma_f32_16x16x32_bf16 v[172:175], a[140:143], a[12:15], v[172:175]
s_lshl_b32 s22, s22, 16
s_add_u32 s31, s31, s22
s_and_b32 s22, s3, 1
v_mfma_f32_16x16x32_bf16 v[180:183], a[136:139], a[16:19], 0
s_lshl_b32 s22, s22, 12
s_add_u32 s31, s31, s22
ds_read_b64_tr_b16 a[132:133], v10 offset:16384
v_mfma_f32_16x16x32_bf16 v[180:183], a[140:143], a[20:23], v[180:183]
v_mfma_f32_16x16x32_bf16 v[188:191], a[136:139], a[24:27], 0
ds_read_b64_tr_b16 a[134:135], v10 offset:18432
v_mfma_f32_16x16x32_bf16 v[188:191], a[140:143], a[28:31], v[188:191]
v_mfma_f32_16x16x32_bf16 v[196:199], a[136:139], a[32:35], 0
v_mfma_f32_16x16x32_bf16 v[196:199], a[140:143], a[36:39], v[196:199]
v_mfma_f32_16x16x32_bf16 v[204:207], a[136:139], a[40:43], 0
ds_read_b128 a[108:111], v3 offset:43008
v_mfma_f32_16x16x32_bf16 v[204:207], a[140:143], a[44:47], v[204:207]
ds_read_b128 a[112:115], v2 offset:45056
v_mfma_f32_16x16x32_bf16 v[212:215], a[136:139], a[48:51], 0
ds_read_b128 a[116:119], v3 offset:45056
v_mfma_f32_16x16x32_bf16 v[212:215], a[140:143], a[52:55], v[212:215]
v_mfma_f32_16x16x32_bf16 v[220:223], a[136:139], a[56:59], 0
ds_read_b128 a[120:123], v2 offset:47104
v_mfma_f32_16x16x32_bf16 v[220:223], a[140:143], a[60:63], v[220:223]
s_waitcnt lgkmcnt(4)
ds_read_b128 a[124:127], v3 offset:47104
v_mfma_f32_16x16x32_bf16 a[192:195], a[128:131], a[0:3], 0
ds_read_b64_tr_b16 a[136:137], v11 offset:0
v_mfma_f32_16x16x32_bf16 a[192:195], a[132:135], a[4:7], a[192:195]
v_mfma_f32_16x16x32_bf16 a[200:203], a[128:131], a[8:11], 0
ds_read_b64_tr_b16 a[138:139], v11 offset:2048
v_mfma_f32_16x16x32_bf16 a[200:203], a[132:135], a[12:15], a[200:203]
v_mfma_f32_16x16x32_bf16 a[208:211], a[128:131], a[16:19], 0
ds_read_b64_tr_b16 a[140:141], v11 offset:16384
v_mfma_f32_16x16x32_bf16 a[208:211], a[132:135], a[20:23], a[208:211]
v_mfma_f32_16x16x32_bf16 a[216:219], a[128:131], a[24:27], 0
ds_read_b64_tr_b16 a[142:143], v11 offset:18432
v_mfma_f32_16x16x32_bf16 a[216:219], a[132:135], a[28:31], a[216:219]
v_mfma_f32_16x16x32_bf16 a[224:227], a[128:131], a[32:35], 0
v_mfma_f32_16x16x32_bf16 a[224:227], a[132:135], a[36:39], a[224:227]
v_mfma_f32_16x16x32_bf16 a[232:235], a[128:131], a[40:43], 0
v_mfma_f32_16x16x32_bf16 a[232:235], a[132:135], a[44:47], a[232:235]
v_mfma_f32_16x16x32_bf16 a[240:243], a[128:131], a[48:51], 0
v_mfma_f32_16x16x32_bf16 a[240:243], a[132:135], a[52:55], a[240:243]
v_mfma_f32_16x16x32_bf16 a[248:251], a[128:131], a[56:59], 0
s_waitcnt vmcnt(1) lgkmcnt(0)
v_mfma_f32_16x16x32_bf16 a[248:251], a[132:135], a[60:63], a[248:251]
s_barrier
v_mfma_f32_16x16x32_bf16 a[196:199], a[136:139], a[0:3], 0
s_add_u32 m0, s29, 65536
ds_read_b64_tr_b16 a[128:129], v4 offset:32768
v_mfma_f32_16x16x32_bf16 a[196:199], a[140:143], a[4:7], a[196:199]
buffer_load_dwordx4 v16, s[12:15], s26 offen offset:0 lds
v_mfma_f32_16x16x32_bf16 a[204:207], a[136:139], a[8:11], 0
ds_read_b64_tr_b16 a[130:131], v4 offset:34816
v_mfma_f32_16x16x32_bf16 a[204:207], a[140:143], a[12:15], a[204:207]
v_mfma_f32_16x16x32_bf16 a[212:215], a[136:139], a[16:19], 0
ds_read_b64_tr_b16 a[132:133], v4 offset:49152
v_mfma_f32_16x16x32_bf16 a[212:215], a[140:143], a[20:23], a[212:215]
buffer_load_dwordx4 v17, s[12:15], s26 offen offset:1024 lds
v_mfma_f32_16x16x32_bf16 a[220:223], a[136:139], a[24:27], 0
ds_read_b64_tr_b16 a[134:135], v4 offset:51200
v_mfma_f32_16x16x32_bf16 a[220:223], a[140:143], a[28:31], a[220:223]
v_mfma_f32_16x16x32_bf16 a[228:231], a[136:139], a[32:35], 0
v_mfma_f32_16x16x32_bf16 a[228:231], a[140:143], a[36:39], a[228:231]
buffer_load_dwordx4 v18, s[12:15], s26 offen offset:2048 lds
v_mfma_f32_16x16x32_bf16 a[236:239], a[136:139], a[40:43], 0
v_mfma_f32_16x16x32_bf16 a[236:239], a[140:143], a[44:47], a[236:239]
v_mfma_f32_16x16x32_bf16 a[244:247], a[136:139], a[48:51], 0
v_mfma_f32_16x16x32_bf16 a[244:247], a[140:143], a[52:55], a[244:247]
buffer_load_dwordx4 v19, s[12:15], s26 offen offset:3072 lds
v_mfma_f32_16x16x32_bf16 a[252:255], a[136:139], a[56:59], 0
s_add_u32 s26, s26, 524288
v_mfma_f32_16x16x32_bf16 a[252:255], a[140:143], a[60:63], a[252:255]
s_waitcnt lgkmcnt(0)
Lg_1:
v_mfma_f32_16x16x32_bf16 v[32:35], a[128:131], a[64:67], v[32:35]
s_add_u32 m0, s29, 81920
ds_read_b64_tr_b16 a[136:137], v5 offset:32768
v_mfma_f32_16x16x32_bf16 v[32:35], a[132:135], a[68:71], v[32:35]
buffer_load_dwordx4 v16, s[12:15], s27 offen offset:0 lds
v_mfma_f32_16x16x32_bf16 v[40:43], a[128:131], a[72:75], v[40:43]
ds_read_b64_tr_b16 a[138:139], v5 offset:34816
v_mfma_f32_16x16x32_bf16 v[40:43], a[132:135], a[76:79], v[40:43]
v_mfma_f32_16x16x32_bf16 v[48:51], a[128:131], a[80:83], v[48:51]
ds_read_b64_tr_b16 a[140:141], v5 offset:49152
v_mfma_f32_16x16x32_bf16 v[48:51], a[132:135], a[84:87], v[48:51]
buffer_load_dwordx4 v17, s[12:15], s27 offen offset:1024 lds
v_mfma_f32_16x16x32_bf16 v[56:59], a[128:131], a[88:91], v[56:59]
ds_read_b64_tr_b16 a[142:143], v5 offset:51200
v_mfma_f32_16x16x32_bf16 v[56:59], a[132:135], a[92:95], v[56:59]
v_mfma_f32_16x16x32_bf16 v[64:67], a[128:131], a[96:99], v[64:67]
ds_read_b128 a[0:3], v2 offset:0
v_mfma_f32_16x16x32_bf16 v[64:67], a[132:135], a[100:103], v[64:67]
buffer_load_dwordx4 v18, s[12:15], s27 offen offset:2048 lds
v_mfma_f32_16x16x32_bf16 v[72:75], a[128:131], a[104:107], v[72:75]
ds_read_b128 a[4:7], v3 offset:0
v_mfma_f32_16x16x32_bf16 v[72:75], a[132:135], a[108:111], v[72:75]
v_mfma_f32_16x16x32_bf16 v[80:83], a[128:131], a[112:115], v[80:83]
v_mfma_f32_16x16x32_bf16 v[80:83], a[132:135], a[116:119], v[80:83]
buffer_load_dwordx4 v19, s[12:15], s27 offen offset:3072 lds
v_mfma_f32_16x16x32_bf16 v[88:91], a[128:131], a[120:123], v[88:91]
s_add_u32 s27, s27, 524288
ds_read_b128 a[8:11], v2 offset:2048
v_mfma_f32_16x16x32_bf16 v[88:91], a[132:135], a[124:127], v[88:91]
s_waitcnt lgkmcnt(3)
v_mfma_f32_16x16x32_bf16 v[36:39], a[136:139], a[64:67], v[36:39]
s_add_u32 m0, s28, 32768
ds_read_b64_tr_b16 a[128:129], v6 offset:32768
v_mfma_f32_16x16x32_bf16 v[36:39], a[140:143], a[68:71], v[36:39]
buffer_load_dwordx4 v12, s[8:11], s24 offen offset:0 lds
v_mfma_f32_16x16x32_bf16 v[44:47], a[136:139], a[72:75], v[44:47]
ds_read_b64_tr_b16 a[130:131], v6 offset:34816
v_mfma_f32_16x16x32_bf16 v[44:47], a[140:143], a[76:79], v[44:47]
v_mfma_f32_16x16x32_bf16 v[52:55], a[136:139], a[80:83], v[52:55]
ds_read_b64_tr_b16 a[132:133], v6 offset:49152
v_mfma_f32_16x16x32_bf16 v[52:55], a[140:143], a[84:87], v[52:55]
buffer_load_dwordx4 v13, s[8:11], s24 offen offset:1024 lds
v_mfma_f32_16x16x32_bf16 v[60:63], a[136:139], a[88:91], v[60:63]
ds_read_b64_tr_b16 a[134:135], v6 offset:51200
v_mfma_f32_16x16x32_bf16 v[60:63], a[140:143], a[92:95], v[60:63]
v_mfma_f32_16x16x32_bf16 v[68:71], a[136:139], a[96:99], v[68:71]
ds_read_b128 a[12:15], v3 offset:2048
v_mfma_f32_16x16x32_bf16 v[68:71], a[140:143], a[100:103], v[68:71]
buffer_load_dwordx4 v14, s[8:11], s24 offen offset:2048 lds
v_mfma_f32_16x16x32_bf16 v[76:79], a[136:139], a[104:107], v[76:79]
v_mfma_f32_16x16x32_bf16 v[76:79], a[140:143], a[108:111], v[76:79]
v_mfma_f32_16x16x32_bf16 v[84:87], a[136:139], a[112:115], v[84:87]
ds_read_b128 a[16:19], v2 offset:4096
v_mfma_f32_16x16x32_bf16 v[84:87], a[140:143], a[116:119], v[84:87]
buffer_load_dwordx4 v15, s[8:11], s24 offen offset:3072 lds
v_mfma_f32_16x16x32_bf16 v[92:95], a[136:139], a[120:123], v[92:95]
s_add_u32 s24, s24, 128
ds_read_b128 a[20:23], v3 offset:4096
v_mfma_f32_16x16x32_bf16 v[92:95], a[140:143], a[124:127], v[92:95]
s_waitcnt lgkmcnt(3)
v_mfma_f32_16x16x32_bf16 v[96:99], a[128:131], a[64:67], v[96:99]
s_add_u32 m0, s28, 36864
ds_read_b64_tr_b16 a[136:137], v7 offset:32768
v_mfma_f32_16x16x32_bf16 v[96:99], a[132:135], a[68:71], v[96:99]
buffer_load_dwordx4 v12, s[8:11], s25 offen offset:0 lds
v_mfma_f32_16x16x32_bf16 v[104:107], a[128:131], a[72:75], v[104:107]
ds_read_b64_tr_b16 a[138:139], v7 offset:34816
v_mfma_f32_16x16x32_bf16 v[104:107], a[132:135], a[76:79], v[104:107]
v_mfma_f32_16x16x32_bf16 v[112:115], a[128:131], a[80:83], v[112:115]
ds_read_b64_tr_b16 a[140:141], v7 offset:49152
v_mfma_f32_16x16x32_bf16 v[112:115], a[132:135], a[84:87], v[112:115]
buffer_load_dwordx4 v13, s[8:11], s25 offen offset:1024 lds
v_mfma_f32_16x16x32_bf16 v[120:123], a[128:131], a[88:91], v[120:123]
ds_read_b64_tr_b16 a[142:143], v7 offset:51200
v_mfma_f32_16x16x32_bf16 v[120:123], a[132:135], a[92:95], v[120:123]
v_mfma_f32_16x16x32_bf16 v[128:131], a[128:131], a[96:99], v[128:131]
v_mfma_f32_16x16x32_bf16 v[128:131], a[132:135], a[100:103], v[128:131]
buffer_load_dwordx4 v14, s[8:11], s25 offen offset:2048 lds
v_mfma_f32_16x16x32_bf16 v[136:139], a[128:131], a[104:107], v[136:139]
ds_read_b128 a[24:27], v2 offset:6144
v_mfma_f32_16x16x32_bf16 v[136:139], a[132:135], a[108:111], v[136:139]
v_mfma_f32_16x16x32_bf16 v[144:147], a[128:131], a[112:115], v[144:147]
ds_read_b128 a[28:31], v3 offset:6144
v_mfma_f32_16x16x32_bf16 v[144:147], a[132:135], a[116:119], v[144:147]
buffer_load_dwordx4 v15, s[8:11], s25 offen offset:3072 lds
v_mfma_f32_16x16x32_bf16 v[152:155], a[128:131], a[120:123], v[152:155]
s_add_u32 s25, s25, 128
v_mfma_f32_16x16x32_bf16 v[152:155], a[132:135], a[124:127], v[152:155]
s_waitcnt lgkmcnt(2)
v_mfma_f32_16x16x32_bf16 v[100:103], a[136:139], a[64:67], v[100:103]
ds_read_b64_tr_b16 a[128:129], v8 offset:32768
v_mfma_f32_16x16x32_bf16 v[100:103], a[140:143], a[68:71], v[100:103]
buffer_load_dword v21, v20, s[16:19], s43 offen
v_mfma_f32_16x16x32_bf16 v[108:111], a[136:139], a[72:75], v[108:111]
s_add_u32 s43, s43, s47
ds_read_b64_tr_b16 a[130:131], v8 offset:34816
v_mfma_f32_16x16x32_bf16 v[108:111], a[140:143], a[76:79], v[108:111]
s_cmp_ge_u32 s43, s51
v_mfma_f32_16x16x32_bf16 v[116:119], a[136:139], a[80:83], v[116:119]
s_cselect_b32 s43, 0, s43
ds_read_b64_tr_b16 a[132:133], v8 offset:49152
v_mfma_f32_16x16x32_bf16 v[116:119], a[140:143], a[84:87], v[116:119]
s_cselect_b32 s51, s42, s51
v_mfma_f32_16x16x32_bf16 v[124:127], a[136:139], a[88:91], v[124:127]
s_cselect_b64 s[16:17], s[40:41], s[16:17]
ds_read_b64_tr_b16 a[134:135], v8 offset:51200
v_mfma_f32_16x16x32_bf16 v[124:127], a[140:143], a[92:95], v[124:127]
s_cselect_b32 s18, s42, s18
v_mfma_f32_16x16x32_bf16 v[132:135], a[136:139], a[96:99], v[132:135]
s_cselect_b64 s[40:41], s[44:45], s[40:41]
ds_read_b128 a[32:35], v2 offset:8192
v_mfma_f32_16x16x32_bf16 v[132:135], a[140:143], a[100:103], v[132:135]
s_cselect_b32 s42, s46, s42
v_mfma_f32_16x16x32_bf16 v[140:143], a[136:139], a[104:107], v[140:143]
s_cselect_b32 s46, 0, s46
v_mfma_f32_16x16x32_bf16 v[140:143], a[140:143], a[108:111], v[140:143]
s_cmp_eq_u32 s30, s55
v_mfma_f32_16x16x32_bf16 v[148:151], a[136:139], a[112:115], v[148:151]
s_cselect_b32 s22, 0, 3221225472
ds_read_b128 a[36:39], v3 offset:8192
v_mfma_f32_16x16x32_bf16 v[148:151], a[140:143], a[116:119], v[148:151]
s_sub_u32 s30, s30, 1
buffer_atomic_add v27, v26, s[60:63], s22 offen sc1
v_mfma_f32_16x16x32_bf16 v[156:159], a[136:139], a[120:123], v[156:159]
ds_read_b128 a[40:43], v2 offset:10240
v_mfma_f32_16x16x32_bf16 v[156:159], a[140:143], a[124:127], v[156:159]
s_waitcnt lgkmcnt(3)
v_mfma_f32_16x16x32_bf16 v[160:163], a[128:131], a[64:67], v[160:163]
ds_read_b64_tr_b16 a[136:137], v9 offset:32768
v_mfma_f32_16x16x32_bf16 v[160:163], a[132:135], a[68:71], v[160:163]
v_mfma_f32_16x16x32_bf16 v[168:171], a[128:131], a[72:75], v[168:171]
ds_read_b64_tr_b16 a[138:139], v9 offset:34816
v_mfma_f32_16x16x32_bf16 v[168:171], a[132:135], a[76:79], v[168:171]
v_mfma_f32_16x16x32_bf16 v[176:179], a[128:131], a[80:83], v[176:179]
ds_read_b64_tr_b16 a[140:141], v9 offset:49152
v_mfma_f32_16x16x32_bf16 v[176:179], a[132:135], a[84:87], v[176:179]
v_mfma_f32_16x16x32_bf16 v[184:187], a[128:131], a[88:91], v[184:187]
ds_read_b64_tr_b16 a[142:143], v9 offset:51200
v_mfma_f32_16x16x32_bf16 v[184:187], a[132:135], a[92:95], v[184:187]
v_mfma_f32_16x16x32_bf16 v[192:195], a[128:131], a[96:99], v[192:195]
v_mfma_f32_16x16x32_bf16 v[192:195], a[132:135], a[100:103], v[192:195]
v_mfma_f32_16x16x32_bf16 v[200:203], a[128:131], a[104:107], v[200:203]
ds_read_b128 a[44:47], v3 offset:10240
v_mfma_f32_16x16x32_bf16 v[200:203], a[132:135], a[108:111], v[200:203]
v_mfma_f32_16x16x32_bf16 v[208:211], a[128:131], a[112:115], v[208:211]
ds_read_b128 a[48:51], v2 offset:12288
v_mfma_f32_16x16x32_bf16 v[208:211], a[132:135], a[116:119], v[208:211]
v_mfma_f32_16x16x32_bf16 v[216:219], a[128:131], a[120:123], v[216:219]
v_mfma_f32_16x16x32_bf16 v[216:219], a[132:135], a[124:127], v[216:219]
s_waitcnt lgkmcnt(2)
v_mfma_f32_16x16x32_bf16 v[164:167], a[136:139], a[64:67], v[164:167]
ds_read_b64_tr_b16 a[128:129], v10 offset:32768
v_mfma_f32_16x16x32_bf16 v[164:167], a[140:143], a[68:71], v[164:167]
v_mfma_f32_16x16x32_bf16 v[172:175], a[136:139], a[72:75], v[172:175]
ds_read_b64_tr_b16 a[130:131], v10 offset:34816
v_mfma_f32_16x16x32_bf16 v[172:175], a[140:143], a[76:79], v[172:175]
v_mfma_f32_16x16x32_bf16 v[180:183], a[136:139], a[80:83], v[180:183]
ds_read_b64_tr_b16 a[132:133], v10 offset:49152
v_mfma_f32_16x16x32_bf16 v[180:183], a[140:143], a[84:87], v[180:183]
v_mfma_f32_16x16x32_bf16 v[188:191], a[136:139], a[88:91], v[188:191]
ds_read_b64_tr_b16 a[134:135], v10 offset:51200
v_mfma_f32_16x16x32_bf16 v[188:191], a[140:143], a[92:95], v[188:191]
v_mfma_f32_16x16x32_bf16 v[196:199], a[136:139], a[96:99], v[196:199]
ds_read_b128 a[52:55], v3 offset:12288
v_mfma_f32_16x16x32_bf16 v[196:199], a[140:143], a[100:103], v[196:199]
v_mfma_f32_16x16x32_bf16 v[204:207], a[136:139], a[104:107], v[204:207]
ds_read_b128 a[56:59], v2 offset:14336
v_mfma_f32_16x16x32_bf16 v[204:207], a[140:143], a[108:111], v[204:207]
v_mfma_f32_16x16x32_bf16 v[212:215], a[136:139], a[112:115], v[212:215]
v_mfma_f32_16x16x32_bf16 v[212:215], a[140:143], a[116:119], v[212:215]
v_mfma_f32_16x16x32_bf16 v[220:223], a[136:139], a[120:123], v[220:223]
ds_read_b128 a[60:63], v3 offset:14336
v_mfma_f32_16x16x32_bf16 v[220:223], a[140:143], a[124:127], v[220:223]
s_waitcnt lgkmcnt(3)
v_mfma_f32_16x16x32_bf16 a[192:195], a[128:131], a[64:67], a[192:195]
ds_read_b64_tr_b16 a[136:137], v11 offset:32768
v_mfma_f32_16x16x32_bf16 a[192:195], a[132:135], a[68:71], a[192:195]
v_mfma_f32_16x16x32_bf16 a[200:203], a[128:131], a[72:75], a[200:203]
ds_read_b64_tr_b16 a[138:139], v11 offset:34816
v_mfma_f32_16x16x32_bf16 a[200:203], a[132:135], a[76:79], a[200:203]
v_mfma_f32_16x16x32_bf16 a[208:211], a[128:131], a[80:83], a[208:211]
ds_read_b64_tr_b16 a[140:141], v11 offset:49152
v_mfma_f32_16x16x32_bf16 a[208:211], a[132:135], a[84:87], a[208:211]
v_mfma_f32_16x16x32_bf16 a[216:219], a[128:131], a[88:91], a[216:219]
ds_read_b64_tr_b16 a[142:143], v11 offset:51200
v_mfma_f32_16x16x32_bf16 a[216:219], a[132:135], a[92:95], a[216:219]
v_mfma_f32_16x16x32_bf16 a[224:227], a[128:131], a[96:99], a[224:227]
v_mfma_f32_16x16x32_bf16 a[224:227], a[132:135], a[100:103], a[224:227]
v_mfma_f32_16x16x32_bf16 a[232:235], a[128:131], a[104:107], a[232:235]
v_mfma_f32_16x16x32_bf16 a[232:235], a[132:135], a[108:111], a[232:235]
v_mfma_f32_16x16x32_bf16 a[240:243], a[128:131], a[112:115], a[240:243]
v_mfma_f32_16x16x32_bf16 a[240:243], a[132:135], a[116:119], a[240:243]
v_mfma_f32_16x16x32_bf16 a[248:251], a[128:131], a[120:123], a[248:251]
s_waitcnt vmcnt(2) lgkmcnt(0)
v_mfma_f32_16x16x32_bf16 a[248:251], a[132:135], a[124:127], a[248:251]
s_barrier
v_mfma_f32_16x16x32_bf16 a[196:199], a[136:139], a[64:67], a[196:199]
s_add_u32 m0, s29, 98304
ds_read_b64_tr_b16 a[128:129], v4 offset:0
v_mfma_f32_16x16x32_bf16 a[196:199], a[140:143], a[68:71], a[196:199]
buffer_load_dwordx4 v16, s[12:15], s26 offen offset:0 lds
v_mfma_f32_16x16x32_bf16 a[204:207], a[136:139], a[72:75], a[204:207]
ds_read_b64_tr_b16 a[130:131], v4 offset:2048
v_mfma_f32_16x16x32_bf16 a[204:207], a[140:143], a[76:79], a[204:207]
v_mfma_f32_16x16x32_bf16 a[212:215], a[136:139], a[80:83], a[212:215]
ds_read_b64_tr_b16 a[132:133], v4 offset:16384
v_mfma_f32_16x16x32_bf16 a[212:215], a[140:143], a[84:87], a[212:215]
buffer_load_dwordx4 v17, s[12:15], s26 offen offset:1024 lds
v_mfma_f32_16x16x32_bf16 a[220:223], a[136:139], a[88:91], a[220:223]
ds_read_b64_tr_b16 a[134:135], v4 offset:18432
v_mfma_f32_16x16x32_bf16 a[220:223], a[140:143], a[92:95], a[220:223]
v_mfma_f32_16x16x32_bf16 a[228:231], a[136:139], a[96:99], a[228:231]
v_mfma_f32_16x16x32_bf16 a[228:231], a[140:143], a[100:103], a[228:231]
buffer_load_dwordx4 v18, s[12:15], s26 offen offset:2048 lds
v_mfma_f32_16x16x32_bf16 a[236:239], a[136:139], a[104:107], a[236:239]
v_mfma_f32_16x16x32_bf16 a[236:239], a[140:143], a[108:111], a[236:239]
v_mfma_f32_16x16x32_bf16 a[244:247], a[136:139], a[112:115], a[244:247]
v_mfma_f32_16x16x32_bf16 a[244:247], a[140:143], a[116:119], a[244:247]
buffer_load_dwordx4 v19, s[12:15], s26 offen offset:3072 lds
v_mfma_f32_16x16x32_bf16 a[252:255], a[136:139], a[120:123], a[252:255]
s_add_u32 s26, s26, 524288
v_mfma_f32_16x16x32_bf16 a[252:255], a[140:143], a[124:127], a[252:255]
s_waitcnt lgkmcnt(0)
buffer_store_dword v27, v26, s[4:7], s82 offen sc1
v_mfma_f32_16x16x32_bf16 v[32:35], a[128:131], a[0:3], v[32:35]
s_add_u32 m0, s29, 114688
ds_read_b64_tr_b16 a[136:137], v5 offset:0
v_mfma_f32_16x16x32_bf16 v[32:35], a[132:135], a[4:7], v[32:35]
buffer_load_dwordx4 v16, s[12:15], s27 offen offset:0 lds
v_mfma_f32_16x16x32_bf16 v[40:43], a[128:131], a[8:11], v[40:43]
ds_read_b64_tr_b16 a[138:139], v5 offset:2048
v_mfma_f32_16x16x32_bf16 v[40:43], a[132:135], a[12:15], v[40:43]
v_mfma_f32_16x16x32_bf16 v[48:51], a[128:131], a[16:19], v[48:51]
ds_read_b64_tr_b16 a[140:141], v5 offset:16384
v_mfma_f32_16x16x32_bf16 v[48:51], a[132:135], a[20:23], v[48:51]
buffer_load_dwordx4 v17, s[12:15], s27 offen offset:1024 lds
v_mfma_f32_16x16x32_bf16 v[56:59], a[128:131], a[24:27], v[56:59]
ds_read_b64_tr_b16 a[142:143], v5 offset:18432
v_mfma_f32_16x16x32_bf16 v[56:59], a[132:135], a[28:31], v[56:59]
v_mfma_f32_16x16x32_bf16 v[64:67], a[128:131], a[32:35], v[64:67]
ds_read_b128 a[64:67], v2 offset:32768
v_mfma_f32_16x16x32_bf16 v[64:67], a[132:135], a[36:39], v[64:67]
buffer_load_dwordx4 v18, s[12:15], s27 offen offset:2048 lds
v_mfma_f32_16x16x32_bf16 v[72:75], a[128:131], a[40:43], v[72:75]
ds_read_b128 a[68:71], v3 offset:32768
v_mfma_f32_16x16x32_bf16 v[72:75], a[132:135], a[44:47], v[72:75]
v_mfma_f32_16x16x32_bf16 v[80:83], a[128:131], a[48:51], v[80:83]
v_mfma_f32_16x16x32_bf16 v[80:83], a[132:135], a[52:55], v[80:83]
buffer_load_dwordx4 v19, s[12:15], s27 offen offset:3072 lds
v_mfma_f32_16x16x32_bf16 v[88:91], a[128:131], a[56:59], v[88:91]
s_add_u32 s27, s27, 524288
ds_read_b128 a[72:75], v2 offset:34816
v_mfma_f32_16x16x32_bf16 v[88:91], a[132:135], a[60:63], v[88:91]
s_waitcnt lgkmcnt(3)
v_mfma_f32_16x16x32_bf16 v[36:39], a[136:139], a[0:3], v[36:39]
s_add_u32 m0, s28, 0
ds_read_b64_tr_b16 a[128:129], v6 offset:0
v_mfma_f32_16x16x32_bf16 v[36:39], a[140:143], a[4:7], v[36:39]
buffer_load_dwordx4 v12, s[8:11], s24 offen offset:0 lds
v_mfma_f32_16x16x32_bf16 v[44:47], a[136:139], a[8:11], v[44:47]
ds_read_b64_tr_b16 a[130:131], v6 offset:2048
v_mfma_f32_16x16x32_bf16 v[44:47], a[140:143], a[12:15], v[44:47]
v_mfma_f32_16x16x32_bf16 v[52:55], a[136:139], a[16:19], v[52:55]
ds_read_b64_tr_b16 a[132:133], v6 offset:16384
v_mfma_f32_16x16x32_bf16 v[52:55], a[140:143], a[20:23], v[52:55]
buffer_load_dwordx4 v13, s[8:11], s24 offen offset:1024 lds
v_mfma_f32_16x16x32_bf16 v[60:63], a[136:139], a[24:27], v[60:63]
ds_read_b64_tr_b16 a[134:135], v6 offset:18432
v_mfma_f32_16x16x32_bf16 v[60:63], a[140:143], a[28:31], v[60:63]
PAD_1:
s_cbranch_execz PAD_5
v_mfma_f32_16x16x32_bf16 v[68:71], a[136:139], a[32:35], v[68:71]
ds_read_b128 a[76:79], v3 offset:34816
v_mfma_f32_16x16x32_bf16 v[68:71], a[140:143], a[36:39], v[68:71]
buffer_load_dwordx4 v14, s[8:11], s24 offen offset:2048 lds
v_mfma_f32_16x16x32_bf16 v[76:79], a[136:139], a[40:43], v[76:79]
v_mfma_f32_16x16x32_bf16 v[76:79], a[140:143], a[44:47], v[76:79]
v_mfma_f32_16x16x32_bf16 v[84:87], a[136:139], a[48:51], v[84:87]
ds_read_b128 a[80:83], v2 offset:36864
v_mfma_f32_16x16x32_bf16 v[84:87], a[140:143], a[52:55], v[84:87]
buffer_load_dwordx4 v15, s[8:11], s24 offen offset:3072 lds
v_mfma_f32_16x16x32_bf16 v[92:95], a[136:139], a[56:59], v[92:95]
s_add_u32 s24, s24, 128
ds_read_b128 a[84:87], v3 offset:36864
v_mfma_f32_16x16x32_bf16 v[92:95], a[140:143], a[60:63], v[92:95]
s_waitcnt lgkmcnt(3)
v_mfma_f32_16x16x32_bf16 v[96:99], a[128:131], a[0:3], v[96:99]
s_add_u32 m0, s28, 4096
ds_read_b64_tr_b16 a[136:137], v7 offset:0
v_mfma_f32_16x16x32_bf16 v[96:99], a[132:135], a[4:7], v[96:99]
buffer_load_dwordx4 v12, s[8:11], s25 offen offset:0 lds
v_mfma_f32_16x16x32_bf16 v[104:107], a[128:131], a[8:11], v[104:107]
ds_read_b64_tr_b16 a[138:139], v7 offset:2048
v_mfma_f32_16x16x32_bf16 v[104:107], a[132:135], a[12:15], v[104:107]
v_mfma_f32_16x16x32_bf16 v[112:115], a[128:131], a[16:19], v[112:115]
ds_read_b64_tr_b16 a[140:141], v7 offset:16384
v_mfma_f32_16x16x32_bf16 v[112:115], a[132:135], a[20:23], v[112:115]
buffer_load_dwordx4 v13, s[8:11], s25 offen offset:1024 lds
v_mfma_f32_16x16x32_bf16 v[120:123], a[128:131], a[24:27], v[120:123]
ds_read_b64_tr_b16 a[142:143], v7 offset:18432
v_mfma_f32_16x16x32_bf16 v[120:123], a[132:135], a[28:31], v[120:123]
v_mfma_f32_16x16x32_bf16 v[128:131], a[128:131], a[32:35], v[128:131]
v_mfma_f32_16x16x32_bf16 v[128:131], a[132:135], a[36:39], v[128:131]
buffer_load_dwordx4 v14, s[8:11], s25 offen offset:2048 lds
v_mfma_f32_16x16x32_bf16 v[136:139], a[128:131], a[40:43], v[136:139]
ds_read_b128 a[88:91], v2 offset:38912
v_mfma_f32_16x16x32_bf16 v[136:139], a[132:135], a[44:47], v[136:139]
v_mfma_f32_16x16x32_bf16 v[144:147], a[128:131], a[48:51], v[144:147]
ds_read_b128 a[92:95], v3 offset:38912
v_mfma_f32_16x16x32_bf16 v[144:147], a[132:135], a[52:55], v[144:147]
buffer_load_dwordx4 v15, s[8:11], s25 offen offset:3072 lds
v_mfma_f32_16x16x32_bf16 v[152:155], a[128:131], a[56:59], v[152:155]
s_add_u32 s25, s25, 128
v_mfma_f32_16x16x32_bf16 v[152:155], a[132:135], a[60:63], v[152:155]
s_waitcnt lgkmcnt(2)
v_mfma_f32_16x16x32_bf16 v[100:103], a[136:139], a[0:3], v[100:103]
ds_read_b64_tr_b16 a[128:129], v8 offset:0
v_mfma_f32_16x16x32_bf16 v[100:103], a[140:143], a[4:7], v[100:103]
buffer_load_dword v21, v20, s[16:19], s43 offen
v_mfma_f32_16x16x32_bf16 v[108:111], a[136:139], a[8:11], v[108:111]
s_add_u32 s43, s43, s47
ds_read_b64_tr_b16 a[130:131], v8 offset:2048
v_mfma_f32_16x16x32_bf16 v[108:111], a[140:143], a[12:15], v[108:111]
s_cmp_ge_u32 s43, s51
v_mfma_f32_16x16x32_bf16 v[116:119], a[136:139], a[16:19], v[116:119]
s_cselect_b32 s43, 0, s43
ds_read_b64_tr_b16 a[132:133], v8 offset:16384
v_mfma_f32_16x16x32_bf16 v[116:119], a[140:143], a[20:23], v[116:119]
s_cselect_b32 s51, s42, s51
v_mfma_f32_16x16x32_bf16 v[124:127], a[136:139], a[24:27], v[124:127]
s_cselect_b64 s[16:17], s[40:41], s[16:17]
ds_read_b64_tr_b16 a[134:135], v8 offset:18432
v_mfma_f32_16x16x32_bf16 v[124:127], a[140:143], a[28:31], v[124:127]
s_cselect_b32 s18, s42, s18
v_mfma_f32_16x16x32_bf16 v[132:135], a[136:139], a[32:35], v[132:135]
s_cselect_b64 s[40:41], s[44:45], s[40:41]
ds_read_b128 a[96:99], v2 offset:40960
v_mfma_f32_16x16x32_bf16 v[132:135], a[140:143], a[36:39], v[132:135]
s_cselect_b32 s42, s46, s42
v_mfma_f32_16x16x32_bf16 v[140:143], a[136:139], a[40:43], v[140:143]
s_cselect_b32 s46, 0, s46
v_mfma_f32_16x16x32_bf16 v[140:143], a[140:143], a[44:47], v[140:143]
s_cmp_eq_u32 s30, s55
v_mfma_f32_16x16x32_bf16 v[148:151], a[136:139], a[48:51], v[148:151]
s_cselect_b32 s22, 0, 3221225472
ds_read_b128 a[100:103], v3 offset:40960
v_mfma_f32_16x16x32_bf16 v[148:151], a[140:143], a[52:55], v[148:151]
s_sub_u32 s30, s30, 1
buffer_atomic_add v27, v26, s[60:63], s22 offen sc1
v_mfma_f32_16x16x32_bf16 v[156:159], a[136:139], a[56:59], v[156:159]
ds_read_b128 a[104:107], v2 offset:43008
v_mfma_f32_16x16x32_bf16 v[156:159], a[140:143], a[60:63], v[156:159]
s_waitcnt lgkmcnt(3)
v_mfma_f32_16x16x32_bf16 v[160:163], a[128:131], a[0:3], v[160:163]
ds_read_b64_tr_b16 a[136:137], v9 offset:0
v_mfma_f32_16x16x32_bf16 v[160:163], a[132:135], a[4:7], v[160:163]
v_mfma_f32_16x16x32_bf16 v[168:171], a[128:131], a[8:11], v[168:171]
ds_read_b64_tr_b16 a[138:139], v9 offset:2048
v_mfma_f32_16x16x32_bf16 v[168:171], a[132:135], a[12:15], v[168:171]
v_mfma_f32_16x16x32_bf16 v[176:179], a[128:131], a[16:19], v[176:179]
ds_read_b64_tr_b16 a[140:141], v9 offset:16384
v_mfma_f32_16x16x32_bf16 v[176:179], a[132:135], a[20:23], v[176:179]
v_mfma_f32_16x16x32_bf16 v[184:187], a[128:131], a[24:27], v[184:187]
ds_read_b64_tr_b16 a[142:143], v9 offset:18432
v_mfma_f32_16x16x32_bf16 v[184:187], a[132:135], a[28:31], v[184:187]
v_mfma_f32_16x16x32_bf16 v[192:195], a[128:131], a[32:35], v[192:195]
v_mfma_f32_16x16x32_bf16 v[192:195], a[132:135], a[36:39], v[192:195]
v_mfma_f32_16x16x32_bf16 v[200:203], a[128:131], a[40:43], v[200:203]
ds_read_b128 a[108:111], v3 offset:43008
v_mfma_f32_16x16x32_bf16 v[200:203], a[132:135], a[44:47], v[200:203]
v_mfma_f32_16x16x32_bf16 v[208:211], a[128:131], a[48:51], v[208:211]
ds_read_b128 a[112:115], v2 offset:45056
v_mfma_f32_16x16x32_bf16 v[208:211], a[132:135], a[52:55], v[208:211]
v_mfma_f32_16x16x32_bf16 v[216:219], a[128:131], a[56:59], v[216:219]
v_mfma_f32_16x16x32_bf16 v[216:219], a[132:135], a[60:63], v[216:219]
s_waitcnt lgkmcnt(2)
v_mfma_f32_16x16x32_bf16 v[164:167], a[136:139], a[0:3], v[164:167]
ds_read_b64_tr_b16 a[128:129], v10 offset:0
v_mfma_f32_16x16x32_bf16 v[164:167], a[140:143], a[4:7], v[164:167]
v_mfma_f32_16x16x32_bf16 v[172:175], a[136:139], a[8:11], v[172:175]
ds_read_b64_tr_b16 a[130:131], v10 offset:2048
v_mfma_f32_16x16x32_bf16 v[172:175], a[140:143], a[12:15], v[172:175]
v_mfma_f32_16x16x32_bf16 v[180:183], a[136:139], a[16:19], v[180:183]
ds_read_b64_tr_b16 a[132:133], v10 offset:16384
v_mfma_f32_16x16x32_bf16 v[180:183], a[140:143], a[20:23], v[180:183]
v_mfma_f32_16x16x32_bf16 v[188:191], a[136:139], a[24:27], v[188:191]
ds_read_b64_tr_b16 a[134:135], v10 offset:18432
v_mfma_f32_16x16x32_bf16 v[188:191], a[140:143], a[28:31], v[188:191]
v_mfma_f32_16x16x32_bf16 v[196:199], a[136:139], a[32:35], v[196:199]
ds_read_b128 a[116:119], v3 offset:45056
v_mfma_f32_16x16x32_bf16 v[196:199], a[140:143], a[36:39], v[196:199]
v_mfma_f32_16x16x32_bf16 v[204:207], a[136:139], a[40:43], v[204:207]
ds_read_b128 a[120:123], v2 offset:47104
v_mfma_f32_16x16x32_bf16 v[204:207], a[140:143], a[44:47], v[204:207]
v_mfma_f32_16x16x32_bf16 v[212:215], a[136:139], a[48:51], v[212:215]
v_mfma_f32_16x16x32_bf16 v[212:215], a[140:143], a[52:55], v[212:215]
v_mfma_f32_16x16x32_bf16 v[220:223], a[136:139], a[56:59], v[220:223]
ds_read_b128 a[124:127], v3 offset:47104
v_mfma_f32_16x16x32_bf16 v[220:223], a[140:143], a[60:63], v[220:223]
s_waitcnt lgkmcnt(3)
v_mfma_f32_16x16x32_bf16 a[192:195], a[128:131], a[0:3], a[192:195]
ds_read_b64_tr_b16 a[136:137], v11 offset:0
v_mfma_f32_16x16x32_bf16 a[192:195], a[132:135], a[4:7], a[192:195]
v_mfma_f32_16x16x32_bf16 a[200:203], a[128:131], a[8:11], a[200:203]
ds_read_b64_tr_b16 a[138:139], v11 offset:2048
v_mfma_f32_16x16x32_bf16 a[200:203], a[132:135], a[12:15], a[200:203]
v_mfma_f32_16x16x32_bf16 a[208:211], a[128:131], a[16:19], a[208:211]
ds_read_b64_tr_b16 a[140:141], v11 offset:16384
v_mfma_f32_16x16x32_bf16 a[208:211], a[132:135], a[20:23], a[208:211]
v_mfma_f32_16x16x32_bf16 a[216:219], a[128:131], a[24:27], a[216:219]
ds_read_b64_tr_b16 a[142:143], v11 offset:18432
v_mfma_f32_16x16x32_bf16 a[216:219], a[132:135], a[28:31], a[216:219]
v_mfma_f32_16x16x32_bf16 a[224:227], a[128:131], a[32:35], a[224:227]
v_mfma_f32_16x16x32_bf16 a[224:227], a[132:135], a[36:39], a[224:227]
v_mfma_f32_16x16x32_bf16 a[232:235], a[128:131], a[40:43], a[232:235]
v_mfma_f32_16x16x32_bf16 a[232:235], a[132:135], a[44:47], a[232:235]
v_mfma_f32_16x16x32_bf16 a[240:243], a[128:131], a[48:51], a[240:243]
v_mfma_f32_16x16x32_bf16 a[240:243], a[132:135], a[52:55], a[240:243]
v_mfma_f32_16x16x32_bf16 a[248:251], a[128:131], a[56:59], a[248:251]
s_waitcnt vmcnt(2) lgkmcnt(0)
v_mfma_f32_16x16x32_bf16 a[248:251], a[132:135], a[60:63], a[248:251]
s_barrier
v_mfma_f32_16x16x32_bf16 a[196:199], a[136:139], a[0:3], a[196:199]
s_add_u32 m0, s29, 65536
ds_read_b64_tr_b16 a[128:129], v4 offset:32768
v_mfma_f32_16x16x32_bf16 a[196:199], a[140:143], a[4:7], a[196:199]
buffer_load_dwordx4 v16, s[12:15], s26 offen offset:0 lds
v_mfma_f32_16x16x32_bf16 a[204:207], a[136:139], a[8:11], a[204:207]
ds_read_b64_tr_b16 a[130:131], v4 offset:34816
v_mfma_f32_16x16x32_bf16 a[204:207], a[140:143], a[12:15], a[204:207]
v_mfma_f32_16x16x32_bf16 a[212:215], a[136:139], a[16:19], a[212:215]
ds_read_b64_tr_b16 a[132:133], v4 offset:49152
v_mfma_f32_16x16x32_bf16 a[212:215], a[140:143], a[20:23], a[212:215]
buffer_load_dwordx4 v17, s[12:15], s26 offen offset:1024 lds
v_mfma_f32_16x16x32_bf16 a[220:223], a[136:139], a[24:27], a[220:223]
ds_read_b64_tr_b16 a[134:135], v4 offset:51200
v_mfma_f32_16x16x32_bf16 a[220:223], a[140:143], a[28:31], a[220:223]
v_mfma_f32_16x16x32_bf16 a[228:231], a[136:139], a[32:35], a[228:231]
v_mfma_f32_16x16x32_bf16 a[228:231], a[140:143], a[36:39], a[228:231]
buffer_load_dwordx4 v18, s[12:15], s26 offen offset:2048 lds
v_mfma_f32_16x16x32_bf16 a[236:239], a[136:139], a[40:43], a[236:239]
v_mfma_f32_16x16x32_bf16 a[236:239], a[140:143], a[44:47], a[236:239]
v_mfma_f32_16x16x32_bf16 a[244:247], a[136:139], a[48:51], a[244:247]
v_mfma_f32_16x16x32_bf16 a[244:247], a[140:143], a[52:55], a[244:247]
s_waitcnt lgkmcnt(0)
buffer_load_dwordx4 v19, s[12:15], s26 offen offset:3072 lds
v_mfma_f32_16x16x32_bf16 a[252:255], a[136:139], a[56:59], a[252:255]
s_add_u32 s26, s26, 524288
s_bitcmp1_b32 s30, 1
v_mfma_f32_16x16x32_bf16 a[252:255], a[140:143], a[60:63], a[252:255]
s_cbranch_scc1 Lg_1
s_cmp_eq_u32 s30, 0
s_cbranch_scc1 Lg_1t
v_mfma_f32_16x16x32_bf16 v[32:35], a[128:131], a[64:67], v[32:35]
s_add_u32 m0, s29, 81920
ds_read_b64_tr_b16 a[136:137], v5 offset:32768
v_mfma_f32_16x16x32_bf16 v[32:35], a[132:135], a[68:71], v[32:35]
buffer_load_dwordx4 v16, s[12:15], s27 offen offset:0 lds
v_mfma_f32_16x16x32_bf16 v[40:43], a[128:131], a[72:75], v[40:43]
s_lshl_b32 s22, s38, 3
ds_read_b64_tr_b16 a[138:139], v5 offset:34816
v_mfma_f32_16x16x32_bf16 v[40:43], a[132:135], a[76:79], v[40:43]
s_lshl_b32 s23, s39, 5
v_and_b32 v252, 31, v0
v_lshrrev_b32 v253, 5, v0
v_mfma_f32_16x16x32_bf16 v[48:51], a[128:131], a[80:83], v[48:51]
ds_read_b64_tr_b16 a[140:141], v5 offset:49152
v_add_u32 v253, s22, v253
v_mfma_f32_16x16x32_bf16 v[48:51], a[132:135], a[84:87], v[48:51]
buffer_load_dwordx4 v17, s[12:15], s27 offen offset:1024 lds
v_mfma_f32_16x16x32_bf16 v[56:59], a[128:131], a[88:91], v[56:59]
ds_read_b64_tr_b16 a[142:143], v5 offset:51200
v_add_u32 v252, s23, v252
v_mfma_f32_16x16x32_bf16 v[56:59], a[132:135], a[92:95], v[56:59]
v_mul_u32_u24 v254, 7168, v253
v_lshl_add_u32 v254, v252, 2, v254
v_mfma_f32_16x16x32_bf16 v[64:67], a[128:131], a[96:99], v[64:67]
ds_read_b128 a[0:3], v2 offset:0
v_lshlrev_b32 v252, 4, v252
v_mfma_f32_16x16x32_bf16 v[64:67], a[132:135], a[100:103], v[64:67]
buffer_load_dwordx4 v18, s[12:15], s27 offen offset:2048 lds
v_mfma_f32_16x16x32_bf16 v[72:75], a[128:131], a[104:107], v[72:75]
ds_read_b128 a[4:7], v3 offset:0
v_add_u32 v255, 3584, v254
v_mfma_f32_16x16x32_bf16 v[72:75], a[132:135], a[108:111], v[72:75]
v_subrev_u32 v22, 3584, v254
v_subrev_u32 v23, 2688, v254
v_mfma_f32_16x16x32_bf16 v[80:83], a[128:131], a[112:115], v[80:83]
v_subrev_u32 v24, 1792, v254
v_subrev_u32 v25, 896, v254
v_mfma_f32_16x16x32_bf16 v[80:83], a[132:135], a[116:119], v[80:83]
buffer_load_dwordx4 v19, s[12:15], s27 offen offset:3072 lds
v_mfma_f32_16x16x32_bf16 v[88:91], a[128:131], a[120:123], v[88:91]
s_add_u32 s27, s27, 524288
ds_read_b128 a[8:11], v2 offset:2048
v_mfma_f32_16x16x32_bf16 v[88:91], a[132:135], a[124:127], v[88:91]
s_waitcnt lgkmcnt(3)
v_mfma_f32_16x16x32_bf16 v[36:39], a[136:139], a[64:67], v[36:39]
s_add_u32 m0, s28, 32768
ds_read_b64_tr_b16 a[128:129], v6 offset:32768
v_mfma_f32_16x16x32_bf16 v[36:39], a[140:143], a[68:71], v[36:39]
buffer_load_dwordx4 v12, s[8:11], s24 offen offset:0 lds
v_mfma_f32_16x16x32_bf16 v[44:47], a[136:139], a[72:75], v[44:47]
ds_read_b64_tr_b16 a[130:131], v6 offset:34816
v_mfma_f32_16x16x32_bf16 v[44:47], a[140:143], a[76:79], v[44:47]
v_mfma_f32_16x16x32_bf16 v[52:55], a[136:139], a[80:83], v[52:55]
ds_read_b64_tr_b16 a[132:133], v6 offset:49152
v_mfma_f32_16x16x32_bf16 v[52:55], a[140:143], a[84:87], v[52:55]
buffer_load_dwordx4 v13, s[8:11], s24 offen offset:1024 lds
v_mfma_f32_16x16x32_bf16 v[60:63], a[136:139], a[88:91], v[60:63]
ds_read_b64_tr_b16 a[134:135], v6 offset:51200
v_mfma_f32_16x16x32_bf16 v[60:63], a[140:143], a[92:95], v[60:63]
v_mfma_f32_16x16x32_bf16 v[68:71], a[136:139], a[96:99], v[68:71]
ds_read_b128 a[12:15], v3 offset:2048
v_mfma_f32_16x16x32_bf16 v[68:71], a[140:143], a[100:103], v[68:71]
buffer_load_dwordx4 v14, s[8:11], s24 offen offset:2048 lds
v_mfma_f32_16x16x32_bf16 v[76:79], a[136:139], a[104:107], v[76:79]
v_mfma_f32_16x16x32_bf16 v[76:79], a[140:143], a[108:111], v[76:79]
v_mfma_f32_16x16x32_bf16 v[84:87], a[136:139], a[112:115], v[84:87]
ds_read_b128 a[16:19], v2 offset:4096
v_mfma_f32_16x16x32_bf16 v[84:87], a[140:143], a[116:119], v[84:87]
buffer_load_dwordx4 v15, s[8:11], s24 offen offset:3072 lds
v_mfma_f32_16x16x32_bf16 v[92:95], a[136:139], a[120:123], v[92:95]
s_add_u32 s24, s24, 128
ds_read_b128 a[20:23], v3 offset:4096
v_mfma_f32_16x16x32_bf16 v[92:95], a[140:143], a[124:127], v[92:95]
s_waitcnt lgkmcnt(3)
v_mfma_f32_16x16x32_bf16 v[96:99], a[128:131], a[64:67], v[96:99]
s_add_u32 m0, s28, 36864
ds_read_b64_tr_b16 a[136:137], v7 offset:32768
v_mfma_f32_16x16x32_bf16 v[96:99], a[132:135], a[68:71], v[96:99]
buffer_load_dwordx4 v12, s[8:11], s25 offen offset:0 lds
v_mfma_f32_16x16x32_bf16 v[104:107], a[128:131], a[72:75], v[104:107]
ds_read_b64_tr_b16 a[138:139], v7 offset:34816
v_mfma_f32_16x16x32_bf16 v[104:107], a[132:135], a[76:79], v[104:107]
v_mfma_f32_16x16x32_bf16 v[112:115], a[128:131], a[80:83], v[112:115]
ds_read_b64_tr_b16 a[140:141], v7 offset:49152
v_mfma_f32_16x16x32_bf16 v[112:115], a[132:135], a[84:87], v[112:115]
buffer_load_dwordx4 v13, s[8:11], s25 offen offset:1024 lds
v_mfma_f32_16x16x32_bf16 v[120:123], a[128:131], a[88:91], v[120:123]
ds_read_b64_tr_b16 a[142:143], v7 offset:51200
v_mfma_f32_16x16x32_bf16 v[120:123], a[132:135], a[92:95], v[120:123]
v_mfma_f32_16x16x32_bf16 v[128:131], a[128:131], a[96:99], v[128:131]
v_mfma_f32_16x16x32_bf16 v[128:131], a[132:135], a[100:103], v[128:131]
buffer_load_dwordx4 v14, s[8:11], s25 offen offset:2048 lds
v_mfma_f32_16x16x32_bf16 v[136:139], a[128:131], a[104:107], v[136:139]
ds_read_b128 a[24:27], v2 offset:6144
v_mfma_f32_16x16x32_bf16 v[136:139], a[132:135], a[108:111], v[136:139]
v_mfma_f32_16x16x32_bf16 v[144:147], a[128:131], a[112:115], v[144:147]
ds_read_b128 a[28:31], v3 offset:6144
v_mfma_f32_16x16x32_bf16 v[144:147], a[132:135], a[116:119], v[144:147]
buffer_load_dwordx4 v15, s[8:11], s25 offen offset:3072 lds
v_mfma_f32_16x16x32_bf16 v[152:155], a[128:131], a[120:123], v[152:155]
s_add_u32 s25, s25, 128
v_mfma_f32_16x16x32_bf16 v[152:155], a[132:135], a[124:127], v[152:155]
s_waitcnt lgkmcnt(2)
v_mfma_f32_16x16x32_bf16 v[100:103], a[136:139], a[64:67], v[100:103]
s_mov_b64 s[56:57], s[70:71]
s_mov_b32 s58, 3584
s_mov_b32 s59, 0x20000
ds_read_b64_tr_b16 a[128:129], v8 offset:32768
v_mfma_f32_16x16x32_bf16 v[100:103], a[140:143], a[68:71], v[100:103]
buffer_load_dwordx4 v[248:251], v252, s[56:59], 0 offen
v_mfma_f32_16x16x32_bf16 v[108:111], a[136:139], a[72:75], v[108:111]
s_mov_b64 s[56:57], s[66:67]
s_mov_b32 s58, 1835008
ds_read_b64_tr_b16 a[130:131], v8 offset:34816
v_mfma_f32_16x16x32_bf16 v[108:111], a[140:143], a[76:79], v[108:111]
buffer_load_dword v224, v22, s[56:59], 0 offen nt
v_mfma_f32_16x16x32_bf16 v[116:119], a[136:139], a[80:83], v[116:119]
ds_read_b64_tr_b16 a[132:133], v8 offset:49152
v_mfma_f32_16x16x32_bf16 v[116:119], a[140:143], a[84:87], v[116:119]
buffer_load_dword v225, v23, s[56:59], 0 offen nt
v_mfma_f32_16x16x32_bf16 v[124:127], a[136:139], a[88:91], v[124:127]
ds_read_b64_tr_b16 a[134:135], v8 offset:51200
v_mfma_f32_16x16x32_bf16 v[124:127], a[140:143], a[92:95], v[124:127]
buffer_load_dword v226, v24, s[56:59], 0 offen nt
v_mfma_f32_16x16x32_bf16 v[132:135], a[136:139], a[96:99], v[132:135]
ds_read_b128 a[32:35], v2 offset:8192
v_mfma_f32_16x16x32_bf16 v[132:135], a[140:143], a[100:103], v[132:135]
buffer_load_dword v227, v25, s[56:59], 0 offen nt
v_mfma_f32_16x16x32_bf16 v[140:143], a[136:139], a[104:107], v[140:143]
buffer_load_dword v228, v254, s[56:59], 0 offen offset:0 nt
v_mfma_f32_16x16x32_bf16 v[140:143], a[140:143], a[108:111], v[140:143]
buffer_load_dword v229, v254, s[56:59], 0 offen offset:896 nt
v_mfma_f32_16x16x32_bf16 v[148:151], a[136:139], a[112:115], v[148:151]
ds_read_b128 a[36:39], v3 offset:8192
v_mfma_f32_16x16x32_bf16 v[148:151], a[140:143], a[116:119], v[148:151]
buffer_load_dword v230, v254, s[56:59], 0 offen offset:1792 nt
v_mfma_f32_16x16x32_bf16 v[156:159], a[136:139], a[120:123], v[156:159]
ds_read_b128 a[40:43], v2 offset:10240
v_mfma_f32_16x16x32_bf16 v[156:159], a[140:143], a[124:127], v[156:159]
s_waitcnt lgkmcnt(3)
buffer_load_dword v231, v254, s[56:59], 0 offen offset:2688 nt
v_mfma_f32_16x16x32_bf16 v[160:163], a[128:131], a[64:67], v[160:163]
ds_read_b64_tr_b16 a[136:137], v9 offset:32768
v_mfma_f32_16x16x32_bf16 v[160:163], a[132:135], a[68:71], v[160:163]
buffer_load_dword v232, v255, s[56:59], 0 offen offset:0 nt
v_mfma_f32_16x16x32_bf16 v[168:171], a[128:131], a[72:75], v[168:171]
ds_read_b64_tr_b16 a[138:139], v9 offset:34816
v_mfma_f32_16x16x32_bf16 v[168:171], a[132:135], a[76:79], v[168:171]
buffer_load_dword v233, v255, s[56:59], 0 offen offset:896 nt
v_mfma_f32_16x16x32_bf16 v[176:179], a[128:131], a[80:83], v[176:179]
ds_read_b64_tr_b16 a[140:141], v9 offset:49152
v_mfma_f32_16x16x32_bf16 v[176:179], a[132:135], a[84:87], v[176:179]
buffer_load_dword v234, v255, s[56:59], 0 offen offset:1792 nt
v_mfma_f32_16x16x32_bf16 v[184:187], a[128:131], a[88:91], v[184:187]
ds_read_b64_tr_b16 a[142:143], v9 offset:51200
v_mfma_f32_16x16x32_bf16 v[184:187], a[132:135], a[92:95], v[184:187]
buffer_load_dword v235, v255, s[56:59], 0 offen offset:2688 nt
v_mfma_f32_16x16x32_bf16 v[192:195], a[128:131], a[96:99], v[192:195]
s_mov_b64 s[56:57], s[68:69]
buffer_load_dword v236, v25, s[56:59], 0 offen nt
v_mfma_f32_16x16x32_bf16 v[192:195], a[132:135], a[100:103], v[192:195]
buffer_load_dword v237, v254, s[56:59], 0 offen offset:0 nt
v_mfma_f32_16x16x32_bf16 v[200:203], a[128:131], a[104:107], v[200:203]
ds_read_b128 a[44:47], v3 offset:10240
v_mfma_f32_16x16x32_bf16 v[200:203], a[132:135], a[108:111], v[200:203]
buffer_load_dword v238, v254, s[56:59], 0 offen offset:896 nt
v_mfma_f32_16x16x32_bf16 v[208:211], a[128:131], a[112:115], v[208:211]
ds_read_b128 a[48:51], v2 offset:12288
v_mfma_f32_16x16x32_bf16 v[208:211], a[132:135], a[116:119], v[208:211]
buffer_load_dword v239, v254, s[56:59], 0 offen offset:1792 nt
v_mfma_f32_16x16x32_bf16 v[216:219], a[128:131], a[120:123], v[216:219]
buffer_load_dword v240, v254, s[56:59], 0 offen offset:2688 nt
v_mfma_f32_16x16x32_bf16 v[216:219], a[132:135], a[124:127], v[216:219]
s_waitcnt lgkmcnt(2)
buffer_load_dword v241, v255, s[56:59], 0 offen offset:0 nt
v_mfma_f32_16x16x32_bf16 v[164:167], a[136:139], a[64:67], v[164:167]
ds_read_b64_tr_b16 a[128:129], v10 offset:32768
v_mfma_f32_16x16x32_bf16 v[164:167], a[140:143], a[68:71], v[164:167]
buffer_load_dword v242, v255, s[56:59], 0 offen offset:896 nt
v_mfma_f32_16x16x32_bf16 v[172:175], a[136:139], a[72:75], v[172:175]
ds_read_b64_tr_b16 a[130:131], v10 offset:34816
v_mfma_f32_16x16x32_bf16 v[172:175], a[140:143], a[76:79], v[172:175]
buffer_load_dword v243, v255, s[56:59], 0 offen offset:1792 nt
v_mfma_f32_16x16x32_bf16 v[180:183], a[136:139], a[80:83], v[180:183]
ds_read_b64_tr_b16 a[132:133], v10 offset:49152
v_mfma_f32_16x16x32_bf16 v[180:183], a[140:143], a[84:87], v[180:183]
buffer_load_dword v244, v255, s[56:59], 0 offen offset:2688 nt
v_mfma_f32_16x16x32_bf16 v[188:191], a[136:139], a[88:91], v[188:191]
ds_read_b64_tr_b16 a[134:135], v10 offset:51200
v_mfma_f32_16x16x32_bf16 v[188:191], a[140:143], a[92:95], v[188:191]
v_mfma_f32_16x16x32_bf16 v[196:199], a[136:139], a[96:99], v[196:199]
ds_read_b128 a[52:55], v3 offset:12288
v_mfma_f32_16x16x32_bf16 v[196:199], a[140:143], a[100:103], v[196:199]
v_mfma_f32_16x16x32_bf16 v[204:207], a[136:139], a[104:107], v[204:207]
ds_read_b128 a[56:59], v2 offset:14336
v_mfma_f32_16x16x32_bf16 v[204:207], a[140:143], a[108:111], v[204:207]
v_mfma_f32_16x16x32_bf16 v[212:215], a[136:139], a[112:115], v[212:215]
v_mfma_f32_16x16x32_bf16 v[212:215], a[140:143], a[116:119], v[212:215]
v_mfma_f32_16x16x32_bf16 v[220:223], a[136:139], a[120:123], v[220:223]
ds_read_b128 a[60:63], v3 offset:14336
v_mfma_f32_16x16x32_bf16 v[220:223], a[140:143], a[124:127], v[220:223]
s_waitcnt lgkmcnt(3)
v_mfma_f32_16x16x32_bf16 a[192:195], a[128:131], a[64:67], a[192:195]
ds_read_b64_tr_b16 a[136:137], v11 offset:32768
v_mfma_f32_16x16x32_bf16 a[192:195], a[132:135], a[68:71], a[192:195]
v_mfma_f32_16x16x32_bf16 a[200:203], a[128:131], a[72:75], a[200:203]
ds_read_b64_tr_b16 a[138:139], v11 offset:34816
v_mfma_f32_16x16x32_bf16 a[200:203], a[132:135], a[76:79], a[200:203]
v_mfma_f32_16x16x32_bf16 a[208:211], a[128:131], a[80:83], a[208:211]
ds_read_b64_tr_b16 a[140:141], v11 offset:49152
v_mfma_f32_16x16x32_bf16 a[208:211], a[132:135], a[84:87], a[208:211]
v_mfma_f32_16x16x32_bf16 a[216:219], a[128:131], a[88:91], a[216:219]
ds_read_b64_tr_b16 a[142:143], v11 offset:51200
v_mfma_f32_16x16x32_bf16 a[216:219], a[132:135], a[92:95], a[216:219]
v_mfma_f32_16x16x32_bf16 a[224:227], a[128:131], a[96:99], a[224:227]
v_mfma_f32_16x16x32_bf16 a[224:227], a[132:135], a[100:103], a[224:227]
v_mfma_f32_16x16x32_bf16 a[232:235], a[128:131], a[104:107], a[232:235]
v_mfma_f32_16x16x32_bf16 a[232:235], a[132:135], a[108:111], a[232:235]
v_mfma_f32_16x16x32_bf16 a[240:243], a[128:131], a[112:115], a[240:243]
v_mfma_f32_16x16x32_bf16 a[240:243], a[132:135], a[116:119], a[240:243]
v_mfma_f32_16x16x32_bf16 a[248:251], a[128:131], a[120:123], a[248:251]
s_waitcnt vmcnt(22) lgkmcnt(0)
v_mfma_f32_16x16x32_bf16 a[248:251], a[132:135], a[124:127], a[248:251]
s_barrier
v_mfma_f32_16x16x32_bf16 a[196:199], a[136:139], a[64:67], a[196:199]
s_add_u32 m0, s29, 98304
ds_read_b64_tr_b16 a[128:129], v4 offset:0
v_mfma_f32_16x16x32_bf16 a[196:199], a[140:143], a[68:71], a[196:199]
buffer_load_dwordx4 v16, s[12:15], s26 offen offset:0 lds
v_mfma_f32_16x16x32_bf16 a[204:207], a[136:139], a[72:75], a[204:207]
ds_read_b64_tr_b16 a[130:131], v4 offset:2048
v_mfma_f32_16x16x32_bf16 a[204:207], a[140:143], a[76:79], a[204:207]
v_mfma_f32_16x16x32_bf16 a[212:215], a[136:139], a[80:83], a[212:215]
ds_read_b64_tr_b16 a[132:133], v4 offset:16384
v_mfma_f32_16x16x32_bf16 a[212:215], a[140:143], a[84:87], a[212:215]
buffer_load_dwordx4 v17, s[12:15], s26 offen offset:1024 lds
v_mfma_f32_16x16x32_bf16 a[220:223], a[136:139], a[88:91], a[220:223]
ds_read_b64_tr_b16 a[134:135], v4 offset:18432
v_mfma_f32_16x16x32_bf16 a[220:223], a[140:143], a[92:95], a[220:223]
v_mfma_f32_16x16x32_bf16 a[228:231], a[136:139], a[96:99], a[228:231]
v_mfma_f32_16x16x32_bf16 a[228:231], a[140:143], a[100:103], a[228:231]
buffer_load_dwordx4 v18, s[12:15], s26 offen offset:2048 lds
v_mfma_f32_16x16x32_bf16 a[236:239], a[136:139], a[104:107], a[236:239]
v_mfma_f32_16x16x32_bf16 a[236:239], a[140:143], a[108:111], a[236:239]
v_mfma_f32_16x16x32_bf16 a[244:247], a[136:139], a[112:115], a[244:247]
v_mfma_f32_16x16x32_bf16 a[244:247], a[140:143], a[116:119], a[244:247]
buffer_load_dwordx4 v19, s[12:15], s26 offen offset:3072 lds
v_mfma_f32_16x16x32_bf16 a[252:255], a[136:139], a[120:123], a[252:255]
s_add_u32 s26, s26, 524288
v_mfma_f32_16x16x32_bf16 a[252:255], a[140:143], a[124:127], a[252:255]
s_waitcnt lgkmcnt(0)
v_mfma_f32_16x16x32_bf16 v[32:35], a[128:131], a[0:3], v[32:35]
s_add_u32 m0, s29, 114688
ds_read_b64_tr_b16 a[136:137], v5 offset:0
v_mfma_f32_16x16x32_bf16 v[32:35], a[132:135], a[4:7], v[32:35]
buffer_load_dwordx4 v16, s[12:15], s27 offen offset:0 lds
v_mfma_f32_16x16x32_bf16 v[40:43], a[128:131], a[8:11], v[40:43]
ds_read_b64_tr_b16 a[138:139], v5 offset:2048
v_mfma_f32_16x16x32_bf16 v[40:43], a[132:135], a[12:15], v[40:43]
v_mfma_f32_16x16x32_bf16 v[48:51], a[128:131], a[16:19], v[48:51]
ds_read_b64_tr_b16 a[140:141], v5 offset:16384
v_mfma_f32_16x16x32_bf16 v[48:51], a[132:135], a[20:23], v[48:51]
buffer_load_dwordx4 v17, s[12:15], s27 offen offset:1024 lds
v_mfma_f32_16x16x32_bf16 v[56:59], a[128:131], a[24:27], v[56:59]
ds_read_b64_tr_b16 a[142:143], v5 offset:18432
v_mfma_f32_16x16x32_bf16 v[56:59], a[132:135], a[28:31], v[56:59]
v_mfma_f32_16x16x32_bf16 v[64:67], a[128:131], a[32:35], v[64:67]
ds_read_b128 a[64:67], v2 offset:32768
v_mfma_f32_16x16x32_bf16 v[64:67], a[132:135], a[36:39], v[64:67]
buffer_load_dwordx4 v18, s[12:15], s27 offen offset:2048 lds
v_mfma_f32_16x16x32_bf16 v[72:75], a[128:131], a[40:43], v[72:75]
ds_read_b128 a[68:71], v3 offset:32768
v_mfma_f32_16x16x32_bf16 v[72:75], a[132:135], a[44:47], v[72:75]
v_mfma_f32_16x16x32_bf16 v[80:83], a[128:131], a[48:51], v[80:83]
v_mfma_f32_16x16x32_bf16 v[80:83], a[132:135], a[52:55], v[80:83]
buffer_load_dwordx4 v19, s[12:15], s27 offen offset:3072 lds
v_mfma_f32_16x16x32_bf16 v[88:91], a[128:131], a[56:59], v[88:91]
s_add_u32 s27, s27, 524288
ds_read_b128 a[72:75], v2 offset:34816
v_mfma_f32_16x16x32_bf16 v[88:91], a[132:135], a[60:63], v[88:91]
s_waitcnt lgkmcnt(3)
v_mfma_f32_16x16x32_bf16 v[36:39], a[136:139], a[0:3], v[36:39]
s_add_u32 m0, s28, 0
ds_read_b64_tr_b16 a[128:129], v6 offset:0
v_mfma_f32_16x16x32_bf16 v[36:39], a[140:143], a[4:7], v[36:39]
buffer_load_dwordx4 v12, s[8:11], s24 offen offset:0 lds
v_mfma_f32_16x16x32_bf16 v[44:47], a[136:139], a[8:11], v[44:47]
ds_read_b64_tr_b16 a[130:131], v6 offset:2048
v_mfma_f32_16x16x32_bf16 v[44:47], a[140:143], a[12:15], v[44:47]
v_mfma_f32_16x16x32_bf16 v[52:55], a[136:139], a[16:19], v[52:55]
ds_read_b64_tr_b16 a[132:133], v6 offset:16384
v_mfma_f32_16x16x32_bf16 v[52:55], a[140:143], a[20:23], v[52:55]
buffer_load_dwordx4 v13, s[8:11], s24 offen offset:1024 lds
v_mfma_f32_16x16x32_bf16 v[60:63], a[136:139], a[24:27], v[60:63]
ds_read_b64_tr_b16 a[134:135], v6 offset:18432
v_mfma_f32_16x16x32_bf16 v[60:63], a[140:143], a[28:31], v[60:63]
v_mfma_f32_16x16x32_bf16 v[68:71], a[136:139], a[32:35], v[68:71]
ds_read_b128 a[76:79], v3 offset:34816
v_mfma_f32_16x16x32_bf16 v[68:71], a[140:143], a[36:39], v[68:71]
buffer_load_dwordx4 v14, s[8:11], s24 offen offset:2048 lds
v_mfma_f32_16x16x32_bf16 v[76:79], a[136:139], a[40:43], v[76:79]
v_mfma_f32_16x16x32_bf16 v[76:79], a[140:143], a[44:47], v[76:79]
v_mfma_f32_16x16x32_bf16 v[84:87], a[136:139], a[48:51], v[84:87]
ds_read_b128 a[80:83], v2 offset:36864
v_mfma_f32_16x16x32_bf16 v[84:87], a[140:143], a[52:55], v[84:87]
buffer_load_dwordx4 v15, s[8:11], s24 offen offset:3072 lds
v_mfma_f32_16x16x32_bf16 v[92:95], a[136:139], a[56:59], v[92:95]
s_add_u32 s24, s24, 128
ds_read_b128 a[84:87], v3 offset:36864
v_mfma_f32_16x16x32_bf16 v[92:95], a[140:143], a[60:63], v[92:95]
s_waitcnt lgkmcnt(3)
v_mfma_f32_16x16x32_bf16 v[96:99], a[128:131], a[0:3], v[96:99]
s_add_u32 m0, s28, 4096
ds_read_b64_tr_b16 a[136:137], v7 offset:0
v_mfma_f32_16x16x32_bf16 v[96:99], a[132:135], a[4:7], v[96:99]
buffer_load_dwordx4 v12, s[8:11], s25 offen offset:0 lds
v_mfma_f32_16x16x32_bf16 v[104:107], a[128:131], a[8:11], v[104:107]
ds_read_b64_tr_b16 a[138:139], v7 offset:2048
v_mfma_f32_16x16x32_bf16 v[104:107], a[132:135], a[12:15], v[104:107]
v_mfma_f32_16x16x32_bf16 v[112:115], a[128:131], a[16:19], v[112:115]
ds_read_b64_tr_b16 a[140:141], v7 offset:16384
v_mfma_f32_16x16x32_bf16 v[112:115], a[132:135], a[20:23], v[112:115]
buffer_load_dwordx4 v13, s[8:11], s25 offen offset:1024 lds
v_mfma_f32_16x16x32_bf16 v[120:123], a[128:131], a[24:27], v[120:123]
ds_read_b64_tr_b16 a[142:143], v7 offset:18432
v_mfma_f32_16x16x32_bf16 v[120:123], a[132:135], a[28:31], v[120:123]
v_mfma_f32_16x16x32_bf16 v[128:131], a[128:131], a[32:35], v[128:131]
v_mfma_f32_16x16x32_bf16 v[128:131], a[132:135], a[36:39], v[128:131]
buffer_load_dwordx4 v14, s[8:11], s25 offen offset:2048 lds
v_mfma_f32_16x16x32_bf16 v[136:139], a[128:131], a[40:43], v[136:139]
ds_read_b128 a[88:91], v2 offset:38912
v_mfma_f32_16x16x32_bf16 v[136:139], a[132:135], a[44:47], v[136:139]
v_mfma_f32_16x16x32_bf16 v[144:147], a[128:131], a[48:51], v[144:147]
ds_read_b128 a[92:95], v3 offset:38912
v_mfma_f32_16x16x32_bf16 v[144:147], a[132:135], a[52:55], v[144:147]
buffer_load_dwordx4 v15, s[8:11], s25 offen offset:3072 lds
v_mfma_f32_16x16x32_bf16 v[152:155], a[128:131], a[56:59], v[152:155]
s_add_u32 s25, s25, 128
v_mfma_f32_16x16x32_bf16 v[152:155], a[132:135], a[60:63], v[152:155]
s_waitcnt lgkmcnt(2)
v_mfma_f32_16x16x32_bf16 v[100:103], a[136:139], a[0:3], v[100:103]
ds_read_b64_tr_b16 a[128:129], v8 offset:0
v_mfma_f32_16x16x32_bf16 v[100:103], a[140:143], a[4:7], v[100:103]
buffer_load_dword v21, v20, s[16:19], s43 offen
v_mfma_f32_16x16x32_bf16 v[108:111], a[136:139], a[8:11], v[108:111]
s_add_u32 s43, s43, s47
ds_read_b64_tr_b16 a[130:131], v8 offset:2048
v_mfma_f32_16x16x32_bf16 v[108:111], a[140:143], a[12:15], v[108:111]
PAD_2:
s_cbranch_execz M_tret
s_cmp_ge_u32 s43, s51
v_mfma_f32_16x16x32_bf16 v[116:119], a[136:139], a[16:19], v[116:119]
s_cselect_b32 s43, 0, s43
ds_read_b64_tr_b16 a[132:133], v8 offset:16384
v_mfma_f32_16x16x32_bf16 v[116:119], a[140:143], a[20:23], v[116:119]
s_cselect_b32 s51, s42, s51
v_mfma_f32_16x16x32_bf16 v[124:127], a[136:139], a[24:27], v[124:127]
s_cselect_b64 s[16:17], s[40:41], s[16:17]
ds_read_b64_tr_b16 a[134:135], v8 offset:18432
v_mfma_f32_16x16x32_bf16 v[124:127], a[140:143], a[28:31], v[124:127]
s_cselect_b32 s18, s42, s18
v_mfma_f32_16x16x32_bf16 v[132:135], a[136:139], a[32:35], v[132:135]
s_cselect_b64 s[40:41], s[44:45], s[40:41]
ds_read_b128 a[96:99], v2 offset:40960
v_mfma_f32_16x16x32_bf16 v[132:135], a[140:143], a[36:39], v[132:135]
s_cselect_b32 s42, s46, s42
v_mfma_f32_16x16x32_bf16 v[140:143], a[136:139], a[40:43], v[140:143]
s_cselect_b32 s46, 0, s46
v_mfma_f32_16x16x32_bf16 v[140:143], a[140:143], a[44:47], v[140:143]
s_lshl_b32 s59, s39, 5
v_mfma_f32_16x16x32_bf16 v[148:151], a[136:139], a[48:51], v[148:151]
s_add_u32 s59, s59, s38
ds_read_b128 a[100:103], v3 offset:40960
v_mfma_f32_16x16x32_bf16 v[148:151], a[140:143], a[52:55], v[148:151]
s_lshl_b32 s59, s59, 2
v_mfma_f32_16x16x32_bf16 v[156:159], a[136:139], a[56:59], v[156:159]
s_add_u32 s59, s59, 94392320
ds_read_b128 a[104:107], v2 offset:43008
v_mfma_f32_16x16x32_bf16 v[156:159], a[140:143], a[60:63], v[156:159]
s_waitcnt lgkmcnt(3)
s_cmp_lt_u32 s2, 224
v_mfma_f32_16x16x32_bf16 v[160:163], a[128:131], a[0:3], v[160:163]
s_cselect_b32 s59, s59, 3221225472
ds_read_b64_tr_b16 a[136:137], v9 offset:0
v_mfma_f32_16x16x32_bf16 v[160:163], a[132:135], a[4:7], v[160:163]
s_mov_b32 s58, 0xffff0000
v_mfma_f32_16x16x32_bf16 v[168:171], a[128:131], a[8:11], v[168:171]
s_cmp_lt_u32 s3, 1
ds_read_b64_tr_b16 a[138:139], v9 offset:2048
v_mfma_f32_16x16x32_bf16 v[168:171], a[132:135], a[12:15], v[168:171]
s_cselect_b32 s54, 0, 3221225472
v_mfma_f32_16x16x32_bf16 v[176:179], a[128:131], a[16:19], v[176:179]
s_cselect_b32 s50, 0x100, 0
ds_read_b64_tr_b16 a[140:141], v9 offset:16384
v_mfma_f32_16x16x32_bf16 v[176:179], a[132:135], a[20:23], v[176:179]
v_mfma_f32_16x16x32_bf16 v[184:187], a[128:131], a[24:27], v[184:187]
ds_read_b64_tr_b16 a[142:143], v9 offset:18432
v_mfma_f32_16x16x32_bf16 v[184:187], a[132:135], a[28:31], v[184:187]
v_mfma_f32_16x16x32_bf16 v[192:195], a[128:131], a[32:35], v[192:195]
v_mfma_f32_16x16x32_bf16 v[192:195], a[132:135], a[36:39], v[192:195]
v_mfma_f32_16x16x32_bf16 v[200:203], a[128:131], a[40:43], v[200:203]
ds_read_b128 a[108:111], v3 offset:43008
v_mfma_f32_16x16x32_bf16 v[200:203], a[132:135], a[44:47], v[200:203]
v_mfma_f32_16x16x32_bf16 v[208:211], a[128:131], a[48:51], v[208:211]
ds_read_b128 a[112:115], v2 offset:45056
v_mfma_f32_16x16x32_bf16 v[208:211], a[132:135], a[52:55], v[208:211]
v_mfma_f32_16x16x32_bf16 v[216:219], a[128:131], a[56:59], v[216:219]
v_mfma_f32_16x16x32_bf16 v[216:219], a[132:135], a[60:63], v[216:219]
s_waitcnt lgkmcnt(2)
v_mfma_f32_16x16x32_bf16 v[164:167], a[136:139], a[0:3], v[164:167]
ds_read_b64_tr_b16 a[128:129], v10 offset:0
v_mfma_f32_16x16x32_bf16 v[164:167], a[140:143], a[4:7], v[164:167]
v_mfma_f32_16x16x32_bf16 v[172:175], a[136:139], a[8:11], v[172:175]
ds_read_b64_tr_b16 a[130:131], v10 offset:2048
v_mfma_f32_16x16x32_bf16 v[172:175], a[140:143], a[12:15], v[172:175]
v_mfma_f32_16x16x32_bf16 v[180:183], a[136:139], a[16:19], v[180:183]
ds_read_b64_tr_b16 a[132:133], v10 offset:16384
v_mfma_f32_16x16x32_bf16 v[180:183], a[140:143], a[20:23], v[180:183]
v_mfma_f32_16x16x32_bf16 v[188:191], a[136:139], a[24:27], v[188:191]
ds_read_b64_tr_b16 a[134:135], v10 offset:18432
v_mfma_f32_16x16x32_bf16 v[188:191], a[140:143], a[28:31], v[188:191]
v_mfma_f32_16x16x32_bf16 v[196:199], a[136:139], a[32:35], v[196:199]
ds_read_b128 a[116:119], v3 offset:45056
v_mfma_f32_16x16x32_bf16 v[196:199], a[140:143], a[36:39], v[196:199]
v_mfma_f32_16x16x32_bf16 v[204:207], a[136:139], a[40:43], v[204:207]
ds_read_b128 a[120:123], v2 offset:47104
v_and_b32 v252, 31, v0
v_mfma_f32_16x16x32_bf16 v[204:207], a[140:143], a[44:47], v[204:207]
v_lshrrev_b32 v253, 5, v0
v_xor_b32 v253, v253, v252
v_mfma_f32_16x16x32_bf16 v[212:215], a[136:139], a[48:51], v[212:215]
v_and_b32 v253, 7, v253
v_lshlrev_b32 v252, 8, v252
v_mfma_f32_16x16x32_bf16 v[212:215], a[140:143], a[52:55], v[212:215]
v_lshl_add_u32 v252, v253, 4, v252
v_add_u32 v252, 147456, v252
v_mfma_f32_16x16x32_bf16 v[220:223], a[136:139], a[56:59], v[220:223]
ds_read_b128 a[124:127], v3 offset:47104
v_mfma_f32_16x16x32_bf16 v[220:223], a[140:143], a[60:63], v[220:223]
s_waitcnt lgkmcnt(3)
v_mfma_f32_16x16x32_bf16 a[192:195], a[128:131], a[0:3], a[192:195]
ds_read_b64_tr_b16 a[136:137], v11 offset:0
v_mfma_f32_16x16x32_bf16 a[192:195], a[132:135], a[4:7], a[192:195]
v_mfma_f32_16x16x32_bf16 a[200:203], a[128:131], a[8:11], a[200:203]
ds_read_b64_tr_b16 a[138:139], v11 offset:2048
v_mfma_f32_16x16x32_bf16 a[200:203], a[132:135], a[12:15], a[200:203]
v_mfma_f32_16x16x32_bf16 a[208:211], a[128:131], a[16:19], a[208:211]
ds_read_b64_tr_b16 a[140:141], v11 offset:16384
v_mfma_f32_16x16x32_bf16 a[208:211], a[132:135], a[20:23], a[208:211]
v_mfma_f32_16x16x32_bf16 a[216:219], a[128:131], a[24:27], a[216:219]
ds_read_b64_tr_b16 a[142:143], v11 offset:18432
v_mfma_f32_16x16x32_bf16 a[216:219], a[132:135], a[28:31], a[216:219]
v_mfma_f32_16x16x32_bf16 a[224:227], a[128:131], a[32:35], a[224:227]
v_mfma_f32_16x16x32_bf16 a[224:227], a[132:135], a[36:39], a[224:227]
v_mfma_f32_16x16x32_bf16 a[232:235], a[128:131], a[40:43], a[232:235]
v_mfma_f32_16x16x32_bf16 a[232:235], a[132:135], a[44:47], a[232:235]
v_mfma_f32_16x16x32_bf16 a[240:243], a[128:131], a[48:51], a[240:243]
v_mfma_f32_16x16x32_bf16 a[240:243], a[132:135], a[52:55], a[240:243]
v_mfma_f32_16x16x32_bf16 a[248:251], a[128:131], a[56:59], a[248:251]
s_waitcnt vmcnt(1) lgkmcnt(0)
v_mfma_f32_16x16x32_bf16 a[248:251], a[132:135], a[60:63], a[248:251]
s_barrier
v_mfma_f32_16x16x32_bf16 a[196:199], a[136:139], a[0:3], a[196:199]
s_add_u32 m0, s29, 65536
ds_read_b64_tr_b16 a[128:129], v4 offset:32768
v_lshlrev_b32 v28, 16, v248
v_mfma_f32_16x16x32_bf16 a[196:199], a[140:143], a[4:7], a[196:199]
buffer_load_dwordx4 v16, s[12:15], s26 offen offset:0 lds
v_mfma_f32_16x16x32_bf16 a[204:207], a[136:139], a[8:11], a[204:207]
ds_read_b64_tr_b16 a[130:131], v4 offset:34816
v_and_b32 v29, s58, v248
v_mfma_f32_16x16x32_bf16 a[204:207], a[140:143], a[12:15], a[204:207]
v_lshlrev_b32 v30, 16, v249
v_and_b32 v253, s58, v249
v_mfma_f32_16x16x32_bf16 a[212:215], a[136:139], a[16:19], a[212:215]
ds_read_b64_tr_b16 a[132:133], v4 offset:49152
v_lshlrev_b32 v22, 16, v224
v_mfma_f32_16x16x32_bf16 a[212:215], a[140:143], a[20:23], a[212:215]
buffer_load_dwordx4 v17, s[12:15], s26 offen offset:1024 lds
v_mfma_f32_16x16x32_bf16 a[220:223], a[136:139], a[24:27], a[220:223]
ds_read_b64_tr_b16 a[134:135], v4 offset:51200
v_lshlrev_b32 v23, 16, v225
v_mfma_f32_16x16x32_bf16 a[220:223], a[140:143], a[28:31], a[220:223]
v_lshlrev_b32 v24, 16, v226
v_mul_f32 v254, v22, v253
v_mfma_f32_16x16x32_bf16 a[228:231], a[136:139], a[32:35], a[228:231]
v_lshlrev_b32 v25, 16, v227
v_lshlrev_b32 v247, 16, v236
v_mfma_f32_16x16x32_bf16 a[228:231], a[140:143], a[36:39], a[228:231]
buffer_load_dwordx4 v18, s[12:15], s26 offen offset:2048 lds
v_mfma_f32_16x16x32_bf16 a[236:239], a[136:139], a[40:43], a[236:239]
v_fmac_f32 v254, v23, v30
v_fmac_f32 v254, v24, v29
v_mfma_f32_16x16x32_bf16 a[236:239], a[140:143], a[44:47], a[236:239]
v_fmac_f32 v254, v25, v28
v_mul_f32 v254, v254, v247
v_mfma_f32_16x16x32_bf16 a[244:247], a[136:139], a[48:51], a[244:247]
v_mul_f32 v255, v23, v253
v_lshlrev_b32 v22, 16, v228
v_mfma_f32_16x16x32_bf16 a[244:247], a[140:143], a[52:55], a[244:247]
buffer_load_dwordx4 v19, s[12:15], s26 offen offset:3072 lds
v_mfma_f32_16x16x32_bf16 a[252:255], a[136:139], a[56:59], a[252:255]
s_add_u32 s26, s26, 524288
v_lshlrev_b32 v247, 16, v237
v_fmac_f32 v255, v24, v30
v_mfma_f32_16x16x32_bf16 a[252:255], a[140:143], a[60:63], a[252:255]
s_waitcnt lgkmcnt(0)
v_fmac_f32 v255, v25, v29
v_fmac_f32 v255, v22, v28
v_mfma_f32_16x16x32_bf16 v[32:35], a[128:131], a[64:67], v[32:35]
s_add_u32 m0, s29, 81920
ds_read_b64_tr_b16 a[136:137], v5 offset:32768
v_mul_f32 v255, v255, v247
v_mfma_f32_16x16x32_bf16 v[32:35], a[132:135], a[68:71], v[32:35]
buffer_load_dwordx4 v16, s[12:15], s27 offen offset:0 lds
v_mfma_f32_16x16x32_bf16 v[40:43], a[128:131], a[72:75], v[40:43]
ds_read_b64_tr_b16 a[138:139], v5 offset:34816
v_cvt_pk_bf16_f32 v246, v254, v255
v_mfma_f32_16x16x32_bf16 v[40:43], a[132:135], a[76:79], v[40:43]
v_accvgpr_write_b32 a180, v246
v_mul_f32 v254, v24, v253
v_mfma_f32_16x16x32_bf16 v[48:51], a[128:131], a[80:83], v[48:51]
ds_read_b64_tr_b16 a[140:141], v5 offset:49152
v_lshlrev_b32 v23, 16, v229
v_mfma_f32_16x16x32_bf16 v[48:51], a[132:135], a[84:87], v[48:51]
buffer_load_dwordx4 v17, s[12:15], s27 offen offset:1024 lds
v_mfma_f32_16x16x32_bf16 v[56:59], a[128:131], a[88:91], v[56:59]
ds_read_b64_tr_b16 a[142:143], v5 offset:51200
v_lshlrev_b32 v247, 16, v238
v_mfma_f32_16x16x32_bf16 v[56:59], a[132:135], a[92:95], v[56:59]
v_fmac_f32 v254, v25, v30
v_fmac_f32 v254, v22, v29
v_fmac_f32 v254, v23, v28
v_mfma_f32_16x16x32_bf16 v[64:67], a[128:131], a[96:99], v[64:67]
ds_read_b128 a[0:3], v2 offset:0
v_mul_f32 v254, v254, v247
v_mfma_f32_16x16x32_bf16 v[64:67], a[132:135], a[100:103], v[64:67]
buffer_load_dwordx4 v18, s[12:15], s27 offen offset:2048 lds
v_mfma_f32_16x16x32_bf16 v[72:75], a[128:131], a[104:107], v[72:75]
ds_read_b128 a[4:7], v3 offset:0
v_cvt_pk_bf16_f32 v246, v255, v254
v_mfma_f32_16x16x32_bf16 v[72:75], a[132:135], a[108:111], v[72:75]
v_accvgpr_write_b32 a176, v246
v_mul_f32 v255, v25, v253
v_mfma_f32_16x16x32_bf16 v[80:83], a[128:131], a[112:115], v[80:83]
v_lshlrev_b32 v24, 16, v230
v_lshlrev_b32 v247, 16, v239
v_mfma_f32_16x16x32_bf16 v[80:83], a[132:135], a[116:119], v[80:83]
buffer_load_dwordx4 v19, s[12:15], s27 offen offset:3072 lds
v_mfma_f32_16x16x32_bf16 v[88:91], a[128:131], a[120:123], v[88:91]
s_add_u32 s27, s27, 524288
ds_read_b128 a[8:11], v2 offset:2048
v_fmac_f32 v255, v22, v30
v_mfma_f32_16x16x32_bf16 v[88:91], a[132:135], a[124:127], v[88:91]
s_waitcnt lgkmcnt(3)
v_fmac_f32 v255, v23, v29
v_fmac_f32 v255, v24, v28
v_mul_f32 v255, v255, v247
v_mfma_f32_16x16x32_bf16 v[36:39], a[136:139], a[64:67], v[36:39]
s_add_u32 m0, s28, 32768
ds_read_b64_tr_b16 a[128:129], v6 offset:32768
v_cvt_pk_bf16_f32 v246, v254, v255
v_mfma_f32_16x16x32_bf16 v[36:39], a[140:143], a[68:71], v[36:39]
buffer_load_dwordx4 v12, s[8:11], s24 offen offset:0 lds
v_mfma_f32_16x16x32_bf16 v[44:47], a[136:139], a[72:75], v[44:47]
ds_read_b64_tr_b16 a[130:131], v6 offset:34816
v_accvgpr_write_b32 a181, v246
v_mfma_f32_16x16x32_bf16 v[44:47], a[140:143], a[76:79], v[44:47]
v_mul_f32 v254, v22, v253
v_lshlrev_b32 v25, 16, v231
v_mfma_f32_16x16x32_bf16 v[52:55], a[136:139], a[80:83], v[52:55]
ds_read_b64_tr_b16 a[132:133], v6 offset:49152
v_lshlrev_b32 v247, 16, v240
v_mfma_f32_16x16x32_bf16 v[52:55], a[140:143], a[84:87], v[52:55]
buffer_load_dwordx4 v13, s[8:11], s24 offen offset:1024 lds
v_mfma_f32_16x16x32_bf16 v[60:63], a[136:139], a[88:91], v[60:63]
ds_read_b64_tr_b16 a[134:135], v6 offset:51200
v_fmac_f32 v254, v23, v30
v_fmac_f32 v254, v24, v29
v_mfma_f32_16x16x32_bf16 v[60:63], a[140:143], a[92:95], v[60:63]
v_fmac_f32 v254, v25, v28
v_mul_f32 v254, v254, v247
v_mfma_f32_16x16x32_bf16 v[68:71], a[136:139], a[96:99], v[68:71]
ds_read_b128 a[12:15], v3 offset:2048
v_cvt_pk_bf16_f32 v246, v255, v254
v_mfma_f32_16x16x32_bf16 v[68:71], a[140:143], a[100:103], v[68:71]
buffer_load_dwordx4 v14, s[8:11], s24 offen offset:2048 lds
v_mfma_f32_16x16x32_bf16 v[76:79], a[136:139], a[104:107], v[76:79]
v_accvgpr_write_b32 a177, v246
v_mul_f32 v255, v23, v253
v_mfma_f32_16x16x32_bf16 v[76:79], a[140:143], a[108:111], v[76:79]
v_lshlrev_b32 v22, 16, v232
v_lshlrev_b32 v247, 16, v241
v_mfma_f32_16x16x32_bf16 v[84:87], a[136:139], a[112:115], v[84:87]
ds_read_b128 a[16:19], v2 offset:4096
v_fmac_f32 v255, v24, v30
v_mfma_f32_16x16x32_bf16 v[84:87], a[140:143], a[116:119], v[84:87]
buffer_load_dwordx4 v15, s[8:11], s24 offen offset:3072 lds
v_mfma_f32_16x16x32_bf16 v[92:95], a[136:139], a[120:123], v[92:95]
s_add_u32 s24, s24, 128
ds_read_b128 a[20:23], v3 offset:4096
v_fmac_f32 v255, v25, v29
v_fmac_f32 v255, v22, v28
v_mfma_f32_16x16x32_bf16 v[92:95], a[140:143], a[124:127], v[92:95]
s_waitcnt lgkmcnt(3)
v_mul_f32 v255, v255, v247
v_cvt_pk_bf16_f32 v246, v254, v255
v_mfma_f32_16x16x32_bf16 v[96:99], a[128:131], a[64:67], v[96:99]
s_add_u32 m0, s28, 36864
ds_read_b64_tr_b16 a[136:137], v7 offset:32768
v_accvgpr_write_b32 a182, v246
v_mfma_f32_16x16x32_bf16 v[96:99], a[132:135], a[68:71], v[96:99]
buffer_load_dwordx4 v12, s[8:11], s25 offen offset:0 lds
v_mfma_f32_16x16x32_bf16 v[104:107], a[128:131], a[72:75], v[104:107]
ds_read_b64_tr_b16 a[138:139], v7 offset:34816
v_mul_f32 v254, v24, v253
v_mfma_f32_16x16x32_bf16 v[104:107], a[132:135], a[76:79], v[104:107]
v_lshlrev_b32 v23, 16, v233
v_lshlrev_b32 v247, 16, v242
v_mfma_f32_16x16x32_bf16 v[112:115], a[128:131], a[80:83], v[112:115]
ds_read_b64_tr_b16 a[140:141], v7 offset:49152
v_fmac_f32 v254, v25, v30
v_mfma_f32_16x16x32_bf16 v[112:115], a[132:135], a[84:87], v[112:115]
buffer_load_dwordx4 v13, s[8:11], s25 offen offset:1024 lds
v_fmac_f32 v254, v22, v29
v_mfma_f32_16x16x32_bf16 v[120:123], a[128:131], a[88:91], v[120:123]
ds_read_b64_tr_b16 a[142:143], v7 offset:51200
v_fmac_f32 v254, v23, v28
v_mfma_f32_16x16x32_bf16 v[120:123], a[132:135], a[92:95], v[120:123]
v_mul_f32 v254, v254, v247
v_cvt_pk_bf16_f32 v246, v255, v254
v_mfma_f32_16x16x32_bf16 v[128:131], a[128:131], a[96:99], v[128:131]
v_accvgpr_write_b32 a178, v246
v_mul_f32 v255, v25, v253
v_mfma_f32_16x16x32_bf16 v[128:131], a[132:135], a[100:103], v[128:131]
buffer_load_dwordx4 v14, s[8:11], s25 offen offset:2048 lds
v_mfma_f32_16x16x32_bf16 v[136:139], a[128:131], a[104:107], v[136:139]
ds_read_b128 a[24:27], v2 offset:6144
v_lshlrev_b32 v24, 16, v234
v_mfma_f32_16x16x32_bf16 v[136:139], a[132:135], a[108:111], v[136:139]
v_lshlrev_b32 v247, 16, v243
v_fmac_f32 v255, v22, v30
v_mfma_f32_16x16x32_bf16 v[144:147], a[128:131], a[112:115], v[144:147]
ds_read_b128 a[28:31], v3 offset:6144
v_fmac_f32 v255, v23, v29
v_mfma_f32_16x16x32_bf16 v[144:147], a[132:135], a[116:119], v[144:147]
buffer_load_dwordx4 v15, s[8:11], s25 offen offset:3072 lds
v_fmac_f32 v255, v24, v28
v_mfma_f32_16x16x32_bf16 v[152:155], a[128:131], a[120:123], v[152:155]
s_add_u32 s25, s25, 128
v_mul_f32 v255, v255, v247
v_cvt_pk_bf16_f32 v246, v254, v255
v_mfma_f32_16x16x32_bf16 v[152:155], a[132:135], a[124:127], v[152:155]
s_waitcnt lgkmcnt(2)
v_accvgpr_write_b32 a183, v246
v_mul_f32 v254, v22, v253
v_mfma_f32_16x16x32_bf16 v[100:103], a[136:139], a[64:67], v[100:103]
ds_read_b64_tr_b16 a[128:129], v8 offset:32768
v_lshlrev_b32 v25, 16, v235
v_mfma_f32_16x16x32_bf16 v[100:103], a[140:143], a[68:71], v[100:103]
buffer_load_dword v21, v20, s[16:19], s43 offen
v_mfma_f32_16x16x32_bf16 v[108:111], a[136:139], a[72:75], v[108:111]
s_add_u32 s43, s43, s47
ds_read_b64_tr_b16 a[130:131], v8 offset:34816
v_lshlrev_b32 v247, 16, v244
v_mfma_f32_16x16x32_bf16 v[108:111], a[140:143], a[76:79], v[108:111]
s_cmp_ge_u32 s43, s51
v_fmac_f32 v254, v23, v30
v_fmac_f32 v254, v24, v29
v_mfma_f32_16x16x32_bf16 v[116:119], a[136:139], a[80:83], v[116:119]
s_cselect_b32 s43, 0, s43
ds_read_b64_tr_b16 a[132:133], v8 offset:49152
v_fmac_f32 v254, v25, v28
v_mul_f32 v254, v254, v247
v_mfma_f32_16x16x32_bf16 v[116:119], a[140:143], a[84:87], v[116:119]
s_cselect_b32 s51, s42, s51
v_cvt_pk_bf16_f32 v246, v255, v254
v_accvgpr_write_b32 a179, v246
v_mfma_f32_16x16x32_bf16 v[124:127], a[136:139], a[88:91], v[124:127]
s_cselect_b64 s[16:17], s[40:41], s[16:17]
ds_read_b64_tr_b16 a[134:135], v8 offset:51200
v_lshlrev_b32 v28, 16, v250
v_mfma_f32_16x16x32_bf16 v[124:127], a[140:143], a[92:95], v[124:127]
s_cselect_b32 s18, s42, s18
v_and_b32 v29, s58, v250
v_lshlrev_b32 v30, 16, v251
v_mfma_f32_16x16x32_bf16 v[132:135], a[136:139], a[96:99], v[132:135]
s_cselect_b64 s[40:41], s[44:45], s[40:41]
ds_read_b128 a[32:35], v2 offset:8192
v_and_b32 v253, s58, v251
v_mfma_f32_16x16x32_bf16 v[132:135], a[140:143], a[100:103], v[132:135]
s_cselect_b32 s42, s46, s42
v_and_b32 v22, s58, v224
v_and_b32 v23, s58, v225
v_mfma_f32_16x16x32_bf16 v[140:143], a[136:139], a[104:107], v[140:143]
s_cselect_b32 s46, 0, s46
v_and_b32 v24, s58, v226
v_mul_f32 v254, v22, v253
v_mfma_f32_16x16x32_bf16 v[140:143], a[140:143], a[108:111], v[140:143]
buffer_load_dword v245, off, s[60:63], s54 sc1
v_mfma_f32_16x16x32_bf16 v[148:151], a[136:139], a[112:115], v[148:151]
ds_read_b128 a[36:39], v3 offset:8192
v_and_b32 v25, s58, v227
v_and_b32 v247, s58, v236
v_mfma_f32_16x16x32_bf16 v[148:151], a[140:143], a[116:119], v[148:151]
v_fmac_f32 v254, v23, v30
v_fmac_f32 v254, v24, v29
v_mfma_f32_16x16x32_bf16 v[156:159], a[136:139], a[120:123], v[156:159]
ds_read_b128 a[40:43], v2 offset:10240
v_fmac_f32 v254, v25, v28
v_mfma_f32_16x16x32_bf16 v[156:159], a[140:143], a[124:127], v[156:159]
s_waitcnt lgkmcnt(3)
v_mul_f32 v254, v254, v247
v_mul_f32 v255, v23, v253
v_mfma_f32_16x16x32_bf16 v[160:163], a[128:131], a[64:67], v[160:163]
ds_read_b64_tr_b16 a[136:137], v9 offset:32768
v_and_b32 v22, s58, v228
v_mfma_f32_16x16x32_bf16 v[160:163], a[132:135], a[68:71], v[160:163]
v_and_b32 v247, s58, v237
v_fmac_f32 v255, v24, v30
v_mfma_f32_16x16x32_bf16 v[168:171], a[128:131], a[72:75], v[168:171]
ds_read_b64_tr_b16 a[138:139], v9 offset:34816
v_fmac_f32 v255, v25, v29
v_mfma_f32_16x16x32_bf16 v[168:171], a[132:135], a[76:79], v[168:171]
v_fmac_f32 v255, v22, v28
v_mul_f32 v255, v255, v247
v_mfma_f32_16x16x32_bf16 v[176:179], a[128:131], a[80:83], v[176:179]
ds_read_b64_tr_b16 a[140:141], v9 offset:49152
v_cvt_pk_bf16_f32 v246, v254, v255
v_accvgpr_write_b32 a188, v246
v_mfma_f32_16x16x32_bf16 v[176:179], a[132:135], a[84:87], v[176:179]
v_mul_f32 v254, v24, v253
v_and_b32 v23, s58, v229
v_mfma_f32_16x16x32_bf16 v[184:187], a[128:131], a[88:91], v[184:187]
ds_read_b64_tr_b16 a[142:143], v9 offset:51200
v_and_b32 v247, s58, v238
v_mfma_f32_16x16x32_bf16 v[184:187], a[132:135], a[92:95], v[184:187]
v_fmac_f32 v254, v25, v30
v_fmac_f32 v254, v22, v29
v_mfma_f32_16x16x32_bf16 v[192:195], a[128:131], a[96:99], v[192:195]
v_fmac_f32 v254, v23, v28
v_mul_f32 v254, v254, v247
v_mfma_f32_16x16x32_bf16 v[192:195], a[132:135], a[100:103], v[192:195]
v_cvt_pk_bf16_f32 v246, v255, v254
v_accvgpr_write_b32 a184, v246
v_mfma_f32_16x16x32_bf16 v[200:203], a[128:131], a[104:107], v[200:203]
ds_read_b128 a[44:47], v3 offset:10240
v_mul_f32 v255, v25, v253
v_mfma_f32_16x16x32_bf16 v[200:203], a[132:135], a[108:111], v[200:203]
v_and_b32 v24, s58, v230
v_and_b32 v247, s58, v239
v_fmac_f32 v255, v22, v30
v_mfma_f32_16x16x32_bf16 v[208:211], a[128:131], a[112:115], v[208:211]
ds_read_b128 a[48:51], v2 offset:12288
v_fmac_f32 v255, v23, v29
v_mfma_f32_16x16x32_bf16 v[208:211], a[132:135], a[116:119], v[208:211]
v_fmac_f32 v255, v24, v28
v_mul_f32 v255, v255, v247
v_mfma_f32_16x16x32_bf16 v[216:219], a[128:131], a[120:123], v[216:219]
v_cvt_pk_bf16_f32 v246, v254, v255
v_accvgpr_write_b32 a189, v246
v_mfma_f32_16x16x32_bf16 v[216:219], a[132:135], a[124:127], v[216:219]
s_waitcnt lgkmcnt(2)
v_mul_f32 v254, v22, v253
v_and_b32 v25, s58, v231
v_mfma_f32_16x16x32_bf16 v[164:167], a[136:139], a[64:67], v[164:167]
ds_read_b64_tr_b16 a[128:129], v10 offset:32768
v_and_b32 v247, s58, v240
v_mfma_f32_16x16x32_bf16 v[164:167], a[140:143], a[68:71], v[164:167]
v_fmac_f32 v254, v23, v30
v_fmac_f32 v254, v24, v29
v_mfma_f32_16x16x32_bf16 v[172:175], a[136:139], a[72:75], v[172:175]
ds_read_b64_tr_b16 a[130:131], v10 offset:34816
v_fmac_f32 v254, v25, v28
v_mfma_f32_16x16x32_bf16 v[172:175], a[140:143], a[76:79], v[172:175]
v_mul_f32 v254, v254, v247
v_cvt_pk_bf16_f32 v246, v255, v254
v_accvgpr_write_b32 a185, v246
v_mfma_f32_16x16x32_bf16 v[180:183], a[136:139], a[80:83], v[180:183]
s_lshr_b32 s22, s3, 1
ds_read_b64_tr_b16 a[132:133], v10 offset:49152
v_mul_f32 v255, v23, v253
v_mfma_f32_16x16x32_bf16 v[180:183], a[140:143], a[84:87], v[180:183]
s_mul_i32 s22, s22, 2097152
v_and_b32 v22, s58, v232
v_and_b32 v247, s58, v241
v_mfma_f32_16x16x32_bf16 v[188:191], a[136:139], a[88:91], v[188:191]
s_and_b32 s23, s3, 1
ds_read_b64_tr_b16 a[134:135], v10 offset:51200
v_fmac_f32 v255, v24, v30
v_mfma_f32_16x16x32_bf16 v[188:191], a[140:143], a[92:95], v[188:191]
s_lshl_b32 s23, s23, 5
v_fmac_f32 v255, v25, v29
v_fmac_f32 v255, v22, v28
v_mfma_f32_16x16x32_bf16 v[196:199], a[136:139], a[96:99], v[196:199]
s_lshl_b32 s56, s39, 6
ds_read_b128 a[52:55], v3 offset:12288
v_mul_f32 v255, v255, v247
v_mfma_f32_16x16x32_bf16 v[196:199], a[140:143], a[100:103], v[196:199]
s_add_u32 s23, s23, s56
v_cvt_pk_bf16_f32 v246, v254, v255
v_accvgpr_write_b32 a190, v246
v_mfma_f32_16x16x32_bf16 v[204:207], a[136:139], a[104:107], v[204:207]
s_mul_i32 s23, s23, 4224
ds_read_b128 a[56:59], v2 offset:14336
v_mul_f32 v254, v24, v253
v_and_b32 v23, s58, v233
v_mfma_f32_16x16x32_bf16 v[204:207], a[140:143], a[108:111], v[204:207]
s_add_u32 s22, s22, s23
v_and_b32 v247, s58, v242
v_fmac_f32 v254, v25, v30
v_mfma_f32_16x16x32_bf16 v[212:215], a[136:139], a[112:115], v[212:215]
s_add_u32 s57, s22, 83886200
v_fmac_f32 v254, v22, v29
v_fmac_f32 v254, v23, v28
v_mfma_f32_16x16x32_bf16 v[212:215], a[140:143], a[116:119], v[212:215]
s_lshl_b32 s23, s38, 7
v_mul_f32 v254, v254, v247
v_cvt_pk_bf16_f32 v246, v255, v254
v_mfma_f32_16x16x32_bf16 v[220:223], a[136:139], a[120:123], v[220:223]
s_add_u32 s22, s22, s23
ds_read_b128 a[60:63], v3 offset:14336
v_accvgpr_write_b32 a186, v246
v_mfma_f32_16x16x32_bf16 v[220:223], a[140:143], a[124:127], v[220:223]
s_waitcnt lgkmcnt(3)
s_add_u32 s56, s22, 83886208
v_mul_f32 v255, v25, v253
v_and_b32 v24, s58, v234
v_mfma_f32_16x16x32_bf16 a[192:195], a[128:131], a[64:67], a[192:195]
s_cmp_lt_u32 s2, 224
ds_read_b64_tr_b16 a[136:137], v11 offset:32768
v_and_b32 v247, s58, v243
v_mfma_f32_16x16x32_bf16 a[192:195], a[132:135], a[68:71], a[192:195]
s_cselect_b32 s56, s56, 3221225472
v_fmac_f32 v255, v22, v30
v_fmac_f32 v255, v23, v29
v_mfma_f32_16x16x32_bf16 a[200:203], a[128:131], a[72:75], a[200:203]
s_cmp_eq_u32 s38, 0
ds_read_b64_tr_b16 a[138:139], v11 offset:34816
v_fmac_f32 v255, v24, v28
v_mul_f32 v255, v255, v247
v_mfma_f32_16x16x32_bf16 a[200:203], a[132:135], a[76:79], a[200:203]
s_cselect_b32 s57, s57, 3221225472
v_cvt_pk_bf16_f32 v246, v254, v255
v_accvgpr_write_b32 a191, v246
v_mfma_f32_16x16x32_bf16 a[208:211], a[128:131], a[80:83], a[208:211]
ds_read_b64_tr_b16 a[140:141], v11 offset:49152
v_mul_f32 v254, v22, v253
v_mfma_f32_16x16x32_bf16 a[208:211], a[132:135], a[84:87], a[208:211]
v_and_b32 v25, s58, v235
v_and_b32 v247, s58, v244
v_mfma_f32_16x16x32_bf16 a[216:219], a[128:131], a[88:91], a[216:219]
ds_read_b64_tr_b16 a[142:143], v11 offset:51200
v_fmac_f32 v254, v23, v30
v_mfma_f32_16x16x32_bf16 a[216:219], a[132:135], a[92:95], a[216:219]
ds_write_b128 v252, a[176:179] offset:0
v_fmac_f32 v254, v24, v29
v_mfma_f32_16x16x32_bf16 a[224:227], a[128:131], a[96:99], a[224:227]
v_fmac_f32 v254, v25, v28
v_mul_f32 v254, v254, v247
v_mfma_f32_16x16x32_bf16 a[224:227], a[132:135], a[100:103], a[224:227]
ds_write_b128 v252, a[180:183] offset:8192
v_cvt_pk_bf16_f32 v246, v255, v254
v_accvgpr_write_b32 a187, v246
v_mfma_f32_16x16x32_bf16 a[232:235], a[128:131], a[104:107], a[232:235]
v_mfma_f32_16x16x32_bf16 a[232:235], a[132:135], a[108:111], a[232:235]
ds_write_b128 v252, a[184:187] offset:128
v_mfma_f32_16x16x32_bf16 a[240:243], a[128:131], a[112:115], a[240:243]
v_mfma_f32_16x16x32_bf16 a[240:243], a[132:135], a[116:119], a[240:243]
ds_write_b128 v252, a[188:191] offset:8320
v_mfma_f32_16x16x32_bf16 a[248:251], a[128:131], a[120:123], a[248:251]
s_waitcnt vmcnt(2) lgkmcnt(0)
v_mfma_f32_16x16x32_bf16 a[248:251], a[132:135], a[124:127], a[248:251]
s_barrier
v_mfma_f32_16x16x32_bf16 a[196:199], a[136:139], a[64:67], a[196:199]
s_add_u32 m0, s29, 98304
ds_read_b64_tr_b16 a[128:129], v4 offset:0
v_lshrrev_b32 v22, 8, v1
v_mfma_f32_16x16x32_bf16 a[196:199], a[140:143], a[68:71], a[196:199]
buffer_load_dwordx4 v16, s[12:15], s26 offen offset:0 lds
v_mfma_f32_16x16x32_bf16 a[204:207], a[136:139], a[72:75], a[204:207]
ds_read_b64_tr_b16 a[130:131], v4 offset:2048
v_lshlrev_b32 v22, 4, v22
v_mfma_f32_16x16x32_bf16 a[204:207], a[140:143], a[76:79], a[204:207]
v_xor_b32 v22, v22, v1
v_add_u32 v22, s29, v22
v_mfma_f32_16x16x32_bf16 a[212:215], a[136:139], a[80:83], a[212:215]
ds_read_b64_tr_b16 a[132:133], v4 offset:16384
v_add_u32 v22, 147456, v22
v_mfma_f32_16x16x32_bf16 a[212:215], a[140:143], a[84:87], a[212:215]
buffer_load_dwordx4 v17, s[12:15], s26 offen offset:1024 lds
v_mfma_f32_16x16x32_bf16 a[220:223], a[136:139], a[88:91], a[220:223]
ds_read_b64_tr_b16 a[134:135], v4 offset:18432
v_xor_b32 v23, 64, v22
v_mfma_f32_16x16x32_bf16 a[220:223], a[140:143], a[92:95], a[220:223]
v_lshrrev_b32 v224, 7, v1
v_mul_u32_u24 v224, 4224, v224
v_mfma_f32_16x16x32_bf16 a[228:231], a[136:139], a[96:99], a[228:231]
v_and_b32 v225, 0x70, v1
v_add_u32 v224, v224, v225
v_mfma_f32_16x16x32_bf16 a[228:231], a[140:143], a[100:103], a[228:231]
buffer_load_dwordx4 v18, s[12:15], s26 offen offset:2048 lds
v_mfma_f32_16x16x32_bf16 a[236:239], a[136:139], a[104:107], a[236:239]
v_bfe_u32 v225, v1, 4, 5
v_mul_u32_u24 v225, 4224, v225
v_mfma_f32_16x16x32_bf16 a[236:239], a[140:143], a[108:111], a[236:239]
v_mov_b32 v226, 0
v_mov_b32 v227, 0
v_mfma_f32_16x16x32_bf16 a[244:247], a[136:139], a[112:115], a[244:247]
v_mfma_f32_16x16x32_bf16 a[244:247], a[140:143], a[116:119], a[244:247]
buffer_load_dwordx4 v19, s[12:15], s26 offen offset:3072 lds
v_mfma_f32_16x16x32_bf16 a[252:255], a[136:139], a[120:123], a[252:255]
s_add_u32 s26, s26, 524288
v_mfma_f32_16x16x32_bf16 a[252:255], a[140:143], a[124:127], a[252:255]
s_waitcnt lgkmcnt(0)
v_mfma_f32_16x16x32_bf16 v[32:35], a[128:131], a[0:3], v[32:35]
s_add_u32 m0, s29, 114688
ds_read_b64_tr_b16 a[136:137], v5 offset:0
v_mfma_f32_16x16x32_bf16 v[32:35], a[132:135], a[4:7], v[32:35]
buffer_load_dwordx4 v16, s[12:15], s27 offen offset:0 lds
v_mfma_f32_16x16x32_bf16 v[40:43], a[128:131], a[8:11], v[40:43]
s_mul_i32 s52, s20, 7
ds_read_b64_tr_b16 a[138:139], v5 offset:2048
v_mfma_f32_16x16x32_bf16 v[40:43], a[132:135], a[12:15], v[40:43]
s_add_u32 s52, s52, s21
buffer_store_dwordx2 v[226:227], v225, s[4:7], s57 offen sc1
v_mfma_f32_16x16x32_bf16 v[48:51], a[128:131], a[16:19], v[48:51]
s_lshl_b32 s53, s52, 2
ds_read_b64_tr_b16 a[140:141], v5 offset:16384
v_mfma_f32_16x16x32_bf16 v[48:51], a[132:135], a[20:23], v[48:51]
s_add_u32 s53, s53, s3
buffer_load_dwordx4 v17, s[12:15], s27 offen offset:1024 lds
v_mfma_f32_16x16x32_bf16 v[56:59], a[128:131], a[24:27], v[56:59]
s_lshl_b32 s49, s53, 12
ds_read_b64_tr_b16 a[142:143], v5 offset:18432
v_mfma_f32_16x16x32_bf16 v[56:59], a[132:135], a[28:31], v[56:59]
s_mul_i32 s53, s53, 4224
v_mfma_f32_16x16x32_bf16 v[64:67], a[128:131], a[32:35], v[64:67]
s_add_u32 s53, s53, 83886080
ds_read_b128 a[64:67], v2 offset:32768
v_mfma_f32_16x16x32_bf16 v[64:67], a[132:135], a[36:39], v[64:67]
s_lshr_b32 s52, s52, 4
buffer_load_dwordx4 v18, s[12:15], s27 offen offset:2048 lds
v_mfma_f32_16x16x32_bf16 v[72:75], a[128:131], a[40:43], v[72:75]
s_min_u32 s52, s52, 6
ds_read_b128 a[68:71], v3 offset:32768
v_mfma_f32_16x16x32_bf16 v[72:75], a[132:135], a[44:47], v[72:75]
s_lshl_b32 s52, s52, 7
ds_read_b128 a[176:179], v22 offset:0
v_mfma_f32_16x16x32_bf16 v[80:83], a[128:131], a[48:51], v[80:83]
s_add_u32 s52, s52, 94392320
ds_read_b128 a[180:183], v23 offset:1024
v_mfma_f32_16x16x32_bf16 v[80:83], a[132:135], a[52:55], v[80:83]
buffer_load_dwordx4 v19, s[12:15], s27 offen offset:3072 lds
v_mfma_f32_16x16x32_bf16 v[88:91], a[128:131], a[56:59], v[88:91]
s_add_u32 s27, s27, 524288
ds_read_b128 a[72:75], v2 offset:34816
v_mfma_f32_16x16x32_bf16 v[88:91], a[132:135], a[60:63], v[88:91]
s_waitcnt lgkmcnt(5)
ds_read_b128 a[184:187], v22 offset:2048
v_mfma_f32_16x16x32_bf16 v[36:39], a[136:139], a[0:3], v[36:39]
s_add_u32 m0, s28, 0
ds_read_b64_tr_b16 a[128:129], v6 offset:0
v_mfma_f32_16x16x32_bf16 v[36:39], a[140:143], a[4:7], v[36:39]
buffer_load_dwordx4 v12, s[8:11], s24 offen offset:0 lds
v_mfma_f32_16x16x32_bf16 v[44:47], a[136:139], a[8:11], v[44:47]
ds_read_b64_tr_b16 a[130:131], v6 offset:2048
v_mfma_f32_16x16x32_bf16 v[44:47], a[140:143], a[12:15], v[44:47]
PAD_3:
s_cbranch_execz M_tret
ds_read_b128 a[188:191], v23 offset:3072
v_mfma_f32_16x16x32_bf16 v[52:55], a[136:139], a[16:19], v[52:55]
ds_read_b64_tr_b16 a[132:133], v6 offset:16384
v_bfe_u32 v231, v1, 4, 5
v_mfma_f32_16x16x32_bf16 v[52:55], a[140:143], a[20:23], v[52:55]
buffer_load_dwordx4 v13, s[8:11], s24 offen offset:1024 lds
v_mfma_f32_16x16x32_bf16 v[60:63], a[136:139], a[24:27], v[60:63]
ds_read_b64_tr_b16 a[134:135], v6 offset:18432
v_lshlrev_b32 v231, 2, v231
v_mfma_f32_16x16x32_bf16 v[60:63], a[140:143], a[28:31], v[60:63]
v_lshlrev_b32 v229, 3, v1
v_min_u32 v229, 4096, v229
v_mfma_f32_16x16x32_bf16 v[68:71], a[136:139], a[32:35], v[68:71]
ds_read_b128 a[76:79], v3 offset:34816
v_mfma_f32_16x16x32_bf16 v[68:71], a[140:143], a[36:39], v[68:71]
buffer_load_dwordx4 v14, s[8:11], s24 offen offset:2048 lds
v_mfma_f32_16x16x32_bf16 v[76:79], a[136:139], a[40:43], v[76:79]
v_mfma_f32_16x16x32_bf16 v[76:79], a[140:143], a[44:47], v[76:79]
v_mfma_f32_16x16x32_bf16 v[84:87], a[136:139], a[48:51], v[84:87]
ds_read_b128 a[80:83], v2 offset:36864
v_mfma_f32_16x16x32_bf16 v[84:87], a[140:143], a[52:55], v[84:87]
buffer_load_dwordx4 v15, s[8:11], s24 offen offset:3072 lds
v_mfma_f32_16x16x32_bf16 v[92:95], a[136:139], a[56:59], v[92:95]
s_add_u32 s24, s24, 128
ds_read_b128 a[84:87], v3 offset:36864
v_mfma_f32_16x16x32_bf16 v[92:95], a[140:143], a[60:63], v[92:95]
s_waitcnt lgkmcnt(3)
v_mfma_f32_16x16x32_bf16 v[96:99], a[128:131], a[0:3], v[96:99]
s_add_u32 m0, s28, 4096
ds_read_b64_tr_b16 a[136:137], v7 offset:0
v_mfma_f32_16x16x32_bf16 v[96:99], a[132:135], a[4:7], v[96:99]
buffer_load_dwordx4 v12, s[8:11], s25 offen offset:0 lds
v_mfma_f32_16x16x32_bf16 v[104:107], a[128:131], a[8:11], v[104:107]
ds_read_b64_tr_b16 a[138:139], v7 offset:2048
v_mfma_f32_16x16x32_bf16 v[104:107], a[132:135], a[12:15], v[104:107]
v_mfma_f32_16x16x32_bf16 v[112:115], a[128:131], a[16:19], v[112:115]
ds_read_b64_tr_b16 a[140:141], v7 offset:16384
v_mfma_f32_16x16x32_bf16 v[112:115], a[132:135], a[20:23], v[112:115]
buffer_load_dwordx4 v13, s[8:11], s25 offen offset:1024 lds
v_mfma_f32_16x16x32_bf16 v[120:123], a[128:131], a[24:27], v[120:123]
ds_read_b64_tr_b16 a[142:143], v7 offset:18432
v_mfma_f32_16x16x32_bf16 v[120:123], a[132:135], a[28:31], v[120:123]
v_mfma_f32_16x16x32_bf16 v[128:131], a[128:131], a[32:35], v[128:131]
v_mfma_f32_16x16x32_bf16 v[128:131], a[132:135], a[36:39], v[128:131]
buffer_load_dwordx4 v14, s[8:11], s25 offen offset:2048 lds
v_mfma_f32_16x16x32_bf16 v[136:139], a[128:131], a[40:43], v[136:139]
ds_read_b128 a[88:91], v2 offset:38912
v_mfma_f32_16x16x32_bf16 v[136:139], a[132:135], a[44:47], v[136:139]
v_mfma_f32_16x16x32_bf16 v[144:147], a[128:131], a[48:51], v[144:147]
ds_read_b128 a[92:95], v3 offset:38912
v_mfma_f32_16x16x32_bf16 v[144:147], a[132:135], a[52:55], v[144:147]
buffer_load_dwordx4 v15, s[8:11], s25 offen offset:3072 lds
v_mfma_f32_16x16x32_bf16 v[152:155], a[128:131], a[56:59], v[152:155]
s_add_u32 s25, s25, 128
v_mfma_f32_16x16x32_bf16 v[152:155], a[132:135], a[60:63], v[152:155]
s_waitcnt lgkmcnt(2)
v_mfma_f32_16x16x32_bf16 v[100:103], a[136:139], a[0:3], v[100:103]
ds_read_b64_tr_b16 a[128:129], v8 offset:0
v_mfma_f32_16x16x32_bf16 v[100:103], a[140:143], a[4:7], v[100:103]
buffer_store_dwordx4 a[176:179], v224, s[4:7], s56 offen sc1
v_mfma_f32_16x16x32_bf16 v[108:111], a[136:139], a[8:11], v[108:111]
s_add_u32 s56, s56, 33792
ds_read_b64_tr_b16 a[130:131], v8 offset:2048
v_mfma_f32_16x16x32_bf16 v[108:111], a[140:143], a[12:15], v[108:111]
v_mfma_f32_16x16x32_bf16 v[116:119], a[136:139], a[16:19], v[116:119]
ds_read_b64_tr_b16 a[132:133], v8 offset:16384
v_mfma_f32_16x16x32_bf16 v[116:119], a[140:143], a[20:23], v[116:119]
v_mfma_f32_16x16x32_bf16 v[124:127], a[136:139], a[24:27], v[124:127]
s_cmp_lt_u32 s21, 0
ds_read_b64_tr_b16 a[134:135], v8 offset:18432
v_mfma_f32_16x16x32_bf16 v[124:127], a[140:143], a[28:31], v[124:127]
s_cselect_b32 s53, s53, 3221225472
v_mfma_f32_16x16x32_bf16 v[132:135], a[136:139], a[32:35], v[132:135]
s_cselect_b32 s49, s49, 3221225472
ds_read_b128 a[96:99], v2 offset:40960
v_mfma_f32_16x16x32_bf16 v[132:135], a[140:143], a[36:39], v[132:135]
s_add_u32 s48, s53, 2097152
v_mfma_f32_16x16x32_bf16 v[140:143], a[136:139], a[40:43], v[140:143]
v_mfma_f32_16x16x32_bf16 v[140:143], a[140:143], a[44:47], v[140:143]
v_mfma_f32_16x16x32_bf16 v[148:151], a[136:139], a[48:51], v[148:151]
ds_read_b128 a[100:103], v3 offset:40960
v_mfma_f32_16x16x32_bf16 v[148:151], a[140:143], a[52:55], v[148:151]
v_mfma_f32_16x16x32_bf16 v[156:159], a[136:139], a[56:59], v[156:159]
ds_read_b128 a[104:107], v2 offset:43008
v_mfma_f32_16x16x32_bf16 v[156:159], a[140:143], a[60:63], v[156:159]
s_waitcnt lgkmcnt(3)
v_mfma_f32_16x16x32_bf16 v[160:163], a[128:131], a[0:3], v[160:163]
ds_read_b64_tr_b16 a[136:137], v9 offset:0
v_mfma_f32_16x16x32_bf16 v[160:163], a[132:135], a[4:7], v[160:163]
v_mfma_f32_16x16x32_bf16 v[168:171], a[128:131], a[8:11], v[168:171]
ds_read_b64_tr_b16 a[138:139], v9 offset:2048
v_mfma_f32_16x16x32_bf16 v[168:171], a[132:135], a[12:15], v[168:171]
buffer_store_dwordx4 a[180:183], v224, s[4:7], s56 offen sc1
v_mfma_f32_16x16x32_bf16 v[176:179], a[128:131], a[16:19], v[176:179]
s_add_u32 s56, s56, 33792
ds_read_b64_tr_b16 a[140:141], v9 offset:16384
v_mfma_f32_16x16x32_bf16 v[176:179], a[132:135], a[20:23], v[176:179]
v_mfma_f32_16x16x32_bf16 v[184:187], a[128:131], a[24:27], v[184:187]
ds_read_b64_tr_b16 a[142:143], v9 offset:18432
v_mfma_f32_16x16x32_bf16 v[184:187], a[132:135], a[28:31], v[184:187]
v_mfma_f32_16x16x32_bf16 v[192:195], a[128:131], a[32:35], v[192:195]
v_mfma_f32_16x16x32_bf16 v[192:195], a[132:135], a[36:39], v[192:195]
v_mfma_f32_16x16x32_bf16 v[200:203], a[128:131], a[40:43], v[200:203]
ds_read_b128 a[108:111], v3 offset:43008
v_mfma_f32_16x16x32_bf16 v[200:203], a[132:135], a[44:47], v[200:203]
v_mfma_f32_16x16x32_bf16 v[208:211], a[128:131], a[48:51], v[208:211]
ds_read_b128 a[112:115], v2 offset:45056
v_mfma_f32_16x16x32_bf16 v[208:211], a[132:135], a[52:55], v[208:211]
v_mfma_f32_16x16x32_bf16 v[216:219], a[128:131], a[56:59], v[216:219]
v_mfma_f32_16x16x32_bf16 v[216:219], a[132:135], a[60:63], v[216:219]
s_waitcnt lgkmcnt(2)
v_mfma_f32_16x16x32_bf16 v[164:167], a[136:139], a[0:3], v[164:167]
ds_read_b64_tr_b16 a[128:129], v10 offset:0
v_mfma_f32_16x16x32_bf16 v[164:167], a[140:143], a[4:7], v[164:167]
v_mfma_f32_16x16x32_bf16 v[172:175], a[136:139], a[8:11], v[172:175]
ds_read_b64_tr_b16 a[130:131], v10 offset:2048
v_mfma_f32_16x16x32_bf16 v[172:175], a[140:143], a[12:15], v[172:175]
v_mfma_f32_16x16x32_bf16 v[180:183], a[136:139], a[16:19], v[180:183]
ds_read_b64_tr_b16 a[132:133], v10 offset:16384
v_mfma_f32_16x16x32_bf16 v[180:183], a[140:143], a[20:23], v[180:183]
buffer_store_dwordx4 a[184:187], v224, s[4:7], s56 offen sc1
v_mfma_f32_16x16x32_bf16 v[188:191], a[136:139], a[24:27], v[188:191]
s_add_u32 s56, s56, 33792
ds_read_b64_tr_b16 a[134:135], v10 offset:18432
v_mfma_f32_16x16x32_bf16 v[188:191], a[140:143], a[28:31], v[188:191]
v_mfma_f32_16x16x32_bf16 v[196:199], a[136:139], a[32:35], v[196:199]
ds_read_b128 a[116:119], v3 offset:45056
v_mfma_f32_16x16x32_bf16 v[196:199], a[140:143], a[36:39], v[196:199]
v_mfma_f32_16x16x32_bf16 v[204:207], a[136:139], a[40:43], v[204:207]
ds_read_b128 a[120:123], v2 offset:47104
v_mfma_f32_16x16x32_bf16 v[204:207], a[140:143], a[44:47], v[204:207]
v_mfma_f32_16x16x32_bf16 v[212:215], a[136:139], a[48:51], v[212:215]
v_mfma_f32_16x16x32_bf16 v[212:215], a[140:143], a[52:55], v[212:215]
v_mfma_f32_16x16x32_bf16 v[220:223], a[136:139], a[56:59], v[220:223]
ds_read_b128 a[124:127], v3 offset:47104
v_mfma_f32_16x16x32_bf16 v[220:223], a[140:143], a[60:63], v[220:223]
s_waitcnt lgkmcnt(3)
v_mfma_f32_16x16x32_bf16 a[192:195], a[128:131], a[0:3], a[192:195]
ds_read_b64_tr_b16 a[136:137], v11 offset:0
v_mfma_f32_16x16x32_bf16 a[192:195], a[132:135], a[4:7], a[192:195]
v_mfma_f32_16x16x32_bf16 a[200:203], a[128:131], a[8:11], a[200:203]
ds_read_b64_tr_b16 a[138:139], v11 offset:2048
v_mfma_f32_16x16x32_bf16 a[200:203], a[132:135], a[12:15], a[200:203]
v_mfma_f32_16x16x32_bf16 a[208:211], a[128:131], a[16:19], a[208:211]
ds_read_b64_tr_b16 a[140:141], v11 offset:16384
v_mfma_f32_16x16x32_bf16 a[208:211], a[132:135], a[20:23], a[208:211]
v_mfma_f32_16x16x32_bf16 a[216:219], a[128:131], a[24:27], a[216:219]
ds_read_b64_tr_b16 a[142:143], v11 offset:18432
v_mfma_f32_16x16x32_bf16 a[216:219], a[132:135], a[28:31], a[216:219]
buffer_store_dwordx4 a[188:191], v224, s[4:7], s56 offen sc1
v_mfma_f32_16x16x32_bf16 a[224:227], a[128:131], a[32:35], a[224:227]
s_add_u32 s56, s56, 33792
v_mfma_f32_16x16x32_bf16 a[224:227], a[132:135], a[36:39], a[224:227]
v_mfma_f32_16x16x32_bf16 a[232:235], a[128:131], a[40:43], a[232:235]
v_mfma_f32_16x16x32_bf16 a[232:235], a[132:135], a[44:47], a[232:235]
v_mfma_f32_16x16x32_bf16 a[240:243], a[128:131], a[48:51], a[240:243]
v_mfma_f32_16x16x32_bf16 a[240:243], a[132:135], a[52:55], a[240:243]
v_mfma_f32_16x16x32_bf16 a[248:251], a[128:131], a[56:59], a[248:251]
s_waitcnt vmcnt(4) lgkmcnt(0)
v_mfma_f32_16x16x32_bf16 a[248:251], a[132:135], a[60:63], a[248:251]
s_barrier
v_mfma_f32_16x16x32_bf16 a[196:199], a[136:139], a[0:3], a[196:199]
s_add_u32 m0, s29, 65536
ds_read_b64_tr_b16 a[128:129], v4 offset:32768
v_mfma_f32_16x16x32_bf16 a[196:199], a[140:143], a[4:7], a[196:199]
buffer_load_dwordx4 v16, s[12:15], s26 offen offset:0 lds
v_mfma_f32_16x16x32_bf16 a[204:207], a[136:139], a[8:11], a[204:207]
ds_read_b64_tr_b16 a[130:131], v4 offset:34816
v_cmp_gt_u32 vcc, s50, v245
v_mfma_f32_16x16x32_bf16 a[204:207], a[140:143], a[12:15], a[204:207]
v_mfma_f32_16x16x32_bf16 a[212:215], a[136:139], a[16:19], a[212:215]
ds_read_b64_tr_b16 a[132:133], v4 offset:49152
v_mfma_f32_16x16x32_bf16 a[212:215], a[140:143], a[20:23], a[212:215]
buffer_load_dwordx4 v17, s[12:15], s26 offen offset:1024 lds
v_mfma_f32_16x16x32_bf16 a[220:223], a[136:139], a[24:27], a[220:223]
ds_read_b64_tr_b16 a[134:135], v4 offset:51200
v_mfma_f32_16x16x32_bf16 a[220:223], a[140:143], a[28:31], a[220:223]
v_mfma_f32_16x16x32_bf16 a[228:231], a[136:139], a[32:35], a[228:231]
v_mfma_f32_16x16x32_bf16 a[228:231], a[140:143], a[36:39], a[228:231]
buffer_load_dwordx4 v18, s[12:15], s26 offen offset:2048 lds
v_mfma_f32_16x16x32_bf16 a[236:239], a[136:139], a[40:43], a[236:239]
v_mfma_f32_16x16x32_bf16 a[236:239], a[140:143], a[44:47], a[236:239]
v_mfma_f32_16x16x32_bf16 a[244:247], a[136:139], a[48:51], a[244:247]
v_mfma_f32_16x16x32_bf16 a[244:247], a[140:143], a[52:55], a[244:247]
buffer_load_dwordx4 v19, s[12:15], s26 offen offset:3072 lds
v_mfma_f32_16x16x32_bf16 a[252:255], a[136:139], a[56:59], a[252:255]
s_add_u32 s26, s26, 524288
v_mfma_f32_16x16x32_bf16 a[252:255], a[140:143], a[60:63], a[252:255]
s_waitcnt lgkmcnt(0)
s_mov_b32 s82, s59
s_cbranch_vccnz M_cntspinK
s_branch Lg_1
PAD_4:
s_cbranch_execz M_tret
Lg_1t:
v_mfma_f32_16x16x32_bf16 v[32:35], a[128:131], a[64:67], v[32:35]
s_add_u32 m0, s29, 81920
ds_read_b64_tr_b16 a[136:137], v5 offset:32768
v_mfma_f32_16x16x32_bf16 v[32:35], a[132:135], a[68:71], v[32:35]
buffer_load_dwordx4 v16, s[12:15], s27 offen offset:0 lds
v_mfma_f32_16x16x32_bf16 v[40:43], a[128:131], a[72:75], v[40:43]
s_and_b32 s44, s3, 1
ds_read_b64_tr_b16 a[138:139], v5 offset:34816
v_mfma_f32_16x16x32_bf16 v[40:43], a[132:135], a[76:79], v[40:43]
s_lshl_b32 s44, s44, 8
v_mfma_f32_16x16x32_bf16 v[48:51], a[128:131], a[80:83], v[48:51]
s_lshl_b32 s45, s3, 7
ds_read_b64_tr_b16 a[140:141], v5 offset:49152
v_mfma_f32_16x16x32_bf16 v[48:51], a[132:135], a[84:87], v[48:51]
s_xor_b32 s44, s44, s45
buffer_load_dwordx4 v17, s[12:15], s27 offen offset:1024 lds
v_mfma_f32_16x16x32_bf16 v[56:59], a[128:131], a[88:91], v[56:59]
s_xor_b32 s44, s44, 196608
ds_read_b64_tr_b16 a[142:143], v5 offset:51200
v_mfma_f32_16x16x32_bf16 v[56:59], a[132:135], a[92:95], v[56:59]
v_mfma_f32_16x16x32_bf16 v[64:67], a[128:131], a[96:99], v[64:67]
ds_read_b128 a[0:3], v2 offset:0
v_mfma_f32_16x16x32_bf16 v[64:67], a[132:135], a[100:103], v[64:67]
buffer_load_dwordx4 v18, s[12:15], s27 offen offset:2048 lds
v_mfma_f32_16x16x32_bf16 v[72:75], a[128:131], a[104:107], v[72:75]
ds_read_b128 a[4:7], v3 offset:0
v_mfma_f32_16x16x32_bf16 v[72:75], a[132:135], a[108:111], v[72:75]
v_mfma_f32_16x16x32_bf16 v[80:83], a[128:131], a[112:115], v[80:83]
v_mfma_f32_16x16x32_bf16 v[80:83], a[132:135], a[116:119], v[80:83]
buffer_load_dwordx4 v19, s[12:15], s27 offen offset:3072 lds
v_mfma_f32_16x16x32_bf16 v[88:91], a[128:131], a[120:123], v[88:91]
s_add_u32 s27, s27, 524288
ds_read_b128 a[8:11], v2 offset:2048
v_mfma_f32_16x16x32_bf16 v[88:91], a[132:135], a[124:127], v[88:91]
s_waitcnt lgkmcnt(3)
v_mfma_f32_16x16x32_bf16 v[36:39], a[136:139], a[64:67], v[36:39]
s_add_u32 m0, s28, 32768
ds_read_b64_tr_b16 a[128:129], v6 offset:32768
v_mfma_f32_16x16x32_bf16 v[36:39], a[140:143], a[68:71], v[36:39]
buffer_load_dwordx4 v12, s[8:11], s24 offen offset:0 lds
v_mfma_f32_16x16x32_bf16 v[44:47], a[136:139], a[72:75], v[44:47]
ds_read_b64_tr_b16 a[130:131], v6 offset:34816
v_mfma_f32_16x16x32_bf16 v[44:47], a[140:143], a[76:79], v[44:47]
v_mfma_f32_16x16x32_bf16 v[52:55], a[136:139], a[80:83], v[52:55]
s_mov_b64 s[56:57], s[72:73]
ds_read_b64_tr_b16 a[132:133], v6 offset:49152
v_mfma_f32_16x16x32_bf16 v[52:55], a[140:143], a[84:87], v[52:55]
s_mov_b32 s58, 1835008
buffer_load_dwordx4 v13, s[8:11], s24 offen offset:1024 lds
v_mfma_f32_16x16x32_bf16 v[60:63], a[136:139], a[88:91], v[60:63]
s_mov_b32 s59, 0x20000
ds_read_b64_tr_b16 a[134:135], v6 offset:51200
v_mfma_f32_16x16x32_bf16 v[60:63], a[140:143], a[92:95], v[60:63]
v_mfma_f32_16x16x32_bf16 v[68:71], a[136:139], a[96:99], v[68:71]
ds_read_b128 a[12:15], v3 offset:2048
v_mfma_f32_16x16x32_bf16 v[68:71], a[140:143], a[100:103], v[68:71]
buffer_load_dwordx4 v14, s[8:11], s24 offen offset:2048 lds
v_mfma_f32_16x16x32_bf16 v[76:79], a[136:139], a[104:107], v[76:79]
v_mfma_f32_16x16x32_bf16 v[76:79], a[140:143], a[108:111], v[76:79]
v_mfma_f32_16x16x32_bf16 v[84:87], a[136:139], a[112:115], v[84:87]
ds_read_b128 a[16:19], v2 offset:4096
v_mfma_f32_16x16x32_bf16 v[84:87], a[140:143], a[116:119], v[84:87]
buffer_load_dwordx4 v15, s[8:11], s24 offen offset:3072 lds
v_mfma_f32_16x16x32_bf16 v[92:95], a[136:139], a[120:123], v[92:95]
s_add_u32 s24, s24, 128
ds_read_b128 a[20:23], v3 offset:4096
v_mfma_f32_16x16x32_bf16 v[92:95], a[140:143], a[124:127], v[92:95]
s_waitcnt lgkmcnt(3)
v_mfma_f32_16x16x32_bf16 v[96:99], a[128:131], a[64:67], v[96:99]
s_add_u32 m0, s28, 36864
ds_read_b64_tr_b16 a[136:137], v7 offset:32768
v_mfma_f32_16x16x32_bf16 v[96:99], a[132:135], a[68:71], v[96:99]
buffer_load_dwordx4 v12, s[8:11], s25 offen offset:0 lds
v_mfma_f32_16x16x32_bf16 v[104:107], a[128:131], a[72:75], v[104:107]
ds_read_b64_tr_b16 a[138:139], v7 offset:34816
v_mfma_f32_16x16x32_bf16 v[104:107], a[132:135], a[76:79], v[104:107]
v_mfma_f32_16x16x32_bf16 v[112:115], a[128:131], a[80:83], v[112:115]
ds_read_b64_tr_b16 a[140:141], v7 offset:49152
v_mfma_f32_16x16x32_bf16 v[112:115], a[132:135], a[84:87], v[112:115]
buffer_load_dwordx4 v13, s[8:11], s25 offen offset:1024 lds
v_mfma_f32_16x16x32_bf16 v[120:123], a[128:131], a[88:91], v[120:123]
ds_read_b64_tr_b16 a[142:143], v7 offset:51200
v_mfma_f32_16x16x32_bf16 v[120:123], a[132:135], a[92:95], v[120:123]
v_mfma_f32_16x16x32_bf16 v[128:131], a[128:131], a[96:99], v[128:131]
v_mfma_f32_16x16x32_bf16 v[128:131], a[132:135], a[100:103], v[128:131]
buffer_load_dwordx4 v14, s[8:11], s25 offen offset:2048 lds
v_mfma_f32_16x16x32_bf16 v[136:139], a[128:131], a[104:107], v[136:139]
ds_read_b128 a[24:27], v2 offset:6144
v_mfma_f32_16x16x32_bf16 v[136:139], a[132:135], a[108:111], v[136:139]
v_mfma_f32_16x16x32_bf16 v[144:147], a[128:131], a[112:115], v[144:147]
ds_read_b128 a[28:31], v3 offset:6144
v_mfma_f32_16x16x32_bf16 v[144:147], a[132:135], a[116:119], v[144:147]
buffer_load_dwordx4 v15, s[8:11], s25 offen offset:3072 lds
v_mfma_f32_16x16x32_bf16 v[152:155], a[128:131], a[120:123], v[152:155]
s_add_u32 s25, s25, 128
v_mfma_f32_16x16x32_bf16 v[152:155], a[132:135], a[124:127], v[152:155]
s_waitcnt lgkmcnt(2)
v_mfma_f32_16x16x32_bf16 v[100:103], a[136:139], a[64:67], v[100:103]
ds_read_b64_tr_b16 a[128:129], v8 offset:32768
v_mfma_f32_16x16x32_bf16 v[100:103], a[140:143], a[68:71], v[100:103]
buffer_load_dword v21, v20, s[16:19], s43 offen
v_mfma_f32_16x16x32_bf16 v[108:111], a[136:139], a[72:75], v[108:111]
s_mov_b64 s[8:9], s[76:77]
ds_read_b64_tr_b16 a[130:131], v8 offset:34816
v_mfma_f32_16x16x32_bf16 v[108:111], a[140:143], a[76:79], v[108:111]
s_mov_b32 s10, 1835008
buffer_load_dword v21, v20, s[16:19], s43 offen offset:256
v_mfma_f32_16x16x32_bf16 v[116:119], a[136:139], a[80:83], v[116:119]
s_lshl_b32 s24, s37, 2
ds_read_b64_tr_b16 a[132:133], v8 offset:49152
v_mfma_f32_16x16x32_bf16 v[116:119], a[140:143], a[84:87], v[116:119]
s_add_u32 s24, s24, s3
buffer_load_dword v21, v20, s[16:19], s43 offen offset:512
v_mfma_f32_16x16x32_bf16 v[124:127], a[136:139], a[88:91], v[124:127]
s_mul_i32 s24, s24, 28672
ds_read_b64_tr_b16 a[134:135], v8 offset:51200
v_mfma_f32_16x16x32_bf16 v[124:127], a[140:143], a[92:95], v[124:127]
s_mov_b32 s28, s29
buffer_load_dword v21, v20, s[16:19], s43 offen offset:768
v_mfma_f32_16x16x32_bf16 v[132:135], a[136:139], a[96:99], v[132:135]
ds_read_b128 a[32:35], v2 offset:8192
v_mfma_f32_16x16x32_bf16 v[132:135], a[140:143], a[100:103], v[132:135]
v_mfma_f32_16x16x32_bf16 v[140:143], a[136:139], a[104:107], v[140:143]
v_mfma_f32_16x16x32_bf16 v[140:143], a[140:143], a[108:111], v[140:143]
v_mfma_f32_16x16x32_bf16 v[148:151], a[136:139], a[112:115], v[148:151]
ds_read_b128 a[36:39], v3 offset:8192
v_lshrrev_b32 v28, 7, v1
v_mfma_f32_16x16x32_bf16 v[148:151], a[140:143], a[116:119], v[148:151]
v_lshrrev_b32 v29, 1, v28
v_lshlrev_b32 v29, 4, v29
v_mfma_f32_16x16x32_bf16 v[156:159], a[136:139], a[120:123], v[156:159]
ds_read_b128 a[40:43], v2 offset:10240
v_and_b32 v30, 0x70, v1
v_mfma_f32_16x16x32_bf16 v[156:159], a[140:143], a[124:127], v[156:159]
s_waitcnt lgkmcnt(3)
v_xor_b32 v29, v29, v30
v_mul_u32_u24 v28, 896, v28
v_mfma_f32_16x16x32_bf16 v[160:163], a[128:131], a[64:67], v[160:163]
ds_read_b64_tr_b16 a[136:137], v9 offset:32768
v_add_u32 v12, v28, v29
v_mfma_f32_16x16x32_bf16 v[160:163], a[132:135], a[68:71], v[160:163]
v_xor_b32 v29, 64, v29
v_add_u32 v28, v28, v29
v_mfma_f32_16x16x32_bf16 v[168:171], a[128:131], a[72:75], v[168:171]
ds_read_b64_tr_b16 a[138:139], v9 offset:34816
v_add_u32 v13, 6144, v28
v_mfma_f32_16x16x32_bf16 v[168:171], a[132:135], a[76:79], v[168:171]
v_add_u32 v14, 12288, v12
v_add_u32 v15, 18432, v28
v_mfma_f32_16x16x32_bf16 v[176:179], a[128:131], a[80:83], v[176:179]
ds_read_b64_tr_b16 a[140:141], v9 offset:49152
v_xor_b32 v22, s44, v4
v_mfma_f32_16x16x32_bf16 v[176:179], a[132:135], a[84:87], v[176:179]
v_xor_b32 v23, 32, v22
v_xor_b32 v24, 64, v22
v_mfma_f32_16x16x32_bf16 v[184:187], a[128:131], a[88:91], v[184:187]
ds_read_b64_tr_b16 a[142:143], v9 offset:51200
v_xor_b32 v25, 96, v22
v_mfma_f32_16x16x32_bf16 v[184:187], a[132:135], a[92:95], v[184:187]
v_mfma_f32_16x16x32_bf16 v[192:195], a[128:131], a[96:99], v[192:195]
v_mfma_f32_16x16x32_bf16 v[192:195], a[132:135], a[100:103], v[192:195]
v_mfma_f32_16x16x32_bf16 v[200:203], a[128:131], a[104:107], v[200:203]
ds_read_b128 a[44:47], v3 offset:10240
v_mfma_f32_16x16x32_bf16 v[200:203], a[132:135], a[108:111], v[200:203]
v_mfma_f32_16x16x32_bf16 v[208:211], a[128:131], a[112:115], v[208:211]
ds_read_b128 a[48:51], v2 offset:12288
v_mfma_f32_16x16x32_bf16 v[208:211], a[132:135], a[116:119], v[208:211]
v_mfma_f32_16x16x32_bf16 v[216:219], a[128:131], a[120:123], v[216:219]
v_mfma_f32_16x16x32_bf16 v[216:219], a[132:135], a[124:127], v[216:219]
s_waitcnt lgkmcnt(2)
v_mfma_f32_16x16x32_bf16 v[164:167], a[136:139], a[64:67], v[164:167]
ds_read_b64_tr_b16 a[128:129], v10 offset:32768
v_mfma_f32_16x16x32_bf16 v[164:167], a[140:143], a[68:71], v[164:167]
v_mfma_f32_16x16x32_bf16 v[172:175], a[136:139], a[72:75], v[172:175]
ds_read_b64_tr_b16 a[130:131], v10 offset:34816
v_mfma_f32_16x16x32_bf16 v[172:175], a[140:143], a[76:79], v[172:175]
v_mfma_f32_16x16x32_bf16 v[180:183], a[136:139], a[80:83], v[180:183]
ds_read_b64_tr_b16 a[132:133], v10 offset:49152
v_mfma_f32_16x16x32_bf16 v[180:183], a[140:143], a[84:87], v[180:183]
v_mfma_f32_16x16x32_bf16 v[188:191], a[136:139], a[88:91], v[188:191]
ds_read_b64_tr_b16 a[134:135], v10 offset:51200
v_mfma_f32_16x16x32_bf16 v[188:191], a[140:143], a[92:95], v[188:191]
v_mfma_f32_16x16x32_bf16 v[196:199], a[136:139], a[96:99], v[196:199]
ds_read_b128 a[52:55], v3 offset:12288
v_mfma_f32_16x16x32_bf16 v[196:199], a[140:143], a[100:103], v[196:199]
v_mfma_f32_16x16x32_bf16 v[204:207], a[136:139], a[104:107], v[204:207]
ds_read_b128 a[56:59], v2 offset:14336
v_mfma_f32_16x16x32_bf16 v[204:207], a[140:143], a[108:111], v[204:207]
v_mfma_f32_16x16x32_bf16 v[212:215], a[136:139], a[112:115], v[212:215]
v_mfma_f32_16x16x32_bf16 v[212:215], a[140:143], a[116:119], v[212:215]
v_mfma_f32_16x16x32_bf16 v[220:223], a[136:139], a[120:123], v[220:223]
ds_read_b128 a[60:63], v3 offset:14336
v_mfma_f32_16x16x32_bf16 v[220:223], a[140:143], a[124:127], v[220:223]
s_waitcnt lgkmcnt(3)
v_mfma_f32_16x16x32_bf16 a[192:195], a[128:131], a[64:67], a[192:195]
ds_read_b64_tr_b16 a[136:137], v11 offset:32768
v_mfma_f32_16x16x32_bf16 a[192:195], a[132:135], a[68:71], a[192:195]
v_mfma_f32_16x16x32_bf16 a[200:203], a[128:131], a[72:75], a[200:203]
ds_read_b64_tr_b16 a[138:139], v11 offset:34816
v_mfma_f32_16x16x32_bf16 a[200:203], a[132:135], a[76:79], a[200:203]
v_mfma_f32_16x16x32_bf16 a[208:211], a[128:131], a[80:83], a[208:211]
ds_read_b64_tr_b16 a[140:141], v11 offset:49152
v_mfma_f32_16x16x32_bf16 a[208:211], a[132:135], a[84:87], a[208:211]
v_mfma_f32_16x16x32_bf16 a[216:219], a[128:131], a[88:91], a[216:219]
ds_read_b64_tr_b16 a[142:143], v11 offset:51200
v_mfma_f32_16x16x32_bf16 a[216:219], a[132:135], a[92:95], a[216:219]
v_mfma_f32_16x16x32_bf16 a[224:227], a[128:131], a[96:99], a[224:227]
v_mfma_f32_16x16x32_bf16 a[224:227], a[132:135], a[100:103], a[224:227]
v_mfma_f32_16x16x32_bf16 a[232:235], a[128:131], a[104:107], a[232:235]
v_mfma_f32_16x16x32_bf16 a[232:235], a[132:135], a[108:111], a[232:235]
v_mfma_f32_16x16x32_bf16 a[240:243], a[128:131], a[112:115], a[240:243]
v_mfma_f32_16x16x32_bf16 a[240:243], a[132:135], a[116:119], a[240:243]
v_mfma_f32_16x16x32_bf16 a[248:251], a[128:131], a[120:123], a[248:251]
s_waitcnt vmcnt(4) lgkmcnt(0)
v_mfma_f32_16x16x32_bf16 a[248:251], a[132:135], a[124:127], a[248:251]
s_barrier
v_mfma_f32_16x16x32_bf16 a[196:199], a[136:139], a[64:67], a[196:199]
s_add_u32 m0, s29, 98304
ds_read_b64_tr_b16 a[128:129], v4 offset:0
v_mfma_f32_16x16x32_bf16 a[196:199], a[140:143], a[68:71], a[196:199]
buffer_load_dwordx4 v16, s[12:15], s26 offen offset:0 lds
v_mfma_f32_16x16x32_bf16 a[204:207], a[136:139], a[72:75], a[204:207]
ds_read_b64_tr_b16 a[130:131], v4 offset:2048
v_mfma_f32_16x16x32_bf16 a[204:207], a[140:143], a[76:79], a[204:207]
v_mfma_f32_16x16x32_bf16 a[212:215], a[136:139], a[80:83], a[212:215]
ds_read_b64_tr_b16 a[132:133], v4 offset:16384
v_mfma_f32_16x16x32_bf16 a[212:215], a[140:143], a[84:87], a[212:215]
buffer_load_dwordx4 v17, s[12:15], s26 offen offset:1024 lds
v_mfma_f32_16x16x32_bf16 a[220:223], a[136:139], a[88:91], a[220:223]
ds_read_b64_tr_b16 a[134:135], v4 offset:18432
v_mfma_f32_16x16x32_bf16 a[220:223], a[140:143], a[92:95], a[220:223]
v_mfma_f32_16x16x32_bf16 a[228:231], a[136:139], a[96:99], a[228:231]
v_mfma_f32_16x16x32_bf16 a[228:231], a[140:143], a[100:103], a[228:231]
buffer_load_dwordx4 v18, s[12:15], s26 offen offset:2048 lds
v_mfma_f32_16x16x32_bf16 a[236:239], a[136:139], a[104:107], a[236:239]
v_mfma_f32_16x16x32_bf16 a[236:239], a[140:143], a[108:111], a[236:239]
v_mfma_f32_16x16x32_bf16 a[244:247], a[136:139], a[112:115], a[244:247]
v_mfma_f32_16x16x32_bf16 a[244:247], a[140:143], a[116:119], a[244:247]
buffer_load_dwordx4 v19, s[12:15], s26 offen offset:3072 lds
v_mfma_f32_16x16x32_bf16 a[252:255], a[136:139], a[120:123], a[252:255]
s_add_u32 s26, s26, 524288
v_mfma_f32_16x16x32_bf16 a[252:255], a[140:143], a[124:127], a[252:255]
s_waitcnt lgkmcnt(0)
v_mfma_f32_16x16x32_bf16 v[32:35], a[128:131], a[0:3], v[32:35]
s_add_u32 m0, s29, 114688
ds_read_b64_tr_b16 a[136:137], v5 offset:0
v_mfma_f32_16x16x32_bf16 v[32:35], a[132:135], a[4:7], v[32:35]
buffer_load_dwordx4 v16, s[12:15], s27 offen offset:0 lds
v_mfma_f32_16x16x32_bf16 v[40:43], a[128:131], a[8:11], v[40:43]
ds_read_b64_tr_b16 a[138:139], v5 offset:2048
v_mfma_f32_16x16x32_bf16 v[40:43], a[132:135], a[12:15], v[40:43]
v_mfma_f32_16x16x32_bf16 v[48:51], a[128:131], a[16:19], v[48:51]
ds_read_b64_tr_b16 a[140:141], v5 offset:16384
v_mfma_f32_16x16x32_bf16 v[48:51], a[132:135], a[20:23], v[48:51]
buffer_load_dwordx4 v17, s[12:15], s27 offen offset:1024 lds
v_mfma_f32_16x16x32_bf16 v[56:59], a[128:131], a[24:27], v[56:59]
ds_read_b64_tr_b16 a[142:143], v5 offset:18432
v_mfma_f32_16x16x32_bf16 v[56:59], a[132:135], a[28:31], v[56:59]
v_mfma_f32_16x16x32_bf16 v[64:67], a[128:131], a[32:35], v[64:67]
ds_read_b128 a[64:67], v2 offset:32768
v_mfma_f32_16x16x32_bf16 v[64:67], a[132:135], a[36:39], v[64:67]
buffer_load_dwordx4 v18, s[12:15], s27 offen offset:2048 lds
v_mfma_f32_16x16x32_bf16 v[72:75], a[128:131], a[40:43], v[72:75]
ds_read_b128 a[68:71], v3 offset:32768
v_mfma_f32_16x16x32_bf16 v[72:75], a[132:135], a[44:47], v[72:75]
v_mfma_f32_16x16x32_bf16 v[80:83], a[128:131], a[48:51], v[80:83]
v_mfma_f32_16x16x32_bf16 v[80:83], a[132:135], a[52:55], v[80:83]
buffer_load_dwordx4 v19, s[12:15], s27 offen offset:3072 lds
v_mfma_f32_16x16x32_bf16 v[88:91], a[128:131], a[56:59], v[88:91]
s_add_u32 s27, s27, 524288
ds_read_b128 a[72:75], v2 offset:34816
v_mfma_f32_16x16x32_bf16 v[88:91], a[132:135], a[60:63], v[88:91]
s_waitcnt lgkmcnt(3)
v_mfma_f32_16x16x32_bf16 v[36:39], a[136:139], a[0:3], v[36:39]
s_add_u32 m0, s28, 0
ds_read_b64_tr_b16 a[128:129], v6 offset:0
v_mfma_f32_16x16x32_bf16 v[36:39], a[140:143], a[4:7], v[36:39]
buffer_load_dwordx4 v12, s[8:11], s24 offen offset:0 lds
v_mfma_f32_16x16x32_bf16 v[44:47], a[136:139], a[8:11], v[44:47]
ds_read_b64_tr_b16 a[130:131], v6 offset:2048
v_mfma_f32_16x16x32_bf16 v[44:47], a[140:143], a[12:15], v[44:47]
v_mfma_f32_16x16x32_bf16 v[52:55], a[136:139], a[16:19], v[52:55]
ds_read_b64_tr_b16 a[132:133], v6 offset:16384
v_mfma_f32_16x16x32_bf16 v[52:55], a[140:143], a[20:23], v[52:55]
buffer_load_dwordx4 v13, s[8:11], s24 offen offset:1024 lds
v_mfma_f32_16x16x32_bf16 v[60:63], a[136:139], a[24:27], v[60:63]
ds_read_b64_tr_b16 a[134:135], v6 offset:18432
v_mfma_f32_16x16x32_bf16 v[60:63], a[140:143], a[28:31], v[60:63]
v_mfma_f32_16x16x32_bf16 v[68:71], a[136:139], a[32:35], v[68:71]
ds_read_b128 a[76:79], v3 offset:34816
v_mfma_f32_16x16x32_bf16 v[68:71], a[140:143], a[36:39], v[68:71]
buffer_load_dwordx4 v14, s[8:11], s24 offen offset:2048 lds
v_mfma_f32_16x16x32_bf16 v[76:79], a[136:139], a[40:43], v[76:79]
v_mfma_f32_16x16x32_bf16 v[76:79], a[140:143], a[44:47], v[76:79]
v_mfma_f32_16x16x32_bf16 v[84:87], a[136:139], a[48:51], v[84:87]
ds_read_b128 a[80:83], v2 offset:36864
v_mfma_f32_16x16x32_bf16 v[84:87], a[140:143], a[52:55], v[84:87]
buffer_load_dwordx4 v15, s[8:11], s24 offen offset:3072 lds
v_mfma_f32_16x16x32_bf16 v[92:95], a[136:139], a[56:59], v[92:95]
s_add_u32 s24, s24, 128
ds_read_b128 a[84:87], v3 offset:36864
v_mfma_f32_16x16x32_bf16 v[92:95], a[140:143], a[60:63], v[92:95]
s_waitcnt lgkmcnt(3)
s_mov_b64 s[12:13], s[80:81]
v_mfma_f32_16x16x32_bf16 v[96:99], a[128:131], a[0:3], v[96:99]
s_mov_b32 s14, 3670016
s_add_u32 m0, s28, 16384
ds_read_b64_tr_b16 a[136:137], v7 offset:0
v_mfma_f32_16x16x32_bf16 v[96:99], a[132:135], a[4:7], v[96:99]
buffer_load_dwordx4 v12, s[8:11], s24 offen offset:0 lds
v_mfma_f32_16x16x32_bf16 v[104:107], a[128:131], a[8:11], v[104:107]
ds_read_b64_tr_b16 a[138:139], v7 offset:2048
v_mfma_f32_16x16x32_bf16 v[104:107], a[132:135], a[12:15], v[104:107]
v_mfma_f32_16x16x32_bf16 v[112:115], a[128:131], a[16:19], v[112:115]
ds_read_b64_tr_b16 a[140:141], v7 offset:16384
v_mfma_f32_16x16x32_bf16 v[112:115], a[132:135], a[20:23], v[112:115]
buffer_load_dwordx4 v13, s[8:11], s24 offen offset:1024 lds
v_mfma_f32_16x16x32_bf16 v[120:123], a[128:131], a[24:27], v[120:123]
ds_read_b64_tr_b16 a[142:143], v7 offset:18432
v_mfma_f32_16x16x32_bf16 v[120:123], a[132:135], a[28:31], v[120:123]
v_mfma_f32_16x16x32_bf16 v[128:131], a[128:131], a[32:35], v[128:131]
v_mfma_f32_16x16x32_bf16 v[128:131], a[132:135], a[36:39], v[128:131]
buffer_load_dwordx4 v14, s[8:11], s24 offen offset:2048 lds
v_mfma_f32_16x16x32_bf16 v[136:139], a[128:131], a[40:43], v[136:139]
ds_read_b128 a[88:91], v2 offset:38912
v_mfma_f32_16x16x32_bf16 v[136:139], a[132:135], a[44:47], v[136:139]
v_mfma_f32_16x16x32_bf16 v[144:147], a[128:131], a[48:51], v[144:147]
ds_read_b128 a[92:95], v3 offset:38912
v_mfma_f32_16x16x32_bf16 v[144:147], a[132:135], a[52:55], v[144:147]
buffer_load_dwordx4 v15, s[8:11], s24 offen offset:3072 lds
v_mfma_f32_16x16x32_bf16 v[152:155], a[128:131], a[56:59], v[152:155]
s_add_u32 s24, s24, 128
v_mfma_f32_16x16x32_bf16 v[152:155], a[132:135], a[60:63], v[152:155]
s_waitcnt lgkmcnt(2)
s_sub_u32 s26, s26, 8388608
v_mfma_f32_16x16x32_bf16 v[100:103], a[136:139], a[0:3], v[100:103]
s_sub_u32 s27, s27, 8388608
s_add_u32 m0, s29, 131072
ds_read_b64_tr_b16 a[128:129], v8 offset:0
v_mfma_f32_16x16x32_bf16 v[100:103], a[140:143], a[4:7], v[100:103]
buffer_load_dwordx4 v16, s[12:15], s26 offen offset:0 lds
v_mfma_f32_16x16x32_bf16 v[108:111], a[136:139], a[8:11], v[108:111]
ds_read_b64_tr_b16 a[130:131], v8 offset:2048
v_mfma_f32_16x16x32_bf16 v[108:111], a[140:143], a[12:15], v[108:111]
PAD_5:
s_cbranch_execz M_tret
v_mfma_f32_16x16x32_bf16 v[116:119], a[136:139], a[16:19], v[116:119]
ds_read_b64_tr_b16 a[132:133], v8 offset:16384
v_mfma_f32_16x16x32_bf16 v[116:119], a[140:143], a[20:23], v[116:119]
buffer_load_dwordx4 v17, s[12:15], s26 offen offset:1024 lds
v_mfma_f32_16x16x32_bf16 v[124:127], a[136:139], a[24:27], v[124:127]
ds_read_b64_tr_b16 a[134:135], v8 offset:18432
v_mfma_f32_16x16x32_bf16 v[124:127], a[140:143], a[28:31], v[124:127]
v_mfma_f32_16x16x32_bf16 v[132:135], a[136:139], a[32:35], v[132:135]
ds_read_b128 a[96:99], v2 offset:40960
v_mfma_f32_16x16x32_bf16 v[132:135], a[140:143], a[36:39], v[132:135]
buffer_load_dwordx4 v18, s[12:15], s26 offen offset:2048 lds
v_mfma_f32_16x16x32_bf16 v[140:143], a[136:139], a[40:43], v[140:143]
v_mfma_f32_16x16x32_bf16 v[140:143], a[140:143], a[44:47], v[140:143]
v_mfma_f32_16x16x32_bf16 v[148:151], a[136:139], a[48:51], v[148:151]
ds_read_b128 a[100:103], v3 offset:40960
v_mfma_f32_16x16x32_bf16 v[148:151], a[140:143], a[52:55], v[148:151]
buffer_load_dwordx4 v19, s[12:15], s26 offen offset:3072 lds
v_mfma_f32_16x16x32_bf16 v[156:159], a[136:139], a[56:59], v[156:159]
s_add_u32 s26, s26, 524288
ds_read_b128 a[104:107], v2 offset:43008
v_mfma_f32_16x16x32_bf16 v[156:159], a[140:143], a[60:63], v[156:159]
s_waitcnt lgkmcnt(3)
v_mfma_f32_16x16x32_bf16 v[160:163], a[128:131], a[0:3], v[160:163]
s_add_u32 m0, s29, 147456
ds_read_b64_tr_b16 a[136:137], v9 offset:0
v_mfma_f32_16x16x32_bf16 v[160:163], a[132:135], a[4:7], v[160:163]
buffer_load_dwordx4 v16, s[12:15], s27 offen offset:0 lds
v_mfma_f32_16x16x32_bf16 v[168:171], a[128:131], a[8:11], v[168:171]
ds_read_b64_tr_b16 a[138:139], v9 offset:2048
v_mfma_f32_16x16x32_bf16 v[168:171], a[132:135], a[12:15], v[168:171]
v_mfma_f32_16x16x32_bf16 v[176:179], a[128:131], a[16:19], v[176:179]
ds_read_b64_tr_b16 a[140:141], v9 offset:16384
v_mfma_f32_16x16x32_bf16 v[176:179], a[132:135], a[20:23], v[176:179]
buffer_load_dwordx4 v17, s[12:15], s27 offen offset:1024 lds
v_mfma_f32_16x16x32_bf16 v[184:187], a[128:131], a[24:27], v[184:187]
ds_read_b64_tr_b16 a[142:143], v9 offset:18432
v_mfma_f32_16x16x32_bf16 v[184:187], a[132:135], a[28:31], v[184:187]
v_mfma_f32_16x16x32_bf16 v[192:195], a[128:131], a[32:35], v[192:195]
v_mfma_f32_16x16x32_bf16 v[192:195], a[132:135], a[36:39], v[192:195]
buffer_load_dwordx4 v18, s[12:15], s27 offen offset:2048 lds
v_mfma_f32_16x16x32_bf16 v[200:203], a[128:131], a[40:43], v[200:203]
ds_read_b128 a[108:111], v3 offset:43008
v_mfma_f32_16x16x32_bf16 v[200:203], a[132:135], a[44:47], v[200:203]
v_mfma_f32_16x16x32_bf16 v[208:211], a[128:131], a[48:51], v[208:211]
ds_read_b128 a[112:115], v2 offset:45056
v_mfma_f32_16x16x32_bf16 v[208:211], a[132:135], a[52:55], v[208:211]
buffer_load_dwordx4 v19, s[12:15], s27 offen offset:3072 lds
v_mfma_f32_16x16x32_bf16 v[216:219], a[128:131], a[56:59], v[216:219]
s_add_u32 s27, s27, 524288
v_mfma_f32_16x16x32_bf16 v[216:219], a[132:135], a[60:63], v[216:219]
s_waitcnt lgkmcnt(2)
v_mfma_f32_16x16x32_bf16 v[164:167], a[136:139], a[0:3], v[164:167]
ds_read_b64_tr_b16 a[128:129], v10 offset:0
v_mfma_f32_16x16x32_bf16 v[164:167], a[140:143], a[4:7], v[164:167]
v_mfma_f32_16x16x32_bf16 v[172:175], a[136:139], a[8:11], v[172:175]
ds_read_b64_tr_b16 a[130:131], v10 offset:2048
v_mfma_f32_16x16x32_bf16 v[172:175], a[140:143], a[12:15], v[172:175]
v_mfma_f32_16x16x32_bf16 v[180:183], a[136:139], a[16:19], v[180:183]
ds_read_b64_tr_b16 a[132:133], v10 offset:16384
v_mfma_f32_16x16x32_bf16 v[180:183], a[140:143], a[20:23], v[180:183]
v_mfma_f32_16x16x32_bf16 v[188:191], a[136:139], a[24:27], v[188:191]
ds_read_b64_tr_b16 a[134:135], v10 offset:18432
v_mfma_f32_16x16x32_bf16 v[188:191], a[140:143], a[28:31], v[188:191]
v_mfma_f32_16x16x32_bf16 v[196:199], a[136:139], a[32:35], v[196:199]
ds_read_b128 a[116:119], v3 offset:45056
v_mfma_f32_16x16x32_bf16 v[196:199], a[140:143], a[36:39], v[196:199]
v_mfma_f32_16x16x32_bf16 v[204:207], a[136:139], a[40:43], v[204:207]
ds_read_b128 a[120:123], v2 offset:47104
v_mfma_f32_16x16x32_bf16 v[204:207], a[140:143], a[44:47], v[204:207]
v_mfma_f32_16x16x32_bf16 v[212:215], a[136:139], a[48:51], v[212:215]
v_mfma_f32_16x16x32_bf16 v[212:215], a[140:143], a[52:55], v[212:215]
v_mfma_f32_16x16x32_bf16 v[220:223], a[136:139], a[56:59], v[220:223]
ds_read_b128 a[124:127], v3 offset:47104
v_mfma_f32_16x16x32_bf16 v[220:223], a[140:143], a[60:63], v[220:223]
s_waitcnt lgkmcnt(3)
v_mfma_f32_16x16x32_bf16 a[192:195], a[128:131], a[0:3], a[192:195]
ds_read_b64_tr_b16 a[136:137], v11 offset:0
v_mfma_f32_16x16x32_bf16 a[192:195], a[132:135], a[4:7], a[192:195]
v_mfma_f32_16x16x32_bf16 a[200:203], a[128:131], a[8:11], a[200:203]
ds_read_b64_tr_b16 a[138:139], v11 offset:2048
v_mfma_f32_16x16x32_bf16 a[200:203], a[132:135], a[12:15], a[200:203]
v_mfma_f32_16x16x32_bf16 a[208:211], a[128:131], a[16:19], a[208:211]
ds_read_b64_tr_b16 a[140:141], v11 offset:16384
v_mfma_f32_16x16x32_bf16 a[208:211], a[132:135], a[20:23], a[208:211]
v_mfma_f32_16x16x32_bf16 a[216:219], a[128:131], a[24:27], a[216:219]
ds_read_b64_tr_b16 a[142:143], v11 offset:18432
v_mfma_f32_16x16x32_bf16 a[216:219], a[132:135], a[28:31], a[216:219]
v_mfma_f32_16x16x32_bf16 a[224:227], a[128:131], a[32:35], a[224:227]
v_mfma_f32_16x16x32_bf16 a[224:227], a[132:135], a[36:39], a[224:227]
v_mfma_f32_16x16x32_bf16 a[232:235], a[128:131], a[40:43], a[232:235]
v_mfma_f32_16x16x32_bf16 a[232:235], a[132:135], a[44:47], a[232:235]
v_mfma_f32_16x16x32_bf16 a[240:243], a[128:131], a[48:51], a[240:243]
v_mfma_f32_16x16x32_bf16 a[240:243], a[132:135], a[52:55], a[240:243]
v_mfma_f32_16x16x32_bf16 a[248:251], a[128:131], a[56:59], a[248:251]
s_waitcnt vmcnt(12) lgkmcnt(0)
v_mfma_f32_16x16x32_bf16 a[248:251], a[132:135], a[60:63], a[248:251]
s_barrier
v_mfma_f32_16x16x32_bf16 a[196:199], a[136:139], a[0:3], a[196:199]
s_add_u32 m0, s28, 32768
ds_read_b64_tr_b16 a[128:129], v4 offset:32768
v_mfma_f32_16x16x32_bf16 a[196:199], a[140:143], a[4:7], a[196:199]
s_lshr_b32 s22, s3, 1
buffer_load_dwordx4 v12, s[8:11], s24 offen offset:0 lds
v_mfma_f32_16x16x32_bf16 a[204:207], a[136:139], a[8:11], a[204:207]
s_lshl_b32 s22, s22, 14
ds_read_b64_tr_b16 a[130:131], v4 offset:34816
v_subrev_u32 v2, s22, v2
v_mfma_f32_16x16x32_bf16 a[204:207], a[140:143], a[12:15], a[204:207]
v_subrev_u32 v3, s22, v3
v_mfma_f32_16x16x32_bf16 a[212:215], a[136:139], a[16:19], a[212:215]
ds_read_b64_tr_b16 a[132:133], v4 offset:49152
v_mfma_f32_16x16x32_bf16 a[212:215], a[140:143], a[20:23], a[212:215]
buffer_load_dwordx4 v13, s[8:11], s24 offen offset:1024 lds
v_mfma_f32_16x16x32_bf16 a[220:223], a[136:139], a[24:27], a[220:223]
ds_read_b64_tr_b16 a[134:135], v4 offset:51200
v_mfma_f32_16x16x32_bf16 a[220:223], a[140:143], a[28:31], a[220:223]
v_mfma_f32_16x16x32_bf16 a[228:231], a[136:139], a[32:35], a[228:231]
v_mfma_f32_16x16x32_bf16 a[228:231], a[140:143], a[36:39], a[228:231]
buffer_load_dwordx4 v14, s[8:11], s24 offen offset:2048 lds
v_mfma_f32_16x16x32_bf16 a[236:239], a[136:139], a[40:43], a[236:239]
v_mfma_f32_16x16x32_bf16 a[236:239], a[140:143], a[44:47], a[236:239]
v_mfma_f32_16x16x32_bf16 a[244:247], a[136:139], a[48:51], a[244:247]
v_mfma_f32_16x16x32_bf16 a[244:247], a[140:143], a[52:55], a[244:247]
buffer_load_dwordx4 v15, s[8:11], s24 offen offset:3072 lds
v_mfma_f32_16x16x32_bf16 a[252:255], a[136:139], a[56:59], a[252:255]
s_add_u32 s24, s24, 128
v_mfma_f32_16x16x32_bf16 a[252:255], a[140:143], a[60:63], a[252:255]
s_waitcnt lgkmcnt(0)
v_mfma_f32_16x16x32_bf16 v[32:35], a[128:131], a[64:67], v[32:35]
s_add_u32 m0, s29, 65536
ds_read_b64_tr_b16 a[136:137], v5 offset:32768
v_mfma_f32_16x16x32_bf16 v[32:35], a[132:135], a[68:71], v[32:35]
buffer_load_dwordx4 v16, s[12:15], s26 offen offset:0 lds
v_mfma_f32_16x16x32_bf16 v[40:43], a[128:131], a[72:75], v[40:43]
ds_read_b64_tr_b16 a[138:139], v5 offset:34816
v_mfma_f32_16x16x32_bf16 v[40:43], a[132:135], a[76:79], v[40:43]
v_mfma_f32_16x16x32_bf16 v[48:51], a[128:131], a[80:83], v[48:51]
ds_read_b64_tr_b16 a[140:141], v5 offset:49152
v_mfma_f32_16x16x32_bf16 v[48:51], a[132:135], a[84:87], v[48:51]
buffer_load_dwordx4 v17, s[12:15], s26 offen offset:1024 lds
v_mfma_f32_16x16x32_bf16 v[56:59], a[128:131], a[88:91], v[56:59]
ds_read_b64_tr_b16 a[142:143], v5 offset:51200
v_mfma_f32_16x16x32_bf16 v[56:59], a[132:135], a[92:95], v[56:59]
v_mfma_f32_16x16x32_bf16 v[64:67], a[128:131], a[96:99], v[64:67]
ds_read_b128 a[0:3], v2 offset:0
v_mfma_f32_16x16x32_bf16 v[64:67], a[132:135], a[100:103], v[64:67]
buffer_load_dwordx4 v18, s[12:15], s26 offen offset:2048 lds
v_mfma_f32_16x16x32_bf16 v[72:75], a[128:131], a[104:107], v[72:75]
ds_read_b128 a[4:7], v3 offset:0
v_mfma_f32_16x16x32_bf16 v[72:75], a[132:135], a[108:111], v[72:75]
v_mfma_f32_16x16x32_bf16 v[80:83], a[128:131], a[112:115], v[80:83]
v_mfma_f32_16x16x32_bf16 v[80:83], a[132:135], a[116:119], v[80:83]
buffer_load_dwordx4 v19, s[12:15], s26 offen offset:3072 lds
v_mfma_f32_16x16x32_bf16 v[88:91], a[128:131], a[120:123], v[88:91]
s_add_u32 s26, s26, 524288
ds_read_b128 a[8:11], v2 offset:2048
v_mfma_f32_16x16x32_bf16 v[88:91], a[132:135], a[124:127], v[88:91]
s_waitcnt lgkmcnt(3)
v_mfma_f32_16x16x32_bf16 v[36:39], a[136:139], a[64:67], v[36:39]
s_add_u32 m0, s29, 81920
ds_read_b64_tr_b16 a[128:129], v6 offset:32768
v_mfma_f32_16x16x32_bf16 v[36:39], a[140:143], a[68:71], v[36:39]
buffer_load_dwordx4 v16, s[12:15], s27 offen offset:0 lds
v_mfma_f32_16x16x32_bf16 v[44:47], a[136:139], a[72:75], v[44:47]
ds_read_b64_tr_b16 a[130:131], v6 offset:34816
v_mfma_f32_16x16x32_bf16 v[44:47], a[140:143], a[76:79], v[44:47]
v_mfma_f32_16x16x32_bf16 v[52:55], a[136:139], a[80:83], v[52:55]
ds_read_b64_tr_b16 a[132:133], v6 offset:49152
v_mfma_f32_16x16x32_bf16 v[52:55], a[140:143], a[84:87], v[52:55]
buffer_load_dwordx4 v17, s[12:15], s27 offen offset:1024 lds
v_mfma_f32_16x16x32_bf16 v[60:63], a[136:139], a[88:91], v[60:63]
ds_read_b64_tr_b16 a[134:135], v6 offset:51200
v_cvt_pk_bf16_f32 v32, v32, v33
v_mfma_f32_16x16x32_bf16 v[60:63], a[140:143], a[92:95], v[60:63]
v_cvt_pk_bf16_f32 v33, v34, v35
v_cvt_pk_bf16_f32 v34, v36, v37
v_mfma_f32_16x16x32_bf16 v[68:71], a[136:139], a[96:99], v[68:71]
ds_read_b128 a[12:15], v3 offset:2048
v_cvt_pk_bf16_f32 v35, v38, v39
v_mfma_f32_16x16x32_bf16 v[68:71], a[140:143], a[100:103], v[68:71]
buffer_load_dwordx4 v18, s[12:15], s27 offen offset:2048 lds
v_mfma_f32_16x16x32_bf16 v[76:79], a[136:139], a[104:107], v[76:79]
v_cvt_pk_bf16_f32 v40, v40, v41
v_cvt_pk_bf16_f32 v41, v42, v43
v_mfma_f32_16x16x32_bf16 v[76:79], a[140:143], a[108:111], v[76:79]
v_cvt_pk_bf16_f32 v42, v44, v45
v_cvt_pk_bf16_f32 v43, v46, v47
v_mfma_f32_16x16x32_bf16 v[84:87], a[136:139], a[112:115], v[84:87]
ds_read_b128 a[16:19], v2 offset:4096
v_cvt_pk_bf16_f32 v48, v48, v49
v_mfma_f32_16x16x32_bf16 v[84:87], a[140:143], a[116:119], v[84:87]
buffer_load_dwordx4 v19, s[12:15], s27 offen offset:3072 lds
v_mfma_f32_16x16x32_bf16 v[92:95], a[136:139], a[120:123], v[92:95]
s_add_u32 s27, s27, 524288
ds_read_b128 a[20:23], v3 offset:4096
v_cvt_pk_bf16_f32 v49, v50, v51
v_mfma_f32_16x16x32_bf16 v[92:95], a[140:143], a[124:127], v[92:95]
s_waitcnt lgkmcnt(3)
v_cvt_pk_bf16_f32 v50, v52, v53
v_cvt_pk_bf16_f32 v51, v54, v55
v_mfma_f32_16x16x32_bf16 v[96:99], a[128:131], a[64:67], v[96:99]
s_add_u32 m0, s28, 49152
ds_read_b64_tr_b16 a[136:137], v7 offset:32768
v_cvt_pk_bf16_f32 v56, v56, v57
v_mfma_f32_16x16x32_bf16 v[96:99], a[132:135], a[68:71], v[96:99]
buffer_load_dwordx4 v12, s[8:11], s24 offen offset:0 lds
v_mfma_f32_16x16x32_bf16 v[104:107], a[128:131], a[72:75], v[104:107]
ds_read_b64_tr_b16 a[138:139], v7 offset:34816
v_cvt_pk_bf16_f32 v57, v58, v59
v_mfma_f32_16x16x32_bf16 v[104:107], a[132:135], a[76:79], v[104:107]
v_cvt_pk_bf16_f32 v58, v60, v61
v_cvt_pk_bf16_f32 v59, v62, v63
v_mfma_f32_16x16x32_bf16 v[112:115], a[128:131], a[80:83], v[112:115]
ds_read_b64_tr_b16 a[140:141], v7 offset:49152
v_cvt_pk_bf16_f32 v64, v64, v65
v_mfma_f32_16x16x32_bf16 v[112:115], a[132:135], a[84:87], v[112:115]
buffer_load_dwordx4 v13, s[8:11], s24 offen offset:1024 lds
v_mfma_f32_16x16x32_bf16 v[120:123], a[128:131], a[88:91], v[120:123]
ds_read_b64_tr_b16 a[142:143], v7 offset:51200
v_cvt_pk_bf16_f32 v65, v66, v67
v_mfma_f32_16x16x32_bf16 v[120:123], a[132:135], a[92:95], v[120:123]
v_cvt_pk_bf16_f32 v66, v68, v69
v_cvt_pk_bf16_f32 v67, v70, v71
v_mfma_f32_16x16x32_bf16 v[128:131], a[128:131], a[96:99], v[128:131]
v_cvt_pk_bf16_f32 v72, v72, v73
v_cvt_pk_bf16_f32 v73, v74, v75
v_mfma_f32_16x16x32_bf16 v[128:131], a[132:135], a[100:103], v[128:131]
buffer_load_dwordx4 v14, s[8:11], s24 offen offset:2048 lds
v_mfma_f32_16x16x32_bf16 v[136:139], a[128:131], a[104:107], v[136:139]
ds_read_b128 a[24:27], v2 offset:6144
v_cvt_pk_bf16_f32 v74, v76, v77
v_mfma_f32_16x16x32_bf16 v[136:139], a[132:135], a[108:111], v[136:139]
buffer_store_dwordx4 v[32:35], v1, s[4:7], s31 offen sc1
v_mfma_f32_16x16x32_bf16 v[144:147], a[128:131], a[112:115], v[144:147]
s_add_u32 s31, s31, s32
ds_read_b128 a[28:31], v3 offset:6144
v_cvt_pk_bf16_f32 v75, v78, v79
v_mfma_f32_16x16x32_bf16 v[144:147], a[132:135], a[116:119], v[144:147]
buffer_load_dwordx4 v15, s[8:11], s24 offen offset:3072 lds
v_mfma_f32_16x16x32_bf16 v[152:155], a[128:131], a[120:123], v[152:155]
s_add_u32 s24, s24, 128
v_cvt_pk_bf16_f32 v80, v80, v81
v_cvt_pk_bf16_f32 v81, v82, v83
v_mfma_f32_16x16x32_bf16 v[152:155], a[132:135], a[124:127], v[152:155]
s_waitcnt lgkmcnt(2)
v_cvt_pk_bf16_f32 v82, v84, v85
v_cvt_pk_bf16_f32 v83, v86, v87
v_mfma_f32_16x16x32_bf16 v[100:103], a[136:139], a[64:67], v[100:103]
ds_read_b64_tr_b16 a[128:129], v8 offset:32768
v_cvt_pk_bf16_f32 v88, v88, v89
v_mfma_f32_16x16x32_bf16 v[100:103], a[140:143], a[68:71], v[100:103]
v_cvt_pk_bf16_f32 v89, v90, v91
v_cvt_pk_bf16_f32 v90, v92, v93
v_mfma_f32_16x16x32_bf16 v[108:111], a[136:139], a[72:75], v[108:111]
ds_read_b64_tr_b16 a[130:131], v8 offset:34816
v_cvt_pk_bf16_f32 v91, v94, v95
v_mfma_f32_16x16x32_bf16 v[108:111], a[140:143], a[76:79], v[108:111]
buffer_store_dwordx4 v[40:43], v1, s[4:7], s31 offen sc1
v_mfma_f32_16x16x32_bf16 v[116:119], a[136:139], a[80:83], v[116:119]
s_add_u32 s31, s31, s33
ds_read_b64_tr_b16 a[132:133], v8 offset:49152
v_mfma_f32_16x16x32_bf16 v[116:119], a[140:143], a[84:87], v[116:119]
v_mfma_f32_16x16x32_bf16 v[124:127], a[136:139], a[88:91], v[124:127]
ds_read_b64_tr_b16 a[134:135], v8 offset:51200
v_cvt_pk_bf16_f32 v96, v96, v97
v_mfma_f32_16x16x32_bf16 v[124:127], a[140:143], a[92:95], v[124:127]
v_cvt_pk_bf16_f32 v97, v98, v99
v_cvt_pk_bf16_f32 v98, v100, v101
v_mfma_f32_16x16x32_bf16 v[132:135], a[136:139], a[96:99], v[132:135]
ds_read_b128 a[32:35], v2 offset:8192
v_cvt_pk_bf16_f32 v99, v102, v103
v_mfma_f32_16x16x32_bf16 v[132:135], a[140:143], a[100:103], v[132:135]
v_cvt_pk_bf16_f32 v104, v104, v105
v_cvt_pk_bf16_f32 v105, v106, v107
v_mfma_f32_16x16x32_bf16 v[140:143], a[136:139], a[104:107], v[140:143]
v_cvt_pk_bf16_f32 v106, v108, v109
v_cvt_pk_bf16_f32 v107, v110, v111
v_mfma_f32_16x16x32_bf16 v[140:143], a[140:143], a[108:111], v[140:143]
v_cvt_pk_bf16_f32 v112, v112, v113
v_cvt_pk_bf16_f32 v113, v114, v115
v_mfma_f32_16x16x32_bf16 v[148:151], a[136:139], a[112:115], v[148:151]
ds_read_b128 a[36:39], v3 offset:8192
v_cvt_pk_bf16_f32 v114, v116, v117
v_mfma_f32_16x16x32_bf16 v[148:151], a[140:143], a[116:119], v[148:151]
v_cvt_pk_bf16_f32 v115, v118, v119
v_cvt_pk_bf16_f32 v120, v120, v121
v_mfma_f32_16x16x32_bf16 v[156:159], a[136:139], a[120:123], v[156:159]
ds_read_b128 a[40:43], v2 offset:10240
v_cvt_pk_bf16_f32 v121, v122, v123
v_mfma_f32_16x16x32_bf16 v[156:159], a[140:143], a[124:127], v[156:159]
s_waitcnt lgkmcnt(3)
buffer_store_dwordx4 v[48:51], v1, s[4:7], s31 offen sc1
v_mfma_f32_16x16x32_bf16 v[160:163], a[128:131], a[64:67], v[160:163]
s_add_u32 s31, s31, s32
ds_read_b64_tr_b16 a[136:137], v9 offset:32768
v_cvt_pk_bf16_f32 v122, v124, v125
v_mfma_f32_16x16x32_bf16 v[160:163], a[132:135], a[68:71], v[160:163]
v_cvt_pk_bf16_f32 v123, v126, v127
v_cvt_pk_bf16_f32 v128, v128, v129
v_mfma_f32_16x16x32_bf16 v[168:171], a[128:131], a[72:75], v[168:171]
ds_read_b64_tr_b16 a[138:139], v9 offset:34816
v_cvt_pk_bf16_f32 v129, v130, v131
v_mfma_f32_16x16x32_bf16 v[168:171], a[132:135], a[76:79], v[168:171]
v_cvt_pk_bf16_f32 v130, v132, v133
v_cvt_pk_bf16_f32 v131, v134, v135
v_mfma_f32_16x16x32_bf16 v[176:179], a[128:131], a[80:83], v[176:179]
ds_read_b64_tr_b16 a[140:141], v9 offset:49152
v_cvt_pk_bf16_f32 v136, v136, v137
v_mfma_f32_16x16x32_bf16 v[176:179], a[132:135], a[84:87], v[176:179]
v_cvt_pk_bf16_f32 v137, v138, v139
v_cvt_pk_bf16_f32 v138, v140, v141
v_mfma_f32_16x16x32_bf16 v[184:187], a[128:131], a[88:91], v[184:187]
ds_read_b64_tr_b16 a[142:143], v9 offset:51200
v_cvt_pk_bf16_f32 v139, v142, v143
v_mfma_f32_16x16x32_bf16 v[184:187], a[132:135], a[92:95], v[184:187]
v_cvt_pk_bf16_f32 v144, v144, v145
v_cvt_pk_bf16_f32 v145, v146, v147
v_mfma_f32_16x16x32_bf16 v[192:195], a[128:131], a[96:99], v[192:195]
buffer_store_dwordx4 v[56:59], v1, s[4:7], s31 offen sc1
v_mfma_f32_16x16x32_bf16 v[192:195], a[132:135], a[100:103], v[192:195]
s_add_u32 s31, s31, s34
v_cvt_pk_bf16_f32 v146, v148, v149
v_cvt_pk_bf16_f32 v147, v150, v151
v_mfma_f32_16x16x32_bf16 v[200:203], a[128:131], a[104:107], v[200:203]
ds_read_b128 a[44:47], v3 offset:10240
v_cvt_pk_bf16_f32 v152, v152, v153
v_mfma_f32_16x16x32_bf16 v[200:203], a[132:135], a[108:111], v[200:203]
v_cvt_pk_bf16_f32 v153, v154, v155
v_cvt_pk_bf16_f32 v154, v156, v157
v_mfma_f32_16x16x32_bf16 v[208:211], a[128:131], a[112:115], v[208:211]
ds_read_b128 a[48:51], v2 offset:12288
v_cvt_pk_bf16_f32 v155, v158, v159
v_mfma_f32_16x16x32_bf16 v[208:211], a[132:135], a[116:119], v[208:211]
v_mfma_f32_16x16x32_bf16 v[216:219], a[128:131], a[120:123], v[216:219]
v_mfma_f32_16x16x32_bf16 v[216:219], a[132:135], a[124:127], v[216:219]
s_waitcnt lgkmcnt(2)
v_mfma_f32_16x16x32_bf16 v[164:167], a[136:139], a[64:67], v[164:167]
ds_read_b64_tr_b16 a[128:129], v10 offset:32768
v_mfma_f32_16x16x32_bf16 v[164:167], a[140:143], a[68:71], v[164:167]
v_mfma_f32_16x16x32_bf16 v[172:175], a[136:139], a[72:75], v[172:175]
ds_read_b64_tr_b16 a[130:131], v10 offset:34816
v_mfma_f32_16x16x32_bf16 v[172:175], a[140:143], a[76:79], v[172:175]
buffer_store_dwordx4 v[64:67], v1, s[4:7], s31 offen sc1
v_mfma_f32_16x16x32_bf16 v[180:183], a[136:139], a[80:83], v[180:183]
s_add_u32 s31, s31, s32
ds_read_b64_tr_b16 a[132:133], v10 offset:49152
v_mfma_f32_16x16x32_bf16 v[180:183], a[140:143], a[84:87], v[180:183]
v_mfma_f32_16x16x32_bf16 v[188:191], a[136:139], a[88:91], v[188:191]
ds_read_b64_tr_b16 a[134:135], v10 offset:51200
v_cvt_pk_bf16_f32 v160, v160, v161
v_mfma_f32_16x16x32_bf16 v[188:191], a[140:143], a[92:95], v[188:191]
v_cvt_pk_bf16_f32 v161, v162, v163
v_cvt_pk_bf16_f32 v162, v164, v165
v_mfma_f32_16x16x32_bf16 v[196:199], a[136:139], a[96:99], v[196:199]
ds_read_b128 a[52:55], v3 offset:12288
v_cvt_pk_bf16_f32 v163, v166, v167
v_mfma_f32_16x16x32_bf16 v[196:199], a[140:143], a[100:103], v[196:199]
v_cvt_pk_bf16_f32 v168, v168, v169
v_cvt_pk_bf16_f32 v169, v170, v171
v_mfma_f32_16x16x32_bf16 v[204:207], a[136:139], a[104:107], v[204:207]
ds_read_b128 a[56:59], v2 offset:14336
v_cvt_pk_bf16_f32 v170, v172, v173
v_mfma_f32_16x16x32_bf16 v[204:207], a[140:143], a[108:111], v[204:207]
v_cvt_pk_bf16_f32 v171, v174, v175
v_cvt_pk_bf16_f32 v176, v176, v177
v_mfma_f32_16x16x32_bf16 v[212:215], a[136:139], a[112:115], v[212:215]
v_cvt_pk_bf16_f32 v177, v178, v179
v_cvt_pk_bf16_f32 v178, v180, v181
v_mfma_f32_16x16x32_bf16 v[212:215], a[140:143], a[116:119], v[212:215]
buffer_store_dwordx4 v[72:75], v1, s[4:7], s31 offen sc1
v_mfma_f32_16x16x32_bf16 v[220:223], a[136:139], a[120:123], v[220:223]
s_add_u32 s31, s31, s33
ds_read_b128 a[60:63], v3 offset:14336
v_cvt_pk_bf16_f32 v179, v182, v183
v_mfma_f32_16x16x32_bf16 v[220:223], a[140:143], a[124:127], v[220:223]
s_waitcnt lgkmcnt(3)
v_cvt_pk_bf16_f32 v184, v184, v185
v_cvt_pk_bf16_f32 v185, v186, v187
v_mfma_f32_16x16x32_bf16 a[192:195], a[128:131], a[64:67], a[192:195]
ds_read_b64_tr_b16 a[136:137], v11 offset:32768
v_cvt_pk_bf16_f32 v186, v188, v189
v_mfma_f32_16x16x32_bf16 a[192:195], a[132:135], a[68:71], a[192:195]
v_cvt_pk_bf16_f32 v187, v190, v191
v_cvt_pk_bf16_f32 v192, v192, v193
v_mfma_f32_16x16x32_bf16 a[200:203], a[128:131], a[72:75], a[200:203]
ds_read_b64_tr_b16 a[138:139], v11 offset:34816
v_cvt_pk_bf16_f32 v193, v194, v195
v_mfma_f32_16x16x32_bf16 a[200:203], a[132:135], a[76:79], a[200:203]
v_cvt_pk_bf16_f32 v194, v196, v197
v_cvt_pk_bf16_f32 v195, v198, v199
v_mfma_f32_16x16x32_bf16 a[208:211], a[128:131], a[80:83], a[208:211]
ds_read_b64_tr_b16 a[140:141], v11 offset:49152
v_cvt_pk_bf16_f32 v200, v200, v201
v_mfma_f32_16x16x32_bf16 a[208:211], a[132:135], a[84:87], a[208:211]
v_cvt_pk_bf16_f32 v201, v202, v203
v_cvt_pk_bf16_f32 v202, v204, v205
v_mfma_f32_16x16x32_bf16 a[216:219], a[128:131], a[88:91], a[216:219]
ds_read_b64_tr_b16 a[142:143], v11 offset:51200
v_cvt_pk_bf16_f32 v203, v206, v207
v_mfma_f32_16x16x32_bf16 a[216:219], a[132:135], a[92:95], a[216:219]
v_cvt_pk_bf16_f32 v208, v208, v209
v_cvt_pk_bf16_f32 v209, v210, v211
v_mfma_f32_16x16x32_bf16 a[224:227], a[128:131], a[96:99], a[224:227]
buffer_store_dwordx4 v[80:83], v1, s[4:7], s31 offen sc1
v_mfma_f32_16x16x32_bf16 a[224:227], a[132:135], a[100:103], a[224:227]
s_add_u32 s31, s31, s32
v_cvt_pk_bf16_f32 v210, v212, v213
v_cvt_pk_bf16_f32 v211, v214, v215
v_mfma_f32_16x16x32_bf16 a[232:235], a[128:131], a[104:107], a[232:235]
v_cvt_pk_bf16_f32 v216, v216, v217
v_cvt_pk_bf16_f32 v217, v218, v219
v_mfma_f32_16x16x32_bf16 a[232:235], a[132:135], a[108:111], a[232:235]
v_cvt_pk_bf16_f32 v218, v220, v221
v_cvt_pk_bf16_f32 v219, v222, v223
v_mfma_f32_16x16x32_bf16 a[240:243], a[128:131], a[112:115], a[240:243]
v_mfma_f32_16x16x32_bf16 a[240:243], a[132:135], a[116:119], a[240:243]
v_mfma_f32_16x16x32_bf16 a[248:251], a[128:131], a[120:123], a[248:251]
s_waitcnt vmcnt(23) lgkmcnt(0)
v_mfma_f32_16x16x32_bf16 a[248:251], a[132:135], a[124:127], a[248:251]
s_barrier
v_mfma_f32_16x16x32_bf16 a[196:199], a[136:139], a[64:67], a[196:199]
s_add_u32 m0, s29, 98304
ds_read_b64_tr_b16 a[128:129], v22 offset:0
v_mfma_f32_16x16x32_bf16 a[196:199], a[140:143], a[68:71], a[196:199]
buffer_load_dwordx4 v16, s[12:15], s26 offen offset:0 lds
v_mfma_f32_16x16x32_bf16 a[204:207], a[136:139], a[72:75], a[204:207]
ds_read_b64_tr_b16 a[130:131], v22 offset:2048
v_mfma_f32_16x16x32_bf16 a[204:207], a[140:143], a[76:79], a[204:207]
buffer_store_dwordx4 v[88:91], v1, s[4:7], s31 offen sc1
v_mfma_f32_16x16x32_bf16 a[212:215], a[136:139], a[80:83], a[212:215]
s_add_u32 s31, s31, s35
ds_read_b64_tr_b16 a[132:133], v22 offset:16384
v_mfma_f32_16x16x32_bf16 a[212:215], a[140:143], a[84:87], a[212:215]
buffer_load_dwordx4 v17, s[12:15], s26 offen offset:1024 lds
v_mfma_f32_16x16x32_bf16 a[220:223], a[136:139], a[88:91], a[220:223]
ds_read_b64_tr_b16 a[134:135], v22 offset:18432
v_add_u32 v22, 4294901760, v22
v_mfma_f32_16x16x32_bf16 a[220:223], a[140:143], a[92:95], a[220:223]
v_mfma_f32_16x16x32_bf16 a[228:231], a[136:139], a[96:99], a[228:231]
v_mfma_f32_16x16x32_bf16 a[228:231], a[140:143], a[100:103], a[228:231]
buffer_load_dwordx4 v18, s[12:15], s26 offen offset:2048 lds
v_mfma_f32_16x16x32_bf16 a[236:239], a[136:139], a[104:107], a[236:239]
v_mfma_f32_16x16x32_bf16 a[236:239], a[140:143], a[108:111], a[236:239]
v_mfma_f32_16x16x32_bf16 a[244:247], a[136:139], a[112:115], a[244:247]
v_mfma_f32_16x16x32_bf16 a[244:247], a[140:143], a[116:119], a[244:247]
buffer_load_dwordx4 v19, s[12:15], s26 offen offset:3072 lds
v_mfma_f32_16x16x32_bf16 a[252:255], a[136:139], a[120:123], a[252:255]
s_add_u32 s26, s26, 524288
v_mfma_f32_16x16x32_bf16 a[252:255], a[140:143], a[124:127], a[252:255]
s_waitcnt lgkmcnt(0)
M_Q:
v_mfma_f32_16x16x32_bf16 v[36:39], a[128:131], a[0:3], 0
s_add_u32 m0, s29, 114688
ds_read_b64_tr_b16 a[136:137], v23 offset:0
v_mfma_f32_16x16x32_bf16 v[36:39], a[132:135], a[4:7], v[36:39]
buffer_load_dwordx4 v16, s[12:15], s27 offen offset:0 lds
v_mfma_f32_16x16x32_bf16 v[44:47], a[128:131], a[8:11], 0
ds_read_b64_tr_b16 a[138:139], v23 offset:2048
v_mfma_f32_16x16x32_bf16 v[44:47], a[132:135], a[12:15], v[44:47]
ds_read_b128 a[64:67], v2 offset:16384
ds_read_b128 a[68:71], v3 offset:16384
v_mfma_f32_16x16x32_bf16 v[52:55], a[128:131], a[16:19], 0
ds_read_b64_tr_b16 a[140:141], v23 offset:16384
v_mfma_f32_16x16x32_bf16 v[52:55], a[132:135], a[20:23], v[52:55]
buffer_load_dwordx4 v17, s[12:15], s27 offen offset:1024 lds
v_mfma_f32_16x16x32_bf16 v[60:63], a[128:131], a[24:27], 0
ds_read_b64_tr_b16 a[142:143], v23 offset:18432
v_add_u32 v23, 4294901760, v23
v_mfma_f32_16x16x32_bf16 v[60:63], a[132:135], a[28:31], v[60:63]
buffer_store_dwordx4 v[96:99], v1, s[4:7], s31 offen sc1
v_mfma_f32_16x16x32_bf16 v[68:71], a[128:131], a[32:35], 0
s_add_u32 s31, s31, s32
ds_read_b128 a[72:75], v2 offset:18432
v_mfma_f32_16x16x32_bf16 v[68:71], a[132:135], a[36:39], v[68:71]
buffer_load_dwordx4 v18, s[12:15], s27 offen offset:2048 lds
v_mfma_f32_16x16x32_bf16 v[76:79], a[128:131], a[40:43], 0
ds_read_b128 a[76:79], v3 offset:18432
v_mfma_f32_16x16x32_bf16 v[76:79], a[132:135], a[44:47], v[76:79]
ds_read_b128 a[80:83], v2 offset:20480
v_mfma_f32_16x16x32_bf16 v[84:87], a[128:131], a[48:51], 0
ds_read_b128 a[84:87], v3 offset:20480
v_mfma_f32_16x16x32_bf16 v[84:87], a[132:135], a[52:55], v[84:87]
buffer_load_dwordx4 v19, s[12:15], s27 offen offset:3072 lds
v_mfma_f32_16x16x32_bf16 v[92:95], a[128:131], a[56:59], 0
s_add_u32 s27, s27, 524288
ds_read_b128 a[88:91], v2 offset:22528
v_mfma_f32_16x16x32_bf16 v[92:95], a[132:135], a[60:63], v[92:95]
s_waitcnt lgkmcnt(5)
buffer_store_dwordx4 v[104:107], v1, s[4:7], s31 offen sc1
v_mfma_f32_16x16x32_bf16 v[100:103], a[136:139], a[0:3], 0
s_add_u32 m0, s28, 0
ds_read_b64_tr_b16 a[128:129], v24 offset:0
v_mfma_f32_16x16x32_bf16 v[100:103], a[140:143], a[4:7], v[100:103]
s_add_u32 s31, s31, s33
buffer_load_dwordx4 v12, s[8:11], s24 offen offset:0 lds
v_mfma_f32_16x16x32_bf16 v[108:111], a[136:139], a[8:11], 0
ds_read_b64_tr_b16 a[130:131], v24 offset:2048
v_mfma_f32_16x16x32_bf16 v[108:111], a[140:143], a[12:15], v[108:111]
ds_read_b128 a[92:95], v3 offset:22528
v_mfma_f32_16x16x32_bf16 v[116:119], a[136:139], a[16:19], 0
ds_read_b64_tr_b16 a[132:133], v24 offset:16384
v_mfma_f32_16x16x32_bf16 v[116:119], a[140:143], a[20:23], v[116:119]
buffer_load_dwordx4 v13, s[8:11], s24 offen offset:1024 lds
v_mfma_f32_16x16x32_bf16 v[124:127], a[136:139], a[24:27], 0
ds_read_b64_tr_b16 a[134:135], v24 offset:18432
v_add_u32 v24, 4294901760, v24
v_mfma_f32_16x16x32_bf16 v[124:127], a[140:143], a[28:31], v[124:127]
v_mfma_f32_16x16x32_bf16 v[132:135], a[136:139], a[32:35], 0
ds_read_b128 a[96:99], v2 offset:24576
v_mfma_f32_16x16x32_bf16 v[132:135], a[140:143], a[36:39], v[132:135]
buffer_load_dwordx4 v14, s[8:11], s24 offen offset:2048 lds
v_mfma_f32_16x16x32_bf16 v[140:143], a[136:139], a[40:43], 0
ds_read_b128 a[100:103], v3 offset:24576
v_mfma_f32_16x16x32_bf16 v[140:143], a[140:143], a[44:47], v[140:143]
ds_read_b128 a[104:107], v2 offset:26624
v_mfma_f32_16x16x32_bf16 v[148:151], a[136:139], a[48:51], 0
ds_read_b128 a[108:111], v3 offset:26624
v_mfma_f32_16x16x32_bf16 v[148:151], a[140:143], a[52:55], v[148:151]
buffer_load_dwordx4 v15, s[8:11], s24 offen offset:3072 lds
v_mfma_f32_16x16x32_bf16 v[156:159], a[136:139], a[56:59], 0
s_add_u32 s24, s24, 128
ds_read_b128 a[112:115], v2 offset:28672
v_mfma_f32_16x16x32_bf16 v[156:159], a[140:143], a[60:63], v[156:159]
s_waitcnt lgkmcnt(5)
buffer_store_dwordx4 v[112:115], v1, s[4:7], s31 offen sc1
v_mfma_f32_16x16x32_bf16 v[164:167], a[128:131], a[0:3], 0
s_add_u32 s31, s31, s32
ds_read_b64_tr_b16 a[136:137], v25 offset:0
v_mfma_f32_16x16x32_bf16 v[164:167], a[132:135], a[4:7], v[164:167]
PAD_6:
s_cbranch_execz M_tret
v_mfma_f32_16x16x32_bf16 v[172:175], a[128:131], a[8:11], 0
ds_read_b64_tr_b16 a[138:139], v25 offset:2048
v_mfma_f32_16x16x32_bf16 v[172:175], a[132:135], a[12:15], v[172:175]
ds_read_b128 a[116:119], v3 offset:28672
v_mfma_f32_16x16x32_bf16 v[180:183], a[128:131], a[16:19], 0
ds_read_b64_tr_b16 a[140:141], v25 offset:16384
v_mfma_f32_16x16x32_bf16 v[180:183], a[132:135], a[20:23], v[180:183]
v_mfma_f32_16x16x32_bf16 v[188:191], a[128:131], a[24:27], 0
ds_read_b64_tr_b16 a[142:143], v25 offset:18432
v_add_u32 v25, 4294901760, v25
v_mfma_f32_16x16x32_bf16 v[188:191], a[132:135], a[28:31], v[188:191]
v_mfma_f32_16x16x32_bf16 v[196:199], a[128:131], a[32:35], 0
ds_read_b128 a[120:123], v2 offset:30720
v_mfma_f32_16x16x32_bf16 v[196:199], a[132:135], a[36:39], v[196:199]
v_mfma_f32_16x16x32_bf16 v[204:207], a[128:131], a[40:43], 0
ds_read_b128 a[124:127], v3 offset:30720
v_mfma_f32_16x16x32_bf16 v[204:207], a[132:135], a[44:47], v[204:207]
v_mfma_f32_16x16x32_bf16 v[212:215], a[128:131], a[48:51], 0
v_mfma_f32_16x16x32_bf16 v[212:215], a[132:135], a[52:55], v[212:215]
buffer_store_dwordx4 v[120:123], v1, s[4:7], s31 offen sc1
v_mfma_f32_16x16x32_bf16 v[220:223], a[128:131], a[56:59], 0
s_add_u32 s31, s31, s34
v_mfma_f32_16x16x32_bf16 v[220:223], a[132:135], a[60:63], v[220:223]
s_waitcnt vmcnt(28) lgkmcnt(0)
s_barrier
v_mfma_f32_16x16x32_bf16 v[224:227], a[136:139], a[0:3], 0
s_add_u32 m0, s29, 131072
ds_read_b64_tr_b16 a[128:129], v22 offset:0
v_mfma_f32_16x16x32_bf16 v[224:227], a[140:143], a[4:7], v[224:227]
buffer_load_dwordx4 v16, s[12:15], s26 offen offset:0 lds
v_mfma_f32_16x16x32_bf16 v[228:231], a[136:139], a[8:11], 0
ds_read_b64_tr_b16 a[130:131], v22 offset:2048
v_mfma_f32_16x16x32_bf16 v[228:231], a[140:143], a[12:15], v[228:231]
v_mfma_f32_16x16x32_bf16 v[232:235], a[136:139], a[16:19], 0
ds_read_b64_tr_b16 a[132:133], v22 offset:16384
v_mfma_f32_16x16x32_bf16 v[232:235], a[140:143], a[20:23], v[232:235]
buffer_load_dwordx4 v17, s[12:15], s26 offen offset:1024 lds
v_mfma_f32_16x16x32_bf16 v[236:239], a[136:139], a[24:27], 0
ds_read_b64_tr_b16 a[134:135], v22 offset:18432
v_add_u32 v22, 32768, v22
v_mfma_f32_16x16x32_bf16 v[236:239], a[140:143], a[28:31], v[236:239]
v_mfma_f32_16x16x32_bf16 v[240:243], a[136:139], a[32:35], 0
v_mfma_f32_16x16x32_bf16 v[240:243], a[140:143], a[36:39], v[240:243]
buffer_load_dwordx4 v18, s[12:15], s26 offen offset:2048 lds
v_mfma_f32_16x16x32_bf16 v[244:247], a[136:139], a[40:43], 0
v_mfma_f32_16x16x32_bf16 v[244:247], a[140:143], a[44:47], v[244:247]
v_mfma_f32_16x16x32_bf16 v[248:251], a[136:139], a[48:51], 0
v_mfma_f32_16x16x32_bf16 v[248:251], a[140:143], a[52:55], v[248:251]
buffer_load_dwordx4 v19, s[12:15], s26 offen offset:3072 lds
v_mfma_f32_16x16x32_bf16 v[252:255], a[136:139], a[56:59], 0
s_add_u32 s26, s26, 524288
v_mfma_f32_16x16x32_bf16 v[252:255], a[140:143], a[60:63], v[252:255]
s_waitcnt lgkmcnt(0)
v_mfma_f32_16x16x32_bf16 v[36:39], a[128:131], a[64:67], v[36:39]
s_add_u32 m0, s29, 147456
ds_read_b64_tr_b16 a[136:137], v23 offset:0
v_mfma_f32_16x16x32_bf16 v[36:39], a[132:135], a[68:71], v[36:39]
buffer_load_dwordx4 v16, s[12:15], s27 offen offset:0 lds
v_mfma_f32_16x16x32_bf16 v[44:47], a[128:131], a[72:75], v[44:47]
ds_read_b64_tr_b16 a[138:139], v23 offset:2048
v_mfma_f32_16x16x32_bf16 v[44:47], a[132:135], a[76:79], v[44:47]
ds_read_b128 a[0:3], v2 offset:32768
ds_read_b128 a[4:7], v3 offset:32768
v_mfma_f32_16x16x32_bf16 v[52:55], a[128:131], a[80:83], v[52:55]
ds_read_b64_tr_b16 a[140:141], v23 offset:16384
v_mfma_f32_16x16x32_bf16 v[52:55], a[132:135], a[84:87], v[52:55]
buffer_load_dwordx4 v17, s[12:15], s27 offen offset:1024 lds
v_mfma_f32_16x16x32_bf16 v[60:63], a[128:131], a[88:91], v[60:63]
ds_read_b64_tr_b16 a[142:143], v23 offset:18432
v_add_u32 v23, 32768, v23
v_mfma_f32_16x16x32_bf16 v[60:63], a[132:135], a[92:95], v[60:63]
buffer_store_dwordx4 v[128:131], v1, s[4:7], s31 offen sc1
v_mfma_f32_16x16x32_bf16 v[68:71], a[128:131], a[96:99], v[68:71]
s_add_u32 s31, s31, s32
ds_read_b128 a[8:11], v2 offset:34816
v_accvgpr_read_b32 v32, a192
v_mfma_f32_16x16x32_bf16 v[68:71], a[132:135], a[100:103], v[68:71]
buffer_load_dwordx4 v18, s[12:15], s27 offen offset:2048 lds
v_mfma_f32_16x16x32_bf16 v[76:79], a[128:131], a[104:107], v[76:79]
ds_read_b128 a[12:15], v3 offset:34816
v_accvgpr_read_b32 v33, a193
v_mfma_f32_16x16x32_bf16 v[76:79], a[132:135], a[108:111], v[76:79]
ds_read_b128 a[16:19], v2 offset:36864
v_accvgpr_read_b32 v34, a194
v_mfma_f32_16x16x32_bf16 v[84:87], a[128:131], a[112:115], v[84:87]
ds_read_b128 a[20:23], v3 offset:36864
v_accvgpr_read_b32 v35, a195
v_mfma_f32_16x16x32_bf16 v[84:87], a[132:135], a[116:119], v[84:87]
buffer_load_dwordx4 v19, s[12:15], s27 offen offset:3072 lds
v_mfma_f32_16x16x32_bf16 v[92:95], a[128:131], a[120:123], v[92:95]
s_add_u32 s27, s27, 524288
ds_read_b128 a[24:27], v2 offset:38912
v_accvgpr_read_b32 v96, a196
v_mfma_f32_16x16x32_bf16 v[92:95], a[132:135], a[124:127], v[92:95]
s_waitcnt lgkmcnt(5)
buffer_store_dwordx4 v[136:139], v1, s[4:7], s31 offen sc1
v_mfma_f32_16x16x32_bf16 v[100:103], a[136:139], a[64:67], v[100:103]
s_add_u32 m0, s28, 16384
ds_read_b64_tr_b16 a[128:129], v24 offset:0
v_accvgpr_read_b32 v97, a197
v_mfma_f32_16x16x32_bf16 v[100:103], a[140:143], a[68:71], v[100:103]
s_add_u32 s31, s31, s33
buffer_load_dwordx4 v12, s[8:11], s24 offen offset:0 lds
v_mfma_f32_16x16x32_bf16 v[108:111], a[136:139], a[72:75], v[108:111]
ds_read_b64_tr_b16 a[130:131], v24 offset:2048
v_accvgpr_read_b32 v98, a198
v_mfma_f32_16x16x32_bf16 v[108:111], a[140:143], a[76:79], v[108:111]
ds_read_b128 a[28:31], v3 offset:38912
v_accvgpr_read_b32 v99, a199
v_mfma_f32_16x16x32_bf16 v[116:119], a[136:139], a[80:83], v[116:119]
ds_read_b64_tr_b16 a[132:133], v24 offset:16384
v_cvt_pk_bf16_f32 v32, v32, v33
v_mfma_f32_16x16x32_bf16 v[116:119], a[140:143], a[84:87], v[116:119]
buffer_load_dwordx4 v13, s[8:11], s24 offen offset:1024 lds
v_mfma_f32_16x16x32_bf16 v[124:127], a[136:139], a[88:91], v[124:127]
ds_read_b64_tr_b16 a[134:135], v24 offset:18432
v_add_u32 v24, 32768, v24
v_mfma_f32_16x16x32_bf16 v[124:127], a[140:143], a[92:95], v[124:127]
v_cvt_pk_bf16_f32 v33, v34, v35
v_cvt_pk_bf16_f32 v34, v96, v97
v_mfma_f32_16x16x32_bf16 v[132:135], a[136:139], a[96:99], v[132:135]
ds_read_b128 a[32:35], v2 offset:40960
v_cvt_pk_bf16_f32 v35, v98, v99
v_mfma_f32_16x16x32_bf16 v[132:135], a[140:143], a[100:103], v[132:135]
buffer_load_dwordx4 v14, s[8:11], s24 offen offset:2048 lds
v_mfma_f32_16x16x32_bf16 v[140:143], a[136:139], a[104:107], v[140:143]
ds_read_b128 a[36:39], v3 offset:40960
v_accvgpr_read_b32 v40, a200
v_mfma_f32_16x16x32_bf16 v[140:143], a[140:143], a[108:111], v[140:143]
ds_read_b128 a[40:43], v2 offset:43008
v_accvgpr_read_b32 v41, a201
v_mfma_f32_16x16x32_bf16 v[148:151], a[136:139], a[112:115], v[148:151]
ds_read_b128 a[44:47], v3 offset:43008
v_accvgpr_read_b32 v42, a202
v_mfma_f32_16x16x32_bf16 v[148:151], a[140:143], a[116:119], v[148:151]
buffer_load_dwordx4 v15, s[8:11], s24 offen offset:3072 lds
v_mfma_f32_16x16x32_bf16 v[156:159], a[136:139], a[120:123], v[156:159]
s_add_u32 s24, s24, 128
ds_read_b128 a[48:51], v2 offset:45056
v_accvgpr_read_b32 v43, a203
v_mfma_f32_16x16x32_bf16 v[156:159], a[140:143], a[124:127], v[156:159]
s_waitcnt lgkmcnt(5)
buffer_store_dwordx4 v[144:147], v1, s[4:7], s31 offen sc1
v_mfma_f32_16x16x32_bf16 v[164:167], a[128:131], a[64:67], v[164:167]
s_add_u32 s31, s31, s32
ds_read_b64_tr_b16 a[136:137], v25 offset:0
v_accvgpr_read_b32 v96, a204
v_mfma_f32_16x16x32_bf16 v[164:167], a[132:135], a[68:71], v[164:167]
v_accvgpr_read_b32 v97, a205
v_accvgpr_read_b32 v98, a206
v_mfma_f32_16x16x32_bf16 v[172:175], a[128:131], a[72:75], v[172:175]
ds_read_b64_tr_b16 a[138:139], v25 offset:2048
v_accvgpr_read_b32 v99, a207
v_mfma_f32_16x16x32_bf16 v[172:175], a[132:135], a[76:79], v[172:175]
ds_read_b128 a[52:55], v3 offset:45056
v_cvt_pk_bf16_f32 v40, v40, v41
v_mfma_f32_16x16x32_bf16 v[180:183], a[128:131], a[80:83], v[180:183]
ds_read_b64_tr_b16 a[140:141], v25 offset:16384
v_cvt_pk_bf16_f32 v41, v42, v43
v_mfma_f32_16x16x32_bf16 v[180:183], a[132:135], a[84:87], v[180:183]
v_cvt_pk_bf16_f32 v42, v96, v97
v_cvt_pk_bf16_f32 v43, v98, v99
v_mfma_f32_16x16x32_bf16 v[188:191], a[128:131], a[88:91], v[188:191]
ds_read_b64_tr_b16 a[142:143], v25 offset:18432
v_add_u32 v25, 32768, v25
v_mfma_f32_16x16x32_bf16 v[188:191], a[132:135], a[92:95], v[188:191]
v_accvgpr_read_b32 v48, a208
v_accvgpr_read_b32 v49, a209
v_mfma_f32_16x16x32_bf16 v[196:199], a[128:131], a[96:99], v[196:199]
ds_read_b128 a[56:59], v2 offset:47104
v_accvgpr_read_b32 v50, a210
v_mfma_f32_16x16x32_bf16 v[196:199], a[132:135], a[100:103], v[196:199]
v_accvgpr_read_b32 v51, a211
v_accvgpr_read_b32 v96, a212
v_mfma_f32_16x16x32_bf16 v[204:207], a[128:131], a[104:107], v[204:207]
ds_read_b128 a[60:63], v3 offset:47104
v_accvgpr_read_b32 v97, a213
v_mfma_f32_16x16x32_bf16 v[204:207], a[132:135], a[108:111], v[204:207]
v_accvgpr_read_b32 v98, a214
v_accvgpr_read_b32 v99, a215
v_mfma_f32_16x16x32_bf16 v[212:215], a[128:131], a[112:115], v[212:215]
v_cvt_pk_bf16_f32 v48, v48, v49
v_cvt_pk_bf16_f32 v49, v50, v51
v_mfma_f32_16x16x32_bf16 v[212:215], a[132:135], a[116:119], v[212:215]
buffer_store_dwordx4 v[152:155], v1, s[4:7], s31 offen sc1
v_mfma_f32_16x16x32_bf16 v[220:223], a[128:131], a[120:123], v[220:223]
s_add_u32 s31, s31, s36
v_cvt_pk_bf16_f32 v50, v96, v97
v_cvt_pk_bf16_f32 v51, v98, v99
v_mfma_f32_16x16x32_bf16 v[220:223], a[132:135], a[124:127], v[220:223]
s_waitcnt vmcnt(23) lgkmcnt(0)
s_barrier
v_accvgpr_read_b32 v56, a216
v_mfma_f32_16x16x32_bf16 v[224:227], a[136:139], a[64:67], v[224:227]
s_add_u32 m0, s29, 65536
ds_read_b64_tr_b16 a[128:129], v22 offset:0
v_accvgpr_read_b32 v57, a217
v_mfma_f32_16x16x32_bf16 v[224:227], a[140:143], a[68:71], v[224:227]
buffer_load_dwordx4 v16, s[12:15], s26 offen offset:0 lds
v_mfma_f32_16x16x32_bf16 v[228:231], a[136:139], a[72:75], v[228:231]
ds_read_b64_tr_b16 a[130:131], v22 offset:2048
v_accvgpr_read_b32 v58, a218
v_mfma_f32_16x16x32_bf16 v[228:231], a[140:143], a[76:79], v[228:231]
v_accvgpr_read_b32 v59, a219
v_accvgpr_read_b32 v96, a220
v_mfma_f32_16x16x32_bf16 v[232:235], a[136:139], a[80:83], v[232:235]
ds_read_b64_tr_b16 a[132:133], v22 offset:16384
v_accvgpr_read_b32 v97, a221
v_mfma_f32_16x16x32_bf16 v[232:235], a[140:143], a[84:87], v[232:235]
buffer_load_dwordx4 v17, s[12:15], s26 offen offset:1024 lds
v_mfma_f32_16x16x32_bf16 v[236:239], a[136:139], a[88:91], v[236:239]
ds_read_b64_tr_b16 a[134:135], v22 offset:18432
v_add_u32 v22, 32768, v22
v_mfma_f32_16x16x32_bf16 v[236:239], a[140:143], a[92:95], v[236:239]
v_accvgpr_read_b32 v98, a222
v_accvgpr_read_b32 v99, a223
v_mfma_f32_16x16x32_bf16 v[240:243], a[136:139], a[96:99], v[240:243]
v_cvt_pk_bf16_f32 v56, v56, v57
v_cvt_pk_bf16_f32 v57, v58, v59
v_mfma_f32_16x16x32_bf16 v[240:243], a[140:143], a[100:103], v[240:243]
buffer_load_dwordx4 v18, s[12:15], s26 offen offset:2048 lds
v_mfma_f32_16x16x32_bf16 v[244:247], a[136:139], a[104:107], v[244:247]
v_cvt_pk_bf16_f32 v58, v96, v97
v_cvt_pk_bf16_f32 v59, v98, v99
v_mfma_f32_16x16x32_bf16 v[244:247], a[140:143], a[108:111], v[244:247]
v_accvgpr_read_b32 v64, a224
v_accvgpr_read_b32 v65, a225
v_mfma_f32_16x16x32_bf16 v[248:251], a[136:139], a[112:115], v[248:251]
v_accvgpr_read_b32 v66, a226
v_accvgpr_read_b32 v67, a227
v_mfma_f32_16x16x32_bf16 v[248:251], a[140:143], a[116:119], v[248:251]
buffer_load_dwordx4 v19, s[12:15], s26 offen offset:3072 lds
v_mfma_f32_16x16x32_bf16 v[252:255], a[136:139], a[120:123], v[252:255]
s_add_u32 s26, s26, 524288
v_accvgpr_read_b32 v96, a228
v_accvgpr_read_b32 v97, a229
v_mfma_f32_16x16x32_bf16 v[252:255], a[140:143], a[124:127], v[252:255]
s_waitcnt lgkmcnt(0)
v_accvgpr_read_b32 v98, a230
v_accvgpr_read_b32 v99, a231
v_mfma_f32_16x16x32_bf16 v[36:39], a[128:131], a[0:3], v[36:39]
s_add_u32 m0, s29, 81920
ds_read_b64_tr_b16 a[136:137], v23 offset:0
v_cvt_pk_bf16_f32 v64, v64, v65
v_mfma_f32_16x16x32_bf16 v[36:39], a[132:135], a[4:7], v[36:39]
buffer_load_dwordx4 v16, s[12:15], s27 offen offset:0 lds
v_mfma_f32_16x16x32_bf16 v[44:47], a[128:131], a[8:11], v[44:47]
ds_read_b64_tr_b16 a[138:139], v23 offset:2048
v_cvt_pk_bf16_f32 v65, v66, v67
v_mfma_f32_16x16x32_bf16 v[44:47], a[132:135], a[12:15], v[44:47]
ds_read_b128 a[64:67], v2 offset:49152
ds_read_b128 a[68:71], v3 offset:49152
v_mfma_f32_16x16x32_bf16 v[52:55], a[128:131], a[16:19], v[52:55]
ds_read_b64_tr_b16 a[140:141], v23 offset:16384
v_cvt_pk_bf16_f32 v66, v96, v97
v_mfma_f32_16x16x32_bf16 v[52:55], a[132:135], a[20:23], v[52:55]
buffer_load_dwordx4 v17, s[12:15], s27 offen offset:1024 lds
v_mfma_f32_16x16x32_bf16 v[60:63], a[128:131], a[24:27], v[60:63]
ds_read_b64_tr_b16 a[142:143], v23 offset:18432
v_add_u32 v23, 32768, v23
v_mfma_f32_16x16x32_bf16 v[60:63], a[132:135], a[28:31], v[60:63]
buffer_store_dwordx4 v[160:163], v1, s[4:7], s31 offen sc1
v_mfma_f32_16x16x32_bf16 v[68:71], a[128:131], a[32:35], v[68:71]
s_add_u32 s31, s31, s32
ds_read_b128 a[72:75], v2 offset:51200
v_cvt_pk_bf16_f32 v67, v98, v99
v_mfma_f32_16x16x32_bf16 v[68:71], a[132:135], a[36:39], v[68:71]
buffer_load_dwordx4 v18, s[12:15], s27 offen offset:2048 lds
v_mfma_f32_16x16x32_bf16 v[76:79], a[128:131], a[40:43], v[76:79]
ds_read_b128 a[76:79], v3 offset:51200
v_accvgpr_read_b32 v72, a232
v_mfma_f32_16x16x32_bf16 v[76:79], a[132:135], a[44:47], v[76:79]
ds_read_b128 a[80:83], v2 offset:53248
v_accvgpr_read_b32 v73, a233
v_mfma_f32_16x16x32_bf16 v[84:87], a[128:131], a[48:51], v[84:87]
ds_read_b128 a[84:87], v3 offset:53248
v_accvgpr_read_b32 v74, a234
v_mfma_f32_16x16x32_bf16 v[84:87], a[132:135], a[52:55], v[84:87]
buffer_load_dwordx4 v19, s[12:15], s27 offen offset:3072 lds
v_mfma_f32_16x16x32_bf16 v[92:95], a[128:131], a[56:59], v[92:95]
s_add_u32 s27, s27, 524288
ds_read_b128 a[88:91], v2 offset:55296
v_accvgpr_read_b32 v75, a235
v_mfma_f32_16x16x32_bf16 v[92:95], a[132:135], a[60:63], v[92:95]
s_waitcnt lgkmcnt(5)
buffer_store_dwordx4 v[168:171], v1, s[4:7], s31 offen sc1
v_mfma_f32_16x16x32_bf16 v[100:103], a[136:139], a[0:3], v[100:103]
s_add_u32 m0, s28, 32768
ds_read_b64_tr_b16 a[128:129], v24 offset:0
v_accvgpr_read_b32 v96, a236
v_mfma_f32_16x16x32_bf16 v[100:103], a[140:143], a[4:7], v[100:103]
s_add_u32 s31, s31, s33
buffer_load_dwordx4 v12, s[8:11], s24 offen offset:0 lds
v_mfma_f32_16x16x32_bf16 v[108:111], a[136:139], a[8:11], v[108:111]
ds_read_b64_tr_b16 a[130:131], v24 offset:2048
v_accvgpr_read_b32 v97, a237
v_mfma_f32_16x16x32_bf16 v[108:111], a[140:143], a[12:15], v[108:111]
ds_read_b128 a[92:95], v3 offset:55296
v_accvgpr_read_b32 v98, a238
v_mfma_f32_16x16x32_bf16 v[116:119], a[136:139], a[16:19], v[116:119]
ds_read_b64_tr_b16 a[132:133], v24 offset:16384
v_accvgpr_read_b32 v99, a239
v_mfma_f32_16x16x32_bf16 v[116:119], a[140:143], a[20:23], v[116:119]
buffer_load_dwordx4 v13, s[8:11], s24 offen offset:1024 lds
v_mfma_f32_16x16x32_bf16 v[124:127], a[136:139], a[24:27], v[124:127]
ds_read_b64_tr_b16 a[134:135], v24 offset:18432
v_add_u32 v24, 32768, v24
v_mfma_f32_16x16x32_bf16 v[124:127], a[140:143], a[28:31], v[124:127]
v_cvt_pk_bf16_f32 v72, v72, v73
v_cvt_pk_bf16_f32 v73, v74, v75
v_mfma_f32_16x16x32_bf16 v[132:135], a[136:139], a[32:35], v[132:135]
ds_read_b128 a[96:99], v2 offset:57344
v_cvt_pk_bf16_f32 v74, v96, v97
v_mfma_f32_16x16x32_bf16 v[132:135], a[140:143], a[36:39], v[132:135]
buffer_load_dwordx4 v14, s[8:11], s24 offen offset:2048 lds
v_mfma_f32_16x16x32_bf16 v[140:143], a[136:139], a[40:43], v[140:143]
ds_read_b128 a[100:103], v3 offset:57344
v_cvt_pk_bf16_f32 v75, v98, v99
v_mfma_f32_16x16x32_bf16 v[140:143], a[140:143], a[44:47], v[140:143]
ds_read_b128 a[104:107], v2 offset:59392
v_accvgpr_read_b32 v80, a240
v_mfma_f32_16x16x32_bf16 v[148:151], a[136:139], a[48:51], v[148:151]
ds_read_b128 a[108:111], v3 offset:59392
v_accvgpr_read_b32 v81, a241
v_mfma_f32_16x16x32_bf16 v[148:151], a[140:143], a[52:55], v[148:151]
buffer_load_dwordx4 v15, s[8:11], s24 offen offset:3072 lds
v_mfma_f32_16x16x32_bf16 v[156:159], a[136:139], a[56:59], v[156:159]
s_add_u32 s24, s24, 128
ds_read_b128 a[112:115], v2 offset:61440
v_accvgpr_read_b32 v82, a242
v_mfma_f32_16x16x32_bf16 v[156:159], a[140:143], a[60:63], v[156:159]
s_waitcnt lgkmcnt(5)
buffer_store_dwordx4 v[176:179], v1, s[4:7], s31 offen sc1
v_mfma_f32_16x16x32_bf16 v[164:167], a[128:131], a[0:3], v[164:167]
s_add_u32 s31, s31, s32
ds_read_b64_tr_b16 a[136:137], v25 offset:0
v_accvgpr_read_b32 v83, a243
v_mfma_f32_16x16x32_bf16 v[164:167], a[132:135], a[4:7], v[164:167]
v_accvgpr_read_b32 v96, a244
v_accvgpr_read_b32 v97, a245
v_mfma_f32_16x16x32_bf16 v[172:175], a[128:131], a[8:11], v[172:175]
ds_read_b64_tr_b16 a[138:139], v25 offset:2048
v_accvgpr_read_b32 v98, a246
v_mfma_f32_16x16x32_bf16 v[172:175], a[132:135], a[12:15], v[172:175]
ds_read_b128 a[116:119], v3 offset:61440
v_accvgpr_read_b32 v99, a247
v_mfma_f32_16x16x32_bf16 v[180:183], a[128:131], a[16:19], v[180:183]
ds_read_b64_tr_b16 a[140:141], v25 offset:16384
v_cvt_pk_bf16_f32 v80, v80, v81
v_mfma_f32_16x16x32_bf16 v[180:183], a[132:135], a[20:23], v[180:183]
buffer_store_dwordx4 v[184:187], v1, s[4:7], s31 offen sc1
v_mfma_f32_16x16x32_bf16 v[188:191], a[128:131], a[24:27], v[188:191]
s_add_u32 s31, s31, s34
ds_read_b64_tr_b16 a[142:143], v25 offset:18432
v_add_u32 v25, 32768, v25
v_mfma_f32_16x16x32_bf16 v[188:191], a[132:135], a[28:31], v[188:191]
v_cvt_pk_bf16_f32 v81, v82, v83
v_cvt_pk_bf16_f32 v82, v96, v97
v_mfma_f32_16x16x32_bf16 v[196:199], a[128:131], a[32:35], v[196:199]
ds_read_b128 a[120:123], v2 offset:63488
v_cvt_pk_bf16_f32 v83, v98, v99
v_mfma_f32_16x16x32_bf16 v[196:199], a[132:135], a[36:39], v[196:199]
v_accvgpr_read_b32 v88, a248
v_accvgpr_read_b32 v89, a249
v_mfma_f32_16x16x32_bf16 v[204:207], a[128:131], a[40:43], v[204:207]
ds_read_b128 a[124:127], v3 offset:63488
v_accvgpr_read_b32 v90, a250
v_mfma_f32_16x16x32_bf16 v[204:207], a[132:135], a[44:47], v[204:207]
v_accvgpr_read_b32 v91, a251
v_accvgpr_read_b32 v96, a252
v_mfma_f32_16x16x32_bf16 v[212:215], a[128:131], a[48:51], v[212:215]
v_accvgpr_read_b32 v97, a253
v_accvgpr_read_b32 v98, a254
v_mfma_f32_16x16x32_bf16 v[212:215], a[132:135], a[52:55], v[212:215]
v_accvgpr_read_b32 v99, a255
v_cvt_pk_bf16_f32 v88, v88, v89
v_mfma_f32_16x16x32_bf16 v[220:223], a[128:131], a[56:59], v[220:223]
v_cvt_pk_bf16_f32 v89, v90, v91
v_cvt_pk_bf16_f32 v90, v96, v97
v_mfma_f32_16x16x32_bf16 v[220:223], a[132:135], a[60:63], v[220:223]
s_waitcnt vmcnt(23) lgkmcnt(0)
s_barrier
v_cvt_pk_bf16_f32 v91, v98, v99
v_mfma_f32_16x16x32_bf16 v[224:227], a[136:139], a[0:3], v[224:227]
s_add_u32 m0, s29, 98304
ds_read_b64_tr_b16 a[128:129], v22 offset:0
v_mfma_f32_16x16x32_bf16 v[224:227], a[140:143], a[4:7], v[224:227]
buffer_load_dwordx4 v16, s[12:15], s26 offen offset:0 lds
v_mfma_f32_16x16x32_bf16 v[228:231], a[136:139], a[8:11], v[228:231]
ds_read_b64_tr_b16 a[130:131], v22 offset:2048
v_mfma_f32_16x16x32_bf16 v[228:231], a[140:143], a[12:15], v[228:231]
buffer_store_dwordx4 v[192:195], v1, s[4:7], s31 offen sc1
v_mfma_f32_16x16x32_bf16 v[232:235], a[136:139], a[16:19], v[232:235]
s_add_u32 s31, s31, s32
ds_read_b64_tr_b16 a[132:133], v22 offset:16384
v_mfma_f32_16x16x32_bf16 v[232:235], a[140:143], a[20:23], v[232:235]
buffer_load_dwordx4 v17, s[12:15], s26 offen offset:1024 lds
v_mfma_f32_16x16x32_bf16 v[236:239], a[136:139], a[24:27], v[236:239]
ds_read_b64_tr_b16 a[134:135], v22 offset:18432
v_add_u32 v22, 4294901760, v22
v_mfma_f32_16x16x32_bf16 v[236:239], a[140:143], a[28:31], v[236:239]
v_mfma_f32_16x16x32_bf16 v[240:243], a[136:139], a[32:35], v[240:243]
v_mfma_f32_16x16x32_bf16 v[240:243], a[140:143], a[36:39], v[240:243]
buffer_load_dwordx4 v18, s[12:15], s26 offen offset:2048 lds
v_mfma_f32_16x16x32_bf16 v[244:247], a[136:139], a[40:43], v[244:247]
v_mfma_f32_16x16x32_bf16 v[244:247], a[140:143], a[44:47], v[244:247]
v_mfma_f32_16x16x32_bf16 v[248:251], a[136:139], a[48:51], v[248:251]
v_mfma_f32_16x16x32_bf16 v[248:251], a[140:143], a[52:55], v[248:251]
buffer_load_dwordx4 v19, s[12:15], s26 offen offset:3072 lds
v_mfma_f32_16x16x32_bf16 v[252:255], a[136:139], a[56:59], v[252:255]
s_add_u32 s26, s26, 524288
v_mfma_f32_16x16x32_bf16 v[252:255], a[140:143], a[60:63], v[252:255]
s_waitcnt lgkmcnt(0)
v_mfma_f32_16x16x32_bf16 v[36:39], a[128:131], a[64:67], v[36:39]
s_add_u32 m0, s29, 114688
ds_read_b64_tr_b16 a[136:137], v23 offset:0
v_mfma_f32_16x16x32_bf16 v[36:39], a[132:135], a[68:71], v[36:39]
buffer_load_dwordx4 v16, s[12:15], s27 offen offset:0 lds
v_mfma_f32_16x16x32_bf16 v[44:47], a[128:131], a[72:75], v[44:47]
ds_read_b64_tr_b16 a[138:139], v23 offset:2048
v_mfma_f32_16x16x32_bf16 v[44:47], a[132:135], a[76:79], v[44:47]
ds_read_b128 a[0:3], v2 offset:0
ds_read_b128 a[4:7], v3 offset:0
v_mfma_f32_16x16x32_bf16 v[52:55], a[128:131], a[80:83], v[52:55]
ds_read_b64_tr_b16 a[140:141], v23 offset:16384
v_mfma_f32_16x16x32_bf16 v[52:55], a[132:135], a[84:87], v[52:55]
buffer_load_dwordx4 v17, s[12:15], s27 offen offset:1024 lds
v_mfma_f32_16x16x32_bf16 v[60:63], a[128:131], a[88:91], v[60:63]
ds_read_b64_tr_b16 a[142:143], v23 offset:18432
v_add_u32 v23, 4294901760, v23
v_mfma_f32_16x16x32_bf16 v[60:63], a[132:135], a[92:95], v[60:63]
buffer_store_dwordx4 v[200:203], v1, s[4:7], s31 offen sc1
v_mfma_f32_16x16x32_bf16 v[68:71], a[128:131], a[96:99], v[68:71]
s_add_u32 s31, s31, s33
ds_read_b128 a[8:11], v2 offset:2048
v_mfma_f32_16x16x32_bf16 v[68:71], a[132:135], a[100:103], v[68:71]
buffer_load_dwordx4 v18, s[12:15], s27 offen offset:2048 lds
v_mfma_f32_16x16x32_bf16 v[76:79], a[128:131], a[104:107], v[76:79]
ds_read_b128 a[12:15], v3 offset:2048
v_mfma_f32_16x16x32_bf16 v[76:79], a[132:135], a[108:111], v[76:79]
ds_read_b128 a[16:19], v2 offset:4096
v_mfma_f32_16x16x32_bf16 v[84:87], a[128:131], a[112:115], v[84:87]
ds_read_b128 a[20:23], v3 offset:4096
v_mfma_f32_16x16x32_bf16 v[84:87], a[132:135], a[116:119], v[84:87]
buffer_load_dwordx4 v19, s[12:15], s27 offen offset:3072 lds
v_mfma_f32_16x16x32_bf16 v[92:95], a[128:131], a[120:123], v[92:95]
s_add_u32 s27, s27, 524288
ds_read_b128 a[24:27], v2 offset:6144
v_mfma_f32_16x16x32_bf16 v[92:95], a[132:135], a[124:127], v[92:95]
s_waitcnt lgkmcnt(5)
buffer_store_dwordx4 v[208:211], v1, s[4:7], s31 offen sc1
v_mfma_f32_16x16x32_bf16 v[100:103], a[136:139], a[64:67], v[100:103]
s_add_u32 s31, s31, s32
ds_read_b64_tr_b16 a[128:129], v24 offset:0
v_mfma_f32_16x16x32_bf16 v[100:103], a[140:143], a[68:71], v[100:103]
v_mfma_f32_16x16x32_bf16 v[108:111], a[136:139], a[72:75], v[108:111]
ds_read_b64_tr_b16 a[130:131], v24 offset:2048
v_mfma_f32_16x16x32_bf16 v[108:111], a[140:143], a[76:79], v[108:111]
ds_read_b128 a[28:31], v3 offset:6144
v_mfma_f32_16x16x32_bf16 v[116:119], a[136:139], a[80:83], v[116:119]
ds_read_b64_tr_b16 a[132:133], v24 offset:16384
v_mfma_f32_16x16x32_bf16 v[116:119], a[140:143], a[84:87], v[116:119]
v_mfma_f32_16x16x32_bf16 v[124:127], a[136:139], a[88:91], v[124:127]
ds_read_b64_tr_b16 a[134:135], v24 offset:18432
v_add_u32 v24, 4294901760, v24
v_mfma_f32_16x16x32_bf16 v[124:127], a[140:143], a[92:95], v[124:127]
v_mfma_f32_16x16x32_bf16 v[132:135], a[136:139], a[96:99], v[132:135]
ds_read_b128 a[32:35], v2 offset:8192
v_mfma_f32_16x16x32_bf16 v[132:135], a[140:143], a[100:103], v[132:135]
buffer_store_dwordx4 v[216:219], v1, s[4:7], s31 offen sc1
v_mfma_f32_16x16x32_bf16 v[140:143], a[136:139], a[104:107], v[140:143]
s_add_u32 s31, s31, s35
ds_read_b128 a[36:39], v3 offset:8192
v_mfma_f32_16x16x32_bf16 v[140:143], a[140:143], a[108:111], v[140:143]
ds_read_b128 a[40:43], v2 offset:10240
v_mfma_f32_16x16x32_bf16 v[148:151], a[136:139], a[112:115], v[148:151]
ds_read_b128 a[44:47], v3 offset:10240
v_mfma_f32_16x16x32_bf16 v[148:151], a[140:143], a[116:119], v[148:151]
v_mfma_f32_16x16x32_bf16 v[156:159], a[136:139], a[120:123], v[156:159]
ds_read_b128 a[48:51], v2 offset:12288
v_mfma_f32_16x16x32_bf16 v[156:159], a[140:143], a[124:127], v[156:159]
s_waitcnt lgkmcnt(5)
v_mfma_f32_16x16x32_bf16 v[164:167], a[128:131], a[64:67], v[164:167]
ds_read_b64_tr_b16 a[136:137], v25 offset:0
v_mfma_f32_16x16x32_bf16 v[164:167], a[132:135], a[68:71], v[164:167]
v_mfma_f32_16x16x32_bf16 v[172:175], a[128:131], a[72:75], v[172:175]
ds_read_b64_tr_b16 a[138:139], v25 offset:2048
v_mfma_f32_16x16x32_bf16 v[172:175], a[132:135], a[76:79], v[172:175]
ds_read_b128 a[52:55], v3 offset:12288
v_mfma_f32_16x16x32_bf16 v[180:183], a[128:131], a[80:83], v[180:183]
ds_read_b64_tr_b16 a[140:141], v25 offset:16384
v_mfma_f32_16x16x32_bf16 v[180:183], a[132:135], a[84:87], v[180:183]
buffer_store_dwordx4 v[32:35], v1, s[4:7], s31 offen sc1
v_mfma_f32_16x16x32_bf16 v[188:191], a[128:131], a[88:91], v[188:191]
s_add_u32 s31, s31, s32
ds_read_b64_tr_b16 a[142:143], v25 offset:18432
v_add_u32 v25, 4294901760, v25
v_mfma_f32_16x16x32_bf16 v[188:191], a[132:135], a[92:95], v[188:191]
v_mfma_f32_16x16x32_bf16 v[196:199], a[128:131], a[96:99], v[196:199]
ds_read_b128 a[56:59], v2 offset:14336
v_mfma_f32_16x16x32_bf16 v[196:199], a[132:135], a[100:103], v[196:199]
v_mfma_f32_16x16x32_bf16 v[204:207], a[128:131], a[104:107], v[204:207]
ds_read_b128 a[60:63], v3 offset:14336
v_mfma_f32_16x16x32_bf16 v[204:207], a[132:135], a[108:111], v[204:207]
v_mfma_f32_16x16x32_bf16 v[212:215], a[128:131], a[112:115], v[212:215]
v_mfma_f32_16x16x32_bf16 v[212:215], a[132:135], a[116:119], v[212:215]
v_mfma_f32_16x16x32_bf16 v[220:223], a[128:131], a[120:123], v[220:223]
v_mfma_f32_16x16x32_bf16 v[220:223], a[132:135], a[124:127], v[220:223]
s_waitcnt vmcnt(20) lgkmcnt(0)
s_barrier
v_mfma_f32_16x16x32_bf16 v[224:227], a[136:139], a[64:67], v[224:227]
s_add_u32 m0, s29, 131072
ds_read_b64_tr_b16 a[128:129], v22 offset:0
v_mfma_f32_16x16x32_bf16 v[224:227], a[140:143], a[68:71], v[224:227]
buffer_load_dwordx4 v16, s[12:15], s26 offen offset:0 lds
v_mfma_f32_16x16x32_bf16 v[228:231], a[136:139], a[72:75], v[228:231]
ds_read_b64_tr_b16 a[130:131], v22 offset:2048
v_mfma_f32_16x16x32_bf16 v[228:231], a[140:143], a[76:79], v[228:231]
buffer_store_dwordx4 v[40:43], v1, s[4:7], s31 offen sc1
v_mfma_f32_16x16x32_bf16 v[232:235], a[136:139], a[80:83], v[232:235]
s_add_u32 s31, s31, s33
ds_read_b64_tr_b16 a[132:133], v22 offset:16384
v_mfma_f32_16x16x32_bf16 v[232:235], a[140:143], a[84:87], v[232:235]
buffer_load_dwordx4 v17, s[12:15], s26 offen offset:1024 lds
v_mfma_f32_16x16x32_bf16 v[236:239], a[136:139], a[88:91], v[236:239]
ds_read_b64_tr_b16 a[134:135], v22 offset:18432
v_add_u32 v22, 32768, v22
v_mfma_f32_16x16x32_bf16 v[236:239], a[140:143], a[92:95], v[236:239]
PAD_7:
s_cbranch_execz M_tret
v_mfma_f32_16x16x32_bf16 v[240:243], a[136:139], a[96:99], v[240:243]
v_mfma_f32_16x16x32_bf16 v[240:243], a[140:143], a[100:103], v[240:243]
buffer_load_dwordx4 v18, s[12:15], s26 offen offset:2048 lds
v_mfma_f32_16x16x32_bf16 v[244:247], a[136:139], a[104:107], v[244:247]
v_mfma_f32_16x16x32_bf16 v[244:247], a[140:143], a[108:111], v[244:247]
v_mfma_f32_16x16x32_bf16 v[248:251], a[136:139], a[112:115], v[248:251]
v_mfma_f32_16x16x32_bf16 v[248:251], a[140:143], a[116:119], v[248:251]
buffer_load_dwordx4 v19, s[12:15], s26 offen offset:3072 lds
v_mfma_f32_16x16x32_bf16 v[252:255], a[136:139], a[120:123], v[252:255]
s_add_u32 s26, s26, 524288
v_mfma_f32_16x16x32_bf16 v[252:255], a[140:143], a[124:127], v[252:255]
s_waitcnt lgkmcnt(0)
v_mfma_f32_16x16x32_bf16 v[36:39], a[128:131], a[0:3], v[36:39]
s_add_u32 m0, s29, 147456
ds_read_b64_tr_b16 a[136:137], v23 offset:0
v_mfma_f32_16x16x32_bf16 v[36:39], a[132:135], a[4:7], v[36:39]
buffer_load_dwordx4 v16, s[12:15], s27 offen offset:0 lds
v_mfma_f32_16x16x32_bf16 v[44:47], a[128:131], a[8:11], v[44:47]
s_lshl_b32 s22, s20, 7
ds_read_b64_tr_b16 a[138:139], v23 offset:2048
v_bfe_u32 v20, v1, 4, 3
v_mfma_f32_16x16x32_bf16 v[44:47], a[132:135], a[12:15], v[44:47]
s_add_u32 s70, s22, 94371840
ds_read_b128 a[64:67], v2 offset:16384
ds_read_b128 a[68:71], v3 offset:16384
v_mfma_f32_16x16x32_bf16 v[52:55], a[128:131], a[16:19], v[52:55]
s_lshr_b32 s22, s2, 4
ds_read_b64_tr_b16 a[140:141], v23 offset:16384
v_lshlrev_b32 v20, 3, v20
v_mfma_f32_16x16x32_bf16 v[52:55], a[132:135], a[20:23], v[52:55]
s_lshl_b32 s22, s22, 2
buffer_load_dwordx4 v17, s[12:15], s27 offen offset:1024 lds
v_mfma_f32_16x16x32_bf16 v[60:63], a[128:131], a[24:27], v[60:63]
s_add_u32 s66, s70, s22
ds_read_b64_tr_b16 a[142:143], v23 offset:18432
v_add_u32 v23, 32768, v23
v_mfma_f32_16x16x32_bf16 v[60:63], a[132:135], a[28:31], v[60:63]
s_and_b32 s22, s2, 16
buffer_store_dwordx4 v[48:51], v1, s[4:7], s31 offen sc1
v_mfma_f32_16x16x32_bf16 v[68:71], a[128:131], a[32:35], v[68:71]
s_add_u32 s31, s31, s32
ds_read_b128 a[72:75], v2 offset:18432
v_add_u32 v15, 2052, v20
v_mfma_f32_16x16x32_bf16 v[68:71], a[132:135], a[36:39], v[68:71]
s_lshl_b32 s22, s22, 7
buffer_load_dwordx4 v18, s[12:15], s27 offen offset:2048 lds
v_mfma_f32_16x16x32_bf16 v[76:79], a[128:131], a[40:43], v[76:79]
s_add_u32 s66, s66, s22
ds_read_b128 a[76:79], v3 offset:18432
v_mfma_f32_16x16x32_bf16 v[76:79], a[132:135], a[44:47], v[76:79]
s_lshl_b32 s67, s20, 20
ds_read_b128 a[80:83], v2 offset:20480
v_mfma_f32_16x16x32_bf16 v[84:87], a[128:131], a[48:51], v[84:87]
s_lshl_b32 s22, s37, 16
ds_read_b128 a[84:87], v3 offset:20480
v_mfma_f32_16x16x32_bf16 v[84:87], a[132:135], a[52:55], v[84:87]
s_add_u32 s67, s67, s22
buffer_load_dwordx4 v19, s[12:15], s27 offen offset:3072 lds
v_mfma_f32_16x16x32_bf16 v[92:95], a[128:131], a[56:59], v[92:95]
s_waitcnt lgkmcnt(5)
s_add_u32 s27, s27, 524288
ds_read_b128 a[88:91], v2 offset:22528
v_mfma_f32_16x16x32_bf16 v[92:95], a[132:135], a[60:63], v[92:95]
s_lshl_b32 s22, s3, 11
buffer_store_dwordx4 v[56:59], v1, s[4:7], s31 offen sc1
v_mfma_f32_16x16x32_bf16 v[100:103], a[136:139], a[0:3], v[100:103]
s_waitcnt lgkmcnt(5)
s_add_u32 s31, s31, s34
ds_read_b64_tr_b16 a[128:129], v24 offset:0
v_mfma_f32_16x16x32_bf16 v[100:103], a[140:143], a[4:7], v[100:103]
s_add_u32 s67, s67, s22
v_mfma_f32_16x16x32_bf16 v[108:111], a[136:139], a[8:11], v[108:111]
s_add_u32 s67, s67, 33554432
ds_read_b64_tr_b16 a[130:131], v24 offset:2048
v_mfma_f32_16x16x32_bf16 v[108:111], a[140:143], a[12:15], v[108:111]
s_mov_b32 s68, 1035512379
ds_read_b128 a[92:95], v3 offset:22528
v_mfma_f32_16x16x32_bf16 v[116:119], a[136:139], a[16:19], v[116:119]
s_mov_b32 s69, 1035512379
ds_read_b64_tr_b16 a[132:133], v24 offset:16384
v_mfma_f32_16x16x32_bf16 v[116:119], a[140:143], a[20:23], v[116:119]
buffer_store_dwordx4 v[64:67], v1, s[4:7], s31 offen sc1
v_mfma_f32_16x16x32_bf16 v[124:127], a[136:139], a[24:27], v[124:127]
s_add_u32 s31, s31, s32
ds_read_b64_tr_b16 a[134:135], v24 offset:18432
v_add_u32 v24, 32768, v24
v_mfma_f32_16x16x32_bf16 v[124:127], a[140:143], a[28:31], v[124:127]
v_mfma_f32_16x16x32_bf16 v[132:135], a[136:139], a[32:35], v[132:135]
ds_read_b128 a[96:99], v2 offset:24576
v_mfma_f32_16x16x32_bf16 v[132:135], a[140:143], a[36:39], v[132:135]
v_mfma_f32_16x16x32_bf16 v[140:143], a[136:139], a[40:43], v[140:143]
ds_read_b128 a[100:103], v3 offset:24576
v_mfma_f32_16x16x32_bf16 v[140:143], a[140:143], a[44:47], v[140:143]
ds_read_b128 a[104:107], v2 offset:26624
v_mfma_f32_16x16x32_bf16 v[148:151], a[136:139], a[48:51], v[148:151]
ds_read_b128 a[108:111], v3 offset:26624
v_mfma_f32_16x16x32_bf16 v[148:151], a[140:143], a[52:55], v[148:151]
v_mfma_f32_16x16x32_bf16 v[156:159], a[136:139], a[56:59], v[156:159]
ds_read_b128 a[112:115], v2 offset:28672
v_mfma_f32_16x16x32_bf16 v[156:159], a[140:143], a[60:63], v[156:159]
s_waitcnt lgkmcnt(5)
buffer_store_dwordx4 v[72:75], v1, s[4:7], s31 offen sc1
v_mfma_f32_16x16x32_bf16 v[164:167], a[128:131], a[0:3], v[164:167]
s_add_u32 s31, s31, s33
ds_read_b64_tr_b16 a[136:137], v25 offset:0
v_mfma_f32_16x16x32_bf16 v[164:167], a[132:135], a[4:7], v[164:167]
v_mfma_f32_16x16x32_bf16 v[172:175], a[128:131], a[8:11], v[172:175]
ds_read_b64_tr_b16 a[138:139], v25 offset:2048
v_mfma_f32_16x16x32_bf16 v[172:175], a[132:135], a[12:15], v[172:175]
ds_read_b128 a[116:119], v3 offset:28672
v_mfma_f32_16x16x32_bf16 v[180:183], a[128:131], a[16:19], v[180:183]
ds_read_b64_tr_b16 a[140:141], v25 offset:16384
v_mfma_f32_16x16x32_bf16 v[180:183], a[132:135], a[20:23], v[180:183]
v_mfma_f32_16x16x32_bf16 v[188:191], a[128:131], a[24:27], v[188:191]
ds_read_b64_tr_b16 a[142:143], v25 offset:18432
v_add_u32 v25, 32768, v25
v_mfma_f32_16x16x32_bf16 v[188:191], a[132:135], a[28:31], v[188:191]
v_mfma_f32_16x16x32_bf16 v[196:199], a[128:131], a[32:35], v[196:199]
ds_read_b128 a[120:123], v2 offset:30720
v_mfma_f32_16x16x32_bf16 v[196:199], a[132:135], a[36:39], v[196:199]
buffer_store_dwordx4 v[80:83], v1, s[4:7], s31 offen sc1
v_mfma_f32_16x16x32_bf16 v[204:207], a[128:131], a[40:43], v[204:207]
s_add_u32 s31, s31, s32
ds_read_b128 a[124:127], v3 offset:30720
v_mfma_f32_16x16x32_bf16 v[204:207], a[132:135], a[44:47], v[204:207]
v_mfma_f32_16x16x32_bf16 v[212:215], a[128:131], a[48:51], v[212:215]
v_mfma_f32_16x16x32_bf16 v[212:215], a[132:135], a[52:55], v[212:215]
v_mfma_f32_16x16x32_bf16 v[220:223], a[128:131], a[56:59], v[220:223]
v_mfma_f32_16x16x32_bf16 v[220:223], a[132:135], a[60:63], v[220:223]
s_waitcnt vmcnt(17) lgkmcnt(0)
s_barrier
v_mfma_f32_16x16x32_bf16 v[224:227], a[136:139], a[0:3], v[224:227]
ds_read_b64_tr_b16 a[128:129], v22 offset:0
v_mfma_f32_16x16x32_bf16 v[224:227], a[140:143], a[4:7], v[224:227]
v_mfma_f32_16x16x32_bf16 v[228:231], a[136:139], a[8:11], v[228:231]
ds_read_b64_tr_b16 a[130:131], v22 offset:2048
v_mfma_f32_16x16x32_bf16 v[228:231], a[140:143], a[12:15], v[228:231]
buffer_store_dwordx4 v[88:91], v1, s[4:7], s31 offen sc1
v_mfma_f32_16x16x32_bf16 v[232:235], a[136:139], a[16:19], v[232:235]
ds_read_b64_tr_b16 a[132:133], v22 offset:16384
v_mfma_f32_16x16x32_bf16 v[232:235], a[140:143], a[20:23], v[232:235]
v_mfma_f32_16x16x32_bf16 v[236:239], a[136:139], a[24:27], v[236:239]
ds_read_b64_tr_b16 a[134:135], v22 offset:18432
v_add_u32 v22, 32768, v22
v_mfma_f32_16x16x32_bf16 v[236:239], a[140:143], a[28:31], v[236:239]
v_mfma_f32_16x16x32_bf16 v[240:243], a[136:139], a[32:35], v[240:243]
v_mfma_f32_16x16x32_bf16 v[240:243], a[140:143], a[36:39], v[240:243]
v_mfma_f32_16x16x32_bf16 v[244:247], a[136:139], a[40:43], v[244:247]
v_mfma_f32_16x16x32_bf16 v[244:247], a[140:143], a[44:47], v[244:247]
v_mfma_f32_16x16x32_bf16 v[248:251], a[136:139], a[48:51], v[248:251]
v_mfma_f32_16x16x32_bf16 v[248:251], a[140:143], a[52:55], v[248:251]
v_mfma_f32_16x16x32_bf16 v[252:255], a[136:139], a[56:59], v[252:255]
v_mfma_f32_16x16x32_bf16 v[252:255], a[140:143], a[60:63], v[252:255]
s_waitcnt lgkmcnt(0)
v_mfma_f32_16x16x32_bf16 v[36:39], a[128:131], a[64:67], v[36:39]
ds_read_b64_tr_b16 a[136:137], v23 offset:0
v_mfma_f32_16x16x32_bf16 v[36:39], a[132:135], a[68:71], v[36:39]
v_mfma_f32_16x16x32_bf16 v[44:47], a[128:131], a[72:75], v[44:47]
ds_read_b64_tr_b16 a[138:139], v23 offset:2048
v_mfma_f32_16x16x32_bf16 v[44:47], a[132:135], a[76:79], v[44:47]
ds_read_b128 a[0:3], v2 offset:32768
ds_read_b128 a[4:7], v3 offset:32768
v_mfma_f32_16x16x32_bf16 v[52:55], a[128:131], a[80:83], v[52:55]
ds_read_b64_tr_b16 a[140:141], v23 offset:16384
v_mfma_f32_16x16x32_bf16 v[52:55], a[132:135], a[84:87], v[52:55]
v_mfma_f32_16x16x32_bf16 v[60:63], a[128:131], a[88:91], v[60:63]
ds_read_b64_tr_b16 a[142:143], v23 offset:18432
v_add_u32 v23, 32768, v23
v_mfma_f32_16x16x32_bf16 v[60:63], a[132:135], a[92:95], v[60:63]
v_mfma_f32_16x16x32_bf16 v[68:71], a[128:131], a[96:99], v[68:71]
ds_read_b128 a[8:11], v2 offset:34816
v_mfma_f32_16x16x32_bf16 v[68:71], a[132:135], a[100:103], v[68:71]
v_mfma_f32_16x16x32_bf16 v[76:79], a[128:131], a[104:107], v[76:79]
ds_read_b128 a[12:15], v3 offset:34816
v_mfma_f32_16x16x32_bf16 v[76:79], a[132:135], a[108:111], v[76:79]
ds_read_b128 a[16:19], v2 offset:36864
v_mfma_f32_16x16x32_bf16 v[84:87], a[128:131], a[112:115], v[84:87]
ds_read_b128 a[20:23], v3 offset:36864
v_mfma_f32_16x16x32_bf16 v[84:87], a[132:135], a[116:119], v[84:87]
v_mfma_f32_16x16x32_bf16 v[92:95], a[128:131], a[120:123], v[92:95]
ds_read_b128 a[24:27], v2 offset:38912
v_mfma_f32_16x16x32_bf16 v[92:95], a[132:135], a[124:127], v[92:95]
s_waitcnt lgkmcnt(5)
v_mfma_f32_16x16x32_bf16 v[100:103], a[136:139], a[64:67], v[100:103]
ds_read_b64_tr_b16 a[128:129], v24 offset:0
v_mfma_f32_16x16x32_bf16 v[100:103], a[140:143], a[68:71], v[100:103]
v_mfma_f32_16x16x32_bf16 v[108:111], a[136:139], a[72:75], v[108:111]
ds_read_b64_tr_b16 a[130:131], v24 offset:2048
v_mfma_f32_16x16x32_bf16 v[108:111], a[140:143], a[76:79], v[108:111]
ds_read_b128 a[28:31], v3 offset:38912
v_mfma_f32_16x16x32_bf16 v[116:119], a[136:139], a[80:83], v[116:119]
ds_read_b64_tr_b16 a[132:133], v24 offset:16384
v_mfma_f32_16x16x32_bf16 v[116:119], a[140:143], a[84:87], v[116:119]
v_mfma_f32_16x16x32_bf16 v[124:127], a[136:139], a[88:91], v[124:127]
ds_read_b64_tr_b16 a[134:135], v24 offset:18432
v_add_u32 v24, 32768, v24
v_mfma_f32_16x16x32_bf16 v[124:127], a[140:143], a[92:95], v[124:127]
v_mfma_f32_16x16x32_bf16 v[132:135], a[136:139], a[96:99], v[132:135]
ds_read_b128 a[32:35], v2 offset:40960
v_mfma_f32_16x16x32_bf16 v[132:135], a[140:143], a[100:103], v[132:135]
v_mfma_f32_16x16x32_bf16 v[140:143], a[136:139], a[104:107], v[140:143]
ds_read_b128 a[36:39], v3 offset:40960
v_mfma_f32_16x16x32_bf16 v[140:143], a[140:143], a[108:111], v[140:143]
ds_read_b128 a[40:43], v2 offset:43008
v_mfma_f32_16x16x32_bf16 v[148:151], a[136:139], a[112:115], v[148:151]
ds_read_b128 a[44:47], v3 offset:43008
v_mfma_f32_16x16x32_bf16 v[148:151], a[140:143], a[116:119], v[148:151]
v_mfma_f32_16x16x32_bf16 v[156:159], a[136:139], a[120:123], v[156:159]
ds_read_b128 a[48:51], v2 offset:45056
v_mfma_f32_16x16x32_bf16 v[156:159], a[140:143], a[124:127], v[156:159]
s_waitcnt lgkmcnt(5)
v_mfma_f32_16x16x32_bf16 v[164:167], a[128:131], a[64:67], v[164:167]
ds_read_b64_tr_b16 a[136:137], v25 offset:0
v_mfma_f32_16x16x32_bf16 v[164:167], a[132:135], a[68:71], v[164:167]
v_mfma_f32_16x16x32_bf16 v[172:175], a[128:131], a[72:75], v[172:175]
ds_read_b64_tr_b16 a[138:139], v25 offset:2048
v_mfma_f32_16x16x32_bf16 v[172:175], a[132:135], a[76:79], v[172:175]
ds_read_b128 a[52:55], v3 offset:45056
v_mfma_f32_16x16x32_bf16 v[180:183], a[128:131], a[80:83], v[180:183]
ds_read_b64_tr_b16 a[140:141], v25 offset:16384
v_mfma_f32_16x16x32_bf16 v[180:183], a[132:135], a[84:87], v[180:183]
v_mfma_f32_16x16x32_bf16 v[188:191], a[128:131], a[88:91], v[188:191]
ds_read_b64_tr_b16 a[142:143], v25 offset:18432
v_add_u32 v25, 32768, v25
v_mfma_f32_16x16x32_bf16 v[188:191], a[132:135], a[92:95], v[188:191]
v_mfma_f32_16x16x32_bf16 v[196:199], a[128:131], a[96:99], v[196:199]
ds_read_b128 a[56:59], v2 offset:47104
v_mfma_f32_16x16x32_bf16 v[196:199], a[132:135], a[100:103], v[196:199]
v_mfma_f32_16x16x32_bf16 v[204:207], a[128:131], a[104:107], v[204:207]
ds_read_b128 a[60:63], v3 offset:47104
v_mfma_f32_16x16x32_bf16 v[204:207], a[132:135], a[108:111], v[204:207]
v_mfma_f32_16x16x32_bf16 v[212:215], a[128:131], a[112:115], v[212:215]
v_mfma_f32_16x16x32_bf16 v[212:215], a[132:135], a[116:119], v[212:215]
v_mfma_f32_16x16x32_bf16 v[220:223], a[128:131], a[120:123], v[220:223]
v_mfma_f32_16x16x32_bf16 v[220:223], a[132:135], a[124:127], v[220:223]
s_waitcnt vmcnt(0) lgkmcnt(0)
s_barrier
v_mfma_f32_16x16x32_bf16 v[224:227], a[136:139], a[64:67], v[224:227]
ds_read_b64_tr_b16 a[128:129], v22 offset:0
v_mfma_f32_16x16x32_bf16 v[224:227], a[140:143], a[68:71], v[224:227]
buffer_store_dword v27, v26, s[4:7], s66 offen sc1
v_mfma_f32_16x16x32_bf16 v[228:231], a[136:139], a[72:75], v[228:231]
ds_read_b64_tr_b16 a[130:131], v22 offset:2048
v_mfma_f32_16x16x32_bf16 v[228:231], a[140:143], a[76:79], v[228:231]
v_mfma_f32_16x16x32_bf16 v[232:235], a[136:139], a[80:83], v[232:235]
ds_read_b64_tr_b16 a[132:133], v22 offset:16384
v_mfma_f32_16x16x32_bf16 v[232:235], a[140:143], a[84:87], v[232:235]
v_mfma_f32_16x16x32_bf16 v[236:239], a[136:139], a[88:91], v[236:239]
ds_read_b64_tr_b16 a[134:135], v22 offset:18432
v_mfma_f32_16x16x32_bf16 v[236:239], a[140:143], a[92:95], v[236:239]
v_mfma_f32_16x16x32_bf16 v[240:243], a[136:139], a[96:99], v[240:243]
v_mfma_f32_16x16x32_bf16 v[240:243], a[140:143], a[100:103], v[240:243]
v_mfma_f32_16x16x32_bf16 v[244:247], a[136:139], a[104:107], v[244:247]
v_mfma_f32_16x16x32_bf16 v[244:247], a[140:143], a[108:111], v[244:247]
v_mfma_f32_16x16x32_bf16 v[248:251], a[136:139], a[112:115], v[248:251]
v_mfma_f32_16x16x32_bf16 v[248:251], a[140:143], a[116:119], v[248:251]
v_mfma_f32_16x16x32_bf16 v[252:255], a[136:139], a[120:123], v[252:255]
v_mfma_f32_16x16x32_bf16 v[252:255], a[140:143], a[124:127], v[252:255]
s_waitcnt lgkmcnt(0)
v_mfma_f32_16x16x32_bf16 v[36:39], a[128:131], a[0:3], v[36:39]
s_lshl_b32 s18, s3, 13
ds_read_b64_tr_b16 a[136:137], v23 offset:0
v_lshrrev_b32 v28, 6, v0
v_mfma_f32_16x16x32_bf16 v[36:39], a[132:135], a[4:7], v[36:39]
s_lshl_b32 s30, s20, 20
v_lshl_add_u32 v28, v28, 11, v1
v_add_u32 v28, 65536, v28
v_mfma_f32_16x16x32_bf16 v[44:47], a[128:131], a[8:11], v[44:47]
s_add_u32 s30, s30, s18
ds_read_b64_tr_b16 a[138:139], v23 offset:2048
v_lshrrev_b32 v3, 6, v0
v_mfma_f32_16x16x32_bf16 v[44:47], a[132:135], a[12:15], v[44:47]
s_lshl_b32 s22, s21, 1
v_and_b32 v4, 63, v0
v_add_u32 v2, 0x10000, v1
v_mfma_f32_16x16x32_bf16 v[52:55], a[128:131], a[16:19], v[52:55]
s_and_b32 s84, s2, 1
ds_read_b64_tr_b16 a[140:141], v23 offset:16384
v_and_b32 v5, 15, v4
v_mfma_f32_16x16x32_bf16 v[52:55], a[132:135], a[20:23], v[52:55]
s_mul_i32 s84, s84, 0
v_lshrrev_b32 v6, 4, v4
v_lshlrev_b32 v6, 2, v6
v_mfma_f32_16x16x32_bf16 v[60:63], a[128:131], a[24:27], v[60:63]
s_add_u32 s84, s84, 2386092
ds_read_b64_tr_b16 a[142:143], v23 offset:18432
v_sub_u32 v5, v5, v6
v_mfma_f32_16x16x32_bf16 v[60:63], a[132:135], a[28:31], v[60:63]
s_lshl_b32 s85, s21, 2
v_lshl_add_u32 v5, v3, 4, v5
v_cmp_gt_i32 s[32:33], 0, v5
v_mfma_f32_16x16x32_bf16 v[68:71], a[128:131], a[32:35], v[68:71]
s_lshr_b32 s85, s84, s85
v_cmp_gt_i32 s[34:35], 1, v5
v_cmp_gt_i32 s[36:37], 2, v5
v_mfma_f32_16x16x32_bf16 v[68:71], a[132:135], a[36:39], v[68:71]
s_and_b32 s9, s85, 15
v_cmp_gt_i32 s[38:39], 3, v5
v_cmp_gt_i32 s[40:41], 16, v5
v_mfma_f32_16x16x32_bf16 v[76:79], a[128:131], a[40:43], v[76:79]
s_and_b32 s84, s85, 1
v_cmp_gt_i32 s[42:43], 17, v5
v_cmp_gt_i32 s[44:45], 18, v5
v_mfma_f32_16x16x32_bf16 v[76:79], a[132:135], a[44:47], v[76:79]
s_lshl_b32 s84, s84, 17
v_cmp_gt_i32 s[46:47], 19, v5
v_cmp_gt_i32 s[48:49], 32, v5
v_mfma_f32_16x16x32_bf16 v[84:87], a[128:131], a[48:51], v[84:87]
s_add_u32 s84, s84, s18
v_cmp_gt_i32 s[50:51], 33, v5
v_cmp_gt_i32 s[52:53], 34, v5
v_mfma_f32_16x16x32_bf16 v[84:87], a[132:135], a[52:55], v[84:87]
s_xor_b32 s85, s84, 0x20000
v_cmp_gt_i32 s[54:55], 35, v5
v_cmp_gt_i32 s[56:57], 48, v5
v_mfma_f32_16x16x32_bf16 v[92:95], a[128:131], a[56:59], v[92:95]
s_sub_u32 s29, 15, s21
v_cmp_gt_i32 s[58:59], 49, v5
v_cmp_gt_i32 s[60:61], 50, v5
v_mfma_f32_16x16x32_bf16 v[92:95], a[132:135], a[60:63], v[92:95]
s_waitcnt lgkmcnt(0)
v_cmp_gt_i32 s[62:63], 51, v5
v_mov_b32 v7, 0xff800000
v_mfma_f32_16x16x32_bf16 v[100:103], a[136:139], a[0:3], v[100:103]
s_cmp_lg_u32 s9, 0
ds_read_b64_tr_b16 a[128:129], v24 offset:0
v_mov_b32 v6, 1
v_mfma_f32_16x16x32_bf16 v[100:103], a[140:143], a[4:7], v[100:103]
s_cselect_b32 s24, 1, 0
v_mov_b32 v5, v26
v_add_u32 v4, 0x20000, v1
v_mfma_f32_16x16x32_bf16 v[108:111], a[136:139], a[8:11], v[108:111]
s_cselect_b32 s67, s67, 3221225472
ds_read_b64_tr_b16 a[130:131], v24 offset:2048
v_mfma_f32_16x16x32_bf16 v[108:111], a[140:143], a[12:15], v[108:111]
s_lshl_b32 s8, s9, 15
v_mfma_f32_16x16x32_bf16 v[116:119], a[136:139], a[16:19], v[116:119]
s_add_u32 s8, s8, s30
ds_read_b64_tr_b16 a[132:133], v24 offset:16384
v_mfma_f32_16x16x32_bf16 v[116:119], a[140:143], a[20:23], v[116:119]
s_add_u32 s9, s9, s22
v_mfma_f32_16x16x32_bf16 v[124:127], a[136:139], a[24:27], v[124:127]
s_sub_u32 s9, 32, s9
ds_read_b64_tr_b16 a[134:135], v24 offset:18432
v_mul_f32 v36, s68, v36
v_mfma_f32_16x16x32_bf16 v[124:127], a[140:143], a[28:31], v[124:127]
s_bitcmp1_b32 s2, 4
v_mul_f32 v37, s68, v37
v_mul_f32 v38, s68, v38
v_mfma_f32_16x16x32_bf16 v[132:135], a[136:139], a[32:35], v[132:135]
s_cselect_b32 s9, 16, s9
v_mul_f32 v39, s68, v39
v_mul_f32 v100, s68, v100
v_mfma_f32_16x16x32_bf16 v[132:135], a[140:143], a[36:39], v[132:135]
s_cselect_b32 s29, 7, s29
v_mul_f32 v101, s68, v101
v_mul_f32 v102, s68, v102
v_mfma_f32_16x16x32_bf16 v[140:143], a[136:139], a[40:43], v[140:143]
s_mov_b32 s10, 3221225472
v_mul_f32 v103, s68, v103
v_cvt_pk_bf16_f32 v36, v36, v37
v_mfma_f32_16x16x32_bf16 v[140:143], a[140:143], a[44:47], v[140:143]
s_mov_b32 s14, 3221225472
v_cvt_pk_bf16_f32 v37, v38, v39
v_cvt_pk_bf16_f32 v38, v100, v101
v_mfma_f32_16x16x32_bf16 v[148:151], a[136:139], a[48:51], v[148:151]
s_mov_b32 s11, 0
v_cvt_pk_bf16_f32 v39, v102, v103
v_mul_f32 v44, s68, v44
v_mfma_f32_16x16x32_bf16 v[148:151], a[140:143], a[52:55], v[148:151]
s_lshr_b32 s19, s9, 1
ds_write_b128 v28, v[36:39] offset:0
v_mul_f32 v45, s68, v45
v_mfma_f32_16x16x32_bf16 v[156:159], a[136:139], a[56:59], v[156:159]
s_sub_u32 s19, s19, 1
s_add_u32 s23, s67, 0
buffer_store_dwordx4 v[36:39], v1, s[4:7], s23 offen offset:0 sc1
v_mfma_f32_16x16x32_bf16 v[156:159], a[140:143], a[60:63], v[156:159]
s_waitcnt lgkmcnt(1)
v_mul_f32 v46, s68, v46
v_mul_f32 v47, s68, v47
v_mfma_f32_16x16x32_bf16 v[164:167], a[128:131], a[0:3], v[164:167]
s_add_u32 s12, s8, 16777216
ds_read_b64_tr_b16 a[136:137], v25 offset:0
v_mul_f32 v108, s68, v108
v_mfma_f32_16x16x32_bf16 v[164:167], a[132:135], a[4:7], v[164:167]
s_mov_b32 s13, s9
v_mul_f32 v109, s68, v109
v_mul_f32 v110, s68, v110
v_mfma_f32_16x16x32_bf16 v[172:175], a[128:131], a[8:11], v[172:175]
s_mov_b32 s15, s11
ds_read_b64_tr_b16 a[138:139], v25 offset:2048
v_mul_f32 v111, s68, v111
v_mfma_f32_16x16x32_bf16 v[172:175], a[132:135], a[12:15], v[172:175]
v_cvt_pk_bf16_f32 v44, v44, v45
v_cvt_pk_bf16_f32 v45, v46, v47
v_mfma_f32_16x16x32_bf16 v[180:183], a[128:131], a[16:19], v[180:183]
ds_read_b64_tr_b16 a[140:141], v25 offset:16384
v_cvt_pk_bf16_f32 v46, v108, v109
v_mfma_f32_16x16x32_bf16 v[180:183], a[132:135], a[20:23], v[180:183]
v_cvt_pk_bf16_f32 v47, v110, v111
v_mul_f32 v52, s68, v52
v_mfma_f32_16x16x32_bf16 v[188:191], a[128:131], a[24:27], v[188:191]
ds_read_b64_tr_b16 a[142:143], v25 offset:18432
v_mul_f32 v53, s68, v53
v_mfma_f32_16x16x32_bf16 v[188:191], a[132:135], a[28:31], v[188:191]
ds_write_b128 v28, v[44:47] offset:8192
v_mul_f32 v54, s68, v54
v_mfma_f32_16x16x32_bf16 v[196:199], a[128:131], a[32:35], v[196:199]
s_add_u32 s23, s67, 8192
buffer_store_dwordx4 v[44:47], v1, s[4:7], s23 offen offset:0 sc1
v_mfma_f32_16x16x32_bf16 v[196:199], a[132:135], a[36:39], v[196:199]
v_mul_f32 v55, s68, v55
v_mul_f32 v116, s68, v116
v_mfma_f32_16x16x32_bf16 v[204:207], a[128:131], a[40:43], v[204:207]
v_mul_f32 v117, s68, v117
v_mul_f32 v118, s68, v118
v_mfma_f32_16x16x32_bf16 v[204:207], a[132:135], a[44:47], v[204:207]
v_mul_f32 v119, s68, v119
v_cvt_pk_bf16_f32 v52, v52, v53
v_mfma_f32_16x16x32_bf16 v[212:215], a[128:131], a[48:51], v[212:215]
v_cvt_pk_bf16_f32 v53, v54, v55
v_cvt_pk_bf16_f32 v54, v116, v117
v_mfma_f32_16x16x32_bf16 v[212:215], a[132:135], a[52:55], v[212:215]
v_cvt_pk_bf16_f32 v55, v118, v119
v_mul_f32 v60, s68, v60
v_mfma_f32_16x16x32_bf16 v[220:223], a[128:131], a[56:59], v[220:223]
ds_write_b128 v28, v[52:55] offset:16384
v_mul_f32 v61, s68, v61
v_mfma_f32_16x16x32_bf16 v[220:223], a[132:135], a[60:63], v[220:223]
s_waitcnt lgkmcnt(0)
s_waitcnt lgkmcnt(0)
s_barrier
v_mfma_f32_16x16x32_bf16 v[224:227], a[136:139], a[0:3], v[224:227]
s_add_u32 s23, s67, 16384
buffer_store_dwordx4 v[52:55], v1, s[4:7], s23 offen offset:0 sc1
v_mfma_f32_16x16x32_bf16 v[224:227], a[140:143], a[4:7], v[224:227]
v_mul_f32 v62, s68, v62
v_mul_f32 v63, s68, v63
v_mfma_f32_16x16x32_bf16 v[228:231], a[136:139], a[8:11], v[228:231]
v_mul_f32 v124, s68, v124
v_mul_f32 v125, s68, v125
v_mfma_f32_16x16x32_bf16 v[228:231], a[140:143], a[12:15], v[228:231]
v_mul_f32 v126, s68, v126
v_mul_f32 v127, s68, v127
v_mfma_f32_16x16x32_bf16 v[232:235], a[136:139], a[16:19], v[232:235]
v_cvt_pk_bf16_f32 v60, v60, v61
v_cvt_pk_bf16_f32 v61, v62, v63
v_mfma_f32_16x16x32_bf16 v[232:235], a[140:143], a[20:23], v[232:235]
v_cvt_pk_bf16_f32 v62, v124, v125
v_cvt_pk_bf16_f32 v63, v126, v127
v_mfma_f32_16x16x32_bf16 v[236:239], a[136:139], a[24:27], v[236:239]
ds_write_b128 v28, v[60:63] offset:24576
v_mul_f32 v68, s68, v68
v_mfma_f32_16x16x32_bf16 v[236:239], a[140:143], a[28:31], v[236:239]
s_add_u32 s23, s67, 24576
buffer_store_dwordx4 v[60:63], v1, s[4:7], s23 offen offset:0 sc1
v_mfma_f32_16x16x32_bf16 v[240:243], a[136:139], a[32:35], v[240:243]
v_mul_f32 v69, s68, v69
v_mul_f32 v70, s68, v70
v_mfma_f32_16x16x32_bf16 v[240:243], a[140:143], a[36:39], v[240:243]
v_mul_f32 v71, s68, v71
v_mul_f32 v132, s68, v132
v_mfma_f32_16x16x32_bf16 v[244:247], a[136:139], a[40:43], v[244:247]
v_mul_f32 v133, s68, v133
v_mul_f32 v134, s68, v134
v_mfma_f32_16x16x32_bf16 v[244:247], a[140:143], a[44:47], v[244:247]
v_mul_f32 v135, s68, v135
v_cvt_pk_bf16_f32 v68, v68, v69
v_mfma_f32_16x16x32_bf16 v[248:251], a[136:139], a[48:51], v[248:251]
v_cvt_pk_bf16_f32 v69, v70, v71
v_cvt_pk_bf16_f32 v70, v132, v133
v_mfma_f32_16x16x32_bf16 v[248:251], a[140:143], a[52:55], v[248:251]
v_cvt_pk_bf16_f32 v71, v134, v135
v_mfma_f32_16x16x32_bf16 v[252:255], a[136:139], a[56:59], v[252:255]
ds_write_b128 v28, v[68:71] offset:32768
v_mfma_f32_16x16x32_bf16 v[252:255], a[140:143], a[60:63], v[252:255]
s_add_u32 s23, s67, 32768
buffer_store_dwordx4 v[68:71], v1, s[4:7], s23 offen offset:0 sc1
buffer_load_dword v21, v20, s[4:7], s70 offen sc1
v_pk_mul_f32 v[76:77], v[76:77], s[68:69]
v_pk_mul_f32 v[78:79], v[78:79], s[68:69]
v_pk_mul_f32 v[140:141], v[140:141], s[68:69]
v_pk_mul_f32 v[142:143], v[142:143], s[68:69]
v_cvt_pk_bf16_f32 v76, v76, v77
v_cvt_pk_bf16_f32 v77, v78, v79
v_cvt_pk_bf16_f32 v78, v140, v141
v_cvt_pk_bf16_f32 v79, v142, v143
ds_write_b128 v28, v[76:79] offset:40960
s_add_u32 s23, s67, 40960
buffer_store_dwordx4 v[76:79], v1, s[4:7], s23 offen offset:0 sc1
v_pk_mul_f32 v[84:85], v[84:85], s[68:69]
v_pk_mul_f32 v[86:87], v[86:87], s[68:69]
v_pk_mul_f32 v[148:149], v[148:149], s[68:69]
v_pk_mul_f32 v[150:151], v[150:151], s[68:69]
v_cvt_pk_bf16_f32 v84, v84, v85
v_cvt_pk_bf16_f32 v85, v86, v87
v_cvt_pk_bf16_f32 v86, v148, v149
v_cvt_pk_bf16_f32 v87, v150, v151
ds_write_b128 v28, v[84:87] offset:49152
s_add_u32 s23, s67, 49152
buffer_store_dwordx4 v[84:87], v1, s[4:7], s23 offen offset:0 sc1
v_pk_mul_f32 v[92:93], v[92:93], s[68:69]
v_pk_mul_f32 v[94:95], v[94:95], s[68:69]
v_pk_mul_f32 v[156:157], v[156:157], s[68:69]
v_pk_mul_f32 v[158:159], v[158:159], s[68:69]
v_cvt_pk_bf16_f32 v92, v92, v93
v_cvt_pk_bf16_f32 v93, v94, v95
v_cvt_pk_bf16_f32 v94, v156, v157
v_cvt_pk_bf16_f32 v95, v158, v159
ds_write_b128 v28, v[92:95] offset:57344
s_add_u32 s23, s67, 57344
buffer_store_dwordx4 v[92:95], v1, s[4:7], s23 offen offset:0 sc1
v_pk_mul_f32 v[164:165], v[164:165], s[68:69]
v_pk_mul_f32 v[166:167], v[166:167], s[68:69]
v_pk_mul_f32 v[224:225], v[224:225], s[68:69]
v_pk_mul_f32 v[226:227], v[226:227], s[68:69]
v_cvt_pk_bf16_f32 v164, v164, v165
v_cvt_pk_bf16_f32 v165, v166, v167
v_cvt_pk_bf16_f32 v166, v224, v225
v_cvt_pk_bf16_f32 v167, v226, v227
ds_write_b128 v28, v[164:167] offset:1024
s_add_u32 s23, s67, 0
buffer_store_dwordx4 v[164:167], v1, s[4:7], s23 offen offset:1024 sc1
v_pk_mul_f32 v[172:173], v[172:173], s[68:69]
v_pk_mul_f32 v[174:175], v[174:175], s[68:69]
v_pk_mul_f32 v[228:229], v[228:229], s[68:69]
v_pk_mul_f32 v[230:231], v[230:231], s[68:69]
v_cvt_pk_bf16_f32 v172, v172, v173
v_cvt_pk_bf16_f32 v173, v174, v175
v_cvt_pk_bf16_f32 v174, v228, v229
v_cvt_pk_bf16_f32 v175, v230, v231
ds_write_b128 v28, v[172:175] offset:9216
s_add_u32 s23, s67, 8192
buffer_store_dwordx4 v[172:175], v1, s[4:7], s23 offen offset:1024 sc1
v_pk_mul_f32 v[180:181], v[180:181], s[68:69]
v_pk_mul_f32 v[182:183], v[182:183], s[68:69]
v_pk_mul_f32 v[232:233], v[232:233], s[68:69]
v_pk_mul_f32 v[234:235], v[234:235], s[68:69]
v_cvt_pk_bf16_f32 v180, v180, v181
v_cvt_pk_bf16_f32 v181, v182, v183
v_cvt_pk_bf16_f32 v182, v232, v233
v_cvt_pk_bf16_f32 v183, v234, v235
ds_write_b128 v28, v[180:183] offset:17408
s_add_u32 s23, s67, 16384
buffer_store_dwordx4 v[180:183], v1, s[4:7], s23 offen offset:1024 sc1
v_pk_mul_f32 v[188:189], v[188:189], s[68:69]
v_pk_mul_f32 v[190:191], v[190:191], s[68:69]
v_pk_mul_f32 v[236:237], v[236:237], s[68:69]
v_pk_mul_f32 v[238:239], v[238:239], s[68:69]
v_cvt_pk_bf16_f32 v188, v188, v189
v_cvt_pk_bf16_f32 v189, v190, v191
v_cvt_pk_bf16_f32 v190, v236, v237
v_cvt_pk_bf16_f32 v191, v238, v239
ds_write_b128 v28, v[188:191] offset:25600
s_add_u32 s23, s67, 24576
buffer_store_dwordx4 v[188:191], v1, s[4:7], s23 offen offset:1024 sc1
v_pk_mul_f32 v[196:197], v[196:197], s[68:69]
v_pk_mul_f32 v[198:199], v[198:199], s[68:69]
v_pk_mul_f32 v[240:241], v[240:241], s[68:69]
v_pk_mul_f32 v[242:243], v[242:243], s[68:69]
v_cvt_pk_bf16_f32 v196, v196, v197
v_cvt_pk_bf16_f32 v197, v198, v199
v_cvt_pk_bf16_f32 v198, v240, v241
v_cvt_pk_bf16_f32 v199, v242, v243
ds_write_b128 v28, v[196:199] offset:33792
s_add_u32 s23, s67, 32768
buffer_store_dwordx4 v[196:199], v1, s[4:7], s23 offen offset:1024 sc1
v_pk_mul_f32 v[204:205], v[204:205], s[68:69]
PAD_8:
s_cbranch_execz M_tret
v_pk_mul_f32 v[206:207], v[206:207], s[68:69]
v_pk_mul_f32 v[244:245], v[244:245], s[68:69]
v_pk_mul_f32 v[246:247], v[246:247], s[68:69]
v_cvt_pk_bf16_f32 v204, v204, v205
v_cvt_pk_bf16_f32 v205, v206, v207
v_cvt_pk_bf16_f32 v206, v244, v245
v_cvt_pk_bf16_f32 v207, v246, v247
ds_write_b128 v28, v[204:207] offset:41984
s_add_u32 s23, s67, 40960
buffer_store_dwordx4 v[204:207], v1, s[4:7], s23 offen offset:1024 sc1
v_pk_mul_f32 v[212:213], v[212:213], s[68:69]
v_pk_mul_f32 v[214:215], v[214:215], s[68:69]
v_pk_mul_f32 v[248:249], v[248:249], s[68:69]
v_pk_mul_f32 v[250:251], v[250:251], s[68:69]
v_cvt_pk_bf16_f32 v212, v212, v213
v_cvt_pk_bf16_f32 v213, v214, v215
v_cvt_pk_bf16_f32 v214, v248, v249
v_cvt_pk_bf16_f32 v215, v250, v251
ds_write_b128 v28, v[212:215] offset:50176
s_add_u32 s23, s67, 49152
buffer_store_dwordx4 v[212:215], v1, s[4:7], s23 offen offset:1024 sc1
v_pk_mul_f32 v[220:221], v[220:221], s[68:69]
v_pk_mul_f32 v[222:223], v[222:223], s[68:69]
v_pk_mul_f32 v[252:253], v[252:253], s[68:69]
v_pk_mul_f32 v[254:255], v[254:255], s[68:69]
v_cvt_pk_bf16_f32 v220, v220, v221
v_cvt_pk_bf16_f32 v221, v222, v223
v_cvt_pk_bf16_f32 v222, v252, v253
v_cvt_pk_bf16_f32 v223, v254, v255
ds_write_b128 v28, v[220:223] offset:58368
s_add_u32 s23, s67, 57344
buffer_store_dwordx4 v[220:223], v1, s[4:7], s23 offen offset:1024 sc1
s_waitcnt vmcnt(11)
v_cmp_gt_u32 vcc, 1, v21
s_cbranch_vccnz M_kspin
M_kok:
buffer_load_dword v21, v15, s[4:7], s70 offen sc1
s_mov_b32 m0, s84
s_nop 0
buffer_load_dwordx4 v1, s[4:7], s8 offen offset:0 sc1 lds
buffer_load_dwordx4 v1, s[4:7], s8 offen offset:1024 sc1 lds
buffer_load_dwordx4 v1, s[4:7], s8 offen offset:2048 sc1 lds
buffer_load_dwordx4 v1, s[4:7], s8 offen offset:3072 sc1 lds
s_add_u32 s8, s8, 4096
s_add_u32 m0, s84, 4096
s_nop 0
buffer_load_dwordx4 v1, s[4:7], s8 offen offset:0 sc1 lds
buffer_load_dwordx4 v1, s[4:7], s8 offen offset:1024 sc1 lds
buffer_load_dwordx4 v1, s[4:7], s8 offen offset:2048 sc1 lds
buffer_load_dwordx4 v1, s[4:7], s8 offen offset:3072 sc1 lds
s_add_u32 s8, s8, 28672
s_sub_u32 s9, s9, 1
s_cmp_eq_u32 s9, 0
s_cselect_b32 s8, s10, s8
s_cselect_b32 s9, s11, s9
s_cselect_b32 s10, 3221225472, s10
v_add_u32 v28, s18, v2
s_waitcnt lgkmcnt(0)
s_barrier
ds_read_b128 a[0:3], v28 offset:0
ds_read_b128 a[4:7], v28 offset:1024
ds_read_b128 a[8:11], v28 offset:2048
ds_read_b128 a[12:15], v28 offset:3072
ds_read_b128 a[16:19], v28 offset:4096
ds_read_b128 a[20:23], v28 offset:5120
ds_read_b128 a[24:27], v28 offset:6144
ds_read_b128 a[28:31], v28 offset:7168
ds_read_b128 a[32:35], v28 offset:32768
ds_read_b128 a[36:39], v28 offset:33792
ds_read_b128 a[40:43], v28 offset:34816
ds_read_b128 a[44:47], v28 offset:35840
ds_read_b128 a[48:51], v28 offset:36864
ds_read_b128 a[52:55], v28 offset:37888
ds_read_b128 a[56:59], v28 offset:38912
ds_read_b128 a[60:63], v28 offset:39936
s_mov_b32 m0, s85
s_nop 0
buffer_load_dwordx4 v1, s[4:7], s8 offen offset:0 sc1 lds
buffer_load_dwordx4 v1, s[4:7], s8 offen offset:1024 sc1 lds
buffer_load_dwordx4 v1, s[4:7], s8 offen offset:2048 sc1 lds
buffer_load_dwordx4 v1, s[4:7], s8 offen offset:3072 sc1 lds
s_add_u32 s8, s8, 4096
s_add_u32 m0, s85, 4096
s_nop 0
buffer_load_dwordx4 v1, s[4:7], s8 offen offset:0 sc1 lds
buffer_load_dwordx4 v1, s[4:7], s8 offen offset:1024 sc1 lds
buffer_load_dwordx4 v1, s[4:7], s8 offen offset:2048 sc1 lds
buffer_load_dwordx4 v1, s[4:7], s8 offen offset:3072 sc1 lds
s_add_u32 s8, s8, 28672
s_sub_u32 s9, s9, 1
s_cmp_eq_u32 s9, 0
s_cselect_b32 s8, s10, s8
s_cselect_b32 s9, s11, s9
s_cselect_b32 s10, 3221225472, s10
s_mov_b32 s25, 1266679808
s_lshl_b32 s22, s21, 3
s_xor_b32 s28, s70, 256
s_add_u32 s28, s28, s22
s_add_u32 s28, s28, 6148
s_lshl_b32 s26, s21, 16
s_add_u32 s26, s26, s30
s_add_u32 s26, s26, 33554432
s_xor_b32 s76, s20, 0
s_lshl_b32 s76, s76, 3
s_add_u32 s76, s76, s21
s_lshl_b32 s76, s76, 2
s_add_u32 s76, s76, s3
s_lshl_b32 s27, s76, 10
s_add_u32 s27, s27, 75497472
s_lshl_b32 s76, s76, 14
s_add_u32 s76, s76, 67108864
s_lshl_b32 s81, s20, 2
s_add_u32 s81, s81, s3
s_mul_i32 s81, s81, 57344
s_cmp_eq_u32 s24, 1
s_cselect_b32 s80, s28, s70
s_add_u32 s77, s76, 8192
v_lshrrev_b32 v8, 7, v1
v_and_b32 v9, 6, v8
v_lshlrev_b32 v9, 4, v9
v_and_b32 v10, 0x70, v1
v_xor_b32 v9, v9, v10
v_mul_u32_u24 v8, 896, v8
v_add_u32 v8, v8, v9
v_accvgpr_write_b32 a184, v8
v_add_u32 v8, 6144, v8
v_accvgpr_write_b32 a185, v8
v_add_u32 v8, 6144, v8
v_accvgpr_write_b32 a186, v8
v_add_u32 v8, 6144, v8
v_accvgpr_write_b32 a187, v8
v_lshrrev_b32 v8, 6, v1
v_bfe_u32 v9, v1, 7, 2
v_lshlrev_b32 v9, 5, v9
v_lshl_add_u32 v8, v8, 7, v9
v_bfe_u32 v9, v1, 4, 2
v_lshl_add_u32 v8, v9, 3, v8
v_add_u32 v8, 32768, v8
v_accvgpr_write_b32 a188, v8
v_xor_b32 v9, 32, v8
v_accvgpr_write_b32 a189, v9
v_xor_b32 v9, 64, v8
v_accvgpr_write_b32 a190, v9
v_xor_b32 v9, 96, v8
v_accvgpr_write_b32 a191, v9
s_add_u32 s22, s66, 16384
s_mov_b32 s71, 3221225472
s_waitcnt vmcnt(17)
s_barrier
buffer_store_dword v6, v5, s[4:7], s22 offen sc1
v_mov_b64 v[128:129], 0
v_mov_b64 v[130:131], 0
v_mov_b64 v[132:133], 0
v_mov_b64 v[134:135], 0
v_mov_b64 v[136:137], 0
v_mov_b64 v[138:139], 0
v_mov_b64 v[140:141], 0
v_mov_b64 v[142:143], 0
v_mov_b64 v[144:145], 0
v_mov_b64 v[146:147], 0
v_mov_b64 v[148:149], 0
v_mov_b64 v[150:151], 0
v_mov_b64 v[152:153], 0
v_mov_b64 v[154:155], 0
v_mov_b64 v[156:157], 0
v_mov_b64 v[158:159], 0
v_mov_b64 v[160:161], 0
v_mov_b64 v[162:163], 0
v_mov_b64 v[164:165], 0
v_mov_b64 v[166:167], 0
v_mov_b64 v[168:169], 0
v_mov_b64 v[170:171], 0
v_mov_b64 v[172:173], 0
v_mov_b64 v[174:175], 0
v_mov_b64 v[176:177], 0
v_mov_b64 v[178:179], 0
v_mov_b64 v[180:181], 0
v_mov_b64 v[182:183], 0
v_mov_b64 v[184:185], 0
v_mov_b64 v[186:187], 0
v_mov_b64 v[188:189], 0
v_mov_b64 v[190:191], 0
v_mov_b64 v[192:193], 0
v_mov_b64 v[194:195], 0
v_mov_b64 v[196:197], 0
v_mov_b64 v[198:199], 0
v_mov_b64 v[200:201], 0
v_mov_b64 v[202:203], 0
v_mov_b64 v[204:205], 0
v_mov_b64 v[206:207], 0
v_mov_b64 v[208:209], 0
v_mov_b64 v[210:211], 0
v_mov_b64 v[212:213], 0
v_mov_b64 v[214:215], 0
v_mov_b64 v[216:217], 0
v_mov_b64 v[218:219], 0
v_mov_b64 v[220:221], 0
v_mov_b64 v[222:223], 0
v_mov_b64 v[224:225], 0
v_mov_b64 v[226:227], 0
v_mov_b64 v[228:229], 0
v_mov_b64 v[230:231], 0
v_mov_b64 v[232:233], 0
v_mov_b64 v[234:235], 0
v_mov_b64 v[236:237], 0
v_mov_b64 v[238:239], 0
v_mov_b64 v[240:241], 0
v_mov_b64 v[242:243], 0
v_mov_b64 v[244:245], 0
v_mov_b64 v[246:247], 0
v_mov_b64 v[248:249], 0
v_mov_b64 v[250:251], 0
v_mov_b64 v[252:253], 0
v_mov_b64 v[254:255], 0
v_mov_b64 v[24:25], 0
s_cmp_eq_u32 s24, 9
s_cbranch_scc1 M_t2A
M_t2Ar:
s_waitcnt vmcnt(9) lgkmcnt(0)
v_cmp_gt_u32 vcc, 1, v21
s_cbranch_vccnz M_vspin
M_vok:
s_barrier
K2_item:
PAD_9:
s_cbranch_execz M_tret
s_cmp_eq_u32 s19, 0
s_cbranch_scc1 K2_p0d
ds_read_b128 a[64:67], v1 offset:0
ds_read_b128 a[68:71], v1 offset:1024
ds_read_b128 a[72:75], v1 offset:2048
ds_read_b128 a[76:79], v1 offset:3072
ds_read_b128 a[80:83], v1 offset:4096
ds_read_b128 a[84:87], v1 offset:5120
ds_read_b128 a[88:91], v1 offset:6144
ds_read_b128 a[92:95], v1 offset:7168
s_waitcnt lgkmcnt(7)
v_mfma_f32_16x16x32_bf16 v[32:35], a[64:67], a[0:3], 0
s_waitcnt lgkmcnt(6)
s_add_u32 m0, s18, 65536
ds_read_b128 a[96:99], v1 offset:8192
v_mfma_f32_16x16x32_bf16 v[32:35], a[68:71], a[4:7], v[32:35]
s_waitcnt lgkmcnt(6)
buffer_load_dwordx4 v1, s[4:7], s12 offen offset:0 sc1 lds
v_mfma_f32_16x16x32_bf16 v[32:35], a[72:75], a[8:11], v[32:35]
s_waitcnt lgkmcnt(5)
ds_read_b128 a[100:103], v1 offset:9216
v_mfma_f32_16x16x32_bf16 v[32:35], a[76:79], a[12:15], v[32:35]
s_waitcnt lgkmcnt(5)
buffer_load_dwordx4 v1, s[4:7], s12 offen offset:1024 sc1 lds
v_mfma_f32_16x16x32_bf16 v[32:35], a[80:83], a[16:19], v[32:35]
s_waitcnt lgkmcnt(4)
ds_read_b128 a[104:107], v1 offset:10240
v_mfma_f32_16x16x32_bf16 v[32:35], a[84:87], a[20:23], v[32:35]
s_waitcnt lgkmcnt(4)
buffer_load_dwordx4 v1, s[4:7], s12 offen offset:2048 sc1 lds
v_mfma_f32_16x16x32_bf16 v[32:35], a[88:91], a[24:27], v[32:35]
s_waitcnt lgkmcnt(3)
ds_read_b128 a[108:111], v1 offset:11264
v_mfma_f32_16x16x32_bf16 v[32:35], a[92:95], a[28:31], v[32:35]
buffer_load_dwordx4 v1, s[4:7], s12 offen offset:3072 sc1 lds
v_mfma_f32_16x16x32_bf16 v[36:39], a[64:67], a[32:35], 0
s_add_u32 s12, s12, 4096
s_add_u32 m0, s18, 69632
ds_read_b128 a[112:115], v1 offset:12288
v_mfma_f32_16x16x32_bf16 v[36:39], a[68:71], a[36:39], v[36:39]
buffer_load_dwordx4 v1, s[4:7], s12 offen offset:0 sc1 lds
v_mfma_f32_16x16x32_bf16 v[36:39], a[72:75], a[40:43], v[36:39]
ds_read_b128 a[116:119], v1 offset:13312
v_mfma_f32_16x16x32_bf16 v[36:39], a[76:79], a[44:47], v[36:39]
buffer_load_dwordx4 v1, s[4:7], s12 offen offset:1024 sc1 lds
v_mfma_f32_16x16x32_bf16 v[36:39], a[80:83], a[48:51], v[36:39]
ds_read_b128 a[120:123], v1 offset:14336
v_max3_f32 v28, v32, v33, v34
v_mfma_f32_16x16x32_bf16 v[36:39], a[84:87], a[52:55], v[36:39]
buffer_load_dwordx4 v1, s[4:7], s12 offen offset:2048 sc1 lds
v_mfma_f32_16x16x32_bf16 v[36:39], a[88:91], a[56:59], v[36:39]
ds_read_b128 a[124:127], v1 offset:15360
v_max_f32 v28, v28, v35
v_mfma_f32_16x16x32_bf16 v[36:39], a[92:95], a[60:63], v[36:39]
s_waitcnt lgkmcnt(4)
buffer_load_dwordx4 v1, s[4:7], s12 offen offset:3072 sc1 lds
v_mfma_f32_16x16x32_bf16 v[40:43], a[96:99], a[0:3], 0
s_add_u32 s12, s12, 28672
ds_read_b128 a[64:67], v1 offset:16384
v_mov_b32 v30, v28
v_mfma_f32_16x16x32_bf16 v[40:43], a[100:103], a[4:7], v[40:43]
s_waitcnt lgkmcnt(2)
s_sub_u32 s13, s13, 1
v_mfma_f32_16x16x32_bf16 v[40:43], a[104:107], a[8:11], v[40:43]
s_cmp_eq_u32 s13, 0
ds_read_b128 a[68:71], v1 offset:17408
v_permlane16_swap_b32 v28, v30
v_mfma_f32_16x16x32_bf16 v[40:43], a[108:111], a[12:15], v[40:43]
s_cselect_b32 s12, s14, s12
v_max_f32 v28, v28, v30
v_mov_b32 v30, v28
v_mfma_f32_16x16x32_bf16 v[40:43], a[112:115], a[16:19], v[40:43]
s_cselect_b32 s13, s15, s13
ds_read_b128 a[72:75], v1 offset:18432
v_max3_f32 v29, v36, v37, v38
v_mfma_f32_16x16x32_bf16 v[40:43], a[116:119], a[20:23], v[40:43]
s_cselect_b32 s14, 3221225472, s14
v_permlane32_swap_b32 v28, v30
v_max_f32 v28, v28, v30
v_mfma_f32_16x16x32_bf16 v[40:43], a[120:123], a[24:27], v[40:43]
s_waitcnt lgkmcnt(3)
ds_read_b128 a[76:79], v1 offset:19456
v_sub_f32 v16, 0, v28
v_mfma_f32_16x16x32_bf16 v[40:43], a[124:127], a[28:31], v[40:43]
v_sub_f32 v17, 0, v28
v_sub_f32 v18, 0, v28
v_mfma_f32_16x16x32_bf16 v[44:47], a[96:99], a[32:35], 0
ds_read_b128 a[80:83], v1 offset:20480
v_sub_f32 v19, 0, v28
v_mfma_f32_16x16x32_bf16 v[44:47], a[100:103], a[36:39], v[44:47]
v_max_f32 v29, v29, v39
v_mov_b32 v31, v29
v_mfma_f32_16x16x32_bf16 v[44:47], a[104:107], a[40:43], v[44:47]
ds_read_b128 a[84:87], v1 offset:21504
v_mfma_f32_16x16x32_bf16 v[44:47], a[108:111], a[44:47], v[44:47]
v_permlane16_swap_b32 v29, v31
v_max_f32 v29, v29, v31
v_mfma_f32_16x16x32_bf16 v[44:47], a[112:115], a[48:51], v[44:47]
ds_read_b128 a[88:91], v1 offset:22528
v_mov_b32 v31, v29
v_mfma_f32_16x16x32_bf16 v[44:47], a[116:119], a[52:55], v[44:47]
v_mfma_f32_16x16x32_bf16 v[44:47], a[120:123], a[56:59], v[44:47]
ds_read_b128 a[92:95], v1 offset:23552
v_permlane32_swap_b32 v29, v31
v_mfma_f32_16x16x32_bf16 v[44:47], a[124:127], a[60:63], v[44:47]
s_waitcnt lgkmcnt(4)
v_max_f32 v29, v29, v31
v_sub_f32 v20, 0, v29
v_mfma_f32_16x16x32_bf16 v[48:51], a[64:67], a[0:3], v[16:19]
ds_read_b128 a[96:99], v1 offset:24576
v_sub_f32 v21, 0, v29
v_mfma_f32_16x16x32_bf16 v[48:51], a[68:71], a[4:7], v[48:51]
v_sub_f32 v22, 0, v29
v_sub_f32 v23, 0, v29
v_mfma_f32_16x16x32_bf16 v[48:51], a[72:75], a[8:11], v[48:51]
ds_read_b128 a[100:103], v1 offset:25600
v_mfma_f32_16x16x32_bf16 v[48:51], a[76:79], a[12:15], v[48:51]
s_waitcnt lgkmcnt(4)
v_mfma_f32_16x16x32_bf16 v[48:51], a[80:83], a[16:19], v[48:51]
ds_read_b128 a[104:107], v1 offset:26624
v_mfma_f32_16x16x32_bf16 v[48:51], a[84:87], a[20:23], v[48:51]
s_waitcnt lgkmcnt(4)
v_add_f32 v32, v32, v16
v_add_f32 v33, v33, v16
v_add_f32 v34, v34, v16
v_add_f32 v35, v35, v16
v_mfma_f32_16x16x32_bf16 v[48:51], a[88:91], a[24:27], v[48:51]
s_waitcnt lgkmcnt(3)
ds_read_b128 a[108:111], v1 offset:27648
v_add_f32 v36, v36, v20
v_add_f32 v37, v37, v20
v_add_f32 v38, v38, v20
v_add_f32 v39, v39, v20
v_mfma_f32_16x16x32_bf16 v[48:51], a[92:95], a[28:31], v[48:51]
v_add_f32 v40, v40, v16
v_add_f32 v41, v41, v16
v_add_f32 v42, v42, v16
v_add_f32 v43, v43, v16
v_mfma_f32_16x16x32_bf16 v[52:55], a[64:67], a[32:35], v[20:23]
ds_read_b128 a[112:115], v1 offset:28672
v_add_f32 v44, v44, v20
v_add_f32 v45, v45, v20
v_add_f32 v46, v46, v20
v_add_f32 v47, v47, v20
v_mfma_f32_16x16x32_bf16 v[52:55], a[68:71], a[36:39], v[52:55]
v_exp_f32 v8, v32
v_mfma_f32_16x16x32_bf16 v[52:55], a[72:75], a[40:43], v[52:55]
ds_read_b128 a[116:119], v1 offset:29696
v_exp_f32 v9, v33
v_mfma_f32_16x16x32_bf16 v[52:55], a[76:79], a[44:47], v[52:55]
v_exp_f32 v10, v34
v_add_f32 v26, v8, v9
v_cvt_pk_bf16_f32 v96, v8, v9
v_mfma_f32_16x16x32_bf16 v[52:55], a[80:83], a[48:51], v[52:55]
ds_read_b128 a[120:123], v1 offset:30720
v_exp_f32 v11, v35
v_add_f32 v26, v26, v10
v_mfma_f32_16x16x32_bf16 v[52:55], a[84:87], a[52:55], v[52:55]
v_exp_f32 v12, v36
v_add_f32 v26, v26, v11
v_cvt_pk_bf16_f32 v97, v10, v11
v_mfma_f32_16x16x32_bf16 v[52:55], a[88:91], a[56:59], v[52:55]
s_waitcnt vmcnt(8) lgkmcnt(4)
ds_read_b128 a[124:127], v1 offset:31744
v_exp_f32 v13, v37
v_mfma_f32_16x16x32_bf16 v[52:55], a[92:95], a[60:63], v[52:55]
s_barrier
v_mfma_f32_16x16x32_bf16 v[56:59], a[96:99], a[0:3], v[16:19]
ds_read_b128 a[64:67], v4 offset:0
v_exp_f32 v14, v38
v_mfma_f32_16x16x32_bf16 v[56:59], a[100:103], a[4:7], v[56:59]
buffer_store_dword v6, v5, s[4:7], s71 offen sc1
v_mfma_f32_16x16x32_bf16 v[56:59], a[104:107], a[8:11], v[56:59]
s_waitcnt lgkmcnt(4)
ds_read_b128 a[68:71], v4 offset:1024
v_add_f32 v27, v12, v13
v_cvt_pk_bf16_f32 v104, v12, v13
v_add_f32 v27, v27, v14
v_mfma_f32_16x16x32_bf16 v[56:59], a[108:111], a[12:15], v[56:59]
v_exp_f32 v15, v39
v_mfma_f32_16x16x32_bf16 v[56:59], a[112:115], a[16:19], v[56:59]
s_waitcnt lgkmcnt(4)
ds_read_b128 a[72:75], v4 offset:2048
v_exp_f32 v8, v40
v_add_f32 v27, v27, v15
v_cvt_pk_bf16_f32 v105, v14, v15
v_mfma_f32_16x16x32_bf16 v[56:59], a[116:119], a[20:23], v[56:59]
s_waitcnt lgkmcnt(4)
v_exp_f32 v9, v41
v_add_f32 v26, v26, v8
v_mfma_f32_16x16x32_bf16 v[56:59], a[120:123], a[24:27], v[56:59]
s_waitcnt lgkmcnt(3)
ds_read_b128 a[76:79], v4 offset:3072
v_exp_f32 v10, v42
v_add_f32 v26, v26, v9
v_cvt_pk_bf16_f32 v98, v8, v9
v_mfma_f32_16x16x32_bf16 v[56:59], a[124:127], a[28:31], v[56:59]
v_exp_f32 v11, v43
v_add_f32 v26, v26, v10
v_mfma_f32_16x16x32_bf16 v[60:63], a[96:99], a[32:35], v[20:23]
ds_read_b128 a[80:83], v4 offset:4096
v_exp_f32 v12, v44
v_mfma_f32_16x16x32_bf16 v[60:63], a[100:103], a[36:39], v[60:63]
v_exp_f32 v13, v45
v_mfma_f32_16x16x32_bf16 v[60:63], a[104:107], a[40:43], v[60:63]
ds_read_b128 a[84:87], v4 offset:5120
v_exp_f32 v14, v46
v_mfma_f32_16x16x32_bf16 v[60:63], a[108:111], a[44:47], v[60:63]
v_exp_f32 v15, v47
v_mfma_f32_16x16x32_bf16 v[60:63], a[112:115], a[48:51], v[60:63]
ds_read_b128 a[88:91], v4 offset:6144
v_add_f32 v26, v26, v11
v_cvt_pk_bf16_f32 v99, v10, v11
v_mfma_f32_16x16x32_bf16 v[60:63], a[116:119], a[52:55], v[60:63]
v_add_f32 v27, v27, v12
v_add_f32 v27, v27, v13
v_cvt_pk_bf16_f32 v106, v12, v13
v_mfma_f32_16x16x32_bf16 v[60:63], a[120:123], a[56:59], v[60:63]
s_waitcnt lgkmcnt(7)
s_barrier
ds_read_b128 a[92:95], v4 offset:7168
v_mfma_f32_16x16x32_bf16 v[60:63], a[124:127], a[60:63], v[60:63]
s_waitcnt lgkmcnt(4)
v_add_f32 v27, v27, v14
v_add_f32 v27, v27, v15
v_cvt_pk_bf16_f32 v107, v14, v15
K2_x1:
v_mfma_f32_16x16x32_bf16 v[64:67], a[64:67], a[0:3], v[16:19]
s_add_u32 m0, s18, 0
ds_read_b128 a[96:99], v4 offset:8192
v_mfma_f32_16x16x32_bf16 v[64:67], a[68:71], a[4:7], v[64:67]
s_waitcnt lgkmcnt(4)
buffer_load_dwordx4 v1, s[4:7], s8 offen offset:0 sc1 lds
v_mfma_f32_16x16x32_bf16 v[64:67], a[72:75], a[8:11], v[64:67]
ds_read_b128 a[100:103], v4 offset:9216
v_mfma_f32_16x16x32_bf16 v[64:67], a[76:79], a[12:15], v[64:67]
s_waitcnt lgkmcnt(4)
v_exp_f32 v8, v48
v_mfma_f32_16x16x32_bf16 v[64:67], a[80:83], a[16:19], v[64:67]
ds_read_b128 a[104:107], v4 offset:10240
v_add_f32 v26, v26, v8
v_mfma_f32_16x16x32_bf16 v[64:67], a[84:87], a[20:23], v[64:67]
s_waitcnt lgkmcnt(4)
buffer_load_dwordx4 v1, s[4:7], s8 offen offset:1024 sc1 lds
v_mfma_f32_16x16x32_bf16 v[64:67], a[88:91], a[24:27], v[64:67]
s_waitcnt lgkmcnt(3)
ds_read_b128 a[108:111], v4 offset:11264
v_mfma_f32_16x16x32_bf16 v[64:67], a[92:95], a[28:31], v[64:67]
v_exp_f32 v9, v49
v_mfma_f32_16x16x32_bf16 v[68:71], a[64:67], a[32:35], v[20:23]
ds_read_b128 a[112:115], v4 offset:12288
v_add_f32 v26, v26, v9
v_mfma_f32_16x16x32_bf16 v[68:71], a[68:71], a[36:39], v[68:71]
buffer_load_dwordx4 v1, s[4:7], s8 offen offset:2048 sc1 lds
v_mfma_f32_16x16x32_bf16 v[68:71], a[72:75], a[40:43], v[68:71]
ds_read_b128 a[116:119], v4 offset:13312
v_cvt_pk_bf16_f32 v100, v8, v9
v_mfma_f32_16x16x32_bf16 v[68:71], a[76:79], a[44:47], v[68:71]
v_exp_f32 v10, v50
v_mfma_f32_16x16x32_bf16 v[68:71], a[80:83], a[48:51], v[68:71]
ds_read_b128 a[120:123], v4 offset:14336
v_add_f32 v26, v26, v10
v_mfma_f32_16x16x32_bf16 v[68:71], a[84:87], a[52:55], v[68:71]
buffer_load_dwordx4 v1, s[4:7], s8 offen offset:3072 sc1 lds
v_mfma_f32_16x16x32_bf16 v[68:71], a[88:91], a[56:59], v[68:71]
s_add_u32 s8, s8, 4096
ds_read_b128 a[124:127], v4 offset:15360
v_mfma_f32_16x16x32_bf16 v[68:71], a[92:95], a[60:63], v[68:71]
s_waitcnt lgkmcnt(4)
v_exp_f32 v11, v51
v_mfma_f32_16x16x32_bf16 v[72:75], a[96:99], a[0:3], v[16:19]
s_add_u32 m0, s18, 4096
ds_read_b128 a[64:67], v4 offset:16384
v_add_f32 v26, v26, v11
v_mfma_f32_16x16x32_bf16 v[72:75], a[100:103], a[4:7], v[72:75]
buffer_load_dwordx4 v1, s[4:7], s8 offen offset:0 sc1 lds
v_mfma_f32_16x16x32_bf16 v[72:75], a[104:107], a[8:11], v[72:75]
ds_read_b128 a[68:71], v4 offset:17408
v_cvt_pk_bf16_f32 v101, v10, v11
v_mfma_f32_16x16x32_bf16 v[72:75], a[108:111], a[12:15], v[72:75]
s_waitcnt lgkmcnt(4)
v_mfma_f32_16x16x32_bf16 v[72:75], a[112:115], a[16:19], v[72:75]
ds_read_b128 a[72:75], v4 offset:18432
v_mfma_f32_16x16x32_bf16 v[72:75], a[116:119], a[20:23], v[72:75]
s_waitcnt lgkmcnt(4)
buffer_load_dwordx4 v1, s[4:7], s8 offen offset:1024 sc1 lds
v_mfma_f32_16x16x32_bf16 v[72:75], a[120:123], a[24:27], v[72:75]
s_waitcnt lgkmcnt(3)
ds_read_b128 a[76:79], v4 offset:19456
v_mfma_f32_16x16x32_bf16 v[72:75], a[124:127], a[28:31], v[72:75]
v_exp_f32 v12, v52
v_mfma_f32_16x16x32_bf16 v[76:79], a[96:99], a[32:35], v[20:23]
ds_read_b128 a[80:83], v4 offset:20480
v_add_f32 v27, v27, v12
v_mfma_f32_16x16x32_bf16 v[76:79], a[100:103], a[36:39], v[76:79]
buffer_load_dwordx4 v1, s[4:7], s8 offen offset:2048 sc1 lds
v_mfma_f32_16x16x32_bf16 v[76:79], a[104:107], a[40:43], v[76:79]
ds_read_b128 a[84:87], v4 offset:21504
v_mfma_f32_16x16x32_bf16 v[76:79], a[108:111], a[44:47], v[76:79]
v_exp_f32 v13, v53
v_mfma_f32_16x16x32_bf16 v[76:79], a[112:115], a[48:51], v[76:79]
ds_read_b128 a[88:91], v4 offset:22528
v_add_f32 v27, v27, v13
v_mfma_f32_16x16x32_bf16 v[76:79], a[116:119], a[52:55], v[76:79]
s_waitcnt lgkmcnt(3)
buffer_load_dwordx4 v1, s[4:7], s8 offen offset:3072 sc1 lds
v_mfma_f32_16x16x32_bf16 v[76:79], a[120:123], a[56:59], v[76:79]
s_add_u32 s8, s8, 28672
ds_read_b128 a[92:95], v4 offset:23552
v_cvt_pk_bf16_f32 v108, v12, v13
v_mfma_f32_16x16x32_bf16 v[76:79], a[124:127], a[60:63], v[76:79]
s_sub_u32 s9, s9, 1
v_exp_f32 v14, v54
v_mfma_f32_16x16x32_bf16 v[80:83], a[64:67], a[0:3], v[16:19]
s_cmp_eq_u32 s9, 0
ds_read_b128 a[96:99], v4 offset:24576
v_add_f32 v27, v27, v14
v_mfma_f32_16x16x32_bf16 v[80:83], a[68:71], a[4:7], v[80:83]
s_cselect_b32 s8, s10, s8
v_exp_f32 v15, v55
v_mfma_f32_16x16x32_bf16 v[80:83], a[72:75], a[8:11], v[80:83]
s_cselect_b32 s9, s11, s9
ds_read_b128 a[100:103], v4 offset:25600
v_add_f32 v27, v27, v15
v_mfma_f32_16x16x32_bf16 v[80:83], a[76:79], a[12:15], v[80:83]
s_waitcnt lgkmcnt(4)
s_cselect_b32 s10, 3221225472, s10
v_cvt_pk_bf16_f32 v109, v14, v15
v_mfma_f32_16x16x32_bf16 v[80:83], a[80:83], a[16:19], v[80:83]
ds_read_b128 a[104:107], v4 offset:26624
v_mfma_f32_16x16x32_bf16 v[80:83], a[84:87], a[20:23], v[80:83]
s_waitcnt lgkmcnt(4)
v_exp_f32 v8, v56
v_mfma_f32_16x16x32_bf16 v[80:83], a[88:91], a[24:27], v[80:83]
s_waitcnt lgkmcnt(3)
ds_read_b128 a[108:111], v4 offset:27648
v_add_f32 v26, v26, v8
v_mfma_f32_16x16x32_bf16 v[80:83], a[92:95], a[28:31], v[80:83]
v_exp_f32 v9, v57
v_mfma_f32_16x16x32_bf16 v[84:87], a[64:67], a[32:35], v[20:23]
ds_read_b128 a[112:115], v4 offset:28672
v_add_f32 v26, v26, v9
v_mfma_f32_16x16x32_bf16 v[84:87], a[68:71], a[36:39], v[84:87]
v_exp_f32 v10, v58
v_mfma_f32_16x16x32_bf16 v[84:87], a[72:75], a[40:43], v[84:87]
ds_read_b128 a[116:119], v4 offset:29696
v_cvt_pk_bf16_f32 v102, v8, v9
v_mfma_f32_16x16x32_bf16 v[84:87], a[76:79], a[44:47], v[84:87]
v_exp_f32 v11, v59
v_mfma_f32_16x16x32_bf16 v[84:87], a[80:83], a[48:51], v[84:87]
ds_read_b128 a[120:123], v4 offset:30720
v_add_f32 v26, v26, v10
v_mfma_f32_16x16x32_bf16 v[84:87], a[84:87], a[52:55], v[84:87]
v_add_f32 v26, v26, v11
v_cvt_pk_bf16_f32 v103, v10, v11
v_mfma_f32_16x16x32_bf16 v[84:87], a[88:91], a[56:59], v[84:87]
s_waitcnt vmcnt(8) lgkmcnt(4)
ds_read_b128 a[124:127], v4 offset:31744
v_mfma_f32_16x16x32_bf16 v[84:87], a[92:95], a[60:63], v[84:87]
s_barrier
v_mfma_f32_16x16x32_bf16 v[88:91], a[96:99], a[0:3], v[16:19]
ds_read_b128 a[64:67], v2 offset:0
v_mfma_f32_16x16x32_bf16 v[88:91], a[100:103], a[4:7], v[88:91]
v_exp_f32 v12, v60
v_mfma_f32_16x16x32_bf16 v[88:91], a[104:107], a[8:11], v[88:91]
s_waitcnt lgkmcnt(4)
ds_read_b128 a[68:71], v2 offset:1024
v_add_f32 v27, v27, v12
v_mfma_f32_16x16x32_bf16 v[88:91], a[108:111], a[12:15], v[88:91]
v_exp_f32 v13, v61
v_mfma_f32_16x16x32_bf16 v[88:91], a[112:115], a[16:19], v[88:91]
s_waitcnt lgkmcnt(4)
ds_read_b128 a[72:75], v2 offset:2048
v_add_f32 v27, v27, v13
v_mfma_f32_16x16x32_bf16 v[88:91], a[116:119], a[20:23], v[88:91]
s_waitcnt lgkmcnt(4)
v_exp_f32 v14, v62
v_mfma_f32_16x16x32_bf16 v[88:91], a[120:123], a[24:27], v[88:91]
s_waitcnt lgkmcnt(3)
ds_read_b128 a[76:79], v2 offset:3072
v_cvt_pk_bf16_f32 v110, v12, v13
v_mfma_f32_16x16x32_bf16 v[88:91], a[124:127], a[28:31], v[88:91]
v_exp_f32 v15, v63
v_mfma_f32_16x16x32_bf16 v[92:95], a[96:99], a[32:35], v[20:23]
s_sub_u32 s19, s19, 1
ds_read_b128 a[80:83], v2 offset:4096
v_add_f32 v27, v27, v14
v_mfma_f32_16x16x32_bf16 v[92:95], a[100:103], a[36:39], v[92:95]
v_add_f32 v27, v27, v15
v_cvt_pk_bf16_f32 v111, v14, v15
v_mfma_f32_16x16x32_bf16 v[92:95], a[104:107], a[40:43], v[92:95]
ds_read_b128 a[84:87], v2 offset:5120
v_add_f32 v28, v26, v27
v_mfma_f32_16x16x32_bf16 v[92:95], a[108:111], a[44:47], v[92:95]
v_cmp_nge_f32 vcc, s25, v28
v_mfma_f32_16x16x32_bf16 v[92:95], a[112:115], a[48:51], v[92:95]
s_cmp_eq_u64 vcc, 0
ds_read_b128 a[88:91], v2 offset:6144
v_mfma_f32_16x16x32_bf16 v[92:95], a[116:119], a[52:55], v[92:95]
s_cselect_b32 s22, s19, 0
v_mfma_f32_16x16x32_bf16 v[92:95], a[120:123], a[56:59], v[92:95]
s_cmp_eq_u32 s22, 0
ds_read_b128 a[92:95], v2 offset:7168
v_mfma_f32_16x16x32_bf16 v[92:95], a[124:127], a[60:63], v[92:95]
s_waitcnt lgkmcnt(4)
s_cbranch_scc1 K2_xexit
K2_loop:
v_mfma_f32_16x16x32_bf16 v[128:131], a[64:67], v[96:99], v[128:131]
s_add_u32 m0, s18, 98304
ds_read_b128 a[96:99], v2 offset:8192
v_add_f32 v24, v24, v26
v_mfma_f32_16x16x32_bf16 v[128:131], a[68:71], v[100:103], v[128:131]
buffer_load_dwordx4 v1, s[4:7], s12 offen offset:0 sc1 lds
v_mfma_f32_16x16x32_bf16 v[132:135], a[68:71], v[108:111], v[132:135]
ds_read_b128 a[100:103], v2 offset:9216
v_add_f32 v25, v25, v27
v_mfma_f32_16x16x32_bf16 v[132:135], a[64:67], v[104:107], v[132:135]
v_exp_f32 v8, v64
v_mfma_f32_16x16x32_bf16 v[136:139], a[72:75], v[96:99], v[136:139]
ds_read_b128 a[104:107], v2 offset:10240
v_mfma_f32_16x16x32_bf16 v[136:139], a[76:79], v[100:103], v[136:139]
buffer_load_dwordx4 v1, s[4:7], s12 offen offset:1024 sc1 lds
v_mfma_f32_16x16x32_bf16 v[140:143], a[76:79], v[108:111], v[140:143]
ds_read_b128 a[108:111], v2 offset:11264
v_mfma_f32_16x16x32_bf16 v[140:143], a[72:75], v[104:107], v[140:143]
s_waitcnt lgkmcnt(4)
v_exp_f32 v9, v65
v_mfma_f32_16x16x32_bf16 v[144:147], a[80:83], v[96:99], v[144:147]
ds_read_b128 a[112:115], v2 offset:12288
v_add_f32 v26, v8, v9
v_mfma_f32_16x16x32_bf16 v[144:147], a[84:87], v[100:103], v[144:147]
buffer_load_dwordx4 v1, s[4:7], s12 offen offset:2048 sc1 lds
v_mfma_f32_16x16x32_bf16 v[148:151], a[84:87], v[108:111], v[148:151]
ds_read_b128 a[116:119], v2 offset:13312
v_cvt_pk_bf16_f32 v112, v8, v9
v_mfma_f32_16x16x32_bf16 v[148:151], a[80:83], v[104:107], v[148:151]
v_exp_f32 v10, v66
v_mfma_f32_16x16x32_bf16 v[152:155], a[88:91], v[96:99], v[152:155]
PAD_10:
s_cbranch_execz M_tret
ds_read_b128 a[120:123], v2 offset:14336
v_add_f32 v26, v26, v10
v_mfma_f32_16x16x32_bf16 v[152:155], a[92:95], v[100:103], v[152:155]
buffer_load_dwordx4 v1, s[4:7], s12 offen offset:3072 sc1 lds
v_mfma_f32_16x16x32_bf16 v[156:159], a[92:95], v[108:111], v[156:159]
s_add_u32 s12, s12, 4096
ds_read_b128 a[124:127], v2 offset:15360
v_mfma_f32_16x16x32_bf16 v[156:159], a[88:91], v[104:107], v[156:159]
s_waitcnt lgkmcnt(4)
v_exp_f32 v11, v67
v_mfma_f32_16x16x32_bf16 v[160:163], a[96:99], v[96:99], v[160:163]
s_add_u32 m0, s18, 102400
ds_read_b128 a[64:67], v2 offset:16384
v_add_f32 v26, v26, v11
v_mfma_f32_16x16x32_bf16 v[160:163], a[100:103], v[100:103], v[160:163]
buffer_load_dwordx4 v1, s[4:7], s12 offen offset:0 sc1 lds
v_mfma_f32_16x16x32_bf16 v[164:167], a[100:103], v[108:111], v[164:167]
ds_read_b128 a[68:71], v2 offset:17408
v_cvt_pk_bf16_f32 v113, v10, v11
v_mfma_f32_16x16x32_bf16 v[164:167], a[96:99], v[104:107], v[164:167]
v_mfma_f32_16x16x32_bf16 v[168:171], a[104:107], v[96:99], v[168:171]
ds_read_b128 a[72:75], v2 offset:18432
v_mfma_f32_16x16x32_bf16 v[168:171], a[108:111], v[100:103], v[168:171]
buffer_load_dwordx4 v1, s[4:7], s12 offen offset:1024 sc1 lds
v_mfma_f32_16x16x32_bf16 v[172:175], a[108:111], v[108:111], v[172:175]
ds_read_b128 a[76:79], v2 offset:19456
v_mfma_f32_16x16x32_bf16 v[172:175], a[104:107], v[104:107], v[172:175]
s_waitcnt lgkmcnt(4)
v_exp_f32 v12, v68
v_mfma_f32_16x16x32_bf16 v[176:179], a[112:115], v[96:99], v[176:179]
ds_read_b128 a[80:83], v2 offset:20480
v_mfma_f32_16x16x32_bf16 v[176:179], a[116:119], v[100:103], v[176:179]
buffer_load_dwordx4 v1, s[4:7], s12 offen offset:2048 sc1 lds
v_mfma_f32_16x16x32_bf16 v[180:183], a[116:119], v[108:111], v[180:183]
ds_read_b128 a[84:87], v2 offset:21504
v_mfma_f32_16x16x32_bf16 v[180:183], a[112:115], v[104:107], v[180:183]
v_exp_f32 v13, v69
v_mfma_f32_16x16x32_bf16 v[184:187], a[120:123], v[96:99], v[184:187]
ds_read_b128 a[88:91], v2 offset:22528
v_add_f32 v27, v12, v13
v_mfma_f32_16x16x32_bf16 v[184:187], a[124:127], v[100:103], v[184:187]
s_waitcnt lgkmcnt(4)
buffer_load_dwordx4 v1, s[4:7], s12 offen offset:3072 sc1 lds
v_mfma_f32_16x16x32_bf16 v[188:191], a[124:127], v[108:111], v[188:191]
s_add_u32 s12, s12, 28672
ds_read_b128 a[92:95], v2 offset:23552
v_cvt_pk_bf16_f32 v120, v12, v13
v_mfma_f32_16x16x32_bf16 v[188:191], a[120:123], v[104:107], v[188:191]
s_sub_u32 s13, s13, 1
v_exp_f32 v14, v70
v_mfma_f32_16x16x32_bf16 v[192:195], a[64:67], v[96:99], v[192:195]
s_cmp_eq_u32 s13, 0
ds_read_b128 a[96:99], v2 offset:24576
v_add_f32 v27, v27, v14
v_mfma_f32_16x16x32_bf16 v[192:195], a[68:71], v[100:103], v[192:195]
s_cselect_b32 s12, s14, s12
v_mfma_f32_16x16x32_bf16 v[196:199], a[68:71], v[108:111], v[196:199]
s_cselect_b32 s13, s15, s13
ds_read_b128 a[100:103], v2 offset:25600
v_mfma_f32_16x16x32_bf16 v[196:199], a[64:67], v[104:107], v[196:199]
s_cselect_b32 s14, 3221225472, s14
v_exp_f32 v15, v71
v_mfma_f32_16x16x32_bf16 v[200:203], a[72:75], v[96:99], v[200:203]
s_waitcnt lgkmcnt(4)
ds_read_b128 a[104:107], v2 offset:26624
v_add_f32 v27, v27, v15
v_mfma_f32_16x16x32_bf16 v[200:203], a[76:79], v[100:103], v[200:203]
v_exp_f32 v8, v72
v_mfma_f32_16x16x32_bf16 v[204:207], a[76:79], v[108:111], v[204:207]
ds_read_b128 a[108:111], v2 offset:27648
v_cvt_pk_bf16_f32 v121, v14, v15
v_mfma_f32_16x16x32_bf16 v[204:207], a[72:75], v[104:107], v[204:207]
v_exp_f32 v9, v73
v_mfma_f32_16x16x32_bf16 v[208:211], a[80:83], v[96:99], v[208:211]
ds_read_b128 a[112:115], v2 offset:28672
v_add_f32 v26, v26, v8
v_mfma_f32_16x16x32_bf16 v[208:211], a[84:87], v[100:103], v[208:211]
v_add_f32 v26, v26, v9
v_cvt_pk_bf16_f32 v114, v8, v9
v_mfma_f32_16x16x32_bf16 v[212:215], a[84:87], v[108:111], v[212:215]
ds_read_b128 a[116:119], v2 offset:29696
v_mfma_f32_16x16x32_bf16 v[212:215], a[80:83], v[104:107], v[212:215]
s_waitcnt lgkmcnt(4)
v_exp_f32 v10, v74
v_mfma_f32_16x16x32_bf16 v[216:219], a[88:91], v[96:99], v[216:219]
ds_read_b128 a[120:123], v2 offset:30720
v_add_f32 v26, v26, v10
v_mfma_f32_16x16x32_bf16 v[216:219], a[92:95], v[100:103], v[216:219]
v_exp_f32 v11, v75
v_mfma_f32_16x16x32_bf16 v[220:223], a[92:95], v[108:111], v[220:223]
s_waitcnt vmcnt(8)
ds_read_b128 a[124:127], v2 offset:31744
v_add_f32 v26, v26, v11
v_mfma_f32_16x16x32_bf16 v[220:223], a[88:91], v[104:107], v[220:223]
s_barrier
v_mfma_f32_16x16x32_bf16 v[224:227], a[96:99], v[96:99], v[224:227]
ds_read_b128 a[64:67], v1 offset:0
v_cvt_pk_bf16_f32 v115, v10, v11
v_mfma_f32_16x16x32_bf16 v[224:227], a[100:103], v[100:103], v[224:227]
v_exp_f32 v12, v76
v_mfma_f32_16x16x32_bf16 v[228:231], a[100:103], v[108:111], v[228:231]
ds_read_b128 a[68:71], v1 offset:1024
v_add_f32 v27, v27, v12
v_mfma_f32_16x16x32_bf16 v[228:231], a[96:99], v[104:107], v[228:231]
s_waitcnt lgkmcnt(4)
v_mfma_f32_16x16x32_bf16 v[232:235], a[104:107], v[96:99], v[232:235]
ds_read_b128 a[72:75], v1 offset:2048
v_mfma_f32_16x16x32_bf16 v[232:235], a[108:111], v[100:103], v[232:235]
v_exp_f32 v13, v77
v_mfma_f32_16x16x32_bf16 v[236:239], a[108:111], v[108:111], v[236:239]
ds_read_b128 a[76:79], v1 offset:3072
v_add_f32 v27, v27, v13
v_mfma_f32_16x16x32_bf16 v[236:239], a[104:107], v[104:107], v[236:239]
v_exp_f32 v14, v78
v_mfma_f32_16x16x32_bf16 v[240:243], a[112:115], v[96:99], v[240:243]
ds_read_b128 a[80:83], v1 offset:4096
v_cvt_pk_bf16_f32 v122, v12, v13
v_mfma_f32_16x16x32_bf16 v[240:243], a[116:119], v[100:103], v[240:243]
v_exp_f32 v15, v79
v_mfma_f32_16x16x32_bf16 v[244:247], a[116:119], v[108:111], v[244:247]
ds_read_b128 a[84:87], v1 offset:5120
v_add_f32 v27, v27, v14
v_mfma_f32_16x16x32_bf16 v[244:247], a[112:115], v[104:107], v[244:247]
s_waitcnt lgkmcnt(4)
v_add_f32 v27, v27, v15
v_cvt_pk_bf16_f32 v123, v14, v15
v_mfma_f32_16x16x32_bf16 v[248:251], a[120:123], v[96:99], v[248:251]
ds_read_b128 a[88:91], v1 offset:6144
v_mfma_f32_16x16x32_bf16 v[248:251], a[124:127], v[100:103], v[248:251]
v_mfma_f32_16x16x32_bf16 v[252:255], a[124:127], v[108:111], v[252:255]
ds_read_b128 a[92:95], v1 offset:7168
v_mfma_f32_16x16x32_bf16 v[252:255], a[120:123], v[104:107], v[252:255]
K2_x0:
v_mfma_f32_16x16x32_bf16 v[32:35], a[64:67], a[0:3], v[16:19]
s_add_u32 m0, s18, 131072
ds_read_b128 a[96:99], v1 offset:8192
v_mfma_f32_16x16x32_bf16 v[32:35], a[68:71], a[4:7], v[32:35]
s_waitcnt lgkmcnt(4)
buffer_load_dwordx4 v1, s[4:7], s8 offen offset:0 sc1 lds
v_mfma_f32_16x16x32_bf16 v[32:35], a[72:75], a[8:11], v[32:35]
ds_read_b128 a[100:103], v1 offset:9216
v_mfma_f32_16x16x32_bf16 v[32:35], a[76:79], a[12:15], v[32:35]
v_exp_f32 v8, v80
v_mfma_f32_16x16x32_bf16 v[32:35], a[80:83], a[16:19], v[32:35]
s_waitcnt lgkmcnt(4)
ds_read_b128 a[104:107], v1 offset:10240
v_add_f32 v26, v26, v8
v_mfma_f32_16x16x32_bf16 v[32:35], a[84:87], a[20:23], v[32:35]
s_waitcnt lgkmcnt(4)
buffer_load_dwordx4 v1, s[4:7], s8 offen offset:1024 sc1 lds
v_mfma_f32_16x16x32_bf16 v[32:35], a[88:91], a[24:27], v[32:35]
s_waitcnt lgkmcnt(3)
ds_read_b128 a[108:111], v1 offset:11264
v_mfma_f32_16x16x32_bf16 v[32:35], a[92:95], a[28:31], v[32:35]
v_exp_f32 v9, v81
v_mfma_f32_16x16x32_bf16 v[36:39], a[64:67], a[32:35], v[20:23]
ds_read_b128 a[112:115], v1 offset:12288
v_add_f32 v26, v26, v9
v_mfma_f32_16x16x32_bf16 v[36:39], a[68:71], a[36:39], v[36:39]
buffer_load_dwordx4 v1, s[4:7], s8 offen offset:2048 sc1 lds
v_mfma_f32_16x16x32_bf16 v[36:39], a[72:75], a[40:43], v[36:39]
ds_read_b128 a[116:119], v1 offset:13312
v_cvt_pk_bf16_f32 v116, v8, v9
v_mfma_f32_16x16x32_bf16 v[36:39], a[76:79], a[44:47], v[36:39]
v_exp_f32 v10, v82
v_mfma_f32_16x16x32_bf16 v[36:39], a[80:83], a[48:51], v[36:39]
ds_read_b128 a[120:123], v1 offset:14336
v_add_f32 v26, v26, v10
v_mfma_f32_16x16x32_bf16 v[36:39], a[84:87], a[52:55], v[36:39]
buffer_load_dwordx4 v1, s[4:7], s8 offen offset:3072 sc1 lds
v_mfma_f32_16x16x32_bf16 v[36:39], a[88:91], a[56:59], v[36:39]
s_add_u32 s8, s8, 4096
ds_read_b128 a[124:127], v1 offset:15360
v_mfma_f32_16x16x32_bf16 v[36:39], a[92:95], a[60:63], v[36:39]
s_waitcnt lgkmcnt(4)
v_exp_f32 v11, v83
v_mfma_f32_16x16x32_bf16 v[40:43], a[96:99], a[0:3], v[16:19]
s_add_u32 m0, s18, 135168
ds_read_b128 a[64:67], v1 offset:16384
v_add_f32 v26, v26, v11
v_mfma_f32_16x16x32_bf16 v[40:43], a[100:103], a[4:7], v[40:43]
buffer_load_dwordx4 v1, s[4:7], s8 offen offset:0 sc1 lds
v_mfma_f32_16x16x32_bf16 v[40:43], a[104:107], a[8:11], v[40:43]
ds_read_b128 a[68:71], v1 offset:17408
v_cvt_pk_bf16_f32 v117, v10, v11
v_mfma_f32_16x16x32_bf16 v[40:43], a[108:111], a[12:15], v[40:43]
s_waitcnt lgkmcnt(4)
v_mfma_f32_16x16x32_bf16 v[40:43], a[112:115], a[16:19], v[40:43]
ds_read_b128 a[72:75], v1 offset:18432
v_mfma_f32_16x16x32_bf16 v[40:43], a[116:119], a[20:23], v[40:43]
s_waitcnt lgkmcnt(4)
buffer_load_dwordx4 v1, s[4:7], s8 offen offset:1024 sc1 lds
v_mfma_f32_16x16x32_bf16 v[40:43], a[120:123], a[24:27], v[40:43]
s_waitcnt lgkmcnt(3)
ds_read_b128 a[76:79], v1 offset:19456
v_mfma_f32_16x16x32_bf16 v[40:43], a[124:127], a[28:31], v[40:43]
v_exp_f32 v12, v84
v_mfma_f32_16x16x32_bf16 v[44:47], a[96:99], a[32:35], v[20:23]
ds_read_b128 a[80:83], v1 offset:20480
v_add_f32 v27, v27, v12
v_mfma_f32_16x16x32_bf16 v[44:47], a[100:103], a[36:39], v[44:47]
buffer_load_dwordx4 v1, s[4:7], s8 offen offset:2048 sc1 lds
v_mfma_f32_16x16x32_bf16 v[44:47], a[104:107], a[40:43], v[44:47]
ds_read_b128 a[84:87], v1 offset:21504
v_mfma_f32_16x16x32_bf16 v[44:47], a[108:111], a[44:47], v[44:47]
v_exp_f32 v13, v85
v_mfma_f32_16x16x32_bf16 v[44:47], a[112:115], a[48:51], v[44:47]
ds_read_b128 a[88:91], v1 offset:22528
v_add_f32 v27, v27, v13
v_mfma_f32_16x16x32_bf16 v[44:47], a[116:119], a[52:55], v[44:47]
s_waitcnt lgkmcnt(3)
buffer_load_dwordx4 v1, s[4:7], s8 offen offset:3072 sc1 lds
v_mfma_f32_16x16x32_bf16 v[44:47], a[120:123], a[56:59], v[44:47]
s_add_u32 s8, s8, 28672
ds_read_b128 a[92:95], v1 offset:23552
v_cvt_pk_bf16_f32 v124, v12, v13
v_mfma_f32_16x16x32_bf16 v[44:47], a[124:127], a[60:63], v[44:47]
s_sub_u32 s9, s9, 1
v_exp_f32 v14, v86
v_mfma_f32_16x16x32_bf16 v[48:51], a[64:67], a[0:3], v[16:19]
s_cmp_eq_u32 s9, 0
ds_read_b128 a[96:99], v1 offset:24576
v_add_f32 v27, v27, v14
v_mfma_f32_16x16x32_bf16 v[48:51], a[68:71], a[4:7], v[48:51]
s_cselect_b32 s8, s10, s8
v_exp_f32 v15, v87
v_mfma_f32_16x16x32_bf16 v[48:51], a[72:75], a[8:11], v[48:51]
s_cselect_b32 s9, s11, s9
ds_read_b128 a[100:103], v1 offset:25600
v_add_f32 v27, v27, v15
v_mfma_f32_16x16x32_bf16 v[48:51], a[76:79], a[12:15], v[48:51]
s_waitcnt lgkmcnt(4)
s_cselect_b32 s10, 3221225472, s10
v_cvt_pk_bf16_f32 v125, v14, v15
v_mfma_f32_16x16x32_bf16 v[48:51], a[80:83], a[16:19], v[48:51]
ds_read_b128 a[104:107], v1 offset:26624
v_mfma_f32_16x16x32_bf16 v[48:51], a[84:87], a[20:23], v[48:51]
s_waitcnt lgkmcnt(4)
v_exp_f32 v8, v88
v_mfma_f32_16x16x32_bf16 v[48:51], a[88:91], a[24:27], v[48:51]
s_waitcnt lgkmcnt(3)
ds_read_b128 a[108:111], v1 offset:27648
v_add_f32 v26, v26, v8
v_mfma_f32_16x16x32_bf16 v[48:51], a[92:95], a[28:31], v[48:51]
v_exp_f32 v9, v89
v_mfma_f32_16x16x32_bf16 v[52:55], a[64:67], a[32:35], v[20:23]
ds_read_b128 a[112:115], v1 offset:28672
v_add_f32 v26, v26, v9
v_mfma_f32_16x16x32_bf16 v[52:55], a[68:71], a[36:39], v[52:55]
v_exp_f32 v10, v90
v_mfma_f32_16x16x32_bf16 v[52:55], a[72:75], a[40:43], v[52:55]
ds_read_b128 a[116:119], v1 offset:29696
v_cvt_pk_bf16_f32 v118, v8, v9
v_mfma_f32_16x16x32_bf16 v[52:55], a[76:79], a[44:47], v[52:55]
v_exp_f32 v11, v91
v_mfma_f32_16x16x32_bf16 v[52:55], a[80:83], a[48:51], v[52:55]
ds_read_b128 a[120:123], v1 offset:30720
v_add_f32 v26, v26, v10
v_mfma_f32_16x16x32_bf16 v[52:55], a[84:87], a[52:55], v[52:55]
v_add_f32 v26, v26, v11
v_cvt_pk_bf16_f32 v119, v10, v11
v_mfma_f32_16x16x32_bf16 v[52:55], a[88:91], a[56:59], v[52:55]
s_waitcnt vmcnt(8) lgkmcnt(4)
ds_read_b128 a[124:127], v1 offset:31744
v_mfma_f32_16x16x32_bf16 v[52:55], a[92:95], a[60:63], v[52:55]
s_barrier
v_mfma_f32_16x16x32_bf16 v[56:59], a[96:99], a[0:3], v[16:19]
ds_read_b128 a[64:67], v2 offset:32768
v_mfma_f32_16x16x32_bf16 v[56:59], a[100:103], a[4:7], v[56:59]
v_exp_f32 v12, v92
v_mfma_f32_16x16x32_bf16 v[56:59], a[104:107], a[8:11], v[56:59]
s_waitcnt lgkmcnt(4)
ds_read_b128 a[68:71], v2 offset:33792
v_add_f32 v27, v27, v12
v_mfma_f32_16x16x32_bf16 v[56:59], a[108:111], a[12:15], v[56:59]
v_exp_f32 v13, v93
v_mfma_f32_16x16x32_bf16 v[56:59], a[112:115], a[16:19], v[56:59]
s_waitcnt lgkmcnt(4)
ds_read_b128 a[72:75], v2 offset:34816
v_add_f32 v27, v27, v13
v_mfma_f32_16x16x32_bf16 v[56:59], a[116:119], a[20:23], v[56:59]
s_waitcnt lgkmcnt(4)
v_exp_f32 v14, v94
v_mfma_f32_16x16x32_bf16 v[56:59], a[120:123], a[24:27], v[56:59]
s_waitcnt lgkmcnt(3)
ds_read_b128 a[76:79], v2 offset:35840
v_cvt_pk_bf16_f32 v126, v12, v13
v_mfma_f32_16x16x32_bf16 v[56:59], a[124:127], a[28:31], v[56:59]
v_exp_f32 v15, v95
v_mfma_f32_16x16x32_bf16 v[60:63], a[96:99], a[32:35], v[20:23]
ds_read_b128 a[80:83], v2 offset:36864
v_add_f32 v27, v27, v14
v_mfma_f32_16x16x32_bf16 v[60:63], a[100:103], a[36:39], v[60:63]
v_add_f32 v27, v27, v15
v_cvt_pk_bf16_f32 v127, v14, v15
v_mfma_f32_16x16x32_bf16 v[60:63], a[104:107], a[40:43], v[60:63]
ds_read_b128 a[84:87], v2 offset:37888
v_add_f32 v28, v26, v27
v_mfma_f32_16x16x32_bf16 v[60:63], a[108:111], a[44:47], v[60:63]
v_cmp_nge_f32 vcc, s25, v28
v_mfma_f32_16x16x32_bf16 v[60:63], a[112:115], a[48:51], v[60:63]
ds_read_b128 a[88:91], v2 offset:38912
v_mfma_f32_16x16x32_bf16 v[60:63], a[116:119], a[52:55], v[60:63]
v_mfma_f32_16x16x32_bf16 v[60:63], a[120:123], a[56:59], v[60:63]
ds_read_b128 a[92:95], v2 offset:39936
v_mfma_f32_16x16x32_bf16 v[60:63], a[124:127], a[60:63], v[60:63]
s_waitcnt lgkmcnt(4)
s_cbranch_vccnz Lstub_2
Lback_3:
v_mfma_f32_16x16x32_bf16 v[128:131], a[64:67], v[112:115], v[128:131]
s_add_u32 m0, s18, 65536
ds_read_b128 a[96:99], v2 offset:40960
v_add_f32 v24, v24, v26
v_mfma_f32_16x16x32_bf16 v[128:131], a[68:71], v[116:119], v[128:131]
buffer_load_dwordx4 v1, s[4:7], s12 offen offset:0 sc1 lds
v_mfma_f32_16x16x32_bf16 v[132:135], a[68:71], v[124:127], v[132:135]
ds_read_b128 a[100:103], v2 offset:41984
v_add_f32 v25, v25, v27
v_mfma_f32_16x16x32_bf16 v[132:135], a[64:67], v[120:123], v[132:135]
v_exp_f32 v8, v32
v_mfma_f32_16x16x32_bf16 v[136:139], a[72:75], v[112:115], v[136:139]
ds_read_b128 a[104:107], v2 offset:43008
v_mfma_f32_16x16x32_bf16 v[136:139], a[76:79], v[116:119], v[136:139]
buffer_load_dwordx4 v1, s[4:7], s12 offen offset:1024 sc1 lds
v_mfma_f32_16x16x32_bf16 v[140:143], a[76:79], v[124:127], v[140:143]
ds_read_b128 a[108:111], v2 offset:44032
v_mfma_f32_16x16x32_bf16 v[140:143], a[72:75], v[120:123], v[140:143]
s_waitcnt lgkmcnt(4)
v_exp_f32 v9, v33
v_mfma_f32_16x16x32_bf16 v[144:147], a[80:83], v[112:115], v[144:147]
ds_read_b128 a[112:115], v2 offset:45056
v_add_f32 v26, v8, v9
v_mfma_f32_16x16x32_bf16 v[144:147], a[84:87], v[116:119], v[144:147]
buffer_load_dwordx4 v1, s[4:7], s12 offen offset:2048 sc1 lds
v_mfma_f32_16x16x32_bf16 v[148:151], a[84:87], v[124:127], v[148:151]
ds_read_b128 a[116:119], v2 offset:46080
v_cvt_pk_bf16_f32 v96, v8, v9
v_mfma_f32_16x16x32_bf16 v[148:151], a[80:83], v[120:123], v[148:151]
v_exp_f32 v10, v34
v_mfma_f32_16x16x32_bf16 v[152:155], a[88:91], v[112:115], v[152:155]
ds_read_b128 a[120:123], v2 offset:47104
v_add_f32 v26, v26, v10
v_mfma_f32_16x16x32_bf16 v[152:155], a[92:95], v[116:119], v[152:155]
buffer_load_dwordx4 v1, s[4:7], s12 offen offset:3072 sc1 lds
v_mfma_f32_16x16x32_bf16 v[156:159], a[92:95], v[124:127], v[156:159]
s_add_u32 s12, s12, 4096
ds_read_b128 a[124:127], v2 offset:48128
v_mfma_f32_16x16x32_bf16 v[156:159], a[88:91], v[120:123], v[156:159]
s_waitcnt lgkmcnt(4)
v_exp_f32 v11, v35
v_mfma_f32_16x16x32_bf16 v[160:163], a[96:99], v[112:115], v[160:163]
s_add_u32 m0, s18, 69632
ds_read_b128 a[64:67], v2 offset:49152
v_add_f32 v26, v26, v11
v_mfma_f32_16x16x32_bf16 v[160:163], a[100:103], v[116:119], v[160:163]
buffer_load_dwordx4 v1, s[4:7], s12 offen offset:0 sc1 lds
v_mfma_f32_16x16x32_bf16 v[164:167], a[100:103], v[124:127], v[164:167]
ds_read_b128 a[68:71], v2 offset:50176
v_cvt_pk_bf16_f32 v97, v10, v11
v_mfma_f32_16x16x32_bf16 v[164:167], a[96:99], v[120:123], v[164:167]
v_mfma_f32_16x16x32_bf16 v[168:171], a[104:107], v[112:115], v[168:171]
ds_read_b128 a[72:75], v2 offset:51200
v_mfma_f32_16x16x32_bf16 v[168:171], a[108:111], v[116:119], v[168:171]
buffer_load_dwordx4 v1, s[4:7], s12 offen offset:1024 sc1 lds
v_mfma_f32_16x16x32_bf16 v[172:175], a[108:111], v[124:127], v[172:175]
ds_read_b128 a[76:79], v2 offset:52224
v_mfma_f32_16x16x32_bf16 v[172:175], a[104:107], v[120:123], v[172:175]
s_waitcnt lgkmcnt(4)
v_exp_f32 v12, v36
v_mfma_f32_16x16x32_bf16 v[176:179], a[112:115], v[112:115], v[176:179]
ds_read_b128 a[80:83], v2 offset:53248
v_mfma_f32_16x16x32_bf16 v[176:179], a[116:119], v[116:119], v[176:179]
buffer_load_dwordx4 v1, s[4:7], s12 offen offset:2048 sc1 lds
v_mfma_f32_16x16x32_bf16 v[180:183], a[116:119], v[124:127], v[180:183]
ds_read_b128 a[84:87], v2 offset:54272
v_mfma_f32_16x16x32_bf16 v[180:183], a[112:115], v[120:123], v[180:183]
v_exp_f32 v13, v37
v_mfma_f32_16x16x32_bf16 v[184:187], a[120:123], v[112:115], v[184:187]
ds_read_b128 a[88:91], v2 offset:55296
v_add_f32 v27, v12, v13
v_mfma_f32_16x16x32_bf16 v[184:187], a[124:127], v[116:119], v[184:187]
s_waitcnt lgkmcnt(4)
buffer_load_dwordx4 v1, s[4:7], s12 offen offset:3072 sc1 lds
v_mfma_f32_16x16x32_bf16 v[188:191], a[124:127], v[124:127], v[188:191]
s_add_u32 s12, s12, 28672
ds_read_b128 a[92:95], v2 offset:56320
v_cvt_pk_bf16_f32 v104, v12, v13
v_mfma_f32_16x16x32_bf16 v[188:191], a[120:123], v[120:123], v[188:191]
s_sub_u32 s13, s13, 1
v_exp_f32 v14, v38
v_mfma_f32_16x16x32_bf16 v[192:195], a[64:67], v[112:115], v[192:195]
s_cmp_eq_u32 s13, 0
ds_read_b128 a[96:99], v2 offset:57344
v_add_f32 v27, v27, v14
v_mfma_f32_16x16x32_bf16 v[192:195], a[68:71], v[116:119], v[192:195]
s_cselect_b32 s12, s14, s12
v_mfma_f32_16x16x32_bf16 v[196:199], a[68:71], v[124:127], v[196:199]
s_cselect_b32 s13, s15, s13
ds_read_b128 a[100:103], v2 offset:58368
v_mfma_f32_16x16x32_bf16 v[196:199], a[64:67], v[120:123], v[196:199]
s_cselect_b32 s14, 3221225472, s14
v_exp_f32 v15, v39
v_mfma_f32_16x16x32_bf16 v[200:203], a[72:75], v[112:115], v[200:203]
s_waitcnt lgkmcnt(4)
ds_read_b128 a[104:107], v2 offset:59392
v_add_f32 v27, v27, v15
v_mfma_f32_16x16x32_bf16 v[200:203], a[76:79], v[116:119], v[200:203]
v_exp_f32 v8, v40
v_mfma_f32_16x16x32_bf16 v[204:207], a[76:79], v[124:127], v[204:207]
ds_read_b128 a[108:111], v2 offset:60416
v_cvt_pk_bf16_f32 v105, v14, v15
v_mfma_f32_16x16x32_bf16 v[204:207], a[72:75], v[120:123], v[204:207]
v_exp_f32 v9, v41
v_mfma_f32_16x16x32_bf16 v[208:211], a[80:83], v[112:115], v[208:211]
ds_read_b128 a[112:115], v2 offset:61440
v_add_f32 v26, v26, v8
v_mfma_f32_16x16x32_bf16 v[208:211], a[84:87], v[116:119], v[208:211]
v_add_f32 v26, v26, v9
v_cvt_pk_bf16_f32 v98, v8, v9
v_mfma_f32_16x16x32_bf16 v[212:215], a[84:87], v[124:127], v[212:215]
ds_read_b128 a[116:119], v2 offset:62464
v_mfma_f32_16x16x32_bf16 v[212:215], a[80:83], v[120:123], v[212:215]
s_waitcnt lgkmcnt(4)
v_exp_f32 v10, v42
v_mfma_f32_16x16x32_bf16 v[216:219], a[88:91], v[112:115], v[216:219]
ds_read_b128 a[120:123], v2 offset:63488
v_add_f32 v26, v26, v10
v_mfma_f32_16x16x32_bf16 v[216:219], a[92:95], v[116:119], v[216:219]
v_exp_f32 v11, v43
v_mfma_f32_16x16x32_bf16 v[220:223], a[92:95], v[124:127], v[220:223]
s_waitcnt vmcnt(8)
ds_read_b128 a[124:127], v2 offset:64512
v_add_f32 v26, v26, v11
v_mfma_f32_16x16x32_bf16 v[220:223], a[88:91], v[120:123], v[220:223]
s_barrier
v_mfma_f32_16x16x32_bf16 v[224:227], a[96:99], v[112:115], v[224:227]
ds_read_b128 a[64:67], v4 offset:0
v_cvt_pk_bf16_f32 v99, v10, v11
v_mfma_f32_16x16x32_bf16 v[224:227], a[100:103], v[116:119], v[224:227]
v_exp_f32 v12, v44
v_mfma_f32_16x16x32_bf16 v[228:231], a[100:103], v[124:127], v[228:231]
ds_read_b128 a[68:71], v4 offset:1024
v_add_f32 v27, v27, v12
v_mfma_f32_16x16x32_bf16 v[228:231], a[96:99], v[120:123], v[228:231]
s_waitcnt lgkmcnt(4)
v_mfma_f32_16x16x32_bf16 v[232:235], a[104:107], v[112:115], v[232:235]
ds_read_b128 a[72:75], v4 offset:2048
v_mfma_f32_16x16x32_bf16 v[232:235], a[108:111], v[116:119], v[232:235]
v_exp_f32 v13, v45
v_mfma_f32_16x16x32_bf16 v[236:239], a[108:111], v[124:127], v[236:239]
ds_read_b128 a[76:79], v4 offset:3072
v_add_f32 v27, v27, v13
v_mfma_f32_16x16x32_bf16 v[236:239], a[104:107], v[120:123], v[236:239]
v_exp_f32 v14, v46
v_mfma_f32_16x16x32_bf16 v[240:243], a[112:115], v[112:115], v[240:243]
ds_read_b128 a[80:83], v4 offset:4096
v_cvt_pk_bf16_f32 v106, v12, v13
v_mfma_f32_16x16x32_bf16 v[240:243], a[116:119], v[116:119], v[240:243]
v_exp_f32 v15, v47
v_mfma_f32_16x16x32_bf16 v[244:247], a[116:119], v[124:127], v[244:247]
ds_read_b128 a[84:87], v4 offset:5120
v_add_f32 v27, v27, v14
v_mfma_f32_16x16x32_bf16 v[244:247], a[112:115], v[120:123], v[244:247]
s_waitcnt lgkmcnt(4)
v_add_f32 v27, v27, v15
v_cvt_pk_bf16_f32 v107, v14, v15
v_mfma_f32_16x16x32_bf16 v[248:251], a[120:123], v[112:115], v[248:251]
ds_read_b128 a[88:91], v4 offset:6144
v_mfma_f32_16x16x32_bf16 v[248:251], a[124:127], v[116:119], v[248:251]
v_mfma_f32_16x16x32_bf16 v[252:255], a[124:127], v[124:127], v[252:255]
s_waitcnt lgkmcnt(5)
ds_read_b128 a[92:95], v4 offset:7168
v_mfma_f32_16x16x32_bf16 v[252:255], a[120:123], v[120:123], v[252:255]
s_branch K2_x1
K2_xexit:
s_cbranch_vccnz Lstub_4
Lback_5:
s_cmp_lg_u32 s19, 0
s_cbranch_scc1 K2_loop
s_cmp_eq_u32 s24, 2
s_cbranch_scc1 K2_ntail
v_mfma_f32_16x16x32_bf16 v[128:131], a[64:67], v[96:99], v[128:131]
s_add_u32 m0, s18, 98304
ds_read_b128 a[96:99], v2 offset:8192
v_add_f32 v24, v24, v26
v_mfma_f32_16x16x32_bf16 v[128:131], a[68:71], v[100:103], v[128:131]
buffer_load_dwordx4 v1, s[4:7], s12 offen offset:0 sc1 lds
v_mfma_f32_16x16x32_bf16 v[132:135], a[68:71], v[108:111], v[132:135]
ds_read_b128 a[100:103], v2 offset:9216
v_add_f32 v25, v25, v27
v_mfma_f32_16x16x32_bf16 v[132:135], a[64:67], v[104:107], v[132:135]
v_exp_f32 v8, v64
v_mfma_f32_16x16x32_bf16 v[136:139], a[72:75], v[96:99], v[136:139]
ds_read_b128 a[104:107], v2 offset:10240
v_mfma_f32_16x16x32_bf16 v[136:139], a[76:79], v[100:103], v[136:139]
buffer_load_dwordx4 v1, s[4:7], s12 offen offset:1024 sc1 lds
v_mfma_f32_16x16x32_bf16 v[140:143], a[76:79], v[108:111], v[140:143]
ds_read_b128 a[108:111], v2 offset:11264
v_mfma_f32_16x16x32_bf16 v[140:143], a[72:75], v[104:107], v[140:143]
s_waitcnt lgkmcnt(4)
v_exp_f32 v9, v65
v_mfma_f32_16x16x32_bf16 v[144:147], a[80:83], v[96:99], v[144:147]
ds_read_b128 a[112:115], v2 offset:12288
v_add_f32 v26, v8, v9
v_mfma_f32_16x16x32_bf16 v[144:147], a[84:87], v[100:103], v[144:147]
buffer_load_dwordx4 v1, s[4:7], s12 offen offset:2048 sc1 lds
v_mfma_f32_16x16x32_bf16 v[148:151], a[84:87], v[108:111], v[148:151]
ds_read_b128 a[116:119], v2 offset:13312
v_cvt_pk_bf16_f32 v112, v8, v9
v_mfma_f32_16x16x32_bf16 v[148:151], a[80:83], v[104:107], v[148:151]
v_exp_f32 v10, v66
v_mfma_f32_16x16x32_bf16 v[152:155], a[88:91], v[96:99], v[152:155]
ds_read_b128 a[120:123], v2 offset:14336
v_add_f32 v26, v26, v10
v_mfma_f32_16x16x32_bf16 v[152:155], a[92:95], v[100:103], v[152:155]
buffer_load_dwordx4 v1, s[4:7], s12 offen offset:3072 sc1 lds
v_mfma_f32_16x16x32_bf16 v[156:159], a[92:95], v[108:111], v[156:159]
s_add_u32 s12, s12, 4096
ds_read_b128 a[124:127], v2 offset:15360
v_mfma_f32_16x16x32_bf16 v[156:159], a[88:91], v[104:107], v[156:159]
s_waitcnt lgkmcnt(4)
v_exp_f32 v11, v67
v_mfma_f32_16x16x32_bf16 v[160:163], a[96:99], v[96:99], v[160:163]
s_add_u32 m0, s18, 102400
ds_read_b128 a[64:67], v2 offset:16384
v_add_f32 v26, v26, v11
v_mfma_f32_16x16x32_bf16 v[160:163], a[100:103], v[100:103], v[160:163]
buffer_load_dwordx4 v1, s[4:7], s12 offen offset:0 sc1 lds
v_mfma_f32_16x16x32_bf16 v[164:167], a[100:103], v[108:111], v[164:167]
ds_read_b128 a[68:71], v2 offset:17408
v_cvt_pk_bf16_f32 v113, v10, v11
v_mfma_f32_16x16x32_bf16 v[164:167], a[96:99], v[104:107], v[164:167]
v_mfma_f32_16x16x32_bf16 v[168:171], a[104:107], v[96:99], v[168:171]
ds_read_b128 a[72:75], v2 offset:18432
v_mfma_f32_16x16x32_bf16 v[168:171], a[108:111], v[100:103], v[168:171]
buffer_load_dwordx4 v1, s[4:7], s12 offen offset:1024 sc1 lds
v_mfma_f32_16x16x32_bf16 v[172:175], a[108:111], v[108:111], v[172:175]
ds_read_b128 a[76:79], v2 offset:19456
v_mfma_f32_16x16x32_bf16 v[172:175], a[104:107], v[104:107], v[172:175]
s_waitcnt lgkmcnt(4)
v_exp_f32 v12, v68
v_mfma_f32_16x16x32_bf16 v[176:179], a[112:115], v[96:99], v[176:179]
ds_read_b128 a[80:83], v2 offset:20480
v_mfma_f32_16x16x32_bf16 v[176:179], a[116:119], v[100:103], v[176:179]
buffer_load_dwordx4 v1, s[4:7], s12 offen offset:2048 sc1 lds
v_mfma_f32_16x16x32_bf16 v[180:183], a[116:119], v[108:111], v[180:183]
ds_read_b128 a[84:87], v2 offset:21504
v_mfma_f32_16x16x32_bf16 v[180:183], a[112:115], v[104:107], v[180:183]
v_exp_f32 v13, v69
v_mfma_f32_16x16x32_bf16 v[184:187], a[120:123], v[96:99], v[184:187]
ds_read_b128 a[88:91], v2 offset:22528
v_add_f32 v27, v12, v13
v_mfma_f32_16x16x32_bf16 v[184:187], a[124:127], v[100:103], v[184:187]
s_waitcnt lgkmcnt(4)
buffer_load_dwordx4 v1, s[4:7], s12 offen offset:3072 sc1 lds
v_mfma_f32_16x16x32_bf16 v[188:191], a[124:127], v[108:111], v[188:191]
s_add_u32 s12, s12, 28672
ds_read_b128 a[92:95], v2 offset:23552
v_cvt_pk_bf16_f32 v120, v12, v13
v_mfma_f32_16x16x32_bf16 v[188:191], a[120:123], v[104:107], v[188:191]
s_sub_u32 s13, s13, 1
v_exp_f32 v14, v70
v_mfma_f32_16x16x32_bf16 v[192:195], a[64:67], v[96:99], v[192:195]
s_cmp_eq_u32 s13, 0
ds_read_b128 a[96:99], v2 offset:24576
v_add_f32 v27, v27, v14
v_mfma_f32_16x16x32_bf16 v[192:195], a[68:71], v[100:103], v[192:195]
s_cselect_b32 s12, s14, s12
v_mfma_f32_16x16x32_bf16 v[196:199], a[68:71], v[108:111], v[196:199]
s_cselect_b32 s13, s15, s13
ds_read_b128 a[100:103], v2 offset:25600
v_mfma_f32_16x16x32_bf16 v[196:199], a[64:67], v[104:107], v[196:199]
s_cselect_b32 s14, 3221225472, s14
v_exp_f32 v15, v71
v_mfma_f32_16x16x32_bf16 v[200:203], a[72:75], v[96:99], v[200:203]
s_waitcnt lgkmcnt(4)
ds_read_b128 a[104:107], v2 offset:26624
v_add_f32 v27, v27, v15
v_mfma_f32_16x16x32_bf16 v[200:203], a[76:79], v[100:103], v[200:203]
v_exp_f32 v8, v72
v_mfma_f32_16x16x32_bf16 v[204:207], a[76:79], v[108:111], v[204:207]
ds_read_b128 a[108:111], v2 offset:27648
v_cvt_pk_bf16_f32 v121, v14, v15
v_mfma_f32_16x16x32_bf16 v[204:207], a[72:75], v[104:107], v[204:207]
v_exp_f32 v9, v73
v_mfma_f32_16x16x32_bf16 v[208:211], a[80:83], v[96:99], v[208:211]
ds_read_b128 a[112:115], v2 offset:28672
v_add_f32 v26, v26, v8
v_mfma_f32_16x16x32_bf16 v[208:211], a[84:87], v[100:103], v[208:211]
v_add_f32 v26, v26, v9
v_cvt_pk_bf16_f32 v114, v8, v9
v_mfma_f32_16x16x32_bf16 v[212:215], a[84:87], v[108:111], v[212:215]
ds_read_b128 a[116:119], v2 offset:29696
v_mfma_f32_16x16x32_bf16 v[212:215], a[80:83], v[104:107], v[212:215]
s_waitcnt lgkmcnt(4)
v_exp_f32 v10, v74
v_mfma_f32_16x16x32_bf16 v[216:219], a[88:91], v[96:99], v[216:219]
ds_read_b128 a[120:123], v2 offset:30720
v_add_f32 v26, v26, v10
v_mfma_f32_16x16x32_bf16 v[216:219], a[92:95], v[100:103], v[216:219]
v_exp_f32 v11, v75
v_mfma_f32_16x16x32_bf16 v[220:223], a[92:95], v[108:111], v[220:223]
s_waitcnt vmcnt(8)
ds_read_b128 a[124:127], v2 offset:31744
v_add_f32 v26, v26, v11
v_mfma_f32_16x16x32_bf16 v[220:223], a[88:91], v[104:107], v[220:223]
s_barrier
v_mfma_f32_16x16x32_bf16 v[224:227], a[96:99], v[96:99], v[224:227]
ds_read_b128 a[64:67], v1 offset:0
v_cvt_pk_bf16_f32 v115, v10, v11
v_mfma_f32_16x16x32_bf16 v[224:227], a[100:103], v[100:103], v[224:227]
v_exp_f32 v12, v76
v_mfma_f32_16x16x32_bf16 v[228:231], a[100:103], v[108:111], v[228:231]
ds_read_b128 a[68:71], v1 offset:1024
v_add_f32 v27, v27, v12
v_mfma_f32_16x16x32_bf16 v[228:231], a[96:99], v[104:107], v[228:231]
PAD_11:
s_cbranch_execz M_tret
s_waitcnt lgkmcnt(4)
v_mfma_f32_16x16x32_bf16 v[232:235], a[104:107], v[96:99], v[232:235]
ds_read_b128 a[72:75], v1 offset:2048
v_mfma_f32_16x16x32_bf16 v[232:235], a[108:111], v[100:103], v[232:235]
v_exp_f32 v13, v77
v_mfma_f32_16x16x32_bf16 v[236:239], a[108:111], v[108:111], v[236:239]
ds_read_b128 a[76:79], v1 offset:3072
v_add_f32 v27, v27, v13
v_mfma_f32_16x16x32_bf16 v[236:239], a[104:107], v[104:107], v[236:239]
v_exp_f32 v14, v78
v_mfma_f32_16x16x32_bf16 v[240:243], a[112:115], v[96:99], v[240:243]
ds_read_b128 a[80:83], v1 offset:4096
v_cvt_pk_bf16_f32 v122, v12, v13
v_mfma_f32_16x16x32_bf16 v[240:243], a[116:119], v[100:103], v[240:243]
v_exp_f32 v15, v79
v_mfma_f32_16x16x32_bf16 v[244:247], a[116:119], v[108:111], v[244:247]
ds_read_b128 a[84:87], v1 offset:5120
v_add_f32 v27, v27, v14
v_mfma_f32_16x16x32_bf16 v[244:247], a[112:115], v[104:107], v[244:247]
s_waitcnt lgkmcnt(4)
v_add_f32 v27, v27, v15
v_cvt_pk_bf16_f32 v123, v14, v15
v_mfma_f32_16x16x32_bf16 v[248:251], a[120:123], v[96:99], v[248:251]
ds_read_b128 a[88:91], v1 offset:6144
v_mfma_f32_16x16x32_bf16 v[248:251], a[124:127], v[100:103], v[248:251]
v_mfma_f32_16x16x32_bf16 v[252:255], a[124:127], v[108:111], v[252:255]
ds_read_b128 a[92:95], v1 offset:7168
v_mfma_f32_16x16x32_bf16 v[252:255], a[120:123], v[104:107], v[252:255]
v_cndmask_b32 v32, v16, v7, s[32:33]
v_cndmask_b32 v33, v16, v7, s[34:35]
v_cndmask_b32 v34, v16, v7, s[36:37]
v_cndmask_b32 v35, v16, v7, s[38:39]
s_nop 1
v_mfma_f32_16x16x32_bf16 v[32:35], a[64:67], a[0:3], v[32:35]
s_add_u32 m0, s18, 131072
ds_read_b128 a[96:99], v1 offset:8192
v_cndmask_b32 v40, v16, v7, s[40:41]
v_mfma_f32_16x16x32_bf16 v[32:35], a[68:71], a[4:7], v[32:35]
s_waitcnt lgkmcnt(4)
buffer_load_dwordx4 v1, s[4:7], s8 offen offset:0 sc1 lds
v_mfma_f32_16x16x32_bf16 v[32:35], a[72:75], a[8:11], v[32:35]
ds_read_b128 a[100:103], v1 offset:9216
v_cndmask_b32 v41, v16, v7, s[42:43]
v_mfma_f32_16x16x32_bf16 v[32:35], a[76:79], a[12:15], v[32:35]
v_cndmask_b32 v42, v16, v7, s[44:45]
v_cndmask_b32 v43, v16, v7, s[46:47]
v_mfma_f32_16x16x32_bf16 v[32:35], a[80:83], a[16:19], v[32:35]
s_waitcnt lgkmcnt(4)
ds_read_b128 a[104:107], v1 offset:10240
v_mfma_f32_16x16x32_bf16 v[32:35], a[84:87], a[20:23], v[32:35]
s_waitcnt lgkmcnt(4)
buffer_load_dwordx4 v1, s[4:7], s8 offen offset:1024 sc1 lds
v_mfma_f32_16x16x32_bf16 v[32:35], a[88:91], a[24:27], v[32:35]
s_waitcnt lgkmcnt(3)
ds_read_b128 a[108:111], v1 offset:11264
v_mfma_f32_16x16x32_bf16 v[32:35], a[92:95], a[28:31], v[32:35]
v_exp_f32 v8, v80
v_mfma_f32_16x16x32_bf16 v[36:39], a[64:67], a[32:35], v[20:23]
ds_read_b128 a[112:115], v1 offset:12288
v_add_f32 v26, v26, v8
v_mfma_f32_16x16x32_bf16 v[36:39], a[68:71], a[36:39], v[36:39]
buffer_load_dwordx4 v1, s[4:7], s8 offen offset:2048 sc1 lds
v_mfma_f32_16x16x32_bf16 v[36:39], a[72:75], a[40:43], v[36:39]
ds_read_b128 a[116:119], v1 offset:13312
v_mfma_f32_16x16x32_bf16 v[36:39], a[76:79], a[44:47], v[36:39]
v_exp_f32 v9, v81
v_mfma_f32_16x16x32_bf16 v[36:39], a[80:83], a[48:51], v[36:39]
ds_read_b128 a[120:123], v1 offset:14336
v_add_f32 v26, v26, v9
v_mfma_f32_16x16x32_bf16 v[36:39], a[84:87], a[52:55], v[36:39]
buffer_load_dwordx4 v1, s[4:7], s8 offen offset:3072 sc1 lds
v_mfma_f32_16x16x32_bf16 v[36:39], a[88:91], a[56:59], v[36:39]
s_add_u32 s8, s8, 4096
ds_read_b128 a[124:127], v1 offset:15360
v_cvt_pk_bf16_f32 v116, v8, v9
v_mfma_f32_16x16x32_bf16 v[36:39], a[92:95], a[60:63], v[36:39]
s_waitcnt lgkmcnt(4)
v_exp_f32 v10, v82
v_mfma_f32_16x16x32_bf16 v[40:43], a[96:99], a[0:3], v[40:43]
s_add_u32 m0, s18, 135168
ds_read_b128 a[64:67], v1 offset:16384
v_cndmask_b32 v48, v16, v7, s[48:49]
v_mfma_f32_16x16x32_bf16 v[40:43], a[100:103], a[4:7], v[40:43]
buffer_load_dwordx4 v1, s[4:7], s8 offen offset:0 sc1 lds
v_mfma_f32_16x16x32_bf16 v[40:43], a[104:107], a[8:11], v[40:43]
ds_read_b128 a[68:71], v1 offset:17408
v_cndmask_b32 v49, v16, v7, s[50:51]
v_mfma_f32_16x16x32_bf16 v[40:43], a[108:111], a[12:15], v[40:43]
s_waitcnt lgkmcnt(4)
v_cndmask_b32 v50, v16, v7, s[52:53]
v_cndmask_b32 v51, v16, v7, s[54:55]
v_mfma_f32_16x16x32_bf16 v[40:43], a[112:115], a[16:19], v[40:43]
ds_read_b128 a[72:75], v1 offset:18432
v_add_f32 v26, v26, v10
v_mfma_f32_16x16x32_bf16 v[40:43], a[116:119], a[20:23], v[40:43]
s_waitcnt lgkmcnt(4)
buffer_load_dwordx4 v1, s[4:7], s8 offen offset:1024 sc1 lds
v_mfma_f32_16x16x32_bf16 v[40:43], a[120:123], a[24:27], v[40:43]
s_waitcnt lgkmcnt(3)
ds_read_b128 a[76:79], v1 offset:19456
v_mfma_f32_16x16x32_bf16 v[40:43], a[124:127], a[28:31], v[40:43]
v_exp_f32 v11, v83
v_mfma_f32_16x16x32_bf16 v[44:47], a[96:99], a[32:35], v[20:23]
ds_read_b128 a[80:83], v1 offset:20480
v_add_f32 v26, v26, v11
v_mfma_f32_16x16x32_bf16 v[44:47], a[100:103], a[36:39], v[44:47]
buffer_load_dwordx4 v1, s[4:7], s8 offen offset:2048 sc1 lds
v_mfma_f32_16x16x32_bf16 v[44:47], a[104:107], a[40:43], v[44:47]
ds_read_b128 a[84:87], v1 offset:21504
v_cvt_pk_bf16_f32 v117, v10, v11
v_mfma_f32_16x16x32_bf16 v[44:47], a[108:111], a[44:47], v[44:47]
v_exp_f32 v12, v84
v_mfma_f32_16x16x32_bf16 v[44:47], a[112:115], a[48:51], v[44:47]
ds_read_b128 a[88:91], v1 offset:22528
v_add_f32 v27, v27, v12
v_mfma_f32_16x16x32_bf16 v[44:47], a[116:119], a[52:55], v[44:47]
buffer_load_dwordx4 v1, s[4:7], s8 offen offset:3072 sc1 lds
v_mfma_f32_16x16x32_bf16 v[44:47], a[120:123], a[56:59], v[44:47]
s_waitcnt lgkmcnt(2)
s_add_u32 s8, s8, 28672
ds_read_b128 a[92:95], v1 offset:23552
v_mfma_f32_16x16x32_bf16 v[44:47], a[124:127], a[60:63], v[44:47]
s_sub_u32 s9, s9, 1
v_exp_f32 v13, v85
v_mfma_f32_16x16x32_bf16 v[48:51], a[64:67], a[0:3], v[48:51]
s_cmp_eq_u32 s9, 0
ds_read_b128 a[96:99], v1 offset:24576
v_cndmask_b32 v56, v16, v7, s[56:57]
v_mfma_f32_16x16x32_bf16 v[48:51], a[68:71], a[4:7], v[48:51]
s_cselect_b32 s8, s10, s8
v_cndmask_b32 v57, v16, v7, s[58:59]
v_cndmask_b32 v58, v16, v7, s[60:61]
v_mfma_f32_16x16x32_bf16 v[48:51], a[72:75], a[8:11], v[48:51]
s_cselect_b32 s9, s11, s9
ds_read_b128 a[100:103], v1 offset:25600
v_cndmask_b32 v59, v16, v7, s[62:63]
v_mfma_f32_16x16x32_bf16 v[48:51], a[76:79], a[12:15], v[48:51]
s_cselect_b32 s10, 3221225472, s10
v_exp_f32 v14, v86
v_mfma_f32_16x16x32_bf16 v[48:51], a[80:83], a[16:19], v[48:51]
s_waitcnt lgkmcnt(4)
ds_read_b128 a[104:107], v1 offset:26624
v_add_f32 v27, v27, v13
v_cvt_pk_bf16_f32 v124, v12, v13
v_mfma_f32_16x16x32_bf16 v[48:51], a[84:87], a[20:23], v[48:51]
s_waitcnt lgkmcnt(4)
v_exp_f32 v15, v87
v_mfma_f32_16x16x32_bf16 v[48:51], a[88:91], a[24:27], v[48:51]
s_waitcnt lgkmcnt(3)
ds_read_b128 a[108:111], v1 offset:27648
v_add_f32 v27, v27, v14
v_mfma_f32_16x16x32_bf16 v[48:51], a[92:95], a[28:31], v[48:51]
v_exp_f32 v8, v88
v_mfma_f32_16x16x32_bf16 v[52:55], a[64:67], a[32:35], v[20:23]
ds_read_b128 a[112:115], v1 offset:28672
v_add_f32 v27, v27, v15
v_mfma_f32_16x16x32_bf16 v[52:55], a[68:71], a[36:39], v[52:55]
v_exp_f32 v9, v89
v_mfma_f32_16x16x32_bf16 v[52:55], a[72:75], a[40:43], v[52:55]
ds_read_b128 a[116:119], v1 offset:29696
v_cvt_pk_bf16_f32 v125, v14, v15
v_mfma_f32_16x16x32_bf16 v[52:55], a[76:79], a[44:47], v[52:55]
v_exp_f32 v10, v90
v_mfma_f32_16x16x32_bf16 v[52:55], a[80:83], a[48:51], v[52:55]
ds_read_b128 a[120:123], v1 offset:30720
v_add_f32 v26, v26, v8
v_mfma_f32_16x16x32_bf16 v[52:55], a[84:87], a[52:55], v[52:55]
v_exp_f32 v11, v91
v_mfma_f32_16x16x32_bf16 v[52:55], a[88:91], a[56:59], v[52:55]
s_waitcnt vmcnt(8) lgkmcnt(4)
ds_read_b128 a[124:127], v1 offset:31744
v_add_f32 v26, v26, v9
v_cvt_pk_bf16_f32 v118, v8, v9
v_mfma_f32_16x16x32_bf16 v[52:55], a[92:95], a[60:63], v[52:55]
s_barrier
v_mfma_f32_16x16x32_bf16 v[56:59], a[96:99], a[0:3], v[56:59]
ds_read_b128 a[64:67], v2 offset:32768
v_add_f32 v26, v26, v10
v_mfma_f32_16x16x32_bf16 v[56:59], a[100:103], a[4:7], v[56:59]
v_exp_f32 v12, v92
v_mfma_f32_16x16x32_bf16 v[56:59], a[104:107], a[8:11], v[56:59]
s_waitcnt lgkmcnt(4)
ds_read_b128 a[68:71], v2 offset:33792
v_add_f32 v26, v26, v11
v_cvt_pk_bf16_f32 v119, v10, v11
v_mfma_f32_16x16x32_bf16 v[56:59], a[108:111], a[12:15], v[56:59]
v_exp_f32 v13, v93
v_mfma_f32_16x16x32_bf16 v[56:59], a[112:115], a[16:19], v[56:59]
s_waitcnt lgkmcnt(4)
ds_read_b128 a[72:75], v2 offset:34816
v_add_f32 v27, v27, v12
v_mfma_f32_16x16x32_bf16 v[56:59], a[116:119], a[20:23], v[56:59]
s_waitcnt lgkmcnt(4)
v_exp_f32 v14, v94
v_mfma_f32_16x16x32_bf16 v[56:59], a[120:123], a[24:27], v[56:59]
s_waitcnt lgkmcnt(3)
ds_read_b128 a[76:79], v2 offset:35840
v_add_f32 v27, v27, v13
v_mfma_f32_16x16x32_bf16 v[56:59], a[124:127], a[28:31], v[56:59]
v_exp_f32 v15, v95
v_mfma_f32_16x16x32_bf16 v[60:63], a[96:99], a[32:35], v[20:23]
ds_read_b128 a[80:83], v2 offset:36864
v_cvt_pk_bf16_f32 v126, v12, v13
v_mfma_f32_16x16x32_bf16 v[60:63], a[100:103], a[36:39], v[60:63]
v_add_f32 v27, v27, v14
v_add_f32 v27, v27, v15
v_mfma_f32_16x16x32_bf16 v[60:63], a[104:107], a[40:43], v[60:63]
ds_read_b128 a[84:87], v2 offset:37888
v_cvt_pk_bf16_f32 v127, v14, v15
v_mfma_f32_16x16x32_bf16 v[60:63], a[108:111], a[44:47], v[60:63]
v_add_f32 v28, v26, v27
v_cmp_nge_f32 vcc, s25, v28
v_mfma_f32_16x16x32_bf16 v[60:63], a[112:115], a[48:51], v[60:63]
ds_read_b128 a[88:91], v2 offset:38912
v_mfma_f32_16x16x32_bf16 v[60:63], a[116:119], a[52:55], v[60:63]
v_mfma_f32_16x16x32_bf16 v[60:63], a[120:123], a[56:59], v[60:63]
ds_read_b128 a[92:95], v2 offset:39936
v_mfma_f32_16x16x32_bf16 v[60:63], a[124:127], a[60:63], v[60:63]
s_waitcnt lgkmcnt(4)
s_cbranch_vccnz Lstub_6
Lback_7:
v_mfma_f32_16x16x32_bf16 v[128:131], a[64:67], v[112:115], v[128:131]
s_add_u32 m0, s18, 65536
ds_read_b128 a[96:99], v2 offset:40960
v_add_f32 v24, v24, v26
v_mfma_f32_16x16x32_bf16 v[128:131], a[68:71], v[116:119], v[128:131]
buffer_load_dwordx4 v1, s[4:7], s12 offen offset:0 sc1 lds
v_mfma_f32_16x16x32_bf16 v[132:135], a[68:71], v[124:127], v[132:135]
ds_read_b128 a[100:103], v2 offset:41984
v_add_f32 v25, v25, v27
v_mfma_f32_16x16x32_bf16 v[132:135], a[64:67], v[120:123], v[132:135]
v_exp_f32 v8, v32
v_mfma_f32_16x16x32_bf16 v[136:139], a[72:75], v[112:115], v[136:139]
ds_read_b128 a[104:107], v2 offset:43008
v_mfma_f32_16x16x32_bf16 v[136:139], a[76:79], v[116:119], v[136:139]
buffer_load_dwordx4 v1, s[4:7], s12 offen offset:1024 sc1 lds
v_mfma_f32_16x16x32_bf16 v[140:143], a[76:79], v[124:127], v[140:143]
ds_read_b128 a[108:111], v2 offset:44032
v_mfma_f32_16x16x32_bf16 v[140:143], a[72:75], v[120:123], v[140:143]
s_waitcnt lgkmcnt(4)
v_exp_f32 v9, v33
v_mfma_f32_16x16x32_bf16 v[144:147], a[80:83], v[112:115], v[144:147]
ds_read_b128 a[112:115], v2 offset:45056
v_add_f32 v26, v8, v9
v_mfma_f32_16x16x32_bf16 v[144:147], a[84:87], v[116:119], v[144:147]
buffer_load_dwordx4 v1, s[4:7], s12 offen offset:2048 sc1 lds
v_mfma_f32_16x16x32_bf16 v[148:151], a[84:87], v[124:127], v[148:151]
ds_read_b128 a[116:119], v2 offset:46080
v_cvt_pk_bf16_f32 v96, v8, v9
v_mfma_f32_16x16x32_bf16 v[148:151], a[80:83], v[120:123], v[148:151]
v_exp_f32 v10, v34
v_mfma_f32_16x16x32_bf16 v[152:155], a[88:91], v[112:115], v[152:155]
ds_read_b128 a[120:123], v2 offset:47104
v_add_f32 v26, v26, v10
v_mfma_f32_16x16x32_bf16 v[152:155], a[92:95], v[116:119], v[152:155]
buffer_load_dwordx4 v1, s[4:7], s12 offen offset:3072 sc1 lds
v_mfma_f32_16x16x32_bf16 v[156:159], a[92:95], v[124:127], v[156:159]
s_add_u32 s12, s12, 4096
ds_read_b128 a[124:127], v2 offset:48128
v_mfma_f32_16x16x32_bf16 v[156:159], a[88:91], v[120:123], v[156:159]
s_waitcnt lgkmcnt(4)
v_exp_f32 v11, v35
v_mfma_f32_16x16x32_bf16 v[160:163], a[96:99], v[112:115], v[160:163]
s_add_u32 m0, s18, 69632
ds_read_b128 a[64:67], v2 offset:49152
v_add_f32 v26, v26, v11
v_mfma_f32_16x16x32_bf16 v[160:163], a[100:103], v[116:119], v[160:163]
buffer_load_dwordx4 v1, s[4:7], s12 offen offset:0 sc1 lds
v_mfma_f32_16x16x32_bf16 v[164:167], a[100:103], v[124:127], v[164:167]
ds_read_b128 a[68:71], v2 offset:50176
v_cvt_pk_bf16_f32 v97, v10, v11
v_mfma_f32_16x16x32_bf16 v[164:167], a[96:99], v[120:123], v[164:167]
v_mfma_f32_16x16x32_bf16 v[168:171], a[104:107], v[112:115], v[168:171]
ds_read_b128 a[72:75], v2 offset:51200
v_mfma_f32_16x16x32_bf16 v[168:171], a[108:111], v[116:119], v[168:171]
buffer_load_dwordx4 v1, s[4:7], s12 offen offset:1024 sc1 lds
v_mfma_f32_16x16x32_bf16 v[172:175], a[108:111], v[124:127], v[172:175]
ds_read_b128 a[76:79], v2 offset:52224
v_mfma_f32_16x16x32_bf16 v[172:175], a[104:107], v[120:123], v[172:175]
s_waitcnt lgkmcnt(4)
v_exp_f32 v12, v36
v_mfma_f32_16x16x32_bf16 v[176:179], a[112:115], v[112:115], v[176:179]
ds_read_b128 a[80:83], v2 offset:53248
v_mfma_f32_16x16x32_bf16 v[176:179], a[116:119], v[116:119], v[176:179]
buffer_load_dwordx4 v1, s[4:7], s12 offen offset:2048 sc1 lds
v_mfma_f32_16x16x32_bf16 v[180:183], a[116:119], v[124:127], v[180:183]
ds_read_b128 a[84:87], v2 offset:54272
v_mfma_f32_16x16x32_bf16 v[180:183], a[112:115], v[120:123], v[180:183]
v_exp_f32 v13, v37
v_mfma_f32_16x16x32_bf16 v[184:187], a[120:123], v[112:115], v[184:187]
ds_read_b128 a[88:91], v2 offset:55296
v_add_f32 v27, v12, v13
v_mfma_f32_16x16x32_bf16 v[184:187], a[124:127], v[116:119], v[184:187]
s_waitcnt lgkmcnt(4)
buffer_load_dwordx4 v1, s[4:7], s12 offen offset:3072 sc1 lds
v_mfma_f32_16x16x32_bf16 v[188:191], a[124:127], v[124:127], v[188:191]
s_add_u32 s12, s12, 28672
ds_read_b128 a[92:95], v2 offset:56320
v_cvt_pk_bf16_f32 v104, v12, v13
v_mfma_f32_16x16x32_bf16 v[188:191], a[120:123], v[120:123], v[188:191]
s_sub_u32 s13, s13, 1
v_exp_f32 v14, v38
v_mfma_f32_16x16x32_bf16 v[192:195], a[64:67], v[112:115], v[192:195]
s_cmp_eq_u32 s13, 0
ds_read_b128 a[96:99], v2 offset:57344
v_add_f32 v27, v27, v14
v_mfma_f32_16x16x32_bf16 v[192:195], a[68:71], v[116:119], v[192:195]
s_cselect_b32 s12, s14, s12
v_exp_f32 v15, v39
v_mfma_f32_16x16x32_bf16 v[196:199], a[68:71], v[124:127], v[196:199]
s_cselect_b32 s13, s15, s13
ds_read_b128 a[100:103], v2 offset:58368
v_add_f32 v27, v27, v15
v_mfma_f32_16x16x32_bf16 v[196:199], a[64:67], v[120:123], v[196:199]
s_cselect_b32 s14, 3221225472, s14
v_cvt_pk_bf16_f32 v105, v14, v15
v_mfma_f32_16x16x32_bf16 v[200:203], a[72:75], v[112:115], v[200:203]
s_waitcnt lgkmcnt(4)
ds_read_b128 a[104:107], v2 offset:59392
v_mfma_f32_16x16x32_bf16 v[200:203], a[76:79], v[116:119], v[200:203]
buffer_load_dword v3, off, s[4:7], s80 sc1
v_mfma_f32_16x16x32_bf16 v[204:207], a[76:79], v[124:127], v[204:207]
ds_read_b128 a[108:111], v2 offset:60416
v_mfma_f32_16x16x32_bf16 v[204:207], a[72:75], v[120:123], v[204:207]
v_exp_f32 v8, v40
v_mfma_f32_16x16x32_bf16 v[208:211], a[80:83], v[112:115], v[208:211]
ds_read_b128 a[112:115], v2 offset:61440
v_add_f32 v26, v26, v8
v_mfma_f32_16x16x32_bf16 v[208:211], a[84:87], v[116:119], v[208:211]
v_exp_f32 v9, v41
v_mfma_f32_16x16x32_bf16 v[212:215], a[84:87], v[124:127], v[212:215]
ds_read_b128 a[116:119], v2 offset:62464
v_add_f32 v26, v26, v9
v_mfma_f32_16x16x32_bf16 v[212:215], a[80:83], v[120:123], v[212:215]
s_waitcnt lgkmcnt(4)
v_exp_f32 v10, v42
v_mfma_f32_16x16x32_bf16 v[216:219], a[88:91], v[112:115], v[216:219]
ds_read_b128 a[120:123], v2 offset:63488
v_cvt_pk_bf16_f32 v98, v8, v9
v_mfma_f32_16x16x32_bf16 v[216:219], a[92:95], v[116:119], v[216:219]
v_exp_f32 v11, v43
v_mfma_f32_16x16x32_bf16 v[220:223], a[92:95], v[124:127], v[220:223]
s_waitcnt vmcnt(9)
ds_read_b128 a[124:127], v2 offset:64512
v_add_f32 v26, v26, v10
v_mfma_f32_16x16x32_bf16 v[220:223], a[88:91], v[120:123], v[220:223]
s_barrier
v_mfma_f32_16x16x32_bf16 v[224:227], a[96:99], v[112:115], v[224:227]
ds_read_b128 a[64:67], v4 offset:0
v_add_f32 v26, v26, v11
v_mfma_f32_16x16x32_bf16 v[224:227], a[100:103], v[116:119], v[224:227]
v_cvt_pk_bf16_f32 v99, v10, v11
v_mfma_f32_16x16x32_bf16 v[228:231], a[100:103], v[124:127], v[228:231]
ds_read_b128 a[68:71], v4 offset:1024
v_mfma_f32_16x16x32_bf16 v[228:231], a[96:99], v[120:123], v[228:231]
s_waitcnt lgkmcnt(4)
v_exp_f32 v12, v44
v_mfma_f32_16x16x32_bf16 v[232:235], a[104:107], v[112:115], v[232:235]
ds_read_b128 a[72:75], v4 offset:2048
v_add_f32 v27, v27, v12
v_mfma_f32_16x16x32_bf16 v[232:235], a[108:111], v[116:119], v[232:235]
v_exp_f32 v13, v45
v_mfma_f32_16x16x32_bf16 v[236:239], a[108:111], v[124:127], v[236:239]
ds_read_b128 a[76:79], v4 offset:3072
v_add_f32 v27, v27, v13
v_mfma_f32_16x16x32_bf16 v[236:239], a[104:107], v[120:123], v[236:239]
v_exp_f32 v14, v46
v_mfma_f32_16x16x32_bf16 v[240:243], a[112:115], v[112:115], v[240:243]
ds_read_b128 a[80:83], v4 offset:4096
v_cvt_pk_bf16_f32 v106, v12, v13
v_mfma_f32_16x16x32_bf16 v[240:243], a[116:119], v[116:119], v[240:243]
v_exp_f32 v15, v47
v_mfma_f32_16x16x32_bf16 v[244:247], a[116:119], v[124:127], v[244:247]
ds_read_b128 a[84:87], v4 offset:5120
v_add_f32 v27, v27, v14
v_mfma_f32_16x16x32_bf16 v[244:247], a[112:115], v[120:123], v[244:247]
s_waitcnt lgkmcnt(4)
v_add_f32 v27, v27, v15
v_cvt_pk_bf16_f32 v107, v14, v15
v_mfma_f32_16x16x32_bf16 v[248:251], a[120:123], v[112:115], v[248:251]
ds_read_b128 a[88:91], v4 offset:6144
v_mfma_f32_16x16x32_bf16 v[248:251], a[124:127], v[116:119], v[248:251]
v_mfma_f32_16x16x32_bf16 v[252:255], a[124:127], v[124:127], v[252:255]
ds_read_b128 a[92:95], v4 offset:7168
v_mfma_f32_16x16x32_bf16 v[252:255], a[120:123], v[120:123], v[252:255]
K2_dx1:
v_cndmask_b32 v68, v20, v7, s[32:33]
v_cndmask_b32 v69, v20, v7, s[34:35]
v_cndmask_b32 v70, v20, v7, s[36:37]
v_cndmask_b32 v71, v20, v7, s[38:39]
s_nop 1
v_mfma_f32_16x16x32_bf16 v[68:71], a[64:67], a[32:35], v[68:71]
s_add_u32 m0, s18, 0
ds_read_b128 a[96:99], v4 offset:8192
v_cndmask_b32 v76, v20, v7, s[40:41]
v_cndmask_b32 v79, v20, v7, s[46:47]
v_mfma_f32_16x16x32_bf16 v[68:71], a[68:71], a[36:39], v[68:71]
s_waitcnt lgkmcnt(4)
ds_read_b128 a[100:103], v4 offset:9216
buffer_load_dwordx4 v1, s[4:7], s12 offen offset:0 sc1 lds
v_mfma_f32_16x16x32_bf16 v[68:71], a[72:75], a[40:43], v[68:71]
ds_read_b128 a[104:107], v4 offset:10240
v_cndmask_b32 v77, v20, v7, s[42:43]
v_mfma_f32_16x16x32_bf16 v[68:71], a[76:79], a[44:47], v[68:71]
ds_read_b128 a[108:111], v4 offset:11264
buffer_load_dwordx4 v1, s[4:7], s12 offen offset:1024 sc1 lds
v_mfma_f32_16x16x32_bf16 v[68:71], a[80:83], a[48:51], v[68:71]
s_waitcnt lgkmcnt(6)
ds_read_b128 a[112:115], v4 offset:12288
v_cndmask_b32 v78, v20, v7, s[44:45]
v_mfma_f32_16x16x32_bf16 v[68:71], a[84:87], a[52:55], v[68:71]
s_waitcnt lgkmcnt(6)
ds_read_b128 a[116:119], v4 offset:13312
buffer_load_dwordx4 v1, s[4:7], s12 offen offset:2048 sc1 lds
v_mfma_f32_16x16x32_bf16 v[68:71], a[88:91], a[56:59], v[68:71]
s_waitcnt lgkmcnt(6)
ds_read_b128 a[120:123], v4 offset:14336
v_exp_f32 v8, v48
v_exp_f32 v9, v49
v_exp_f32 v10, v50
v_mfma_f32_16x16x32_bf16 v[68:71], a[92:95], a[60:63], v[68:71]
s_waitcnt lgkmcnt(5)
ds_read_b128 a[124:127], v4 offset:15360
buffer_load_dwordx4 v1, s[4:7], s12 offen offset:3072 sc1 lds
v_add_f32 v26, v26, v8
v_add_f32 v26, v26, v9
v_cvt_pk_bf16_f32 v100, v8, v9
v_add_f32 v26, v26, v10
v_mfma_f32_16x16x32_bf16 v[76:79], a[96:99], a[32:35], v[76:79]
s_add_u32 s12, s12, 4096
s_add_u32 m0, s18, 4096
ds_read_b128 a[64:67], v4 offset:16384
v_cndmask_b32 v86, v20, v7, s[52:53]
v_cndmask_b32 v87, v20, v7, s[54:55]
v_mfma_f32_16x16x32_bf16 v[76:79], a[100:103], a[36:39], v[76:79]
s_waitcnt lgkmcnt(6)
ds_read_b128 a[68:71], v4 offset:17408
buffer_load_dwordx4 v1, s[4:7], s12 offen offset:0 sc1 lds
v_mfma_f32_16x16x32_bf16 v[76:79], a[104:107], a[40:43], v[76:79]
s_waitcnt lgkmcnt(6)
ds_read_b128 a[72:75], v4 offset:18432
v_cndmask_b32 v84, v20, v7, s[48:49]
v_mfma_f32_16x16x32_bf16 v[76:79], a[108:111], a[44:47], v[76:79]
s_waitcnt lgkmcnt(6)
ds_read_b128 a[76:79], v4 offset:19456
buffer_load_dwordx4 v1, s[4:7], s12 offen offset:1024 sc1 lds
v_mfma_f32_16x16x32_bf16 v[76:79], a[112:115], a[48:51], v[76:79]
s_waitcnt lgkmcnt(6)
ds_read_b128 a[80:83], v4 offset:20480
v_cndmask_b32 v85, v20, v7, s[50:51]
v_mfma_f32_16x16x32_bf16 v[76:79], a[116:119], a[52:55], v[76:79]
s_waitcnt lgkmcnt(6)
ds_read_b128 a[84:87], v4 offset:21504
buffer_load_dwordx4 v1, s[4:7], s12 offen offset:2048 sc1 lds
v_mfma_f32_16x16x32_bf16 v[76:79], a[120:123], a[56:59], v[76:79]
s_waitcnt lgkmcnt(6)
ds_read_b128 a[88:91], v4 offset:22528
v_exp_f32 v11, v51
v_exp_f32 v12, v52
v_mfma_f32_16x16x32_bf16 v[76:79], a[124:127], a[60:63], v[76:79]
s_waitcnt lgkmcnt(1)
ds_read_b128 a[92:95], v4 offset:23552
buffer_load_dwordx4 v1, s[4:7], s12 offen offset:3072 sc1 lds
v_add_f32 v26, v26, v11
v_cvt_pk_bf16_f32 v101, v10, v11
v_add_f32 v27, v27, v12
v_mfma_f32_16x16x32_bf16 v[84:87], a[64:67], a[32:35], v[84:87]
s_add_u32 s12, s12, 28672
ds_read_b128 a[96:99], v4 offset:24576
v_cndmask_b32 v92, v20, v7, s[56:57]
v_mfma_f32_16x16x32_bf16 v[84:87], a[68:71], a[36:39], v[84:87]
s_sub_u32 s13, s13, 1
ds_read_b128 a[100:103], v4 offset:25600
v_cndmask_b32 v93, v20, v7, s[58:59]
v_mfma_f32_16x16x32_bf16 v[84:87], a[72:75], a[40:43], v[84:87]
s_cmp_eq_u32 s13, 0
ds_read_b128 a[104:107], v4 offset:26624
v_cndmask_b32 v94, v20, v7, s[60:61]
v_mfma_f32_16x16x32_bf16 v[84:87], a[76:79], a[44:47], v[84:87]
s_cselect_b32 s12, s14, s12
ds_read_b128 a[108:111], v4 offset:27648
v_cndmask_b32 v95, v20, v7, s[62:63]
v_mfma_f32_16x16x32_bf16 v[84:87], a[80:83], a[48:51], v[84:87]
s_cselect_b32 s13, s15, s13
ds_read_b128 a[112:115], v4 offset:28672
v_exp_f32 v13, v53
v_exp_f32 v14, v54
v_mfma_f32_16x16x32_bf16 v[84:87], a[84:87], a[52:55], v[84:87]
s_waitcnt lgkmcnt(6)
s_cselect_b32 s14, 3221225472, s14
ds_read_b128 a[116:119], v4 offset:29696
v_exp_f32 v15, v55
v_exp_f32 v8, v56
v_exp_f32 v9, v57
v_add_f32 v27, v27, v13
v_cvt_pk_bf16_f32 v108, v12, v13
v_add_f32 v27, v27, v14
v_mfma_f32_16x16x32_bf16 v[84:87], a[88:91], a[56:59], v[84:87]
s_waitcnt lgkmcnt(6)
ds_read_b128 a[120:123], v4 offset:30720
v_exp_f32 v10, v58
v_exp_f32 v11, v59
v_add_f32 v27, v27, v15
v_cvt_pk_bf16_f32 v109, v14, v15
v_mfma_f32_16x16x32_bf16 v[84:87], a[92:95], a[60:63], v[84:87]
s_waitcnt vmcnt(8) lgkmcnt(6)
s_barrier
ds_read_b128 a[124:127], v4 offset:31744
v_mfma_f32_16x16x32_bf16 v[92:95], a[96:99], a[32:35], v[92:95]
s_waitcnt lgkmcnt(6)
ds_read_b128 a[64:67], v2 offset:0
v_exp_f32 v12, v60
v_exp_f32 v13, v61
v_mfma_f32_16x16x32_bf16 v[92:95], a[100:103], a[36:39], v[92:95]
s_waitcnt lgkmcnt(6)
ds_read_b128 a[68:71], v2 offset:1024
v_exp_f32 v14, v62
v_exp_f32 v15, v63
v_mfma_f32_16x16x32_bf16 v[92:95], a[104:107], a[40:43], v[92:95]
s_waitcnt lgkmcnt(6)
ds_read_b128 a[72:75], v2 offset:2048
v_add_f32 v26, v26, v8
v_add_f32 v26, v26, v9
v_cvt_pk_bf16_f32 v102, v8, v9
v_mfma_f32_16x16x32_bf16 v[92:95], a[108:111], a[44:47], v[92:95]
s_waitcnt lgkmcnt(6)
ds_read_b128 a[76:79], v2 offset:3072
v_add_f32 v26, v26, v10
v_add_f32 v26, v26, v11
v_cvt_pk_bf16_f32 v103, v10, v11
v_mfma_f32_16x16x32_bf16 v[92:95], a[112:115], a[48:51], v[92:95]
s_waitcnt lgkmcnt(6)
ds_read_b128 a[80:83], v2 offset:4096
v_add_f32 v27, v27, v12
v_mfma_f32_16x16x32_bf16 v[92:95], a[116:119], a[52:55], v[92:95]
s_waitcnt lgkmcnt(6)
ds_read_b128 a[84:87], v2 offset:5120
v_add_f32 v27, v27, v13
v_cvt_pk_bf16_f32 v110, v12, v13
v_mfma_f32_16x16x32_bf16 v[92:95], a[120:123], a[56:59], v[92:95]
s_waitcnt lgkmcnt(6)
ds_read_b128 a[88:91], v2 offset:6144
v_add_f32 v27, v27, v14
v_add_f32 v27, v27, v15
v_cvt_pk_bf16_f32 v111, v14, v15
v_mfma_f32_16x16x32_bf16 v[92:95], a[124:127], a[60:63], v[92:95]
s_waitcnt lgkmcnt(6)
ds_read_b128 a[92:95], v2 offset:7168
v_add_f32 v28, v26, v27
v_cmp_nge_f32 vcc, s25, v28
s_cbranch_vccnz Lstub_8
Lback_9:
s_cmp_lg_u32 s24, 1
s_cbranch_scc1 K2_plain
v_cmp_gt_u32 vcc, 1, v3
s_cbranch_vccnz K2_tspin
K2_tok:
v_mfma_f32_16x16x32_bf16 v[128:131], a[64:67], v[96:99], v[128:131]
s_waitcnt lgkmcnt(6)
ds_read_b128 a[96:99], v2 offset:8192
v_add_f32 v24, v24, v26
v_mfma_f32_16x16x32_bf16 v[128:131], a[68:71], v[100:103], v[128:131]
buffer_load_dwordx4 v[28:31], v1, s[4:7], s27 offen sc1
v_mfma_f32_16x16x32_bf16 v[132:135], a[68:71], v[108:111], v[132:135]
ds_read_b128 a[100:103], v2 offset:9216
v_add_f32 v25, v25, v27
v_mfma_f32_16x16x32_bf16 v[132:135], a[64:67], v[104:107], v[132:135]
s_waitcnt lgkmcnt(6)
v_exp_f32 v8, v68
v_mfma_f32_16x16x32_bf16 v[136:139], a[72:75], v[96:99], v[136:139]
s_add_u32 s22, s76, 0
ds_read_b128 a[104:107], v2 offset:10240
v_exp_f32 v9, v69
v_mfma_f32_16x16x32_bf16 v[136:139], a[76:79], v[100:103], v[136:139]
buffer_load_dwordx4 v[32:35], v1, s[4:7], s22 offen offset:0 sc1
v_mfma_f32_16x16x32_bf16 v[140:143], a[76:79], v[108:111], v[140:143]
ds_read_b128 a[108:111], v2 offset:11264
v_add_f32 v27, v8, v9
v_mfma_f32_16x16x32_bf16 v[140:143], a[72:75], v[104:107], v[140:143]
s_waitcnt lgkmcnt(5)
v_exp_f32 v10, v70
v_mfma_f32_16x16x32_bf16 v[144:147], a[80:83], v[96:99], v[144:147]
ds_read_b128 a[112:115], v2 offset:12288
v_cvt_pk_bf16_f32 v120, v8, v9
v_mfma_f32_16x16x32_bf16 v[144:147], a[84:87], v[100:103], v[144:147]
buffer_load_dwordx4 v[36:39], v1, s[4:7], s22 offen offset:1024 sc1
v_mfma_f32_16x16x32_bf16 v[148:151], a[84:87], v[108:111], v[148:151]
ds_read_b128 a[116:119], v2 offset:13312
v_add_f32 v27, v27, v10
v_mfma_f32_16x16x32_bf16 v[148:151], a[80:83], v[104:107], v[148:151]
v_exp_f32 v11, v71
v_mfma_f32_16x16x32_bf16 v[152:155], a[88:91], v[96:99], v[152:155]
s_waitcnt lgkmcnt(4)
ds_read_b128 a[120:123], v2 offset:14336
v_add_f32 v27, v27, v11
v_mfma_f32_16x16x32_bf16 v[152:155], a[92:95], v[100:103], v[152:155]
buffer_load_dwordx4 v[40:43], v1, s[4:7], s22 offen offset:2048 sc1
v_mfma_f32_16x16x32_bf16 v[156:159], a[92:95], v[108:111], v[156:159]
ds_read_b128 a[124:127], v2 offset:15360
v_cvt_pk_bf16_f32 v121, v10, v11
v_mfma_f32_16x16x32_bf16 v[156:159], a[88:91], v[104:107], v[156:159]
v_exp_f32 v12, v76
v_mfma_f32_16x16x32_bf16 v[160:163], a[96:99], v[96:99], v[160:163]
ds_read_b128 a[64:67], v2 offset:16384
v_add_f32 v27, v27, v12
v_mfma_f32_16x16x32_bf16 v[160:163], a[100:103], v[100:103], v[160:163]
buffer_load_dwordx4 v[44:47], v1, s[4:7], s22 offen offset:3072 sc1
v_mfma_f32_16x16x32_bf16 v[164:167], a[100:103], v[108:111], v[164:167]
ds_read_b128 a[68:71], v2 offset:17408
v_mfma_f32_16x16x32_bf16 v[164:167], a[96:99], v[104:107], v[164:167]
s_waitcnt lgkmcnt(4)
v_exp_f32 v13, v77
v_mfma_f32_16x16x32_bf16 v[168:171], a[104:107], v[96:99], v[168:171]
s_add_u32 s22, s76, 4096
ds_read_b128 a[72:75], v2 offset:18432
v_add_f32 v27, v27, v13
v_mfma_f32_16x16x32_bf16 v[168:171], a[108:111], v[100:103], v[168:171]
PAD_12:
s_cbranch_execz M_tret
buffer_load_dwordx4 v[48:51], v1, s[4:7], s22 offen offset:0 sc1
v_mfma_f32_16x16x32_bf16 v[172:175], a[108:111], v[108:111], v[172:175]
ds_read_b128 a[76:79], v2 offset:19456
v_exp_f32 v14, v78
v_mfma_f32_16x16x32_bf16 v[172:175], a[104:107], v[104:107], v[172:175]
v_exp_f32 v15, v79
v_mfma_f32_16x16x32_bf16 v[176:179], a[112:115], v[96:99], v[176:179]
ds_read_b128 a[80:83], v2 offset:20480
v_cvt_pk_bf16_f32 v122, v12, v13
v_mfma_f32_16x16x32_bf16 v[176:179], a[116:119], v[100:103], v[176:179]
buffer_load_dwordx4 v[52:55], v1, s[4:7], s22 offen offset:1024 sc1
v_mfma_f32_16x16x32_bf16 v[180:183], a[116:119], v[108:111], v[180:183]
ds_read_b128 a[84:87], v2 offset:21504
v_add_f32 v27, v27, v14
v_mfma_f32_16x16x32_bf16 v[180:183], a[112:115], v[104:107], v[180:183]
s_waitcnt lgkmcnt(4)
v_exp_f32 v8, v84
v_mfma_f32_16x16x32_bf16 v[184:187], a[120:123], v[96:99], v[184:187]
ds_read_b128 a[88:91], v2 offset:22528
v_add_f32 v27, v27, v15
v_cvt_pk_bf16_f32 v123, v14, v15
v_mfma_f32_16x16x32_bf16 v[184:187], a[124:127], v[100:103], v[184:187]
buffer_load_dwordx4 v[56:59], v1, s[4:7], s22 offen offset:2048 sc1
v_mfma_f32_16x16x32_bf16 v[188:191], a[124:127], v[108:111], v[188:191]
ds_read_b128 a[92:95], v2 offset:23552
v_add_f32 v27, v27, v8
v_mfma_f32_16x16x32_bf16 v[188:191], a[120:123], v[104:107], v[188:191]
v_exp_f32 v9, v85
v_mfma_f32_16x16x32_bf16 v[192:195], a[64:67], v[96:99], v[192:195]
ds_read_b128 a[96:99], v2 offset:24576
v_add_f32 v27, v27, v9
v_mfma_f32_16x16x32_bf16 v[192:195], a[68:71], v[100:103], v[192:195]
buffer_load_dwordx4 v[60:63], v1, s[4:7], s22 offen offset:3072 sc1
v_mfma_f32_16x16x32_bf16 v[196:199], a[68:71], v[108:111], v[196:199]
ds_read_b128 a[100:103], v2 offset:25600
v_cvt_pk_bf16_f32 v124, v8, v9
v_mfma_f32_16x16x32_bf16 v[196:199], a[64:67], v[104:107], v[196:199]
s_waitcnt lgkmcnt(4)
v_exp_f32 v10, v86
v_mfma_f32_16x16x32_bf16 v[200:203], a[72:75], v[96:99], v[200:203]
s_add_u32 s22, s76, 8192
ds_read_b128 a[104:107], v2 offset:26624
v_add_f32 v27, v27, v10
v_mfma_f32_16x16x32_bf16 v[200:203], a[76:79], v[100:103], v[200:203]
buffer_load_dwordx4 a[32:35], v1, s[4:7], s22 offen offset:0 sc1
v_mfma_f32_16x16x32_bf16 v[204:207], a[76:79], v[108:111], v[204:207]
ds_read_b128 a[108:111], v2 offset:27648
v_mfma_f32_16x16x32_bf16 v[204:207], a[72:75], v[104:107], v[204:207]
v_exp_f32 v11, v87
v_mfma_f32_16x16x32_bf16 v[208:211], a[80:83], v[96:99], v[208:211]
ds_read_b128 a[112:115], v2 offset:28672
v_exp_f32 v12, v92
v_mfma_f32_16x16x32_bf16 v[208:211], a[84:87], v[100:103], v[208:211]
buffer_load_dwordx4 a[36:39], v1, s[4:7], s22 offen offset:1024 sc1
v_mfma_f32_16x16x32_bf16 v[212:215], a[84:87], v[108:111], v[212:215]
ds_read_b128 a[116:119], v2 offset:29696
v_add_f32 v27, v27, v11
v_mfma_f32_16x16x32_bf16 v[212:215], a[80:83], v[104:107], v[212:215]
s_waitcnt lgkmcnt(4)
v_exp_f32 v13, v93
v_mfma_f32_16x16x32_bf16 v[216:219], a[88:91], v[96:99], v[216:219]
ds_read_b128 a[120:123], v2 offset:30720
v_cvt_pk_bf16_f32 v125, v10, v11
v_add_f32 v27, v27, v12
v_mfma_f32_16x16x32_bf16 v[216:219], a[92:95], v[100:103], v[216:219]
buffer_load_dwordx4 a[40:43], v1, s[4:7], s22 offen offset:2048 sc1
v_mfma_f32_16x16x32_bf16 v[220:223], a[92:95], v[108:111], v[220:223]
s_waitcnt vmcnt(12)
ds_read_b128 a[124:127], v2 offset:31744
v_add_f32 v27, v27, v13
v_mfma_f32_16x16x32_bf16 v[220:223], a[88:91], v[104:107], v[220:223]
s_barrier
v_mfma_f32_16x16x32_bf16 v[224:227], a[96:99], v[96:99], v[224:227]
ds_read_b128 a[64:67], v1 offset:0
v_cvt_pk_bf16_f32 v126, v12, v13
v_mfma_f32_16x16x32_bf16 v[224:227], a[100:103], v[100:103], v[224:227]
buffer_load_dwordx4 a[44:47], v1, s[4:7], s22 offen offset:3072 sc1
v_mfma_f32_16x16x32_bf16 v[228:231], a[100:103], v[108:111], v[228:231]
ds_read_b128 a[68:71], v1 offset:1024
v_mfma_f32_16x16x32_bf16 v[228:231], a[96:99], v[104:107], v[228:231]
s_waitcnt lgkmcnt(4)
v_exp_f32 v14, v94
v_mfma_f32_16x16x32_bf16 v[232:235], a[104:107], v[96:99], v[232:235]
s_add_u32 s22, s76, 12288
ds_read_b128 a[72:75], v1 offset:2048
v_add_f32 v27, v27, v14
v_mfma_f32_16x16x32_bf16 v[232:235], a[108:111], v[100:103], v[232:235]
buffer_load_dwordx4 a[48:51], v1, s[4:7], s22 offen offset:0 sc1
v_mfma_f32_16x16x32_bf16 v[236:239], a[108:111], v[108:111], v[236:239]
ds_read_b128 a[76:79], v1 offset:3072
v_mfma_f32_16x16x32_bf16 v[236:239], a[104:107], v[104:107], v[236:239]
v_exp_f32 v15, v95
v_mfma_f32_16x16x32_bf16 v[240:243], a[112:115], v[96:99], v[240:243]
ds_read_b128 a[80:83], v1 offset:4096
v_add_f32 v27, v27, v15
v_mfma_f32_16x16x32_bf16 v[240:243], a[116:119], v[100:103], v[240:243]
buffer_load_dwordx4 a[52:55], v1, s[4:7], s22 offen offset:1024 sc1
v_mfma_f32_16x16x32_bf16 v[244:247], a[116:119], v[108:111], v[244:247]
ds_read_b128 a[84:87], v1 offset:5120
v_cvt_pk_bf16_f32 v127, v14, v15
v_mfma_f32_16x16x32_bf16 v[244:247], a[112:115], v[104:107], v[244:247]
s_waitcnt lgkmcnt(4)
v_cmp_nge_f32 vcc, s25, v27
v_mfma_f32_16x16x32_bf16 v[248:251], a[120:123], v[96:99], v[248:251]
ds_read_b128 a[88:91], v1 offset:6144
v_mfma_f32_16x16x32_bf16 v[248:251], a[124:127], v[100:103], v[248:251]
buffer_load_dwordx4 a[56:59], v1, s[4:7], s22 offen offset:2048 sc1
v_mfma_f32_16x16x32_bf16 v[252:255], a[124:127], v[108:111], v[252:255]
ds_read_b128 a[92:95], v1 offset:7168
v_mfma_f32_16x16x32_bf16 v[252:255], a[120:123], v[104:107], v[252:255]
s_waitcnt lgkmcnt(2)
buffer_load_dwordx4 a[60:63], v1, s[4:7], s22 offen offset:3072 sc1
s_cbranch_vccnz Lstub_10
Lback_11:
v_mfma_f32_16x16x32_bf16 v[132:135], a[64:67], v[120:123], v[132:135]
s_mov_b64 s[36:37], s[86:87]
ds_read_b128 a[96:99], v1 offset:8192
v_add_f32 v25, v25, v27
v_mfma_f32_16x16x32_bf16 v[132:135], a[68:71], v[124:127], v[132:135]
s_mov_b32 s38, 3670016
ds_read_b128 a[100:103], v1 offset:9216
v_accvgpr_read_b32 v112, a184
v_mfma_f32_16x16x32_bf16 v[140:143], a[72:75], v[120:123], v[140:143]
s_mov_b32 s39, 0x20000
ds_read_b128 a[104:107], v1 offset:10240
v_accvgpr_read_b32 v113, a185
v_mfma_f32_16x16x32_bf16 v[140:143], a[76:79], v[124:127], v[140:143]
s_lshl_b32 s8, s29, 3
ds_read_b128 a[108:111], v1 offset:11264
v_accvgpr_read_b32 v114, a186
v_mfma_f32_16x16x32_bf16 v[148:151], a[80:83], v[120:123], v[148:151]
s_add_u32 s8, s8, s3
ds_read_b128 a[112:115], v1 offset:12288
v_accvgpr_read_b32 v115, a187
v_mfma_f32_16x16x32_bf16 v[148:151], a[84:87], v[124:127], v[148:151]
s_waitcnt lgkmcnt(3)
s_lshl_b32 s8, s8, 4
ds_read_b128 a[116:119], v1 offset:13312
v_accvgpr_read_b32 v116, a188
v_mfma_f32_16x16x32_bf16 v[156:159], a[88:91], v[120:123], v[156:159]
s_add_u32 s8, s8, s20
ds_read_b128 a[120:123], v1 offset:14336
v_accvgpr_read_b32 v117, a189
v_mfma_f32_16x16x32_bf16 v[156:159], a[92:95], v[124:127], v[156:159]
s_mul_i32 s8, s8, 14336
ds_read_b128 a[124:127], v1 offset:15360
v_accvgpr_read_b32 v118, a190
v_mfma_f32_16x16x32_bf16 v[164:167], a[96:99], v[120:123], v[164:167]
s_add_u32 s8, s8, 104857600
ds_read_b128 a[64:67], v1 offset:16384
v_accvgpr_read_b32 v119, a191
v_mfma_f32_16x16x32_bf16 v[164:167], a[100:103], v[124:127], v[164:167]
s_waitcnt lgkmcnt(6)
s_add_u32 s12, s8, 917504
ds_read_b128 a[68:71], v1 offset:17408
v_mfma_f32_16x16x32_bf16 v[172:175], a[104:107], v[120:123], v[172:175]
s_waitcnt lgkmcnt(6)
ds_read_b128 a[72:75], v1 offset:18432
v_mfma_f32_16x16x32_bf16 v[172:175], a[108:111], v[124:127], v[172:175]
s_waitcnt lgkmcnt(6)
ds_read_b128 a[76:79], v1 offset:19456
v_mfma_f32_16x16x32_bf16 v[180:183], a[112:115], v[120:123], v[180:183]
s_waitcnt lgkmcnt(6)
ds_read_b128 a[80:83], v1 offset:20480
v_mfma_f32_16x16x32_bf16 v[180:183], a[116:119], v[124:127], v[180:183]
s_waitcnt lgkmcnt(6)
ds_read_b128 a[84:87], v1 offset:21504
v_mfma_f32_16x16x32_bf16 v[188:191], a[120:123], v[120:123], v[188:191]
s_waitcnt lgkmcnt(6)
ds_read_b128 a[88:91], v1 offset:22528
v_mfma_f32_16x16x32_bf16 v[188:191], a[124:127], v[124:127], v[188:191]
s_waitcnt lgkmcnt(6)
ds_read_b128 a[92:95], v1 offset:23552
v_mfma_f32_16x16x32_bf16 v[196:199], a[64:67], v[120:123], v[196:199]
s_waitcnt lgkmcnt(6)
ds_read_b128 a[96:99], v1 offset:24576
v_mfma_f32_16x16x32_bf16 v[196:199], a[68:71], v[124:127], v[196:199]
s_waitcnt lgkmcnt(6)
ds_read_b128 a[100:103], v1 offset:25600
v_mfma_f32_16x16x32_bf16 v[204:207], a[72:75], v[120:123], v[204:207]
s_waitcnt lgkmcnt(6)
ds_read_b128 a[104:107], v1 offset:26624
v_mfma_f32_16x16x32_bf16 v[204:207], a[76:79], v[124:127], v[204:207]
s_waitcnt lgkmcnt(6)
ds_read_b128 a[108:111], v1 offset:27648
v_mfma_f32_16x16x32_bf16 v[212:215], a[80:83], v[120:123], v[212:215]
s_waitcnt lgkmcnt(6)
ds_read_b128 a[112:115], v1 offset:28672
v_mfma_f32_16x16x32_bf16 v[212:215], a[84:87], v[124:127], v[212:215]
s_waitcnt lgkmcnt(6)
ds_read_b128 a[116:119], v1 offset:29696
v_mfma_f32_16x16x32_bf16 v[220:223], a[88:91], v[120:123], v[220:223]
s_waitcnt lgkmcnt(6)
s_add_u32 m0, s18, 32768
ds_read_b128 a[120:123], v1 offset:30720
v_mfma_f32_16x16x32_bf16 v[220:223], a[92:95], v[124:127], v[220:223]
s_waitcnt lgkmcnt(6)
ds_read_b128 a[124:127], v1 offset:31744
v_mfma_f32_16x16x32_bf16 v[228:231], a[96:99], v[120:123], v[228:231]
s_waitcnt lgkmcnt(6)
buffer_load_dwordx4 v112, s[36:39], s81 offen offset:0 lds
v_mfma_f32_16x16x32_bf16 v[228:231], a[100:103], v[124:127], v[228:231]
s_waitcnt lgkmcnt(5)
buffer_load_dwordx4 v113, s[36:39], s81 offen offset:1024 lds
v_mfma_f32_16x16x32_bf16 v[236:239], a[104:107], v[120:123], v[236:239]
s_waitcnt lgkmcnt(4)
buffer_load_dwordx4 v114, s[36:39], s81 offen offset:2048 lds
v_mfma_f32_16x16x32_bf16 v[236:239], a[108:111], v[124:127], v[236:239]
s_waitcnt lgkmcnt(3)
buffer_load_dwordx4 v115, s[36:39], s81 offen offset:3072 lds
v_mfma_f32_16x16x32_bf16 v[244:247], a[112:115], v[120:123], v[244:247]
s_waitcnt lgkmcnt(2)
s_add_u32 s81, s81, 28672
v_mfma_f32_16x16x32_bf16 v[244:247], a[116:119], v[124:127], v[244:247]
s_waitcnt lgkmcnt(1)
s_add_u32 m0, s18, 36864
v_mfma_f32_16x16x32_bf16 v[252:255], a[120:123], v[120:123], v[252:255]
s_waitcnt lgkmcnt(0)
buffer_load_dwordx4 v112, s[36:39], s81 offen offset:0 lds
v_mfma_f32_16x16x32_bf16 v[252:255], a[124:127], v[124:127], v[252:255]
buffer_load_dwordx4 v113, s[36:39], s81 offen offset:1024 lds
buffer_load_dwordx4 v114, s[36:39], s81 offen offset:2048 lds
buffer_load_dwordx4 v115, s[36:39], s81 offen offset:3072 lds
s_sub_u32 s81, s81, 28544
s_waitcnt vmcnt(8)
v_sub_f32 v8, v16, v28
v_sub_f32 v10, v20, v30
v_max_f32 v9, v8, v10
v_cmp_lt_f32 vcc, 1114636288, v9
s_cbranch_vccnz K2_cfix
K2_cok:
v_exp_f32 v8, v8
v_exp_f32 v10, v10
s_nop 0
v_mov_b32 v9, v8
v_mov_b32 v11, v10
v_fmac_f32 v24, v8, v29
v_fmac_f32 v25, v10, v31
s_mov_b32 s23, 0xffff0000
v_lshlrev_b32 v64, 16, v32
v_and_b32 v65, s23, v32
v_lshlrev_b32 v66, 16, v33
v_and_b32 v67, s23, v33
v_lshlrev_b32 v68, 16, v34
v_and_b32 v69, s23, v34
v_lshlrev_b32 v70, 16, v35
v_and_b32 v71, s23, v35
v_pk_fma_f32 v[128:129], v[64:65], v[8:9], v[128:129]
v_pk_fma_f32 v[130:131], v[66:67], v[8:9], v[130:131]
v_pk_fma_f32 v[136:137], v[68:69], v[8:9], v[136:137]
v_pk_fma_f32 v[138:139], v[70:71], v[8:9], v[138:139]
v_cvt_pk_bf16_f32 v128, v128, v129
v_cvt_pk_bf16_f32 v129, v130, v131
v_cvt_pk_bf16_f32 v130, v136, v137
v_cvt_pk_bf16_f32 v131, v138, v139
s_add_u32 m0, s18, 98304
s_nop 0
buffer_load_dwordx4 v112, s[36:39], s81 offen offset:0 lds
v_lshlrev_b32 v64, 16, v36
v_and_b32 v65, s23, v36
v_lshlrev_b32 v66, 16, v37
v_and_b32 v67, s23, v37
v_lshlrev_b32 v68, 16, v38
v_and_b32 v69, s23, v38
v_lshlrev_b32 v70, 16, v39
v_and_b32 v71, s23, v39
v_pk_fma_f32 v[144:145], v[64:65], v[8:9], v[144:145]
v_pk_fma_f32 v[146:147], v[66:67], v[8:9], v[146:147]
v_pk_fma_f32 v[152:153], v[68:69], v[8:9], v[152:153]
v_pk_fma_f32 v[154:155], v[70:71], v[8:9], v[154:155]
v_cvt_pk_bf16_f32 v144, v144, v145
v_cvt_pk_bf16_f32 v145, v146, v147
v_cvt_pk_bf16_f32 v146, v152, v153
v_cvt_pk_bf16_f32 v147, v154, v155
buffer_load_dwordx4 v113, s[36:39], s81 offen offset:1024 lds
v_lshlrev_b32 v64, 16, v40
v_and_b32 v65, s23, v40
v_lshlrev_b32 v66, 16, v41
v_and_b32 v67, s23, v41
v_lshlrev_b32 v68, 16, v42
v_and_b32 v69, s23, v42
v_lshlrev_b32 v70, 16, v43
v_and_b32 v71, s23, v43
v_pk_fma_f32 v[160:161], v[64:65], v[8:9], v[160:161]
v_pk_fma_f32 v[162:163], v[66:67], v[8:9], v[162:163]
v_pk_fma_f32 v[168:169], v[68:69], v[8:9], v[168:169]
v_pk_fma_f32 v[170:171], v[70:71], v[8:9], v[170:171]
v_cvt_pk_bf16_f32 v160, v160, v161
v_cvt_pk_bf16_f32 v161, v162, v163
v_cvt_pk_bf16_f32 v162, v168, v169
v_cvt_pk_bf16_f32 v163, v170, v171
buffer_load_dwordx4 v114, s[36:39], s81 offen offset:2048 lds
v_lshlrev_b32 v64, 16, v44
v_and_b32 v65, s23, v44
v_lshlrev_b32 v66, 16, v45
v_and_b32 v67, s23, v45
v_lshlrev_b32 v68, 16, v46
v_and_b32 v69, s23, v46
v_lshlrev_b32 v70, 16, v47
v_and_b32 v71, s23, v47
v_pk_fma_f32 v[176:177], v[64:65], v[8:9], v[176:177]
v_pk_fma_f32 v[178:179], v[66:67], v[8:9], v[178:179]
v_pk_fma_f32 v[184:185], v[68:69], v[8:9], v[184:185]
v_pk_fma_f32 v[186:187], v[70:71], v[8:9], v[186:187]
v_cvt_pk_bf16_f32 v176, v176, v177
v_cvt_pk_bf16_f32 v177, v178, v179
v_cvt_pk_bf16_f32 v178, v184, v185
v_cvt_pk_bf16_f32 v179, v186, v187
buffer_load_dwordx4 v115, s[36:39], s81 offen offset:3072 lds
v_lshlrev_b32 v64, 16, v48
v_and_b32 v65, s23, v48
v_lshlrev_b32 v66, 16, v49
v_and_b32 v67, s23, v49
v_lshlrev_b32 v68, 16, v50
v_and_b32 v69, s23, v50
v_lshlrev_b32 v70, 16, v51
v_and_b32 v71, s23, v51
v_pk_fma_f32 v[192:193], v[64:65], v[8:9], v[192:193]
v_pk_fma_f32 v[194:195], v[66:67], v[8:9], v[194:195]
v_pk_fma_f32 v[200:201], v[68:69], v[8:9], v[200:201]
v_pk_fma_f32 v[202:203], v[70:71], v[8:9], v[202:203]
v_cvt_pk_bf16_f32 v192, v192, v193
v_cvt_pk_bf16_f32 v193, v194, v195
v_cvt_pk_bf16_f32 v194, v200, v201
v_cvt_pk_bf16_f32 v195, v202, v203
s_add_u32 s81, s81, 28672
s_add_u32 m0, s18, 102400
s_nop 0
buffer_load_dwordx4 v112, s[36:39], s81 offen offset:0 lds
v_lshlrev_b32 v64, 16, v52
v_and_b32 v65, s23, v52
v_lshlrev_b32 v66, 16, v53
v_and_b32 v67, s23, v53
v_lshlrev_b32 v68, 16, v54
v_and_b32 v69, s23, v54
v_lshlrev_b32 v70, 16, v55
v_and_b32 v71, s23, v55
v_pk_fma_f32 v[208:209], v[64:65], v[8:9], v[208:209]
v_pk_fma_f32 v[210:211], v[66:67], v[8:9], v[210:211]
v_pk_fma_f32 v[216:217], v[68:69], v[8:9], v[216:217]
v_pk_fma_f32 v[218:219], v[70:71], v[8:9], v[218:219]
v_cvt_pk_bf16_f32 v208, v208, v209
v_cvt_pk_bf16_f32 v209, v210, v211
v_cvt_pk_bf16_f32 v210, v216, v217
v_cvt_pk_bf16_f32 v211, v218, v219
buffer_load_dwordx4 v113, s[36:39], s81 offen offset:1024 lds
v_lshlrev_b32 v64, 16, v56
v_and_b32 v65, s23, v56
v_lshlrev_b32 v66, 16, v57
v_and_b32 v67, s23, v57
v_lshlrev_b32 v68, 16, v58
v_and_b32 v69, s23, v58
v_lshlrev_b32 v70, 16, v59
v_and_b32 v71, s23, v59
v_pk_fma_f32 v[224:225], v[64:65], v[8:9], v[224:225]
v_pk_fma_f32 v[226:227], v[66:67], v[8:9], v[226:227]
v_pk_fma_f32 v[232:233], v[68:69], v[8:9], v[232:233]
v_pk_fma_f32 v[234:235], v[70:71], v[8:9], v[234:235]
v_cvt_pk_bf16_f32 v224, v224, v225
v_cvt_pk_bf16_f32 v225, v226, v227
v_cvt_pk_bf16_f32 v226, v232, v233
v_cvt_pk_bf16_f32 v227, v234, v235
buffer_load_dwordx4 v114, s[36:39], s81 offen offset:2048 lds
v_lshlrev_b32 v64, 16, v60
v_and_b32 v65, s23, v60
v_lshlrev_b32 v66, 16, v61
v_and_b32 v67, s23, v61
v_lshlrev_b32 v68, 16, v62
v_and_b32 v69, s23, v62
v_lshlrev_b32 v70, 16, v63
v_and_b32 v71, s23, v63
v_pk_fma_f32 v[240:241], v[64:65], v[8:9], v[240:241]
v_pk_fma_f32 v[242:243], v[66:67], v[8:9], v[242:243]
v_pk_fma_f32 v[248:249], v[68:69], v[8:9], v[248:249]
v_pk_fma_f32 v[250:251], v[70:71], v[8:9], v[250:251]
v_cvt_pk_bf16_f32 v240, v240, v241
v_cvt_pk_bf16_f32 v241, v242, v243
v_cvt_pk_bf16_f32 v242, v248, v249
v_cvt_pk_bf16_f32 v243, v250, v251
buffer_load_dwordx4 v115, s[36:39], s81 offen offset:3072 lds
v_accvgpr_read_b32 v32, a32
v_accvgpr_read_b32 v33, a33
v_accvgpr_read_b32 v34, a34
v_accvgpr_read_b32 v35, a35
v_lshlrev_b32 v64, 16, v32
v_and_b32 v65, s23, v32
v_lshlrev_b32 v66, 16, v33
v_and_b32 v67, s23, v33
v_lshlrev_b32 v68, 16, v34
v_and_b32 v69, s23, v34
v_lshlrev_b32 v70, 16, v35
v_and_b32 v71, s23, v35
v_pk_fma_f32 v[132:133], v[64:65], v[10:11], v[132:133]
v_pk_fma_f32 v[134:135], v[66:67], v[10:11], v[134:135]
v_pk_fma_f32 v[140:141], v[68:69], v[10:11], v[140:141]
v_pk_fma_f32 v[142:143], v[70:71], v[10:11], v[142:143]
v_cvt_pk_bf16_f32 v132, v132, v133
v_cvt_pk_bf16_f32 v133, v134, v135
v_cvt_pk_bf16_f32 v134, v140, v141
v_cvt_pk_bf16_f32 v135, v142, v143
s_sub_u32 s81, s81, 28544
s_add_u32 m0, s18, 131072
s_nop 0
buffer_load_dwordx4 v112, s[36:39], s81 offen offset:0 lds
v_accvgpr_read_b32 v36, a36
v_accvgpr_read_b32 v37, a37
v_accvgpr_read_b32 v38, a38
v_accvgpr_read_b32 v39, a39
v_lshlrev_b32 v64, 16, v36
v_and_b32 v65, s23, v36
v_lshlrev_b32 v66, 16, v37
v_and_b32 v67, s23, v37
v_lshlrev_b32 v68, 16, v38
v_and_b32 v69, s23, v38
v_lshlrev_b32 v70, 16, v39
v_and_b32 v71, s23, v39
v_pk_fma_f32 v[148:149], v[64:65], v[10:11], v[148:149]
v_pk_fma_f32 v[150:151], v[66:67], v[10:11], v[150:151]
v_pk_fma_f32 v[156:157], v[68:69], v[10:11], v[156:157]
v_pk_fma_f32 v[158:159], v[70:71], v[10:11], v[158:159]
v_cvt_pk_bf16_f32 v148, v148, v149
v_cvt_pk_bf16_f32 v149, v150, v151
v_cvt_pk_bf16_f32 v150, v156, v157
v_cvt_pk_bf16_f32 v151, v158, v159
buffer_load_dwordx4 v113, s[36:39], s81 offen offset:1024 lds
v_accvgpr_read_b32 v40, a40
v_accvgpr_read_b32 v41, a41
v_accvgpr_read_b32 v42, a42
v_accvgpr_read_b32 v43, a43
v_lshlrev_b32 v64, 16, v40
v_and_b32 v65, s23, v40
v_lshlrev_b32 v66, 16, v41
v_and_b32 v67, s23, v41
v_lshlrev_b32 v68, 16, v42
v_and_b32 v69, s23, v42
v_lshlrev_b32 v70, 16, v43
v_and_b32 v71, s23, v43
v_pk_fma_f32 v[164:165], v[64:65], v[10:11], v[164:165]
v_pk_fma_f32 v[166:167], v[66:67], v[10:11], v[166:167]
v_pk_fma_f32 v[172:173], v[68:69], v[10:11], v[172:173]
v_pk_fma_f32 v[174:175], v[70:71], v[10:11], v[174:175]
v_cvt_pk_bf16_f32 v164, v164, v165
v_cvt_pk_bf16_f32 v165, v166, v167
v_cvt_pk_bf16_f32 v166, v172, v173
v_cvt_pk_bf16_f32 v167, v174, v175
buffer_load_dwordx4 v114, s[36:39], s81 offen offset:2048 lds
v_accvgpr_read_b32 v44, a44
v_accvgpr_read_b32 v45, a45
v_accvgpr_read_b32 v46, a46
v_accvgpr_read_b32 v47, a47
v_lshlrev_b32 v64, 16, v44
v_and_b32 v65, s23, v44
v_lshlrev_b32 v66, 16, v45
v_and_b32 v67, s23, v45
v_lshlrev_b32 v68, 16, v46
v_and_b32 v69, s23, v46
v_lshlrev_b32 v70, 16, v47
v_and_b32 v71, s23, v47
v_pk_fma_f32 v[180:181], v[64:65], v[10:11], v[180:181]
v_pk_fma_f32 v[182:183], v[66:67], v[10:11], v[182:183]
v_pk_fma_f32 v[188:189], v[68:69], v[10:11], v[188:189]
v_pk_fma_f32 v[190:191], v[70:71], v[10:11], v[190:191]
v_cvt_pk_bf16_f32 v180, v180, v181
v_cvt_pk_bf16_f32 v181, v182, v183
v_cvt_pk_bf16_f32 v182, v188, v189
v_cvt_pk_bf16_f32 v183, v190, v191
buffer_load_dwordx4 v115, s[36:39], s81 offen offset:3072 lds
v_accvgpr_read_b32 v48, a48
v_accvgpr_read_b32 v49, a49
v_accvgpr_read_b32 v50, a50
v_accvgpr_read_b32 v51, a51
v_lshlrev_b32 v64, 16, v48
v_and_b32 v65, s23, v48
v_lshlrev_b32 v66, 16, v49
v_and_b32 v67, s23, v49
v_lshlrev_b32 v68, 16, v50
v_and_b32 v69, s23, v50
v_lshlrev_b32 v70, 16, v51
v_and_b32 v71, s23, v51
v_pk_fma_f32 v[196:197], v[64:65], v[10:11], v[196:197]
v_pk_fma_f32 v[198:199], v[66:67], v[10:11], v[198:199]
v_pk_fma_f32 v[204:205], v[68:69], v[10:11], v[204:205]
v_pk_fma_f32 v[206:207], v[70:71], v[10:11], v[206:207]
v_cvt_pk_bf16_f32 v196, v196, v197
v_cvt_pk_bf16_f32 v197, v198, v199
v_cvt_pk_bf16_f32 v198, v204, v205
v_cvt_pk_bf16_f32 v199, v206, v207
s_add_u32 s81, s81, 28672
s_add_u32 m0, s18, 135168
s_nop 0
buffer_load_dwordx4 v112, s[36:39], s81 offen offset:0 lds
v_accvgpr_read_b32 v52, a52
v_accvgpr_read_b32 v53, a53
v_accvgpr_read_b32 v54, a54
v_accvgpr_read_b32 v55, a55
v_lshlrev_b32 v64, 16, v52
v_and_b32 v65, s23, v52
v_lshlrev_b32 v66, 16, v53
v_and_b32 v67, s23, v53
v_lshlrev_b32 v68, 16, v54
v_and_b32 v69, s23, v54
v_lshlrev_b32 v70, 16, v55
v_and_b32 v71, s23, v55
v_pk_fma_f32 v[212:213], v[64:65], v[10:11], v[212:213]
v_pk_fma_f32 v[214:215], v[66:67], v[10:11], v[214:215]
v_pk_fma_f32 v[220:221], v[68:69], v[10:11], v[220:221]
v_pk_fma_f32 v[222:223], v[70:71], v[10:11], v[222:223]
v_cvt_pk_bf16_f32 v212, v212, v213
v_cvt_pk_bf16_f32 v213, v214, v215
v_cvt_pk_bf16_f32 v214, v220, v221
v_cvt_pk_bf16_f32 v215, v222, v223
buffer_load_dwordx4 v113, s[36:39], s81 offen offset:1024 lds
v_accvgpr_read_b32 v56, a56
v_accvgpr_read_b32 v57, a57
v_accvgpr_read_b32 v58, a58
v_accvgpr_read_b32 v59, a59
v_lshlrev_b32 v64, 16, v56
v_and_b32 v65, s23, v56
v_lshlrev_b32 v66, 16, v57
v_and_b32 v67, s23, v57
v_lshlrev_b32 v68, 16, v58
v_and_b32 v69, s23, v58
v_lshlrev_b32 v70, 16, v59
v_and_b32 v71, s23, v59
v_pk_fma_f32 v[228:229], v[64:65], v[10:11], v[228:229]
v_pk_fma_f32 v[230:231], v[66:67], v[10:11], v[230:231]
v_pk_fma_f32 v[236:237], v[68:69], v[10:11], v[236:237]
v_pk_fma_f32 v[238:239], v[70:71], v[10:11], v[238:239]
v_cvt_pk_bf16_f32 v228, v228, v229
v_cvt_pk_bf16_f32 v229, v230, v231
v_cvt_pk_bf16_f32 v230, v236, v237
v_cvt_pk_bf16_f32 v231, v238, v239
buffer_load_dwordx4 v114, s[36:39], s81 offen offset:2048 lds
v_accvgpr_read_b32 v60, a60
v_accvgpr_read_b32 v61, a61
v_accvgpr_read_b32 v62, a62
v_accvgpr_read_b32 v63, a63
v_lshlrev_b32 v64, 16, v60
v_and_b32 v65, s23, v60
v_lshlrev_b32 v66, 16, v61
v_and_b32 v67, s23, v61
v_lshlrev_b32 v68, 16, v62
v_and_b32 v69, s23, v62
v_lshlrev_b32 v70, 16, v63
v_and_b32 v71, s23, v63
v_pk_fma_f32 v[244:245], v[64:65], v[10:11], v[244:245]
v_pk_fma_f32 v[246:247], v[66:67], v[10:11], v[246:247]
v_pk_fma_f32 v[252:253], v[68:69], v[10:11], v[252:253]
v_pk_fma_f32 v[254:255], v[70:71], v[10:11], v[254:255]
v_cvt_pk_bf16_f32 v244, v244, v245
v_cvt_pk_bf16_f32 v245, v246, v247
v_cvt_pk_bf16_f32 v246, v252, v253
v_cvt_pk_bf16_f32 v247, v254, v255
buffer_load_dwordx4 v115, s[36:39], s81 offen offset:3072 lds
s_sub_u32 s81, s81, 28544
K2_done:
PAD_13:
s_cbranch_execz PAD_17
s_waitcnt vmcnt(16)
s_barrier
ds_read_b64_tr_b16 a[64:65], v116 offset:0
ds_read_b64_tr_b16 a[66:67], v116 offset:2048
ds_read_b64_tr_b16 a[68:69], v116 offset:4096
ds_read_b64_tr_b16 a[70:71], v116 offset:6144
ds_read_b64_tr_b16 a[72:73], v116 offset:8192
ds_read_b64_tr_b16 a[74:75], v116 offset:10240
ds_read_b64_tr_b16 a[76:77], v116 offset:12288
ds_read_b64_tr_b16 a[78:79], v116 offset:14336
ds_read_b64_tr_b16 a[80:81], v116 offset:16384
ds_read_b64_tr_b16 a[82:83], v116 offset:18432
ds_read_b64_tr_b16 a[84:85], v116 offset:20480
ds_read_b64_tr_b16 a[86:87], v116 offset:22528
ds_read_b64_tr_b16 a[88:89], v116 offset:24576
ds_read_b64_tr_b16 a[90:91], v116 offset:26624
ds_read_b64_tr_b16 a[92:93], v116 offset:28672
ds_read_b64_tr_b16 a[94:95], v116 offset:30720
v_add_u32 v116, 65536, v116
s_waitcnt lgkmcnt(14)
v_mfma_f32_16x16x32_bf16 v[32:35], a[64:67], v[128:131], 0
s_waitcnt lgkmcnt(12)
s_add_u32 m0, s18, 65536
ds_read_b64_tr_b16 a[96:97], v117 offset:0
v_mov_b32 v28, v24
v_mfma_f32_16x16x32_bf16 v[32:35], a[68:71], v[144:147], v[32:35]
s_waitcnt lgkmcnt(11)
buffer_load_dwordx4 v112, s[36:39], s81 offen offset:0 lds
ds_read_b64_tr_b16 a[98:99], v117 offset:2048
v_mfma_f32_16x16x32_bf16 v[32:35], a[72:75], v[160:163], v[32:35]
s_waitcnt lgkmcnt(10)
ds_read_b64_tr_b16 a[100:101], v117 offset:4096
v_permlane16_swap_b32 v24, v28
v_mfma_f32_16x16x32_bf16 v[32:35], a[76:79], v[176:179], v[32:35]
s_waitcnt lgkmcnt(9)
ds_read_b64_tr_b16 a[102:103], v117 offset:6144
v_add_f32 v24, v24, v28
v_mfma_f32_16x16x32_bf16 v[32:35], a[80:83], v[192:195], v[32:35]
s_waitcnt lgkmcnt(8)
buffer_load_dwordx4 v113, s[36:39], s81 offen offset:1024 lds
ds_read_b64_tr_b16 a[104:105], v117 offset:8192
v_mfma_f32_16x16x32_bf16 v[32:35], a[84:87], v[208:211], v[32:35]
s_waitcnt lgkmcnt(7)
ds_read_b64_tr_b16 a[106:107], v117 offset:10240
v_mov_b32 v28, v24
v_mfma_f32_16x16x32_bf16 v[32:35], a[88:91], v[224:227], v[32:35]
s_waitcnt lgkmcnt(6)
ds_read_b64_tr_b16 a[108:109], v117 offset:12288
v_lshrrev_b32 v20, 4, v1
v_mfma_f32_16x16x32_bf16 v[32:35], a[92:95], v[240:243], v[32:35]
buffer_load_dwordx4 v114, s[36:39], s81 offen offset:2048 lds
ds_read_b64_tr_b16 a[110:111], v117 offset:14336
v_mfma_f32_16x16x32_bf16 v[36:39], a[64:67], v[132:135], 0
ds_read_b64_tr_b16 a[112:113], v117 offset:16384
v_permlane32_swap_b32 v24, v28
v_mfma_f32_16x16x32_bf16 v[36:39], a[68:71], v[148:151], v[36:39]
ds_read_b64_tr_b16 a[114:115], v117 offset:18432
v_add_f32 v24, v24, v28
v_mfma_f32_16x16x32_bf16 v[36:39], a[72:75], v[164:167], v[36:39]
buffer_load_dwordx4 v115, s[36:39], s81 offen offset:3072 lds
ds_read_b64_tr_b16 a[116:117], v117 offset:20480
v_mfma_f32_16x16x32_bf16 v[36:39], a[76:79], v[180:183], v[36:39]
ds_read_b64_tr_b16 a[118:119], v117 offset:22528
v_mov_b32 v29, v25
v_mfma_f32_16x16x32_bf16 v[36:39], a[80:83], v[196:199], v[36:39]
PAD_14:
s_cbranch_execz PAD_18
s_add_u32 s81, s81, 28672
s_add_u32 m0, s18, 69632
ds_read_b64_tr_b16 a[120:121], v117 offset:24576
v_mfma_f32_16x16x32_bf16 v[36:39], a[84:87], v[212:215], v[36:39]
buffer_load_dwordx4 v112, s[36:39], s81 offen offset:0 lds
ds_read_b64_tr_b16 a[122:123], v117 offset:26624
v_mfma_f32_16x16x32_bf16 v[36:39], a[88:91], v[228:231], v[36:39]
ds_read_b64_tr_b16 a[124:125], v117 offset:28672
v_permlane16_swap_b32 v25, v29
v_mfma_f32_16x16x32_bf16 v[36:39], a[92:95], v[244:247], v[36:39]
s_waitcnt lgkmcnt(8)
ds_read_b64_tr_b16 a[126:127], v117 offset:30720
v_add_u32 v117, 65536, v117
v_mfma_f32_16x16x32_bf16 v[40:43], a[96:99], v[128:131], 0
buffer_load_dwordx4 v113, s[36:39], s81 offen offset:1024 lds
ds_read_b64_tr_b16 a[64:65], v118 offset:0
v_mfma_f32_16x16x32_bf16 v[40:43], a[100:103], v[144:147], v[40:43]
ds_read_b64_tr_b16 a[66:67], v118 offset:2048
v_add_f32 v25, v25, v29
v_mfma_f32_16x16x32_bf16 v[40:43], a[104:107], v[160:163], v[40:43]
s_waitcnt lgkmcnt(8)
ds_read_b64_tr_b16 a[68:69], v118 offset:4096
v_mov_b32 v29, v25
v_mfma_f32_16x16x32_bf16 v[40:43], a[108:111], v[176:179], v[40:43]
buffer_load_dwordx4 v114, s[36:39], s81 offen offset:2048 lds
ds_read_b64_tr_b16 a[70:71], v118 offset:6144
v_mfma_f32_16x16x32_bf16 v[40:43], a[112:115], v[192:195], v[40:43]
s_waitcnt lgkmcnt(8)
ds_read_b64_tr_b16 a[72:73], v118 offset:8192
v_permlane32_swap_b32 v25, v29
v_mfma_f32_16x16x32_bf16 v[40:43], a[116:119], v[208:211], v[40:43]
s_waitcnt lgkmcnt(7)
ds_read_b64_tr_b16 a[74:75], v118 offset:10240
v_add_f32 v25, v25, v29
v_mfma_f32_16x16x32_bf16 v[40:43], a[120:123], v[224:227], v[40:43]
s_waitcnt lgkmcnt(6)
buffer_load_dwordx4 v115, s[36:39], s81 offen offset:3072 lds
ds_read_b64_tr_b16 a[76:77], v118 offset:12288
v_mfma_f32_16x16x32_bf16 v[40:43], a[124:127], v[240:243], v[40:43]
ds_read_b64_tr_b16 a[78:79], v118 offset:14336
v_rcp_f32 v24, v24
v_mfma_f32_16x16x32_bf16 v[44:47], a[96:99], v[132:135], 0
s_sub_u32 s81, s81, 28544
s_add_u32 m0, s18, 0
ds_read_b64_tr_b16 a[80:81], v118 offset:16384
v_mfma_f32_16x16x32_bf16 v[44:47], a[100:103], v[148:151], v[44:47]
buffer_load_dwordx4 v112, s[36:39], s81 offen offset:0 lds
ds_read_b64_tr_b16 a[82:83], v118 offset:18432
v_mfma_f32_16x16x32_bf16 v[44:47], a[104:107], v[164:167], v[44:47]
ds_read_b64_tr_b16 a[84:85], v118 offset:20480
v_rcp_f32 v25, v25
v_mfma_f32_16x16x32_bf16 v[44:47], a[108:111], v[180:183], v[44:47]
ds_read_b64_tr_b16 a[86:87], v118 offset:22528
v_and_b32 v19, 15, v20
v_mfma_f32_16x16x32_bf16 v[44:47], a[112:115], v[196:199], v[44:47]
buffer_load_dwordx4 v113, s[36:39], s81 offen offset:1024 lds
ds_read_b64_tr_b16 a[88:89], v118 offset:24576
v_mfma_f32_16x16x32_bf16 v[44:47], a[116:119], v[212:215], v[44:47]
ds_read_b64_tr_b16 a[90:91], v118 offset:26624
v_mul_f32 v32, v32, v24
v_mfma_f32_16x16x32_bf16 v[44:47], a[120:123], v[228:231], v[44:47]
ds_read_b64_tr_b16 a[92:93], v118 offset:28672
v_mul_f32 v33, v33, v24
v_mfma_f32_16x16x32_bf16 v[44:47], a[124:127], v[244:247], v[44:47]
s_waitcnt lgkmcnt(8)
ds_read_b64_tr_b16 a[94:95], v118 offset:30720
v_add_u32 v118, 65536, v118
v_mfma_f32_16x16x32_bf16 v[48:51], a[64:67], v[128:131], 0
buffer_load_dwordx4 v114, s[36:39], s81 offen offset:2048 lds
ds_read_b64_tr_b16 a[96:97], v119 offset:0
v_mfma_f32_16x16x32_bf16 v[48:51], a[68:71], v[144:147], v[48:51]
ds_read_b64_tr_b16 a[98:99], v119 offset:2048
v_mul_f32 v34, v34, v24
v_mfma_f32_16x16x32_bf16 v[48:51], a[72:75], v[160:163], v[48:51]
s_waitcnt lgkmcnt(8)
ds_read_b64_tr_b16 a[100:101], v119 offset:4096
v_mul_f32 v35, v35, v24
v_mfma_f32_16x16x32_bf16 v[48:51], a[76:79], v[176:179], v[48:51]
buffer_load_dwordx4 v115, s[36:39], s81 offen offset:3072 lds
ds_read_b64_tr_b16 a[102:103], v119 offset:6144
v_mfma_f32_16x16x32_bf16 v[48:51], a[80:83], v[192:195], v[48:51]
s_waitcnt lgkmcnt(6)
ds_read_b64_tr_b16 a[104:105], v119 offset:8192
v_mul_f32 v40, v40, v24
v_mfma_f32_16x16x32_bf16 v[48:51], a[84:87], v[208:211], v[48:51]
s_add_u32 s81, s81, 28672
s_add_u32 m0, s18, 4096
ds_read_b64_tr_b16 a[106:107], v119 offset:10240
v_mfma_f32_16x16x32_bf16 v[48:51], a[88:91], v[224:227], v[48:51]
s_waitcnt lgkmcnt(6)
buffer_load_dwordx4 v112, s[36:39], s81 offen offset:0 lds
ds_read_b64_tr_b16 a[108:109], v119 offset:12288
v_mfma_f32_16x16x32_bf16 v[48:51], a[92:95], v[240:243], v[48:51]
ds_read_b64_tr_b16 a[110:111], v119 offset:14336
v_mul_f32 v41, v41, v24
v_mfma_f32_16x16x32_bf16 v[52:55], a[64:67], v[132:135], 0
ds_read_b64_tr_b16 a[112:113], v119 offset:16384
v_mul_f32 v42, v42, v24
v_mfma_f32_16x16x32_bf16 v[52:55], a[68:71], v[148:151], v[52:55]
buffer_load_dwordx4 v113, s[36:39], s81 offen offset:1024 lds
ds_read_b64_tr_b16 a[114:115], v119 offset:18432
v_mfma_f32_16x16x32_bf16 v[52:55], a[72:75], v[164:167], v[52:55]
ds_read_b64_tr_b16 a[116:117], v119 offset:20480
v_mul_f32 v43, v43, v24
v_mfma_f32_16x16x32_bf16 v[52:55], a[76:79], v[180:183], v[52:55]
ds_read_b64_tr_b16 a[118:119], v119 offset:22528
v_cvt_pk_bf16_f32 v32, v32, v33
v_mfma_f32_16x16x32_bf16 v[52:55], a[80:83], v[196:199], v[52:55]
buffer_load_dwordx4 v114, s[36:39], s81 offen offset:2048 lds
ds_read_b64_tr_b16 a[120:121], v119 offset:24576
v_mfma_f32_16x16x32_bf16 v[52:55], a[84:87], v[212:215], v[52:55]
ds_read_b64_tr_b16 a[122:123], v119 offset:26624
v_cvt_pk_bf16_f32 v33, v34, v35
v_mfma_f32_16x16x32_bf16 v[52:55], a[88:91], v[228:231], v[52:55]
ds_read_b64_tr_b16 a[124:125], v119 offset:28672
ds_read_b64_tr_b16 a[126:127], v119 offset:30720
v_mfma_f32_16x16x32_bf16 v[52:55], a[92:95], v[244:247], v[52:55]
s_waitcnt vmcnt(23) lgkmcnt(9)
s_barrier
v_add_u32 v119, 65536, v119
v_mfma_f32_16x16x32_bf16 v[56:59], a[96:99], v[128:131], 0
buffer_load_dwordx4 v115, s[36:39], s81 offen offset:3072 lds
ds_read_b64_tr_b16 a[64:65], v116 offset:0
v_mfma_f32_16x16x32_bf16 v[56:59], a[100:103], v[144:147], v[56:59]
s_waitcnt lgkmcnt(8)
ds_read_b64_tr_b16 a[66:67], v116 offset:2048
v_cvt_pk_bf16_f32 v34, v40, v41
v_mfma_f32_16x16x32_bf16 v[56:59], a[104:107], v[160:163], v[56:59]
s_sub_u32 s81, s81, 28544
ds_read_b64_tr_b16 a[68:69], v116 offset:4096
v_cvt_pk_bf16_f32 v35, v42, v43
v_mfma_f32_16x16x32_bf16 v[56:59], a[108:111], v[176:179], v[56:59]
s_waitcnt lgkmcnt(8)
buffer_store_dwordx4 v[32:35], v1, s[4:7], s8 offen offset:0 sc1
ds_read_b64_tr_b16 a[70:71], v116 offset:6144
v_mfma_f32_16x16x32_bf16 v[56:59], a[112:115], v[192:195], v[56:59]
s_waitcnt lgkmcnt(8)
ds_read_b64_tr_b16 a[72:73], v116 offset:8192
v_mul_f32 v36, v36, v25
v_mfma_f32_16x16x32_bf16 v[56:59], a[116:119], v[208:211], v[56:59]
s_waitcnt lgkmcnt(7)
ds_read_b64_tr_b16 a[74:75], v116 offset:10240
v_mul_f32 v37, v37, v25
v_mfma_f32_16x16x32_bf16 v[56:59], a[120:123], v[224:227], v[56:59]
s_waitcnt lgkmcnt(6)
ds_read_b64_tr_b16 a[76:77], v116 offset:12288
v_mul_f32 v38, v38, v25
v_mfma_f32_16x16x32_bf16 v[56:59], a[124:127], v[240:243], v[56:59]
ds_read_b64_tr_b16 a[78:79], v116 offset:14336
v_mul_f32 v39, v39, v25
v_mfma_f32_16x16x32_bf16 v[60:63], a[96:99], v[132:135], 0
ds_read_b64_tr_b16 a[80:81], v116 offset:16384
v_mul_f32 v44, v44, v25
v_mfma_f32_16x16x32_bf16 v[60:63], a[100:103], v[148:151], v[60:63]
ds_read_b64_tr_b16 a[82:83], v116 offset:18432
v_mul_f32 v45, v45, v25
v_mfma_f32_16x16x32_bf16 v[60:63], a[104:107], v[164:167], v[60:63]
ds_read_b64_tr_b16 a[84:85], v116 offset:20480
v_mul_f32 v46, v46, v25
v_mfma_f32_16x16x32_bf16 v[60:63], a[108:111], v[180:183], v[60:63]
ds_read_b64_tr_b16 a[86:87], v116 offset:22528
v_mul_f32 v47, v47, v25
v_mfma_f32_16x16x32_bf16 v[60:63], a[112:115], v[196:199], v[60:63]
ds_read_b64_tr_b16 a[88:89], v116 offset:24576
v_cvt_pk_bf16_f32 v36, v36, v37
v_mfma_f32_16x16x32_bf16 v[60:63], a[116:119], v[212:215], v[60:63]
ds_read_b64_tr_b16 a[90:91], v116 offset:26624
v_cvt_pk_bf16_f32 v37, v38, v39
v_mfma_f32_16x16x32_bf16 v[60:63], a[120:123], v[228:231], v[60:63]
ds_read_b64_tr_b16 a[92:93], v116 offset:28672
v_cvt_pk_bf16_f32 v38, v44, v45
v_mfma_f32_16x16x32_bf16 v[60:63], a[124:127], v[244:247], v[60:63]
s_waitcnt lgkmcnt(3)
ds_read_b64_tr_b16 a[94:95], v116 offset:30720
v_add_u32 v116, 32768, v116
v_mfma_f32_16x16x32_bf16 v[64:67], a[64:67], v[128:131], 0
s_lshl_b32 s34, s29, 5
ds_read_b64_tr_b16 a[96:97], v117 offset:0
v_cvt_pk_bf16_f32 v39, v46, v47
v_mfma_f32_16x16x32_bf16 v[64:67], a[68:71], v[144:147], v[64:67]
s_add_u32 s34, s34, s20
buffer_store_dwordx4 v[36:39], v1, s[4:7], s12 offen offset:0 sc1
ds_read_b64_tr_b16 a[98:99], v117 offset:2048
v_mfma_f32_16x16x32_bf16 v[64:67], a[72:75], v[160:163], v[64:67]
s_lshl_b32 s34, s34, 2
ds_read_b64_tr_b16 a[100:101], v117 offset:4096
v_mul_f32 v48, v48, v24
v_mfma_f32_16x16x32_bf16 v[64:67], a[76:79], v[176:179], v[64:67]
s_add_u32 s34, s34, 94380032
ds_read_b64_tr_b16 a[102:103], v117 offset:6144
v_mul_f32 v49, v49, v24
v_mfma_f32_16x16x32_bf16 v[64:67], a[80:83], v[192:195], v[64:67]
s_add_u32 s35, s34, 2048
ds_read_b64_tr_b16 a[104:105], v117 offset:8192
v_mul_f32 v50, v50, v24
v_mfma_f32_16x16x32_bf16 v[64:67], a[84:87], v[208:211], v[64:67]
s_waitcnt lgkmcnt(5)
s_add_u32 s44, s34, 6144
ds_read_b64_tr_b16 a[106:107], v117 offset:10240
v_mul_f32 v51, v51, v24
v_mfma_f32_16x16x32_bf16 v[64:67], a[88:91], v[224:227], v[64:67]
s_min_u32 s80, s21, 6
ds_read_b64_tr_b16 a[108:109], v117 offset:12288
v_mul_f32 v56, v56, v24
v_mfma_f32_16x16x32_bf16 v[64:67], a[92:95], v[240:243], v[64:67]
s_add_u32 s79, s2, 0
ds_read_b64_tr_b16 a[110:111], v117 offset:14336
v_mul_f32 v57, v57, v24
v_mfma_f32_16x16x32_bf16 v[68:71], a[64:67], v[132:135], 0
s_lshr_b32 s79, s79, 4
ds_read_b64_tr_b16 a[112:113], v117 offset:16384
v_mul_f32 v58, v58, v24
v_mfma_f32_16x16x32_bf16 v[68:71], a[68:71], v[148:151], v[68:71]
s_or_b32 s79, s79, s2
ds_read_b64_tr_b16 a[114:115], v117 offset:18432
v_mul_f32 v59, v59, v24
v_mfma_f32_16x16x32_bf16 v[68:71], a[72:75], v[164:167], v[68:71]
s_andn2_b32 s79, 16, s79
ds_read_b64_tr_b16 a[116:117], v117 offset:20480
v_cvt_pk_bf16_f32 v48, v48, v49
v_mfma_f32_16x16x32_bf16 v[68:71], a[76:79], v[180:183], v[68:71]
s_add_u32 s79, s79, s20
ds_read_b64_tr_b16 a[118:119], v117 offset:22528
v_cvt_pk_bf16_f32 v49, v50, v51
v_mfma_f32_16x16x32_bf16 v[68:71], a[80:83], v[196:199], v[68:71]
s_lshl_b32 s22, s79, 2
ds_read_b64_tr_b16 a[120:121], v117 offset:24576
v_cvt_pk_bf16_f32 v50, v56, v57
v_mfma_f32_16x16x32_bf16 v[68:71], a[84:87], v[212:215], v[68:71]
s_add_u32 s22, s22, s3
ds_read_b64_tr_b16 a[122:123], v117 offset:26624
v_cvt_pk_bf16_f32 v51, v58, v59
v_mfma_f32_16x16x32_bf16 v[68:71], a[88:91], v[228:231], v[68:71]
s_mul_i32 s25, s22, 28672
buffer_store_dwordx4 v[48:51], v1, s[4:7], s8 offen offset:1024 sc1
ds_read_b64_tr_b16 a[124:125], v117 offset:28672
v_mfma_f32_16x16x32_bf16 v[68:71], a[92:95], v[244:247], v[68:71]
s_waitcnt lgkmcnt(3)
s_lshl_b32 s23, s80, 6
ds_read_b64_tr_b16 a[126:127], v117 offset:30720
v_add_u32 v117, 32768, v117
v_mfma_f32_16x16x32_bf16 v[72:75], a[96:99], v[128:131], 0
s_add_u32 s25, s25, s23
ds_read_b64_tr_b16 a[64:65], v118 offset:0
v_mul_f32 v52, v52, v25
v_mfma_f32_16x16x32_bf16 v[72:75], a[100:103], v[144:147], v[72:75]
s_mul_i32 s26, s22, 229376
ds_read_b64_tr_b16 a[66:67], v118 offset:2048
v_mul_f32 v53, v53, v25
v_mfma_f32_16x16x32_bf16 v[72:75], a[104:107], v[160:163], v[72:75]
s_lshl_b32 s23, s80, 10
ds_read_b64_tr_b16 a[68:69], v118 offset:4096
v_mul_f32 v54, v54, v25
v_mfma_f32_16x16x32_bf16 v[72:75], a[108:111], v[176:179], v[72:75]
s_add_u32 s26, s26, s23
ds_read_b64_tr_b16 a[70:71], v118 offset:6144
v_mul_f32 v55, v55, v25
v_mfma_f32_16x16x32_bf16 v[72:75], a[112:115], v[192:195], v[72:75]
s_add_u32 s26, s26, 104857600
ds_read_b64_tr_b16 a[72:73], v118 offset:8192
v_mul_f32 v60, v60, v25
v_mfma_f32_16x16x32_bf16 v[72:75], a[116:119], v[208:211], v[72:75]
s_waitcnt lgkmcnt(5)
s_lshr_b32 s22, s79, 1
ds_read_b64_tr_b16 a[74:75], v118 offset:10240
v_mul_f32 v61, v61, v25
v_mfma_f32_16x16x32_bf16 v[72:75], a[120:123], v[224:227], v[72:75]
s_lshl_b32 s22, s22, 7
ds_read_b64_tr_b16 a[76:77], v118 offset:12288
v_mul_f32 v62, v62, v25
v_mfma_f32_16x16x32_bf16 v[72:75], a[124:127], v[240:243], v[72:75]
s_add_u32 s33, s22, 94380032
ds_read_b64_tr_b16 a[78:79], v118 offset:14336
v_mul_f32 v63, v63, v25
v_mfma_f32_16x16x32_bf16 v[76:79], a[96:99], v[132:135], 0
s_mov_b64 s[40:41], s[88:89]
ds_read_b64_tr_b16 a[80:81], v118 offset:16384
v_cvt_pk_bf16_f32 v52, v52, v53
v_mfma_f32_16x16x32_bf16 v[76:79], a[100:103], v[148:151], v[76:79]
s_mov_b32 s42, 3670016
ds_read_b64_tr_b16 a[82:83], v118 offset:18432
v_cvt_pk_bf16_f32 v53, v54, v55
v_mfma_f32_16x16x32_bf16 v[76:79], a[104:107], v[164:167], v[76:79]
s_mov_b32 s43, 0x20000
ds_read_b64_tr_b16 a[84:85], v118 offset:20480
v_cvt_pk_bf16_f32 v54, v60, v61
v_mfma_f32_16x16x32_bf16 v[76:79], a[108:111], v[180:183], v[76:79]
ds_read_b64_tr_b16 a[86:87], v118 offset:22528
v_cvt_pk_bf16_f32 v55, v62, v63
v_mfma_f32_16x16x32_bf16 v[76:79], a[112:115], v[196:199], v[76:79]
buffer_store_dwordx4 v[52:55], v1, s[4:7], s12 offen offset:1024 sc1
ds_read_b64_tr_b16 a[88:89], v118 offset:24576
v_mfma_f32_16x16x32_bf16 v[76:79], a[116:119], v[212:215], v[76:79]
ds_read_b64_tr_b16 a[90:91], v118 offset:26624
v_mfma_f32_16x16x32_bf16 v[76:79], a[120:123], v[228:231], v[76:79]
ds_read_b64_tr_b16 a[92:93], v118 offset:28672
v_mul_f32 v64, v64, v24
v_mfma_f32_16x16x32_bf16 v[76:79], a[124:127], v[244:247], v[76:79]
s_waitcnt lgkmcnt(8)
ds_read_b64_tr_b16 a[94:95], v118 offset:30720
v_add_u32 v118, 32768, v118
v_mfma_f32_16x16x32_bf16 v[80:83], a[64:67], v[128:131], 0
ds_read_b64_tr_b16 a[96:97], v119 offset:0
v_mul_f32 v65, v65, v24
v_mfma_f32_16x16x32_bf16 v[80:83], a[68:71], v[144:147], v[80:83]
ds_read_b64_tr_b16 a[98:99], v119 offset:2048
v_mul_f32 v66, v66, v24
v_mfma_f32_16x16x32_bf16 v[80:83], a[72:75], v[160:163], v[80:83]
s_waitcnt lgkmcnt(8)
ds_read_b64_tr_b16 a[100:101], v119 offset:4096
v_mul_f32 v67, v67, v24
v_mfma_f32_16x16x32_bf16 v[80:83], a[76:79], v[176:179], v[80:83]
ds_read_b64_tr_b16 a[102:103], v119 offset:6144
v_mul_f32 v72, v72, v24
v_mfma_f32_16x16x32_bf16 v[80:83], a[80:83], v[192:195], v[80:83]
s_waitcnt lgkmcnt(8)
ds_read_b64_tr_b16 a[104:105], v119 offset:8192
v_mul_f32 v73, v73, v24
v_mfma_f32_16x16x32_bf16 v[80:83], a[84:87], v[208:211], v[80:83]
s_waitcnt lgkmcnt(7)
ds_read_b64_tr_b16 a[106:107], v119 offset:10240
v_mul_f32 v74, v74, v24
v_mfma_f32_16x16x32_bf16 v[80:83], a[88:91], v[224:227], v[80:83]
s_waitcnt lgkmcnt(6)
ds_read_b64_tr_b16 a[108:109], v119 offset:12288
v_mul_f32 v75, v75, v24
v_mfma_f32_16x16x32_bf16 v[80:83], a[92:95], v[240:243], v[80:83]
ds_read_b64_tr_b16 a[110:111], v119 offset:14336
v_cvt_pk_bf16_f32 v64, v64, v65
v_mfma_f32_16x16x32_bf16 v[84:87], a[64:67], v[132:135], 0
ds_read_b64_tr_b16 a[112:113], v119 offset:16384
v_cvt_pk_bf16_f32 v65, v66, v67
v_mfma_f32_16x16x32_bf16 v[84:87], a[68:71], v[148:151], v[84:87]
ds_read_b64_tr_b16 a[114:115], v119 offset:18432
v_cvt_pk_bf16_f32 v66, v72, v73
v_mfma_f32_16x16x32_bf16 v[84:87], a[72:75], v[164:167], v[84:87]
ds_read_b64_tr_b16 a[116:117], v119 offset:20480
v_cvt_pk_bf16_f32 v67, v74, v75
v_mfma_f32_16x16x32_bf16 v[84:87], a[76:79], v[180:183], v[84:87]
buffer_store_dwordx4 v[64:67], v1, s[4:7], s8 offen offset:2048 sc1
ds_read_b64_tr_b16 a[118:119], v119 offset:22528
v_mfma_f32_16x16x32_bf16 v[84:87], a[80:83], v[196:199], v[84:87]
ds_read_b64_tr_b16 a[120:121], v119 offset:24576
v_mul_f32 v68, v68, v25
v_mfma_f32_16x16x32_bf16 v[84:87], a[84:87], v[212:215], v[84:87]
ds_read_b64_tr_b16 a[122:123], v119 offset:26624
v_mul_f32 v69, v69, v25
v_mfma_f32_16x16x32_bf16 v[84:87], a[88:91], v[228:231], v[84:87]
ds_read_b64_tr_b16 a[124:125], v119 offset:28672
ds_read_b64_tr_b16 a[126:127], v119 offset:30720
v_mfma_f32_16x16x32_bf16 v[84:87], a[92:95], v[244:247], v[84:87]
s_waitcnt vmcnt(21) lgkmcnt(9)
s_barrier
v_add_u32 v119, 32768, v119
v_mfma_f32_16x16x32_bf16 v[88:91], a[96:99], v[128:131], 0
ds_read_b64_tr_b16 a[64:65], v116 offset:0
v_mul_f32 v70, v70, v25
v_mfma_f32_16x16x32_bf16 v[88:91], a[100:103], v[144:147], v[88:91]
ds_read_b64_tr_b16 a[66:67], v116 offset:2048
v_mul_f32 v71, v71, v25
v_mfma_f32_16x16x32_bf16 v[88:91], a[104:107], v[160:163], v[88:91]
s_waitcnt lgkmcnt(8)
ds_read_b64_tr_b16 a[68:69], v116 offset:4096
v_mul_f32 v76, v76, v25
v_mfma_f32_16x16x32_bf16 v[88:91], a[108:111], v[176:179], v[88:91]
ds_read_b64_tr_b16 a[70:71], v116 offset:6144
v_mul_f32 v77, v77, v25
v_mfma_f32_16x16x32_bf16 v[88:91], a[112:115], v[192:195], v[88:91]
s_waitcnt lgkmcnt(8)
ds_read_b64_tr_b16 a[72:73], v116 offset:8192
v_mul_f32 v78, v78, v25
v_mfma_f32_16x16x32_bf16 v[88:91], a[116:119], v[208:211], v[88:91]
s_waitcnt lgkmcnt(7)
ds_read_b64_tr_b16 a[74:75], v116 offset:10240
v_mul_f32 v79, v79, v25
v_mfma_f32_16x16x32_bf16 v[88:91], a[120:123], v[224:227], v[88:91]
s_waitcnt lgkmcnt(6)
ds_read_b64_tr_b16 a[76:77], v116 offset:12288
v_cvt_pk_bf16_f32 v68, v68, v69
v_mfma_f32_16x16x32_bf16 v[88:91], a[124:127], v[240:243], v[88:91]
ds_read_b64_tr_b16 a[78:79], v116 offset:14336
v_cvt_pk_bf16_f32 v69, v70, v71
v_mfma_f32_16x16x32_bf16 v[92:95], a[96:99], v[132:135], 0
ds_read_b64_tr_b16 a[80:81], v116 offset:16384
v_cvt_pk_bf16_f32 v70, v76, v77
v_mfma_f32_16x16x32_bf16 v[92:95], a[100:103], v[148:151], v[92:95]
ds_read_b64_tr_b16 a[82:83], v116 offset:18432
v_cvt_pk_bf16_f32 v71, v78, v79
v_mfma_f32_16x16x32_bf16 v[92:95], a[104:107], v[164:167], v[92:95]
buffer_store_dwordx4 v[68:71], v1, s[4:7], s12 offen offset:2048 sc1
ds_read_b64_tr_b16 a[84:85], v116 offset:20480
v_mfma_f32_16x16x32_bf16 v[92:95], a[108:111], v[180:183], v[92:95]
ds_read_b64_tr_b16 a[86:87], v116 offset:22528
v_mfma_f32_16x16x32_bf16 v[92:95], a[112:115], v[196:199], v[92:95]
ds_read_b64_tr_b16 a[88:89], v116 offset:24576
v_mfma_f32_16x16x32_bf16 v[92:95], a[116:119], v[212:215], v[92:95]
ds_read_b64_tr_b16 a[90:91], v116 offset:26624
v_mfma_f32_16x16x32_bf16 v[92:95], a[120:123], v[228:231], v[92:95]
ds_read_b64_tr_b16 a[92:93], v116 offset:28672
v_mfma_f32_16x16x32_bf16 v[92:95], a[124:127], v[244:247], v[92:95]
s_waitcnt lgkmcnt(8)
ds_read_b64_tr_b16 a[94:95], v116 offset:30720
v_add_u32 v116, 4294901760, v116
v_mfma_f32_16x16x32_bf16 v[32:35], a[64:67], v[128:131], 0
s_add_u32 m0, s18, 32768
ds_read_b64_tr_b16 a[96:97], v117 offset:0
v_mul_f32 v80, v80, v24
v_mfma_f32_16x16x32_bf16 v[32:35], a[68:71], v[144:147], v[32:35]
buffer_load_dwordx4 v112, s[36:39], s81 offen offset:0 lds
ds_read_b64_tr_b16 a[98:99], v117 offset:2048
v_mfma_f32_16x16x32_bf16 v[32:35], a[72:75], v[160:163], v[32:35]
s_waitcnt lgkmcnt(8)
ds_read_b64_tr_b16 a[100:101], v117 offset:4096
v_mul_f32 v81, v81, v24
v_mfma_f32_16x16x32_bf16 v[32:35], a[76:79], v[176:179], v[32:35]
ds_read_b64_tr_b16 a[102:103], v117 offset:6144
v_mul_f32 v82, v82, v24
v_mfma_f32_16x16x32_bf16 v[32:35], a[80:83], v[192:195], v[32:35]
s_waitcnt lgkmcnt(8)
ds_read_b64_tr_b16 a[104:105], v117 offset:8192
v_mul_f32 v83, v83, v24
v_mfma_f32_16x16x32_bf16 v[32:35], a[84:87], v[208:211], v[32:35]
s_waitcnt lgkmcnt(7)
ds_read_b64_tr_b16 a[106:107], v117 offset:10240
v_mul_f32 v88, v88, v24
v_mfma_f32_16x16x32_bf16 v[32:35], a[88:91], v[224:227], v[32:35]
s_waitcnt lgkmcnt(6)
ds_read_b64_tr_b16 a[108:109], v117 offset:12288
v_mul_f32 v89, v89, v24
v_mfma_f32_16x16x32_bf16 v[32:35], a[92:95], v[240:243], v[32:35]
ds_read_b64_tr_b16 a[110:111], v117 offset:14336
v_mul_f32 v90, v90, v24
v_mfma_f32_16x16x32_bf16 v[36:39], a[64:67], v[132:135], 0
buffer_load_dwordx4 v113, s[36:39], s81 offen offset:1024 lds
ds_read_b64_tr_b16 a[112:113], v117 offset:16384
v_mfma_f32_16x16x32_bf16 v[36:39], a[68:71], v[148:151], v[36:39]
ds_read_b64_tr_b16 a[114:115], v117 offset:18432
v_mul_f32 v91, v91, v24
v_mfma_f32_16x16x32_bf16 v[36:39], a[72:75], v[164:167], v[36:39]
ds_read_b64_tr_b16 a[116:117], v117 offset:20480
v_cvt_pk_bf16_f32 v80, v80, v81
v_mfma_f32_16x16x32_bf16 v[36:39], a[76:79], v[180:183], v[36:39]
ds_read_b64_tr_b16 a[118:119], v117 offset:22528
v_cvt_pk_bf16_f32 v81, v82, v83
v_mfma_f32_16x16x32_bf16 v[36:39], a[80:83], v[196:199], v[36:39]
ds_read_b64_tr_b16 a[120:121], v117 offset:24576
v_cvt_pk_bf16_f32 v82, v88, v89
v_mfma_f32_16x16x32_bf16 v[36:39], a[84:87], v[212:215], v[36:39]
ds_read_b64_tr_b16 a[122:123], v117 offset:26624
v_cvt_pk_bf16_f32 v83, v90, v91
v_mfma_f32_16x16x32_bf16 v[36:39], a[88:91], v[228:231], v[36:39]
buffer_store_dwordx4 v[80:83], v1, s[4:7], s8 offen offset:3072 sc1
ds_read_b64_tr_b16 a[124:125], v117 offset:28672
v_mfma_f32_16x16x32_bf16 v[36:39], a[92:95], v[244:247], v[36:39]
s_waitcnt lgkmcnt(8)
ds_read_b64_tr_b16 a[126:127], v117 offset:30720
v_add_u32 v117, 4294901760, v117
v_mfma_f32_16x16x32_bf16 v[40:43], a[96:99], v[128:131], 0
buffer_load_dwordx4 v114, s[36:39], s81 offen offset:2048 lds
ds_read_b64_tr_b16 a[64:65], v118 offset:0
v_mfma_f32_16x16x32_bf16 v[40:43], a[100:103], v[144:147], v[40:43]
ds_read_b64_tr_b16 a[66:67], v118 offset:2048
v_mul_f32 v84, v84, v25
v_mfma_f32_16x16x32_bf16 v[40:43], a[104:107], v[160:163], v[40:43]
s_waitcnt lgkmcnt(8)
ds_read_b64_tr_b16 a[68:69], v118 offset:4096
v_mul_f32 v85, v85, v25
v_mfma_f32_16x16x32_bf16 v[40:43], a[108:111], v[176:179], v[40:43]
ds_read_b64_tr_b16 a[70:71], v118 offset:6144
v_mul_f32 v86, v86, v25
v_mfma_f32_16x16x32_bf16 v[40:43], a[112:115], v[192:195], v[40:43]
s_waitcnt lgkmcnt(8)
ds_read_b64_tr_b16 a[72:73], v118 offset:8192
v_mul_f32 v87, v87, v25
v_mfma_f32_16x16x32_bf16 v[40:43], a[116:119], v[208:211], v[40:43]
s_waitcnt lgkmcnt(7)
ds_read_b64_tr_b16 a[74:75], v118 offset:10240
v_mul_f32 v92, v92, v25
v_mfma_f32_16x16x32_bf16 v[40:43], a[120:123], v[224:227], v[40:43]
s_waitcnt lgkmcnt(6)
ds_read_b64_tr_b16 a[76:77], v118 offset:12288
v_mul_f32 v93, v93, v25
v_mfma_f32_16x16x32_bf16 v[40:43], a[124:127], v[240:243], v[40:43]
buffer_load_dwordx4 v115, s[36:39], s81 offen offset:3072 lds
ds_read_b64_tr_b16 a[78:79], v118 offset:14336
v_mfma_f32_16x16x32_bf16 v[44:47], a[96:99], v[132:135], 0
ds_read_b64_tr_b16 a[80:81], v118 offset:16384
v_mul_f32 v94, v94, v25
v_mfma_f32_16x16x32_bf16 v[44:47], a[100:103], v[148:151], v[44:47]
ds_read_b64_tr_b16 a[82:83], v118 offset:18432
v_mul_f32 v95, v95, v25
v_mfma_f32_16x16x32_bf16 v[44:47], a[104:107], v[164:167], v[44:47]
ds_read_b64_tr_b16 a[84:85], v118 offset:20480
v_cvt_pk_bf16_f32 v84, v84, v85
v_mfma_f32_16x16x32_bf16 v[44:47], a[108:111], v[180:183], v[44:47]
ds_read_b64_tr_b16 a[86:87], v118 offset:22528
v_cvt_pk_bf16_f32 v85, v86, v87
v_mfma_f32_16x16x32_bf16 v[44:47], a[112:115], v[196:199], v[44:47]
ds_read_b64_tr_b16 a[88:89], v118 offset:24576
v_cvt_pk_bf16_f32 v86, v92, v93
v_mfma_f32_16x16x32_bf16 v[44:47], a[116:119], v[212:215], v[44:47]
s_add_u32 s81, s81, 28672
s_add_u32 m0, s18, 36864
ds_read_b64_tr_b16 a[90:91], v118 offset:26624
v_mfma_f32_16x16x32_bf16 v[44:47], a[120:123], v[228:231], v[44:47]
buffer_load_dwordx4 v112, s[36:39], s81 offen offset:0 lds
ds_read_b64_tr_b16 a[92:93], v118 offset:28672
v_mfma_f32_16x16x32_bf16 v[44:47], a[124:127], v[244:247], v[44:47]
s_waitcnt lgkmcnt(8)
ds_read_b64_tr_b16 a[94:95], v118 offset:30720
v_add_u32 v118, 4294901760, v118
v_mfma_f32_16x16x32_bf16 v[48:51], a[64:67], v[128:131], 0
ds_read_b64_tr_b16 a[96:97], v119 offset:0
v_cvt_pk_bf16_f32 v87, v94, v95
v_mfma_f32_16x16x32_bf16 v[48:51], a[68:71], v[144:147], v[48:51]
s_waitcnt lgkmcnt(8)
buffer_store_dwordx4 v[84:87], v1, s[4:7], s12 offen offset:3072 sc1
ds_read_b64_tr_b16 a[98:99], v119 offset:2048
v_mfma_f32_16x16x32_bf16 v[48:51], a[72:75], v[160:163], v[48:51]
s_add_u32 s8, s8, 4096
s_add_u32 s12, s12, 4096
ds_read_b64_tr_b16 a[100:101], v119 offset:4096
v_mfma_f32_16x16x32_bf16 v[48:51], a[76:79], v[176:179], v[48:51]
s_waitcnt lgkmcnt(8)
ds_read_b64_tr_b16 a[102:103], v119 offset:6144
v_mul_f32 v32, v32, v24
v_mfma_f32_16x16x32_bf16 v[48:51], a[80:83], v[192:195], v[48:51]
s_waitcnt lgkmcnt(8)
ds_read_b64_tr_b16 a[104:105], v119 offset:8192
v_mul_f32 v33, v33, v24
v_mfma_f32_16x16x32_bf16 v[48:51], a[84:87], v[208:211], v[48:51]
s_waitcnt lgkmcnt(7)
buffer_load_dwordx4 v113, s[36:39], s81 offen offset:1024 lds
ds_read_b64_tr_b16 a[106:107], v119 offset:10240
v_mfma_f32_16x16x32_bf16 v[48:51], a[88:91], v[224:227], v[48:51]
s_waitcnt lgkmcnt(6)
ds_read_b64_tr_b16 a[108:109], v119 offset:12288
v_mul_f32 v34, v34, v24
v_mfma_f32_16x16x32_bf16 v[48:51], a[92:95], v[240:243], v[48:51]
ds_read_b64_tr_b16 a[110:111], v119 offset:14336
v_mul_f32 v35, v35, v24
v_mfma_f32_16x16x32_bf16 v[52:55], a[64:67], v[132:135], 0
ds_read_b64_tr_b16 a[112:113], v119 offset:16384
v_mul_f32 v40, v40, v24
v_mfma_f32_16x16x32_bf16 v[52:55], a[68:71], v[148:151], v[52:55]
ds_read_b64_tr_b16 a[114:115], v119 offset:18432
v_mul_f32 v41, v41, v24
v_mfma_f32_16x16x32_bf16 v[52:55], a[72:75], v[164:167], v[52:55]
ds_read_b64_tr_b16 a[116:117], v119 offset:20480
v_mul_f32 v42, v42, v24
v_mfma_f32_16x16x32_bf16 v[52:55], a[76:79], v[180:183], v[52:55]
ds_read_b64_tr_b16 a[118:119], v119 offset:22528
v_mul_f32 v43, v43, v24
v_mfma_f32_16x16x32_bf16 v[52:55], a[80:83], v[196:199], v[52:55]
buffer_load_dwordx4 v114, s[36:39], s81 offen offset:2048 lds
ds_read_b64_tr_b16 a[120:121], v119 offset:24576
v_mfma_f32_16x16x32_bf16 v[52:55], a[84:87], v[212:215], v[52:55]
ds_read_b64_tr_b16 a[122:123], v119 offset:26624
v_cvt_pk_bf16_f32 v32, v32, v33
v_mfma_f32_16x16x32_bf16 v[52:55], a[88:91], v[228:231], v[52:55]
ds_read_b64_tr_b16 a[124:125], v119 offset:28672
ds_read_b64_tr_b16 a[126:127], v119 offset:30720
v_mfma_f32_16x16x32_bf16 v[52:55], a[92:95], v[244:247], v[52:55]
s_waitcnt vmcnt(23) lgkmcnt(9)
s_barrier
v_add_u32 v119, 4294901760, v119
v_mfma_f32_16x16x32_bf16 v[56:59], a[96:99], v[128:131], 0
ds_read_b64_tr_b16 a[64:65], v116 offset:0
v_cvt_pk_bf16_f32 v33, v34, v35
v_mfma_f32_16x16x32_bf16 v[56:59], a[100:103], v[144:147], v[56:59]
ds_read_b64_tr_b16 a[66:67], v116 offset:2048
v_cvt_pk_bf16_f32 v34, v40, v41
v_mfma_f32_16x16x32_bf16 v[56:59], a[104:107], v[160:163], v[56:59]
s_waitcnt lgkmcnt(8)
ds_read_b64_tr_b16 a[68:69], v116 offset:4096
v_cvt_pk_bf16_f32 v35, v42, v43
v_mfma_f32_16x16x32_bf16 v[56:59], a[108:111], v[176:179], v[56:59]
buffer_load_dwordx4 v115, s[36:39], s81 offen offset:3072 lds
ds_read_b64_tr_b16 a[70:71], v116 offset:6144
v_mfma_f32_16x16x32_bf16 v[56:59], a[112:115], v[192:195], v[56:59]
s_waitcnt lgkmcnt(8)
buffer_store_dwordx4 v[32:35], v1, s[4:7], s8 offen offset:0 sc1
ds_read_b64_tr_b16 a[72:73], v116 offset:8192
v_mfma_f32_16x16x32_bf16 v[56:59], a[116:119], v[208:211], v[56:59]
s_waitcnt lgkmcnt(7)
ds_read_b64_tr_b16 a[74:75], v116 offset:10240
v_mul_f32 v36, v36, v25
v_mfma_f32_16x16x32_bf16 v[56:59], a[120:123], v[224:227], v[56:59]
s_waitcnt lgkmcnt(6)
ds_read_b64_tr_b16 a[76:77], v116 offset:12288
v_mul_f32 v37, v37, v25
v_mfma_f32_16x16x32_bf16 v[56:59], a[124:127], v[240:243], v[56:59]
PAD_15:
s_cbranch_execz M_tret
ds_read_b64_tr_b16 a[78:79], v116 offset:14336
v_mul_f32 v38, v38, v25
v_mfma_f32_16x16x32_bf16 v[60:63], a[96:99], v[132:135], 0
ds_read_b64_tr_b16 a[80:81], v116 offset:16384
v_mul_f32 v39, v39, v25
v_mfma_f32_16x16x32_bf16 v[60:63], a[100:103], v[148:151], v[60:63]
s_sub_u32 s81, s81, 28544
ds_read_b64_tr_b16 a[82:83], v116 offset:18432
v_mul_f32 v44, v44, v25
v_mfma_f32_16x16x32_bf16 v[60:63], a[104:107], v[164:167], v[60:63]
ds_read_b64_tr_b16 a[84:85], v116 offset:20480
v_mul_f32 v45, v45, v25
v_mfma_f32_16x16x32_bf16 v[60:63], a[108:111], v[180:183], v[60:63]
ds_read_b64_tr_b16 a[86:87], v116 offset:22528
v_mul_f32 v46, v46, v25
v_mfma_f32_16x16x32_bf16 v[60:63], a[112:115], v[196:199], v[60:63]
ds_read_b64_tr_b16 a[88:89], v116 offset:24576
v_mul_f32 v47, v47, v25
v_mfma_f32_16x16x32_bf16 v[60:63], a[116:119], v[212:215], v[60:63]
ds_read_b64_tr_b16 a[90:91], v116 offset:26624
v_cvt_pk_bf16_f32 v36, v36, v37
v_mfma_f32_16x16x32_bf16 v[60:63], a[120:123], v[228:231], v[60:63]
ds_read_b64_tr_b16 a[92:93], v116 offset:28672
v_cvt_pk_bf16_f32 v37, v38, v39
v_mfma_f32_16x16x32_bf16 v[60:63], a[124:127], v[244:247], v[60:63]
s_waitcnt lgkmcnt(8)
ds_read_b64_tr_b16 a[94:95], v116 offset:30720
v_add_u32 v116, 4294901760, v116
v_mfma_f32_16x16x32_bf16 v[64:67], a[64:67], v[128:131], 0
s_add_u32 m0, s18, 98304
ds_read_b64_tr_b16 a[96:97], v117 offset:0
v_cvt_pk_bf16_f32 v38, v44, v45
v_mfma_f32_16x16x32_bf16 v[64:67], a[68:71], v[144:147], v[64:67]
buffer_load_dwordx4 v112, s[36:39], s81 offen offset:0 lds
ds_read_b64_tr_b16 a[98:99], v117 offset:2048
v_mfma_f32_16x16x32_bf16 v[64:67], a[72:75], v[160:163], v[64:67]
s_waitcnt lgkmcnt(8)
ds_read_b64_tr_b16 a[100:101], v117 offset:4096
v_cvt_pk_bf16_f32 v39, v46, v47
v_mfma_f32_16x16x32_bf16 v[64:67], a[76:79], v[176:179], v[64:67]
buffer_store_dwordx4 v[36:39], v1, s[4:7], s12 offen offset:0 sc1
ds_read_b64_tr_b16 a[102:103], v117 offset:6144
v_mfma_f32_16x16x32_bf16 v[64:67], a[80:83], v[192:195], v[64:67]
s_waitcnt lgkmcnt(8)
ds_read_b64_tr_b16 a[104:105], v117 offset:8192
v_mul_f32 v48, v48, v24
v_mfma_f32_16x16x32_bf16 v[64:67], a[84:87], v[208:211], v[64:67]
s_waitcnt lgkmcnt(7)
ds_read_b64_tr_b16 a[106:107], v117 offset:10240
v_mul_f32 v49, v49, v24
v_mfma_f32_16x16x32_bf16 v[64:67], a[88:91], v[224:227], v[64:67]
s_waitcnt lgkmcnt(6)
ds_read_b64_tr_b16 a[108:109], v117 offset:12288
v_mul_f32 v50, v50, v24
v_mfma_f32_16x16x32_bf16 v[64:67], a[92:95], v[240:243], v[64:67]
ds_read_b64_tr_b16 a[110:111], v117 offset:14336
v_mul_f32 v51, v51, v24
v_mfma_f32_16x16x32_bf16 v[68:71], a[64:67], v[132:135], 0
buffer_load_dwordx4 v113, s[36:39], s81 offen offset:1024 lds
ds_read_b64_tr_b16 a[112:113], v117 offset:16384
v_mfma_f32_16x16x32_bf16 v[68:71], a[68:71], v[148:151], v[68:71]
ds_read_b64_tr_b16 a[114:115], v117 offset:18432
v_mul_f32 v56, v56, v24
v_mfma_f32_16x16x32_bf16 v[68:71], a[72:75], v[164:167], v[68:71]
ds_read_b64_tr_b16 a[116:117], v117 offset:20480
v_mul_f32 v57, v57, v24
v_mfma_f32_16x16x32_bf16 v[68:71], a[76:79], v[180:183], v[68:71]
ds_read_b64_tr_b16 a[118:119], v117 offset:22528
v_mul_f32 v58, v58, v24
v_mfma_f32_16x16x32_bf16 v[68:71], a[80:83], v[196:199], v[68:71]
ds_read_b64_tr_b16 a[120:121], v117 offset:24576
v_mul_f32 v59, v59, v24
v_mfma_f32_16x16x32_bf16 v[68:71], a[84:87], v[212:215], v[68:71]
ds_read_b64_tr_b16 a[122:123], v117 offset:26624
v_cvt_pk_bf16_f32 v48, v48, v49
v_mfma_f32_16x16x32_bf16 v[68:71], a[88:91], v[228:231], v[68:71]
ds_read_b64_tr_b16 a[124:125], v117 offset:28672
v_cvt_pk_bf16_f32 v49, v50, v51
v_mfma_f32_16x16x32_bf16 v[68:71], a[92:95], v[244:247], v[68:71]
s_waitcnt lgkmcnt(8)
ds_read_b64_tr_b16 a[126:127], v117 offset:30720
v_add_u32 v117, 4294901760, v117
v_mfma_f32_16x16x32_bf16 v[72:75], a[96:99], v[128:131], 0
buffer_load_dwordx4 v114, s[36:39], s81 offen offset:2048 lds
ds_read_b64_tr_b16 a[64:65], v118 offset:0
v_mfma_f32_16x16x32_bf16 v[72:75], a[100:103], v[144:147], v[72:75]
ds_read_b64_tr_b16 a[66:67], v118 offset:2048
v_cvt_pk_bf16_f32 v50, v56, v57
v_mfma_f32_16x16x32_bf16 v[72:75], a[104:107], v[160:163], v[72:75]
s_waitcnt lgkmcnt(8)
ds_read_b64_tr_b16 a[68:69], v118 offset:4096
v_cvt_pk_bf16_f32 v51, v58, v59
v_mfma_f32_16x16x32_bf16 v[72:75], a[108:111], v[176:179], v[72:75]
buffer_store_dwordx4 v[48:51], v1, s[4:7], s8 offen offset:1024 sc1
ds_read_b64_tr_b16 a[70:71], v118 offset:6144
v_mfma_f32_16x16x32_bf16 v[72:75], a[112:115], v[192:195], v[72:75]
s_waitcnt lgkmcnt(8)
ds_read_b64_tr_b16 a[72:73], v118 offset:8192
v_mul_f32 v52, v52, v25
v_mfma_f32_16x16x32_bf16 v[72:75], a[116:119], v[208:211], v[72:75]
s_waitcnt lgkmcnt(7)
ds_read_b64_tr_b16 a[74:75], v118 offset:10240
v_mul_f32 v53, v53, v25
v_mfma_f32_16x16x32_bf16 v[72:75], a[120:123], v[224:227], v[72:75]
s_waitcnt lgkmcnt(6)
ds_read_b64_tr_b16 a[76:77], v118 offset:12288
v_mul_f32 v54, v54, v25
v_mfma_f32_16x16x32_bf16 v[72:75], a[124:127], v[240:243], v[72:75]
buffer_load_dwordx4 v115, s[36:39], s81 offen offset:3072 lds
ds_read_b64_tr_b16 a[78:79], v118 offset:14336
v_mfma_f32_16x16x32_bf16 v[76:79], a[96:99], v[132:135], 0
ds_read_b64_tr_b16 a[80:81], v118 offset:16384
v_mul_f32 v55, v55, v25
v_mfma_f32_16x16x32_bf16 v[76:79], a[100:103], v[148:151], v[76:79]
ds_read_b64_tr_b16 a[82:83], v118 offset:18432
v_mul_f32 v60, v60, v25
v_mfma_f32_16x16x32_bf16 v[76:79], a[104:107], v[164:167], v[76:79]
ds_read_b64_tr_b16 a[84:85], v118 offset:20480
v_mul_f32 v61, v61, v25
v_mfma_f32_16x16x32_bf16 v[76:79], a[108:111], v[180:183], v[76:79]
ds_read_b64_tr_b16 a[86:87], v118 offset:22528
v_mul_f32 v62, v62, v25
v_mfma_f32_16x16x32_bf16 v[76:79], a[112:115], v[196:199], v[76:79]
ds_read_b64_tr_b16 a[88:89], v118 offset:24576
v_mul_f32 v63, v63, v25
v_mfma_f32_16x16x32_bf16 v[76:79], a[116:119], v[212:215], v[76:79]
s_add_u32 s81, s81, 28672
s_add_u32 m0, s18, 102400
ds_read_b64_tr_b16 a[90:91], v118 offset:26624
v_mfma_f32_16x16x32_bf16 v[76:79], a[120:123], v[228:231], v[76:79]
buffer_load_dwordx4 v112, s[36:39], s81 offen offset:0 lds
ds_read_b64_tr_b16 a[92:93], v118 offset:28672
v_mfma_f32_16x16x32_bf16 v[76:79], a[124:127], v[244:247], v[76:79]
s_waitcnt lgkmcnt(8)
ds_read_b64_tr_b16 a[94:95], v118 offset:30720
v_add_u32 v118, 4294901760, v118
v_mfma_f32_16x16x32_bf16 v[80:83], a[64:67], v[128:131], 0
ds_read_b64_tr_b16 a[96:97], v119 offset:0
v_cvt_pk_bf16_f32 v52, v52, v53
v_mfma_f32_16x16x32_bf16 v[80:83], a[68:71], v[144:147], v[80:83]
ds_read_b64_tr_b16 a[98:99], v119 offset:2048
v_cvt_pk_bf16_f32 v53, v54, v55
v_mfma_f32_16x16x32_bf16 v[80:83], a[72:75], v[160:163], v[80:83]
s_waitcnt lgkmcnt(8)
ds_read_b64_tr_b16 a[100:101], v119 offset:4096
v_cvt_pk_bf16_f32 v54, v60, v61
v_mfma_f32_16x16x32_bf16 v[80:83], a[76:79], v[176:179], v[80:83]
ds_read_b64_tr_b16 a[102:103], v119 offset:6144
v_cvt_pk_bf16_f32 v55, v62, v63
v_mfma_f32_16x16x32_bf16 v[80:83], a[80:83], v[192:195], v[80:83]
s_waitcnt lgkmcnt(8)
buffer_store_dwordx4 v[52:55], v1, s[4:7], s12 offen offset:1024 sc1
ds_read_b64_tr_b16 a[104:105], v119 offset:8192
v_mfma_f32_16x16x32_bf16 v[80:83], a[84:87], v[208:211], v[80:83]
s_waitcnt lgkmcnt(7)
buffer_load_dwordx4 v113, s[36:39], s81 offen offset:1024 lds
ds_read_b64_tr_b16 a[106:107], v119 offset:10240
v_mfma_f32_16x16x32_bf16 v[80:83], a[88:91], v[224:227], v[80:83]
s_waitcnt lgkmcnt(6)
ds_read_b64_tr_b16 a[108:109], v119 offset:12288
v_mul_f32 v64, v64, v24
v_mfma_f32_16x16x32_bf16 v[80:83], a[92:95], v[240:243], v[80:83]
ds_read_b64_tr_b16 a[110:111], v119 offset:14336
v_mul_f32 v65, v65, v24
v_mfma_f32_16x16x32_bf16 v[84:87], a[64:67], v[132:135], 0
ds_read_b64_tr_b16 a[112:113], v119 offset:16384
v_mul_f32 v66, v66, v24
v_mfma_f32_16x16x32_bf16 v[84:87], a[68:71], v[148:151], v[84:87]
ds_read_b64_tr_b16 a[114:115], v119 offset:18432
v_mul_f32 v67, v67, v24
v_mfma_f32_16x16x32_bf16 v[84:87], a[72:75], v[164:167], v[84:87]
ds_read_b64_tr_b16 a[116:117], v119 offset:20480
v_mul_f32 v72, v72, v24
v_mfma_f32_16x16x32_bf16 v[84:87], a[76:79], v[180:183], v[84:87]
ds_read_b64_tr_b16 a[118:119], v119 offset:22528
v_mul_f32 v73, v73, v24
v_mfma_f32_16x16x32_bf16 v[84:87], a[80:83], v[196:199], v[84:87]
buffer_load_dwordx4 v114, s[36:39], s81 offen offset:2048 lds
ds_read_b64_tr_b16 a[120:121], v119 offset:24576
v_mfma_f32_16x16x32_bf16 v[84:87], a[84:87], v[212:215], v[84:87]
ds_read_b64_tr_b16 a[122:123], v119 offset:26624
v_mul_f32 v74, v74, v24
v_mfma_f32_16x16x32_bf16 v[84:87], a[88:91], v[228:231], v[84:87]
ds_read_b64_tr_b16 a[124:125], v119 offset:28672
ds_read_b64_tr_b16 a[126:127], v119 offset:30720
v_mfma_f32_16x16x32_bf16 v[84:87], a[92:95], v[244:247], v[84:87]
s_waitcnt vmcnt(27) lgkmcnt(9)
s_barrier
v_add_u32 v119, 4294901760, v119
v_mfma_f32_16x16x32_bf16 v[88:91], a[96:99], v[128:131], 0
ds_read_b64_tr_b16 a[64:65], v116 offset:0
v_mul_f32 v75, v75, v24
v_mfma_f32_16x16x32_bf16 v[88:91], a[100:103], v[144:147], v[88:91]
ds_read_b64_tr_b16 a[66:67], v116 offset:2048
v_cvt_pk_bf16_f32 v64, v64, v65
v_mfma_f32_16x16x32_bf16 v[88:91], a[104:107], v[160:163], v[88:91]
s_waitcnt lgkmcnt(8)
ds_read_b64_tr_b16 a[68:69], v116 offset:4096
v_cvt_pk_bf16_f32 v65, v66, v67
v_mfma_f32_16x16x32_bf16 v[88:91], a[108:111], v[176:179], v[88:91]
buffer_load_dwordx4 v115, s[36:39], s81 offen offset:3072 lds
ds_read_b64_tr_b16 a[70:71], v116 offset:6144
v_mfma_f32_16x16x32_bf16 v[88:91], a[112:115], v[192:195], v[88:91]
s_waitcnt lgkmcnt(8)
ds_read_b64_tr_b16 a[72:73], v116 offset:8192
v_cvt_pk_bf16_f32 v66, v72, v73
v_mfma_f32_16x16x32_bf16 v[88:91], a[116:119], v[208:211], v[88:91]
s_waitcnt lgkmcnt(7)
ds_read_b64_tr_b16 a[74:75], v116 offset:10240
v_cvt_pk_bf16_f32 v67, v74, v75
v_mfma_f32_16x16x32_bf16 v[88:91], a[120:123], v[224:227], v[88:91]
s_waitcnt lgkmcnt(6)
buffer_store_dwordx4 v[64:67], v1, s[4:7], s8 offen offset:2048 sc1
ds_read_b64_tr_b16 a[76:77], v116 offset:12288
v_mfma_f32_16x16x32_bf16 v[88:91], a[124:127], v[240:243], v[88:91]
ds_read_b64_tr_b16 a[78:79], v116 offset:14336
v_mul_f32 v68, v68, v25
v_mfma_f32_16x16x32_bf16 v[92:95], a[96:99], v[132:135], 0
ds_read_b64_tr_b16 a[80:81], v116 offset:16384
v_mul_f32 v69, v69, v25
v_mfma_f32_16x16x32_bf16 v[92:95], a[100:103], v[148:151], v[92:95]
s_sub_u32 s81, s81, 28544
ds_read_b64_tr_b16 a[82:83], v116 offset:18432
v_mul_f32 v70, v70, v25
v_mfma_f32_16x16x32_bf16 v[92:95], a[104:107], v[164:167], v[92:95]
ds_read_b64_tr_b16 a[84:85], v116 offset:20480
v_mul_f32 v71, v71, v25
v_mfma_f32_16x16x32_bf16 v[92:95], a[108:111], v[180:183], v[92:95]
ds_read_b64_tr_b16 a[86:87], v116 offset:22528
v_mul_f32 v76, v76, v25
v_mfma_f32_16x16x32_bf16 v[92:95], a[112:115], v[196:199], v[92:95]
ds_read_b64_tr_b16 a[88:89], v116 offset:24576
v_mul_f32 v77, v77, v25
v_mfma_f32_16x16x32_bf16 v[92:95], a[116:119], v[212:215], v[92:95]
ds_read_b64_tr_b16 a[90:91], v116 offset:26624
v_mul_f32 v78, v78, v25
v_mfma_f32_16x16x32_bf16 v[92:95], a[120:123], v[228:231], v[92:95]
ds_read_b64_tr_b16 a[92:93], v116 offset:28672
v_mul_f32 v79, v79, v25
v_mfma_f32_16x16x32_bf16 v[92:95], a[124:127], v[244:247], v[92:95]
s_waitcnt lgkmcnt(8)
ds_read_b64_tr_b16 a[94:95], v116 offset:30720
v_add_u32 v116, 32768, v116
v_mfma_f32_16x16x32_bf16 v[32:35], a[64:67], v[128:131], 0
ds_read_b64_tr_b16 a[96:97], v117 offset:0
v_cvt_pk_bf16_f32 v68, v68, v69
v_mfma_f32_16x16x32_bf16 v[32:35], a[68:71], v[144:147], v[32:35]
ds_read_b64_tr_b16 a[98:99], v117 offset:2048
v_cvt_pk_bf16_f32 v69, v70, v71
v_mfma_f32_16x16x32_bf16 v[32:35], a[72:75], v[160:163], v[32:35]
s_waitcnt lgkmcnt(8)
ds_read_b64_tr_b16 a[100:101], v117 offset:4096
v_cvt_pk_bf16_f32 v70, v76, v77
v_mfma_f32_16x16x32_bf16 v[32:35], a[76:79], v[176:179], v[32:35]
ds_read_b64_tr_b16 a[102:103], v117 offset:6144
v_cvt_pk_bf16_f32 v71, v78, v79
v_mfma_f32_16x16x32_bf16 v[32:35], a[80:83], v[192:195], v[32:35]
s_waitcnt lgkmcnt(8)
buffer_store_dwordx4 v[68:71], v1, s[4:7], s12 offen offset:2048 sc1
ds_read_b64_tr_b16 a[104:105], v117 offset:8192
v_mfma_f32_16x16x32_bf16 v[32:35], a[84:87], v[208:211], v[32:35]
s_waitcnt lgkmcnt(7)
ds_read_b64_tr_b16 a[106:107], v117 offset:10240
v_mul_f32 v80, v80, v24
v_mfma_f32_16x16x32_bf16 v[32:35], a[88:91], v[224:227], v[32:35]
s_waitcnt lgkmcnt(6)
ds_read_b64_tr_b16 a[108:109], v117 offset:12288
v_mul_f32 v81, v81, v24
v_mfma_f32_16x16x32_bf16 v[32:35], a[92:95], v[240:243], v[32:35]
ds_read_b64_tr_b16 a[110:111], v117 offset:14336
v_mul_f32 v82, v82, v24
v_mfma_f32_16x16x32_bf16 v[36:39], a[64:67], v[132:135], 0
ds_read_b64_tr_b16 a[112:113], v117 offset:16384
v_mul_f32 v83, v83, v24
v_mfma_f32_16x16x32_bf16 v[36:39], a[68:71], v[148:151], v[36:39]
ds_read_b64_tr_b16 a[114:115], v117 offset:18432
v_mul_f32 v88, v88, v24
v_mfma_f32_16x16x32_bf16 v[36:39], a[72:75], v[164:167], v[36:39]
ds_read_b64_tr_b16 a[116:117], v117 offset:20480
v_mul_f32 v89, v89, v24
v_mfma_f32_16x16x32_bf16 v[36:39], a[76:79], v[180:183], v[36:39]
ds_read_b64_tr_b16 a[118:119], v117 offset:22528
v_mul_f32 v90, v90, v24
v_mfma_f32_16x16x32_bf16 v[36:39], a[80:83], v[196:199], v[36:39]
ds_read_b64_tr_b16 a[120:121], v117 offset:24576
v_mul_f32 v91, v91, v24
v_mfma_f32_16x16x32_bf16 v[36:39], a[84:87], v[212:215], v[36:39]
ds_read_b64_tr_b16 a[122:123], v117 offset:26624
v_cvt_pk_bf16_f32 v80, v80, v81
v_mfma_f32_16x16x32_bf16 v[36:39], a[88:91], v[228:231], v[36:39]
ds_read_b64_tr_b16 a[124:125], v117 offset:28672
v_cvt_pk_bf16_f32 v81, v82, v83
v_mfma_f32_16x16x32_bf16 v[36:39], a[92:95], v[244:247], v[36:39]
s_waitcnt lgkmcnt(8)
ds_read_b64_tr_b16 a[126:127], v117 offset:30720
v_add_u32 v117, 32768, v117
v_mfma_f32_16x16x32_bf16 v[40:43], a[96:99], v[128:131], 0
ds_read_b64_tr_b16 a[64:65], v118 offset:0
v_cvt_pk_bf16_f32 v82, v88, v89
v_mfma_f32_16x16x32_bf16 v[40:43], a[100:103], v[144:147], v[40:43]
ds_read_b64_tr_b16 a[66:67], v118 offset:2048
v_cvt_pk_bf16_f32 v83, v90, v91
v_mfma_f32_16x16x32_bf16 v[40:43], a[104:107], v[160:163], v[40:43]
s_waitcnt lgkmcnt(8)
buffer_store_dwordx4 v[80:83], v1, s[4:7], s8 offen offset:3072 sc1
ds_read_b64_tr_b16 a[68:69], v118 offset:4096
v_mfma_f32_16x16x32_bf16 v[40:43], a[108:111], v[176:179], v[40:43]
ds_read_b64_tr_b16 a[70:71], v118 offset:6144
v_mul_f32 v84, v84, v25
v_mfma_f32_16x16x32_bf16 v[40:43], a[112:115], v[192:195], v[40:43]
s_waitcnt lgkmcnt(8)
ds_read_b64_tr_b16 a[72:73], v118 offset:8192
v_mul_f32 v85, v85, v25
v_mfma_f32_16x16x32_bf16 v[40:43], a[116:119], v[208:211], v[40:43]
s_waitcnt lgkmcnt(7)
ds_read_b64_tr_b16 a[74:75], v118 offset:10240
v_mul_f32 v86, v86, v25
v_mfma_f32_16x16x32_bf16 v[40:43], a[120:123], v[224:227], v[40:43]
s_waitcnt lgkmcnt(6)
ds_read_b64_tr_b16 a[76:77], v118 offset:12288
v_mul_f32 v87, v87, v25
v_mfma_f32_16x16x32_bf16 v[40:43], a[124:127], v[240:243], v[40:43]
ds_read_b64_tr_b16 a[78:79], v118 offset:14336
v_mul_f32 v92, v92, v25
v_mfma_f32_16x16x32_bf16 v[44:47], a[96:99], v[132:135], 0
ds_read_b64_tr_b16 a[80:81], v118 offset:16384
v_mul_f32 v93, v93, v25
v_mfma_f32_16x16x32_bf16 v[44:47], a[100:103], v[148:151], v[44:47]
ds_read_b64_tr_b16 a[82:83], v118 offset:18432
v_mul_f32 v94, v94, v25
v_mfma_f32_16x16x32_bf16 v[44:47], a[104:107], v[164:167], v[44:47]
ds_read_b64_tr_b16 a[84:85], v118 offset:20480
v_mul_f32 v95, v95, v25
v_mfma_f32_16x16x32_bf16 v[44:47], a[108:111], v[180:183], v[44:47]
ds_read_b64_tr_b16 a[86:87], v118 offset:22528
v_cvt_pk_bf16_f32 v84, v84, v85
v_mfma_f32_16x16x32_bf16 v[44:47], a[112:115], v[196:199], v[44:47]
ds_read_b64_tr_b16 a[88:89], v118 offset:24576
v_cvt_pk_bf16_f32 v85, v86, v87
v_mfma_f32_16x16x32_bf16 v[44:47], a[116:119], v[212:215], v[44:47]
ds_read_b64_tr_b16 a[90:91], v118 offset:26624
v_cvt_pk_bf16_f32 v86, v92, v93
v_mfma_f32_16x16x32_bf16 v[44:47], a[120:123], v[228:231], v[44:47]
ds_read_b64_tr_b16 a[92:93], v118 offset:28672
v_cvt_pk_bf16_f32 v87, v94, v95
v_mfma_f32_16x16x32_bf16 v[44:47], a[124:127], v[244:247], v[44:47]
s_waitcnt lgkmcnt(8)
ds_read_b64_tr_b16 a[94:95], v118 offset:30720
v_add_u32 v118, 32768, v118
v_mfma_f32_16x16x32_bf16 v[48:51], a[64:67], v[128:131], 0
buffer_store_dwordx4 v[84:87], v1, s[4:7], s12 offen offset:3072 sc1
ds_read_b64_tr_b16 a[96:97], v119 offset:0
v_mfma_f32_16x16x32_bf16 v[48:51], a[68:71], v[144:147], v[48:51]
s_add_u32 s8, s8, 4096
s_add_u32 s12, s12, 4096
ds_read_b64_tr_b16 a[98:99], v119 offset:2048
v_mfma_f32_16x16x32_bf16 v[48:51], a[72:75], v[160:163], v[48:51]
s_waitcnt lgkmcnt(8)
ds_read_b64_tr_b16 a[100:101], v119 offset:4096
v_mul_f32 v32, v32, v24
v_mfma_f32_16x16x32_bf16 v[48:51], a[76:79], v[176:179], v[48:51]
ds_read_b64_tr_b16 a[102:103], v119 offset:6144
v_mul_f32 v33, v33, v24
v_mfma_f32_16x16x32_bf16 v[48:51], a[80:83], v[192:195], v[48:51]
s_waitcnt lgkmcnt(8)
ds_read_b64_tr_b16 a[104:105], v119 offset:8192
v_mul_f32 v34, v34, v24
v_mfma_f32_16x16x32_bf16 v[48:51], a[84:87], v[208:211], v[48:51]
s_waitcnt lgkmcnt(7)
ds_read_b64_tr_b16 a[106:107], v119 offset:10240
v_mul_f32 v35, v35, v24
v_mfma_f32_16x16x32_bf16 v[48:51], a[88:91], v[224:227], v[48:51]
s_waitcnt lgkmcnt(6)
ds_read_b64_tr_b16 a[108:109], v119 offset:12288
v_mul_f32 v40, v40, v24
v_mfma_f32_16x16x32_bf16 v[48:51], a[92:95], v[240:243], v[48:51]
ds_read_b64_tr_b16 a[110:111], v119 offset:14336
v_mul_f32 v41, v41, v24
v_mfma_f32_16x16x32_bf16 v[52:55], a[64:67], v[132:135], 0
ds_read_b64_tr_b16 a[112:113], v119 offset:16384
v_mul_f32 v42, v42, v24
v_mfma_f32_16x16x32_bf16 v[52:55], a[68:71], v[148:151], v[52:55]
ds_read_b64_tr_b16 a[114:115], v119 offset:18432
v_mul_f32 v43, v43, v24
v_mfma_f32_16x16x32_bf16 v[52:55], a[72:75], v[164:167], v[52:55]
ds_read_b64_tr_b16 a[116:117], v119 offset:20480
v_cvt_pk_bf16_f32 v32, v32, v33
v_mfma_f32_16x16x32_bf16 v[52:55], a[76:79], v[180:183], v[52:55]
ds_read_b64_tr_b16 a[118:119], v119 offset:22528
v_cvt_pk_bf16_f32 v33, v34, v35
v_mfma_f32_16x16x32_bf16 v[52:55], a[80:83], v[196:199], v[52:55]
ds_read_b64_tr_b16 a[120:121], v119 offset:24576
v_cvt_pk_bf16_f32 v34, v40, v41
v_mfma_f32_16x16x32_bf16 v[52:55], a[84:87], v[212:215], v[52:55]
ds_read_b64_tr_b16 a[122:123], v119 offset:26624
v_cvt_pk_bf16_f32 v35, v42, v43
v_mfma_f32_16x16x32_bf16 v[52:55], a[88:91], v[228:231], v[52:55]
ds_read_b64_tr_b16 a[124:125], v119 offset:28672
ds_read_b64_tr_b16 a[126:127], v119 offset:30720
v_mfma_f32_16x16x32_bf16 v[52:55], a[92:95], v[244:247], v[52:55]
s_waitcnt vmcnt(16) lgkmcnt(9)
s_barrier
v_add_u32 v119, 32768, v119
v_mfma_f32_16x16x32_bf16 v[56:59], a[96:99], v[128:131], 0
buffer_store_dwordx4 v[32:35], v1, s[4:7], s8 offen offset:0 sc1
ds_read_b64_tr_b16 a[64:65], v116 offset:0
v_mfma_f32_16x16x32_bf16 v[56:59], a[100:103], v[144:147], v[56:59]
ds_read_b64_tr_b16 a[66:67], v116 offset:2048
v_mul_f32 v36, v36, v25
v_mfma_f32_16x16x32_bf16 v[56:59], a[104:107], v[160:163], v[56:59]
s_waitcnt lgkmcnt(8)
ds_read_b64_tr_b16 a[68:69], v116 offset:4096
v_mul_f32 v37, v37, v25
v_mfma_f32_16x16x32_bf16 v[56:59], a[108:111], v[176:179], v[56:59]
ds_read_b64_tr_b16 a[70:71], v116 offset:6144
v_mul_f32 v38, v38, v25
v_mfma_f32_16x16x32_bf16 v[56:59], a[112:115], v[192:195], v[56:59]
s_waitcnt lgkmcnt(8)
ds_read_b64_tr_b16 a[72:73], v116 offset:8192
v_mul_f32 v39, v39, v25
v_mfma_f32_16x16x32_bf16 v[56:59], a[116:119], v[208:211], v[56:59]
s_waitcnt lgkmcnt(7)
ds_read_b64_tr_b16 a[74:75], v116 offset:10240
v_mul_f32 v44, v44, v25
v_mfma_f32_16x16x32_bf16 v[56:59], a[120:123], v[224:227], v[56:59]
s_waitcnt lgkmcnt(6)
ds_read_b64_tr_b16 a[76:77], v116 offset:12288
v_mul_f32 v45, v45, v25
v_mfma_f32_16x16x32_bf16 v[56:59], a[124:127], v[240:243], v[56:59]
ds_read_b64_tr_b16 a[78:79], v116 offset:14336
v_mul_f32 v46, v46, v25
v_mfma_f32_16x16x32_bf16 v[60:63], a[96:99], v[132:135], 0
ds_read_b64_tr_b16 a[80:81], v116 offset:16384
v_mul_f32 v47, v47, v25
v_mfma_f32_16x16x32_bf16 v[60:63], a[100:103], v[148:151], v[60:63]
ds_read_b64_tr_b16 a[82:83], v116 offset:18432
v_cvt_pk_bf16_f32 v36, v36, v37
v_mfma_f32_16x16x32_bf16 v[60:63], a[104:107], v[164:167], v[60:63]
ds_read_b64_tr_b16 a[84:85], v116 offset:20480
v_cvt_pk_bf16_f32 v37, v38, v39
v_mfma_f32_16x16x32_bf16 v[60:63], a[108:111], v[180:183], v[60:63]
ds_read_b64_tr_b16 a[86:87], v116 offset:22528
v_cvt_pk_bf16_f32 v38, v44, v45
v_mfma_f32_16x16x32_bf16 v[60:63], a[112:115], v[196:199], v[60:63]
ds_read_b64_tr_b16 a[88:89], v116 offset:24576
v_cvt_pk_bf16_f32 v39, v46, v47
v_mfma_f32_16x16x32_bf16 v[60:63], a[116:119], v[212:215], v[60:63]
buffer_store_dwordx4 v[36:39], v1, s[4:7], s12 offen offset:0 sc1
ds_read_b64_tr_b16 a[90:91], v116 offset:26624
v_mfma_f32_16x16x32_bf16 v[60:63], a[120:123], v[228:231], v[60:63]
ds_read_b64_tr_b16 a[92:93], v116 offset:28672
v_mfma_f32_16x16x32_bf16 v[60:63], a[124:127], v[244:247], v[60:63]
s_waitcnt lgkmcnt(8)
ds_read_b64_tr_b16 a[94:95], v116 offset:30720
v_add_u32 v116, 65536, v116
v_mfma_f32_16x16x32_bf16 v[64:67], a[64:67], v[128:131], 0
ds_read_b64_tr_b16 a[96:97], v117 offset:0
v_mul_f32 v48, v48, v24
v_mfma_f32_16x16x32_bf16 v[64:67], a[68:71], v[144:147], v[64:67]
ds_read_b64_tr_b16 a[98:99], v117 offset:2048
v_mul_f32 v49, v49, v24
v_mfma_f32_16x16x32_bf16 v[64:67], a[72:75], v[160:163], v[64:67]
s_waitcnt lgkmcnt(8)
ds_read_b64_tr_b16 a[100:101], v117 offset:4096
v_mul_f32 v50, v50, v24
v_mfma_f32_16x16x32_bf16 v[64:67], a[76:79], v[176:179], v[64:67]
ds_read_b64_tr_b16 a[102:103], v117 offset:6144
v_mul_f32 v51, v51, v24
v_mfma_f32_16x16x32_bf16 v[64:67], a[80:83], v[192:195], v[64:67]
s_waitcnt lgkmcnt(8)
ds_read_b64_tr_b16 a[104:105], v117 offset:8192
v_mul_f32 v56, v56, v24
v_mfma_f32_16x16x32_bf16 v[64:67], a[84:87], v[208:211], v[64:67]
s_waitcnt lgkmcnt(7)
ds_read_b64_tr_b16 a[106:107], v117 offset:10240
v_mul_f32 v57, v57, v24
v_mfma_f32_16x16x32_bf16 v[64:67], a[88:91], v[224:227], v[64:67]
s_waitcnt lgkmcnt(6)
ds_read_b64_tr_b16 a[108:109], v117 offset:12288
v_mul_f32 v58, v58, v24
v_mfma_f32_16x16x32_bf16 v[64:67], a[92:95], v[240:243], v[64:67]
ds_read_b64_tr_b16 a[110:111], v117 offset:14336
v_mul_f32 v59, v59, v24
v_mfma_f32_16x16x32_bf16 v[68:71], a[64:67], v[132:135], 0
ds_read_b64_tr_b16 a[112:113], v117 offset:16384
v_cvt_pk_bf16_f32 v48, v48, v49
v_mfma_f32_16x16x32_bf16 v[68:71], a[68:71], v[148:151], v[68:71]
ds_read_b64_tr_b16 a[114:115], v117 offset:18432
v_cvt_pk_bf16_f32 v49, v50, v51
v_mfma_f32_16x16x32_bf16 v[68:71], a[72:75], v[164:167], v[68:71]
ds_read_b64_tr_b16 a[116:117], v117 offset:20480
v_cvt_pk_bf16_f32 v50, v56, v57
v_mfma_f32_16x16x32_bf16 v[68:71], a[76:79], v[180:183], v[68:71]
ds_read_b64_tr_b16 a[118:119], v117 offset:22528
v_cvt_pk_bf16_f32 v51, v58, v59
v_mfma_f32_16x16x32_bf16 v[68:71], a[80:83], v[196:199], v[68:71]
buffer_store_dwordx4 v[48:51], v1, s[4:7], s8 offen offset:1024 sc1
ds_read_b64_tr_b16 a[120:121], v117 offset:24576
v_mfma_f32_16x16x32_bf16 v[68:71], a[84:87], v[212:215], v[68:71]
ds_read_b64_tr_b16 a[122:123], v117 offset:26624
v_mul_f32 v52, v52, v25
v_mfma_f32_16x16x32_bf16 v[68:71], a[88:91], v[228:231], v[68:71]
ds_read_b64_tr_b16 a[124:125], v117 offset:28672
v_mul_f32 v53, v53, v25
v_mfma_f32_16x16x32_bf16 v[68:71], a[92:95], v[244:247], v[68:71]
s_waitcnt lgkmcnt(8)
ds_read_b64_tr_b16 a[126:127], v117 offset:30720
v_add_u32 v117, 65536, v117
v_mfma_f32_16x16x32_bf16 v[72:75], a[96:99], v[128:131], 0
ds_read_b64_tr_b16 a[64:65], v118 offset:0
v_mul_f32 v54, v54, v25
v_mfma_f32_16x16x32_bf16 v[72:75], a[100:103], v[144:147], v[72:75]
ds_read_b64_tr_b16 a[66:67], v118 offset:2048
v_mul_f32 v55, v55, v25
v_mfma_f32_16x16x32_bf16 v[72:75], a[104:107], v[160:163], v[72:75]
s_waitcnt lgkmcnt(8)
ds_read_b64_tr_b16 a[68:69], v118 offset:4096
v_mul_f32 v60, v60, v25
v_mfma_f32_16x16x32_bf16 v[72:75], a[108:111], v[176:179], v[72:75]
ds_read_b64_tr_b16 a[70:71], v118 offset:6144
v_mul_f32 v61, v61, v25
v_mfma_f32_16x16x32_bf16 v[72:75], a[112:115], v[192:195], v[72:75]
s_waitcnt lgkmcnt(8)
ds_read_b64_tr_b16 a[72:73], v118 offset:8192
v_mul_f32 v62, v62, v25
v_mfma_f32_16x16x32_bf16 v[72:75], a[116:119], v[208:211], v[72:75]
s_waitcnt lgkmcnt(7)
ds_read_b64_tr_b16 a[74:75], v118 offset:10240
v_mul_f32 v63, v63, v25
v_mfma_f32_16x16x32_bf16 v[72:75], a[120:123], v[224:227], v[72:75]
s_waitcnt lgkmcnt(6)
ds_read_b64_tr_b16 a[76:77], v118 offset:12288
v_cvt_pk_bf16_f32 v52, v52, v53
v_mfma_f32_16x16x32_bf16 v[72:75], a[124:127], v[240:243], v[72:75]
ds_read_b64_tr_b16 a[78:79], v118 offset:14336
v_cvt_pk_bf16_f32 v53, v54, v55
v_mfma_f32_16x16x32_bf16 v[76:79], a[96:99], v[132:135], 0
ds_read_b64_tr_b16 a[80:81], v118 offset:16384
v_cvt_pk_bf16_f32 v54, v60, v61
v_mfma_f32_16x16x32_bf16 v[76:79], a[100:103], v[148:151], v[76:79]
ds_read_b64_tr_b16 a[82:83], v118 offset:18432
v_cvt_pk_bf16_f32 v55, v62, v63
v_mfma_f32_16x16x32_bf16 v[76:79], a[104:107], v[164:167], v[76:79]
buffer_store_dwordx4 v[52:55], v1, s[4:7], s12 offen offset:1024 sc1
ds_read_b64_tr_b16 a[84:85], v118 offset:20480
v_mfma_f32_16x16x32_bf16 v[76:79], a[108:111], v[180:183], v[76:79]
ds_read_b64_tr_b16 a[86:87], v118 offset:22528
v_mul_u32_u24 v21, 1792, v19
v_mfma_f32_16x16x32_bf16 v[76:79], a[112:115], v[196:199], v[76:79]
ds_read_b64_tr_b16 a[88:89], v118 offset:24576
v_mul_f32 v64, v64, v24
v_mfma_f32_16x16x32_bf16 v[76:79], a[116:119], v[212:215], v[76:79]
ds_read_b64_tr_b16 a[90:91], v118 offset:26624
v_mul_f32 v65, v65, v24
v_mfma_f32_16x16x32_bf16 v[76:79], a[120:123], v[228:231], v[76:79]
ds_read_b64_tr_b16 a[92:93], v118 offset:28672
v_mul_f32 v66, v66, v24
v_mfma_f32_16x16x32_bf16 v[76:79], a[124:127], v[244:247], v[76:79]
s_waitcnt lgkmcnt(8)
ds_read_b64_tr_b16 a[94:95], v118 offset:30720
v_add_u32 v118, 65536, v118
v_mfma_f32_16x16x32_bf16 v[80:83], a[64:67], v[128:131], 0
ds_read_b64_tr_b16 a[96:97], v119 offset:0
v_mul_f32 v67, v67, v24
v_mfma_f32_16x16x32_bf16 v[80:83], a[68:71], v[144:147], v[80:83]
ds_read_b64_tr_b16 a[98:99], v119 offset:2048
v_mul_f32 v72, v72, v24
v_mfma_f32_16x16x32_bf16 v[80:83], a[72:75], v[160:163], v[80:83]
s_waitcnt lgkmcnt(8)
ds_read_b64_tr_b16 a[100:101], v119 offset:4096
v_mul_f32 v73, v73, v24
v_mfma_f32_16x16x32_bf16 v[80:83], a[76:79], v[176:179], v[80:83]
ds_read_b64_tr_b16 a[102:103], v119 offset:6144
v_mul_f32 v74, v74, v24
v_mfma_f32_16x16x32_bf16 v[80:83], a[80:83], v[192:195], v[80:83]
s_waitcnt lgkmcnt(8)
ds_read_b64_tr_b16 a[104:105], v119 offset:8192
v_mul_f32 v75, v75, v24
v_mfma_f32_16x16x32_bf16 v[80:83], a[84:87], v[208:211], v[80:83]
s_waitcnt lgkmcnt(7)
ds_read_b64_tr_b16 a[106:107], v119 offset:10240
v_cvt_pk_bf16_f32 v64, v64, v65
v_mfma_f32_16x16x32_bf16 v[80:83], a[88:91], v[224:227], v[80:83]
s_waitcnt lgkmcnt(6)
ds_read_b64_tr_b16 a[108:109], v119 offset:12288
v_cvt_pk_bf16_f32 v65, v66, v67
v_mfma_f32_16x16x32_bf16 v[80:83], a[92:95], v[240:243], v[80:83]
PAD_16:
s_cbranch_execz M_tret
ds_read_b64_tr_b16 a[110:111], v119 offset:14336
v_cvt_pk_bf16_f32 v66, v72, v73
v_mfma_f32_16x16x32_bf16 v[84:87], a[64:67], v[132:135], 0
ds_read_b64_tr_b16 a[112:113], v119 offset:16384
v_cvt_pk_bf16_f32 v67, v74, v75
v_mfma_f32_16x16x32_bf16 v[84:87], a[68:71], v[148:151], v[84:87]
buffer_store_dwordx4 v[64:67], v1, s[4:7], s8 offen offset:2048 sc1
ds_read_b64_tr_b16 a[114:115], v119 offset:18432
v_mfma_f32_16x16x32_bf16 v[84:87], a[72:75], v[164:167], v[84:87]
ds_read_b64_tr_b16 a[116:117], v119 offset:20480
v_mul_f32 v68, v68, v25
v_mfma_f32_16x16x32_bf16 v[84:87], a[76:79], v[180:183], v[84:87]
ds_read_b64_tr_b16 a[118:119], v119 offset:22528
v_mul_f32 v69, v69, v25
v_mfma_f32_16x16x32_bf16 v[84:87], a[80:83], v[196:199], v[84:87]
ds_read_b64_tr_b16 a[120:121], v119 offset:24576
v_mul_f32 v70, v70, v25
v_mfma_f32_16x16x32_bf16 v[84:87], a[84:87], v[212:215], v[84:87]
ds_read_b64_tr_b16 a[122:123], v119 offset:26624
v_mul_f32 v71, v71, v25
v_mfma_f32_16x16x32_bf16 v[84:87], a[88:91], v[228:231], v[84:87]
ds_read_b64_tr_b16 a[124:125], v119 offset:28672
ds_read_b64_tr_b16 a[126:127], v119 offset:30720
v_mfma_f32_16x16x32_bf16 v[84:87], a[92:95], v[244:247], v[84:87]
s_waitcnt vmcnt(7) lgkmcnt(9)
s_barrier
v_add_u32 v119, 65536, v119
v_mfma_f32_16x16x32_bf16 v[88:91], a[96:99], v[128:131], 0
ds_read_b64_tr_b16 a[64:65], v116 offset:0
v_mul_f32 v76, v76, v25
v_mfma_f32_16x16x32_bf16 v[88:91], a[100:103], v[144:147], v[88:91]
buffer_store_dword v6, v5, s[4:7], s34 offen sc1
ds_read_b64_tr_b16 a[66:67], v116 offset:2048
v_mfma_f32_16x16x32_bf16 v[88:91], a[104:107], v[160:163], v[88:91]
s_waitcnt lgkmcnt(8)
ds_read_b64_tr_b16 a[68:69], v116 offset:4096
v_mul_f32 v77, v77, v25
v_mfma_f32_16x16x32_bf16 v[88:91], a[108:111], v[176:179], v[88:91]
ds_read_b64_tr_b16 a[70:71], v116 offset:6144
v_mul_f32 v78, v78, v25
v_mfma_f32_16x16x32_bf16 v[88:91], a[112:115], v[192:195], v[88:91]
s_waitcnt lgkmcnt(8)
ds_read_b64_tr_b16 a[72:73], v116 offset:8192
v_mul_f32 v79, v79, v25
v_mfma_f32_16x16x32_bf16 v[88:91], a[116:119], v[208:211], v[88:91]
s_waitcnt lgkmcnt(7)
ds_read_b64_tr_b16 a[74:75], v116 offset:10240
v_cvt_pk_bf16_f32 v68, v68, v69
v_mfma_f32_16x16x32_bf16 v[88:91], a[120:123], v[224:227], v[88:91]
s_waitcnt lgkmcnt(6)
ds_read_b64_tr_b16 a[76:77], v116 offset:12288
v_cvt_pk_bf16_f32 v69, v70, v71
v_mfma_f32_16x16x32_bf16 v[88:91], a[124:127], v[240:243], v[88:91]
ds_read_b64_tr_b16 a[78:79], v116 offset:14336
v_cvt_pk_bf16_f32 v70, v76, v77
v_mfma_f32_16x16x32_bf16 v[92:95], a[96:99], v[132:135], 0
ds_read_b64_tr_b16 a[80:81], v116 offset:16384
v_cvt_pk_bf16_f32 v71, v78, v79
v_mfma_f32_16x16x32_bf16 v[92:95], a[100:103], v[148:151], v[92:95]
buffer_store_dwordx4 v[68:71], v1, s[4:7], s12 offen offset:2048 sc1
ds_read_b64_tr_b16 a[82:83], v116 offset:18432
v_mfma_f32_16x16x32_bf16 v[92:95], a[104:107], v[164:167], v[92:95]
ds_read_b64_tr_b16 a[84:85], v116 offset:20480
v_lshlrev_b32 v19, 2, v19
v_mfma_f32_16x16x32_bf16 v[92:95], a[108:111], v[180:183], v[92:95]
ds_read_b64_tr_b16 a[86:87], v116 offset:22528
v_mfma_f32_16x16x32_bf16 v[92:95], a[112:115], v[196:199], v[92:95]
ds_read_b64_tr_b16 a[88:89], v116 offset:24576
v_mfma_f32_16x16x32_bf16 v[92:95], a[116:119], v[212:215], v[92:95]
ds_read_b64_tr_b16 a[90:91], v116 offset:26624
v_mfma_f32_16x16x32_bf16 v[92:95], a[120:123], v[228:231], v[92:95]
ds_read_b64_tr_b16 a[92:93], v116 offset:28672
v_mfma_f32_16x16x32_bf16 v[92:95], a[124:127], v[244:247], v[92:95]
s_waitcnt lgkmcnt(8)
ds_read_b64_tr_b16 a[94:95], v116 offset:30720
v_mfma_f32_16x16x32_bf16 v[32:35], a[64:67], v[128:131], 0
ds_read_b64_tr_b16 a[96:97], v117 offset:0
v_mul_f32 v80, v80, v24
v_mfma_f32_16x16x32_bf16 v[32:35], a[68:71], v[144:147], v[32:35]
ds_read_b64_tr_b16 a[98:99], v117 offset:2048
v_mul_f32 v81, v81, v24
v_mfma_f32_16x16x32_bf16 v[32:35], a[72:75], v[160:163], v[32:35]
s_waitcnt lgkmcnt(8)
ds_read_b64_tr_b16 a[100:101], v117 offset:4096
v_mul_f32 v82, v82, v24
v_mfma_f32_16x16x32_bf16 v[32:35], a[76:79], v[176:179], v[32:35]
ds_read_b64_tr_b16 a[102:103], v117 offset:6144
v_mul_f32 v83, v83, v24
v_mfma_f32_16x16x32_bf16 v[32:35], a[80:83], v[192:195], v[32:35]
s_waitcnt lgkmcnt(8)
ds_read_b64_tr_b16 a[104:105], v117 offset:8192
v_mul_f32 v88, v88, v24
v_mfma_f32_16x16x32_bf16 v[32:35], a[84:87], v[208:211], v[32:35]
s_waitcnt lgkmcnt(7)
ds_read_b64_tr_b16 a[106:107], v117 offset:10240
v_mul_f32 v89, v89, v24
v_mfma_f32_16x16x32_bf16 v[32:35], a[88:91], v[224:227], v[32:35]
s_waitcnt lgkmcnt(6)
ds_read_b64_tr_b16 a[108:109], v117 offset:12288
v_mul_f32 v90, v90, v24
v_mfma_f32_16x16x32_bf16 v[32:35], a[92:95], v[240:243], v[32:35]
ds_read_b64_tr_b16 a[110:111], v117 offset:14336
v_mul_f32 v91, v91, v24
v_mfma_f32_16x16x32_bf16 v[36:39], a[64:67], v[132:135], 0
ds_read_b64_tr_b16 a[112:113], v117 offset:16384
v_cvt_pk_bf16_f32 v80, v80, v81
v_mfma_f32_16x16x32_bf16 v[36:39], a[68:71], v[148:151], v[36:39]
ds_read_b64_tr_b16 a[114:115], v117 offset:18432
v_cvt_pk_bf16_f32 v81, v82, v83
v_mfma_f32_16x16x32_bf16 v[36:39], a[72:75], v[164:167], v[36:39]
ds_read_b64_tr_b16 a[116:117], v117 offset:20480
v_cvt_pk_bf16_f32 v82, v88, v89
v_mfma_f32_16x16x32_bf16 v[36:39], a[76:79], v[180:183], v[36:39]
ds_read_b64_tr_b16 a[118:119], v117 offset:22528
v_cvt_pk_bf16_f32 v83, v90, v91
v_mfma_f32_16x16x32_bf16 v[36:39], a[80:83], v[196:199], v[36:39]
buffer_store_dwordx4 v[80:83], v1, s[4:7], s8 offen offset:3072 sc1
ds_read_b64_tr_b16 a[120:121], v117 offset:24576
v_mfma_f32_16x16x32_bf16 v[36:39], a[84:87], v[212:215], v[36:39]
ds_read_b64_tr_b16 a[122:123], v117 offset:26624
v_mul_f32 v84, v84, v25
v_mfma_f32_16x16x32_bf16 v[36:39], a[88:91], v[228:231], v[36:39]
ds_read_b64_tr_b16 a[124:125], v117 offset:28672
v_mul_f32 v85, v85, v25
v_mfma_f32_16x16x32_bf16 v[36:39], a[92:95], v[244:247], v[36:39]
s_waitcnt lgkmcnt(8)
ds_read_b64_tr_b16 a[126:127], v117 offset:30720
v_mul_f32 v86, v86, v25
v_mfma_f32_16x16x32_bf16 v[40:43], a[96:99], v[128:131], 0
ds_read_b64_tr_b16 a[64:65], v118 offset:0
v_mul_f32 v87, v87, v25
v_mfma_f32_16x16x32_bf16 v[40:43], a[100:103], v[144:147], v[40:43]
ds_read_b64_tr_b16 a[66:67], v118 offset:2048
v_mul_f32 v92, v92, v25
v_mfma_f32_16x16x32_bf16 v[40:43], a[104:107], v[160:163], v[40:43]
s_waitcnt lgkmcnt(8)
ds_read_b64_tr_b16 a[68:69], v118 offset:4096
v_mul_f32 v93, v93, v25
v_mfma_f32_16x16x32_bf16 v[40:43], a[108:111], v[176:179], v[40:43]
ds_read_b64_tr_b16 a[70:71], v118 offset:6144
v_mul_f32 v94, v94, v25
v_mfma_f32_16x16x32_bf16 v[40:43], a[112:115], v[192:195], v[40:43]
s_waitcnt lgkmcnt(8)
ds_read_b64_tr_b16 a[72:73], v118 offset:8192
v_mul_f32 v95, v95, v25
v_mfma_f32_16x16x32_bf16 v[40:43], a[116:119], v[208:211], v[40:43]
s_waitcnt lgkmcnt(7)
ds_read_b64_tr_b16 a[74:75], v118 offset:10240
v_cvt_pk_bf16_f32 v84, v84, v85
v_mfma_f32_16x16x32_bf16 v[40:43], a[120:123], v[224:227], v[40:43]
s_waitcnt lgkmcnt(6)
ds_read_b64_tr_b16 a[76:77], v118 offset:12288
v_cvt_pk_bf16_f32 v85, v86, v87
v_mfma_f32_16x16x32_bf16 v[40:43], a[124:127], v[240:243], v[40:43]
ds_read_b64_tr_b16 a[78:79], v118 offset:14336
v_cvt_pk_bf16_f32 v86, v92, v93
v_mfma_f32_16x16x32_bf16 v[44:47], a[96:99], v[132:135], 0
ds_read_b64_tr_b16 a[80:81], v118 offset:16384
v_cvt_pk_bf16_f32 v87, v94, v95
v_mfma_f32_16x16x32_bf16 v[44:47], a[100:103], v[148:151], v[44:47]
buffer_store_dwordx4 v[84:87], v1, s[4:7], s12 offen offset:3072 sc1
ds_read_b64_tr_b16 a[82:83], v118 offset:18432
v_mfma_f32_16x16x32_bf16 v[44:47], a[104:107], v[164:167], v[44:47]
s_add_u32 s8, s8, 4096
s_add_u32 s12, s12, 4096
ds_read_b64_tr_b16 a[84:85], v118 offset:20480
v_mfma_f32_16x16x32_bf16 v[44:47], a[108:111], v[180:183], v[44:47]
ds_read_b64_tr_b16 a[86:87], v118 offset:22528
v_lshrrev_b32 v22, 4, v20
v_mfma_f32_16x16x32_bf16 v[44:47], a[112:115], v[196:199], v[44:47]
ds_read_b64_tr_b16 a[88:89], v118 offset:24576
v_mul_f32 v32, v32, v24
v_mfma_f32_16x16x32_bf16 v[44:47], a[116:119], v[212:215], v[44:47]
ds_read_b64_tr_b16 a[90:91], v118 offset:26624
v_mul_f32 v33, v33, v24
v_mfma_f32_16x16x32_bf16 v[44:47], a[120:123], v[228:231], v[44:47]
ds_read_b64_tr_b16 a[92:93], v118 offset:28672
v_mul_f32 v34, v34, v24
v_mfma_f32_16x16x32_bf16 v[44:47], a[124:127], v[244:247], v[44:47]
s_waitcnt lgkmcnt(8)
ds_read_b64_tr_b16 a[94:95], v118 offset:30720
v_mul_f32 v35, v35, v24
v_mfma_f32_16x16x32_bf16 v[48:51], a[64:67], v[128:131], 0
ds_read_b64_tr_b16 a[96:97], v119 offset:0
v_mul_f32 v40, v40, v24
v_mfma_f32_16x16x32_bf16 v[48:51], a[68:71], v[144:147], v[48:51]
ds_read_b64_tr_b16 a[98:99], v119 offset:2048
v_mul_f32 v41, v41, v24
v_mfma_f32_16x16x32_bf16 v[48:51], a[72:75], v[160:163], v[48:51]
s_waitcnt lgkmcnt(8)
ds_read_b64_tr_b16 a[100:101], v119 offset:4096
v_mul_f32 v42, v42, v24
v_mfma_f32_16x16x32_bf16 v[48:51], a[76:79], v[176:179], v[48:51]
ds_read_b64_tr_b16 a[102:103], v119 offset:6144
v_mul_f32 v43, v43, v24
v_mfma_f32_16x16x32_bf16 v[48:51], a[80:83], v[192:195], v[48:51]
s_waitcnt lgkmcnt(8)
ds_read_b64_tr_b16 a[104:105], v119 offset:8192
v_cvt_pk_bf16_f32 v32, v32, v33
v_mfma_f32_16x16x32_bf16 v[48:51], a[84:87], v[208:211], v[48:51]
s_waitcnt lgkmcnt(7)
ds_read_b64_tr_b16 a[106:107], v119 offset:10240
v_cvt_pk_bf16_f32 v33, v34, v35
v_mfma_f32_16x16x32_bf16 v[48:51], a[88:91], v[224:227], v[48:51]
s_waitcnt lgkmcnt(6)
ds_read_b64_tr_b16 a[108:109], v119 offset:12288
v_cvt_pk_bf16_f32 v34, v40, v41
v_mfma_f32_16x16x32_bf16 v[48:51], a[92:95], v[240:243], v[48:51]
ds_read_b64_tr_b16 a[110:111], v119 offset:14336
v_cvt_pk_bf16_f32 v35, v42, v43
v_mfma_f32_16x16x32_bf16 v[52:55], a[64:67], v[132:135], 0
buffer_store_dwordx4 v[32:35], v1, s[4:7], s8 offen offset:0 sc1
ds_read_b64_tr_b16 a[112:113], v119 offset:16384
v_mfma_f32_16x16x32_bf16 v[52:55], a[68:71], v[148:151], v[52:55]
ds_read_b64_tr_b16 a[114:115], v119 offset:18432
v_mul_f32 v36, v36, v25
v_mfma_f32_16x16x32_bf16 v[52:55], a[72:75], v[164:167], v[52:55]
ds_read_b64_tr_b16 a[116:117], v119 offset:20480
v_mul_f32 v37, v37, v25
v_mfma_f32_16x16x32_bf16 v[52:55], a[76:79], v[180:183], v[52:55]
ds_read_b64_tr_b16 a[118:119], v119 offset:22528
v_mul_f32 v38, v38, v25
v_mfma_f32_16x16x32_bf16 v[52:55], a[80:83], v[196:199], v[52:55]
ds_read_b64_tr_b16 a[120:121], v119 offset:24576
v_mul_f32 v39, v39, v25
v_mfma_f32_16x16x32_bf16 v[52:55], a[84:87], v[212:215], v[52:55]
ds_read_b64_tr_b16 a[122:123], v119 offset:26624
v_mul_f32 v44, v44, v25
v_mfma_f32_16x16x32_bf16 v[52:55], a[88:91], v[228:231], v[52:55]
ds_read_b64_tr_b16 a[124:125], v119 offset:28672
ds_read_b64_tr_b16 a[126:127], v119 offset:30720
v_mfma_f32_16x16x32_bf16 v[52:55], a[92:95], v[244:247], v[52:55]
s_waitcnt lgkmcnt(9)
v_mul_f32 v45, v45, v25
v_mul_f32 v46, v46, v25
v_mfma_f32_16x16x32_bf16 v[56:59], a[96:99], v[128:131], 0
v_mul_f32 v47, v47, v25
v_cvt_pk_bf16_f32 v36, v36, v37
v_mfma_f32_16x16x32_bf16 v[56:59], a[100:103], v[144:147], v[56:59]
v_cvt_pk_bf16_f32 v37, v38, v39
v_cvt_pk_bf16_f32 v38, v44, v45
v_mfma_f32_16x16x32_bf16 v[56:59], a[104:107], v[160:163], v[56:59]
s_waitcnt lgkmcnt(6)
v_cvt_pk_bf16_f32 v39, v46, v47
v_lshl_add_u32 v21, v22, 3, v21
v_mfma_f32_16x16x32_bf16 v[56:59], a[108:111], v[176:179], v[56:59]
buffer_store_dwordx4 v[36:39], v1, s[4:7], s12 offen offset:0 sc1
v_mfma_f32_16x16x32_bf16 v[56:59], a[112:115], v[192:195], v[56:59]
s_waitcnt lgkmcnt(4)
v_mfma_f32_16x16x32_bf16 v[56:59], a[116:119], v[208:211], v[56:59]
s_waitcnt lgkmcnt(2)
v_mfma_f32_16x16x32_bf16 v[56:59], a[120:123], v[224:227], v[56:59]
s_waitcnt lgkmcnt(0)
v_mfma_f32_16x16x32_bf16 v[56:59], a[124:127], v[240:243], v[56:59]
v_mfma_f32_16x16x32_bf16 v[60:63], a[96:99], v[132:135], 0
v_mfma_f32_16x16x32_bf16 v[60:63], a[100:103], v[148:151], v[60:63]
v_mfma_f32_16x16x32_bf16 v[60:63], a[104:107], v[164:167], v[60:63]
v_mfma_f32_16x16x32_bf16 v[60:63], a[108:111], v[180:183], v[60:63]
v_mfma_f32_16x16x32_bf16 v[60:63], a[112:115], v[196:199], v[60:63]
buffer_load_dword v18, v19, s[4:7], s33 offen offset:0 sc1
v_mfma_f32_16x16x32_bf16 v[60:63], a[116:119], v[212:215], v[60:63]
v_mfma_f32_16x16x32_bf16 v[60:63], a[120:123], v[228:231], v[60:63]
v_mfma_f32_16x16x32_bf16 v[60:63], a[124:127], v[244:247], v[60:63]
v_mul_f32 v48, v48, v24
v_mul_f32 v49, v49, v24
v_mul_f32 v50, v50, v24
v_mul_f32 v51, v51, v24
v_mul_f32 v56, v56, v24
v_mul_f32 v57, v57, v24
v_mul_f32 v58, v58, v24
v_mul_f32 v59, v59, v24
v_cvt_pk_bf16_f32 v48, v48, v49
v_cvt_pk_bf16_f32 v49, v50, v51
v_cvt_pk_bf16_f32 v50, v56, v57
v_cvt_pk_bf16_f32 v51, v58, v59
buffer_store_dwordx4 v[48:51], v1, s[4:7], s8 offen offset:1024 sc1
v_mul_f32 v52, v52, v25
v_mul_f32 v53, v53, v25
v_mul_f32 v54, v54, v25
v_mul_f32 v55, v55, v25
v_mul_f32 v60, v60, v25
v_mul_f32 v61, v61, v25
v_mul_f32 v62, v62, v25
v_mul_f32 v63, v63, v25
v_cvt_pk_bf16_f32 v52, v52, v53
v_cvt_pk_bf16_f32 v53, v54, v55
v_cvt_pk_bf16_f32 v54, v60, v61
v_cvt_pk_bf16_f32 v55, v62, v63
buffer_store_dwordx4 v[52:55], v1, s[4:7], s12 offen offset:1024 sc1
s_and_b32 s22, s2, 224
s_cmp_eq_u32 s22, 224
s_cbranch_scc1 M_final
s_waitcnt vmcnt(0)
s_barrier
buffer_store_dword v6, v5, s[4:7], s35 offen sc1
s_bitcmp1_b32 s79, 4
s_cbranch_scc1 M_rA
v_cmp_gt_u32 vcc, 1, v18
s_cbranch_vccnz M_rslow
M_rjoin:
buffer_load_dwordx4 v[128:131], v1, s[4:7], s26 offen sc1
s_add_u32 s26, s26, 14336
buffer_load_dwordx4 v[132:135], v1, s[4:7], s26 offen sc1
s_add_u32 s26, s26, 14336
buffer_load_dwordx4 v[136:139], v1, s[4:7], s26 offen sc1
s_add_u32 s26, s26, 14336
buffer_load_dwordx4 v[140:143], v1, s[4:7], s26 offen sc1
s_add_u32 s26, s26, 14336
buffer_load_dwordx4 v[144:147], v1, s[4:7], s26 offen sc1
s_add_u32 s26, s26, 14336
buffer_load_dwordx4 v[148:151], v1, s[4:7], s26 offen sc1
s_add_u32 s26, s26, 14336
buffer_load_dwordx4 v[152:155], v1, s[4:7], s26 offen sc1
s_add_u32 s26, s26, 14336
buffer_load_dwordx4 v[156:159], v1, s[4:7], s26 offen sc1
s_add_u32 s26, s26, 14336
buffer_load_dwordx4 v[160:163], v1, s[4:7], s26 offen sc1
s_add_u32 s26, s26, 14336
buffer_load_dwordx4 v[164:167], v1, s[4:7], s26 offen sc1
s_add_u32 s26, s26, 14336
buffer_load_dwordx4 v[168:171], v1, s[4:7], s26 offen sc1
s_add_u32 s26, s26, 14336
buffer_load_dwordx4 v[172:175], v1, s[4:7], s26 offen sc1
s_add_u32 s26, s26, 14336
buffer_load_dwordx4 v[176:179], v1, s[4:7], s26 offen sc1
s_add_u32 s26, s26, 14336
buffer_load_dwordx4 v[180:183], v1, s[4:7], s26 offen sc1
s_add_u32 s26, s26, 14336
buffer_load_dwordx4 v[184:187], v1, s[4:7], s26 offen sc1
s_add_u32 s26, s26, 14336
buffer_load_dwordx4 v[188:191], v1, s[4:7], s26 offen sc1
Lp_9201:
buffer_load_dword v18, v19, s[4:7], s33 offen offset:2048 sc1
s_waitcnt vmcnt(0)
v_cmp_gt_u32 vcc, 1, v18
s_cbranch_vccz Lpd_9202
s_sleep 8
s_sub_u32 s101, s101, 1
s_cbranch_scc0 Lp_9201
s_mov_b32 s101, 0
Lpd_9202:
s_sub_u32 s26, s26, 207872
buffer_load_dwordx4 v[192:195], v1, s[4:7], s26 offen sc1
s_add_u32 s26, s26, 14336
buffer_load_dwordx4 v[196:199], v1, s[4:7], s26 offen sc1
s_add_u32 s26, s26, 14336
buffer_load_dwordx4 v[200:203], v1, s[4:7], s26 offen sc1
s_add_u32 s26, s26, 14336
buffer_load_dwordx4 v[204:207], v1, s[4:7], s26 offen sc1
s_add_u32 s26, s26, 14336
buffer_load_dwordx4 v[208:211], v1, s[4:7], s26 offen sc1
s_add_u32 s26, s26, 14336
buffer_load_dwordx4 v[212:215], v1, s[4:7], s26 offen sc1
s_add_u32 s26, s26, 14336
buffer_load_dwordx4 v[216:219], v1, s[4:7], s26 offen sc1
s_add_u32 s26, s26, 14336
buffer_load_dwordx4 v[220:223], v1, s[4:7], s26 offen sc1
s_add_u32 s26, s26, 14336
buffer_load_dwordx4 v[224:227], v1, s[4:7], s26 offen sc1
s_add_u32 s26, s26, 14336
buffer_load_dwordx4 v[228:231], v1, s[4:7], s26 offen sc1
s_add_u32 s26, s26, 14336
buffer_load_dwordx4 v[232:235], v1, s[4:7], s26 offen sc1
s_add_u32 s26, s26, 14336
buffer_load_dwordx4 v[236:239], v1, s[4:7], s26 offen sc1
s_add_u32 s26, s26, 14336
buffer_load_dwordx4 v[240:243], v1, s[4:7], s26 offen sc1
s_add_u32 s26, s26, 14336
buffer_load_dwordx4 v[244:247], v1, s[4:7], s26 offen sc1
s_add_u32 s26, s26, 14336
buffer_load_dwordx4 v[248:251], v1, s[4:7], s26 offen sc1
s_add_u32 s26, s26, 14336
buffer_load_dwordx4 v[252:255], v1, s[4:7], s26 offen sc1
v_lshlrev_b32 v96, 16, v128
v_and_b32 v97, 0xffff0000, v128
v_lshlrev_b32 v98, 16, v129
v_and_b32 v99, 0xffff0000, v129
v_lshlrev_b32 v100, 16, v130
v_and_b32 v101, 0xffff0000, v130
v_lshlrev_b32 v102, 16, v131
v_and_b32 v103, 0xffff0000, v131
v_lshlrev_b32 v10, 16, v132
v_and_b32 v11, 0xffff0000, v132
v_lshlrev_b32 v12, 16, v133
v_and_b32 v13, 0xffff0000, v133
v_lshlrev_b32 v14, 16, v134
v_and_b32 v15, 0xffff0000, v134
v_lshlrev_b32 v16, 16, v135
v_and_b32 v17, 0xffff0000, v135
v_pk_add_f32 v[96:97], v[96:97], v[10:11]
v_pk_add_f32 v[98:99], v[98:99], v[12:13]
v_pk_add_f32 v[100:101], v[100:101], v[14:15]
v_pk_add_f32 v[102:103], v[102:103], v[16:17]
v_lshlrev_b32 v10, 16, v136
v_and_b32 v11, 0xffff0000, v136
v_lshlrev_b32 v12, 16, v137
v_and_b32 v13, 0xffff0000, v137
v_lshlrev_b32 v14, 16, v138
v_and_b32 v15, 0xffff0000, v138
v_lshlrev_b32 v16, 16, v139
v_and_b32 v17, 0xffff0000, v139
v_pk_add_f32 v[96:97], v[96:97], v[10:11]
v_pk_add_f32 v[98:99], v[98:99], v[12:13]
v_pk_add_f32 v[100:101], v[100:101], v[14:15]
v_pk_add_f32 v[102:103], v[102:103], v[16:17]
v_lshlrev_b32 v10, 16, v140
v_and_b32 v11, 0xffff0000, v140
v_lshlrev_b32 v12, 16, v141
v_and_b32 v13, 0xffff0000, v141
v_lshlrev_b32 v14, 16, v142
v_and_b32 v15, 0xffff0000, v142
v_lshlrev_b32 v16, 16, v143
v_and_b32 v17, 0xffff0000, v143
v_pk_add_f32 v[96:97], v[96:97], v[10:11]
v_pk_add_f32 v[98:99], v[98:99], v[12:13]
v_pk_add_f32 v[100:101], v[100:101], v[14:15]
v_pk_add_f32 v[102:103], v[102:103], v[16:17]
v_lshlrev_b32 v10, 16, v144
v_and_b32 v11, 0xffff0000, v144
v_lshlrev_b32 v12, 16, v145
v_and_b32 v13, 0xffff0000, v145
v_lshlrev_b32 v14, 16, v146
v_and_b32 v15, 0xffff0000, v146
v_lshlrev_b32 v16, 16, v147
v_and_b32 v17, 0xffff0000, v147
v_pk_add_f32 v[96:97], v[96:97], v[10:11]
v_pk_add_f32 v[98:99], v[98:99], v[12:13]
v_pk_add_f32 v[100:101], v[100:101], v[14:15]
v_pk_add_f32 v[102:103], v[102:103], v[16:17]
v_lshlrev_b32 v10, 16, v148
v_and_b32 v11, 0xffff0000, v148
v_lshlrev_b32 v12, 16, v149
v_and_b32 v13, 0xffff0000, v149
v_lshlrev_b32 v14, 16, v150
v_and_b32 v15, 0xffff0000, v150
v_lshlrev_b32 v16, 16, v151
v_and_b32 v17, 0xffff0000, v151
v_pk_add_f32 v[96:97], v[96:97], v[10:11]
v_pk_add_f32 v[98:99], v[98:99], v[12:13]
v_pk_add_f32 v[100:101], v[100:101], v[14:15]
v_pk_add_f32 v[102:103], v[102:103], v[16:17]
v_lshlrev_b32 v10, 16, v152
v_and_b32 v11, 0xffff0000, v152
v_lshlrev_b32 v12, 16, v153
v_and_b32 v13, 0xffff0000, v153
v_lshlrev_b32 v14, 16, v154
v_and_b32 v15, 0xffff0000, v154
v_lshlrev_b32 v16, 16, v155
v_and_b32 v17, 0xffff0000, v155
v_pk_add_f32 v[96:97], v[96:97], v[10:11]
v_pk_add_f32 v[98:99], v[98:99], v[12:13]
v_pk_add_f32 v[100:101], v[100:101], v[14:15]
v_pk_add_f32 v[102:103], v[102:103], v[16:17]
v_lshlrev_b32 v10, 16, v156
v_and_b32 v11, 0xffff0000, v156
v_lshlrev_b32 v12, 16, v157
v_and_b32 v13, 0xffff0000, v157
v_lshlrev_b32 v14, 16, v158
v_and_b32 v15, 0xffff0000, v158
v_lshlrev_b32 v16, 16, v159
v_and_b32 v17, 0xffff0000, v159
v_pk_add_f32 v[96:97], v[96:97], v[10:11]
v_pk_add_f32 v[98:99], v[98:99], v[12:13]
v_pk_add_f32 v[100:101], v[100:101], v[14:15]
v_pk_add_f32 v[102:103], v[102:103], v[16:17]
v_lshlrev_b32 v10, 16, v160
v_and_b32 v11, 0xffff0000, v160
v_lshlrev_b32 v12, 16, v161
v_and_b32 v13, 0xffff0000, v161
v_lshlrev_b32 v14, 16, v162
v_and_b32 v15, 0xffff0000, v162
v_lshlrev_b32 v16, 16, v163
v_and_b32 v17, 0xffff0000, v163
v_pk_add_f32 v[96:97], v[96:97], v[10:11]
v_pk_add_f32 v[98:99], v[98:99], v[12:13]
v_pk_add_f32 v[100:101], v[100:101], v[14:15]
v_pk_add_f32 v[102:103], v[102:103], v[16:17]
v_lshlrev_b32 v10, 16, v164
v_and_b32 v11, 0xffff0000, v164
v_lshlrev_b32 v12, 16, v165
v_and_b32 v13, 0xffff0000, v165
v_lshlrev_b32 v14, 16, v166
v_and_b32 v15, 0xffff0000, v166
v_lshlrev_b32 v16, 16, v167
v_and_b32 v17, 0xffff0000, v167
v_pk_add_f32 v[96:97], v[96:97], v[10:11]
v_pk_add_f32 v[98:99], v[98:99], v[12:13]
v_pk_add_f32 v[100:101], v[100:101], v[14:15]
v_pk_add_f32 v[102:103], v[102:103], v[16:17]
v_lshlrev_b32 v10, 16, v168
v_and_b32 v11, 0xffff0000, v168
v_lshlrev_b32 v12, 16, v169
v_and_b32 v13, 0xffff0000, v169
v_lshlrev_b32 v14, 16, v170
v_and_b32 v15, 0xffff0000, v170
v_lshlrev_b32 v16, 16, v171
v_and_b32 v17, 0xffff0000, v171
v_pk_add_f32 v[96:97], v[96:97], v[10:11]
v_pk_add_f32 v[98:99], v[98:99], v[12:13]
v_pk_add_f32 v[100:101], v[100:101], v[14:15]
v_pk_add_f32 v[102:103], v[102:103], v[16:17]
v_lshlrev_b32 v10, 16, v172
v_and_b32 v11, 0xffff0000, v172
v_lshlrev_b32 v12, 16, v173
v_and_b32 v13, 0xffff0000, v173
v_lshlrev_b32 v14, 16, v174
v_and_b32 v15, 0xffff0000, v174
v_lshlrev_b32 v16, 16, v175
v_and_b32 v17, 0xffff0000, v175
v_pk_add_f32 v[96:97], v[96:97], v[10:11]
v_pk_add_f32 v[98:99], v[98:99], v[12:13]
v_pk_add_f32 v[100:101], v[100:101], v[14:15]
v_pk_add_f32 v[102:103], v[102:103], v[16:17]
v_lshlrev_b32 v10, 16, v176
v_and_b32 v11, 0xffff0000, v176
v_lshlrev_b32 v12, 16, v177
v_and_b32 v13, 0xffff0000, v177
v_lshlrev_b32 v14, 16, v178
v_and_b32 v15, 0xffff0000, v178
v_lshlrev_b32 v16, 16, v179
v_and_b32 v17, 0xffff0000, v179
v_pk_add_f32 v[96:97], v[96:97], v[10:11]
v_pk_add_f32 v[98:99], v[98:99], v[12:13]
v_pk_add_f32 v[100:101], v[100:101], v[14:15]
v_pk_add_f32 v[102:103], v[102:103], v[16:17]
v_lshlrev_b32 v10, 16, v180
v_and_b32 v11, 0xffff0000, v180
v_lshlrev_b32 v12, 16, v181
v_and_b32 v13, 0xffff0000, v181
v_lshlrev_b32 v14, 16, v182
v_and_b32 v15, 0xffff0000, v182
v_lshlrev_b32 v16, 16, v183
v_and_b32 v17, 0xffff0000, v183
v_pk_add_f32 v[96:97], v[96:97], v[10:11]
v_pk_add_f32 v[98:99], v[98:99], v[12:13]
v_pk_add_f32 v[100:101], v[100:101], v[14:15]
v_pk_add_f32 v[102:103], v[102:103], v[16:17]
v_lshlrev_b32 v10, 16, v184
v_and_b32 v11, 0xffff0000, v184
v_lshlrev_b32 v12, 16, v185
v_and_b32 v13, 0xffff0000, v185
v_lshlrev_b32 v14, 16, v186
v_and_b32 v15, 0xffff0000, v186
v_lshlrev_b32 v16, 16, v187
v_and_b32 v17, 0xffff0000, v187
v_pk_add_f32 v[96:97], v[96:97], v[10:11]
v_pk_add_f32 v[98:99], v[98:99], v[12:13]
v_pk_add_f32 v[100:101], v[100:101], v[14:15]
v_pk_add_f32 v[102:103], v[102:103], v[16:17]
v_lshlrev_b32 v10, 16, v188
v_and_b32 v11, 0xffff0000, v188
v_lshlrev_b32 v12, 16, v189
v_and_b32 v13, 0xffff0000, v189
v_lshlrev_b32 v14, 16, v190
v_and_b32 v15, 0xffff0000, v190
v_lshlrev_b32 v16, 16, v191
v_and_b32 v17, 0xffff0000, v191
v_pk_add_f32 v[96:97], v[96:97], v[10:11]
v_pk_add_f32 v[98:99], v[98:99], v[12:13]
v_pk_add_f32 v[100:101], v[100:101], v[14:15]
v_pk_add_f32 v[102:103], v[102:103], v[16:17]
v_cvt_pk_bf16_f32 v96, v96, v97
v_cvt_pk_bf16_f32 v97, v98, v99
v_cvt_pk_bf16_f32 v98, v100, v101
v_cvt_pk_bf16_f32 v99, v102, v103
buffer_store_dwordx2 v[96:97], v21, s[40:43], s25 offen offset:896
buffer_store_dwordx2 v[98:99], v21, s[40:43], s25 offen offset:928
s_waitcnt vmcnt(17)
v_lshlrev_b32 v104, 16, v192
v_and_b32 v105, 0xffff0000, v192
v_lshlrev_b32 v106, 16, v193
v_and_b32 v107, 0xffff0000, v193
v_lshlrev_b32 v108, 16, v194
v_and_b32 v109, 0xffff0000, v194
v_lshlrev_b32 v110, 16, v195
v_and_b32 v111, 0xffff0000, v195
s_waitcnt vmcnt(16)
v_lshlrev_b32 v10, 16, v196
v_and_b32 v11, 0xffff0000, v196
v_lshlrev_b32 v12, 16, v197
v_and_b32 v13, 0xffff0000, v197
v_lshlrev_b32 v14, 16, v198
v_and_b32 v15, 0xffff0000, v198
v_lshlrev_b32 v16, 16, v199
v_and_b32 v17, 0xffff0000, v199
v_pk_add_f32 v[104:105], v[104:105], v[10:11]
v_pk_add_f32 v[106:107], v[106:107], v[12:13]
v_pk_add_f32 v[108:109], v[108:109], v[14:15]
v_pk_add_f32 v[110:111], v[110:111], v[16:17]
s_waitcnt vmcnt(15)
v_lshlrev_b32 v10, 16, v200
v_and_b32 v11, 0xffff0000, v200
v_lshlrev_b32 v12, 16, v201
v_and_b32 v13, 0xffff0000, v201
v_lshlrev_b32 v14, 16, v202
v_and_b32 v15, 0xffff0000, v202
v_lshlrev_b32 v16, 16, v203
v_and_b32 v17, 0xffff0000, v203
v_pk_add_f32 v[104:105], v[104:105], v[10:11]
PAD_17:
s_cbranch_execz M_tret
v_pk_add_f32 v[106:107], v[106:107], v[12:13]
v_pk_add_f32 v[108:109], v[108:109], v[14:15]
v_pk_add_f32 v[110:111], v[110:111], v[16:17]
s_waitcnt vmcnt(14)
v_lshlrev_b32 v10, 16, v204
v_and_b32 v11, 0xffff0000, v204
v_lshlrev_b32 v12, 16, v205
v_and_b32 v13, 0xffff0000, v205
v_lshlrev_b32 v14, 16, v206
v_and_b32 v15, 0xffff0000, v206
v_lshlrev_b32 v16, 16, v207
v_and_b32 v17, 0xffff0000, v207
v_pk_add_f32 v[104:105], v[104:105], v[10:11]
v_pk_add_f32 v[106:107], v[106:107], v[12:13]
v_pk_add_f32 v[108:109], v[108:109], v[14:15]
v_pk_add_f32 v[110:111], v[110:111], v[16:17]
s_waitcnt vmcnt(13)
v_lshlrev_b32 v10, 16, v208
v_and_b32 v11, 0xffff0000, v208
v_lshlrev_b32 v12, 16, v209
v_and_b32 v13, 0xffff0000, v209
v_lshlrev_b32 v14, 16, v210
v_and_b32 v15, 0xffff0000, v210
v_lshlrev_b32 v16, 16, v211
v_and_b32 v17, 0xffff0000, v211
v_pk_add_f32 v[104:105], v[104:105], v[10:11]
v_pk_add_f32 v[106:107], v[106:107], v[12:13]
v_pk_add_f32 v[108:109], v[108:109], v[14:15]
v_pk_add_f32 v[110:111], v[110:111], v[16:17]
s_waitcnt vmcnt(12)
v_lshlrev_b32 v10, 16, v212
v_and_b32 v11, 0xffff0000, v212
v_lshlrev_b32 v12, 16, v213
v_and_b32 v13, 0xffff0000, v213
v_lshlrev_b32 v14, 16, v214
v_and_b32 v15, 0xffff0000, v214
v_lshlrev_b32 v16, 16, v215
v_and_b32 v17, 0xffff0000, v215
v_pk_add_f32 v[104:105], v[104:105], v[10:11]
v_pk_add_f32 v[106:107], v[106:107], v[12:13]
v_pk_add_f32 v[108:109], v[108:109], v[14:15]
v_pk_add_f32 v[110:111], v[110:111], v[16:17]
s_waitcnt vmcnt(11)
v_lshlrev_b32 v10, 16, v216
v_and_b32 v11, 0xffff0000, v216
v_lshlrev_b32 v12, 16, v217
v_and_b32 v13, 0xffff0000, v217
v_lshlrev_b32 v14, 16, v218
v_and_b32 v15, 0xffff0000, v218
v_lshlrev_b32 v16, 16, v219
v_and_b32 v17, 0xffff0000, v219
v_pk_add_f32 v[104:105], v[104:105], v[10:11]
v_pk_add_f32 v[106:107], v[106:107], v[12:13]
v_pk_add_f32 v[108:109], v[108:109], v[14:15]
v_pk_add_f32 v[110:111], v[110:111], v[16:17]
s_waitcnt vmcnt(10)
v_lshlrev_b32 v10, 16, v220
v_and_b32 v11, 0xffff0000, v220
v_lshlrev_b32 v12, 16, v221
v_and_b32 v13, 0xffff0000, v221
v_lshlrev_b32 v14, 16, v222
v_and_b32 v15, 0xffff0000, v222
v_lshlrev_b32 v16, 16, v223
v_and_b32 v17, 0xffff0000, v223
v_pk_add_f32 v[104:105], v[104:105], v[10:11]
v_pk_add_f32 v[106:107], v[106:107], v[12:13]
v_pk_add_f32 v[108:109], v[108:109], v[14:15]
v_pk_add_f32 v[110:111], v[110:111], v[16:17]
s_waitcnt vmcnt(9)
v_lshlrev_b32 v10, 16, v224
v_and_b32 v11, 0xffff0000, v224
v_lshlrev_b32 v12, 16, v225
v_and_b32 v13, 0xffff0000, v225
v_lshlrev_b32 v14, 16, v226
v_and_b32 v15, 0xffff0000, v226
v_lshlrev_b32 v16, 16, v227
v_and_b32 v17, 0xffff0000, v227
v_pk_add_f32 v[104:105], v[104:105], v[10:11]
v_pk_add_f32 v[106:107], v[106:107], v[12:13]
v_pk_add_f32 v[108:109], v[108:109], v[14:15]
v_pk_add_f32 v[110:111], v[110:111], v[16:17]
s_waitcnt vmcnt(8)
v_lshlrev_b32 v10, 16, v228
v_and_b32 v11, 0xffff0000, v228
v_lshlrev_b32 v12, 16, v229
v_and_b32 v13, 0xffff0000, v229
v_lshlrev_b32 v14, 16, v230
v_and_b32 v15, 0xffff0000, v230
v_lshlrev_b32 v16, 16, v231
v_and_b32 v17, 0xffff0000, v231
v_pk_add_f32 v[104:105], v[104:105], v[10:11]
v_pk_add_f32 v[106:107], v[106:107], v[12:13]
v_pk_add_f32 v[108:109], v[108:109], v[14:15]
v_pk_add_f32 v[110:111], v[110:111], v[16:17]
s_waitcnt vmcnt(7)
v_lshlrev_b32 v10, 16, v232
v_and_b32 v11, 0xffff0000, v232
v_lshlrev_b32 v12, 16, v233
v_and_b32 v13, 0xffff0000, v233
v_lshlrev_b32 v14, 16, v234
v_and_b32 v15, 0xffff0000, v234
v_lshlrev_b32 v16, 16, v235
v_and_b32 v17, 0xffff0000, v235
v_pk_add_f32 v[104:105], v[104:105], v[10:11]
v_pk_add_f32 v[106:107], v[106:107], v[12:13]
v_pk_add_f32 v[108:109], v[108:109], v[14:15]
v_pk_add_f32 v[110:111], v[110:111], v[16:17]
s_waitcnt vmcnt(6)
v_lshlrev_b32 v10, 16, v236
v_and_b32 v11, 0xffff0000, v236
v_lshlrev_b32 v12, 16, v237
v_and_b32 v13, 0xffff0000, v237
v_lshlrev_b32 v14, 16, v238
v_and_b32 v15, 0xffff0000, v238
v_lshlrev_b32 v16, 16, v239
v_and_b32 v17, 0xffff0000, v239
v_pk_add_f32 v[104:105], v[104:105], v[10:11]
v_pk_add_f32 v[106:107], v[106:107], v[12:13]
v_pk_add_f32 v[108:109], v[108:109], v[14:15]
v_pk_add_f32 v[110:111], v[110:111], v[16:17]
s_waitcnt vmcnt(5)
v_lshlrev_b32 v10, 16, v240
v_and_b32 v11, 0xffff0000, v240
v_lshlrev_b32 v12, 16, v241
v_and_b32 v13, 0xffff0000, v241
v_lshlrev_b32 v14, 16, v242
v_and_b32 v15, 0xffff0000, v242
v_lshlrev_b32 v16, 16, v243
v_and_b32 v17, 0xffff0000, v243
v_pk_add_f32 v[104:105], v[104:105], v[10:11]
v_pk_add_f32 v[106:107], v[106:107], v[12:13]
v_pk_add_f32 v[108:109], v[108:109], v[14:15]
v_pk_add_f32 v[110:111], v[110:111], v[16:17]
s_waitcnt vmcnt(4)
v_lshlrev_b32 v10, 16, v244
v_and_b32 v11, 0xffff0000, v244
v_lshlrev_b32 v12, 16, v245
v_and_b32 v13, 0xffff0000, v245
v_lshlrev_b32 v14, 16, v246
v_and_b32 v15, 0xffff0000, v246
v_lshlrev_b32 v16, 16, v247
v_and_b32 v17, 0xffff0000, v247
v_pk_add_f32 v[104:105], v[104:105], v[10:11]
v_pk_add_f32 v[106:107], v[106:107], v[12:13]
v_pk_add_f32 v[108:109], v[108:109], v[14:15]
v_pk_add_f32 v[110:111], v[110:111], v[16:17]
s_waitcnt vmcnt(3)
v_lshlrev_b32 v10, 16, v248
v_and_b32 v11, 0xffff0000, v248
v_lshlrev_b32 v12, 16, v249
v_and_b32 v13, 0xffff0000, v249
v_lshlrev_b32 v14, 16, v250
v_and_b32 v15, 0xffff0000, v250
v_lshlrev_b32 v16, 16, v251
v_and_b32 v17, 0xffff0000, v251
v_pk_add_f32 v[104:105], v[104:105], v[10:11]
v_pk_add_f32 v[106:107], v[106:107], v[12:13]
v_pk_add_f32 v[108:109], v[108:109], v[14:15]
v_pk_add_f32 v[110:111], v[110:111], v[16:17]
s_waitcnt vmcnt(2)
v_lshlrev_b32 v10, 16, v252
v_and_b32 v11, 0xffff0000, v252
v_lshlrev_b32 v12, 16, v253
v_and_b32 v13, 0xffff0000, v253
v_lshlrev_b32 v14, 16, v254
v_and_b32 v15, 0xffff0000, v254
v_lshlrev_b32 v16, 16, v255
v_and_b32 v17, 0xffff0000, v255
v_pk_add_f32 v[104:105], v[104:105], v[10:11]
v_pk_add_f32 v[106:107], v[106:107], v[12:13]
v_pk_add_f32 v[108:109], v[108:109], v[14:15]
v_pk_add_f32 v[110:111], v[110:111], v[16:17]
v_cvt_pk_bf16_f32 v104, v104, v105
v_cvt_pk_bf16_f32 v105, v106, v107
v_cvt_pk_bf16_f32 v106, v108, v109
v_cvt_pk_bf16_f32 v107, v110, v111
buffer_store_dwordx2 v[104:105], v21, s[40:43], s25 offen offset:1344
buffer_store_dwordx2 v[106:107], v21, s[40:43], s25 offen offset:1376
s_add_u32 s25, s25, 1835008
s_add_u32 s26, s26, 14457856
s_add_u32 s33, s33, 1024
s_branch M_r1
PAD_18:
s_cbranch_execz M_tret
M_rA:
s_add_u32 s25, s25, 448
s_add_u32 s26, s26, 7168
s_add_u32 s33, s33, 2048
M_r1:
Lp_9203:
buffer_load_dword v18, v19, s[4:7], s33 offen offset:0 sc1
s_waitcnt vmcnt(0)
v_cmp_gt_u32 vcc, 1, v18
s_cbranch_vccz Lpd_9204
s_sleep 8
s_sub_u32 s101, s101, 1
s_cbranch_scc0 Lp_9203
s_mov_b32 s101, 0
Lpd_9204:
buffer_load_dwordx4 v[128:131], v1, s[4:7], s26 offen sc1
s_add_u32 s26, s26, 14336
buffer_load_dwordx4 v[132:135], v1, s[4:7], s26 offen sc1
s_add_u32 s26, s26, 14336
buffer_load_dwordx4 v[136:139], v1, s[4:7], s26 offen sc1
s_add_u32 s26, s26, 14336
buffer_load_dwordx4 v[140:143], v1, s[4:7], s26 offen sc1
s_add_u32 s26, s26, 14336
buffer_load_dwordx4 v[144:147], v1, s[4:7], s26 offen sc1
s_add_u32 s26, s26, 14336
buffer_load_dwordx4 v[148:151], v1, s[4:7], s26 offen sc1
s_add_u32 s26, s26, 14336
buffer_load_dwordx4 v[152:155], v1, s[4:7], s26 offen sc1
s_add_u32 s26, s26, 14336
buffer_load_dwordx4 v[156:159], v1, s[4:7], s26 offen sc1
s_add_u32 s26, s26, 14336
buffer_load_dwordx4 v[160:163], v1, s[4:7], s26 offen sc1
s_add_u32 s26, s26, 14336
buffer_load_dwordx4 v[164:167], v1, s[4:7], s26 offen sc1
s_add_u32 s26, s26, 14336
buffer_load_dwordx4 v[168:171], v1, s[4:7], s26 offen sc1
s_add_u32 s26, s26, 14336
buffer_load_dwordx4 v[172:175], v1, s[4:7], s26 offen sc1
s_add_u32 s26, s26, 14336
buffer_load_dwordx4 v[176:179], v1, s[4:7], s26 offen sc1
s_add_u32 s26, s26, 14336
buffer_load_dwordx4 v[180:183], v1, s[4:7], s26 offen sc1
s_add_u32 s26, s26, 14336
buffer_load_dwordx4 v[184:187], v1, s[4:7], s26 offen sc1
s_add_u32 s26, s26, 14336
buffer_load_dwordx4 v[188:191], v1, s[4:7], s26 offen sc1
s_waitcnt vmcnt(15)
v_lshlrev_b32 v96, 16, v128
v_and_b32 v97, 0xffff0000, v128
v_lshlrev_b32 v98, 16, v129
v_and_b32 v99, 0xffff0000, v129
v_lshlrev_b32 v100, 16, v130
v_and_b32 v101, 0xffff0000, v130
v_lshlrev_b32 v102, 16, v131
v_and_b32 v103, 0xffff0000, v131
s_waitcnt vmcnt(14)
v_lshlrev_b32 v10, 16, v132
v_and_b32 v11, 0xffff0000, v132
v_lshlrev_b32 v12, 16, v133
v_and_b32 v13, 0xffff0000, v133
v_lshlrev_b32 v14, 16, v134
v_and_b32 v15, 0xffff0000, v134
v_lshlrev_b32 v16, 16, v135
v_and_b32 v17, 0xffff0000, v135
v_pk_add_f32 v[96:97], v[96:97], v[10:11]
v_pk_add_f32 v[98:99], v[98:99], v[12:13]
v_pk_add_f32 v[100:101], v[100:101], v[14:15]
v_pk_add_f32 v[102:103], v[102:103], v[16:17]
s_waitcnt vmcnt(13)
v_lshlrev_b32 v10, 16, v136
v_and_b32 v11, 0xffff0000, v136
v_lshlrev_b32 v12, 16, v137
v_and_b32 v13, 0xffff0000, v137
v_lshlrev_b32 v14, 16, v138
v_and_b32 v15, 0xffff0000, v138
v_lshlrev_b32 v16, 16, v139
v_and_b32 v17, 0xffff0000, v139
v_pk_add_f32 v[96:97], v[96:97], v[10:11]
v_pk_add_f32 v[98:99], v[98:99], v[12:13]
v_pk_add_f32 v[100:101], v[100:101], v[14:15]
v_pk_add_f32 v[102:103], v[102:103], v[16:17]
s_waitcnt vmcnt(12)
v_lshlrev_b32 v10, 16, v140
v_and_b32 v11, 0xffff0000, v140
v_lshlrev_b32 v12, 16, v141
v_and_b32 v13, 0xffff0000, v141
v_lshlrev_b32 v14, 16, v142
v_and_b32 v15, 0xffff0000, v142
v_lshlrev_b32 v16, 16, v143
v_and_b32 v17, 0xffff0000, v143
v_pk_add_f32 v[96:97], v[96:97], v[10:11]
v_pk_add_f32 v[98:99], v[98:99], v[12:13]
v_pk_add_f32 v[100:101], v[100:101], v[14:15]
v_pk_add_f32 v[102:103], v[102:103], v[16:17]
s_waitcnt vmcnt(11)
v_lshlrev_b32 v10, 16, v144
v_and_b32 v11, 0xffff0000, v144
v_lshlrev_b32 v12, 16, v145
v_and_b32 v13, 0xffff0000, v145
v_lshlrev_b32 v14, 16, v146
v_and_b32 v15, 0xffff0000, v146
v_lshlrev_b32 v16, 16, v147
v_and_b32 v17, 0xffff0000, v147
v_pk_add_f32 v[96:97], v[96:97], v[10:11]
v_pk_add_f32 v[98:99], v[98:99], v[12:13]
v_pk_add_f32 v[100:101], v[100:101], v[14:15]
v_pk_add_f32 v[102:103], v[102:103], v[16:17]
s_waitcnt vmcnt(10)
v_lshlrev_b32 v10, 16, v148
v_and_b32 v11, 0xffff0000, v148
v_lshlrev_b32 v12, 16, v149
v_and_b32 v13, 0xffff0000, v149
v_lshlrev_b32 v14, 16, v150
v_and_b32 v15, 0xffff0000, v150
v_lshlrev_b32 v16, 16, v151
v_and_b32 v17, 0xffff0000, v151
v_pk_add_f32 v[96:97], v[96:97], v[10:11]
v_pk_add_f32 v[98:99], v[98:99], v[12:13]
v_pk_add_f32 v[100:101], v[100:101], v[14:15]
v_pk_add_f32 v[102:103], v[102:103], v[16:17]
s_waitcnt vmcnt(9)
v_lshlrev_b32 v10, 16, v152
v_and_b32 v11, 0xffff0000, v152
v_lshlrev_b32 v12, 16, v153
v_and_b32 v13, 0xffff0000, v153
v_lshlrev_b32 v14, 16, v154
v_and_b32 v15, 0xffff0000, v154
v_lshlrev_b32 v16, 16, v155
v_and_b32 v17, 0xffff0000, v155
v_pk_add_f32 v[96:97], v[96:97], v[10:11]
v_pk_add_f32 v[98:99], v[98:99], v[12:13]
v_pk_add_f32 v[100:101], v[100:101], v[14:15]
v_pk_add_f32 v[102:103], v[102:103], v[16:17]
s_waitcnt vmcnt(8)
v_lshlrev_b32 v10, 16, v156
v_and_b32 v11, 0xffff0000, v156
v_lshlrev_b32 v12, 16, v157
v_and_b32 v13, 0xffff0000, v157
v_lshlrev_b32 v14, 16, v158
v_and_b32 v15, 0xffff0000, v158
v_lshlrev_b32 v16, 16, v159
v_and_b32 v17, 0xffff0000, v159
v_pk_add_f32 v[96:97], v[96:97], v[10:11]
v_pk_add_f32 v[98:99], v[98:99], v[12:13]
v_pk_add_f32 v[100:101], v[100:101], v[14:15]
v_pk_add_f32 v[102:103], v[102:103], v[16:17]
s_waitcnt vmcnt(7)
v_lshlrev_b32 v10, 16, v160
v_and_b32 v11, 0xffff0000, v160
v_lshlrev_b32 v12, 16, v161
v_and_b32 v13, 0xffff0000, v161
v_lshlrev_b32 v14, 16, v162
v_and_b32 v15, 0xffff0000, v162
v_lshlrev_b32 v16, 16, v163
v_and_b32 v17, 0xffff0000, v163
v_pk_add_f32 v[96:97], v[96:97], v[10:11]
v_pk_add_f32 v[98:99], v[98:99], v[12:13]
v_pk_add_f32 v[100:101], v[100:101], v[14:15]
v_pk_add_f32 v[102:103], v[102:103], v[16:17]
s_waitcnt vmcnt(6)
v_lshlrev_b32 v10, 16, v164
v_and_b32 v11, 0xffff0000, v164
v_lshlrev_b32 v12, 16, v165
v_and_b32 v13, 0xffff0000, v165
v_lshlrev_b32 v14, 16, v166
v_and_b32 v15, 0xffff0000, v166
v_lshlrev_b32 v16, 16, v167
v_and_b32 v17, 0xffff0000, v167
v_pk_add_f32 v[96:97], v[96:97], v[10:11]
v_pk_add_f32 v[98:99], v[98:99], v[12:13]
v_pk_add_f32 v[100:101], v[100:101], v[14:15]
v_pk_add_f32 v[102:103], v[102:103], v[16:17]
s_waitcnt vmcnt(5)
v_lshlrev_b32 v10, 16, v168
v_and_b32 v11, 0xffff0000, v168
v_lshlrev_b32 v12, 16, v169
v_and_b32 v13, 0xffff0000, v169
v_lshlrev_b32 v14, 16, v170
v_and_b32 v15, 0xffff0000, v170
v_lshlrev_b32 v16, 16, v171
v_and_b32 v17, 0xffff0000, v171
v_pk_add_f32 v[96:97], v[96:97], v[10:11]
v_pk_add_f32 v[98:99], v[98:99], v[12:13]
v_pk_add_f32 v[100:101], v[100:101], v[14:15]
v_pk_add_f32 v[102:103], v[102:103], v[16:17]
s_waitcnt vmcnt(4)
v_lshlrev_b32 v10, 16, v172
v_and_b32 v11, 0xffff0000, v172
v_lshlrev_b32 v12, 16, v173
v_and_b32 v13, 0xffff0000, v173
v_lshlrev_b32 v14, 16, v174
v_and_b32 v15, 0xffff0000, v174
v_lshlrev_b32 v16, 16, v175
v_and_b32 v17, 0xffff0000, v175
v_pk_add_f32 v[96:97], v[96:97], v[10:11]
v_pk_add_f32 v[98:99], v[98:99], v[12:13]
v_pk_add_f32 v[100:101], v[100:101], v[14:15]
v_pk_add_f32 v[102:103], v[102:103], v[16:17]
s_waitcnt vmcnt(3)
v_lshlrev_b32 v10, 16, v176
v_and_b32 v11, 0xffff0000, v176
v_lshlrev_b32 v12, 16, v177
v_and_b32 v13, 0xffff0000, v177
v_lshlrev_b32 v14, 16, v178
v_and_b32 v15, 0xffff0000, v178
v_lshlrev_b32 v16, 16, v179
v_and_b32 v17, 0xffff0000, v179
v_pk_add_f32 v[96:97], v[96:97], v[10:11]
v_pk_add_f32 v[98:99], v[98:99], v[12:13]
v_pk_add_f32 v[100:101], v[100:101], v[14:15]
v_pk_add_f32 v[102:103], v[102:103], v[16:17]
s_waitcnt vmcnt(2)
v_lshlrev_b32 v10, 16, v180
v_and_b32 v11, 0xffff0000, v180
v_lshlrev_b32 v12, 16, v181
v_and_b32 v13, 0xffff0000, v181
v_lshlrev_b32 v14, 16, v182
v_and_b32 v15, 0xffff0000, v182
v_lshlrev_b32 v16, 16, v183
v_and_b32 v17, 0xffff0000, v183
v_pk_add_f32 v[96:97], v[96:97], v[10:11]
v_pk_add_f32 v[98:99], v[98:99], v[12:13]
v_pk_add_f32 v[100:101], v[100:101], v[14:15]
v_pk_add_f32 v[102:103], v[102:103], v[16:17]
s_waitcnt vmcnt(1)
v_lshlrev_b32 v10, 16, v184
v_and_b32 v11, 0xffff0000, v184
v_lshlrev_b32 v12, 16, v185
v_and_b32 v13, 0xffff0000, v185
v_lshlrev_b32 v14, 16, v186
v_and_b32 v15, 0xffff0000, v186
v_lshlrev_b32 v16, 16, v187
v_and_b32 v17, 0xffff0000, v187
v_pk_add_f32 v[96:97], v[96:97], v[10:11]
v_pk_add_f32 v[98:99], v[98:99], v[12:13]
v_pk_add_f32 v[100:101], v[100:101], v[14:15]
v_pk_add_f32 v[102:103], v[102:103], v[16:17]
s_waitcnt vmcnt(0)
v_lshlrev_b32 v10, 16, v188
v_and_b32 v11, 0xffff0000, v188
v_lshlrev_b32 v12, 16, v189
v_and_b32 v13, 0xffff0000, v189
v_lshlrev_b32 v14, 16, v190
v_and_b32 v15, 0xffff0000, v190
v_lshlrev_b32 v16, 16, v191
v_and_b32 v17, 0xffff0000, v191
v_pk_add_f32 v[96:97], v[96:97], v[10:11]
v_pk_add_f32 v[98:99], v[98:99], v[12:13]
v_pk_add_f32 v[100:101], v[100:101], v[14:15]
v_pk_add_f32 v[102:103], v[102:103], v[16:17]
v_cvt_pk_bf16_f32 v96, v96, v97
v_cvt_pk_bf16_f32 v97, v98, v99
v_cvt_pk_bf16_f32 v98, v100, v101
v_cvt_pk_bf16_f32 v99, v102, v103
buffer_store_dwordx2 v[96:97], v21, s[40:43], s25 offen offset:896
buffer_store_dwordx2 v[98:99], v21, s[40:43], s25 offen offset:928
M_fin:
s_endpgm
M_final:
PAD_19:
s_cbranch_execz M_tret
s_mov_b32 s8, s64
s_mov_b32 s9, s65
s_mov_b32 s10, 1835008
s_mov_b32 s11, 0x20000
s_mov_b32 s12, s88
s_mov_b32 s13, s89
s_mov_b32 s14, 3670016
s_mov_b32 s15, 0x20000
s_lshr_b32 s24, s2, 0
s_and_b32 s24, s24, 16
s_add_u32 s24, s24, s20
v_lshrrev_b32 v20, 4, v1
v_and_b32 v21, 15, v20
v_lshrrev_b32 v22, 4, v20
v_mul_u32_u24 v2, 896, v21
v_lshlrev_b32 v9, 1, v2
v_lshl_add_u32 v2, v22, 4, v2
v_lshl_add_u32 v9, v22, 4, v9
s_lshl_b32 s22, s24, 2
s_add_u32 s22, s22, s3
s_mul_i32 s25, s22, 14336
s_lshl_b32 s26, s25, 1
v_lshlrev_b32 v10, 5, v22
v_add3_u32 v10, v10, v21, 16
v_lshlrev_b32 v10, 2, v10
v_min_u32 v11, 380, v10
v_add_u32 v11, 512, v11
s_mov_b32 s27, 94384128
Lfp:
buffer_load_dword v3, v10, s[4:7], s27 offen sc1
buffer_load_dword v4, v11, s[4:7], s27 offen sc1
s_waitcnt vmcnt(0)
v_and_b32 v3, v3, v4
v_cmp_gt_u32 vcc, 1, v3
s_cbranch_vccz Lfpd
s_sleep 2
s_sub_u32 s101, s101, 1
s_cbranch_scc0 Lfp
s_mov_b32 s101, 0
Lfpd:
s_barrier
buffer_store_dword v6, v5, s[4:7], s35 offen sc1
Lfg:
v_lshrrev_b32 v3, 3, v20
v_and_b32 v4, 7, v20
v_lshlrev_b32 v4, 4, v4
v_lshl_add_u32 v3, v3, 12, v4
s_mul_i32 s27, s3, 458752
s_lshl_b32 s22, s24, 7
s_add_u32 s27, s27, s22
s_add_u32 s27, s27, 88080384
s_mul_i32 s28, s3, 14336
s_add_u32 m0, s28, 0
s_nop 0
buffer_load_dwordx4 v3, s[4:7], s27 offen sc1 lds
s_add_u32 s27, s27, 32768
s_add_u32 m0, s28, 1024
s_nop 0
buffer_load_dwordx4 v3, s[4:7], s27 offen sc1 lds
s_add_u32 s27, s27, 32768
s_add_u32 m0, s28, 2048
s_nop 0
buffer_load_dwordx4 v3, s[4:7], s27 offen sc1 lds
s_add_u32 s27, s27, 32768
s_add_u32 m0, s28, 3072
s_nop 0
buffer_load_dwordx4 v3, s[4:7], s27 offen sc1 lds
s_add_u32 s27, s27, 32768
s_add_u32 m0, s28, 4096
s_nop 0
buffer_load_dwordx4 v3, s[4:7], s27 offen sc1 lds
s_add_u32 s27, s27, 32768
s_add_u32 m0, s28, 5120
s_nop 0
buffer_load_dwordx4 v3, s[4:7], s27 offen sc1 lds
s_add_u32 s27, s27, 32768
s_add_u32 m0, s28, 6144
s_nop 0
buffer_load_dwordx4 v3, s[4:7], s27 offen sc1 lds
s_add_u32 s27, s27, 32768
s_add_u32 m0, s28, 7168
s_nop 0
buffer_load_dwordx4 v3, s[4:7], s27 offen sc1 lds
s_add_u32 s27, s27, 32768
s_add_u32 m0, s28, 8192
s_nop 0
buffer_load_dwordx4 v3, s[4:7], s27 offen sc1 lds
s_add_u32 s27, s27, 32768
s_add_u32 m0, s28, 9216
s_nop 0
buffer_load_dwordx4 v3, s[4:7], s27 offen sc1 lds
s_add_u32 s27, s27, 32768
s_add_u32 m0, s28, 10240
s_nop 0
buffer_load_dwordx4 v3, s[4:7], s27 offen sc1 lds
s_add_u32 s27, s27, 32768
s_add_u32 m0, s28, 11264
s_nop 0
buffer_load_dwordx4 v3, s[4:7], s27 offen sc1 lds
s_add_u32 s27, s27, 32768
s_add_u32 m0, s28, 12288
s_nop 0
buffer_load_dwordx4 v3, s[4:7], s27 offen sc1 lds
s_add_u32 s27, s27, 32768
s_add_u32 m0, s28, 13312
s_nop 0
buffer_load_dwordx4 v3, s[4:7], s27 offen sc1 lds
s_add_u32 s27, s27, 32768
buffer_load_dwordx4 v[160:163], v2, s[8:11], s25 offen offset:0
buffer_load_dwordx4 v[164:167], v2, s[8:11], s25 offen offset:64
buffer_load_dwordx4 v[168:171], v2, s[8:11], s25 offen offset:128
buffer_load_dwordx4 v[172:175], v2, s[8:11], s25 offen offset:192
buffer_load_dwordx4 v[176:179], v2, s[8:11], s25 offen offset:256
buffer_load_dwordx4 v[180:183], v2, s[8:11], s25 offen offset:320
buffer_load_dwordx4 v[184:187], v2, s[8:11], s25 offen offset:384
buffer_load_dwordx4 v[188:191], v2, s[8:11], s25 offen offset:448
buffer_load_dwordx4 v[192:195], v2, s[8:11], s25 offen offset:512
buffer_load_dwordx4 v[196:199], v2, s[8:11], s25 offen offset:576
buffer_load_dwordx4 v[200:203], v2, s[8:11], s25 offen offset:640
buffer_load_dwordx4 v[204:207], v2, s[8:11], s25 offen offset:704
buffer_load_dwordx4 v[208:211], v2, s[8:11], s25 offen offset:768
buffer_load_dwordx4 v[212:215], v2, s[8:11], s25 offen offset:832
v_lshrrev_b32 v3, 2, v21
v_lshl_add_u32 v3, v22, 3, v3
v_lshlrev_b32 v3, 7, v3
v_and_b32 v4, 3, v20
v_lshl_add_u32 v3, v4, 3, v3
s_lshl_b32 s22, s3, 5
v_add_u32 v3, s22, v3
s_waitcnt vmcnt(14)
s_barrier
ds_read_b64_tr_b16 v[96:97], v3 offset:0
ds_read_b64_tr_b16 v[98:99], v3 offset:512
ds_read_b64_tr_b16 v[100:101], v3 offset:4096
ds_read_b64_tr_b16 v[102:103], v3 offset:4608
ds_read_b64_tr_b16 v[104:105], v3 offset:8192
ds_read_b64_tr_b16 v[106:107], v3 offset:8704
ds_read_b64_tr_b16 v[108:109], v3 offset:12288
ds_read_b64_tr_b16 v[110:111], v3 offset:12800
ds_read_b64_tr_b16 v[112:113], v3 offset:16384
ds_read_b64_tr_b16 v[114:115], v3 offset:16896
ds_read_b64_tr_b16 v[116:117], v3 offset:20480
ds_read_b64_tr_b16 v[118:119], v3 offset:20992
ds_read_b64_tr_b16 v[120:121], v3 offset:24576
ds_read_b64_tr_b16 v[122:123], v3 offset:25088
s_waitcnt lgkmcnt(0)
ds_read_b64_tr_b16 v[124:125], v3 offset:28672
ds_read_b64_tr_b16 v[126:127], v3 offset:29184
ds_read_b64_tr_b16 v[128:129], v3 offset:32768
ds_read_b64_tr_b16 v[130:131], v3 offset:33280
ds_read_b64_tr_b16 v[132:133], v3 offset:36864
ds_read_b64_tr_b16 v[134:135], v3 offset:37376
ds_read_b64_tr_b16 v[136:137], v3 offset:40960
ds_read_b64_tr_b16 v[138:139], v3 offset:41472
ds_read_b64_tr_b16 v[140:141], v3 offset:45056
ds_read_b64_tr_b16 v[142:143], v3 offset:45568
ds_read_b64_tr_b16 v[144:145], v3 offset:49152
ds_read_b64_tr_b16 v[146:147], v3 offset:49664
ds_read_b64_tr_b16 v[148:149], v3 offset:53248
ds_read_b64_tr_b16 v[150:151], v3 offset:53760
s_waitcnt vmcnt(13)
v_lshlrev_b32 v10, 16, v160
v_and_b32 v11, 0xffff0000, v160
v_lshlrev_b32 v12, 16, v96
v_and_b32 v13, 0xffff0000, v96
v_pk_mul_f32 v[10:11], v[10:11], v[12:13]
v_cvt_pk_bf16_f32 v160, v10, v11
v_lshlrev_b32 v10, 16, v161
v_and_b32 v11, 0xffff0000, v161
v_lshlrev_b32 v12, 16, v97
v_and_b32 v13, 0xffff0000, v97
v_pk_mul_f32 v[10:11], v[10:11], v[12:13]
v_cvt_pk_bf16_f32 v161, v10, v11
v_lshlrev_b32 v10, 16, v162
v_and_b32 v11, 0xffff0000, v162
v_lshlrev_b32 v12, 16, v98
v_and_b32 v13, 0xffff0000, v98
v_pk_mul_f32 v[10:11], v[10:11], v[12:13]
v_cvt_pk_bf16_f32 v162, v10, v11
v_lshlrev_b32 v10, 16, v163
v_and_b32 v11, 0xffff0000, v163
v_lshlrev_b32 v12, 16, v99
v_and_b32 v13, 0xffff0000, v99
v_pk_mul_f32 v[10:11], v[10:11], v[12:13]
v_cvt_pk_bf16_f32 v163, v10, v11
buffer_store_dwordx4 v[160:163], v9, s[12:15], s26 offen offset:0
PAD_20:
s_cbranch_execz M_tret
s_waitcnt vmcnt(13)
v_lshlrev_b32 v10, 16, v164
v_and_b32 v11, 0xffff0000, v164
v_lshlrev_b32 v12, 16, v100
v_and_b32 v13, 0xffff0000, v100
v_pk_mul_f32 v[10:11], v[10:11], v[12:13]
v_cvt_pk_bf16_f32 v164, v10, v11
v_lshlrev_b32 v10, 16, v165
v_and_b32 v11, 0xffff0000, v165
v_lshlrev_b32 v12, 16, v101
v_and_b32 v13, 0xffff0000, v101
v_pk_mul_f32 v[10:11], v[10:11], v[12:13]
v_cvt_pk_bf16_f32 v165, v10, v11
v_lshlrev_b32 v10, 16, v166
v_and_b32 v11, 0xffff0000, v166
v_lshlrev_b32 v12, 16, v102
v_and_b32 v13, 0xffff0000, v102
v_pk_mul_f32 v[10:11], v[10:11], v[12:13]
v_cvt_pk_bf16_f32 v166, v10, v11
v_lshlrev_b32 v10, 16, v167
v_and_b32 v11, 0xffff0000, v167
v_lshlrev_b32 v12, 16, v103
v_and_b32 v13, 0xffff0000, v103
v_pk_mul_f32 v[10:11], v[10:11], v[12:13]
v_cvt_pk_bf16_f32 v167, v10, v11
buffer_store_dwordx4 v[164:167], v9, s[12:15], s26 offen offset:64
s_waitcnt vmcnt(13)
v_lshlrev_b32 v10, 16, v168
v_and_b32 v11, 0xffff0000, v168
v_lshlrev_b32 v12, 16, v104
v_and_b32 v13, 0xffff0000, v104
v_pk_mul_f32 v[10:11], v[10:11], v[12:13]
v_cvt_pk_bf16_f32 v168, v10, v11
v_lshlrev_b32 v10, 16, v169
v_and_b32 v11, 0xffff0000, v169
v_lshlrev_b32 v12, 16, v105
v_and_b32 v13, 0xffff0000, v105
v_pk_mul_f32 v[10:11], v[10:11], v[12:13]
v_cvt_pk_bf16_f32 v169, v10, v11
v_lshlrev_b32 v10, 16, v170
v_and_b32 v11, 0xffff0000, v170
v_lshlrev_b32 v12, 16, v106
v_and_b32 v13, 0xffff0000, v106
v_pk_mul_f32 v[10:11], v[10:11], v[12:13]
v_cvt_pk_bf16_f32 v170, v10, v11
v_lshlrev_b32 v10, 16, v171
v_and_b32 v11, 0xffff0000, v171
v_lshlrev_b32 v12, 16, v107
v_and_b32 v13, 0xffff0000, v107
v_pk_mul_f32 v[10:11], v[10:11], v[12:13]
v_cvt_pk_bf16_f32 v171, v10, v11
buffer_store_dwordx4 v[168:171], v9, s[12:15], s26 offen offset:128
s_waitcnt vmcnt(13)
v_lshlrev_b32 v10, 16, v172
v_and_b32 v11, 0xffff0000, v172
v_lshlrev_b32 v12, 16, v108
v_and_b32 v13, 0xffff0000, v108
v_pk_mul_f32 v[10:11], v[10:11], v[12:13]
v_cvt_pk_bf16_f32 v172, v10, v11
v_lshlrev_b32 v10, 16, v173
v_and_b32 v11, 0xffff0000, v173
v_lshlrev_b32 v12, 16, v109
v_and_b32 v13, 0xffff0000, v109
v_pk_mul_f32 v[10:11], v[10:11], v[12:13]
v_cvt_pk_bf16_f32 v173, v10, v11
v_lshlrev_b32 v10, 16, v174
v_and_b32 v11, 0xffff0000, v174
v_lshlrev_b32 v12, 16, v110
v_and_b32 v13, 0xffff0000, v110
v_pk_mul_f32 v[10:11], v[10:11], v[12:13]
v_cvt_pk_bf16_f32 v174, v10, v11
v_lshlrev_b32 v10, 16, v175
v_and_b32 v11, 0xffff0000, v175
v_lshlrev_b32 v12, 16, v111
v_and_b32 v13, 0xffff0000, v111
v_pk_mul_f32 v[10:11], v[10:11], v[12:13]
v_cvt_pk_bf16_f32 v175, v10, v11
buffer_store_dwordx4 v[172:175], v9, s[12:15], s26 offen offset:192
s_waitcnt vmcnt(13)
v_lshlrev_b32 v10, 16, v176
v_and_b32 v11, 0xffff0000, v176
v_lshlrev_b32 v12, 16, v112
v_and_b32 v13, 0xffff0000, v112
v_pk_mul_f32 v[10:11], v[10:11], v[12:13]
v_cvt_pk_bf16_f32 v176, v10, v11
v_lshlrev_b32 v10, 16, v177
v_and_b32 v11, 0xffff0000, v177
v_lshlrev_b32 v12, 16, v113
v_and_b32 v13, 0xffff0000, v113
v_pk_mul_f32 v[10:11], v[10:11], v[12:13]
v_cvt_pk_bf16_f32 v177, v10, v11
v_lshlrev_b32 v10, 16, v178
v_and_b32 v11, 0xffff0000, v178
v_lshlrev_b32 v12, 16, v114
v_and_b32 v13, 0xffff0000, v114
v_pk_mul_f32 v[10:11], v[10:11], v[12:13]
v_cvt_pk_bf16_f32 v178, v10, v11
v_lshlrev_b32 v10, 16, v179
v_and_b32 v11, 0xffff0000, v179
v_lshlrev_b32 v12, 16, v115
v_and_b32 v13, 0xffff0000, v115
v_pk_mul_f32 v[10:11], v[10:11], v[12:13]
v_cvt_pk_bf16_f32 v179, v10, v11
buffer_store_dwordx4 v[176:179], v9, s[12:15], s26 offen offset:256
s_waitcnt vmcnt(13)
v_lshlrev_b32 v10, 16, v180
v_and_b32 v11, 0xffff0000, v180
v_lshlrev_b32 v12, 16, v116
v_and_b32 v13, 0xffff0000, v116
v_pk_mul_f32 v[10:11], v[10:11], v[12:13]
v_cvt_pk_bf16_f32 v180, v10, v11
v_lshlrev_b32 v10, 16, v181
v_and_b32 v11, 0xffff0000, v181
v_lshlrev_b32 v12, 16, v117
v_and_b32 v13, 0xffff0000, v117
v_pk_mul_f32 v[10:11], v[10:11], v[12:13]
v_cvt_pk_bf16_f32 v181, v10, v11
v_lshlrev_b32 v10, 16, v182
v_and_b32 v11, 0xffff0000, v182
v_lshlrev_b32 v12, 16, v118
v_and_b32 v13, 0xffff0000, v118
v_pk_mul_f32 v[10:11], v[10:11], v[12:13]
v_cvt_pk_bf16_f32 v182, v10, v11
v_lshlrev_b32 v10, 16, v183
v_and_b32 v11, 0xffff0000, v183
v_lshlrev_b32 v12, 16, v119
v_and_b32 v13, 0xffff0000, v119
v_pk_mul_f32 v[10:11], v[10:11], v[12:13]
v_cvt_pk_bf16_f32 v183, v10, v11
buffer_store_dwordx4 v[180:183], v9, s[12:15], s26 offen offset:320
s_waitcnt vmcnt(13)
v_lshlrev_b32 v10, 16, v184
v_and_b32 v11, 0xffff0000, v184
v_lshlrev_b32 v12, 16, v120
v_and_b32 v13, 0xffff0000, v120
v_pk_mul_f32 v[10:11], v[10:11], v[12:13]
v_cvt_pk_bf16_f32 v184, v10, v11
v_lshlrev_b32 v10, 16, v185
v_and_b32 v11, 0xffff0000, v185
v_lshlrev_b32 v12, 16, v121
v_and_b32 v13, 0xffff0000, v121
v_pk_mul_f32 v[10:11], v[10:11], v[12:13]
v_cvt_pk_bf16_f32 v185, v10, v11
v_lshlrev_b32 v10, 16, v186
v_and_b32 v11, 0xffff0000, v186
v_lshlrev_b32 v12, 16, v122
v_and_b32 v13, 0xffff0000, v122
v_pk_mul_f32 v[10:11], v[10:11], v[12:13]
v_cvt_pk_bf16_f32 v186, v10, v11
v_lshlrev_b32 v10, 16, v187
v_and_b32 v11, 0xffff0000, v187
v_lshlrev_b32 v12, 16, v123
v_and_b32 v13, 0xffff0000, v123
v_pk_mul_f32 v[10:11], v[10:11], v[12:13]
v_cvt_pk_bf16_f32 v187, v10, v11
buffer_store_dwordx4 v[184:187], v9, s[12:15], s26 offen offset:384
s_waitcnt lgkmcnt(0)
s_waitcnt vmcnt(13)
v_lshlrev_b32 v10, 16, v188
v_and_b32 v11, 0xffff0000, v188
v_lshlrev_b32 v12, 16, v124
v_and_b32 v13, 0xffff0000, v124
v_pk_mul_f32 v[10:11], v[10:11], v[12:13]
v_cvt_pk_bf16_f32 v188, v10, v11
v_lshlrev_b32 v10, 16, v189
v_and_b32 v11, 0xffff0000, v189
v_lshlrev_b32 v12, 16, v125
v_and_b32 v13, 0xffff0000, v125
v_pk_mul_f32 v[10:11], v[10:11], v[12:13]
v_cvt_pk_bf16_f32 v189, v10, v11
v_lshlrev_b32 v10, 16, v190
v_and_b32 v11, 0xffff0000, v190
v_lshlrev_b32 v12, 16, v126
v_and_b32 v13, 0xffff0000, v126
v_pk_mul_f32 v[10:11], v[10:11], v[12:13]
v_cvt_pk_bf16_f32 v190, v10, v11
v_lshlrev_b32 v10, 16, v191
v_and_b32 v11, 0xffff0000, v191
v_lshlrev_b32 v12, 16, v127
v_and_b32 v13, 0xffff0000, v127
v_pk_mul_f32 v[10:11], v[10:11], v[12:13]
v_cvt_pk_bf16_f32 v191, v10, v11
buffer_store_dwordx4 v[188:191], v9, s[12:15], s26 offen offset:448
s_waitcnt vmcnt(13)
v_lshlrev_b32 v10, 16, v192
v_and_b32 v11, 0xffff0000, v192
v_lshlrev_b32 v12, 16, v128
v_and_b32 v13, 0xffff0000, v128
v_pk_mul_f32 v[10:11], v[10:11], v[12:13]
v_cvt_pk_bf16_f32 v192, v10, v11
v_lshlrev_b32 v10, 16, v193
v_and_b32 v11, 0xffff0000, v193
v_lshlrev_b32 v12, 16, v129
v_and_b32 v13, 0xffff0000, v129
v_pk_mul_f32 v[10:11], v[10:11], v[12:13]
v_cvt_pk_bf16_f32 v193, v10, v11
v_lshlrev_b32 v10, 16, v194
v_and_b32 v11, 0xffff0000, v194
v_lshlrev_b32 v12, 16, v130
v_and_b32 v13, 0xffff0000, v130
v_pk_mul_f32 v[10:11], v[10:11], v[12:13]
v_cvt_pk_bf16_f32 v194, v10, v11
v_lshlrev_b32 v10, 16, v195
v_and_b32 v11, 0xffff0000, v195
v_lshlrev_b32 v12, 16, v131
v_and_b32 v13, 0xffff0000, v131
v_pk_mul_f32 v[10:11], v[10:11], v[12:13]
v_cvt_pk_bf16_f32 v195, v10, v11
buffer_store_dwordx4 v[192:195], v9, s[12:15], s26 offen offset:512
s_waitcnt vmcnt(13)
v_lshlrev_b32 v10, 16, v196
v_and_b32 v11, 0xffff0000, v196
v_lshlrev_b32 v12, 16, v132
v_and_b32 v13, 0xffff0000, v132
v_pk_mul_f32 v[10:11], v[10:11], v[12:13]
v_cvt_pk_bf16_f32 v196, v10, v11
v_lshlrev_b32 v10, 16, v197
v_and_b32 v11, 0xffff0000, v197
v_lshlrev_b32 v12, 16, v133
v_and_b32 v13, 0xffff0000, v133
v_pk_mul_f32 v[10:11], v[10:11], v[12:13]
v_cvt_pk_bf16_f32 v197, v10, v11
v_lshlrev_b32 v10, 16, v198
v_and_b32 v11, 0xffff0000, v198
v_lshlrev_b32 v12, 16, v134
v_and_b32 v13, 0xffff0000, v134
v_pk_mul_f32 v[10:11], v[10:11], v[12:13]
v_cvt_pk_bf16_f32 v198, v10, v11
v_lshlrev_b32 v10, 16, v199
v_and_b32 v11, 0xffff0000, v199
v_lshlrev_b32 v12, 16, v135
v_and_b32 v13, 0xffff0000, v135
v_pk_mul_f32 v[10:11], v[10:11], v[12:13]
v_cvt_pk_bf16_f32 v199, v10, v11
buffer_store_dwordx4 v[196:199], v9, s[12:15], s26 offen offset:576
s_waitcnt vmcnt(13)
v_lshlrev_b32 v10, 16, v200
v_and_b32 v11, 0xffff0000, v200
v_lshlrev_b32 v12, 16, v136
v_and_b32 v13, 0xffff0000, v136
v_pk_mul_f32 v[10:11], v[10:11], v[12:13]
v_cvt_pk_bf16_f32 v200, v10, v11
v_lshlrev_b32 v10, 16, v201
v_and_b32 v11, 0xffff0000, v201
v_lshlrev_b32 v12, 16, v137
v_and_b32 v13, 0xffff0000, v137
v_pk_mul_f32 v[10:11], v[10:11], v[12:13]
v_cvt_pk_bf16_f32 v201, v10, v11
v_lshlrev_b32 v10, 16, v202
v_and_b32 v11, 0xffff0000, v202
v_lshlrev_b32 v12, 16, v138
v_and_b32 v13, 0xffff0000, v138
v_pk_mul_f32 v[10:11], v[10:11], v[12:13]
v_cvt_pk_bf16_f32 v202, v10, v11
v_lshlrev_b32 v10, 16, v203
v_and_b32 v11, 0xffff0000, v203
v_lshlrev_b32 v12, 16, v139
v_and_b32 v13, 0xffff0000, v139
v_pk_mul_f32 v[10:11], v[10:11], v[12:13]
v_cvt_pk_bf16_f32 v203, v10, v11
buffer_store_dwordx4 v[200:203], v9, s[12:15], s26 offen offset:640
s_waitcnt vmcnt(13)
v_lshlrev_b32 v10, 16, v204
v_and_b32 v11, 0xffff0000, v204
v_lshlrev_b32 v12, 16, v140
v_and_b32 v13, 0xffff0000, v140
v_pk_mul_f32 v[10:11], v[10:11], v[12:13]
v_cvt_pk_bf16_f32 v204, v10, v11
v_lshlrev_b32 v10, 16, v205
v_and_b32 v11, 0xffff0000, v205
v_lshlrev_b32 v12, 16, v141
v_and_b32 v13, 0xffff0000, v141
v_pk_mul_f32 v[10:11], v[10:11], v[12:13]
v_cvt_pk_bf16_f32 v205, v10, v11
v_lshlrev_b32 v10, 16, v206
v_and_b32 v11, 0xffff0000, v206
v_lshlrev_b32 v12, 16, v142
v_and_b32 v13, 0xffff0000, v142
v_pk_mul_f32 v[10:11], v[10:11], v[12:13]
v_cvt_pk_bf16_f32 v206, v10, v11
v_lshlrev_b32 v10, 16, v207
v_and_b32 v11, 0xffff0000, v207
v_lshlrev_b32 v12, 16, v143
v_and_b32 v13, 0xffff0000, v143
v_pk_mul_f32 v[10:11], v[10:11], v[12:13]
v_cvt_pk_bf16_f32 v207, v10, v11
buffer_store_dwordx4 v[204:207], v9, s[12:15], s26 offen offset:704
s_waitcnt vmcnt(13)
v_lshlrev_b32 v10, 16, v208
v_and_b32 v11, 0xffff0000, v208
v_lshlrev_b32 v12, 16, v144
v_and_b32 v13, 0xffff0000, v144
v_pk_mul_f32 v[10:11], v[10:11], v[12:13]
v_cvt_pk_bf16_f32 v208, v10, v11
v_lshlrev_b32 v10, 16, v209
v_and_b32 v11, 0xffff0000, v209
v_lshlrev_b32 v12, 16, v145
v_and_b32 v13, 0xffff0000, v145
v_pk_mul_f32 v[10:11], v[10:11], v[12:13]
v_cvt_pk_bf16_f32 v209, v10, v11
v_lshlrev_b32 v10, 16, v210
v_and_b32 v11, 0xffff0000, v210
v_lshlrev_b32 v12, 16, v146
v_and_b32 v13, 0xffff0000, v146
v_pk_mul_f32 v[10:11], v[10:11], v[12:13]
v_cvt_pk_bf16_f32 v210, v10, v11
v_lshlrev_b32 v10, 16, v211
v_and_b32 v11, 0xffff0000, v211
v_lshlrev_b32 v12, 16, v147
v_and_b32 v13, 0xffff0000, v147
v_pk_mul_f32 v[10:11], v[10:11], v[12:13]
v_cvt_pk_bf16_f32 v211, v10, v11
buffer_store_dwordx4 v[208:211], v9, s[12:15], s26 offen offset:768
s_waitcnt vmcnt(13)
v_lshlrev_b32 v10, 16, v212
v_and_b32 v11, 0xffff0000, v212
v_lshlrev_b32 v12, 16, v148
v_and_b32 v13, 0xffff0000, v148
v_pk_mul_f32 v[10:11], v[10:11], v[12:13]
v_cvt_pk_bf16_f32 v212, v10, v11
v_lshlrev_b32 v10, 16, v213
v_and_b32 v11, 0xffff0000, v213
v_lshlrev_b32 v12, 16, v149
v_and_b32 v13, 0xffff0000, v149
v_pk_mul_f32 v[10:11], v[10:11], v[12:13]
v_cvt_pk_bf16_f32 v213, v10, v11
v_lshlrev_b32 v10, 16, v214
v_and_b32 v11, 0xffff0000, v214
v_lshlrev_b32 v12, 16, v150
v_and_b32 v13, 0xffff0000, v150
v_pk_mul_f32 v[10:11], v[10:11], v[12:13]
v_cvt_pk_bf16_f32 v214, v10, v11
v_lshlrev_b32 v10, 16, v215
v_and_b32 v11, 0xffff0000, v215
v_lshlrev_b32 v12, 16, v151
v_and_b32 v13, 0xffff0000, v151
v_pk_mul_f32 v[10:11], v[10:11], v[12:13]
v_cvt_pk_bf16_f32 v215, v10, v11
buffer_store_dwordx4 v[212:215], v9, s[12:15], s26 offen offset:832
s_branch M_fin
M_fend:
M_rslow:
Lp_9251:
buffer_load_dword v18, v19, s[4:7], s33 offen offset:0 sc1
s_waitcnt vmcnt(0)
v_cmp_gt_u32 vcc, 1, v18
s_cbranch_vccz Lpd_9252
s_sleep 8
s_sub_u32 s101, s101, 1
s_cbranch_scc0 Lp_9251
s_mov_b32 s101, 0
Lpd_9252:
s_branch M_rjoin
PAD_21:
s_cbranch_execz PAD_25
M_V:
v_mfma_f32_16x16x32_bf16 v[32:35], a[0:3], a[128:131], 0
s_add_u32 m0, s29, 98304
ds_read_b64_tr_b16 a[136:137], v5 offset:0
v_mfma_f32_16x16x32_bf16 v[32:35], a[4:7], a[132:135], v[32:35]
s_mov_b32 s32, 1024
buffer_load_dwordx4 v16, s[12:15], s26 offen offset:0 lds
v_mfma_f32_16x16x32_bf16 v[36:39], a[8:11], a[128:131], 0
s_mov_b32 s33, 31744
ds_read_b64_tr_b16 a[138:139], v5 offset:2048
v_mfma_f32_16x16x32_bf16 v[36:39], a[12:15], a[132:135], v[36:39]
s_mov_b32 s34, 4294935552
v_mfma_f32_16x16x32_bf16 v[40:43], a[16:19], a[128:131], 0
s_mov_b32 s35, 4294935552
ds_read_b64_tr_b16 a[140:141], v5 offset:16384
v_mfma_f32_16x16x32_bf16 v[40:43], a[20:23], a[132:135], v[40:43]
s_mov_b32 s36, 4294935552
buffer_load_dwordx4 v17, s[12:15], s26 offen offset:1024 lds
v_mfma_f32_16x16x32_bf16 v[44:47], a[24:27], a[128:131], 0
s_mov_b32 s30, 8
ds_read_b64_tr_b16 a[142:143], v5 offset:18432
v_mfma_f32_16x16x32_bf16 v[44:47], a[28:31], a[132:135], v[44:47]
s_mov_b32 s82, 3221225472
v_mfma_f32_16x16x32_bf16 v[48:51], a[32:35], a[128:131], 0
s_mul_hi_u32 s38, s2, 613566757
v_mfma_f32_16x16x32_bf16 v[48:51], a[36:39], a[132:135], v[48:51]
s_mul_i32 s39, s38, 7
buffer_load_dwordx4 v18, s[12:15], s26 offen offset:2048 lds
v_mfma_f32_16x16x32_bf16 v[52:55], a[40:43], a[128:131], 0
s_sub_u32 s39, s2, s39
v_mov_b32 v246, 0
v_mov_b32 v229, 0
v_mfma_f32_16x16x32_bf16 v[52:55], a[44:47], a[132:135], v[52:55]
v_mov_b32 v231, 0
v_mfma_f32_16x16x32_bf16 v[56:59], a[48:51], a[128:131], 0
s_mov_b32 s60, s90
v_mfma_f32_16x16x32_bf16 v[56:59], a[52:55], a[132:135], v[56:59]
s_mov_b32 s61, s91
buffer_load_dwordx4 v19, s[12:15], s26 offen offset:3072 lds
v_mfma_f32_16x16x32_bf16 v[60:63], a[56:59], a[128:131], 0
s_add_u32 s26, s26, 524288
v_mfma_f32_16x16x32_bf16 v[60:63], a[60:63], a[132:135], v[60:63]
s_waitcnt lgkmcnt(0)
s_mov_b32 s62, 256
v_mfma_f32_16x16x32_bf16 v[64:67], a[0:3], a[136:139], 0
s_add_u32 m0, s29, 114688
ds_read_b64_tr_b16 a[128:129], v6 offset:0
v_mfma_f32_16x16x32_bf16 v[64:67], a[4:7], a[140:143], v[64:67]
s_mov_b32 s63, 0x20000
buffer_load_dwordx4 v16, s[12:15], s27 offen offset:0 lds
v_mfma_f32_16x16x32_bf16 v[68:71], a[8:11], a[136:139], 0
s_mul_hi_u32 s55, s2, 1431655766
ds_read_b64_tr_b16 a[130:131], v6 offset:2048
v_mfma_f32_16x16x32_bf16 v[68:71], a[12:15], a[140:143], v[68:71]
s_mul_i32 s55, s55, 3
v_mfma_f32_16x16x32_bf16 v[72:75], a[16:19], a[136:139], 0
s_sub_u32 s55, s2, s55
ds_read_b64_tr_b16 a[132:133], v6 offset:16384
v_mfma_f32_16x16x32_bf16 v[72:75], a[20:23], a[140:143], v[72:75]
s_add_u32 s55, s55, 5
buffer_load_dwordx4 v17, s[12:15], s27 offen offset:1024 lds
v_mfma_f32_16x16x32_bf16 v[76:79], a[24:27], a[136:139], 0
s_lshr_b32 s22, s2, 4
ds_read_b64_tr_b16 a[134:135], v6 offset:18432
v_mfma_f32_16x16x32_bf16 v[76:79], a[28:31], a[140:143], v[76:79]
s_lshl_b32 s23, s20, 5
v_mfma_f32_16x16x32_bf16 v[80:83], a[32:35], a[136:139], 0
s_add_u32 s23, s23, s22
v_mfma_f32_16x16x32_bf16 v[80:83], a[36:39], a[140:143], v[80:83]
s_lshl_b32 s23, s23, 2
buffer_load_dwordx4 v18, s[12:15], s27 offen offset:2048 lds
v_mfma_f32_16x16x32_bf16 v[84:87], a[40:43], a[136:139], 0
s_and_b32 s22, s2, 16
v_mfma_f32_16x16x32_bf16 v[84:87], a[44:47], a[140:143], v[84:87]
s_lshl_b32 s22, s22, 7
v_mfma_f32_16x16x32_bf16 v[88:91], a[48:51], a[136:139], 0
s_add_u32 s23, s23, s22
v_mov_b32 v28, 3221225472
v_writelane_b32 v28, s23, 0
v_mfma_f32_16x16x32_bf16 v[88:91], a[52:55], a[140:143], v[88:91]
s_add_u32 s56, s23, 16384
buffer_load_dwordx4 v19, s[12:15], s27 offen offset:3072 lds
v_mfma_f32_16x16x32_bf16 v[92:95], a[56:59], a[136:139], 0
s_add_u32 s27, s27, 524288
v_writelane_b32 v28, s56, 1
v_mfma_f32_16x16x32_bf16 v[92:95], a[60:63], a[140:143], v[92:95]
s_waitcnt lgkmcnt(0)
s_add_u32 s56, s23, 4096
v_writelane_b32 v28, s56, 2
v_mfma_f32_16x16x32_bf16 v[96:99], a[0:3], a[128:131], 0
s_add_u32 m0, s28, 0
ds_read_b64_tr_b16 a[136:137], v7 offset:0
v_mfma_f32_16x16x32_bf16 v[96:99], a[4:7], a[132:135], v[96:99]
s_sub_u32 s37, 15, s21
buffer_load_dwordx4 v12, s[8:11], s24 offen offset:0 lds
v_mfma_f32_16x16x32_bf16 v[100:103], a[8:11], a[128:131], 0
ds_read_b64_tr_b16 a[138:139], v7 offset:2048
v_mfma_f32_16x16x32_bf16 v[100:103], a[12:15], a[132:135], v[100:103]
v_mfma_f32_16x16x32_bf16 v[104:107], a[16:19], a[128:131], 0
ds_read_b64_tr_b16 a[140:141], v7 offset:16384
v_mfma_f32_16x16x32_bf16 v[104:107], a[20:23], a[132:135], v[104:107]
buffer_load_dwordx4 v13, s[8:11], s24 offen offset:1024 lds
v_mfma_f32_16x16x32_bf16 v[108:111], a[24:27], a[128:131], 0
ds_read_b64_tr_b16 a[142:143], v7 offset:18432
v_mfma_f32_16x16x32_bf16 v[108:111], a[28:31], a[132:135], v[108:111]
v_mfma_f32_16x16x32_bf16 v[112:115], a[32:35], a[128:131], 0
v_mfma_f32_16x16x32_bf16 v[112:115], a[36:39], a[132:135], v[112:115]
buffer_load_dwordx4 v14, s[8:11], s24 offen offset:2048 lds
v_mfma_f32_16x16x32_bf16 v[116:119], a[40:43], a[128:131], 0
v_mfma_f32_16x16x32_bf16 v[116:119], a[44:47], a[132:135], v[116:119]
v_mfma_f32_16x16x32_bf16 v[120:123], a[48:51], a[128:131], 0
v_mfma_f32_16x16x32_bf16 v[120:123], a[52:55], a[132:135], v[120:123]
buffer_load_dwordx4 v15, s[8:11], s24 offen offset:3072 lds
v_mfma_f32_16x16x32_bf16 v[124:127], a[56:59], a[128:131], 0
s_add_u32 s24, s24, 128
v_mfma_f32_16x16x32_bf16 v[124:127], a[60:63], a[132:135], v[124:127]
s_waitcnt vmcnt(12) lgkmcnt(0)
s_barrier
v_mfma_f32_16x16x32_bf16 v[128:131], a[0:3], a[136:139], 0
s_add_u32 m0, s28, 4096
ds_read_b64_tr_b16 a[128:129], v8 offset:0
v_mfma_f32_16x16x32_bf16 v[128:131], a[4:7], a[140:143], v[128:131]
buffer_load_dwordx4 v12, s[8:11], s25 offen offset:0 lds
v_mfma_f32_16x16x32_bf16 v[132:135], a[8:11], a[136:139], 0
ds_read_b64_tr_b16 a[130:131], v8 offset:2048
v_mfma_f32_16x16x32_bf16 v[132:135], a[12:15], a[140:143], v[132:135]
v_mfma_f32_16x16x32_bf16 v[136:139], a[16:19], a[136:139], 0
ds_read_b64_tr_b16 a[132:133], v8 offset:16384
v_mfma_f32_16x16x32_bf16 v[136:139], a[20:23], a[140:143], v[136:139]
buffer_load_dwordx4 v13, s[8:11], s25 offen offset:1024 lds
v_mfma_f32_16x16x32_bf16 v[140:143], a[24:27], a[136:139], 0
ds_read_b64_tr_b16 a[134:135], v8 offset:18432
v_mfma_f32_16x16x32_bf16 v[140:143], a[28:31], a[140:143], v[140:143]
v_mfma_f32_16x16x32_bf16 v[144:147], a[32:35], a[136:139], 0
ds_read_b128 a[64:67], v2 offset:32768
v_mfma_f32_16x16x32_bf16 v[144:147], a[36:39], a[140:143], v[144:147]
buffer_load_dwordx4 v14, s[8:11], s25 offen offset:2048 lds
v_mfma_f32_16x16x32_bf16 v[148:151], a[40:43], a[136:139], 0
ds_read_b128 a[68:71], v3 offset:32768
v_mfma_f32_16x16x32_bf16 v[148:151], a[44:47], a[140:143], v[148:151]
ds_read_b128 a[72:75], v2 offset:34816
v_mfma_f32_16x16x32_bf16 v[152:155], a[48:51], a[136:139], 0
ds_read_b128 a[76:79], v3 offset:34816
v_mfma_f32_16x16x32_bf16 v[152:155], a[52:55], a[140:143], v[152:155]
buffer_load_dwordx4 v15, s[8:11], s25 offen offset:3072 lds
v_mfma_f32_16x16x32_bf16 v[156:159], a[56:59], a[136:139], 0
s_add_u32 s25, s25, 128
ds_read_b128 a[80:83], v2 offset:36864
v_mfma_f32_16x16x32_bf16 v[156:159], a[60:63], a[140:143], v[156:159]
s_waitcnt lgkmcnt(5)
ds_read_b128 a[84:87], v3 offset:36864
v_mfma_f32_16x16x32_bf16 v[160:163], a[0:3], a[128:131], 0
s_bitcmp1_b32 s2, 4
s_cselect_b32 s37, s21, s37
ds_read_b64_tr_b16 a[136:137], v9 offset:0
v_mfma_f32_16x16x32_bf16 v[160:163], a[4:7], a[132:135], v[160:163]
s_lshl_b32 s56, s37, 5
s_add_u32 s56, s56, s20
s_lshl_b32 s56, s56, 2
v_mfma_f32_16x16x32_bf16 v[164:167], a[8:11], a[128:131], 0
s_add_u32 s56, s56, 8192
ds_read_b64_tr_b16 a[138:139], v9 offset:2048
v_writelane_b32 v28, s56, 3
v_mfma_f32_16x16x32_bf16 v[164:167], a[12:15], a[132:135], v[164:167]
s_add_u32 s56, s56, 2048
v_writelane_b32 v28, s56, 6
v_mfma_f32_16x16x32_bf16 v[168:171], a[16:19], a[128:131], 0
s_add_u32 s56, s56, 4096
ds_read_b64_tr_b16 a[140:141], v9 offset:16384
v_writelane_b32 v28, s56, 5
v_mfma_f32_16x16x32_bf16 v[168:171], a[20:23], a[132:135], v[168:171]
s_lshl_b32 s56, s2, 2
s_add_u32 s56, s56, 12288
v_writelane_b32 v28, s56, 4
v_mfma_f32_16x16x32_bf16 v[172:175], a[24:27], a[128:131], 0
s_lshl_b32 s56, s39, 5
s_add_u32 s56, s56, s38
ds_read_b64_tr_b16 a[142:143], v9 offset:18432
v_mfma_f32_16x16x32_bf16 v[172:175], a[28:31], a[132:135], v[172:175]
s_lshl_b32 s56, s56, 2
s_add_u32 s56, s56, 20480
s_cmp_lt_u32 s2, 224
v_mfma_f32_16x16x32_bf16 v[176:179], a[32:35], a[128:131], 0
s_cselect_b32 s56, s56, 3221225472
v_writelane_b32 v28, s56, 7
v_mfma_f32_16x16x32_bf16 v[176:179], a[36:39], a[132:135], v[176:179]
s_cmp_eq_u32 s3, 0
s_cselect_b32 s56, 94371840, 3221225472
v_mfma_f32_16x16x32_bf16 v[180:183], a[40:43], a[128:131], 0
ds_read_b128 a[88:91], v2 offset:38912
v_mfma_f32_16x16x32_bf16 v[180:183], a[44:47], a[132:135], v[180:183]
ds_read_b128 a[92:95], v3 offset:38912
v_mfma_f32_16x16x32_bf16 v[184:187], a[48:51], a[128:131], 0
ds_read_b128 a[96:99], v2 offset:40960
v_mfma_f32_16x16x32_bf16 v[184:187], a[52:55], a[132:135], v[184:187]
buffer_store_dword v246, v28, s[4:7], s56 offen sc1
v_mfma_f32_16x16x32_bf16 v[188:191], a[56:59], a[128:131], 0
ds_read_b128 a[100:103], v3 offset:40960
v_mov_b32 v27, 1
v_mfma_f32_16x16x32_bf16 v[188:191], a[60:63], a[132:135], v[188:191]
s_waitcnt lgkmcnt(4)
ds_read_b128 a[104:107], v2 offset:43008
v_cmp_eq_u32 vcc, 0, v0
v_mfma_f32_16x16x32_bf16 v[192:195], a[0:3], a[136:139], 0
ds_read_b64_tr_b16 a[128:129], v10 offset:0
v_mov_b32 v26, 3221225472
v_mfma_f32_16x16x32_bf16 v[192:195], a[4:7], a[140:143], v[192:195]
s_lshl_b32 s31, s20, 20
s_lshl_b32 s22, s21, 17
v_cndmask_b32 v26, v26, v246, vcc
v_mfma_f32_16x16x32_bf16 v[196:199], a[8:11], a[136:139], 0
s_add_u32 s31, s31, s22
s_lshr_b32 s22, s3, 1
ds_read_b64_tr_b16 a[130:131], v10 offset:2048
v_mfma_f32_16x16x32_bf16 v[196:199], a[12:15], a[140:143], v[196:199]
s_lshl_b32 s22, s22, 16
s_add_u32 s31, s31, s22
s_and_b32 s22, s3, 1
v_mfma_f32_16x16x32_bf16 v[200:203], a[16:19], a[136:139], 0
s_lshl_b32 s22, s22, 14
s_add_u32 s31, s31, s22
ds_read_b64_tr_b16 a[132:133], v10 offset:16384
v_mfma_f32_16x16x32_bf16 v[200:203], a[20:23], a[140:143], v[200:203]
s_add_u32 s31, s31, 16777216
v_mfma_f32_16x16x32_bf16 v[204:207], a[24:27], a[136:139], 0
ds_read_b64_tr_b16 a[134:135], v10 offset:18432
v_mfma_f32_16x16x32_bf16 v[204:207], a[28:31], a[140:143], v[204:207]
v_mfma_f32_16x16x32_bf16 v[208:211], a[32:35], a[136:139], 0
v_mfma_f32_16x16x32_bf16 v[208:211], a[36:39], a[140:143], v[208:211]
v_mfma_f32_16x16x32_bf16 v[212:215], a[40:43], a[136:139], 0
ds_read_b128 a[108:111], v3 offset:43008
v_mfma_f32_16x16x32_bf16 v[212:215], a[44:47], a[140:143], v[212:215]
ds_read_b128 a[112:115], v2 offset:45056
v_mfma_f32_16x16x32_bf16 v[216:219], a[48:51], a[136:139], 0
ds_read_b128 a[116:119], v3 offset:45056
v_mfma_f32_16x16x32_bf16 v[216:219], a[52:55], a[140:143], v[216:219]
v_mfma_f32_16x16x32_bf16 v[220:223], a[56:59], a[136:139], 0
ds_read_b128 a[120:123], v2 offset:47104
v_mfma_f32_16x16x32_bf16 v[220:223], a[60:63], a[140:143], v[220:223]
s_waitcnt lgkmcnt(4)
ds_read_b128 a[124:127], v3 offset:47104
v_mfma_f32_16x16x32_bf16 a[192:195], a[0:3], a[128:131], 0
ds_read_b64_tr_b16 a[136:137], v11 offset:0
v_mfma_f32_16x16x32_bf16 a[192:195], a[4:7], a[132:135], a[192:195]
v_mfma_f32_16x16x32_bf16 a[196:199], a[8:11], a[128:131], 0
ds_read_b64_tr_b16 a[138:139], v11 offset:2048
v_mfma_f32_16x16x32_bf16 a[196:199], a[12:15], a[132:135], a[196:199]
v_mfma_f32_16x16x32_bf16 a[200:203], a[16:19], a[128:131], 0
ds_read_b64_tr_b16 a[140:141], v11 offset:16384
v_mfma_f32_16x16x32_bf16 a[200:203], a[20:23], a[132:135], a[200:203]
v_mfma_f32_16x16x32_bf16 a[204:207], a[24:27], a[128:131], 0
ds_read_b64_tr_b16 a[142:143], v11 offset:18432
v_mfma_f32_16x16x32_bf16 a[204:207], a[28:31], a[132:135], a[204:207]
PAD_22:
s_cbranch_execz PAD_26
v_mfma_f32_16x16x32_bf16 a[208:211], a[32:35], a[128:131], 0
v_mfma_f32_16x16x32_bf16 a[208:211], a[36:39], a[132:135], a[208:211]
v_mfma_f32_16x16x32_bf16 a[212:215], a[40:43], a[128:131], 0
v_mfma_f32_16x16x32_bf16 a[212:215], a[44:47], a[132:135], a[212:215]
v_mfma_f32_16x16x32_bf16 a[216:219], a[48:51], a[128:131], 0
v_mfma_f32_16x16x32_bf16 a[216:219], a[52:55], a[132:135], a[216:219]
v_mfma_f32_16x16x32_bf16 a[220:223], a[56:59], a[128:131], 0
s_waitcnt vmcnt(1) lgkmcnt(0)
v_mfma_f32_16x16x32_bf16 a[220:223], a[60:63], a[132:135], a[220:223]
s_barrier
v_mfma_f32_16x16x32_bf16 a[224:227], a[0:3], a[136:139], 0
s_add_u32 m0, s29, 65536
ds_read_b64_tr_b16 a[128:129], v4 offset:32768
v_mfma_f32_16x16x32_bf16 a[224:227], a[4:7], a[140:143], a[224:227]
buffer_load_dwordx4 v16, s[12:15], s26 offen offset:0 lds
v_mfma_f32_16x16x32_bf16 a[228:231], a[8:11], a[136:139], 0
ds_read_b64_tr_b16 a[130:131], v4 offset:34816
v_mfma_f32_16x16x32_bf16 a[228:231], a[12:15], a[140:143], a[228:231]
v_mfma_f32_16x16x32_bf16 a[232:235], a[16:19], a[136:139], 0
ds_read_b64_tr_b16 a[132:133], v4 offset:49152
v_mfma_f32_16x16x32_bf16 a[232:235], a[20:23], a[140:143], a[232:235]
buffer_load_dwordx4 v17, s[12:15], s26 offen offset:1024 lds
v_mfma_f32_16x16x32_bf16 a[236:239], a[24:27], a[136:139], 0
ds_read_b64_tr_b16 a[134:135], v4 offset:51200
v_mfma_f32_16x16x32_bf16 a[236:239], a[28:31], a[140:143], a[236:239]
v_mfma_f32_16x16x32_bf16 a[240:243], a[32:35], a[136:139], 0
v_mfma_f32_16x16x32_bf16 a[240:243], a[36:39], a[140:143], a[240:243]
buffer_load_dwordx4 v18, s[12:15], s26 offen offset:2048 lds
v_mfma_f32_16x16x32_bf16 a[244:247], a[40:43], a[136:139], 0
v_mfma_f32_16x16x32_bf16 a[244:247], a[44:47], a[140:143], a[244:247]
v_mfma_f32_16x16x32_bf16 a[248:251], a[48:51], a[136:139], 0
v_mfma_f32_16x16x32_bf16 a[248:251], a[52:55], a[140:143], a[248:251]
buffer_load_dwordx4 v19, s[12:15], s26 offen offset:3072 lds
v_mfma_f32_16x16x32_bf16 a[252:255], a[56:59], a[136:139], 0
s_add_u32 s26, s26, 524288
v_mfma_f32_16x16x32_bf16 a[252:255], a[60:63], a[140:143], a[252:255]
s_waitcnt lgkmcnt(0)
Lg_501:
v_mfma_f32_16x16x32_bf16 v[32:35], a[64:67], a[128:131], v[32:35]
s_add_u32 m0, s29, 81920
ds_read_b64_tr_b16 a[136:137], v5 offset:32768
v_mfma_f32_16x16x32_bf16 v[32:35], a[68:71], a[132:135], v[32:35]
buffer_load_dwordx4 v16, s[12:15], s27 offen offset:0 lds
v_mfma_f32_16x16x32_bf16 v[36:39], a[72:75], a[128:131], v[36:39]
ds_read_b64_tr_b16 a[138:139], v5 offset:34816
v_mfma_f32_16x16x32_bf16 v[36:39], a[76:79], a[132:135], v[36:39]
v_mfma_f32_16x16x32_bf16 v[40:43], a[80:83], a[128:131], v[40:43]
ds_read_b64_tr_b16 a[140:141], v5 offset:49152
v_mfma_f32_16x16x32_bf16 v[40:43], a[84:87], a[132:135], v[40:43]
buffer_load_dwordx4 v17, s[12:15], s27 offen offset:1024 lds
v_mfma_f32_16x16x32_bf16 v[44:47], a[88:91], a[128:131], v[44:47]
ds_read_b64_tr_b16 a[142:143], v5 offset:51200
v_mfma_f32_16x16x32_bf16 v[44:47], a[92:95], a[132:135], v[44:47]
v_mfma_f32_16x16x32_bf16 v[48:51], a[96:99], a[128:131], v[48:51]
ds_read_b128 a[0:3], v2 offset:0
v_mfma_f32_16x16x32_bf16 v[48:51], a[100:103], a[132:135], v[48:51]
buffer_load_dwordx4 v18, s[12:15], s27 offen offset:2048 lds
v_mfma_f32_16x16x32_bf16 v[52:55], a[104:107], a[128:131], v[52:55]
ds_read_b128 a[4:7], v3 offset:0
v_mfma_f32_16x16x32_bf16 v[52:55], a[108:111], a[132:135], v[52:55]
v_mfma_f32_16x16x32_bf16 v[56:59], a[112:115], a[128:131], v[56:59]
v_mfma_f32_16x16x32_bf16 v[56:59], a[116:119], a[132:135], v[56:59]
buffer_load_dwordx4 v19, s[12:15], s27 offen offset:3072 lds
v_mfma_f32_16x16x32_bf16 v[60:63], a[120:123], a[128:131], v[60:63]
s_add_u32 s27, s27, 524288
ds_read_b128 a[8:11], v2 offset:2048
v_mfma_f32_16x16x32_bf16 v[60:63], a[124:127], a[132:135], v[60:63]
s_waitcnt lgkmcnt(3)
v_mfma_f32_16x16x32_bf16 v[64:67], a[64:67], a[136:139], v[64:67]
s_add_u32 m0, s28, 32768
ds_read_b64_tr_b16 a[128:129], v6 offset:32768
v_mfma_f32_16x16x32_bf16 v[64:67], a[68:71], a[140:143], v[64:67]
buffer_load_dwordx4 v12, s[8:11], s24 offen offset:0 lds
v_mfma_f32_16x16x32_bf16 v[68:71], a[72:75], a[136:139], v[68:71]
ds_read_b64_tr_b16 a[130:131], v6 offset:34816
v_mfma_f32_16x16x32_bf16 v[68:71], a[76:79], a[140:143], v[68:71]
v_mfma_f32_16x16x32_bf16 v[72:75], a[80:83], a[136:139], v[72:75]
ds_read_b64_tr_b16 a[132:133], v6 offset:49152
v_mfma_f32_16x16x32_bf16 v[72:75], a[84:87], a[140:143], v[72:75]
buffer_load_dwordx4 v13, s[8:11], s24 offen offset:1024 lds
v_mfma_f32_16x16x32_bf16 v[76:79], a[88:91], a[136:139], v[76:79]
ds_read_b64_tr_b16 a[134:135], v6 offset:51200
v_mfma_f32_16x16x32_bf16 v[76:79], a[92:95], a[140:143], v[76:79]
v_mfma_f32_16x16x32_bf16 v[80:83], a[96:99], a[136:139], v[80:83]
ds_read_b128 a[12:15], v3 offset:2048
v_mfma_f32_16x16x32_bf16 v[80:83], a[100:103], a[140:143], v[80:83]
buffer_load_dwordx4 v14, s[8:11], s24 offen offset:2048 lds
v_mfma_f32_16x16x32_bf16 v[84:87], a[104:107], a[136:139], v[84:87]
v_mfma_f32_16x16x32_bf16 v[84:87], a[108:111], a[140:143], v[84:87]
v_mfma_f32_16x16x32_bf16 v[88:91], a[112:115], a[136:139], v[88:91]
ds_read_b128 a[16:19], v2 offset:4096
v_mfma_f32_16x16x32_bf16 v[88:91], a[116:119], a[140:143], v[88:91]
buffer_load_dwordx4 v15, s[8:11], s24 offen offset:3072 lds
v_mfma_f32_16x16x32_bf16 v[92:95], a[120:123], a[136:139], v[92:95]
s_add_u32 s24, s24, 128
ds_read_b128 a[20:23], v3 offset:4096
v_mfma_f32_16x16x32_bf16 v[92:95], a[124:127], a[140:143], v[92:95]
s_waitcnt lgkmcnt(3)
v_mfma_f32_16x16x32_bf16 v[96:99], a[64:67], a[128:131], v[96:99]
s_add_u32 m0, s28, 36864
ds_read_b64_tr_b16 a[136:137], v7 offset:32768
v_mfma_f32_16x16x32_bf16 v[96:99], a[68:71], a[132:135], v[96:99]
buffer_load_dwordx4 v12, s[8:11], s25 offen offset:0 lds
v_mfma_f32_16x16x32_bf16 v[100:103], a[72:75], a[128:131], v[100:103]
ds_read_b64_tr_b16 a[138:139], v7 offset:34816
v_mfma_f32_16x16x32_bf16 v[100:103], a[76:79], a[132:135], v[100:103]
v_mfma_f32_16x16x32_bf16 v[104:107], a[80:83], a[128:131], v[104:107]
ds_read_b64_tr_b16 a[140:141], v7 offset:49152
v_mfma_f32_16x16x32_bf16 v[104:107], a[84:87], a[132:135], v[104:107]
buffer_load_dwordx4 v13, s[8:11], s25 offen offset:1024 lds
v_mfma_f32_16x16x32_bf16 v[108:111], a[88:91], a[128:131], v[108:111]
ds_read_b64_tr_b16 a[142:143], v7 offset:51200
v_mfma_f32_16x16x32_bf16 v[108:111], a[92:95], a[132:135], v[108:111]
v_mfma_f32_16x16x32_bf16 v[112:115], a[96:99], a[128:131], v[112:115]
v_mfma_f32_16x16x32_bf16 v[112:115], a[100:103], a[132:135], v[112:115]
buffer_load_dwordx4 v14, s[8:11], s25 offen offset:2048 lds
v_mfma_f32_16x16x32_bf16 v[116:119], a[104:107], a[128:131], v[116:119]
ds_read_b128 a[24:27], v2 offset:6144
v_mfma_f32_16x16x32_bf16 v[116:119], a[108:111], a[132:135], v[116:119]
v_mfma_f32_16x16x32_bf16 v[120:123], a[112:115], a[128:131], v[120:123]
ds_read_b128 a[28:31], v3 offset:6144
v_mfma_f32_16x16x32_bf16 v[120:123], a[116:119], a[132:135], v[120:123]
buffer_load_dwordx4 v15, s[8:11], s25 offen offset:3072 lds
v_mfma_f32_16x16x32_bf16 v[124:127], a[120:123], a[128:131], v[124:127]
s_add_u32 s25, s25, 128
v_mfma_f32_16x16x32_bf16 v[124:127], a[124:127], a[132:135], v[124:127]
s_waitcnt lgkmcnt(2)
v_mfma_f32_16x16x32_bf16 v[128:131], a[64:67], a[136:139], v[128:131]
ds_read_b64_tr_b16 a[128:129], v8 offset:32768
v_mfma_f32_16x16x32_bf16 v[128:131], a[68:71], a[140:143], v[128:131]
buffer_load_dword v21, v20, s[16:19], s43 offen
v_mfma_f32_16x16x32_bf16 v[132:135], a[72:75], a[136:139], v[132:135]
s_add_u32 s43, s43, s47
ds_read_b64_tr_b16 a[130:131], v8 offset:34816
v_mfma_f32_16x16x32_bf16 v[132:135], a[76:79], a[140:143], v[132:135]
s_cmp_ge_u32 s43, s51
v_mfma_f32_16x16x32_bf16 v[136:139], a[80:83], a[136:139], v[136:139]
s_cselect_b32 s43, 0, s43
ds_read_b64_tr_b16 a[132:133], v8 offset:49152
v_mfma_f32_16x16x32_bf16 v[136:139], a[84:87], a[140:143], v[136:139]
s_cselect_b32 s51, s42, s51
v_mfma_f32_16x16x32_bf16 v[140:143], a[88:91], a[136:139], v[140:143]
s_cselect_b64 s[16:17], s[40:41], s[16:17]
ds_read_b64_tr_b16 a[134:135], v8 offset:51200
v_mfma_f32_16x16x32_bf16 v[140:143], a[92:95], a[140:143], v[140:143]
s_cselect_b32 s18, s42, s18
v_mfma_f32_16x16x32_bf16 v[144:147], a[96:99], a[136:139], v[144:147]
s_cselect_b64 s[40:41], s[44:45], s[40:41]
ds_read_b128 a[32:35], v2 offset:8192
v_mfma_f32_16x16x32_bf16 v[144:147], a[100:103], a[140:143], v[144:147]
s_cselect_b32 s42, s46, s42
v_mfma_f32_16x16x32_bf16 v[148:151], a[104:107], a[136:139], v[148:151]
s_cselect_b32 s46, 0, s46
v_mfma_f32_16x16x32_bf16 v[148:151], a[108:111], a[140:143], v[148:151]
s_cmp_eq_u32 s30, s55
v_mfma_f32_16x16x32_bf16 v[152:155], a[112:115], a[136:139], v[152:155]
s_cselect_b32 s22, 0, 3221225472
ds_read_b128 a[36:39], v3 offset:8192
v_mfma_f32_16x16x32_bf16 v[152:155], a[116:119], a[140:143], v[152:155]
s_sub_u32 s30, s30, 1
buffer_atomic_add v27, v26, s[60:63], s22 offen sc1
v_mfma_f32_16x16x32_bf16 v[156:159], a[120:123], a[136:139], v[156:159]
ds_read_b128 a[40:43], v2 offset:10240
v_mfma_f32_16x16x32_bf16 v[156:159], a[124:127], a[140:143], v[156:159]
s_waitcnt lgkmcnt(3)
v_mfma_f32_16x16x32_bf16 v[160:163], a[64:67], a[128:131], v[160:163]
ds_read_b64_tr_b16 a[136:137], v9 offset:32768
v_mfma_f32_16x16x32_bf16 v[160:163], a[68:71], a[132:135], v[160:163]
v_mfma_f32_16x16x32_bf16 v[164:167], a[72:75], a[128:131], v[164:167]
ds_read_b64_tr_b16 a[138:139], v9 offset:34816
v_mfma_f32_16x16x32_bf16 v[164:167], a[76:79], a[132:135], v[164:167]
v_mfma_f32_16x16x32_bf16 v[168:171], a[80:83], a[128:131], v[168:171]
ds_read_b64_tr_b16 a[140:141], v9 offset:49152
v_mfma_f32_16x16x32_bf16 v[168:171], a[84:87], a[132:135], v[168:171]
v_mfma_f32_16x16x32_bf16 v[172:175], a[88:91], a[128:131], v[172:175]
ds_read_b64_tr_b16 a[142:143], v9 offset:51200
v_mfma_f32_16x16x32_bf16 v[172:175], a[92:95], a[132:135], v[172:175]
v_mfma_f32_16x16x32_bf16 v[176:179], a[96:99], a[128:131], v[176:179]
v_mfma_f32_16x16x32_bf16 v[176:179], a[100:103], a[132:135], v[176:179]
v_mfma_f32_16x16x32_bf16 v[180:183], a[104:107], a[128:131], v[180:183]
ds_read_b128 a[44:47], v3 offset:10240
v_mfma_f32_16x16x32_bf16 v[180:183], a[108:111], a[132:135], v[180:183]
v_mfma_f32_16x16x32_bf16 v[184:187], a[112:115], a[128:131], v[184:187]
ds_read_b128 a[48:51], v2 offset:12288
v_mfma_f32_16x16x32_bf16 v[184:187], a[116:119], a[132:135], v[184:187]
v_mfma_f32_16x16x32_bf16 v[188:191], a[120:123], a[128:131], v[188:191]
v_mfma_f32_16x16x32_bf16 v[188:191], a[124:127], a[132:135], v[188:191]
s_waitcnt lgkmcnt(2)
v_mfma_f32_16x16x32_bf16 v[192:195], a[64:67], a[136:139], v[192:195]
ds_read_b64_tr_b16 a[128:129], v10 offset:32768
v_mfma_f32_16x16x32_bf16 v[192:195], a[68:71], a[140:143], v[192:195]
v_mfma_f32_16x16x32_bf16 v[196:199], a[72:75], a[136:139], v[196:199]
ds_read_b64_tr_b16 a[130:131], v10 offset:34816
v_mfma_f32_16x16x32_bf16 v[196:199], a[76:79], a[140:143], v[196:199]
v_mfma_f32_16x16x32_bf16 v[200:203], a[80:83], a[136:139], v[200:203]
ds_read_b64_tr_b16 a[132:133], v10 offset:49152
v_mfma_f32_16x16x32_bf16 v[200:203], a[84:87], a[140:143], v[200:203]
v_mfma_f32_16x16x32_bf16 v[204:207], a[88:91], a[136:139], v[204:207]
ds_read_b64_tr_b16 a[134:135], v10 offset:51200
v_mfma_f32_16x16x32_bf16 v[204:207], a[92:95], a[140:143], v[204:207]
v_mfma_f32_16x16x32_bf16 v[208:211], a[96:99], a[136:139], v[208:211]
ds_read_b128 a[52:55], v3 offset:12288
v_mfma_f32_16x16x32_bf16 v[208:211], a[100:103], a[140:143], v[208:211]
v_mfma_f32_16x16x32_bf16 v[212:215], a[104:107], a[136:139], v[212:215]
ds_read_b128 a[56:59], v2 offset:14336
v_mfma_f32_16x16x32_bf16 v[212:215], a[108:111], a[140:143], v[212:215]
v_mfma_f32_16x16x32_bf16 v[216:219], a[112:115], a[136:139], v[216:219]
v_mfma_f32_16x16x32_bf16 v[216:219], a[116:119], a[140:143], v[216:219]
v_mfma_f32_16x16x32_bf16 v[220:223], a[120:123], a[136:139], v[220:223]
ds_read_b128 a[60:63], v3 offset:14336
v_mfma_f32_16x16x32_bf16 v[220:223], a[124:127], a[140:143], v[220:223]
s_waitcnt lgkmcnt(3)
v_mfma_f32_16x16x32_bf16 a[192:195], a[64:67], a[128:131], a[192:195]
ds_read_b64_tr_b16 a[136:137], v11 offset:32768
v_mfma_f32_16x16x32_bf16 a[192:195], a[68:71], a[132:135], a[192:195]
v_mfma_f32_16x16x32_bf16 a[196:199], a[72:75], a[128:131], a[196:199]
ds_read_b64_tr_b16 a[138:139], v11 offset:34816
v_mfma_f32_16x16x32_bf16 a[196:199], a[76:79], a[132:135], a[196:199]
v_mfma_f32_16x16x32_bf16 a[200:203], a[80:83], a[128:131], a[200:203]
ds_read_b64_tr_b16 a[140:141], v11 offset:49152
v_mfma_f32_16x16x32_bf16 a[200:203], a[84:87], a[132:135], a[200:203]
v_mfma_f32_16x16x32_bf16 a[204:207], a[88:91], a[128:131], a[204:207]
ds_read_b64_tr_b16 a[142:143], v11 offset:51200
v_mfma_f32_16x16x32_bf16 a[204:207], a[92:95], a[132:135], a[204:207]
v_mfma_f32_16x16x32_bf16 a[208:211], a[96:99], a[128:131], a[208:211]
v_mfma_f32_16x16x32_bf16 a[208:211], a[100:103], a[132:135], a[208:211]
v_mfma_f32_16x16x32_bf16 a[212:215], a[104:107], a[128:131], a[212:215]
v_mfma_f32_16x16x32_bf16 a[212:215], a[108:111], a[132:135], a[212:215]
v_mfma_f32_16x16x32_bf16 a[216:219], a[112:115], a[128:131], a[216:219]
v_mfma_f32_16x16x32_bf16 a[216:219], a[116:119], a[132:135], a[216:219]
v_mfma_f32_16x16x32_bf16 a[220:223], a[120:123], a[128:131], a[220:223]
s_waitcnt vmcnt(2) lgkmcnt(0)
v_mfma_f32_16x16x32_bf16 a[220:223], a[124:127], a[132:135], a[220:223]
s_barrier
v_mfma_f32_16x16x32_bf16 a[224:227], a[64:67], a[136:139], a[224:227]
s_add_u32 m0, s29, 98304
ds_read_b64_tr_b16 a[128:129], v4 offset:0
v_mfma_f32_16x16x32_bf16 a[224:227], a[68:71], a[140:143], a[224:227]
buffer_load_dwordx4 v16, s[12:15], s26 offen offset:0 lds
v_mfma_f32_16x16x32_bf16 a[228:231], a[72:75], a[136:139], a[228:231]
ds_read_b64_tr_b16 a[130:131], v4 offset:2048
v_mfma_f32_16x16x32_bf16 a[228:231], a[76:79], a[140:143], a[228:231]
v_mfma_f32_16x16x32_bf16 a[232:235], a[80:83], a[136:139], a[232:235]
ds_read_b64_tr_b16 a[132:133], v4 offset:16384
v_mfma_f32_16x16x32_bf16 a[232:235], a[84:87], a[140:143], a[232:235]
buffer_load_dwordx4 v17, s[12:15], s26 offen offset:1024 lds
v_mfma_f32_16x16x32_bf16 a[236:239], a[88:91], a[136:139], a[236:239]
ds_read_b64_tr_b16 a[134:135], v4 offset:18432
v_mfma_f32_16x16x32_bf16 a[236:239], a[92:95], a[140:143], a[236:239]
v_mfma_f32_16x16x32_bf16 a[240:243], a[96:99], a[136:139], a[240:243]
v_mfma_f32_16x16x32_bf16 a[240:243], a[100:103], a[140:143], a[240:243]
buffer_load_dwordx4 v18, s[12:15], s26 offen offset:2048 lds
v_mfma_f32_16x16x32_bf16 a[244:247], a[104:107], a[136:139], a[244:247]
v_mfma_f32_16x16x32_bf16 a[244:247], a[108:111], a[140:143], a[244:247]
v_mfma_f32_16x16x32_bf16 a[248:251], a[112:115], a[136:139], a[248:251]
v_mfma_f32_16x16x32_bf16 a[248:251], a[116:119], a[140:143], a[248:251]
buffer_load_dwordx4 v19, s[12:15], s26 offen offset:3072 lds
v_mfma_f32_16x16x32_bf16 a[252:255], a[120:123], a[136:139], a[252:255]
s_add_u32 s26, s26, 524288
v_mfma_f32_16x16x32_bf16 a[252:255], a[124:127], a[140:143], a[252:255]
s_waitcnt lgkmcnt(0)
buffer_store_dword v27, v26, s[4:7], s82 offen sc1
v_mfma_f32_16x16x32_bf16 v[32:35], a[0:3], a[128:131], v[32:35]
s_add_u32 m0, s29, 114688
ds_read_b64_tr_b16 a[136:137], v5 offset:0
v_mfma_f32_16x16x32_bf16 v[32:35], a[4:7], a[132:135], v[32:35]
buffer_load_dwordx4 v16, s[12:15], s27 offen offset:0 lds
v_mfma_f32_16x16x32_bf16 v[36:39], a[8:11], a[128:131], v[36:39]
ds_read_b64_tr_b16 a[138:139], v5 offset:2048
v_mfma_f32_16x16x32_bf16 v[36:39], a[12:15], a[132:135], v[36:39]
v_mfma_f32_16x16x32_bf16 v[40:43], a[16:19], a[128:131], v[40:43]
ds_read_b64_tr_b16 a[140:141], v5 offset:16384
v_mfma_f32_16x16x32_bf16 v[40:43], a[20:23], a[132:135], v[40:43]
buffer_load_dwordx4 v17, s[12:15], s27 offen offset:1024 lds
v_mfma_f32_16x16x32_bf16 v[44:47], a[24:27], a[128:131], v[44:47]
ds_read_b64_tr_b16 a[142:143], v5 offset:18432
v_mfma_f32_16x16x32_bf16 v[44:47], a[28:31], a[132:135], v[44:47]
v_mfma_f32_16x16x32_bf16 v[48:51], a[32:35], a[128:131], v[48:51]
ds_read_b128 a[64:67], v2 offset:32768
v_mfma_f32_16x16x32_bf16 v[48:51], a[36:39], a[132:135], v[48:51]
buffer_load_dwordx4 v18, s[12:15], s27 offen offset:2048 lds
v_mfma_f32_16x16x32_bf16 v[52:55], a[40:43], a[128:131], v[52:55]
ds_read_b128 a[68:71], v3 offset:32768
v_mfma_f32_16x16x32_bf16 v[52:55], a[44:47], a[132:135], v[52:55]
v_mfma_f32_16x16x32_bf16 v[56:59], a[48:51], a[128:131], v[56:59]
v_mfma_f32_16x16x32_bf16 v[56:59], a[52:55], a[132:135], v[56:59]
buffer_load_dwordx4 v19, s[12:15], s27 offen offset:3072 lds
v_mfma_f32_16x16x32_bf16 v[60:63], a[56:59], a[128:131], v[60:63]
s_add_u32 s27, s27, 524288
ds_read_b128 a[72:75], v2 offset:34816
v_mfma_f32_16x16x32_bf16 v[60:63], a[60:63], a[132:135], v[60:63]
s_waitcnt lgkmcnt(3)
v_mfma_f32_16x16x32_bf16 v[64:67], a[0:3], a[136:139], v[64:67]
s_add_u32 m0, s28, 0
ds_read_b64_tr_b16 a[128:129], v6 offset:0
v_mfma_f32_16x16x32_bf16 v[64:67], a[4:7], a[140:143], v[64:67]
buffer_load_dwordx4 v12, s[8:11], s24 offen offset:0 lds
v_mfma_f32_16x16x32_bf16 v[68:71], a[8:11], a[136:139], v[68:71]
ds_read_b64_tr_b16 a[130:131], v6 offset:2048
v_mfma_f32_16x16x32_bf16 v[68:71], a[12:15], a[140:143], v[68:71]
v_mfma_f32_16x16x32_bf16 v[72:75], a[16:19], a[136:139], v[72:75]
ds_read_b64_tr_b16 a[132:133], v6 offset:16384
v_mfma_f32_16x16x32_bf16 v[72:75], a[20:23], a[140:143], v[72:75]
buffer_load_dwordx4 v13, s[8:11], s24 offen offset:1024 lds
v_mfma_f32_16x16x32_bf16 v[76:79], a[24:27], a[136:139], v[76:79]
ds_read_b64_tr_b16 a[134:135], v6 offset:18432
v_mfma_f32_16x16x32_bf16 v[76:79], a[28:31], a[140:143], v[76:79]
v_mfma_f32_16x16x32_bf16 v[80:83], a[32:35], a[136:139], v[80:83]
ds_read_b128 a[76:79], v3 offset:34816
v_mfma_f32_16x16x32_bf16 v[80:83], a[36:39], a[140:143], v[80:83]
buffer_load_dwordx4 v14, s[8:11], s24 offen offset:2048 lds
v_mfma_f32_16x16x32_bf16 v[84:87], a[40:43], a[136:139], v[84:87]
v_mfma_f32_16x16x32_bf16 v[84:87], a[44:47], a[140:143], v[84:87]
v_mfma_f32_16x16x32_bf16 v[88:91], a[48:51], a[136:139], v[88:91]
ds_read_b128 a[80:83], v2 offset:36864
v_mfma_f32_16x16x32_bf16 v[88:91], a[52:55], a[140:143], v[88:91]
buffer_load_dwordx4 v15, s[8:11], s24 offen offset:3072 lds
v_mfma_f32_16x16x32_bf16 v[92:95], a[56:59], a[136:139], v[92:95]
s_add_u32 s24, s24, 128
ds_read_b128 a[84:87], v3 offset:36864
v_mfma_f32_16x16x32_bf16 v[92:95], a[60:63], a[140:143], v[92:95]
s_waitcnt lgkmcnt(3)
v_mfma_f32_16x16x32_bf16 v[96:99], a[0:3], a[128:131], v[96:99]
s_add_u32 m0, s28, 4096
ds_read_b64_tr_b16 a[136:137], v7 offset:0
v_mfma_f32_16x16x32_bf16 v[96:99], a[4:7], a[132:135], v[96:99]
buffer_load_dwordx4 v12, s[8:11], s25 offen offset:0 lds
v_mfma_f32_16x16x32_bf16 v[100:103], a[8:11], a[128:131], v[100:103]
ds_read_b64_tr_b16 a[138:139], v7 offset:2048
v_mfma_f32_16x16x32_bf16 v[100:103], a[12:15], a[132:135], v[100:103]
v_mfma_f32_16x16x32_bf16 v[104:107], a[16:19], a[128:131], v[104:107]
ds_read_b64_tr_b16 a[140:141], v7 offset:16384
v_mfma_f32_16x16x32_bf16 v[104:107], a[20:23], a[132:135], v[104:107]
buffer_load_dwordx4 v13, s[8:11], s25 offen offset:1024 lds
v_mfma_f32_16x16x32_bf16 v[108:111], a[24:27], a[128:131], v[108:111]
ds_read_b64_tr_b16 a[142:143], v7 offset:18432
v_mfma_f32_16x16x32_bf16 v[108:111], a[28:31], a[132:135], v[108:111]
v_mfma_f32_16x16x32_bf16 v[112:115], a[32:35], a[128:131], v[112:115]
v_mfma_f32_16x16x32_bf16 v[112:115], a[36:39], a[132:135], v[112:115]
buffer_load_dwordx4 v14, s[8:11], s25 offen offset:2048 lds
v_mfma_f32_16x16x32_bf16 v[116:119], a[40:43], a[128:131], v[116:119]
ds_read_b128 a[88:91], v2 offset:38912
v_mfma_f32_16x16x32_bf16 v[116:119], a[44:47], a[132:135], v[116:119]
v_mfma_f32_16x16x32_bf16 v[120:123], a[48:51], a[128:131], v[120:123]
ds_read_b128 a[92:95], v3 offset:38912
v_mfma_f32_16x16x32_bf16 v[120:123], a[52:55], a[132:135], v[120:123]
buffer_load_dwordx4 v15, s[8:11], s25 offen offset:3072 lds
v_mfma_f32_16x16x32_bf16 v[124:127], a[56:59], a[128:131], v[124:127]
s_add_u32 s25, s25, 128
v_mfma_f32_16x16x32_bf16 v[124:127], a[60:63], a[132:135], v[124:127]
s_waitcnt lgkmcnt(2)
v_mfma_f32_16x16x32_bf16 v[128:131], a[0:3], a[136:139], v[128:131]
ds_read_b64_tr_b16 a[128:129], v8 offset:0
v_mfma_f32_16x16x32_bf16 v[128:131], a[4:7], a[140:143], v[128:131]
buffer_load_dword v21, v20, s[16:19], s43 offen
v_mfma_f32_16x16x32_bf16 v[132:135], a[8:11], a[136:139], v[132:135]
s_add_u32 s43, s43, s47
ds_read_b64_tr_b16 a[130:131], v8 offset:2048
v_mfma_f32_16x16x32_bf16 v[132:135], a[12:15], a[140:143], v[132:135]
s_cmp_ge_u32 s43, s51
v_mfma_f32_16x16x32_bf16 v[136:139], a[16:19], a[136:139], v[136:139]
s_cselect_b32 s43, 0, s43
ds_read_b64_tr_b16 a[132:133], v8 offset:16384
v_mfma_f32_16x16x32_bf16 v[136:139], a[20:23], a[140:143], v[136:139]
s_cselect_b32 s51, s42, s51
v_mfma_f32_16x16x32_bf16 v[140:143], a[24:27], a[136:139], v[140:143]
s_cselect_b64 s[16:17], s[40:41], s[16:17]
ds_read_b64_tr_b16 a[134:135], v8 offset:18432
v_mfma_f32_16x16x32_bf16 v[140:143], a[28:31], a[140:143], v[140:143]
s_cselect_b32 s18, s42, s18
v_mfma_f32_16x16x32_bf16 v[144:147], a[32:35], a[136:139], v[144:147]
s_cselect_b64 s[40:41], s[44:45], s[40:41]
ds_read_b128 a[96:99], v2 offset:40960
v_mfma_f32_16x16x32_bf16 v[144:147], a[36:39], a[140:143], v[144:147]
s_cselect_b32 s42, s46, s42
v_mfma_f32_16x16x32_bf16 v[148:151], a[40:43], a[136:139], v[148:151]
s_cselect_b32 s46, 0, s46
v_mfma_f32_16x16x32_bf16 v[148:151], a[44:47], a[140:143], v[148:151]
s_cmp_eq_u32 s30, s55
v_mfma_f32_16x16x32_bf16 v[152:155], a[48:51], a[136:139], v[152:155]
s_cselect_b32 s22, 0, 3221225472
ds_read_b128 a[100:103], v3 offset:40960
v_mfma_f32_16x16x32_bf16 v[152:155], a[52:55], a[140:143], v[152:155]
s_sub_u32 s30, s30, 1
buffer_atomic_add v27, v26, s[60:63], s22 offen sc1
v_mfma_f32_16x16x32_bf16 v[156:159], a[56:59], a[136:139], v[156:159]
ds_read_b128 a[104:107], v2 offset:43008
v_mfma_f32_16x16x32_bf16 v[156:159], a[60:63], a[140:143], v[156:159]
s_waitcnt lgkmcnt(3)
v_mfma_f32_16x16x32_bf16 v[160:163], a[0:3], a[128:131], v[160:163]
ds_read_b64_tr_b16 a[136:137], v9 offset:0
v_mfma_f32_16x16x32_bf16 v[160:163], a[4:7], a[132:135], v[160:163]
v_mfma_f32_16x16x32_bf16 v[164:167], a[8:11], a[128:131], v[164:167]
ds_read_b64_tr_b16 a[138:139], v9 offset:2048
v_mfma_f32_16x16x32_bf16 v[164:167], a[12:15], a[132:135], v[164:167]
v_mfma_f32_16x16x32_bf16 v[168:171], a[16:19], a[128:131], v[168:171]
ds_read_b64_tr_b16 a[140:141], v9 offset:16384
v_mfma_f32_16x16x32_bf16 v[168:171], a[20:23], a[132:135], v[168:171]
v_mfma_f32_16x16x32_bf16 v[172:175], a[24:27], a[128:131], v[172:175]
ds_read_b64_tr_b16 a[142:143], v9 offset:18432
v_mfma_f32_16x16x32_bf16 v[172:175], a[28:31], a[132:135], v[172:175]
v_mfma_f32_16x16x32_bf16 v[176:179], a[32:35], a[128:131], v[176:179]
v_mfma_f32_16x16x32_bf16 v[176:179], a[36:39], a[132:135], v[176:179]
v_mfma_f32_16x16x32_bf16 v[180:183], a[40:43], a[128:131], v[180:183]
ds_read_b128 a[108:111], v3 offset:43008
v_mfma_f32_16x16x32_bf16 v[180:183], a[44:47], a[132:135], v[180:183]
v_mfma_f32_16x16x32_bf16 v[184:187], a[48:51], a[128:131], v[184:187]
ds_read_b128 a[112:115], v2 offset:45056
v_mfma_f32_16x16x32_bf16 v[184:187], a[52:55], a[132:135], v[184:187]
v_mfma_f32_16x16x32_bf16 v[188:191], a[56:59], a[128:131], v[188:191]
v_mfma_f32_16x16x32_bf16 v[188:191], a[60:63], a[132:135], v[188:191]
s_waitcnt lgkmcnt(2)
v_mfma_f32_16x16x32_bf16 v[192:195], a[0:3], a[136:139], v[192:195]
ds_read_b64_tr_b16 a[128:129], v10 offset:0
v_mfma_f32_16x16x32_bf16 v[192:195], a[4:7], a[140:143], v[192:195]
v_mfma_f32_16x16x32_bf16 v[196:199], a[8:11], a[136:139], v[196:199]
ds_read_b64_tr_b16 a[130:131], v10 offset:2048
v_mfma_f32_16x16x32_bf16 v[196:199], a[12:15], a[140:143], v[196:199]
v_mfma_f32_16x16x32_bf16 v[200:203], a[16:19], a[136:139], v[200:203]
ds_read_b64_tr_b16 a[132:133], v10 offset:16384
v_mfma_f32_16x16x32_bf16 v[200:203], a[20:23], a[140:143], v[200:203]
v_mfma_f32_16x16x32_bf16 v[204:207], a[24:27], a[136:139], v[204:207]
ds_read_b64_tr_b16 a[134:135], v10 offset:18432
v_mfma_f32_16x16x32_bf16 v[204:207], a[28:31], a[140:143], v[204:207]
v_mfma_f32_16x16x32_bf16 v[208:211], a[32:35], a[136:139], v[208:211]
ds_read_b128 a[116:119], v3 offset:45056
v_mfma_f32_16x16x32_bf16 v[208:211], a[36:39], a[140:143], v[208:211]
v_mfma_f32_16x16x32_bf16 v[212:215], a[40:43], a[136:139], v[212:215]
ds_read_b128 a[120:123], v2 offset:47104
v_mfma_f32_16x16x32_bf16 v[212:215], a[44:47], a[140:143], v[212:215]
v_mfma_f32_16x16x32_bf16 v[216:219], a[48:51], a[136:139], v[216:219]
v_mfma_f32_16x16x32_bf16 v[216:219], a[52:55], a[140:143], v[216:219]
v_mfma_f32_16x16x32_bf16 v[220:223], a[56:59], a[136:139], v[220:223]
ds_read_b128 a[124:127], v3 offset:47104
v_mfma_f32_16x16x32_bf16 v[220:223], a[60:63], a[140:143], v[220:223]
s_waitcnt lgkmcnt(3)
v_mfma_f32_16x16x32_bf16 a[192:195], a[0:3], a[128:131], a[192:195]
ds_read_b64_tr_b16 a[136:137], v11 offset:0
v_mfma_f32_16x16x32_bf16 a[192:195], a[4:7], a[132:135], a[192:195]
v_mfma_f32_16x16x32_bf16 a[196:199], a[8:11], a[128:131], a[196:199]
ds_read_b64_tr_b16 a[138:139], v11 offset:2048
v_mfma_f32_16x16x32_bf16 a[196:199], a[12:15], a[132:135], a[196:199]
v_mfma_f32_16x16x32_bf16 a[200:203], a[16:19], a[128:131], a[200:203]
ds_read_b64_tr_b16 a[140:141], v11 offset:16384
v_mfma_f32_16x16x32_bf16 a[200:203], a[20:23], a[132:135], a[200:203]
v_mfma_f32_16x16x32_bf16 a[204:207], a[24:27], a[128:131], a[204:207]
ds_read_b64_tr_b16 a[142:143], v11 offset:18432
v_mfma_f32_16x16x32_bf16 a[204:207], a[28:31], a[132:135], a[204:207]
v_mfma_f32_16x16x32_bf16 a[208:211], a[32:35], a[128:131], a[208:211]
v_mfma_f32_16x16x32_bf16 a[208:211], a[36:39], a[132:135], a[208:211]
v_mfma_f32_16x16x32_bf16 a[212:215], a[40:43], a[128:131], a[212:215]
v_mfma_f32_16x16x32_bf16 a[212:215], a[44:47], a[132:135], a[212:215]
v_mfma_f32_16x16x32_bf16 a[216:219], a[48:51], a[128:131], a[216:219]
v_mfma_f32_16x16x32_bf16 a[216:219], a[52:55], a[132:135], a[216:219]
v_mfma_f32_16x16x32_bf16 a[220:223], a[56:59], a[128:131], a[220:223]
s_waitcnt vmcnt(2) lgkmcnt(0)
v_mfma_f32_16x16x32_bf16 a[220:223], a[60:63], a[132:135], a[220:223]
s_barrier
v_mfma_f32_16x16x32_bf16 a[224:227], a[0:3], a[136:139], a[224:227]
s_add_u32 m0, s29, 65536
ds_read_b64_tr_b16 a[128:129], v4 offset:32768
v_mfma_f32_16x16x32_bf16 a[224:227], a[4:7], a[140:143], a[224:227]
buffer_load_dwordx4 v16, s[12:15], s26 offen offset:0 lds
v_mfma_f32_16x16x32_bf16 a[228:231], a[8:11], a[136:139], a[228:231]
ds_read_b64_tr_b16 a[130:131], v4 offset:34816
v_mfma_f32_16x16x32_bf16 a[228:231], a[12:15], a[140:143], a[228:231]
v_mfma_f32_16x16x32_bf16 a[232:235], a[16:19], a[136:139], a[232:235]
ds_read_b64_tr_b16 a[132:133], v4 offset:49152
v_mfma_f32_16x16x32_bf16 a[232:235], a[20:23], a[140:143], a[232:235]
buffer_load_dwordx4 v17, s[12:15], s26 offen offset:1024 lds
v_mfma_f32_16x16x32_bf16 a[236:239], a[24:27], a[136:139], a[236:239]
ds_read_b64_tr_b16 a[134:135], v4 offset:51200
v_mfma_f32_16x16x32_bf16 a[236:239], a[28:31], a[140:143], a[236:239]
v_mfma_f32_16x16x32_bf16 a[240:243], a[32:35], a[136:139], a[240:243]
v_mfma_f32_16x16x32_bf16 a[240:243], a[36:39], a[140:143], a[240:243]
buffer_load_dwordx4 v18, s[12:15], s26 offen offset:2048 lds
v_mfma_f32_16x16x32_bf16 a[244:247], a[40:43], a[136:139], a[244:247]
v_mfma_f32_16x16x32_bf16 a[244:247], a[44:47], a[140:143], a[244:247]
v_mfma_f32_16x16x32_bf16 a[248:251], a[48:51], a[136:139], a[248:251]
v_mfma_f32_16x16x32_bf16 a[248:251], a[52:55], a[140:143], a[248:251]
s_waitcnt lgkmcnt(0)
buffer_load_dwordx4 v19, s[12:15], s26 offen offset:3072 lds
v_mfma_f32_16x16x32_bf16 a[252:255], a[56:59], a[136:139], a[252:255]
s_add_u32 s26, s26, 524288
s_bitcmp1_b32 s30, 1
v_mfma_f32_16x16x32_bf16 a[252:255], a[60:63], a[140:143], a[252:255]
s_cbranch_scc1 Lg_501
s_cmp_eq_u32 s30, 0
s_cbranch_scc1 Lg_501t
v_mfma_f32_16x16x32_bf16 v[32:35], a[64:67], a[128:131], v[32:35]
s_add_u32 m0, s29, 81920
ds_read_b64_tr_b16 a[136:137], v5 offset:32768
v_mfma_f32_16x16x32_bf16 v[32:35], a[68:71], a[132:135], v[32:35]
buffer_load_dwordx4 v16, s[12:15], s27 offen offset:0 lds
v_mfma_f32_16x16x32_bf16 v[36:39], a[72:75], a[128:131], v[36:39]
s_lshl_b32 s22, s38, 3
ds_read_b64_tr_b16 a[138:139], v5 offset:34816
v_mfma_f32_16x16x32_bf16 v[36:39], a[76:79], a[132:135], v[36:39]
s_lshl_b32 s23, s39, 5
v_and_b32 v252, 31, v0
v_lshrrev_b32 v253, 5, v0
v_mfma_f32_16x16x32_bf16 v[40:43], a[80:83], a[128:131], v[40:43]
ds_read_b64_tr_b16 a[140:141], v5 offset:49152
v_add_u32 v253, s22, v253
v_mfma_f32_16x16x32_bf16 v[40:43], a[84:87], a[132:135], v[40:43]
buffer_load_dwordx4 v17, s[12:15], s27 offen offset:1024 lds
v_mfma_f32_16x16x32_bf16 v[44:47], a[88:91], a[128:131], v[44:47]
ds_read_b64_tr_b16 a[142:143], v5 offset:51200
v_add_u32 v252, s23, v252
v_mfma_f32_16x16x32_bf16 v[44:47], a[92:95], a[132:135], v[44:47]
v_mul_u32_u24 v254, 7168, v253
v_lshl_add_u32 v254, v252, 2, v254
v_mfma_f32_16x16x32_bf16 v[48:51], a[96:99], a[128:131], v[48:51]
ds_read_b128 a[0:3], v2 offset:0
v_lshlrev_b32 v252, 4, v252
v_mfma_f32_16x16x32_bf16 v[48:51], a[100:103], a[132:135], v[48:51]
buffer_load_dwordx4 v18, s[12:15], s27 offen offset:2048 lds
v_mfma_f32_16x16x32_bf16 v[52:55], a[104:107], a[128:131], v[52:55]
ds_read_b128 a[4:7], v3 offset:0
v_add_u32 v255, 3584, v254
v_mfma_f32_16x16x32_bf16 v[52:55], a[108:111], a[132:135], v[52:55]
v_subrev_u32 v22, 3584, v254
v_subrev_u32 v23, 2688, v254
v_mfma_f32_16x16x32_bf16 v[56:59], a[112:115], a[128:131], v[56:59]
v_subrev_u32 v24, 1792, v254
v_subrev_u32 v25, 896, v254
v_mfma_f32_16x16x32_bf16 v[56:59], a[116:119], a[132:135], v[56:59]
buffer_load_dwordx4 v19, s[12:15], s27 offen offset:3072 lds
v_mfma_f32_16x16x32_bf16 v[60:63], a[120:123], a[128:131], v[60:63]
s_add_u32 s27, s27, 524288
ds_read_b128 a[8:11], v2 offset:2048
v_mfma_f32_16x16x32_bf16 v[60:63], a[124:127], a[132:135], v[60:63]
s_waitcnt lgkmcnt(3)
v_mfma_f32_16x16x32_bf16 v[64:67], a[64:67], a[136:139], v[64:67]
s_add_u32 m0, s28, 32768
ds_read_b64_tr_b16 a[128:129], v6 offset:32768
v_mfma_f32_16x16x32_bf16 v[64:67], a[68:71], a[140:143], v[64:67]
buffer_load_dwordx4 v12, s[8:11], s24 offen offset:0 lds
v_mfma_f32_16x16x32_bf16 v[68:71], a[72:75], a[136:139], v[68:71]
ds_read_b64_tr_b16 a[130:131], v6 offset:34816
v_mfma_f32_16x16x32_bf16 v[68:71], a[76:79], a[140:143], v[68:71]
v_mfma_f32_16x16x32_bf16 v[72:75], a[80:83], a[136:139], v[72:75]
ds_read_b64_tr_b16 a[132:133], v6 offset:49152
v_mfma_f32_16x16x32_bf16 v[72:75], a[84:87], a[140:143], v[72:75]
buffer_load_dwordx4 v13, s[8:11], s24 offen offset:1024 lds
v_mfma_f32_16x16x32_bf16 v[76:79], a[88:91], a[136:139], v[76:79]
ds_read_b64_tr_b16 a[134:135], v6 offset:51200
v_mfma_f32_16x16x32_bf16 v[76:79], a[92:95], a[140:143], v[76:79]
PAD_23:
s_cbranch_execz PAD_27
v_mfma_f32_16x16x32_bf16 v[80:83], a[96:99], a[136:139], v[80:83]
ds_read_b128 a[12:15], v3 offset:2048
v_mfma_f32_16x16x32_bf16 v[80:83], a[100:103], a[140:143], v[80:83]
buffer_load_dwordx4 v14, s[8:11], s24 offen offset:2048 lds
v_mfma_f32_16x16x32_bf16 v[84:87], a[104:107], a[136:139], v[84:87]
v_mfma_f32_16x16x32_bf16 v[84:87], a[108:111], a[140:143], v[84:87]
v_mfma_f32_16x16x32_bf16 v[88:91], a[112:115], a[136:139], v[88:91]
ds_read_b128 a[16:19], v2 offset:4096
v_mfma_f32_16x16x32_bf16 v[88:91], a[116:119], a[140:143], v[88:91]
buffer_load_dwordx4 v15, s[8:11], s24 offen offset:3072 lds
v_mfma_f32_16x16x32_bf16 v[92:95], a[120:123], a[136:139], v[92:95]
s_add_u32 s24, s24, 128
ds_read_b128 a[20:23], v3 offset:4096
v_mfma_f32_16x16x32_bf16 v[92:95], a[124:127], a[140:143], v[92:95]
s_waitcnt lgkmcnt(3)
v_mfma_f32_16x16x32_bf16 v[96:99], a[64:67], a[128:131], v[96:99]
s_add_u32 m0, s28, 36864
ds_read_b64_tr_b16 a[136:137], v7 offset:32768
v_mfma_f32_16x16x32_bf16 v[96:99], a[68:71], a[132:135], v[96:99]
buffer_load_dwordx4 v12, s[8:11], s25 offen offset:0 lds
v_mfma_f32_16x16x32_bf16 v[100:103], a[72:75], a[128:131], v[100:103]
ds_read_b64_tr_b16 a[138:139], v7 offset:34816
v_mfma_f32_16x16x32_bf16 v[100:103], a[76:79], a[132:135], v[100:103]
v_mfma_f32_16x16x32_bf16 v[104:107], a[80:83], a[128:131], v[104:107]
ds_read_b64_tr_b16 a[140:141], v7 offset:49152
v_mfma_f32_16x16x32_bf16 v[104:107], a[84:87], a[132:135], v[104:107]
buffer_load_dwordx4 v13, s[8:11], s25 offen offset:1024 lds
v_mfma_f32_16x16x32_bf16 v[108:111], a[88:91], a[128:131], v[108:111]
ds_read_b64_tr_b16 a[142:143], v7 offset:51200
v_mfma_f32_16x16x32_bf16 v[108:111], a[92:95], a[132:135], v[108:111]
v_mfma_f32_16x16x32_bf16 v[112:115], a[96:99], a[128:131], v[112:115]
v_mfma_f32_16x16x32_bf16 v[112:115], a[100:103], a[132:135], v[112:115]
buffer_load_dwordx4 v14, s[8:11], s25 offen offset:2048 lds
v_mfma_f32_16x16x32_bf16 v[116:119], a[104:107], a[128:131], v[116:119]
ds_read_b128 a[24:27], v2 offset:6144
v_mfma_f32_16x16x32_bf16 v[116:119], a[108:111], a[132:135], v[116:119]
v_mfma_f32_16x16x32_bf16 v[120:123], a[112:115], a[128:131], v[120:123]
ds_read_b128 a[28:31], v3 offset:6144
v_mfma_f32_16x16x32_bf16 v[120:123], a[116:119], a[132:135], v[120:123]
buffer_load_dwordx4 v15, s[8:11], s25 offen offset:3072 lds
v_mfma_f32_16x16x32_bf16 v[124:127], a[120:123], a[128:131], v[124:127]
s_add_u32 s25, s25, 128
v_mfma_f32_16x16x32_bf16 v[124:127], a[124:127], a[132:135], v[124:127]
s_waitcnt lgkmcnt(2)
v_mfma_f32_16x16x32_bf16 v[128:131], a[64:67], a[136:139], v[128:131]
s_mov_b64 s[56:57], s[70:71]
s_mov_b32 s58, 3584
s_mov_b32 s59, 0x20000
ds_read_b64_tr_b16 a[128:129], v8 offset:32768
v_mfma_f32_16x16x32_bf16 v[128:131], a[68:71], a[140:143], v[128:131]
buffer_load_dwordx4 v[248:251], v252, s[56:59], 0 offen
v_mfma_f32_16x16x32_bf16 v[132:135], a[72:75], a[136:139], v[132:135]
s_mov_b64 s[56:57], s[66:67]
s_mov_b32 s58, 1835008
ds_read_b64_tr_b16 a[130:131], v8 offset:34816
v_mfma_f32_16x16x32_bf16 v[132:135], a[76:79], a[140:143], v[132:135]
buffer_load_dword v224, v22, s[56:59], 0 offen nt
v_mfma_f32_16x16x32_bf16 v[136:139], a[80:83], a[136:139], v[136:139]
ds_read_b64_tr_b16 a[132:133], v8 offset:49152
v_mfma_f32_16x16x32_bf16 v[136:139], a[84:87], a[140:143], v[136:139]
buffer_load_dword v225, v23, s[56:59], 0 offen nt
v_mfma_f32_16x16x32_bf16 v[140:143], a[88:91], a[136:139], v[140:143]
ds_read_b64_tr_b16 a[134:135], v8 offset:51200
v_mfma_f32_16x16x32_bf16 v[140:143], a[92:95], a[140:143], v[140:143]
buffer_load_dword v226, v24, s[56:59], 0 offen nt
v_mfma_f32_16x16x32_bf16 v[144:147], a[96:99], a[136:139], v[144:147]
ds_read_b128 a[32:35], v2 offset:8192
v_mfma_f32_16x16x32_bf16 v[144:147], a[100:103], a[140:143], v[144:147]
buffer_load_dword v227, v25, s[56:59], 0 offen nt
v_mfma_f32_16x16x32_bf16 v[148:151], a[104:107], a[136:139], v[148:151]
buffer_load_dword v228, v254, s[56:59], 0 offen offset:0 nt
v_mfma_f32_16x16x32_bf16 v[148:151], a[108:111], a[140:143], v[148:151]
buffer_load_dword v229, v254, s[56:59], 0 offen offset:896 nt
v_mfma_f32_16x16x32_bf16 v[152:155], a[112:115], a[136:139], v[152:155]
ds_read_b128 a[36:39], v3 offset:8192
v_mfma_f32_16x16x32_bf16 v[152:155], a[116:119], a[140:143], v[152:155]
buffer_load_dword v230, v254, s[56:59], 0 offen offset:1792 nt
v_mfma_f32_16x16x32_bf16 v[156:159], a[120:123], a[136:139], v[156:159]
ds_read_b128 a[40:43], v2 offset:10240
v_mfma_f32_16x16x32_bf16 v[156:159], a[124:127], a[140:143], v[156:159]
s_waitcnt lgkmcnt(3)
buffer_load_dword v231, v254, s[56:59], 0 offen offset:2688 nt
v_mfma_f32_16x16x32_bf16 v[160:163], a[64:67], a[128:131], v[160:163]
ds_read_b64_tr_b16 a[136:137], v9 offset:32768
v_mfma_f32_16x16x32_bf16 v[160:163], a[68:71], a[132:135], v[160:163]
buffer_load_dword v232, v255, s[56:59], 0 offen offset:0 nt
v_mfma_f32_16x16x32_bf16 v[164:167], a[72:75], a[128:131], v[164:167]
ds_read_b64_tr_b16 a[138:139], v9 offset:34816
v_mfma_f32_16x16x32_bf16 v[164:167], a[76:79], a[132:135], v[164:167]
buffer_load_dword v233, v255, s[56:59], 0 offen offset:896 nt
v_mfma_f32_16x16x32_bf16 v[168:171], a[80:83], a[128:131], v[168:171]
ds_read_b64_tr_b16 a[140:141], v9 offset:49152
v_mfma_f32_16x16x32_bf16 v[168:171], a[84:87], a[132:135], v[168:171]
buffer_load_dword v234, v255, s[56:59], 0 offen offset:1792 nt
v_mfma_f32_16x16x32_bf16 v[172:175], a[88:91], a[128:131], v[172:175]
ds_read_b64_tr_b16 a[142:143], v9 offset:51200
v_mfma_f32_16x16x32_bf16 v[172:175], a[92:95], a[132:135], v[172:175]
buffer_load_dword v235, v255, s[56:59], 0 offen offset:2688 nt
v_mfma_f32_16x16x32_bf16 v[176:179], a[96:99], a[128:131], v[176:179]
s_mov_b64 s[56:57], s[68:69]
buffer_load_dword v236, v25, s[56:59], 0 offen nt
v_mfma_f32_16x16x32_bf16 v[176:179], a[100:103], a[132:135], v[176:179]
buffer_load_dword v237, v254, s[56:59], 0 offen offset:0 nt
v_mfma_f32_16x16x32_bf16 v[180:183], a[104:107], a[128:131], v[180:183]
ds_read_b128 a[44:47], v3 offset:10240
v_mfma_f32_16x16x32_bf16 v[180:183], a[108:111], a[132:135], v[180:183]
buffer_load_dword v238, v254, s[56:59], 0 offen offset:896 nt
v_mfma_f32_16x16x32_bf16 v[184:187], a[112:115], a[128:131], v[184:187]
ds_read_b128 a[48:51], v2 offset:12288
v_mfma_f32_16x16x32_bf16 v[184:187], a[116:119], a[132:135], v[184:187]
buffer_load_dword v239, v254, s[56:59], 0 offen offset:1792 nt
v_mfma_f32_16x16x32_bf16 v[188:191], a[120:123], a[128:131], v[188:191]
buffer_load_dword v240, v254, s[56:59], 0 offen offset:2688 nt
v_mfma_f32_16x16x32_bf16 v[188:191], a[124:127], a[132:135], v[188:191]
s_waitcnt lgkmcnt(2)
buffer_load_dword v241, v255, s[56:59], 0 offen offset:0 nt
v_mfma_f32_16x16x32_bf16 v[192:195], a[64:67], a[136:139], v[192:195]
ds_read_b64_tr_b16 a[128:129], v10 offset:32768
v_mfma_f32_16x16x32_bf16 v[192:195], a[68:71], a[140:143], v[192:195]
buffer_load_dword v242, v255, s[56:59], 0 offen offset:896 nt
v_mfma_f32_16x16x32_bf16 v[196:199], a[72:75], a[136:139], v[196:199]
ds_read_b64_tr_b16 a[130:131], v10 offset:34816
v_mfma_f32_16x16x32_bf16 v[196:199], a[76:79], a[140:143], v[196:199]
buffer_load_dword v243, v255, s[56:59], 0 offen offset:1792 nt
v_mfma_f32_16x16x32_bf16 v[200:203], a[80:83], a[136:139], v[200:203]
ds_read_b64_tr_b16 a[132:133], v10 offset:49152
v_mfma_f32_16x16x32_bf16 v[200:203], a[84:87], a[140:143], v[200:203]
buffer_load_dword v244, v255, s[56:59], 0 offen offset:2688 nt
v_mfma_f32_16x16x32_bf16 v[204:207], a[88:91], a[136:139], v[204:207]
ds_read_b64_tr_b16 a[134:135], v10 offset:51200
v_mfma_f32_16x16x32_bf16 v[204:207], a[92:95], a[140:143], v[204:207]
v_mfma_f32_16x16x32_bf16 v[208:211], a[96:99], a[136:139], v[208:211]
ds_read_b128 a[52:55], v3 offset:12288
v_mfma_f32_16x16x32_bf16 v[208:211], a[100:103], a[140:143], v[208:211]
v_mfma_f32_16x16x32_bf16 v[212:215], a[104:107], a[136:139], v[212:215]
ds_read_b128 a[56:59], v2 offset:14336
v_mfma_f32_16x16x32_bf16 v[212:215], a[108:111], a[140:143], v[212:215]
v_mfma_f32_16x16x32_bf16 v[216:219], a[112:115], a[136:139], v[216:219]
v_mfma_f32_16x16x32_bf16 v[216:219], a[116:119], a[140:143], v[216:219]
v_mfma_f32_16x16x32_bf16 v[220:223], a[120:123], a[136:139], v[220:223]
ds_read_b128 a[60:63], v3 offset:14336
v_mfma_f32_16x16x32_bf16 v[220:223], a[124:127], a[140:143], v[220:223]
s_waitcnt lgkmcnt(3)
v_mfma_f32_16x16x32_bf16 a[192:195], a[64:67], a[128:131], a[192:195]
ds_read_b64_tr_b16 a[136:137], v11 offset:32768
v_mfma_f32_16x16x32_bf16 a[192:195], a[68:71], a[132:135], a[192:195]
v_mfma_f32_16x16x32_bf16 a[196:199], a[72:75], a[128:131], a[196:199]
ds_read_b64_tr_b16 a[138:139], v11 offset:34816
v_mfma_f32_16x16x32_bf16 a[196:199], a[76:79], a[132:135], a[196:199]
v_mfma_f32_16x16x32_bf16 a[200:203], a[80:83], a[128:131], a[200:203]
ds_read_b64_tr_b16 a[140:141], v11 offset:49152
v_mfma_f32_16x16x32_bf16 a[200:203], a[84:87], a[132:135], a[200:203]
v_mfma_f32_16x16x32_bf16 a[204:207], a[88:91], a[128:131], a[204:207]
ds_read_b64_tr_b16 a[142:143], v11 offset:51200
v_mfma_f32_16x16x32_bf16 a[204:207], a[92:95], a[132:135], a[204:207]
v_mfma_f32_16x16x32_bf16 a[208:211], a[96:99], a[128:131], a[208:211]
v_mfma_f32_16x16x32_bf16 a[208:211], a[100:103], a[132:135], a[208:211]
v_mfma_f32_16x16x32_bf16 a[212:215], a[104:107], a[128:131], a[212:215]
v_mfma_f32_16x16x32_bf16 a[212:215], a[108:111], a[132:135], a[212:215]
v_mfma_f32_16x16x32_bf16 a[216:219], a[112:115], a[128:131], a[216:219]
v_mfma_f32_16x16x32_bf16 a[216:219], a[116:119], a[132:135], a[216:219]
v_mfma_f32_16x16x32_bf16 a[220:223], a[120:123], a[128:131], a[220:223]
s_waitcnt vmcnt(22) lgkmcnt(0)
v_mfma_f32_16x16x32_bf16 a[220:223], a[124:127], a[132:135], a[220:223]
s_barrier
v_mfma_f32_16x16x32_bf16 a[224:227], a[64:67], a[136:139], a[224:227]
s_add_u32 m0, s29, 98304
ds_read_b64_tr_b16 a[128:129], v4 offset:0
v_mfma_f32_16x16x32_bf16 a[224:227], a[68:71], a[140:143], a[224:227]
buffer_load_dwordx4 v16, s[12:15], s26 offen offset:0 lds
v_mfma_f32_16x16x32_bf16 a[228:231], a[72:75], a[136:139], a[228:231]
ds_read_b64_tr_b16 a[130:131], v4 offset:2048
v_mfma_f32_16x16x32_bf16 a[228:231], a[76:79], a[140:143], a[228:231]
v_mfma_f32_16x16x32_bf16 a[232:235], a[80:83], a[136:139], a[232:235]
ds_read_b64_tr_b16 a[132:133], v4 offset:16384
v_mfma_f32_16x16x32_bf16 a[232:235], a[84:87], a[140:143], a[232:235]
buffer_load_dwordx4 v17, s[12:15], s26 offen offset:1024 lds
v_mfma_f32_16x16x32_bf16 a[236:239], a[88:91], a[136:139], a[236:239]
ds_read_b64_tr_b16 a[134:135], v4 offset:18432
v_mfma_f32_16x16x32_bf16 a[236:239], a[92:95], a[140:143], a[236:239]
v_mfma_f32_16x16x32_bf16 a[240:243], a[96:99], a[136:139], a[240:243]
v_mfma_f32_16x16x32_bf16 a[240:243], a[100:103], a[140:143], a[240:243]
buffer_load_dwordx4 v18, s[12:15], s26 offen offset:2048 lds
v_mfma_f32_16x16x32_bf16 a[244:247], a[104:107], a[136:139], a[244:247]
v_mfma_f32_16x16x32_bf16 a[244:247], a[108:111], a[140:143], a[244:247]
v_mfma_f32_16x16x32_bf16 a[248:251], a[112:115], a[136:139], a[248:251]
v_mfma_f32_16x16x32_bf16 a[248:251], a[116:119], a[140:143], a[248:251]
buffer_load_dwordx4 v19, s[12:15], s26 offen offset:3072 lds
v_mfma_f32_16x16x32_bf16 a[252:255], a[120:123], a[136:139], a[252:255]
s_add_u32 s26, s26, 524288
v_mfma_f32_16x16x32_bf16 a[252:255], a[124:127], a[140:143], a[252:255]
s_waitcnt lgkmcnt(0)
v_mfma_f32_16x16x32_bf16 v[32:35], a[0:3], a[128:131], v[32:35]
s_add_u32 m0, s29, 114688
ds_read_b64_tr_b16 a[136:137], v5 offset:0
v_mfma_f32_16x16x32_bf16 v[32:35], a[4:7], a[132:135], v[32:35]
buffer_load_dwordx4 v16, s[12:15], s27 offen offset:0 lds
v_mfma_f32_16x16x32_bf16 v[36:39], a[8:11], a[128:131], v[36:39]
ds_read_b64_tr_b16 a[138:139], v5 offset:2048
v_mfma_f32_16x16x32_bf16 v[36:39], a[12:15], a[132:135], v[36:39]
v_mfma_f32_16x16x32_bf16 v[40:43], a[16:19], a[128:131], v[40:43]
ds_read_b64_tr_b16 a[140:141], v5 offset:16384
v_mfma_f32_16x16x32_bf16 v[40:43], a[20:23], a[132:135], v[40:43]
buffer_load_dwordx4 v17, s[12:15], s27 offen offset:1024 lds
v_mfma_f32_16x16x32_bf16 v[44:47], a[24:27], a[128:131], v[44:47]
ds_read_b64_tr_b16 a[142:143], v5 offset:18432
v_mfma_f32_16x16x32_bf16 v[44:47], a[28:31], a[132:135], v[44:47]
v_mfma_f32_16x16x32_bf16 v[48:51], a[32:35], a[128:131], v[48:51]
ds_read_b128 a[64:67], v2 offset:32768
v_mfma_f32_16x16x32_bf16 v[48:51], a[36:39], a[132:135], v[48:51]
buffer_load_dwordx4 v18, s[12:15], s27 offen offset:2048 lds
v_mfma_f32_16x16x32_bf16 v[52:55], a[40:43], a[128:131], v[52:55]
ds_read_b128 a[68:71], v3 offset:32768
v_mfma_f32_16x16x32_bf16 v[52:55], a[44:47], a[132:135], v[52:55]
v_mfma_f32_16x16x32_bf16 v[56:59], a[48:51], a[128:131], v[56:59]
v_mfma_f32_16x16x32_bf16 v[56:59], a[52:55], a[132:135], v[56:59]
buffer_load_dwordx4 v19, s[12:15], s27 offen offset:3072 lds
v_mfma_f32_16x16x32_bf16 v[60:63], a[56:59], a[128:131], v[60:63]
s_add_u32 s27, s27, 524288
ds_read_b128 a[72:75], v2 offset:34816
v_mfma_f32_16x16x32_bf16 v[60:63], a[60:63], a[132:135], v[60:63]
s_waitcnt lgkmcnt(3)
v_mfma_f32_16x16x32_bf16 v[64:67], a[0:3], a[136:139], v[64:67]
s_add_u32 m0, s28, 0
ds_read_b64_tr_b16 a[128:129], v6 offset:0
v_mfma_f32_16x16x32_bf16 v[64:67], a[4:7], a[140:143], v[64:67]
buffer_load_dwordx4 v12, s[8:11], s24 offen offset:0 lds
v_mfma_f32_16x16x32_bf16 v[68:71], a[8:11], a[136:139], v[68:71]
ds_read_b64_tr_b16 a[130:131], v6 offset:2048
v_mfma_f32_16x16x32_bf16 v[68:71], a[12:15], a[140:143], v[68:71]
v_mfma_f32_16x16x32_bf16 v[72:75], a[16:19], a[136:139], v[72:75]
ds_read_b64_tr_b16 a[132:133], v6 offset:16384
v_mfma_f32_16x16x32_bf16 v[72:75], a[20:23], a[140:143], v[72:75]
buffer_load_dwordx4 v13, s[8:11], s24 offen offset:1024 lds
v_mfma_f32_16x16x32_bf16 v[76:79], a[24:27], a[136:139], v[76:79]
ds_read_b64_tr_b16 a[134:135], v6 offset:18432
v_mfma_f32_16x16x32_bf16 v[76:79], a[28:31], a[140:143], v[76:79]
v_mfma_f32_16x16x32_bf16 v[80:83], a[32:35], a[136:139], v[80:83]
ds_read_b128 a[76:79], v3 offset:34816
v_mfma_f32_16x16x32_bf16 v[80:83], a[36:39], a[140:143], v[80:83]
buffer_load_dwordx4 v14, s[8:11], s24 offen offset:2048 lds
v_mfma_f32_16x16x32_bf16 v[84:87], a[40:43], a[136:139], v[84:87]
v_mfma_f32_16x16x32_bf16 v[84:87], a[44:47], a[140:143], v[84:87]
v_mfma_f32_16x16x32_bf16 v[88:91], a[48:51], a[136:139], v[88:91]
ds_read_b128 a[80:83], v2 offset:36864
v_mfma_f32_16x16x32_bf16 v[88:91], a[52:55], a[140:143], v[88:91]
buffer_load_dwordx4 v15, s[8:11], s24 offen offset:3072 lds
v_mfma_f32_16x16x32_bf16 v[92:95], a[56:59], a[136:139], v[92:95]
s_add_u32 s24, s24, 128
ds_read_b128 a[84:87], v3 offset:36864
v_mfma_f32_16x16x32_bf16 v[92:95], a[60:63], a[140:143], v[92:95]
s_waitcnt lgkmcnt(3)
v_mfma_f32_16x16x32_bf16 v[96:99], a[0:3], a[128:131], v[96:99]
s_add_u32 m0, s28, 4096
ds_read_b64_tr_b16 a[136:137], v7 offset:0
v_mfma_f32_16x16x32_bf16 v[96:99], a[4:7], a[132:135], v[96:99]
buffer_load_dwordx4 v12, s[8:11], s25 offen offset:0 lds
v_mfma_f32_16x16x32_bf16 v[100:103], a[8:11], a[128:131], v[100:103]
ds_read_b64_tr_b16 a[138:139], v7 offset:2048
v_mfma_f32_16x16x32_bf16 v[100:103], a[12:15], a[132:135], v[100:103]
v_mfma_f32_16x16x32_bf16 v[104:107], a[16:19], a[128:131], v[104:107]
ds_read_b64_tr_b16 a[140:141], v7 offset:16384
v_mfma_f32_16x16x32_bf16 v[104:107], a[20:23], a[132:135], v[104:107]
buffer_load_dwordx4 v13, s[8:11], s25 offen offset:1024 lds
v_mfma_f32_16x16x32_bf16 v[108:111], a[24:27], a[128:131], v[108:111]
ds_read_b64_tr_b16 a[142:143], v7 offset:18432
v_mfma_f32_16x16x32_bf16 v[108:111], a[28:31], a[132:135], v[108:111]
v_mfma_f32_16x16x32_bf16 v[112:115], a[32:35], a[128:131], v[112:115]
v_mfma_f32_16x16x32_bf16 v[112:115], a[36:39], a[132:135], v[112:115]
buffer_load_dwordx4 v14, s[8:11], s25 offen offset:2048 lds
v_mfma_f32_16x16x32_bf16 v[116:119], a[40:43], a[128:131], v[116:119]
ds_read_b128 a[88:91], v2 offset:38912
v_mfma_f32_16x16x32_bf16 v[116:119], a[44:47], a[132:135], v[116:119]
v_mfma_f32_16x16x32_bf16 v[120:123], a[48:51], a[128:131], v[120:123]
ds_read_b128 a[92:95], v3 offset:38912
v_mfma_f32_16x16x32_bf16 v[120:123], a[52:55], a[132:135], v[120:123]
buffer_load_dwordx4 v15, s[8:11], s25 offen offset:3072 lds
v_mfma_f32_16x16x32_bf16 v[124:127], a[56:59], a[128:131], v[124:127]
s_add_u32 s25, s25, 128
v_mfma_f32_16x16x32_bf16 v[124:127], a[60:63], a[132:135], v[124:127]
s_waitcnt lgkmcnt(2)
v_mfma_f32_16x16x32_bf16 v[128:131], a[0:3], a[136:139], v[128:131]
ds_read_b64_tr_b16 a[128:129], v8 offset:0
v_mfma_f32_16x16x32_bf16 v[128:131], a[4:7], a[140:143], v[128:131]
buffer_load_dword v21, v20, s[16:19], s43 offen
v_mfma_f32_16x16x32_bf16 v[132:135], a[8:11], a[136:139], v[132:135]
s_add_u32 s43, s43, s47
ds_read_b64_tr_b16 a[130:131], v8 offset:2048
v_mfma_f32_16x16x32_bf16 v[132:135], a[12:15], a[140:143], v[132:135]
s_cmp_ge_u32 s43, s51
v_mfma_f32_16x16x32_bf16 v[136:139], a[16:19], a[136:139], v[136:139]
s_cselect_b32 s43, 0, s43
ds_read_b64_tr_b16 a[132:133], v8 offset:16384
v_mfma_f32_16x16x32_bf16 v[136:139], a[20:23], a[140:143], v[136:139]
s_cselect_b32 s51, s42, s51
v_mfma_f32_16x16x32_bf16 v[140:143], a[24:27], a[136:139], v[140:143]
s_cselect_b64 s[16:17], s[40:41], s[16:17]
ds_read_b64_tr_b16 a[134:135], v8 offset:18432
v_mfma_f32_16x16x32_bf16 v[140:143], a[28:31], a[140:143], v[140:143]
s_cselect_b32 s18, s42, s18
v_mfma_f32_16x16x32_bf16 v[144:147], a[32:35], a[136:139], v[144:147]
s_cselect_b64 s[40:41], s[44:45], s[40:41]
ds_read_b128 a[96:99], v2 offset:40960
v_mfma_f32_16x16x32_bf16 v[144:147], a[36:39], a[140:143], v[144:147]
s_cselect_b32 s42, s46, s42
v_mfma_f32_16x16x32_bf16 v[148:151], a[40:43], a[136:139], v[148:151]
s_cselect_b32 s46, 0, s46
v_mfma_f32_16x16x32_bf16 v[148:151], a[44:47], a[140:143], v[148:151]
s_lshl_b32 s59, s39, 5
v_mfma_f32_16x16x32_bf16 v[152:155], a[48:51], a[136:139], v[152:155]
s_add_u32 s59, s59, s38
ds_read_b128 a[100:103], v3 offset:40960
v_mfma_f32_16x16x32_bf16 v[152:155], a[52:55], a[140:143], v[152:155]
s_lshl_b32 s59, s59, 2
v_mfma_f32_16x16x32_bf16 v[156:159], a[56:59], a[136:139], v[156:159]
s_add_u32 s59, s59, 94392320
ds_read_b128 a[104:107], v2 offset:43008
v_mfma_f32_16x16x32_bf16 v[156:159], a[60:63], a[140:143], v[156:159]
s_waitcnt lgkmcnt(3)
s_cmp_lt_u32 s2, 224
v_mfma_f32_16x16x32_bf16 v[160:163], a[0:3], a[128:131], v[160:163]
s_cselect_b32 s59, s59, 3221225472
ds_read_b64_tr_b16 a[136:137], v9 offset:0
v_mfma_f32_16x16x32_bf16 v[160:163], a[4:7], a[132:135], v[160:163]
s_mov_b32 s58, 0xffff0000
v_mfma_f32_16x16x32_bf16 v[164:167], a[8:11], a[128:131], v[164:167]
s_cmp_lt_u32 s3, 1
ds_read_b64_tr_b16 a[138:139], v9 offset:2048
v_mfma_f32_16x16x32_bf16 v[164:167], a[12:15], a[132:135], v[164:167]
s_cselect_b32 s54, 0, 3221225472
v_mfma_f32_16x16x32_bf16 v[168:171], a[16:19], a[128:131], v[168:171]
s_cselect_b32 s50, 0x100, 0
ds_read_b64_tr_b16 a[140:141], v9 offset:16384
v_mfma_f32_16x16x32_bf16 v[168:171], a[20:23], a[132:135], v[168:171]
v_mfma_f32_16x16x32_bf16 v[172:175], a[24:27], a[128:131], v[172:175]
ds_read_b64_tr_b16 a[142:143], v9 offset:18432
v_mfma_f32_16x16x32_bf16 v[172:175], a[28:31], a[132:135], v[172:175]
v_mfma_f32_16x16x32_bf16 v[176:179], a[32:35], a[128:131], v[176:179]
v_mfma_f32_16x16x32_bf16 v[176:179], a[36:39], a[132:135], v[176:179]
v_mfma_f32_16x16x32_bf16 v[180:183], a[40:43], a[128:131], v[180:183]
ds_read_b128 a[108:111], v3 offset:43008
v_mfma_f32_16x16x32_bf16 v[180:183], a[44:47], a[132:135], v[180:183]
v_mfma_f32_16x16x32_bf16 v[184:187], a[48:51], a[128:131], v[184:187]
ds_read_b128 a[112:115], v2 offset:45056
v_mfma_f32_16x16x32_bf16 v[184:187], a[52:55], a[132:135], v[184:187]
v_mfma_f32_16x16x32_bf16 v[188:191], a[56:59], a[128:131], v[188:191]
v_mfma_f32_16x16x32_bf16 v[188:191], a[60:63], a[132:135], v[188:191]
s_waitcnt lgkmcnt(2)
v_mfma_f32_16x16x32_bf16 v[192:195], a[0:3], a[136:139], v[192:195]
ds_read_b64_tr_b16 a[128:129], v10 offset:0
v_mfma_f32_16x16x32_bf16 v[192:195], a[4:7], a[140:143], v[192:195]
v_mfma_f32_16x16x32_bf16 v[196:199], a[8:11], a[136:139], v[196:199]
ds_read_b64_tr_b16 a[130:131], v10 offset:2048
v_mfma_f32_16x16x32_bf16 v[196:199], a[12:15], a[140:143], v[196:199]
v_mfma_f32_16x16x32_bf16 v[200:203], a[16:19], a[136:139], v[200:203]
ds_read_b64_tr_b16 a[132:133], v10 offset:16384
v_mfma_f32_16x16x32_bf16 v[200:203], a[20:23], a[140:143], v[200:203]
v_mfma_f32_16x16x32_bf16 v[204:207], a[24:27], a[136:139], v[204:207]
ds_read_b64_tr_b16 a[134:135], v10 offset:18432
v_mfma_f32_16x16x32_bf16 v[204:207], a[28:31], a[140:143], v[204:207]
v_mfma_f32_16x16x32_bf16 v[208:211], a[32:35], a[136:139], v[208:211]
ds_read_b128 a[116:119], v3 offset:45056
v_mfma_f32_16x16x32_bf16 v[208:211], a[36:39], a[140:143], v[208:211]
v_mfma_f32_16x16x32_bf16 v[212:215], a[40:43], a[136:139], v[212:215]
ds_read_b128 a[120:123], v2 offset:47104
v_and_b32 v252, 31, v0
v_mfma_f32_16x16x32_bf16 v[212:215], a[44:47], a[140:143], v[212:215]
v_lshrrev_b32 v253, 5, v0
v_xor_b32 v253, v253, v252
v_mfma_f32_16x16x32_bf16 v[216:219], a[48:51], a[136:139], v[216:219]
v_and_b32 v253, 7, v253
v_lshlrev_b32 v252, 8, v252
v_mfma_f32_16x16x32_bf16 v[216:219], a[52:55], a[140:143], v[216:219]
v_lshl_add_u32 v252, v253, 4, v252
v_add_u32 v252, 147456, v252
v_mfma_f32_16x16x32_bf16 v[220:223], a[56:59], a[136:139], v[220:223]
ds_read_b128 a[124:127], v3 offset:47104
v_mfma_f32_16x16x32_bf16 v[220:223], a[60:63], a[140:143], v[220:223]
s_waitcnt lgkmcnt(3)
v_mfma_f32_16x16x32_bf16 a[192:195], a[0:3], a[128:131], a[192:195]
ds_read_b64_tr_b16 a[136:137], v11 offset:0
v_mfma_f32_16x16x32_bf16 a[192:195], a[4:7], a[132:135], a[192:195]
v_mfma_f32_16x16x32_bf16 a[196:199], a[8:11], a[128:131], a[196:199]
ds_read_b64_tr_b16 a[138:139], v11 offset:2048
v_mfma_f32_16x16x32_bf16 a[196:199], a[12:15], a[132:135], a[196:199]
v_mfma_f32_16x16x32_bf16 a[200:203], a[16:19], a[128:131], a[200:203]
ds_read_b64_tr_b16 a[140:141], v11 offset:16384
v_mfma_f32_16x16x32_bf16 a[200:203], a[20:23], a[132:135], a[200:203]
v_mfma_f32_16x16x32_bf16 a[204:207], a[24:27], a[128:131], a[204:207]
ds_read_b64_tr_b16 a[142:143], v11 offset:18432
v_mfma_f32_16x16x32_bf16 a[204:207], a[28:31], a[132:135], a[204:207]
v_mfma_f32_16x16x32_bf16 a[208:211], a[32:35], a[128:131], a[208:211]
v_mfma_f32_16x16x32_bf16 a[208:211], a[36:39], a[132:135], a[208:211]
v_mfma_f32_16x16x32_bf16 a[212:215], a[40:43], a[128:131], a[212:215]
v_mfma_f32_16x16x32_bf16 a[212:215], a[44:47], a[132:135], a[212:215]
v_mfma_f32_16x16x32_bf16 a[216:219], a[48:51], a[128:131], a[216:219]
v_mfma_f32_16x16x32_bf16 a[216:219], a[52:55], a[132:135], a[216:219]
v_mfma_f32_16x16x32_bf16 a[220:223], a[56:59], a[128:131], a[220:223]
s_waitcnt vmcnt(1) lgkmcnt(0)
v_mfma_f32_16x16x32_bf16 a[220:223], a[60:63], a[132:135], a[220:223]
s_barrier
v_mfma_f32_16x16x32_bf16 a[224:227], a[0:3], a[136:139], a[224:227]
s_add_u32 m0, s29, 65536
ds_read_b64_tr_b16 a[128:129], v4 offset:32768
v_lshlrev_b32 v28, 16, v248
v_mfma_f32_16x16x32_bf16 a[224:227], a[4:7], a[140:143], a[224:227]
buffer_load_dwordx4 v16, s[12:15], s26 offen offset:0 lds
v_mfma_f32_16x16x32_bf16 a[228:231], a[8:11], a[136:139], a[228:231]
ds_read_b64_tr_b16 a[130:131], v4 offset:34816
v_and_b32 v29, s58, v248
v_mfma_f32_16x16x32_bf16 a[228:231], a[12:15], a[140:143], a[228:231]
v_lshlrev_b32 v30, 16, v249
v_and_b32 v253, s58, v249
v_mfma_f32_16x16x32_bf16 a[232:235], a[16:19], a[136:139], a[232:235]
ds_read_b64_tr_b16 a[132:133], v4 offset:49152
v_lshlrev_b32 v22, 16, v224
v_mfma_f32_16x16x32_bf16 a[232:235], a[20:23], a[140:143], a[232:235]
buffer_load_dwordx4 v17, s[12:15], s26 offen offset:1024 lds
v_mfma_f32_16x16x32_bf16 a[236:239], a[24:27], a[136:139], a[236:239]
ds_read_b64_tr_b16 a[134:135], v4 offset:51200
v_lshlrev_b32 v23, 16, v225
v_mfma_f32_16x16x32_bf16 a[236:239], a[28:31], a[140:143], a[236:239]
v_lshlrev_b32 v24, 16, v226
v_mul_f32 v254, v22, v253
v_mfma_f32_16x16x32_bf16 a[240:243], a[32:35], a[136:139], a[240:243]
v_lshlrev_b32 v25, 16, v227
v_lshlrev_b32 v247, 16, v236
v_mfma_f32_16x16x32_bf16 a[240:243], a[36:39], a[140:143], a[240:243]
buffer_load_dwordx4 v18, s[12:15], s26 offen offset:2048 lds
v_mfma_f32_16x16x32_bf16 a[244:247], a[40:43], a[136:139], a[244:247]
v_fmac_f32 v254, v23, v30
v_fmac_f32 v254, v24, v29
v_mfma_f32_16x16x32_bf16 a[244:247], a[44:47], a[140:143], a[244:247]
v_fmac_f32 v254, v25, v28
v_mul_f32 v254, v254, v247
v_mfma_f32_16x16x32_bf16 a[248:251], a[48:51], a[136:139], a[248:251]
v_mul_f32 v255, v23, v253
v_lshlrev_b32 v22, 16, v228
v_mfma_f32_16x16x32_bf16 a[248:251], a[52:55], a[140:143], a[248:251]
buffer_load_dwordx4 v19, s[12:15], s26 offen offset:3072 lds
v_mfma_f32_16x16x32_bf16 a[252:255], a[56:59], a[136:139], a[252:255]
s_add_u32 s26, s26, 524288
v_lshlrev_b32 v247, 16, v237
v_fmac_f32 v255, v24, v30
v_mfma_f32_16x16x32_bf16 a[252:255], a[60:63], a[140:143], a[252:255]
s_waitcnt lgkmcnt(0)
v_fmac_f32 v255, v25, v29
v_fmac_f32 v255, v22, v28
v_mfma_f32_16x16x32_bf16 v[32:35], a[64:67], a[128:131], v[32:35]
s_add_u32 m0, s29, 81920
ds_read_b64_tr_b16 a[136:137], v5 offset:32768
v_mul_f32 v255, v255, v247
v_mfma_f32_16x16x32_bf16 v[32:35], a[68:71], a[132:135], v[32:35]
buffer_load_dwordx4 v16, s[12:15], s27 offen offset:0 lds
v_mfma_f32_16x16x32_bf16 v[36:39], a[72:75], a[128:131], v[36:39]
ds_read_b64_tr_b16 a[138:139], v5 offset:34816
v_cvt_pk_bf16_f32 v246, v254, v255
v_mfma_f32_16x16x32_bf16 v[36:39], a[76:79], a[132:135], v[36:39]
v_accvgpr_write_b32 a180, v246
v_mul_f32 v254, v24, v253
v_mfma_f32_16x16x32_bf16 v[40:43], a[80:83], a[128:131], v[40:43]
ds_read_b64_tr_b16 a[140:141], v5 offset:49152
v_lshlrev_b32 v23, 16, v229
v_mfma_f32_16x16x32_bf16 v[40:43], a[84:87], a[132:135], v[40:43]
buffer_load_dwordx4 v17, s[12:15], s27 offen offset:1024 lds
v_mfma_f32_16x16x32_bf16 v[44:47], a[88:91], a[128:131], v[44:47]
ds_read_b64_tr_b16 a[142:143], v5 offset:51200
v_lshlrev_b32 v247, 16, v238
v_mfma_f32_16x16x32_bf16 v[44:47], a[92:95], a[132:135], v[44:47]
v_fmac_f32 v254, v25, v30
v_fmac_f32 v254, v22, v29
v_fmac_f32 v254, v23, v28
v_mfma_f32_16x16x32_bf16 v[48:51], a[96:99], a[128:131], v[48:51]
ds_read_b128 a[0:3], v2 offset:0
v_mul_f32 v254, v254, v247
v_mfma_f32_16x16x32_bf16 v[48:51], a[100:103], a[132:135], v[48:51]
buffer_load_dwordx4 v18, s[12:15], s27 offen offset:2048 lds
v_mfma_f32_16x16x32_bf16 v[52:55], a[104:107], a[128:131], v[52:55]
ds_read_b128 a[4:7], v3 offset:0
v_cvt_pk_bf16_f32 v246, v255, v254
v_mfma_f32_16x16x32_bf16 v[52:55], a[108:111], a[132:135], v[52:55]
v_accvgpr_write_b32 a176, v246
v_mul_f32 v255, v25, v253
v_mfma_f32_16x16x32_bf16 v[56:59], a[112:115], a[128:131], v[56:59]
v_lshlrev_b32 v24, 16, v230
v_lshlrev_b32 v247, 16, v239
v_mfma_f32_16x16x32_bf16 v[56:59], a[116:119], a[132:135], v[56:59]
buffer_load_dwordx4 v19, s[12:15], s27 offen offset:3072 lds
v_mfma_f32_16x16x32_bf16 v[60:63], a[120:123], a[128:131], v[60:63]
s_add_u32 s27, s27, 524288
ds_read_b128 a[8:11], v2 offset:2048
v_fmac_f32 v255, v22, v30
v_mfma_f32_16x16x32_bf16 v[60:63], a[124:127], a[132:135], v[60:63]
s_waitcnt lgkmcnt(3)
v_fmac_f32 v255, v23, v29
v_fmac_f32 v255, v24, v28
v_mul_f32 v255, v255, v247
v_mfma_f32_16x16x32_bf16 v[64:67], a[64:67], a[136:139], v[64:67]
s_add_u32 m0, s28, 32768
ds_read_b64_tr_b16 a[128:129], v6 offset:32768
v_cvt_pk_bf16_f32 v246, v254, v255
v_mfma_f32_16x16x32_bf16 v[64:67], a[68:71], a[140:143], v[64:67]
buffer_load_dwordx4 v12, s[8:11], s24 offen offset:0 lds
v_mfma_f32_16x16x32_bf16 v[68:71], a[72:75], a[136:139], v[68:71]
ds_read_b64_tr_b16 a[130:131], v6 offset:34816
v_accvgpr_write_b32 a181, v246
v_mfma_f32_16x16x32_bf16 v[68:71], a[76:79], a[140:143], v[68:71]
v_mul_f32 v254, v22, v253
v_lshlrev_b32 v25, 16, v231
v_mfma_f32_16x16x32_bf16 v[72:75], a[80:83], a[136:139], v[72:75]
ds_read_b64_tr_b16 a[132:133], v6 offset:49152
v_lshlrev_b32 v247, 16, v240
v_mfma_f32_16x16x32_bf16 v[72:75], a[84:87], a[140:143], v[72:75]
buffer_load_dwordx4 v13, s[8:11], s24 offen offset:1024 lds
v_mfma_f32_16x16x32_bf16 v[76:79], a[88:91], a[136:139], v[76:79]
ds_read_b64_tr_b16 a[134:135], v6 offset:51200
v_fmac_f32 v254, v23, v30
v_fmac_f32 v254, v24, v29
v_mfma_f32_16x16x32_bf16 v[76:79], a[92:95], a[140:143], v[76:79]
v_fmac_f32 v254, v25, v28
v_mul_f32 v254, v254, v247
v_mfma_f32_16x16x32_bf16 v[80:83], a[96:99], a[136:139], v[80:83]
ds_read_b128 a[12:15], v3 offset:2048
v_cvt_pk_bf16_f32 v246, v255, v254
v_mfma_f32_16x16x32_bf16 v[80:83], a[100:103], a[140:143], v[80:83]
buffer_load_dwordx4 v14, s[8:11], s24 offen offset:2048 lds
v_mfma_f32_16x16x32_bf16 v[84:87], a[104:107], a[136:139], v[84:87]
v_accvgpr_write_b32 a177, v246
v_mul_f32 v255, v23, v253
v_mfma_f32_16x16x32_bf16 v[84:87], a[108:111], a[140:143], v[84:87]
v_lshlrev_b32 v22, 16, v232
v_lshlrev_b32 v247, 16, v241
v_mfma_f32_16x16x32_bf16 v[88:91], a[112:115], a[136:139], v[88:91]
ds_read_b128 a[16:19], v2 offset:4096
v_fmac_f32 v255, v24, v30
v_mfma_f32_16x16x32_bf16 v[88:91], a[116:119], a[140:143], v[88:91]
buffer_load_dwordx4 v15, s[8:11], s24 offen offset:3072 lds
v_mfma_f32_16x16x32_bf16 v[92:95], a[120:123], a[136:139], v[92:95]
s_add_u32 s24, s24, 128
ds_read_b128 a[20:23], v3 offset:4096
v_fmac_f32 v255, v25, v29
v_fmac_f32 v255, v22, v28
v_mfma_f32_16x16x32_bf16 v[92:95], a[124:127], a[140:143], v[92:95]
s_waitcnt lgkmcnt(3)
v_mul_f32 v255, v255, v247
v_cvt_pk_bf16_f32 v246, v254, v255
v_mfma_f32_16x16x32_bf16 v[96:99], a[64:67], a[128:131], v[96:99]
s_add_u32 m0, s28, 36864
ds_read_b64_tr_b16 a[136:137], v7 offset:32768
v_accvgpr_write_b32 a182, v246
v_mfma_f32_16x16x32_bf16 v[96:99], a[68:71], a[132:135], v[96:99]
PAD_24:
s_cbranch_execz PAD_28
buffer_load_dwordx4 v12, s[8:11], s25 offen offset:0 lds
v_mfma_f32_16x16x32_bf16 v[100:103], a[72:75], a[128:131], v[100:103]
ds_read_b64_tr_b16 a[138:139], v7 offset:34816
v_mul_f32 v254, v24, v253
v_mfma_f32_16x16x32_bf16 v[100:103], a[76:79], a[132:135], v[100:103]
v_lshlrev_b32 v23, 16, v233
v_lshlrev_b32 v247, 16, v242
v_mfma_f32_16x16x32_bf16 v[104:107], a[80:83], a[128:131], v[104:107]
ds_read_b64_tr_b16 a[140:141], v7 offset:49152
v_fmac_f32 v254, v25, v30
v_mfma_f32_16x16x32_bf16 v[104:107], a[84:87], a[132:135], v[104:107]
buffer_load_dwordx4 v13, s[8:11], s25 offen offset:1024 lds
v_fmac_f32 v254, v22, v29
v_mfma_f32_16x16x32_bf16 v[108:111], a[88:91], a[128:131], v[108:111]
ds_read_b64_tr_b16 a[142:143], v7 offset:51200
v_fmac_f32 v254, v23, v28
v_mfma_f32_16x16x32_bf16 v[108:111], a[92:95], a[132:135], v[108:111]
v_mul_f32 v254, v254, v247
v_cvt_pk_bf16_f32 v246, v255, v254
v_mfma_f32_16x16x32_bf16 v[112:115], a[96:99], a[128:131], v[112:115]
v_accvgpr_write_b32 a178, v246
v_mul_f32 v255, v25, v253
v_mfma_f32_16x16x32_bf16 v[112:115], a[100:103], a[132:135], v[112:115]
buffer_load_dwordx4 v14, s[8:11], s25 offen offset:2048 lds
v_mfma_f32_16x16x32_bf16 v[116:119], a[104:107], a[128:131], v[116:119]
ds_read_b128 a[24:27], v2 offset:6144
v_lshlrev_b32 v24, 16, v234
v_mfma_f32_16x16x32_bf16 v[116:119], a[108:111], a[132:135], v[116:119]
v_lshlrev_b32 v247, 16, v243
v_fmac_f32 v255, v22, v30
v_mfma_f32_16x16x32_bf16 v[120:123], a[112:115], a[128:131], v[120:123]
ds_read_b128 a[28:31], v3 offset:6144
v_fmac_f32 v255, v23, v29
v_mfma_f32_16x16x32_bf16 v[120:123], a[116:119], a[132:135], v[120:123]
buffer_load_dwordx4 v15, s[8:11], s25 offen offset:3072 lds
v_fmac_f32 v255, v24, v28
v_mfma_f32_16x16x32_bf16 v[124:127], a[120:123], a[128:131], v[124:127]
s_add_u32 s25, s25, 128
v_mul_f32 v255, v255, v247
v_cvt_pk_bf16_f32 v246, v254, v255
v_mfma_f32_16x16x32_bf16 v[124:127], a[124:127], a[132:135], v[124:127]
s_waitcnt lgkmcnt(2)
v_accvgpr_write_b32 a183, v246
v_mul_f32 v254, v22, v253
v_mfma_f32_16x16x32_bf16 v[128:131], a[64:67], a[136:139], v[128:131]
ds_read_b64_tr_b16 a[128:129], v8 offset:32768
v_lshlrev_b32 v25, 16, v235
v_mfma_f32_16x16x32_bf16 v[128:131], a[68:71], a[140:143], v[128:131]
buffer_load_dword v21, v20, s[16:19], s43 offen
v_mfma_f32_16x16x32_bf16 v[132:135], a[72:75], a[136:139], v[132:135]
s_add_u32 s43, s43, s47
ds_read_b64_tr_b16 a[130:131], v8 offset:34816
v_lshlrev_b32 v247, 16, v244
v_mfma_f32_16x16x32_bf16 v[132:135], a[76:79], a[140:143], v[132:135]
s_cmp_ge_u32 s43, s51
v_fmac_f32 v254, v23, v30
v_fmac_f32 v254, v24, v29
v_mfma_f32_16x16x32_bf16 v[136:139], a[80:83], a[136:139], v[136:139]
s_cselect_b32 s43, 0, s43
ds_read_b64_tr_b16 a[132:133], v8 offset:49152
v_fmac_f32 v254, v25, v28
v_mul_f32 v254, v254, v247
v_mfma_f32_16x16x32_bf16 v[136:139], a[84:87], a[140:143], v[136:139]
s_cselect_b32 s51, s42, s51
v_cvt_pk_bf16_f32 v246, v255, v254
v_accvgpr_write_b32 a179, v246
v_mfma_f32_16x16x32_bf16 v[140:143], a[88:91], a[136:139], v[140:143]
s_cselect_b64 s[16:17], s[40:41], s[16:17]
ds_read_b64_tr_b16 a[134:135], v8 offset:51200
v_lshlrev_b32 v28, 16, v250
v_mfma_f32_16x16x32_bf16 v[140:143], a[92:95], a[140:143], v[140:143]
s_cselect_b32 s18, s42, s18
v_and_b32 v29, s58, v250
v_lshlrev_b32 v30, 16, v251
v_mfma_f32_16x16x32_bf16 v[144:147], a[96:99], a[136:139], v[144:147]
s_cselect_b64 s[40:41], s[44:45], s[40:41]
ds_read_b128 a[32:35], v2 offset:8192
v_and_b32 v253, s58, v251
v_mfma_f32_16x16x32_bf16 v[144:147], a[100:103], a[140:143], v[144:147]
s_cselect_b32 s42, s46, s42
v_and_b32 v22, s58, v224
v_and_b32 v23, s58, v225
v_mfma_f32_16x16x32_bf16 v[148:151], a[104:107], a[136:139], v[148:151]
s_cselect_b32 s46, 0, s46
v_and_b32 v24, s58, v226
v_mul_f32 v254, v22, v253
v_mfma_f32_16x16x32_bf16 v[148:151], a[108:111], a[140:143], v[148:151]
buffer_load_dword v245, off, s[60:63], s54 sc1
v_mfma_f32_16x16x32_bf16 v[152:155], a[112:115], a[136:139], v[152:155]
ds_read_b128 a[36:39], v3 offset:8192
v_and_b32 v25, s58, v227
v_and_b32 v247, s58, v236
v_mfma_f32_16x16x32_bf16 v[152:155], a[116:119], a[140:143], v[152:155]
v_fmac_f32 v254, v23, v30
v_fmac_f32 v254, v24, v29
v_mfma_f32_16x16x32_bf16 v[156:159], a[120:123], a[136:139], v[156:159]
ds_read_b128 a[40:43], v2 offset:10240
v_fmac_f32 v254, v25, v28
v_mfma_f32_16x16x32_bf16 v[156:159], a[124:127], a[140:143], v[156:159]
s_waitcnt lgkmcnt(3)
v_mul_f32 v254, v254, v247
v_mul_f32 v255, v23, v253
v_mfma_f32_16x16x32_bf16 v[160:163], a[64:67], a[128:131], v[160:163]
ds_read_b64_tr_b16 a[136:137], v9 offset:32768
v_and_b32 v22, s58, v228
v_mfma_f32_16x16x32_bf16 v[160:163], a[68:71], a[132:135], v[160:163]
v_and_b32 v247, s58, v237
v_fmac_f32 v255, v24, v30
v_mfma_f32_16x16x32_bf16 v[164:167], a[72:75], a[128:131], v[164:167]
ds_read_b64_tr_b16 a[138:139], v9 offset:34816
v_fmac_f32 v255, v25, v29
v_mfma_f32_16x16x32_bf16 v[164:167], a[76:79], a[132:135], v[164:167]
v_fmac_f32 v255, v22, v28
v_mul_f32 v255, v255, v247
v_mfma_f32_16x16x32_bf16 v[168:171], a[80:83], a[128:131], v[168:171]
ds_read_b64_tr_b16 a[140:141], v9 offset:49152
v_cvt_pk_bf16_f32 v246, v254, v255
v_accvgpr_write_b32 a188, v246
v_mfma_f32_16x16x32_bf16 v[168:171], a[84:87], a[132:135], v[168:171]
v_mul_f32 v254, v24, v253
v_and_b32 v23, s58, v229
v_mfma_f32_16x16x32_bf16 v[172:175], a[88:91], a[128:131], v[172:175]
ds_read_b64_tr_b16 a[142:143], v9 offset:51200
v_and_b32 v247, s58, v238
v_mfma_f32_16x16x32_bf16 v[172:175], a[92:95], a[132:135], v[172:175]
v_fmac_f32 v254, v25, v30
v_fmac_f32 v254, v22, v29
v_mfma_f32_16x16x32_bf16 v[176:179], a[96:99], a[128:131], v[176:179]
v_fmac_f32 v254, v23, v28
v_mul_f32 v254, v254, v247
v_mfma_f32_16x16x32_bf16 v[176:179], a[100:103], a[132:135], v[176:179]
v_cvt_pk_bf16_f32 v246, v255, v254
v_accvgpr_write_b32 a184, v246
v_mfma_f32_16x16x32_bf16 v[180:183], a[104:107], a[128:131], v[180:183]
ds_read_b128 a[44:47], v3 offset:10240
v_mul_f32 v255, v25, v253
v_mfma_f32_16x16x32_bf16 v[180:183], a[108:111], a[132:135], v[180:183]
v_and_b32 v24, s58, v230
v_and_b32 v247, s58, v239
v_fmac_f32 v255, v22, v30
v_mfma_f32_16x16x32_bf16 v[184:187], a[112:115], a[128:131], v[184:187]
ds_read_b128 a[48:51], v2 offset:12288
v_fmac_f32 v255, v23, v29
v_mfma_f32_16x16x32_bf16 v[184:187], a[116:119], a[132:135], v[184:187]
v_fmac_f32 v255, v24, v28
v_mul_f32 v255, v255, v247
v_mfma_f32_16x16x32_bf16 v[188:191], a[120:123], a[128:131], v[188:191]
v_cvt_pk_bf16_f32 v246, v254, v255
v_accvgpr_write_b32 a189, v246
v_mfma_f32_16x16x32_bf16 v[188:191], a[124:127], a[132:135], v[188:191]
s_waitcnt lgkmcnt(2)
v_mul_f32 v254, v22, v253
v_and_b32 v25, s58, v231
v_mfma_f32_16x16x32_bf16 v[192:195], a[64:67], a[136:139], v[192:195]
ds_read_b64_tr_b16 a[128:129], v10 offset:32768
v_and_b32 v247, s58, v240
v_mfma_f32_16x16x32_bf16 v[192:195], a[68:71], a[140:143], v[192:195]
v_fmac_f32 v254, v23, v30
v_fmac_f32 v254, v24, v29
v_mfma_f32_16x16x32_bf16 v[196:199], a[72:75], a[136:139], v[196:199]
ds_read_b64_tr_b16 a[130:131], v10 offset:34816
v_fmac_f32 v254, v25, v28
v_mfma_f32_16x16x32_bf16 v[196:199], a[76:79], a[140:143], v[196:199]
v_mul_f32 v254, v254, v247
v_cvt_pk_bf16_f32 v246, v255, v254
v_accvgpr_write_b32 a185, v246
v_mfma_f32_16x16x32_bf16 v[200:203], a[80:83], a[136:139], v[200:203]
s_lshr_b32 s22, s3, 1
ds_read_b64_tr_b16 a[132:133], v10 offset:49152
v_mul_f32 v255, v23, v253
v_mfma_f32_16x16x32_bf16 v[200:203], a[84:87], a[140:143], v[200:203]
s_mul_i32 s22, s22, 2097152
v_and_b32 v22, s58, v232
v_and_b32 v247, s58, v241
v_mfma_f32_16x16x32_bf16 v[204:207], a[88:91], a[136:139], v[204:207]
s_and_b32 s23, s3, 1
ds_read_b64_tr_b16 a[134:135], v10 offset:51200
v_fmac_f32 v255, v24, v30
v_mfma_f32_16x16x32_bf16 v[204:207], a[92:95], a[140:143], v[204:207]
s_lshl_b32 s23, s23, 5
v_fmac_f32 v255, v25, v29
v_fmac_f32 v255, v22, v28
v_mfma_f32_16x16x32_bf16 v[208:211], a[96:99], a[136:139], v[208:211]
s_lshl_b32 s56, s39, 6
ds_read_b128 a[52:55], v3 offset:12288
v_mul_f32 v255, v255, v247
v_mfma_f32_16x16x32_bf16 v[208:211], a[100:103], a[140:143], v[208:211]
s_add_u32 s23, s23, s56
v_cvt_pk_bf16_f32 v246, v254, v255
v_accvgpr_write_b32 a190, v246
v_mfma_f32_16x16x32_bf16 v[212:215], a[104:107], a[136:139], v[212:215]
s_mul_i32 s23, s23, 4224
ds_read_b128 a[56:59], v2 offset:14336
v_mul_f32 v254, v24, v253
v_and_b32 v23, s58, v233
v_mfma_f32_16x16x32_bf16 v[212:215], a[108:111], a[140:143], v[212:215]
s_add_u32 s22, s22, s23
v_and_b32 v247, s58, v242
v_fmac_f32 v254, v25, v30
v_mfma_f32_16x16x32_bf16 v[216:219], a[112:115], a[136:139], v[216:219]
s_add_u32 s57, s22, 83886200
v_fmac_f32 v254, v22, v29
v_fmac_f32 v254, v23, v28
v_mfma_f32_16x16x32_bf16 v[216:219], a[116:119], a[140:143], v[216:219]
s_lshl_b32 s23, s38, 7
v_mul_f32 v254, v254, v247
v_cvt_pk_bf16_f32 v246, v255, v254
v_mfma_f32_16x16x32_bf16 v[220:223], a[120:123], a[136:139], v[220:223]
s_add_u32 s22, s22, s23
ds_read_b128 a[60:63], v3 offset:14336
v_accvgpr_write_b32 a186, v246
v_mfma_f32_16x16x32_bf16 v[220:223], a[124:127], a[140:143], v[220:223]
s_waitcnt lgkmcnt(3)
s_add_u32 s56, s22, 83886208
v_mul_f32 v255, v25, v253
v_and_b32 v24, s58, v234
v_mfma_f32_16x16x32_bf16 a[192:195], a[64:67], a[128:131], a[192:195]
s_cmp_lt_u32 s2, 224
ds_read_b64_tr_b16 a[136:137], v11 offset:32768
v_and_b32 v247, s58, v243
v_mfma_f32_16x16x32_bf16 a[192:195], a[68:71], a[132:135], a[192:195]
s_cselect_b32 s56, s56, 3221225472
v_fmac_f32 v255, v22, v30
v_fmac_f32 v255, v23, v29
v_mfma_f32_16x16x32_bf16 a[196:199], a[72:75], a[128:131], a[196:199]
s_cmp_eq_u32 s38, 0
ds_read_b64_tr_b16 a[138:139], v11 offset:34816
v_fmac_f32 v255, v24, v28
v_mul_f32 v255, v255, v247
v_mfma_f32_16x16x32_bf16 a[196:199], a[76:79], a[132:135], a[196:199]
s_cselect_b32 s57, s57, 3221225472
v_cvt_pk_bf16_f32 v246, v254, v255
v_accvgpr_write_b32 a191, v246
v_mfma_f32_16x16x32_bf16 a[200:203], a[80:83], a[128:131], a[200:203]
ds_read_b64_tr_b16 a[140:141], v11 offset:49152
v_mul_f32 v254, v22, v253
v_mfma_f32_16x16x32_bf16 a[200:203], a[84:87], a[132:135], a[200:203]
v_and_b32 v25, s58, v235
v_and_b32 v247, s58, v244
v_mfma_f32_16x16x32_bf16 a[204:207], a[88:91], a[128:131], a[204:207]
ds_read_b64_tr_b16 a[142:143], v11 offset:51200
v_fmac_f32 v254, v23, v30
v_mfma_f32_16x16x32_bf16 a[204:207], a[92:95], a[132:135], a[204:207]
ds_write_b128 v252, a[176:179] offset:0
v_fmac_f32 v254, v24, v29
v_mfma_f32_16x16x32_bf16 a[208:211], a[96:99], a[128:131], a[208:211]
v_fmac_f32 v254, v25, v28
v_mul_f32 v254, v254, v247
v_mfma_f32_16x16x32_bf16 a[208:211], a[100:103], a[132:135], a[208:211]
ds_write_b128 v252, a[180:183] offset:8192
v_cvt_pk_bf16_f32 v246, v255, v254
v_accvgpr_write_b32 a187, v246
v_mfma_f32_16x16x32_bf16 a[212:215], a[104:107], a[128:131], a[212:215]
v_mfma_f32_16x16x32_bf16 a[212:215], a[108:111], a[132:135], a[212:215]
ds_write_b128 v252, a[184:187] offset:128
v_mfma_f32_16x16x32_bf16 a[216:219], a[112:115], a[128:131], a[216:219]
v_mfma_f32_16x16x32_bf16 a[216:219], a[116:119], a[132:135], a[216:219]
ds_write_b128 v252, a[188:191] offset:8320
v_mfma_f32_16x16x32_bf16 a[220:223], a[120:123], a[128:131], a[220:223]
s_waitcnt vmcnt(2) lgkmcnt(0)
v_mfma_f32_16x16x32_bf16 a[220:223], a[124:127], a[132:135], a[220:223]
s_barrier
v_mfma_f32_16x16x32_bf16 a[224:227], a[64:67], a[136:139], a[224:227]
s_add_u32 m0, s29, 98304
ds_read_b64_tr_b16 a[128:129], v4 offset:0
v_lshrrev_b32 v22, 8, v1
v_mfma_f32_16x16x32_bf16 a[224:227], a[68:71], a[140:143], a[224:227]
buffer_load_dwordx4 v16, s[12:15], s26 offen offset:0 lds
v_mfma_f32_16x16x32_bf16 a[228:231], a[72:75], a[136:139], a[228:231]
ds_read_b64_tr_b16 a[130:131], v4 offset:2048
v_lshlrev_b32 v22, 4, v22
v_mfma_f32_16x16x32_bf16 a[228:231], a[76:79], a[140:143], a[228:231]
v_xor_b32 v22, v22, v1
v_add_u32 v22, s29, v22
v_mfma_f32_16x16x32_bf16 a[232:235], a[80:83], a[136:139], a[232:235]
ds_read_b64_tr_b16 a[132:133], v4 offset:16384
v_add_u32 v22, 147456, v22
v_mfma_f32_16x16x32_bf16 a[232:235], a[84:87], a[140:143], a[232:235]
buffer_load_dwordx4 v17, s[12:15], s26 offen offset:1024 lds
v_mfma_f32_16x16x32_bf16 a[236:239], a[88:91], a[136:139], a[236:239]
ds_read_b64_tr_b16 a[134:135], v4 offset:18432
v_xor_b32 v23, 64, v22
v_mfma_f32_16x16x32_bf16 a[236:239], a[92:95], a[140:143], a[236:239]
v_lshrrev_b32 v224, 7, v1
v_mul_u32_u24 v224, 4224, v224
v_mfma_f32_16x16x32_bf16 a[240:243], a[96:99], a[136:139], a[240:243]
v_and_b32 v225, 0x70, v1
v_add_u32 v224, v224, v225
v_mfma_f32_16x16x32_bf16 a[240:243], a[100:103], a[140:143], a[240:243]
buffer_load_dwordx4 v18, s[12:15], s26 offen offset:2048 lds
v_mfma_f32_16x16x32_bf16 a[244:247], a[104:107], a[136:139], a[244:247]
v_bfe_u32 v225, v1, 4, 5
v_mul_u32_u24 v225, 4224, v225
v_mfma_f32_16x16x32_bf16 a[244:247], a[108:111], a[140:143], a[244:247]
v_mov_b32 v226, 0
v_mov_b32 v227, 0
v_mfma_f32_16x16x32_bf16 a[248:251], a[112:115], a[136:139], a[248:251]
v_mfma_f32_16x16x32_bf16 a[248:251], a[116:119], a[140:143], a[248:251]
buffer_load_dwordx4 v19, s[12:15], s26 offen offset:3072 lds
v_mfma_f32_16x16x32_bf16 a[252:255], a[120:123], a[136:139], a[252:255]
s_add_u32 s26, s26, 524288
v_mfma_f32_16x16x32_bf16 a[252:255], a[124:127], a[140:143], a[252:255]
s_waitcnt lgkmcnt(0)
v_mfma_f32_16x16x32_bf16 v[32:35], a[0:3], a[128:131], v[32:35]
s_add_u32 m0, s29, 114688
ds_read_b64_tr_b16 a[136:137], v5 offset:0
v_mfma_f32_16x16x32_bf16 v[32:35], a[4:7], a[132:135], v[32:35]
buffer_load_dwordx4 v16, s[12:15], s27 offen offset:0 lds
v_mfma_f32_16x16x32_bf16 v[36:39], a[8:11], a[128:131], v[36:39]
s_mul_i32 s52, s20, 7
ds_read_b64_tr_b16 a[138:139], v5 offset:2048
v_mfma_f32_16x16x32_bf16 v[36:39], a[12:15], a[132:135], v[36:39]
s_add_u32 s52, s52, s21
buffer_store_dwordx2 v[226:227], v225, s[4:7], s57 offen sc1
v_mfma_f32_16x16x32_bf16 v[40:43], a[16:19], a[128:131], v[40:43]
s_lshl_b32 s53, s52, 2
ds_read_b64_tr_b16 a[140:141], v5 offset:16384
v_mfma_f32_16x16x32_bf16 v[40:43], a[20:23], a[132:135], v[40:43]
s_add_u32 s53, s53, s3
buffer_load_dwordx4 v17, s[12:15], s27 offen offset:1024 lds
v_mfma_f32_16x16x32_bf16 v[44:47], a[24:27], a[128:131], v[44:47]
s_lshl_b32 s49, s53, 12
ds_read_b64_tr_b16 a[142:143], v5 offset:18432
v_mfma_f32_16x16x32_bf16 v[44:47], a[28:31], a[132:135], v[44:47]
s_mul_i32 s53, s53, 4224
v_mfma_f32_16x16x32_bf16 v[48:51], a[32:35], a[128:131], v[48:51]
s_add_u32 s53, s53, 83886080
ds_read_b128 a[64:67], v2 offset:32768
v_mfma_f32_16x16x32_bf16 v[48:51], a[36:39], a[132:135], v[48:51]
s_lshr_b32 s52, s52, 4
buffer_load_dwordx4 v18, s[12:15], s27 offen offset:2048 lds
v_mfma_f32_16x16x32_bf16 v[52:55], a[40:43], a[128:131], v[52:55]
s_min_u32 s52, s52, 6
ds_read_b128 a[68:71], v3 offset:32768
v_mfma_f32_16x16x32_bf16 v[52:55], a[44:47], a[132:135], v[52:55]
s_lshl_b32 s52, s52, 7
ds_read_b128 a[176:179], v22 offset:0
v_mfma_f32_16x16x32_bf16 v[56:59], a[48:51], a[128:131], v[56:59]
s_add_u32 s52, s52, 94392320
ds_read_b128 a[180:183], v23 offset:1024
v_mfma_f32_16x16x32_bf16 v[56:59], a[52:55], a[132:135], v[56:59]
buffer_load_dwordx4 v19, s[12:15], s27 offen offset:3072 lds
v_mfma_f32_16x16x32_bf16 v[60:63], a[56:59], a[128:131], v[60:63]
s_add_u32 s27, s27, 524288
ds_read_b128 a[72:75], v2 offset:34816
v_mfma_f32_16x16x32_bf16 v[60:63], a[60:63], a[132:135], v[60:63]
s_waitcnt lgkmcnt(5)
ds_read_b128 a[184:187], v22 offset:2048
v_mfma_f32_16x16x32_bf16 v[64:67], a[0:3], a[136:139], v[64:67]
s_add_u32 m0, s28, 0
ds_read_b64_tr_b16 a[128:129], v6 offset:0
v_mfma_f32_16x16x32_bf16 v[64:67], a[4:7], a[140:143], v[64:67]
buffer_load_dwordx4 v12, s[8:11], s24 offen offset:0 lds
v_mfma_f32_16x16x32_bf16 v[68:71], a[8:11], a[136:139], v[68:71]
ds_read_b64_tr_b16 a[130:131], v6 offset:2048
v_mfma_f32_16x16x32_bf16 v[68:71], a[12:15], a[140:143], v[68:71]
ds_read_b128 a[188:191], v23 offset:3072
v_mfma_f32_16x16x32_bf16 v[72:75], a[16:19], a[136:139], v[72:75]
ds_read_b64_tr_b16 a[132:133], v6 offset:16384
v_bfe_u32 v231, v1, 4, 5
v_mfma_f32_16x16x32_bf16 v[72:75], a[20:23], a[140:143], v[72:75]
buffer_load_dwordx4 v13, s[8:11], s24 offen offset:1024 lds
v_mfma_f32_16x16x32_bf16 v[76:79], a[24:27], a[136:139], v[76:79]
ds_read_b64_tr_b16 a[134:135], v6 offset:18432
v_lshlrev_b32 v231, 2, v231
v_mfma_f32_16x16x32_bf16 v[76:79], a[28:31], a[140:143], v[76:79]
v_lshlrev_b32 v229, 3, v1
v_min_u32 v229, 4096, v229
v_mfma_f32_16x16x32_bf16 v[80:83], a[32:35], a[136:139], v[80:83]
ds_read_b128 a[76:79], v3 offset:34816
v_mfma_f32_16x16x32_bf16 v[80:83], a[36:39], a[140:143], v[80:83]
buffer_load_dwordx4 v14, s[8:11], s24 offen offset:2048 lds
v_mfma_f32_16x16x32_bf16 v[84:87], a[40:43], a[136:139], v[84:87]
v_mfma_f32_16x16x32_bf16 v[84:87], a[44:47], a[140:143], v[84:87]
v_mfma_f32_16x16x32_bf16 v[88:91], a[48:51], a[136:139], v[88:91]
ds_read_b128 a[80:83], v2 offset:36864
v_mfma_f32_16x16x32_bf16 v[88:91], a[52:55], a[140:143], v[88:91]
buffer_load_dwordx4 v15, s[8:11], s24 offen offset:3072 lds
v_mfma_f32_16x16x32_bf16 v[92:95], a[56:59], a[136:139], v[92:95]
s_add_u32 s24, s24, 128
ds_read_b128 a[84:87], v3 offset:36864
v_mfma_f32_16x16x32_bf16 v[92:95], a[60:63], a[140:143], v[92:95]
s_waitcnt lgkmcnt(3)
v_mfma_f32_16x16x32_bf16 v[96:99], a[0:3], a[128:131], v[96:99]
s_add_u32 m0, s28, 4096
ds_read_b64_tr_b16 a[136:137], v7 offset:0
v_mfma_f32_16x16x32_bf16 v[96:99], a[4:7], a[132:135], v[96:99]
buffer_load_dwordx4 v12, s[8:11], s25 offen offset:0 lds
v_mfma_f32_16x16x32_bf16 v[100:103], a[8:11], a[128:131], v[100:103]
ds_read_b64_tr_b16 a[138:139], v7 offset:2048
v_mfma_f32_16x16x32_bf16 v[100:103], a[12:15], a[132:135], v[100:103]
v_mfma_f32_16x16x32_bf16 v[104:107], a[16:19], a[128:131], v[104:107]
ds_read_b64_tr_b16 a[140:141], v7 offset:16384
v_mfma_f32_16x16x32_bf16 v[104:107], a[20:23], a[132:135], v[104:107]
buffer_load_dwordx4 v13, s[8:11], s25 offen offset:1024 lds
v_mfma_f32_16x16x32_bf16 v[108:111], a[24:27], a[128:131], v[108:111]
ds_read_b64_tr_b16 a[142:143], v7 offset:18432
v_mfma_f32_16x16x32_bf16 v[108:111], a[28:31], a[132:135], v[108:111]
v_mfma_f32_16x16x32_bf16 v[112:115], a[32:35], a[128:131], v[112:115]
v_mfma_f32_16x16x32_bf16 v[112:115], a[36:39], a[132:135], v[112:115]
buffer_load_dwordx4 v14, s[8:11], s25 offen offset:2048 lds
v_mfma_f32_16x16x32_bf16 v[116:119], a[40:43], a[128:131], v[116:119]
ds_read_b128 a[88:91], v2 offset:38912
v_mfma_f32_16x16x32_bf16 v[116:119], a[44:47], a[132:135], v[116:119]
v_mfma_f32_16x16x32_bf16 v[120:123], a[48:51], a[128:131], v[120:123]
ds_read_b128 a[92:95], v3 offset:38912
v_mfma_f32_16x16x32_bf16 v[120:123], a[52:55], a[132:135], v[120:123]
buffer_load_dwordx4 v15, s[8:11], s25 offen offset:3072 lds
v_mfma_f32_16x16x32_bf16 v[124:127], a[56:59], a[128:131], v[124:127]
s_add_u32 s25, s25, 128
v_mfma_f32_16x16x32_bf16 v[124:127], a[60:63], a[132:135], v[124:127]
s_waitcnt lgkmcnt(2)
v_mfma_f32_16x16x32_bf16 v[128:131], a[0:3], a[136:139], v[128:131]
ds_read_b64_tr_b16 a[128:129], v8 offset:0
v_mfma_f32_16x16x32_bf16 v[128:131], a[4:7], a[140:143], v[128:131]
buffer_store_dwordx4 a[176:179], v224, s[4:7], s56 offen sc1
v_mfma_f32_16x16x32_bf16 v[132:135], a[8:11], a[136:139], v[132:135]
s_add_u32 s56, s56, 33792
ds_read_b64_tr_b16 a[130:131], v8 offset:2048
v_mfma_f32_16x16x32_bf16 v[132:135], a[12:15], a[140:143], v[132:135]
v_mfma_f32_16x16x32_bf16 v[136:139], a[16:19], a[136:139], v[136:139]
ds_read_b64_tr_b16 a[132:133], v8 offset:16384
v_mfma_f32_16x16x32_bf16 v[136:139], a[20:23], a[140:143], v[136:139]
v_mfma_f32_16x16x32_bf16 v[140:143], a[24:27], a[136:139], v[140:143]
s_cmp_lt_u32 s21, 7
ds_read_b64_tr_b16 a[134:135], v8 offset:18432
v_mfma_f32_16x16x32_bf16 v[140:143], a[28:31], a[140:143], v[140:143]
s_cselect_b32 s53, s53, 3221225472
v_mfma_f32_16x16x32_bf16 v[144:147], a[32:35], a[136:139], v[144:147]
s_cselect_b32 s49, s49, 3221225472
ds_read_b128 a[96:99], v2 offset:40960
v_mfma_f32_16x16x32_bf16 v[144:147], a[36:39], a[140:143], v[144:147]
s_add_u32 s48, s53, 2097152
v_mfma_f32_16x16x32_bf16 v[148:151], a[40:43], a[136:139], v[148:151]
v_mfma_f32_16x16x32_bf16 v[148:151], a[44:47], a[140:143], v[148:151]
v_mfma_f32_16x16x32_bf16 v[152:155], a[48:51], a[136:139], v[152:155]
ds_read_b128 a[100:103], v3 offset:40960
v_mfma_f32_16x16x32_bf16 v[152:155], a[52:55], a[140:143], v[152:155]
v_mfma_f32_16x16x32_bf16 v[156:159], a[56:59], a[136:139], v[156:159]
ds_read_b128 a[104:107], v2 offset:43008
v_mfma_f32_16x16x32_bf16 v[156:159], a[60:63], a[140:143], v[156:159]
s_waitcnt lgkmcnt(3)
v_mfma_f32_16x16x32_bf16 v[160:163], a[0:3], a[128:131], v[160:163]
ds_read_b64_tr_b16 a[136:137], v9 offset:0
v_mfma_f32_16x16x32_bf16 v[160:163], a[4:7], a[132:135], v[160:163]
v_mfma_f32_16x16x32_bf16 v[164:167], a[8:11], a[128:131], v[164:167]
ds_read_b64_tr_b16 a[138:139], v9 offset:2048
v_mfma_f32_16x16x32_bf16 v[164:167], a[12:15], a[132:135], v[164:167]
buffer_store_dwordx4 a[180:183], v224, s[4:7], s56 offen sc1
v_mfma_f32_16x16x32_bf16 v[168:171], a[16:19], a[128:131], v[168:171]
s_add_u32 s56, s56, 33792
ds_read_b64_tr_b16 a[140:141], v9 offset:16384
v_mfma_f32_16x16x32_bf16 v[168:171], a[20:23], a[132:135], v[168:171]
v_mfma_f32_16x16x32_bf16 v[172:175], a[24:27], a[128:131], v[172:175]
ds_read_b64_tr_b16 a[142:143], v9 offset:18432
v_mfma_f32_16x16x32_bf16 v[172:175], a[28:31], a[132:135], v[172:175]
v_mfma_f32_16x16x32_bf16 v[176:179], a[32:35], a[128:131], v[176:179]
v_mfma_f32_16x16x32_bf16 v[176:179], a[36:39], a[132:135], v[176:179]
v_mfma_f32_16x16x32_bf16 v[180:183], a[40:43], a[128:131], v[180:183]
ds_read_b128 a[108:111], v3 offset:43008
v_mfma_f32_16x16x32_bf16 v[180:183], a[44:47], a[132:135], v[180:183]
v_mfma_f32_16x16x32_bf16 v[184:187], a[48:51], a[128:131], v[184:187]
ds_read_b128 a[112:115], v2 offset:45056
v_mfma_f32_16x16x32_bf16 v[184:187], a[52:55], a[132:135], v[184:187]
v_mfma_f32_16x16x32_bf16 v[188:191], a[56:59], a[128:131], v[188:191]
v_mfma_f32_16x16x32_bf16 v[188:191], a[60:63], a[132:135], v[188:191]
s_waitcnt lgkmcnt(2)
v_mfma_f32_16x16x32_bf16 v[192:195], a[0:3], a[136:139], v[192:195]
ds_read_b64_tr_b16 a[128:129], v10 offset:0
v_mfma_f32_16x16x32_bf16 v[192:195], a[4:7], a[140:143], v[192:195]
v_mfma_f32_16x16x32_bf16 v[196:199], a[8:11], a[136:139], v[196:199]
ds_read_b64_tr_b16 a[130:131], v10 offset:2048
v_mfma_f32_16x16x32_bf16 v[196:199], a[12:15], a[140:143], v[196:199]
v_mfma_f32_16x16x32_bf16 v[200:203], a[16:19], a[136:139], v[200:203]
ds_read_b64_tr_b16 a[132:133], v10 offset:16384
v_mfma_f32_16x16x32_bf16 v[200:203], a[20:23], a[140:143], v[200:203]
buffer_store_dwordx4 a[184:187], v224, s[4:7], s56 offen sc1
v_mfma_f32_16x16x32_bf16 v[204:207], a[24:27], a[136:139], v[204:207]
s_add_u32 s56, s56, 33792
ds_read_b64_tr_b16 a[134:135], v10 offset:18432
v_mfma_f32_16x16x32_bf16 v[204:207], a[28:31], a[140:143], v[204:207]
v_mfma_f32_16x16x32_bf16 v[208:211], a[32:35], a[136:139], v[208:211]
ds_read_b128 a[116:119], v3 offset:45056
v_mfma_f32_16x16x32_bf16 v[208:211], a[36:39], a[140:143], v[208:211]
v_mfma_f32_16x16x32_bf16 v[212:215], a[40:43], a[136:139], v[212:215]
ds_read_b128 a[120:123], v2 offset:47104
v_mfma_f32_16x16x32_bf16 v[212:215], a[44:47], a[140:143], v[212:215]
v_mfma_f32_16x16x32_bf16 v[216:219], a[48:51], a[136:139], v[216:219]
v_mfma_f32_16x16x32_bf16 v[216:219], a[52:55], a[140:143], v[216:219]
v_mfma_f32_16x16x32_bf16 v[220:223], a[56:59], a[136:139], v[220:223]
ds_read_b128 a[124:127], v3 offset:47104
v_mfma_f32_16x16x32_bf16 v[220:223], a[60:63], a[140:143], v[220:223]
s_waitcnt lgkmcnt(3)
v_mfma_f32_16x16x32_bf16 a[192:195], a[0:3], a[128:131], a[192:195]
ds_read_b64_tr_b16 a[136:137], v11 offset:0
v_mfma_f32_16x16x32_bf16 a[192:195], a[4:7], a[132:135], a[192:195]
v_mfma_f32_16x16x32_bf16 a[196:199], a[8:11], a[128:131], a[196:199]
ds_read_b64_tr_b16 a[138:139], v11 offset:2048
v_mfma_f32_16x16x32_bf16 a[196:199], a[12:15], a[132:135], a[196:199]
v_mfma_f32_16x16x32_bf16 a[200:203], a[16:19], a[128:131], a[200:203]
ds_read_b64_tr_b16 a[140:141], v11 offset:16384
v_mfma_f32_16x16x32_bf16 a[200:203], a[20:23], a[132:135], a[200:203]
v_mfma_f32_16x16x32_bf16 a[204:207], a[24:27], a[128:131], a[204:207]
ds_read_b64_tr_b16 a[142:143], v11 offset:18432
v_mfma_f32_16x16x32_bf16 a[204:207], a[28:31], a[132:135], a[204:207]
buffer_store_dwordx4 a[188:191], v224, s[4:7], s56 offen sc1
v_mfma_f32_16x16x32_bf16 a[208:211], a[32:35], a[128:131], a[208:211]
s_add_u32 s56, s56, 33792
v_mfma_f32_16x16x32_bf16 a[208:211], a[36:39], a[132:135], a[208:211]
v_mfma_f32_16x16x32_bf16 a[212:215], a[40:43], a[128:131], a[212:215]
v_mfma_f32_16x16x32_bf16 a[212:215], a[44:47], a[132:135], a[212:215]
v_mfma_f32_16x16x32_bf16 a[216:219], a[48:51], a[128:131], a[216:219]
v_mfma_f32_16x16x32_bf16 a[216:219], a[52:55], a[132:135], a[216:219]
v_mfma_f32_16x16x32_bf16 a[220:223], a[56:59], a[128:131], a[220:223]
s_waitcnt vmcnt(4) lgkmcnt(0)
v_mfma_f32_16x16x32_bf16 a[220:223], a[60:63], a[132:135], a[220:223]
s_barrier
v_mfma_f32_16x16x32_bf16 a[224:227], a[0:3], a[136:139], a[224:227]
s_add_u32 m0, s29, 65536
ds_read_b64_tr_b16 a[128:129], v4 offset:32768
v_mfma_f32_16x16x32_bf16 a[224:227], a[4:7], a[140:143], a[224:227]
buffer_load_dwordx4 v16, s[12:15], s26 offen offset:0 lds
v_mfma_f32_16x16x32_bf16 a[228:231], a[8:11], a[136:139], a[228:231]
ds_read_b64_tr_b16 a[130:131], v4 offset:34816
v_cmp_gt_u32 vcc, s50, v245
v_mfma_f32_16x16x32_bf16 a[228:231], a[12:15], a[140:143], a[228:231]
v_mfma_f32_16x16x32_bf16 a[232:235], a[16:19], a[136:139], a[232:235]
ds_read_b64_tr_b16 a[132:133], v4 offset:49152
v_mfma_f32_16x16x32_bf16 a[232:235], a[20:23], a[140:143], a[232:235]
buffer_load_dwordx4 v17, s[12:15], s26 offen offset:1024 lds
v_mfma_f32_16x16x32_bf16 a[236:239], a[24:27], a[136:139], a[236:239]
ds_read_b64_tr_b16 a[134:135], v4 offset:51200
v_mfma_f32_16x16x32_bf16 a[236:239], a[28:31], a[140:143], a[236:239]
v_mfma_f32_16x16x32_bf16 a[240:243], a[32:35], a[136:139], a[240:243]
v_mfma_f32_16x16x32_bf16 a[240:243], a[36:39], a[140:143], a[240:243]
buffer_load_dwordx4 v18, s[12:15], s26 offen offset:2048 lds
v_mfma_f32_16x16x32_bf16 a[244:247], a[40:43], a[136:139], a[244:247]
v_mfma_f32_16x16x32_bf16 a[244:247], a[44:47], a[140:143], a[244:247]
v_mfma_f32_16x16x32_bf16 a[248:251], a[48:51], a[136:139], a[248:251]
v_mfma_f32_16x16x32_bf16 a[248:251], a[52:55], a[140:143], a[248:251]
buffer_load_dwordx4 v19, s[12:15], s26 offen offset:3072 lds
v_mfma_f32_16x16x32_bf16 a[252:255], a[56:59], a[136:139], a[252:255]
s_add_u32 s26, s26, 524288
v_mfma_f32_16x16x32_bf16 a[252:255], a[60:63], a[140:143], a[252:255]
s_waitcnt lgkmcnt(0)
s_mov_b32 s82, s59
s_cbranch_vccnz M_cntspinV
s_branch Lg_501
Lg_501t:
PAD_25:
s_cbranch_execz PAD_29
buffer_load_dword v230, v231, s[4:7], s52 offen sc1
v_mfma_f32_16x16x32_bf16 v[32:35], a[64:67], a[128:131], v[32:35]
s_add_u32 m0, s29, 81920
ds_read_b64_tr_b16 a[136:137], v5 offset:32768
v_mfma_f32_16x16x32_bf16 v[32:35], a[68:71], a[132:135], v[32:35]
buffer_load_dwordx4 v16, s[12:15], s27 offen offset:0 lds
v_mfma_f32_16x16x32_bf16 v[36:39], a[72:75], a[128:131], v[36:39]
s_and_b32 s44, s3, 1
ds_read_b64_tr_b16 a[138:139], v5 offset:34816
v_mfma_f32_16x16x32_bf16 v[36:39], a[76:79], a[132:135], v[36:39]
s_lshl_b32 s44, s44, 8
v_mfma_f32_16x16x32_bf16 v[40:43], a[80:83], a[128:131], v[40:43]
s_lshl_b32 s45, s3, 7
ds_read_b64_tr_b16 a[140:141], v5 offset:49152
v_mfma_f32_16x16x32_bf16 v[40:43], a[84:87], a[132:135], v[40:43]
s_xor_b32 s44, s44, s45
buffer_load_dwordx4 v17, s[12:15], s27 offen offset:1024 lds
v_mfma_f32_16x16x32_bf16 v[44:47], a[88:91], a[128:131], v[44:47]
s_xor_b32 s44, s44, 196608
ds_read_b64_tr_b16 a[142:143], v5 offset:51200
v_mfma_f32_16x16x32_bf16 v[44:47], a[92:95], a[132:135], v[44:47]
v_mfma_f32_16x16x32_bf16 v[48:51], a[96:99], a[128:131], v[48:51]
ds_read_b128 a[0:3], v2 offset:0
v_mfma_f32_16x16x32_bf16 v[48:51], a[100:103], a[132:135], v[48:51]
buffer_load_dwordx4 v18, s[12:15], s27 offen offset:2048 lds
v_mfma_f32_16x16x32_bf16 v[52:55], a[104:107], a[128:131], v[52:55]
ds_read_b128 a[4:7], v3 offset:0
v_mfma_f32_16x16x32_bf16 v[52:55], a[108:111], a[132:135], v[52:55]
v_mfma_f32_16x16x32_bf16 v[56:59], a[112:115], a[128:131], v[56:59]
v_mfma_f32_16x16x32_bf16 v[56:59], a[116:119], a[132:135], v[56:59]
buffer_load_dwordx4 v19, s[12:15], s27 offen offset:3072 lds
v_mfma_f32_16x16x32_bf16 v[60:63], a[120:123], a[128:131], v[60:63]
s_add_u32 s27, s27, 524288
ds_read_b128 a[8:11], v2 offset:2048
v_mfma_f32_16x16x32_bf16 v[60:63], a[124:127], a[132:135], v[60:63]
s_waitcnt lgkmcnt(3)
v_mfma_f32_16x16x32_bf16 v[64:67], a[64:67], a[136:139], v[64:67]
s_add_u32 m0, s28, 32768
ds_read_b64_tr_b16 a[128:129], v6 offset:32768
v_mfma_f32_16x16x32_bf16 v[64:67], a[68:71], a[140:143], v[64:67]
buffer_load_dwordx4 v12, s[8:11], s24 offen offset:0 lds
v_mfma_f32_16x16x32_bf16 v[68:71], a[72:75], a[136:139], v[68:71]
ds_read_b64_tr_b16 a[130:131], v6 offset:34816
v_mfma_f32_16x16x32_bf16 v[68:71], a[76:79], a[140:143], v[68:71]
PAD_26:
s_cbranch_execz PAD_30
v_mfma_f32_16x16x32_bf16 v[72:75], a[80:83], a[136:139], v[72:75]
s_mov_b64 s[56:57], s[72:73]
ds_read_b64_tr_b16 a[132:133], v6 offset:49152
v_mfma_f32_16x16x32_bf16 v[72:75], a[84:87], a[140:143], v[72:75]
s_mov_b32 s58, 1835008
buffer_load_dwordx4 v13, s[8:11], s24 offen offset:1024 lds
v_mfma_f32_16x16x32_bf16 v[76:79], a[88:91], a[136:139], v[76:79]
s_mov_b32 s59, 0x20000
ds_read_b64_tr_b16 a[134:135], v6 offset:51200
v_mfma_f32_16x16x32_bf16 v[76:79], a[92:95], a[140:143], v[76:79]
v_mfma_f32_16x16x32_bf16 v[80:83], a[96:99], a[136:139], v[80:83]
ds_read_b128 a[12:15], v3 offset:2048
v_mfma_f32_16x16x32_bf16 v[80:83], a[100:103], a[140:143], v[80:83]
buffer_load_dwordx4 v14, s[8:11], s24 offen offset:2048 lds
v_mfma_f32_16x16x32_bf16 v[84:87], a[104:107], a[136:139], v[84:87]
v_mfma_f32_16x16x32_bf16 v[84:87], a[108:111], a[140:143], v[84:87]
v_mfma_f32_16x16x32_bf16 v[88:91], a[112:115], a[136:139], v[88:91]
ds_read_b128 a[16:19], v2 offset:4096
v_mfma_f32_16x16x32_bf16 v[88:91], a[116:119], a[140:143], v[88:91]
buffer_load_dwordx4 v15, s[8:11], s24 offen offset:3072 lds
v_mfma_f32_16x16x32_bf16 v[92:95], a[120:123], a[136:139], v[92:95]
s_add_u32 s24, s24, 128
ds_read_b128 a[20:23], v3 offset:4096
v_mfma_f32_16x16x32_bf16 v[92:95], a[124:127], a[140:143], v[92:95]
s_waitcnt lgkmcnt(3)
v_mfma_f32_16x16x32_bf16 v[96:99], a[64:67], a[128:131], v[96:99]
s_add_u32 m0, s28, 36864
ds_read_b64_tr_b16 a[136:137], v7 offset:32768
v_mfma_f32_16x16x32_bf16 v[96:99], a[68:71], a[132:135], v[96:99]
buffer_load_dwordx4 v12, s[8:11], s25 offen offset:0 lds
v_mfma_f32_16x16x32_bf16 v[100:103], a[72:75], a[128:131], v[100:103]
ds_read_b64_tr_b16 a[138:139], v7 offset:34816
v_mfma_f32_16x16x32_bf16 v[100:103], a[76:79], a[132:135], v[100:103]
v_mfma_f32_16x16x32_bf16 v[104:107], a[80:83], a[128:131], v[104:107]
ds_read_b64_tr_b16 a[140:141], v7 offset:49152
v_mfma_f32_16x16x32_bf16 v[104:107], a[84:87], a[132:135], v[104:107]
buffer_load_dwordx4 v13, s[8:11], s25 offen offset:1024 lds
v_mfma_f32_16x16x32_bf16 v[108:111], a[88:91], a[128:131], v[108:111]
ds_read_b64_tr_b16 a[142:143], v7 offset:51200
v_mfma_f32_16x16x32_bf16 v[108:111], a[92:95], a[132:135], v[108:111]
v_mfma_f32_16x16x32_bf16 v[112:115], a[96:99], a[128:131], v[112:115]
v_mfma_f32_16x16x32_bf16 v[112:115], a[100:103], a[132:135], v[112:115]
buffer_load_dwordx4 v14, s[8:11], s25 offen offset:2048 lds
v_mfma_f32_16x16x32_bf16 v[116:119], a[104:107], a[128:131], v[116:119]
ds_read_b128 a[24:27], v2 offset:6144
v_mfma_f32_16x16x32_bf16 v[116:119], a[108:111], a[132:135], v[116:119]
v_mfma_f32_16x16x32_bf16 v[120:123], a[112:115], a[128:131], v[120:123]
ds_read_b128 a[28:31], v3 offset:6144
v_mfma_f32_16x16x32_bf16 v[120:123], a[116:119], a[132:135], v[120:123]
buffer_load_dwordx4 v15, s[8:11], s25 offen offset:3072 lds
v_mfma_f32_16x16x32_bf16 v[124:127], a[120:123], a[128:131], v[124:127]
s_add_u32 s25, s25, 128
s_waitcnt vmcnt(12)
v_mfma_f32_16x16x32_bf16 v[124:127], a[124:127], a[132:135], v[124:127]
s_waitcnt lgkmcnt(2)
v_cmp_gt_u32 vcc, 1, v230
v_mfma_f32_16x16x32_bf16 v[128:131], a[64:67], a[136:139], v[128:131]
s_cbranch_vccnz M_ppspinV
M_ppokV:
ds_read_b64_tr_b16 a[128:129], v8 offset:32768
v_mfma_f32_16x16x32_bf16 v[128:131], a[68:71], a[140:143], v[128:131]
buffer_load_dword v230, v229, s[4:7], s53 offen sc1
v_mfma_f32_16x16x32_bf16 v[132:135], a[72:75], a[136:139], v[132:135]
s_mov_b64 s[8:9], s[76:77]
ds_read_b64_tr_b16 a[130:131], v8 offset:34816
v_mfma_f32_16x16x32_bf16 v[132:135], a[76:79], a[140:143], v[132:135]
s_mov_b32 s10, 1835008
buffer_load_dword v230, v229, s[4:7], s48 offen sc1
v_mfma_f32_16x16x32_bf16 v[136:139], a[80:83], a[136:139], v[136:139]
s_lshl_b32 s24, s37, 2
ds_read_b64_tr_b16 a[132:133], v8 offset:49152
v_mfma_f32_16x16x32_bf16 v[136:139], a[84:87], a[140:143], v[136:139]
s_add_u32 s24, s24, s3
buffer_load_dword v230, v229, s[56:59], s49 offen
v_mfma_f32_16x16x32_bf16 v[140:143], a[88:91], a[136:139], v[140:143]
s_mul_i32 s24, s24, 28672
ds_read_b64_tr_b16 a[134:135], v8 offset:51200
v_mfma_f32_16x16x32_bf16 v[140:143], a[92:95], a[140:143], v[140:143]
s_mov_b32 s28, s29
buffer_load_dword v21, v20, s[16:19], s43 offen
v_mfma_f32_16x16x32_bf16 v[144:147], a[96:99], a[136:139], v[144:147]
ds_read_b128 a[32:35], v2 offset:8192
v_mfma_f32_16x16x32_bf16 v[144:147], a[100:103], a[140:143], v[144:147]
buffer_load_dword v21, v20, s[16:19], s43 offen offset:256
v_mfma_f32_16x16x32_bf16 v[148:151], a[104:107], a[136:139], v[148:151]
buffer_load_dword v21, v20, s[16:19], s43 offen offset:512
v_mfma_f32_16x16x32_bf16 v[148:151], a[108:111], a[140:143], v[148:151]
buffer_load_dword v21, v20, s[16:19], s43 offen offset:768
v_mfma_f32_16x16x32_bf16 v[152:155], a[112:115], a[136:139], v[152:155]
ds_read_b128 a[36:39], v3 offset:8192
v_lshrrev_b32 v28, 7, v1
v_mfma_f32_16x16x32_bf16 v[152:155], a[116:119], a[140:143], v[152:155]
v_lshrrev_b32 v29, 1, v28
v_lshlrev_b32 v29, 4, v29
v_mfma_f32_16x16x32_bf16 v[156:159], a[120:123], a[136:139], v[156:159]
ds_read_b128 a[40:43], v2 offset:10240
v_and_b32 v30, 0x70, v1
v_mfma_f32_16x16x32_bf16 v[156:159], a[124:127], a[140:143], v[156:159]
s_waitcnt lgkmcnt(3)
v_xor_b32 v29, v29, v30
v_mul_u32_u24 v28, 896, v28
v_mfma_f32_16x16x32_bf16 v[160:163], a[64:67], a[128:131], v[160:163]
ds_read_b64_tr_b16 a[136:137], v9 offset:32768
v_add_u32 v12, v28, v29
v_mfma_f32_16x16x32_bf16 v[160:163], a[68:71], a[132:135], v[160:163]
v_xor_b32 v29, 64, v29
v_add_u32 v28, v28, v29
v_mfma_f32_16x16x32_bf16 v[164:167], a[72:75], a[128:131], v[164:167]
ds_read_b64_tr_b16 a[138:139], v9 offset:34816
v_add_u32 v13, 6144, v28
v_mfma_f32_16x16x32_bf16 v[164:167], a[76:79], a[132:135], v[164:167]
v_add_u32 v14, 12288, v12
v_add_u32 v15, 18432, v28
v_mfma_f32_16x16x32_bf16 v[168:171], a[80:83], a[128:131], v[168:171]
ds_read_b64_tr_b16 a[140:141], v9 offset:49152
v_xor_b32 v22, s44, v4
v_mfma_f32_16x16x32_bf16 v[168:171], a[84:87], a[132:135], v[168:171]
v_xor_b32 v23, 32, v22
v_xor_b32 v24, 64, v22
v_mfma_f32_16x16x32_bf16 v[172:175], a[88:91], a[128:131], v[172:175]
ds_read_b64_tr_b16 a[142:143], v9 offset:51200
v_xor_b32 v25, 96, v22
v_mfma_f32_16x16x32_bf16 v[172:175], a[92:95], a[132:135], v[172:175]
v_mfma_f32_16x16x32_bf16 v[176:179], a[96:99], a[128:131], v[176:179]
v_mfma_f32_16x16x32_bf16 v[176:179], a[100:103], a[132:135], v[176:179]
v_mfma_f32_16x16x32_bf16 v[180:183], a[104:107], a[128:131], v[180:183]
ds_read_b128 a[44:47], v3 offset:10240
v_mfma_f32_16x16x32_bf16 v[180:183], a[108:111], a[132:135], v[180:183]
v_mfma_f32_16x16x32_bf16 v[184:187], a[112:115], a[128:131], v[184:187]
ds_read_b128 a[48:51], v2 offset:12288
v_mfma_f32_16x16x32_bf16 v[184:187], a[116:119], a[132:135], v[184:187]
v_mfma_f32_16x16x32_bf16 v[188:191], a[120:123], a[128:131], v[188:191]
v_mfma_f32_16x16x32_bf16 v[188:191], a[124:127], a[132:135], v[188:191]
s_waitcnt lgkmcnt(2)
v_mfma_f32_16x16x32_bf16 v[192:195], a[64:67], a[136:139], v[192:195]
ds_read_b64_tr_b16 a[128:129], v10 offset:32768
v_mfma_f32_16x16x32_bf16 v[192:195], a[68:71], a[140:143], v[192:195]
v_mfma_f32_16x16x32_bf16 v[196:199], a[72:75], a[136:139], v[196:199]
ds_read_b64_tr_b16 a[130:131], v10 offset:34816
v_mfma_f32_16x16x32_bf16 v[196:199], a[76:79], a[140:143], v[196:199]
v_mfma_f32_16x16x32_bf16 v[200:203], a[80:83], a[136:139], v[200:203]
ds_read_b64_tr_b16 a[132:133], v10 offset:49152
v_mfma_f32_16x16x32_bf16 v[200:203], a[84:87], a[140:143], v[200:203]
v_mfma_f32_16x16x32_bf16 v[204:207], a[88:91], a[136:139], v[204:207]
ds_read_b64_tr_b16 a[134:135], v10 offset:51200
v_mfma_f32_16x16x32_bf16 v[204:207], a[92:95], a[140:143], v[204:207]
v_mfma_f32_16x16x32_bf16 v[208:211], a[96:99], a[136:139], v[208:211]
ds_read_b128 a[52:55], v3 offset:12288
v_mfma_f32_16x16x32_bf16 v[208:211], a[100:103], a[140:143], v[208:211]
v_mfma_f32_16x16x32_bf16 v[212:215], a[104:107], a[136:139], v[212:215]
ds_read_b128 a[56:59], v2 offset:14336
v_mfma_f32_16x16x32_bf16 v[212:215], a[108:111], a[140:143], v[212:215]
v_mfma_f32_16x16x32_bf16 v[216:219], a[112:115], a[136:139], v[216:219]
v_mfma_f32_16x16x32_bf16 v[216:219], a[116:119], a[140:143], v[216:219]
v_mfma_f32_16x16x32_bf16 v[220:223], a[120:123], a[136:139], v[220:223]
ds_read_b128 a[60:63], v3 offset:14336
v_mfma_f32_16x16x32_bf16 v[220:223], a[124:127], a[140:143], v[220:223]
s_waitcnt lgkmcnt(3)
v_mfma_f32_16x16x32_bf16 a[192:195], a[64:67], a[128:131], a[192:195]
ds_read_b64_tr_b16 a[136:137], v11 offset:32768
v_mfma_f32_16x16x32_bf16 a[192:195], a[68:71], a[132:135], a[192:195]
v_mfma_f32_16x16x32_bf16 a[196:199], a[72:75], a[128:131], a[196:199]
ds_read_b64_tr_b16 a[138:139], v11 offset:34816
v_mfma_f32_16x16x32_bf16 a[196:199], a[76:79], a[132:135], a[196:199]
v_mfma_f32_16x16x32_bf16 a[200:203], a[80:83], a[128:131], a[200:203]
ds_read_b64_tr_b16 a[140:141], v11 offset:49152
v_mfma_f32_16x16x32_bf16 a[200:203], a[84:87], a[132:135], a[200:203]
v_mfma_f32_16x16x32_bf16 a[204:207], a[88:91], a[128:131], a[204:207]
ds_read_b64_tr_b16 a[142:143], v11 offset:51200
v_mfma_f32_16x16x32_bf16 a[204:207], a[92:95], a[132:135], a[204:207]
v_mfma_f32_16x16x32_bf16 a[208:211], a[96:99], a[128:131], a[208:211]
v_mfma_f32_16x16x32_bf16 a[208:211], a[100:103], a[132:135], a[208:211]
v_mfma_f32_16x16x32_bf16 a[212:215], a[104:107], a[128:131], a[212:215]
v_mfma_f32_16x16x32_bf16 a[212:215], a[108:111], a[132:135], a[212:215]
v_mfma_f32_16x16x32_bf16 a[216:219], a[112:115], a[128:131], a[216:219]
v_mfma_f32_16x16x32_bf16 a[216:219], a[116:119], a[132:135], a[216:219]
v_mfma_f32_16x16x32_bf16 a[220:223], a[120:123], a[128:131], a[220:223]
s_waitcnt vmcnt(7) lgkmcnt(0)
v_mfma_f32_16x16x32_bf16 a[220:223], a[124:127], a[132:135], a[220:223]
s_barrier
v_mfma_f32_16x16x32_bf16 a[224:227], a[64:67], a[136:139], a[224:227]
s_add_u32 m0, s29, 98304
ds_read_b64_tr_b16 a[128:129], v4 offset:0
v_mfma_f32_16x16x32_bf16 a[224:227], a[68:71], a[140:143], a[224:227]
buffer_load_dwordx4 v16, s[12:15], s26 offen offset:0 lds
v_mfma_f32_16x16x32_bf16 a[228:231], a[72:75], a[136:139], a[228:231]
ds_read_b64_tr_b16 a[130:131], v4 offset:2048
v_mfma_f32_16x16x32_bf16 a[228:231], a[76:79], a[140:143], a[228:231]
v_mfma_f32_16x16x32_bf16 a[232:235], a[80:83], a[136:139], a[232:235]
ds_read_b64_tr_b16 a[132:133], v4 offset:16384
v_mfma_f32_16x16x32_bf16 a[232:235], a[84:87], a[140:143], a[232:235]
buffer_load_dwordx4 v17, s[12:15], s26 offen offset:1024 lds
v_mfma_f32_16x16x32_bf16 a[236:239], a[88:91], a[136:139], a[236:239]
ds_read_b64_tr_b16 a[134:135], v4 offset:18432
v_mfma_f32_16x16x32_bf16 a[236:239], a[92:95], a[140:143], a[236:239]
v_mfma_f32_16x16x32_bf16 a[240:243], a[96:99], a[136:139], a[240:243]
v_mfma_f32_16x16x32_bf16 a[240:243], a[100:103], a[140:143], a[240:243]
buffer_load_dwordx4 v18, s[12:15], s26 offen offset:2048 lds
v_mfma_f32_16x16x32_bf16 a[244:247], a[104:107], a[136:139], a[244:247]
v_mfma_f32_16x16x32_bf16 a[244:247], a[108:111], a[140:143], a[244:247]
v_mfma_f32_16x16x32_bf16 a[248:251], a[112:115], a[136:139], a[248:251]
v_mfma_f32_16x16x32_bf16 a[248:251], a[116:119], a[140:143], a[248:251]
buffer_load_dwordx4 v19, s[12:15], s26 offen offset:3072 lds
v_mfma_f32_16x16x32_bf16 a[252:255], a[120:123], a[136:139], a[252:255]
s_add_u32 s26, s26, 524288
v_mfma_f32_16x16x32_bf16 a[252:255], a[124:127], a[140:143], a[252:255]
s_waitcnt lgkmcnt(0)
v_mfma_f32_16x16x32_bf16 v[32:35], a[0:3], a[128:131], v[32:35]
s_add_u32 m0, s29, 114688
ds_read_b64_tr_b16 a[136:137], v5 offset:0
v_mfma_f32_16x16x32_bf16 v[32:35], a[4:7], a[132:135], v[32:35]
buffer_load_dwordx4 v16, s[12:15], s27 offen offset:0 lds
v_mfma_f32_16x16x32_bf16 v[36:39], a[8:11], a[128:131], v[36:39]
ds_read_b64_tr_b16 a[138:139], v5 offset:2048
v_mfma_f32_16x16x32_bf16 v[36:39], a[12:15], a[132:135], v[36:39]
v_mfma_f32_16x16x32_bf16 v[40:43], a[16:19], a[128:131], v[40:43]
ds_read_b64_tr_b16 a[140:141], v5 offset:16384
v_mfma_f32_16x16x32_bf16 v[40:43], a[20:23], a[132:135], v[40:43]
buffer_load_dwordx4 v17, s[12:15], s27 offen offset:1024 lds
v_mfma_f32_16x16x32_bf16 v[44:47], a[24:27], a[128:131], v[44:47]
ds_read_b64_tr_b16 a[142:143], v5 offset:18432
v_mfma_f32_16x16x32_bf16 v[44:47], a[28:31], a[132:135], v[44:47]
v_mfma_f32_16x16x32_bf16 v[48:51], a[32:35], a[128:131], v[48:51]
ds_read_b128 a[64:67], v2 offset:32768
v_mfma_f32_16x16x32_bf16 v[48:51], a[36:39], a[132:135], v[48:51]
buffer_load_dwordx4 v18, s[12:15], s27 offen offset:2048 lds
v_mfma_f32_16x16x32_bf16 v[52:55], a[40:43], a[128:131], v[52:55]
ds_read_b128 a[68:71], v3 offset:32768
v_mfma_f32_16x16x32_bf16 v[52:55], a[44:47], a[132:135], v[52:55]
v_mfma_f32_16x16x32_bf16 v[56:59], a[48:51], a[128:131], v[56:59]
v_mfma_f32_16x16x32_bf16 v[56:59], a[52:55], a[132:135], v[56:59]
buffer_load_dwordx4 v19, s[12:15], s27 offen offset:3072 lds
v_mfma_f32_16x16x32_bf16 v[60:63], a[56:59], a[128:131], v[60:63]
s_add_u32 s27, s27, 524288
ds_read_b128 a[72:75], v2 offset:34816
v_mfma_f32_16x16x32_bf16 v[60:63], a[60:63], a[132:135], v[60:63]
s_waitcnt lgkmcnt(3)
v_mfma_f32_16x16x32_bf16 v[64:67], a[0:3], a[136:139], v[64:67]
s_add_u32 m0, s28, 0
ds_read_b64_tr_b16 a[128:129], v6 offset:0
v_mfma_f32_16x16x32_bf16 v[64:67], a[4:7], a[140:143], v[64:67]
buffer_load_dwordx4 v12, s[8:11], s24 offen offset:0 lds
v_mfma_f32_16x16x32_bf16 v[68:71], a[8:11], a[136:139], v[68:71]
ds_read_b64_tr_b16 a[130:131], v6 offset:2048
v_mfma_f32_16x16x32_bf16 v[68:71], a[12:15], a[140:143], v[68:71]
v_mfma_f32_16x16x32_bf16 v[72:75], a[16:19], a[136:139], v[72:75]
ds_read_b64_tr_b16 a[132:133], v6 offset:16384
v_mfma_f32_16x16x32_bf16 v[72:75], a[20:23], a[140:143], v[72:75]
buffer_load_dwordx4 v13, s[8:11], s24 offen offset:1024 lds
v_mfma_f32_16x16x32_bf16 v[76:79], a[24:27], a[136:139], v[76:79]
ds_read_b64_tr_b16 a[134:135], v6 offset:18432
v_mfma_f32_16x16x32_bf16 v[76:79], a[28:31], a[140:143], v[76:79]
v_mfma_f32_16x16x32_bf16 v[80:83], a[32:35], a[136:139], v[80:83]
ds_read_b128 a[76:79], v3 offset:34816
v_mfma_f32_16x16x32_bf16 v[80:83], a[36:39], a[140:143], v[80:83]
buffer_load_dwordx4 v14, s[8:11], s24 offen offset:2048 lds
v_mfma_f32_16x16x32_bf16 v[84:87], a[40:43], a[136:139], v[84:87]
v_mfma_f32_16x16x32_bf16 v[84:87], a[44:47], a[140:143], v[84:87]
v_mfma_f32_16x16x32_bf16 v[88:91], a[48:51], a[136:139], v[88:91]
ds_read_b128 a[80:83], v2 offset:36864
v_mfma_f32_16x16x32_bf16 v[88:91], a[52:55], a[140:143], v[88:91]
buffer_load_dwordx4 v15, s[8:11], s24 offen offset:3072 lds
v_mfma_f32_16x16x32_bf16 v[92:95], a[56:59], a[136:139], v[92:95]
s_add_u32 s24, s24, 128
ds_read_b128 a[84:87], v3 offset:36864
v_mfma_f32_16x16x32_bf16 v[92:95], a[60:63], a[140:143], v[92:95]
s_waitcnt lgkmcnt(3)
s_mov_b64 s[12:13], s[80:81]
v_mfma_f32_16x16x32_bf16 v[96:99], a[0:3], a[128:131], v[96:99]
s_mov_b32 s14, 3670016
s_add_u32 m0, s28, 16384
ds_read_b64_tr_b16 a[136:137], v7 offset:0
v_mfma_f32_16x16x32_bf16 v[96:99], a[4:7], a[132:135], v[96:99]
buffer_load_dwordx4 v12, s[8:11], s24 offen offset:0 lds
v_mfma_f32_16x16x32_bf16 v[100:103], a[8:11], a[128:131], v[100:103]
ds_read_b64_tr_b16 a[138:139], v7 offset:2048
v_mfma_f32_16x16x32_bf16 v[100:103], a[12:15], a[132:135], v[100:103]
v_mfma_f32_16x16x32_bf16 v[104:107], a[16:19], a[128:131], v[104:107]
ds_read_b64_tr_b16 a[140:141], v7 offset:16384
v_mfma_f32_16x16x32_bf16 v[104:107], a[20:23], a[132:135], v[104:107]
buffer_load_dwordx4 v13, s[8:11], s24 offen offset:1024 lds
v_mfma_f32_16x16x32_bf16 v[108:111], a[24:27], a[128:131], v[108:111]
ds_read_b64_tr_b16 a[142:143], v7 offset:18432
v_mfma_f32_16x16x32_bf16 v[108:111], a[28:31], a[132:135], v[108:111]
v_mfma_f32_16x16x32_bf16 v[112:115], a[32:35], a[128:131], v[112:115]
v_mfma_f32_16x16x32_bf16 v[112:115], a[36:39], a[132:135], v[112:115]
buffer_load_dwordx4 v14, s[8:11], s24 offen offset:2048 lds
v_mfma_f32_16x16x32_bf16 v[116:119], a[40:43], a[128:131], v[116:119]
ds_read_b128 a[88:91], v2 offset:38912
v_mfma_f32_16x16x32_bf16 v[116:119], a[44:47], a[132:135], v[116:119]
v_mfma_f32_16x16x32_bf16 v[120:123], a[48:51], a[128:131], v[120:123]
ds_read_b128 a[92:95], v3 offset:38912
v_mfma_f32_16x16x32_bf16 v[120:123], a[52:55], a[132:135], v[120:123]
buffer_load_dwordx4 v15, s[8:11], s24 offen offset:3072 lds
v_mfma_f32_16x16x32_bf16 v[124:127], a[56:59], a[128:131], v[124:127]
s_add_u32 s24, s24, 128
v_mfma_f32_16x16x32_bf16 v[124:127], a[60:63], a[132:135], v[124:127]
s_waitcnt lgkmcnt(2)
s_sub_u32 s26, s26, 8388608
v_mfma_f32_16x16x32_bf16 v[128:131], a[0:3], a[136:139], v[128:131]
s_sub_u32 s27, s27, 8388608
s_add_u32 m0, s29, 131072
ds_read_b64_tr_b16 a[128:129], v8 offset:0
v_mfma_f32_16x16x32_bf16 v[128:131], a[4:7], a[140:143], v[128:131]
buffer_load_dwordx4 v16, s[12:15], s26 offen offset:0 lds
v_mfma_f32_16x16x32_bf16 v[132:135], a[8:11], a[136:139], v[132:135]
ds_read_b64_tr_b16 a[130:131], v8 offset:2048
v_mfma_f32_16x16x32_bf16 v[132:135], a[12:15], a[140:143], v[132:135]
v_mfma_f32_16x16x32_bf16 v[136:139], a[16:19], a[136:139], v[136:139]
ds_read_b64_tr_b16 a[132:133], v8 offset:16384
v_mfma_f32_16x16x32_bf16 v[136:139], a[20:23], a[140:143], v[136:139]
buffer_load_dwordx4 v17, s[12:15], s26 offen offset:1024 lds
v_mfma_f32_16x16x32_bf16 v[140:143], a[24:27], a[136:139], v[140:143]
ds_read_b64_tr_b16 a[134:135], v8 offset:18432
v_mfma_f32_16x16x32_bf16 v[140:143], a[28:31], a[140:143], v[140:143]
v_mfma_f32_16x16x32_bf16 v[144:147], a[32:35], a[136:139], v[144:147]
ds_read_b128 a[96:99], v2 offset:40960
v_mfma_f32_16x16x32_bf16 v[144:147], a[36:39], a[140:143], v[144:147]
buffer_load_dwordx4 v18, s[12:15], s26 offen offset:2048 lds
v_mfma_f32_16x16x32_bf16 v[148:151], a[40:43], a[136:139], v[148:151]
v_mfma_f32_16x16x32_bf16 v[148:151], a[44:47], a[140:143], v[148:151]
v_mfma_f32_16x16x32_bf16 v[152:155], a[48:51], a[136:139], v[152:155]
ds_read_b128 a[100:103], v3 offset:40960
v_mfma_f32_16x16x32_bf16 v[152:155], a[52:55], a[140:143], v[152:155]
buffer_load_dwordx4 v19, s[12:15], s26 offen offset:3072 lds
v_mfma_f32_16x16x32_bf16 v[156:159], a[56:59], a[136:139], v[156:159]
s_add_u32 s26, s26, 524288
ds_read_b128 a[104:107], v2 offset:43008
v_mfma_f32_16x16x32_bf16 v[156:159], a[60:63], a[140:143], v[156:159]
s_waitcnt lgkmcnt(3)
v_mfma_f32_16x16x32_bf16 v[160:163], a[0:3], a[128:131], v[160:163]
s_add_u32 m0, s29, 147456
ds_read_b64_tr_b16 a[136:137], v9 offset:0
v_mfma_f32_16x16x32_bf16 v[160:163], a[4:7], a[132:135], v[160:163]
buffer_load_dwordx4 v16, s[12:15], s27 offen offset:0 lds
v_mfma_f32_16x16x32_bf16 v[164:167], a[8:11], a[128:131], v[164:167]
ds_read_b64_tr_b16 a[138:139], v9 offset:2048
v_mfma_f32_16x16x32_bf16 v[164:167], a[12:15], a[132:135], v[164:167]
v_mfma_f32_16x16x32_bf16 v[168:171], a[16:19], a[128:131], v[168:171]
ds_read_b64_tr_b16 a[140:141], v9 offset:16384
v_mfma_f32_16x16x32_bf16 v[168:171], a[20:23], a[132:135], v[168:171]
buffer_load_dwordx4 v17, s[12:15], s27 offen offset:1024 lds
v_mfma_f32_16x16x32_bf16 v[172:175], a[24:27], a[128:131], v[172:175]
ds_read_b64_tr_b16 a[142:143], v9 offset:18432
v_mfma_f32_16x16x32_bf16 v[172:175], a[28:31], a[132:135], v[172:175]
v_mfma_f32_16x16x32_bf16 v[176:179], a[32:35], a[128:131], v[176:179]
v_mfma_f32_16x16x32_bf16 v[176:179], a[36:39], a[132:135], v[176:179]
buffer_load_dwordx4 v18, s[12:15], s27 offen offset:2048 lds
v_mfma_f32_16x16x32_bf16 v[180:183], a[40:43], a[128:131], v[180:183]
ds_read_b128 a[108:111], v3 offset:43008
v_mfma_f32_16x16x32_bf16 v[180:183], a[44:47], a[132:135], v[180:183]
v_mfma_f32_16x16x32_bf16 v[184:187], a[48:51], a[128:131], v[184:187]
ds_read_b128 a[112:115], v2 offset:45056
v_mfma_f32_16x16x32_bf16 v[184:187], a[52:55], a[132:135], v[184:187]
buffer_load_dwordx4 v19, s[12:15], s27 offen offset:3072 lds
v_mfma_f32_16x16x32_bf16 v[188:191], a[56:59], a[128:131], v[188:191]
s_add_u32 s27, s27, 524288
v_mfma_f32_16x16x32_bf16 v[188:191], a[60:63], a[132:135], v[188:191]
s_waitcnt lgkmcnt(2)
v_mfma_f32_16x16x32_bf16 v[192:195], a[0:3], a[136:139], v[192:195]
ds_read_b64_tr_b16 a[128:129], v10 offset:0
v_mfma_f32_16x16x32_bf16 v[192:195], a[4:7], a[140:143], v[192:195]
v_mfma_f32_16x16x32_bf16 v[196:199], a[8:11], a[136:139], v[196:199]
ds_read_b64_tr_b16 a[130:131], v10 offset:2048
v_mfma_f32_16x16x32_bf16 v[196:199], a[12:15], a[140:143], v[196:199]
v_mfma_f32_16x16x32_bf16 v[200:203], a[16:19], a[136:139], v[200:203]
ds_read_b64_tr_b16 a[132:133], v10 offset:16384
v_mfma_f32_16x16x32_bf16 v[200:203], a[20:23], a[140:143], v[200:203]
v_mfma_f32_16x16x32_bf16 v[204:207], a[24:27], a[136:139], v[204:207]
ds_read_b64_tr_b16 a[134:135], v10 offset:18432
v_mfma_f32_16x16x32_bf16 v[204:207], a[28:31], a[140:143], v[204:207]
v_mfma_f32_16x16x32_bf16 v[208:211], a[32:35], a[136:139], v[208:211]
ds_read_b128 a[116:119], v3 offset:45056
v_mfma_f32_16x16x32_bf16 v[208:211], a[36:39], a[140:143], v[208:211]
v_mfma_f32_16x16x32_bf16 v[212:215], a[40:43], a[136:139], v[212:215]
ds_read_b128 a[120:123], v2 offset:47104
v_mfma_f32_16x16x32_bf16 v[212:215], a[44:47], a[140:143], v[212:215]
v_mfma_f32_16x16x32_bf16 v[216:219], a[48:51], a[136:139], v[216:219]
v_mfma_f32_16x16x32_bf16 v[216:219], a[52:55], a[140:143], v[216:219]
v_mfma_f32_16x16x32_bf16 v[220:223], a[56:59], a[136:139], v[220:223]
ds_read_b128 a[124:127], v3 offset:47104
v_mfma_f32_16x16x32_bf16 v[220:223], a[60:63], a[140:143], v[220:223]
s_waitcnt lgkmcnt(3)
v_mfma_f32_16x16x32_bf16 a[192:195], a[0:3], a[128:131], a[192:195]
ds_read_b64_tr_b16 a[136:137], v11 offset:0
v_mfma_f32_16x16x32_bf16 a[192:195], a[4:7], a[132:135], a[192:195]
v_mfma_f32_16x16x32_bf16 a[196:199], a[8:11], a[128:131], a[196:199]
ds_read_b64_tr_b16 a[138:139], v11 offset:2048
v_mfma_f32_16x16x32_bf16 a[196:199], a[12:15], a[132:135], a[196:199]
v_mfma_f32_16x16x32_bf16 a[200:203], a[16:19], a[128:131], a[200:203]
ds_read_b64_tr_b16 a[140:141], v11 offset:16384
v_mfma_f32_16x16x32_bf16 a[200:203], a[20:23], a[132:135], a[200:203]
v_mfma_f32_16x16x32_bf16 a[204:207], a[24:27], a[128:131], a[204:207]
ds_read_b64_tr_b16 a[142:143], v11 offset:18432
v_mfma_f32_16x16x32_bf16 a[204:207], a[28:31], a[132:135], a[204:207]
v_mfma_f32_16x16x32_bf16 a[208:211], a[32:35], a[128:131], a[208:211]
v_mfma_f32_16x16x32_bf16 a[208:211], a[36:39], a[132:135], a[208:211]
v_mfma_f32_16x16x32_bf16 a[212:215], a[40:43], a[128:131], a[212:215]
v_mfma_f32_16x16x32_bf16 a[212:215], a[44:47], a[132:135], a[212:215]
v_mfma_f32_16x16x32_bf16 a[216:219], a[48:51], a[128:131], a[216:219]
v_mfma_f32_16x16x32_bf16 a[216:219], a[52:55], a[132:135], a[216:219]
v_mfma_f32_16x16x32_bf16 a[220:223], a[56:59], a[128:131], a[220:223]
s_waitcnt vmcnt(12) lgkmcnt(0)
v_mfma_f32_16x16x32_bf16 a[220:223], a[60:63], a[132:135], a[220:223]
s_barrier
v_mfma_f32_16x16x32_bf16 a[224:227], a[0:3], a[136:139], a[224:227]
s_add_u32 m0, s28, 32768
ds_read_b64_tr_b16 a[128:129], v4 offset:32768
v_mfma_f32_16x16x32_bf16 a[224:227], a[4:7], a[140:143], a[224:227]
s_lshr_b32 s22, s3, 1
buffer_load_dwordx4 v12, s[8:11], s24 offen offset:0 lds
v_mfma_f32_16x16x32_bf16 a[228:231], a[8:11], a[136:139], a[228:231]
s_lshl_b32 s22, s22, 14
ds_read_b64_tr_b16 a[130:131], v4 offset:34816
v_subrev_u32 v2, s22, v2
v_mfma_f32_16x16x32_bf16 a[228:231], a[12:15], a[140:143], a[228:231]
v_subrev_u32 v3, s22, v3
v_mfma_f32_16x16x32_bf16 a[232:235], a[16:19], a[136:139], a[232:235]
ds_read_b64_tr_b16 a[132:133], v4 offset:49152
v_mfma_f32_16x16x32_bf16 a[232:235], a[20:23], a[140:143], a[232:235]
buffer_load_dwordx4 v13, s[8:11], s24 offen offset:1024 lds
v_mfma_f32_16x16x32_bf16 a[236:239], a[24:27], a[136:139], a[236:239]
ds_read_b64_tr_b16 a[134:135], v4 offset:51200
v_mfma_f32_16x16x32_bf16 a[236:239], a[28:31], a[140:143], a[236:239]
v_mfma_f32_16x16x32_bf16 a[240:243], a[32:35], a[136:139], a[240:243]
v_mfma_f32_16x16x32_bf16 a[240:243], a[36:39], a[140:143], a[240:243]
buffer_load_dwordx4 v14, s[8:11], s24 offen offset:2048 lds
v_mfma_f32_16x16x32_bf16 a[244:247], a[40:43], a[136:139], a[244:247]
v_mfma_f32_16x16x32_bf16 a[244:247], a[44:47], a[140:143], a[244:247]
v_mfma_f32_16x16x32_bf16 a[248:251], a[48:51], a[136:139], a[248:251]
v_mfma_f32_16x16x32_bf16 a[248:251], a[52:55], a[140:143], a[248:251]
buffer_load_dwordx4 v15, s[8:11], s24 offen offset:3072 lds
v_mfma_f32_16x16x32_bf16 a[252:255], a[56:59], a[136:139], a[252:255]
s_add_u32 s24, s24, 128
v_mfma_f32_16x16x32_bf16 a[252:255], a[60:63], a[140:143], a[252:255]
s_waitcnt lgkmcnt(0)
v_mfma_f32_16x16x32_bf16 v[32:35], a[64:67], a[128:131], v[32:35]
s_add_u32 m0, s29, 65536
ds_read_b64_tr_b16 a[136:137], v5 offset:32768
v_mfma_f32_16x16x32_bf16 v[32:35], a[68:71], a[132:135], v[32:35]
buffer_load_dwordx4 v16, s[12:15], s26 offen offset:0 lds
v_mfma_f32_16x16x32_bf16 v[36:39], a[72:75], a[128:131], v[36:39]
ds_read_b64_tr_b16 a[138:139], v5 offset:34816
v_mfma_f32_16x16x32_bf16 v[36:39], a[76:79], a[132:135], v[36:39]
v_mfma_f32_16x16x32_bf16 v[40:43], a[80:83], a[128:131], v[40:43]
ds_read_b64_tr_b16 a[140:141], v5 offset:49152
v_mfma_f32_16x16x32_bf16 v[40:43], a[84:87], a[132:135], v[40:43]
buffer_load_dwordx4 v17, s[12:15], s26 offen offset:1024 lds
v_mfma_f32_16x16x32_bf16 v[44:47], a[88:91], a[128:131], v[44:47]
ds_read_b64_tr_b16 a[142:143], v5 offset:51200
v_mfma_f32_16x16x32_bf16 v[44:47], a[92:95], a[132:135], v[44:47]
v_mfma_f32_16x16x32_bf16 v[48:51], a[96:99], a[128:131], v[48:51]
ds_read_b128 a[0:3], v2 offset:0
v_cvt_pk_bf16_f32 v32, v32, v33
v_mfma_f32_16x16x32_bf16 v[48:51], a[100:103], a[132:135], v[48:51]
buffer_load_dwordx4 v18, s[12:15], s26 offen offset:2048 lds
v_mfma_f32_16x16x32_bf16 v[52:55], a[104:107], a[128:131], v[52:55]
ds_read_b128 a[4:7], v3 offset:0
v_cvt_pk_bf16_f32 v33, v34, v35
v_mfma_f32_16x16x32_bf16 v[52:55], a[108:111], a[132:135], v[52:55]
v_cvt_pk_bf16_f32 v34, v36, v37
v_cvt_pk_bf16_f32 v35, v38, v39
v_mfma_f32_16x16x32_bf16 v[56:59], a[112:115], a[128:131], v[56:59]
v_cvt_pk_bf16_f32 v40, v40, v41
v_cvt_pk_bf16_f32 v41, v42, v43
v_mfma_f32_16x16x32_bf16 v[56:59], a[116:119], a[132:135], v[56:59]
buffer_load_dwordx4 v19, s[12:15], s26 offen offset:3072 lds
v_mfma_f32_16x16x32_bf16 v[60:63], a[120:123], a[128:131], v[60:63]
s_add_u32 s26, s26, 524288
ds_read_b128 a[8:11], v2 offset:2048
v_cvt_pk_bf16_f32 v42, v44, v45
v_mfma_f32_16x16x32_bf16 v[60:63], a[124:127], a[132:135], v[60:63]
s_waitcnt lgkmcnt(3)
v_cvt_pk_bf16_f32 v43, v46, v47
v_mfma_f32_16x16x32_bf16 v[64:67], a[64:67], a[136:139], v[64:67]
s_add_u32 m0, s29, 81920
ds_read_b64_tr_b16 a[128:129], v6 offset:32768
v_cvt_pk_bf16_f32 v48, v48, v49
v_mfma_f32_16x16x32_bf16 v[64:67], a[68:71], a[140:143], v[64:67]
buffer_load_dwordx4 v16, s[12:15], s27 offen offset:0 lds
v_mfma_f32_16x16x32_bf16 v[68:71], a[72:75], a[136:139], v[68:71]
ds_read_b64_tr_b16 a[130:131], v6 offset:34816
v_cvt_pk_bf16_f32 v49, v50, v51
v_mfma_f32_16x16x32_bf16 v[68:71], a[76:79], a[140:143], v[68:71]
v_cvt_pk_bf16_f32 v50, v52, v53
v_cvt_pk_bf16_f32 v51, v54, v55
v_mfma_f32_16x16x32_bf16 v[72:75], a[80:83], a[136:139], v[72:75]
ds_read_b64_tr_b16 a[132:133], v6 offset:49152
v_cvt_pk_bf16_f32 v56, v56, v57
v_mfma_f32_16x16x32_bf16 v[72:75], a[84:87], a[140:143], v[72:75]
buffer_load_dwordx4 v17, s[12:15], s27 offen offset:1024 lds
v_mfma_f32_16x16x32_bf16 v[76:79], a[88:91], a[136:139], v[76:79]
ds_read_b64_tr_b16 a[134:135], v6 offset:51200
v_cvt_pk_bf16_f32 v57, v58, v59
v_mfma_f32_16x16x32_bf16 v[76:79], a[92:95], a[140:143], v[76:79]
v_cvt_pk_bf16_f32 v58, v60, v61
v_cvt_pk_bf16_f32 v59, v62, v63
v_mfma_f32_16x16x32_bf16 v[80:83], a[96:99], a[136:139], v[80:83]
ds_read_b128 a[12:15], v3 offset:2048
v_cvt_pk_bf16_f32 v64, v64, v65
v_mfma_f32_16x16x32_bf16 v[80:83], a[100:103], a[140:143], v[80:83]
buffer_load_dwordx4 v18, s[12:15], s27 offen offset:2048 lds
v_mfma_f32_16x16x32_bf16 v[84:87], a[104:107], a[136:139], v[84:87]
v_cvt_pk_bf16_f32 v65, v66, v67
v_cvt_pk_bf16_f32 v66, v68, v69
v_mfma_f32_16x16x32_bf16 v[84:87], a[108:111], a[140:143], v[84:87]
v_cvt_pk_bf16_f32 v67, v70, v71
v_mfma_f32_16x16x32_bf16 v[88:91], a[112:115], a[136:139], v[88:91]
ds_read_b128 a[16:19], v2 offset:4096
v_cvt_pk_bf16_f32 v72, v72, v73
v_mfma_f32_16x16x32_bf16 v[88:91], a[116:119], a[140:143], v[88:91]
buffer_load_dwordx4 v19, s[12:15], s27 offen offset:3072 lds
v_mfma_f32_16x16x32_bf16 v[92:95], a[120:123], a[136:139], v[92:95]
s_add_u32 s27, s27, 524288
ds_read_b128 a[20:23], v3 offset:4096
v_cvt_pk_bf16_f32 v73, v74, v75
v_mfma_f32_16x16x32_bf16 v[92:95], a[124:127], a[140:143], v[92:95]
s_waitcnt lgkmcnt(3)
v_cvt_pk_bf16_f32 v74, v76, v77
v_cvt_pk_bf16_f32 v75, v78, v79
v_mfma_f32_16x16x32_bf16 v[96:99], a[64:67], a[128:131], v[96:99]
s_add_u32 m0, s28, 49152
ds_read_b64_tr_b16 a[136:137], v7 offset:32768
v_cvt_pk_bf16_f32 v80, v80, v81
v_mfma_f32_16x16x32_bf16 v[96:99], a[68:71], a[132:135], v[96:99]
buffer_load_dwordx4 v12, s[8:11], s24 offen offset:0 lds
v_mfma_f32_16x16x32_bf16 v[100:103], a[72:75], a[128:131], v[100:103]
ds_read_b64_tr_b16 a[138:139], v7 offset:34816
v_cvt_pk_bf16_f32 v81, v82, v83
v_mfma_f32_16x16x32_bf16 v[100:103], a[76:79], a[132:135], v[100:103]
v_cvt_pk_bf16_f32 v82, v84, v85
v_cvt_pk_bf16_f32 v83, v86, v87
v_mfma_f32_16x16x32_bf16 v[104:107], a[80:83], a[128:131], v[104:107]
PAD_27:
s_cbranch_execz PAD_31
ds_read_b64_tr_b16 a[140:141], v7 offset:49152
v_cvt_pk_bf16_f32 v88, v88, v89
v_mfma_f32_16x16x32_bf16 v[104:107], a[84:87], a[132:135], v[104:107]
buffer_load_dwordx4 v13, s[8:11], s24 offen offset:1024 lds
v_mfma_f32_16x16x32_bf16 v[108:111], a[88:91], a[128:131], v[108:111]
ds_read_b64_tr_b16 a[142:143], v7 offset:51200
v_cvt_pk_bf16_f32 v89, v90, v91
v_mfma_f32_16x16x32_bf16 v[108:111], a[92:95], a[132:135], v[108:111]
v_cvt_pk_bf16_f32 v90, v92, v93
v_cvt_pk_bf16_f32 v91, v94, v95
v_mfma_f32_16x16x32_bf16 v[112:115], a[96:99], a[128:131], v[112:115]
v_cvt_pk_bf16_f32 v96, v96, v97
v_cvt_pk_bf16_f32 v97, v98, v99
v_mfma_f32_16x16x32_bf16 v[112:115], a[100:103], a[132:135], v[112:115]
buffer_load_dwordx4 v14, s[8:11], s24 offen offset:2048 lds
v_mfma_f32_16x16x32_bf16 v[116:119], a[104:107], a[128:131], v[116:119]
ds_read_b128 a[24:27], v2 offset:6144
v_cvt_pk_bf16_f32 v98, v100, v101
v_mfma_f32_16x16x32_bf16 v[116:119], a[108:111], a[132:135], v[116:119]
buffer_store_dwordx4 v[32:35], v1, s[4:7], s31 offen sc1
v_mfma_f32_16x16x32_bf16 v[120:123], a[112:115], a[128:131], v[120:123]
s_add_u32 s31, s31, s32
ds_read_b128 a[28:31], v3 offset:6144
v_cvt_pk_bf16_f32 v99, v102, v103
v_mfma_f32_16x16x32_bf16 v[120:123], a[116:119], a[132:135], v[120:123]
buffer_load_dwordx4 v15, s[8:11], s24 offen offset:3072 lds
v_mfma_f32_16x16x32_bf16 v[124:127], a[120:123], a[128:131], v[124:127]
s_add_u32 s24, s24, 128
v_cvt_pk_bf16_f32 v104, v104, v105
v_cvt_pk_bf16_f32 v105, v106, v107
v_mfma_f32_16x16x32_bf16 v[124:127], a[124:127], a[132:135], v[124:127]
s_waitcnt lgkmcnt(2)
v_cvt_pk_bf16_f32 v106, v108, v109
v_cvt_pk_bf16_f32 v107, v110, v111
v_mfma_f32_16x16x32_bf16 v[128:131], a[64:67], a[136:139], v[128:131]
ds_read_b64_tr_b16 a[128:129], v8 offset:32768
v_cvt_pk_bf16_f32 v112, v112, v113
v_mfma_f32_16x16x32_bf16 v[128:131], a[68:71], a[140:143], v[128:131]
v_cvt_pk_bf16_f32 v113, v114, v115
v_cvt_pk_bf16_f32 v114, v116, v117
v_mfma_f32_16x16x32_bf16 v[132:135], a[72:75], a[136:139], v[132:135]
ds_read_b64_tr_b16 a[130:131], v8 offset:34816
v_cvt_pk_bf16_f32 v115, v118, v119
v_mfma_f32_16x16x32_bf16 v[132:135], a[76:79], a[140:143], v[132:135]
buffer_store_dwordx4 v[40:43], v1, s[4:7], s31 offen sc1
v_mfma_f32_16x16x32_bf16 v[136:139], a[80:83], a[136:139], v[136:139]
s_add_u32 s31, s31, s33
ds_read_b64_tr_b16 a[132:133], v8 offset:49152
v_cvt_pk_bf16_f32 v120, v120, v121
v_mfma_f32_16x16x32_bf16 v[136:139], a[84:87], a[140:143], v[136:139]
v_cvt_pk_bf16_f32 v121, v122, v123
v_cvt_pk_bf16_f32 v122, v124, v125
v_mfma_f32_16x16x32_bf16 v[140:143], a[88:91], a[136:139], v[140:143]
ds_read_b64_tr_b16 a[134:135], v8 offset:51200
v_cvt_pk_bf16_f32 v123, v126, v127
v_mfma_f32_16x16x32_bf16 v[140:143], a[92:95], a[140:143], v[140:143]
v_mfma_f32_16x16x32_bf16 v[144:147], a[96:99], a[136:139], v[144:147]
ds_read_b128 a[32:35], v2 offset:8192
v_cvt_pk_bf16_f32 v128, v128, v129
v_mfma_f32_16x16x32_bf16 v[144:147], a[100:103], a[140:143], v[144:147]
v_cvt_pk_bf16_f32 v129, v130, v131
v_cvt_pk_bf16_f32 v130, v132, v133
v_mfma_f32_16x16x32_bf16 v[148:151], a[104:107], a[136:139], v[148:151]
v_cvt_pk_bf16_f32 v131, v134, v135
v_mfma_f32_16x16x32_bf16 v[148:151], a[108:111], a[140:143], v[148:151]
v_mfma_f32_16x16x32_bf16 v[152:155], a[112:115], a[136:139], v[152:155]
ds_read_b128 a[36:39], v3 offset:8192
v_cvt_pk_bf16_f32 v136, v136, v137
v_mfma_f32_16x16x32_bf16 v[152:155], a[116:119], a[140:143], v[152:155]
v_cvt_pk_bf16_f32 v137, v138, v139
v_cvt_pk_bf16_f32 v138, v140, v141
v_mfma_f32_16x16x32_bf16 v[156:159], a[120:123], a[136:139], v[156:159]
ds_read_b128 a[40:43], v2 offset:10240
v_cvt_pk_bf16_f32 v139, v142, v143
v_mfma_f32_16x16x32_bf16 v[156:159], a[124:127], a[140:143], v[156:159]
s_waitcnt lgkmcnt(3)
buffer_store_dwordx4 v[48:51], v1, s[4:7], s31 offen sc1
v_mfma_f32_16x16x32_bf16 v[160:163], a[64:67], a[128:131], v[160:163]
s_add_u32 s31, s31, s32
ds_read_b64_tr_b16 a[136:137], v9 offset:32768
v_cvt_pk_bf16_f32 v144, v144, v145
v_mfma_f32_16x16x32_bf16 v[160:163], a[68:71], a[132:135], v[160:163]
v_cvt_pk_bf16_f32 v145, v146, v147
v_cvt_pk_bf16_f32 v146, v148, v149
v_mfma_f32_16x16x32_bf16 v[164:167], a[72:75], a[128:131], v[164:167]
ds_read_b64_tr_b16 a[138:139], v9 offset:34816
v_cvt_pk_bf16_f32 v147, v150, v151
v_mfma_f32_16x16x32_bf16 v[164:167], a[76:79], a[132:135], v[164:167]
v_mfma_f32_16x16x32_bf16 v[168:171], a[80:83], a[128:131], v[168:171]
ds_read_b64_tr_b16 a[140:141], v9 offset:49152
v_cvt_pk_bf16_f32 v152, v152, v153
v_mfma_f32_16x16x32_bf16 v[168:171], a[84:87], a[132:135], v[168:171]
v_cvt_pk_bf16_f32 v153, v154, v155
v_cvt_pk_bf16_f32 v154, v156, v157
v_mfma_f32_16x16x32_bf16 v[172:175], a[88:91], a[128:131], v[172:175]
ds_read_b64_tr_b16 a[142:143], v9 offset:51200
v_cvt_pk_bf16_f32 v155, v158, v159
v_mfma_f32_16x16x32_bf16 v[172:175], a[92:95], a[132:135], v[172:175]
v_mfma_f32_16x16x32_bf16 v[176:179], a[96:99], a[128:131], v[176:179]
buffer_store_dwordx4 v[56:59], v1, s[4:7], s31 offen sc1
v_mfma_f32_16x16x32_bf16 v[176:179], a[100:103], a[132:135], v[176:179]
s_add_u32 s31, s31, s34
v_cvt_pk_bf16_f32 v160, v160, v161
v_cvt_pk_bf16_f32 v161, v162, v163
v_mfma_f32_16x16x32_bf16 v[180:183], a[104:107], a[128:131], v[180:183]
ds_read_b128 a[44:47], v3 offset:10240
v_cvt_pk_bf16_f32 v162, v164, v165
v_mfma_f32_16x16x32_bf16 v[180:183], a[108:111], a[132:135], v[180:183]
v_cvt_pk_bf16_f32 v163, v166, v167
v_mfma_f32_16x16x32_bf16 v[184:187], a[112:115], a[128:131], v[184:187]
ds_read_b128 a[48:51], v2 offset:12288
v_cvt_pk_bf16_f32 v168, v168, v169
v_mfma_f32_16x16x32_bf16 v[184:187], a[116:119], a[132:135], v[184:187]
v_cvt_pk_bf16_f32 v169, v170, v171
v_cvt_pk_bf16_f32 v170, v172, v173
v_mfma_f32_16x16x32_bf16 v[188:191], a[120:123], a[128:131], v[188:191]
v_cvt_pk_bf16_f32 v171, v174, v175
v_mfma_f32_16x16x32_bf16 v[188:191], a[124:127], a[132:135], v[188:191]
s_waitcnt lgkmcnt(2)
v_mfma_f32_16x16x32_bf16 v[192:195], a[64:67], a[136:139], v[192:195]
ds_read_b64_tr_b16 a[128:129], v10 offset:32768
v_cvt_pk_bf16_f32 v176, v176, v177
v_mfma_f32_16x16x32_bf16 v[192:195], a[68:71], a[140:143], v[192:195]
v_cvt_pk_bf16_f32 v177, v178, v179
v_cvt_pk_bf16_f32 v178, v180, v181
v_mfma_f32_16x16x32_bf16 v[196:199], a[72:75], a[136:139], v[196:199]
ds_read_b64_tr_b16 a[130:131], v10 offset:34816
v_cvt_pk_bf16_f32 v179, v182, v183
v_mfma_f32_16x16x32_bf16 v[196:199], a[76:79], a[140:143], v[196:199]
buffer_store_dwordx4 v[64:67], v1, s[4:7], s31 offen sc1
v_mfma_f32_16x16x32_bf16 v[200:203], a[80:83], a[136:139], v[200:203]
s_add_u32 s31, s31, s32
ds_read_b64_tr_b16 a[132:133], v10 offset:49152
v_cvt_pk_bf16_f32 v184, v184, v185
v_mfma_f32_16x16x32_bf16 v[200:203], a[84:87], a[140:143], v[200:203]
v_cvt_pk_bf16_f32 v185, v186, v187
v_cvt_pk_bf16_f32 v186, v188, v189
v_mfma_f32_16x16x32_bf16 v[204:207], a[88:91], a[136:139], v[204:207]
ds_read_b64_tr_b16 a[134:135], v10 offset:51200
v_cvt_pk_bf16_f32 v187, v190, v191
v_mfma_f32_16x16x32_bf16 v[204:207], a[92:95], a[140:143], v[204:207]
v_mfma_f32_16x16x32_bf16 v[208:211], a[96:99], a[136:139], v[208:211]
ds_read_b128 a[52:55], v3 offset:12288
v_cvt_pk_bf16_f32 v192, v192, v193
v_mfma_f32_16x16x32_bf16 v[208:211], a[100:103], a[140:143], v[208:211]
v_cvt_pk_bf16_f32 v193, v194, v195
v_cvt_pk_bf16_f32 v194, v196, v197
v_mfma_f32_16x16x32_bf16 v[212:215], a[104:107], a[136:139], v[212:215]
ds_read_b128 a[56:59], v2 offset:14336
v_cvt_pk_bf16_f32 v195, v198, v199
v_mfma_f32_16x16x32_bf16 v[212:215], a[108:111], a[140:143], v[212:215]
v_mfma_f32_16x16x32_bf16 v[216:219], a[112:115], a[136:139], v[216:219]
v_cvt_pk_bf16_f32 v200, v200, v201
v_cvt_pk_bf16_f32 v201, v202, v203
v_mfma_f32_16x16x32_bf16 v[216:219], a[116:119], a[140:143], v[216:219]
buffer_store_dwordx4 v[72:75], v1, s[4:7], s31 offen sc1
v_mfma_f32_16x16x32_bf16 v[220:223], a[120:123], a[136:139], v[220:223]
s_add_u32 s31, s31, s33
ds_read_b128 a[60:63], v3 offset:14336
v_cvt_pk_bf16_f32 v202, v204, v205
v_mfma_f32_16x16x32_bf16 v[220:223], a[124:127], a[140:143], v[220:223]
s_waitcnt lgkmcnt(3)
v_cvt_pk_bf16_f32 v203, v206, v207
v_mfma_f32_16x16x32_bf16 a[192:195], a[64:67], a[128:131], a[192:195]
ds_read_b64_tr_b16 a[136:137], v11 offset:32768
v_cvt_pk_bf16_f32 v208, v208, v209
v_mfma_f32_16x16x32_bf16 a[192:195], a[68:71], a[132:135], a[192:195]
v_cvt_pk_bf16_f32 v209, v210, v211
v_cvt_pk_bf16_f32 v210, v212, v213
v_mfma_f32_16x16x32_bf16 a[196:199], a[72:75], a[128:131], a[196:199]
ds_read_b64_tr_b16 a[138:139], v11 offset:34816
v_cvt_pk_bf16_f32 v211, v214, v215
v_mfma_f32_16x16x32_bf16 a[196:199], a[76:79], a[132:135], a[196:199]
v_mfma_f32_16x16x32_bf16 a[200:203], a[80:83], a[128:131], a[200:203]
ds_read_b64_tr_b16 a[140:141], v11 offset:49152
v_cvt_pk_bf16_f32 v216, v216, v217
v_mfma_f32_16x16x32_bf16 a[200:203], a[84:87], a[132:135], a[200:203]
v_cvt_pk_bf16_f32 v217, v218, v219
v_cvt_pk_bf16_f32 v218, v220, v221
v_mfma_f32_16x16x32_bf16 a[204:207], a[88:91], a[128:131], a[204:207]
ds_read_b64_tr_b16 a[142:143], v11 offset:51200
v_cvt_pk_bf16_f32 v219, v222, v223
v_mfma_f32_16x16x32_bf16 a[204:207], a[92:95], a[132:135], a[204:207]
v_mfma_f32_16x16x32_bf16 a[208:211], a[96:99], a[128:131], a[208:211]
buffer_store_dwordx4 v[80:83], v1, s[4:7], s31 offen sc1
v_mfma_f32_16x16x32_bf16 a[208:211], a[100:103], a[132:135], a[208:211]
s_add_u32 s31, s31, s32
v_mfma_f32_16x16x32_bf16 a[212:215], a[104:107], a[128:131], a[212:215]
v_mfma_f32_16x16x32_bf16 a[212:215], a[108:111], a[132:135], a[212:215]
v_mfma_f32_16x16x32_bf16 a[216:219], a[112:115], a[128:131], a[216:219]
v_mfma_f32_16x16x32_bf16 a[216:219], a[116:119], a[132:135], a[216:219]
v_mfma_f32_16x16x32_bf16 a[220:223], a[120:123], a[128:131], a[220:223]
s_waitcnt vmcnt(23) lgkmcnt(0)
v_mfma_f32_16x16x32_bf16 a[220:223], a[124:127], a[132:135], a[220:223]
s_barrier
v_mfma_f32_16x16x32_bf16 a[224:227], a[64:67], a[136:139], a[224:227]
s_add_u32 m0, s29, 98304
ds_read_b64_tr_b16 a[128:129], v22 offset:0
v_mfma_f32_16x16x32_bf16 a[224:227], a[68:71], a[140:143], a[224:227]
buffer_load_dwordx4 v16, s[12:15], s26 offen offset:0 lds
v_mfma_f32_16x16x32_bf16 a[228:231], a[72:75], a[136:139], a[228:231]
ds_read_b64_tr_b16 a[130:131], v22 offset:2048
v_mfma_f32_16x16x32_bf16 a[228:231], a[76:79], a[140:143], a[228:231]
buffer_store_dwordx4 v[88:91], v1, s[4:7], s31 offen sc1
v_mfma_f32_16x16x32_bf16 a[232:235], a[80:83], a[136:139], a[232:235]
s_add_u32 s31, s31, s35
ds_read_b64_tr_b16 a[132:133], v22 offset:16384
v_mfma_f32_16x16x32_bf16 a[232:235], a[84:87], a[140:143], a[232:235]
buffer_load_dwordx4 v17, s[12:15], s26 offen offset:1024 lds
v_mfma_f32_16x16x32_bf16 a[236:239], a[88:91], a[136:139], a[236:239]
ds_read_b64_tr_b16 a[134:135], v22 offset:18432
v_add_u32 v22, 4294901760, v22
v_mfma_f32_16x16x32_bf16 a[236:239], a[92:95], a[140:143], a[236:239]
v_mfma_f32_16x16x32_bf16 a[240:243], a[96:99], a[136:139], a[240:243]
v_mfma_f32_16x16x32_bf16 a[240:243], a[100:103], a[140:143], a[240:243]
buffer_load_dwordx4 v18, s[12:15], s26 offen offset:2048 lds
v_mfma_f32_16x16x32_bf16 a[244:247], a[104:107], a[136:139], a[244:247]
v_mfma_f32_16x16x32_bf16 a[244:247], a[108:111], a[140:143], a[244:247]
v_mfma_f32_16x16x32_bf16 a[248:251], a[112:115], a[136:139], a[248:251]
v_mfma_f32_16x16x32_bf16 a[248:251], a[116:119], a[140:143], a[248:251]
buffer_load_dwordx4 v19, s[12:15], s26 offen offset:3072 lds
v_mfma_f32_16x16x32_bf16 a[252:255], a[120:123], a[136:139], a[252:255]
s_add_u32 s26, s26, 524288
v_mfma_f32_16x16x32_bf16 a[252:255], a[124:127], a[140:143], a[252:255]
s_waitcnt lgkmcnt(0)
s_cmp_ge_u32 s21, 7
s_cbranch_scc1 M_Q
M_conv:
v_mfma_f32_16x16x32_bf16 v[36:39], a[128:131], a[0:3], 0
s_add_u32 m0, s29, 114688
ds_read_b64_tr_b16 a[136:137], v23 offset:0
v_mfma_f32_16x16x32_bf16 v[36:39], a[132:135], a[4:7], v[36:39]
buffer_load_dwordx4 v16, s[12:15], s27 offen offset:0 lds
v_mfma_f32_16x16x32_bf16 v[44:47], a[128:131], a[8:11], 0
ds_read_b64_tr_b16 a[138:139], v23 offset:2048
v_mfma_f32_16x16x32_bf16 v[44:47], a[132:135], a[12:15], v[44:47]
ds_read_b128 a[64:67], v2 offset:16384
ds_read_b128 a[68:71], v3 offset:16384
v_mfma_f32_16x16x32_bf16 v[52:55], a[128:131], a[16:19], 0
ds_read_b64_tr_b16 a[140:141], v23 offset:16384
v_mfma_f32_16x16x32_bf16 v[52:55], a[132:135], a[20:23], v[52:55]
buffer_load_dwordx4 v17, s[12:15], s27 offen offset:1024 lds
v_mfma_f32_16x16x32_bf16 v[60:63], a[128:131], a[24:27], 0
ds_read_b64_tr_b16 a[142:143], v23 offset:18432
v_add_u32 v23, 4294901760, v23
v_mfma_f32_16x16x32_bf16 v[60:63], a[132:135], a[28:31], v[60:63]
buffer_store_dwordx4 v[96:99], v1, s[4:7], s31 offen sc1
v_mfma_f32_16x16x32_bf16 v[68:71], a[128:131], a[32:35], 0
s_add_u32 s31, s31, s32
ds_read_b128 a[72:75], v2 offset:18432
v_mfma_f32_16x16x32_bf16 v[68:71], a[132:135], a[36:39], v[68:71]
buffer_load_dwordx4 v18, s[12:15], s27 offen offset:2048 lds
v_mfma_f32_16x16x32_bf16 v[76:79], a[128:131], a[40:43], 0
ds_read_b128 a[76:79], v3 offset:18432
v_mfma_f32_16x16x32_bf16 v[76:79], a[132:135], a[44:47], v[76:79]
ds_read_b128 a[80:83], v2 offset:20480
v_mfma_f32_16x16x32_bf16 v[84:87], a[128:131], a[48:51], 0
ds_read_b128 a[84:87], v3 offset:20480
v_mfma_f32_16x16x32_bf16 v[84:87], a[132:135], a[52:55], v[84:87]
buffer_load_dwordx4 v19, s[12:15], s27 offen offset:3072 lds
v_mfma_f32_16x16x32_bf16 v[92:95], a[128:131], a[56:59], 0
s_add_u32 s27, s27, 524288
ds_read_b128 a[88:91], v2 offset:22528
v_mfma_f32_16x16x32_bf16 v[92:95], a[132:135], a[60:63], v[92:95]
s_waitcnt lgkmcnt(5)
buffer_store_dwordx4 v[104:107], v1, s[4:7], s31 offen sc1
v_mfma_f32_16x16x32_bf16 v[100:103], a[136:139], a[0:3], 0
s_add_u32 m0, s28, 0
ds_read_b64_tr_b16 a[128:129], v24 offset:0
v_mfma_f32_16x16x32_bf16 v[100:103], a[140:143], a[4:7], v[100:103]
s_add_u32 s31, s31, s33
buffer_load_dwordx4 v12, s[8:11], s24 offen offset:0 lds
v_mfma_f32_16x16x32_bf16 v[108:111], a[136:139], a[8:11], 0
ds_read_b64_tr_b16 a[130:131], v24 offset:2048
v_mfma_f32_16x16x32_bf16 v[108:111], a[140:143], a[12:15], v[108:111]
ds_read_b128 a[92:95], v3 offset:22528
v_mfma_f32_16x16x32_bf16 v[116:119], a[136:139], a[16:19], 0
ds_read_b64_tr_b16 a[132:133], v24 offset:16384
v_mfma_f32_16x16x32_bf16 v[116:119], a[140:143], a[20:23], v[116:119]
buffer_load_dwordx4 v13, s[8:11], s24 offen offset:1024 lds
v_mfma_f32_16x16x32_bf16 v[124:127], a[136:139], a[24:27], 0
ds_read_b64_tr_b16 a[134:135], v24 offset:18432
v_add_u32 v24, 4294901760, v24
v_mfma_f32_16x16x32_bf16 v[124:127], a[140:143], a[28:31], v[124:127]
v_mfma_f32_16x16x32_bf16 v[132:135], a[136:139], a[32:35], 0
ds_read_b128 a[96:99], v2 offset:24576
v_mfma_f32_16x16x32_bf16 v[132:135], a[140:143], a[36:39], v[132:135]
buffer_load_dwordx4 v14, s[8:11], s24 offen offset:2048 lds
v_mfma_f32_16x16x32_bf16 v[140:143], a[136:139], a[40:43], 0
ds_read_b128 a[100:103], v3 offset:24576
v_mfma_f32_16x16x32_bf16 v[140:143], a[140:143], a[44:47], v[140:143]
ds_read_b128 a[104:107], v2 offset:26624
v_mfma_f32_16x16x32_bf16 v[148:151], a[136:139], a[48:51], 0
ds_read_b128 a[108:111], v3 offset:26624
v_mfma_f32_16x16x32_bf16 v[148:151], a[140:143], a[52:55], v[148:151]
buffer_load_dwordx4 v15, s[8:11], s24 offen offset:3072 lds
v_mfma_f32_16x16x32_bf16 v[156:159], a[136:139], a[56:59], 0
s_add_u32 s24, s24, 128
ds_read_b128 a[112:115], v2 offset:28672
v_mfma_f32_16x16x32_bf16 v[156:159], a[140:143], a[60:63], v[156:159]
s_waitcnt lgkmcnt(5)
buffer_store_dwordx4 v[112:115], v1, s[4:7], s31 offen sc1
v_mfma_f32_16x16x32_bf16 v[164:167], a[128:131], a[0:3], 0
s_add_u32 s31, s31, s32
ds_read_b64_tr_b16 a[136:137], v25 offset:0
v_mfma_f32_16x16x32_bf16 v[164:167], a[132:135], a[4:7], v[164:167]
v_mfma_f32_16x16x32_bf16 v[172:175], a[128:131], a[8:11], 0
ds_read_b64_tr_b16 a[138:139], v25 offset:2048
v_mfma_f32_16x16x32_bf16 v[172:175], a[132:135], a[12:15], v[172:175]
ds_read_b128 a[116:119], v3 offset:28672
v_mfma_f32_16x16x32_bf16 v[180:183], a[128:131], a[16:19], 0
ds_read_b64_tr_b16 a[140:141], v25 offset:16384
v_mfma_f32_16x16x32_bf16 v[180:183], a[132:135], a[20:23], v[180:183]
v_mfma_f32_16x16x32_bf16 v[188:191], a[128:131], a[24:27], 0
ds_read_b64_tr_b16 a[142:143], v25 offset:18432
v_add_u32 v25, 4294901760, v25
v_mfma_f32_16x16x32_bf16 v[188:191], a[132:135], a[28:31], v[188:191]
v_mfma_f32_16x16x32_bf16 v[196:199], a[128:131], a[32:35], 0
ds_read_b128 a[120:123], v2 offset:30720
v_mfma_f32_16x16x32_bf16 v[196:199], a[132:135], a[36:39], v[196:199]
v_mfma_f32_16x16x32_bf16 v[204:207], a[128:131], a[40:43], 0
ds_read_b128 a[124:127], v3 offset:30720
v_mfma_f32_16x16x32_bf16 v[204:207], a[132:135], a[44:47], v[204:207]
v_mfma_f32_16x16x32_bf16 v[212:215], a[128:131], a[48:51], 0
v_mfma_f32_16x16x32_bf16 v[212:215], a[132:135], a[52:55], v[212:215]
buffer_store_dwordx4 v[120:123], v1, s[4:7], s31 offen sc1
v_mfma_f32_16x16x32_bf16 v[220:223], a[128:131], a[56:59], 0
s_add_u32 s31, s31, s34
v_mfma_f32_16x16x32_bf16 v[220:223], a[132:135], a[60:63], v[220:223]
s_waitcnt vmcnt(28) lgkmcnt(0)
s_barrier
v_mfma_f32_16x16x32_bf16 v[224:227], a[136:139], a[0:3], 0
s_add_u32 m0, s29, 131072
ds_read_b64_tr_b16 a[128:129], v22 offset:0
v_mfma_f32_16x16x32_bf16 v[224:227], a[140:143], a[4:7], v[224:227]
buffer_load_dwordx4 v16, s[12:15], s26 offen offset:0 lds
v_mfma_f32_16x16x32_bf16 v[228:231], a[136:139], a[8:11], 0
ds_read_b64_tr_b16 a[130:131], v22 offset:2048
v_mfma_f32_16x16x32_bf16 v[228:231], a[140:143], a[12:15], v[228:231]
v_mfma_f32_16x16x32_bf16 v[232:235], a[136:139], a[16:19], 0
ds_read_b64_tr_b16 a[132:133], v22 offset:16384
v_mfma_f32_16x16x32_bf16 v[232:235], a[140:143], a[20:23], v[232:235]
buffer_load_dwordx4 v17, s[12:15], s26 offen offset:1024 lds
v_mfma_f32_16x16x32_bf16 v[236:239], a[136:139], a[24:27], 0
ds_read_b64_tr_b16 a[134:135], v22 offset:18432
v_add_u32 v22, 32768, v22
v_mfma_f32_16x16x32_bf16 v[236:239], a[140:143], a[28:31], v[236:239]
v_mfma_f32_16x16x32_bf16 v[240:243], a[136:139], a[32:35], 0
v_mfma_f32_16x16x32_bf16 v[240:243], a[140:143], a[36:39], v[240:243]
buffer_load_dwordx4 v18, s[12:15], s26 offen offset:2048 lds
v_mfma_f32_16x16x32_bf16 v[244:247], a[136:139], a[40:43], 0
v_mfma_f32_16x16x32_bf16 v[244:247], a[140:143], a[44:47], v[244:247]
v_mfma_f32_16x16x32_bf16 v[248:251], a[136:139], a[48:51], 0
v_mfma_f32_16x16x32_bf16 v[248:251], a[140:143], a[52:55], v[248:251]
buffer_load_dwordx4 v19, s[12:15], s26 offen offset:3072 lds
v_mfma_f32_16x16x32_bf16 v[252:255], a[136:139], a[56:59], 0
s_add_u32 s26, s26, 524288
v_mfma_f32_16x16x32_bf16 v[252:255], a[140:143], a[60:63], v[252:255]
s_waitcnt lgkmcnt(0)
v_mfma_f32_16x16x32_bf16 v[36:39], a[128:131], a[64:67], v[36:39]
s_add_u32 m0, s29, 147456
ds_read_b64_tr_b16 a[136:137], v23 offset:0
v_mfma_f32_16x16x32_bf16 v[36:39], a[132:135], a[68:71], v[36:39]
buffer_load_dwordx4 v16, s[12:15], s27 offen offset:0 lds
v_mfma_f32_16x16x32_bf16 v[44:47], a[128:131], a[72:75], v[44:47]
ds_read_b64_tr_b16 a[138:139], v23 offset:2048
v_mfma_f32_16x16x32_bf16 v[44:47], a[132:135], a[76:79], v[44:47]
ds_read_b128 a[0:3], v2 offset:32768
ds_read_b128 a[4:7], v3 offset:32768
v_mfma_f32_16x16x32_bf16 v[52:55], a[128:131], a[80:83], v[52:55]
ds_read_b64_tr_b16 a[140:141], v23 offset:16384
v_mfma_f32_16x16x32_bf16 v[52:55], a[132:135], a[84:87], v[52:55]
buffer_load_dwordx4 v17, s[12:15], s27 offen offset:1024 lds
v_mfma_f32_16x16x32_bf16 v[60:63], a[128:131], a[88:91], v[60:63]
ds_read_b64_tr_b16 a[142:143], v23 offset:18432
v_add_u32 v23, 32768, v23
v_mfma_f32_16x16x32_bf16 v[60:63], a[132:135], a[92:95], v[60:63]
buffer_store_dwordx4 v[128:131], v1, s[4:7], s31 offen sc1
v_mfma_f32_16x16x32_bf16 v[68:71], a[128:131], a[96:99], v[68:71]
s_add_u32 s31, s31, s32
ds_read_b128 a[8:11], v2 offset:34816
v_accvgpr_read_b32 v32, a192
v_mfma_f32_16x16x32_bf16 v[68:71], a[132:135], a[100:103], v[68:71]
buffer_load_dwordx4 v18, s[12:15], s27 offen offset:2048 lds
v_mfma_f32_16x16x32_bf16 v[76:79], a[128:131], a[104:107], v[76:79]
ds_read_b128 a[12:15], v3 offset:34816
v_accvgpr_read_b32 v33, a193
v_mfma_f32_16x16x32_bf16 v[76:79], a[132:135], a[108:111], v[76:79]
ds_read_b128 a[16:19], v2 offset:36864
v_accvgpr_read_b32 v34, a194
v_mfma_f32_16x16x32_bf16 v[84:87], a[128:131], a[112:115], v[84:87]
ds_read_b128 a[20:23], v3 offset:36864
v_accvgpr_read_b32 v35, a195
v_mfma_f32_16x16x32_bf16 v[84:87], a[132:135], a[116:119], v[84:87]
buffer_load_dwordx4 v19, s[12:15], s27 offen offset:3072 lds
v_mfma_f32_16x16x32_bf16 v[92:95], a[128:131], a[120:123], v[92:95]
s_add_u32 s27, s27, 524288
ds_read_b128 a[24:27], v2 offset:38912
v_accvgpr_read_b32 v96, a196
v_mfma_f32_16x16x32_bf16 v[92:95], a[132:135], a[124:127], v[92:95]
s_waitcnt lgkmcnt(5)
buffer_store_dwordx4 v[136:139], v1, s[4:7], s31 offen sc1
v_mfma_f32_16x16x32_bf16 v[100:103], a[136:139], a[64:67], v[100:103]
s_add_u32 m0, s28, 16384
ds_read_b64_tr_b16 a[128:129], v24 offset:0
v_accvgpr_read_b32 v97, a197
v_mfma_f32_16x16x32_bf16 v[100:103], a[140:143], a[68:71], v[100:103]
s_add_u32 s31, s31, s33
buffer_load_dwordx4 v12, s[8:11], s24 offen offset:0 lds
v_mfma_f32_16x16x32_bf16 v[108:111], a[136:139], a[72:75], v[108:111]
ds_read_b64_tr_b16 a[130:131], v24 offset:2048
v_accvgpr_read_b32 v98, a198
v_mfma_f32_16x16x32_bf16 v[108:111], a[140:143], a[76:79], v[108:111]
ds_read_b128 a[28:31], v3 offset:38912
v_accvgpr_read_b32 v99, a199
v_mfma_f32_16x16x32_bf16 v[116:119], a[136:139], a[80:83], v[116:119]
ds_read_b64_tr_b16 a[132:133], v24 offset:16384
v_cvt_pk_bf16_f32 v32, v32, v33
v_mfma_f32_16x16x32_bf16 v[116:119], a[140:143], a[84:87], v[116:119]
buffer_load_dwordx4 v13, s[8:11], s24 offen offset:1024 lds
v_mfma_f32_16x16x32_bf16 v[124:127], a[136:139], a[88:91], v[124:127]
ds_read_b64_tr_b16 a[134:135], v24 offset:18432
v_add_u32 v24, 32768, v24
v_mfma_f32_16x16x32_bf16 v[124:127], a[140:143], a[92:95], v[124:127]
v_cvt_pk_bf16_f32 v33, v34, v35
v_cvt_pk_bf16_f32 v34, v96, v97
v_mfma_f32_16x16x32_bf16 v[132:135], a[136:139], a[96:99], v[132:135]
ds_read_b128 a[32:35], v2 offset:40960
v_cvt_pk_bf16_f32 v35, v98, v99
v_mfma_f32_16x16x32_bf16 v[132:135], a[140:143], a[100:103], v[132:135]
buffer_load_dwordx4 v14, s[8:11], s24 offen offset:2048 lds
v_mfma_f32_16x16x32_bf16 v[140:143], a[136:139], a[104:107], v[140:143]
ds_read_b128 a[36:39], v3 offset:40960
v_accvgpr_read_b32 v40, a200
v_mfma_f32_16x16x32_bf16 v[140:143], a[140:143], a[108:111], v[140:143]
ds_read_b128 a[40:43], v2 offset:43008
v_accvgpr_read_b32 v41, a201
v_mfma_f32_16x16x32_bf16 v[148:151], a[136:139], a[112:115], v[148:151]
ds_read_b128 a[44:47], v3 offset:43008
v_accvgpr_read_b32 v42, a202
v_mfma_f32_16x16x32_bf16 v[148:151], a[140:143], a[116:119], v[148:151]
buffer_load_dwordx4 v15, s[8:11], s24 offen offset:3072 lds
v_mfma_f32_16x16x32_bf16 v[156:159], a[136:139], a[120:123], v[156:159]
s_add_u32 s24, s24, 128
ds_read_b128 a[48:51], v2 offset:45056
v_accvgpr_read_b32 v43, a203
v_mfma_f32_16x16x32_bf16 v[156:159], a[140:143], a[124:127], v[156:159]
s_waitcnt lgkmcnt(5)
buffer_store_dwordx4 v[144:147], v1, s[4:7], s31 offen sc1
v_mfma_f32_16x16x32_bf16 v[164:167], a[128:131], a[64:67], v[164:167]
s_add_u32 s31, s31, s32
ds_read_b64_tr_b16 a[136:137], v25 offset:0
v_accvgpr_read_b32 v96, a204
v_mfma_f32_16x16x32_bf16 v[164:167], a[132:135], a[68:71], v[164:167]
v_accvgpr_read_b32 v97, a205
v_accvgpr_read_b32 v98, a206
v_mfma_f32_16x16x32_bf16 v[172:175], a[128:131], a[72:75], v[172:175]
ds_read_b64_tr_b16 a[138:139], v25 offset:2048
v_accvgpr_read_b32 v99, a207
v_mfma_f32_16x16x32_bf16 v[172:175], a[132:135], a[76:79], v[172:175]
ds_read_b128 a[52:55], v3 offset:45056
v_cvt_pk_bf16_f32 v40, v40, v41
v_mfma_f32_16x16x32_bf16 v[180:183], a[128:131], a[80:83], v[180:183]
ds_read_b64_tr_b16 a[140:141], v25 offset:16384
v_cvt_pk_bf16_f32 v41, v42, v43
v_mfma_f32_16x16x32_bf16 v[180:183], a[132:135], a[84:87], v[180:183]
v_cvt_pk_bf16_f32 v42, v96, v97
v_cvt_pk_bf16_f32 v43, v98, v99
v_mfma_f32_16x16x32_bf16 v[188:191], a[128:131], a[88:91], v[188:191]
ds_read_b64_tr_b16 a[142:143], v25 offset:18432
v_add_u32 v25, 32768, v25
v_mfma_f32_16x16x32_bf16 v[188:191], a[132:135], a[92:95], v[188:191]
v_accvgpr_read_b32 v48, a208
v_accvgpr_read_b32 v49, a209
v_mfma_f32_16x16x32_bf16 v[196:199], a[128:131], a[96:99], v[196:199]
ds_read_b128 a[56:59], v2 offset:47104
v_accvgpr_read_b32 v50, a210
v_mfma_f32_16x16x32_bf16 v[196:199], a[132:135], a[100:103], v[196:199]
v_accvgpr_read_b32 v51, a211
v_accvgpr_read_b32 v96, a212
v_mfma_f32_16x16x32_bf16 v[204:207], a[128:131], a[104:107], v[204:207]
ds_read_b128 a[60:63], v3 offset:47104
v_accvgpr_read_b32 v97, a213
v_mfma_f32_16x16x32_bf16 v[204:207], a[132:135], a[108:111], v[204:207]
v_accvgpr_read_b32 v98, a214
v_accvgpr_read_b32 v99, a215
v_mfma_f32_16x16x32_bf16 v[212:215], a[128:131], a[112:115], v[212:215]
v_cvt_pk_bf16_f32 v48, v48, v49
v_cvt_pk_bf16_f32 v49, v50, v51
v_mfma_f32_16x16x32_bf16 v[212:215], a[132:135], a[116:119], v[212:215]
buffer_store_dwordx4 v[152:155], v1, s[4:7], s31 offen sc1
v_mfma_f32_16x16x32_bf16 v[220:223], a[128:131], a[120:123], v[220:223]
s_add_u32 s31, s31, s36
v_cvt_pk_bf16_f32 v50, v96, v97
v_cvt_pk_bf16_f32 v51, v98, v99
v_mfma_f32_16x16x32_bf16 v[220:223], a[132:135], a[124:127], v[220:223]
s_waitcnt vmcnt(23) lgkmcnt(0)
s_barrier
v_accvgpr_read_b32 v56, a216
v_mfma_f32_16x16x32_bf16 v[224:227], a[136:139], a[64:67], v[224:227]
s_add_u32 m0, s29, 65536
ds_read_b64_tr_b16 a[128:129], v22 offset:0
v_accvgpr_read_b32 v57, a217
v_mfma_f32_16x16x32_bf16 v[224:227], a[140:143], a[68:71], v[224:227]
buffer_load_dwordx4 v16, s[12:15], s26 offen offset:0 lds
v_mfma_f32_16x16x32_bf16 v[228:231], a[136:139], a[72:75], v[228:231]
ds_read_b64_tr_b16 a[130:131], v22 offset:2048
v_accvgpr_read_b32 v58, a218
v_mfma_f32_16x16x32_bf16 v[228:231], a[140:143], a[76:79], v[228:231]
v_accvgpr_read_b32 v59, a219
v_accvgpr_read_b32 v96, a220
v_mfma_f32_16x16x32_bf16 v[232:235], a[136:139], a[80:83], v[232:235]
ds_read_b64_tr_b16 a[132:133], v22 offset:16384
v_accvgpr_read_b32 v97, a221
v_mfma_f32_16x16x32_bf16 v[232:235], a[140:143], a[84:87], v[232:235]
buffer_load_dwordx4 v17, s[12:15], s26 offen offset:1024 lds
v_mfma_f32_16x16x32_bf16 v[236:239], a[136:139], a[88:91], v[236:239]
ds_read_b64_tr_b16 a[134:135], v22 offset:18432
v_add_u32 v22, 32768, v22
v_mfma_f32_16x16x32_bf16 v[236:239], a[140:143], a[92:95], v[236:239]
v_accvgpr_read_b32 v98, a222
v_accvgpr_read_b32 v99, a223
v_mfma_f32_16x16x32_bf16 v[240:243], a[136:139], a[96:99], v[240:243]
v_cvt_pk_bf16_f32 v56, v56, v57
v_cvt_pk_bf16_f32 v57, v58, v59
v_mfma_f32_16x16x32_bf16 v[240:243], a[140:143], a[100:103], v[240:243]
buffer_load_dwordx4 v18, s[12:15], s26 offen offset:2048 lds
v_mfma_f32_16x16x32_bf16 v[244:247], a[136:139], a[104:107], v[244:247]
v_cvt_pk_bf16_f32 v58, v96, v97
v_cvt_pk_bf16_f32 v59, v98, v99
v_mfma_f32_16x16x32_bf16 v[244:247], a[140:143], a[108:111], v[244:247]
PAD_28:
s_cbranch_execz M_tret
v_accvgpr_read_b32 v64, a224
v_accvgpr_read_b32 v65, a225
v_mfma_f32_16x16x32_bf16 v[248:251], a[136:139], a[112:115], v[248:251]
v_accvgpr_read_b32 v66, a226
v_accvgpr_read_b32 v67, a227
v_mfma_f32_16x16x32_bf16 v[248:251], a[140:143], a[116:119], v[248:251]
buffer_load_dwordx4 v19, s[12:15], s26 offen offset:3072 lds
v_mfma_f32_16x16x32_bf16 v[252:255], a[136:139], a[120:123], v[252:255]
s_add_u32 s26, s26, 524288
v_accvgpr_read_b32 v96, a228
v_accvgpr_read_b32 v97, a229
v_mfma_f32_16x16x32_bf16 v[252:255], a[140:143], a[124:127], v[252:255]
s_waitcnt lgkmcnt(0)
v_accvgpr_read_b32 v98, a230
v_accvgpr_read_b32 v99, a231
v_mfma_f32_16x16x32_bf16 v[36:39], a[128:131], a[0:3], v[36:39]
s_add_u32 m0, s29, 81920
ds_read_b64_tr_b16 a[136:137], v23 offset:0
v_cvt_pk_bf16_f32 v64, v64, v65
v_mfma_f32_16x16x32_bf16 v[36:39], a[132:135], a[4:7], v[36:39]
buffer_load_dwordx4 v16, s[12:15], s27 offen offset:0 lds
v_mfma_f32_16x16x32_bf16 v[44:47], a[128:131], a[8:11], v[44:47]
ds_read_b64_tr_b16 a[138:139], v23 offset:2048
v_cvt_pk_bf16_f32 v65, v66, v67
v_mfma_f32_16x16x32_bf16 v[44:47], a[132:135], a[12:15], v[44:47]
ds_read_b128 a[64:67], v2 offset:49152
ds_read_b128 a[68:71], v3 offset:49152
v_mfma_f32_16x16x32_bf16 v[52:55], a[128:131], a[16:19], v[52:55]
ds_read_b64_tr_b16 a[140:141], v23 offset:16384
v_cvt_pk_bf16_f32 v66, v96, v97
v_mfma_f32_16x16x32_bf16 v[52:55], a[132:135], a[20:23], v[52:55]
buffer_load_dwordx4 v17, s[12:15], s27 offen offset:1024 lds
v_mfma_f32_16x16x32_bf16 v[60:63], a[128:131], a[24:27], v[60:63]
ds_read_b64_tr_b16 a[142:143], v23 offset:18432
v_add_u32 v23, 32768, v23
v_mfma_f32_16x16x32_bf16 v[60:63], a[132:135], a[28:31], v[60:63]
buffer_store_dwordx4 v[160:163], v1, s[4:7], s31 offen sc1
v_mfma_f32_16x16x32_bf16 v[68:71], a[128:131], a[32:35], v[68:71]
s_add_u32 s31, s31, s32
ds_read_b128 a[72:75], v2 offset:51200
v_cvt_pk_bf16_f32 v67, v98, v99
v_mfma_f32_16x16x32_bf16 v[68:71], a[132:135], a[36:39], v[68:71]
buffer_load_dwordx4 v18, s[12:15], s27 offen offset:2048 lds
v_mfma_f32_16x16x32_bf16 v[76:79], a[128:131], a[40:43], v[76:79]
ds_read_b128 a[76:79], v3 offset:51200
v_accvgpr_read_b32 v72, a232
v_mfma_f32_16x16x32_bf16 v[76:79], a[132:135], a[44:47], v[76:79]
ds_read_b128 a[80:83], v2 offset:53248
v_accvgpr_read_b32 v73, a233
v_mfma_f32_16x16x32_bf16 v[84:87], a[128:131], a[48:51], v[84:87]
ds_read_b128 a[84:87], v3 offset:53248
v_accvgpr_read_b32 v74, a234
v_mfma_f32_16x16x32_bf16 v[84:87], a[132:135], a[52:55], v[84:87]
buffer_load_dwordx4 v19, s[12:15], s27 offen offset:3072 lds
v_mfma_f32_16x16x32_bf16 v[92:95], a[128:131], a[56:59], v[92:95]
s_add_u32 s27, s27, 524288
ds_read_b128 a[88:91], v2 offset:55296
v_accvgpr_read_b32 v75, a235
v_mfma_f32_16x16x32_bf16 v[92:95], a[132:135], a[60:63], v[92:95]
s_waitcnt lgkmcnt(5)
buffer_store_dwordx4 v[168:171], v1, s[4:7], s31 offen sc1
v_mfma_f32_16x16x32_bf16 v[100:103], a[136:139], a[0:3], v[100:103]
s_add_u32 m0, s28, 32768
ds_read_b64_tr_b16 a[128:129], v24 offset:0
v_accvgpr_read_b32 v96, a236
v_mfma_f32_16x16x32_bf16 v[100:103], a[140:143], a[4:7], v[100:103]
s_add_u32 s31, s31, s33
buffer_load_dwordx4 v12, s[8:11], s24 offen offset:0 lds
v_mfma_f32_16x16x32_bf16 v[108:111], a[136:139], a[8:11], v[108:111]
ds_read_b64_tr_b16 a[130:131], v24 offset:2048
v_accvgpr_read_b32 v97, a237
v_mfma_f32_16x16x32_bf16 v[108:111], a[140:143], a[12:15], v[108:111]
ds_read_b128 a[92:95], v3 offset:55296
v_accvgpr_read_b32 v98, a238
v_mfma_f32_16x16x32_bf16 v[116:119], a[136:139], a[16:19], v[116:119]
ds_read_b64_tr_b16 a[132:133], v24 offset:16384
v_accvgpr_read_b32 v99, a239
v_mfma_f32_16x16x32_bf16 v[116:119], a[140:143], a[20:23], v[116:119]
buffer_load_dwordx4 v13, s[8:11], s24 offen offset:1024 lds
v_mfma_f32_16x16x32_bf16 v[124:127], a[136:139], a[24:27], v[124:127]
ds_read_b64_tr_b16 a[134:135], v24 offset:18432
v_add_u32 v24, 32768, v24
v_mfma_f32_16x16x32_bf16 v[124:127], a[140:143], a[28:31], v[124:127]
v_cvt_pk_bf16_f32 v72, v72, v73
v_cvt_pk_bf16_f32 v73, v74, v75
v_mfma_f32_16x16x32_bf16 v[132:135], a[136:139], a[32:35], v[132:135]
ds_read_b128 a[96:99], v2 offset:57344
v_cvt_pk_bf16_f32 v74, v96, v97
v_mfma_f32_16x16x32_bf16 v[132:135], a[140:143], a[36:39], v[132:135]
buffer_load_dwordx4 v14, s[8:11], s24 offen offset:2048 lds
v_mfma_f32_16x16x32_bf16 v[140:143], a[136:139], a[40:43], v[140:143]
ds_read_b128 a[100:103], v3 offset:57344
v_cvt_pk_bf16_f32 v75, v98, v99
v_mfma_f32_16x16x32_bf16 v[140:143], a[140:143], a[44:47], v[140:143]
ds_read_b128 a[104:107], v2 offset:59392
v_accvgpr_read_b32 v80, a240
v_mfma_f32_16x16x32_bf16 v[148:151], a[136:139], a[48:51], v[148:151]
ds_read_b128 a[108:111], v3 offset:59392
v_accvgpr_read_b32 v81, a241
v_mfma_f32_16x16x32_bf16 v[148:151], a[140:143], a[52:55], v[148:151]
buffer_load_dwordx4 v15, s[8:11], s24 offen offset:3072 lds
v_mfma_f32_16x16x32_bf16 v[156:159], a[136:139], a[56:59], v[156:159]
s_add_u32 s24, s24, 128
ds_read_b128 a[112:115], v2 offset:61440
v_accvgpr_read_b32 v82, a242
v_mfma_f32_16x16x32_bf16 v[156:159], a[140:143], a[60:63], v[156:159]
s_waitcnt lgkmcnt(5)
buffer_store_dwordx4 v[176:179], v1, s[4:7], s31 offen sc1
v_mfma_f32_16x16x32_bf16 v[164:167], a[128:131], a[0:3], v[164:167]
s_add_u32 s31, s31, s32
ds_read_b64_tr_b16 a[136:137], v25 offset:0
v_accvgpr_read_b32 v83, a243
v_mfma_f32_16x16x32_bf16 v[164:167], a[132:135], a[4:7], v[164:167]
v_accvgpr_read_b32 v96, a244
v_accvgpr_read_b32 v97, a245
v_mfma_f32_16x16x32_bf16 v[172:175], a[128:131], a[8:11], v[172:175]
ds_read_b64_tr_b16 a[138:139], v25 offset:2048
v_accvgpr_read_b32 v98, a246
v_mfma_f32_16x16x32_bf16 v[172:175], a[132:135], a[12:15], v[172:175]
ds_read_b128 a[116:119], v3 offset:61440
v_accvgpr_read_b32 v99, a247
v_mfma_f32_16x16x32_bf16 v[180:183], a[128:131], a[16:19], v[180:183]
ds_read_b64_tr_b16 a[140:141], v25 offset:16384
v_cvt_pk_bf16_f32 v80, v80, v81
v_mfma_f32_16x16x32_bf16 v[180:183], a[132:135], a[20:23], v[180:183]
buffer_store_dwordx4 v[184:187], v1, s[4:7], s31 offen sc1
v_mfma_f32_16x16x32_bf16 v[188:191], a[128:131], a[24:27], v[188:191]
s_add_u32 s31, s31, s34
ds_read_b64_tr_b16 a[142:143], v25 offset:18432
v_add_u32 v25, 32768, v25
v_mfma_f32_16x16x32_bf16 v[188:191], a[132:135], a[28:31], v[188:191]
v_cvt_pk_bf16_f32 v81, v82, v83
v_cvt_pk_bf16_f32 v82, v96, v97
v_mfma_f32_16x16x32_bf16 v[196:199], a[128:131], a[32:35], v[196:199]
ds_read_b128 a[120:123], v2 offset:63488
v_cvt_pk_bf16_f32 v83, v98, v99
v_mfma_f32_16x16x32_bf16 v[196:199], a[132:135], a[36:39], v[196:199]
v_accvgpr_read_b32 v88, a248
v_accvgpr_read_b32 v89, a249
v_mfma_f32_16x16x32_bf16 v[204:207], a[128:131], a[40:43], v[204:207]
ds_read_b128 a[124:127], v3 offset:63488
v_accvgpr_read_b32 v90, a250
v_mfma_f32_16x16x32_bf16 v[204:207], a[132:135], a[44:47], v[204:207]
v_accvgpr_read_b32 v91, a251
v_accvgpr_read_b32 v96, a252
v_mfma_f32_16x16x32_bf16 v[212:215], a[128:131], a[48:51], v[212:215]
v_accvgpr_read_b32 v97, a253
v_accvgpr_read_b32 v98, a254
v_mfma_f32_16x16x32_bf16 v[212:215], a[132:135], a[52:55], v[212:215]
v_accvgpr_read_b32 v99, a255
v_cvt_pk_bf16_f32 v88, v88, v89
v_mfma_f32_16x16x32_bf16 v[220:223], a[128:131], a[56:59], v[220:223]
v_cvt_pk_bf16_f32 v89, v90, v91
v_cvt_pk_bf16_f32 v90, v96, v97
v_mfma_f32_16x16x32_bf16 v[220:223], a[132:135], a[60:63], v[220:223]
s_waitcnt vmcnt(23) lgkmcnt(0)
s_barrier
v_cvt_pk_bf16_f32 v91, v98, v99
v_mfma_f32_16x16x32_bf16 v[224:227], a[136:139], a[0:3], v[224:227]
s_add_u32 m0, s29, 98304
ds_read_b64_tr_b16 a[128:129], v22 offset:0
v_mfma_f32_16x16x32_bf16 v[224:227], a[140:143], a[4:7], v[224:227]
buffer_load_dwordx4 v16, s[12:15], s26 offen offset:0 lds
v_mfma_f32_16x16x32_bf16 v[228:231], a[136:139], a[8:11], v[228:231]
ds_read_b64_tr_b16 a[130:131], v22 offset:2048
v_mfma_f32_16x16x32_bf16 v[228:231], a[140:143], a[12:15], v[228:231]
buffer_store_dwordx4 v[192:195], v1, s[4:7], s31 offen sc1
v_mfma_f32_16x16x32_bf16 v[232:235], a[136:139], a[16:19], v[232:235]
s_add_u32 s31, s31, s32
ds_read_b64_tr_b16 a[132:133], v22 offset:16384
v_mfma_f32_16x16x32_bf16 v[232:235], a[140:143], a[20:23], v[232:235]
buffer_load_dwordx4 v17, s[12:15], s26 offen offset:1024 lds
v_mfma_f32_16x16x32_bf16 v[236:239], a[136:139], a[24:27], v[236:239]
ds_read_b64_tr_b16 a[134:135], v22 offset:18432
v_add_u32 v22, 4294901760, v22
v_mfma_f32_16x16x32_bf16 v[236:239], a[140:143], a[28:31], v[236:239]
v_mfma_f32_16x16x32_bf16 v[240:243], a[136:139], a[32:35], v[240:243]
v_mfma_f32_16x16x32_bf16 v[240:243], a[140:143], a[36:39], v[240:243]
buffer_load_dwordx4 v18, s[12:15], s26 offen offset:2048 lds
v_mfma_f32_16x16x32_bf16 v[244:247], a[136:139], a[40:43], v[244:247]
v_mfma_f32_16x16x32_bf16 v[244:247], a[140:143], a[44:47], v[244:247]
v_mfma_f32_16x16x32_bf16 v[248:251], a[136:139], a[48:51], v[248:251]
v_mfma_f32_16x16x32_bf16 v[248:251], a[140:143], a[52:55], v[248:251]
buffer_load_dwordx4 v19, s[12:15], s26 offen offset:3072 lds
v_mfma_f32_16x16x32_bf16 v[252:255], a[136:139], a[56:59], v[252:255]
s_add_u32 s26, s26, 524288
v_mfma_f32_16x16x32_bf16 v[252:255], a[140:143], a[60:63], v[252:255]
s_waitcnt lgkmcnt(0)
v_mfma_f32_16x16x32_bf16 v[36:39], a[128:131], a[64:67], v[36:39]
s_add_u32 m0, s29, 114688
ds_read_b64_tr_b16 a[136:137], v23 offset:0
v_mfma_f32_16x16x32_bf16 v[36:39], a[132:135], a[68:71], v[36:39]
buffer_load_dwordx4 v16, s[12:15], s27 offen offset:0 lds
v_mfma_f32_16x16x32_bf16 v[44:47], a[128:131], a[72:75], v[44:47]
ds_read_b64_tr_b16 a[138:139], v23 offset:2048
v_mfma_f32_16x16x32_bf16 v[44:47], a[132:135], a[76:79], v[44:47]
ds_read_b128 a[0:3], v2 offset:0
ds_read_b128 a[4:7], v3 offset:0
v_mfma_f32_16x16x32_bf16 v[52:55], a[128:131], a[80:83], v[52:55]
ds_read_b64_tr_b16 a[140:141], v23 offset:16384
v_mfma_f32_16x16x32_bf16 v[52:55], a[132:135], a[84:87], v[52:55]
buffer_load_dwordx4 v17, s[12:15], s27 offen offset:1024 lds
v_mfma_f32_16x16x32_bf16 v[60:63], a[128:131], a[88:91], v[60:63]
ds_read_b64_tr_b16 a[142:143], v23 offset:18432
v_add_u32 v23, 4294901760, v23
v_mfma_f32_16x16x32_bf16 v[60:63], a[132:135], a[92:95], v[60:63]
buffer_store_dwordx4 v[200:203], v1, s[4:7], s31 offen sc1
v_mfma_f32_16x16x32_bf16 v[68:71], a[128:131], a[96:99], v[68:71]
s_add_u32 s31, s31, s33
ds_read_b128 a[8:11], v2 offset:2048
v_mfma_f32_16x16x32_bf16 v[68:71], a[132:135], a[100:103], v[68:71]
buffer_load_dwordx4 v18, s[12:15], s27 offen offset:2048 lds
v_mfma_f32_16x16x32_bf16 v[76:79], a[128:131], a[104:107], v[76:79]
ds_read_b128 a[12:15], v3 offset:2048
v_mfma_f32_16x16x32_bf16 v[76:79], a[132:135], a[108:111], v[76:79]
ds_read_b128 a[16:19], v2 offset:4096
v_mfma_f32_16x16x32_bf16 v[84:87], a[128:131], a[112:115], v[84:87]
ds_read_b128 a[20:23], v3 offset:4096
v_mfma_f32_16x16x32_bf16 v[84:87], a[132:135], a[116:119], v[84:87]
buffer_load_dwordx4 v19, s[12:15], s27 offen offset:3072 lds
v_mfma_f32_16x16x32_bf16 v[92:95], a[128:131], a[120:123], v[92:95]
s_add_u32 s27, s27, 524288
ds_read_b128 a[24:27], v2 offset:6144
v_mfma_f32_16x16x32_bf16 v[92:95], a[132:135], a[124:127], v[92:95]
s_waitcnt lgkmcnt(5)
buffer_store_dwordx4 v[208:211], v1, s[4:7], s31 offen sc1
v_mfma_f32_16x16x32_bf16 v[100:103], a[136:139], a[64:67], v[100:103]
s_add_u32 s31, s31, s32
ds_read_b64_tr_b16 a[128:129], v24 offset:0
v_mfma_f32_16x16x32_bf16 v[100:103], a[140:143], a[68:71], v[100:103]
v_mfma_f32_16x16x32_bf16 v[108:111], a[136:139], a[72:75], v[108:111]
ds_read_b64_tr_b16 a[130:131], v24 offset:2048
v_mfma_f32_16x16x32_bf16 v[108:111], a[140:143], a[76:79], v[108:111]
ds_read_b128 a[28:31], v3 offset:6144
v_mfma_f32_16x16x32_bf16 v[116:119], a[136:139], a[80:83], v[116:119]
ds_read_b64_tr_b16 a[132:133], v24 offset:16384
v_mfma_f32_16x16x32_bf16 v[116:119], a[140:143], a[84:87], v[116:119]
v_mfma_f32_16x16x32_bf16 v[124:127], a[136:139], a[88:91], v[124:127]
ds_read_b64_tr_b16 a[134:135], v24 offset:18432
v_add_u32 v24, 4294901760, v24
v_mfma_f32_16x16x32_bf16 v[124:127], a[140:143], a[92:95], v[124:127]
v_mfma_f32_16x16x32_bf16 v[132:135], a[136:139], a[96:99], v[132:135]
ds_read_b128 a[32:35], v2 offset:8192
v_mfma_f32_16x16x32_bf16 v[132:135], a[140:143], a[100:103], v[132:135]
buffer_store_dwordx4 v[216:219], v1, s[4:7], s31 offen sc1
v_mfma_f32_16x16x32_bf16 v[140:143], a[136:139], a[104:107], v[140:143]
s_add_u32 s31, s31, s35
ds_read_b128 a[36:39], v3 offset:8192
v_mfma_f32_16x16x32_bf16 v[140:143], a[140:143], a[108:111], v[140:143]
ds_read_b128 a[40:43], v2 offset:10240
v_mfma_f32_16x16x32_bf16 v[148:151], a[136:139], a[112:115], v[148:151]
ds_read_b128 a[44:47], v3 offset:10240
v_mfma_f32_16x16x32_bf16 v[148:151], a[140:143], a[116:119], v[148:151]
v_mfma_f32_16x16x32_bf16 v[156:159], a[136:139], a[120:123], v[156:159]
ds_read_b128 a[48:51], v2 offset:12288
v_mfma_f32_16x16x32_bf16 v[156:159], a[140:143], a[124:127], v[156:159]
s_waitcnt lgkmcnt(5)
v_mfma_f32_16x16x32_bf16 v[164:167], a[128:131], a[64:67], v[164:167]
ds_read_b64_tr_b16 a[136:137], v25 offset:0
v_mfma_f32_16x16x32_bf16 v[164:167], a[132:135], a[68:71], v[164:167]
v_mfma_f32_16x16x32_bf16 v[172:175], a[128:131], a[72:75], v[172:175]
ds_read_b64_tr_b16 a[138:139], v25 offset:2048
v_mfma_f32_16x16x32_bf16 v[172:175], a[132:135], a[76:79], v[172:175]
ds_read_b128 a[52:55], v3 offset:12288
v_mfma_f32_16x16x32_bf16 v[180:183], a[128:131], a[80:83], v[180:183]
ds_read_b64_tr_b16 a[140:141], v25 offset:16384
v_mfma_f32_16x16x32_bf16 v[180:183], a[132:135], a[84:87], v[180:183]
buffer_store_dwordx4 v[32:35], v1, s[4:7], s31 offen sc1
v_mfma_f32_16x16x32_bf16 v[188:191], a[128:131], a[88:91], v[188:191]
s_add_u32 s31, s31, s32
ds_read_b64_tr_b16 a[142:143], v25 offset:18432
v_add_u32 v25, 4294901760, v25
v_mfma_f32_16x16x32_bf16 v[188:191], a[132:135], a[92:95], v[188:191]
v_mfma_f32_16x16x32_bf16 v[196:199], a[128:131], a[96:99], v[196:199]
ds_read_b128 a[56:59], v2 offset:14336
v_mfma_f32_16x16x32_bf16 v[196:199], a[132:135], a[100:103], v[196:199]
v_mfma_f32_16x16x32_bf16 v[204:207], a[128:131], a[104:107], v[204:207]
ds_read_b128 a[60:63], v3 offset:14336
v_mfma_f32_16x16x32_bf16 v[204:207], a[132:135], a[108:111], v[204:207]
v_mfma_f32_16x16x32_bf16 v[212:215], a[128:131], a[112:115], v[212:215]
v_mfma_f32_16x16x32_bf16 v[212:215], a[132:135], a[116:119], v[212:215]
v_mfma_f32_16x16x32_bf16 v[220:223], a[128:131], a[120:123], v[220:223]
v_mfma_f32_16x16x32_bf16 v[220:223], a[132:135], a[124:127], v[220:223]
s_waitcnt vmcnt(20) lgkmcnt(0)
s_barrier
v_mfma_f32_16x16x32_bf16 v[224:227], a[136:139], a[64:67], v[224:227]
s_add_u32 m0, s29, 131072
ds_read_b64_tr_b16 a[128:129], v22 offset:0
v_mfma_f32_16x16x32_bf16 v[224:227], a[140:143], a[68:71], v[224:227]
buffer_load_dwordx4 v16, s[12:15], s26 offen offset:0 lds
v_mfma_f32_16x16x32_bf16 v[228:231], a[136:139], a[72:75], v[228:231]
ds_read_b64_tr_b16 a[130:131], v22 offset:2048
v_mfma_f32_16x16x32_bf16 v[228:231], a[140:143], a[76:79], v[228:231]
buffer_store_dwordx4 v[40:43], v1, s[4:7], s31 offen sc1
v_mfma_f32_16x16x32_bf16 v[232:235], a[136:139], a[80:83], v[232:235]
s_add_u32 s31, s31, s33
ds_read_b64_tr_b16 a[132:133], v22 offset:16384
v_mfma_f32_16x16x32_bf16 v[232:235], a[140:143], a[84:87], v[232:235]
buffer_load_dwordx4 v17, s[12:15], s26 offen offset:1024 lds
v_mfma_f32_16x16x32_bf16 v[236:239], a[136:139], a[88:91], v[236:239]
ds_read_b64_tr_b16 a[134:135], v22 offset:18432
v_add_u32 v22, 32768, v22
v_mfma_f32_16x16x32_bf16 v[236:239], a[140:143], a[92:95], v[236:239]
v_mfma_f32_16x16x32_bf16 v[240:243], a[136:139], a[96:99], v[240:243]
v_mfma_f32_16x16x32_bf16 v[240:243], a[140:143], a[100:103], v[240:243]
buffer_load_dwordx4 v18, s[12:15], s26 offen offset:2048 lds
v_mfma_f32_16x16x32_bf16 v[244:247], a[136:139], a[104:107], v[244:247]
v_mfma_f32_16x16x32_bf16 v[244:247], a[140:143], a[108:111], v[244:247]
v_mfma_f32_16x16x32_bf16 v[248:251], a[136:139], a[112:115], v[248:251]
v_mfma_f32_16x16x32_bf16 v[248:251], a[140:143], a[116:119], v[248:251]
buffer_load_dwordx4 v19, s[12:15], s26 offen offset:3072 lds
v_mfma_f32_16x16x32_bf16 v[252:255], a[136:139], a[120:123], v[252:255]
s_add_u32 s26, s26, 524288
v_mfma_f32_16x16x32_bf16 v[252:255], a[140:143], a[124:127], v[252:255]
s_waitcnt lgkmcnt(0)
v_mfma_f32_16x16x32_bf16 v[36:39], a[128:131], a[0:3], v[36:39]
s_add_u32 m0, s29, 147456
ds_read_b64_tr_b16 a[136:137], v23 offset:0
v_mfma_f32_16x16x32_bf16 v[36:39], a[132:135], a[4:7], v[36:39]
buffer_load_dwordx4 v16, s[12:15], s27 offen offset:0 lds
v_mfma_f32_16x16x32_bf16 v[44:47], a[128:131], a[8:11], v[44:47]
s_lshl_b32 s22, s20, 7
ds_read_b64_tr_b16 a[138:139], v23 offset:2048
v_bfe_u32 v20, v1, 4, 3
v_mfma_f32_16x16x32_bf16 v[44:47], a[132:135], a[12:15], v[44:47]
s_add_u32 s70, s22, 94371840
ds_read_b128 a[64:67], v2 offset:16384
ds_read_b128 a[68:71], v3 offset:16384
v_mfma_f32_16x16x32_bf16 v[52:55], a[128:131], a[16:19], v[52:55]
s_lshr_b32 s22, s2, 4
ds_read_b64_tr_b16 a[140:141], v23 offset:16384
v_lshlrev_b32 v20, 3, v20
v_mfma_f32_16x16x32_bf16 v[52:55], a[132:135], a[20:23], v[52:55]
s_lshl_b32 s22, s22, 2
buffer_load_dwordx4 v17, s[12:15], s27 offen offset:1024 lds
v_mfma_f32_16x16x32_bf16 v[60:63], a[128:131], a[24:27], v[60:63]
s_add_u32 s66, s70, s22
ds_read_b64_tr_b16 a[142:143], v23 offset:18432
v_add_u32 v23, 32768, v23
v_mfma_f32_16x16x32_bf16 v[60:63], a[132:135], a[28:31], v[60:63]
s_and_b32 s22, s2, 16
buffer_store_dwordx4 v[48:51], v1, s[4:7], s31 offen sc1
v_mfma_f32_16x16x32_bf16 v[68:71], a[128:131], a[32:35], v[68:71]
s_add_u32 s31, s31, s32
ds_read_b128 a[72:75], v2 offset:18432
v_add_u32 v15, 2052, v20
v_mfma_f32_16x16x32_bf16 v[68:71], a[132:135], a[36:39], v[68:71]
s_lshl_b32 s22, s22, 7
buffer_load_dwordx4 v18, s[12:15], s27 offen offset:2048 lds
v_mfma_f32_16x16x32_bf16 v[76:79], a[128:131], a[40:43], v[76:79]
s_add_u32 s66, s66, s22
ds_read_b128 a[76:79], v3 offset:18432
v_mfma_f32_16x16x32_bf16 v[76:79], a[132:135], a[44:47], v[76:79]
s_lshl_b32 s67, s20, 20
ds_read_b128 a[80:83], v2 offset:20480
v_mfma_f32_16x16x32_bf16 v[84:87], a[128:131], a[48:51], v[84:87]
s_lshl_b32 s22, s37, 16
ds_read_b128 a[84:87], v3 offset:20480
v_mfma_f32_16x16x32_bf16 v[84:87], a[132:135], a[52:55], v[84:87]
s_add_u32 s67, s67, s22
buffer_load_dwordx4 v19, s[12:15], s27 offen offset:3072 lds
v_mfma_f32_16x16x32_bf16 v[92:95], a[128:131], a[56:59], v[92:95]
s_waitcnt lgkmcnt(5)
s_add_u32 s27, s27, 524288
ds_read_b128 a[88:91], v2 offset:22528
v_mfma_f32_16x16x32_bf16 v[92:95], a[132:135], a[60:63], v[92:95]
s_lshl_b32 s22, s3, 11
buffer_store_dwordx4 v[56:59], v1, s[4:7], s31 offen sc1
v_mfma_f32_16x16x32_bf16 v[100:103], a[136:139], a[0:3], v[100:103]
s_waitcnt lgkmcnt(5)
s_add_u32 s31, s31, s34
ds_read_b64_tr_b16 a[128:129], v24 offset:0
v_mfma_f32_16x16x32_bf16 v[100:103], a[140:143], a[4:7], v[100:103]
s_add_u32 s67, s67, s22
v_mfma_f32_16x16x32_bf16 v[108:111], a[136:139], a[8:11], v[108:111]
s_add_u32 s67, s67, 33554432
ds_read_b64_tr_b16 a[130:131], v24 offset:2048
v_mfma_f32_16x16x32_bf16 v[108:111], a[140:143], a[12:15], v[108:111]
s_mov_b32 s68, 1035512379
ds_read_b128 a[92:95], v3 offset:22528
v_mfma_f32_16x16x32_bf16 v[116:119], a[136:139], a[16:19], v[116:119]
s_mov_b32 s69, 1035512379
ds_read_b64_tr_b16 a[132:133], v24 offset:16384
v_mfma_f32_16x16x32_bf16 v[116:119], a[140:143], a[20:23], v[116:119]
buffer_store_dwordx4 v[64:67], v1, s[4:7], s31 offen sc1
v_mfma_f32_16x16x32_bf16 v[124:127], a[136:139], a[24:27], v[124:127]
s_add_u32 s31, s31, s32
ds_read_b64_tr_b16 a[134:135], v24 offset:18432
v_add_u32 v24, 32768, v24
v_mfma_f32_16x16x32_bf16 v[124:127], a[140:143], a[28:31], v[124:127]
v_mfma_f32_16x16x32_bf16 v[132:135], a[136:139], a[32:35], v[132:135]
ds_read_b128 a[96:99], v2 offset:24576
v_mfma_f32_16x16x32_bf16 v[132:135], a[140:143], a[36:39], v[132:135]
v_mfma_f32_16x16x32_bf16 v[140:143], a[136:139], a[40:43], v[140:143]
ds_read_b128 a[100:103], v3 offset:24576
v_mfma_f32_16x16x32_bf16 v[140:143], a[140:143], a[44:47], v[140:143]
ds_read_b128 a[104:107], v2 offset:26624
v_mfma_f32_16x16x32_bf16 v[148:151], a[136:139], a[48:51], v[148:151]
ds_read_b128 a[108:111], v3 offset:26624
v_mfma_f32_16x16x32_bf16 v[148:151], a[140:143], a[52:55], v[148:151]
v_mfma_f32_16x16x32_bf16 v[156:159], a[136:139], a[56:59], v[156:159]
ds_read_b128 a[112:115], v2 offset:28672
v_mfma_f32_16x16x32_bf16 v[156:159], a[140:143], a[60:63], v[156:159]
s_waitcnt lgkmcnt(5)
buffer_store_dwordx4 v[72:75], v1, s[4:7], s31 offen sc1
v_mfma_f32_16x16x32_bf16 v[164:167], a[128:131], a[0:3], v[164:167]
s_add_u32 s31, s31, s33
ds_read_b64_tr_b16 a[136:137], v25 offset:0
v_mfma_f32_16x16x32_bf16 v[164:167], a[132:135], a[4:7], v[164:167]
v_mfma_f32_16x16x32_bf16 v[172:175], a[128:131], a[8:11], v[172:175]
ds_read_b64_tr_b16 a[138:139], v25 offset:2048
v_mfma_f32_16x16x32_bf16 v[172:175], a[132:135], a[12:15], v[172:175]
ds_read_b128 a[116:119], v3 offset:28672
v_mfma_f32_16x16x32_bf16 v[180:183], a[128:131], a[16:19], v[180:183]
ds_read_b64_tr_b16 a[140:141], v25 offset:16384
v_mfma_f32_16x16x32_bf16 v[180:183], a[132:135], a[20:23], v[180:183]
v_mfma_f32_16x16x32_bf16 v[188:191], a[128:131], a[24:27], v[188:191]
ds_read_b64_tr_b16 a[142:143], v25 offset:18432
v_add_u32 v25, 32768, v25
v_mfma_f32_16x16x32_bf16 v[188:191], a[132:135], a[28:31], v[188:191]
v_mfma_f32_16x16x32_bf16 v[196:199], a[128:131], a[32:35], v[196:199]
ds_read_b128 a[120:123], v2 offset:30720
v_mfma_f32_16x16x32_bf16 v[196:199], a[132:135], a[36:39], v[196:199]
buffer_store_dwordx4 v[80:83], v1, s[4:7], s31 offen sc1
v_mfma_f32_16x16x32_bf16 v[204:207], a[128:131], a[40:43], v[204:207]
s_add_u32 s31, s31, s32
ds_read_b128 a[124:127], v3 offset:30720
v_mfma_f32_16x16x32_bf16 v[204:207], a[132:135], a[44:47], v[204:207]
v_mfma_f32_16x16x32_bf16 v[212:215], a[128:131], a[48:51], v[212:215]
v_mfma_f32_16x16x32_bf16 v[212:215], a[132:135], a[52:55], v[212:215]
v_mfma_f32_16x16x32_bf16 v[220:223], a[128:131], a[56:59], v[220:223]
v_mfma_f32_16x16x32_bf16 v[220:223], a[132:135], a[60:63], v[220:223]
s_waitcnt vmcnt(17) lgkmcnt(0)
s_barrier
v_mfma_f32_16x16x32_bf16 v[224:227], a[136:139], a[0:3], v[224:227]
ds_read_b64_tr_b16 a[128:129], v22 offset:0
v_mfma_f32_16x16x32_bf16 v[224:227], a[140:143], a[4:7], v[224:227]
v_mfma_f32_16x16x32_bf16 v[228:231], a[136:139], a[8:11], v[228:231]
ds_read_b64_tr_b16 a[130:131], v22 offset:2048
v_mfma_f32_16x16x32_bf16 v[228:231], a[140:143], a[12:15], v[228:231]
buffer_store_dwordx4 v[88:91], v1, s[4:7], s31 offen sc1
v_mfma_f32_16x16x32_bf16 v[232:235], a[136:139], a[16:19], v[232:235]
ds_read_b64_tr_b16 a[132:133], v22 offset:16384
v_mfma_f32_16x16x32_bf16 v[232:235], a[140:143], a[20:23], v[232:235]
v_mfma_f32_16x16x32_bf16 v[236:239], a[136:139], a[24:27], v[236:239]
ds_read_b64_tr_b16 a[134:135], v22 offset:18432
v_add_u32 v22, 32768, v22
v_mfma_f32_16x16x32_bf16 v[236:239], a[140:143], a[28:31], v[236:239]
v_mfma_f32_16x16x32_bf16 v[240:243], a[136:139], a[32:35], v[240:243]
v_mfma_f32_16x16x32_bf16 v[240:243], a[140:143], a[36:39], v[240:243]
v_mfma_f32_16x16x32_bf16 v[244:247], a[136:139], a[40:43], v[244:247]
v_mfma_f32_16x16x32_bf16 v[244:247], a[140:143], a[44:47], v[244:247]
v_mfma_f32_16x16x32_bf16 v[248:251], a[136:139], a[48:51], v[248:251]
v_mfma_f32_16x16x32_bf16 v[248:251], a[140:143], a[52:55], v[248:251]
v_mfma_f32_16x16x32_bf16 v[252:255], a[136:139], a[56:59], v[252:255]
v_mfma_f32_16x16x32_bf16 v[252:255], a[140:143], a[60:63], v[252:255]
s_waitcnt lgkmcnt(0)
v_mfma_f32_16x16x32_bf16 v[36:39], a[128:131], a[64:67], v[36:39]
ds_read_b64_tr_b16 a[136:137], v23 offset:0
v_and_b32 v14, 128, v1
v_mfma_f32_16x16x32_bf16 v[36:39], a[132:135], a[68:71], v[36:39]
v_mul_u32_u24 v14, 2, v14
v_add_u32 v20, v14, v20
v_mfma_f32_16x16x32_bf16 v[44:47], a[128:131], a[72:75], v[44:47]
s_mul_i32 s85, s20, 7
ds_read_b64_tr_b16 a[138:139], v23 offset:2048
v_add_u32 v15, v14, v15
v_mfma_f32_16x16x32_bf16 v[44:47], a[132:135], a[76:79], v[44:47]
s_add_u32 s85, s85, s21
ds_read_b128 a[0:3], v2 offset:32768
ds_read_b128 a[4:7], v3 offset:32768
v_mfma_f32_16x16x32_bf16 v[52:55], a[128:131], a[80:83], v[52:55]
s_lshl_b32 s85, s85, 2
ds_read_b64_tr_b16 a[140:141], v23 offset:16384
v_mfma_f32_16x16x32_bf16 v[52:55], a[132:135], a[84:87], v[52:55]
s_add_u32 s85, s85, s3
v_mfma_f32_16x16x32_bf16 v[60:63], a[128:131], a[88:91], v[60:63]
s_mul_i32 s82, s85, 4224
ds_read_b64_tr_b16 a[142:143], v23 offset:18432
v_add_u32 v23, 32768, v23
v_mfma_f32_16x16x32_bf16 v[60:63], a[132:135], a[92:95], v[60:63]
s_add_u32 s82, s82, 83886208
v_mfma_f32_16x16x32_bf16 v[68:71], a[128:131], a[96:99], v[68:71]
s_lshl_b32 s83, s85, 12
ds_read_b128 a[8:11], v2 offset:34816
v_mfma_f32_16x16x32_bf16 v[68:71], a[132:135], a[100:103], v[68:71]
s_mul_i32 s84, s3, 21248
v_mfma_f32_16x16x32_bf16 v[76:79], a[128:131], a[104:107], v[76:79]
s_add_u32 s84, s84, 46080
ds_read_b128 a[12:15], v3 offset:34816
v_mfma_f32_16x16x32_bf16 v[76:79], a[132:135], a[108:111], v[76:79]
s_mov_b64 s[60:61], s[72:73]
ds_read_b128 a[16:19], v2 offset:36864
v_mfma_f32_16x16x32_bf16 v[84:87], a[128:131], a[112:115], v[84:87]
s_mov_b32 s62, 1835008
ds_read_b128 a[20:23], v3 offset:36864
v_mfma_f32_16x16x32_bf16 v[84:87], a[132:135], a[116:119], v[84:87]
v_mfma_f32_16x16x32_bf16 v[92:95], a[128:131], a[120:123], v[92:95]
ds_read_b128 a[24:27], v2 offset:38912
v_mfma_f32_16x16x32_bf16 v[92:95], a[132:135], a[124:127], v[92:95]
s_waitcnt lgkmcnt(5)
v_mfma_f32_16x16x32_bf16 v[100:103], a[136:139], a[64:67], v[100:103]
ds_read_b64_tr_b16 a[128:129], v24 offset:0
v_mfma_f32_16x16x32_bf16 v[100:103], a[140:143], a[68:71], v[100:103]
v_mfma_f32_16x16x32_bf16 v[108:111], a[136:139], a[72:75], v[108:111]
ds_read_b64_tr_b16 a[130:131], v24 offset:2048
v_mfma_f32_16x16x32_bf16 v[108:111], a[140:143], a[76:79], v[108:111]
ds_read_b128 a[28:31], v3 offset:38912
v_mfma_f32_16x16x32_bf16 v[116:119], a[136:139], a[80:83], v[116:119]
ds_read_b64_tr_b16 a[132:133], v24 offset:16384
v_mfma_f32_16x16x32_bf16 v[116:119], a[140:143], a[84:87], v[116:119]
v_mfma_f32_16x16x32_bf16 v[124:127], a[136:139], a[88:91], v[124:127]
ds_read_b64_tr_b16 a[134:135], v24 offset:18432
v_add_u32 v24, 32768, v24
v_mfma_f32_16x16x32_bf16 v[124:127], a[140:143], a[92:95], v[124:127]
v_mfma_f32_16x16x32_bf16 v[132:135], a[136:139], a[96:99], v[132:135]
ds_read_b128 a[32:35], v2 offset:40960
v_mfma_f32_16x16x32_bf16 v[132:135], a[140:143], a[100:103], v[132:135]
v_mfma_f32_16x16x32_bf16 v[140:143], a[136:139], a[104:107], v[140:143]
ds_read_b128 a[36:39], v3 offset:40960
v_mfma_f32_16x16x32_bf16 v[140:143], a[140:143], a[108:111], v[140:143]
ds_read_b128 a[40:43], v2 offset:43008
v_mfma_f32_16x16x32_bf16 v[148:151], a[136:139], a[112:115], v[148:151]
ds_read_b128 a[44:47], v3 offset:43008
v_mfma_f32_16x16x32_bf16 v[148:151], a[140:143], a[116:119], v[148:151]
v_mfma_f32_16x16x32_bf16 v[156:159], a[136:139], a[120:123], v[156:159]
s_andn2_b32 s31, s70, 256
ds_read_b128 a[48:51], v2 offset:45056
v_mfma_f32_16x16x32_bf16 v[156:159], a[140:143], a[124:127], v[156:159]
s_waitcnt lgkmcnt(5)
v_mfma_f32_16x16x32_bf16 v[164:167], a[128:131], a[64:67], v[164:167]
ds_read_b64_tr_b16 a[136:137], v25 offset:0
v_mfma_f32_16x16x32_bf16 v[164:167], a[132:135], a[68:71], v[164:167]
v_mfma_f32_16x16x32_bf16 v[172:175], a[128:131], a[72:75], v[172:175]
ds_read_b64_tr_b16 a[138:139], v25 offset:2048
v_mfma_f32_16x16x32_bf16 v[172:175], a[132:135], a[76:79], v[172:175]
ds_read_b128 a[52:55], v3 offset:45056
v_mfma_f32_16x16x32_bf16 v[180:183], a[128:131], a[80:83], v[180:183]
ds_read_b64_tr_b16 a[140:141], v25 offset:16384
v_mfma_f32_16x16x32_bf16 v[180:183], a[132:135], a[84:87], v[180:183]
PAD_29:
s_cbranch_execz M_tret
v_mfma_f32_16x16x32_bf16 v[188:191], a[128:131], a[88:91], v[188:191]
ds_read_b64_tr_b16 a[142:143], v25 offset:18432
v_add_u32 v25, 32768, v25
v_mfma_f32_16x16x32_bf16 v[188:191], a[132:135], a[92:95], v[188:191]
v_mfma_f32_16x16x32_bf16 v[196:199], a[128:131], a[96:99], v[196:199]
ds_read_b128 a[56:59], v2 offset:47104
v_mfma_f32_16x16x32_bf16 v[196:199], a[132:135], a[100:103], v[196:199]
v_mfma_f32_16x16x32_bf16 v[204:207], a[128:131], a[104:107], v[204:207]
ds_read_b128 a[60:63], v3 offset:47104
v_mfma_f32_16x16x32_bf16 v[204:207], a[132:135], a[108:111], v[204:207]
v_mfma_f32_16x16x32_bf16 v[212:215], a[128:131], a[112:115], v[212:215]
v_mfma_f32_16x16x32_bf16 v[212:215], a[132:135], a[116:119], v[212:215]
v_mfma_f32_16x16x32_bf16 v[220:223], a[128:131], a[120:123], v[220:223]
v_mfma_f32_16x16x32_bf16 v[220:223], a[132:135], a[124:127], v[220:223]
s_waitcnt vmcnt(0) lgkmcnt(0)
s_barrier
v_mfma_f32_16x16x32_bf16 v[224:227], a[136:139], a[64:67], v[224:227]
ds_read_b64_tr_b16 a[128:129], v22 offset:0
v_mfma_f32_16x16x32_bf16 v[224:227], a[140:143], a[68:71], v[224:227]
buffer_store_dword v27, v26, s[4:7], s66 offen sc1
v_mfma_f32_16x16x32_bf16 v[228:231], a[136:139], a[72:75], v[228:231]
ds_read_b64_tr_b16 a[130:131], v22 offset:2048
v_mfma_f32_16x16x32_bf16 v[228:231], a[140:143], a[76:79], v[228:231]
v_mfma_f32_16x16x32_bf16 v[232:235], a[136:139], a[80:83], v[232:235]
ds_read_b64_tr_b16 a[132:133], v22 offset:16384
v_mfma_f32_16x16x32_bf16 v[232:235], a[140:143], a[84:87], v[232:235]
v_mfma_f32_16x16x32_bf16 v[236:239], a[136:139], a[88:91], v[236:239]
ds_read_b64_tr_b16 a[134:135], v22 offset:18432
v_mfma_f32_16x16x32_bf16 v[236:239], a[140:143], a[92:95], v[236:239]
v_mfma_f32_16x16x32_bf16 v[240:243], a[136:139], a[96:99], v[240:243]
v_mfma_f32_16x16x32_bf16 v[240:243], a[140:143], a[100:103], v[240:243]
v_mfma_f32_16x16x32_bf16 v[244:247], a[136:139], a[104:107], v[244:247]
v_mfma_f32_16x16x32_bf16 v[244:247], a[140:143], a[108:111], v[244:247]
v_mfma_f32_16x16x32_bf16 v[248:251], a[136:139], a[112:115], v[248:251]
v_mfma_f32_16x16x32_bf16 v[248:251], a[140:143], a[116:119], v[248:251]
v_mfma_f32_16x16x32_bf16 v[252:255], a[136:139], a[120:123], v[252:255]
v_mfma_f32_16x16x32_bf16 v[252:255], a[140:143], a[124:127], v[252:255]
s_waitcnt lgkmcnt(0)
v_mfma_f32_16x16x32_bf16 v[36:39], a[128:131], a[0:3], v[36:39]
s_add_u32 m0, s84, 17152
ds_read_b64_tr_b16 a[136:137], v23 offset:0
v_lshrrev_b32 v9, 4, v1
v_mfma_f32_16x16x32_bf16 v[36:39], a[132:135], a[4:7], v[36:39]
buffer_load_dwordx4 v1, s[60:63], s83 offen offset:0 lds
v_mfma_f32_16x16x32_bf16 v[44:47], a[128:131], a[8:11], v[44:47]
ds_read_b64_tr_b16 a[138:139], v23 offset:2048
v_and_b32 v10, 15, v9
v_mfma_f32_16x16x32_bf16 v[44:47], a[132:135], a[12:15], v[44:47]
buffer_load_dwordx4 v1, s[60:63], s83 offen offset:1024 lds
v_mfma_f32_16x16x32_bf16 v[52:55], a[128:131], a[16:19], v[52:55]
ds_read_b64_tr_b16 a[140:141], v23 offset:16384
v_lshrrev_b32 v11, 4, v9
v_mfma_f32_16x16x32_bf16 v[52:55], a[132:135], a[20:23], v[52:55]
buffer_load_dwordx4 v1, s[60:63], s83 offen offset:2048 lds
v_mfma_f32_16x16x32_bf16 v[60:63], a[128:131], a[24:27], v[60:63]
ds_read_b64_tr_b16 a[142:143], v23 offset:18432
v_lshrrev_b32 v12, 2, v10
v_mfma_f32_16x16x32_bf16 v[60:63], a[132:135], a[28:31], v[60:63]
buffer_load_dwordx4 v1, s[60:63], s83 offen offset:3072 lds
v_mfma_f32_16x16x32_bf16 v[68:71], a[128:131], a[32:35], v[68:71]
s_add_u32 m0, s84, 64
v_mul_u32_u24 v12, 4160, v12
v_and_b32 v13, 3, v9
v_mfma_f32_16x16x32_bf16 v[68:71], a[132:135], a[36:39], v[68:71]
buffer_load_dwordx4 v1, s[4:7], s82 offen offset:0 sc1 lds
v_mfma_f32_16x16x32_bf16 v[76:79], a[128:131], a[40:43], v[76:79]
buffer_load_dwordx4 v1, s[4:7], s82 offen offset:1024 sc1 lds
v_mfma_f32_16x16x32_bf16 v[76:79], a[132:135], a[44:47], v[76:79]
buffer_load_dwordx4 v1, s[4:7], s82 offen offset:2048 sc1 lds
v_mfma_f32_16x16x32_bf16 v[84:87], a[128:131], a[48:51], v[84:87]
buffer_load_dwordx4 v1, s[4:7], s82 offen offset:3072 sc1 lds
v_mfma_f32_16x16x32_bf16 v[84:87], a[132:135], a[52:55], v[84:87]
s_add_u32 s82, s82, 2097152
v_lshl_add_u32 v12, v13, 3, v12
v_lshlrev_b32 v13, 4, v11
v_mfma_f32_16x16x32_bf16 v[92:95], a[128:131], a[56:59], v[92:95]
s_add_u32 m0, s84, 4224
v_sub_u32 v12, v12, v13
v_add_u32 v12, 88, v12
v_mfma_f32_16x16x32_bf16 v[92:95], a[132:135], a[60:63], v[92:95]
s_waitcnt lgkmcnt(0)
buffer_load_dwordx4 v1, s[4:7], s82 offen offset:0 sc1 lds
v_mfma_f32_16x16x32_bf16 v[100:103], a[136:139], a[0:3], v[100:103]
ds_read_b64_tr_b16 a[128:129], v24 offset:0
v_add_u32 v16, s84, v12
v_mfma_f32_16x16x32_bf16 v[100:103], a[140:143], a[4:7], v[100:103]
buffer_load_dwordx4 v1, s[4:7], s82 offen offset:1024 sc1 lds
v_mfma_f32_16x16x32_bf16 v[108:111], a[136:139], a[8:11], v[108:111]
ds_read_b64_tr_b16 a[130:131], v24 offset:2048
v_lshl_add_u32 v12, v10, 5, v13
v_mfma_f32_16x16x32_bf16 v[108:111], a[140:143], a[12:15], v[108:111]
buffer_load_dwordx4 v1, s[4:7], s82 offen offset:2048 sc1 lds
v_mfma_f32_16x16x32_bf16 v[116:119], a[136:139], a[16:19], v[116:119]
ds_read_b64_tr_b16 a[132:133], v24 offset:16384
v_add_u32 v12, 16672, v12
v_mfma_f32_16x16x32_bf16 v[116:119], a[140:143], a[20:23], v[116:119]
buffer_load_dwordx4 v1, s[4:7], s82 offen offset:3072 sc1 lds
v_mfma_f32_16x16x32_bf16 v[124:127], a[136:139], a[24:27], v[124:127]
s_add_u32 s82, s82, 4292870140
ds_read_b64_tr_b16 a[134:135], v24 offset:18432
v_add_u32 v17, s84, v12
v_mfma_f32_16x16x32_bf16 v[124:127], a[140:143], a[28:31], v[124:127]
s_add_u32 m0, s84, 8384
v_lshlrev_b32 v12, 5, v10
v_lshl_add_u32 v8, v11, 3, v12
v_mfma_f32_16x16x32_bf16 v[132:135], a[136:139], a[32:35], v[132:135]
buffer_load_dwordx4 v1, s[4:7], s82 offen offset:0 sc1 lds
v_mfma_f32_16x16x32_bf16 v[132:135], a[140:143], a[36:39], v[132:135]
buffer_load_dwordx4 v1, s[4:7], s82 offen offset:1024 sc1 lds
v_mfma_f32_16x16x32_bf16 v[140:143], a[136:139], a[40:43], v[140:143]
buffer_load_dwordx4 v1, s[4:7], s82 offen offset:2048 sc1 lds
v_mfma_f32_16x16x32_bf16 v[140:143], a[140:143], a[44:47], v[140:143]
buffer_load_dwordx4 v1, s[4:7], s82 offen offset:3072 sc1 lds
v_mfma_f32_16x16x32_bf16 v[148:151], a[136:139], a[48:51], v[148:151]
s_add_u32 s82, s82, 2097152
v_add3_u32 v18, s84, 64, v8
v_mov_b32 v19, 0
v_mfma_f32_16x16x32_bf16 v[148:151], a[140:143], a[52:55], v[148:151]
s_add_u32 m0, s84, 12544
v_mov_b32 v12, 0
v_mov_b32 v13, 0
v_mfma_f32_16x16x32_bf16 v[156:159], a[136:139], a[56:59], v[156:159]
buffer_load_dwordx4 v1, s[4:7], s82 offen offset:0 sc1 lds
v_mfma_f32_16x16x32_bf16 v[156:159], a[140:143], a[60:63], v[156:159]
s_waitcnt lgkmcnt(0)
buffer_load_dwordx4 v1, s[4:7], s82 offen offset:1024 sc1 lds
v_mfma_f32_16x16x32_bf16 v[164:167], a[128:131], a[0:3], v[164:167]
ds_read_b64_tr_b16 a[136:137], v25 offset:0
v_lshl_add_u32 v14, v9, 3, s84
v_mfma_f32_16x16x32_bf16 v[164:167], a[132:135], a[4:7], v[164:167]
buffer_load_dwordx4 v1, s[4:7], s82 offen offset:2048 sc1 lds
v_mfma_f32_16x16x32_bf16 v[172:175], a[128:131], a[8:11], v[172:175]
ds_read_b64_tr_b16 a[138:139], v25 offset:2048
v_mfma_f32_16x16x32_bf16 v[172:175], a[132:135], a[12:15], v[172:175]
buffer_load_dwordx4 v1, s[4:7], s82 offen offset:3072 sc1 lds
v_mfma_f32_16x16x32_bf16 v[180:183], a[128:131], a[16:19], v[180:183]
ds_read_b64_tr_b16 a[140:141], v25 offset:16384
v_mfma_f32_16x16x32_bf16 v[180:183], a[132:135], a[20:23], v[180:183]
ds_write_b64 v14, v[12:13] offset:16640
v_mul_u32_u24 v14, 4160, v11
v_mfma_f32_16x16x32_bf16 v[188:191], a[128:131], a[24:27], v[188:191]
ds_read_b64_tr_b16 a[142:143], v25 offset:18432
v_lshl_add_u32 v14, v10, 2, v14
v_mfma_f32_16x16x32_bf16 v[188:191], a[132:135], a[28:31], v[188:191]
v_add_u32 v14, s84, v14
v_mfma_f32_16x16x32_bf16 v[196:199], a[128:131], a[32:35], v[196:199]
ds_write_b32 v14, v12
v_lshrrev_b32 v30, 6, v0
v_mfma_f32_16x16x32_bf16 v[196:199], a[132:135], a[36:39], v[196:199]
v_lshl_add_u32 v28, v30, 11, v1
v_add_u32 v29, 0x20000, v28
v_mfma_f32_16x16x32_bf16 v[204:207], a[128:131], a[40:43], v[204:207]
v_lshl_add_u32 v30, v30, 13, v1
v_add_u32 v31, 0x20000, v30
v_mfma_f32_16x16x32_bf16 v[204:207], a[132:135], a[44:47], v[204:207]
v_mul_f32 v36, s68, v36
v_mul_f32 v37, s68, v37
v_mfma_f32_16x16x32_bf16 v[212:215], a[128:131], a[48:51], v[212:215]
v_mul_f32 v38, s68, v38
v_mul_f32 v39, s68, v39
v_mfma_f32_16x16x32_bf16 v[212:215], a[132:135], a[52:55], v[212:215]
v_mul_f32 v100, s68, v100
v_mul_f32 v101, s68, v101
v_mfma_f32_16x16x32_bf16 v[220:223], a[128:131], a[56:59], v[220:223]
v_mul_f32 v102, s68, v102
v_mul_f32 v103, s68, v103
v_mfma_f32_16x16x32_bf16 v[220:223], a[132:135], a[60:63], v[220:223]
s_waitcnt lgkmcnt(0)
s_waitcnt lgkmcnt(0)
s_barrier
v_mfma_f32_16x16x32_bf16 v[224:227], a[136:139], a[0:3], v[224:227]
v_cvt_pk_bf16_f32 v36, v36, v37
v_cvt_pk_bf16_f32 v37, v38, v39
v_mfma_f32_16x16x32_bf16 v[224:227], a[140:143], a[4:7], v[224:227]
v_cvt_pk_bf16_f32 v38, v100, v101
v_cvt_pk_bf16_f32 v39, v102, v103
v_mfma_f32_16x16x32_bf16 v[228:231], a[136:139], a[8:11], v[228:231]
v_mul_f32 v44, s68, v44
v_mul_f32 v45, s68, v45
v_mfma_f32_16x16x32_bf16 v[228:231], a[140:143], a[12:15], v[228:231]
v_mul_f32 v46, s68, v46
v_mul_f32 v47, s68, v47
v_mfma_f32_16x16x32_bf16 v[232:235], a[136:139], a[16:19], v[232:235]
v_mul_f32 v108, s68, v108
v_mul_f32 v109, s68, v109
v_mfma_f32_16x16x32_bf16 v[232:235], a[140:143], a[20:23], v[232:235]
v_mul_f32 v110, s68, v110
v_mul_f32 v111, s68, v111
v_mfma_f32_16x16x32_bf16 v[236:239], a[136:139], a[24:27], v[236:239]
v_cvt_pk_bf16_f32 v44, v44, v45
v_cvt_pk_bf16_f32 v45, v46, v47
v_mfma_f32_16x16x32_bf16 v[236:239], a[140:143], a[28:31], v[236:239]
v_cvt_pk_bf16_f32 v46, v108, v109
v_cvt_pk_bf16_f32 v47, v110, v111
v_mfma_f32_16x16x32_bf16 v[240:243], a[136:139], a[32:35], v[240:243]
v_mul_f32 v52, s68, v52
v_mul_f32 v53, s68, v53
v_mfma_f32_16x16x32_bf16 v[240:243], a[140:143], a[36:39], v[240:243]
v_mul_f32 v54, s68, v54
v_mul_f32 v55, s68, v55
v_mfma_f32_16x16x32_bf16 v[244:247], a[136:139], a[40:43], v[244:247]
v_mul_f32 v116, s68, v116
v_mul_f32 v117, s68, v117
v_mfma_f32_16x16x32_bf16 v[244:247], a[140:143], a[44:47], v[244:247]
v_mul_f32 v118, s68, v118
v_mul_f32 v119, s68, v119
v_mfma_f32_16x16x32_bf16 v[248:251], a[136:139], a[48:51], v[248:251]
v_cvt_pk_bf16_f32 v52, v52, v53
v_cvt_pk_bf16_f32 v53, v54, v55
v_mfma_f32_16x16x32_bf16 v[248:251], a[140:143], a[52:55], v[248:251]
v_cvt_pk_bf16_f32 v54, v116, v117
v_cvt_pk_bf16_f32 v55, v118, v119
v_mfma_f32_16x16x32_bf16 v[252:255], a[136:139], a[56:59], v[252:255]
v_mfma_f32_16x16x32_bf16 v[252:255], a[140:143], a[60:63], v[252:255]
s_mov_b64 s[60:61], s[74:75]
s_mov_b32 s62, 896
s_lshl_b32 s79, s85, 1
buffer_load_short_d16_hi v19, off, s[60:63], s79
s_lshl_b32 s83, s85, 12
s_add_u32 s83, s83, 88080384
ds_write_b128 v28, v[36:39] offset:0
ds_write_b128 v28, v[44:47] offset:8192
ds_write_b128 v28, v[52:55] offset:16384
v_pk_mul_f32 v[60:61], v[60:61], s[68:69]
v_pk_mul_f32 v[62:63], v[62:63], s[68:69]
v_pk_mul_f32 v[124:125], v[124:125], s[68:69]
v_pk_mul_f32 v[126:127], v[126:127], s[68:69]
v_cvt_pk_bf16_f32 v60, v60, v61
v_cvt_pk_bf16_f32 v61, v62, v63
v_cvt_pk_bf16_f32 v62, v124, v125
v_cvt_pk_bf16_f32 v63, v126, v127
ds_write_b128 v28, v[60:63] offset:24576
v_pk_mul_f32 v[68:69], v[68:69], s[68:69]
v_pk_mul_f32 v[70:71], v[70:71], s[68:69]
v_pk_mul_f32 v[132:133], v[132:133], s[68:69]
v_pk_mul_f32 v[134:135], v[134:135], s[68:69]
v_cvt_pk_bf16_f32 v68, v68, v69
v_cvt_pk_bf16_f32 v69, v70, v71
v_cvt_pk_bf16_f32 v70, v132, v133
v_cvt_pk_bf16_f32 v71, v134, v135
ds_write_b128 v29, v[68:71] offset:0
v_pk_mul_f32 v[76:77], v[76:77], s[68:69]
v_pk_mul_f32 v[78:79], v[78:79], s[68:69]
v_pk_mul_f32 v[140:141], v[140:141], s[68:69]
v_pk_mul_f32 v[142:143], v[142:143], s[68:69]
v_cvt_pk_bf16_f32 v76, v76, v77
v_cvt_pk_bf16_f32 v77, v78, v79
v_cvt_pk_bf16_f32 v78, v140, v141
v_cvt_pk_bf16_f32 v79, v142, v143
ds_write_b128 v29, v[76:79] offset:8192
v_pk_mul_f32 v[84:85], v[84:85], s[68:69]
v_pk_mul_f32 v[86:87], v[86:87], s[68:69]
v_pk_mul_f32 v[148:149], v[148:149], s[68:69]
v_pk_mul_f32 v[150:151], v[150:151], s[68:69]
v_cvt_pk_bf16_f32 v84, v84, v85
v_cvt_pk_bf16_f32 v85, v86, v87
v_cvt_pk_bf16_f32 v86, v148, v149
v_cvt_pk_bf16_f32 v87, v150, v151
ds_write_b128 v29, v[84:87] offset:16384
v_pk_mul_f32 v[92:93], v[92:93], s[68:69]
v_pk_mul_f32 v[94:95], v[94:95], s[68:69]
v_pk_mul_f32 v[156:157], v[156:157], s[68:69]
v_pk_mul_f32 v[158:159], v[158:159], s[68:69]
v_cvt_pk_bf16_f32 v92, v92, v93
v_cvt_pk_bf16_f32 v93, v94, v95
v_cvt_pk_bf16_f32 v94, v156, v157
v_cvt_pk_bf16_f32 v95, v158, v159
ds_write_b128 v29, v[92:95] offset:24576
v_pk_mul_f32 v[164:165], v[164:165], s[68:69]
v_pk_mul_f32 v[166:167], v[166:167], s[68:69]
v_pk_mul_f32 v[224:225], v[224:225], s[68:69]
v_pk_mul_f32 v[226:227], v[226:227], s[68:69]
v_cvt_pk_bf16_f32 v164, v164, v165
v_cvt_pk_bf16_f32 v165, v166, v167
v_cvt_pk_bf16_f32 v166, v224, v225
v_cvt_pk_bf16_f32 v167, v226, v227
ds_write_b128 v28, v[164:167] offset:1024
v_pk_mul_f32 v[172:173], v[172:173], s[68:69]
v_pk_mul_f32 v[174:175], v[174:175], s[68:69]
v_pk_mul_f32 v[228:229], v[228:229], s[68:69]
v_pk_mul_f32 v[230:231], v[230:231], s[68:69]
v_cvt_pk_bf16_f32 v172, v172, v173
v_cvt_pk_bf16_f32 v173, v174, v175
v_cvt_pk_bf16_f32 v174, v228, v229
v_cvt_pk_bf16_f32 v175, v230, v231
ds_write_b128 v28, v[172:175] offset:9216
v_pk_mul_f32 v[180:181], v[180:181], s[68:69]
v_pk_mul_f32 v[182:183], v[182:183], s[68:69]
v_pk_mul_f32 v[232:233], v[232:233], s[68:69]
v_pk_mul_f32 v[234:235], v[234:235], s[68:69]
v_cvt_pk_bf16_f32 v180, v180, v181
v_cvt_pk_bf16_f32 v181, v182, v183
v_cvt_pk_bf16_f32 v182, v232, v233
v_cvt_pk_bf16_f32 v183, v234, v235
ds_write_b128 v28, v[180:183] offset:17408
v_pk_mul_f32 v[188:189], v[188:189], s[68:69]
v_pk_mul_f32 v[190:191], v[190:191], s[68:69]
v_pk_mul_f32 v[236:237], v[236:237], s[68:69]
v_pk_mul_f32 v[238:239], v[238:239], s[68:69]
v_cvt_pk_bf16_f32 v188, v188, v189
v_cvt_pk_bf16_f32 v189, v190, v191
v_cvt_pk_bf16_f32 v190, v236, v237
v_cvt_pk_bf16_f32 v191, v238, v239
ds_write_b128 v28, v[188:191] offset:25600
v_pk_mul_f32 v[196:197], v[196:197], s[68:69]
v_pk_mul_f32 v[198:199], v[198:199], s[68:69]
v_pk_mul_f32 v[240:241], v[240:241], s[68:69]
v_pk_mul_f32 v[242:243], v[242:243], s[68:69]
v_cvt_pk_bf16_f32 v196, v196, v197
v_cvt_pk_bf16_f32 v197, v198, v199
v_cvt_pk_bf16_f32 v198, v240, v241
v_cvt_pk_bf16_f32 v199, v242, v243
ds_write_b128 v29, v[196:199] offset:1024
v_pk_mul_f32 v[204:205], v[204:205], s[68:69]
v_pk_mul_f32 v[206:207], v[206:207], s[68:69]
v_pk_mul_f32 v[244:245], v[244:245], s[68:69]
v_pk_mul_f32 v[246:247], v[246:247], s[68:69]
v_cvt_pk_bf16_f32 v204, v204, v205
v_cvt_pk_bf16_f32 v205, v206, v207
v_cvt_pk_bf16_f32 v206, v244, v245
v_cvt_pk_bf16_f32 v207, v246, v247
ds_write_b128 v29, v[204:207] offset:9216
v_pk_mul_f32 v[212:213], v[212:213], s[68:69]
v_pk_mul_f32 v[214:215], v[214:215], s[68:69]
v_pk_mul_f32 v[248:249], v[248:249], s[68:69]
v_pk_mul_f32 v[250:251], v[250:251], s[68:69]
v_cvt_pk_bf16_f32 v212, v212, v213
v_cvt_pk_bf16_f32 v213, v214, v215
v_cvt_pk_bf16_f32 v214, v248, v249
v_cvt_pk_bf16_f32 v215, v250, v251
ds_write_b128 v29, v[212:215] offset:17408
v_pk_mul_f32 v[220:221], v[220:221], s[68:69]
v_pk_mul_f32 v[222:223], v[222:223], s[68:69]
v_pk_mul_f32 v[252:253], v[252:253], s[68:69]
v_pk_mul_f32 v[254:255], v[254:255], s[68:69]
v_cvt_pk_bf16_f32 v220, v220, v221
v_cvt_pk_bf16_f32 v221, v222, v223
v_cvt_pk_bf16_f32 v222, v252, v253
v_cvt_pk_bf16_f32 v223, v254, v255
ds_write_b128 v29, v[220:223] offset:25600
s_waitcnt vmcnt(1) lgkmcnt(0)
s_barrier
buffer_load_dword v21, v20, s[4:7], s31 offen sc1
ds_read_b64_tr_b16 a[64:65], v16 offset:8
ds_read_b64_tr_b16 a[66:67], v16 offset:0
ds_read_b128 a[96:99], v17 offset:448
ds_read_b64_tr_b16 a[68:69], v16 offset:520
ds_read_b64_tr_b16 a[70:71], v16 offset:512
ds_read_b128 a[100:103], v17 offset:960
ds_read_b64_tr_b16 a[72:73], v16 offset:1032
ds_read_b64_tr_b16 a[74:75], v16 offset:1024
ds_read_b128 a[104:107], v17 offset:1472
ds_read_b64_tr_b16 a[76:77], v16 offset:1544
ds_read_b64_tr_b16 a[78:79], v16 offset:1536
ds_read_b128 a[108:111], v17 offset:1984
ds_read_b64_tr_b16 a[80:81], v16 offset:2056
ds_read_b64_tr_b16 a[82:83], v16 offset:2048
ds_read_b128 a[112:115], v17 offset:2496
ds_read_b64_tr_b16 a[84:85], v16 offset:2568
ds_read_b64_tr_b16 a[86:87], v16 offset:2560
ds_read_b128 a[116:119], v17 offset:3008
ds_read_b64_tr_b16 a[88:89], v16 offset:3080
ds_read_b64_tr_b16 a[90:91], v16 offset:3072
ds_read_b128 a[120:123], v17 offset:3520
ds_read_b64_tr_b16 a[92:93], v16 offset:3592
ds_read_b64_tr_b16 a[94:95], v16 offset:3584
ds_read_b128 a[124:127], v17 offset:4032
s_waitcnt lgkmcnt(15)
v_mfma_f32_16x16x32_bf16 v[96:99], a[64:67], a[96:99], 0
s_waitcnt lgkmcnt(12)
s_lshl_b32 s18, s3, 13
ds_read_b64_tr_b16 a[128:129], v16 offset:72
v_mov_b32 v24, 0
v_mfma_f32_16x16x32_bf16 v[100:103], a[64:67], a[100:103], 0
s_lshl_b32 s30, s20, 20
ds_read_b64_tr_b16 a[130:131], v16 offset:64
v_lshrrev_b32 v3, 6, v0
v_mfma_f32_16x16x32_bf16 v[100:103], a[68:71], a[96:99], v[100:103]
s_add_u32 s30, s30, s18
ds_read_b128 a[160:163], v17 offset:384
v_and_b32 v4, 63, v0
v_mfma_f32_16x16x32_bf16 v[104:107], a[64:67], a[104:107], 0
s_lshl_b32 s22, s21, 1
ds_read_b128 a[192:195], v30 offset:0
v_add_u32 v2, 0x10000, v1
v_mfma_f32_16x16x32_bf16 v[104:107], a[68:71], a[100:103], v[104:107]
s_and_b32 s84, s2, 1
ds_read_b64_tr_b16 a[132:133], v16 offset:584
v_and_b32 v5, 15, v4
v_mfma_f32_16x16x32_bf16 v[104:107], a[72:75], a[96:99], v[104:107]
s_mul_i32 s84, s84, 0
ds_read_b64_tr_b16 a[134:135], v16 offset:576
v_lshrrev_b32 v6, 4, v4
v_mfma_f32_16x16x32_bf16 v[108:111], a[64:67], a[108:111], 0
s_add_u32 s84, s84, 2386092
ds_read_b128 a[164:167], v17 offset:896
v_lshlrev_b32 v6, 2, v6
v_mfma_f32_16x16x32_bf16 v[108:111], a[68:71], a[104:107], v[108:111]
s_lshl_b32 s85, s21, 2
ds_read_b128 a[196:199], v30 offset:1024
v_sub_u32 v5, v5, v6
v_mfma_f32_16x16x32_bf16 v[108:111], a[72:75], a[100:103], v[108:111]
s_lshr_b32 s85, s84, s85
ds_read_b64_tr_b16 a[136:137], v16 offset:1096
v_lshl_add_u32 v5, v3, 4, v5
v_mfma_f32_16x16x32_bf16 v[108:111], a[76:79], a[96:99], v[108:111]
s_waitcnt lgkmcnt(8)
s_and_b32 s9, s85, 15
ds_read_b64_tr_b16 a[138:139], v16 offset:1088
v_cmp_gt_i32 s[32:33], 0, v5
v_mfma_f32_16x16x32_bf16 v[112:115], a[64:67], a[112:115], 0
s_and_b32 s84, s85, 1
ds_read_b128 a[168:171], v17 offset:1408
v_cmp_gt_i32 s[34:35], 1, v5
v_mfma_f32_16x16x32_bf16 v[112:115], a[68:71], a[108:111], v[112:115]
s_lshl_b32 s84, s84, 17
ds_read_b128 a[200:203], v30 offset:2048
v_cmp_gt_i32 s[36:37], 2, v5
v_mfma_f32_16x16x32_bf16 v[112:115], a[72:75], a[104:107], v[112:115]
s_add_u32 s84, s84, s18
ds_read_b64_tr_b16 a[140:141], v16 offset:1608
v_cmp_gt_i32 s[38:39], 3, v5
v_mfma_f32_16x16x32_bf16 v[112:115], a[76:79], a[100:103], v[112:115]
s_xor_b32 s85, s84, 0x20000
ds_read_b64_tr_b16 a[142:143], v16 offset:1600
v_cmp_gt_i32 s[40:41], 16, v5
v_mfma_f32_16x16x32_bf16 v[112:115], a[80:83], a[96:99], v[112:115]
s_sub_u32 s29, 15, s21
ds_read_b128 a[172:175], v17 offset:1920
v_cmp_gt_i32 s[42:43], 17, v5
v_mfma_f32_16x16x32_bf16 v[116:119], a[64:67], a[116:119], 0
s_xor_b32 s8, s30, 2097152
ds_read_b128 a[204:207], v30 offset:3072
v_cmp_gt_i32 s[44:45], 18, v5
v_mfma_f32_16x16x32_bf16 v[116:119], a[68:71], a[112:115], v[116:119]
s_add_u32 s11, s22, 2
ds_read_b64_tr_b16 a[144:145], v16 offset:2120
v_cmp_gt_i32 s[46:47], 19, v5
v_mfma_f32_16x16x32_bf16 v[116:119], a[72:75], a[108:111], v[116:119]
s_add_u32 s14, s30, 16777216
ds_read_b64_tr_b16 a[146:147], v16 offset:2112
v_cmp_gt_i32 s[48:49], 32, v5
v_mfma_f32_16x16x32_bf16 v[116:119], a[76:79], a[104:107], v[116:119]
s_lshr_b32 s19, s9, 1
ds_read_b128 a[176:179], v17 offset:2432
v_cmp_gt_i32 s[50:51], 33, v5
v_mfma_f32_16x16x32_bf16 v[116:119], a[80:83], a[100:103], v[116:119]
s_cmp_lg_u32 s9, 0
ds_read_b128 a[208:211], v30 offset:4096
v_cmp_gt_i32 s[52:53], 34, v5
v_mfma_f32_16x16x32_bf16 v[116:119], a[84:87], a[96:99], v[116:119]
s_cselect_b32 s10, s30, 3221225472
ds_read_b64_tr_b16 a[148:149], v16 offset:2632
v_cmp_gt_i32 s[54:55], 35, v5
v_mfma_f32_16x16x32_bf16 v[120:123], a[64:67], a[120:123], 0
s_cselect_b32 s8, s8, s30
ds_read_b64_tr_b16 a[150:151], v16 offset:2624
v_cmp_gt_i32 s[56:57], 48, v5
v_mfma_f32_16x16x32_bf16 v[120:123], a[68:71], a[116:119], v[120:123]
s_cselect_b32 s14, s14, 3221225472
ds_read_b128 a[180:183], v17 offset:2944
v_cmp_gt_i32 s[58:59], 49, v5
v_mfma_f32_16x16x32_bf16 v[120:123], a[72:75], a[112:115], v[120:123]
s_cselect_b32 s9, s9, s11
ds_read_b128 a[212:215], v30 offset:5120
v_cmp_gt_i32 s[60:61], 50, v5
v_mfma_f32_16x16x32_bf16 v[120:123], a[76:79], a[108:111], v[120:123]
s_cselect_b32 s19, s19, s21
ds_read_b64_tr_b16 a[152:153], v16 offset:3144
v_cmp_gt_i32 s[62:63], 51, v5
v_mfma_f32_16x16x32_bf16 v[120:123], a[80:83], a[104:107], v[120:123]
s_cselect_b32 s29, s29, s21
ds_read_b64_tr_b16 a[154:155], v16 offset:3136
v_mov_b32 v7, 0xff800000
v_mfma_f32_16x16x32_bf16 v[120:123], a[84:87], a[100:103], v[120:123]
s_cselect_b32 s24, 2, 0
ds_read_b128 a[184:187], v17 offset:3456
v_mov_b32 v6, 1
v_mfma_f32_16x16x32_bf16 v[120:123], a[88:91], a[96:99], v[120:123]
s_add_u32 s12, s8, 16777216
ds_read_b128 a[216:219], v30 offset:6144
v_mov_b32 v5, v26
v_mfma_f32_16x16x32_bf16 v[124:127], a[64:67], a[124:127], 0
s_mov_b32 s13, s9
ds_read_b64_tr_b16 a[156:157], v16 offset:3656
v_add_u32 v4, 0x20000, v1
v_mfma_f32_16x16x32_bf16 v[124:127], a[68:71], a[120:123], v[124:127]
s_mov_b32 s15, s11
ds_read_b64_tr_b16 a[158:159], v16 offset:3648
v_mfma_f32_16x16x32_bf16 v[124:127], a[72:75], a[116:119], v[124:127]
s_mov_b32 s25, 1266679808
ds_read_b128 a[188:191], v17 offset:3968
v_mfma_f32_16x16x32_bf16 v[124:127], a[76:79], a[112:115], v[124:127]
s_lshl_b32 s22, s21, 3
ds_read_b128 a[220:223], v30 offset:7168
v_mfma_f32_16x16x32_bf16 v[124:127], a[80:83], a[108:111], v[124:127]
s_xor_b32 s28, s70, 0
ds_read_b128 a[224:227], v31 offset:0
v_mfma_f32_16x16x32_bf16 v[124:127], a[84:87], a[104:107], v[124:127]
s_add_u32 s28, s28, s22
ds_read_b128 a[228:231], v31 offset:1024
v_mfma_f32_16x16x32_bf16 v[124:127], a[88:91], a[100:103], v[124:127]
s_add_u32 s28, s28, 6148
ds_read_b128 a[232:235], v31 offset:2048
v_mfma_f32_16x16x32_bf16 v[124:127], a[92:95], a[96:99], v[124:127]
s_waitcnt lgkmcnt(8)
s_lshl_b32 s26, s21, 16
ds_read_b128 a[236:239], v31 offset:3072
v_mfma_f32_16x16x32_bf16 v[96:99], a[128:131], a[160:163], v[96:99]
s_add_u32 s26, s26, s30
ds_read_b64_tr_b16 a[64:65], v16 offset:136
v_mfma_f32_16x16x32_bf16 v[100:103], a[128:131], a[164:167], v[100:103]
s_add_u32 s26, s26, 33554432
ds_read_b64_tr_b16 a[66:67], v16 offset:128
v_mfma_f32_16x16x32_bf16 v[100:103], a[132:135], a[160:163], v[100:103]
s_xor_b32 s76, s20, 2
ds_read_b128 a[96:99], v17 offset:320
v_mfma_f32_16x16x32_bf16 v[104:107], a[128:131], a[168:171], v[104:107]
s_lshl_b32 s76, s76, 3
ds_read_b128 a[240:243], v31 offset:4096
v_mfma_f32_16x16x32_bf16 v[104:107], a[132:135], a[164:167], v[104:107]
s_add_u32 s76, s76, s21
ds_read_b64_tr_b16 a[68:69], v16 offset:648
v_mfma_f32_16x16x32_bf16 v[104:107], a[136:139], a[160:163], v[104:107]
s_lshl_b32 s76, s76, 2
ds_read_b64_tr_b16 a[70:71], v16 offset:640
v_mfma_f32_16x16x32_bf16 v[108:111], a[128:131], a[172:175], v[108:111]
s_add_u32 s76, s76, s3
ds_read_b128 a[100:103], v17 offset:832
v_mfma_f32_16x16x32_bf16 v[108:111], a[132:135], a[168:171], v[108:111]
s_lshl_b32 s27, s76, 10
ds_read_b128 a[244:247], v31 offset:5120
v_mfma_f32_16x16x32_bf16 v[108:111], a[136:139], a[164:167], v[108:111]
s_add_u32 s27, s27, 75497472
ds_read_b64_tr_b16 a[72:73], v16 offset:1160
v_mfma_f32_16x16x32_bf16 v[108:111], a[140:143], a[160:163], v[108:111]
s_lshl_b32 s76, s76, 14
ds_read_b64_tr_b16 a[74:75], v16 offset:1152
v_mfma_f32_16x16x32_bf16 v[112:115], a[128:131], a[176:179], v[112:115]
s_add_u32 s76, s76, 67108864
ds_read_b128 a[104:107], v17 offset:1344
v_mfma_f32_16x16x32_bf16 v[112:115], a[132:135], a[172:175], v[112:115]
s_lshl_b32 s81, s20, 2
ds_read_b128 a[248:251], v31 offset:6144
v_mfma_f32_16x16x32_bf16 v[112:115], a[136:139], a[168:171], v[112:115]
s_add_u32 s81, s81, s3
ds_read_b64_tr_b16 a[76:77], v16 offset:1672
v_mfma_f32_16x16x32_bf16 v[112:115], a[140:143], a[164:167], v[112:115]
s_mul_i32 s81, s81, 57344
ds_read_b64_tr_b16 a[78:79], v16 offset:1664
v_mfma_f32_16x16x32_bf16 v[112:115], a[144:147], a[160:163], v[112:115]
s_cmp_eq_u32 s24, 1
ds_read_b128 a[108:111], v17 offset:1856
v_mfma_f32_16x16x32_bf16 v[116:119], a[128:131], a[180:183], v[116:119]
s_cselect_b32 s80, s28, s70
ds_read_b128 a[252:255], v31 offset:7168
v_mfma_f32_16x16x32_bf16 v[116:119], a[132:135], a[176:179], v[116:119]
s_add_u32 s77, s76, 8192
ds_read_b64_tr_b16 a[80:81], v16 offset:2184
v_mfma_f32_16x16x32_bf16 v[116:119], a[136:139], a[172:175], v[116:119]
s_lshl_b32 s71, s2, 2
ds_read_b64_tr_b16 a[82:83], v16 offset:2176
v_mfma_f32_16x16x32_bf16 v[116:119], a[140:143], a[168:171], v[116:119]
s_add_u32 s71, s71, 94384128
ds_read_b128 a[112:115], v17 offset:2368
v_mfma_f32_16x16x32_bf16 v[116:119], a[144:147], a[164:167], v[116:119]
PAD_30:
s_cbranch_execz M_tret
s_lshl_b32 s78, s29, 16
v_mfma_f32_16x16x32_bf16 v[116:119], a[148:151], a[160:163], v[116:119]
s_add_u32 s78, s78, s8
ds_read_b64_tr_b16 a[84:85], v16 offset:2696
v_mfma_f32_16x16x32_bf16 v[120:123], a[128:131], a[184:187], v[120:123]
s_add_u32 s78, s78, 33554432
ds_read_b64_tr_b16 a[86:87], v16 offset:2688
v_mfma_f32_16x16x32_bf16 v[120:123], a[132:135], a[180:183], v[120:123]
s_cmp_eq_u32 s24, 0
ds_read_b128 a[116:119], v17 offset:2880
v_mfma_f32_16x16x32_bf16 v[120:123], a[136:139], a[176:179], v[120:123]
s_cselect_b32 s78, 3221225472, s78
v_mfma_f32_16x16x32_bf16 v[120:123], a[140:143], a[172:175], v[120:123]
s_lshl_b32 s22, s21, 3
ds_read_b64_tr_b16 a[88:89], v16 offset:3208
v_mfma_f32_16x16x32_bf16 v[120:123], a[144:147], a[168:171], v[120:123]
s_add_u32 s22, s22, 16384
ds_read_b64_tr_b16 a[90:91], v16 offset:3200
v_mfma_f32_16x16x32_bf16 v[120:123], a[148:151], a[164:167], v[120:123]
s_andn2_b32 s23, 256, s70
ds_read_b128 a[120:123], v17 offset:3392
v_mfma_f32_16x16x32_bf16 v[120:123], a[152:155], a[160:163], v[120:123]
s_waitcnt lgkmcnt(6)
s_add_u32 s22, s22, s23
v_mfma_f32_16x16x32_bf16 v[124:127], a[128:131], a[188:191], v[124:127]
s_waitcnt vmcnt(0) lgkmcnt(9)
s_barrier
ds_read_b64_tr_b16 a[92:93], v16 offset:3720
v_writelane_b32 v15, s22, 63
v_cmp_gt_u32 vcc, 1, v21
v_mfma_f32_16x16x32_bf16 v[124:127], a[132:135], a[184:187], v[124:127]
s_cbranch_vccnz M_kspin2
M_kok2:
ds_read_b64_tr_b16 a[94:95], v16 offset:3712
v_mov_b32 v25, 0
v_mfma_f32_16x16x32_bf16 v[124:127], a[136:139], a[180:183], v[124:127]
s_mov_b32 m0, s84
ds_read_b128 a[124:127], v17 offset:3904
v_mov_b32 v128, 0
v_mfma_f32_16x16x32_bf16 v[124:127], a[140:143], a[176:179], v[124:127]
buffer_load_dwordx4 v1, s[4:7], s8 offen offset:0 sc1 lds
v_mfma_f32_16x16x32_bf16 v[124:127], a[144:147], a[172:175], v[124:127]
buffer_load_dwordx4 v1, s[4:7], s8 offen offset:1024 sc1 lds
v_mfma_f32_16x16x32_bf16 v[124:127], a[148:151], a[168:171], v[124:127]
buffer_load_dwordx4 v1, s[4:7], s8 offen offset:2048 sc1 lds
v_mfma_f32_16x16x32_bf16 v[124:127], a[152:155], a[164:167], v[124:127]
buffer_load_dwordx4 v1, s[4:7], s8 offen offset:3072 sc1 lds
v_mfma_f32_16x16x32_bf16 v[124:127], a[156:159], a[160:163], v[124:127]
s_add_u32 s8, s8, 4096
v_mov_b32 v129, 0
v_mov_b32 v130, 0
v_mfma_f32_16x16x32_bf16 v[96:99], a[64:67], a[96:99], v[96:99]
s_add_u32 m0, s84, 4096
ds_read_b64_tr_b16 a[128:129], v16 offset:200
v_mov_b32 v131, 0
v_mfma_f32_16x16x32_bf16 v[100:103], a[64:67], a[100:103], v[100:103]
ds_read_b64_tr_b16 a[130:131], v16 offset:192
v_mov_b32 v132, 0
v_mfma_f32_16x16x32_bf16 v[100:103], a[68:71], a[96:99], v[100:103]
ds_read_b128 a[160:163], v17 offset:256
v_mov_b32 v133, 0
v_mfma_f32_16x16x32_bf16 v[104:107], a[64:67], a[104:107], v[104:107]
buffer_load_dwordx4 v1, s[4:7], s8 offen offset:0 sc1 lds
v_mfma_f32_16x16x32_bf16 v[104:107], a[68:71], a[100:103], v[104:107]
ds_read_b64_tr_b16 a[132:133], v16 offset:712
v_mov_b32 v134, 0
v_mfma_f32_16x16x32_bf16 v[104:107], a[72:75], a[96:99], v[104:107]
ds_read_b64_tr_b16 a[134:135], v16 offset:704
v_mov_b32 v135, 0
v_mfma_f32_16x16x32_bf16 v[108:111], a[64:67], a[108:111], v[108:111]
ds_read_b128 a[164:167], v17 offset:768
v_mov_b32 v136, 0
v_mfma_f32_16x16x32_bf16 v[108:111], a[68:71], a[104:107], v[108:111]
buffer_load_dwordx4 v1, s[4:7], s8 offen offset:1024 sc1 lds
v_mfma_f32_16x16x32_bf16 v[108:111], a[72:75], a[100:103], v[108:111]
ds_read_b64_tr_b16 a[136:137], v16 offset:1224
v_mov_b32 v137, 0
v_mfma_f32_16x16x32_bf16 v[108:111], a[76:79], a[96:99], v[108:111]
ds_read_b64_tr_b16 a[138:139], v16 offset:1216
v_mov_b32 v138, 0
v_mfma_f32_16x16x32_bf16 v[112:115], a[64:67], a[112:115], v[112:115]
ds_read_b128 a[168:171], v17 offset:1280
v_mov_b32 v139, 0
v_mfma_f32_16x16x32_bf16 v[112:115], a[68:71], a[108:111], v[112:115]
buffer_load_dwordx4 v1, s[4:7], s8 offen offset:2048 sc1 lds
v_mfma_f32_16x16x32_bf16 v[112:115], a[72:75], a[104:107], v[112:115]
ds_read_b64_tr_b16 a[140:141], v16 offset:1736
v_mov_b32 v140, 0
v_mfma_f32_16x16x32_bf16 v[112:115], a[76:79], a[100:103], v[112:115]
ds_read_b64_tr_b16 a[142:143], v16 offset:1728
v_mov_b32 v141, 0
v_mfma_f32_16x16x32_bf16 v[112:115], a[80:83], a[96:99], v[112:115]
s_waitcnt lgkmcnt(6)
ds_read_b128 a[172:175], v17 offset:1792
v_mov_b32 v142, 0
v_mfma_f32_16x16x32_bf16 v[116:119], a[64:67], a[116:119], v[116:119]
buffer_load_dwordx4 v1, s[4:7], s8 offen offset:3072 sc1 lds
v_mfma_f32_16x16x32_bf16 v[116:119], a[68:71], a[112:115], v[116:119]
s_add_u32 s8, s8, 28672
ds_read_b64_tr_b16 a[144:145], v16 offset:2248
v_mov_b32 v143, 0
v_mfma_f32_16x16x32_bf16 v[116:119], a[72:75], a[108:111], v[116:119]
s_sub_u32 s9, s9, 1
ds_read_b64_tr_b16 a[146:147], v16 offset:2240
v_mov_b32 v144, 0
v_mfma_f32_16x16x32_bf16 v[116:119], a[76:79], a[104:107], v[116:119]
s_cmp_eq_u32 s9, 0
ds_read_b128 a[176:179], v17 offset:2304
v_mov_b32 v145, 0
v_mfma_f32_16x16x32_bf16 v[116:119], a[80:83], a[100:103], v[116:119]
s_cselect_b32 s8, s10, s8
v_mov_b32 v146, 0
v_mov_b32 v147, 0
v_mfma_f32_16x16x32_bf16 v[116:119], a[84:87], a[96:99], v[116:119]
s_cselect_b32 s9, s11, s9
ds_read_b64_tr_b16 a[148:149], v16 offset:2760
v_mov_b32 v148, 0
v_mfma_f32_16x16x32_bf16 v[120:123], a[64:67], a[120:123], v[120:123]
s_cselect_b32 s10, 3221225472, s10
ds_read_b64_tr_b16 a[150:151], v16 offset:2752
v_mov_b32 v149, 0
v_mfma_f32_16x16x32_bf16 v[120:123], a[68:71], a[116:119], v[120:123]
s_mov_b32 m0, s85
ds_read_b128 a[180:183], v17 offset:2816
v_mov_b32 v150, 0
v_mfma_f32_16x16x32_bf16 v[120:123], a[72:75], a[112:115], v[120:123]
buffer_load_dwordx4 v1, s[4:7], s8 offen offset:0 sc1 lds
v_mfma_f32_16x16x32_bf16 v[120:123], a[76:79], a[108:111], v[120:123]
ds_read_b64_tr_b16 a[152:153], v16 offset:3272
v_mov_b32 v151, 0
v_mfma_f32_16x16x32_bf16 v[120:123], a[80:83], a[104:107], v[120:123]
ds_read_b64_tr_b16 a[154:155], v16 offset:3264
v_mov_b32 v152, 0
v_mfma_f32_16x16x32_bf16 v[120:123], a[84:87], a[100:103], v[120:123]
ds_read_b128 a[184:187], v17 offset:3328
v_mov_b32 v153, 0
v_mfma_f32_16x16x32_bf16 v[120:123], a[88:91], a[96:99], v[120:123]
buffer_load_dwordx4 v1, s[4:7], s8 offen offset:1024 sc1 lds
v_mfma_f32_16x16x32_bf16 v[124:127], a[64:67], a[124:127], v[124:127]
ds_read_b64_tr_b16 a[156:157], v16 offset:3784
v_mov_b32 v154, 0
v_mfma_f32_16x16x32_bf16 v[124:127], a[68:71], a[120:123], v[124:127]
ds_read_b64_tr_b16 a[158:159], v16 offset:3776
v_mov_b32 v155, 0
v_mfma_f32_16x16x32_bf16 v[124:127], a[72:75], a[116:119], v[124:127]
ds_read_b128 a[188:191], v17 offset:3840
v_mov_b32 v156, 0
v_mfma_f32_16x16x32_bf16 v[124:127], a[76:79], a[112:115], v[124:127]
buffer_load_dwordx4 v1, s[4:7], s8 offen offset:2048 sc1 lds
v_mfma_f32_16x16x32_bf16 v[124:127], a[80:83], a[108:111], v[124:127]
buffer_load_dwordx4 v1, s[4:7], s8 offen offset:3072 sc1 lds
v_mfma_f32_16x16x32_bf16 v[124:127], a[84:87], a[104:107], v[124:127]
s_add_u32 s8, s8, 4096
v_mov_b32 v157, 0
v_mov_b32 v158, 0
v_mfma_f32_16x16x32_bf16 v[124:127], a[88:91], a[100:103], v[124:127]
s_add_u32 m0, s85, 4096
v_mov_b32 v159, 0
v_mov_b32 v160, 0
v_mfma_f32_16x16x32_bf16 v[124:127], a[92:95], a[96:99], v[124:127]
buffer_load_dwordx4 v1, s[4:7], s8 offen offset:0 sc1 lds
v_mfma_f32_16x16x32_bf16 v[96:99], a[128:131], a[160:163], v[96:99]
s_waitcnt lgkmcnt(3)
ds_read_b64_tr_b16 a[64:65], v16 offset:264
v_mov_b32 v161, 0
v_mfma_f32_16x16x32_bf16 v[100:103], a[128:131], a[164:167], v[100:103]
ds_read_b64_tr_b16 a[66:67], v16 offset:256
v_mov_b32 v162, 0
v_mfma_f32_16x16x32_bf16 v[100:103], a[132:135], a[160:163], v[100:103]
ds_read_b128 a[96:99], v17 offset:192
v_mov_b32 v163, 0
v_mfma_f32_16x16x32_bf16 v[104:107], a[128:131], a[168:171], v[104:107]
buffer_load_dwordx4 v1, s[4:7], s8 offen offset:1024 sc1 lds
v_mfma_f32_16x16x32_bf16 v[104:107], a[132:135], a[164:167], v[104:107]
ds_read_b64_tr_b16 a[68:69], v16 offset:776
v_mov_b32 v164, 0
v_mfma_f32_16x16x32_bf16 v[104:107], a[136:139], a[160:163], v[104:107]
ds_read_b64_tr_b16 a[70:71], v16 offset:768
v_mov_b32 v165, 0
v_mfma_f32_16x16x32_bf16 v[108:111], a[128:131], a[172:175], v[108:111]
ds_read_b128 a[100:103], v17 offset:704
v_mov_b32 v166, 0
v_mfma_f32_16x16x32_bf16 v[108:111], a[132:135], a[168:171], v[108:111]
buffer_load_dwordx4 v1, s[4:7], s8 offen offset:2048 sc1 lds
v_mfma_f32_16x16x32_bf16 v[108:111], a[136:139], a[164:167], v[108:111]
ds_read_b64_tr_b16 a[72:73], v16 offset:1288
v_mov_b32 v167, 0
v_mfma_f32_16x16x32_bf16 v[108:111], a[140:143], a[160:163], v[108:111]
ds_read_b64_tr_b16 a[74:75], v16 offset:1280
v_mov_b32 v168, 0
v_mfma_f32_16x16x32_bf16 v[112:115], a[128:131], a[176:179], v[112:115]
ds_read_b128 a[104:107], v17 offset:1216
v_mov_b32 v169, 0
v_mfma_f32_16x16x32_bf16 v[112:115], a[132:135], a[172:175], v[112:115]
buffer_load_dwordx4 v1, s[4:7], s8 offen offset:3072 sc1 lds
v_mfma_f32_16x16x32_bf16 v[112:115], a[136:139], a[168:171], v[112:115]
s_add_u32 s8, s8, 28672
ds_read_b64_tr_b16 a[76:77], v16 offset:1800
v_mov_b32 v170, 0
v_mfma_f32_16x16x32_bf16 v[112:115], a[140:143], a[164:167], v[112:115]
s_sub_u32 s9, s9, 1
ds_read_b64_tr_b16 a[78:79], v16 offset:1792
v_mov_b32 v171, 0
v_mfma_f32_16x16x32_bf16 v[112:115], a[144:147], a[160:163], v[112:115]
s_cmp_eq_u32 s9, 0
ds_read_b128 a[108:111], v17 offset:1728
v_mov_b32 v172, 0
v_mfma_f32_16x16x32_bf16 v[116:119], a[128:131], a[180:183], v[116:119]
s_cselect_b32 s8, s10, s8
buffer_load_dword v14, v15, s[4:7], s31 offen sc1
v_mfma_f32_16x16x32_bf16 v[116:119], a[132:135], a[176:179], v[116:119]
s_cselect_b32 s9, s11, s9
ds_read_b64_tr_b16 a[80:81], v16 offset:2312
v_mov_b32 v173, 0
v_mfma_f32_16x16x32_bf16 v[116:119], a[136:139], a[172:175], v[116:119]
s_cselect_b32 s10, 3221225472, s10
ds_read_b64_tr_b16 a[82:83], v16 offset:2304
v_mov_b32 v174, 0
v_mfma_f32_16x16x32_bf16 v[116:119], a[140:143], a[168:171], v[116:119]
ds_read_b128 a[112:115], v17 offset:2240
v_mov_b32 v175, 0
v_mfma_f32_16x16x32_bf16 v[116:119], a[144:147], a[164:167], v[116:119]
v_mov_b32 v176, 0
v_mov_b32 v177, 0
v_mfma_f32_16x16x32_bf16 v[116:119], a[148:151], a[160:163], v[116:119]
ds_read_b64_tr_b16 a[84:85], v16 offset:2824
v_mov_b32 v178, 0
v_mfma_f32_16x16x32_bf16 v[120:123], a[128:131], a[184:187], v[120:123]
ds_read_b64_tr_b16 a[86:87], v16 offset:2816
v_mov_b32 v179, 0
v_mfma_f32_16x16x32_bf16 v[120:123], a[132:135], a[180:183], v[120:123]
ds_read_b128 a[116:119], v17 offset:2752
v_mov_b32 v180, 0
v_mfma_f32_16x16x32_bf16 v[120:123], a[136:139], a[176:179], v[120:123]
v_mov_b32 v181, 0
v_mov_b32 v182, 0
v_mfma_f32_16x16x32_bf16 v[120:123], a[140:143], a[172:175], v[120:123]
ds_read_b64_tr_b16 a[88:89], v16 offset:3336
v_mov_b32 v183, 0
v_mfma_f32_16x16x32_bf16 v[120:123], a[144:147], a[168:171], v[120:123]
ds_read_b64_tr_b16 a[90:91], v16 offset:3328
v_mov_b32 v184, 0
v_mfma_f32_16x16x32_bf16 v[120:123], a[148:151], a[164:167], v[120:123]
ds_read_b128 a[120:123], v17 offset:3264
v_mov_b32 v185, 0
v_mfma_f32_16x16x32_bf16 v[120:123], a[152:155], a[160:163], v[120:123]
s_waitcnt lgkmcnt(6)
v_mov_b32 v186, 0
v_mov_b32 v187, 0
v_mfma_f32_16x16x32_bf16 v[124:127], a[128:131], a[188:191], v[124:127]
ds_read_b64_tr_b16 a[92:93], v16 offset:3848
v_mov_b32 v188, 0
v_mfma_f32_16x16x32_bf16 v[124:127], a[132:135], a[184:187], v[124:127]
ds_read_b64_tr_b16 a[94:95], v16 offset:3840
v_mov_b32 v189, 0
v_mfma_f32_16x16x32_bf16 v[124:127], a[136:139], a[180:183], v[124:127]
ds_read_b128 a[124:127], v17 offset:3776
v_mov_b32 v190, 0
v_mfma_f32_16x16x32_bf16 v[124:127], a[140:143], a[176:179], v[124:127]
v_mov_b32 v191, 0
v_mov_b32 v192, 0
v_mfma_f32_16x16x32_bf16 v[124:127], a[144:147], a[172:175], v[124:127]
v_mov_b32 v193, 0
v_mov_b32 v194, 0
v_mfma_f32_16x16x32_bf16 v[124:127], a[148:151], a[168:171], v[124:127]
v_mov_b32 v195, 0
v_mov_b32 v196, 0
v_mfma_f32_16x16x32_bf16 v[124:127], a[152:155], a[164:167], v[124:127]
v_mov_b32 v197, 0
v_mov_b32 v198, 0
v_mfma_f32_16x16x32_bf16 v[124:127], a[156:159], a[160:163], v[124:127]
v_mov_b32 v199, 0
v_mov_b32 v200, 0
s_waitcnt vmcnt(0)
v_cmp_gt_u32 vcc, 1, v14
s_cbranch_vccnz M_cspin
M_cok:
v_mfma_f32_16x16x32_bf16 v[96:99], a[64:67], a[96:99], v[96:99]
s_add_u32 s22, s78, 0
ds_read_b64_tr_b16 a[128:129], v16 offset:328
v_mov_b32 v201, 0
v_mfma_f32_16x16x32_bf16 v[100:103], a[64:67], a[100:103], v[100:103]
ds_read_b64_tr_b16 a[130:131], v16 offset:320
v_mov_b32 v202, 0
v_mfma_f32_16x16x32_bf16 v[100:103], a[68:71], a[96:99], v[100:103]
ds_read_b128 a[160:163], v17 offset:128
v_mov_b32 v203, 0
v_mfma_f32_16x16x32_bf16 v[104:107], a[64:67], a[104:107], v[104:107]
buffer_load_dwordx4 a[0:3], v1, s[4:7], s22 offen offset:0 sc1
v_mfma_f32_16x16x32_bf16 v[104:107], a[68:71], a[100:103], v[104:107]
ds_read_b64_tr_b16 a[132:133], v16 offset:840
v_mov_b32 v204, 0
v_mfma_f32_16x16x32_bf16 v[104:107], a[72:75], a[96:99], v[104:107]
ds_read_b64_tr_b16 a[134:135], v16 offset:832
v_mov_b32 v205, 0
v_mfma_f32_16x16x32_bf16 v[108:111], a[64:67], a[108:111], v[108:111]
ds_read_b128 a[164:167], v17 offset:640
v_mov_b32 v206, 0
v_mfma_f32_16x16x32_bf16 v[108:111], a[68:71], a[104:107], v[108:111]
buffer_load_dwordx4 a[4:7], v1, s[4:7], s22 offen offset:1024 sc1
v_mfma_f32_16x16x32_bf16 v[108:111], a[72:75], a[100:103], v[108:111]
ds_read_b64_tr_b16 a[136:137], v16 offset:1352
v_mov_b32 v207, 0
v_mfma_f32_16x16x32_bf16 v[108:111], a[76:79], a[96:99], v[108:111]
ds_read_b64_tr_b16 a[138:139], v16 offset:1344
v_mov_b32 v208, 0
v_mfma_f32_16x16x32_bf16 v[112:115], a[64:67], a[112:115], v[112:115]
ds_read_b128 a[168:171], v17 offset:1152
v_mov_b32 v209, 0
v_mfma_f32_16x16x32_bf16 v[112:115], a[68:71], a[108:111], v[112:115]
buffer_load_dwordx4 a[8:11], v1, s[4:7], s22 offen offset:2048 sc1
v_mfma_f32_16x16x32_bf16 v[112:115], a[72:75], a[104:107], v[112:115]
ds_read_b64_tr_b16 a[140:141], v16 offset:1864
v_mov_b32 v210, 0
v_mfma_f32_16x16x32_bf16 v[112:115], a[76:79], a[100:103], v[112:115]
ds_read_b64_tr_b16 a[142:143], v16 offset:1856
v_mov_b32 v211, 0
v_mfma_f32_16x16x32_bf16 v[112:115], a[80:83], a[96:99], v[112:115]
s_waitcnt lgkmcnt(6)
ds_read_b128 a[172:175], v17 offset:1664
v_mov_b32 v212, 0
v_mfma_f32_16x16x32_bf16 v[116:119], a[64:67], a[116:119], v[116:119]
buffer_load_dwordx4 a[12:15], v1, s[4:7], s22 offen offset:3072 sc1
v_mfma_f32_16x16x32_bf16 v[116:119], a[68:71], a[112:115], v[116:119]
s_add_u32 s22, s78, 4096
ds_read_b64_tr_b16 a[144:145], v16 offset:2376
v_mov_b32 v213, 0
v_mfma_f32_16x16x32_bf16 v[116:119], a[72:75], a[108:111], v[116:119]
ds_read_b64_tr_b16 a[146:147], v16 offset:2368
v_mov_b32 v214, 0
v_mfma_f32_16x16x32_bf16 v[116:119], a[76:79], a[104:107], v[116:119]
ds_read_b128 a[176:179], v17 offset:2176
v_mov_b32 v215, 0
v_mfma_f32_16x16x32_bf16 v[116:119], a[80:83], a[100:103], v[116:119]
buffer_load_dwordx4 a[16:19], v1, s[4:7], s22 offen offset:0 sc1
v_mfma_f32_16x16x32_bf16 v[116:119], a[84:87], a[96:99], v[116:119]
ds_read_b64_tr_b16 a[148:149], v16 offset:2888
v_mov_b32 v216, 0
v_mfma_f32_16x16x32_bf16 v[120:123], a[64:67], a[120:123], v[120:123]
ds_read_b64_tr_b16 a[150:151], v16 offset:2880
v_mov_b32 v217, 0
v_mfma_f32_16x16x32_bf16 v[120:123], a[68:71], a[116:119], v[120:123]
ds_read_b128 a[180:183], v17 offset:2688
v_mov_b32 v218, 0
v_mfma_f32_16x16x32_bf16 v[120:123], a[72:75], a[112:115], v[120:123]
buffer_load_dwordx4 a[20:23], v1, s[4:7], s22 offen offset:1024 sc1
v_mfma_f32_16x16x32_bf16 v[120:123], a[76:79], a[108:111], v[120:123]
ds_read_b64_tr_b16 a[152:153], v16 offset:3400
v_mov_b32 v219, 0
v_mfma_f32_16x16x32_bf16 v[120:123], a[80:83], a[104:107], v[120:123]
ds_read_b64_tr_b16 a[154:155], v16 offset:3392
v_mov_b32 v220, 0
v_mfma_f32_16x16x32_bf16 v[120:123], a[84:87], a[100:103], v[120:123]
ds_read_b128 a[184:187], v17 offset:3200
v_mov_b32 v221, 0
v_mfma_f32_16x16x32_bf16 v[120:123], a[88:91], a[96:99], v[120:123]
buffer_load_dwordx4 a[24:27], v1, s[4:7], s22 offen offset:2048 sc1
v_mfma_f32_16x16x32_bf16 v[124:127], a[64:67], a[124:127], v[124:127]
ds_read_b64_tr_b16 a[156:157], v16 offset:3912
v_mov_b32 v222, 0
v_mfma_f32_16x16x32_bf16 v[124:127], a[68:71], a[120:123], v[124:127]
ds_read_b64_tr_b16 a[158:159], v16 offset:3904
v_mov_b32 v223, 0
v_mfma_f32_16x16x32_bf16 v[124:127], a[72:75], a[116:119], v[124:127]
ds_read_b128 a[188:191], v17 offset:3712
v_mov_b32 v224, 0
v_mfma_f32_16x16x32_bf16 v[124:127], a[76:79], a[112:115], v[124:127]
buffer_load_dwordx4 a[28:31], v1, s[4:7], s22 offen offset:3072 sc1
v_mfma_f32_16x16x32_bf16 v[124:127], a[80:83], a[108:111], v[124:127]
s_add_u32 s22, s78, 32768
buffer_load_dwordx4 a[32:35], v1, s[4:7], s22 offen offset:0 sc1
v_mfma_f32_16x16x32_bf16 v[124:127], a[84:87], a[104:107], v[124:127]
buffer_load_dwordx4 a[36:39], v1, s[4:7], s22 offen offset:1024 sc1
v_mfma_f32_16x16x32_bf16 v[124:127], a[88:91], a[100:103], v[124:127]
buffer_load_dwordx4 a[40:43], v1, s[4:7], s22 offen offset:2048 sc1
v_mfma_f32_16x16x32_bf16 v[124:127], a[92:95], a[96:99], v[124:127]
s_waitcnt lgkmcnt(3)
buffer_load_dwordx4 a[44:47], v1, s[4:7], s22 offen offset:3072 sc1
v_mfma_f32_16x16x32_bf16 v[96:99], a[128:131], a[160:163], v[96:99]
s_add_u32 s22, s78, 36864
ds_read_b64_tr_b16 a[64:65], v16 offset:392
v_mov_b32 v225, 0
v_mfma_f32_16x16x32_bf16 v[100:103], a[128:131], a[164:167], v[100:103]
ds_read_b64_tr_b16 a[66:67], v16 offset:384
v_mov_b32 v226, 0
v_mfma_f32_16x16x32_bf16 v[100:103], a[132:135], a[160:163], v[100:103]
ds_read_b128 a[96:99], v17 offset:64
v_mov_b32 v227, 0
v_mfma_f32_16x16x32_bf16 v[104:107], a[128:131], a[168:171], v[104:107]
ds_read_b64 v[36:37], v18 offset:0
v_mov_b32 v228, 0
v_mfma_f32_16x16x32_bf16 v[104:107], a[132:135], a[164:167], v[104:107]
ds_read_b64_tr_b16 a[68:69], v16 offset:904
v_mov_b32 v229, 0
v_mfma_f32_16x16x32_bf16 v[104:107], a[136:139], a[160:163], v[104:107]
ds_read_b64_tr_b16 a[70:71], v16 offset:896
v_mov_b32 v230, 0
v_mfma_f32_16x16x32_bf16 v[108:111], a[128:131], a[172:175], v[108:111]
ds_read_b128 a[100:103], v17 offset:576
v_mov_b32 v231, 0
v_mfma_f32_16x16x32_bf16 v[108:111], a[132:135], a[168:171], v[108:111]
ds_read_b64 v[38:39], v18 offset:512
v_mov_b32 v232, 0
v_mfma_f32_16x16x32_bf16 v[108:111], a[136:139], a[164:167], v[108:111]
ds_read_b64_tr_b16 a[72:73], v16 offset:1416
v_mov_b32 v233, 0
v_mfma_f32_16x16x32_bf16 v[108:111], a[140:143], a[160:163], v[108:111]
ds_read_b64_tr_b16 a[74:75], v16 offset:1408
v_mov_b32 v234, 0
v_mfma_f32_16x16x32_bf16 v[112:115], a[128:131], a[176:179], v[112:115]
ds_read_b128 a[104:107], v17 offset:1088
v_mov_b32 v235, 0
v_mfma_f32_16x16x32_bf16 v[112:115], a[132:135], a[172:175], v[112:115]
ds_read_b64 v[44:45], v18 offset:1024
v_mov_b32 v236, 0
v_mfma_f32_16x16x32_bf16 v[112:115], a[136:139], a[168:171], v[112:115]
ds_read_b64_tr_b16 a[76:77], v16 offset:1928
v_mov_b32 v237, 0
v_mfma_f32_16x16x32_bf16 v[112:115], a[140:143], a[164:167], v[112:115]
ds_read_b64_tr_b16 a[78:79], v16 offset:1920
v_mov_b32 v238, 0
v_mfma_f32_16x16x32_bf16 v[112:115], a[144:147], a[160:163], v[112:115]
ds_read_b128 a[108:111], v17 offset:1600
v_mov_b32 v239, 0
v_mfma_f32_16x16x32_bf16 v[116:119], a[128:131], a[180:183], v[116:119]
ds_read_b64 v[46:47], v18 offset:1536
v_mov_b32 v240, 0
v_mfma_f32_16x16x32_bf16 v[116:119], a[132:135], a[176:179], v[116:119]
ds_read_b64_tr_b16 a[80:81], v16 offset:2440
v_mov_b32 v241, 0
v_mfma_f32_16x16x32_bf16 v[116:119], a[136:139], a[172:175], v[116:119]
ds_read_b64_tr_b16 a[82:83], v16 offset:2432
v_mov_b32 v242, 0
v_mfma_f32_16x16x32_bf16 v[116:119], a[140:143], a[168:171], v[116:119]
ds_read_b128 a[112:115], v17 offset:2112
v_mov_b32 v243, 0
v_mfma_f32_16x16x32_bf16 v[116:119], a[144:147], a[164:167], v[116:119]
ds_read_b64 v[52:53], v18 offset:2048
v_mov_b32 v244, 0
v_mfma_f32_16x16x32_bf16 v[116:119], a[148:151], a[160:163], v[116:119]
ds_read_b64_tr_b16 a[84:85], v16 offset:2952
v_mov_b32 v245, 0
v_mfma_f32_16x16x32_bf16 v[120:123], a[128:131], a[184:187], v[120:123]
ds_read_b64_tr_b16 a[86:87], v16 offset:2944
v_mov_b32 v246, 0
v_mfma_f32_16x16x32_bf16 v[120:123], a[132:135], a[180:183], v[120:123]
ds_read_b128 a[116:119], v17 offset:2624
v_mov_b32 v247, 0
v_mfma_f32_16x16x32_bf16 v[120:123], a[136:139], a[176:179], v[120:123]
ds_read_b64 v[54:55], v18 offset:2560
v_mov_b32 v248, 0
v_mfma_f32_16x16x32_bf16 v[120:123], a[140:143], a[172:175], v[120:123]
ds_read_b64_tr_b16 a[88:89], v16 offset:3464
v_mov_b32 v249, 0
v_mfma_f32_16x16x32_bf16 v[120:123], a[144:147], a[168:171], v[120:123]
ds_read_b64_tr_b16 a[90:91], v16 offset:3456
v_mov_b32 v250, 0
v_mfma_f32_16x16x32_bf16 v[120:123], a[148:151], a[164:167], v[120:123]
ds_read_b128 a[120:123], v17 offset:3136
v_mov_b32 v251, 0
v_mfma_f32_16x16x32_bf16 v[120:123], a[152:155], a[160:163], v[120:123]
s_waitcnt lgkmcnt(8)
ds_read_b64 v[60:61], v18 offset:3072
v_mov_b32 v252, 0
v_mfma_f32_16x16x32_bf16 v[124:127], a[128:131], a[188:191], v[124:127]
ds_read_b64_tr_b16 a[92:93], v16 offset:3976
v_mov_b32 v253, 0
v_mfma_f32_16x16x32_bf16 v[124:127], a[132:135], a[184:187], v[124:127]
ds_read_b64_tr_b16 a[94:95], v16 offset:3968
v_mov_b32 v254, 0
v_mfma_f32_16x16x32_bf16 v[124:127], a[136:139], a[180:183], v[124:127]
ds_read_b128 a[124:127], v17 offset:3648
v_mov_b32 v255, 0
v_mfma_f32_16x16x32_bf16 v[124:127], a[140:143], a[176:179], v[124:127]
ds_read_b64 v[62:63], v18 offset:3584
v_mfma_f32_16x16x32_bf16 v[124:127], a[144:147], a[172:175], v[124:127]
buffer_load_dwordx4 a[48:51], v1, s[4:7], s22 offen offset:0 sc1
v_mfma_f32_16x16x32_bf16 v[124:127], a[148:151], a[168:171], v[124:127]
buffer_load_dwordx4 a[52:55], v1, s[4:7], s22 offen offset:1024 sc1
v_mfma_f32_16x16x32_bf16 v[124:127], a[152:155], a[164:167], v[124:127]
buffer_load_dwordx4 a[56:59], v1, s[4:7], s22 offen offset:2048 sc1
v_mfma_f32_16x16x32_bf16 v[124:127], a[156:159], a[160:163], v[124:127]
buffer_load_dwordx4 a[60:63], v1, s[4:7], s22 offen offset:3072 sc1
v_mfma_f32_16x16x32_bf16 v[96:99], a[64:67], a[96:99], v[96:99]
ds_read_b64_tr_b16 a[128:129], v16 offset:456
v_mfma_f32_16x16x32_bf16 v[100:103], a[64:67], a[100:103], v[100:103]
ds_read_b64_tr_b16 a[130:131], v16 offset:448
v_mfma_f32_16x16x32_bf16 v[100:103], a[68:71], a[96:99], v[100:103]
ds_read_b128 a[160:163], v17 offset:0
v_mfma_f32_16x16x32_bf16 v[104:107], a[64:67], a[104:107], v[104:107]
v_mfma_f32_16x16x32_bf16 v[104:107], a[68:71], a[100:103], v[104:107]
ds_read_b64_tr_b16 a[132:133], v16 offset:968
v_mfma_f32_16x16x32_bf16 v[104:107], a[72:75], a[96:99], v[104:107]
ds_read_b64_tr_b16 a[134:135], v16 offset:960
v_mfma_f32_16x16x32_bf16 v[108:111], a[64:67], a[108:111], v[108:111]
ds_read_b128 a[164:167], v17 offset:512
v_mfma_f32_16x16x32_bf16 v[108:111], a[68:71], a[104:107], v[108:111]
v_mfma_f32_16x16x32_bf16 v[108:111], a[72:75], a[100:103], v[108:111]
ds_read_b64_tr_b16 a[136:137], v16 offset:1480
v_mfma_f32_16x16x32_bf16 v[108:111], a[76:79], a[96:99], v[108:111]
ds_read_b64_tr_b16 a[138:139], v16 offset:1472
v_mfma_f32_16x16x32_bf16 v[112:115], a[64:67], a[112:115], v[112:115]
ds_read_b128 a[168:171], v17 offset:1024
v_mfma_f32_16x16x32_bf16 v[112:115], a[68:71], a[108:111], v[112:115]
v_mfma_f32_16x16x32_bf16 v[112:115], a[72:75], a[104:107], v[112:115]
ds_read_b64_tr_b16 a[140:141], v16 offset:1992
v_mfma_f32_16x16x32_bf16 v[112:115], a[76:79], a[100:103], v[112:115]
ds_read_b64_tr_b16 a[142:143], v16 offset:1984
v_mfma_f32_16x16x32_bf16 v[112:115], a[80:83], a[96:99], v[112:115]
s_waitcnt lgkmcnt(6)
ds_read_b128 a[172:175], v17 offset:1536
v_mfma_f32_16x16x32_bf16 v[116:119], a[64:67], a[116:119], v[116:119]
v_mfma_f32_16x16x32_bf16 v[116:119], a[68:71], a[112:115], v[116:119]
ds_read_b64_tr_b16 a[144:145], v16 offset:2504
v_mfma_f32_16x16x32_bf16 v[116:119], a[72:75], a[108:111], v[116:119]
ds_read_b64_tr_b16 a[146:147], v16 offset:2496
v_mfma_f32_16x16x32_bf16 v[116:119], a[76:79], a[104:107], v[116:119]
ds_read_b128 a[176:179], v17 offset:2048
v_mfma_f32_16x16x32_bf16 v[116:119], a[80:83], a[100:103], v[116:119]
v_mfma_f32_16x16x32_bf16 v[116:119], a[84:87], a[96:99], v[116:119]
ds_read_b64_tr_b16 a[148:149], v16 offset:3016
v_mfma_f32_16x16x32_bf16 v[120:123], a[64:67], a[120:123], v[120:123]
ds_read_b64_tr_b16 a[150:151], v16 offset:3008
v_mfma_f32_16x16x32_bf16 v[120:123], a[68:71], a[116:119], v[120:123]
ds_read_b128 a[180:183], v17 offset:2560
v_mfma_f32_16x16x32_bf16 v[120:123], a[72:75], a[112:115], v[120:123]
v_mfma_f32_16x16x32_bf16 v[120:123], a[76:79], a[108:111], v[120:123]
ds_read_b64_tr_b16 a[152:153], v16 offset:3528
v_mfma_f32_16x16x32_bf16 v[120:123], a[80:83], a[104:107], v[120:123]
ds_read_b64_tr_b16 a[154:155], v16 offset:3520
v_mfma_f32_16x16x32_bf16 v[120:123], a[84:87], a[100:103], v[120:123]
ds_read_b128 a[184:187], v17 offset:3072
v_mfma_f32_16x16x32_bf16 v[120:123], a[88:91], a[96:99], v[120:123]
v_mfma_f32_16x16x32_bf16 v[124:127], a[64:67], a[124:127], v[124:127]
ds_read_b64_tr_b16 a[156:157], v16 offset:4040
v_mfma_f32_16x16x32_bf16 v[124:127], a[68:71], a[120:123], v[124:127]
ds_read_b64_tr_b16 a[158:159], v16 offset:4032
v_mfma_f32_16x16x32_bf16 v[124:127], a[72:75], a[116:119], v[124:127]
ds_read_b128 a[188:191], v17 offset:3584
v_mfma_f32_16x16x32_bf16 v[124:127], a[76:79], a[112:115], v[124:127]
v_mfma_f32_16x16x32_bf16 v[124:127], a[80:83], a[108:111], v[124:127]
v_mfma_f32_16x16x32_bf16 v[124:127], a[84:87], a[104:107], v[124:127]
v_mfma_f32_16x16x32_bf16 v[124:127], a[88:91], a[100:103], v[124:127]
v_mfma_f32_16x16x32_bf16 v[124:127], a[92:95], a[96:99], v[124:127]
v_mfma_f32_16x16x32_bf16 v[96:99], a[128:131], a[160:163], v[96:99]
s_waitcnt lgkmcnt(3)
v_mfma_f32_16x16x32_bf16 v[100:103], a[128:131], a[164:167], v[100:103]
v_mfma_f32_16x16x32_bf16 v[100:103], a[132:135], a[160:163], v[100:103]
v_mfma_f32_16x16x32_bf16 v[104:107], a[128:131], a[168:171], v[104:107]
v_mfma_f32_16x16x32_bf16 v[104:107], a[132:135], a[164:167], v[104:107]
v_mfma_f32_16x16x32_bf16 v[104:107], a[136:139], a[160:163], v[104:107]
v_mfma_f32_16x16x32_bf16 v[108:111], a[128:131], a[172:175], v[108:111]
v_mfma_f32_16x16x32_bf16 v[108:111], a[132:135], a[168:171], v[108:111]
v_mfma_f32_16x16x32_bf16 v[108:111], a[136:139], a[164:167], v[108:111]
v_lshlrev_b32 v10, 16, v36
v_fmac_f32 v96, v19, v10
v_mfma_f32_16x16x32_bf16 v[108:111], a[140:143], a[160:163], v[108:111]
v_and_b32 v11, 0xffff0000, v36
v_fmac_f32 v97, v19, v11
v_mfma_f32_16x16x32_bf16 v[112:115], a[128:131], a[176:179], v[112:115]
v_lshlrev_b32 v12, 16, v37
v_fmac_f32 v98, v19, v12
v_mfma_f32_16x16x32_bf16 v[112:115], a[132:135], a[172:175], v[112:115]
v_and_b32 v13, 0xffff0000, v37
v_fmac_f32 v99, v19, v13
v_mfma_f32_16x16x32_bf16 v[112:115], a[136:139], a[168:171], v[112:115]
v_cvt_pk_bf16_f32 v96, v96, v97
v_cvt_pk_bf16_f32 v97, v98, v99
v_mfma_f32_16x16x32_bf16 v[112:115], a[140:143], a[164:167], v[112:115]
buffer_store_dwordx2 v[96:97], v8, s[4:7], s83 offen offset:0 sc1
v_mfma_f32_16x16x32_bf16 v[112:115], a[144:147], a[160:163], v[112:115]
v_lshlrev_b32 v10, 16, v38
v_fmac_f32 v100, v19, v10
v_mfma_f32_16x16x32_bf16 v[116:119], a[128:131], a[180:183], v[116:119]
v_and_b32 v11, 0xffff0000, v38
v_fmac_f32 v101, v19, v11
v_mfma_f32_16x16x32_bf16 v[116:119], a[132:135], a[176:179], v[116:119]
v_lshlrev_b32 v12, 16, v39
v_fmac_f32 v102, v19, v12
v_mfma_f32_16x16x32_bf16 v[116:119], a[136:139], a[172:175], v[116:119]
v_and_b32 v13, 0xffff0000, v39
v_fmac_f32 v103, v19, v13
v_mfma_f32_16x16x32_bf16 v[116:119], a[140:143], a[168:171], v[116:119]
v_cvt_pk_bf16_f32 v100, v100, v101
v_cvt_pk_bf16_f32 v101, v102, v103
v_mfma_f32_16x16x32_bf16 v[116:119], a[144:147], a[164:167], v[116:119]
buffer_store_dwordx2 v[100:101], v8, s[4:7], s83 offen offset:512 sc1
v_mfma_f32_16x16x32_bf16 v[116:119], a[148:151], a[160:163], v[116:119]
v_lshlrev_b32 v10, 16, v44
v_fmac_f32 v104, v19, v10
v_mfma_f32_16x16x32_bf16 v[120:123], a[128:131], a[184:187], v[120:123]
v_and_b32 v11, 0xffff0000, v44
v_fmac_f32 v105, v19, v11
v_mfma_f32_16x16x32_bf16 v[120:123], a[132:135], a[180:183], v[120:123]
v_lshlrev_b32 v12, 16, v45
v_fmac_f32 v106, v19, v12
v_mfma_f32_16x16x32_bf16 v[120:123], a[136:139], a[176:179], v[120:123]
v_and_b32 v13, 0xffff0000, v45
v_fmac_f32 v107, v19, v13
v_mfma_f32_16x16x32_bf16 v[120:123], a[140:143], a[172:175], v[120:123]
v_cvt_pk_bf16_f32 v104, v104, v105
v_cvt_pk_bf16_f32 v105, v106, v107
v_mfma_f32_16x16x32_bf16 v[120:123], a[144:147], a[168:171], v[120:123]
PAD_31:
s_cbranch_execz M_tret
buffer_store_dwordx2 v[104:105], v8, s[4:7], s83 offen offset:1024 sc1
v_mfma_f32_16x16x32_bf16 v[120:123], a[148:151], a[164:167], v[120:123]
v_lshlrev_b32 v10, 16, v46
v_fmac_f32 v108, v19, v10
v_mfma_f32_16x16x32_bf16 v[120:123], a[152:155], a[160:163], v[120:123]
s_waitcnt lgkmcnt(0)
v_and_b32 v11, 0xffff0000, v46
v_fmac_f32 v109, v19, v11
v_mfma_f32_16x16x32_bf16 v[124:127], a[128:131], a[188:191], v[124:127]
v_lshlrev_b32 v12, 16, v47
v_fmac_f32 v110, v19, v12
v_mfma_f32_16x16x32_bf16 v[124:127], a[132:135], a[184:187], v[124:127]
v_and_b32 v13, 0xffff0000, v47
v_fmac_f32 v111, v19, v13
v_mfma_f32_16x16x32_bf16 v[124:127], a[136:139], a[180:183], v[124:127]
v_cvt_pk_bf16_f32 v108, v108, v109
v_cvt_pk_bf16_f32 v109, v110, v111
v_mfma_f32_16x16x32_bf16 v[124:127], a[140:143], a[176:179], v[124:127]
buffer_store_dwordx2 v[108:109], v8, s[4:7], s83 offen offset:1536 sc1
v_mfma_f32_16x16x32_bf16 v[124:127], a[144:147], a[172:175], v[124:127]
v_lshlrev_b32 v10, 16, v52
v_fmac_f32 v112, v19, v10
v_mfma_f32_16x16x32_bf16 v[124:127], a[148:151], a[168:171], v[124:127]
v_and_b32 v11, 0xffff0000, v52
v_fmac_f32 v113, v19, v11
v_mfma_f32_16x16x32_bf16 v[124:127], a[152:155], a[164:167], v[124:127]
v_lshlrev_b32 v12, 16, v53
v_fmac_f32 v114, v19, v12
v_mfma_f32_16x16x32_bf16 v[124:127], a[156:159], a[160:163], v[124:127]
v_and_b32 v13, 0xffff0000, v53
v_fmac_f32 v115, v19, v13
v_cvt_pk_bf16_f32 v112, v112, v113
v_cvt_pk_bf16_f32 v113, v114, v115
buffer_store_dwordx2 v[112:113], v8, s[4:7], s83 offen offset:2048 sc1
v_lshlrev_b32 v10, 16, v54
v_fmac_f32 v116, v19, v10
v_and_b32 v11, 0xffff0000, v54
v_fmac_f32 v117, v19, v11
v_lshlrev_b32 v12, 16, v55
v_fmac_f32 v118, v19, v12
v_and_b32 v13, 0xffff0000, v55
v_fmac_f32 v119, v19, v13
v_cvt_pk_bf16_f32 v116, v116, v117
v_cvt_pk_bf16_f32 v117, v118, v119
buffer_store_dwordx2 v[116:117], v8, s[4:7], s83 offen offset:2560 sc1
v_lshlrev_b32 v10, 16, v60
v_fmac_f32 v120, v19, v10
v_and_b32 v11, 0xffff0000, v60
v_fmac_f32 v121, v19, v11
v_lshlrev_b32 v12, 16, v61
v_fmac_f32 v122, v19, v12
v_and_b32 v13, 0xffff0000, v61
v_fmac_f32 v123, v19, v13
v_cvt_pk_bf16_f32 v120, v120, v121
v_cvt_pk_bf16_f32 v121, v122, v123
buffer_store_dwordx2 v[120:121], v8, s[4:7], s83 offen offset:3072 sc1
v_lshlrev_b32 v10, 16, v62
v_fmac_f32 v124, v19, v10
v_and_b32 v11, 0xffff0000, v62
v_fmac_f32 v125, v19, v11
v_lshlrev_b32 v12, 16, v63
v_fmac_f32 v126, v19, v12
v_and_b32 v13, 0xffff0000, v63
v_fmac_f32 v127, v19, v13
v_cvt_pk_bf16_f32 v124, v124, v125
v_cvt_pk_bf16_f32 v125, v126, v127
buffer_store_dwordx2 v[124:125], v8, s[4:7], s83 offen offset:3584 sc1
v_lshrrev_b32 v8, 7, v1
v_and_b32 v9, 6, v8
v_lshlrev_b32 v9, 4, v9
v_and_b32 v10, 0x70, v1
v_xor_b32 v9, v9, v10
v_mul_u32_u24 v8, 896, v8
v_add_u32 v8, v8, v9
v_accvgpr_write_b32 a184, v8
v_add_u32 v8, 6144, v8
v_accvgpr_write_b32 a185, v8
v_add_u32 v8, 6144, v8
v_accvgpr_write_b32 a186, v8
v_add_u32 v8, 6144, v8
v_accvgpr_write_b32 a187, v8
v_lshrrev_b32 v8, 6, v1
v_bfe_u32 v9, v1, 7, 2
v_lshlrev_b32 v9, 5, v9
v_lshl_add_u32 v8, v8, 7, v9
v_bfe_u32 v9, v1, 4, 2
v_lshl_add_u32 v8, v9, 3, v8
v_add_u32 v8, 32768, v8
v_accvgpr_write_b32 a188, v8
v_xor_b32 v9, 32, v8
v_accvgpr_write_b32 a189, v9
v_xor_b32 v9, 64, v8
v_accvgpr_write_b32 a190, v9
v_xor_b32 v9, 96, v8
v_accvgpr_write_b32 a191, v9
s_branch M_t2B
M_t2Br:
s_waitcnt vmcnt(8)
s_barrier
s_cmp_lg_u32 s24, 0
s_cbranch_scc1 K2_item
v_accvgpr_mov_b32 a0, a192
v_accvgpr_mov_b32 a1, a193
v_accvgpr_mov_b32 a2, a194
v_accvgpr_mov_b32 a3, a195
v_accvgpr_mov_b32 a4, a196
v_accvgpr_mov_b32 a5, a197
v_accvgpr_mov_b32 a6, a198
v_accvgpr_mov_b32 a7, a199
v_accvgpr_mov_b32 a8, a200
v_accvgpr_mov_b32 a9, a201
v_accvgpr_mov_b32 a10, a202
v_accvgpr_mov_b32 a11, a203
v_accvgpr_mov_b32 a12, a204
v_accvgpr_mov_b32 a13, a205
v_accvgpr_mov_b32 a14, a206
v_accvgpr_mov_b32 a15, a207
v_accvgpr_mov_b32 a16, a208
v_accvgpr_mov_b32 a17, a209
v_accvgpr_mov_b32 a18, a210
v_accvgpr_mov_b32 a19, a211
v_accvgpr_mov_b32 a20, a212
v_accvgpr_mov_b32 a21, a213
v_accvgpr_mov_b32 a22, a214
v_accvgpr_mov_b32 a23, a215
v_accvgpr_mov_b32 a24, a216
v_accvgpr_mov_b32 a25, a217
v_accvgpr_mov_b32 a26, a218
v_accvgpr_mov_b32 a27, a219
v_accvgpr_mov_b32 a28, a220
v_accvgpr_mov_b32 a29, a221
v_accvgpr_mov_b32 a30, a222
v_accvgpr_mov_b32 a31, a223
v_accvgpr_mov_b32 a32, a224
v_accvgpr_mov_b32 a33, a225
v_accvgpr_mov_b32 a34, a226
v_accvgpr_mov_b32 a35, a227
v_accvgpr_mov_b32 a36, a228
v_accvgpr_mov_b32 a37, a229
v_accvgpr_mov_b32 a38, a230
v_accvgpr_mov_b32 a39, a231
v_accvgpr_mov_b32 a40, a232
v_accvgpr_mov_b32 a41, a233
v_accvgpr_mov_b32 a42, a234
v_accvgpr_mov_b32 a43, a235
v_accvgpr_mov_b32 a44, a236
v_accvgpr_mov_b32 a45, a237
v_accvgpr_mov_b32 a46, a238
v_accvgpr_mov_b32 a47, a239
v_accvgpr_mov_b32 a48, a240
v_accvgpr_mov_b32 a49, a241
v_accvgpr_mov_b32 a50, a242
v_accvgpr_mov_b32 a51, a243
v_accvgpr_mov_b32 a52, a244
v_accvgpr_mov_b32 a53, a245
v_accvgpr_mov_b32 a54, a246
v_accvgpr_mov_b32 a55, a247
v_accvgpr_mov_b32 a56, a248
v_accvgpr_mov_b32 a57, a249
v_accvgpr_mov_b32 a58, a250
v_accvgpr_mov_b32 a59, a251
v_accvgpr_mov_b32 a60, a252
v_accvgpr_mov_b32 a61, a253
v_accvgpr_mov_b32 a62, a254
v_accvgpr_mov_b32 a63, a255
s_branch K2_item
M_cend:
M_cspin:
Lp_16:
buffer_load_dword v14, v15, s[4:7], s31 offen sc1
s_waitcnt vmcnt(0)
v_cmp_gt_u32 vcc, 1, v14
s_cbranch_vccz Lpd_17
s_sleep 8
s_sub_u32 s101, s101, 1
s_cbranch_scc0 Lp_16
s_mov_b32 s101, 0
Lpd_17:
s_branch M_cok
M_kspin:
Lp_18:
buffer_load_dword v21, v20, s[4:7], s70 offen sc1
s_waitcnt vmcnt(0)
v_cmp_gt_u32 vcc, 1, v21
s_cbranch_vccz Lpd_19
s_sleep 8
s_sub_u32 s101, s101, 1
s_cbranch_scc0 Lp_18
s_mov_b32 s101, 0
Lpd_19:
s_branch M_kok
M_kspin2:
Lp_20:
buffer_load_dword v21, v20, s[4:7], s31 offen sc1
s_waitcnt vmcnt(0)
v_cmp_gt_u32 vcc, 1, v21
s_cbranch_vccz Lpd_21
s_sleep 8
s_sub_u32 s101, s101, 1
s_cbranch_scc0 Lp_20
s_mov_b32 s101, 0
Lpd_21:
s_branch M_kok2
M_vspin:
Lp_22:
buffer_load_dword v21, v15, s[4:7], s70 offen sc1
s_waitcnt vmcnt(0)
v_cmp_gt_u32 vcc, 1, v21
s_cbranch_vccz Lpd_23
s_sleep 8
s_sub_u32 s101, s101, 1
s_cbranch_scc0 Lp_22
s_mov_b32 s101, 0
Lpd_23:
s_branch M_vok
PAD_32:
s_cbranch_execz M_tret
K2_plain:
v_mfma_f32_16x16x32_bf16 v[128:131], a[64:67], v[96:99], v[128:131]
s_waitcnt lgkmcnt(6)
ds_read_b128 a[96:99], v2 offset:8192
v_add_f32 v24, v24, v26
v_mfma_f32_16x16x32_bf16 v[128:131], a[68:71], v[100:103], v[128:131]
s_waitcnt lgkmcnt(5)
v_mfma_f32_16x16x32_bf16 v[132:135], a[68:71], v[108:111], v[132:135]
s_mov_b64 s[36:37], s[86:87]
ds_read_b128 a[100:103], v2 offset:9216
v_add_f32 v25, v25, v27
v_mfma_f32_16x16x32_bf16 v[132:135], a[64:67], v[104:107], v[132:135]
s_mov_b32 s38, 3670016
v_exp_f32 v8, v68
v_mfma_f32_16x16x32_bf16 v[136:139], a[72:75], v[96:99], v[136:139]
s_mov_b32 s39, 0x20000
ds_read_b128 a[104:107], v2 offset:10240
v_accvgpr_read_b32 v112, a184
v_mfma_f32_16x16x32_bf16 v[136:139], a[76:79], v[100:103], v[136:139]
v_accvgpr_read_b32 v113, a185
v_accvgpr_read_b32 v114, a186
v_mfma_f32_16x16x32_bf16 v[140:143], a[76:79], v[108:111], v[140:143]
ds_read_b128 a[108:111], v2 offset:11264
v_accvgpr_read_b32 v115, a187
v_mfma_f32_16x16x32_bf16 v[140:143], a[72:75], v[104:107], v[140:143]
s_waitcnt lgkmcnt(5)
v_accvgpr_read_b32 v116, a188
v_accvgpr_read_b32 v117, a189
v_mfma_f32_16x16x32_bf16 v[144:147], a[80:83], v[96:99], v[144:147]
ds_read_b128 a[112:115], v2 offset:12288
v_accvgpr_read_b32 v118, a190
v_mfma_f32_16x16x32_bf16 v[144:147], a[84:87], v[100:103], v[144:147]
v_accvgpr_read_b32 v119, a191
v_mfma_f32_16x16x32_bf16 v[148:151], a[84:87], v[108:111], v[148:151]
s_add_u32 m0, s18, 32768
ds_read_b128 a[116:119], v2 offset:13312
v_cvt_pk_bf16_f32 v128, v128, v129
v_mfma_f32_16x16x32_bf16 v[148:151], a[80:83], v[104:107], v[148:151]
buffer_load_dwordx4 v112, s[36:39], s81 offen offset:0 lds
v_mfma_f32_16x16x32_bf16 v[152:155], a[88:91], v[96:99], v[152:155]
s_waitcnt lgkmcnt(4)
ds_read_b128 a[120:123], v2 offset:14336
v_cvt_pk_bf16_f32 v129, v130, v131
v_mfma_f32_16x16x32_bf16 v[152:155], a[92:95], v[100:103], v[152:155]
v_exp_f32 v9, v69
v_mfma_f32_16x16x32_bf16 v[156:159], a[92:95], v[108:111], v[156:159]
ds_read_b128 a[124:127], v2 offset:15360
v_add_f32 v27, v8, v9
v_mfma_f32_16x16x32_bf16 v[156:159], a[88:91], v[104:107], v[156:159]
buffer_load_dwordx4 v113, s[36:39], s81 offen offset:1024 lds
v_mfma_f32_16x16x32_bf16 v[160:163], a[96:99], v[96:99], v[160:163]
ds_read_b128 a[64:67], v2 offset:16384
v_cvt_pk_bf16_f32 v120, v8, v9
v_mfma_f32_16x16x32_bf16 v[160:163], a[100:103], v[100:103], v[160:163]
v_exp_f32 v10, v70
v_mfma_f32_16x16x32_bf16 v[164:167], a[100:103], v[108:111], v[164:167]
ds_read_b128 a[68:71], v2 offset:17408
v_add_f32 v27, v27, v10
v_mfma_f32_16x16x32_bf16 v[164:167], a[96:99], v[104:107], v[164:167]
s_waitcnt lgkmcnt(4)
buffer_load_dwordx4 v114, s[36:39], s81 offen offset:2048 lds
v_mfma_f32_16x16x32_bf16 v[168:171], a[104:107], v[96:99], v[168:171]
ds_read_b128 a[72:75], v2 offset:18432
v_cvt_pk_bf16_f32 v130, v136, v137
v_mfma_f32_16x16x32_bf16 v[168:171], a[108:111], v[100:103], v[168:171]
v_exp_f32 v11, v71
v_mfma_f32_16x16x32_bf16 v[172:175], a[108:111], v[108:111], v[172:175]
ds_read_b128 a[76:79], v2 offset:19456
v_add_f32 v27, v27, v11
v_mfma_f32_16x16x32_bf16 v[172:175], a[104:107], v[104:107], v[172:175]
buffer_load_dwordx4 v115, s[36:39], s81 offen offset:3072 lds
v_mfma_f32_16x16x32_bf16 v[176:179], a[112:115], v[96:99], v[176:179]
ds_read_b128 a[80:83], v2 offset:20480
v_cvt_pk_bf16_f32 v121, v10, v11
v_mfma_f32_16x16x32_bf16 v[176:179], a[116:119], v[100:103], v[176:179]
s_waitcnt lgkmcnt(4)
v_exp_f32 v12, v76
v_mfma_f32_16x16x32_bf16 v[180:183], a[116:119], v[108:111], v[180:183]
s_add_u32 s81, s81, 28672
ds_read_b128 a[84:87], v2 offset:21504
v_add_f32 v27, v27, v12
v_mfma_f32_16x16x32_bf16 v[180:183], a[112:115], v[104:107], v[180:183]
s_add_u32 m0, s18, 36864
v_exp_f32 v13, v77
v_mfma_f32_16x16x32_bf16 v[184:187], a[120:123], v[96:99], v[184:187]
ds_read_b128 a[88:91], v2 offset:22528
v_add_f32 v27, v27, v13
v_mfma_f32_16x16x32_bf16 v[184:187], a[124:127], v[100:103], v[184:187]
buffer_load_dwordx4 v112, s[36:39], s81 offen offset:0 lds
v_mfma_f32_16x16x32_bf16 v[188:191], a[124:127], v[108:111], v[188:191]
ds_read_b128 a[92:95], v2 offset:23552
v_cvt_pk_bf16_f32 v122, v12, v13
v_mfma_f32_16x16x32_bf16 v[188:191], a[120:123], v[104:107], v[188:191]
v_exp_f32 v14, v78
v_mfma_f32_16x16x32_bf16 v[192:195], a[64:67], v[96:99], v[192:195]
s_waitcnt lgkmcnt(4)
ds_read_b128 a[96:99], v2 offset:24576
v_add_f32 v27, v27, v14
v_mfma_f32_16x16x32_bf16 v[192:195], a[68:71], v[100:103], v[192:195]
buffer_load_dwordx4 v113, s[36:39], s81 offen offset:1024 lds
v_mfma_f32_16x16x32_bf16 v[196:199], a[68:71], v[108:111], v[196:199]
ds_read_b128 a[100:103], v2 offset:25600
v_cvt_pk_bf16_f32 v131, v138, v139
v_mfma_f32_16x16x32_bf16 v[196:199], a[64:67], v[104:107], v[196:199]
v_exp_f32 v15, v79
v_mfma_f32_16x16x32_bf16 v[200:203], a[72:75], v[96:99], v[200:203]
ds_read_b128 a[104:107], v2 offset:26624
v_add_f32 v27, v27, v15
v_mfma_f32_16x16x32_bf16 v[200:203], a[76:79], v[100:103], v[200:203]
buffer_load_dwordx4 v114, s[36:39], s81 offen offset:2048 lds
v_mfma_f32_16x16x32_bf16 v[204:207], a[76:79], v[108:111], v[204:207]
ds_read_b128 a[108:111], v2 offset:27648
v_cvt_pk_bf16_f32 v123, v14, v15
v_mfma_f32_16x16x32_bf16 v[204:207], a[72:75], v[104:107], v[204:207]
s_waitcnt lgkmcnt(4)
v_exp_f32 v8, v84
v_mfma_f32_16x16x32_bf16 v[208:211], a[80:83], v[96:99], v[208:211]
ds_read_b128 a[112:115], v2 offset:28672
v_add_f32 v27, v27, v8
v_mfma_f32_16x16x32_bf16 v[208:211], a[84:87], v[100:103], v[208:211]
buffer_load_dwordx4 v115, s[36:39], s81 offen offset:3072 lds
v_mfma_f32_16x16x32_bf16 v[212:215], a[84:87], v[108:111], v[212:215]
ds_read_b128 a[116:119], v2 offset:29696
v_cvt_pk_bf16_f32 v144, v144, v145
v_mfma_f32_16x16x32_bf16 v[212:215], a[80:83], v[104:107], v[212:215]
v_exp_f32 v9, v85
v_mfma_f32_16x16x32_bf16 v[216:219], a[88:91], v[96:99], v[216:219]
s_sub_u32 s81, s81, 28544
ds_read_b128 a[120:123], v2 offset:30720
v_add_f32 v27, v27, v9
v_mfma_f32_16x16x32_bf16 v[216:219], a[92:95], v[100:103], v[216:219]
v_exp_f32 v10, v86
v_mfma_f32_16x16x32_bf16 v[220:223], a[92:95], v[108:111], v[220:223]
s_waitcnt vmcnt(8) lgkmcnt(4)
ds_read_b128 a[124:127], v2 offset:31744
v_cvt_pk_bf16_f32 v124, v8, v9
v_mfma_f32_16x16x32_bf16 v[220:223], a[88:91], v[104:107], v[220:223]
s_barrier
v_mfma_f32_16x16x32_bf16 v[224:227], a[96:99], v[96:99], v[224:227]
ds_read_b128 a[64:67], v1 offset:0
v_add_f32 v27, v27, v10
v_mfma_f32_16x16x32_bf16 v[224:227], a[100:103], v[100:103], v[224:227]
v_exp_f32 v11, v87
v_mfma_f32_16x16x32_bf16 v[228:231], a[100:103], v[108:111], v[228:231]
ds_read_b128 a[68:71], v1 offset:1024
v_add_f32 v27, v27, v11
v_mfma_f32_16x16x32_bf16 v[228:231], a[96:99], v[104:107], v[228:231]
v_exp_f32 v12, v92
v_mfma_f32_16x16x32_bf16 v[232:235], a[104:107], v[96:99], v[232:235]
s_waitcnt lgkmcnt(4)
ds_read_b128 a[72:75], v1 offset:2048
v_cvt_pk_bf16_f32 v125, v10, v11
v_mfma_f32_16x16x32_bf16 v[232:235], a[108:111], v[100:103], v[232:235]
v_exp_f32 v13, v93
v_mfma_f32_16x16x32_bf16 v[236:239], a[108:111], v[108:111], v[236:239]
ds_read_b128 a[76:79], v1 offset:3072
v_add_f32 v27, v27, v12
v_mfma_f32_16x16x32_bf16 v[236:239], a[104:107], v[104:107], v[236:239]
v_exp_f32 v14, v94
v_mfma_f32_16x16x32_bf16 v[240:243], a[112:115], v[96:99], v[240:243]
ds_read_b128 a[80:83], v1 offset:4096
v_add_f32 v27, v27, v13
v_mfma_f32_16x16x32_bf16 v[240:243], a[116:119], v[100:103], v[240:243]
v_exp_f32 v15, v95
v_mfma_f32_16x16x32_bf16 v[244:247], a[116:119], v[108:111], v[244:247]
ds_read_b128 a[84:87], v1 offset:5120
v_cvt_pk_bf16_f32 v126, v12, v13
v_mfma_f32_16x16x32_bf16 v[244:247], a[112:115], v[104:107], v[244:247]
s_waitcnt lgkmcnt(4)
v_add_f32 v27, v27, v14
v_add_f32 v27, v27, v15
v_mfma_f32_16x16x32_bf16 v[248:251], a[120:123], v[96:99], v[248:251]
ds_read_b128 a[88:91], v1 offset:6144
v_cvt_pk_bf16_f32 v127, v14, v15
v_mfma_f32_16x16x32_bf16 v[248:251], a[124:127], v[100:103], v[248:251]
v_cmp_nge_f32 vcc, s25, v27
v_cvt_pk_bf16_f32 v145, v146, v147
v_mfma_f32_16x16x32_bf16 v[252:255], a[124:127], v[108:111], v[252:255]
ds_read_b128 a[92:95], v1 offset:7168
v_cvt_pk_bf16_f32 v146, v152, v153
v_mfma_f32_16x16x32_bf16 v[252:255], a[120:123], v[104:107], v[252:255]
s_waitcnt lgkmcnt(2)
v_cvt_pk_bf16_f32 v147, v154, v155
v_cvt_pk_bf16_f32 v160, v160, v161
s_cbranch_vccnz Lstub_12
Lback_13:
v_mfma_f32_16x16x32_bf16 v[132:135], a[64:67], v[120:123], v[132:135]
s_lshl_b32 s8, s29, 3
ds_read_b128 a[96:99], v1 offset:8192
v_add_f32 v25, v25, v27
v_mfma_f32_16x16x32_bf16 v[132:135], a[68:71], v[124:127], v[132:135]
s_add_u32 s8, s8, s3
ds_read_b128 a[100:103], v1 offset:9216
v_cvt_pk_bf16_f32 v161, v162, v163
v_mfma_f32_16x16x32_bf16 v[140:143], a[72:75], v[120:123], v[140:143]
s_lshl_b32 s8, s8, 4
ds_read_b128 a[104:107], v1 offset:10240
v_cvt_pk_bf16_f32 v162, v168, v169
v_mfma_f32_16x16x32_bf16 v[140:143], a[76:79], v[124:127], v[140:143]
s_add_u32 s8, s8, s20
ds_read_b128 a[108:111], v1 offset:11264
v_cvt_pk_bf16_f32 v163, v170, v171
v_mfma_f32_16x16x32_bf16 v[148:151], a[80:83], v[120:123], v[148:151]
s_mul_i32 s8, s8, 14336
ds_read_b128 a[112:115], v1 offset:12288
v_cvt_pk_bf16_f32 v176, v176, v177
v_mfma_f32_16x16x32_bf16 v[148:151], a[84:87], v[124:127], v[148:151]
s_waitcnt lgkmcnt(5)
s_add_u32 s8, s8, 104857600
ds_read_b128 a[116:119], v1 offset:13312
v_cvt_pk_bf16_f32 v177, v178, v179
v_mfma_f32_16x16x32_bf16 v[156:159], a[88:91], v[120:123], v[156:159]
s_add_u32 s12, s8, 917504
ds_read_b128 a[120:123], v1 offset:14336
v_cvt_pk_bf16_f32 v178, v184, v185
v_mfma_f32_16x16x32_bf16 v[156:159], a[92:95], v[124:127], v[156:159]
s_waitcnt lgkmcnt(6)
ds_read_b128 a[124:127], v1 offset:15360
v_cvt_pk_bf16_f32 v179, v186, v187
v_mfma_f32_16x16x32_bf16 v[164:167], a[96:99], v[120:123], v[164:167]
s_waitcnt lgkmcnt(6)
ds_read_b128 a[64:67], v1 offset:16384
v_cvt_pk_bf16_f32 v192, v192, v193
v_mfma_f32_16x16x32_bf16 v[164:167], a[100:103], v[124:127], v[164:167]
s_waitcnt lgkmcnt(6)
ds_read_b128 a[68:71], v1 offset:17408
v_cvt_pk_bf16_f32 v193, v194, v195
v_mfma_f32_16x16x32_bf16 v[172:175], a[104:107], v[120:123], v[172:175]
s_waitcnt lgkmcnt(6)
ds_read_b128 a[72:75], v1 offset:18432
v_cvt_pk_bf16_f32 v194, v200, v201
v_mfma_f32_16x16x32_bf16 v[172:175], a[108:111], v[124:127], v[172:175]
s_waitcnt lgkmcnt(6)
ds_read_b128 a[76:79], v1 offset:19456
v_cvt_pk_bf16_f32 v195, v202, v203
v_mfma_f32_16x16x32_bf16 v[180:183], a[112:115], v[120:123], v[180:183]
s_waitcnt lgkmcnt(6)
ds_read_b128 a[80:83], v1 offset:20480
v_cvt_pk_bf16_f32 v208, v208, v209
v_mfma_f32_16x16x32_bf16 v[180:183], a[116:119], v[124:127], v[180:183]
s_waitcnt lgkmcnt(6)
ds_read_b128 a[84:87], v1 offset:21504
v_cvt_pk_bf16_f32 v209, v210, v211
v_mfma_f32_16x16x32_bf16 v[188:191], a[120:123], v[120:123], v[188:191]
s_waitcnt lgkmcnt(6)
ds_read_b128 a[88:91], v1 offset:22528
v_cvt_pk_bf16_f32 v210, v216, v217
v_mfma_f32_16x16x32_bf16 v[188:191], a[124:127], v[124:127], v[188:191]
s_waitcnt lgkmcnt(6)
ds_read_b128 a[92:95], v1 offset:23552
v_cvt_pk_bf16_f32 v211, v218, v219
v_mfma_f32_16x16x32_bf16 v[196:199], a[64:67], v[120:123], v[196:199]
s_waitcnt lgkmcnt(6)
ds_read_b128 a[96:99], v1 offset:24576
v_cvt_pk_bf16_f32 v224, v224, v225
v_mfma_f32_16x16x32_bf16 v[196:199], a[68:71], v[124:127], v[196:199]
s_waitcnt lgkmcnt(6)
ds_read_b128 a[100:103], v1 offset:25600
v_cvt_pk_bf16_f32 v225, v226, v227
v_mfma_f32_16x16x32_bf16 v[204:207], a[72:75], v[120:123], v[204:207]
s_waitcnt lgkmcnt(6)
ds_read_b128 a[104:107], v1 offset:26624
v_cvt_pk_bf16_f32 v226, v232, v233
v_mfma_f32_16x16x32_bf16 v[204:207], a[76:79], v[124:127], v[204:207]
s_waitcnt lgkmcnt(6)
ds_read_b128 a[108:111], v1 offset:27648
v_cvt_pk_bf16_f32 v227, v234, v235
v_mfma_f32_16x16x32_bf16 v[212:215], a[80:83], v[120:123], v[212:215]
s_waitcnt lgkmcnt(6)
ds_read_b128 a[112:115], v1 offset:28672
v_cvt_pk_bf16_f32 v240, v240, v241
v_mfma_f32_16x16x32_bf16 v[212:215], a[84:87], v[124:127], v[212:215]
s_waitcnt lgkmcnt(5)
ds_read_b128 a[116:119], v1 offset:29696
v_cvt_pk_bf16_f32 v241, v242, v243
v_mfma_f32_16x16x32_bf16 v[220:223], a[88:91], v[120:123], v[220:223]
s_add_u32 m0, s18, 98304
ds_read_b128 a[120:123], v1 offset:30720
v_cvt_pk_bf16_f32 v242, v248, v249
v_mfma_f32_16x16x32_bf16 v[220:223], a[92:95], v[124:127], v[220:223]
s_waitcnt lgkmcnt(6)
ds_read_b128 a[124:127], v1 offset:31744
v_cvt_pk_bf16_f32 v243, v250, v251
v_mfma_f32_16x16x32_bf16 v[228:231], a[96:99], v[120:123], v[228:231]
s_waitcnt lgkmcnt(6)
buffer_load_dwordx4 v112, s[36:39], s81 offen offset:0 lds
v_mfma_f32_16x16x32_bf16 v[228:231], a[100:103], v[124:127], v[228:231]
s_waitcnt lgkmcnt(5)
buffer_load_dwordx4 v113, s[36:39], s81 offen offset:1024 lds
v_mfma_f32_16x16x32_bf16 v[236:239], a[104:107], v[120:123], v[236:239]
s_waitcnt lgkmcnt(4)
buffer_load_dwordx4 v114, s[36:39], s81 offen offset:2048 lds
v_mfma_f32_16x16x32_bf16 v[236:239], a[108:111], v[124:127], v[236:239]
s_waitcnt lgkmcnt(1)
buffer_load_dwordx4 v115, s[36:39], s81 offen offset:3072 lds
v_mfma_f32_16x16x32_bf16 v[244:247], a[112:115], v[120:123], v[244:247]
s_add_u32 s81, s81, 28672
v_cvt_pk_bf16_f32 v132, v132, v133
v_cvt_pk_bf16_f32 v133, v134, v135
v_mfma_f32_16x16x32_bf16 v[244:247], a[116:119], v[124:127], v[244:247]
s_add_u32 m0, s18, 102400
v_cvt_pk_bf16_f32 v134, v140, v141
v_cvt_pk_bf16_f32 v135, v142, v143
v_mfma_f32_16x16x32_bf16 v[252:255], a[120:123], v[120:123], v[252:255]
s_waitcnt lgkmcnt(0)
buffer_load_dwordx4 v112, s[36:39], s81 offen offset:0 lds
v_mfma_f32_16x16x32_bf16 v[252:255], a[124:127], v[124:127], v[252:255]
buffer_load_dwordx4 v113, s[36:39], s81 offen offset:1024 lds
buffer_load_dwordx4 v114, s[36:39], s81 offen offset:2048 lds
buffer_load_dwordx4 v115, s[36:39], s81 offen offset:3072 lds
s_sub_u32 s81, s81, 28544
s_add_u32 m0, s18, 131072
s_nop 0
buffer_load_dwordx4 v112, s[36:39], s81 offen offset:0 lds
v_cvt_pk_bf16_f32 v148, v148, v149
v_cvt_pk_bf16_f32 v149, v150, v151
v_cvt_pk_bf16_f32 v150, v156, v157
v_cvt_pk_bf16_f32 v151, v158, v159
buffer_load_dwordx4 v113, s[36:39], s81 offen offset:1024 lds
v_cvt_pk_bf16_f32 v164, v164, v165
v_cvt_pk_bf16_f32 v165, v166, v167
v_cvt_pk_bf16_f32 v166, v172, v173
v_cvt_pk_bf16_f32 v167, v174, v175
buffer_load_dwordx4 v114, s[36:39], s81 offen offset:2048 lds
v_cvt_pk_bf16_f32 v180, v180, v181
v_cvt_pk_bf16_f32 v181, v182, v183
v_cvt_pk_bf16_f32 v182, v188, v189
v_cvt_pk_bf16_f32 v183, v190, v191
buffer_load_dwordx4 v115, s[36:39], s81 offen offset:3072 lds
v_cvt_pk_bf16_f32 v196, v196, v197
v_cvt_pk_bf16_f32 v197, v198, v199
v_cvt_pk_bf16_f32 v198, v204, v205
v_cvt_pk_bf16_f32 v199, v206, v207
s_add_u32 s81, s81, 28672
s_add_u32 m0, s18, 135168
s_nop 0
buffer_load_dwordx4 v112, s[36:39], s81 offen offset:0 lds
v_cvt_pk_bf16_f32 v212, v212, v213
v_cvt_pk_bf16_f32 v213, v214, v215
v_cvt_pk_bf16_f32 v214, v220, v221
v_cvt_pk_bf16_f32 v215, v222, v223
buffer_load_dwordx4 v113, s[36:39], s81 offen offset:1024 lds
v_cvt_pk_bf16_f32 v228, v228, v229
v_cvt_pk_bf16_f32 v229, v230, v231
v_cvt_pk_bf16_f32 v230, v236, v237
v_cvt_pk_bf16_f32 v231, v238, v239
buffer_load_dwordx4 v114, s[36:39], s81 offen offset:2048 lds
v_cvt_pk_bf16_f32 v244, v244, v245
v_cvt_pk_bf16_f32 v245, v246, v247
v_cvt_pk_bf16_f32 v246, v252, v253
v_cvt_pk_bf16_f32 v247, v254, v255
buffer_load_dwordx4 v115, s[36:39], s81 offen offset:3072 lds
s_sub_u32 s81, s81, 28544
s_branch K2_done
K2_cfix:
s_nop 7
v_max_f32 v12, 0, v8
v_exp_f32 v13, -v12
v_sub_f32 v8, v8, v12
v_mul_f32 v24, v24, v13
v_mul_f32 v128, v128, v13
v_mul_f32 v129, v129, v13
v_mul_f32 v130, v130, v13
v_mul_f32 v131, v131, v13
v_mul_f32 v136, v136, v13
v_mul_f32 v137, v137, v13
v_mul_f32 v138, v138, v13
v_mul_f32 v139, v139, v13
v_mul_f32 v144, v144, v13
v_mul_f32 v145, v145, v13
v_mul_f32 v146, v146, v13
v_mul_f32 v147, v147, v13
v_mul_f32 v152, v152, v13
v_mul_f32 v153, v153, v13
v_mul_f32 v154, v154, v13
v_mul_f32 v155, v155, v13
v_mul_f32 v160, v160, v13
v_mul_f32 v161, v161, v13
v_mul_f32 v162, v162, v13
v_mul_f32 v163, v163, v13
v_mul_f32 v168, v168, v13
v_mul_f32 v169, v169, v13
v_mul_f32 v170, v170, v13
v_mul_f32 v171, v171, v13
v_mul_f32 v176, v176, v13
v_mul_f32 v177, v177, v13
v_mul_f32 v178, v178, v13
v_mul_f32 v179, v179, v13
v_mul_f32 v184, v184, v13
v_mul_f32 v185, v185, v13
v_mul_f32 v186, v186, v13
v_mul_f32 v187, v187, v13
v_mul_f32 v192, v192, v13
v_mul_f32 v193, v193, v13
v_mul_f32 v194, v194, v13
v_mul_f32 v195, v195, v13
v_mul_f32 v200, v200, v13
v_mul_f32 v201, v201, v13
v_mul_f32 v202, v202, v13
v_mul_f32 v203, v203, v13
v_mul_f32 v208, v208, v13
v_mul_f32 v209, v209, v13
v_mul_f32 v210, v210, v13
v_mul_f32 v211, v211, v13
v_mul_f32 v216, v216, v13
v_mul_f32 v217, v217, v13
v_mul_f32 v218, v218, v13
v_mul_f32 v219, v219, v13
v_mul_f32 v224, v224, v13
v_mul_f32 v225, v225, v13
v_mul_f32 v226, v226, v13
v_mul_f32 v227, v227, v13
v_mul_f32 v232, v232, v13
v_mul_f32 v233, v233, v13
v_mul_f32 v234, v234, v13
v_mul_f32 v235, v235, v13
v_mul_f32 v240, v240, v13
v_mul_f32 v241, v241, v13
v_mul_f32 v242, v242, v13
v_mul_f32 v243, v243, v13
v_mul_f32 v248, v248, v13
v_mul_f32 v249, v249, v13
v_mul_f32 v250, v250, v13
v_mul_f32 v251, v251, v13
v_max_f32 v12, 0, v10
v_exp_f32 v13, -v12
v_sub_f32 v10, v10, v12
v_mul_f32 v25, v25, v13
v_mul_f32 v132, v132, v13
v_mul_f32 v133, v133, v13
v_mul_f32 v134, v134, v13
v_mul_f32 v135, v135, v13
v_mul_f32 v140, v140, v13
v_mul_f32 v141, v141, v13
v_mul_f32 v142, v142, v13
v_mul_f32 v143, v143, v13
v_mul_f32 v148, v148, v13
v_mul_f32 v149, v149, v13
v_mul_f32 v150, v150, v13
v_mul_f32 v151, v151, v13
v_mul_f32 v156, v156, v13
v_mul_f32 v157, v157, v13
v_mul_f32 v158, v158, v13
v_mul_f32 v159, v159, v13
v_mul_f32 v164, v164, v13
v_mul_f32 v165, v165, v13
v_mul_f32 v166, v166, v13
v_mul_f32 v167, v167, v13
v_mul_f32 v172, v172, v13
v_mul_f32 v173, v173, v13
v_mul_f32 v174, v174, v13
v_mul_f32 v175, v175, v13
v_mul_f32 v180, v180, v13
v_mul_f32 v181, v181, v13
v_mul_f32 v182, v182, v13
v_mul_f32 v183, v183, v13
v_mul_f32 v188, v188, v13
v_mul_f32 v189, v189, v13
v_mul_f32 v190, v190, v13
v_mul_f32 v191, v191, v13
v_mul_f32 v196, v196, v13
v_mul_f32 v197, v197, v13
v_mul_f32 v198, v198, v13
v_mul_f32 v199, v199, v13
v_mul_f32 v204, v204, v13
v_mul_f32 v205, v205, v13
v_mul_f32 v206, v206, v13
v_mul_f32 v207, v207, v13
v_mul_f32 v212, v212, v13
v_mul_f32 v213, v213, v13
v_mul_f32 v214, v214, v13
v_mul_f32 v215, v215, v13
v_mul_f32 v220, v220, v13
v_mul_f32 v221, v221, v13
v_mul_f32 v222, v222, v13
v_mul_f32 v223, v223, v13
v_mul_f32 v228, v228, v13
v_mul_f32 v229, v229, v13
v_mul_f32 v230, v230, v13
v_mul_f32 v231, v231, v13
v_mul_f32 v236, v236, v13
v_mul_f32 v237, v237, v13
v_mul_f32 v238, v238, v13
v_mul_f32 v239, v239, v13
v_mul_f32 v244, v244, v13
v_mul_f32 v245, v245, v13
v_mul_f32 v246, v246, v13
v_mul_f32 v247, v247, v13
v_mul_f32 v252, v252, v13
v_mul_f32 v253, v253, v13
v_mul_f32 v254, v254, v13
v_mul_f32 v255, v255, v13
s_branch K2_cok
K2_tspin:
Lp_9101:
buffer_load_dword v3, off, s[4:7], s80 sc1
s_waitcnt vmcnt(0)
v_cmp_gt_u32 vcc, 1, v3
s_cbranch_vccz Lpd_9102
s_sleep 8
s_sub_u32 s101, s101, 1
s_cbranch_scc0 Lp_9101
s_mov_b32 s101, 0
Lpd_9102:
s_branch K2_tok
K2_p0d:
ds_read_b128 a[64:67], v1 offset:0
ds_read_b128 a[68:71], v1 offset:1024
ds_read_b128 a[72:75], v1 offset:2048
ds_read_b128 a[76:79], v1 offset:3072
ds_read_b128 a[80:83], v1 offset:4096
ds_read_b128 a[84:87], v1 offset:5120
ds_read_b128 a[88:91], v1 offset:6144
ds_read_b128 a[92:95], v1 offset:7168
v_cndmask_b32 v32, 0, v7, s[32:33]
v_cndmask_b32 v33, 0, v7, s[34:35]
v_cndmask_b32 v34, 0, v7, s[36:37]
v_cndmask_b32 v35, 0, v7, s[38:39]
v_cndmask_b32 v40, 0, v7, s[40:41]
v_cndmask_b32 v41, 0, v7, s[42:43]
v_cndmask_b32 v42, 0, v7, s[44:45]
v_cndmask_b32 v43, 0, v7, s[46:47]
s_waitcnt lgkmcnt(7)
v_mfma_f32_16x16x32_bf16 v[32:35], a[64:67], a[0:3], v[32:35]
s_waitcnt lgkmcnt(6)
s_add_u32 m0, s18, 65536
ds_read_b128 a[96:99], v1 offset:8192
v_mfma_f32_16x16x32_bf16 v[32:35], a[68:71], a[4:7], v[32:35]
s_waitcnt lgkmcnt(6)
buffer_load_dwordx4 v1, s[4:7], s12 offen offset:0 sc1 lds
v_mfma_f32_16x16x32_bf16 v[32:35], a[72:75], a[8:11], v[32:35]
s_waitcnt lgkmcnt(5)
ds_read_b128 a[100:103], v1 offset:9216
v_mfma_f32_16x16x32_bf16 v[32:35], a[76:79], a[12:15], v[32:35]
s_waitcnt lgkmcnt(5)
buffer_load_dwordx4 v1, s[4:7], s12 offen offset:1024 sc1 lds
v_mfma_f32_16x16x32_bf16 v[32:35], a[80:83], a[16:19], v[32:35]
s_waitcnt lgkmcnt(4)
ds_read_b128 a[104:107], v1 offset:10240
v_mfma_f32_16x16x32_bf16 v[32:35], a[84:87], a[20:23], v[32:35]
s_waitcnt lgkmcnt(4)
buffer_load_dwordx4 v1, s[4:7], s12 offen offset:2048 sc1 lds
v_mfma_f32_16x16x32_bf16 v[32:35], a[88:91], a[24:27], v[32:35]
s_waitcnt lgkmcnt(3)
ds_read_b128 a[108:111], v1 offset:11264
v_mfma_f32_16x16x32_bf16 v[32:35], a[92:95], a[28:31], v[32:35]
buffer_load_dwordx4 v1, s[4:7], s12 offen offset:3072 sc1 lds
v_mfma_f32_16x16x32_bf16 v[36:39], a[64:67], a[32:35], 0
s_add_u32 s12, s12, 4096
s_add_u32 m0, s18, 69632
ds_read_b128 a[112:115], v1 offset:12288
v_mfma_f32_16x16x32_bf16 v[36:39], a[68:71], a[36:39], v[36:39]
buffer_load_dwordx4 v1, s[4:7], s12 offen offset:0 sc1 lds
v_mfma_f32_16x16x32_bf16 v[36:39], a[72:75], a[40:43], v[36:39]
ds_read_b128 a[116:119], v1 offset:13312
v_mfma_f32_16x16x32_bf16 v[36:39], a[76:79], a[44:47], v[36:39]
buffer_load_dwordx4 v1, s[4:7], s12 offen offset:1024 sc1 lds
v_mfma_f32_16x16x32_bf16 v[36:39], a[80:83], a[48:51], v[36:39]
ds_read_b128 a[120:123], v1 offset:14336
v_max3_f32 v28, v32, v33, v34
v_mfma_f32_16x16x32_bf16 v[36:39], a[84:87], a[52:55], v[36:39]
buffer_load_dwordx4 v1, s[4:7], s12 offen offset:2048 sc1 lds
v_mfma_f32_16x16x32_bf16 v[36:39], a[88:91], a[56:59], v[36:39]
ds_read_b128 a[124:127], v1 offset:15360
v_max_f32 v28, v28, v35
v_mfma_f32_16x16x32_bf16 v[36:39], a[92:95], a[60:63], v[36:39]
s_waitcnt lgkmcnt(4)
buffer_load_dwordx4 v1, s[4:7], s12 offen offset:3072 sc1 lds
v_mfma_f32_16x16x32_bf16 v[40:43], a[96:99], a[0:3], v[40:43]
s_add_u32 s12, s12, 28672
ds_read_b128 a[64:67], v1 offset:16384
v_mov_b32 v30, v28
v_mfma_f32_16x16x32_bf16 v[40:43], a[100:103], a[4:7], v[40:43]
s_waitcnt lgkmcnt(2)
s_sub_u32 s13, s13, 1
v_mfma_f32_16x16x32_bf16 v[40:43], a[104:107], a[8:11], v[40:43]
s_cmp_eq_u32 s13, 0
ds_read_b128 a[68:71], v1 offset:17408
v_permlane16_swap_b32 v28, v30
v_mfma_f32_16x16x32_bf16 v[40:43], a[108:111], a[12:15], v[40:43]
s_cselect_b32 s12, s14, s12
v_max_f32 v28, v28, v30
v_mov_b32 v30, v28
v_mfma_f32_16x16x32_bf16 v[40:43], a[112:115], a[16:19], v[40:43]
s_cselect_b32 s13, s15, s13
ds_read_b128 a[72:75], v1 offset:18432
v_max3_f32 v29, v36, v37, v38
v_mfma_f32_16x16x32_bf16 v[40:43], a[116:119], a[20:23], v[40:43]
s_cselect_b32 s14, 3221225472, s14
v_permlane32_swap_b32 v28, v30
v_max_f32 v28, v28, v30
v_mfma_f32_16x16x32_bf16 v[40:43], a[120:123], a[24:27], v[40:43]
s_waitcnt lgkmcnt(3)
ds_read_b128 a[76:79], v1 offset:19456
v_sub_f32 v16, 0, v28
v_mfma_f32_16x16x32_bf16 v[40:43], a[124:127], a[28:31], v[40:43]
v_sub_f32 v17, 0, v28
v_sub_f32 v18, 0, v28
v_mfma_f32_16x16x32_bf16 v[44:47], a[96:99], a[32:35], 0
ds_read_b128 a[80:83], v1 offset:20480
v_sub_f32 v19, 0, v28
v_mfma_f32_16x16x32_bf16 v[44:47], a[100:103], a[36:39], v[44:47]
v_max_f32 v29, v29, v39
v_mov_b32 v31, v29
v_cndmask_b32 v48, v16, v7, s[48:49]
v_mfma_f32_16x16x32_bf16 v[44:47], a[104:107], a[40:43], v[44:47]
ds_read_b128 a[84:87], v1 offset:21504
v_cndmask_b32 v49, v16, v7, s[50:51]
v_mfma_f32_16x16x32_bf16 v[44:47], a[108:111], a[44:47], v[44:47]
v_permlane16_swap_b32 v29, v31
v_max_f32 v29, v29, v31
v_cndmask_b32 v50, v16, v7, s[52:53]
v_mfma_f32_16x16x32_bf16 v[44:47], a[112:115], a[48:51], v[44:47]
ds_read_b128 a[88:91], v1 offset:22528
v_mov_b32 v31, v29
v_cndmask_b32 v51, v16, v7, s[54:55]
v_mfma_f32_16x16x32_bf16 v[44:47], a[116:119], a[52:55], v[44:47]
v_cndmask_b32 v56, v16, v7, s[56:57]
v_cndmask_b32 v57, v16, v7, s[58:59]
v_mfma_f32_16x16x32_bf16 v[44:47], a[120:123], a[56:59], v[44:47]
ds_read_b128 a[92:95], v1 offset:23552
v_permlane32_swap_b32 v29, v31
v_mfma_f32_16x16x32_bf16 v[44:47], a[124:127], a[60:63], v[44:47]
s_waitcnt lgkmcnt(4)
v_max_f32 v29, v29, v31
v_sub_f32 v20, 0, v29
v_mfma_f32_16x16x32_bf16 v[48:51], a[64:67], a[0:3], v[48:51]
ds_read_b128 a[96:99], v1 offset:24576
v_sub_f32 v21, 0, v29
v_mfma_f32_16x16x32_bf16 v[48:51], a[68:71], a[4:7], v[48:51]
v_sub_f32 v22, 0, v29
v_sub_f32 v23, 0, v29
v_mfma_f32_16x16x32_bf16 v[48:51], a[72:75], a[8:11], v[48:51]
ds_read_b128 a[100:103], v1 offset:25600
v_cndmask_b32 v58, v16, v7, s[60:61]
v_mfma_f32_16x16x32_bf16 v[48:51], a[76:79], a[12:15], v[48:51]
s_waitcnt lgkmcnt(4)
v_cndmask_b32 v59, v16, v7, s[62:63]
v_mfma_f32_16x16x32_bf16 v[48:51], a[80:83], a[16:19], v[48:51]
ds_read_b128 a[104:107], v1 offset:26624
v_mfma_f32_16x16x32_bf16 v[48:51], a[84:87], a[20:23], v[48:51]
s_waitcnt lgkmcnt(4)
v_add_f32 v32, v32, v16
v_add_f32 v33, v33, v16
v_add_f32 v34, v34, v16
v_add_f32 v35, v35, v16
v_mfma_f32_16x16x32_bf16 v[48:51], a[88:91], a[24:27], v[48:51]
s_waitcnt lgkmcnt(3)
ds_read_b128 a[108:111], v1 offset:27648
v_add_f32 v36, v36, v20
v_add_f32 v37, v37, v20
v_add_f32 v38, v38, v20
v_add_f32 v39, v39, v20
v_mfma_f32_16x16x32_bf16 v[48:51], a[92:95], a[28:31], v[48:51]
v_add_f32 v40, v40, v16
v_add_f32 v41, v41, v16
v_add_f32 v42, v42, v16
v_add_f32 v43, v43, v16
v_mfma_f32_16x16x32_bf16 v[52:55], a[64:67], a[32:35], v[20:23]
ds_read_b128 a[112:115], v1 offset:28672
v_add_f32 v44, v44, v20
v_add_f32 v45, v45, v20
v_add_f32 v46, v46, v20
v_add_f32 v47, v47, v20
v_mfma_f32_16x16x32_bf16 v[52:55], a[68:71], a[36:39], v[52:55]
v_exp_f32 v8, v32
v_mfma_f32_16x16x32_bf16 v[52:55], a[72:75], a[40:43], v[52:55]
ds_read_b128 a[116:119], v1 offset:29696
v_exp_f32 v9, v33
v_mfma_f32_16x16x32_bf16 v[52:55], a[76:79], a[44:47], v[52:55]
v_exp_f32 v10, v34
v_add_f32 v26, v8, v9
v_cvt_pk_bf16_f32 v96, v8, v9
v_mfma_f32_16x16x32_bf16 v[52:55], a[80:83], a[48:51], v[52:55]
ds_read_b128 a[120:123], v1 offset:30720
v_exp_f32 v11, v35
v_add_f32 v26, v26, v10
v_mfma_f32_16x16x32_bf16 v[52:55], a[84:87], a[52:55], v[52:55]
v_exp_f32 v12, v36
v_add_f32 v26, v26, v11
v_cvt_pk_bf16_f32 v97, v10, v11
v_mfma_f32_16x16x32_bf16 v[52:55], a[88:91], a[56:59], v[52:55]
s_waitcnt vmcnt(8) lgkmcnt(4)
ds_read_b128 a[124:127], v1 offset:31744
v_exp_f32 v13, v37
v_mfma_f32_16x16x32_bf16 v[52:55], a[92:95], a[60:63], v[52:55]
s_barrier
v_mfma_f32_16x16x32_bf16 v[56:59], a[96:99], a[0:3], v[56:59]
ds_read_b128 a[64:67], v4 offset:0
v_exp_f32 v14, v38
v_mfma_f32_16x16x32_bf16 v[56:59], a[100:103], a[4:7], v[56:59]
buffer_store_dword v6, v5, s[4:7], s71 offen sc1
v_mfma_f32_16x16x32_bf16 v[56:59], a[104:107], a[8:11], v[56:59]
s_waitcnt lgkmcnt(4)
ds_read_b128 a[68:71], v4 offset:1024
v_add_f32 v27, v12, v13
v_cvt_pk_bf16_f32 v104, v12, v13
v_add_f32 v27, v27, v14
v_mfma_f32_16x16x32_bf16 v[56:59], a[108:111], a[12:15], v[56:59]
v_exp_f32 v15, v39
v_mfma_f32_16x16x32_bf16 v[56:59], a[112:115], a[16:19], v[56:59]
s_waitcnt lgkmcnt(4)
ds_read_b128 a[72:75], v4 offset:2048
v_exp_f32 v8, v40
v_add_f32 v27, v27, v15
v_cvt_pk_bf16_f32 v105, v14, v15
v_mfma_f32_16x16x32_bf16 v[56:59], a[116:119], a[20:23], v[56:59]
s_waitcnt lgkmcnt(4)
v_exp_f32 v9, v41
v_add_f32 v26, v26, v8
v_mfma_f32_16x16x32_bf16 v[56:59], a[120:123], a[24:27], v[56:59]
s_waitcnt lgkmcnt(3)
ds_read_b128 a[76:79], v4 offset:3072
v_exp_f32 v10, v42
v_add_f32 v26, v26, v9
v_cvt_pk_bf16_f32 v98, v8, v9
v_mfma_f32_16x16x32_bf16 v[56:59], a[124:127], a[28:31], v[56:59]
v_exp_f32 v11, v43
v_add_f32 v26, v26, v10
v_mfma_f32_16x16x32_bf16 v[60:63], a[96:99], a[32:35], v[20:23]
ds_read_b128 a[80:83], v4 offset:4096
v_exp_f32 v12, v44
v_mfma_f32_16x16x32_bf16 v[60:63], a[100:103], a[36:39], v[60:63]
v_exp_f32 v13, v45
v_mfma_f32_16x16x32_bf16 v[60:63], a[104:107], a[40:43], v[60:63]
ds_read_b128 a[84:87], v4 offset:5120
v_exp_f32 v14, v46
v_mfma_f32_16x16x32_bf16 v[60:63], a[108:111], a[44:47], v[60:63]
v_exp_f32 v15, v47
v_mfma_f32_16x16x32_bf16 v[60:63], a[112:115], a[48:51], v[60:63]
ds_read_b128 a[88:91], v4 offset:6144
v_add_f32 v26, v26, v11
v_cvt_pk_bf16_f32 v99, v10, v11
v_mfma_f32_16x16x32_bf16 v[60:63], a[116:119], a[52:55], v[60:63]
v_add_f32 v27, v27, v12
v_add_f32 v27, v27, v13
v_cvt_pk_bf16_f32 v106, v12, v13
v_mfma_f32_16x16x32_bf16 v[60:63], a[120:123], a[56:59], v[60:63]
s_waitcnt lgkmcnt(7)
s_barrier
ds_read_b128 a[92:95], v4 offset:7168
v_mfma_f32_16x16x32_bf16 v[60:63], a[124:127], a[60:63], v[60:63]
s_waitcnt lgkmcnt(4)
v_add_f32 v27, v27, v14
v_add_f32 v27, v27, v15
v_cvt_pk_bf16_f32 v107, v14, v15
s_branch K2_dx1
K2_ntail:
PAD_33:
s_cbranch_execz M_tret
v_mfma_f32_16x16x32_bf16 v[128:131], a[64:67], v[96:99], v[128:131]
s_add_u32 m0, s18, 98304
ds_read_b128 a[96:99], v2 offset:8192
v_add_f32 v24, v24, v26
v_mfma_f32_16x16x32_bf16 v[128:131], a[68:71], v[100:103], v[128:131]
buffer_load_dwordx4 v1, s[4:7], s12 offen offset:0 sc1 lds
v_mfma_f32_16x16x32_bf16 v[132:135], a[68:71], v[108:111], v[132:135]
ds_read_b128 a[100:103], v2 offset:9216
v_add_f32 v25, v25, v27
v_mfma_f32_16x16x32_bf16 v[132:135], a[64:67], v[104:107], v[132:135]
buffer_load_dwordx4 v1, s[4:7], s12 offen offset:1024 sc1 lds
v_mfma_f32_16x16x32_bf16 v[136:139], a[72:75], v[96:99], v[136:139]
ds_read_b128 a[104:107], v2 offset:10240
v_exp_f32 v8, v64
v_mfma_f32_16x16x32_bf16 v[136:139], a[76:79], v[100:103], v[136:139]
buffer_load_dwordx4 v1, s[4:7], s12 offen offset:2048 sc1 lds
v_mfma_f32_16x16x32_bf16 v[140:143], a[76:79], v[108:111], v[140:143]
ds_read_b128 a[108:111], v2 offset:11264
v_mfma_f32_16x16x32_bf16 v[140:143], a[72:75], v[104:107], v[140:143]
s_waitcnt lgkmcnt(4)
buffer_load_dwordx4 v1, s[4:7], s12 offen offset:3072 sc1 lds
v_mfma_f32_16x16x32_bf16 v[144:147], a[80:83], v[96:99], v[144:147]
s_add_u32 s12, s12, 4096
s_add_u32 m0, s18, 102400
ds_read_b128 a[112:115], v2 offset:12288
v_mfma_f32_16x16x32_bf16 v[144:147], a[84:87], v[100:103], v[144:147]
buffer_load_dwordx4 v1, s[4:7], s12 offen offset:0 sc1 lds
v_mfma_f32_16x16x32_bf16 v[148:151], a[84:87], v[108:111], v[148:151]
ds_read_b128 a[116:119], v2 offset:13312
v_exp_f32 v9, v65
v_mfma_f32_16x16x32_bf16 v[148:151], a[80:83], v[104:107], v[148:151]
buffer_load_dwordx4 v1, s[4:7], s12 offen offset:1024 sc1 lds
v_mfma_f32_16x16x32_bf16 v[152:155], a[88:91], v[96:99], v[152:155]
ds_read_b128 a[120:123], v2 offset:14336
v_add_f32 v26, v8, v9
v_cvt_pk_bf16_f32 v112, v8, v9
v_mfma_f32_16x16x32_bf16 v[152:155], a[92:95], v[100:103], v[152:155]
buffer_load_dwordx4 v1, s[4:7], s12 offen offset:2048 sc1 lds
v_mfma_f32_16x16x32_bf16 v[156:159], a[92:95], v[108:111], v[156:159]
ds_read_b128 a[124:127], v2 offset:15360
v_exp_f32 v10, v66
v_mfma_f32_16x16x32_bf16 v[156:159], a[88:91], v[104:107], v[156:159]
s_waitcnt lgkmcnt(4)
buffer_load_dwordx4 v1, s[4:7], s12 offen offset:3072 sc1 lds
v_mfma_f32_16x16x32_bf16 v[160:163], a[96:99], v[96:99], v[160:163]
s_add_u32 s12, s12, 28672
ds_read_b128 a[64:67], v2 offset:16384
v_add_f32 v26, v26, v10
v_mfma_f32_16x16x32_bf16 v[160:163], a[100:103], v[100:103], v[160:163]
s_sub_u32 s13, s13, 1
v_exp_f32 v11, v67
v_mfma_f32_16x16x32_bf16 v[164:167], a[100:103], v[108:111], v[164:167]
s_cmp_eq_u32 s13, 0
ds_read_b128 a[68:71], v2 offset:17408
v_exp_f32 v12, v68
v_mfma_f32_16x16x32_bf16 v[164:167], a[96:99], v[104:107], v[164:167]
s_cselect_b32 s12, s14, s12
v_exp_f32 v13, v69
v_mfma_f32_16x16x32_bf16 v[168:171], a[104:107], v[96:99], v[168:171]
s_cselect_b32 s13, s15, s13
ds_read_b128 a[72:75], v2 offset:18432
v_add_f32 v26, v26, v11
v_cvt_pk_bf16_f32 v113, v10, v11
v_mfma_f32_16x16x32_bf16 v[168:171], a[108:111], v[100:103], v[168:171]
s_cselect_b32 s14, 3221225472, s14
v_exp_f32 v14, v70
v_mfma_f32_16x16x32_bf16 v[172:175], a[108:111], v[108:111], v[172:175]
ds_read_b128 a[76:79], v2 offset:19456
v_exp_f32 v15, v71
v_mfma_f32_16x16x32_bf16 v[172:175], a[104:107], v[104:107], v[172:175]
s_waitcnt lgkmcnt(4)
v_exp_f32 v8, v72
v_mfma_f32_16x16x32_bf16 v[176:179], a[112:115], v[96:99], v[176:179]
ds_read_b128 a[80:83], v2 offset:20480
v_add_f32 v27, v12, v13
v_cvt_pk_bf16_f32 v120, v12, v13
v_add_f32 v27, v27, v14
v_add_f32 v27, v27, v15
v_cvt_pk_bf16_f32 v121, v14, v15
v_mfma_f32_16x16x32_bf16 v[176:179], a[116:119], v[100:103], v[176:179]
v_exp_f32 v9, v73
v_mfma_f32_16x16x32_bf16 v[180:183], a[116:119], v[108:111], v[180:183]
ds_read_b128 a[84:87], v2 offset:21504
v_exp_f32 v10, v74
v_mfma_f32_16x16x32_bf16 v[180:183], a[112:115], v[104:107], v[180:183]
v_exp_f32 v11, v75
v_mfma_f32_16x16x32_bf16 v[184:187], a[120:123], v[96:99], v[184:187]
ds_read_b128 a[88:91], v2 offset:22528
v_add_f32 v26, v26, v8
v_mfma_f32_16x16x32_bf16 v[184:187], a[124:127], v[100:103], v[184:187]
v_exp_f32 v12, v76
v_mfma_f32_16x16x32_bf16 v[188:191], a[124:127], v[108:111], v[188:191]
ds_read_b128 a[92:95], v2 offset:23552
v_add_f32 v26, v26, v9
v_cvt_pk_bf16_f32 v114, v8, v9
v_add_f32 v26, v26, v10
v_add_f32 v26, v26, v11
v_cvt_pk_bf16_f32 v115, v10, v11
v_mfma_f32_16x16x32_bf16 v[188:191], a[120:123], v[104:107], v[188:191]
s_waitcnt lgkmcnt(4)
v_exp_f32 v13, v77
v_mfma_f32_16x16x32_bf16 v[192:195], a[64:67], v[96:99], v[192:195]
ds_read_b128 a[96:99], v2 offset:24576
v_exp_f32 v14, v78
v_mfma_f32_16x16x32_bf16 v[192:195], a[68:71], v[100:103], v[192:195]
v_exp_f32 v15, v79
v_mfma_f32_16x16x32_bf16 v[196:199], a[68:71], v[108:111], v[196:199]
ds_read_b128 a[100:103], v2 offset:25600
v_add_f32 v27, v27, v12
v_add_f32 v27, v27, v13
v_cvt_pk_bf16_f32 v122, v12, v13
v_add_f32 v27, v27, v14
v_mfma_f32_16x16x32_bf16 v[196:199], a[64:67], v[104:107], v[196:199]
v_exp_f32 v8, v80
v_mfma_f32_16x16x32_bf16 v[200:203], a[72:75], v[96:99], v[200:203]
ds_read_b128 a[104:107], v2 offset:26624
v_exp_f32 v9, v81
v_mfma_f32_16x16x32_bf16 v[200:203], a[76:79], v[100:103], v[200:203]
v_exp_f32 v10, v82
v_mfma_f32_16x16x32_bf16 v[204:207], a[76:79], v[108:111], v[204:207]
ds_read_b128 a[108:111], v2 offset:27648
v_add_f32 v27, v27, v15
v_cvt_pk_bf16_f32 v123, v14, v15
v_add_f32 v26, v26, v8
v_add_f32 v26, v26, v9
v_cvt_pk_bf16_f32 v116, v8, v9
v_mfma_f32_16x16x32_bf16 v[204:207], a[72:75], v[104:107], v[204:207]
s_waitcnt lgkmcnt(4)
v_exp_f32 v11, v83
v_mfma_f32_16x16x32_bf16 v[208:211], a[80:83], v[96:99], v[208:211]
ds_read_b128 a[112:115], v2 offset:28672
v_exp_f32 v12, v84
v_mfma_f32_16x16x32_bf16 v[208:211], a[84:87], v[100:103], v[208:211]
v_exp_f32 v13, v85
v_mfma_f32_16x16x32_bf16 v[212:215], a[84:87], v[108:111], v[212:215]
ds_read_b128 a[116:119], v2 offset:29696
v_add_f32 v26, v26, v10
v_add_f32 v26, v26, v11
v_cvt_pk_bf16_f32 v117, v10, v11
v_add_f32 v27, v27, v12
v_mfma_f32_16x16x32_bf16 v[212:215], a[80:83], v[104:107], v[212:215]
v_exp_f32 v14, v86
v_mfma_f32_16x16x32_bf16 v[216:219], a[88:91], v[96:99], v[216:219]
ds_read_b128 a[120:123], v2 offset:30720
v_exp_f32 v15, v87
v_mfma_f32_16x16x32_bf16 v[216:219], a[92:95], v[100:103], v[216:219]
v_exp_f32 v8, v88
v_mfma_f32_16x16x32_bf16 v[220:223], a[92:95], v[108:111], v[220:223]
s_waitcnt vmcnt(0) lgkmcnt(4)
ds_read_b128 a[124:127], v2 offset:31744
v_add_f32 v27, v27, v13
v_cvt_pk_bf16_f32 v124, v12, v13
v_add_f32 v27, v27, v14
v_add_f32 v27, v27, v15
v_cvt_pk_bf16_f32 v125, v14, v15
v_mfma_f32_16x16x32_bf16 v[220:223], a[88:91], v[104:107], v[220:223]
s_barrier
v_mfma_f32_16x16x32_bf16 v[224:227], a[96:99], v[96:99], v[224:227]
ds_read_b128 a[64:67], v2 offset:32768
v_exp_f32 v9, v89
v_mfma_f32_16x16x32_bf16 v[224:227], a[100:103], v[100:103], v[224:227]
v_exp_f32 v10, v90
v_mfma_f32_16x16x32_bf16 v[228:231], a[100:103], v[108:111], v[228:231]
ds_read_b128 a[68:71], v2 offset:33792
v_add_f32 v26, v26, v8
v_add_f32 v26, v26, v9
v_cvt_pk_bf16_f32 v118, v8, v9
v_mfma_f32_16x16x32_bf16 v[228:231], a[96:99], v[104:107], v[228:231]
v_exp_f32 v11, v91
v_mfma_f32_16x16x32_bf16 v[232:235], a[104:107], v[96:99], v[232:235]
s_waitcnt lgkmcnt(4)
ds_read_b128 a[72:75], v2 offset:34816
v_exp_f32 v12, v92
v_mfma_f32_16x16x32_bf16 v[232:235], a[108:111], v[100:103], v[232:235]
v_exp_f32 v13, v93
v_mfma_f32_16x16x32_bf16 v[236:239], a[108:111], v[108:111], v[236:239]
ds_read_b128 a[76:79], v2 offset:35840
v_add_f32 v26, v26, v10
v_mfma_f32_16x16x32_bf16 v[236:239], a[104:107], v[104:107], v[236:239]
v_exp_f32 v14, v94
v_mfma_f32_16x16x32_bf16 v[240:243], a[112:115], v[96:99], v[240:243]
ds_read_b128 a[80:83], v2 offset:36864
v_add_f32 v26, v26, v11
v_cvt_pk_bf16_f32 v119, v10, v11
v_add_f32 v27, v27, v12
v_mfma_f32_16x16x32_bf16 v[240:243], a[116:119], v[100:103], v[240:243]
v_exp_f32 v15, v95
v_mfma_f32_16x16x32_bf16 v[244:247], a[116:119], v[108:111], v[244:247]
ds_read_b128 a[84:87], v2 offset:37888
v_add_f32 v27, v27, v13
v_cvt_pk_bf16_f32 v126, v12, v13
v_mfma_f32_16x16x32_bf16 v[244:247], a[112:115], v[104:107], v[244:247]
s_waitcnt lgkmcnt(4)
v_add_f32 v27, v27, v14
v_add_f32 v27, v27, v15
v_mfma_f32_16x16x32_bf16 v[248:251], a[120:123], v[96:99], v[248:251]
ds_read_b128 a[88:91], v2 offset:38912
v_cvt_pk_bf16_f32 v127, v14, v15
v_mfma_f32_16x16x32_bf16 v[248:251], a[124:127], v[100:103], v[248:251]
v_add_f32 v28, v26, v27
v_cmp_nge_f32 vcc, s25, v28
v_mfma_f32_16x16x32_bf16 v[252:255], a[124:127], v[108:111], v[252:255]
ds_read_b128 a[92:95], v2 offset:39936
v_mfma_f32_16x16x32_bf16 v[252:255], a[120:123], v[104:107], v[252:255]
s_cbranch_vccnz Lstub_14
Lback_15:
v_mfma_f32_16x16x32_bf16 v[128:131], a[64:67], v[112:115], v[128:131]
s_add_u32 m0, s18, 131072
ds_read_b128 a[96:99], v2 offset:40960
v_add_f32 v24, v24, v26
v_mfma_f32_16x16x32_bf16 v[128:131], a[68:71], v[116:119], v[128:131]
buffer_load_dwordx4 v1, s[4:7], s8 offen offset:0 sc1 lds
v_mfma_f32_16x16x32_bf16 v[132:135], a[68:71], v[124:127], v[132:135]
ds_read_b128 a[100:103], v2 offset:41984
v_add_f32 v25, v25, v27
v_mfma_f32_16x16x32_bf16 v[132:135], a[64:67], v[120:123], v[132:135]
s_waitcnt lgkmcnt(4)
buffer_load_dwordx4 v1, s[4:7], s8 offen offset:1024 sc1 lds
v_mfma_f32_16x16x32_bf16 v[136:139], a[72:75], v[112:115], v[136:139]
ds_read_b128 a[104:107], v2 offset:43008
v_mov_b32 v8, v16
v_mfma_f32_16x16x32_bf16 v[136:139], a[76:79], v[116:119], v[136:139]
buffer_load_dwordx4 v1, s[4:7], s8 offen offset:2048 sc1 lds
v_mfma_f32_16x16x32_bf16 v[140:143], a[76:79], v[124:127], v[140:143]
ds_read_b128 a[108:111], v2 offset:44032
v_mov_b32 v9, v24
v_mfma_f32_16x16x32_bf16 v[140:143], a[72:75], v[120:123], v[140:143]
buffer_load_dwordx4 v1, s[4:7], s8 offen offset:3072 sc1 lds
v_mfma_f32_16x16x32_bf16 v[144:147], a[80:83], v[112:115], v[144:147]
s_add_u32 s8, s8, 4096
s_add_u32 m0, s18, 135168
ds_read_b128 a[112:115], v2 offset:45056
v_mfma_f32_16x16x32_bf16 v[144:147], a[84:87], v[116:119], v[144:147]
buffer_load_dwordx4 v1, s[4:7], s8 offen offset:0 sc1 lds
v_mfma_f32_16x16x32_bf16 v[148:151], a[84:87], v[124:127], v[148:151]
ds_read_b128 a[116:119], v2 offset:46080
v_mov_b32 v10, v20
v_mfma_f32_16x16x32_bf16 v[148:151], a[80:83], v[120:123], v[148:151]
s_waitcnt lgkmcnt(4)
buffer_load_dwordx4 v1, s[4:7], s8 offen offset:1024 sc1 lds
v_mfma_f32_16x16x32_bf16 v[152:155], a[88:91], v[112:115], v[152:155]
ds_read_b128 a[120:123], v2 offset:47104
v_mov_b32 v11, v25
v_mfma_f32_16x16x32_bf16 v[152:155], a[92:95], v[116:119], v[152:155]
buffer_load_dwordx4 v1, s[4:7], s8 offen offset:2048 sc1 lds
v_mfma_f32_16x16x32_bf16 v[156:159], a[92:95], v[124:127], v[156:159]
ds_read_b128 a[124:127], v2 offset:48128
v_cvt_pk_bf16_f32 v128, v128, v129
v_mfma_f32_16x16x32_bf16 v[156:159], a[88:91], v[120:123], v[156:159]
s_waitcnt lgkmcnt(4)
buffer_load_dwordx4 v1, s[4:7], s8 offen offset:3072 sc1 lds
v_mfma_f32_16x16x32_bf16 v[160:163], a[96:99], v[112:115], v[160:163]
s_add_u32 s8, s8, 28672
ds_read_b128 a[64:67], v2 offset:49152
v_cvt_pk_bf16_f32 v129, v130, v131
v_mfma_f32_16x16x32_bf16 v[160:163], a[100:103], v[116:119], v[160:163]
s_sub_u32 s9, s9, 1
buffer_store_dwordx4 v[8:11], v1, s[4:7], s27 offen sc1
v_mfma_f32_16x16x32_bf16 v[164:167], a[100:103], v[124:127], v[164:167]
s_cmp_eq_u32 s9, 0
ds_read_b128 a[68:71], v2 offset:50176
v_cvt_pk_bf16_f32 v130, v136, v137
v_mfma_f32_16x16x32_bf16 v[164:167], a[96:99], v[120:123], v[164:167]
s_cselect_b32 s8, s10, s8
v_cvt_pk_bf16_f32 v131, v138, v139
v_accvgpr_mov_b32 a0, a192
v_mfma_f32_16x16x32_bf16 v[168:171], a[104:107], v[112:115], v[168:171]
s_cselect_b32 s9, s11, s9
ds_read_b128 a[72:75], v2 offset:51200
v_accvgpr_mov_b32 a1, a193
v_mfma_f32_16x16x32_bf16 v[168:171], a[108:111], v[116:119], v[168:171]
s_cselect_b32 s10, 3221225472, s10
buffer_store_dwordx4 v[128:131], v1, s[4:7], s76 offen offset:0 sc1
v_mfma_f32_16x16x32_bf16 v[172:175], a[108:111], v[124:127], v[172:175]
ds_read_b128 a[76:79], v2 offset:52224
v_cvt_pk_bf16_f32 v132, v132, v133
v_mfma_f32_16x16x32_bf16 v[172:175], a[104:107], v[120:123], v[172:175]
s_waitcnt lgkmcnt(4)
v_cvt_pk_bf16_f32 v133, v134, v135
v_cvt_pk_bf16_f32 v134, v140, v141
v_mfma_f32_16x16x32_bf16 v[176:179], a[112:115], v[112:115], v[176:179]
ds_read_b128 a[80:83], v2 offset:53248
v_cvt_pk_bf16_f32 v135, v142, v143
v_mfma_f32_16x16x32_bf16 v[176:179], a[116:119], v[116:119], v[176:179]
buffer_store_dwordx4 v[132:135], v1, s[4:7], s77 offen offset:0 sc1
v_mfma_f32_16x16x32_bf16 v[180:183], a[116:119], v[124:127], v[180:183]
ds_read_b128 a[84:87], v2 offset:54272
v_cvt_pk_bf16_f32 v144, v144, v145
v_mfma_f32_16x16x32_bf16 v[180:183], a[112:115], v[120:123], v[180:183]
v_cvt_pk_bf16_f32 v145, v146, v147
v_cvt_pk_bf16_f32 v146, v152, v153
v_mfma_f32_16x16x32_bf16 v[184:187], a[120:123], v[112:115], v[184:187]
ds_read_b128 a[88:91], v2 offset:55296
v_cvt_pk_bf16_f32 v147, v154, v155
v_mfma_f32_16x16x32_bf16 v[184:187], a[124:127], v[116:119], v[184:187]
buffer_store_dwordx4 v[144:147], v1, s[4:7], s76 offen offset:1024 sc1
v_mfma_f32_16x16x32_bf16 v[188:191], a[124:127], v[124:127], v[188:191]
ds_read_b128 a[92:95], v2 offset:56320
v_cvt_pk_bf16_f32 v148, v148, v149
v_mfma_f32_16x16x32_bf16 v[188:191], a[120:123], v[120:123], v[188:191]
s_waitcnt lgkmcnt(4)
v_cvt_pk_bf16_f32 v149, v150, v151
v_cvt_pk_bf16_f32 v150, v156, v157
v_mfma_f32_16x16x32_bf16 v[192:195], a[64:67], v[112:115], v[192:195]
ds_read_b128 a[96:99], v2 offset:57344
v_cvt_pk_bf16_f32 v151, v158, v159
v_mfma_f32_16x16x32_bf16 v[192:195], a[68:71], v[116:119], v[192:195]
buffer_store_dwordx4 v[148:151], v1, s[4:7], s77 offen offset:1024 sc1
v_mfma_f32_16x16x32_bf16 v[196:199], a[68:71], v[124:127], v[196:199]
ds_read_b128 a[100:103], v2 offset:58368
v_cvt_pk_bf16_f32 v160, v160, v161
v_mfma_f32_16x16x32_bf16 v[196:199], a[64:67], v[120:123], v[196:199]
v_cvt_pk_bf16_f32 v161, v162, v163
v_cvt_pk_bf16_f32 v162, v168, v169
v_mfma_f32_16x16x32_bf16 v[200:203], a[72:75], v[112:115], v[200:203]
ds_read_b128 a[104:107], v2 offset:59392
v_cvt_pk_bf16_f32 v163, v170, v171
v_mfma_f32_16x16x32_bf16 v[200:203], a[76:79], v[116:119], v[200:203]
buffer_store_dwordx4 v[160:163], v1, s[4:7], s76 offen offset:2048 sc1
v_mfma_f32_16x16x32_bf16 v[204:207], a[76:79], v[124:127], v[204:207]
ds_read_b128 a[108:111], v2 offset:60416
v_cvt_pk_bf16_f32 v164, v164, v165
v_mfma_f32_16x16x32_bf16 v[204:207], a[72:75], v[120:123], v[204:207]
s_waitcnt lgkmcnt(4)
v_cvt_pk_bf16_f32 v165, v166, v167
v_cvt_pk_bf16_f32 v166, v172, v173
v_mfma_f32_16x16x32_bf16 v[208:211], a[80:83], v[112:115], v[208:211]
ds_read_b128 a[112:115], v2 offset:61440
v_cvt_pk_bf16_f32 v167, v174, v175
v_mfma_f32_16x16x32_bf16 v[208:211], a[84:87], v[116:119], v[208:211]
buffer_store_dwordx4 v[164:167], v1, s[4:7], s77 offen offset:2048 sc1
v_mfma_f32_16x16x32_bf16 v[212:215], a[84:87], v[124:127], v[212:215]
ds_read_b128 a[116:119], v2 offset:62464
v_cvt_pk_bf16_f32 v176, v176, v177
v_mfma_f32_16x16x32_bf16 v[212:215], a[80:83], v[120:123], v[212:215]
v_cvt_pk_bf16_f32 v177, v178, v179
v_cvt_pk_bf16_f32 v178, v184, v185
v_mfma_f32_16x16x32_bf16 v[216:219], a[88:91], v[112:115], v[216:219]
ds_read_b128 a[120:123], v2 offset:63488
v_cvt_pk_bf16_f32 v179, v186, v187
v_mfma_f32_16x16x32_bf16 v[216:219], a[92:95], v[116:119], v[216:219]
buffer_store_dwordx4 v[176:179], v1, s[4:7], s76 offen offset:3072 sc1
v_mfma_f32_16x16x32_bf16 v[220:223], a[92:95], v[124:127], v[220:223]
ds_read_b128 a[124:127], v2 offset:64512
v_cvt_pk_bf16_f32 v180, v180, v181
v_mfma_f32_16x16x32_bf16 v[220:223], a[88:91], v[120:123], v[220:223]
s_waitcnt lgkmcnt(4)
v_cvt_pk_bf16_f32 v181, v182, v183
v_cvt_pk_bf16_f32 v182, v188, v189
v_mfma_f32_16x16x32_bf16 v[224:227], a[96:99], v[112:115], v[224:227]
v_cvt_pk_bf16_f32 v183, v190, v191
v_accvgpr_mov_b32 a2, a194
v_mfma_f32_16x16x32_bf16 v[224:227], a[100:103], v[116:119], v[224:227]
buffer_store_dwordx4 v[180:183], v1, s[4:7], s77 offen offset:3072 sc1
v_mfma_f32_16x16x32_bf16 v[228:231], a[100:103], v[124:127], v[228:231]
s_add_u32 s76, s76, 4096
v_accvgpr_mov_b32 a3, a195
v_accvgpr_mov_b32 a4, a196
v_mfma_f32_16x16x32_bf16 v[228:231], a[96:99], v[120:123], v[228:231]
s_add_u32 s77, s77, 4096
v_cvt_pk_bf16_f32 v192, v192, v193
v_cvt_pk_bf16_f32 v193, v194, v195
v_mfma_f32_16x16x32_bf16 v[232:235], a[104:107], v[112:115], v[232:235]
v_cvt_pk_bf16_f32 v194, v200, v201
v_cvt_pk_bf16_f32 v195, v202, v203
v_mfma_f32_16x16x32_bf16 v[232:235], a[108:111], v[116:119], v[232:235]
PAD_34:
s_cbranch_execz M_tret
buffer_store_dwordx4 v[192:195], v1, s[4:7], s76 offen offset:0 sc1
v_mfma_f32_16x16x32_bf16 v[236:239], a[108:111], v[124:127], v[236:239]
v_cvt_pk_bf16_f32 v196, v196, v197
v_cvt_pk_bf16_f32 v197, v198, v199
v_mfma_f32_16x16x32_bf16 v[236:239], a[104:107], v[120:123], v[236:239]
s_waitcnt lgkmcnt(0)
v_cvt_pk_bf16_f32 v198, v204, v205
v_cvt_pk_bf16_f32 v199, v206, v207
v_mfma_f32_16x16x32_bf16 v[240:243], a[112:115], v[112:115], v[240:243]
buffer_store_dwordx4 v[196:199], v1, s[4:7], s77 offen offset:0 sc1
v_mfma_f32_16x16x32_bf16 v[240:243], a[116:119], v[116:119], v[240:243]
v_cvt_pk_bf16_f32 v208, v208, v209
v_cvt_pk_bf16_f32 v209, v210, v211
v_mfma_f32_16x16x32_bf16 v[244:247], a[116:119], v[124:127], v[244:247]
v_cvt_pk_bf16_f32 v210, v216, v217
v_cvt_pk_bf16_f32 v211, v218, v219
v_mfma_f32_16x16x32_bf16 v[244:247], a[112:115], v[120:123], v[244:247]
buffer_store_dwordx4 v[208:211], v1, s[4:7], s76 offen offset:1024 sc1
v_mfma_f32_16x16x32_bf16 v[248:251], a[120:123], v[112:115], v[248:251]
v_cvt_pk_bf16_f32 v212, v212, v213
v_cvt_pk_bf16_f32 v213, v214, v215
v_mfma_f32_16x16x32_bf16 v[248:251], a[124:127], v[116:119], v[248:251]
v_cvt_pk_bf16_f32 v214, v220, v221
v_cvt_pk_bf16_f32 v215, v222, v223
v_mfma_f32_16x16x32_bf16 v[252:255], a[124:127], v[124:127], v[252:255]
buffer_store_dwordx4 v[212:215], v1, s[4:7], s77 offen offset:1024 sc1
v_mfma_f32_16x16x32_bf16 v[252:255], a[120:123], v[120:123], v[252:255]
v_cvt_pk_bf16_f32 v224, v224, v225
v_cvt_pk_bf16_f32 v225, v226, v227
v_accvgpr_mov_b32 a5, a197
v_accvgpr_mov_b32 a6, a198
v_accvgpr_mov_b32 a7, a199
v_accvgpr_mov_b32 a8, a200
v_accvgpr_mov_b32 a9, a201
v_accvgpr_mov_b32 a10, a202
v_accvgpr_mov_b32 a11, a203
v_accvgpr_mov_b32 a12, a204
v_cvt_pk_bf16_f32 v226, v232, v233
v_cvt_pk_bf16_f32 v227, v234, v235
buffer_store_dwordx4 v[224:227], v1, s[4:7], s76 offen offset:2048 sc1
v_cvt_pk_bf16_f32 v228, v228, v229
v_cvt_pk_bf16_f32 v229, v230, v231
v_cvt_pk_bf16_f32 v230, v236, v237
v_cvt_pk_bf16_f32 v231, v238, v239
buffer_store_dwordx4 v[228:231], v1, s[4:7], s77 offen offset:2048 sc1
v_cvt_pk_bf16_f32 v240, v240, v241
v_cvt_pk_bf16_f32 v241, v242, v243
v_cvt_pk_bf16_f32 v242, v248, v249
v_cvt_pk_bf16_f32 v243, v250, v251
buffer_store_dwordx4 v[240:243], v1, s[4:7], s76 offen offset:3072 sc1
v_cvt_pk_bf16_f32 v244, v244, v245
v_cvt_pk_bf16_f32 v245, v246, v247
v_cvt_pk_bf16_f32 v246, v252, v253
v_cvt_pk_bf16_f32 v247, v254, v255
buffer_store_dwordx4 v[244:247], v1, s[4:7], s77 offen offset:3072 sc1
v_accvgpr_mov_b32 a13, a205
v_accvgpr_mov_b32 a14, a206
v_accvgpr_mov_b32 a15, a207
v_accvgpr_mov_b32 a16, a208
v_accvgpr_mov_b32 a17, a209
v_accvgpr_mov_b32 a18, a210
v_accvgpr_mov_b32 a19, a211
v_accvgpr_mov_b32 a20, a212
v_accvgpr_mov_b32 a21, a213
v_accvgpr_mov_b32 a22, a214
v_accvgpr_mov_b32 a23, a215
v_accvgpr_mov_b32 a24, a216
v_accvgpr_mov_b32 a25, a217
v_accvgpr_mov_b32 a26, a218
v_accvgpr_mov_b32 a27, a219
v_accvgpr_mov_b32 a28, a220
v_accvgpr_mov_b32 a29, a221
v_accvgpr_mov_b32 a30, a222
v_accvgpr_mov_b32 a31, a223
v_accvgpr_mov_b32 a32, a224
v_accvgpr_mov_b32 a33, a225
v_accvgpr_mov_b32 a34, a226
v_accvgpr_mov_b32 a35, a227
v_accvgpr_mov_b32 a36, a228
v_accvgpr_mov_b32 a37, a229
v_accvgpr_mov_b32 a38, a230
v_accvgpr_mov_b32 a39, a231
v_accvgpr_mov_b32 a40, a232
v_accvgpr_mov_b32 a41, a233
v_accvgpr_mov_b32 a42, a234
v_accvgpr_mov_b32 a43, a235
v_accvgpr_mov_b32 a44, a236
v_accvgpr_mov_b32 a45, a237
v_accvgpr_mov_b32 a46, a238
v_accvgpr_mov_b32 a47, a239
v_accvgpr_mov_b32 a48, a240
v_accvgpr_mov_b32 a49, a241
v_accvgpr_mov_b32 a50, a242
v_accvgpr_mov_b32 a51, a243
v_accvgpr_mov_b32 a52, a244
v_accvgpr_mov_b32 a53, a245
v_accvgpr_mov_b32 a54, a246
v_accvgpr_mov_b32 a55, a247
v_accvgpr_mov_b32 a56, a248
v_accvgpr_mov_b32 a57, a249
v_accvgpr_mov_b32 a58, a250
v_accvgpr_mov_b32 a59, a251
v_accvgpr_mov_b32 a60, a252
v_accvgpr_mov_b32 a61, a253
v_accvgpr_mov_b32 a62, a254
v_accvgpr_mov_b32 a63, a255
s_mov_b32 s24, 0
s_mov_b32 s29, s21
s_mov_b32 s19, s21
v_mov_b64 v[128:129], 0
v_mov_b64 v[130:131], 0
v_mov_b64 v[132:133], 0
v_mov_b64 v[134:135], 0
v_mov_b64 v[136:137], 0
v_mov_b64 v[138:139], 0
v_mov_b64 v[140:141], 0
v_mov_b64 v[142:143], 0
v_mov_b64 v[144:145], 0
v_mov_b64 v[146:147], 0
v_mov_b64 v[148:149], 0
v_mov_b64 v[150:151], 0
v_mov_b64 v[152:153], 0
v_mov_b64 v[154:155], 0
v_mov_b64 v[156:157], 0
v_mov_b64 v[158:159], 0
v_mov_b64 v[160:161], 0
v_mov_b64 v[162:163], 0
v_mov_b64 v[164:165], 0
v_mov_b64 v[166:167], 0
v_mov_b64 v[168:169], 0
v_mov_b64 v[170:171], 0
v_mov_b64 v[172:173], 0
v_mov_b64 v[174:175], 0
v_mov_b64 v[176:177], 0
v_mov_b64 v[178:179], 0
v_mov_b64 v[180:181], 0
v_mov_b64 v[182:183], 0
v_mov_b64 v[184:185], 0
v_mov_b64 v[186:187], 0
v_mov_b64 v[188:189], 0
v_mov_b64 v[190:191], 0
v_mov_b64 v[192:193], 0
v_mov_b64 v[194:195], 0
v_mov_b64 v[196:197], 0
v_mov_b64 v[198:199], 0
v_mov_b64 v[200:201], 0
v_mov_b64 v[202:203], 0
v_mov_b64 v[204:205], 0
v_mov_b64 v[206:207], 0
v_mov_b64 v[208:209], 0
v_mov_b64 v[210:211], 0
v_mov_b64 v[212:213], 0
v_mov_b64 v[214:215], 0
v_mov_b64 v[216:217], 0
v_mov_b64 v[218:219], 0
v_mov_b64 v[220:221], 0
v_mov_b64 v[222:223], 0
v_mov_b64 v[224:225], 0
v_mov_b64 v[226:227], 0
v_mov_b64 v[228:229], 0
v_mov_b64 v[230:231], 0
v_mov_b64 v[232:233], 0
v_mov_b64 v[234:235], 0
v_mov_b64 v[236:237], 0
v_mov_b64 v[238:239], 0
v_mov_b64 v[240:241], 0
v_mov_b64 v[242:243], 0
v_mov_b64 v[244:245], 0
v_mov_b64 v[246:247], 0
v_mov_b64 v[248:249], 0
v_mov_b64 v[250:251], 0
v_mov_b64 v[252:253], 0
v_mov_b64 v[254:255], 0
v_mov_b64 v[24:25], 0
s_mov_b32 s71, s28
s_mov_b32 s84, 0
s_barrier
s_branch K2_item
K2_nend:
Lstub_2:
s_call_b64 s[16:17], K2_slow1
s_branch Lback_3
Lstub_4:
s_call_b64 s[16:17], K2_slow0
s_branch Lback_5
Lstub_6:
s_call_b64 s[16:17], K2_slow1
s_branch Lback_7
Lstub_8:
s_call_b64 s[16:17], K2_slow0
s_branch Lback_9
Lstub_10:
s_call_b64 s[16:17], K2_slow2
s_branch Lback_11
Lstub_12:
s_call_b64 s[16:17], K2_slow2
s_branch Lback_13
Lstub_14:
s_call_b64 s[16:17], K2_slow1
s_branch Lback_15
K2_slow0:
s_nop 7
s_nop 7
v_max3_f32 v8, v32, v33, 0
v_max3_f32 v8, v34, v35, v8
v_max3_f32 v8, v40, v41, v8
v_max3_f32 v8, v42, v43, v8
v_max3_f32 v8, v48, v49, v8
v_max3_f32 v8, v50, v51, v8
v_max3_f32 v8, v56, v57, v8
v_max3_f32 v8, v58, v59, v8
v_mov_b32 v9, v8
s_nop 1
v_permlane16_swap_b32 v8, v9
v_max_f32 v8, v8, v9
v_mov_b32 v9, v8
s_nop 1
v_permlane32_swap_b32 v8, v9
v_max_f32 v8, v8, v9
v_exp_f32 v9, -v8
v_sub_f32 v16, v16, v8
v_sub_f32 v17, v17, v8
v_sub_f32 v18, v18, v8
v_sub_f32 v19, v19, v8
v_mul_f32 v24, v24, v9
v_mul_f32 v128, v128, v9
v_mul_f32 v129, v129, v9
v_mul_f32 v130, v130, v9
v_mul_f32 v131, v131, v9
v_mul_f32 v136, v136, v9
v_mul_f32 v137, v137, v9
v_mul_f32 v138, v138, v9
v_mul_f32 v139, v139, v9
v_mul_f32 v144, v144, v9
v_mul_f32 v145, v145, v9
v_mul_f32 v146, v146, v9
v_mul_f32 v147, v147, v9
v_mul_f32 v152, v152, v9
v_mul_f32 v153, v153, v9
v_mul_f32 v154, v154, v9
v_mul_f32 v155, v155, v9
v_mul_f32 v160, v160, v9
v_mul_f32 v161, v161, v9
v_mul_f32 v162, v162, v9
v_mul_f32 v163, v163, v9
v_mul_f32 v168, v168, v9
v_mul_f32 v169, v169, v9
v_mul_f32 v170, v170, v9
v_mul_f32 v171, v171, v9
v_mul_f32 v176, v176, v9
v_mul_f32 v177, v177, v9
v_mul_f32 v178, v178, v9
v_mul_f32 v179, v179, v9
v_mul_f32 v184, v184, v9
v_mul_f32 v185, v185, v9
v_mul_f32 v186, v186, v9
v_mul_f32 v187, v187, v9
v_mul_f32 v192, v192, v9
v_mul_f32 v193, v193, v9
v_mul_f32 v194, v194, v9
v_mul_f32 v195, v195, v9
v_mul_f32 v200, v200, v9
v_mul_f32 v201, v201, v9
v_mul_f32 v202, v202, v9
v_mul_f32 v203, v203, v9
v_mul_f32 v208, v208, v9
v_mul_f32 v209, v209, v9
v_mul_f32 v210, v210, v9
v_mul_f32 v211, v211, v9
v_mul_f32 v216, v216, v9
v_mul_f32 v217, v217, v9
v_mul_f32 v218, v218, v9
v_mul_f32 v219, v219, v9
v_mul_f32 v224, v224, v9
v_mul_f32 v225, v225, v9
v_mul_f32 v226, v226, v9
v_mul_f32 v227, v227, v9
v_mul_f32 v232, v232, v9
v_mul_f32 v233, v233, v9
v_mul_f32 v234, v234, v9
v_mul_f32 v235, v235, v9
v_mul_f32 v240, v240, v9
v_mul_f32 v241, v241, v9
v_mul_f32 v242, v242, v9
v_mul_f32 v243, v243, v9
v_mul_f32 v248, v248, v9
v_mul_f32 v249, v249, v9
v_mul_f32 v250, v250, v9
v_mul_f32 v251, v251, v9
v_sub_f32 v32, v32, v8
v_sub_f32 v33, v33, v8
v_sub_f32 v34, v34, v8
v_sub_f32 v35, v35, v8
v_sub_f32 v40, v40, v8
v_sub_f32 v41, v41, v8
v_sub_f32 v42, v42, v8
v_sub_f32 v43, v43, v8
v_sub_f32 v48, v48, v8
v_sub_f32 v49, v49, v8
v_sub_f32 v50, v50, v8
v_sub_f32 v51, v51, v8
v_sub_f32 v56, v56, v8
v_sub_f32 v57, v57, v8
v_sub_f32 v58, v58, v8
v_sub_f32 v59, v59, v8
v_sub_f32 v64, v64, v8
v_sub_f32 v65, v65, v8
v_sub_f32 v66, v66, v8
v_sub_f32 v67, v67, v8
v_sub_f32 v72, v72, v8
v_sub_f32 v73, v73, v8
v_sub_f32 v74, v74, v8
v_sub_f32 v75, v75, v8
v_sub_f32 v80, v80, v8
v_sub_f32 v81, v81, v8
v_sub_f32 v82, v82, v8
v_sub_f32 v83, v83, v8
v_sub_f32 v88, v88, v8
v_sub_f32 v89, v89, v8
v_sub_f32 v90, v90, v8
v_sub_f32 v91, v91, v8
v_max3_f32 v8, v36, v37, 0
v_max3_f32 v8, v38, v39, v8
v_max3_f32 v8, v44, v45, v8
v_max3_f32 v8, v46, v47, v8
v_max3_f32 v8, v52, v53, v8
v_max3_f32 v8, v54, v55, v8
v_max3_f32 v8, v60, v61, v8
v_max3_f32 v8, v62, v63, v8
v_mov_b32 v9, v8
s_nop 1
v_permlane16_swap_b32 v8, v9
v_max_f32 v8, v8, v9
v_mov_b32 v9, v8
s_nop 1
v_permlane32_swap_b32 v8, v9
v_max_f32 v8, v8, v9
v_exp_f32 v9, -v8
v_sub_f32 v20, v20, v8
v_sub_f32 v21, v21, v8
v_sub_f32 v22, v22, v8
v_sub_f32 v23, v23, v8
v_mul_f32 v25, v25, v9
v_mul_f32 v132, v132, v9
v_mul_f32 v133, v133, v9
v_mul_f32 v134, v134, v9
v_mul_f32 v135, v135, v9
v_mul_f32 v140, v140, v9
v_mul_f32 v141, v141, v9
v_mul_f32 v142, v142, v9
v_mul_f32 v143, v143, v9
v_mul_f32 v148, v148, v9
v_mul_f32 v149, v149, v9
v_mul_f32 v150, v150, v9
v_mul_f32 v151, v151, v9
v_mul_f32 v156, v156, v9
v_mul_f32 v157, v157, v9
v_mul_f32 v158, v158, v9
v_mul_f32 v159, v159, v9
v_mul_f32 v164, v164, v9
v_mul_f32 v165, v165, v9
v_mul_f32 v166, v166, v9
v_mul_f32 v167, v167, v9
v_mul_f32 v172, v172, v9
v_mul_f32 v173, v173, v9
v_mul_f32 v174, v174, v9
v_mul_f32 v175, v175, v9
v_mul_f32 v180, v180, v9
v_mul_f32 v181, v181, v9
v_mul_f32 v182, v182, v9
v_mul_f32 v183, v183, v9
v_mul_f32 v188, v188, v9
v_mul_f32 v189, v189, v9
v_mul_f32 v190, v190, v9
v_mul_f32 v191, v191, v9
v_mul_f32 v196, v196, v9
v_mul_f32 v197, v197, v9
v_mul_f32 v198, v198, v9
v_mul_f32 v199, v199, v9
v_mul_f32 v204, v204, v9
v_mul_f32 v205, v205, v9
v_mul_f32 v206, v206, v9
v_mul_f32 v207, v207, v9
v_mul_f32 v212, v212, v9
v_mul_f32 v213, v213, v9
v_mul_f32 v214, v214, v9
v_mul_f32 v215, v215, v9
v_mul_f32 v220, v220, v9
v_mul_f32 v221, v221, v9
v_mul_f32 v222, v222, v9
v_mul_f32 v223, v223, v9
v_mul_f32 v228, v228, v9
v_mul_f32 v229, v229, v9
v_mul_f32 v230, v230, v9
v_mul_f32 v231, v231, v9
v_mul_f32 v236, v236, v9
v_mul_f32 v237, v237, v9
v_mul_f32 v238, v238, v9
v_mul_f32 v239, v239, v9
v_mul_f32 v244, v244, v9
v_mul_f32 v245, v245, v9
v_mul_f32 v246, v246, v9
v_mul_f32 v247, v247, v9
v_mul_f32 v252, v252, v9
v_mul_f32 v253, v253, v9
v_mul_f32 v254, v254, v9
v_mul_f32 v255, v255, v9
v_sub_f32 v36, v36, v8
v_sub_f32 v37, v37, v8
v_sub_f32 v38, v38, v8
v_sub_f32 v39, v39, v8
v_sub_f32 v44, v44, v8
v_sub_f32 v45, v45, v8
v_sub_f32 v46, v46, v8
v_sub_f32 v47, v47, v8
v_sub_f32 v52, v52, v8
v_sub_f32 v53, v53, v8
v_sub_f32 v54, v54, v8
v_sub_f32 v55, v55, v8
v_sub_f32 v60, v60, v8
v_sub_f32 v61, v61, v8
v_sub_f32 v62, v62, v8
v_sub_f32 v63, v63, v8
v_sub_f32 v68, v68, v8
v_sub_f32 v69, v69, v8
v_sub_f32 v70, v70, v8
v_sub_f32 v71, v71, v8
v_sub_f32 v76, v76, v8
v_sub_f32 v77, v77, v8
v_sub_f32 v78, v78, v8
v_sub_f32 v79, v79, v8
v_sub_f32 v84, v84, v8
v_sub_f32 v85, v85, v8
v_sub_f32 v86, v86, v8
v_sub_f32 v87, v87, v8
v_sub_f32 v92, v92, v8
v_sub_f32 v93, v93, v8
v_sub_f32 v94, v94, v8
v_sub_f32 v95, v95, v8
v_exp_f32 v8, v32
v_exp_f32 v9, v33
v_exp_f32 v10, v34
v_exp_f32 v11, v35
s_nop 0
v_add_f32 v26, v8, v9
v_cvt_pk_bf16_f32 v96, v8, v9
v_add_f32 v26, v26, v10
v_add_f32 v26, v26, v11
v_cvt_pk_bf16_f32 v97, v10, v11
v_exp_f32 v12, v36
v_exp_f32 v13, v37
v_exp_f32 v14, v38
v_exp_f32 v15, v39
s_nop 0
v_add_f32 v27, v12, v13
v_cvt_pk_bf16_f32 v104, v12, v13
v_add_f32 v27, v27, v14
v_add_f32 v27, v27, v15
v_cvt_pk_bf16_f32 v105, v14, v15
v_exp_f32 v8, v40
v_exp_f32 v9, v41
v_exp_f32 v10, v42
v_exp_f32 v11, v43
s_nop 0
v_add_f32 v26, v26, v8
v_add_f32 v26, v26, v9
v_cvt_pk_bf16_f32 v98, v8, v9
v_add_f32 v26, v26, v10
v_add_f32 v26, v26, v11
v_cvt_pk_bf16_f32 v99, v10, v11
v_exp_f32 v12, v44
v_exp_f32 v13, v45
v_exp_f32 v14, v46
v_exp_f32 v15, v47
s_nop 0
v_add_f32 v27, v27, v12
v_add_f32 v27, v27, v13
v_cvt_pk_bf16_f32 v106, v12, v13
v_add_f32 v27, v27, v14
v_add_f32 v27, v27, v15
v_cvt_pk_bf16_f32 v107, v14, v15
v_exp_f32 v8, v48
v_exp_f32 v9, v49
v_exp_f32 v10, v50
v_exp_f32 v11, v51
s_nop 0
v_add_f32 v26, v26, v8
v_add_f32 v26, v26, v9
v_cvt_pk_bf16_f32 v100, v8, v9
v_add_f32 v26, v26, v10
v_add_f32 v26, v26, v11
v_cvt_pk_bf16_f32 v101, v10, v11
v_exp_f32 v12, v52
v_exp_f32 v13, v53
v_exp_f32 v14, v54
v_exp_f32 v15, v55
s_nop 0
v_add_f32 v27, v27, v12
v_add_f32 v27, v27, v13
v_cvt_pk_bf16_f32 v108, v12, v13
v_add_f32 v27, v27, v14
v_add_f32 v27, v27, v15
v_cvt_pk_bf16_f32 v109, v14, v15
v_exp_f32 v8, v56
v_exp_f32 v9, v57
v_exp_f32 v10, v58
v_exp_f32 v11, v59
s_nop 0
v_add_f32 v26, v26, v8
v_add_f32 v26, v26, v9
v_cvt_pk_bf16_f32 v102, v8, v9
v_add_f32 v26, v26, v10
v_add_f32 v26, v26, v11
v_cvt_pk_bf16_f32 v103, v10, v11
v_exp_f32 v12, v60
v_exp_f32 v13, v61
v_exp_f32 v14, v62
v_exp_f32 v15, v63
s_nop 0
v_add_f32 v27, v27, v12
v_add_f32 v27, v27, v13
v_cvt_pk_bf16_f32 v110, v12, v13
v_add_f32 v27, v27, v14
v_add_f32 v27, v27, v15
v_cvt_pk_bf16_f32 v111, v14, v15
s_nop 1
s_setpc_b64 s[16:17]
K2_slow1:
s_nop 7
s_nop 7
v_max3_f32 v8, v64, v65, 0
v_max3_f32 v8, v66, v67, v8
v_max3_f32 v8, v72, v73, v8
v_max3_f32 v8, v74, v75, v8
v_max3_f32 v8, v80, v81, v8
v_max3_f32 v8, v82, v83, v8
v_max3_f32 v8, v88, v89, v8
v_max3_f32 v8, v90, v91, v8
v_mov_b32 v9, v8
s_nop 1
v_permlane16_swap_b32 v8, v9
v_max_f32 v8, v8, v9
v_mov_b32 v9, v8
s_nop 1
v_permlane32_swap_b32 v8, v9
v_max_f32 v8, v8, v9
v_exp_f32 v9, -v8
v_sub_f32 v16, v16, v8
v_sub_f32 v17, v17, v8
v_sub_f32 v18, v18, v8
v_sub_f32 v19, v19, v8
v_mul_f32 v24, v24, v9
v_mul_f32 v128, v128, v9
v_mul_f32 v129, v129, v9
v_mul_f32 v130, v130, v9
v_mul_f32 v131, v131, v9
v_mul_f32 v136, v136, v9
v_mul_f32 v137, v137, v9
v_mul_f32 v138, v138, v9
v_mul_f32 v139, v139, v9
v_mul_f32 v144, v144, v9
v_mul_f32 v145, v145, v9
v_mul_f32 v146, v146, v9
v_mul_f32 v147, v147, v9
v_mul_f32 v152, v152, v9
v_mul_f32 v153, v153, v9
v_mul_f32 v154, v154, v9
v_mul_f32 v155, v155, v9
v_mul_f32 v160, v160, v9
v_mul_f32 v161, v161, v9
v_mul_f32 v162, v162, v9
v_mul_f32 v163, v163, v9
v_mul_f32 v168, v168, v9
v_mul_f32 v169, v169, v9
v_mul_f32 v170, v170, v9
v_mul_f32 v171, v171, v9
v_mul_f32 v176, v176, v9
v_mul_f32 v177, v177, v9
v_mul_f32 v178, v178, v9
v_mul_f32 v179, v179, v9
v_mul_f32 v184, v184, v9
v_mul_f32 v185, v185, v9
v_mul_f32 v186, v186, v9
v_mul_f32 v187, v187, v9
v_mul_f32 v192, v192, v9
v_mul_f32 v193, v193, v9
v_mul_f32 v194, v194, v9
v_mul_f32 v195, v195, v9
v_mul_f32 v200, v200, v9
v_mul_f32 v201, v201, v9
v_mul_f32 v202, v202, v9
v_mul_f32 v203, v203, v9
v_mul_f32 v208, v208, v9
v_mul_f32 v209, v209, v9
v_mul_f32 v210, v210, v9
v_mul_f32 v211, v211, v9
v_mul_f32 v216, v216, v9
v_mul_f32 v217, v217, v9
v_mul_f32 v218, v218, v9
v_mul_f32 v219, v219, v9
v_mul_f32 v224, v224, v9
v_mul_f32 v225, v225, v9
v_mul_f32 v226, v226, v9
v_mul_f32 v227, v227, v9
v_mul_f32 v232, v232, v9
v_mul_f32 v233, v233, v9
v_mul_f32 v234, v234, v9
v_mul_f32 v235, v235, v9
v_mul_f32 v240, v240, v9
v_mul_f32 v241, v241, v9
v_mul_f32 v242, v242, v9
v_mul_f32 v243, v243, v9
v_mul_f32 v248, v248, v9
v_mul_f32 v249, v249, v9
v_mul_f32 v250, v250, v9
v_mul_f32 v251, v251, v9
v_sub_f32 v32, v32, v8
v_sub_f32 v33, v33, v8
v_sub_f32 v34, v34, v8
v_sub_f32 v35, v35, v8
v_sub_f32 v40, v40, v8
v_sub_f32 v41, v41, v8
v_sub_f32 v42, v42, v8
v_sub_f32 v43, v43, v8
v_sub_f32 v48, v48, v8
v_sub_f32 v49, v49, v8
v_sub_f32 v50, v50, v8
v_sub_f32 v51, v51, v8
v_sub_f32 v56, v56, v8
v_sub_f32 v57, v57, v8
v_sub_f32 v58, v58, v8
v_sub_f32 v59, v59, v8
v_sub_f32 v64, v64, v8
v_sub_f32 v65, v65, v8
v_sub_f32 v66, v66, v8
v_sub_f32 v67, v67, v8
v_sub_f32 v72, v72, v8
v_sub_f32 v73, v73, v8
v_sub_f32 v74, v74, v8
v_sub_f32 v75, v75, v8
v_sub_f32 v80, v80, v8
v_sub_f32 v81, v81, v8
v_sub_f32 v82, v82, v8
v_sub_f32 v83, v83, v8
v_sub_f32 v88, v88, v8
v_sub_f32 v89, v89, v8
v_sub_f32 v90, v90, v8
v_sub_f32 v91, v91, v8
v_max3_f32 v8, v68, v69, 0
v_max3_f32 v8, v70, v71, v8
v_max3_f32 v8, v76, v77, v8
v_max3_f32 v8, v78, v79, v8
v_max3_f32 v8, v84, v85, v8
v_max3_f32 v8, v86, v87, v8
v_max3_f32 v8, v92, v93, v8
v_max3_f32 v8, v94, v95, v8
v_mov_b32 v9, v8
s_nop 1
v_permlane16_swap_b32 v8, v9
v_max_f32 v8, v8, v9
v_mov_b32 v9, v8
s_nop 1
v_permlane32_swap_b32 v8, v9
v_max_f32 v8, v8, v9
v_exp_f32 v9, -v8
v_sub_f32 v20, v20, v8
v_sub_f32 v21, v21, v8
v_sub_f32 v22, v22, v8
v_sub_f32 v23, v23, v8
v_mul_f32 v25, v25, v9
v_mul_f32 v132, v132, v9
v_mul_f32 v133, v133, v9
v_mul_f32 v134, v134, v9
v_mul_f32 v135, v135, v9
v_mul_f32 v140, v140, v9
v_mul_f32 v141, v141, v9
v_mul_f32 v142, v142, v9
v_mul_f32 v143, v143, v9
v_mul_f32 v148, v148, v9
v_mul_f32 v149, v149, v9
v_mul_f32 v150, v150, v9
v_mul_f32 v151, v151, v9
v_mul_f32 v156, v156, v9
v_mul_f32 v157, v157, v9
v_mul_f32 v158, v158, v9
v_mul_f32 v159, v159, v9
v_mul_f32 v164, v164, v9
v_mul_f32 v165, v165, v9
v_mul_f32 v166, v166, v9
v_mul_f32 v167, v167, v9
v_mul_f32 v172, v172, v9
v_mul_f32 v173, v173, v9
v_mul_f32 v174, v174, v9
v_mul_f32 v175, v175, v9
v_mul_f32 v180, v180, v9
v_mul_f32 v181, v181, v9
v_mul_f32 v182, v182, v9
v_mul_f32 v183, v183, v9
v_mul_f32 v188, v188, v9
v_mul_f32 v189, v189, v9
v_mul_f32 v190, v190, v9
v_mul_f32 v191, v191, v9
v_mul_f32 v196, v196, v9
v_mul_f32 v197, v197, v9
v_mul_f32 v198, v198, v9
v_mul_f32 v199, v199, v9
v_mul_f32 v204, v204, v9
v_mul_f32 v205, v205, v9
v_mul_f32 v206, v206, v9
v_mul_f32 v207, v207, v9
v_mul_f32 v212, v212, v9
v_mul_f32 v213, v213, v9
v_mul_f32 v214, v214, v9
v_mul_f32 v215, v215, v9
v_mul_f32 v220, v220, v9
v_mul_f32 v221, v221, v9
v_mul_f32 v222, v222, v9
v_mul_f32 v223, v223, v9
v_mul_f32 v228, v228, v9
v_mul_f32 v229, v229, v9
v_mul_f32 v230, v230, v9
v_mul_f32 v231, v231, v9
v_mul_f32 v236, v236, v9
v_mul_f32 v237, v237, v9
v_mul_f32 v238, v238, v9
v_mul_f32 v239, v239, v9
v_mul_f32 v244, v244, v9
v_mul_f32 v245, v245, v9
v_mul_f32 v246, v246, v9
v_mul_f32 v247, v247, v9
v_mul_f32 v252, v252, v9
v_mul_f32 v253, v253, v9
v_mul_f32 v254, v254, v9
v_mul_f32 v255, v255, v9
v_sub_f32 v36, v36, v8
v_sub_f32 v37, v37, v8
v_sub_f32 v38, v38, v8
v_sub_f32 v39, v39, v8
v_sub_f32 v44, v44, v8
v_sub_f32 v45, v45, v8
v_sub_f32 v46, v46, v8
v_sub_f32 v47, v47, v8
v_sub_f32 v52, v52, v8
v_sub_f32 v53, v53, v8
v_sub_f32 v54, v54, v8
v_sub_f32 v55, v55, v8
v_sub_f32 v60, v60, v8
v_sub_f32 v61, v61, v8
v_sub_f32 v62, v62, v8
v_sub_f32 v63, v63, v8
v_sub_f32 v68, v68, v8
v_sub_f32 v69, v69, v8
v_sub_f32 v70, v70, v8
v_sub_f32 v71, v71, v8
v_sub_f32 v76, v76, v8
v_sub_f32 v77, v77, v8
v_sub_f32 v78, v78, v8
v_sub_f32 v79, v79, v8
v_sub_f32 v84, v84, v8
v_sub_f32 v85, v85, v8
v_sub_f32 v86, v86, v8
v_sub_f32 v87, v87, v8
v_sub_f32 v92, v92, v8
v_sub_f32 v93, v93, v8
v_sub_f32 v94, v94, v8
v_sub_f32 v95, v95, v8
v_exp_f32 v8, v64
v_exp_f32 v9, v65
v_exp_f32 v10, v66
v_exp_f32 v11, v67
s_nop 0
v_add_f32 v26, v8, v9
v_cvt_pk_bf16_f32 v112, v8, v9
v_add_f32 v26, v26, v10
v_add_f32 v26, v26, v11
v_cvt_pk_bf16_f32 v113, v10, v11
v_exp_f32 v12, v68
v_exp_f32 v13, v69
v_exp_f32 v14, v70
v_exp_f32 v15, v71
s_nop 0
v_add_f32 v27, v12, v13
v_cvt_pk_bf16_f32 v120, v12, v13
v_add_f32 v27, v27, v14
v_add_f32 v27, v27, v15
v_cvt_pk_bf16_f32 v121, v14, v15
v_exp_f32 v8, v72
v_exp_f32 v9, v73
v_exp_f32 v10, v74
v_exp_f32 v11, v75
s_nop 0
v_add_f32 v26, v26, v8
v_add_f32 v26, v26, v9
v_cvt_pk_bf16_f32 v114, v8, v9
v_add_f32 v26, v26, v10
v_add_f32 v26, v26, v11
v_cvt_pk_bf16_f32 v115, v10, v11
v_exp_f32 v12, v76
v_exp_f32 v13, v77
v_exp_f32 v14, v78
v_exp_f32 v15, v79
s_nop 0
v_add_f32 v27, v27, v12
v_add_f32 v27, v27, v13
v_cvt_pk_bf16_f32 v122, v12, v13
v_add_f32 v27, v27, v14
v_add_f32 v27, v27, v15
v_cvt_pk_bf16_f32 v123, v14, v15
v_exp_f32 v8, v80
v_exp_f32 v9, v81
v_exp_f32 v10, v82
v_exp_f32 v11, v83
s_nop 0
v_add_f32 v26, v26, v8
v_add_f32 v26, v26, v9
v_cvt_pk_bf16_f32 v116, v8, v9
v_add_f32 v26, v26, v10
v_add_f32 v26, v26, v11
v_cvt_pk_bf16_f32 v117, v10, v11
v_exp_f32 v12, v84
v_exp_f32 v13, v85
v_exp_f32 v14, v86
v_exp_f32 v15, v87
s_nop 0
v_add_f32 v27, v27, v12
v_add_f32 v27, v27, v13
v_cvt_pk_bf16_f32 v124, v12, v13
v_add_f32 v27, v27, v14
v_add_f32 v27, v27, v15
v_cvt_pk_bf16_f32 v125, v14, v15
v_exp_f32 v8, v88
v_exp_f32 v9, v89
v_exp_f32 v10, v90
v_exp_f32 v11, v91
s_nop 0
v_add_f32 v26, v26, v8
v_add_f32 v26, v26, v9
v_cvt_pk_bf16_f32 v118, v8, v9
v_add_f32 v26, v26, v10
v_add_f32 v26, v26, v11
v_cvt_pk_bf16_f32 v119, v10, v11
v_exp_f32 v12, v92
v_exp_f32 v13, v93
v_exp_f32 v14, v94
v_exp_f32 v15, v95
s_nop 0
v_add_f32 v27, v27, v12
v_add_f32 v27, v27, v13
v_cvt_pk_bf16_f32 v126, v12, v13
v_add_f32 v27, v27, v14
v_add_f32 v27, v27, v15
v_cvt_pk_bf16_f32 v127, v14, v15
s_nop 1
s_setpc_b64 s[16:17]
K2_slow2:
s_nop 7
s_nop 7
v_max3_f32 v8, v68, v69, 0
v_max3_f32 v8, v70, v71, v8
v_max3_f32 v8, v76, v77, v8
v_max3_f32 v8, v78, v79, v8
v_max3_f32 v8, v84, v85, v8
v_max3_f32 v8, v86, v87, v8
v_max3_f32 v8, v92, v93, v8
v_max3_f32 v8, v94, v95, v8
v_mov_b32 v9, v8
s_nop 1
v_permlane16_swap_b32 v8, v9
v_max_f32 v8, v8, v9
v_mov_b32 v9, v8
s_nop 1
v_permlane32_swap_b32 v8, v9
v_max_f32 v8, v8, v9
v_exp_f32 v9, -v8
v_sub_f32 v20, v20, v8
v_sub_f32 v21, v21, v8
v_sub_f32 v22, v22, v8
v_sub_f32 v23, v23, v8
v_mul_f32 v25, v25, v9
v_mul_f32 v132, v132, v9
v_mul_f32 v133, v133, v9
v_mul_f32 v134, v134, v9
v_mul_f32 v135, v135, v9
v_mul_f32 v140, v140, v9
v_mul_f32 v141, v141, v9
v_mul_f32 v142, v142, v9
v_mul_f32 v143, v143, v9
v_mul_f32 v148, v148, v9
v_mul_f32 v149, v149, v9
v_mul_f32 v150, v150, v9
v_mul_f32 v151, v151, v9
v_mul_f32 v156, v156, v9
v_mul_f32 v157, v157, v9
v_mul_f32 v158, v158, v9
v_mul_f32 v159, v159, v9
v_mul_f32 v164, v164, v9
v_mul_f32 v165, v165, v9
v_mul_f32 v166, v166, v9
v_mul_f32 v167, v167, v9
v_mul_f32 v172, v172, v9
v_mul_f32 v173, v173, v9
v_mul_f32 v174, v174, v9
v_mul_f32 v175, v175, v9
v_mul_f32 v180, v180, v9
v_mul_f32 v181, v181, v9
v_mul_f32 v182, v182, v9
v_mul_f32 v183, v183, v9
v_mul_f32 v188, v188, v9
v_mul_f32 v189, v189, v9
v_mul_f32 v190, v190, v9
v_mul_f32 v191, v191, v9
v_mul_f32 v196, v196, v9
v_mul_f32 v197, v197, v9
v_mul_f32 v198, v198, v9
v_mul_f32 v199, v199, v9
v_mul_f32 v204, v204, v9
v_mul_f32 v205, v205, v9
v_mul_f32 v206, v206, v9
v_mul_f32 v207, v207, v9
v_mul_f32 v212, v212, v9
v_mul_f32 v213, v213, v9
v_mul_f32 v214, v214, v9
v_mul_f32 v215, v215, v9
v_mul_f32 v220, v220, v9
v_mul_f32 v221, v221, v9
v_mul_f32 v222, v222, v9
v_mul_f32 v223, v223, v9
v_mul_f32 v228, v228, v9
v_mul_f32 v229, v229, v9
v_mul_f32 v230, v230, v9
v_mul_f32 v231, v231, v9
v_mul_f32 v236, v236, v9
v_mul_f32 v237, v237, v9
v_mul_f32 v238, v238, v9
v_mul_f32 v239, v239, v9
v_mul_f32 v244, v244, v9
v_mul_f32 v245, v245, v9
v_mul_f32 v246, v246, v9
v_mul_f32 v247, v247, v9
v_mul_f32 v252, v252, v9
v_mul_f32 v253, v253, v9
v_mul_f32 v254, v254, v9
v_mul_f32 v255, v255, v9
v_sub_f32 v68, v68, v8
v_sub_f32 v69, v69, v8
v_sub_f32 v70, v70, v8
v_sub_f32 v71, v71, v8
v_sub_f32 v76, v76, v8
v_sub_f32 v77, v77, v8
v_sub_f32 v78, v78, v8
v_sub_f32 v79, v79, v8
v_sub_f32 v84, v84, v8
v_sub_f32 v85, v85, v8
v_sub_f32 v86, v86, v8
v_sub_f32 v87, v87, v8
v_sub_f32 v92, v92, v8
v_sub_f32 v93, v93, v8
v_sub_f32 v94, v94, v8
v_sub_f32 v95, v95, v8
v_exp_f32 v8, v68
v_exp_f32 v9, v69
v_exp_f32 v10, v70
v_exp_f32 v11, v71
s_nop 0
v_add_f32 v27, v8, v9
v_cvt_pk_bf16_f32 v120, v8, v9
v_add_f32 v27, v27, v10
v_add_f32 v27, v27, v11
v_cvt_pk_bf16_f32 v121, v10, v11
v_exp_f32 v12, v76
v_exp_f32 v13, v77
v_exp_f32 v14, v78
v_exp_f32 v15, v79
s_nop 0
v_add_f32 v27, v27, v12
v_add_f32 v27, v27, v13
v_cvt_pk_bf16_f32 v122, v12, v13
v_add_f32 v27, v27, v14
v_add_f32 v27, v27, v15
v_cvt_pk_bf16_f32 v123, v14, v15
v_exp_f32 v8, v84
v_exp_f32 v9, v85
v_exp_f32 v10, v86
v_exp_f32 v11, v87
s_nop 0
v_add_f32 v27, v27, v8
v_add_f32 v27, v27, v9
v_cvt_pk_bf16_f32 v124, v8, v9
v_add_f32 v27, v27, v10
v_add_f32 v27, v27, v11
v_cvt_pk_bf16_f32 v125, v10, v11
v_exp_f32 v12, v92
v_exp_f32 v13, v93
v_exp_f32 v14, v94
v_exp_f32 v15, v95
s_nop 0
v_add_f32 v27, v27, v12
v_add_f32 v27, v27, v13
v_cvt_pk_bf16_f32 v126, v12, v13
v_add_f32 v27, v27, v14
v_add_f32 v27, v27, v15
v_cvt_pk_bf16_f32 v127, v14, v15
s_nop 1
s_setpc_b64 s[16:17]
M_cntspinK:
Lp_9801:
buffer_load_dword v245, off, s[60:63], s54 sc1
s_waitcnt vmcnt(0)
v_cmp_gt_u32 vcc, s50, v245
s_cbranch_vccz Lpd_9802
s_sleep 8
s_sub_u32 s101, s101, 1
s_cbranch_scc0 Lp_9801
s_mov_b32 s101, 0
Lpd_9802:
s_branch Lg_1
M_cntspinV:
Lp_9803:
buffer_load_dword v245, off, s[60:63], s54 sc1
s_waitcnt vmcnt(0)
v_cmp_gt_u32 vcc, s50, v245
s_cbranch_vccz Lpd_9804
s_sleep 8
s_sub_u32 s101, s101, 1
s_cbranch_scc0 Lp_9803
s_mov_b32 s101, 0
Lpd_9804:
s_branch Lg_501
M_ppspinV:
Lp_9805:
buffer_load_dword v230, v231, s[4:7], s52 offen sc1
s_waitcnt vmcnt(0)
v_cmp_gt_u32 vcc, 1, v230
s_cbranch_vccz Lpd_9806
s_sleep 8
s_sub_u32 s101, s101, 1
s_cbranch_scc0 Lp_9805
s_mov_b32 s101, 0
Lpd_9806:
s_branch M_ppokV
M_end:
s_endpgm
.section .rodata,"a"
.p2align 6
.amdhsa_kernel concat_heads__ssm_conv_h3__compressed_kv_cla__prompt_kernel
  .amdhsa_next_free_vgpr 512
  .amdhsa_next_free_sgpr 102
  .amdhsa_accum_offset 256
  .amdhsa_group_segment_fixed_size 0
  .amdhsa_kernarg_size 120
  .amdhsa_user_sgpr_count 2
  .amdhsa_user_sgpr_kernarg_segment_ptr 1
  .amdhsa_system_sgpr_workgroup_id_x 1
  .amdhsa_float_denorm_mode_32 3
  .amdhsa_float_denorm_mode_16_64 3
  .amdhsa_ieee_mode 0
  .amdhsa_dx10_clamp 0
.end_amdhsa_kernel
```

```asm
; @launch grid=(256,1,1) block=(256,1,1) lds=163840
.amdgcn_target "amdgcn-amd-amdhsa--gfx950"
.text
.globl concat_heads__ssm_conv_h3__compressed_kv_cla__prompt_kernel
.p2align 8
.type concat_heads__ssm_conv_h3__compressed_kv_cla__prompt_kernel,@function
concat_heads__ssm_conv_h3__compressed_kv_cla__prompt_kernel:
s_cmp_ge_u32 s2, 256
s_cbranch_scc1 M_end
s_load_dwordx16 s[64:79], s[0:1], 0
s_load_dwordx8 s[80:87], s[0:1], 64
s_load_dwordx4 s[88:91], s[0:1], 96
s_load_dwordx2 s[92:93], s[0:1], 112
s_getpc_b64 s[58:59]
M_pc:
s_lshr_b32 s22, s2, 3
s_lshl_b32 s22, s22, 5
v_and_b32 v26, 31, v0
v_add_u32 v26, s22, v26
v_lshlrev_b32 v26, 7, v26
v_min_u32 v26, M_end-M_pc, v26
v_mov_b32 v27, s59
v_add_co_u32 v26, vcc, s58, v26
s_nop 1
v_addc_co_u32 v27, vcc, 0, v27, vcc
global_load_dword v21, v[26:27], off
v_lshrrev_b32 v28, 6, v0
v_and_b32 v29, 63, v0
v_lshlrev_b32 v1, 4, v29
v_readfirstlane_b32 s3, v28
s_lshr_b32 s21, s2, 5
v_lshrrev_b32 v26, 7, v1
v_lshrrev_b32 v27, 1, v26
v_lshlrev_b32 v27, 4, v27
v_and_b32 v28, 0x70, v1
v_xor_b32 v27, v27, v28
v_mul_u32_u24 v26, 2048, v26
v_add_u32 v12, v26, v27
v_xor_b32 v27, 64, v27
v_add_u32 v26, v26, v27
v_add_u32 v13, 15360, v26
v_add_u32 v14, 30720, v12
v_add_u32 v15, 46080, v26
s_lshl_b32 s28, s3, 13
s_lshl_b32 s24, s21, 19
s_lshl_b32 s22, s3, 17
s_add_u32 s24, s24, s22
s_add_u32 s25, s24, 65536
s_mov_b32 s10, 4194304
s_mov_b32 s11, 0x20000
s_and_b32 s20, s2, 7
s_lshl_b32 s20, s20, 1
s_bfe_u32 s22, s2, 0x10003
s_add_u32 s20, s20, s22
v_lshrrev_b32 v26, 5, v29
v_and_b32 v27, 31, v29
s_and_b32 s22, s3, 1
s_lshl_b32 s22, s22, 2
v_or_b32 v28, s22, v26
v_lshlrev_b32 v28, 1, v28
v_xor_b32 v27, v27, v28
v_lshlrev_b32 v27, 4, v27
v_lshl_add_u32 v16, v26, 13, v27
v_xor_b32 v26, 64, v16
v_add_u32 v17, 15360, v26
v_add_u32 v18, 30720, v16
v_add_u32 v19, 46080, v26
s_lshl_b32 s29, s3, 12
s_lshl_b32 s26, s3, 16
s_lshl_b32 s22, s20, 9
s_add_u32 s26, s26, s22
s_add_u32 s27, s26, 262144
s_mov_b32 s14, 8388608
s_mov_b32 s15, 0x20000
s_mov_b32 s101, 0x40000
v_and_b32 v30, 15, v29
v_lshrrev_b32 v31, 4, v29
v_lshrrev_b32 v26, 1, v30
v_xor_b32 v26, v31, v26
v_lshlrev_b32 v26, 4, v26
v_lshl_add_u32 v2, v30, 7, v26
s_lshr_b32 s22, s3, 1
s_lshl_b32 s22, s22, 14
v_add_u32 v2, s22, v2
v_xor_b32 v3, 64, v2
v_lshrrev_b32 v26, 2, v30
v_and_b32 v27, 1, v31
v_lshl_or_b32 v27, v27, 2, v26
v_lshl_add_u32 v26, v31, 3, v26
v_lshlrev_b32 v26, 9, v26
v_lshl_add_u32 v26, v27, 5, v26
v_and_b32 v27, 3, v29
v_lshl_add_u32 v26, v27, 3, v26
s_and_b32 s22, s3, 1
s_lshl_b32 s22, s22, 8
s_add_u32 s22, s22, 0x10000
v_xor_b32 v4, s22, v26
v_xor_b32 v5, 32, v4
v_xor_b32 v6, 64, v4
v_xor_b32 v7, 96, v4
v_xor_b32 v8, 128, v4
v_xor_b32 v9, 160, v4
v_xor_b32 v10, 192, v4
v_xor_b32 v11, 224, v4
s_mov_b32 s19, 0x20000
s_cmp_eq_u32 s3, 2
s_cbranch_scc1 M_pf2
s_cmp_lg_u32 s3, 0
s_cbranch_scc1 M_pf3
s_mov_b32 s18, 8388608
s_mov_b32 s51, 8388608
s_mov_b32 s47, 524288
s_mov_b32 s43, 524288
s_lshl_b32 s22, s21, 16
s_lshl_b32 s23, s20, 9
s_add_u32 s22, s22, s23
v_bfe_u32 v26, v29, 2, 3
v_lshl_add_u32 v26, v26, 13, s22
v_and_b32 v27, 3, v29
v_lshl_add_u32 v20, v27, 7, v26
v_lshrrev_b32 v27, 5, v29
v_lshl_add_u32 v22, v27, 19, v20
s_mov_b32 s47, 786432
s_mov_b32 s43, 0
v_add_u32 v22, 524288, v22
s_mul_i32 s22, s21, 98304
s_add_u32 s22, s22, s23
v_lshrrev_b32 v26, 2, v29
v_lshl_add_u32 v26, v26, 13, s22
v_and_b32 v27, 3, v29
v_lshl_add_u32 v20, v27, 7, v26
v_cmp_gt_u32 vcc, 48, v29
s_branch M_pfd
M_pf2:
s_mov_b32 s18, 4194304
s_mov_b32 s51, 2048
s_mov_b32 s47, 256
s_mov_b32 s43, 0
s_lshl_b32 s22, s2, 14
v_bfe_u32 v26, v29, 1, 3
v_lshl_add_u32 v26, v26, 11, s22
v_and_b32 v27, 1, v29
v_lshl_add_u32 v20, v27, 7, v26
v_bfe_u32 v27, v29, 4, 1
v_lshl_add_u32 v22, v27, 8, v20
v_cmp_gt_u32 vcc, 16, v29
s_branch M_pfd
M_pf3:
s_mov_b32 s18, 0
s_mov_b32 s51, 2260992
s_mov_b32 s47, 753664
s_mov_b32 s43, 0
s_mul_i32 s22, s2, 2944
v_lshl_add_u32 v20, v29, 7, s22
v_mov_b32 v22, v20
v_cmp_gt_u32 vcc, 23, v29
M_pfd:
v_mov_b32 v26, 3221225472
s_nop 0
v_cndmask_b32 v20, v26, v20, vcc
s_bitcmp1_b32 s2, 4
s_waitcnt lgkmcnt(0)
s_mov_b64 s[8:9], s[78:79]
s_cselect_b64 s[12:13], s[84:85], s[82:83]
s_cmp_eq_u32 s3, 2
s_cselect_b32 s22, 0, 3221225472
buffer_load_dword v21, v20, s[8:11], s22 offen
s_add_u32 m0, s28, 0
s_nop 0
buffer_load_dwordx4 v12, s[8:11], s24 offen offset:0 lds
buffer_load_dwordx4 v13, s[8:11], s24 offen offset:1024 lds
buffer_load_dwordx4 v14, s[8:11], s24 offen offset:2048 lds
buffer_load_dwordx4 v15, s[8:11], s24 offen offset:3072 lds
s_add_u32 s24, s24, 128
s_add_u32 m0, s28, 4096
s_nop 0
buffer_load_dwordx4 v12, s[8:11], s25 offen offset:0 lds
buffer_load_dwordx4 v13, s[8:11], s25 offen offset:1024 lds
buffer_load_dwordx4 v14, s[8:11], s25 offen offset:2048 lds
buffer_load_dwordx4 v15, s[8:11], s25 offen offset:3072 lds
s_add_u32 s25, s25, 128
s_add_u32 m0, s29, 65536
s_nop 0
buffer_load_dwordx4 v16, s[12:15], s26 offen offset:0 lds
buffer_load_dwordx4 v17, s[12:15], s26 offen offset:1024 lds
buffer_load_dwordx4 v18, s[12:15], s26 offen offset:2048 lds
buffer_load_dwordx4 v19, s[12:15], s26 offen offset:3072 lds
s_add_u32 s26, s26, 524288
s_add_u32 m0, s29, 81920
s_nop 0
buffer_load_dwordx4 v16, s[12:15], s27 offen offset:0 lds
buffer_load_dwordx4 v17, s[12:15], s27 offen offset:1024 lds
buffer_load_dwordx4 v18, s[12:15], s27 offen offset:2048 lds
buffer_load_dwordx4 v19, s[12:15], s27 offen offset:3072 lds
s_add_u32 s27, s27, 524288
s_mov_b64 exec, 0
s_bfe_u32 s22, s2, 0x10004
s_lshl_b32 s22, s22, 2
s_add_u32 s22, s22, s3
s_cmp_lg_u32 s22, 0
s_cbranch_scc1 M_tw1
s_call_b64 s[98:99], PAD_0
s_call_b64 s[98:99], PAD_8
s_call_b64 s[98:99], PAD_12
s_call_b64 s[98:99], PAD_16
s_branch M_td
M_tw1:
s_cmp_lg_u32 s22, 1
s_cbranch_scc1 M_tw2
s_call_b64 s[98:99], PAD_1
s_call_b64 s[98:99], PAD_9
s_call_b64 s[98:99], PAD_13
s_branch M_td
M_tw2:
s_cmp_lg_u32 s22, 2
s_cbranch_scc1 M_tw3
s_call_b64 s[98:99], PAD_2
s_call_b64 s[98:99], PAD_6
s_call_b64 s[98:99], PAD_10
s_call_b64 s[98:99], PAD_14
s_branch M_td
M_tw3:
s_cmp_lg_u32 s22, 3
s_cbranch_scc1 M_tw4
s_call_b64 s[98:99], PAD_3
s_call_b64 s[98:99], PAD_7
s_call_b64 s[98:99], PAD_11
s_call_b64 s[98:99], PAD_15
s_branch M_td
M_tw4:
s_cmp_lg_u32 s22, 4
s_cbranch_scc1 M_tw5
s_call_b64 s[98:99], PAD_22
s_branch M_td
M_tw5:
s_cmp_lg_u32 s22, 5
s_cbranch_scc1 M_tw6
s_call_b64 s[98:99], PAD_23
s_branch M_td
M_tw6:
s_cmp_lg_u32 s22, 6
s_cbranch_scc1 M_tw7
s_call_b64 s[98:99], PAD_24
s_branch M_td
M_tw7:
s_call_b64 s[98:99], PAD_21
M_td:
s_mov_b64 exec, -1
s_cmp_eq_u32 s3, 0
s_cselect_b64 s[16:17], s[12:13], s[8:9]
buffer_load_dword v21, v22, s[16:19], s43 offen
s_add_u32 s43, s43, s47
s_add_u32 s43, s43, s47
s_add_u32 m0, s28, 32768
s_nop 0
buffer_load_dwordx4 v12, s[8:11], s24 offen offset:0 lds
buffer_load_dwordx4 v13, s[8:11], s24 offen offset:1024 lds
buffer_load_dwordx4 v14, s[8:11], s24 offen offset:2048 lds
buffer_load_dwordx4 v15, s[8:11], s24 offen offset:3072 lds
s_add_u32 s24, s24, 128
s_add_u32 m0, s28, 36864
s_nop 0
buffer_load_dwordx4 v12, s[8:11], s25 offen offset:0 lds
buffer_load_dwordx4 v13, s[8:11], s25 offen offset:1024 lds
buffer_load_dwordx4 v14, s[8:11], s25 offen offset:2048 lds
buffer_load_dwordx4 v15, s[8:11], s25 offen offset:3072 lds
s_add_u32 s25, s25, 128
s_mov_b32 s4, s92
s_mov_b32 s5, s93
s_mov_b32 s6, 268435456
s_mov_b32 s7, 0x20000
s_cmp_eq_u32 s3, 3
s_cselect_b64 s[40:41], s[76:77], s[80:81]
s_cselect_b32 s42, 1835008, 0
s_cmp_eq_u32 s3, 1
s_cselect_b32 s42, 3670016, s42
s_cmp_eq_u32 s3, 3
s_cselect_b64 s[44:45], s[86:87], s[72:73]
s_cselect_b32 s46, 3670016, 0
s_cmp_eq_u32 s3, 1
s_cselect_b32 s46, 1835008, s46
s_cmp_eq_u32 s3, 2
s_cselect_b64 s[40:41], s[64:65], s[40:41]
s_cselect_b32 s42, 1835008, s42
s_waitcnt vmcnt(17)
s_barrier
ds_read_b128 a[0:3], v2 offset:0
ds_read_b128 a[4:7], v3 offset:0
ds_read_b128 a[8:11], v2 offset:2048
ds_read_b128 a[12:15], v3 offset:2048
ds_read_b128 a[16:19], v2 offset:4096
ds_read_b128 a[20:23], v3 offset:4096
ds_read_b128 a[24:27], v2 offset:6144
ds_read_b128 a[28:31], v3 offset:6144
ds_read_b128 a[32:35], v2 offset:8192
ds_read_b128 a[36:39], v3 offset:8192
ds_read_b128 a[40:43], v2 offset:10240
ds_read_b128 a[44:47], v3 offset:10240
ds_read_b128 a[48:51], v2 offset:12288
ds_read_b128 a[52:55], v3 offset:12288
ds_read_b128 a[56:59], v2 offset:14336
ds_read_b128 a[60:63], v3 offset:14336
s_waitcnt vmcnt(9) lgkmcnt(0)
s_barrier
ds_read_b64_tr_b16 a[128:129], v4 offset:0
ds_read_b64_tr_b16 a[130:131], v4 offset:2048
ds_read_b64_tr_b16 a[132:133], v4 offset:16384
ds_read_b64_tr_b16 a[134:135], v4 offset:18432
s_waitcnt lgkmcnt(0)
s_bitcmp1_b32 s2, 4
s_cbranch_scc1 M_V
s_branch M_K
M_t2B:
s_mov_b64 exec, 0
s_cmp_lg_u32 s3, 0
s_cbranch_scc1 M_uw1
s_call_b64 s[98:99], PAD_32
s_call_b64 s[98:99], PAD_16
s_branch M_ud
M_uw1:
s_cmp_lg_u32 s3, 1
s_cbranch_scc1 M_uw2
s_call_b64 s[98:99], PAD_9
s_call_b64 s[98:99], PAD_33
s_call_b64 s[98:99], PAD_13
s_branch M_ud
M_uw2:
s_cmp_lg_u32 s3, 2
s_cbranch_scc1 M_uw3
s_call_b64 s[98:99], PAD_10
s_call_b64 s[98:99], PAD_34
s_call_b64 s[98:99], PAD_14
s_branch M_ud
M_uw3:
s_call_b64 s[98:99], PAD_11
s_call_b64 s[98:99], PAD_15
M_ud:
s_mov_b64 exec, -1
s_branch M_t2Br
M_t2A:
s_mov_b64 exec, 0
s_lshl_b32 s22, s24, 2
s_add_u32 s22, s22, s3
s_cmp_lg_u32 s22, 0
s_cbranch_scc1 M_vw1
s_call_b64 s[98:99], PAD_32
s_call_b64 s[98:99], PAD_16
s_branch M_vd
M_vw1:
s_cmp_lg_u32 s22, 1
s_cbranch_scc1 M_vw2
s_call_b64 s[98:99], PAD_13
s_branch M_vd
M_vw2:
s_cmp_lg_u32 s22, 2
s_cbranch_scc1 M_vw3
s_call_b64 s[98:99], PAD_14
s_call_b64 s[98:99], PAD_19
s_branch M_vd
M_vw3:
s_cmp_lg_u32 s22, 3
s_cbranch_scc1 M_vw4
s_call_b64 s[98:99], PAD_15
s_call_b64 s[98:99], PAD_20
s_branch M_vd
M_vw4:
s_cmp_lg_u32 s22, 4
s_cbranch_scc1 M_vw5
s_call_b64 s[98:99], PAD_12
s_call_b64 s[98:99], PAD_16
s_branch M_vd
M_vw5:
s_cmp_lg_u32 s22, 5
s_cbranch_scc1 M_vw6
s_call_b64 s[98:99], PAD_13
s_branch M_vd
M_vw6:
s_cmp_lg_u32 s22, 6
s_cbranch_scc1 M_vw7
s_call_b64 s[98:99], PAD_14
s_branch M_vd
M_vw7:
s_call_b64 s[98:99], PAD_15
M_vd:
s_mov_b64 exec, -1
s_branch M_t2Ar
M_tret:
s_setpc_b64 s[98:99]
.p2align 12
PAD_0:
s_cbranch_execz PAD_4
M_K:
v_mfma_f32_16x16x32_bf16 v[32:35], a[128:131], a[0:3], 0
s_add_u32 m0, s29, 98304
ds_read_b64_tr_b16 a[136:137], v5 offset:0
v_mfma_f32_16x16x32_bf16 v[32:35], a[132:135], a[4:7], v[32:35]
s_mov_b32 s32, 8192
buffer_load_dwordx4 v16, s[12:15], s26 offen offset:0 lds
v_mfma_f32_16x16x32_bf16 v[40:43], a[128:131], a[8:11], 0
s_mov_b32 s33, 8192
ds_read_b64_tr_b16 a[138:139], v5 offset:2048
v_mfma_f32_16x16x32_bf16 v[40:43], a[132:135], a[12:15], v[40:43]
s_mov_b32 s34, 8192
v_mfma_f32_16x16x32_bf16 v[48:51], a[128:131], a[16:19], 0
s_mov_b32 s35, 4294910976
ds_read_b64_tr_b16 a[140:141], v5 offset:16384
v_mfma_f32_16x16x32_bf16 v[48:51], a[132:135], a[20:23], v[48:51]
s_mov_b32 s36, 4294910976
buffer_load_dwordx4 v17, s[12:15], s26 offen offset:1024 lds
v_mfma_f32_16x16x32_bf16 v[56:59], a[128:131], a[24:27], 0
s_mov_b32 s30, 8
ds_read_b64_tr_b16 a[142:143], v5 offset:18432
v_mfma_f32_16x16x32_bf16 v[56:59], a[132:135], a[28:31], v[56:59]
s_mov_b32 s82, 3221225472
v_mfma_f32_16x16x32_bf16 v[64:67], a[128:131], a[32:35], 0
s_mul_hi_u32 s38, s2, 613566757
v_mfma_f32_16x16x32_bf16 v[64:67], a[132:135], a[36:39], v[64:67]
s_mul_i32 s39, s38, 7
buffer_load_dwordx4 v18, s[12:15], s26 offen offset:2048 lds
v_mfma_f32_16x16x32_bf16 v[72:75], a[128:131], a[40:43], 0
s_sub_u32 s39, s2, s39
v_mov_b32 v246, 0
v_mov_b32 v229, 0
v_mfma_f32_16x16x32_bf16 v[72:75], a[132:135], a[44:47], v[72:75]
v_mov_b32 v231, 0
v_mfma_f32_16x16x32_bf16 v[80:83], a[128:131], a[48:51], 0
s_mov_b32 s60, s90
v_mfma_f32_16x16x32_bf16 v[80:83], a[132:135], a[52:55], v[80:83]
s_mov_b32 s61, s91
buffer_load_dwordx4 v19, s[12:15], s26 offen offset:3072 lds
v_mfma_f32_16x16x32_bf16 v[88:91], a[128:131], a[56:59], 0
s_add_u32 s26, s26, 524288
v_mfma_f32_16x16x32_bf16 v[88:91], a[132:135], a[60:63], v[88:91]
s_waitcnt lgkmcnt(0)
s_mov_b32 s62, 256
v_mfma_f32_16x16x32_bf16 v[36:39], a[136:139], a[0:3], 0
s_add_u32 m0, s29, 114688
ds_read_b64_tr_b16 a[128:129], v6 offset:0
v_mfma_f32_16x16x32_bf16 v[36:39], a[140:143], a[4:7], v[36:39]
s_mov_b32 s63, 0x20000
buffer_load_dwordx4 v16, s[12:15], s27 offen offset:0 lds
v_mfma_f32_16x16x32_bf16 v[44:47], a[136:139], a[8:11], 0
s_mul_hi_u32 s55, s2, 1431655766
ds_read_b64_tr_b16 a[130:131], v6 offset:2048
v_mfma_f32_16x16x32_bf16 v[44:47], a[140:143], a[12:15], v[44:47]
s_mul_i32 s55, s55, 3
v_mfma_f32_16x16x32_bf16 v[52:55], a[136:139], a[16:19], 0
s_sub_u32 s55, s2, s55
ds_read_b64_tr_b16 a[132:133], v6 offset:16384
v_mfma_f32_16x16x32_bf16 v[52:55], a[140:143], a[20:23], v[52:55]
s_add_u32 s55, s55, 5
buffer_load_dwordx4 v17, s[12:15], s27 offen offset:1024 lds
v_mfma_f32_16x16x32_bf16 v[60:63], a[136:139], a[24:27], 0
s_lshr_b32 s22, s2, 4
ds_read_b64_tr_b16 a[134:135], v6 offset:18432
v_mfma_f32_16x16x32_bf16 v[60:63], a[140:143], a[28:31], v[60:63]
s_lshl_b32 s23, s20, 5
v_mfma_f32_16x16x32_bf16 v[68:71], a[136:139], a[32:35], 0
s_add_u32 s23, s23, s22
v_mfma_f32_16x16x32_bf16 v[68:71], a[140:143], a[36:39], v[68:71]
s_lshl_b32 s23, s23, 2
buffer_load_dwordx4 v18, s[12:15], s27 offen offset:2048 lds
v_mfma_f32_16x16x32_bf16 v[76:79], a[136:139], a[40:43], 0
s_and_b32 s22, s2, 16
v_mfma_f32_16x16x32_bf16 v[76:79], a[140:143], a[44:47], v[76:79]
s_lshl_b32 s22, s22, 7
v_mfma_f32_16x16x32_bf16 v[84:87], a[136:139], a[48:51], 0
s_add_u32 s23, s23, s22
v_mov_b32 v28, 3221225472
v_writelane_b32 v28, s23, 0
v_mfma_f32_16x16x32_bf16 v[84:87], a[140:143], a[52:55], v[84:87]
s_add_u32 s56, s23, 16384
buffer_load_dwordx4 v19, s[12:15], s27 offen offset:3072 lds
v_mfma_f32_16x16x32_bf16 v[92:95], a[136:139], a[56:59], 0
s_add_u32 s27, s27, 524288
v_writelane_b32 v28, s56, 1
v_mfma_f32_16x16x32_bf16 v[92:95], a[140:143], a[60:63], v[92:95]
s_waitcnt lgkmcnt(0)
s_add_u32 s56, s23, 4096
v_writelane_b32 v28, s56, 2
v_mfma_f32_16x16x32_bf16 v[96:99], a[128:131], a[0:3], 0
s_add_u32 m0, s28, 0
ds_read_b64_tr_b16 a[136:137], v7 offset:0
v_mfma_f32_16x16x32_bf16 v[96:99], a[132:135], a[4:7], v[96:99]
s_sub_u32 s37, 15, s21
buffer_load_dwordx4 v12, s[8:11], s24 offen offset:0 lds
v_mfma_f32_16x16x32_bf16 v[104:107], a[128:131], a[8:11], 0
ds_read_b64_tr_b16 a[138:139], v7 offset:2048
v_mfma_f32_16x16x32_bf16 v[104:107], a[132:135], a[12:15], v[104:107]
v_mfma_f32_16x16x32_bf16 v[112:115], a[128:131], a[16:19], 0
ds_read_b64_tr_b16 a[140:141], v7 offset:16384
v_mfma_f32_16x16x32_bf16 v[112:115], a[132:135], a[20:23], v[112:115]
buffer_load_dwordx4 v13, s[8:11], s24 offen offset:1024 lds
v_mfma_f32_16x16x32_bf16 v[120:123], a[128:131], a[24:27], 0
ds_read_b64_tr_b16 a[142:143], v7 offset:18432
v_mfma_f32_16x16x32_bf16 v[120:123], a[132:135], a[28:31], v[120:123]
v_mfma_f32_16x16x32_bf16 v[128:131], a[128:131], a[32:35], 0
v_mfma_f32_16x16x32_bf16 v[128:131], a[132:135], a[36:39], v[128:131]
buffer_load_dwordx4 v14, s[8:11], s24 offen offset:2048 lds
v_mfma_f32_16x16x32_bf16 v[136:139], a[128:131], a[40:43], 0
v_mfma_f32_16x16x32_bf16 v[136:139], a[132:135], a[44:47], v[136:139]
v_mfma_f32_16x16x32_bf16 v[144:147], a[128:131], a[48:51], 0
v_mfma_f32_16x16x32_bf16 v[144:147], a[132:135], a[52:55], v[144:147]
buffer_load_dwordx4 v15, s[8:11], s24 offen offset:3072 lds
v_mfma_f32_16x16x32_bf16 v[152:155], a[128:131], a[56:59], 0
s_add_u32 s24, s24, 128
v_mfma_f32_16x16x32_bf16 v[152:155], a[132:135], a[60:63], v[152:155]
s_waitcnt vmcnt(12) lgkmcnt(0)
s_barrier
v_mfma_f32_16x16x32_bf16 v[100:103], a[136:139], a[0:3], 0
s_add_u32 m0, s28, 4096
ds_read_b64_tr_b16 a[128:129], v8 offset:0
v_mfma_f32_16x16x32_bf16 v[100:103], a[140:143], a[4:7], v[100:103]
buffer_load_dwordx4 v12, s[8:11], s25 offen offset:0 lds
v_mfma_f32_16x16x32_bf16 v[108:111], a[136:139], a[8:11], 0
ds_read_b64_tr_b16 a[130:131], v8 offset:2048
v_mfma_f32_16x16x32_bf16 v[108:111], a[140:143], a[12:15], v[108:111]
v_mfma_f32_16x16x32_bf16 v[116:119], a[136:139], a[16:19], 0
ds_read_b64_tr_b16 a[132:133], v8 offset:16384
v_mfma_f32_16x16x32_bf16 v[116:119], a[140:143], a[20:23], v[116:119]
buffer_load_dwordx4 v13, s[8:11], s25 offen offset:1024 lds
v_mfma_f32_16x16x32_bf16 v[124:127], a[136:139], a[24:27], 0
ds_read_b64_tr_b16 a[134:135], v8 offset:18432
v_mfma_f32_16x16x32_bf16 v[124:127], a[140:143], a[28:31], v[124:127]
v_mfma_f32_16x16x32_bf16 v[132:135], a[136:139], a[32:35], 0
ds_read_b128 a[64:67], v2 offset:32768
v_mfma_f32_16x16x32_bf16 v[132:135], a[140:143], a[36:39], v[132:135]
buffer_load_dwordx4 v14, s[8:11], s25 offen offset:2048 lds
v_mfma_f32_16x16x32_bf16 v[140:143], a[136:139], a[40:43], 0
ds_read_b128 a[68:71], v3 offset:32768
v_mfma_f32_16x16x32_bf16 v[140:143], a[140:143], a[44:47], v[140:143]
ds_read_b128 a[72:75], v2 offset:34816
v_mfma_f32_16x16x32_bf16 v[148:151], a[136:139], a[48:51], 0
ds_read_b128 a[76:79], v3 offset:34816
v_mfma_f32_16x16x32_bf16 v[148:151], a[140:143], a[52:55], v[148:151]
buffer_load_dwordx4 v15, s[8:11], s25 offen offset:3072 lds
v_mfma_f32_16x16x32_bf16 v[156:159], a[136:139], a[56:59], 0
s_add_u32 s25, s25, 128
ds_read_b128 a[80:83], v2 offset:36864
v_mfma_f32_16x16x32_bf16 v[156:159], a[140:143], a[60:63], v[156:159]
s_waitcnt lgkmcnt(5)
ds_read_b128 a[84:87], v3 offset:36864
v_mfma_f32_16x16x32_bf16 v[160:163], a[128:131], a[0:3], 0
s_bitcmp1_b32 s2, 4
s_cselect_b32 s37, s21, s37
ds_read_b64_tr_b16 a[136:137], v9 offset:0
v_mfma_f32_16x16x32_bf16 v[160:163], a[132:135], a[4:7], v[160:163]
s_lshl_b32 s56, s37, 5
s_add_u32 s56, s56, s20
s_lshl_b32 s56, s56, 2
v_mfma_f32_16x16x32_bf16 v[168:171], a[128:131], a[8:11], 0
s_add_u32 s56, s56, 8192
ds_read_b64_tr_b16 a[138:139], v9 offset:2048
v_writelane_b32 v28, s56, 3
v_mfma_f32_16x16x32_bf16 v[168:171], a[132:135], a[12:15], v[168:171]
s_add_u32 s56, s56, 2048
v_writelane_b32 v28, s56, 6
v_mfma_f32_16x16x32_bf16 v[176:179], a[128:131], a[16:19], 0
s_add_u32 s56, s56, 4096
ds_read_b64_tr_b16 a[140:141], v9 offset:16384
v_writelane_b32 v28, s56, 5
v_mfma_f32_16x16x32_bf16 v[176:179], a[132:135], a[20:23], v[176:179]
s_lshl_b32 s56, s2, 2
s_add_u32 s56, s56, 12288
v_writelane_b32 v28, s56, 4
v_mfma_f32_16x16x32_bf16 v[184:187], a[128:131], a[24:27], 0
s_lshl_b32 s56, s39, 5
s_add_u32 s56, s56, s38
ds_read_b64_tr_b16 a[142:143], v9 offset:18432
v_mfma_f32_16x16x32_bf16 v[184:187], a[132:135], a[28:31], v[184:187]
s_lshl_b32 s56, s56, 2
s_add_u32 s56, s56, 20480
s_cmp_lt_u32 s2, 224
v_mfma_f32_16x16x32_bf16 v[192:195], a[128:131], a[32:35], 0
s_cselect_b32 s56, s56, 3221225472
v_writelane_b32 v28, s56, 7
v_mfma_f32_16x16x32_bf16 v[192:195], a[132:135], a[36:39], v[192:195]
s_cmp_eq_u32 s3, 0
s_cselect_b32 s56, 94371840, 3221225472
v_mfma_f32_16x16x32_bf16 v[200:203], a[128:131], a[40:43], 0
ds_read_b128 a[88:91], v2 offset:38912
v_mfma_f32_16x16x32_bf16 v[200:203], a[132:135], a[44:47], v[200:203]
ds_read_b128 a[92:95], v3 offset:38912
v_mfma_f32_16x16x32_bf16 v[208:211], a[128:131], a[48:51], 0
ds_read_b128 a[96:99], v2 offset:40960
v_mfma_f32_16x16x32_bf16 v[208:211], a[132:135], a[52:55], v[208:211]
buffer_store_dword v246, v28, s[4:7], s56 offen sc1
v_mfma_f32_16x16x32_bf16 v[216:219], a[128:131], a[56:59], 0
ds_read_b128 a[100:103], v3 offset:40960
v_mov_b32 v27, 1
v_mfma_f32_16x16x32_bf16 v[216:219], a[132:135], a[60:63], v[216:219]
s_waitcnt lgkmcnt(4)
ds_read_b128 a[104:107], v2 offset:43008
v_cmp_eq_u32 vcc, 0, v0
v_mfma_f32_16x16x32_bf16 v[164:167], a[136:139], a[0:3], 0
ds_read_b64_tr_b16 a[128:129], v10 offset:0
v_mov_b32 v26, 3221225472
v_mfma_f32_16x16x32_bf16 v[164:167], a[140:143], a[4:7], v[164:167]
s_lshl_b32 s31, s20, 20
s_lshl_b32 s22, s21, 17
v_cndmask_b32 v26, v26, v246, vcc
v_mfma_f32_16x16x32_bf16 v[172:175], a[136:139], a[8:11], 0
s_add_u32 s31, s31, s22
s_lshr_b32 s22, s3, 1
ds_read_b64_tr_b16 a[130:131], v10 offset:2048
v_mfma_f32_16x16x32_bf16 v[172:175], a[140:143], a[12:15], v[172:175]
s_lshl_b32 s22, s22, 16
s_add_u32 s31, s31, s22
s_and_b32 s22, s3, 1
v_mfma_f32_16x16x32_bf16 v[180:183], a[136:139], a[16:19], 0
s_lshl_b32 s22, s22, 12
s_add_u32 s31, s31, s22
ds_read_b64_tr_b16 a[132:133], v10 offset:16384
v_mfma_f32_16x16x32_bf16 v[180:183], a[140:143], a[20:23], v[180:183]
v_mfma_f32_16x16x32_bf16 v[188:191], a[136:139], a[24:27], 0
ds_read_b64_tr_b16 a[134:135], v10 offset:18432
v_mfma_f32_16x16x32_bf16 v[188:191], a[140:143], a[28:31], v[188:191]
v_mfma_f32_16x16x32_bf16 v[196:199], a[136:139], a[32:35], 0
v_mfma_f32_16x16x32_bf16 v[196:199], a[140:143], a[36:39], v[196:199]
v_mfma_f32_16x16x32_bf16 v[204:207], a[136:139], a[40:43], 0
ds_read_b128 a[108:111], v3 offset:43008
v_mfma_f32_16x16x32_bf16 v[204:207], a[140:143], a[44:47], v[204:207]
ds_read_b128 a[112:115], v2 offset:45056
v_mfma_f32_16x16x32_bf16 v[212:215], a[136:139], a[48:51], 0
ds_read_b128 a[116:119], v3 offset:45056
v_mfma_f32_16x16x32_bf16 v[212:215], a[140:143], a[52:55], v[212:215]
v_mfma_f32_16x16x32_bf16 v[220:223], a[136:139], a[56:59], 0
ds_read_b128 a[120:123], v2 offset:47104
v_mfma_f32_16x16x32_bf16 v[220:223], a[140:143], a[60:63], v[220:223]
s_waitcnt lgkmcnt(4)
ds_read_b128 a[124:127], v3 offset:47104
v_mfma_f32_16x16x32_bf16 a[192:195], a[128:131], a[0:3], 0
ds_read_b64_tr_b16 a[136:137], v11 offset:0
v_mfma_f32_16x16x32_bf16 a[192:195], a[132:135], a[4:7], a[192:195]
v_mfma_f32_16x16x32_bf16 a[200:203], a[128:131], a[8:11], 0
ds_read_b64_tr_b16 a[138:139], v11 offset:2048
v_mfma_f32_16x16x32_bf16 a[200:203], a[132:135], a[12:15], a[200:203]
v_mfma_f32_16x16x32_bf16 a[208:211], a[128:131], a[16:19], 0
ds_read_b64_tr_b16 a[140:141], v11 offset:16384
v_mfma_f32_16x16x32_bf16 a[208:211], a[132:135], a[20:23], a[208:211]
v_mfma_f32_16x16x32_bf16 a[216:219], a[128:131], a[24:27], 0
ds_read_b64_tr_b16 a[142:143], v11 offset:18432
v_mfma_f32_16x16x32_bf16 a[216:219], a[132:135], a[28:31], a[216:219]
v_mfma_f32_16x16x32_bf16 a[224:227], a[128:131], a[32:35], 0
v_mfma_f32_16x16x32_bf16 a[224:227], a[132:135], a[36:39], a[224:227]
v_mfma_f32_16x16x32_bf16 a[232:235], a[128:131], a[40:43], 0
v_mfma_f32_16x16x32_bf16 a[232:235], a[132:135], a[44:47], a[232:235]
v_mfma_f32_16x16x32_bf16 a[240:243], a[128:131], a[48:51], 0
v_mfma_f32_16x16x32_bf16 a[240:243], a[132:135], a[52:55], a[240:243]
v_mfma_f32_16x16x32_bf16 a[248:251], a[128:131], a[56:59], 0
s_waitcnt vmcnt(1) lgkmcnt(0)
v_mfma_f32_16x16x32_bf16 a[248:251], a[132:135], a[60:63], a[248:251]
s_barrier
v_mfma_f32_16x16x32_bf16 a[196:199], a[136:139], a[0:3], 0
s_add_u32 m0, s29, 65536
ds_read_b64_tr_b16 a[128:129], v4 offset:32768
v_mfma_f32_16x16x32_bf16 a[196:199], a[140:143], a[4:7], a[196:199]
buffer_load_dwordx4 v16, s[12:15], s26 offen offset:0 lds
v_mfma_f32_16x16x32_bf16 a[204:207], a[136:139], a[8:11], 0
ds_read_b64_tr_b16 a[130:131], v4 offset:34816
v_mfma_f32_16x16x32_bf16 a[204:207], a[140:143], a[12:15], a[204:207]
v_mfma_f32_16x16x32_bf16 a[212:215], a[136:139], a[16:19], 0
ds_read_b64_tr_b16 a[132:133], v4 offset:49152
v_mfma_f32_16x16x32_bf16 a[212:215], a[140:143], a[20:23], a[212:215]
buffer_load_dwordx4 v17, s[12:15], s26 offen offset:1024 lds
v_mfma_f32_16x16x32_bf16 a[220:223], a[136:139], a[24:27], 0
ds_read_b64_tr_b16 a[134:135], v4 offset:51200
v_mfma_f32_16x16x32_bf16 a[220:223], a[140:143], a[28:31], a[220:223]
v_mfma_f32_16x16x32_bf16 a[228:231], a[136:139], a[32:35], 0
v_mfma_f32_16x16x32_bf16 a[228:231], a[140:143], a[36:39], a[228:231]
buffer_load_dwordx4 v18, s[12:15], s26 offen offset:2048 lds
v_mfma_f32_16x16x32_bf16 a[236:239], a[136:139], a[40:43], 0
v_mfma_f32_16x16x32_bf16 a[236:239], a[140:143], a[44:47], a[236:239]
v_mfma_f32_16x16x32_bf16 a[244:247], a[136:139], a[48:51], 0
v_mfma_f32_16x16x32_bf16 a[244:247], a[140:143], a[52:55], a[244:247]
buffer_load_dwordx4 v19, s[12:15], s26 offen offset:3072 lds
v_mfma_f32_16x16x32_bf16 a[252:255], a[136:139], a[56:59], 0
s_add_u32 s26, s26, 524288
v_mfma_f32_16x16x32_bf16 a[252:255], a[140:143], a[60:63], a[252:255]
s_waitcnt lgkmcnt(0)
Lg_1:
v_mfma_f32_16x16x32_bf16 v[32:35], a[128:131], a[64:67], v[32:35]
s_add_u32 m0, s29, 81920
ds_read_b64_tr_b16 a[136:137], v5 offset:32768
v_mfma_f32_16x16x32_bf16 v[32:35], a[132:135], a[68:71], v[32:35]
buffer_load_dwordx4 v16, s[12:15], s27 offen offset:0 lds
v_mfma_f32_16x16x32_bf16 v[40:43], a[128:131], a[72:75], v[40:43]
ds_read_b64_tr_b16 a[138:139], v5 offset:34816
v_mfma_f32_16x16x32_bf16 v[40:43], a[132:135], a[76:79], v[40:43]
v_mfma_f32_16x16x32_bf16 v[48:51], a[128:131], a[80:83], v[48:51]
ds_read_b64_tr_b16 a[140:141], v5 offset:49152
v_mfma_f32_16x16x32_bf16 v[48:51], a[132:135], a[84:87], v[48:51]
buffer_load_dwordx4 v17, s[12:15], s27 offen offset:1024 lds
v_mfma_f32_16x16x32_bf16 v[56:59], a[128:131], a[88:91], v[56:59]
ds_read_b64_tr_b16 a[142:143], v5 offset:51200
v_mfma_f32_16x16x32_bf16 v[56:59], a[132:135], a[92:95], v[56:59]
v_mfma_f32_16x16x32_bf16 v[64:67], a[128:131], a[96:99], v[64:67]
ds_read_b128 a[0:3], v2 offset:0
v_mfma_f32_16x16x32_bf16 v[64:67], a[132:135], a[100:103], v[64:67]
buffer_load_dwordx4 v18, s[12:15], s27 offen offset:2048 lds
v_mfma_f32_16x16x32_bf16 v[72:75], a[128:131], a[104:107], v[72:75]
ds_read_b128 a[4:7], v3 offset:0
v_mfma_f32_16x16x32_bf16 v[72:75], a[132:135], a[108:111], v[72:75]
v_mfma_f32_16x16x32_bf16 v[80:83], a[128:131], a[112:115], v[80:83]
v_mfma_f32_16x16x32_bf16 v[80:83], a[132:135], a[116:119], v[80:83]
buffer_load_dwordx4 v19, s[12:15], s27 offen offset:3072 lds
v_mfma_f32_16x16x32_bf16 v[88:91], a[128:131], a[120:123], v[88:91]
s_add_u32 s27, s27, 524288
ds_read_b128 a[8:11], v2 offset:2048
v_mfma_f32_16x16x32_bf16 v[88:91], a[132:135], a[124:127], v[88:91]
s_waitcnt lgkmcnt(3)
v_mfma_f32_16x16x32_bf16 v[36:39], a[136:139], a[64:67], v[36:39]
s_add_u32 m0, s28, 32768
ds_read_b64_tr_b16 a[128:129], v6 offset:32768
v_mfma_f32_16x16x32_bf16 v[36:39], a[140:143], a[68:71], v[36:39]
buffer_load_dwordx4 v12, s[8:11], s24 offen offset:0 lds
v_mfma_f32_16x16x32_bf16 v[44:47], a[136:139], a[72:75], v[44:47]
ds_read_b64_tr_b16 a[130:131], v6 offset:34816
v_mfma_f32_16x16x32_bf16 v[44:47], a[140:143], a[76:79], v[44:47]
v_mfma_f32_16x16x32_bf16 v[52:55], a[136:139], a[80:83], v[52:55]
ds_read_b64_tr_b16 a[132:133], v6 offset:49152
v_mfma_f32_16x16x32_bf16 v[52:55], a[140:143], a[84:87], v[52:55]
buffer_load_dwordx4 v13, s[8:11], s24 offen offset:1024 lds
v_mfma_f32_16x16x32_bf16 v[60:63], a[136:139], a[88:91], v[60:63]
ds_read_b64_tr_b16 a[134:135], v6 offset:51200
v_mfma_f32_16x16x32_bf16 v[60:63], a[140:143], a[92:95], v[60:63]
v_mfma_f32_16x16x32_bf16 v[68:71], a[136:139], a[96:99], v[68:71]
ds_read_b128 a[12:15], v3 offset:2048
v_mfma_f32_16x16x32_bf16 v[68:71], a[140:143], a[100:103], v[68:71]
buffer_load_dwordx4 v14, s[8:11], s24 offen offset:2048 lds
v_mfma_f32_16x16x32_bf16 v[76:79], a[136:139], a[104:107], v[76:79]
v_mfma_f32_16x16x32_bf16 v[76:79], a[140:143], a[108:111], v[76:79]
v_mfma_f32_16x16x32_bf16 v[84:87], a[136:139], a[112:115], v[84:87]
ds_read_b128 a[16:19], v2 offset:4096
v_mfma_f32_16x16x32_bf16 v[84:87], a[140:143], a[116:119], v[84:87]
buffer_load_dwordx4 v15, s[8:11], s24 offen offset:3072 lds
v_mfma_f32_16x16x32_bf16 v[92:95], a[136:139], a[120:123], v[92:95]
s_add_u32 s24, s24, 128
ds_read_b128 a[20:23], v3 offset:4096
v_mfma_f32_16x16x32_bf16 v[92:95], a[140:143], a[124:127], v[92:95]
s_waitcnt lgkmcnt(3)
v_mfma_f32_16x16x32_bf16 v[96:99], a[128:131], a[64:67], v[96:99]
s_add_u32 m0, s28, 36864
ds_read_b64_tr_b16 a[136:137], v7 offset:32768
v_mfma_f32_16x16x32_bf16 v[96:99], a[132:135], a[68:71], v[96:99]
buffer_load_dwordx4 v12, s[8:11], s25 offen offset:0 lds
v_mfma_f32_16x16x32_bf16 v[104:107], a[128:131], a[72:75], v[104:107]
ds_read_b64_tr_b16 a[138:139], v7 offset:34816
v_mfma_f32_16x16x32_bf16 v[104:107], a[132:135], a[76:79], v[104:107]
v_mfma_f32_16x16x32_bf16 v[112:115], a[128:131], a[80:83], v[112:115]
ds_read_b64_tr_b16 a[140:141], v7 offset:49152
v_mfma_f32_16x16x32_bf16 v[112:115], a[132:135], a[84:87], v[112:115]
buffer_load_dwordx4 v13, s[8:11], s25 offen offset:1024 lds
v_mfma_f32_16x16x32_bf16 v[120:123], a[128:131], a[88:91], v[120:123]
ds_read_b64_tr_b16 a[142:143], v7 offset:51200
v_mfma_f32_16x16x32_bf16 v[120:123], a[132:135], a[92:95], v[120:123]
v_mfma_f32_16x16x32_bf16 v[128:131], a[128:131], a[96:99], v[128:131]
v_mfma_f32_16x16x32_bf16 v[128:131], a[132:135], a[100:103], v[128:131]
buffer_load_dwordx4 v14, s[8:11], s25 offen offset:2048 lds
v_mfma_f32_16x16x32_bf16 v[136:139], a[128:131], a[104:107], v[136:139]
ds_read_b128 a[24:27], v2 offset:6144
v_mfma_f32_16x16x32_bf16 v[136:139], a[132:135], a[108:111], v[136:139]
v_mfma_f32_16x16x32_bf16 v[144:147], a[128:131], a[112:115], v[144:147]
ds_read_b128 a[28:31], v3 offset:6144
v_mfma_f32_16x16x32_bf16 v[144:147], a[132:135], a[116:119], v[144:147]
buffer_load_dwordx4 v15, s[8:11], s25 offen offset:3072 lds
v_mfma_f32_16x16x32_bf16 v[152:155], a[128:131], a[120:123], v[152:155]
s_add_u32 s25, s25, 128
v_mfma_f32_16x16x32_bf16 v[152:155], a[132:135], a[124:127], v[152:155]
s_waitcnt lgkmcnt(2)
v_mfma_f32_16x16x32_bf16 v[100:103], a[136:139], a[64:67], v[100:103]
ds_read_b64_tr_b16 a[128:129], v8 offset:32768
v_mfma_f32_16x16x32_bf16 v[100:103], a[140:143], a[68:71], v[100:103]
buffer_load_dword v21, v20, s[16:19], s43 offen
v_mfma_f32_16x16x32_bf16 v[108:111], a[136:139], a[72:75], v[108:111]
s_add_u32 s43, s43, s47
ds_read_b64_tr_b16 a[130:131], v8 offset:34816
v_mfma_f32_16x16x32_bf16 v[108:111], a[140:143], a[76:79], v[108:111]
s_cmp_ge_u32 s43, s51
v_mfma_f32_16x16x32_bf16 v[116:119], a[136:139], a[80:83], v[116:119]
s_cselect_b32 s43, 0, s43
ds_read_b64_tr_b16 a[132:133], v8 offset:49152
v_mfma_f32_16x16x32_bf16 v[116:119], a[140:143], a[84:87], v[116:119]
s_cselect_b32 s51, s42, s51
v_mfma_f32_16x16x32_bf16 v[124:127], a[136:139], a[88:91], v[124:127]
s_cselect_b64 s[16:17], s[40:41], s[16:17]
ds_read_b64_tr_b16 a[134:135], v8 offset:51200
v_mfma_f32_16x16x32_bf16 v[124:127], a[140:143], a[92:95], v[124:127]
s_cselect_b32 s18, s42, s18
v_mfma_f32_16x16x32_bf16 v[132:135], a[136:139], a[96:99], v[132:135]
s_cselect_b64 s[40:41], s[44:45], s[40:41]
ds_read_b128 a[32:35], v2 offset:8192
v_mfma_f32_16x16x32_bf16 v[132:135], a[140:143], a[100:103], v[132:135]
s_cselect_b32 s42, s46, s42
v_mfma_f32_16x16x32_bf16 v[140:143], a[136:139], a[104:107], v[140:143]
s_cselect_b32 s46, 0, s46
v_mfma_f32_16x16x32_bf16 v[140:143], a[140:143], a[108:111], v[140:143]
s_cmp_eq_u32 s30, s55
v_mfma_f32_16x16x32_bf16 v[148:151], a[136:139], a[112:115], v[148:151]
s_cselect_b32 s22, 0, 3221225472
ds_read_b128 a[36:39], v3 offset:8192
v_mfma_f32_16x16x32_bf16 v[148:151], a[140:143], a[116:119], v[148:151]
s_sub_u32 s30, s30, 1
buffer_atomic_add v27, v26, s[60:63], s22 offen sc1
v_mfma_f32_16x16x32_bf16 v[156:159], a[136:139], a[120:123], v[156:159]
ds_read_b128 a[40:43], v2 offset:10240
v_mfma_f32_16x16x32_bf16 v[156:159], a[140:143], a[124:127], v[156:159]
s_waitcnt lgkmcnt(3)
v_mfma_f32_16x16x32_bf16 v[160:163], a[128:131], a[64:67], v[160:163]
ds_read_b64_tr_b16 a[136:137], v9 offset:32768
v_mfma_f32_16x16x32_bf16 v[160:163], a[132:135], a[68:71], v[160:163]
v_mfma_f32_16x16x32_bf16 v[168:171], a[128:131], a[72:75], v[168:171]
ds_read_b64_tr_b16 a[138:139], v9 offset:34816
v_mfma_f32_16x16x32_bf16 v[168:171], a[132:135], a[76:79], v[168:171]
v_mfma_f32_16x16x32_bf16 v[176:179], a[128:131], a[80:83], v[176:179]
ds_read_b64_tr_b16 a[140:141], v9 offset:49152
v_mfma_f32_16x16x32_bf16 v[176:179], a[132:135], a[84:87], v[176:179]
v_mfma_f32_16x16x32_bf16 v[184:187], a[128:131], a[88:91], v[184:187]
ds_read_b64_tr_b16 a[142:143], v9 offset:51200
v_mfma_f32_16x16x32_bf16 v[184:187], a[132:135], a[92:95], v[184:187]
v_mfma_f32_16x16x32_bf16 v[192:195], a[128:131], a[96:99], v[192:195]
v_mfma_f32_16x16x32_bf16 v[192:195], a[132:135], a[100:103], v[192:195]
v_mfma_f32_16x16x32_bf16 v[200:203], a[128:131], a[104:107], v[200:203]
ds_read_b128 a[44:47], v3 offset:10240
v_mfma_f32_16x16x32_bf16 v[200:203], a[132:135], a[108:111], v[200:203]
v_mfma_f32_16x16x32_bf16 v[208:211], a[128:131], a[112:115], v[208:211]
ds_read_b128 a[48:51], v2 offset:12288
v_mfma_f32_16x16x32_bf16 v[208:211], a[132:135], a[116:119], v[208:211]
v_mfma_f32_16x16x32_bf16 v[216:219], a[128:131], a[120:123], v[216:219]
v_mfma_f32_16x16x32_bf16 v[216:219], a[132:135], a[124:127], v[216:219]
s_waitcnt lgkmcnt(2)
v_mfma_f32_16x16x32_bf16 v[164:167], a[136:139], a[64:67], v[164:167]
ds_read_b64_tr_b16 a[128:129], v10 offset:32768
v_mfma_f32_16x16x32_bf16 v[164:167], a[140:143], a[68:71], v[164:167]
v_mfma_f32_16x16x32_bf16 v[172:175], a[136:139], a[72:75], v[172:175]
ds_read_b64_tr_b16 a[130:131], v10 offset:34816
v_mfma_f32_16x16x32_bf16 v[172:175], a[140:143], a[76:79], v[172:175]
v_mfma_f32_16x16x32_bf16 v[180:183], a[136:139], a[80:83], v[180:183]
ds_read_b64_tr_b16 a[132:133], v10 offset:49152
v_mfma_f32_16x16x32_bf16 v[180:183], a[140:143], a[84:87], v[180:183]
v_mfma_f32_16x16x32_bf16 v[188:191], a[136:139], a[88:91], v[188:191]
ds_read_b64_tr_b16 a[134:135], v10 offset:51200
v_mfma_f32_16x16x32_bf16 v[188:191], a[140:143], a[92:95], v[188:191]
v_mfma_f32_16x16x32_bf16 v[196:199], a[136:139], a[96:99], v[196:199]
ds_read_b128 a[52:55], v3 offset:12288
v_mfma_f32_16x16x32_bf16 v[196:199], a[140:143], a[100:103], v[196:199]
v_mfma_f32_16x16x32_bf16 v[204:207], a[136:139], a[104:107], v[204:207]
ds_read_b128 a[56:59], v2 offset:14336
v_mfma_f32_16x16x32_bf16 v[204:207], a[140:143], a[108:111], v[204:207]
v_mfma_f32_16x16x32_bf16 v[212:215], a[136:139], a[112:115], v[212:215]
v_mfma_f32_16x16x32_bf16 v[212:215], a[140:143], a[116:119], v[212:215]
v_mfma_f32_16x16x32_bf16 v[220:223], a[136:139], a[120:123], v[220:223]
ds_read_b128 a[60:63], v3 offset:14336
v_mfma_f32_16x16x32_bf16 v[220:223], a[140:143], a[124:127], v[220:223]
s_waitcnt lgkmcnt(3)
v_mfma_f32_16x16x32_bf16 a[192:195], a[128:131], a[64:67], a[192:195]
ds_read_b64_tr_b16 a[136:137], v11 offset:32768
v_mfma_f32_16x16x32_bf16 a[192:195], a[132:135], a[68:71], a[192:195]
v_mfma_f32_16x16x32_bf16 a[200:203], a[128:131], a[72:75], a[200:203]
ds_read_b64_tr_b16 a[138:139], v11 offset:34816
v_mfma_f32_16x16x32_bf16 a[200:203], a[132:135], a[76:79], a[200:203]
v_mfma_f32_16x16x32_bf16 a[208:211], a[128:131], a[80:83], a[208:211]
ds_read_b64_tr_b16 a[140:141], v11 offset:49152
v_mfma_f32_16x16x32_bf16 a[208:211], a[132:135], a[84:87], a[208:211]
v_mfma_f32_16x16x32_bf16 a[216:219], a[128:131], a[88:91], a[216:219]
ds_read_b64_tr_b16 a[142:143], v11 offset:51200
v_mfma_f32_16x16x32_bf16 a[216:219], a[132:135], a[92:95], a[216:219]
v_mfma_f32_16x16x32_bf16 a[224:227], a[128:131], a[96:99], a[224:227]
v_mfma_f32_16x16x32_bf16 a[224:227], a[132:135], a[100:103], a[224:227]
v_mfma_f32_16x16x32_bf16 a[232:235], a[128:131], a[104:107], a[232:235]
v_mfma_f32_16x16x32_bf16 a[232:235], a[132:135], a[108:111], a[232:235]
v_mfma_f32_16x16x32_bf16 a[240:243], a[128:131], a[112:115], a[240:243]
v_mfma_f32_16x16x32_bf16 a[240:243], a[132:135], a[116:119], a[240:243]
v_mfma_f32_16x16x32_bf16 a[248:251], a[128:131], a[120:123], a[248:251]
s_waitcnt vmcnt(2) lgkmcnt(0)
v_mfma_f32_16x16x32_bf16 a[248:251], a[132:135], a[124:127], a[248:251]
s_barrier
v_mfma_f32_16x16x32_bf16 a[196:199], a[136:139], a[64:67], a[196:199]
s_add_u32 m0, s29, 98304
ds_read_b64_tr_b16 a[128:129], v4 offset:0
v_mfma_f32_16x16x32_bf16 a[196:199], a[140:143], a[68:71], a[196:199]
buffer_load_dwordx4 v16, s[12:15], s26 offen offset:0 lds
v_mfma_f32_16x16x32_bf16 a[204:207], a[136:139], a[72:75], a[204:207]
ds_read_b64_tr_b16 a[130:131], v4 offset:2048
v_mfma_f32_16x16x32_bf16 a[204:207], a[140:143], a[76:79], a[204:207]
v_mfma_f32_16x16x32_bf16 a[212:215], a[136:139], a[80:83], a[212:215]
ds_read_b64_tr_b16 a[132:133], v4 offset:16384
v_mfma_f32_16x16x32_bf16 a[212:215], a[140:143], a[84:87], a[212:215]
buffer_load_dwordx4 v17, s[12:15], s26 offen offset:1024 lds
v_mfma_f32_16x16x32_bf16 a[220:223], a[136:139], a[88:91], a[220:223]
ds_read_b64_tr_b16 a[134:135], v4 offset:18432
v_mfma_f32_16x16x32_bf16 a[220:223], a[140:143], a[92:95], a[220:223]
v_mfma_f32_16x16x32_bf16 a[228:231], a[136:139], a[96:99], a[228:231]
v_mfma_f32_16x16x32_bf16 a[228:231], a[140:143], a[100:103], a[228:231]
buffer_load_dwordx4 v18, s[12:15], s26 offen offset:2048 lds
v_mfma_f32_16x16x32_bf16 a[236:239], a[136:139], a[104:107], a[236:239]
v_mfma_f32_16x16x32_bf16 a[236:239], a[140:143], a[108:111], a[236:239]
v_mfma_f32_16x16x32_bf16 a[244:247], a[136:139], a[112:115], a[244:247]
v_mfma_f32_16x16x32_bf16 a[244:247], a[140:143], a[116:119], a[244:247]
buffer_load_dwordx4 v19, s[12:15], s26 offen offset:3072 lds
v_mfma_f32_16x16x32_bf16 a[252:255], a[136:139], a[120:123], a[252:255]
s_add_u32 s26, s26, 524288
v_mfma_f32_16x16x32_bf16 a[252:255], a[140:143], a[124:127], a[252:255]
s_waitcnt lgkmcnt(0)
buffer_store_dword v27, v26, s[4:7], s82 offen sc1
v_mfma_f32_16x16x32_bf16 v[32:35], a[128:131], a[0:3], v[32:35]
s_add_u32 m0, s29, 114688
ds_read_b64_tr_b16 a[136:137], v5 offset:0
v_mfma_f32_16x16x32_bf16 v[32:35], a[132:135], a[4:7], v[32:35]
buffer_load_dwordx4 v16, s[12:15], s27 offen offset:0 lds
v_mfma_f32_16x16x32_bf16 v[40:43], a[128:131], a[8:11], v[40:43]
ds_read_b64_tr_b16 a[138:139], v5 offset:2048
v_mfma_f32_16x16x32_bf16 v[40:43], a[132:135], a[12:15], v[40:43]
v_mfma_f32_16x16x32_bf16 v[48:51], a[128:131], a[16:19], v[48:51]
ds_read_b64_tr_b16 a[140:141], v5 offset:16384
v_mfma_f32_16x16x32_bf16 v[48:51], a[132:135], a[20:23], v[48:51]
buffer_load_dwordx4 v17, s[12:15], s27 offen offset:1024 lds
v_mfma_f32_16x16x32_bf16 v[56:59], a[128:131], a[24:27], v[56:59]
ds_read_b64_tr_b16 a[142:143], v5 offset:18432
v_mfma_f32_16x16x32_bf16 v[56:59], a[132:135], a[28:31], v[56:59]
v_mfma_f32_16x16x32_bf16 v[64:67], a[128:131], a[32:35], v[64:67]
ds_read_b128 a[64:67], v2 offset:32768
v_mfma_f32_16x16x32_bf16 v[64:67], a[132:135], a[36:39], v[64:67]
buffer_load_dwordx4 v18, s[12:15], s27 offen offset:2048 lds
v_mfma_f32_16x16x32_bf16 v[72:75], a[128:131], a[40:43], v[72:75]
ds_read_b128 a[68:71], v3 offset:32768
v_mfma_f32_16x16x32_bf16 v[72:75], a[132:135], a[44:47], v[72:75]
v_mfma_f32_16x16x32_bf16 v[80:83], a[128:131], a[48:51], v[80:83]
v_mfma_f32_16x16x32_bf16 v[80:83], a[132:135], a[52:55], v[80:83]
buffer_load_dwordx4 v19, s[12:15], s27 offen offset:3072 lds
v_mfma_f32_16x16x32_bf16 v[88:91], a[128:131], a[56:59], v[88:91]
s_add_u32 s27, s27, 524288
ds_read_b128 a[72:75], v2 offset:34816
v_mfma_f32_16x16x32_bf16 v[88:91], a[132:135], a[60:63], v[88:91]
s_waitcnt lgkmcnt(3)
v_mfma_f32_16x16x32_bf16 v[36:39], a[136:139], a[0:3], v[36:39]
s_add_u32 m0, s28, 0
ds_read_b64_tr_b16 a[128:129], v6 offset:0
v_mfma_f32_16x16x32_bf16 v[36:39], a[140:143], a[4:7], v[36:39]
buffer_load_dwordx4 v12, s[8:11], s24 offen offset:0 lds
v_mfma_f32_16x16x32_bf16 v[44:47], a[136:139], a[8:11], v[44:47]
ds_read_b64_tr_b16 a[130:131], v6 offset:2048
v_mfma_f32_16x16x32_bf16 v[44:47], a[140:143], a[12:15], v[44:47]
v_mfma_f32_16x16x32_bf16 v[52:55], a[136:139], a[16:19], v[52:55]
ds_read_b64_tr_b16 a[132:133], v6 offset:16384
v_mfma_f32_16x16x32_bf16 v[52:55], a[140:143], a[20:23], v[52:55]
buffer_load_dwordx4 v13, s[8:11], s24 offen offset:1024 lds
v_mfma_f32_16x16x32_bf16 v[60:63], a[136:139], a[24:27], v[60:63]
ds_read_b64_tr_b16 a[134:135], v6 offset:18432
v_mfma_f32_16x16x32_bf16 v[60:63], a[140:143], a[28:31], v[60:63]
PAD_1:
s_cbranch_execz PAD_5
v_mfma_f32_16x16x32_bf16 v[68:71], a[136:139], a[32:35], v[68:71]
ds_read_b128 a[76:79], v3 offset:34816
v_mfma_f32_16x16x32_bf16 v[68:71], a[140:143], a[36:39], v[68:71]
buffer_load_dwordx4 v14, s[8:11], s24 offen offset:2048 lds
v_mfma_f32_16x16x32_bf16 v[76:79], a[136:139], a[40:43], v[76:79]
v_mfma_f32_16x16x32_bf16 v[76:79], a[140:143], a[44:47], v[76:79]
v_mfma_f32_16x16x32_bf16 v[84:87], a[136:139], a[48:51], v[84:87]
ds_read_b128 a[80:83], v2 offset:36864
v_mfma_f32_16x16x32_bf16 v[84:87], a[140:143], a[52:55], v[84:87]
buffer_load_dwordx4 v15, s[8:11], s24 offen offset:3072 lds
v_mfma_f32_16x16x32_bf16 v[92:95], a[136:139], a[56:59], v[92:95]
s_add_u32 s24, s24, 128
ds_read_b128 a[84:87], v3 offset:36864
v_mfma_f32_16x16x32_bf16 v[92:95], a[140:143], a[60:63], v[92:95]
s_waitcnt lgkmcnt(3)
v_mfma_f32_16x16x32_bf16 v[96:99], a[128:131], a[0:3], v[96:99]
s_add_u32 m0, s28, 4096
ds_read_b64_tr_b16 a[136:137], v7 offset:0
v_mfma_f32_16x16x32_bf16 v[96:99], a[132:135], a[4:7], v[96:99]
buffer_load_dwordx4 v12, s[8:11], s25 offen offset:0 lds
v_mfma_f32_16x16x32_bf16 v[104:107], a[128:131], a[8:11], v[104:107]
ds_read_b64_tr_b16 a[138:139], v7 offset:2048
v_mfma_f32_16x16x32_bf16 v[104:107], a[132:135], a[12:15], v[104:107]
v_mfma_f32_16x16x32_bf16 v[112:115], a[128:131], a[16:19], v[112:115]
ds_read_b64_tr_b16 a[140:141], v7 offset:16384
v_mfma_f32_16x16x32_bf16 v[112:115], a[132:135], a[20:23], v[112:115]
buffer_load_dwordx4 v13, s[8:11], s25 offen offset:1024 lds
v_mfma_f32_16x16x32_bf16 v[120:123], a[128:131], a[24:27], v[120:123]
ds_read_b64_tr_b16 a[142:143], v7 offset:18432
v_mfma_f32_16x16x32_bf16 v[120:123], a[132:135], a[28:31], v[120:123]
v_mfma_f32_16x16x32_bf16 v[128:131], a[128:131], a[32:35], v[128:131]
v_mfma_f32_16x16x32_bf16 v[128:131], a[132:135], a[36:39], v[128:131]
buffer_load_dwordx4 v14, s[8:11], s25 offen offset:2048 lds
v_mfma_f32_16x16x32_bf16 v[136:139], a[128:131], a[40:43], v[136:139]
ds_read_b128 a[88:91], v2 offset:38912
v_mfma_f32_16x16x32_bf16 v[136:139], a[132:135], a[44:47], v[136:139]
v_mfma_f32_16x16x32_bf16 v[144:147], a[128:131], a[48:51], v[144:147]
ds_read_b128 a[92:95], v3 offset:38912
v_mfma_f32_16x16x32_bf16 v[144:147], a[132:135], a[52:55], v[144:147]
buffer_load_dwordx4 v15, s[8:11], s25 offen offset:3072 lds
v_mfma_f32_16x16x32_bf16 v[152:155], a[128:131], a[56:59], v[152:155]
s_add_u32 s25, s25, 128
v_mfma_f32_16x16x32_bf16 v[152:155], a[132:135], a[60:63], v[152:155]
s_waitcnt lgkmcnt(2)
v_mfma_f32_16x16x32_bf16 v[100:103], a[136:139], a[0:3], v[100:103]
ds_read_b64_tr_b16 a[128:129], v8 offset:0
v_mfma_f32_16x16x32_bf16 v[100:103], a[140:143], a[4:7], v[100:103]
buffer_load_dword v21, v20, s[16:19], s43 offen
v_mfma_f32_16x16x32_bf16 v[108:111], a[136:139], a[8:11], v[108:111]
s_add_u32 s43, s43, s47
ds_read_b64_tr_b16 a[130:131], v8 offset:2048
v_mfma_f32_16x16x32_bf16 v[108:111], a[140:143], a[12:15], v[108:111]
s_cmp_ge_u32 s43, s51
v_mfma_f32_16x16x32_bf16 v[116:119], a[136:139], a[16:19], v[116:119]
s_cselect_b32 s43, 0, s43
ds_read_b64_tr_b16 a[132:133], v8 offset:16384
v_mfma_f32_16x16x32_bf16 v[116:119], a[140:143], a[20:23], v[116:119]
s_cselect_b32 s51, s42, s51
v_mfma_f32_16x16x32_bf16 v[124:127], a[136:139], a[24:27], v[124:127]
s_cselect_b64 s[16:17], s[40:41], s[16:17]
ds_read_b64_tr_b16 a[134:135], v8 offset:18432
v_mfma_f32_16x16x32_bf16 v[124:127], a[140:143], a[28:31], v[124:127]
s_cselect_b32 s18, s42, s18
v_mfma_f32_16x16x32_bf16 v[132:135], a[136:139], a[32:35], v[132:135]
s_cselect_b64 s[40:41], s[44:45], s[40:41]
ds_read_b128 a[96:99], v2 offset:40960
v_mfma_f32_16x16x32_bf16 v[132:135], a[140:143], a[36:39], v[132:135]
s_cselect_b32 s42, s46, s42
v_mfma_f32_16x16x32_bf16 v[140:143], a[136:139], a[40:43], v[140:143]
s_cselect_b32 s46, 0, s46
v_mfma_f32_16x16x32_bf16 v[140:143], a[140:143], a[44:47], v[140:143]
s_cmp_eq_u32 s30, s55
v_mfma_f32_16x16x32_bf16 v[148:151], a[136:139], a[48:51], v[148:151]
s_cselect_b32 s22, 0, 3221225472
ds_read_b128 a[100:103], v3 offset:40960
v_mfma_f32_16x16x32_bf16 v[148:151], a[140:143], a[52:55], v[148:151]
s_sub_u32 s30, s30, 1
buffer_atomic_add v27, v26, s[60:63], s22 offen sc1
v_mfma_f32_16x16x32_bf16 v[156:159], a[136:139], a[56:59], v[156:159]
ds_read_b128 a[104:107], v2 offset:43008
v_mfma_f32_16x16x32_bf16 v[156:159], a[140:143], a[60:63], v[156:159]
s_waitcnt lgkmcnt(3)
v_mfma_f32_16x16x32_bf16 v[160:163], a[128:131], a[0:3], v[160:163]
ds_read_b64_tr_b16 a[136:137], v9 offset:0
v_mfma_f32_16x16x32_bf16 v[160:163], a[132:135], a[4:7], v[160:163]
v_mfma_f32_16x16x32_bf16 v[168:171], a[128:131], a[8:11], v[168:171]
ds_read_b64_tr_b16 a[138:139], v9 offset:2048
v_mfma_f32_16x16x32_bf16 v[168:171], a[132:135], a[12:15], v[168:171]
v_mfma_f32_16x16x32_bf16 v[176:179], a[128:131], a[16:19], v[176:179]
ds_read_b64_tr_b16 a[140:141], v9 offset:16384
v_mfma_f32_16x16x32_bf16 v[176:179], a[132:135], a[20:23], v[176:179]
v_mfma_f32_16x16x32_bf16 v[184:187], a[128:131], a[24:27], v[184:187]
ds_read_b64_tr_b16 a[142:143], v9 offset:18432
v_mfma_f32_16x16x32_bf16 v[184:187], a[132:135], a[28:31], v[184:187]
v_mfma_f32_16x16x32_bf16 v[192:195], a[128:131], a[32:35], v[192:195]
v_mfma_f32_16x16x32_bf16 v[192:195], a[132:135], a[36:39], v[192:195]
v_mfma_f32_16x16x32_bf16 v[200:203], a[128:131], a[40:43], v[200:203]
ds_read_b128 a[108:111], v3 offset:43008
v_mfma_f32_16x16x32_bf16 v[200:203], a[132:135], a[44:47], v[200:203]
v_mfma_f32_16x16x32_bf16 v[208:211], a[128:131], a[48:51], v[208:211]
ds_read_b128 a[112:115], v2 offset:45056
v_mfma_f32_16x16x32_bf16 v[208:211], a[132:135], a[52:55], v[208:211]
v_mfma_f32_16x16x32_bf16 v[216:219], a[128:131], a[56:59], v[216:219]
v_mfma_f32_16x16x32_bf16 v[216:219], a[132:135], a[60:63], v[216:219]
s_waitcnt lgkmcnt(2)
v_mfma_f32_16x16x32_bf16 v[164:167], a[136:139], a[0:3], v[164:167]
ds_read_b64_tr_b16 a[128:129], v10 offset:0
v_mfma_f32_16x16x32_bf16 v[164:167], a[140:143], a[4:7], v[164:167]
v_mfma_f32_16x16x32_bf16 v[172:175], a[136:139], a[8:11], v[172:175]
ds_read_b64_tr_b16 a[130:131], v10 offset:2048
v_mfma_f32_16x16x32_bf16 v[172:175], a[140:143], a[12:15], v[172:175]
v_mfma_f32_16x16x32_bf16 v[180:183], a[136:139], a[16:19], v[180:183]
ds_read_b64_tr_b16 a[132:133], v10 offset:16384
v_mfma_f32_16x16x32_bf16 v[180:183], a[140:143], a[20:23], v[180:183]
v_mfma_f32_16x16x32_bf16 v[188:191], a[136:139], a[24:27], v[188:191]
ds_read_b64_tr_b16 a[134:135], v10 offset:18432
v_mfma_f32_16x16x32_bf16 v[188:191], a[140:143], a[28:31], v[188:191]
v_mfma_f32_16x16x32_bf16 v[196:199], a[136:139], a[32:35], v[196:199]
ds_read_b128 a[116:119], v3 offset:45056
v_mfma_f32_16x16x32_bf16 v[196:199], a[140:143], a[36:39], v[196:199]
v_mfma_f32_16x16x32_bf16 v[204:207], a[136:139], a[40:43], v[204:207]
ds_read_b128 a[120:123], v2 offset:47104
v_mfma_f32_16x16x32_bf16 v[204:207], a[140:143], a[44:47], v[204:207]
v_mfma_f32_16x16x32_bf16 v[212:215], a[136:139], a[48:51], v[212:215]
v_mfma_f32_16x16x32_bf16 v[212:215], a[140:143], a[52:55], v[212:215]
v_mfma_f32_16x16x32_bf16 v[220:223], a[136:139], a[56:59], v[220:223]
ds_read_b128 a[124:127], v3 offset:47104
v_mfma_f32_16x16x32_bf16 v[220:223], a[140:143], a[60:63], v[220:223]
s_waitcnt lgkmcnt(3)
v_mfma_f32_16x16x32_bf16 a[192:195], a[128:131], a[0:3], a[192:195]
ds_read_b64_tr_b16 a[136:137], v11 offset:0
v_mfma_f32_16x16x32_bf16 a[192:195], a[132:135], a[4:7], a[192:195]
v_mfma_f32_16x16x32_bf16 a[200:203], a[128:131], a[8:11], a[200:203]
ds_read_b64_tr_b16 a[138:139], v11 offset:2048
v_mfma_f32_16x16x32_bf16 a[200:203], a[132:135], a[12:15], a[200:203]
v_mfma_f32_16x16x32_bf16 a[208:211], a[128:131], a[16:19], a[208:211]
ds_read_b64_tr_b16 a[140:141], v11 offset:16384
v_mfma_f32_16x16x32_bf16 a[208:211], a[132:135], a[20:23], a[208:211]
v_mfma_f32_16x16x32_bf16 a[216:219], a[128:131], a[24:27], a[216:219]
ds_read_b64_tr_b16 a[142:143], v11 offset:18432
v_mfma_f32_16x16x32_bf16 a[216:219], a[132:135], a[28:31], a[216:219]
v_mfma_f32_16x16x32_bf16 a[224:227], a[128:131], a[32:35], a[224:227]
v_mfma_f32_16x16x32_bf16 a[224:227], a[132:135], a[36:39], a[224:227]
v_mfma_f32_16x16x32_bf16 a[232:235], a[128:131], a[40:43], a[232:235]
v_mfma_f32_16x16x32_bf16 a[232:235], a[132:135], a[44:47], a[232:235]
v_mfma_f32_16x16x32_bf16 a[240:243], a[128:131], a[48:51], a[240:243]
v_mfma_f32_16x16x32_bf16 a[240:243], a[132:135], a[52:55], a[240:243]
v_mfma_f32_16x16x32_bf16 a[248:251], a[128:131], a[56:59], a[248:251]
s_waitcnt vmcnt(2) lgkmcnt(0)
v_mfma_f32_16x16x32_bf16 a[248:251], a[132:135], a[60:63], a[248:251]
s_barrier
v_mfma_f32_16x16x32_bf16 a[196:199], a[136:139], a[0:3], a[196:199]
s_add_u32 m0, s29, 65536
ds_read_b64_tr_b16 a[128:129], v4 offset:32768
v_mfma_f32_16x16x32_bf16 a[196:199], a[140:143], a[4:7], a[196:199]
buffer_load_dwordx4 v16, s[12:15], s26 offen offset:0 lds
v_mfma_f32_16x16x32_bf16 a[204:207], a[136:139], a[8:11], a[204:207]
ds_read_b64_tr_b16 a[130:131], v4 offset:34816
v_mfma_f32_16x16x32_bf16 a[204:207], a[140:143], a[12:15], a[204:207]
v_mfma_f32_16x16x32_bf16 a[212:215], a[136:139], a[16:19], a[212:215]
ds_read_b64_tr_b16 a[132:133], v4 offset:49152
v_mfma_f32_16x16x32_bf16 a[212:215], a[140:143], a[20:23], a[212:215]
buffer_load_dwordx4 v17, s[12:15], s26 offen offset:1024 lds
v_mfma_f32_16x16x32_bf16 a[220:223], a[136:139], a[24:27], a[220:223]
ds_read_b64_tr_b16 a[134:135], v4 offset:51200
v_mfma_f32_16x16x32_bf16 a[220:223], a[140:143], a[28:31], a[220:223]
v_mfma_f32_16x16x32_bf16 a[228:231], a[136:139], a[32:35], a[228:231]
v_mfma_f32_16x16x32_bf16 a[228:231], a[140:143], a[36:39], a[228:231]
buffer_load_dwordx4 v18, s[12:15], s26 offen offset:2048 lds
v_mfma_f32_16x16x32_bf16 a[236:239], a[136:139], a[40:43], a[236:239]
v_mfma_f32_16x16x32_bf16 a[236:239], a[140:143], a[44:47], a[236:239]
v_mfma_f32_16x16x32_bf16 a[244:247], a[136:139], a[48:51], a[244:247]
v_mfma_f32_16x16x32_bf16 a[244:247], a[140:143], a[52:55], a[244:247]
s_waitcnt lgkmcnt(0)
buffer_load_dwordx4 v19, s[12:15], s26 offen offset:3072 lds
v_mfma_f32_16x16x32_bf16 a[252:255], a[136:139], a[56:59], a[252:255]
s_add_u32 s26, s26, 524288
s_bitcmp1_b32 s30, 1
v_mfma_f32_16x16x32_bf16 a[252:255], a[140:143], a[60:63], a[252:255]
s_cbranch_scc1 Lg_1
s_cmp_eq_u32 s30, 0
s_cbranch_scc1 Lg_1t
v_mfma_f32_16x16x32_bf16 v[32:35], a[128:131], a[64:67], v[32:35]
s_add_u32 m0, s29, 81920
ds_read_b64_tr_b16 a[136:137], v5 offset:32768
v_mfma_f32_16x16x32_bf16 v[32:35], a[132:135], a[68:71], v[32:35]
buffer_load_dwordx4 v16, s[12:15], s27 offen offset:0 lds
v_mfma_f32_16x16x32_bf16 v[40:43], a[128:131], a[72:75], v[40:43]
s_lshl_b32 s22, s38, 3
ds_read_b64_tr_b16 a[138:139], v5 offset:34816
v_mfma_f32_16x16x32_bf16 v[40:43], a[132:135], a[76:79], v[40:43]
s_lshl_b32 s23, s39, 5
v_and_b32 v252, 31, v0
v_lshrrev_b32 v253, 5, v0
v_mfma_f32_16x16x32_bf16 v[48:51], a[128:131], a[80:83], v[48:51]
ds_read_b64_tr_b16 a[140:141], v5 offset:49152
v_add_u32 v253, s22, v253
v_mfma_f32_16x16x32_bf16 v[48:51], a[132:135], a[84:87], v[48:51]
buffer_load_dwordx4 v17, s[12:15], s27 offen offset:1024 lds
v_mfma_f32_16x16x32_bf16 v[56:59], a[128:131], a[88:91], v[56:59]
ds_read_b64_tr_b16 a[142:143], v5 offset:51200
v_add_u32 v252, s23, v252
v_mfma_f32_16x16x32_bf16 v[56:59], a[132:135], a[92:95], v[56:59]
v_mul_u32_u24 v254, 7168, v253
v_lshl_add_u32 v254, v252, 2, v254
v_mfma_f32_16x16x32_bf16 v[64:67], a[128:131], a[96:99], v[64:67]
ds_read_b128 a[0:3], v2 offset:0
v_lshlrev_b32 v252, 4, v252
v_mfma_f32_16x16x32_bf16 v[64:67], a[132:135], a[100:103], v[64:67]
buffer_load_dwordx4 v18, s[12:15], s27 offen offset:2048 lds
v_mfma_f32_16x16x32_bf16 v[72:75], a[128:131], a[104:107], v[72:75]
ds_read_b128 a[4:7], v3 offset:0
v_add_u32 v255, 3584, v254
v_mfma_f32_16x16x32_bf16 v[72:75], a[132:135], a[108:111], v[72:75]
v_subrev_u32 v22, 3584, v254
v_subrev_u32 v23, 2688, v254
v_mfma_f32_16x16x32_bf16 v[80:83], a[128:131], a[112:115], v[80:83]
v_subrev_u32 v24, 1792, v254
v_subrev_u32 v25, 896, v254
v_mfma_f32_16x16x32_bf16 v[80:83], a[132:135], a[116:119], v[80:83]
buffer_load_dwordx4 v19, s[12:15], s27 offen offset:3072 lds
v_mfma_f32_16x16x32_bf16 v[88:91], a[128:131], a[120:123], v[88:91]
s_add_u32 s27, s27, 524288
ds_read_b128 a[8:11], v2 offset:2048
v_mfma_f32_16x16x32_bf16 v[88:91], a[132:135], a[124:127], v[88:91]
s_waitcnt lgkmcnt(3)
v_mfma_f32_16x16x32_bf16 v[36:39], a[136:139], a[64:67], v[36:39]
s_add_u32 m0, s28, 32768
ds_read_b64_tr_b16 a[128:129], v6 offset:32768
v_mfma_f32_16x16x32_bf16 v[36:39], a[140:143], a[68:71], v[36:39]
buffer_load_dwordx4 v12, s[8:11], s24 offen offset:0 lds
v_mfma_f32_16x16x32_bf16 v[44:47], a[136:139], a[72:75], v[44:47]
ds_read_b64_tr_b16 a[130:131], v6 offset:34816
v_mfma_f32_16x16x32_bf16 v[44:47], a[140:143], a[76:79], v[44:47]
v_mfma_f32_16x16x32_bf16 v[52:55], a[136:139], a[80:83], v[52:55]
ds_read_b64_tr_b16 a[132:133], v6 offset:49152
v_mfma_f32_16x16x32_bf16 v[52:55], a[140:143], a[84:87], v[52:55]
buffer_load_dwordx4 v13, s[8:11], s24 offen offset:1024 lds
v_mfma_f32_16x16x32_bf16 v[60:63], a[136:139], a[88:91], v[60:63]
ds_read_b64_tr_b16 a[134:135], v6 offset:51200
v_mfma_f32_16x16x32_bf16 v[60:63], a[140:143], a[92:95], v[60:63]
v_mfma_f32_16x16x32_bf16 v[68:71], a[136:139], a[96:99], v[68:71]
ds_read_b128 a[12:15], v3 offset:2048
v_mfma_f32_16x16x32_bf16 v[68:71], a[140:143], a[100:103], v[68:71]
buffer_load_dwordx4 v14, s[8:11], s24 offen offset:2048 lds
v_mfma_f32_16x16x32_bf16 v[76:79], a[136:139], a[104:107], v[76:79]
v_mfma_f32_16x16x32_bf16 v[76:79], a[140:143], a[108:111], v[76:79]
v_mfma_f32_16x16x32_bf16 v[84:87], a[136:139], a[112:115], v[84:87]
ds_read_b128 a[16:19], v2 offset:4096
v_mfma_f32_16x16x32_bf16 v[84:87], a[140:143], a[116:119], v[84:87]
buffer_load_dwordx4 v15, s[8:11], s24 offen offset:3072 lds
v_mfma_f32_16x16x32_bf16 v[92:95], a[136:139], a[120:123], v[92:95]
s_add_u32 s24, s24, 128
ds_read_b128 a[20:23], v3 offset:4096
v_mfma_f32_16x16x32_bf16 v[92:95], a[140:143], a[124:127], v[92:95]
s_waitcnt lgkmcnt(3)
v_mfma_f32_16x16x32_bf16 v[96:99], a[128:131], a[64:67], v[96:99]
s_add_u32 m0, s28, 36864
ds_read_b64_tr_b16 a[136:137], v7 offset:32768
v_mfma_f32_16x16x32_bf16 v[96:99], a[132:135], a[68:71], v[96:99]
buffer_load_dwordx4 v12, s[8:11], s25 offen offset:0 lds
v_mfma_f32_16x16x32_bf16 v[104:107], a[128:131], a[72:75], v[104:107]
ds_read_b64_tr_b16 a[138:139], v7 offset:34816
v_mfma_f32_16x16x32_bf16 v[104:107], a[132:135], a[76:79], v[104:107]
v_mfma_f32_16x16x32_bf16 v[112:115], a[128:131], a[80:83], v[112:115]
ds_read_b64_tr_b16 a[140:141], v7 offset:49152
v_mfma_f32_16x16x32_bf16 v[112:115], a[132:135], a[84:87], v[112:115]
buffer_load_dwordx4 v13, s[8:11], s25 offen offset:1024 lds
v_mfma_f32_16x16x32_bf16 v[120:123], a[128:131], a[88:91], v[120:123]
ds_read_b64_tr_b16 a[142:143], v7 offset:51200
v_mfma_f32_16x16x32_bf16 v[120:123], a[132:135], a[92:95], v[120:123]
v_mfma_f32_16x16x32_bf16 v[128:131], a[128:131], a[96:99], v[128:131]
v_mfma_f32_16x16x32_bf16 v[128:131], a[132:135], a[100:103], v[128:131]
buffer_load_dwordx4 v14, s[8:11], s25 offen offset:2048 lds
v_mfma_f32_16x16x32_bf16 v[136:139], a[128:131], a[104:107], v[136:139]
ds_read_b128 a[24:27], v2 offset:6144
v_mfma_f32_16x16x32_bf16 v[136:139], a[132:135], a[108:111], v[136:139]
v_mfma_f32_16x16x32_bf16 v[144:147], a[128:131], a[112:115], v[144:147]
ds_read_b128 a[28:31], v3 offset:6144
v_mfma_f32_16x16x32_bf16 v[144:147], a[132:135], a[116:119], v[144:147]
buffer_load_dwordx4 v15, s[8:11], s25 offen offset:3072 lds
v_mfma_f32_16x16x32_bf16 v[152:155], a[128:131], a[120:123], v[152:155]
s_add_u32 s25, s25, 128
v_mfma_f32_16x16x32_bf16 v[152:155], a[132:135], a[124:127], v[152:155]
s_waitcnt lgkmcnt(2)
v_mfma_f32_16x16x32_bf16 v[100:103], a[136:139], a[64:67], v[100:103]
s_mov_b64 s[56:57], s[70:71]
s_mov_b32 s58, 3584
s_mov_b32 s59, 0x20000
ds_read_b64_tr_b16 a[128:129], v8 offset:32768
v_mfma_f32_16x16x32_bf16 v[100:103], a[140:143], a[68:71], v[100:103]
buffer_load_dwordx4 v[248:251], v252, s[56:59], 0 offen
v_mfma_f32_16x16x32_bf16 v[108:111], a[136:139], a[72:75], v[108:111]
s_mov_b64 s[56:57], s[66:67]
s_mov_b32 s58, 1835008
ds_read_b64_tr_b16 a[130:131], v8 offset:34816
v_mfma_f32_16x16x32_bf16 v[108:111], a[140:143], a[76:79], v[108:111]
buffer_load_dword v224, v22, s[56:59], 0 offen nt
v_mfma_f32_16x16x32_bf16 v[116:119], a[136:139], a[80:83], v[116:119]
ds_read_b64_tr_b16 a[132:133], v8 offset:49152
v_mfma_f32_16x16x32_bf16 v[116:119], a[140:143], a[84:87], v[116:119]
buffer_load_dword v225, v23, s[56:59], 0 offen nt
v_mfma_f32_16x16x32_bf16 v[124:127], a[136:139], a[88:91], v[124:127]
ds_read_b64_tr_b16 a[134:135], v8 offset:51200
v_mfma_f32_16x16x32_bf16 v[124:127], a[140:143], a[92:95], v[124:127]
buffer_load_dword v226, v24, s[56:59], 0 offen nt
v_mfma_f32_16x16x32_bf16 v[132:135], a[136:139], a[96:99], v[132:135]
ds_read_b128 a[32:35], v2 offset:8192
v_mfma_f32_16x16x32_bf16 v[132:135], a[140:143], a[100:103], v[132:135]
buffer_load_dword v227, v25, s[56:59], 0 offen nt
v_mfma_f32_16x16x32_bf16 v[140:143], a[136:139], a[104:107], v[140:143]
buffer_load_dword v228, v254, s[56:59], 0 offen offset:0 nt
v_mfma_f32_16x16x32_bf16 v[140:143], a[140:143], a[108:111], v[140:143]
buffer_load_dword v229, v254, s[56:59], 0 offen offset:896 nt
v_mfma_f32_16x16x32_bf16 v[148:151], a[136:139], a[112:115], v[148:151]
ds_read_b128 a[36:39], v3 offset:8192
v_mfma_f32_16x16x32_bf16 v[148:151], a[140:143], a[116:119], v[148:151]
buffer_load_dword v230, v254, s[56:59], 0 offen offset:1792 nt
v_mfma_f32_16x16x32_bf16 v[156:159], a[136:139], a[120:123], v[156:159]
ds_read_b128 a[40:43], v2 offset:10240
v_mfma_f32_16x16x32_bf16 v[156:159], a[140:143], a[124:127], v[156:159]
s_waitcnt lgkmcnt(3)
buffer_load_dword v231, v254, s[56:59], 0 offen offset:2688 nt
v_mfma_f32_16x16x32_bf16 v[160:163], a[128:131], a[64:67], v[160:163]
ds_read_b64_tr_b16 a[136:137], v9 offset:32768
v_mfma_f32_16x16x32_bf16 v[160:163], a[132:135], a[68:71], v[160:163]
buffer_load_dword v232, v255, s[56:59], 0 offen offset:0 nt
v_mfma_f32_16x16x32_bf16 v[168:171], a[128:131], a[72:75], v[168:171]
ds_read_b64_tr_b16 a[138:139], v9 offset:34816
v_mfma_f32_16x16x32_bf16 v[168:171], a[132:135], a[76:79], v[168:171]
buffer_load_dword v233, v255, s[56:59], 0 offen offset:896 nt
v_mfma_f32_16x16x32_bf16 v[176:179], a[128:131], a[80:83], v[176:179]
ds_read_b64_tr_b16 a[140:141], v9 offset:49152
v_mfma_f32_16x16x32_bf16 v[176:179], a[132:135], a[84:87], v[176:179]
buffer_load_dword v234, v255, s[56:59], 0 offen offset:1792 nt
v_mfma_f32_16x16x32_bf16 v[184:187], a[128:131], a[88:91], v[184:187]
ds_read_b64_tr_b16 a[142:143], v9 offset:51200
v_mfma_f32_16x16x32_bf16 v[184:187], a[132:135], a[92:95], v[184:187]
buffer_load_dword v235, v255, s[56:59], 0 offen offset:2688 nt
v_mfma_f32_16x16x32_bf16 v[192:195], a[128:131], a[96:99], v[192:195]
s_mov_b64 s[56:57], s[68:69]
buffer_load_dword v236, v25, s[56:59], 0 offen nt
v_mfma_f32_16x16x32_bf16 v[192:195], a[132:135], a[100:103], v[192:195]
buffer_load_dword v237, v254, s[56:59], 0 offen offset:0 nt
v_mfma_f32_16x16x32_bf16 v[200:203], a[128:131], a[104:107], v[200:203]
ds_read_b128 a[44:47], v3 offset:10240
v_mfma_f32_16x16x32_bf16 v[200:203], a[132:135], a[108:111], v[200:203]
buffer_load_dword v238, v254, s[56:59], 0 offen offset:896 nt
v_mfma_f32_16x16x32_bf16 v[208:211], a[128:131], a[112:115], v[208:211]
ds_read_b128 a[48:51], v2 offset:12288
v_mfma_f32_16x16x32_bf16 v[208:211], a[132:135], a[116:119], v[208:211]
buffer_load_dword v239, v254, s[56:59], 0 offen offset:1792 nt
v_mfma_f32_16x16x32_bf16 v[216:219], a[128:131], a[120:123], v[216:219]
buffer_load_dword v240, v254, s[56:59], 0 offen offset:2688 nt
v_mfma_f32_16x16x32_bf16 v[216:219], a[132:135], a[124:127], v[216:219]
s_waitcnt lgkmcnt(2)
buffer_load_dword v241, v255, s[56:59], 0 offen offset:0 nt
v_mfma_f32_16x16x32_bf16 v[164:167], a[136:139], a[64:67], v[164:167]
ds_read_b64_tr_b16 a[128:129], v10 offset:32768
v_mfma_f32_16x16x32_bf16 v[164:167], a[140:143], a[68:71], v[164:167]
buffer_load_dword v242, v255, s[56:59], 0 offen offset:896 nt
v_mfma_f32_16x16x32_bf16 v[172:175], a[136:139], a[72:75], v[172:175]
ds_read_b64_tr_b16 a[130:131], v10 offset:34816
v_mfma_f32_16x16x32_bf16 v[172:175], a[140:143], a[76:79], v[172:175]
buffer_load_dword v243, v255, s[56:59], 0 offen offset:1792 nt
v_mfma_f32_16x16x32_bf16 v[180:183], a[136:139], a[80:83], v[180:183]
ds_read_b64_tr_b16 a[132:133], v10 offset:49152
v_mfma_f32_16x16x32_bf16 v[180:183], a[140:143], a[84:87], v[180:183]
buffer_load_dword v244, v255, s[56:59], 0 offen offset:2688 nt
v_mfma_f32_16x16x32_bf16 v[188:191], a[136:139], a[88:91], v[188:191]
ds_read_b64_tr_b16 a[134:135], v10 offset:51200
v_mfma_f32_16x16x32_bf16 v[188:191], a[140:143], a[92:95], v[188:191]
v_mfma_f32_16x16x32_bf16 v[196:199], a[136:139], a[96:99], v[196:199]
ds_read_b128 a[52:55], v3 offset:12288
v_mfma_f32_16x16x32_bf16 v[196:199], a[140:143], a[100:103], v[196:199]
v_mfma_f32_16x16x32_bf16 v[204:207], a[136:139], a[104:107], v[204:207]
ds_read_b128 a[56:59], v2 offset:14336
v_mfma_f32_16x16x32_bf16 v[204:207], a[140:143], a[108:111], v[204:207]
v_mfma_f32_16x16x32_bf16 v[212:215], a[136:139], a[112:115], v[212:215]
v_mfma_f32_16x16x32_bf16 v[212:215], a[140:143], a[116:119], v[212:215]
v_mfma_f32_16x16x32_bf16 v[220:223], a[136:139], a[120:123], v[220:223]
ds_read_b128 a[60:63], v3 offset:14336
v_mfma_f32_16x16x32_bf16 v[220:223], a[140:143], a[124:127], v[220:223]
s_waitcnt lgkmcnt(3)
v_mfma_f32_16x16x32_bf16 a[192:195], a[128:131], a[64:67], a[192:195]
ds_read_b64_tr_b16 a[136:137], v11 offset:32768
v_mfma_f32_16x16x32_bf16 a[192:195], a[132:135], a[68:71], a[192:195]
v_mfma_f32_16x16x32_bf16 a[200:203], a[128:131], a[72:75], a[200:203]
ds_read_b64_tr_b16 a[138:139], v11 offset:34816
v_mfma_f32_16x16x32_bf16 a[200:203], a[132:135], a[76:79], a[200:203]
v_mfma_f32_16x16x32_bf16 a[208:211], a[128:131], a[80:83], a[208:211]
ds_read_b64_tr_b16 a[140:141], v11 offset:49152
v_mfma_f32_16x16x32_bf16 a[208:211], a[132:135], a[84:87], a[208:211]
v_mfma_f32_16x16x32_bf16 a[216:219], a[128:131], a[88:91], a[216:219]
ds_read_b64_tr_b16 a[142:143], v11 offset:51200
v_mfma_f32_16x16x32_bf16 a[216:219], a[132:135], a[92:95], a[216:219]
v_mfma_f32_16x16x32_bf16 a[224:227], a[128:131], a[96:99], a[224:227]
v_mfma_f32_16x16x32_bf16 a[224:227], a[132:135], a[100:103], a[224:227]
v_mfma_f32_16x16x32_bf16 a[232:235], a[128:131], a[104:107], a[232:235]
v_mfma_f32_16x16x32_bf16 a[232:235], a[132:135], a[108:111], a[232:235]
v_mfma_f32_16x16x32_bf16 a[240:243], a[128:131], a[112:115], a[240:243]
v_mfma_f32_16x16x32_bf16 a[240:243], a[132:135], a[116:119], a[240:243]
v_mfma_f32_16x16x32_bf16 a[248:251], a[128:131], a[120:123], a[248:251]
s_waitcnt vmcnt(22) lgkmcnt(0)
v_mfma_f32_16x16x32_bf16 a[248:251], a[132:135], a[124:127], a[248:251]
s_barrier
v_mfma_f32_16x16x32_bf16 a[196:199], a[136:139], a[64:67], a[196:199]
s_add_u32 m0, s29, 98304
ds_read_b64_tr_b16 a[128:129], v4 offset:0
v_mfma_f32_16x16x32_bf16 a[196:199], a[140:143], a[68:71], a[196:199]
buffer_load_dwordx4 v16, s[12:15], s26 offen offset:0 lds
v_mfma_f32_16x16x32_bf16 a[204:207], a[136:139], a[72:75], a[204:207]
ds_read_b64_tr_b16 a[130:131], v4 offset:2048
v_mfma_f32_16x16x32_bf16 a[204:207], a[140:143], a[76:79], a[204:207]
v_mfma_f32_16x16x32_bf16 a[212:215], a[136:139], a[80:83], a[212:215]
ds_read_b64_tr_b16 a[132:133], v4 offset:16384
v_mfma_f32_16x16x32_bf16 a[212:215], a[140:143], a[84:87], a[212:215]
buffer_load_dwordx4 v17, s[12:15], s26 offen offset:1024 lds
v_mfma_f32_16x16x32_bf16 a[220:223], a[136:139], a[88:91], a[220:223]
ds_read_b64_tr_b16 a[134:135], v4 offset:18432
v_mfma_f32_16x16x32_bf16 a[220:223], a[140:143], a[92:95], a[220:223]
v_mfma_f32_16x16x32_bf16 a[228:231], a[136:139], a[96:99], a[228:231]
v_mfma_f32_16x16x32_bf16 a[228:231], a[140:143], a[100:103], a[228:231]
buffer_load_dwordx4 v18, s[12:15], s26 offen offset:2048 lds
v_mfma_f32_16x16x32_bf16 a[236:239], a[136:139], a[104:107], a[236:239]
v_mfma_f32_16x16x32_bf16 a[236:239], a[140:143], a[108:111], a[236:239]
v_mfma_f32_16x16x32_bf16 a[244:247], a[136:139], a[112:115], a[244:247]
v_mfma_f32_16x16x32_bf16 a[244:247], a[140:143], a[116:119], a[244:247]
buffer_load_dwordx4 v19, s[12:15], s26 offen offset:3072 lds
v_mfma_f32_16x16x32_bf16 a[252:255], a[136:139], a[120:123], a[252:255]
s_add_u32 s26, s26, 524288
v_mfma_f32_16x16x32_bf16 a[252:255], a[140:143], a[124:127], a[252:255]
s_waitcnt lgkmcnt(0)
v_mfma_f32_16x16x32_bf16 v[32:35], a[128:131], a[0:3], v[32:35]
s_add_u32 m0, s29, 114688
ds_read_b64_tr_b16 a[136:137], v5 offset:0
v_mfma_f32_16x16x32_bf16 v[32:35], a[132:135], a[4:7], v[32:35]
buffer_load_dwordx4 v16, s[12:15], s27 offen offset:0 lds
v_mfma_f32_16x16x32_bf16 v[40:43], a[128:131], a[8:11], v[40:43]
ds_read_b64_tr_b16 a[138:139], v5 offset:2048
v_mfma_f32_16x16x32_bf16 v[40:43], a[132:135], a[12:15], v[40:43]
v_mfma_f32_16x16x32_bf16 v[48:51], a[128:131], a[16:19], v[48:51]
ds_read_b64_tr_b16 a[140:141], v5 offset:16384
v_mfma_f32_16x16x32_bf16 v[48:51], a[132:135], a[20:23], v[48:51]
buffer_load_dwordx4 v17, s[12:15], s27 offen offset:1024 lds
v_mfma_f32_16x16x32_bf16 v[56:59], a[128:131], a[24:27], v[56:59]
ds_read_b64_tr_b16 a[142:143], v5 offset:18432
v_mfma_f32_16x16x32_bf16 v[56:59], a[132:135], a[28:31], v[56:59]
v_mfma_f32_16x16x32_bf16 v[64:67], a[128:131], a[32:35], v[64:67]
ds_read_b128 a[64:67], v2 offset:32768
v_mfma_f32_16x16x32_bf16 v[64:67], a[132:135], a[36:39], v[64:67]
buffer_load_dwordx4 v18, s[12:15], s27 offen offset:2048 lds
v_mfma_f32_16x16x32_bf16 v[72:75], a[128:131], a[40:43], v[72:75]
ds_read_b128 a[68:71], v3 offset:32768
v_mfma_f32_16x16x32_bf16 v[72:75], a[132:135], a[44:47], v[72:75]
v_mfma_f32_16x16x32_bf16 v[80:83], a[128:131], a[48:51], v[80:83]
v_mfma_f32_16x16x32_bf16 v[80:83], a[132:135], a[52:55], v[80:83]
buffer_load_dwordx4 v19, s[12:15], s27 offen offset:3072 lds
v_mfma_f32_16x16x32_bf16 v[88:91], a[128:131], a[56:59], v[88:91]
s_add_u32 s27, s27, 524288
ds_read_b128 a[72:75], v2 offset:34816
v_mfma_f32_16x16x32_bf16 v[88:91], a[132:135], a[60:63], v[88:91]
s_waitcnt lgkmcnt(3)
v_mfma_f32_16x16x32_bf16 v[36:39], a[136:139], a[0:3], v[36:39]
s_add_u32 m0, s28, 0
ds_read_b64_tr_b16 a[128:129], v6 offset:0
v_mfma_f32_16x16x32_bf16 v[36:39], a[140:143], a[4:7], v[36:39]
buffer_load_dwordx4 v12, s[8:11], s24 offen offset:0 lds
v_mfma_f32_16x16x32_bf16 v[44:47], a[136:139], a[8:11], v[44:47]
ds_read_b64_tr_b16 a[130:131], v6 offset:2048
v_mfma_f32_16x16x32_bf16 v[44:47], a[140:143], a[12:15], v[44:47]
v_mfma_f32_16x16x32_bf16 v[52:55], a[136:139], a[16:19], v[52:55]
ds_read_b64_tr_b16 a[132:133], v6 offset:16384
v_mfma_f32_16x16x32_bf16 v[52:55], a[140:143], a[20:23], v[52:55]
buffer_load_dwordx4 v13, s[8:11], s24 offen offset:1024 lds
v_mfma_f32_16x16x32_bf16 v[60:63], a[136:139], a[24:27], v[60:63]
ds_read_b64_tr_b16 a[134:135], v6 offset:18432
v_mfma_f32_16x16x32_bf16 v[60:63], a[140:143], a[28:31], v[60:63]
v_mfma_f32_16x16x32_bf16 v[68:71], a[136:139], a[32:35], v[68:71]
ds_read_b128 a[76:79], v3 offset:34816
v_mfma_f32_16x16x32_bf16 v[68:71], a[140:143], a[36:39], v[68:71]
buffer_load_dwordx4 v14, s[8:11], s24 offen offset:2048 lds
v_mfma_f32_16x16x32_bf16 v[76:79], a[136:139], a[40:43], v[76:79]
v_mfma_f32_16x16x32_bf16 v[76:79], a[140:143], a[44:47], v[76:79]
v_mfma_f32_16x16x32_bf16 v[84:87], a[136:139], a[48:51], v[84:87]
ds_read_b128 a[80:83], v2 offset:36864
v_mfma_f32_16x16x32_bf16 v[84:87], a[140:143], a[52:55], v[84:87]
buffer_load_dwordx4 v15, s[8:11], s24 offen offset:3072 lds
v_mfma_f32_16x16x32_bf16 v[92:95], a[136:139], a[56:59], v[92:95]
s_add_u32 s24, s24, 128
ds_read_b128 a[84:87], v3 offset:36864
v_mfma_f32_16x16x32_bf16 v[92:95], a[140:143], a[60:63], v[92:95]
s_waitcnt lgkmcnt(3)
v_mfma_f32_16x16x32_bf16 v[96:99], a[128:131], a[0:3], v[96:99]
s_add_u32 m0, s28, 4096
ds_read_b64_tr_b16 a[136:137], v7 offset:0
v_mfma_f32_16x16x32_bf16 v[96:99], a[132:135], a[4:7], v[96:99]
buffer_load_dwordx4 v12, s[8:11], s25 offen offset:0 lds
v_mfma_f32_16x16x32_bf16 v[104:107], a[128:131], a[8:11], v[104:107]
ds_read_b64_tr_b16 a[138:139], v7 offset:2048
v_mfma_f32_16x16x32_bf16 v[104:107], a[132:135], a[12:15], v[104:107]
v_mfma_f32_16x16x32_bf16 v[112:115], a[128:131], a[16:19], v[112:115]
ds_read_b64_tr_b16 a[140:141], v7 offset:16384
v_mfma_f32_16x16x32_bf16 v[112:115], a[132:135], a[20:23], v[112:115]
buffer_load_dwordx4 v13, s[8:11], s25 offen offset:1024 lds
v_mfma_f32_16x16x32_bf16 v[120:123], a[128:131], a[24:27], v[120:123]
ds_read_b64_tr_b16 a[142:143], v7 offset:18432
v_mfma_f32_16x16x32_bf16 v[120:123], a[132:135], a[28:31], v[120:123]
v_mfma_f32_16x16x32_bf16 v[128:131], a[128:131], a[32:35], v[128:131]
v_mfma_f32_16x16x32_bf16 v[128:131], a[132:135], a[36:39], v[128:131]
buffer_load_dwordx4 v14, s[8:11], s25 offen offset:2048 lds
v_mfma_f32_16x16x32_bf16 v[136:139], a[128:131], a[40:43], v[136:139]
ds_read_b128 a[88:91], v2 offset:38912
v_mfma_f32_16x16x32_bf16 v[136:139], a[132:135], a[44:47], v[136:139]
v_mfma_f32_16x16x32_bf16 v[144:147], a[128:131], a[48:51], v[144:147]
ds_read_b128 a[92:95], v3 offset:38912
v_mfma_f32_16x16x32_bf16 v[144:147], a[132:135], a[52:55], v[144:147]
buffer_load_dwordx4 v15, s[8:11], s25 offen offset:3072 lds
v_mfma_f32_16x16x32_bf16 v[152:155], a[128:131], a[56:59], v[152:155]
s_add_u32 s25, s25, 128
v_mfma_f32_16x16x32_bf16 v[152:155], a[132:135], a[60:63], v[152:155]
s_waitcnt lgkmcnt(2)
v_mfma_f32_16x16x32_bf16 v[100:103], a[136:139], a[0:3], v[100:103]
ds_read_b64_tr_b16 a[128:129], v8 offset:0
v_mfma_f32_16x16x32_bf16 v[100:103], a[140:143], a[4:7], v[100:103]
buffer_load_dword v21, v20, s[16:19], s43 offen
v_mfma_f32_16x16x32_bf16 v[108:111], a[136:139], a[8:11], v[108:111]
s_add_u32 s43, s43, s47
ds_read_b64_tr_b16 a[130:131], v8 offset:2048
v_mfma_f32_16x16x32_bf16 v[108:111], a[140:143], a[12:15], v[108:111]
PAD_2:
s_cbranch_execz M_tret
s_cmp_ge_u32 s43, s51
v_mfma_f32_16x16x32_bf16 v[116:119], a[136:139], a[16:19], v[116:119]
s_cselect_b32 s43, 0, s43
ds_read_b64_tr_b16 a[132:133], v8 offset:16384
v_mfma_f32_16x16x32_bf16 v[116:119], a[140:143], a[20:23], v[116:119]
s_cselect_b32 s51, s42, s51
v_mfma_f32_16x16x32_bf16 v[124:127], a[136:139], a[24:27], v[124:127]
s_cselect_b64 s[16:17], s[40:41], s[16:17]
ds_read_b64_tr_b16 a[134:135], v8 offset:18432
v_mfma_f32_16x16x32_bf16 v[124:127], a[140:143], a[28:31], v[124:127]
s_cselect_b32 s18, s42, s18
v_mfma_f32_16x16x32_bf16 v[132:135], a[136:139], a[32:35], v[132:135]
s_cselect_b64 s[40:41], s[44:45], s[40:41]
ds_read_b128 a[96:99], v2 offset:40960
v_mfma_f32_16x16x32_bf16 v[132:135], a[140:143], a[36:39], v[132:135]
s_cselect_b32 s42, s46, s42
v_mfma_f32_16x16x32_bf16 v[140:143], a[136:139], a[40:43], v[140:143]
s_cselect_b32 s46, 0, s46
v_mfma_f32_16x16x32_bf16 v[140:143], a[140:143], a[44:47], v[140:143]
s_lshl_b32 s59, s39, 5
v_mfma_f32_16x16x32_bf16 v[148:151], a[136:139], a[48:51], v[148:151]
s_add_u32 s59, s59, s38
ds_read_b128 a[100:103], v3 offset:40960
v_mfma_f32_16x16x32_bf16 v[148:151], a[140:143], a[52:55], v[148:151]
s_lshl_b32 s59, s59, 2
v_mfma_f32_16x16x32_bf16 v[156:159], a[136:139], a[56:59], v[156:159]
s_add_u32 s59, s59, 94392320
ds_read_b128 a[104:107], v2 offset:43008
v_mfma_f32_16x16x32_bf16 v[156:159], a[140:143], a[60:63], v[156:159]
s_waitcnt lgkmcnt(3)
s_cmp_lt_u32 s2, 224
v_mfma_f32_16x16x32_bf16 v[160:163], a[128:131], a[0:3], v[160:163]
s_cselect_b32 s59, s59, 3221225472
ds_read_b64_tr_b16 a[136:137], v9 offset:0
v_mfma_f32_16x16x32_bf16 v[160:163], a[132:135], a[4:7], v[160:163]
s_mov_b32 s58, 0xffff0000
v_mfma_f32_16x16x32_bf16 v[168:171], a[128:131], a[8:11], v[168:171]
s_cmp_lt_u32 s3, 1
ds_read_b64_tr_b16 a[138:139], v9 offset:2048
v_mfma_f32_16x16x32_bf16 v[168:171], a[132:135], a[12:15], v[168:171]
s_cselect_b32 s54, 0, 3221225472
v_mfma_f32_16x16x32_bf16 v[176:179], a[128:131], a[16:19], v[176:179]
s_cselect_b32 s50, 0x100, 0
ds_read_b64_tr_b16 a[140:141], v9 offset:16384
v_mfma_f32_16x16x32_bf16 v[176:179], a[132:135], a[20:23], v[176:179]
v_mfma_f32_16x16x32_bf16 v[184:187], a[128:131], a[24:27], v[184:187]
ds_read_b64_tr_b16 a[142:143], v9 offset:18432
v_mfma_f32_16x16x32_bf16 v[184:187], a[132:135], a[28:31], v[184:187]
v_mfma_f32_16x16x32_bf16 v[192:195], a[128:131], a[32:35], v[192:195]
v_mfma_f32_16x16x32_bf16 v[192:195], a[132:135], a[36:39], v[192:195]
v_mfma_f32_16x16x32_bf16 v[200:203], a[128:131], a[40:43], v[200:203]
ds_read_b128 a[108:111], v3 offset:43008
v_mfma_f32_16x16x32_bf16 v[200:203], a[132:135], a[44:47], v[200:203]
v_mfma_f32_16x16x32_bf16 v[208:211], a[128:131], a[48:51], v[208:211]
ds_read_b128 a[112:115], v2 offset:45056
v_mfma_f32_16x16x32_bf16 v[208:211], a[132:135], a[52:55], v[208:211]
v_mfma_f32_16x16x32_bf16 v[216:219], a[128:131], a[56:59], v[216:219]
v_mfma_f32_16x16x32_bf16 v[216:219], a[132:135], a[60:63], v[216:219]
s_waitcnt lgkmcnt(2)
v_mfma_f32_16x16x32_bf16 v[164:167], a[136:139], a[0:3], v[164:167]
ds_read_b64_tr_b16 a[128:129], v10 offset:0
v_mfma_f32_16x16x32_bf16 v[164:167], a[140:143], a[4:7], v[164:167]
v_mfma_f32_16x16x32_bf16 v[172:175], a[136:139], a[8:11], v[172:175]
ds_read_b64_tr_b16 a[130:131], v10 offset:2048
v_mfma_f32_16x16x32_bf16 v[172:175], a[140:143], a[12:15], v[172:175]
v_mfma_f32_16x16x32_bf16 v[180:183], a[136:139], a[16:19], v[180:183]
ds_read_b64_tr_b16 a[132:133], v10 offset:16384
v_mfma_f32_16x16x32_bf16 v[180:183], a[140:143], a[20:23], v[180:183]
v_mfma_f32_16x16x32_bf16 v[188:191], a[136:139], a[24:27], v[188:191]
ds_read_b64_tr_b16 a[134:135], v10 offset:18432
v_mfma_f32_16x16x32_bf16 v[188:191], a[140:143], a[28:31], v[188:191]
v_mfma_f32_16x16x32_bf16 v[196:199], a[136:139], a[32:35], v[196:199]
ds_read_b128 a[116:119], v3 offset:45056
v_mfma_f32_16x16x32_bf16 v[196:199], a[140:143], a[36:39], v[196:199]
v_mfma_f32_16x16x32_bf16 v[204:207], a[136:139], a[40:43], v[204:207]
ds_read_b128 a[120:123], v2 offset:47104
v_and_b32 v252, 31, v0
v_mfma_f32_16x16x32_bf16 v[204:207], a[140:143], a[44:47], v[204:207]
v_lshrrev_b32 v253, 5, v0
v_xor_b32 v253, v253, v252
v_mfma_f32_16x16x32_bf16 v[212:215], a[136:139], a[48:51], v[212:215]
v_and_b32 v253, 7, v253
v_lshlrev_b32 v252, 8, v252
v_mfma_f32_16x16x32_bf16 v[212:215], a[140:143], a[52:55], v[212:215]
v_lshl_add_u32 v252, v253, 4, v252
v_add_u32 v252, 147456, v252
v_mfma_f32_16x16x32_bf16 v[220:223], a[136:139], a[56:59], v[220:223]
ds_read_b128 a[124:127], v3 offset:47104
v_mfma_f32_16x16x32_bf16 v[220:223], a[140:143], a[60:63], v[220:223]
s_waitcnt lgkmcnt(3)
v_mfma_f32_16x16x32_bf16 a[192:195], a[128:131], a[0:3], a[192:195]
ds_read_b64_tr_b16 a[136:137], v11 offset:0
v_mfma_f32_16x16x32_bf16 a[192:195], a[132:135], a[4:7], a[192:195]
v_mfma_f32_16x16x32_bf16 a[200:203], a[128:131], a[8:11], a[200:203]
ds_read_b64_tr_b16 a[138:139], v11 offset:2048
v_mfma_f32_16x16x32_bf16 a[200:203], a[132:135], a[12:15], a[200:203]
v_mfma_f32_16x16x32_bf16 a[208:211], a[128:131], a[16:19], a[208:211]
ds_read_b64_tr_b16 a[140:141], v11 offset:16384
v_mfma_f32_16x16x32_bf16 a[208:211], a[132:135], a[20:23], a[208:211]
v_mfma_f32_16x16x32_bf16 a[216:219], a[128:131], a[24:27], a[216:219]
ds_read_b64_tr_b16 a[142:143], v11 offset:18432
v_mfma_f32_16x16x32_bf16 a[216:219], a[132:135], a[28:31], a[216:219]
v_mfma_f32_16x16x32_bf16 a[224:227], a[128:131], a[32:35], a[224:227]
v_mfma_f32_16x16x32_bf16 a[224:227], a[132:135], a[36:39], a[224:227]
v_mfma_f32_16x16x32_bf16 a[232:235], a[128:131], a[40:43], a[232:235]
v_mfma_f32_16x16x32_bf16 a[232:235], a[132:135], a[44:47], a[232:235]
v_mfma_f32_16x16x32_bf16 a[240:243], a[128:131], a[48:51], a[240:243]
v_mfma_f32_16x16x32_bf16 a[240:243], a[132:135], a[52:55], a[240:243]
v_mfma_f32_16x16x32_bf16 a[248:251], a[128:131], a[56:59], a[248:251]
s_waitcnt vmcnt(1) lgkmcnt(0)
v_mfma_f32_16x16x32_bf16 a[248:251], a[132:135], a[60:63], a[248:251]
s_barrier
v_mfma_f32_16x16x32_bf16 a[196:199], a[136:139], a[0:3], a[196:199]
s_add_u32 m0, s29, 65536
ds_read_b64_tr_b16 a[128:129], v4 offset:32768
v_lshlrev_b32 v28, 16, v248
v_mfma_f32_16x16x32_bf16 a[196:199], a[140:143], a[4:7], a[196:199]
buffer_load_dwordx4 v16, s[12:15], s26 offen offset:0 lds
v_mfma_f32_16x16x32_bf16 a[204:207], a[136:139], a[8:11], a[204:207]
ds_read_b64_tr_b16 a[130:131], v4 offset:34816
v_and_b32 v29, s58, v248
v_mfma_f32_16x16x32_bf16 a[204:207], a[140:143], a[12:15], a[204:207]
v_lshlrev_b32 v30, 16, v249
v_and_b32 v253, s58, v249
v_mfma_f32_16x16x32_bf16 a[212:215], a[136:139], a[16:19], a[212:215]
ds_read_b64_tr_b16 a[132:133], v4 offset:49152
v_lshlrev_b32 v22, 16, v224
v_mfma_f32_16x16x32_bf16 a[212:215], a[140:143], a[20:23], a[212:215]
buffer_load_dwordx4 v17, s[12:15], s26 offen offset:1024 lds
v_mfma_f32_16x16x32_bf16 a[220:223], a[136:139], a[24:27], a[220:223]
ds_read_b64_tr_b16 a[134:135], v4 offset:51200
v_lshlrev_b32 v23, 16, v225
v_mfma_f32_16x16x32_bf16 a[220:223], a[140:143], a[28:31], a[220:223]
v_lshlrev_b32 v24, 16, v226
v_mul_f32 v254, v22, v253
v_mfma_f32_16x16x32_bf16 a[228:231], a[136:139], a[32:35], a[228:231]
v_lshlrev_b32 v25, 16, v227
v_lshlrev_b32 v247, 16, v236
v_mfma_f32_16x16x32_bf16 a[228:231], a[140:143], a[36:39], a[228:231]
buffer_load_dwordx4 v18, s[12:15], s26 offen offset:2048 lds
v_mfma_f32_16x16x32_bf16 a[236:239], a[136:139], a[40:43], a[236:239]
v_fmac_f32 v254, v23, v30
v_fmac_f32 v254, v24, v29
v_mfma_f32_16x16x32_bf16 a[236:239], a[140:143], a[44:47], a[236:239]
v_fmac_f32 v254, v25, v28
v_mul_f32 v254, v254, v247
v_mfma_f32_16x16x32_bf16 a[244:247], a[136:139], a[48:51], a[244:247]
v_mul_f32 v255, v23, v253
v_lshlrev_b32 v22, 16, v228
v_mfma_f32_16x16x32_bf16 a[244:247], a[140:143], a[52:55], a[244:247]
buffer_load_dwordx4 v19, s[12:15], s26 offen offset:3072 lds
v_mfma_f32_16x16x32_bf16 a[252:255], a[136:139], a[56:59], a[252:255]
s_add_u32 s26, s26, 524288
v_lshlrev_b32 v247, 16, v237
v_fmac_f32 v255, v24, v30
v_mfma_f32_16x16x32_bf16 a[252:255], a[140:143], a[60:63], a[252:255]
s_waitcnt lgkmcnt(0)
v_fmac_f32 v255, v25, v29
v_fmac_f32 v255, v22, v28
v_mfma_f32_16x16x32_bf16 v[32:35], a[128:131], a[64:67], v[32:35]
s_add_u32 m0, s29, 81920
ds_read_b64_tr_b16 a[136:137], v5 offset:32768
v_mul_f32 v255, v255, v247
v_mfma_f32_16x16x32_bf16 v[32:35], a[132:135], a[68:71], v[32:35]
buffer_load_dwordx4 v16, s[12:15], s27 offen offset:0 lds
v_mfma_f32_16x16x32_bf16 v[40:43], a[128:131], a[72:75], v[40:43]
ds_read_b64_tr_b16 a[138:139], v5 offset:34816
v_cvt_pk_bf16_f32 v246, v254, v255
v_mfma_f32_16x16x32_bf16 v[40:43], a[132:135], a[76:79], v[40:43]
v_accvgpr_write_b32 a180, v246
v_mul_f32 v254, v24, v253
v_mfma_f32_16x16x32_bf16 v[48:51], a[128:131], a[80:83], v[48:51]
ds_read_b64_tr_b16 a[140:141], v5 offset:49152
v_lshlrev_b32 v23, 16, v229
v_mfma_f32_16x16x32_bf16 v[48:51], a[132:135], a[84:87], v[48:51]
buffer_load_dwordx4 v17, s[12:15], s27 offen offset:1024 lds
v_mfma_f32_16x16x32_bf16 v[56:59], a[128:131], a[88:91], v[56:59]
ds_read_b64_tr_b16 a[142:143], v5 offset:51200
v_lshlrev_b32 v247, 16, v238
v_mfma_f32_16x16x32_bf16 v[56:59], a[132:135], a[92:95], v[56:59]
v_fmac_f32 v254, v25, v30
v_fmac_f32 v254, v22, v29
v_fmac_f32 v254, v23, v28
v_mfma_f32_16x16x32_bf16 v[64:67], a[128:131], a[96:99], v[64:67]
ds_read_b128 a[0:3], v2 offset:0
v_mul_f32 v254, v254, v247
v_mfma_f32_16x16x32_bf16 v[64:67], a[132:135], a[100:103], v[64:67]
buffer_load_dwordx4 v18, s[12:15], s27 offen offset:2048 lds
v_mfma_f32_16x16x32_bf16 v[72:75], a[128:131], a[104:107], v[72:75]
ds_read_b128 a[4:7], v3 offset:0
v_cvt_pk_bf16_f32 v246, v255, v254
v_mfma_f32_16x16x32_bf16 v[72:75], a[132:135], a[108:111], v[72:75]
v_accvgpr_write_b32 a176, v246
v_mul_f32 v255, v25, v253
v_mfma_f32_16x16x32_bf16 v[80:83], a[128:131], a[112:115], v[80:83]
v_lshlrev_b32 v24, 16, v230
v_lshlrev_b32 v247, 16, v239
v_mfma_f32_16x16x32_bf16 v[80:83], a[132:135], a[116:119], v[80:83]
buffer_load_dwordx4 v19, s[12:15], s27 offen offset:3072 lds
v_mfma_f32_16x16x32_bf16 v[88:91], a[128:131], a[120:123], v[88:91]
s_add_u32 s27, s27, 524288
ds_read_b128 a[8:11], v2 offset:2048
v_fmac_f32 v255, v22, v30
v_mfma_f32_16x16x32_bf16 v[88:91], a[132:135], a[124:127], v[88:91]
s_waitcnt lgkmcnt(3)
v_fmac_f32 v255, v23, v29
v_fmac_f32 v255, v24, v28
v_mul_f32 v255, v255, v247
v_mfma_f32_16x16x32_bf16 v[36:39], a[136:139], a[64:67], v[36:39]
s_add_u32 m0, s28, 32768
ds_read_b64_tr_b16 a[128:129], v6 offset:32768
v_cvt_pk_bf16_f32 v246, v254, v255
v_mfma_f32_16x16x32_bf16 v[36:39], a[140:143], a[68:71], v[36:39]
buffer_load_dwordx4 v12, s[8:11], s24 offen offset:0 lds
v_mfma_f32_16x16x32_bf16 v[44:47], a[136:139], a[72:75], v[44:47]
ds_read_b64_tr_b16 a[130:131], v6 offset:34816
v_accvgpr_write_b32 a181, v246
v_mfma_f32_16x16x32_bf16 v[44:47], a[140:143], a[76:79], v[44:47]
v_mul_f32 v254, v22, v253
v_lshlrev_b32 v25, 16, v231
v_mfma_f32_16x16x32_bf16 v[52:55], a[136:139], a[80:83], v[52:55]
ds_read_b64_tr_b16 a[132:133], v6 offset:49152
v_lshlrev_b32 v247, 16, v240
v_mfma_f32_16x16x32_bf16 v[52:55], a[140:143], a[84:87], v[52:55]
buffer_load_dwordx4 v13, s[8:11], s24 offen offset:1024 lds
v_mfma_f32_16x16x32_bf16 v[60:63], a[136:139], a[88:91], v[60:63]
ds_read_b64_tr_b16 a[134:135], v6 offset:51200
v_fmac_f32 v254, v23, v30
v_fmac_f32 v254, v24, v29
v_mfma_f32_16x16x32_bf16 v[60:63], a[140:143], a[92:95], v[60:63]
v_fmac_f32 v254, v25, v28
v_mul_f32 v254, v254, v247
v_mfma_f32_16x16x32_bf16 v[68:71], a[136:139], a[96:99], v[68:71]
ds_read_b128 a[12:15], v3 offset:2048
v_cvt_pk_bf16_f32 v246, v255, v254
v_mfma_f32_16x16x32_bf16 v[68:71], a[140:143], a[100:103], v[68:71]
buffer_load_dwordx4 v14, s[8:11], s24 offen offset:2048 lds
v_mfma_f32_16x16x32_bf16 v[76:79], a[136:139], a[104:107], v[76:79]
v_accvgpr_write_b32 a177, v246
v_mul_f32 v255, v23, v253
v_mfma_f32_16x16x32_bf16 v[76:79], a[140:143], a[108:111], v[76:79]
v_lshlrev_b32 v22, 16, v232
v_lshlrev_b32 v247, 16, v241
v_mfma_f32_16x16x32_bf16 v[84:87], a[136:139], a[112:115], v[84:87]
ds_read_b128 a[16:19], v2 offset:4096
v_fmac_f32 v255, v24, v30
v_mfma_f32_16x16x32_bf16 v[84:87], a[140:143], a[116:119], v[84:87]
buffer_load_dwordx4 v15, s[8:11], s24 offen offset:3072 lds
v_mfma_f32_16x16x32_bf16 v[92:95], a[136:139], a[120:123], v[92:95]
s_add_u32 s24, s24, 128
ds_read_b128 a[20:23], v3 offset:4096
v_fmac_f32 v255, v25, v29
v_fmac_f32 v255, v22, v28
v_mfma_f32_16x16x32_bf16 v[92:95], a[140:143], a[124:127], v[92:95]
s_waitcnt lgkmcnt(3)
v_mul_f32 v255, v255, v247
v_cvt_pk_bf16_f32 v246, v254, v255
v_mfma_f32_16x16x32_bf16 v[96:99], a[128:131], a[64:67], v[96:99]
s_add_u32 m0, s28, 36864
ds_read_b64_tr_b16 a[136:137], v7 offset:32768
v_accvgpr_write_b32 a182, v246
v_mfma_f32_16x16x32_bf16 v[96:99], a[132:135], a[68:71], v[96:99]
buffer_load_dwordx4 v12, s[8:11], s25 offen offset:0 lds
v_mfma_f32_16x16x32_bf16 v[104:107], a[128:131], a[72:75], v[104:107]
ds_read_b64_tr_b16 a[138:139], v7 offset:34816
v_mul_f32 v254, v24, v253
v_mfma_f32_16x16x32_bf16 v[104:107], a[132:135], a[76:79], v[104:107]
v_lshlrev_b32 v23, 16, v233
v_lshlrev_b32 v247, 16, v242
v_mfma_f32_16x16x32_bf16 v[112:115], a[128:131], a[80:83], v[112:115]
ds_read_b64_tr_b16 a[140:141], v7 offset:49152
v_fmac_f32 v254, v25, v30
v_mfma_f32_16x16x32_bf16 v[112:115], a[132:135], a[84:87], v[112:115]
buffer_load_dwordx4 v13, s[8:11], s25 offen offset:1024 lds
v_fmac_f32 v254, v22, v29
v_mfma_f32_16x16x32_bf16 v[120:123], a[128:131], a[88:91], v[120:123]
ds_read_b64_tr_b16 a[142:143], v7 offset:51200
v_fmac_f32 v254, v23, v28
v_mfma_f32_16x16x32_bf16 v[120:123], a[132:135], a[92:95], v[120:123]
v_mul_f32 v254, v254, v247
v_cvt_pk_bf16_f32 v246, v255, v254
v_mfma_f32_16x16x32_bf16 v[128:131], a[128:131], a[96:99], v[128:131]
v_accvgpr_write_b32 a178, v246
v_mul_f32 v255, v25, v253
v_mfma_f32_16x16x32_bf16 v[128:131], a[132:135], a[100:103], v[128:131]
buffer_load_dwordx4 v14, s[8:11], s25 offen offset:2048 lds
v_mfma_f32_16x16x32_bf16 v[136:139], a[128:131], a[104:107], v[136:139]
ds_read_b128 a[24:27], v2 offset:6144
v_lshlrev_b32 v24, 16, v234
v_mfma_f32_16x16x32_bf16 v[136:139], a[132:135], a[108:111], v[136:139]
v_lshlrev_b32 v247, 16, v243
v_fmac_f32 v255, v22, v30
v_mfma_f32_16x16x32_bf16 v[144:147], a[128:131], a[112:115], v[144:147]
ds_read_b128 a[28:31], v3 offset:6144
v_fmac_f32 v255, v23, v29
v_mfma_f32_16x16x32_bf16 v[144:147], a[132:135], a[116:119], v[144:147]
buffer_load_dwordx4 v15, s[8:11], s25 offen offset:3072 lds
v_fmac_f32 v255, v24, v28
v_mfma_f32_16x16x32_bf16 v[152:155], a[128:131], a[120:123], v[152:155]
s_add_u32 s25, s25, 128
v_mul_f32 v255, v255, v247
v_cvt_pk_bf16_f32 v246, v254, v255
v_mfma_f32_16x16x32_bf16 v[152:155], a[132:135], a[124:127], v[152:155]
s_waitcnt lgkmcnt(2)
v_accvgpr_write_b32 a183, v246
v_mul_f32 v254, v22, v253
v_mfma_f32_16x16x32_bf16 v[100:103], a[136:139], a[64:67], v[100:103]
ds_read_b64_tr_b16 a[128:129], v8 offset:32768
v_lshlrev_b32 v25, 16, v235
v_mfma_f32_16x16x32_bf16 v[100:103], a[140:143], a[68:71], v[100:103]
buffer_load_dword v21, v20, s[16:19], s43 offen
v_mfma_f32_16x16x32_bf16 v[108:111], a[136:139], a[72:75], v[108:111]
s_add_u32 s43, s43, s47
ds_read_b64_tr_b16 a[130:131], v8 offset:34816
v_lshlrev_b32 v247, 16, v244
v_mfma_f32_16x16x32_bf16 v[108:111], a[140:143], a[76:79], v[108:111]
s_cmp_ge_u32 s43, s51
v_fmac_f32 v254, v23, v30
v_fmac_f32 v254, v24, v29
v_mfma_f32_16x16x32_bf16 v[116:119], a[136:139], a[80:83], v[116:119]
s_cselect_b32 s43, 0, s43
ds_read_b64_tr_b16 a[132:133], v8 offset:49152
v_fmac_f32 v254, v25, v28
v_mul_f32 v254, v254, v247
v_mfma_f32_16x16x32_bf16 v[116:119], a[140:143], a[84:87], v[116:119]
s_cselect_b32 s51, s42, s51
v_cvt_pk_bf16_f32 v246, v255, v254
v_accvgpr_write_b32 a179, v246
v_mfma_f32_16x16x32_bf16 v[124:127], a[136:139], a[88:91], v[124:127]
s_cselect_b64 s[16:17], s[40:41], s[16:17]
ds_read_b64_tr_b16 a[134:135], v8 offset:51200
v_lshlrev_b32 v28, 16, v250
v_mfma_f32_16x16x32_bf16 v[124:127], a[140:143], a[92:95], v[124:127]
s_cselect_b32 s18, s42, s18
v_and_b32 v29, s58, v250
v_lshlrev_b32 v30, 16, v251
v_mfma_f32_16x16x32_bf16 v[132:135], a[136:139], a[96:99], v[132:135]
s_cselect_b64 s[40:41], s[44:45], s[40:41]
ds_read_b128 a[32:35], v2 offset:8192
v_and_b32 v253, s58, v251
v_mfma_f32_16x16x32_bf16 v[132:135], a[140:143], a[100:103], v[132:135]
s_cselect_b32 s42, s46, s42
v_and_b32 v22, s58, v224
v_and_b32 v23, s58, v225
v_mfma_f32_16x16x32_bf16 v[140:143], a[136:139], a[104:107], v[140:143]
s_cselect_b32 s46, 0, s46
v_and_b32 v24, s58, v226
v_mul_f32 v254, v22, v253
v_mfma_f32_16x16x32_bf16 v[140:143], a[140:143], a[108:111], v[140:143]
buffer_load_dword v245, off, s[60:63], s54 sc1
v_mfma_f32_16x16x32_bf16 v[148:151], a[136:139], a[112:115], v[148:151]
ds_read_b128 a[36:39], v3 offset:8192
v_and_b32 v25, s58, v227
v_and_b32 v247, s58, v236
v_mfma_f32_16x16x32_bf16 v[148:151], a[140:143], a[116:119], v[148:151]
v_fmac_f32 v254, v23, v30
v_fmac_f32 v254, v24, v29
v_mfma_f32_16x16x32_bf16 v[156:159], a[136:139], a[120:123], v[156:159]
ds_read_b128 a[40:43], v2 offset:10240
v_fmac_f32 v254, v25, v28
v_mfma_f32_16x16x32_bf16 v[156:159], a[140:143], a[124:127], v[156:159]
s_waitcnt lgkmcnt(3)
v_mul_f32 v254, v254, v247
v_mul_f32 v255, v23, v253
v_mfma_f32_16x16x32_bf16 v[160:163], a[128:131], a[64:67], v[160:163]
ds_read_b64_tr_b16 a[136:137], v9 offset:32768
v_and_b32 v22, s58, v228
v_mfma_f32_16x16x32_bf16 v[160:163], a[132:135], a[68:71], v[160:163]
v_and_b32 v247, s58, v237
v_fmac_f32 v255, v24, v30
v_mfma_f32_16x16x32_bf16 v[168:171], a[128:131], a[72:75], v[168:171]
ds_read_b64_tr_b16 a[138:139], v9 offset:34816
v_fmac_f32 v255, v25, v29
v_mfma_f32_16x16x32_bf16 v[168:171], a[132:135], a[76:79], v[168:171]
v_fmac_f32 v255, v22, v28
v_mul_f32 v255, v255, v247
v_mfma_f32_16x16x32_bf16 v[176:179], a[128:131], a[80:83], v[176:179]
ds_read_b64_tr_b16 a[140:141], v9 offset:49152
v_cvt_pk_bf16_f32 v246, v254, v255
v_accvgpr_write_b32 a188, v246
v_mfma_f32_16x16x32_bf16 v[176:179], a[132:135], a[84:87], v[176:179]
v_mul_f32 v254, v24, v253
v_and_b32 v23, s58, v229
v_mfma_f32_16x16x32_bf16 v[184:187], a[128:131], a[88:91], v[184:187]
ds_read_b64_tr_b16 a[142:143], v9 offset:51200
v_and_b32 v247, s58, v238
v_mfma_f32_16x16x32_bf16 v[184:187], a[132:135], a[92:95], v[184:187]
v_fmac_f32 v254, v25, v30
v_fmac_f32 v254, v22, v29
v_mfma_f32_16x16x32_bf16 v[192:195], a[128:131], a[96:99], v[192:195]
v_fmac_f32 v254, v23, v28
v_mul_f32 v254, v254, v247
v_mfma_f32_16x16x32_bf16 v[192:195], a[132:135], a[100:103], v[192:195]
v_cvt_pk_bf16_f32 v246, v255, v254
v_accvgpr_write_b32 a184, v246
v_mfma_f32_16x16x32_bf16 v[200:203], a[128:131], a[104:107], v[200:203]
ds_read_b128 a[44:47], v3 offset:10240
v_mul_f32 v255, v25, v253
v_mfma_f32_16x16x32_bf16 v[200:203], a[132:135], a[108:111], v[200:203]
v_and_b32 v24, s58, v230
v_and_b32 v247, s58, v239
v_fmac_f32 v255, v22, v30
v_mfma_f32_16x16x32_bf16 v[208:211], a[128:131], a[112:115], v[208:211]
ds_read_b128 a[48:51], v2 offset:12288
v_fmac_f32 v255, v23, v29
v_mfma_f32_16x16x32_bf16 v[208:211], a[132:135], a[116:119], v[208:211]
v_fmac_f32 v255, v24, v28
v_mul_f32 v255, v255, v247
v_mfma_f32_16x16x32_bf16 v[216:219], a[128:131], a[120:123], v[216:219]
v_cvt_pk_bf16_f32 v246, v254, v255
v_accvgpr_write_b32 a189, v246
v_mfma_f32_16x16x32_bf16 v[216:219], a[132:135], a[124:127], v[216:219]
s_waitcnt lgkmcnt(2)
v_mul_f32 v254, v22, v253
v_and_b32 v25, s58, v231
v_mfma_f32_16x16x32_bf16 v[164:167], a[136:139], a[64:67], v[164:167]
ds_read_b64_tr_b16 a[128:129], v10 offset:32768
v_and_b32 v247, s58, v240
v_mfma_f32_16x16x32_bf16 v[164:167], a[140:143], a[68:71], v[164:167]
v_fmac_f32 v254, v23, v30
v_fmac_f32 v254, v24, v29
v_mfma_f32_16x16x32_bf16 v[172:175], a[136:139], a[72:75], v[172:175]
ds_read_b64_tr_b16 a[130:131], v10 offset:34816
v_fmac_f32 v254, v25, v28
v_mfma_f32_16x16x32_bf16 v[172:175], a[140:143], a[76:79], v[172:175]
v_mul_f32 v254, v254, v247
v_cvt_pk_bf16_f32 v246, v255, v254
v_accvgpr_write_b32 a185, v246
v_mfma_f32_16x16x32_bf16 v[180:183], a[136:139], a[80:83], v[180:183]
s_lshr_b32 s22, s3, 1
ds_read_b64_tr_b16 a[132:133], v10 offset:49152
v_mul_f32 v255, v23, v253
v_mfma_f32_16x16x32_bf16 v[180:183], a[140:143], a[84:87], v[180:183]
s_mul_i32 s22, s22, 2097152
v_and_b32 v22, s58, v232
v_and_b32 v247, s58, v241
v_mfma_f32_16x16x32_bf16 v[188:191], a[136:139], a[88:91], v[188:191]
s_and_b32 s23, s3, 1
ds_read_b64_tr_b16 a[134:135], v10 offset:51200
v_fmac_f32 v255, v24, v30
v_mfma_f32_16x16x32_bf16 v[188:191], a[140:143], a[92:95], v[188:191]
s_lshl_b32 s23, s23, 5
v_fmac_f32 v255, v25, v29
v_fmac_f32 v255, v22, v28
v_mfma_f32_16x16x32_bf16 v[196:199], a[136:139], a[96:99], v[196:199]
s_lshl_b32 s56, s39, 6
ds_read_b128 a[52:55], v3 offset:12288
v_mul_f32 v255, v255, v247
v_mfma_f32_16x16x32_bf16 v[196:199], a[140:143], a[100:103], v[196:199]
s_add_u32 s23, s23, s56
v_cvt_pk_bf16_f32 v246, v254, v255
v_accvgpr_write_b32 a190, v246
v_mfma_f32_16x16x32_bf16 v[204:207], a[136:139], a[104:107], v[204:207]
s_mul_i32 s23, s23, 4224
ds_read_b128 a[56:59], v2 offset:14336
v_mul_f32 v254, v24, v253
v_and_b32 v23, s58, v233
v_mfma_f32_16x16x32_bf16 v[204:207], a[140:143], a[108:111], v[204:207]
s_add_u32 s22, s22, s23
v_and_b32 v247, s58, v242
v_fmac_f32 v254, v25, v30
v_mfma_f32_16x16x32_bf16 v[212:215], a[136:139], a[112:115], v[212:215]
s_add_u32 s57, s22, 83886200
v_fmac_f32 v254, v22, v29
v_fmac_f32 v254, v23, v28
v_mfma_f32_16x16x32_bf16 v[212:215], a[140:143], a[116:119], v[212:215]
s_lshl_b32 s23, s38, 7
v_mul_f32 v254, v254, v247
v_cvt_pk_bf16_f32 v246, v255, v254
v_mfma_f32_16x16x32_bf16 v[220:223], a[136:139], a[120:123], v[220:223]
s_add_u32 s22, s22, s23
ds_read_b128 a[60:63], v3 offset:14336
v_accvgpr_write_b32 a186, v246
v_mfma_f32_16x16x32_bf16 v[220:223], a[140:143], a[124:127], v[220:223]
s_waitcnt lgkmcnt(3)
s_add_u32 s56, s22, 83886208
v_mul_f32 v255, v25, v253
v_and_b32 v24, s58, v234
v_mfma_f32_16x16x32_bf16 a[192:195], a[128:131], a[64:67], a[192:195]
s_cmp_lt_u32 s2, 224
ds_read_b64_tr_b16 a[136:137], v11 offset:32768
v_and_b32 v247, s58, v243
v_mfma_f32_16x16x32_bf16 a[192:195], a[132:135], a[68:71], a[192:195]
s_cselect_b32 s56, s56, 3221225472
v_fmac_f32 v255, v22, v30
v_fmac_f32 v255, v23, v29
v_mfma_f32_16x16x32_bf16 a[200:203], a[128:131], a[72:75], a[200:203]
s_cmp_eq_u32 s38, 0
ds_read_b64_tr_b16 a[138:139], v11 offset:34816
v_fmac_f32 v255, v24, v28
v_mul_f32 v255, v255, v247
v_mfma_f32_16x16x32_bf16 a[200:203], a[132:135], a[76:79], a[200:203]
s_cselect_b32 s57, s57, 3221225472
v_cvt_pk_bf16_f32 v246, v254, v255
v_accvgpr_write_b32 a191, v246
v_mfma_f32_16x16x32_bf16 a[208:211], a[128:131], a[80:83], a[208:211]
ds_read_b64_tr_b16 a[140:141], v11 offset:49152
v_mul_f32 v254, v22, v253
v_mfma_f32_16x16x32_bf16 a[208:211], a[132:135], a[84:87], a[208:211]
v_and_b32 v25, s58, v235
v_and_b32 v247, s58, v244
v_mfma_f32_16x16x32_bf16 a[216:219], a[128:131], a[88:91], a[216:219]
ds_read_b64_tr_b16 a[142:143], v11 offset:51200
v_fmac_f32 v254, v23, v30
v_mfma_f32_16x16x32_bf16 a[216:219], a[132:135], a[92:95], a[216:219]
ds_write_b128 v252, a[176:179] offset:0
v_fmac_f32 v254, v24, v29
v_mfma_f32_16x16x32_bf16 a[224:227], a[128:131], a[96:99], a[224:227]
v_fmac_f32 v254, v25, v28
v_mul_f32 v254, v254, v247
v_mfma_f32_16x16x32_bf16 a[224:227], a[132:135], a[100:103], a[224:227]
ds_write_b128 v252, a[180:183] offset:8192
v_cvt_pk_bf16_f32 v246, v255, v254
v_accvgpr_write_b32 a187, v246
v_mfma_f32_16x16x32_bf16 a[232:235], a[128:131], a[104:107], a[232:235]
v_mfma_f32_16x16x32_bf16 a[232:235], a[132:135], a[108:111], a[232:235]
ds_write_b128 v252, a[184:187] offset:128
v_mfma_f32_16x16x32_bf16 a[240:243], a[128:131], a[112:115], a[240:243]
v_mfma_f32_16x16x32_bf16 a[240:243], a[132:135], a[116:119], a[240:243]
ds_write_b128 v252, a[188:191] offset:8320
v_mfma_f32_16x16x32_bf16 a[248:251], a[128:131], a[120:123], a[248:251]
s_waitcnt vmcnt(2) lgkmcnt(0)
v_mfma_f32_16x16x32_bf16 a[248:251], a[132:135], a[124:127], a[248:251]
s_barrier
v_mfma_f32_16x16x32_bf16 a[196:199], a[136:139], a[64:67], a[196:199]
s_add_u32 m0, s29, 98304
ds_read_b64_tr_b16 a[128:129], v4 offset:0
v_lshrrev_b32 v22, 8, v1
v_mfma_f32_16x16x32_bf16 a[196:199], a[140:143], a[68:71], a[196:199]
buffer_load_dwordx4 v16, s[12:15], s26 offen offset:0 lds
v_mfma_f32_16x16x32_bf16 a[204:207], a[136:139], a[72:75], a[204:207]
ds_read_b64_tr_b16 a[130:131], v4 offset:2048
v_lshlrev_b32 v22, 4, v22
v_mfma_f32_16x16x32_bf16 a[204:207], a[140:143], a[76:79], a[204:207]
v_xor_b32 v22, v22, v1
v_add_u32 v22, s29, v22
v_mfma_f32_16x16x32_bf16 a[212:215], a[136:139], a[80:83], a[212:215]
ds_read_b64_tr_b16 a[132:133], v4 offset:16384
v_add_u32 v22, 147456, v22
v_mfma_f32_16x16x32_bf16 a[212:215], a[140:143], a[84:87], a[212:215]
buffer_load_dwordx4 v17, s[12:15], s26 offen offset:1024 lds
v_mfma_f32_16x16x32_bf16 a[220:223], a[136:139], a[88:91], a[220:223]
ds_read_b64_tr_b16 a[134:135], v4 offset:18432
v_xor_b32 v23, 64, v22
v_mfma_f32_16x16x32_bf16 a[220:223], a[140:143], a[92:95], a[220:223]
v_lshrrev_b32 v224, 7, v1
v_mul_u32_u24 v224, 4224, v224
v_mfma_f32_16x16x32_bf16 a[228:231], a[136:139], a[96:99], a[228:231]
v_and_b32 v225, 0x70, v1
v_add_u32 v224, v224, v225
v_mfma_f32_16x16x32_bf16 a[228:231], a[140:143], a[100:103], a[228:231]
buffer_load_dwordx4 v18, s[12:15], s26 offen offset:2048 lds
v_mfma_f32_16x16x32_bf16 a[236:239], a[136:139], a[104:107], a[236:239]
v_bfe_u32 v225, v1, 4, 5
v_mul_u32_u24 v225, 4224, v225
v_mfma_f32_16x16x32_bf16 a[236:239], a[140:143], a[108:111], a[236:239]
v_mov_b32 v226, 0
v_mov_b32 v227, 0
v_mfma_f32_16x16x32_bf16 a[244:247], a[136:139], a[112:115], a[244:247]
v_mfma_f32_16x16x32_bf16 a[244:247], a[140:143], a[116:119], a[244:247]
buffer_load_dwordx4 v19, s[12:15], s26 offen offset:3072 lds
v_mfma_f32_16x16x32_bf16 a[252:255], a[136:139], a[120:123], a[252:255]
s_add_u32 s26, s26, 524288
v_mfma_f32_16x16x32_bf16 a[252:255], a[140:143], a[124:127], a[252:255]
s_waitcnt lgkmcnt(0)
v_mfma_f32_16x16x32_bf16 v[32:35], a[128:131], a[0:3], v[32:35]
s_add_u32 m0, s29, 114688
ds_read_b64_tr_b16 a[136:137], v5 offset:0
v_mfma_f32_16x16x32_bf16 v[32:35], a[132:135], a[4:7], v[32:35]
buffer_load_dwordx4 v16, s[12:15], s27 offen offset:0 lds
v_mfma_f32_16x16x32_bf16 v[40:43], a[128:131], a[8:11], v[40:43]
s_mul_i32 s52, s20, 7
ds_read_b64_tr_b16 a[138:139], v5 offset:2048
v_mfma_f32_16x16x32_bf16 v[40:43], a[132:135], a[12:15], v[40:43]
s_add_u32 s52, s52, s21
buffer_store_dwordx2 v[226:227], v225, s[4:7], s57 offen sc1
v_mfma_f32_16x16x32_bf16 v[48:51], a[128:131], a[16:19], v[48:51]
s_lshl_b32 s53, s52, 2
ds_read_b64_tr_b16 a[140:141], v5 offset:16384
v_mfma_f32_16x16x32_bf16 v[48:51], a[132:135], a[20:23], v[48:51]
s_add_u32 s53, s53, s3
buffer_load_dwordx4 v17, s[12:15], s27 offen offset:1024 lds
v_mfma_f32_16x16x32_bf16 v[56:59], a[128:131], a[24:27], v[56:59]
s_lshl_b32 s49, s53, 12
ds_read_b64_tr_b16 a[142:143], v5 offset:18432
v_mfma_f32_16x16x32_bf16 v[56:59], a[132:135], a[28:31], v[56:59]
s_mul_i32 s53, s53, 4224
v_mfma_f32_16x16x32_bf16 v[64:67], a[128:131], a[32:35], v[64:67]
s_add_u32 s53, s53, 83886080
ds_read_b128 a[64:67], v2 offset:32768
v_mfma_f32_16x16x32_bf16 v[64:67], a[132:135], a[36:39], v[64:67]
s_lshr_b32 s52, s52, 4
buffer_load_dwordx4 v18, s[12:15], s27 offen offset:2048 lds
v_mfma_f32_16x16x32_bf16 v[72:75], a[128:131], a[40:43], v[72:75]
s_min_u32 s52, s52, 6
ds_read_b128 a[68:71], v3 offset:32768
v_mfma_f32_16x16x32_bf16 v[72:75], a[132:135], a[44:47], v[72:75]
s_lshl_b32 s52, s52, 7
ds_read_b128 a[176:179], v22 offset:0
v_mfma_f32_16x16x32_bf16 v[80:83], a[128:131], a[48:51], v[80:83]
s_add_u32 s52, s52, 94392320
ds_read_b128 a[180:183], v23 offset:1024
v_mfma_f32_16x16x32_bf16 v[80:83], a[132:135], a[52:55], v[80:83]
buffer_load_dwordx4 v19, s[12:15], s27 offen offset:3072 lds
v_mfma_f32_16x16x32_bf16 v[88:91], a[128:131], a[56:59], v[88:91]
s_add_u32 s27, s27, 524288
ds_read_b128 a[72:75], v2 offset:34816
v_mfma_f32_16x16x32_bf16 v[88:91], a[132:135], a[60:63], v[88:91]
s_waitcnt lgkmcnt(5)
ds_read_b128 a[184:187], v22 offset:2048
v_mfma_f32_16x16x32_bf16 v[36:39], a[136:139], a[0:3], v[36:39]
s_add_u32 m0, s28, 0
ds_read_b64_tr_b16 a[128:129], v6 offset:0
v_mfma_f32_16x16x32_bf16 v[36:39], a[140:143], a[4:7], v[36:39]
buffer_load_dwordx4 v12, s[8:11], s24 offen offset:0 lds
v_mfma_f32_16x16x32_bf16 v[44:47], a[136:139], a[8:11], v[44:47]
ds_read_b64_tr_b16 a[130:131], v6 offset:2048
v_mfma_f32_16x16x32_bf16 v[44:47], a[140:143], a[12:15], v[44:47]
PAD_3:
s_cbranch_execz M_tret
ds_read_b128 a[188:191], v23 offset:3072
v_mfma_f32_16x16x32_bf16 v[52:55], a[136:139], a[16:19], v[52:55]
ds_read_b64_tr_b16 a[132:133], v6 offset:16384
v_bfe_u32 v231, v1, 4, 5
v_mfma_f32_16x16x32_bf16 v[52:55], a[140:143], a[20:23], v[52:55]
buffer_load_dwordx4 v13, s[8:11], s24 offen offset:1024 lds
v_mfma_f32_16x16x32_bf16 v[60:63], a[136:139], a[24:27], v[60:63]
ds_read_b64_tr_b16 a[134:135], v6 offset:18432
v_lshlrev_b32 v231, 2, v231
v_mfma_f32_16x16x32_bf16 v[60:63], a[140:143], a[28:31], v[60:63]
v_lshlrev_b32 v229, 3, v1
v_min_u32 v229, 4096, v229
v_mfma_f32_16x16x32_bf16 v[68:71], a[136:139], a[32:35], v[68:71]
ds_read_b128 a[76:79], v3 offset:34816
v_mfma_f32_16x16x32_bf16 v[68:71], a[140:143], a[36:39], v[68:71]
buffer_load_dwordx4 v14, s[8:11], s24 offen offset:2048 lds
v_mfma_f32_16x16x32_bf16 v[76:79], a[136:139], a[40:43], v[76:79]
v_mfma_f32_16x16x32_bf16 v[76:79], a[140:143], a[44:47], v[76:79]
v_mfma_f32_16x16x32_bf16 v[84:87], a[136:139], a[48:51], v[84:87]
ds_read_b128 a[80:83], v2 offset:36864
v_mfma_f32_16x16x32_bf16 v[84:87], a[140:143], a[52:55], v[84:87]
buffer_load_dwordx4 v15, s[8:11], s24 offen offset:3072 lds
v_mfma_f32_16x16x32_bf16 v[92:95], a[136:139], a[56:59], v[92:95]
s_add_u32 s24, s24, 128
ds_read_b128 a[84:87], v3 offset:36864
v_mfma_f32_16x16x32_bf16 v[92:95], a[140:143], a[60:63], v[92:95]
s_waitcnt lgkmcnt(3)
v_mfma_f32_16x16x32_bf16 v[96:99], a[128:131], a[0:3], v[96:99]
s_add_u32 m0, s28, 4096
ds_read_b64_tr_b16 a[136:137], v7 offset:0
v_mfma_f32_16x16x32_bf16 v[96:99], a[132:135], a[4:7], v[96:99]
buffer_load_dwordx4 v12, s[8:11], s25 offen offset:0 lds
v_mfma_f32_16x16x32_bf16 v[104:107], a[128:131], a[8:11], v[104:107]
ds_read_b64_tr_b16 a[138:139], v7 offset:2048
v_mfma_f32_16x16x32_bf16 v[104:107], a[132:135], a[12:15], v[104:107]
v_mfma_f32_16x16x32_bf16 v[112:115], a[128:131], a[16:19], v[112:115]
ds_read_b64_tr_b16 a[140:141], v7 offset:16384
v_mfma_f32_16x16x32_bf16 v[112:115], a[132:135], a[20:23], v[112:115]
buffer_load_dwordx4 v13, s[8:11], s25 offen offset:1024 lds
v_mfma_f32_16x16x32_bf16 v[120:123], a[128:131], a[24:27], v[120:123]
ds_read_b64_tr_b16 a[142:143], v7 offset:18432
v_mfma_f32_16x16x32_bf16 v[120:123], a[132:135], a[28:31], v[120:123]
v_mfma_f32_16x16x32_bf16 v[128:131], a[128:131], a[32:35], v[128:131]
v_mfma_f32_16x16x32_bf16 v[128:131], a[132:135], a[36:39], v[128:131]
buffer_load_dwordx4 v14, s[8:11], s25 offen offset:2048 lds
v_mfma_f32_16x16x32_bf16 v[136:139], a[128:131], a[40:43], v[136:139]
ds_read_b128 a[88:91], v2 offset:38912
v_mfma_f32_16x16x32_bf16 v[136:139], a[132:135], a[44:47], v[136:139]
v_mfma_f32_16x16x32_bf16 v[144:147], a[128:131], a[48:51], v[144:147]
ds_read_b128 a[92:95], v3 offset:38912
v_mfma_f32_16x16x32_bf16 v[144:147], a[132:135], a[52:55], v[144:147]
buffer_load_dwordx4 v15, s[8:11], s25 offen offset:3072 lds
v_mfma_f32_16x16x32_bf16 v[152:155], a[128:131], a[56:59], v[152:155]
s_add_u32 s25, s25, 128
v_mfma_f32_16x16x32_bf16 v[152:155], a[132:135], a[60:63], v[152:155]
s_waitcnt lgkmcnt(2)
v_mfma_f32_16x16x32_bf16 v[100:103], a[136:139], a[0:3], v[100:103]
ds_read_b64_tr_b16 a[128:129], v8 offset:0
v_mfma_f32_16x16x32_bf16 v[100:103], a[140:143], a[4:7], v[100:103]
buffer_store_dwordx4 a[176:179], v224, s[4:7], s56 offen sc1
v_mfma_f32_16x16x32_bf16 v[108:111], a[136:139], a[8:11], v[108:111]
s_add_u32 s56, s56, 33792
ds_read_b64_tr_b16 a[130:131], v8 offset:2048
v_mfma_f32_16x16x32_bf16 v[108:111], a[140:143], a[12:15], v[108:111]
v_mfma_f32_16x16x32_bf16 v[116:119], a[136:139], a[16:19], v[116:119]
ds_read_b64_tr_b16 a[132:133], v8 offset:16384
v_mfma_f32_16x16x32_bf16 v[116:119], a[140:143], a[20:23], v[116:119]
v_mfma_f32_16x16x32_bf16 v[124:127], a[136:139], a[24:27], v[124:127]
s_cmp_lt_u32 s21, 0
ds_read_b64_tr_b16 a[134:135], v8 offset:18432
v_mfma_f32_16x16x32_bf16 v[124:127], a[140:143], a[28:31], v[124:127]
s_cselect_b32 s53, s53, 3221225472
v_mfma_f32_16x16x32_bf16 v[132:135], a[136:139], a[32:35], v[132:135]
s_cselect_b32 s49, s49, 3221225472
ds_read_b128 a[96:99], v2 offset:40960
v_mfma_f32_16x16x32_bf16 v[132:135], a[140:143], a[36:39], v[132:135]
s_add_u32 s48, s53, 2097152
v_mfma_f32_16x16x32_bf16 v[140:143], a[136:139], a[40:43], v[140:143]
v_mfma_f32_16x16x32_bf16 v[140:143], a[140:143], a[44:47], v[140:143]
v_mfma_f32_16x16x32_bf16 v[148:151], a[136:139], a[48:51], v[148:151]
ds_read_b128 a[100:103], v3 offset:40960
v_mfma_f32_16x16x32_bf16 v[148:151], a[140:143], a[52:55], v[148:151]
v_mfma_f32_16x16x32_bf16 v[156:159], a[136:139], a[56:59], v[156:159]
ds_read_b128 a[104:107], v2 offset:43008
v_mfma_f32_16x16x32_bf16 v[156:159], a[140:143], a[60:63], v[156:159]
s_waitcnt lgkmcnt(3)
v_mfma_f32_16x16x32_bf16 v[160:163], a[128:131], a[0:3], v[160:163]
ds_read_b64_tr_b16 a[136:137], v9 offset:0
v_mfma_f32_16x16x32_bf16 v[160:163], a[132:135], a[4:7], v[160:163]
v_mfma_f32_16x16x32_bf16 v[168:171], a[128:131], a[8:11], v[168:171]
ds_read_b64_tr_b16 a[138:139], v9 offset:2048
v_mfma_f32_16x16x32_bf16 v[168:171], a[132:135], a[12:15], v[168:171]
buffer_store_dwordx4 a[180:183], v224, s[4:7], s56 offen sc1
v_mfma_f32_16x16x32_bf16 v[176:179], a[128:131], a[16:19], v[176:179]
s_add_u32 s56, s56, 33792
ds_read_b64_tr_b16 a[140:141], v9 offset:16384
v_mfma_f32_16x16x32_bf16 v[176:179], a[132:135], a[20:23], v[176:179]
v_mfma_f32_16x16x32_bf16 v[184:187], a[128:131], a[24:27], v[184:187]
ds_read_b64_tr_b16 a[142:143], v9 offset:18432
v_mfma_f32_16x16x32_bf16 v[184:187], a[132:135], a[28:31], v[184:187]
v_mfma_f32_16x16x32_bf16 v[192:195], a[128:131], a[32:35], v[192:195]
v_mfma_f32_16x16x32_bf16 v[192:195], a[132:135], a[36:39], v[192:195]
v_mfma_f32_16x16x32_bf16 v[200:203], a[128:131], a[40:43], v[200:203]
ds_read_b128 a[108:111], v3 offset:43008
v_mfma_f32_16x16x32_bf16 v[200:203], a[132:135], a[44:47], v[200:203]
v_mfma_f32_16x16x32_bf16 v[208:211], a[128:131], a[48:51], v[208:211]
ds_read_b128 a[112:115], v2 offset:45056
v_mfma_f32_16x16x32_bf16 v[208:211], a[132:135], a[52:55], v[208:211]
v_mfma_f32_16x16x32_bf16 v[216:219], a[128:131], a[56:59], v[216:219]
v_mfma_f32_16x16x32_bf16 v[216:219], a[132:135], a[60:63], v[216:219]
s_waitcnt lgkmcnt(2)
v_mfma_f32_16x16x32_bf16 v[164:167], a[136:139], a[0:3], v[164:167]
ds_read_b64_tr_b16 a[128:129], v10 offset:0
v_mfma_f32_16x16x32_bf16 v[164:167], a[140:143], a[4:7], v[164:167]
v_mfma_f32_16x16x32_bf16 v[172:175], a[136:139], a[8:11], v[172:175]
ds_read_b64_tr_b16 a[130:131], v10 offset:2048
v_mfma_f32_16x16x32_bf16 v[172:175], a[140:143], a[12:15], v[172:175]
v_mfma_f32_16x16x32_bf16 v[180:183], a[136:139], a[16:19], v[180:183]
ds_read_b64_tr_b16 a[132:133], v10 offset:16384
v_mfma_f32_16x16x32_bf16 v[180:183], a[140:143], a[20:23], v[180:183]
buffer_store_dwordx4 a[184:187], v224, s[4:7], s56 offen sc1
v_mfma_f32_16x16x32_bf16 v[188:191], a[136:139], a[24:27], v[188:191]
s_add_u32 s56, s56, 33792
ds_read_b64_tr_b16 a[134:135], v10 offset:18432
v_mfma_f32_16x16x32_bf16 v[188:191], a[140:143], a[28:31], v[188:191]
v_mfma_f32_16x16x32_bf16 v[196:199], a[136:139], a[32:35], v[196:199]
ds_read_b128 a[116:119], v3 offset:45056
v_mfma_f32_16x16x32_bf16 v[196:199], a[140:143], a[36:39], v[196:199]
v_mfma_f32_16x16x32_bf16 v[204:207], a[136:139], a[40:43], v[204:207]
ds_read_b128 a[120:123], v2 offset:47104
v_mfma_f32_16x16x32_bf16 v[204:207], a[140:143], a[44:47], v[204:207]
v_mfma_f32_16x16x32_bf16 v[212:215], a[136:139], a[48:51], v[212:215]
v_mfma_f32_16x16x32_bf16 v[212:215], a[140:143], a[52:55], v[212:215]
v_mfma_f32_16x16x32_bf16 v[220:223], a[136:139], a[56:59], v[220:223]
ds_read_b128 a[124:127], v3 offset:47104
v_mfma_f32_16x16x32_bf16 v[220:223], a[140:143], a[60:63], v[220:223]
s_waitcnt lgkmcnt(3)
v_mfma_f32_16x16x32_bf16 a[192:195], a[128:131], a[0:3], a[192:195]
ds_read_b64_tr_b16 a[136:137], v11 offset:0
v_mfma_f32_16x16x32_bf16 a[192:195], a[132:135], a[4:7], a[192:195]
v_mfma_f32_16x16x32_bf16 a[200:203], a[128:131], a[8:11], a[200:203]
ds_read_b64_tr_b16 a[138:139], v11 offset:2048
v_mfma_f32_16x16x32_bf16 a[200:203], a[132:135], a[12:15], a[200:203]
v_mfma_f32_16x16x32_bf16 a[208:211], a[128:131], a[16:19], a[208:211]
ds_read_b64_tr_b16 a[140:141], v11 offset:16384
v_mfma_f32_16x16x32_bf16 a[208:211], a[132:135], a[20:23], a[208:211]
v_mfma_f32_16x16x32_bf16 a[216:219], a[128:131], a[24:27], a[216:219]
ds_read_b64_tr_b16 a[142:143], v11 offset:18432
v_mfma_f32_16x16x32_bf16 a[216:219], a[132:135], a[28:31], a[216:219]
buffer_store_dwordx4 a[188:191], v224, s[4:7], s56 offen sc1
v_mfma_f32_16x16x32_bf16 a[224:227], a[128:131], a[32:35], a[224:227]
s_add_u32 s56, s56, 33792
v_mfma_f32_16x16x32_bf16 a[224:227], a[132:135], a[36:39], a[224:227]
v_mfma_f32_16x16x32_bf16 a[232:235], a[128:131], a[40:43], a[232:235]
v_mfma_f32_16x16x32_bf16 a[232:235], a[132:135], a[44:47], a[232:235]
v_mfma_f32_16x16x32_bf16 a[240:243], a[128:131], a[48:51], a[240:243]
v_mfma_f32_16x16x32_bf16 a[240:243], a[132:135], a[52:55], a[240:243]
v_mfma_f32_16x16x32_bf16 a[248:251], a[128:131], a[56:59], a[248:251]
s_waitcnt vmcnt(4) lgkmcnt(0)
v_mfma_f32_16x16x32_bf16 a[248:251], a[132:135], a[60:63], a[248:251]
s_barrier
v_mfma_f32_16x16x32_bf16 a[196:199], a[136:139], a[0:3], a[196:199]
s_add_u32 m0, s29, 65536
ds_read_b64_tr_b16 a[128:129], v4 offset:32768
v_mfma_f32_16x16x32_bf16 a[196:199], a[140:143], a[4:7], a[196:199]
buffer_load_dwordx4 v16, s[12:15], s26 offen offset:0 lds
v_mfma_f32_16x16x32_bf16 a[204:207], a[136:139], a[8:11], a[204:207]
ds_read_b64_tr_b16 a[130:131], v4 offset:34816
v_cmp_gt_u32 vcc, s50, v245
v_mfma_f32_16x16x32_bf16 a[204:207], a[140:143], a[12:15], a[204:207]
v_mfma_f32_16x16x32_bf16 a[212:215], a[136:139], a[16:19], a[212:215]
ds_read_b64_tr_b16 a[132:133], v4 offset:49152
v_mfma_f32_16x16x32_bf16 a[212:215], a[140:143], a[20:23], a[212:215]
buffer_load_dwordx4 v17, s[12:15], s26 offen offset:1024 lds
v_mfma_f32_16x16x32_bf16 a[220:223], a[136:139], a[24:27], a[220:223]
ds_read_b64_tr_b16 a[134:135], v4 offset:51200
v_mfma_f32_16x16x32_bf16 a[220:223], a[140:143], a[28:31], a[220:223]
v_mfma_f32_16x16x32_bf16 a[228:231], a[136:139], a[32:35], a[228:231]
v_mfma_f32_16x16x32_bf16 a[228:231], a[140:143], a[36:39], a[228:231]
buffer_load_dwordx4 v18, s[12:15], s26 offen offset:2048 lds
v_mfma_f32_16x16x32_bf16 a[236:239], a[136:139], a[40:43], a[236:239]
v_mfma_f32_16x16x32_bf16 a[236:239], a[140:143], a[44:47], a[236:239]
v_mfma_f32_16x16x32_bf16 a[244:247], a[136:139], a[48:51], a[244:247]
v_mfma_f32_16x16x32_bf16 a[244:247], a[140:143], a[52:55], a[244:247]
buffer_load_dwordx4 v19, s[12:15], s26 offen offset:3072 lds
v_mfma_f32_16x16x32_bf16 a[252:255], a[136:139], a[56:59], a[252:255]
s_add_u32 s26, s26, 524288
v_mfma_f32_16x16x32_bf16 a[252:255], a[140:143], a[60:63], a[252:255]
s_waitcnt lgkmcnt(0)
s_mov_b32 s82, s59
s_cbranch_vccnz M_cntspinK
s_branch Lg_1
PAD_4:
s_cbranch_execz M_tret
Lg_1t:
v_mfma_f32_16x16x32_bf16 v[32:35], a[128:131], a[64:67], v[32:35]
s_add_u32 m0, s29, 81920
ds_read_b64_tr_b16 a[136:137], v5 offset:32768
v_mfma_f32_16x16x32_bf16 v[32:35], a[132:135], a[68:71], v[32:35]
buffer_load_dwordx4 v16, s[12:15], s27 offen offset:0 lds
v_mfma_f32_16x16x32_bf16 v[40:43], a[128:131], a[72:75], v[40:43]
s_and_b32 s44, s3, 1
ds_read_b64_tr_b16 a[138:139], v5 offset:34816
v_mfma_f32_16x16x32_bf16 v[40:43], a[132:135], a[76:79], v[40:43]
s_lshl_b32 s44, s44, 8
v_mfma_f32_16x16x32_bf16 v[48:51], a[128:131], a[80:83], v[48:51]
s_lshl_b32 s45, s3, 7
ds_read_b64_tr_b16 a[140:141], v5 offset:49152
v_mfma_f32_16x16x32_bf16 v[48:51], a[132:135], a[84:87], v[48:51]
s_xor_b32 s44, s44, s45
buffer_load_dwordx4 v17, s[12:15], s27 offen offset:1024 lds
v_mfma_f32_16x16x32_bf16 v[56:59], a[128:131], a[88:91], v[56:59]
s_xor_b32 s44, s44, 196608
ds_read_b64_tr_b16 a[142:143], v5 offset:51200
v_mfma_f32_16x16x32_bf16 v[56:59], a[132:135], a[92:95], v[56:59]
v_mfma_f32_16x16x32_bf16 v[64:67], a[128:131], a[96:99], v[64:67]
ds_read_b128 a[0:3], v2 offset:0
v_mfma_f32_16x16x32_bf16 v[64:67], a[132:135], a[100:103], v[64:67]
buffer_load_dwordx4 v18, s[12:15], s27 offen offset:2048 lds
v_mfma_f32_16x16x32_bf16 v[72:75], a[128:131], a[104:107], v[72:75]
ds_read_b128 a[4:7], v3 offset:0
v_mfma_f32_16x16x32_bf16 v[72:75], a[132:135], a[108:111], v[72:75]
v_mfma_f32_16x16x32_bf16 v[80:83], a[128:131], a[112:115], v[80:83]
v_mfma_f32_16x16x32_bf16 v[80:83], a[132:135], a[116:119], v[80:83]
buffer_load_dwordx4 v19, s[12:15], s27 offen offset:3072 lds
v_mfma_f32_16x16x32_bf16 v[88:91], a[128:131], a[120:123], v[88:91]
s_add_u32 s27, s27, 524288
ds_read_b128 a[8:11], v2 offset:2048
v_mfma_f32_16x16x32_bf16 v[88:91], a[132:135], a[124:127], v[88:91]
s_waitcnt lgkmcnt(3)
v_mfma_f32_16x16x32_bf16 v[36:39], a[136:139], a[64:67], v[36:39]
s_add_u32 m0, s28, 32768
ds_read_b64_tr_b16 a[128:129], v6 offset:32768
v_mfma_f32_16x16x32_bf16 v[36:39], a[140:143], a[68:71], v[36:39]
buffer_load_dwordx4 v12, s[8:11], s24 offen offset:0 lds
v_mfma_f32_16x16x32_bf16 v[44:47], a[136:139], a[72:75], v[44:47]
ds_read_b64_tr_b16 a[130:131], v6 offset:34816
v_mfma_f32_16x16x32_bf16 v[44:47], a[140:143], a[76:79], v[44:47]
v_mfma_f32_16x16x32_bf16 v[52:55], a[136:139], a[80:83], v[52:55]
s_mov_b64 s[56:57], s[72:73]
ds_read_b64_tr_b16 a[132:133], v6 offset:49152
v_mfma_f32_16x16x32_bf16 v[52:55], a[140:143], a[84:87], v[52:55]
s_mov_b32 s58, 1835008
buffer_load_dwordx4 v13, s[8:11], s24 offen offset:1024 lds
v_mfma_f32_16x16x32_bf16 v[60:63], a[136:139], a[88:91], v[60:63]
s_mov_b32 s59, 0x20000
ds_read_b64_tr_b16 a[134:135], v6 offset:51200
v_mfma_f32_16x16x32_bf16 v[60:63], a[140:143], a[92:95], v[60:63]
v_mfma_f32_16x16x32_bf16 v[68:71], a[136:139], a[96:99], v[68:71]
ds_read_b128 a[12:15], v3 offset:2048
v_mfma_f32_16x16x32_bf16 v[68:71], a[140:143], a[100:103], v[68:71]
buffer_load_dwordx4 v14, s[8:11], s24 offen offset:2048 lds
v_mfma_f32_16x16x32_bf16 v[76:79], a[136:139], a[104:107], v[76:79]
v_mfma_f32_16x16x32_bf16 v[76:79], a[140:143], a[108:111], v[76:79]
v_mfma_f32_16x16x32_bf16 v[84:87], a[136:139], a[112:115], v[84:87]
ds_read_b128 a[16:19], v2 offset:4096
v_mfma_f32_16x16x32_bf16 v[84:87], a[140:143], a[116:119], v[84:87]
buffer_load_dwordx4 v15, s[8:11], s24 offen offset:3072 lds
v_mfma_f32_16x16x32_bf16 v[92:95], a[136:139], a[120:123], v[92:95]
s_add_u32 s24, s24, 128
ds_read_b128 a[20:23], v3 offset:4096
v_mfma_f32_16x16x32_bf16 v[92:95], a[140:143], a[124:127], v[92:95]
s_waitcnt lgkmcnt(3)
v_mfma_f32_16x16x32_bf16 v[96:99], a[128:131], a[64:67], v[96:99]
s_add_u32 m0, s28, 36864
ds_read_b64_tr_b16 a[136:137], v7 offset:32768
v_mfma_f32_16x16x32_bf16 v[96:99], a[132:135], a[68:71], v[96:99]
buffer_load_dwordx4 v12, s[8:11], s25 offen offset:0 lds
v_mfma_f32_16x16x32_bf16 v[104:107], a[128:131], a[72:75], v[104:107]
ds_read_b64_tr_b16 a[138:139], v7 offset:34816
v_mfma_f32_16x16x32_bf16 v[104:107], a[132:135], a[76:79], v[104:107]
v_mfma_f32_16x16x32_bf16 v[112:115], a[128:131], a[80:83], v[112:115]
ds_read_b64_tr_b16 a[140:141], v7 offset:49152
v_mfma_f32_16x16x32_bf16 v[112:115], a[132:135], a[84:87], v[112:115]
buffer_load_dwordx4 v13, s[8:11], s25 offen offset:1024 lds
v_mfma_f32_16x16x32_bf16 v[120:123], a[128:131], a[88:91], v[120:123]
ds_read_b64_tr_b16 a[142:143], v7 offset:51200
v_mfma_f32_16x16x32_bf16 v[120:123], a[132:135], a[92:95], v[120:123]
v_mfma_f32_16x16x32_bf16 v[128:131], a[128:131], a[96:99], v[128:131]
v_mfma_f32_16x16x32_bf16 v[128:131], a[132:135], a[100:103], v[128:131]
buffer_load_dwordx4 v14, s[8:11], s25 offen offset:2048 lds
v_mfma_f32_16x16x32_bf16 v[136:139], a[128:131], a[104:107], v[136:139]
ds_read_b128 a[24:27], v2 offset:6144
v_mfma_f32_16x16x32_bf16 v[136:139], a[132:135], a[108:111], v[136:139]
v_mfma_f32_16x16x32_bf16 v[144:147], a[128:131], a[112:115], v[144:147]
ds_read_b128 a[28:31], v3 offset:6144
v_mfma_f32_16x16x32_bf16 v[144:147], a[132:135], a[116:119], v[144:147]
buffer_load_dwordx4 v15, s[8:11], s25 offen offset:3072 lds
v_mfma_f32_16x16x32_bf16 v[152:155], a[128:131], a[120:123], v[152:155]
s_add_u32 s25, s25, 128
v_mfma_f32_16x16x32_bf16 v[152:155], a[132:135], a[124:127], v[152:155]
s_waitcnt lgkmcnt(2)
v_mfma_f32_16x16x32_bf16 v[100:103], a[136:139], a[64:67], v[100:103]
ds_read_b64_tr_b16 a[128:129], v8 offset:32768
v_mfma_f32_16x16x32_bf16 v[100:103], a[140:143], a[68:71], v[100:103]
buffer_load_dword v21, v20, s[16:19], s43 offen
v_mfma_f32_16x16x32_bf16 v[108:111], a[136:139], a[72:75], v[108:111]
s_mov_b64 s[8:9], s[76:77]
ds_read_b64_tr_b16 a[130:131], v8 offset:34816
v_mfma_f32_16x16x32_bf16 v[108:111], a[140:143], a[76:79], v[108:111]
s_mov_b32 s10, 1835008
buffer_load_dword v21, v20, s[16:19], s43 offen offset:256
v_mfma_f32_16x16x32_bf16 v[116:119], a[136:139], a[80:83], v[116:119]
s_lshl_b32 s24, s37, 2
ds_read_b64_tr_b16 a[132:133], v8 offset:49152
v_mfma_f32_16x16x32_bf16 v[116:119], a[140:143], a[84:87], v[116:119]
s_add_u32 s24, s24, s3
buffer_load_dword v21, v20, s[16:19], s43 offen offset:512
v_mfma_f32_16x16x32_bf16 v[124:127], a[136:139], a[88:91], v[124:127]
s_mul_i32 s24, s24, 28672
ds_read_b64_tr_b16 a[134:135], v8 offset:51200
v_mfma_f32_16x16x32_bf16 v[124:127], a[140:143], a[92:95], v[124:127]
s_mov_b32 s28, s29
buffer_load_dword v21, v20, s[16:19], s43 offen offset:768
v_mfma_f32_16x16x32_bf16 v[132:135], a[136:139], a[96:99], v[132:135]
ds_read_b128 a[32:35], v2 offset:8192
v_mfma_f32_16x16x32_bf16 v[132:135], a[140:143], a[100:103], v[132:135]
v_mfma_f32_16x16x32_bf16 v[140:143], a[136:139], a[104:107], v[140:143]
v_mfma_f32_16x16x32_bf16 v[140:143], a[140:143], a[108:111], v[140:143]
v_mfma_f32_16x16x32_bf16 v[148:151], a[136:139], a[112:115], v[148:151]
ds_read_b128 a[36:39], v3 offset:8192
v_lshrrev_b32 v28, 7, v1
v_mfma_f32_16x16x32_bf16 v[148:151], a[140:143], a[116:119], v[148:151]
v_lshrrev_b32 v29, 1, v28
v_lshlrev_b32 v29, 4, v29
v_mfma_f32_16x16x32_bf16 v[156:159], a[136:139], a[120:123], v[156:159]
ds_read_b128 a[40:43], v2 offset:10240
v_and_b32 v30, 0x70, v1
v_mfma_f32_16x16x32_bf16 v[156:159], a[140:143], a[124:127], v[156:159]
s_waitcnt lgkmcnt(3)
v_xor_b32 v29, v29, v30
v_mul_u32_u24 v28, 896, v28
v_mfma_f32_16x16x32_bf16 v[160:163], a[128:131], a[64:67], v[160:163]
ds_read_b64_tr_b16 a[136:137], v9 offset:32768
v_add_u32 v12, v28, v29
v_mfma_f32_16x16x32_bf16 v[160:163], a[132:135], a[68:71], v[160:163]
v_xor_b32 v29, 64, v29
v_add_u32 v28, v28, v29
v_mfma_f32_16x16x32_bf16 v[168:171], a[128:131], a[72:75], v[168:171]
ds_read_b64_tr_b16 a[138:139], v9 offset:34816
v_add_u32 v13, 6144, v28
v_mfma_f32_16x16x32_bf16 v[168:171], a[132:135], a[76:79], v[168:171]
v_add_u32 v14, 12288, v12
v_add_u32 v15, 18432, v28
v_mfma_f32_16x16x32_bf16 v[176:179], a[128:131], a[80:83], v[176:179]
ds_read_b64_tr_b16 a[140:141], v9 offset:49152
v_xor_b32 v22, s44, v4
v_mfma_f32_16x16x32_bf16 v[176:179], a[132:135], a[84:87], v[176:179]
v_xor_b32 v23, 32, v22
v_xor_b32 v24, 64, v22
v_mfma_f32_16x16x32_bf16 v[184:187], a[128:131], a[88:91], v[184:187]
ds_read_b64_tr_b16 a[142:143], v9 offset:51200
v_xor_b32 v25, 96, v22
v_mfma_f32_16x16x32_bf16 v[184:187], a[132:135], a[92:95], v[184:187]
v_mfma_f32_16x16x32_bf16 v[192:195], a[128:131], a[96:99], v[192:195]
v_mfma_f32_16x16x32_bf16 v[192:195], a[132:135], a[100:103], v[192:195]
v_mfma_f32_16x16x32_bf16 v[200:203], a[128:131], a[104:107], v[200:203]
ds_read_b128 a[44:47], v3 offset:10240
v_mfma_f32_16x16x32_bf16 v[200:203], a[132:135], a[108:111], v[200:203]
v_mfma_f32_16x16x32_bf16 v[208:211], a[128:131], a[112:115], v[208:211]
ds_read_b128 a[48:51], v2 offset:12288
v_mfma_f32_16x16x32_bf16 v[208:211], a[132:135], a[116:119], v[208:211]
v_mfma_f32_16x16x32_bf16 v[216:219], a[128:131], a[120:123], v[216:219]
v_mfma_f32_16x16x32_bf16 v[216:219], a[132:135], a[124:127], v[216:219]
s_waitcnt lgkmcnt(2)
v_mfma_f32_16x16x32_bf16 v[164:167], a[136:139], a[64:67], v[164:167]
ds_read_b64_tr_b16 a[128:129], v10 offset:32768
v_mfma_f32_16x16x32_bf16 v[164:167], a[140:143], a[68:71], v[164:167]
v_mfma_f32_16x16x32_bf16 v[172:175], a[136:139], a[72:75], v[172:175]
ds_read_b64_tr_b16 a[130:131], v10 offset:34816
v_mfma_f32_16x16x32_bf16 v[172:175], a[140:143], a[76:79], v[172:175]
v_mfma_f32_16x16x32_bf16 v[180:183], a[136:139], a[80:83], v[180:183]
ds_read_b64_tr_b16 a[132:133], v10 offset:49152
v_mfma_f32_16x16x32_bf16 v[180:183], a[140:143], a[84:87], v[180:183]
v_mfma_f32_16x16x32_bf16 v[188:191], a[136:139], a[88:91], v[188:191]
ds_read_b64_tr_b16 a[134:135], v10 offset:51200
v_mfma_f32_16x16x32_bf16 v[188:191], a[140:143], a[92:95], v[188:191]
v_mfma_f32_16x16x32_bf16 v[196:199], a[136:139], a[96:99], v[196:199]
ds_read_b128 a[52:55], v3 offset:12288
v_mfma_f32_16x16x32_bf16 v[196:199], a[140:143], a[100:103], v[196:199]
v_mfma_f32_16x16x32_bf16 v[204:207], a[136:139], a[104:107], v[204:207]
ds_read_b128 a[56:59], v2 offset:14336
v_mfma_f32_16x16x32_bf16 v[204:207], a[140:143], a[108:111], v[204:207]
v_mfma_f32_16x16x32_bf16 v[212:215], a[136:139], a[112:115], v[212:215]
v_mfma_f32_16x16x32_bf16 v[212:215], a[140:143], a[116:119], v[212:215]
v_mfma_f32_16x16x32_bf16 v[220:223], a[136:139], a[120:123], v[220:223]
ds_read_b128 a[60:63], v3 offset:14336
v_mfma_f32_16x16x32_bf16 v[220:223], a[140:143], a[124:127], v[220:223]
s_waitcnt lgkmcnt(3)
v_mfma_f32_16x16x32_bf16 a[192:195], a[128:131], a[64:67], a[192:195]
ds_read_b64_tr_b16 a[136:137], v11 offset:32768
v_mfma_f32_16x16x32_bf16 a[192:195], a[132:135], a[68:71], a[192:195]
v_mfma_f32_16x16x32_bf16 a[200:203], a[128:131], a[72:75], a[200:203]
ds_read_b64_tr_b16 a[138:139], v11 offset:34816
v_mfma_f32_16x16x32_bf16 a[200:203], a[132:135], a[76:79], a[200:203]
v_mfma_f32_16x16x32_bf16 a[208:211], a[128:131], a[80:83], a[208:211]
ds_read_b64_tr_b16 a[140:141], v11 offset:49152
v_mfma_f32_16x16x32_bf16 a[208:211], a[132:135], a[84:87], a[208:211]
v_mfma_f32_16x16x32_bf16 a[216:219], a[128:131], a[88:91], a[216:219]
ds_read_b64_tr_b16 a[142:143], v11 offset:51200
v_mfma_f32_16x16x32_bf16 a[216:219], a[132:135], a[92:95], a[216:219]
v_mfma_f32_16x16x32_bf16 a[224:227], a[128:131], a[96:99], a[224:227]
v_mfma_f32_16x16x32_bf16 a[224:227], a[132:135], a[100:103], a[224:227]
v_mfma_f32_16x16x32_bf16 a[232:235], a[128:131], a[104:107], a[232:235]
v_mfma_f32_16x16x32_bf16 a[232:235], a[132:135], a[108:111], a[232:235]
v_mfma_f32_16x16x32_bf16 a[240:243], a[128:131], a[112:115], a[240:243]
v_mfma_f32_16x16x32_bf16 a[240:243], a[132:135], a[116:119], a[240:243]
v_mfma_f32_16x16x32_bf16 a[248:251], a[128:131], a[120:123], a[248:251]
s_waitcnt vmcnt(4) lgkmcnt(0)
v_mfma_f32_16x16x32_bf16 a[248:251], a[132:135], a[124:127], a[248:251]
s_barrier
v_mfma_f32_16x16x32_bf16 a[196:199], a[136:139], a[64:67], a[196:199]
s_add_u32 m0, s29, 98304
ds_read_b64_tr_b16 a[128:129], v4 offset:0
v_mfma_f32_16x16x32_bf16 a[196:199], a[140:143], a[68:71], a[196:199]
buffer_load_dwordx4 v16, s[12:15], s26 offen offset:0 lds
v_mfma_f32_16x16x32_bf16 a[204:207], a[136:139], a[72:75], a[204:207]
ds_read_b64_tr_b16 a[130:131], v4 offset:2048
v_mfma_f32_16x16x32_bf16 a[204:207], a[140:143], a[76:79], a[204:207]
v_mfma_f32_16x16x32_bf16 a[212:215], a[136:139], a[80:83], a[212:215]
ds_read_b64_tr_b16 a[132:133], v4 offset:16384
v_mfma_f32_16x16x32_bf16 a[212:215], a[140:143], a[84:87], a[212:215]
buffer_load_dwordx4 v17, s[12:15], s26 offen offset:1024 lds
v_mfma_f32_16x16x32_bf16 a[220:223], a[136:139], a[88:91], a[220:223]
ds_read_b64_tr_b16 a[134:135], v4 offset:18432
v_mfma_f32_16x16x32_bf16 a[220:223], a[140:143], a[92:95], a[220:223]
v_mfma_f32_16x16x32_bf16 a[228:231], a[136:139], a[96:99], a[228:231]
v_mfma_f32_16x16x32_bf16 a[228:231], a[140:143], a[100:103], a[228:231]
buffer_load_dwordx4 v18, s[12:15], s26 offen offset:2048 lds
v_mfma_f32_16x16x32_bf16 a[236:239], a[136:139], a[104:107], a[236:239]
v_mfma_f32_16x16x32_bf16 a[236:239], a[140:143], a[108:111], a[236:239]
v_mfma_f32_16x16x32_bf16 a[244:247], a[136:139], a[112:115], a[244:247]
v_mfma_f32_16x16x32_bf16 a[244:247], a[140:143], a[116:119], a[244:247]
buffer_load_dwordx4 v19, s[12:15], s26 offen offset:3072 lds
v_mfma_f32_16x16x32_bf16 a[252:255], a[136:139], a[120:123], a[252:255]
s_add_u32 s26, s26, 524288
v_mfma_f32_16x16x32_bf16 a[252:255], a[140:143], a[124:127], a[252:255]
s_waitcnt lgkmcnt(0)
v_mfma_f32_16x16x32_bf16 v[32:35], a[128:131], a[0:3], v[32:35]
s_add_u32 m0, s29, 114688
ds_read_b64_tr_b16 a[136:137], v5 offset:0
v_mfma_f32_16x16x32_bf16 v[32:35], a[132:135], a[4:7], v[32:35]
buffer_load_dwordx4 v16, s[12:15], s27 offen offset:0 lds
v_mfma_f32_16x16x32_bf16 v[40:43], a[128:131], a[8:11], v[40:43]
ds_read_b64_tr_b16 a[138:139], v5 offset:2048
v_mfma_f32_16x16x32_bf16 v[40:43], a[132:135], a[12:15], v[40:43]
v_mfma_f32_16x16x32_bf16 v[48:51], a[128:131], a[16:19], v[48:51]
ds_read_b64_tr_b16 a[140:141], v5 offset:16384
v_mfma_f32_16x16x32_bf16 v[48:51], a[132:135], a[20:23], v[48:51]
buffer_load_dwordx4 v17, s[12:15], s27 offen offset:1024 lds
v_mfma_f32_16x16x32_bf16 v[56:59], a[128:131], a[24:27], v[56:59]
ds_read_b64_tr_b16 a[142:143], v5 offset:18432
v_mfma_f32_16x16x32_bf16 v[56:59], a[132:135], a[28:31], v[56:59]
v_mfma_f32_16x16x32_bf16 v[64:67], a[128:131], a[32:35], v[64:67]
ds_read_b128 a[64:67], v2 offset:32768
v_mfma_f32_16x16x32_bf16 v[64:67], a[132:135], a[36:39], v[64:67]
buffer_load_dwordx4 v18, s[12:15], s27 offen offset:2048 lds
v_mfma_f32_16x16x32_bf16 v[72:75], a[128:131], a[40:43], v[72:75]
ds_read_b128 a[68:71], v3 offset:32768
v_mfma_f32_16x16x32_bf16 v[72:75], a[132:135], a[44:47], v[72:75]
v_mfma_f32_16x16x32_bf16 v[80:83], a[128:131], a[48:51], v[80:83]
v_mfma_f32_16x16x32_bf16 v[80:83], a[132:135], a[52:55], v[80:83]
buffer_load_dwordx4 v19, s[12:15], s27 offen offset:3072 lds
v_mfma_f32_16x16x32_bf16 v[88:91], a[128:131], a[56:59], v[88:91]
s_add_u32 s27, s27, 524288
ds_read_b128 a[72:75], v2 offset:34816
v_mfma_f32_16x16x32_bf16 v[88:91], a[132:135], a[60:63], v[88:91]
s_waitcnt lgkmcnt(3)
v_mfma_f32_16x16x32_bf16 v[36:39], a[136:139], a[0:3], v[36:39]
s_add_u32 m0, s28, 0
ds_read_b64_tr_b16 a[128:129], v6 offset:0
v_mfma_f32_16x16x32_bf16 v[36:39], a[140:143], a[4:7], v[36:39]
buffer_load_dwordx4 v12, s[8:11], s24 offen offset:0 lds
v_mfma_f32_16x16x32_bf16 v[44:47], a[136:139], a[8:11], v[44:47]
ds_read_b64_tr_b16 a[130:131], v6 offset:2048
v_mfma_f32_16x16x32_bf16 v[44:47], a[140:143], a[12:15], v[44:47]
v_mfma_f32_16x16x32_bf16 v[52:55], a[136:139], a[16:19], v[52:55]
ds_read_b64_tr_b16 a[132:133], v6 offset:16384
v_mfma_f32_16x16x32_bf16 v[52:55], a[140:143], a[20:23], v[52:55]
buffer_load_dwordx4 v13, s[8:11], s24 offen offset:1024 lds
v_mfma_f32_16x16x32_bf16 v[60:63], a[136:139], a[24:27], v[60:63]
ds_read_b64_tr_b16 a[134:135], v6 offset:18432
v_mfma_f32_16x16x32_bf16 v[60:63], a[140:143], a[28:31], v[60:63]
v_mfma_f32_16x16x32_bf16 v[68:71], a[136:139], a[32:35], v[68:71]
ds_read_b128 a[76:79], v3 offset:34816
v_mfma_f32_16x16x32_bf16 v[68:71], a[140:143], a[36:39], v[68:71]
buffer_load_dwordx4 v14, s[8:11], s24 offen offset:2048 lds
v_mfma_f32_16x16x32_bf16 v[76:79], a[136:139], a[40:43], v[76:79]
v_mfma_f32_16x16x32_bf16 v[76:79], a[140:143], a[44:47], v[76:79]
v_mfma_f32_16x16x32_bf16 v[84:87], a[136:139], a[48:51], v[84:87]
ds_read_b128 a[80:83], v2 offset:36864
v_mfma_f32_16x16x32_bf16 v[84:87], a[140:143], a[52:55], v[84:87]
buffer_load_dwordx4 v15, s[8:11], s24 offen offset:3072 lds
v_mfma_f32_16x16x32_bf16 v[92:95], a[136:139], a[56:59], v[92:95]
s_add_u32 s24, s24, 128
ds_read_b128 a[84:87], v3 offset:36864
v_mfma_f32_16x16x32_bf16 v[92:95], a[140:143], a[60:63], v[92:95]
s_waitcnt lgkmcnt(3)
s_mov_b64 s[12:13], s[80:81]
v_mfma_f32_16x16x32_bf16 v[96:99], a[128:131], a[0:3], v[96:99]
s_mov_b32 s14, 3670016
s_add_u32 m0, s28, 16384
ds_read_b64_tr_b16 a[136:137], v7 offset:0
v_mfma_f32_16x16x32_bf16 v[96:99], a[132:135], a[4:7], v[96:99]
buffer_load_dwordx4 v12, s[8:11], s24 offen offset:0 lds
v_mfma_f32_16x16x32_bf16 v[104:107], a[128:131], a[8:11], v[104:107]
ds_read_b64_tr_b16 a[138:139], v7 offset:2048
v_mfma_f32_16x16x32_bf16 v[104:107], a[132:135], a[12:15], v[104:107]
v_mfma_f32_16x16x32_bf16 v[112:115], a[128:131], a[16:19], v[112:115]
ds_read_b64_tr_b16 a[140:141], v7 offset:16384
v_mfma_f32_16x16x32_bf16 v[112:115], a[132:135], a[20:23], v[112:115]
buffer_load_dwordx4 v13, s[8:11], s24 offen offset:1024 lds
v_mfma_f32_16x16x32_bf16 v[120:123], a[128:131], a[24:27], v[120:123]
ds_read_b64_tr_b16 a[142:143], v7 offset:18432
v_mfma_f32_16x16x32_bf16 v[120:123], a[132:135], a[28:31], v[120:123]
v_mfma_f32_16x16x32_bf16 v[128:131], a[128:131], a[32:35], v[128:131]
v_mfma_f32_16x16x32_bf16 v[128:131], a[132:135], a[36:39], v[128:131]
buffer_load_dwordx4 v14, s[8:11], s24 offen offset:2048 lds
v_mfma_f32_16x16x32_bf16 v[136:139], a[128:131], a[40:43], v[136:139]
ds_read_b128 a[88:91], v2 offset:38912
v_mfma_f32_16x16x32_bf16 v[136:139], a[132:135], a[44:47], v[136:139]
v_mfma_f32_16x16x32_bf16 v[144:147], a[128:131], a[48:51], v[144:147]
ds_read_b128 a[92:95], v3 offset:38912
v_mfma_f32_16x16x32_bf16 v[144:147], a[132:135], a[52:55], v[144:147]
buffer_load_dwordx4 v15, s[8:11], s24 offen offset:3072 lds
v_mfma_f32_16x16x32_bf16 v[152:155], a[128:131], a[56:59], v[152:155]
s_add_u32 s24, s24, 128
v_mfma_f32_16x16x32_bf16 v[152:155], a[132:135], a[60:63], v[152:155]
s_waitcnt lgkmcnt(2)
s_sub_u32 s26, s26, 8388608
v_mfma_f32_16x16x32_bf16 v[100:103], a[136:139], a[0:3], v[100:103]
s_sub_u32 s27, s27, 8388608
s_add_u32 m0, s29, 131072
ds_read_b64_tr_b16 a[128:129], v8 offset:0
v_mfma_f32_16x16x32_bf16 v[100:103], a[140:143], a[4:7], v[100:103]
buffer_load_dwordx4 v16, s[12:15], s26 offen offset:0 lds
v_mfma_f32_16x16x32_bf16 v[108:111], a[136:139], a[8:11], v[108:111]
ds_read_b64_tr_b16 a[130:131], v8 offset:2048
v_mfma_f32_16x16x32_bf16 v[108:111], a[140:143], a[12:15], v[108:111]
PAD_5:
s_cbranch_execz M_tret
v_mfma_f32_16x16x32_bf16 v[116:119], a[136:139], a[16:19], v[116:119]
ds_read_b64_tr_b16 a[132:133], v8 offset:16384
v_mfma_f32_16x16x32_bf16 v[116:119], a[140:143], a[20:23], v[116:119]
buffer_load_dwordx4 v17, s[12:15], s26 offen offset:1024 lds
v_mfma_f32_16x16x32_bf16 v[124:127], a[136:139], a[24:27], v[124:127]
ds_read_b64_tr_b16 a[134:135], v8 offset:18432
v_mfma_f32_16x16x32_bf16 v[124:127], a[140:143], a[28:31], v[124:127]
v_mfma_f32_16x16x32_bf16 v[132:135], a[136:139], a[32:35], v[132:135]
ds_read_b128 a[96:99], v2 offset:40960
v_mfma_f32_16x16x32_bf16 v[132:135], a[140:143], a[36:39], v[132:135]
buffer_load_dwordx4 v18, s[12:15], s26 offen offset:2048 lds
v_mfma_f32_16x16x32_bf16 v[140:143], a[136:139], a[40:43], v[140:143]
v_mfma_f32_16x16x32_bf16 v[140:143], a[140:143], a[44:47], v[140:143]
v_mfma_f32_16x16x32_bf16 v[148:151], a[136:139], a[48:51], v[148:151]
ds_read_b128 a[100:103], v3 offset:40960
v_mfma_f32_16x16x32_bf16 v[148:151], a[140:143], a[52:55], v[148:151]
buffer_load_dwordx4 v19, s[12:15], s26 offen offset:3072 lds
v_mfma_f32_16x16x32_bf16 v[156:159], a[136:139], a[56:59], v[156:159]
s_add_u32 s26, s26, 524288
ds_read_b128 a[104:107], v2 offset:43008
v_mfma_f32_16x16x32_bf16 v[156:159], a[140:143], a[60:63], v[156:159]
s_waitcnt lgkmcnt(3)
v_mfma_f32_16x16x32_bf16 v[160:163], a[128:131], a[0:3], v[160:163]
s_add_u32 m0, s29, 147456
ds_read_b64_tr_b16 a[136:137], v9 offset:0
v_mfma_f32_16x16x32_bf16 v[160:163], a[132:135], a[4:7], v[160:163]
buffer_load_dwordx4 v16, s[12:15], s27 offen offset:0 lds
v_mfma_f32_16x16x32_bf16 v[168:171], a[128:131], a[8:11], v[168:171]
ds_read_b64_tr_b16 a[138:139], v9 offset:2048
v_mfma_f32_16x16x32_bf16 v[168:171], a[132:135], a[12:15], v[168:171]
v_mfma_f32_16x16x32_bf16 v[176:179], a[128:131], a[16:19], v[176:179]
ds_read_b64_tr_b16 a[140:141], v9 offset:16384
v_mfma_f32_16x16x32_bf16 v[176:179], a[132:135], a[20:23], v[176:179]
buffer_load_dwordx4 v17, s[12:15], s27 offen offset:1024 lds
v_mfma_f32_16x16x32_bf16 v[184:187], a[128:131], a[24:27], v[184:187]
ds_read_b64_tr_b16 a[142:143], v9 offset:18432
v_mfma_f32_16x16x32_bf16 v[184:187], a[132:135], a[28:31], v[184:187]
v_mfma_f32_16x16x32_bf16 v[192:195], a[128:131], a[32:35], v[192:195]
v_mfma_f32_16x16x32_bf16 v[192:195], a[132:135], a[36:39], v[192:195]
buffer_load_dwordx4 v18, s[12:15], s27 offen offset:2048 lds
v_mfma_f32_16x16x32_bf16 v[200:203], a[128:131], a[40:43], v[200:203]
ds_read_b128 a[108:111], v3 offset:43008
v_mfma_f32_16x16x32_bf16 v[200:203], a[132:135], a[44:47], v[200:203]
v_mfma_f32_16x16x32_bf16 v[208:211], a[128:131], a[48:51], v[208:211]
ds_read_b128 a[112:115], v2 offset:45056
v_mfma_f32_16x16x32_bf16 v[208:211], a[132:135], a[52:55], v[208:211]
buffer_load_dwordx4 v19, s[12:15], s27 offen offset:3072 lds
v_mfma_f32_16x16x32_bf16 v[216:219], a[128:131], a[56:59], v[216:219]
s_add_u32 s27, s27, 524288
v_mfma_f32_16x16x32_bf16 v[216:219], a[132:135], a[60:63], v[216:219]
s_waitcnt lgkmcnt(2)
v_mfma_f32_16x16x32_bf16 v[164:167], a[136:139], a[0:3], v[164:167]
ds_read_b64_tr_b16 a[128:129], v10 offset:0
v_mfma_f32_16x16x32_bf16 v[164:167], a[140:143], a[4:7], v[164:167]
v_mfma_f32_16x16x32_bf16 v[172:175], a[136:139], a[8:11], v[172:175]
ds_read_b64_tr_b16 a[130:131], v10 offset:2048
v_mfma_f32_16x16x32_bf16 v[172:175], a[140:143], a[12:15], v[172:175]
v_mfma_f32_16x16x32_bf16 v[180:183], a[136:139], a[16:19], v[180:183]
ds_read_b64_tr_b16 a[132:133], v10 offset:16384
v_mfma_f32_16x16x32_bf16 v[180:183], a[140:143], a[20:23], v[180:183]
v_mfma_f32_16x16x32_bf16 v[188:191], a[136:139], a[24:27], v[188:191]
ds_read_b64_tr_b16 a[134:135], v10 offset:18432
v_mfma_f32_16x16x32_bf16 v[188:191], a[140:143], a[28:31], v[188:191]
v_mfma_f32_16x16x32_bf16 v[196:199], a[136:139], a[32:35], v[196:199]
ds_read_b128 a[116:119], v3 offset:45056
v_mfma_f32_16x16x32_bf16 v[196:199], a[140:143], a[36:39], v[196:199]
v_mfma_f32_16x16x32_bf16 v[204:207], a[136:139], a[40:43], v[204:207]
ds_read_b128 a[120:123], v2 offset:47104
v_mfma_f32_16x16x32_bf16 v[204:207], a[140:143], a[44:47], v[204:207]
v_mfma_f32_16x16x32_bf16 v[212:215], a[136:139], a[48:51], v[212:215]
v_mfma_f32_16x16x32_bf16 v[212:215], a[140:143], a[52:55], v[212:215]
v_mfma_f32_16x16x32_bf16 v[220:223], a[136:139], a[56:59], v[220:223]
ds_read_b128 a[124:127], v3 offset:47104
v_mfma_f32_16x16x32_bf16 v[220:223], a[140:143], a[60:63], v[220:223]
s_waitcnt lgkmcnt(3)
v_mfma_f32_16x16x32_bf16 a[192:195], a[128:131], a[0:3], a[192:195]
ds_read_b64_tr_b16 a[136:137], v11 offset:0
v_mfma_f32_16x16x32_bf16 a[192:195], a[132:135], a[4:7], a[192:195]
v_mfma_f32_16x16x32_bf16 a[200:203], a[128:131], a[8:11], a[200:203]
ds_read_b64_tr_b16 a[138:139], v11 offset:2048
v_mfma_f32_16x16x32_bf16 a[200:203], a[132:135], a[12:15], a[200:203]
v_mfma_f32_16x16x32_bf16 a[208:211], a[128:131], a[16:19], a[208:211]
ds_read_b64_tr_b16 a[140:141], v11 offset:16384
v_mfma_f32_16x16x32_bf16 a[208:211], a[132:135], a[20:23], a[208:211]
v_mfma_f32_16x16x32_bf16 a[216:219], a[128:131], a[24:27], a[216:219]
ds_read_b64_tr_b16 a[142:143], v11 offset:18432
v_mfma_f32_16x16x32_bf16 a[216:219], a[132:135], a[28:31], a[216:219]
v_mfma_f32_16x16x32_bf16 a[224:227], a[128:131], a[32:35], a[224:227]
v_mfma_f32_16x16x32_bf16 a[224:227], a[132:135], a[36:39], a[224:227]
v_mfma_f32_16x16x32_bf16 a[232:235], a[128:131], a[40:43], a[232:235]
v_mfma_f32_16x16x32_bf16 a[232:235], a[132:135], a[44:47], a[232:235]
v_mfma_f32_16x16x32_bf16 a[240:243], a[128:131], a[48:51], a[240:243]
v_mfma_f32_16x16x32_bf16 a[240:243], a[132:135], a[52:55], a[240:243]
v_mfma_f32_16x16x32_bf16 a[248:251], a[128:131], a[56:59], a[248:251]
s_waitcnt vmcnt(12) lgkmcnt(0)
v_mfma_f32_16x16x32_bf16 a[248:251], a[132:135], a[60:63], a[248:251]
s_barrier
v_mfma_f32_16x16x32_bf16 a[196:199], a[136:139], a[0:3], a[196:199]
s_add_u32 m0, s28, 32768
ds_read_b64_tr_b16 a[128:129], v4 offset:32768
v_mfma_f32_16x16x32_bf16 a[196:199], a[140:143], a[4:7], a[196:199]
s_lshr_b32 s22, s3, 1
buffer_load_dwordx4 v12, s[8:11], s24 offen offset:0 lds
v_mfma_f32_16x16x32_bf16 a[204:207], a[136:139], a[8:11], a[204:207]
s_lshl_b32 s22, s22, 14
ds_read_b64_tr_b16 a[130:131], v4 offset:34816
v_subrev_u32 v2, s22, v2
v_mfma_f32_16x16x32_bf16 a[204:207], a[140:143], a[12:15], a[204:207]
v_subrev_u32 v3, s22, v3
v_mfma_f32_16x16x32_bf16 a[212:215], a[136:139], a[16:19], a[212:215]
ds_read_b64_tr_b16 a[132:133], v4 offset:49152
v_mfma_f32_16x16x32_bf16 a[212:215], a[140:143], a[20:23], a[212:215]
buffer_load_dwordx4 v13, s[8:11], s24 offen offset:1024 lds
v_mfma_f32_16x16x32_bf16 a[220:223], a[136:139], a[24:27], a[220:223]
ds_read_b64_tr_b16 a[134:135], v4 offset:51200
v_mfma_f32_16x16x32_bf16 a[220:223], a[140:143], a[28:31], a[220:223]
v_mfma_f32_16x16x32_bf16 a[228:231], a[136:139], a[32:35], a[228:231]
v_mfma_f32_16x16x32_bf16 a[228:231], a[140:143], a[36:39], a[228:231]
buffer_load_dwordx4 v14, s[8:11], s24 offen offset:2048 lds
v_mfma_f32_16x16x32_bf16 a[236:239], a[136:139], a[40:43], a[236:239]
v_mfma_f32_16x16x32_bf16 a[236:239], a[140:143], a[44:47], a[236:239]
v_mfma_f32_16x16x32_bf16 a[244:247], a[136:139], a[48:51], a[244:247]
v_mfma_f32_16x16x32_bf16 a[244:247], a[140:143], a[52:55], a[244:247]
buffer_load_dwordx4 v15, s[8:11], s24 offen offset:3072 lds
v_mfma_f32_16x16x32_bf16 a[252:255], a[136:139], a[56:59], a[252:255]
s_add_u32 s24, s24, 128
v_mfma_f32_16x16x32_bf16 a[252:255], a[140:143], a[60:63], a[252:255]
s_waitcnt lgkmcnt(0)
v_mfma_f32_16x16x32_bf16 v[32:35], a[128:131], a[64:67], v[32:35]
s_add_u32 m0, s29, 65536
ds_read_b64_tr_b16 a[136:137], v5 offset:32768
v_mfma_f32_16x16x32_bf16 v[32:35], a[132:135], a[68:71], v[32:35]
buffer_load_dwordx4 v16, s[12:15], s26 offen offset:0 lds
v_mfma_f32_16x16x32_bf16 v[40:43], a[128:131], a[72:75], v[40:43]
ds_read_b64_tr_b16 a[138:139], v5 offset:34816
v_mfma_f32_16x16x32_bf16 v[40:43], a[132:135], a[76:79], v[40:43]
v_mfma_f32_16x16x32_bf16 v[48:51], a[128:131], a[80:83], v[48:51]
ds_read_b64_tr_b16 a[140:141], v5 offset:49152
v_mfma_f32_16x16x32_bf16 v[48:51], a[132:135], a[84:87], v[48:51]
buffer_load_dwordx4 v17, s[12:15], s26 offen offset:1024 lds
v_mfma_f32_16x16x32_bf16 v[56:59], a[128:131], a[88:91], v[56:59]
ds_read_b64_tr_b16 a[142:143], v5 offset:51200
v_mfma_f32_16x16x32_bf16 v[56:59], a[132:135], a[92:95], v[56:59]
v_mfma_f32_16x16x32_bf16 v[64:67], a[128:131], a[96:99], v[64:67]
ds_read_b128 a[0:3], v2 offset:0
v_mfma_f32_16x16x32_bf16 v[64:67], a[132:135], a[100:103], v[64:67]
buffer_load_dwordx4 v18, s[12:15], s26 offen offset:2048 lds
v_mfma_f32_16x16x32_bf16 v[72:75], a[128:131], a[104:107], v[72:75]
ds_read_b128 a[4:7], v3 offset:0
v_mfma_f32_16x16x32_bf16 v[72:75], a[132:135], a[108:111], v[72:75]
v_mfma_f32_16x16x32_bf16 v[80:83], a[128:131], a[112:115], v[80:83]
v_mfma_f32_16x16x32_bf16 v[80:83], a[132:135], a[116:119], v[80:83]
buffer_load_dwordx4 v19, s[12:15], s26 offen offset:3072 lds
v_mfma_f32_16x16x32_bf16 v[88:91], a[128:131], a[120:123], v[88:91]
s_add_u32 s26, s26, 524288
ds_read_b128 a[8:11], v2 offset:2048
v_mfma_f32_16x16x32_bf16 v[88:91], a[132:135], a[124:127], v[88:91]
s_waitcnt lgkmcnt(3)
v_mfma_f32_16x16x32_bf16 v[36:39], a[136:139], a[64:67], v[36:39]
s_add_u32 m0, s29, 81920
ds_read_b64_tr_b16 a[128:129], v6 offset:32768
v_mfma_f32_16x16x32_bf16 v[36:39], a[140:143], a[68:71], v[36:39]
buffer_load_dwordx4 v16, s[12:15], s27 offen offset:0 lds
v_mfma_f32_16x16x32_bf16 v[44:47], a[136:139], a[72:75], v[44:47]
ds_read_b64_tr_b16 a[130:131], v6 offset:34816
v_mfma_f32_16x16x32_bf16 v[44:47], a[140:143], a[76:79], v[44:47]
v_mfma_f32_16x16x32_bf16 v[52:55], a[136:139], a[80:83], v[52:55]
ds_read_b64_tr_b16 a[132:133], v6 offset:49152
v_mfma_f32_16x16x32_bf16 v[52:55], a[140:143], a[84:87], v[52:55]
buffer_load_dwordx4 v17, s[12:15], s27 offen offset:1024 lds
v_mfma_f32_16x16x32_bf16 v[60:63], a[136:139], a[88:91], v[60:63]
ds_read_b64_tr_b16 a[134:135], v6 offset:51200
v_cvt_pk_bf16_f32 v32, v32, v33
v_mfma_f32_16x16x32_bf16 v[60:63], a[140:143], a[92:95], v[60:63]
v_cvt_pk_bf16_f32 v33, v34, v35
v_cvt_pk_bf16_f32 v34, v36, v37
v_mfma_f32_16x16x32_bf16 v[68:71], a[136:139], a[96:99], v[68:71]
ds_read_b128 a[12:15], v3 offset:2048
v_cvt_pk_bf16_f32 v35, v38, v39
v_mfma_f32_16x16x32_bf16 v[68:71], a[140:143], a[100:103], v[68:71]
buffer_load_dwordx4 v18, s[12:15], s27 offen offset:2048 lds
v_mfma_f32_16x16x32_bf16 v[76:79], a[136:139], a[104:107], v[76:79]
v_cvt_pk_bf16_f32 v40, v40, v41
v_cvt_pk_bf16_f32 v41, v42, v43
v_mfma_f32_16x16x32_bf16 v[76:79], a[140:143], a[108:111], v[76:79]
v_cvt_pk_bf16_f32 v42, v44, v45
v_cvt_pk_bf16_f32 v43, v46, v47
v_mfma_f32_16x16x32_bf16 v[84:87], a[136:139], a[112:115], v[84:87]
ds_read_b128 a[16:19], v2 offset:4096
v_cvt_pk_bf16_f32 v48, v48, v49
v_mfma_f32_16x16x32_bf16 v[84:87], a[140:143], a[116:119], v[84:87]
buffer_load_dwordx4 v19, s[12:15], s27 offen offset:3072 lds
v_mfma_f32_16x16x32_bf16 v[92:95], a[136:139], a[120:123], v[92:95]
s_add_u32 s27, s27, 524288
ds_read_b128 a[20:23], v3 offset:4096
v_cvt_pk_bf16_f32 v49, v50, v51
v_mfma_f32_16x16x32_bf16 v[92:95], a[140:143], a[124:127], v[92:95]
s_waitcnt lgkmcnt(3)
v_cvt_pk_bf16_f32 v50, v52, v53
v_cvt_pk_bf16_f32 v51, v54, v55
v_mfma_f32_16x16x32_bf16 v[96:99], a[128:131], a[64:67], v[96:99]
s_add_u32 m0, s28, 49152
ds_read_b64_tr_b16 a[136:137], v7 offset:32768
v_cvt_pk_bf16_f32 v56, v56, v57
v_mfma_f32_16x16x32_bf16 v[96:99], a[132:135], a[68:71], v[96:99]
buffer_load_dwordx4 v12, s[8:11], s24 offen offset:0 lds
v_mfma_f32_16x16x32_bf16 v[104:107], a[128:131], a[72:75], v[104:107]
ds_read_b64_tr_b16 a[138:139], v7 offset:34816
v_cvt_pk_bf16_f32 v57, v58, v59
v_mfma_f32_16x16x32_bf16 v[104:107], a[132:135], a[76:79], v[104:107]
v_cvt_pk_bf16_f32 v58, v60, v61
v_cvt_pk_bf16_f32 v59, v62, v63
v_mfma_f32_16x16x32_bf16 v[112:115], a[128:131], a[80:83], v[112:115]
ds_read_b64_tr_b16 a[140:141], v7 offset:49152
v_cvt_pk_bf16_f32 v64, v64, v65
v_mfma_f32_16x16x32_bf16 v[112:115], a[132:135], a[84:87], v[112:115]
buffer_load_dwordx4 v13, s[8:11], s24 offen offset:1024 lds
v_mfma_f32_16x16x32_bf16 v[120:123], a[128:131], a[88:91], v[120:123]
ds_read_b64_tr_b16 a[142:143], v7 offset:51200
v_cvt_pk_bf16_f32 v65, v66, v67
v_mfma_f32_16x16x32_bf16 v[120:123], a[132:135], a[92:95], v[120:123]
v_cvt_pk_bf16_f32 v66, v68, v69
v_cvt_pk_bf16_f32 v67, v70, v71
v_mfma_f32_16x16x32_bf16 v[128:131], a[128:131], a[96:99], v[128:131]
v_cvt_pk_bf16_f32 v72, v72, v73
v_cvt_pk_bf16_f32 v73, v74, v75
v_mfma_f32_16x16x32_bf16 v[128:131], a[132:135], a[100:103], v[128:131]
buffer_load_dwordx4 v14, s[8:11], s24 offen offset:2048 lds
v_mfma_f32_16x16x32_bf16 v[136:139], a[128:131], a[104:107], v[136:139]
ds_read_b128 a[24:27], v2 offset:6144
v_cvt_pk_bf16_f32 v74, v76, v77
v_mfma_f32_16x16x32_bf16 v[136:139], a[132:135], a[108:111], v[136:139]
buffer_store_dwordx4 v[32:35], v1, s[4:7], s31 offen sc1
v_mfma_f32_16x16x32_bf16 v[144:147], a[128:131], a[112:115], v[144:147]
s_add_u32 s31, s31, s32
ds_read_b128 a[28:31], v3 offset:6144
v_cvt_pk_bf16_f32 v75, v78, v79
v_mfma_f32_16x16x32_bf16 v[144:147], a[132:135], a[116:119], v[144:147]
buffer_load_dwordx4 v15, s[8:11], s24 offen offset:3072 lds
v_mfma_f32_16x16x32_bf16 v[152:155], a[128:131], a[120:123], v[152:155]
s_add_u32 s24, s24, 128
v_cvt_pk_bf16_f32 v80, v80, v81
v_cvt_pk_bf16_f32 v81, v82, v83
v_mfma_f32_16x16x32_bf16 v[152:155], a[132:135], a[124:127], v[152:155]
s_waitcnt lgkmcnt(2)
v_cvt_pk_bf16_f32 v82, v84, v85
v_cvt_pk_bf16_f32 v83, v86, v87
v_mfma_f32_16x16x32_bf16 v[100:103], a[136:139], a[64:67], v[100:103]
ds_read_b64_tr_b16 a[128:129], v8 offset:32768
v_cvt_pk_bf16_f32 v88, v88, v89
v_mfma_f32_16x16x32_bf16 v[100:103], a[140:143], a[68:71], v[100:103]
v_cvt_pk_bf16_f32 v89, v90, v91
v_cvt_pk_bf16_f32 v90, v92, v93
v_mfma_f32_16x16x32_bf16 v[108:111], a[136:139], a[72:75], v[108:111]
ds_read_b64_tr_b16 a[130:131], v8 offset:34816
v_cvt_pk_bf16_f32 v91, v94, v95
v_mfma_f32_16x16x32_bf16 v[108:111], a[140:143], a[76:79], v[108:111]
buffer_store_dwordx4 v[40:43], v1, s[4:7], s31 offen sc1
v_mfma_f32_16x16x32_bf16 v[116:119], a[136:139], a[80:83], v[116:119]
s_add_u32 s31, s31, s33
ds_read_b64_tr_b16 a[132:133], v8 offset:49152
v_mfma_f32_16x16x32_bf16 v[116:119], a[140:143], a[84:87], v[116:119]
v_mfma_f32_16x16x32_bf16 v[124:127], a[136:139], a[88:91], v[124:127]
ds_read_b64_tr_b16 a[134:135], v8 offset:51200
v_cvt_pk_bf16_f32 v96, v96, v97
v_mfma_f32_16x16x32_bf16 v[124:127], a[140:143], a[92:95], v[124:127]
v_cvt_pk_bf16_f32 v97, v98, v99
v_cvt_pk_bf16_f32 v98, v100, v101
v_mfma_f32_16x16x32_bf16 v[132:135], a[136:139], a[96:99], v[132:135]
ds_read_b128 a[32:35], v2 offset:8192
v_cvt_pk_bf16_f32 v99, v102, v103
v_mfma_f32_16x16x32_bf16 v[132:135], a[140:143], a[100:103], v[132:135]
v_cvt_pk_bf16_f32 v104, v104, v105
v_cvt_pk_bf16_f32 v105, v106, v107
v_mfma_f32_16x16x32_bf16 v[140:143], a[136:139], a[104:107], v[140:143]
v_cvt_pk_bf16_f32 v106, v108, v109
v_cvt_pk_bf16_f32 v107, v110, v111
v_mfma_f32_16x16x32_bf16 v[140:143], a[140:143], a[108:111], v[140:143]
v_cvt_pk_bf16_f32 v112, v112, v113
v_cvt_pk_bf16_f32 v113, v114, v115
v_mfma_f32_16x16x32_bf16 v[148:151], a[136:139], a[112:115], v[148:151]
ds_read_b128 a[36:39], v3 offset:8192
v_cvt_pk_bf16_f32 v114, v116, v117
v_mfma_f32_16x16x32_bf16 v[148:151], a[140:143], a[116:119], v[148:151]
v_cvt_pk_bf16_f32 v115, v118, v119
v_cvt_pk_bf16_f32 v120, v120, v121
v_mfma_f32_16x16x32_bf16 v[156:159], a[136:139], a[120:123], v[156:159]
ds_read_b128 a[40:43], v2 offset:10240
v_cvt_pk_bf16_f32 v121, v122, v123
v_mfma_f32_16x16x32_bf16 v[156:159], a[140:143], a[124:127], v[156:159]
s_waitcnt lgkmcnt(3)
buffer_store_dwordx4 v[48:51], v1, s[4:7], s31 offen sc1
v_mfma_f32_16x16x32_bf16 v[160:163], a[128:131], a[64:67], v[160:163]
s_add_u32 s31, s31, s32
ds_read_b64_tr_b16 a[136:137], v9 offset:32768
v_cvt_pk_bf16_f32 v122, v124, v125
v_mfma_f32_16x16x32_bf16 v[160:163], a[132:135], a[68:71], v[160:163]
v_cvt_pk_bf16_f32 v123, v126, v127
v_cvt_pk_bf16_f32 v128, v128, v129
v_mfma_f32_16x16x32_bf16 v[168:171], a[128:131], a[72:75], v[168:171]
ds_read_b64_tr_b16 a[138:139], v9 offset:34816
v_cvt_pk_bf16_f32 v129, v130, v131
v_mfma_f32_16x16x32_bf16 v[168:171], a[132:135], a[76:79], v[168:171]
v_cvt_pk_bf16_f32 v130, v132, v133
v_cvt_pk_bf16_f32 v131, v134, v135
v_mfma_f32_16x16x32_bf16 v[176:179], a[128:131], a[80:83], v[176:179]
ds_read_b64_tr_b16 a[140:141], v9 offset:49152
v_cvt_pk_bf16_f32 v136, v136, v137
v_mfma_f32_16x16x32_bf16 v[176:179], a[132:135], a[84:87], v[176:179]
v_cvt_pk_bf16_f32 v137, v138, v139
v_cvt_pk_bf16_f32 v138, v140, v141
v_mfma_f32_16x16x32_bf16 v[184:187], a[128:131], a[88:91], v[184:187]
ds_read_b64_tr_b16 a[142:143], v9 offset:51200
v_cvt_pk_bf16_f32 v139, v142, v143
v_mfma_f32_16x16x32_bf16 v[184:187], a[132:135], a[92:95], v[184:187]
v_cvt_pk_bf16_f32 v144, v144, v145
v_cvt_pk_bf16_f32 v145, v146, v147
v_mfma_f32_16x16x32_bf16 v[192:195], a[128:131], a[96:99], v[192:195]
buffer_store_dwordx4 v[56:59], v1, s[4:7], s31 offen sc1
v_mfma_f32_16x16x32_bf16 v[192:195], a[132:135], a[100:103], v[192:195]
s_add_u32 s31, s31, s34
v_cvt_pk_bf16_f32 v146, v148, v149
v_cvt_pk_bf16_f32 v147, v150, v151
v_mfma_f32_16x16x32_bf16 v[200:203], a[128:131], a[104:107], v[200:203]
ds_read_b128 a[44:47], v3 offset:10240
v_cvt_pk_bf16_f32 v152, v152, v153
v_mfma_f32_16x16x32_bf16 v[200:203], a[132:135], a[108:111], v[200:203]
v_cvt_pk_bf16_f32 v153, v154, v155
v_cvt_pk_bf16_f32 v154, v156, v157
v_mfma_f32_16x16x32_bf16 v[208:211], a[128:131], a[112:115], v[208:211]
ds_read_b128 a[48:51], v2 offset:12288
v_cvt_pk_bf16_f32 v155, v158, v159
v_mfma_f32_16x16x32_bf16 v[208:211], a[132:135], a[116:119], v[208:211]
v_mfma_f32_16x16x32_bf16 v[216:219], a[128:131], a[120:123], v[216:219]
v_mfma_f32_16x16x32_bf16 v[216:219], a[132:135], a[124:127], v[216:219]
s_waitcnt lgkmcnt(2)
v_mfma_f32_16x16x32_bf16 v[164:167], a[136:139], a[64:67], v[164:167]
ds_read_b64_tr_b16 a[128:129], v10 offset:32768
v_mfma_f32_16x16x32_bf16 v[164:167], a[140:143], a[68:71], v[164:167]
v_mfma_f32_16x16x32_bf16 v[172:175], a[136:139], a[72:75], v[172:175]
ds_read_b64_tr_b16 a[130:131], v10 offset:34816
v_mfma_f32_16x16x32_bf16 v[172:175], a[140:143], a[76:79], v[172:175]
buffer_store_dwordx4 v[64:67], v1, s[4:7], s31 offen sc1
v_mfma_f32_16x16x32_bf16 v[180:183], a[136:139], a[80:83], v[180:183]
s_add_u32 s31, s31, s32
ds_read_b64_tr_b16 a[132:133], v10 offset:49152
v_mfma_f32_16x16x32_bf16 v[180:183], a[140:143], a[84:87], v[180:183]
v_mfma_f32_16x16x32_bf16 v[188:191], a[136:139], a[88:91], v[188:191]
ds_read_b64_tr_b16 a[134:135], v10 offset:51200
v_cvt_pk_bf16_f32 v160, v160, v161
v_mfma_f32_16x16x32_bf16 v[188:191], a[140:143], a[92:95], v[188:191]
v_cvt_pk_bf16_f32 v161, v162, v163
v_cvt_pk_bf16_f32 v162, v164, v165
v_mfma_f32_16x16x32_bf16 v[196:199], a[136:139], a[96:99], v[196:199]
ds_read_b128 a[52:55], v3 offset:12288
v_cvt_pk_bf16_f32 v163, v166, v167
v_mfma_f32_16x16x32_bf16 v[196:199], a[140:143], a[100:103], v[196:199]
v_cvt_pk_bf16_f32 v168, v168, v169
v_cvt_pk_bf16_f32 v169, v170, v171
v_mfma_f32_16x16x32_bf16 v[204:207], a[136:139], a[104:107], v[204:207]
ds_read_b128 a[56:59], v2 offset:14336
v_cvt_pk_bf16_f32 v170, v172, v173
v_mfma_f32_16x16x32_bf16 v[204:207], a[140:143], a[108:111], v[204:207]
v_cvt_pk_bf16_f32 v171, v174, v175
v_cvt_pk_bf16_f32 v176, v176, v177
v_mfma_f32_16x16x32_bf16 v[212:215], a[136:139], a[112:115], v[212:215]
v_cvt_pk_bf16_f32 v177, v178, v179
v_cvt_pk_bf16_f32 v178, v180, v181
v_mfma_f32_16x16x32_bf16 v[212:215], a[140:143], a[116:119], v[212:215]
buffer_store_dwordx4 v[72:75], v1, s[4:7], s31 offen sc1
v_mfma_f32_16x16x32_bf16 v[220:223], a[136:139], a[120:123], v[220:223]
s_add_u32 s31, s31, s33
ds_read_b128 a[60:63], v3 offset:14336
v_cvt_pk_bf16_f32 v179, v182, v183
v_mfma_f32_16x16x32_bf16 v[220:223], a[140:143], a[124:127], v[220:223]
s_waitcnt lgkmcnt(3)
v_cvt_pk_bf16_f32 v184, v184, v185
v_cvt_pk_bf16_f32 v185, v186, v187
v_mfma_f32_16x16x32_bf16 a[192:195], a[128:131], a[64:67], a[192:195]
ds_read_b64_tr_b16 a[136:137], v11 offset:32768
v_cvt_pk_bf16_f32 v186, v188, v189
v_mfma_f32_16x16x32_bf16 a[192:195], a[132:135], a[68:71], a[192:195]
v_cvt_pk_bf16_f32 v187, v190, v191
v_cvt_pk_bf16_f32 v192, v192, v193
v_mfma_f32_16x16x32_bf16 a[200:203], a[128:131], a[72:75], a[200:203]
ds_read_b64_tr_b16 a[138:139], v11 offset:34816
v_cvt_pk_bf16_f32 v193, v194, v195
v_mfma_f32_16x16x32_bf16 a[200:203], a[132:135], a[76:79], a[200:203]
v_cvt_pk_bf16_f32 v194, v196, v197
v_cvt_pk_bf16_f32 v195, v198, v199
v_mfma_f32_16x16x32_bf16 a[208:211], a[128:131], a[80:83], a[208:211]
ds_read_b64_tr_b16 a[140:141], v11 offset:49152
v_cvt_pk_bf16_f32 v200, v200, v201
v_mfma_f32_16x16x32_bf16 a[208:211], a[132:135], a[84:87], a[208:211]
v_cvt_pk_bf16_f32 v201, v202, v203
v_cvt_pk_bf16_f32 v202, v204, v205
v_mfma_f32_16x16x32_bf16 a[216:219], a[128:131], a[88:91], a[216:219]
ds_read_b64_tr_b16 a[142:143], v11 offset:51200
v_cvt_pk_bf16_f32 v203, v206, v207
v_mfma_f32_16x16x32_bf16 a[216:219], a[132:135], a[92:95], a[216:219]
v_cvt_pk_bf16_f32 v208, v208, v209
v_cvt_pk_bf16_f32 v209, v210, v211
v_mfma_f32_16x16x32_bf16 a[224:227], a[128:131], a[96:99], a[224:227]
buffer_store_dwordx4 v[80:83], v1, s[4:7], s31 offen sc1
v_mfma_f32_16x16x32_bf16 a[224:227], a[132:135], a[100:103], a[224:227]
s_add_u32 s31, s31, s32
v_cvt_pk_bf16_f32 v210, v212, v213
v_cvt_pk_bf16_f32 v211, v214, v215
v_mfma_f32_16x16x32_bf16 a[232:235], a[128:131], a[104:107], a[232:235]
v_cvt_pk_bf16_f32 v216, v216, v217
v_cvt_pk_bf16_f32 v217, v218, v219
v_mfma_f32_16x16x32_bf16 a[232:235], a[132:135], a[108:111], a[232:235]
v_cvt_pk_bf16_f32 v218, v220, v221
v_cvt_pk_bf16_f32 v219, v222, v223
v_mfma_f32_16x16x32_bf16 a[240:243], a[128:131], a[112:115], a[240:243]
v_mfma_f32_16x16x32_bf16 a[240:243], a[132:135], a[116:119], a[240:243]
v_mfma_f32_16x16x32_bf16 a[248:251], a[128:131], a[120:123], a[248:251]
s_waitcnt vmcnt(23) lgkmcnt(0)
v_mfma_f32_16x16x32_bf16 a[248:251], a[132:135], a[124:127], a[248:251]
s_barrier
v_mfma_f32_16x16x32_bf16 a[196:199], a[136:139], a[64:67], a[196:199]
s_add_u32 m0, s29, 98304
ds_read_b64_tr_b16 a[128:129], v22 offset:0
v_mfma_f32_16x16x32_bf16 a[196:199], a[140:143], a[68:71], a[196:199]
buffer_load_dwordx4 v16, s[12:15], s26 offen offset:0 lds
v_mfma_f32_16x16x32_bf16 a[204:207], a[136:139], a[72:75], a[204:207]
ds_read_b64_tr_b16 a[130:131], v22 offset:2048
v_mfma_f32_16x16x32_bf16 a[204:207], a[140:143], a[76:79], a[204:207]
buffer_store_dwordx4 v[88:91], v1, s[4:7], s31 offen sc1
v_mfma_f32_16x16x32_bf16 a[212:215], a[136:139], a[80:83], a[212:215]
s_add_u32 s31, s31, s35
ds_read_b64_tr_b16 a[132:133], v22 offset:16384
v_mfma_f32_16x16x32_bf16 a[212:215], a[140:143], a[84:87], a[212:215]
buffer_load_dwordx4 v17, s[12:15], s26 offen offset:1024 lds
v_mfma_f32_16x16x32_bf16 a[220:223], a[136:139], a[88:91], a[220:223]
ds_read_b64_tr_b16 a[134:135], v22 offset:18432
v_add_u32 v22, 4294901760, v22
v_mfma_f32_16x16x32_bf16 a[220:223], a[140:143], a[92:95], a[220:223]
v_mfma_f32_16x16x32_bf16 a[228:231], a[136:139], a[96:99], a[228:231]
v_mfma_f32_16x16x32_bf16 a[228:231], a[140:143], a[100:103], a[228:231]
buffer_load_dwordx4 v18, s[12:15], s26 offen offset:2048 lds
v_mfma_f32_16x16x32_bf16 a[236:239], a[136:139], a[104:107], a[236:239]
v_mfma_f32_16x16x32_bf16 a[236:239], a[140:143], a[108:111], a[236:239]
v_mfma_f32_16x16x32_bf16 a[244:247], a[136:139], a[112:115], a[244:247]
v_mfma_f32_16x16x32_bf16 a[244:247], a[140:143], a[116:119], a[244:247]
buffer_load_dwordx4 v19, s[12:15], s26 offen offset:3072 lds
v_mfma_f32_16x16x32_bf16 a[252:255], a[136:139], a[120:123], a[252:255]
s_add_u32 s26, s26, 524288
v_mfma_f32_16x16x32_bf16 a[252:255], a[140:143], a[124:127], a[252:255]
s_waitcnt lgkmcnt(0)
M_Q:
v_mfma_f32_16x16x32_bf16 v[36:39], a[128:131], a[0:3], 0
s_add_u32 m0, s29, 114688
ds_read_b64_tr_b16 a[136:137], v23 offset:0
v_mfma_f32_16x16x32_bf16 v[36:39], a[132:135], a[4:7], v[36:39]
buffer_load_dwordx4 v16, s[12:15], s27 offen offset:0 lds
v_mfma_f32_16x16x32_bf16 v[44:47], a[128:131], a[8:11], 0
ds_read_b64_tr_b16 a[138:139], v23 offset:2048
v_mfma_f32_16x16x32_bf16 v[44:47], a[132:135], a[12:15], v[44:47]
ds_read_b128 a[64:67], v2 offset:16384
ds_read_b128 a[68:71], v3 offset:16384
v_mfma_f32_16x16x32_bf16 v[52:55], a[128:131], a[16:19], 0
ds_read_b64_tr_b16 a[140:141], v23 offset:16384
v_mfma_f32_16x16x32_bf16 v[52:55], a[132:135], a[20:23], v[52:55]
buffer_load_dwordx4 v17, s[12:15], s27 offen offset:1024 lds
v_mfma_f32_16x16x32_bf16 v[60:63], a[128:131], a[24:27], 0
ds_read_b64_tr_b16 a[142:143], v23 offset:18432
v_add_u32 v23, 4294901760, v23
v_mfma_f32_16x16x32_bf16 v[60:63], a[132:135], a[28:31], v[60:63]
buffer_store_dwordx4 v[96:99], v1, s[4:7], s31 offen sc1
v_mfma_f32_16x16x32_bf16 v[68:71], a[128:131], a[32:35], 0
s_add_u32 s31, s31, s32
ds_read_b128 a[72:75], v2 offset:18432
v_mfma_f32_16x16x32_bf16 v[68:71], a[132:135], a[36:39], v[68:71]
buffer_load_dwordx4 v18, s[12:15], s27 offen offset:2048 lds
v_mfma_f32_16x16x32_bf16 v[76:79], a[128:131], a[40:43], 0
ds_read_b128 a[76:79], v3 offset:18432
v_mfma_f32_16x16x32_bf16 v[76:79], a[132:135], a[44:47], v[76:79]
ds_read_b128 a[80:83], v2 offset:20480
v_mfma_f32_16x16x32_bf16 v[84:87], a[128:131], a[48:51], 0
ds_read_b128 a[84:87], v3 offset:20480
v_mfma_f32_16x16x32_bf16 v[84:87], a[132:135], a[52:55], v[84:87]
buffer_load_dwordx4 v19, s[12:15], s27 offen offset:3072 lds
v_mfma_f32_16x16x32_bf16 v[92:95], a[128:131], a[56:59], 0
s_add_u32 s27, s27, 524288
ds_read_b128 a[88:91], v2 offset:22528
v_mfma_f32_16x16x32_bf16 v[92:95], a[132:135], a[60:63], v[92:95]
s_waitcnt lgkmcnt(5)
buffer_store_dwordx4 v[104:107], v1, s[4:7], s31 offen sc1
v_mfma_f32_16x16x32_bf16 v[100:103], a[136:139], a[0:3], 0
s_add_u32 m0, s28, 0
ds_read_b64_tr_b16 a[128:129], v24 offset:0
v_mfma_f32_16x16x32_bf16 v[100:103], a[140:143], a[4:7], v[100:103]
s_add_u32 s31, s31, s33
buffer_load_dwordx4 v12, s[8:11], s24 offen offset:0 lds
v_mfma_f32_16x16x32_bf16 v[108:111], a[136:139], a[8:11], 0
ds_read_b64_tr_b16 a[130:131], v24 offset:2048
v_mfma_f32_16x16x32_bf16 v[108:111], a[140:143], a[12:15], v[108:111]
ds_read_b128 a[92:95], v3 offset:22528
v_mfma_f32_16x16x32_bf16 v[116:119], a[136:139], a[16:19], 0
ds_read_b64_tr_b16 a[132:133], v24 offset:16384
v_mfma_f32_16x16x32_bf16 v[116:119], a[140:143], a[20:23], v[116:119]
buffer_load_dwordx4 v13, s[8:11], s24 offen offset:1024 lds
v_mfma_f32_16x16x32_bf16 v[124:127], a[136:139], a[24:27], 0
ds_read_b64_tr_b16 a[134:135], v24 offset:18432
v_add_u32 v24, 4294901760, v24
v_mfma_f32_16x16x32_bf16 v[124:127], a[140:143], a[28:31], v[124:127]
v_mfma_f32_16x16x32_bf16 v[132:135], a[136:139], a[32:35], 0
ds_read_b128 a[96:99], v2 offset:24576
v_mfma_f32_16x16x32_bf16 v[132:135], a[140:143], a[36:39], v[132:135]
buffer_load_dwordx4 v14, s[8:11], s24 offen offset:2048 lds
v_mfma_f32_16x16x32_bf16 v[140:143], a[136:139], a[40:43], 0
ds_read_b128 a[100:103], v3 offset:24576
v_mfma_f32_16x16x32_bf16 v[140:143], a[140:143], a[44:47], v[140:143]
ds_read_b128 a[104:107], v2 offset:26624
v_mfma_f32_16x16x32_bf16 v[148:151], a[136:139], a[48:51], 0
ds_read_b128 a[108:111], v3 offset:26624
v_mfma_f32_16x16x32_bf16 v[148:151], a[140:143], a[52:55], v[148:151]
buffer_load_dwordx4 v15, s[8:11], s24 offen offset:3072 lds
v_mfma_f32_16x16x32_bf16 v[156:159], a[136:139], a[56:59], 0
s_add_u32 s24, s24, 128
ds_read_b128 a[112:115], v2 offset:28672
v_mfma_f32_16x16x32_bf16 v[156:159], a[140:143], a[60:63], v[156:159]
s_waitcnt lgkmcnt(5)
buffer_store_dwordx4 v[112:115], v1, s[4:7], s31 offen sc1
v_mfma_f32_16x16x32_bf16 v[164:167], a[128:131], a[0:3], 0
s_add_u32 s31, s31, s32
ds_read_b64_tr_b16 a[136:137], v25 offset:0
v_mfma_f32_16x16x32_bf16 v[164:167], a[132:135], a[4:7], v[164:167]
PAD_6:
s_cbranch_execz M_tret
v_mfma_f32_16x16x32_bf16 v[172:175], a[128:131], a[8:11], 0
ds_read_b64_tr_b16 a[138:139], v25 offset:2048
v_mfma_f32_16x16x32_bf16 v[172:175], a[132:135], a[12:15], v[172:175]
ds_read_b128 a[116:119], v3 offset:28672
v_mfma_f32_16x16x32_bf16 v[180:183], a[128:131], a[16:19], 0
ds_read_b64_tr_b16 a[140:141], v25 offset:16384
v_mfma_f32_16x16x32_bf16 v[180:183], a[132:135], a[20:23], v[180:183]
v_mfma_f32_16x16x32_bf16 v[188:191], a[128:131], a[24:27], 0
ds_read_b64_tr_b16 a[142:143], v25 offset:18432
v_add_u32 v25, 4294901760, v25
v_mfma_f32_16x16x32_bf16 v[188:191], a[132:135], a[28:31], v[188:191]
v_mfma_f32_16x16x32_bf16 v[196:199], a[128:131], a[32:35], 0
ds_read_b128 a[120:123], v2 offset:30720
v_mfma_f32_16x16x32_bf16 v[196:199], a[132:135], a[36:39], v[196:199]
v_mfma_f32_16x16x32_bf16 v[204:207], a[128:131], a[40:43], 0
ds_read_b128 a[124:127], v3 offset:30720
v_mfma_f32_16x16x32_bf16 v[204:207], a[132:135], a[44:47], v[204:207]
v_mfma_f32_16x16x32_bf16 v[212:215], a[128:131], a[48:51], 0
v_mfma_f32_16x16x32_bf16 v[212:215], a[132:135], a[52:55], v[212:215]
buffer_store_dwordx4 v[120:123], v1, s[4:7], s31 offen sc1
v_mfma_f32_16x16x32_bf16 v[220:223], a[128:131], a[56:59], 0
s_add_u32 s31, s31, s34
v_mfma_f32_16x16x32_bf16 v[220:223], a[132:135], a[60:63], v[220:223]
s_waitcnt vmcnt(28) lgkmcnt(0)
s_barrier
v_mfma_f32_16x16x32_bf16 v[224:227], a[136:139], a[0:3], 0
s_add_u32 m0, s29, 131072
ds_read_b64_tr_b16 a[128:129], v22 offset:0
v_mfma_f32_16x16x32_bf16 v[224:227], a[140:143], a[4:7], v[224:227]
buffer_load_dwordx4 v16, s[12:15], s26 offen offset:0 lds
v_mfma_f32_16x16x32_bf16 v[228:231], a[136:139], a[8:11], 0
ds_read_b64_tr_b16 a[130:131], v22 offset:2048
v_mfma_f32_16x16x32_bf16 v[228:231], a[140:143], a[12:15], v[228:231]
v_mfma_f32_16x16x32_bf16 v[232:235], a[136:139], a[16:19], 0
ds_read_b64_tr_b16 a[132:133], v22 offset:16384
v_mfma_f32_16x16x32_bf16 v[232:235], a[140:143], a[20:23], v[232:235]
buffer_load_dwordx4 v17, s[12:15], s26 offen offset:1024 lds
v_mfma_f32_16x16x32_bf16 v[236:239], a[136:139], a[24:27], 0
ds_read_b64_tr_b16 a[134:135], v22 offset:18432
v_add_u32 v22, 32768, v22
v_mfma_f32_16x16x32_bf16 v[236:239], a[140:143], a[28:31], v[236:239]
v_mfma_f32_16x16x32_bf16 v[240:243], a[136:139], a[32:35], 0
v_mfma_f32_16x16x32_bf16 v[240:243], a[140:143], a[36:39], v[240:243]
buffer_load_dwordx4 v18, s[12:15], s26 offen offset:2048 lds
v_mfma_f32_16x16x32_bf16 v[244:247], a[136:139], a[40:43], 0
v_mfma_f32_16x16x32_bf16 v[244:247], a[140:143], a[44:47], v[244:247]
v_mfma_f32_16x16x32_bf16 v[248:251], a[136:139], a[48:51], 0
v_mfma_f32_16x16x32_bf16 v[248:251], a[140:143], a[52:55], v[248:251]
buffer_load_dwordx4 v19, s[12:15], s26 offen offset:3072 lds
v_mfma_f32_16x16x32_bf16 v[252:255], a[136:139], a[56:59], 0
s_add_u32 s26, s26, 524288
v_mfma_f32_16x16x32_bf16 v[252:255], a[140:143], a[60:63], v[252:255]
s_waitcnt lgkmcnt(0)
v_mfma_f32_16x16x32_bf16 v[36:39], a[128:131], a[64:67], v[36:39]
s_add_u32 m0, s29, 147456
ds_read_b64_tr_b16 a[136:137], v23 offset:0
v_mfma_f32_16x16x32_bf16 v[36:39], a[132:135], a[68:71], v[36:39]
buffer_load_dwordx4 v16, s[12:15], s27 offen offset:0 lds
v_mfma_f32_16x16x32_bf16 v[44:47], a[128:131], a[72:75], v[44:47]
ds_read_b64_tr_b16 a[138:139], v23 offset:2048
v_mfma_f32_16x16x32_bf16 v[44:47], a[132:135], a[76:79], v[44:47]
ds_read_b128 a[0:3], v2 offset:32768
ds_read_b128 a[4:7], v3 offset:32768
v_mfma_f32_16x16x32_bf16 v[52:55], a[128:131], a[80:83], v[52:55]
ds_read_b64_tr_b16 a[140:141], v23 offset:16384
v_mfma_f32_16x16x32_bf16 v[52:55], a[132:135], a[84:87], v[52:55]
buffer_load_dwordx4 v17, s[12:15], s27 offen offset:1024 lds
v_mfma_f32_16x16x32_bf16 v[60:63], a[128:131], a[88:91], v[60:63]
ds_read_b64_tr_b16 a[142:143], v23 offset:18432
v_add_u32 v23, 32768, v23
v_mfma_f32_16x16x32_bf16 v[60:63], a[132:135], a[92:95], v[60:63]
buffer_store_dwordx4 v[128:131], v1, s[4:7], s31 offen sc1
v_mfma_f32_16x16x32_bf16 v[68:71], a[128:131], a[96:99], v[68:71]
s_add_u32 s31, s31, s32
ds_read_b128 a[8:11], v2 offset:34816
v_accvgpr_read_b32 v32, a192
v_mfma_f32_16x16x32_bf16 v[68:71], a[132:135], a[100:103], v[68:71]
buffer_load_dwordx4 v18, s[12:15], s27 offen offset:2048 lds
v_mfma_f32_16x16x32_bf16 v[76:79], a[128:131], a[104:107], v[76:79]
ds_read_b128 a[12:15], v3 offset:34816
v_accvgpr_read_b32 v33, a193
v_mfma_f32_16x16x32_bf16 v[76:79], a[132:135], a[108:111], v[76:79]
ds_read_b128 a[16:19], v2 offset:36864
v_accvgpr_read_b32 v34, a194
v_mfma_f32_16x16x32_bf16 v[84:87], a[128:131], a[112:115], v[84:87]
ds_read_b128 a[20:23], v3 offset:36864
v_accvgpr_read_b32 v35, a195
v_mfma_f32_16x16x32_bf16 v[84:87], a[132:135], a[116:119], v[84:87]
buffer_load_dwordx4 v19, s[12:15], s27 offen offset:3072 lds
v_mfma_f32_16x16x32_bf16 v[92:95], a[128:131], a[120:123], v[92:95]
s_add_u32 s27, s27, 524288
ds_read_b128 a[24:27], v2 offset:38912
v_accvgpr_read_b32 v96, a196
v_mfma_f32_16x16x32_bf16 v[92:95], a[132:135], a[124:127], v[92:95]
s_waitcnt lgkmcnt(5)
buffer_store_dwordx4 v[136:139], v1, s[4:7], s31 offen sc1
v_mfma_f32_16x16x32_bf16 v[100:103], a[136:139], a[64:67], v[100:103]
s_add_u32 m0, s28, 16384
ds_read_b64_tr_b16 a[128:129], v24 offset:0
v_accvgpr_read_b32 v97, a197
v_mfma_f32_16x16x32_bf16 v[100:103], a[140:143], a[68:71], v[100:103]
s_add_u32 s31, s31, s33
buffer_load_dwordx4 v12, s[8:11], s24 offen offset:0 lds
v_mfma_f32_16x16x32_bf16 v[108:111], a[136:139], a[72:75], v[108:111]
ds_read_b64_tr_b16 a[130:131], v24 offset:2048
v_accvgpr_read_b32 v98, a198
v_mfma_f32_16x16x32_bf16 v[108:111], a[140:143], a[76:79], v[108:111]
ds_read_b128 a[28:31], v3 offset:38912
v_accvgpr_read_b32 v99, a199
v_mfma_f32_16x16x32_bf16 v[116:119], a[136:139], a[80:83], v[116:119]
ds_read_b64_tr_b16 a[132:133], v24 offset:16384
v_cvt_pk_bf16_f32 v32, v32, v33
v_mfma_f32_16x16x32_bf16 v[116:119], a[140:143], a[84:87], v[116:119]
buffer_load_dwordx4 v13, s[8:11], s24 offen offset:1024 lds
v_mfma_f32_16x16x32_bf16 v[124:127], a[136:139], a[88:91], v[124:127]
ds_read_b64_tr_b16 a[134:135], v24 offset:18432
v_add_u32 v24, 32768, v24
v_mfma_f32_16x16x32_bf16 v[124:127], a[140:143], a[92:95], v[124:127]
v_cvt_pk_bf16_f32 v33, v34, v35
v_cvt_pk_bf16_f32 v34, v96, v97
v_mfma_f32_16x16x32_bf16 v[132:135], a[136:139], a[96:99], v[132:135]
ds_read_b128 a[32:35], v2 offset:40960
v_cvt_pk_bf16_f32 v35, v98, v99
v_mfma_f32_16x16x32_bf16 v[132:135], a[140:143], a[100:103], v[132:135]
buffer_load_dwordx4 v14, s[8:11], s24 offen offset:2048 lds
v_mfma_f32_16x16x32_bf16 v[140:143], a[136:139], a[104:107], v[140:143]
ds_read_b128 a[36:39], v3 offset:40960
v_accvgpr_read_b32 v40, a200
v_mfma_f32_16x16x32_bf16 v[140:143], a[140:143], a[108:111], v[140:143]
ds_read_b128 a[40:43], v2 offset:43008
v_accvgpr_read_b32 v41, a201
v_mfma_f32_16x16x32_bf16 v[148:151], a[136:139], a[112:115], v[148:151]
ds_read_b128 a[44:47], v3 offset:43008
v_accvgpr_read_b32 v42, a202
v_mfma_f32_16x16x32_bf16 v[148:151], a[140:143], a[116:119], v[148:151]
buffer_load_dwordx4 v15, s[8:11], s24 offen offset:3072 lds
v_mfma_f32_16x16x32_bf16 v[156:159], a[136:139], a[120:123], v[156:159]
s_add_u32 s24, s24, 128
ds_read_b128 a[48:51], v2 offset:45056
v_accvgpr_read_b32 v43, a203
v_mfma_f32_16x16x32_bf16 v[156:159], a[140:143], a[124:127], v[156:159]
s_waitcnt lgkmcnt(5)
buffer_store_dwordx4 v[144:147], v1, s[4:7], s31 offen sc1
v_mfma_f32_16x16x32_bf16 v[164:167], a[128:131], a[64:67], v[164:167]
s_add_u32 s31, s31, s32
ds_read_b64_tr_b16 a[136:137], v25 offset:0
v_accvgpr_read_b32 v96, a204
v_mfma_f32_16x16x32_bf16 v[164:167], a[132:135], a[68:71], v[164:167]
v_accvgpr_read_b32 v97, a205
v_accvgpr_read_b32 v98, a206
v_mfma_f32_16x16x32_bf16 v[172:175], a[128:131], a[72:75], v[172:175]
ds_read_b64_tr_b16 a[138:139], v25 offset:2048
v_accvgpr_read_b32 v99, a207
v_mfma_f32_16x16x32_bf16 v[172:175], a[132:135], a[76:79], v[172:175]
ds_read_b128 a[52:55], v3 offset:45056
v_cvt_pk_bf16_f32 v40, v40, v41
v_mfma_f32_16x16x32_bf16 v[180:183], a[128:131], a[80:83], v[180:183]
ds_read_b64_tr_b16 a[140:141], v25 offset:16384
v_cvt_pk_bf16_f32 v41, v42, v43
v_mfma_f32_16x16x32_bf16 v[180:183], a[132:135], a[84:87], v[180:183]
v_cvt_pk_bf16_f32 v42, v96, v97
v_cvt_pk_bf16_f32 v43, v98, v99
v_mfma_f32_16x16x32_bf16 v[188:191], a[128:131], a[88:91], v[188:191]
ds_read_b64_tr_b16 a[142:143], v25 offset:18432
v_add_u32 v25, 32768, v25
v_mfma_f32_16x16x32_bf16 v[188:191], a[132:135], a[92:95], v[188:191]
v_accvgpr_read_b32 v48, a208
v_accvgpr_read_b32 v49, a209
v_mfma_f32_16x16x32_bf16 v[196:199], a[128:131], a[96:99], v[196:199]
ds_read_b128 a[56:59], v2 offset:47104
v_accvgpr_read_b32 v50, a210
v_mfma_f32_16x16x32_bf16 v[196:199], a[132:135], a[100:103], v[196:199]
v_accvgpr_read_b32 v51, a211
v_accvgpr_read_b32 v96, a212
v_mfma_f32_16x16x32_bf16 v[204:207], a[128:131], a[104:107], v[204:207]
ds_read_b128 a[60:63], v3 offset:47104
v_accvgpr_read_b32 v97, a213
v_mfma_f32_16x16x32_bf16 v[204:207], a[132:135], a[108:111], v[204:207]
v_accvgpr_read_b32 v98, a214
v_accvgpr_read_b32 v99, a215
v_mfma_f32_16x16x32_bf16 v[212:215], a[128:131], a[112:115], v[212:215]
v_cvt_pk_bf16_f32 v48, v48, v49
v_cvt_pk_bf16_f32 v49, v50, v51
v_mfma_f32_16x16x32_bf16 v[212:215], a[132:135], a[116:119], v[212:215]
buffer_store_dwordx4 v[152:155], v1, s[4:7], s31 offen sc1
v_mfma_f32_16x16x32_bf16 v[220:223], a[128:131], a[120:123], v[220:223]
s_add_u32 s31, s31, s36
v_cvt_pk_bf16_f32 v50, v96, v97
v_cvt_pk_bf16_f32 v51, v98, v99
v_mfma_f32_16x16x32_bf16 v[220:223], a[132:135], a[124:127], v[220:223]
s_waitcnt vmcnt(23) lgkmcnt(0)
s_barrier
v_accvgpr_read_b32 v56, a216
v_mfma_f32_16x16x32_bf16 v[224:227], a[136:139], a[64:67], v[224:227]
s_add_u32 m0, s29, 65536
ds_read_b64_tr_b16 a[128:129], v22 offset:0
v_accvgpr_read_b32 v57, a217
v_mfma_f32_16x16x32_bf16 v[224:227], a[140:143], a[68:71], v[224:227]
buffer_load_dwordx4 v16, s[12:15], s26 offen offset:0 lds
v_mfma_f32_16x16x32_bf16 v[228:231], a[136:139], a[72:75], v[228:231]
ds_read_b64_tr_b16 a[130:131], v22 offset:2048
v_accvgpr_read_b32 v58, a218
v_mfma_f32_16x16x32_bf16 v[228:231], a[140:143], a[76:79], v[228:231]
v_accvgpr_read_b32 v59, a219
v_accvgpr_read_b32 v96, a220
v_mfma_f32_16x16x32_bf16 v[232:235], a[136:139], a[80:83], v[232:235]
ds_read_b64_tr_b16 a[132:133], v22 offset:16384
v_accvgpr_read_b32 v97, a221
v_mfma_f32_16x16x32_bf16 v[232:235], a[140:143], a[84:87], v[232:235]
buffer_load_dwordx4 v17, s[12:15], s26 offen offset:1024 lds
v_mfma_f32_16x16x32_bf16 v[236:239], a[136:139], a[88:91], v[236:239]
ds_read_b64_tr_b16 a[134:135], v22 offset:18432
v_add_u32 v22, 32768, v22
v_mfma_f32_16x16x32_bf16 v[236:239], a[140:143], a[92:95], v[236:239]
v_accvgpr_read_b32 v98, a222
v_accvgpr_read_b32 v99, a223
v_mfma_f32_16x16x32_bf16 v[240:243], a[136:139], a[96:99], v[240:243]
v_cvt_pk_bf16_f32 v56, v56, v57
v_cvt_pk_bf16_f32 v57, v58, v59
v_mfma_f32_16x16x32_bf16 v[240:243], a[140:143], a[100:103], v[240:243]
buffer_load_dwordx4 v18, s[12:15], s26 offen offset:2048 lds
v_mfma_f32_16x16x32_bf16 v[244:247], a[136:139], a[104:107], v[244:247]
v_cvt_pk_bf16_f32 v58, v96, v97
v_cvt_pk_bf16_f32 v59, v98, v99
v_mfma_f32_16x16x32_bf16 v[244:247], a[140:143], a[108:111], v[244:247]
v_accvgpr_read_b32 v64, a224
v_accvgpr_read_b32 v65, a225
v_mfma_f32_16x16x32_bf16 v[248:251], a[136:139], a[112:115], v[248:251]
v_accvgpr_read_b32 v66, a226
v_accvgpr_read_b32 v67, a227
v_mfma_f32_16x16x32_bf16 v[248:251], a[140:143], a[116:119], v[248:251]
buffer_load_dwordx4 v19, s[12:15], s26 offen offset:3072 lds
v_mfma_f32_16x16x32_bf16 v[252:255], a[136:139], a[120:123], v[252:255]
s_add_u32 s26, s26, 524288
v_accvgpr_read_b32 v96, a228
v_accvgpr_read_b32 v97, a229
v_mfma_f32_16x16x32_bf16 v[252:255], a[140:143], a[124:127], v[252:255]
s_waitcnt lgkmcnt(0)
v_accvgpr_read_b32 v98, a230
v_accvgpr_read_b32 v99, a231
v_mfma_f32_16x16x32_bf16 v[36:39], a[128:131], a[0:3], v[36:39]
s_add_u32 m0, s29, 81920
ds_read_b64_tr_b16 a[136:137], v23 offset:0
v_cvt_pk_bf16_f32 v64, v64, v65
v_mfma_f32_16x16x32_bf16 v[36:39], a[132:135], a[4:7], v[36:39]
buffer_load_dwordx4 v16, s[12:15], s27 offen offset:0 lds
v_mfma_f32_16x16x32_bf16 v[44:47], a[128:131], a[8:11], v[44:47]
ds_read_b64_tr_b16 a[138:139], v23 offset:2048
v_cvt_pk_bf16_f32 v65, v66, v67
v_mfma_f32_16x16x32_bf16 v[44:47], a[132:135], a[12:15], v[44:47]
ds_read_b128 a[64:67], v2 offset:49152
ds_read_b128 a[68:71], v3 offset:49152
v_mfma_f32_16x16x32_bf16 v[52:55], a[128:131], a[16:19], v[52:55]
ds_read_b64_tr_b16 a[140:141], v23 offset:16384
v_cvt_pk_bf16_f32 v66, v96, v97
v_mfma_f32_16x16x32_bf16 v[52:55], a[132:135], a[20:23], v[52:55]
buffer_load_dwordx4 v17, s[12:15], s27 offen offset:1024 lds
v_mfma_f32_16x16x32_bf16 v[60:63], a[128:131], a[24:27], v[60:63]
ds_read_b64_tr_b16 a[142:143], v23 offset:18432
v_add_u32 v23, 32768, v23
v_mfma_f32_16x16x32_bf16 v[60:63], a[132:135], a[28:31], v[60:63]
buffer_store_dwordx4 v[160:163], v1, s[4:7], s31 offen sc1
v_mfma_f32_16x16x32_bf16 v[68:71], a[128:131], a[32:35], v[68:71]
s_add_u32 s31, s31, s32
ds_read_b128 a[72:75], v2 offset:51200
v_cvt_pk_bf16_f32 v67, v98, v99
v_mfma_f32_16x16x32_bf16 v[68:71], a[132:135], a[36:39], v[68:71]
buffer_load_dwordx4 v18, s[12:15], s27 offen offset:2048 lds
v_mfma_f32_16x16x32_bf16 v[76:79], a[128:131], a[40:43], v[76:79]
ds_read_b128 a[76:79], v3 offset:51200
v_accvgpr_read_b32 v72, a232
v_mfma_f32_16x16x32_bf16 v[76:79], a[132:135], a[44:47], v[76:79]
ds_read_b128 a[80:83], v2 offset:53248
v_accvgpr_read_b32 v73, a233
v_mfma_f32_16x16x32_bf16 v[84:87], a[128:131], a[48:51], v[84:87]
ds_read_b128 a[84:87], v3 offset:53248
v_accvgpr_read_b32 v74, a234
v_mfma_f32_16x16x32_bf16 v[84:87], a[132:135], a[52:55], v[84:87]
buffer_load_dwordx4 v19, s[12:15], s27 offen offset:3072 lds
v_mfma_f32_16x16x32_bf16 v[92:95], a[128:131], a[56:59], v[92:95]
s_add_u32 s27, s27, 524288
ds_read_b128 a[88:91], v2 offset:55296
v_accvgpr_read_b32 v75, a235
v_mfma_f32_16x16x32_bf16 v[92:95], a[132:135], a[60:63], v[92:95]
s_waitcnt lgkmcnt(5)
buffer_store_dwordx4 v[168:171], v1, s[4:7], s31 offen sc1
v_mfma_f32_16x16x32_bf16 v[100:103], a[136:139], a[0:3], v[100:103]
s_add_u32 m0, s28, 32768
ds_read_b64_tr_b16 a[128:129], v24 offset:0
v_accvgpr_read_b32 v96, a236
v_mfma_f32_16x16x32_bf16 v[100:103], a[140:143], a[4:7], v[100:103]
s_add_u32 s31, s31, s33
buffer_load_dwordx4 v12, s[8:11], s24 offen offset:0 lds
v_mfma_f32_16x16x32_bf16 v[108:111], a[136:139], a[8:11], v[108:111]
ds_read_b64_tr_b16 a[130:131], v24 offset:2048
v_accvgpr_read_b32 v97, a237
v_mfma_f32_16x16x32_bf16 v[108:111], a[140:143], a[12:15], v[108:111]
ds_read_b128 a[92:95], v3 offset:55296
v_accvgpr_read_b32 v98, a238
v_mfma_f32_16x16x32_bf16 v[116:119], a[136:139], a[16:19], v[116:119]
ds_read_b64_tr_b16 a[132:133], v24 offset:16384
v_accvgpr_read_b32 v99, a239
v_mfma_f32_16x16x32_bf16 v[116:119], a[140:143], a[20:23], v[116:119]
buffer_load_dwordx4 v13, s[8:11], s24 offen offset:1024 lds
v_mfma_f32_16x16x32_bf16 v[124:127], a[136:139], a[24:27], v[124:127]
ds_read_b64_tr_b16 a[134:135], v24 offset:18432
v_add_u32 v24, 32768, v24
v_mfma_f32_16x16x32_bf16 v[124:127], a[140:143], a[28:31], v[124:127]
v_cvt_pk_bf16_f32 v72, v72, v73
v_cvt_pk_bf16_f32 v73, v74, v75
v_mfma_f32_16x16x32_bf16 v[132:135], a[136:139], a[32:35], v[132:135]
ds_read_b128 a[96:99], v2 offset:57344
v_cvt_pk_bf16_f32 v74, v96, v97
v_mfma_f32_16x16x32_bf16 v[132:135], a[140:143], a[36:39], v[132:135]
buffer_load_dwordx4 v14, s[8:11], s24 offen offset:2048 lds
v_mfma_f32_16x16x32_bf16 v[140:143], a[136:139], a[40:43], v[140:143]
ds_read_b128 a[100:103], v3 offset:57344
v_cvt_pk_bf16_f32 v75, v98, v99
v_mfma_f32_16x16x32_bf16 v[140:143], a[140:143], a[44:47], v[140:143]
ds_read_b128 a[104:107], v2 offset:59392
v_accvgpr_read_b32 v80, a240
v_mfma_f32_16x16x32_bf16 v[148:151], a[136:139], a[48:51], v[148:151]
ds_read_b128 a[108:111], v3 offset:59392
v_accvgpr_read_b32 v81, a241
v_mfma_f32_16x16x32_bf16 v[148:151], a[140:143], a[52:55], v[148:151]
buffer_load_dwordx4 v15, s[8:11], s24 offen offset:3072 lds
v_mfma_f32_16x16x32_bf16 v[156:159], a[136:139], a[56:59], v[156:159]
s_add_u32 s24, s24, 128
ds_read_b128 a[112:115], v2 offset:61440
v_accvgpr_read_b32 v82, a242
v_mfma_f32_16x16x32_bf16 v[156:159], a[140:143], a[60:63], v[156:159]
s_waitcnt lgkmcnt(5)
buffer_store_dwordx4 v[176:179], v1, s[4:7], s31 offen sc1
v_mfma_f32_16x16x32_bf16 v[164:167], a[128:131], a[0:3], v[164:167]
s_add_u32 s31, s31, s32
ds_read_b64_tr_b16 a[136:137], v25 offset:0
v_accvgpr_read_b32 v83, a243
v_mfma_f32_16x16x32_bf16 v[164:167], a[132:135], a[4:7], v[164:167]
v_accvgpr_read_b32 v96, a244
v_accvgpr_read_b32 v97, a245
v_mfma_f32_16x16x32_bf16 v[172:175], a[128:131], a[8:11], v[172:175]
ds_read_b64_tr_b16 a[138:139], v25 offset:2048
v_accvgpr_read_b32 v98, a246
v_mfma_f32_16x16x32_bf16 v[172:175], a[132:135], a[12:15], v[172:175]
ds_read_b128 a[116:119], v3 offset:61440
v_accvgpr_read_b32 v99, a247
v_mfma_f32_16x16x32_bf16 v[180:183], a[128:131], a[16:19], v[180:183]
ds_read_b64_tr_b16 a[140:141], v25 offset:16384
v_cvt_pk_bf16_f32 v80, v80, v81
v_mfma_f32_16x16x32_bf16 v[180:183], a[132:135], a[20:23], v[180:183]
buffer_store_dwordx4 v[184:187], v1, s[4:7], s31 offen sc1
v_mfma_f32_16x16x32_bf16 v[188:191], a[128:131], a[24:27], v[188:191]
s_add_u32 s31, s31, s34
ds_read_b64_tr_b16 a[142:143], v25 offset:18432
v_add_u32 v25, 32768, v25
v_mfma_f32_16x16x32_bf16 v[188:191], a[132:135], a[28:31], v[188:191]
v_cvt_pk_bf16_f32 v81, v82, v83
v_cvt_pk_bf16_f32 v82, v96, v97
v_mfma_f32_16x16x32_bf16 v[196:199], a[128:131], a[32:35], v[196:199]
ds_read_b128 a[120:123], v2 offset:63488
v_cvt_pk_bf16_f32 v83, v98, v99
v_mfma_f32_16x16x32_bf16 v[196:199], a[132:135], a[36:39], v[196:199]
v_accvgpr_read_b32 v88, a248
v_accvgpr_read_b32 v89, a249
v_mfma_f32_16x16x32_bf16 v[204:207], a[128:131], a[40:43], v[204:207]
ds_read_b128 a[124:127], v3 offset:63488
v_accvgpr_read_b32 v90, a250
v_mfma_f32_16x16x32_bf16 v[204:207], a[132:135], a[44:47], v[204:207]
v_accvgpr_read_b32 v91, a251
v_accvgpr_read_b32 v96, a252
v_mfma_f32_16x16x32_bf16 v[212:215], a[128:131], a[48:51], v[212:215]
v_accvgpr_read_b32 v97, a253
v_accvgpr_read_b32 v98, a254
v_mfma_f32_16x16x32_bf16 v[212:215], a[132:135], a[52:55], v[212:215]
v_accvgpr_read_b32 v99, a255
v_cvt_pk_bf16_f32 v88, v88, v89
v_mfma_f32_16x16x32_bf16 v[220:223], a[128:131], a[56:59], v[220:223]
v_cvt_pk_bf16_f32 v89, v90, v91
v_cvt_pk_bf16_f32 v90, v96, v97
v_mfma_f32_16x16x32_bf16 v[220:223], a[132:135], a[60:63], v[220:223]
s_waitcnt vmcnt(23) lgkmcnt(0)
s_barrier
v_cvt_pk_bf16_f32 v91, v98, v99
v_mfma_f32_16x16x32_bf16 v[224:227], a[136:139], a[0:3], v[224:227]
s_add_u32 m0, s29, 98304
ds_read_b64_tr_b16 a[128:129], v22 offset:0
v_mfma_f32_16x16x32_bf16 v[224:227], a[140:143], a[4:7], v[224:227]
buffer_load_dwordx4 v16, s[12:15], s26 offen offset:0 lds
v_mfma_f32_16x16x32_bf16 v[228:231], a[136:139], a[8:11], v[228:231]
ds_read_b64_tr_b16 a[130:131], v22 offset:2048
v_mfma_f32_16x16x32_bf16 v[228:231], a[140:143], a[12:15], v[228:231]
buffer_store_dwordx4 v[192:195], v1, s[4:7], s31 offen sc1
v_mfma_f32_16x16x32_bf16 v[232:235], a[136:139], a[16:19], v[232:235]
s_add_u32 s31, s31, s32
ds_read_b64_tr_b16 a[132:133], v22 offset:16384
v_mfma_f32_16x16x32_bf16 v[232:235], a[140:143], a[20:23], v[232:235]
buffer_load_dwordx4 v17, s[12:15], s26 offen offset:1024 lds
v_mfma_f32_16x16x32_bf16 v[236:239], a[136:139], a[24:27], v[236:239]
ds_read_b64_tr_b16 a[134:135], v22 offset:18432
v_add_u32 v22, 4294901760, v22
v_mfma_f32_16x16x32_bf16 v[236:239], a[140:143], a[28:31], v[236:239]
v_mfma_f32_16x16x32_bf16 v[240:243], a[136:139], a[32:35], v[240:243]
v_mfma_f32_16x16x32_bf16 v[240:243], a[140:143], a[36:39], v[240:243]
buffer_load_dwordx4 v18, s[12:15], s26 offen offset:2048 lds
v_mfma_f32_16x16x32_bf16 v[244:247], a[136:139], a[40:43], v[244:247]
v_mfma_f32_16x16x32_bf16 v[244:247], a[140:143], a[44:47], v[244:247]
v_mfma_f32_16x16x32_bf16 v[248:251], a[136:139], a[48:51], v[248:251]
v_mfma_f32_16x16x32_bf16 v[248:251], a[140:143], a[52:55], v[248:251]
buffer_load_dwordx4 v19, s[12:15], s26 offen offset:3072 lds
v_mfma_f32_16x16x32_bf16 v[252:255], a[136:139], a[56:59], v[252:255]
s_add_u32 s26, s26, 524288
v_mfma_f32_16x16x32_bf16 v[252:255], a[140:143], a[60:63], v[252:255]
s_waitcnt lgkmcnt(0)
v_mfma_f32_16x16x32_bf16 v[36:39], a[128:131], a[64:67], v[36:39]
s_add_u32 m0, s29, 114688
ds_read_b64_tr_b16 a[136:137], v23 offset:0
v_mfma_f32_16x16x32_bf16 v[36:39], a[132:135], a[68:71], v[36:39]
buffer_load_dwordx4 v16, s[12:15], s27 offen offset:0 lds
v_mfma_f32_16x16x32_bf16 v[44:47], a[128:131], a[72:75], v[44:47]
ds_read_b64_tr_b16 a[138:139], v23 offset:2048
v_mfma_f32_16x16x32_bf16 v[44:47], a[132:135], a[76:79], v[44:47]
ds_read_b128 a[0:3], v2 offset:0
ds_read_b128 a[4:7], v3 offset:0
v_mfma_f32_16x16x32_bf16 v[52:55], a[128:131], a[80:83], v[52:55]
ds_read_b64_tr_b16 a[140:141], v23 offset:16384
v_mfma_f32_16x16x32_bf16 v[52:55], a[132:135], a[84:87], v[52:55]
buffer_load_dwordx4 v17, s[12:15], s27 offen offset:1024 lds
v_mfma_f32_16x16x32_bf16 v[60:63], a[128:131], a[88:91], v[60:63]
ds_read_b64_tr_b16 a[142:143], v23 offset:18432
v_add_u32 v23, 4294901760, v23
v_mfma_f32_16x16x32_bf16 v[60:63], a[132:135], a[92:95], v[60:63]
buffer_store_dwordx4 v[200:203], v1, s[4:7], s31 offen sc1
v_mfma_f32_16x16x32_bf16 v[68:71], a[128:131], a[96:99], v[68:71]
s_add_u32 s31, s31, s33
ds_read_b128 a[8:11], v2 offset:2048
v_mfma_f32_16x16x32_bf16 v[68:71], a[132:135], a[100:103], v[68:71]
buffer_load_dwordx4 v18, s[12:15], s27 offen offset:2048 lds
v_mfma_f32_16x16x32_bf16 v[76:79], a[128:131], a[104:107], v[76:79]
ds_read_b128 a[12:15], v3 offset:2048
v_mfma_f32_16x16x32_bf16 v[76:79], a[132:135], a[108:111], v[76:79]
ds_read_b128 a[16:19], v2 offset:4096
v_mfma_f32_16x16x32_bf16 v[84:87], a[128:131], a[112:115], v[84:87]
ds_read_b128 a[20:23], v3 offset:4096
v_mfma_f32_16x16x32_bf16 v[84:87], a[132:135], a[116:119], v[84:87]
buffer_load_dwordx4 v19, s[12:15], s27 offen offset:3072 lds
v_mfma_f32_16x16x32_bf16 v[92:95], a[128:131], a[120:123], v[92:95]
s_add_u32 s27, s27, 524288
ds_read_b128 a[24:27], v2 offset:6144
v_mfma_f32_16x16x32_bf16 v[92:95], a[132:135], a[124:127], v[92:95]
s_waitcnt lgkmcnt(5)
buffer_store_dwordx4 v[208:211], v1, s[4:7], s31 offen sc1
v_mfma_f32_16x16x32_bf16 v[100:103], a[136:139], a[64:67], v[100:103]
s_add_u32 s31, s31, s32
ds_read_b64_tr_b16 a[128:129], v24 offset:0
v_mfma_f32_16x16x32_bf16 v[100:103], a[140:143], a[68:71], v[100:103]
v_mfma_f32_16x16x32_bf16 v[108:111], a[136:139], a[72:75], v[108:111]
ds_read_b64_tr_b16 a[130:131], v24 offset:2048
v_mfma_f32_16x16x32_bf16 v[108:111], a[140:143], a[76:79], v[108:111]
ds_read_b128 a[28:31], v3 offset:6144
v_mfma_f32_16x16x32_bf16 v[116:119], a[136:139], a[80:83], v[116:119]
ds_read_b64_tr_b16 a[132:133], v24 offset:16384
v_mfma_f32_16x16x32_bf16 v[116:119], a[140:143], a[84:87], v[116:119]
v_mfma_f32_16x16x32_bf16 v[124:127], a[136:139], a[88:91], v[124:127]
ds_read_b64_tr_b16 a[134:135], v24 offset:18432
v_add_u32 v24, 4294901760, v24
v_mfma_f32_16x16x32_bf16 v[124:127], a[140:143], a[92:95], v[124:127]
v_mfma_f32_16x16x32_bf16 v[132:135], a[136:139], a[96:99], v[132:135]
ds_read_b128 a[32:35], v2 offset:8192
v_mfma_f32_16x16x32_bf16 v[132:135], a[140:143], a[100:103], v[132:135]
buffer_store_dwordx4 v[216:219], v1, s[4:7], s31 offen sc1
v_mfma_f32_16x16x32_bf16 v[140:143], a[136:139], a[104:107], v[140:143]
s_add_u32 s31, s31, s35
ds_read_b128 a[36:39], v3 offset:8192
v_mfma_f32_16x16x32_bf16 v[140:143], a[140:143], a[108:111], v[140:143]
ds_read_b128 a[40:43], v2 offset:10240
v_mfma_f32_16x16x32_bf16 v[148:151], a[136:139], a[112:115], v[148:151]
ds_read_b128 a[44:47], v3 offset:10240
v_mfma_f32_16x16x32_bf16 v[148:151], a[140:143], a[116:119], v[148:151]
v_mfma_f32_16x16x32_bf16 v[156:159], a[136:139], a[120:123], v[156:159]
ds_read_b128 a[48:51], v2 offset:12288
v_mfma_f32_16x16x32_bf16 v[156:159], a[140:143], a[124:127], v[156:159]
s_waitcnt lgkmcnt(5)
v_mfma_f32_16x16x32_bf16 v[164:167], a[128:131], a[64:67], v[164:167]
ds_read_b64_tr_b16 a[136:137], v25 offset:0
v_mfma_f32_16x16x32_bf16 v[164:167], a[132:135], a[68:71], v[164:167]
v_mfma_f32_16x16x32_bf16 v[172:175], a[128:131], a[72:75], v[172:175]
ds_read_b64_tr_b16 a[138:139], v25 offset:2048
v_mfma_f32_16x16x32_bf16 v[172:175], a[132:135], a[76:79], v[172:175]
ds_read_b128 a[52:55], v3 offset:12288
v_mfma_f32_16x16x32_bf16 v[180:183], a[128:131], a[80:83], v[180:183]
ds_read_b64_tr_b16 a[140:141], v25 offset:16384
v_mfma_f32_16x16x32_bf16 v[180:183], a[132:135], a[84:87], v[180:183]
buffer_store_dwordx4 v[32:35], v1, s[4:7], s31 offen sc1
v_mfma_f32_16x16x32_bf16 v[188:191], a[128:131], a[88:91], v[188:191]
s_add_u32 s31, s31, s32
ds_read_b64_tr_b16 a[142:143], v25 offset:18432
v_add_u32 v25, 4294901760, v25
v_mfma_f32_16x16x32_bf16 v[188:191], a[132:135], a[92:95], v[188:191]
v_mfma_f32_16x16x32_bf16 v[196:199], a[128:131], a[96:99], v[196:199]
ds_read_b128 a[56:59], v2 offset:14336
v_mfma_f32_16x16x32_bf16 v[196:199], a[132:135], a[100:103], v[196:199]
v_mfma_f32_16x16x32_bf16 v[204:207], a[128:131], a[104:107], v[204:207]
ds_read_b128 a[60:63], v3 offset:14336
v_mfma_f32_16x16x32_bf16 v[204:207], a[132:135], a[108:111], v[204:207]
v_mfma_f32_16x16x32_bf16 v[212:215], a[128:131], a[112:115], v[212:215]
v_mfma_f32_16x16x32_bf16 v[212:215], a[132:135], a[116:119], v[212:215]
v_mfma_f32_16x16x32_bf16 v[220:223], a[128:131], a[120:123], v[220:223]
v_mfma_f32_16x16x32_bf16 v[220:223], a[132:135], a[124:127], v[220:223]
s_waitcnt vmcnt(20) lgkmcnt(0)
s_barrier
v_mfma_f32_16x16x32_bf16 v[224:227], a[136:139], a[64:67], v[224:227]
s_add_u32 m0, s29, 131072
ds_read_b64_tr_b16 a[128:129], v22 offset:0
v_mfma_f32_16x16x32_bf16 v[224:227], a[140:143], a[68:71], v[224:227]
buffer_load_dwordx4 v16, s[12:15], s26 offen offset:0 lds
v_mfma_f32_16x16x32_bf16 v[228:231], a[136:139], a[72:75], v[228:231]
ds_read_b64_tr_b16 a[130:131], v22 offset:2048
v_mfma_f32_16x16x32_bf16 v[228:231], a[140:143], a[76:79], v[228:231]
buffer_store_dwordx4 v[40:43], v1, s[4:7], s31 offen sc1
v_mfma_f32_16x16x32_bf16 v[232:235], a[136:139], a[80:83], v[232:235]
s_add_u32 s31, s31, s33
ds_read_b64_tr_b16 a[132:133], v22 offset:16384
v_mfma_f32_16x16x32_bf16 v[232:235], a[140:143], a[84:87], v[232:235]
buffer_load_dwordx4 v17, s[12:15], s26 offen offset:1024 lds
v_mfma_f32_16x16x32_bf16 v[236:239], a[136:139], a[88:91], v[236:239]
ds_read_b64_tr_b16 a[134:135], v22 offset:18432
v_add_u32 v22, 32768, v22
v_mfma_f32_16x16x32_bf16 v[236:239], a[140:143], a[92:95], v[236:239]
PAD_7:
s_cbranch_execz M_tret
v_mfma_f32_16x16x32_bf16 v[240:243], a[136:139], a[96:99], v[240:243]
v_mfma_f32_16x16x32_bf16 v[240:243], a[140:143], a[100:103], v[240:243]
buffer_load_dwordx4 v18, s[12:15], s26 offen offset:2048 lds
v_mfma_f32_16x16x32_bf16 v[244:247], a[136:139], a[104:107], v[244:247]
v_mfma_f32_16x16x32_bf16 v[244:247], a[140:143], a[108:111], v[244:247]
v_mfma_f32_16x16x32_bf16 v[248:251], a[136:139], a[112:115], v[248:251]
v_mfma_f32_16x16x32_bf16 v[248:251], a[140:143], a[116:119], v[248:251]
buffer_load_dwordx4 v19, s[12:15], s26 offen offset:3072 lds
v_mfma_f32_16x16x32_bf16 v[252:255], a[136:139], a[120:123], v[252:255]
s_add_u32 s26, s26, 524288
v_mfma_f32_16x16x32_bf16 v[252:255], a[140:143], a[124:127], v[252:255]
s_waitcnt lgkmcnt(0)
v_mfma_f32_16x16x32_bf16 v[36:39], a[128:131], a[0:3], v[36:39]
s_add_u32 m0, s29, 147456
ds_read_b64_tr_b16 a[136:137], v23 offset:0
v_mfma_f32_16x16x32_bf16 v[36:39], a[132:135], a[4:7], v[36:39]
buffer_load_dwordx4 v16, s[12:15], s27 offen offset:0 lds
v_mfma_f32_16x16x32_bf16 v[44:47], a[128:131], a[8:11], v[44:47]
s_lshl_b32 s22, s20, 7
ds_read_b64_tr_b16 a[138:139], v23 offset:2048
v_bfe_u32 v20, v1, 4, 3
v_mfma_f32_16x16x32_bf16 v[44:47], a[132:135], a[12:15], v[44:47]
s_add_u32 s70, s22, 94371840
ds_read_b128 a[64:67], v2 offset:16384
ds_read_b128 a[68:71], v3 offset:16384
v_mfma_f32_16x16x32_bf16 v[52:55], a[128:131], a[16:19], v[52:55]
s_lshr_b32 s22, s2, 4
ds_read_b64_tr_b16 a[140:141], v23 offset:16384
v_lshlrev_b32 v20, 3, v20
v_mfma_f32_16x16x32_bf16 v[52:55], a[132:135], a[20:23], v[52:55]
s_lshl_b32 s22, s22, 2
buffer_load_dwordx4 v17, s[12:15], s27 offen offset:1024 lds
v_mfma_f32_16x16x32_bf16 v[60:63], a[128:131], a[24:27], v[60:63]
s_add_u32 s66, s70, s22
ds_read_b64_tr_b16 a[142:143], v23 offset:18432
v_add_u32 v23, 32768, v23
v_mfma_f32_16x16x32_bf16 v[60:63], a[132:135], a[28:31], v[60:63]
s_and_b32 s22, s2, 16
buffer_store_dwordx4 v[48:51], v1, s[4:7], s31 offen sc1
v_mfma_f32_16x16x32_bf16 v[68:71], a[128:131], a[32:35], v[68:71]
s_add_u32 s31, s31, s32
ds_read_b128 a[72:75], v2 offset:18432
v_add_u32 v15, 2052, v20
v_mfma_f32_16x16x32_bf16 v[68:71], a[132:135], a[36:39], v[68:71]
s_lshl_b32 s22, s22, 7
buffer_load_dwordx4 v18, s[12:15], s27 offen offset:2048 lds
v_mfma_f32_16x16x32_bf16 v[76:79], a[128:131], a[40:43], v[76:79]
s_add_u32 s66, s66, s22
ds_read_b128 a[76:79], v3 offset:18432
v_mfma_f32_16x16x32_bf16 v[76:79], a[132:135], a[44:47], v[76:79]
s_lshl_b32 s67, s20, 20
ds_read_b128 a[80:83], v2 offset:20480
v_mfma_f32_16x16x32_bf16 v[84:87], a[128:131], a[48:51], v[84:87]
s_lshl_b32 s22, s37, 16
ds_read_b128 a[84:87], v3 offset:20480
v_mfma_f32_16x16x32_bf16 v[84:87], a[132:135], a[52:55], v[84:87]
s_add_u32 s67, s67, s22
buffer_load_dwordx4 v19, s[12:15], s27 offen offset:3072 lds
v_mfma_f32_16x16x32_bf16 v[92:95], a[128:131], a[56:59], v[92:95]
s_waitcnt lgkmcnt(5)
s_add_u32 s27, s27, 524288
ds_read_b128 a[88:91], v2 offset:22528
v_mfma_f32_16x16x32_bf16 v[92:95], a[132:135], a[60:63], v[92:95]
s_lshl_b32 s22, s3, 11
buffer_store_dwordx4 v[56:59], v1, s[4:7], s31 offen sc1
v_mfma_f32_16x16x32_bf16 v[100:103], a[136:139], a[0:3], v[100:103]
s_waitcnt lgkmcnt(5)
s_add_u32 s31, s31, s34
ds_read_b64_tr_b16 a[128:129], v24 offset:0
v_mfma_f32_16x16x32_bf16 v[100:103], a[140:143], a[4:7], v[100:103]
s_add_u32 s67, s67, s22
v_mfma_f32_16x16x32_bf16 v[108:111], a[136:139], a[8:11], v[108:111]
s_add_u32 s67, s67, 33554432
ds_read_b64_tr_b16 a[130:131], v24 offset:2048
v_mfma_f32_16x16x32_bf16 v[108:111], a[140:143], a[12:15], v[108:111]
s_mov_b32 s68, 1035512379
ds_read_b128 a[92:95], v3 offset:22528
v_mfma_f32_16x16x32_bf16 v[116:119], a[136:139], a[16:19], v[116:119]
s_mov_b32 s69, 1035512379
ds_read_b64_tr_b16 a[132:133], v24 offset:16384
v_mfma_f32_16x16x32_bf16 v[116:119], a[140:143], a[20:23], v[116:119]
buffer_store_dwordx4 v[64:67], v1, s[4:7], s31 offen sc1
v_mfma_f32_16x16x32_bf16 v[124:127], a[136:139], a[24:27], v[124:127]
s_add_u32 s31, s31, s32
ds_read_b64_tr_b16 a[134:135], v24 offset:18432
v_add_u32 v24, 32768, v24
v_mfma_f32_16x16x32_bf16 v[124:127], a[140:143], a[28:31], v[124:127]
v_mfma_f32_16x16x32_bf16 v[132:135], a[136:139], a[32:35], v[132:135]
ds_read_b128 a[96:99], v2 offset:24576
v_mfma_f32_16x16x32_bf16 v[132:135], a[140:143], a[36:39], v[132:135]
v_mfma_f32_16x16x32_bf16 v[140:143], a[136:139], a[40:43], v[140:143]
ds_read_b128 a[100:103], v3 offset:24576
v_mfma_f32_16x16x32_bf16 v[140:143], a[140:143], a[44:47], v[140:143]
ds_read_b128 a[104:107], v2 offset:26624
v_mfma_f32_16x16x32_bf16 v[148:151], a[136:139], a[48:51], v[148:151]
ds_read_b128 a[108:111], v3 offset:26624
v_mfma_f32_16x16x32_bf16 v[148:151], a[140:143], a[52:55], v[148:151]
v_mfma_f32_16x16x32_bf16 v[156:159], a[136:139], a[56:59], v[156:159]
ds_read_b128 a[112:115], v2 offset:28672
v_mfma_f32_16x16x32_bf16 v[156:159], a[140:143], a[60:63], v[156:159]
s_waitcnt lgkmcnt(5)
buffer_store_dwordx4 v[72:75], v1, s[4:7], s31 offen sc1
v_mfma_f32_16x16x32_bf16 v[164:167], a[128:131], a[0:3], v[164:167]
s_add_u32 s31, s31, s33
ds_read_b64_tr_b16 a[136:137], v25 offset:0
v_mfma_f32_16x16x32_bf16 v[164:167], a[132:135], a[4:7], v[164:167]
v_mfma_f32_16x16x32_bf16 v[172:175], a[128:131], a[8:11], v[172:175]
ds_read_b64_tr_b16 a[138:139], v25 offset:2048
v_mfma_f32_16x16x32_bf16 v[172:175], a[132:135], a[12:15], v[172:175]
ds_read_b128 a[116:119], v3 offset:28672
v_mfma_f32_16x16x32_bf16 v[180:183], a[128:131], a[16:19], v[180:183]
ds_read_b64_tr_b16 a[140:141], v25 offset:16384
v_mfma_f32_16x16x32_bf16 v[180:183], a[132:135], a[20:23], v[180:183]
v_mfma_f32_16x16x32_bf16 v[188:191], a[128:131], a[24:27], v[188:191]
ds_read_b64_tr_b16 a[142:143], v25 offset:18432
v_add_u32 v25, 32768, v25
v_mfma_f32_16x16x32_bf16 v[188:191], a[132:135], a[28:31], v[188:191]
v_mfma_f32_16x16x32_bf16 v[196:199], a[128:131], a[32:35], v[196:199]
ds_read_b128 a[120:123], v2 offset:30720
v_mfma_f32_16x16x32_bf16 v[196:199], a[132:135], a[36:39], v[196:199]
buffer_store_dwordx4 v[80:83], v1, s[4:7], s31 offen sc1
v_mfma_f32_16x16x32_bf16 v[204:207], a[128:131], a[40:43], v[204:207]
s_add_u32 s31, s31, s32
ds_read_b128 a[124:127], v3 offset:30720
v_mfma_f32_16x16x32_bf16 v[204:207], a[132:135], a[44:47], v[204:207]
v_mfma_f32_16x16x32_bf16 v[212:215], a[128:131], a[48:51], v[212:215]
v_mfma_f32_16x16x32_bf16 v[212:215], a[132:135], a[52:55], v[212:215]
v_mfma_f32_16x16x32_bf16 v[220:223], a[128:131], a[56:59], v[220:223]
v_mfma_f32_16x16x32_bf16 v[220:223], a[132:135], a[60:63], v[220:223]
s_waitcnt vmcnt(17) lgkmcnt(0)
s_barrier
v_mfma_f32_16x16x32_bf16 v[224:227], a[136:139], a[0:3], v[224:227]
ds_read_b64_tr_b16 a[128:129], v22 offset:0
v_mfma_f32_16x16x32_bf16 v[224:227], a[140:143], a[4:7], v[224:227]
v_mfma_f32_16x16x32_bf16 v[228:231], a[136:139], a[8:11], v[228:231]
ds_read_b64_tr_b16 a[130:131], v22 offset:2048
v_mfma_f32_16x16x32_bf16 v[228:231], a[140:143], a[12:15], v[228:231]
buffer_store_dwordx4 v[88:91], v1, s[4:7], s31 offen sc1
v_mfma_f32_16x16x32_bf16 v[232:235], a[136:139], a[16:19], v[232:235]
ds_read_b64_tr_b16 a[132:133], v22 offset:16384
v_mfma_f32_16x16x32_bf16 v[232:235], a[140:143], a[20:23], v[232:235]
v_mfma_f32_16x16x32_bf16 v[236:239], a[136:139], a[24:27], v[236:239]
ds_read_b64_tr_b16 a[134:135], v22 offset:18432
v_add_u32 v22, 32768, v22
v_mfma_f32_16x16x32_bf16 v[236:239], a[140:143], a[28:31], v[236:239]
v_mfma_f32_16x16x32_bf16 v[240:243], a[136:139], a[32:35], v[240:243]
v_mfma_f32_16x16x32_bf16 v[240:243], a[140:143], a[36:39], v[240:243]
v_mfma_f32_16x16x32_bf16 v[244:247], a[136:139], a[40:43], v[244:247]
v_mfma_f32_16x16x32_bf16 v[244:247], a[140:143], a[44:47], v[244:247]
v_mfma_f32_16x16x32_bf16 v[248:251], a[136:139], a[48:51], v[248:251]
v_mfma_f32_16x16x32_bf16 v[248:251], a[140:143], a[52:55], v[248:251]
v_mfma_f32_16x16x32_bf16 v[252:255], a[136:139], a[56:59], v[252:255]
v_mfma_f32_16x16x32_bf16 v[252:255], a[140:143], a[60:63], v[252:255]
s_waitcnt lgkmcnt(0)
v_mfma_f32_16x16x32_bf16 v[36:39], a[128:131], a[64:67], v[36:39]
ds_read_b64_tr_b16 a[136:137], v23 offset:0
v_mfma_f32_16x16x32_bf16 v[36:39], a[132:135], a[68:71], v[36:39]
v_mfma_f32_16x16x32_bf16 v[44:47], a[128:131], a[72:75], v[44:47]
ds_read_b64_tr_b16 a[138:139], v23 offset:2048
v_mfma_f32_16x16x32_bf16 v[44:47], a[132:135], a[76:79], v[44:47]
ds_read_b128 a[0:3], v2 offset:32768
ds_read_b128 a[4:7], v3 offset:32768
v_mfma_f32_16x16x32_bf16 v[52:55], a[128:131], a[80:83], v[52:55]
ds_read_b64_tr_b16 a[140:141], v23 offset:16384
v_mfma_f32_16x16x32_bf16 v[52:55], a[132:135], a[84:87], v[52:55]
v_mfma_f32_16x16x32_bf16 v[60:63], a[128:131], a[88:91], v[60:63]
ds_read_b64_tr_b16 a[142:143], v23 offset:18432
v_add_u32 v23, 32768, v23
v_mfma_f32_16x16x32_bf16 v[60:63], a[132:135], a[92:95], v[60:63]
v_mfma_f32_16x16x32_bf16 v[68:71], a[128:131], a[96:99], v[68:71]
ds_read_b128 a[8:11], v2 offset:34816
v_mfma_f32_16x16x32_bf16 v[68:71], a[132:135], a[100:103], v[68:71]
v_mfma_f32_16x16x32_bf16 v[76:79], a[128:131], a[104:107], v[76:79]
ds_read_b128 a[12:15], v3 offset:34816
v_mfma_f32_16x16x32_bf16 v[76:79], a[132:135], a[108:111], v[76:79]
ds_read_b128 a[16:19], v2 offset:36864
v_mfma_f32_16x16x32_bf16 v[84:87], a[128:131], a[112:115], v[84:87]
ds_read_b128 a[20:23], v3 offset:36864
v_mfma_f32_16x16x32_bf16 v[84:87], a[132:135], a[116:119], v[84:87]
v_mfma_f32_16x16x32_bf16 v[92:95], a[128:131], a[120:123], v[92:95]
ds_read_b128 a[24:27], v2 offset:38912
v_mfma_f32_16x16x32_bf16 v[92:95], a[132:135], a[124:127], v[92:95]
s_waitcnt lgkmcnt(5)
v_mfma_f32_16x16x32_bf16 v[100:103], a[136:139], a[64:67], v[100:103]
ds_read_b64_tr_b16 a[128:129], v24 offset:0
v_mfma_f32_16x16x32_bf16 v[100:103], a[140:143], a[68:71], v[100:103]
v_mfma_f32_16x16x32_bf16 v[108:111], a[136:139], a[72:75], v[108:111]
ds_read_b64_tr_b16 a[130:131], v24 offset:2048
v_mfma_f32_16x16x32_bf16 v[108:111], a[140:143], a[76:79], v[108:111]
ds_read_b128 a[28:31], v3 offset:38912
v_mfma_f32_16x16x32_bf16 v[116:119], a[136:139], a[80:83], v[116:119]
ds_read_b64_tr_b16 a[132:133], v24 offset:16384
v_mfma_f32_16x16x32_bf16 v[116:119], a[140:143], a[84:87], v[116:119]
v_mfma_f32_16x16x32_bf16 v[124:127], a[136:139], a[88:91], v[124:127]
ds_read_b64_tr_b16 a[134:135], v24 offset:18432
v_add_u32 v24, 32768, v24
v_mfma_f32_16x16x32_bf16 v[124:127], a[140:143], a[92:95], v[124:127]
v_mfma_f32_16x16x32_bf16 v[132:135], a[136:139], a[96:99], v[132:135]
ds_read_b128 a[32:35], v2 offset:40960
v_mfma_f32_16x16x32_bf16 v[132:135], a[140:143], a[100:103], v[132:135]
v_mfma_f32_16x16x32_bf16 v[140:143], a[136:139], a[104:107], v[140:143]
ds_read_b128 a[36:39], v3 offset:40960
v_mfma_f32_16x16x32_bf16 v[140:143], a[140:143], a[108:111], v[140:143]
ds_read_b128 a[40:43], v2 offset:43008
v_mfma_f32_16x16x32_bf16 v[148:151], a[136:139], a[112:115], v[148:151]
ds_read_b128 a[44:47], v3 offset:43008
v_mfma_f32_16x16x32_bf16 v[148:151], a[140:143], a[116:119], v[148:151]
v_mfma_f32_16x16x32_bf16 v[156:159], a[136:139], a[120:123], v[156:159]
ds_read_b128 a[48:51], v2 offset:45056
v_mfma_f32_16x16x32_bf16 v[156:159], a[140:143], a[124:127], v[156:159]
s_waitcnt lgkmcnt(5)
v_mfma_f32_16x16x32_bf16 v[164:167], a[128:131], a[64:67], v[164:167]
ds_read_b64_tr_b16 a[136:137], v25 offset:0
v_mfma_f32_16x16x32_bf16 v[164:167], a[132:135], a[68:71], v[164:167]
v_mfma_f32_16x16x32_bf16 v[172:175], a[128:131], a[72:75], v[172:175]
ds_read_b64_tr_b16 a[138:139], v25 offset:2048
v_mfma_f32_16x16x32_bf16 v[172:175], a[132:135], a[76:79], v[172:175]
ds_read_b128 a[52:55], v3 offset:45056
v_mfma_f32_16x16x32_bf16 v[180:183], a[128:131], a[80:83], v[180:183]
ds_read_b64_tr_b16 a[140:141], v25 offset:16384
v_mfma_f32_16x16x32_bf16 v[180:183], a[132:135], a[84:87], v[180:183]
v_mfma_f32_16x16x32_bf16 v[188:191], a[128:131], a[88:91], v[188:191]
ds_read_b64_tr_b16 a[142:143], v25 offset:18432
v_add_u32 v25, 32768, v25
v_mfma_f32_16x16x32_bf16 v[188:191], a[132:135], a[92:95], v[188:191]
v_mfma_f32_16x16x32_bf16 v[196:199], a[128:131], a[96:99], v[196:199]
ds_read_b128 a[56:59], v2 offset:47104
v_mfma_f32_16x16x32_bf16 v[196:199], a[132:135], a[100:103], v[196:199]
v_mfma_f32_16x16x32_bf16 v[204:207], a[128:131], a[104:107], v[204:207]
ds_read_b128 a[60:63], v3 offset:47104
v_mfma_f32_16x16x32_bf16 v[204:207], a[132:135], a[108:111], v[204:207]
v_mfma_f32_16x16x32_bf16 v[212:215], a[128:131], a[112:115], v[212:215]
v_mfma_f32_16x16x32_bf16 v[212:215], a[132:135], a[116:119], v[212:215]
v_mfma_f32_16x16x32_bf16 v[220:223], a[128:131], a[120:123], v[220:223]
v_mfma_f32_16x16x32_bf16 v[220:223], a[132:135], a[124:127], v[220:223]
s_waitcnt vmcnt(0) lgkmcnt(0)
s_barrier
v_mfma_f32_16x16x32_bf16 v[224:227], a[136:139], a[64:67], v[224:227]
ds_read_b64_tr_b16 a[128:129], v22 offset:0
v_mfma_f32_16x16x32_bf16 v[224:227], a[140:143], a[68:71], v[224:227]
buffer_store_dword v27, v26, s[4:7], s66 offen sc1
v_mfma_f32_16x16x32_bf16 v[228:231], a[136:139], a[72:75], v[228:231]
ds_read_b64_tr_b16 a[130:131], v22 offset:2048
v_mfma_f32_16x16x32_bf16 v[228:231], a[140:143], a[76:79], v[228:231]
v_mfma_f32_16x16x32_bf16 v[232:235], a[136:139], a[80:83], v[232:235]
ds_read_b64_tr_b16 a[132:133], v22 offset:16384
v_mfma_f32_16x16x32_bf16 v[232:235], a[140:143], a[84:87], v[232:235]
v_mfma_f32_16x16x32_bf16 v[236:239], a[136:139], a[88:91], v[236:239]
ds_read_b64_tr_b16 a[134:135], v22 offset:18432
v_mfma_f32_16x16x32_bf16 v[236:239], a[140:143], a[92:95], v[236:239]
v_mfma_f32_16x16x32_bf16 v[240:243], a[136:139], a[96:99], v[240:243]
v_mfma_f32_16x16x32_bf16 v[240:243], a[140:143], a[100:103], v[240:243]
v_mfma_f32_16x16x32_bf16 v[244:247], a[136:139], a[104:107], v[244:247]
v_mfma_f32_16x16x32_bf16 v[244:247], a[140:143], a[108:111], v[244:247]
v_mfma_f32_16x16x32_bf16 v[248:251], a[136:139], a[112:115], v[248:251]
v_mfma_f32_16x16x32_bf16 v[248:251], a[140:143], a[116:119], v[248:251]
v_mfma_f32_16x16x32_bf16 v[252:255], a[136:139], a[120:123], v[252:255]
v_mfma_f32_16x16x32_bf16 v[252:255], a[140:143], a[124:127], v[252:255]
s_waitcnt lgkmcnt(0)
v_mfma_f32_16x16x32_bf16 v[36:39], a[128:131], a[0:3], v[36:39]
s_lshl_b32 s18, s3, 13
ds_read_b64_tr_b16 a[136:137], v23 offset:0
v_lshrrev_b32 v28, 6, v0
v_mfma_f32_16x16x32_bf16 v[36:39], a[132:135], a[4:7], v[36:39]
s_lshl_b32 s30, s20, 20
v_lshl_add_u32 v28, v28, 11, v1
v_add_u32 v28, 65536, v28
v_mfma_f32_16x16x32_bf16 v[44:47], a[128:131], a[8:11], v[44:47]
s_add_u32 s30, s30, s18
ds_read_b64_tr_b16 a[138:139], v23 offset:2048
v_lshrrev_b32 v3, 6, v0
v_mfma_f32_16x16x32_bf16 v[44:47], a[132:135], a[12:15], v[44:47]
s_lshl_b32 s22, s21, 1
v_and_b32 v4, 63, v0
v_add_u32 v2, 0x10000, v1
v_mfma_f32_16x16x32_bf16 v[52:55], a[128:131], a[16:19], v[52:55]
s_and_b32 s84, s2, 1
ds_read_b64_tr_b16 a[140:141], v23 offset:16384
v_and_b32 v5, 15, v4
v_mfma_f32_16x16x32_bf16 v[52:55], a[132:135], a[20:23], v[52:55]
s_mul_i32 s84, s84, 0
v_lshrrev_b32 v6, 4, v4
v_lshlrev_b32 v6, 2, v6
v_mfma_f32_16x16x32_bf16 v[60:63], a[128:131], a[24:27], v[60:63]
s_add_u32 s84, s84, 2386092
ds_read_b64_tr_b16 a[142:143], v23 offset:18432
v_sub_u32 v5, v5, v6
v_mfma_f32_16x16x32_bf16 v[60:63], a[132:135], a[28:31], v[60:63]
s_lshl_b32 s85, s21, 2
v_lshl_add_u32 v5, v3, 4, v5
v_cmp_gt_i32 s[32:33], 0, v5
v_mfma_f32_16x16x32_bf16 v[68:71], a[128:131], a[32:35], v[68:71]
s_lshr_b32 s85, s84, s85
v_cmp_gt_i32 s[34:35], 1, v5
v_cmp_gt_i32 s[36:37], 2, v5
v_mfma_f32_16x16x32_bf16 v[68:71], a[132:135], a[36:39], v[68:71]
s_and_b32 s9, s85, 15
v_cmp_gt_i32 s[38:39], 3, v5
v_cmp_gt_i32 s[40:41], 16, v5
v_mfma_f32_16x16x32_bf16 v[76:79], a[128:131], a[40:43], v[76:79]
s_and_b32 s84, s85, 1
v_cmp_gt_i32 s[42:43], 17, v5
v_cmp_gt_i32 s[44:45], 18, v5
v_mfma_f32_16x16x32_bf16 v[76:79], a[132:135], a[44:47], v[76:79]
s_lshl_b32 s84, s84, 17
v_cmp_gt_i32 s[46:47], 19, v5
v_cmp_gt_i32 s[48:49], 32, v5
v_mfma_f32_16x16x32_bf16 v[84:87], a[128:131], a[48:51], v[84:87]
s_add_u32 s84, s84, s18
v_cmp_gt_i32 s[50:51], 33, v5
v_cmp_gt_i32 s[52:53], 34, v5
v_mfma_f32_16x16x32_bf16 v[84:87], a[132:135], a[52:55], v[84:87]
s_xor_b32 s85, s84, 0x20000
v_cmp_gt_i32 s[54:55], 35, v5
v_cmp_gt_i32 s[56:57], 48, v5
v_mfma_f32_16x16x32_bf16 v[92:95], a[128:131], a[56:59], v[92:95]
s_sub_u32 s29, 15, s21
v_cmp_gt_i32 s[58:59], 49, v5
v_cmp_gt_i32 s[60:61], 50, v5
v_mfma_f32_16x16x32_bf16 v[92:95], a[132:135], a[60:63], v[92:95]
s_waitcnt lgkmcnt(0)
v_cmp_gt_i32 s[62:63], 51, v5
v_mov_b32 v7, 0xff800000
v_mfma_f32_16x16x32_bf16 v[100:103], a[136:139], a[0:3], v[100:103]
s_cmp_lg_u32 s9, 0
ds_read_b64_tr_b16 a[128:129], v24 offset:0
v_mov_b32 v6, 1
v_mfma_f32_16x16x32_bf16 v[100:103], a[140:143], a[4:7], v[100:103]
s_cselect_b32 s24, 1, 0
v_mov_b32 v5, v26
v_add_u32 v4, 0x20000, v1
v_mfma_f32_16x16x32_bf16 v[108:111], a[136:139], a[8:11], v[108:111]
s_cselect_b32 s67, s67, 3221225472
ds_read_b64_tr_b16 a[130:131], v24 offset:2048
v_mfma_f32_16x16x32_bf16 v[108:111], a[140:143], a[12:15], v[108:111]
s_lshl_b32 s8, s9, 15
v_mfma_f32_16x16x32_bf16 v[116:119], a[136:139], a[16:19], v[116:119]
s_add_u32 s8, s8, s30
ds_read_b64_tr_b16 a[132:133], v24 offset:16384
v_mfma_f32_16x16x32_bf16 v[116:119], a[140:143], a[20:23], v[116:119]
s_add_u32 s9, s9, s22
v_mfma_f32_16x16x32_bf16 v[124:127], a[136:139], a[24:27], v[124:127]
s_sub_u32 s9, 32, s9
ds_read_b64_tr_b16 a[134:135], v24 offset:18432
v_mul_f32 v36, s68, v36
v_mfma_f32_16x16x32_bf16 v[124:127], a[140:143], a[28:31], v[124:127]
s_bitcmp1_b32 s2, 4
v_mul_f32 v37, s68, v37
v_mul_f32 v38, s68, v38
v_mfma_f32_16x16x32_bf16 v[132:135], a[136:139], a[32:35], v[132:135]
s_cselect_b32 s9, 16, s9
v_mul_f32 v39, s68, v39
v_mul_f32 v100, s68, v100
v_mfma_f32_16x16x32_bf16 v[132:135], a[140:143], a[36:39], v[132:135]
s_cselect_b32 s29, 7, s29
v_mul_f32 v101, s68, v101
v_mul_f32 v102, s68, v102
v_mfma_f32_16x16x32_bf16 v[140:143], a[136:139], a[40:43], v[140:143]
s_mov_b32 s10, 3221225472
v_mul_f32 v103, s68, v103
v_cvt_pk_bf16_f32 v36, v36, v37
v_mfma_f32_16x16x32_bf16 v[140:143], a[140:143], a[44:47], v[140:143]
s_mov_b32 s14, 3221225472
v_cvt_pk_bf16_f32 v37, v38, v39
v_cvt_pk_bf16_f32 v38, v100, v101
v_mfma_f32_16x16x32_bf16 v[148:151], a[136:139], a[48:51], v[148:151]
s_mov_b32 s11, 0
v_cvt_pk_bf16_f32 v39, v102, v103
v_mul_f32 v44, s68, v44
v_mfma_f32_16x16x32_bf16 v[148:151], a[140:143], a[52:55], v[148:151]
s_lshr_b32 s19, s9, 1
ds_write_b128 v28, v[36:39] offset:0
v_mul_f32 v45, s68, v45
v_mfma_f32_16x16x32_bf16 v[156:159], a[136:139], a[56:59], v[156:159]
s_sub_u32 s19, s19, 1
s_add_u32 s23, s67, 0
buffer_store_dwordx4 v[36:39], v1, s[4:7], s23 offen offset:0 sc1
v_mfma_f32_16x16x32_bf16 v[156:159], a[140:143], a[60:63], v[156:159]
s_waitcnt lgkmcnt(1)
v_mul_f32 v46, s68, v46
v_mul_f32 v47, s68, v47
v_mfma_f32_16x16x32_bf16 v[164:167], a[128:131], a[0:3], v[164:167]
s_add_u32 s12, s8, 16777216
ds_read_b64_tr_b16 a[136:137], v25 offset:0
v_mul_f32 v108, s68, v108
v_mfma_f32_16x16x32_bf16 v[164:167], a[132:135], a[4:7], v[164:167]
s_mov_b32 s13, s9
v_mul_f32 v109, s68, v109
v_mul_f32 v110, s68, v110
v_mfma_f32_16x16x32_bf16 v[172:175], a[128:131], a[8:11], v[172:175]
s_mov_b32 s15, s11
ds_read_b64_tr_b16 a[138:139], v25 offset:2048
v_mul_f32 v111, s68, v111
v_mfma_f32_16x16x32_bf16 v[172:175], a[132:135], a[12:15], v[172:175]
v_cvt_pk_bf16_f32 v44, v44, v45
v_cvt_pk_bf16_f32 v45, v46, v47
v_mfma_f32_16x16x32_bf16 v[180:183], a[128:131], a[16:19], v[180:183]
ds_read_b64_tr_b16 a[140:141], v25 offset:16384
v_cvt_pk_bf16_f32 v46, v108, v109
v_mfma_f32_16x16x32_bf16 v[180:183], a[132:135], a[20:23], v[180:183]
v_cvt_pk_bf16_f32 v47, v110, v111
v_mul_f32 v52, s68, v52
v_mfma_f32_16x16x32_bf16 v[188:191], a[128:131], a[24:27], v[188:191]
ds_read_b64_tr_b16 a[142:143], v25 offset:18432
v_mul_f32 v53, s68, v53
v_mfma_f32_16x16x32_bf16 v[188:191], a[132:135], a[28:31], v[188:191]
ds_write_b128 v28, v[44:47] offset:8192
v_mul_f32 v54, s68, v54
v_mfma_f32_16x16x32_bf16 v[196:199], a[128:131], a[32:35], v[196:199]
s_add_u32 s23, s67, 8192
buffer_store_dwordx4 v[44:47], v1, s[4:7], s23 offen offset:0 sc1
v_mfma_f32_16x16x32_bf16 v[196:199], a[132:135], a[36:39], v[196:199]
v_mul_f32 v55, s68, v55
v_mul_f32 v116, s68, v116
v_mfma_f32_16x16x32_bf16 v[204:207], a[128:131], a[40:43], v[204:207]
v_mul_f32 v117, s68, v117
v_mul_f32 v118, s68, v118
v_mfma_f32_16x16x32_bf16 v[204:207], a[132:135], a[44:47], v[204:207]
v_mul_f32 v119, s68, v119
v_cvt_pk_bf16_f32 v52, v52, v53
v_mfma_f32_16x16x32_bf16 v[212:215], a[128:131], a[48:51], v[212:215]
v_cvt_pk_bf16_f32 v53, v54, v55
v_cvt_pk_bf16_f32 v54, v116, v117
v_mfma_f32_16x16x32_bf16 v[212:215], a[132:135], a[52:55], v[212:215]
v_cvt_pk_bf16_f32 v55, v118, v119
v_mul_f32 v60, s68, v60
v_mfma_f32_16x16x32_bf16 v[220:223], a[128:131], a[56:59], v[220:223]
ds_write_b128 v28, v[52:55] offset:16384
v_mul_f32 v61, s68, v61
v_mfma_f32_16x16x32_bf16 v[220:223], a[132:135], a[60:63], v[220:223]
s_waitcnt lgkmcnt(0)
s_waitcnt lgkmcnt(0)
s_barrier
v_mfma_f32_16x16x32_bf16 v[224:227], a[136:139], a[0:3], v[224:227]
s_add_u32 s23, s67, 16384
buffer_store_dwordx4 v[52:55], v1, s[4:7], s23 offen offset:0 sc1
v_mfma_f32_16x16x32_bf16 v[224:227], a[140:143], a[4:7], v[224:227]
v_mul_f32 v62, s68, v62
v_mul_f32 v63, s68, v63
v_mfma_f32_16x16x32_bf16 v[228:231], a[136:139], a[8:11], v[228:231]
v_mul_f32 v124, s68, v124
v_mul_f32 v125, s68, v125
v_mfma_f32_16x16x32_bf16 v[228:231], a[140:143], a[12:15], v[228:231]
v_mul_f32 v126, s68, v126
v_mul_f32 v127, s68, v127
v_mfma_f32_16x16x32_bf16 v[232:235], a[136:139], a[16:19], v[232:235]
v_cvt_pk_bf16_f32 v60, v60, v61
v_cvt_pk_bf16_f32 v61, v62, v63
v_mfma_f32_16x16x32_bf16 v[232:235], a[140:143], a[20:23], v[232:235]
v_cvt_pk_bf16_f32 v62, v124, v125
v_cvt_pk_bf16_f32 v63, v126, v127
v_mfma_f32_16x16x32_bf16 v[236:239], a[136:139], a[24:27], v[236:239]
ds_write_b128 v28, v[60:63] offset:24576
v_mul_f32 v68, s68, v68
v_mfma_f32_16x16x32_bf16 v[236:239], a[140:143], a[28:31], v[236:239]
s_add_u32 s23, s67, 24576
buffer_store_dwordx4 v[60:63], v1, s[4:7], s23 offen offset:0 sc1
v_mfma_f32_16x16x32_bf16 v[240:243], a[136:139], a[32:35], v[240:243]
v_mul_f32 v69, s68, v69
v_mul_f32 v70, s68, v70
v_mfma_f32_16x16x32_bf16 v[240:243], a[140:143], a[36:39], v[240:243]
v_mul_f32 v71, s68, v71
v_mul_f32 v132, s68, v132
v_mfma_f32_16x16x32_bf16 v[244:247], a[136:139], a[40:43], v[244:247]
v_mul_f32 v133, s68, v133
v_mul_f32 v134, s68, v134
v_mfma_f32_16x16x32_bf16 v[244:247], a[140:143], a[44:47], v[244:247]
v_mul_f32 v135, s68, v135
v_cvt_pk_bf16_f32 v68, v68, v69
v_mfma_f32_16x16x32_bf16 v[248:251], a[136:139], a[48:51], v[248:251]
v_cvt_pk_bf16_f32 v69, v70, v71
v_cvt_pk_bf16_f32 v70, v132, v133
v_mfma_f32_16x16x32_bf16 v[248:251], a[140:143], a[52:55], v[248:251]
v_cvt_pk_bf16_f32 v71, v134, v135
v_mfma_f32_16x16x32_bf16 v[252:255], a[136:139], a[56:59], v[252:255]
ds_write_b128 v28, v[68:71] offset:32768
v_mfma_f32_16x16x32_bf16 v[252:255], a[140:143], a[60:63], v[252:255]
s_add_u32 s23, s67, 32768
buffer_store_dwordx4 v[68:71], v1, s[4:7], s23 offen offset:0 sc1
buffer_load_dword v21, v20, s[4:7], s70 offen sc1
v_pk_mul_f32 v[76:77], v[76:77], s[68:69]
v_pk_mul_f32 v[78:79], v[78:79], s[68:69]
v_pk_mul_f32 v[140:141], v[140:141], s[68:69]
v_pk_mul_f32 v[142:143], v[142:143], s[68:69]
v_cvt_pk_bf16_f32 v76, v76, v77
v_cvt_pk_bf16_f32 v77, v78, v79
v_cvt_pk_bf16_f32 v78, v140, v141
v_cvt_pk_bf16_f32 v79, v142, v143
ds_write_b128 v28, v[76:79] offset:40960
s_add_u32 s23, s67, 40960
buffer_store_dwordx4 v[76:79], v1, s[4:7], s23 offen offset:0 sc1
v_pk_mul_f32 v[84:85], v[84:85], s[68:69]
v_pk_mul_f32 v[86:87], v[86:87], s[68:69]
v_pk_mul_f32 v[148:149], v[148:149], s[68:69]
v_pk_mul_f32 v[150:151], v[150:151], s[68:69]
v_cvt_pk_bf16_f32 v84, v84, v85
v_cvt_pk_bf16_f32 v85, v86, v87
v_cvt_pk_bf16_f32 v86, v148, v149
v_cvt_pk_bf16_f32 v87, v150, v151
ds_write_b128 v28, v[84:87] offset:49152
s_add_u32 s23, s67, 49152
buffer_store_dwordx4 v[84:87], v1, s[4:7], s23 offen offset:0 sc1
v_pk_mul_f32 v[92:93], v[92:93], s[68:69]
v_pk_mul_f32 v[94:95], v[94:95], s[68:69]
v_pk_mul_f32 v[156:157], v[156:157], s[68:69]
v_pk_mul_f32 v[158:159], v[158:159], s[68:69]
v_cvt_pk_bf16_f32 v92, v92, v93
v_cvt_pk_bf16_f32 v93, v94, v95
v_cvt_pk_bf16_f32 v94, v156, v157
v_cvt_pk_bf16_f32 v95, v158, v159
ds_write_b128 v28, v[92:95] offset:57344
s_add_u32 s23, s67, 57344
buffer_store_dwordx4 v[92:95], v1, s[4:7], s23 offen offset:0 sc1
v_pk_mul_f32 v[164:165], v[164:165], s[68:69]
v_pk_mul_f32 v[166:167], v[166:167], s[68:69]
v_pk_mul_f32 v[224:225], v[224:225], s[68:69]
v_pk_mul_f32 v[226:227], v[226:227], s[68:69]
v_cvt_pk_bf16_f32 v164, v164, v165
v_cvt_pk_bf16_f32 v165, v166, v167
v_cvt_pk_bf16_f32 v166, v224, v225
v_cvt_pk_bf16_f32 v167, v226, v227
ds_write_b128 v28, v[164:167] offset:1024
s_add_u32 s23, s67, 0
buffer_store_dwordx4 v[164:167], v1, s[4:7], s23 offen offset:1024 sc1
v_pk_mul_f32 v[172:173], v[172:173], s[68:69]
v_pk_mul_f32 v[174:175], v[174:175], s[68:69]
v_pk_mul_f32 v[228:229], v[228:229], s[68:69]
v_pk_mul_f32 v[230:231], v[230:231], s[68:69]
v_cvt_pk_bf16_f32 v172, v172, v173
v_cvt_pk_bf16_f32 v173, v174, v175
v_cvt_pk_bf16_f32 v174, v228, v229
v_cvt_pk_bf16_f32 v175, v230, v231
ds_write_b128 v28, v[172:175] offset:9216
s_add_u32 s23, s67, 8192
buffer_store_dwordx4 v[172:175], v1, s[4:7], s23 offen offset:1024 sc1
v_pk_mul_f32 v[180:181], v[180:181], s[68:69]
v_pk_mul_f32 v[182:183], v[182:183], s[68:69]
v_pk_mul_f32 v[232:233], v[232:233], s[68:69]
v_pk_mul_f32 v[234:235], v[234:235], s[68:69]
v_cvt_pk_bf16_f32 v180, v180, v181
v_cvt_pk_bf16_f32 v181, v182, v183
v_cvt_pk_bf16_f32 v182, v232, v233
v_cvt_pk_bf16_f32 v183, v234, v235
ds_write_b128 v28, v[180:183] offset:17408
s_add_u32 s23, s67, 16384
buffer_store_dwordx4 v[180:183], v1, s[4:7], s23 offen offset:1024 sc1
v_pk_mul_f32 v[188:189], v[188:189], s[68:69]
v_pk_mul_f32 v[190:191], v[190:191], s[68:69]
v_pk_mul_f32 v[236:237], v[236:237], s[68:69]
v_pk_mul_f32 v[238:239], v[238:239], s[68:69]
v_cvt_pk_bf16_f32 v188, v188, v189
v_cvt_pk_bf16_f32 v189, v190, v191
v_cvt_pk_bf16_f32 v190, v236, v237
v_cvt_pk_bf16_f32 v191, v238, v239
ds_write_b128 v28, v[188:191] offset:25600
s_add_u32 s23, s67, 24576
buffer_store_dwordx4 v[188:191], v1, s[4:7], s23 offen offset:1024 sc1
v_pk_mul_f32 v[196:197], v[196:197], s[68:69]
v_pk_mul_f32 v[198:199], v[198:199], s[68:69]
v_pk_mul_f32 v[240:241], v[240:241], s[68:69]
v_pk_mul_f32 v[242:243], v[242:243], s[68:69]
v_cvt_pk_bf16_f32 v196, v196, v197
v_cvt_pk_bf16_f32 v197, v198, v199
v_cvt_pk_bf16_f32 v198, v240, v241
v_cvt_pk_bf16_f32 v199, v242, v243
ds_write_b128 v28, v[196:199] offset:33792
s_add_u32 s23, s67, 32768
buffer_store_dwordx4 v[196:199], v1, s[4:7], s23 offen offset:1024 sc1
v_pk_mul_f32 v[204:205], v[204:205], s[68:69]
PAD_8:
s_cbranch_execz M_tret
v_pk_mul_f32 v[206:207], v[206:207], s[68:69]
v_pk_mul_f32 v[244:245], v[244:245], s[68:69]
v_pk_mul_f32 v[246:247], v[246:247], s[68:69]
v_cvt_pk_bf16_f32 v204, v204, v205
v_cvt_pk_bf16_f32 v205, v206, v207
v_cvt_pk_bf16_f32 v206, v244, v245
v_cvt_pk_bf16_f32 v207, v246, v247
ds_write_b128 v28, v[204:207] offset:41984
s_add_u32 s23, s67, 40960
buffer_store_dwordx4 v[204:207], v1, s[4:7], s23 offen offset:1024 sc1
v_pk_mul_f32 v[212:213], v[212:213], s[68:69]
v_pk_mul_f32 v[214:215], v[214:215], s[68:69]
v_pk_mul_f32 v[248:249], v[248:249], s[68:69]
v_pk_mul_f32 v[250:251], v[250:251], s[68:69]
v_cvt_pk_bf16_f32 v212, v212, v213
v_cvt_pk_bf16_f32 v213, v214, v215
v_cvt_pk_bf16_f32 v214, v248, v249
v_cvt_pk_bf16_f32 v215, v250, v251
ds_write_b128 v28, v[212:215] offset:50176
s_add_u32 s23, s67, 49152
buffer_store_dwordx4 v[212:215], v1, s[4:7], s23 offen offset:1024 sc1
v_pk_mul_f32 v[220:221], v[220:221], s[68:69]
v_pk_mul_f32 v[222:223], v[222:223], s[68:69]
v_pk_mul_f32 v[252:253], v[252:253], s[68:69]
v_pk_mul_f32 v[254:255], v[254:255], s[68:69]
v_cvt_pk_bf16_f32 v220, v220, v221
v_cvt_pk_bf16_f32 v221, v222, v223
v_cvt_pk_bf16_f32 v222, v252, v253
v_cvt_pk_bf16_f32 v223, v254, v255
ds_write_b128 v28, v[220:223] offset:58368
s_add_u32 s23, s67, 57344
buffer_store_dwordx4 v[220:223], v1, s[4:7], s23 offen offset:1024 sc1
s_waitcnt vmcnt(11)
v_cmp_gt_u32 vcc, 1, v21
s_cbranch_vccnz M_kspin
M_kok:
buffer_load_dword v21, v15, s[4:7], s70 offen sc1
s_mov_b32 m0, s84
s_nop 0
buffer_load_dwordx4 v1, s[4:7], s8 offen offset:0 sc1 lds
buffer_load_dwordx4 v1, s[4:7], s8 offen offset:1024 sc1 lds
buffer_load_dwordx4 v1, s[4:7], s8 offen offset:2048 sc1 lds
buffer_load_dwordx4 v1, s[4:7], s8 offen offset:3072 sc1 lds
s_add_u32 s8, s8, 4096
s_add_u32 m0, s84, 4096
s_nop 0
buffer_load_dwordx4 v1, s[4:7], s8 offen offset:0 sc1 lds
buffer_load_dwordx4 v1, s[4:7], s8 offen offset:1024 sc1 lds
buffer_load_dwordx4 v1, s[4:7], s8 offen offset:2048 sc1 lds
buffer_load_dwordx4 v1, s[4:7], s8 offen offset:3072 sc1 lds
s_add_u32 s8, s8, 28672
s_sub_u32 s9, s9, 1
s_cmp_eq_u32 s9, 0
s_cselect_b32 s8, s10, s8
s_cselect_b32 s9, s11, s9
s_cselect_b32 s10, 3221225472, s10
v_add_u32 v28, s18, v2
s_waitcnt lgkmcnt(0)
s_barrier
ds_read_b128 a[0:3], v28 offset:0
ds_read_b128 a[4:7], v28 offset:1024
ds_read_b128 a[8:11], v28 offset:2048
ds_read_b128 a[12:15], v28 offset:3072
ds_read_b128 a[16:19], v28 offset:4096
ds_read_b128 a[20:23], v28 offset:5120
ds_read_b128 a[24:27], v28 offset:6144
ds_read_b128 a[28:31], v28 offset:7168
ds_read_b128 a[32:35], v28 offset:32768
ds_read_b128 a[36:39], v28 offset:33792
ds_read_b128 a[40:43], v28 offset:34816
ds_read_b128 a[44:47], v28 offset:35840
ds_read_b128 a[48:51], v28 offset:36864
ds_read_b128 a[52:55], v28 offset:37888
ds_read_b128 a[56:59], v28 offset:38912
ds_read_b128 a[60:63], v28 offset:39936
s_mov_b32 m0, s85
s_nop 0
buffer_load_dwordx4 v1, s[4:7], s8 offen offset:0 sc1 lds
buffer_load_dwordx4 v1, s[4:7], s8 offen offset:1024 sc1 lds
buffer_load_dwordx4 v1, s[4:7], s8 offen offset:2048 sc1 lds
buffer_load_dwordx4 v1, s[4:7], s8 offen offset:3072 sc1 lds
s_add_u32 s8, s8, 4096
s_add_u32 m0, s85, 4096
s_nop 0
buffer_load_dwordx4 v1, s[4:7], s8 offen offset:0 sc1 lds
buffer_load_dwordx4 v1, s[4:7], s8 offen offset:1024 sc1 lds
buffer_load_dwordx4 v1, s[4:7], s8 offen offset:2048 sc1 lds
buffer_load_dwordx4 v1, s[4:7], s8 offen offset:3072 sc1 lds
s_add_u32 s8, s8, 28672
s_sub_u32 s9, s9, 1
s_cmp_eq_u32 s9, 0
s_cselect_b32 s8, s10, s8
s_cselect_b32 s9, s11, s9
s_cselect_b32 s10, 3221225472, s10
s_mov_b32 s25, 1266679808
s_lshl_b32 s22, s21, 3
s_xor_b32 s28, s70, 256
s_add_u32 s28, s28, s22
s_add_u32 s28, s28, 6148
s_lshl_b32 s26, s21, 16
s_add_u32 s26, s26, s30
s_add_u32 s26, s26, 33554432
s_xor_b32 s76, s20, 0
s_lshl_b32 s76, s76, 3
s_add_u32 s76, s76, s21
s_lshl_b32 s76, s76, 2
s_add_u32 s76, s76, s3
s_lshl_b32 s27, s76, 10
s_add_u32 s27, s27, 75497472
s_lshl_b32 s76, s76, 14
s_add_u32 s76, s76, 67108864
s_lshl_b32 s81, s20, 2
s_add_u32 s81, s81, s3
s_mul_i32 s81, s81, 57344
s_cmp_eq_u32 s24, 1
s_cselect_b32 s80, s28, s70
s_add_u32 s77, s76, 8192
v_lshrrev_b32 v8, 7, v1
v_and_b32 v9, 6, v8
v_lshlrev_b32 v9, 4, v9
v_and_b32 v10, 0x70, v1
v_xor_b32 v9, v9, v10
v_mul_u32_u24 v8, 896, v8
v_add_u32 v8, v8, v9
v_accvgpr_write_b32 a184, v8
v_add_u32 v8, 6144, v8
v_accvgpr_write_b32 a185, v8
v_add_u32 v8, 6144, v8
v_accvgpr_write_b32 a186, v8
v_add_u32 v8, 6144, v8
v_accvgpr_write_b32 a187, v8
v_lshrrev_b32 v8, 6, v1
v_bfe_u32 v9, v1, 7, 2
v_lshlrev_b32 v9, 5, v9
v_lshl_add_u32 v8, v8, 7, v9
v_bfe_u32 v9, v1, 4, 2
v_lshl_add_u32 v8, v9, 3, v8
v_add_u32 v8, 32768, v8
v_accvgpr_write_b32 a188, v8
v_xor_b32 v9, 32, v8
v_accvgpr_write_b32 a189, v9
v_xor_b32 v9, 64, v8
v_accvgpr_write_b32 a190, v9
v_xor_b32 v9, 96, v8
v_accvgpr_write_b32 a191, v9
s_add_u32 s22, s66, 16384
s_mov_b32 s71, 3221225472
s_waitcnt vmcnt(17)
s_barrier
buffer_store_dword v6, v5, s[4:7], s22 offen sc1
v_mov_b64 v[128:129], 0
v_mov_b64 v[130:131], 0
v_mov_b64 v[132:133], 0
v_mov_b64 v[134:135], 0
v_mov_b64 v[136:137], 0
v_mov_b64 v[138:139], 0
v_mov_b64 v[140:141], 0
v_mov_b64 v[142:143], 0
v_mov_b64 v[144:145], 0
v_mov_b64 v[146:147], 0
v_mov_b64 v[148:149], 0
v_mov_b64 v[150:151], 0
v_mov_b64 v[152:153], 0
v_mov_b64 v[154:155], 0
v_mov_b64 v[156:157], 0
v_mov_b64 v[158:159], 0
v_mov_b64 v[160:161], 0
v_mov_b64 v[162:163], 0
v_mov_b64 v[164:165], 0
v_mov_b64 v[166:167], 0
v_mov_b64 v[168:169], 0
v_mov_b64 v[170:171], 0
v_mov_b64 v[172:173], 0
v_mov_b64 v[174:175], 0
v_mov_b64 v[176:177], 0
v_mov_b64 v[178:179], 0
v_mov_b64 v[180:181], 0
v_mov_b64 v[182:183], 0
v_mov_b64 v[184:185], 0
v_mov_b64 v[186:187], 0
v_mov_b64 v[188:189], 0
v_mov_b64 v[190:191], 0
v_mov_b64 v[192:193], 0
v_mov_b64 v[194:195], 0
v_mov_b64 v[196:197], 0
v_mov_b64 v[198:199], 0
v_mov_b64 v[200:201], 0
v_mov_b64 v[202:203], 0
v_mov_b64 v[204:205], 0
v_mov_b64 v[206:207], 0
v_mov_b64 v[208:209], 0
v_mov_b64 v[210:211], 0
v_mov_b64 v[212:213], 0
v_mov_b64 v[214:215], 0
v_mov_b64 v[216:217], 0
v_mov_b64 v[218:219], 0
v_mov_b64 v[220:221], 0
v_mov_b64 v[222:223], 0
v_mov_b64 v[224:225], 0
v_mov_b64 v[226:227], 0
v_mov_b64 v[228:229], 0
v_mov_b64 v[230:231], 0
v_mov_b64 v[232:233], 0
v_mov_b64 v[234:235], 0
v_mov_b64 v[236:237], 0
v_mov_b64 v[238:239], 0
v_mov_b64 v[240:241], 0
v_mov_b64 v[242:243], 0
v_mov_b64 v[244:245], 0
v_mov_b64 v[246:247], 0
v_mov_b64 v[248:249], 0
v_mov_b64 v[250:251], 0
v_mov_b64 v[252:253], 0
v_mov_b64 v[254:255], 0
v_mov_b64 v[24:25], 0
s_cmp_eq_u32 s24, 9
s_cbranch_scc1 M_t2A
M_t2Ar:
s_waitcnt vmcnt(9) lgkmcnt(0)
v_cmp_gt_u32 vcc, 1, v21
s_cbranch_vccnz M_vspin
M_vok:
s_barrier
K2_item:
PAD_9:
s_cbranch_execz M_tret
s_cmp_eq_u32 s19, 0
s_cbranch_scc1 K2_p0d
ds_read_b128 a[64:67], v1 offset:0
ds_read_b128 a[68:71], v1 offset:1024
ds_read_b128 a[72:75], v1 offset:2048
ds_read_b128 a[76:79], v1 offset:3072
ds_read_b128 a[80:83], v1 offset:4096
ds_read_b128 a[84:87], v1 offset:5120
ds_read_b128 a[88:91], v1 offset:6144
ds_read_b128 a[92:95], v1 offset:7168
s_waitcnt lgkmcnt(7)
v_mfma_f32_16x16x32_bf16 v[32:35], a[64:67], a[0:3], 0
s_waitcnt lgkmcnt(6)
s_add_u32 m0, s18, 65536
ds_read_b128 a[96:99], v1 offset:8192
v_mfma_f32_16x16x32_bf16 v[32:35], a[68:71], a[4:7], v[32:35]
s_waitcnt lgkmcnt(6)
buffer_load_dwordx4 v1, s[4:7], s12 offen offset:0 sc1 lds
v_mfma_f32_16x16x32_bf16 v[32:35], a[72:75], a[8:11], v[32:35]
s_waitcnt lgkmcnt(5)
ds_read_b128 a[100:103], v1 offset:9216
v_mfma_f32_16x16x32_bf16 v[32:35], a[76:79], a[12:15], v[32:35]
s_waitcnt lgkmcnt(5)
buffer_load_dwordx4 v1, s[4:7], s12 offen offset:1024 sc1 lds
v_mfma_f32_16x16x32_bf16 v[32:35], a[80:83], a[16:19], v[32:35]
s_waitcnt lgkmcnt(4)
ds_read_b128 a[104:107], v1 offset:10240
v_mfma_f32_16x16x32_bf16 v[32:35], a[84:87], a[20:23], v[32:35]
s_waitcnt lgkmcnt(4)
buffer_load_dwordx4 v1, s[4:7], s12 offen offset:2048 sc1 lds
v_mfma_f32_16x16x32_bf16 v[32:35], a[88:91], a[24:27], v[32:35]
s_waitcnt lgkmcnt(3)
ds_read_b128 a[108:111], v1 offset:11264
v_mfma_f32_16x16x32_bf16 v[32:35], a[92:95], a[28:31], v[32:35]
buffer_load_dwordx4 v1, s[4:7], s12 offen offset:3072 sc1 lds
v_mfma_f32_16x16x32_bf16 v[36:39], a[64:67], a[32:35], 0
s_add_u32 s12, s12, 4096
s_add_u32 m0, s18, 69632
ds_read_b128 a[112:115], v1 offset:12288
v_mfma_f32_16x16x32_bf16 v[36:39], a[68:71], a[36:39], v[36:39]
buffer_load_dwordx4 v1, s[4:7], s12 offen offset:0 sc1 lds
v_mfma_f32_16x16x32_bf16 v[36:39], a[72:75], a[40:43], v[36:39]
ds_read_b128 a[116:119], v1 offset:13312
v_mfma_f32_16x16x32_bf16 v[36:39], a[76:79], a[44:47], v[36:39]
buffer_load_dwordx4 v1, s[4:7], s12 offen offset:1024 sc1 lds
v_mfma_f32_16x16x32_bf16 v[36:39], a[80:83], a[48:51], v[36:39]
ds_read_b128 a[120:123], v1 offset:14336
v_max3_f32 v28, v32, v33, v34
v_mfma_f32_16x16x32_bf16 v[36:39], a[84:87], a[52:55], v[36:39]
buffer_load_dwordx4 v1, s[4:7], s12 offen offset:2048 sc1 lds
v_mfma_f32_16x16x32_bf16 v[36:39], a[88:91], a[56:59], v[36:39]
ds_read_b128 a[124:127], v1 offset:15360
v_max_f32 v28, v28, v35
v_mfma_f32_16x16x32_bf16 v[36:39], a[92:95], a[60:63], v[36:39]
s_waitcnt lgkmcnt(4)
buffer_load_dwordx4 v1, s[4:7], s12 offen offset:3072 sc1 lds
v_mfma_f32_16x16x32_bf16 v[40:43], a[96:99], a[0:3], 0
s_add_u32 s12, s12, 28672
ds_read_b128 a[64:67], v1 offset:16384
v_mov_b32 v30, v28
v_mfma_f32_16x16x32_bf16 v[40:43], a[100:103], a[4:7], v[40:43]
s_waitcnt lgkmcnt(2)
s_sub_u32 s13, s13, 1
v_mfma_f32_16x16x32_bf16 v[40:43], a[104:107], a[8:11], v[40:43]
s_cmp_eq_u32 s13, 0
ds_read_b128 a[68:71], v1 offset:17408
v_permlane16_swap_b32 v28, v30
v_mfma_f32_16x16x32_bf16 v[40:43], a[108:111], a[12:15], v[40:43]
s_cselect_b32 s12, s14, s12
v_max_f32 v28, v28, v30
v_mov_b32 v30, v28
v_mfma_f32_16x16x32_bf16 v[40:43], a[112:115], a[16:19], v[40:43]
s_cselect_b32 s13, s15, s13
ds_read_b128 a[72:75], v1 offset:18432
v_max3_f32 v29, v36, v37, v38
v_mfma_f32_16x16x32_bf16 v[40:43], a[116:119], a[20:23], v[40:43]
s_cselect_b32 s14, 3221225472, s14
v_permlane32_swap_b32 v28, v30
v_max_f32 v28, v28, v30
v_mfma_f32_16x16x32_bf16 v[40:43], a[120:123], a[24:27], v[40:43]
s_waitcnt lgkmcnt(3)
ds_read_b128 a[76:79], v1 offset:19456
v_sub_f32 v16, 0, v28
v_mfma_f32_16x16x32_bf16 v[40:43], a[124:127], a[28:31], v[40:43]
v_sub_f32 v17, 0, v28
v_sub_f32 v18, 0, v28
v_mfma_f32_16x16x32_bf16 v[44:47], a[96:99], a[32:35], 0
ds_read_b128 a[80:83], v1 offset:20480
v_sub_f32 v19, 0, v28
v_mfma_f32_16x16x32_bf16 v[44:47], a[100:103], a[36:39], v[44:47]
v_max_f32 v29, v29, v39
v_mov_b32 v31, v29
v_mfma_f32_16x16x32_bf16 v[44:47], a[104:107], a[40:43], v[44:47]
ds_read_b128 a[84:87], v1 offset:21504
v_mfma_f32_16x16x32_bf16 v[44:47], a[108:111], a[44:47], v[44:47]
v_permlane16_swap_b32 v29, v31
v_max_f32 v29, v29, v31
v_mfma_f32_16x16x32_bf16 v[44:47], a[112:115], a[48:51], v[44:47]
ds_read_b128 a[88:91], v1 offset:22528
v_mov_b32 v31, v29
v_mfma_f32_16x16x32_bf16 v[44:47], a[116:119], a[52:55], v[44:47]
v_mfma_f32_16x16x32_bf16 v[44:47], a[120:123], a[56:59], v[44:47]
ds_read_b128 a[92:95], v1 offset:23552
v_permlane32_swap_b32 v29, v31
v_mfma_f32_16x16x32_bf16 v[44:47], a[124:127], a[60:63], v[44:47]
s_waitcnt lgkmcnt(4)
v_max_f32 v29, v29, v31
v_sub_f32 v20, 0, v29
v_mfma_f32_16x16x32_bf16 v[48:51], a[64:67], a[0:3], v[16:19]
ds_read_b128 a[96:99], v1 offset:24576
v_sub_f32 v21, 0, v29
v_mfma_f32_16x16x32_bf16 v[48:51], a[68:71], a[4:7], v[48:51]
v_sub_f32 v22, 0, v29
v_sub_f32 v23, 0, v29
v_mfma_f32_16x16x32_bf16 v[48:51], a[72:75], a[8:11], v[48:51]
ds_read_b128 a[100:103], v1 offset:25600
v_mfma_f32_16x16x32_bf16 v[48:51], a[76:79], a[12:15], v[48:51]
s_waitcnt lgkmcnt(4)
v_mfma_f32_16x16x32_bf16 v[48:51], a[80:83], a[16:19], v[48:51]
ds_read_b128 a[104:107], v1 offset:26624
v_mfma_f32_16x16x32_bf16 v[48:51], a[84:87], a[20:23], v[48:51]
s_waitcnt lgkmcnt(4)
v_add_f32 v32, v32, v16
v_add_f32 v33, v33, v16
v_add_f32 v34, v34, v16
v_add_f32 v35, v35, v16
v_mfma_f32_16x16x32_bf16 v[48:51], a[88:91], a[24:27], v[48:51]
s_waitcnt lgkmcnt(3)
ds_read_b128 a[108:111], v1 offset:27648
v_add_f32 v36, v36, v20
v_add_f32 v37, v37, v20
v_add_f32 v38, v38, v20
v_add_f32 v39, v39, v20
v_mfma_f32_16x16x32_bf16 v[48:51], a[92:95], a[28:31], v[48:51]
v_add_f32 v40, v40, v16
v_add_f32 v41, v41, v16
v_add_f32 v42, v42, v16
v_add_f32 v43, v43, v16
v_mfma_f32_16x16x32_bf16 v[52:55], a[64:67], a[32:35], v[20:23]
ds_read_b128 a[112:115], v1 offset:28672
v_add_f32 v44, v44, v20
v_add_f32 v45, v45, v20
v_add_f32 v46, v46, v20
v_add_f32 v47, v47, v20
v_mfma_f32_16x16x32_bf16 v[52:55], a[68:71], a[36:39], v[52:55]
v_exp_f32 v8, v32
v_mfma_f32_16x16x32_bf16 v[52:55], a[72:75], a[40:43], v[52:55]
ds_read_b128 a[116:119], v1 offset:29696
v_exp_f32 v9, v33
v_mfma_f32_16x16x32_bf16 v[52:55], a[76:79], a[44:47], v[52:55]
v_exp_f32 v10, v34
v_add_f32 v26, v8, v9
v_cvt_pk_bf16_f32 v96, v8, v9
v_mfma_f32_16x16x32_bf16 v[52:55], a[80:83], a[48:51], v[52:55]
ds_read_b128 a[120:123], v1 offset:30720
v_exp_f32 v11, v35
v_add_f32 v26, v26, v10
v_mfma_f32_16x16x32_bf16 v[52:55], a[84:87], a[52:55], v[52:55]
v_exp_f32 v12, v36
v_add_f32 v26, v26, v11
v_cvt_pk_bf16_f32 v97, v10, v11
v_mfma_f32_16x16x32_bf16 v[52:55], a[88:91], a[56:59], v[52:55]
s_waitcnt vmcnt(8) lgkmcnt(4)
ds_read_b128 a[124:127], v1 offset:31744
v_exp_f32 v13, v37
v_mfma_f32_16x16x32_bf16 v[52:55], a[92:95], a[60:63], v[52:55]
s_barrier
v_mfma_f32_16x16x32_bf16 v[56:59], a[96:99], a[0:3], v[16:19]
ds_read_b128 a[64:67], v4 offset:0
v_exp_f32 v14, v38
v_mfma_f32_16x16x32_bf16 v[56:59], a[100:103], a[4:7], v[56:59]
buffer_store_dword v6, v5, s[4:7], s71 offen sc1
v_mfma_f32_16x16x32_bf16 v[56:59], a[104:107], a[8:11], v[56:59]
s_waitcnt lgkmcnt(4)
ds_read_b128 a[68:71], v4 offset:1024
v_add_f32 v27, v12, v13
v_cvt_pk_bf16_f32 v104, v12, v13
v_add_f32 v27, v27, v14
v_mfma_f32_16x16x32_bf16 v[56:59], a[108:111], a[12:15], v[56:59]
v_exp_f32 v15, v39
v_mfma_f32_16x16x32_bf16 v[56:59], a[112:115], a[16:19], v[56:59]
s_waitcnt lgkmcnt(4)
ds_read_b128 a[72:75], v4 offset:2048
v_exp_f32 v8, v40
v_add_f32 v27, v27, v15
v_cvt_pk_bf16_f32 v105, v14, v15
v_mfma_f32_16x16x32_bf16 v[56:59], a[116:119], a[20:23], v[56:59]
s_waitcnt lgkmcnt(4)
v_exp_f32 v9, v41
v_add_f32 v26, v26, v8
v_mfma_f32_16x16x32_bf16 v[56:59], a[120:123], a[24:27], v[56:59]
s_waitcnt lgkmcnt(3)
ds_read_b128 a[76:79], v4 offset:3072
v_exp_f32 v10, v42
v_add_f32 v26, v26, v9
v_cvt_pk_bf16_f32 v98, v8, v9
v_mfma_f32_16x16x32_bf16 v[56:59], a[124:127], a[28:31], v[56:59]
v_exp_f32 v11, v43
v_add_f32 v26, v26, v10
v_mfma_f32_16x16x32_bf16 v[60:63], a[96:99], a[32:35], v[20:23]
ds_read_b128 a[80:83], v4 offset:4096
v_exp_f32 v12, v44
v_mfma_f32_16x16x32_bf16 v[60:63], a[100:103], a[36:39], v[60:63]
v_exp_f32 v13, v45
v_mfma_f32_16x16x32_bf16 v[60:63], a[104:107], a[40:43], v[60:63]
ds_read_b128 a[84:87], v4 offset:5120
v_exp_f32 v14, v46
v_mfma_f32_16x16x32_bf16 v[60:63], a[108:111], a[44:47], v[60:63]
v_exp_f32 v15, v47
v_mfma_f32_16x16x32_bf16 v[60:63], a[112:115], a[48:51], v[60:63]
ds_read_b128 a[88:91], v4 offset:6144
v_add_f32 v26, v26, v11
v_cvt_pk_bf16_f32 v99, v10, v11
v_mfma_f32_16x16x32_bf16 v[60:63], a[116:119], a[52:55], v[60:63]
v_add_f32 v27, v27, v12
v_add_f32 v27, v27, v13
v_cvt_pk_bf16_f32 v106, v12, v13
v_mfma_f32_16x16x32_bf16 v[60:63], a[120:123], a[56:59], v[60:63]
s_waitcnt lgkmcnt(7)
s_barrier
ds_read_b128 a[92:95], v4 offset:7168
v_mfma_f32_16x16x32_bf16 v[60:63], a[124:127], a[60:63], v[60:63]
s_waitcnt lgkmcnt(4)
v_add_f32 v27, v27, v14
v_add_f32 v27, v27, v15
v_cvt_pk_bf16_f32 v107, v14, v15
K2_x1:
v_mfma_f32_16x16x32_bf16 v[64:67], a[64:67], a[0:3], v[16:19]
s_add_u32 m0, s18, 0
ds_read_b128 a[96:99], v4 offset:8192
v_mfma_f32_16x16x32_bf16 v[64:67], a[68:71], a[4:7], v[64:67]
s_waitcnt lgkmcnt(4)
buffer_load_dwordx4 v1, s[4:7], s8 offen offset:0 sc1 lds
v_mfma_f32_16x16x32_bf16 v[64:67], a[72:75], a[8:11], v[64:67]
ds_read_b128 a[100:103], v4 offset:9216
v_mfma_f32_16x16x32_bf16 v[64:67], a[76:79], a[12:15], v[64:67]
s_waitcnt lgkmcnt(4)
v_exp_f32 v8, v48
v_mfma_f32_16x16x32_bf16 v[64:67], a[80:83], a[16:19], v[64:67]
ds_read_b128 a[104:107], v4 offset:10240
v_add_f32 v26, v26, v8
v_mfma_f32_16x16x32_bf16 v[64:67], a[84:87], a[20:23], v[64:67]
s_waitcnt lgkmcnt(4)
buffer_load_dwordx4 v1, s[4:7], s8 offen offset:1024 sc1 lds
v_mfma_f32_16x16x32_bf16 v[64:67], a[88:91], a[24:27], v[64:67]
s_waitcnt lgkmcnt(3)
ds_read_b128 a[108:111], v4 offset:11264
v_mfma_f32_16x16x32_bf16 v[64:67], a[92:95], a[28:31], v[64:67]
v_exp_f32 v9, v49
v_mfma_f32_16x16x32_bf16 v[68:71], a[64:67], a[32:35], v[20:23]
ds_read_b128 a[112:115], v4 offset:12288
v_add_f32 v26, v26, v9
v_mfma_f32_16x16x32_bf16 v[68:71], a[68:71], a[36:39], v[68:71]
buffer_load_dwordx4 v1, s[4:7], s8 offen offset:2048 sc1 lds
v_mfma_f32_16x16x32_bf16 v[68:71], a[72:75], a[40:43], v[68:71]
ds_read_b128 a[116:119], v4 offset:13312
v_cvt_pk_bf16_f32 v100, v8, v9
v_mfma_f32_16x16x32_bf16 v[68:71], a[76:79], a[44:47], v[68:71]
v_exp_f32 v10, v50
v_mfma_f32_16x16x32_bf16 v[68:71], a[80:83], a[48:51], v[68:71]
ds_read_b128 a[120:123], v4 offset:14336
v_add_f32 v26, v26, v10
v_mfma_f32_16x16x32_bf16 v[68:71], a[84:87], a[52:55], v[68:71]
buffer_load_dwordx4 v1, s[4:7], s8 offen offset:3072 sc1 lds
v_mfma_f32_16x16x32_bf16 v[68:71], a[88:91], a[56:59], v[68:71]
s_add_u32 s8, s8, 4096
ds_read_b128 a[124:127], v4 offset:15360
v_mfma_f32_16x16x32_bf16 v[68:71], a[92:95], a[60:63], v[68:71]
s_waitcnt lgkmcnt(4)
v_exp_f32 v11, v51
v_mfma_f32_16x16x32_bf16 v[72:75], a[96:99], a[0:3], v[16:19]
s_add_u32 m0, s18, 4096
ds_read_b128 a[64:67], v4 offset:16384
v_add_f32 v26, v26, v11
v_mfma_f32_16x16x32_bf16 v[72:75], a[100:103], a[4:7], v[72:75]
buffer_load_dwordx4 v1, s[4:7], s8 offen offset:0 sc1 lds
v_mfma_f32_16x16x32_bf16 v[72:75], a[104:107], a[8:11], v[72:75]
ds_read_b128 a[68:71], v4 offset:17408
v_cvt_pk_bf16_f32 v101, v10, v11
v_mfma_f32_16x16x32_bf16 v[72:75], a[108:111], a[12:15], v[72:75]
s_waitcnt lgkmcnt(4)
v_mfma_f32_16x16x32_bf16 v[72:75], a[112:115], a[16:19], v[72:75]
ds_read_b128 a[72:75], v4 offset:18432
v_mfma_f32_16x16x32_bf16 v[72:75], a[116:119], a[20:23], v[72:75]
s_waitcnt lgkmcnt(4)
buffer_load_dwordx4 v1, s[4:7], s8 offen offset:1024 sc1 lds
v_mfma_f32_16x16x32_bf16 v[72:75], a[120:123], a[24:27], v[72:75]
s_waitcnt lgkmcnt(3)
ds_read_b128 a[76:79], v4 offset:19456
v_mfma_f32_16x16x32_bf16 v[72:75], a[124:127], a[28:31], v[72:75]
v_exp_f32 v12, v52
v_mfma_f32_16x16x32_bf16 v[76:79], a[96:99], a[32:35], v[20:23]
ds_read_b128 a[80:83], v4 offset:20480
v_add_f32 v27, v27, v12
v_mfma_f32_16x16x32_bf16 v[76:79], a[100:103], a[36:39], v[76:79]
buffer_load_dwordx4 v1, s[4:7], s8 offen offset:2048 sc1 lds
v_mfma_f32_16x16x32_bf16 v[76:79], a[104:107], a[40:43], v[76:79]
ds_read_b128 a[84:87], v4 offset:21504
v_mfma_f32_16x16x32_bf16 v[76:79], a[108:111], a[44:47], v[76:79]
v_exp_f32 v13, v53
v_mfma_f32_16x16x32_bf16 v[76:79], a[112:115], a[48:51], v[76:79]
ds_read_b128 a[88:91], v4 offset:22528
v_add_f32 v27, v27, v13
v_mfma_f32_16x16x32_bf16 v[76:79], a[116:119], a[52:55], v[76:79]
s_waitcnt lgkmcnt(3)
buffer_load_dwordx4 v1, s[4:7], s8 offen offset:3072 sc1 lds
v_mfma_f32_16x16x32_bf16 v[76:79], a[120:123], a[56:59], v[76:79]
s_add_u32 s8, s8, 28672
ds_read_b128 a[92:95], v4 offset:23552
v_cvt_pk_bf16_f32 v108, v12, v13
v_mfma_f32_16x16x32_bf16 v[76:79], a[124:127], a[60:63], v[76:79]
s_sub_u32 s9, s9, 1
v_exp_f32 v14, v54
v_mfma_f32_16x16x32_bf16 v[80:83], a[64:67], a[0:3], v[16:19]
s_cmp_eq_u32 s9, 0
ds_read_b128 a[96:99], v4 offset:24576
v_add_f32 v27, v27, v14
v_mfma_f32_16x16x32_bf16 v[80:83], a[68:71], a[4:7], v[80:83]
s_cselect_b32 s8, s10, s8
v_exp_f32 v15, v55
v_mfma_f32_16x16x32_bf16 v[80:83], a[72:75], a[8:11], v[80:83]
s_cselect_b32 s9, s11, s9
ds_read_b128 a[100:103], v4 offset:25600
v_add_f32 v27, v27, v15
v_mfma_f32_16x16x32_bf16 v[80:83], a[76:79], a[12:15], v[80:83]
s_waitcnt lgkmcnt(4)
s_cselect_b32 s10, 3221225472, s10
v_cvt_pk_bf16_f32 v109, v14, v15
v_mfma_f32_16x16x32_bf16 v[80:83], a[80:83], a[16:19], v[80:83]
ds_read_b128 a[104:107], v4 offset:26624
v_mfma_f32_16x16x32_bf16 v[80:83], a[84:87], a[20:23], v[80:83]
s_waitcnt lgkmcnt(4)
v_exp_f32 v8, v56
v_mfma_f32_16x16x32_bf16 v[80:83], a[88:91], a[24:27], v[80:83]
s_waitcnt lgkmcnt(3)
ds_read_b128 a[108:111], v4 offset:27648
v_add_f32 v26, v26, v8
v_mfma_f32_16x16x32_bf16 v[80:83], a[92:95], a[28:31], v[80:83]
v_exp_f32 v9, v57
v_mfma_f32_16x16x32_bf16 v[84:87], a[64:67], a[32:35], v[20:23]
ds_read_b128 a[112:115], v4 offset:28672
v_add_f32 v26, v26, v9
v_mfma_f32_16x16x32_bf16 v[84:87], a[68:71], a[36:39], v[84:87]
v_exp_f32 v10, v58
v_mfma_f32_16x16x32_bf16 v[84:87], a[72:75], a[40:43], v[84:87]
ds_read_b128 a[116:119], v4 offset:29696
v_cvt_pk_bf16_f32 v102, v8, v9
v_mfma_f32_16x16x32_bf16 v[84:87], a[76:79], a[44:47], v[84:87]
v_exp_f32 v11, v59
v_mfma_f32_16x16x32_bf16 v[84:87], a[80:83], a[48:51], v[84:87]
ds_read_b128 a[120:123], v4 offset:30720
v_add_f32 v26, v26, v10
v_mfma_f32_16x16x32_bf16 v[84:87], a[84:87], a[52:55], v[84:87]
v_add_f32 v26, v26, v11
v_cvt_pk_bf16_f32 v103, v10, v11
v_mfma_f32_16x16x32_bf16 v[84:87], a[88:91], a[56:59], v[84:87]
s_waitcnt vmcnt(8) lgkmcnt(4)
ds_read_b128 a[124:127], v4 offset:31744
v_mfma_f32_16x16x32_bf16 v[84:87], a[92:95], a[60:63], v[84:87]
s_barrier
v_mfma_f32_16x16x32_bf16 v[88:91], a[96:99], a[0:3], v[16:19]
ds_read_b128 a[64:67], v2 offset:0
v_mfma_f32_16x16x32_bf16 v[88:91], a[100:103], a[4:7], v[88:91]
v_exp_f32 v12, v60
v_mfma_f32_16x16x32_bf16 v[88:91], a[104:107], a[8:11], v[88:91]
s_waitcnt lgkmcnt(4)
ds_read_b128 a[68:71], v2 offset:1024
v_add_f32 v27, v27, v12
v_mfma_f32_16x16x32_bf16 v[88:91], a[108:111], a[12:15], v[88:91]
v_exp_f32 v13, v61
v_mfma_f32_16x16x32_bf16 v[88:91], a[112:115], a[16:19], v[88:91]
s_waitcnt lgkmcnt(4)
ds_read_b128 a[72:75], v2 offset:2048
v_add_f32 v27, v27, v13
v_mfma_f32_16x16x32_bf16 v[88:91], a[116:119], a[20:23], v[88:91]
s_waitcnt lgkmcnt(4)
v_exp_f32 v14, v62
v_mfma_f32_16x16x32_bf16 v[88:91], a[120:123], a[24:27], v[88:91]
s_waitcnt lgkmcnt(3)
ds_read_b128 a[76:79], v2 offset:3072
v_cvt_pk_bf16_f32 v110, v12, v13
v_mfma_f32_16x16x32_bf16 v[88:91], a[124:127], a[28:31], v[88:91]
v_exp_f32 v15, v63
v_mfma_f32_16x16x32_bf16 v[92:95], a[96:99], a[32:35], v[20:23]
s_sub_u32 s19, s19, 1
ds_read_b128 a[80:83], v2 offset:4096
v_add_f32 v27, v27, v14
v_mfma_f32_16x16x32_bf16 v[92:95], a[100:103], a[36:39], v[92:95]
v_add_f32 v27, v27, v15
v_cvt_pk_bf16_f32 v111, v14, v15
v_mfma_f32_16x16x32_bf16 v[92:95], a[104:107], a[40:43], v[92:95]
ds_read_b128 a[84:87], v2 offset:5120
v_add_f32 v28, v26, v27
v_mfma_f32_16x16x32_bf16 v[92:95], a[108:111], a[44:47], v[92:95]
v_cmp_nge_f32 vcc, s25, v28
v_mfma_f32_16x16x32_bf16 v[92:95], a[112:115], a[48:51], v[92:95]
s_cmp_eq_u64 vcc, 0
ds_read_b128 a[88:91], v2 offset:6144
v_mfma_f32_16x16x32_bf16 v[92:95], a[116:119], a[52:55], v[92:95]
s_cselect_b32 s22, s19, 0
v_mfma_f32_16x16x32_bf16 v[92:95], a[120:123], a[56:59], v[92:95]
s_cmp_eq_u32 s22, 0
ds_read_b128 a[92:95], v2 offset:7168
v_mfma_f32_16x16x32_bf16 v[92:95], a[124:127], a[60:63], v[92:95]
s_waitcnt lgkmcnt(4)
s_cbranch_scc1 K2_xexit
K2_loop:
v_mfma_f32_16x16x32_bf16 v[128:131], a[64:67], v[96:99], v[128:131]
s_add_u32 m0, s18, 98304
ds_read_b128 a[96:99], v2 offset:8192
v_add_f32 v24, v24, v26
v_mfma_f32_16x16x32_bf16 v[128:131], a[68:71], v[100:103], v[128:131]
buffer_load_dwordx4 v1, s[4:7], s12 offen offset:0 sc1 lds
v_mfma_f32_16x16x32_bf16 v[132:135], a[68:71], v[108:111], v[132:135]
ds_read_b128 a[100:103], v2 offset:9216
v_add_f32 v25, v25, v27
v_mfma_f32_16x16x32_bf16 v[132:135], a[64:67], v[104:107], v[132:135]
v_exp_f32 v8, v64
v_mfma_f32_16x16x32_bf16 v[136:139], a[72:75], v[96:99], v[136:139]
ds_read_b128 a[104:107], v2 offset:10240
v_mfma_f32_16x16x32_bf16 v[136:139], a[76:79], v[100:103], v[136:139]
buffer_load_dwordx4 v1, s[4:7], s12 offen offset:1024 sc1 lds
v_mfma_f32_16x16x32_bf16 v[140:143], a[76:79], v[108:111], v[140:143]
ds_read_b128 a[108:111], v2 offset:11264
v_mfma_f32_16x16x32_bf16 v[140:143], a[72:75], v[104:107], v[140:143]
s_waitcnt lgkmcnt(4)
v_exp_f32 v9, v65
v_mfma_f32_16x16x32_bf16 v[144:147], a[80:83], v[96:99], v[144:147]
ds_read_b128 a[112:115], v2 offset:12288
v_add_f32 v26, v8, v9
v_mfma_f32_16x16x32_bf16 v[144:147], a[84:87], v[100:103], v[144:147]
buffer_load_dwordx4 v1, s[4:7], s12 offen offset:2048 sc1 lds
v_mfma_f32_16x16x32_bf16 v[148:151], a[84:87], v[108:111], v[148:151]
ds_read_b128 a[116:119], v2 offset:13312
v_cvt_pk_bf16_f32 v112, v8, v9
v_mfma_f32_16x16x32_bf16 v[148:151], a[80:83], v[104:107], v[148:151]
v_exp_f32 v10, v66
v_mfma_f32_16x16x32_bf16 v[152:155], a[88:91], v[96:99], v[152:155]
PAD_10:
s_cbranch_execz M_tret
ds_read_b128 a[120:123], v2 offset:14336
v_add_f32 v26, v26, v10
v_mfma_f32_16x16x32_bf16 v[152:155], a[92:95], v[100:103], v[152:155]
buffer_load_dwordx4 v1, s[4:7], s12 offen offset:3072 sc1 lds
v_mfma_f32_16x16x32_bf16 v[156:159], a[92:95], v[108:111], v[156:159]
s_add_u32 s12, s12, 4096
ds_read_b128 a[124:127], v2 offset:15360
v_mfma_f32_16x16x32_bf16 v[156:159], a[88:91], v[104:107], v[156:159]
s_waitcnt lgkmcnt(4)
v_exp_f32 v11, v67
v_mfma_f32_16x16x32_bf16 v[160:163], a[96:99], v[96:99], v[160:163]
s_add_u32 m0, s18, 102400
ds_read_b128 a[64:67], v2 offset:16384
v_add_f32 v26, v26, v11
v_mfma_f32_16x16x32_bf16 v[160:163], a[100:103], v[100:103], v[160:163]
buffer_load_dwordx4 v1, s[4:7], s12 offen offset:0 sc1 lds
v_mfma_f32_16x16x32_bf16 v[164:167], a[100:103], v[108:111], v[164:167]
ds_read_b128 a[68:71], v2 offset:17408
v_cvt_pk_bf16_f32 v113, v10, v11
v_mfma_f32_16x16x32_bf16 v[164:167], a[96:99], v[104:107], v[164:167]
v_mfma_f32_16x16x32_bf16 v[168:171], a[104:107], v[96:99], v[168:171]
ds_read_b128 a[72:75], v2 offset:18432
v_mfma_f32_16x16x32_bf16 v[168:171], a[108:111], v[100:103], v[168:171]
buffer_load_dwordx4 v1, s[4:7], s12 offen offset:1024 sc1 lds
v_mfma_f32_16x16x32_bf16 v[172:175], a[108:111], v[108:111], v[172:175]
ds_read_b128 a[76:79], v2 offset:19456
v_mfma_f32_16x16x32_bf16 v[172:175], a[104:107], v[104:107], v[172:175]
s_waitcnt lgkmcnt(4)
v_exp_f32 v12, v68
v_mfma_f32_16x16x32_bf16 v[176:179], a[112:115], v[96:99], v[176:179]
ds_read_b128 a[80:83], v2 offset:20480
v_mfma_f32_16x16x32_bf16 v[176:179], a[116:119], v[100:103], v[176:179]
buffer_load_dwordx4 v1, s[4:7], s12 offen offset:2048 sc1 lds
v_mfma_f32_16x16x32_bf16 v[180:183], a[116:119], v[108:111], v[180:183]
ds_read_b128 a[84:87], v2 offset:21504
v_mfma_f32_16x16x32_bf16 v[180:183], a[112:115], v[104:107], v[180:183]
v_exp_f32 v13, v69
v_mfma_f32_16x16x32_bf16 v[184:187], a[120:123], v[96:99], v[184:187]
ds_read_b128 a[88:91], v2 offset:22528
v_add_f32 v27, v12, v13
v_mfma_f32_16x16x32_bf16 v[184:187], a[124:127], v[100:103], v[184:187]
s_waitcnt lgkmcnt(4)
buffer_load_dwordx4 v1, s[4:7], s12 offen offset:3072 sc1 lds
v_mfma_f32_16x16x32_bf16 v[188:191], a[124:127], v[108:111], v[188:191]
s_add_u32 s12, s12, 28672
ds_read_b128 a[92:95], v2 offset:23552
v_cvt_pk_bf16_f32 v120, v12, v13
v_mfma_f32_16x16x32_bf16 v[188:191], a[120:123], v[104:107], v[188:191]
s_sub_u32 s13, s13, 1
v_exp_f32 v14, v70
v_mfma_f32_16x16x32_bf16 v[192:195], a[64:67], v[96:99], v[192:195]
s_cmp_eq_u32 s13, 0
ds_read_b128 a[96:99], v2 offset:24576
v_add_f32 v27, v27, v14
v_mfma_f32_16x16x32_bf16 v[192:195], a[68:71], v[100:103], v[192:195]
s_cselect_b32 s12, s14, s12
v_mfma_f32_16x16x32_bf16 v[196:199], a[68:71], v[108:111], v[196:199]
s_cselect_b32 s13, s15, s13
ds_read_b128 a[100:103], v2 offset:25600
v_mfma_f32_16x16x32_bf16 v[196:199], a[64:67], v[104:107], v[196:199]
s_cselect_b32 s14, 3221225472, s14
v_exp_f32 v15, v71
v_mfma_f32_16x16x32_bf16 v[200:203], a[72:75], v[96:99], v[200:203]
s_waitcnt lgkmcnt(4)
ds_read_b128 a[104:107], v2 offset:26624
v_add_f32 v27, v27, v15
v_mfma_f32_16x16x32_bf16 v[200:203], a[76:79], v[100:103], v[200:203]
v_exp_f32 v8, v72
v_mfma_f32_16x16x32_bf16 v[204:207], a[76:79], v[108:111], v[204:207]
ds_read_b128 a[108:111], v2 offset:27648
v_cvt_pk_bf16_f32 v121, v14, v15
v_mfma_f32_16x16x32_bf16 v[204:207], a[72:75], v[104:107], v[204:207]
v_exp_f32 v9, v73
v_mfma_f32_16x16x32_bf16 v[208:211], a[80:83], v[96:99], v[208:211]
ds_read_b128 a[112:115], v2 offset:28672
v_add_f32 v26, v26, v8
v_mfma_f32_16x16x32_bf16 v[208:211], a[84:87], v[100:103], v[208:211]
v_add_f32 v26, v26, v9
v_cvt_pk_bf16_f32 v114, v8, v9
v_mfma_f32_16x16x32_bf16 v[212:215], a[84:87], v[108:111], v[212:215]
ds_read_b128 a[116:119], v2 offset:29696
v_mfma_f32_16x16x32_bf16 v[212:215], a[80:83], v[104:107], v[212:215]
s_waitcnt lgkmcnt(4)
v_exp_f32 v10, v74
v_mfma_f32_16x16x32_bf16 v[216:219], a[88:91], v[96:99], v[216:219]
ds_read_b128 a[120:123], v2 offset:30720
v_add_f32 v26, v26, v10
v_mfma_f32_16x16x32_bf16 v[216:219], a[92:95], v[100:103], v[216:219]
v_exp_f32 v11, v75
v_mfma_f32_16x16x32_bf16 v[220:223], a[92:95], v[108:111], v[220:223]
s_waitcnt vmcnt(8)
ds_read_b128 a[124:127], v2 offset:31744
v_add_f32 v26, v26, v11
v_mfma_f32_16x16x32_bf16 v[220:223], a[88:91], v[104:107], v[220:223]
s_barrier
v_mfma_f32_16x16x32_bf16 v[224:227], a[96:99], v[96:99], v[224:227]
ds_read_b128 a[64:67], v1 offset:0
v_cvt_pk_bf16_f32 v115, v10, v11
v_mfma_f32_16x16x32_bf16 v[224:227], a[100:103], v[100:103], v[224:227]
v_exp_f32 v12, v76
v_mfma_f32_16x16x32_bf16 v[228:231], a[100:103], v[108:111], v[228:231]
ds_read_b128 a[68:71], v1 offset:1024
v_add_f32 v27, v27, v12
v_mfma_f32_16x16x32_bf16 v[228:231], a[96:99], v[104:107], v[228:231]
s_waitcnt lgkmcnt(4)
v_mfma_f32_16x16x32_bf16 v[232:235], a[104:107], v[96:99], v[232:235]
ds_read_b128 a[72:75], v1 offset:2048
v_mfma_f32_16x16x32_bf16 v[232:235], a[108:111], v[100:103], v[232:235]
v_exp_f32 v13, v77
v_mfma_f32_16x16x32_bf16 v[236:239], a[108:111], v[108:111], v[236:239]
ds_read_b128 a[76:79], v1 offset:3072
v_add_f32 v27, v27, v13
v_mfma_f32_16x16x32_bf16 v[236:239], a[104:107], v[104:107], v[236:239]
v_exp_f32 v14, v78
v_mfma_f32_16x16x32_bf16 v[240:243], a[112:115], v[96:99], v[240:243]
ds_read_b128 a[80:83], v1 offset:4096
v_cvt_pk_bf16_f32 v122, v12, v13
v_mfma_f32_16x16x32_bf16 v[240:243], a[116:119], v[100:103], v[240:243]
v_exp_f32 v15, v79
v_mfma_f32_16x16x32_bf16 v[244:247], a[116:119], v[108:111], v[244:247]
ds_read_b128 a[84:87], v1 offset:5120
v_add_f32 v27, v27, v14
v_mfma_f32_16x16x32_bf16 v[244:247], a[112:115], v[104:107], v[244:247]
s_waitcnt lgkmcnt(4)
v_add_f32 v27, v27, v15
v_cvt_pk_bf16_f32 v123, v14, v15
v_mfma_f32_16x16x32_bf16 v[248:251], a[120:123], v[96:99], v[248:251]
ds_read_b128 a[88:91], v1 offset:6144
v_mfma_f32_16x16x32_bf16 v[248:251], a[124:127], v[100:103], v[248:251]
v_mfma_f32_16x16x32_bf16 v[252:255], a[124:127], v[108:111], v[252:255]
ds_read_b128 a[92:95], v1 offset:7168
v_mfma_f32_16x16x32_bf16 v[252:255], a[120:123], v[104:107], v[252:255]
K2_x0:
v_mfma_f32_16x16x32_bf16 v[32:35], a[64:67], a[0:3], v[16:19]
s_add_u32 m0, s18, 131072
ds_read_b128 a[96:99], v1 offset:8192
v_mfma_f32_16x16x32_bf16 v[32:35], a[68:71], a[4:7], v[32:35]
s_waitcnt lgkmcnt(4)
buffer_load_dwordx4 v1, s[4:7], s8 offen offset:0 sc1 lds
v_mfma_f32_16x16x32_bf16 v[32:35], a[72:75], a[8:11], v[32:35]
ds_read_b128 a[100:103], v1 offset:9216
v_mfma_f32_16x16x32_bf16 v[32:35], a[76:79], a[12:15], v[32:35]
v_exp_f32 v8, v80
v_mfma_f32_16x16x32_bf16 v[32:35], a[80:83], a[16:19], v[32:35]
s_waitcnt lgkmcnt(4)
ds_read_b128 a[104:107], v1 offset:10240
v_add_f32 v26, v26, v8
v_mfma_f32_16x16x32_bf16 v[32:35], a[84:87], a[20:23], v[32:35]
s_waitcnt lgkmcnt(4)
buffer_load_dwordx4 v1, s[4:7], s8 offen offset:1024 sc1 lds
v_mfma_f32_16x16x32_bf16 v[32:35], a[88:91], a[24:27], v[32:35]
s_waitcnt lgkmcnt(3)
ds_read_b128 a[108:111], v1 offset:11264
v_mfma_f32_16x16x32_bf16 v[32:35], a[92:95], a[28:31], v[32:35]
v_exp_f32 v9, v81
v_mfma_f32_16x16x32_bf16 v[36:39], a[64:67], a[32:35], v[20:23]
ds_read_b128 a[112:115], v1 offset:12288
v_add_f32 v26, v26, v9
v_mfma_f32_16x16x32_bf16 v[36:39], a[68:71], a[36:39], v[36:39]
buffer_load_dwordx4 v1, s[4:7], s8 offen offset:2048 sc1 lds
v_mfma_f32_16x16x32_bf16 v[36:39], a[72:75], a[40:43], v[36:39]
ds_read_b128 a[116:119], v1 offset:13312
v_cvt_pk_bf16_f32 v116, v8, v9
v_mfma_f32_16x16x32_bf16 v[36:39], a[76:79], a[44:47], v[36:39]
v_exp_f32 v10, v82
v_mfma_f32_16x16x32_bf16 v[36:39], a[80:83], a[48:51], v[36:39]
ds_read_b128 a[120:123], v1 offset:14336
v_add_f32 v26, v26, v10
v_mfma_f32_16x16x32_bf16 v[36:39], a[84:87], a[52:55], v[36:39]
buffer_load_dwordx4 v1, s[4:7], s8 offen offset:3072 sc1 lds
v_mfma_f32_16x16x32_bf16 v[36:39], a[88:91], a[56:59], v[36:39]
s_add_u32 s8, s8, 4096
ds_read_b128 a[124:127], v1 offset:15360
v_mfma_f32_16x16x32_bf16 v[36:39], a[92:95], a[60:63], v[36:39]
s_waitcnt lgkmcnt(4)
v_exp_f32 v11, v83
v_mfma_f32_16x16x32_bf16 v[40:43], a[96:99], a[0:3], v[16:19]
s_add_u32 m0, s18, 135168
ds_read_b128 a[64:67], v1 offset:16384
v_add_f32 v26, v26, v11
v_mfma_f32_16x16x32_bf16 v[40:43], a[100:103], a[4:7], v[40:43]
buffer_load_dwordx4 v1, s[4:7], s8 offen offset:0 sc1 lds
v_mfma_f32_16x16x32_bf16 v[40:43], a[104:107], a[8:11], v[40:43]
ds_read_b128 a[68:71], v1 offset:17408
v_cvt_pk_bf16_f32 v117, v10, v11
v_mfma_f32_16x16x32_bf16 v[40:43], a[108:111], a[12:15], v[40:43]
s_waitcnt lgkmcnt(4)
v_mfma_f32_16x16x32_bf16 v[40:43], a[112:115], a[16:19], v[40:43]
ds_read_b128 a[72:75], v1 offset:18432
v_mfma_f32_16x16x32_bf16 v[40:43], a[116:119], a[20:23], v[40:43]
s_waitcnt lgkmcnt(4)
buffer_load_dwordx4 v1, s[4:7], s8 offen offset:1024 sc1 lds
v_mfma_f32_16x16x32_bf16 v[40:43], a[120:123], a[24:27], v[40:43]
s_waitcnt lgkmcnt(3)
ds_read_b128 a[76:79], v1 offset:19456
v_mfma_f32_16x16x32_bf16 v[40:43], a[124:127], a[28:31], v[40:43]
v_exp_f32 v12, v84
v_mfma_f32_16x16x32_bf16 v[44:47], a[96:99], a[32:35], v[20:23]
ds_read_b128 a[80:83], v1 offset:20480
v_add_f32 v27, v27, v12
v_mfma_f32_16x16x32_bf16 v[44:47], a[100:103], a[36:39], v[44:47]
buffer_load_dwordx4 v1, s[4:7], s8 offen offset:2048 sc1 lds
v_mfma_f32_16x16x32_bf16 v[44:47], a[104:107], a[40:43], v[44:47]
ds_read_b128 a[84:87], v1 offset:21504
v_mfma_f32_16x16x32_bf16 v[44:47], a[108:111], a[44:47], v[44:47]
v_exp_f32 v13, v85
v_mfma_f32_16x16x32_bf16 v[44:47], a[112:115], a[48:51], v[44:47]
ds_read_b128 a[88:91], v1 offset:22528
v_add_f32 v27, v27, v13
v_mfma_f32_16x16x32_bf16 v[44:47], a[116:119], a[52:55], v[44:47]
s_waitcnt lgkmcnt(3)
buffer_load_dwordx4 v1, s[4:7], s8 offen offset:3072 sc1 lds
v_mfma_f32_16x16x32_bf16 v[44:47], a[120:123], a[56:59], v[44:47]
s_add_u32 s8, s8, 28672
ds_read_b128 a[92:95], v1 offset:23552
v_cvt_pk_bf16_f32 v124, v12, v13
v_mfma_f32_16x16x32_bf16 v[44:47], a[124:127], a[60:63], v[44:47]
s_sub_u32 s9, s9, 1
v_exp_f32 v14, v86
v_mfma_f32_16x16x32_bf16 v[48:51], a[64:67], a[0:3], v[16:19]
s_cmp_eq_u32 s9, 0
ds_read_b128 a[96:99], v1 offset:24576
v_add_f32 v27, v27, v14
v_mfma_f32_16x16x32_bf16 v[48:51], a[68:71], a[4:7], v[48:51]
s_cselect_b32 s8, s10, s8
v_exp_f32 v15, v87
v_mfma_f32_16x16x32_bf16 v[48:51], a[72:75], a[8:11], v[48:51]
s_cselect_b32 s9, s11, s9
ds_read_b128 a[100:103], v1 offset:25600
v_add_f32 v27, v27, v15
v_mfma_f32_16x16x32_bf16 v[48:51], a[76:79], a[12:15], v[48:51]
s_waitcnt lgkmcnt(4)
s_cselect_b32 s10, 3221225472, s10
v_cvt_pk_bf16_f32 v125, v14, v15
v_mfma_f32_16x16x32_bf16 v[48:51], a[80:83], a[16:19], v[48:51]
ds_read_b128 a[104:107], v1 offset:26624
v_mfma_f32_16x16x32_bf16 v[48:51], a[84:87], a[20:23], v[48:51]
s_waitcnt lgkmcnt(4)
v_exp_f32 v8, v88
v_mfma_f32_16x16x32_bf16 v[48:51], a[88:91], a[24:27], v[48:51]
s_waitcnt lgkmcnt(3)
ds_read_b128 a[108:111], v1 offset:27648
v_add_f32 v26, v26, v8
v_mfma_f32_16x16x32_bf16 v[48:51], a[92:95], a[28:31], v[48:51]
v_exp_f32 v9, v89
v_mfma_f32_16x16x32_bf16 v[52:55], a[64:67], a[32:35], v[20:23]
ds_read_b128 a[112:115], v1 offset:28672
v_add_f32 v26, v26, v9
v_mfma_f32_16x16x32_bf16 v[52:55], a[68:71], a[36:39], v[52:55]
v_exp_f32 v10, v90
v_mfma_f32_16x16x32_bf16 v[52:55], a[72:75], a[40:43], v[52:55]
ds_read_b128 a[116:119], v1 offset:29696
v_cvt_pk_bf16_f32 v118, v8, v9
v_mfma_f32_16x16x32_bf16 v[52:55], a[76:79], a[44:47], v[52:55]
v_exp_f32 v11, v91
v_mfma_f32_16x16x32_bf16 v[52:55], a[80:83], a[48:51], v[52:55]
ds_read_b128 a[120:123], v1 offset:30720
v_add_f32 v26, v26, v10
v_mfma_f32_16x16x32_bf16 v[52:55], a[84:87], a[52:55], v[52:55]
v_add_f32 v26, v26, v11
v_cvt_pk_bf16_f32 v119, v10, v11
v_mfma_f32_16x16x32_bf16 v[52:55], a[88:91], a[56:59], v[52:55]
s_waitcnt vmcnt(8) lgkmcnt(4)
ds_read_b128 a[124:127], v1 offset:31744
v_mfma_f32_16x16x32_bf16 v[52:55], a[92:95], a[60:63], v[52:55]
s_barrier
v_mfma_f32_16x16x32_bf16 v[56:59], a[96:99], a[0:3], v[16:19]
ds_read_b128 a[64:67], v2 offset:32768
v_mfma_f32_16x16x32_bf16 v[56:59], a[100:103], a[4:7], v[56:59]
v_exp_f32 v12, v92
v_mfma_f32_16x16x32_bf16 v[56:59], a[104:107], a[8:11], v[56:59]
s_waitcnt lgkmcnt(4)
ds_read_b128 a[68:71], v2 offset:33792
v_add_f32 v27, v27, v12
v_mfma_f32_16x16x32_bf16 v[56:59], a[108:111], a[12:15], v[56:59]
v_exp_f32 v13, v93
v_mfma_f32_16x16x32_bf16 v[56:59], a[112:115], a[16:19], v[56:59]
s_waitcnt lgkmcnt(4)
ds_read_b128 a[72:75], v2 offset:34816
v_add_f32 v27, v27, v13
v_mfma_f32_16x16x32_bf16 v[56:59], a[116:119], a[20:23], v[56:59]
s_waitcnt lgkmcnt(4)
v_exp_f32 v14, v94
v_mfma_f32_16x16x32_bf16 v[56:59], a[120:123], a[24:27], v[56:59]
s_waitcnt lgkmcnt(3)
ds_read_b128 a[76:79], v2 offset:35840
v_cvt_pk_bf16_f32 v126, v12, v13
v_mfma_f32_16x16x32_bf16 v[56:59], a[124:127], a[28:31], v[56:59]
v_exp_f32 v15, v95
v_mfma_f32_16x16x32_bf16 v[60:63], a[96:99], a[32:35], v[20:23]
ds_read_b128 a[80:83], v2 offset:36864
v_add_f32 v27, v27, v14
v_mfma_f32_16x16x32_bf16 v[60:63], a[100:103], a[36:39], v[60:63]
v_add_f32 v27, v27, v15
v_cvt_pk_bf16_f32 v127, v14, v15
v_mfma_f32_16x16x32_bf16 v[60:63], a[104:107], a[40:43], v[60:63]
ds_read_b128 a[84:87], v2 offset:37888
v_add_f32 v28, v26, v27
v_mfma_f32_16x16x32_bf16 v[60:63], a[108:111], a[44:47], v[60:63]
v_cmp_nge_f32 vcc, s25, v28
v_mfma_f32_16x16x32_bf16 v[60:63], a[112:115], a[48:51], v[60:63]
ds_read_b128 a[88:91], v2 offset:38912
v_mfma_f32_16x16x32_bf16 v[60:63], a[116:119], a[52:55], v[60:63]
v_mfma_f32_16x16x32_bf16 v[60:63], a[120:123], a[56:59], v[60:63]
ds_read_b128 a[92:95], v2 offset:39936
v_mfma_f32_16x16x32_bf16 v[60:63], a[124:127], a[60:63], v[60:63]
s_waitcnt lgkmcnt(4)
s_cbranch_vccnz Lstub_2
Lback_3:
v_mfma_f32_16x16x32_bf16 v[128:131], a[64:67], v[112:115], v[128:131]
s_add_u32 m0, s18, 65536
ds_read_b128 a[96:99], v2 offset:40960
v_add_f32 v24, v24, v26
v_mfma_f32_16x16x32_bf16 v[128:131], a[68:71], v[116:119], v[128:131]
buffer_load_dwordx4 v1, s[4:7], s12 offen offset:0 sc1 lds
v_mfma_f32_16x16x32_bf16 v[132:135], a[68:71], v[124:127], v[132:135]
ds_read_b128 a[100:103], v2 offset:41984
v_add_f32 v25, v25, v27
v_mfma_f32_16x16x32_bf16 v[132:135], a[64:67], v[120:123], v[132:135]
v_exp_f32 v8, v32
v_mfma_f32_16x16x32_bf16 v[136:139], a[72:75], v[112:115], v[136:139]
ds_read_b128 a[104:107], v2 offset:43008
v_mfma_f32_16x16x32_bf16 v[136:139], a[76:79], v[116:119], v[136:139]
buffer_load_dwordx4 v1, s[4:7], s12 offen offset:1024 sc1 lds
v_mfma_f32_16x16x32_bf16 v[140:143], a[76:79], v[124:127], v[140:143]
ds_read_b128 a[108:111], v2 offset:44032
v_mfma_f32_16x16x32_bf16 v[140:143], a[72:75], v[120:123], v[140:143]
s_waitcnt lgkmcnt(4)
v_exp_f32 v9, v33
v_mfma_f32_16x16x32_bf16 v[144:147], a[80:83], v[112:115], v[144:147]
ds_read_b128 a[112:115], v2 offset:45056
v_add_f32 v26, v8, v9
v_mfma_f32_16x16x32_bf16 v[144:147], a[84:87], v[116:119], v[144:147]
buffer_load_dwordx4 v1, s[4:7], s12 offen offset:2048 sc1 lds
v_mfma_f32_16x16x32_bf16 v[148:151], a[84:87], v[124:127], v[148:151]
ds_read_b128 a[116:119], v2 offset:46080
v_cvt_pk_bf16_f32 v96, v8, v9
v_mfma_f32_16x16x32_bf16 v[148:151], a[80:83], v[120:123], v[148:151]
v_exp_f32 v10, v34
v_mfma_f32_16x16x32_bf16 v[152:155], a[88:91], v[112:115], v[152:155]
ds_read_b128 a[120:123], v2 offset:47104
v_add_f32 v26, v26, v10
v_mfma_f32_16x16x32_bf16 v[152:155], a[92:95], v[116:119], v[152:155]
buffer_load_dwordx4 v1, s[4:7], s12 offen offset:3072 sc1 lds
v_mfma_f32_16x16x32_bf16 v[156:159], a[92:95], v[124:127], v[156:159]
s_add_u32 s12, s12, 4096
ds_read_b128 a[124:127], v2 offset:48128
v_mfma_f32_16x16x32_bf16 v[156:159], a[88:91], v[120:123], v[156:159]
s_waitcnt lgkmcnt(4)
v_exp_f32 v11, v35
v_mfma_f32_16x16x32_bf16 v[160:163], a[96:99], v[112:115], v[160:163]
s_add_u32 m0, s18, 69632
ds_read_b128 a[64:67], v2 offset:49152
v_add_f32 v26, v26, v11
v_mfma_f32_16x16x32_bf16 v[160:163], a[100:103], v[116:119], v[160:163]
buffer_load_dwordx4 v1, s[4:7], s12 offen offset:0 sc1 lds
v_mfma_f32_16x16x32_bf16 v[164:167], a[100:103], v[124:127], v[164:167]
ds_read_b128 a[68:71], v2 offset:50176
v_cvt_pk_bf16_f32 v97, v10, v11
v_mfma_f32_16x16x32_bf16 v[164:167], a[96:99], v[120:123], v[164:167]
v_mfma_f32_16x16x32_bf16 v[168:171], a[104:107], v[112:115], v[168:171]
ds_read_b128 a[72:75], v2 offset:51200
v_mfma_f32_16x16x32_bf16 v[168:171], a[108:111], v[116:119], v[168:171]
buffer_load_dwordx4 v1, s[4:7], s12 offen offset:1024 sc1 lds
v_mfma_f32_16x16x32_bf16 v[172:175], a[108:111], v[124:127], v[172:175]
ds_read_b128 a[76:79], v2 offset:52224
v_mfma_f32_16x16x32_bf16 v[172:175], a[104:107], v[120:123], v[172:175]
s_waitcnt lgkmcnt(4)
v_exp_f32 v12, v36
v_mfma_f32_16x16x32_bf16 v[176:179], a[112:115], v[112:115], v[176:179]
ds_read_b128 a[80:83], v2 offset:53248
v_mfma_f32_16x16x32_bf16 v[176:179], a[116:119], v[116:119], v[176:179]
buffer_load_dwordx4 v1, s[4:7], s12 offen offset:2048 sc1 lds
v_mfma_f32_16x16x32_bf16 v[180:183], a[116:119], v[124:127], v[180:183]
ds_read_b128 a[84:87], v2 offset:54272
v_mfma_f32_16x16x32_bf16 v[180:183], a[112:115], v[120:123], v[180:183]
v_exp_f32 v13, v37
v_mfma_f32_16x16x32_bf16 v[184:187], a[120:123], v[112:115], v[184:187]
ds_read_b128 a[88:91], v2 offset:55296
v_add_f32 v27, v12, v13
v_mfma_f32_16x16x32_bf16 v[184:187], a[124:127], v[116:119], v[184:187]
s_waitcnt lgkmcnt(4)
buffer_load_dwordx4 v1, s[4:7], s12 offen offset:3072 sc1 lds
v_mfma_f32_16x16x32_bf16 v[188:191], a[124:127], v[124:127], v[188:191]
s_add_u32 s12, s12, 28672
ds_read_b128 a[92:95], v2 offset:56320
v_cvt_pk_bf16_f32 v104, v12, v13
v_mfma_f32_16x16x32_bf16 v[188:191], a[120:123], v[120:123], v[188:191]
s_sub_u32 s13, s13, 1
v_exp_f32 v14, v38
v_mfma_f32_16x16x32_bf16 v[192:195], a[64:67], v[112:115], v[192:195]
s_cmp_eq_u32 s13, 0
ds_read_b128 a[96:99], v2 offset:57344
v_add_f32 v27, v27, v14
v_mfma_f32_16x16x32_bf16 v[192:195], a[68:71], v[116:119], v[192:195]
s_cselect_b32 s12, s14, s12
v_mfma_f32_16x16x32_bf16 v[196:199], a[68:71], v[124:127], v[196:199]
s_cselect_b32 s13, s15, s13
ds_read_b128 a[100:103], v2 offset:58368
v_mfma_f32_16x16x32_bf16 v[196:199], a[64:67], v[120:123], v[196:199]
s_cselect_b32 s14, 3221225472, s14
v_exp_f32 v15, v39
v_mfma_f32_16x16x32_bf16 v[200:203], a[72:75], v[112:115], v[200:203]
s_waitcnt lgkmcnt(4)
ds_read_b128 a[104:107], v2 offset:59392
v_add_f32 v27, v27, v15
v_mfma_f32_16x16x32_bf16 v[200:203], a[76:79], v[116:119], v[200:203]
v_exp_f32 v8, v40
v_mfma_f32_16x16x32_bf16 v[204:207], a[76:79], v[124:127], v[204:207]
ds_read_b128 a[108:111], v2 offset:60416
v_cvt_pk_bf16_f32 v105, v14, v15
v_mfma_f32_16x16x32_bf16 v[204:207], a[72:75], v[120:123], v[204:207]
v_exp_f32 v9, v41
v_mfma_f32_16x16x32_bf16 v[208:211], a[80:83], v[112:115], v[208:211]
ds_read_b128 a[112:115], v2 offset:61440
v_add_f32 v26, v26, v8
v_mfma_f32_16x16x32_bf16 v[208:211], a[84:87], v[116:119], v[208:211]
v_add_f32 v26, v26, v9
v_cvt_pk_bf16_f32 v98, v8, v9
v_mfma_f32_16x16x32_bf16 v[212:215], a[84:87], v[124:127], v[212:215]
ds_read_b128 a[116:119], v2 offset:62464
v_mfma_f32_16x16x32_bf16 v[212:215], a[80:83], v[120:123], v[212:215]
s_waitcnt lgkmcnt(4)
v_exp_f32 v10, v42
v_mfma_f32_16x16x32_bf16 v[216:219], a[88:91], v[112:115], v[216:219]
ds_read_b128 a[120:123], v2 offset:63488
v_add_f32 v26, v26, v10
v_mfma_f32_16x16x32_bf16 v[216:219], a[92:95], v[116:119], v[216:219]
v_exp_f32 v11, v43
v_mfma_f32_16x16x32_bf16 v[220:223], a[92:95], v[124:127], v[220:223]
s_waitcnt vmcnt(8)
ds_read_b128 a[124:127], v2 offset:64512
v_add_f32 v26, v26, v11
v_mfma_f32_16x16x32_bf16 v[220:223], a[88:91], v[120:123], v[220:223]
s_barrier
v_mfma_f32_16x16x32_bf16 v[224:227], a[96:99], v[112:115], v[224:227]
ds_read_b128 a[64:67], v4 offset:0
v_cvt_pk_bf16_f32 v99, v10, v11
v_mfma_f32_16x16x32_bf16 v[224:227], a[100:103], v[116:119], v[224:227]
v_exp_f32 v12, v44
v_mfma_f32_16x16x32_bf16 v[228:231], a[100:103], v[124:127], v[228:231]
ds_read_b128 a[68:71], v4 offset:1024
v_add_f32 v27, v27, v12
v_mfma_f32_16x16x32_bf16 v[228:231], a[96:99], v[120:123], v[228:231]
s_waitcnt lgkmcnt(4)
v_mfma_f32_16x16x32_bf16 v[232:235], a[104:107], v[112:115], v[232:235]
ds_read_b128 a[72:75], v4 offset:2048
v_mfma_f32_16x16x32_bf16 v[232:235], a[108:111], v[116:119], v[232:235]
v_exp_f32 v13, v45
v_mfma_f32_16x16x32_bf16 v[236:239], a[108:111], v[124:127], v[236:239]
ds_read_b128 a[76:79], v4 offset:3072
v_add_f32 v27, v27, v13
v_mfma_f32_16x16x32_bf16 v[236:239], a[104:107], v[120:123], v[236:239]
v_exp_f32 v14, v46
v_mfma_f32_16x16x32_bf16 v[240:243], a[112:115], v[112:115], v[240:243]
ds_read_b128 a[80:83], v4 offset:4096
v_cvt_pk_bf16_f32 v106, v12, v13
v_mfma_f32_16x16x32_bf16 v[240:243], a[116:119], v[116:119], v[240:243]
v_exp_f32 v15, v47
v_mfma_f32_16x16x32_bf16 v[244:247], a[116:119], v[124:127], v[244:247]
ds_read_b128 a[84:87], v4 offset:5120
v_add_f32 v27, v27, v14
v_mfma_f32_16x16x32_bf16 v[244:247], a[112:115], v[120:123], v[244:247]
s_waitcnt lgkmcnt(4)
v_add_f32 v27, v27, v15
v_cvt_pk_bf16_f32 v107, v14, v15
v_mfma_f32_16x16x32_bf16 v[248:251], a[120:123], v[112:115], v[248:251]
ds_read_b128 a[88:91], v4 offset:6144
v_mfma_f32_16x16x32_bf16 v[248:251], a[124:127], v[116:119], v[248:251]
v_mfma_f32_16x16x32_bf16 v[252:255], a[124:127], v[124:127], v[252:255]
s_waitcnt lgkmcnt(5)
ds_read_b128 a[92:95], v4 offset:7168
v_mfma_f32_16x16x32_bf16 v[252:255], a[120:123], v[120:123], v[252:255]
s_branch K2_x1
K2_xexit:
s_cbranch_vccnz Lstub_4
Lback_5:
s_cmp_lg_u32 s19, 0
s_cbranch_scc1 K2_loop
s_cmp_eq_u32 s24, 2
s_cbranch_scc1 K2_ntail
v_mfma_f32_16x16x32_bf16 v[128:131], a[64:67], v[96:99], v[128:131]
s_add_u32 m0, s18, 98304
ds_read_b128 a[96:99], v2 offset:8192
v_add_f32 v24, v24, v26
v_mfma_f32_16x16x32_bf16 v[128:131], a[68:71], v[100:103], v[128:131]
buffer_load_dwordx4 v1, s[4:7], s12 offen offset:0 sc1 lds
v_mfma_f32_16x16x32_bf16 v[132:135], a[68:71], v[108:111], v[132:135]
ds_read_b128 a[100:103], v2 offset:9216
v_add_f32 v25, v25, v27
v_mfma_f32_16x16x32_bf16 v[132:135], a[64:67], v[104:107], v[132:135]
v_exp_f32 v8, v64
v_mfma_f32_16x16x32_bf16 v[136:139], a[72:75], v[96:99], v[136:139]
ds_read_b128 a[104:107], v2 offset:10240
v_mfma_f32_16x16x32_bf16 v[136:139], a[76:79], v[100:103], v[136:139]
buffer_load_dwordx4 v1, s[4:7], s12 offen offset:1024 sc1 lds
v_mfma_f32_16x16x32_bf16 v[140:143], a[76:79], v[108:111], v[140:143]
ds_read_b128 a[108:111], v2 offset:11264
v_mfma_f32_16x16x32_bf16 v[140:143], a[72:75], v[104:107], v[140:143]
s_waitcnt lgkmcnt(4)
v_exp_f32 v9, v65
v_mfma_f32_16x16x32_bf16 v[144:147], a[80:83], v[96:99], v[144:147]
ds_read_b128 a[112:115], v2 offset:12288
v_add_f32 v26, v8, v9
v_mfma_f32_16x16x32_bf16 v[144:147], a[84:87], v[100:103], v[144:147]
buffer_load_dwordx4 v1, s[4:7], s12 offen offset:2048 sc1 lds
v_mfma_f32_16x16x32_bf16 v[148:151], a[84:87], v[108:111], v[148:151]
ds_read_b128 a[116:119], v2 offset:13312
v_cvt_pk_bf16_f32 v112, v8, v9
v_mfma_f32_16x16x32_bf16 v[148:151], a[80:83], v[104:107], v[148:151]
v_exp_f32 v10, v66
v_mfma_f32_16x16x32_bf16 v[152:155], a[88:91], v[96:99], v[152:155]
ds_read_b128 a[120:123], v2 offset:14336
v_add_f32 v26, v26, v10
v_mfma_f32_16x16x32_bf16 v[152:155], a[92:95], v[100:103], v[152:155]
buffer_load_dwordx4 v1, s[4:7], s12 offen offset:3072 sc1 lds
v_mfma_f32_16x16x32_bf16 v[156:159], a[92:95], v[108:111], v[156:159]
s_add_u32 s12, s12, 4096
ds_read_b128 a[124:127], v2 offset:15360
v_mfma_f32_16x16x32_bf16 v[156:159], a[88:91], v[104:107], v[156:159]
s_waitcnt lgkmcnt(4)
v_exp_f32 v11, v67
v_mfma_f32_16x16x32_bf16 v[160:163], a[96:99], v[96:99], v[160:163]
s_add_u32 m0, s18, 102400
ds_read_b128 a[64:67], v2 offset:16384
v_add_f32 v26, v26, v11
v_mfma_f32_16x16x32_bf16 v[160:163], a[100:103], v[100:103], v[160:163]
buffer_load_dwordx4 v1, s[4:7], s12 offen offset:0 sc1 lds
v_mfma_f32_16x16x32_bf16 v[164:167], a[100:103], v[108:111], v[164:167]
ds_read_b128 a[68:71], v2 offset:17408
v_cvt_pk_bf16_f32 v113, v10, v11
v_mfma_f32_16x16x32_bf16 v[164:167], a[96:99], v[104:107], v[164:167]
v_mfma_f32_16x16x32_bf16 v[168:171], a[104:107], v[96:99], v[168:171]
ds_read_b128 a[72:75], v2 offset:18432
v_mfma_f32_16x16x32_bf16 v[168:171], a[108:111], v[100:103], v[168:171]
buffer_load_dwordx4 v1, s[4:7], s12 offen offset:1024 sc1 lds
v_mfma_f32_16x16x32_bf16 v[172:175], a[108:111], v[108:111], v[172:175]
ds_read_b128 a[76:79], v2 offset:19456
v_mfma_f32_16x16x32_bf16 v[172:175], a[104:107], v[104:107], v[172:175]
s_waitcnt lgkmcnt(4)
v_exp_f32 v12, v68
v_mfma_f32_16x16x32_bf16 v[176:179], a[112:115], v[96:99], v[176:179]
ds_read_b128 a[80:83], v2 offset:20480
v_mfma_f32_16x16x32_bf16 v[176:179], a[116:119], v[100:103], v[176:179]
buffer_load_dwordx4 v1, s[4:7], s12 offen offset:2048 sc1 lds
v_mfma_f32_16x16x32_bf16 v[180:183], a[116:119], v[108:111], v[180:183]
ds_read_b128 a[84:87], v2 offset:21504
v_mfma_f32_16x16x32_bf16 v[180:183], a[112:115], v[104:107], v[180:183]
v_exp_f32 v13, v69
v_mfma_f32_16x16x32_bf16 v[184:187], a[120:123], v[96:99], v[184:187]
ds_read_b128 a[88:91], v2 offset:22528
v_add_f32 v27, v12, v13
v_mfma_f32_16x16x32_bf16 v[184:187], a[124:127], v[100:103], v[184:187]
s_waitcnt lgkmcnt(4)
buffer_load_dwordx4 v1, s[4:7], s12 offen offset:3072 sc1 lds
v_mfma_f32_16x16x32_bf16 v[188:191], a[124:127], v[108:111], v[188:191]
s_add_u32 s12, s12, 28672
ds_read_b128 a[92:95], v2 offset:23552
v_cvt_pk_bf16_f32 v120, v12, v13
v_mfma_f32_16x16x32_bf16 v[188:191], a[120:123], v[104:107], v[188:191]
s_sub_u32 s13, s13, 1
v_exp_f32 v14, v70
v_mfma_f32_16x16x32_bf16 v[192:195], a[64:67], v[96:99], v[192:195]
s_cmp_eq_u32 s13, 0
ds_read_b128 a[96:99], v2 offset:24576
v_add_f32 v27, v27, v14
v_mfma_f32_16x16x32_bf16 v[192:195], a[68:71], v[100:103], v[192:195]
s_cselect_b32 s12, s14, s12
v_mfma_f32_16x16x32_bf16 v[196:199], a[68:71], v[108:111], v[196:199]
s_cselect_b32 s13, s15, s13
ds_read_b128 a[100:103], v2 offset:25600
v_mfma_f32_16x16x32_bf16 v[196:199], a[64:67], v[104:107], v[196:199]
s_cselect_b32 s14, 3221225472, s14
v_exp_f32 v15, v71
v_mfma_f32_16x16x32_bf16 v[200:203], a[72:75], v[96:99], v[200:203]
s_waitcnt lgkmcnt(4)
ds_read_b128 a[104:107], v2 offset:26624
v_add_f32 v27, v27, v15
v_mfma_f32_16x16x32_bf16 v[200:203], a[76:79], v[100:103], v[200:203]
v_exp_f32 v8, v72
v_mfma_f32_16x16x32_bf16 v[204:207], a[76:79], v[108:111], v[204:207]
ds_read_b128 a[108:111], v2 offset:27648
v_cvt_pk_bf16_f32 v121, v14, v15
v_mfma_f32_16x16x32_bf16 v[204:207], a[72:75], v[104:107], v[204:207]
v_exp_f32 v9, v73
v_mfma_f32_16x16x32_bf16 v[208:211], a[80:83], v[96:99], v[208:211]
ds_read_b128 a[112:115], v2 offset:28672
v_add_f32 v26, v26, v8
v_mfma_f32_16x16x32_bf16 v[208:211], a[84:87], v[100:103], v[208:211]
v_add_f32 v26, v26, v9
v_cvt_pk_bf16_f32 v114, v8, v9
v_mfma_f32_16x16x32_bf16 v[212:215], a[84:87], v[108:111], v[212:215]
ds_read_b128 a[116:119], v2 offset:29696
v_mfma_f32_16x16x32_bf16 v[212:215], a[80:83], v[104:107], v[212:215]
s_waitcnt lgkmcnt(4)
v_exp_f32 v10, v74
v_mfma_f32_16x16x32_bf16 v[216:219], a[88:91], v[96:99], v[216:219]
ds_read_b128 a[120:123], v2 offset:30720
v_add_f32 v26, v26, v10
v_mfma_f32_16x16x32_bf16 v[216:219], a[92:95], v[100:103], v[216:219]
v_exp_f32 v11, v75
v_mfma_f32_16x16x32_bf16 v[220:223], a[92:95], v[108:111], v[220:223]
s_waitcnt vmcnt(8)
ds_read_b128 a[124:127], v2 offset:31744
v_add_f32 v26, v26, v11
v_mfma_f32_16x16x32_bf16 v[220:223], a[88:91], v[104:107], v[220:223]
s_barrier
v_mfma_f32_16x16x32_bf16 v[224:227], a[96:99], v[96:99], v[224:227]
ds_read_b128 a[64:67], v1 offset:0
v_cvt_pk_bf16_f32 v115, v10, v11
v_mfma_f32_16x16x32_bf16 v[224:227], a[100:103], v[100:103], v[224:227]
v_exp_f32 v12, v76
v_mfma_f32_16x16x32_bf16 v[228:231], a[100:103], v[108:111], v[228:231]
ds_read_b128 a[68:71], v1 offset:1024
v_add_f32 v27, v27, v12
v_mfma_f32_16x16x32_bf16 v[228:231], a[96:99], v[104:107], v[228:231]
PAD_11:
s_cbranch_execz M_tret
s_waitcnt lgkmcnt(4)
v_mfma_f32_16x16x32_bf16 v[232:235], a[104:107], v[96:99], v[232:235]
ds_read_b128 a[72:75], v1 offset:2048
v_mfma_f32_16x16x32_bf16 v[232:235], a[108:111], v[100:103], v[232:235]
v_exp_f32 v13, v77
v_mfma_f32_16x16x32_bf16 v[236:239], a[108:111], v[108:111], v[236:239]
ds_read_b128 a[76:79], v1 offset:3072
v_add_f32 v27, v27, v13
v_mfma_f32_16x16x32_bf16 v[236:239], a[104:107], v[104:107], v[236:239]
v_exp_f32 v14, v78
v_mfma_f32_16x16x32_bf16 v[240:243], a[112:115], v[96:99], v[240:243]
ds_read_b128 a[80:83], v1 offset:4096
v_cvt_pk_bf16_f32 v122, v12, v13
v_mfma_f32_16x16x32_bf16 v[240:243], a[116:119], v[100:103], v[240:243]
v_exp_f32 v15, v79
v_mfma_f32_16x16x32_bf16 v[244:247], a[116:119], v[108:111], v[244:247]
ds_read_b128 a[84:87], v1 offset:5120
v_add_f32 v27, v27, v14
v_mfma_f32_16x16x32_bf16 v[244:247], a[112:115], v[104:107], v[244:247]
s_waitcnt lgkmcnt(4)
v_add_f32 v27, v27, v15
v_cvt_pk_bf16_f32 v123, v14, v15
v_mfma_f32_16x16x32_bf16 v[248:251], a[120:123], v[96:99], v[248:251]
ds_read_b128 a[88:91], v1 offset:6144
v_mfma_f32_16x16x32_bf16 v[248:251], a[124:127], v[100:103], v[248:251]
v_mfma_f32_16x16x32_bf16 v[252:255], a[124:127], v[108:111], v[252:255]
ds_read_b128 a[92:95], v1 offset:7168
v_mfma_f32_16x16x32_bf16 v[252:255], a[120:123], v[104:107], v[252:255]
v_cndmask_b32 v32, v16, v7, s[32:33]
v_cndmask_b32 v33, v16, v7, s[34:35]
v_cndmask_b32 v34, v16, v7, s[36:37]
v_cndmask_b32 v35, v16, v7, s[38:39]
s_nop 1
v_mfma_f32_16x16x32_bf16 v[32:35], a[64:67], a[0:3], v[32:35]
s_add_u32 m0, s18, 131072
ds_read_b128 a[96:99], v1 offset:8192
v_cndmask_b32 v40, v16, v7, s[40:41]
v_mfma_f32_16x16x32_bf16 v[32:35], a[68:71], a[4:7], v[32:35]
s_waitcnt lgkmcnt(4)
buffer_load_dwordx4 v1, s[4:7], s8 offen offset:0 sc1 lds
v_mfma_f32_16x16x32_bf16 v[32:35], a[72:75], a[8:11], v[32:35]
ds_read_b128 a[100:103], v1 offset:9216
v_cndmask_b32 v41, v16, v7, s[42:43]
v_mfma_f32_16x16x32_bf16 v[32:35], a[76:79], a[12:15], v[32:35]
v_cndmask_b32 v42, v16, v7, s[44:45]
v_cndmask_b32 v43, v16, v7, s[46:47]
v_mfma_f32_16x16x32_bf16 v[32:35], a[80:83], a[16:19], v[32:35]
s_waitcnt lgkmcnt(4)
ds_read_b128 a[104:107], v1 offset:10240
v_mfma_f32_16x16x32_bf16 v[32:35], a[84:87], a[20:23], v[32:35]
s_waitcnt lgkmcnt(4)
buffer_load_dwordx4 v1, s[4:7], s8 offen offset:1024 sc1 lds
v_mfma_f32_16x16x32_bf16 v[32:35], a[88:91], a[24:27], v[32:35]
s_waitcnt lgkmcnt(3)
ds_read_b128 a[108:111], v1 offset:11264
v_mfma_f32_16x16x32_bf16 v[32:35], a[92:95], a[28:31], v[32:35]
v_exp_f32 v8, v80
v_mfma_f32_16x16x32_bf16 v[36:39], a[64:67], a[32:35], v[20:23]
ds_read_b128 a[112:115], v1 offset:12288
v_add_f32 v26, v26, v8
v_mfma_f32_16x16x32_bf16 v[36:39], a[68:71], a[36:39], v[36:39]
buffer_load_dwordx4 v1, s[4:7], s8 offen offset:2048 sc1 lds
v_mfma_f32_16x16x32_bf16 v[36:39], a[72:75], a[40:43], v[36:39]
ds_read_b128 a[116:119], v1 offset:13312
v_mfma_f32_16x16x32_bf16 v[36:39], a[76:79], a[44:47], v[36:39]
v_exp_f32 v9, v81
v_mfma_f32_16x16x32_bf16 v[36:39], a[80:83], a[48:51], v[36:39]
ds_read_b128 a[120:123], v1 offset:14336
v_add_f32 v26, v26, v9
v_mfma_f32_16x16x32_bf16 v[36:39], a[84:87], a[52:55], v[36:39]
buffer_load_dwordx4 v1, s[4:7], s8 offen offset:3072 sc1 lds
v_mfma_f32_16x16x32_bf16 v[36:39], a[88:91], a[56:59], v[36:39]
s_add_u32 s8, s8, 4096
ds_read_b128 a[124:127], v1 offset:15360
v_cvt_pk_bf16_f32 v116, v8, v9
v_mfma_f32_16x16x32_bf16 v[36:39], a[92:95], a[60:63], v[36:39]
s_waitcnt lgkmcnt(4)
v_exp_f32 v10, v82
v_mfma_f32_16x16x32_bf16 v[40:43], a[96:99], a[0:3], v[40:43]
s_add_u32 m0, s18, 135168
ds_read_b128 a[64:67], v1 offset:16384
v_cndmask_b32 v48, v16, v7, s[48:49]
v_mfma_f32_16x16x32_bf16 v[40:43], a[100:103], a[4:7], v[40:43]
buffer_load_dwordx4 v1, s[4:7], s8 offen offset:0 sc1 lds
v_mfma_f32_16x16x32_bf16 v[40:43], a[104:107], a[8:11], v[40:43]
ds_read_b128 a[68:71], v1 offset:17408
v_cndmask_b32 v49, v16, v7, s[50:51]
v_mfma_f32_16x16x32_bf16 v[40:43], a[108:111], a[12:15], v[40:43]
s_waitcnt lgkmcnt(4)
v_cndmask_b32 v50, v16, v7, s[52:53]
v_cndmask_b32 v51, v16, v7, s[54:55]
v_mfma_f32_16x16x32_bf16 v[40:43], a[112:115], a[16:19], v[40:43]
ds_read_b128 a[72:75], v1 offset:18432
v_add_f32 v26, v26, v10
v_mfma_f32_16x16x32_bf16 v[40:43], a[116:119], a[20:23], v[40:43]
s_waitcnt lgkmcnt(4)
buffer_load_dwordx4 v1, s[4:7], s8 offen offset:1024 sc1 lds
v_mfma_f32_16x16x32_bf16 v[40:43], a[120:123], a[24:27], v[40:43]
s_waitcnt lgkmcnt(3)
ds_read_b128 a[76:79], v1 offset:19456
v_mfma_f32_16x16x32_bf16 v[40:43], a[124:127], a[28:31], v[40:43]
v_exp_f32 v11, v83
v_mfma_f32_16x16x32_bf16 v[44:47], a[96:99], a[32:35], v[20:23]
ds_read_b128 a[80:83], v1 offset:20480
v_add_f32 v26, v26, v11
v_mfma_f32_16x16x32_bf16 v[44:47], a[100:103], a[36:39], v[44:47]
buffer_load_dwordx4 v1, s[4:7], s8 offen offset:2048 sc1 lds
v_mfma_f32_16x16x32_bf16 v[44:47], a[104:107], a[40:43], v[44:47]
ds_read_b128 a[84:87], v1 offset:21504
v_cvt_pk_bf16_f32 v117, v10, v11
v_mfma_f32_16x16x32_bf16 v[44:47], a[108:111], a[44:47], v[44:47]
v_exp_f32 v12, v84
v_mfma_f32_16x16x32_bf16 v[44:47], a[112:115], a[48:51], v[44:47]
ds_read_b128 a[88:91], v1 offset:22528
v_add_f32 v27, v27, v12
v_mfma_f32_16x16x32_bf16 v[44:47], a[116:119], a[52:55], v[44:47]
buffer_load_dwordx4 v1, s[4:7], s8 offen offset:3072 sc1 lds
v_mfma_f32_16x16x32_bf16 v[44:47], a[120:123], a[56:59], v[44:47]
s_waitcnt lgkmcnt(2)
s_add_u32 s8, s8, 28672
ds_read_b128 a[92:95], v1 offset:23552
v_mfma_f32_16x16x32_bf16 v[44:47], a[124:127], a[60:63], v[44:47]
s_sub_u32 s9, s9, 1
v_exp_f32 v13, v85
v_mfma_f32_16x16x32_bf16 v[48:51], a[64:67], a[0:3], v[48:51]
s_cmp_eq_u32 s9, 0
ds_read_b128 a[96:99], v1 offset:24576
v_cndmask_b32 v56, v16, v7, s[56:57]
v_mfma_f32_16x16x32_bf16 v[48:51], a[68:71], a[4:7], v[48:51]
s_cselect_b32 s8, s10, s8
v_cndmask_b32 v57, v16, v7, s[58:59]
v_cndmask_b32 v58, v16, v7, s[60:61]
v_mfma_f32_16x16x32_bf16 v[48:51], a[72:75], a[8:11], v[48:51]
s_cselect_b32 s9, s11, s9
ds_read_b128 a[100:103], v1 offset:25600
v_cndmask_b32 v59, v16, v7, s[62:63]
v_mfma_f32_16x16x32_bf16 v[48:51], a[76:79], a[12:15], v[48:51]
s_cselect_b32 s10, 3221225472, s10
v_exp_f32 v14, v86
v_mfma_f32_16x16x32_bf16 v[48:51], a[80:83], a[16:19], v[48:51]
s_waitcnt lgkmcnt(4)
ds_read_b128 a[104:107], v1 offset:26624
v_add_f32 v27, v27, v13
v_cvt_pk_bf16_f32 v124, v12, v13
v_mfma_f32_16x16x32_bf16 v[48:51], a[84:87], a[20:23], v[48:51]
s_waitcnt lgkmcnt(4)
v_exp_f32 v15, v87
v_mfma_f32_16x16x32_bf16 v[48:51], a[88:91], a[24:27], v[48:51]
s_waitcnt lgkmcnt(3)
ds_read_b128 a[108:111], v1 offset:27648
v_add_f32 v27, v27, v14
v_mfma_f32_16x16x32_bf16 v[48:51], a[92:95], a[28:31], v[48:51]
v_exp_f32 v8, v88
v_mfma_f32_16x16x32_bf16 v[52:55], a[64:67], a[32:35], v[20:23]
ds_read_b128 a[112:115], v1 offset:28672
v_add_f32 v27, v27, v15
v_mfma_f32_16x16x32_bf16 v[52:55], a[68:71], a[36:39], v[52:55]
v_exp_f32 v9, v89
v_mfma_f32_16x16x32_bf16 v[52:55], a[72:75], a[40:43], v[52:55]
ds_read_b128 a[116:119], v1 offset:29696
v_cvt_pk_bf16_f32 v125, v14, v15
v_mfma_f32_16x16x32_bf16 v[52:55], a[76:79], a[44:47], v[52:55]
v_exp_f32 v10, v90
v_mfma_f32_16x16x32_bf16 v[52:55], a[80:83], a[48:51], v[52:55]
ds_read_b128 a[120:123], v1 offset:30720
v_add_f32 v26, v26, v8
v_mfma_f32_16x16x32_bf16 v[52:55], a[84:87], a[52:55], v[52:55]
v_exp_f32 v11, v91
v_mfma_f32_16x16x32_bf16 v[52:55], a[88:91], a[56:59], v[52:55]
s_waitcnt vmcnt(8) lgkmcnt(4)
ds_read_b128 a[124:127], v1 offset:31744
v_add_f32 v26, v26, v9
v_cvt_pk_bf16_f32 v118, v8, v9
v_mfma_f32_16x16x32_bf16 v[52:55], a[92:95], a[60:63], v[52:55]
s_barrier
v_mfma_f32_16x16x32_bf16 v[56:59], a[96:99], a[0:3], v[56:59]
ds_read_b128 a[64:67], v2 offset:32768
v_add_f32 v26, v26, v10
v_mfma_f32_16x16x32_bf16 v[56:59], a[100:103], a[4:7], v[56:59]
v_exp_f32 v12, v92
v_mfma_f32_16x16x32_bf16 v[56:59], a[104:107], a[8:11], v[56:59]
s_waitcnt lgkmcnt(4)
ds_read_b128 a[68:71], v2 offset:33792
v_add_f32 v26, v26, v11
v_cvt_pk_bf16_f32 v119, v10, v11
v_mfma_f32_16x16x32_bf16 v[56:59], a[108:111], a[12:15], v[56:59]
v_exp_f32 v13, v93
v_mfma_f32_16x16x32_bf16 v[56:59], a[112:115], a[16:19], v[56:59]
s_waitcnt lgkmcnt(4)
ds_read_b128 a[72:75], v2 offset:34816
v_add_f32 v27, v27, v12
v_mfma_f32_16x16x32_bf16 v[56:59], a[116:119], a[20:23], v[56:59]
s_waitcnt lgkmcnt(4)
v_exp_f32 v14, v94
v_mfma_f32_16x16x32_bf16 v[56:59], a[120:123], a[24:27], v[56:59]
s_waitcnt lgkmcnt(3)
ds_read_b128 a[76:79], v2 offset:35840
v_add_f32 v27, v27, v13
v_mfma_f32_16x16x32_bf16 v[56:59], a[124:127], a[28:31], v[56:59]
v_exp_f32 v15, v95
v_mfma_f32_16x16x32_bf16 v[60:63], a[96:99], a[32:35], v[20:23]
ds_read_b128 a[80:83], v2 offset:36864
v_cvt_pk_bf16_f32 v126, v12, v13
v_mfma_f32_16x16x32_bf16 v[60:63], a[100:103], a[36:39], v[60:63]
v_add_f32 v27, v27, v14
v_add_f32 v27, v27, v15
v_mfma_f32_16x16x32_bf16 v[60:63], a[104:107], a[40:43], v[60:63]
ds_read_b128 a[84:87], v2 offset:37888
v_cvt_pk_bf16_f32 v127, v14, v15
v_mfma_f32_16x16x32_bf16 v[60:63], a[108:111], a[44:47], v[60:63]
v_add_f32 v28, v26, v27
v_cmp_nge_f32 vcc, s25, v28
v_mfma_f32_16x16x32_bf16 v[60:63], a[112:115], a[48:51], v[60:63]
ds_read_b128 a[88:91], v2 offset:38912
v_mfma_f32_16x16x32_bf16 v[60:63], a[116:119], a[52:55], v[60:63]
v_mfma_f32_16x16x32_bf16 v[60:63], a[120:123], a[56:59], v[60:63]
ds_read_b128 a[92:95], v2 offset:39936
v_mfma_f32_16x16x32_bf16 v[60:63], a[124:127], a[60:63], v[60:63]
s_waitcnt lgkmcnt(4)
s_cbranch_vccnz Lstub_6
Lback_7:
v_mfma_f32_16x16x32_bf16 v[128:131], a[64:67], v[112:115], v[128:131]
s_add_u32 m0, s18, 65536
ds_read_b128 a[96:99], v2 offset:40960
v_add_f32 v24, v24, v26
v_mfma_f32_16x16x32_bf16 v[128:131], a[68:71], v[116:119], v[128:131]
buffer_load_dwordx4 v1, s[4:7], s12 offen offset:0 sc1 lds
v_mfma_f32_16x16x32_bf16 v[132:135], a[68:71], v[124:127], v[132:135]
ds_read_b128 a[100:103], v2 offset:41984
v_add_f32 v25, v25, v27
v_mfma_f32_16x16x32_bf16 v[132:135], a[64:67], v[120:123], v[132:135]
v_exp_f32 v8, v32
v_mfma_f32_16x16x32_bf16 v[136:139], a[72:75], v[112:115], v[136:139]
ds_read_b128 a[104:107], v2 offset:43008
v_mfma_f32_16x16x32_bf16 v[136:139], a[76:79], v[116:119], v[136:139]
buffer_load_dwordx4 v1, s[4:7], s12 offen offset:1024 sc1 lds
v_mfma_f32_16x16x32_bf16 v[140:143], a[76:79], v[124:127], v[140:143]
ds_read_b128 a[108:111], v2 offset:44032
v_mfma_f32_16x16x32_bf16 v[140:143], a[72:75], v[120:123], v[140:143]
s_waitcnt lgkmcnt(4)
v_exp_f32 v9, v33
v_mfma_f32_16x16x32_bf16 v[144:147], a[80:83], v[112:115], v[144:147]
ds_read_b128 a[112:115], v2 offset:45056
v_add_f32 v26, v8, v9
v_mfma_f32_16x16x32_bf16 v[144:147], a[84:87], v[116:119], v[144:147]
buffer_load_dwordx4 v1, s[4:7], s12 offen offset:2048 sc1 lds
v_mfma_f32_16x16x32_bf16 v[148:151], a[84:87], v[124:127], v[148:151]
ds_read_b128 a[116:119], v2 offset:46080
v_cvt_pk_bf16_f32 v96, v8, v9
v_mfma_f32_16x16x32_bf16 v[148:151], a[80:83], v[120:123], v[148:151]
v_exp_f32 v10, v34
v_mfma_f32_16x16x32_bf16 v[152:155], a[88:91], v[112:115], v[152:155]
ds_read_b128 a[120:123], v2 offset:47104
v_add_f32 v26, v26, v10
v_mfma_f32_16x16x32_bf16 v[152:155], a[92:95], v[116:119], v[152:155]
buffer_load_dwordx4 v1, s[4:7], s12 offen offset:3072 sc1 lds
v_mfma_f32_16x16x32_bf16 v[156:159], a[92:95], v[124:127], v[156:159]
s_add_u32 s12, s12, 4096
ds_read_b128 a[124:127], v2 offset:48128
v_mfma_f32_16x16x32_bf16 v[156:159], a[88:91], v[120:123], v[156:159]
s_waitcnt lgkmcnt(4)
v_exp_f32 v11, v35
v_mfma_f32_16x16x32_bf16 v[160:163], a[96:99], v[112:115], v[160:163]
s_add_u32 m0, s18, 69632
ds_read_b128 a[64:67], v2 offset:49152
v_add_f32 v26, v26, v11
v_mfma_f32_16x16x32_bf16 v[160:163], a[100:103], v[116:119], v[160:163]
buffer_load_dwordx4 v1, s[4:7], s12 offen offset:0 sc1 lds
v_mfma_f32_16x16x32_bf16 v[164:167], a[100:103], v[124:127], v[164:167]
ds_read_b128 a[68:71], v2 offset:50176
v_cvt_pk_bf16_f32 v97, v10, v11
v_mfma_f32_16x16x32_bf16 v[164:167], a[96:99], v[120:123], v[164:167]
v_exp_f32 v12, v36
v_mfma_f32_16x16x32_bf16 v[168:171], a[104:107], v[112:115], v[168:171]
ds_read_b128 a[72:75], v2 offset:51200
v_mfma_f32_16x16x32_bf16 v[168:171], a[108:111], v[116:119], v[168:171]
buffer_load_dwordx4 v1, s[4:7], s12 offen offset:1024 sc1 lds
v_mfma_f32_16x16x32_bf16 v[172:175], a[108:111], v[124:127], v[172:175]
ds_read_b128 a[76:79], v2 offset:52224
v_mfma_f32_16x16x32_bf16 v[172:175], a[104:107], v[120:123], v[172:175]
s_waitcnt lgkmcnt(4)
v_exp_f32 v13, v37
v_mfma_f32_16x16x32_bf16 v[176:179], a[112:115], v[112:115], v[176:179]
ds_read_b128 a[80:83], v2 offset:53248
v_add_f32 v27, v12, v13
v_mfma_f32_16x16x32_bf16 v[176:179], a[116:119], v[116:119], v[176:179]
buffer_load_dwordx4 v1, s[4:7], s12 offen offset:2048 sc1 lds
v_mfma_f32_16x16x32_bf16 v[180:183], a[116:119], v[124:127], v[180:183]
ds_read_b128 a[84:87], v2 offset:54272
v_cvt_pk_bf16_f32 v104, v12, v13
v_mfma_f32_16x16x32_bf16 v[180:183], a[112:115], v[120:123], v[180:183]
v_exp_f32 v14, v38
v_mfma_f32_16x16x32_bf16 v[184:187], a[120:123], v[112:115], v[184:187]
ds_read_b128 a[88:91], v2 offset:55296
v_add_f32 v27, v27, v14
v_mfma_f32_16x16x32_bf16 v[184:187], a[124:127], v[116:119], v[184:187]
buffer_load_dwordx4 v1, s[4:7], s12 offen offset:3072 sc1 lds
v_mfma_f32_16x16x32_bf16 v[188:191], a[124:127], v[124:127], v[188:191]
s_waitcnt lgkmcnt(4)
s_add_u32 s12, s12, 28672
ds_read_b128 a[92:95], v2 offset:56320
v_mfma_f32_16x16x32_bf16 v[188:191], a[120:123], v[120:123], v[188:191]
s_sub_u32 s13, s13, 1
v_exp_f32 v15, v39
v_mfma_f32_16x16x32_bf16 v[192:195], a[64:67], v[112:115], v[192:195]
s_cmp_eq_u32 s13, 0
ds_read_b128 a[96:99], v2 offset:57344
v_add_f32 v27, v27, v15
v_mfma_f32_16x16x32_bf16 v[192:195], a[68:71], v[116:119], v[192:195]
s_cselect_b32 s12, s14, s12
v_exp_f32 v8, v40
v_mfma_f32_16x16x32_bf16 v[196:199], a[68:71], v[124:127], v[196:199]
s_cselect_b32 s13, s15, s13
ds_read_b128 a[100:103], v2 offset:58368
v_cvt_pk_bf16_f32 v105, v14, v15
v_mfma_f32_16x16x32_bf16 v[196:199], a[64:67], v[120:123], v[196:199]
s_cselect_b32 s14, 3221225472, s14
v_exp_f32 v9, v41
v_mfma_f32_16x16x32_bf16 v[200:203], a[72:75], v[112:115], v[200:203]
s_waitcnt lgkmcnt(4)
ds_read_b128 a[104:107], v2 offset:59392
v_add_f32 v26, v26, v8
v_mfma_f32_16x16x32_bf16 v[200:203], a[76:79], v[116:119], v[200:203]
buffer_load_dword v3, off, s[4:7], s80 sc1
v_mfma_f32_16x16x32_bf16 v[204:207], a[76:79], v[124:127], v[204:207]
ds_read_b128 a[108:111], v2 offset:60416
v_add_f32 v26, v26, v9
v_mfma_f32_16x16x32_bf16 v[204:207], a[72:75], v[120:123], v[204:207]
v_exp_f32 v10, v42
v_mfma_f32_16x16x32_bf16 v[208:211], a[80:83], v[112:115], v[208:211]
ds_read_b128 a[112:115], v2 offset:61440
v_cvt_pk_bf16_f32 v98, v8, v9
v_mfma_f32_16x16x32_bf16 v[208:211], a[84:87], v[116:119], v[208:211]
v_exp_f32 v11, v43
v_mfma_f32_16x16x32_bf16 v[212:215], a[84:87], v[124:127], v[212:215]
ds_read_b128 a[116:119], v2 offset:62464
v_add_f32 v26, v26, v10
v_mfma_f32_16x16x32_bf16 v[212:215], a[80:83], v[120:123], v[212:215]
s_waitcnt lgkmcnt(4)
v_exp_f32 v12, v44
v_mfma_f32_16x16x32_bf16 v[216:219], a[88:91], v[112:115], v[216:219]
ds_read_b128 a[120:123], v2 offset:63488
v_add_f32 v26, v26, v11
v_mfma_f32_16x16x32_bf16 v[216:219], a[92:95], v[116:119], v[216:219]
v_exp_f32 v13, v45
v_mfma_f32_16x16x32_bf16 v[220:223], a[92:95], v[124:127], v[220:223]
s_waitcnt vmcnt(9)
ds_read_b128 a[124:127], v2 offset:64512
v_cvt_pk_bf16_f32 v99, v10, v11
v_mfma_f32_16x16x32_bf16 v[220:223], a[88:91], v[120:123], v[220:223]
s_barrier
v_mfma_f32_16x16x32_bf16 v[224:227], a[96:99], v[112:115], v[224:227]
ds_read_b128 a[64:67], v4 offset:0
v_add_f32 v27, v27, v12
v_mfma_f32_16x16x32_bf16 v[224:227], a[100:103], v[116:119], v[224:227]
v_exp_f32 v14, v46
v_mfma_f32_16x16x32_bf16 v[228:231], a[100:103], v[124:127], v[228:231]
ds_read_b128 a[68:71], v4 offset:1024
v_add_f32 v27, v27, v13
v_cvt_pk_bf16_f32 v106, v12, v13
v_mfma_f32_16x16x32_bf16 v[228:231], a[96:99], v[120:123], v[228:231]
s_waitcnt lgkmcnt(4)
v_exp_f32 v15, v47
v_mfma_f32_16x16x32_bf16 v[232:235], a[104:107], v[112:115], v[232:235]
ds_read_b128 a[72:75], v4 offset:2048
v_add_f32 v27, v27, v14
v_mfma_f32_16x16x32_bf16 v[232:235], a[108:111], v[116:119], v[232:235]
v_exp_f32 v8, v48
v_mfma_f32_16x16x32_bf16 v[236:239], a[108:111], v[124:127], v[236:239]
ds_read_b128 a[76:79], v4 offset:3072
v_add_f32 v27, v27, v15
v_mfma_f32_16x16x32_bf16 v[236:239], a[104:107], v[120:123], v[236:239]
v_exp_f32 v9, v49
v_mfma_f32_16x16x32_bf16 v[240:243], a[112:115], v[112:115], v[240:243]
ds_read_b128 a[80:83], v4 offset:4096
v_cvt_pk_bf16_f32 v107, v14, v15
v_mfma_f32_16x16x32_bf16 v[240:243], a[116:119], v[116:119], v[240:243]
v_exp_f32 v10, v50
v_mfma_f32_16x16x32_bf16 v[244:247], a[116:119], v[124:127], v[244:247]
ds_read_b128 a[84:87], v4 offset:5120
v_add_f32 v26, v26, v8
v_mfma_f32_16x16x32_bf16 v[244:247], a[112:115], v[120:123], v[244:247]
s_waitcnt lgkmcnt(4)
v_exp_f32 v11, v51
v_mfma_f32_16x16x32_bf16 v[248:251], a[120:123], v[112:115], v[248:251]
ds_read_b128 a[88:91], v4 offset:6144
v_add_f32 v26, v26, v9
v_cvt_pk_bf16_f32 v100, v8, v9
v_mfma_f32_16x16x32_bf16 v[248:251], a[124:127], v[116:119], v[248:251]
v_add_f32 v26, v26, v10
v_add_f32 v26, v26, v11
v_mfma_f32_16x16x32_bf16 v[252:255], a[124:127], v[124:127], v[252:255]
ds_read_b128 a[92:95], v4 offset:7168
v_cvt_pk_bf16_f32 v101, v10, v11
v_mfma_f32_16x16x32_bf16 v[252:255], a[120:123], v[120:123], v[252:255]
K2_dx1:
v_cndmask_b32 v68, v20, v7, s[32:33]
v_cndmask_b32 v69, v20, v7, s[34:35]
v_cndmask_b32 v70, v20, v7, s[36:37]
v_cndmask_b32 v71, v20, v7, s[38:39]
s_nop 1
v_mfma_f32_16x16x32_bf16 v[68:71], a[64:67], a[32:35], v[68:71]
s_add_u32 m0, s18, 0
ds_read_b128 a[96:99], v4 offset:8192
v_cndmask_b32 v76, v20, v7, s[40:41]
v_cndmask_b32 v79, v20, v7, s[46:47]
v_mfma_f32_16x16x32_bf16 v[68:71], a[68:71], a[36:39], v[68:71]
s_waitcnt lgkmcnt(4)
ds_read_b128 a[100:103], v4 offset:9216
buffer_load_dwordx4 v1, s[4:7], s12 offen offset:0 sc1 lds
v_mfma_f32_16x16x32_bf16 v[68:71], a[72:75], a[40:43], v[68:71]
ds_read_b128 a[104:107], v4 offset:10240
v_cndmask_b32 v77, v20, v7, s[42:43]
v_mfma_f32_16x16x32_bf16 v[68:71], a[76:79], a[44:47], v[68:71]
ds_read_b128 a[108:111], v4 offset:11264
buffer_load_dwordx4 v1, s[4:7], s12 offen offset:1024 sc1 lds
v_mfma_f32_16x16x32_bf16 v[68:71], a[80:83], a[48:51], v[68:71]
s_waitcnt lgkmcnt(6)
ds_read_b128 a[112:115], v4 offset:12288
v_cndmask_b32 v78, v20, v7, s[44:45]
v_mfma_f32_16x16x32_bf16 v[68:71], a[84:87], a[52:55], v[68:71]
s_waitcnt lgkmcnt(6)
ds_read_b128 a[116:119], v4 offset:13312
buffer_load_dwordx4 v1, s[4:7], s12 offen offset:2048 sc1 lds
v_mfma_f32_16x16x32_bf16 v[68:71], a[88:91], a[56:59], v[68:71]
s_waitcnt lgkmcnt(6)
ds_read_b128 a[120:123], v4 offset:14336
v_exp_f32 v8, v52
v_exp_f32 v9, v53
v_mfma_f32_16x16x32_bf16 v[68:71], a[92:95], a[60:63], v[68:71]
s_waitcnt lgkmcnt(5)
ds_read_b128 a[124:127], v4 offset:15360
buffer_load_dwordx4 v1, s[4:7], s12 offen offset:3072 sc1 lds
v_add_f32 v27, v27, v8
v_add_f32 v27, v27, v9
v_cvt_pk_bf16_f32 v108, v8, v9
v_mfma_f32_16x16x32_bf16 v[76:79], a[96:99], a[32:35], v[76:79]
s_add_u32 s12, s12, 4096
s_add_u32 m0, s18, 4096
ds_read_b128 a[64:67], v4 offset:16384
v_cndmask_b32 v86, v20, v7, s[52:53]
v_cndmask_b32 v87, v20, v7, s[54:55]
v_mfma_f32_16x16x32_bf16 v[76:79], a[100:103], a[36:39], v[76:79]
s_waitcnt lgkmcnt(6)
ds_read_b128 a[68:71], v4 offset:17408
buffer_load_dwordx4 v1, s[4:7], s12 offen offset:0 sc1 lds
v_mfma_f32_16x16x32_bf16 v[76:79], a[104:107], a[40:43], v[76:79]
s_waitcnt lgkmcnt(6)
ds_read_b128 a[72:75], v4 offset:18432
v_cndmask_b32 v84, v20, v7, s[48:49]
v_mfma_f32_16x16x32_bf16 v[76:79], a[108:111], a[44:47], v[76:79]
s_waitcnt lgkmcnt(6)
ds_read_b128 a[76:79], v4 offset:19456
buffer_load_dwordx4 v1, s[4:7], s12 offen offset:1024 sc1 lds
v_mfma_f32_16x16x32_bf16 v[76:79], a[112:115], a[48:51], v[76:79]
s_waitcnt lgkmcnt(6)
ds_read_b128 a[80:83], v4 offset:20480
v_cndmask_b32 v85, v20, v7, s[50:51]
v_mfma_f32_16x16x32_bf16 v[76:79], a[116:119], a[52:55], v[76:79]
s_waitcnt lgkmcnt(6)
ds_read_b128 a[84:87], v4 offset:21504
buffer_load_dwordx4 v1, s[4:7], s12 offen offset:2048 sc1 lds
v_mfma_f32_16x16x32_bf16 v[76:79], a[120:123], a[56:59], v[76:79]
s_waitcnt lgkmcnt(6)
ds_read_b128 a[88:91], v4 offset:22528
v_exp_f32 v10, v54
v_exp_f32 v11, v55
v_mfma_f32_16x16x32_bf16 v[76:79], a[124:127], a[60:63], v[76:79]
s_waitcnt lgkmcnt(1)
ds_read_b128 a[92:95], v4 offset:23552
buffer_load_dwordx4 v1, s[4:7], s12 offen offset:3072 sc1 lds
v_add_f32 v27, v27, v10
v_add_f32 v27, v27, v11
v_cvt_pk_bf16_f32 v109, v10, v11
v_mfma_f32_16x16x32_bf16 v[84:87], a[64:67], a[32:35], v[84:87]
s_add_u32 s12, s12, 28672
ds_read_b128 a[96:99], v4 offset:24576
v_cndmask_b32 v92, v20, v7, s[56:57]
v_mfma_f32_16x16x32_bf16 v[84:87], a[68:71], a[36:39], v[84:87]
s_sub_u32 s13, s13, 1
ds_read_b128 a[100:103], v4 offset:25600
v_cndmask_b32 v93, v20, v7, s[58:59]
v_mfma_f32_16x16x32_bf16 v[84:87], a[72:75], a[40:43], v[84:87]
s_cmp_eq_u32 s13, 0
ds_read_b128 a[104:107], v4 offset:26624
v_cndmask_b32 v94, v20, v7, s[60:61]
v_mfma_f32_16x16x32_bf16 v[84:87], a[76:79], a[44:47], v[84:87]
s_cselect_b32 s12, s14, s12
ds_read_b128 a[108:111], v4 offset:27648
v_cndmask_b32 v95, v20, v7, s[62:63]
v_mfma_f32_16x16x32_bf16 v[84:87], a[80:83], a[48:51], v[84:87]
s_cselect_b32 s13, s15, s13
ds_read_b128 a[112:115], v4 offset:28672
v_exp_f32 v12, v56
v_exp_f32 v13, v57
v_mfma_f32_16x16x32_bf16 v[84:87], a[84:87], a[52:55], v[84:87]
s_waitcnt lgkmcnt(6)
s_cselect_b32 s14, 3221225472, s14
ds_read_b128 a[116:119], v4 offset:29696
v_exp_f32 v14, v58
v_add_f32 v26, v26, v12
v_add_f32 v26, v26, v13
v_cvt_pk_bf16_f32 v102, v12, v13
v_mfma_f32_16x16x32_bf16 v[84:87], a[88:91], a[56:59], v[84:87]
s_waitcnt lgkmcnt(6)
ds_read_b128 a[120:123], v4 offset:30720
v_exp_f32 v15, v59
v_exp_f32 v8, v60
v_mfma_f32_16x16x32_bf16 v[84:87], a[92:95], a[60:63], v[84:87]
s_waitcnt vmcnt(8) lgkmcnt(6)
s_barrier
ds_read_b128 a[124:127], v4 offset:31744
v_mfma_f32_16x16x32_bf16 v[92:95], a[96:99], a[32:35], v[92:95]
s_waitcnt lgkmcnt(6)
ds_read_b128 a[64:67], v2 offset:0
v_exp_f32 v9, v61
v_exp_f32 v10, v62
v_mfma_f32_16x16x32_bf16 v[92:95], a[100:103], a[36:39], v[92:95]
s_waitcnt lgkmcnt(6)
ds_read_b128 a[68:71], v2 offset:1024
v_exp_f32 v11, v63
v_mfma_f32_16x16x32_bf16 v[92:95], a[104:107], a[40:43], v[92:95]
s_waitcnt lgkmcnt(6)
ds_read_b128 a[72:75], v2 offset:2048
v_add_f32 v26, v26, v14
v_mfma_f32_16x16x32_bf16 v[92:95], a[108:111], a[44:47], v[92:95]
s_waitcnt lgkmcnt(6)
ds_read_b128 a[76:79], v2 offset:3072
v_add_f32 v26, v26, v15
v_cvt_pk_bf16_f32 v103, v14, v15
v_add_f32 v27, v27, v8
v_mfma_f32_16x16x32_bf16 v[92:95], a[112:115], a[48:51], v[92:95]
s_waitcnt lgkmcnt(6)
ds_read_b128 a[80:83], v2 offset:4096
v_add_f32 v27, v27, v9
v_mfma_f32_16x16x32_bf16 v[92:95], a[116:119], a[52:55], v[92:95]
s_waitcnt lgkmcnt(6)
ds_read_b128 a[84:87], v2 offset:5120
v_cvt_pk_bf16_f32 v110, v8, v9
v_add_f32 v27, v27, v10
v_mfma_f32_16x16x32_bf16 v[92:95], a[120:123], a[56:59], v[92:95]
s_waitcnt lgkmcnt(6)
ds_read_b128 a[88:91], v2 offset:6144
v_add_f32 v27, v27, v11
v_cvt_pk_bf16_f32 v111, v10, v11
v_mfma_f32_16x16x32_bf16 v[92:95], a[124:127], a[60:63], v[92:95]
s_waitcnt lgkmcnt(6)
ds_read_b128 a[92:95], v2 offset:7168
v_add_f32 v28, v26, v27
v_cmp_nge_f32 vcc, s25, v28
s_cbranch_vccnz Lstub_8
Lback_9:
s_cmp_lg_u32 s24, 1
s_cbranch_scc1 K2_plain
v_cmp_gt_u32 vcc, 1, v3
s_cbranch_vccnz K2_tspin
K2_tok:
v_mfma_f32_16x16x32_bf16 v[128:131], a[64:67], v[96:99], v[128:131]
s_waitcnt lgkmcnt(6)
ds_read_b128 a[96:99], v2 offset:8192
v_add_f32 v24, v24, v26
v_mfma_f32_16x16x32_bf16 v[128:131], a[68:71], v[100:103], v[128:131]
buffer_load_dwordx4 v[28:31], v1, s[4:7], s27 offen sc1
v_mfma_f32_16x16x32_bf16 v[132:135], a[68:71], v[108:111], v[132:135]
ds_read_b128 a[100:103], v2 offset:9216
v_add_f32 v25, v25, v27
v_mfma_f32_16x16x32_bf16 v[132:135], a[64:67], v[104:107], v[132:135]
s_waitcnt lgkmcnt(6)
v_exp_f32 v8, v68
v_mfma_f32_16x16x32_bf16 v[136:139], a[72:75], v[96:99], v[136:139]
s_add_u32 s22, s76, 0
ds_read_b128 a[104:107], v2 offset:10240
v_exp_f32 v9, v69
v_mfma_f32_16x16x32_bf16 v[136:139], a[76:79], v[100:103], v[136:139]
buffer_load_dwordx4 v[32:35], v1, s[4:7], s22 offen offset:0 sc1
v_mfma_f32_16x16x32_bf16 v[140:143], a[76:79], v[108:111], v[140:143]
ds_read_b128 a[108:111], v2 offset:11264
v_add_f32 v27, v8, v9
v_mfma_f32_16x16x32_bf16 v[140:143], a[72:75], v[104:107], v[140:143]
s_waitcnt lgkmcnt(5)
v_exp_f32 v10, v70
v_mfma_f32_16x16x32_bf16 v[144:147], a[80:83], v[96:99], v[144:147]
ds_read_b128 a[112:115], v2 offset:12288
v_cvt_pk_bf16_f32 v120, v8, v9
v_mfma_f32_16x16x32_bf16 v[144:147], a[84:87], v[100:103], v[144:147]
buffer_load_dwordx4 v[36:39], v1, s[4:7], s22 offen offset:1024 sc1
v_mfma_f32_16x16x32_bf16 v[148:151], a[84:87], v[108:111], v[148:151]
ds_read_b128 a[116:119], v2 offset:13312
v_add_f32 v27, v27, v10
v_mfma_f32_16x16x32_bf16 v[148:151], a[80:83], v[104:107], v[148:151]
v_exp_f32 v11, v71
v_mfma_f32_16x16x32_bf16 v[152:155], a[88:91], v[96:99], v[152:155]
s_waitcnt lgkmcnt(4)
ds_read_b128 a[120:123], v2 offset:14336
v_add_f32 v27, v27, v11
v_mfma_f32_16x16x32_bf16 v[152:155], a[92:95], v[100:103], v[152:155]
buffer_load_dwordx4 v[40:43], v1, s[4:7], s22 offen offset:2048 sc1
v_mfma_f32_16x16x32_bf16 v[156:159], a[92:95], v[108:111], v[156:159]
ds_read_b128 a[124:127], v2 offset:15360
v_cvt_pk_bf16_f32 v121, v10, v11
v_mfma_f32_16x16x32_bf16 v[156:159], a[88:91], v[104:107], v[156:159]
v_exp_f32 v12, v76
v_mfma_f32_16x16x32_bf16 v[160:163], a[96:99], v[96:99], v[160:163]
ds_read_b128 a[64:67], v2 offset:16384
v_add_f32 v27, v27, v12
v_mfma_f32_16x16x32_bf16 v[160:163], a[100:103], v[100:103], v[160:163]
buffer_load_dwordx4 v[44:47], v1, s[4:7], s22 offen offset:3072 sc1
v_mfma_f32_16x16x32_bf16 v[164:167], a[100:103], v[108:111], v[164:167]
ds_read_b128 a[68:71], v2 offset:17408
v_mfma_f32_16x16x32_bf16 v[164:167], a[96:99], v[104:107], v[164:167]
s_waitcnt lgkmcnt(4)
v_exp_f32 v13, v77
v_mfma_f32_16x16x32_bf16 v[168:171], a[104:107], v[96:99], v[168:171]
s_add_u32 s22, s76, 4096
ds_read_b128 a[72:75], v2 offset:18432
v_add_f32 v27, v27, v13
v_mfma_f32_16x16x32_bf16 v[168:171], a[108:111], v[100:103], v[168:171]
PAD_12:
s_cbranch_execz M_tret
buffer_load_dwordx4 v[48:51], v1, s[4:7], s22 offen offset:0 sc1
v_mfma_f32_16x16x32_bf16 v[172:175], a[108:111], v[108:111], v[172:175]
ds_read_b128 a[76:79], v2 offset:19456
v_cvt_pk_bf16_f32 v122, v12, v13
v_mfma_f32_16x16x32_bf16 v[172:175], a[104:107], v[104:107], v[172:175]
v_exp_f32 v14, v78
v_mfma_f32_16x16x32_bf16 v[176:179], a[112:115], v[96:99], v[176:179]
ds_read_b128 a[80:83], v2 offset:20480
v_add_f32 v27, v27, v14
v_mfma_f32_16x16x32_bf16 v[176:179], a[116:119], v[100:103], v[176:179]
buffer_load_dwordx4 v[52:55], v1, s[4:7], s22 offen offset:1024 sc1
v_mfma_f32_16x16x32_bf16 v[180:183], a[116:119], v[108:111], v[180:183]
ds_read_b128 a[84:87], v2 offset:21504
v_mfma_f32_16x16x32_bf16 v[180:183], a[112:115], v[104:107], v[180:183]
s_waitcnt lgkmcnt(4)
v_exp_f32 v15, v79
v_mfma_f32_16x16x32_bf16 v[184:187], a[120:123], v[96:99], v[184:187]
ds_read_b128 a[88:91], v2 offset:22528
v_add_f32 v27, v27, v15
v_mfma_f32_16x16x32_bf16 v[184:187], a[124:127], v[100:103], v[184:187]
buffer_load_dwordx4 v[56:59], v1, s[4:7], s22 offen offset:2048 sc1
v_mfma_f32_16x16x32_bf16 v[188:191], a[124:127], v[108:111], v[188:191]
ds_read_b128 a[92:95], v2 offset:23552
v_cvt_pk_bf16_f32 v123, v14, v15
v_mfma_f32_16x16x32_bf16 v[188:191], a[120:123], v[104:107], v[188:191]
v_exp_f32 v8, v84
v_mfma_f32_16x16x32_bf16 v[192:195], a[64:67], v[96:99], v[192:195]
ds_read_b128 a[96:99], v2 offset:24576
v_add_f32 v27, v27, v8
v_mfma_f32_16x16x32_bf16 v[192:195], a[68:71], v[100:103], v[192:195]
buffer_load_dwordx4 v[60:63], v1, s[4:7], s22 offen offset:3072 sc1
v_mfma_f32_16x16x32_bf16 v[196:199], a[68:71], v[108:111], v[196:199]
ds_read_b128 a[100:103], v2 offset:25600
v_mfma_f32_16x16x32_bf16 v[196:199], a[64:67], v[104:107], v[196:199]
s_waitcnt lgkmcnt(4)
v_exp_f32 v9, v85
v_mfma_f32_16x16x32_bf16 v[200:203], a[72:75], v[96:99], v[200:203]
s_add_u32 s22, s76, 8192
ds_read_b128 a[104:107], v2 offset:26624
v_add_f32 v27, v27, v9
v_mfma_f32_16x16x32_bf16 v[200:203], a[76:79], v[100:103], v[200:203]
buffer_load_dwordx4 v[64:67], v1, s[4:7], s22 offen offset:0 sc1
v_mfma_f32_16x16x32_bf16 v[204:207], a[76:79], v[108:111], v[204:207]
ds_read_b128 a[108:111], v2 offset:27648
v_cvt_pk_bf16_f32 v124, v8, v9
v_mfma_f32_16x16x32_bf16 v[204:207], a[72:75], v[104:107], v[204:207]
v_exp_f32 v10, v86
v_mfma_f32_16x16x32_bf16 v[208:211], a[80:83], v[96:99], v[208:211]
ds_read_b128 a[112:115], v2 offset:28672
v_add_f32 v27, v27, v10
v_mfma_f32_16x16x32_bf16 v[208:211], a[84:87], v[100:103], v[208:211]
buffer_load_dwordx4 v[72:75], v1, s[4:7], s22 offen offset:1024 sc1
v_mfma_f32_16x16x32_bf16 v[212:215], a[84:87], v[108:111], v[212:215]
ds_read_b128 a[116:119], v2 offset:29696
v_mfma_f32_16x16x32_bf16 v[212:215], a[80:83], v[104:107], v[212:215]
s_waitcnt lgkmcnt(4)
v_exp_f32 v11, v87
v_mfma_f32_16x16x32_bf16 v[216:219], a[88:91], v[96:99], v[216:219]
ds_read_b128 a[120:123], v2 offset:30720
v_add_f32 v27, v27, v11
v_mfma_f32_16x16x32_bf16 v[216:219], a[92:95], v[100:103], v[216:219]
buffer_load_dwordx4 v[80:83], v1, s[4:7], s22 offen offset:2048 sc1
v_mfma_f32_16x16x32_bf16 v[220:223], a[92:95], v[108:111], v[220:223]
s_waitcnt vmcnt(12)
ds_read_b128 a[124:127], v2 offset:31744
v_cvt_pk_bf16_f32 v125, v10, v11
v_mfma_f32_16x16x32_bf16 v[220:223], a[88:91], v[104:107], v[220:223]
s_barrier
v_mfma_f32_16x16x32_bf16 v[224:227], a[96:99], v[96:99], v[224:227]
ds_read_b128 a[64:67], v1 offset:0
v_mfma_f32_16x16x32_bf16 v[224:227], a[100:103], v[100:103], v[224:227]
buffer_load_dwordx4 v[88:91], v1, s[4:7], s22 offen offset:3072 sc1
v_mfma_f32_16x16x32_bf16 v[228:231], a[100:103], v[108:111], v[228:231]
ds_read_b128 a[68:71], v1 offset:1024
v_mfma_f32_16x16x32_bf16 v[228:231], a[96:99], v[104:107], v[228:231]
s_waitcnt lgkmcnt(4)
v_exp_f32 v12, v92
v_mfma_f32_16x16x32_bf16 v[232:235], a[104:107], v[96:99], v[232:235]
ds_read_b128 a[72:75], v1 offset:2048
v_add_f32 v27, v27, v12
v_mfma_f32_16x16x32_bf16 v[232:235], a[108:111], v[100:103], v[232:235]
v_exp_f32 v13, v93
v_mfma_f32_16x16x32_bf16 v[236:239], a[108:111], v[108:111], v[236:239]
ds_read_b128 a[76:79], v1 offset:3072
v_add_f32 v27, v27, v13
v_mfma_f32_16x16x32_bf16 v[236:239], a[104:107], v[104:107], v[236:239]
v_exp_f32 v14, v94
v_mfma_f32_16x16x32_bf16 v[240:243], a[112:115], v[96:99], v[240:243]
ds_read_b128 a[80:83], v1 offset:4096
v_cvt_pk_bf16_f32 v126, v12, v13
v_mfma_f32_16x16x32_bf16 v[240:243], a[116:119], v[100:103], v[240:243]
v_exp_f32 v15, v95
v_mfma_f32_16x16x32_bf16 v[244:247], a[116:119], v[108:111], v[244:247]
ds_read_b128 a[84:87], v1 offset:5120
v_add_f32 v27, v27, v14
v_mfma_f32_16x16x32_bf16 v[244:247], a[112:115], v[104:107], v[244:247]
s_waitcnt lgkmcnt(4)
v_add_f32 v27, v27, v15
v_cvt_pk_bf16_f32 v127, v14, v15
v_mfma_f32_16x16x32_bf16 v[248:251], a[120:123], v[96:99], v[248:251]
ds_read_b128 a[88:91], v1 offset:6144
v_cmp_nge_f32 vcc, s25, v27
v_mfma_f32_16x16x32_bf16 v[248:251], a[124:127], v[100:103], v[248:251]
v_mfma_f32_16x16x32_bf16 v[252:255], a[124:127], v[108:111], v[252:255]
ds_read_b128 a[92:95], v1 offset:7168
v_mfma_f32_16x16x32_bf16 v[252:255], a[120:123], v[104:107], v[252:255]
s_waitcnt lgkmcnt(2)
s_cbranch_vccnz Lstub_10
Lback_11:
v_mfma_f32_16x16x32_bf16 v[132:135], a[64:67], v[120:123], v[132:135]
s_mov_b64 s[36:37], s[86:87]
ds_read_b128 a[96:99], v1 offset:8192
v_add_f32 v25, v25, v27
v_mfma_f32_16x16x32_bf16 v[132:135], a[68:71], v[124:127], v[132:135]
s_mov_b32 s38, 3670016
ds_read_b128 a[100:103], v1 offset:9216
v_accvgpr_read_b32 v112, a184
v_mfma_f32_16x16x32_bf16 v[140:143], a[72:75], v[120:123], v[140:143]
s_mov_b32 s39, 0x20000
ds_read_b128 a[104:107], v1 offset:10240
v_accvgpr_read_b32 v113, a185
v_mfma_f32_16x16x32_bf16 v[140:143], a[76:79], v[124:127], v[140:143]
s_lshl_b32 s8, s29, 3
ds_read_b128 a[108:111], v1 offset:11264
v_accvgpr_read_b32 v114, a186
v_mfma_f32_16x16x32_bf16 v[148:151], a[80:83], v[120:123], v[148:151]
s_add_u32 s8, s8, s3
ds_read_b128 a[112:115], v1 offset:12288
v_accvgpr_read_b32 v115, a187
v_mfma_f32_16x16x32_bf16 v[148:151], a[84:87], v[124:127], v[148:151]
s_waitcnt lgkmcnt(3)
s_lshl_b32 s8, s8, 4
ds_read_b128 a[116:119], v1 offset:13312
v_accvgpr_read_b32 v116, a188
v_mfma_f32_16x16x32_bf16 v[156:159], a[88:91], v[120:123], v[156:159]
s_add_u32 s8, s8, s20
ds_read_b128 a[120:123], v1 offset:14336
v_accvgpr_read_b32 v117, a189
v_mfma_f32_16x16x32_bf16 v[156:159], a[92:95], v[124:127], v[156:159]
s_mul_i32 s8, s8, 14336
ds_read_b128 a[124:127], v1 offset:15360
v_accvgpr_read_b32 v118, a190
v_mfma_f32_16x16x32_bf16 v[164:167], a[96:99], v[120:123], v[164:167]
s_add_u32 s8, s8, 104857600
ds_read_b128 a[64:67], v1 offset:16384
v_accvgpr_read_b32 v119, a191
v_mfma_f32_16x16x32_bf16 v[164:167], a[100:103], v[124:127], v[164:167]
s_waitcnt lgkmcnt(6)
s_add_u32 s12, s8, 917504
ds_read_b128 a[68:71], v1 offset:17408
v_mfma_f32_16x16x32_bf16 v[172:175], a[104:107], v[120:123], v[172:175]
s_waitcnt lgkmcnt(6)
ds_read_b128 a[72:75], v1 offset:18432
v_mfma_f32_16x16x32_bf16 v[172:175], a[108:111], v[124:127], v[172:175]
s_waitcnt lgkmcnt(6)
s_add_u32 s22, s76, 12288
ds_read_b128 a[76:79], v1 offset:19456
v_mfma_f32_16x16x32_bf16 v[180:183], a[112:115], v[120:123], v[180:183]
s_waitcnt lgkmcnt(6)
ds_read_b128 a[80:83], v1 offset:20480
buffer_load_dwordx4 v[96:99], v1, s[4:7], s22 offen offset:0 sc1
v_mfma_f32_16x16x32_bf16 v[180:183], a[116:119], v[124:127], v[180:183]
s_waitcnt lgkmcnt(6)
ds_read_b128 a[84:87], v1 offset:21504
v_mfma_f32_16x16x32_bf16 v[188:191], a[120:123], v[120:123], v[188:191]
s_waitcnt lgkmcnt(6)
ds_read_b128 a[88:91], v1 offset:22528
v_mfma_f32_16x16x32_bf16 v[188:191], a[124:127], v[124:127], v[188:191]
s_waitcnt lgkmcnt(6)
ds_read_b128 a[92:95], v1 offset:23552
buffer_load_dwordx4 v[100:103], v1, s[4:7], s22 offen offset:1024 sc1
v_mfma_f32_16x16x32_bf16 v[196:199], a[64:67], v[120:123], v[196:199]
s_waitcnt lgkmcnt(6)
ds_read_b128 a[96:99], v1 offset:24576
v_mfma_f32_16x16x32_bf16 v[196:199], a[68:71], v[124:127], v[196:199]
s_waitcnt lgkmcnt(6)
ds_read_b128 a[100:103], v1 offset:25600
v_mfma_f32_16x16x32_bf16 v[204:207], a[72:75], v[120:123], v[204:207]
s_waitcnt lgkmcnt(6)
ds_read_b128 a[104:107], v1 offset:26624
buffer_load_dwordx4 v[104:107], v1, s[4:7], s22 offen offset:2048 sc1
v_mfma_f32_16x16x32_bf16 v[204:207], a[76:79], v[124:127], v[204:207]
s_waitcnt lgkmcnt(6)
ds_read_b128 a[108:111], v1 offset:27648
v_mfma_f32_16x16x32_bf16 v[212:215], a[80:83], v[120:123], v[212:215]
s_waitcnt lgkmcnt(6)
ds_read_b128 a[112:115], v1 offset:28672
v_mfma_f32_16x16x32_bf16 v[212:215], a[84:87], v[124:127], v[212:215]
s_waitcnt lgkmcnt(6)
ds_read_b128 a[116:119], v1 offset:29696
buffer_load_dwordx4 v[108:111], v1, s[4:7], s22 offen offset:3072 sc1
v_mfma_f32_16x16x32_bf16 v[220:223], a[88:91], v[120:123], v[220:223]
s_waitcnt lgkmcnt(6)
s_add_u32 m0, s18, 32768
ds_read_b128 a[120:123], v1 offset:30720
v_mfma_f32_16x16x32_bf16 v[220:223], a[92:95], v[124:127], v[220:223]
s_waitcnt lgkmcnt(6)
ds_read_b128 a[124:127], v1 offset:31744
v_mfma_f32_16x16x32_bf16 v[228:231], a[96:99], v[120:123], v[228:231]
s_waitcnt lgkmcnt(6)
buffer_load_dwordx4 v112, s[36:39], s81 offen offset:0 lds
v_mfma_f32_16x16x32_bf16 v[228:231], a[100:103], v[124:127], v[228:231]
s_waitcnt lgkmcnt(5)
buffer_load_dwordx4 v113, s[36:39], s81 offen offset:1024 lds
v_mfma_f32_16x16x32_bf16 v[236:239], a[104:107], v[120:123], v[236:239]
s_waitcnt lgkmcnt(4)
buffer_load_dwordx4 v114, s[36:39], s81 offen offset:2048 lds
v_mfma_f32_16x16x32_bf16 v[236:239], a[108:111], v[124:127], v[236:239]
s_waitcnt lgkmcnt(3)
buffer_load_dwordx4 v115, s[36:39], s81 offen offset:3072 lds
v_mfma_f32_16x16x32_bf16 v[244:247], a[112:115], v[120:123], v[244:247]
s_waitcnt lgkmcnt(2)
s_add_u32 s81, s81, 28672
v_mfma_f32_16x16x32_bf16 v[244:247], a[116:119], v[124:127], v[244:247]
s_waitcnt lgkmcnt(1)
s_add_u32 m0, s18, 36864
v_mfma_f32_16x16x32_bf16 v[252:255], a[120:123], v[120:123], v[252:255]
s_waitcnt lgkmcnt(0)
buffer_load_dwordx4 v112, s[36:39], s81 offen offset:0 lds
v_mfma_f32_16x16x32_bf16 v[252:255], a[124:127], v[124:127], v[252:255]
buffer_load_dwordx4 v113, s[36:39], s81 offen offset:1024 lds
buffer_load_dwordx4 v114, s[36:39], s81 offen offset:2048 lds
buffer_load_dwordx4 v115, s[36:39], s81 offen offset:3072 lds
s_sub_u32 s81, s81, 28544
s_waitcnt vmcnt(24)
v_sub_f32 v8, v16, v28
v_sub_f32 v10, v20, v30
v_max_f32 v9, v8, v10
v_cmp_lt_f32 vcc, 1114636288, v9
s_cbranch_vccnz K2_cfix
K2_cok:
v_exp_f32 v8, v8
v_exp_f32 v10, v10
s_nop 0
v_mov_b32 v9, v8
v_mov_b32 v11, v10
v_fmac_f32 v24, v8, v29
v_fmac_f32 v25, v10, v31
s_mov_b32 s23, 0xffff0000
s_waitcnt vmcnt(23)
v_lshlrev_b32 v68, 16, v32
v_and_b32 v69, s23, v32
v_lshlrev_b32 v70, 16, v33
v_and_b32 v71, s23, v33
v_lshlrev_b32 v76, 16, v34
v_and_b32 v77, s23, v34
v_lshlrev_b32 v78, 16, v35
v_and_b32 v79, s23, v35
v_pk_fma_f32 v[128:129], v[68:69], v[8:9], v[128:129]
v_pk_fma_f32 v[130:131], v[70:71], v[8:9], v[130:131]
v_pk_fma_f32 v[136:137], v[76:77], v[8:9], v[136:137]
v_pk_fma_f32 v[138:139], v[78:79], v[8:9], v[138:139]
v_cvt_pk_bf16_f32 v128, v128, v129
v_cvt_pk_bf16_f32 v129, v130, v131
v_cvt_pk_bf16_f32 v130, v136, v137
v_cvt_pk_bf16_f32 v131, v138, v139
s_waitcnt vmcnt(22)
v_lshlrev_b32 v68, 16, v36
v_and_b32 v69, s23, v36
v_lshlrev_b32 v70, 16, v37
v_and_b32 v71, s23, v37
v_lshlrev_b32 v76, 16, v38
v_and_b32 v77, s23, v38
v_lshlrev_b32 v78, 16, v39
v_and_b32 v79, s23, v39
v_pk_fma_f32 v[144:145], v[68:69], v[8:9], v[144:145]
v_pk_fma_f32 v[146:147], v[70:71], v[8:9], v[146:147]
v_pk_fma_f32 v[152:153], v[76:77], v[8:9], v[152:153]
v_pk_fma_f32 v[154:155], v[78:79], v[8:9], v[154:155]
v_cvt_pk_bf16_f32 v144, v144, v145
v_cvt_pk_bf16_f32 v145, v146, v147
v_cvt_pk_bf16_f32 v146, v152, v153
v_cvt_pk_bf16_f32 v147, v154, v155
s_add_u32 m0, s18, 98304
s_nop 0
buffer_load_dwordx4 v112, s[36:39], s81 offen offset:0 lds
s_waitcnt vmcnt(22)
v_lshlrev_b32 v68, 16, v40
v_and_b32 v69, s23, v40
v_lshlrev_b32 v70, 16, v41
v_and_b32 v71, s23, v41
v_lshlrev_b32 v76, 16, v42
v_and_b32 v77, s23, v42
v_lshlrev_b32 v78, 16, v43
v_and_b32 v79, s23, v43
v_pk_fma_f32 v[160:161], v[68:69], v[8:9], v[160:161]
v_pk_fma_f32 v[162:163], v[70:71], v[8:9], v[162:163]
v_pk_fma_f32 v[168:169], v[76:77], v[8:9], v[168:169]
v_pk_fma_f32 v[170:171], v[78:79], v[8:9], v[170:171]
v_cvt_pk_bf16_f32 v160, v160, v161
v_cvt_pk_bf16_f32 v161, v162, v163
v_cvt_pk_bf16_f32 v162, v168, v169
v_cvt_pk_bf16_f32 v163, v170, v171
s_waitcnt vmcnt(21)
v_lshlrev_b32 v68, 16, v44
v_and_b32 v69, s23, v44
v_lshlrev_b32 v70, 16, v45
v_and_b32 v71, s23, v45
v_lshlrev_b32 v76, 16, v46
v_and_b32 v77, s23, v46
v_lshlrev_b32 v78, 16, v47
v_and_b32 v79, s23, v47
v_pk_fma_f32 v[176:177], v[68:69], v[8:9], v[176:177]
v_pk_fma_f32 v[178:179], v[70:71], v[8:9], v[178:179]
v_pk_fma_f32 v[184:185], v[76:77], v[8:9], v[184:185]
v_pk_fma_f32 v[186:187], v[78:79], v[8:9], v[186:187]
v_cvt_pk_bf16_f32 v176, v176, v177
v_cvt_pk_bf16_f32 v177, v178, v179
v_cvt_pk_bf16_f32 v178, v184, v185
v_cvt_pk_bf16_f32 v179, v186, v187
buffer_load_dwordx4 v113, s[36:39], s81 offen offset:1024 lds
s_waitcnt vmcnt(21)
v_lshlrev_b32 v68, 16, v48
v_and_b32 v69, s23, v48
v_lshlrev_b32 v70, 16, v49
v_and_b32 v71, s23, v49
v_lshlrev_b32 v76, 16, v50
v_and_b32 v77, s23, v50
v_lshlrev_b32 v78, 16, v51
v_and_b32 v79, s23, v51
v_pk_fma_f32 v[192:193], v[68:69], v[8:9], v[192:193]
v_pk_fma_f32 v[194:195], v[70:71], v[8:9], v[194:195]
v_pk_fma_f32 v[200:201], v[76:77], v[8:9], v[200:201]
v_pk_fma_f32 v[202:203], v[78:79], v[8:9], v[202:203]
v_cvt_pk_bf16_f32 v192, v192, v193
v_cvt_pk_bf16_f32 v193, v194, v195
v_cvt_pk_bf16_f32 v194, v200, v201
v_cvt_pk_bf16_f32 v195, v202, v203
s_waitcnt vmcnt(20)
v_lshlrev_b32 v68, 16, v52
v_and_b32 v69, s23, v52
v_lshlrev_b32 v70, 16, v53
v_and_b32 v71, s23, v53
v_lshlrev_b32 v76, 16, v54
v_and_b32 v77, s23, v54
v_lshlrev_b32 v78, 16, v55
v_and_b32 v79, s23, v55
v_pk_fma_f32 v[208:209], v[68:69], v[8:9], v[208:209]
v_pk_fma_f32 v[210:211], v[70:71], v[8:9], v[210:211]
v_pk_fma_f32 v[216:217], v[76:77], v[8:9], v[216:217]
v_pk_fma_f32 v[218:219], v[78:79], v[8:9], v[218:219]
v_cvt_pk_bf16_f32 v208, v208, v209
v_cvt_pk_bf16_f32 v209, v210, v211
v_cvt_pk_bf16_f32 v210, v216, v217
v_cvt_pk_bf16_f32 v211, v218, v219
buffer_load_dwordx4 v114, s[36:39], s81 offen offset:2048 lds
s_waitcnt vmcnt(20)
v_lshlrev_b32 v68, 16, v56
v_and_b32 v69, s23, v56
v_lshlrev_b32 v70, 16, v57
v_and_b32 v71, s23, v57
v_lshlrev_b32 v76, 16, v58
v_and_b32 v77, s23, v58
v_lshlrev_b32 v78, 16, v59
v_and_b32 v79, s23, v59
v_pk_fma_f32 v[224:225], v[68:69], v[8:9], v[224:225]
v_pk_fma_f32 v[226:227], v[70:71], v[8:9], v[226:227]
v_pk_fma_f32 v[232:233], v[76:77], v[8:9], v[232:233]
v_pk_fma_f32 v[234:235], v[78:79], v[8:9], v[234:235]
v_cvt_pk_bf16_f32 v224, v224, v225
v_cvt_pk_bf16_f32 v225, v226, v227
v_cvt_pk_bf16_f32 v226, v232, v233
v_cvt_pk_bf16_f32 v227, v234, v235
s_waitcnt vmcnt(19)
v_lshlrev_b32 v68, 16, v60
v_and_b32 v69, s23, v60
v_lshlrev_b32 v70, 16, v61
v_and_b32 v71, s23, v61
v_lshlrev_b32 v76, 16, v62
v_and_b32 v77, s23, v62
v_lshlrev_b32 v78, 16, v63
v_and_b32 v79, s23, v63
v_pk_fma_f32 v[240:241], v[68:69], v[8:9], v[240:241]
v_pk_fma_f32 v[242:243], v[70:71], v[8:9], v[242:243]
v_pk_fma_f32 v[248:249], v[76:77], v[8:9], v[248:249]
v_pk_fma_f32 v[250:251], v[78:79], v[8:9], v[250:251]
v_cvt_pk_bf16_f32 v240, v240, v241
v_cvt_pk_bf16_f32 v241, v242, v243
v_cvt_pk_bf16_f32 v242, v248, v249
v_cvt_pk_bf16_f32 v243, v250, v251
buffer_load_dwordx4 v115, s[36:39], s81 offen offset:3072 lds
s_waitcnt vmcnt(19)
v_lshlrev_b32 v68, 16, v64
v_and_b32 v69, s23, v64
v_lshlrev_b32 v70, 16, v65
v_and_b32 v71, s23, v65
v_lshlrev_b32 v76, 16, v66
v_and_b32 v77, s23, v66
v_lshlrev_b32 v78, 16, v67
v_and_b32 v79, s23, v67
v_pk_fma_f32 v[132:133], v[68:69], v[10:11], v[132:133]
v_pk_fma_f32 v[134:135], v[70:71], v[10:11], v[134:135]
v_pk_fma_f32 v[140:141], v[76:77], v[10:11], v[140:141]
v_pk_fma_f32 v[142:143], v[78:79], v[10:11], v[142:143]
v_cvt_pk_bf16_f32 v132, v132, v133
v_cvt_pk_bf16_f32 v133, v134, v135
v_cvt_pk_bf16_f32 v134, v140, v141
v_cvt_pk_bf16_f32 v135, v142, v143
s_waitcnt vmcnt(18)
v_lshlrev_b32 v68, 16, v72
v_and_b32 v69, s23, v72
v_lshlrev_b32 v70, 16, v73
v_and_b32 v71, s23, v73
v_lshlrev_b32 v76, 16, v74
v_and_b32 v77, s23, v74
v_lshlrev_b32 v78, 16, v75
v_and_b32 v79, s23, v75
v_pk_fma_f32 v[148:149], v[68:69], v[10:11], v[148:149]
v_pk_fma_f32 v[150:151], v[70:71], v[10:11], v[150:151]
v_pk_fma_f32 v[156:157], v[76:77], v[10:11], v[156:157]
v_pk_fma_f32 v[158:159], v[78:79], v[10:11], v[158:159]
v_cvt_pk_bf16_f32 v148, v148, v149
v_cvt_pk_bf16_f32 v149, v150, v151
v_cvt_pk_bf16_f32 v150, v156, v157
v_cvt_pk_bf16_f32 v151, v158, v159
s_add_u32 s81, s81, 28672
s_add_u32 m0, s18, 102400
s_nop 0
buffer_load_dwordx4 v112, s[36:39], s81 offen offset:0 lds
s_waitcnt vmcnt(18)
v_lshlrev_b32 v68, 16, v80
v_and_b32 v69, s23, v80
v_lshlrev_b32 v70, 16, v81
v_and_b32 v71, s23, v81
v_lshlrev_b32 v76, 16, v82
v_and_b32 v77, s23, v82
v_lshlrev_b32 v78, 16, v83
v_and_b32 v79, s23, v83
v_pk_fma_f32 v[164:165], v[68:69], v[10:11], v[164:165]
v_pk_fma_f32 v[166:167], v[70:71], v[10:11], v[166:167]
v_pk_fma_f32 v[172:173], v[76:77], v[10:11], v[172:173]
v_pk_fma_f32 v[174:175], v[78:79], v[10:11], v[174:175]
v_cvt_pk_bf16_f32 v164, v164, v165
v_cvt_pk_bf16_f32 v165, v166, v167
v_cvt_pk_bf16_f32 v166, v172, v173
v_cvt_pk_bf16_f32 v167, v174, v175
s_waitcnt vmcnt(5)
s_barrier
v_lshlrev_b32 v68, 16, v88
v_and_b32 v69, s23, v88
v_lshlrev_b32 v70, 16, v89
v_and_b32 v71, s23, v89
v_lshlrev_b32 v76, 16, v90
v_and_b32 v77, s23, v90
v_lshlrev_b32 v78, 16, v91
v_and_b32 v79, s23, v91
v_pk_fma_f32 v[180:181], v[68:69], v[10:11], v[180:181]
v_pk_fma_f32 v[182:183], v[70:71], v[10:11], v[182:183]
v_pk_fma_f32 v[188:189], v[76:77], v[10:11], v[188:189]
v_pk_fma_f32 v[190:191], v[78:79], v[10:11], v[190:191]
v_cvt_pk_bf16_f32 v180, v180, v181
v_cvt_pk_bf16_f32 v181, v182, v183
v_cvt_pk_bf16_f32 v182, v188, v189
v_cvt_pk_bf16_f32 v183, v190, v191
buffer_load_dwordx4 v113, s[36:39], s81 offen offset:1024 lds
ds_read_b64_tr_b16 a[64:65], v116 offset:0
ds_read_b64_tr_b16 a[66:67], v116 offset:2048
ds_read_b64_tr_b16 a[68:69], v116 offset:4096
ds_read_b64_tr_b16 a[70:71], v116 offset:6144
v_lshlrev_b32 v68, 16, v96
v_and_b32 v69, s23, v96
v_lshlrev_b32 v70, 16, v97
v_and_b32 v71, s23, v97
v_lshlrev_b32 v76, 16, v98
v_and_b32 v77, s23, v98
v_lshlrev_b32 v78, 16, v99
v_and_b32 v79, s23, v99
v_pk_fma_f32 v[196:197], v[68:69], v[10:11], v[196:197]
v_pk_fma_f32 v[198:199], v[70:71], v[10:11], v[198:199]
v_pk_fma_f32 v[204:205], v[76:77], v[10:11], v[204:205]
v_pk_fma_f32 v[206:207], v[78:79], v[10:11], v[206:207]
v_cvt_pk_bf16_f32 v196, v196, v197
v_cvt_pk_bf16_f32 v197, v198, v199
v_cvt_pk_bf16_f32 v198, v204, v205
v_cvt_pk_bf16_f32 v199, v206, v207
ds_read_b64_tr_b16 a[72:73], v116 offset:8192
ds_read_b64_tr_b16 a[74:75], v116 offset:10240
ds_read_b64_tr_b16 a[76:77], v116 offset:12288
ds_read_b64_tr_b16 a[78:79], v116 offset:14336
v_lshlrev_b32 v68, 16, v100
v_and_b32 v69, s23, v100
v_lshlrev_b32 v70, 16, v101
v_and_b32 v71, s23, v101
v_lshlrev_b32 v76, 16, v102
v_and_b32 v77, s23, v102
v_lshlrev_b32 v78, 16, v103
v_and_b32 v79, s23, v103
v_pk_fma_f32 v[212:213], v[68:69], v[10:11], v[212:213]
v_pk_fma_f32 v[214:215], v[70:71], v[10:11], v[214:215]
v_pk_fma_f32 v[220:221], v[76:77], v[10:11], v[220:221]
v_pk_fma_f32 v[222:223], v[78:79], v[10:11], v[222:223]
v_cvt_pk_bf16_f32 v212, v212, v213
v_cvt_pk_bf16_f32 v213, v214, v215
v_cvt_pk_bf16_f32 v214, v220, v221
v_cvt_pk_bf16_f32 v215, v222, v223
buffer_load_dwordx4 v114, s[36:39], s81 offen offset:2048 lds
ds_read_b64_tr_b16 a[80:81], v116 offset:16384
ds_read_b64_tr_b16 a[82:83], v116 offset:18432
ds_read_b64_tr_b16 a[84:85], v116 offset:20480
ds_read_b64_tr_b16 a[86:87], v116 offset:22528
v_lshlrev_b32 v68, 16, v104
v_and_b32 v69, s23, v104
v_lshlrev_b32 v70, 16, v105
v_and_b32 v71, s23, v105
v_lshlrev_b32 v76, 16, v106
v_and_b32 v77, s23, v106
v_lshlrev_b32 v78, 16, v107
v_and_b32 v79, s23, v107
v_pk_fma_f32 v[228:229], v[68:69], v[10:11], v[228:229]
v_pk_fma_f32 v[230:231], v[70:71], v[10:11], v[230:231]
v_pk_fma_f32 v[236:237], v[76:77], v[10:11], v[236:237]
v_pk_fma_f32 v[238:239], v[78:79], v[10:11], v[238:239]
v_cvt_pk_bf16_f32 v228, v228, v229
v_cvt_pk_bf16_f32 v229, v230, v231
v_cvt_pk_bf16_f32 v230, v236, v237
v_cvt_pk_bf16_f32 v231, v238, v239
ds_read_b64_tr_b16 a[88:89], v116 offset:24576
ds_read_b64_tr_b16 a[90:91], v116 offset:26624
ds_read_b64_tr_b16 a[92:93], v116 offset:28672
ds_read_b64_tr_b16 a[94:95], v116 offset:30720
v_lshlrev_b32 v68, 16, v108
v_and_b32 v69, s23, v108
v_lshlrev_b32 v70, 16, v109
v_and_b32 v71, s23, v109
v_lshlrev_b32 v76, 16, v110
v_and_b32 v77, s23, v110
v_lshlrev_b32 v78, 16, v111
v_and_b32 v79, s23, v111
v_pk_fma_f32 v[244:245], v[68:69], v[10:11], v[244:245]
v_pk_fma_f32 v[246:247], v[70:71], v[10:11], v[246:247]
v_pk_fma_f32 v[252:253], v[76:77], v[10:11], v[252:253]
v_pk_fma_f32 v[254:255], v[78:79], v[10:11], v[254:255]
v_cvt_pk_bf16_f32 v244, v244, v245
v_cvt_pk_bf16_f32 v245, v246, v247
v_cvt_pk_bf16_f32 v246, v252, v253
v_cvt_pk_bf16_f32 v247, v254, v255
buffer_load_dwordx4 v115, s[36:39], s81 offen offset:3072 lds
s_sub_u32 s81, s81, 28544
v_add_u32 v116, 65536, v116
K2_done:
s_waitcnt lgkmcnt(0)
s_nop 0
v_mfma_f32_16x16x32_bf16 v[32:35], a[64:67], v[128:131], 0
PAD_13:
s_cbranch_execz PAD_17
s_add_u32 m0, s18, 131072
ds_read_b64_tr_b16 a[96:97], v117 offset:0
v_mov_b32 v28, v24
v_mfma_f32_16x16x32_bf16 v[32:35], a[68:71], v[144:147], v[32:35]
buffer_load_dwordx4 v112, s[36:39], s81 offen offset:0 lds
ds_read_b64_tr_b16 a[98:99], v117 offset:2048
v_mfma_f32_16x16x32_bf16 v[32:35], a[72:75], v[160:163], v[32:35]
ds_read_b64_tr_b16 a[100:101], v117 offset:4096
v_permlane16_swap_b32 v24, v28
v_mfma_f32_16x16x32_bf16 v[32:35], a[76:79], v[176:179], v[32:35]
ds_read_b64_tr_b16 a[102:103], v117 offset:6144
v_add_f32 v24, v24, v28
v_mfma_f32_16x16x32_bf16 v[32:35], a[80:83], v[192:195], v[32:35]
buffer_load_dwordx4 v113, s[36:39], s81 offen offset:1024 lds
ds_read_b64_tr_b16 a[104:105], v117 offset:8192
v_mfma_f32_16x16x32_bf16 v[32:35], a[84:87], v[208:211], v[32:35]
ds_read_b64_tr_b16 a[106:107], v117 offset:10240
v_mov_b32 v28, v24
v_mfma_f32_16x16x32_bf16 v[32:35], a[88:91], v[224:227], v[32:35]
ds_read_b64_tr_b16 a[108:109], v117 offset:12288
v_lshrrev_b32 v20, 4, v1
v_mfma_f32_16x16x32_bf16 v[32:35], a[92:95], v[240:243], v[32:35]
buffer_load_dwordx4 v114, s[36:39], s81 offen offset:2048 lds
ds_read_b64_tr_b16 a[110:111], v117 offset:14336
v_mfma_f32_16x16x32_bf16 v[36:39], a[64:67], v[132:135], 0
ds_read_b64_tr_b16 a[112:113], v117 offset:16384
v_permlane32_swap_b32 v24, v28
v_mfma_f32_16x16x32_bf16 v[36:39], a[68:71], v[148:151], v[36:39]
ds_read_b64_tr_b16 a[114:115], v117 offset:18432
v_add_f32 v24, v24, v28
v_mfma_f32_16x16x32_bf16 v[36:39], a[72:75], v[164:167], v[36:39]
buffer_load_dwordx4 v115, s[36:39], s81 offen offset:3072 lds
ds_read_b64_tr_b16 a[116:117], v117 offset:20480
v_mfma_f32_16x16x32_bf16 v[36:39], a[76:79], v[180:183], v[36:39]
ds_read_b64_tr_b16 a[118:119], v117 offset:22528
v_mov_b32 v29, v25
v_mfma_f32_16x16x32_bf16 v[36:39], a[80:83], v[196:199], v[36:39]
s_add_u32 s81, s81, 28672
s_add_u32 m0, s18, 135168
ds_read_b64_tr_b16 a[120:121], v117 offset:24576
v_mfma_f32_16x16x32_bf16 v[36:39], a[84:87], v[212:215], v[36:39]
buffer_load_dwordx4 v112, s[36:39], s81 offen offset:0 lds
ds_read_b64_tr_b16 a[122:123], v117 offset:26624
v_mfma_f32_16x16x32_bf16 v[36:39], a[88:91], v[228:231], v[36:39]
ds_read_b64_tr_b16 a[124:125], v117 offset:28672
v_permlane16_swap_b32 v25, v29
v_mfma_f32_16x16x32_bf16 v[36:39], a[92:95], v[244:247], v[36:39]
s_waitcnt lgkmcnt(8)
ds_read_b64_tr_b16 a[126:127], v117 offset:30720
v_add_u32 v117, 65536, v117
v_mfma_f32_16x16x32_bf16 v[40:43], a[96:99], v[128:131], 0
buffer_load_dwordx4 v113, s[36:39], s81 offen offset:1024 lds
ds_read_b64_tr_b16 a[64:65], v118 offset:0
v_mfma_f32_16x16x32_bf16 v[40:43], a[100:103], v[144:147], v[40:43]
ds_read_b64_tr_b16 a[66:67], v118 offset:2048
v_add_f32 v25, v25, v29
v_mfma_f32_16x16x32_bf16 v[40:43], a[104:107], v[160:163], v[40:43]
s_waitcnt lgkmcnt(8)
ds_read_b64_tr_b16 a[68:69], v118 offset:4096
v_mov_b32 v29, v25
v_mfma_f32_16x16x32_bf16 v[40:43], a[108:111], v[176:179], v[40:43]
buffer_load_dwordx4 v114, s[36:39], s81 offen offset:2048 lds
ds_read_b64_tr_b16 a[70:71], v118 offset:6144
v_mfma_f32_16x16x32_bf16 v[40:43], a[112:115], v[192:195], v[40:43]
s_waitcnt lgkmcnt(8)
ds_read_b64_tr_b16 a[72:73], v118 offset:8192
v_permlane32_swap_b32 v25, v29
v_mfma_f32_16x16x32_bf16 v[40:43], a[116:119], v[208:211], v[40:43]
s_waitcnt lgkmcnt(7)
ds_read_b64_tr_b16 a[74:75], v118 offset:10240
v_add_f32 v25, v25, v29
v_mfma_f32_16x16x32_bf16 v[40:43], a[120:123], v[224:227], v[40:43]
s_waitcnt lgkmcnt(6)
buffer_load_dwordx4 v115, s[36:39], s81 offen offset:3072 lds
ds_read_b64_tr_b16 a[76:77], v118 offset:12288
v_mfma_f32_16x16x32_bf16 v[40:43], a[124:127], v[240:243], v[40:43]
ds_read_b64_tr_b16 a[78:79], v118 offset:14336
v_rcp_f32 v24, v24
v_mfma_f32_16x16x32_bf16 v[44:47], a[96:99], v[132:135], 0
s_sub_u32 s81, s81, 28544
s_add_u32 m0, s18, 65536
ds_read_b64_tr_b16 a[80:81], v118 offset:16384
v_mfma_f32_16x16x32_bf16 v[44:47], a[100:103], v[148:151], v[44:47]
buffer_load_dwordx4 v112, s[36:39], s81 offen offset:0 lds
ds_read_b64_tr_b16 a[82:83], v118 offset:18432
v_mfma_f32_16x16x32_bf16 v[44:47], a[104:107], v[164:167], v[44:47]
ds_read_b64_tr_b16 a[84:85], v118 offset:20480
v_rcp_f32 v25, v25
v_mfma_f32_16x16x32_bf16 v[44:47], a[108:111], v[180:183], v[44:47]
PAD_14:
s_cbranch_execz PAD_18
ds_read_b64_tr_b16 a[86:87], v118 offset:22528
v_and_b32 v19, 15, v20
v_mfma_f32_16x16x32_bf16 v[44:47], a[112:115], v[196:199], v[44:47]
buffer_load_dwordx4 v113, s[36:39], s81 offen offset:1024 lds
ds_read_b64_tr_b16 a[88:89], v118 offset:24576
v_mfma_f32_16x16x32_bf16 v[44:47], a[116:119], v[212:215], v[44:47]
ds_read_b64_tr_b16 a[90:91], v118 offset:26624
v_mul_f32 v32, v32, v24
v_mfma_f32_16x16x32_bf16 v[44:47], a[120:123], v[228:231], v[44:47]
ds_read_b64_tr_b16 a[92:93], v118 offset:28672
v_mul_f32 v33, v33, v24
v_mfma_f32_16x16x32_bf16 v[44:47], a[124:127], v[244:247], v[44:47]
s_waitcnt lgkmcnt(8)
ds_read_b64_tr_b16 a[94:95], v118 offset:30720
v_add_u32 v118, 65536, v118
v_mfma_f32_16x16x32_bf16 v[48:51], a[64:67], v[128:131], 0
buffer_load_dwordx4 v114, s[36:39], s81 offen offset:2048 lds
ds_read_b64_tr_b16 a[96:97], v119 offset:0
v_mfma_f32_16x16x32_bf16 v[48:51], a[68:71], v[144:147], v[48:51]
ds_read_b64_tr_b16 a[98:99], v119 offset:2048
v_mul_f32 v34, v34, v24
v_mfma_f32_16x16x32_bf16 v[48:51], a[72:75], v[160:163], v[48:51]
s_waitcnt lgkmcnt(8)
ds_read_b64_tr_b16 a[100:101], v119 offset:4096
v_mul_f32 v35, v35, v24
v_mfma_f32_16x16x32_bf16 v[48:51], a[76:79], v[176:179], v[48:51]
buffer_load_dwordx4 v115, s[36:39], s81 offen offset:3072 lds
ds_read_b64_tr_b16 a[102:103], v119 offset:6144
v_mfma_f32_16x16x32_bf16 v[48:51], a[80:83], v[192:195], v[48:51]
s_waitcnt lgkmcnt(6)
ds_read_b64_tr_b16 a[104:105], v119 offset:8192
v_mul_f32 v40, v40, v24
v_mfma_f32_16x16x32_bf16 v[48:51], a[84:87], v[208:211], v[48:51]
s_add_u32 s81, s81, 28672
s_add_u32 m0, s18, 69632
ds_read_b64_tr_b16 a[106:107], v119 offset:10240
v_mfma_f32_16x16x32_bf16 v[48:51], a[88:91], v[224:227], v[48:51]
s_waitcnt lgkmcnt(6)
buffer_load_dwordx4 v112, s[36:39], s81 offen offset:0 lds
ds_read_b64_tr_b16 a[108:109], v119 offset:12288
v_mfma_f32_16x16x32_bf16 v[48:51], a[92:95], v[240:243], v[48:51]
ds_read_b64_tr_b16 a[110:111], v119 offset:14336
v_mul_f32 v41, v41, v24
v_mfma_f32_16x16x32_bf16 v[52:55], a[64:67], v[132:135], 0
ds_read_b64_tr_b16 a[112:113], v119 offset:16384
v_mul_f32 v42, v42, v24
v_mfma_f32_16x16x32_bf16 v[52:55], a[68:71], v[148:151], v[52:55]
buffer_load_dwordx4 v113, s[36:39], s81 offen offset:1024 lds
ds_read_b64_tr_b16 a[114:115], v119 offset:18432
v_mfma_f32_16x16x32_bf16 v[52:55], a[72:75], v[164:167], v[52:55]
ds_read_b64_tr_b16 a[116:117], v119 offset:20480
v_mul_f32 v43, v43, v24
v_mfma_f32_16x16x32_bf16 v[52:55], a[76:79], v[180:183], v[52:55]
ds_read_b64_tr_b16 a[118:119], v119 offset:22528
v_cvt_pk_bf16_f32 v32, v32, v33
v_mfma_f32_16x16x32_bf16 v[52:55], a[80:83], v[196:199], v[52:55]
buffer_load_dwordx4 v114, s[36:39], s81 offen offset:2048 lds
ds_read_b64_tr_b16 a[120:121], v119 offset:24576
v_mfma_f32_16x16x32_bf16 v[52:55], a[84:87], v[212:215], v[52:55]
ds_read_b64_tr_b16 a[122:123], v119 offset:26624
v_cvt_pk_bf16_f32 v33, v34, v35
v_mfma_f32_16x16x32_bf16 v[52:55], a[88:91], v[228:231], v[52:55]
ds_read_b64_tr_b16 a[124:125], v119 offset:28672
ds_read_b64_tr_b16 a[126:127], v119 offset:30720
v_mfma_f32_16x16x32_bf16 v[52:55], a[92:95], v[244:247], v[52:55]
s_waitcnt vmcnt(15) lgkmcnt(9)
s_barrier
v_add_u32 v119, 65536, v119
v_mfma_f32_16x16x32_bf16 v[56:59], a[96:99], v[128:131], 0
buffer_load_dwordx4 v115, s[36:39], s81 offen offset:3072 lds
ds_read_b64_tr_b16 a[64:65], v116 offset:0
v_mfma_f32_16x16x32_bf16 v[56:59], a[100:103], v[144:147], v[56:59]
s_waitcnt lgkmcnt(8)
ds_read_b64_tr_b16 a[66:67], v116 offset:2048
v_cvt_pk_bf16_f32 v34, v40, v41
v_mfma_f32_16x16x32_bf16 v[56:59], a[104:107], v[160:163], v[56:59]
s_sub_u32 s81, s81, 28544
ds_read_b64_tr_b16 a[68:69], v116 offset:4096
v_cvt_pk_bf16_f32 v35, v42, v43
v_mfma_f32_16x16x32_bf16 v[56:59], a[108:111], v[176:179], v[56:59]
s_waitcnt lgkmcnt(8)
buffer_store_dwordx4 v[32:35], v1, s[4:7], s8 offen offset:0 sc1
ds_read_b64_tr_b16 a[70:71], v116 offset:6144
v_mfma_f32_16x16x32_bf16 v[56:59], a[112:115], v[192:195], v[56:59]
s_waitcnt lgkmcnt(8)
ds_read_b64_tr_b16 a[72:73], v116 offset:8192
v_mul_f32 v36, v36, v25
v_mfma_f32_16x16x32_bf16 v[56:59], a[116:119], v[208:211], v[56:59]
s_waitcnt lgkmcnt(7)
ds_read_b64_tr_b16 a[74:75], v116 offset:10240
v_mul_f32 v37, v37, v25
v_mfma_f32_16x16x32_bf16 v[56:59], a[120:123], v[224:227], v[56:59]
s_waitcnt lgkmcnt(6)
ds_read_b64_tr_b16 a[76:77], v116 offset:12288
v_mul_f32 v38, v38, v25
v_mfma_f32_16x16x32_bf16 v[56:59], a[124:127], v[240:243], v[56:59]
ds_read_b64_tr_b16 a[78:79], v116 offset:14336
v_mul_f32 v39, v39, v25
v_mfma_f32_16x16x32_bf16 v[60:63], a[96:99], v[132:135], 0
ds_read_b64_tr_b16 a[80:81], v116 offset:16384
v_mul_f32 v44, v44, v25
v_mfma_f32_16x16x32_bf16 v[60:63], a[100:103], v[148:151], v[60:63]
ds_read_b64_tr_b16 a[82:83], v116 offset:18432
v_mul_f32 v45, v45, v25
v_mfma_f32_16x16x32_bf16 v[60:63], a[104:107], v[164:167], v[60:63]
ds_read_b64_tr_b16 a[84:85], v116 offset:20480
v_mul_f32 v46, v46, v25
v_mfma_f32_16x16x32_bf16 v[60:63], a[108:111], v[180:183], v[60:63]
ds_read_b64_tr_b16 a[86:87], v116 offset:22528
v_mul_f32 v47, v47, v25
v_mfma_f32_16x16x32_bf16 v[60:63], a[112:115], v[196:199], v[60:63]
ds_read_b64_tr_b16 a[88:89], v116 offset:24576
v_cvt_pk_bf16_f32 v36, v36, v37
v_mfma_f32_16x16x32_bf16 v[60:63], a[116:119], v[212:215], v[60:63]
ds_read_b64_tr_b16 a[90:91], v116 offset:26624
v_cvt_pk_bf16_f32 v37, v38, v39
v_mfma_f32_16x16x32_bf16 v[60:63], a[120:123], v[228:231], v[60:63]
ds_read_b64_tr_b16 a[92:93], v116 offset:28672
v_cvt_pk_bf16_f32 v38, v44, v45
v_mfma_f32_16x16x32_bf16 v[60:63], a[124:127], v[244:247], v[60:63]
s_waitcnt lgkmcnt(3)
ds_read_b64_tr_b16 a[94:95], v116 offset:30720
v_add_u32 v116, 32768, v116
v_mfma_f32_16x16x32_bf16 v[64:67], a[64:67], v[128:131], 0
s_add_u32 m0, s18, 0
ds_read_b64_tr_b16 a[96:97], v117 offset:0
v_cvt_pk_bf16_f32 v39, v46, v47
v_mfma_f32_16x16x32_bf16 v[64:67], a[68:71], v[144:147], v[64:67]
s_lshl_b32 s34, s29, 5
buffer_load_dwordx4 v112, s[36:39], s81 offen offset:0 lds
ds_read_b64_tr_b16 a[98:99], v117 offset:2048
v_mfma_f32_16x16x32_bf16 v[64:67], a[72:75], v[160:163], v[64:67]
s_add_u32 s34, s34, s20
buffer_store_dwordx4 v[36:39], v1, s[4:7], s12 offen offset:0 sc1
ds_read_b64_tr_b16 a[100:101], v117 offset:4096
v_mfma_f32_16x16x32_bf16 v[64:67], a[76:79], v[176:179], v[64:67]
s_lshl_b32 s34, s34, 2
ds_read_b64_tr_b16 a[102:103], v117 offset:6144
v_mul_f32 v48, v48, v24
v_mfma_f32_16x16x32_bf16 v[64:67], a[80:83], v[192:195], v[64:67]
s_add_u32 s34, s34, 94380032
ds_read_b64_tr_b16 a[104:105], v117 offset:8192
v_mul_f32 v49, v49, v24
v_mfma_f32_16x16x32_bf16 v[64:67], a[84:87], v[208:211], v[64:67]
s_waitcnt lgkmcnt(5)
s_add_u32 s35, s34, 2048
ds_read_b64_tr_b16 a[106:107], v117 offset:10240
v_mul_f32 v50, v50, v24
v_mfma_f32_16x16x32_bf16 v[64:67], a[88:91], v[224:227], v[64:67]
s_add_u32 s44, s34, 6144
ds_read_b64_tr_b16 a[108:109], v117 offset:12288
v_mul_f32 v51, v51, v24
v_mfma_f32_16x16x32_bf16 v[64:67], a[92:95], v[240:243], v[64:67]
s_min_u32 s80, s21, 6
ds_read_b64_tr_b16 a[110:111], v117 offset:14336
v_mul_f32 v56, v56, v24
v_mfma_f32_16x16x32_bf16 v[68:71], a[64:67], v[132:135], 0
s_add_u32 s79, s2, 0
buffer_load_dwordx4 v113, s[36:39], s81 offen offset:1024 lds
ds_read_b64_tr_b16 a[112:113], v117 offset:16384
v_mfma_f32_16x16x32_bf16 v[68:71], a[68:71], v[148:151], v[68:71]
s_lshr_b32 s79, s79, 4
ds_read_b64_tr_b16 a[114:115], v117 offset:18432
v_mul_f32 v57, v57, v24
v_mfma_f32_16x16x32_bf16 v[68:71], a[72:75], v[164:167], v[68:71]
s_or_b32 s79, s79, s2
ds_read_b64_tr_b16 a[116:117], v117 offset:20480
v_mul_f32 v58, v58, v24
v_mfma_f32_16x16x32_bf16 v[68:71], a[76:79], v[180:183], v[68:71]
s_andn2_b32 s79, 16, s79
ds_read_b64_tr_b16 a[118:119], v117 offset:22528
v_mul_f32 v59, v59, v24
v_mfma_f32_16x16x32_bf16 v[68:71], a[80:83], v[196:199], v[68:71]
s_add_u32 s79, s79, s20
ds_read_b64_tr_b16 a[120:121], v117 offset:24576
v_cvt_pk_bf16_f32 v48, v48, v49
v_mfma_f32_16x16x32_bf16 v[68:71], a[84:87], v[212:215], v[68:71]
s_lshl_b32 s22, s79, 2
ds_read_b64_tr_b16 a[122:123], v117 offset:26624
v_cvt_pk_bf16_f32 v49, v50, v51
v_mfma_f32_16x16x32_bf16 v[68:71], a[88:91], v[228:231], v[68:71]
s_add_u32 s22, s22, s3
ds_read_b64_tr_b16 a[124:125], v117 offset:28672
v_cvt_pk_bf16_f32 v50, v56, v57
v_mfma_f32_16x16x32_bf16 v[68:71], a[92:95], v[244:247], v[68:71]
s_waitcnt lgkmcnt(3)
s_mul_i32 s25, s22, 28672
ds_read_b64_tr_b16 a[126:127], v117 offset:30720
v_add_u32 v117, 32768, v117
v_mfma_f32_16x16x32_bf16 v[72:75], a[96:99], v[128:131], 0
s_lshl_b32 s23, s80, 6
buffer_load_dwordx4 v114, s[36:39], s81 offen offset:2048 lds
ds_read_b64_tr_b16 a[64:65], v118 offset:0
v_mfma_f32_16x16x32_bf16 v[72:75], a[100:103], v[144:147], v[72:75]
s_add_u32 s25, s25, s23
ds_read_b64_tr_b16 a[66:67], v118 offset:2048
v_cvt_pk_bf16_f32 v51, v58, v59
v_mfma_f32_16x16x32_bf16 v[72:75], a[104:107], v[160:163], v[72:75]
s_mul_i32 s26, s22, 229376
buffer_store_dwordx4 v[48:51], v1, s[4:7], s8 offen offset:1024 sc1
ds_read_b64_tr_b16 a[68:69], v118 offset:4096
v_mfma_f32_16x16x32_bf16 v[72:75], a[108:111], v[176:179], v[72:75]
s_lshl_b32 s23, s80, 10
ds_read_b64_tr_b16 a[70:71], v118 offset:6144
v_mul_f32 v52, v52, v25
v_mfma_f32_16x16x32_bf16 v[72:75], a[112:115], v[192:195], v[72:75]
s_add_u32 s26, s26, s23
ds_read_b64_tr_b16 a[72:73], v118 offset:8192
v_mul_f32 v53, v53, v25
v_mfma_f32_16x16x32_bf16 v[72:75], a[116:119], v[208:211], v[72:75]
s_waitcnt lgkmcnt(5)
s_add_u32 s26, s26, 104857600
ds_read_b64_tr_b16 a[74:75], v118 offset:10240
v_mul_f32 v54, v54, v25
v_mfma_f32_16x16x32_bf16 v[72:75], a[120:123], v[224:227], v[72:75]
s_lshr_b32 s22, s79, 1
ds_read_b64_tr_b16 a[76:77], v118 offset:12288
v_mul_f32 v55, v55, v25
v_mfma_f32_16x16x32_bf16 v[72:75], a[124:127], v[240:243], v[72:75]
s_lshl_b32 s22, s22, 7
buffer_load_dwordx4 v115, s[36:39], s81 offen offset:3072 lds
ds_read_b64_tr_b16 a[78:79], v118 offset:14336
v_mfma_f32_16x16x32_bf16 v[76:79], a[96:99], v[132:135], 0
s_add_u32 s33, s22, 94380032
ds_read_b64_tr_b16 a[80:81], v118 offset:16384
v_mul_f32 v60, v60, v25
v_mfma_f32_16x16x32_bf16 v[76:79], a[100:103], v[148:151], v[76:79]
s_mov_b64 s[40:41], s[88:89]
ds_read_b64_tr_b16 a[82:83], v118 offset:18432
v_mul_f32 v61, v61, v25
v_mfma_f32_16x16x32_bf16 v[76:79], a[104:107], v[164:167], v[76:79]
s_mov_b32 s42, 3670016
ds_read_b64_tr_b16 a[84:85], v118 offset:20480
v_mul_f32 v62, v62, v25
v_mfma_f32_16x16x32_bf16 v[76:79], a[108:111], v[180:183], v[76:79]
s_mov_b32 s43, 0x20000
ds_read_b64_tr_b16 a[86:87], v118 offset:22528
v_mul_f32 v63, v63, v25
v_mfma_f32_16x16x32_bf16 v[76:79], a[112:115], v[196:199], v[76:79]
ds_read_b64_tr_b16 a[88:89], v118 offset:24576
v_cvt_pk_bf16_f32 v52, v52, v53
v_mfma_f32_16x16x32_bf16 v[76:79], a[116:119], v[212:215], v[76:79]
s_add_u32 s81, s81, 28672
s_add_u32 m0, s18, 4096
ds_read_b64_tr_b16 a[90:91], v118 offset:26624
v_mfma_f32_16x16x32_bf16 v[76:79], a[120:123], v[228:231], v[76:79]
buffer_load_dwordx4 v112, s[36:39], s81 offen offset:0 lds
ds_read_b64_tr_b16 a[92:93], v118 offset:28672
v_mfma_f32_16x16x32_bf16 v[76:79], a[124:127], v[244:247], v[76:79]
s_waitcnt lgkmcnt(8)
ds_read_b64_tr_b16 a[94:95], v118 offset:30720
v_add_u32 v118, 32768, v118
v_mfma_f32_16x16x32_bf16 v[80:83], a[64:67], v[128:131], 0
ds_read_b64_tr_b16 a[96:97], v119 offset:0
v_cvt_pk_bf16_f32 v53, v54, v55
v_mfma_f32_16x16x32_bf16 v[80:83], a[68:71], v[144:147], v[80:83]
ds_read_b64_tr_b16 a[98:99], v119 offset:2048
v_cvt_pk_bf16_f32 v54, v60, v61
v_mfma_f32_16x16x32_bf16 v[80:83], a[72:75], v[160:163], v[80:83]
s_waitcnt lgkmcnt(8)
ds_read_b64_tr_b16 a[100:101], v119 offset:4096
v_cvt_pk_bf16_f32 v55, v62, v63
v_mfma_f32_16x16x32_bf16 v[80:83], a[76:79], v[176:179], v[80:83]
buffer_store_dwordx4 v[52:55], v1, s[4:7], s12 offen offset:1024 sc1
ds_read_b64_tr_b16 a[102:103], v119 offset:6144
v_mfma_f32_16x16x32_bf16 v[80:83], a[80:83], v[192:195], v[80:83]
s_waitcnt lgkmcnt(8)
ds_read_b64_tr_b16 a[104:105], v119 offset:8192
v_mfma_f32_16x16x32_bf16 v[80:83], a[84:87], v[208:211], v[80:83]
s_waitcnt lgkmcnt(7)
buffer_load_dwordx4 v113, s[36:39], s81 offen offset:1024 lds
ds_read_b64_tr_b16 a[106:107], v119 offset:10240
v_mfma_f32_16x16x32_bf16 v[80:83], a[88:91], v[224:227], v[80:83]
s_waitcnt lgkmcnt(6)
ds_read_b64_tr_b16 a[108:109], v119 offset:12288
v_mul_f32 v64, v64, v24
v_mfma_f32_16x16x32_bf16 v[80:83], a[92:95], v[240:243], v[80:83]
ds_read_b64_tr_b16 a[110:111], v119 offset:14336
v_mul_f32 v65, v65, v24
v_mfma_f32_16x16x32_bf16 v[84:87], a[64:67], v[132:135], 0
ds_read_b64_tr_b16 a[112:113], v119 offset:16384
v_mul_f32 v66, v66, v24
v_mfma_f32_16x16x32_bf16 v[84:87], a[68:71], v[148:151], v[84:87]
ds_read_b64_tr_b16 a[114:115], v119 offset:18432
v_mul_f32 v67, v67, v24
v_mfma_f32_16x16x32_bf16 v[84:87], a[72:75], v[164:167], v[84:87]
ds_read_b64_tr_b16 a[116:117], v119 offset:20480
v_mul_f32 v72, v72, v24
v_mfma_f32_16x16x32_bf16 v[84:87], a[76:79], v[180:183], v[84:87]
ds_read_b64_tr_b16 a[118:119], v119 offset:22528
v_mul_f32 v73, v73, v24
v_mfma_f32_16x16x32_bf16 v[84:87], a[80:83], v[196:199], v[84:87]
buffer_load_dwordx4 v114, s[36:39], s81 offen offset:2048 lds
ds_read_b64_tr_b16 a[120:121], v119 offset:24576
v_mfma_f32_16x16x32_bf16 v[84:87], a[84:87], v[212:215], v[84:87]
ds_read_b64_tr_b16 a[122:123], v119 offset:26624
v_mul_f32 v74, v74, v24
v_mfma_f32_16x16x32_bf16 v[84:87], a[88:91], v[228:231], v[84:87]
ds_read_b64_tr_b16 a[124:125], v119 offset:28672
ds_read_b64_tr_b16 a[126:127], v119 offset:30720
v_mfma_f32_16x16x32_bf16 v[84:87], a[92:95], v[244:247], v[84:87]
s_waitcnt vmcnt(19) lgkmcnt(9)
s_barrier
v_add_u32 v119, 32768, v119
v_mfma_f32_16x16x32_bf16 v[88:91], a[96:99], v[128:131], 0
ds_read_b64_tr_b16 a[64:65], v116 offset:0
v_mul_f32 v75, v75, v24
v_mfma_f32_16x16x32_bf16 v[88:91], a[100:103], v[144:147], v[88:91]
ds_read_b64_tr_b16 a[66:67], v116 offset:2048
v_cvt_pk_bf16_f32 v64, v64, v65
v_mfma_f32_16x16x32_bf16 v[88:91], a[104:107], v[160:163], v[88:91]
s_waitcnt lgkmcnt(8)
ds_read_b64_tr_b16 a[68:69], v116 offset:4096
v_cvt_pk_bf16_f32 v65, v66, v67
v_mfma_f32_16x16x32_bf16 v[88:91], a[108:111], v[176:179], v[88:91]
buffer_load_dwordx4 v115, s[36:39], s81 offen offset:3072 lds
ds_read_b64_tr_b16 a[70:71], v116 offset:6144
v_mfma_f32_16x16x32_bf16 v[88:91], a[112:115], v[192:195], v[88:91]
s_waitcnt lgkmcnt(8)
ds_read_b64_tr_b16 a[72:73], v116 offset:8192
v_cvt_pk_bf16_f32 v66, v72, v73
v_mfma_f32_16x16x32_bf16 v[88:91], a[116:119], v[208:211], v[88:91]
s_waitcnt lgkmcnt(7)
ds_read_b64_tr_b16 a[74:75], v116 offset:10240
v_cvt_pk_bf16_f32 v67, v74, v75
v_mfma_f32_16x16x32_bf16 v[88:91], a[120:123], v[224:227], v[88:91]
s_waitcnt lgkmcnt(6)
buffer_store_dwordx4 v[64:67], v1, s[4:7], s8 offen offset:2048 sc1
ds_read_b64_tr_b16 a[76:77], v116 offset:12288
v_mfma_f32_16x16x32_bf16 v[88:91], a[124:127], v[240:243], v[88:91]
ds_read_b64_tr_b16 a[78:79], v116 offset:14336
v_mul_f32 v68, v68, v25
v_mfma_f32_16x16x32_bf16 v[92:95], a[96:99], v[132:135], 0
ds_read_b64_tr_b16 a[80:81], v116 offset:16384
v_mul_f32 v69, v69, v25
v_mfma_f32_16x16x32_bf16 v[92:95], a[100:103], v[148:151], v[92:95]
s_sub_u32 s81, s81, 28544
ds_read_b64_tr_b16 a[82:83], v116 offset:18432
v_mul_f32 v70, v70, v25
v_mfma_f32_16x16x32_bf16 v[92:95], a[104:107], v[164:167], v[92:95]
ds_read_b64_tr_b16 a[84:85], v116 offset:20480
v_mul_f32 v71, v71, v25
v_mfma_f32_16x16x32_bf16 v[92:95], a[108:111], v[180:183], v[92:95]
ds_read_b64_tr_b16 a[86:87], v116 offset:22528
v_mul_f32 v76, v76, v25
v_mfma_f32_16x16x32_bf16 v[92:95], a[112:115], v[196:199], v[92:95]
ds_read_b64_tr_b16 a[88:89], v116 offset:24576
v_mul_f32 v77, v77, v25
v_mfma_f32_16x16x32_bf16 v[92:95], a[116:119], v[212:215], v[92:95]
ds_read_b64_tr_b16 a[90:91], v116 offset:26624
v_mul_f32 v78, v78, v25
v_mfma_f32_16x16x32_bf16 v[92:95], a[120:123], v[228:231], v[92:95]
ds_read_b64_tr_b16 a[92:93], v116 offset:28672
v_mul_f32 v79, v79, v25
v_mfma_f32_16x16x32_bf16 v[92:95], a[124:127], v[244:247], v[92:95]
s_waitcnt lgkmcnt(8)
ds_read_b64_tr_b16 a[94:95], v116 offset:30720
v_add_u32 v116, 4294901760, v116
v_mfma_f32_16x16x32_bf16 v[32:35], a[64:67], v[128:131], 0
s_add_u32 m0, s18, 32768
ds_read_b64_tr_b16 a[96:97], v117 offset:0
v_cvt_pk_bf16_f32 v68, v68, v69
v_mfma_f32_16x16x32_bf16 v[32:35], a[68:71], v[144:147], v[32:35]
buffer_load_dwordx4 v112, s[36:39], s81 offen offset:0 lds
ds_read_b64_tr_b16 a[98:99], v117 offset:2048
v_mfma_f32_16x16x32_bf16 v[32:35], a[72:75], v[160:163], v[32:35]
s_waitcnt lgkmcnt(8)
ds_read_b64_tr_b16 a[100:101], v117 offset:4096
v_cvt_pk_bf16_f32 v69, v70, v71
v_mfma_f32_16x16x32_bf16 v[32:35], a[76:79], v[176:179], v[32:35]
ds_read_b64_tr_b16 a[102:103], v117 offset:6144
v_cvt_pk_bf16_f32 v70, v76, v77
v_mfma_f32_16x16x32_bf16 v[32:35], a[80:83], v[192:195], v[32:35]
s_waitcnt lgkmcnt(8)
ds_read_b64_tr_b16 a[104:105], v117 offset:8192
v_cvt_pk_bf16_f32 v71, v78, v79
v_mfma_f32_16x16x32_bf16 v[32:35], a[84:87], v[208:211], v[32:35]
s_waitcnt lgkmcnt(7)
buffer_store_dwordx4 v[68:71], v1, s[4:7], s12 offen offset:2048 sc1
ds_read_b64_tr_b16 a[106:107], v117 offset:10240
v_mfma_f32_16x16x32_bf16 v[32:35], a[88:91], v[224:227], v[32:35]
s_waitcnt lgkmcnt(6)
ds_read_b64_tr_b16 a[108:109], v117 offset:12288
v_mul_f32 v80, v80, v24
v_mfma_f32_16x16x32_bf16 v[32:35], a[92:95], v[240:243], v[32:35]
ds_read_b64_tr_b16 a[110:111], v117 offset:14336
v_mul_f32 v81, v81, v24
v_mfma_f32_16x16x32_bf16 v[36:39], a[64:67], v[132:135], 0
buffer_load_dwordx4 v113, s[36:39], s81 offen offset:1024 lds
ds_read_b64_tr_b16 a[112:113], v117 offset:16384
v_mfma_f32_16x16x32_bf16 v[36:39], a[68:71], v[148:151], v[36:39]
ds_read_b64_tr_b16 a[114:115], v117 offset:18432
v_mul_f32 v82, v82, v24
v_mfma_f32_16x16x32_bf16 v[36:39], a[72:75], v[164:167], v[36:39]
ds_read_b64_tr_b16 a[116:117], v117 offset:20480
v_mul_f32 v83, v83, v24
v_mfma_f32_16x16x32_bf16 v[36:39], a[76:79], v[180:183], v[36:39]
ds_read_b64_tr_b16 a[118:119], v117 offset:22528
v_mul_f32 v88, v88, v24
v_mfma_f32_16x16x32_bf16 v[36:39], a[80:83], v[196:199], v[36:39]
ds_read_b64_tr_b16 a[120:121], v117 offset:24576
v_mul_f32 v89, v89, v24
v_mfma_f32_16x16x32_bf16 v[36:39], a[84:87], v[212:215], v[36:39]
ds_read_b64_tr_b16 a[122:123], v117 offset:26624
v_mul_f32 v90, v90, v24
v_mfma_f32_16x16x32_bf16 v[36:39], a[88:91], v[228:231], v[36:39]
ds_read_b64_tr_b16 a[124:125], v117 offset:28672
v_mul_f32 v91, v91, v24
v_mfma_f32_16x16x32_bf16 v[36:39], a[92:95], v[244:247], v[36:39]
s_waitcnt lgkmcnt(8)
ds_read_b64_tr_b16 a[126:127], v117 offset:30720
v_add_u32 v117, 4294901760, v117
v_mfma_f32_16x16x32_bf16 v[40:43], a[96:99], v[128:131], 0
buffer_load_dwordx4 v114, s[36:39], s81 offen offset:2048 lds
ds_read_b64_tr_b16 a[64:65], v118 offset:0
v_mfma_f32_16x16x32_bf16 v[40:43], a[100:103], v[144:147], v[40:43]
ds_read_b64_tr_b16 a[66:67], v118 offset:2048
v_cvt_pk_bf16_f32 v80, v80, v81
v_mfma_f32_16x16x32_bf16 v[40:43], a[104:107], v[160:163], v[40:43]
s_waitcnt lgkmcnt(8)
ds_read_b64_tr_b16 a[68:69], v118 offset:4096
v_cvt_pk_bf16_f32 v81, v82, v83
v_mfma_f32_16x16x32_bf16 v[40:43], a[108:111], v[176:179], v[40:43]
ds_read_b64_tr_b16 a[70:71], v118 offset:6144
v_cvt_pk_bf16_f32 v82, v88, v89
v_mfma_f32_16x16x32_bf16 v[40:43], a[112:115], v[192:195], v[40:43]
s_waitcnt lgkmcnt(8)
ds_read_b64_tr_b16 a[72:73], v118 offset:8192
v_cvt_pk_bf16_f32 v83, v90, v91
v_mfma_f32_16x16x32_bf16 v[40:43], a[116:119], v[208:211], v[40:43]
s_waitcnt lgkmcnt(7)
buffer_store_dwordx4 v[80:83], v1, s[4:7], s8 offen offset:3072 sc1
ds_read_b64_tr_b16 a[74:75], v118 offset:10240
v_mfma_f32_16x16x32_bf16 v[40:43], a[120:123], v[224:227], v[40:43]
s_waitcnt lgkmcnt(6)
ds_read_b64_tr_b16 a[76:77], v118 offset:12288
v_mul_f32 v84, v84, v25
v_mfma_f32_16x16x32_bf16 v[40:43], a[124:127], v[240:243], v[40:43]
buffer_load_dwordx4 v115, s[36:39], s81 offen offset:3072 lds
ds_read_b64_tr_b16 a[78:79], v118 offset:14336
v_mfma_f32_16x16x32_bf16 v[44:47], a[96:99], v[132:135], 0
ds_read_b64_tr_b16 a[80:81], v118 offset:16384
v_mul_f32 v85, v85, v25
v_mfma_f32_16x16x32_bf16 v[44:47], a[100:103], v[148:151], v[44:47]
ds_read_b64_tr_b16 a[82:83], v118 offset:18432
v_mul_f32 v86, v86, v25
v_mfma_f32_16x16x32_bf16 v[44:47], a[104:107], v[164:167], v[44:47]
ds_read_b64_tr_b16 a[84:85], v118 offset:20480
v_mul_f32 v87, v87, v25
v_mfma_f32_16x16x32_bf16 v[44:47], a[108:111], v[180:183], v[44:47]
ds_read_b64_tr_b16 a[86:87], v118 offset:22528
v_mul_f32 v92, v92, v25
v_mfma_f32_16x16x32_bf16 v[44:47], a[112:115], v[196:199], v[44:47]
ds_read_b64_tr_b16 a[88:89], v118 offset:24576
v_mul_f32 v93, v93, v25
v_mfma_f32_16x16x32_bf16 v[44:47], a[116:119], v[212:215], v[44:47]
s_add_u32 s81, s81, 28672
s_add_u32 m0, s18, 36864
ds_read_b64_tr_b16 a[90:91], v118 offset:26624
v_mfma_f32_16x16x32_bf16 v[44:47], a[120:123], v[228:231], v[44:47]
buffer_load_dwordx4 v112, s[36:39], s81 offen offset:0 lds
ds_read_b64_tr_b16 a[92:93], v118 offset:28672
v_mfma_f32_16x16x32_bf16 v[44:47], a[124:127], v[244:247], v[44:47]
s_waitcnt lgkmcnt(8)
ds_read_b64_tr_b16 a[94:95], v118 offset:30720
v_add_u32 v118, 4294901760, v118
v_mfma_f32_16x16x32_bf16 v[48:51], a[64:67], v[128:131], 0
ds_read_b64_tr_b16 a[96:97], v119 offset:0
v_mul_f32 v94, v94, v25
v_mfma_f32_16x16x32_bf16 v[48:51], a[68:71], v[144:147], v[48:51]
ds_read_b64_tr_b16 a[98:99], v119 offset:2048
v_mul_f32 v95, v95, v25
v_mfma_f32_16x16x32_bf16 v[48:51], a[72:75], v[160:163], v[48:51]
s_waitcnt lgkmcnt(8)
ds_read_b64_tr_b16 a[100:101], v119 offset:4096
v_cvt_pk_bf16_f32 v84, v84, v85
v_mfma_f32_16x16x32_bf16 v[48:51], a[76:79], v[176:179], v[48:51]
ds_read_b64_tr_b16 a[102:103], v119 offset:6144
v_cvt_pk_bf16_f32 v85, v86, v87
v_mfma_f32_16x16x32_bf16 v[48:51], a[80:83], v[192:195], v[48:51]
s_waitcnt lgkmcnt(8)
ds_read_b64_tr_b16 a[104:105], v119 offset:8192
v_cvt_pk_bf16_f32 v86, v92, v93
v_mfma_f32_16x16x32_bf16 v[48:51], a[84:87], v[208:211], v[48:51]
s_waitcnt lgkmcnt(7)
buffer_load_dwordx4 v113, s[36:39], s81 offen offset:1024 lds
ds_read_b64_tr_b16 a[106:107], v119 offset:10240
v_mfma_f32_16x16x32_bf16 v[48:51], a[88:91], v[224:227], v[48:51]
s_waitcnt lgkmcnt(6)
ds_read_b64_tr_b16 a[108:109], v119 offset:12288
v_cvt_pk_bf16_f32 v87, v94, v95
v_mfma_f32_16x16x32_bf16 v[48:51], a[92:95], v[240:243], v[48:51]
buffer_store_dwordx4 v[84:87], v1, s[4:7], s12 offen offset:3072 sc1
ds_read_b64_tr_b16 a[110:111], v119 offset:14336
v_mfma_f32_16x16x32_bf16 v[52:55], a[64:67], v[132:135], 0
s_add_u32 s8, s8, 4096
s_add_u32 s12, s12, 4096
ds_read_b64_tr_b16 a[112:113], v119 offset:16384
v_mfma_f32_16x16x32_bf16 v[52:55], a[68:71], v[148:151], v[52:55]
ds_read_b64_tr_b16 a[114:115], v119 offset:18432
v_mul_f32 v32, v32, v24
v_mfma_f32_16x16x32_bf16 v[52:55], a[72:75], v[164:167], v[52:55]
ds_read_b64_tr_b16 a[116:117], v119 offset:20480
v_mul_f32 v33, v33, v24
v_mfma_f32_16x16x32_bf16 v[52:55], a[76:79], v[180:183], v[52:55]
ds_read_b64_tr_b16 a[118:119], v119 offset:22528
v_mul_f32 v34, v34, v24
v_mfma_f32_16x16x32_bf16 v[52:55], a[80:83], v[196:199], v[52:55]
buffer_load_dwordx4 v114, s[36:39], s81 offen offset:2048 lds
ds_read_b64_tr_b16 a[120:121], v119 offset:24576
v_mfma_f32_16x16x32_bf16 v[52:55], a[84:87], v[212:215], v[52:55]
ds_read_b64_tr_b16 a[122:123], v119 offset:26624
v_mul_f32 v35, v35, v24
v_mfma_f32_16x16x32_bf16 v[52:55], a[88:91], v[228:231], v[52:55]
ds_read_b64_tr_b16 a[124:125], v119 offset:28672
ds_read_b64_tr_b16 a[126:127], v119 offset:30720
v_mfma_f32_16x16x32_bf16 v[52:55], a[92:95], v[244:247], v[52:55]
s_waitcnt vmcnt(23) lgkmcnt(9)
s_barrier
v_add_u32 v119, 4294901760, v119
v_mfma_f32_16x16x32_bf16 v[56:59], a[96:99], v[128:131], 0
ds_read_b64_tr_b16 a[64:65], v116 offset:0
v_mul_f32 v40, v40, v24
v_mfma_f32_16x16x32_bf16 v[56:59], a[100:103], v[144:147], v[56:59]
ds_read_b64_tr_b16 a[66:67], v116 offset:2048
v_mul_f32 v41, v41, v24
v_mfma_f32_16x16x32_bf16 v[56:59], a[104:107], v[160:163], v[56:59]
s_waitcnt lgkmcnt(8)
ds_read_b64_tr_b16 a[68:69], v116 offset:4096
v_mul_f32 v42, v42, v24
v_mfma_f32_16x16x32_bf16 v[56:59], a[108:111], v[176:179], v[56:59]
buffer_load_dwordx4 v115, s[36:39], s81 offen offset:3072 lds
ds_read_b64_tr_b16 a[70:71], v116 offset:6144
v_mfma_f32_16x16x32_bf16 v[56:59], a[112:115], v[192:195], v[56:59]
s_waitcnt lgkmcnt(8)
ds_read_b64_tr_b16 a[72:73], v116 offset:8192
v_mul_f32 v43, v43, v24
v_mfma_f32_16x16x32_bf16 v[56:59], a[116:119], v[208:211], v[56:59]
s_waitcnt lgkmcnt(7)
ds_read_b64_tr_b16 a[74:75], v116 offset:10240
v_cvt_pk_bf16_f32 v32, v32, v33
v_mfma_f32_16x16x32_bf16 v[56:59], a[120:123], v[224:227], v[56:59]
s_waitcnt lgkmcnt(6)
ds_read_b64_tr_b16 a[76:77], v116 offset:12288
v_cvt_pk_bf16_f32 v33, v34, v35
v_mfma_f32_16x16x32_bf16 v[56:59], a[124:127], v[240:243], v[56:59]
ds_read_b64_tr_b16 a[78:79], v116 offset:14336
v_cvt_pk_bf16_f32 v34, v40, v41
v_mfma_f32_16x16x32_bf16 v[60:63], a[96:99], v[132:135], 0
ds_read_b64_tr_b16 a[80:81], v116 offset:16384
v_cvt_pk_bf16_f32 v35, v42, v43
v_mfma_f32_16x16x32_bf16 v[60:63], a[100:103], v[148:151], v[60:63]
s_sub_u32 s81, s81, 28544
buffer_store_dwordx4 v[32:35], v1, s[4:7], s8 offen offset:0 sc1
ds_read_b64_tr_b16 a[82:83], v116 offset:18432
v_mfma_f32_16x16x32_bf16 v[60:63], a[104:107], v[164:167], v[60:63]
ds_read_b64_tr_b16 a[84:85], v116 offset:20480
v_mul_f32 v36, v36, v25
v_mfma_f32_16x16x32_bf16 v[60:63], a[108:111], v[180:183], v[60:63]
ds_read_b64_tr_b16 a[86:87], v116 offset:22528
v_mul_f32 v37, v37, v25
v_mfma_f32_16x16x32_bf16 v[60:63], a[112:115], v[196:199], v[60:63]
ds_read_b64_tr_b16 a[88:89], v116 offset:24576
v_mul_f32 v38, v38, v25
v_mfma_f32_16x16x32_bf16 v[60:63], a[116:119], v[212:215], v[60:63]
ds_read_b64_tr_b16 a[90:91], v116 offset:26624
v_mul_f32 v39, v39, v25
v_mfma_f32_16x16x32_bf16 v[60:63], a[120:123], v[228:231], v[60:63]
ds_read_b64_tr_b16 a[92:93], v116 offset:28672
v_mul_f32 v44, v44, v25
v_mfma_f32_16x16x32_bf16 v[60:63], a[124:127], v[244:247], v[60:63]
s_waitcnt lgkmcnt(8)
ds_read_b64_tr_b16 a[94:95], v116 offset:30720
v_add_u32 v116, 4294901760, v116
v_mfma_f32_16x16x32_bf16 v[64:67], a[64:67], v[128:131], 0
s_add_u32 m0, s18, 98304
ds_read_b64_tr_b16 a[96:97], v117 offset:0
v_mul_f32 v45, v45, v25
v_mfma_f32_16x16x32_bf16 v[64:67], a[68:71], v[144:147], v[64:67]
buffer_load_dwordx4 v112, s[36:39], s81 offen offset:0 lds
ds_read_b64_tr_b16 a[98:99], v117 offset:2048
v_mfma_f32_16x16x32_bf16 v[64:67], a[72:75], v[160:163], v[64:67]
s_waitcnt lgkmcnt(8)
ds_read_b64_tr_b16 a[100:101], v117 offset:4096
v_mul_f32 v46, v46, v25
v_mfma_f32_16x16x32_bf16 v[64:67], a[76:79], v[176:179], v[64:67]
PAD_15:
s_cbranch_execz M_tret
ds_read_b64_tr_b16 a[102:103], v117 offset:6144
v_mul_f32 v47, v47, v25
v_mfma_f32_16x16x32_bf16 v[64:67], a[80:83], v[192:195], v[64:67]
s_waitcnt lgkmcnt(8)
ds_read_b64_tr_b16 a[104:105], v117 offset:8192
v_cvt_pk_bf16_f32 v36, v36, v37
v_mfma_f32_16x16x32_bf16 v[64:67], a[84:87], v[208:211], v[64:67]
s_waitcnt lgkmcnt(7)
ds_read_b64_tr_b16 a[106:107], v117 offset:10240
v_cvt_pk_bf16_f32 v37, v38, v39
v_mfma_f32_16x16x32_bf16 v[64:67], a[88:91], v[224:227], v[64:67]
s_waitcnt lgkmcnt(6)
ds_read_b64_tr_b16 a[108:109], v117 offset:12288
v_cvt_pk_bf16_f32 v38, v44, v45
v_mfma_f32_16x16x32_bf16 v[64:67], a[92:95], v[240:243], v[64:67]
ds_read_b64_tr_b16 a[110:111], v117 offset:14336
v_cvt_pk_bf16_f32 v39, v46, v47
v_mfma_f32_16x16x32_bf16 v[68:71], a[64:67], v[132:135], 0
buffer_load_dwordx4 v113, s[36:39], s81 offen offset:1024 lds
ds_read_b64_tr_b16 a[112:113], v117 offset:16384
v_mfma_f32_16x16x32_bf16 v[68:71], a[68:71], v[148:151], v[68:71]
buffer_store_dwordx4 v[36:39], v1, s[4:7], s12 offen offset:0 sc1
ds_read_b64_tr_b16 a[114:115], v117 offset:18432
v_mfma_f32_16x16x32_bf16 v[68:71], a[72:75], v[164:167], v[68:71]
ds_read_b64_tr_b16 a[116:117], v117 offset:20480
v_mul_f32 v48, v48, v24
v_mfma_f32_16x16x32_bf16 v[68:71], a[76:79], v[180:183], v[68:71]
ds_read_b64_tr_b16 a[118:119], v117 offset:22528
v_mul_f32 v49, v49, v24
v_mfma_f32_16x16x32_bf16 v[68:71], a[80:83], v[196:199], v[68:71]
ds_read_b64_tr_b16 a[120:121], v117 offset:24576
v_mul_f32 v50, v50, v24
v_mfma_f32_16x16x32_bf16 v[68:71], a[84:87], v[212:215], v[68:71]
ds_read_b64_tr_b16 a[122:123], v117 offset:26624
v_mul_f32 v51, v51, v24
v_mfma_f32_16x16x32_bf16 v[68:71], a[88:91], v[228:231], v[68:71]
ds_read_b64_tr_b16 a[124:125], v117 offset:28672
v_mul_f32 v56, v56, v24
v_mfma_f32_16x16x32_bf16 v[68:71], a[92:95], v[244:247], v[68:71]
s_waitcnt lgkmcnt(8)
ds_read_b64_tr_b16 a[126:127], v117 offset:30720
v_add_u32 v117, 4294901760, v117
v_mfma_f32_16x16x32_bf16 v[72:75], a[96:99], v[128:131], 0
buffer_load_dwordx4 v114, s[36:39], s81 offen offset:2048 lds
ds_read_b64_tr_b16 a[64:65], v118 offset:0
v_mfma_f32_16x16x32_bf16 v[72:75], a[100:103], v[144:147], v[72:75]
ds_read_b64_tr_b16 a[66:67], v118 offset:2048
v_mul_f32 v57, v57, v24
v_mfma_f32_16x16x32_bf16 v[72:75], a[104:107], v[160:163], v[72:75]
s_waitcnt lgkmcnt(8)
ds_read_b64_tr_b16 a[68:69], v118 offset:4096
v_mul_f32 v58, v58, v24
v_mfma_f32_16x16x32_bf16 v[72:75], a[108:111], v[176:179], v[72:75]
ds_read_b64_tr_b16 a[70:71], v118 offset:6144
v_mul_f32 v59, v59, v24
v_mfma_f32_16x16x32_bf16 v[72:75], a[112:115], v[192:195], v[72:75]
s_waitcnt lgkmcnt(8)
ds_read_b64_tr_b16 a[72:73], v118 offset:8192
v_cvt_pk_bf16_f32 v48, v48, v49
v_mfma_f32_16x16x32_bf16 v[72:75], a[116:119], v[208:211], v[72:75]
s_waitcnt lgkmcnt(7)
ds_read_b64_tr_b16 a[74:75], v118 offset:10240
v_cvt_pk_bf16_f32 v49, v50, v51
v_mfma_f32_16x16x32_bf16 v[72:75], a[120:123], v[224:227], v[72:75]
s_waitcnt lgkmcnt(6)
ds_read_b64_tr_b16 a[76:77], v118 offset:12288
v_cvt_pk_bf16_f32 v50, v56, v57
v_mfma_f32_16x16x32_bf16 v[72:75], a[124:127], v[240:243], v[72:75]
buffer_load_dwordx4 v115, s[36:39], s81 offen offset:3072 lds
ds_read_b64_tr_b16 a[78:79], v118 offset:14336
v_mfma_f32_16x16x32_bf16 v[76:79], a[96:99], v[132:135], 0
ds_read_b64_tr_b16 a[80:81], v118 offset:16384
v_cvt_pk_bf16_f32 v51, v58, v59
v_mfma_f32_16x16x32_bf16 v[76:79], a[100:103], v[148:151], v[76:79]
buffer_store_dwordx4 v[48:51], v1, s[4:7], s8 offen offset:1024 sc1
ds_read_b64_tr_b16 a[82:83], v118 offset:18432
v_mfma_f32_16x16x32_bf16 v[76:79], a[104:107], v[164:167], v[76:79]
ds_read_b64_tr_b16 a[84:85], v118 offset:20480
v_mul_f32 v52, v52, v25
v_mfma_f32_16x16x32_bf16 v[76:79], a[108:111], v[180:183], v[76:79]
ds_read_b64_tr_b16 a[86:87], v118 offset:22528
v_mul_f32 v53, v53, v25
v_mfma_f32_16x16x32_bf16 v[76:79], a[112:115], v[196:199], v[76:79]
ds_read_b64_tr_b16 a[88:89], v118 offset:24576
v_mul_f32 v54, v54, v25
v_mfma_f32_16x16x32_bf16 v[76:79], a[116:119], v[212:215], v[76:79]
s_add_u32 s81, s81, 28672
s_add_u32 m0, s18, 102400
ds_read_b64_tr_b16 a[90:91], v118 offset:26624
v_mfma_f32_16x16x32_bf16 v[76:79], a[120:123], v[228:231], v[76:79]
buffer_load_dwordx4 v112, s[36:39], s81 offen offset:0 lds
ds_read_b64_tr_b16 a[92:93], v118 offset:28672
v_mfma_f32_16x16x32_bf16 v[76:79], a[124:127], v[244:247], v[76:79]
s_waitcnt lgkmcnt(8)
ds_read_b64_tr_b16 a[94:95], v118 offset:30720
v_add_u32 v118, 4294901760, v118
v_mfma_f32_16x16x32_bf16 v[80:83], a[64:67], v[128:131], 0
ds_read_b64_tr_b16 a[96:97], v119 offset:0
v_mul_f32 v55, v55, v25
v_mfma_f32_16x16x32_bf16 v[80:83], a[68:71], v[144:147], v[80:83]
ds_read_b64_tr_b16 a[98:99], v119 offset:2048
v_mul_f32 v60, v60, v25
v_mfma_f32_16x16x32_bf16 v[80:83], a[72:75], v[160:163], v[80:83]
s_waitcnt lgkmcnt(8)
ds_read_b64_tr_b16 a[100:101], v119 offset:4096
v_mul_f32 v61, v61, v25
v_mfma_f32_16x16x32_bf16 v[80:83], a[76:79], v[176:179], v[80:83]
ds_read_b64_tr_b16 a[102:103], v119 offset:6144
v_mul_f32 v62, v62, v25
v_mfma_f32_16x16x32_bf16 v[80:83], a[80:83], v[192:195], v[80:83]
s_waitcnt lgkmcnt(8)
ds_read_b64_tr_b16 a[104:105], v119 offset:8192
v_mul_f32 v63, v63, v25
v_mfma_f32_16x16x32_bf16 v[80:83], a[84:87], v[208:211], v[80:83]
s_waitcnt lgkmcnt(7)
buffer_load_dwordx4 v113, s[36:39], s81 offen offset:1024 lds
ds_read_b64_tr_b16 a[106:107], v119 offset:10240
v_mfma_f32_16x16x32_bf16 v[80:83], a[88:91], v[224:227], v[80:83]
s_waitcnt lgkmcnt(6)
ds_read_b64_tr_b16 a[108:109], v119 offset:12288
v_cvt_pk_bf16_f32 v52, v52, v53
v_mfma_f32_16x16x32_bf16 v[80:83], a[92:95], v[240:243], v[80:83]
ds_read_b64_tr_b16 a[110:111], v119 offset:14336
v_cvt_pk_bf16_f32 v53, v54, v55
v_mfma_f32_16x16x32_bf16 v[84:87], a[64:67], v[132:135], 0
ds_read_b64_tr_b16 a[112:113], v119 offset:16384
v_cvt_pk_bf16_f32 v54, v60, v61
v_mfma_f32_16x16x32_bf16 v[84:87], a[68:71], v[148:151], v[84:87]
ds_read_b64_tr_b16 a[114:115], v119 offset:18432
v_cvt_pk_bf16_f32 v55, v62, v63
v_mfma_f32_16x16x32_bf16 v[84:87], a[72:75], v[164:167], v[84:87]
buffer_store_dwordx4 v[52:55], v1, s[4:7], s12 offen offset:1024 sc1
ds_read_b64_tr_b16 a[116:117], v119 offset:20480
v_mfma_f32_16x16x32_bf16 v[84:87], a[76:79], v[180:183], v[84:87]
ds_read_b64_tr_b16 a[118:119], v119 offset:22528
v_mfma_f32_16x16x32_bf16 v[84:87], a[80:83], v[196:199], v[84:87]
buffer_load_dwordx4 v114, s[36:39], s81 offen offset:2048 lds
ds_read_b64_tr_b16 a[120:121], v119 offset:24576
v_mfma_f32_16x16x32_bf16 v[84:87], a[84:87], v[212:215], v[84:87]
ds_read_b64_tr_b16 a[122:123], v119 offset:26624
v_mul_f32 v64, v64, v24
v_mfma_f32_16x16x32_bf16 v[84:87], a[88:91], v[228:231], v[84:87]
ds_read_b64_tr_b16 a[124:125], v119 offset:28672
ds_read_b64_tr_b16 a[126:127], v119 offset:30720
v_mfma_f32_16x16x32_bf16 v[84:87], a[92:95], v[244:247], v[84:87]
s_waitcnt vmcnt(23) lgkmcnt(9)
s_barrier
v_add_u32 v119, 4294901760, v119
v_mfma_f32_16x16x32_bf16 v[88:91], a[96:99], v[128:131], 0
ds_read_b64_tr_b16 a[64:65], v116 offset:0
v_mul_f32 v65, v65, v24
v_mfma_f32_16x16x32_bf16 v[88:91], a[100:103], v[144:147], v[88:91]
ds_read_b64_tr_b16 a[66:67], v116 offset:2048
v_mul_f32 v66, v66, v24
v_mfma_f32_16x16x32_bf16 v[88:91], a[104:107], v[160:163], v[88:91]
s_waitcnt lgkmcnt(8)
ds_read_b64_tr_b16 a[68:69], v116 offset:4096
v_mul_f32 v67, v67, v24
v_mfma_f32_16x16x32_bf16 v[88:91], a[108:111], v[176:179], v[88:91]
buffer_load_dwordx4 v115, s[36:39], s81 offen offset:3072 lds
ds_read_b64_tr_b16 a[70:71], v116 offset:6144
v_mfma_f32_16x16x32_bf16 v[88:91], a[112:115], v[192:195], v[88:91]
s_waitcnt lgkmcnt(8)
ds_read_b64_tr_b16 a[72:73], v116 offset:8192
v_mul_f32 v72, v72, v24
v_mfma_f32_16x16x32_bf16 v[88:91], a[116:119], v[208:211], v[88:91]
s_waitcnt lgkmcnt(7)
ds_read_b64_tr_b16 a[74:75], v116 offset:10240
v_mul_f32 v73, v73, v24
v_mfma_f32_16x16x32_bf16 v[88:91], a[120:123], v[224:227], v[88:91]
s_waitcnt lgkmcnt(6)
ds_read_b64_tr_b16 a[76:77], v116 offset:12288
v_mul_f32 v74, v74, v24
v_mfma_f32_16x16x32_bf16 v[88:91], a[124:127], v[240:243], v[88:91]
ds_read_b64_tr_b16 a[78:79], v116 offset:14336
v_mul_f32 v75, v75, v24
v_mfma_f32_16x16x32_bf16 v[92:95], a[96:99], v[132:135], 0
ds_read_b64_tr_b16 a[80:81], v116 offset:16384
v_cvt_pk_bf16_f32 v64, v64, v65
v_mfma_f32_16x16x32_bf16 v[92:95], a[100:103], v[148:151], v[92:95]
s_sub_u32 s81, s81, 28544
ds_read_b64_tr_b16 a[82:83], v116 offset:18432
v_cvt_pk_bf16_f32 v65, v66, v67
v_mfma_f32_16x16x32_bf16 v[92:95], a[104:107], v[164:167], v[92:95]
ds_read_b64_tr_b16 a[84:85], v116 offset:20480
v_cvt_pk_bf16_f32 v66, v72, v73
v_mfma_f32_16x16x32_bf16 v[92:95], a[108:111], v[180:183], v[92:95]
ds_read_b64_tr_b16 a[86:87], v116 offset:22528
v_cvt_pk_bf16_f32 v67, v74, v75
v_mfma_f32_16x16x32_bf16 v[92:95], a[112:115], v[196:199], v[92:95]
buffer_store_dwordx4 v[64:67], v1, s[4:7], s8 offen offset:2048 sc1
ds_read_b64_tr_b16 a[88:89], v116 offset:24576
v_mfma_f32_16x16x32_bf16 v[92:95], a[116:119], v[212:215], v[92:95]
ds_read_b64_tr_b16 a[90:91], v116 offset:26624
v_mul_f32 v68, v68, v25
v_mfma_f32_16x16x32_bf16 v[92:95], a[120:123], v[228:231], v[92:95]
ds_read_b64_tr_b16 a[92:93], v116 offset:28672
v_mul_f32 v69, v69, v25
v_mfma_f32_16x16x32_bf16 v[92:95], a[124:127], v[244:247], v[92:95]
s_waitcnt lgkmcnt(8)
ds_read_b64_tr_b16 a[94:95], v116 offset:30720
v_add_u32 v116, 32768, v116
v_mfma_f32_16x16x32_bf16 v[32:35], a[64:67], v[128:131], 0
ds_read_b64_tr_b16 a[96:97], v117 offset:0
v_mul_f32 v70, v70, v25
v_mfma_f32_16x16x32_bf16 v[32:35], a[68:71], v[144:147], v[32:35]
ds_read_b64_tr_b16 a[98:99], v117 offset:2048
v_mul_f32 v71, v71, v25
v_mfma_f32_16x16x32_bf16 v[32:35], a[72:75], v[160:163], v[32:35]
s_waitcnt lgkmcnt(8)
ds_read_b64_tr_b16 a[100:101], v117 offset:4096
v_mul_f32 v76, v76, v25
v_mfma_f32_16x16x32_bf16 v[32:35], a[76:79], v[176:179], v[32:35]
ds_read_b64_tr_b16 a[102:103], v117 offset:6144
v_mul_f32 v77, v77, v25
v_mfma_f32_16x16x32_bf16 v[32:35], a[80:83], v[192:195], v[32:35]
s_waitcnt lgkmcnt(8)
ds_read_b64_tr_b16 a[104:105], v117 offset:8192
v_mul_f32 v78, v78, v25
v_mfma_f32_16x16x32_bf16 v[32:35], a[84:87], v[208:211], v[32:35]
s_waitcnt lgkmcnt(7)
ds_read_b64_tr_b16 a[106:107], v117 offset:10240
v_mul_f32 v79, v79, v25
v_mfma_f32_16x16x32_bf16 v[32:35], a[88:91], v[224:227], v[32:35]
s_waitcnt lgkmcnt(6)
ds_read_b64_tr_b16 a[108:109], v117 offset:12288
v_cvt_pk_bf16_f32 v68, v68, v69
v_mfma_f32_16x16x32_bf16 v[32:35], a[92:95], v[240:243], v[32:35]
ds_read_b64_tr_b16 a[110:111], v117 offset:14336
v_cvt_pk_bf16_f32 v69, v70, v71
v_mfma_f32_16x16x32_bf16 v[36:39], a[64:67], v[132:135], 0
ds_read_b64_tr_b16 a[112:113], v117 offset:16384
v_cvt_pk_bf16_f32 v70, v76, v77
v_mfma_f32_16x16x32_bf16 v[36:39], a[68:71], v[148:151], v[36:39]
ds_read_b64_tr_b16 a[114:115], v117 offset:18432
v_cvt_pk_bf16_f32 v71, v78, v79
v_mfma_f32_16x16x32_bf16 v[36:39], a[72:75], v[164:167], v[36:39]
buffer_store_dwordx4 v[68:71], v1, s[4:7], s12 offen offset:2048 sc1
ds_read_b64_tr_b16 a[116:117], v117 offset:20480
v_mfma_f32_16x16x32_bf16 v[36:39], a[76:79], v[180:183], v[36:39]
ds_read_b64_tr_b16 a[118:119], v117 offset:22528
v_mul_f32 v80, v80, v24
v_mfma_f32_16x16x32_bf16 v[36:39], a[80:83], v[196:199], v[36:39]
ds_read_b64_tr_b16 a[120:121], v117 offset:24576
v_mul_f32 v81, v81, v24
v_mfma_f32_16x16x32_bf16 v[36:39], a[84:87], v[212:215], v[36:39]
ds_read_b64_tr_b16 a[122:123], v117 offset:26624
v_mul_f32 v82, v82, v24
v_mfma_f32_16x16x32_bf16 v[36:39], a[88:91], v[228:231], v[36:39]
ds_read_b64_tr_b16 a[124:125], v117 offset:28672
v_mul_f32 v83, v83, v24
v_mfma_f32_16x16x32_bf16 v[36:39], a[92:95], v[244:247], v[36:39]
s_waitcnt lgkmcnt(8)
ds_read_b64_tr_b16 a[126:127], v117 offset:30720
v_add_u32 v117, 32768, v117
v_mfma_f32_16x16x32_bf16 v[40:43], a[96:99], v[128:131], 0
ds_read_b64_tr_b16 a[64:65], v118 offset:0
v_mul_f32 v88, v88, v24
v_mfma_f32_16x16x32_bf16 v[40:43], a[100:103], v[144:147], v[40:43]
ds_read_b64_tr_b16 a[66:67], v118 offset:2048
v_mul_f32 v89, v89, v24
v_mfma_f32_16x16x32_bf16 v[40:43], a[104:107], v[160:163], v[40:43]
s_waitcnt lgkmcnt(8)
ds_read_b64_tr_b16 a[68:69], v118 offset:4096
v_mul_f32 v90, v90, v24
v_mfma_f32_16x16x32_bf16 v[40:43], a[108:111], v[176:179], v[40:43]
ds_read_b64_tr_b16 a[70:71], v118 offset:6144
v_mul_f32 v91, v91, v24
v_mfma_f32_16x16x32_bf16 v[40:43], a[112:115], v[192:195], v[40:43]
s_waitcnt lgkmcnt(8)
ds_read_b64_tr_b16 a[72:73], v118 offset:8192
v_cvt_pk_bf16_f32 v80, v80, v81
v_mfma_f32_16x16x32_bf16 v[40:43], a[116:119], v[208:211], v[40:43]
s_waitcnt lgkmcnt(7)
ds_read_b64_tr_b16 a[74:75], v118 offset:10240
v_cvt_pk_bf16_f32 v81, v82, v83
v_mfma_f32_16x16x32_bf16 v[40:43], a[120:123], v[224:227], v[40:43]
s_waitcnt lgkmcnt(6)
ds_read_b64_tr_b16 a[76:77], v118 offset:12288
v_cvt_pk_bf16_f32 v82, v88, v89
v_mfma_f32_16x16x32_bf16 v[40:43], a[124:127], v[240:243], v[40:43]
ds_read_b64_tr_b16 a[78:79], v118 offset:14336
v_cvt_pk_bf16_f32 v83, v90, v91
v_mfma_f32_16x16x32_bf16 v[44:47], a[96:99], v[132:135], 0
buffer_store_dwordx4 v[80:83], v1, s[4:7], s8 offen offset:3072 sc1
ds_read_b64_tr_b16 a[80:81], v118 offset:16384
v_mfma_f32_16x16x32_bf16 v[44:47], a[100:103], v[148:151], v[44:47]
ds_read_b64_tr_b16 a[82:83], v118 offset:18432
v_mul_f32 v84, v84, v25
v_mfma_f32_16x16x32_bf16 v[44:47], a[104:107], v[164:167], v[44:47]
ds_read_b64_tr_b16 a[84:85], v118 offset:20480
v_mul_f32 v85, v85, v25
v_mfma_f32_16x16x32_bf16 v[44:47], a[108:111], v[180:183], v[44:47]
ds_read_b64_tr_b16 a[86:87], v118 offset:22528
v_mul_f32 v86, v86, v25
v_mfma_f32_16x16x32_bf16 v[44:47], a[112:115], v[196:199], v[44:47]
ds_read_b64_tr_b16 a[88:89], v118 offset:24576
v_mul_f32 v87, v87, v25
v_mfma_f32_16x16x32_bf16 v[44:47], a[116:119], v[212:215], v[44:47]
ds_read_b64_tr_b16 a[90:91], v118 offset:26624
v_mul_f32 v92, v92, v25
v_mfma_f32_16x16x32_bf16 v[44:47], a[120:123], v[228:231], v[44:47]
ds_read_b64_tr_b16 a[92:93], v118 offset:28672
v_mul_f32 v93, v93, v25
v_mfma_f32_16x16x32_bf16 v[44:47], a[124:127], v[244:247], v[44:47]
s_waitcnt lgkmcnt(8)
ds_read_b64_tr_b16 a[94:95], v118 offset:30720
v_add_u32 v118, 32768, v118
v_mfma_f32_16x16x32_bf16 v[48:51], a[64:67], v[128:131], 0
ds_read_b64_tr_b16 a[96:97], v119 offset:0
v_mul_f32 v94, v94, v25
v_mfma_f32_16x16x32_bf16 v[48:51], a[68:71], v[144:147], v[48:51]
ds_read_b64_tr_b16 a[98:99], v119 offset:2048
v_mul_f32 v95, v95, v25
v_mfma_f32_16x16x32_bf16 v[48:51], a[72:75], v[160:163], v[48:51]
s_waitcnt lgkmcnt(8)
ds_read_b64_tr_b16 a[100:101], v119 offset:4096
v_cvt_pk_bf16_f32 v84, v84, v85
v_mfma_f32_16x16x32_bf16 v[48:51], a[76:79], v[176:179], v[48:51]
ds_read_b64_tr_b16 a[102:103], v119 offset:6144
v_cvt_pk_bf16_f32 v85, v86, v87
v_mfma_f32_16x16x32_bf16 v[48:51], a[80:83], v[192:195], v[48:51]
s_waitcnt lgkmcnt(8)
ds_read_b64_tr_b16 a[104:105], v119 offset:8192
v_cvt_pk_bf16_f32 v86, v92, v93
v_mfma_f32_16x16x32_bf16 v[48:51], a[84:87], v[208:211], v[48:51]
s_waitcnt lgkmcnt(7)
ds_read_b64_tr_b16 a[106:107], v119 offset:10240
v_cvt_pk_bf16_f32 v87, v94, v95
v_mfma_f32_16x16x32_bf16 v[48:51], a[88:91], v[224:227], v[48:51]
s_waitcnt lgkmcnt(6)
buffer_store_dwordx4 v[84:87], v1, s[4:7], s12 offen offset:3072 sc1
ds_read_b64_tr_b16 a[108:109], v119 offset:12288
v_mfma_f32_16x16x32_bf16 v[48:51], a[92:95], v[240:243], v[48:51]
s_add_u32 s8, s8, 4096
s_add_u32 s12, s12, 4096
ds_read_b64_tr_b16 a[110:111], v119 offset:14336
v_mfma_f32_16x16x32_bf16 v[52:55], a[64:67], v[132:135], 0
ds_read_b64_tr_b16 a[112:113], v119 offset:16384
v_mul_f32 v32, v32, v24
v_mfma_f32_16x16x32_bf16 v[52:55], a[68:71], v[148:151], v[52:55]
ds_read_b64_tr_b16 a[114:115], v119 offset:18432
v_mul_f32 v33, v33, v24
v_mfma_f32_16x16x32_bf16 v[52:55], a[72:75], v[164:167], v[52:55]
ds_read_b64_tr_b16 a[116:117], v119 offset:20480
v_mul_f32 v34, v34, v24
v_mfma_f32_16x16x32_bf16 v[52:55], a[76:79], v[180:183], v[52:55]
ds_read_b64_tr_b16 a[118:119], v119 offset:22528
v_mul_f32 v35, v35, v24
v_mfma_f32_16x16x32_bf16 v[52:55], a[80:83], v[196:199], v[52:55]
ds_read_b64_tr_b16 a[120:121], v119 offset:24576
v_mul_f32 v40, v40, v24
v_mfma_f32_16x16x32_bf16 v[52:55], a[84:87], v[212:215], v[52:55]
ds_read_b64_tr_b16 a[122:123], v119 offset:26624
v_mul_f32 v41, v41, v24
v_mfma_f32_16x16x32_bf16 v[52:55], a[88:91], v[228:231], v[52:55]
ds_read_b64_tr_b16 a[124:125], v119 offset:28672
ds_read_b64_tr_b16 a[126:127], v119 offset:30720
v_mfma_f32_16x16x32_bf16 v[52:55], a[92:95], v[244:247], v[52:55]
s_waitcnt vmcnt(16) lgkmcnt(9)
s_barrier
v_add_u32 v119, 32768, v119
v_mfma_f32_16x16x32_bf16 v[56:59], a[96:99], v[128:131], 0
ds_read_b64_tr_b16 a[64:65], v116 offset:0
v_mul_f32 v42, v42, v24
v_mfma_f32_16x16x32_bf16 v[56:59], a[100:103], v[144:147], v[56:59]
ds_read_b64_tr_b16 a[66:67], v116 offset:2048
v_mul_f32 v43, v43, v24
v_mfma_f32_16x16x32_bf16 v[56:59], a[104:107], v[160:163], v[56:59]
s_waitcnt lgkmcnt(8)
ds_read_b64_tr_b16 a[68:69], v116 offset:4096
v_cvt_pk_bf16_f32 v32, v32, v33
v_mfma_f32_16x16x32_bf16 v[56:59], a[108:111], v[176:179], v[56:59]
ds_read_b64_tr_b16 a[70:71], v116 offset:6144
v_cvt_pk_bf16_f32 v33, v34, v35
v_mfma_f32_16x16x32_bf16 v[56:59], a[112:115], v[192:195], v[56:59]
s_waitcnt lgkmcnt(8)
ds_read_b64_tr_b16 a[72:73], v116 offset:8192
v_cvt_pk_bf16_f32 v34, v40, v41
v_mfma_f32_16x16x32_bf16 v[56:59], a[116:119], v[208:211], v[56:59]
s_waitcnt lgkmcnt(7)
ds_read_b64_tr_b16 a[74:75], v116 offset:10240
v_cvt_pk_bf16_f32 v35, v42, v43
v_mfma_f32_16x16x32_bf16 v[56:59], a[120:123], v[224:227], v[56:59]
s_waitcnt lgkmcnt(6)
buffer_store_dwordx4 v[32:35], v1, s[4:7], s8 offen offset:0 sc1
ds_read_b64_tr_b16 a[76:77], v116 offset:12288
v_mfma_f32_16x16x32_bf16 v[56:59], a[124:127], v[240:243], v[56:59]
ds_read_b64_tr_b16 a[78:79], v116 offset:14336
v_mul_f32 v36, v36, v25
v_mfma_f32_16x16x32_bf16 v[60:63], a[96:99], v[132:135], 0
ds_read_b64_tr_b16 a[80:81], v116 offset:16384
v_mul_f32 v37, v37, v25
v_mfma_f32_16x16x32_bf16 v[60:63], a[100:103], v[148:151], v[60:63]
ds_read_b64_tr_b16 a[82:83], v116 offset:18432
v_mul_f32 v38, v38, v25
v_mfma_f32_16x16x32_bf16 v[60:63], a[104:107], v[164:167], v[60:63]
ds_read_b64_tr_b16 a[84:85], v116 offset:20480
v_mul_f32 v39, v39, v25
v_mfma_f32_16x16x32_bf16 v[60:63], a[108:111], v[180:183], v[60:63]
ds_read_b64_tr_b16 a[86:87], v116 offset:22528
v_mul_f32 v44, v44, v25
v_mfma_f32_16x16x32_bf16 v[60:63], a[112:115], v[196:199], v[60:63]
ds_read_b64_tr_b16 a[88:89], v116 offset:24576
v_mul_f32 v45, v45, v25
v_mfma_f32_16x16x32_bf16 v[60:63], a[116:119], v[212:215], v[60:63]
ds_read_b64_tr_b16 a[90:91], v116 offset:26624
v_mul_f32 v46, v46, v25
v_mfma_f32_16x16x32_bf16 v[60:63], a[120:123], v[228:231], v[60:63]
ds_read_b64_tr_b16 a[92:93], v116 offset:28672
v_mul_f32 v47, v47, v25
v_mfma_f32_16x16x32_bf16 v[60:63], a[124:127], v[244:247], v[60:63]
s_waitcnt lgkmcnt(8)
ds_read_b64_tr_b16 a[94:95], v116 offset:30720
v_add_u32 v116, 65536, v116
v_mfma_f32_16x16x32_bf16 v[64:67], a[64:67], v[128:131], 0
ds_read_b64_tr_b16 a[96:97], v117 offset:0
v_cvt_pk_bf16_f32 v36, v36, v37
v_mfma_f32_16x16x32_bf16 v[64:67], a[68:71], v[144:147], v[64:67]
ds_read_b64_tr_b16 a[98:99], v117 offset:2048
v_cvt_pk_bf16_f32 v37, v38, v39
v_mfma_f32_16x16x32_bf16 v[64:67], a[72:75], v[160:163], v[64:67]
s_waitcnt lgkmcnt(8)
ds_read_b64_tr_b16 a[100:101], v117 offset:4096
v_cvt_pk_bf16_f32 v38, v44, v45
v_mfma_f32_16x16x32_bf16 v[64:67], a[76:79], v[176:179], v[64:67]
ds_read_b64_tr_b16 a[102:103], v117 offset:6144
v_cvt_pk_bf16_f32 v39, v46, v47
v_mfma_f32_16x16x32_bf16 v[64:67], a[80:83], v[192:195], v[64:67]
s_waitcnt lgkmcnt(8)
buffer_store_dwordx4 v[36:39], v1, s[4:7], s12 offen offset:0 sc1
ds_read_b64_tr_b16 a[104:105], v117 offset:8192
v_mfma_f32_16x16x32_bf16 v[64:67], a[84:87], v[208:211], v[64:67]
s_waitcnt lgkmcnt(7)
ds_read_b64_tr_b16 a[106:107], v117 offset:10240
v_mul_f32 v48, v48, v24
v_mfma_f32_16x16x32_bf16 v[64:67], a[88:91], v[224:227], v[64:67]
s_waitcnt lgkmcnt(6)
ds_read_b64_tr_b16 a[108:109], v117 offset:12288
v_mul_f32 v49, v49, v24
v_mfma_f32_16x16x32_bf16 v[64:67], a[92:95], v[240:243], v[64:67]
ds_read_b64_tr_b16 a[110:111], v117 offset:14336
v_mul_f32 v50, v50, v24
v_mfma_f32_16x16x32_bf16 v[68:71], a[64:67], v[132:135], 0
ds_read_b64_tr_b16 a[112:113], v117 offset:16384
v_mul_f32 v51, v51, v24
v_mfma_f32_16x16x32_bf16 v[68:71], a[68:71], v[148:151], v[68:71]
ds_read_b64_tr_b16 a[114:115], v117 offset:18432
v_mul_f32 v56, v56, v24
v_mfma_f32_16x16x32_bf16 v[68:71], a[72:75], v[164:167], v[68:71]
ds_read_b64_tr_b16 a[116:117], v117 offset:20480
v_mul_f32 v57, v57, v24
v_mfma_f32_16x16x32_bf16 v[68:71], a[76:79], v[180:183], v[68:71]
ds_read_b64_tr_b16 a[118:119], v117 offset:22528
v_mul_f32 v58, v58, v24
v_mfma_f32_16x16x32_bf16 v[68:71], a[80:83], v[196:199], v[68:71]
ds_read_b64_tr_b16 a[120:121], v117 offset:24576
v_mul_f32 v59, v59, v24
v_mfma_f32_16x16x32_bf16 v[68:71], a[84:87], v[212:215], v[68:71]
ds_read_b64_tr_b16 a[122:123], v117 offset:26624
v_cvt_pk_bf16_f32 v48, v48, v49
v_mfma_f32_16x16x32_bf16 v[68:71], a[88:91], v[228:231], v[68:71]
ds_read_b64_tr_b16 a[124:125], v117 offset:28672
v_cvt_pk_bf16_f32 v49, v50, v51
v_mfma_f32_16x16x32_bf16 v[68:71], a[92:95], v[244:247], v[68:71]
s_waitcnt lgkmcnt(8)
ds_read_b64_tr_b16 a[126:127], v117 offset:30720
v_add_u32 v117, 65536, v117
v_mfma_f32_16x16x32_bf16 v[72:75], a[96:99], v[128:131], 0
ds_read_b64_tr_b16 a[64:65], v118 offset:0
v_cvt_pk_bf16_f32 v50, v56, v57
v_mfma_f32_16x16x32_bf16 v[72:75], a[100:103], v[144:147], v[72:75]
ds_read_b64_tr_b16 a[66:67], v118 offset:2048
v_cvt_pk_bf16_f32 v51, v58, v59
v_mfma_f32_16x16x32_bf16 v[72:75], a[104:107], v[160:163], v[72:75]
s_waitcnt lgkmcnt(8)
buffer_store_dwordx4 v[48:51], v1, s[4:7], s8 offen offset:1024 sc1
ds_read_b64_tr_b16 a[68:69], v118 offset:4096
v_mfma_f32_16x16x32_bf16 v[72:75], a[108:111], v[176:179], v[72:75]
ds_read_b64_tr_b16 a[70:71], v118 offset:6144
v_mul_f32 v52, v52, v25
v_mfma_f32_16x16x32_bf16 v[72:75], a[112:115], v[192:195], v[72:75]
s_waitcnt lgkmcnt(8)
ds_read_b64_tr_b16 a[72:73], v118 offset:8192
v_mul_f32 v53, v53, v25
v_mfma_f32_16x16x32_bf16 v[72:75], a[116:119], v[208:211], v[72:75]
s_waitcnt lgkmcnt(7)
ds_read_b64_tr_b16 a[74:75], v118 offset:10240
v_mul_f32 v54, v54, v25
v_mfma_f32_16x16x32_bf16 v[72:75], a[120:123], v[224:227], v[72:75]
s_waitcnt lgkmcnt(6)
ds_read_b64_tr_b16 a[76:77], v118 offset:12288
v_mul_f32 v55, v55, v25
v_mfma_f32_16x16x32_bf16 v[72:75], a[124:127], v[240:243], v[72:75]
ds_read_b64_tr_b16 a[78:79], v118 offset:14336
v_mul_f32 v60, v60, v25
v_mfma_f32_16x16x32_bf16 v[76:79], a[96:99], v[132:135], 0
ds_read_b64_tr_b16 a[80:81], v118 offset:16384
v_mul_f32 v61, v61, v25
v_mfma_f32_16x16x32_bf16 v[76:79], a[100:103], v[148:151], v[76:79]
ds_read_b64_tr_b16 a[82:83], v118 offset:18432
v_mul_f32 v62, v62, v25
v_mfma_f32_16x16x32_bf16 v[76:79], a[104:107], v[164:167], v[76:79]
ds_read_b64_tr_b16 a[84:85], v118 offset:20480
v_mul_f32 v63, v63, v25
v_mfma_f32_16x16x32_bf16 v[76:79], a[108:111], v[180:183], v[76:79]
ds_read_b64_tr_b16 a[86:87], v118 offset:22528
v_cvt_pk_bf16_f32 v52, v52, v53
v_mfma_f32_16x16x32_bf16 v[76:79], a[112:115], v[196:199], v[76:79]
ds_read_b64_tr_b16 a[88:89], v118 offset:24576
v_cvt_pk_bf16_f32 v53, v54, v55
v_mfma_f32_16x16x32_bf16 v[76:79], a[116:119], v[212:215], v[76:79]
ds_read_b64_tr_b16 a[90:91], v118 offset:26624
v_cvt_pk_bf16_f32 v54, v60, v61
v_mfma_f32_16x16x32_bf16 v[76:79], a[120:123], v[228:231], v[76:79]
ds_read_b64_tr_b16 a[92:93], v118 offset:28672
v_cvt_pk_bf16_f32 v55, v62, v63
v_mfma_f32_16x16x32_bf16 v[76:79], a[124:127], v[244:247], v[76:79]
s_waitcnt lgkmcnt(8)
ds_read_b64_tr_b16 a[94:95], v118 offset:30720
v_add_u32 v118, 65536, v118
v_mfma_f32_16x16x32_bf16 v[80:83], a[64:67], v[128:131], 0
buffer_store_dwordx4 v[52:55], v1, s[4:7], s12 offen offset:1024 sc1
ds_read_b64_tr_b16 a[96:97], v119 offset:0
v_mfma_f32_16x16x32_bf16 v[80:83], a[68:71], v[144:147], v[80:83]
ds_read_b64_tr_b16 a[98:99], v119 offset:2048
v_mul_u32_u24 v21, 1792, v19
v_mfma_f32_16x16x32_bf16 v[80:83], a[72:75], v[160:163], v[80:83]
s_waitcnt lgkmcnt(8)
ds_read_b64_tr_b16 a[100:101], v119 offset:4096
v_mul_f32 v64, v64, v24
v_mfma_f32_16x16x32_bf16 v[80:83], a[76:79], v[176:179], v[80:83]
ds_read_b64_tr_b16 a[102:103], v119 offset:6144
v_mul_f32 v65, v65, v24
v_mfma_f32_16x16x32_bf16 v[80:83], a[80:83], v[192:195], v[80:83]
s_waitcnt lgkmcnt(8)
ds_read_b64_tr_b16 a[104:105], v119 offset:8192
v_mul_f32 v66, v66, v24
v_mfma_f32_16x16x32_bf16 v[80:83], a[84:87], v[208:211], v[80:83]
s_waitcnt lgkmcnt(7)
ds_read_b64_tr_b16 a[106:107], v119 offset:10240
v_mul_f32 v67, v67, v24
v_mfma_f32_16x16x32_bf16 v[80:83], a[88:91], v[224:227], v[80:83]
s_waitcnt lgkmcnt(6)
ds_read_b64_tr_b16 a[108:109], v119 offset:12288
v_mul_f32 v72, v72, v24
v_mfma_f32_16x16x32_bf16 v[80:83], a[92:95], v[240:243], v[80:83]
ds_read_b64_tr_b16 a[110:111], v119 offset:14336
v_mul_f32 v73, v73, v24
v_mfma_f32_16x16x32_bf16 v[84:87], a[64:67], v[132:135], 0
ds_read_b64_tr_b16 a[112:113], v119 offset:16384
v_mul_f32 v74, v74, v24
v_mfma_f32_16x16x32_bf16 v[84:87], a[68:71], v[148:151], v[84:87]
ds_read_b64_tr_b16 a[114:115], v119 offset:18432
v_mul_f32 v75, v75, v24
v_mfma_f32_16x16x32_bf16 v[84:87], a[72:75], v[164:167], v[84:87]
ds_read_b64_tr_b16 a[116:117], v119 offset:20480
v_cvt_pk_bf16_f32 v64, v64, v65
v_mfma_f32_16x16x32_bf16 v[84:87], a[76:79], v[180:183], v[84:87]
ds_read_b64_tr_b16 a[118:119], v119 offset:22528
v_cvt_pk_bf16_f32 v65, v66, v67
v_mfma_f32_16x16x32_bf16 v[84:87], a[80:83], v[196:199], v[84:87]
ds_read_b64_tr_b16 a[120:121], v119 offset:24576
v_cvt_pk_bf16_f32 v66, v72, v73
v_mfma_f32_16x16x32_bf16 v[84:87], a[84:87], v[212:215], v[84:87]
ds_read_b64_tr_b16 a[122:123], v119 offset:26624
v_cvt_pk_bf16_f32 v67, v74, v75
v_mfma_f32_16x16x32_bf16 v[84:87], a[88:91], v[228:231], v[84:87]
ds_read_b64_tr_b16 a[124:125], v119 offset:28672
ds_read_b64_tr_b16 a[126:127], v119 offset:30720
v_mfma_f32_16x16x32_bf16 v[84:87], a[92:95], v[244:247], v[84:87]
s_waitcnt vmcnt(6) lgkmcnt(9)
s_barrier
v_add_u32 v119, 65536, v119
v_mfma_f32_16x16x32_bf16 v[88:91], a[96:99], v[128:131], 0
buffer_store_dwordx4 v[64:67], v1, s[4:7], s8 offen offset:2048 sc1
ds_read_b64_tr_b16 a[64:65], v116 offset:0
v_mfma_f32_16x16x32_bf16 v[88:91], a[100:103], v[144:147], v[88:91]
buffer_store_dword v6, v5, s[4:7], s34 offen sc1
ds_read_b64_tr_b16 a[66:67], v116 offset:2048
v_mfma_f32_16x16x32_bf16 v[88:91], a[104:107], v[160:163], v[88:91]
s_waitcnt lgkmcnt(8)
ds_read_b64_tr_b16 a[68:69], v116 offset:4096
v_mul_f32 v68, v68, v25
v_mfma_f32_16x16x32_bf16 v[88:91], a[108:111], v[176:179], v[88:91]
PAD_16:
s_cbranch_execz M_tret
ds_read_b64_tr_b16 a[70:71], v116 offset:6144
v_mul_f32 v69, v69, v25
v_mfma_f32_16x16x32_bf16 v[88:91], a[112:115], v[192:195], v[88:91]
s_waitcnt lgkmcnt(8)
ds_read_b64_tr_b16 a[72:73], v116 offset:8192
v_mul_f32 v70, v70, v25
v_mfma_f32_16x16x32_bf16 v[88:91], a[116:119], v[208:211], v[88:91]
s_waitcnt lgkmcnt(7)
ds_read_b64_tr_b16 a[74:75], v116 offset:10240
v_mul_f32 v71, v71, v25
v_mfma_f32_16x16x32_bf16 v[88:91], a[120:123], v[224:227], v[88:91]
s_waitcnt lgkmcnt(6)
ds_read_b64_tr_b16 a[76:77], v116 offset:12288
v_mul_f32 v76, v76, v25
v_mfma_f32_16x16x32_bf16 v[88:91], a[124:127], v[240:243], v[88:91]
ds_read_b64_tr_b16 a[78:79], v116 offset:14336
v_mul_f32 v77, v77, v25
v_mfma_f32_16x16x32_bf16 v[92:95], a[96:99], v[132:135], 0
ds_read_b64_tr_b16 a[80:81], v116 offset:16384
v_mul_f32 v78, v78, v25
v_mfma_f32_16x16x32_bf16 v[92:95], a[100:103], v[148:151], v[92:95]
ds_read_b64_tr_b16 a[82:83], v116 offset:18432
v_mul_f32 v79, v79, v25
v_mfma_f32_16x16x32_bf16 v[92:95], a[104:107], v[164:167], v[92:95]
ds_read_b64_tr_b16 a[84:85], v116 offset:20480
v_cvt_pk_bf16_f32 v68, v68, v69
v_mfma_f32_16x16x32_bf16 v[92:95], a[108:111], v[180:183], v[92:95]
ds_read_b64_tr_b16 a[86:87], v116 offset:22528
v_cvt_pk_bf16_f32 v69, v70, v71
v_mfma_f32_16x16x32_bf16 v[92:95], a[112:115], v[196:199], v[92:95]
ds_read_b64_tr_b16 a[88:89], v116 offset:24576
v_cvt_pk_bf16_f32 v70, v76, v77
v_mfma_f32_16x16x32_bf16 v[92:95], a[116:119], v[212:215], v[92:95]
ds_read_b64_tr_b16 a[90:91], v116 offset:26624
v_cvt_pk_bf16_f32 v71, v78, v79
v_mfma_f32_16x16x32_bf16 v[92:95], a[120:123], v[228:231], v[92:95]
buffer_store_dwordx4 v[68:71], v1, s[4:7], s12 offen offset:2048 sc1
ds_read_b64_tr_b16 a[92:93], v116 offset:28672
v_mfma_f32_16x16x32_bf16 v[92:95], a[124:127], v[244:247], v[92:95]
s_waitcnt lgkmcnt(8)
ds_read_b64_tr_b16 a[94:95], v116 offset:30720
v_mfma_f32_16x16x32_bf16 v[32:35], a[64:67], v[128:131], 0
ds_read_b64_tr_b16 a[96:97], v117 offset:0
v_mul_f32 v80, v80, v24
v_mfma_f32_16x16x32_bf16 v[32:35], a[68:71], v[144:147], v[32:35]
ds_read_b64_tr_b16 a[98:99], v117 offset:2048
v_mul_f32 v81, v81, v24
v_mfma_f32_16x16x32_bf16 v[32:35], a[72:75], v[160:163], v[32:35]
s_waitcnt lgkmcnt(8)
ds_read_b64_tr_b16 a[100:101], v117 offset:4096
v_mul_f32 v82, v82, v24
v_mfma_f32_16x16x32_bf16 v[32:35], a[76:79], v[176:179], v[32:35]
ds_read_b64_tr_b16 a[102:103], v117 offset:6144
v_mul_f32 v83, v83, v24
v_mfma_f32_16x16x32_bf16 v[32:35], a[80:83], v[192:195], v[32:35]
s_waitcnt lgkmcnt(8)
ds_read_b64_tr_b16 a[104:105], v117 offset:8192
v_mul_f32 v88, v88, v24
v_mfma_f32_16x16x32_bf16 v[32:35], a[84:87], v[208:211], v[32:35]
s_waitcnt lgkmcnt(7)
ds_read_b64_tr_b16 a[106:107], v117 offset:10240
v_mul_f32 v89, v89, v24
v_mfma_f32_16x16x32_bf16 v[32:35], a[88:91], v[224:227], v[32:35]
s_waitcnt lgkmcnt(6)
ds_read_b64_tr_b16 a[108:109], v117 offset:12288
v_mul_f32 v90, v90, v24
v_mfma_f32_16x16x32_bf16 v[32:35], a[92:95], v[240:243], v[32:35]
ds_read_b64_tr_b16 a[110:111], v117 offset:14336
v_mul_f32 v91, v91, v24
v_mfma_f32_16x16x32_bf16 v[36:39], a[64:67], v[132:135], 0
ds_read_b64_tr_b16 a[112:113], v117 offset:16384
v_cvt_pk_bf16_f32 v80, v80, v81
v_mfma_f32_16x16x32_bf16 v[36:39], a[68:71], v[148:151], v[36:39]
ds_read_b64_tr_b16 a[114:115], v117 offset:18432
v_cvt_pk_bf16_f32 v81, v82, v83
v_mfma_f32_16x16x32_bf16 v[36:39], a[72:75], v[164:167], v[36:39]
ds_read_b64_tr_b16 a[116:117], v117 offset:20480
v_cvt_pk_bf16_f32 v82, v88, v89
v_mfma_f32_16x16x32_bf16 v[36:39], a[76:79], v[180:183], v[36:39]
ds_read_b64_tr_b16 a[118:119], v117 offset:22528
v_cvt_pk_bf16_f32 v83, v90, v91
v_mfma_f32_16x16x32_bf16 v[36:39], a[80:83], v[196:199], v[36:39]
buffer_store_dwordx4 v[80:83], v1, s[4:7], s8 offen offset:3072 sc1
ds_read_b64_tr_b16 a[120:121], v117 offset:24576
v_mfma_f32_16x16x32_bf16 v[36:39], a[84:87], v[212:215], v[36:39]
ds_read_b64_tr_b16 a[122:123], v117 offset:26624
v_mul_f32 v84, v84, v25
v_mfma_f32_16x16x32_bf16 v[36:39], a[88:91], v[228:231], v[36:39]
ds_read_b64_tr_b16 a[124:125], v117 offset:28672
v_mul_f32 v85, v85, v25
v_mfma_f32_16x16x32_bf16 v[36:39], a[92:95], v[244:247], v[36:39]
s_waitcnt lgkmcnt(8)
ds_read_b64_tr_b16 a[126:127], v117 offset:30720
v_mul_f32 v86, v86, v25
v_mfma_f32_16x16x32_bf16 v[40:43], a[96:99], v[128:131], 0
ds_read_b64_tr_b16 a[64:65], v118 offset:0
v_mul_f32 v87, v87, v25
v_mfma_f32_16x16x32_bf16 v[40:43], a[100:103], v[144:147], v[40:43]
ds_read_b64_tr_b16 a[66:67], v118 offset:2048
v_mul_f32 v92, v92, v25
v_mfma_f32_16x16x32_bf16 v[40:43], a[104:107], v[160:163], v[40:43]
s_waitcnt lgkmcnt(8)
ds_read_b64_tr_b16 a[68:69], v118 offset:4096
v_mul_f32 v93, v93, v25
v_mfma_f32_16x16x32_bf16 v[40:43], a[108:111], v[176:179], v[40:43]
ds_read_b64_tr_b16 a[70:71], v118 offset:6144
v_mul_f32 v94, v94, v25
v_mfma_f32_16x16x32_bf16 v[40:43], a[112:115], v[192:195], v[40:43]
s_waitcnt lgkmcnt(8)
ds_read_b64_tr_b16 a[72:73], v118 offset:8192
v_mul_f32 v95, v95, v25
v_mfma_f32_16x16x32_bf16 v[40:43], a[116:119], v[208:211], v[40:43]
s_waitcnt lgkmcnt(7)
ds_read_b64_tr_b16 a[74:75], v118 offset:10240
v_cvt_pk_bf16_f32 v84, v84, v85
v_mfma_f32_16x16x32_bf16 v[40:43], a[120:123], v[224:227], v[40:43]
s_waitcnt lgkmcnt(6)
ds_read_b64_tr_b16 a[76:77], v118 offset:12288
v_cvt_pk_bf16_f32 v85, v86, v87
v_mfma_f32_16x16x32_bf16 v[40:43], a[124:127], v[240:243], v[40:43]
ds_read_b64_tr_b16 a[78:79], v118 offset:14336
v_cvt_pk_bf16_f32 v86, v92, v93
v_mfma_f32_16x16x32_bf16 v[44:47], a[96:99], v[132:135], 0
ds_read_b64_tr_b16 a[80:81], v118 offset:16384
v_cvt_pk_bf16_f32 v87, v94, v95
v_mfma_f32_16x16x32_bf16 v[44:47], a[100:103], v[148:151], v[44:47]
buffer_store_dwordx4 v[84:87], v1, s[4:7], s12 offen offset:3072 sc1
ds_read_b64_tr_b16 a[82:83], v118 offset:18432
v_mfma_f32_16x16x32_bf16 v[44:47], a[104:107], v[164:167], v[44:47]
s_add_u32 s8, s8, 4096
s_add_u32 s12, s12, 4096
ds_read_b64_tr_b16 a[84:85], v118 offset:20480
v_mfma_f32_16x16x32_bf16 v[44:47], a[108:111], v[180:183], v[44:47]
ds_read_b64_tr_b16 a[86:87], v118 offset:22528
v_lshlrev_b32 v19, 2, v19
v_mfma_f32_16x16x32_bf16 v[44:47], a[112:115], v[196:199], v[44:47]
ds_read_b64_tr_b16 a[88:89], v118 offset:24576
v_mul_f32 v32, v32, v24
v_mfma_f32_16x16x32_bf16 v[44:47], a[116:119], v[212:215], v[44:47]
ds_read_b64_tr_b16 a[90:91], v118 offset:26624
v_mul_f32 v33, v33, v24
v_mfma_f32_16x16x32_bf16 v[44:47], a[120:123], v[228:231], v[44:47]
ds_read_b64_tr_b16 a[92:93], v118 offset:28672
v_mul_f32 v34, v34, v24
v_mfma_f32_16x16x32_bf16 v[44:47], a[124:127], v[244:247], v[44:47]
s_waitcnt lgkmcnt(8)
ds_read_b64_tr_b16 a[94:95], v118 offset:30720
v_mul_f32 v35, v35, v24
v_mfma_f32_16x16x32_bf16 v[48:51], a[64:67], v[128:131], 0
ds_read_b64_tr_b16 a[96:97], v119 offset:0
v_mul_f32 v40, v40, v24
v_mfma_f32_16x16x32_bf16 v[48:51], a[68:71], v[144:147], v[48:51]
ds_read_b64_tr_b16 a[98:99], v119 offset:2048
v_mul_f32 v41, v41, v24
v_mfma_f32_16x16x32_bf16 v[48:51], a[72:75], v[160:163], v[48:51]
s_waitcnt lgkmcnt(8)
ds_read_b64_tr_b16 a[100:101], v119 offset:4096
v_mul_f32 v42, v42, v24
v_mfma_f32_16x16x32_bf16 v[48:51], a[76:79], v[176:179], v[48:51]
ds_read_b64_tr_b16 a[102:103], v119 offset:6144
v_mul_f32 v43, v43, v24
v_mfma_f32_16x16x32_bf16 v[48:51], a[80:83], v[192:195], v[48:51]
s_waitcnt lgkmcnt(8)
ds_read_b64_tr_b16 a[104:105], v119 offset:8192
v_cvt_pk_bf16_f32 v32, v32, v33
v_mfma_f32_16x16x32_bf16 v[48:51], a[84:87], v[208:211], v[48:51]
s_waitcnt lgkmcnt(7)
ds_read_b64_tr_b16 a[106:107], v119 offset:10240
v_cvt_pk_bf16_f32 v33, v34, v35
v_mfma_f32_16x16x32_bf16 v[48:51], a[88:91], v[224:227], v[48:51]
s_waitcnt lgkmcnt(6)
ds_read_b64_tr_b16 a[108:109], v119 offset:12288
v_cvt_pk_bf16_f32 v34, v40, v41
v_mfma_f32_16x16x32_bf16 v[48:51], a[92:95], v[240:243], v[48:51]
ds_read_b64_tr_b16 a[110:111], v119 offset:14336
v_cvt_pk_bf16_f32 v35, v42, v43
v_mfma_f32_16x16x32_bf16 v[52:55], a[64:67], v[132:135], 0
buffer_store_dwordx4 v[32:35], v1, s[4:7], s8 offen offset:0 sc1
ds_read_b64_tr_b16 a[112:113], v119 offset:16384
v_mfma_f32_16x16x32_bf16 v[52:55], a[68:71], v[148:151], v[52:55]
ds_read_b64_tr_b16 a[114:115], v119 offset:18432
v_mul_f32 v36, v36, v25
v_mfma_f32_16x16x32_bf16 v[52:55], a[72:75], v[164:167], v[52:55]
ds_read_b64_tr_b16 a[116:117], v119 offset:20480
v_mul_f32 v37, v37, v25
v_mfma_f32_16x16x32_bf16 v[52:55], a[76:79], v[180:183], v[52:55]
ds_read_b64_tr_b16 a[118:119], v119 offset:22528
v_mul_f32 v38, v38, v25
v_mfma_f32_16x16x32_bf16 v[52:55], a[80:83], v[196:199], v[52:55]
ds_read_b64_tr_b16 a[120:121], v119 offset:24576
v_mul_f32 v39, v39, v25
v_mfma_f32_16x16x32_bf16 v[52:55], a[84:87], v[212:215], v[52:55]
ds_read_b64_tr_b16 a[122:123], v119 offset:26624
v_mul_f32 v44, v44, v25
v_mfma_f32_16x16x32_bf16 v[52:55], a[88:91], v[228:231], v[52:55]
ds_read_b64_tr_b16 a[124:125], v119 offset:28672
ds_read_b64_tr_b16 a[126:127], v119 offset:30720
v_mfma_f32_16x16x32_bf16 v[52:55], a[92:95], v[244:247], v[52:55]
s_waitcnt lgkmcnt(9)
v_mul_f32 v45, v45, v25
v_mul_f32 v46, v46, v25
v_mfma_f32_16x16x32_bf16 v[56:59], a[96:99], v[128:131], 0
v_mul_f32 v47, v47, v25
v_cvt_pk_bf16_f32 v36, v36, v37
v_mfma_f32_16x16x32_bf16 v[56:59], a[100:103], v[144:147], v[56:59]
v_cvt_pk_bf16_f32 v37, v38, v39
v_cvt_pk_bf16_f32 v38, v44, v45
v_mfma_f32_16x16x32_bf16 v[56:59], a[104:107], v[160:163], v[56:59]
s_waitcnt lgkmcnt(6)
v_cvt_pk_bf16_f32 v39, v46, v47
v_lshrrev_b32 v22, 4, v20
v_mfma_f32_16x16x32_bf16 v[56:59], a[108:111], v[176:179], v[56:59]
buffer_store_dwordx4 v[36:39], v1, s[4:7], s12 offen offset:0 sc1
v_mfma_f32_16x16x32_bf16 v[56:59], a[112:115], v[192:195], v[56:59]
s_waitcnt lgkmcnt(4)
v_lshl_add_u32 v21, v22, 3, v21
v_mfma_f32_16x16x32_bf16 v[56:59], a[116:119], v[208:211], v[56:59]
s_waitcnt lgkmcnt(2)
v_mfma_f32_16x16x32_bf16 v[56:59], a[120:123], v[224:227], v[56:59]
s_waitcnt lgkmcnt(0)
v_mfma_f32_16x16x32_bf16 v[56:59], a[124:127], v[240:243], v[56:59]
v_mfma_f32_16x16x32_bf16 v[60:63], a[96:99], v[132:135], 0
v_mfma_f32_16x16x32_bf16 v[60:63], a[100:103], v[148:151], v[60:63]
v_mfma_f32_16x16x32_bf16 v[60:63], a[104:107], v[164:167], v[60:63]
v_mfma_f32_16x16x32_bf16 v[60:63], a[108:111], v[180:183], v[60:63]
v_mfma_f32_16x16x32_bf16 v[60:63], a[112:115], v[196:199], v[60:63]
buffer_load_dword v18, v19, s[4:7], s33 offen offset:0 sc1
v_mfma_f32_16x16x32_bf16 v[60:63], a[116:119], v[212:215], v[60:63]
v_mfma_f32_16x16x32_bf16 v[60:63], a[120:123], v[228:231], v[60:63]
v_mfma_f32_16x16x32_bf16 v[60:63], a[124:127], v[244:247], v[60:63]
v_mul_f32 v48, v48, v24
v_mul_f32 v49, v49, v24
v_mul_f32 v50, v50, v24
v_mul_f32 v51, v51, v24
v_mul_f32 v56, v56, v24
v_mul_f32 v57, v57, v24
v_mul_f32 v58, v58, v24
v_mul_f32 v59, v59, v24
v_cvt_pk_bf16_f32 v48, v48, v49
v_cvt_pk_bf16_f32 v49, v50, v51
v_cvt_pk_bf16_f32 v50, v56, v57
v_cvt_pk_bf16_f32 v51, v58, v59
buffer_store_dwordx4 v[48:51], v1, s[4:7], s8 offen offset:1024 sc1
v_mul_f32 v52, v52, v25
v_mul_f32 v53, v53, v25
v_mul_f32 v54, v54, v25
v_mul_f32 v55, v55, v25
v_mul_f32 v60, v60, v25
v_mul_f32 v61, v61, v25
v_mul_f32 v62, v62, v25
v_mul_f32 v63, v63, v25
v_cvt_pk_bf16_f32 v52, v52, v53
v_cvt_pk_bf16_f32 v53, v54, v55
v_cvt_pk_bf16_f32 v54, v60, v61
v_cvt_pk_bf16_f32 v55, v62, v63
buffer_store_dwordx4 v[52:55], v1, s[4:7], s12 offen offset:1024 sc1
s_and_b32 s22, s2, 224
s_cmp_eq_u32 s22, 224
s_cbranch_scc1 M_final
s_waitcnt vmcnt(0)
s_barrier
buffer_store_dword v6, v5, s[4:7], s35 offen sc1
s_bitcmp1_b32 s79, 4
s_cbranch_scc1 M_rA
v_cmp_gt_u32 vcc, 1, v18
s_cbranch_vccnz M_rslow
M_rjoin:
buffer_load_dwordx4 v[128:131], v1, s[4:7], s26 offen sc1
s_add_u32 s26, s26, 14336
buffer_load_dwordx4 v[132:135], v1, s[4:7], s26 offen sc1
s_add_u32 s26, s26, 14336
buffer_load_dwordx4 v[136:139], v1, s[4:7], s26 offen sc1
s_add_u32 s26, s26, 14336
buffer_load_dwordx4 v[140:143], v1, s[4:7], s26 offen sc1
s_add_u32 s26, s26, 14336
buffer_load_dwordx4 v[144:147], v1, s[4:7], s26 offen sc1
s_add_u32 s26, s26, 14336
buffer_load_dwordx4 v[148:151], v1, s[4:7], s26 offen sc1
s_add_u32 s26, s26, 14336
buffer_load_dwordx4 v[152:155], v1, s[4:7], s26 offen sc1
s_add_u32 s26, s26, 14336
buffer_load_dwordx4 v[156:159], v1, s[4:7], s26 offen sc1
s_add_u32 s26, s26, 14336
buffer_load_dwordx4 v[160:163], v1, s[4:7], s26 offen sc1
s_add_u32 s26, s26, 14336
buffer_load_dwordx4 v[164:167], v1, s[4:7], s26 offen sc1
s_add_u32 s26, s26, 14336
buffer_load_dwordx4 v[168:171], v1, s[4:7], s26 offen sc1
s_add_u32 s26, s26, 14336
buffer_load_dwordx4 v[172:175], v1, s[4:7], s26 offen sc1
s_add_u32 s26, s26, 14336
buffer_load_dwordx4 v[176:179], v1, s[4:7], s26 offen sc1
s_add_u32 s26, s26, 14336
buffer_load_dwordx4 v[180:183], v1, s[4:7], s26 offen sc1
s_add_u32 s26, s26, 14336
buffer_load_dwordx4 v[184:187], v1, s[4:7], s26 offen sc1
s_add_u32 s26, s26, 14336
buffer_load_dwordx4 v[188:191], v1, s[4:7], s26 offen sc1
Lp_9201:
buffer_load_dword v18, v19, s[4:7], s33 offen offset:2048 sc1
s_waitcnt vmcnt(0)
v_cmp_gt_u32 vcc, 1, v18
s_cbranch_vccz Lpd_9202
s_sleep 8
s_sub_u32 s101, s101, 1
s_cbranch_scc0 Lp_9201
s_mov_b32 s101, 0
Lpd_9202:
s_sub_u32 s26, s26, 207872
buffer_load_dwordx4 v[192:195], v1, s[4:7], s26 offen sc1
s_add_u32 s26, s26, 14336
buffer_load_dwordx4 v[196:199], v1, s[4:7], s26 offen sc1
s_add_u32 s26, s26, 14336
buffer_load_dwordx4 v[200:203], v1, s[4:7], s26 offen sc1
s_add_u32 s26, s26, 14336
buffer_load_dwordx4 v[204:207], v1, s[4:7], s26 offen sc1
s_add_u32 s26, s26, 14336
buffer_load_dwordx4 v[208:211], v1, s[4:7], s26 offen sc1
s_add_u32 s26, s26, 14336
buffer_load_dwordx4 v[212:215], v1, s[4:7], s26 offen sc1
s_add_u32 s26, s26, 14336
buffer_load_dwordx4 v[216:219], v1, s[4:7], s26 offen sc1
s_add_u32 s26, s26, 14336
buffer_load_dwordx4 v[220:223], v1, s[4:7], s26 offen sc1
s_add_u32 s26, s26, 14336
buffer_load_dwordx4 v[224:227], v1, s[4:7], s26 offen sc1
s_add_u32 s26, s26, 14336
buffer_load_dwordx4 v[228:231], v1, s[4:7], s26 offen sc1
s_add_u32 s26, s26, 14336
buffer_load_dwordx4 v[232:235], v1, s[4:7], s26 offen sc1
s_add_u32 s26, s26, 14336
buffer_load_dwordx4 v[236:239], v1, s[4:7], s26 offen sc1
s_add_u32 s26, s26, 14336
buffer_load_dwordx4 v[240:243], v1, s[4:7], s26 offen sc1
s_add_u32 s26, s26, 14336
buffer_load_dwordx4 v[244:247], v1, s[4:7], s26 offen sc1
s_add_u32 s26, s26, 14336
buffer_load_dwordx4 v[248:251], v1, s[4:7], s26 offen sc1
s_add_u32 s26, s26, 14336
buffer_load_dwordx4 v[252:255], v1, s[4:7], s26 offen sc1
v_lshlrev_b32 v96, 16, v128
v_and_b32 v97, 0xffff0000, v128
v_lshlrev_b32 v98, 16, v129
v_and_b32 v99, 0xffff0000, v129
v_lshlrev_b32 v100, 16, v130
v_and_b32 v101, 0xffff0000, v130
v_lshlrev_b32 v102, 16, v131
v_and_b32 v103, 0xffff0000, v131
v_lshlrev_b32 v10, 16, v132
v_and_b32 v11, 0xffff0000, v132
v_lshlrev_b32 v12, 16, v133
v_and_b32 v13, 0xffff0000, v133
v_lshlrev_b32 v14, 16, v134
v_and_b32 v15, 0xffff0000, v134
v_lshlrev_b32 v16, 16, v135
v_and_b32 v17, 0xffff0000, v135
v_pk_add_f32 v[96:97], v[96:97], v[10:11]
v_pk_add_f32 v[98:99], v[98:99], v[12:13]
v_pk_add_f32 v[100:101], v[100:101], v[14:15]
v_pk_add_f32 v[102:103], v[102:103], v[16:17]
v_lshlrev_b32 v10, 16, v136
v_and_b32 v11, 0xffff0000, v136
v_lshlrev_b32 v12, 16, v137
v_and_b32 v13, 0xffff0000, v137
v_lshlrev_b32 v14, 16, v138
v_and_b32 v15, 0xffff0000, v138
v_lshlrev_b32 v16, 16, v139
v_and_b32 v17, 0xffff0000, v139
v_pk_add_f32 v[96:97], v[96:97], v[10:11]
v_pk_add_f32 v[98:99], v[98:99], v[12:13]
v_pk_add_f32 v[100:101], v[100:101], v[14:15]
v_pk_add_f32 v[102:103], v[102:103], v[16:17]
v_lshlrev_b32 v10, 16, v140
v_and_b32 v11, 0xffff0000, v140
v_lshlrev_b32 v12, 16, v141
v_and_b32 v13, 0xffff0000, v141
v_lshlrev_b32 v14, 16, v142
v_and_b32 v15, 0xffff0000, v142
v_lshlrev_b32 v16, 16, v143
v_and_b32 v17, 0xffff0000, v143
v_pk_add_f32 v[96:97], v[96:97], v[10:11]
v_pk_add_f32 v[98:99], v[98:99], v[12:13]
v_pk_add_f32 v[100:101], v[100:101], v[14:15]
v_pk_add_f32 v[102:103], v[102:103], v[16:17]
v_lshlrev_b32 v10, 16, v144
v_and_b32 v11, 0xffff0000, v144
v_lshlrev_b32 v12, 16, v145
v_and_b32 v13, 0xffff0000, v145
v_lshlrev_b32 v14, 16, v146
v_and_b32 v15, 0xffff0000, v146
v_lshlrev_b32 v16, 16, v147
v_and_b32 v17, 0xffff0000, v147
v_pk_add_f32 v[96:97], v[96:97], v[10:11]
v_pk_add_f32 v[98:99], v[98:99], v[12:13]
v_pk_add_f32 v[100:101], v[100:101], v[14:15]
v_pk_add_f32 v[102:103], v[102:103], v[16:17]
v_lshlrev_b32 v10, 16, v148
v_and_b32 v11, 0xffff0000, v148
v_lshlrev_b32 v12, 16, v149
v_and_b32 v13, 0xffff0000, v149
v_lshlrev_b32 v14, 16, v150
v_and_b32 v15, 0xffff0000, v150
v_lshlrev_b32 v16, 16, v151
v_and_b32 v17, 0xffff0000, v151
v_pk_add_f32 v[96:97], v[96:97], v[10:11]
v_pk_add_f32 v[98:99], v[98:99], v[12:13]
v_pk_add_f32 v[100:101], v[100:101], v[14:15]
v_pk_add_f32 v[102:103], v[102:103], v[16:17]
v_lshlrev_b32 v10, 16, v152
v_and_b32 v11, 0xffff0000, v152
v_lshlrev_b32 v12, 16, v153
v_and_b32 v13, 0xffff0000, v153
v_lshlrev_b32 v14, 16, v154
v_and_b32 v15, 0xffff0000, v154
v_lshlrev_b32 v16, 16, v155
v_and_b32 v17, 0xffff0000, v155
v_pk_add_f32 v[96:97], v[96:97], v[10:11]
v_pk_add_f32 v[98:99], v[98:99], v[12:13]
v_pk_add_f32 v[100:101], v[100:101], v[14:15]
v_pk_add_f32 v[102:103], v[102:103], v[16:17]
v_lshlrev_b32 v10, 16, v156
v_and_b32 v11, 0xffff0000, v156
v_lshlrev_b32 v12, 16, v157
v_and_b32 v13, 0xffff0000, v157
v_lshlrev_b32 v14, 16, v158
v_and_b32 v15, 0xffff0000, v158
v_lshlrev_b32 v16, 16, v159
v_and_b32 v17, 0xffff0000, v159
v_pk_add_f32 v[96:97], v[96:97], v[10:11]
v_pk_add_f32 v[98:99], v[98:99], v[12:13]
v_pk_add_f32 v[100:101], v[100:101], v[14:15]
v_pk_add_f32 v[102:103], v[102:103], v[16:17]
v_lshlrev_b32 v10, 16, v160
v_and_b32 v11, 0xffff0000, v160
v_lshlrev_b32 v12, 16, v161
v_and_b32 v13, 0xffff0000, v161
v_lshlrev_b32 v14, 16, v162
v_and_b32 v15, 0xffff0000, v162
v_lshlrev_b32 v16, 16, v163
v_and_b32 v17, 0xffff0000, v163
v_pk_add_f32 v[96:97], v[96:97], v[10:11]
v_pk_add_f32 v[98:99], v[98:99], v[12:13]
v_pk_add_f32 v[100:101], v[100:101], v[14:15]
v_pk_add_f32 v[102:103], v[102:103], v[16:17]
v_lshlrev_b32 v10, 16, v164
v_and_b32 v11, 0xffff0000, v164
v_lshlrev_b32 v12, 16, v165
v_and_b32 v13, 0xffff0000, v165
v_lshlrev_b32 v14, 16, v166
v_and_b32 v15, 0xffff0000, v166
v_lshlrev_b32 v16, 16, v167
v_and_b32 v17, 0xffff0000, v167
v_pk_add_f32 v[96:97], v[96:97], v[10:11]
v_pk_add_f32 v[98:99], v[98:99], v[12:13]
v_pk_add_f32 v[100:101], v[100:101], v[14:15]
v_pk_add_f32 v[102:103], v[102:103], v[16:17]
v_lshlrev_b32 v10, 16, v168
v_and_b32 v11, 0xffff0000, v168
v_lshlrev_b32 v12, 16, v169
v_and_b32 v13, 0xffff0000, v169
v_lshlrev_b32 v14, 16, v170
v_and_b32 v15, 0xffff0000, v170
v_lshlrev_b32 v16, 16, v171
v_and_b32 v17, 0xffff0000, v171
v_pk_add_f32 v[96:97], v[96:97], v[10:11]
v_pk_add_f32 v[98:99], v[98:99], v[12:13]
v_pk_add_f32 v[100:101], v[100:101], v[14:15]
v_pk_add_f32 v[102:103], v[102:103], v[16:17]
v_lshlrev_b32 v10, 16, v172
v_and_b32 v11, 0xffff0000, v172
v_lshlrev_b32 v12, 16, v173
v_and_b32 v13, 0xffff0000, v173
v_lshlrev_b32 v14, 16, v174
v_and_b32 v15, 0xffff0000, v174
v_lshlrev_b32 v16, 16, v175
v_and_b32 v17, 0xffff0000, v175
v_pk_add_f32 v[96:97], v[96:97], v[10:11]
v_pk_add_f32 v[98:99], v[98:99], v[12:13]
v_pk_add_f32 v[100:101], v[100:101], v[14:15]
v_pk_add_f32 v[102:103], v[102:103], v[16:17]
v_lshlrev_b32 v10, 16, v176
v_and_b32 v11, 0xffff0000, v176
v_lshlrev_b32 v12, 16, v177
v_and_b32 v13, 0xffff0000, v177
v_lshlrev_b32 v14, 16, v178
v_and_b32 v15, 0xffff0000, v178
v_lshlrev_b32 v16, 16, v179
v_and_b32 v17, 0xffff0000, v179
v_pk_add_f32 v[96:97], v[96:97], v[10:11]
v_pk_add_f32 v[98:99], v[98:99], v[12:13]
v_pk_add_f32 v[100:101], v[100:101], v[14:15]
v_pk_add_f32 v[102:103], v[102:103], v[16:17]
v_lshlrev_b32 v10, 16, v180
v_and_b32 v11, 0xffff0000, v180
v_lshlrev_b32 v12, 16, v181
v_and_b32 v13, 0xffff0000, v181
v_lshlrev_b32 v14, 16, v182
v_and_b32 v15, 0xffff0000, v182
v_lshlrev_b32 v16, 16, v183
v_and_b32 v17, 0xffff0000, v183
v_pk_add_f32 v[96:97], v[96:97], v[10:11]
v_pk_add_f32 v[98:99], v[98:99], v[12:13]
v_pk_add_f32 v[100:101], v[100:101], v[14:15]
v_pk_add_f32 v[102:103], v[102:103], v[16:17]
v_lshlrev_b32 v10, 16, v184
v_and_b32 v11, 0xffff0000, v184
v_lshlrev_b32 v12, 16, v185
v_and_b32 v13, 0xffff0000, v185
v_lshlrev_b32 v14, 16, v186
v_and_b32 v15, 0xffff0000, v186
v_lshlrev_b32 v16, 16, v187
v_and_b32 v17, 0xffff0000, v187
v_pk_add_f32 v[96:97], v[96:97], v[10:11]
v_pk_add_f32 v[98:99], v[98:99], v[12:13]
v_pk_add_f32 v[100:101], v[100:101], v[14:15]
v_pk_add_f32 v[102:103], v[102:103], v[16:17]
v_lshlrev_b32 v10, 16, v188
v_and_b32 v11, 0xffff0000, v188
v_lshlrev_b32 v12, 16, v189
v_and_b32 v13, 0xffff0000, v189
v_lshlrev_b32 v14, 16, v190
v_and_b32 v15, 0xffff0000, v190
v_lshlrev_b32 v16, 16, v191
v_and_b32 v17, 0xffff0000, v191
v_pk_add_f32 v[96:97], v[96:97], v[10:11]
v_pk_add_f32 v[98:99], v[98:99], v[12:13]
v_pk_add_f32 v[100:101], v[100:101], v[14:15]
v_pk_add_f32 v[102:103], v[102:103], v[16:17]
v_cvt_pk_bf16_f32 v96, v96, v97
v_cvt_pk_bf16_f32 v97, v98, v99
v_cvt_pk_bf16_f32 v98, v100, v101
v_cvt_pk_bf16_f32 v99, v102, v103
buffer_store_dwordx2 v[96:97], v21, s[40:43], s25 offen offset:896
buffer_store_dwordx2 v[98:99], v21, s[40:43], s25 offen offset:928
s_waitcnt vmcnt(17)
v_lshlrev_b32 v104, 16, v192
v_and_b32 v105, 0xffff0000, v192
v_lshlrev_b32 v106, 16, v193
v_and_b32 v107, 0xffff0000, v193
v_lshlrev_b32 v108, 16, v194
v_and_b32 v109, 0xffff0000, v194
v_lshlrev_b32 v110, 16, v195
v_and_b32 v111, 0xffff0000, v195
s_waitcnt vmcnt(16)
v_lshlrev_b32 v10, 16, v196
v_and_b32 v11, 0xffff0000, v196
v_lshlrev_b32 v12, 16, v197
v_and_b32 v13, 0xffff0000, v197
v_lshlrev_b32 v14, 16, v198
v_and_b32 v15, 0xffff0000, v198
v_lshlrev_b32 v16, 16, v199
v_and_b32 v17, 0xffff0000, v199
v_pk_add_f32 v[104:105], v[104:105], v[10:11]
v_pk_add_f32 v[106:107], v[106:107], v[12:13]
v_pk_add_f32 v[108:109], v[108:109], v[14:15]
v_pk_add_f32 v[110:111], v[110:111], v[16:17]
s_waitcnt vmcnt(15)
v_lshlrev_b32 v10, 16, v200
v_and_b32 v11, 0xffff0000, v200
v_lshlrev_b32 v12, 16, v201
v_and_b32 v13, 0xffff0000, v201
v_lshlrev_b32 v14, 16, v202
v_and_b32 v15, 0xffff0000, v202
v_lshlrev_b32 v16, 16, v203
v_and_b32 v17, 0xffff0000, v203
v_pk_add_f32 v[104:105], v[104:105], v[10:11]
v_pk_add_f32 v[106:107], v[106:107], v[12:13]
v_pk_add_f32 v[108:109], v[108:109], v[14:15]
v_pk_add_f32 v[110:111], v[110:111], v[16:17]
s_waitcnt vmcnt(14)
v_lshlrev_b32 v10, 16, v204
v_and_b32 v11, 0xffff0000, v204
v_lshlrev_b32 v12, 16, v205
v_and_b32 v13, 0xffff0000, v205
v_lshlrev_b32 v14, 16, v206
v_and_b32 v15, 0xffff0000, v206
v_lshlrev_b32 v16, 16, v207
v_and_b32 v17, 0xffff0000, v207
v_pk_add_f32 v[104:105], v[104:105], v[10:11]
v_pk_add_f32 v[106:107], v[106:107], v[12:13]
v_pk_add_f32 v[108:109], v[108:109], v[14:15]
v_pk_add_f32 v[110:111], v[110:111], v[16:17]
s_waitcnt vmcnt(13)
v_lshlrev_b32 v10, 16, v208
v_and_b32 v11, 0xffff0000, v208
v_lshlrev_b32 v12, 16, v209
v_and_b32 v13, 0xffff0000, v209
v_lshlrev_b32 v14, 16, v210
v_and_b32 v15, 0xffff0000, v210
v_lshlrev_b32 v16, 16, v211
v_and_b32 v17, 0xffff0000, v211
v_pk_add_f32 v[104:105], v[104:105], v[10:11]
v_pk_add_f32 v[106:107], v[106:107], v[12:13]
v_pk_add_f32 v[108:109], v[108:109], v[14:15]
v_pk_add_f32 v[110:111], v[110:111], v[16:17]
s_waitcnt vmcnt(12)
v_lshlrev_b32 v10, 16, v212
v_and_b32 v11, 0xffff0000, v212
v_lshlrev_b32 v12, 16, v213
v_and_b32 v13, 0xffff0000, v213
v_lshlrev_b32 v14, 16, v214
v_and_b32 v15, 0xffff0000, v214
v_lshlrev_b32 v16, 16, v215
v_and_b32 v17, 0xffff0000, v215
PAD_17:
s_cbranch_execz M_tret
v_pk_add_f32 v[104:105], v[104:105], v[10:11]
v_pk_add_f32 v[106:107], v[106:107], v[12:13]
v_pk_add_f32 v[108:109], v[108:109], v[14:15]
v_pk_add_f32 v[110:111], v[110:111], v[16:17]
s_waitcnt vmcnt(11)
v_lshlrev_b32 v10, 16, v216
v_and_b32 v11, 0xffff0000, v216
v_lshlrev_b32 v12, 16, v217
v_and_b32 v13, 0xffff0000, v217
v_lshlrev_b32 v14, 16, v218
v_and_b32 v15, 0xffff0000, v218
v_lshlrev_b32 v16, 16, v219
v_and_b32 v17, 0xffff0000, v219
v_pk_add_f32 v[104:105], v[104:105], v[10:11]
v_pk_add_f32 v[106:107], v[106:107], v[12:13]
v_pk_add_f32 v[108:109], v[108:109], v[14:15]
v_pk_add_f32 v[110:111], v[110:111], v[16:17]
s_waitcnt vmcnt(10)
v_lshlrev_b32 v10, 16, v220
v_and_b32 v11, 0xffff0000, v220
v_lshlrev_b32 v12, 16, v221
v_and_b32 v13, 0xffff0000, v221
v_lshlrev_b32 v14, 16, v222
v_and_b32 v15, 0xffff0000, v222
v_lshlrev_b32 v16, 16, v223
v_and_b32 v17, 0xffff0000, v223
v_pk_add_f32 v[104:105], v[104:105], v[10:11]
v_pk_add_f32 v[106:107], v[106:107], v[12:13]
v_pk_add_f32 v[108:109], v[108:109], v[14:15]
v_pk_add_f32 v[110:111], v[110:111], v[16:17]
s_waitcnt vmcnt(9)
v_lshlrev_b32 v10, 16, v224
v_and_b32 v11, 0xffff0000, v224
v_lshlrev_b32 v12, 16, v225
v_and_b32 v13, 0xffff0000, v225
v_lshlrev_b32 v14, 16, v226
v_and_b32 v15, 0xffff0000, v226
v_lshlrev_b32 v16, 16, v227
v_and_b32 v17, 0xffff0000, v227
v_pk_add_f32 v[104:105], v[104:105], v[10:11]
v_pk_add_f32 v[106:107], v[106:107], v[12:13]
v_pk_add_f32 v[108:109], v[108:109], v[14:15]
v_pk_add_f32 v[110:111], v[110:111], v[16:17]
s_waitcnt vmcnt(8)
v_lshlrev_b32 v10, 16, v228
v_and_b32 v11, 0xffff0000, v228
v_lshlrev_b32 v12, 16, v229
v_and_b32 v13, 0xffff0000, v229
v_lshlrev_b32 v14, 16, v230
v_and_b32 v15, 0xffff0000, v230
v_lshlrev_b32 v16, 16, v231
v_and_b32 v17, 0xffff0000, v231
v_pk_add_f32 v[104:105], v[104:105], v[10:11]
v_pk_add_f32 v[106:107], v[106:107], v[12:13]
v_pk_add_f32 v[108:109], v[108:109], v[14:15]
v_pk_add_f32 v[110:111], v[110:111], v[16:17]
s_waitcnt vmcnt(7)
v_lshlrev_b32 v10, 16, v232
v_and_b32 v11, 0xffff0000, v232
v_lshlrev_b32 v12, 16, v233
v_and_b32 v13, 0xffff0000, v233
v_lshlrev_b32 v14, 16, v234
v_and_b32 v15, 0xffff0000, v234
v_lshlrev_b32 v16, 16, v235
v_and_b32 v17, 0xffff0000, v235
v_pk_add_f32 v[104:105], v[104:105], v[10:11]
v_pk_add_f32 v[106:107], v[106:107], v[12:13]
v_pk_add_f32 v[108:109], v[108:109], v[14:15]
v_pk_add_f32 v[110:111], v[110:111], v[16:17]
s_waitcnt vmcnt(6)
v_lshlrev_b32 v10, 16, v236
v_and_b32 v11, 0xffff0000, v236
v_lshlrev_b32 v12, 16, v237
v_and_b32 v13, 0xffff0000, v237
v_lshlrev_b32 v14, 16, v238
v_and_b32 v15, 0xffff0000, v238
v_lshlrev_b32 v16, 16, v239
v_and_b32 v17, 0xffff0000, v239
v_pk_add_f32 v[104:105], v[104:105], v[10:11]
v_pk_add_f32 v[106:107], v[106:107], v[12:13]
v_pk_add_f32 v[108:109], v[108:109], v[14:15]
v_pk_add_f32 v[110:111], v[110:111], v[16:17]
s_waitcnt vmcnt(5)
v_lshlrev_b32 v10, 16, v240
v_and_b32 v11, 0xffff0000, v240
v_lshlrev_b32 v12, 16, v241
v_and_b32 v13, 0xffff0000, v241
v_lshlrev_b32 v14, 16, v242
v_and_b32 v15, 0xffff0000, v242
v_lshlrev_b32 v16, 16, v243
v_and_b32 v17, 0xffff0000, v243
v_pk_add_f32 v[104:105], v[104:105], v[10:11]
v_pk_add_f32 v[106:107], v[106:107], v[12:13]
v_pk_add_f32 v[108:109], v[108:109], v[14:15]
v_pk_add_f32 v[110:111], v[110:111], v[16:17]
s_waitcnt vmcnt(4)
v_lshlrev_b32 v10, 16, v244
v_and_b32 v11, 0xffff0000, v244
v_lshlrev_b32 v12, 16, v245
v_and_b32 v13, 0xffff0000, v245
v_lshlrev_b32 v14, 16, v246
v_and_b32 v15, 0xffff0000, v246
v_lshlrev_b32 v16, 16, v247
v_and_b32 v17, 0xffff0000, v247
v_pk_add_f32 v[104:105], v[104:105], v[10:11]
v_pk_add_f32 v[106:107], v[106:107], v[12:13]
v_pk_add_f32 v[108:109], v[108:109], v[14:15]
v_pk_add_f32 v[110:111], v[110:111], v[16:17]
s_waitcnt vmcnt(3)
v_lshlrev_b32 v10, 16, v248
v_and_b32 v11, 0xffff0000, v248
v_lshlrev_b32 v12, 16, v249
v_and_b32 v13, 0xffff0000, v249
v_lshlrev_b32 v14, 16, v250
v_and_b32 v15, 0xffff0000, v250
v_lshlrev_b32 v16, 16, v251
v_and_b32 v17, 0xffff0000, v251
v_pk_add_f32 v[104:105], v[104:105], v[10:11]
v_pk_add_f32 v[106:107], v[106:107], v[12:13]
v_pk_add_f32 v[108:109], v[108:109], v[14:15]
v_pk_add_f32 v[110:111], v[110:111], v[16:17]
s_waitcnt vmcnt(2)
v_lshlrev_b32 v10, 16, v252
v_and_b32 v11, 0xffff0000, v252
v_lshlrev_b32 v12, 16, v253
v_and_b32 v13, 0xffff0000, v253
v_lshlrev_b32 v14, 16, v254
v_and_b32 v15, 0xffff0000, v254
v_lshlrev_b32 v16, 16, v255
v_and_b32 v17, 0xffff0000, v255
v_pk_add_f32 v[104:105], v[104:105], v[10:11]
v_pk_add_f32 v[106:107], v[106:107], v[12:13]
v_pk_add_f32 v[108:109], v[108:109], v[14:15]
v_pk_add_f32 v[110:111], v[110:111], v[16:17]
v_cvt_pk_bf16_f32 v104, v104, v105
v_cvt_pk_bf16_f32 v105, v106, v107
v_cvt_pk_bf16_f32 v106, v108, v109
v_cvt_pk_bf16_f32 v107, v110, v111
buffer_store_dwordx2 v[104:105], v21, s[40:43], s25 offen offset:1344
buffer_store_dwordx2 v[106:107], v21, s[40:43], s25 offen offset:1376
s_add_u32 s25, s25, 1835008
s_add_u32 s26, s26, 14457856
s_add_u32 s33, s33, 1024
s_branch M_r1
M_rA:
PAD_18:
s_cbranch_execz M_tret
s_add_u32 s25, s25, 448
s_add_u32 s26, s26, 7168
s_add_u32 s33, s33, 2048
M_r1:
Lp_9203:
buffer_load_dword v18, v19, s[4:7], s33 offen offset:0 sc1
s_waitcnt vmcnt(0)
v_cmp_gt_u32 vcc, 1, v18
s_cbranch_vccz Lpd_9204
s_sleep 8
s_sub_u32 s101, s101, 1
s_cbranch_scc0 Lp_9203
s_mov_b32 s101, 0
Lpd_9204:
buffer_load_dwordx4 v[128:131], v1, s[4:7], s26 offen sc1
s_add_u32 s26, s26, 14336
buffer_load_dwordx4 v[132:135], v1, s[4:7], s26 offen sc1
s_add_u32 s26, s26, 14336
buffer_load_dwordx4 v[136:139], v1, s[4:7], s26 offen sc1
s_add_u32 s26, s26, 14336
buffer_load_dwordx4 v[140:143], v1, s[4:7], s26 offen sc1
s_add_u32 s26, s26, 14336
buffer_load_dwordx4 v[144:147], v1, s[4:7], s26 offen sc1
s_add_u32 s26, s26, 14336
buffer_load_dwordx4 v[148:151], v1, s[4:7], s26 offen sc1
s_add_u32 s26, s26, 14336
buffer_load_dwordx4 v[152:155], v1, s[4:7], s26 offen sc1
s_add_u32 s26, s26, 14336
buffer_load_dwordx4 v[156:159], v1, s[4:7], s26 offen sc1
s_add_u32 s26, s26, 14336
buffer_load_dwordx4 v[160:163], v1, s[4:7], s26 offen sc1
s_add_u32 s26, s26, 14336
buffer_load_dwordx4 v[164:167], v1, s[4:7], s26 offen sc1
s_add_u32 s26, s26, 14336
buffer_load_dwordx4 v[168:171], v1, s[4:7], s26 offen sc1
s_add_u32 s26, s26, 14336
buffer_load_dwordx4 v[172:175], v1, s[4:7], s26 offen sc1
s_add_u32 s26, s26, 14336
buffer_load_dwordx4 v[176:179], v1, s[4:7], s26 offen sc1
s_add_u32 s26, s26, 14336
buffer_load_dwordx4 v[180:183], v1, s[4:7], s26 offen sc1
s_add_u32 s26, s26, 14336
buffer_load_dwordx4 v[184:187], v1, s[4:7], s26 offen sc1
s_add_u32 s26, s26, 14336
buffer_load_dwordx4 v[188:191], v1, s[4:7], s26 offen sc1
s_waitcnt vmcnt(15)
v_lshlrev_b32 v96, 16, v128
v_and_b32 v97, 0xffff0000, v128
v_lshlrev_b32 v98, 16, v129
v_and_b32 v99, 0xffff0000, v129
v_lshlrev_b32 v100, 16, v130
v_and_b32 v101, 0xffff0000, v130
v_lshlrev_b32 v102, 16, v131
v_and_b32 v103, 0xffff0000, v131
s_waitcnt vmcnt(14)
v_lshlrev_b32 v10, 16, v132
v_and_b32 v11, 0xffff0000, v132
v_lshlrev_b32 v12, 16, v133
v_and_b32 v13, 0xffff0000, v133
v_lshlrev_b32 v14, 16, v134
v_and_b32 v15, 0xffff0000, v134
v_lshlrev_b32 v16, 16, v135
v_and_b32 v17, 0xffff0000, v135
v_pk_add_f32 v[96:97], v[96:97], v[10:11]
v_pk_add_f32 v[98:99], v[98:99], v[12:13]
v_pk_add_f32 v[100:101], v[100:101], v[14:15]
v_pk_add_f32 v[102:103], v[102:103], v[16:17]
s_waitcnt vmcnt(13)
v_lshlrev_b32 v10, 16, v136
v_and_b32 v11, 0xffff0000, v136
v_lshlrev_b32 v12, 16, v137
v_and_b32 v13, 0xffff0000, v137
v_lshlrev_b32 v14, 16, v138
v_and_b32 v15, 0xffff0000, v138
v_lshlrev_b32 v16, 16, v139
v_and_b32 v17, 0xffff0000, v139
v_pk_add_f32 v[96:97], v[96:97], v[10:11]
v_pk_add_f32 v[98:99], v[98:99], v[12:13]
v_pk_add_f32 v[100:101], v[100:101], v[14:15]
v_pk_add_f32 v[102:103], v[102:103], v[16:17]
s_waitcnt vmcnt(12)
v_lshlrev_b32 v10, 16, v140
v_and_b32 v11, 0xffff0000, v140
v_lshlrev_b32 v12, 16, v141
v_and_b32 v13, 0xffff0000, v141
v_lshlrev_b32 v14, 16, v142
v_and_b32 v15, 0xffff0000, v142
v_lshlrev_b32 v16, 16, v143
v_and_b32 v17, 0xffff0000, v143
v_pk_add_f32 v[96:97], v[96:97], v[10:11]
v_pk_add_f32 v[98:99], v[98:99], v[12:13]
v_pk_add_f32 v[100:101], v[100:101], v[14:15]
v_pk_add_f32 v[102:103], v[102:103], v[16:17]
s_waitcnt vmcnt(11)
v_lshlrev_b32 v10, 16, v144
v_and_b32 v11, 0xffff0000, v144
v_lshlrev_b32 v12, 16, v145
v_and_b32 v13, 0xffff0000, v145
v_lshlrev_b32 v14, 16, v146
v_and_b32 v15, 0xffff0000, v146
v_lshlrev_b32 v16, 16, v147
v_and_b32 v17, 0xffff0000, v147
v_pk_add_f32 v[96:97], v[96:97], v[10:11]
v_pk_add_f32 v[98:99], v[98:99], v[12:13]
v_pk_add_f32 v[100:101], v[100:101], v[14:15]
v_pk_add_f32 v[102:103], v[102:103], v[16:17]
s_waitcnt vmcnt(10)
v_lshlrev_b32 v10, 16, v148
v_and_b32 v11, 0xffff0000, v148
v_lshlrev_b32 v12, 16, v149
v_and_b32 v13, 0xffff0000, v149
v_lshlrev_b32 v14, 16, v150
v_and_b32 v15, 0xffff0000, v150
v_lshlrev_b32 v16, 16, v151
v_and_b32 v17, 0xffff0000, v151
v_pk_add_f32 v[96:97], v[96:97], v[10:11]
v_pk_add_f32 v[98:99], v[98:99], v[12:13]
v_pk_add_f32 v[100:101], v[100:101], v[14:15]
v_pk_add_f32 v[102:103], v[102:103], v[16:17]
s_waitcnt vmcnt(9)
v_lshlrev_b32 v10, 16, v152
v_and_b32 v11, 0xffff0000, v152
v_lshlrev_b32 v12, 16, v153
v_and_b32 v13, 0xffff0000, v153
v_lshlrev_b32 v14, 16, v154
v_and_b32 v15, 0xffff0000, v154
v_lshlrev_b32 v16, 16, v155
v_and_b32 v17, 0xffff0000, v155
v_pk_add_f32 v[96:97], v[96:97], v[10:11]
v_pk_add_f32 v[98:99], v[98:99], v[12:13]
v_pk_add_f32 v[100:101], v[100:101], v[14:15]
v_pk_add_f32 v[102:103], v[102:103], v[16:17]
s_waitcnt vmcnt(8)
v_lshlrev_b32 v10, 16, v156
v_and_b32 v11, 0xffff0000, v156
v_lshlrev_b32 v12, 16, v157
v_and_b32 v13, 0xffff0000, v157
v_lshlrev_b32 v14, 16, v158
v_and_b32 v15, 0xffff0000, v158
v_lshlrev_b32 v16, 16, v159
v_and_b32 v17, 0xffff0000, v159
v_pk_add_f32 v[96:97], v[96:97], v[10:11]
v_pk_add_f32 v[98:99], v[98:99], v[12:13]
v_pk_add_f32 v[100:101], v[100:101], v[14:15]
v_pk_add_f32 v[102:103], v[102:103], v[16:17]
s_waitcnt vmcnt(7)
v_lshlrev_b32 v10, 16, v160
v_and_b32 v11, 0xffff0000, v160
v_lshlrev_b32 v12, 16, v161
v_and_b32 v13, 0xffff0000, v161
v_lshlrev_b32 v14, 16, v162
v_and_b32 v15, 0xffff0000, v162
v_lshlrev_b32 v16, 16, v163
v_and_b32 v17, 0xffff0000, v163
v_pk_add_f32 v[96:97], v[96:97], v[10:11]
v_pk_add_f32 v[98:99], v[98:99], v[12:13]
v_pk_add_f32 v[100:101], v[100:101], v[14:15]
v_pk_add_f32 v[102:103], v[102:103], v[16:17]
s_waitcnt vmcnt(6)
v_lshlrev_b32 v10, 16, v164
v_and_b32 v11, 0xffff0000, v164
v_lshlrev_b32 v12, 16, v165
v_and_b32 v13, 0xffff0000, v165
v_lshlrev_b32 v14, 16, v166
v_and_b32 v15, 0xffff0000, v166
v_lshlrev_b32 v16, 16, v167
v_and_b32 v17, 0xffff0000, v167
v_pk_add_f32 v[96:97], v[96:97], v[10:11]
v_pk_add_f32 v[98:99], v[98:99], v[12:13]
v_pk_add_f32 v[100:101], v[100:101], v[14:15]
v_pk_add_f32 v[102:103], v[102:103], v[16:17]
s_waitcnt vmcnt(5)
v_lshlrev_b32 v10, 16, v168
v_and_b32 v11, 0xffff0000, v168
v_lshlrev_b32 v12, 16, v169
v_and_b32 v13, 0xffff0000, v169
v_lshlrev_b32 v14, 16, v170
v_and_b32 v15, 0xffff0000, v170
v_lshlrev_b32 v16, 16, v171
v_and_b32 v17, 0xffff0000, v171
v_pk_add_f32 v[96:97], v[96:97], v[10:11]
v_pk_add_f32 v[98:99], v[98:99], v[12:13]
v_pk_add_f32 v[100:101], v[100:101], v[14:15]
v_pk_add_f32 v[102:103], v[102:103], v[16:17]
s_waitcnt vmcnt(4)
v_lshlrev_b32 v10, 16, v172
v_and_b32 v11, 0xffff0000, v172
v_lshlrev_b32 v12, 16, v173
v_and_b32 v13, 0xffff0000, v173
v_lshlrev_b32 v14, 16, v174
v_and_b32 v15, 0xffff0000, v174
v_lshlrev_b32 v16, 16, v175
v_and_b32 v17, 0xffff0000, v175
v_pk_add_f32 v[96:97], v[96:97], v[10:11]
v_pk_add_f32 v[98:99], v[98:99], v[12:13]
v_pk_add_f32 v[100:101], v[100:101], v[14:15]
v_pk_add_f32 v[102:103], v[102:103], v[16:17]
s_waitcnt vmcnt(3)
v_lshlrev_b32 v10, 16, v176
v_and_b32 v11, 0xffff0000, v176
v_lshlrev_b32 v12, 16, v177
v_and_b32 v13, 0xffff0000, v177
v_lshlrev_b32 v14, 16, v178
v_and_b32 v15, 0xffff0000, v178
v_lshlrev_b32 v16, 16, v179
v_and_b32 v17, 0xffff0000, v179
v_pk_add_f32 v[96:97], v[96:97], v[10:11]
v_pk_add_f32 v[98:99], v[98:99], v[12:13]
v_pk_add_f32 v[100:101], v[100:101], v[14:15]
v_pk_add_f32 v[102:103], v[102:103], v[16:17]
s_waitcnt vmcnt(2)
v_lshlrev_b32 v10, 16, v180
v_and_b32 v11, 0xffff0000, v180
v_lshlrev_b32 v12, 16, v181
v_and_b32 v13, 0xffff0000, v181
v_lshlrev_b32 v14, 16, v182
v_and_b32 v15, 0xffff0000, v182
v_lshlrev_b32 v16, 16, v183
v_and_b32 v17, 0xffff0000, v183
v_pk_add_f32 v[96:97], v[96:97], v[10:11]
v_pk_add_f32 v[98:99], v[98:99], v[12:13]
v_pk_add_f32 v[100:101], v[100:101], v[14:15]
v_pk_add_f32 v[102:103], v[102:103], v[16:17]
s_waitcnt vmcnt(1)
v_lshlrev_b32 v10, 16, v184
v_and_b32 v11, 0xffff0000, v184
v_lshlrev_b32 v12, 16, v185
v_and_b32 v13, 0xffff0000, v185
v_lshlrev_b32 v14, 16, v186
v_and_b32 v15, 0xffff0000, v186
v_lshlrev_b32 v16, 16, v187
v_and_b32 v17, 0xffff0000, v187
v_pk_add_f32 v[96:97], v[96:97], v[10:11]
v_pk_add_f32 v[98:99], v[98:99], v[12:13]
v_pk_add_f32 v[100:101], v[100:101], v[14:15]
v_pk_add_f32 v[102:103], v[102:103], v[16:17]
s_waitcnt vmcnt(0)
v_lshlrev_b32 v10, 16, v188
v_and_b32 v11, 0xffff0000, v188
v_lshlrev_b32 v12, 16, v189
v_and_b32 v13, 0xffff0000, v189
v_lshlrev_b32 v14, 16, v190
v_and_b32 v15, 0xffff0000, v190
v_lshlrev_b32 v16, 16, v191
v_and_b32 v17, 0xffff0000, v191
v_pk_add_f32 v[96:97], v[96:97], v[10:11]
v_pk_add_f32 v[98:99], v[98:99], v[12:13]
v_pk_add_f32 v[100:101], v[100:101], v[14:15]
v_pk_add_f32 v[102:103], v[102:103], v[16:17]
v_cvt_pk_bf16_f32 v96, v96, v97
v_cvt_pk_bf16_f32 v97, v98, v99
v_cvt_pk_bf16_f32 v98, v100, v101
v_cvt_pk_bf16_f32 v99, v102, v103
buffer_store_dwordx2 v[96:97], v21, s[40:43], s25 offen offset:896
buffer_store_dwordx2 v[98:99], v21, s[40:43], s25 offen offset:928
M_fin:
s_endpgm
PAD_19:
s_cbranch_execz M_tret
M_final:
s_mov_b32 s8, s64
s_mov_b32 s9, s65
s_mov_b32 s10, 1835008
s_mov_b32 s11, 0x20000
s_mov_b32 s12, s88
s_mov_b32 s13, s89
s_mov_b32 s14, 3670016
s_mov_b32 s15, 0x20000
s_lshr_b32 s24, s2, 0
s_and_b32 s24, s24, 16
s_add_u32 s24, s24, s20
v_lshrrev_b32 v20, 4, v1
v_and_b32 v21, 15, v20
v_lshrrev_b32 v22, 4, v20
v_mul_u32_u24 v2, 896, v21
v_lshlrev_b32 v9, 1, v2
v_lshl_add_u32 v2, v22, 4, v2
v_lshl_add_u32 v9, v22, 4, v9
s_lshl_b32 s22, s24, 2
s_add_u32 s22, s22, s3
s_mul_i32 s25, s22, 14336
s_lshl_b32 s26, s25, 1
v_lshlrev_b32 v10, 5, v22
v_add3_u32 v10, v10, v21, 16
v_lshlrev_b32 v10, 2, v10
v_min_u32 v11, 380, v10
v_add_u32 v11, 512, v11
s_mov_b32 s27, 94384128
Lfp:
buffer_load_dword v3, v10, s[4:7], s27 offen sc1
buffer_load_dword v4, v11, s[4:7], s27 offen sc1
s_waitcnt vmcnt(0)
v_and_b32 v3, v3, v4
v_cmp_gt_u32 vcc, 1, v3
s_cbranch_vccz Lfpd
s_sleep 2
s_sub_u32 s101, s101, 1
s_cbranch_scc0 Lfp
s_mov_b32 s101, 0
Lfpd:
s_barrier
buffer_store_dword v6, v5, s[4:7], s35 offen sc1
Lfg:
v_lshrrev_b32 v3, 3, v20
v_and_b32 v4, 7, v20
v_lshlrev_b32 v4, 4, v4
v_lshl_add_u32 v3, v3, 12, v4
s_mul_i32 s27, s3, 458752
s_lshl_b32 s22, s24, 7
s_add_u32 s27, s27, s22
s_add_u32 s27, s27, 88080384
s_mul_i32 s28, s3, 14336
s_add_u32 m0, s28, 0
s_nop 0
buffer_load_dwordx4 v3, s[4:7], s27 offen sc1 lds
s_add_u32 s27, s27, 32768
s_add_u32 m0, s28, 1024
s_nop 0
buffer_load_dwordx4 v3, s[4:7], s27 offen sc1 lds
s_add_u32 s27, s27, 32768
s_add_u32 m0, s28, 2048
s_nop 0
buffer_load_dwordx4 v3, s[4:7], s27 offen sc1 lds
s_add_u32 s27, s27, 32768
s_add_u32 m0, s28, 3072
s_nop 0
buffer_load_dwordx4 v3, s[4:7], s27 offen sc1 lds
s_add_u32 s27, s27, 32768
s_add_u32 m0, s28, 4096
s_nop 0
buffer_load_dwordx4 v3, s[4:7], s27 offen sc1 lds
s_add_u32 s27, s27, 32768
s_add_u32 m0, s28, 5120
s_nop 0
buffer_load_dwordx4 v3, s[4:7], s27 offen sc1 lds
s_add_u32 s27, s27, 32768
s_add_u32 m0, s28, 6144
s_nop 0
buffer_load_dwordx4 v3, s[4:7], s27 offen sc1 lds
s_add_u32 s27, s27, 32768
s_add_u32 m0, s28, 7168
s_nop 0
buffer_load_dwordx4 v3, s[4:7], s27 offen sc1 lds
s_add_u32 s27, s27, 32768
s_add_u32 m0, s28, 8192
s_nop 0
buffer_load_dwordx4 v3, s[4:7], s27 offen sc1 lds
s_add_u32 s27, s27, 32768
s_add_u32 m0, s28, 9216
s_nop 0
buffer_load_dwordx4 v3, s[4:7], s27 offen sc1 lds
s_add_u32 s27, s27, 32768
s_add_u32 m0, s28, 10240
s_nop 0
buffer_load_dwordx4 v3, s[4:7], s27 offen sc1 lds
s_add_u32 s27, s27, 32768
s_add_u32 m0, s28, 11264
s_nop 0
buffer_load_dwordx4 v3, s[4:7], s27 offen sc1 lds
s_add_u32 s27, s27, 32768
s_add_u32 m0, s28, 12288
s_nop 0
buffer_load_dwordx4 v3, s[4:7], s27 offen sc1 lds
s_add_u32 s27, s27, 32768
s_add_u32 m0, s28, 13312
s_nop 0
buffer_load_dwordx4 v3, s[4:7], s27 offen sc1 lds
s_add_u32 s27, s27, 32768
buffer_load_dwordx4 v[160:163], v2, s[8:11], s25 offen offset:0
buffer_load_dwordx4 v[164:167], v2, s[8:11], s25 offen offset:64
buffer_load_dwordx4 v[168:171], v2, s[8:11], s25 offen offset:128
buffer_load_dwordx4 v[172:175], v2, s[8:11], s25 offen offset:192
buffer_load_dwordx4 v[176:179], v2, s[8:11], s25 offen offset:256
buffer_load_dwordx4 v[180:183], v2, s[8:11], s25 offen offset:320
buffer_load_dwordx4 v[184:187], v2, s[8:11], s25 offen offset:384
buffer_load_dwordx4 v[188:191], v2, s[8:11], s25 offen offset:448
buffer_load_dwordx4 v[192:195], v2, s[8:11], s25 offen offset:512
buffer_load_dwordx4 v[196:199], v2, s[8:11], s25 offen offset:576
buffer_load_dwordx4 v[200:203], v2, s[8:11], s25 offen offset:640
buffer_load_dwordx4 v[204:207], v2, s[8:11], s25 offen offset:704
buffer_load_dwordx4 v[208:211], v2, s[8:11], s25 offen offset:768
buffer_load_dwordx4 v[212:215], v2, s[8:11], s25 offen offset:832
v_lshrrev_b32 v3, 2, v21
v_lshl_add_u32 v3, v22, 3, v3
v_lshlrev_b32 v3, 7, v3
v_and_b32 v4, 3, v20
v_lshl_add_u32 v3, v4, 3, v3
s_lshl_b32 s22, s3, 5
v_add_u32 v3, s22, v3
s_waitcnt vmcnt(14)
s_barrier
ds_read_b64_tr_b16 v[96:97], v3 offset:0
ds_read_b64_tr_b16 v[98:99], v3 offset:512
ds_read_b64_tr_b16 v[100:101], v3 offset:4096
ds_read_b64_tr_b16 v[102:103], v3 offset:4608
ds_read_b64_tr_b16 v[104:105], v3 offset:8192
ds_read_b64_tr_b16 v[106:107], v3 offset:8704
ds_read_b64_tr_b16 v[108:109], v3 offset:12288
ds_read_b64_tr_b16 v[110:111], v3 offset:12800
ds_read_b64_tr_b16 v[112:113], v3 offset:16384
ds_read_b64_tr_b16 v[114:115], v3 offset:16896
ds_read_b64_tr_b16 v[116:117], v3 offset:20480
ds_read_b64_tr_b16 v[118:119], v3 offset:20992
ds_read_b64_tr_b16 v[120:121], v3 offset:24576
ds_read_b64_tr_b16 v[122:123], v3 offset:25088
s_waitcnt lgkmcnt(0)
ds_read_b64_tr_b16 v[124:125], v3 offset:28672
ds_read_b64_tr_b16 v[126:127], v3 offset:29184
ds_read_b64_tr_b16 v[128:129], v3 offset:32768
ds_read_b64_tr_b16 v[130:131], v3 offset:33280
ds_read_b64_tr_b16 v[132:133], v3 offset:36864
ds_read_b64_tr_b16 v[134:135], v3 offset:37376
ds_read_b64_tr_b16 v[136:137], v3 offset:40960
ds_read_b64_tr_b16 v[138:139], v3 offset:41472
ds_read_b64_tr_b16 v[140:141], v3 offset:45056
ds_read_b64_tr_b16 v[142:143], v3 offset:45568
ds_read_b64_tr_b16 v[144:145], v3 offset:49152
ds_read_b64_tr_b16 v[146:147], v3 offset:49664
ds_read_b64_tr_b16 v[148:149], v3 offset:53248
ds_read_b64_tr_b16 v[150:151], v3 offset:53760
s_waitcnt vmcnt(13)
v_lshlrev_b32 v10, 16, v160
v_and_b32 v11, 0xffff0000, v160
v_lshlrev_b32 v12, 16, v96
v_and_b32 v13, 0xffff0000, v96
v_pk_mul_f32 v[10:11], v[10:11], v[12:13]
v_cvt_pk_bf16_f32 v160, v10, v11
v_lshlrev_b32 v10, 16, v161
v_and_b32 v11, 0xffff0000, v161
v_lshlrev_b32 v12, 16, v97
v_and_b32 v13, 0xffff0000, v97
v_pk_mul_f32 v[10:11], v[10:11], v[12:13]
v_cvt_pk_bf16_f32 v161, v10, v11
v_lshlrev_b32 v10, 16, v162
v_and_b32 v11, 0xffff0000, v162
v_lshlrev_b32 v12, 16, v98
v_and_b32 v13, 0xffff0000, v98
v_pk_mul_f32 v[10:11], v[10:11], v[12:13]
v_cvt_pk_bf16_f32 v162, v10, v11
v_lshlrev_b32 v10, 16, v163
v_and_b32 v11, 0xffff0000, v163
v_lshlrev_b32 v12, 16, v99
v_and_b32 v13, 0xffff0000, v99
v_pk_mul_f32 v[10:11], v[10:11], v[12:13]
v_cvt_pk_bf16_f32 v163, v10, v11
buffer_store_dwordx4 v[160:163], v9, s[12:15], s26 offen offset:0
s_waitcnt vmcnt(13)
v_lshlrev_b32 v10, 16, v164
v_and_b32 v11, 0xffff0000, v164
v_lshlrev_b32 v12, 16, v100
v_and_b32 v13, 0xffff0000, v100
v_pk_mul_f32 v[10:11], v[10:11], v[12:13]
v_cvt_pk_bf16_f32 v164, v10, v11
v_lshlrev_b32 v10, 16, v165
v_and_b32 v11, 0xffff0000, v165
v_lshlrev_b32 v12, 16, v101
v_and_b32 v13, 0xffff0000, v101
v_pk_mul_f32 v[10:11], v[10:11], v[12:13]
v_cvt_pk_bf16_f32 v165, v10, v11
v_lshlrev_b32 v10, 16, v166
v_and_b32 v11, 0xffff0000, v166
v_lshlrev_b32 v12, 16, v102
v_and_b32 v13, 0xffff0000, v102
v_pk_mul_f32 v[10:11], v[10:11], v[12:13]
v_cvt_pk_bf16_f32 v166, v10, v11
v_lshlrev_b32 v10, 16, v167
v_and_b32 v11, 0xffff0000, v167
v_lshlrev_b32 v12, 16, v103
v_and_b32 v13, 0xffff0000, v103
v_pk_mul_f32 v[10:11], v[10:11], v[12:13]
v_cvt_pk_bf16_f32 v167, v10, v11
buffer_store_dwordx4 v[164:167], v9, s[12:15], s26 offen offset:64
s_waitcnt vmcnt(13)
v_lshlrev_b32 v10, 16, v168
v_and_b32 v11, 0xffff0000, v168
v_lshlrev_b32 v12, 16, v104
v_and_b32 v13, 0xffff0000, v104
v_pk_mul_f32 v[10:11], v[10:11], v[12:13]
v_cvt_pk_bf16_f32 v168, v10, v11
v_lshlrev_b32 v10, 16, v169
v_and_b32 v11, 0xffff0000, v169
v_lshlrev_b32 v12, 16, v105
v_and_b32 v13, 0xffff0000, v105
v_pk_mul_f32 v[10:11], v[10:11], v[12:13]
PAD_20:
s_cbranch_execz M_tret
v_cvt_pk_bf16_f32 v169, v10, v11
v_lshlrev_b32 v10, 16, v170
v_and_b32 v11, 0xffff0000, v170
v_lshlrev_b32 v12, 16, v106
v_and_b32 v13, 0xffff0000, v106
v_pk_mul_f32 v[10:11], v[10:11], v[12:13]
v_cvt_pk_bf16_f32 v170, v10, v11
v_lshlrev_b32 v10, 16, v171
v_and_b32 v11, 0xffff0000, v171
v_lshlrev_b32 v12, 16, v107
v_and_b32 v13, 0xffff0000, v107
v_pk_mul_f32 v[10:11], v[10:11], v[12:13]
v_cvt_pk_bf16_f32 v171, v10, v11
buffer_store_dwordx4 v[168:171], v9, s[12:15], s26 offen offset:128
s_waitcnt vmcnt(13)
v_lshlrev_b32 v10, 16, v172
v_and_b32 v11, 0xffff0000, v172
v_lshlrev_b32 v12, 16, v108
v_and_b32 v13, 0xffff0000, v108
v_pk_mul_f32 v[10:11], v[10:11], v[12:13]
v_cvt_pk_bf16_f32 v172, v10, v11
v_lshlrev_b32 v10, 16, v173
v_and_b32 v11, 0xffff0000, v173
v_lshlrev_b32 v12, 16, v109
v_and_b32 v13, 0xffff0000, v109
v_pk_mul_f32 v[10:11], v[10:11], v[12:13]
v_cvt_pk_bf16_f32 v173, v10, v11
v_lshlrev_b32 v10, 16, v174
v_and_b32 v11, 0xffff0000, v174
v_lshlrev_b32 v12, 16, v110
v_and_b32 v13, 0xffff0000, v110
v_pk_mul_f32 v[10:11], v[10:11], v[12:13]
v_cvt_pk_bf16_f32 v174, v10, v11
v_lshlrev_b32 v10, 16, v175
v_and_b32 v11, 0xffff0000, v175
v_lshlrev_b32 v12, 16, v111
v_and_b32 v13, 0xffff0000, v111
v_pk_mul_f32 v[10:11], v[10:11], v[12:13]
v_cvt_pk_bf16_f32 v175, v10, v11
buffer_store_dwordx4 v[172:175], v9, s[12:15], s26 offen offset:192
s_waitcnt vmcnt(13)
v_lshlrev_b32 v10, 16, v176
v_and_b32 v11, 0xffff0000, v176
v_lshlrev_b32 v12, 16, v112
v_and_b32 v13, 0xffff0000, v112
v_pk_mul_f32 v[10:11], v[10:11], v[12:13]
v_cvt_pk_bf16_f32 v176, v10, v11
v_lshlrev_b32 v10, 16, v177
v_and_b32 v11, 0xffff0000, v177
v_lshlrev_b32 v12, 16, v113
v_and_b32 v13, 0xffff0000, v113
v_pk_mul_f32 v[10:11], v[10:11], v[12:13]
v_cvt_pk_bf16_f32 v177, v10, v11
v_lshlrev_b32 v10, 16, v178
v_and_b32 v11, 0xffff0000, v178
v_lshlrev_b32 v12, 16, v114
v_and_b32 v13, 0xffff0000, v114
v_pk_mul_f32 v[10:11], v[10:11], v[12:13]
v_cvt_pk_bf16_f32 v178, v10, v11
v_lshlrev_b32 v10, 16, v179
v_and_b32 v11, 0xffff0000, v179
v_lshlrev_b32 v12, 16, v115
v_and_b32 v13, 0xffff0000, v115
v_pk_mul_f32 v[10:11], v[10:11], v[12:13]
v_cvt_pk_bf16_f32 v179, v10, v11
buffer_store_dwordx4 v[176:179], v9, s[12:15], s26 offen offset:256
s_waitcnt vmcnt(13)
v_lshlrev_b32 v10, 16, v180
v_and_b32 v11, 0xffff0000, v180
v_lshlrev_b32 v12, 16, v116
v_and_b32 v13, 0xffff0000, v116
v_pk_mul_f32 v[10:11], v[10:11], v[12:13]
v_cvt_pk_bf16_f32 v180, v10, v11
v_lshlrev_b32 v10, 16, v181
v_and_b32 v11, 0xffff0000, v181
v_lshlrev_b32 v12, 16, v117
v_and_b32 v13, 0xffff0000, v117
v_pk_mul_f32 v[10:11], v[10:11], v[12:13]
v_cvt_pk_bf16_f32 v181, v10, v11
v_lshlrev_b32 v10, 16, v182
v_and_b32 v11, 0xffff0000, v182
v_lshlrev_b32 v12, 16, v118
v_and_b32 v13, 0xffff0000, v118
v_pk_mul_f32 v[10:11], v[10:11], v[12:13]
v_cvt_pk_bf16_f32 v182, v10, v11
v_lshlrev_b32 v10, 16, v183
v_and_b32 v11, 0xffff0000, v183
v_lshlrev_b32 v12, 16, v119
v_and_b32 v13, 0xffff0000, v119
v_pk_mul_f32 v[10:11], v[10:11], v[12:13]
v_cvt_pk_bf16_f32 v183, v10, v11
buffer_store_dwordx4 v[180:183], v9, s[12:15], s26 offen offset:320
s_waitcnt vmcnt(13)
v_lshlrev_b32 v10, 16, v184
v_and_b32 v11, 0xffff0000, v184
v_lshlrev_b32 v12, 16, v120
v_and_b32 v13, 0xffff0000, v120
v_pk_mul_f32 v[10:11], v[10:11], v[12:13]
v_cvt_pk_bf16_f32 v184, v10, v11
v_lshlrev_b32 v10, 16, v185
v_and_b32 v11, 0xffff0000, v185
v_lshlrev_b32 v12, 16, v121
v_and_b32 v13, 0xffff0000, v121
v_pk_mul_f32 v[10:11], v[10:11], v[12:13]
v_cvt_pk_bf16_f32 v185, v10, v11
v_lshlrev_b32 v10, 16, v186
v_and_b32 v11, 0xffff0000, v186
v_lshlrev_b32 v12, 16, v122
v_and_b32 v13, 0xffff0000, v122
v_pk_mul_f32 v[10:11], v[10:11], v[12:13]
v_cvt_pk_bf16_f32 v186, v10, v11
v_lshlrev_b32 v10, 16, v187
v_and_b32 v11, 0xffff0000, v187
v_lshlrev_b32 v12, 16, v123
v_and_b32 v13, 0xffff0000, v123
v_pk_mul_f32 v[10:11], v[10:11], v[12:13]
v_cvt_pk_bf16_f32 v187, v10, v11
buffer_store_dwordx4 v[184:187], v9, s[12:15], s26 offen offset:384
s_waitcnt lgkmcnt(0)
s_waitcnt vmcnt(13)
v_lshlrev_b32 v10, 16, v188
v_and_b32 v11, 0xffff0000, v188
v_lshlrev_b32 v12, 16, v124
v_and_b32 v13, 0xffff0000, v124
v_pk_mul_f32 v[10:11], v[10:11], v[12:13]
v_cvt_pk_bf16_f32 v188, v10, v11
v_lshlrev_b32 v10, 16, v189
v_and_b32 v11, 0xffff0000, v189
v_lshlrev_b32 v12, 16, v125
v_and_b32 v13, 0xffff0000, v125
v_pk_mul_f32 v[10:11], v[10:11], v[12:13]
v_cvt_pk_bf16_f32 v189, v10, v11
v_lshlrev_b32 v10, 16, v190
v_and_b32 v11, 0xffff0000, v190
v_lshlrev_b32 v12, 16, v126
v_and_b32 v13, 0xffff0000, v126
v_pk_mul_f32 v[10:11], v[10:11], v[12:13]
v_cvt_pk_bf16_f32 v190, v10, v11
v_lshlrev_b32 v10, 16, v191
v_and_b32 v11, 0xffff0000, v191
v_lshlrev_b32 v12, 16, v127
v_and_b32 v13, 0xffff0000, v127
v_pk_mul_f32 v[10:11], v[10:11], v[12:13]
v_cvt_pk_bf16_f32 v191, v10, v11
buffer_store_dwordx4 v[188:191], v9, s[12:15], s26 offen offset:448
s_waitcnt vmcnt(13)
v_lshlrev_b32 v10, 16, v192
v_and_b32 v11, 0xffff0000, v192
v_lshlrev_b32 v12, 16, v128
v_and_b32 v13, 0xffff0000, v128
v_pk_mul_f32 v[10:11], v[10:11], v[12:13]
v_cvt_pk_bf16_f32 v192, v10, v11
v_lshlrev_b32 v10, 16, v193
v_and_b32 v11, 0xffff0000, v193
v_lshlrev_b32 v12, 16, v129
v_and_b32 v13, 0xffff0000, v129
v_pk_mul_f32 v[10:11], v[10:11], v[12:13]
v_cvt_pk_bf16_f32 v193, v10, v11
v_lshlrev_b32 v10, 16, v194
v_and_b32 v11, 0xffff0000, v194
v_lshlrev_b32 v12, 16, v130
v_and_b32 v13, 0xffff0000, v130
v_pk_mul_f32 v[10:11], v[10:11], v[12:13]
v_cvt_pk_bf16_f32 v194, v10, v11
v_lshlrev_b32 v10, 16, v195
v_and_b32 v11, 0xffff0000, v195
v_lshlrev_b32 v12, 16, v131
v_and_b32 v13, 0xffff0000, v131
v_pk_mul_f32 v[10:11], v[10:11], v[12:13]
v_cvt_pk_bf16_f32 v195, v10, v11
buffer_store_dwordx4 v[192:195], v9, s[12:15], s26 offen offset:512
s_waitcnt vmcnt(13)
v_lshlrev_b32 v10, 16, v196
v_and_b32 v11, 0xffff0000, v196
v_lshlrev_b32 v12, 16, v132
v_and_b32 v13, 0xffff0000, v132
v_pk_mul_f32 v[10:11], v[10:11], v[12:13]
v_cvt_pk_bf16_f32 v196, v10, v11
v_lshlrev_b32 v10, 16, v197
v_and_b32 v11, 0xffff0000, v197
v_lshlrev_b32 v12, 16, v133
v_and_b32 v13, 0xffff0000, v133
v_pk_mul_f32 v[10:11], v[10:11], v[12:13]
v_cvt_pk_bf16_f32 v197, v10, v11
v_lshlrev_b32 v10, 16, v198
v_and_b32 v11, 0xffff0000, v198
v_lshlrev_b32 v12, 16, v134
v_and_b32 v13, 0xffff0000, v134
v_pk_mul_f32 v[10:11], v[10:11], v[12:13]
v_cvt_pk_bf16_f32 v198, v10, v11
v_lshlrev_b32 v10, 16, v199
v_and_b32 v11, 0xffff0000, v199
v_lshlrev_b32 v12, 16, v135
v_and_b32 v13, 0xffff0000, v135
v_pk_mul_f32 v[10:11], v[10:11], v[12:13]
v_cvt_pk_bf16_f32 v199, v10, v11
buffer_store_dwordx4 v[196:199], v9, s[12:15], s26 offen offset:576
s_waitcnt vmcnt(13)
v_lshlrev_b32 v10, 16, v200
v_and_b32 v11, 0xffff0000, v200
v_lshlrev_b32 v12, 16, v136
v_and_b32 v13, 0xffff0000, v136
v_pk_mul_f32 v[10:11], v[10:11], v[12:13]
v_cvt_pk_bf16_f32 v200, v10, v11
v_lshlrev_b32 v10, 16, v201
v_and_b32 v11, 0xffff0000, v201
v_lshlrev_b32 v12, 16, v137
v_and_b32 v13, 0xffff0000, v137
v_pk_mul_f32 v[10:11], v[10:11], v[12:13]
v_cvt_pk_bf16_f32 v201, v10, v11
v_lshlrev_b32 v10, 16, v202
v_and_b32 v11, 0xffff0000, v202
v_lshlrev_b32 v12, 16, v138
v_and_b32 v13, 0xffff0000, v138
v_pk_mul_f32 v[10:11], v[10:11], v[12:13]
v_cvt_pk_bf16_f32 v202, v10, v11
v_lshlrev_b32 v10, 16, v203
v_and_b32 v11, 0xffff0000, v203
v_lshlrev_b32 v12, 16, v139
v_and_b32 v13, 0xffff0000, v139
v_pk_mul_f32 v[10:11], v[10:11], v[12:13]
v_cvt_pk_bf16_f32 v203, v10, v11
buffer_store_dwordx4 v[200:203], v9, s[12:15], s26 offen offset:640
s_waitcnt vmcnt(13)
v_lshlrev_b32 v10, 16, v204
v_and_b32 v11, 0xffff0000, v204
v_lshlrev_b32 v12, 16, v140
v_and_b32 v13, 0xffff0000, v140
v_pk_mul_f32 v[10:11], v[10:11], v[12:13]
v_cvt_pk_bf16_f32 v204, v10, v11
v_lshlrev_b32 v10, 16, v205
v_and_b32 v11, 0xffff0000, v205
v_lshlrev_b32 v12, 16, v141
v_and_b32 v13, 0xffff0000, v141
v_pk_mul_f32 v[10:11], v[10:11], v[12:13]
v_cvt_pk_bf16_f32 v205, v10, v11
v_lshlrev_b32 v10, 16, v206
v_and_b32 v11, 0xffff0000, v206
v_lshlrev_b32 v12, 16, v142
v_and_b32 v13, 0xffff0000, v142
v_pk_mul_f32 v[10:11], v[10:11], v[12:13]
v_cvt_pk_bf16_f32 v206, v10, v11
v_lshlrev_b32 v10, 16, v207
v_and_b32 v11, 0xffff0000, v207
v_lshlrev_b32 v12, 16, v143
v_and_b32 v13, 0xffff0000, v143
v_pk_mul_f32 v[10:11], v[10:11], v[12:13]
v_cvt_pk_bf16_f32 v207, v10, v11
buffer_store_dwordx4 v[204:207], v9, s[12:15], s26 offen offset:704
s_waitcnt vmcnt(13)
v_lshlrev_b32 v10, 16, v208
v_and_b32 v11, 0xffff0000, v208
v_lshlrev_b32 v12, 16, v144
v_and_b32 v13, 0xffff0000, v144
v_pk_mul_f32 v[10:11], v[10:11], v[12:13]
v_cvt_pk_bf16_f32 v208, v10, v11
v_lshlrev_b32 v10, 16, v209
v_and_b32 v11, 0xffff0000, v209
v_lshlrev_b32 v12, 16, v145
v_and_b32 v13, 0xffff0000, v145
v_pk_mul_f32 v[10:11], v[10:11], v[12:13]
v_cvt_pk_bf16_f32 v209, v10, v11
v_lshlrev_b32 v10, 16, v210
v_and_b32 v11, 0xffff0000, v210
v_lshlrev_b32 v12, 16, v146
v_and_b32 v13, 0xffff0000, v146
v_pk_mul_f32 v[10:11], v[10:11], v[12:13]
v_cvt_pk_bf16_f32 v210, v10, v11
v_lshlrev_b32 v10, 16, v211
v_and_b32 v11, 0xffff0000, v211
v_lshlrev_b32 v12, 16, v147
v_and_b32 v13, 0xffff0000, v147
v_pk_mul_f32 v[10:11], v[10:11], v[12:13]
v_cvt_pk_bf16_f32 v211, v10, v11
buffer_store_dwordx4 v[208:211], v9, s[12:15], s26 offen offset:768
s_waitcnt vmcnt(13)
v_lshlrev_b32 v10, 16, v212
v_and_b32 v11, 0xffff0000, v212
v_lshlrev_b32 v12, 16, v148
v_and_b32 v13, 0xffff0000, v148
v_pk_mul_f32 v[10:11], v[10:11], v[12:13]
v_cvt_pk_bf16_f32 v212, v10, v11
v_lshlrev_b32 v10, 16, v213
v_and_b32 v11, 0xffff0000, v213
v_lshlrev_b32 v12, 16, v149
v_and_b32 v13, 0xffff0000, v149
v_pk_mul_f32 v[10:11], v[10:11], v[12:13]
v_cvt_pk_bf16_f32 v213, v10, v11
v_lshlrev_b32 v10, 16, v214
v_and_b32 v11, 0xffff0000, v214
v_lshlrev_b32 v12, 16, v150
v_and_b32 v13, 0xffff0000, v150
v_pk_mul_f32 v[10:11], v[10:11], v[12:13]
v_cvt_pk_bf16_f32 v214, v10, v11
v_lshlrev_b32 v10, 16, v215
v_and_b32 v11, 0xffff0000, v215
v_lshlrev_b32 v12, 16, v151
v_and_b32 v13, 0xffff0000, v151
v_pk_mul_f32 v[10:11], v[10:11], v[12:13]
v_cvt_pk_bf16_f32 v215, v10, v11
buffer_store_dwordx4 v[212:215], v9, s[12:15], s26 offen offset:832
s_branch M_fin
M_fend:
M_rslow:
Lp_9251:
buffer_load_dword v18, v19, s[4:7], s33 offen offset:0 sc1
s_waitcnt vmcnt(0)
v_cmp_gt_u32 vcc, 1, v18
s_cbranch_vccz Lpd_9252
s_sleep 8
s_sub_u32 s101, s101, 1
s_cbranch_scc0 Lp_9251
s_mov_b32 s101, 0
Lpd_9252:
s_branch M_rjoin
M_V:
PAD_21:
s_cbranch_execz PAD_25
v_mfma_f32_16x16x32_bf16 v[32:35], a[0:3], a[128:131], 0
s_add_u32 m0, s29, 98304
ds_read_b64_tr_b16 a[136:137], v5 offset:0
v_mfma_f32_16x16x32_bf16 v[32:35], a[4:7], a[132:135], v[32:35]
s_mov_b32 s32, 1024
buffer_load_dwordx4 v16, s[12:15], s26 offen offset:0 lds
v_mfma_f32_16x16x32_bf16 v[36:39], a[8:11], a[128:131], 0
s_mov_b32 s33, 31744
ds_read_b64_tr_b16 a[138:139], v5 offset:2048
v_mfma_f32_16x16x32_bf16 v[36:39], a[12:15], a[132:135], v[36:39]
s_mov_b32 s34, 4294935552
v_mfma_f32_16x16x32_bf16 v[40:43], a[16:19], a[128:131], 0
s_mov_b32 s35, 4294935552
ds_read_b64_tr_b16 a[140:141], v5 offset:16384
v_mfma_f32_16x16x32_bf16 v[40:43], a[20:23], a[132:135], v[40:43]
s_mov_b32 s36, 4294935552
buffer_load_dwordx4 v17, s[12:15], s26 offen offset:1024 lds
v_mfma_f32_16x16x32_bf16 v[44:47], a[24:27], a[128:131], 0
s_mov_b32 s30, 8
ds_read_b64_tr_b16 a[142:143], v5 offset:18432
v_mfma_f32_16x16x32_bf16 v[44:47], a[28:31], a[132:135], v[44:47]
s_mov_b32 s82, 3221225472
v_mfma_f32_16x16x32_bf16 v[48:51], a[32:35], a[128:131], 0
s_mul_hi_u32 s38, s2, 613566757
v_mfma_f32_16x16x32_bf16 v[48:51], a[36:39], a[132:135], v[48:51]
s_mul_i32 s39, s38, 7
buffer_load_dwordx4 v18, s[12:15], s26 offen offset:2048 lds
v_mfma_f32_16x16x32_bf16 v[52:55], a[40:43], a[128:131], 0
s_sub_u32 s39, s2, s39
v_mov_b32 v246, 0
v_mov_b32 v229, 0
v_mfma_f32_16x16x32_bf16 v[52:55], a[44:47], a[132:135], v[52:55]
v_mov_b32 v231, 0
v_mfma_f32_16x16x32_bf16 v[56:59], a[48:51], a[128:131], 0
s_mov_b32 s60, s90
v_mfma_f32_16x16x32_bf16 v[56:59], a[52:55], a[132:135], v[56:59]
s_mov_b32 s61, s91
buffer_load_dwordx4 v19, s[12:15], s26 offen offset:3072 lds
v_mfma_f32_16x16x32_bf16 v[60:63], a[56:59], a[128:131], 0
s_add_u32 s26, s26, 524288
v_mfma_f32_16x16x32_bf16 v[60:63], a[60:63], a[132:135], v[60:63]
s_waitcnt lgkmcnt(0)
s_mov_b32 s62, 256
v_mfma_f32_16x16x32_bf16 v[64:67], a[0:3], a[136:139], 0
s_add_u32 m0, s29, 114688
ds_read_b64_tr_b16 a[128:129], v6 offset:0
v_mfma_f32_16x16x32_bf16 v[64:67], a[4:7], a[140:143], v[64:67]
s_mov_b32 s63, 0x20000
buffer_load_dwordx4 v16, s[12:15], s27 offen offset:0 lds
v_mfma_f32_16x16x32_bf16 v[68:71], a[8:11], a[136:139], 0
s_mul_hi_u32 s55, s2, 1431655766
ds_read_b64_tr_b16 a[130:131], v6 offset:2048
v_mfma_f32_16x16x32_bf16 v[68:71], a[12:15], a[140:143], v[68:71]
s_mul_i32 s55, s55, 3
v_mfma_f32_16x16x32_bf16 v[72:75], a[16:19], a[136:139], 0
s_sub_u32 s55, s2, s55
ds_read_b64_tr_b16 a[132:133], v6 offset:16384
v_mfma_f32_16x16x32_bf16 v[72:75], a[20:23], a[140:143], v[72:75]
s_add_u32 s55, s55, 5
buffer_load_dwordx4 v17, s[12:15], s27 offen offset:1024 lds
v_mfma_f32_16x16x32_bf16 v[76:79], a[24:27], a[136:139], 0
s_lshr_b32 s22, s2, 4
ds_read_b64_tr_b16 a[134:135], v6 offset:18432
v_mfma_f32_16x16x32_bf16 v[76:79], a[28:31], a[140:143], v[76:79]
s_lshl_b32 s23, s20, 5
v_mfma_f32_16x16x32_bf16 v[80:83], a[32:35], a[136:139], 0
s_add_u32 s23, s23, s22
v_mfma_f32_16x16x32_bf16 v[80:83], a[36:39], a[140:143], v[80:83]
s_lshl_b32 s23, s23, 2
buffer_load_dwordx4 v18, s[12:15], s27 offen offset:2048 lds
v_mfma_f32_16x16x32_bf16 v[84:87], a[40:43], a[136:139], 0
s_and_b32 s22, s2, 16
v_mfma_f32_16x16x32_bf16 v[84:87], a[44:47], a[140:143], v[84:87]
s_lshl_b32 s22, s22, 7
v_mfma_f32_16x16x32_bf16 v[88:91], a[48:51], a[136:139], 0
s_add_u32 s23, s23, s22
v_mov_b32 v28, 3221225472
v_writelane_b32 v28, s23, 0
v_mfma_f32_16x16x32_bf16 v[88:91], a[52:55], a[140:143], v[88:91]
s_add_u32 s56, s23, 16384
buffer_load_dwordx4 v19, s[12:15], s27 offen offset:3072 lds
v_mfma_f32_16x16x32_bf16 v[92:95], a[56:59], a[136:139], 0
s_add_u32 s27, s27, 524288
v_writelane_b32 v28, s56, 1
v_mfma_f32_16x16x32_bf16 v[92:95], a[60:63], a[140:143], v[92:95]
s_waitcnt lgkmcnt(0)
s_add_u32 s56, s23, 4096
v_writelane_b32 v28, s56, 2
v_mfma_f32_16x16x32_bf16 v[96:99], a[0:3], a[128:131], 0
s_add_u32 m0, s28, 0
ds_read_b64_tr_b16 a[136:137], v7 offset:0
v_mfma_f32_16x16x32_bf16 v[96:99], a[4:7], a[132:135], v[96:99]
s_sub_u32 s37, 15, s21
buffer_load_dwordx4 v12, s[8:11], s24 offen offset:0 lds
v_mfma_f32_16x16x32_bf16 v[100:103], a[8:11], a[128:131], 0
ds_read_b64_tr_b16 a[138:139], v7 offset:2048
v_mfma_f32_16x16x32_bf16 v[100:103], a[12:15], a[132:135], v[100:103]
v_mfma_f32_16x16x32_bf16 v[104:107], a[16:19], a[128:131], 0
ds_read_b64_tr_b16 a[140:141], v7 offset:16384
v_mfma_f32_16x16x32_bf16 v[104:107], a[20:23], a[132:135], v[104:107]
buffer_load_dwordx4 v13, s[8:11], s24 offen offset:1024 lds
v_mfma_f32_16x16x32_bf16 v[108:111], a[24:27], a[128:131], 0
ds_read_b64_tr_b16 a[142:143], v7 offset:18432
v_mfma_f32_16x16x32_bf16 v[108:111], a[28:31], a[132:135], v[108:111]
v_mfma_f32_16x16x32_bf16 v[112:115], a[32:35], a[128:131], 0
v_mfma_f32_16x16x32_bf16 v[112:115], a[36:39], a[132:135], v[112:115]
buffer_load_dwordx4 v14, s[8:11], s24 offen offset:2048 lds
v_mfma_f32_16x16x32_bf16 v[116:119], a[40:43], a[128:131], 0
v_mfma_f32_16x16x32_bf16 v[116:119], a[44:47], a[132:135], v[116:119]
v_mfma_f32_16x16x32_bf16 v[120:123], a[48:51], a[128:131], 0
v_mfma_f32_16x16x32_bf16 v[120:123], a[52:55], a[132:135], v[120:123]
buffer_load_dwordx4 v15, s[8:11], s24 offen offset:3072 lds
v_mfma_f32_16x16x32_bf16 v[124:127], a[56:59], a[128:131], 0
s_add_u32 s24, s24, 128
v_mfma_f32_16x16x32_bf16 v[124:127], a[60:63], a[132:135], v[124:127]
s_waitcnt vmcnt(12) lgkmcnt(0)
s_barrier
v_mfma_f32_16x16x32_bf16 v[128:131], a[0:3], a[136:139], 0
s_add_u32 m0, s28, 4096
ds_read_b64_tr_b16 a[128:129], v8 offset:0
v_mfma_f32_16x16x32_bf16 v[128:131], a[4:7], a[140:143], v[128:131]
buffer_load_dwordx4 v12, s[8:11], s25 offen offset:0 lds
v_mfma_f32_16x16x32_bf16 v[132:135], a[8:11], a[136:139], 0
ds_read_b64_tr_b16 a[130:131], v8 offset:2048
v_mfma_f32_16x16x32_bf16 v[132:135], a[12:15], a[140:143], v[132:135]
v_mfma_f32_16x16x32_bf16 v[136:139], a[16:19], a[136:139], 0
ds_read_b64_tr_b16 a[132:133], v8 offset:16384
v_mfma_f32_16x16x32_bf16 v[136:139], a[20:23], a[140:143], v[136:139]
buffer_load_dwordx4 v13, s[8:11], s25 offen offset:1024 lds
v_mfma_f32_16x16x32_bf16 v[140:143], a[24:27], a[136:139], 0
ds_read_b64_tr_b16 a[134:135], v8 offset:18432
v_mfma_f32_16x16x32_bf16 v[140:143], a[28:31], a[140:143], v[140:143]
v_mfma_f32_16x16x32_bf16 v[144:147], a[32:35], a[136:139], 0
ds_read_b128 a[64:67], v2 offset:32768
v_mfma_f32_16x16x32_bf16 v[144:147], a[36:39], a[140:143], v[144:147]
buffer_load_dwordx4 v14, s[8:11], s25 offen offset:2048 lds
v_mfma_f32_16x16x32_bf16 v[148:151], a[40:43], a[136:139], 0
ds_read_b128 a[68:71], v3 offset:32768
v_mfma_f32_16x16x32_bf16 v[148:151], a[44:47], a[140:143], v[148:151]
ds_read_b128 a[72:75], v2 offset:34816
v_mfma_f32_16x16x32_bf16 v[152:155], a[48:51], a[136:139], 0
ds_read_b128 a[76:79], v3 offset:34816
v_mfma_f32_16x16x32_bf16 v[152:155], a[52:55], a[140:143], v[152:155]
buffer_load_dwordx4 v15, s[8:11], s25 offen offset:3072 lds
v_mfma_f32_16x16x32_bf16 v[156:159], a[56:59], a[136:139], 0
s_add_u32 s25, s25, 128
ds_read_b128 a[80:83], v2 offset:36864
v_mfma_f32_16x16x32_bf16 v[156:159], a[60:63], a[140:143], v[156:159]
s_waitcnt lgkmcnt(5)
ds_read_b128 a[84:87], v3 offset:36864
v_mfma_f32_16x16x32_bf16 v[160:163], a[0:3], a[128:131], 0
s_bitcmp1_b32 s2, 4
s_cselect_b32 s37, s21, s37
ds_read_b64_tr_b16 a[136:137], v9 offset:0
v_mfma_f32_16x16x32_bf16 v[160:163], a[4:7], a[132:135], v[160:163]
s_lshl_b32 s56, s37, 5
s_add_u32 s56, s56, s20
s_lshl_b32 s56, s56, 2
v_mfma_f32_16x16x32_bf16 v[164:167], a[8:11], a[128:131], 0
s_add_u32 s56, s56, 8192
ds_read_b64_tr_b16 a[138:139], v9 offset:2048
v_writelane_b32 v28, s56, 3
v_mfma_f32_16x16x32_bf16 v[164:167], a[12:15], a[132:135], v[164:167]
s_add_u32 s56, s56, 2048
v_writelane_b32 v28, s56, 6
v_mfma_f32_16x16x32_bf16 v[168:171], a[16:19], a[128:131], 0
s_add_u32 s56, s56, 4096
ds_read_b64_tr_b16 a[140:141], v9 offset:16384
v_writelane_b32 v28, s56, 5
v_mfma_f32_16x16x32_bf16 v[168:171], a[20:23], a[132:135], v[168:171]
s_lshl_b32 s56, s2, 2
s_add_u32 s56, s56, 12288
v_writelane_b32 v28, s56, 4
v_mfma_f32_16x16x32_bf16 v[172:175], a[24:27], a[128:131], 0
s_lshl_b32 s56, s39, 5
s_add_u32 s56, s56, s38
ds_read_b64_tr_b16 a[142:143], v9 offset:18432
v_mfma_f32_16x16x32_bf16 v[172:175], a[28:31], a[132:135], v[172:175]
s_lshl_b32 s56, s56, 2
s_add_u32 s56, s56, 20480
s_cmp_lt_u32 s2, 224
v_mfma_f32_16x16x32_bf16 v[176:179], a[32:35], a[128:131], 0
s_cselect_b32 s56, s56, 3221225472
v_writelane_b32 v28, s56, 7
v_mfma_f32_16x16x32_bf16 v[176:179], a[36:39], a[132:135], v[176:179]
s_cmp_eq_u32 s3, 0
s_cselect_b32 s56, 94371840, 3221225472
v_mfma_f32_16x16x32_bf16 v[180:183], a[40:43], a[128:131], 0
ds_read_b128 a[88:91], v2 offset:38912
v_mfma_f32_16x16x32_bf16 v[180:183], a[44:47], a[132:135], v[180:183]
ds_read_b128 a[92:95], v3 offset:38912
v_mfma_f32_16x16x32_bf16 v[184:187], a[48:51], a[128:131], 0
ds_read_b128 a[96:99], v2 offset:40960
v_mfma_f32_16x16x32_bf16 v[184:187], a[52:55], a[132:135], v[184:187]
buffer_store_dword v246, v28, s[4:7], s56 offen sc1
v_mfma_f32_16x16x32_bf16 v[188:191], a[56:59], a[128:131], 0
ds_read_b128 a[100:103], v3 offset:40960
v_mov_b32 v27, 1
v_mfma_f32_16x16x32_bf16 v[188:191], a[60:63], a[132:135], v[188:191]
s_waitcnt lgkmcnt(4)
ds_read_b128 a[104:107], v2 offset:43008
v_cmp_eq_u32 vcc, 0, v0
v_mfma_f32_16x16x32_bf16 v[192:195], a[0:3], a[136:139], 0
ds_read_b64_tr_b16 a[128:129], v10 offset:0
v_mov_b32 v26, 3221225472
v_mfma_f32_16x16x32_bf16 v[192:195], a[4:7], a[140:143], v[192:195]
s_lshl_b32 s31, s20, 20
s_lshl_b32 s22, s21, 17
v_cndmask_b32 v26, v26, v246, vcc
v_mfma_f32_16x16x32_bf16 v[196:199], a[8:11], a[136:139], 0
s_add_u32 s31, s31, s22
s_lshr_b32 s22, s3, 1
ds_read_b64_tr_b16 a[130:131], v10 offset:2048
v_mfma_f32_16x16x32_bf16 v[196:199], a[12:15], a[140:143], v[196:199]
s_lshl_b32 s22, s22, 16
s_add_u32 s31, s31, s22
s_and_b32 s22, s3, 1
v_mfma_f32_16x16x32_bf16 v[200:203], a[16:19], a[136:139], 0
s_lshl_b32 s22, s22, 14
s_add_u32 s31, s31, s22
ds_read_b64_tr_b16 a[132:133], v10 offset:16384
v_mfma_f32_16x16x32_bf16 v[200:203], a[20:23], a[140:143], v[200:203]
s_add_u32 s31, s31, 16777216
v_mfma_f32_16x16x32_bf16 v[204:207], a[24:27], a[136:139], 0
ds_read_b64_tr_b16 a[134:135], v10 offset:18432
v_mfma_f32_16x16x32_bf16 v[204:207], a[28:31], a[140:143], v[204:207]
v_mfma_f32_16x16x32_bf16 v[208:211], a[32:35], a[136:139], 0
v_mfma_f32_16x16x32_bf16 v[208:211], a[36:39], a[140:143], v[208:211]
v_mfma_f32_16x16x32_bf16 v[212:215], a[40:43], a[136:139], 0
ds_read_b128 a[108:111], v3 offset:43008
v_mfma_f32_16x16x32_bf16 v[212:215], a[44:47], a[140:143], v[212:215]
ds_read_b128 a[112:115], v2 offset:45056
v_mfma_f32_16x16x32_bf16 v[216:219], a[48:51], a[136:139], 0
ds_read_b128 a[116:119], v3 offset:45056
v_mfma_f32_16x16x32_bf16 v[216:219], a[52:55], a[140:143], v[216:219]
v_mfma_f32_16x16x32_bf16 v[220:223], a[56:59], a[136:139], 0
ds_read_b128 a[120:123], v2 offset:47104
v_mfma_f32_16x16x32_bf16 v[220:223], a[60:63], a[140:143], v[220:223]
s_waitcnt lgkmcnt(4)
ds_read_b128 a[124:127], v3 offset:47104
v_mfma_f32_16x16x32_bf16 a[192:195], a[0:3], a[128:131], 0
ds_read_b64_tr_b16 a[136:137], v11 offset:0
v_mfma_f32_16x16x32_bf16 a[192:195], a[4:7], a[132:135], a[192:195]
v_mfma_f32_16x16x32_bf16 a[196:199], a[8:11], a[128:131], 0
ds_read_b64_tr_b16 a[138:139], v11 offset:2048
v_mfma_f32_16x16x32_bf16 a[196:199], a[12:15], a[132:135], a[196:199]
v_mfma_f32_16x16x32_bf16 a[200:203], a[16:19], a[128:131], 0
ds_read_b64_tr_b16 a[140:141], v11 offset:16384
v_mfma_f32_16x16x32_bf16 a[200:203], a[20:23], a[132:135], a[200:203]
v_mfma_f32_16x16x32_bf16 a[204:207], a[24:27], a[128:131], 0
ds_read_b64_tr_b16 a[142:143], v11 offset:18432
v_mfma_f32_16x16x32_bf16 a[204:207], a[28:31], a[132:135], a[204:207]
v_mfma_f32_16x16x32_bf16 a[208:211], a[32:35], a[128:131], 0
v_mfma_f32_16x16x32_bf16 a[208:211], a[36:39], a[132:135], a[208:211]
v_mfma_f32_16x16x32_bf16 a[212:215], a[40:43], a[128:131], 0
v_mfma_f32_16x16x32_bf16 a[212:215], a[44:47], a[132:135], a[212:215]
v_mfma_f32_16x16x32_bf16 a[216:219], a[48:51], a[128:131], 0
v_mfma_f32_16x16x32_bf16 a[216:219], a[52:55], a[132:135], a[216:219]
v_mfma_f32_16x16x32_bf16 a[220:223], a[56:59], a[128:131], 0
s_waitcnt vmcnt(1) lgkmcnt(0)
v_mfma_f32_16x16x32_bf16 a[220:223], a[60:63], a[132:135], a[220:223]
s_barrier
v_mfma_f32_16x16x32_bf16 a[224:227], a[0:3], a[136:139], 0
s_add_u32 m0, s29, 65536
ds_read_b64_tr_b16 a[128:129], v4 offset:32768
v_mfma_f32_16x16x32_bf16 a[224:227], a[4:7], a[140:143], a[224:227]
buffer_load_dwordx4 v16, s[12:15], s26 offen offset:0 lds
v_mfma_f32_16x16x32_bf16 a[228:231], a[8:11], a[136:139], 0
ds_read_b64_tr_b16 a[130:131], v4 offset:34816
v_mfma_f32_16x16x32_bf16 a[228:231], a[12:15], a[140:143], a[228:231]
v_mfma_f32_16x16x32_bf16 a[232:235], a[16:19], a[136:139], 0
ds_read_b64_tr_b16 a[132:133], v4 offset:49152
v_mfma_f32_16x16x32_bf16 a[232:235], a[20:23], a[140:143], a[232:235]
buffer_load_dwordx4 v17, s[12:15], s26 offen offset:1024 lds
v_mfma_f32_16x16x32_bf16 a[236:239], a[24:27], a[136:139], 0
ds_read_b64_tr_b16 a[134:135], v4 offset:51200
v_mfma_f32_16x16x32_bf16 a[236:239], a[28:31], a[140:143], a[236:239]
v_mfma_f32_16x16x32_bf16 a[240:243], a[32:35], a[136:139], 0
v_mfma_f32_16x16x32_bf16 a[240:243], a[36:39], a[140:143], a[240:243]
buffer_load_dwordx4 v18, s[12:15], s26 offen offset:2048 lds
v_mfma_f32_16x16x32_bf16 a[244:247], a[40:43], a[136:139], 0
v_mfma_f32_16x16x32_bf16 a[244:247], a[44:47], a[140:143], a[244:247]
v_mfma_f32_16x16x32_bf16 a[248:251], a[48:51], a[136:139], 0
v_mfma_f32_16x16x32_bf16 a[248:251], a[52:55], a[140:143], a[248:251]
buffer_load_dwordx4 v19, s[12:15], s26 offen offset:3072 lds
v_mfma_f32_16x16x32_bf16 a[252:255], a[56:59], a[136:139], 0
PAD_22:
s_cbranch_execz PAD_26
s_add_u32 s26, s26, 524288
v_mfma_f32_16x16x32_bf16 a[252:255], a[60:63], a[140:143], a[252:255]
s_waitcnt lgkmcnt(0)
Lg_501:
v_mfma_f32_16x16x32_bf16 v[32:35], a[64:67], a[128:131], v[32:35]
s_add_u32 m0, s29, 81920
ds_read_b64_tr_b16 a[136:137], v5 offset:32768
v_mfma_f32_16x16x32_bf16 v[32:35], a[68:71], a[132:135], v[32:35]
buffer_load_dwordx4 v16, s[12:15], s27 offen offset:0 lds
v_mfma_f32_16x16x32_bf16 v[36:39], a[72:75], a[128:131], v[36:39]
ds_read_b64_tr_b16 a[138:139], v5 offset:34816
v_mfma_f32_16x16x32_bf16 v[36:39], a[76:79], a[132:135], v[36:39]
v_mfma_f32_16x16x32_bf16 v[40:43], a[80:83], a[128:131], v[40:43]
ds_read_b64_tr_b16 a[140:141], v5 offset:49152
v_mfma_f32_16x16x32_bf16 v[40:43], a[84:87], a[132:135], v[40:43]
buffer_load_dwordx4 v17, s[12:15], s27 offen offset:1024 lds
v_mfma_f32_16x16x32_bf16 v[44:47], a[88:91], a[128:131], v[44:47]
ds_read_b64_tr_b16 a[142:143], v5 offset:51200
v_mfma_f32_16x16x32_bf16 v[44:47], a[92:95], a[132:135], v[44:47]
v_mfma_f32_16x16x32_bf16 v[48:51], a[96:99], a[128:131], v[48:51]
ds_read_b128 a[0:3], v2 offset:0
v_mfma_f32_16x16x32_bf16 v[48:51], a[100:103], a[132:135], v[48:51]
buffer_load_dwordx4 v18, s[12:15], s27 offen offset:2048 lds
v_mfma_f32_16x16x32_bf16 v[52:55], a[104:107], a[128:131], v[52:55]
ds_read_b128 a[4:7], v3 offset:0
v_mfma_f32_16x16x32_bf16 v[52:55], a[108:111], a[132:135], v[52:55]
v_mfma_f32_16x16x32_bf16 v[56:59], a[112:115], a[128:131], v[56:59]
v_mfma_f32_16x16x32_bf16 v[56:59], a[116:119], a[132:135], v[56:59]
buffer_load_dwordx4 v19, s[12:15], s27 offen offset:3072 lds
v_mfma_f32_16x16x32_bf16 v[60:63], a[120:123], a[128:131], v[60:63]
s_add_u32 s27, s27, 524288
ds_read_b128 a[8:11], v2 offset:2048
v_mfma_f32_16x16x32_bf16 v[60:63], a[124:127], a[132:135], v[60:63]
s_waitcnt lgkmcnt(3)
v_mfma_f32_16x16x32_bf16 v[64:67], a[64:67], a[136:139], v[64:67]
s_add_u32 m0, s28, 32768
ds_read_b64_tr_b16 a[128:129], v6 offset:32768
v_mfma_f32_16x16x32_bf16 v[64:67], a[68:71], a[140:143], v[64:67]
buffer_load_dwordx4 v12, s[8:11], s24 offen offset:0 lds
v_mfma_f32_16x16x32_bf16 v[68:71], a[72:75], a[136:139], v[68:71]
ds_read_b64_tr_b16 a[130:131], v6 offset:34816
v_mfma_f32_16x16x32_bf16 v[68:71], a[76:79], a[140:143], v[68:71]
v_mfma_f32_16x16x32_bf16 v[72:75], a[80:83], a[136:139], v[72:75]
ds_read_b64_tr_b16 a[132:133], v6 offset:49152
v_mfma_f32_16x16x32_bf16 v[72:75], a[84:87], a[140:143], v[72:75]
buffer_load_dwordx4 v13, s[8:11], s24 offen offset:1024 lds
v_mfma_f32_16x16x32_bf16 v[76:79], a[88:91], a[136:139], v[76:79]
ds_read_b64_tr_b16 a[134:135], v6 offset:51200
v_mfma_f32_16x16x32_bf16 v[76:79], a[92:95], a[140:143], v[76:79]
v_mfma_f32_16x16x32_bf16 v[80:83], a[96:99], a[136:139], v[80:83]
ds_read_b128 a[12:15], v3 offset:2048
v_mfma_f32_16x16x32_bf16 v[80:83], a[100:103], a[140:143], v[80:83]
buffer_load_dwordx4 v14, s[8:11], s24 offen offset:2048 lds
v_mfma_f32_16x16x32_bf16 v[84:87], a[104:107], a[136:139], v[84:87]
v_mfma_f32_16x16x32_bf16 v[84:87], a[108:111], a[140:143], v[84:87]
v_mfma_f32_16x16x32_bf16 v[88:91], a[112:115], a[136:139], v[88:91]
ds_read_b128 a[16:19], v2 offset:4096
v_mfma_f32_16x16x32_bf16 v[88:91], a[116:119], a[140:143], v[88:91]
buffer_load_dwordx4 v15, s[8:11], s24 offen offset:3072 lds
v_mfma_f32_16x16x32_bf16 v[92:95], a[120:123], a[136:139], v[92:95]
s_add_u32 s24, s24, 128
ds_read_b128 a[20:23], v3 offset:4096
v_mfma_f32_16x16x32_bf16 v[92:95], a[124:127], a[140:143], v[92:95]
s_waitcnt lgkmcnt(3)
v_mfma_f32_16x16x32_bf16 v[96:99], a[64:67], a[128:131], v[96:99]
s_add_u32 m0, s28, 36864
ds_read_b64_tr_b16 a[136:137], v7 offset:32768
v_mfma_f32_16x16x32_bf16 v[96:99], a[68:71], a[132:135], v[96:99]
buffer_load_dwordx4 v12, s[8:11], s25 offen offset:0 lds
v_mfma_f32_16x16x32_bf16 v[100:103], a[72:75], a[128:131], v[100:103]
ds_read_b64_tr_b16 a[138:139], v7 offset:34816
v_mfma_f32_16x16x32_bf16 v[100:103], a[76:79], a[132:135], v[100:103]
v_mfma_f32_16x16x32_bf16 v[104:107], a[80:83], a[128:131], v[104:107]
ds_read_b64_tr_b16 a[140:141], v7 offset:49152
v_mfma_f32_16x16x32_bf16 v[104:107], a[84:87], a[132:135], v[104:107]
buffer_load_dwordx4 v13, s[8:11], s25 offen offset:1024 lds
v_mfma_f32_16x16x32_bf16 v[108:111], a[88:91], a[128:131], v[108:111]
ds_read_b64_tr_b16 a[142:143], v7 offset:51200
v_mfma_f32_16x16x32_bf16 v[108:111], a[92:95], a[132:135], v[108:111]
v_mfma_f32_16x16x32_bf16 v[112:115], a[96:99], a[128:131], v[112:115]
v_mfma_f32_16x16x32_bf16 v[112:115], a[100:103], a[132:135], v[112:115]
buffer_load_dwordx4 v14, s[8:11], s25 offen offset:2048 lds
v_mfma_f32_16x16x32_bf16 v[116:119], a[104:107], a[128:131], v[116:119]
ds_read_b128 a[24:27], v2 offset:6144
v_mfma_f32_16x16x32_bf16 v[116:119], a[108:111], a[132:135], v[116:119]
v_mfma_f32_16x16x32_bf16 v[120:123], a[112:115], a[128:131], v[120:123]
ds_read_b128 a[28:31], v3 offset:6144
v_mfma_f32_16x16x32_bf16 v[120:123], a[116:119], a[132:135], v[120:123]
buffer_load_dwordx4 v15, s[8:11], s25 offen offset:3072 lds
v_mfma_f32_16x16x32_bf16 v[124:127], a[120:123], a[128:131], v[124:127]
s_add_u32 s25, s25, 128
v_mfma_f32_16x16x32_bf16 v[124:127], a[124:127], a[132:135], v[124:127]
s_waitcnt lgkmcnt(2)
v_mfma_f32_16x16x32_bf16 v[128:131], a[64:67], a[136:139], v[128:131]
ds_read_b64_tr_b16 a[128:129], v8 offset:32768
v_mfma_f32_16x16x32_bf16 v[128:131], a[68:71], a[140:143], v[128:131]
buffer_load_dword v21, v20, s[16:19], s43 offen
v_mfma_f32_16x16x32_bf16 v[132:135], a[72:75], a[136:139], v[132:135]
s_add_u32 s43, s43, s47
ds_read_b64_tr_b16 a[130:131], v8 offset:34816
v_mfma_f32_16x16x32_bf16 v[132:135], a[76:79], a[140:143], v[132:135]
s_cmp_ge_u32 s43, s51
v_mfma_f32_16x16x32_bf16 v[136:139], a[80:83], a[136:139], v[136:139]
s_cselect_b32 s43, 0, s43
ds_read_b64_tr_b16 a[132:133], v8 offset:49152
v_mfma_f32_16x16x32_bf16 v[136:139], a[84:87], a[140:143], v[136:139]
s_cselect_b32 s51, s42, s51
v_mfma_f32_16x16x32_bf16 v[140:143], a[88:91], a[136:139], v[140:143]
s_cselect_b64 s[16:17], s[40:41], s[16:17]
ds_read_b64_tr_b16 a[134:135], v8 offset:51200
v_mfma_f32_16x16x32_bf16 v[140:143], a[92:95], a[140:143], v[140:143]
s_cselect_b32 s18, s42, s18
v_mfma_f32_16x16x32_bf16 v[144:147], a[96:99], a[136:139], v[144:147]
s_cselect_b64 s[40:41], s[44:45], s[40:41]
ds_read_b128 a[32:35], v2 offset:8192
v_mfma_f32_16x16x32_bf16 v[144:147], a[100:103], a[140:143], v[144:147]
s_cselect_b32 s42, s46, s42
v_mfma_f32_16x16x32_bf16 v[148:151], a[104:107], a[136:139], v[148:151]
s_cselect_b32 s46, 0, s46
v_mfma_f32_16x16x32_bf16 v[148:151], a[108:111], a[140:143], v[148:151]
s_cmp_eq_u32 s30, s55
v_mfma_f32_16x16x32_bf16 v[152:155], a[112:115], a[136:139], v[152:155]
s_cselect_b32 s22, 0, 3221225472
ds_read_b128 a[36:39], v3 offset:8192
v_mfma_f32_16x16x32_bf16 v[152:155], a[116:119], a[140:143], v[152:155]
s_sub_u32 s30, s30, 1
buffer_atomic_add v27, v26, s[60:63], s22 offen sc1
v_mfma_f32_16x16x32_bf16 v[156:159], a[120:123], a[136:139], v[156:159]
ds_read_b128 a[40:43], v2 offset:10240
v_mfma_f32_16x16x32_bf16 v[156:159], a[124:127], a[140:143], v[156:159]
s_waitcnt lgkmcnt(3)
v_mfma_f32_16x16x32_bf16 v[160:163], a[64:67], a[128:131], v[160:163]
ds_read_b64_tr_b16 a[136:137], v9 offset:32768
v_mfma_f32_16x16x32_bf16 v[160:163], a[68:71], a[132:135], v[160:163]
v_mfma_f32_16x16x32_bf16 v[164:167], a[72:75], a[128:131], v[164:167]
ds_read_b64_tr_b16 a[138:139], v9 offset:34816
v_mfma_f32_16x16x32_bf16 v[164:167], a[76:79], a[132:135], v[164:167]
v_mfma_f32_16x16x32_bf16 v[168:171], a[80:83], a[128:131], v[168:171]
ds_read_b64_tr_b16 a[140:141], v9 offset:49152
v_mfma_f32_16x16x32_bf16 v[168:171], a[84:87], a[132:135], v[168:171]
v_mfma_f32_16x16x32_bf16 v[172:175], a[88:91], a[128:131], v[172:175]
ds_read_b64_tr_b16 a[142:143], v9 offset:51200
v_mfma_f32_16x16x32_bf16 v[172:175], a[92:95], a[132:135], v[172:175]
v_mfma_f32_16x16x32_bf16 v[176:179], a[96:99], a[128:131], v[176:179]
v_mfma_f32_16x16x32_bf16 v[176:179], a[100:103], a[132:135], v[176:179]
v_mfma_f32_16x16x32_bf16 v[180:183], a[104:107], a[128:131], v[180:183]
ds_read_b128 a[44:47], v3 offset:10240
v_mfma_f32_16x16x32_bf16 v[180:183], a[108:111], a[132:135], v[180:183]
v_mfma_f32_16x16x32_bf16 v[184:187], a[112:115], a[128:131], v[184:187]
ds_read_b128 a[48:51], v2 offset:12288
v_mfma_f32_16x16x32_bf16 v[184:187], a[116:119], a[132:135], v[184:187]
v_mfma_f32_16x16x32_bf16 v[188:191], a[120:123], a[128:131], v[188:191]
v_mfma_f32_16x16x32_bf16 v[188:191], a[124:127], a[132:135], v[188:191]
s_waitcnt lgkmcnt(2)
v_mfma_f32_16x16x32_bf16 v[192:195], a[64:67], a[136:139], v[192:195]
ds_read_b64_tr_b16 a[128:129], v10 offset:32768
v_mfma_f32_16x16x32_bf16 v[192:195], a[68:71], a[140:143], v[192:195]
v_mfma_f32_16x16x32_bf16 v[196:199], a[72:75], a[136:139], v[196:199]
ds_read_b64_tr_b16 a[130:131], v10 offset:34816
v_mfma_f32_16x16x32_bf16 v[196:199], a[76:79], a[140:143], v[196:199]
v_mfma_f32_16x16x32_bf16 v[200:203], a[80:83], a[136:139], v[200:203]
ds_read_b64_tr_b16 a[132:133], v10 offset:49152
v_mfma_f32_16x16x32_bf16 v[200:203], a[84:87], a[140:143], v[200:203]
v_mfma_f32_16x16x32_bf16 v[204:207], a[88:91], a[136:139], v[204:207]
ds_read_b64_tr_b16 a[134:135], v10 offset:51200
v_mfma_f32_16x16x32_bf16 v[204:207], a[92:95], a[140:143], v[204:207]
v_mfma_f32_16x16x32_bf16 v[208:211], a[96:99], a[136:139], v[208:211]
ds_read_b128 a[52:55], v3 offset:12288
v_mfma_f32_16x16x32_bf16 v[208:211], a[100:103], a[140:143], v[208:211]
v_mfma_f32_16x16x32_bf16 v[212:215], a[104:107], a[136:139], v[212:215]
ds_read_b128 a[56:59], v2 offset:14336
v_mfma_f32_16x16x32_bf16 v[212:215], a[108:111], a[140:143], v[212:215]
v_mfma_f32_16x16x32_bf16 v[216:219], a[112:115], a[136:139], v[216:219]
v_mfma_f32_16x16x32_bf16 v[216:219], a[116:119], a[140:143], v[216:219]
v_mfma_f32_16x16x32_bf16 v[220:223], a[120:123], a[136:139], v[220:223]
ds_read_b128 a[60:63], v3 offset:14336
v_mfma_f32_16x16x32_bf16 v[220:223], a[124:127], a[140:143], v[220:223]
s_waitcnt lgkmcnt(3)
v_mfma_f32_16x16x32_bf16 a[192:195], a[64:67], a[128:131], a[192:195]
ds_read_b64_tr_b16 a[136:137], v11 offset:32768
v_mfma_f32_16x16x32_bf16 a[192:195], a[68:71], a[132:135], a[192:195]
v_mfma_f32_16x16x32_bf16 a[196:199], a[72:75], a[128:131], a[196:199]
ds_read_b64_tr_b16 a[138:139], v11 offset:34816
v_mfma_f32_16x16x32_bf16 a[196:199], a[76:79], a[132:135], a[196:199]
v_mfma_f32_16x16x32_bf16 a[200:203], a[80:83], a[128:131], a[200:203]
ds_read_b64_tr_b16 a[140:141], v11 offset:49152
v_mfma_f32_16x16x32_bf16 a[200:203], a[84:87], a[132:135], a[200:203]
v_mfma_f32_16x16x32_bf16 a[204:207], a[88:91], a[128:131], a[204:207]
ds_read_b64_tr_b16 a[142:143], v11 offset:51200
v_mfma_f32_16x16x32_bf16 a[204:207], a[92:95], a[132:135], a[204:207]
v_mfma_f32_16x16x32_bf16 a[208:211], a[96:99], a[128:131], a[208:211]
v_mfma_f32_16x16x32_bf16 a[208:211], a[100:103], a[132:135], a[208:211]
v_mfma_f32_16x16x32_bf16 a[212:215], a[104:107], a[128:131], a[212:215]
v_mfma_f32_16x16x32_bf16 a[212:215], a[108:111], a[132:135], a[212:215]
v_mfma_f32_16x16x32_bf16 a[216:219], a[112:115], a[128:131], a[216:219]
v_mfma_f32_16x16x32_bf16 a[216:219], a[116:119], a[132:135], a[216:219]
v_mfma_f32_16x16x32_bf16 a[220:223], a[120:123], a[128:131], a[220:223]
s_waitcnt vmcnt(2) lgkmcnt(0)
v_mfma_f32_16x16x32_bf16 a[220:223], a[124:127], a[132:135], a[220:223]
s_barrier
v_mfma_f32_16x16x32_bf16 a[224:227], a[64:67], a[136:139], a[224:227]
s_add_u32 m0, s29, 98304
ds_read_b64_tr_b16 a[128:129], v4 offset:0
v_mfma_f32_16x16x32_bf16 a[224:227], a[68:71], a[140:143], a[224:227]
buffer_load_dwordx4 v16, s[12:15], s26 offen offset:0 lds
v_mfma_f32_16x16x32_bf16 a[228:231], a[72:75], a[136:139], a[228:231]
ds_read_b64_tr_b16 a[130:131], v4 offset:2048
v_mfma_f32_16x16x32_bf16 a[228:231], a[76:79], a[140:143], a[228:231]
v_mfma_f32_16x16x32_bf16 a[232:235], a[80:83], a[136:139], a[232:235]
ds_read_b64_tr_b16 a[132:133], v4 offset:16384
v_mfma_f32_16x16x32_bf16 a[232:235], a[84:87], a[140:143], a[232:235]
buffer_load_dwordx4 v17, s[12:15], s26 offen offset:1024 lds
v_mfma_f32_16x16x32_bf16 a[236:239], a[88:91], a[136:139], a[236:239]
ds_read_b64_tr_b16 a[134:135], v4 offset:18432
v_mfma_f32_16x16x32_bf16 a[236:239], a[92:95], a[140:143], a[236:239]
v_mfma_f32_16x16x32_bf16 a[240:243], a[96:99], a[136:139], a[240:243]
v_mfma_f32_16x16x32_bf16 a[240:243], a[100:103], a[140:143], a[240:243]
buffer_load_dwordx4 v18, s[12:15], s26 offen offset:2048 lds
v_mfma_f32_16x16x32_bf16 a[244:247], a[104:107], a[136:139], a[244:247]
v_mfma_f32_16x16x32_bf16 a[244:247], a[108:111], a[140:143], a[244:247]
v_mfma_f32_16x16x32_bf16 a[248:251], a[112:115], a[136:139], a[248:251]
v_mfma_f32_16x16x32_bf16 a[248:251], a[116:119], a[140:143], a[248:251]
buffer_load_dwordx4 v19, s[12:15], s26 offen offset:3072 lds
v_mfma_f32_16x16x32_bf16 a[252:255], a[120:123], a[136:139], a[252:255]
s_add_u32 s26, s26, 524288
v_mfma_f32_16x16x32_bf16 a[252:255], a[124:127], a[140:143], a[252:255]
s_waitcnt lgkmcnt(0)
buffer_store_dword v27, v26, s[4:7], s82 offen sc1
v_mfma_f32_16x16x32_bf16 v[32:35], a[0:3], a[128:131], v[32:35]
s_add_u32 m0, s29, 114688
ds_read_b64_tr_b16 a[136:137], v5 offset:0
v_mfma_f32_16x16x32_bf16 v[32:35], a[4:7], a[132:135], v[32:35]
buffer_load_dwordx4 v16, s[12:15], s27 offen offset:0 lds
v_mfma_f32_16x16x32_bf16 v[36:39], a[8:11], a[128:131], v[36:39]
ds_read_b64_tr_b16 a[138:139], v5 offset:2048
v_mfma_f32_16x16x32_bf16 v[36:39], a[12:15], a[132:135], v[36:39]
v_mfma_f32_16x16x32_bf16 v[40:43], a[16:19], a[128:131], v[40:43]
ds_read_b64_tr_b16 a[140:141], v5 offset:16384
v_mfma_f32_16x16x32_bf16 v[40:43], a[20:23], a[132:135], v[40:43]
buffer_load_dwordx4 v17, s[12:15], s27 offen offset:1024 lds
v_mfma_f32_16x16x32_bf16 v[44:47], a[24:27], a[128:131], v[44:47]
ds_read_b64_tr_b16 a[142:143], v5 offset:18432
v_mfma_f32_16x16x32_bf16 v[44:47], a[28:31], a[132:135], v[44:47]
v_mfma_f32_16x16x32_bf16 v[48:51], a[32:35], a[128:131], v[48:51]
ds_read_b128 a[64:67], v2 offset:32768
v_mfma_f32_16x16x32_bf16 v[48:51], a[36:39], a[132:135], v[48:51]
buffer_load_dwordx4 v18, s[12:15], s27 offen offset:2048 lds
v_mfma_f32_16x16x32_bf16 v[52:55], a[40:43], a[128:131], v[52:55]
ds_read_b128 a[68:71], v3 offset:32768
v_mfma_f32_16x16x32_bf16 v[52:55], a[44:47], a[132:135], v[52:55]
v_mfma_f32_16x16x32_bf16 v[56:59], a[48:51], a[128:131], v[56:59]
v_mfma_f32_16x16x32_bf16 v[56:59], a[52:55], a[132:135], v[56:59]
buffer_load_dwordx4 v19, s[12:15], s27 offen offset:3072 lds
v_mfma_f32_16x16x32_bf16 v[60:63], a[56:59], a[128:131], v[60:63]
s_add_u32 s27, s27, 524288
ds_read_b128 a[72:75], v2 offset:34816
v_mfma_f32_16x16x32_bf16 v[60:63], a[60:63], a[132:135], v[60:63]
s_waitcnt lgkmcnt(3)
v_mfma_f32_16x16x32_bf16 v[64:67], a[0:3], a[136:139], v[64:67]
s_add_u32 m0, s28, 0
ds_read_b64_tr_b16 a[128:129], v6 offset:0
v_mfma_f32_16x16x32_bf16 v[64:67], a[4:7], a[140:143], v[64:67]
buffer_load_dwordx4 v12, s[8:11], s24 offen offset:0 lds
v_mfma_f32_16x16x32_bf16 v[68:71], a[8:11], a[136:139], v[68:71]
ds_read_b64_tr_b16 a[130:131], v6 offset:2048
v_mfma_f32_16x16x32_bf16 v[68:71], a[12:15], a[140:143], v[68:71]
v_mfma_f32_16x16x32_bf16 v[72:75], a[16:19], a[136:139], v[72:75]
ds_read_b64_tr_b16 a[132:133], v6 offset:16384
v_mfma_f32_16x16x32_bf16 v[72:75], a[20:23], a[140:143], v[72:75]
buffer_load_dwordx4 v13, s[8:11], s24 offen offset:1024 lds
v_mfma_f32_16x16x32_bf16 v[76:79], a[24:27], a[136:139], v[76:79]
ds_read_b64_tr_b16 a[134:135], v6 offset:18432
v_mfma_f32_16x16x32_bf16 v[76:79], a[28:31], a[140:143], v[76:79]
v_mfma_f32_16x16x32_bf16 v[80:83], a[32:35], a[136:139], v[80:83]
ds_read_b128 a[76:79], v3 offset:34816
v_mfma_f32_16x16x32_bf16 v[80:83], a[36:39], a[140:143], v[80:83]
buffer_load_dwordx4 v14, s[8:11], s24 offen offset:2048 lds
v_mfma_f32_16x16x32_bf16 v[84:87], a[40:43], a[136:139], v[84:87]
v_mfma_f32_16x16x32_bf16 v[84:87], a[44:47], a[140:143], v[84:87]
v_mfma_f32_16x16x32_bf16 v[88:91], a[48:51], a[136:139], v[88:91]
ds_read_b128 a[80:83], v2 offset:36864
v_mfma_f32_16x16x32_bf16 v[88:91], a[52:55], a[140:143], v[88:91]
buffer_load_dwordx4 v15, s[8:11], s24 offen offset:3072 lds
v_mfma_f32_16x16x32_bf16 v[92:95], a[56:59], a[136:139], v[92:95]
s_add_u32 s24, s24, 128
ds_read_b128 a[84:87], v3 offset:36864
v_mfma_f32_16x16x32_bf16 v[92:95], a[60:63], a[140:143], v[92:95]
s_waitcnt lgkmcnt(3)
v_mfma_f32_16x16x32_bf16 v[96:99], a[0:3], a[128:131], v[96:99]
s_add_u32 m0, s28, 4096
ds_read_b64_tr_b16 a[136:137], v7 offset:0
v_mfma_f32_16x16x32_bf16 v[96:99], a[4:7], a[132:135], v[96:99]
buffer_load_dwordx4 v12, s[8:11], s25 offen offset:0 lds
v_mfma_f32_16x16x32_bf16 v[100:103], a[8:11], a[128:131], v[100:103]
ds_read_b64_tr_b16 a[138:139], v7 offset:2048
v_mfma_f32_16x16x32_bf16 v[100:103], a[12:15], a[132:135], v[100:103]
v_mfma_f32_16x16x32_bf16 v[104:107], a[16:19], a[128:131], v[104:107]
ds_read_b64_tr_b16 a[140:141], v7 offset:16384
v_mfma_f32_16x16x32_bf16 v[104:107], a[20:23], a[132:135], v[104:107]
buffer_load_dwordx4 v13, s[8:11], s25 offen offset:1024 lds
v_mfma_f32_16x16x32_bf16 v[108:111], a[24:27], a[128:131], v[108:111]
ds_read_b64_tr_b16 a[142:143], v7 offset:18432
v_mfma_f32_16x16x32_bf16 v[108:111], a[28:31], a[132:135], v[108:111]
v_mfma_f32_16x16x32_bf16 v[112:115], a[32:35], a[128:131], v[112:115]
v_mfma_f32_16x16x32_bf16 v[112:115], a[36:39], a[132:135], v[112:115]
buffer_load_dwordx4 v14, s[8:11], s25 offen offset:2048 lds
v_mfma_f32_16x16x32_bf16 v[116:119], a[40:43], a[128:131], v[116:119]
ds_read_b128 a[88:91], v2 offset:38912
v_mfma_f32_16x16x32_bf16 v[116:119], a[44:47], a[132:135], v[116:119]
v_mfma_f32_16x16x32_bf16 v[120:123], a[48:51], a[128:131], v[120:123]
ds_read_b128 a[92:95], v3 offset:38912
v_mfma_f32_16x16x32_bf16 v[120:123], a[52:55], a[132:135], v[120:123]
buffer_load_dwordx4 v15, s[8:11], s25 offen offset:3072 lds
v_mfma_f32_16x16x32_bf16 v[124:127], a[56:59], a[128:131], v[124:127]
s_add_u32 s25, s25, 128
v_mfma_f32_16x16x32_bf16 v[124:127], a[60:63], a[132:135], v[124:127]
s_waitcnt lgkmcnt(2)
v_mfma_f32_16x16x32_bf16 v[128:131], a[0:3], a[136:139], v[128:131]
ds_read_b64_tr_b16 a[128:129], v8 offset:0
v_mfma_f32_16x16x32_bf16 v[128:131], a[4:7], a[140:143], v[128:131]
buffer_load_dword v21, v20, s[16:19], s43 offen
v_mfma_f32_16x16x32_bf16 v[132:135], a[8:11], a[136:139], v[132:135]
s_add_u32 s43, s43, s47
ds_read_b64_tr_b16 a[130:131], v8 offset:2048
v_mfma_f32_16x16x32_bf16 v[132:135], a[12:15], a[140:143], v[132:135]
s_cmp_ge_u32 s43, s51
v_mfma_f32_16x16x32_bf16 v[136:139], a[16:19], a[136:139], v[136:139]
s_cselect_b32 s43, 0, s43
ds_read_b64_tr_b16 a[132:133], v8 offset:16384
v_mfma_f32_16x16x32_bf16 v[136:139], a[20:23], a[140:143], v[136:139]
s_cselect_b32 s51, s42, s51
v_mfma_f32_16x16x32_bf16 v[140:143], a[24:27], a[136:139], v[140:143]
s_cselect_b64 s[16:17], s[40:41], s[16:17]
ds_read_b64_tr_b16 a[134:135], v8 offset:18432
v_mfma_f32_16x16x32_bf16 v[140:143], a[28:31], a[140:143], v[140:143]
s_cselect_b32 s18, s42, s18
v_mfma_f32_16x16x32_bf16 v[144:147], a[32:35], a[136:139], v[144:147]
s_cselect_b64 s[40:41], s[44:45], s[40:41]
ds_read_b128 a[96:99], v2 offset:40960
v_mfma_f32_16x16x32_bf16 v[144:147], a[36:39], a[140:143], v[144:147]
s_cselect_b32 s42, s46, s42
v_mfma_f32_16x16x32_bf16 v[148:151], a[40:43], a[136:139], v[148:151]
s_cselect_b32 s46, 0, s46
v_mfma_f32_16x16x32_bf16 v[148:151], a[44:47], a[140:143], v[148:151]
s_cmp_eq_u32 s30, s55
v_mfma_f32_16x16x32_bf16 v[152:155], a[48:51], a[136:139], v[152:155]
s_cselect_b32 s22, 0, 3221225472
ds_read_b128 a[100:103], v3 offset:40960
v_mfma_f32_16x16x32_bf16 v[152:155], a[52:55], a[140:143], v[152:155]
s_sub_u32 s30, s30, 1
buffer_atomic_add v27, v26, s[60:63], s22 offen sc1
v_mfma_f32_16x16x32_bf16 v[156:159], a[56:59], a[136:139], v[156:159]
ds_read_b128 a[104:107], v2 offset:43008
v_mfma_f32_16x16x32_bf16 v[156:159], a[60:63], a[140:143], v[156:159]
s_waitcnt lgkmcnt(3)
v_mfma_f32_16x16x32_bf16 v[160:163], a[0:3], a[128:131], v[160:163]
ds_read_b64_tr_b16 a[136:137], v9 offset:0
v_mfma_f32_16x16x32_bf16 v[160:163], a[4:7], a[132:135], v[160:163]
v_mfma_f32_16x16x32_bf16 v[164:167], a[8:11], a[128:131], v[164:167]
ds_read_b64_tr_b16 a[138:139], v9 offset:2048
v_mfma_f32_16x16x32_bf16 v[164:167], a[12:15], a[132:135], v[164:167]
v_mfma_f32_16x16x32_bf16 v[168:171], a[16:19], a[128:131], v[168:171]
ds_read_b64_tr_b16 a[140:141], v9 offset:16384
v_mfma_f32_16x16x32_bf16 v[168:171], a[20:23], a[132:135], v[168:171]
v_mfma_f32_16x16x32_bf16 v[172:175], a[24:27], a[128:131], v[172:175]
ds_read_b64_tr_b16 a[142:143], v9 offset:18432
v_mfma_f32_16x16x32_bf16 v[172:175], a[28:31], a[132:135], v[172:175]
v_mfma_f32_16x16x32_bf16 v[176:179], a[32:35], a[128:131], v[176:179]
v_mfma_f32_16x16x32_bf16 v[176:179], a[36:39], a[132:135], v[176:179]
v_mfma_f32_16x16x32_bf16 v[180:183], a[40:43], a[128:131], v[180:183]
ds_read_b128 a[108:111], v3 offset:43008
v_mfma_f32_16x16x32_bf16 v[180:183], a[44:47], a[132:135], v[180:183]
v_mfma_f32_16x16x32_bf16 v[184:187], a[48:51], a[128:131], v[184:187]
ds_read_b128 a[112:115], v2 offset:45056
v_mfma_f32_16x16x32_bf16 v[184:187], a[52:55], a[132:135], v[184:187]
v_mfma_f32_16x16x32_bf16 v[188:191], a[56:59], a[128:131], v[188:191]
v_mfma_f32_16x16x32_bf16 v[188:191], a[60:63], a[132:135], v[188:191]
s_waitcnt lgkmcnt(2)
v_mfma_f32_16x16x32_bf16 v[192:195], a[0:3], a[136:139], v[192:195]
ds_read_b64_tr_b16 a[128:129], v10 offset:0
v_mfma_f32_16x16x32_bf16 v[192:195], a[4:7], a[140:143], v[192:195]
v_mfma_f32_16x16x32_bf16 v[196:199], a[8:11], a[136:139], v[196:199]
ds_read_b64_tr_b16 a[130:131], v10 offset:2048
v_mfma_f32_16x16x32_bf16 v[196:199], a[12:15], a[140:143], v[196:199]
v_mfma_f32_16x16x32_bf16 v[200:203], a[16:19], a[136:139], v[200:203]
ds_read_b64_tr_b16 a[132:133], v10 offset:16384
v_mfma_f32_16x16x32_bf16 v[200:203], a[20:23], a[140:143], v[200:203]
v_mfma_f32_16x16x32_bf16 v[204:207], a[24:27], a[136:139], v[204:207]
ds_read_b64_tr_b16 a[134:135], v10 offset:18432
v_mfma_f32_16x16x32_bf16 v[204:207], a[28:31], a[140:143], v[204:207]
v_mfma_f32_16x16x32_bf16 v[208:211], a[32:35], a[136:139], v[208:211]
ds_read_b128 a[116:119], v3 offset:45056
v_mfma_f32_16x16x32_bf16 v[208:211], a[36:39], a[140:143], v[208:211]
v_mfma_f32_16x16x32_bf16 v[212:215], a[40:43], a[136:139], v[212:215]
ds_read_b128 a[120:123], v2 offset:47104
v_mfma_f32_16x16x32_bf16 v[212:215], a[44:47], a[140:143], v[212:215]
v_mfma_f32_16x16x32_bf16 v[216:219], a[48:51], a[136:139], v[216:219]
v_mfma_f32_16x16x32_bf16 v[216:219], a[52:55], a[140:143], v[216:219]
v_mfma_f32_16x16x32_bf16 v[220:223], a[56:59], a[136:139], v[220:223]
ds_read_b128 a[124:127], v3 offset:47104
v_mfma_f32_16x16x32_bf16 v[220:223], a[60:63], a[140:143], v[220:223]
s_waitcnt lgkmcnt(3)
v_mfma_f32_16x16x32_bf16 a[192:195], a[0:3], a[128:131], a[192:195]
ds_read_b64_tr_b16 a[136:137], v11 offset:0
v_mfma_f32_16x16x32_bf16 a[192:195], a[4:7], a[132:135], a[192:195]
v_mfma_f32_16x16x32_bf16 a[196:199], a[8:11], a[128:131], a[196:199]
ds_read_b64_tr_b16 a[138:139], v11 offset:2048
v_mfma_f32_16x16x32_bf16 a[196:199], a[12:15], a[132:135], a[196:199]
v_mfma_f32_16x16x32_bf16 a[200:203], a[16:19], a[128:131], a[200:203]
ds_read_b64_tr_b16 a[140:141], v11 offset:16384
v_mfma_f32_16x16x32_bf16 a[200:203], a[20:23], a[132:135], a[200:203]
v_mfma_f32_16x16x32_bf16 a[204:207], a[24:27], a[128:131], a[204:207]
ds_read_b64_tr_b16 a[142:143], v11 offset:18432
v_mfma_f32_16x16x32_bf16 a[204:207], a[28:31], a[132:135], a[204:207]
v_mfma_f32_16x16x32_bf16 a[208:211], a[32:35], a[128:131], a[208:211]
v_mfma_f32_16x16x32_bf16 a[208:211], a[36:39], a[132:135], a[208:211]
v_mfma_f32_16x16x32_bf16 a[212:215], a[40:43], a[128:131], a[212:215]
v_mfma_f32_16x16x32_bf16 a[212:215], a[44:47], a[132:135], a[212:215]
v_mfma_f32_16x16x32_bf16 a[216:219], a[48:51], a[128:131], a[216:219]
v_mfma_f32_16x16x32_bf16 a[216:219], a[52:55], a[132:135], a[216:219]
v_mfma_f32_16x16x32_bf16 a[220:223], a[56:59], a[128:131], a[220:223]
s_waitcnt vmcnt(2) lgkmcnt(0)
v_mfma_f32_16x16x32_bf16 a[220:223], a[60:63], a[132:135], a[220:223]
s_barrier
v_mfma_f32_16x16x32_bf16 a[224:227], a[0:3], a[136:139], a[224:227]
s_add_u32 m0, s29, 65536
ds_read_b64_tr_b16 a[128:129], v4 offset:32768
v_mfma_f32_16x16x32_bf16 a[224:227], a[4:7], a[140:143], a[224:227]
buffer_load_dwordx4 v16, s[12:15], s26 offen offset:0 lds
v_mfma_f32_16x16x32_bf16 a[228:231], a[8:11], a[136:139], a[228:231]
ds_read_b64_tr_b16 a[130:131], v4 offset:34816
v_mfma_f32_16x16x32_bf16 a[228:231], a[12:15], a[140:143], a[228:231]
v_mfma_f32_16x16x32_bf16 a[232:235], a[16:19], a[136:139], a[232:235]
ds_read_b64_tr_b16 a[132:133], v4 offset:49152
v_mfma_f32_16x16x32_bf16 a[232:235], a[20:23], a[140:143], a[232:235]
buffer_load_dwordx4 v17, s[12:15], s26 offen offset:1024 lds
v_mfma_f32_16x16x32_bf16 a[236:239], a[24:27], a[136:139], a[236:239]
ds_read_b64_tr_b16 a[134:135], v4 offset:51200
v_mfma_f32_16x16x32_bf16 a[236:239], a[28:31], a[140:143], a[236:239]
v_mfma_f32_16x16x32_bf16 a[240:243], a[32:35], a[136:139], a[240:243]
v_mfma_f32_16x16x32_bf16 a[240:243], a[36:39], a[140:143], a[240:243]
buffer_load_dwordx4 v18, s[12:15], s26 offen offset:2048 lds
v_mfma_f32_16x16x32_bf16 a[244:247], a[40:43], a[136:139], a[244:247]
v_mfma_f32_16x16x32_bf16 a[244:247], a[44:47], a[140:143], a[244:247]
v_mfma_f32_16x16x32_bf16 a[248:251], a[48:51], a[136:139], a[248:251]
v_mfma_f32_16x16x32_bf16 a[248:251], a[52:55], a[140:143], a[248:251]
s_waitcnt lgkmcnt(0)
buffer_load_dwordx4 v19, s[12:15], s26 offen offset:3072 lds
v_mfma_f32_16x16x32_bf16 a[252:255], a[56:59], a[136:139], a[252:255]
s_add_u32 s26, s26, 524288
s_bitcmp1_b32 s30, 1
v_mfma_f32_16x16x32_bf16 a[252:255], a[60:63], a[140:143], a[252:255]
s_cbranch_scc1 Lg_501
s_cmp_eq_u32 s30, 0
s_cbranch_scc1 Lg_501t
v_mfma_f32_16x16x32_bf16 v[32:35], a[64:67], a[128:131], v[32:35]
s_add_u32 m0, s29, 81920
ds_read_b64_tr_b16 a[136:137], v5 offset:32768
v_mfma_f32_16x16x32_bf16 v[32:35], a[68:71], a[132:135], v[32:35]
buffer_load_dwordx4 v16, s[12:15], s27 offen offset:0 lds
v_mfma_f32_16x16x32_bf16 v[36:39], a[72:75], a[128:131], v[36:39]
s_lshl_b32 s22, s38, 3
ds_read_b64_tr_b16 a[138:139], v5 offset:34816
v_mfma_f32_16x16x32_bf16 v[36:39], a[76:79], a[132:135], v[36:39]
s_lshl_b32 s23, s39, 5
v_and_b32 v252, 31, v0
v_lshrrev_b32 v253, 5, v0
v_mfma_f32_16x16x32_bf16 v[40:43], a[80:83], a[128:131], v[40:43]
ds_read_b64_tr_b16 a[140:141], v5 offset:49152
v_add_u32 v253, s22, v253
v_mfma_f32_16x16x32_bf16 v[40:43], a[84:87], a[132:135], v[40:43]
buffer_load_dwordx4 v17, s[12:15], s27 offen offset:1024 lds
v_mfma_f32_16x16x32_bf16 v[44:47], a[88:91], a[128:131], v[44:47]
ds_read_b64_tr_b16 a[142:143], v5 offset:51200
v_add_u32 v252, s23, v252
v_mfma_f32_16x16x32_bf16 v[44:47], a[92:95], a[132:135], v[44:47]
v_mul_u32_u24 v254, 7168, v253
v_lshl_add_u32 v254, v252, 2, v254
v_mfma_f32_16x16x32_bf16 v[48:51], a[96:99], a[128:131], v[48:51]
ds_read_b128 a[0:3], v2 offset:0
v_lshlrev_b32 v252, 4, v252
v_mfma_f32_16x16x32_bf16 v[48:51], a[100:103], a[132:135], v[48:51]
buffer_load_dwordx4 v18, s[12:15], s27 offen offset:2048 lds
v_mfma_f32_16x16x32_bf16 v[52:55], a[104:107], a[128:131], v[52:55]
ds_read_b128 a[4:7], v3 offset:0
v_add_u32 v255, 3584, v254
v_mfma_f32_16x16x32_bf16 v[52:55], a[108:111], a[132:135], v[52:55]
v_subrev_u32 v22, 3584, v254
v_subrev_u32 v23, 2688, v254
v_mfma_f32_16x16x32_bf16 v[56:59], a[112:115], a[128:131], v[56:59]
v_subrev_u32 v24, 1792, v254
v_subrev_u32 v25, 896, v254
v_mfma_f32_16x16x32_bf16 v[56:59], a[116:119], a[132:135], v[56:59]
buffer_load_dwordx4 v19, s[12:15], s27 offen offset:3072 lds
v_mfma_f32_16x16x32_bf16 v[60:63], a[120:123], a[128:131], v[60:63]
s_add_u32 s27, s27, 524288
ds_read_b128 a[8:11], v2 offset:2048
v_mfma_f32_16x16x32_bf16 v[60:63], a[124:127], a[132:135], v[60:63]
s_waitcnt lgkmcnt(3)
v_mfma_f32_16x16x32_bf16 v[64:67], a[64:67], a[136:139], v[64:67]
s_add_u32 m0, s28, 32768
ds_read_b64_tr_b16 a[128:129], v6 offset:32768
v_mfma_f32_16x16x32_bf16 v[64:67], a[68:71], a[140:143], v[64:67]
buffer_load_dwordx4 v12, s[8:11], s24 offen offset:0 lds
v_mfma_f32_16x16x32_bf16 v[68:71], a[72:75], a[136:139], v[68:71]
ds_read_b64_tr_b16 a[130:131], v6 offset:34816
v_mfma_f32_16x16x32_bf16 v[68:71], a[76:79], a[140:143], v[68:71]
v_mfma_f32_16x16x32_bf16 v[72:75], a[80:83], a[136:139], v[72:75]
ds_read_b64_tr_b16 a[132:133], v6 offset:49152
v_mfma_f32_16x16x32_bf16 v[72:75], a[84:87], a[140:143], v[72:75]
buffer_load_dwordx4 v13, s[8:11], s24 offen offset:1024 lds
v_mfma_f32_16x16x32_bf16 v[76:79], a[88:91], a[136:139], v[76:79]
ds_read_b64_tr_b16 a[134:135], v6 offset:51200
v_mfma_f32_16x16x32_bf16 v[76:79], a[92:95], a[140:143], v[76:79]
v_mfma_f32_16x16x32_bf16 v[80:83], a[96:99], a[136:139], v[80:83]
ds_read_b128 a[12:15], v3 offset:2048
v_mfma_f32_16x16x32_bf16 v[80:83], a[100:103], a[140:143], v[80:83]
buffer_load_dwordx4 v14, s[8:11], s24 offen offset:2048 lds
v_mfma_f32_16x16x32_bf16 v[84:87], a[104:107], a[136:139], v[84:87]
v_mfma_f32_16x16x32_bf16 v[84:87], a[108:111], a[140:143], v[84:87]
v_mfma_f32_16x16x32_bf16 v[88:91], a[112:115], a[136:139], v[88:91]
ds_read_b128 a[16:19], v2 offset:4096
v_mfma_f32_16x16x32_bf16 v[88:91], a[116:119], a[140:143], v[88:91]
buffer_load_dwordx4 v15, s[8:11], s24 offen offset:3072 lds
v_mfma_f32_16x16x32_bf16 v[92:95], a[120:123], a[136:139], v[92:95]
s_add_u32 s24, s24, 128
ds_read_b128 a[20:23], v3 offset:4096
v_mfma_f32_16x16x32_bf16 v[92:95], a[124:127], a[140:143], v[92:95]
s_waitcnt lgkmcnt(3)
v_mfma_f32_16x16x32_bf16 v[96:99], a[64:67], a[128:131], v[96:99]
s_add_u32 m0, s28, 36864
ds_read_b64_tr_b16 a[136:137], v7 offset:32768
v_mfma_f32_16x16x32_bf16 v[96:99], a[68:71], a[132:135], v[96:99]
buffer_load_dwordx4 v12, s[8:11], s25 offen offset:0 lds
v_mfma_f32_16x16x32_bf16 v[100:103], a[72:75], a[128:131], v[100:103]
ds_read_b64_tr_b16 a[138:139], v7 offset:34816
v_mfma_f32_16x16x32_bf16 v[100:103], a[76:79], a[132:135], v[100:103]
v_mfma_f32_16x16x32_bf16 v[104:107], a[80:83], a[128:131], v[104:107]
ds_read_b64_tr_b16 a[140:141], v7 offset:49152
v_mfma_f32_16x16x32_bf16 v[104:107], a[84:87], a[132:135], v[104:107]
buffer_load_dwordx4 v13, s[8:11], s25 offen offset:1024 lds
v_mfma_f32_16x16x32_bf16 v[108:111], a[88:91], a[128:131], v[108:111]
ds_read_b64_tr_b16 a[142:143], v7 offset:51200
v_mfma_f32_16x16x32_bf16 v[108:111], a[92:95], a[132:135], v[108:111]
PAD_23:
s_cbranch_execz PAD_27
v_mfma_f32_16x16x32_bf16 v[112:115], a[96:99], a[128:131], v[112:115]
v_mfma_f32_16x16x32_bf16 v[112:115], a[100:103], a[132:135], v[112:115]
buffer_load_dwordx4 v14, s[8:11], s25 offen offset:2048 lds
v_mfma_f32_16x16x32_bf16 v[116:119], a[104:107], a[128:131], v[116:119]
ds_read_b128 a[24:27], v2 offset:6144
v_mfma_f32_16x16x32_bf16 v[116:119], a[108:111], a[132:135], v[116:119]
v_mfma_f32_16x16x32_bf16 v[120:123], a[112:115], a[128:131], v[120:123]
ds_read_b128 a[28:31], v3 offset:6144
v_mfma_f32_16x16x32_bf16 v[120:123], a[116:119], a[132:135], v[120:123]
buffer_load_dwordx4 v15, s[8:11], s25 offen offset:3072 lds
v_mfma_f32_16x16x32_bf16 v[124:127], a[120:123], a[128:131], v[124:127]
s_add_u32 s25, s25, 128
v_mfma_f32_16x16x32_bf16 v[124:127], a[124:127], a[132:135], v[124:127]
s_waitcnt lgkmcnt(2)
v_mfma_f32_16x16x32_bf16 v[128:131], a[64:67], a[136:139], v[128:131]
s_mov_b64 s[56:57], s[70:71]
s_mov_b32 s58, 3584
s_mov_b32 s59, 0x20000
ds_read_b64_tr_b16 a[128:129], v8 offset:32768
v_mfma_f32_16x16x32_bf16 v[128:131], a[68:71], a[140:143], v[128:131]
buffer_load_dwordx4 v[248:251], v252, s[56:59], 0 offen
v_mfma_f32_16x16x32_bf16 v[132:135], a[72:75], a[136:139], v[132:135]
s_mov_b64 s[56:57], s[66:67]
s_mov_b32 s58, 1835008
ds_read_b64_tr_b16 a[130:131], v8 offset:34816
v_mfma_f32_16x16x32_bf16 v[132:135], a[76:79], a[140:143], v[132:135]
buffer_load_dword v224, v22, s[56:59], 0 offen nt
v_mfma_f32_16x16x32_bf16 v[136:139], a[80:83], a[136:139], v[136:139]
ds_read_b64_tr_b16 a[132:133], v8 offset:49152
v_mfma_f32_16x16x32_bf16 v[136:139], a[84:87], a[140:143], v[136:139]
buffer_load_dword v225, v23, s[56:59], 0 offen nt
v_mfma_f32_16x16x32_bf16 v[140:143], a[88:91], a[136:139], v[140:143]
ds_read_b64_tr_b16 a[134:135], v8 offset:51200
v_mfma_f32_16x16x32_bf16 v[140:143], a[92:95], a[140:143], v[140:143]
buffer_load_dword v226, v24, s[56:59], 0 offen nt
v_mfma_f32_16x16x32_bf16 v[144:147], a[96:99], a[136:139], v[144:147]
ds_read_b128 a[32:35], v2 offset:8192
v_mfma_f32_16x16x32_bf16 v[144:147], a[100:103], a[140:143], v[144:147]
buffer_load_dword v227, v25, s[56:59], 0 offen nt
v_mfma_f32_16x16x32_bf16 v[148:151], a[104:107], a[136:139], v[148:151]
buffer_load_dword v228, v254, s[56:59], 0 offen offset:0 nt
v_mfma_f32_16x16x32_bf16 v[148:151], a[108:111], a[140:143], v[148:151]
buffer_load_dword v229, v254, s[56:59], 0 offen offset:896 nt
v_mfma_f32_16x16x32_bf16 v[152:155], a[112:115], a[136:139], v[152:155]
ds_read_b128 a[36:39], v3 offset:8192
v_mfma_f32_16x16x32_bf16 v[152:155], a[116:119], a[140:143], v[152:155]
buffer_load_dword v230, v254, s[56:59], 0 offen offset:1792 nt
v_mfma_f32_16x16x32_bf16 v[156:159], a[120:123], a[136:139], v[156:159]
ds_read_b128 a[40:43], v2 offset:10240
v_mfma_f32_16x16x32_bf16 v[156:159], a[124:127], a[140:143], v[156:159]
s_waitcnt lgkmcnt(3)
buffer_load_dword v231, v254, s[56:59], 0 offen offset:2688 nt
v_mfma_f32_16x16x32_bf16 v[160:163], a[64:67], a[128:131], v[160:163]
ds_read_b64_tr_b16 a[136:137], v9 offset:32768
v_mfma_f32_16x16x32_bf16 v[160:163], a[68:71], a[132:135], v[160:163]
buffer_load_dword v232, v255, s[56:59], 0 offen offset:0 nt
v_mfma_f32_16x16x32_bf16 v[164:167], a[72:75], a[128:131], v[164:167]
ds_read_b64_tr_b16 a[138:139], v9 offset:34816
v_mfma_f32_16x16x32_bf16 v[164:167], a[76:79], a[132:135], v[164:167]
buffer_load_dword v233, v255, s[56:59], 0 offen offset:896 nt
v_mfma_f32_16x16x32_bf16 v[168:171], a[80:83], a[128:131], v[168:171]
ds_read_b64_tr_b16 a[140:141], v9 offset:49152
v_mfma_f32_16x16x32_bf16 v[168:171], a[84:87], a[132:135], v[168:171]
buffer_load_dword v234, v255, s[56:59], 0 offen offset:1792 nt
v_mfma_f32_16x16x32_bf16 v[172:175], a[88:91], a[128:131], v[172:175]
ds_read_b64_tr_b16 a[142:143], v9 offset:51200
v_mfma_f32_16x16x32_bf16 v[172:175], a[92:95], a[132:135], v[172:175]
buffer_load_dword v235, v255, s[56:59], 0 offen offset:2688 nt
v_mfma_f32_16x16x32_bf16 v[176:179], a[96:99], a[128:131], v[176:179]
s_mov_b64 s[56:57], s[68:69]
buffer_load_dword v236, v25, s[56:59], 0 offen nt
v_mfma_f32_16x16x32_bf16 v[176:179], a[100:103], a[132:135], v[176:179]
buffer_load_dword v237, v254, s[56:59], 0 offen offset:0 nt
v_mfma_f32_16x16x32_bf16 v[180:183], a[104:107], a[128:131], v[180:183]
ds_read_b128 a[44:47], v3 offset:10240
v_mfma_f32_16x16x32_bf16 v[180:183], a[108:111], a[132:135], v[180:183]
buffer_load_dword v238, v254, s[56:59], 0 offen offset:896 nt
v_mfma_f32_16x16x32_bf16 v[184:187], a[112:115], a[128:131], v[184:187]
ds_read_b128 a[48:51], v2 offset:12288
v_mfma_f32_16x16x32_bf16 v[184:187], a[116:119], a[132:135], v[184:187]
buffer_load_dword v239, v254, s[56:59], 0 offen offset:1792 nt
v_mfma_f32_16x16x32_bf16 v[188:191], a[120:123], a[128:131], v[188:191]
buffer_load_dword v240, v254, s[56:59], 0 offen offset:2688 nt
v_mfma_f32_16x16x32_bf16 v[188:191], a[124:127], a[132:135], v[188:191]
s_waitcnt lgkmcnt(2)
buffer_load_dword v241, v255, s[56:59], 0 offen offset:0 nt
v_mfma_f32_16x16x32_bf16 v[192:195], a[64:67], a[136:139], v[192:195]
ds_read_b64_tr_b16 a[128:129], v10 offset:32768
v_mfma_f32_16x16x32_bf16 v[192:195], a[68:71], a[140:143], v[192:195]
buffer_load_dword v242, v255, s[56:59], 0 offen offset:896 nt
v_mfma_f32_16x16x32_bf16 v[196:199], a[72:75], a[136:139], v[196:199]
ds_read_b64_tr_b16 a[130:131], v10 offset:34816
v_mfma_f32_16x16x32_bf16 v[196:199], a[76:79], a[140:143], v[196:199]
buffer_load_dword v243, v255, s[56:59], 0 offen offset:1792 nt
v_mfma_f32_16x16x32_bf16 v[200:203], a[80:83], a[136:139], v[200:203]
ds_read_b64_tr_b16 a[132:133], v10 offset:49152
v_mfma_f32_16x16x32_bf16 v[200:203], a[84:87], a[140:143], v[200:203]
buffer_load_dword v244, v255, s[56:59], 0 offen offset:2688 nt
v_mfma_f32_16x16x32_bf16 v[204:207], a[88:91], a[136:139], v[204:207]
ds_read_b64_tr_b16 a[134:135], v10 offset:51200
v_mfma_f32_16x16x32_bf16 v[204:207], a[92:95], a[140:143], v[204:207]
v_mfma_f32_16x16x32_bf16 v[208:211], a[96:99], a[136:139], v[208:211]
ds_read_b128 a[52:55], v3 offset:12288
v_mfma_f32_16x16x32_bf16 v[208:211], a[100:103], a[140:143], v[208:211]
v_mfma_f32_16x16x32_bf16 v[212:215], a[104:107], a[136:139], v[212:215]
ds_read_b128 a[56:59], v2 offset:14336
v_mfma_f32_16x16x32_bf16 v[212:215], a[108:111], a[140:143], v[212:215]
v_mfma_f32_16x16x32_bf16 v[216:219], a[112:115], a[136:139], v[216:219]
v_mfma_f32_16x16x32_bf16 v[216:219], a[116:119], a[140:143], v[216:219]
v_mfma_f32_16x16x32_bf16 v[220:223], a[120:123], a[136:139], v[220:223]
ds_read_b128 a[60:63], v3 offset:14336
v_mfma_f32_16x16x32_bf16 v[220:223], a[124:127], a[140:143], v[220:223]
s_waitcnt lgkmcnt(3)
v_mfma_f32_16x16x32_bf16 a[192:195], a[64:67], a[128:131], a[192:195]
ds_read_b64_tr_b16 a[136:137], v11 offset:32768
v_mfma_f32_16x16x32_bf16 a[192:195], a[68:71], a[132:135], a[192:195]
v_mfma_f32_16x16x32_bf16 a[196:199], a[72:75], a[128:131], a[196:199]
ds_read_b64_tr_b16 a[138:139], v11 offset:34816
v_mfma_f32_16x16x32_bf16 a[196:199], a[76:79], a[132:135], a[196:199]
v_mfma_f32_16x16x32_bf16 a[200:203], a[80:83], a[128:131], a[200:203]
ds_read_b64_tr_b16 a[140:141], v11 offset:49152
v_mfma_f32_16x16x32_bf16 a[200:203], a[84:87], a[132:135], a[200:203]
v_mfma_f32_16x16x32_bf16 a[204:207], a[88:91], a[128:131], a[204:207]
ds_read_b64_tr_b16 a[142:143], v11 offset:51200
v_mfma_f32_16x16x32_bf16 a[204:207], a[92:95], a[132:135], a[204:207]
v_mfma_f32_16x16x32_bf16 a[208:211], a[96:99], a[128:131], a[208:211]
v_mfma_f32_16x16x32_bf16 a[208:211], a[100:103], a[132:135], a[208:211]
v_mfma_f32_16x16x32_bf16 a[212:215], a[104:107], a[128:131], a[212:215]
v_mfma_f32_16x16x32_bf16 a[212:215], a[108:111], a[132:135], a[212:215]
v_mfma_f32_16x16x32_bf16 a[216:219], a[112:115], a[128:131], a[216:219]
v_mfma_f32_16x16x32_bf16 a[216:219], a[116:119], a[132:135], a[216:219]
v_mfma_f32_16x16x32_bf16 a[220:223], a[120:123], a[128:131], a[220:223]
s_waitcnt vmcnt(22) lgkmcnt(0)
v_mfma_f32_16x16x32_bf16 a[220:223], a[124:127], a[132:135], a[220:223]
s_barrier
v_mfma_f32_16x16x32_bf16 a[224:227], a[64:67], a[136:139], a[224:227]
s_add_u32 m0, s29, 98304
ds_read_b64_tr_b16 a[128:129], v4 offset:0
v_mfma_f32_16x16x32_bf16 a[224:227], a[68:71], a[140:143], a[224:227]
buffer_load_dwordx4 v16, s[12:15], s26 offen offset:0 lds
v_mfma_f32_16x16x32_bf16 a[228:231], a[72:75], a[136:139], a[228:231]
ds_read_b64_tr_b16 a[130:131], v4 offset:2048
v_mfma_f32_16x16x32_bf16 a[228:231], a[76:79], a[140:143], a[228:231]
v_mfma_f32_16x16x32_bf16 a[232:235], a[80:83], a[136:139], a[232:235]
ds_read_b64_tr_b16 a[132:133], v4 offset:16384
v_mfma_f32_16x16x32_bf16 a[232:235], a[84:87], a[140:143], a[232:235]
buffer_load_dwordx4 v17, s[12:15], s26 offen offset:1024 lds
v_mfma_f32_16x16x32_bf16 a[236:239], a[88:91], a[136:139], a[236:239]
ds_read_b64_tr_b16 a[134:135], v4 offset:18432
v_mfma_f32_16x16x32_bf16 a[236:239], a[92:95], a[140:143], a[236:239]
v_mfma_f32_16x16x32_bf16 a[240:243], a[96:99], a[136:139], a[240:243]
v_mfma_f32_16x16x32_bf16 a[240:243], a[100:103], a[140:143], a[240:243]
buffer_load_dwordx4 v18, s[12:15], s26 offen offset:2048 lds
v_mfma_f32_16x16x32_bf16 a[244:247], a[104:107], a[136:139], a[244:247]
v_mfma_f32_16x16x32_bf16 a[244:247], a[108:111], a[140:143], a[244:247]
v_mfma_f32_16x16x32_bf16 a[248:251], a[112:115], a[136:139], a[248:251]
v_mfma_f32_16x16x32_bf16 a[248:251], a[116:119], a[140:143], a[248:251]
buffer_load_dwordx4 v19, s[12:15], s26 offen offset:3072 lds
v_mfma_f32_16x16x32_bf16 a[252:255], a[120:123], a[136:139], a[252:255]
s_add_u32 s26, s26, 524288
v_mfma_f32_16x16x32_bf16 a[252:255], a[124:127], a[140:143], a[252:255]
s_waitcnt lgkmcnt(0)
v_mfma_f32_16x16x32_bf16 v[32:35], a[0:3], a[128:131], v[32:35]
s_add_u32 m0, s29, 114688
ds_read_b64_tr_b16 a[136:137], v5 offset:0
v_mfma_f32_16x16x32_bf16 v[32:35], a[4:7], a[132:135], v[32:35]
buffer_load_dwordx4 v16, s[12:15], s27 offen offset:0 lds
v_mfma_f32_16x16x32_bf16 v[36:39], a[8:11], a[128:131], v[36:39]
ds_read_b64_tr_b16 a[138:139], v5 offset:2048
v_mfma_f32_16x16x32_bf16 v[36:39], a[12:15], a[132:135], v[36:39]
v_mfma_f32_16x16x32_bf16 v[40:43], a[16:19], a[128:131], v[40:43]
ds_read_b64_tr_b16 a[140:141], v5 offset:16384
v_mfma_f32_16x16x32_bf16 v[40:43], a[20:23], a[132:135], v[40:43]
buffer_load_dwordx4 v17, s[12:15], s27 offen offset:1024 lds
v_mfma_f32_16x16x32_bf16 v[44:47], a[24:27], a[128:131], v[44:47]
ds_read_b64_tr_b16 a[142:143], v5 offset:18432
v_mfma_f32_16x16x32_bf16 v[44:47], a[28:31], a[132:135], v[44:47]
v_mfma_f32_16x16x32_bf16 v[48:51], a[32:35], a[128:131], v[48:51]
ds_read_b128 a[64:67], v2 offset:32768
v_mfma_f32_16x16x32_bf16 v[48:51], a[36:39], a[132:135], v[48:51]
buffer_load_dwordx4 v18, s[12:15], s27 offen offset:2048 lds
v_mfma_f32_16x16x32_bf16 v[52:55], a[40:43], a[128:131], v[52:55]
ds_read_b128 a[68:71], v3 offset:32768
v_mfma_f32_16x16x32_bf16 v[52:55], a[44:47], a[132:135], v[52:55]
v_mfma_f32_16x16x32_bf16 v[56:59], a[48:51], a[128:131], v[56:59]
v_mfma_f32_16x16x32_bf16 v[56:59], a[52:55], a[132:135], v[56:59]
buffer_load_dwordx4 v19, s[12:15], s27 offen offset:3072 lds
v_mfma_f32_16x16x32_bf16 v[60:63], a[56:59], a[128:131], v[60:63]
s_add_u32 s27, s27, 524288
ds_read_b128 a[72:75], v2 offset:34816
v_mfma_f32_16x16x32_bf16 v[60:63], a[60:63], a[132:135], v[60:63]
s_waitcnt lgkmcnt(3)
v_mfma_f32_16x16x32_bf16 v[64:67], a[0:3], a[136:139], v[64:67]
s_add_u32 m0, s28, 0
ds_read_b64_tr_b16 a[128:129], v6 offset:0
v_mfma_f32_16x16x32_bf16 v[64:67], a[4:7], a[140:143], v[64:67]
buffer_load_dwordx4 v12, s[8:11], s24 offen offset:0 lds
v_mfma_f32_16x16x32_bf16 v[68:71], a[8:11], a[136:139], v[68:71]
ds_read_b64_tr_b16 a[130:131], v6 offset:2048
v_mfma_f32_16x16x32_bf16 v[68:71], a[12:15], a[140:143], v[68:71]
v_mfma_f32_16x16x32_bf16 v[72:75], a[16:19], a[136:139], v[72:75]
ds_read_b64_tr_b16 a[132:133], v6 offset:16384
v_mfma_f32_16x16x32_bf16 v[72:75], a[20:23], a[140:143], v[72:75]
buffer_load_dwordx4 v13, s[8:11], s24 offen offset:1024 lds
v_mfma_f32_16x16x32_bf16 v[76:79], a[24:27], a[136:139], v[76:79]
ds_read_b64_tr_b16 a[134:135], v6 offset:18432
v_mfma_f32_16x16x32_bf16 v[76:79], a[28:31], a[140:143], v[76:79]
v_mfma_f32_16x16x32_bf16 v[80:83], a[32:35], a[136:139], v[80:83]
ds_read_b128 a[76:79], v3 offset:34816
v_mfma_f32_16x16x32_bf16 v[80:83], a[36:39], a[140:143], v[80:83]
buffer_load_dwordx4 v14, s[8:11], s24 offen offset:2048 lds
v_mfma_f32_16x16x32_bf16 v[84:87], a[40:43], a[136:139], v[84:87]
v_mfma_f32_16x16x32_bf16 v[84:87], a[44:47], a[140:143], v[84:87]
v_mfma_f32_16x16x32_bf16 v[88:91], a[48:51], a[136:139], v[88:91]
ds_read_b128 a[80:83], v2 offset:36864
v_mfma_f32_16x16x32_bf16 v[88:91], a[52:55], a[140:143], v[88:91]
buffer_load_dwordx4 v15, s[8:11], s24 offen offset:3072 lds
v_mfma_f32_16x16x32_bf16 v[92:95], a[56:59], a[136:139], v[92:95]
s_add_u32 s24, s24, 128
ds_read_b128 a[84:87], v3 offset:36864
v_mfma_f32_16x16x32_bf16 v[92:95], a[60:63], a[140:143], v[92:95]
s_waitcnt lgkmcnt(3)
v_mfma_f32_16x16x32_bf16 v[96:99], a[0:3], a[128:131], v[96:99]
s_add_u32 m0, s28, 4096
ds_read_b64_tr_b16 a[136:137], v7 offset:0
v_mfma_f32_16x16x32_bf16 v[96:99], a[4:7], a[132:135], v[96:99]
buffer_load_dwordx4 v12, s[8:11], s25 offen offset:0 lds
v_mfma_f32_16x16x32_bf16 v[100:103], a[8:11], a[128:131], v[100:103]
ds_read_b64_tr_b16 a[138:139], v7 offset:2048
v_mfma_f32_16x16x32_bf16 v[100:103], a[12:15], a[132:135], v[100:103]
v_mfma_f32_16x16x32_bf16 v[104:107], a[16:19], a[128:131], v[104:107]
ds_read_b64_tr_b16 a[140:141], v7 offset:16384
v_mfma_f32_16x16x32_bf16 v[104:107], a[20:23], a[132:135], v[104:107]
buffer_load_dwordx4 v13, s[8:11], s25 offen offset:1024 lds
v_mfma_f32_16x16x32_bf16 v[108:111], a[24:27], a[128:131], v[108:111]
ds_read_b64_tr_b16 a[142:143], v7 offset:18432
v_mfma_f32_16x16x32_bf16 v[108:111], a[28:31], a[132:135], v[108:111]
v_mfma_f32_16x16x32_bf16 v[112:115], a[32:35], a[128:131], v[112:115]
v_mfma_f32_16x16x32_bf16 v[112:115], a[36:39], a[132:135], v[112:115]
buffer_load_dwordx4 v14, s[8:11], s25 offen offset:2048 lds
v_mfma_f32_16x16x32_bf16 v[116:119], a[40:43], a[128:131], v[116:119]
ds_read_b128 a[88:91], v2 offset:38912
v_mfma_f32_16x16x32_bf16 v[116:119], a[44:47], a[132:135], v[116:119]
v_mfma_f32_16x16x32_bf16 v[120:123], a[48:51], a[128:131], v[120:123]
ds_read_b128 a[92:95], v3 offset:38912
v_mfma_f32_16x16x32_bf16 v[120:123], a[52:55], a[132:135], v[120:123]
buffer_load_dwordx4 v15, s[8:11], s25 offen offset:3072 lds
v_mfma_f32_16x16x32_bf16 v[124:127], a[56:59], a[128:131], v[124:127]
s_add_u32 s25, s25, 128
v_mfma_f32_16x16x32_bf16 v[124:127], a[60:63], a[132:135], v[124:127]
s_waitcnt lgkmcnt(2)
v_mfma_f32_16x16x32_bf16 v[128:131], a[0:3], a[136:139], v[128:131]
ds_read_b64_tr_b16 a[128:129], v8 offset:0
v_mfma_f32_16x16x32_bf16 v[128:131], a[4:7], a[140:143], v[128:131]
buffer_load_dword v21, v20, s[16:19], s43 offen
v_mfma_f32_16x16x32_bf16 v[132:135], a[8:11], a[136:139], v[132:135]
s_add_u32 s43, s43, s47
ds_read_b64_tr_b16 a[130:131], v8 offset:2048
v_mfma_f32_16x16x32_bf16 v[132:135], a[12:15], a[140:143], v[132:135]
s_cmp_ge_u32 s43, s51
v_mfma_f32_16x16x32_bf16 v[136:139], a[16:19], a[136:139], v[136:139]
s_cselect_b32 s43, 0, s43
ds_read_b64_tr_b16 a[132:133], v8 offset:16384
v_mfma_f32_16x16x32_bf16 v[136:139], a[20:23], a[140:143], v[136:139]
s_cselect_b32 s51, s42, s51
v_mfma_f32_16x16x32_bf16 v[140:143], a[24:27], a[136:139], v[140:143]
s_cselect_b64 s[16:17], s[40:41], s[16:17]
ds_read_b64_tr_b16 a[134:135], v8 offset:18432
v_mfma_f32_16x16x32_bf16 v[140:143], a[28:31], a[140:143], v[140:143]
s_cselect_b32 s18, s42, s18
v_mfma_f32_16x16x32_bf16 v[144:147], a[32:35], a[136:139], v[144:147]
s_cselect_b64 s[40:41], s[44:45], s[40:41]
ds_read_b128 a[96:99], v2 offset:40960
v_mfma_f32_16x16x32_bf16 v[144:147], a[36:39], a[140:143], v[144:147]
s_cselect_b32 s42, s46, s42
v_mfma_f32_16x16x32_bf16 v[148:151], a[40:43], a[136:139], v[148:151]
s_cselect_b32 s46, 0, s46
v_mfma_f32_16x16x32_bf16 v[148:151], a[44:47], a[140:143], v[148:151]
s_lshl_b32 s59, s39, 5
v_mfma_f32_16x16x32_bf16 v[152:155], a[48:51], a[136:139], v[152:155]
s_add_u32 s59, s59, s38
ds_read_b128 a[100:103], v3 offset:40960
v_mfma_f32_16x16x32_bf16 v[152:155], a[52:55], a[140:143], v[152:155]
s_lshl_b32 s59, s59, 2
v_mfma_f32_16x16x32_bf16 v[156:159], a[56:59], a[136:139], v[156:159]
s_add_u32 s59, s59, 94392320
ds_read_b128 a[104:107], v2 offset:43008
v_mfma_f32_16x16x32_bf16 v[156:159], a[60:63], a[140:143], v[156:159]
s_waitcnt lgkmcnt(3)
s_cmp_lt_u32 s2, 224
v_mfma_f32_16x16x32_bf16 v[160:163], a[0:3], a[128:131], v[160:163]
s_cselect_b32 s59, s59, 3221225472
ds_read_b64_tr_b16 a[136:137], v9 offset:0
v_mfma_f32_16x16x32_bf16 v[160:163], a[4:7], a[132:135], v[160:163]
s_mov_b32 s58, 0xffff0000
v_mfma_f32_16x16x32_bf16 v[164:167], a[8:11], a[128:131], v[164:167]
s_cmp_lt_u32 s3, 1
ds_read_b64_tr_b16 a[138:139], v9 offset:2048
v_mfma_f32_16x16x32_bf16 v[164:167], a[12:15], a[132:135], v[164:167]
s_cselect_b32 s54, 0, 3221225472
v_mfma_f32_16x16x32_bf16 v[168:171], a[16:19], a[128:131], v[168:171]
s_cselect_b32 s50, 0x100, 0
ds_read_b64_tr_b16 a[140:141], v9 offset:16384
v_mfma_f32_16x16x32_bf16 v[168:171], a[20:23], a[132:135], v[168:171]
v_mfma_f32_16x16x32_bf16 v[172:175], a[24:27], a[128:131], v[172:175]
ds_read_b64_tr_b16 a[142:143], v9 offset:18432
v_mfma_f32_16x16x32_bf16 v[172:175], a[28:31], a[132:135], v[172:175]
v_mfma_f32_16x16x32_bf16 v[176:179], a[32:35], a[128:131], v[176:179]
v_mfma_f32_16x16x32_bf16 v[176:179], a[36:39], a[132:135], v[176:179]
v_mfma_f32_16x16x32_bf16 v[180:183], a[40:43], a[128:131], v[180:183]
ds_read_b128 a[108:111], v3 offset:43008
v_mfma_f32_16x16x32_bf16 v[180:183], a[44:47], a[132:135], v[180:183]
v_mfma_f32_16x16x32_bf16 v[184:187], a[48:51], a[128:131], v[184:187]
ds_read_b128 a[112:115], v2 offset:45056
v_mfma_f32_16x16x32_bf16 v[184:187], a[52:55], a[132:135], v[184:187]
v_mfma_f32_16x16x32_bf16 v[188:191], a[56:59], a[128:131], v[188:191]
v_mfma_f32_16x16x32_bf16 v[188:191], a[60:63], a[132:135], v[188:191]
s_waitcnt lgkmcnt(2)
v_mfma_f32_16x16x32_bf16 v[192:195], a[0:3], a[136:139], v[192:195]
ds_read_b64_tr_b16 a[128:129], v10 offset:0
v_mfma_f32_16x16x32_bf16 v[192:195], a[4:7], a[140:143], v[192:195]
v_mfma_f32_16x16x32_bf16 v[196:199], a[8:11], a[136:139], v[196:199]
ds_read_b64_tr_b16 a[130:131], v10 offset:2048
v_mfma_f32_16x16x32_bf16 v[196:199], a[12:15], a[140:143], v[196:199]
v_mfma_f32_16x16x32_bf16 v[200:203], a[16:19], a[136:139], v[200:203]
ds_read_b64_tr_b16 a[132:133], v10 offset:16384
v_mfma_f32_16x16x32_bf16 v[200:203], a[20:23], a[140:143], v[200:203]
v_mfma_f32_16x16x32_bf16 v[204:207], a[24:27], a[136:139], v[204:207]
ds_read_b64_tr_b16 a[134:135], v10 offset:18432
v_mfma_f32_16x16x32_bf16 v[204:207], a[28:31], a[140:143], v[204:207]
v_mfma_f32_16x16x32_bf16 v[208:211], a[32:35], a[136:139], v[208:211]
ds_read_b128 a[116:119], v3 offset:45056
v_mfma_f32_16x16x32_bf16 v[208:211], a[36:39], a[140:143], v[208:211]
v_mfma_f32_16x16x32_bf16 v[212:215], a[40:43], a[136:139], v[212:215]
ds_read_b128 a[120:123], v2 offset:47104
v_and_b32 v252, 31, v0
v_mfma_f32_16x16x32_bf16 v[212:215], a[44:47], a[140:143], v[212:215]
v_lshrrev_b32 v253, 5, v0
v_xor_b32 v253, v253, v252
v_mfma_f32_16x16x32_bf16 v[216:219], a[48:51], a[136:139], v[216:219]
v_and_b32 v253, 7, v253
v_lshlrev_b32 v252, 8, v252
v_mfma_f32_16x16x32_bf16 v[216:219], a[52:55], a[140:143], v[216:219]
v_lshl_add_u32 v252, v253, 4, v252
v_add_u32 v252, 147456, v252
v_mfma_f32_16x16x32_bf16 v[220:223], a[56:59], a[136:139], v[220:223]
ds_read_b128 a[124:127], v3 offset:47104
v_mfma_f32_16x16x32_bf16 v[220:223], a[60:63], a[140:143], v[220:223]
s_waitcnt lgkmcnt(3)
v_mfma_f32_16x16x32_bf16 a[192:195], a[0:3], a[128:131], a[192:195]
ds_read_b64_tr_b16 a[136:137], v11 offset:0
v_mfma_f32_16x16x32_bf16 a[192:195], a[4:7], a[132:135], a[192:195]
v_mfma_f32_16x16x32_bf16 a[196:199], a[8:11], a[128:131], a[196:199]
ds_read_b64_tr_b16 a[138:139], v11 offset:2048
v_mfma_f32_16x16x32_bf16 a[196:199], a[12:15], a[132:135], a[196:199]
v_mfma_f32_16x16x32_bf16 a[200:203], a[16:19], a[128:131], a[200:203]
ds_read_b64_tr_b16 a[140:141], v11 offset:16384
v_mfma_f32_16x16x32_bf16 a[200:203], a[20:23], a[132:135], a[200:203]
v_mfma_f32_16x16x32_bf16 a[204:207], a[24:27], a[128:131], a[204:207]
ds_read_b64_tr_b16 a[142:143], v11 offset:18432
v_mfma_f32_16x16x32_bf16 a[204:207], a[28:31], a[132:135], a[204:207]
v_mfma_f32_16x16x32_bf16 a[208:211], a[32:35], a[128:131], a[208:211]
v_mfma_f32_16x16x32_bf16 a[208:211], a[36:39], a[132:135], a[208:211]
v_mfma_f32_16x16x32_bf16 a[212:215], a[40:43], a[128:131], a[212:215]
v_mfma_f32_16x16x32_bf16 a[212:215], a[44:47], a[132:135], a[212:215]
v_mfma_f32_16x16x32_bf16 a[216:219], a[48:51], a[128:131], a[216:219]
v_mfma_f32_16x16x32_bf16 a[216:219], a[52:55], a[132:135], a[216:219]
v_mfma_f32_16x16x32_bf16 a[220:223], a[56:59], a[128:131], a[220:223]
s_waitcnt vmcnt(1) lgkmcnt(0)
v_mfma_f32_16x16x32_bf16 a[220:223], a[60:63], a[132:135], a[220:223]
s_barrier
v_mfma_f32_16x16x32_bf16 a[224:227], a[0:3], a[136:139], a[224:227]
s_add_u32 m0, s29, 65536
ds_read_b64_tr_b16 a[128:129], v4 offset:32768
v_lshlrev_b32 v28, 16, v248
v_mfma_f32_16x16x32_bf16 a[224:227], a[4:7], a[140:143], a[224:227]
buffer_load_dwordx4 v16, s[12:15], s26 offen offset:0 lds
v_mfma_f32_16x16x32_bf16 a[228:231], a[8:11], a[136:139], a[228:231]
ds_read_b64_tr_b16 a[130:131], v4 offset:34816
v_and_b32 v29, s58, v248
v_mfma_f32_16x16x32_bf16 a[228:231], a[12:15], a[140:143], a[228:231]
v_lshlrev_b32 v30, 16, v249
v_and_b32 v253, s58, v249
v_mfma_f32_16x16x32_bf16 a[232:235], a[16:19], a[136:139], a[232:235]
ds_read_b64_tr_b16 a[132:133], v4 offset:49152
v_lshlrev_b32 v22, 16, v224
v_mfma_f32_16x16x32_bf16 a[232:235], a[20:23], a[140:143], a[232:235]
buffer_load_dwordx4 v17, s[12:15], s26 offen offset:1024 lds
v_mfma_f32_16x16x32_bf16 a[236:239], a[24:27], a[136:139], a[236:239]
ds_read_b64_tr_b16 a[134:135], v4 offset:51200
v_lshlrev_b32 v23, 16, v225
v_mfma_f32_16x16x32_bf16 a[236:239], a[28:31], a[140:143], a[236:239]
v_lshlrev_b32 v24, 16, v226
v_mul_f32 v254, v22, v253
v_mfma_f32_16x16x32_bf16 a[240:243], a[32:35], a[136:139], a[240:243]
v_lshlrev_b32 v25, 16, v227
v_lshlrev_b32 v247, 16, v236
v_mfma_f32_16x16x32_bf16 a[240:243], a[36:39], a[140:143], a[240:243]
buffer_load_dwordx4 v18, s[12:15], s26 offen offset:2048 lds
v_mfma_f32_16x16x32_bf16 a[244:247], a[40:43], a[136:139], a[244:247]
v_fmac_f32 v254, v23, v30
v_fmac_f32 v254, v24, v29
v_mfma_f32_16x16x32_bf16 a[244:247], a[44:47], a[140:143], a[244:247]
v_fmac_f32 v254, v25, v28
v_mul_f32 v254, v254, v247
v_mfma_f32_16x16x32_bf16 a[248:251], a[48:51], a[136:139], a[248:251]
v_mul_f32 v255, v23, v253
v_lshlrev_b32 v22, 16, v228
v_mfma_f32_16x16x32_bf16 a[248:251], a[52:55], a[140:143], a[248:251]
buffer_load_dwordx4 v19, s[12:15], s26 offen offset:3072 lds
v_mfma_f32_16x16x32_bf16 a[252:255], a[56:59], a[136:139], a[252:255]
s_add_u32 s26, s26, 524288
v_lshlrev_b32 v247, 16, v237
v_fmac_f32 v255, v24, v30
v_mfma_f32_16x16x32_bf16 a[252:255], a[60:63], a[140:143], a[252:255]
s_waitcnt lgkmcnt(0)
v_fmac_f32 v255, v25, v29
v_fmac_f32 v255, v22, v28
v_mfma_f32_16x16x32_bf16 v[32:35], a[64:67], a[128:131], v[32:35]
s_add_u32 m0, s29, 81920
ds_read_b64_tr_b16 a[136:137], v5 offset:32768
v_mul_f32 v255, v255, v247
v_mfma_f32_16x16x32_bf16 v[32:35], a[68:71], a[132:135], v[32:35]
buffer_load_dwordx4 v16, s[12:15], s27 offen offset:0 lds
v_mfma_f32_16x16x32_bf16 v[36:39], a[72:75], a[128:131], v[36:39]
ds_read_b64_tr_b16 a[138:139], v5 offset:34816
v_cvt_pk_bf16_f32 v246, v254, v255
v_mfma_f32_16x16x32_bf16 v[36:39], a[76:79], a[132:135], v[36:39]
v_accvgpr_write_b32 a180, v246
v_mul_f32 v254, v24, v253
v_mfma_f32_16x16x32_bf16 v[40:43], a[80:83], a[128:131], v[40:43]
ds_read_b64_tr_b16 a[140:141], v5 offset:49152
v_lshlrev_b32 v23, 16, v229
v_mfma_f32_16x16x32_bf16 v[40:43], a[84:87], a[132:135], v[40:43]
buffer_load_dwordx4 v17, s[12:15], s27 offen offset:1024 lds
v_mfma_f32_16x16x32_bf16 v[44:47], a[88:91], a[128:131], v[44:47]
ds_read_b64_tr_b16 a[142:143], v5 offset:51200
v_lshlrev_b32 v247, 16, v238
v_mfma_f32_16x16x32_bf16 v[44:47], a[92:95], a[132:135], v[44:47]
v_fmac_f32 v254, v25, v30
v_fmac_f32 v254, v22, v29
v_fmac_f32 v254, v23, v28
v_mfma_f32_16x16x32_bf16 v[48:51], a[96:99], a[128:131], v[48:51]
ds_read_b128 a[0:3], v2 offset:0
v_mul_f32 v254, v254, v247
v_mfma_f32_16x16x32_bf16 v[48:51], a[100:103], a[132:135], v[48:51]
buffer_load_dwordx4 v18, s[12:15], s27 offen offset:2048 lds
v_mfma_f32_16x16x32_bf16 v[52:55], a[104:107], a[128:131], v[52:55]
ds_read_b128 a[4:7], v3 offset:0
v_cvt_pk_bf16_f32 v246, v255, v254
v_mfma_f32_16x16x32_bf16 v[52:55], a[108:111], a[132:135], v[52:55]
v_accvgpr_write_b32 a176, v246
v_mul_f32 v255, v25, v253
v_mfma_f32_16x16x32_bf16 v[56:59], a[112:115], a[128:131], v[56:59]
v_lshlrev_b32 v24, 16, v230
v_lshlrev_b32 v247, 16, v239
v_mfma_f32_16x16x32_bf16 v[56:59], a[116:119], a[132:135], v[56:59]
buffer_load_dwordx4 v19, s[12:15], s27 offen offset:3072 lds
v_mfma_f32_16x16x32_bf16 v[60:63], a[120:123], a[128:131], v[60:63]
s_add_u32 s27, s27, 524288
ds_read_b128 a[8:11], v2 offset:2048
v_fmac_f32 v255, v22, v30
v_mfma_f32_16x16x32_bf16 v[60:63], a[124:127], a[132:135], v[60:63]
s_waitcnt lgkmcnt(3)
v_fmac_f32 v255, v23, v29
v_fmac_f32 v255, v24, v28
v_mul_f32 v255, v255, v247
v_mfma_f32_16x16x32_bf16 v[64:67], a[64:67], a[136:139], v[64:67]
s_add_u32 m0, s28, 32768
ds_read_b64_tr_b16 a[128:129], v6 offset:32768
v_cvt_pk_bf16_f32 v246, v254, v255
v_mfma_f32_16x16x32_bf16 v[64:67], a[68:71], a[140:143], v[64:67]
buffer_load_dwordx4 v12, s[8:11], s24 offen offset:0 lds
v_mfma_f32_16x16x32_bf16 v[68:71], a[72:75], a[136:139], v[68:71]
ds_read_b64_tr_b16 a[130:131], v6 offset:34816
v_accvgpr_write_b32 a181, v246
v_mfma_f32_16x16x32_bf16 v[68:71], a[76:79], a[140:143], v[68:71]
v_mul_f32 v254, v22, v253
v_lshlrev_b32 v25, 16, v231
v_mfma_f32_16x16x32_bf16 v[72:75], a[80:83], a[136:139], v[72:75]
ds_read_b64_tr_b16 a[132:133], v6 offset:49152
v_lshlrev_b32 v247, 16, v240
v_mfma_f32_16x16x32_bf16 v[72:75], a[84:87], a[140:143], v[72:75]
buffer_load_dwordx4 v13, s[8:11], s24 offen offset:1024 lds
v_mfma_f32_16x16x32_bf16 v[76:79], a[88:91], a[136:139], v[76:79]
ds_read_b64_tr_b16 a[134:135], v6 offset:51200
v_fmac_f32 v254, v23, v30
v_fmac_f32 v254, v24, v29
v_mfma_f32_16x16x32_bf16 v[76:79], a[92:95], a[140:143], v[76:79]
v_fmac_f32 v254, v25, v28
v_mul_f32 v254, v254, v247
v_mfma_f32_16x16x32_bf16 v[80:83], a[96:99], a[136:139], v[80:83]
ds_read_b128 a[12:15], v3 offset:2048
v_cvt_pk_bf16_f32 v246, v255, v254
v_mfma_f32_16x16x32_bf16 v[80:83], a[100:103], a[140:143], v[80:83]
buffer_load_dwordx4 v14, s[8:11], s24 offen offset:2048 lds
v_mfma_f32_16x16x32_bf16 v[84:87], a[104:107], a[136:139], v[84:87]
v_accvgpr_write_b32 a177, v246
v_mul_f32 v255, v23, v253
v_mfma_f32_16x16x32_bf16 v[84:87], a[108:111], a[140:143], v[84:87]
v_lshlrev_b32 v22, 16, v232
v_lshlrev_b32 v247, 16, v241
v_mfma_f32_16x16x32_bf16 v[88:91], a[112:115], a[136:139], v[88:91]
ds_read_b128 a[16:19], v2 offset:4096
v_fmac_f32 v255, v24, v30
v_mfma_f32_16x16x32_bf16 v[88:91], a[116:119], a[140:143], v[88:91]
buffer_load_dwordx4 v15, s[8:11], s24 offen offset:3072 lds
v_mfma_f32_16x16x32_bf16 v[92:95], a[120:123], a[136:139], v[92:95]
s_add_u32 s24, s24, 128
ds_read_b128 a[20:23], v3 offset:4096
v_fmac_f32 v255, v25, v29
v_fmac_f32 v255, v22, v28
v_mfma_f32_16x16x32_bf16 v[92:95], a[124:127], a[140:143], v[92:95]
s_waitcnt lgkmcnt(3)
v_mul_f32 v255, v255, v247
v_cvt_pk_bf16_f32 v246, v254, v255
v_mfma_f32_16x16x32_bf16 v[96:99], a[64:67], a[128:131], v[96:99]
s_add_u32 m0, s28, 36864
ds_read_b64_tr_b16 a[136:137], v7 offset:32768
v_accvgpr_write_b32 a182, v246
v_mfma_f32_16x16x32_bf16 v[96:99], a[68:71], a[132:135], v[96:99]
buffer_load_dwordx4 v12, s[8:11], s25 offen offset:0 lds
v_mfma_f32_16x16x32_bf16 v[100:103], a[72:75], a[128:131], v[100:103]
ds_read_b64_tr_b16 a[138:139], v7 offset:34816
v_mul_f32 v254, v24, v253
v_mfma_f32_16x16x32_bf16 v[100:103], a[76:79], a[132:135], v[100:103]
v_lshlrev_b32 v23, 16, v233
v_lshlrev_b32 v247, 16, v242
v_mfma_f32_16x16x32_bf16 v[104:107], a[80:83], a[128:131], v[104:107]
ds_read_b64_tr_b16 a[140:141], v7 offset:49152
v_fmac_f32 v254, v25, v30
v_mfma_f32_16x16x32_bf16 v[104:107], a[84:87], a[132:135], v[104:107]
buffer_load_dwordx4 v13, s[8:11], s25 offen offset:1024 lds
v_fmac_f32 v254, v22, v29
v_mfma_f32_16x16x32_bf16 v[108:111], a[88:91], a[128:131], v[108:111]
ds_read_b64_tr_b16 a[142:143], v7 offset:51200
v_fmac_f32 v254, v23, v28
v_mfma_f32_16x16x32_bf16 v[108:111], a[92:95], a[132:135], v[108:111]
v_mul_f32 v254, v254, v247
v_cvt_pk_bf16_f32 v246, v255, v254
v_mfma_f32_16x16x32_bf16 v[112:115], a[96:99], a[128:131], v[112:115]
v_accvgpr_write_b32 a178, v246
v_mul_f32 v255, v25, v253
v_mfma_f32_16x16x32_bf16 v[112:115], a[100:103], a[132:135], v[112:115]
buffer_load_dwordx4 v14, s[8:11], s25 offen offset:2048 lds
v_mfma_f32_16x16x32_bf16 v[116:119], a[104:107], a[128:131], v[116:119]
ds_read_b128 a[24:27], v2 offset:6144
v_lshlrev_b32 v24, 16, v234
v_mfma_f32_16x16x32_bf16 v[116:119], a[108:111], a[132:135], v[116:119]
v_lshlrev_b32 v247, 16, v243
v_fmac_f32 v255, v22, v30
v_mfma_f32_16x16x32_bf16 v[120:123], a[112:115], a[128:131], v[120:123]
ds_read_b128 a[28:31], v3 offset:6144
v_fmac_f32 v255, v23, v29
v_mfma_f32_16x16x32_bf16 v[120:123], a[116:119], a[132:135], v[120:123]
buffer_load_dwordx4 v15, s[8:11], s25 offen offset:3072 lds
v_fmac_f32 v255, v24, v28
v_mfma_f32_16x16x32_bf16 v[124:127], a[120:123], a[128:131], v[124:127]
s_add_u32 s25, s25, 128
v_mul_f32 v255, v255, v247
v_cvt_pk_bf16_f32 v246, v254, v255
v_mfma_f32_16x16x32_bf16 v[124:127], a[124:127], a[132:135], v[124:127]
s_waitcnt lgkmcnt(2)
v_accvgpr_write_b32 a183, v246
v_mul_f32 v254, v22, v253
v_mfma_f32_16x16x32_bf16 v[128:131], a[64:67], a[136:139], v[128:131]
PAD_24:
s_cbranch_execz PAD_28
ds_read_b64_tr_b16 a[128:129], v8 offset:32768
v_lshlrev_b32 v25, 16, v235
v_mfma_f32_16x16x32_bf16 v[128:131], a[68:71], a[140:143], v[128:131]
buffer_load_dword v21, v20, s[16:19], s43 offen
v_mfma_f32_16x16x32_bf16 v[132:135], a[72:75], a[136:139], v[132:135]
s_add_u32 s43, s43, s47
ds_read_b64_tr_b16 a[130:131], v8 offset:34816
v_lshlrev_b32 v247, 16, v244
v_mfma_f32_16x16x32_bf16 v[132:135], a[76:79], a[140:143], v[132:135]
s_cmp_ge_u32 s43, s51
v_fmac_f32 v254, v23, v30
v_fmac_f32 v254, v24, v29
v_mfma_f32_16x16x32_bf16 v[136:139], a[80:83], a[136:139], v[136:139]
s_cselect_b32 s43, 0, s43
ds_read_b64_tr_b16 a[132:133], v8 offset:49152
v_fmac_f32 v254, v25, v28
v_mul_f32 v254, v254, v247
v_mfma_f32_16x16x32_bf16 v[136:139], a[84:87], a[140:143], v[136:139]
s_cselect_b32 s51, s42, s51
v_cvt_pk_bf16_f32 v246, v255, v254
v_accvgpr_write_b32 a179, v246
v_mfma_f32_16x16x32_bf16 v[140:143], a[88:91], a[136:139], v[140:143]
s_cselect_b64 s[16:17], s[40:41], s[16:17]
ds_read_b64_tr_b16 a[134:135], v8 offset:51200
v_lshlrev_b32 v28, 16, v250
v_mfma_f32_16x16x32_bf16 v[140:143], a[92:95], a[140:143], v[140:143]
s_cselect_b32 s18, s42, s18
v_and_b32 v29, s58, v250
v_lshlrev_b32 v30, 16, v251
v_mfma_f32_16x16x32_bf16 v[144:147], a[96:99], a[136:139], v[144:147]
s_cselect_b64 s[40:41], s[44:45], s[40:41]
ds_read_b128 a[32:35], v2 offset:8192
v_and_b32 v253, s58, v251
v_mfma_f32_16x16x32_bf16 v[144:147], a[100:103], a[140:143], v[144:147]
s_cselect_b32 s42, s46, s42
v_and_b32 v22, s58, v224
v_and_b32 v23, s58, v225
v_mfma_f32_16x16x32_bf16 v[148:151], a[104:107], a[136:139], v[148:151]
s_cselect_b32 s46, 0, s46
v_and_b32 v24, s58, v226
v_mul_f32 v254, v22, v253
v_mfma_f32_16x16x32_bf16 v[148:151], a[108:111], a[140:143], v[148:151]
buffer_load_dword v245, off, s[60:63], s54 sc1
v_mfma_f32_16x16x32_bf16 v[152:155], a[112:115], a[136:139], v[152:155]
ds_read_b128 a[36:39], v3 offset:8192
v_and_b32 v25, s58, v227
v_and_b32 v247, s58, v236
v_mfma_f32_16x16x32_bf16 v[152:155], a[116:119], a[140:143], v[152:155]
v_fmac_f32 v254, v23, v30
v_fmac_f32 v254, v24, v29
v_mfma_f32_16x16x32_bf16 v[156:159], a[120:123], a[136:139], v[156:159]
ds_read_b128 a[40:43], v2 offset:10240
v_fmac_f32 v254, v25, v28
v_mfma_f32_16x16x32_bf16 v[156:159], a[124:127], a[140:143], v[156:159]
s_waitcnt lgkmcnt(3)
v_mul_f32 v254, v254, v247
v_mul_f32 v255, v23, v253
v_mfma_f32_16x16x32_bf16 v[160:163], a[64:67], a[128:131], v[160:163]
ds_read_b64_tr_b16 a[136:137], v9 offset:32768
v_and_b32 v22, s58, v228
v_mfma_f32_16x16x32_bf16 v[160:163], a[68:71], a[132:135], v[160:163]
v_and_b32 v247, s58, v237
v_fmac_f32 v255, v24, v30
v_mfma_f32_16x16x32_bf16 v[164:167], a[72:75], a[128:131], v[164:167]
ds_read_b64_tr_b16 a[138:139], v9 offset:34816
v_fmac_f32 v255, v25, v29
v_mfma_f32_16x16x32_bf16 v[164:167], a[76:79], a[132:135], v[164:167]
v_fmac_f32 v255, v22, v28
v_mul_f32 v255, v255, v247
v_mfma_f32_16x16x32_bf16 v[168:171], a[80:83], a[128:131], v[168:171]
ds_read_b64_tr_b16 a[140:141], v9 offset:49152
v_cvt_pk_bf16_f32 v246, v254, v255
v_accvgpr_write_b32 a188, v246
v_mfma_f32_16x16x32_bf16 v[168:171], a[84:87], a[132:135], v[168:171]
v_mul_f32 v254, v24, v253
v_and_b32 v23, s58, v229
v_mfma_f32_16x16x32_bf16 v[172:175], a[88:91], a[128:131], v[172:175]
ds_read_b64_tr_b16 a[142:143], v9 offset:51200
v_and_b32 v247, s58, v238
v_mfma_f32_16x16x32_bf16 v[172:175], a[92:95], a[132:135], v[172:175]
v_fmac_f32 v254, v25, v30
v_fmac_f32 v254, v22, v29
v_mfma_f32_16x16x32_bf16 v[176:179], a[96:99], a[128:131], v[176:179]
v_fmac_f32 v254, v23, v28
v_mul_f32 v254, v254, v247
v_mfma_f32_16x16x32_bf16 v[176:179], a[100:103], a[132:135], v[176:179]
v_cvt_pk_bf16_f32 v246, v255, v254
v_accvgpr_write_b32 a184, v246
v_mfma_f32_16x16x32_bf16 v[180:183], a[104:107], a[128:131], v[180:183]
ds_read_b128 a[44:47], v3 offset:10240
v_mul_f32 v255, v25, v253
v_mfma_f32_16x16x32_bf16 v[180:183], a[108:111], a[132:135], v[180:183]
v_and_b32 v24, s58, v230
v_and_b32 v247, s58, v239
v_fmac_f32 v255, v22, v30
v_mfma_f32_16x16x32_bf16 v[184:187], a[112:115], a[128:131], v[184:187]
ds_read_b128 a[48:51], v2 offset:12288
v_fmac_f32 v255, v23, v29
v_mfma_f32_16x16x32_bf16 v[184:187], a[116:119], a[132:135], v[184:187]
v_fmac_f32 v255, v24, v28
v_mul_f32 v255, v255, v247
v_mfma_f32_16x16x32_bf16 v[188:191], a[120:123], a[128:131], v[188:191]
v_cvt_pk_bf16_f32 v246, v254, v255
v_accvgpr_write_b32 a189, v246
v_mfma_f32_16x16x32_bf16 v[188:191], a[124:127], a[132:135], v[188:191]
s_waitcnt lgkmcnt(2)
v_mul_f32 v254, v22, v253
v_and_b32 v25, s58, v231
v_mfma_f32_16x16x32_bf16 v[192:195], a[64:67], a[136:139], v[192:195]
ds_read_b64_tr_b16 a[128:129], v10 offset:32768
v_and_b32 v247, s58, v240
v_mfma_f32_16x16x32_bf16 v[192:195], a[68:71], a[140:143], v[192:195]
v_fmac_f32 v254, v23, v30
v_fmac_f32 v254, v24, v29
v_mfma_f32_16x16x32_bf16 v[196:199], a[72:75], a[136:139], v[196:199]
ds_read_b64_tr_b16 a[130:131], v10 offset:34816
v_fmac_f32 v254, v25, v28
v_mfma_f32_16x16x32_bf16 v[196:199], a[76:79], a[140:143], v[196:199]
v_mul_f32 v254, v254, v247
v_cvt_pk_bf16_f32 v246, v255, v254
v_accvgpr_write_b32 a185, v246
v_mfma_f32_16x16x32_bf16 v[200:203], a[80:83], a[136:139], v[200:203]
s_lshr_b32 s22, s3, 1
ds_read_b64_tr_b16 a[132:133], v10 offset:49152
v_mul_f32 v255, v23, v253
v_mfma_f32_16x16x32_bf16 v[200:203], a[84:87], a[140:143], v[200:203]
s_mul_i32 s22, s22, 2097152
v_and_b32 v22, s58, v232
v_and_b32 v247, s58, v241
v_mfma_f32_16x16x32_bf16 v[204:207], a[88:91], a[136:139], v[204:207]
s_and_b32 s23, s3, 1
ds_read_b64_tr_b16 a[134:135], v10 offset:51200
v_fmac_f32 v255, v24, v30
v_mfma_f32_16x16x32_bf16 v[204:207], a[92:95], a[140:143], v[204:207]
s_lshl_b32 s23, s23, 5
v_fmac_f32 v255, v25, v29
v_fmac_f32 v255, v22, v28
v_mfma_f32_16x16x32_bf16 v[208:211], a[96:99], a[136:139], v[208:211]
s_lshl_b32 s56, s39, 6
ds_read_b128 a[52:55], v3 offset:12288
v_mul_f32 v255, v255, v247
v_mfma_f32_16x16x32_bf16 v[208:211], a[100:103], a[140:143], v[208:211]
s_add_u32 s23, s23, s56
v_cvt_pk_bf16_f32 v246, v254, v255
v_accvgpr_write_b32 a190, v246
v_mfma_f32_16x16x32_bf16 v[212:215], a[104:107], a[136:139], v[212:215]
s_mul_i32 s23, s23, 4224
ds_read_b128 a[56:59], v2 offset:14336
v_mul_f32 v254, v24, v253
v_and_b32 v23, s58, v233
v_mfma_f32_16x16x32_bf16 v[212:215], a[108:111], a[140:143], v[212:215]
s_add_u32 s22, s22, s23
v_and_b32 v247, s58, v242
v_fmac_f32 v254, v25, v30
v_mfma_f32_16x16x32_bf16 v[216:219], a[112:115], a[136:139], v[216:219]
s_add_u32 s57, s22, 83886200
v_fmac_f32 v254, v22, v29
v_fmac_f32 v254, v23, v28
v_mfma_f32_16x16x32_bf16 v[216:219], a[116:119], a[140:143], v[216:219]
s_lshl_b32 s23, s38, 7
v_mul_f32 v254, v254, v247
v_cvt_pk_bf16_f32 v246, v255, v254
v_mfma_f32_16x16x32_bf16 v[220:223], a[120:123], a[136:139], v[220:223]
s_add_u32 s22, s22, s23
ds_read_b128 a[60:63], v3 offset:14336
v_accvgpr_write_b32 a186, v246
v_mfma_f32_16x16x32_bf16 v[220:223], a[124:127], a[140:143], v[220:223]
s_waitcnt lgkmcnt(3)
s_add_u32 s56, s22, 83886208
v_mul_f32 v255, v25, v253
v_and_b32 v24, s58, v234
v_mfma_f32_16x16x32_bf16 a[192:195], a[64:67], a[128:131], a[192:195]
s_cmp_lt_u32 s2, 224
ds_read_b64_tr_b16 a[136:137], v11 offset:32768
v_and_b32 v247, s58, v243
v_mfma_f32_16x16x32_bf16 a[192:195], a[68:71], a[132:135], a[192:195]
s_cselect_b32 s56, s56, 3221225472
v_fmac_f32 v255, v22, v30
v_fmac_f32 v255, v23, v29
v_mfma_f32_16x16x32_bf16 a[196:199], a[72:75], a[128:131], a[196:199]
s_cmp_eq_u32 s38, 0
ds_read_b64_tr_b16 a[138:139], v11 offset:34816
v_fmac_f32 v255, v24, v28
v_mul_f32 v255, v255, v247
v_mfma_f32_16x16x32_bf16 a[196:199], a[76:79], a[132:135], a[196:199]
s_cselect_b32 s57, s57, 3221225472
v_cvt_pk_bf16_f32 v246, v254, v255
v_accvgpr_write_b32 a191, v246
v_mfma_f32_16x16x32_bf16 a[200:203], a[80:83], a[128:131], a[200:203]
ds_read_b64_tr_b16 a[140:141], v11 offset:49152
v_mul_f32 v254, v22, v253
v_mfma_f32_16x16x32_bf16 a[200:203], a[84:87], a[132:135], a[200:203]
v_and_b32 v25, s58, v235
v_and_b32 v247, s58, v244
v_mfma_f32_16x16x32_bf16 a[204:207], a[88:91], a[128:131], a[204:207]
ds_read_b64_tr_b16 a[142:143], v11 offset:51200
v_fmac_f32 v254, v23, v30
v_mfma_f32_16x16x32_bf16 a[204:207], a[92:95], a[132:135], a[204:207]
ds_write_b128 v252, a[176:179] offset:0
v_fmac_f32 v254, v24, v29
v_mfma_f32_16x16x32_bf16 a[208:211], a[96:99], a[128:131], a[208:211]
v_fmac_f32 v254, v25, v28
v_mul_f32 v254, v254, v247
v_mfma_f32_16x16x32_bf16 a[208:211], a[100:103], a[132:135], a[208:211]
ds_write_b128 v252, a[180:183] offset:8192
v_cvt_pk_bf16_f32 v246, v255, v254
v_accvgpr_write_b32 a187, v246
v_mfma_f32_16x16x32_bf16 a[212:215], a[104:107], a[128:131], a[212:215]
v_mfma_f32_16x16x32_bf16 a[212:215], a[108:111], a[132:135], a[212:215]
ds_write_b128 v252, a[184:187] offset:128
v_mfma_f32_16x16x32_bf16 a[216:219], a[112:115], a[128:131], a[216:219]
v_mfma_f32_16x16x32_bf16 a[216:219], a[116:119], a[132:135], a[216:219]
ds_write_b128 v252, a[188:191] offset:8320
v_mfma_f32_16x16x32_bf16 a[220:223], a[120:123], a[128:131], a[220:223]
s_waitcnt vmcnt(2) lgkmcnt(0)
v_mfma_f32_16x16x32_bf16 a[220:223], a[124:127], a[132:135], a[220:223]
s_barrier
v_mfma_f32_16x16x32_bf16 a[224:227], a[64:67], a[136:139], a[224:227]
s_add_u32 m0, s29, 98304
ds_read_b64_tr_b16 a[128:129], v4 offset:0
v_lshrrev_b32 v22, 8, v1
v_mfma_f32_16x16x32_bf16 a[224:227], a[68:71], a[140:143], a[224:227]
buffer_load_dwordx4 v16, s[12:15], s26 offen offset:0 lds
v_mfma_f32_16x16x32_bf16 a[228:231], a[72:75], a[136:139], a[228:231]
ds_read_b64_tr_b16 a[130:131], v4 offset:2048
v_lshlrev_b32 v22, 4, v22
v_mfma_f32_16x16x32_bf16 a[228:231], a[76:79], a[140:143], a[228:231]
v_xor_b32 v22, v22, v1
v_add_u32 v22, s29, v22
v_mfma_f32_16x16x32_bf16 a[232:235], a[80:83], a[136:139], a[232:235]
ds_read_b64_tr_b16 a[132:133], v4 offset:16384
v_add_u32 v22, 147456, v22
v_mfma_f32_16x16x32_bf16 a[232:235], a[84:87], a[140:143], a[232:235]
buffer_load_dwordx4 v17, s[12:15], s26 offen offset:1024 lds
v_mfma_f32_16x16x32_bf16 a[236:239], a[88:91], a[136:139], a[236:239]
ds_read_b64_tr_b16 a[134:135], v4 offset:18432
v_xor_b32 v23, 64, v22
v_mfma_f32_16x16x32_bf16 a[236:239], a[92:95], a[140:143], a[236:239]
v_lshrrev_b32 v224, 7, v1
v_mul_u32_u24 v224, 4224, v224
v_mfma_f32_16x16x32_bf16 a[240:243], a[96:99], a[136:139], a[240:243]
v_and_b32 v225, 0x70, v1
v_add_u32 v224, v224, v225
v_mfma_f32_16x16x32_bf16 a[240:243], a[100:103], a[140:143], a[240:243]
buffer_load_dwordx4 v18, s[12:15], s26 offen offset:2048 lds
v_mfma_f32_16x16x32_bf16 a[244:247], a[104:107], a[136:139], a[244:247]
v_bfe_u32 v225, v1, 4, 5
v_mul_u32_u24 v225, 4224, v225
v_mfma_f32_16x16x32_bf16 a[244:247], a[108:111], a[140:143], a[244:247]
v_mov_b32 v226, 0
v_mov_b32 v227, 0
v_mfma_f32_16x16x32_bf16 a[248:251], a[112:115], a[136:139], a[248:251]
v_mfma_f32_16x16x32_bf16 a[248:251], a[116:119], a[140:143], a[248:251]
buffer_load_dwordx4 v19, s[12:15], s26 offen offset:3072 lds
v_mfma_f32_16x16x32_bf16 a[252:255], a[120:123], a[136:139], a[252:255]
s_add_u32 s26, s26, 524288
v_mfma_f32_16x16x32_bf16 a[252:255], a[124:127], a[140:143], a[252:255]
s_waitcnt lgkmcnt(0)
v_mfma_f32_16x16x32_bf16 v[32:35], a[0:3], a[128:131], v[32:35]
s_add_u32 m0, s29, 114688
ds_read_b64_tr_b16 a[136:137], v5 offset:0
v_mfma_f32_16x16x32_bf16 v[32:35], a[4:7], a[132:135], v[32:35]
buffer_load_dwordx4 v16, s[12:15], s27 offen offset:0 lds
v_mfma_f32_16x16x32_bf16 v[36:39], a[8:11], a[128:131], v[36:39]
s_mul_i32 s52, s20, 7
ds_read_b64_tr_b16 a[138:139], v5 offset:2048
v_mfma_f32_16x16x32_bf16 v[36:39], a[12:15], a[132:135], v[36:39]
s_add_u32 s52, s52, s21
buffer_store_dwordx2 v[226:227], v225, s[4:7], s57 offen sc1
v_mfma_f32_16x16x32_bf16 v[40:43], a[16:19], a[128:131], v[40:43]
s_lshl_b32 s53, s52, 2
ds_read_b64_tr_b16 a[140:141], v5 offset:16384
v_mfma_f32_16x16x32_bf16 v[40:43], a[20:23], a[132:135], v[40:43]
s_add_u32 s53, s53, s3
buffer_load_dwordx4 v17, s[12:15], s27 offen offset:1024 lds
v_mfma_f32_16x16x32_bf16 v[44:47], a[24:27], a[128:131], v[44:47]
s_lshl_b32 s49, s53, 12
ds_read_b64_tr_b16 a[142:143], v5 offset:18432
v_mfma_f32_16x16x32_bf16 v[44:47], a[28:31], a[132:135], v[44:47]
s_mul_i32 s53, s53, 4224
v_mfma_f32_16x16x32_bf16 v[48:51], a[32:35], a[128:131], v[48:51]
s_add_u32 s53, s53, 83886080
ds_read_b128 a[64:67], v2 offset:32768
v_mfma_f32_16x16x32_bf16 v[48:51], a[36:39], a[132:135], v[48:51]
s_lshr_b32 s52, s52, 4
buffer_load_dwordx4 v18, s[12:15], s27 offen offset:2048 lds
v_mfma_f32_16x16x32_bf16 v[52:55], a[40:43], a[128:131], v[52:55]
s_min_u32 s52, s52, 6
ds_read_b128 a[68:71], v3 offset:32768
v_mfma_f32_16x16x32_bf16 v[52:55], a[44:47], a[132:135], v[52:55]
s_lshl_b32 s52, s52, 7
ds_read_b128 a[176:179], v22 offset:0
v_mfma_f32_16x16x32_bf16 v[56:59], a[48:51], a[128:131], v[56:59]
s_add_u32 s52, s52, 94392320
ds_read_b128 a[180:183], v23 offset:1024
v_mfma_f32_16x16x32_bf16 v[56:59], a[52:55], a[132:135], v[56:59]
buffer_load_dwordx4 v19, s[12:15], s27 offen offset:3072 lds
v_mfma_f32_16x16x32_bf16 v[60:63], a[56:59], a[128:131], v[60:63]
s_add_u32 s27, s27, 524288
ds_read_b128 a[72:75], v2 offset:34816
v_mfma_f32_16x16x32_bf16 v[60:63], a[60:63], a[132:135], v[60:63]
s_waitcnt lgkmcnt(5)
ds_read_b128 a[184:187], v22 offset:2048
v_mfma_f32_16x16x32_bf16 v[64:67], a[0:3], a[136:139], v[64:67]
s_add_u32 m0, s28, 0
ds_read_b64_tr_b16 a[128:129], v6 offset:0
v_mfma_f32_16x16x32_bf16 v[64:67], a[4:7], a[140:143], v[64:67]
buffer_load_dwordx4 v12, s[8:11], s24 offen offset:0 lds
v_mfma_f32_16x16x32_bf16 v[68:71], a[8:11], a[136:139], v[68:71]
ds_read_b64_tr_b16 a[130:131], v6 offset:2048
v_mfma_f32_16x16x32_bf16 v[68:71], a[12:15], a[140:143], v[68:71]
ds_read_b128 a[188:191], v23 offset:3072
v_mfma_f32_16x16x32_bf16 v[72:75], a[16:19], a[136:139], v[72:75]
ds_read_b64_tr_b16 a[132:133], v6 offset:16384
v_bfe_u32 v231, v1, 4, 5
v_mfma_f32_16x16x32_bf16 v[72:75], a[20:23], a[140:143], v[72:75]
buffer_load_dwordx4 v13, s[8:11], s24 offen offset:1024 lds
v_mfma_f32_16x16x32_bf16 v[76:79], a[24:27], a[136:139], v[76:79]
ds_read_b64_tr_b16 a[134:135], v6 offset:18432
v_lshlrev_b32 v231, 2, v231
v_mfma_f32_16x16x32_bf16 v[76:79], a[28:31], a[140:143], v[76:79]
v_lshlrev_b32 v229, 3, v1
v_min_u32 v229, 4096, v229
v_mfma_f32_16x16x32_bf16 v[80:83], a[32:35], a[136:139], v[80:83]
ds_read_b128 a[76:79], v3 offset:34816
v_mfma_f32_16x16x32_bf16 v[80:83], a[36:39], a[140:143], v[80:83]
buffer_load_dwordx4 v14, s[8:11], s24 offen offset:2048 lds
v_mfma_f32_16x16x32_bf16 v[84:87], a[40:43], a[136:139], v[84:87]
v_mfma_f32_16x16x32_bf16 v[84:87], a[44:47], a[140:143], v[84:87]
v_mfma_f32_16x16x32_bf16 v[88:91], a[48:51], a[136:139], v[88:91]
ds_read_b128 a[80:83], v2 offset:36864
v_mfma_f32_16x16x32_bf16 v[88:91], a[52:55], a[140:143], v[88:91]
buffer_load_dwordx4 v15, s[8:11], s24 offen offset:3072 lds
v_mfma_f32_16x16x32_bf16 v[92:95], a[56:59], a[136:139], v[92:95]
s_add_u32 s24, s24, 128
ds_read_b128 a[84:87], v3 offset:36864
v_mfma_f32_16x16x32_bf16 v[92:95], a[60:63], a[140:143], v[92:95]
s_waitcnt lgkmcnt(3)
v_mfma_f32_16x16x32_bf16 v[96:99], a[0:3], a[128:131], v[96:99]
s_add_u32 m0, s28, 4096
ds_read_b64_tr_b16 a[136:137], v7 offset:0
v_mfma_f32_16x16x32_bf16 v[96:99], a[4:7], a[132:135], v[96:99]
buffer_load_dwordx4 v12, s[8:11], s25 offen offset:0 lds
v_mfma_f32_16x16x32_bf16 v[100:103], a[8:11], a[128:131], v[100:103]
ds_read_b64_tr_b16 a[138:139], v7 offset:2048
v_mfma_f32_16x16x32_bf16 v[100:103], a[12:15], a[132:135], v[100:103]
v_mfma_f32_16x16x32_bf16 v[104:107], a[16:19], a[128:131], v[104:107]
ds_read_b64_tr_b16 a[140:141], v7 offset:16384
v_mfma_f32_16x16x32_bf16 v[104:107], a[20:23], a[132:135], v[104:107]
buffer_load_dwordx4 v13, s[8:11], s25 offen offset:1024 lds
v_mfma_f32_16x16x32_bf16 v[108:111], a[24:27], a[128:131], v[108:111]
ds_read_b64_tr_b16 a[142:143], v7 offset:18432
v_mfma_f32_16x16x32_bf16 v[108:111], a[28:31], a[132:135], v[108:111]
v_mfma_f32_16x16x32_bf16 v[112:115], a[32:35], a[128:131], v[112:115]
v_mfma_f32_16x16x32_bf16 v[112:115], a[36:39], a[132:135], v[112:115]
buffer_load_dwordx4 v14, s[8:11], s25 offen offset:2048 lds
v_mfma_f32_16x16x32_bf16 v[116:119], a[40:43], a[128:131], v[116:119]
ds_read_b128 a[88:91], v2 offset:38912
v_mfma_f32_16x16x32_bf16 v[116:119], a[44:47], a[132:135], v[116:119]
v_mfma_f32_16x16x32_bf16 v[120:123], a[48:51], a[128:131], v[120:123]
ds_read_b128 a[92:95], v3 offset:38912
v_mfma_f32_16x16x32_bf16 v[120:123], a[52:55], a[132:135], v[120:123]
buffer_load_dwordx4 v15, s[8:11], s25 offen offset:3072 lds
v_mfma_f32_16x16x32_bf16 v[124:127], a[56:59], a[128:131], v[124:127]
s_add_u32 s25, s25, 128
v_mfma_f32_16x16x32_bf16 v[124:127], a[60:63], a[132:135], v[124:127]
s_waitcnt lgkmcnt(2)
v_mfma_f32_16x16x32_bf16 v[128:131], a[0:3], a[136:139], v[128:131]
ds_read_b64_tr_b16 a[128:129], v8 offset:0
v_mfma_f32_16x16x32_bf16 v[128:131], a[4:7], a[140:143], v[128:131]
buffer_store_dwordx4 a[176:179], v224, s[4:7], s56 offen sc1
v_mfma_f32_16x16x32_bf16 v[132:135], a[8:11], a[136:139], v[132:135]
s_add_u32 s56, s56, 33792
ds_read_b64_tr_b16 a[130:131], v8 offset:2048
v_mfma_f32_16x16x32_bf16 v[132:135], a[12:15], a[140:143], v[132:135]
v_mfma_f32_16x16x32_bf16 v[136:139], a[16:19], a[136:139], v[136:139]
ds_read_b64_tr_b16 a[132:133], v8 offset:16384
v_mfma_f32_16x16x32_bf16 v[136:139], a[20:23], a[140:143], v[136:139]
v_mfma_f32_16x16x32_bf16 v[140:143], a[24:27], a[136:139], v[140:143]
s_cmp_lt_u32 s21, 7
ds_read_b64_tr_b16 a[134:135], v8 offset:18432
v_mfma_f32_16x16x32_bf16 v[140:143], a[28:31], a[140:143], v[140:143]
s_cselect_b32 s53, s53, 3221225472
v_mfma_f32_16x16x32_bf16 v[144:147], a[32:35], a[136:139], v[144:147]
s_cselect_b32 s49, s49, 3221225472
ds_read_b128 a[96:99], v2 offset:40960
v_mfma_f32_16x16x32_bf16 v[144:147], a[36:39], a[140:143], v[144:147]
s_add_u32 s48, s53, 2097152
v_mfma_f32_16x16x32_bf16 v[148:151], a[40:43], a[136:139], v[148:151]
v_mfma_f32_16x16x32_bf16 v[148:151], a[44:47], a[140:143], v[148:151]
v_mfma_f32_16x16x32_bf16 v[152:155], a[48:51], a[136:139], v[152:155]
ds_read_b128 a[100:103], v3 offset:40960
v_mfma_f32_16x16x32_bf16 v[152:155], a[52:55], a[140:143], v[152:155]
v_mfma_f32_16x16x32_bf16 v[156:159], a[56:59], a[136:139], v[156:159]
ds_read_b128 a[104:107], v2 offset:43008
v_mfma_f32_16x16x32_bf16 v[156:159], a[60:63], a[140:143], v[156:159]
s_waitcnt lgkmcnt(3)
v_mfma_f32_16x16x32_bf16 v[160:163], a[0:3], a[128:131], v[160:163]
ds_read_b64_tr_b16 a[136:137], v9 offset:0
v_mfma_f32_16x16x32_bf16 v[160:163], a[4:7], a[132:135], v[160:163]
v_mfma_f32_16x16x32_bf16 v[164:167], a[8:11], a[128:131], v[164:167]
ds_read_b64_tr_b16 a[138:139], v9 offset:2048
v_mfma_f32_16x16x32_bf16 v[164:167], a[12:15], a[132:135], v[164:167]
buffer_store_dwordx4 a[180:183], v224, s[4:7], s56 offen sc1
v_mfma_f32_16x16x32_bf16 v[168:171], a[16:19], a[128:131], v[168:171]
s_add_u32 s56, s56, 33792
ds_read_b64_tr_b16 a[140:141], v9 offset:16384
v_mfma_f32_16x16x32_bf16 v[168:171], a[20:23], a[132:135], v[168:171]
v_mfma_f32_16x16x32_bf16 v[172:175], a[24:27], a[128:131], v[172:175]
ds_read_b64_tr_b16 a[142:143], v9 offset:18432
v_mfma_f32_16x16x32_bf16 v[172:175], a[28:31], a[132:135], v[172:175]
v_mfma_f32_16x16x32_bf16 v[176:179], a[32:35], a[128:131], v[176:179]
v_mfma_f32_16x16x32_bf16 v[176:179], a[36:39], a[132:135], v[176:179]
v_mfma_f32_16x16x32_bf16 v[180:183], a[40:43], a[128:131], v[180:183]
ds_read_b128 a[108:111], v3 offset:43008
v_mfma_f32_16x16x32_bf16 v[180:183], a[44:47], a[132:135], v[180:183]
v_mfma_f32_16x16x32_bf16 v[184:187], a[48:51], a[128:131], v[184:187]
ds_read_b128 a[112:115], v2 offset:45056
v_mfma_f32_16x16x32_bf16 v[184:187], a[52:55], a[132:135], v[184:187]
v_mfma_f32_16x16x32_bf16 v[188:191], a[56:59], a[128:131], v[188:191]
v_mfma_f32_16x16x32_bf16 v[188:191], a[60:63], a[132:135], v[188:191]
s_waitcnt lgkmcnt(2)
v_mfma_f32_16x16x32_bf16 v[192:195], a[0:3], a[136:139], v[192:195]
ds_read_b64_tr_b16 a[128:129], v10 offset:0
v_mfma_f32_16x16x32_bf16 v[192:195], a[4:7], a[140:143], v[192:195]
v_mfma_f32_16x16x32_bf16 v[196:199], a[8:11], a[136:139], v[196:199]
ds_read_b64_tr_b16 a[130:131], v10 offset:2048
v_mfma_f32_16x16x32_bf16 v[196:199], a[12:15], a[140:143], v[196:199]
v_mfma_f32_16x16x32_bf16 v[200:203], a[16:19], a[136:139], v[200:203]
ds_read_b64_tr_b16 a[132:133], v10 offset:16384
v_mfma_f32_16x16x32_bf16 v[200:203], a[20:23], a[140:143], v[200:203]
buffer_store_dwordx4 a[184:187], v224, s[4:7], s56 offen sc1
v_mfma_f32_16x16x32_bf16 v[204:207], a[24:27], a[136:139], v[204:207]
s_add_u32 s56, s56, 33792
ds_read_b64_tr_b16 a[134:135], v10 offset:18432
v_mfma_f32_16x16x32_bf16 v[204:207], a[28:31], a[140:143], v[204:207]
v_mfma_f32_16x16x32_bf16 v[208:211], a[32:35], a[136:139], v[208:211]
ds_read_b128 a[116:119], v3 offset:45056
v_mfma_f32_16x16x32_bf16 v[208:211], a[36:39], a[140:143], v[208:211]
v_mfma_f32_16x16x32_bf16 v[212:215], a[40:43], a[136:139], v[212:215]
ds_read_b128 a[120:123], v2 offset:47104
v_mfma_f32_16x16x32_bf16 v[212:215], a[44:47], a[140:143], v[212:215]
v_mfma_f32_16x16x32_bf16 v[216:219], a[48:51], a[136:139], v[216:219]
v_mfma_f32_16x16x32_bf16 v[216:219], a[52:55], a[140:143], v[216:219]
v_mfma_f32_16x16x32_bf16 v[220:223], a[56:59], a[136:139], v[220:223]
ds_read_b128 a[124:127], v3 offset:47104
v_mfma_f32_16x16x32_bf16 v[220:223], a[60:63], a[140:143], v[220:223]
s_waitcnt lgkmcnt(3)
v_mfma_f32_16x16x32_bf16 a[192:195], a[0:3], a[128:131], a[192:195]
ds_read_b64_tr_b16 a[136:137], v11 offset:0
v_mfma_f32_16x16x32_bf16 a[192:195], a[4:7], a[132:135], a[192:195]
v_mfma_f32_16x16x32_bf16 a[196:199], a[8:11], a[128:131], a[196:199]
ds_read_b64_tr_b16 a[138:139], v11 offset:2048
v_mfma_f32_16x16x32_bf16 a[196:199], a[12:15], a[132:135], a[196:199]
v_mfma_f32_16x16x32_bf16 a[200:203], a[16:19], a[128:131], a[200:203]
ds_read_b64_tr_b16 a[140:141], v11 offset:16384
v_mfma_f32_16x16x32_bf16 a[200:203], a[20:23], a[132:135], a[200:203]
v_mfma_f32_16x16x32_bf16 a[204:207], a[24:27], a[128:131], a[204:207]
ds_read_b64_tr_b16 a[142:143], v11 offset:18432
v_mfma_f32_16x16x32_bf16 a[204:207], a[28:31], a[132:135], a[204:207]
buffer_store_dwordx4 a[188:191], v224, s[4:7], s56 offen sc1
v_mfma_f32_16x16x32_bf16 a[208:211], a[32:35], a[128:131], a[208:211]
s_add_u32 s56, s56, 33792
v_mfma_f32_16x16x32_bf16 a[208:211], a[36:39], a[132:135], a[208:211]
v_mfma_f32_16x16x32_bf16 a[212:215], a[40:43], a[128:131], a[212:215]
v_mfma_f32_16x16x32_bf16 a[212:215], a[44:47], a[132:135], a[212:215]
v_mfma_f32_16x16x32_bf16 a[216:219], a[48:51], a[128:131], a[216:219]
v_mfma_f32_16x16x32_bf16 a[216:219], a[52:55], a[132:135], a[216:219]
v_mfma_f32_16x16x32_bf16 a[220:223], a[56:59], a[128:131], a[220:223]
s_waitcnt vmcnt(4) lgkmcnt(0)
v_mfma_f32_16x16x32_bf16 a[220:223], a[60:63], a[132:135], a[220:223]
s_barrier
v_mfma_f32_16x16x32_bf16 a[224:227], a[0:3], a[136:139], a[224:227]
s_add_u32 m0, s29, 65536
ds_read_b64_tr_b16 a[128:129], v4 offset:32768
v_mfma_f32_16x16x32_bf16 a[224:227], a[4:7], a[140:143], a[224:227]
buffer_load_dwordx4 v16, s[12:15], s26 offen offset:0 lds
v_mfma_f32_16x16x32_bf16 a[228:231], a[8:11], a[136:139], a[228:231]
ds_read_b64_tr_b16 a[130:131], v4 offset:34816
v_cmp_gt_u32 vcc, s50, v245
v_mfma_f32_16x16x32_bf16 a[228:231], a[12:15], a[140:143], a[228:231]
v_mfma_f32_16x16x32_bf16 a[232:235], a[16:19], a[136:139], a[232:235]
ds_read_b64_tr_b16 a[132:133], v4 offset:49152
v_mfma_f32_16x16x32_bf16 a[232:235], a[20:23], a[140:143], a[232:235]
buffer_load_dwordx4 v17, s[12:15], s26 offen offset:1024 lds
v_mfma_f32_16x16x32_bf16 a[236:239], a[24:27], a[136:139], a[236:239]
ds_read_b64_tr_b16 a[134:135], v4 offset:51200
v_mfma_f32_16x16x32_bf16 a[236:239], a[28:31], a[140:143], a[236:239]
v_mfma_f32_16x16x32_bf16 a[240:243], a[32:35], a[136:139], a[240:243]
v_mfma_f32_16x16x32_bf16 a[240:243], a[36:39], a[140:143], a[240:243]
buffer_load_dwordx4 v18, s[12:15], s26 offen offset:2048 lds
v_mfma_f32_16x16x32_bf16 a[244:247], a[40:43], a[136:139], a[244:247]
v_mfma_f32_16x16x32_bf16 a[244:247], a[44:47], a[140:143], a[244:247]
v_mfma_f32_16x16x32_bf16 a[248:251], a[48:51], a[136:139], a[248:251]
v_mfma_f32_16x16x32_bf16 a[248:251], a[52:55], a[140:143], a[248:251]
buffer_load_dwordx4 v19, s[12:15], s26 offen offset:3072 lds
v_mfma_f32_16x16x32_bf16 a[252:255], a[56:59], a[136:139], a[252:255]
s_add_u32 s26, s26, 524288
v_mfma_f32_16x16x32_bf16 a[252:255], a[60:63], a[140:143], a[252:255]
s_waitcnt lgkmcnt(0)
s_mov_b32 s82, s59
s_cbranch_vccnz M_cntspinV
s_branch Lg_501
PAD_25:
s_cbranch_execz PAD_29
Lg_501t:
buffer_load_dword v230, v231, s[4:7], s52 offen sc1
v_mfma_f32_16x16x32_bf16 v[32:35], a[64:67], a[128:131], v[32:35]
s_add_u32 m0, s29, 81920
ds_read_b64_tr_b16 a[136:137], v5 offset:32768
v_mfma_f32_16x16x32_bf16 v[32:35], a[68:71], a[132:135], v[32:35]
buffer_load_dwordx4 v16, s[12:15], s27 offen offset:0 lds
v_mfma_f32_16x16x32_bf16 v[36:39], a[72:75], a[128:131], v[36:39]
s_and_b32 s44, s3, 1
ds_read_b64_tr_b16 a[138:139], v5 offset:34816
v_mfma_f32_16x16x32_bf16 v[36:39], a[76:79], a[132:135], v[36:39]
s_lshl_b32 s44, s44, 8
v_mfma_f32_16x16x32_bf16 v[40:43], a[80:83], a[128:131], v[40:43]
s_lshl_b32 s45, s3, 7
ds_read_b64_tr_b16 a[140:141], v5 offset:49152
v_mfma_f32_16x16x32_bf16 v[40:43], a[84:87], a[132:135], v[40:43]
s_xor_b32 s44, s44, s45
buffer_load_dwordx4 v17, s[12:15], s27 offen offset:1024 lds
v_mfma_f32_16x16x32_bf16 v[44:47], a[88:91], a[128:131], v[44:47]
s_xor_b32 s44, s44, 196608
ds_read_b64_tr_b16 a[142:143], v5 offset:51200
v_mfma_f32_16x16x32_bf16 v[44:47], a[92:95], a[132:135], v[44:47]
v_mfma_f32_16x16x32_bf16 v[48:51], a[96:99], a[128:131], v[48:51]
ds_read_b128 a[0:3], v2 offset:0
v_mfma_f32_16x16x32_bf16 v[48:51], a[100:103], a[132:135], v[48:51]
buffer_load_dwordx4 v18, s[12:15], s27 offen offset:2048 lds
v_mfma_f32_16x16x32_bf16 v[52:55], a[104:107], a[128:131], v[52:55]
ds_read_b128 a[4:7], v3 offset:0
v_mfma_f32_16x16x32_bf16 v[52:55], a[108:111], a[132:135], v[52:55]
v_mfma_f32_16x16x32_bf16 v[56:59], a[112:115], a[128:131], v[56:59]
v_mfma_f32_16x16x32_bf16 v[56:59], a[116:119], a[132:135], v[56:59]
buffer_load_dwordx4 v19, s[12:15], s27 offen offset:3072 lds
v_mfma_f32_16x16x32_bf16 v[60:63], a[120:123], a[128:131], v[60:63]
s_add_u32 s27, s27, 524288
ds_read_b128 a[8:11], v2 offset:2048
v_mfma_f32_16x16x32_bf16 v[60:63], a[124:127], a[132:135], v[60:63]
s_waitcnt lgkmcnt(3)
v_mfma_f32_16x16x32_bf16 v[64:67], a[64:67], a[136:139], v[64:67]
s_add_u32 m0, s28, 32768
ds_read_b64_tr_b16 a[128:129], v6 offset:32768
v_mfma_f32_16x16x32_bf16 v[64:67], a[68:71], a[140:143], v[64:67]
buffer_load_dwordx4 v12, s[8:11], s24 offen offset:0 lds
v_mfma_f32_16x16x32_bf16 v[68:71], a[72:75], a[136:139], v[68:71]
ds_read_b64_tr_b16 a[130:131], v6 offset:34816
v_mfma_f32_16x16x32_bf16 v[68:71], a[76:79], a[140:143], v[68:71]
v_mfma_f32_16x16x32_bf16 v[72:75], a[80:83], a[136:139], v[72:75]
s_mov_b64 s[56:57], s[72:73]
ds_read_b64_tr_b16 a[132:133], v6 offset:49152
v_mfma_f32_16x16x32_bf16 v[72:75], a[84:87], a[140:143], v[72:75]
s_mov_b32 s58, 1835008
buffer_load_dwordx4 v13, s[8:11], s24 offen offset:1024 lds
v_mfma_f32_16x16x32_bf16 v[76:79], a[88:91], a[136:139], v[76:79]
s_mov_b32 s59, 0x20000
ds_read_b64_tr_b16 a[134:135], v6 offset:51200
v_mfma_f32_16x16x32_bf16 v[76:79], a[92:95], a[140:143], v[76:79]
v_mfma_f32_16x16x32_bf16 v[80:83], a[96:99], a[136:139], v[80:83]
ds_read_b128 a[12:15], v3 offset:2048
v_mfma_f32_16x16x32_bf16 v[80:83], a[100:103], a[140:143], v[80:83]
buffer_load_dwordx4 v14, s[8:11], s24 offen offset:2048 lds
v_mfma_f32_16x16x32_bf16 v[84:87], a[104:107], a[136:139], v[84:87]
v_mfma_f32_16x16x32_bf16 v[84:87], a[108:111], a[140:143], v[84:87]
v_mfma_f32_16x16x32_bf16 v[88:91], a[112:115], a[136:139], v[88:91]
ds_read_b128 a[16:19], v2 offset:4096
v_mfma_f32_16x16x32_bf16 v[88:91], a[116:119], a[140:143], v[88:91]
buffer_load_dwordx4 v15, s[8:11], s24 offen offset:3072 lds
v_mfma_f32_16x16x32_bf16 v[92:95], a[120:123], a[136:139], v[92:95]
s_add_u32 s24, s24, 128
ds_read_b128 a[20:23], v3 offset:4096
v_mfma_f32_16x16x32_bf16 v[92:95], a[124:127], a[140:143], v[92:95]
s_waitcnt lgkmcnt(3)
v_mfma_f32_16x16x32_bf16 v[96:99], a[64:67], a[128:131], v[96:99]
s_add_u32 m0, s28, 36864
ds_read_b64_tr_b16 a[136:137], v7 offset:32768
v_mfma_f32_16x16x32_bf16 v[96:99], a[68:71], a[132:135], v[96:99]
buffer_load_dwordx4 v12, s[8:11], s25 offen offset:0 lds
v_mfma_f32_16x16x32_bf16 v[100:103], a[72:75], a[128:131], v[100:103]
ds_read_b64_tr_b16 a[138:139], v7 offset:34816
v_mfma_f32_16x16x32_bf16 v[100:103], a[76:79], a[132:135], v[100:103]
PAD_26:
s_cbranch_execz PAD_30
v_mfma_f32_16x16x32_bf16 v[104:107], a[80:83], a[128:131], v[104:107]
ds_read_b64_tr_b16 a[140:141], v7 offset:49152
v_mfma_f32_16x16x32_bf16 v[104:107], a[84:87], a[132:135], v[104:107]
buffer_load_dwordx4 v13, s[8:11], s25 offen offset:1024 lds
v_mfma_f32_16x16x32_bf16 v[108:111], a[88:91], a[128:131], v[108:111]
ds_read_b64_tr_b16 a[142:143], v7 offset:51200
v_mfma_f32_16x16x32_bf16 v[108:111], a[92:95], a[132:135], v[108:111]
v_mfma_f32_16x16x32_bf16 v[112:115], a[96:99], a[128:131], v[112:115]
v_mfma_f32_16x16x32_bf16 v[112:115], a[100:103], a[132:135], v[112:115]
buffer_load_dwordx4 v14, s[8:11], s25 offen offset:2048 lds
v_mfma_f32_16x16x32_bf16 v[116:119], a[104:107], a[128:131], v[116:119]
ds_read_b128 a[24:27], v2 offset:6144
v_mfma_f32_16x16x32_bf16 v[116:119], a[108:111], a[132:135], v[116:119]
v_mfma_f32_16x16x32_bf16 v[120:123], a[112:115], a[128:131], v[120:123]
ds_read_b128 a[28:31], v3 offset:6144
v_mfma_f32_16x16x32_bf16 v[120:123], a[116:119], a[132:135], v[120:123]
buffer_load_dwordx4 v15, s[8:11], s25 offen offset:3072 lds
v_mfma_f32_16x16x32_bf16 v[124:127], a[120:123], a[128:131], v[124:127]
s_add_u32 s25, s25, 128
s_waitcnt vmcnt(12)
v_mfma_f32_16x16x32_bf16 v[124:127], a[124:127], a[132:135], v[124:127]
s_waitcnt lgkmcnt(2)
v_cmp_gt_u32 vcc, 1, v230
v_mfma_f32_16x16x32_bf16 v[128:131], a[64:67], a[136:139], v[128:131]
s_cbranch_vccnz M_ppspinV
M_ppokV:
ds_read_b64_tr_b16 a[128:129], v8 offset:32768
v_mfma_f32_16x16x32_bf16 v[128:131], a[68:71], a[140:143], v[128:131]
buffer_load_dword v230, v229, s[4:7], s53 offen sc1
v_mfma_f32_16x16x32_bf16 v[132:135], a[72:75], a[136:139], v[132:135]
s_mov_b64 s[8:9], s[76:77]
ds_read_b64_tr_b16 a[130:131], v8 offset:34816
v_mfma_f32_16x16x32_bf16 v[132:135], a[76:79], a[140:143], v[132:135]
s_mov_b32 s10, 1835008
buffer_load_dword v230, v229, s[4:7], s48 offen sc1
v_mfma_f32_16x16x32_bf16 v[136:139], a[80:83], a[136:139], v[136:139]
s_lshl_b32 s24, s37, 2
ds_read_b64_tr_b16 a[132:133], v8 offset:49152
v_mfma_f32_16x16x32_bf16 v[136:139], a[84:87], a[140:143], v[136:139]
s_add_u32 s24, s24, s3
buffer_load_dword v230, v229, s[56:59], s49 offen
v_mfma_f32_16x16x32_bf16 v[140:143], a[88:91], a[136:139], v[140:143]
s_mul_i32 s24, s24, 28672
ds_read_b64_tr_b16 a[134:135], v8 offset:51200
v_mfma_f32_16x16x32_bf16 v[140:143], a[92:95], a[140:143], v[140:143]
s_mov_b32 s28, s29
buffer_load_dword v21, v20, s[16:19], s43 offen
v_mfma_f32_16x16x32_bf16 v[144:147], a[96:99], a[136:139], v[144:147]
ds_read_b128 a[32:35], v2 offset:8192
v_mfma_f32_16x16x32_bf16 v[144:147], a[100:103], a[140:143], v[144:147]
buffer_load_dword v21, v20, s[16:19], s43 offen offset:256
v_mfma_f32_16x16x32_bf16 v[148:151], a[104:107], a[136:139], v[148:151]
buffer_load_dword v21, v20, s[16:19], s43 offen offset:512
v_mfma_f32_16x16x32_bf16 v[148:151], a[108:111], a[140:143], v[148:151]
buffer_load_dword v21, v20, s[16:19], s43 offen offset:768
v_mfma_f32_16x16x32_bf16 v[152:155], a[112:115], a[136:139], v[152:155]
ds_read_b128 a[36:39], v3 offset:8192
v_lshrrev_b32 v28, 7, v1
v_mfma_f32_16x16x32_bf16 v[152:155], a[116:119], a[140:143], v[152:155]
v_lshrrev_b32 v29, 1, v28
v_lshlrev_b32 v29, 4, v29
v_mfma_f32_16x16x32_bf16 v[156:159], a[120:123], a[136:139], v[156:159]
ds_read_b128 a[40:43], v2 offset:10240
v_and_b32 v30, 0x70, v1
v_mfma_f32_16x16x32_bf16 v[156:159], a[124:127], a[140:143], v[156:159]
s_waitcnt lgkmcnt(3)
v_xor_b32 v29, v29, v30
v_mul_u32_u24 v28, 896, v28
v_mfma_f32_16x16x32_bf16 v[160:163], a[64:67], a[128:131], v[160:163]
ds_read_b64_tr_b16 a[136:137], v9 offset:32768
v_add_u32 v12, v28, v29
v_mfma_f32_16x16x32_bf16 v[160:163], a[68:71], a[132:135], v[160:163]
v_xor_b32 v29, 64, v29
v_add_u32 v28, v28, v29
v_mfma_f32_16x16x32_bf16 v[164:167], a[72:75], a[128:131], v[164:167]
ds_read_b64_tr_b16 a[138:139], v9 offset:34816
v_add_u32 v13, 6144, v28
v_mfma_f32_16x16x32_bf16 v[164:167], a[76:79], a[132:135], v[164:167]
v_add_u32 v14, 12288, v12
v_add_u32 v15, 18432, v28
v_mfma_f32_16x16x32_bf16 v[168:171], a[80:83], a[128:131], v[168:171]
ds_read_b64_tr_b16 a[140:141], v9 offset:49152
v_xor_b32 v22, s44, v4
v_mfma_f32_16x16x32_bf16 v[168:171], a[84:87], a[132:135], v[168:171]
v_xor_b32 v23, 32, v22
v_xor_b32 v24, 64, v22
v_mfma_f32_16x16x32_bf16 v[172:175], a[88:91], a[128:131], v[172:175]
ds_read_b64_tr_b16 a[142:143], v9 offset:51200
v_xor_b32 v25, 96, v22
v_mfma_f32_16x16x32_bf16 v[172:175], a[92:95], a[132:135], v[172:175]
v_mfma_f32_16x16x32_bf16 v[176:179], a[96:99], a[128:131], v[176:179]
v_mfma_f32_16x16x32_bf16 v[176:179], a[100:103], a[132:135], v[176:179]
v_mfma_f32_16x16x32_bf16 v[180:183], a[104:107], a[128:131], v[180:183]
ds_read_b128 a[44:47], v3 offset:10240
v_mfma_f32_16x16x32_bf16 v[180:183], a[108:111], a[132:135], v[180:183]
v_mfma_f32_16x16x32_bf16 v[184:187], a[112:115], a[128:131], v[184:187]
ds_read_b128 a[48:51], v2 offset:12288
v_mfma_f32_16x16x32_bf16 v[184:187], a[116:119], a[132:135], v[184:187]
v_mfma_f32_16x16x32_bf16 v[188:191], a[120:123], a[128:131], v[188:191]
v_mfma_f32_16x16x32_bf16 v[188:191], a[124:127], a[132:135], v[188:191]
s_waitcnt lgkmcnt(2)
v_mfma_f32_16x16x32_bf16 v[192:195], a[64:67], a[136:139], v[192:195]
ds_read_b64_tr_b16 a[128:129], v10 offset:32768
v_mfma_f32_16x16x32_bf16 v[192:195], a[68:71], a[140:143], v[192:195]
v_mfma_f32_16x16x32_bf16 v[196:199], a[72:75], a[136:139], v[196:199]
ds_read_b64_tr_b16 a[130:131], v10 offset:34816
v_mfma_f32_16x16x32_bf16 v[196:199], a[76:79], a[140:143], v[196:199]
v_mfma_f32_16x16x32_bf16 v[200:203], a[80:83], a[136:139], v[200:203]
ds_read_b64_tr_b16 a[132:133], v10 offset:49152
v_mfma_f32_16x16x32_bf16 v[200:203], a[84:87], a[140:143], v[200:203]
v_mfma_f32_16x16x32_bf16 v[204:207], a[88:91], a[136:139], v[204:207]
ds_read_b64_tr_b16 a[134:135], v10 offset:51200
v_mfma_f32_16x16x32_bf16 v[204:207], a[92:95], a[140:143], v[204:207]
v_mfma_f32_16x16x32_bf16 v[208:211], a[96:99], a[136:139], v[208:211]
ds_read_b128 a[52:55], v3 offset:12288
v_mfma_f32_16x16x32_bf16 v[208:211], a[100:103], a[140:143], v[208:211]
v_mfma_f32_16x16x32_bf16 v[212:215], a[104:107], a[136:139], v[212:215]
ds_read_b128 a[56:59], v2 offset:14336
v_mfma_f32_16x16x32_bf16 v[212:215], a[108:111], a[140:143], v[212:215]
v_mfma_f32_16x16x32_bf16 v[216:219], a[112:115], a[136:139], v[216:219]
v_mfma_f32_16x16x32_bf16 v[216:219], a[116:119], a[140:143], v[216:219]
v_mfma_f32_16x16x32_bf16 v[220:223], a[120:123], a[136:139], v[220:223]
ds_read_b128 a[60:63], v3 offset:14336
v_mfma_f32_16x16x32_bf16 v[220:223], a[124:127], a[140:143], v[220:223]
s_waitcnt lgkmcnt(3)
v_mfma_f32_16x16x32_bf16 a[192:195], a[64:67], a[128:131], a[192:195]
ds_read_b64_tr_b16 a[136:137], v11 offset:32768
v_mfma_f32_16x16x32_bf16 a[192:195], a[68:71], a[132:135], a[192:195]
v_mfma_f32_16x16x32_bf16 a[196:199], a[72:75], a[128:131], a[196:199]
ds_read_b64_tr_b16 a[138:139], v11 offset:34816
v_mfma_f32_16x16x32_bf16 a[196:199], a[76:79], a[132:135], a[196:199]
v_mfma_f32_16x16x32_bf16 a[200:203], a[80:83], a[128:131], a[200:203]
ds_read_b64_tr_b16 a[140:141], v11 offset:49152
v_mfma_f32_16x16x32_bf16 a[200:203], a[84:87], a[132:135], a[200:203]
v_mfma_f32_16x16x32_bf16 a[204:207], a[88:91], a[128:131], a[204:207]
ds_read_b64_tr_b16 a[142:143], v11 offset:51200
v_mfma_f32_16x16x32_bf16 a[204:207], a[92:95], a[132:135], a[204:207]
v_mfma_f32_16x16x32_bf16 a[208:211], a[96:99], a[128:131], a[208:211]
v_mfma_f32_16x16x32_bf16 a[208:211], a[100:103], a[132:135], a[208:211]
v_mfma_f32_16x16x32_bf16 a[212:215], a[104:107], a[128:131], a[212:215]
v_mfma_f32_16x16x32_bf16 a[212:215], a[108:111], a[132:135], a[212:215]
v_mfma_f32_16x16x32_bf16 a[216:219], a[112:115], a[128:131], a[216:219]
v_mfma_f32_16x16x32_bf16 a[216:219], a[116:119], a[132:135], a[216:219]
v_mfma_f32_16x16x32_bf16 a[220:223], a[120:123], a[128:131], a[220:223]
s_waitcnt vmcnt(7) lgkmcnt(0)
v_mfma_f32_16x16x32_bf16 a[220:223], a[124:127], a[132:135], a[220:223]
s_barrier
v_mfma_f32_16x16x32_bf16 a[224:227], a[64:67], a[136:139], a[224:227]
s_add_u32 m0, s29, 98304
ds_read_b64_tr_b16 a[128:129], v4 offset:0
v_mfma_f32_16x16x32_bf16 a[224:227], a[68:71], a[140:143], a[224:227]
buffer_load_dwordx4 v16, s[12:15], s26 offen offset:0 lds
v_mfma_f32_16x16x32_bf16 a[228:231], a[72:75], a[136:139], a[228:231]
ds_read_b64_tr_b16 a[130:131], v4 offset:2048
v_mfma_f32_16x16x32_bf16 a[228:231], a[76:79], a[140:143], a[228:231]
v_mfma_f32_16x16x32_bf16 a[232:235], a[80:83], a[136:139], a[232:235]
ds_read_b64_tr_b16 a[132:133], v4 offset:16384
v_mfma_f32_16x16x32_bf16 a[232:235], a[84:87], a[140:143], a[232:235]
buffer_load_dwordx4 v17, s[12:15], s26 offen offset:1024 lds
v_mfma_f32_16x16x32_bf16 a[236:239], a[88:91], a[136:139], a[236:239]
ds_read_b64_tr_b16 a[134:135], v4 offset:18432
v_mfma_f32_16x16x32_bf16 a[236:239], a[92:95], a[140:143], a[236:239]
v_mfma_f32_16x16x32_bf16 a[240:243], a[96:99], a[136:139], a[240:243]
v_mfma_f32_16x16x32_bf16 a[240:243], a[100:103], a[140:143], a[240:243]
buffer_load_dwordx4 v18, s[12:15], s26 offen offset:2048 lds
v_mfma_f32_16x16x32_bf16 a[244:247], a[104:107], a[136:139], a[244:247]
v_mfma_f32_16x16x32_bf16 a[244:247], a[108:111], a[140:143], a[244:247]
v_mfma_f32_16x16x32_bf16 a[248:251], a[112:115], a[136:139], a[248:251]
v_mfma_f32_16x16x32_bf16 a[248:251], a[116:119], a[140:143], a[248:251]
buffer_load_dwordx4 v19, s[12:15], s26 offen offset:3072 lds
v_mfma_f32_16x16x32_bf16 a[252:255], a[120:123], a[136:139], a[252:255]
s_add_u32 s26, s26, 524288
v_mfma_f32_16x16x32_bf16 a[252:255], a[124:127], a[140:143], a[252:255]
s_waitcnt lgkmcnt(0)
v_mfma_f32_16x16x32_bf16 v[32:35], a[0:3], a[128:131], v[32:35]
s_add_u32 m0, s29, 114688
ds_read_b64_tr_b16 a[136:137], v5 offset:0
v_mfma_f32_16x16x32_bf16 v[32:35], a[4:7], a[132:135], v[32:35]
buffer_load_dwordx4 v16, s[12:15], s27 offen offset:0 lds
v_mfma_f32_16x16x32_bf16 v[36:39], a[8:11], a[128:131], v[36:39]
ds_read_b64_tr_b16 a[138:139], v5 offset:2048
v_mfma_f32_16x16x32_bf16 v[36:39], a[12:15], a[132:135], v[36:39]
v_mfma_f32_16x16x32_bf16 v[40:43], a[16:19], a[128:131], v[40:43]
ds_read_b64_tr_b16 a[140:141], v5 offset:16384
v_mfma_f32_16x16x32_bf16 v[40:43], a[20:23], a[132:135], v[40:43]
buffer_load_dwordx4 v17, s[12:15], s27 offen offset:1024 lds
v_mfma_f32_16x16x32_bf16 v[44:47], a[24:27], a[128:131], v[44:47]
ds_read_b64_tr_b16 a[142:143], v5 offset:18432
v_mfma_f32_16x16x32_bf16 v[44:47], a[28:31], a[132:135], v[44:47]
v_mfma_f32_16x16x32_bf16 v[48:51], a[32:35], a[128:131], v[48:51]
ds_read_b128 a[64:67], v2 offset:32768
v_mfma_f32_16x16x32_bf16 v[48:51], a[36:39], a[132:135], v[48:51]
buffer_load_dwordx4 v18, s[12:15], s27 offen offset:2048 lds
v_mfma_f32_16x16x32_bf16 v[52:55], a[40:43], a[128:131], v[52:55]
ds_read_b128 a[68:71], v3 offset:32768
v_mfma_f32_16x16x32_bf16 v[52:55], a[44:47], a[132:135], v[52:55]
v_mfma_f32_16x16x32_bf16 v[56:59], a[48:51], a[128:131], v[56:59]
v_mfma_f32_16x16x32_bf16 v[56:59], a[52:55], a[132:135], v[56:59]
buffer_load_dwordx4 v19, s[12:15], s27 offen offset:3072 lds
v_mfma_f32_16x16x32_bf16 v[60:63], a[56:59], a[128:131], v[60:63]
s_add_u32 s27, s27, 524288
ds_read_b128 a[72:75], v2 offset:34816
v_mfma_f32_16x16x32_bf16 v[60:63], a[60:63], a[132:135], v[60:63]
s_waitcnt lgkmcnt(3)
v_mfma_f32_16x16x32_bf16 v[64:67], a[0:3], a[136:139], v[64:67]
s_add_u32 m0, s28, 0
ds_read_b64_tr_b16 a[128:129], v6 offset:0
v_mfma_f32_16x16x32_bf16 v[64:67], a[4:7], a[140:143], v[64:67]
buffer_load_dwordx4 v12, s[8:11], s24 offen offset:0 lds
v_mfma_f32_16x16x32_bf16 v[68:71], a[8:11], a[136:139], v[68:71]
ds_read_b64_tr_b16 a[130:131], v6 offset:2048
v_mfma_f32_16x16x32_bf16 v[68:71], a[12:15], a[140:143], v[68:71]
v_mfma_f32_16x16x32_bf16 v[72:75], a[16:19], a[136:139], v[72:75]
ds_read_b64_tr_b16 a[132:133], v6 offset:16384
v_mfma_f32_16x16x32_bf16 v[72:75], a[20:23], a[140:143], v[72:75]
buffer_load_dwordx4 v13, s[8:11], s24 offen offset:1024 lds
v_mfma_f32_16x16x32_bf16 v[76:79], a[24:27], a[136:139], v[76:79]
ds_read_b64_tr_b16 a[134:135], v6 offset:18432
v_mfma_f32_16x16x32_bf16 v[76:79], a[28:31], a[140:143], v[76:79]
v_mfma_f32_16x16x32_bf16 v[80:83], a[32:35], a[136:139], v[80:83]
ds_read_b128 a[76:79], v3 offset:34816
v_mfma_f32_16x16x32_bf16 v[80:83], a[36:39], a[140:143], v[80:83]
buffer_load_dwordx4 v14, s[8:11], s24 offen offset:2048 lds
v_mfma_f32_16x16x32_bf16 v[84:87], a[40:43], a[136:139], v[84:87]
v_mfma_f32_16x16x32_bf16 v[84:87], a[44:47], a[140:143], v[84:87]
v_mfma_f32_16x16x32_bf16 v[88:91], a[48:51], a[136:139], v[88:91]
ds_read_b128 a[80:83], v2 offset:36864
v_mfma_f32_16x16x32_bf16 v[88:91], a[52:55], a[140:143], v[88:91]
buffer_load_dwordx4 v15, s[8:11], s24 offen offset:3072 lds
v_mfma_f32_16x16x32_bf16 v[92:95], a[56:59], a[136:139], v[92:95]
s_add_u32 s24, s24, 128
ds_read_b128 a[84:87], v3 offset:36864
v_mfma_f32_16x16x32_bf16 v[92:95], a[60:63], a[140:143], v[92:95]
s_waitcnt lgkmcnt(3)
s_mov_b64 s[12:13], s[80:81]
v_mfma_f32_16x16x32_bf16 v[96:99], a[0:3], a[128:131], v[96:99]
s_mov_b32 s14, 3670016
s_add_u32 m0, s28, 16384
ds_read_b64_tr_b16 a[136:137], v7 offset:0
v_mfma_f32_16x16x32_bf16 v[96:99], a[4:7], a[132:135], v[96:99]
buffer_load_dwordx4 v12, s[8:11], s24 offen offset:0 lds
v_mfma_f32_16x16x32_bf16 v[100:103], a[8:11], a[128:131], v[100:103]
ds_read_b64_tr_b16 a[138:139], v7 offset:2048
v_mfma_f32_16x16x32_bf16 v[100:103], a[12:15], a[132:135], v[100:103]
v_mfma_f32_16x16x32_bf16 v[104:107], a[16:19], a[128:131], v[104:107]
ds_read_b64_tr_b16 a[140:141], v7 offset:16384
v_mfma_f32_16x16x32_bf16 v[104:107], a[20:23], a[132:135], v[104:107]
buffer_load_dwordx4 v13, s[8:11], s24 offen offset:1024 lds
v_mfma_f32_16x16x32_bf16 v[108:111], a[24:27], a[128:131], v[108:111]
ds_read_b64_tr_b16 a[142:143], v7 offset:18432
v_mfma_f32_16x16x32_bf16 v[108:111], a[28:31], a[132:135], v[108:111]
v_mfma_f32_16x16x32_bf16 v[112:115], a[32:35], a[128:131], v[112:115]
v_mfma_f32_16x16x32_bf16 v[112:115], a[36:39], a[132:135], v[112:115]
buffer_load_dwordx4 v14, s[8:11], s24 offen offset:2048 lds
v_mfma_f32_16x16x32_bf16 v[116:119], a[40:43], a[128:131], v[116:119]
ds_read_b128 a[88:91], v2 offset:38912
v_mfma_f32_16x16x32_bf16 v[116:119], a[44:47], a[132:135], v[116:119]
v_mfma_f32_16x16x32_bf16 v[120:123], a[48:51], a[128:131], v[120:123]
ds_read_b128 a[92:95], v3 offset:38912
v_mfma_f32_16x16x32_bf16 v[120:123], a[52:55], a[132:135], v[120:123]
buffer_load_dwordx4 v15, s[8:11], s24 offen offset:3072 lds
v_mfma_f32_16x16x32_bf16 v[124:127], a[56:59], a[128:131], v[124:127]
s_add_u32 s24, s24, 128
v_mfma_f32_16x16x32_bf16 v[124:127], a[60:63], a[132:135], v[124:127]
s_waitcnt lgkmcnt(2)
s_sub_u32 s26, s26, 8388608
v_mfma_f32_16x16x32_bf16 v[128:131], a[0:3], a[136:139], v[128:131]
s_sub_u32 s27, s27, 8388608
s_add_u32 m0, s29, 131072
ds_read_b64_tr_b16 a[128:129], v8 offset:0
v_mfma_f32_16x16x32_bf16 v[128:131], a[4:7], a[140:143], v[128:131]
buffer_load_dwordx4 v16, s[12:15], s26 offen offset:0 lds
v_mfma_f32_16x16x32_bf16 v[132:135], a[8:11], a[136:139], v[132:135]
ds_read_b64_tr_b16 a[130:131], v8 offset:2048
v_mfma_f32_16x16x32_bf16 v[132:135], a[12:15], a[140:143], v[132:135]
v_mfma_f32_16x16x32_bf16 v[136:139], a[16:19], a[136:139], v[136:139]
ds_read_b64_tr_b16 a[132:133], v8 offset:16384
v_mfma_f32_16x16x32_bf16 v[136:139], a[20:23], a[140:143], v[136:139]
buffer_load_dwordx4 v17, s[12:15], s26 offen offset:1024 lds
v_mfma_f32_16x16x32_bf16 v[140:143], a[24:27], a[136:139], v[140:143]
ds_read_b64_tr_b16 a[134:135], v8 offset:18432
v_mfma_f32_16x16x32_bf16 v[140:143], a[28:31], a[140:143], v[140:143]
v_mfma_f32_16x16x32_bf16 v[144:147], a[32:35], a[136:139], v[144:147]
ds_read_b128 a[96:99], v2 offset:40960
v_mfma_f32_16x16x32_bf16 v[144:147], a[36:39], a[140:143], v[144:147]
buffer_load_dwordx4 v18, s[12:15], s26 offen offset:2048 lds
v_mfma_f32_16x16x32_bf16 v[148:151], a[40:43], a[136:139], v[148:151]
v_mfma_f32_16x16x32_bf16 v[148:151], a[44:47], a[140:143], v[148:151]
v_mfma_f32_16x16x32_bf16 v[152:155], a[48:51], a[136:139], v[152:155]
ds_read_b128 a[100:103], v3 offset:40960
v_mfma_f32_16x16x32_bf16 v[152:155], a[52:55], a[140:143], v[152:155]
buffer_load_dwordx4 v19, s[12:15], s26 offen offset:3072 lds
v_mfma_f32_16x16x32_bf16 v[156:159], a[56:59], a[136:139], v[156:159]
s_add_u32 s26, s26, 524288
ds_read_b128 a[104:107], v2 offset:43008
v_mfma_f32_16x16x32_bf16 v[156:159], a[60:63], a[140:143], v[156:159]
s_waitcnt lgkmcnt(3)
v_mfma_f32_16x16x32_bf16 v[160:163], a[0:3], a[128:131], v[160:163]
s_add_u32 m0, s29, 147456
ds_read_b64_tr_b16 a[136:137], v9 offset:0
v_mfma_f32_16x16x32_bf16 v[160:163], a[4:7], a[132:135], v[160:163]
buffer_load_dwordx4 v16, s[12:15], s27 offen offset:0 lds
v_mfma_f32_16x16x32_bf16 v[164:167], a[8:11], a[128:131], v[164:167]
ds_read_b64_tr_b16 a[138:139], v9 offset:2048
v_mfma_f32_16x16x32_bf16 v[164:167], a[12:15], a[132:135], v[164:167]
v_mfma_f32_16x16x32_bf16 v[168:171], a[16:19], a[128:131], v[168:171]
ds_read_b64_tr_b16 a[140:141], v9 offset:16384
v_mfma_f32_16x16x32_bf16 v[168:171], a[20:23], a[132:135], v[168:171]
buffer_load_dwordx4 v17, s[12:15], s27 offen offset:1024 lds
v_mfma_f32_16x16x32_bf16 v[172:175], a[24:27], a[128:131], v[172:175]
ds_read_b64_tr_b16 a[142:143], v9 offset:18432
v_mfma_f32_16x16x32_bf16 v[172:175], a[28:31], a[132:135], v[172:175]
v_mfma_f32_16x16x32_bf16 v[176:179], a[32:35], a[128:131], v[176:179]
v_mfma_f32_16x16x32_bf16 v[176:179], a[36:39], a[132:135], v[176:179]
buffer_load_dwordx4 v18, s[12:15], s27 offen offset:2048 lds
v_mfma_f32_16x16x32_bf16 v[180:183], a[40:43], a[128:131], v[180:183]
ds_read_b128 a[108:111], v3 offset:43008
v_mfma_f32_16x16x32_bf16 v[180:183], a[44:47], a[132:135], v[180:183]
v_mfma_f32_16x16x32_bf16 v[184:187], a[48:51], a[128:131], v[184:187]
ds_read_b128 a[112:115], v2 offset:45056
v_mfma_f32_16x16x32_bf16 v[184:187], a[52:55], a[132:135], v[184:187]
buffer_load_dwordx4 v19, s[12:15], s27 offen offset:3072 lds
v_mfma_f32_16x16x32_bf16 v[188:191], a[56:59], a[128:131], v[188:191]
s_add_u32 s27, s27, 524288
v_mfma_f32_16x16x32_bf16 v[188:191], a[60:63], a[132:135], v[188:191]
s_waitcnt lgkmcnt(2)
v_mfma_f32_16x16x32_bf16 v[192:195], a[0:3], a[136:139], v[192:195]
ds_read_b64_tr_b16 a[128:129], v10 offset:0
v_mfma_f32_16x16x32_bf16 v[192:195], a[4:7], a[140:143], v[192:195]
v_mfma_f32_16x16x32_bf16 v[196:199], a[8:11], a[136:139], v[196:199]
ds_read_b64_tr_b16 a[130:131], v10 offset:2048
v_mfma_f32_16x16x32_bf16 v[196:199], a[12:15], a[140:143], v[196:199]
v_mfma_f32_16x16x32_bf16 v[200:203], a[16:19], a[136:139], v[200:203]
ds_read_b64_tr_b16 a[132:133], v10 offset:16384
v_mfma_f32_16x16x32_bf16 v[200:203], a[20:23], a[140:143], v[200:203]
v_mfma_f32_16x16x32_bf16 v[204:207], a[24:27], a[136:139], v[204:207]
ds_read_b64_tr_b16 a[134:135], v10 offset:18432
v_mfma_f32_16x16x32_bf16 v[204:207], a[28:31], a[140:143], v[204:207]
v_mfma_f32_16x16x32_bf16 v[208:211], a[32:35], a[136:139], v[208:211]
ds_read_b128 a[116:119], v3 offset:45056
v_mfma_f32_16x16x32_bf16 v[208:211], a[36:39], a[140:143], v[208:211]
v_mfma_f32_16x16x32_bf16 v[212:215], a[40:43], a[136:139], v[212:215]
ds_read_b128 a[120:123], v2 offset:47104
v_mfma_f32_16x16x32_bf16 v[212:215], a[44:47], a[140:143], v[212:215]
v_mfma_f32_16x16x32_bf16 v[216:219], a[48:51], a[136:139], v[216:219]
v_mfma_f32_16x16x32_bf16 v[216:219], a[52:55], a[140:143], v[216:219]
v_mfma_f32_16x16x32_bf16 v[220:223], a[56:59], a[136:139], v[220:223]
ds_read_b128 a[124:127], v3 offset:47104
v_mfma_f32_16x16x32_bf16 v[220:223], a[60:63], a[140:143], v[220:223]
s_waitcnt lgkmcnt(3)
v_mfma_f32_16x16x32_bf16 a[192:195], a[0:3], a[128:131], a[192:195]
ds_read_b64_tr_b16 a[136:137], v11 offset:0
v_mfma_f32_16x16x32_bf16 a[192:195], a[4:7], a[132:135], a[192:195]
v_mfma_f32_16x16x32_bf16 a[196:199], a[8:11], a[128:131], a[196:199]
ds_read_b64_tr_b16 a[138:139], v11 offset:2048
v_mfma_f32_16x16x32_bf16 a[196:199], a[12:15], a[132:135], a[196:199]
v_mfma_f32_16x16x32_bf16 a[200:203], a[16:19], a[128:131], a[200:203]
ds_read_b64_tr_b16 a[140:141], v11 offset:16384
v_mfma_f32_16x16x32_bf16 a[200:203], a[20:23], a[132:135], a[200:203]
v_mfma_f32_16x16x32_bf16 a[204:207], a[24:27], a[128:131], a[204:207]
ds_read_b64_tr_b16 a[142:143], v11 offset:18432
v_mfma_f32_16x16x32_bf16 a[204:207], a[28:31], a[132:135], a[204:207]
v_mfma_f32_16x16x32_bf16 a[208:211], a[32:35], a[128:131], a[208:211]
v_mfma_f32_16x16x32_bf16 a[208:211], a[36:39], a[132:135], a[208:211]
v_mfma_f32_16x16x32_bf16 a[212:215], a[40:43], a[128:131], a[212:215]
v_mfma_f32_16x16x32_bf16 a[212:215], a[44:47], a[132:135], a[212:215]
v_mfma_f32_16x16x32_bf16 a[216:219], a[48:51], a[128:131], a[216:219]
v_mfma_f32_16x16x32_bf16 a[216:219], a[52:55], a[132:135], a[216:219]
v_mfma_f32_16x16x32_bf16 a[220:223], a[56:59], a[128:131], a[220:223]
s_waitcnt vmcnt(12) lgkmcnt(0)
v_mfma_f32_16x16x32_bf16 a[220:223], a[60:63], a[132:135], a[220:223]
s_barrier
v_mfma_f32_16x16x32_bf16 a[224:227], a[0:3], a[136:139], a[224:227]
s_add_u32 m0, s28, 32768
ds_read_b64_tr_b16 a[128:129], v4 offset:32768
v_mfma_f32_16x16x32_bf16 a[224:227], a[4:7], a[140:143], a[224:227]
s_lshr_b32 s22, s3, 1
buffer_load_dwordx4 v12, s[8:11], s24 offen offset:0 lds
v_mfma_f32_16x16x32_bf16 a[228:231], a[8:11], a[136:139], a[228:231]
s_lshl_b32 s22, s22, 14
ds_read_b64_tr_b16 a[130:131], v4 offset:34816
v_subrev_u32 v2, s22, v2
v_mfma_f32_16x16x32_bf16 a[228:231], a[12:15], a[140:143], a[228:231]
v_subrev_u32 v3, s22, v3
v_mfma_f32_16x16x32_bf16 a[232:235], a[16:19], a[136:139], a[232:235]
ds_read_b64_tr_b16 a[132:133], v4 offset:49152
v_mfma_f32_16x16x32_bf16 a[232:235], a[20:23], a[140:143], a[232:235]
buffer_load_dwordx4 v13, s[8:11], s24 offen offset:1024 lds
v_mfma_f32_16x16x32_bf16 a[236:239], a[24:27], a[136:139], a[236:239]
ds_read_b64_tr_b16 a[134:135], v4 offset:51200
v_mfma_f32_16x16x32_bf16 a[236:239], a[28:31], a[140:143], a[236:239]
v_mfma_f32_16x16x32_bf16 a[240:243], a[32:35], a[136:139], a[240:243]
v_mfma_f32_16x16x32_bf16 a[240:243], a[36:39], a[140:143], a[240:243]
buffer_load_dwordx4 v14, s[8:11], s24 offen offset:2048 lds
v_mfma_f32_16x16x32_bf16 a[244:247], a[40:43], a[136:139], a[244:247]
v_mfma_f32_16x16x32_bf16 a[244:247], a[44:47], a[140:143], a[244:247]
v_mfma_f32_16x16x32_bf16 a[248:251], a[48:51], a[136:139], a[248:251]
v_mfma_f32_16x16x32_bf16 a[248:251], a[52:55], a[140:143], a[248:251]
buffer_load_dwordx4 v15, s[8:11], s24 offen offset:3072 lds
v_mfma_f32_16x16x32_bf16 a[252:255], a[56:59], a[136:139], a[252:255]
s_add_u32 s24, s24, 128
v_mfma_f32_16x16x32_bf16 a[252:255], a[60:63], a[140:143], a[252:255]
s_waitcnt lgkmcnt(0)
v_mfma_f32_16x16x32_bf16 v[32:35], a[64:67], a[128:131], v[32:35]
s_add_u32 m0, s29, 65536
ds_read_b64_tr_b16 a[136:137], v5 offset:32768
v_mfma_f32_16x16x32_bf16 v[32:35], a[68:71], a[132:135], v[32:35]
buffer_load_dwordx4 v16, s[12:15], s26 offen offset:0 lds
v_mfma_f32_16x16x32_bf16 v[36:39], a[72:75], a[128:131], v[36:39]
ds_read_b64_tr_b16 a[138:139], v5 offset:34816
v_mfma_f32_16x16x32_bf16 v[36:39], a[76:79], a[132:135], v[36:39]
v_mfma_f32_16x16x32_bf16 v[40:43], a[80:83], a[128:131], v[40:43]
ds_read_b64_tr_b16 a[140:141], v5 offset:49152
v_mfma_f32_16x16x32_bf16 v[40:43], a[84:87], a[132:135], v[40:43]
buffer_load_dwordx4 v17, s[12:15], s26 offen offset:1024 lds
v_mfma_f32_16x16x32_bf16 v[44:47], a[88:91], a[128:131], v[44:47]
ds_read_b64_tr_b16 a[142:143], v5 offset:51200
v_mfma_f32_16x16x32_bf16 v[44:47], a[92:95], a[132:135], v[44:47]
v_mfma_f32_16x16x32_bf16 v[48:51], a[96:99], a[128:131], v[48:51]
ds_read_b128 a[0:3], v2 offset:0
v_cvt_pk_bf16_f32 v32, v32, v33
v_mfma_f32_16x16x32_bf16 v[48:51], a[100:103], a[132:135], v[48:51]
buffer_load_dwordx4 v18, s[12:15], s26 offen offset:2048 lds
v_mfma_f32_16x16x32_bf16 v[52:55], a[104:107], a[128:131], v[52:55]
ds_read_b128 a[4:7], v3 offset:0
v_cvt_pk_bf16_f32 v33, v34, v35
v_mfma_f32_16x16x32_bf16 v[52:55], a[108:111], a[132:135], v[52:55]
v_cvt_pk_bf16_f32 v34, v36, v37
v_cvt_pk_bf16_f32 v35, v38, v39
v_mfma_f32_16x16x32_bf16 v[56:59], a[112:115], a[128:131], v[56:59]
v_cvt_pk_bf16_f32 v40, v40, v41
v_cvt_pk_bf16_f32 v41, v42, v43
v_mfma_f32_16x16x32_bf16 v[56:59], a[116:119], a[132:135], v[56:59]
buffer_load_dwordx4 v19, s[12:15], s26 offen offset:3072 lds
v_mfma_f32_16x16x32_bf16 v[60:63], a[120:123], a[128:131], v[60:63]
s_add_u32 s26, s26, 524288
ds_read_b128 a[8:11], v2 offset:2048
v_cvt_pk_bf16_f32 v42, v44, v45
v_mfma_f32_16x16x32_bf16 v[60:63], a[124:127], a[132:135], v[60:63]
s_waitcnt lgkmcnt(3)
v_cvt_pk_bf16_f32 v43, v46, v47
v_mfma_f32_16x16x32_bf16 v[64:67], a[64:67], a[136:139], v[64:67]
s_add_u32 m0, s29, 81920
ds_read_b64_tr_b16 a[128:129], v6 offset:32768
v_cvt_pk_bf16_f32 v48, v48, v49
v_mfma_f32_16x16x32_bf16 v[64:67], a[68:71], a[140:143], v[64:67]
buffer_load_dwordx4 v16, s[12:15], s27 offen offset:0 lds
v_mfma_f32_16x16x32_bf16 v[68:71], a[72:75], a[136:139], v[68:71]
ds_read_b64_tr_b16 a[130:131], v6 offset:34816
v_cvt_pk_bf16_f32 v49, v50, v51
v_mfma_f32_16x16x32_bf16 v[68:71], a[76:79], a[140:143], v[68:71]
v_cvt_pk_bf16_f32 v50, v52, v53
v_cvt_pk_bf16_f32 v51, v54, v55
v_mfma_f32_16x16x32_bf16 v[72:75], a[80:83], a[136:139], v[72:75]
ds_read_b64_tr_b16 a[132:133], v6 offset:49152
v_cvt_pk_bf16_f32 v56, v56, v57
v_mfma_f32_16x16x32_bf16 v[72:75], a[84:87], a[140:143], v[72:75]
buffer_load_dwordx4 v17, s[12:15], s27 offen offset:1024 lds
v_mfma_f32_16x16x32_bf16 v[76:79], a[88:91], a[136:139], v[76:79]
ds_read_b64_tr_b16 a[134:135], v6 offset:51200
v_cvt_pk_bf16_f32 v57, v58, v59
v_mfma_f32_16x16x32_bf16 v[76:79], a[92:95], a[140:143], v[76:79]
v_cvt_pk_bf16_f32 v58, v60, v61
v_cvt_pk_bf16_f32 v59, v62, v63
v_mfma_f32_16x16x32_bf16 v[80:83], a[96:99], a[136:139], v[80:83]
ds_read_b128 a[12:15], v3 offset:2048
v_cvt_pk_bf16_f32 v64, v64, v65
v_mfma_f32_16x16x32_bf16 v[80:83], a[100:103], a[140:143], v[80:83]
buffer_load_dwordx4 v18, s[12:15], s27 offen offset:2048 lds
v_mfma_f32_16x16x32_bf16 v[84:87], a[104:107], a[136:139], v[84:87]
v_cvt_pk_bf16_f32 v65, v66, v67
v_cvt_pk_bf16_f32 v66, v68, v69
v_mfma_f32_16x16x32_bf16 v[84:87], a[108:111], a[140:143], v[84:87]
v_cvt_pk_bf16_f32 v67, v70, v71
v_mfma_f32_16x16x32_bf16 v[88:91], a[112:115], a[136:139], v[88:91]
ds_read_b128 a[16:19], v2 offset:4096
v_cvt_pk_bf16_f32 v72, v72, v73
v_mfma_f32_16x16x32_bf16 v[88:91], a[116:119], a[140:143], v[88:91]
buffer_load_dwordx4 v19, s[12:15], s27 offen offset:3072 lds
v_mfma_f32_16x16x32_bf16 v[92:95], a[120:123], a[136:139], v[92:95]
s_add_u32 s27, s27, 524288
ds_read_b128 a[20:23], v3 offset:4096
v_cvt_pk_bf16_f32 v73, v74, v75
v_mfma_f32_16x16x32_bf16 v[92:95], a[124:127], a[140:143], v[92:95]
s_waitcnt lgkmcnt(3)
v_cvt_pk_bf16_f32 v74, v76, v77
v_cvt_pk_bf16_f32 v75, v78, v79
v_mfma_f32_16x16x32_bf16 v[96:99], a[64:67], a[128:131], v[96:99]
s_add_u32 m0, s28, 49152
ds_read_b64_tr_b16 a[136:137], v7 offset:32768
v_cvt_pk_bf16_f32 v80, v80, v81
v_mfma_f32_16x16x32_bf16 v[96:99], a[68:71], a[132:135], v[96:99]
buffer_load_dwordx4 v12, s[8:11], s24 offen offset:0 lds
v_mfma_f32_16x16x32_bf16 v[100:103], a[72:75], a[128:131], v[100:103]
ds_read_b64_tr_b16 a[138:139], v7 offset:34816
v_cvt_pk_bf16_f32 v81, v82, v83
v_mfma_f32_16x16x32_bf16 v[100:103], a[76:79], a[132:135], v[100:103]
v_cvt_pk_bf16_f32 v82, v84, v85
v_cvt_pk_bf16_f32 v83, v86, v87
v_mfma_f32_16x16x32_bf16 v[104:107], a[80:83], a[128:131], v[104:107]
ds_read_b64_tr_b16 a[140:141], v7 offset:49152
v_cvt_pk_bf16_f32 v88, v88, v89
v_mfma_f32_16x16x32_bf16 v[104:107], a[84:87], a[132:135], v[104:107]
buffer_load_dwordx4 v13, s[8:11], s24 offen offset:1024 lds
v_mfma_f32_16x16x32_bf16 v[108:111], a[88:91], a[128:131], v[108:111]
ds_read_b64_tr_b16 a[142:143], v7 offset:51200
v_cvt_pk_bf16_f32 v89, v90, v91
v_mfma_f32_16x16x32_bf16 v[108:111], a[92:95], a[132:135], v[108:111]
v_cvt_pk_bf16_f32 v90, v92, v93
v_cvt_pk_bf16_f32 v91, v94, v95
v_mfma_f32_16x16x32_bf16 v[112:115], a[96:99], a[128:131], v[112:115]
v_cvt_pk_bf16_f32 v96, v96, v97
v_cvt_pk_bf16_f32 v97, v98, v99
v_mfma_f32_16x16x32_bf16 v[112:115], a[100:103], a[132:135], v[112:115]
buffer_load_dwordx4 v14, s[8:11], s24 offen offset:2048 lds
v_mfma_f32_16x16x32_bf16 v[116:119], a[104:107], a[128:131], v[116:119]
ds_read_b128 a[24:27], v2 offset:6144
v_cvt_pk_bf16_f32 v98, v100, v101
v_mfma_f32_16x16x32_bf16 v[116:119], a[108:111], a[132:135], v[116:119]
buffer_store_dwordx4 v[32:35], v1, s[4:7], s31 offen sc1
v_mfma_f32_16x16x32_bf16 v[120:123], a[112:115], a[128:131], v[120:123]
s_add_u32 s31, s31, s32
ds_read_b128 a[28:31], v3 offset:6144
v_cvt_pk_bf16_f32 v99, v102, v103
v_mfma_f32_16x16x32_bf16 v[120:123], a[116:119], a[132:135], v[120:123]
buffer_load_dwordx4 v15, s[8:11], s24 offen offset:3072 lds
v_mfma_f32_16x16x32_bf16 v[124:127], a[120:123], a[128:131], v[124:127]
s_add_u32 s24, s24, 128
v_cvt_pk_bf16_f32 v104, v104, v105
v_cvt_pk_bf16_f32 v105, v106, v107
v_mfma_f32_16x16x32_bf16 v[124:127], a[124:127], a[132:135], v[124:127]
s_waitcnt lgkmcnt(2)
v_cvt_pk_bf16_f32 v106, v108, v109
v_cvt_pk_bf16_f32 v107, v110, v111
v_mfma_f32_16x16x32_bf16 v[128:131], a[64:67], a[136:139], v[128:131]
PAD_27:
s_cbranch_execz PAD_31
ds_read_b64_tr_b16 a[128:129], v8 offset:32768
v_cvt_pk_bf16_f32 v112, v112, v113
v_mfma_f32_16x16x32_bf16 v[128:131], a[68:71], a[140:143], v[128:131]
v_cvt_pk_bf16_f32 v113, v114, v115
v_cvt_pk_bf16_f32 v114, v116, v117
v_mfma_f32_16x16x32_bf16 v[132:135], a[72:75], a[136:139], v[132:135]
ds_read_b64_tr_b16 a[130:131], v8 offset:34816
v_cvt_pk_bf16_f32 v115, v118, v119
v_mfma_f32_16x16x32_bf16 v[132:135], a[76:79], a[140:143], v[132:135]
buffer_store_dwordx4 v[40:43], v1, s[4:7], s31 offen sc1
v_mfma_f32_16x16x32_bf16 v[136:139], a[80:83], a[136:139], v[136:139]
s_add_u32 s31, s31, s33
ds_read_b64_tr_b16 a[132:133], v8 offset:49152
v_cvt_pk_bf16_f32 v120, v120, v121
v_mfma_f32_16x16x32_bf16 v[136:139], a[84:87], a[140:143], v[136:139]
v_cvt_pk_bf16_f32 v121, v122, v123
v_cvt_pk_bf16_f32 v122, v124, v125
v_mfma_f32_16x16x32_bf16 v[140:143], a[88:91], a[136:139], v[140:143]
ds_read_b64_tr_b16 a[134:135], v8 offset:51200
v_cvt_pk_bf16_f32 v123, v126, v127
v_mfma_f32_16x16x32_bf16 v[140:143], a[92:95], a[140:143], v[140:143]
v_mfma_f32_16x16x32_bf16 v[144:147], a[96:99], a[136:139], v[144:147]
ds_read_b128 a[32:35], v2 offset:8192
v_cvt_pk_bf16_f32 v128, v128, v129
v_mfma_f32_16x16x32_bf16 v[144:147], a[100:103], a[140:143], v[144:147]
v_cvt_pk_bf16_f32 v129, v130, v131
v_cvt_pk_bf16_f32 v130, v132, v133
v_mfma_f32_16x16x32_bf16 v[148:151], a[104:107], a[136:139], v[148:151]
v_cvt_pk_bf16_f32 v131, v134, v135
v_mfma_f32_16x16x32_bf16 v[148:151], a[108:111], a[140:143], v[148:151]
v_mfma_f32_16x16x32_bf16 v[152:155], a[112:115], a[136:139], v[152:155]
ds_read_b128 a[36:39], v3 offset:8192
v_cvt_pk_bf16_f32 v136, v136, v137
v_mfma_f32_16x16x32_bf16 v[152:155], a[116:119], a[140:143], v[152:155]
v_cvt_pk_bf16_f32 v137, v138, v139
v_cvt_pk_bf16_f32 v138, v140, v141
v_mfma_f32_16x16x32_bf16 v[156:159], a[120:123], a[136:139], v[156:159]
ds_read_b128 a[40:43], v2 offset:10240
v_cvt_pk_bf16_f32 v139, v142, v143
v_mfma_f32_16x16x32_bf16 v[156:159], a[124:127], a[140:143], v[156:159]
s_waitcnt lgkmcnt(3)
buffer_store_dwordx4 v[48:51], v1, s[4:7], s31 offen sc1
v_mfma_f32_16x16x32_bf16 v[160:163], a[64:67], a[128:131], v[160:163]
s_add_u32 s31, s31, s32
ds_read_b64_tr_b16 a[136:137], v9 offset:32768
v_cvt_pk_bf16_f32 v144, v144, v145
v_mfma_f32_16x16x32_bf16 v[160:163], a[68:71], a[132:135], v[160:163]
v_cvt_pk_bf16_f32 v145, v146, v147
v_cvt_pk_bf16_f32 v146, v148, v149
v_mfma_f32_16x16x32_bf16 v[164:167], a[72:75], a[128:131], v[164:167]
ds_read_b64_tr_b16 a[138:139], v9 offset:34816
v_cvt_pk_bf16_f32 v147, v150, v151
v_mfma_f32_16x16x32_bf16 v[164:167], a[76:79], a[132:135], v[164:167]
v_mfma_f32_16x16x32_bf16 v[168:171], a[80:83], a[128:131], v[168:171]
ds_read_b64_tr_b16 a[140:141], v9 offset:49152
v_cvt_pk_bf16_f32 v152, v152, v153
v_mfma_f32_16x16x32_bf16 v[168:171], a[84:87], a[132:135], v[168:171]
v_cvt_pk_bf16_f32 v153, v154, v155
v_cvt_pk_bf16_f32 v154, v156, v157
v_mfma_f32_16x16x32_bf16 v[172:175], a[88:91], a[128:131], v[172:175]
ds_read_b64_tr_b16 a[142:143], v9 offset:51200
v_cvt_pk_bf16_f32 v155, v158, v159
v_mfma_f32_16x16x32_bf16 v[172:175], a[92:95], a[132:135], v[172:175]
v_mfma_f32_16x16x32_bf16 v[176:179], a[96:99], a[128:131], v[176:179]
buffer_store_dwordx4 v[56:59], v1, s[4:7], s31 offen sc1
v_mfma_f32_16x16x32_bf16 v[176:179], a[100:103], a[132:135], v[176:179]
s_add_u32 s31, s31, s34
v_cvt_pk_bf16_f32 v160, v160, v161
v_cvt_pk_bf16_f32 v161, v162, v163
v_mfma_f32_16x16x32_bf16 v[180:183], a[104:107], a[128:131], v[180:183]
ds_read_b128 a[44:47], v3 offset:10240
v_cvt_pk_bf16_f32 v162, v164, v165
v_mfma_f32_16x16x32_bf16 v[180:183], a[108:111], a[132:135], v[180:183]
v_cvt_pk_bf16_f32 v163, v166, v167
v_mfma_f32_16x16x32_bf16 v[184:187], a[112:115], a[128:131], v[184:187]
ds_read_b128 a[48:51], v2 offset:12288
v_cvt_pk_bf16_f32 v168, v168, v169
v_mfma_f32_16x16x32_bf16 v[184:187], a[116:119], a[132:135], v[184:187]
v_cvt_pk_bf16_f32 v169, v170, v171
v_cvt_pk_bf16_f32 v170, v172, v173
v_mfma_f32_16x16x32_bf16 v[188:191], a[120:123], a[128:131], v[188:191]
v_cvt_pk_bf16_f32 v171, v174, v175
v_mfma_f32_16x16x32_bf16 v[188:191], a[124:127], a[132:135], v[188:191]
s_waitcnt lgkmcnt(2)
v_mfma_f32_16x16x32_bf16 v[192:195], a[64:67], a[136:139], v[192:195]
ds_read_b64_tr_b16 a[128:129], v10 offset:32768
v_cvt_pk_bf16_f32 v176, v176, v177
v_mfma_f32_16x16x32_bf16 v[192:195], a[68:71], a[140:143], v[192:195]
v_cvt_pk_bf16_f32 v177, v178, v179
v_cvt_pk_bf16_f32 v178, v180, v181
v_mfma_f32_16x16x32_bf16 v[196:199], a[72:75], a[136:139], v[196:199]
ds_read_b64_tr_b16 a[130:131], v10 offset:34816
v_cvt_pk_bf16_f32 v179, v182, v183
v_mfma_f32_16x16x32_bf16 v[196:199], a[76:79], a[140:143], v[196:199]
buffer_store_dwordx4 v[64:67], v1, s[4:7], s31 offen sc1
v_mfma_f32_16x16x32_bf16 v[200:203], a[80:83], a[136:139], v[200:203]
s_add_u32 s31, s31, s32
ds_read_b64_tr_b16 a[132:133], v10 offset:49152
v_cvt_pk_bf16_f32 v184, v184, v185
v_mfma_f32_16x16x32_bf16 v[200:203], a[84:87], a[140:143], v[200:203]
v_cvt_pk_bf16_f32 v185, v186, v187
v_cvt_pk_bf16_f32 v186, v188, v189
v_mfma_f32_16x16x32_bf16 v[204:207], a[88:91], a[136:139], v[204:207]
ds_read_b64_tr_b16 a[134:135], v10 offset:51200
v_cvt_pk_bf16_f32 v187, v190, v191
v_mfma_f32_16x16x32_bf16 v[204:207], a[92:95], a[140:143], v[204:207]
v_mfma_f32_16x16x32_bf16 v[208:211], a[96:99], a[136:139], v[208:211]
ds_read_b128 a[52:55], v3 offset:12288
v_cvt_pk_bf16_f32 v192, v192, v193
v_mfma_f32_16x16x32_bf16 v[208:211], a[100:103], a[140:143], v[208:211]
v_cvt_pk_bf16_f32 v193, v194, v195
v_cvt_pk_bf16_f32 v194, v196, v197
v_mfma_f32_16x16x32_bf16 v[212:215], a[104:107], a[136:139], v[212:215]
ds_read_b128 a[56:59], v2 offset:14336
v_cvt_pk_bf16_f32 v195, v198, v199
v_mfma_f32_16x16x32_bf16 v[212:215], a[108:111], a[140:143], v[212:215]
v_mfma_f32_16x16x32_bf16 v[216:219], a[112:115], a[136:139], v[216:219]
v_cvt_pk_bf16_f32 v200, v200, v201
v_cvt_pk_bf16_f32 v201, v202, v203
v_mfma_f32_16x16x32_bf16 v[216:219], a[116:119], a[140:143], v[216:219]
buffer_store_dwordx4 v[72:75], v1, s[4:7], s31 offen sc1
v_mfma_f32_16x16x32_bf16 v[220:223], a[120:123], a[136:139], v[220:223]
s_add_u32 s31, s31, s33
ds_read_b128 a[60:63], v3 offset:14336
v_cvt_pk_bf16_f32 v202, v204, v205
v_mfma_f32_16x16x32_bf16 v[220:223], a[124:127], a[140:143], v[220:223]
s_waitcnt lgkmcnt(3)
v_cvt_pk_bf16_f32 v203, v206, v207
v_mfma_f32_16x16x32_bf16 a[192:195], a[64:67], a[128:131], a[192:195]
ds_read_b64_tr_b16 a[136:137], v11 offset:32768
v_cvt_pk_bf16_f32 v208, v208, v209
v_mfma_f32_16x16x32_bf16 a[192:195], a[68:71], a[132:135], a[192:195]
v_cvt_pk_bf16_f32 v209, v210, v211
v_cvt_pk_bf16_f32 v210, v212, v213
v_mfma_f32_16x16x32_bf16 a[196:199], a[72:75], a[128:131], a[196:199]
ds_read_b64_tr_b16 a[138:139], v11 offset:34816
v_cvt_pk_bf16_f32 v211, v214, v215
v_mfma_f32_16x16x32_bf16 a[196:199], a[76:79], a[132:135], a[196:199]
v_mfma_f32_16x16x32_bf16 a[200:203], a[80:83], a[128:131], a[200:203]
ds_read_b64_tr_b16 a[140:141], v11 offset:49152
v_cvt_pk_bf16_f32 v216, v216, v217
v_mfma_f32_16x16x32_bf16 a[200:203], a[84:87], a[132:135], a[200:203]
v_cvt_pk_bf16_f32 v217, v218, v219
v_cvt_pk_bf16_f32 v218, v220, v221
v_mfma_f32_16x16x32_bf16 a[204:207], a[88:91], a[128:131], a[204:207]
ds_read_b64_tr_b16 a[142:143], v11 offset:51200
v_cvt_pk_bf16_f32 v219, v222, v223
v_mfma_f32_16x16x32_bf16 a[204:207], a[92:95], a[132:135], a[204:207]
v_mfma_f32_16x16x32_bf16 a[208:211], a[96:99], a[128:131], a[208:211]
buffer_store_dwordx4 v[80:83], v1, s[4:7], s31 offen sc1
v_mfma_f32_16x16x32_bf16 a[208:211], a[100:103], a[132:135], a[208:211]
s_add_u32 s31, s31, s32
v_mfma_f32_16x16x32_bf16 a[212:215], a[104:107], a[128:131], a[212:215]
v_mfma_f32_16x16x32_bf16 a[212:215], a[108:111], a[132:135], a[212:215]
v_mfma_f32_16x16x32_bf16 a[216:219], a[112:115], a[128:131], a[216:219]
v_mfma_f32_16x16x32_bf16 a[216:219], a[116:119], a[132:135], a[216:219]
v_mfma_f32_16x16x32_bf16 a[220:223], a[120:123], a[128:131], a[220:223]
s_waitcnt vmcnt(23) lgkmcnt(0)
v_mfma_f32_16x16x32_bf16 a[220:223], a[124:127], a[132:135], a[220:223]
s_barrier
v_mfma_f32_16x16x32_bf16 a[224:227], a[64:67], a[136:139], a[224:227]
s_add_u32 m0, s29, 98304
ds_read_b64_tr_b16 a[128:129], v22 offset:0
v_mfma_f32_16x16x32_bf16 a[224:227], a[68:71], a[140:143], a[224:227]
buffer_load_dwordx4 v16, s[12:15], s26 offen offset:0 lds
v_mfma_f32_16x16x32_bf16 a[228:231], a[72:75], a[136:139], a[228:231]
ds_read_b64_tr_b16 a[130:131], v22 offset:2048
v_mfma_f32_16x16x32_bf16 a[228:231], a[76:79], a[140:143], a[228:231]
buffer_store_dwordx4 v[88:91], v1, s[4:7], s31 offen sc1
v_mfma_f32_16x16x32_bf16 a[232:235], a[80:83], a[136:139], a[232:235]
s_add_u32 s31, s31, s35
ds_read_b64_tr_b16 a[132:133], v22 offset:16384
v_mfma_f32_16x16x32_bf16 a[232:235], a[84:87], a[140:143], a[232:235]
buffer_load_dwordx4 v17, s[12:15], s26 offen offset:1024 lds
v_mfma_f32_16x16x32_bf16 a[236:239], a[88:91], a[136:139], a[236:239]
ds_read_b64_tr_b16 a[134:135], v22 offset:18432
v_add_u32 v22, 4294901760, v22
v_mfma_f32_16x16x32_bf16 a[236:239], a[92:95], a[140:143], a[236:239]
v_mfma_f32_16x16x32_bf16 a[240:243], a[96:99], a[136:139], a[240:243]
v_mfma_f32_16x16x32_bf16 a[240:243], a[100:103], a[140:143], a[240:243]
buffer_load_dwordx4 v18, s[12:15], s26 offen offset:2048 lds
v_mfma_f32_16x16x32_bf16 a[244:247], a[104:107], a[136:139], a[244:247]
v_mfma_f32_16x16x32_bf16 a[244:247], a[108:111], a[140:143], a[244:247]
v_mfma_f32_16x16x32_bf16 a[248:251], a[112:115], a[136:139], a[248:251]
v_mfma_f32_16x16x32_bf16 a[248:251], a[116:119], a[140:143], a[248:251]
buffer_load_dwordx4 v19, s[12:15], s26 offen offset:3072 lds
v_mfma_f32_16x16x32_bf16 a[252:255], a[120:123], a[136:139], a[252:255]
s_add_u32 s26, s26, 524288
v_mfma_f32_16x16x32_bf16 a[252:255], a[124:127], a[140:143], a[252:255]
s_waitcnt lgkmcnt(0)
s_cmp_ge_u32 s21, 7
s_cbranch_scc1 M_Q
M_conv:
v_mfma_f32_16x16x32_bf16 v[36:39], a[128:131], a[0:3], 0
s_add_u32 m0, s29, 114688
ds_read_b64_tr_b16 a[136:137], v23 offset:0
v_mfma_f32_16x16x32_bf16 v[36:39], a[132:135], a[4:7], v[36:39]
buffer_load_dwordx4 v16, s[12:15], s27 offen offset:0 lds
v_mfma_f32_16x16x32_bf16 v[44:47], a[128:131], a[8:11], 0
ds_read_b64_tr_b16 a[138:139], v23 offset:2048
v_mfma_f32_16x16x32_bf16 v[44:47], a[132:135], a[12:15], v[44:47]
ds_read_b128 a[64:67], v2 offset:16384
ds_read_b128 a[68:71], v3 offset:16384
v_mfma_f32_16x16x32_bf16 v[52:55], a[128:131], a[16:19], 0
ds_read_b64_tr_b16 a[140:141], v23 offset:16384
v_mfma_f32_16x16x32_bf16 v[52:55], a[132:135], a[20:23], v[52:55]
buffer_load_dwordx4 v17, s[12:15], s27 offen offset:1024 lds
v_mfma_f32_16x16x32_bf16 v[60:63], a[128:131], a[24:27], 0
ds_read_b64_tr_b16 a[142:143], v23 offset:18432
v_add_u32 v23, 4294901760, v23
v_mfma_f32_16x16x32_bf16 v[60:63], a[132:135], a[28:31], v[60:63]
buffer_store_dwordx4 v[96:99], v1, s[4:7], s31 offen sc1
v_mfma_f32_16x16x32_bf16 v[68:71], a[128:131], a[32:35], 0
s_add_u32 s31, s31, s32
ds_read_b128 a[72:75], v2 offset:18432
v_mfma_f32_16x16x32_bf16 v[68:71], a[132:135], a[36:39], v[68:71]
buffer_load_dwordx4 v18, s[12:15], s27 offen offset:2048 lds
v_mfma_f32_16x16x32_bf16 v[76:79], a[128:131], a[40:43], 0
ds_read_b128 a[76:79], v3 offset:18432
v_mfma_f32_16x16x32_bf16 v[76:79], a[132:135], a[44:47], v[76:79]
ds_read_b128 a[80:83], v2 offset:20480
v_mfma_f32_16x16x32_bf16 v[84:87], a[128:131], a[48:51], 0
ds_read_b128 a[84:87], v3 offset:20480
v_mfma_f32_16x16x32_bf16 v[84:87], a[132:135], a[52:55], v[84:87]
buffer_load_dwordx4 v19, s[12:15], s27 offen offset:3072 lds
v_mfma_f32_16x16x32_bf16 v[92:95], a[128:131], a[56:59], 0
s_add_u32 s27, s27, 524288
ds_read_b128 a[88:91], v2 offset:22528
v_mfma_f32_16x16x32_bf16 v[92:95], a[132:135], a[60:63], v[92:95]
s_waitcnt lgkmcnt(5)
buffer_store_dwordx4 v[104:107], v1, s[4:7], s31 offen sc1
v_mfma_f32_16x16x32_bf16 v[100:103], a[136:139], a[0:3], 0
s_add_u32 m0, s28, 0
ds_read_b64_tr_b16 a[128:129], v24 offset:0
v_mfma_f32_16x16x32_bf16 v[100:103], a[140:143], a[4:7], v[100:103]
s_add_u32 s31, s31, s33
buffer_load_dwordx4 v12, s[8:11], s24 offen offset:0 lds
v_mfma_f32_16x16x32_bf16 v[108:111], a[136:139], a[8:11], 0
ds_read_b64_tr_b16 a[130:131], v24 offset:2048
v_mfma_f32_16x16x32_bf16 v[108:111], a[140:143], a[12:15], v[108:111]
ds_read_b128 a[92:95], v3 offset:22528
v_mfma_f32_16x16x32_bf16 v[116:119], a[136:139], a[16:19], 0
ds_read_b64_tr_b16 a[132:133], v24 offset:16384
v_mfma_f32_16x16x32_bf16 v[116:119], a[140:143], a[20:23], v[116:119]
buffer_load_dwordx4 v13, s[8:11], s24 offen offset:1024 lds
v_mfma_f32_16x16x32_bf16 v[124:127], a[136:139], a[24:27], 0
ds_read_b64_tr_b16 a[134:135], v24 offset:18432
v_add_u32 v24, 4294901760, v24
v_mfma_f32_16x16x32_bf16 v[124:127], a[140:143], a[28:31], v[124:127]
v_mfma_f32_16x16x32_bf16 v[132:135], a[136:139], a[32:35], 0
ds_read_b128 a[96:99], v2 offset:24576
v_mfma_f32_16x16x32_bf16 v[132:135], a[140:143], a[36:39], v[132:135]
buffer_load_dwordx4 v14, s[8:11], s24 offen offset:2048 lds
v_mfma_f32_16x16x32_bf16 v[140:143], a[136:139], a[40:43], 0
ds_read_b128 a[100:103], v3 offset:24576
v_mfma_f32_16x16x32_bf16 v[140:143], a[140:143], a[44:47], v[140:143]
ds_read_b128 a[104:107], v2 offset:26624
v_mfma_f32_16x16x32_bf16 v[148:151], a[136:139], a[48:51], 0
ds_read_b128 a[108:111], v3 offset:26624
v_mfma_f32_16x16x32_bf16 v[148:151], a[140:143], a[52:55], v[148:151]
buffer_load_dwordx4 v15, s[8:11], s24 offen offset:3072 lds
v_mfma_f32_16x16x32_bf16 v[156:159], a[136:139], a[56:59], 0
s_add_u32 s24, s24, 128
ds_read_b128 a[112:115], v2 offset:28672
v_mfma_f32_16x16x32_bf16 v[156:159], a[140:143], a[60:63], v[156:159]
s_waitcnt lgkmcnt(5)
buffer_store_dwordx4 v[112:115], v1, s[4:7], s31 offen sc1
v_mfma_f32_16x16x32_bf16 v[164:167], a[128:131], a[0:3], 0
s_add_u32 s31, s31, s32
ds_read_b64_tr_b16 a[136:137], v25 offset:0
v_mfma_f32_16x16x32_bf16 v[164:167], a[132:135], a[4:7], v[164:167]
v_mfma_f32_16x16x32_bf16 v[172:175], a[128:131], a[8:11], 0
ds_read_b64_tr_b16 a[138:139], v25 offset:2048
v_mfma_f32_16x16x32_bf16 v[172:175], a[132:135], a[12:15], v[172:175]
ds_read_b128 a[116:119], v3 offset:28672
v_mfma_f32_16x16x32_bf16 v[180:183], a[128:131], a[16:19], 0
ds_read_b64_tr_b16 a[140:141], v25 offset:16384
v_mfma_f32_16x16x32_bf16 v[180:183], a[132:135], a[20:23], v[180:183]
v_mfma_f32_16x16x32_bf16 v[188:191], a[128:131], a[24:27], 0
ds_read_b64_tr_b16 a[142:143], v25 offset:18432
v_add_u32 v25, 4294901760, v25
v_mfma_f32_16x16x32_bf16 v[188:191], a[132:135], a[28:31], v[188:191]
v_mfma_f32_16x16x32_bf16 v[196:199], a[128:131], a[32:35], 0
ds_read_b128 a[120:123], v2 offset:30720
v_mfma_f32_16x16x32_bf16 v[196:199], a[132:135], a[36:39], v[196:199]
v_mfma_f32_16x16x32_bf16 v[204:207], a[128:131], a[40:43], 0
ds_read_b128 a[124:127], v3 offset:30720
v_mfma_f32_16x16x32_bf16 v[204:207], a[132:135], a[44:47], v[204:207]
v_mfma_f32_16x16x32_bf16 v[212:215], a[128:131], a[48:51], 0
v_mfma_f32_16x16x32_bf16 v[212:215], a[132:135], a[52:55], v[212:215]
buffer_store_dwordx4 v[120:123], v1, s[4:7], s31 offen sc1
v_mfma_f32_16x16x32_bf16 v[220:223], a[128:131], a[56:59], 0
s_add_u32 s31, s31, s34
v_mfma_f32_16x16x32_bf16 v[220:223], a[132:135], a[60:63], v[220:223]
s_waitcnt vmcnt(28) lgkmcnt(0)
s_barrier
v_mfma_f32_16x16x32_bf16 v[224:227], a[136:139], a[0:3], 0
s_add_u32 m0, s29, 131072
ds_read_b64_tr_b16 a[128:129], v22 offset:0
v_mfma_f32_16x16x32_bf16 v[224:227], a[140:143], a[4:7], v[224:227]
buffer_load_dwordx4 v16, s[12:15], s26 offen offset:0 lds
v_mfma_f32_16x16x32_bf16 v[228:231], a[136:139], a[8:11], 0
ds_read_b64_tr_b16 a[130:131], v22 offset:2048
v_mfma_f32_16x16x32_bf16 v[228:231], a[140:143], a[12:15], v[228:231]
v_mfma_f32_16x16x32_bf16 v[232:235], a[136:139], a[16:19], 0
ds_read_b64_tr_b16 a[132:133], v22 offset:16384
v_mfma_f32_16x16x32_bf16 v[232:235], a[140:143], a[20:23], v[232:235]
buffer_load_dwordx4 v17, s[12:15], s26 offen offset:1024 lds
v_mfma_f32_16x16x32_bf16 v[236:239], a[136:139], a[24:27], 0
ds_read_b64_tr_b16 a[134:135], v22 offset:18432
v_add_u32 v22, 32768, v22
v_mfma_f32_16x16x32_bf16 v[236:239], a[140:143], a[28:31], v[236:239]
v_mfma_f32_16x16x32_bf16 v[240:243], a[136:139], a[32:35], 0
v_mfma_f32_16x16x32_bf16 v[240:243], a[140:143], a[36:39], v[240:243]
buffer_load_dwordx4 v18, s[12:15], s26 offen offset:2048 lds
v_mfma_f32_16x16x32_bf16 v[244:247], a[136:139], a[40:43], 0
v_mfma_f32_16x16x32_bf16 v[244:247], a[140:143], a[44:47], v[244:247]
v_mfma_f32_16x16x32_bf16 v[248:251], a[136:139], a[48:51], 0
v_mfma_f32_16x16x32_bf16 v[248:251], a[140:143], a[52:55], v[248:251]
buffer_load_dwordx4 v19, s[12:15], s26 offen offset:3072 lds
v_mfma_f32_16x16x32_bf16 v[252:255], a[136:139], a[56:59], 0
s_add_u32 s26, s26, 524288
v_mfma_f32_16x16x32_bf16 v[252:255], a[140:143], a[60:63], v[252:255]
s_waitcnt lgkmcnt(0)
v_mfma_f32_16x16x32_bf16 v[36:39], a[128:131], a[64:67], v[36:39]
s_add_u32 m0, s29, 147456
ds_read_b64_tr_b16 a[136:137], v23 offset:0
v_mfma_f32_16x16x32_bf16 v[36:39], a[132:135], a[68:71], v[36:39]
buffer_load_dwordx4 v16, s[12:15], s27 offen offset:0 lds
v_mfma_f32_16x16x32_bf16 v[44:47], a[128:131], a[72:75], v[44:47]
ds_read_b64_tr_b16 a[138:139], v23 offset:2048
v_mfma_f32_16x16x32_bf16 v[44:47], a[132:135], a[76:79], v[44:47]
ds_read_b128 a[0:3], v2 offset:32768
ds_read_b128 a[4:7], v3 offset:32768
v_mfma_f32_16x16x32_bf16 v[52:55], a[128:131], a[80:83], v[52:55]
ds_read_b64_tr_b16 a[140:141], v23 offset:16384
v_mfma_f32_16x16x32_bf16 v[52:55], a[132:135], a[84:87], v[52:55]
buffer_load_dwordx4 v17, s[12:15], s27 offen offset:1024 lds
v_mfma_f32_16x16x32_bf16 v[60:63], a[128:131], a[88:91], v[60:63]
ds_read_b64_tr_b16 a[142:143], v23 offset:18432
v_add_u32 v23, 32768, v23
v_mfma_f32_16x16x32_bf16 v[60:63], a[132:135], a[92:95], v[60:63]
buffer_store_dwordx4 v[128:131], v1, s[4:7], s31 offen sc1
v_mfma_f32_16x16x32_bf16 v[68:71], a[128:131], a[96:99], v[68:71]
s_add_u32 s31, s31, s32
ds_read_b128 a[8:11], v2 offset:34816
v_accvgpr_read_b32 v32, a192
v_mfma_f32_16x16x32_bf16 v[68:71], a[132:135], a[100:103], v[68:71]
buffer_load_dwordx4 v18, s[12:15], s27 offen offset:2048 lds
v_mfma_f32_16x16x32_bf16 v[76:79], a[128:131], a[104:107], v[76:79]
ds_read_b128 a[12:15], v3 offset:34816
v_accvgpr_read_b32 v33, a193
v_mfma_f32_16x16x32_bf16 v[76:79], a[132:135], a[108:111], v[76:79]
ds_read_b128 a[16:19], v2 offset:36864
v_accvgpr_read_b32 v34, a194
v_mfma_f32_16x16x32_bf16 v[84:87], a[128:131], a[112:115], v[84:87]
ds_read_b128 a[20:23], v3 offset:36864
v_accvgpr_read_b32 v35, a195
v_mfma_f32_16x16x32_bf16 v[84:87], a[132:135], a[116:119], v[84:87]
buffer_load_dwordx4 v19, s[12:15], s27 offen offset:3072 lds
v_mfma_f32_16x16x32_bf16 v[92:95], a[128:131], a[120:123], v[92:95]
s_add_u32 s27, s27, 524288
ds_read_b128 a[24:27], v2 offset:38912
v_accvgpr_read_b32 v96, a196
v_mfma_f32_16x16x32_bf16 v[92:95], a[132:135], a[124:127], v[92:95]
s_waitcnt lgkmcnt(5)
buffer_store_dwordx4 v[136:139], v1, s[4:7], s31 offen sc1
v_mfma_f32_16x16x32_bf16 v[100:103], a[136:139], a[64:67], v[100:103]
s_add_u32 m0, s28, 16384
ds_read_b64_tr_b16 a[128:129], v24 offset:0
v_accvgpr_read_b32 v97, a197
v_mfma_f32_16x16x32_bf16 v[100:103], a[140:143], a[68:71], v[100:103]
s_add_u32 s31, s31, s33
buffer_load_dwordx4 v12, s[8:11], s24 offen offset:0 lds
v_mfma_f32_16x16x32_bf16 v[108:111], a[136:139], a[72:75], v[108:111]
ds_read_b64_tr_b16 a[130:131], v24 offset:2048
v_accvgpr_read_b32 v98, a198
v_mfma_f32_16x16x32_bf16 v[108:111], a[140:143], a[76:79], v[108:111]
ds_read_b128 a[28:31], v3 offset:38912
v_accvgpr_read_b32 v99, a199
v_mfma_f32_16x16x32_bf16 v[116:119], a[136:139], a[80:83], v[116:119]
ds_read_b64_tr_b16 a[132:133], v24 offset:16384
v_cvt_pk_bf16_f32 v32, v32, v33
v_mfma_f32_16x16x32_bf16 v[116:119], a[140:143], a[84:87], v[116:119]
buffer_load_dwordx4 v13, s[8:11], s24 offen offset:1024 lds
v_mfma_f32_16x16x32_bf16 v[124:127], a[136:139], a[88:91], v[124:127]
ds_read_b64_tr_b16 a[134:135], v24 offset:18432
v_add_u32 v24, 32768, v24
v_mfma_f32_16x16x32_bf16 v[124:127], a[140:143], a[92:95], v[124:127]
v_cvt_pk_bf16_f32 v33, v34, v35
v_cvt_pk_bf16_f32 v34, v96, v97
v_mfma_f32_16x16x32_bf16 v[132:135], a[136:139], a[96:99], v[132:135]
ds_read_b128 a[32:35], v2 offset:40960
v_cvt_pk_bf16_f32 v35, v98, v99
v_mfma_f32_16x16x32_bf16 v[132:135], a[140:143], a[100:103], v[132:135]
buffer_load_dwordx4 v14, s[8:11], s24 offen offset:2048 lds
v_mfma_f32_16x16x32_bf16 v[140:143], a[136:139], a[104:107], v[140:143]
ds_read_b128 a[36:39], v3 offset:40960
v_accvgpr_read_b32 v40, a200
v_mfma_f32_16x16x32_bf16 v[140:143], a[140:143], a[108:111], v[140:143]
ds_read_b128 a[40:43], v2 offset:43008
v_accvgpr_read_b32 v41, a201
v_mfma_f32_16x16x32_bf16 v[148:151], a[136:139], a[112:115], v[148:151]
ds_read_b128 a[44:47], v3 offset:43008
v_accvgpr_read_b32 v42, a202
v_mfma_f32_16x16x32_bf16 v[148:151], a[140:143], a[116:119], v[148:151]
buffer_load_dwordx4 v15, s[8:11], s24 offen offset:3072 lds
v_mfma_f32_16x16x32_bf16 v[156:159], a[136:139], a[120:123], v[156:159]
s_add_u32 s24, s24, 128
ds_read_b128 a[48:51], v2 offset:45056
v_accvgpr_read_b32 v43, a203
v_mfma_f32_16x16x32_bf16 v[156:159], a[140:143], a[124:127], v[156:159]
s_waitcnt lgkmcnt(5)
buffer_store_dwordx4 v[144:147], v1, s[4:7], s31 offen sc1
v_mfma_f32_16x16x32_bf16 v[164:167], a[128:131], a[64:67], v[164:167]
s_add_u32 s31, s31, s32
ds_read_b64_tr_b16 a[136:137], v25 offset:0
v_accvgpr_read_b32 v96, a204
v_mfma_f32_16x16x32_bf16 v[164:167], a[132:135], a[68:71], v[164:167]
v_accvgpr_read_b32 v97, a205
v_accvgpr_read_b32 v98, a206
v_mfma_f32_16x16x32_bf16 v[172:175], a[128:131], a[72:75], v[172:175]
ds_read_b64_tr_b16 a[138:139], v25 offset:2048
v_accvgpr_read_b32 v99, a207
v_mfma_f32_16x16x32_bf16 v[172:175], a[132:135], a[76:79], v[172:175]
ds_read_b128 a[52:55], v3 offset:45056
v_cvt_pk_bf16_f32 v40, v40, v41
v_mfma_f32_16x16x32_bf16 v[180:183], a[128:131], a[80:83], v[180:183]
ds_read_b64_tr_b16 a[140:141], v25 offset:16384
v_cvt_pk_bf16_f32 v41, v42, v43
v_mfma_f32_16x16x32_bf16 v[180:183], a[132:135], a[84:87], v[180:183]
v_cvt_pk_bf16_f32 v42, v96, v97
v_cvt_pk_bf16_f32 v43, v98, v99
v_mfma_f32_16x16x32_bf16 v[188:191], a[128:131], a[88:91], v[188:191]
ds_read_b64_tr_b16 a[142:143], v25 offset:18432
v_add_u32 v25, 32768, v25
v_mfma_f32_16x16x32_bf16 v[188:191], a[132:135], a[92:95], v[188:191]
v_accvgpr_read_b32 v48, a208
v_accvgpr_read_b32 v49, a209
v_mfma_f32_16x16x32_bf16 v[196:199], a[128:131], a[96:99], v[196:199]
ds_read_b128 a[56:59], v2 offset:47104
v_accvgpr_read_b32 v50, a210
v_mfma_f32_16x16x32_bf16 v[196:199], a[132:135], a[100:103], v[196:199]
v_accvgpr_read_b32 v51, a211
v_accvgpr_read_b32 v96, a212
v_mfma_f32_16x16x32_bf16 v[204:207], a[128:131], a[104:107], v[204:207]
ds_read_b128 a[60:63], v3 offset:47104
v_accvgpr_read_b32 v97, a213
v_mfma_f32_16x16x32_bf16 v[204:207], a[132:135], a[108:111], v[204:207]
v_accvgpr_read_b32 v98, a214
v_accvgpr_read_b32 v99, a215
v_mfma_f32_16x16x32_bf16 v[212:215], a[128:131], a[112:115], v[212:215]
v_cvt_pk_bf16_f32 v48, v48, v49
v_cvt_pk_bf16_f32 v49, v50, v51
v_mfma_f32_16x16x32_bf16 v[212:215], a[132:135], a[116:119], v[212:215]
buffer_store_dwordx4 v[152:155], v1, s[4:7], s31 offen sc1
v_mfma_f32_16x16x32_bf16 v[220:223], a[128:131], a[120:123], v[220:223]
s_add_u32 s31, s31, s36
v_cvt_pk_bf16_f32 v50, v96, v97
v_cvt_pk_bf16_f32 v51, v98, v99
v_mfma_f32_16x16x32_bf16 v[220:223], a[132:135], a[124:127], v[220:223]
s_waitcnt vmcnt(23) lgkmcnt(0)
s_barrier
v_accvgpr_read_b32 v56, a216
v_mfma_f32_16x16x32_bf16 v[224:227], a[136:139], a[64:67], v[224:227]
s_add_u32 m0, s29, 65536
ds_read_b64_tr_b16 a[128:129], v22 offset:0
v_accvgpr_read_b32 v57, a217
v_mfma_f32_16x16x32_bf16 v[224:227], a[140:143], a[68:71], v[224:227]
buffer_load_dwordx4 v16, s[12:15], s26 offen offset:0 lds
v_mfma_f32_16x16x32_bf16 v[228:231], a[136:139], a[72:75], v[228:231]
ds_read_b64_tr_b16 a[130:131], v22 offset:2048
v_accvgpr_read_b32 v58, a218
v_mfma_f32_16x16x32_bf16 v[228:231], a[140:143], a[76:79], v[228:231]
v_accvgpr_read_b32 v59, a219
v_accvgpr_read_b32 v96, a220
v_mfma_f32_16x16x32_bf16 v[232:235], a[136:139], a[80:83], v[232:235]
ds_read_b64_tr_b16 a[132:133], v22 offset:16384
v_accvgpr_read_b32 v97, a221
v_mfma_f32_16x16x32_bf16 v[232:235], a[140:143], a[84:87], v[232:235]
buffer_load_dwordx4 v17, s[12:15], s26 offen offset:1024 lds
v_mfma_f32_16x16x32_bf16 v[236:239], a[136:139], a[88:91], v[236:239]
ds_read_b64_tr_b16 a[134:135], v22 offset:18432
v_add_u32 v22, 32768, v22
v_mfma_f32_16x16x32_bf16 v[236:239], a[140:143], a[92:95], v[236:239]
v_accvgpr_read_b32 v98, a222
v_accvgpr_read_b32 v99, a223
v_mfma_f32_16x16x32_bf16 v[240:243], a[136:139], a[96:99], v[240:243]
v_cvt_pk_bf16_f32 v56, v56, v57
v_cvt_pk_bf16_f32 v57, v58, v59
v_mfma_f32_16x16x32_bf16 v[240:243], a[140:143], a[100:103], v[240:243]
buffer_load_dwordx4 v18, s[12:15], s26 offen offset:2048 lds
v_mfma_f32_16x16x32_bf16 v[244:247], a[136:139], a[104:107], v[244:247]
v_cvt_pk_bf16_f32 v58, v96, v97
v_cvt_pk_bf16_f32 v59, v98, v99
v_mfma_f32_16x16x32_bf16 v[244:247], a[140:143], a[108:111], v[244:247]
v_accvgpr_read_b32 v64, a224
v_accvgpr_read_b32 v65, a225
v_mfma_f32_16x16x32_bf16 v[248:251], a[136:139], a[112:115], v[248:251]
v_accvgpr_read_b32 v66, a226
v_accvgpr_read_b32 v67, a227
v_mfma_f32_16x16x32_bf16 v[248:251], a[140:143], a[116:119], v[248:251]
buffer_load_dwordx4 v19, s[12:15], s26 offen offset:3072 lds
v_mfma_f32_16x16x32_bf16 v[252:255], a[136:139], a[120:123], v[252:255]
s_add_u32 s26, s26, 524288
v_accvgpr_read_b32 v96, a228
v_accvgpr_read_b32 v97, a229
v_mfma_f32_16x16x32_bf16 v[252:255], a[140:143], a[124:127], v[252:255]
s_waitcnt lgkmcnt(0)
v_accvgpr_read_b32 v98, a230
v_accvgpr_read_b32 v99, a231
v_mfma_f32_16x16x32_bf16 v[36:39], a[128:131], a[0:3], v[36:39]
s_add_u32 m0, s29, 81920
ds_read_b64_tr_b16 a[136:137], v23 offset:0
v_cvt_pk_bf16_f32 v64, v64, v65
v_mfma_f32_16x16x32_bf16 v[36:39], a[132:135], a[4:7], v[36:39]
buffer_load_dwordx4 v16, s[12:15], s27 offen offset:0 lds
v_mfma_f32_16x16x32_bf16 v[44:47], a[128:131], a[8:11], v[44:47]
ds_read_b64_tr_b16 a[138:139], v23 offset:2048
v_cvt_pk_bf16_f32 v65, v66, v67
v_mfma_f32_16x16x32_bf16 v[44:47], a[132:135], a[12:15], v[44:47]
ds_read_b128 a[64:67], v2 offset:49152
ds_read_b128 a[68:71], v3 offset:49152
v_mfma_f32_16x16x32_bf16 v[52:55], a[128:131], a[16:19], v[52:55]
ds_read_b64_tr_b16 a[140:141], v23 offset:16384
v_cvt_pk_bf16_f32 v66, v96, v97
v_mfma_f32_16x16x32_bf16 v[52:55], a[132:135], a[20:23], v[52:55]
PAD_28:
s_cbranch_execz M_tret
buffer_load_dwordx4 v17, s[12:15], s27 offen offset:1024 lds
v_mfma_f32_16x16x32_bf16 v[60:63], a[128:131], a[24:27], v[60:63]
ds_read_b64_tr_b16 a[142:143], v23 offset:18432
v_add_u32 v23, 32768, v23
v_mfma_f32_16x16x32_bf16 v[60:63], a[132:135], a[28:31], v[60:63]
buffer_store_dwordx4 v[160:163], v1, s[4:7], s31 offen sc1
v_mfma_f32_16x16x32_bf16 v[68:71], a[128:131], a[32:35], v[68:71]
s_add_u32 s31, s31, s32
ds_read_b128 a[72:75], v2 offset:51200
v_cvt_pk_bf16_f32 v67, v98, v99
v_mfma_f32_16x16x32_bf16 v[68:71], a[132:135], a[36:39], v[68:71]
buffer_load_dwordx4 v18, s[12:15], s27 offen offset:2048 lds
v_mfma_f32_16x16x32_bf16 v[76:79], a[128:131], a[40:43], v[76:79]
ds_read_b128 a[76:79], v3 offset:51200
v_accvgpr_read_b32 v72, a232
v_mfma_f32_16x16x32_bf16 v[76:79], a[132:135], a[44:47], v[76:79]
ds_read_b128 a[80:83], v2 offset:53248
v_accvgpr_read_b32 v73, a233
v_mfma_f32_16x16x32_bf16 v[84:87], a[128:131], a[48:51], v[84:87]
ds_read_b128 a[84:87], v3 offset:53248
v_accvgpr_read_b32 v74, a234
v_mfma_f32_16x16x32_bf16 v[84:87], a[132:135], a[52:55], v[84:87]
buffer_load_dwordx4 v19, s[12:15], s27 offen offset:3072 lds
v_mfma_f32_16x16x32_bf16 v[92:95], a[128:131], a[56:59], v[92:95]
s_add_u32 s27, s27, 524288
ds_read_b128 a[88:91], v2 offset:55296
v_accvgpr_read_b32 v75, a235
v_mfma_f32_16x16x32_bf16 v[92:95], a[132:135], a[60:63], v[92:95]
s_waitcnt lgkmcnt(5)
buffer_store_dwordx4 v[168:171], v1, s[4:7], s31 offen sc1
v_mfma_f32_16x16x32_bf16 v[100:103], a[136:139], a[0:3], v[100:103]
s_add_u32 m0, s28, 32768
ds_read_b64_tr_b16 a[128:129], v24 offset:0
v_accvgpr_read_b32 v96, a236
v_mfma_f32_16x16x32_bf16 v[100:103], a[140:143], a[4:7], v[100:103]
s_add_u32 s31, s31, s33
buffer_load_dwordx4 v12, s[8:11], s24 offen offset:0 lds
v_mfma_f32_16x16x32_bf16 v[108:111], a[136:139], a[8:11], v[108:111]
ds_read_b64_tr_b16 a[130:131], v24 offset:2048
v_accvgpr_read_b32 v97, a237
v_mfma_f32_16x16x32_bf16 v[108:111], a[140:143], a[12:15], v[108:111]
ds_read_b128 a[92:95], v3 offset:55296
v_accvgpr_read_b32 v98, a238
v_mfma_f32_16x16x32_bf16 v[116:119], a[136:139], a[16:19], v[116:119]
ds_read_b64_tr_b16 a[132:133], v24 offset:16384
v_accvgpr_read_b32 v99, a239
v_mfma_f32_16x16x32_bf16 v[116:119], a[140:143], a[20:23], v[116:119]
buffer_load_dwordx4 v13, s[8:11], s24 offen offset:1024 lds
v_mfma_f32_16x16x32_bf16 v[124:127], a[136:139], a[24:27], v[124:127]
ds_read_b64_tr_b16 a[134:135], v24 offset:18432
v_add_u32 v24, 32768, v24
v_mfma_f32_16x16x32_bf16 v[124:127], a[140:143], a[28:31], v[124:127]
v_cvt_pk_bf16_f32 v72, v72, v73
v_cvt_pk_bf16_f32 v73, v74, v75
v_mfma_f32_16x16x32_bf16 v[132:135], a[136:139], a[32:35], v[132:135]
ds_read_b128 a[96:99], v2 offset:57344
v_cvt_pk_bf16_f32 v74, v96, v97
v_mfma_f32_16x16x32_bf16 v[132:135], a[140:143], a[36:39], v[132:135]
buffer_load_dwordx4 v14, s[8:11], s24 offen offset:2048 lds
v_mfma_f32_16x16x32_bf16 v[140:143], a[136:139], a[40:43], v[140:143]
ds_read_b128 a[100:103], v3 offset:57344
v_cvt_pk_bf16_f32 v75, v98, v99
v_mfma_f32_16x16x32_bf16 v[140:143], a[140:143], a[44:47], v[140:143]
ds_read_b128 a[104:107], v2 offset:59392
v_accvgpr_read_b32 v80, a240
v_mfma_f32_16x16x32_bf16 v[148:151], a[136:139], a[48:51], v[148:151]
ds_read_b128 a[108:111], v3 offset:59392
v_accvgpr_read_b32 v81, a241
v_mfma_f32_16x16x32_bf16 v[148:151], a[140:143], a[52:55], v[148:151]
buffer_load_dwordx4 v15, s[8:11], s24 offen offset:3072 lds
v_mfma_f32_16x16x32_bf16 v[156:159], a[136:139], a[56:59], v[156:159]
s_add_u32 s24, s24, 128
ds_read_b128 a[112:115], v2 offset:61440
v_accvgpr_read_b32 v82, a242
v_mfma_f32_16x16x32_bf16 v[156:159], a[140:143], a[60:63], v[156:159]
s_waitcnt lgkmcnt(5)
buffer_store_dwordx4 v[176:179], v1, s[4:7], s31 offen sc1
v_mfma_f32_16x16x32_bf16 v[164:167], a[128:131], a[0:3], v[164:167]
s_add_u32 s31, s31, s32
ds_read_b64_tr_b16 a[136:137], v25 offset:0
v_accvgpr_read_b32 v83, a243
v_mfma_f32_16x16x32_bf16 v[164:167], a[132:135], a[4:7], v[164:167]
v_accvgpr_read_b32 v96, a244
v_accvgpr_read_b32 v97, a245
v_mfma_f32_16x16x32_bf16 v[172:175], a[128:131], a[8:11], v[172:175]
ds_read_b64_tr_b16 a[138:139], v25 offset:2048
v_accvgpr_read_b32 v98, a246
v_mfma_f32_16x16x32_bf16 v[172:175], a[132:135], a[12:15], v[172:175]
ds_read_b128 a[116:119], v3 offset:61440
v_accvgpr_read_b32 v99, a247
v_mfma_f32_16x16x32_bf16 v[180:183], a[128:131], a[16:19], v[180:183]
ds_read_b64_tr_b16 a[140:141], v25 offset:16384
v_cvt_pk_bf16_f32 v80, v80, v81
v_mfma_f32_16x16x32_bf16 v[180:183], a[132:135], a[20:23], v[180:183]
buffer_store_dwordx4 v[184:187], v1, s[4:7], s31 offen sc1
v_mfma_f32_16x16x32_bf16 v[188:191], a[128:131], a[24:27], v[188:191]
s_add_u32 s31, s31, s34
ds_read_b64_tr_b16 a[142:143], v25 offset:18432
v_add_u32 v25, 32768, v25
v_mfma_f32_16x16x32_bf16 v[188:191], a[132:135], a[28:31], v[188:191]
v_cvt_pk_bf16_f32 v81, v82, v83
v_cvt_pk_bf16_f32 v82, v96, v97
v_mfma_f32_16x16x32_bf16 v[196:199], a[128:131], a[32:35], v[196:199]
ds_read_b128 a[120:123], v2 offset:63488
v_cvt_pk_bf16_f32 v83, v98, v99
v_mfma_f32_16x16x32_bf16 v[196:199], a[132:135], a[36:39], v[196:199]
v_accvgpr_read_b32 v88, a248
v_accvgpr_read_b32 v89, a249
v_mfma_f32_16x16x32_bf16 v[204:207], a[128:131], a[40:43], v[204:207]
ds_read_b128 a[124:127], v3 offset:63488
v_accvgpr_read_b32 v90, a250
v_mfma_f32_16x16x32_bf16 v[204:207], a[132:135], a[44:47], v[204:207]
v_accvgpr_read_b32 v91, a251
v_accvgpr_read_b32 v96, a252
v_mfma_f32_16x16x32_bf16 v[212:215], a[128:131], a[48:51], v[212:215]
v_accvgpr_read_b32 v97, a253
v_accvgpr_read_b32 v98, a254
v_mfma_f32_16x16x32_bf16 v[212:215], a[132:135], a[52:55], v[212:215]
v_accvgpr_read_b32 v99, a255
v_cvt_pk_bf16_f32 v88, v88, v89
v_mfma_f32_16x16x32_bf16 v[220:223], a[128:131], a[56:59], v[220:223]
v_cvt_pk_bf16_f32 v89, v90, v91
v_cvt_pk_bf16_f32 v90, v96, v97
v_mfma_f32_16x16x32_bf16 v[220:223], a[132:135], a[60:63], v[220:223]
s_waitcnt vmcnt(23) lgkmcnt(0)
s_barrier
v_cvt_pk_bf16_f32 v91, v98, v99
v_mfma_f32_16x16x32_bf16 v[224:227], a[136:139], a[0:3], v[224:227]
s_add_u32 m0, s29, 98304
ds_read_b64_tr_b16 a[128:129], v22 offset:0
v_mfma_f32_16x16x32_bf16 v[224:227], a[140:143], a[4:7], v[224:227]
buffer_load_dwordx4 v16, s[12:15], s26 offen offset:0 lds
v_mfma_f32_16x16x32_bf16 v[228:231], a[136:139], a[8:11], v[228:231]
ds_read_b64_tr_b16 a[130:131], v22 offset:2048
v_mfma_f32_16x16x32_bf16 v[228:231], a[140:143], a[12:15], v[228:231]
buffer_store_dwordx4 v[192:195], v1, s[4:7], s31 offen sc1
v_mfma_f32_16x16x32_bf16 v[232:235], a[136:139], a[16:19], v[232:235]
s_add_u32 s31, s31, s32
ds_read_b64_tr_b16 a[132:133], v22 offset:16384
v_mfma_f32_16x16x32_bf16 v[232:235], a[140:143], a[20:23], v[232:235]
buffer_load_dwordx4 v17, s[12:15], s26 offen offset:1024 lds
v_mfma_f32_16x16x32_bf16 v[236:239], a[136:139], a[24:27], v[236:239]
ds_read_b64_tr_b16 a[134:135], v22 offset:18432
v_add_u32 v22, 4294901760, v22
v_mfma_f32_16x16x32_bf16 v[236:239], a[140:143], a[28:31], v[236:239]
v_mfma_f32_16x16x32_bf16 v[240:243], a[136:139], a[32:35], v[240:243]
v_mfma_f32_16x16x32_bf16 v[240:243], a[140:143], a[36:39], v[240:243]
buffer_load_dwordx4 v18, s[12:15], s26 offen offset:2048 lds
v_mfma_f32_16x16x32_bf16 v[244:247], a[136:139], a[40:43], v[244:247]
v_mfma_f32_16x16x32_bf16 v[244:247], a[140:143], a[44:47], v[244:247]
v_mfma_f32_16x16x32_bf16 v[248:251], a[136:139], a[48:51], v[248:251]
v_mfma_f32_16x16x32_bf16 v[248:251], a[140:143], a[52:55], v[248:251]
buffer_load_dwordx4 v19, s[12:15], s26 offen offset:3072 lds
v_mfma_f32_16x16x32_bf16 v[252:255], a[136:139], a[56:59], v[252:255]
s_add_u32 s26, s26, 524288
v_mfma_f32_16x16x32_bf16 v[252:255], a[140:143], a[60:63], v[252:255]
s_waitcnt lgkmcnt(0)
v_mfma_f32_16x16x32_bf16 v[36:39], a[128:131], a[64:67], v[36:39]
s_add_u32 m0, s29, 114688
ds_read_b64_tr_b16 a[136:137], v23 offset:0
v_mfma_f32_16x16x32_bf16 v[36:39], a[132:135], a[68:71], v[36:39]
buffer_load_dwordx4 v16, s[12:15], s27 offen offset:0 lds
v_mfma_f32_16x16x32_bf16 v[44:47], a[128:131], a[72:75], v[44:47]
ds_read_b64_tr_b16 a[138:139], v23 offset:2048
v_mfma_f32_16x16x32_bf16 v[44:47], a[132:135], a[76:79], v[44:47]
ds_read_b128 a[0:3], v2 offset:0
ds_read_b128 a[4:7], v3 offset:0
v_mfma_f32_16x16x32_bf16 v[52:55], a[128:131], a[80:83], v[52:55]
ds_read_b64_tr_b16 a[140:141], v23 offset:16384
v_mfma_f32_16x16x32_bf16 v[52:55], a[132:135], a[84:87], v[52:55]
buffer_load_dwordx4 v17, s[12:15], s27 offen offset:1024 lds
v_mfma_f32_16x16x32_bf16 v[60:63], a[128:131], a[88:91], v[60:63]
ds_read_b64_tr_b16 a[142:143], v23 offset:18432
v_add_u32 v23, 4294901760, v23
v_mfma_f32_16x16x32_bf16 v[60:63], a[132:135], a[92:95], v[60:63]
buffer_store_dwordx4 v[200:203], v1, s[4:7], s31 offen sc1
v_mfma_f32_16x16x32_bf16 v[68:71], a[128:131], a[96:99], v[68:71]
s_add_u32 s31, s31, s33
ds_read_b128 a[8:11], v2 offset:2048
v_mfma_f32_16x16x32_bf16 v[68:71], a[132:135], a[100:103], v[68:71]
buffer_load_dwordx4 v18, s[12:15], s27 offen offset:2048 lds
v_mfma_f32_16x16x32_bf16 v[76:79], a[128:131], a[104:107], v[76:79]
ds_read_b128 a[12:15], v3 offset:2048
v_mfma_f32_16x16x32_bf16 v[76:79], a[132:135], a[108:111], v[76:79]
ds_read_b128 a[16:19], v2 offset:4096
v_mfma_f32_16x16x32_bf16 v[84:87], a[128:131], a[112:115], v[84:87]
ds_read_b128 a[20:23], v3 offset:4096
v_mfma_f32_16x16x32_bf16 v[84:87], a[132:135], a[116:119], v[84:87]
buffer_load_dwordx4 v19, s[12:15], s27 offen offset:3072 lds
v_mfma_f32_16x16x32_bf16 v[92:95], a[128:131], a[120:123], v[92:95]
s_add_u32 s27, s27, 524288
ds_read_b128 a[24:27], v2 offset:6144
v_mfma_f32_16x16x32_bf16 v[92:95], a[132:135], a[124:127], v[92:95]
s_waitcnt lgkmcnt(5)
buffer_store_dwordx4 v[208:211], v1, s[4:7], s31 offen sc1
v_mfma_f32_16x16x32_bf16 v[100:103], a[136:139], a[64:67], v[100:103]
s_add_u32 s31, s31, s32
ds_read_b64_tr_b16 a[128:129], v24 offset:0
v_mfma_f32_16x16x32_bf16 v[100:103], a[140:143], a[68:71], v[100:103]
v_mfma_f32_16x16x32_bf16 v[108:111], a[136:139], a[72:75], v[108:111]
ds_read_b64_tr_b16 a[130:131], v24 offset:2048
v_mfma_f32_16x16x32_bf16 v[108:111], a[140:143], a[76:79], v[108:111]
ds_read_b128 a[28:31], v3 offset:6144
v_mfma_f32_16x16x32_bf16 v[116:119], a[136:139], a[80:83], v[116:119]
ds_read_b64_tr_b16 a[132:133], v24 offset:16384
v_mfma_f32_16x16x32_bf16 v[116:119], a[140:143], a[84:87], v[116:119]
v_mfma_f32_16x16x32_bf16 v[124:127], a[136:139], a[88:91], v[124:127]
ds_read_b64_tr_b16 a[134:135], v24 offset:18432
v_add_u32 v24, 4294901760, v24
v_mfma_f32_16x16x32_bf16 v[124:127], a[140:143], a[92:95], v[124:127]
v_mfma_f32_16x16x32_bf16 v[132:135], a[136:139], a[96:99], v[132:135]
ds_read_b128 a[32:35], v2 offset:8192
v_mfma_f32_16x16x32_bf16 v[132:135], a[140:143], a[100:103], v[132:135]
buffer_store_dwordx4 v[216:219], v1, s[4:7], s31 offen sc1
v_mfma_f32_16x16x32_bf16 v[140:143], a[136:139], a[104:107], v[140:143]
s_add_u32 s31, s31, s35
ds_read_b128 a[36:39], v3 offset:8192
v_mfma_f32_16x16x32_bf16 v[140:143], a[140:143], a[108:111], v[140:143]
ds_read_b128 a[40:43], v2 offset:10240
v_mfma_f32_16x16x32_bf16 v[148:151], a[136:139], a[112:115], v[148:151]
ds_read_b128 a[44:47], v3 offset:10240
v_mfma_f32_16x16x32_bf16 v[148:151], a[140:143], a[116:119], v[148:151]
v_mfma_f32_16x16x32_bf16 v[156:159], a[136:139], a[120:123], v[156:159]
ds_read_b128 a[48:51], v2 offset:12288
v_mfma_f32_16x16x32_bf16 v[156:159], a[140:143], a[124:127], v[156:159]
s_waitcnt lgkmcnt(5)
v_mfma_f32_16x16x32_bf16 v[164:167], a[128:131], a[64:67], v[164:167]
ds_read_b64_tr_b16 a[136:137], v25 offset:0
v_mfma_f32_16x16x32_bf16 v[164:167], a[132:135], a[68:71], v[164:167]
v_mfma_f32_16x16x32_bf16 v[172:175], a[128:131], a[72:75], v[172:175]
ds_read_b64_tr_b16 a[138:139], v25 offset:2048
v_mfma_f32_16x16x32_bf16 v[172:175], a[132:135], a[76:79], v[172:175]
ds_read_b128 a[52:55], v3 offset:12288
v_mfma_f32_16x16x32_bf16 v[180:183], a[128:131], a[80:83], v[180:183]
ds_read_b64_tr_b16 a[140:141], v25 offset:16384
v_mfma_f32_16x16x32_bf16 v[180:183], a[132:135], a[84:87], v[180:183]
buffer_store_dwordx4 v[32:35], v1, s[4:7], s31 offen sc1
v_mfma_f32_16x16x32_bf16 v[188:191], a[128:131], a[88:91], v[188:191]
s_add_u32 s31, s31, s32
ds_read_b64_tr_b16 a[142:143], v25 offset:18432
v_add_u32 v25, 4294901760, v25
v_mfma_f32_16x16x32_bf16 v[188:191], a[132:135], a[92:95], v[188:191]
v_mfma_f32_16x16x32_bf16 v[196:199], a[128:131], a[96:99], v[196:199]
ds_read_b128 a[56:59], v2 offset:14336
v_mfma_f32_16x16x32_bf16 v[196:199], a[132:135], a[100:103], v[196:199]
v_mfma_f32_16x16x32_bf16 v[204:207], a[128:131], a[104:107], v[204:207]
ds_read_b128 a[60:63], v3 offset:14336
v_mfma_f32_16x16x32_bf16 v[204:207], a[132:135], a[108:111], v[204:207]
v_mfma_f32_16x16x32_bf16 v[212:215], a[128:131], a[112:115], v[212:215]
v_mfma_f32_16x16x32_bf16 v[212:215], a[132:135], a[116:119], v[212:215]
v_mfma_f32_16x16x32_bf16 v[220:223], a[128:131], a[120:123], v[220:223]
v_mfma_f32_16x16x32_bf16 v[220:223], a[132:135], a[124:127], v[220:223]
s_waitcnt vmcnt(20) lgkmcnt(0)
s_barrier
v_mfma_f32_16x16x32_bf16 v[224:227], a[136:139], a[64:67], v[224:227]
s_add_u32 m0, s29, 131072
ds_read_b64_tr_b16 a[128:129], v22 offset:0
v_mfma_f32_16x16x32_bf16 v[224:227], a[140:143], a[68:71], v[224:227]
buffer_load_dwordx4 v16, s[12:15], s26 offen offset:0 lds
v_mfma_f32_16x16x32_bf16 v[228:231], a[136:139], a[72:75], v[228:231]
ds_read_b64_tr_b16 a[130:131], v22 offset:2048
v_mfma_f32_16x16x32_bf16 v[228:231], a[140:143], a[76:79], v[228:231]
buffer_store_dwordx4 v[40:43], v1, s[4:7], s31 offen sc1
v_mfma_f32_16x16x32_bf16 v[232:235], a[136:139], a[80:83], v[232:235]
s_add_u32 s31, s31, s33
ds_read_b64_tr_b16 a[132:133], v22 offset:16384
v_mfma_f32_16x16x32_bf16 v[232:235], a[140:143], a[84:87], v[232:235]
buffer_load_dwordx4 v17, s[12:15], s26 offen offset:1024 lds
v_mfma_f32_16x16x32_bf16 v[236:239], a[136:139], a[88:91], v[236:239]
ds_read_b64_tr_b16 a[134:135], v22 offset:18432
v_add_u32 v22, 32768, v22
v_mfma_f32_16x16x32_bf16 v[236:239], a[140:143], a[92:95], v[236:239]
v_mfma_f32_16x16x32_bf16 v[240:243], a[136:139], a[96:99], v[240:243]
v_mfma_f32_16x16x32_bf16 v[240:243], a[140:143], a[100:103], v[240:243]
buffer_load_dwordx4 v18, s[12:15], s26 offen offset:2048 lds
v_mfma_f32_16x16x32_bf16 v[244:247], a[136:139], a[104:107], v[244:247]
v_mfma_f32_16x16x32_bf16 v[244:247], a[140:143], a[108:111], v[244:247]
v_mfma_f32_16x16x32_bf16 v[248:251], a[136:139], a[112:115], v[248:251]
v_mfma_f32_16x16x32_bf16 v[248:251], a[140:143], a[116:119], v[248:251]
buffer_load_dwordx4 v19, s[12:15], s26 offen offset:3072 lds
v_mfma_f32_16x16x32_bf16 v[252:255], a[136:139], a[120:123], v[252:255]
s_add_u32 s26, s26, 524288
v_mfma_f32_16x16x32_bf16 v[252:255], a[140:143], a[124:127], v[252:255]
s_waitcnt lgkmcnt(0)
v_mfma_f32_16x16x32_bf16 v[36:39], a[128:131], a[0:3], v[36:39]
s_add_u32 m0, s29, 147456
ds_read_b64_tr_b16 a[136:137], v23 offset:0
v_mfma_f32_16x16x32_bf16 v[36:39], a[132:135], a[4:7], v[36:39]
buffer_load_dwordx4 v16, s[12:15], s27 offen offset:0 lds
v_mfma_f32_16x16x32_bf16 v[44:47], a[128:131], a[8:11], v[44:47]
s_lshl_b32 s22, s20, 7
ds_read_b64_tr_b16 a[138:139], v23 offset:2048
v_bfe_u32 v20, v1, 4, 3
v_mfma_f32_16x16x32_bf16 v[44:47], a[132:135], a[12:15], v[44:47]
s_add_u32 s70, s22, 94371840
ds_read_b128 a[64:67], v2 offset:16384
ds_read_b128 a[68:71], v3 offset:16384
v_mfma_f32_16x16x32_bf16 v[52:55], a[128:131], a[16:19], v[52:55]
s_lshr_b32 s22, s2, 4
ds_read_b64_tr_b16 a[140:141], v23 offset:16384
v_lshlrev_b32 v20, 3, v20
v_mfma_f32_16x16x32_bf16 v[52:55], a[132:135], a[20:23], v[52:55]
s_lshl_b32 s22, s22, 2
buffer_load_dwordx4 v17, s[12:15], s27 offen offset:1024 lds
v_mfma_f32_16x16x32_bf16 v[60:63], a[128:131], a[24:27], v[60:63]
s_add_u32 s66, s70, s22
ds_read_b64_tr_b16 a[142:143], v23 offset:18432
v_add_u32 v23, 32768, v23
v_mfma_f32_16x16x32_bf16 v[60:63], a[132:135], a[28:31], v[60:63]
s_and_b32 s22, s2, 16
buffer_store_dwordx4 v[48:51], v1, s[4:7], s31 offen sc1
v_mfma_f32_16x16x32_bf16 v[68:71], a[128:131], a[32:35], v[68:71]
s_add_u32 s31, s31, s32
ds_read_b128 a[72:75], v2 offset:18432
v_add_u32 v15, 2052, v20
v_mfma_f32_16x16x32_bf16 v[68:71], a[132:135], a[36:39], v[68:71]
s_lshl_b32 s22, s22, 7
buffer_load_dwordx4 v18, s[12:15], s27 offen offset:2048 lds
v_mfma_f32_16x16x32_bf16 v[76:79], a[128:131], a[40:43], v[76:79]
s_add_u32 s66, s66, s22
ds_read_b128 a[76:79], v3 offset:18432
v_mfma_f32_16x16x32_bf16 v[76:79], a[132:135], a[44:47], v[76:79]
s_lshl_b32 s67, s20, 20
ds_read_b128 a[80:83], v2 offset:20480
v_mfma_f32_16x16x32_bf16 v[84:87], a[128:131], a[48:51], v[84:87]
s_lshl_b32 s22, s37, 16
ds_read_b128 a[84:87], v3 offset:20480
v_mfma_f32_16x16x32_bf16 v[84:87], a[132:135], a[52:55], v[84:87]
s_add_u32 s67, s67, s22
buffer_load_dwordx4 v19, s[12:15], s27 offen offset:3072 lds
v_mfma_f32_16x16x32_bf16 v[92:95], a[128:131], a[56:59], v[92:95]
s_waitcnt lgkmcnt(5)
s_add_u32 s27, s27, 524288
ds_read_b128 a[88:91], v2 offset:22528
v_mfma_f32_16x16x32_bf16 v[92:95], a[132:135], a[60:63], v[92:95]
s_lshl_b32 s22, s3, 11
buffer_store_dwordx4 v[56:59], v1, s[4:7], s31 offen sc1
v_mfma_f32_16x16x32_bf16 v[100:103], a[136:139], a[0:3], v[100:103]
s_waitcnt lgkmcnt(5)
s_add_u32 s31, s31, s34
ds_read_b64_tr_b16 a[128:129], v24 offset:0
v_mfma_f32_16x16x32_bf16 v[100:103], a[140:143], a[4:7], v[100:103]
s_add_u32 s67, s67, s22
v_mfma_f32_16x16x32_bf16 v[108:111], a[136:139], a[8:11], v[108:111]
s_add_u32 s67, s67, 33554432
ds_read_b64_tr_b16 a[130:131], v24 offset:2048
v_mfma_f32_16x16x32_bf16 v[108:111], a[140:143], a[12:15], v[108:111]
s_mov_b32 s68, 1035512379
ds_read_b128 a[92:95], v3 offset:22528
v_mfma_f32_16x16x32_bf16 v[116:119], a[136:139], a[16:19], v[116:119]
s_mov_b32 s69, 1035512379
ds_read_b64_tr_b16 a[132:133], v24 offset:16384
v_mfma_f32_16x16x32_bf16 v[116:119], a[140:143], a[20:23], v[116:119]
buffer_store_dwordx4 v[64:67], v1, s[4:7], s31 offen sc1
v_mfma_f32_16x16x32_bf16 v[124:127], a[136:139], a[24:27], v[124:127]
s_add_u32 s31, s31, s32
ds_read_b64_tr_b16 a[134:135], v24 offset:18432
v_add_u32 v24, 32768, v24
v_mfma_f32_16x16x32_bf16 v[124:127], a[140:143], a[28:31], v[124:127]
v_mfma_f32_16x16x32_bf16 v[132:135], a[136:139], a[32:35], v[132:135]
ds_read_b128 a[96:99], v2 offset:24576
v_mfma_f32_16x16x32_bf16 v[132:135], a[140:143], a[36:39], v[132:135]
v_mfma_f32_16x16x32_bf16 v[140:143], a[136:139], a[40:43], v[140:143]
ds_read_b128 a[100:103], v3 offset:24576
v_mfma_f32_16x16x32_bf16 v[140:143], a[140:143], a[44:47], v[140:143]
ds_read_b128 a[104:107], v2 offset:26624
v_mfma_f32_16x16x32_bf16 v[148:151], a[136:139], a[48:51], v[148:151]
ds_read_b128 a[108:111], v3 offset:26624
v_mfma_f32_16x16x32_bf16 v[148:151], a[140:143], a[52:55], v[148:151]
v_mfma_f32_16x16x32_bf16 v[156:159], a[136:139], a[56:59], v[156:159]
ds_read_b128 a[112:115], v2 offset:28672
v_mfma_f32_16x16x32_bf16 v[156:159], a[140:143], a[60:63], v[156:159]
s_waitcnt lgkmcnt(5)
buffer_store_dwordx4 v[72:75], v1, s[4:7], s31 offen sc1
v_mfma_f32_16x16x32_bf16 v[164:167], a[128:131], a[0:3], v[164:167]
s_add_u32 s31, s31, s33
ds_read_b64_tr_b16 a[136:137], v25 offset:0
v_mfma_f32_16x16x32_bf16 v[164:167], a[132:135], a[4:7], v[164:167]
v_mfma_f32_16x16x32_bf16 v[172:175], a[128:131], a[8:11], v[172:175]
ds_read_b64_tr_b16 a[138:139], v25 offset:2048
v_mfma_f32_16x16x32_bf16 v[172:175], a[132:135], a[12:15], v[172:175]
ds_read_b128 a[116:119], v3 offset:28672
v_mfma_f32_16x16x32_bf16 v[180:183], a[128:131], a[16:19], v[180:183]
ds_read_b64_tr_b16 a[140:141], v25 offset:16384
v_mfma_f32_16x16x32_bf16 v[180:183], a[132:135], a[20:23], v[180:183]
v_mfma_f32_16x16x32_bf16 v[188:191], a[128:131], a[24:27], v[188:191]
ds_read_b64_tr_b16 a[142:143], v25 offset:18432
v_add_u32 v25, 32768, v25
v_mfma_f32_16x16x32_bf16 v[188:191], a[132:135], a[28:31], v[188:191]
v_mfma_f32_16x16x32_bf16 v[196:199], a[128:131], a[32:35], v[196:199]
ds_read_b128 a[120:123], v2 offset:30720
v_mfma_f32_16x16x32_bf16 v[196:199], a[132:135], a[36:39], v[196:199]
buffer_store_dwordx4 v[80:83], v1, s[4:7], s31 offen sc1
v_mfma_f32_16x16x32_bf16 v[204:207], a[128:131], a[40:43], v[204:207]
s_add_u32 s31, s31, s32
ds_read_b128 a[124:127], v3 offset:30720
v_mfma_f32_16x16x32_bf16 v[204:207], a[132:135], a[44:47], v[204:207]
v_mfma_f32_16x16x32_bf16 v[212:215], a[128:131], a[48:51], v[212:215]
v_mfma_f32_16x16x32_bf16 v[212:215], a[132:135], a[52:55], v[212:215]
v_mfma_f32_16x16x32_bf16 v[220:223], a[128:131], a[56:59], v[220:223]
v_mfma_f32_16x16x32_bf16 v[220:223], a[132:135], a[60:63], v[220:223]
s_waitcnt vmcnt(17) lgkmcnt(0)
s_barrier
v_mfma_f32_16x16x32_bf16 v[224:227], a[136:139], a[0:3], v[224:227]
ds_read_b64_tr_b16 a[128:129], v22 offset:0
v_mfma_f32_16x16x32_bf16 v[224:227], a[140:143], a[4:7], v[224:227]
v_mfma_f32_16x16x32_bf16 v[228:231], a[136:139], a[8:11], v[228:231]
ds_read_b64_tr_b16 a[130:131], v22 offset:2048
v_mfma_f32_16x16x32_bf16 v[228:231], a[140:143], a[12:15], v[228:231]
buffer_store_dwordx4 v[88:91], v1, s[4:7], s31 offen sc1
v_mfma_f32_16x16x32_bf16 v[232:235], a[136:139], a[16:19], v[232:235]
ds_read_b64_tr_b16 a[132:133], v22 offset:16384
v_mfma_f32_16x16x32_bf16 v[232:235], a[140:143], a[20:23], v[232:235]
v_mfma_f32_16x16x32_bf16 v[236:239], a[136:139], a[24:27], v[236:239]
ds_read_b64_tr_b16 a[134:135], v22 offset:18432
v_add_u32 v22, 32768, v22
v_mfma_f32_16x16x32_bf16 v[236:239], a[140:143], a[28:31], v[236:239]
v_mfma_f32_16x16x32_bf16 v[240:243], a[136:139], a[32:35], v[240:243]
v_mfma_f32_16x16x32_bf16 v[240:243], a[140:143], a[36:39], v[240:243]
v_mfma_f32_16x16x32_bf16 v[244:247], a[136:139], a[40:43], v[244:247]
v_mfma_f32_16x16x32_bf16 v[244:247], a[140:143], a[44:47], v[244:247]
v_mfma_f32_16x16x32_bf16 v[248:251], a[136:139], a[48:51], v[248:251]
v_mfma_f32_16x16x32_bf16 v[248:251], a[140:143], a[52:55], v[248:251]
v_mfma_f32_16x16x32_bf16 v[252:255], a[136:139], a[56:59], v[252:255]
v_mfma_f32_16x16x32_bf16 v[252:255], a[140:143], a[60:63], v[252:255]
s_waitcnt lgkmcnt(0)
v_mfma_f32_16x16x32_bf16 v[36:39], a[128:131], a[64:67], v[36:39]
ds_read_b64_tr_b16 a[136:137], v23 offset:0
v_and_b32 v14, 128, v1
v_mfma_f32_16x16x32_bf16 v[36:39], a[132:135], a[68:71], v[36:39]
v_mul_u32_u24 v14, 2, v14
v_add_u32 v20, v14, v20
v_mfma_f32_16x16x32_bf16 v[44:47], a[128:131], a[72:75], v[44:47]
s_mul_i32 s85, s20, 7
ds_read_b64_tr_b16 a[138:139], v23 offset:2048
v_add_u32 v15, v14, v15
v_mfma_f32_16x16x32_bf16 v[44:47], a[132:135], a[76:79], v[44:47]
s_add_u32 s85, s85, s21
ds_read_b128 a[0:3], v2 offset:32768
ds_read_b128 a[4:7], v3 offset:32768
v_mfma_f32_16x16x32_bf16 v[52:55], a[128:131], a[80:83], v[52:55]
s_lshl_b32 s85, s85, 2
ds_read_b64_tr_b16 a[140:141], v23 offset:16384
v_mfma_f32_16x16x32_bf16 v[52:55], a[132:135], a[84:87], v[52:55]
s_add_u32 s85, s85, s3
v_mfma_f32_16x16x32_bf16 v[60:63], a[128:131], a[88:91], v[60:63]
s_mul_i32 s82, s85, 4224
ds_read_b64_tr_b16 a[142:143], v23 offset:18432
v_add_u32 v23, 32768, v23
v_mfma_f32_16x16x32_bf16 v[60:63], a[132:135], a[92:95], v[60:63]
s_add_u32 s82, s82, 83886208
v_mfma_f32_16x16x32_bf16 v[68:71], a[128:131], a[96:99], v[68:71]
s_lshl_b32 s83, s85, 12
ds_read_b128 a[8:11], v2 offset:34816
v_mfma_f32_16x16x32_bf16 v[68:71], a[132:135], a[100:103], v[68:71]
s_mul_i32 s84, s3, 21248
v_mfma_f32_16x16x32_bf16 v[76:79], a[128:131], a[104:107], v[76:79]
s_add_u32 s84, s84, 46080
ds_read_b128 a[12:15], v3 offset:34816
v_mfma_f32_16x16x32_bf16 v[76:79], a[132:135], a[108:111], v[76:79]
s_mov_b64 s[60:61], s[72:73]
ds_read_b128 a[16:19], v2 offset:36864
v_mfma_f32_16x16x32_bf16 v[84:87], a[128:131], a[112:115], v[84:87]
s_mov_b32 s62, 1835008
ds_read_b128 a[20:23], v3 offset:36864
v_mfma_f32_16x16x32_bf16 v[84:87], a[132:135], a[116:119], v[84:87]
v_mfma_f32_16x16x32_bf16 v[92:95], a[128:131], a[120:123], v[92:95]
ds_read_b128 a[24:27], v2 offset:38912
v_mfma_f32_16x16x32_bf16 v[92:95], a[132:135], a[124:127], v[92:95]
s_waitcnt lgkmcnt(5)
v_mfma_f32_16x16x32_bf16 v[100:103], a[136:139], a[64:67], v[100:103]
ds_read_b64_tr_b16 a[128:129], v24 offset:0
v_mfma_f32_16x16x32_bf16 v[100:103], a[140:143], a[68:71], v[100:103]
v_mfma_f32_16x16x32_bf16 v[108:111], a[136:139], a[72:75], v[108:111]
ds_read_b64_tr_b16 a[130:131], v24 offset:2048
v_mfma_f32_16x16x32_bf16 v[108:111], a[140:143], a[76:79], v[108:111]
ds_read_b128 a[28:31], v3 offset:38912
v_mfma_f32_16x16x32_bf16 v[116:119], a[136:139], a[80:83], v[116:119]
ds_read_b64_tr_b16 a[132:133], v24 offset:16384
v_mfma_f32_16x16x32_bf16 v[116:119], a[140:143], a[84:87], v[116:119]
v_mfma_f32_16x16x32_bf16 v[124:127], a[136:139], a[88:91], v[124:127]
ds_read_b64_tr_b16 a[134:135], v24 offset:18432
v_add_u32 v24, 32768, v24
v_mfma_f32_16x16x32_bf16 v[124:127], a[140:143], a[92:95], v[124:127]
v_mfma_f32_16x16x32_bf16 v[132:135], a[136:139], a[96:99], v[132:135]
ds_read_b128 a[32:35], v2 offset:40960
v_mfma_f32_16x16x32_bf16 v[132:135], a[140:143], a[100:103], v[132:135]
v_mfma_f32_16x16x32_bf16 v[140:143], a[136:139], a[104:107], v[140:143]
ds_read_b128 a[36:39], v3 offset:40960
v_mfma_f32_16x16x32_bf16 v[140:143], a[140:143], a[108:111], v[140:143]
ds_read_b128 a[40:43], v2 offset:43008
v_mfma_f32_16x16x32_bf16 v[148:151], a[136:139], a[112:115], v[148:151]
ds_read_b128 a[44:47], v3 offset:43008
v_mfma_f32_16x16x32_bf16 v[148:151], a[140:143], a[116:119], v[148:151]
v_mfma_f32_16x16x32_bf16 v[156:159], a[136:139], a[120:123], v[156:159]
s_andn2_b32 s31, s70, 256
ds_read_b128 a[48:51], v2 offset:45056
v_mfma_f32_16x16x32_bf16 v[156:159], a[140:143], a[124:127], v[156:159]
s_waitcnt lgkmcnt(5)
v_mfma_f32_16x16x32_bf16 v[164:167], a[128:131], a[64:67], v[164:167]
ds_read_b64_tr_b16 a[136:137], v25 offset:0
v_mfma_f32_16x16x32_bf16 v[164:167], a[132:135], a[68:71], v[164:167]
v_mfma_f32_16x16x32_bf16 v[172:175], a[128:131], a[72:75], v[172:175]
ds_read_b64_tr_b16 a[138:139], v25 offset:2048
v_mfma_f32_16x16x32_bf16 v[172:175], a[132:135], a[76:79], v[172:175]
ds_read_b128 a[52:55], v3 offset:45056
v_mfma_f32_16x16x32_bf16 v[180:183], a[128:131], a[80:83], v[180:183]
ds_read_b64_tr_b16 a[140:141], v25 offset:16384
v_mfma_f32_16x16x32_bf16 v[180:183], a[132:135], a[84:87], v[180:183]
v_mfma_f32_16x16x32_bf16 v[188:191], a[128:131], a[88:91], v[188:191]
ds_read_b64_tr_b16 a[142:143], v25 offset:18432
v_add_u32 v25, 32768, v25
v_mfma_f32_16x16x32_bf16 v[188:191], a[132:135], a[92:95], v[188:191]
v_mfma_f32_16x16x32_bf16 v[196:199], a[128:131], a[96:99], v[196:199]
ds_read_b128 a[56:59], v2 offset:47104
v_mfma_f32_16x16x32_bf16 v[196:199], a[132:135], a[100:103], v[196:199]
v_mfma_f32_16x16x32_bf16 v[204:207], a[128:131], a[104:107], v[204:207]
ds_read_b128 a[60:63], v3 offset:47104
v_mfma_f32_16x16x32_bf16 v[204:207], a[132:135], a[108:111], v[204:207]
v_mfma_f32_16x16x32_bf16 v[212:215], a[128:131], a[112:115], v[212:215]
v_mfma_f32_16x16x32_bf16 v[212:215], a[132:135], a[116:119], v[212:215]
v_mfma_f32_16x16x32_bf16 v[220:223], a[128:131], a[120:123], v[220:223]
v_mfma_f32_16x16x32_bf16 v[220:223], a[132:135], a[124:127], v[220:223]
s_waitcnt vmcnt(0) lgkmcnt(0)
s_barrier
v_mfma_f32_16x16x32_bf16 v[224:227], a[136:139], a[64:67], v[224:227]
ds_read_b64_tr_b16 a[128:129], v22 offset:0
v_mfma_f32_16x16x32_bf16 v[224:227], a[140:143], a[68:71], v[224:227]
buffer_store_dword v27, v26, s[4:7], s66 offen sc1
v_mfma_f32_16x16x32_bf16 v[228:231], a[136:139], a[72:75], v[228:231]
ds_read_b64_tr_b16 a[130:131], v22 offset:2048
v_mfma_f32_16x16x32_bf16 v[228:231], a[140:143], a[76:79], v[228:231]
v_mfma_f32_16x16x32_bf16 v[232:235], a[136:139], a[80:83], v[232:235]
ds_read_b64_tr_b16 a[132:133], v22 offset:16384
v_mfma_f32_16x16x32_bf16 v[232:235], a[140:143], a[84:87], v[232:235]
v_mfma_f32_16x16x32_bf16 v[236:239], a[136:139], a[88:91], v[236:239]
ds_read_b64_tr_b16 a[134:135], v22 offset:18432
v_mfma_f32_16x16x32_bf16 v[236:239], a[140:143], a[92:95], v[236:239]
v_mfma_f32_16x16x32_bf16 v[240:243], a[136:139], a[96:99], v[240:243]
PAD_29:
s_cbranch_execz M_tret
v_mfma_f32_16x16x32_bf16 v[240:243], a[140:143], a[100:103], v[240:243]
v_mfma_f32_16x16x32_bf16 v[244:247], a[136:139], a[104:107], v[244:247]
v_mfma_f32_16x16x32_bf16 v[244:247], a[140:143], a[108:111], v[244:247]
v_mfma_f32_16x16x32_bf16 v[248:251], a[136:139], a[112:115], v[248:251]
v_mfma_f32_16x16x32_bf16 v[248:251], a[140:143], a[116:119], v[248:251]
v_mfma_f32_16x16x32_bf16 v[252:255], a[136:139], a[120:123], v[252:255]
v_mfma_f32_16x16x32_bf16 v[252:255], a[140:143], a[124:127], v[252:255]
s_waitcnt lgkmcnt(0)
v_mfma_f32_16x16x32_bf16 v[36:39], a[128:131], a[0:3], v[36:39]
s_add_u32 m0, s84, 17152
ds_read_b64_tr_b16 a[136:137], v23 offset:0
v_lshrrev_b32 v9, 4, v1
v_mfma_f32_16x16x32_bf16 v[36:39], a[132:135], a[4:7], v[36:39]
buffer_load_dwordx4 v1, s[60:63], s83 offen offset:0 lds
v_mfma_f32_16x16x32_bf16 v[44:47], a[128:131], a[8:11], v[44:47]
ds_read_b64_tr_b16 a[138:139], v23 offset:2048
v_and_b32 v10, 15, v9
v_mfma_f32_16x16x32_bf16 v[44:47], a[132:135], a[12:15], v[44:47]
buffer_load_dwordx4 v1, s[60:63], s83 offen offset:1024 lds
v_mfma_f32_16x16x32_bf16 v[52:55], a[128:131], a[16:19], v[52:55]
ds_read_b64_tr_b16 a[140:141], v23 offset:16384
v_lshrrev_b32 v11, 4, v9
v_mfma_f32_16x16x32_bf16 v[52:55], a[132:135], a[20:23], v[52:55]
buffer_load_dwordx4 v1, s[60:63], s83 offen offset:2048 lds
v_mfma_f32_16x16x32_bf16 v[60:63], a[128:131], a[24:27], v[60:63]
ds_read_b64_tr_b16 a[142:143], v23 offset:18432
v_lshrrev_b32 v12, 2, v10
v_mfma_f32_16x16x32_bf16 v[60:63], a[132:135], a[28:31], v[60:63]
buffer_load_dwordx4 v1, s[60:63], s83 offen offset:3072 lds
v_mfma_f32_16x16x32_bf16 v[68:71], a[128:131], a[32:35], v[68:71]
s_add_u32 m0, s84, 64
v_mul_u32_u24 v12, 4160, v12
v_and_b32 v13, 3, v9
v_mfma_f32_16x16x32_bf16 v[68:71], a[132:135], a[36:39], v[68:71]
buffer_load_dwordx4 v1, s[4:7], s82 offen offset:0 sc1 lds
v_mfma_f32_16x16x32_bf16 v[76:79], a[128:131], a[40:43], v[76:79]
buffer_load_dwordx4 v1, s[4:7], s82 offen offset:1024 sc1 lds
v_mfma_f32_16x16x32_bf16 v[76:79], a[132:135], a[44:47], v[76:79]
buffer_load_dwordx4 v1, s[4:7], s82 offen offset:2048 sc1 lds
v_mfma_f32_16x16x32_bf16 v[84:87], a[128:131], a[48:51], v[84:87]
buffer_load_dwordx4 v1, s[4:7], s82 offen offset:3072 sc1 lds
v_mfma_f32_16x16x32_bf16 v[84:87], a[132:135], a[52:55], v[84:87]
s_add_u32 s82, s82, 2097152
v_lshl_add_u32 v12, v13, 3, v12
v_lshlrev_b32 v13, 4, v11
v_mfma_f32_16x16x32_bf16 v[92:95], a[128:131], a[56:59], v[92:95]
s_add_u32 m0, s84, 4224
v_sub_u32 v12, v12, v13
v_add_u32 v12, 88, v12
v_mfma_f32_16x16x32_bf16 v[92:95], a[132:135], a[60:63], v[92:95]
s_waitcnt lgkmcnt(0)
buffer_load_dwordx4 v1, s[4:7], s82 offen offset:0 sc1 lds
v_mfma_f32_16x16x32_bf16 v[100:103], a[136:139], a[0:3], v[100:103]
ds_read_b64_tr_b16 a[128:129], v24 offset:0
v_add_u32 v16, s84, v12
v_mfma_f32_16x16x32_bf16 v[100:103], a[140:143], a[4:7], v[100:103]
buffer_load_dwordx4 v1, s[4:7], s82 offen offset:1024 sc1 lds
v_mfma_f32_16x16x32_bf16 v[108:111], a[136:139], a[8:11], v[108:111]
ds_read_b64_tr_b16 a[130:131], v24 offset:2048
v_lshl_add_u32 v12, v10, 5, v13
v_mfma_f32_16x16x32_bf16 v[108:111], a[140:143], a[12:15], v[108:111]
buffer_load_dwordx4 v1, s[4:7], s82 offen offset:2048 sc1 lds
v_mfma_f32_16x16x32_bf16 v[116:119], a[136:139], a[16:19], v[116:119]
ds_read_b64_tr_b16 a[132:133], v24 offset:16384
v_add_u32 v12, 16672, v12
v_mfma_f32_16x16x32_bf16 v[116:119], a[140:143], a[20:23], v[116:119]
buffer_load_dwordx4 v1, s[4:7], s82 offen offset:3072 sc1 lds
v_mfma_f32_16x16x32_bf16 v[124:127], a[136:139], a[24:27], v[124:127]
s_add_u32 s82, s82, 4292870140
ds_read_b64_tr_b16 a[134:135], v24 offset:18432
v_add_u32 v17, s84, v12
v_mfma_f32_16x16x32_bf16 v[124:127], a[140:143], a[28:31], v[124:127]
s_add_u32 m0, s84, 8384
v_lshlrev_b32 v12, 5, v10
v_lshl_add_u32 v8, v11, 3, v12
v_mfma_f32_16x16x32_bf16 v[132:135], a[136:139], a[32:35], v[132:135]
buffer_load_dwordx4 v1, s[4:7], s82 offen offset:0 sc1 lds
v_mfma_f32_16x16x32_bf16 v[132:135], a[140:143], a[36:39], v[132:135]
buffer_load_dwordx4 v1, s[4:7], s82 offen offset:1024 sc1 lds
v_mfma_f32_16x16x32_bf16 v[140:143], a[136:139], a[40:43], v[140:143]
buffer_load_dwordx4 v1, s[4:7], s82 offen offset:2048 sc1 lds
v_mfma_f32_16x16x32_bf16 v[140:143], a[140:143], a[44:47], v[140:143]
buffer_load_dwordx4 v1, s[4:7], s82 offen offset:3072 sc1 lds
v_mfma_f32_16x16x32_bf16 v[148:151], a[136:139], a[48:51], v[148:151]
s_add_u32 s82, s82, 2097152
v_add3_u32 v18, s84, 64, v8
v_mov_b32 v19, 0
v_mfma_f32_16x16x32_bf16 v[148:151], a[140:143], a[52:55], v[148:151]
s_add_u32 m0, s84, 12544
v_mov_b32 v12, 0
v_mov_b32 v13, 0
v_mfma_f32_16x16x32_bf16 v[156:159], a[136:139], a[56:59], v[156:159]
buffer_load_dwordx4 v1, s[4:7], s82 offen offset:0 sc1 lds
v_mfma_f32_16x16x32_bf16 v[156:159], a[140:143], a[60:63], v[156:159]
s_waitcnt lgkmcnt(0)
buffer_load_dwordx4 v1, s[4:7], s82 offen offset:1024 sc1 lds
v_mfma_f32_16x16x32_bf16 v[164:167], a[128:131], a[0:3], v[164:167]
ds_read_b64_tr_b16 a[136:137], v25 offset:0
v_lshl_add_u32 v14, v9, 3, s84
v_mfma_f32_16x16x32_bf16 v[164:167], a[132:135], a[4:7], v[164:167]
buffer_load_dwordx4 v1, s[4:7], s82 offen offset:2048 sc1 lds
v_mfma_f32_16x16x32_bf16 v[172:175], a[128:131], a[8:11], v[172:175]
ds_read_b64_tr_b16 a[138:139], v25 offset:2048
v_mfma_f32_16x16x32_bf16 v[172:175], a[132:135], a[12:15], v[172:175]
buffer_load_dwordx4 v1, s[4:7], s82 offen offset:3072 sc1 lds
v_mfma_f32_16x16x32_bf16 v[180:183], a[128:131], a[16:19], v[180:183]
ds_read_b64_tr_b16 a[140:141], v25 offset:16384
v_mfma_f32_16x16x32_bf16 v[180:183], a[132:135], a[20:23], v[180:183]
ds_write_b64 v14, v[12:13] offset:16640
v_mul_u32_u24 v14, 4160, v11
v_mfma_f32_16x16x32_bf16 v[188:191], a[128:131], a[24:27], v[188:191]
ds_read_b64_tr_b16 a[142:143], v25 offset:18432
v_lshl_add_u32 v14, v10, 2, v14
v_mfma_f32_16x16x32_bf16 v[188:191], a[132:135], a[28:31], v[188:191]
v_add_u32 v14, s84, v14
v_mfma_f32_16x16x32_bf16 v[196:199], a[128:131], a[32:35], v[196:199]
ds_write_b32 v14, v12
v_lshrrev_b32 v30, 6, v0
v_mfma_f32_16x16x32_bf16 v[196:199], a[132:135], a[36:39], v[196:199]
v_lshl_add_u32 v28, v30, 11, v1
v_add_u32 v29, 0x20000, v28
v_mfma_f32_16x16x32_bf16 v[204:207], a[128:131], a[40:43], v[204:207]
v_lshl_add_u32 v30, v30, 13, v1
v_add_u32 v31, 0x20000, v30
v_mfma_f32_16x16x32_bf16 v[204:207], a[132:135], a[44:47], v[204:207]
v_mul_f32 v36, s68, v36
v_mul_f32 v37, s68, v37
v_mfma_f32_16x16x32_bf16 v[212:215], a[128:131], a[48:51], v[212:215]
v_mul_f32 v38, s68, v38
v_mul_f32 v39, s68, v39
v_mfma_f32_16x16x32_bf16 v[212:215], a[132:135], a[52:55], v[212:215]
v_mul_f32 v100, s68, v100
v_mul_f32 v101, s68, v101
v_mfma_f32_16x16x32_bf16 v[220:223], a[128:131], a[56:59], v[220:223]
v_mul_f32 v102, s68, v102
v_mul_f32 v103, s68, v103
v_mfma_f32_16x16x32_bf16 v[220:223], a[132:135], a[60:63], v[220:223]
s_waitcnt lgkmcnt(0)
s_waitcnt lgkmcnt(0)
s_barrier
v_mfma_f32_16x16x32_bf16 v[224:227], a[136:139], a[0:3], v[224:227]
v_cvt_pk_bf16_f32 v36, v36, v37
v_cvt_pk_bf16_f32 v37, v38, v39
v_mfma_f32_16x16x32_bf16 v[224:227], a[140:143], a[4:7], v[224:227]
v_cvt_pk_bf16_f32 v38, v100, v101
v_cvt_pk_bf16_f32 v39, v102, v103
v_mfma_f32_16x16x32_bf16 v[228:231], a[136:139], a[8:11], v[228:231]
v_mul_f32 v44, s68, v44
v_mul_f32 v45, s68, v45
v_mfma_f32_16x16x32_bf16 v[228:231], a[140:143], a[12:15], v[228:231]
v_mul_f32 v46, s68, v46
v_mul_f32 v47, s68, v47
v_mfma_f32_16x16x32_bf16 v[232:235], a[136:139], a[16:19], v[232:235]
v_mul_f32 v108, s68, v108
v_mul_f32 v109, s68, v109
v_mfma_f32_16x16x32_bf16 v[232:235], a[140:143], a[20:23], v[232:235]
v_mul_f32 v110, s68, v110
v_mul_f32 v111, s68, v111
v_mfma_f32_16x16x32_bf16 v[236:239], a[136:139], a[24:27], v[236:239]
v_cvt_pk_bf16_f32 v44, v44, v45
v_cvt_pk_bf16_f32 v45, v46, v47
v_mfma_f32_16x16x32_bf16 v[236:239], a[140:143], a[28:31], v[236:239]
v_cvt_pk_bf16_f32 v46, v108, v109
v_cvt_pk_bf16_f32 v47, v110, v111
v_mfma_f32_16x16x32_bf16 v[240:243], a[136:139], a[32:35], v[240:243]
v_mul_f32 v52, s68, v52
v_mul_f32 v53, s68, v53
v_mfma_f32_16x16x32_bf16 v[240:243], a[140:143], a[36:39], v[240:243]
v_mul_f32 v54, s68, v54
v_mul_f32 v55, s68, v55
v_mfma_f32_16x16x32_bf16 v[244:247], a[136:139], a[40:43], v[244:247]
v_mul_f32 v116, s68, v116
v_mul_f32 v117, s68, v117
v_mfma_f32_16x16x32_bf16 v[244:247], a[140:143], a[44:47], v[244:247]
v_mul_f32 v118, s68, v118
v_mul_f32 v119, s68, v119
v_mfma_f32_16x16x32_bf16 v[248:251], a[136:139], a[48:51], v[248:251]
v_cvt_pk_bf16_f32 v52, v52, v53
v_cvt_pk_bf16_f32 v53, v54, v55
v_mfma_f32_16x16x32_bf16 v[248:251], a[140:143], a[52:55], v[248:251]
v_cvt_pk_bf16_f32 v54, v116, v117
v_cvt_pk_bf16_f32 v55, v118, v119
v_mfma_f32_16x16x32_bf16 v[252:255], a[136:139], a[56:59], v[252:255]
v_mfma_f32_16x16x32_bf16 v[252:255], a[140:143], a[60:63], v[252:255]
s_mov_b64 s[60:61], s[74:75]
s_mov_b32 s62, 896
s_lshl_b32 s79, s85, 1
buffer_load_short_d16_hi v19, off, s[60:63], s79
s_lshl_b32 s83, s85, 12
s_add_u32 s83, s83, 88080384
ds_write_b128 v28, v[36:39] offset:0
ds_write_b128 v28, v[44:47] offset:8192
ds_write_b128 v28, v[52:55] offset:16384
v_pk_mul_f32 v[60:61], v[60:61], s[68:69]
v_pk_mul_f32 v[62:63], v[62:63], s[68:69]
v_pk_mul_f32 v[124:125], v[124:125], s[68:69]
v_pk_mul_f32 v[126:127], v[126:127], s[68:69]
v_cvt_pk_bf16_f32 v60, v60, v61
v_cvt_pk_bf16_f32 v61, v62, v63
v_cvt_pk_bf16_f32 v62, v124, v125
v_cvt_pk_bf16_f32 v63, v126, v127
ds_write_b128 v28, v[60:63] offset:24576
v_pk_mul_f32 v[68:69], v[68:69], s[68:69]
v_pk_mul_f32 v[70:71], v[70:71], s[68:69]
v_pk_mul_f32 v[132:133], v[132:133], s[68:69]
v_pk_mul_f32 v[134:135], v[134:135], s[68:69]
v_cvt_pk_bf16_f32 v68, v68, v69
v_cvt_pk_bf16_f32 v69, v70, v71
v_cvt_pk_bf16_f32 v70, v132, v133
v_cvt_pk_bf16_f32 v71, v134, v135
ds_write_b128 v29, v[68:71] offset:0
v_pk_mul_f32 v[76:77], v[76:77], s[68:69]
v_pk_mul_f32 v[78:79], v[78:79], s[68:69]
v_pk_mul_f32 v[140:141], v[140:141], s[68:69]
v_pk_mul_f32 v[142:143], v[142:143], s[68:69]
v_cvt_pk_bf16_f32 v76, v76, v77
v_cvt_pk_bf16_f32 v77, v78, v79
v_cvt_pk_bf16_f32 v78, v140, v141
v_cvt_pk_bf16_f32 v79, v142, v143
ds_write_b128 v29, v[76:79] offset:8192
v_pk_mul_f32 v[84:85], v[84:85], s[68:69]
v_pk_mul_f32 v[86:87], v[86:87], s[68:69]
v_pk_mul_f32 v[148:149], v[148:149], s[68:69]
v_pk_mul_f32 v[150:151], v[150:151], s[68:69]
v_cvt_pk_bf16_f32 v84, v84, v85
v_cvt_pk_bf16_f32 v85, v86, v87
v_cvt_pk_bf16_f32 v86, v148, v149
v_cvt_pk_bf16_f32 v87, v150, v151
ds_write_b128 v29, v[84:87] offset:16384
v_pk_mul_f32 v[92:93], v[92:93], s[68:69]
v_pk_mul_f32 v[94:95], v[94:95], s[68:69]
v_pk_mul_f32 v[156:157], v[156:157], s[68:69]
v_pk_mul_f32 v[158:159], v[158:159], s[68:69]
v_cvt_pk_bf16_f32 v92, v92, v93
v_cvt_pk_bf16_f32 v93, v94, v95
v_cvt_pk_bf16_f32 v94, v156, v157
v_cvt_pk_bf16_f32 v95, v158, v159
ds_write_b128 v29, v[92:95] offset:24576
v_pk_mul_f32 v[164:165], v[164:165], s[68:69]
v_pk_mul_f32 v[166:167], v[166:167], s[68:69]
v_pk_mul_f32 v[224:225], v[224:225], s[68:69]
v_pk_mul_f32 v[226:227], v[226:227], s[68:69]
v_cvt_pk_bf16_f32 v164, v164, v165
v_cvt_pk_bf16_f32 v165, v166, v167
v_cvt_pk_bf16_f32 v166, v224, v225
v_cvt_pk_bf16_f32 v167, v226, v227
ds_write_b128 v28, v[164:167] offset:1024
v_pk_mul_f32 v[172:173], v[172:173], s[68:69]
v_pk_mul_f32 v[174:175], v[174:175], s[68:69]
v_pk_mul_f32 v[228:229], v[228:229], s[68:69]
v_pk_mul_f32 v[230:231], v[230:231], s[68:69]
v_cvt_pk_bf16_f32 v172, v172, v173
v_cvt_pk_bf16_f32 v173, v174, v175
v_cvt_pk_bf16_f32 v174, v228, v229
v_cvt_pk_bf16_f32 v175, v230, v231
ds_write_b128 v28, v[172:175] offset:9216
v_pk_mul_f32 v[180:181], v[180:181], s[68:69]
v_pk_mul_f32 v[182:183], v[182:183], s[68:69]
v_pk_mul_f32 v[232:233], v[232:233], s[68:69]
v_pk_mul_f32 v[234:235], v[234:235], s[68:69]
v_cvt_pk_bf16_f32 v180, v180, v181
v_cvt_pk_bf16_f32 v181, v182, v183
v_cvt_pk_bf16_f32 v182, v232, v233
v_cvt_pk_bf16_f32 v183, v234, v235
ds_write_b128 v28, v[180:183] offset:17408
v_pk_mul_f32 v[188:189], v[188:189], s[68:69]
v_pk_mul_f32 v[190:191], v[190:191], s[68:69]
v_pk_mul_f32 v[236:237], v[236:237], s[68:69]
v_pk_mul_f32 v[238:239], v[238:239], s[68:69]
v_cvt_pk_bf16_f32 v188, v188, v189
v_cvt_pk_bf16_f32 v189, v190, v191
v_cvt_pk_bf16_f32 v190, v236, v237
v_cvt_pk_bf16_f32 v191, v238, v239
ds_write_b128 v28, v[188:191] offset:25600
v_pk_mul_f32 v[196:197], v[196:197], s[68:69]
v_pk_mul_f32 v[198:199], v[198:199], s[68:69]
v_pk_mul_f32 v[240:241], v[240:241], s[68:69]
v_pk_mul_f32 v[242:243], v[242:243], s[68:69]
v_cvt_pk_bf16_f32 v196, v196, v197
v_cvt_pk_bf16_f32 v197, v198, v199
v_cvt_pk_bf16_f32 v198, v240, v241
v_cvt_pk_bf16_f32 v199, v242, v243
ds_write_b128 v29, v[196:199] offset:1024
v_pk_mul_f32 v[204:205], v[204:205], s[68:69]
v_pk_mul_f32 v[206:207], v[206:207], s[68:69]
v_pk_mul_f32 v[244:245], v[244:245], s[68:69]
v_pk_mul_f32 v[246:247], v[246:247], s[68:69]
v_cvt_pk_bf16_f32 v204, v204, v205
v_cvt_pk_bf16_f32 v205, v206, v207
v_cvt_pk_bf16_f32 v206, v244, v245
v_cvt_pk_bf16_f32 v207, v246, v247
ds_write_b128 v29, v[204:207] offset:9216
v_pk_mul_f32 v[212:213], v[212:213], s[68:69]
v_pk_mul_f32 v[214:215], v[214:215], s[68:69]
v_pk_mul_f32 v[248:249], v[248:249], s[68:69]
v_pk_mul_f32 v[250:251], v[250:251], s[68:69]
v_cvt_pk_bf16_f32 v212, v212, v213
v_cvt_pk_bf16_f32 v213, v214, v215
v_cvt_pk_bf16_f32 v214, v248, v249
v_cvt_pk_bf16_f32 v215, v250, v251
ds_write_b128 v29, v[212:215] offset:17408
v_pk_mul_f32 v[220:221], v[220:221], s[68:69]
v_pk_mul_f32 v[222:223], v[222:223], s[68:69]
v_pk_mul_f32 v[252:253], v[252:253], s[68:69]
v_pk_mul_f32 v[254:255], v[254:255], s[68:69]
v_cvt_pk_bf16_f32 v220, v220, v221
v_cvt_pk_bf16_f32 v221, v222, v223
v_cvt_pk_bf16_f32 v222, v252, v253
v_cvt_pk_bf16_f32 v223, v254, v255
ds_write_b128 v29, v[220:223] offset:25600
s_waitcnt vmcnt(1) lgkmcnt(0)
s_barrier
buffer_load_dword v21, v20, s[4:7], s31 offen sc1
ds_read_b64_tr_b16 a[64:65], v16 offset:8
ds_read_b64_tr_b16 a[66:67], v16 offset:0
ds_read_b128 a[96:99], v17 offset:448
ds_read_b64_tr_b16 a[68:69], v16 offset:520
ds_read_b64_tr_b16 a[70:71], v16 offset:512
ds_read_b128 a[100:103], v17 offset:960
ds_read_b64_tr_b16 a[72:73], v16 offset:1032
ds_read_b64_tr_b16 a[74:75], v16 offset:1024
ds_read_b128 a[104:107], v17 offset:1472
ds_read_b64_tr_b16 a[76:77], v16 offset:1544
ds_read_b64_tr_b16 a[78:79], v16 offset:1536
ds_read_b128 a[108:111], v17 offset:1984
ds_read_b64_tr_b16 a[80:81], v16 offset:2056
ds_read_b64_tr_b16 a[82:83], v16 offset:2048
ds_read_b128 a[112:115], v17 offset:2496
ds_read_b64_tr_b16 a[84:85], v16 offset:2568
ds_read_b64_tr_b16 a[86:87], v16 offset:2560
ds_read_b128 a[116:119], v17 offset:3008
ds_read_b64_tr_b16 a[88:89], v16 offset:3080
ds_read_b64_tr_b16 a[90:91], v16 offset:3072
ds_read_b128 a[120:123], v17 offset:3520
ds_read_b64_tr_b16 a[92:93], v16 offset:3592
ds_read_b64_tr_b16 a[94:95], v16 offset:3584
ds_read_b128 a[124:127], v17 offset:4032
s_waitcnt lgkmcnt(15)
v_mfma_f32_16x16x32_bf16 v[96:99], a[64:67], a[96:99], 0
s_waitcnt lgkmcnt(12)
s_lshl_b32 s18, s3, 13
ds_read_b64_tr_b16 a[128:129], v16 offset:72
v_mov_b32 v24, 0
v_mfma_f32_16x16x32_bf16 v[100:103], a[64:67], a[100:103], 0
s_lshl_b32 s30, s20, 20
ds_read_b64_tr_b16 a[130:131], v16 offset:64
v_lshrrev_b32 v3, 6, v0
v_mfma_f32_16x16x32_bf16 v[100:103], a[68:71], a[96:99], v[100:103]
s_add_u32 s30, s30, s18
ds_read_b128 a[160:163], v17 offset:384
v_and_b32 v4, 63, v0
v_mfma_f32_16x16x32_bf16 v[104:107], a[64:67], a[104:107], 0
s_lshl_b32 s22, s21, 1
ds_read_b128 a[192:195], v30 offset:0
v_add_u32 v2, 0x10000, v1
v_mfma_f32_16x16x32_bf16 v[104:107], a[68:71], a[100:103], v[104:107]
s_and_b32 s84, s2, 1
ds_read_b64_tr_b16 a[132:133], v16 offset:584
v_and_b32 v5, 15, v4
v_mfma_f32_16x16x32_bf16 v[104:107], a[72:75], a[96:99], v[104:107]
s_mul_i32 s84, s84, 0
ds_read_b64_tr_b16 a[134:135], v16 offset:576
v_lshrrev_b32 v6, 4, v4
v_mfma_f32_16x16x32_bf16 v[108:111], a[64:67], a[108:111], 0
s_add_u32 s84, s84, 2386092
ds_read_b128 a[164:167], v17 offset:896
v_lshlrev_b32 v6, 2, v6
v_mfma_f32_16x16x32_bf16 v[108:111], a[68:71], a[104:107], v[108:111]
s_lshl_b32 s85, s21, 2
ds_read_b128 a[196:199], v30 offset:1024
v_sub_u32 v5, v5, v6
v_mfma_f32_16x16x32_bf16 v[108:111], a[72:75], a[100:103], v[108:111]
s_lshr_b32 s85, s84, s85
ds_read_b64_tr_b16 a[136:137], v16 offset:1096
v_lshl_add_u32 v5, v3, 4, v5
v_mfma_f32_16x16x32_bf16 v[108:111], a[76:79], a[96:99], v[108:111]
s_waitcnt lgkmcnt(8)
s_and_b32 s9, s85, 15
ds_read_b64_tr_b16 a[138:139], v16 offset:1088
v_cmp_gt_i32 s[32:33], 0, v5
v_mfma_f32_16x16x32_bf16 v[112:115], a[64:67], a[112:115], 0
s_and_b32 s84, s85, 1
ds_read_b128 a[168:171], v17 offset:1408
v_cmp_gt_i32 s[34:35], 1, v5
v_mfma_f32_16x16x32_bf16 v[112:115], a[68:71], a[108:111], v[112:115]
s_lshl_b32 s84, s84, 17
ds_read_b128 a[200:203], v30 offset:2048
v_cmp_gt_i32 s[36:37], 2, v5
v_mfma_f32_16x16x32_bf16 v[112:115], a[72:75], a[104:107], v[112:115]
s_add_u32 s84, s84, s18
ds_read_b64_tr_b16 a[140:141], v16 offset:1608
v_cmp_gt_i32 s[38:39], 3, v5
v_mfma_f32_16x16x32_bf16 v[112:115], a[76:79], a[100:103], v[112:115]
s_xor_b32 s85, s84, 0x20000
ds_read_b64_tr_b16 a[142:143], v16 offset:1600
v_cmp_gt_i32 s[40:41], 16, v5
v_mfma_f32_16x16x32_bf16 v[112:115], a[80:83], a[96:99], v[112:115]
s_sub_u32 s29, 15, s21
ds_read_b128 a[172:175], v17 offset:1920
v_cmp_gt_i32 s[42:43], 17, v5
v_mfma_f32_16x16x32_bf16 v[116:119], a[64:67], a[116:119], 0
s_xor_b32 s8, s30, 2097152
ds_read_b128 a[204:207], v30 offset:3072
v_cmp_gt_i32 s[44:45], 18, v5
v_mfma_f32_16x16x32_bf16 v[116:119], a[68:71], a[112:115], v[116:119]
s_add_u32 s11, s22, 2
ds_read_b64_tr_b16 a[144:145], v16 offset:2120
v_cmp_gt_i32 s[46:47], 19, v5
v_mfma_f32_16x16x32_bf16 v[116:119], a[72:75], a[108:111], v[116:119]
s_add_u32 s14, s30, 16777216
ds_read_b64_tr_b16 a[146:147], v16 offset:2112
v_cmp_gt_i32 s[48:49], 32, v5
v_mfma_f32_16x16x32_bf16 v[116:119], a[76:79], a[104:107], v[116:119]
s_lshr_b32 s19, s9, 1
ds_read_b128 a[176:179], v17 offset:2432
v_cmp_gt_i32 s[50:51], 33, v5
v_mfma_f32_16x16x32_bf16 v[116:119], a[80:83], a[100:103], v[116:119]
s_cmp_lg_u32 s9, 0
ds_read_b128 a[208:211], v30 offset:4096
v_cmp_gt_i32 s[52:53], 34, v5
v_mfma_f32_16x16x32_bf16 v[116:119], a[84:87], a[96:99], v[116:119]
s_cselect_b32 s10, s30, 3221225472
ds_read_b64_tr_b16 a[148:149], v16 offset:2632
v_cmp_gt_i32 s[54:55], 35, v5
v_mfma_f32_16x16x32_bf16 v[120:123], a[64:67], a[120:123], 0
s_cselect_b32 s8, s8, s30
ds_read_b64_tr_b16 a[150:151], v16 offset:2624
v_cmp_gt_i32 s[56:57], 48, v5
v_mfma_f32_16x16x32_bf16 v[120:123], a[68:71], a[116:119], v[120:123]
s_cselect_b32 s14, s14, 3221225472
ds_read_b128 a[180:183], v17 offset:2944
v_cmp_gt_i32 s[58:59], 49, v5
v_mfma_f32_16x16x32_bf16 v[120:123], a[72:75], a[112:115], v[120:123]
s_cselect_b32 s9, s9, s11
ds_read_b128 a[212:215], v30 offset:5120
v_cmp_gt_i32 s[60:61], 50, v5
v_mfma_f32_16x16x32_bf16 v[120:123], a[76:79], a[108:111], v[120:123]
s_cselect_b32 s19, s19, s21
ds_read_b64_tr_b16 a[152:153], v16 offset:3144
v_cmp_gt_i32 s[62:63], 51, v5
v_mfma_f32_16x16x32_bf16 v[120:123], a[80:83], a[104:107], v[120:123]
s_cselect_b32 s29, s29, s21
ds_read_b64_tr_b16 a[154:155], v16 offset:3136
v_mov_b32 v7, 0xff800000
v_mfma_f32_16x16x32_bf16 v[120:123], a[84:87], a[100:103], v[120:123]
s_cselect_b32 s24, 2, 0
ds_read_b128 a[184:187], v17 offset:3456
v_mov_b32 v6, 1
v_mfma_f32_16x16x32_bf16 v[120:123], a[88:91], a[96:99], v[120:123]
s_add_u32 s12, s8, 16777216
ds_read_b128 a[216:219], v30 offset:6144
v_mov_b32 v5, v26
v_mfma_f32_16x16x32_bf16 v[124:127], a[64:67], a[124:127], 0
s_mov_b32 s13, s9
ds_read_b64_tr_b16 a[156:157], v16 offset:3656
v_add_u32 v4, 0x20000, v1
v_mfma_f32_16x16x32_bf16 v[124:127], a[68:71], a[120:123], v[124:127]
s_mov_b32 s15, s11
ds_read_b64_tr_b16 a[158:159], v16 offset:3648
v_mfma_f32_16x16x32_bf16 v[124:127], a[72:75], a[116:119], v[124:127]
s_mov_b32 s25, 1266679808
ds_read_b128 a[188:191], v17 offset:3968
v_mfma_f32_16x16x32_bf16 v[124:127], a[76:79], a[112:115], v[124:127]
s_lshl_b32 s22, s21, 3
ds_read_b128 a[220:223], v30 offset:7168
v_mfma_f32_16x16x32_bf16 v[124:127], a[80:83], a[108:111], v[124:127]
s_xor_b32 s28, s70, 0
ds_read_b128 a[224:227], v31 offset:0
v_mfma_f32_16x16x32_bf16 v[124:127], a[84:87], a[104:107], v[124:127]
s_add_u32 s28, s28, s22
ds_read_b128 a[228:231], v31 offset:1024
v_mfma_f32_16x16x32_bf16 v[124:127], a[88:91], a[100:103], v[124:127]
s_add_u32 s28, s28, 6148
ds_read_b128 a[232:235], v31 offset:2048
v_mfma_f32_16x16x32_bf16 v[124:127], a[92:95], a[96:99], v[124:127]
s_waitcnt lgkmcnt(8)
s_lshl_b32 s26, s21, 16
ds_read_b128 a[236:239], v31 offset:3072
v_mfma_f32_16x16x32_bf16 v[96:99], a[128:131], a[160:163], v[96:99]
s_add_u32 s26, s26, s30
ds_read_b64_tr_b16 a[64:65], v16 offset:136
v_mfma_f32_16x16x32_bf16 v[100:103], a[128:131], a[164:167], v[100:103]
s_add_u32 s26, s26, 33554432
ds_read_b64_tr_b16 a[66:67], v16 offset:128
v_mfma_f32_16x16x32_bf16 v[100:103], a[132:135], a[160:163], v[100:103]
s_xor_b32 s76, s20, 2
ds_read_b128 a[96:99], v17 offset:320
v_mfma_f32_16x16x32_bf16 v[104:107], a[128:131], a[168:171], v[104:107]
s_lshl_b32 s76, s76, 3
ds_read_b128 a[240:243], v31 offset:4096
v_mfma_f32_16x16x32_bf16 v[104:107], a[132:135], a[164:167], v[104:107]
s_add_u32 s76, s76, s21
ds_read_b64_tr_b16 a[68:69], v16 offset:648
v_mfma_f32_16x16x32_bf16 v[104:107], a[136:139], a[160:163], v[104:107]
s_lshl_b32 s76, s76, 2
ds_read_b64_tr_b16 a[70:71], v16 offset:640
v_mfma_f32_16x16x32_bf16 v[108:111], a[128:131], a[172:175], v[108:111]
s_add_u32 s76, s76, s3
ds_read_b128 a[100:103], v17 offset:832
v_mfma_f32_16x16x32_bf16 v[108:111], a[132:135], a[168:171], v[108:111]
s_lshl_b32 s27, s76, 10
ds_read_b128 a[244:247], v31 offset:5120
v_mfma_f32_16x16x32_bf16 v[108:111], a[136:139], a[164:167], v[108:111]
s_add_u32 s27, s27, 75497472
ds_read_b64_tr_b16 a[72:73], v16 offset:1160
v_mfma_f32_16x16x32_bf16 v[108:111], a[140:143], a[160:163], v[108:111]
s_lshl_b32 s76, s76, 14
ds_read_b64_tr_b16 a[74:75], v16 offset:1152
v_mfma_f32_16x16x32_bf16 v[112:115], a[128:131], a[176:179], v[112:115]
s_add_u32 s76, s76, 67108864
ds_read_b128 a[104:107], v17 offset:1344
v_mfma_f32_16x16x32_bf16 v[112:115], a[132:135], a[172:175], v[112:115]
s_lshl_b32 s81, s20, 2
ds_read_b128 a[248:251], v31 offset:6144
v_mfma_f32_16x16x32_bf16 v[112:115], a[136:139], a[168:171], v[112:115]
s_add_u32 s81, s81, s3
ds_read_b64_tr_b16 a[76:77], v16 offset:1672
v_mfma_f32_16x16x32_bf16 v[112:115], a[140:143], a[164:167], v[112:115]
s_mul_i32 s81, s81, 57344
ds_read_b64_tr_b16 a[78:79], v16 offset:1664
v_mfma_f32_16x16x32_bf16 v[112:115], a[144:147], a[160:163], v[112:115]
s_cmp_eq_u32 s24, 1
ds_read_b128 a[108:111], v17 offset:1856
v_mfma_f32_16x16x32_bf16 v[116:119], a[128:131], a[180:183], v[116:119]
s_cselect_b32 s80, s28, s70
ds_read_b128 a[252:255], v31 offset:7168
v_mfma_f32_16x16x32_bf16 v[116:119], a[132:135], a[176:179], v[116:119]
s_add_u32 s77, s76, 8192
ds_read_b64_tr_b16 a[80:81], v16 offset:2184
v_mfma_f32_16x16x32_bf16 v[116:119], a[136:139], a[172:175], v[116:119]
s_lshl_b32 s71, s2, 2
ds_read_b64_tr_b16 a[82:83], v16 offset:2176
v_mfma_f32_16x16x32_bf16 v[116:119], a[140:143], a[168:171], v[116:119]
s_add_u32 s71, s71, 94384128
ds_read_b128 a[112:115], v17 offset:2368
v_mfma_f32_16x16x32_bf16 v[116:119], a[144:147], a[164:167], v[116:119]
s_lshl_b32 s78, s29, 16
v_mfma_f32_16x16x32_bf16 v[116:119], a[148:151], a[160:163], v[116:119]
s_add_u32 s78, s78, s8
ds_read_b64_tr_b16 a[84:85], v16 offset:2696
v_mfma_f32_16x16x32_bf16 v[120:123], a[128:131], a[184:187], v[120:123]
s_add_u32 s78, s78, 33554432
ds_read_b64_tr_b16 a[86:87], v16 offset:2688
v_mfma_f32_16x16x32_bf16 v[120:123], a[132:135], a[180:183], v[120:123]
s_cmp_eq_u32 s24, 0
ds_read_b128 a[116:119], v17 offset:2880
v_mfma_f32_16x16x32_bf16 v[120:123], a[136:139], a[176:179], v[120:123]
s_cselect_b32 s78, 3221225472, s78
v_mfma_f32_16x16x32_bf16 v[120:123], a[140:143], a[172:175], v[120:123]
s_lshl_b32 s22, s21, 3
ds_read_b64_tr_b16 a[88:89], v16 offset:3208
v_mfma_f32_16x16x32_bf16 v[120:123], a[144:147], a[168:171], v[120:123]
s_add_u32 s22, s22, 16384
ds_read_b64_tr_b16 a[90:91], v16 offset:3200
v_mfma_f32_16x16x32_bf16 v[120:123], a[148:151], a[164:167], v[120:123]
s_andn2_b32 s23, 256, s70
ds_read_b128 a[120:123], v17 offset:3392
v_mfma_f32_16x16x32_bf16 v[120:123], a[152:155], a[160:163], v[120:123]
s_waitcnt lgkmcnt(6)
s_add_u32 s22, s22, s23
v_mfma_f32_16x16x32_bf16 v[124:127], a[128:131], a[188:191], v[124:127]
s_waitcnt vmcnt(0) lgkmcnt(9)
s_barrier
ds_read_b64_tr_b16 a[92:93], v16 offset:3720
v_writelane_b32 v15, s22, 63
v_cmp_gt_u32 vcc, 1, v21
v_mfma_f32_16x16x32_bf16 v[124:127], a[132:135], a[184:187], v[124:127]
s_cbranch_vccnz M_kspin2
M_kok2:
ds_read_b64_tr_b16 a[94:95], v16 offset:3712
v_mov_b32 v25, 0
v_mfma_f32_16x16x32_bf16 v[124:127], a[136:139], a[180:183], v[124:127]
s_mov_b32 m0, s84
ds_read_b128 a[124:127], v17 offset:3904
v_mov_b32 v128, 0
v_mfma_f32_16x16x32_bf16 v[124:127], a[140:143], a[176:179], v[124:127]
PAD_30:
s_cbranch_execz M_tret
buffer_load_dwordx4 v1, s[4:7], s8 offen offset:0 sc1 lds
v_mfma_f32_16x16x32_bf16 v[124:127], a[144:147], a[172:175], v[124:127]
buffer_load_dwordx4 v1, s[4:7], s8 offen offset:1024 sc1 lds
v_mfma_f32_16x16x32_bf16 v[124:127], a[148:151], a[168:171], v[124:127]
buffer_load_dwordx4 v1, s[4:7], s8 offen offset:2048 sc1 lds
v_mfma_f32_16x16x32_bf16 v[124:127], a[152:155], a[164:167], v[124:127]
buffer_load_dwordx4 v1, s[4:7], s8 offen offset:3072 sc1 lds
v_mfma_f32_16x16x32_bf16 v[124:127], a[156:159], a[160:163], v[124:127]
s_add_u32 s8, s8, 4096
v_mov_b32 v129, 0
v_mov_b32 v130, 0
v_mfma_f32_16x16x32_bf16 v[96:99], a[64:67], a[96:99], v[96:99]
s_add_u32 m0, s84, 4096
ds_read_b64_tr_b16 a[128:129], v16 offset:200
v_mov_b32 v131, 0
v_mfma_f32_16x16x32_bf16 v[100:103], a[64:67], a[100:103], v[100:103]
ds_read_b64_tr_b16 a[130:131], v16 offset:192
v_mov_b32 v132, 0
v_mfma_f32_16x16x32_bf16 v[100:103], a[68:71], a[96:99], v[100:103]
ds_read_b128 a[160:163], v17 offset:256
v_mov_b32 v133, 0
v_mfma_f32_16x16x32_bf16 v[104:107], a[64:67], a[104:107], v[104:107]
buffer_load_dwordx4 v1, s[4:7], s8 offen offset:0 sc1 lds
v_mfma_f32_16x16x32_bf16 v[104:107], a[68:71], a[100:103], v[104:107]
ds_read_b64_tr_b16 a[132:133], v16 offset:712
v_mov_b32 v134, 0
v_mfma_f32_16x16x32_bf16 v[104:107], a[72:75], a[96:99], v[104:107]
ds_read_b64_tr_b16 a[134:135], v16 offset:704
v_mov_b32 v135, 0
v_mfma_f32_16x16x32_bf16 v[108:111], a[64:67], a[108:111], v[108:111]
ds_read_b128 a[164:167], v17 offset:768
v_mov_b32 v136, 0
v_mfma_f32_16x16x32_bf16 v[108:111], a[68:71], a[104:107], v[108:111]
buffer_load_dwordx4 v1, s[4:7], s8 offen offset:1024 sc1 lds
v_mfma_f32_16x16x32_bf16 v[108:111], a[72:75], a[100:103], v[108:111]
ds_read_b64_tr_b16 a[136:137], v16 offset:1224
v_mov_b32 v137, 0
v_mfma_f32_16x16x32_bf16 v[108:111], a[76:79], a[96:99], v[108:111]
ds_read_b64_tr_b16 a[138:139], v16 offset:1216
v_mov_b32 v138, 0
v_mfma_f32_16x16x32_bf16 v[112:115], a[64:67], a[112:115], v[112:115]
ds_read_b128 a[168:171], v17 offset:1280
v_mov_b32 v139, 0
v_mfma_f32_16x16x32_bf16 v[112:115], a[68:71], a[108:111], v[112:115]
buffer_load_dwordx4 v1, s[4:7], s8 offen offset:2048 sc1 lds
v_mfma_f32_16x16x32_bf16 v[112:115], a[72:75], a[104:107], v[112:115]
ds_read_b64_tr_b16 a[140:141], v16 offset:1736
v_mov_b32 v140, 0
v_mfma_f32_16x16x32_bf16 v[112:115], a[76:79], a[100:103], v[112:115]
ds_read_b64_tr_b16 a[142:143], v16 offset:1728
v_mov_b32 v141, 0
v_mfma_f32_16x16x32_bf16 v[112:115], a[80:83], a[96:99], v[112:115]
s_waitcnt lgkmcnt(6)
ds_read_b128 a[172:175], v17 offset:1792
v_mov_b32 v142, 0
v_mfma_f32_16x16x32_bf16 v[116:119], a[64:67], a[116:119], v[116:119]
buffer_load_dwordx4 v1, s[4:7], s8 offen offset:3072 sc1 lds
v_mfma_f32_16x16x32_bf16 v[116:119], a[68:71], a[112:115], v[116:119]
s_add_u32 s8, s8, 28672
ds_read_b64_tr_b16 a[144:145], v16 offset:2248
v_mov_b32 v143, 0
v_mfma_f32_16x16x32_bf16 v[116:119], a[72:75], a[108:111], v[116:119]
s_sub_u32 s9, s9, 1
ds_read_b64_tr_b16 a[146:147], v16 offset:2240
v_mov_b32 v144, 0
v_mfma_f32_16x16x32_bf16 v[116:119], a[76:79], a[104:107], v[116:119]
s_cmp_eq_u32 s9, 0
ds_read_b128 a[176:179], v17 offset:2304
v_mov_b32 v145, 0
v_mfma_f32_16x16x32_bf16 v[116:119], a[80:83], a[100:103], v[116:119]
s_cselect_b32 s8, s10, s8
v_mov_b32 v146, 0
v_mov_b32 v147, 0
v_mfma_f32_16x16x32_bf16 v[116:119], a[84:87], a[96:99], v[116:119]
s_cselect_b32 s9, s11, s9
ds_read_b64_tr_b16 a[148:149], v16 offset:2760
v_mov_b32 v148, 0
v_mfma_f32_16x16x32_bf16 v[120:123], a[64:67], a[120:123], v[120:123]
s_cselect_b32 s10, 3221225472, s10
ds_read_b64_tr_b16 a[150:151], v16 offset:2752
v_mov_b32 v149, 0
v_mfma_f32_16x16x32_bf16 v[120:123], a[68:71], a[116:119], v[120:123]
s_mov_b32 m0, s85
ds_read_b128 a[180:183], v17 offset:2816
v_mov_b32 v150, 0
v_mfma_f32_16x16x32_bf16 v[120:123], a[72:75], a[112:115], v[120:123]
buffer_load_dwordx4 v1, s[4:7], s8 offen offset:0 sc1 lds
v_mfma_f32_16x16x32_bf16 v[120:123], a[76:79], a[108:111], v[120:123]
ds_read_b64_tr_b16 a[152:153], v16 offset:3272
v_mov_b32 v151, 0
v_mfma_f32_16x16x32_bf16 v[120:123], a[80:83], a[104:107], v[120:123]
ds_read_b64_tr_b16 a[154:155], v16 offset:3264
v_mov_b32 v152, 0
v_mfma_f32_16x16x32_bf16 v[120:123], a[84:87], a[100:103], v[120:123]
ds_read_b128 a[184:187], v17 offset:3328
v_mov_b32 v153, 0
v_mfma_f32_16x16x32_bf16 v[120:123], a[88:91], a[96:99], v[120:123]
buffer_load_dwordx4 v1, s[4:7], s8 offen offset:1024 sc1 lds
v_mfma_f32_16x16x32_bf16 v[124:127], a[64:67], a[124:127], v[124:127]
ds_read_b64_tr_b16 a[156:157], v16 offset:3784
v_mov_b32 v154, 0
v_mfma_f32_16x16x32_bf16 v[124:127], a[68:71], a[120:123], v[124:127]
ds_read_b64_tr_b16 a[158:159], v16 offset:3776
v_mov_b32 v155, 0
v_mfma_f32_16x16x32_bf16 v[124:127], a[72:75], a[116:119], v[124:127]
ds_read_b128 a[188:191], v17 offset:3840
v_mov_b32 v156, 0
v_mfma_f32_16x16x32_bf16 v[124:127], a[76:79], a[112:115], v[124:127]
buffer_load_dwordx4 v1, s[4:7], s8 offen offset:2048 sc1 lds
v_mfma_f32_16x16x32_bf16 v[124:127], a[80:83], a[108:111], v[124:127]
buffer_load_dwordx4 v1, s[4:7], s8 offen offset:3072 sc1 lds
v_mfma_f32_16x16x32_bf16 v[124:127], a[84:87], a[104:107], v[124:127]
s_add_u32 s8, s8, 4096
v_mov_b32 v157, 0
v_mov_b32 v158, 0
v_mfma_f32_16x16x32_bf16 v[124:127], a[88:91], a[100:103], v[124:127]
s_add_u32 m0, s85, 4096
v_mov_b32 v159, 0
v_mov_b32 v160, 0
v_mfma_f32_16x16x32_bf16 v[124:127], a[92:95], a[96:99], v[124:127]
buffer_load_dwordx4 v1, s[4:7], s8 offen offset:0 sc1 lds
v_mfma_f32_16x16x32_bf16 v[96:99], a[128:131], a[160:163], v[96:99]
s_waitcnt lgkmcnt(3)
ds_read_b64_tr_b16 a[64:65], v16 offset:264
v_mov_b32 v161, 0
v_mfma_f32_16x16x32_bf16 v[100:103], a[128:131], a[164:167], v[100:103]
ds_read_b64_tr_b16 a[66:67], v16 offset:256
v_mov_b32 v162, 0
v_mfma_f32_16x16x32_bf16 v[100:103], a[132:135], a[160:163], v[100:103]
ds_read_b128 a[96:99], v17 offset:192
v_mov_b32 v163, 0
v_mfma_f32_16x16x32_bf16 v[104:107], a[128:131], a[168:171], v[104:107]
buffer_load_dwordx4 v1, s[4:7], s8 offen offset:1024 sc1 lds
v_mfma_f32_16x16x32_bf16 v[104:107], a[132:135], a[164:167], v[104:107]
ds_read_b64_tr_b16 a[68:69], v16 offset:776
v_mov_b32 v164, 0
v_mfma_f32_16x16x32_bf16 v[104:107], a[136:139], a[160:163], v[104:107]
ds_read_b64_tr_b16 a[70:71], v16 offset:768
v_mov_b32 v165, 0
v_mfma_f32_16x16x32_bf16 v[108:111], a[128:131], a[172:175], v[108:111]
ds_read_b128 a[100:103], v17 offset:704
v_mov_b32 v166, 0
v_mfma_f32_16x16x32_bf16 v[108:111], a[132:135], a[168:171], v[108:111]
buffer_load_dwordx4 v1, s[4:7], s8 offen offset:2048 sc1 lds
v_mfma_f32_16x16x32_bf16 v[108:111], a[136:139], a[164:167], v[108:111]
ds_read_b64_tr_b16 a[72:73], v16 offset:1288
v_mov_b32 v167, 0
v_mfma_f32_16x16x32_bf16 v[108:111], a[140:143], a[160:163], v[108:111]
ds_read_b64_tr_b16 a[74:75], v16 offset:1280
v_mov_b32 v168, 0
v_mfma_f32_16x16x32_bf16 v[112:115], a[128:131], a[176:179], v[112:115]
ds_read_b128 a[104:107], v17 offset:1216
v_mov_b32 v169, 0
v_mfma_f32_16x16x32_bf16 v[112:115], a[132:135], a[172:175], v[112:115]
buffer_load_dwordx4 v1, s[4:7], s8 offen offset:3072 sc1 lds
v_mfma_f32_16x16x32_bf16 v[112:115], a[136:139], a[168:171], v[112:115]
s_add_u32 s8, s8, 28672
ds_read_b64_tr_b16 a[76:77], v16 offset:1800
v_mov_b32 v170, 0
v_mfma_f32_16x16x32_bf16 v[112:115], a[140:143], a[164:167], v[112:115]
s_sub_u32 s9, s9, 1
ds_read_b64_tr_b16 a[78:79], v16 offset:1792
v_mov_b32 v171, 0
v_mfma_f32_16x16x32_bf16 v[112:115], a[144:147], a[160:163], v[112:115]
s_cmp_eq_u32 s9, 0
ds_read_b128 a[108:111], v17 offset:1728
v_mov_b32 v172, 0
v_mfma_f32_16x16x32_bf16 v[116:119], a[128:131], a[180:183], v[116:119]
s_cselect_b32 s8, s10, s8
buffer_load_dword v14, v15, s[4:7], s31 offen sc1
v_mfma_f32_16x16x32_bf16 v[116:119], a[132:135], a[176:179], v[116:119]
s_cselect_b32 s9, s11, s9
ds_read_b64_tr_b16 a[80:81], v16 offset:2312
v_mov_b32 v173, 0
v_mfma_f32_16x16x32_bf16 v[116:119], a[136:139], a[172:175], v[116:119]
s_cselect_b32 s10, 3221225472, s10
ds_read_b64_tr_b16 a[82:83], v16 offset:2304
v_mov_b32 v174, 0
v_mfma_f32_16x16x32_bf16 v[116:119], a[140:143], a[168:171], v[116:119]
ds_read_b128 a[112:115], v17 offset:2240
v_mov_b32 v175, 0
v_mfma_f32_16x16x32_bf16 v[116:119], a[144:147], a[164:167], v[116:119]
v_mov_b32 v176, 0
v_mov_b32 v177, 0
v_mfma_f32_16x16x32_bf16 v[116:119], a[148:151], a[160:163], v[116:119]
ds_read_b64_tr_b16 a[84:85], v16 offset:2824
v_mov_b32 v178, 0
v_mfma_f32_16x16x32_bf16 v[120:123], a[128:131], a[184:187], v[120:123]
ds_read_b64_tr_b16 a[86:87], v16 offset:2816
v_mov_b32 v179, 0
v_mfma_f32_16x16x32_bf16 v[120:123], a[132:135], a[180:183], v[120:123]
ds_read_b128 a[116:119], v17 offset:2752
v_mov_b32 v180, 0
v_mfma_f32_16x16x32_bf16 v[120:123], a[136:139], a[176:179], v[120:123]
v_mov_b32 v181, 0
v_mov_b32 v182, 0
v_mfma_f32_16x16x32_bf16 v[120:123], a[140:143], a[172:175], v[120:123]
ds_read_b64_tr_b16 a[88:89], v16 offset:3336
v_mov_b32 v183, 0
v_mfma_f32_16x16x32_bf16 v[120:123], a[144:147], a[168:171], v[120:123]
ds_read_b64_tr_b16 a[90:91], v16 offset:3328
v_mov_b32 v184, 0
v_mfma_f32_16x16x32_bf16 v[120:123], a[148:151], a[164:167], v[120:123]
ds_read_b128 a[120:123], v17 offset:3264
v_mov_b32 v185, 0
v_mfma_f32_16x16x32_bf16 v[120:123], a[152:155], a[160:163], v[120:123]
s_waitcnt lgkmcnt(6)
v_mov_b32 v186, 0
v_mov_b32 v187, 0
v_mfma_f32_16x16x32_bf16 v[124:127], a[128:131], a[188:191], v[124:127]
ds_read_b64_tr_b16 a[92:93], v16 offset:3848
v_mov_b32 v188, 0
v_mfma_f32_16x16x32_bf16 v[124:127], a[132:135], a[184:187], v[124:127]
ds_read_b64_tr_b16 a[94:95], v16 offset:3840
v_mov_b32 v189, 0
v_mfma_f32_16x16x32_bf16 v[124:127], a[136:139], a[180:183], v[124:127]
ds_read_b128 a[124:127], v17 offset:3776
v_mov_b32 v190, 0
v_mfma_f32_16x16x32_bf16 v[124:127], a[140:143], a[176:179], v[124:127]
v_mov_b32 v191, 0
v_mov_b32 v192, 0
v_mfma_f32_16x16x32_bf16 v[124:127], a[144:147], a[172:175], v[124:127]
v_mov_b32 v193, 0
v_mov_b32 v194, 0
v_mfma_f32_16x16x32_bf16 v[124:127], a[148:151], a[168:171], v[124:127]
v_mov_b32 v195, 0
v_mov_b32 v196, 0
v_mfma_f32_16x16x32_bf16 v[124:127], a[152:155], a[164:167], v[124:127]
v_mov_b32 v197, 0
v_mov_b32 v198, 0
v_mfma_f32_16x16x32_bf16 v[124:127], a[156:159], a[160:163], v[124:127]
v_mov_b32 v199, 0
v_mov_b32 v200, 0
s_waitcnt vmcnt(0)
v_cmp_gt_u32 vcc, 1, v14
s_cbranch_vccnz M_cspin
M_cok:
v_mfma_f32_16x16x32_bf16 v[96:99], a[64:67], a[96:99], v[96:99]
s_add_u32 s22, s78, 0
ds_read_b64_tr_b16 a[128:129], v16 offset:328
v_mov_b32 v201, 0
v_mfma_f32_16x16x32_bf16 v[100:103], a[64:67], a[100:103], v[100:103]
ds_read_b64_tr_b16 a[130:131], v16 offset:320
v_mov_b32 v202, 0
v_mfma_f32_16x16x32_bf16 v[100:103], a[68:71], a[96:99], v[100:103]
ds_read_b128 a[160:163], v17 offset:128
v_mov_b32 v203, 0
v_mfma_f32_16x16x32_bf16 v[104:107], a[64:67], a[104:107], v[104:107]
buffer_load_dwordx4 a[0:3], v1, s[4:7], s22 offen offset:0 sc1
v_mfma_f32_16x16x32_bf16 v[104:107], a[68:71], a[100:103], v[104:107]
ds_read_b64_tr_b16 a[132:133], v16 offset:840
v_mov_b32 v204, 0
v_mfma_f32_16x16x32_bf16 v[104:107], a[72:75], a[96:99], v[104:107]
ds_read_b64_tr_b16 a[134:135], v16 offset:832
v_mov_b32 v205, 0
v_mfma_f32_16x16x32_bf16 v[108:111], a[64:67], a[108:111], v[108:111]
ds_read_b128 a[164:167], v17 offset:640
v_mov_b32 v206, 0
v_mfma_f32_16x16x32_bf16 v[108:111], a[68:71], a[104:107], v[108:111]
buffer_load_dwordx4 a[4:7], v1, s[4:7], s22 offen offset:1024 sc1
v_mfma_f32_16x16x32_bf16 v[108:111], a[72:75], a[100:103], v[108:111]
ds_read_b64_tr_b16 a[136:137], v16 offset:1352
v_mov_b32 v207, 0
v_mfma_f32_16x16x32_bf16 v[108:111], a[76:79], a[96:99], v[108:111]
ds_read_b64_tr_b16 a[138:139], v16 offset:1344
v_mov_b32 v208, 0
v_mfma_f32_16x16x32_bf16 v[112:115], a[64:67], a[112:115], v[112:115]
ds_read_b128 a[168:171], v17 offset:1152
v_mov_b32 v209, 0
v_mfma_f32_16x16x32_bf16 v[112:115], a[68:71], a[108:111], v[112:115]
buffer_load_dwordx4 a[8:11], v1, s[4:7], s22 offen offset:2048 sc1
v_mfma_f32_16x16x32_bf16 v[112:115], a[72:75], a[104:107], v[112:115]
ds_read_b64_tr_b16 a[140:141], v16 offset:1864
v_mov_b32 v210, 0
v_mfma_f32_16x16x32_bf16 v[112:115], a[76:79], a[100:103], v[112:115]
ds_read_b64_tr_b16 a[142:143], v16 offset:1856
v_mov_b32 v211, 0
v_mfma_f32_16x16x32_bf16 v[112:115], a[80:83], a[96:99], v[112:115]
s_waitcnt lgkmcnt(6)
ds_read_b128 a[172:175], v17 offset:1664
v_mov_b32 v212, 0
v_mfma_f32_16x16x32_bf16 v[116:119], a[64:67], a[116:119], v[116:119]
buffer_load_dwordx4 a[12:15], v1, s[4:7], s22 offen offset:3072 sc1
v_mfma_f32_16x16x32_bf16 v[116:119], a[68:71], a[112:115], v[116:119]
s_add_u32 s22, s78, 4096
ds_read_b64_tr_b16 a[144:145], v16 offset:2376
v_mov_b32 v213, 0
v_mfma_f32_16x16x32_bf16 v[116:119], a[72:75], a[108:111], v[116:119]
ds_read_b64_tr_b16 a[146:147], v16 offset:2368
v_mov_b32 v214, 0
v_mfma_f32_16x16x32_bf16 v[116:119], a[76:79], a[104:107], v[116:119]
ds_read_b128 a[176:179], v17 offset:2176
v_mov_b32 v215, 0
v_mfma_f32_16x16x32_bf16 v[116:119], a[80:83], a[100:103], v[116:119]
buffer_load_dwordx4 a[16:19], v1, s[4:7], s22 offen offset:0 sc1
v_mfma_f32_16x16x32_bf16 v[116:119], a[84:87], a[96:99], v[116:119]
ds_read_b64_tr_b16 a[148:149], v16 offset:2888
v_mov_b32 v216, 0
v_mfma_f32_16x16x32_bf16 v[120:123], a[64:67], a[120:123], v[120:123]
ds_read_b64_tr_b16 a[150:151], v16 offset:2880
v_mov_b32 v217, 0
v_mfma_f32_16x16x32_bf16 v[120:123], a[68:71], a[116:119], v[120:123]
ds_read_b128 a[180:183], v17 offset:2688
v_mov_b32 v218, 0
v_mfma_f32_16x16x32_bf16 v[120:123], a[72:75], a[112:115], v[120:123]
buffer_load_dwordx4 a[20:23], v1, s[4:7], s22 offen offset:1024 sc1
v_mfma_f32_16x16x32_bf16 v[120:123], a[76:79], a[108:111], v[120:123]
ds_read_b64_tr_b16 a[152:153], v16 offset:3400
v_mov_b32 v219, 0
v_mfma_f32_16x16x32_bf16 v[120:123], a[80:83], a[104:107], v[120:123]
ds_read_b64_tr_b16 a[154:155], v16 offset:3392
v_mov_b32 v220, 0
v_mfma_f32_16x16x32_bf16 v[120:123], a[84:87], a[100:103], v[120:123]
ds_read_b128 a[184:187], v17 offset:3200
v_mov_b32 v221, 0
v_mfma_f32_16x16x32_bf16 v[120:123], a[88:91], a[96:99], v[120:123]
buffer_load_dwordx4 a[24:27], v1, s[4:7], s22 offen offset:2048 sc1
v_mfma_f32_16x16x32_bf16 v[124:127], a[64:67], a[124:127], v[124:127]
ds_read_b64_tr_b16 a[156:157], v16 offset:3912
v_mov_b32 v222, 0
v_mfma_f32_16x16x32_bf16 v[124:127], a[68:71], a[120:123], v[124:127]
ds_read_b64_tr_b16 a[158:159], v16 offset:3904
v_mov_b32 v223, 0
v_mfma_f32_16x16x32_bf16 v[124:127], a[72:75], a[116:119], v[124:127]
ds_read_b128 a[188:191], v17 offset:3712
v_mov_b32 v224, 0
v_mfma_f32_16x16x32_bf16 v[124:127], a[76:79], a[112:115], v[124:127]
buffer_load_dwordx4 a[28:31], v1, s[4:7], s22 offen offset:3072 sc1
v_mfma_f32_16x16x32_bf16 v[124:127], a[80:83], a[108:111], v[124:127]
s_add_u32 s22, s78, 32768
buffer_load_dwordx4 a[32:35], v1, s[4:7], s22 offen offset:0 sc1
v_mfma_f32_16x16x32_bf16 v[124:127], a[84:87], a[104:107], v[124:127]
buffer_load_dwordx4 a[36:39], v1, s[4:7], s22 offen offset:1024 sc1
v_mfma_f32_16x16x32_bf16 v[124:127], a[88:91], a[100:103], v[124:127]
buffer_load_dwordx4 a[40:43], v1, s[4:7], s22 offen offset:2048 sc1
v_mfma_f32_16x16x32_bf16 v[124:127], a[92:95], a[96:99], v[124:127]
s_waitcnt lgkmcnt(3)
buffer_load_dwordx4 a[44:47], v1, s[4:7], s22 offen offset:3072 sc1
v_mfma_f32_16x16x32_bf16 v[96:99], a[128:131], a[160:163], v[96:99]
s_add_u32 s22, s78, 36864
ds_read_b64_tr_b16 a[64:65], v16 offset:392
v_mov_b32 v225, 0
v_mfma_f32_16x16x32_bf16 v[100:103], a[128:131], a[164:167], v[100:103]
ds_read_b64_tr_b16 a[66:67], v16 offset:384
v_mov_b32 v226, 0
v_mfma_f32_16x16x32_bf16 v[100:103], a[132:135], a[160:163], v[100:103]
ds_read_b128 a[96:99], v17 offset:64
v_mov_b32 v227, 0
v_mfma_f32_16x16x32_bf16 v[104:107], a[128:131], a[168:171], v[104:107]
ds_read_b64 v[36:37], v18 offset:0
v_mov_b32 v228, 0
v_mfma_f32_16x16x32_bf16 v[104:107], a[132:135], a[164:167], v[104:107]
ds_read_b64_tr_b16 a[68:69], v16 offset:904
v_mov_b32 v229, 0
v_mfma_f32_16x16x32_bf16 v[104:107], a[136:139], a[160:163], v[104:107]
ds_read_b64_tr_b16 a[70:71], v16 offset:896
v_mov_b32 v230, 0
v_mfma_f32_16x16x32_bf16 v[108:111], a[128:131], a[172:175], v[108:111]
ds_read_b128 a[100:103], v17 offset:576
v_mov_b32 v231, 0
v_mfma_f32_16x16x32_bf16 v[108:111], a[132:135], a[168:171], v[108:111]
ds_read_b64 v[38:39], v18 offset:512
v_mov_b32 v232, 0
v_mfma_f32_16x16x32_bf16 v[108:111], a[136:139], a[164:167], v[108:111]
ds_read_b64_tr_b16 a[72:73], v16 offset:1416
v_mov_b32 v233, 0
v_mfma_f32_16x16x32_bf16 v[108:111], a[140:143], a[160:163], v[108:111]
ds_read_b64_tr_b16 a[74:75], v16 offset:1408
v_mov_b32 v234, 0
v_mfma_f32_16x16x32_bf16 v[112:115], a[128:131], a[176:179], v[112:115]
ds_read_b128 a[104:107], v17 offset:1088
v_mov_b32 v235, 0
v_mfma_f32_16x16x32_bf16 v[112:115], a[132:135], a[172:175], v[112:115]
ds_read_b64 v[44:45], v18 offset:1024
v_mov_b32 v236, 0
v_mfma_f32_16x16x32_bf16 v[112:115], a[136:139], a[168:171], v[112:115]
ds_read_b64_tr_b16 a[76:77], v16 offset:1928
v_mov_b32 v237, 0
v_mfma_f32_16x16x32_bf16 v[112:115], a[140:143], a[164:167], v[112:115]
ds_read_b64_tr_b16 a[78:79], v16 offset:1920
v_mov_b32 v238, 0
v_mfma_f32_16x16x32_bf16 v[112:115], a[144:147], a[160:163], v[112:115]
ds_read_b128 a[108:111], v17 offset:1600
v_mov_b32 v239, 0
v_mfma_f32_16x16x32_bf16 v[116:119], a[128:131], a[180:183], v[116:119]
ds_read_b64 v[46:47], v18 offset:1536
v_mov_b32 v240, 0
v_mfma_f32_16x16x32_bf16 v[116:119], a[132:135], a[176:179], v[116:119]
ds_read_b64_tr_b16 a[80:81], v16 offset:2440
v_mov_b32 v241, 0
v_mfma_f32_16x16x32_bf16 v[116:119], a[136:139], a[172:175], v[116:119]
ds_read_b64_tr_b16 a[82:83], v16 offset:2432
v_mov_b32 v242, 0
v_mfma_f32_16x16x32_bf16 v[116:119], a[140:143], a[168:171], v[116:119]
ds_read_b128 a[112:115], v17 offset:2112
v_mov_b32 v243, 0
v_mfma_f32_16x16x32_bf16 v[116:119], a[144:147], a[164:167], v[116:119]
ds_read_b64 v[52:53], v18 offset:2048
v_mov_b32 v244, 0
v_mfma_f32_16x16x32_bf16 v[116:119], a[148:151], a[160:163], v[116:119]
ds_read_b64_tr_b16 a[84:85], v16 offset:2952
v_mov_b32 v245, 0
v_mfma_f32_16x16x32_bf16 v[120:123], a[128:131], a[184:187], v[120:123]
ds_read_b64_tr_b16 a[86:87], v16 offset:2944
v_mov_b32 v246, 0
v_mfma_f32_16x16x32_bf16 v[120:123], a[132:135], a[180:183], v[120:123]
ds_read_b128 a[116:119], v17 offset:2624
v_mov_b32 v247, 0
v_mfma_f32_16x16x32_bf16 v[120:123], a[136:139], a[176:179], v[120:123]
ds_read_b64 v[54:55], v18 offset:2560
v_mov_b32 v248, 0
v_mfma_f32_16x16x32_bf16 v[120:123], a[140:143], a[172:175], v[120:123]
ds_read_b64_tr_b16 a[88:89], v16 offset:3464
v_mov_b32 v249, 0
v_mfma_f32_16x16x32_bf16 v[120:123], a[144:147], a[168:171], v[120:123]
ds_read_b64_tr_b16 a[90:91], v16 offset:3456
v_mov_b32 v250, 0
v_mfma_f32_16x16x32_bf16 v[120:123], a[148:151], a[164:167], v[120:123]
ds_read_b128 a[120:123], v17 offset:3136
v_mov_b32 v251, 0
v_mfma_f32_16x16x32_bf16 v[120:123], a[152:155], a[160:163], v[120:123]
s_waitcnt lgkmcnt(8)
ds_read_b64 v[60:61], v18 offset:3072
v_mov_b32 v252, 0
v_mfma_f32_16x16x32_bf16 v[124:127], a[128:131], a[188:191], v[124:127]
ds_read_b64_tr_b16 a[92:93], v16 offset:3976
v_mov_b32 v253, 0
v_mfma_f32_16x16x32_bf16 v[124:127], a[132:135], a[184:187], v[124:127]
ds_read_b64_tr_b16 a[94:95], v16 offset:3968
v_mov_b32 v254, 0
v_mfma_f32_16x16x32_bf16 v[124:127], a[136:139], a[180:183], v[124:127]
ds_read_b128 a[124:127], v17 offset:3648
v_mov_b32 v255, 0
v_mfma_f32_16x16x32_bf16 v[124:127], a[140:143], a[176:179], v[124:127]
ds_read_b64 v[62:63], v18 offset:3584
v_mfma_f32_16x16x32_bf16 v[124:127], a[144:147], a[172:175], v[124:127]
buffer_load_dwordx4 a[48:51], v1, s[4:7], s22 offen offset:0 sc1
v_mfma_f32_16x16x32_bf16 v[124:127], a[148:151], a[168:171], v[124:127]
buffer_load_dwordx4 a[52:55], v1, s[4:7], s22 offen offset:1024 sc1
v_mfma_f32_16x16x32_bf16 v[124:127], a[152:155], a[164:167], v[124:127]
buffer_load_dwordx4 a[56:59], v1, s[4:7], s22 offen offset:2048 sc1
v_mfma_f32_16x16x32_bf16 v[124:127], a[156:159], a[160:163], v[124:127]
buffer_load_dwordx4 a[60:63], v1, s[4:7], s22 offen offset:3072 sc1
v_mfma_f32_16x16x32_bf16 v[96:99], a[64:67], a[96:99], v[96:99]
ds_read_b64_tr_b16 a[128:129], v16 offset:456
v_mfma_f32_16x16x32_bf16 v[100:103], a[64:67], a[100:103], v[100:103]
ds_read_b64_tr_b16 a[130:131], v16 offset:448
v_mfma_f32_16x16x32_bf16 v[100:103], a[68:71], a[96:99], v[100:103]
ds_read_b128 a[160:163], v17 offset:0
v_mfma_f32_16x16x32_bf16 v[104:107], a[64:67], a[104:107], v[104:107]
v_mfma_f32_16x16x32_bf16 v[104:107], a[68:71], a[100:103], v[104:107]
ds_read_b64_tr_b16 a[132:133], v16 offset:968
v_mfma_f32_16x16x32_bf16 v[104:107], a[72:75], a[96:99], v[104:107]
ds_read_b64_tr_b16 a[134:135], v16 offset:960
v_mfma_f32_16x16x32_bf16 v[108:111], a[64:67], a[108:111], v[108:111]
ds_read_b128 a[164:167], v17 offset:512
v_mfma_f32_16x16x32_bf16 v[108:111], a[68:71], a[104:107], v[108:111]
v_mfma_f32_16x16x32_bf16 v[108:111], a[72:75], a[100:103], v[108:111]
ds_read_b64_tr_b16 a[136:137], v16 offset:1480
v_mfma_f32_16x16x32_bf16 v[108:111], a[76:79], a[96:99], v[108:111]
ds_read_b64_tr_b16 a[138:139], v16 offset:1472
v_mfma_f32_16x16x32_bf16 v[112:115], a[64:67], a[112:115], v[112:115]
ds_read_b128 a[168:171], v17 offset:1024
v_mfma_f32_16x16x32_bf16 v[112:115], a[68:71], a[108:111], v[112:115]
v_mfma_f32_16x16x32_bf16 v[112:115], a[72:75], a[104:107], v[112:115]
ds_read_b64_tr_b16 a[140:141], v16 offset:1992
v_mfma_f32_16x16x32_bf16 v[112:115], a[76:79], a[100:103], v[112:115]
ds_read_b64_tr_b16 a[142:143], v16 offset:1984
v_mfma_f32_16x16x32_bf16 v[112:115], a[80:83], a[96:99], v[112:115]
s_waitcnt lgkmcnt(6)
ds_read_b128 a[172:175], v17 offset:1536
v_mfma_f32_16x16x32_bf16 v[116:119], a[64:67], a[116:119], v[116:119]
v_mfma_f32_16x16x32_bf16 v[116:119], a[68:71], a[112:115], v[116:119]
ds_read_b64_tr_b16 a[144:145], v16 offset:2504
v_mfma_f32_16x16x32_bf16 v[116:119], a[72:75], a[108:111], v[116:119]
ds_read_b64_tr_b16 a[146:147], v16 offset:2496
v_mfma_f32_16x16x32_bf16 v[116:119], a[76:79], a[104:107], v[116:119]
ds_read_b128 a[176:179], v17 offset:2048
v_mfma_f32_16x16x32_bf16 v[116:119], a[80:83], a[100:103], v[116:119]
v_mfma_f32_16x16x32_bf16 v[116:119], a[84:87], a[96:99], v[116:119]
ds_read_b64_tr_b16 a[148:149], v16 offset:3016
v_mfma_f32_16x16x32_bf16 v[120:123], a[64:67], a[120:123], v[120:123]
ds_read_b64_tr_b16 a[150:151], v16 offset:3008
v_mfma_f32_16x16x32_bf16 v[120:123], a[68:71], a[116:119], v[120:123]
ds_read_b128 a[180:183], v17 offset:2560
v_mfma_f32_16x16x32_bf16 v[120:123], a[72:75], a[112:115], v[120:123]
v_mfma_f32_16x16x32_bf16 v[120:123], a[76:79], a[108:111], v[120:123]
ds_read_b64_tr_b16 a[152:153], v16 offset:3528
v_mfma_f32_16x16x32_bf16 v[120:123], a[80:83], a[104:107], v[120:123]
ds_read_b64_tr_b16 a[154:155], v16 offset:3520
v_mfma_f32_16x16x32_bf16 v[120:123], a[84:87], a[100:103], v[120:123]
ds_read_b128 a[184:187], v17 offset:3072
v_mfma_f32_16x16x32_bf16 v[120:123], a[88:91], a[96:99], v[120:123]
v_mfma_f32_16x16x32_bf16 v[124:127], a[64:67], a[124:127], v[124:127]
ds_read_b64_tr_b16 a[156:157], v16 offset:4040
v_mfma_f32_16x16x32_bf16 v[124:127], a[68:71], a[120:123], v[124:127]
ds_read_b64_tr_b16 a[158:159], v16 offset:4032
v_mfma_f32_16x16x32_bf16 v[124:127], a[72:75], a[116:119], v[124:127]
ds_read_b128 a[188:191], v17 offset:3584
v_mfma_f32_16x16x32_bf16 v[124:127], a[76:79], a[112:115], v[124:127]
v_mfma_f32_16x16x32_bf16 v[124:127], a[80:83], a[108:111], v[124:127]
v_mfma_f32_16x16x32_bf16 v[124:127], a[84:87], a[104:107], v[124:127]
v_mfma_f32_16x16x32_bf16 v[124:127], a[88:91], a[100:103], v[124:127]
v_mfma_f32_16x16x32_bf16 v[124:127], a[92:95], a[96:99], v[124:127]
v_mfma_f32_16x16x32_bf16 v[96:99], a[128:131], a[160:163], v[96:99]
s_waitcnt lgkmcnt(3)
v_mfma_f32_16x16x32_bf16 v[100:103], a[128:131], a[164:167], v[100:103]
v_mfma_f32_16x16x32_bf16 v[100:103], a[132:135], a[160:163], v[100:103]
v_mfma_f32_16x16x32_bf16 v[104:107], a[128:131], a[168:171], v[104:107]
v_mfma_f32_16x16x32_bf16 v[104:107], a[132:135], a[164:167], v[104:107]
v_mfma_f32_16x16x32_bf16 v[104:107], a[136:139], a[160:163], v[104:107]
v_mfma_f32_16x16x32_bf16 v[108:111], a[128:131], a[172:175], v[108:111]
v_mfma_f32_16x16x32_bf16 v[108:111], a[132:135], a[168:171], v[108:111]
v_mfma_f32_16x16x32_bf16 v[108:111], a[136:139], a[164:167], v[108:111]
v_lshlrev_b32 v10, 16, v36
v_fmac_f32 v96, v19, v10
v_mfma_f32_16x16x32_bf16 v[108:111], a[140:143], a[160:163], v[108:111]
v_and_b32 v11, 0xffff0000, v36
v_fmac_f32 v97, v19, v11
v_mfma_f32_16x16x32_bf16 v[112:115], a[128:131], a[176:179], v[112:115]
v_lshlrev_b32 v12, 16, v37
v_fmac_f32 v98, v19, v12
v_mfma_f32_16x16x32_bf16 v[112:115], a[132:135], a[172:175], v[112:115]
v_and_b32 v13, 0xffff0000, v37
v_fmac_f32 v99, v19, v13
v_mfma_f32_16x16x32_bf16 v[112:115], a[136:139], a[168:171], v[112:115]
v_cvt_pk_bf16_f32 v96, v96, v97
v_cvt_pk_bf16_f32 v97, v98, v99
v_mfma_f32_16x16x32_bf16 v[112:115], a[140:143], a[164:167], v[112:115]
buffer_store_dwordx2 v[96:97], v8, s[4:7], s83 offen offset:0 sc1
v_mfma_f32_16x16x32_bf16 v[112:115], a[144:147], a[160:163], v[112:115]
v_lshlrev_b32 v10, 16, v38
v_fmac_f32 v100, v19, v10
v_mfma_f32_16x16x32_bf16 v[116:119], a[128:131], a[180:183], v[116:119]
v_and_b32 v11, 0xffff0000, v38
v_fmac_f32 v101, v19, v11
v_mfma_f32_16x16x32_bf16 v[116:119], a[132:135], a[176:179], v[116:119]
v_lshlrev_b32 v12, 16, v39
v_fmac_f32 v102, v19, v12
v_mfma_f32_16x16x32_bf16 v[116:119], a[136:139], a[172:175], v[116:119]
v_and_b32 v13, 0xffff0000, v39
v_fmac_f32 v103, v19, v13
v_mfma_f32_16x16x32_bf16 v[116:119], a[140:143], a[168:171], v[116:119]
v_cvt_pk_bf16_f32 v100, v100, v101
v_cvt_pk_bf16_f32 v101, v102, v103
v_mfma_f32_16x16x32_bf16 v[116:119], a[144:147], a[164:167], v[116:119]
buffer_store_dwordx2 v[100:101], v8, s[4:7], s83 offen offset:512 sc1
v_mfma_f32_16x16x32_bf16 v[116:119], a[148:151], a[160:163], v[116:119]
v_lshlrev_b32 v10, 16, v44
v_fmac_f32 v104, v19, v10
v_mfma_f32_16x16x32_bf16 v[120:123], a[128:131], a[184:187], v[120:123]
v_and_b32 v11, 0xffff0000, v44
v_fmac_f32 v105, v19, v11
v_mfma_f32_16x16x32_bf16 v[120:123], a[132:135], a[180:183], v[120:123]
v_lshlrev_b32 v12, 16, v45
v_fmac_f32 v106, v19, v12
v_mfma_f32_16x16x32_bf16 v[120:123], a[136:139], a[176:179], v[120:123]
v_and_b32 v13, 0xffff0000, v45
v_fmac_f32 v107, v19, v13
v_mfma_f32_16x16x32_bf16 v[120:123], a[140:143], a[172:175], v[120:123]
v_cvt_pk_bf16_f32 v104, v104, v105
v_cvt_pk_bf16_f32 v105, v106, v107
v_mfma_f32_16x16x32_bf16 v[120:123], a[144:147], a[168:171], v[120:123]
buffer_store_dwordx2 v[104:105], v8, s[4:7], s83 offen offset:1024 sc1
v_mfma_f32_16x16x32_bf16 v[120:123], a[148:151], a[164:167], v[120:123]
v_lshlrev_b32 v10, 16, v46
v_fmac_f32 v108, v19, v10
v_mfma_f32_16x16x32_bf16 v[120:123], a[152:155], a[160:163], v[120:123]
s_waitcnt lgkmcnt(0)
v_and_b32 v11, 0xffff0000, v46
v_fmac_f32 v109, v19, v11
v_mfma_f32_16x16x32_bf16 v[124:127], a[128:131], a[188:191], v[124:127]
v_lshlrev_b32 v12, 16, v47
v_fmac_f32 v110, v19, v12
v_mfma_f32_16x16x32_bf16 v[124:127], a[132:135], a[184:187], v[124:127]
v_and_b32 v13, 0xffff0000, v47
v_fmac_f32 v111, v19, v13
v_mfma_f32_16x16x32_bf16 v[124:127], a[136:139], a[180:183], v[124:127]
v_cvt_pk_bf16_f32 v108, v108, v109
v_cvt_pk_bf16_f32 v109, v110, v111
v_mfma_f32_16x16x32_bf16 v[124:127], a[140:143], a[176:179], v[124:127]
buffer_store_dwordx2 v[108:109], v8, s[4:7], s83 offen offset:1536 sc1
v_mfma_f32_16x16x32_bf16 v[124:127], a[144:147], a[172:175], v[124:127]
v_lshlrev_b32 v10, 16, v52
v_fmac_f32 v112, v19, v10
v_mfma_f32_16x16x32_bf16 v[124:127], a[148:151], a[168:171], v[124:127]
v_and_b32 v11, 0xffff0000, v52
v_fmac_f32 v113, v19, v11
v_mfma_f32_16x16x32_bf16 v[124:127], a[152:155], a[164:167], v[124:127]
v_lshlrev_b32 v12, 16, v53
v_fmac_f32 v114, v19, v12
v_mfma_f32_16x16x32_bf16 v[124:127], a[156:159], a[160:163], v[124:127]
v_and_b32 v13, 0xffff0000, v53
v_fmac_f32 v115, v19, v13
v_cvt_pk_bf16_f32 v112, v112, v113
v_cvt_pk_bf16_f32 v113, v114, v115
buffer_store_dwordx2 v[112:113], v8, s[4:7], s83 offen offset:2048 sc1
v_lshlrev_b32 v10, 16, v54
v_fmac_f32 v116, v19, v10
v_and_b32 v11, 0xffff0000, v54
v_fmac_f32 v117, v19, v11
PAD_31:
s_cbranch_execz M_tret
v_lshlrev_b32 v12, 16, v55
v_fmac_f32 v118, v19, v12
v_and_b32 v13, 0xffff0000, v55
v_fmac_f32 v119, v19, v13
v_cvt_pk_bf16_f32 v116, v116, v117
v_cvt_pk_bf16_f32 v117, v118, v119
buffer_store_dwordx2 v[116:117], v8, s[4:7], s83 offen offset:2560 sc1
v_lshlrev_b32 v10, 16, v60
v_fmac_f32 v120, v19, v10
v_and_b32 v11, 0xffff0000, v60
v_fmac_f32 v121, v19, v11
v_lshlrev_b32 v12, 16, v61
v_fmac_f32 v122, v19, v12
v_and_b32 v13, 0xffff0000, v61
v_fmac_f32 v123, v19, v13
v_cvt_pk_bf16_f32 v120, v120, v121
v_cvt_pk_bf16_f32 v121, v122, v123
buffer_store_dwordx2 v[120:121], v8, s[4:7], s83 offen offset:3072 sc1
v_lshlrev_b32 v10, 16, v62
v_fmac_f32 v124, v19, v10
v_and_b32 v11, 0xffff0000, v62
v_fmac_f32 v125, v19, v11
v_lshlrev_b32 v12, 16, v63
v_fmac_f32 v126, v19, v12
v_and_b32 v13, 0xffff0000, v63
v_fmac_f32 v127, v19, v13
v_cvt_pk_bf16_f32 v124, v124, v125
v_cvt_pk_bf16_f32 v125, v126, v127
buffer_store_dwordx2 v[124:125], v8, s[4:7], s83 offen offset:3584 sc1
v_lshrrev_b32 v8, 7, v1
v_and_b32 v9, 6, v8
v_lshlrev_b32 v9, 4, v9
v_and_b32 v10, 0x70, v1
v_xor_b32 v9, v9, v10
v_mul_u32_u24 v8, 896, v8
v_add_u32 v8, v8, v9
v_accvgpr_write_b32 a184, v8
v_add_u32 v8, 6144, v8
v_accvgpr_write_b32 a185, v8
v_add_u32 v8, 6144, v8
v_accvgpr_write_b32 a186, v8
v_add_u32 v8, 6144, v8
v_accvgpr_write_b32 a187, v8
v_lshrrev_b32 v8, 6, v1
v_bfe_u32 v9, v1, 7, 2
v_lshlrev_b32 v9, 5, v9
v_lshl_add_u32 v8, v8, 7, v9
v_bfe_u32 v9, v1, 4, 2
v_lshl_add_u32 v8, v9, 3, v8
v_add_u32 v8, 32768, v8
v_accvgpr_write_b32 a188, v8
v_xor_b32 v9, 32, v8
v_accvgpr_write_b32 a189, v9
v_xor_b32 v9, 64, v8
v_accvgpr_write_b32 a190, v9
v_xor_b32 v9, 96, v8
v_accvgpr_write_b32 a191, v9
s_branch M_t2B
M_t2Br:
s_waitcnt vmcnt(8)
s_barrier
s_cmp_lg_u32 s24, 0
s_cbranch_scc1 K2_item
v_accvgpr_mov_b32 a0, a192
v_accvgpr_mov_b32 a1, a193
v_accvgpr_mov_b32 a2, a194
v_accvgpr_mov_b32 a3, a195
v_accvgpr_mov_b32 a4, a196
v_accvgpr_mov_b32 a5, a197
v_accvgpr_mov_b32 a6, a198
v_accvgpr_mov_b32 a7, a199
v_accvgpr_mov_b32 a8, a200
v_accvgpr_mov_b32 a9, a201
v_accvgpr_mov_b32 a10, a202
v_accvgpr_mov_b32 a11, a203
v_accvgpr_mov_b32 a12, a204
v_accvgpr_mov_b32 a13, a205
v_accvgpr_mov_b32 a14, a206
v_accvgpr_mov_b32 a15, a207
v_accvgpr_mov_b32 a16, a208
v_accvgpr_mov_b32 a17, a209
v_accvgpr_mov_b32 a18, a210
v_accvgpr_mov_b32 a19, a211
v_accvgpr_mov_b32 a20, a212
v_accvgpr_mov_b32 a21, a213
v_accvgpr_mov_b32 a22, a214
v_accvgpr_mov_b32 a23, a215
v_accvgpr_mov_b32 a24, a216
v_accvgpr_mov_b32 a25, a217
v_accvgpr_mov_b32 a26, a218
v_accvgpr_mov_b32 a27, a219
v_accvgpr_mov_b32 a28, a220
v_accvgpr_mov_b32 a29, a221
v_accvgpr_mov_b32 a30, a222
v_accvgpr_mov_b32 a31, a223
v_accvgpr_mov_b32 a32, a224
v_accvgpr_mov_b32 a33, a225
v_accvgpr_mov_b32 a34, a226
v_accvgpr_mov_b32 a35, a227
v_accvgpr_mov_b32 a36, a228
v_accvgpr_mov_b32 a37, a229
v_accvgpr_mov_b32 a38, a230
v_accvgpr_mov_b32 a39, a231
v_accvgpr_mov_b32 a40, a232
v_accvgpr_mov_b32 a41, a233
v_accvgpr_mov_b32 a42, a234
v_accvgpr_mov_b32 a43, a235
v_accvgpr_mov_b32 a44, a236
v_accvgpr_mov_b32 a45, a237
v_accvgpr_mov_b32 a46, a238
v_accvgpr_mov_b32 a47, a239
v_accvgpr_mov_b32 a48, a240
v_accvgpr_mov_b32 a49, a241
v_accvgpr_mov_b32 a50, a242
v_accvgpr_mov_b32 a51, a243
v_accvgpr_mov_b32 a52, a244
v_accvgpr_mov_b32 a53, a245
v_accvgpr_mov_b32 a54, a246
v_accvgpr_mov_b32 a55, a247
v_accvgpr_mov_b32 a56, a248
v_accvgpr_mov_b32 a57, a249
v_accvgpr_mov_b32 a58, a250
v_accvgpr_mov_b32 a59, a251
v_accvgpr_mov_b32 a60, a252
v_accvgpr_mov_b32 a61, a253
v_accvgpr_mov_b32 a62, a254
v_accvgpr_mov_b32 a63, a255
s_branch K2_item
M_cend:
M_cspin:
Lp_16:
buffer_load_dword v14, v15, s[4:7], s31 offen sc1
s_waitcnt vmcnt(0)
v_cmp_gt_u32 vcc, 1, v14
s_cbranch_vccz Lpd_17
s_sleep 8
s_sub_u32 s101, s101, 1
s_cbranch_scc0 Lp_16
s_mov_b32 s101, 0
Lpd_17:
s_branch M_cok
M_kspin:
Lp_18:
buffer_load_dword v21, v20, s[4:7], s70 offen sc1
s_waitcnt vmcnt(0)
v_cmp_gt_u32 vcc, 1, v21
s_cbranch_vccz Lpd_19
s_sleep 8
s_sub_u32 s101, s101, 1
s_cbranch_scc0 Lp_18
s_mov_b32 s101, 0
Lpd_19:
s_branch M_kok
M_kspin2:
Lp_20:
buffer_load_dword v21, v20, s[4:7], s31 offen sc1
s_waitcnt vmcnt(0)
v_cmp_gt_u32 vcc, 1, v21
s_cbranch_vccz Lpd_21
s_sleep 8
s_sub_u32 s101, s101, 1
s_cbranch_scc0 Lp_20
s_mov_b32 s101, 0
Lpd_21:
s_branch M_kok2
M_vspin:
Lp_22:
buffer_load_dword v21, v15, s[4:7], s70 offen sc1
s_waitcnt vmcnt(0)
v_cmp_gt_u32 vcc, 1, v21
s_cbranch_vccz Lpd_23
s_sleep 8
s_sub_u32 s101, s101, 1
s_cbranch_scc0 Lp_22
s_mov_b32 s101, 0
Lpd_23:
s_branch M_vok
PAD_32:
s_cbranch_execz M_tret
K2_plain:
v_mfma_f32_16x16x32_bf16 v[128:131], a[64:67], v[96:99], v[128:131]
s_waitcnt lgkmcnt(6)
ds_read_b128 a[96:99], v2 offset:8192
v_add_f32 v24, v24, v26
v_mfma_f32_16x16x32_bf16 v[128:131], a[68:71], v[100:103], v[128:131]
s_waitcnt lgkmcnt(5)
v_mfma_f32_16x16x32_bf16 v[132:135], a[68:71], v[108:111], v[132:135]
s_mov_b64 s[36:37], s[86:87]
ds_read_b128 a[100:103], v2 offset:9216
v_add_f32 v25, v25, v27
v_mfma_f32_16x16x32_bf16 v[132:135], a[64:67], v[104:107], v[132:135]
s_mov_b32 s38, 3670016
v_exp_f32 v8, v68
v_mfma_f32_16x16x32_bf16 v[136:139], a[72:75], v[96:99], v[136:139]
s_mov_b32 s39, 0x20000
ds_read_b128 a[104:107], v2 offset:10240
v_accvgpr_read_b32 v112, a184
v_mfma_f32_16x16x32_bf16 v[136:139], a[76:79], v[100:103], v[136:139]
v_accvgpr_read_b32 v113, a185
v_accvgpr_read_b32 v114, a186
v_mfma_f32_16x16x32_bf16 v[140:143], a[76:79], v[108:111], v[140:143]
ds_read_b128 a[108:111], v2 offset:11264
v_accvgpr_read_b32 v115, a187
v_mfma_f32_16x16x32_bf16 v[140:143], a[72:75], v[104:107], v[140:143]
s_waitcnt lgkmcnt(5)
v_accvgpr_read_b32 v116, a188
v_accvgpr_read_b32 v117, a189
v_mfma_f32_16x16x32_bf16 v[144:147], a[80:83], v[96:99], v[144:147]
ds_read_b128 a[112:115], v2 offset:12288
v_accvgpr_read_b32 v118, a190
v_mfma_f32_16x16x32_bf16 v[144:147], a[84:87], v[100:103], v[144:147]
v_accvgpr_read_b32 v119, a191
v_mfma_f32_16x16x32_bf16 v[148:151], a[84:87], v[108:111], v[148:151]
s_add_u32 m0, s18, 32768
ds_read_b128 a[116:119], v2 offset:13312
v_cvt_pk_bf16_f32 v128, v128, v129
v_mfma_f32_16x16x32_bf16 v[148:151], a[80:83], v[104:107], v[148:151]
buffer_load_dwordx4 v112, s[36:39], s81 offen offset:0 lds
v_mfma_f32_16x16x32_bf16 v[152:155], a[88:91], v[96:99], v[152:155]
s_waitcnt lgkmcnt(4)
ds_read_b128 a[120:123], v2 offset:14336
v_cvt_pk_bf16_f32 v129, v130, v131
v_mfma_f32_16x16x32_bf16 v[152:155], a[92:95], v[100:103], v[152:155]
v_exp_f32 v9, v69
v_mfma_f32_16x16x32_bf16 v[156:159], a[92:95], v[108:111], v[156:159]
ds_read_b128 a[124:127], v2 offset:15360
v_add_f32 v27, v8, v9
v_mfma_f32_16x16x32_bf16 v[156:159], a[88:91], v[104:107], v[156:159]
buffer_load_dwordx4 v113, s[36:39], s81 offen offset:1024 lds
v_mfma_f32_16x16x32_bf16 v[160:163], a[96:99], v[96:99], v[160:163]
ds_read_b128 a[64:67], v2 offset:16384
v_cvt_pk_bf16_f32 v120, v8, v9
v_mfma_f32_16x16x32_bf16 v[160:163], a[100:103], v[100:103], v[160:163]
v_exp_f32 v10, v70
v_mfma_f32_16x16x32_bf16 v[164:167], a[100:103], v[108:111], v[164:167]
ds_read_b128 a[68:71], v2 offset:17408
v_add_f32 v27, v27, v10
v_mfma_f32_16x16x32_bf16 v[164:167], a[96:99], v[104:107], v[164:167]
s_waitcnt lgkmcnt(4)
buffer_load_dwordx4 v114, s[36:39], s81 offen offset:2048 lds
v_mfma_f32_16x16x32_bf16 v[168:171], a[104:107], v[96:99], v[168:171]
ds_read_b128 a[72:75], v2 offset:18432
v_cvt_pk_bf16_f32 v130, v136, v137
v_mfma_f32_16x16x32_bf16 v[168:171], a[108:111], v[100:103], v[168:171]
v_exp_f32 v11, v71
v_mfma_f32_16x16x32_bf16 v[172:175], a[108:111], v[108:111], v[172:175]
ds_read_b128 a[76:79], v2 offset:19456
v_add_f32 v27, v27, v11
v_mfma_f32_16x16x32_bf16 v[172:175], a[104:107], v[104:107], v[172:175]
buffer_load_dwordx4 v115, s[36:39], s81 offen offset:3072 lds
v_mfma_f32_16x16x32_bf16 v[176:179], a[112:115], v[96:99], v[176:179]
ds_read_b128 a[80:83], v2 offset:20480
v_cvt_pk_bf16_f32 v121, v10, v11
v_mfma_f32_16x16x32_bf16 v[176:179], a[116:119], v[100:103], v[176:179]
s_waitcnt lgkmcnt(4)
v_exp_f32 v12, v76
v_mfma_f32_16x16x32_bf16 v[180:183], a[116:119], v[108:111], v[180:183]
s_add_u32 s81, s81, 28672
ds_read_b128 a[84:87], v2 offset:21504
v_add_f32 v27, v27, v12
v_mfma_f32_16x16x32_bf16 v[180:183], a[112:115], v[104:107], v[180:183]
s_add_u32 m0, s18, 36864
v_exp_f32 v13, v77
v_mfma_f32_16x16x32_bf16 v[184:187], a[120:123], v[96:99], v[184:187]
ds_read_b128 a[88:91], v2 offset:22528
v_add_f32 v27, v27, v13
v_mfma_f32_16x16x32_bf16 v[184:187], a[124:127], v[100:103], v[184:187]
buffer_load_dwordx4 v112, s[36:39], s81 offen offset:0 lds
v_mfma_f32_16x16x32_bf16 v[188:191], a[124:127], v[108:111], v[188:191]
ds_read_b128 a[92:95], v2 offset:23552
v_cvt_pk_bf16_f32 v122, v12, v13
v_mfma_f32_16x16x32_bf16 v[188:191], a[120:123], v[104:107], v[188:191]
v_exp_f32 v14, v78
v_mfma_f32_16x16x32_bf16 v[192:195], a[64:67], v[96:99], v[192:195]
s_waitcnt lgkmcnt(4)
ds_read_b128 a[96:99], v2 offset:24576
v_add_f32 v27, v27, v14
v_mfma_f32_16x16x32_bf16 v[192:195], a[68:71], v[100:103], v[192:195]
buffer_load_dwordx4 v113, s[36:39], s81 offen offset:1024 lds
v_mfma_f32_16x16x32_bf16 v[196:199], a[68:71], v[108:111], v[196:199]
ds_read_b128 a[100:103], v2 offset:25600
v_cvt_pk_bf16_f32 v131, v138, v139
v_mfma_f32_16x16x32_bf16 v[196:199], a[64:67], v[104:107], v[196:199]
v_exp_f32 v15, v79
v_mfma_f32_16x16x32_bf16 v[200:203], a[72:75], v[96:99], v[200:203]
ds_read_b128 a[104:107], v2 offset:26624
v_add_f32 v27, v27, v15
v_mfma_f32_16x16x32_bf16 v[200:203], a[76:79], v[100:103], v[200:203]
buffer_load_dwordx4 v114, s[36:39], s81 offen offset:2048 lds
v_mfma_f32_16x16x32_bf16 v[204:207], a[76:79], v[108:111], v[204:207]
ds_read_b128 a[108:111], v2 offset:27648
v_cvt_pk_bf16_f32 v123, v14, v15
v_mfma_f32_16x16x32_bf16 v[204:207], a[72:75], v[104:107], v[204:207]
s_waitcnt lgkmcnt(4)
v_exp_f32 v8, v84
v_mfma_f32_16x16x32_bf16 v[208:211], a[80:83], v[96:99], v[208:211]
ds_read_b128 a[112:115], v2 offset:28672
v_add_f32 v27, v27, v8
v_mfma_f32_16x16x32_bf16 v[208:211], a[84:87], v[100:103], v[208:211]
buffer_load_dwordx4 v115, s[36:39], s81 offen offset:3072 lds
v_mfma_f32_16x16x32_bf16 v[212:215], a[84:87], v[108:111], v[212:215]
ds_read_b128 a[116:119], v2 offset:29696
v_cvt_pk_bf16_f32 v144, v144, v145
v_mfma_f32_16x16x32_bf16 v[212:215], a[80:83], v[104:107], v[212:215]
v_exp_f32 v9, v85
v_mfma_f32_16x16x32_bf16 v[216:219], a[88:91], v[96:99], v[216:219]
s_sub_u32 s81, s81, 28544
ds_read_b128 a[120:123], v2 offset:30720
v_add_f32 v27, v27, v9
v_mfma_f32_16x16x32_bf16 v[216:219], a[92:95], v[100:103], v[216:219]
v_exp_f32 v10, v86
v_mfma_f32_16x16x32_bf16 v[220:223], a[92:95], v[108:111], v[220:223]
s_waitcnt vmcnt(8) lgkmcnt(4)
ds_read_b128 a[124:127], v2 offset:31744
v_cvt_pk_bf16_f32 v124, v8, v9
v_mfma_f32_16x16x32_bf16 v[220:223], a[88:91], v[104:107], v[220:223]
s_barrier
v_mfma_f32_16x16x32_bf16 v[224:227], a[96:99], v[96:99], v[224:227]
ds_read_b128 a[64:67], v1 offset:0
v_add_f32 v27, v27, v10
v_mfma_f32_16x16x32_bf16 v[224:227], a[100:103], v[100:103], v[224:227]
v_exp_f32 v11, v87
v_mfma_f32_16x16x32_bf16 v[228:231], a[100:103], v[108:111], v[228:231]
ds_read_b128 a[68:71], v1 offset:1024
v_add_f32 v27, v27, v11
v_mfma_f32_16x16x32_bf16 v[228:231], a[96:99], v[104:107], v[228:231]
v_exp_f32 v12, v92
v_mfma_f32_16x16x32_bf16 v[232:235], a[104:107], v[96:99], v[232:235]
s_waitcnt lgkmcnt(4)
ds_read_b128 a[72:75], v1 offset:2048
v_cvt_pk_bf16_f32 v125, v10, v11
v_mfma_f32_16x16x32_bf16 v[232:235], a[108:111], v[100:103], v[232:235]
v_exp_f32 v13, v93
v_mfma_f32_16x16x32_bf16 v[236:239], a[108:111], v[108:111], v[236:239]
ds_read_b128 a[76:79], v1 offset:3072
v_add_f32 v27, v27, v12
v_mfma_f32_16x16x32_bf16 v[236:239], a[104:107], v[104:107], v[236:239]
v_exp_f32 v14, v94
v_mfma_f32_16x16x32_bf16 v[240:243], a[112:115], v[96:99], v[240:243]
ds_read_b128 a[80:83], v1 offset:4096
v_add_f32 v27, v27, v13
v_mfma_f32_16x16x32_bf16 v[240:243], a[116:119], v[100:103], v[240:243]
v_exp_f32 v15, v95
v_mfma_f32_16x16x32_bf16 v[244:247], a[116:119], v[108:111], v[244:247]
ds_read_b128 a[84:87], v1 offset:5120
v_cvt_pk_bf16_f32 v126, v12, v13
v_mfma_f32_16x16x32_bf16 v[244:247], a[112:115], v[104:107], v[244:247]
s_waitcnt lgkmcnt(4)
v_add_f32 v27, v27, v14
v_add_f32 v27, v27, v15
v_mfma_f32_16x16x32_bf16 v[248:251], a[120:123], v[96:99], v[248:251]
ds_read_b128 a[88:91], v1 offset:6144
v_cvt_pk_bf16_f32 v127, v14, v15
v_mfma_f32_16x16x32_bf16 v[248:251], a[124:127], v[100:103], v[248:251]
v_cmp_nge_f32 vcc, s25, v27
v_cvt_pk_bf16_f32 v145, v146, v147
v_mfma_f32_16x16x32_bf16 v[252:255], a[124:127], v[108:111], v[252:255]
ds_read_b128 a[92:95], v1 offset:7168
v_cvt_pk_bf16_f32 v146, v152, v153
v_mfma_f32_16x16x32_bf16 v[252:255], a[120:123], v[104:107], v[252:255]
s_waitcnt lgkmcnt(2)
v_cvt_pk_bf16_f32 v147, v154, v155
v_cvt_pk_bf16_f32 v160, v160, v161
s_cbranch_vccnz Lstub_12
Lback_13:
v_mfma_f32_16x16x32_bf16 v[132:135], a[64:67], v[120:123], v[132:135]
s_lshl_b32 s8, s29, 3
ds_read_b128 a[96:99], v1 offset:8192
v_add_f32 v25, v25, v27
v_mfma_f32_16x16x32_bf16 v[132:135], a[68:71], v[124:127], v[132:135]
s_add_u32 s8, s8, s3
ds_read_b128 a[100:103], v1 offset:9216
v_cvt_pk_bf16_f32 v161, v162, v163
v_mfma_f32_16x16x32_bf16 v[140:143], a[72:75], v[120:123], v[140:143]
s_lshl_b32 s8, s8, 4
ds_read_b128 a[104:107], v1 offset:10240
v_cvt_pk_bf16_f32 v162, v168, v169
v_mfma_f32_16x16x32_bf16 v[140:143], a[76:79], v[124:127], v[140:143]
s_add_u32 s8, s8, s20
ds_read_b128 a[108:111], v1 offset:11264
v_cvt_pk_bf16_f32 v163, v170, v171
v_mfma_f32_16x16x32_bf16 v[148:151], a[80:83], v[120:123], v[148:151]
s_mul_i32 s8, s8, 14336
ds_read_b128 a[112:115], v1 offset:12288
v_cvt_pk_bf16_f32 v176, v176, v177
v_mfma_f32_16x16x32_bf16 v[148:151], a[84:87], v[124:127], v[148:151]
s_waitcnt lgkmcnt(5)
s_add_u32 s8, s8, 104857600
ds_read_b128 a[116:119], v1 offset:13312
v_cvt_pk_bf16_f32 v177, v178, v179
v_mfma_f32_16x16x32_bf16 v[156:159], a[88:91], v[120:123], v[156:159]
s_add_u32 s12, s8, 917504
ds_read_b128 a[120:123], v1 offset:14336
v_cvt_pk_bf16_f32 v178, v184, v185
v_mfma_f32_16x16x32_bf16 v[156:159], a[92:95], v[124:127], v[156:159]
s_waitcnt lgkmcnt(6)
ds_read_b128 a[124:127], v1 offset:15360
v_cvt_pk_bf16_f32 v179, v186, v187
v_mfma_f32_16x16x32_bf16 v[164:167], a[96:99], v[120:123], v[164:167]
s_waitcnt lgkmcnt(6)
ds_read_b128 a[64:67], v1 offset:16384
v_cvt_pk_bf16_f32 v192, v192, v193
v_mfma_f32_16x16x32_bf16 v[164:167], a[100:103], v[124:127], v[164:167]
s_waitcnt lgkmcnt(6)
ds_read_b128 a[68:71], v1 offset:17408
v_cvt_pk_bf16_f32 v193, v194, v195
v_mfma_f32_16x16x32_bf16 v[172:175], a[104:107], v[120:123], v[172:175]
s_waitcnt lgkmcnt(6)
ds_read_b128 a[72:75], v1 offset:18432
v_cvt_pk_bf16_f32 v194, v200, v201
v_mfma_f32_16x16x32_bf16 v[172:175], a[108:111], v[124:127], v[172:175]
s_waitcnt lgkmcnt(6)
ds_read_b128 a[76:79], v1 offset:19456
v_cvt_pk_bf16_f32 v195, v202, v203
v_mfma_f32_16x16x32_bf16 v[180:183], a[112:115], v[120:123], v[180:183]
s_waitcnt lgkmcnt(6)
ds_read_b128 a[80:83], v1 offset:20480
v_cvt_pk_bf16_f32 v208, v208, v209
v_mfma_f32_16x16x32_bf16 v[180:183], a[116:119], v[124:127], v[180:183]
s_waitcnt lgkmcnt(6)
ds_read_b128 a[84:87], v1 offset:21504
v_cvt_pk_bf16_f32 v209, v210, v211
v_mfma_f32_16x16x32_bf16 v[188:191], a[120:123], v[120:123], v[188:191]
s_waitcnt lgkmcnt(6)
ds_read_b128 a[88:91], v1 offset:22528
v_cvt_pk_bf16_f32 v210, v216, v217
v_mfma_f32_16x16x32_bf16 v[188:191], a[124:127], v[124:127], v[188:191]
s_waitcnt lgkmcnt(6)
ds_read_b128 a[92:95], v1 offset:23552
v_cvt_pk_bf16_f32 v211, v218, v219
v_mfma_f32_16x16x32_bf16 v[196:199], a[64:67], v[120:123], v[196:199]
s_waitcnt lgkmcnt(6)
ds_read_b128 a[96:99], v1 offset:24576
v_cvt_pk_bf16_f32 v224, v224, v225
v_mfma_f32_16x16x32_bf16 v[196:199], a[68:71], v[124:127], v[196:199]
s_waitcnt lgkmcnt(6)
ds_read_b128 a[100:103], v1 offset:25600
v_cvt_pk_bf16_f32 v225, v226, v227
v_mfma_f32_16x16x32_bf16 v[204:207], a[72:75], v[120:123], v[204:207]
s_waitcnt lgkmcnt(6)
ds_read_b128 a[104:107], v1 offset:26624
v_cvt_pk_bf16_f32 v226, v232, v233
v_mfma_f32_16x16x32_bf16 v[204:207], a[76:79], v[124:127], v[204:207]
s_waitcnt lgkmcnt(6)
ds_read_b128 a[108:111], v1 offset:27648
v_cvt_pk_bf16_f32 v227, v234, v235
v_mfma_f32_16x16x32_bf16 v[212:215], a[80:83], v[120:123], v[212:215]
s_waitcnt lgkmcnt(6)
ds_read_b128 a[112:115], v1 offset:28672
v_cvt_pk_bf16_f32 v240, v240, v241
v_mfma_f32_16x16x32_bf16 v[212:215], a[84:87], v[124:127], v[212:215]
s_waitcnt lgkmcnt(5)
ds_read_b128 a[116:119], v1 offset:29696
v_cvt_pk_bf16_f32 v241, v242, v243
v_mfma_f32_16x16x32_bf16 v[220:223], a[88:91], v[120:123], v[220:223]
s_add_u32 m0, s18, 98304
ds_read_b128 a[120:123], v1 offset:30720
v_cvt_pk_bf16_f32 v242, v248, v249
v_mfma_f32_16x16x32_bf16 v[220:223], a[92:95], v[124:127], v[220:223]
s_waitcnt lgkmcnt(6)
ds_read_b128 a[124:127], v1 offset:31744
v_cvt_pk_bf16_f32 v243, v250, v251
v_mfma_f32_16x16x32_bf16 v[228:231], a[96:99], v[120:123], v[228:231]
s_waitcnt lgkmcnt(6)
buffer_load_dwordx4 v112, s[36:39], s81 offen offset:0 lds
v_mfma_f32_16x16x32_bf16 v[228:231], a[100:103], v[124:127], v[228:231]
s_waitcnt lgkmcnt(5)
buffer_load_dwordx4 v113, s[36:39], s81 offen offset:1024 lds
v_mfma_f32_16x16x32_bf16 v[236:239], a[104:107], v[120:123], v[236:239]
s_waitcnt lgkmcnt(4)
buffer_load_dwordx4 v114, s[36:39], s81 offen offset:2048 lds
v_mfma_f32_16x16x32_bf16 v[236:239], a[108:111], v[124:127], v[236:239]
s_waitcnt lgkmcnt(1)
buffer_load_dwordx4 v115, s[36:39], s81 offen offset:3072 lds
v_mfma_f32_16x16x32_bf16 v[244:247], a[112:115], v[120:123], v[244:247]
s_add_u32 s81, s81, 28672
v_cvt_pk_bf16_f32 v132, v132, v133
v_cvt_pk_bf16_f32 v133, v134, v135
v_mfma_f32_16x16x32_bf16 v[244:247], a[116:119], v[124:127], v[244:247]
s_add_u32 m0, s18, 102400
v_cvt_pk_bf16_f32 v134, v140, v141
v_cvt_pk_bf16_f32 v135, v142, v143
v_mfma_f32_16x16x32_bf16 v[252:255], a[120:123], v[120:123], v[252:255]
s_waitcnt lgkmcnt(0)
buffer_load_dwordx4 v112, s[36:39], s81 offen offset:0 lds
v_mfma_f32_16x16x32_bf16 v[252:255], a[124:127], v[124:127], v[252:255]
buffer_load_dwordx4 v113, s[36:39], s81 offen offset:1024 lds
buffer_load_dwordx4 v114, s[36:39], s81 offen offset:2048 lds
buffer_load_dwordx4 v115, s[36:39], s81 offen offset:3072 lds
s_sub_u32 s81, s81, 28544
s_waitcnt vmcnt(8)
s_barrier
ds_read_b64_tr_b16 a[64:65], v116 offset:0
ds_read_b64_tr_b16 a[66:67], v116 offset:2048
ds_read_b64_tr_b16 a[68:69], v116 offset:4096
ds_read_b64_tr_b16 a[70:71], v116 offset:6144
v_cvt_pk_bf16_f32 v148, v148, v149
v_cvt_pk_bf16_f32 v149, v150, v151
v_cvt_pk_bf16_f32 v150, v156, v157
v_cvt_pk_bf16_f32 v151, v158, v159
ds_read_b64_tr_b16 a[72:73], v116 offset:8192
ds_read_b64_tr_b16 a[74:75], v116 offset:10240
ds_read_b64_tr_b16 a[76:77], v116 offset:12288
ds_read_b64_tr_b16 a[78:79], v116 offset:14336
v_cvt_pk_bf16_f32 v164, v164, v165
v_cvt_pk_bf16_f32 v165, v166, v167
v_cvt_pk_bf16_f32 v166, v172, v173
v_cvt_pk_bf16_f32 v167, v174, v175
ds_read_b64_tr_b16 a[80:81], v116 offset:16384
ds_read_b64_tr_b16 a[82:83], v116 offset:18432
ds_read_b64_tr_b16 a[84:85], v116 offset:20480
ds_read_b64_tr_b16 a[86:87], v116 offset:22528
v_cvt_pk_bf16_f32 v180, v180, v181
v_cvt_pk_bf16_f32 v181, v182, v183
v_cvt_pk_bf16_f32 v182, v188, v189
v_cvt_pk_bf16_f32 v183, v190, v191
ds_read_b64_tr_b16 a[88:89], v116 offset:24576
ds_read_b64_tr_b16 a[90:91], v116 offset:26624
ds_read_b64_tr_b16 a[92:93], v116 offset:28672
ds_read_b64_tr_b16 a[94:95], v116 offset:30720
v_cvt_pk_bf16_f32 v196, v196, v197
v_cvt_pk_bf16_f32 v197, v198, v199
v_cvt_pk_bf16_f32 v198, v204, v205
v_cvt_pk_bf16_f32 v199, v206, v207
v_cvt_pk_bf16_f32 v212, v212, v213
v_cvt_pk_bf16_f32 v213, v214, v215
v_cvt_pk_bf16_f32 v214, v220, v221
v_cvt_pk_bf16_f32 v215, v222, v223
v_cvt_pk_bf16_f32 v228, v228, v229
v_cvt_pk_bf16_f32 v229, v230, v231
v_cvt_pk_bf16_f32 v230, v236, v237
v_cvt_pk_bf16_f32 v231, v238, v239
v_cvt_pk_bf16_f32 v244, v244, v245
v_cvt_pk_bf16_f32 v245, v246, v247
v_cvt_pk_bf16_f32 v246, v252, v253
v_cvt_pk_bf16_f32 v247, v254, v255
v_add_u32 v116, 65536, v116
s_branch K2_done
K2_cfix:
s_nop 7
v_max_f32 v12, 0, v8
v_exp_f32 v13, -v12
v_sub_f32 v8, v8, v12
v_mul_f32 v24, v24, v13
v_mul_f32 v128, v128, v13
v_mul_f32 v129, v129, v13
v_mul_f32 v130, v130, v13
v_mul_f32 v131, v131, v13
v_mul_f32 v136, v136, v13
v_mul_f32 v137, v137, v13
v_mul_f32 v138, v138, v13
v_mul_f32 v139, v139, v13
v_mul_f32 v144, v144, v13
v_mul_f32 v145, v145, v13
v_mul_f32 v146, v146, v13
v_mul_f32 v147, v147, v13
v_mul_f32 v152, v152, v13
v_mul_f32 v153, v153, v13
v_mul_f32 v154, v154, v13
v_mul_f32 v155, v155, v13
v_mul_f32 v160, v160, v13
v_mul_f32 v161, v161, v13
v_mul_f32 v162, v162, v13
v_mul_f32 v163, v163, v13
v_mul_f32 v168, v168, v13
v_mul_f32 v169, v169, v13
v_mul_f32 v170, v170, v13
v_mul_f32 v171, v171, v13
v_mul_f32 v176, v176, v13
v_mul_f32 v177, v177, v13
v_mul_f32 v178, v178, v13
v_mul_f32 v179, v179, v13
v_mul_f32 v184, v184, v13
v_mul_f32 v185, v185, v13
v_mul_f32 v186, v186, v13
v_mul_f32 v187, v187, v13
v_mul_f32 v192, v192, v13
v_mul_f32 v193, v193, v13
v_mul_f32 v194, v194, v13
v_mul_f32 v195, v195, v13
v_mul_f32 v200, v200, v13
v_mul_f32 v201, v201, v13
v_mul_f32 v202, v202, v13
v_mul_f32 v203, v203, v13
v_mul_f32 v208, v208, v13
v_mul_f32 v209, v209, v13
v_mul_f32 v210, v210, v13
v_mul_f32 v211, v211, v13
v_mul_f32 v216, v216, v13
v_mul_f32 v217, v217, v13
v_mul_f32 v218, v218, v13
v_mul_f32 v219, v219, v13
v_mul_f32 v224, v224, v13
v_mul_f32 v225, v225, v13
v_mul_f32 v226, v226, v13
v_mul_f32 v227, v227, v13
v_mul_f32 v232, v232, v13
v_mul_f32 v233, v233, v13
v_mul_f32 v234, v234, v13
v_mul_f32 v235, v235, v13
v_mul_f32 v240, v240, v13
v_mul_f32 v241, v241, v13
v_mul_f32 v242, v242, v13
v_mul_f32 v243, v243, v13
v_mul_f32 v248, v248, v13
v_mul_f32 v249, v249, v13
v_mul_f32 v250, v250, v13
v_mul_f32 v251, v251, v13
v_max_f32 v12, 0, v10
v_exp_f32 v13, -v12
v_sub_f32 v10, v10, v12
v_mul_f32 v25, v25, v13
v_mul_f32 v132, v132, v13
v_mul_f32 v133, v133, v13
v_mul_f32 v134, v134, v13
v_mul_f32 v135, v135, v13
v_mul_f32 v140, v140, v13
v_mul_f32 v141, v141, v13
v_mul_f32 v142, v142, v13
v_mul_f32 v143, v143, v13
v_mul_f32 v148, v148, v13
v_mul_f32 v149, v149, v13
v_mul_f32 v150, v150, v13
v_mul_f32 v151, v151, v13
v_mul_f32 v156, v156, v13
v_mul_f32 v157, v157, v13
v_mul_f32 v158, v158, v13
v_mul_f32 v159, v159, v13
v_mul_f32 v164, v164, v13
v_mul_f32 v165, v165, v13
v_mul_f32 v166, v166, v13
v_mul_f32 v167, v167, v13
v_mul_f32 v172, v172, v13
v_mul_f32 v173, v173, v13
v_mul_f32 v174, v174, v13
v_mul_f32 v175, v175, v13
v_mul_f32 v180, v180, v13
v_mul_f32 v181, v181, v13
v_mul_f32 v182, v182, v13
v_mul_f32 v183, v183, v13
v_mul_f32 v188, v188, v13
v_mul_f32 v189, v189, v13
v_mul_f32 v190, v190, v13
v_mul_f32 v191, v191, v13
v_mul_f32 v196, v196, v13
v_mul_f32 v197, v197, v13
v_mul_f32 v198, v198, v13
v_mul_f32 v199, v199, v13
v_mul_f32 v204, v204, v13
v_mul_f32 v205, v205, v13
v_mul_f32 v206, v206, v13
v_mul_f32 v207, v207, v13
v_mul_f32 v212, v212, v13
v_mul_f32 v213, v213, v13
v_mul_f32 v214, v214, v13
v_mul_f32 v215, v215, v13
v_mul_f32 v220, v220, v13
v_mul_f32 v221, v221, v13
v_mul_f32 v222, v222, v13
v_mul_f32 v223, v223, v13
v_mul_f32 v228, v228, v13
v_mul_f32 v229, v229, v13
v_mul_f32 v230, v230, v13
v_mul_f32 v231, v231, v13
v_mul_f32 v236, v236, v13
v_mul_f32 v237, v237, v13
v_mul_f32 v238, v238, v13
v_mul_f32 v239, v239, v13
v_mul_f32 v244, v244, v13
v_mul_f32 v245, v245, v13
v_mul_f32 v246, v246, v13
v_mul_f32 v247, v247, v13
v_mul_f32 v252, v252, v13
v_mul_f32 v253, v253, v13
v_mul_f32 v254, v254, v13
v_mul_f32 v255, v255, v13
s_branch K2_cok
K2_tspin:
Lp_9101:
buffer_load_dword v3, off, s[4:7], s80 sc1
s_waitcnt vmcnt(0)
v_cmp_gt_u32 vcc, 1, v3
s_cbranch_vccz Lpd_9102
s_sleep 8
s_sub_u32 s101, s101, 1
s_cbranch_scc0 Lp_9101
s_mov_b32 s101, 0
Lpd_9102:
s_branch K2_tok
K2_p0d:
ds_read_b128 a[64:67], v1 offset:0
ds_read_b128 a[68:71], v1 offset:1024
ds_read_b128 a[72:75], v1 offset:2048
ds_read_b128 a[76:79], v1 offset:3072
ds_read_b128 a[80:83], v1 offset:4096
ds_read_b128 a[84:87], v1 offset:5120
ds_read_b128 a[88:91], v1 offset:6144
ds_read_b128 a[92:95], v1 offset:7168
v_cndmask_b32 v32, 0, v7, s[32:33]
v_cndmask_b32 v33, 0, v7, s[34:35]
v_cndmask_b32 v34, 0, v7, s[36:37]
v_cndmask_b32 v35, 0, v7, s[38:39]
v_cndmask_b32 v40, 0, v7, s[40:41]
v_cndmask_b32 v41, 0, v7, s[42:43]
v_cndmask_b32 v42, 0, v7, s[44:45]
v_cndmask_b32 v43, 0, v7, s[46:47]
s_waitcnt lgkmcnt(7)
v_mfma_f32_16x16x32_bf16 v[32:35], a[64:67], a[0:3], v[32:35]
s_waitcnt lgkmcnt(6)
s_add_u32 m0, s18, 65536
ds_read_b128 a[96:99], v1 offset:8192
v_mfma_f32_16x16x32_bf16 v[32:35], a[68:71], a[4:7], v[32:35]
s_waitcnt lgkmcnt(6)
buffer_load_dwordx4 v1, s[4:7], s12 offen offset:0 sc1 lds
v_mfma_f32_16x16x32_bf16 v[32:35], a[72:75], a[8:11], v[32:35]
s_waitcnt lgkmcnt(5)
ds_read_b128 a[100:103], v1 offset:9216
v_mfma_f32_16x16x32_bf16 v[32:35], a[76:79], a[12:15], v[32:35]
s_waitcnt lgkmcnt(5)
buffer_load_dwordx4 v1, s[4:7], s12 offen offset:1024 sc1 lds
v_mfma_f32_16x16x32_bf16 v[32:35], a[80:83], a[16:19], v[32:35]
s_waitcnt lgkmcnt(4)
ds_read_b128 a[104:107], v1 offset:10240
v_mfma_f32_16x16x32_bf16 v[32:35], a[84:87], a[20:23], v[32:35]
s_waitcnt lgkmcnt(4)
buffer_load_dwordx4 v1, s[4:7], s12 offen offset:2048 sc1 lds
v_mfma_f32_16x16x32_bf16 v[32:35], a[88:91], a[24:27], v[32:35]
s_waitcnt lgkmcnt(3)
ds_read_b128 a[108:111], v1 offset:11264
v_mfma_f32_16x16x32_bf16 v[32:35], a[92:95], a[28:31], v[32:35]
buffer_load_dwordx4 v1, s[4:7], s12 offen offset:3072 sc1 lds
v_mfma_f32_16x16x32_bf16 v[36:39], a[64:67], a[32:35], 0
s_add_u32 s12, s12, 4096
s_add_u32 m0, s18, 69632
ds_read_b128 a[112:115], v1 offset:12288
v_mfma_f32_16x16x32_bf16 v[36:39], a[68:71], a[36:39], v[36:39]
buffer_load_dwordx4 v1, s[4:7], s12 offen offset:0 sc1 lds
v_mfma_f32_16x16x32_bf16 v[36:39], a[72:75], a[40:43], v[36:39]
ds_read_b128 a[116:119], v1 offset:13312
v_mfma_f32_16x16x32_bf16 v[36:39], a[76:79], a[44:47], v[36:39]
buffer_load_dwordx4 v1, s[4:7], s12 offen offset:1024 sc1 lds
v_mfma_f32_16x16x32_bf16 v[36:39], a[80:83], a[48:51], v[36:39]
ds_read_b128 a[120:123], v1 offset:14336
v_max3_f32 v28, v32, v33, v34
v_mfma_f32_16x16x32_bf16 v[36:39], a[84:87], a[52:55], v[36:39]
buffer_load_dwordx4 v1, s[4:7], s12 offen offset:2048 sc1 lds
v_mfma_f32_16x16x32_bf16 v[36:39], a[88:91], a[56:59], v[36:39]
ds_read_b128 a[124:127], v1 offset:15360
v_max_f32 v28, v28, v35
v_mfma_f32_16x16x32_bf16 v[36:39], a[92:95], a[60:63], v[36:39]
s_waitcnt lgkmcnt(4)
buffer_load_dwordx4 v1, s[4:7], s12 offen offset:3072 sc1 lds
v_mfma_f32_16x16x32_bf16 v[40:43], a[96:99], a[0:3], v[40:43]
s_add_u32 s12, s12, 28672
ds_read_b128 a[64:67], v1 offset:16384
v_mov_b32 v30, v28
v_mfma_f32_16x16x32_bf16 v[40:43], a[100:103], a[4:7], v[40:43]
s_waitcnt lgkmcnt(2)
s_sub_u32 s13, s13, 1
v_mfma_f32_16x16x32_bf16 v[40:43], a[104:107], a[8:11], v[40:43]
s_cmp_eq_u32 s13, 0
ds_read_b128 a[68:71], v1 offset:17408
v_permlane16_swap_b32 v28, v30
v_mfma_f32_16x16x32_bf16 v[40:43], a[108:111], a[12:15], v[40:43]
s_cselect_b32 s12, s14, s12
v_max_f32 v28, v28, v30
v_mov_b32 v30, v28
v_mfma_f32_16x16x32_bf16 v[40:43], a[112:115], a[16:19], v[40:43]
s_cselect_b32 s13, s15, s13
ds_read_b128 a[72:75], v1 offset:18432
v_max3_f32 v29, v36, v37, v38
v_mfma_f32_16x16x32_bf16 v[40:43], a[116:119], a[20:23], v[40:43]
s_cselect_b32 s14, 3221225472, s14
v_permlane32_swap_b32 v28, v30
v_max_f32 v28, v28, v30
v_mfma_f32_16x16x32_bf16 v[40:43], a[120:123], a[24:27], v[40:43]
s_waitcnt lgkmcnt(3)
ds_read_b128 a[76:79], v1 offset:19456
v_sub_f32 v16, 0, v28
v_mfma_f32_16x16x32_bf16 v[40:43], a[124:127], a[28:31], v[40:43]
v_sub_f32 v17, 0, v28
v_sub_f32 v18, 0, v28
v_mfma_f32_16x16x32_bf16 v[44:47], a[96:99], a[32:35], 0
ds_read_b128 a[80:83], v1 offset:20480
v_sub_f32 v19, 0, v28
v_mfma_f32_16x16x32_bf16 v[44:47], a[100:103], a[36:39], v[44:47]
v_max_f32 v29, v29, v39
v_mov_b32 v31, v29
v_cndmask_b32 v48, v16, v7, s[48:49]
v_mfma_f32_16x16x32_bf16 v[44:47], a[104:107], a[40:43], v[44:47]
ds_read_b128 a[84:87], v1 offset:21504
v_cndmask_b32 v49, v16, v7, s[50:51]
v_mfma_f32_16x16x32_bf16 v[44:47], a[108:111], a[44:47], v[44:47]
v_permlane16_swap_b32 v29, v31
v_max_f32 v29, v29, v31
v_cndmask_b32 v50, v16, v7, s[52:53]
v_mfma_f32_16x16x32_bf16 v[44:47], a[112:115], a[48:51], v[44:47]
ds_read_b128 a[88:91], v1 offset:22528
v_mov_b32 v31, v29
v_cndmask_b32 v51, v16, v7, s[54:55]
v_mfma_f32_16x16x32_bf16 v[44:47], a[116:119], a[52:55], v[44:47]
v_cndmask_b32 v56, v16, v7, s[56:57]
v_cndmask_b32 v57, v16, v7, s[58:59]
v_mfma_f32_16x16x32_bf16 v[44:47], a[120:123], a[56:59], v[44:47]
ds_read_b128 a[92:95], v1 offset:23552
v_permlane32_swap_b32 v29, v31
v_mfma_f32_16x16x32_bf16 v[44:47], a[124:127], a[60:63], v[44:47]
s_waitcnt lgkmcnt(4)
v_max_f32 v29, v29, v31
v_sub_f32 v20, 0, v29
v_mfma_f32_16x16x32_bf16 v[48:51], a[64:67], a[0:3], v[48:51]
ds_read_b128 a[96:99], v1 offset:24576
v_sub_f32 v21, 0, v29
v_mfma_f32_16x16x32_bf16 v[48:51], a[68:71], a[4:7], v[48:51]
v_sub_f32 v22, 0, v29
v_sub_f32 v23, 0, v29
v_mfma_f32_16x16x32_bf16 v[48:51], a[72:75], a[8:11], v[48:51]
ds_read_b128 a[100:103], v1 offset:25600
v_cndmask_b32 v58, v16, v7, s[60:61]
v_mfma_f32_16x16x32_bf16 v[48:51], a[76:79], a[12:15], v[48:51]
s_waitcnt lgkmcnt(4)
v_cndmask_b32 v59, v16, v7, s[62:63]
v_mfma_f32_16x16x32_bf16 v[48:51], a[80:83], a[16:19], v[48:51]
ds_read_b128 a[104:107], v1 offset:26624
v_mfma_f32_16x16x32_bf16 v[48:51], a[84:87], a[20:23], v[48:51]
s_waitcnt lgkmcnt(4)
v_add_f32 v32, v32, v16
v_add_f32 v33, v33, v16
v_add_f32 v34, v34, v16
v_add_f32 v35, v35, v16
v_mfma_f32_16x16x32_bf16 v[48:51], a[88:91], a[24:27], v[48:51]
s_waitcnt lgkmcnt(3)
ds_read_b128 a[108:111], v1 offset:27648
v_add_f32 v36, v36, v20
v_add_f32 v37, v37, v20
v_add_f32 v38, v38, v20
v_add_f32 v39, v39, v20
v_mfma_f32_16x16x32_bf16 v[48:51], a[92:95], a[28:31], v[48:51]
v_add_f32 v40, v40, v16
v_add_f32 v41, v41, v16
v_add_f32 v42, v42, v16
v_add_f32 v43, v43, v16
v_mfma_f32_16x16x32_bf16 v[52:55], a[64:67], a[32:35], v[20:23]
ds_read_b128 a[112:115], v1 offset:28672
v_add_f32 v44, v44, v20
v_add_f32 v45, v45, v20
v_add_f32 v46, v46, v20
v_add_f32 v47, v47, v20
v_mfma_f32_16x16x32_bf16 v[52:55], a[68:71], a[36:39], v[52:55]
v_exp_f32 v8, v32
v_mfma_f32_16x16x32_bf16 v[52:55], a[72:75], a[40:43], v[52:55]
ds_read_b128 a[116:119], v1 offset:29696
v_exp_f32 v9, v33
v_exp_f32 v10, v34
v_mfma_f32_16x16x32_bf16 v[52:55], a[76:79], a[44:47], v[52:55]
v_exp_f32 v11, v35
v_add_f32 v26, v8, v9
v_cvt_pk_bf16_f32 v96, v8, v9
v_add_f32 v26, v26, v10
v_mfma_f32_16x16x32_bf16 v[52:55], a[80:83], a[48:51], v[52:55]
ds_read_b128 a[120:123], v1 offset:30720
v_exp_f32 v12, v36
v_add_f32 v26, v26, v11
v_cvt_pk_bf16_f32 v97, v10, v11
v_mfma_f32_16x16x32_bf16 v[52:55], a[84:87], a[52:55], v[52:55]
v_exp_f32 v13, v37
v_mfma_f32_16x16x32_bf16 v[52:55], a[88:91], a[56:59], v[52:55]
s_waitcnt vmcnt(8) lgkmcnt(4)
ds_read_b128 a[124:127], v1 offset:31744
v_exp_f32 v14, v38
v_add_f32 v27, v12, v13
v_cvt_pk_bf16_f32 v104, v12, v13
v_mfma_f32_16x16x32_bf16 v[52:55], a[92:95], a[60:63], v[52:55]
s_barrier
v_add_f32 v27, v27, v14
v_mfma_f32_16x16x32_bf16 v[56:59], a[96:99], a[0:3], v[56:59]
ds_read_b128 a[64:67], v4 offset:0
v_exp_f32 v15, v39
v_mfma_f32_16x16x32_bf16 v[56:59], a[100:103], a[4:7], v[56:59]
buffer_store_dword v6, v5, s[4:7], s71 offen sc1
v_add_f32 v27, v27, v15
v_cvt_pk_bf16_f32 v105, v14, v15
v_mfma_f32_16x16x32_bf16 v[56:59], a[104:107], a[8:11], v[56:59]
s_waitcnt lgkmcnt(4)
ds_read_b128 a[68:71], v4 offset:1024
v_exp_f32 v8, v40
v_mfma_f32_16x16x32_bf16 v[56:59], a[108:111], a[12:15], v[56:59]
v_exp_f32 v9, v41
v_add_f32 v26, v26, v8
v_mfma_f32_16x16x32_bf16 v[56:59], a[112:115], a[16:19], v[56:59]
s_waitcnt lgkmcnt(4)
ds_read_b128 a[72:75], v4 offset:2048
v_exp_f32 v10, v42
v_exp_f32 v11, v43
v_add_f32 v26, v26, v9
v_cvt_pk_bf16_f32 v98, v8, v9
v_mfma_f32_16x16x32_bf16 v[56:59], a[116:119], a[20:23], v[56:59]
s_waitcnt lgkmcnt(4)
v_exp_f32 v12, v44
v_add_f32 v26, v26, v10
v_add_f32 v26, v26, v11
v_cvt_pk_bf16_f32 v99, v10, v11
v_mfma_f32_16x16x32_bf16 v[56:59], a[120:123], a[24:27], v[56:59]
s_waitcnt lgkmcnt(3)
ds_read_b128 a[76:79], v4 offset:3072
v_exp_f32 v13, v45
v_add_f32 v27, v27, v12
v_mfma_f32_16x16x32_bf16 v[56:59], a[124:127], a[28:31], v[56:59]
v_exp_f32 v14, v46
v_add_f32 v27, v27, v13
v_cvt_pk_bf16_f32 v106, v12, v13
v_mfma_f32_16x16x32_bf16 v[60:63], a[96:99], a[32:35], v[20:23]
ds_read_b128 a[80:83], v4 offset:4096
v_exp_f32 v15, v47
v_add_f32 v27, v27, v14
v_mfma_f32_16x16x32_bf16 v[60:63], a[100:103], a[36:39], v[60:63]
v_exp_f32 v8, v48
v_mfma_f32_16x16x32_bf16 v[60:63], a[104:107], a[40:43], v[60:63]
ds_read_b128 a[84:87], v4 offset:5120
v_exp_f32 v9, v49
v_mfma_f32_16x16x32_bf16 v[60:63], a[108:111], a[44:47], v[60:63]
v_exp_f32 v10, v50
v_mfma_f32_16x16x32_bf16 v[60:63], a[112:115], a[48:51], v[60:63]
ds_read_b128 a[88:91], v4 offset:6144
v_exp_f32 v11, v51
v_mfma_f32_16x16x32_bf16 v[60:63], a[116:119], a[52:55], v[60:63]
v_add_f32 v27, v27, v15
v_cvt_pk_bf16_f32 v107, v14, v15
v_add_f32 v26, v26, v8
v_mfma_f32_16x16x32_bf16 v[60:63], a[120:123], a[56:59], v[60:63]
s_waitcnt lgkmcnt(7)
s_barrier
ds_read_b128 a[92:95], v4 offset:7168
v_mfma_f32_16x16x32_bf16 v[60:63], a[124:127], a[60:63], v[60:63]
s_waitcnt lgkmcnt(4)
v_add_f32 v26, v26, v9
v_cvt_pk_bf16_f32 v100, v8, v9
v_add_f32 v26, v26, v10
v_add_f32 v26, v26, v11
v_cvt_pk_bf16_f32 v101, v10, v11
s_branch K2_dx1
PAD_33:
s_cbranch_execz M_tret
K2_ntail:
v_mfma_f32_16x16x32_bf16 v[128:131], a[64:67], v[96:99], v[128:131]
s_add_u32 m0, s18, 98304
ds_read_b128 a[96:99], v2 offset:8192
v_add_f32 v24, v24, v26
v_mfma_f32_16x16x32_bf16 v[128:131], a[68:71], v[100:103], v[128:131]
buffer_load_dwordx4 v1, s[4:7], s12 offen offset:0 sc1 lds
v_mfma_f32_16x16x32_bf16 v[132:135], a[68:71], v[108:111], v[132:135]
ds_read_b128 a[100:103], v2 offset:9216
v_add_f32 v25, v25, v27
v_mfma_f32_16x16x32_bf16 v[132:135], a[64:67], v[104:107], v[132:135]
buffer_load_dwordx4 v1, s[4:7], s12 offen offset:1024 sc1 lds
v_mfma_f32_16x16x32_bf16 v[136:139], a[72:75], v[96:99], v[136:139]
ds_read_b128 a[104:107], v2 offset:10240
v_exp_f32 v8, v64
v_mfma_f32_16x16x32_bf16 v[136:139], a[76:79], v[100:103], v[136:139]
buffer_load_dwordx4 v1, s[4:7], s12 offen offset:2048 sc1 lds
v_mfma_f32_16x16x32_bf16 v[140:143], a[76:79], v[108:111], v[140:143]
ds_read_b128 a[108:111], v2 offset:11264
v_mfma_f32_16x16x32_bf16 v[140:143], a[72:75], v[104:107], v[140:143]
s_waitcnt lgkmcnt(4)
buffer_load_dwordx4 v1, s[4:7], s12 offen offset:3072 sc1 lds
v_mfma_f32_16x16x32_bf16 v[144:147], a[80:83], v[96:99], v[144:147]
s_add_u32 s12, s12, 4096
s_add_u32 m0, s18, 102400
ds_read_b128 a[112:115], v2 offset:12288
v_mfma_f32_16x16x32_bf16 v[144:147], a[84:87], v[100:103], v[144:147]
buffer_load_dwordx4 v1, s[4:7], s12 offen offset:0 sc1 lds
v_mfma_f32_16x16x32_bf16 v[148:151], a[84:87], v[108:111], v[148:151]
ds_read_b128 a[116:119], v2 offset:13312
v_exp_f32 v9, v65
v_mfma_f32_16x16x32_bf16 v[148:151], a[80:83], v[104:107], v[148:151]
buffer_load_dwordx4 v1, s[4:7], s12 offen offset:1024 sc1 lds
v_mfma_f32_16x16x32_bf16 v[152:155], a[88:91], v[96:99], v[152:155]
ds_read_b128 a[120:123], v2 offset:14336
v_add_f32 v26, v8, v9
v_cvt_pk_bf16_f32 v112, v8, v9
v_mfma_f32_16x16x32_bf16 v[152:155], a[92:95], v[100:103], v[152:155]
buffer_load_dwordx4 v1, s[4:7], s12 offen offset:2048 sc1 lds
v_mfma_f32_16x16x32_bf16 v[156:159], a[92:95], v[108:111], v[156:159]
ds_read_b128 a[124:127], v2 offset:15360
v_exp_f32 v10, v66
v_mfma_f32_16x16x32_bf16 v[156:159], a[88:91], v[104:107], v[156:159]
s_waitcnt lgkmcnt(4)
buffer_load_dwordx4 v1, s[4:7], s12 offen offset:3072 sc1 lds
v_mfma_f32_16x16x32_bf16 v[160:163], a[96:99], v[96:99], v[160:163]
s_add_u32 s12, s12, 28672
ds_read_b128 a[64:67], v2 offset:16384
v_add_f32 v26, v26, v10
v_mfma_f32_16x16x32_bf16 v[160:163], a[100:103], v[100:103], v[160:163]
s_sub_u32 s13, s13, 1
v_exp_f32 v11, v67
v_mfma_f32_16x16x32_bf16 v[164:167], a[100:103], v[108:111], v[164:167]
s_cmp_eq_u32 s13, 0
ds_read_b128 a[68:71], v2 offset:17408
v_exp_f32 v12, v68
v_mfma_f32_16x16x32_bf16 v[164:167], a[96:99], v[104:107], v[164:167]
s_cselect_b32 s12, s14, s12
v_exp_f32 v13, v69
v_mfma_f32_16x16x32_bf16 v[168:171], a[104:107], v[96:99], v[168:171]
s_cselect_b32 s13, s15, s13
ds_read_b128 a[72:75], v2 offset:18432
v_add_f32 v26, v26, v11
v_cvt_pk_bf16_f32 v113, v10, v11
v_mfma_f32_16x16x32_bf16 v[168:171], a[108:111], v[100:103], v[168:171]
s_cselect_b32 s14, 3221225472, s14
v_exp_f32 v14, v70
v_mfma_f32_16x16x32_bf16 v[172:175], a[108:111], v[108:111], v[172:175]
ds_read_b128 a[76:79], v2 offset:19456
v_exp_f32 v15, v71
v_mfma_f32_16x16x32_bf16 v[172:175], a[104:107], v[104:107], v[172:175]
s_waitcnt lgkmcnt(4)
v_exp_f32 v8, v72
v_mfma_f32_16x16x32_bf16 v[176:179], a[112:115], v[96:99], v[176:179]
ds_read_b128 a[80:83], v2 offset:20480
v_add_f32 v27, v12, v13
v_cvt_pk_bf16_f32 v120, v12, v13
v_add_f32 v27, v27, v14
v_add_f32 v27, v27, v15
v_cvt_pk_bf16_f32 v121, v14, v15
v_mfma_f32_16x16x32_bf16 v[176:179], a[116:119], v[100:103], v[176:179]
v_exp_f32 v9, v73
v_mfma_f32_16x16x32_bf16 v[180:183], a[116:119], v[108:111], v[180:183]
ds_read_b128 a[84:87], v2 offset:21504
v_exp_f32 v10, v74
v_mfma_f32_16x16x32_bf16 v[180:183], a[112:115], v[104:107], v[180:183]
v_exp_f32 v11, v75
v_mfma_f32_16x16x32_bf16 v[184:187], a[120:123], v[96:99], v[184:187]
ds_read_b128 a[88:91], v2 offset:22528
v_add_f32 v26, v26, v8
v_mfma_f32_16x16x32_bf16 v[184:187], a[124:127], v[100:103], v[184:187]
v_exp_f32 v12, v76
v_mfma_f32_16x16x32_bf16 v[188:191], a[124:127], v[108:111], v[188:191]
ds_read_b128 a[92:95], v2 offset:23552
v_add_f32 v26, v26, v9
v_cvt_pk_bf16_f32 v114, v8, v9
v_add_f32 v26, v26, v10
v_add_f32 v26, v26, v11
v_cvt_pk_bf16_f32 v115, v10, v11
v_mfma_f32_16x16x32_bf16 v[188:191], a[120:123], v[104:107], v[188:191]
s_waitcnt lgkmcnt(4)
v_exp_f32 v13, v77
v_mfma_f32_16x16x32_bf16 v[192:195], a[64:67], v[96:99], v[192:195]
ds_read_b128 a[96:99], v2 offset:24576
v_exp_f32 v14, v78
v_mfma_f32_16x16x32_bf16 v[192:195], a[68:71], v[100:103], v[192:195]
v_exp_f32 v15, v79
v_mfma_f32_16x16x32_bf16 v[196:199], a[68:71], v[108:111], v[196:199]
ds_read_b128 a[100:103], v2 offset:25600
v_add_f32 v27, v27, v12
v_add_f32 v27, v27, v13
v_cvt_pk_bf16_f32 v122, v12, v13
v_add_f32 v27, v27, v14
v_mfma_f32_16x16x32_bf16 v[196:199], a[64:67], v[104:107], v[196:199]
v_exp_f32 v8, v80
v_mfma_f32_16x16x32_bf16 v[200:203], a[72:75], v[96:99], v[200:203]
ds_read_b128 a[104:107], v2 offset:26624
v_exp_f32 v9, v81
v_mfma_f32_16x16x32_bf16 v[200:203], a[76:79], v[100:103], v[200:203]
v_exp_f32 v10, v82
v_mfma_f32_16x16x32_bf16 v[204:207], a[76:79], v[108:111], v[204:207]
ds_read_b128 a[108:111], v2 offset:27648
v_add_f32 v27, v27, v15
v_cvt_pk_bf16_f32 v123, v14, v15
v_add_f32 v26, v26, v8
v_add_f32 v26, v26, v9
v_cvt_pk_bf16_f32 v116, v8, v9
v_mfma_f32_16x16x32_bf16 v[204:207], a[72:75], v[104:107], v[204:207]
s_waitcnt lgkmcnt(4)
v_exp_f32 v11, v83
v_mfma_f32_16x16x32_bf16 v[208:211], a[80:83], v[96:99], v[208:211]
ds_read_b128 a[112:115], v2 offset:28672
v_exp_f32 v12, v84
v_mfma_f32_16x16x32_bf16 v[208:211], a[84:87], v[100:103], v[208:211]
v_exp_f32 v13, v85
v_mfma_f32_16x16x32_bf16 v[212:215], a[84:87], v[108:111], v[212:215]
ds_read_b128 a[116:119], v2 offset:29696
v_add_f32 v26, v26, v10
v_add_f32 v26, v26, v11
v_cvt_pk_bf16_f32 v117, v10, v11
v_add_f32 v27, v27, v12
v_mfma_f32_16x16x32_bf16 v[212:215], a[80:83], v[104:107], v[212:215]
v_exp_f32 v14, v86
v_mfma_f32_16x16x32_bf16 v[216:219], a[88:91], v[96:99], v[216:219]
ds_read_b128 a[120:123], v2 offset:30720
v_exp_f32 v15, v87
v_mfma_f32_16x16x32_bf16 v[216:219], a[92:95], v[100:103], v[216:219]
v_exp_f32 v8, v88
v_mfma_f32_16x16x32_bf16 v[220:223], a[92:95], v[108:111], v[220:223]
s_waitcnt vmcnt(0) lgkmcnt(4)
ds_read_b128 a[124:127], v2 offset:31744
v_add_f32 v27, v27, v13
v_cvt_pk_bf16_f32 v124, v12, v13
v_add_f32 v27, v27, v14
v_add_f32 v27, v27, v15
v_cvt_pk_bf16_f32 v125, v14, v15
v_mfma_f32_16x16x32_bf16 v[220:223], a[88:91], v[104:107], v[220:223]
s_barrier
v_mfma_f32_16x16x32_bf16 v[224:227], a[96:99], v[96:99], v[224:227]
ds_read_b128 a[64:67], v2 offset:32768
v_exp_f32 v9, v89
v_mfma_f32_16x16x32_bf16 v[224:227], a[100:103], v[100:103], v[224:227]
v_exp_f32 v10, v90
v_mfma_f32_16x16x32_bf16 v[228:231], a[100:103], v[108:111], v[228:231]
ds_read_b128 a[68:71], v2 offset:33792
v_add_f32 v26, v26, v8
v_add_f32 v26, v26, v9
v_cvt_pk_bf16_f32 v118, v8, v9
v_mfma_f32_16x16x32_bf16 v[228:231], a[96:99], v[104:107], v[228:231]
v_exp_f32 v11, v91
v_mfma_f32_16x16x32_bf16 v[232:235], a[104:107], v[96:99], v[232:235]
s_waitcnt lgkmcnt(4)
ds_read_b128 a[72:75], v2 offset:34816
v_exp_f32 v12, v92
v_mfma_f32_16x16x32_bf16 v[232:235], a[108:111], v[100:103], v[232:235]
v_exp_f32 v13, v93
v_mfma_f32_16x16x32_bf16 v[236:239], a[108:111], v[108:111], v[236:239]
ds_read_b128 a[76:79], v2 offset:35840
v_add_f32 v26, v26, v10
v_mfma_f32_16x16x32_bf16 v[236:239], a[104:107], v[104:107], v[236:239]
v_exp_f32 v14, v94
v_mfma_f32_16x16x32_bf16 v[240:243], a[112:115], v[96:99], v[240:243]
ds_read_b128 a[80:83], v2 offset:36864
v_add_f32 v26, v26, v11
v_cvt_pk_bf16_f32 v119, v10, v11
v_add_f32 v27, v27, v12
v_mfma_f32_16x16x32_bf16 v[240:243], a[116:119], v[100:103], v[240:243]
v_exp_f32 v15, v95
v_mfma_f32_16x16x32_bf16 v[244:247], a[116:119], v[108:111], v[244:247]
ds_read_b128 a[84:87], v2 offset:37888
v_add_f32 v27, v27, v13
v_cvt_pk_bf16_f32 v126, v12, v13
v_mfma_f32_16x16x32_bf16 v[244:247], a[112:115], v[104:107], v[244:247]
s_waitcnt lgkmcnt(4)
v_add_f32 v27, v27, v14
v_add_f32 v27, v27, v15
v_mfma_f32_16x16x32_bf16 v[248:251], a[120:123], v[96:99], v[248:251]
ds_read_b128 a[88:91], v2 offset:38912
v_cvt_pk_bf16_f32 v127, v14, v15
v_mfma_f32_16x16x32_bf16 v[248:251], a[124:127], v[100:103], v[248:251]
v_add_f32 v28, v26, v27
v_cmp_nge_f32 vcc, s25, v28
v_mfma_f32_16x16x32_bf16 v[252:255], a[124:127], v[108:111], v[252:255]
ds_read_b128 a[92:95], v2 offset:39936
v_mfma_f32_16x16x32_bf16 v[252:255], a[120:123], v[104:107], v[252:255]
s_cbranch_vccnz Lstub_14
Lback_15:
v_mfma_f32_16x16x32_bf16 v[128:131], a[64:67], v[112:115], v[128:131]
s_add_u32 m0, s18, 131072
ds_read_b128 a[96:99], v2 offset:40960
v_add_f32 v24, v24, v26
v_mfma_f32_16x16x32_bf16 v[128:131], a[68:71], v[116:119], v[128:131]
buffer_load_dwordx4 v1, s[4:7], s8 offen offset:0 sc1 lds
v_mfma_f32_16x16x32_bf16 v[132:135], a[68:71], v[124:127], v[132:135]
ds_read_b128 a[100:103], v2 offset:41984
v_add_f32 v25, v25, v27
v_mfma_f32_16x16x32_bf16 v[132:135], a[64:67], v[120:123], v[132:135]
s_waitcnt lgkmcnt(4)
buffer_load_dwordx4 v1, s[4:7], s8 offen offset:1024 sc1 lds
v_mfma_f32_16x16x32_bf16 v[136:139], a[72:75], v[112:115], v[136:139]
ds_read_b128 a[104:107], v2 offset:43008
v_mov_b32 v8, v16
v_mfma_f32_16x16x32_bf16 v[136:139], a[76:79], v[116:119], v[136:139]
buffer_load_dwordx4 v1, s[4:7], s8 offen offset:2048 sc1 lds
v_mfma_f32_16x16x32_bf16 v[140:143], a[76:79], v[124:127], v[140:143]
ds_read_b128 a[108:111], v2 offset:44032
v_mov_b32 v9, v24
v_mfma_f32_16x16x32_bf16 v[140:143], a[72:75], v[120:123], v[140:143]
buffer_load_dwordx4 v1, s[4:7], s8 offen offset:3072 sc1 lds
v_mfma_f32_16x16x32_bf16 v[144:147], a[80:83], v[112:115], v[144:147]
s_add_u32 s8, s8, 4096
s_add_u32 m0, s18, 135168
ds_read_b128 a[112:115], v2 offset:45056
v_mfma_f32_16x16x32_bf16 v[144:147], a[84:87], v[116:119], v[144:147]
buffer_load_dwordx4 v1, s[4:7], s8 offen offset:0 sc1 lds
v_mfma_f32_16x16x32_bf16 v[148:151], a[84:87], v[124:127], v[148:151]
ds_read_b128 a[116:119], v2 offset:46080
v_mov_b32 v10, v20
v_mfma_f32_16x16x32_bf16 v[148:151], a[80:83], v[120:123], v[148:151]
s_waitcnt lgkmcnt(4)
buffer_load_dwordx4 v1, s[4:7], s8 offen offset:1024 sc1 lds
v_mfma_f32_16x16x32_bf16 v[152:155], a[88:91], v[112:115], v[152:155]
ds_read_b128 a[120:123], v2 offset:47104
v_mov_b32 v11, v25
v_mfma_f32_16x16x32_bf16 v[152:155], a[92:95], v[116:119], v[152:155]
buffer_load_dwordx4 v1, s[4:7], s8 offen offset:2048 sc1 lds
v_mfma_f32_16x16x32_bf16 v[156:159], a[92:95], v[124:127], v[156:159]
ds_read_b128 a[124:127], v2 offset:48128
v_cvt_pk_bf16_f32 v128, v128, v129
v_mfma_f32_16x16x32_bf16 v[156:159], a[88:91], v[120:123], v[156:159]
s_waitcnt lgkmcnt(4)
buffer_load_dwordx4 v1, s[4:7], s8 offen offset:3072 sc1 lds
v_mfma_f32_16x16x32_bf16 v[160:163], a[96:99], v[112:115], v[160:163]
s_add_u32 s8, s8, 28672
ds_read_b128 a[64:67], v2 offset:49152
v_cvt_pk_bf16_f32 v129, v130, v131
v_mfma_f32_16x16x32_bf16 v[160:163], a[100:103], v[116:119], v[160:163]
s_sub_u32 s9, s9, 1
buffer_store_dwordx4 v[8:11], v1, s[4:7], s27 offen sc1
v_mfma_f32_16x16x32_bf16 v[164:167], a[100:103], v[124:127], v[164:167]
s_cmp_eq_u32 s9, 0
ds_read_b128 a[68:71], v2 offset:50176
v_cvt_pk_bf16_f32 v130, v136, v137
v_mfma_f32_16x16x32_bf16 v[164:167], a[96:99], v[120:123], v[164:167]
s_cselect_b32 s8, s10, s8
v_cvt_pk_bf16_f32 v131, v138, v139
v_accvgpr_mov_b32 a0, a192
v_mfma_f32_16x16x32_bf16 v[168:171], a[104:107], v[112:115], v[168:171]
s_cselect_b32 s9, s11, s9
ds_read_b128 a[72:75], v2 offset:51200
v_accvgpr_mov_b32 a1, a193
v_mfma_f32_16x16x32_bf16 v[168:171], a[108:111], v[116:119], v[168:171]
s_cselect_b32 s10, 3221225472, s10
buffer_store_dwordx4 v[128:131], v1, s[4:7], s76 offen offset:0 sc1
v_mfma_f32_16x16x32_bf16 v[172:175], a[108:111], v[124:127], v[172:175]
ds_read_b128 a[76:79], v2 offset:52224
v_cvt_pk_bf16_f32 v132, v132, v133
v_mfma_f32_16x16x32_bf16 v[172:175], a[104:107], v[120:123], v[172:175]
s_waitcnt lgkmcnt(4)
v_cvt_pk_bf16_f32 v133, v134, v135
v_cvt_pk_bf16_f32 v134, v140, v141
v_mfma_f32_16x16x32_bf16 v[176:179], a[112:115], v[112:115], v[176:179]
ds_read_b128 a[80:83], v2 offset:53248
v_cvt_pk_bf16_f32 v135, v142, v143
v_mfma_f32_16x16x32_bf16 v[176:179], a[116:119], v[116:119], v[176:179]
buffer_store_dwordx4 v[132:135], v1, s[4:7], s77 offen offset:0 sc1
v_mfma_f32_16x16x32_bf16 v[180:183], a[116:119], v[124:127], v[180:183]
ds_read_b128 a[84:87], v2 offset:54272
v_cvt_pk_bf16_f32 v144, v144, v145
v_mfma_f32_16x16x32_bf16 v[180:183], a[112:115], v[120:123], v[180:183]
v_cvt_pk_bf16_f32 v145, v146, v147
v_cvt_pk_bf16_f32 v146, v152, v153
v_mfma_f32_16x16x32_bf16 v[184:187], a[120:123], v[112:115], v[184:187]
ds_read_b128 a[88:91], v2 offset:55296
v_cvt_pk_bf16_f32 v147, v154, v155
v_mfma_f32_16x16x32_bf16 v[184:187], a[124:127], v[116:119], v[184:187]
buffer_store_dwordx4 v[144:147], v1, s[4:7], s76 offen offset:1024 sc1
v_mfma_f32_16x16x32_bf16 v[188:191], a[124:127], v[124:127], v[188:191]
ds_read_b128 a[92:95], v2 offset:56320
v_cvt_pk_bf16_f32 v148, v148, v149
v_mfma_f32_16x16x32_bf16 v[188:191], a[120:123], v[120:123], v[188:191]
s_waitcnt lgkmcnt(4)
v_cvt_pk_bf16_f32 v149, v150, v151
v_cvt_pk_bf16_f32 v150, v156, v157
v_mfma_f32_16x16x32_bf16 v[192:195], a[64:67], v[112:115], v[192:195]
ds_read_b128 a[96:99], v2 offset:57344
v_cvt_pk_bf16_f32 v151, v158, v159
v_mfma_f32_16x16x32_bf16 v[192:195], a[68:71], v[116:119], v[192:195]
buffer_store_dwordx4 v[148:151], v1, s[4:7], s77 offen offset:1024 sc1
v_mfma_f32_16x16x32_bf16 v[196:199], a[68:71], v[124:127], v[196:199]
ds_read_b128 a[100:103], v2 offset:58368
v_cvt_pk_bf16_f32 v160, v160, v161
v_mfma_f32_16x16x32_bf16 v[196:199], a[64:67], v[120:123], v[196:199]
v_cvt_pk_bf16_f32 v161, v162, v163
v_cvt_pk_bf16_f32 v162, v168, v169
v_mfma_f32_16x16x32_bf16 v[200:203], a[72:75], v[112:115], v[200:203]
ds_read_b128 a[104:107], v2 offset:59392
v_cvt_pk_bf16_f32 v163, v170, v171
v_mfma_f32_16x16x32_bf16 v[200:203], a[76:79], v[116:119], v[200:203]
buffer_store_dwordx4 v[160:163], v1, s[4:7], s76 offen offset:2048 sc1
v_mfma_f32_16x16x32_bf16 v[204:207], a[76:79], v[124:127], v[204:207]
ds_read_b128 a[108:111], v2 offset:60416
v_cvt_pk_bf16_f32 v164, v164, v165
v_mfma_f32_16x16x32_bf16 v[204:207], a[72:75], v[120:123], v[204:207]
s_waitcnt lgkmcnt(4)
v_cvt_pk_bf16_f32 v165, v166, v167
v_cvt_pk_bf16_f32 v166, v172, v173
v_mfma_f32_16x16x32_bf16 v[208:211], a[80:83], v[112:115], v[208:211]
ds_read_b128 a[112:115], v2 offset:61440
v_cvt_pk_bf16_f32 v167, v174, v175
v_mfma_f32_16x16x32_bf16 v[208:211], a[84:87], v[116:119], v[208:211]
buffer_store_dwordx4 v[164:167], v1, s[4:7], s77 offen offset:2048 sc1
v_mfma_f32_16x16x32_bf16 v[212:215], a[84:87], v[124:127], v[212:215]
ds_read_b128 a[116:119], v2 offset:62464
v_cvt_pk_bf16_f32 v176, v176, v177
v_mfma_f32_16x16x32_bf16 v[212:215], a[80:83], v[120:123], v[212:215]
v_cvt_pk_bf16_f32 v177, v178, v179
v_cvt_pk_bf16_f32 v178, v184, v185
v_mfma_f32_16x16x32_bf16 v[216:219], a[88:91], v[112:115], v[216:219]
ds_read_b128 a[120:123], v2 offset:63488
v_cvt_pk_bf16_f32 v179, v186, v187
v_mfma_f32_16x16x32_bf16 v[216:219], a[92:95], v[116:119], v[216:219]
buffer_store_dwordx4 v[176:179], v1, s[4:7], s76 offen offset:3072 sc1
v_mfma_f32_16x16x32_bf16 v[220:223], a[92:95], v[124:127], v[220:223]
ds_read_b128 a[124:127], v2 offset:64512
v_cvt_pk_bf16_f32 v180, v180, v181
v_mfma_f32_16x16x32_bf16 v[220:223], a[88:91], v[120:123], v[220:223]
s_waitcnt lgkmcnt(4)
v_cvt_pk_bf16_f32 v181, v182, v183
v_cvt_pk_bf16_f32 v182, v188, v189
v_mfma_f32_16x16x32_bf16 v[224:227], a[96:99], v[112:115], v[224:227]
v_cvt_pk_bf16_f32 v183, v190, v191
v_accvgpr_mov_b32 a2, a194
v_mfma_f32_16x16x32_bf16 v[224:227], a[100:103], v[116:119], v[224:227]
buffer_store_dwordx4 v[180:183], v1, s[4:7], s77 offen offset:3072 sc1
v_mfma_f32_16x16x32_bf16 v[228:231], a[100:103], v[124:127], v[228:231]
s_add_u32 s76, s76, 4096
v_accvgpr_mov_b32 a3, a195
v_accvgpr_mov_b32 a4, a196
v_mfma_f32_16x16x32_bf16 v[228:231], a[96:99], v[120:123], v[228:231]
s_add_u32 s77, s77, 4096
v_cvt_pk_bf16_f32 v192, v192, v193
v_cvt_pk_bf16_f32 v193, v194, v195
v_mfma_f32_16x16x32_bf16 v[232:235], a[104:107], v[112:115], v[232:235]
v_cvt_pk_bf16_f32 v194, v200, v201
v_cvt_pk_bf16_f32 v195, v202, v203
v_mfma_f32_16x16x32_bf16 v[232:235], a[108:111], v[116:119], v[232:235]
buffer_store_dwordx4 v[192:195], v1, s[4:7], s76 offen offset:0 sc1
v_mfma_f32_16x16x32_bf16 v[236:239], a[108:111], v[124:127], v[236:239]
v_cvt_pk_bf16_f32 v196, v196, v197
v_cvt_pk_bf16_f32 v197, v198, v199
v_mfma_f32_16x16x32_bf16 v[236:239], a[104:107], v[120:123], v[236:239]
s_waitcnt lgkmcnt(0)
v_cvt_pk_bf16_f32 v198, v204, v205
v_cvt_pk_bf16_f32 v199, v206, v207
v_mfma_f32_16x16x32_bf16 v[240:243], a[112:115], v[112:115], v[240:243]
buffer_store_dwordx4 v[196:199], v1, s[4:7], s77 offen offset:0 sc1
v_mfma_f32_16x16x32_bf16 v[240:243], a[116:119], v[116:119], v[240:243]
v_cvt_pk_bf16_f32 v208, v208, v209
v_cvt_pk_bf16_f32 v209, v210, v211
v_mfma_f32_16x16x32_bf16 v[244:247], a[116:119], v[124:127], v[244:247]
v_cvt_pk_bf16_f32 v210, v216, v217
v_cvt_pk_bf16_f32 v211, v218, v219
v_mfma_f32_16x16x32_bf16 v[244:247], a[112:115], v[120:123], v[244:247]
buffer_store_dwordx4 v[208:211], v1, s[4:7], s76 offen offset:1024 sc1
v_mfma_f32_16x16x32_bf16 v[248:251], a[120:123], v[112:115], v[248:251]
v_cvt_pk_bf16_f32 v212, v212, v213
v_cvt_pk_bf16_f32 v213, v214, v215
v_mfma_f32_16x16x32_bf16 v[248:251], a[124:127], v[116:119], v[248:251]
PAD_34:
s_cbranch_execz M_tret
v_cvt_pk_bf16_f32 v214, v220, v221
v_cvt_pk_bf16_f32 v215, v222, v223
v_mfma_f32_16x16x32_bf16 v[252:255], a[124:127], v[124:127], v[252:255]
buffer_store_dwordx4 v[212:215], v1, s[4:7], s77 offen offset:1024 sc1
v_mfma_f32_16x16x32_bf16 v[252:255], a[120:123], v[120:123], v[252:255]
v_cvt_pk_bf16_f32 v224, v224, v225
v_cvt_pk_bf16_f32 v225, v226, v227
v_accvgpr_mov_b32 a5, a197
v_accvgpr_mov_b32 a6, a198
v_accvgpr_mov_b32 a7, a199
v_accvgpr_mov_b32 a8, a200
v_accvgpr_mov_b32 a9, a201
v_accvgpr_mov_b32 a10, a202
v_accvgpr_mov_b32 a11, a203
v_accvgpr_mov_b32 a12, a204
v_cvt_pk_bf16_f32 v226, v232, v233
v_cvt_pk_bf16_f32 v227, v234, v235
buffer_store_dwordx4 v[224:227], v1, s[4:7], s76 offen offset:2048 sc1
v_cvt_pk_bf16_f32 v228, v228, v229
v_cvt_pk_bf16_f32 v229, v230, v231
v_cvt_pk_bf16_f32 v230, v236, v237
v_cvt_pk_bf16_f32 v231, v238, v239
buffer_store_dwordx4 v[228:231], v1, s[4:7], s77 offen offset:2048 sc1
v_cvt_pk_bf16_f32 v240, v240, v241
v_cvt_pk_bf16_f32 v241, v242, v243
v_cvt_pk_bf16_f32 v242, v248, v249
v_cvt_pk_bf16_f32 v243, v250, v251
buffer_store_dwordx4 v[240:243], v1, s[4:7], s76 offen offset:3072 sc1
v_cvt_pk_bf16_f32 v244, v244, v245
v_cvt_pk_bf16_f32 v245, v246, v247
v_cvt_pk_bf16_f32 v246, v252, v253
v_cvt_pk_bf16_f32 v247, v254, v255
buffer_store_dwordx4 v[244:247], v1, s[4:7], s77 offen offset:3072 sc1
v_accvgpr_mov_b32 a13, a205
v_accvgpr_mov_b32 a14, a206
v_accvgpr_mov_b32 a15, a207
v_accvgpr_mov_b32 a16, a208
v_accvgpr_mov_b32 a17, a209
v_accvgpr_mov_b32 a18, a210
v_accvgpr_mov_b32 a19, a211
v_accvgpr_mov_b32 a20, a212
v_accvgpr_mov_b32 a21, a213
v_accvgpr_mov_b32 a22, a214
v_accvgpr_mov_b32 a23, a215
v_accvgpr_mov_b32 a24, a216
v_accvgpr_mov_b32 a25, a217
v_accvgpr_mov_b32 a26, a218
v_accvgpr_mov_b32 a27, a219
v_accvgpr_mov_b32 a28, a220
v_accvgpr_mov_b32 a29, a221
v_accvgpr_mov_b32 a30, a222
v_accvgpr_mov_b32 a31, a223
v_accvgpr_mov_b32 a32, a224
v_accvgpr_mov_b32 a33, a225
v_accvgpr_mov_b32 a34, a226
v_accvgpr_mov_b32 a35, a227
v_accvgpr_mov_b32 a36, a228
v_accvgpr_mov_b32 a37, a229
v_accvgpr_mov_b32 a38, a230
v_accvgpr_mov_b32 a39, a231
v_accvgpr_mov_b32 a40, a232
v_accvgpr_mov_b32 a41, a233
v_accvgpr_mov_b32 a42, a234
v_accvgpr_mov_b32 a43, a235
v_accvgpr_mov_b32 a44, a236
v_accvgpr_mov_b32 a45, a237
v_accvgpr_mov_b32 a46, a238
v_accvgpr_mov_b32 a47, a239
v_accvgpr_mov_b32 a48, a240
v_accvgpr_mov_b32 a49, a241
v_accvgpr_mov_b32 a50, a242
v_accvgpr_mov_b32 a51, a243
v_accvgpr_mov_b32 a52, a244
v_accvgpr_mov_b32 a53, a245
v_accvgpr_mov_b32 a54, a246
v_accvgpr_mov_b32 a55, a247
v_accvgpr_mov_b32 a56, a248
v_accvgpr_mov_b32 a57, a249
v_accvgpr_mov_b32 a58, a250
v_accvgpr_mov_b32 a59, a251
v_accvgpr_mov_b32 a60, a252
v_accvgpr_mov_b32 a61, a253
v_accvgpr_mov_b32 a62, a254
v_accvgpr_mov_b32 a63, a255
s_mov_b32 s24, 0
s_mov_b32 s29, s21
s_mov_b32 s19, s21
v_mov_b64 v[128:129], 0
v_mov_b64 v[130:131], 0
v_mov_b64 v[132:133], 0
v_mov_b64 v[134:135], 0
v_mov_b64 v[136:137], 0
v_mov_b64 v[138:139], 0
v_mov_b64 v[140:141], 0
v_mov_b64 v[142:143], 0
v_mov_b64 v[144:145], 0
v_mov_b64 v[146:147], 0
v_mov_b64 v[148:149], 0
v_mov_b64 v[150:151], 0
v_mov_b64 v[152:153], 0
v_mov_b64 v[154:155], 0
v_mov_b64 v[156:157], 0
v_mov_b64 v[158:159], 0
v_mov_b64 v[160:161], 0
v_mov_b64 v[162:163], 0
v_mov_b64 v[164:165], 0
v_mov_b64 v[166:167], 0
v_mov_b64 v[168:169], 0
v_mov_b64 v[170:171], 0
v_mov_b64 v[172:173], 0
v_mov_b64 v[174:175], 0
v_mov_b64 v[176:177], 0
v_mov_b64 v[178:179], 0
v_mov_b64 v[180:181], 0
v_mov_b64 v[182:183], 0
v_mov_b64 v[184:185], 0
v_mov_b64 v[186:187], 0
v_mov_b64 v[188:189], 0
v_mov_b64 v[190:191], 0
v_mov_b64 v[192:193], 0
v_mov_b64 v[194:195], 0
v_mov_b64 v[196:197], 0
v_mov_b64 v[198:199], 0
v_mov_b64 v[200:201], 0
v_mov_b64 v[202:203], 0
v_mov_b64 v[204:205], 0
v_mov_b64 v[206:207], 0
v_mov_b64 v[208:209], 0
v_mov_b64 v[210:211], 0
v_mov_b64 v[212:213], 0
v_mov_b64 v[214:215], 0
v_mov_b64 v[216:217], 0
v_mov_b64 v[218:219], 0
v_mov_b64 v[220:221], 0
v_mov_b64 v[222:223], 0
v_mov_b64 v[224:225], 0
v_mov_b64 v[226:227], 0
v_mov_b64 v[228:229], 0
v_mov_b64 v[230:231], 0
v_mov_b64 v[232:233], 0
v_mov_b64 v[234:235], 0
v_mov_b64 v[236:237], 0
v_mov_b64 v[238:239], 0
v_mov_b64 v[240:241], 0
v_mov_b64 v[242:243], 0
v_mov_b64 v[244:245], 0
v_mov_b64 v[246:247], 0
v_mov_b64 v[248:249], 0
v_mov_b64 v[250:251], 0
v_mov_b64 v[252:253], 0
v_mov_b64 v[254:255], 0
v_mov_b64 v[24:25], 0
s_mov_b32 s71, s28
s_mov_b32 s84, 0
s_barrier
s_branch K2_item
K2_nend:
Lstub_2:
s_call_b64 s[16:17], K2_slow1
s_branch Lback_3
Lstub_4:
s_call_b64 s[16:17], K2_slow0
s_branch Lback_5
Lstub_6:
s_call_b64 s[16:17], K2_slow1
s_branch Lback_7
Lstub_8:
s_call_b64 s[16:17], K2_slow0
s_branch Lback_9
Lstub_10:
s_call_b64 s[16:17], K2_slow2
s_branch Lback_11
Lstub_12:
s_call_b64 s[16:17], K2_slow2
s_branch Lback_13
Lstub_14:
s_call_b64 s[16:17], K2_slow1
s_branch Lback_15
K2_slow0:
s_nop 7
s_nop 7
v_max3_f32 v8, v32, v33, 0
v_max3_f32 v8, v34, v35, v8
v_max3_f32 v8, v40, v41, v8
v_max3_f32 v8, v42, v43, v8
v_max3_f32 v8, v48, v49, v8
v_max3_f32 v8, v50, v51, v8
v_max3_f32 v8, v56, v57, v8
v_max3_f32 v8, v58, v59, v8
v_mov_b32 v9, v8
s_nop 1
v_permlane16_swap_b32 v8, v9
v_max_f32 v8, v8, v9
v_mov_b32 v9, v8
s_nop 1
v_permlane32_swap_b32 v8, v9
v_max_f32 v8, v8, v9
v_exp_f32 v9, -v8
v_sub_f32 v16, v16, v8
v_sub_f32 v17, v17, v8
v_sub_f32 v18, v18, v8
v_sub_f32 v19, v19, v8
v_mul_f32 v24, v24, v9
v_mul_f32 v128, v128, v9
v_mul_f32 v129, v129, v9
v_mul_f32 v130, v130, v9
v_mul_f32 v131, v131, v9
v_mul_f32 v136, v136, v9
v_mul_f32 v137, v137, v9
v_mul_f32 v138, v138, v9
v_mul_f32 v139, v139, v9
v_mul_f32 v144, v144, v9
v_mul_f32 v145, v145, v9
v_mul_f32 v146, v146, v9
v_mul_f32 v147, v147, v9
v_mul_f32 v152, v152, v9
v_mul_f32 v153, v153, v9
v_mul_f32 v154, v154, v9
v_mul_f32 v155, v155, v9
v_mul_f32 v160, v160, v9
v_mul_f32 v161, v161, v9
v_mul_f32 v162, v162, v9
v_mul_f32 v163, v163, v9
v_mul_f32 v168, v168, v9
v_mul_f32 v169, v169, v9
v_mul_f32 v170, v170, v9
v_mul_f32 v171, v171, v9
v_mul_f32 v176, v176, v9
v_mul_f32 v177, v177, v9
v_mul_f32 v178, v178, v9
v_mul_f32 v179, v179, v9
v_mul_f32 v184, v184, v9
v_mul_f32 v185, v185, v9
v_mul_f32 v186, v186, v9
v_mul_f32 v187, v187, v9
v_mul_f32 v192, v192, v9
v_mul_f32 v193, v193, v9
v_mul_f32 v194, v194, v9
v_mul_f32 v195, v195, v9
v_mul_f32 v200, v200, v9
v_mul_f32 v201, v201, v9
v_mul_f32 v202, v202, v9
v_mul_f32 v203, v203, v9
v_mul_f32 v208, v208, v9
v_mul_f32 v209, v209, v9
v_mul_f32 v210, v210, v9
v_mul_f32 v211, v211, v9
v_mul_f32 v216, v216, v9
v_mul_f32 v217, v217, v9
v_mul_f32 v218, v218, v9
v_mul_f32 v219, v219, v9
v_mul_f32 v224, v224, v9
v_mul_f32 v225, v225, v9
v_mul_f32 v226, v226, v9
v_mul_f32 v227, v227, v9
v_mul_f32 v232, v232, v9
v_mul_f32 v233, v233, v9
v_mul_f32 v234, v234, v9
v_mul_f32 v235, v235, v9
v_mul_f32 v240, v240, v9
v_mul_f32 v241, v241, v9
v_mul_f32 v242, v242, v9
v_mul_f32 v243, v243, v9
v_mul_f32 v248, v248, v9
v_mul_f32 v249, v249, v9
v_mul_f32 v250, v250, v9
v_mul_f32 v251, v251, v9
v_sub_f32 v32, v32, v8
v_sub_f32 v33, v33, v8
v_sub_f32 v34, v34, v8
v_sub_f32 v35, v35, v8
v_sub_f32 v40, v40, v8
v_sub_f32 v41, v41, v8
v_sub_f32 v42, v42, v8
v_sub_f32 v43, v43, v8
v_sub_f32 v48, v48, v8
v_sub_f32 v49, v49, v8
v_sub_f32 v50, v50, v8
v_sub_f32 v51, v51, v8
v_sub_f32 v56, v56, v8
v_sub_f32 v57, v57, v8
v_sub_f32 v58, v58, v8
v_sub_f32 v59, v59, v8
v_sub_f32 v64, v64, v8
v_sub_f32 v65, v65, v8
v_sub_f32 v66, v66, v8
v_sub_f32 v67, v67, v8
v_sub_f32 v72, v72, v8
v_sub_f32 v73, v73, v8
v_sub_f32 v74, v74, v8
v_sub_f32 v75, v75, v8
v_sub_f32 v80, v80, v8
v_sub_f32 v81, v81, v8
v_sub_f32 v82, v82, v8
v_sub_f32 v83, v83, v8
v_sub_f32 v88, v88, v8
v_sub_f32 v89, v89, v8
v_sub_f32 v90, v90, v8
v_sub_f32 v91, v91, v8
v_max3_f32 v8, v36, v37, 0
v_max3_f32 v8, v38, v39, v8
v_max3_f32 v8, v44, v45, v8
v_max3_f32 v8, v46, v47, v8
v_max3_f32 v8, v52, v53, v8
v_max3_f32 v8, v54, v55, v8
v_max3_f32 v8, v60, v61, v8
v_max3_f32 v8, v62, v63, v8
v_mov_b32 v9, v8
s_nop 1
v_permlane16_swap_b32 v8, v9
v_max_f32 v8, v8, v9
v_mov_b32 v9, v8
s_nop 1
v_permlane32_swap_b32 v8, v9
v_max_f32 v8, v8, v9
v_exp_f32 v9, -v8
v_sub_f32 v20, v20, v8
v_sub_f32 v21, v21, v8
v_sub_f32 v22, v22, v8
v_sub_f32 v23, v23, v8
v_mul_f32 v25, v25, v9
v_mul_f32 v132, v132, v9
v_mul_f32 v133, v133, v9
v_mul_f32 v134, v134, v9
v_mul_f32 v135, v135, v9
v_mul_f32 v140, v140, v9
v_mul_f32 v141, v141, v9
v_mul_f32 v142, v142, v9
v_mul_f32 v143, v143, v9
v_mul_f32 v148, v148, v9
v_mul_f32 v149, v149, v9
v_mul_f32 v150, v150, v9
v_mul_f32 v151, v151, v9
v_mul_f32 v156, v156, v9
v_mul_f32 v157, v157, v9
v_mul_f32 v158, v158, v9
v_mul_f32 v159, v159, v9
v_mul_f32 v164, v164, v9
v_mul_f32 v165, v165, v9
v_mul_f32 v166, v166, v9
v_mul_f32 v167, v167, v9
v_mul_f32 v172, v172, v9
v_mul_f32 v173, v173, v9
v_mul_f32 v174, v174, v9
v_mul_f32 v175, v175, v9
v_mul_f32 v180, v180, v9
v_mul_f32 v181, v181, v9
v_mul_f32 v182, v182, v9
v_mul_f32 v183, v183, v9
v_mul_f32 v188, v188, v9
v_mul_f32 v189, v189, v9
v_mul_f32 v190, v190, v9
v_mul_f32 v191, v191, v9
v_mul_f32 v196, v196, v9
v_mul_f32 v197, v197, v9
v_mul_f32 v198, v198, v9
v_mul_f32 v199, v199, v9
v_mul_f32 v204, v204, v9
v_mul_f32 v205, v205, v9
v_mul_f32 v206, v206, v9
v_mul_f32 v207, v207, v9
v_mul_f32 v212, v212, v9
v_mul_f32 v213, v213, v9
v_mul_f32 v214, v214, v9
v_mul_f32 v215, v215, v9
v_mul_f32 v220, v220, v9
v_mul_f32 v221, v221, v9
v_mul_f32 v222, v222, v9
v_mul_f32 v223, v223, v9
v_mul_f32 v228, v228, v9
v_mul_f32 v229, v229, v9
v_mul_f32 v230, v230, v9
v_mul_f32 v231, v231, v9
v_mul_f32 v236, v236, v9
v_mul_f32 v237, v237, v9
v_mul_f32 v238, v238, v9
v_mul_f32 v239, v239, v9
v_mul_f32 v244, v244, v9
v_mul_f32 v245, v245, v9
v_mul_f32 v246, v246, v9
v_mul_f32 v247, v247, v9
v_mul_f32 v252, v252, v9
v_mul_f32 v253, v253, v9
v_mul_f32 v254, v254, v9
v_mul_f32 v255, v255, v9
v_sub_f32 v36, v36, v8
v_sub_f32 v37, v37, v8
v_sub_f32 v38, v38, v8
v_sub_f32 v39, v39, v8
v_sub_f32 v44, v44, v8
v_sub_f32 v45, v45, v8
v_sub_f32 v46, v46, v8
v_sub_f32 v47, v47, v8
v_sub_f32 v52, v52, v8
v_sub_f32 v53, v53, v8
v_sub_f32 v54, v54, v8
v_sub_f32 v55, v55, v8
v_sub_f32 v60, v60, v8
v_sub_f32 v61, v61, v8
v_sub_f32 v62, v62, v8
v_sub_f32 v63, v63, v8
v_sub_f32 v68, v68, v8
v_sub_f32 v69, v69, v8
v_sub_f32 v70, v70, v8
v_sub_f32 v71, v71, v8
v_sub_f32 v76, v76, v8
v_sub_f32 v77, v77, v8
v_sub_f32 v78, v78, v8
v_sub_f32 v79, v79, v8
v_sub_f32 v84, v84, v8
v_sub_f32 v85, v85, v8
v_sub_f32 v86, v86, v8
v_sub_f32 v87, v87, v8
v_sub_f32 v92, v92, v8
v_sub_f32 v93, v93, v8
v_sub_f32 v94, v94, v8
v_sub_f32 v95, v95, v8
v_exp_f32 v8, v32
v_exp_f32 v9, v33
v_exp_f32 v10, v34
v_exp_f32 v11, v35
s_nop 0
v_add_f32 v26, v8, v9
v_cvt_pk_bf16_f32 v96, v8, v9
v_add_f32 v26, v26, v10
v_add_f32 v26, v26, v11
v_cvt_pk_bf16_f32 v97, v10, v11
v_exp_f32 v12, v36
v_exp_f32 v13, v37
v_exp_f32 v14, v38
v_exp_f32 v15, v39
s_nop 0
v_add_f32 v27, v12, v13
v_cvt_pk_bf16_f32 v104, v12, v13
v_add_f32 v27, v27, v14
v_add_f32 v27, v27, v15
v_cvt_pk_bf16_f32 v105, v14, v15
v_exp_f32 v8, v40
v_exp_f32 v9, v41
v_exp_f32 v10, v42
v_exp_f32 v11, v43
s_nop 0
v_add_f32 v26, v26, v8
v_add_f32 v26, v26, v9
v_cvt_pk_bf16_f32 v98, v8, v9
v_add_f32 v26, v26, v10
v_add_f32 v26, v26, v11
v_cvt_pk_bf16_f32 v99, v10, v11
v_exp_f32 v12, v44
v_exp_f32 v13, v45
v_exp_f32 v14, v46
v_exp_f32 v15, v47
s_nop 0
v_add_f32 v27, v27, v12
v_add_f32 v27, v27, v13
v_cvt_pk_bf16_f32 v106, v12, v13
v_add_f32 v27, v27, v14
v_add_f32 v27, v27, v15
v_cvt_pk_bf16_f32 v107, v14, v15
v_exp_f32 v8, v48
v_exp_f32 v9, v49
v_exp_f32 v10, v50
v_exp_f32 v11, v51
s_nop 0
v_add_f32 v26, v26, v8
v_add_f32 v26, v26, v9
v_cvt_pk_bf16_f32 v100, v8, v9
v_add_f32 v26, v26, v10
v_add_f32 v26, v26, v11
v_cvt_pk_bf16_f32 v101, v10, v11
v_exp_f32 v12, v52
v_exp_f32 v13, v53
v_exp_f32 v14, v54
v_exp_f32 v15, v55
s_nop 0
v_add_f32 v27, v27, v12
v_add_f32 v27, v27, v13
v_cvt_pk_bf16_f32 v108, v12, v13
v_add_f32 v27, v27, v14
v_add_f32 v27, v27, v15
v_cvt_pk_bf16_f32 v109, v14, v15
v_exp_f32 v8, v56
v_exp_f32 v9, v57
v_exp_f32 v10, v58
v_exp_f32 v11, v59
s_nop 0
v_add_f32 v26, v26, v8
v_add_f32 v26, v26, v9
v_cvt_pk_bf16_f32 v102, v8, v9
v_add_f32 v26, v26, v10
v_add_f32 v26, v26, v11
v_cvt_pk_bf16_f32 v103, v10, v11
v_exp_f32 v12, v60
v_exp_f32 v13, v61
v_exp_f32 v14, v62
v_exp_f32 v15, v63
s_nop 0
v_add_f32 v27, v27, v12
v_add_f32 v27, v27, v13
v_cvt_pk_bf16_f32 v110, v12, v13
v_add_f32 v27, v27, v14
v_add_f32 v27, v27, v15
v_cvt_pk_bf16_f32 v111, v14, v15
s_nop 1
s_setpc_b64 s[16:17]
K2_slow1:
s_nop 7
s_nop 7
v_max3_f32 v8, v64, v65, 0
v_max3_f32 v8, v66, v67, v8
v_max3_f32 v8, v72, v73, v8
v_max3_f32 v8, v74, v75, v8
v_max3_f32 v8, v80, v81, v8
v_max3_f32 v8, v82, v83, v8
v_max3_f32 v8, v88, v89, v8
v_max3_f32 v8, v90, v91, v8
v_mov_b32 v9, v8
s_nop 1
v_permlane16_swap_b32 v8, v9
v_max_f32 v8, v8, v9
v_mov_b32 v9, v8
s_nop 1
v_permlane32_swap_b32 v8, v9
v_max_f32 v8, v8, v9
v_exp_f32 v9, -v8
v_sub_f32 v16, v16, v8
v_sub_f32 v17, v17, v8
v_sub_f32 v18, v18, v8
v_sub_f32 v19, v19, v8
v_mul_f32 v24, v24, v9
v_mul_f32 v128, v128, v9
v_mul_f32 v129, v129, v9
v_mul_f32 v130, v130, v9
v_mul_f32 v131, v131, v9
v_mul_f32 v136, v136, v9
v_mul_f32 v137, v137, v9
v_mul_f32 v138, v138, v9
v_mul_f32 v139, v139, v9
v_mul_f32 v144, v144, v9
v_mul_f32 v145, v145, v9
v_mul_f32 v146, v146, v9
v_mul_f32 v147, v147, v9
v_mul_f32 v152, v152, v9
v_mul_f32 v153, v153, v9
v_mul_f32 v154, v154, v9
v_mul_f32 v155, v155, v9
v_mul_f32 v160, v160, v9
v_mul_f32 v161, v161, v9
v_mul_f32 v162, v162, v9
v_mul_f32 v163, v163, v9
v_mul_f32 v168, v168, v9
v_mul_f32 v169, v169, v9
v_mul_f32 v170, v170, v9
v_mul_f32 v171, v171, v9
v_mul_f32 v176, v176, v9
v_mul_f32 v177, v177, v9
v_mul_f32 v178, v178, v9
v_mul_f32 v179, v179, v9
v_mul_f32 v184, v184, v9
v_mul_f32 v185, v185, v9
v_mul_f32 v186, v186, v9
v_mul_f32 v187, v187, v9
v_mul_f32 v192, v192, v9
v_mul_f32 v193, v193, v9
v_mul_f32 v194, v194, v9
v_mul_f32 v195, v195, v9
v_mul_f32 v200, v200, v9
v_mul_f32 v201, v201, v9
v_mul_f32 v202, v202, v9
v_mul_f32 v203, v203, v9
v_mul_f32 v208, v208, v9
v_mul_f32 v209, v209, v9
v_mul_f32 v210, v210, v9
v_mul_f32 v211, v211, v9
v_mul_f32 v216, v216, v9
v_mul_f32 v217, v217, v9
v_mul_f32 v218, v218, v9
v_mul_f32 v219, v219, v9
v_mul_f32 v224, v224, v9
v_mul_f32 v225, v225, v9
v_mul_f32 v226, v226, v9
v_mul_f32 v227, v227, v9
v_mul_f32 v232, v232, v9
v_mul_f32 v233, v233, v9
v_mul_f32 v234, v234, v9
v_mul_f32 v235, v235, v9
v_mul_f32 v240, v240, v9
v_mul_f32 v241, v241, v9
v_mul_f32 v242, v242, v9
v_mul_f32 v243, v243, v9
v_mul_f32 v248, v248, v9
v_mul_f32 v249, v249, v9
v_mul_f32 v250, v250, v9
v_mul_f32 v251, v251, v9
v_sub_f32 v32, v32, v8
v_sub_f32 v33, v33, v8
v_sub_f32 v34, v34, v8
v_sub_f32 v35, v35, v8
v_sub_f32 v40, v40, v8
v_sub_f32 v41, v41, v8
v_sub_f32 v42, v42, v8
v_sub_f32 v43, v43, v8
v_sub_f32 v48, v48, v8
v_sub_f32 v49, v49, v8
v_sub_f32 v50, v50, v8
v_sub_f32 v51, v51, v8
v_sub_f32 v56, v56, v8
v_sub_f32 v57, v57, v8
v_sub_f32 v58, v58, v8
v_sub_f32 v59, v59, v8
v_sub_f32 v64, v64, v8
v_sub_f32 v65, v65, v8
v_sub_f32 v66, v66, v8
v_sub_f32 v67, v67, v8
v_sub_f32 v72, v72, v8
v_sub_f32 v73, v73, v8
v_sub_f32 v74, v74, v8
v_sub_f32 v75, v75, v8
v_sub_f32 v80, v80, v8
v_sub_f32 v81, v81, v8
v_sub_f32 v82, v82, v8
v_sub_f32 v83, v83, v8
v_sub_f32 v88, v88, v8
v_sub_f32 v89, v89, v8
v_sub_f32 v90, v90, v8
v_sub_f32 v91, v91, v8
v_max3_f32 v8, v68, v69, 0
v_max3_f32 v8, v70, v71, v8
v_max3_f32 v8, v76, v77, v8
v_max3_f32 v8, v78, v79, v8
v_max3_f32 v8, v84, v85, v8
v_max3_f32 v8, v86, v87, v8
v_max3_f32 v8, v92, v93, v8
v_max3_f32 v8, v94, v95, v8
v_mov_b32 v9, v8
s_nop 1
v_permlane16_swap_b32 v8, v9
v_max_f32 v8, v8, v9
v_mov_b32 v9, v8
s_nop 1
v_permlane32_swap_b32 v8, v9
v_max_f32 v8, v8, v9
v_exp_f32 v9, -v8
v_sub_f32 v20, v20, v8
v_sub_f32 v21, v21, v8
v_sub_f32 v22, v22, v8
v_sub_f32 v23, v23, v8
v_mul_f32 v25, v25, v9
v_mul_f32 v132, v132, v9
v_mul_f32 v133, v133, v9
v_mul_f32 v134, v134, v9
v_mul_f32 v135, v135, v9
v_mul_f32 v140, v140, v9
v_mul_f32 v141, v141, v9
v_mul_f32 v142, v142, v9
v_mul_f32 v143, v143, v9
v_mul_f32 v148, v148, v9
v_mul_f32 v149, v149, v9
v_mul_f32 v150, v150, v9
v_mul_f32 v151, v151, v9
v_mul_f32 v156, v156, v9
v_mul_f32 v157, v157, v9
v_mul_f32 v158, v158, v9
v_mul_f32 v159, v159, v9
v_mul_f32 v164, v164, v9
v_mul_f32 v165, v165, v9
v_mul_f32 v166, v166, v9
v_mul_f32 v167, v167, v9
v_mul_f32 v172, v172, v9
v_mul_f32 v173, v173, v9
v_mul_f32 v174, v174, v9
v_mul_f32 v175, v175, v9
v_mul_f32 v180, v180, v9
v_mul_f32 v181, v181, v9
v_mul_f32 v182, v182, v9
v_mul_f32 v183, v183, v9
v_mul_f32 v188, v188, v9
v_mul_f32 v189, v189, v9
v_mul_f32 v190, v190, v9
v_mul_f32 v191, v191, v9
v_mul_f32 v196, v196, v9
v_mul_f32 v197, v197, v9
v_mul_f32 v198, v198, v9
v_mul_f32 v199, v199, v9
v_mul_f32 v204, v204, v9
v_mul_f32 v205, v205, v9
v_mul_f32 v206, v206, v9
v_mul_f32 v207, v207, v9
v_mul_f32 v212, v212, v9
v_mul_f32 v213, v213, v9
v_mul_f32 v214, v214, v9
v_mul_f32 v215, v215, v9
v_mul_f32 v220, v220, v9
v_mul_f32 v221, v221, v9
v_mul_f32 v222, v222, v9
v_mul_f32 v223, v223, v9
v_mul_f32 v228, v228, v9
v_mul_f32 v229, v229, v9
v_mul_f32 v230, v230, v9
v_mul_f32 v231, v231, v9
v_mul_f32 v236, v236, v9
v_mul_f32 v237, v237, v9
v_mul_f32 v238, v238, v9
v_mul_f32 v239, v239, v9
v_mul_f32 v244, v244, v9
v_mul_f32 v245, v245, v9
v_mul_f32 v246, v246, v9
v_mul_f32 v247, v247, v9
v_mul_f32 v252, v252, v9
v_mul_f32 v253, v253, v9
v_mul_f32 v254, v254, v9
v_mul_f32 v255, v255, v9
v_sub_f32 v36, v36, v8
v_sub_f32 v37, v37, v8
v_sub_f32 v38, v38, v8
v_sub_f32 v39, v39, v8
v_sub_f32 v44, v44, v8
v_sub_f32 v45, v45, v8
v_sub_f32 v46, v46, v8
v_sub_f32 v47, v47, v8
v_sub_f32 v52, v52, v8
v_sub_f32 v53, v53, v8
v_sub_f32 v54, v54, v8
v_sub_f32 v55, v55, v8
v_sub_f32 v60, v60, v8
v_sub_f32 v61, v61, v8
v_sub_f32 v62, v62, v8
v_sub_f32 v63, v63, v8
v_sub_f32 v68, v68, v8
v_sub_f32 v69, v69, v8
v_sub_f32 v70, v70, v8
v_sub_f32 v71, v71, v8
v_sub_f32 v76, v76, v8
v_sub_f32 v77, v77, v8
v_sub_f32 v78, v78, v8
v_sub_f32 v79, v79, v8
v_sub_f32 v84, v84, v8
v_sub_f32 v85, v85, v8
v_sub_f32 v86, v86, v8
v_sub_f32 v87, v87, v8
v_sub_f32 v92, v92, v8
v_sub_f32 v93, v93, v8
v_sub_f32 v94, v94, v8
v_sub_f32 v95, v95, v8
v_exp_f32 v8, v64
v_exp_f32 v9, v65
v_exp_f32 v10, v66
v_exp_f32 v11, v67
s_nop 0
v_add_f32 v26, v8, v9
v_cvt_pk_bf16_f32 v112, v8, v9
v_add_f32 v26, v26, v10
v_add_f32 v26, v26, v11
v_cvt_pk_bf16_f32 v113, v10, v11
v_exp_f32 v12, v68
v_exp_f32 v13, v69
v_exp_f32 v14, v70
v_exp_f32 v15, v71
s_nop 0
v_add_f32 v27, v12, v13
v_cvt_pk_bf16_f32 v120, v12, v13
v_add_f32 v27, v27, v14
v_add_f32 v27, v27, v15
v_cvt_pk_bf16_f32 v121, v14, v15
v_exp_f32 v8, v72
v_exp_f32 v9, v73
v_exp_f32 v10, v74
v_exp_f32 v11, v75
s_nop 0
v_add_f32 v26, v26, v8
v_add_f32 v26, v26, v9
v_cvt_pk_bf16_f32 v114, v8, v9
v_add_f32 v26, v26, v10
v_add_f32 v26, v26, v11
v_cvt_pk_bf16_f32 v115, v10, v11
v_exp_f32 v12, v76
v_exp_f32 v13, v77
v_exp_f32 v14, v78
v_exp_f32 v15, v79
s_nop 0
v_add_f32 v27, v27, v12
v_add_f32 v27, v27, v13
v_cvt_pk_bf16_f32 v122, v12, v13
v_add_f32 v27, v27, v14
v_add_f32 v27, v27, v15
v_cvt_pk_bf16_f32 v123, v14, v15
v_exp_f32 v8, v80
v_exp_f32 v9, v81
v_exp_f32 v10, v82
v_exp_f32 v11, v83
s_nop 0
v_add_f32 v26, v26, v8
v_add_f32 v26, v26, v9
v_cvt_pk_bf16_f32 v116, v8, v9
v_add_f32 v26, v26, v10
v_add_f32 v26, v26, v11
v_cvt_pk_bf16_f32 v117, v10, v11
v_exp_f32 v12, v84
v_exp_f32 v13, v85
v_exp_f32 v14, v86
v_exp_f32 v15, v87
s_nop 0
v_add_f32 v27, v27, v12
v_add_f32 v27, v27, v13
v_cvt_pk_bf16_f32 v124, v12, v13
v_add_f32 v27, v27, v14
v_add_f32 v27, v27, v15
v_cvt_pk_bf16_f32 v125, v14, v15
v_exp_f32 v8, v88
v_exp_f32 v9, v89
v_exp_f32 v10, v90
v_exp_f32 v11, v91
s_nop 0
v_add_f32 v26, v26, v8
v_add_f32 v26, v26, v9
v_cvt_pk_bf16_f32 v118, v8, v9
v_add_f32 v26, v26, v10
v_add_f32 v26, v26, v11
v_cvt_pk_bf16_f32 v119, v10, v11
v_exp_f32 v12, v92
v_exp_f32 v13, v93
v_exp_f32 v14, v94
v_exp_f32 v15, v95
s_nop 0
v_add_f32 v27, v27, v12
v_add_f32 v27, v27, v13
v_cvt_pk_bf16_f32 v126, v12, v13
v_add_f32 v27, v27, v14
v_add_f32 v27, v27, v15
v_cvt_pk_bf16_f32 v127, v14, v15
s_nop 1
s_setpc_b64 s[16:17]
K2_slow2:
s_nop 7
s_nop 7
v_max3_f32 v8, v68, v69, 0
v_max3_f32 v8, v70, v71, v8
v_max3_f32 v8, v76, v77, v8
v_max3_f32 v8, v78, v79, v8
v_max3_f32 v8, v84, v85, v8
v_max3_f32 v8, v86, v87, v8
v_max3_f32 v8, v92, v93, v8
v_max3_f32 v8, v94, v95, v8
v_mov_b32 v9, v8
s_nop 1
v_permlane16_swap_b32 v8, v9
v_max_f32 v8, v8, v9
v_mov_b32 v9, v8
s_nop 1
v_permlane32_swap_b32 v8, v9
v_max_f32 v8, v8, v9
v_exp_f32 v9, -v8
v_sub_f32 v20, v20, v8
v_sub_f32 v21, v21, v8
v_sub_f32 v22, v22, v8
v_sub_f32 v23, v23, v8
v_mul_f32 v25, v25, v9
v_mul_f32 v132, v132, v9
v_mul_f32 v133, v133, v9
v_mul_f32 v134, v134, v9
v_mul_f32 v135, v135, v9
v_mul_f32 v140, v140, v9
v_mul_f32 v141, v141, v9
v_mul_f32 v142, v142, v9
v_mul_f32 v143, v143, v9
v_mul_f32 v148, v148, v9
v_mul_f32 v149, v149, v9
v_mul_f32 v150, v150, v9
v_mul_f32 v151, v151, v9
v_mul_f32 v156, v156, v9
v_mul_f32 v157, v157, v9
v_mul_f32 v158, v158, v9
v_mul_f32 v159, v159, v9
v_mul_f32 v164, v164, v9
v_mul_f32 v165, v165, v9
v_mul_f32 v166, v166, v9
v_mul_f32 v167, v167, v9
v_mul_f32 v172, v172, v9
v_mul_f32 v173, v173, v9
v_mul_f32 v174, v174, v9
v_mul_f32 v175, v175, v9
v_mul_f32 v180, v180, v9
v_mul_f32 v181, v181, v9
v_mul_f32 v182, v182, v9
v_mul_f32 v183, v183, v9
v_mul_f32 v188, v188, v9
v_mul_f32 v189, v189, v9
v_mul_f32 v190, v190, v9
v_mul_f32 v191, v191, v9
v_mul_f32 v196, v196, v9
v_mul_f32 v197, v197, v9
v_mul_f32 v198, v198, v9
v_mul_f32 v199, v199, v9
v_mul_f32 v204, v204, v9
v_mul_f32 v205, v205, v9
v_mul_f32 v206, v206, v9
v_mul_f32 v207, v207, v9
v_mul_f32 v212, v212, v9
v_mul_f32 v213, v213, v9
v_mul_f32 v214, v214, v9
v_mul_f32 v215, v215, v9
v_mul_f32 v220, v220, v9
v_mul_f32 v221, v221, v9
v_mul_f32 v222, v222, v9
v_mul_f32 v223, v223, v9
v_mul_f32 v228, v228, v9
v_mul_f32 v229, v229, v9
v_mul_f32 v230, v230, v9
v_mul_f32 v231, v231, v9
v_mul_f32 v236, v236, v9
v_mul_f32 v237, v237, v9
v_mul_f32 v238, v238, v9
v_mul_f32 v239, v239, v9
v_mul_f32 v244, v244, v9
v_mul_f32 v245, v245, v9
v_mul_f32 v246, v246, v9
v_mul_f32 v247, v247, v9
v_mul_f32 v252, v252, v9
v_mul_f32 v253, v253, v9
v_mul_f32 v254, v254, v9
v_mul_f32 v255, v255, v9
v_sub_f32 v68, v68, v8
v_sub_f32 v69, v69, v8
v_sub_f32 v70, v70, v8
v_sub_f32 v71, v71, v8
v_sub_f32 v76, v76, v8
v_sub_f32 v77, v77, v8
v_sub_f32 v78, v78, v8
v_sub_f32 v79, v79, v8
v_sub_f32 v84, v84, v8
v_sub_f32 v85, v85, v8
v_sub_f32 v86, v86, v8
v_sub_f32 v87, v87, v8
v_sub_f32 v92, v92, v8
v_sub_f32 v93, v93, v8
v_sub_f32 v94, v94, v8
v_sub_f32 v95, v95, v8
v_exp_f32 v8, v68
v_exp_f32 v9, v69
v_exp_f32 v10, v70
v_exp_f32 v11, v71
s_nop 0
v_add_f32 v27, v8, v9
v_cvt_pk_bf16_f32 v120, v8, v9
v_add_f32 v27, v27, v10
v_add_f32 v27, v27, v11
v_cvt_pk_bf16_f32 v121, v10, v11
v_exp_f32 v12, v76
v_exp_f32 v13, v77
v_exp_f32 v14, v78
v_exp_f32 v15, v79
s_nop 0
v_add_f32 v27, v27, v12
v_add_f32 v27, v27, v13
v_cvt_pk_bf16_f32 v122, v12, v13
v_add_f32 v27, v27, v14
v_add_f32 v27, v27, v15
v_cvt_pk_bf16_f32 v123, v14, v15
v_exp_f32 v8, v84
v_exp_f32 v9, v85
v_exp_f32 v10, v86
v_exp_f32 v11, v87
s_nop 0
v_add_f32 v27, v27, v8
v_add_f32 v27, v27, v9
v_cvt_pk_bf16_f32 v124, v8, v9
v_add_f32 v27, v27, v10
v_add_f32 v27, v27, v11
v_cvt_pk_bf16_f32 v125, v10, v11
v_exp_f32 v12, v92
v_exp_f32 v13, v93
v_exp_f32 v14, v94
v_exp_f32 v15, v95
s_nop 0
v_add_f32 v27, v27, v12
v_add_f32 v27, v27, v13
v_cvt_pk_bf16_f32 v126, v12, v13
v_add_f32 v27, v27, v14
v_add_f32 v27, v27, v15
v_cvt_pk_bf16_f32 v127, v14, v15
s_nop 1
s_setpc_b64 s[16:17]
M_cntspinK:
Lp_9801:
buffer_load_dword v245, off, s[60:63], s54 sc1
s_waitcnt vmcnt(0)
v_cmp_gt_u32 vcc, s50, v245
s_cbranch_vccz Lpd_9802
s_sleep 8
s_sub_u32 s101, s101, 1
s_cbranch_scc0 Lp_9801
s_mov_b32 s101, 0
Lpd_9802:
s_branch Lg_1
M_cntspinV:
Lp_9803:
buffer_load_dword v245, off, s[60:63], s54 sc1
s_waitcnt vmcnt(0)
v_cmp_gt_u32 vcc, s50, v245
s_cbranch_vccz Lpd_9804
s_sleep 8
s_sub_u32 s101, s101, 1
s_cbranch_scc0 Lp_9803
s_mov_b32 s101, 0
Lpd_9804:
s_branch Lg_501
M_ppspinV:
Lp_9805:
buffer_load_dword v230, v231, s[4:7], s52 offen sc1
s_waitcnt vmcnt(0)
v_cmp_gt_u32 vcc, 1, v230
s_cbranch_vccz Lpd_9806
s_sleep 8
s_sub_u32 s101, s101, 1
s_cbranch_scc0 Lp_9805
s_mov_b32 s101, 0
Lpd_9806:
s_branch M_ppokV
M_end:
s_endpgm
.section .rodata,"a"
.p2align 6
.amdhsa_kernel concat_heads__ssm_conv_h3__compressed_kv_cla__prompt_kernel
  .amdhsa_next_free_vgpr 512
  .amdhsa_next_free_sgpr 102
  .amdhsa_accum_offset 256
  .amdhsa_group_segment_fixed_size 0
  .amdhsa_kernarg_size 120
  .amdhsa_user_sgpr_count 2
  .amdhsa_user_sgpr_kernarg_segment_ptr 1
  .amdhsa_system_sgpr_workgroup_id_x 1
  .amdhsa_float_denorm_mode_32 3
  .amdhsa_float_denorm_mode_16_64 3
  .amdhsa_ieee_mode 0
  .amdhsa_dx10_clamp 0
.end_amdhsa_kernel
```

```asm
; @launch grid=(256,1,1) block=(256,1,1) lds=163840
.amdgcn_target "amdgcn-amd-amdhsa--gfx950"
.text
.globl concat_heads__ssm_conv_h3__compressed_kv_cla__prompt_kernel
.p2align 8
.type concat_heads__ssm_conv_h3__compressed_kv_cla__prompt_kernel,@function
concat_heads__ssm_conv_h3__compressed_kv_cla__prompt_kernel:
s_cmp_ge_u32 s2, 256
s_cbranch_scc1 M_end
s_load_dwordx16 s[64:79], s[0:1], 0
s_load_dwordx8 s[80:87], s[0:1], 64
s_load_dwordx4 s[88:91], s[0:1], 96
s_load_dwordx2 s[92:93], s[0:1], 112
s_getpc_b64 s[58:59]
M_pc:
s_lshr_b32 s22, s2, 3
s_lshl_b32 s22, s22, 5
v_and_b32 v26, 31, v0
v_add_u32 v26, s22, v26
v_lshlrev_b32 v26, 7, v26
v_min_u32 v26, M_end-M_pc, v26
v_mov_b32 v27, s59
v_add_co_u32 v26, vcc, s58, v26
s_nop 1
v_addc_co_u32 v27, vcc, 0, v27, vcc
global_load_dword v21, v[26:27], off
v_lshrrev_b32 v28, 6, v0
v_and_b32 v29, 63, v0
v_lshlrev_b32 v1, 4, v29
v_readfirstlane_b32 s3, v28
s_lshr_b32 s21, s2, 5
v_lshrrev_b32 v26, 7, v1
v_lshrrev_b32 v27, 1, v26
v_lshlrev_b32 v27, 4, v27
v_and_b32 v28, 0x70, v1
v_xor_b32 v27, v27, v28
v_mul_u32_u24 v26, 2048, v26
v_add_u32 v12, v26, v27
v_xor_b32 v27, 64, v27
v_add_u32 v26, v26, v27
v_add_u32 v13, 15360, v26
v_add_u32 v14, 30720, v12
v_add_u32 v15, 46080, v26
s_lshl_b32 s28, s3, 13
s_lshl_b32 s24, s21, 19
s_lshl_b32 s22, s3, 17
s_add_u32 s24, s24, s22
s_add_u32 s25, s24, 65536
s_mov_b32 s10, 4194304
s_mov_b32 s11, 0x20000
s_and_b32 s20, s2, 7
s_lshl_b32 s20, s20, 1
s_bfe_u32 s22, s2, 0x10003
s_add_u32 s20, s20, s22
v_lshrrev_b32 v26, 5, v29
v_and_b32 v27, 31, v29
s_and_b32 s22, s3, 1
s_lshl_b32 s22, s22, 2
v_or_b32 v28, s22, v26
v_lshlrev_b32 v28, 1, v28
v_xor_b32 v27, v27, v28
v_lshlrev_b32 v27, 4, v27
v_lshl_add_u32 v16, v26, 13, v27
v_xor_b32 v26, 64, v16
v_add_u32 v17, 15360, v26
v_add_u32 v18, 30720, v16
v_add_u32 v19, 46080, v26
s_lshl_b32 s29, s3, 12
s_lshl_b32 s26, s3, 16
s_lshl_b32 s22, s20, 9
s_add_u32 s26, s26, s22
s_add_u32 s27, s26, 262144
s_mov_b32 s14, 8388608
s_mov_b32 s15, 0x20000
s_mov_b32 s101, 0x40000
v_and_b32 v30, 15, v29
v_lshrrev_b32 v31, 4, v29
v_lshrrev_b32 v26, 1, v30
v_xor_b32 v26, v31, v26
v_lshlrev_b32 v26, 4, v26
v_lshl_add_u32 v2, v30, 7, v26
s_lshr_b32 s22, s3, 1
s_lshl_b32 s22, s22, 14
v_add_u32 v2, s22, v2
v_xor_b32 v3, 64, v2
v_lshrrev_b32 v26, 2, v30
v_and_b32 v27, 1, v31
v_lshl_or_b32 v27, v27, 2, v26
v_lshl_add_u32 v26, v31, 3, v26
v_lshlrev_b32 v26, 9, v26
v_lshl_add_u32 v26, v27, 5, v26
v_and_b32 v27, 3, v29
v_lshl_add_u32 v26, v27, 3, v26
s_and_b32 s22, s3, 1
s_lshl_b32 s22, s22, 8
s_add_u32 s22, s22, 0x10000
v_xor_b32 v4, s22, v26
v_xor_b32 v5, 32, v4
v_xor_b32 v6, 64, v4
v_xor_b32 v7, 96, v4
v_xor_b32 v8, 128, v4
v_xor_b32 v9, 160, v4
v_xor_b32 v10, 192, v4
v_xor_b32 v11, 224, v4
s_mov_b32 s19, 0x20000
s_cmp_eq_u32 s3, 2
s_cbranch_scc1 M_pf2
s_cmp_lg_u32 s3, 0
s_cbranch_scc1 M_pf3
s_mov_b32 s18, 8388608
s_mov_b32 s51, 8388608
s_mov_b32 s47, 524288
s_mov_b32 s43, 524288
s_lshl_b32 s22, s21, 16
s_lshl_b32 s23, s20, 9
s_add_u32 s22, s22, s23
v_bfe_u32 v26, v29, 2, 3
v_lshl_add_u32 v26, v26, 13, s22
v_and_b32 v27, 3, v29
v_lshl_add_u32 v20, v27, 7, v26
v_lshrrev_b32 v27, 5, v29
v_lshl_add_u32 v22, v27, 19, v20
s_mov_b32 s47, 786432
s_mov_b32 s43, 0
v_add_u32 v22, 524288, v22
s_mul_i32 s22, s21, 98304
s_add_u32 s22, s22, s23
v_lshrrev_b32 v26, 2, v29
v_lshl_add_u32 v26, v26, 13, s22
v_and_b32 v27, 3, v29
v_lshl_add_u32 v20, v27, 7, v26
v_cmp_gt_u32 vcc, 48, v29
s_branch M_pfd
M_pf2:
s_mov_b32 s18, 4194304
s_mov_b32 s51, 2048
s_mov_b32 s47, 256
s_mov_b32 s43, 0
s_lshl_b32 s22, s2, 14
v_bfe_u32 v26, v29, 1, 3
v_lshl_add_u32 v26, v26, 11, s22
v_and_b32 v27, 1, v29
v_lshl_add_u32 v20, v27, 7, v26
v_bfe_u32 v27, v29, 4, 1
v_lshl_add_u32 v22, v27, 8, v20
v_cmp_gt_u32 vcc, 16, v29
s_branch M_pfd
M_pf3:
s_mov_b32 s18, 0
s_mov_b32 s51, 2260992
s_mov_b32 s47, 753664
s_mov_b32 s43, 0
s_mul_i32 s22, s2, 2944
v_lshl_add_u32 v20, v29, 7, s22
v_mov_b32 v22, v20
v_cmp_gt_u32 vcc, 23, v29
M_pfd:
v_mov_b32 v26, 3221225472
s_nop 0
v_cndmask_b32 v20, v26, v20, vcc
s_bitcmp1_b32 s2, 4
s_waitcnt lgkmcnt(0)
s_mov_b64 s[8:9], s[78:79]
s_cselect_b64 s[12:13], s[84:85], s[82:83]
s_cmp_eq_u32 s3, 2
s_cselect_b32 s22, 0, 3221225472
buffer_load_dword v21, v20, s[8:11], s22 offen
s_add_u32 m0, s28, 0
s_nop 0
buffer_load_dwordx4 v12, s[8:11], s24 offen offset:0 lds
buffer_load_dwordx4 v13, s[8:11], s24 offen offset:1024 lds
buffer_load_dwordx4 v14, s[8:11], s24 offen offset:2048 lds
buffer_load_dwordx4 v15, s[8:11], s24 offen offset:3072 lds
s_add_u32 s24, s24, 128
s_add_u32 m0, s28, 4096
s_nop 0
buffer_load_dwordx4 v12, s[8:11], s25 offen offset:0 lds
buffer_load_dwordx4 v13, s[8:11], s25 offen offset:1024 lds
buffer_load_dwordx4 v14, s[8:11], s25 offen offset:2048 lds
buffer_load_dwordx4 v15, s[8:11], s25 offen offset:3072 lds
s_add_u32 s25, s25, 128
s_add_u32 m0, s29, 65536
s_nop 0
buffer_load_dwordx4 v16, s[12:15], s26 offen offset:0 lds
buffer_load_dwordx4 v17, s[12:15], s26 offen offset:1024 lds
buffer_load_dwordx4 v18, s[12:15], s26 offen offset:2048 lds
buffer_load_dwordx4 v19, s[12:15], s26 offen offset:3072 lds
s_add_u32 s26, s26, 524288
s_add_u32 m0, s29, 81920
s_nop 0
buffer_load_dwordx4 v16, s[12:15], s27 offen offset:0 lds
buffer_load_dwordx4 v17, s[12:15], s27 offen offset:1024 lds
buffer_load_dwordx4 v18, s[12:15], s27 offen offset:2048 lds
buffer_load_dwordx4 v19, s[12:15], s27 offen offset:3072 lds
s_add_u32 s27, s27, 524288
s_mov_b64 exec, 0
s_bfe_u32 s22, s2, 0x10004
s_lshl_b32 s22, s22, 2
s_add_u32 s22, s22, s3
s_cmp_lg_u32 s22, 0
s_cbranch_scc1 M_tw1
s_call_b64 s[98:99], PAD_0
s_call_b64 s[98:99], PAD_8
s_call_b64 s[98:99], PAD_12
s_call_b64 s[98:99], PAD_16
s_branch M_td
M_tw1:
s_cmp_lg_u32 s22, 1
s_cbranch_scc1 M_tw2
s_call_b64 s[98:99], PAD_1
s_call_b64 s[98:99], PAD_9
s_call_b64 s[98:99], PAD_13
s_branch M_td
M_tw2:
s_cmp_lg_u32 s22, 2
s_cbranch_scc1 M_tw3
s_call_b64 s[98:99], PAD_2
s_call_b64 s[98:99], PAD_6
s_call_b64 s[98:99], PAD_10
s_call_b64 s[98:99], PAD_14
s_branch M_td
M_tw3:
s_cmp_lg_u32 s22, 3
s_cbranch_scc1 M_tw4
s_call_b64 s[98:99], PAD_3
s_call_b64 s[98:99], PAD_7
s_call_b64 s[98:99], PAD_11
s_call_b64 s[98:99], PAD_15
s_branch M_td
M_tw4:
s_cmp_lg_u32 s22, 4
s_cbranch_scc1 M_tw5
s_call_b64 s[98:99], PAD_22
s_branch M_td
M_tw5:
s_cmp_lg_u32 s22, 5
s_cbranch_scc1 M_tw6
s_call_b64 s[98:99], PAD_23
s_branch M_td
M_tw6:
s_cmp_lg_u32 s22, 6
s_cbranch_scc1 M_tw7
s_call_b64 s[98:99], PAD_24
s_branch M_td
M_tw7:
s_call_b64 s[98:99], PAD_21
M_td:
s_mov_b64 exec, -1
s_cmp_eq_u32 s3, 0
s_cselect_b64 s[16:17], s[12:13], s[8:9]
buffer_load_dword v21, v22, s[16:19], s43 offen
s_add_u32 s43, s43, s47
s_add_u32 s43, s43, s47
s_add_u32 m0, s28, 32768
s_nop 0
buffer_load_dwordx4 v12, s[8:11], s24 offen offset:0 lds
buffer_load_dwordx4 v13, s[8:11], s24 offen offset:1024 lds
buffer_load_dwordx4 v14, s[8:11], s24 offen offset:2048 lds
buffer_load_dwordx4 v15, s[8:11], s24 offen offset:3072 lds
s_add_u32 s24, s24, 128
s_add_u32 m0, s28, 36864
s_nop 0
buffer_load_dwordx4 v12, s[8:11], s25 offen offset:0 lds
buffer_load_dwordx4 v13, s[8:11], s25 offen offset:1024 lds
buffer_load_dwordx4 v14, s[8:11], s25 offen offset:2048 lds
buffer_load_dwordx4 v15, s[8:11], s25 offen offset:3072 lds
s_add_u32 s25, s25, 128
s_mov_b32 s4, s92
s_mov_b32 s5, s93
s_mov_b32 s6, 268435456
s_mov_b32 s7, 0x20000
s_cmp_eq_u32 s3, 3
s_cselect_b64 s[40:41], s[76:77], s[80:81]
s_cselect_b32 s42, 1835008, 0
s_cmp_eq_u32 s3, 1
s_cselect_b32 s42, 3670016, s42
s_cmp_eq_u32 s3, 3
s_cselect_b64 s[44:45], s[86:87], s[72:73]
s_cselect_b32 s46, 3670016, 0
s_cmp_eq_u32 s3, 1
s_cselect_b32 s46, 1835008, s46
s_cmp_eq_u32 s3, 2
s_cselect_b64 s[40:41], s[64:65], s[40:41]
s_cselect_b32 s42, 1835008, s42
s_waitcnt vmcnt(17)
s_barrier
ds_read_b128 a[0:3], v2 offset:0
ds_read_b128 a[4:7], v3 offset:0
ds_read_b128 a[8:11], v2 offset:2048
ds_read_b128 a[12:15], v3 offset:2048
ds_read_b128 a[16:19], v2 offset:4096
ds_read_b128 a[20:23], v3 offset:4096
ds_read_b128 a[24:27], v2 offset:6144
ds_read_b128 a[28:31], v3 offset:6144
ds_read_b128 a[32:35], v2 offset:8192
ds_read_b128 a[36:39], v3 offset:8192
ds_read_b128 a[40:43], v2 offset:10240
ds_read_b128 a[44:47], v3 offset:10240
ds_read_b128 a[48:51], v2 offset:12288
ds_read_b128 a[52:55], v3 offset:12288
ds_read_b128 a[56:59], v2 offset:14336
ds_read_b128 a[60:63], v3 offset:14336
s_waitcnt vmcnt(9) lgkmcnt(0)
s_barrier
ds_read_b64_tr_b16 a[128:129], v4 offset:0
ds_read_b64_tr_b16 a[130:131], v4 offset:2048
ds_read_b64_tr_b16 a[132:133], v4 offset:16384
ds_read_b64_tr_b16 a[134:135], v4 offset:18432
s_waitcnt lgkmcnt(0)
s_bitcmp1_b32 s2, 4
s_cbranch_scc1 M_V
s_branch M_K
M_t2B:
s_mov_b64 exec, 0
s_cmp_lg_u32 s3, 0
s_cbranch_scc1 M_uw1
s_call_b64 s[98:99], PAD_32
s_call_b64 s[98:99], PAD_16
s_branch M_ud
M_uw1:
s_cmp_lg_u32 s3, 1
s_cbranch_scc1 M_uw2
s_call_b64 s[98:99], PAD_9
s_call_b64 s[98:99], PAD_33
s_call_b64 s[98:99], PAD_13
s_branch M_ud
M_uw2:
s_cmp_lg_u32 s3, 2
s_cbranch_scc1 M_uw3
s_call_b64 s[98:99], PAD_10
s_call_b64 s[98:99], PAD_34
s_call_b64 s[98:99], PAD_14
s_branch M_ud
M_uw3:
s_call_b64 s[98:99], PAD_11
s_call_b64 s[98:99], PAD_15
M_ud:
s_mov_b64 exec, -1
s_branch M_t2Br
M_t2A:
s_mov_b64 exec, 0
s_lshl_b32 s22, s24, 2
s_add_u32 s22, s22, s3
s_cmp_lg_u32 s22, 0
s_cbranch_scc1 M_vw1
s_call_b64 s[98:99], PAD_32
s_call_b64 s[98:99], PAD_16
s_branch M_vd
M_vw1:
s_cmp_lg_u32 s22, 1
s_cbranch_scc1 M_vw2
s_call_b64 s[98:99], PAD_13
s_branch M_vd
M_vw2:
s_cmp_lg_u32 s22, 2
s_cbranch_scc1 M_vw3
s_call_b64 s[98:99], PAD_14
s_call_b64 s[98:99], PAD_19
s_branch M_vd
M_vw3:
s_cmp_lg_u32 s22, 3
s_cbranch_scc1 M_vw4
s_call_b64 s[98:99], PAD_15
s_call_b64 s[98:99], PAD_20
s_branch M_vd
M_vw4:
s_cmp_lg_u32 s22, 4
s_cbranch_scc1 M_vw5
s_call_b64 s[98:99], PAD_12
s_call_b64 s[98:99], PAD_16
s_branch M_vd
M_vw5:
s_cmp_lg_u32 s22, 5
s_cbranch_scc1 M_vw6
s_call_b64 s[98:99], PAD_13
s_branch M_vd
M_vw6:
s_cmp_lg_u32 s22, 6
s_cbranch_scc1 M_vw7
s_call_b64 s[98:99], PAD_14
s_branch M_vd
M_vw7:
s_call_b64 s[98:99], PAD_15
M_vd:
s_mov_b64 exec, -1
s_branch M_t2Ar
M_tret:
s_setpc_b64 s[98:99]
.p2align 12
PAD_0:
s_cbranch_execz PAD_4
M_K:
v_mfma_f32_16x16x32_bf16 v[32:35], a[128:131], a[0:3], 0
s_add_u32 m0, s29, 98304
ds_read_b64_tr_b16 a[136:137], v5 offset:0
v_mfma_f32_16x16x32_bf16 v[32:35], a[132:135], a[4:7], v[32:35]
s_mov_b32 s32, 8192
buffer_load_dwordx4 v16, s[12:15], s26 offen offset:0 lds
v_mfma_f32_16x16x32_bf16 v[40:43], a[128:131], a[8:11], 0
s_mov_b32 s33, 8192
ds_read_b64_tr_b16 a[138:139], v5 offset:2048
v_mfma_f32_16x16x32_bf16 v[40:43], a[132:135], a[12:15], v[40:43]
s_mov_b32 s34, 8192
v_mfma_f32_16x16x32_bf16 v[48:51], a[128:131], a[16:19], 0
s_mov_b32 s35, 4294910976
ds_read_b64_tr_b16 a[140:141], v5 offset:16384
v_mfma_f32_16x16x32_bf16 v[48:51], a[132:135], a[20:23], v[48:51]
s_mov_b32 s36, 4294910976
buffer_load_dwordx4 v17, s[12:15], s26 offen offset:1024 lds
v_mfma_f32_16x16x32_bf16 v[56:59], a[128:131], a[24:27], 0
s_mov_b32 s30, 8
ds_read_b64_tr_b16 a[142:143], v5 offset:18432
v_mfma_f32_16x16x32_bf16 v[56:59], a[132:135], a[28:31], v[56:59]
s_mov_b32 s82, 3221225472
v_mfma_f32_16x16x32_bf16 v[64:67], a[128:131], a[32:35], 0
s_mul_hi_u32 s38, s2, 613566757
v_mfma_f32_16x16x32_bf16 v[64:67], a[132:135], a[36:39], v[64:67]
s_mul_i32 s39, s38, 7
buffer_load_dwordx4 v18, s[12:15], s26 offen offset:2048 lds
v_mfma_f32_16x16x32_bf16 v[72:75], a[128:131], a[40:43], 0
s_sub_u32 s39, s2, s39
v_mov_b32 v246, 0
v_mov_b32 v229, 0
v_mfma_f32_16x16x32_bf16 v[72:75], a[132:135], a[44:47], v[72:75]
v_mov_b32 v231, 0
v_mfma_f32_16x16x32_bf16 v[80:83], a[128:131], a[48:51], 0
s_mov_b32 s60, s90
v_mfma_f32_16x16x32_bf16 v[80:83], a[132:135], a[52:55], v[80:83]
s_mov_b32 s61, s91
buffer_load_dwordx4 v19, s[12:15], s26 offen offset:3072 lds
v_mfma_f32_16x16x32_bf16 v[88:91], a[128:131], a[56:59], 0
s_add_u32 s26, s26, 524288
v_mfma_f32_16x16x32_bf16 v[88:91], a[132:135], a[60:63], v[88:91]
s_waitcnt lgkmcnt(0)
s_mov_b32 s62, 256
v_mfma_f32_16x16x32_bf16 v[36:39], a[136:139], a[0:3], 0
s_add_u32 m0, s29, 114688
ds_read_b64_tr_b16 a[128:129], v6 offset:0
v_mfma_f32_16x16x32_bf16 v[36:39], a[140:143], a[4:7], v[36:39]
s_mov_b32 s63, 0x20000
buffer_load_dwordx4 v16, s[12:15], s27 offen offset:0 lds
v_mfma_f32_16x16x32_bf16 v[44:47], a[136:139], a[8:11], 0
s_mul_hi_u32 s55, s2, 1431655766
ds_read_b64_tr_b16 a[130:131], v6 offset:2048
v_mfma_f32_16x16x32_bf16 v[44:47], a[140:143], a[12:15], v[44:47]
s_mul_i32 s55, s55, 3
v_mfma_f32_16x16x32_bf16 v[52:55], a[136:139], a[16:19], 0
s_sub_u32 s55, s2, s55
ds_read_b64_tr_b16 a[132:133], v6 offset:16384
v_mfma_f32_16x16x32_bf16 v[52:55], a[140:143], a[20:23], v[52:55]
s_add_u32 s55, s55, 5
buffer_load_dwordx4 v17, s[12:15], s27 offen offset:1024 lds
v_mfma_f32_16x16x32_bf16 v[60:63], a[136:139], a[24:27], 0
s_lshr_b32 s22, s2, 4
ds_read_b64_tr_b16 a[134:135], v6 offset:18432
v_mfma_f32_16x16x32_bf16 v[60:63], a[140:143], a[28:31], v[60:63]
s_lshl_b32 s23, s20, 5
v_mfma_f32_16x16x32_bf16 v[68:71], a[136:139], a[32:35], 0
s_add_u32 s23, s23, s22
v_mfma_f32_16x16x32_bf16 v[68:71], a[140:143], a[36:39], v[68:71]
s_lshl_b32 s23, s23, 2
buffer_load_dwordx4 v18, s[12:15], s27 offen offset:2048 lds
v_mfma_f32_16x16x32_bf16 v[76:79], a[136:139], a[40:43], 0
s_and_b32 s22, s2, 16
v_mfma_f32_16x16x32_bf16 v[76:79], a[140:143], a[44:47], v[76:79]
s_lshl_b32 s22, s22, 7
v_mfma_f32_16x16x32_bf16 v[84:87], a[136:139], a[48:51], 0
s_add_u32 s23, s23, s22
v_mov_b32 v28, 3221225472
v_writelane_b32 v28, s23, 0
v_mfma_f32_16x16x32_bf16 v[84:87], a[140:143], a[52:55], v[84:87]
s_add_u32 s56, s23, 16384
buffer_load_dwordx4 v19, s[12:15], s27 offen offset:3072 lds
v_mfma_f32_16x16x32_bf16 v[92:95], a[136:139], a[56:59], 0
s_add_u32 s27, s27, 524288
v_writelane_b32 v28, s56, 1
v_mfma_f32_16x16x32_bf16 v[92:95], a[140:143], a[60:63], v[92:95]
s_waitcnt lgkmcnt(0)
s_add_u32 s56, s23, 4096
v_writelane_b32 v28, s56, 2
v_mfma_f32_16x16x32_bf16 v[96:99], a[128:131], a[0:3], 0
s_add_u32 m0, s28, 0
ds_read_b64_tr_b16 a[136:137], v7 offset:0
v_mfma_f32_16x16x32_bf16 v[96:99], a[132:135], a[4:7], v[96:99]
s_sub_u32 s37, 15, s21
buffer_load_dwordx4 v12, s[8:11], s24 offen offset:0 lds
v_mfma_f32_16x16x32_bf16 v[104:107], a[128:131], a[8:11], 0
ds_read_b64_tr_b16 a[138:139], v7 offset:2048
v_mfma_f32_16x16x32_bf16 v[104:107], a[132:135], a[12:15], v[104:107]
v_mfma_f32_16x16x32_bf16 v[112:115], a[128:131], a[16:19], 0
ds_read_b64_tr_b16 a[140:141], v7 offset:16384
v_mfma_f32_16x16x32_bf16 v[112:115], a[132:135], a[20:23], v[112:115]
buffer_load_dwordx4 v13, s[8:11], s24 offen offset:1024 lds
v_mfma_f32_16x16x32_bf16 v[120:123], a[128:131], a[24:27], 0
ds_read_b64_tr_b16 a[142:143], v7 offset:18432
v_mfma_f32_16x16x32_bf16 v[120:123], a[132:135], a[28:31], v[120:123]
v_mfma_f32_16x16x32_bf16 v[128:131], a[128:131], a[32:35], 0
v_mfma_f32_16x16x32_bf16 v[128:131], a[132:135], a[36:39], v[128:131]
buffer_load_dwordx4 v14, s[8:11], s24 offen offset:2048 lds
v_mfma_f32_16x16x32_bf16 v[136:139], a[128:131], a[40:43], 0
v_mfma_f32_16x16x32_bf16 v[136:139], a[132:135], a[44:47], v[136:139]
v_mfma_f32_16x16x32_bf16 v[144:147], a[128:131], a[48:51], 0
v_mfma_f32_16x16x32_bf16 v[144:147], a[132:135], a[52:55], v[144:147]
buffer_load_dwordx4 v15, s[8:11], s24 offen offset:3072 lds
v_mfma_f32_16x16x32_bf16 v[152:155], a[128:131], a[56:59], 0
s_add_u32 s24, s24, 128
v_mfma_f32_16x16x32_bf16 v[152:155], a[132:135], a[60:63], v[152:155]
s_waitcnt vmcnt(12) lgkmcnt(0)
s_barrier
v_mfma_f32_16x16x32_bf16 v[100:103], a[136:139], a[0:3], 0
s_add_u32 m0, s28, 4096
ds_read_b64_tr_b16 a[128:129], v8 offset:0
v_mfma_f32_16x16x32_bf16 v[100:103], a[140:143], a[4:7], v[100:103]
buffer_load_dwordx4 v12, s[8:11], s25 offen offset:0 lds
v_mfma_f32_16x16x32_bf16 v[108:111], a[136:139], a[8:11], 0
ds_read_b64_tr_b16 a[130:131], v8 offset:2048
v_mfma_f32_16x16x32_bf16 v[108:111], a[140:143], a[12:15], v[108:111]
v_mfma_f32_16x16x32_bf16 v[116:119], a[136:139], a[16:19], 0
ds_read_b64_tr_b16 a[132:133], v8 offset:16384
v_mfma_f32_16x16x32_bf16 v[116:119], a[140:143], a[20:23], v[116:119]
buffer_load_dwordx4 v13, s[8:11], s25 offen offset:1024 lds
v_mfma_f32_16x16x32_bf16 v[124:127], a[136:139], a[24:27], 0
ds_read_b64_tr_b16 a[134:135], v8 offset:18432
v_mfma_f32_16x16x32_bf16 v[124:127], a[140:143], a[28:31], v[124:127]
v_mfma_f32_16x16x32_bf16 v[132:135], a[136:139], a[32:35], 0
ds_read_b128 a[64:67], v2 offset:32768
v_mfma_f32_16x16x32_bf16 v[132:135], a[140:143], a[36:39], v[132:135]
buffer_load_dwordx4 v14, s[8:11], s25 offen offset:2048 lds
v_mfma_f32_16x16x32_bf16 v[140:143], a[136:139], a[40:43], 0
ds_read_b128 a[68:71], v3 offset:32768
v_mfma_f32_16x16x32_bf16 v[140:143], a[140:143], a[44:47], v[140:143]
ds_read_b128 a[72:75], v2 offset:34816
v_mfma_f32_16x16x32_bf16 v[148:151], a[136:139], a[48:51], 0
ds_read_b128 a[76:79], v3 offset:34816
v_mfma_f32_16x16x32_bf16 v[148:151], a[140:143], a[52:55], v[148:151]
buffer_load_dwordx4 v15, s[8:11], s25 offen offset:3072 lds
v_mfma_f32_16x16x32_bf16 v[156:159], a[136:139], a[56:59], 0
s_add_u32 s25, s25, 128
ds_read_b128 a[80:83], v2 offset:36864
v_mfma_f32_16x16x32_bf16 v[156:159], a[140:143], a[60:63], v[156:159]
s_waitcnt lgkmcnt(5)
ds_read_b128 a[84:87], v3 offset:36864
v_mfma_f32_16x16x32_bf16 v[160:163], a[128:131], a[0:3], 0
s_bitcmp1_b32 s2, 4
s_cselect_b32 s37, s21, s37
ds_read_b64_tr_b16 a[136:137], v9 offset:0
v_mfma_f32_16x16x32_bf16 v[160:163], a[132:135], a[4:7], v[160:163]
s_lshl_b32 s56, s37, 5
s_add_u32 s56, s56, s20
s_lshl_b32 s56, s56, 2
v_mfma_f32_16x16x32_bf16 v[168:171], a[128:131], a[8:11], 0
s_add_u32 s56, s56, 8192
ds_read_b64_tr_b16 a[138:139], v9 offset:2048
v_writelane_b32 v28, s56, 3
v_mfma_f32_16x16x32_bf16 v[168:171], a[132:135], a[12:15], v[168:171]
s_add_u32 s56, s56, 2048
v_writelane_b32 v28, s56, 6
v_mfma_f32_16x16x32_bf16 v[176:179], a[128:131], a[16:19], 0
s_add_u32 s56, s56, 4096
ds_read_b64_tr_b16 a[140:141], v9 offset:16384
v_writelane_b32 v28, s56, 5
v_mfma_f32_16x16x32_bf16 v[176:179], a[132:135], a[20:23], v[176:179]
s_lshl_b32 s56, s2, 2
s_add_u32 s56, s56, 12288
v_writelane_b32 v28, s56, 4
v_mfma_f32_16x16x32_bf16 v[184:187], a[128:131], a[24:27], 0
s_lshl_b32 s56, s39, 5
s_add_u32 s56, s56, s38
ds_read_b64_tr_b16 a[142:143], v9 offset:18432
v_mfma_f32_16x16x32_bf16 v[184:187], a[132:135], a[28:31], v[184:187]
s_lshl_b32 s56, s56, 2
s_add_u32 s56, s56, 20480
s_cmp_lt_u32 s2, 224
v_mfma_f32_16x16x32_bf16 v[192:195], a[128:131], a[32:35], 0
s_cselect_b32 s56, s56, 3221225472
v_writelane_b32 v28, s56, 7
v_mfma_f32_16x16x32_bf16 v[192:195], a[132:135], a[36:39], v[192:195]
s_cmp_eq_u32 s3, 0
s_cselect_b32 s56, 94371840, 3221225472
v_mfma_f32_16x16x32_bf16 v[200:203], a[128:131], a[40:43], 0
ds_read_b128 a[88:91], v2 offset:38912
v_mfma_f32_16x16x32_bf16 v[200:203], a[132:135], a[44:47], v[200:203]
ds_read_b128 a[92:95], v3 offset:38912
v_mfma_f32_16x16x32_bf16 v[208:211], a[128:131], a[48:51], 0
ds_read_b128 a[96:99], v2 offset:40960
v_mfma_f32_16x16x32_bf16 v[208:211], a[132:135], a[52:55], v[208:211]
buffer_store_dword v246, v28, s[4:7], s56 offen sc1
v_mfma_f32_16x16x32_bf16 v[216:219], a[128:131], a[56:59], 0
ds_read_b128 a[100:103], v3 offset:40960
v_mov_b32 v27, 1
v_mfma_f32_16x16x32_bf16 v[216:219], a[132:135], a[60:63], v[216:219]
s_waitcnt lgkmcnt(4)
ds_read_b128 a[104:107], v2 offset:43008
v_cmp_eq_u32 vcc, 0, v0
v_mfma_f32_16x16x32_bf16 v[164:167], a[136:139], a[0:3], 0
ds_read_b64_tr_b16 a[128:129], v10 offset:0
v_mov_b32 v26, 3221225472
v_mfma_f32_16x16x32_bf16 v[164:167], a[140:143], a[4:7], v[164:167]
s_lshl_b32 s31, s20, 20
s_lshl_b32 s22, s21, 17
v_cndmask_b32 v26, v26, v246, vcc
v_mfma_f32_16x16x32_bf16 v[172:175], a[136:139], a[8:11], 0
s_add_u32 s31, s31, s22
s_lshr_b32 s22, s3, 1
ds_read_b64_tr_b16 a[130:131], v10 offset:2048
v_mfma_f32_16x16x32_bf16 v[172:175], a[140:143], a[12:15], v[172:175]
s_lshl_b32 s22, s22, 16
s_add_u32 s31, s31, s22
s_and_b32 s22, s3, 1
v_mfma_f32_16x16x32_bf16 v[180:183], a[136:139], a[16:19], 0
s_lshl_b32 s22, s22, 12
s_add_u32 s31, s31, s22
ds_read_b64_tr_b16 a[132:133], v10 offset:16384
v_mfma_f32_16x16x32_bf16 v[180:183], a[140:143], a[20:23], v[180:183]
v_mfma_f32_16x16x32_bf16 v[188:191], a[136:139], a[24:27], 0
ds_read_b64_tr_b16 a[134:135], v10 offset:18432
v_mfma_f32_16x16x32_bf16 v[188:191], a[140:143], a[28:31], v[188:191]
v_mfma_f32_16x16x32_bf16 v[196:199], a[136:139], a[32:35], 0
v_mfma_f32_16x16x32_bf16 v[196:199], a[140:143], a[36:39], v[196:199]
v_mfma_f32_16x16x32_bf16 v[204:207], a[136:139], a[40:43], 0
ds_read_b128 a[108:111], v3 offset:43008
v_mfma_f32_16x16x32_bf16 v[204:207], a[140:143], a[44:47], v[204:207]
ds_read_b128 a[112:115], v2 offset:45056
v_mfma_f32_16x16x32_bf16 v[212:215], a[136:139], a[48:51], 0
ds_read_b128 a[116:119], v3 offset:45056
v_mfma_f32_16x16x32_bf16 v[212:215], a[140:143], a[52:55], v[212:215]
v_mfma_f32_16x16x32_bf16 v[220:223], a[136:139], a[56:59], 0
ds_read_b128 a[120:123], v2 offset:47104
v_mfma_f32_16x16x32_bf16 v[220:223], a[140:143], a[60:63], v[220:223]
s_waitcnt lgkmcnt(4)
ds_read_b128 a[124:127], v3 offset:47104
v_mfma_f32_16x16x32_bf16 a[192:195], a[128:131], a[0:3], 0
ds_read_b64_tr_b16 a[136:137], v11 offset:0
v_mfma_f32_16x16x32_bf16 a[192:195], a[132:135], a[4:7], a[192:195]
v_mfma_f32_16x16x32_bf16 a[200:203], a[128:131], a[8:11], 0
ds_read_b64_tr_b16 a[138:139], v11 offset:2048
v_mfma_f32_16x16x32_bf16 a[200:203], a[132:135], a[12:15], a[200:203]
v_mfma_f32_16x16x32_bf16 a[208:211], a[128:131], a[16:19], 0
ds_read_b64_tr_b16 a[140:141], v11 offset:16384
v_mfma_f32_16x16x32_bf16 a[208:211], a[132:135], a[20:23], a[208:211]
v_mfma_f32_16x16x32_bf16 a[216:219], a[128:131], a[24:27], 0
ds_read_b64_tr_b16 a[142:143], v11 offset:18432
v_mfma_f32_16x16x32_bf16 a[216:219], a[132:135], a[28:31], a[216:219]
v_mfma_f32_16x16x32_bf16 a[224:227], a[128:131], a[32:35], 0
v_mfma_f32_16x16x32_bf16 a[224:227], a[132:135], a[36:39], a[224:227]
v_mfma_f32_16x16x32_bf16 a[232:235], a[128:131], a[40:43], 0
v_mfma_f32_16x16x32_bf16 a[232:235], a[132:135], a[44:47], a[232:235]
v_mfma_f32_16x16x32_bf16 a[240:243], a[128:131], a[48:51], 0
v_mfma_f32_16x16x32_bf16 a[240:243], a[132:135], a[52:55], a[240:243]
v_mfma_f32_16x16x32_bf16 a[248:251], a[128:131], a[56:59], 0
s_waitcnt vmcnt(1) lgkmcnt(0)
v_mfma_f32_16x16x32_bf16 a[248:251], a[132:135], a[60:63], a[248:251]
s_barrier
v_mfma_f32_16x16x32_bf16 a[196:199], a[136:139], a[0:3], 0
s_add_u32 m0, s29, 65536
ds_read_b64_tr_b16 a[128:129], v4 offset:32768
v_mfma_f32_16x16x32_bf16 a[196:199], a[140:143], a[4:7], a[196:199]
buffer_load_dwordx4 v16, s[12:15], s26 offen offset:0 lds
v_mfma_f32_16x16x32_bf16 a[204:207], a[136:139], a[8:11], 0
ds_read_b64_tr_b16 a[130:131], v4 offset:34816
v_mfma_f32_16x16x32_bf16 a[204:207], a[140:143], a[12:15], a[204:207]
v_mfma_f32_16x16x32_bf16 a[212:215], a[136:139], a[16:19], 0
ds_read_b64_tr_b16 a[132:133], v4 offset:49152
v_mfma_f32_16x16x32_bf16 a[212:215], a[140:143], a[20:23], a[212:215]
buffer_load_dwordx4 v17, s[12:15], s26 offen offset:1024 lds
v_mfma_f32_16x16x32_bf16 a[220:223], a[136:139], a[24:27], 0
ds_read_b64_tr_b16 a[134:135], v4 offset:51200
v_mfma_f32_16x16x32_bf16 a[220:223], a[140:143], a[28:31], a[220:223]
v_mfma_f32_16x16x32_bf16 a[228:231], a[136:139], a[32:35], 0
v_mfma_f32_16x16x32_bf16 a[228:231], a[140:143], a[36:39], a[228:231]
buffer_load_dwordx4 v18, s[12:15], s26 offen offset:2048 lds
v_mfma_f32_16x16x32_bf16 a[236:239], a[136:139], a[40:43], 0
v_mfma_f32_16x16x32_bf16 a[236:239], a[140:143], a[44:47], a[236:239]
v_mfma_f32_16x16x32_bf16 a[244:247], a[136:139], a[48:51], 0
v_mfma_f32_16x16x32_bf16 a[244:247], a[140:143], a[52:55], a[244:247]
buffer_load_dwordx4 v19, s[12:15], s26 offen offset:3072 lds
v_mfma_f32_16x16x32_bf16 a[252:255], a[136:139], a[56:59], 0
s_add_u32 s26, s26, 524288
v_mfma_f32_16x16x32_bf16 a[252:255], a[140:143], a[60:63], a[252:255]
s_waitcnt lgkmcnt(0)
Lg_1:
v_mfma_f32_16x16x32_bf16 v[32:35], a[128:131], a[64:67], v[32:35]
s_add_u32 m0, s29, 81920
ds_read_b64_tr_b16 a[136:137], v5 offset:32768
v_mfma_f32_16x16x32_bf16 v[32:35], a[132:135], a[68:71], v[32:35]
buffer_load_dwordx4 v16, s[12:15], s27 offen offset:0 lds
v_mfma_f32_16x16x32_bf16 v[40:43], a[128:131], a[72:75], v[40:43]
ds_read_b64_tr_b16 a[138:139], v5 offset:34816
v_mfma_f32_16x16x32_bf16 v[40:43], a[132:135], a[76:79], v[40:43]
v_mfma_f32_16x16x32_bf16 v[48:51], a[128:131], a[80:83], v[48:51]
ds_read_b64_tr_b16 a[140:141], v5 offset:49152
v_mfma_f32_16x16x32_bf16 v[48:51], a[132:135], a[84:87], v[48:51]
buffer_load_dwordx4 v17, s[12:15], s27 offen offset:1024 lds
v_mfma_f32_16x16x32_bf16 v[56:59], a[128:131], a[88:91], v[56:59]
ds_read_b64_tr_b16 a[142:143], v5 offset:51200
v_mfma_f32_16x16x32_bf16 v[56:59], a[132:135], a[92:95], v[56:59]
v_mfma_f32_16x16x32_bf16 v[64:67], a[128:131], a[96:99], v[64:67]
ds_read_b128 a[0:3], v2 offset:0
v_mfma_f32_16x16x32_bf16 v[64:67], a[132:135], a[100:103], v[64:67]
buffer_load_dwordx4 v18, s[12:15], s27 offen offset:2048 lds
v_mfma_f32_16x16x32_bf16 v[72:75], a[128:131], a[104:107], v[72:75]
ds_read_b128 a[4:7], v3 offset:0
v_mfma_f32_16x16x32_bf16 v[72:75], a[132:135], a[108:111], v[72:75]
v_mfma_f32_16x16x32_bf16 v[80:83], a[128:131], a[112:115], v[80:83]
v_mfma_f32_16x16x32_bf16 v[80:83], a[132:135], a[116:119], v[80:83]
buffer_load_dwordx4 v19, s[12:15], s27 offen offset:3072 lds
v_mfma_f32_16x16x32_bf16 v[88:91], a[128:131], a[120:123], v[88:91]
s_add_u32 s27, s27, 524288
ds_read_b128 a[8:11], v2 offset:2048
v_mfma_f32_16x16x32_bf16 v[88:91], a[132:135], a[124:127], v[88:91]
s_waitcnt lgkmcnt(3)
v_mfma_f32_16x16x32_bf16 v[36:39], a[136:139], a[64:67], v[36:39]
s_add_u32 m0, s28, 32768
ds_read_b64_tr_b16 a[128:129], v6 offset:32768
v_mfma_f32_16x16x32_bf16 v[36:39], a[140:143], a[68:71], v[36:39]
buffer_load_dwordx4 v12, s[8:11], s24 offen offset:0 lds
v_mfma_f32_16x16x32_bf16 v[44:47], a[136:139], a[72:75], v[44:47]
ds_read_b64_tr_b16 a[130:131], v6 offset:34816
v_mfma_f32_16x16x32_bf16 v[44:47], a[140:143], a[76:79], v[44:47]
v_mfma_f32_16x16x32_bf16 v[52:55], a[136:139], a[80:83], v[52:55]
ds_read_b64_tr_b16 a[132:133], v6 offset:49152
v_mfma_f32_16x16x32_bf16 v[52:55], a[140:143], a[84:87], v[52:55]
buffer_load_dwordx4 v13, s[8:11], s24 offen offset:1024 lds
v_mfma_f32_16x16x32_bf16 v[60:63], a[136:139], a[88:91], v[60:63]
ds_read_b64_tr_b16 a[134:135], v6 offset:51200
v_mfma_f32_16x16x32_bf16 v[60:63], a[140:143], a[92:95], v[60:63]
v_mfma_f32_16x16x32_bf16 v[68:71], a[136:139], a[96:99], v[68:71]
ds_read_b128 a[12:15], v3 offset:2048
v_mfma_f32_16x16x32_bf16 v[68:71], a[140:143], a[100:103], v[68:71]
buffer_load_dwordx4 v14, s[8:11], s24 offen offset:2048 lds
v_mfma_f32_16x16x32_bf16 v[76:79], a[136:139], a[104:107], v[76:79]
v_mfma_f32_16x16x32_bf16 v[76:79], a[140:143], a[108:111], v[76:79]
v_mfma_f32_16x16x32_bf16 v[84:87], a[136:139], a[112:115], v[84:87]
ds_read_b128 a[16:19], v2 offset:4096
v_mfma_f32_16x16x32_bf16 v[84:87], a[140:143], a[116:119], v[84:87]
buffer_load_dwordx4 v15, s[8:11], s24 offen offset:3072 lds
v_mfma_f32_16x16x32_bf16 v[92:95], a[136:139], a[120:123], v[92:95]
s_add_u32 s24, s24, 128
ds_read_b128 a[20:23], v3 offset:4096
v_mfma_f32_16x16x32_bf16 v[92:95], a[140:143], a[124:127], v[92:95]
s_waitcnt lgkmcnt(3)
v_mfma_f32_16x16x32_bf16 v[96:99], a[128:131], a[64:67], v[96:99]
s_add_u32 m0, s28, 36864
ds_read_b64_tr_b16 a[136:137], v7 offset:32768
v_mfma_f32_16x16x32_bf16 v[96:99], a[132:135], a[68:71], v[96:99]
buffer_load_dwordx4 v12, s[8:11], s25 offen offset:0 lds
v_mfma_f32_16x16x32_bf16 v[104:107], a[128:131], a[72:75], v[104:107]
ds_read_b64_tr_b16 a[138:139], v7 offset:34816
v_mfma_f32_16x16x32_bf16 v[104:107], a[132:135], a[76:79], v[104:107]
v_mfma_f32_16x16x32_bf16 v[112:115], a[128:131], a[80:83], v[112:115]
ds_read_b64_tr_b16 a[140:141], v7 offset:49152
v_mfma_f32_16x16x32_bf16 v[112:115], a[132:135], a[84:87], v[112:115]
buffer_load_dwordx4 v13, s[8:11], s25 offen offset:1024 lds
v_mfma_f32_16x16x32_bf16 v[120:123], a[128:131], a[88:91], v[120:123]
ds_read_b64_tr_b16 a[142:143], v7 offset:51200
v_mfma_f32_16x16x32_bf16 v[120:123], a[132:135], a[92:95], v[120:123]
v_mfma_f32_16x16x32_bf16 v[128:131], a[128:131], a[96:99], v[128:131]
v_mfma_f32_16x16x32_bf16 v[128:131], a[132:135], a[100:103], v[128:131]
buffer_load_dwordx4 v14, s[8:11], s25 offen offset:2048 lds
v_mfma_f32_16x16x32_bf16 v[136:139], a[128:131], a[104:107], v[136:139]
ds_read_b128 a[24:27], v2 offset:6144
v_mfma_f32_16x16x32_bf16 v[136:139], a[132:135], a[108:111], v[136:139]
v_mfma_f32_16x16x32_bf16 v[144:147], a[128:131], a[112:115], v[144:147]
ds_read_b128 a[28:31], v3 offset:6144
v_mfma_f32_16x16x32_bf16 v[144:147], a[132:135], a[116:119], v[144:147]
buffer_load_dwordx4 v15, s[8:11], s25 offen offset:3072 lds
v_mfma_f32_16x16x32_bf16 v[152:155], a[128:131], a[120:123], v[152:155]
s_add_u32 s25, s25, 128
v_mfma_f32_16x16x32_bf16 v[152:155], a[132:135], a[124:127], v[152:155]
s_waitcnt lgkmcnt(2)
v_mfma_f32_16x16x32_bf16 v[100:103], a[136:139], a[64:67], v[100:103]
ds_read_b64_tr_b16 a[128:129], v8 offset:32768
v_mfma_f32_16x16x32_bf16 v[100:103], a[140:143], a[68:71], v[100:103]
buffer_load_dword v21, v20, s[16:19], s43 offen
v_mfma_f32_16x16x32_bf16 v[108:111], a[136:139], a[72:75], v[108:111]
s_add_u32 s43, s43, s47
ds_read_b64_tr_b16 a[130:131], v8 offset:34816
v_mfma_f32_16x16x32_bf16 v[108:111], a[140:143], a[76:79], v[108:111]
s_cmp_ge_u32 s43, s51
v_mfma_f32_16x16x32_bf16 v[116:119], a[136:139], a[80:83], v[116:119]
s_cselect_b32 s43, 0, s43
ds_read_b64_tr_b16 a[132:133], v8 offset:49152
v_mfma_f32_16x16x32_bf16 v[116:119], a[140:143], a[84:87], v[116:119]
s_cselect_b32 s51, s42, s51
v_mfma_f32_16x16x32_bf16 v[124:127], a[136:139], a[88:91], v[124:127]
s_cselect_b64 s[16:17], s[40:41], s[16:17]
ds_read_b64_tr_b16 a[134:135], v8 offset:51200
v_mfma_f32_16x16x32_bf16 v[124:127], a[140:143], a[92:95], v[124:127]
s_cselect_b32 s18, s42, s18
v_mfma_f32_16x16x32_bf16 v[132:135], a[136:139], a[96:99], v[132:135]
s_cselect_b64 s[40:41], s[44:45], s[40:41]
ds_read_b128 a[32:35], v2 offset:8192
v_mfma_f32_16x16x32_bf16 v[132:135], a[140:143], a[100:103], v[132:135]
s_cselect_b32 s42, s46, s42
v_mfma_f32_16x16x32_bf16 v[140:143], a[136:139], a[104:107], v[140:143]
s_cselect_b32 s46, 0, s46
v_mfma_f32_16x16x32_bf16 v[140:143], a[140:143], a[108:111], v[140:143]
s_cmp_eq_u32 s30, s55
v_mfma_f32_16x16x32_bf16 v[148:151], a[136:139], a[112:115], v[148:151]
s_cselect_b32 s22, 0, 3221225472
ds_read_b128 a[36:39], v3 offset:8192
v_mfma_f32_16x16x32_bf16 v[148:151], a[140:143], a[116:119], v[148:151]
s_sub_u32 s30, s30, 1
buffer_atomic_add v27, v26, s[60:63], s22 offen sc1
v_mfma_f32_16x16x32_bf16 v[156:159], a[136:139], a[120:123], v[156:159]
ds_read_b128 a[40:43], v2 offset:10240
v_mfma_f32_16x16x32_bf16 v[156:159], a[140:143], a[124:127], v[156:159]
s_waitcnt lgkmcnt(3)
v_mfma_f32_16x16x32_bf16 v[160:163], a[128:131], a[64:67], v[160:163]
ds_read_b64_tr_b16 a[136:137], v9 offset:32768
v_mfma_f32_16x16x32_bf16 v[160:163], a[132:135], a[68:71], v[160:163]
v_mfma_f32_16x16x32_bf16 v[168:171], a[128:131], a[72:75], v[168:171]
ds_read_b64_tr_b16 a[138:139], v9 offset:34816
v_mfma_f32_16x16x32_bf16 v[168:171], a[132:135], a[76:79], v[168:171]
v_mfma_f32_16x16x32_bf16 v[176:179], a[128:131], a[80:83], v[176:179]
ds_read_b64_tr_b16 a[140:141], v9 offset:49152
v_mfma_f32_16x16x32_bf16 v[176:179], a[132:135], a[84:87], v[176:179]
v_mfma_f32_16x16x32_bf16 v[184:187], a[128:131], a[88:91], v[184:187]
ds_read_b64_tr_b16 a[142:143], v9 offset:51200
v_mfma_f32_16x16x32_bf16 v[184:187], a[132:135], a[92:95], v[184:187]
v_mfma_f32_16x16x32_bf16 v[192:195], a[128:131], a[96:99], v[192:195]
v_mfma_f32_16x16x32_bf16 v[192:195], a[132:135], a[100:103], v[192:195]
v_mfma_f32_16x16x32_bf16 v[200:203], a[128:131], a[104:107], v[200:203]
ds_read_b128 a[44:47], v3 offset:10240
v_mfma_f32_16x16x32_bf16 v[200:203], a[132:135], a[108:111], v[200:203]
v_mfma_f32_16x16x32_bf16 v[208:211], a[128:131], a[112:115], v[208:211]
ds_read_b128 a[48:51], v2 offset:12288
v_mfma_f32_16x16x32_bf16 v[208:211], a[132:135], a[116:119], v[208:211]
v_mfma_f32_16x16x32_bf16 v[216:219], a[128:131], a[120:123], v[216:219]
v_mfma_f32_16x16x32_bf16 v[216:219], a[132:135], a[124:127], v[216:219]
s_waitcnt lgkmcnt(2)
v_mfma_f32_16x16x32_bf16 v[164:167], a[136:139], a[64:67], v[164:167]
ds_read_b64_tr_b16 a[128:129], v10 offset:32768
v_mfma_f32_16x16x32_bf16 v[164:167], a[140:143], a[68:71], v[164:167]
v_mfma_f32_16x16x32_bf16 v[172:175], a[136:139], a[72:75], v[172:175]
ds_read_b64_tr_b16 a[130:131], v10 offset:34816
v_mfma_f32_16x16x32_bf16 v[172:175], a[140:143], a[76:79], v[172:175]
v_mfma_f32_16x16x32_bf16 v[180:183], a[136:139], a[80:83], v[180:183]
ds_read_b64_tr_b16 a[132:133], v10 offset:49152
v_mfma_f32_16x16x32_bf16 v[180:183], a[140:143], a[84:87], v[180:183]
v_mfma_f32_16x16x32_bf16 v[188:191], a[136:139], a[88:91], v[188:191]
ds_read_b64_tr_b16 a[134:135], v10 offset:51200
v_mfma_f32_16x16x32_bf16 v[188:191], a[140:143], a[92:95], v[188:191]
v_mfma_f32_16x16x32_bf16 v[196:199], a[136:139], a[96:99], v[196:199]
ds_read_b128 a[52:55], v3 offset:12288
v_mfma_f32_16x16x32_bf16 v[196:199], a[140:143], a[100:103], v[196:199]
v_mfma_f32_16x16x32_bf16 v[204:207], a[136:139], a[104:107], v[204:207]
ds_read_b128 a[56:59], v2 offset:14336
v_mfma_f32_16x16x32_bf16 v[204:207], a[140:143], a[108:111], v[204:207]
v_mfma_f32_16x16x32_bf16 v[212:215], a[136:139], a[112:115], v[212:215]
v_mfma_f32_16x16x32_bf16 v[212:215], a[140:143], a[116:119], v[212:215]
v_mfma_f32_16x16x32_bf16 v[220:223], a[136:139], a[120:123], v[220:223]
ds_read_b128 a[60:63], v3 offset:14336
v_mfma_f32_16x16x32_bf16 v[220:223], a[140:143], a[124:127], v[220:223]
s_waitcnt lgkmcnt(3)
v_mfma_f32_16x16x32_bf16 a[192:195], a[128:131], a[64:67], a[192:195]
ds_read_b64_tr_b16 a[136:137], v11 offset:32768
v_mfma_f32_16x16x32_bf16 a[192:195], a[132:135], a[68:71], a[192:195]
v_mfma_f32_16x16x32_bf16 a[200:203], a[128:131], a[72:75], a[200:203]
ds_read_b64_tr_b16 a[138:139], v11 offset:34816
v_mfma_f32_16x16x32_bf16 a[200:203], a[132:135], a[76:79], a[200:203]
v_mfma_f32_16x16x32_bf16 a[208:211], a[128:131], a[80:83], a[208:211]
ds_read_b64_tr_b16 a[140:141], v11 offset:49152
v_mfma_f32_16x16x32_bf16 a[208:211], a[132:135], a[84:87], a[208:211]
v_mfma_f32_16x16x32_bf16 a[216:219], a[128:131], a[88:91], a[216:219]
ds_read_b64_tr_b16 a[142:143], v11 offset:51200
v_mfma_f32_16x16x32_bf16 a[216:219], a[132:135], a[92:95], a[216:219]
v_mfma_f32_16x16x32_bf16 a[224:227], a[128:131], a[96:99], a[224:227]
v_mfma_f32_16x16x32_bf16 a[224:227], a[132:135], a[100:103], a[224:227]
v_mfma_f32_16x16x32_bf16 a[232:235], a[128:131], a[104:107], a[232:235]
v_mfma_f32_16x16x32_bf16 a[232:235], a[132:135], a[108:111], a[232:235]
v_mfma_f32_16x16x32_bf16 a[240:243], a[128:131], a[112:115], a[240:243]
v_mfma_f32_16x16x32_bf16 a[240:243], a[132:135], a[116:119], a[240:243]
v_mfma_f32_16x16x32_bf16 a[248:251], a[128:131], a[120:123], a[248:251]
s_waitcnt vmcnt(2) lgkmcnt(0)
v_mfma_f32_16x16x32_bf16 a[248:251], a[132:135], a[124:127], a[248:251]
s_barrier
v_mfma_f32_16x16x32_bf16 a[196:199], a[136:139], a[64:67], a[196:199]
s_add_u32 m0, s29, 98304
ds_read_b64_tr_b16 a[128:129], v4 offset:0
v_mfma_f32_16x16x32_bf16 a[196:199], a[140:143], a[68:71], a[196:199]
buffer_load_dwordx4 v16, s[12:15], s26 offen offset:0 lds
v_mfma_f32_16x16x32_bf16 a[204:207], a[136:139], a[72:75], a[204:207]
ds_read_b64_tr_b16 a[130:131], v4 offset:2048
v_mfma_f32_16x16x32_bf16 a[204:207], a[140:143], a[76:79], a[204:207]
v_mfma_f32_16x16x32_bf16 a[212:215], a[136:139], a[80:83], a[212:215]
ds_read_b64_tr_b16 a[132:133], v4 offset:16384
v_mfma_f32_16x16x32_bf16 a[212:215], a[140:143], a[84:87], a[212:215]
buffer_load_dwordx4 v17, s[12:15], s26 offen offset:1024 lds
v_mfma_f32_16x16x32_bf16 a[220:223], a[136:139], a[88:91], a[220:223]
ds_read_b64_tr_b16 a[134:135], v4 offset:18432
v_mfma_f32_16x16x32_bf16 a[220:223], a[140:143], a[92:95], a[220:223]
v_mfma_f32_16x16x32_bf16 a[228:231], a[136:139], a[96:99], a[228:231]
v_mfma_f32_16x16x32_bf16 a[228:231], a[140:143], a[100:103], a[228:231]
buffer_load_dwordx4 v18, s[12:15], s26 offen offset:2048 lds
v_mfma_f32_16x16x32_bf16 a[236:239], a[136:139], a[104:107], a[236:239]
v_mfma_f32_16x16x32_bf16 a[236:239], a[140:143], a[108:111], a[236:239]
v_mfma_f32_16x16x32_bf16 a[244:247], a[136:139], a[112:115], a[244:247]
v_mfma_f32_16x16x32_bf16 a[244:247], a[140:143], a[116:119], a[244:247]
buffer_load_dwordx4 v19, s[12:15], s26 offen offset:3072 lds
v_mfma_f32_16x16x32_bf16 a[252:255], a[136:139], a[120:123], a[252:255]
s_add_u32 s26, s26, 524288
v_mfma_f32_16x16x32_bf16 a[252:255], a[140:143], a[124:127], a[252:255]
s_waitcnt lgkmcnt(0)
buffer_store_dword v27, v26, s[4:7], s82 offen sc1
v_mfma_f32_16x16x32_bf16 v[32:35], a[128:131], a[0:3], v[32:35]
s_add_u32 m0, s29, 114688
ds_read_b64_tr_b16 a[136:137], v5 offset:0
v_mfma_f32_16x16x32_bf16 v[32:35], a[132:135], a[4:7], v[32:35]
buffer_load_dwordx4 v16, s[12:15], s27 offen offset:0 lds
v_mfma_f32_16x16x32_bf16 v[40:43], a[128:131], a[8:11], v[40:43]
ds_read_b64_tr_b16 a[138:139], v5 offset:2048
v_mfma_f32_16x16x32_bf16 v[40:43], a[132:135], a[12:15], v[40:43]
v_mfma_f32_16x16x32_bf16 v[48:51], a[128:131], a[16:19], v[48:51]
ds_read_b64_tr_b16 a[140:141], v5 offset:16384
v_mfma_f32_16x16x32_bf16 v[48:51], a[132:135], a[20:23], v[48:51]
buffer_load_dwordx4 v17, s[12:15], s27 offen offset:1024 lds
v_mfma_f32_16x16x32_bf16 v[56:59], a[128:131], a[24:27], v[56:59]
ds_read_b64_tr_b16 a[142:143], v5 offset:18432
v_mfma_f32_16x16x32_bf16 v[56:59], a[132:135], a[28:31], v[56:59]
v_mfma_f32_16x16x32_bf16 v[64:67], a[128:131], a[32:35], v[64:67]
ds_read_b128 a[64:67], v2 offset:32768
v_mfma_f32_16x16x32_bf16 v[64:67], a[132:135], a[36:39], v[64:67]
buffer_load_dwordx4 v18, s[12:15], s27 offen offset:2048 lds
v_mfma_f32_16x16x32_bf16 v[72:75], a[128:131], a[40:43], v[72:75]
ds_read_b128 a[68:71], v3 offset:32768
v_mfma_f32_16x16x32_bf16 v[72:75], a[132:135], a[44:47], v[72:75]
v_mfma_f32_16x16x32_bf16 v[80:83], a[128:131], a[48:51], v[80:83]
v_mfma_f32_16x16x32_bf16 v[80:83], a[132:135], a[52:55], v[80:83]
buffer_load_dwordx4 v19, s[12:15], s27 offen offset:3072 lds
v_mfma_f32_16x16x32_bf16 v[88:91], a[128:131], a[56:59], v[88:91]
s_add_u32 s27, s27, 524288
ds_read_b128 a[72:75], v2 offset:34816
v_mfma_f32_16x16x32_bf16 v[88:91], a[132:135], a[60:63], v[88:91]
s_waitcnt lgkmcnt(3)
v_mfma_f32_16x16x32_bf16 v[36:39], a[136:139], a[0:3], v[36:39]
s_add_u32 m0, s28, 0
ds_read_b64_tr_b16 a[128:129], v6 offset:0
v_mfma_f32_16x16x32_bf16 v[36:39], a[140:143], a[4:7], v[36:39]
buffer_load_dwordx4 v12, s[8:11], s24 offen offset:0 lds
v_mfma_f32_16x16x32_bf16 v[44:47], a[136:139], a[8:11], v[44:47]
ds_read_b64_tr_b16 a[130:131], v6 offset:2048
v_mfma_f32_16x16x32_bf16 v[44:47], a[140:143], a[12:15], v[44:47]
v_mfma_f32_16x16x32_bf16 v[52:55], a[136:139], a[16:19], v[52:55]
ds_read_b64_tr_b16 a[132:133], v6 offset:16384
v_mfma_f32_16x16x32_bf16 v[52:55], a[140:143], a[20:23], v[52:55]
buffer_load_dwordx4 v13, s[8:11], s24 offen offset:1024 lds
v_mfma_f32_16x16x32_bf16 v[60:63], a[136:139], a[24:27], v[60:63]
ds_read_b64_tr_b16 a[134:135], v6 offset:18432
v_mfma_f32_16x16x32_bf16 v[60:63], a[140:143], a[28:31], v[60:63]
PAD_1:
s_cbranch_execz PAD_5
v_mfma_f32_16x16x32_bf16 v[68:71], a[136:139], a[32:35], v[68:71]
ds_read_b128 a[76:79], v3 offset:34816
v_mfma_f32_16x16x32_bf16 v[68:71], a[140:143], a[36:39], v[68:71]
buffer_load_dwordx4 v14, s[8:11], s24 offen offset:2048 lds
v_mfma_f32_16x16x32_bf16 v[76:79], a[136:139], a[40:43], v[76:79]
v_mfma_f32_16x16x32_bf16 v[76:79], a[140:143], a[44:47], v[76:79]
v_mfma_f32_16x16x32_bf16 v[84:87], a[136:139], a[48:51], v[84:87]
ds_read_b128 a[80:83], v2 offset:36864
v_mfma_f32_16x16x32_bf16 v[84:87], a[140:143], a[52:55], v[84:87]
buffer_load_dwordx4 v15, s[8:11], s24 offen offset:3072 lds
v_mfma_f32_16x16x32_bf16 v[92:95], a[136:139], a[56:59], v[92:95]
s_add_u32 s24, s24, 128
ds_read_b128 a[84:87], v3 offset:36864
v_mfma_f32_16x16x32_bf16 v[92:95], a[140:143], a[60:63], v[92:95]
s_waitcnt lgkmcnt(3)
v_mfma_f32_16x16x32_bf16 v[96:99], a[128:131], a[0:3], v[96:99]
s_add_u32 m0, s28, 4096
ds_read_b64_tr_b16 a[136:137], v7 offset:0
v_mfma_f32_16x16x32_bf16 v[96:99], a[132:135], a[4:7], v[96:99]
buffer_load_dwordx4 v12, s[8:11], s25 offen offset:0 lds
v_mfma_f32_16x16x32_bf16 v[104:107], a[128:131], a[8:11], v[104:107]
ds_read_b64_tr_b16 a[138:139], v7 offset:2048
v_mfma_f32_16x16x32_bf16 v[104:107], a[132:135], a[12:15], v[104:107]
v_mfma_f32_16x16x32_bf16 v[112:115], a[128:131], a[16:19], v[112:115]
ds_read_b64_tr_b16 a[140:141], v7 offset:16384
v_mfma_f32_16x16x32_bf16 v[112:115], a[132:135], a[20:23], v[112:115]
buffer_load_dwordx4 v13, s[8:11], s25 offen offset:1024 lds
v_mfma_f32_16x16x32_bf16 v[120:123], a[128:131], a[24:27], v[120:123]
ds_read_b64_tr_b16 a[142:143], v7 offset:18432
v_mfma_f32_16x16x32_bf16 v[120:123], a[132:135], a[28:31], v[120:123]
v_mfma_f32_16x16x32_bf16 v[128:131], a[128:131], a[32:35], v[128:131]
v_mfma_f32_16x16x32_bf16 v[128:131], a[132:135], a[36:39], v[128:131]
buffer_load_dwordx4 v14, s[8:11], s25 offen offset:2048 lds
v_mfma_f32_16x16x32_bf16 v[136:139], a[128:131], a[40:43], v[136:139]
ds_read_b128 a[88:91], v2 offset:38912
v_mfma_f32_16x16x32_bf16 v[136:139], a[132:135], a[44:47], v[136:139]
v_mfma_f32_16x16x32_bf16 v[144:147], a[128:131], a[48:51], v[144:147]
ds_read_b128 a[92:95], v3 offset:38912
v_mfma_f32_16x16x32_bf16 v[144:147], a[132:135], a[52:55], v[144:147]
buffer_load_dwordx4 v15, s[8:11], s25 offen offset:3072 lds
v_mfma_f32_16x16x32_bf16 v[152:155], a[128:131], a[56:59], v[152:155]
s_add_u32 s25, s25, 128
v_mfma_f32_16x16x32_bf16 v[152:155], a[132:135], a[60:63], v[152:155]
s_waitcnt lgkmcnt(2)
v_mfma_f32_16x16x32_bf16 v[100:103], a[136:139], a[0:3], v[100:103]
ds_read_b64_tr_b16 a[128:129], v8 offset:0
v_mfma_f32_16x16x32_bf16 v[100:103], a[140:143], a[4:7], v[100:103]
buffer_load_dword v21, v20, s[16:19], s43 offen
v_mfma_f32_16x16x32_bf16 v[108:111], a[136:139], a[8:11], v[108:111]
s_add_u32 s43, s43, s47
ds_read_b64_tr_b16 a[130:131], v8 offset:2048
v_mfma_f32_16x16x32_bf16 v[108:111], a[140:143], a[12:15], v[108:111]
s_cmp_ge_u32 s43, s51
v_mfma_f32_16x16x32_bf16 v[116:119], a[136:139], a[16:19], v[116:119]
s_cselect_b32 s43, 0, s43
ds_read_b64_tr_b16 a[132:133], v8 offset:16384
v_mfma_f32_16x16x32_bf16 v[116:119], a[140:143], a[20:23], v[116:119]
s_cselect_b32 s51, s42, s51
v_mfma_f32_16x16x32_bf16 v[124:127], a[136:139], a[24:27], v[124:127]
s_cselect_b64 s[16:17], s[40:41], s[16:17]
ds_read_b64_tr_b16 a[134:135], v8 offset:18432
v_mfma_f32_16x16x32_bf16 v[124:127], a[140:143], a[28:31], v[124:127]
s_cselect_b32 s18, s42, s18
v_mfma_f32_16x16x32_bf16 v[132:135], a[136:139], a[32:35], v[132:135]
s_cselect_b64 s[40:41], s[44:45], s[40:41]
ds_read_b128 a[96:99], v2 offset:40960
v_mfma_f32_16x16x32_bf16 v[132:135], a[140:143], a[36:39], v[132:135]
s_cselect_b32 s42, s46, s42
v_mfma_f32_16x16x32_bf16 v[140:143], a[136:139], a[40:43], v[140:143]
s_cselect_b32 s46, 0, s46
v_mfma_f32_16x16x32_bf16 v[140:143], a[140:143], a[44:47], v[140:143]
s_cmp_eq_u32 s30, s55
v_mfma_f32_16x16x32_bf16 v[148:151], a[136:139], a[48:51], v[148:151]
s_cselect_b32 s22, 0, 3221225472
ds_read_b128 a[100:103], v3 offset:40960
v_mfma_f32_16x16x32_bf16 v[148:151], a[140:143], a[52:55], v[148:151]
s_sub_u32 s30, s30, 1
buffer_atomic_add v27, v26, s[60:63], s22 offen sc1
v_mfma_f32_16x16x32_bf16 v[156:159], a[136:139], a[56:59], v[156:159]
ds_read_b128 a[104:107], v2 offset:43008
v_mfma_f32_16x16x32_bf16 v[156:159], a[140:143], a[60:63], v[156:159]
s_waitcnt lgkmcnt(3)
v_mfma_f32_16x16x32_bf16 v[160:163], a[128:131], a[0:3], v[160:163]
ds_read_b64_tr_b16 a[136:137], v9 offset:0
v_mfma_f32_16x16x32_bf16 v[160:163], a[132:135], a[4:7], v[160:163]
v_mfma_f32_16x16x32_bf16 v[168:171], a[128:131], a[8:11], v[168:171]
ds_read_b64_tr_b16 a[138:139], v9 offset:2048
v_mfma_f32_16x16x32_bf16 v[168:171], a[132:135], a[12:15], v[168:171]
v_mfma_f32_16x16x32_bf16 v[176:179], a[128:131], a[16:19], v[176:179]
ds_read_b64_tr_b16 a[140:141], v9 offset:16384
v_mfma_f32_16x16x32_bf16 v[176:179], a[132:135], a[20:23], v[176:179]
v_mfma_f32_16x16x32_bf16 v[184:187], a[128:131], a[24:27], v[184:187]
ds_read_b64_tr_b16 a[142:143], v9 offset:18432
v_mfma_f32_16x16x32_bf16 v[184:187], a[132:135], a[28:31], v[184:187]
v_mfma_f32_16x16x32_bf16 v[192:195], a[128:131], a[32:35], v[192:195]
v_mfma_f32_16x16x32_bf16 v[192:195], a[132:135], a[36:39], v[192:195]
v_mfma_f32_16x16x32_bf16 v[200:203], a[128:131], a[40:43], v[200:203]
ds_read_b128 a[108:111], v3 offset:43008
v_mfma_f32_16x16x32_bf16 v[200:203], a[132:135], a[44:47], v[200:203]
v_mfma_f32_16x16x32_bf16 v[208:211], a[128:131], a[48:51], v[208:211]
ds_read_b128 a[112:115], v2 offset:45056
v_mfma_f32_16x16x32_bf16 v[208:211], a[132:135], a[52:55], v[208:211]
v_mfma_f32_16x16x32_bf16 v[216:219], a[128:131], a[56:59], v[216:219]
v_mfma_f32_16x16x32_bf16 v[216:219], a[132:135], a[60:63], v[216:219]
s_waitcnt lgkmcnt(2)
v_mfma_f32_16x16x32_bf16 v[164:167], a[136:139], a[0:3], v[164:167]
ds_read_b64_tr_b16 a[128:129], v10 offset:0
v_mfma_f32_16x16x32_bf16 v[164:167], a[140:143], a[4:7], v[164:167]
v_mfma_f32_16x16x32_bf16 v[172:175], a[136:139], a[8:11], v[172:175]
ds_read_b64_tr_b16 a[130:131], v10 offset:2048
v_mfma_f32_16x16x32_bf16 v[172:175], a[140:143], a[12:15], v[172:175]
v_mfma_f32_16x16x32_bf16 v[180:183], a[136:139], a[16:19], v[180:183]
ds_read_b64_tr_b16 a[132:133], v10 offset:16384
v_mfma_f32_16x16x32_bf16 v[180:183], a[140:143], a[20:23], v[180:183]
v_mfma_f32_16x16x32_bf16 v[188:191], a[136:139], a[24:27], v[188:191]
ds_read_b64_tr_b16 a[134:135], v10 offset:18432
v_mfma_f32_16x16x32_bf16 v[188:191], a[140:143], a[28:31], v[188:191]
v_mfma_f32_16x16x32_bf16 v[196:199], a[136:139], a[32:35], v[196:199]
ds_read_b128 a[116:119], v3 offset:45056
v_mfma_f32_16x16x32_bf16 v[196:199], a[140:143], a[36:39], v[196:199]
v_mfma_f32_16x16x32_bf16 v[204:207], a[136:139], a[40:43], v[204:207]
ds_read_b128 a[120:123], v2 offset:47104
v_mfma_f32_16x16x32_bf16 v[204:207], a[140:143], a[44:47], v[204:207]
v_mfma_f32_16x16x32_bf16 v[212:215], a[136:139], a[48:51], v[212:215]
v_mfma_f32_16x16x32_bf16 v[212:215], a[140:143], a[52:55], v[212:215]
v_mfma_f32_16x16x32_bf16 v[220:223], a[136:139], a[56:59], v[220:223]
ds_read_b128 a[124:127], v3 offset:47104
v_mfma_f32_16x16x32_bf16 v[220:223], a[140:143], a[60:63], v[220:223]
s_waitcnt lgkmcnt(3)
v_mfma_f32_16x16x32_bf16 a[192:195], a[128:131], a[0:3], a[192:195]
ds_read_b64_tr_b16 a[136:137], v11 offset:0
v_mfma_f32_16x16x32_bf16 a[192:195], a[132:135], a[4:7], a[192:195]
v_mfma_f32_16x16x32_bf16 a[200:203], a[128:131], a[8:11], a[200:203]
ds_read_b64_tr_b16 a[138:139], v11 offset:2048
v_mfma_f32_16x16x32_bf16 a[200:203], a[132:135], a[12:15], a[200:203]
v_mfma_f32_16x16x32_bf16 a[208:211], a[128:131], a[16:19], a[208:211]
ds_read_b64_tr_b16 a[140:141], v11 offset:16384
v_mfma_f32_16x16x32_bf16 a[208:211], a[132:135], a[20:23], a[208:211]
v_mfma_f32_16x16x32_bf16 a[216:219], a[128:131], a[24:27], a[216:219]
ds_read_b64_tr_b16 a[142:143], v11 offset:18432
v_mfma_f32_16x16x32_bf16 a[216:219], a[132:135], a[28:31], a[216:219]
v_mfma_f32_16x16x32_bf16 a[224:227], a[128:131], a[32:35], a[224:227]
v_mfma_f32_16x16x32_bf16 a[224:227], a[132:135], a[36:39], a[224:227]
v_mfma_f32_16x16x32_bf16 a[232:235], a[128:131], a[40:43], a[232:235]
v_mfma_f32_16x16x32_bf16 a[232:235], a[132:135], a[44:47], a[232:235]
v_mfma_f32_16x16x32_bf16 a[240:243], a[128:131], a[48:51], a[240:243]
v_mfma_f32_16x16x32_bf16 a[240:243], a[132:135], a[52:55], a[240:243]
v_mfma_f32_16x16x32_bf16 a[248:251], a[128:131], a[56:59], a[248:251]
s_waitcnt vmcnt(2) lgkmcnt(0)
v_mfma_f32_16x16x32_bf16 a[248:251], a[132:135], a[60:63], a[248:251]
s_barrier
v_mfma_f32_16x16x32_bf16 a[196:199], a[136:139], a[0:3], a[196:199]
s_add_u32 m0, s29, 65536
ds_read_b64_tr_b16 a[128:129], v4 offset:32768
v_mfma_f32_16x16x32_bf16 a[196:199], a[140:143], a[4:7], a[196:199]
buffer_load_dwordx4 v16, s[12:15], s26 offen offset:0 lds
v_mfma_f32_16x16x32_bf16 a[204:207], a[136:139], a[8:11], a[204:207]
ds_read_b64_tr_b16 a[130:131], v4 offset:34816
v_mfma_f32_16x16x32_bf16 a[204:207], a[140:143], a[12:15], a[204:207]
v_mfma_f32_16x16x32_bf16 a[212:215], a[136:139], a[16:19], a[212:215]
ds_read_b64_tr_b16 a[132:133], v4 offset:49152
v_mfma_f32_16x16x32_bf16 a[212:215], a[140:143], a[20:23], a[212:215]
buffer_load_dwordx4 v17, s[12:15], s26 offen offset:1024 lds
v_mfma_f32_16x16x32_bf16 a[220:223], a[136:139], a[24:27], a[220:223]
ds_read_b64_tr_b16 a[134:135], v4 offset:51200
v_mfma_f32_16x16x32_bf16 a[220:223], a[140:143], a[28:31], a[220:223]
v_mfma_f32_16x16x32_bf16 a[228:231], a[136:139], a[32:35], a[228:231]
v_mfma_f32_16x16x32_bf16 a[228:231], a[140:143], a[36:39], a[228:231]
buffer_load_dwordx4 v18, s[12:15], s26 offen offset:2048 lds
v_mfma_f32_16x16x32_bf16 a[236:239], a[136:139], a[40:43], a[236:239]
v_mfma_f32_16x16x32_bf16 a[236:239], a[140:143], a[44:47], a[236:239]
v_mfma_f32_16x16x32_bf16 a[244:247], a[136:139], a[48:51], a[244:247]
v_mfma_f32_16x16x32_bf16 a[244:247], a[140:143], a[52:55], a[244:247]
s_waitcnt lgkmcnt(0)
buffer_load_dwordx4 v19, s[12:15], s26 offen offset:3072 lds
v_mfma_f32_16x16x32_bf16 a[252:255], a[136:139], a[56:59], a[252:255]
s_add_u32 s26, s26, 524288
s_bitcmp1_b32 s30, 1
v_mfma_f32_16x16x32_bf16 a[252:255], a[140:143], a[60:63], a[252:255]
s_cbranch_scc1 Lg_1
s_cmp_eq_u32 s30, 0
s_cbranch_scc1 Lg_1t
v_mfma_f32_16x16x32_bf16 v[32:35], a[128:131], a[64:67], v[32:35]
s_add_u32 m0, s29, 81920
ds_read_b64_tr_b16 a[136:137], v5 offset:32768
v_mfma_f32_16x16x32_bf16 v[32:35], a[132:135], a[68:71], v[32:35]
buffer_load_dwordx4 v16, s[12:15], s27 offen offset:0 lds
v_mfma_f32_16x16x32_bf16 v[40:43], a[128:131], a[72:75], v[40:43]
s_lshl_b32 s22, s38, 3
ds_read_b64_tr_b16 a[138:139], v5 offset:34816
v_mfma_f32_16x16x32_bf16 v[40:43], a[132:135], a[76:79], v[40:43]
s_lshl_b32 s23, s39, 5
v_and_b32 v252, 31, v0
v_lshrrev_b32 v253, 5, v0
v_mfma_f32_16x16x32_bf16 v[48:51], a[128:131], a[80:83], v[48:51]
ds_read_b64_tr_b16 a[140:141], v5 offset:49152
v_add_u32 v253, s22, v253
v_mfma_f32_16x16x32_bf16 v[48:51], a[132:135], a[84:87], v[48:51]
buffer_load_dwordx4 v17, s[12:15], s27 offen offset:1024 lds
v_mfma_f32_16x16x32_bf16 v[56:59], a[128:131], a[88:91], v[56:59]
ds_read_b64_tr_b16 a[142:143], v5 offset:51200
v_add_u32 v252, s23, v252
v_mfma_f32_16x16x32_bf16 v[56:59], a[132:135], a[92:95], v[56:59]
v_mul_u32_u24 v254, 7168, v253
v_lshl_add_u32 v254, v252, 2, v254
v_mfma_f32_16x16x32_bf16 v[64:67], a[128:131], a[96:99], v[64:67]
ds_read_b128 a[0:3], v2 offset:0
v_lshlrev_b32 v252, 4, v252
v_mfma_f32_16x16x32_bf16 v[64:67], a[132:135], a[100:103], v[64:67]
buffer_load_dwordx4 v18, s[12:15], s27 offen offset:2048 lds
v_mfma_f32_16x16x32_bf16 v[72:75], a[128:131], a[104:107], v[72:75]
ds_read_b128 a[4:7], v3 offset:0
v_add_u32 v255, 3584, v254
v_mfma_f32_16x16x32_bf16 v[72:75], a[132:135], a[108:111], v[72:75]
v_subrev_u32 v22, 3584, v254
v_subrev_u32 v23, 2688, v254
v_mfma_f32_16x16x32_bf16 v[80:83], a[128:131], a[112:115], v[80:83]
v_subrev_u32 v24, 1792, v254
v_subrev_u32 v25, 896, v254
v_mfma_f32_16x16x32_bf16 v[80:83], a[132:135], a[116:119], v[80:83]
buffer_load_dwordx4 v19, s[12:15], s27 offen offset:3072 lds
v_mfma_f32_16x16x32_bf16 v[88:91], a[128:131], a[120:123], v[88:91]
s_add_u32 s27, s27, 524288
ds_read_b128 a[8:11], v2 offset:2048
v_mfma_f32_16x16x32_bf16 v[88:91], a[132:135], a[124:127], v[88:91]
s_waitcnt lgkmcnt(3)
v_mfma_f32_16x16x32_bf16 v[36:39], a[136:139], a[64:67], v[36:39]
s_add_u32 m0, s28, 32768
ds_read_b64_tr_b16 a[128:129], v6 offset:32768
v_mfma_f32_16x16x32_bf16 v[36:39], a[140:143], a[68:71], v[36:39]
buffer_load_dwordx4 v12, s[8:11], s24 offen offset:0 lds
v_mfma_f32_16x16x32_bf16 v[44:47], a[136:139], a[72:75], v[44:47]
ds_read_b64_tr_b16 a[130:131], v6 offset:34816
v_mfma_f32_16x16x32_bf16 v[44:47], a[140:143], a[76:79], v[44:47]
v_mfma_f32_16x16x32_bf16 v[52:55], a[136:139], a[80:83], v[52:55]
ds_read_b64_tr_b16 a[132:133], v6 offset:49152
v_mfma_f32_16x16x32_bf16 v[52:55], a[140:143], a[84:87], v[52:55]
buffer_load_dwordx4 v13, s[8:11], s24 offen offset:1024 lds
v_mfma_f32_16x16x32_bf16 v[60:63], a[136:139], a[88:91], v[60:63]
ds_read_b64_tr_b16 a[134:135], v6 offset:51200
v_mfma_f32_16x16x32_bf16 v[60:63], a[140:143], a[92:95], v[60:63]
v_mfma_f32_16x16x32_bf16 v[68:71], a[136:139], a[96:99], v[68:71]
ds_read_b128 a[12:15], v3 offset:2048
v_mfma_f32_16x16x32_bf16 v[68:71], a[140:143], a[100:103], v[68:71]
buffer_load_dwordx4 v14, s[8:11], s24 offen offset:2048 lds
v_mfma_f32_16x16x32_bf16 v[76:79], a[136:139], a[104:107], v[76:79]
v_mfma_f32_16x16x32_bf16 v[76:79], a[140:143], a[108:111], v[76:79]
v_mfma_f32_16x16x32_bf16 v[84:87], a[136:139], a[112:115], v[84:87]
ds_read_b128 a[16:19], v2 offset:4096
v_mfma_f32_16x16x32_bf16 v[84:87], a[140:143], a[116:119], v[84:87]
buffer_load_dwordx4 v15, s[8:11], s24 offen offset:3072 lds
v_mfma_f32_16x16x32_bf16 v[92:95], a[136:139], a[120:123], v[92:95]
s_add_u32 s24, s24, 128
ds_read_b128 a[20:23], v3 offset:4096
v_mfma_f32_16x16x32_bf16 v[92:95], a[140:143], a[124:127], v[92:95]
s_waitcnt lgkmcnt(3)
v_mfma_f32_16x16x32_bf16 v[96:99], a[128:131], a[64:67], v[96:99]
s_add_u32 m0, s28, 36864
ds_read_b64_tr_b16 a[136:137], v7 offset:32768
v_mfma_f32_16x16x32_bf16 v[96:99], a[132:135], a[68:71], v[96:99]
buffer_load_dwordx4 v12, s[8:11], s25 offen offset:0 lds
v_mfma_f32_16x16x32_bf16 v[104:107], a[128:131], a[72:75], v[104:107]
ds_read_b64_tr_b16 a[138:139], v7 offset:34816
v_mfma_f32_16x16x32_bf16 v[104:107], a[132:135], a[76:79], v[104:107]
v_mfma_f32_16x16x32_bf16 v[112:115], a[128:131], a[80:83], v[112:115]
ds_read_b64_tr_b16 a[140:141], v7 offset:49152
v_mfma_f32_16x16x32_bf16 v[112:115], a[132:135], a[84:87], v[112:115]
buffer_load_dwordx4 v13, s[8:11], s25 offen offset:1024 lds
v_mfma_f32_16x16x32_bf16 v[120:123], a[128:131], a[88:91], v[120:123]
ds_read_b64_tr_b16 a[142:143], v7 offset:51200
v_mfma_f32_16x16x32_bf16 v[120:123], a[132:135], a[92:95], v[120:123]
v_mfma_f32_16x16x32_bf16 v[128:131], a[128:131], a[96:99], v[128:131]
v_mfma_f32_16x16x32_bf16 v[128:131], a[132:135], a[100:103], v[128:131]
buffer_load_dwordx4 v14, s[8:11], s25 offen offset:2048 lds
v_mfma_f32_16x16x32_bf16 v[136:139], a[128:131], a[104:107], v[136:139]
ds_read_b128 a[24:27], v2 offset:6144
v_mfma_f32_16x16x32_bf16 v[136:139], a[132:135], a[108:111], v[136:139]
v_mfma_f32_16x16x32_bf16 v[144:147], a[128:131], a[112:115], v[144:147]
ds_read_b128 a[28:31], v3 offset:6144
v_mfma_f32_16x16x32_bf16 v[144:147], a[132:135], a[116:119], v[144:147]
buffer_load_dwordx4 v15, s[8:11], s25 offen offset:3072 lds
v_mfma_f32_16x16x32_bf16 v[152:155], a[128:131], a[120:123], v[152:155]
s_add_u32 s25, s25, 128
v_mfma_f32_16x16x32_bf16 v[152:155], a[132:135], a[124:127], v[152:155]
s_waitcnt lgkmcnt(2)
v_mfma_f32_16x16x32_bf16 v[100:103], a[136:139], a[64:67], v[100:103]
s_mov_b64 s[56:57], s[70:71]
s_mov_b32 s58, 3584
s_mov_b32 s59, 0x20000
ds_read_b64_tr_b16 a[128:129], v8 offset:32768
v_mfma_f32_16x16x32_bf16 v[100:103], a[140:143], a[68:71], v[100:103]
buffer_load_dwordx4 v[248:251], v252, s[56:59], 0 offen
v_mfma_f32_16x16x32_bf16 v[108:111], a[136:139], a[72:75], v[108:111]
s_mov_b64 s[56:57], s[66:67]
s_mov_b32 s58, 1835008
ds_read_b64_tr_b16 a[130:131], v8 offset:34816
v_mfma_f32_16x16x32_bf16 v[108:111], a[140:143], a[76:79], v[108:111]
buffer_load_dword v224, v22, s[56:59], 0 offen nt
v_mfma_f32_16x16x32_bf16 v[116:119], a[136:139], a[80:83], v[116:119]
ds_read_b64_tr_b16 a[132:133], v8 offset:49152
v_mfma_f32_16x16x32_bf16 v[116:119], a[140:143], a[84:87], v[116:119]
buffer_load_dword v225, v23, s[56:59], 0 offen nt
v_mfma_f32_16x16x32_bf16 v[124:127], a[136:139], a[88:91], v[124:127]
ds_read_b64_tr_b16 a[134:135], v8 offset:51200
v_mfma_f32_16x16x32_bf16 v[124:127], a[140:143], a[92:95], v[124:127]
buffer_load_dword v226, v24, s[56:59], 0 offen nt
v_mfma_f32_16x16x32_bf16 v[132:135], a[136:139], a[96:99], v[132:135]
ds_read_b128 a[32:35], v2 offset:8192
v_mfma_f32_16x16x32_bf16 v[132:135], a[140:143], a[100:103], v[132:135]
buffer_load_dword v227, v25, s[56:59], 0 offen nt
v_mfma_f32_16x16x32_bf16 v[140:143], a[136:139], a[104:107], v[140:143]
buffer_load_dword v228, v254, s[56:59], 0 offen offset:0 nt
v_mfma_f32_16x16x32_bf16 v[140:143], a[140:143], a[108:111], v[140:143]
buffer_load_dword v229, v254, s[56:59], 0 offen offset:896 nt
v_mfma_f32_16x16x32_bf16 v[148:151], a[136:139], a[112:115], v[148:151]
ds_read_b128 a[36:39], v3 offset:8192
v_mfma_f32_16x16x32_bf16 v[148:151], a[140:143], a[116:119], v[148:151]
buffer_load_dword v230, v254, s[56:59], 0 offen offset:1792 nt
v_mfma_f32_16x16x32_bf16 v[156:159], a[136:139], a[120:123], v[156:159]
ds_read_b128 a[40:43], v2 offset:10240
v_mfma_f32_16x16x32_bf16 v[156:159], a[140:143], a[124:127], v[156:159]
s_waitcnt lgkmcnt(3)
buffer_load_dword v231, v254, s[56:59], 0 offen offset:2688 nt
v_mfma_f32_16x16x32_bf16 v[160:163], a[128:131], a[64:67], v[160:163]
ds_read_b64_tr_b16 a[136:137], v9 offset:32768
v_mfma_f32_16x16x32_bf16 v[160:163], a[132:135], a[68:71], v[160:163]
buffer_load_dword v232, v255, s[56:59], 0 offen offset:0 nt
v_mfma_f32_16x16x32_bf16 v[168:171], a[128:131], a[72:75], v[168:171]
ds_read_b64_tr_b16 a[138:139], v9 offset:34816
v_mfma_f32_16x16x32_bf16 v[168:171], a[132:135], a[76:79], v[168:171]
buffer_load_dword v233, v255, s[56:59], 0 offen offset:896 nt
v_mfma_f32_16x16x32_bf16 v[176:179], a[128:131], a[80:83], v[176:179]
ds_read_b64_tr_b16 a[140:141], v9 offset:49152
v_mfma_f32_16x16x32_bf16 v[176:179], a[132:135], a[84:87], v[176:179]
buffer_load_dword v234, v255, s[56:59], 0 offen offset:1792 nt
v_mfma_f32_16x16x32_bf16 v[184:187], a[128:131], a[88:91], v[184:187]
ds_read_b64_tr_b16 a[142:143], v9 offset:51200
v_mfma_f32_16x16x32_bf16 v[184:187], a[132:135], a[92:95], v[184:187]
buffer_load_dword v235, v255, s[56:59], 0 offen offset:2688 nt
v_mfma_f32_16x16x32_bf16 v[192:195], a[128:131], a[96:99], v[192:195]
s_mov_b64 s[56:57], s[68:69]
buffer_load_dword v236, v25, s[56:59], 0 offen nt
v_mfma_f32_16x16x32_bf16 v[192:195], a[132:135], a[100:103], v[192:195]
buffer_load_dword v237, v254, s[56:59], 0 offen offset:0 nt
v_mfma_f32_16x16x32_bf16 v[200:203], a[128:131], a[104:107], v[200:203]
ds_read_b128 a[44:47], v3 offset:10240
v_mfma_f32_16x16x32_bf16 v[200:203], a[132:135], a[108:111], v[200:203]
buffer_load_dword v238, v254, s[56:59], 0 offen offset:896 nt
v_mfma_f32_16x16x32_bf16 v[208:211], a[128:131], a[112:115], v[208:211]
ds_read_b128 a[48:51], v2 offset:12288
v_mfma_f32_16x16x32_bf16 v[208:211], a[132:135], a[116:119], v[208:211]
buffer_load_dword v239, v254, s[56:59], 0 offen offset:1792 nt
v_mfma_f32_16x16x32_bf16 v[216:219], a[128:131], a[120:123], v[216:219]
buffer_load_dword v240, v254, s[56:59], 0 offen offset:2688 nt
v_mfma_f32_16x16x32_bf16 v[216:219], a[132:135], a[124:127], v[216:219]
s_waitcnt lgkmcnt(2)
buffer_load_dword v241, v255, s[56:59], 0 offen offset:0 nt
v_mfma_f32_16x16x32_bf16 v[164:167], a[136:139], a[64:67], v[164:167]
ds_read_b64_tr_b16 a[128:129], v10 offset:32768
v_mfma_f32_16x16x32_bf16 v[164:167], a[140:143], a[68:71], v[164:167]
buffer_load_dword v242, v255, s[56:59], 0 offen offset:896 nt
v_mfma_f32_16x16x32_bf16 v[172:175], a[136:139], a[72:75], v[172:175]
ds_read_b64_tr_b16 a[130:131], v10 offset:34816
v_mfma_f32_16x16x32_bf16 v[172:175], a[140:143], a[76:79], v[172:175]
buffer_load_dword v243, v255, s[56:59], 0 offen offset:1792 nt
v_mfma_f32_16x16x32_bf16 v[180:183], a[136:139], a[80:83], v[180:183]
ds_read_b64_tr_b16 a[132:133], v10 offset:49152
v_mfma_f32_16x16x32_bf16 v[180:183], a[140:143], a[84:87], v[180:183]
buffer_load_dword v244, v255, s[56:59], 0 offen offset:2688 nt
v_mfma_f32_16x16x32_bf16 v[188:191], a[136:139], a[88:91], v[188:191]
ds_read_b64_tr_b16 a[134:135], v10 offset:51200
v_mfma_f32_16x16x32_bf16 v[188:191], a[140:143], a[92:95], v[188:191]
v_mfma_f32_16x16x32_bf16 v[196:199], a[136:139], a[96:99], v[196:199]
ds_read_b128 a[52:55], v3 offset:12288
v_mfma_f32_16x16x32_bf16 v[196:199], a[140:143], a[100:103], v[196:199]
v_mfma_f32_16x16x32_bf16 v[204:207], a[136:139], a[104:107], v[204:207]
ds_read_b128 a[56:59], v2 offset:14336
v_mfma_f32_16x16x32_bf16 v[204:207], a[140:143], a[108:111], v[204:207]
v_mfma_f32_16x16x32_bf16 v[212:215], a[136:139], a[112:115], v[212:215]
v_mfma_f32_16x16x32_bf16 v[212:215], a[140:143], a[116:119], v[212:215]
v_mfma_f32_16x16x32_bf16 v[220:223], a[136:139], a[120:123], v[220:223]
ds_read_b128 a[60:63], v3 offset:14336
v_mfma_f32_16x16x32_bf16 v[220:223], a[140:143], a[124:127], v[220:223]
s_waitcnt lgkmcnt(3)
v_mfma_f32_16x16x32_bf16 a[192:195], a[128:131], a[64:67], a[192:195]
ds_read_b64_tr_b16 a[136:137], v11 offset:32768
v_mfma_f32_16x16x32_bf16 a[192:195], a[132:135], a[68:71], a[192:195]
v_mfma_f32_16x16x32_bf16 a[200:203], a[128:131], a[72:75], a[200:203]
ds_read_b64_tr_b16 a[138:139], v11 offset:34816
v_mfma_f32_16x16x32_bf16 a[200:203], a[132:135], a[76:79], a[200:203]
v_mfma_f32_16x16x32_bf16 a[208:211], a[128:131], a[80:83], a[208:211]
ds_read_b64_tr_b16 a[140:141], v11 offset:49152
v_mfma_f32_16x16x32_bf16 a[208:211], a[132:135], a[84:87], a[208:211]
v_mfma_f32_16x16x32_bf16 a[216:219], a[128:131], a[88:91], a[216:219]
ds_read_b64_tr_b16 a[142:143], v11 offset:51200
v_mfma_f32_16x16x32_bf16 a[216:219], a[132:135], a[92:95], a[216:219]
v_mfma_f32_16x16x32_bf16 a[224:227], a[128:131], a[96:99], a[224:227]
v_mfma_f32_16x16x32_bf16 a[224:227], a[132:135], a[100:103], a[224:227]
v_mfma_f32_16x16x32_bf16 a[232:235], a[128:131], a[104:107], a[232:235]
v_mfma_f32_16x16x32_bf16 a[232:235], a[132:135], a[108:111], a[232:235]
v_mfma_f32_16x16x32_bf16 a[240:243], a[128:131], a[112:115], a[240:243]
v_mfma_f32_16x16x32_bf16 a[240:243], a[132:135], a[116:119], a[240:243]
v_mfma_f32_16x16x32_bf16 a[248:251], a[128:131], a[120:123], a[248:251]
s_waitcnt vmcnt(22) lgkmcnt(0)
v_mfma_f32_16x16x32_bf16 a[248:251], a[132:135], a[124:127], a[248:251]
s_barrier
v_mfma_f32_16x16x32_bf16 a[196:199], a[136:139], a[64:67], a[196:199]
s_add_u32 m0, s29, 98304
ds_read_b64_tr_b16 a[128:129], v4 offset:0
v_mfma_f32_16x16x32_bf16 a[196:199], a[140:143], a[68:71], a[196:199]
buffer_load_dwordx4 v16, s[12:15], s26 offen offset:0 lds
v_mfma_f32_16x16x32_bf16 a[204:207], a[136:139], a[72:75], a[204:207]
ds_read_b64_tr_b16 a[130:131], v4 offset:2048
v_mfma_f32_16x16x32_bf16 a[204:207], a[140:143], a[76:79], a[204:207]
v_mfma_f32_16x16x32_bf16 a[212:215], a[136:139], a[80:83], a[212:215]
ds_read_b64_tr_b16 a[132:133], v4 offset:16384
v_mfma_f32_16x16x32_bf16 a[212:215], a[140:143], a[84:87], a[212:215]
buffer_load_dwordx4 v17, s[12:15], s26 offen offset:1024 lds
v_mfma_f32_16x16x32_bf16 a[220:223], a[136:139], a[88:91], a[220:223]
ds_read_b64_tr_b16 a[134:135], v4 offset:18432
v_mfma_f32_16x16x32_bf16 a[220:223], a[140:143], a[92:95], a[220:223]
v_mfma_f32_16x16x32_bf16 a[228:231], a[136:139], a[96:99], a[228:231]
v_mfma_f32_16x16x32_bf16 a[228:231], a[140:143], a[100:103], a[228:231]
buffer_load_dwordx4 v18, s[12:15], s26 offen offset:2048 lds
v_mfma_f32_16x16x32_bf16 a[236:239], a[136:139], a[104:107], a[236:239]
v_mfma_f32_16x16x32_bf16 a[236:239], a[140:143], a[108:111], a[236:239]
v_mfma_f32_16x16x32_bf16 a[244:247], a[136:139], a[112:115], a[244:247]
v_mfma_f32_16x16x32_bf16 a[244:247], a[140:143], a[116:119], a[244:247]
buffer_load_dwordx4 v19, s[12:15], s26 offen offset:3072 lds
v_mfma_f32_16x16x32_bf16 a[252:255], a[136:139], a[120:123], a[252:255]
s_add_u32 s26, s26, 524288
v_mfma_f32_16x16x32_bf16 a[252:255], a[140:143], a[124:127], a[252:255]
s_waitcnt lgkmcnt(0)
v_mfma_f32_16x16x32_bf16 v[32:35], a[128:131], a[0:3], v[32:35]
s_add_u32 m0, s29, 114688
ds_read_b64_tr_b16 a[136:137], v5 offset:0
v_mfma_f32_16x16x32_bf16 v[32:35], a[132:135], a[4:7], v[32:35]
buffer_load_dwordx4 v16, s[12:15], s27 offen offset:0 lds
v_mfma_f32_16x16x32_bf16 v[40:43], a[128:131], a[8:11], v[40:43]
ds_read_b64_tr_b16 a[138:139], v5 offset:2048
v_mfma_f32_16x16x32_bf16 v[40:43], a[132:135], a[12:15], v[40:43]
v_mfma_f32_16x16x32_bf16 v[48:51], a[128:131], a[16:19], v[48:51]
ds_read_b64_tr_b16 a[140:141], v5 offset:16384
v_mfma_f32_16x16x32_bf16 v[48:51], a[132:135], a[20:23], v[48:51]
buffer_load_dwordx4 v17, s[12:15], s27 offen offset:1024 lds
v_mfma_f32_16x16x32_bf16 v[56:59], a[128:131], a[24:27], v[56:59]
ds_read_b64_tr_b16 a[142:143], v5 offset:18432
v_mfma_f32_16x16x32_bf16 v[56:59], a[132:135], a[28:31], v[56:59]
v_mfma_f32_16x16x32_bf16 v[64:67], a[128:131], a[32:35], v[64:67]
ds_read_b128 a[64:67], v2 offset:32768
v_mfma_f32_16x16x32_bf16 v[64:67], a[132:135], a[36:39], v[64:67]
buffer_load_dwordx4 v18, s[12:15], s27 offen offset:2048 lds
v_mfma_f32_16x16x32_bf16 v[72:75], a[128:131], a[40:43], v[72:75]
ds_read_b128 a[68:71], v3 offset:32768
v_mfma_f32_16x16x32_bf16 v[72:75], a[132:135], a[44:47], v[72:75]
v_mfma_f32_16x16x32_bf16 v[80:83], a[128:131], a[48:51], v[80:83]
v_mfma_f32_16x16x32_bf16 v[80:83], a[132:135], a[52:55], v[80:83]
buffer_load_dwordx4 v19, s[12:15], s27 offen offset:3072 lds
v_mfma_f32_16x16x32_bf16 v[88:91], a[128:131], a[56:59], v[88:91]
s_add_u32 s27, s27, 524288
ds_read_b128 a[72:75], v2 offset:34816
v_mfma_f32_16x16x32_bf16 v[88:91], a[132:135], a[60:63], v[88:91]
s_waitcnt lgkmcnt(3)
v_mfma_f32_16x16x32_bf16 v[36:39], a[136:139], a[0:3], v[36:39]
s_add_u32 m0, s28, 0
ds_read_b64_tr_b16 a[128:129], v6 offset:0
v_mfma_f32_16x16x32_bf16 v[36:39], a[140:143], a[4:7], v[36:39]
buffer_load_dwordx4 v12, s[8:11], s24 offen offset:0 lds
v_mfma_f32_16x16x32_bf16 v[44:47], a[136:139], a[8:11], v[44:47]
ds_read_b64_tr_b16 a[130:131], v6 offset:2048
v_mfma_f32_16x16x32_bf16 v[44:47], a[140:143], a[12:15], v[44:47]
v_mfma_f32_16x16x32_bf16 v[52:55], a[136:139], a[16:19], v[52:55]
ds_read_b64_tr_b16 a[132:133], v6 offset:16384
v_mfma_f32_16x16x32_bf16 v[52:55], a[140:143], a[20:23], v[52:55]
buffer_load_dwordx4 v13, s[8:11], s24 offen offset:1024 lds
v_mfma_f32_16x16x32_bf16 v[60:63], a[136:139], a[24:27], v[60:63]
ds_read_b64_tr_b16 a[134:135], v6 offset:18432
v_mfma_f32_16x16x32_bf16 v[60:63], a[140:143], a[28:31], v[60:63]
v_mfma_f32_16x16x32_bf16 v[68:71], a[136:139], a[32:35], v[68:71]
ds_read_b128 a[76:79], v3 offset:34816
v_mfma_f32_16x16x32_bf16 v[68:71], a[140:143], a[36:39], v[68:71]
buffer_load_dwordx4 v14, s[8:11], s24 offen offset:2048 lds
v_mfma_f32_16x16x32_bf16 v[76:79], a[136:139], a[40:43], v[76:79]
v_mfma_f32_16x16x32_bf16 v[76:79], a[140:143], a[44:47], v[76:79]
v_mfma_f32_16x16x32_bf16 v[84:87], a[136:139], a[48:51], v[84:87]
ds_read_b128 a[80:83], v2 offset:36864
v_mfma_f32_16x16x32_bf16 v[84:87], a[140:143], a[52:55], v[84:87]
buffer_load_dwordx4 v15, s[8:11], s24 offen offset:3072 lds
v_mfma_f32_16x16x32_bf16 v[92:95], a[136:139], a[56:59], v[92:95]
s_add_u32 s24, s24, 128
ds_read_b128 a[84:87], v3 offset:36864
v_mfma_f32_16x16x32_bf16 v[92:95], a[140:143], a[60:63], v[92:95]
s_waitcnt lgkmcnt(3)
v_mfma_f32_16x16x32_bf16 v[96:99], a[128:131], a[0:3], v[96:99]
s_add_u32 m0, s28, 4096
ds_read_b64_tr_b16 a[136:137], v7 offset:0
v_mfma_f32_16x16x32_bf16 v[96:99], a[132:135], a[4:7], v[96:99]
buffer_load_dwordx4 v12, s[8:11], s25 offen offset:0 lds
v_mfma_f32_16x16x32_bf16 v[104:107], a[128:131], a[8:11], v[104:107]
ds_read_b64_tr_b16 a[138:139], v7 offset:2048
v_mfma_f32_16x16x32_bf16 v[104:107], a[132:135], a[12:15], v[104:107]
v_mfma_f32_16x16x32_bf16 v[112:115], a[128:131], a[16:19], v[112:115]
ds_read_b64_tr_b16 a[140:141], v7 offset:16384
v_mfma_f32_16x16x32_bf16 v[112:115], a[132:135], a[20:23], v[112:115]
buffer_load_dwordx4 v13, s[8:11], s25 offen offset:1024 lds
v_mfma_f32_16x16x32_bf16 v[120:123], a[128:131], a[24:27], v[120:123]
ds_read_b64_tr_b16 a[142:143], v7 offset:18432
v_mfma_f32_16x16x32_bf16 v[120:123], a[132:135], a[28:31], v[120:123]
v_mfma_f32_16x16x32_bf16 v[128:131], a[128:131], a[32:35], v[128:131]
v_mfma_f32_16x16x32_bf16 v[128:131], a[132:135], a[36:39], v[128:131]
buffer_load_dwordx4 v14, s[8:11], s25 offen offset:2048 lds
v_mfma_f32_16x16x32_bf16 v[136:139], a[128:131], a[40:43], v[136:139]
ds_read_b128 a[88:91], v2 offset:38912
v_mfma_f32_16x16x32_bf16 v[136:139], a[132:135], a[44:47], v[136:139]
v_mfma_f32_16x16x32_bf16 v[144:147], a[128:131], a[48:51], v[144:147]
ds_read_b128 a[92:95], v3 offset:38912
v_mfma_f32_16x16x32_bf16 v[144:147], a[132:135], a[52:55], v[144:147]
buffer_load_dwordx4 v15, s[8:11], s25 offen offset:3072 lds
v_mfma_f32_16x16x32_bf16 v[152:155], a[128:131], a[56:59], v[152:155]
s_add_u32 s25, s25, 128
v_mfma_f32_16x16x32_bf16 v[152:155], a[132:135], a[60:63], v[152:155]
s_waitcnt lgkmcnt(2)
v_mfma_f32_16x16x32_bf16 v[100:103], a[136:139], a[0:3], v[100:103]
ds_read_b64_tr_b16 a[128:129], v8 offset:0
v_mfma_f32_16x16x32_bf16 v[100:103], a[140:143], a[4:7], v[100:103]
buffer_load_dword v21, v20, s[16:19], s43 offen
v_mfma_f32_16x16x32_bf16 v[108:111], a[136:139], a[8:11], v[108:111]
s_add_u32 s43, s43, s47
ds_read_b64_tr_b16 a[130:131], v8 offset:2048
v_mfma_f32_16x16x32_bf16 v[108:111], a[140:143], a[12:15], v[108:111]
PAD_2:
s_cbranch_execz M_tret
s_cmp_ge_u32 s43, s51
v_mfma_f32_16x16x32_bf16 v[116:119], a[136:139], a[16:19], v[116:119]
s_cselect_b32 s43, 0, s43
ds_read_b64_tr_b16 a[132:133], v8 offset:16384
v_mfma_f32_16x16x32_bf16 v[116:119], a[140:143], a[20:23], v[116:119]
s_cselect_b32 s51, s42, s51
v_mfma_f32_16x16x32_bf16 v[124:127], a[136:139], a[24:27], v[124:127]
s_cselect_b64 s[16:17], s[40:41], s[16:17]
ds_read_b64_tr_b16 a[134:135], v8 offset:18432
v_mfma_f32_16x16x32_bf16 v[124:127], a[140:143], a[28:31], v[124:127]
s_cselect_b32 s18, s42, s18
v_mfma_f32_16x16x32_bf16 v[132:135], a[136:139], a[32:35], v[132:135]
s_cselect_b64 s[40:41], s[44:45], s[40:41]
ds_read_b128 a[96:99], v2 offset:40960
v_mfma_f32_16x16x32_bf16 v[132:135], a[140:143], a[36:39], v[132:135]
s_cselect_b32 s42, s46, s42
v_mfma_f32_16x16x32_bf16 v[140:143], a[136:139], a[40:43], v[140:143]
s_cselect_b32 s46, 0, s46
v_mfma_f32_16x16x32_bf16 v[140:143], a[140:143], a[44:47], v[140:143]
s_lshl_b32 s59, s39, 5
v_mfma_f32_16x16x32_bf16 v[148:151], a[136:139], a[48:51], v[148:151]
s_add_u32 s59, s59, s38
ds_read_b128 a[100:103], v3 offset:40960
v_mfma_f32_16x16x32_bf16 v[148:151], a[140:143], a[52:55], v[148:151]
s_lshl_b32 s59, s59, 2
v_mfma_f32_16x16x32_bf16 v[156:159], a[136:139], a[56:59], v[156:159]
s_add_u32 s59, s59, 94392320
ds_read_b128 a[104:107], v2 offset:43008
v_mfma_f32_16x16x32_bf16 v[156:159], a[140:143], a[60:63], v[156:159]
s_waitcnt lgkmcnt(3)
s_cmp_lt_u32 s2, 224
v_mfma_f32_16x16x32_bf16 v[160:163], a[128:131], a[0:3], v[160:163]
s_cselect_b32 s59, s59, 3221225472
ds_read_b64_tr_b16 a[136:137], v9 offset:0
v_mfma_f32_16x16x32_bf16 v[160:163], a[132:135], a[4:7], v[160:163]
s_mov_b32 s58, 0xffff0000
v_mfma_f32_16x16x32_bf16 v[168:171], a[128:131], a[8:11], v[168:171]
s_cmp_lt_u32 s3, 1
ds_read_b64_tr_b16 a[138:139], v9 offset:2048
v_mfma_f32_16x16x32_bf16 v[168:171], a[132:135], a[12:15], v[168:171]
s_cselect_b32 s54, 0, 3221225472
v_mfma_f32_16x16x32_bf16 v[176:179], a[128:131], a[16:19], v[176:179]
s_cselect_b32 s50, 0x100, 0
ds_read_b64_tr_b16 a[140:141], v9 offset:16384
v_mfma_f32_16x16x32_bf16 v[176:179], a[132:135], a[20:23], v[176:179]
v_mfma_f32_16x16x32_bf16 v[184:187], a[128:131], a[24:27], v[184:187]
ds_read_b64_tr_b16 a[142:143], v9 offset:18432
v_mfma_f32_16x16x32_bf16 v[184:187], a[132:135], a[28:31], v[184:187]
v_mfma_f32_16x16x32_bf16 v[192:195], a[128:131], a[32:35], v[192:195]
v_mfma_f32_16x16x32_bf16 v[192:195], a[132:135], a[36:39], v[192:195]
v_mfma_f32_16x16x32_bf16 v[200:203], a[128:131], a[40:43], v[200:203]
ds_read_b128 a[108:111], v3 offset:43008
v_mfma_f32_16x16x32_bf16 v[200:203], a[132:135], a[44:47], v[200:203]
v_mfma_f32_16x16x32_bf16 v[208:211], a[128:131], a[48:51], v[208:211]
ds_read_b128 a[112:115], v2 offset:45056
v_mfma_f32_16x16x32_bf16 v[208:211], a[132:135], a[52:55], v[208:211]
v_mfma_f32_16x16x32_bf16 v[216:219], a[128:131], a[56:59], v[216:219]
v_mfma_f32_16x16x32_bf16 v[216:219], a[132:135], a[60:63], v[216:219]
s_waitcnt lgkmcnt(2)
v_mfma_f32_16x16x32_bf16 v[164:167], a[136:139], a[0:3], v[164:167]
ds_read_b64_tr_b16 a[128:129], v10 offset:0
v_mfma_f32_16x16x32_bf16 v[164:167], a[140:143], a[4:7], v[164:167]
v_mfma_f32_16x16x32_bf16 v[172:175], a[136:139], a[8:11], v[172:175]
ds_read_b64_tr_b16 a[130:131], v10 offset:2048
v_mfma_f32_16x16x32_bf16 v[172:175], a[140:143], a[12:15], v[172:175]
v_mfma_f32_16x16x32_bf16 v[180:183], a[136:139], a[16:19], v[180:183]
ds_read_b64_tr_b16 a[132:133], v10 offset:16384
v_mfma_f32_16x16x32_bf16 v[180:183], a[140:143], a[20:23], v[180:183]
v_mfma_f32_16x16x32_bf16 v[188:191], a[136:139], a[24:27], v[188:191]
ds_read_b64_tr_b16 a[134:135], v10 offset:18432
v_mfma_f32_16x16x32_bf16 v[188:191], a[140:143], a[28:31], v[188:191]
v_mfma_f32_16x16x32_bf16 v[196:199], a[136:139], a[32:35], v[196:199]
ds_read_b128 a[116:119], v3 offset:45056
v_mfma_f32_16x16x32_bf16 v[196:199], a[140:143], a[36:39], v[196:199]
v_mfma_f32_16x16x32_bf16 v[204:207], a[136:139], a[40:43], v[204:207]
ds_read_b128 a[120:123], v2 offset:47104
v_and_b32 v252, 31, v0
v_mfma_f32_16x16x32_bf16 v[204:207], a[140:143], a[44:47], v[204:207]
v_lshrrev_b32 v253, 5, v0
v_xor_b32 v253, v253, v252
v_mfma_f32_16x16x32_bf16 v[212:215], a[136:139], a[48:51], v[212:215]
v_and_b32 v253, 7, v253
v_lshlrev_b32 v252, 8, v252
v_mfma_f32_16x16x32_bf16 v[212:215], a[140:143], a[52:55], v[212:215]
v_lshl_add_u32 v252, v253, 4, v252
v_add_u32 v252, 147456, v252
v_mfma_f32_16x16x32_bf16 v[220:223], a[136:139], a[56:59], v[220:223]
ds_read_b128 a[124:127], v3 offset:47104
v_mfma_f32_16x16x32_bf16 v[220:223], a[140:143], a[60:63], v[220:223]
s_waitcnt lgkmcnt(3)
v_mfma_f32_16x16x32_bf16 a[192:195], a[128:131], a[0:3], a[192:195]
ds_read_b64_tr_b16 a[136:137], v11 offset:0
v_mfma_f32_16x16x32_bf16 a[192:195], a[132:135], a[4:7], a[192:195]
v_mfma_f32_16x16x32_bf16 a[200:203], a[128:131], a[8:11], a[200:203]
ds_read_b64_tr_b16 a[138:139], v11 offset:2048
v_mfma_f32_16x16x32_bf16 a[200:203], a[132:135], a[12:15], a[200:203]
v_mfma_f32_16x16x32_bf16 a[208:211], a[128:131], a[16:19], a[208:211]
ds_read_b64_tr_b16 a[140:141], v11 offset:16384
v_mfma_f32_16x16x32_bf16 a[208:211], a[132:135], a[20:23], a[208:211]
v_mfma_f32_16x16x32_bf16 a[216:219], a[128:131], a[24:27], a[216:219]
ds_read_b64_tr_b16 a[142:143], v11 offset:18432
v_mfma_f32_16x16x32_bf16 a[216:219], a[132:135], a[28:31], a[216:219]
v_mfma_f32_16x16x32_bf16 a[224:227], a[128:131], a[32:35], a[224:227]
v_mfma_f32_16x16x32_bf16 a[224:227], a[132:135], a[36:39], a[224:227]
v_mfma_f32_16x16x32_bf16 a[232:235], a[128:131], a[40:43], a[232:235]
v_mfma_f32_16x16x32_bf16 a[232:235], a[132:135], a[44:47], a[232:235]
v_mfma_f32_16x16x32_bf16 a[240:243], a[128:131], a[48:51], a[240:243]
v_mfma_f32_16x16x32_bf16 a[240:243], a[132:135], a[52:55], a[240:243]
v_mfma_f32_16x16x32_bf16 a[248:251], a[128:131], a[56:59], a[248:251]
s_waitcnt vmcnt(1) lgkmcnt(0)
v_mfma_f32_16x16x32_bf16 a[248:251], a[132:135], a[60:63], a[248:251]
s_barrier
v_mfma_f32_16x16x32_bf16 a[196:199], a[136:139], a[0:3], a[196:199]
s_add_u32 m0, s29, 65536
ds_read_b64_tr_b16 a[128:129], v4 offset:32768
v_lshlrev_b32 v28, 16, v248
v_mfma_f32_16x16x32_bf16 a[196:199], a[140:143], a[4:7], a[196:199]
buffer_load_dwordx4 v16, s[12:15], s26 offen offset:0 lds
v_mfma_f32_16x16x32_bf16 a[204:207], a[136:139], a[8:11], a[204:207]
ds_read_b64_tr_b16 a[130:131], v4 offset:34816
v_and_b32 v29, s58, v248
v_mfma_f32_16x16x32_bf16 a[204:207], a[140:143], a[12:15], a[204:207]
v_lshlrev_b32 v30, 16, v249
v_and_b32 v253, s58, v249
v_mfma_f32_16x16x32_bf16 a[212:215], a[136:139], a[16:19], a[212:215]
ds_read_b64_tr_b16 a[132:133], v4 offset:49152
v_lshlrev_b32 v22, 16, v224
v_mfma_f32_16x16x32_bf16 a[212:215], a[140:143], a[20:23], a[212:215]
buffer_load_dwordx4 v17, s[12:15], s26 offen offset:1024 lds
v_mfma_f32_16x16x32_bf16 a[220:223], a[136:139], a[24:27], a[220:223]
ds_read_b64_tr_b16 a[134:135], v4 offset:51200
v_lshlrev_b32 v23, 16, v225
v_mfma_f32_16x16x32_bf16 a[220:223], a[140:143], a[28:31], a[220:223]
v_lshlrev_b32 v24, 16, v226
v_mul_f32 v254, v22, v253
v_mfma_f32_16x16x32_bf16 a[228:231], a[136:139], a[32:35], a[228:231]
v_lshlrev_b32 v25, 16, v227
v_lshlrev_b32 v247, 16, v236
v_mfma_f32_16x16x32_bf16 a[228:231], a[140:143], a[36:39], a[228:231]
buffer_load_dwordx4 v18, s[12:15], s26 offen offset:2048 lds
v_mfma_f32_16x16x32_bf16 a[236:239], a[136:139], a[40:43], a[236:239]
v_fmac_f32 v254, v23, v30
v_fmac_f32 v254, v24, v29
v_mfma_f32_16x16x32_bf16 a[236:239], a[140:143], a[44:47], a[236:239]
v_fmac_f32 v254, v25, v28
v_mul_f32 v254, v254, v247
v_mfma_f32_16x16x32_bf16 a[244:247], a[136:139], a[48:51], a[244:247]
v_mul_f32 v255, v23, v253
v_lshlrev_b32 v22, 16, v228
v_mfma_f32_16x16x32_bf16 a[244:247], a[140:143], a[52:55], a[244:247]
buffer_load_dwordx4 v19, s[12:15], s26 offen offset:3072 lds
v_mfma_f32_16x16x32_bf16 a[252:255], a[136:139], a[56:59], a[252:255]
s_add_u32 s26, s26, 524288
v_lshlrev_b32 v247, 16, v237
v_fmac_f32 v255, v24, v30
v_mfma_f32_16x16x32_bf16 a[252:255], a[140:143], a[60:63], a[252:255]
s_waitcnt lgkmcnt(0)
v_fmac_f32 v255, v25, v29
v_fmac_f32 v255, v22, v28
v_mfma_f32_16x16x32_bf16 v[32:35], a[128:131], a[64:67], v[32:35]
s_add_u32 m0, s29, 81920
ds_read_b64_tr_b16 a[136:137], v5 offset:32768
v_mul_f32 v255, v255, v247
v_mfma_f32_16x16x32_bf16 v[32:35], a[132:135], a[68:71], v[32:35]
buffer_load_dwordx4 v16, s[12:15], s27 offen offset:0 lds
v_mfma_f32_16x16x32_bf16 v[40:43], a[128:131], a[72:75], v[40:43]
ds_read_b64_tr_b16 a[138:139], v5 offset:34816
v_cvt_pk_bf16_f32 v246, v254, v255
v_mfma_f32_16x16x32_bf16 v[40:43], a[132:135], a[76:79], v[40:43]
v_accvgpr_write_b32 a180, v246
v_mul_f32 v254, v24, v253
v_mfma_f32_16x16x32_bf16 v[48:51], a[128:131], a[80:83], v[48:51]
ds_read_b64_tr_b16 a[140:141], v5 offset:49152
v_lshlrev_b32 v23, 16, v229
v_mfma_f32_16x16x32_bf16 v[48:51], a[132:135], a[84:87], v[48:51]
buffer_load_dwordx4 v17, s[12:15], s27 offen offset:1024 lds
v_mfma_f32_16x16x32_bf16 v[56:59], a[128:131], a[88:91], v[56:59]
ds_read_b64_tr_b16 a[142:143], v5 offset:51200
v_lshlrev_b32 v247, 16, v238
v_mfma_f32_16x16x32_bf16 v[56:59], a[132:135], a[92:95], v[56:59]
v_fmac_f32 v254, v25, v30
v_fmac_f32 v254, v22, v29
v_fmac_f32 v254, v23, v28
v_mfma_f32_16x16x32_bf16 v[64:67], a[128:131], a[96:99], v[64:67]
ds_read_b128 a[0:3], v2 offset:0
v_mul_f32 v254, v254, v247
v_mfma_f32_16x16x32_bf16 v[64:67], a[132:135], a[100:103], v[64:67]
buffer_load_dwordx4 v18, s[12:15], s27 offen offset:2048 lds
v_mfma_f32_16x16x32_bf16 v[72:75], a[128:131], a[104:107], v[72:75]
ds_read_b128 a[4:7], v3 offset:0
v_cvt_pk_bf16_f32 v246, v255, v254
v_mfma_f32_16x16x32_bf16 v[72:75], a[132:135], a[108:111], v[72:75]
v_accvgpr_write_b32 a176, v246
v_mul_f32 v255, v25, v253
v_mfma_f32_16x16x32_bf16 v[80:83], a[128:131], a[112:115], v[80:83]
v_lshlrev_b32 v24, 16, v230
v_lshlrev_b32 v247, 16, v239
v_mfma_f32_16x16x32_bf16 v[80:83], a[132:135], a[116:119], v[80:83]
buffer_load_dwordx4 v19, s[12:15], s27 offen offset:3072 lds
v_mfma_f32_16x16x32_bf16 v[88:91], a[128:131], a[120:123], v[88:91]
s_add_u32 s27, s27, 524288
ds_read_b128 a[8:11], v2 offset:2048
v_fmac_f32 v255, v22, v30
v_mfma_f32_16x16x32_bf16 v[88:91], a[132:135], a[124:127], v[88:91]
s_waitcnt lgkmcnt(3)
v_fmac_f32 v255, v23, v29
v_fmac_f32 v255, v24, v28
v_mul_f32 v255, v255, v247
v_mfma_f32_16x16x32_bf16 v[36:39], a[136:139], a[64:67], v[36:39]
s_add_u32 m0, s28, 32768
ds_read_b64_tr_b16 a[128:129], v6 offset:32768
v_cvt_pk_bf16_f32 v246, v254, v255
v_mfma_f32_16x16x32_bf16 v[36:39], a[140:143], a[68:71], v[36:39]
buffer_load_dwordx4 v12, s[8:11], s24 offen offset:0 lds
v_mfma_f32_16x16x32_bf16 v[44:47], a[136:139], a[72:75], v[44:47]
ds_read_b64_tr_b16 a[130:131], v6 offset:34816
v_accvgpr_write_b32 a181, v246
v_mfma_f32_16x16x32_bf16 v[44:47], a[140:143], a[76:79], v[44:47]
v_mul_f32 v254, v22, v253
v_lshlrev_b32 v25, 16, v231
v_mfma_f32_16x16x32_bf16 v[52:55], a[136:139], a[80:83], v[52:55]
ds_read_b64_tr_b16 a[132:133], v6 offset:49152
v_lshlrev_b32 v247, 16, v240
v_mfma_f32_16x16x32_bf16 v[52:55], a[140:143], a[84:87], v[52:55]
buffer_load_dwordx4 v13, s[8:11], s24 offen offset:1024 lds
v_mfma_f32_16x16x32_bf16 v[60:63], a[136:139], a[88:91], v[60:63]
ds_read_b64_tr_b16 a[134:135], v6 offset:51200
v_fmac_f32 v254, v23, v30
v_fmac_f32 v254, v24, v29
v_mfma_f32_16x16x32_bf16 v[60:63], a[140:143], a[92:95], v[60:63]
v_fmac_f32 v254, v25, v28
v_mul_f32 v254, v254, v247
v_mfma_f32_16x16x32_bf16 v[68:71], a[136:139], a[96:99], v[68:71]
ds_read_b128 a[12:15], v3 offset:2048
v_cvt_pk_bf16_f32 v246, v255, v254
v_mfma_f32_16x16x32_bf16 v[68:71], a[140:143], a[100:103], v[68:71]
buffer_load_dwordx4 v14, s[8:11], s24 offen offset:2048 lds
v_mfma_f32_16x16x32_bf16 v[76:79], a[136:139], a[104:107], v[76:79]
v_accvgpr_write_b32 a177, v246
v_mul_f32 v255, v23, v253
v_mfma_f32_16x16x32_bf16 v[76:79], a[140:143], a[108:111], v[76:79]
v_lshlrev_b32 v22, 16, v232
v_lshlrev_b32 v247, 16, v241
v_mfma_f32_16x16x32_bf16 v[84:87], a[136:139], a[112:115], v[84:87]
ds_read_b128 a[16:19], v2 offset:4096
v_fmac_f32 v255, v24, v30
v_mfma_f32_16x16x32_bf16 v[84:87], a[140:143], a[116:119], v[84:87]
buffer_load_dwordx4 v15, s[8:11], s24 offen offset:3072 lds
v_mfma_f32_16x16x32_bf16 v[92:95], a[136:139], a[120:123], v[92:95]
s_add_u32 s24, s24, 128
ds_read_b128 a[20:23], v3 offset:4096
v_fmac_f32 v255, v25, v29
v_fmac_f32 v255, v22, v28
v_mfma_f32_16x16x32_bf16 v[92:95], a[140:143], a[124:127], v[92:95]
s_waitcnt lgkmcnt(3)
v_mul_f32 v255, v255, v247
v_cvt_pk_bf16_f32 v246, v254, v255
v_mfma_f32_16x16x32_bf16 v[96:99], a[128:131], a[64:67], v[96:99]
s_add_u32 m0, s28, 36864
ds_read_b64_tr_b16 a[136:137], v7 offset:32768
v_accvgpr_write_b32 a182, v246
v_mfma_f32_16x16x32_bf16 v[96:99], a[132:135], a[68:71], v[96:99]
buffer_load_dwordx4 v12, s[8:11], s25 offen offset:0 lds
v_mfma_f32_16x16x32_bf16 v[104:107], a[128:131], a[72:75], v[104:107]
ds_read_b64_tr_b16 a[138:139], v7 offset:34816
v_mul_f32 v254, v24, v253
v_mfma_f32_16x16x32_bf16 v[104:107], a[132:135], a[76:79], v[104:107]
v_lshlrev_b32 v23, 16, v233
v_lshlrev_b32 v247, 16, v242
v_mfma_f32_16x16x32_bf16 v[112:115], a[128:131], a[80:83], v[112:115]
ds_read_b64_tr_b16 a[140:141], v7 offset:49152
v_fmac_f32 v254, v25, v30
v_mfma_f32_16x16x32_bf16 v[112:115], a[132:135], a[84:87], v[112:115]
buffer_load_dwordx4 v13, s[8:11], s25 offen offset:1024 lds
v_fmac_f32 v254, v22, v29
v_mfma_f32_16x16x32_bf16 v[120:123], a[128:131], a[88:91], v[120:123]
ds_read_b64_tr_b16 a[142:143], v7 offset:51200
v_fmac_f32 v254, v23, v28
v_mfma_f32_16x16x32_bf16 v[120:123], a[132:135], a[92:95], v[120:123]
v_mul_f32 v254, v254, v247
v_cvt_pk_bf16_f32 v246, v255, v254
v_mfma_f32_16x16x32_bf16 v[128:131], a[128:131], a[96:99], v[128:131]
v_accvgpr_write_b32 a178, v246
v_mul_f32 v255, v25, v253
v_mfma_f32_16x16x32_bf16 v[128:131], a[132:135], a[100:103], v[128:131]
buffer_load_dwordx4 v14, s[8:11], s25 offen offset:2048 lds
v_mfma_f32_16x16x32_bf16 v[136:139], a[128:131], a[104:107], v[136:139]
ds_read_b128 a[24:27], v2 offset:6144
v_lshlrev_b32 v24, 16, v234
v_mfma_f32_16x16x32_bf16 v[136:139], a[132:135], a[108:111], v[136:139]
v_lshlrev_b32 v247, 16, v243
v_fmac_f32 v255, v22, v30
v_mfma_f32_16x16x32_bf16 v[144:147], a[128:131], a[112:115], v[144:147]
ds_read_b128 a[28:31], v3 offset:6144
v_fmac_f32 v255, v23, v29
v_mfma_f32_16x16x32_bf16 v[144:147], a[132:135], a[116:119], v[144:147]
buffer_load_dwordx4 v15, s[8:11], s25 offen offset:3072 lds
v_fmac_f32 v255, v24, v28
v_mfma_f32_16x16x32_bf16 v[152:155], a[128:131], a[120:123], v[152:155]
s_add_u32 s25, s25, 128
v_mul_f32 v255, v255, v247
v_cvt_pk_bf16_f32 v246, v254, v255
v_mfma_f32_16x16x32_bf16 v[152:155], a[132:135], a[124:127], v[152:155]
s_waitcnt lgkmcnt(2)
v_accvgpr_write_b32 a183, v246
v_mul_f32 v254, v22, v253
v_mfma_f32_16x16x32_bf16 v[100:103], a[136:139], a[64:67], v[100:103]
ds_read_b64_tr_b16 a[128:129], v8 offset:32768
v_lshlrev_b32 v25, 16, v235
v_mfma_f32_16x16x32_bf16 v[100:103], a[140:143], a[68:71], v[100:103]
buffer_load_dword v21, v20, s[16:19], s43 offen
v_mfma_f32_16x16x32_bf16 v[108:111], a[136:139], a[72:75], v[108:111]
s_add_u32 s43, s43, s47
ds_read_b64_tr_b16 a[130:131], v8 offset:34816
v_lshlrev_b32 v247, 16, v244
v_mfma_f32_16x16x32_bf16 v[108:111], a[140:143], a[76:79], v[108:111]
s_cmp_ge_u32 s43, s51
v_fmac_f32 v254, v23, v30
v_fmac_f32 v254, v24, v29
v_mfma_f32_16x16x32_bf16 v[116:119], a[136:139], a[80:83], v[116:119]
s_cselect_b32 s43, 0, s43
ds_read_b64_tr_b16 a[132:133], v8 offset:49152
v_fmac_f32 v254, v25, v28
v_mul_f32 v254, v254, v247
v_mfma_f32_16x16x32_bf16 v[116:119], a[140:143], a[84:87], v[116:119]
s_cselect_b32 s51, s42, s51
v_cvt_pk_bf16_f32 v246, v255, v254
v_accvgpr_write_b32 a179, v246
v_mfma_f32_16x16x32_bf16 v[124:127], a[136:139], a[88:91], v[124:127]
s_cselect_b64 s[16:17], s[40:41], s[16:17]
ds_read_b64_tr_b16 a[134:135], v8 offset:51200
v_lshlrev_b32 v28, 16, v250
v_mfma_f32_16x16x32_bf16 v[124:127], a[140:143], a[92:95], v[124:127]
s_cselect_b32 s18, s42, s18
v_and_b32 v29, s58, v250
v_lshlrev_b32 v30, 16, v251
v_mfma_f32_16x16x32_bf16 v[132:135], a[136:139], a[96:99], v[132:135]
s_cselect_b64 s[40:41], s[44:45], s[40:41]
ds_read_b128 a[32:35], v2 offset:8192
v_and_b32 v253, s58, v251
v_mfma_f32_16x16x32_bf16 v[132:135], a[140:143], a[100:103], v[132:135]
s_cselect_b32 s42, s46, s42
v_and_b32 v22, s58, v224
v_and_b32 v23, s58, v225
v_mfma_f32_16x16x32_bf16 v[140:143], a[136:139], a[104:107], v[140:143]
s_cselect_b32 s46, 0, s46
v_and_b32 v24, s58, v226
v_mul_f32 v254, v22, v253
v_mfma_f32_16x16x32_bf16 v[140:143], a[140:143], a[108:111], v[140:143]
buffer_load_dword v21, off, s[60:63], s54 sc1
v_mfma_f32_16x16x32_bf16 v[148:151], a[136:139], a[112:115], v[148:151]
ds_read_b128 a[36:39], v3 offset:8192
v_and_b32 v25, s58, v227
v_and_b32 v247, s58, v236
v_mfma_f32_16x16x32_bf16 v[148:151], a[140:143], a[116:119], v[148:151]
v_fmac_f32 v254, v23, v30
v_fmac_f32 v254, v24, v29
v_mfma_f32_16x16x32_bf16 v[156:159], a[136:139], a[120:123], v[156:159]
ds_read_b128 a[40:43], v2 offset:10240
v_fmac_f32 v254, v25, v28
v_mfma_f32_16x16x32_bf16 v[156:159], a[140:143], a[124:127], v[156:159]
s_waitcnt lgkmcnt(3)
v_mul_f32 v254, v254, v247
v_mul_f32 v255, v23, v253
v_mfma_f32_16x16x32_bf16 v[160:163], a[128:131], a[64:67], v[160:163]
ds_read_b64_tr_b16 a[136:137], v9 offset:32768
v_and_b32 v22, s58, v228
v_mfma_f32_16x16x32_bf16 v[160:163], a[132:135], a[68:71], v[160:163]
v_and_b32 v247, s58, v237
v_fmac_f32 v255, v24, v30
v_mfma_f32_16x16x32_bf16 v[168:171], a[128:131], a[72:75], v[168:171]
ds_read_b64_tr_b16 a[138:139], v9 offset:34816
v_fmac_f32 v255, v25, v29
v_mfma_f32_16x16x32_bf16 v[168:171], a[132:135], a[76:79], v[168:171]
v_fmac_f32 v255, v22, v28
v_mul_f32 v255, v255, v247
v_mfma_f32_16x16x32_bf16 v[176:179], a[128:131], a[80:83], v[176:179]
ds_read_b64_tr_b16 a[140:141], v9 offset:49152
v_cvt_pk_bf16_f32 v246, v254, v255
v_accvgpr_write_b32 a188, v246
v_mfma_f32_16x16x32_bf16 v[176:179], a[132:135], a[84:87], v[176:179]
v_mul_f32 v254, v24, v253
v_and_b32 v23, s58, v229
v_mfma_f32_16x16x32_bf16 v[184:187], a[128:131], a[88:91], v[184:187]
ds_read_b64_tr_b16 a[142:143], v9 offset:51200
v_and_b32 v247, s58, v238
v_mfma_f32_16x16x32_bf16 v[184:187], a[132:135], a[92:95], v[184:187]
v_fmac_f32 v254, v25, v30
v_fmac_f32 v254, v22, v29
v_mfma_f32_16x16x32_bf16 v[192:195], a[128:131], a[96:99], v[192:195]
v_fmac_f32 v254, v23, v28
v_mul_f32 v254, v254, v247
v_mfma_f32_16x16x32_bf16 v[192:195], a[132:135], a[100:103], v[192:195]
v_cvt_pk_bf16_f32 v246, v255, v254
v_accvgpr_write_b32 a184, v246
v_mfma_f32_16x16x32_bf16 v[200:203], a[128:131], a[104:107], v[200:203]
ds_read_b128 a[44:47], v3 offset:10240
v_mul_f32 v255, v25, v253
v_mfma_f32_16x16x32_bf16 v[200:203], a[132:135], a[108:111], v[200:203]
v_and_b32 v24, s58, v230
v_and_b32 v247, s58, v239
v_fmac_f32 v255, v22, v30
v_mfma_f32_16x16x32_bf16 v[208:211], a[128:131], a[112:115], v[208:211]
ds_read_b128 a[48:51], v2 offset:12288
v_fmac_f32 v255, v23, v29
v_mfma_f32_16x16x32_bf16 v[208:211], a[132:135], a[116:119], v[208:211]
v_fmac_f32 v255, v24, v28
v_mul_f32 v255, v255, v247
v_mfma_f32_16x16x32_bf16 v[216:219], a[128:131], a[120:123], v[216:219]
v_cvt_pk_bf16_f32 v246, v254, v255
v_accvgpr_write_b32 a189, v246
v_mfma_f32_16x16x32_bf16 v[216:219], a[132:135], a[124:127], v[216:219]
s_waitcnt lgkmcnt(2)
v_mul_f32 v254, v22, v253
v_and_b32 v25, s58, v231
v_mfma_f32_16x16x32_bf16 v[164:167], a[136:139], a[64:67], v[164:167]
ds_read_b64_tr_b16 a[128:129], v10 offset:32768
v_and_b32 v247, s58, v240
v_mfma_f32_16x16x32_bf16 v[164:167], a[140:143], a[68:71], v[164:167]
v_fmac_f32 v254, v23, v30
v_fmac_f32 v254, v24, v29
v_mfma_f32_16x16x32_bf16 v[172:175], a[136:139], a[72:75], v[172:175]
ds_read_b64_tr_b16 a[130:131], v10 offset:34816
v_fmac_f32 v254, v25, v28
v_mfma_f32_16x16x32_bf16 v[172:175], a[140:143], a[76:79], v[172:175]
v_mul_f32 v254, v254, v247
v_cvt_pk_bf16_f32 v246, v255, v254
v_accvgpr_write_b32 a185, v246
v_mfma_f32_16x16x32_bf16 v[180:183], a[136:139], a[80:83], v[180:183]
s_lshr_b32 s22, s3, 1
ds_read_b64_tr_b16 a[132:133], v10 offset:49152
v_mul_f32 v255, v23, v253
v_mfma_f32_16x16x32_bf16 v[180:183], a[140:143], a[84:87], v[180:183]
s_mul_i32 s22, s22, 2097152
v_and_b32 v22, s58, v232
v_and_b32 v247, s58, v241
v_mfma_f32_16x16x32_bf16 v[188:191], a[136:139], a[88:91], v[188:191]
s_and_b32 s23, s3, 1
ds_read_b64_tr_b16 a[134:135], v10 offset:51200
v_fmac_f32 v255, v24, v30
v_mfma_f32_16x16x32_bf16 v[188:191], a[140:143], a[92:95], v[188:191]
s_lshl_b32 s23, s23, 5
v_fmac_f32 v255, v25, v29
v_fmac_f32 v255, v22, v28
v_mfma_f32_16x16x32_bf16 v[196:199], a[136:139], a[96:99], v[196:199]
s_lshl_b32 s56, s39, 6
ds_read_b128 a[52:55], v3 offset:12288
v_mul_f32 v255, v255, v247
v_mfma_f32_16x16x32_bf16 v[196:199], a[140:143], a[100:103], v[196:199]
s_add_u32 s23, s23, s56
v_cvt_pk_bf16_f32 v246, v254, v255
v_accvgpr_write_b32 a190, v246
v_mfma_f32_16x16x32_bf16 v[204:207], a[136:139], a[104:107], v[204:207]
s_mul_i32 s23, s23, 4224
ds_read_b128 a[56:59], v2 offset:14336
v_mul_f32 v254, v24, v253
v_and_b32 v23, s58, v233
v_mfma_f32_16x16x32_bf16 v[204:207], a[140:143], a[108:111], v[204:207]
s_add_u32 s22, s22, s23
v_and_b32 v247, s58, v242
v_fmac_f32 v254, v25, v30
v_mfma_f32_16x16x32_bf16 v[212:215], a[136:139], a[112:115], v[212:215]
s_add_u32 s57, s22, 83886200
v_fmac_f32 v254, v22, v29
v_fmac_f32 v254, v23, v28
v_mfma_f32_16x16x32_bf16 v[212:215], a[140:143], a[116:119], v[212:215]
s_lshl_b32 s23, s38, 7
v_mul_f32 v254, v254, v247
v_cvt_pk_bf16_f32 v246, v255, v254
v_mfma_f32_16x16x32_bf16 v[220:223], a[136:139], a[120:123], v[220:223]
s_add_u32 s22, s22, s23
ds_read_b128 a[60:63], v3 offset:14336
v_accvgpr_write_b32 a186, v246
v_mfma_f32_16x16x32_bf16 v[220:223], a[140:143], a[124:127], v[220:223]
s_waitcnt lgkmcnt(3)
s_add_u32 s56, s22, 83886208
v_mul_f32 v255, v25, v253
v_and_b32 v24, s58, v234
v_mfma_f32_16x16x32_bf16 a[192:195], a[128:131], a[64:67], a[192:195]
s_cmp_lt_u32 s2, 224
ds_read_b64_tr_b16 a[136:137], v11 offset:32768
v_and_b32 v247, s58, v243
v_mfma_f32_16x16x32_bf16 a[192:195], a[132:135], a[68:71], a[192:195]
s_cselect_b32 s56, s56, 3221225472
v_fmac_f32 v255, v22, v30
v_fmac_f32 v255, v23, v29
v_mfma_f32_16x16x32_bf16 a[200:203], a[128:131], a[72:75], a[200:203]
s_cmp_eq_u32 s38, 0
ds_read_b64_tr_b16 a[138:139], v11 offset:34816
v_fmac_f32 v255, v24, v28
v_mul_f32 v255, v255, v247
v_mfma_f32_16x16x32_bf16 a[200:203], a[132:135], a[76:79], a[200:203]
s_cselect_b32 s57, s57, 3221225472
v_cvt_pk_bf16_f32 v246, v254, v255
v_accvgpr_write_b32 a191, v246
v_mfma_f32_16x16x32_bf16 a[208:211], a[128:131], a[80:83], a[208:211]
ds_read_b64_tr_b16 a[140:141], v11 offset:49152
v_mul_f32 v254, v22, v253
v_mfma_f32_16x16x32_bf16 a[208:211], a[132:135], a[84:87], a[208:211]
v_and_b32 v25, s58, v235
v_and_b32 v247, s58, v244
v_mfma_f32_16x16x32_bf16 a[216:219], a[128:131], a[88:91], a[216:219]
ds_read_b64_tr_b16 a[142:143], v11 offset:51200
v_fmac_f32 v254, v23, v30
v_mfma_f32_16x16x32_bf16 a[216:219], a[132:135], a[92:95], a[216:219]
ds_write_b128 v252, a[176:179] offset:0
v_fmac_f32 v254, v24, v29
v_mfma_f32_16x16x32_bf16 a[224:227], a[128:131], a[96:99], a[224:227]
v_fmac_f32 v254, v25, v28
v_mul_f32 v254, v254, v247
v_mfma_f32_16x16x32_bf16 a[224:227], a[132:135], a[100:103], a[224:227]
ds_write_b128 v252, a[180:183] offset:8192
v_cvt_pk_bf16_f32 v246, v255, v254
v_accvgpr_write_b32 a187, v246
v_mfma_f32_16x16x32_bf16 a[232:235], a[128:131], a[104:107], a[232:235]
v_mfma_f32_16x16x32_bf16 a[232:235], a[132:135], a[108:111], a[232:235]
ds_write_b128 v252, a[184:187] offset:128
v_mfma_f32_16x16x32_bf16 a[240:243], a[128:131], a[112:115], a[240:243]
v_mfma_f32_16x16x32_bf16 a[240:243], a[132:135], a[116:119], a[240:243]
ds_write_b128 v252, a[188:191] offset:8320
v_mfma_f32_16x16x32_bf16 a[248:251], a[128:131], a[120:123], a[248:251]
s_waitcnt vmcnt(2) lgkmcnt(0)
v_mfma_f32_16x16x32_bf16 a[248:251], a[132:135], a[124:127], a[248:251]
s_barrier
v_mfma_f32_16x16x32_bf16 a[196:199], a[136:139], a[64:67], a[196:199]
s_add_u32 m0, s29, 98304
ds_read_b64_tr_b16 a[128:129], v4 offset:0
v_lshrrev_b32 v22, 8, v1
v_mfma_f32_16x16x32_bf16 a[196:199], a[140:143], a[68:71], a[196:199]
buffer_load_dwordx4 v16, s[12:15], s26 offen offset:0 lds
v_mfma_f32_16x16x32_bf16 a[204:207], a[136:139], a[72:75], a[204:207]
ds_read_b64_tr_b16 a[130:131], v4 offset:2048
v_lshlrev_b32 v22, 4, v22
v_mfma_f32_16x16x32_bf16 a[204:207], a[140:143], a[76:79], a[204:207]
v_xor_b32 v22, v22, v1
v_add_u32 v22, s29, v22
v_mfma_f32_16x16x32_bf16 a[212:215], a[136:139], a[80:83], a[212:215]
ds_read_b64_tr_b16 a[132:133], v4 offset:16384
v_add_u32 v22, 147456, v22
v_mfma_f32_16x16x32_bf16 a[212:215], a[140:143], a[84:87], a[212:215]
buffer_load_dwordx4 v17, s[12:15], s26 offen offset:1024 lds
v_mfma_f32_16x16x32_bf16 a[220:223], a[136:139], a[88:91], a[220:223]
ds_read_b64_tr_b16 a[134:135], v4 offset:18432
v_xor_b32 v23, 64, v22
v_mfma_f32_16x16x32_bf16 a[220:223], a[140:143], a[92:95], a[220:223]
v_lshrrev_b32 v224, 7, v1
v_mul_u32_u24 v224, 4224, v224
v_mfma_f32_16x16x32_bf16 a[228:231], a[136:139], a[96:99], a[228:231]
v_and_b32 v225, 0x70, v1
v_add_u32 v224, v224, v225
v_mfma_f32_16x16x32_bf16 a[228:231], a[140:143], a[100:103], a[228:231]
buffer_load_dwordx4 v18, s[12:15], s26 offen offset:2048 lds
v_mfma_f32_16x16x32_bf16 a[236:239], a[136:139], a[104:107], a[236:239]
v_bfe_u32 v225, v1, 4, 5
v_mul_u32_u24 v225, 4224, v225
v_mfma_f32_16x16x32_bf16 a[236:239], a[140:143], a[108:111], a[236:239]
v_mov_b32 v226, 0
v_mov_b32 v227, 0
v_mfma_f32_16x16x32_bf16 a[244:247], a[136:139], a[112:115], a[244:247]
v_mfma_f32_16x16x32_bf16 a[244:247], a[140:143], a[116:119], a[244:247]
buffer_load_dwordx4 v19, s[12:15], s26 offen offset:3072 lds
v_mfma_f32_16x16x32_bf16 a[252:255], a[136:139], a[120:123], a[252:255]
s_add_u32 s26, s26, 524288
v_mfma_f32_16x16x32_bf16 a[252:255], a[140:143], a[124:127], a[252:255]
s_waitcnt lgkmcnt(0)
v_mfma_f32_16x16x32_bf16 v[32:35], a[128:131], a[0:3], v[32:35]
s_add_u32 m0, s29, 114688
ds_read_b64_tr_b16 a[136:137], v5 offset:0
v_mfma_f32_16x16x32_bf16 v[32:35], a[132:135], a[4:7], v[32:35]
buffer_load_dwordx4 v16, s[12:15], s27 offen offset:0 lds
v_mfma_f32_16x16x32_bf16 v[40:43], a[128:131], a[8:11], v[40:43]
s_mul_i32 s52, s20, 7
ds_read_b64_tr_b16 a[138:139], v5 offset:2048
v_mfma_f32_16x16x32_bf16 v[40:43], a[132:135], a[12:15], v[40:43]
s_add_u32 s52, s52, s21
buffer_store_dwordx2 v[226:227], v225, s[4:7], s57 offen sc1
v_mfma_f32_16x16x32_bf16 v[48:51], a[128:131], a[16:19], v[48:51]
s_lshl_b32 s53, s52, 2
ds_read_b64_tr_b16 a[140:141], v5 offset:16384
v_mfma_f32_16x16x32_bf16 v[48:51], a[132:135], a[20:23], v[48:51]
s_add_u32 s53, s53, s3
buffer_load_dwordx4 v17, s[12:15], s27 offen offset:1024 lds
v_mfma_f32_16x16x32_bf16 v[56:59], a[128:131], a[24:27], v[56:59]
s_lshl_b32 s49, s53, 12
ds_read_b64_tr_b16 a[142:143], v5 offset:18432
v_mfma_f32_16x16x32_bf16 v[56:59], a[132:135], a[28:31], v[56:59]
s_mul_i32 s53, s53, 4224
v_mfma_f32_16x16x32_bf16 v[64:67], a[128:131], a[32:35], v[64:67]
s_add_u32 s53, s53, 83886080
ds_read_b128 a[64:67], v2 offset:32768
v_mfma_f32_16x16x32_bf16 v[64:67], a[132:135], a[36:39], v[64:67]
s_lshr_b32 s52, s52, 4
buffer_load_dwordx4 v18, s[12:15], s27 offen offset:2048 lds
v_mfma_f32_16x16x32_bf16 v[72:75], a[128:131], a[40:43], v[72:75]
s_min_u32 s52, s52, 6
ds_read_b128 a[68:71], v3 offset:32768
v_mfma_f32_16x16x32_bf16 v[72:75], a[132:135], a[44:47], v[72:75]
s_lshl_b32 s52, s52, 7
ds_read_b128 a[176:179], v22 offset:0
v_mfma_f32_16x16x32_bf16 v[80:83], a[128:131], a[48:51], v[80:83]
s_add_u32 s52, s52, 94392320
ds_read_b128 a[180:183], v23 offset:1024
v_mfma_f32_16x16x32_bf16 v[80:83], a[132:135], a[52:55], v[80:83]
buffer_load_dwordx4 v19, s[12:15], s27 offen offset:3072 lds
v_mfma_f32_16x16x32_bf16 v[88:91], a[128:131], a[56:59], v[88:91]
s_add_u32 s27, s27, 524288
ds_read_b128 a[72:75], v2 offset:34816
v_mfma_f32_16x16x32_bf16 v[88:91], a[132:135], a[60:63], v[88:91]
s_waitcnt lgkmcnt(5)
ds_read_b128 a[184:187], v22 offset:2048
v_mfma_f32_16x16x32_bf16 v[36:39], a[136:139], a[0:3], v[36:39]
s_add_u32 m0, s28, 0
ds_read_b64_tr_b16 a[128:129], v6 offset:0
v_mfma_f32_16x16x32_bf16 v[36:39], a[140:143], a[4:7], v[36:39]
buffer_load_dwordx4 v12, s[8:11], s24 offen offset:0 lds
v_mfma_f32_16x16x32_bf16 v[44:47], a[136:139], a[8:11], v[44:47]
ds_read_b64_tr_b16 a[130:131], v6 offset:2048
v_mfma_f32_16x16x32_bf16 v[44:47], a[140:143], a[12:15], v[44:47]
PAD_3:
s_cbranch_execz M_tret
ds_read_b128 a[188:191], v23 offset:3072
v_mfma_f32_16x16x32_bf16 v[52:55], a[136:139], a[16:19], v[52:55]
ds_read_b64_tr_b16 a[132:133], v6 offset:16384
v_bfe_u32 v231, v1, 4, 5
v_mfma_f32_16x16x32_bf16 v[52:55], a[140:143], a[20:23], v[52:55]
buffer_load_dwordx4 v13, s[8:11], s24 offen offset:1024 lds
v_mfma_f32_16x16x32_bf16 v[60:63], a[136:139], a[24:27], v[60:63]
ds_read_b64_tr_b16 a[134:135], v6 offset:18432
v_lshlrev_b32 v231, 2, v231
v_mfma_f32_16x16x32_bf16 v[60:63], a[140:143], a[28:31], v[60:63]
v_lshlrev_b32 v229, 3, v1
v_min_u32 v229, 4096, v229
v_mfma_f32_16x16x32_bf16 v[68:71], a[136:139], a[32:35], v[68:71]
ds_read_b128 a[76:79], v3 offset:34816
v_mfma_f32_16x16x32_bf16 v[68:71], a[140:143], a[36:39], v[68:71]
buffer_load_dwordx4 v14, s[8:11], s24 offen offset:2048 lds
v_mfma_f32_16x16x32_bf16 v[76:79], a[136:139], a[40:43], v[76:79]
v_mfma_f32_16x16x32_bf16 v[76:79], a[140:143], a[44:47], v[76:79]
v_mfma_f32_16x16x32_bf16 v[84:87], a[136:139], a[48:51], v[84:87]
ds_read_b128 a[80:83], v2 offset:36864
v_mfma_f32_16x16x32_bf16 v[84:87], a[140:143], a[52:55], v[84:87]
buffer_load_dwordx4 v15, s[8:11], s24 offen offset:3072 lds
v_mfma_f32_16x16x32_bf16 v[92:95], a[136:139], a[56:59], v[92:95]
s_add_u32 s24, s24, 128
ds_read_b128 a[84:87], v3 offset:36864
v_mfma_f32_16x16x32_bf16 v[92:95], a[140:143], a[60:63], v[92:95]
s_waitcnt lgkmcnt(3)
v_mfma_f32_16x16x32_bf16 v[96:99], a[128:131], a[0:3], v[96:99]
s_add_u32 m0, s28, 4096
ds_read_b64_tr_b16 a[136:137], v7 offset:0
v_mfma_f32_16x16x32_bf16 v[96:99], a[132:135], a[4:7], v[96:99]
buffer_load_dwordx4 v12, s[8:11], s25 offen offset:0 lds
v_mfma_f32_16x16x32_bf16 v[104:107], a[128:131], a[8:11], v[104:107]
ds_read_b64_tr_b16 a[138:139], v7 offset:2048
v_mfma_f32_16x16x32_bf16 v[104:107], a[132:135], a[12:15], v[104:107]
v_mfma_f32_16x16x32_bf16 v[112:115], a[128:131], a[16:19], v[112:115]
ds_read_b64_tr_b16 a[140:141], v7 offset:16384
v_mfma_f32_16x16x32_bf16 v[112:115], a[132:135], a[20:23], v[112:115]
buffer_load_dwordx4 v13, s[8:11], s25 offen offset:1024 lds
v_mfma_f32_16x16x32_bf16 v[120:123], a[128:131], a[24:27], v[120:123]
ds_read_b64_tr_b16 a[142:143], v7 offset:18432
v_mfma_f32_16x16x32_bf16 v[120:123], a[132:135], a[28:31], v[120:123]
v_mfma_f32_16x16x32_bf16 v[128:131], a[128:131], a[32:35], v[128:131]
v_mfma_f32_16x16x32_bf16 v[128:131], a[132:135], a[36:39], v[128:131]
buffer_load_dwordx4 v14, s[8:11], s25 offen offset:2048 lds
v_mfma_f32_16x16x32_bf16 v[136:139], a[128:131], a[40:43], v[136:139]
ds_read_b128 a[88:91], v2 offset:38912
v_mfma_f32_16x16x32_bf16 v[136:139], a[132:135], a[44:47], v[136:139]
v_mfma_f32_16x16x32_bf16 v[144:147], a[128:131], a[48:51], v[144:147]
ds_read_b128 a[92:95], v3 offset:38912
v_mfma_f32_16x16x32_bf16 v[144:147], a[132:135], a[52:55], v[144:147]
buffer_load_dwordx4 v15, s[8:11], s25 offen offset:3072 lds
v_mfma_f32_16x16x32_bf16 v[152:155], a[128:131], a[56:59], v[152:155]
s_add_u32 s25, s25, 128
v_mfma_f32_16x16x32_bf16 v[152:155], a[132:135], a[60:63], v[152:155]
s_waitcnt lgkmcnt(2)
v_mfma_f32_16x16x32_bf16 v[100:103], a[136:139], a[0:3], v[100:103]
ds_read_b64_tr_b16 a[128:129], v8 offset:0
v_mfma_f32_16x16x32_bf16 v[100:103], a[140:143], a[4:7], v[100:103]
buffer_store_dwordx4 a[176:179], v224, s[4:7], s56 offen sc1
v_mfma_f32_16x16x32_bf16 v[108:111], a[136:139], a[8:11], v[108:111]
s_add_u32 s56, s56, 33792
ds_read_b64_tr_b16 a[130:131], v8 offset:2048
v_mfma_f32_16x16x32_bf16 v[108:111], a[140:143], a[12:15], v[108:111]
v_mfma_f32_16x16x32_bf16 v[116:119], a[136:139], a[16:19], v[116:119]
ds_read_b64_tr_b16 a[132:133], v8 offset:16384
v_mfma_f32_16x16x32_bf16 v[116:119], a[140:143], a[20:23], v[116:119]
v_mfma_f32_16x16x32_bf16 v[124:127], a[136:139], a[24:27], v[124:127]
s_cmp_lt_u32 s21, 0
ds_read_b64_tr_b16 a[134:135], v8 offset:18432
v_mfma_f32_16x16x32_bf16 v[124:127], a[140:143], a[28:31], v[124:127]
s_cselect_b32 s53, s53, 3221225472
v_mfma_f32_16x16x32_bf16 v[132:135], a[136:139], a[32:35], v[132:135]
s_cselect_b32 s49, s49, 3221225472
ds_read_b128 a[96:99], v2 offset:40960
v_mfma_f32_16x16x32_bf16 v[132:135], a[140:143], a[36:39], v[132:135]
s_add_u32 s48, s53, 2097152
v_mfma_f32_16x16x32_bf16 v[140:143], a[136:139], a[40:43], v[140:143]
v_mfma_f32_16x16x32_bf16 v[140:143], a[140:143], a[44:47], v[140:143]
v_mfma_f32_16x16x32_bf16 v[148:151], a[136:139], a[48:51], v[148:151]
ds_read_b128 a[100:103], v3 offset:40960
v_mfma_f32_16x16x32_bf16 v[148:151], a[140:143], a[52:55], v[148:151]
v_mfma_f32_16x16x32_bf16 v[156:159], a[136:139], a[56:59], v[156:159]
ds_read_b128 a[104:107], v2 offset:43008
v_mfma_f32_16x16x32_bf16 v[156:159], a[140:143], a[60:63], v[156:159]
s_waitcnt lgkmcnt(3)
v_mfma_f32_16x16x32_bf16 v[160:163], a[128:131], a[0:3], v[160:163]
ds_read_b64_tr_b16 a[136:137], v9 offset:0
v_mfma_f32_16x16x32_bf16 v[160:163], a[132:135], a[4:7], v[160:163]
v_mfma_f32_16x16x32_bf16 v[168:171], a[128:131], a[8:11], v[168:171]
ds_read_b64_tr_b16 a[138:139], v9 offset:2048
v_mfma_f32_16x16x32_bf16 v[168:171], a[132:135], a[12:15], v[168:171]
buffer_store_dwordx4 a[180:183], v224, s[4:7], s56 offen sc1
v_mfma_f32_16x16x32_bf16 v[176:179], a[128:131], a[16:19], v[176:179]
s_add_u32 s56, s56, 33792
ds_read_b64_tr_b16 a[140:141], v9 offset:16384
v_mfma_f32_16x16x32_bf16 v[176:179], a[132:135], a[20:23], v[176:179]
v_mfma_f32_16x16x32_bf16 v[184:187], a[128:131], a[24:27], v[184:187]
s_lshl_b32 s22, s2, 14
ds_read_b64_tr_b16 a[142:143], v9 offset:18432
v_mfma_f32_16x16x32_bf16 v[184:187], a[132:135], a[28:31], v[184:187]
s_cmp_eq_u32 s3, 2
v_mfma_f32_16x16x32_bf16 v[192:195], a[128:131], a[32:35], v[192:195]
s_cselect_b32 s47, 512, s47
v_mfma_f32_16x16x32_bf16 v[192:195], a[132:135], a[36:39], v[192:195]
s_cselect_b32 vcc_lo, -1, 0
v_mfma_f32_16x16x32_bf16 v[200:203], a[128:131], a[40:43], v[200:203]
s_mov_b32 vcc_hi, 0
ds_read_b128 a[108:111], v3 offset:43008
v_bfe_u32 v232, v1, 6, 3
v_mfma_f32_16x16x32_bf16 v[200:203], a[132:135], a[44:47], v[200:203]
v_lshl_add_u32 v232, v232, 11, s22
v_bfe_u32 v233, v1, 4, 2
v_mfma_f32_16x16x32_bf16 v[208:211], a[128:131], a[48:51], v[208:211]
ds_read_b128 a[112:115], v2 offset:45056
v_lshl_add_u32 v232, v233, 7, v232
v_mfma_f32_16x16x32_bf16 v[208:211], a[132:135], a[52:55], v[208:211]
v_cndmask_b32 v20, v20, v232, vcc
v_mfma_f32_16x16x32_bf16 v[216:219], a[128:131], a[56:59], v[216:219]
v_mfma_f32_16x16x32_bf16 v[216:219], a[132:135], a[60:63], v[216:219]
s_waitcnt lgkmcnt(2)
v_mfma_f32_16x16x32_bf16 v[164:167], a[136:139], a[0:3], v[164:167]
ds_read_b64_tr_b16 a[128:129], v10 offset:0
v_mfma_f32_16x16x32_bf16 v[164:167], a[140:143], a[4:7], v[164:167]
v_mfma_f32_16x16x32_bf16 v[172:175], a[136:139], a[8:11], v[172:175]
ds_read_b64_tr_b16 a[130:131], v10 offset:2048
v_mfma_f32_16x16x32_bf16 v[172:175], a[140:143], a[12:15], v[172:175]
v_mfma_f32_16x16x32_bf16 v[180:183], a[136:139], a[16:19], v[180:183]
ds_read_b64_tr_b16 a[132:133], v10 offset:16384
v_mfma_f32_16x16x32_bf16 v[180:183], a[140:143], a[20:23], v[180:183]
buffer_store_dwordx4 a[184:187], v224, s[4:7], s56 offen sc1
v_mfma_f32_16x16x32_bf16 v[188:191], a[136:139], a[24:27], v[188:191]
s_add_u32 s56, s56, 33792
ds_read_b64_tr_b16 a[134:135], v10 offset:18432
v_mfma_f32_16x16x32_bf16 v[188:191], a[140:143], a[28:31], v[188:191]
v_mfma_f32_16x16x32_bf16 v[196:199], a[136:139], a[32:35], v[196:199]
ds_read_b128 a[116:119], v3 offset:45056
v_mfma_f32_16x16x32_bf16 v[196:199], a[140:143], a[36:39], v[196:199]
v_mfma_f32_16x16x32_bf16 v[204:207], a[136:139], a[40:43], v[204:207]
ds_read_b128 a[120:123], v2 offset:47104
v_mfma_f32_16x16x32_bf16 v[204:207], a[140:143], a[44:47], v[204:207]
v_mfma_f32_16x16x32_bf16 v[212:215], a[136:139], a[48:51], v[212:215]
v_mfma_f32_16x16x32_bf16 v[212:215], a[140:143], a[52:55], v[212:215]
v_mfma_f32_16x16x32_bf16 v[220:223], a[136:139], a[56:59], v[220:223]
ds_read_b128 a[124:127], v3 offset:47104
v_mfma_f32_16x16x32_bf16 v[220:223], a[140:143], a[60:63], v[220:223]
s_waitcnt lgkmcnt(3)
v_mfma_f32_16x16x32_bf16 a[192:195], a[128:131], a[0:3], a[192:195]
ds_read_b64_tr_b16 a[136:137], v11 offset:0
v_mfma_f32_16x16x32_bf16 a[192:195], a[132:135], a[4:7], a[192:195]
v_mfma_f32_16x16x32_bf16 a[200:203], a[128:131], a[8:11], a[200:203]
ds_read_b64_tr_b16 a[138:139], v11 offset:2048
v_mfma_f32_16x16x32_bf16 a[200:203], a[132:135], a[12:15], a[200:203]
v_mfma_f32_16x16x32_bf16 a[208:211], a[128:131], a[16:19], a[208:211]
ds_read_b64_tr_b16 a[140:141], v11 offset:16384
v_mfma_f32_16x16x32_bf16 a[208:211], a[132:135], a[20:23], a[208:211]
v_mfma_f32_16x16x32_bf16 a[216:219], a[128:131], a[24:27], a[216:219]
ds_read_b64_tr_b16 a[142:143], v11 offset:18432
v_mfma_f32_16x16x32_bf16 a[216:219], a[132:135], a[28:31], a[216:219]
buffer_store_dwordx4 a[188:191], v224, s[4:7], s56 offen sc1
v_mfma_f32_16x16x32_bf16 a[224:227], a[128:131], a[32:35], a[224:227]
s_add_u32 s56, s56, 33792
v_mfma_f32_16x16x32_bf16 a[224:227], a[132:135], a[36:39], a[224:227]
v_mfma_f32_16x16x32_bf16 a[232:235], a[128:131], a[40:43], a[232:235]
v_mfma_f32_16x16x32_bf16 a[232:235], a[132:135], a[44:47], a[232:235]
v_mfma_f32_16x16x32_bf16 a[240:243], a[128:131], a[48:51], a[240:243]
v_mfma_f32_16x16x32_bf16 a[240:243], a[132:135], a[52:55], a[240:243]
v_mfma_f32_16x16x32_bf16 a[248:251], a[128:131], a[56:59], a[248:251]
s_waitcnt vmcnt(4) lgkmcnt(0)
v_mfma_f32_16x16x32_bf16 a[248:251], a[132:135], a[60:63], a[248:251]
s_barrier
v_mfma_f32_16x16x32_bf16 a[196:199], a[136:139], a[0:3], a[196:199]
s_add_u32 m0, s29, 65536
ds_read_b64_tr_b16 a[128:129], v4 offset:32768
v_mfma_f32_16x16x32_bf16 a[196:199], a[140:143], a[4:7], a[196:199]
buffer_load_dwordx4 v16, s[12:15], s26 offen offset:0 lds
v_mfma_f32_16x16x32_bf16 a[204:207], a[136:139], a[8:11], a[204:207]
ds_read_b64_tr_b16 a[130:131], v4 offset:34816
v_cmp_gt_u32 vcc, s50, v21
v_mfma_f32_16x16x32_bf16 a[204:207], a[140:143], a[12:15], a[204:207]
v_mfma_f32_16x16x32_bf16 a[212:215], a[136:139], a[16:19], a[212:215]
ds_read_b64_tr_b16 a[132:133], v4 offset:49152
v_mfma_f32_16x16x32_bf16 a[212:215], a[140:143], a[20:23], a[212:215]
buffer_load_dwordx4 v17, s[12:15], s26 offen offset:1024 lds
v_mfma_f32_16x16x32_bf16 a[220:223], a[136:139], a[24:27], a[220:223]
ds_read_b64_tr_b16 a[134:135], v4 offset:51200
v_mfma_f32_16x16x32_bf16 a[220:223], a[140:143], a[28:31], a[220:223]
v_mfma_f32_16x16x32_bf16 a[228:231], a[136:139], a[32:35], a[228:231]
v_mfma_f32_16x16x32_bf16 a[228:231], a[140:143], a[36:39], a[228:231]
buffer_load_dwordx4 v18, s[12:15], s26 offen offset:2048 lds
v_mfma_f32_16x16x32_bf16 a[236:239], a[136:139], a[40:43], a[236:239]
v_mfma_f32_16x16x32_bf16 a[236:239], a[140:143], a[44:47], a[236:239]
v_mfma_f32_16x16x32_bf16 a[244:247], a[136:139], a[48:51], a[244:247]
v_mfma_f32_16x16x32_bf16 a[244:247], a[140:143], a[52:55], a[244:247]
buffer_load_dwordx4 v19, s[12:15], s26 offen offset:3072 lds
v_mfma_f32_16x16x32_bf16 a[252:255], a[136:139], a[56:59], a[252:255]
s_add_u32 s26, s26, 524288
v_mfma_f32_16x16x32_bf16 a[252:255], a[140:143], a[60:63], a[252:255]
s_waitcnt lgkmcnt(0)
s_mov_b32 s82, s59
s_cbranch_vccnz M_cntspinK
s_branch Lg_1
PAD_4:
s_cbranch_execz M_tret
Lg_1t:
v_mfma_f32_16x16x32_bf16 v[32:35], a[128:131], a[64:67], v[32:35]
s_add_u32 m0, s29, 81920
ds_read_b64_tr_b16 a[136:137], v5 offset:32768
v_mfma_f32_16x16x32_bf16 v[32:35], a[132:135], a[68:71], v[32:35]
buffer_load_dwordx4 v16, s[12:15], s27 offen offset:0 lds
v_mfma_f32_16x16x32_bf16 v[40:43], a[128:131], a[72:75], v[40:43]
s_and_b32 s44, s3, 1
ds_read_b64_tr_b16 a[138:139], v5 offset:34816
v_mfma_f32_16x16x32_bf16 v[40:43], a[132:135], a[76:79], v[40:43]
s_lshl_b32 s44, s44, 8
v_mfma_f32_16x16x32_bf16 v[48:51], a[128:131], a[80:83], v[48:51]
s_lshl_b32 s45, s3, 7
ds_read_b64_tr_b16 a[140:141], v5 offset:49152
v_mfma_f32_16x16x32_bf16 v[48:51], a[132:135], a[84:87], v[48:51]
s_xor_b32 s44, s44, s45
buffer_load_dwordx4 v17, s[12:15], s27 offen offset:1024 lds
v_mfma_f32_16x16x32_bf16 v[56:59], a[128:131], a[88:91], v[56:59]
s_xor_b32 s44, s44, 196608
ds_read_b64_tr_b16 a[142:143], v5 offset:51200
v_mfma_f32_16x16x32_bf16 v[56:59], a[132:135], a[92:95], v[56:59]
v_mfma_f32_16x16x32_bf16 v[64:67], a[128:131], a[96:99], v[64:67]
ds_read_b128 a[0:3], v2 offset:0
v_mfma_f32_16x16x32_bf16 v[64:67], a[132:135], a[100:103], v[64:67]
buffer_load_dwordx4 v18, s[12:15], s27 offen offset:2048 lds
v_mfma_f32_16x16x32_bf16 v[72:75], a[128:131], a[104:107], v[72:75]
ds_read_b128 a[4:7], v3 offset:0
v_mfma_f32_16x16x32_bf16 v[72:75], a[132:135], a[108:111], v[72:75]
v_mfma_f32_16x16x32_bf16 v[80:83], a[128:131], a[112:115], v[80:83]
v_mfma_f32_16x16x32_bf16 v[80:83], a[132:135], a[116:119], v[80:83]
buffer_load_dwordx4 v19, s[12:15], s27 offen offset:3072 lds
v_mfma_f32_16x16x32_bf16 v[88:91], a[128:131], a[120:123], v[88:91]
s_add_u32 s27, s27, 524288
ds_read_b128 a[8:11], v2 offset:2048
v_mfma_f32_16x16x32_bf16 v[88:91], a[132:135], a[124:127], v[88:91]
s_waitcnt lgkmcnt(3)
v_mfma_f32_16x16x32_bf16 v[36:39], a[136:139], a[64:67], v[36:39]
s_add_u32 m0, s28, 32768
ds_read_b64_tr_b16 a[128:129], v6 offset:32768
v_mfma_f32_16x16x32_bf16 v[36:39], a[140:143], a[68:71], v[36:39]
buffer_load_dwordx4 v12, s[8:11], s24 offen offset:0 lds
v_mfma_f32_16x16x32_bf16 v[44:47], a[136:139], a[72:75], v[44:47]
ds_read_b64_tr_b16 a[130:131], v6 offset:34816
v_mfma_f32_16x16x32_bf16 v[44:47], a[140:143], a[76:79], v[44:47]
v_mfma_f32_16x16x32_bf16 v[52:55], a[136:139], a[80:83], v[52:55]
s_mov_b64 s[56:57], s[72:73]
ds_read_b64_tr_b16 a[132:133], v6 offset:49152
v_mfma_f32_16x16x32_bf16 v[52:55], a[140:143], a[84:87], v[52:55]
s_mov_b32 s58, 1835008
buffer_load_dwordx4 v13, s[8:11], s24 offen offset:1024 lds
v_mfma_f32_16x16x32_bf16 v[60:63], a[136:139], a[88:91], v[60:63]
s_mov_b32 s59, 0x20000
ds_read_b64_tr_b16 a[134:135], v6 offset:51200
v_mfma_f32_16x16x32_bf16 v[60:63], a[140:143], a[92:95], v[60:63]
v_mfma_f32_16x16x32_bf16 v[68:71], a[136:139], a[96:99], v[68:71]
ds_read_b128 a[12:15], v3 offset:2048
v_mfma_f32_16x16x32_bf16 v[68:71], a[140:143], a[100:103], v[68:71]
buffer_load_dwordx4 v14, s[8:11], s24 offen offset:2048 lds
v_mfma_f32_16x16x32_bf16 v[76:79], a[136:139], a[104:107], v[76:79]
v_mfma_f32_16x16x32_bf16 v[76:79], a[140:143], a[108:111], v[76:79]
v_mfma_f32_16x16x32_bf16 v[84:87], a[136:139], a[112:115], v[84:87]
ds_read_b128 a[16:19], v2 offset:4096
v_mfma_f32_16x16x32_bf16 v[84:87], a[140:143], a[116:119], v[84:87]
buffer_load_dwordx4 v15, s[8:11], s24 offen offset:3072 lds
v_mfma_f32_16x16x32_bf16 v[92:95], a[136:139], a[120:123], v[92:95]
s_add_u32 s24, s24, 128
ds_read_b128 a[20:23], v3 offset:4096
v_mfma_f32_16x16x32_bf16 v[92:95], a[140:143], a[124:127], v[92:95]
s_waitcnt lgkmcnt(3)
v_mfma_f32_16x16x32_bf16 v[96:99], a[128:131], a[64:67], v[96:99]
s_add_u32 m0, s28, 36864
ds_read_b64_tr_b16 a[136:137], v7 offset:32768
v_mfma_f32_16x16x32_bf16 v[96:99], a[132:135], a[68:71], v[96:99]
buffer_load_dwordx4 v12, s[8:11], s25 offen offset:0 lds
v_mfma_f32_16x16x32_bf16 v[104:107], a[128:131], a[72:75], v[104:107]
ds_read_b64_tr_b16 a[138:139], v7 offset:34816
v_mfma_f32_16x16x32_bf16 v[104:107], a[132:135], a[76:79], v[104:107]
v_mfma_f32_16x16x32_bf16 v[112:115], a[128:131], a[80:83], v[112:115]
ds_read_b64_tr_b16 a[140:141], v7 offset:49152
v_mfma_f32_16x16x32_bf16 v[112:115], a[132:135], a[84:87], v[112:115]
buffer_load_dwordx4 v13, s[8:11], s25 offen offset:1024 lds
v_mfma_f32_16x16x32_bf16 v[120:123], a[128:131], a[88:91], v[120:123]
ds_read_b64_tr_b16 a[142:143], v7 offset:51200
v_mfma_f32_16x16x32_bf16 v[120:123], a[132:135], a[92:95], v[120:123]
v_mfma_f32_16x16x32_bf16 v[128:131], a[128:131], a[96:99], v[128:131]
v_mfma_f32_16x16x32_bf16 v[128:131], a[132:135], a[100:103], v[128:131]
buffer_load_dwordx4 v14, s[8:11], s25 offen offset:2048 lds
v_mfma_f32_16x16x32_bf16 v[136:139], a[128:131], a[104:107], v[136:139]
ds_read_b128 a[24:27], v2 offset:6144
v_mfma_f32_16x16x32_bf16 v[136:139], a[132:135], a[108:111], v[136:139]
v_mfma_f32_16x16x32_bf16 v[144:147], a[128:131], a[112:115], v[144:147]
ds_read_b128 a[28:31], v3 offset:6144
v_mfma_f32_16x16x32_bf16 v[144:147], a[132:135], a[116:119], v[144:147]
buffer_load_dwordx4 v15, s[8:11], s25 offen offset:3072 lds
v_mfma_f32_16x16x32_bf16 v[152:155], a[128:131], a[120:123], v[152:155]
s_add_u32 s25, s25, 128
v_mfma_f32_16x16x32_bf16 v[152:155], a[132:135], a[124:127], v[152:155]
s_waitcnt lgkmcnt(2)
v_mfma_f32_16x16x32_bf16 v[100:103], a[136:139], a[64:67], v[100:103]
ds_read_b64_tr_b16 a[128:129], v8 offset:32768
v_mfma_f32_16x16x32_bf16 v[100:103], a[140:143], a[68:71], v[100:103]
v_mfma_f32_16x16x32_bf16 v[108:111], a[136:139], a[72:75], v[108:111]
s_mov_b64 s[8:9], s[76:77]
ds_read_b64_tr_b16 a[130:131], v8 offset:34816
v_mfma_f32_16x16x32_bf16 v[108:111], a[140:143], a[76:79], v[108:111]
s_mov_b32 s10, 1835008
v_mfma_f32_16x16x32_bf16 v[116:119], a[136:139], a[80:83], v[116:119]
s_lshl_b32 s24, s37, 2
ds_read_b64_tr_b16 a[132:133], v8 offset:49152
v_mfma_f32_16x16x32_bf16 v[116:119], a[140:143], a[84:87], v[116:119]
s_add_u32 s24, s24, s3
v_mfma_f32_16x16x32_bf16 v[124:127], a[136:139], a[88:91], v[124:127]
s_mul_i32 s24, s24, 28672
ds_read_b64_tr_b16 a[134:135], v8 offset:51200
v_mfma_f32_16x16x32_bf16 v[124:127], a[140:143], a[92:95], v[124:127]
s_mov_b32 s28, s29
v_mfma_f32_16x16x32_bf16 v[132:135], a[136:139], a[96:99], v[132:135]
ds_read_b128 a[32:35], v2 offset:8192
v_mfma_f32_16x16x32_bf16 v[132:135], a[140:143], a[100:103], v[132:135]
v_mfma_f32_16x16x32_bf16 v[140:143], a[136:139], a[104:107], v[140:143]
v_mfma_f32_16x16x32_bf16 v[140:143], a[140:143], a[108:111], v[140:143]
v_mfma_f32_16x16x32_bf16 v[148:151], a[136:139], a[112:115], v[148:151]
ds_read_b128 a[36:39], v3 offset:8192
v_lshrrev_b32 v28, 7, v1
v_mfma_f32_16x16x32_bf16 v[148:151], a[140:143], a[116:119], v[148:151]
v_lshrrev_b32 v29, 1, v28
v_lshlrev_b32 v29, 4, v29
v_mfma_f32_16x16x32_bf16 v[156:159], a[136:139], a[120:123], v[156:159]
ds_read_b128 a[40:43], v2 offset:10240
v_and_b32 v30, 0x70, v1
v_mfma_f32_16x16x32_bf16 v[156:159], a[140:143], a[124:127], v[156:159]
s_waitcnt lgkmcnt(3)
v_xor_b32 v29, v29, v30
v_mul_u32_u24 v28, 896, v28
v_mfma_f32_16x16x32_bf16 v[160:163], a[128:131], a[64:67], v[160:163]
ds_read_b64_tr_b16 a[136:137], v9 offset:32768
v_add_u32 v12, v28, v29
v_mfma_f32_16x16x32_bf16 v[160:163], a[132:135], a[68:71], v[160:163]
v_xor_b32 v29, 64, v29
v_add_u32 v28, v28, v29
v_mfma_f32_16x16x32_bf16 v[168:171], a[128:131], a[72:75], v[168:171]
ds_read_b64_tr_b16 a[138:139], v9 offset:34816
v_add_u32 v13, 6144, v28
v_mfma_f32_16x16x32_bf16 v[168:171], a[132:135], a[76:79], v[168:171]
v_add_u32 v14, 12288, v12
v_add_u32 v15, 18432, v28
v_mfma_f32_16x16x32_bf16 v[176:179], a[128:131], a[80:83], v[176:179]
ds_read_b64_tr_b16 a[140:141], v9 offset:49152
v_xor_b32 v22, s44, v4
v_mfma_f32_16x16x32_bf16 v[176:179], a[132:135], a[84:87], v[176:179]
v_xor_b32 v23, 32, v22
v_xor_b32 v24, 64, v22
v_mfma_f32_16x16x32_bf16 v[184:187], a[128:131], a[88:91], v[184:187]
ds_read_b64_tr_b16 a[142:143], v9 offset:51200
v_xor_b32 v25, 96, v22
v_mfma_f32_16x16x32_bf16 v[184:187], a[132:135], a[92:95], v[184:187]
v_mfma_f32_16x16x32_bf16 v[192:195], a[128:131], a[96:99], v[192:195]
v_mfma_f32_16x16x32_bf16 v[192:195], a[132:135], a[100:103], v[192:195]
v_mfma_f32_16x16x32_bf16 v[200:203], a[128:131], a[104:107], v[200:203]
ds_read_b128 a[44:47], v3 offset:10240
v_mfma_f32_16x16x32_bf16 v[200:203], a[132:135], a[108:111], v[200:203]
v_mfma_f32_16x16x32_bf16 v[208:211], a[128:131], a[112:115], v[208:211]
ds_read_b128 a[48:51], v2 offset:12288
v_mfma_f32_16x16x32_bf16 v[208:211], a[132:135], a[116:119], v[208:211]
v_mfma_f32_16x16x32_bf16 v[216:219], a[128:131], a[120:123], v[216:219]
v_mfma_f32_16x16x32_bf16 v[216:219], a[132:135], a[124:127], v[216:219]
s_waitcnt lgkmcnt(2)
v_mfma_f32_16x16x32_bf16 v[164:167], a[136:139], a[64:67], v[164:167]
ds_read_b64_tr_b16 a[128:129], v10 offset:32768
v_mfma_f32_16x16x32_bf16 v[164:167], a[140:143], a[68:71], v[164:167]
v_mfma_f32_16x16x32_bf16 v[172:175], a[136:139], a[72:75], v[172:175]
ds_read_b64_tr_b16 a[130:131], v10 offset:34816
v_mfma_f32_16x16x32_bf16 v[172:175], a[140:143], a[76:79], v[172:175]
v_mfma_f32_16x16x32_bf16 v[180:183], a[136:139], a[80:83], v[180:183]
ds_read_b64_tr_b16 a[132:133], v10 offset:49152
v_mfma_f32_16x16x32_bf16 v[180:183], a[140:143], a[84:87], v[180:183]
v_mfma_f32_16x16x32_bf16 v[188:191], a[136:139], a[88:91], v[188:191]
ds_read_b64_tr_b16 a[134:135], v10 offset:51200
v_mfma_f32_16x16x32_bf16 v[188:191], a[140:143], a[92:95], v[188:191]
v_mfma_f32_16x16x32_bf16 v[196:199], a[136:139], a[96:99], v[196:199]
ds_read_b128 a[52:55], v3 offset:12288
v_mfma_f32_16x16x32_bf16 v[196:199], a[140:143], a[100:103], v[196:199]
v_mfma_f32_16x16x32_bf16 v[204:207], a[136:139], a[104:107], v[204:207]
ds_read_b128 a[56:59], v2 offset:14336
v_mfma_f32_16x16x32_bf16 v[204:207], a[140:143], a[108:111], v[204:207]
v_mfma_f32_16x16x32_bf16 v[212:215], a[136:139], a[112:115], v[212:215]
v_mfma_f32_16x16x32_bf16 v[212:215], a[140:143], a[116:119], v[212:215]
v_mfma_f32_16x16x32_bf16 v[220:223], a[136:139], a[120:123], v[220:223]
ds_read_b128 a[60:63], v3 offset:14336
v_mfma_f32_16x16x32_bf16 v[220:223], a[140:143], a[124:127], v[220:223]
s_waitcnt lgkmcnt(3)
v_mfma_f32_16x16x32_bf16 a[192:195], a[128:131], a[64:67], a[192:195]
ds_read_b64_tr_b16 a[136:137], v11 offset:32768
v_mfma_f32_16x16x32_bf16 a[192:195], a[132:135], a[68:71], a[192:195]
v_mfma_f32_16x16x32_bf16 a[200:203], a[128:131], a[72:75], a[200:203]
ds_read_b64_tr_b16 a[138:139], v11 offset:34816
v_mfma_f32_16x16x32_bf16 a[200:203], a[132:135], a[76:79], a[200:203]
v_mfma_f32_16x16x32_bf16 a[208:211], a[128:131], a[80:83], a[208:211]
ds_read_b64_tr_b16 a[140:141], v11 offset:49152
v_mfma_f32_16x16x32_bf16 a[208:211], a[132:135], a[84:87], a[208:211]
v_mfma_f32_16x16x32_bf16 a[216:219], a[128:131], a[88:91], a[216:219]
ds_read_b64_tr_b16 a[142:143], v11 offset:51200
v_mfma_f32_16x16x32_bf16 a[216:219], a[132:135], a[92:95], a[216:219]
v_mfma_f32_16x16x32_bf16 a[224:227], a[128:131], a[96:99], a[224:227]
v_mfma_f32_16x16x32_bf16 a[224:227], a[132:135], a[100:103], a[224:227]
v_mfma_f32_16x16x32_bf16 a[232:235], a[128:131], a[104:107], a[232:235]
v_mfma_f32_16x16x32_bf16 a[232:235], a[132:135], a[108:111], a[232:235]
v_mfma_f32_16x16x32_bf16 a[240:243], a[128:131], a[112:115], a[240:243]
v_mfma_f32_16x16x32_bf16 a[240:243], a[132:135], a[116:119], a[240:243]
v_mfma_f32_16x16x32_bf16 a[248:251], a[128:131], a[120:123], a[248:251]
s_waitcnt vmcnt(0) lgkmcnt(0)
v_mfma_f32_16x16x32_bf16 a[248:251], a[132:135], a[124:127], a[248:251]
s_barrier
v_mfma_f32_16x16x32_bf16 a[196:199], a[136:139], a[64:67], a[196:199]
s_add_u32 m0, s29, 98304
ds_read_b64_tr_b16 a[128:129], v4 offset:0
v_mfma_f32_16x16x32_bf16 a[196:199], a[140:143], a[68:71], a[196:199]
buffer_load_dwordx4 v16, s[12:15], s26 offen offset:0 lds
v_mfma_f32_16x16x32_bf16 a[204:207], a[136:139], a[72:75], a[204:207]
ds_read_b64_tr_b16 a[130:131], v4 offset:2048
v_mfma_f32_16x16x32_bf16 a[204:207], a[140:143], a[76:79], a[204:207]
v_mfma_f32_16x16x32_bf16 a[212:215], a[136:139], a[80:83], a[212:215]
ds_read_b64_tr_b16 a[132:133], v4 offset:16384
v_mfma_f32_16x16x32_bf16 a[212:215], a[140:143], a[84:87], a[212:215]
buffer_load_dwordx4 v17, s[12:15], s26 offen offset:1024 lds
v_mfma_f32_16x16x32_bf16 a[220:223], a[136:139], a[88:91], a[220:223]
ds_read_b64_tr_b16 a[134:135], v4 offset:18432
v_mfma_f32_16x16x32_bf16 a[220:223], a[140:143], a[92:95], a[220:223]
v_mfma_f32_16x16x32_bf16 a[228:231], a[136:139], a[96:99], a[228:231]
v_mfma_f32_16x16x32_bf16 a[228:231], a[140:143], a[100:103], a[228:231]
buffer_load_dwordx4 v18, s[12:15], s26 offen offset:2048 lds
v_mfma_f32_16x16x32_bf16 a[236:239], a[136:139], a[104:107], a[236:239]
v_mfma_f32_16x16x32_bf16 a[236:239], a[140:143], a[108:111], a[236:239]
v_mfma_f32_16x16x32_bf16 a[244:247], a[136:139], a[112:115], a[244:247]
v_mfma_f32_16x16x32_bf16 a[244:247], a[140:143], a[116:119], a[244:247]
buffer_load_dwordx4 v19, s[12:15], s26 offen offset:3072 lds
v_mfma_f32_16x16x32_bf16 a[252:255], a[136:139], a[120:123], a[252:255]
s_add_u32 s26, s26, 524288
v_mfma_f32_16x16x32_bf16 a[252:255], a[140:143], a[124:127], a[252:255]
s_waitcnt lgkmcnt(0)
v_mfma_f32_16x16x32_bf16 v[32:35], a[128:131], a[0:3], v[32:35]
s_add_u32 m0, s29, 114688
ds_read_b64_tr_b16 a[136:137], v5 offset:0
v_mfma_f32_16x16x32_bf16 v[32:35], a[132:135], a[4:7], v[32:35]
buffer_load_dwordx4 v16, s[12:15], s27 offen offset:0 lds
v_mfma_f32_16x16x32_bf16 v[40:43], a[128:131], a[8:11], v[40:43]
ds_read_b64_tr_b16 a[138:139], v5 offset:2048
v_mfma_f32_16x16x32_bf16 v[40:43], a[132:135], a[12:15], v[40:43]
v_mfma_f32_16x16x32_bf16 v[48:51], a[128:131], a[16:19], v[48:51]
ds_read_b64_tr_b16 a[140:141], v5 offset:16384
v_mfma_f32_16x16x32_bf16 v[48:51], a[132:135], a[20:23], v[48:51]
buffer_load_dwordx4 v17, s[12:15], s27 offen offset:1024 lds
v_mfma_f32_16x16x32_bf16 v[56:59], a[128:131], a[24:27], v[56:59]
ds_read_b64_tr_b16 a[142:143], v5 offset:18432
v_mfma_f32_16x16x32_bf16 v[56:59], a[132:135], a[28:31], v[56:59]
v_mfma_f32_16x16x32_bf16 v[64:67], a[128:131], a[32:35], v[64:67]
ds_read_b128 a[64:67], v2 offset:32768
v_mfma_f32_16x16x32_bf16 v[64:67], a[132:135], a[36:39], v[64:67]
buffer_load_dwordx4 v18, s[12:15], s27 offen offset:2048 lds
v_mfma_f32_16x16x32_bf16 v[72:75], a[128:131], a[40:43], v[72:75]
ds_read_b128 a[68:71], v3 offset:32768
v_mfma_f32_16x16x32_bf16 v[72:75], a[132:135], a[44:47], v[72:75]
v_mfma_f32_16x16x32_bf16 v[80:83], a[128:131], a[48:51], v[80:83]
v_mfma_f32_16x16x32_bf16 v[80:83], a[132:135], a[52:55], v[80:83]
buffer_load_dwordx4 v19, s[12:15], s27 offen offset:3072 lds
v_mfma_f32_16x16x32_bf16 v[88:91], a[128:131], a[56:59], v[88:91]
s_add_u32 s27, s27, 524288
ds_read_b128 a[72:75], v2 offset:34816
v_mfma_f32_16x16x32_bf16 v[88:91], a[132:135], a[60:63], v[88:91]
s_waitcnt lgkmcnt(3)
v_mfma_f32_16x16x32_bf16 v[36:39], a[136:139], a[0:3], v[36:39]
s_add_u32 m0, s28, 0
ds_read_b64_tr_b16 a[128:129], v6 offset:0
v_mfma_f32_16x16x32_bf16 v[36:39], a[140:143], a[4:7], v[36:39]
buffer_load_dwordx4 v12, s[8:11], s24 offen offset:0 lds
v_mfma_f32_16x16x32_bf16 v[44:47], a[136:139], a[8:11], v[44:47]
ds_read_b64_tr_b16 a[130:131], v6 offset:2048
v_mfma_f32_16x16x32_bf16 v[44:47], a[140:143], a[12:15], v[44:47]
v_mfma_f32_16x16x32_bf16 v[52:55], a[136:139], a[16:19], v[52:55]
ds_read_b64_tr_b16 a[132:133], v6 offset:16384
v_mfma_f32_16x16x32_bf16 v[52:55], a[140:143], a[20:23], v[52:55]
buffer_load_dwordx4 v13, s[8:11], s24 offen offset:1024 lds
v_mfma_f32_16x16x32_bf16 v[60:63], a[136:139], a[24:27], v[60:63]
ds_read_b64_tr_b16 a[134:135], v6 offset:18432
v_mfma_f32_16x16x32_bf16 v[60:63], a[140:143], a[28:31], v[60:63]
v_mfma_f32_16x16x32_bf16 v[68:71], a[136:139], a[32:35], v[68:71]
ds_read_b128 a[76:79], v3 offset:34816
v_mfma_f32_16x16x32_bf16 v[68:71], a[140:143], a[36:39], v[68:71]
buffer_load_dwordx4 v14, s[8:11], s24 offen offset:2048 lds
v_mfma_f32_16x16x32_bf16 v[76:79], a[136:139], a[40:43], v[76:79]
v_mfma_f32_16x16x32_bf16 v[76:79], a[140:143], a[44:47], v[76:79]
v_mfma_f32_16x16x32_bf16 v[84:87], a[136:139], a[48:51], v[84:87]
ds_read_b128 a[80:83], v2 offset:36864
v_mfma_f32_16x16x32_bf16 v[84:87], a[140:143], a[52:55], v[84:87]
buffer_load_dwordx4 v15, s[8:11], s24 offen offset:3072 lds
v_mfma_f32_16x16x32_bf16 v[92:95], a[136:139], a[56:59], v[92:95]
s_add_u32 s24, s24, 128
ds_read_b128 a[84:87], v3 offset:36864
v_mfma_f32_16x16x32_bf16 v[92:95], a[140:143], a[60:63], v[92:95]
s_waitcnt lgkmcnt(3)
s_mov_b64 s[12:13], s[80:81]
v_mfma_f32_16x16x32_bf16 v[96:99], a[128:131], a[0:3], v[96:99]
s_mov_b32 s14, 3670016
s_add_u32 m0, s28, 16384
ds_read_b64_tr_b16 a[136:137], v7 offset:0
v_mfma_f32_16x16x32_bf16 v[96:99], a[132:135], a[4:7], v[96:99]
buffer_load_dwordx4 v12, s[8:11], s24 offen offset:0 lds
v_mfma_f32_16x16x32_bf16 v[104:107], a[128:131], a[8:11], v[104:107]
ds_read_b64_tr_b16 a[138:139], v7 offset:2048
v_mfma_f32_16x16x32_bf16 v[104:107], a[132:135], a[12:15], v[104:107]
v_mfma_f32_16x16x32_bf16 v[112:115], a[128:131], a[16:19], v[112:115]
ds_read_b64_tr_b16 a[140:141], v7 offset:16384
v_mfma_f32_16x16x32_bf16 v[112:115], a[132:135], a[20:23], v[112:115]
buffer_load_dwordx4 v13, s[8:11], s24 offen offset:1024 lds
v_mfma_f32_16x16x32_bf16 v[120:123], a[128:131], a[24:27], v[120:123]
ds_read_b64_tr_b16 a[142:143], v7 offset:18432
v_mfma_f32_16x16x32_bf16 v[120:123], a[132:135], a[28:31], v[120:123]
v_mfma_f32_16x16x32_bf16 v[128:131], a[128:131], a[32:35], v[128:131]
v_mfma_f32_16x16x32_bf16 v[128:131], a[132:135], a[36:39], v[128:131]
buffer_load_dwordx4 v14, s[8:11], s24 offen offset:2048 lds
v_mfma_f32_16x16x32_bf16 v[136:139], a[128:131], a[40:43], v[136:139]
ds_read_b128 a[88:91], v2 offset:38912
v_mfma_f32_16x16x32_bf16 v[136:139], a[132:135], a[44:47], v[136:139]
v_mfma_f32_16x16x32_bf16 v[144:147], a[128:131], a[48:51], v[144:147]
ds_read_b128 a[92:95], v3 offset:38912
v_mfma_f32_16x16x32_bf16 v[144:147], a[132:135], a[52:55], v[144:147]
buffer_load_dwordx4 v15, s[8:11], s24 offen offset:3072 lds
v_mfma_f32_16x16x32_bf16 v[152:155], a[128:131], a[56:59], v[152:155]
s_add_u32 s24, s24, 128
v_mfma_f32_16x16x32_bf16 v[152:155], a[132:135], a[60:63], v[152:155]
s_waitcnt lgkmcnt(2)
s_sub_u32 s26, s26, 8388608
v_mfma_f32_16x16x32_bf16 v[100:103], a[136:139], a[0:3], v[100:103]
s_sub_u32 s27, s27, 8388608
s_add_u32 m0, s29, 131072
ds_read_b64_tr_b16 a[128:129], v8 offset:0
v_mfma_f32_16x16x32_bf16 v[100:103], a[140:143], a[4:7], v[100:103]
buffer_load_dwordx4 v16, s[12:15], s26 offen offset:0 lds
v_mfma_f32_16x16x32_bf16 v[108:111], a[136:139], a[8:11], v[108:111]
ds_read_b64_tr_b16 a[130:131], v8 offset:2048
v_mfma_f32_16x16x32_bf16 v[108:111], a[140:143], a[12:15], v[108:111]
PAD_5:
s_cbranch_execz M_tret
v_mfma_f32_16x16x32_bf16 v[116:119], a[136:139], a[16:19], v[116:119]
ds_read_b64_tr_b16 a[132:133], v8 offset:16384
v_mfma_f32_16x16x32_bf16 v[116:119], a[140:143], a[20:23], v[116:119]
buffer_load_dwordx4 v17, s[12:15], s26 offen offset:1024 lds
v_mfma_f32_16x16x32_bf16 v[124:127], a[136:139], a[24:27], v[124:127]
ds_read_b64_tr_b16 a[134:135], v8 offset:18432
v_mfma_f32_16x16x32_bf16 v[124:127], a[140:143], a[28:31], v[124:127]
v_mfma_f32_16x16x32_bf16 v[132:135], a[136:139], a[32:35], v[132:135]
ds_read_b128 a[96:99], v2 offset:40960
v_mfma_f32_16x16x32_bf16 v[132:135], a[140:143], a[36:39], v[132:135]
buffer_load_dwordx4 v18, s[12:15], s26 offen offset:2048 lds
v_mfma_f32_16x16x32_bf16 v[140:143], a[136:139], a[40:43], v[140:143]
v_mfma_f32_16x16x32_bf16 v[140:143], a[140:143], a[44:47], v[140:143]
v_mfma_f32_16x16x32_bf16 v[148:151], a[136:139], a[48:51], v[148:151]
ds_read_b128 a[100:103], v3 offset:40960
v_mfma_f32_16x16x32_bf16 v[148:151], a[140:143], a[52:55], v[148:151]
buffer_load_dwordx4 v19, s[12:15], s26 offen offset:3072 lds
v_mfma_f32_16x16x32_bf16 v[156:159], a[136:139], a[56:59], v[156:159]
s_add_u32 s26, s26, 524288
ds_read_b128 a[104:107], v2 offset:43008
v_mfma_f32_16x16x32_bf16 v[156:159], a[140:143], a[60:63], v[156:159]
s_waitcnt lgkmcnt(3)
v_mfma_f32_16x16x32_bf16 v[160:163], a[128:131], a[0:3], v[160:163]
s_add_u32 m0, s29, 147456
ds_read_b64_tr_b16 a[136:137], v9 offset:0
v_mfma_f32_16x16x32_bf16 v[160:163], a[132:135], a[4:7], v[160:163]
buffer_load_dwordx4 v16, s[12:15], s27 offen offset:0 lds
v_mfma_f32_16x16x32_bf16 v[168:171], a[128:131], a[8:11], v[168:171]
ds_read_b64_tr_b16 a[138:139], v9 offset:2048
v_mfma_f32_16x16x32_bf16 v[168:171], a[132:135], a[12:15], v[168:171]
v_mfma_f32_16x16x32_bf16 v[176:179], a[128:131], a[16:19], v[176:179]
ds_read_b64_tr_b16 a[140:141], v9 offset:16384
v_mfma_f32_16x16x32_bf16 v[176:179], a[132:135], a[20:23], v[176:179]
buffer_load_dwordx4 v17, s[12:15], s27 offen offset:1024 lds
v_mfma_f32_16x16x32_bf16 v[184:187], a[128:131], a[24:27], v[184:187]
ds_read_b64_tr_b16 a[142:143], v9 offset:18432
v_mfma_f32_16x16x32_bf16 v[184:187], a[132:135], a[28:31], v[184:187]
v_mfma_f32_16x16x32_bf16 v[192:195], a[128:131], a[32:35], v[192:195]
v_mfma_f32_16x16x32_bf16 v[192:195], a[132:135], a[36:39], v[192:195]
buffer_load_dwordx4 v18, s[12:15], s27 offen offset:2048 lds
v_mfma_f32_16x16x32_bf16 v[200:203], a[128:131], a[40:43], v[200:203]
ds_read_b128 a[108:111], v3 offset:43008
v_mfma_f32_16x16x32_bf16 v[200:203], a[132:135], a[44:47], v[200:203]
v_mfma_f32_16x16x32_bf16 v[208:211], a[128:131], a[48:51], v[208:211]
ds_read_b128 a[112:115], v2 offset:45056
v_mfma_f32_16x16x32_bf16 v[208:211], a[132:135], a[52:55], v[208:211]
buffer_load_dwordx4 v19, s[12:15], s27 offen offset:3072 lds
v_mfma_f32_16x16x32_bf16 v[216:219], a[128:131], a[56:59], v[216:219]
s_add_u32 s27, s27, 524288
v_mfma_f32_16x16x32_bf16 v[216:219], a[132:135], a[60:63], v[216:219]
s_waitcnt lgkmcnt(2)
v_mfma_f32_16x16x32_bf16 v[164:167], a[136:139], a[0:3], v[164:167]
ds_read_b64_tr_b16 a[128:129], v10 offset:0
v_mfma_f32_16x16x32_bf16 v[164:167], a[140:143], a[4:7], v[164:167]
v_mfma_f32_16x16x32_bf16 v[172:175], a[136:139], a[8:11], v[172:175]
ds_read_b64_tr_b16 a[130:131], v10 offset:2048
v_mfma_f32_16x16x32_bf16 v[172:175], a[140:143], a[12:15], v[172:175]
v_mfma_f32_16x16x32_bf16 v[180:183], a[136:139], a[16:19], v[180:183]
ds_read_b64_tr_b16 a[132:133], v10 offset:16384
v_mfma_f32_16x16x32_bf16 v[180:183], a[140:143], a[20:23], v[180:183]
v_mfma_f32_16x16x32_bf16 v[188:191], a[136:139], a[24:27], v[188:191]
ds_read_b64_tr_b16 a[134:135], v10 offset:18432
v_mfma_f32_16x16x32_bf16 v[188:191], a[140:143], a[28:31], v[188:191]
v_mfma_f32_16x16x32_bf16 v[196:199], a[136:139], a[32:35], v[196:199]
ds_read_b128 a[116:119], v3 offset:45056
v_mfma_f32_16x16x32_bf16 v[196:199], a[140:143], a[36:39], v[196:199]
v_mfma_f32_16x16x32_bf16 v[204:207], a[136:139], a[40:43], v[204:207]
ds_read_b128 a[120:123], v2 offset:47104
v_mfma_f32_16x16x32_bf16 v[204:207], a[140:143], a[44:47], v[204:207]
v_mfma_f32_16x16x32_bf16 v[212:215], a[136:139], a[48:51], v[212:215]
v_mfma_f32_16x16x32_bf16 v[212:215], a[140:143], a[52:55], v[212:215]
v_mfma_f32_16x16x32_bf16 v[220:223], a[136:139], a[56:59], v[220:223]
ds_read_b128 a[124:127], v3 offset:47104
v_mfma_f32_16x16x32_bf16 v[220:223], a[140:143], a[60:63], v[220:223]
s_waitcnt lgkmcnt(3)
v_mfma_f32_16x16x32_bf16 a[192:195], a[128:131], a[0:3], a[192:195]
ds_read_b64_tr_b16 a[136:137], v11 offset:0
v_mfma_f32_16x16x32_bf16 a[192:195], a[132:135], a[4:7], a[192:195]
v_mfma_f32_16x16x32_bf16 a[200:203], a[128:131], a[8:11], a[200:203]
ds_read_b64_tr_b16 a[138:139], v11 offset:2048
v_mfma_f32_16x16x32_bf16 a[200:203], a[132:135], a[12:15], a[200:203]
v_mfma_f32_16x16x32_bf16 a[208:211], a[128:131], a[16:19], a[208:211]
ds_read_b64_tr_b16 a[140:141], v11 offset:16384
v_mfma_f32_16x16x32_bf16 a[208:211], a[132:135], a[20:23], a[208:211]
v_mfma_f32_16x16x32_bf16 a[216:219], a[128:131], a[24:27], a[216:219]
ds_read_b64_tr_b16 a[142:143], v11 offset:18432
v_mfma_f32_16x16x32_bf16 a[216:219], a[132:135], a[28:31], a[216:219]
v_mfma_f32_16x16x32_bf16 a[224:227], a[128:131], a[32:35], a[224:227]
v_mfma_f32_16x16x32_bf16 a[224:227], a[132:135], a[36:39], a[224:227]
v_mfma_f32_16x16x32_bf16 a[232:235], a[128:131], a[40:43], a[232:235]
v_mfma_f32_16x16x32_bf16 a[232:235], a[132:135], a[44:47], a[232:235]
v_mfma_f32_16x16x32_bf16 a[240:243], a[128:131], a[48:51], a[240:243]
v_mfma_f32_16x16x32_bf16 a[240:243], a[132:135], a[52:55], a[240:243]
v_mfma_f32_16x16x32_bf16 a[248:251], a[128:131], a[56:59], a[248:251]
s_waitcnt vmcnt(12) lgkmcnt(0)
v_mfma_f32_16x16x32_bf16 a[248:251], a[132:135], a[60:63], a[248:251]
s_barrier
v_mfma_f32_16x16x32_bf16 a[196:199], a[136:139], a[0:3], a[196:199]
s_add_u32 m0, s28, 32768
ds_read_b64_tr_b16 a[128:129], v4 offset:32768
v_mfma_f32_16x16x32_bf16 a[196:199], a[140:143], a[4:7], a[196:199]
s_lshr_b32 s22, s3, 1
buffer_load_dwordx4 v12, s[8:11], s24 offen offset:0 lds
v_mfma_f32_16x16x32_bf16 a[204:207], a[136:139], a[8:11], a[204:207]
s_lshl_b32 s22, s22, 14
ds_read_b64_tr_b16 a[130:131], v4 offset:34816
v_subrev_u32 v2, s22, v2
v_mfma_f32_16x16x32_bf16 a[204:207], a[140:143], a[12:15], a[204:207]
v_subrev_u32 v3, s22, v3
v_mfma_f32_16x16x32_bf16 a[212:215], a[136:139], a[16:19], a[212:215]
ds_read_b64_tr_b16 a[132:133], v4 offset:49152
v_mfma_f32_16x16x32_bf16 a[212:215], a[140:143], a[20:23], a[212:215]
buffer_load_dwordx4 v13, s[8:11], s24 offen offset:1024 lds
v_mfma_f32_16x16x32_bf16 a[220:223], a[136:139], a[24:27], a[220:223]
ds_read_b64_tr_b16 a[134:135], v4 offset:51200
v_mfma_f32_16x16x32_bf16 a[220:223], a[140:143], a[28:31], a[220:223]
v_mfma_f32_16x16x32_bf16 a[228:231], a[136:139], a[32:35], a[228:231]
v_mfma_f32_16x16x32_bf16 a[228:231], a[140:143], a[36:39], a[228:231]
buffer_load_dwordx4 v14, s[8:11], s24 offen offset:2048 lds
v_mfma_f32_16x16x32_bf16 a[236:239], a[136:139], a[40:43], a[236:239]
v_mfma_f32_16x16x32_bf16 a[236:239], a[140:143], a[44:47], a[236:239]
v_mfma_f32_16x16x32_bf16 a[244:247], a[136:139], a[48:51], a[244:247]
v_mfma_f32_16x16x32_bf16 a[244:247], a[140:143], a[52:55], a[244:247]
buffer_load_dwordx4 v15, s[8:11], s24 offen offset:3072 lds
v_mfma_f32_16x16x32_bf16 a[252:255], a[136:139], a[56:59], a[252:255]
s_add_u32 s24, s24, 128
v_mfma_f32_16x16x32_bf16 a[252:255], a[140:143], a[60:63], a[252:255]
s_waitcnt lgkmcnt(0)
v_mfma_f32_16x16x32_bf16 v[32:35], a[128:131], a[64:67], v[32:35]
s_add_u32 m0, s29, 65536
ds_read_b64_tr_b16 a[136:137], v5 offset:32768
v_mfma_f32_16x16x32_bf16 v[32:35], a[132:135], a[68:71], v[32:35]
buffer_load_dwordx4 v16, s[12:15], s26 offen offset:0 lds
v_mfma_f32_16x16x32_bf16 v[40:43], a[128:131], a[72:75], v[40:43]
ds_read_b64_tr_b16 a[138:139], v5 offset:34816
v_mfma_f32_16x16x32_bf16 v[40:43], a[132:135], a[76:79], v[40:43]
v_mfma_f32_16x16x32_bf16 v[48:51], a[128:131], a[80:83], v[48:51]
ds_read_b64_tr_b16 a[140:141], v5 offset:49152
v_mfma_f32_16x16x32_bf16 v[48:51], a[132:135], a[84:87], v[48:51]
buffer_load_dwordx4 v17, s[12:15], s26 offen offset:1024 lds
v_mfma_f32_16x16x32_bf16 v[56:59], a[128:131], a[88:91], v[56:59]
ds_read_b64_tr_b16 a[142:143], v5 offset:51200
v_mfma_f32_16x16x32_bf16 v[56:59], a[132:135], a[92:95], v[56:59]
v_mfma_f32_16x16x32_bf16 v[64:67], a[128:131], a[96:99], v[64:67]
ds_read_b128 a[0:3], v2 offset:0
v_mfma_f32_16x16x32_bf16 v[64:67], a[132:135], a[100:103], v[64:67]
buffer_load_dwordx4 v18, s[12:15], s26 offen offset:2048 lds
v_mfma_f32_16x16x32_bf16 v[72:75], a[128:131], a[104:107], v[72:75]
ds_read_b128 a[4:7], v3 offset:0
v_mfma_f32_16x16x32_bf16 v[72:75], a[132:135], a[108:111], v[72:75]
v_mfma_f32_16x16x32_bf16 v[80:83], a[128:131], a[112:115], v[80:83]
v_mfma_f32_16x16x32_bf16 v[80:83], a[132:135], a[116:119], v[80:83]
buffer_load_dwordx4 v19, s[12:15], s26 offen offset:3072 lds
v_mfma_f32_16x16x32_bf16 v[88:91], a[128:131], a[120:123], v[88:91]
s_add_u32 s26, s26, 524288
ds_read_b128 a[8:11], v2 offset:2048
v_mfma_f32_16x16x32_bf16 v[88:91], a[132:135], a[124:127], v[88:91]
s_waitcnt lgkmcnt(3)
v_mfma_f32_16x16x32_bf16 v[36:39], a[136:139], a[64:67], v[36:39]
s_add_u32 m0, s29, 81920
ds_read_b64_tr_b16 a[128:129], v6 offset:32768
v_mfma_f32_16x16x32_bf16 v[36:39], a[140:143], a[68:71], v[36:39]
buffer_load_dwordx4 v16, s[12:15], s27 offen offset:0 lds
v_mfma_f32_16x16x32_bf16 v[44:47], a[136:139], a[72:75], v[44:47]
ds_read_b64_tr_b16 a[130:131], v6 offset:34816
v_mfma_f32_16x16x32_bf16 v[44:47], a[140:143], a[76:79], v[44:47]
v_mfma_f32_16x16x32_bf16 v[52:55], a[136:139], a[80:83], v[52:55]
ds_read_b64_tr_b16 a[132:133], v6 offset:49152
v_mfma_f32_16x16x32_bf16 v[52:55], a[140:143], a[84:87], v[52:55]
buffer_load_dwordx4 v17, s[12:15], s27 offen offset:1024 lds
v_mfma_f32_16x16x32_bf16 v[60:63], a[136:139], a[88:91], v[60:63]
ds_read_b64_tr_b16 a[134:135], v6 offset:51200
v_cvt_pk_bf16_f32 v32, v32, v33
v_mfma_f32_16x16x32_bf16 v[60:63], a[140:143], a[92:95], v[60:63]
v_cvt_pk_bf16_f32 v33, v34, v35
v_cvt_pk_bf16_f32 v34, v36, v37
v_mfma_f32_16x16x32_bf16 v[68:71], a[136:139], a[96:99], v[68:71]
ds_read_b128 a[12:15], v3 offset:2048
v_cvt_pk_bf16_f32 v35, v38, v39
v_mfma_f32_16x16x32_bf16 v[68:71], a[140:143], a[100:103], v[68:71]
buffer_load_dwordx4 v18, s[12:15], s27 offen offset:2048 lds
v_mfma_f32_16x16x32_bf16 v[76:79], a[136:139], a[104:107], v[76:79]
v_cvt_pk_bf16_f32 v40, v40, v41
v_cvt_pk_bf16_f32 v41, v42, v43
v_mfma_f32_16x16x32_bf16 v[76:79], a[140:143], a[108:111], v[76:79]
v_cvt_pk_bf16_f32 v42, v44, v45
v_cvt_pk_bf16_f32 v43, v46, v47
v_mfma_f32_16x16x32_bf16 v[84:87], a[136:139], a[112:115], v[84:87]
ds_read_b128 a[16:19], v2 offset:4096
v_cvt_pk_bf16_f32 v48, v48, v49
v_mfma_f32_16x16x32_bf16 v[84:87], a[140:143], a[116:119], v[84:87]
buffer_load_dwordx4 v19, s[12:15], s27 offen offset:3072 lds
v_mfma_f32_16x16x32_bf16 v[92:95], a[136:139], a[120:123], v[92:95]
s_add_u32 s27, s27, 524288
ds_read_b128 a[20:23], v3 offset:4096
v_cvt_pk_bf16_f32 v49, v50, v51
v_mfma_f32_16x16x32_bf16 v[92:95], a[140:143], a[124:127], v[92:95]
s_waitcnt lgkmcnt(3)
v_cvt_pk_bf16_f32 v50, v52, v53
v_cvt_pk_bf16_f32 v51, v54, v55
v_mfma_f32_16x16x32_bf16 v[96:99], a[128:131], a[64:67], v[96:99]
s_add_u32 m0, s28, 49152
ds_read_b64_tr_b16 a[136:137], v7 offset:32768
v_cvt_pk_bf16_f32 v56, v56, v57
v_mfma_f32_16x16x32_bf16 v[96:99], a[132:135], a[68:71], v[96:99]
buffer_load_dwordx4 v12, s[8:11], s24 offen offset:0 lds
v_mfma_f32_16x16x32_bf16 v[104:107], a[128:131], a[72:75], v[104:107]
ds_read_b64_tr_b16 a[138:139], v7 offset:34816
v_cvt_pk_bf16_f32 v57, v58, v59
v_mfma_f32_16x16x32_bf16 v[104:107], a[132:135], a[76:79], v[104:107]
v_cvt_pk_bf16_f32 v58, v60, v61
v_cvt_pk_bf16_f32 v59, v62, v63
v_mfma_f32_16x16x32_bf16 v[112:115], a[128:131], a[80:83], v[112:115]
ds_read_b64_tr_b16 a[140:141], v7 offset:49152
v_cvt_pk_bf16_f32 v64, v64, v65
v_mfma_f32_16x16x32_bf16 v[112:115], a[132:135], a[84:87], v[112:115]
buffer_load_dwordx4 v13, s[8:11], s24 offen offset:1024 lds
v_mfma_f32_16x16x32_bf16 v[120:123], a[128:131], a[88:91], v[120:123]
ds_read_b64_tr_b16 a[142:143], v7 offset:51200
v_cvt_pk_bf16_f32 v65, v66, v67
v_mfma_f32_16x16x32_bf16 v[120:123], a[132:135], a[92:95], v[120:123]
v_cvt_pk_bf16_f32 v66, v68, v69
v_cvt_pk_bf16_f32 v67, v70, v71
v_mfma_f32_16x16x32_bf16 v[128:131], a[128:131], a[96:99], v[128:131]
v_cvt_pk_bf16_f32 v72, v72, v73
v_cvt_pk_bf16_f32 v73, v74, v75
v_mfma_f32_16x16x32_bf16 v[128:131], a[132:135], a[100:103], v[128:131]
buffer_load_dwordx4 v14, s[8:11], s24 offen offset:2048 lds
v_mfma_f32_16x16x32_bf16 v[136:139], a[128:131], a[104:107], v[136:139]
ds_read_b128 a[24:27], v2 offset:6144
v_cvt_pk_bf16_f32 v74, v76, v77
v_mfma_f32_16x16x32_bf16 v[136:139], a[132:135], a[108:111], v[136:139]
buffer_store_dwordx4 v[32:35], v1, s[4:7], s31 offen sc1
v_mfma_f32_16x16x32_bf16 v[144:147], a[128:131], a[112:115], v[144:147]
s_add_u32 s31, s31, s32
ds_read_b128 a[28:31], v3 offset:6144
v_cvt_pk_bf16_f32 v75, v78, v79
v_mfma_f32_16x16x32_bf16 v[144:147], a[132:135], a[116:119], v[144:147]
buffer_load_dwordx4 v15, s[8:11], s24 offen offset:3072 lds
v_mfma_f32_16x16x32_bf16 v[152:155], a[128:131], a[120:123], v[152:155]
s_add_u32 s24, s24, 128
v_cvt_pk_bf16_f32 v80, v80, v81
v_cvt_pk_bf16_f32 v81, v82, v83
v_mfma_f32_16x16x32_bf16 v[152:155], a[132:135], a[124:127], v[152:155]
s_waitcnt lgkmcnt(2)
v_cvt_pk_bf16_f32 v82, v84, v85
v_cvt_pk_bf16_f32 v83, v86, v87
v_mfma_f32_16x16x32_bf16 v[100:103], a[136:139], a[64:67], v[100:103]
ds_read_b64_tr_b16 a[128:129], v8 offset:32768
v_cvt_pk_bf16_f32 v88, v88, v89
v_mfma_f32_16x16x32_bf16 v[100:103], a[140:143], a[68:71], v[100:103]
v_cvt_pk_bf16_f32 v89, v90, v91
v_cvt_pk_bf16_f32 v90, v92, v93
v_mfma_f32_16x16x32_bf16 v[108:111], a[136:139], a[72:75], v[108:111]
ds_read_b64_tr_b16 a[130:131], v8 offset:34816
v_cvt_pk_bf16_f32 v91, v94, v95
v_mfma_f32_16x16x32_bf16 v[108:111], a[140:143], a[76:79], v[108:111]
buffer_store_dwordx4 v[40:43], v1, s[4:7], s31 offen sc1
v_mfma_f32_16x16x32_bf16 v[116:119], a[136:139], a[80:83], v[116:119]
s_add_u32 s31, s31, s33
ds_read_b64_tr_b16 a[132:133], v8 offset:49152
v_mfma_f32_16x16x32_bf16 v[116:119], a[140:143], a[84:87], v[116:119]
v_mfma_f32_16x16x32_bf16 v[124:127], a[136:139], a[88:91], v[124:127]
ds_read_b64_tr_b16 a[134:135], v8 offset:51200
v_cvt_pk_bf16_f32 v96, v96, v97
v_mfma_f32_16x16x32_bf16 v[124:127], a[140:143], a[92:95], v[124:127]
v_cvt_pk_bf16_f32 v97, v98, v99
v_cvt_pk_bf16_f32 v98, v100, v101
v_mfma_f32_16x16x32_bf16 v[132:135], a[136:139], a[96:99], v[132:135]
ds_read_b128 a[32:35], v2 offset:8192
v_cvt_pk_bf16_f32 v99, v102, v103
v_mfma_f32_16x16x32_bf16 v[132:135], a[140:143], a[100:103], v[132:135]
v_cvt_pk_bf16_f32 v104, v104, v105
v_cvt_pk_bf16_f32 v105, v106, v107
v_mfma_f32_16x16x32_bf16 v[140:143], a[136:139], a[104:107], v[140:143]
v_cvt_pk_bf16_f32 v106, v108, v109
v_cvt_pk_bf16_f32 v107, v110, v111
v_mfma_f32_16x16x32_bf16 v[140:143], a[140:143], a[108:111], v[140:143]
v_cvt_pk_bf16_f32 v112, v112, v113
v_cvt_pk_bf16_f32 v113, v114, v115
v_mfma_f32_16x16x32_bf16 v[148:151], a[136:139], a[112:115], v[148:151]
ds_read_b128 a[36:39], v3 offset:8192
v_cvt_pk_bf16_f32 v114, v116, v117
v_mfma_f32_16x16x32_bf16 v[148:151], a[140:143], a[116:119], v[148:151]
v_cvt_pk_bf16_f32 v115, v118, v119
v_cvt_pk_bf16_f32 v120, v120, v121
v_mfma_f32_16x16x32_bf16 v[156:159], a[136:139], a[120:123], v[156:159]
ds_read_b128 a[40:43], v2 offset:10240
v_cvt_pk_bf16_f32 v121, v122, v123
v_mfma_f32_16x16x32_bf16 v[156:159], a[140:143], a[124:127], v[156:159]
s_waitcnt lgkmcnt(3)
buffer_store_dwordx4 v[48:51], v1, s[4:7], s31 offen sc1
v_mfma_f32_16x16x32_bf16 v[160:163], a[128:131], a[64:67], v[160:163]
s_add_u32 s31, s31, s32
ds_read_b64_tr_b16 a[136:137], v9 offset:32768
v_cvt_pk_bf16_f32 v122, v124, v125
v_mfma_f32_16x16x32_bf16 v[160:163], a[132:135], a[68:71], v[160:163]
v_cvt_pk_bf16_f32 v123, v126, v127
v_cvt_pk_bf16_f32 v128, v128, v129
v_mfma_f32_16x16x32_bf16 v[168:171], a[128:131], a[72:75], v[168:171]
ds_read_b64_tr_b16 a[138:139], v9 offset:34816
v_cvt_pk_bf16_f32 v129, v130, v131
v_mfma_f32_16x16x32_bf16 v[168:171], a[132:135], a[76:79], v[168:171]
v_cvt_pk_bf16_f32 v130, v132, v133
v_cvt_pk_bf16_f32 v131, v134, v135
v_mfma_f32_16x16x32_bf16 v[176:179], a[128:131], a[80:83], v[176:179]
ds_read_b64_tr_b16 a[140:141], v9 offset:49152
v_cvt_pk_bf16_f32 v136, v136, v137
v_mfma_f32_16x16x32_bf16 v[176:179], a[132:135], a[84:87], v[176:179]
v_cvt_pk_bf16_f32 v137, v138, v139
v_cvt_pk_bf16_f32 v138, v140, v141
v_mfma_f32_16x16x32_bf16 v[184:187], a[128:131], a[88:91], v[184:187]
ds_read_b64_tr_b16 a[142:143], v9 offset:51200
v_cvt_pk_bf16_f32 v139, v142, v143
v_mfma_f32_16x16x32_bf16 v[184:187], a[132:135], a[92:95], v[184:187]
v_cvt_pk_bf16_f32 v144, v144, v145
v_cvt_pk_bf16_f32 v145, v146, v147
v_mfma_f32_16x16x32_bf16 v[192:195], a[128:131], a[96:99], v[192:195]
buffer_store_dwordx4 v[56:59], v1, s[4:7], s31 offen sc1
v_mfma_f32_16x16x32_bf16 v[192:195], a[132:135], a[100:103], v[192:195]
s_add_u32 s31, s31, s34
v_cvt_pk_bf16_f32 v146, v148, v149
v_cvt_pk_bf16_f32 v147, v150, v151
v_mfma_f32_16x16x32_bf16 v[200:203], a[128:131], a[104:107], v[200:203]
ds_read_b128 a[44:47], v3 offset:10240
v_cvt_pk_bf16_f32 v152, v152, v153
v_mfma_f32_16x16x32_bf16 v[200:203], a[132:135], a[108:111], v[200:203]
v_cvt_pk_bf16_f32 v153, v154, v155
v_cvt_pk_bf16_f32 v154, v156, v157
v_mfma_f32_16x16x32_bf16 v[208:211], a[128:131], a[112:115], v[208:211]
ds_read_b128 a[48:51], v2 offset:12288
v_cvt_pk_bf16_f32 v155, v158, v159
v_mfma_f32_16x16x32_bf16 v[208:211], a[132:135], a[116:119], v[208:211]
v_mfma_f32_16x16x32_bf16 v[216:219], a[128:131], a[120:123], v[216:219]
v_mfma_f32_16x16x32_bf16 v[216:219], a[132:135], a[124:127], v[216:219]
s_waitcnt lgkmcnt(2)
v_mfma_f32_16x16x32_bf16 v[164:167], a[136:139], a[64:67], v[164:167]
ds_read_b64_tr_b16 a[128:129], v10 offset:32768
v_mfma_f32_16x16x32_bf16 v[164:167], a[140:143], a[68:71], v[164:167]
v_mfma_f32_16x16x32_bf16 v[172:175], a[136:139], a[72:75], v[172:175]
ds_read_b64_tr_b16 a[130:131], v10 offset:34816
v_mfma_f32_16x16x32_bf16 v[172:175], a[140:143], a[76:79], v[172:175]
buffer_store_dwordx4 v[64:67], v1, s[4:7], s31 offen sc1
v_mfma_f32_16x16x32_bf16 v[180:183], a[136:139], a[80:83], v[180:183]
s_add_u32 s31, s31, s32
ds_read_b64_tr_b16 a[132:133], v10 offset:49152
v_mfma_f32_16x16x32_bf16 v[180:183], a[140:143], a[84:87], v[180:183]
v_mfma_f32_16x16x32_bf16 v[188:191], a[136:139], a[88:91], v[188:191]
ds_read_b64_tr_b16 a[134:135], v10 offset:51200
v_cvt_pk_bf16_f32 v160, v160, v161
v_mfma_f32_16x16x32_bf16 v[188:191], a[140:143], a[92:95], v[188:191]
v_cvt_pk_bf16_f32 v161, v162, v163
v_cvt_pk_bf16_f32 v162, v164, v165
v_mfma_f32_16x16x32_bf16 v[196:199], a[136:139], a[96:99], v[196:199]
ds_read_b128 a[52:55], v3 offset:12288
v_cvt_pk_bf16_f32 v163, v166, v167
v_mfma_f32_16x16x32_bf16 v[196:199], a[140:143], a[100:103], v[196:199]
v_cvt_pk_bf16_f32 v168, v168, v169
v_cvt_pk_bf16_f32 v169, v170, v171
v_mfma_f32_16x16x32_bf16 v[204:207], a[136:139], a[104:107], v[204:207]
ds_read_b128 a[56:59], v2 offset:14336
v_cvt_pk_bf16_f32 v170, v172, v173
v_mfma_f32_16x16x32_bf16 v[204:207], a[140:143], a[108:111], v[204:207]
v_cvt_pk_bf16_f32 v171, v174, v175
v_cvt_pk_bf16_f32 v176, v176, v177
v_mfma_f32_16x16x32_bf16 v[212:215], a[136:139], a[112:115], v[212:215]
v_cvt_pk_bf16_f32 v177, v178, v179
v_cvt_pk_bf16_f32 v178, v180, v181
v_mfma_f32_16x16x32_bf16 v[212:215], a[140:143], a[116:119], v[212:215]
buffer_store_dwordx4 v[72:75], v1, s[4:7], s31 offen sc1
v_mfma_f32_16x16x32_bf16 v[220:223], a[136:139], a[120:123], v[220:223]
s_add_u32 s31, s31, s33
ds_read_b128 a[60:63], v3 offset:14336
v_cvt_pk_bf16_f32 v179, v182, v183
v_mfma_f32_16x16x32_bf16 v[220:223], a[140:143], a[124:127], v[220:223]
s_waitcnt lgkmcnt(3)
v_cvt_pk_bf16_f32 v184, v184, v185
v_cvt_pk_bf16_f32 v185, v186, v187
v_mfma_f32_16x16x32_bf16 a[192:195], a[128:131], a[64:67], a[192:195]
ds_read_b64_tr_b16 a[136:137], v11 offset:32768
v_cvt_pk_bf16_f32 v186, v188, v189
v_mfma_f32_16x16x32_bf16 a[192:195], a[132:135], a[68:71], a[192:195]
v_cvt_pk_bf16_f32 v187, v190, v191
v_cvt_pk_bf16_f32 v192, v192, v193
v_mfma_f32_16x16x32_bf16 a[200:203], a[128:131], a[72:75], a[200:203]
ds_read_b64_tr_b16 a[138:139], v11 offset:34816
v_cvt_pk_bf16_f32 v193, v194, v195
v_mfma_f32_16x16x32_bf16 a[200:203], a[132:135], a[76:79], a[200:203]
v_cvt_pk_bf16_f32 v194, v196, v197
v_cvt_pk_bf16_f32 v195, v198, v199
v_mfma_f32_16x16x32_bf16 a[208:211], a[128:131], a[80:83], a[208:211]
ds_read_b64_tr_b16 a[140:141], v11 offset:49152
v_cvt_pk_bf16_f32 v200, v200, v201
v_mfma_f32_16x16x32_bf16 a[208:211], a[132:135], a[84:87], a[208:211]
v_cvt_pk_bf16_f32 v201, v202, v203
v_cvt_pk_bf16_f32 v202, v204, v205
v_mfma_f32_16x16x32_bf16 a[216:219], a[128:131], a[88:91], a[216:219]
ds_read_b64_tr_b16 a[142:143], v11 offset:51200
v_cvt_pk_bf16_f32 v203, v206, v207
v_mfma_f32_16x16x32_bf16 a[216:219], a[132:135], a[92:95], a[216:219]
v_cvt_pk_bf16_f32 v208, v208, v209
v_cvt_pk_bf16_f32 v209, v210, v211
v_mfma_f32_16x16x32_bf16 a[224:227], a[128:131], a[96:99], a[224:227]
buffer_store_dwordx4 v[80:83], v1, s[4:7], s31 offen sc1
v_mfma_f32_16x16x32_bf16 a[224:227], a[132:135], a[100:103], a[224:227]
s_add_u32 s31, s31, s32
v_cvt_pk_bf16_f32 v210, v212, v213
v_cvt_pk_bf16_f32 v211, v214, v215
v_mfma_f32_16x16x32_bf16 a[232:235], a[128:131], a[104:107], a[232:235]
v_cvt_pk_bf16_f32 v216, v216, v217
v_cvt_pk_bf16_f32 v217, v218, v219
v_mfma_f32_16x16x32_bf16 a[232:235], a[132:135], a[108:111], a[232:235]
v_cvt_pk_bf16_f32 v218, v220, v221
v_cvt_pk_bf16_f32 v219, v222, v223
v_mfma_f32_16x16x32_bf16 a[240:243], a[128:131], a[112:115], a[240:243]
v_mfma_f32_16x16x32_bf16 a[240:243], a[132:135], a[116:119], a[240:243]
v_mfma_f32_16x16x32_bf16 a[248:251], a[128:131], a[120:123], a[248:251]
s_waitcnt vmcnt(23) lgkmcnt(0)
v_mfma_f32_16x16x32_bf16 a[248:251], a[132:135], a[124:127], a[248:251]
s_barrier
v_mfma_f32_16x16x32_bf16 a[196:199], a[136:139], a[64:67], a[196:199]
s_add_u32 m0, s29, 98304
ds_read_b64_tr_b16 a[128:129], v22 offset:0
v_mfma_f32_16x16x32_bf16 a[196:199], a[140:143], a[68:71], a[196:199]
buffer_load_dwordx4 v16, s[12:15], s26 offen offset:0 lds
v_mfma_f32_16x16x32_bf16 a[204:207], a[136:139], a[72:75], a[204:207]
ds_read_b64_tr_b16 a[130:131], v22 offset:2048
v_mfma_f32_16x16x32_bf16 a[204:207], a[140:143], a[76:79], a[204:207]
buffer_store_dwordx4 v[88:91], v1, s[4:7], s31 offen sc1
v_mfma_f32_16x16x32_bf16 a[212:215], a[136:139], a[80:83], a[212:215]
s_add_u32 s31, s31, s35
ds_read_b64_tr_b16 a[132:133], v22 offset:16384
v_mfma_f32_16x16x32_bf16 a[212:215], a[140:143], a[84:87], a[212:215]
buffer_load_dwordx4 v17, s[12:15], s26 offen offset:1024 lds
v_mfma_f32_16x16x32_bf16 a[220:223], a[136:139], a[88:91], a[220:223]
ds_read_b64_tr_b16 a[134:135], v22 offset:18432
v_add_u32 v22, 4294901760, v22
v_mfma_f32_16x16x32_bf16 a[220:223], a[140:143], a[92:95], a[220:223]
v_mfma_f32_16x16x32_bf16 a[228:231], a[136:139], a[96:99], a[228:231]
v_mfma_f32_16x16x32_bf16 a[228:231], a[140:143], a[100:103], a[228:231]
buffer_load_dwordx4 v18, s[12:15], s26 offen offset:2048 lds
v_mfma_f32_16x16x32_bf16 a[236:239], a[136:139], a[104:107], a[236:239]
v_mfma_f32_16x16x32_bf16 a[236:239], a[140:143], a[108:111], a[236:239]
v_mfma_f32_16x16x32_bf16 a[244:247], a[136:139], a[112:115], a[244:247]
v_mfma_f32_16x16x32_bf16 a[244:247], a[140:143], a[116:119], a[244:247]
buffer_load_dwordx4 v19, s[12:15], s26 offen offset:3072 lds
v_mfma_f32_16x16x32_bf16 a[252:255], a[136:139], a[120:123], a[252:255]
s_add_u32 s26, s26, 524288
v_mfma_f32_16x16x32_bf16 a[252:255], a[140:143], a[124:127], a[252:255]
s_waitcnt lgkmcnt(0)
M_Q:
v_mfma_f32_16x16x32_bf16 v[36:39], a[128:131], a[0:3], 0
s_add_u32 m0, s29, 114688
ds_read_b64_tr_b16 a[136:137], v23 offset:0
v_mfma_f32_16x16x32_bf16 v[36:39], a[132:135], a[4:7], v[36:39]
buffer_load_dwordx4 v16, s[12:15], s27 offen offset:0 lds
v_mfma_f32_16x16x32_bf16 v[44:47], a[128:131], a[8:11], 0
ds_read_b64_tr_b16 a[138:139], v23 offset:2048
v_mfma_f32_16x16x32_bf16 v[44:47], a[132:135], a[12:15], v[44:47]
ds_read_b128 a[64:67], v2 offset:16384
ds_read_b128 a[68:71], v3 offset:16384
v_mfma_f32_16x16x32_bf16 v[52:55], a[128:131], a[16:19], 0
ds_read_b64_tr_b16 a[140:141], v23 offset:16384
v_mfma_f32_16x16x32_bf16 v[52:55], a[132:135], a[20:23], v[52:55]
buffer_load_dwordx4 v17, s[12:15], s27 offen offset:1024 lds
v_mfma_f32_16x16x32_bf16 v[60:63], a[128:131], a[24:27], 0
ds_read_b64_tr_b16 a[142:143], v23 offset:18432
v_add_u32 v23, 4294901760, v23
v_mfma_f32_16x16x32_bf16 v[60:63], a[132:135], a[28:31], v[60:63]
buffer_store_dwordx4 v[96:99], v1, s[4:7], s31 offen sc1
v_mfma_f32_16x16x32_bf16 v[68:71], a[128:131], a[32:35], 0
s_add_u32 s31, s31, s32
ds_read_b128 a[72:75], v2 offset:18432
v_mfma_f32_16x16x32_bf16 v[68:71], a[132:135], a[36:39], v[68:71]
buffer_load_dwordx4 v18, s[12:15], s27 offen offset:2048 lds
v_mfma_f32_16x16x32_bf16 v[76:79], a[128:131], a[40:43], 0
ds_read_b128 a[76:79], v3 offset:18432
v_mfma_f32_16x16x32_bf16 v[76:79], a[132:135], a[44:47], v[76:79]
ds_read_b128 a[80:83], v2 offset:20480
v_mfma_f32_16x16x32_bf16 v[84:87], a[128:131], a[48:51], 0
ds_read_b128 a[84:87], v3 offset:20480
v_mfma_f32_16x16x32_bf16 v[84:87], a[132:135], a[52:55], v[84:87]
buffer_load_dwordx4 v19, s[12:15], s27 offen offset:3072 lds
v_mfma_f32_16x16x32_bf16 v[92:95], a[128:131], a[56:59], 0
s_add_u32 s27, s27, 524288
ds_read_b128 a[88:91], v2 offset:22528
v_mfma_f32_16x16x32_bf16 v[92:95], a[132:135], a[60:63], v[92:95]
s_waitcnt lgkmcnt(5)
buffer_store_dwordx4 v[104:107], v1, s[4:7], s31 offen sc1
v_mfma_f32_16x16x32_bf16 v[100:103], a[136:139], a[0:3], 0
s_add_u32 m0, s28, 0
ds_read_b64_tr_b16 a[128:129], v24 offset:0
v_mfma_f32_16x16x32_bf16 v[100:103], a[140:143], a[4:7], v[100:103]
s_add_u32 s31, s31, s33
buffer_load_dwordx4 v12, s[8:11], s24 offen offset:0 lds
v_mfma_f32_16x16x32_bf16 v[108:111], a[136:139], a[8:11], 0
ds_read_b64_tr_b16 a[130:131], v24 offset:2048
v_mfma_f32_16x16x32_bf16 v[108:111], a[140:143], a[12:15], v[108:111]
ds_read_b128 a[92:95], v3 offset:22528
v_mfma_f32_16x16x32_bf16 v[116:119], a[136:139], a[16:19], 0
ds_read_b64_tr_b16 a[132:133], v24 offset:16384
v_mfma_f32_16x16x32_bf16 v[116:119], a[140:143], a[20:23], v[116:119]
buffer_load_dwordx4 v13, s[8:11], s24 offen offset:1024 lds
v_mfma_f32_16x16x32_bf16 v[124:127], a[136:139], a[24:27], 0
ds_read_b64_tr_b16 a[134:135], v24 offset:18432
v_add_u32 v24, 4294901760, v24
v_mfma_f32_16x16x32_bf16 v[124:127], a[140:143], a[28:31], v[124:127]
v_mfma_f32_16x16x32_bf16 v[132:135], a[136:139], a[32:35], 0
ds_read_b128 a[96:99], v2 offset:24576
v_mfma_f32_16x16x32_bf16 v[132:135], a[140:143], a[36:39], v[132:135]
buffer_load_dwordx4 v14, s[8:11], s24 offen offset:2048 lds
v_mfma_f32_16x16x32_bf16 v[140:143], a[136:139], a[40:43], 0
ds_read_b128 a[100:103], v3 offset:24576
v_mfma_f32_16x16x32_bf16 v[140:143], a[140:143], a[44:47], v[140:143]
ds_read_b128 a[104:107], v2 offset:26624
v_mfma_f32_16x16x32_bf16 v[148:151], a[136:139], a[48:51], 0
ds_read_b128 a[108:111], v3 offset:26624
v_mfma_f32_16x16x32_bf16 v[148:151], a[140:143], a[52:55], v[148:151]
buffer_load_dwordx4 v15, s[8:11], s24 offen offset:3072 lds
v_mfma_f32_16x16x32_bf16 v[156:159], a[136:139], a[56:59], 0
s_add_u32 s24, s24, 128
ds_read_b128 a[112:115], v2 offset:28672
v_mfma_f32_16x16x32_bf16 v[156:159], a[140:143], a[60:63], v[156:159]
s_waitcnt lgkmcnt(5)
buffer_store_dwordx4 v[112:115], v1, s[4:7], s31 offen sc1
v_mfma_f32_16x16x32_bf16 v[164:167], a[128:131], a[0:3], 0
s_add_u32 s31, s31, s32
ds_read_b64_tr_b16 a[136:137], v25 offset:0
v_mfma_f32_16x16x32_bf16 v[164:167], a[132:135], a[4:7], v[164:167]
PAD_6:
s_cbranch_execz M_tret
v_mfma_f32_16x16x32_bf16 v[172:175], a[128:131], a[8:11], 0
ds_read_b64_tr_b16 a[138:139], v25 offset:2048
v_mfma_f32_16x16x32_bf16 v[172:175], a[132:135], a[12:15], v[172:175]
ds_read_b128 a[116:119], v3 offset:28672
v_mfma_f32_16x16x32_bf16 v[180:183], a[128:131], a[16:19], 0
ds_read_b64_tr_b16 a[140:141], v25 offset:16384
v_mfma_f32_16x16x32_bf16 v[180:183], a[132:135], a[20:23], v[180:183]
v_mfma_f32_16x16x32_bf16 v[188:191], a[128:131], a[24:27], 0
ds_read_b64_tr_b16 a[142:143], v25 offset:18432
v_add_u32 v25, 4294901760, v25
v_mfma_f32_16x16x32_bf16 v[188:191], a[132:135], a[28:31], v[188:191]
v_mfma_f32_16x16x32_bf16 v[196:199], a[128:131], a[32:35], 0
ds_read_b128 a[120:123], v2 offset:30720
v_mfma_f32_16x16x32_bf16 v[196:199], a[132:135], a[36:39], v[196:199]
v_mfma_f32_16x16x32_bf16 v[204:207], a[128:131], a[40:43], 0
ds_read_b128 a[124:127], v3 offset:30720
v_mfma_f32_16x16x32_bf16 v[204:207], a[132:135], a[44:47], v[204:207]
v_mfma_f32_16x16x32_bf16 v[212:215], a[128:131], a[48:51], 0
v_mfma_f32_16x16x32_bf16 v[212:215], a[132:135], a[52:55], v[212:215]
buffer_store_dwordx4 v[120:123], v1, s[4:7], s31 offen sc1
v_mfma_f32_16x16x32_bf16 v[220:223], a[128:131], a[56:59], 0
s_add_u32 s31, s31, s34
v_mfma_f32_16x16x32_bf16 v[220:223], a[132:135], a[60:63], v[220:223]
s_waitcnt vmcnt(28) lgkmcnt(0)
s_barrier
v_mfma_f32_16x16x32_bf16 v[224:227], a[136:139], a[0:3], 0
s_add_u32 m0, s29, 131072
ds_read_b64_tr_b16 a[128:129], v22 offset:0
v_mfma_f32_16x16x32_bf16 v[224:227], a[140:143], a[4:7], v[224:227]
buffer_load_dwordx4 v16, s[12:15], s26 offen offset:0 lds
v_mfma_f32_16x16x32_bf16 v[228:231], a[136:139], a[8:11], 0
ds_read_b64_tr_b16 a[130:131], v22 offset:2048
v_mfma_f32_16x16x32_bf16 v[228:231], a[140:143], a[12:15], v[228:231]
v_mfma_f32_16x16x32_bf16 v[232:235], a[136:139], a[16:19], 0
ds_read_b64_tr_b16 a[132:133], v22 offset:16384
v_mfma_f32_16x16x32_bf16 v[232:235], a[140:143], a[20:23], v[232:235]
buffer_load_dwordx4 v17, s[12:15], s26 offen offset:1024 lds
v_mfma_f32_16x16x32_bf16 v[236:239], a[136:139], a[24:27], 0
ds_read_b64_tr_b16 a[134:135], v22 offset:18432
v_add_u32 v22, 32768, v22
v_mfma_f32_16x16x32_bf16 v[236:239], a[140:143], a[28:31], v[236:239]
v_mfma_f32_16x16x32_bf16 v[240:243], a[136:139], a[32:35], 0
v_mfma_f32_16x16x32_bf16 v[240:243], a[140:143], a[36:39], v[240:243]
buffer_load_dwordx4 v18, s[12:15], s26 offen offset:2048 lds
v_mfma_f32_16x16x32_bf16 v[244:247], a[136:139], a[40:43], 0
v_mfma_f32_16x16x32_bf16 v[244:247], a[140:143], a[44:47], v[244:247]
v_mfma_f32_16x16x32_bf16 v[248:251], a[136:139], a[48:51], 0
v_mfma_f32_16x16x32_bf16 v[248:251], a[140:143], a[52:55], v[248:251]
buffer_load_dwordx4 v19, s[12:15], s26 offen offset:3072 lds
v_mfma_f32_16x16x32_bf16 v[252:255], a[136:139], a[56:59], 0
s_add_u32 s26, s26, 524288
v_mfma_f32_16x16x32_bf16 v[252:255], a[140:143], a[60:63], v[252:255]
s_waitcnt lgkmcnt(0)
v_mfma_f32_16x16x32_bf16 v[36:39], a[128:131], a[64:67], v[36:39]
s_add_u32 m0, s29, 147456
ds_read_b64_tr_b16 a[136:137], v23 offset:0
v_mfma_f32_16x16x32_bf16 v[36:39], a[132:135], a[68:71], v[36:39]
buffer_load_dwordx4 v16, s[12:15], s27 offen offset:0 lds
v_mfma_f32_16x16x32_bf16 v[44:47], a[128:131], a[72:75], v[44:47]
ds_read_b64_tr_b16 a[138:139], v23 offset:2048
v_mfma_f32_16x16x32_bf16 v[44:47], a[132:135], a[76:79], v[44:47]
ds_read_b128 a[0:3], v2 offset:32768
ds_read_b128 a[4:7], v3 offset:32768
v_mfma_f32_16x16x32_bf16 v[52:55], a[128:131], a[80:83], v[52:55]
ds_read_b64_tr_b16 a[140:141], v23 offset:16384
v_mfma_f32_16x16x32_bf16 v[52:55], a[132:135], a[84:87], v[52:55]
buffer_load_dwordx4 v17, s[12:15], s27 offen offset:1024 lds
v_mfma_f32_16x16x32_bf16 v[60:63], a[128:131], a[88:91], v[60:63]
ds_read_b64_tr_b16 a[142:143], v23 offset:18432
v_add_u32 v23, 32768, v23
v_mfma_f32_16x16x32_bf16 v[60:63], a[132:135], a[92:95], v[60:63]
buffer_store_dwordx4 v[128:131], v1, s[4:7], s31 offen sc1
v_mfma_f32_16x16x32_bf16 v[68:71], a[128:131], a[96:99], v[68:71]
s_add_u32 s31, s31, s32
ds_read_b128 a[8:11], v2 offset:34816
v_accvgpr_read_b32 v32, a192
v_mfma_f32_16x16x32_bf16 v[68:71], a[132:135], a[100:103], v[68:71]
buffer_load_dwordx4 v18, s[12:15], s27 offen offset:2048 lds
v_mfma_f32_16x16x32_bf16 v[76:79], a[128:131], a[104:107], v[76:79]
ds_read_b128 a[12:15], v3 offset:34816
v_accvgpr_read_b32 v33, a193
v_mfma_f32_16x16x32_bf16 v[76:79], a[132:135], a[108:111], v[76:79]
ds_read_b128 a[16:19], v2 offset:36864
v_accvgpr_read_b32 v34, a194
v_mfma_f32_16x16x32_bf16 v[84:87], a[128:131], a[112:115], v[84:87]
ds_read_b128 a[20:23], v3 offset:36864
v_accvgpr_read_b32 v35, a195
v_mfma_f32_16x16x32_bf16 v[84:87], a[132:135], a[116:119], v[84:87]
buffer_load_dwordx4 v19, s[12:15], s27 offen offset:3072 lds
v_mfma_f32_16x16x32_bf16 v[92:95], a[128:131], a[120:123], v[92:95]
s_add_u32 s27, s27, 524288
ds_read_b128 a[24:27], v2 offset:38912
v_accvgpr_read_b32 v96, a196
v_mfma_f32_16x16x32_bf16 v[92:95], a[132:135], a[124:127], v[92:95]
s_waitcnt lgkmcnt(5)
buffer_store_dwordx4 v[136:139], v1, s[4:7], s31 offen sc1
v_mfma_f32_16x16x32_bf16 v[100:103], a[136:139], a[64:67], v[100:103]
s_add_u32 m0, s28, 16384
ds_read_b64_tr_b16 a[128:129], v24 offset:0
v_accvgpr_read_b32 v97, a197
v_mfma_f32_16x16x32_bf16 v[100:103], a[140:143], a[68:71], v[100:103]
s_add_u32 s31, s31, s33
buffer_load_dwordx4 v12, s[8:11], s24 offen offset:0 lds
v_mfma_f32_16x16x32_bf16 v[108:111], a[136:139], a[72:75], v[108:111]
ds_read_b64_tr_b16 a[130:131], v24 offset:2048
v_accvgpr_read_b32 v98, a198
v_mfma_f32_16x16x32_bf16 v[108:111], a[140:143], a[76:79], v[108:111]
ds_read_b128 a[28:31], v3 offset:38912
v_accvgpr_read_b32 v99, a199
v_mfma_f32_16x16x32_bf16 v[116:119], a[136:139], a[80:83], v[116:119]
ds_read_b64_tr_b16 a[132:133], v24 offset:16384
v_cvt_pk_bf16_f32 v32, v32, v33
v_mfma_f32_16x16x32_bf16 v[116:119], a[140:143], a[84:87], v[116:119]
buffer_load_dwordx4 v13, s[8:11], s24 offen offset:1024 lds
v_mfma_f32_16x16x32_bf16 v[124:127], a[136:139], a[88:91], v[124:127]
ds_read_b64_tr_b16 a[134:135], v24 offset:18432
v_add_u32 v24, 32768, v24
v_mfma_f32_16x16x32_bf16 v[124:127], a[140:143], a[92:95], v[124:127]
v_cvt_pk_bf16_f32 v33, v34, v35
v_cvt_pk_bf16_f32 v34, v96, v97
v_mfma_f32_16x16x32_bf16 v[132:135], a[136:139], a[96:99], v[132:135]
ds_read_b128 a[32:35], v2 offset:40960
v_cvt_pk_bf16_f32 v35, v98, v99
v_mfma_f32_16x16x32_bf16 v[132:135], a[140:143], a[100:103], v[132:135]
buffer_load_dwordx4 v14, s[8:11], s24 offen offset:2048 lds
v_mfma_f32_16x16x32_bf16 v[140:143], a[136:139], a[104:107], v[140:143]
ds_read_b128 a[36:39], v3 offset:40960
v_accvgpr_read_b32 v40, a200
v_mfma_f32_16x16x32_bf16 v[140:143], a[140:143], a[108:111], v[140:143]
ds_read_b128 a[40:43], v2 offset:43008
v_accvgpr_read_b32 v41, a201
v_mfma_f32_16x16x32_bf16 v[148:151], a[136:139], a[112:115], v[148:151]
ds_read_b128 a[44:47], v3 offset:43008
v_accvgpr_read_b32 v42, a202
v_mfma_f32_16x16x32_bf16 v[148:151], a[140:143], a[116:119], v[148:151]
buffer_load_dwordx4 v15, s[8:11], s24 offen offset:3072 lds
v_mfma_f32_16x16x32_bf16 v[156:159], a[136:139], a[120:123], v[156:159]
s_add_u32 s24, s24, 128
ds_read_b128 a[48:51], v2 offset:45056
v_accvgpr_read_b32 v43, a203
v_mfma_f32_16x16x32_bf16 v[156:159], a[140:143], a[124:127], v[156:159]
s_waitcnt lgkmcnt(5)
buffer_store_dwordx4 v[144:147], v1, s[4:7], s31 offen sc1
v_mfma_f32_16x16x32_bf16 v[164:167], a[128:131], a[64:67], v[164:167]
s_add_u32 s31, s31, s32
ds_read_b64_tr_b16 a[136:137], v25 offset:0
v_accvgpr_read_b32 v96, a204
v_mfma_f32_16x16x32_bf16 v[164:167], a[132:135], a[68:71], v[164:167]
v_accvgpr_read_b32 v97, a205
v_accvgpr_read_b32 v98, a206
v_mfma_f32_16x16x32_bf16 v[172:175], a[128:131], a[72:75], v[172:175]
ds_read_b64_tr_b16 a[138:139], v25 offset:2048
v_accvgpr_read_b32 v99, a207
v_mfma_f32_16x16x32_bf16 v[172:175], a[132:135], a[76:79], v[172:175]
ds_read_b128 a[52:55], v3 offset:45056
v_cvt_pk_bf16_f32 v40, v40, v41
v_mfma_f32_16x16x32_bf16 v[180:183], a[128:131], a[80:83], v[180:183]
ds_read_b64_tr_b16 a[140:141], v25 offset:16384
v_cvt_pk_bf16_f32 v41, v42, v43
v_mfma_f32_16x16x32_bf16 v[180:183], a[132:135], a[84:87], v[180:183]
v_cvt_pk_bf16_f32 v42, v96, v97
v_cvt_pk_bf16_f32 v43, v98, v99
v_mfma_f32_16x16x32_bf16 v[188:191], a[128:131], a[88:91], v[188:191]
ds_read_b64_tr_b16 a[142:143], v25 offset:18432
v_add_u32 v25, 32768, v25
v_mfma_f32_16x16x32_bf16 v[188:191], a[132:135], a[92:95], v[188:191]
v_accvgpr_read_b32 v48, a208
v_accvgpr_read_b32 v49, a209
v_mfma_f32_16x16x32_bf16 v[196:199], a[128:131], a[96:99], v[196:199]
ds_read_b128 a[56:59], v2 offset:47104
v_accvgpr_read_b32 v50, a210
v_mfma_f32_16x16x32_bf16 v[196:199], a[132:135], a[100:103], v[196:199]
v_accvgpr_read_b32 v51, a211
v_accvgpr_read_b32 v96, a212
v_mfma_f32_16x16x32_bf16 v[204:207], a[128:131], a[104:107], v[204:207]
ds_read_b128 a[60:63], v3 offset:47104
v_accvgpr_read_b32 v97, a213
v_mfma_f32_16x16x32_bf16 v[204:207], a[132:135], a[108:111], v[204:207]
v_accvgpr_read_b32 v98, a214
v_accvgpr_read_b32 v99, a215
v_mfma_f32_16x16x32_bf16 v[212:215], a[128:131], a[112:115], v[212:215]
v_cvt_pk_bf16_f32 v48, v48, v49
v_cvt_pk_bf16_f32 v49, v50, v51
v_mfma_f32_16x16x32_bf16 v[212:215], a[132:135], a[116:119], v[212:215]
buffer_store_dwordx4 v[152:155], v1, s[4:7], s31 offen sc1
v_mfma_f32_16x16x32_bf16 v[220:223], a[128:131], a[120:123], v[220:223]
s_add_u32 s31, s31, s36
v_cvt_pk_bf16_f32 v50, v96, v97
v_cvt_pk_bf16_f32 v51, v98, v99
v_mfma_f32_16x16x32_bf16 v[220:223], a[132:135], a[124:127], v[220:223]
s_waitcnt vmcnt(23) lgkmcnt(0)
s_barrier
v_accvgpr_read_b32 v56, a216
v_mfma_f32_16x16x32_bf16 v[224:227], a[136:139], a[64:67], v[224:227]
s_add_u32 m0, s29, 65536
ds_read_b64_tr_b16 a[128:129], v22 offset:0
v_accvgpr_read_b32 v57, a217
v_mfma_f32_16x16x32_bf16 v[224:227], a[140:143], a[68:71], v[224:227]
buffer_load_dwordx4 v16, s[12:15], s26 offen offset:0 lds
v_mfma_f32_16x16x32_bf16 v[228:231], a[136:139], a[72:75], v[228:231]
ds_read_b64_tr_b16 a[130:131], v22 offset:2048
v_accvgpr_read_b32 v58, a218
v_mfma_f32_16x16x32_bf16 v[228:231], a[140:143], a[76:79], v[228:231]
v_accvgpr_read_b32 v59, a219
v_accvgpr_read_b32 v96, a220
v_mfma_f32_16x16x32_bf16 v[232:235], a[136:139], a[80:83], v[232:235]
ds_read_b64_tr_b16 a[132:133], v22 offset:16384
v_accvgpr_read_b32 v97, a221
v_mfma_f32_16x16x32_bf16 v[232:235], a[140:143], a[84:87], v[232:235]
buffer_load_dwordx4 v17, s[12:15], s26 offen offset:1024 lds
v_mfma_f32_16x16x32_bf16 v[236:239], a[136:139], a[88:91], v[236:239]
ds_read_b64_tr_b16 a[134:135], v22 offset:18432
v_add_u32 v22, 32768, v22
v_mfma_f32_16x16x32_bf16 v[236:239], a[140:143], a[92:95], v[236:239]
v_accvgpr_read_b32 v98, a222
v_accvgpr_read_b32 v99, a223
v_mfma_f32_16x16x32_bf16 v[240:243], a[136:139], a[96:99], v[240:243]
v_cvt_pk_bf16_f32 v56, v56, v57
v_cvt_pk_bf16_f32 v57, v58, v59
v_mfma_f32_16x16x32_bf16 v[240:243], a[140:143], a[100:103], v[240:243]
buffer_load_dwordx4 v18, s[12:15], s26 offen offset:2048 lds
v_mfma_f32_16x16x32_bf16 v[244:247], a[136:139], a[104:107], v[244:247]
v_cvt_pk_bf16_f32 v58, v96, v97
v_cvt_pk_bf16_f32 v59, v98, v99
v_mfma_f32_16x16x32_bf16 v[244:247], a[140:143], a[108:111], v[244:247]
v_accvgpr_read_b32 v64, a224
v_accvgpr_read_b32 v65, a225
v_mfma_f32_16x16x32_bf16 v[248:251], a[136:139], a[112:115], v[248:251]
v_accvgpr_read_b32 v66, a226
v_accvgpr_read_b32 v67, a227
v_mfma_f32_16x16x32_bf16 v[248:251], a[140:143], a[116:119], v[248:251]
buffer_load_dwordx4 v19, s[12:15], s26 offen offset:3072 lds
v_mfma_f32_16x16x32_bf16 v[252:255], a[136:139], a[120:123], v[252:255]
s_add_u32 s26, s26, 524288
v_accvgpr_read_b32 v96, a228
v_accvgpr_read_b32 v97, a229
v_mfma_f32_16x16x32_bf16 v[252:255], a[140:143], a[124:127], v[252:255]
s_waitcnt lgkmcnt(0)
v_accvgpr_read_b32 v98, a230
v_accvgpr_read_b32 v99, a231
v_mfma_f32_16x16x32_bf16 v[36:39], a[128:131], a[0:3], v[36:39]
s_add_u32 m0, s29, 81920
ds_read_b64_tr_b16 a[136:137], v23 offset:0
v_cvt_pk_bf16_f32 v64, v64, v65
v_mfma_f32_16x16x32_bf16 v[36:39], a[132:135], a[4:7], v[36:39]
buffer_load_dwordx4 v16, s[12:15], s27 offen offset:0 lds
v_mfma_f32_16x16x32_bf16 v[44:47], a[128:131], a[8:11], v[44:47]
ds_read_b64_tr_b16 a[138:139], v23 offset:2048
v_cvt_pk_bf16_f32 v65, v66, v67
v_mfma_f32_16x16x32_bf16 v[44:47], a[132:135], a[12:15], v[44:47]
ds_read_b128 a[64:67], v2 offset:49152
ds_read_b128 a[68:71], v3 offset:49152
v_mfma_f32_16x16x32_bf16 v[52:55], a[128:131], a[16:19], v[52:55]
ds_read_b64_tr_b16 a[140:141], v23 offset:16384
v_cvt_pk_bf16_f32 v66, v96, v97
v_mfma_f32_16x16x32_bf16 v[52:55], a[132:135], a[20:23], v[52:55]
buffer_load_dwordx4 v17, s[12:15], s27 offen offset:1024 lds
v_mfma_f32_16x16x32_bf16 v[60:63], a[128:131], a[24:27], v[60:63]
ds_read_b64_tr_b16 a[142:143], v23 offset:18432
v_add_u32 v23, 32768, v23
v_mfma_f32_16x16x32_bf16 v[60:63], a[132:135], a[28:31], v[60:63]
buffer_store_dwordx4 v[160:163], v1, s[4:7], s31 offen sc1
v_mfma_f32_16x16x32_bf16 v[68:71], a[128:131], a[32:35], v[68:71]
s_add_u32 s31, s31, s32
ds_read_b128 a[72:75], v2 offset:51200
v_cvt_pk_bf16_f32 v67, v98, v99
v_mfma_f32_16x16x32_bf16 v[68:71], a[132:135], a[36:39], v[68:71]
buffer_load_dwordx4 v18, s[12:15], s27 offen offset:2048 lds
v_mfma_f32_16x16x32_bf16 v[76:79], a[128:131], a[40:43], v[76:79]
ds_read_b128 a[76:79], v3 offset:51200
v_accvgpr_read_b32 v72, a232
v_mfma_f32_16x16x32_bf16 v[76:79], a[132:135], a[44:47], v[76:79]
ds_read_b128 a[80:83], v2 offset:53248
v_accvgpr_read_b32 v73, a233
v_mfma_f32_16x16x32_bf16 v[84:87], a[128:131], a[48:51], v[84:87]
ds_read_b128 a[84:87], v3 offset:53248
v_accvgpr_read_b32 v74, a234
v_mfma_f32_16x16x32_bf16 v[84:87], a[132:135], a[52:55], v[84:87]
buffer_load_dwordx4 v19, s[12:15], s27 offen offset:3072 lds
v_mfma_f32_16x16x32_bf16 v[92:95], a[128:131], a[56:59], v[92:95]
s_add_u32 s27, s27, 524288
ds_read_b128 a[88:91], v2 offset:55296
v_accvgpr_read_b32 v75, a235
v_mfma_f32_16x16x32_bf16 v[92:95], a[132:135], a[60:63], v[92:95]
s_waitcnt lgkmcnt(5)
buffer_store_dwordx4 v[168:171], v1, s[4:7], s31 offen sc1
v_mfma_f32_16x16x32_bf16 v[100:103], a[136:139], a[0:3], v[100:103]
s_add_u32 m0, s28, 32768
ds_read_b64_tr_b16 a[128:129], v24 offset:0
v_accvgpr_read_b32 v96, a236
v_mfma_f32_16x16x32_bf16 v[100:103], a[140:143], a[4:7], v[100:103]
s_add_u32 s31, s31, s33
buffer_load_dwordx4 v12, s[8:11], s24 offen offset:0 lds
v_mfma_f32_16x16x32_bf16 v[108:111], a[136:139], a[8:11], v[108:111]
ds_read_b64_tr_b16 a[130:131], v24 offset:2048
v_accvgpr_read_b32 v97, a237
v_mfma_f32_16x16x32_bf16 v[108:111], a[140:143], a[12:15], v[108:111]
ds_read_b128 a[92:95], v3 offset:55296
v_accvgpr_read_b32 v98, a238
v_mfma_f32_16x16x32_bf16 v[116:119], a[136:139], a[16:19], v[116:119]
ds_read_b64_tr_b16 a[132:133], v24 offset:16384
v_accvgpr_read_b32 v99, a239
v_mfma_f32_16x16x32_bf16 v[116:119], a[140:143], a[20:23], v[116:119]
buffer_load_dwordx4 v13, s[8:11], s24 offen offset:1024 lds
v_mfma_f32_16x16x32_bf16 v[124:127], a[136:139], a[24:27], v[124:127]
ds_read_b64_tr_b16 a[134:135], v24 offset:18432
v_add_u32 v24, 32768, v24
v_mfma_f32_16x16x32_bf16 v[124:127], a[140:143], a[28:31], v[124:127]
v_cvt_pk_bf16_f32 v72, v72, v73
v_cvt_pk_bf16_f32 v73, v74, v75
v_mfma_f32_16x16x32_bf16 v[132:135], a[136:139], a[32:35], v[132:135]
ds_read_b128 a[96:99], v2 offset:57344
v_cvt_pk_bf16_f32 v74, v96, v97
v_mfma_f32_16x16x32_bf16 v[132:135], a[140:143], a[36:39], v[132:135]
buffer_load_dwordx4 v14, s[8:11], s24 offen offset:2048 lds
v_mfma_f32_16x16x32_bf16 v[140:143], a[136:139], a[40:43], v[140:143]
ds_read_b128 a[100:103], v3 offset:57344
v_cvt_pk_bf16_f32 v75, v98, v99
v_mfma_f32_16x16x32_bf16 v[140:143], a[140:143], a[44:47], v[140:143]
ds_read_b128 a[104:107], v2 offset:59392
v_accvgpr_read_b32 v80, a240
v_mfma_f32_16x16x32_bf16 v[148:151], a[136:139], a[48:51], v[148:151]
ds_read_b128 a[108:111], v3 offset:59392
v_accvgpr_read_b32 v81, a241
v_mfma_f32_16x16x32_bf16 v[148:151], a[140:143], a[52:55], v[148:151]
buffer_load_dwordx4 v15, s[8:11], s24 offen offset:3072 lds
v_mfma_f32_16x16x32_bf16 v[156:159], a[136:139], a[56:59], v[156:159]
s_add_u32 s24, s24, 128
ds_read_b128 a[112:115], v2 offset:61440
v_accvgpr_read_b32 v82, a242
v_mfma_f32_16x16x32_bf16 v[156:159], a[140:143], a[60:63], v[156:159]
s_waitcnt lgkmcnt(5)
buffer_store_dwordx4 v[176:179], v1, s[4:7], s31 offen sc1
v_mfma_f32_16x16x32_bf16 v[164:167], a[128:131], a[0:3], v[164:167]
s_add_u32 s31, s31, s32
ds_read_b64_tr_b16 a[136:137], v25 offset:0
v_accvgpr_read_b32 v83, a243
v_mfma_f32_16x16x32_bf16 v[164:167], a[132:135], a[4:7], v[164:167]
v_accvgpr_read_b32 v96, a244
v_accvgpr_read_b32 v97, a245
v_mfma_f32_16x16x32_bf16 v[172:175], a[128:131], a[8:11], v[172:175]
ds_read_b64_tr_b16 a[138:139], v25 offset:2048
v_accvgpr_read_b32 v98, a246
v_mfma_f32_16x16x32_bf16 v[172:175], a[132:135], a[12:15], v[172:175]
ds_read_b128 a[116:119], v3 offset:61440
v_accvgpr_read_b32 v99, a247
v_mfma_f32_16x16x32_bf16 v[180:183], a[128:131], a[16:19], v[180:183]
ds_read_b64_tr_b16 a[140:141], v25 offset:16384
v_cvt_pk_bf16_f32 v80, v80, v81
v_mfma_f32_16x16x32_bf16 v[180:183], a[132:135], a[20:23], v[180:183]
buffer_store_dwordx4 v[184:187], v1, s[4:7], s31 offen sc1
v_mfma_f32_16x16x32_bf16 v[188:191], a[128:131], a[24:27], v[188:191]
s_add_u32 s31, s31, s34
ds_read_b64_tr_b16 a[142:143], v25 offset:18432
v_add_u32 v25, 32768, v25
v_mfma_f32_16x16x32_bf16 v[188:191], a[132:135], a[28:31], v[188:191]
v_cvt_pk_bf16_f32 v81, v82, v83
v_cvt_pk_bf16_f32 v82, v96, v97
v_mfma_f32_16x16x32_bf16 v[196:199], a[128:131], a[32:35], v[196:199]
ds_read_b128 a[120:123], v2 offset:63488
v_cvt_pk_bf16_f32 v83, v98, v99
v_mfma_f32_16x16x32_bf16 v[196:199], a[132:135], a[36:39], v[196:199]
v_accvgpr_read_b32 v88, a248
v_accvgpr_read_b32 v89, a249
v_mfma_f32_16x16x32_bf16 v[204:207], a[128:131], a[40:43], v[204:207]
ds_read_b128 a[124:127], v3 offset:63488
v_accvgpr_read_b32 v90, a250
v_mfma_f32_16x16x32_bf16 v[204:207], a[132:135], a[44:47], v[204:207]
v_accvgpr_read_b32 v91, a251
v_accvgpr_read_b32 v96, a252
v_mfma_f32_16x16x32_bf16 v[212:215], a[128:131], a[48:51], v[212:215]
v_accvgpr_read_b32 v97, a253
v_accvgpr_read_b32 v98, a254
v_mfma_f32_16x16x32_bf16 v[212:215], a[132:135], a[52:55], v[212:215]
v_accvgpr_read_b32 v99, a255
v_cvt_pk_bf16_f32 v88, v88, v89
v_mfma_f32_16x16x32_bf16 v[220:223], a[128:131], a[56:59], v[220:223]
v_cvt_pk_bf16_f32 v89, v90, v91
v_cvt_pk_bf16_f32 v90, v96, v97
v_mfma_f32_16x16x32_bf16 v[220:223], a[132:135], a[60:63], v[220:223]
s_waitcnt vmcnt(23) lgkmcnt(0)
s_barrier
v_cvt_pk_bf16_f32 v91, v98, v99
v_mfma_f32_16x16x32_bf16 v[224:227], a[136:139], a[0:3], v[224:227]
s_add_u32 m0, s29, 98304
ds_read_b64_tr_b16 a[128:129], v22 offset:0
v_mfma_f32_16x16x32_bf16 v[224:227], a[140:143], a[4:7], v[224:227]
buffer_load_dwordx4 v16, s[12:15], s26 offen offset:0 lds
v_mfma_f32_16x16x32_bf16 v[228:231], a[136:139], a[8:11], v[228:231]
ds_read_b64_tr_b16 a[130:131], v22 offset:2048
v_mfma_f32_16x16x32_bf16 v[228:231], a[140:143], a[12:15], v[228:231]
buffer_store_dwordx4 v[192:195], v1, s[4:7], s31 offen sc1
v_mfma_f32_16x16x32_bf16 v[232:235], a[136:139], a[16:19], v[232:235]
s_add_u32 s31, s31, s32
ds_read_b64_tr_b16 a[132:133], v22 offset:16384
v_mfma_f32_16x16x32_bf16 v[232:235], a[140:143], a[20:23], v[232:235]
buffer_load_dwordx4 v17, s[12:15], s26 offen offset:1024 lds
v_mfma_f32_16x16x32_bf16 v[236:239], a[136:139], a[24:27], v[236:239]
ds_read_b64_tr_b16 a[134:135], v22 offset:18432
v_add_u32 v22, 4294901760, v22
v_mfma_f32_16x16x32_bf16 v[236:239], a[140:143], a[28:31], v[236:239]
v_mfma_f32_16x16x32_bf16 v[240:243], a[136:139], a[32:35], v[240:243]
v_mfma_f32_16x16x32_bf16 v[240:243], a[140:143], a[36:39], v[240:243]
buffer_load_dwordx4 v18, s[12:15], s26 offen offset:2048 lds
v_mfma_f32_16x16x32_bf16 v[244:247], a[136:139], a[40:43], v[244:247]
v_mfma_f32_16x16x32_bf16 v[244:247], a[140:143], a[44:47], v[244:247]
v_mfma_f32_16x16x32_bf16 v[248:251], a[136:139], a[48:51], v[248:251]
v_mfma_f32_16x16x32_bf16 v[248:251], a[140:143], a[52:55], v[248:251]
buffer_load_dwordx4 v19, s[12:15], s26 offen offset:3072 lds
v_mfma_f32_16x16x32_bf16 v[252:255], a[136:139], a[56:59], v[252:255]
s_add_u32 s26, s26, 524288
v_mfma_f32_16x16x32_bf16 v[252:255], a[140:143], a[60:63], v[252:255]
s_waitcnt lgkmcnt(0)
v_mfma_f32_16x16x32_bf16 v[36:39], a[128:131], a[64:67], v[36:39]
s_add_u32 m0, s29, 114688
ds_read_b64_tr_b16 a[136:137], v23 offset:0
v_mfma_f32_16x16x32_bf16 v[36:39], a[132:135], a[68:71], v[36:39]
buffer_load_dwordx4 v16, s[12:15], s27 offen offset:0 lds
v_mfma_f32_16x16x32_bf16 v[44:47], a[128:131], a[72:75], v[44:47]
ds_read_b64_tr_b16 a[138:139], v23 offset:2048
v_mfma_f32_16x16x32_bf16 v[44:47], a[132:135], a[76:79], v[44:47]
ds_read_b128 a[0:3], v2 offset:0
ds_read_b128 a[4:7], v3 offset:0
v_mfma_f32_16x16x32_bf16 v[52:55], a[128:131], a[80:83], v[52:55]
ds_read_b64_tr_b16 a[140:141], v23 offset:16384
v_mfma_f32_16x16x32_bf16 v[52:55], a[132:135], a[84:87], v[52:55]
buffer_load_dwordx4 v17, s[12:15], s27 offen offset:1024 lds
v_mfma_f32_16x16x32_bf16 v[60:63], a[128:131], a[88:91], v[60:63]
ds_read_b64_tr_b16 a[142:143], v23 offset:18432
v_add_u32 v23, 4294901760, v23
v_mfma_f32_16x16x32_bf16 v[60:63], a[132:135], a[92:95], v[60:63]
buffer_store_dwordx4 v[200:203], v1, s[4:7], s31 offen sc1
v_mfma_f32_16x16x32_bf16 v[68:71], a[128:131], a[96:99], v[68:71]
s_add_u32 s31, s31, s33
ds_read_b128 a[8:11], v2 offset:2048
v_mfma_f32_16x16x32_bf16 v[68:71], a[132:135], a[100:103], v[68:71]
buffer_load_dwordx4 v18, s[12:15], s27 offen offset:2048 lds
v_mfma_f32_16x16x32_bf16 v[76:79], a[128:131], a[104:107], v[76:79]
ds_read_b128 a[12:15], v3 offset:2048
v_mfma_f32_16x16x32_bf16 v[76:79], a[132:135], a[108:111], v[76:79]
ds_read_b128 a[16:19], v2 offset:4096
v_mfma_f32_16x16x32_bf16 v[84:87], a[128:131], a[112:115], v[84:87]
ds_read_b128 a[20:23], v3 offset:4096
v_mfma_f32_16x16x32_bf16 v[84:87], a[132:135], a[116:119], v[84:87]
buffer_load_dwordx4 v19, s[12:15], s27 offen offset:3072 lds
v_mfma_f32_16x16x32_bf16 v[92:95], a[128:131], a[120:123], v[92:95]
s_add_u32 s27, s27, 524288
ds_read_b128 a[24:27], v2 offset:6144
v_mfma_f32_16x16x32_bf16 v[92:95], a[132:135], a[124:127], v[92:95]
s_waitcnt lgkmcnt(5)
buffer_store_dwordx4 v[208:211], v1, s[4:7], s31 offen sc1
v_mfma_f32_16x16x32_bf16 v[100:103], a[136:139], a[64:67], v[100:103]
s_add_u32 s31, s31, s32
ds_read_b64_tr_b16 a[128:129], v24 offset:0
v_mfma_f32_16x16x32_bf16 v[100:103], a[140:143], a[68:71], v[100:103]
v_mfma_f32_16x16x32_bf16 v[108:111], a[136:139], a[72:75], v[108:111]
ds_read_b64_tr_b16 a[130:131], v24 offset:2048
v_mfma_f32_16x16x32_bf16 v[108:111], a[140:143], a[76:79], v[108:111]
ds_read_b128 a[28:31], v3 offset:6144
v_mfma_f32_16x16x32_bf16 v[116:119], a[136:139], a[80:83], v[116:119]
ds_read_b64_tr_b16 a[132:133], v24 offset:16384
v_mfma_f32_16x16x32_bf16 v[116:119], a[140:143], a[84:87], v[116:119]
v_mfma_f32_16x16x32_bf16 v[124:127], a[136:139], a[88:91], v[124:127]
ds_read_b64_tr_b16 a[134:135], v24 offset:18432
v_add_u32 v24, 4294901760, v24
v_mfma_f32_16x16x32_bf16 v[124:127], a[140:143], a[92:95], v[124:127]
v_mfma_f32_16x16x32_bf16 v[132:135], a[136:139], a[96:99], v[132:135]
ds_read_b128 a[32:35], v2 offset:8192
v_mfma_f32_16x16x32_bf16 v[132:135], a[140:143], a[100:103], v[132:135]
buffer_store_dwordx4 v[216:219], v1, s[4:7], s31 offen sc1
v_mfma_f32_16x16x32_bf16 v[140:143], a[136:139], a[104:107], v[140:143]
s_add_u32 s31, s31, s35
ds_read_b128 a[36:39], v3 offset:8192
v_mfma_f32_16x16x32_bf16 v[140:143], a[140:143], a[108:111], v[140:143]
ds_read_b128 a[40:43], v2 offset:10240
v_mfma_f32_16x16x32_bf16 v[148:151], a[136:139], a[112:115], v[148:151]
ds_read_b128 a[44:47], v3 offset:10240
v_mfma_f32_16x16x32_bf16 v[148:151], a[140:143], a[116:119], v[148:151]
v_mfma_f32_16x16x32_bf16 v[156:159], a[136:139], a[120:123], v[156:159]
ds_read_b128 a[48:51], v2 offset:12288
v_mfma_f32_16x16x32_bf16 v[156:159], a[140:143], a[124:127], v[156:159]
s_waitcnt lgkmcnt(5)
v_mfma_f32_16x16x32_bf16 v[164:167], a[128:131], a[64:67], v[164:167]
ds_read_b64_tr_b16 a[136:137], v25 offset:0
v_mfma_f32_16x16x32_bf16 v[164:167], a[132:135], a[68:71], v[164:167]
v_mfma_f32_16x16x32_bf16 v[172:175], a[128:131], a[72:75], v[172:175]
ds_read_b64_tr_b16 a[138:139], v25 offset:2048
v_mfma_f32_16x16x32_bf16 v[172:175], a[132:135], a[76:79], v[172:175]
ds_read_b128 a[52:55], v3 offset:12288
v_mfma_f32_16x16x32_bf16 v[180:183], a[128:131], a[80:83], v[180:183]
ds_read_b64_tr_b16 a[140:141], v25 offset:16384
v_mfma_f32_16x16x32_bf16 v[180:183], a[132:135], a[84:87], v[180:183]
buffer_store_dwordx4 v[32:35], v1, s[4:7], s31 offen sc1
v_mfma_f32_16x16x32_bf16 v[188:191], a[128:131], a[88:91], v[188:191]
s_add_u32 s31, s31, s32
ds_read_b64_tr_b16 a[142:143], v25 offset:18432
v_add_u32 v25, 4294901760, v25
v_mfma_f32_16x16x32_bf16 v[188:191], a[132:135], a[92:95], v[188:191]
v_mfma_f32_16x16x32_bf16 v[196:199], a[128:131], a[96:99], v[196:199]
ds_read_b128 a[56:59], v2 offset:14336
v_mfma_f32_16x16x32_bf16 v[196:199], a[132:135], a[100:103], v[196:199]
v_mfma_f32_16x16x32_bf16 v[204:207], a[128:131], a[104:107], v[204:207]
ds_read_b128 a[60:63], v3 offset:14336
v_mfma_f32_16x16x32_bf16 v[204:207], a[132:135], a[108:111], v[204:207]
v_mfma_f32_16x16x32_bf16 v[212:215], a[128:131], a[112:115], v[212:215]
v_mfma_f32_16x16x32_bf16 v[212:215], a[132:135], a[116:119], v[212:215]
v_mfma_f32_16x16x32_bf16 v[220:223], a[128:131], a[120:123], v[220:223]
v_mfma_f32_16x16x32_bf16 v[220:223], a[132:135], a[124:127], v[220:223]
s_waitcnt vmcnt(20) lgkmcnt(0)
s_barrier
v_mfma_f32_16x16x32_bf16 v[224:227], a[136:139], a[64:67], v[224:227]
s_add_u32 m0, s29, 131072
ds_read_b64_tr_b16 a[128:129], v22 offset:0
v_mfma_f32_16x16x32_bf16 v[224:227], a[140:143], a[68:71], v[224:227]
buffer_load_dwordx4 v16, s[12:15], s26 offen offset:0 lds
v_mfma_f32_16x16x32_bf16 v[228:231], a[136:139], a[72:75], v[228:231]
ds_read_b64_tr_b16 a[130:131], v22 offset:2048
v_mfma_f32_16x16x32_bf16 v[228:231], a[140:143], a[76:79], v[228:231]
buffer_store_dwordx4 v[40:43], v1, s[4:7], s31 offen sc1
v_mfma_f32_16x16x32_bf16 v[232:235], a[136:139], a[80:83], v[232:235]
s_add_u32 s31, s31, s33
ds_read_b64_tr_b16 a[132:133], v22 offset:16384
v_mfma_f32_16x16x32_bf16 v[232:235], a[140:143], a[84:87], v[232:235]
buffer_load_dwordx4 v17, s[12:15], s26 offen offset:1024 lds
v_mfma_f32_16x16x32_bf16 v[236:239], a[136:139], a[88:91], v[236:239]
ds_read_b64_tr_b16 a[134:135], v22 offset:18432
v_add_u32 v22, 32768, v22
v_mfma_f32_16x16x32_bf16 v[236:239], a[140:143], a[92:95], v[236:239]
PAD_7:
s_cbranch_execz M_tret
v_mfma_f32_16x16x32_bf16 v[240:243], a[136:139], a[96:99], v[240:243]
v_mfma_f32_16x16x32_bf16 v[240:243], a[140:143], a[100:103], v[240:243]
buffer_load_dwordx4 v18, s[12:15], s26 offen offset:2048 lds
v_mfma_f32_16x16x32_bf16 v[244:247], a[136:139], a[104:107], v[244:247]
v_mfma_f32_16x16x32_bf16 v[244:247], a[140:143], a[108:111], v[244:247]
v_mfma_f32_16x16x32_bf16 v[248:251], a[136:139], a[112:115], v[248:251]
v_mfma_f32_16x16x32_bf16 v[248:251], a[140:143], a[116:119], v[248:251]
buffer_load_dwordx4 v19, s[12:15], s26 offen offset:3072 lds
v_mfma_f32_16x16x32_bf16 v[252:255], a[136:139], a[120:123], v[252:255]
s_add_u32 s26, s26, 524288
v_mfma_f32_16x16x32_bf16 v[252:255], a[140:143], a[124:127], v[252:255]
s_waitcnt lgkmcnt(0)
v_mfma_f32_16x16x32_bf16 v[36:39], a[128:131], a[0:3], v[36:39]
s_add_u32 m0, s29, 147456
ds_read_b64_tr_b16 a[136:137], v23 offset:0
v_mfma_f32_16x16x32_bf16 v[36:39], a[132:135], a[4:7], v[36:39]
buffer_load_dwordx4 v16, s[12:15], s27 offen offset:0 lds
v_mfma_f32_16x16x32_bf16 v[44:47], a[128:131], a[8:11], v[44:47]
s_lshl_b32 s22, s20, 7
ds_read_b64_tr_b16 a[138:139], v23 offset:2048
v_bfe_u32 v20, v1, 4, 3
v_mfma_f32_16x16x32_bf16 v[44:47], a[132:135], a[12:15], v[44:47]
s_add_u32 s70, s22, 94371840
ds_read_b128 a[64:67], v2 offset:16384
ds_read_b128 a[68:71], v3 offset:16384
v_mfma_f32_16x16x32_bf16 v[52:55], a[128:131], a[16:19], v[52:55]
s_lshr_b32 s22, s2, 4
ds_read_b64_tr_b16 a[140:141], v23 offset:16384
v_lshlrev_b32 v20, 3, v20
v_mfma_f32_16x16x32_bf16 v[52:55], a[132:135], a[20:23], v[52:55]
s_lshl_b32 s22, s22, 2
buffer_load_dwordx4 v17, s[12:15], s27 offen offset:1024 lds
v_mfma_f32_16x16x32_bf16 v[60:63], a[128:131], a[24:27], v[60:63]
s_add_u32 s66, s70, s22
ds_read_b64_tr_b16 a[142:143], v23 offset:18432
v_add_u32 v23, 32768, v23
v_mfma_f32_16x16x32_bf16 v[60:63], a[132:135], a[28:31], v[60:63]
s_and_b32 s22, s2, 16
buffer_store_dwordx4 v[48:51], v1, s[4:7], s31 offen sc1
v_mfma_f32_16x16x32_bf16 v[68:71], a[128:131], a[32:35], v[68:71]
s_add_u32 s31, s31, s32
ds_read_b128 a[72:75], v2 offset:18432
v_add_u32 v15, 2052, v20
v_mfma_f32_16x16x32_bf16 v[68:71], a[132:135], a[36:39], v[68:71]
s_lshl_b32 s22, s22, 7
buffer_load_dwordx4 v18, s[12:15], s27 offen offset:2048 lds
v_mfma_f32_16x16x32_bf16 v[76:79], a[128:131], a[40:43], v[76:79]
s_add_u32 s66, s66, s22
ds_read_b128 a[76:79], v3 offset:18432
v_mfma_f32_16x16x32_bf16 v[76:79], a[132:135], a[44:47], v[76:79]
s_lshl_b32 s67, s20, 20
ds_read_b128 a[80:83], v2 offset:20480
v_mfma_f32_16x16x32_bf16 v[84:87], a[128:131], a[48:51], v[84:87]
s_lshl_b32 s22, s37, 16
ds_read_b128 a[84:87], v3 offset:20480
v_mfma_f32_16x16x32_bf16 v[84:87], a[132:135], a[52:55], v[84:87]
s_add_u32 s67, s67, s22
buffer_load_dwordx4 v19, s[12:15], s27 offen offset:3072 lds
v_mfma_f32_16x16x32_bf16 v[92:95], a[128:131], a[56:59], v[92:95]
s_waitcnt lgkmcnt(5)
s_add_u32 s27, s27, 524288
ds_read_b128 a[88:91], v2 offset:22528
v_mfma_f32_16x16x32_bf16 v[92:95], a[132:135], a[60:63], v[92:95]
s_lshl_b32 s22, s3, 11
buffer_store_dwordx4 v[56:59], v1, s[4:7], s31 offen sc1
v_mfma_f32_16x16x32_bf16 v[100:103], a[136:139], a[0:3], v[100:103]
s_waitcnt lgkmcnt(5)
s_add_u32 s31, s31, s34
ds_read_b64_tr_b16 a[128:129], v24 offset:0
v_mfma_f32_16x16x32_bf16 v[100:103], a[140:143], a[4:7], v[100:103]
s_add_u32 s67, s67, s22
v_mfma_f32_16x16x32_bf16 v[108:111], a[136:139], a[8:11], v[108:111]
s_add_u32 s67, s67, 33554432
ds_read_b64_tr_b16 a[130:131], v24 offset:2048
v_mfma_f32_16x16x32_bf16 v[108:111], a[140:143], a[12:15], v[108:111]
s_mov_b32 s68, 1035512379
ds_read_b128 a[92:95], v3 offset:22528
v_mfma_f32_16x16x32_bf16 v[116:119], a[136:139], a[16:19], v[116:119]
s_mov_b32 s69, 1035512379
ds_read_b64_tr_b16 a[132:133], v24 offset:16384
v_mfma_f32_16x16x32_bf16 v[116:119], a[140:143], a[20:23], v[116:119]
buffer_store_dwordx4 v[64:67], v1, s[4:7], s31 offen sc1
v_mfma_f32_16x16x32_bf16 v[124:127], a[136:139], a[24:27], v[124:127]
s_add_u32 s31, s31, s32
ds_read_b64_tr_b16 a[134:135], v24 offset:18432
v_add_u32 v24, 32768, v24
v_mfma_f32_16x16x32_bf16 v[124:127], a[140:143], a[28:31], v[124:127]
v_mfma_f32_16x16x32_bf16 v[132:135], a[136:139], a[32:35], v[132:135]
ds_read_b128 a[96:99], v2 offset:24576
v_mfma_f32_16x16x32_bf16 v[132:135], a[140:143], a[36:39], v[132:135]
v_mfma_f32_16x16x32_bf16 v[140:143], a[136:139], a[40:43], v[140:143]
ds_read_b128 a[100:103], v3 offset:24576
v_mfma_f32_16x16x32_bf16 v[140:143], a[140:143], a[44:47], v[140:143]
ds_read_b128 a[104:107], v2 offset:26624
v_mfma_f32_16x16x32_bf16 v[148:151], a[136:139], a[48:51], v[148:151]
ds_read_b128 a[108:111], v3 offset:26624
v_mfma_f32_16x16x32_bf16 v[148:151], a[140:143], a[52:55], v[148:151]
v_mfma_f32_16x16x32_bf16 v[156:159], a[136:139], a[56:59], v[156:159]
ds_read_b128 a[112:115], v2 offset:28672
v_mfma_f32_16x16x32_bf16 v[156:159], a[140:143], a[60:63], v[156:159]
s_waitcnt lgkmcnt(5)
buffer_store_dwordx4 v[72:75], v1, s[4:7], s31 offen sc1
v_mfma_f32_16x16x32_bf16 v[164:167], a[128:131], a[0:3], v[164:167]
s_add_u32 s31, s31, s33
ds_read_b64_tr_b16 a[136:137], v25 offset:0
v_mfma_f32_16x16x32_bf16 v[164:167], a[132:135], a[4:7], v[164:167]
v_mfma_f32_16x16x32_bf16 v[172:175], a[128:131], a[8:11], v[172:175]
ds_read_b64_tr_b16 a[138:139], v25 offset:2048
v_mfma_f32_16x16x32_bf16 v[172:175], a[132:135], a[12:15], v[172:175]
ds_read_b128 a[116:119], v3 offset:28672
v_mfma_f32_16x16x32_bf16 v[180:183], a[128:131], a[16:19], v[180:183]
ds_read_b64_tr_b16 a[140:141], v25 offset:16384
v_mfma_f32_16x16x32_bf16 v[180:183], a[132:135], a[20:23], v[180:183]
v_mfma_f32_16x16x32_bf16 v[188:191], a[128:131], a[24:27], v[188:191]
ds_read_b64_tr_b16 a[142:143], v25 offset:18432
v_add_u32 v25, 32768, v25
v_mfma_f32_16x16x32_bf16 v[188:191], a[132:135], a[28:31], v[188:191]
v_mfma_f32_16x16x32_bf16 v[196:199], a[128:131], a[32:35], v[196:199]
ds_read_b128 a[120:123], v2 offset:30720
v_mfma_f32_16x16x32_bf16 v[196:199], a[132:135], a[36:39], v[196:199]
buffer_store_dwordx4 v[80:83], v1, s[4:7], s31 offen sc1
v_mfma_f32_16x16x32_bf16 v[204:207], a[128:131], a[40:43], v[204:207]
s_add_u32 s31, s31, s32
ds_read_b128 a[124:127], v3 offset:30720
v_mfma_f32_16x16x32_bf16 v[204:207], a[132:135], a[44:47], v[204:207]
v_mfma_f32_16x16x32_bf16 v[212:215], a[128:131], a[48:51], v[212:215]
v_mfma_f32_16x16x32_bf16 v[212:215], a[132:135], a[52:55], v[212:215]
v_mfma_f32_16x16x32_bf16 v[220:223], a[128:131], a[56:59], v[220:223]
v_mfma_f32_16x16x32_bf16 v[220:223], a[132:135], a[60:63], v[220:223]
s_waitcnt vmcnt(17) lgkmcnt(0)
s_barrier
v_mfma_f32_16x16x32_bf16 v[224:227], a[136:139], a[0:3], v[224:227]
ds_read_b64_tr_b16 a[128:129], v22 offset:0
v_mfma_f32_16x16x32_bf16 v[224:227], a[140:143], a[4:7], v[224:227]
v_mfma_f32_16x16x32_bf16 v[228:231], a[136:139], a[8:11], v[228:231]
ds_read_b64_tr_b16 a[130:131], v22 offset:2048
v_mfma_f32_16x16x32_bf16 v[228:231], a[140:143], a[12:15], v[228:231]
buffer_store_dwordx4 v[88:91], v1, s[4:7], s31 offen sc1
v_mfma_f32_16x16x32_bf16 v[232:235], a[136:139], a[16:19], v[232:235]
ds_read_b64_tr_b16 a[132:133], v22 offset:16384
v_mfma_f32_16x16x32_bf16 v[232:235], a[140:143], a[20:23], v[232:235]
v_mfma_f32_16x16x32_bf16 v[236:239], a[136:139], a[24:27], v[236:239]
ds_read_b64_tr_b16 a[134:135], v22 offset:18432
v_add_u32 v22, 32768, v22
v_mfma_f32_16x16x32_bf16 v[236:239], a[140:143], a[28:31], v[236:239]
v_mfma_f32_16x16x32_bf16 v[240:243], a[136:139], a[32:35], v[240:243]
v_mfma_f32_16x16x32_bf16 v[240:243], a[140:143], a[36:39], v[240:243]
v_mfma_f32_16x16x32_bf16 v[244:247], a[136:139], a[40:43], v[244:247]
v_mfma_f32_16x16x32_bf16 v[244:247], a[140:143], a[44:47], v[244:247]
v_mfma_f32_16x16x32_bf16 v[248:251], a[136:139], a[48:51], v[248:251]
v_mfma_f32_16x16x32_bf16 v[248:251], a[140:143], a[52:55], v[248:251]
v_mfma_f32_16x16x32_bf16 v[252:255], a[136:139], a[56:59], v[252:255]
v_mfma_f32_16x16x32_bf16 v[252:255], a[140:143], a[60:63], v[252:255]
s_waitcnt lgkmcnt(0)
v_mfma_f32_16x16x32_bf16 v[36:39], a[128:131], a[64:67], v[36:39]
ds_read_b64_tr_b16 a[136:137], v23 offset:0
v_mfma_f32_16x16x32_bf16 v[36:39], a[132:135], a[68:71], v[36:39]
v_mfma_f32_16x16x32_bf16 v[44:47], a[128:131], a[72:75], v[44:47]
ds_read_b64_tr_b16 a[138:139], v23 offset:2048
v_mfma_f32_16x16x32_bf16 v[44:47], a[132:135], a[76:79], v[44:47]
ds_read_b128 a[0:3], v2 offset:32768
ds_read_b128 a[4:7], v3 offset:32768
v_mfma_f32_16x16x32_bf16 v[52:55], a[128:131], a[80:83], v[52:55]
ds_read_b64_tr_b16 a[140:141], v23 offset:16384
v_mfma_f32_16x16x32_bf16 v[52:55], a[132:135], a[84:87], v[52:55]
v_mfma_f32_16x16x32_bf16 v[60:63], a[128:131], a[88:91], v[60:63]
ds_read_b64_tr_b16 a[142:143], v23 offset:18432
v_add_u32 v23, 32768, v23
v_mfma_f32_16x16x32_bf16 v[60:63], a[132:135], a[92:95], v[60:63]
v_mfma_f32_16x16x32_bf16 v[68:71], a[128:131], a[96:99], v[68:71]
ds_read_b128 a[8:11], v2 offset:34816
v_mfma_f32_16x16x32_bf16 v[68:71], a[132:135], a[100:103], v[68:71]
v_mfma_f32_16x16x32_bf16 v[76:79], a[128:131], a[104:107], v[76:79]
ds_read_b128 a[12:15], v3 offset:34816
v_mfma_f32_16x16x32_bf16 v[76:79], a[132:135], a[108:111], v[76:79]
ds_read_b128 a[16:19], v2 offset:36864
v_mfma_f32_16x16x32_bf16 v[84:87], a[128:131], a[112:115], v[84:87]
ds_read_b128 a[20:23], v3 offset:36864
v_mfma_f32_16x16x32_bf16 v[84:87], a[132:135], a[116:119], v[84:87]
v_mfma_f32_16x16x32_bf16 v[92:95], a[128:131], a[120:123], v[92:95]
ds_read_b128 a[24:27], v2 offset:38912
v_mfma_f32_16x16x32_bf16 v[92:95], a[132:135], a[124:127], v[92:95]
s_waitcnt lgkmcnt(5)
v_mfma_f32_16x16x32_bf16 v[100:103], a[136:139], a[64:67], v[100:103]
ds_read_b64_tr_b16 a[128:129], v24 offset:0
v_mfma_f32_16x16x32_bf16 v[100:103], a[140:143], a[68:71], v[100:103]
v_mfma_f32_16x16x32_bf16 v[108:111], a[136:139], a[72:75], v[108:111]
ds_read_b64_tr_b16 a[130:131], v24 offset:2048
v_mfma_f32_16x16x32_bf16 v[108:111], a[140:143], a[76:79], v[108:111]
ds_read_b128 a[28:31], v3 offset:38912
v_mfma_f32_16x16x32_bf16 v[116:119], a[136:139], a[80:83], v[116:119]
ds_read_b64_tr_b16 a[132:133], v24 offset:16384
v_mfma_f32_16x16x32_bf16 v[116:119], a[140:143], a[84:87], v[116:119]
v_mfma_f32_16x16x32_bf16 v[124:127], a[136:139], a[88:91], v[124:127]
ds_read_b64_tr_b16 a[134:135], v24 offset:18432
v_add_u32 v24, 32768, v24
v_mfma_f32_16x16x32_bf16 v[124:127], a[140:143], a[92:95], v[124:127]
v_mfma_f32_16x16x32_bf16 v[132:135], a[136:139], a[96:99], v[132:135]
ds_read_b128 a[32:35], v2 offset:40960
v_mfma_f32_16x16x32_bf16 v[132:135], a[140:143], a[100:103], v[132:135]
v_mfma_f32_16x16x32_bf16 v[140:143], a[136:139], a[104:107], v[140:143]
ds_read_b128 a[36:39], v3 offset:40960
v_mfma_f32_16x16x32_bf16 v[140:143], a[140:143], a[108:111], v[140:143]
ds_read_b128 a[40:43], v2 offset:43008
v_mfma_f32_16x16x32_bf16 v[148:151], a[136:139], a[112:115], v[148:151]
ds_read_b128 a[44:47], v3 offset:43008
v_mfma_f32_16x16x32_bf16 v[148:151], a[140:143], a[116:119], v[148:151]
v_mfma_f32_16x16x32_bf16 v[156:159], a[136:139], a[120:123], v[156:159]
ds_read_b128 a[48:51], v2 offset:45056
v_mfma_f32_16x16x32_bf16 v[156:159], a[140:143], a[124:127], v[156:159]
s_waitcnt lgkmcnt(5)
v_mfma_f32_16x16x32_bf16 v[164:167], a[128:131], a[64:67], v[164:167]
ds_read_b64_tr_b16 a[136:137], v25 offset:0
v_mfma_f32_16x16x32_bf16 v[164:167], a[132:135], a[68:71], v[164:167]
v_mfma_f32_16x16x32_bf16 v[172:175], a[128:131], a[72:75], v[172:175]
ds_read_b64_tr_b16 a[138:139], v25 offset:2048
v_mfma_f32_16x16x32_bf16 v[172:175], a[132:135], a[76:79], v[172:175]
ds_read_b128 a[52:55], v3 offset:45056
v_mfma_f32_16x16x32_bf16 v[180:183], a[128:131], a[80:83], v[180:183]
ds_read_b64_tr_b16 a[140:141], v25 offset:16384
v_mfma_f32_16x16x32_bf16 v[180:183], a[132:135], a[84:87], v[180:183]
v_mfma_f32_16x16x32_bf16 v[188:191], a[128:131], a[88:91], v[188:191]
ds_read_b64_tr_b16 a[142:143], v25 offset:18432
v_add_u32 v25, 32768, v25
v_mfma_f32_16x16x32_bf16 v[188:191], a[132:135], a[92:95], v[188:191]
v_mfma_f32_16x16x32_bf16 v[196:199], a[128:131], a[96:99], v[196:199]
ds_read_b128 a[56:59], v2 offset:47104
v_mfma_f32_16x16x32_bf16 v[196:199], a[132:135], a[100:103], v[196:199]
v_mfma_f32_16x16x32_bf16 v[204:207], a[128:131], a[104:107], v[204:207]
ds_read_b128 a[60:63], v3 offset:47104
v_mfma_f32_16x16x32_bf16 v[204:207], a[132:135], a[108:111], v[204:207]
v_mfma_f32_16x16x32_bf16 v[212:215], a[128:131], a[112:115], v[212:215]
v_mfma_f32_16x16x32_bf16 v[212:215], a[132:135], a[116:119], v[212:215]
v_mfma_f32_16x16x32_bf16 v[220:223], a[128:131], a[120:123], v[220:223]
v_mfma_f32_16x16x32_bf16 v[220:223], a[132:135], a[124:127], v[220:223]
s_waitcnt vmcnt(0) lgkmcnt(0)
s_barrier
v_mfma_f32_16x16x32_bf16 v[224:227], a[136:139], a[64:67], v[224:227]
ds_read_b64_tr_b16 a[128:129], v22 offset:0
v_mfma_f32_16x16x32_bf16 v[224:227], a[140:143], a[68:71], v[224:227]
buffer_store_dword v27, v26, s[4:7], s66 offen sc1
v_mfma_f32_16x16x32_bf16 v[228:231], a[136:139], a[72:75], v[228:231]
ds_read_b64_tr_b16 a[130:131], v22 offset:2048
v_mfma_f32_16x16x32_bf16 v[228:231], a[140:143], a[76:79], v[228:231]
v_mfma_f32_16x16x32_bf16 v[232:235], a[136:139], a[80:83], v[232:235]
ds_read_b64_tr_b16 a[132:133], v22 offset:16384
v_mfma_f32_16x16x32_bf16 v[232:235], a[140:143], a[84:87], v[232:235]
v_mfma_f32_16x16x32_bf16 v[236:239], a[136:139], a[88:91], v[236:239]
ds_read_b64_tr_b16 a[134:135], v22 offset:18432
v_mfma_f32_16x16x32_bf16 v[236:239], a[140:143], a[92:95], v[236:239]
v_mfma_f32_16x16x32_bf16 v[240:243], a[136:139], a[96:99], v[240:243]
v_mfma_f32_16x16x32_bf16 v[240:243], a[140:143], a[100:103], v[240:243]
v_mfma_f32_16x16x32_bf16 v[244:247], a[136:139], a[104:107], v[244:247]
v_mfma_f32_16x16x32_bf16 v[244:247], a[140:143], a[108:111], v[244:247]
v_mfma_f32_16x16x32_bf16 v[248:251], a[136:139], a[112:115], v[248:251]
v_mfma_f32_16x16x32_bf16 v[248:251], a[140:143], a[116:119], v[248:251]
v_mfma_f32_16x16x32_bf16 v[252:255], a[136:139], a[120:123], v[252:255]
v_mfma_f32_16x16x32_bf16 v[252:255], a[140:143], a[124:127], v[252:255]
s_waitcnt lgkmcnt(0)
v_mfma_f32_16x16x32_bf16 v[36:39], a[128:131], a[0:3], v[36:39]
s_lshl_b32 s18, s3, 13
ds_read_b64_tr_b16 a[136:137], v23 offset:0
v_lshrrev_b32 v28, 6, v0
v_mfma_f32_16x16x32_bf16 v[36:39], a[132:135], a[4:7], v[36:39]
s_lshl_b32 s30, s20, 20
v_lshl_add_u32 v28, v28, 11, v1
v_add_u32 v28, 65536, v28
v_mfma_f32_16x16x32_bf16 v[44:47], a[128:131], a[8:11], v[44:47]
s_add_u32 s30, s30, s18
ds_read_b64_tr_b16 a[138:139], v23 offset:2048
v_lshrrev_b32 v3, 6, v0
v_mfma_f32_16x16x32_bf16 v[44:47], a[132:135], a[12:15], v[44:47]
s_lshl_b32 s22, s21, 1
v_and_b32 v4, 63, v0
v_add_u32 v2, 0x10000, v1
v_mfma_f32_16x16x32_bf16 v[52:55], a[128:131], a[16:19], v[52:55]
s_and_b32 s84, s2, 1
ds_read_b64_tr_b16 a[140:141], v23 offset:16384
v_and_b32 v5, 15, v4
v_mfma_f32_16x16x32_bf16 v[52:55], a[132:135], a[20:23], v[52:55]
s_mul_i32 s84, s84, 0
v_lshrrev_b32 v6, 4, v4
v_lshlrev_b32 v6, 2, v6
v_mfma_f32_16x16x32_bf16 v[60:63], a[128:131], a[24:27], v[60:63]
s_add_u32 s84, s84, 2386092
ds_read_b64_tr_b16 a[142:143], v23 offset:18432
v_sub_u32 v5, v5, v6
v_mfma_f32_16x16x32_bf16 v[60:63], a[132:135], a[28:31], v[60:63]
s_lshl_b32 s85, s21, 2
v_lshl_add_u32 v5, v3, 4, v5
v_cmp_gt_i32 s[32:33], 0, v5
v_mfma_f32_16x16x32_bf16 v[68:71], a[128:131], a[32:35], v[68:71]
s_lshr_b32 s85, s84, s85
v_cmp_gt_i32 s[34:35], 1, v5
v_cmp_gt_i32 s[36:37], 2, v5
v_mfma_f32_16x16x32_bf16 v[68:71], a[132:135], a[36:39], v[68:71]
s_and_b32 s9, s85, 15
v_cmp_gt_i32 s[38:39], 3, v5
v_cmp_gt_i32 s[40:41], 16, v5
v_mfma_f32_16x16x32_bf16 v[76:79], a[128:131], a[40:43], v[76:79]
s_and_b32 s84, s85, 1
v_cmp_gt_i32 s[42:43], 17, v5
v_cmp_gt_i32 s[44:45], 18, v5
v_mfma_f32_16x16x32_bf16 v[76:79], a[132:135], a[44:47], v[76:79]
s_lshl_b32 s84, s84, 17
v_cmp_gt_i32 s[46:47], 19, v5
v_cmp_gt_i32 s[48:49], 32, v5
v_mfma_f32_16x16x32_bf16 v[84:87], a[128:131], a[48:51], v[84:87]
s_add_u32 s84, s84, s18
v_cmp_gt_i32 s[50:51], 33, v5
v_cmp_gt_i32 s[52:53], 34, v5
v_mfma_f32_16x16x32_bf16 v[84:87], a[132:135], a[52:55], v[84:87]
s_xor_b32 s85, s84, 0x20000
v_cmp_gt_i32 s[54:55], 35, v5
v_cmp_gt_i32 s[56:57], 48, v5
v_mfma_f32_16x16x32_bf16 v[92:95], a[128:131], a[56:59], v[92:95]
s_sub_u32 s29, 15, s21
v_cmp_gt_i32 s[58:59], 49, v5
v_cmp_gt_i32 s[60:61], 50, v5
v_mfma_f32_16x16x32_bf16 v[92:95], a[132:135], a[60:63], v[92:95]
s_waitcnt lgkmcnt(0)
v_cmp_gt_i32 s[62:63], 51, v5
v_mov_b32 v7, 0xff800000
v_mfma_f32_16x16x32_bf16 v[100:103], a[136:139], a[0:3], v[100:103]
s_cmp_lg_u32 s9, 0
ds_read_b64_tr_b16 a[128:129], v24 offset:0
v_mov_b32 v6, 1
v_mfma_f32_16x16x32_bf16 v[100:103], a[140:143], a[4:7], v[100:103]
s_cselect_b32 s24, 1, 0
v_mov_b32 v5, v26
v_add_u32 v4, 0x20000, v1
v_mfma_f32_16x16x32_bf16 v[108:111], a[136:139], a[8:11], v[108:111]
s_cselect_b32 s67, s67, 3221225472
ds_read_b64_tr_b16 a[130:131], v24 offset:2048
v_mfma_f32_16x16x32_bf16 v[108:111], a[140:143], a[12:15], v[108:111]
s_lshl_b32 s8, s9, 15
v_mfma_f32_16x16x32_bf16 v[116:119], a[136:139], a[16:19], v[116:119]
s_add_u32 s8, s8, s30
ds_read_b64_tr_b16 a[132:133], v24 offset:16384
v_mfma_f32_16x16x32_bf16 v[116:119], a[140:143], a[20:23], v[116:119]
s_add_u32 s9, s9, s22
v_mfma_f32_16x16x32_bf16 v[124:127], a[136:139], a[24:27], v[124:127]
s_sub_u32 s9, 32, s9
ds_read_b64_tr_b16 a[134:135], v24 offset:18432
v_mul_f32 v36, s68, v36
v_mfma_f32_16x16x32_bf16 v[124:127], a[140:143], a[28:31], v[124:127]
s_bitcmp1_b32 s2, 4
v_mul_f32 v37, s68, v37
v_mul_f32 v38, s68, v38
v_mfma_f32_16x16x32_bf16 v[132:135], a[136:139], a[32:35], v[132:135]
s_cselect_b32 s9, 16, s9
v_mul_f32 v39, s68, v39
v_mul_f32 v100, s68, v100
v_mfma_f32_16x16x32_bf16 v[132:135], a[140:143], a[36:39], v[132:135]
s_cselect_b32 s29, 7, s29
v_mul_f32 v101, s68, v101
v_mul_f32 v102, s68, v102
v_mfma_f32_16x16x32_bf16 v[140:143], a[136:139], a[40:43], v[140:143]
s_mov_b32 s10, 3221225472
v_mul_f32 v103, s68, v103
v_cvt_pk_bf16_f32 v36, v36, v37
v_mfma_f32_16x16x32_bf16 v[140:143], a[140:143], a[44:47], v[140:143]
s_mov_b32 s14, 3221225472
v_cvt_pk_bf16_f32 v37, v38, v39
v_cvt_pk_bf16_f32 v38, v100, v101
v_mfma_f32_16x16x32_bf16 v[148:151], a[136:139], a[48:51], v[148:151]
s_mov_b32 s11, 0
v_cvt_pk_bf16_f32 v39, v102, v103
v_mul_f32 v44, s68, v44
v_mfma_f32_16x16x32_bf16 v[148:151], a[140:143], a[52:55], v[148:151]
s_lshr_b32 s19, s9, 1
ds_write_b128 v28, v[36:39] offset:0
v_mul_f32 v45, s68, v45
v_mfma_f32_16x16x32_bf16 v[156:159], a[136:139], a[56:59], v[156:159]
s_sub_u32 s19, s19, 1
s_add_u32 s23, s67, 0
buffer_store_dwordx4 v[36:39], v1, s[4:7], s23 offen offset:0 sc1
v_mfma_f32_16x16x32_bf16 v[156:159], a[140:143], a[60:63], v[156:159]
s_waitcnt lgkmcnt(1)
v_mul_f32 v46, s68, v46
v_mul_f32 v47, s68, v47
v_mfma_f32_16x16x32_bf16 v[164:167], a[128:131], a[0:3], v[164:167]
s_add_u32 s12, s8, 16777216
ds_read_b64_tr_b16 a[136:137], v25 offset:0
v_mul_f32 v108, s68, v108
v_mfma_f32_16x16x32_bf16 v[164:167], a[132:135], a[4:7], v[164:167]
s_mov_b32 s13, s9
v_mul_f32 v109, s68, v109
v_mul_f32 v110, s68, v110
v_mfma_f32_16x16x32_bf16 v[172:175], a[128:131], a[8:11], v[172:175]
s_mov_b32 s15, s11
ds_read_b64_tr_b16 a[138:139], v25 offset:2048
v_mul_f32 v111, s68, v111
v_mfma_f32_16x16x32_bf16 v[172:175], a[132:135], a[12:15], v[172:175]
v_cvt_pk_bf16_f32 v44, v44, v45
v_cvt_pk_bf16_f32 v45, v46, v47
v_mfma_f32_16x16x32_bf16 v[180:183], a[128:131], a[16:19], v[180:183]
ds_read_b64_tr_b16 a[140:141], v25 offset:16384
v_cvt_pk_bf16_f32 v46, v108, v109
v_mfma_f32_16x16x32_bf16 v[180:183], a[132:135], a[20:23], v[180:183]
v_cvt_pk_bf16_f32 v47, v110, v111
v_mul_f32 v52, s68, v52
v_mfma_f32_16x16x32_bf16 v[188:191], a[128:131], a[24:27], v[188:191]
ds_read_b64_tr_b16 a[142:143], v25 offset:18432
v_mul_f32 v53, s68, v53
v_mfma_f32_16x16x32_bf16 v[188:191], a[132:135], a[28:31], v[188:191]
ds_write_b128 v28, v[44:47] offset:8192
v_mul_f32 v54, s68, v54
v_mfma_f32_16x16x32_bf16 v[196:199], a[128:131], a[32:35], v[196:199]
s_add_u32 s23, s67, 8192
buffer_store_dwordx4 v[44:47], v1, s[4:7], s23 offen offset:0 sc1
v_mfma_f32_16x16x32_bf16 v[196:199], a[132:135], a[36:39], v[196:199]
v_mul_f32 v55, s68, v55
v_mul_f32 v116, s68, v116
v_mfma_f32_16x16x32_bf16 v[204:207], a[128:131], a[40:43], v[204:207]
v_mul_f32 v117, s68, v117
v_mul_f32 v118, s68, v118
v_mfma_f32_16x16x32_bf16 v[204:207], a[132:135], a[44:47], v[204:207]
v_mul_f32 v119, s68, v119
v_cvt_pk_bf16_f32 v52, v52, v53
v_mfma_f32_16x16x32_bf16 v[212:215], a[128:131], a[48:51], v[212:215]
v_cvt_pk_bf16_f32 v53, v54, v55
v_cvt_pk_bf16_f32 v54, v116, v117
v_mfma_f32_16x16x32_bf16 v[212:215], a[132:135], a[52:55], v[212:215]
v_cvt_pk_bf16_f32 v55, v118, v119
v_mul_f32 v60, s68, v60
v_mfma_f32_16x16x32_bf16 v[220:223], a[128:131], a[56:59], v[220:223]
ds_write_b128 v28, v[52:55] offset:16384
v_mul_f32 v61, s68, v61
v_mfma_f32_16x16x32_bf16 v[220:223], a[132:135], a[60:63], v[220:223]
s_waitcnt lgkmcnt(0)
s_waitcnt lgkmcnt(0)
s_barrier
v_mfma_f32_16x16x32_bf16 v[224:227], a[136:139], a[0:3], v[224:227]
s_add_u32 s23, s67, 16384
buffer_store_dwordx4 v[52:55], v1, s[4:7], s23 offen offset:0 sc1
v_mfma_f32_16x16x32_bf16 v[224:227], a[140:143], a[4:7], v[224:227]
v_mul_f32 v62, s68, v62
v_mul_f32 v63, s68, v63
v_mfma_f32_16x16x32_bf16 v[228:231], a[136:139], a[8:11], v[228:231]
v_mul_f32 v124, s68, v124
v_mul_f32 v125, s68, v125
v_mfma_f32_16x16x32_bf16 v[228:231], a[140:143], a[12:15], v[228:231]
v_mul_f32 v126, s68, v126
v_mul_f32 v127, s68, v127
v_mfma_f32_16x16x32_bf16 v[232:235], a[136:139], a[16:19], v[232:235]
v_cvt_pk_bf16_f32 v60, v60, v61
v_cvt_pk_bf16_f32 v61, v62, v63
v_mfma_f32_16x16x32_bf16 v[232:235], a[140:143], a[20:23], v[232:235]
v_cvt_pk_bf16_f32 v62, v124, v125
v_cvt_pk_bf16_f32 v63, v126, v127
v_mfma_f32_16x16x32_bf16 v[236:239], a[136:139], a[24:27], v[236:239]
ds_write_b128 v28, v[60:63] offset:24576
v_mul_f32 v68, s68, v68
v_mfma_f32_16x16x32_bf16 v[236:239], a[140:143], a[28:31], v[236:239]
s_add_u32 s23, s67, 24576
buffer_store_dwordx4 v[60:63], v1, s[4:7], s23 offen offset:0 sc1
v_mfma_f32_16x16x32_bf16 v[240:243], a[136:139], a[32:35], v[240:243]
v_mul_f32 v69, s68, v69
v_mul_f32 v70, s68, v70
v_mfma_f32_16x16x32_bf16 v[240:243], a[140:143], a[36:39], v[240:243]
v_mul_f32 v71, s68, v71
v_mul_f32 v132, s68, v132
v_mfma_f32_16x16x32_bf16 v[244:247], a[136:139], a[40:43], v[244:247]
v_mul_f32 v133, s68, v133
v_mul_f32 v134, s68, v134
v_mfma_f32_16x16x32_bf16 v[244:247], a[140:143], a[44:47], v[244:247]
v_mul_f32 v135, s68, v135
v_cvt_pk_bf16_f32 v68, v68, v69
v_mfma_f32_16x16x32_bf16 v[248:251], a[136:139], a[48:51], v[248:251]
v_cvt_pk_bf16_f32 v69, v70, v71
v_cvt_pk_bf16_f32 v70, v132, v133
v_mfma_f32_16x16x32_bf16 v[248:251], a[140:143], a[52:55], v[248:251]
v_cvt_pk_bf16_f32 v71, v134, v135
v_mfma_f32_16x16x32_bf16 v[252:255], a[136:139], a[56:59], v[252:255]
ds_write_b128 v28, v[68:71] offset:32768
v_mfma_f32_16x16x32_bf16 v[252:255], a[140:143], a[60:63], v[252:255]
s_add_u32 s23, s67, 32768
buffer_store_dwordx4 v[68:71], v1, s[4:7], s23 offen offset:0 sc1
buffer_load_dword v21, v20, s[4:7], s70 offen sc1
v_pk_mul_f32 v[76:77], v[76:77], s[68:69]
v_pk_mul_f32 v[78:79], v[78:79], s[68:69]
v_pk_mul_f32 v[140:141], v[140:141], s[68:69]
v_pk_mul_f32 v[142:143], v[142:143], s[68:69]
v_cvt_pk_bf16_f32 v76, v76, v77
v_cvt_pk_bf16_f32 v77, v78, v79
v_cvt_pk_bf16_f32 v78, v140, v141
v_cvt_pk_bf16_f32 v79, v142, v143
ds_write_b128 v28, v[76:79] offset:40960
s_add_u32 s23, s67, 40960
buffer_store_dwordx4 v[76:79], v1, s[4:7], s23 offen offset:0 sc1
v_pk_mul_f32 v[84:85], v[84:85], s[68:69]
v_pk_mul_f32 v[86:87], v[86:87], s[68:69]
v_pk_mul_f32 v[148:149], v[148:149], s[68:69]
v_pk_mul_f32 v[150:151], v[150:151], s[68:69]
v_cvt_pk_bf16_f32 v84, v84, v85
v_cvt_pk_bf16_f32 v85, v86, v87
v_cvt_pk_bf16_f32 v86, v148, v149
v_cvt_pk_bf16_f32 v87, v150, v151
ds_write_b128 v28, v[84:87] offset:49152
s_add_u32 s23, s67, 49152
buffer_store_dwordx4 v[84:87], v1, s[4:7], s23 offen offset:0 sc1
v_pk_mul_f32 v[92:93], v[92:93], s[68:69]
v_pk_mul_f32 v[94:95], v[94:95], s[68:69]
v_pk_mul_f32 v[156:157], v[156:157], s[68:69]
v_pk_mul_f32 v[158:159], v[158:159], s[68:69]
v_cvt_pk_bf16_f32 v92, v92, v93
v_cvt_pk_bf16_f32 v93, v94, v95
v_cvt_pk_bf16_f32 v94, v156, v157
v_cvt_pk_bf16_f32 v95, v158, v159
ds_write_b128 v28, v[92:95] offset:57344
s_add_u32 s23, s67, 57344
buffer_store_dwordx4 v[92:95], v1, s[4:7], s23 offen offset:0 sc1
v_pk_mul_f32 v[164:165], v[164:165], s[68:69]
v_pk_mul_f32 v[166:167], v[166:167], s[68:69]
v_pk_mul_f32 v[224:225], v[224:225], s[68:69]
v_pk_mul_f32 v[226:227], v[226:227], s[68:69]
v_cvt_pk_bf16_f32 v164, v164, v165
v_cvt_pk_bf16_f32 v165, v166, v167
v_cvt_pk_bf16_f32 v166, v224, v225
v_cvt_pk_bf16_f32 v167, v226, v227
ds_write_b128 v28, v[164:167] offset:1024
s_add_u32 s23, s67, 0
buffer_store_dwordx4 v[164:167], v1, s[4:7], s23 offen offset:1024 sc1
v_pk_mul_f32 v[172:173], v[172:173], s[68:69]
v_pk_mul_f32 v[174:175], v[174:175], s[68:69]
v_pk_mul_f32 v[228:229], v[228:229], s[68:69]
v_pk_mul_f32 v[230:231], v[230:231], s[68:69]
v_cvt_pk_bf16_f32 v172, v172, v173
v_cvt_pk_bf16_f32 v173, v174, v175
v_cvt_pk_bf16_f32 v174, v228, v229
v_cvt_pk_bf16_f32 v175, v230, v231
ds_write_b128 v28, v[172:175] offset:9216
s_add_u32 s23, s67, 8192
buffer_store_dwordx4 v[172:175], v1, s[4:7], s23 offen offset:1024 sc1
v_pk_mul_f32 v[180:181], v[180:181], s[68:69]
v_pk_mul_f32 v[182:183], v[182:183], s[68:69]
v_pk_mul_f32 v[232:233], v[232:233], s[68:69]
v_pk_mul_f32 v[234:235], v[234:235], s[68:69]
v_cvt_pk_bf16_f32 v180, v180, v181
v_cvt_pk_bf16_f32 v181, v182, v183
v_cvt_pk_bf16_f32 v182, v232, v233
v_cvt_pk_bf16_f32 v183, v234, v235
ds_write_b128 v28, v[180:183] offset:17408
s_add_u32 s23, s67, 16384
buffer_store_dwordx4 v[180:183], v1, s[4:7], s23 offen offset:1024 sc1
v_pk_mul_f32 v[188:189], v[188:189], s[68:69]
v_pk_mul_f32 v[190:191], v[190:191], s[68:69]
v_pk_mul_f32 v[236:237], v[236:237], s[68:69]
v_pk_mul_f32 v[238:239], v[238:239], s[68:69]
v_cvt_pk_bf16_f32 v188, v188, v189
v_cvt_pk_bf16_f32 v189, v190, v191
v_cvt_pk_bf16_f32 v190, v236, v237
v_cvt_pk_bf16_f32 v191, v238, v239
ds_write_b128 v28, v[188:191] offset:25600
s_add_u32 s23, s67, 24576
buffer_store_dwordx4 v[188:191], v1, s[4:7], s23 offen offset:1024 sc1
v_pk_mul_f32 v[196:197], v[196:197], s[68:69]
v_pk_mul_f32 v[198:199], v[198:199], s[68:69]
v_pk_mul_f32 v[240:241], v[240:241], s[68:69]
v_pk_mul_f32 v[242:243], v[242:243], s[68:69]
v_cvt_pk_bf16_f32 v196, v196, v197
v_cvt_pk_bf16_f32 v197, v198, v199
v_cvt_pk_bf16_f32 v198, v240, v241
v_cvt_pk_bf16_f32 v199, v242, v243
PAD_8:
s_cbranch_execz M_tret
ds_write_b128 v28, v[196:199] offset:33792
s_add_u32 s23, s67, 32768
buffer_store_dwordx4 v[196:199], v1, s[4:7], s23 offen offset:1024 sc1
v_pk_mul_f32 v[204:205], v[204:205], s[68:69]
v_pk_mul_f32 v[206:207], v[206:207], s[68:69]
v_pk_mul_f32 v[244:245], v[244:245], s[68:69]
v_pk_mul_f32 v[246:247], v[246:247], s[68:69]
v_cvt_pk_bf16_f32 v204, v204, v205
v_cvt_pk_bf16_f32 v205, v206, v207
v_cvt_pk_bf16_f32 v206, v244, v245
v_cvt_pk_bf16_f32 v207, v246, v247
ds_write_b128 v28, v[204:207] offset:41984
s_add_u32 s23, s67, 40960
buffer_store_dwordx4 v[204:207], v1, s[4:7], s23 offen offset:1024 sc1
v_pk_mul_f32 v[212:213], v[212:213], s[68:69]
v_pk_mul_f32 v[214:215], v[214:215], s[68:69]
v_pk_mul_f32 v[248:249], v[248:249], s[68:69]
v_pk_mul_f32 v[250:251], v[250:251], s[68:69]
v_cvt_pk_bf16_f32 v212, v212, v213
v_cvt_pk_bf16_f32 v213, v214, v215
v_cvt_pk_bf16_f32 v214, v248, v249
v_cvt_pk_bf16_f32 v215, v250, v251
ds_write_b128 v28, v[212:215] offset:50176
s_add_u32 s23, s67, 49152
buffer_store_dwordx4 v[212:215], v1, s[4:7], s23 offen offset:1024 sc1
v_pk_mul_f32 v[220:221], v[220:221], s[68:69]
v_pk_mul_f32 v[222:223], v[222:223], s[68:69]
v_pk_mul_f32 v[252:253], v[252:253], s[68:69]
v_pk_mul_f32 v[254:255], v[254:255], s[68:69]
v_cvt_pk_bf16_f32 v220, v220, v221
v_cvt_pk_bf16_f32 v221, v222, v223
v_cvt_pk_bf16_f32 v222, v252, v253
v_cvt_pk_bf16_f32 v223, v254, v255
ds_write_b128 v28, v[220:223] offset:58368
s_add_u32 s23, s67, 57344
buffer_store_dwordx4 v[220:223], v1, s[4:7], s23 offen offset:1024 sc1
s_waitcnt vmcnt(11)
v_cmp_gt_u32 vcc, 1, v21
s_cbranch_vccnz M_kspin
M_kok:
buffer_load_dword v21, v15, s[4:7], s70 offen sc1
s_mov_b32 m0, s84
s_nop 0
buffer_load_dwordx4 v1, s[4:7], s8 offen offset:0 sc1 lds
buffer_load_dwordx4 v1, s[4:7], s8 offen offset:1024 sc1 lds
buffer_load_dwordx4 v1, s[4:7], s8 offen offset:2048 sc1 lds
buffer_load_dwordx4 v1, s[4:7], s8 offen offset:3072 sc1 lds
s_add_u32 s8, s8, 4096
s_add_u32 m0, s84, 4096
s_nop 0
buffer_load_dwordx4 v1, s[4:7], s8 offen offset:0 sc1 lds
buffer_load_dwordx4 v1, s[4:7], s8 offen offset:1024 sc1 lds
buffer_load_dwordx4 v1, s[4:7], s8 offen offset:2048 sc1 lds
buffer_load_dwordx4 v1, s[4:7], s8 offen offset:3072 sc1 lds
s_add_u32 s8, s8, 28672
s_sub_u32 s9, s9, 1
s_cmp_eq_u32 s9, 0
s_cselect_b32 s8, s10, s8
s_cselect_b32 s9, s11, s9
s_cselect_b32 s10, 3221225472, s10
v_add_u32 v28, s18, v2
s_waitcnt lgkmcnt(0)
s_barrier
ds_read_b128 a[0:3], v28 offset:0
ds_read_b128 a[4:7], v28 offset:1024
ds_read_b128 a[8:11], v28 offset:2048
ds_read_b128 a[12:15], v28 offset:3072
ds_read_b128 a[16:19], v28 offset:4096
ds_read_b128 a[20:23], v28 offset:5120
ds_read_b128 a[24:27], v28 offset:6144
ds_read_b128 a[28:31], v28 offset:7168
ds_read_b128 a[32:35], v28 offset:32768
ds_read_b128 a[36:39], v28 offset:33792
ds_read_b128 a[40:43], v28 offset:34816
ds_read_b128 a[44:47], v28 offset:35840
ds_read_b128 a[48:51], v28 offset:36864
ds_read_b128 a[52:55], v28 offset:37888
ds_read_b128 a[56:59], v28 offset:38912
ds_read_b128 a[60:63], v28 offset:39936
s_mov_b32 m0, s85
s_nop 0
buffer_load_dwordx4 v1, s[4:7], s8 offen offset:0 sc1 lds
buffer_load_dwordx4 v1, s[4:7], s8 offen offset:1024 sc1 lds
buffer_load_dwordx4 v1, s[4:7], s8 offen offset:2048 sc1 lds
buffer_load_dwordx4 v1, s[4:7], s8 offen offset:3072 sc1 lds
s_add_u32 s8, s8, 4096
s_add_u32 m0, s85, 4096
s_nop 0
buffer_load_dwordx4 v1, s[4:7], s8 offen offset:0 sc1 lds
buffer_load_dwordx4 v1, s[4:7], s8 offen offset:1024 sc1 lds
buffer_load_dwordx4 v1, s[4:7], s8 offen offset:2048 sc1 lds
buffer_load_dwordx4 v1, s[4:7], s8 offen offset:3072 sc1 lds
s_add_u32 s8, s8, 28672
s_sub_u32 s9, s9, 1
s_cmp_eq_u32 s9, 0
s_cselect_b32 s8, s10, s8
s_cselect_b32 s9, s11, s9
s_cselect_b32 s10, 3221225472, s10
s_mov_b32 s25, 1266679808
s_lshl_b32 s22, s21, 3
s_xor_b32 s28, s70, 256
s_add_u32 s28, s28, s22
s_add_u32 s28, s28, 6148
s_lshl_b32 s26, s21, 16
s_add_u32 s26, s26, s30
s_add_u32 s26, s26, 33554432
s_xor_b32 s76, s20, 0
s_lshl_b32 s76, s76, 3
s_add_u32 s76, s76, s21
s_lshl_b32 s76, s76, 2
s_add_u32 s76, s76, s3
s_lshl_b32 s27, s76, 10
s_add_u32 s27, s27, 75497472
s_lshl_b32 s76, s76, 14
s_add_u32 s76, s76, 67108864
s_lshl_b32 s81, s20, 2
s_add_u32 s81, s81, s3
s_mul_i32 s81, s81, 57344
s_cmp_eq_u32 s24, 1
s_cselect_b32 s80, s28, s70
s_add_u32 s77, s76, 8192
v_lshrrev_b32 v8, 7, v1
v_and_b32 v9, 6, v8
v_lshlrev_b32 v9, 4, v9
v_and_b32 v10, 0x70, v1
v_xor_b32 v9, v9, v10
v_mul_u32_u24 v8, 896, v8
v_add_u32 v8, v8, v9
v_accvgpr_write_b32 a184, v8
v_add_u32 v8, 6144, v8
v_accvgpr_write_b32 a185, v8
v_add_u32 v8, 6144, v8
v_accvgpr_write_b32 a186, v8
v_add_u32 v8, 6144, v8
v_accvgpr_write_b32 a187, v8
v_lshrrev_b32 v8, 6, v1
v_bfe_u32 v9, v1, 7, 2
v_lshlrev_b32 v9, 5, v9
v_lshl_add_u32 v8, v8, 7, v9
v_bfe_u32 v9, v1, 4, 2
v_lshl_add_u32 v8, v9, 3, v8
v_add_u32 v8, 32768, v8
v_accvgpr_write_b32 a188, v8
v_xor_b32 v9, 32, v8
v_accvgpr_write_b32 a189, v9
v_xor_b32 v9, 64, v8
v_accvgpr_write_b32 a190, v9
v_xor_b32 v9, 96, v8
v_accvgpr_write_b32 a191, v9
s_add_u32 s22, s66, 16384
s_mov_b32 s71, 3221225472
s_waitcnt vmcnt(17)
s_barrier
buffer_store_dword v6, v5, s[4:7], s22 offen sc1
v_mov_b64 v[128:129], 0
v_mov_b64 v[130:131], 0
v_mov_b64 v[132:133], 0
v_mov_b64 v[134:135], 0
v_mov_b64 v[136:137], 0
v_mov_b64 v[138:139], 0
v_mov_b64 v[140:141], 0
v_mov_b64 v[142:143], 0
v_mov_b64 v[144:145], 0
v_mov_b64 v[146:147], 0
v_mov_b64 v[148:149], 0
v_mov_b64 v[150:151], 0
v_mov_b64 v[152:153], 0
v_mov_b64 v[154:155], 0
v_mov_b64 v[156:157], 0
v_mov_b64 v[158:159], 0
v_mov_b64 v[160:161], 0
v_mov_b64 v[162:163], 0
v_mov_b64 v[164:165], 0
v_mov_b64 v[166:167], 0
v_mov_b64 v[168:169], 0
v_mov_b64 v[170:171], 0
v_mov_b64 v[172:173], 0
v_mov_b64 v[174:175], 0
v_mov_b64 v[176:177], 0
v_mov_b64 v[178:179], 0
v_mov_b64 v[180:181], 0
v_mov_b64 v[182:183], 0
v_mov_b64 v[184:185], 0
v_mov_b64 v[186:187], 0
v_mov_b64 v[188:189], 0
v_mov_b64 v[190:191], 0
v_mov_b64 v[192:193], 0
v_mov_b64 v[194:195], 0
v_mov_b64 v[196:197], 0
v_mov_b64 v[198:199], 0
v_mov_b64 v[200:201], 0
v_mov_b64 v[202:203], 0
v_mov_b64 v[204:205], 0
v_mov_b64 v[206:207], 0
v_mov_b64 v[208:209], 0
v_mov_b64 v[210:211], 0
v_mov_b64 v[212:213], 0
v_mov_b64 v[214:215], 0
v_mov_b64 v[216:217], 0
v_mov_b64 v[218:219], 0
v_mov_b64 v[220:221], 0
v_mov_b64 v[222:223], 0
v_mov_b64 v[224:225], 0
v_mov_b64 v[226:227], 0
v_mov_b64 v[228:229], 0
v_mov_b64 v[230:231], 0
v_mov_b64 v[232:233], 0
v_mov_b64 v[234:235], 0
v_mov_b64 v[236:237], 0
v_mov_b64 v[238:239], 0
v_mov_b64 v[240:241], 0
v_mov_b64 v[242:243], 0
v_mov_b64 v[244:245], 0
v_mov_b64 v[246:247], 0
v_mov_b64 v[248:249], 0
v_mov_b64 v[250:251], 0
v_mov_b64 v[252:253], 0
v_mov_b64 v[254:255], 0
v_mov_b64 v[24:25], 0
s_cmp_eq_u32 s24, 9
s_cbranch_scc1 M_t2A
M_t2Ar:
s_waitcnt vmcnt(9) lgkmcnt(0)
v_cmp_gt_u32 vcc, 1, v21
s_cbranch_vccnz M_vspin
M_vok:
s_barrier
K2_item:
PAD_9:
s_cbranch_execz M_tret
s_cmp_eq_u32 s19, 0
s_cbranch_scc1 K2_p0d
ds_read_b128 a[64:67], v1 offset:0
ds_read_b128 a[68:71], v1 offset:1024
ds_read_b128 a[72:75], v1 offset:2048
ds_read_b128 a[76:79], v1 offset:3072
ds_read_b128 a[80:83], v1 offset:4096
ds_read_b128 a[84:87], v1 offset:5120
ds_read_b128 a[88:91], v1 offset:6144
ds_read_b128 a[92:95], v1 offset:7168
s_waitcnt lgkmcnt(7)
v_mfma_f32_16x16x32_bf16 v[32:35], a[64:67], a[0:3], 0
s_waitcnt lgkmcnt(6)
s_add_u32 m0, s18, 65536
ds_read_b128 a[96:99], v1 offset:8192
v_mfma_f32_16x16x32_bf16 v[32:35], a[68:71], a[4:7], v[32:35]
s_waitcnt lgkmcnt(6)
buffer_load_dwordx4 v1, s[4:7], s12 offen offset:0 sc1 lds
v_mfma_f32_16x16x32_bf16 v[32:35], a[72:75], a[8:11], v[32:35]
s_waitcnt lgkmcnt(5)
ds_read_b128 a[100:103], v1 offset:9216
v_mfma_f32_16x16x32_bf16 v[32:35], a[76:79], a[12:15], v[32:35]
s_waitcnt lgkmcnt(5)
buffer_load_dwordx4 v1, s[4:7], s12 offen offset:1024 sc1 lds
v_mfma_f32_16x16x32_bf16 v[32:35], a[80:83], a[16:19], v[32:35]
s_waitcnt lgkmcnt(4)
ds_read_b128 a[104:107], v1 offset:10240
v_mfma_f32_16x16x32_bf16 v[32:35], a[84:87], a[20:23], v[32:35]
s_waitcnt lgkmcnt(4)
buffer_load_dwordx4 v1, s[4:7], s12 offen offset:2048 sc1 lds
v_mfma_f32_16x16x32_bf16 v[32:35], a[88:91], a[24:27], v[32:35]
s_waitcnt lgkmcnt(3)
ds_read_b128 a[108:111], v1 offset:11264
v_mfma_f32_16x16x32_bf16 v[32:35], a[92:95], a[28:31], v[32:35]
buffer_load_dwordx4 v1, s[4:7], s12 offen offset:3072 sc1 lds
v_mfma_f32_16x16x32_bf16 v[36:39], a[64:67], a[32:35], 0
s_add_u32 s12, s12, 4096
s_add_u32 m0, s18, 69632
ds_read_b128 a[112:115], v1 offset:12288
v_mfma_f32_16x16x32_bf16 v[36:39], a[68:71], a[36:39], v[36:39]
buffer_load_dwordx4 v1, s[4:7], s12 offen offset:0 sc1 lds
v_mfma_f32_16x16x32_bf16 v[36:39], a[72:75], a[40:43], v[36:39]
ds_read_b128 a[116:119], v1 offset:13312
v_mfma_f32_16x16x32_bf16 v[36:39], a[76:79], a[44:47], v[36:39]
buffer_load_dwordx4 v1, s[4:7], s12 offen offset:1024 sc1 lds
v_mfma_f32_16x16x32_bf16 v[36:39], a[80:83], a[48:51], v[36:39]
ds_read_b128 a[120:123], v1 offset:14336
v_max3_f32 v28, v32, v33, v34
v_mfma_f32_16x16x32_bf16 v[36:39], a[84:87], a[52:55], v[36:39]
buffer_load_dwordx4 v1, s[4:7], s12 offen offset:2048 sc1 lds
v_mfma_f32_16x16x32_bf16 v[36:39], a[88:91], a[56:59], v[36:39]
ds_read_b128 a[124:127], v1 offset:15360
v_max_f32 v28, v28, v35
v_mfma_f32_16x16x32_bf16 v[36:39], a[92:95], a[60:63], v[36:39]
s_waitcnt lgkmcnt(4)
buffer_load_dwordx4 v1, s[4:7], s12 offen offset:3072 sc1 lds
v_mfma_f32_16x16x32_bf16 v[40:43], a[96:99], a[0:3], 0
s_add_u32 s12, s12, 28672
ds_read_b128 a[64:67], v1 offset:16384
v_mov_b32 v30, v28
v_mfma_f32_16x16x32_bf16 v[40:43], a[100:103], a[4:7], v[40:43]
s_waitcnt lgkmcnt(2)
s_sub_u32 s13, s13, 1
v_mfma_f32_16x16x32_bf16 v[40:43], a[104:107], a[8:11], v[40:43]
s_cmp_eq_u32 s13, 0
ds_read_b128 a[68:71], v1 offset:17408
v_permlane16_swap_b32 v28, v30
v_mfma_f32_16x16x32_bf16 v[40:43], a[108:111], a[12:15], v[40:43]
s_cselect_b32 s12, s14, s12
v_max_f32 v28, v28, v30
v_mov_b32 v30, v28
v_mfma_f32_16x16x32_bf16 v[40:43], a[112:115], a[16:19], v[40:43]
s_cselect_b32 s13, s15, s13
ds_read_b128 a[72:75], v1 offset:18432
v_max3_f32 v29, v36, v37, v38
v_mfma_f32_16x16x32_bf16 v[40:43], a[116:119], a[20:23], v[40:43]
s_cselect_b32 s14, 3221225472, s14
v_permlane32_swap_b32 v28, v30
v_max_f32 v28, v28, v30
v_mfma_f32_16x16x32_bf16 v[40:43], a[120:123], a[24:27], v[40:43]
s_waitcnt lgkmcnt(3)
ds_read_b128 a[76:79], v1 offset:19456
v_sub_f32 v16, 0, v28
v_mfma_f32_16x16x32_bf16 v[40:43], a[124:127], a[28:31], v[40:43]
v_sub_f32 v17, 0, v28
v_sub_f32 v18, 0, v28
v_mfma_f32_16x16x32_bf16 v[44:47], a[96:99], a[32:35], 0
ds_read_b128 a[80:83], v1 offset:20480
v_sub_f32 v19, 0, v28
v_mfma_f32_16x16x32_bf16 v[44:47], a[100:103], a[36:39], v[44:47]
v_max_f32 v29, v29, v39
v_mov_b32 v31, v29
v_mfma_f32_16x16x32_bf16 v[44:47], a[104:107], a[40:43], v[44:47]
ds_read_b128 a[84:87], v1 offset:21504
v_mfma_f32_16x16x32_bf16 v[44:47], a[108:111], a[44:47], v[44:47]
v_permlane16_swap_b32 v29, v31
v_max_f32 v29, v29, v31
v_mfma_f32_16x16x32_bf16 v[44:47], a[112:115], a[48:51], v[44:47]
ds_read_b128 a[88:91], v1 offset:22528
v_mov_b32 v31, v29
v_mfma_f32_16x16x32_bf16 v[44:47], a[116:119], a[52:55], v[44:47]
v_mfma_f32_16x16x32_bf16 v[44:47], a[120:123], a[56:59], v[44:47]
ds_read_b128 a[92:95], v1 offset:23552
v_permlane32_swap_b32 v29, v31
v_mfma_f32_16x16x32_bf16 v[44:47], a[124:127], a[60:63], v[44:47]
s_waitcnt lgkmcnt(4)
v_max_f32 v29, v29, v31
v_sub_f32 v20, 0, v29
v_mfma_f32_16x16x32_bf16 v[48:51], a[64:67], a[0:3], v[16:19]
ds_read_b128 a[96:99], v1 offset:24576
v_sub_f32 v21, 0, v29
v_mfma_f32_16x16x32_bf16 v[48:51], a[68:71], a[4:7], v[48:51]
v_sub_f32 v22, 0, v29
v_sub_f32 v23, 0, v29
v_mfma_f32_16x16x32_bf16 v[48:51], a[72:75], a[8:11], v[48:51]
ds_read_b128 a[100:103], v1 offset:25600
v_mfma_f32_16x16x32_bf16 v[48:51], a[76:79], a[12:15], v[48:51]
s_waitcnt lgkmcnt(4)
v_mfma_f32_16x16x32_bf16 v[48:51], a[80:83], a[16:19], v[48:51]
ds_read_b128 a[104:107], v1 offset:26624
v_mfma_f32_16x16x32_bf16 v[48:51], a[84:87], a[20:23], v[48:51]
s_waitcnt lgkmcnt(4)
v_add_f32 v32, v32, v16
v_add_f32 v33, v33, v16
v_add_f32 v34, v34, v16
v_add_f32 v35, v35, v16
v_mfma_f32_16x16x32_bf16 v[48:51], a[88:91], a[24:27], v[48:51]
s_waitcnt lgkmcnt(3)
ds_read_b128 a[108:111], v1 offset:27648
v_add_f32 v36, v36, v20
v_add_f32 v37, v37, v20
v_add_f32 v38, v38, v20
v_add_f32 v39, v39, v20
v_mfma_f32_16x16x32_bf16 v[48:51], a[92:95], a[28:31], v[48:51]
v_add_f32 v40, v40, v16
v_add_f32 v41, v41, v16
v_add_f32 v42, v42, v16
v_add_f32 v43, v43, v16
v_mfma_f32_16x16x32_bf16 v[52:55], a[64:67], a[32:35], v[20:23]
ds_read_b128 a[112:115], v1 offset:28672
v_add_f32 v44, v44, v20
v_add_f32 v45, v45, v20
v_add_f32 v46, v46, v20
v_add_f32 v47, v47, v20
v_mfma_f32_16x16x32_bf16 v[52:55], a[68:71], a[36:39], v[52:55]
v_exp_f32 v8, v32
v_mfma_f32_16x16x32_bf16 v[52:55], a[72:75], a[40:43], v[52:55]
ds_read_b128 a[116:119], v1 offset:29696
v_exp_f32 v9, v33
v_mfma_f32_16x16x32_bf16 v[52:55], a[76:79], a[44:47], v[52:55]
v_exp_f32 v10, v34
v_add_f32 v26, v8, v9
v_cvt_pk_bf16_f32 v96, v8, v9
v_mfma_f32_16x16x32_bf16 v[52:55], a[80:83], a[48:51], v[52:55]
ds_read_b128 a[120:123], v1 offset:30720
v_exp_f32 v11, v35
v_add_f32 v26, v26, v10
v_mfma_f32_16x16x32_bf16 v[52:55], a[84:87], a[52:55], v[52:55]
v_exp_f32 v12, v36
v_add_f32 v26, v26, v11
v_cvt_pk_bf16_f32 v97, v10, v11
v_mfma_f32_16x16x32_bf16 v[52:55], a[88:91], a[56:59], v[52:55]
s_waitcnt vmcnt(8) lgkmcnt(4)
ds_read_b128 a[124:127], v1 offset:31744
v_exp_f32 v13, v37
v_mfma_f32_16x16x32_bf16 v[52:55], a[92:95], a[60:63], v[52:55]
s_barrier
v_mfma_f32_16x16x32_bf16 v[56:59], a[96:99], a[0:3], v[16:19]
ds_read_b128 a[64:67], v4 offset:0
v_exp_f32 v14, v38
v_mfma_f32_16x16x32_bf16 v[56:59], a[100:103], a[4:7], v[56:59]
buffer_store_dword v6, v5, s[4:7], s71 offen sc1
v_mfma_f32_16x16x32_bf16 v[56:59], a[104:107], a[8:11], v[56:59]
s_waitcnt lgkmcnt(4)
ds_read_b128 a[68:71], v4 offset:1024
v_add_f32 v27, v12, v13
v_cvt_pk_bf16_f32 v104, v12, v13
v_add_f32 v27, v27, v14
v_mfma_f32_16x16x32_bf16 v[56:59], a[108:111], a[12:15], v[56:59]
v_exp_f32 v15, v39
v_mfma_f32_16x16x32_bf16 v[56:59], a[112:115], a[16:19], v[56:59]
s_waitcnt lgkmcnt(4)
ds_read_b128 a[72:75], v4 offset:2048
v_exp_f32 v8, v40
v_add_f32 v27, v27, v15
v_cvt_pk_bf16_f32 v105, v14, v15
v_mfma_f32_16x16x32_bf16 v[56:59], a[116:119], a[20:23], v[56:59]
s_waitcnt lgkmcnt(4)
v_exp_f32 v9, v41
v_add_f32 v26, v26, v8
v_mfma_f32_16x16x32_bf16 v[56:59], a[120:123], a[24:27], v[56:59]
s_waitcnt lgkmcnt(3)
ds_read_b128 a[76:79], v4 offset:3072
v_exp_f32 v10, v42
v_add_f32 v26, v26, v9
v_cvt_pk_bf16_f32 v98, v8, v9
v_mfma_f32_16x16x32_bf16 v[56:59], a[124:127], a[28:31], v[56:59]
v_exp_f32 v11, v43
v_add_f32 v26, v26, v10
v_mfma_f32_16x16x32_bf16 v[60:63], a[96:99], a[32:35], v[20:23]
ds_read_b128 a[80:83], v4 offset:4096
v_exp_f32 v12, v44
v_mfma_f32_16x16x32_bf16 v[60:63], a[100:103], a[36:39], v[60:63]
v_exp_f32 v13, v45
v_mfma_f32_16x16x32_bf16 v[60:63], a[104:107], a[40:43], v[60:63]
ds_read_b128 a[84:87], v4 offset:5120
v_exp_f32 v14, v46
v_mfma_f32_16x16x32_bf16 v[60:63], a[108:111], a[44:47], v[60:63]
v_exp_f32 v15, v47
v_mfma_f32_16x16x32_bf16 v[60:63], a[112:115], a[48:51], v[60:63]
ds_read_b128 a[88:91], v4 offset:6144
v_add_f32 v26, v26, v11
v_cvt_pk_bf16_f32 v99, v10, v11
v_mfma_f32_16x16x32_bf16 v[60:63], a[116:119], a[52:55], v[60:63]
v_add_f32 v27, v27, v12
v_add_f32 v27, v27, v13
v_cvt_pk_bf16_f32 v106, v12, v13
v_mfma_f32_16x16x32_bf16 v[60:63], a[120:123], a[56:59], v[60:63]
s_waitcnt lgkmcnt(7)
s_barrier
ds_read_b128 a[92:95], v4 offset:7168
v_mfma_f32_16x16x32_bf16 v[60:63], a[124:127], a[60:63], v[60:63]
s_waitcnt lgkmcnt(4)
v_add_f32 v27, v27, v14
v_add_f32 v27, v27, v15
v_cvt_pk_bf16_f32 v107, v14, v15
K2_x1:
v_mfma_f32_16x16x32_bf16 v[64:67], a[64:67], a[0:3], v[16:19]
s_add_u32 m0, s18, 0
ds_read_b128 a[96:99], v4 offset:8192
v_mfma_f32_16x16x32_bf16 v[64:67], a[68:71], a[4:7], v[64:67]
s_waitcnt lgkmcnt(4)
buffer_load_dwordx4 v1, s[4:7], s8 offen offset:0 sc1 lds
v_mfma_f32_16x16x32_bf16 v[64:67], a[72:75], a[8:11], v[64:67]
ds_read_b128 a[100:103], v4 offset:9216
v_mfma_f32_16x16x32_bf16 v[64:67], a[76:79], a[12:15], v[64:67]
s_waitcnt lgkmcnt(4)
v_exp_f32 v8, v48
v_mfma_f32_16x16x32_bf16 v[64:67], a[80:83], a[16:19], v[64:67]
ds_read_b128 a[104:107], v4 offset:10240
v_add_f32 v26, v26, v8
v_mfma_f32_16x16x32_bf16 v[64:67], a[84:87], a[20:23], v[64:67]
s_waitcnt lgkmcnt(4)
buffer_load_dwordx4 v1, s[4:7], s8 offen offset:1024 sc1 lds
v_mfma_f32_16x16x32_bf16 v[64:67], a[88:91], a[24:27], v[64:67]
s_waitcnt lgkmcnt(3)
ds_read_b128 a[108:111], v4 offset:11264
v_mfma_f32_16x16x32_bf16 v[64:67], a[92:95], a[28:31], v[64:67]
v_exp_f32 v9, v49
v_mfma_f32_16x16x32_bf16 v[68:71], a[64:67], a[32:35], v[20:23]
ds_read_b128 a[112:115], v4 offset:12288
v_add_f32 v26, v26, v9
v_mfma_f32_16x16x32_bf16 v[68:71], a[68:71], a[36:39], v[68:71]
buffer_load_dwordx4 v1, s[4:7], s8 offen offset:2048 sc1 lds
v_mfma_f32_16x16x32_bf16 v[68:71], a[72:75], a[40:43], v[68:71]
ds_read_b128 a[116:119], v4 offset:13312
v_cvt_pk_bf16_f32 v100, v8, v9
v_mfma_f32_16x16x32_bf16 v[68:71], a[76:79], a[44:47], v[68:71]
v_exp_f32 v10, v50
v_mfma_f32_16x16x32_bf16 v[68:71], a[80:83], a[48:51], v[68:71]
ds_read_b128 a[120:123], v4 offset:14336
v_add_f32 v26, v26, v10
v_mfma_f32_16x16x32_bf16 v[68:71], a[84:87], a[52:55], v[68:71]
buffer_load_dwordx4 v1, s[4:7], s8 offen offset:3072 sc1 lds
v_mfma_f32_16x16x32_bf16 v[68:71], a[88:91], a[56:59], v[68:71]
s_add_u32 s8, s8, 4096
ds_read_b128 a[124:127], v4 offset:15360
v_mfma_f32_16x16x32_bf16 v[68:71], a[92:95], a[60:63], v[68:71]
s_waitcnt lgkmcnt(4)
v_exp_f32 v11, v51
v_mfma_f32_16x16x32_bf16 v[72:75], a[96:99], a[0:3], v[16:19]
s_add_u32 m0, s18, 4096
ds_read_b128 a[64:67], v4 offset:16384
v_add_f32 v26, v26, v11
v_mfma_f32_16x16x32_bf16 v[72:75], a[100:103], a[4:7], v[72:75]
buffer_load_dwordx4 v1, s[4:7], s8 offen offset:0 sc1 lds
v_mfma_f32_16x16x32_bf16 v[72:75], a[104:107], a[8:11], v[72:75]
ds_read_b128 a[68:71], v4 offset:17408
v_cvt_pk_bf16_f32 v101, v10, v11
v_mfma_f32_16x16x32_bf16 v[72:75], a[108:111], a[12:15], v[72:75]
s_waitcnt lgkmcnt(4)
v_mfma_f32_16x16x32_bf16 v[72:75], a[112:115], a[16:19], v[72:75]
ds_read_b128 a[72:75], v4 offset:18432
v_mfma_f32_16x16x32_bf16 v[72:75], a[116:119], a[20:23], v[72:75]
s_waitcnt lgkmcnt(4)
buffer_load_dwordx4 v1, s[4:7], s8 offen offset:1024 sc1 lds
v_mfma_f32_16x16x32_bf16 v[72:75], a[120:123], a[24:27], v[72:75]
s_waitcnt lgkmcnt(3)
ds_read_b128 a[76:79], v4 offset:19456
v_mfma_f32_16x16x32_bf16 v[72:75], a[124:127], a[28:31], v[72:75]
v_exp_f32 v12, v52
v_mfma_f32_16x16x32_bf16 v[76:79], a[96:99], a[32:35], v[20:23]
ds_read_b128 a[80:83], v4 offset:20480
v_add_f32 v27, v27, v12
v_mfma_f32_16x16x32_bf16 v[76:79], a[100:103], a[36:39], v[76:79]
buffer_load_dwordx4 v1, s[4:7], s8 offen offset:2048 sc1 lds
v_mfma_f32_16x16x32_bf16 v[76:79], a[104:107], a[40:43], v[76:79]
ds_read_b128 a[84:87], v4 offset:21504
v_mfma_f32_16x16x32_bf16 v[76:79], a[108:111], a[44:47], v[76:79]
v_exp_f32 v13, v53
v_mfma_f32_16x16x32_bf16 v[76:79], a[112:115], a[48:51], v[76:79]
ds_read_b128 a[88:91], v4 offset:22528
v_add_f32 v27, v27, v13
v_mfma_f32_16x16x32_bf16 v[76:79], a[116:119], a[52:55], v[76:79]
s_waitcnt lgkmcnt(3)
buffer_load_dwordx4 v1, s[4:7], s8 offen offset:3072 sc1 lds
v_mfma_f32_16x16x32_bf16 v[76:79], a[120:123], a[56:59], v[76:79]
s_add_u32 s8, s8, 28672
ds_read_b128 a[92:95], v4 offset:23552
v_cvt_pk_bf16_f32 v108, v12, v13
v_mfma_f32_16x16x32_bf16 v[76:79], a[124:127], a[60:63], v[76:79]
s_sub_u32 s9, s9, 1
v_exp_f32 v14, v54
v_mfma_f32_16x16x32_bf16 v[80:83], a[64:67], a[0:3], v[16:19]
s_cmp_eq_u32 s9, 0
ds_read_b128 a[96:99], v4 offset:24576
v_add_f32 v27, v27, v14
v_mfma_f32_16x16x32_bf16 v[80:83], a[68:71], a[4:7], v[80:83]
s_cselect_b32 s8, s10, s8
v_exp_f32 v15, v55
v_mfma_f32_16x16x32_bf16 v[80:83], a[72:75], a[8:11], v[80:83]
s_cselect_b32 s9, s11, s9
ds_read_b128 a[100:103], v4 offset:25600
v_add_f32 v27, v27, v15
v_mfma_f32_16x16x32_bf16 v[80:83], a[76:79], a[12:15], v[80:83]
s_waitcnt lgkmcnt(4)
s_cselect_b32 s10, 3221225472, s10
v_cvt_pk_bf16_f32 v109, v14, v15
v_mfma_f32_16x16x32_bf16 v[80:83], a[80:83], a[16:19], v[80:83]
ds_read_b128 a[104:107], v4 offset:26624
v_mfma_f32_16x16x32_bf16 v[80:83], a[84:87], a[20:23], v[80:83]
s_waitcnt lgkmcnt(4)
v_exp_f32 v8, v56
v_mfma_f32_16x16x32_bf16 v[80:83], a[88:91], a[24:27], v[80:83]
s_waitcnt lgkmcnt(3)
ds_read_b128 a[108:111], v4 offset:27648
v_add_f32 v26, v26, v8
v_mfma_f32_16x16x32_bf16 v[80:83], a[92:95], a[28:31], v[80:83]
v_exp_f32 v9, v57
v_mfma_f32_16x16x32_bf16 v[84:87], a[64:67], a[32:35], v[20:23]
ds_read_b128 a[112:115], v4 offset:28672
v_add_f32 v26, v26, v9
v_mfma_f32_16x16x32_bf16 v[84:87], a[68:71], a[36:39], v[84:87]
v_exp_f32 v10, v58
v_mfma_f32_16x16x32_bf16 v[84:87], a[72:75], a[40:43], v[84:87]
ds_read_b128 a[116:119], v4 offset:29696
v_cvt_pk_bf16_f32 v102, v8, v9
v_mfma_f32_16x16x32_bf16 v[84:87], a[76:79], a[44:47], v[84:87]
v_exp_f32 v11, v59
v_mfma_f32_16x16x32_bf16 v[84:87], a[80:83], a[48:51], v[84:87]
ds_read_b128 a[120:123], v4 offset:30720
v_add_f32 v26, v26, v10
v_mfma_f32_16x16x32_bf16 v[84:87], a[84:87], a[52:55], v[84:87]
v_add_f32 v26, v26, v11
v_cvt_pk_bf16_f32 v103, v10, v11
v_mfma_f32_16x16x32_bf16 v[84:87], a[88:91], a[56:59], v[84:87]
s_waitcnt vmcnt(8) lgkmcnt(4)
ds_read_b128 a[124:127], v4 offset:31744
v_mfma_f32_16x16x32_bf16 v[84:87], a[92:95], a[60:63], v[84:87]
s_barrier
v_mfma_f32_16x16x32_bf16 v[88:91], a[96:99], a[0:3], v[16:19]
ds_read_b128 a[64:67], v2 offset:0
v_mfma_f32_16x16x32_bf16 v[88:91], a[100:103], a[4:7], v[88:91]
v_exp_f32 v12, v60
v_mfma_f32_16x16x32_bf16 v[88:91], a[104:107], a[8:11], v[88:91]
s_waitcnt lgkmcnt(4)
ds_read_b128 a[68:71], v2 offset:1024
v_add_f32 v27, v27, v12
v_mfma_f32_16x16x32_bf16 v[88:91], a[108:111], a[12:15], v[88:91]
v_exp_f32 v13, v61
v_mfma_f32_16x16x32_bf16 v[88:91], a[112:115], a[16:19], v[88:91]
s_waitcnt lgkmcnt(4)
ds_read_b128 a[72:75], v2 offset:2048
v_add_f32 v27, v27, v13
v_mfma_f32_16x16x32_bf16 v[88:91], a[116:119], a[20:23], v[88:91]
s_waitcnt lgkmcnt(4)
v_exp_f32 v14, v62
v_mfma_f32_16x16x32_bf16 v[88:91], a[120:123], a[24:27], v[88:91]
s_waitcnt lgkmcnt(3)
ds_read_b128 a[76:79], v2 offset:3072
v_cvt_pk_bf16_f32 v110, v12, v13
v_mfma_f32_16x16x32_bf16 v[88:91], a[124:127], a[28:31], v[88:91]
v_exp_f32 v15, v63
v_mfma_f32_16x16x32_bf16 v[92:95], a[96:99], a[32:35], v[20:23]
s_sub_u32 s19, s19, 1
ds_read_b128 a[80:83], v2 offset:4096
v_add_f32 v27, v27, v14
v_mfma_f32_16x16x32_bf16 v[92:95], a[100:103], a[36:39], v[92:95]
v_add_f32 v27, v27, v15
v_cvt_pk_bf16_f32 v111, v14, v15
v_mfma_f32_16x16x32_bf16 v[92:95], a[104:107], a[40:43], v[92:95]
ds_read_b128 a[84:87], v2 offset:5120
v_add_f32 v28, v26, v27
v_mfma_f32_16x16x32_bf16 v[92:95], a[108:111], a[44:47], v[92:95]
v_cmp_nge_f32 vcc, s25, v28
v_mfma_f32_16x16x32_bf16 v[92:95], a[112:115], a[48:51], v[92:95]
s_cmp_eq_u64 vcc, 0
ds_read_b128 a[88:91], v2 offset:6144
v_mfma_f32_16x16x32_bf16 v[92:95], a[116:119], a[52:55], v[92:95]
s_cselect_b32 s22, s19, 0
v_mfma_f32_16x16x32_bf16 v[92:95], a[120:123], a[56:59], v[92:95]
s_cmp_eq_u32 s22, 0
ds_read_b128 a[92:95], v2 offset:7168
v_mfma_f32_16x16x32_bf16 v[92:95], a[124:127], a[60:63], v[92:95]
s_waitcnt lgkmcnt(4)
s_cbranch_scc1 K2_xexit
K2_loop:
v_mfma_f32_16x16x32_bf16 v[128:131], a[64:67], v[96:99], v[128:131]
s_add_u32 m0, s18, 98304
ds_read_b128 a[96:99], v2 offset:8192
v_add_f32 v24, v24, v26
v_mfma_f32_16x16x32_bf16 v[128:131], a[68:71], v[100:103], v[128:131]
buffer_load_dwordx4 v1, s[4:7], s12 offen offset:0 sc1 lds
v_mfma_f32_16x16x32_bf16 v[132:135], a[68:71], v[108:111], v[132:135]
ds_read_b128 a[100:103], v2 offset:9216
v_add_f32 v25, v25, v27
v_mfma_f32_16x16x32_bf16 v[132:135], a[64:67], v[104:107], v[132:135]
v_exp_f32 v8, v64
v_mfma_f32_16x16x32_bf16 v[136:139], a[72:75], v[96:99], v[136:139]
ds_read_b128 a[104:107], v2 offset:10240
v_mfma_f32_16x16x32_bf16 v[136:139], a[76:79], v[100:103], v[136:139]
buffer_load_dwordx4 v1, s[4:7], s12 offen offset:1024 sc1 lds
v_mfma_f32_16x16x32_bf16 v[140:143], a[76:79], v[108:111], v[140:143]
ds_read_b128 a[108:111], v2 offset:11264
v_mfma_f32_16x16x32_bf16 v[140:143], a[72:75], v[104:107], v[140:143]
s_waitcnt lgkmcnt(4)
v_exp_f32 v9, v65
v_mfma_f32_16x16x32_bf16 v[144:147], a[80:83], v[96:99], v[144:147]
ds_read_b128 a[112:115], v2 offset:12288
v_add_f32 v26, v8, v9
v_mfma_f32_16x16x32_bf16 v[144:147], a[84:87], v[100:103], v[144:147]
buffer_load_dwordx4 v1, s[4:7], s12 offen offset:2048 sc1 lds
v_mfma_f32_16x16x32_bf16 v[148:151], a[84:87], v[108:111], v[148:151]
ds_read_b128 a[116:119], v2 offset:13312
v_cvt_pk_bf16_f32 v112, v8, v9
v_mfma_f32_16x16x32_bf16 v[148:151], a[80:83], v[104:107], v[148:151]
PAD_10:
s_cbranch_execz M_tret
v_exp_f32 v10, v66
v_mfma_f32_16x16x32_bf16 v[152:155], a[88:91], v[96:99], v[152:155]
ds_read_b128 a[120:123], v2 offset:14336
v_add_f32 v26, v26, v10
v_mfma_f32_16x16x32_bf16 v[152:155], a[92:95], v[100:103], v[152:155]
buffer_load_dwordx4 v1, s[4:7], s12 offen offset:3072 sc1 lds
v_mfma_f32_16x16x32_bf16 v[156:159], a[92:95], v[108:111], v[156:159]
s_add_u32 s12, s12, 4096
ds_read_b128 a[124:127], v2 offset:15360
v_mfma_f32_16x16x32_bf16 v[156:159], a[88:91], v[104:107], v[156:159]
s_waitcnt lgkmcnt(4)
v_exp_f32 v11, v67
v_mfma_f32_16x16x32_bf16 v[160:163], a[96:99], v[96:99], v[160:163]
s_add_u32 m0, s18, 102400
ds_read_b128 a[64:67], v2 offset:16384
v_add_f32 v26, v26, v11
v_mfma_f32_16x16x32_bf16 v[160:163], a[100:103], v[100:103], v[160:163]
buffer_load_dwordx4 v1, s[4:7], s12 offen offset:0 sc1 lds
v_mfma_f32_16x16x32_bf16 v[164:167], a[100:103], v[108:111], v[164:167]
ds_read_b128 a[68:71], v2 offset:17408
v_cvt_pk_bf16_f32 v113, v10, v11
v_mfma_f32_16x16x32_bf16 v[164:167], a[96:99], v[104:107], v[164:167]
v_mfma_f32_16x16x32_bf16 v[168:171], a[104:107], v[96:99], v[168:171]
ds_read_b128 a[72:75], v2 offset:18432
v_mfma_f32_16x16x32_bf16 v[168:171], a[108:111], v[100:103], v[168:171]
buffer_load_dwordx4 v1, s[4:7], s12 offen offset:1024 sc1 lds
v_mfma_f32_16x16x32_bf16 v[172:175], a[108:111], v[108:111], v[172:175]
ds_read_b128 a[76:79], v2 offset:19456
v_mfma_f32_16x16x32_bf16 v[172:175], a[104:107], v[104:107], v[172:175]
s_waitcnt lgkmcnt(4)
v_exp_f32 v12, v68
v_mfma_f32_16x16x32_bf16 v[176:179], a[112:115], v[96:99], v[176:179]
ds_read_b128 a[80:83], v2 offset:20480
v_mfma_f32_16x16x32_bf16 v[176:179], a[116:119], v[100:103], v[176:179]
buffer_load_dwordx4 v1, s[4:7], s12 offen offset:2048 sc1 lds
v_mfma_f32_16x16x32_bf16 v[180:183], a[116:119], v[108:111], v[180:183]
ds_read_b128 a[84:87], v2 offset:21504
v_mfma_f32_16x16x32_bf16 v[180:183], a[112:115], v[104:107], v[180:183]
v_exp_f32 v13, v69
v_mfma_f32_16x16x32_bf16 v[184:187], a[120:123], v[96:99], v[184:187]
ds_read_b128 a[88:91], v2 offset:22528
v_add_f32 v27, v12, v13
v_mfma_f32_16x16x32_bf16 v[184:187], a[124:127], v[100:103], v[184:187]
s_waitcnt lgkmcnt(4)
buffer_load_dwordx4 v1, s[4:7], s12 offen offset:3072 sc1 lds
v_mfma_f32_16x16x32_bf16 v[188:191], a[124:127], v[108:111], v[188:191]
s_add_u32 s12, s12, 28672
ds_read_b128 a[92:95], v2 offset:23552
v_cvt_pk_bf16_f32 v120, v12, v13
v_mfma_f32_16x16x32_bf16 v[188:191], a[120:123], v[104:107], v[188:191]
s_sub_u32 s13, s13, 1
v_exp_f32 v14, v70
v_mfma_f32_16x16x32_bf16 v[192:195], a[64:67], v[96:99], v[192:195]
s_cmp_eq_u32 s13, 0
ds_read_b128 a[96:99], v2 offset:24576
v_add_f32 v27, v27, v14
v_mfma_f32_16x16x32_bf16 v[192:195], a[68:71], v[100:103], v[192:195]
s_cselect_b32 s12, s14, s12
v_mfma_f32_16x16x32_bf16 v[196:199], a[68:71], v[108:111], v[196:199]
s_cselect_b32 s13, s15, s13
ds_read_b128 a[100:103], v2 offset:25600
v_mfma_f32_16x16x32_bf16 v[196:199], a[64:67], v[104:107], v[196:199]
s_cselect_b32 s14, 3221225472, s14
v_exp_f32 v15, v71
v_mfma_f32_16x16x32_bf16 v[200:203], a[72:75], v[96:99], v[200:203]
s_waitcnt lgkmcnt(4)
ds_read_b128 a[104:107], v2 offset:26624
v_add_f32 v27, v27, v15
v_mfma_f32_16x16x32_bf16 v[200:203], a[76:79], v[100:103], v[200:203]
v_exp_f32 v8, v72
v_mfma_f32_16x16x32_bf16 v[204:207], a[76:79], v[108:111], v[204:207]
ds_read_b128 a[108:111], v2 offset:27648
v_cvt_pk_bf16_f32 v121, v14, v15
v_mfma_f32_16x16x32_bf16 v[204:207], a[72:75], v[104:107], v[204:207]
v_exp_f32 v9, v73
v_mfma_f32_16x16x32_bf16 v[208:211], a[80:83], v[96:99], v[208:211]
ds_read_b128 a[112:115], v2 offset:28672
v_add_f32 v26, v26, v8
v_mfma_f32_16x16x32_bf16 v[208:211], a[84:87], v[100:103], v[208:211]
v_add_f32 v26, v26, v9
v_cvt_pk_bf16_f32 v114, v8, v9
v_mfma_f32_16x16x32_bf16 v[212:215], a[84:87], v[108:111], v[212:215]
ds_read_b128 a[116:119], v2 offset:29696
v_mfma_f32_16x16x32_bf16 v[212:215], a[80:83], v[104:107], v[212:215]
s_waitcnt lgkmcnt(4)
v_exp_f32 v10, v74
v_mfma_f32_16x16x32_bf16 v[216:219], a[88:91], v[96:99], v[216:219]
ds_read_b128 a[120:123], v2 offset:30720
v_add_f32 v26, v26, v10
v_mfma_f32_16x16x32_bf16 v[216:219], a[92:95], v[100:103], v[216:219]
v_exp_f32 v11, v75
v_mfma_f32_16x16x32_bf16 v[220:223], a[92:95], v[108:111], v[220:223]
s_waitcnt vmcnt(8)
ds_read_b128 a[124:127], v2 offset:31744
v_add_f32 v26, v26, v11
v_mfma_f32_16x16x32_bf16 v[220:223], a[88:91], v[104:107], v[220:223]
s_barrier
v_mfma_f32_16x16x32_bf16 v[224:227], a[96:99], v[96:99], v[224:227]
ds_read_b128 a[64:67], v1 offset:0
v_cvt_pk_bf16_f32 v115, v10, v11
v_mfma_f32_16x16x32_bf16 v[224:227], a[100:103], v[100:103], v[224:227]
v_exp_f32 v12, v76
v_mfma_f32_16x16x32_bf16 v[228:231], a[100:103], v[108:111], v[228:231]
ds_read_b128 a[68:71], v1 offset:1024
v_add_f32 v27, v27, v12
v_mfma_f32_16x16x32_bf16 v[228:231], a[96:99], v[104:107], v[228:231]
s_waitcnt lgkmcnt(4)
v_mfma_f32_16x16x32_bf16 v[232:235], a[104:107], v[96:99], v[232:235]
ds_read_b128 a[72:75], v1 offset:2048
v_mfma_f32_16x16x32_bf16 v[232:235], a[108:111], v[100:103], v[232:235]
v_exp_f32 v13, v77
v_mfma_f32_16x16x32_bf16 v[236:239], a[108:111], v[108:111], v[236:239]
ds_read_b128 a[76:79], v1 offset:3072
v_add_f32 v27, v27, v13
v_mfma_f32_16x16x32_bf16 v[236:239], a[104:107], v[104:107], v[236:239]
v_exp_f32 v14, v78
v_mfma_f32_16x16x32_bf16 v[240:243], a[112:115], v[96:99], v[240:243]
ds_read_b128 a[80:83], v1 offset:4096
v_cvt_pk_bf16_f32 v122, v12, v13
v_mfma_f32_16x16x32_bf16 v[240:243], a[116:119], v[100:103], v[240:243]
v_exp_f32 v15, v79
v_mfma_f32_16x16x32_bf16 v[244:247], a[116:119], v[108:111], v[244:247]
ds_read_b128 a[84:87], v1 offset:5120
v_add_f32 v27, v27, v14
v_mfma_f32_16x16x32_bf16 v[244:247], a[112:115], v[104:107], v[244:247]
s_waitcnt lgkmcnt(4)
v_add_f32 v27, v27, v15
v_cvt_pk_bf16_f32 v123, v14, v15
v_mfma_f32_16x16x32_bf16 v[248:251], a[120:123], v[96:99], v[248:251]
ds_read_b128 a[88:91], v1 offset:6144
v_mfma_f32_16x16x32_bf16 v[248:251], a[124:127], v[100:103], v[248:251]
v_mfma_f32_16x16x32_bf16 v[252:255], a[124:127], v[108:111], v[252:255]
ds_read_b128 a[92:95], v1 offset:7168
v_mfma_f32_16x16x32_bf16 v[252:255], a[120:123], v[104:107], v[252:255]
K2_x0:
v_mfma_f32_16x16x32_bf16 v[32:35], a[64:67], a[0:3], v[16:19]
s_add_u32 m0, s18, 131072
ds_read_b128 a[96:99], v1 offset:8192
v_mfma_f32_16x16x32_bf16 v[32:35], a[68:71], a[4:7], v[32:35]
s_waitcnt lgkmcnt(4)
buffer_load_dwordx4 v1, s[4:7], s8 offen offset:0 sc1 lds
v_mfma_f32_16x16x32_bf16 v[32:35], a[72:75], a[8:11], v[32:35]
ds_read_b128 a[100:103], v1 offset:9216
v_mfma_f32_16x16x32_bf16 v[32:35], a[76:79], a[12:15], v[32:35]
v_exp_f32 v8, v80
v_mfma_f32_16x16x32_bf16 v[32:35], a[80:83], a[16:19], v[32:35]
s_waitcnt lgkmcnt(4)
ds_read_b128 a[104:107], v1 offset:10240
v_add_f32 v26, v26, v8
v_mfma_f32_16x16x32_bf16 v[32:35], a[84:87], a[20:23], v[32:35]
s_waitcnt lgkmcnt(4)
buffer_load_dwordx4 v1, s[4:7], s8 offen offset:1024 sc1 lds
v_mfma_f32_16x16x32_bf16 v[32:35], a[88:91], a[24:27], v[32:35]
s_waitcnt lgkmcnt(3)
ds_read_b128 a[108:111], v1 offset:11264
v_mfma_f32_16x16x32_bf16 v[32:35], a[92:95], a[28:31], v[32:35]
v_exp_f32 v9, v81
v_mfma_f32_16x16x32_bf16 v[36:39], a[64:67], a[32:35], v[20:23]
ds_read_b128 a[112:115], v1 offset:12288
v_add_f32 v26, v26, v9
v_mfma_f32_16x16x32_bf16 v[36:39], a[68:71], a[36:39], v[36:39]
buffer_load_dwordx4 v1, s[4:7], s8 offen offset:2048 sc1 lds
v_mfma_f32_16x16x32_bf16 v[36:39], a[72:75], a[40:43], v[36:39]
ds_read_b128 a[116:119], v1 offset:13312
v_cvt_pk_bf16_f32 v116, v8, v9
v_mfma_f32_16x16x32_bf16 v[36:39], a[76:79], a[44:47], v[36:39]
v_exp_f32 v10, v82
v_mfma_f32_16x16x32_bf16 v[36:39], a[80:83], a[48:51], v[36:39]
ds_read_b128 a[120:123], v1 offset:14336
v_add_f32 v26, v26, v10
v_mfma_f32_16x16x32_bf16 v[36:39], a[84:87], a[52:55], v[36:39]
buffer_load_dwordx4 v1, s[4:7], s8 offen offset:3072 sc1 lds
v_mfma_f32_16x16x32_bf16 v[36:39], a[88:91], a[56:59], v[36:39]
s_add_u32 s8, s8, 4096
ds_read_b128 a[124:127], v1 offset:15360
v_mfma_f32_16x16x32_bf16 v[36:39], a[92:95], a[60:63], v[36:39]
s_waitcnt lgkmcnt(4)
v_exp_f32 v11, v83
v_mfma_f32_16x16x32_bf16 v[40:43], a[96:99], a[0:3], v[16:19]
s_add_u32 m0, s18, 135168
ds_read_b128 a[64:67], v1 offset:16384
v_add_f32 v26, v26, v11
v_mfma_f32_16x16x32_bf16 v[40:43], a[100:103], a[4:7], v[40:43]
buffer_load_dwordx4 v1, s[4:7], s8 offen offset:0 sc1 lds
v_mfma_f32_16x16x32_bf16 v[40:43], a[104:107], a[8:11], v[40:43]
ds_read_b128 a[68:71], v1 offset:17408
v_cvt_pk_bf16_f32 v117, v10, v11
v_mfma_f32_16x16x32_bf16 v[40:43], a[108:111], a[12:15], v[40:43]
s_waitcnt lgkmcnt(4)
v_mfma_f32_16x16x32_bf16 v[40:43], a[112:115], a[16:19], v[40:43]
ds_read_b128 a[72:75], v1 offset:18432
v_mfma_f32_16x16x32_bf16 v[40:43], a[116:119], a[20:23], v[40:43]
s_waitcnt lgkmcnt(4)
buffer_load_dwordx4 v1, s[4:7], s8 offen offset:1024 sc1 lds
v_mfma_f32_16x16x32_bf16 v[40:43], a[120:123], a[24:27], v[40:43]
s_waitcnt lgkmcnt(3)
ds_read_b128 a[76:79], v1 offset:19456
v_mfma_f32_16x16x32_bf16 v[40:43], a[124:127], a[28:31], v[40:43]
v_exp_f32 v12, v84
v_mfma_f32_16x16x32_bf16 v[44:47], a[96:99], a[32:35], v[20:23]
ds_read_b128 a[80:83], v1 offset:20480
v_add_f32 v27, v27, v12
v_mfma_f32_16x16x32_bf16 v[44:47], a[100:103], a[36:39], v[44:47]
buffer_load_dwordx4 v1, s[4:7], s8 offen offset:2048 sc1 lds
v_mfma_f32_16x16x32_bf16 v[44:47], a[104:107], a[40:43], v[44:47]
ds_read_b128 a[84:87], v1 offset:21504
v_mfma_f32_16x16x32_bf16 v[44:47], a[108:111], a[44:47], v[44:47]
v_exp_f32 v13, v85
v_mfma_f32_16x16x32_bf16 v[44:47], a[112:115], a[48:51], v[44:47]
ds_read_b128 a[88:91], v1 offset:22528
v_add_f32 v27, v27, v13
v_mfma_f32_16x16x32_bf16 v[44:47], a[116:119], a[52:55], v[44:47]
s_waitcnt lgkmcnt(3)
buffer_load_dwordx4 v1, s[4:7], s8 offen offset:3072 sc1 lds
v_mfma_f32_16x16x32_bf16 v[44:47], a[120:123], a[56:59], v[44:47]
s_add_u32 s8, s8, 28672
ds_read_b128 a[92:95], v1 offset:23552
v_cvt_pk_bf16_f32 v124, v12, v13
v_mfma_f32_16x16x32_bf16 v[44:47], a[124:127], a[60:63], v[44:47]
s_sub_u32 s9, s9, 1
v_exp_f32 v14, v86
v_mfma_f32_16x16x32_bf16 v[48:51], a[64:67], a[0:3], v[16:19]
s_cmp_eq_u32 s9, 0
ds_read_b128 a[96:99], v1 offset:24576
v_add_f32 v27, v27, v14
v_mfma_f32_16x16x32_bf16 v[48:51], a[68:71], a[4:7], v[48:51]
s_cselect_b32 s8, s10, s8
v_exp_f32 v15, v87
v_mfma_f32_16x16x32_bf16 v[48:51], a[72:75], a[8:11], v[48:51]
s_cselect_b32 s9, s11, s9
ds_read_b128 a[100:103], v1 offset:25600
v_add_f32 v27, v27, v15
v_mfma_f32_16x16x32_bf16 v[48:51], a[76:79], a[12:15], v[48:51]
s_waitcnt lgkmcnt(4)
s_cselect_b32 s10, 3221225472, s10
v_cvt_pk_bf16_f32 v125, v14, v15
v_mfma_f32_16x16x32_bf16 v[48:51], a[80:83], a[16:19], v[48:51]
ds_read_b128 a[104:107], v1 offset:26624
v_mfma_f32_16x16x32_bf16 v[48:51], a[84:87], a[20:23], v[48:51]
s_waitcnt lgkmcnt(4)
v_exp_f32 v8, v88
v_mfma_f32_16x16x32_bf16 v[48:51], a[88:91], a[24:27], v[48:51]
s_waitcnt lgkmcnt(3)
ds_read_b128 a[108:111], v1 offset:27648
v_add_f32 v26, v26, v8
v_mfma_f32_16x16x32_bf16 v[48:51], a[92:95], a[28:31], v[48:51]
v_exp_f32 v9, v89
v_mfma_f32_16x16x32_bf16 v[52:55], a[64:67], a[32:35], v[20:23]
ds_read_b128 a[112:115], v1 offset:28672
v_add_f32 v26, v26, v9
v_mfma_f32_16x16x32_bf16 v[52:55], a[68:71], a[36:39], v[52:55]
v_exp_f32 v10, v90
v_mfma_f32_16x16x32_bf16 v[52:55], a[72:75], a[40:43], v[52:55]
ds_read_b128 a[116:119], v1 offset:29696
v_cvt_pk_bf16_f32 v118, v8, v9
v_mfma_f32_16x16x32_bf16 v[52:55], a[76:79], a[44:47], v[52:55]
v_exp_f32 v11, v91
v_mfma_f32_16x16x32_bf16 v[52:55], a[80:83], a[48:51], v[52:55]
ds_read_b128 a[120:123], v1 offset:30720
v_add_f32 v26, v26, v10
v_mfma_f32_16x16x32_bf16 v[52:55], a[84:87], a[52:55], v[52:55]
v_add_f32 v26, v26, v11
v_cvt_pk_bf16_f32 v119, v10, v11
v_mfma_f32_16x16x32_bf16 v[52:55], a[88:91], a[56:59], v[52:55]
s_waitcnt vmcnt(8) lgkmcnt(4)
ds_read_b128 a[124:127], v1 offset:31744
v_mfma_f32_16x16x32_bf16 v[52:55], a[92:95], a[60:63], v[52:55]
s_barrier
v_mfma_f32_16x16x32_bf16 v[56:59], a[96:99], a[0:3], v[16:19]
ds_read_b128 a[64:67], v2 offset:32768
v_mfma_f32_16x16x32_bf16 v[56:59], a[100:103], a[4:7], v[56:59]
v_exp_f32 v12, v92
v_mfma_f32_16x16x32_bf16 v[56:59], a[104:107], a[8:11], v[56:59]
s_waitcnt lgkmcnt(4)
ds_read_b128 a[68:71], v2 offset:33792
v_add_f32 v27, v27, v12
v_mfma_f32_16x16x32_bf16 v[56:59], a[108:111], a[12:15], v[56:59]
v_exp_f32 v13, v93
v_mfma_f32_16x16x32_bf16 v[56:59], a[112:115], a[16:19], v[56:59]
s_waitcnt lgkmcnt(4)
ds_read_b128 a[72:75], v2 offset:34816
v_add_f32 v27, v27, v13
v_mfma_f32_16x16x32_bf16 v[56:59], a[116:119], a[20:23], v[56:59]
s_waitcnt lgkmcnt(4)
v_exp_f32 v14, v94
v_mfma_f32_16x16x32_bf16 v[56:59], a[120:123], a[24:27], v[56:59]
s_waitcnt lgkmcnt(3)
ds_read_b128 a[76:79], v2 offset:35840
v_cvt_pk_bf16_f32 v126, v12, v13
v_mfma_f32_16x16x32_bf16 v[56:59], a[124:127], a[28:31], v[56:59]
v_exp_f32 v15, v95
v_mfma_f32_16x16x32_bf16 v[60:63], a[96:99], a[32:35], v[20:23]
ds_read_b128 a[80:83], v2 offset:36864
v_add_f32 v27, v27, v14
v_mfma_f32_16x16x32_bf16 v[60:63], a[100:103], a[36:39], v[60:63]
v_add_f32 v27, v27, v15
v_cvt_pk_bf16_f32 v127, v14, v15
v_mfma_f32_16x16x32_bf16 v[60:63], a[104:107], a[40:43], v[60:63]
ds_read_b128 a[84:87], v2 offset:37888
v_add_f32 v28, v26, v27
v_mfma_f32_16x16x32_bf16 v[60:63], a[108:111], a[44:47], v[60:63]
v_cmp_nge_f32 vcc, s25, v28
v_mfma_f32_16x16x32_bf16 v[60:63], a[112:115], a[48:51], v[60:63]
ds_read_b128 a[88:91], v2 offset:38912
v_mfma_f32_16x16x32_bf16 v[60:63], a[116:119], a[52:55], v[60:63]
v_mfma_f32_16x16x32_bf16 v[60:63], a[120:123], a[56:59], v[60:63]
ds_read_b128 a[92:95], v2 offset:39936
v_mfma_f32_16x16x32_bf16 v[60:63], a[124:127], a[60:63], v[60:63]
s_waitcnt lgkmcnt(4)
s_cbranch_vccnz Lstub_2
Lback_3:
v_mfma_f32_16x16x32_bf16 v[128:131], a[64:67], v[112:115], v[128:131]
s_add_u32 m0, s18, 65536
ds_read_b128 a[96:99], v2 offset:40960
v_add_f32 v24, v24, v26
v_mfma_f32_16x16x32_bf16 v[128:131], a[68:71], v[116:119], v[128:131]
buffer_load_dwordx4 v1, s[4:7], s12 offen offset:0 sc1 lds
v_mfma_f32_16x16x32_bf16 v[132:135], a[68:71], v[124:127], v[132:135]
ds_read_b128 a[100:103], v2 offset:41984
v_add_f32 v25, v25, v27
v_mfma_f32_16x16x32_bf16 v[132:135], a[64:67], v[120:123], v[132:135]
v_exp_f32 v8, v32
v_mfma_f32_16x16x32_bf16 v[136:139], a[72:75], v[112:115], v[136:139]
ds_read_b128 a[104:107], v2 offset:43008
v_mfma_f32_16x16x32_bf16 v[136:139], a[76:79], v[116:119], v[136:139]
buffer_load_dwordx4 v1, s[4:7], s12 offen offset:1024 sc1 lds
v_mfma_f32_16x16x32_bf16 v[140:143], a[76:79], v[124:127], v[140:143]
ds_read_b128 a[108:111], v2 offset:44032
v_mfma_f32_16x16x32_bf16 v[140:143], a[72:75], v[120:123], v[140:143]
s_waitcnt lgkmcnt(4)
v_exp_f32 v9, v33
v_mfma_f32_16x16x32_bf16 v[144:147], a[80:83], v[112:115], v[144:147]
ds_read_b128 a[112:115], v2 offset:45056
v_add_f32 v26, v8, v9
v_mfma_f32_16x16x32_bf16 v[144:147], a[84:87], v[116:119], v[144:147]
buffer_load_dwordx4 v1, s[4:7], s12 offen offset:2048 sc1 lds
v_mfma_f32_16x16x32_bf16 v[148:151], a[84:87], v[124:127], v[148:151]
ds_read_b128 a[116:119], v2 offset:46080
v_cvt_pk_bf16_f32 v96, v8, v9
v_mfma_f32_16x16x32_bf16 v[148:151], a[80:83], v[120:123], v[148:151]
v_exp_f32 v10, v34
v_mfma_f32_16x16x32_bf16 v[152:155], a[88:91], v[112:115], v[152:155]
ds_read_b128 a[120:123], v2 offset:47104
v_add_f32 v26, v26, v10
v_mfma_f32_16x16x32_bf16 v[152:155], a[92:95], v[116:119], v[152:155]
buffer_load_dwordx4 v1, s[4:7], s12 offen offset:3072 sc1 lds
v_mfma_f32_16x16x32_bf16 v[156:159], a[92:95], v[124:127], v[156:159]
s_add_u32 s12, s12, 4096
ds_read_b128 a[124:127], v2 offset:48128
v_mfma_f32_16x16x32_bf16 v[156:159], a[88:91], v[120:123], v[156:159]
s_waitcnt lgkmcnt(4)
v_exp_f32 v11, v35
v_mfma_f32_16x16x32_bf16 v[160:163], a[96:99], v[112:115], v[160:163]
s_add_u32 m0, s18, 69632
ds_read_b128 a[64:67], v2 offset:49152
v_add_f32 v26, v26, v11
v_mfma_f32_16x16x32_bf16 v[160:163], a[100:103], v[116:119], v[160:163]
buffer_load_dwordx4 v1, s[4:7], s12 offen offset:0 sc1 lds
v_mfma_f32_16x16x32_bf16 v[164:167], a[100:103], v[124:127], v[164:167]
ds_read_b128 a[68:71], v2 offset:50176
v_cvt_pk_bf16_f32 v97, v10, v11
v_mfma_f32_16x16x32_bf16 v[164:167], a[96:99], v[120:123], v[164:167]
v_mfma_f32_16x16x32_bf16 v[168:171], a[104:107], v[112:115], v[168:171]
ds_read_b128 a[72:75], v2 offset:51200
v_mfma_f32_16x16x32_bf16 v[168:171], a[108:111], v[116:119], v[168:171]
buffer_load_dwordx4 v1, s[4:7], s12 offen offset:1024 sc1 lds
v_mfma_f32_16x16x32_bf16 v[172:175], a[108:111], v[124:127], v[172:175]
ds_read_b128 a[76:79], v2 offset:52224
v_mfma_f32_16x16x32_bf16 v[172:175], a[104:107], v[120:123], v[172:175]
s_waitcnt lgkmcnt(4)
v_exp_f32 v12, v36
v_mfma_f32_16x16x32_bf16 v[176:179], a[112:115], v[112:115], v[176:179]
ds_read_b128 a[80:83], v2 offset:53248
v_mfma_f32_16x16x32_bf16 v[176:179], a[116:119], v[116:119], v[176:179]
buffer_load_dwordx4 v1, s[4:7], s12 offen offset:2048 sc1 lds
v_mfma_f32_16x16x32_bf16 v[180:183], a[116:119], v[124:127], v[180:183]
ds_read_b128 a[84:87], v2 offset:54272
v_mfma_f32_16x16x32_bf16 v[180:183], a[112:115], v[120:123], v[180:183]
v_exp_f32 v13, v37
v_mfma_f32_16x16x32_bf16 v[184:187], a[120:123], v[112:115], v[184:187]
ds_read_b128 a[88:91], v2 offset:55296
v_add_f32 v27, v12, v13
v_mfma_f32_16x16x32_bf16 v[184:187], a[124:127], v[116:119], v[184:187]
s_waitcnt lgkmcnt(4)
buffer_load_dwordx4 v1, s[4:7], s12 offen offset:3072 sc1 lds
v_mfma_f32_16x16x32_bf16 v[188:191], a[124:127], v[124:127], v[188:191]
s_add_u32 s12, s12, 28672
ds_read_b128 a[92:95], v2 offset:56320
v_cvt_pk_bf16_f32 v104, v12, v13
v_mfma_f32_16x16x32_bf16 v[188:191], a[120:123], v[120:123], v[188:191]
s_sub_u32 s13, s13, 1
v_exp_f32 v14, v38
v_mfma_f32_16x16x32_bf16 v[192:195], a[64:67], v[112:115], v[192:195]
s_cmp_eq_u32 s13, 0
ds_read_b128 a[96:99], v2 offset:57344
v_add_f32 v27, v27, v14
v_mfma_f32_16x16x32_bf16 v[192:195], a[68:71], v[116:119], v[192:195]
s_cselect_b32 s12, s14, s12
v_mfma_f32_16x16x32_bf16 v[196:199], a[68:71], v[124:127], v[196:199]
s_cselect_b32 s13, s15, s13
ds_read_b128 a[100:103], v2 offset:58368
v_mfma_f32_16x16x32_bf16 v[196:199], a[64:67], v[120:123], v[196:199]
s_cselect_b32 s14, 3221225472, s14
v_exp_f32 v15, v39
v_mfma_f32_16x16x32_bf16 v[200:203], a[72:75], v[112:115], v[200:203]
s_waitcnt lgkmcnt(4)
ds_read_b128 a[104:107], v2 offset:59392
v_add_f32 v27, v27, v15
v_mfma_f32_16x16x32_bf16 v[200:203], a[76:79], v[116:119], v[200:203]
v_exp_f32 v8, v40
v_mfma_f32_16x16x32_bf16 v[204:207], a[76:79], v[124:127], v[204:207]
ds_read_b128 a[108:111], v2 offset:60416
v_cvt_pk_bf16_f32 v105, v14, v15
v_mfma_f32_16x16x32_bf16 v[204:207], a[72:75], v[120:123], v[204:207]
v_exp_f32 v9, v41
v_mfma_f32_16x16x32_bf16 v[208:211], a[80:83], v[112:115], v[208:211]
ds_read_b128 a[112:115], v2 offset:61440
v_add_f32 v26, v26, v8
v_mfma_f32_16x16x32_bf16 v[208:211], a[84:87], v[116:119], v[208:211]
v_add_f32 v26, v26, v9
v_cvt_pk_bf16_f32 v98, v8, v9
v_mfma_f32_16x16x32_bf16 v[212:215], a[84:87], v[124:127], v[212:215]
ds_read_b128 a[116:119], v2 offset:62464
v_mfma_f32_16x16x32_bf16 v[212:215], a[80:83], v[120:123], v[212:215]
s_waitcnt lgkmcnt(4)
v_exp_f32 v10, v42
v_mfma_f32_16x16x32_bf16 v[216:219], a[88:91], v[112:115], v[216:219]
ds_read_b128 a[120:123], v2 offset:63488
v_add_f32 v26, v26, v10
v_mfma_f32_16x16x32_bf16 v[216:219], a[92:95], v[116:119], v[216:219]
v_exp_f32 v11, v43
v_mfma_f32_16x16x32_bf16 v[220:223], a[92:95], v[124:127], v[220:223]
s_waitcnt vmcnt(8)
ds_read_b128 a[124:127], v2 offset:64512
v_add_f32 v26, v26, v11
v_mfma_f32_16x16x32_bf16 v[220:223], a[88:91], v[120:123], v[220:223]
s_barrier
v_mfma_f32_16x16x32_bf16 v[224:227], a[96:99], v[112:115], v[224:227]
ds_read_b128 a[64:67], v4 offset:0
v_cvt_pk_bf16_f32 v99, v10, v11
v_mfma_f32_16x16x32_bf16 v[224:227], a[100:103], v[116:119], v[224:227]
v_exp_f32 v12, v44
v_mfma_f32_16x16x32_bf16 v[228:231], a[100:103], v[124:127], v[228:231]
ds_read_b128 a[68:71], v4 offset:1024
v_add_f32 v27, v27, v12
v_mfma_f32_16x16x32_bf16 v[228:231], a[96:99], v[120:123], v[228:231]
s_waitcnt lgkmcnt(4)
v_mfma_f32_16x16x32_bf16 v[232:235], a[104:107], v[112:115], v[232:235]
ds_read_b128 a[72:75], v4 offset:2048
v_mfma_f32_16x16x32_bf16 v[232:235], a[108:111], v[116:119], v[232:235]
v_exp_f32 v13, v45
v_mfma_f32_16x16x32_bf16 v[236:239], a[108:111], v[124:127], v[236:239]
ds_read_b128 a[76:79], v4 offset:3072
v_add_f32 v27, v27, v13
v_mfma_f32_16x16x32_bf16 v[236:239], a[104:107], v[120:123], v[236:239]
v_exp_f32 v14, v46
v_mfma_f32_16x16x32_bf16 v[240:243], a[112:115], v[112:115], v[240:243]
ds_read_b128 a[80:83], v4 offset:4096
v_cvt_pk_bf16_f32 v106, v12, v13
v_mfma_f32_16x16x32_bf16 v[240:243], a[116:119], v[116:119], v[240:243]
v_exp_f32 v15, v47
v_mfma_f32_16x16x32_bf16 v[244:247], a[116:119], v[124:127], v[244:247]
ds_read_b128 a[84:87], v4 offset:5120
v_add_f32 v27, v27, v14
v_mfma_f32_16x16x32_bf16 v[244:247], a[112:115], v[120:123], v[244:247]
s_waitcnt lgkmcnt(4)
v_add_f32 v27, v27, v15
v_cvt_pk_bf16_f32 v107, v14, v15
v_mfma_f32_16x16x32_bf16 v[248:251], a[120:123], v[112:115], v[248:251]
ds_read_b128 a[88:91], v4 offset:6144
v_mfma_f32_16x16x32_bf16 v[248:251], a[124:127], v[116:119], v[248:251]
v_mfma_f32_16x16x32_bf16 v[252:255], a[124:127], v[124:127], v[252:255]
s_waitcnt lgkmcnt(5)
ds_read_b128 a[92:95], v4 offset:7168
v_mfma_f32_16x16x32_bf16 v[252:255], a[120:123], v[120:123], v[252:255]
s_branch K2_x1
K2_xexit:
s_cbranch_vccnz Lstub_4
Lback_5:
s_cmp_lg_u32 s19, 0
s_cbranch_scc1 K2_loop
s_cmp_eq_u32 s24, 2
s_cbranch_scc1 K2_ntail
v_mfma_f32_16x16x32_bf16 v[128:131], a[64:67], v[96:99], v[128:131]
s_add_u32 m0, s18, 98304
ds_read_b128 a[96:99], v2 offset:8192
v_add_f32 v24, v24, v26
v_mfma_f32_16x16x32_bf16 v[128:131], a[68:71], v[100:103], v[128:131]
buffer_load_dwordx4 v1, s[4:7], s12 offen offset:0 sc1 lds
v_mfma_f32_16x16x32_bf16 v[132:135], a[68:71], v[108:111], v[132:135]
ds_read_b128 a[100:103], v2 offset:9216
v_add_f32 v25, v25, v27
v_mfma_f32_16x16x32_bf16 v[132:135], a[64:67], v[104:107], v[132:135]
v_exp_f32 v8, v64
v_mfma_f32_16x16x32_bf16 v[136:139], a[72:75], v[96:99], v[136:139]
ds_read_b128 a[104:107], v2 offset:10240
v_mfma_f32_16x16x32_bf16 v[136:139], a[76:79], v[100:103], v[136:139]
buffer_load_dwordx4 v1, s[4:7], s12 offen offset:1024 sc1 lds
v_mfma_f32_16x16x32_bf16 v[140:143], a[76:79], v[108:111], v[140:143]
ds_read_b128 a[108:111], v2 offset:11264
v_mfma_f32_16x16x32_bf16 v[140:143], a[72:75], v[104:107], v[140:143]
s_waitcnt lgkmcnt(4)
v_exp_f32 v9, v65
v_mfma_f32_16x16x32_bf16 v[144:147], a[80:83], v[96:99], v[144:147]
ds_read_b128 a[112:115], v2 offset:12288
v_add_f32 v26, v8, v9
v_mfma_f32_16x16x32_bf16 v[144:147], a[84:87], v[100:103], v[144:147]
buffer_load_dwordx4 v1, s[4:7], s12 offen offset:2048 sc1 lds
v_mfma_f32_16x16x32_bf16 v[148:151], a[84:87], v[108:111], v[148:151]
ds_read_b128 a[116:119], v2 offset:13312
v_cvt_pk_bf16_f32 v112, v8, v9
v_mfma_f32_16x16x32_bf16 v[148:151], a[80:83], v[104:107], v[148:151]
v_exp_f32 v10, v66
v_mfma_f32_16x16x32_bf16 v[152:155], a[88:91], v[96:99], v[152:155]
ds_read_b128 a[120:123], v2 offset:14336
v_add_f32 v26, v26, v10
v_mfma_f32_16x16x32_bf16 v[152:155], a[92:95], v[100:103], v[152:155]
buffer_load_dwordx4 v1, s[4:7], s12 offen offset:3072 sc1 lds
v_mfma_f32_16x16x32_bf16 v[156:159], a[92:95], v[108:111], v[156:159]
s_add_u32 s12, s12, 4096
ds_read_b128 a[124:127], v2 offset:15360
v_mfma_f32_16x16x32_bf16 v[156:159], a[88:91], v[104:107], v[156:159]
s_waitcnt lgkmcnt(4)
v_exp_f32 v11, v67
v_mfma_f32_16x16x32_bf16 v[160:163], a[96:99], v[96:99], v[160:163]
s_add_u32 m0, s18, 102400
ds_read_b128 a[64:67], v2 offset:16384
v_add_f32 v26, v26, v11
v_mfma_f32_16x16x32_bf16 v[160:163], a[100:103], v[100:103], v[160:163]
buffer_load_dwordx4 v1, s[4:7], s12 offen offset:0 sc1 lds
v_mfma_f32_16x16x32_bf16 v[164:167], a[100:103], v[108:111], v[164:167]
ds_read_b128 a[68:71], v2 offset:17408
v_cvt_pk_bf16_f32 v113, v10, v11
v_mfma_f32_16x16x32_bf16 v[164:167], a[96:99], v[104:107], v[164:167]
v_mfma_f32_16x16x32_bf16 v[168:171], a[104:107], v[96:99], v[168:171]
ds_read_b128 a[72:75], v2 offset:18432
v_mfma_f32_16x16x32_bf16 v[168:171], a[108:111], v[100:103], v[168:171]
buffer_load_dwordx4 v1, s[4:7], s12 offen offset:1024 sc1 lds
v_mfma_f32_16x16x32_bf16 v[172:175], a[108:111], v[108:111], v[172:175]
ds_read_b128 a[76:79], v2 offset:19456
v_mfma_f32_16x16x32_bf16 v[172:175], a[104:107], v[104:107], v[172:175]
s_waitcnt lgkmcnt(4)
v_exp_f32 v12, v68
v_mfma_f32_16x16x32_bf16 v[176:179], a[112:115], v[96:99], v[176:179]
ds_read_b128 a[80:83], v2 offset:20480
v_mfma_f32_16x16x32_bf16 v[176:179], a[116:119], v[100:103], v[176:179]
buffer_load_dwordx4 v1, s[4:7], s12 offen offset:2048 sc1 lds
v_mfma_f32_16x16x32_bf16 v[180:183], a[116:119], v[108:111], v[180:183]
ds_read_b128 a[84:87], v2 offset:21504
v_mfma_f32_16x16x32_bf16 v[180:183], a[112:115], v[104:107], v[180:183]
v_exp_f32 v13, v69
v_mfma_f32_16x16x32_bf16 v[184:187], a[120:123], v[96:99], v[184:187]
ds_read_b128 a[88:91], v2 offset:22528
v_add_f32 v27, v12, v13
v_mfma_f32_16x16x32_bf16 v[184:187], a[124:127], v[100:103], v[184:187]
s_waitcnt lgkmcnt(4)
buffer_load_dwordx4 v1, s[4:7], s12 offen offset:3072 sc1 lds
v_mfma_f32_16x16x32_bf16 v[188:191], a[124:127], v[108:111], v[188:191]
s_add_u32 s12, s12, 28672
ds_read_b128 a[92:95], v2 offset:23552
v_cvt_pk_bf16_f32 v120, v12, v13
v_mfma_f32_16x16x32_bf16 v[188:191], a[120:123], v[104:107], v[188:191]
s_sub_u32 s13, s13, 1
v_exp_f32 v14, v70
v_mfma_f32_16x16x32_bf16 v[192:195], a[64:67], v[96:99], v[192:195]
s_cmp_eq_u32 s13, 0
ds_read_b128 a[96:99], v2 offset:24576
v_add_f32 v27, v27, v14
v_mfma_f32_16x16x32_bf16 v[192:195], a[68:71], v[100:103], v[192:195]
s_cselect_b32 s12, s14, s12
v_mfma_f32_16x16x32_bf16 v[196:199], a[68:71], v[108:111], v[196:199]
s_cselect_b32 s13, s15, s13
ds_read_b128 a[100:103], v2 offset:25600
v_mfma_f32_16x16x32_bf16 v[196:199], a[64:67], v[104:107], v[196:199]
s_cselect_b32 s14, 3221225472, s14
v_exp_f32 v15, v71
v_mfma_f32_16x16x32_bf16 v[200:203], a[72:75], v[96:99], v[200:203]
s_waitcnt lgkmcnt(4)
ds_read_b128 a[104:107], v2 offset:26624
v_add_f32 v27, v27, v15
v_mfma_f32_16x16x32_bf16 v[200:203], a[76:79], v[100:103], v[200:203]
v_exp_f32 v8, v72
v_mfma_f32_16x16x32_bf16 v[204:207], a[76:79], v[108:111], v[204:207]
ds_read_b128 a[108:111], v2 offset:27648
v_cvt_pk_bf16_f32 v121, v14, v15
v_mfma_f32_16x16x32_bf16 v[204:207], a[72:75], v[104:107], v[204:207]
v_exp_f32 v9, v73
v_mfma_f32_16x16x32_bf16 v[208:211], a[80:83], v[96:99], v[208:211]
ds_read_b128 a[112:115], v2 offset:28672
v_add_f32 v26, v26, v8
v_mfma_f32_16x16x32_bf16 v[208:211], a[84:87], v[100:103], v[208:211]
v_add_f32 v26, v26, v9
v_cvt_pk_bf16_f32 v114, v8, v9
v_mfma_f32_16x16x32_bf16 v[212:215], a[84:87], v[108:111], v[212:215]
ds_read_b128 a[116:119], v2 offset:29696
v_mfma_f32_16x16x32_bf16 v[212:215], a[80:83], v[104:107], v[212:215]
s_waitcnt lgkmcnt(4)
v_exp_f32 v10, v74
v_mfma_f32_16x16x32_bf16 v[216:219], a[88:91], v[96:99], v[216:219]
ds_read_b128 a[120:123], v2 offset:30720
v_add_f32 v26, v26, v10
v_mfma_f32_16x16x32_bf16 v[216:219], a[92:95], v[100:103], v[216:219]
v_exp_f32 v11, v75
v_mfma_f32_16x16x32_bf16 v[220:223], a[92:95], v[108:111], v[220:223]
s_waitcnt vmcnt(8)
ds_read_b128 a[124:127], v2 offset:31744
v_add_f32 v26, v26, v11
v_mfma_f32_16x16x32_bf16 v[220:223], a[88:91], v[104:107], v[220:223]
PAD_11:
s_cbranch_execz M_tret
s_barrier
v_mfma_f32_16x16x32_bf16 v[224:227], a[96:99], v[96:99], v[224:227]
ds_read_b128 a[64:67], v1 offset:0
v_cvt_pk_bf16_f32 v115, v10, v11
v_mfma_f32_16x16x32_bf16 v[224:227], a[100:103], v[100:103], v[224:227]
v_exp_f32 v12, v76
v_mfma_f32_16x16x32_bf16 v[228:231], a[100:103], v[108:111], v[228:231]
ds_read_b128 a[68:71], v1 offset:1024
v_add_f32 v27, v27, v12
v_mfma_f32_16x16x32_bf16 v[228:231], a[96:99], v[104:107], v[228:231]
s_waitcnt lgkmcnt(4)
v_mfma_f32_16x16x32_bf16 v[232:235], a[104:107], v[96:99], v[232:235]
ds_read_b128 a[72:75], v1 offset:2048
v_mfma_f32_16x16x32_bf16 v[232:235], a[108:111], v[100:103], v[232:235]
v_exp_f32 v13, v77
v_mfma_f32_16x16x32_bf16 v[236:239], a[108:111], v[108:111], v[236:239]
ds_read_b128 a[76:79], v1 offset:3072
v_add_f32 v27, v27, v13
v_mfma_f32_16x16x32_bf16 v[236:239], a[104:107], v[104:107], v[236:239]
v_exp_f32 v14, v78
v_mfma_f32_16x16x32_bf16 v[240:243], a[112:115], v[96:99], v[240:243]
ds_read_b128 a[80:83], v1 offset:4096
v_cvt_pk_bf16_f32 v122, v12, v13
v_mfma_f32_16x16x32_bf16 v[240:243], a[116:119], v[100:103], v[240:243]
v_exp_f32 v15, v79
v_mfma_f32_16x16x32_bf16 v[244:247], a[116:119], v[108:111], v[244:247]
ds_read_b128 a[84:87], v1 offset:5120
v_add_f32 v27, v27, v14
v_mfma_f32_16x16x32_bf16 v[244:247], a[112:115], v[104:107], v[244:247]
s_waitcnt lgkmcnt(4)
v_add_f32 v27, v27, v15
v_cvt_pk_bf16_f32 v123, v14, v15
v_mfma_f32_16x16x32_bf16 v[248:251], a[120:123], v[96:99], v[248:251]
ds_read_b128 a[88:91], v1 offset:6144
v_mfma_f32_16x16x32_bf16 v[248:251], a[124:127], v[100:103], v[248:251]
v_mfma_f32_16x16x32_bf16 v[252:255], a[124:127], v[108:111], v[252:255]
ds_read_b128 a[92:95], v1 offset:7168
v_mfma_f32_16x16x32_bf16 v[252:255], a[120:123], v[104:107], v[252:255]
v_cndmask_b32 v32, v16, v7, s[32:33]
v_cndmask_b32 v33, v16, v7, s[34:35]
v_cndmask_b32 v34, v16, v7, s[36:37]
v_cndmask_b32 v35, v16, v7, s[38:39]
s_nop 1
v_mfma_f32_16x16x32_bf16 v[32:35], a[64:67], a[0:3], v[32:35]
s_add_u32 m0, s18, 131072
ds_read_b128 a[96:99], v1 offset:8192
v_cndmask_b32 v40, v16, v7, s[40:41]
v_mfma_f32_16x16x32_bf16 v[32:35], a[68:71], a[4:7], v[32:35]
s_waitcnt lgkmcnt(4)
buffer_load_dwordx4 v1, s[4:7], s8 offen offset:0 sc1 lds
v_mfma_f32_16x16x32_bf16 v[32:35], a[72:75], a[8:11], v[32:35]
ds_read_b128 a[100:103], v1 offset:9216
v_cndmask_b32 v41, v16, v7, s[42:43]
v_mfma_f32_16x16x32_bf16 v[32:35], a[76:79], a[12:15], v[32:35]
v_cndmask_b32 v42, v16, v7, s[44:45]
v_cndmask_b32 v43, v16, v7, s[46:47]
v_mfma_f32_16x16x32_bf16 v[32:35], a[80:83], a[16:19], v[32:35]
s_waitcnt lgkmcnt(4)
ds_read_b128 a[104:107], v1 offset:10240
v_mfma_f32_16x16x32_bf16 v[32:35], a[84:87], a[20:23], v[32:35]
s_waitcnt lgkmcnt(4)
buffer_load_dwordx4 v1, s[4:7], s8 offen offset:1024 sc1 lds
v_mfma_f32_16x16x32_bf16 v[32:35], a[88:91], a[24:27], v[32:35]
s_waitcnt lgkmcnt(3)
ds_read_b128 a[108:111], v1 offset:11264
v_mfma_f32_16x16x32_bf16 v[32:35], a[92:95], a[28:31], v[32:35]
v_exp_f32 v8, v80
v_mfma_f32_16x16x32_bf16 v[36:39], a[64:67], a[32:35], v[20:23]
ds_read_b128 a[112:115], v1 offset:12288
v_add_f32 v26, v26, v8
v_mfma_f32_16x16x32_bf16 v[36:39], a[68:71], a[36:39], v[36:39]
buffer_load_dwordx4 v1, s[4:7], s8 offen offset:2048 sc1 lds
v_mfma_f32_16x16x32_bf16 v[36:39], a[72:75], a[40:43], v[36:39]
ds_read_b128 a[116:119], v1 offset:13312
v_mfma_f32_16x16x32_bf16 v[36:39], a[76:79], a[44:47], v[36:39]
v_exp_f32 v9, v81
v_mfma_f32_16x16x32_bf16 v[36:39], a[80:83], a[48:51], v[36:39]
ds_read_b128 a[120:123], v1 offset:14336
v_add_f32 v26, v26, v9
v_mfma_f32_16x16x32_bf16 v[36:39], a[84:87], a[52:55], v[36:39]
buffer_load_dwordx4 v1, s[4:7], s8 offen offset:3072 sc1 lds
v_mfma_f32_16x16x32_bf16 v[36:39], a[88:91], a[56:59], v[36:39]
s_add_u32 s8, s8, 4096
ds_read_b128 a[124:127], v1 offset:15360
v_cvt_pk_bf16_f32 v116, v8, v9
v_mfma_f32_16x16x32_bf16 v[36:39], a[92:95], a[60:63], v[36:39]
s_waitcnt lgkmcnt(4)
v_exp_f32 v10, v82
v_mfma_f32_16x16x32_bf16 v[40:43], a[96:99], a[0:3], v[40:43]
s_add_u32 m0, s18, 135168
ds_read_b128 a[64:67], v1 offset:16384
v_cndmask_b32 v48, v16, v7, s[48:49]
v_mfma_f32_16x16x32_bf16 v[40:43], a[100:103], a[4:7], v[40:43]
buffer_load_dwordx4 v1, s[4:7], s8 offen offset:0 sc1 lds
v_mfma_f32_16x16x32_bf16 v[40:43], a[104:107], a[8:11], v[40:43]
ds_read_b128 a[68:71], v1 offset:17408
v_cndmask_b32 v49, v16, v7, s[50:51]
v_mfma_f32_16x16x32_bf16 v[40:43], a[108:111], a[12:15], v[40:43]
s_waitcnt lgkmcnt(4)
v_cndmask_b32 v50, v16, v7, s[52:53]
v_cndmask_b32 v51, v16, v7, s[54:55]
v_mfma_f32_16x16x32_bf16 v[40:43], a[112:115], a[16:19], v[40:43]
ds_read_b128 a[72:75], v1 offset:18432
v_add_f32 v26, v26, v10
v_mfma_f32_16x16x32_bf16 v[40:43], a[116:119], a[20:23], v[40:43]
s_waitcnt lgkmcnt(4)
buffer_load_dwordx4 v1, s[4:7], s8 offen offset:1024 sc1 lds
v_mfma_f32_16x16x32_bf16 v[40:43], a[120:123], a[24:27], v[40:43]
s_waitcnt lgkmcnt(3)
ds_read_b128 a[76:79], v1 offset:19456
v_mfma_f32_16x16x32_bf16 v[40:43], a[124:127], a[28:31], v[40:43]
v_exp_f32 v11, v83
v_mfma_f32_16x16x32_bf16 v[44:47], a[96:99], a[32:35], v[20:23]
ds_read_b128 a[80:83], v1 offset:20480
v_add_f32 v26, v26, v11
v_mfma_f32_16x16x32_bf16 v[44:47], a[100:103], a[36:39], v[44:47]
buffer_load_dwordx4 v1, s[4:7], s8 offen offset:2048 sc1 lds
v_mfma_f32_16x16x32_bf16 v[44:47], a[104:107], a[40:43], v[44:47]
ds_read_b128 a[84:87], v1 offset:21504
v_cvt_pk_bf16_f32 v117, v10, v11
v_mfma_f32_16x16x32_bf16 v[44:47], a[108:111], a[44:47], v[44:47]
v_exp_f32 v12, v84
v_mfma_f32_16x16x32_bf16 v[44:47], a[112:115], a[48:51], v[44:47]
ds_read_b128 a[88:91], v1 offset:22528
v_add_f32 v27, v27, v12
v_mfma_f32_16x16x32_bf16 v[44:47], a[116:119], a[52:55], v[44:47]
buffer_load_dwordx4 v1, s[4:7], s8 offen offset:3072 sc1 lds
v_mfma_f32_16x16x32_bf16 v[44:47], a[120:123], a[56:59], v[44:47]
s_waitcnt lgkmcnt(2)
s_add_u32 s8, s8, 28672
ds_read_b128 a[92:95], v1 offset:23552
v_mfma_f32_16x16x32_bf16 v[44:47], a[124:127], a[60:63], v[44:47]
s_sub_u32 s9, s9, 1
v_exp_f32 v13, v85
v_mfma_f32_16x16x32_bf16 v[48:51], a[64:67], a[0:3], v[48:51]
s_cmp_eq_u32 s9, 0
ds_read_b128 a[96:99], v1 offset:24576
v_cndmask_b32 v56, v16, v7, s[56:57]
v_mfma_f32_16x16x32_bf16 v[48:51], a[68:71], a[4:7], v[48:51]
s_cselect_b32 s8, s10, s8
v_cndmask_b32 v57, v16, v7, s[58:59]
v_cndmask_b32 v58, v16, v7, s[60:61]
v_mfma_f32_16x16x32_bf16 v[48:51], a[72:75], a[8:11], v[48:51]
s_cselect_b32 s9, s11, s9
ds_read_b128 a[100:103], v1 offset:25600
v_cndmask_b32 v59, v16, v7, s[62:63]
v_mfma_f32_16x16x32_bf16 v[48:51], a[76:79], a[12:15], v[48:51]
s_cselect_b32 s10, 3221225472, s10
v_exp_f32 v14, v86
v_mfma_f32_16x16x32_bf16 v[48:51], a[80:83], a[16:19], v[48:51]
s_waitcnt lgkmcnt(4)
ds_read_b128 a[104:107], v1 offset:26624
v_add_f32 v27, v27, v13
v_cvt_pk_bf16_f32 v124, v12, v13
v_mfma_f32_16x16x32_bf16 v[48:51], a[84:87], a[20:23], v[48:51]
s_waitcnt lgkmcnt(4)
v_exp_f32 v15, v87
v_mfma_f32_16x16x32_bf16 v[48:51], a[88:91], a[24:27], v[48:51]
s_waitcnt lgkmcnt(3)
ds_read_b128 a[108:111], v1 offset:27648
v_add_f32 v27, v27, v14
v_mfma_f32_16x16x32_bf16 v[48:51], a[92:95], a[28:31], v[48:51]
v_exp_f32 v8, v88
v_mfma_f32_16x16x32_bf16 v[52:55], a[64:67], a[32:35], v[20:23]
ds_read_b128 a[112:115], v1 offset:28672
v_add_f32 v27, v27, v15
v_mfma_f32_16x16x32_bf16 v[52:55], a[68:71], a[36:39], v[52:55]
v_exp_f32 v9, v89
v_mfma_f32_16x16x32_bf16 v[52:55], a[72:75], a[40:43], v[52:55]
ds_read_b128 a[116:119], v1 offset:29696
v_cvt_pk_bf16_f32 v125, v14, v15
v_mfma_f32_16x16x32_bf16 v[52:55], a[76:79], a[44:47], v[52:55]
v_exp_f32 v10, v90
v_mfma_f32_16x16x32_bf16 v[52:55], a[80:83], a[48:51], v[52:55]
ds_read_b128 a[120:123], v1 offset:30720
v_add_f32 v26, v26, v8
v_mfma_f32_16x16x32_bf16 v[52:55], a[84:87], a[52:55], v[52:55]
v_exp_f32 v11, v91
v_mfma_f32_16x16x32_bf16 v[52:55], a[88:91], a[56:59], v[52:55]
s_waitcnt vmcnt(8) lgkmcnt(4)
ds_read_b128 a[124:127], v1 offset:31744
v_add_f32 v26, v26, v9
v_cvt_pk_bf16_f32 v118, v8, v9
v_mfma_f32_16x16x32_bf16 v[52:55], a[92:95], a[60:63], v[52:55]
s_barrier
v_mfma_f32_16x16x32_bf16 v[56:59], a[96:99], a[0:3], v[56:59]
ds_read_b128 a[64:67], v2 offset:32768
v_add_f32 v26, v26, v10
v_mfma_f32_16x16x32_bf16 v[56:59], a[100:103], a[4:7], v[56:59]
v_exp_f32 v12, v92
v_mfma_f32_16x16x32_bf16 v[56:59], a[104:107], a[8:11], v[56:59]
s_waitcnt lgkmcnt(4)
ds_read_b128 a[68:71], v2 offset:33792
v_add_f32 v26, v26, v11
v_cvt_pk_bf16_f32 v119, v10, v11
v_mfma_f32_16x16x32_bf16 v[56:59], a[108:111], a[12:15], v[56:59]
v_exp_f32 v13, v93
v_mfma_f32_16x16x32_bf16 v[56:59], a[112:115], a[16:19], v[56:59]
s_waitcnt lgkmcnt(4)
ds_read_b128 a[72:75], v2 offset:34816
v_add_f32 v27, v27, v12
v_mfma_f32_16x16x32_bf16 v[56:59], a[116:119], a[20:23], v[56:59]
s_waitcnt lgkmcnt(4)
v_exp_f32 v14, v94
v_mfma_f32_16x16x32_bf16 v[56:59], a[120:123], a[24:27], v[56:59]
s_waitcnt lgkmcnt(3)
ds_read_b128 a[76:79], v2 offset:35840
v_add_f32 v27, v27, v13
v_mfma_f32_16x16x32_bf16 v[56:59], a[124:127], a[28:31], v[56:59]
v_exp_f32 v15, v95
v_mfma_f32_16x16x32_bf16 v[60:63], a[96:99], a[32:35], v[20:23]
ds_read_b128 a[80:83], v2 offset:36864
v_cvt_pk_bf16_f32 v126, v12, v13
v_mfma_f32_16x16x32_bf16 v[60:63], a[100:103], a[36:39], v[60:63]
v_add_f32 v27, v27, v14
v_add_f32 v27, v27, v15
v_mfma_f32_16x16x32_bf16 v[60:63], a[104:107], a[40:43], v[60:63]
ds_read_b128 a[84:87], v2 offset:37888
v_cvt_pk_bf16_f32 v127, v14, v15
v_mfma_f32_16x16x32_bf16 v[60:63], a[108:111], a[44:47], v[60:63]
v_add_f32 v28, v26, v27
v_cmp_nge_f32 vcc, s25, v28
v_mfma_f32_16x16x32_bf16 v[60:63], a[112:115], a[48:51], v[60:63]
ds_read_b128 a[88:91], v2 offset:38912
v_mfma_f32_16x16x32_bf16 v[60:63], a[116:119], a[52:55], v[60:63]
v_mfma_f32_16x16x32_bf16 v[60:63], a[120:123], a[56:59], v[60:63]
ds_read_b128 a[92:95], v2 offset:39936
v_mfma_f32_16x16x32_bf16 v[60:63], a[124:127], a[60:63], v[60:63]
s_waitcnt lgkmcnt(4)
s_cbranch_vccnz Lstub_6
Lback_7:
v_mfma_f32_16x16x32_bf16 v[128:131], a[64:67], v[112:115], v[128:131]
s_add_u32 m0, s18, 65536
ds_read_b128 a[96:99], v2 offset:40960
v_add_f32 v24, v24, v26
v_mfma_f32_16x16x32_bf16 v[128:131], a[68:71], v[116:119], v[128:131]
buffer_load_dwordx4 v1, s[4:7], s12 offen offset:0 sc1 lds
v_mfma_f32_16x16x32_bf16 v[132:135], a[68:71], v[124:127], v[132:135]
ds_read_b128 a[100:103], v2 offset:41984
v_add_f32 v25, v25, v27
v_mfma_f32_16x16x32_bf16 v[132:135], a[64:67], v[120:123], v[132:135]
v_exp_f32 v8, v32
v_mfma_f32_16x16x32_bf16 v[136:139], a[72:75], v[112:115], v[136:139]
ds_read_b128 a[104:107], v2 offset:43008
v_mfma_f32_16x16x32_bf16 v[136:139], a[76:79], v[116:119], v[136:139]
buffer_load_dwordx4 v1, s[4:7], s12 offen offset:1024 sc1 lds
v_mfma_f32_16x16x32_bf16 v[140:143], a[76:79], v[124:127], v[140:143]
ds_read_b128 a[108:111], v2 offset:44032
v_mfma_f32_16x16x32_bf16 v[140:143], a[72:75], v[120:123], v[140:143]
s_waitcnt lgkmcnt(4)
v_exp_f32 v9, v33
v_mfma_f32_16x16x32_bf16 v[144:147], a[80:83], v[112:115], v[144:147]
ds_read_b128 a[112:115], v2 offset:45056
v_add_f32 v26, v8, v9
v_mfma_f32_16x16x32_bf16 v[144:147], a[84:87], v[116:119], v[144:147]
buffer_load_dwordx4 v1, s[4:7], s12 offen offset:2048 sc1 lds
v_mfma_f32_16x16x32_bf16 v[148:151], a[84:87], v[124:127], v[148:151]
ds_read_b128 a[116:119], v2 offset:46080
v_cvt_pk_bf16_f32 v96, v8, v9
v_mfma_f32_16x16x32_bf16 v[148:151], a[80:83], v[120:123], v[148:151]
v_exp_f32 v10, v34
v_mfma_f32_16x16x32_bf16 v[152:155], a[88:91], v[112:115], v[152:155]
ds_read_b128 a[120:123], v2 offset:47104
v_add_f32 v26, v26, v10
v_mfma_f32_16x16x32_bf16 v[152:155], a[92:95], v[116:119], v[152:155]
buffer_load_dwordx4 v1, s[4:7], s12 offen offset:3072 sc1 lds
v_mfma_f32_16x16x32_bf16 v[156:159], a[92:95], v[124:127], v[156:159]
s_add_u32 s12, s12, 4096
ds_read_b128 a[124:127], v2 offset:48128
v_mfma_f32_16x16x32_bf16 v[156:159], a[88:91], v[120:123], v[156:159]
s_waitcnt lgkmcnt(4)
v_exp_f32 v11, v35
v_mfma_f32_16x16x32_bf16 v[160:163], a[96:99], v[112:115], v[160:163]
s_add_u32 m0, s18, 69632
ds_read_b128 a[64:67], v2 offset:49152
v_add_f32 v26, v26, v11
v_mfma_f32_16x16x32_bf16 v[160:163], a[100:103], v[116:119], v[160:163]
buffer_load_dwordx4 v1, s[4:7], s12 offen offset:0 sc1 lds
v_mfma_f32_16x16x32_bf16 v[164:167], a[100:103], v[124:127], v[164:167]
ds_read_b128 a[68:71], v2 offset:50176
v_cvt_pk_bf16_f32 v97, v10, v11
v_mfma_f32_16x16x32_bf16 v[164:167], a[96:99], v[120:123], v[164:167]
v_exp_f32 v12, v36
v_mfma_f32_16x16x32_bf16 v[168:171], a[104:107], v[112:115], v[168:171]
ds_read_b128 a[72:75], v2 offset:51200
v_mfma_f32_16x16x32_bf16 v[168:171], a[108:111], v[116:119], v[168:171]
buffer_load_dwordx4 v1, s[4:7], s12 offen offset:1024 sc1 lds
v_mfma_f32_16x16x32_bf16 v[172:175], a[108:111], v[124:127], v[172:175]
ds_read_b128 a[76:79], v2 offset:52224
v_mfma_f32_16x16x32_bf16 v[172:175], a[104:107], v[120:123], v[172:175]
s_waitcnt lgkmcnt(4)
v_exp_f32 v13, v37
v_mfma_f32_16x16x32_bf16 v[176:179], a[112:115], v[112:115], v[176:179]
ds_read_b128 a[80:83], v2 offset:53248
v_add_f32 v27, v12, v13
v_mfma_f32_16x16x32_bf16 v[176:179], a[116:119], v[116:119], v[176:179]
buffer_load_dwordx4 v1, s[4:7], s12 offen offset:2048 sc1 lds
v_mfma_f32_16x16x32_bf16 v[180:183], a[116:119], v[124:127], v[180:183]
ds_read_b128 a[84:87], v2 offset:54272
v_cvt_pk_bf16_f32 v104, v12, v13
v_mfma_f32_16x16x32_bf16 v[180:183], a[112:115], v[120:123], v[180:183]
v_exp_f32 v14, v38
v_mfma_f32_16x16x32_bf16 v[184:187], a[120:123], v[112:115], v[184:187]
ds_read_b128 a[88:91], v2 offset:55296
v_add_f32 v27, v27, v14
v_mfma_f32_16x16x32_bf16 v[184:187], a[124:127], v[116:119], v[184:187]
buffer_load_dwordx4 v1, s[4:7], s12 offen offset:3072 sc1 lds
v_mfma_f32_16x16x32_bf16 v[188:191], a[124:127], v[124:127], v[188:191]
s_waitcnt lgkmcnt(4)
s_add_u32 s12, s12, 28672
ds_read_b128 a[92:95], v2 offset:56320
v_mfma_f32_16x16x32_bf16 v[188:191], a[120:123], v[120:123], v[188:191]
s_sub_u32 s13, s13, 1
v_exp_f32 v15, v39
v_mfma_f32_16x16x32_bf16 v[192:195], a[64:67], v[112:115], v[192:195]
s_cmp_eq_u32 s13, 0
ds_read_b128 a[96:99], v2 offset:57344
v_add_f32 v27, v27, v15
v_mfma_f32_16x16x32_bf16 v[192:195], a[68:71], v[116:119], v[192:195]
s_cselect_b32 s12, s14, s12
v_exp_f32 v8, v40
v_mfma_f32_16x16x32_bf16 v[196:199], a[68:71], v[124:127], v[196:199]
s_cselect_b32 s13, s15, s13
ds_read_b128 a[100:103], v2 offset:58368
v_cvt_pk_bf16_f32 v105, v14, v15
v_mfma_f32_16x16x32_bf16 v[196:199], a[64:67], v[120:123], v[196:199]
s_cselect_b32 s14, 3221225472, s14
v_exp_f32 v9, v41
v_mfma_f32_16x16x32_bf16 v[200:203], a[72:75], v[112:115], v[200:203]
s_waitcnt lgkmcnt(4)
ds_read_b128 a[104:107], v2 offset:59392
v_add_f32 v26, v26, v8
v_mfma_f32_16x16x32_bf16 v[200:203], a[76:79], v[116:119], v[200:203]
buffer_load_dword v3, off, s[4:7], s80 sc1
v_mfma_f32_16x16x32_bf16 v[204:207], a[76:79], v[124:127], v[204:207]
ds_read_b128 a[108:111], v2 offset:60416
v_add_f32 v26, v26, v9
v_mfma_f32_16x16x32_bf16 v[204:207], a[72:75], v[120:123], v[204:207]
v_exp_f32 v10, v42
v_mfma_f32_16x16x32_bf16 v[208:211], a[80:83], v[112:115], v[208:211]
ds_read_b128 a[112:115], v2 offset:61440
v_cvt_pk_bf16_f32 v98, v8, v9
v_mfma_f32_16x16x32_bf16 v[208:211], a[84:87], v[116:119], v[208:211]
v_exp_f32 v11, v43
v_mfma_f32_16x16x32_bf16 v[212:215], a[84:87], v[124:127], v[212:215]
ds_read_b128 a[116:119], v2 offset:62464
v_add_f32 v26, v26, v10
v_mfma_f32_16x16x32_bf16 v[212:215], a[80:83], v[120:123], v[212:215]
s_waitcnt lgkmcnt(4)
v_exp_f32 v12, v44
v_mfma_f32_16x16x32_bf16 v[216:219], a[88:91], v[112:115], v[216:219]
ds_read_b128 a[120:123], v2 offset:63488
v_add_f32 v26, v26, v11
v_mfma_f32_16x16x32_bf16 v[216:219], a[92:95], v[116:119], v[216:219]
v_exp_f32 v13, v45
v_mfma_f32_16x16x32_bf16 v[220:223], a[92:95], v[124:127], v[220:223]
s_waitcnt vmcnt(9)
ds_read_b128 a[124:127], v2 offset:64512
v_cvt_pk_bf16_f32 v99, v10, v11
v_mfma_f32_16x16x32_bf16 v[220:223], a[88:91], v[120:123], v[220:223]
s_barrier
v_mfma_f32_16x16x32_bf16 v[224:227], a[96:99], v[112:115], v[224:227]
ds_read_b128 a[64:67], v4 offset:0
v_add_f32 v27, v27, v12
v_mfma_f32_16x16x32_bf16 v[224:227], a[100:103], v[116:119], v[224:227]
v_exp_f32 v14, v46
v_mfma_f32_16x16x32_bf16 v[228:231], a[100:103], v[124:127], v[228:231]
ds_read_b128 a[68:71], v4 offset:1024
v_add_f32 v27, v27, v13
v_cvt_pk_bf16_f32 v106, v12, v13
v_mfma_f32_16x16x32_bf16 v[228:231], a[96:99], v[120:123], v[228:231]
s_waitcnt lgkmcnt(4)
v_exp_f32 v15, v47
v_mfma_f32_16x16x32_bf16 v[232:235], a[104:107], v[112:115], v[232:235]
ds_read_b128 a[72:75], v4 offset:2048
v_add_f32 v27, v27, v14
v_mfma_f32_16x16x32_bf16 v[232:235], a[108:111], v[116:119], v[232:235]
v_exp_f32 v8, v48
v_mfma_f32_16x16x32_bf16 v[236:239], a[108:111], v[124:127], v[236:239]
ds_read_b128 a[76:79], v4 offset:3072
v_add_f32 v27, v27, v15
v_mfma_f32_16x16x32_bf16 v[236:239], a[104:107], v[120:123], v[236:239]
v_exp_f32 v9, v49
v_mfma_f32_16x16x32_bf16 v[240:243], a[112:115], v[112:115], v[240:243]
ds_read_b128 a[80:83], v4 offset:4096
v_cvt_pk_bf16_f32 v107, v14, v15
v_mfma_f32_16x16x32_bf16 v[240:243], a[116:119], v[116:119], v[240:243]
v_exp_f32 v10, v50
v_mfma_f32_16x16x32_bf16 v[244:247], a[116:119], v[124:127], v[244:247]
ds_read_b128 a[84:87], v4 offset:5120
v_add_f32 v26, v26, v8
v_mfma_f32_16x16x32_bf16 v[244:247], a[112:115], v[120:123], v[244:247]
s_waitcnt lgkmcnt(4)
v_exp_f32 v11, v51
v_mfma_f32_16x16x32_bf16 v[248:251], a[120:123], v[112:115], v[248:251]
ds_read_b128 a[88:91], v4 offset:6144
v_add_f32 v26, v26, v9
v_cvt_pk_bf16_f32 v100, v8, v9
v_mfma_f32_16x16x32_bf16 v[248:251], a[124:127], v[116:119], v[248:251]
v_add_f32 v26, v26, v10
v_add_f32 v26, v26, v11
v_mfma_f32_16x16x32_bf16 v[252:255], a[124:127], v[124:127], v[252:255]
ds_read_b128 a[92:95], v4 offset:7168
v_cvt_pk_bf16_f32 v101, v10, v11
v_mfma_f32_16x16x32_bf16 v[252:255], a[120:123], v[120:123], v[252:255]
K2_dx1:
v_cndmask_b32 v68, v20, v7, s[32:33]
v_cndmask_b32 v69, v20, v7, s[34:35]
v_cndmask_b32 v70, v20, v7, s[36:37]
v_cndmask_b32 v71, v20, v7, s[38:39]
s_nop 1
v_mfma_f32_16x16x32_bf16 v[68:71], a[64:67], a[32:35], v[68:71]
s_add_u32 m0, s18, 0
ds_read_b128 a[96:99], v4 offset:8192
v_cndmask_b32 v76, v20, v7, s[40:41]
v_cndmask_b32 v79, v20, v7, s[46:47]
v_mfma_f32_16x16x32_bf16 v[68:71], a[68:71], a[36:39], v[68:71]
s_waitcnt lgkmcnt(4)
ds_read_b128 a[100:103], v4 offset:9216
buffer_load_dwordx4 v1, s[4:7], s12 offen offset:0 sc1 lds
v_mfma_f32_16x16x32_bf16 v[68:71], a[72:75], a[40:43], v[68:71]
ds_read_b128 a[104:107], v4 offset:10240
v_cndmask_b32 v77, v20, v7, s[42:43]
v_mfma_f32_16x16x32_bf16 v[68:71], a[76:79], a[44:47], v[68:71]
ds_read_b128 a[108:111], v4 offset:11264
buffer_load_dwordx4 v1, s[4:7], s12 offen offset:1024 sc1 lds
v_mfma_f32_16x16x32_bf16 v[68:71], a[80:83], a[48:51], v[68:71]
s_waitcnt lgkmcnt(6)
ds_read_b128 a[112:115], v4 offset:12288
v_cndmask_b32 v78, v20, v7, s[44:45]
v_mfma_f32_16x16x32_bf16 v[68:71], a[84:87], a[52:55], v[68:71]
s_waitcnt lgkmcnt(6)
ds_read_b128 a[116:119], v4 offset:13312
buffer_load_dwordx4 v1, s[4:7], s12 offen offset:2048 sc1 lds
v_mfma_f32_16x16x32_bf16 v[68:71], a[88:91], a[56:59], v[68:71]
s_waitcnt lgkmcnt(6)
ds_read_b128 a[120:123], v4 offset:14336
v_exp_f32 v8, v52
v_exp_f32 v9, v53
v_mfma_f32_16x16x32_bf16 v[68:71], a[92:95], a[60:63], v[68:71]
s_waitcnt lgkmcnt(5)
ds_read_b128 a[124:127], v4 offset:15360
buffer_load_dwordx4 v1, s[4:7], s12 offen offset:3072 sc1 lds
v_add_f32 v27, v27, v8
v_add_f32 v27, v27, v9
v_cvt_pk_bf16_f32 v108, v8, v9
v_mfma_f32_16x16x32_bf16 v[76:79], a[96:99], a[32:35], v[76:79]
s_add_u32 s12, s12, 4096
s_add_u32 m0, s18, 4096
ds_read_b128 a[64:67], v4 offset:16384
v_cndmask_b32 v86, v20, v7, s[52:53]
v_cndmask_b32 v87, v20, v7, s[54:55]
v_mfma_f32_16x16x32_bf16 v[76:79], a[100:103], a[36:39], v[76:79]
s_waitcnt lgkmcnt(6)
ds_read_b128 a[68:71], v4 offset:17408
buffer_load_dwordx4 v1, s[4:7], s12 offen offset:0 sc1 lds
v_mfma_f32_16x16x32_bf16 v[76:79], a[104:107], a[40:43], v[76:79]
s_waitcnt lgkmcnt(6)
ds_read_b128 a[72:75], v4 offset:18432
v_cndmask_b32 v84, v20, v7, s[48:49]
v_mfma_f32_16x16x32_bf16 v[76:79], a[108:111], a[44:47], v[76:79]
s_waitcnt lgkmcnt(6)
ds_read_b128 a[76:79], v4 offset:19456
buffer_load_dwordx4 v1, s[4:7], s12 offen offset:1024 sc1 lds
v_mfma_f32_16x16x32_bf16 v[76:79], a[112:115], a[48:51], v[76:79]
s_waitcnt lgkmcnt(6)
ds_read_b128 a[80:83], v4 offset:20480
v_cndmask_b32 v85, v20, v7, s[50:51]
v_mfma_f32_16x16x32_bf16 v[76:79], a[116:119], a[52:55], v[76:79]
s_waitcnt lgkmcnt(6)
ds_read_b128 a[84:87], v4 offset:21504
buffer_load_dwordx4 v1, s[4:7], s12 offen offset:2048 sc1 lds
v_mfma_f32_16x16x32_bf16 v[76:79], a[120:123], a[56:59], v[76:79]
s_waitcnt lgkmcnt(6)
ds_read_b128 a[88:91], v4 offset:22528
v_exp_f32 v10, v54
v_exp_f32 v11, v55
v_mfma_f32_16x16x32_bf16 v[76:79], a[124:127], a[60:63], v[76:79]
s_waitcnt lgkmcnt(1)
ds_read_b128 a[92:95], v4 offset:23552
buffer_load_dwordx4 v1, s[4:7], s12 offen offset:3072 sc1 lds
v_add_f32 v27, v27, v10
v_add_f32 v27, v27, v11
v_cvt_pk_bf16_f32 v109, v10, v11
v_mfma_f32_16x16x32_bf16 v[84:87], a[64:67], a[32:35], v[84:87]
s_add_u32 s12, s12, 28672
ds_read_b128 a[96:99], v4 offset:24576
v_cndmask_b32 v92, v20, v7, s[56:57]
v_mfma_f32_16x16x32_bf16 v[84:87], a[68:71], a[36:39], v[84:87]
s_sub_u32 s13, s13, 1
ds_read_b128 a[100:103], v4 offset:25600
v_cndmask_b32 v93, v20, v7, s[58:59]
v_mfma_f32_16x16x32_bf16 v[84:87], a[72:75], a[40:43], v[84:87]
s_cmp_eq_u32 s13, 0
ds_read_b128 a[104:107], v4 offset:26624
v_cndmask_b32 v94, v20, v7, s[60:61]
v_mfma_f32_16x16x32_bf16 v[84:87], a[76:79], a[44:47], v[84:87]
s_cselect_b32 s12, s14, s12
ds_read_b128 a[108:111], v4 offset:27648
v_cndmask_b32 v95, v20, v7, s[62:63]
v_mfma_f32_16x16x32_bf16 v[84:87], a[80:83], a[48:51], v[84:87]
s_cselect_b32 s13, s15, s13
ds_read_b128 a[112:115], v4 offset:28672
v_exp_f32 v12, v56
v_exp_f32 v13, v57
v_mfma_f32_16x16x32_bf16 v[84:87], a[84:87], a[52:55], v[84:87]
s_waitcnt lgkmcnt(6)
s_cselect_b32 s14, 3221225472, s14
ds_read_b128 a[116:119], v4 offset:29696
v_exp_f32 v14, v58
v_add_f32 v26, v26, v12
v_add_f32 v26, v26, v13
v_cvt_pk_bf16_f32 v102, v12, v13
v_mfma_f32_16x16x32_bf16 v[84:87], a[88:91], a[56:59], v[84:87]
s_waitcnt lgkmcnt(6)
ds_read_b128 a[120:123], v4 offset:30720
v_exp_f32 v15, v59
v_exp_f32 v8, v60
v_mfma_f32_16x16x32_bf16 v[84:87], a[92:95], a[60:63], v[84:87]
s_waitcnt vmcnt(8) lgkmcnt(6)
s_barrier
ds_read_b128 a[124:127], v4 offset:31744
v_mfma_f32_16x16x32_bf16 v[92:95], a[96:99], a[32:35], v[92:95]
s_waitcnt lgkmcnt(6)
ds_read_b128 a[64:67], v2 offset:0
v_exp_f32 v9, v61
v_exp_f32 v10, v62
v_mfma_f32_16x16x32_bf16 v[92:95], a[100:103], a[36:39], v[92:95]
s_waitcnt lgkmcnt(6)
ds_read_b128 a[68:71], v2 offset:1024
v_exp_f32 v11, v63
v_mfma_f32_16x16x32_bf16 v[92:95], a[104:107], a[40:43], v[92:95]
s_waitcnt lgkmcnt(6)
ds_read_b128 a[72:75], v2 offset:2048
v_add_f32 v26, v26, v14
v_mfma_f32_16x16x32_bf16 v[92:95], a[108:111], a[44:47], v[92:95]
s_waitcnt lgkmcnt(6)
ds_read_b128 a[76:79], v2 offset:3072
v_add_f32 v26, v26, v15
v_cvt_pk_bf16_f32 v103, v14, v15
v_add_f32 v27, v27, v8
v_mfma_f32_16x16x32_bf16 v[92:95], a[112:115], a[48:51], v[92:95]
s_waitcnt lgkmcnt(6)
ds_read_b128 a[80:83], v2 offset:4096
v_add_f32 v27, v27, v9
v_mfma_f32_16x16x32_bf16 v[92:95], a[116:119], a[52:55], v[92:95]
s_waitcnt lgkmcnt(6)
ds_read_b128 a[84:87], v2 offset:5120
v_cvt_pk_bf16_f32 v110, v8, v9
v_add_f32 v27, v27, v10
v_mfma_f32_16x16x32_bf16 v[92:95], a[120:123], a[56:59], v[92:95]
s_waitcnt lgkmcnt(6)
ds_read_b128 a[88:91], v2 offset:6144
v_add_f32 v27, v27, v11
v_cvt_pk_bf16_f32 v111, v10, v11
v_mfma_f32_16x16x32_bf16 v[92:95], a[124:127], a[60:63], v[92:95]
s_waitcnt lgkmcnt(6)
ds_read_b128 a[92:95], v2 offset:7168
v_add_f32 v28, v26, v27
v_cmp_nge_f32 vcc, s25, v28
s_cbranch_vccnz Lstub_8
Lback_9:
s_cmp_lg_u32 s24, 1
s_cbranch_scc1 K2_plain
v_cmp_gt_u32 vcc, 1, v3
s_cbranch_vccnz K2_tspin
K2_tok:
v_mfma_f32_16x16x32_bf16 v[128:131], a[64:67], v[96:99], v[128:131]
s_waitcnt lgkmcnt(6)
ds_read_b128 a[96:99], v2 offset:8192
v_add_f32 v24, v24, v26
v_mfma_f32_16x16x32_bf16 v[128:131], a[68:71], v[100:103], v[128:131]
buffer_load_dwordx4 v[28:31], v1, s[4:7], s27 offen sc1
v_mfma_f32_16x16x32_bf16 v[132:135], a[68:71], v[108:111], v[132:135]
ds_read_b128 a[100:103], v2 offset:9216
v_add_f32 v25, v25, v27
v_mfma_f32_16x16x32_bf16 v[132:135], a[64:67], v[104:107], v[132:135]
s_waitcnt lgkmcnt(6)
v_exp_f32 v8, v68
v_mfma_f32_16x16x32_bf16 v[136:139], a[72:75], v[96:99], v[136:139]
s_add_u32 s22, s76, 0
ds_read_b128 a[104:107], v2 offset:10240
v_exp_f32 v9, v69
v_mfma_f32_16x16x32_bf16 v[136:139], a[76:79], v[100:103], v[136:139]
buffer_load_dwordx4 v[32:35], v1, s[4:7], s22 offen offset:0 sc1
v_mfma_f32_16x16x32_bf16 v[140:143], a[76:79], v[108:111], v[140:143]
ds_read_b128 a[108:111], v2 offset:11264
v_add_f32 v27, v8, v9
v_mfma_f32_16x16x32_bf16 v[140:143], a[72:75], v[104:107], v[140:143]
s_waitcnt lgkmcnt(5)
v_exp_f32 v10, v70
v_mfma_f32_16x16x32_bf16 v[144:147], a[80:83], v[96:99], v[144:147]
ds_read_b128 a[112:115], v2 offset:12288
v_cvt_pk_bf16_f32 v120, v8, v9
v_mfma_f32_16x16x32_bf16 v[144:147], a[84:87], v[100:103], v[144:147]
buffer_load_dwordx4 v[36:39], v1, s[4:7], s22 offen offset:1024 sc1
v_mfma_f32_16x16x32_bf16 v[148:151], a[84:87], v[108:111], v[148:151]
ds_read_b128 a[116:119], v2 offset:13312
v_add_f32 v27, v27, v10
v_mfma_f32_16x16x32_bf16 v[148:151], a[80:83], v[104:107], v[148:151]
v_exp_f32 v11, v71
v_mfma_f32_16x16x32_bf16 v[152:155], a[88:91], v[96:99], v[152:155]
s_waitcnt lgkmcnt(4)
ds_read_b128 a[120:123], v2 offset:14336
v_add_f32 v27, v27, v11
v_mfma_f32_16x16x32_bf16 v[152:155], a[92:95], v[100:103], v[152:155]
buffer_load_dwordx4 v[40:43], v1, s[4:7], s22 offen offset:2048 sc1
v_mfma_f32_16x16x32_bf16 v[156:159], a[92:95], v[108:111], v[156:159]
ds_read_b128 a[124:127], v2 offset:15360
v_cvt_pk_bf16_f32 v121, v10, v11
v_mfma_f32_16x16x32_bf16 v[156:159], a[88:91], v[104:107], v[156:159]
v_exp_f32 v12, v76
v_mfma_f32_16x16x32_bf16 v[160:163], a[96:99], v[96:99], v[160:163]
ds_read_b128 a[64:67], v2 offset:16384
v_add_f32 v27, v27, v12
v_mfma_f32_16x16x32_bf16 v[160:163], a[100:103], v[100:103], v[160:163]
buffer_load_dwordx4 v[44:47], v1, s[4:7], s22 offen offset:3072 sc1
v_mfma_f32_16x16x32_bf16 v[164:167], a[100:103], v[108:111], v[164:167]
PAD_12:
s_cbranch_execz M_tret
ds_read_b128 a[68:71], v2 offset:17408
v_mfma_f32_16x16x32_bf16 v[164:167], a[96:99], v[104:107], v[164:167]
s_waitcnt lgkmcnt(4)
v_exp_f32 v13, v77
v_mfma_f32_16x16x32_bf16 v[168:171], a[104:107], v[96:99], v[168:171]
s_add_u32 s22, s76, 4096
ds_read_b128 a[72:75], v2 offset:18432
v_add_f32 v27, v27, v13
v_mfma_f32_16x16x32_bf16 v[168:171], a[108:111], v[100:103], v[168:171]
buffer_load_dwordx4 v[48:51], v1, s[4:7], s22 offen offset:0 sc1
v_mfma_f32_16x16x32_bf16 v[172:175], a[108:111], v[108:111], v[172:175]
ds_read_b128 a[76:79], v2 offset:19456
v_cvt_pk_bf16_f32 v122, v12, v13
v_mfma_f32_16x16x32_bf16 v[172:175], a[104:107], v[104:107], v[172:175]
v_exp_f32 v14, v78
v_mfma_f32_16x16x32_bf16 v[176:179], a[112:115], v[96:99], v[176:179]
ds_read_b128 a[80:83], v2 offset:20480
v_add_f32 v27, v27, v14
v_mfma_f32_16x16x32_bf16 v[176:179], a[116:119], v[100:103], v[176:179]
buffer_load_dwordx4 v[52:55], v1, s[4:7], s22 offen offset:1024 sc1
v_mfma_f32_16x16x32_bf16 v[180:183], a[116:119], v[108:111], v[180:183]
ds_read_b128 a[84:87], v2 offset:21504
v_mfma_f32_16x16x32_bf16 v[180:183], a[112:115], v[104:107], v[180:183]
s_waitcnt lgkmcnt(4)
v_exp_f32 v15, v79
v_mfma_f32_16x16x32_bf16 v[184:187], a[120:123], v[96:99], v[184:187]
ds_read_b128 a[88:91], v2 offset:22528
v_add_f32 v27, v27, v15
v_mfma_f32_16x16x32_bf16 v[184:187], a[124:127], v[100:103], v[184:187]
buffer_load_dwordx4 v[56:59], v1, s[4:7], s22 offen offset:2048 sc1
v_mfma_f32_16x16x32_bf16 v[188:191], a[124:127], v[108:111], v[188:191]
ds_read_b128 a[92:95], v2 offset:23552
v_cvt_pk_bf16_f32 v123, v14, v15
v_mfma_f32_16x16x32_bf16 v[188:191], a[120:123], v[104:107], v[188:191]
v_exp_f32 v8, v84
v_mfma_f32_16x16x32_bf16 v[192:195], a[64:67], v[96:99], v[192:195]
ds_read_b128 a[96:99], v2 offset:24576
v_add_f32 v27, v27, v8
v_mfma_f32_16x16x32_bf16 v[192:195], a[68:71], v[100:103], v[192:195]
buffer_load_dwordx4 v[60:63], v1, s[4:7], s22 offen offset:3072 sc1
v_mfma_f32_16x16x32_bf16 v[196:199], a[68:71], v[108:111], v[196:199]
ds_read_b128 a[100:103], v2 offset:25600
v_mfma_f32_16x16x32_bf16 v[196:199], a[64:67], v[104:107], v[196:199]
s_waitcnt lgkmcnt(4)
v_exp_f32 v9, v85
v_mfma_f32_16x16x32_bf16 v[200:203], a[72:75], v[96:99], v[200:203]
s_add_u32 s22, s76, 8192
ds_read_b128 a[104:107], v2 offset:26624
v_add_f32 v27, v27, v9
v_mfma_f32_16x16x32_bf16 v[200:203], a[76:79], v[100:103], v[200:203]
buffer_load_dwordx4 v[64:67], v1, s[4:7], s22 offen offset:0 sc1
v_mfma_f32_16x16x32_bf16 v[204:207], a[76:79], v[108:111], v[204:207]
ds_read_b128 a[108:111], v2 offset:27648
v_cvt_pk_bf16_f32 v124, v8, v9
v_mfma_f32_16x16x32_bf16 v[204:207], a[72:75], v[104:107], v[204:207]
v_exp_f32 v10, v86
v_mfma_f32_16x16x32_bf16 v[208:211], a[80:83], v[96:99], v[208:211]
ds_read_b128 a[112:115], v2 offset:28672
v_add_f32 v27, v27, v10
v_mfma_f32_16x16x32_bf16 v[208:211], a[84:87], v[100:103], v[208:211]
buffer_load_dwordx4 v[72:75], v1, s[4:7], s22 offen offset:1024 sc1
v_mfma_f32_16x16x32_bf16 v[212:215], a[84:87], v[108:111], v[212:215]
ds_read_b128 a[116:119], v2 offset:29696
v_mfma_f32_16x16x32_bf16 v[212:215], a[80:83], v[104:107], v[212:215]
s_waitcnt lgkmcnt(4)
v_exp_f32 v11, v87
v_mfma_f32_16x16x32_bf16 v[216:219], a[88:91], v[96:99], v[216:219]
ds_read_b128 a[120:123], v2 offset:30720
v_add_f32 v27, v27, v11
v_mfma_f32_16x16x32_bf16 v[216:219], a[92:95], v[100:103], v[216:219]
buffer_load_dwordx4 v[80:83], v1, s[4:7], s22 offen offset:2048 sc1
v_mfma_f32_16x16x32_bf16 v[220:223], a[92:95], v[108:111], v[220:223]
s_waitcnt vmcnt(12)
ds_read_b128 a[124:127], v2 offset:31744
v_cvt_pk_bf16_f32 v125, v10, v11
v_mfma_f32_16x16x32_bf16 v[220:223], a[88:91], v[104:107], v[220:223]
s_barrier
v_mfma_f32_16x16x32_bf16 v[224:227], a[96:99], v[96:99], v[224:227]
ds_read_b128 a[64:67], v1 offset:0
v_mfma_f32_16x16x32_bf16 v[224:227], a[100:103], v[100:103], v[224:227]
buffer_load_dwordx4 v[88:91], v1, s[4:7], s22 offen offset:3072 sc1
v_mfma_f32_16x16x32_bf16 v[228:231], a[100:103], v[108:111], v[228:231]
ds_read_b128 a[68:71], v1 offset:1024
v_mfma_f32_16x16x32_bf16 v[228:231], a[96:99], v[104:107], v[228:231]
s_waitcnt lgkmcnt(4)
v_exp_f32 v12, v92
v_mfma_f32_16x16x32_bf16 v[232:235], a[104:107], v[96:99], v[232:235]
ds_read_b128 a[72:75], v1 offset:2048
v_add_f32 v27, v27, v12
v_mfma_f32_16x16x32_bf16 v[232:235], a[108:111], v[100:103], v[232:235]
v_exp_f32 v13, v93
v_mfma_f32_16x16x32_bf16 v[236:239], a[108:111], v[108:111], v[236:239]
ds_read_b128 a[76:79], v1 offset:3072
v_add_f32 v27, v27, v13
v_mfma_f32_16x16x32_bf16 v[236:239], a[104:107], v[104:107], v[236:239]
v_exp_f32 v14, v94
v_mfma_f32_16x16x32_bf16 v[240:243], a[112:115], v[96:99], v[240:243]
ds_read_b128 a[80:83], v1 offset:4096
v_cvt_pk_bf16_f32 v126, v12, v13
v_mfma_f32_16x16x32_bf16 v[240:243], a[116:119], v[100:103], v[240:243]
v_exp_f32 v15, v95
v_mfma_f32_16x16x32_bf16 v[244:247], a[116:119], v[108:111], v[244:247]
ds_read_b128 a[84:87], v1 offset:5120
v_add_f32 v27, v27, v14
v_mfma_f32_16x16x32_bf16 v[244:247], a[112:115], v[104:107], v[244:247]
s_waitcnt lgkmcnt(4)
v_add_f32 v27, v27, v15
v_cvt_pk_bf16_f32 v127, v14, v15
v_mfma_f32_16x16x32_bf16 v[248:251], a[120:123], v[96:99], v[248:251]
ds_read_b128 a[88:91], v1 offset:6144
v_cmp_nge_f32 vcc, s25, v27
v_mfma_f32_16x16x32_bf16 v[248:251], a[124:127], v[100:103], v[248:251]
v_mfma_f32_16x16x32_bf16 v[252:255], a[124:127], v[108:111], v[252:255]
ds_read_b128 a[92:95], v1 offset:7168
v_mfma_f32_16x16x32_bf16 v[252:255], a[120:123], v[104:107], v[252:255]
s_waitcnt lgkmcnt(2)
s_cbranch_vccnz Lstub_10
Lback_11:
v_mfma_f32_16x16x32_bf16 v[132:135], a[64:67], v[120:123], v[132:135]
s_mov_b64 s[36:37], s[86:87]
ds_read_b128 a[96:99], v1 offset:8192
v_add_f32 v25, v25, v27
v_mfma_f32_16x16x32_bf16 v[132:135], a[68:71], v[124:127], v[132:135]
s_mov_b32 s38, 3670016
ds_read_b128 a[100:103], v1 offset:9216
v_accvgpr_read_b32 v112, a184
v_mfma_f32_16x16x32_bf16 v[140:143], a[72:75], v[120:123], v[140:143]
s_mov_b32 s39, 0x20000
ds_read_b128 a[104:107], v1 offset:10240
v_accvgpr_read_b32 v113, a185
v_mfma_f32_16x16x32_bf16 v[140:143], a[76:79], v[124:127], v[140:143]
s_lshl_b32 s8, s29, 3
ds_read_b128 a[108:111], v1 offset:11264
v_accvgpr_read_b32 v114, a186
v_mfma_f32_16x16x32_bf16 v[148:151], a[80:83], v[120:123], v[148:151]
s_add_u32 s8, s8, s3
ds_read_b128 a[112:115], v1 offset:12288
v_accvgpr_read_b32 v115, a187
v_mfma_f32_16x16x32_bf16 v[148:151], a[84:87], v[124:127], v[148:151]
s_waitcnt lgkmcnt(3)
s_lshl_b32 s8, s8, 4
ds_read_b128 a[116:119], v1 offset:13312
v_accvgpr_read_b32 v116, a188
v_mfma_f32_16x16x32_bf16 v[156:159], a[88:91], v[120:123], v[156:159]
s_add_u32 s8, s8, s20
ds_read_b128 a[120:123], v1 offset:14336
v_accvgpr_read_b32 v117, a189
v_mfma_f32_16x16x32_bf16 v[156:159], a[92:95], v[124:127], v[156:159]
s_mul_i32 s8, s8, 14336
ds_read_b128 a[124:127], v1 offset:15360
v_accvgpr_read_b32 v118, a190
v_mfma_f32_16x16x32_bf16 v[164:167], a[96:99], v[120:123], v[164:167]
s_add_u32 s8, s8, 104857600
ds_read_b128 a[64:67], v1 offset:16384
v_accvgpr_read_b32 v119, a191
v_mfma_f32_16x16x32_bf16 v[164:167], a[100:103], v[124:127], v[164:167]
s_waitcnt lgkmcnt(6)
s_add_u32 s12, s8, 917504
ds_read_b128 a[68:71], v1 offset:17408
v_mfma_f32_16x16x32_bf16 v[172:175], a[104:107], v[120:123], v[172:175]
s_waitcnt lgkmcnt(6)
ds_read_b128 a[72:75], v1 offset:18432
v_mfma_f32_16x16x32_bf16 v[172:175], a[108:111], v[124:127], v[172:175]
s_waitcnt lgkmcnt(6)
s_add_u32 s22, s76, 12288
ds_read_b128 a[76:79], v1 offset:19456
v_mfma_f32_16x16x32_bf16 v[180:183], a[112:115], v[120:123], v[180:183]
s_waitcnt lgkmcnt(6)
ds_read_b128 a[80:83], v1 offset:20480
buffer_load_dwordx4 v[96:99], v1, s[4:7], s22 offen offset:0 sc1
v_mfma_f32_16x16x32_bf16 v[180:183], a[116:119], v[124:127], v[180:183]
s_waitcnt lgkmcnt(6)
ds_read_b128 a[84:87], v1 offset:21504
v_mfma_f32_16x16x32_bf16 v[188:191], a[120:123], v[120:123], v[188:191]
s_waitcnt lgkmcnt(6)
ds_read_b128 a[88:91], v1 offset:22528
v_mfma_f32_16x16x32_bf16 v[188:191], a[124:127], v[124:127], v[188:191]
s_waitcnt lgkmcnt(6)
ds_read_b128 a[92:95], v1 offset:23552
buffer_load_dwordx4 v[100:103], v1, s[4:7], s22 offen offset:1024 sc1
v_mfma_f32_16x16x32_bf16 v[196:199], a[64:67], v[120:123], v[196:199]
s_waitcnt lgkmcnt(6)
ds_read_b128 a[96:99], v1 offset:24576
v_mfma_f32_16x16x32_bf16 v[196:199], a[68:71], v[124:127], v[196:199]
s_waitcnt lgkmcnt(6)
ds_read_b128 a[100:103], v1 offset:25600
v_mfma_f32_16x16x32_bf16 v[204:207], a[72:75], v[120:123], v[204:207]
s_waitcnt lgkmcnt(6)
ds_read_b128 a[104:107], v1 offset:26624
buffer_load_dwordx4 v[104:107], v1, s[4:7], s22 offen offset:2048 sc1
v_mfma_f32_16x16x32_bf16 v[204:207], a[76:79], v[124:127], v[204:207]
s_waitcnt lgkmcnt(6)
ds_read_b128 a[108:111], v1 offset:27648
v_mfma_f32_16x16x32_bf16 v[212:215], a[80:83], v[120:123], v[212:215]
s_waitcnt lgkmcnt(6)
ds_read_b128 a[112:115], v1 offset:28672
v_mfma_f32_16x16x32_bf16 v[212:215], a[84:87], v[124:127], v[212:215]
s_waitcnt lgkmcnt(6)
ds_read_b128 a[116:119], v1 offset:29696
buffer_load_dwordx4 v[108:111], v1, s[4:7], s22 offen offset:3072 sc1
v_mfma_f32_16x16x32_bf16 v[220:223], a[88:91], v[120:123], v[220:223]
s_waitcnt lgkmcnt(6)
s_add_u32 m0, s18, 32768
ds_read_b128 a[120:123], v1 offset:30720
v_mfma_f32_16x16x32_bf16 v[220:223], a[92:95], v[124:127], v[220:223]
s_waitcnt lgkmcnt(6)
ds_read_b128 a[124:127], v1 offset:31744
v_mfma_f32_16x16x32_bf16 v[228:231], a[96:99], v[120:123], v[228:231]
s_waitcnt lgkmcnt(6)
buffer_load_dwordx4 v112, s[36:39], s81 offen offset:0 lds
v_mfma_f32_16x16x32_bf16 v[228:231], a[100:103], v[124:127], v[228:231]
s_waitcnt lgkmcnt(5)
buffer_load_dwordx4 v113, s[36:39], s81 offen offset:1024 lds
v_mfma_f32_16x16x32_bf16 v[236:239], a[104:107], v[120:123], v[236:239]
s_waitcnt lgkmcnt(4)
buffer_load_dwordx4 v114, s[36:39], s81 offen offset:2048 lds
v_mfma_f32_16x16x32_bf16 v[236:239], a[108:111], v[124:127], v[236:239]
s_waitcnt lgkmcnt(3)
buffer_load_dwordx4 v115, s[36:39], s81 offen offset:3072 lds
v_mfma_f32_16x16x32_bf16 v[244:247], a[112:115], v[120:123], v[244:247]
s_waitcnt lgkmcnt(2)
s_add_u32 s81, s81, 28672
v_mfma_f32_16x16x32_bf16 v[244:247], a[116:119], v[124:127], v[244:247]
s_waitcnt lgkmcnt(1)
s_add_u32 m0, s18, 36864
v_mfma_f32_16x16x32_bf16 v[252:255], a[120:123], v[120:123], v[252:255]
s_waitcnt lgkmcnt(0)
buffer_load_dwordx4 v112, s[36:39], s81 offen offset:0 lds
v_mfma_f32_16x16x32_bf16 v[252:255], a[124:127], v[124:127], v[252:255]
buffer_load_dwordx4 v113, s[36:39], s81 offen offset:1024 lds
buffer_load_dwordx4 v114, s[36:39], s81 offen offset:2048 lds
buffer_load_dwordx4 v115, s[36:39], s81 offen offset:3072 lds
s_sub_u32 s81, s81, 28544
s_waitcnt vmcnt(24)
v_sub_f32 v8, v16, v28
v_sub_f32 v10, v20, v30
v_max_f32 v9, v8, v10
v_cmp_lt_f32 vcc, 1114636288, v9
s_cbranch_vccnz K2_cfix
K2_cok:
v_exp_f32 v8, v8
v_exp_f32 v10, v10
s_nop 0
v_mov_b32 v9, v8
v_mov_b32 v11, v10
v_fmac_f32 v24, v8, v29
v_fmac_f32 v25, v10, v31
s_mov_b32 s23, 0xffff0000
s_waitcnt vmcnt(23)
v_lshlrev_b32 v68, 16, v32
v_and_b32 v69, s23, v32
v_lshlrev_b32 v70, 16, v33
v_and_b32 v71, s23, v33
v_lshlrev_b32 v76, 16, v34
v_and_b32 v77, s23, v34
v_lshlrev_b32 v78, 16, v35
v_and_b32 v79, s23, v35
v_pk_fma_f32 v[128:129], v[68:69], v[8:9], v[128:129]
v_pk_fma_f32 v[130:131], v[70:71], v[8:9], v[130:131]
v_pk_fma_f32 v[136:137], v[76:77], v[8:9], v[136:137]
v_pk_fma_f32 v[138:139], v[78:79], v[8:9], v[138:139]
v_cvt_pk_bf16_f32 v128, v128, v129
v_cvt_pk_bf16_f32 v129, v130, v131
v_cvt_pk_bf16_f32 v130, v136, v137
v_cvt_pk_bf16_f32 v131, v138, v139
s_waitcnt vmcnt(22)
v_lshlrev_b32 v68, 16, v36
v_and_b32 v69, s23, v36
v_lshlrev_b32 v70, 16, v37
v_and_b32 v71, s23, v37
v_lshlrev_b32 v76, 16, v38
v_and_b32 v77, s23, v38
v_lshlrev_b32 v78, 16, v39
v_and_b32 v79, s23, v39
v_pk_fma_f32 v[144:145], v[68:69], v[8:9], v[144:145]
v_pk_fma_f32 v[146:147], v[70:71], v[8:9], v[146:147]
v_pk_fma_f32 v[152:153], v[76:77], v[8:9], v[152:153]
v_pk_fma_f32 v[154:155], v[78:79], v[8:9], v[154:155]
v_cvt_pk_bf16_f32 v144, v144, v145
v_cvt_pk_bf16_f32 v145, v146, v147
v_cvt_pk_bf16_f32 v146, v152, v153
v_cvt_pk_bf16_f32 v147, v154, v155
s_add_u32 m0, s18, 98304
s_nop 0
buffer_load_dwordx4 v112, s[36:39], s81 offen offset:0 lds
s_waitcnt vmcnt(22)
v_lshlrev_b32 v68, 16, v40
v_and_b32 v69, s23, v40
v_lshlrev_b32 v70, 16, v41
v_and_b32 v71, s23, v41
v_lshlrev_b32 v76, 16, v42
v_and_b32 v77, s23, v42
v_lshlrev_b32 v78, 16, v43
v_and_b32 v79, s23, v43
v_pk_fma_f32 v[160:161], v[68:69], v[8:9], v[160:161]
v_pk_fma_f32 v[162:163], v[70:71], v[8:9], v[162:163]
v_pk_fma_f32 v[168:169], v[76:77], v[8:9], v[168:169]
v_pk_fma_f32 v[170:171], v[78:79], v[8:9], v[170:171]
v_cvt_pk_bf16_f32 v160, v160, v161
v_cvt_pk_bf16_f32 v161, v162, v163
v_cvt_pk_bf16_f32 v162, v168, v169
v_cvt_pk_bf16_f32 v163, v170, v171
s_waitcnt vmcnt(21)
v_lshlrev_b32 v68, 16, v44
v_and_b32 v69, s23, v44
v_lshlrev_b32 v70, 16, v45
v_and_b32 v71, s23, v45
v_lshlrev_b32 v76, 16, v46
v_and_b32 v77, s23, v46
v_lshlrev_b32 v78, 16, v47
v_and_b32 v79, s23, v47
v_pk_fma_f32 v[176:177], v[68:69], v[8:9], v[176:177]
v_pk_fma_f32 v[178:179], v[70:71], v[8:9], v[178:179]
v_pk_fma_f32 v[184:185], v[76:77], v[8:9], v[184:185]
v_pk_fma_f32 v[186:187], v[78:79], v[8:9], v[186:187]
v_cvt_pk_bf16_f32 v176, v176, v177
v_cvt_pk_bf16_f32 v177, v178, v179
v_cvt_pk_bf16_f32 v178, v184, v185
v_cvt_pk_bf16_f32 v179, v186, v187
buffer_load_dwordx4 v113, s[36:39], s81 offen offset:1024 lds
s_waitcnt vmcnt(21)
v_lshlrev_b32 v68, 16, v48
v_and_b32 v69, s23, v48
v_lshlrev_b32 v70, 16, v49
v_and_b32 v71, s23, v49
v_lshlrev_b32 v76, 16, v50
v_and_b32 v77, s23, v50
v_lshlrev_b32 v78, 16, v51
v_and_b32 v79, s23, v51
v_pk_fma_f32 v[192:193], v[68:69], v[8:9], v[192:193]
v_pk_fma_f32 v[194:195], v[70:71], v[8:9], v[194:195]
v_pk_fma_f32 v[200:201], v[76:77], v[8:9], v[200:201]
v_pk_fma_f32 v[202:203], v[78:79], v[8:9], v[202:203]
v_cvt_pk_bf16_f32 v192, v192, v193
v_cvt_pk_bf16_f32 v193, v194, v195
v_cvt_pk_bf16_f32 v194, v200, v201
v_cvt_pk_bf16_f32 v195, v202, v203
s_waitcnt vmcnt(20)
v_lshlrev_b32 v68, 16, v52
v_and_b32 v69, s23, v52
v_lshlrev_b32 v70, 16, v53
v_and_b32 v71, s23, v53
v_lshlrev_b32 v76, 16, v54
v_and_b32 v77, s23, v54
v_lshlrev_b32 v78, 16, v55
v_and_b32 v79, s23, v55
v_pk_fma_f32 v[208:209], v[68:69], v[8:9], v[208:209]
v_pk_fma_f32 v[210:211], v[70:71], v[8:9], v[210:211]
v_pk_fma_f32 v[216:217], v[76:77], v[8:9], v[216:217]
v_pk_fma_f32 v[218:219], v[78:79], v[8:9], v[218:219]
v_cvt_pk_bf16_f32 v208, v208, v209
v_cvt_pk_bf16_f32 v209, v210, v211
v_cvt_pk_bf16_f32 v210, v216, v217
v_cvt_pk_bf16_f32 v211, v218, v219
buffer_load_dwordx4 v114, s[36:39], s81 offen offset:2048 lds
s_waitcnt vmcnt(20)
v_lshlrev_b32 v68, 16, v56
v_and_b32 v69, s23, v56
v_lshlrev_b32 v70, 16, v57
v_and_b32 v71, s23, v57
v_lshlrev_b32 v76, 16, v58
v_and_b32 v77, s23, v58
v_lshlrev_b32 v78, 16, v59
v_and_b32 v79, s23, v59
v_pk_fma_f32 v[224:225], v[68:69], v[8:9], v[224:225]
v_pk_fma_f32 v[226:227], v[70:71], v[8:9], v[226:227]
v_pk_fma_f32 v[232:233], v[76:77], v[8:9], v[232:233]
v_pk_fma_f32 v[234:235], v[78:79], v[8:9], v[234:235]
v_cvt_pk_bf16_f32 v224, v224, v225
v_cvt_pk_bf16_f32 v225, v226, v227
v_cvt_pk_bf16_f32 v226, v232, v233
v_cvt_pk_bf16_f32 v227, v234, v235
s_waitcnt vmcnt(19)
v_lshlrev_b32 v68, 16, v60
v_and_b32 v69, s23, v60
v_lshlrev_b32 v70, 16, v61
v_and_b32 v71, s23, v61
v_lshlrev_b32 v76, 16, v62
v_and_b32 v77, s23, v62
v_lshlrev_b32 v78, 16, v63
v_and_b32 v79, s23, v63
v_pk_fma_f32 v[240:241], v[68:69], v[8:9], v[240:241]
v_pk_fma_f32 v[242:243], v[70:71], v[8:9], v[242:243]
v_pk_fma_f32 v[248:249], v[76:77], v[8:9], v[248:249]
v_pk_fma_f32 v[250:251], v[78:79], v[8:9], v[250:251]
v_cvt_pk_bf16_f32 v240, v240, v241
v_cvt_pk_bf16_f32 v241, v242, v243
v_cvt_pk_bf16_f32 v242, v248, v249
v_cvt_pk_bf16_f32 v243, v250, v251
buffer_load_dwordx4 v115, s[36:39], s81 offen offset:3072 lds
s_waitcnt vmcnt(19)
v_lshlrev_b32 v68, 16, v64
v_and_b32 v69, s23, v64
v_lshlrev_b32 v70, 16, v65
v_and_b32 v71, s23, v65
v_lshlrev_b32 v76, 16, v66
v_and_b32 v77, s23, v66
v_lshlrev_b32 v78, 16, v67
v_and_b32 v79, s23, v67
v_pk_fma_f32 v[132:133], v[68:69], v[10:11], v[132:133]
v_pk_fma_f32 v[134:135], v[70:71], v[10:11], v[134:135]
v_pk_fma_f32 v[140:141], v[76:77], v[10:11], v[140:141]
v_pk_fma_f32 v[142:143], v[78:79], v[10:11], v[142:143]
v_cvt_pk_bf16_f32 v132, v132, v133
v_cvt_pk_bf16_f32 v133, v134, v135
v_cvt_pk_bf16_f32 v134, v140, v141
v_cvt_pk_bf16_f32 v135, v142, v143
s_waitcnt vmcnt(18)
v_lshlrev_b32 v68, 16, v72
v_and_b32 v69, s23, v72
v_lshlrev_b32 v70, 16, v73
v_and_b32 v71, s23, v73
v_lshlrev_b32 v76, 16, v74
v_and_b32 v77, s23, v74
v_lshlrev_b32 v78, 16, v75
v_and_b32 v79, s23, v75
v_pk_fma_f32 v[148:149], v[68:69], v[10:11], v[148:149]
v_pk_fma_f32 v[150:151], v[70:71], v[10:11], v[150:151]
v_pk_fma_f32 v[156:157], v[76:77], v[10:11], v[156:157]
v_pk_fma_f32 v[158:159], v[78:79], v[10:11], v[158:159]
v_cvt_pk_bf16_f32 v148, v148, v149
v_cvt_pk_bf16_f32 v149, v150, v151
v_cvt_pk_bf16_f32 v150, v156, v157
v_cvt_pk_bf16_f32 v151, v158, v159
s_add_u32 s81, s81, 28672
s_add_u32 m0, s18, 102400
s_nop 0
buffer_load_dwordx4 v112, s[36:39], s81 offen offset:0 lds
s_waitcnt vmcnt(18)
v_lshlrev_b32 v68, 16, v80
v_and_b32 v69, s23, v80
v_lshlrev_b32 v70, 16, v81
v_and_b32 v71, s23, v81
v_lshlrev_b32 v76, 16, v82
v_and_b32 v77, s23, v82
v_lshlrev_b32 v78, 16, v83
v_and_b32 v79, s23, v83
v_pk_fma_f32 v[164:165], v[68:69], v[10:11], v[164:165]
v_pk_fma_f32 v[166:167], v[70:71], v[10:11], v[166:167]
v_pk_fma_f32 v[172:173], v[76:77], v[10:11], v[172:173]
v_pk_fma_f32 v[174:175], v[78:79], v[10:11], v[174:175]
v_cvt_pk_bf16_f32 v164, v164, v165
v_cvt_pk_bf16_f32 v165, v166, v167
v_cvt_pk_bf16_f32 v166, v172, v173
v_cvt_pk_bf16_f32 v167, v174, v175
s_waitcnt vmcnt(5)
s_barrier
v_lshlrev_b32 v68, 16, v88
v_and_b32 v69, s23, v88
v_lshlrev_b32 v70, 16, v89
v_and_b32 v71, s23, v89
v_lshlrev_b32 v76, 16, v90
v_and_b32 v77, s23, v90
v_lshlrev_b32 v78, 16, v91
v_and_b32 v79, s23, v91
v_pk_fma_f32 v[180:181], v[68:69], v[10:11], v[180:181]
v_pk_fma_f32 v[182:183], v[70:71], v[10:11], v[182:183]
v_pk_fma_f32 v[188:189], v[76:77], v[10:11], v[188:189]
v_pk_fma_f32 v[190:191], v[78:79], v[10:11], v[190:191]
v_cvt_pk_bf16_f32 v180, v180, v181
v_cvt_pk_bf16_f32 v181, v182, v183
v_cvt_pk_bf16_f32 v182, v188, v189
v_cvt_pk_bf16_f32 v183, v190, v191
buffer_load_dwordx4 v113, s[36:39], s81 offen offset:1024 lds
ds_read_b64_tr_b16 a[64:65], v116 offset:0
ds_read_b64_tr_b16 a[66:67], v116 offset:2048
ds_read_b64_tr_b16 a[68:69], v116 offset:4096
ds_read_b64_tr_b16 a[70:71], v116 offset:6144
v_lshlrev_b32 v68, 16, v96
v_and_b32 v69, s23, v96
v_lshlrev_b32 v70, 16, v97
v_and_b32 v71, s23, v97
v_lshlrev_b32 v76, 16, v98
v_and_b32 v77, s23, v98
v_lshlrev_b32 v78, 16, v99
v_and_b32 v79, s23, v99
v_pk_fma_f32 v[196:197], v[68:69], v[10:11], v[196:197]
v_pk_fma_f32 v[198:199], v[70:71], v[10:11], v[198:199]
v_pk_fma_f32 v[204:205], v[76:77], v[10:11], v[204:205]
v_pk_fma_f32 v[206:207], v[78:79], v[10:11], v[206:207]
v_cvt_pk_bf16_f32 v196, v196, v197
v_cvt_pk_bf16_f32 v197, v198, v199
v_cvt_pk_bf16_f32 v198, v204, v205
v_cvt_pk_bf16_f32 v199, v206, v207
ds_read_b64_tr_b16 a[72:73], v116 offset:8192
ds_read_b64_tr_b16 a[74:75], v116 offset:10240
ds_read_b64_tr_b16 a[76:77], v116 offset:12288
ds_read_b64_tr_b16 a[78:79], v116 offset:14336
v_lshlrev_b32 v68, 16, v100
v_and_b32 v69, s23, v100
v_lshlrev_b32 v70, 16, v101
v_and_b32 v71, s23, v101
v_lshlrev_b32 v76, 16, v102
v_and_b32 v77, s23, v102
v_lshlrev_b32 v78, 16, v103
v_and_b32 v79, s23, v103
v_pk_fma_f32 v[212:213], v[68:69], v[10:11], v[212:213]
v_pk_fma_f32 v[214:215], v[70:71], v[10:11], v[214:215]
v_pk_fma_f32 v[220:221], v[76:77], v[10:11], v[220:221]
v_pk_fma_f32 v[222:223], v[78:79], v[10:11], v[222:223]
v_cvt_pk_bf16_f32 v212, v212, v213
v_cvt_pk_bf16_f32 v213, v214, v215
v_cvt_pk_bf16_f32 v214, v220, v221
v_cvt_pk_bf16_f32 v215, v222, v223
buffer_load_dwordx4 v114, s[36:39], s81 offen offset:2048 lds
ds_read_b64_tr_b16 a[80:81], v116 offset:16384
ds_read_b64_tr_b16 a[82:83], v116 offset:18432
ds_read_b64_tr_b16 a[84:85], v116 offset:20480
ds_read_b64_tr_b16 a[86:87], v116 offset:22528
v_lshlrev_b32 v68, 16, v104
v_and_b32 v69, s23, v104
v_lshlrev_b32 v70, 16, v105
v_and_b32 v71, s23, v105
v_lshlrev_b32 v76, 16, v106
v_and_b32 v77, s23, v106
v_lshlrev_b32 v78, 16, v107
v_and_b32 v79, s23, v107
v_pk_fma_f32 v[228:229], v[68:69], v[10:11], v[228:229]
v_pk_fma_f32 v[230:231], v[70:71], v[10:11], v[230:231]
v_pk_fma_f32 v[236:237], v[76:77], v[10:11], v[236:237]
v_pk_fma_f32 v[238:239], v[78:79], v[10:11], v[238:239]
v_cvt_pk_bf16_f32 v228, v228, v229
v_cvt_pk_bf16_f32 v229, v230, v231
v_cvt_pk_bf16_f32 v230, v236, v237
v_cvt_pk_bf16_f32 v231, v238, v239
ds_read_b64_tr_b16 a[88:89], v116 offset:24576
ds_read_b64_tr_b16 a[90:91], v116 offset:26624
ds_read_b64_tr_b16 a[92:93], v116 offset:28672
ds_read_b64_tr_b16 a[94:95], v116 offset:30720
v_lshlrev_b32 v68, 16, v108
v_and_b32 v69, s23, v108
v_lshlrev_b32 v70, 16, v109
v_and_b32 v71, s23, v109
v_lshlrev_b32 v76, 16, v110
v_and_b32 v77, s23, v110
v_lshlrev_b32 v78, 16, v111
v_and_b32 v79, s23, v111
v_pk_fma_f32 v[244:245], v[68:69], v[10:11], v[244:245]
v_pk_fma_f32 v[246:247], v[70:71], v[10:11], v[246:247]
v_pk_fma_f32 v[252:253], v[76:77], v[10:11], v[252:253]
v_pk_fma_f32 v[254:255], v[78:79], v[10:11], v[254:255]
v_cvt_pk_bf16_f32 v244, v244, v245
v_cvt_pk_bf16_f32 v245, v246, v247
v_cvt_pk_bf16_f32 v246, v252, v253
v_cvt_pk_bf16_f32 v247, v254, v255
buffer_load_dwordx4 v115, s[36:39], s81 offen offset:3072 lds
s_sub_u32 s81, s81, 28544
v_add_u32 v116, 65536, v116
K2_done:
PAD_13:
s_cbranch_execz PAD_17
s_waitcnt lgkmcnt(0)
s_nop 0
v_mfma_f32_16x16x32_bf16 v[32:35], a[64:67], v[128:131], 0
s_add_u32 m0, s18, 131072
ds_read_b64_tr_b16 a[96:97], v117 offset:0
v_mov_b32 v28, v24
v_mfma_f32_16x16x32_bf16 v[32:35], a[68:71], v[144:147], v[32:35]
buffer_load_dwordx4 v112, s[36:39], s81 offen offset:0 lds
ds_read_b64_tr_b16 a[98:99], v117 offset:2048
v_mfma_f32_16x16x32_bf16 v[32:35], a[72:75], v[160:163], v[32:35]
ds_read_b64_tr_b16 a[100:101], v117 offset:4096
v_permlane16_swap_b32 v24, v28
v_mfma_f32_16x16x32_bf16 v[32:35], a[76:79], v[176:179], v[32:35]
ds_read_b64_tr_b16 a[102:103], v117 offset:6144
v_add_f32 v24, v24, v28
v_mfma_f32_16x16x32_bf16 v[32:35], a[80:83], v[192:195], v[32:35]
buffer_load_dwordx4 v113, s[36:39], s81 offen offset:1024 lds
ds_read_b64_tr_b16 a[104:105], v117 offset:8192
v_mfma_f32_16x16x32_bf16 v[32:35], a[84:87], v[208:211], v[32:35]
ds_read_b64_tr_b16 a[106:107], v117 offset:10240
v_mov_b32 v28, v24
v_mfma_f32_16x16x32_bf16 v[32:35], a[88:91], v[224:227], v[32:35]
ds_read_b64_tr_b16 a[108:109], v117 offset:12288
v_lshrrev_b32 v20, 4, v1
v_mfma_f32_16x16x32_bf16 v[32:35], a[92:95], v[240:243], v[32:35]
buffer_load_dwordx4 v114, s[36:39], s81 offen offset:2048 lds
ds_read_b64_tr_b16 a[110:111], v117 offset:14336
v_mfma_f32_16x16x32_bf16 v[36:39], a[64:67], v[132:135], 0
ds_read_b64_tr_b16 a[112:113], v117 offset:16384
v_permlane32_swap_b32 v24, v28
v_mfma_f32_16x16x32_bf16 v[36:39], a[68:71], v[148:151], v[36:39]
ds_read_b64_tr_b16 a[114:115], v117 offset:18432
v_add_f32 v24, v24, v28
v_mfma_f32_16x16x32_bf16 v[36:39], a[72:75], v[164:167], v[36:39]
buffer_load_dwordx4 v115, s[36:39], s81 offen offset:3072 lds
ds_read_b64_tr_b16 a[116:117], v117 offset:20480
v_mfma_f32_16x16x32_bf16 v[36:39], a[76:79], v[180:183], v[36:39]
ds_read_b64_tr_b16 a[118:119], v117 offset:22528
v_mov_b32 v29, v25
v_mfma_f32_16x16x32_bf16 v[36:39], a[80:83], v[196:199], v[36:39]
s_add_u32 s81, s81, 28672
s_add_u32 m0, s18, 135168
ds_read_b64_tr_b16 a[120:121], v117 offset:24576
v_mfma_f32_16x16x32_bf16 v[36:39], a[84:87], v[212:215], v[36:39]
buffer_load_dwordx4 v112, s[36:39], s81 offen offset:0 lds
ds_read_b64_tr_b16 a[122:123], v117 offset:26624
v_mfma_f32_16x16x32_bf16 v[36:39], a[88:91], v[228:231], v[36:39]
ds_read_b64_tr_b16 a[124:125], v117 offset:28672
v_permlane16_swap_b32 v25, v29
v_mfma_f32_16x16x32_bf16 v[36:39], a[92:95], v[244:247], v[36:39]
s_waitcnt lgkmcnt(8)
ds_read_b64_tr_b16 a[126:127], v117 offset:30720
v_add_u32 v117, 65536, v117
v_mfma_f32_16x16x32_bf16 v[40:43], a[96:99], v[128:131], 0
buffer_load_dwordx4 v113, s[36:39], s81 offen offset:1024 lds
ds_read_b64_tr_b16 a[64:65], v118 offset:0
v_mfma_f32_16x16x32_bf16 v[40:43], a[100:103], v[144:147], v[40:43]
ds_read_b64_tr_b16 a[66:67], v118 offset:2048
v_add_f32 v25, v25, v29
v_mfma_f32_16x16x32_bf16 v[40:43], a[104:107], v[160:163], v[40:43]
s_waitcnt lgkmcnt(8)
ds_read_b64_tr_b16 a[68:69], v118 offset:4096
v_mov_b32 v29, v25
v_mfma_f32_16x16x32_bf16 v[40:43], a[108:111], v[176:179], v[40:43]
buffer_load_dwordx4 v114, s[36:39], s81 offen offset:2048 lds
ds_read_b64_tr_b16 a[70:71], v118 offset:6144
v_mfma_f32_16x16x32_bf16 v[40:43], a[112:115], v[192:195], v[40:43]
s_waitcnt lgkmcnt(8)
ds_read_b64_tr_b16 a[72:73], v118 offset:8192
v_permlane32_swap_b32 v25, v29
v_mfma_f32_16x16x32_bf16 v[40:43], a[116:119], v[208:211], v[40:43]
s_waitcnt lgkmcnt(7)
ds_read_b64_tr_b16 a[74:75], v118 offset:10240
v_add_f32 v25, v25, v29
v_mfma_f32_16x16x32_bf16 v[40:43], a[120:123], v[224:227], v[40:43]
s_waitcnt lgkmcnt(6)
buffer_load_dwordx4 v115, s[36:39], s81 offen offset:3072 lds
ds_read_b64_tr_b16 a[76:77], v118 offset:12288
v_mfma_f32_16x16x32_bf16 v[40:43], a[124:127], v[240:243], v[40:43]
ds_read_b64_tr_b16 a[78:79], v118 offset:14336
v_rcp_f32 v24, v24
v_mfma_f32_16x16x32_bf16 v[44:47], a[96:99], v[132:135], 0
s_sub_u32 s81, s81, 28544
s_add_u32 m0, s18, 65536
ds_read_b64_tr_b16 a[80:81], v118 offset:16384
v_mfma_f32_16x16x32_bf16 v[44:47], a[100:103], v[148:151], v[44:47]
PAD_14:
s_cbranch_execz PAD_18
buffer_load_dwordx4 v112, s[36:39], s81 offen offset:0 lds
ds_read_b64_tr_b16 a[82:83], v118 offset:18432
v_mfma_f32_16x16x32_bf16 v[44:47], a[104:107], v[164:167], v[44:47]
ds_read_b64_tr_b16 a[84:85], v118 offset:20480
v_rcp_f32 v25, v25
v_mfma_f32_16x16x32_bf16 v[44:47], a[108:111], v[180:183], v[44:47]
ds_read_b64_tr_b16 a[86:87], v118 offset:22528
v_and_b32 v19, 15, v20
v_mfma_f32_16x16x32_bf16 v[44:47], a[112:115], v[196:199], v[44:47]
buffer_load_dwordx4 v113, s[36:39], s81 offen offset:1024 lds
ds_read_b64_tr_b16 a[88:89], v118 offset:24576
v_mfma_f32_16x16x32_bf16 v[44:47], a[116:119], v[212:215], v[44:47]
ds_read_b64_tr_b16 a[90:91], v118 offset:26624
v_mul_f32 v32, v32, v24
v_mfma_f32_16x16x32_bf16 v[44:47], a[120:123], v[228:231], v[44:47]
ds_read_b64_tr_b16 a[92:93], v118 offset:28672
v_mul_f32 v33, v33, v24
v_mfma_f32_16x16x32_bf16 v[44:47], a[124:127], v[244:247], v[44:47]
s_waitcnt lgkmcnt(8)
ds_read_b64_tr_b16 a[94:95], v118 offset:30720
v_add_u32 v118, 65536, v118
v_mfma_f32_16x16x32_bf16 v[48:51], a[64:67], v[128:131], 0
buffer_load_dwordx4 v114, s[36:39], s81 offen offset:2048 lds
ds_read_b64_tr_b16 a[96:97], v119 offset:0
v_mfma_f32_16x16x32_bf16 v[48:51], a[68:71], v[144:147], v[48:51]
ds_read_b64_tr_b16 a[98:99], v119 offset:2048
v_mul_f32 v34, v34, v24
v_mfma_f32_16x16x32_bf16 v[48:51], a[72:75], v[160:163], v[48:51]
s_waitcnt lgkmcnt(8)
ds_read_b64_tr_b16 a[100:101], v119 offset:4096
v_mul_f32 v35, v35, v24
v_mfma_f32_16x16x32_bf16 v[48:51], a[76:79], v[176:179], v[48:51]
buffer_load_dwordx4 v115, s[36:39], s81 offen offset:3072 lds
ds_read_b64_tr_b16 a[102:103], v119 offset:6144
v_mfma_f32_16x16x32_bf16 v[48:51], a[80:83], v[192:195], v[48:51]
s_waitcnt lgkmcnt(6)
ds_read_b64_tr_b16 a[104:105], v119 offset:8192
v_mul_f32 v40, v40, v24
v_mfma_f32_16x16x32_bf16 v[48:51], a[84:87], v[208:211], v[48:51]
s_add_u32 s81, s81, 28672
s_add_u32 m0, s18, 69632
ds_read_b64_tr_b16 a[106:107], v119 offset:10240
v_mfma_f32_16x16x32_bf16 v[48:51], a[88:91], v[224:227], v[48:51]
s_waitcnt lgkmcnt(6)
buffer_load_dwordx4 v112, s[36:39], s81 offen offset:0 lds
ds_read_b64_tr_b16 a[108:109], v119 offset:12288
v_mfma_f32_16x16x32_bf16 v[48:51], a[92:95], v[240:243], v[48:51]
ds_read_b64_tr_b16 a[110:111], v119 offset:14336
v_mul_f32 v41, v41, v24
v_mfma_f32_16x16x32_bf16 v[52:55], a[64:67], v[132:135], 0
ds_read_b64_tr_b16 a[112:113], v119 offset:16384
v_mul_f32 v42, v42, v24
v_mfma_f32_16x16x32_bf16 v[52:55], a[68:71], v[148:151], v[52:55]
buffer_load_dwordx4 v113, s[36:39], s81 offen offset:1024 lds
ds_read_b64_tr_b16 a[114:115], v119 offset:18432
v_mfma_f32_16x16x32_bf16 v[52:55], a[72:75], v[164:167], v[52:55]
ds_read_b64_tr_b16 a[116:117], v119 offset:20480
v_mul_f32 v43, v43, v24
v_mfma_f32_16x16x32_bf16 v[52:55], a[76:79], v[180:183], v[52:55]
ds_read_b64_tr_b16 a[118:119], v119 offset:22528
v_cvt_pk_bf16_f32 v32, v32, v33
v_mfma_f32_16x16x32_bf16 v[52:55], a[80:83], v[196:199], v[52:55]
buffer_load_dwordx4 v114, s[36:39], s81 offen offset:2048 lds
ds_read_b64_tr_b16 a[120:121], v119 offset:24576
v_mfma_f32_16x16x32_bf16 v[52:55], a[84:87], v[212:215], v[52:55]
ds_read_b64_tr_b16 a[122:123], v119 offset:26624
v_cvt_pk_bf16_f32 v33, v34, v35
v_mfma_f32_16x16x32_bf16 v[52:55], a[88:91], v[228:231], v[52:55]
ds_read_b64_tr_b16 a[124:125], v119 offset:28672
ds_read_b64_tr_b16 a[126:127], v119 offset:30720
v_mfma_f32_16x16x32_bf16 v[52:55], a[92:95], v[244:247], v[52:55]
s_waitcnt vmcnt(15) lgkmcnt(9)
s_barrier
v_add_u32 v119, 65536, v119
v_mfma_f32_16x16x32_bf16 v[56:59], a[96:99], v[128:131], 0
buffer_load_dwordx4 v115, s[36:39], s81 offen offset:3072 lds
ds_read_b64_tr_b16 a[64:65], v116 offset:0
v_mfma_f32_16x16x32_bf16 v[56:59], a[100:103], v[144:147], v[56:59]
s_waitcnt lgkmcnt(8)
ds_read_b64_tr_b16 a[66:67], v116 offset:2048
v_cvt_pk_bf16_f32 v34, v40, v41
v_mfma_f32_16x16x32_bf16 v[56:59], a[104:107], v[160:163], v[56:59]
s_sub_u32 s81, s81, 28544
ds_read_b64_tr_b16 a[68:69], v116 offset:4096
v_cvt_pk_bf16_f32 v35, v42, v43
v_mfma_f32_16x16x32_bf16 v[56:59], a[108:111], v[176:179], v[56:59]
s_waitcnt lgkmcnt(8)
buffer_store_dwordx4 v[32:35], v1, s[4:7], s8 offen offset:0 sc1
ds_read_b64_tr_b16 a[70:71], v116 offset:6144
v_mfma_f32_16x16x32_bf16 v[56:59], a[112:115], v[192:195], v[56:59]
s_waitcnt lgkmcnt(8)
ds_read_b64_tr_b16 a[72:73], v116 offset:8192
v_mul_f32 v36, v36, v25
v_mfma_f32_16x16x32_bf16 v[56:59], a[116:119], v[208:211], v[56:59]
s_waitcnt lgkmcnt(7)
ds_read_b64_tr_b16 a[74:75], v116 offset:10240
v_mul_f32 v37, v37, v25
v_mfma_f32_16x16x32_bf16 v[56:59], a[120:123], v[224:227], v[56:59]
s_waitcnt lgkmcnt(6)
ds_read_b64_tr_b16 a[76:77], v116 offset:12288
v_mul_f32 v38, v38, v25
v_mfma_f32_16x16x32_bf16 v[56:59], a[124:127], v[240:243], v[56:59]
ds_read_b64_tr_b16 a[78:79], v116 offset:14336
v_mul_f32 v39, v39, v25
v_mfma_f32_16x16x32_bf16 v[60:63], a[96:99], v[132:135], 0
ds_read_b64_tr_b16 a[80:81], v116 offset:16384
v_mul_f32 v44, v44, v25
v_mfma_f32_16x16x32_bf16 v[60:63], a[100:103], v[148:151], v[60:63]
ds_read_b64_tr_b16 a[82:83], v116 offset:18432
v_mul_f32 v45, v45, v25
v_mfma_f32_16x16x32_bf16 v[60:63], a[104:107], v[164:167], v[60:63]
ds_read_b64_tr_b16 a[84:85], v116 offset:20480
v_mul_f32 v46, v46, v25
v_mfma_f32_16x16x32_bf16 v[60:63], a[108:111], v[180:183], v[60:63]
ds_read_b64_tr_b16 a[86:87], v116 offset:22528
v_mul_f32 v47, v47, v25
v_mfma_f32_16x16x32_bf16 v[60:63], a[112:115], v[196:199], v[60:63]
ds_read_b64_tr_b16 a[88:89], v116 offset:24576
v_cvt_pk_bf16_f32 v36, v36, v37
v_mfma_f32_16x16x32_bf16 v[60:63], a[116:119], v[212:215], v[60:63]
ds_read_b64_tr_b16 a[90:91], v116 offset:26624
v_cvt_pk_bf16_f32 v37, v38, v39
v_mfma_f32_16x16x32_bf16 v[60:63], a[120:123], v[228:231], v[60:63]
ds_read_b64_tr_b16 a[92:93], v116 offset:28672
v_cvt_pk_bf16_f32 v38, v44, v45
v_mfma_f32_16x16x32_bf16 v[60:63], a[124:127], v[244:247], v[60:63]
s_waitcnt lgkmcnt(3)
ds_read_b64_tr_b16 a[94:95], v116 offset:30720
v_add_u32 v116, 32768, v116
v_mfma_f32_16x16x32_bf16 v[64:67], a[64:67], v[128:131], 0
s_add_u32 m0, s18, 0
ds_read_b64_tr_b16 a[96:97], v117 offset:0
v_cvt_pk_bf16_f32 v39, v46, v47
v_mfma_f32_16x16x32_bf16 v[64:67], a[68:71], v[144:147], v[64:67]
s_lshl_b32 s34, s29, 5
buffer_load_dwordx4 v112, s[36:39], s81 offen offset:0 lds
ds_read_b64_tr_b16 a[98:99], v117 offset:2048
v_mfma_f32_16x16x32_bf16 v[64:67], a[72:75], v[160:163], v[64:67]
s_add_u32 s34, s34, s20
buffer_store_dwordx4 v[36:39], v1, s[4:7], s12 offen offset:0 sc1
ds_read_b64_tr_b16 a[100:101], v117 offset:4096
v_mfma_f32_16x16x32_bf16 v[64:67], a[76:79], v[176:179], v[64:67]
s_lshl_b32 s34, s34, 2
ds_read_b64_tr_b16 a[102:103], v117 offset:6144
v_mul_f32 v48, v48, v24
v_mfma_f32_16x16x32_bf16 v[64:67], a[80:83], v[192:195], v[64:67]
s_add_u32 s34, s34, 94380032
ds_read_b64_tr_b16 a[104:105], v117 offset:8192
v_mul_f32 v49, v49, v24
v_mfma_f32_16x16x32_bf16 v[64:67], a[84:87], v[208:211], v[64:67]
s_waitcnt lgkmcnt(5)
s_add_u32 s35, s34, 2048
ds_read_b64_tr_b16 a[106:107], v117 offset:10240
v_mul_f32 v50, v50, v24
v_mfma_f32_16x16x32_bf16 v[64:67], a[88:91], v[224:227], v[64:67]
s_add_u32 s44, s34, 6144
ds_read_b64_tr_b16 a[108:109], v117 offset:12288
v_mul_f32 v51, v51, v24
v_mfma_f32_16x16x32_bf16 v[64:67], a[92:95], v[240:243], v[64:67]
s_min_u32 s80, s21, 6
ds_read_b64_tr_b16 a[110:111], v117 offset:14336
v_mul_f32 v56, v56, v24
v_mfma_f32_16x16x32_bf16 v[68:71], a[64:67], v[132:135], 0
s_add_u32 s79, s2, 0
buffer_load_dwordx4 v113, s[36:39], s81 offen offset:1024 lds
ds_read_b64_tr_b16 a[112:113], v117 offset:16384
v_mfma_f32_16x16x32_bf16 v[68:71], a[68:71], v[148:151], v[68:71]
s_lshr_b32 s79, s79, 4
ds_read_b64_tr_b16 a[114:115], v117 offset:18432
v_mul_f32 v57, v57, v24
v_mfma_f32_16x16x32_bf16 v[68:71], a[72:75], v[164:167], v[68:71]
s_or_b32 s79, s79, s2
ds_read_b64_tr_b16 a[116:117], v117 offset:20480
v_mul_f32 v58, v58, v24
v_mfma_f32_16x16x32_bf16 v[68:71], a[76:79], v[180:183], v[68:71]
s_andn2_b32 s79, 16, s79
ds_read_b64_tr_b16 a[118:119], v117 offset:22528
v_mul_f32 v59, v59, v24
v_mfma_f32_16x16x32_bf16 v[68:71], a[80:83], v[196:199], v[68:71]
s_add_u32 s79, s79, s20
ds_read_b64_tr_b16 a[120:121], v117 offset:24576
v_cvt_pk_bf16_f32 v48, v48, v49
v_mfma_f32_16x16x32_bf16 v[68:71], a[84:87], v[212:215], v[68:71]
s_lshl_b32 s22, s79, 2
ds_read_b64_tr_b16 a[122:123], v117 offset:26624
v_cvt_pk_bf16_f32 v49, v50, v51
v_mfma_f32_16x16x32_bf16 v[68:71], a[88:91], v[228:231], v[68:71]
s_add_u32 s22, s22, s3
ds_read_b64_tr_b16 a[124:125], v117 offset:28672
v_cvt_pk_bf16_f32 v50, v56, v57
v_mfma_f32_16x16x32_bf16 v[68:71], a[92:95], v[244:247], v[68:71]
s_waitcnt lgkmcnt(3)
s_mul_i32 s25, s22, 28672
ds_read_b64_tr_b16 a[126:127], v117 offset:30720
v_add_u32 v117, 32768, v117
v_mfma_f32_16x16x32_bf16 v[72:75], a[96:99], v[128:131], 0
s_lshl_b32 s23, s80, 6
buffer_load_dwordx4 v114, s[36:39], s81 offen offset:2048 lds
ds_read_b64_tr_b16 a[64:65], v118 offset:0
v_mfma_f32_16x16x32_bf16 v[72:75], a[100:103], v[144:147], v[72:75]
s_add_u32 s25, s25, s23
ds_read_b64_tr_b16 a[66:67], v118 offset:2048
v_cvt_pk_bf16_f32 v51, v58, v59
v_mfma_f32_16x16x32_bf16 v[72:75], a[104:107], v[160:163], v[72:75]
s_mul_i32 s26, s22, 229376
buffer_store_dwordx4 v[48:51], v1, s[4:7], s8 offen offset:1024 sc1
ds_read_b64_tr_b16 a[68:69], v118 offset:4096
v_mfma_f32_16x16x32_bf16 v[72:75], a[108:111], v[176:179], v[72:75]
s_lshl_b32 s23, s80, 10
ds_read_b64_tr_b16 a[70:71], v118 offset:6144
v_mul_f32 v52, v52, v25
v_mfma_f32_16x16x32_bf16 v[72:75], a[112:115], v[192:195], v[72:75]
s_add_u32 s26, s26, s23
ds_read_b64_tr_b16 a[72:73], v118 offset:8192
v_mul_f32 v53, v53, v25
v_mfma_f32_16x16x32_bf16 v[72:75], a[116:119], v[208:211], v[72:75]
s_waitcnt lgkmcnt(5)
s_add_u32 s26, s26, 104857600
ds_read_b64_tr_b16 a[74:75], v118 offset:10240
v_mul_f32 v54, v54, v25
v_mfma_f32_16x16x32_bf16 v[72:75], a[120:123], v[224:227], v[72:75]
s_lshr_b32 s22, s79, 1
ds_read_b64_tr_b16 a[76:77], v118 offset:12288
v_mul_f32 v55, v55, v25
v_mfma_f32_16x16x32_bf16 v[72:75], a[124:127], v[240:243], v[72:75]
s_lshl_b32 s22, s22, 7
buffer_load_dwordx4 v115, s[36:39], s81 offen offset:3072 lds
ds_read_b64_tr_b16 a[78:79], v118 offset:14336
v_mfma_f32_16x16x32_bf16 v[76:79], a[96:99], v[132:135], 0
s_add_u32 s33, s22, 94380032
ds_read_b64_tr_b16 a[80:81], v118 offset:16384
v_mul_f32 v60, v60, v25
v_mfma_f32_16x16x32_bf16 v[76:79], a[100:103], v[148:151], v[76:79]
s_mov_b64 s[40:41], s[88:89]
ds_read_b64_tr_b16 a[82:83], v118 offset:18432
v_mul_f32 v61, v61, v25
v_mfma_f32_16x16x32_bf16 v[76:79], a[104:107], v[164:167], v[76:79]
s_mov_b32 s42, 3670016
ds_read_b64_tr_b16 a[84:85], v118 offset:20480
v_mul_f32 v62, v62, v25
v_mfma_f32_16x16x32_bf16 v[76:79], a[108:111], v[180:183], v[76:79]
s_mov_b32 s43, 0x20000
ds_read_b64_tr_b16 a[86:87], v118 offset:22528
v_mul_f32 v63, v63, v25
v_mfma_f32_16x16x32_bf16 v[76:79], a[112:115], v[196:199], v[76:79]
ds_read_b64_tr_b16 a[88:89], v118 offset:24576
v_cvt_pk_bf16_f32 v52, v52, v53
v_mfma_f32_16x16x32_bf16 v[76:79], a[116:119], v[212:215], v[76:79]
s_add_u32 s81, s81, 28672
s_add_u32 m0, s18, 4096
ds_read_b64_tr_b16 a[90:91], v118 offset:26624
v_mfma_f32_16x16x32_bf16 v[76:79], a[120:123], v[228:231], v[76:79]
buffer_load_dwordx4 v112, s[36:39], s81 offen offset:0 lds
ds_read_b64_tr_b16 a[92:93], v118 offset:28672
v_mfma_f32_16x16x32_bf16 v[76:79], a[124:127], v[244:247], v[76:79]
s_waitcnt lgkmcnt(8)
ds_read_b64_tr_b16 a[94:95], v118 offset:30720
v_add_u32 v118, 32768, v118
v_mfma_f32_16x16x32_bf16 v[80:83], a[64:67], v[128:131], 0
ds_read_b64_tr_b16 a[96:97], v119 offset:0
v_cvt_pk_bf16_f32 v53, v54, v55
v_mfma_f32_16x16x32_bf16 v[80:83], a[68:71], v[144:147], v[80:83]
ds_read_b64_tr_b16 a[98:99], v119 offset:2048
v_cvt_pk_bf16_f32 v54, v60, v61
v_mfma_f32_16x16x32_bf16 v[80:83], a[72:75], v[160:163], v[80:83]
s_waitcnt lgkmcnt(8)
ds_read_b64_tr_b16 a[100:101], v119 offset:4096
v_cvt_pk_bf16_f32 v55, v62, v63
v_mfma_f32_16x16x32_bf16 v[80:83], a[76:79], v[176:179], v[80:83]
buffer_store_dwordx4 v[52:55], v1, s[4:7], s12 offen offset:1024 sc1
ds_read_b64_tr_b16 a[102:103], v119 offset:6144
v_mfma_f32_16x16x32_bf16 v[80:83], a[80:83], v[192:195], v[80:83]
s_waitcnt lgkmcnt(8)
ds_read_b64_tr_b16 a[104:105], v119 offset:8192
v_mfma_f32_16x16x32_bf16 v[80:83], a[84:87], v[208:211], v[80:83]
s_waitcnt lgkmcnt(7)
buffer_load_dwordx4 v113, s[36:39], s81 offen offset:1024 lds
ds_read_b64_tr_b16 a[106:107], v119 offset:10240
v_mfma_f32_16x16x32_bf16 v[80:83], a[88:91], v[224:227], v[80:83]
s_waitcnt lgkmcnt(6)
ds_read_b64_tr_b16 a[108:109], v119 offset:12288
v_mul_f32 v64, v64, v24
v_mfma_f32_16x16x32_bf16 v[80:83], a[92:95], v[240:243], v[80:83]
ds_read_b64_tr_b16 a[110:111], v119 offset:14336
v_mul_f32 v65, v65, v24
v_mfma_f32_16x16x32_bf16 v[84:87], a[64:67], v[132:135], 0
ds_read_b64_tr_b16 a[112:113], v119 offset:16384
v_mul_f32 v66, v66, v24
v_mfma_f32_16x16x32_bf16 v[84:87], a[68:71], v[148:151], v[84:87]
ds_read_b64_tr_b16 a[114:115], v119 offset:18432
v_mul_f32 v67, v67, v24
v_mfma_f32_16x16x32_bf16 v[84:87], a[72:75], v[164:167], v[84:87]
ds_read_b64_tr_b16 a[116:117], v119 offset:20480
v_mul_f32 v72, v72, v24
v_mfma_f32_16x16x32_bf16 v[84:87], a[76:79], v[180:183], v[84:87]
ds_read_b64_tr_b16 a[118:119], v119 offset:22528
v_mul_f32 v73, v73, v24
v_mfma_f32_16x16x32_bf16 v[84:87], a[80:83], v[196:199], v[84:87]
buffer_load_dwordx4 v114, s[36:39], s81 offen offset:2048 lds
ds_read_b64_tr_b16 a[120:121], v119 offset:24576
v_mfma_f32_16x16x32_bf16 v[84:87], a[84:87], v[212:215], v[84:87]
ds_read_b64_tr_b16 a[122:123], v119 offset:26624
v_mul_f32 v74, v74, v24
v_mfma_f32_16x16x32_bf16 v[84:87], a[88:91], v[228:231], v[84:87]
ds_read_b64_tr_b16 a[124:125], v119 offset:28672
ds_read_b64_tr_b16 a[126:127], v119 offset:30720
v_mfma_f32_16x16x32_bf16 v[84:87], a[92:95], v[244:247], v[84:87]
s_waitcnt vmcnt(19) lgkmcnt(9)
s_barrier
v_add_u32 v119, 32768, v119
v_mfma_f32_16x16x32_bf16 v[88:91], a[96:99], v[128:131], 0
ds_read_b64_tr_b16 a[64:65], v116 offset:0
v_mul_f32 v75, v75, v24
v_mfma_f32_16x16x32_bf16 v[88:91], a[100:103], v[144:147], v[88:91]
ds_read_b64_tr_b16 a[66:67], v116 offset:2048
v_cvt_pk_bf16_f32 v64, v64, v65
v_mfma_f32_16x16x32_bf16 v[88:91], a[104:107], v[160:163], v[88:91]
s_waitcnt lgkmcnt(8)
ds_read_b64_tr_b16 a[68:69], v116 offset:4096
v_cvt_pk_bf16_f32 v65, v66, v67
v_mfma_f32_16x16x32_bf16 v[88:91], a[108:111], v[176:179], v[88:91]
buffer_load_dwordx4 v115, s[36:39], s81 offen offset:3072 lds
ds_read_b64_tr_b16 a[70:71], v116 offset:6144
v_mfma_f32_16x16x32_bf16 v[88:91], a[112:115], v[192:195], v[88:91]
s_waitcnt lgkmcnt(8)
ds_read_b64_tr_b16 a[72:73], v116 offset:8192
v_cvt_pk_bf16_f32 v66, v72, v73
v_mfma_f32_16x16x32_bf16 v[88:91], a[116:119], v[208:211], v[88:91]
s_waitcnt lgkmcnt(7)
ds_read_b64_tr_b16 a[74:75], v116 offset:10240
v_cvt_pk_bf16_f32 v67, v74, v75
v_mfma_f32_16x16x32_bf16 v[88:91], a[120:123], v[224:227], v[88:91]
s_waitcnt lgkmcnt(6)
buffer_store_dwordx4 v[64:67], v1, s[4:7], s8 offen offset:2048 sc1
ds_read_b64_tr_b16 a[76:77], v116 offset:12288
v_mfma_f32_16x16x32_bf16 v[88:91], a[124:127], v[240:243], v[88:91]
ds_read_b64_tr_b16 a[78:79], v116 offset:14336
v_mul_f32 v68, v68, v25
v_mfma_f32_16x16x32_bf16 v[92:95], a[96:99], v[132:135], 0
ds_read_b64_tr_b16 a[80:81], v116 offset:16384
v_mul_f32 v69, v69, v25
v_mfma_f32_16x16x32_bf16 v[92:95], a[100:103], v[148:151], v[92:95]
s_sub_u32 s81, s81, 28544
ds_read_b64_tr_b16 a[82:83], v116 offset:18432
v_mul_f32 v70, v70, v25
v_mfma_f32_16x16x32_bf16 v[92:95], a[104:107], v[164:167], v[92:95]
ds_read_b64_tr_b16 a[84:85], v116 offset:20480
v_mul_f32 v71, v71, v25
v_mfma_f32_16x16x32_bf16 v[92:95], a[108:111], v[180:183], v[92:95]
ds_read_b64_tr_b16 a[86:87], v116 offset:22528
v_mul_f32 v76, v76, v25
v_mfma_f32_16x16x32_bf16 v[92:95], a[112:115], v[196:199], v[92:95]
ds_read_b64_tr_b16 a[88:89], v116 offset:24576
v_mul_f32 v77, v77, v25
v_mfma_f32_16x16x32_bf16 v[92:95], a[116:119], v[212:215], v[92:95]
ds_read_b64_tr_b16 a[90:91], v116 offset:26624
v_mul_f32 v78, v78, v25
v_mfma_f32_16x16x32_bf16 v[92:95], a[120:123], v[228:231], v[92:95]
ds_read_b64_tr_b16 a[92:93], v116 offset:28672
v_mul_f32 v79, v79, v25
v_mfma_f32_16x16x32_bf16 v[92:95], a[124:127], v[244:247], v[92:95]
s_waitcnt lgkmcnt(8)
ds_read_b64_tr_b16 a[94:95], v116 offset:30720
v_add_u32 v116, 4294901760, v116
v_mfma_f32_16x16x32_bf16 v[32:35], a[64:67], v[128:131], 0
s_add_u32 m0, s18, 32768
ds_read_b64_tr_b16 a[96:97], v117 offset:0
v_cvt_pk_bf16_f32 v68, v68, v69
v_mfma_f32_16x16x32_bf16 v[32:35], a[68:71], v[144:147], v[32:35]
buffer_load_dwordx4 v112, s[36:39], s81 offen offset:0 lds
ds_read_b64_tr_b16 a[98:99], v117 offset:2048
v_mfma_f32_16x16x32_bf16 v[32:35], a[72:75], v[160:163], v[32:35]
s_waitcnt lgkmcnt(8)
ds_read_b64_tr_b16 a[100:101], v117 offset:4096
v_cvt_pk_bf16_f32 v69, v70, v71
v_mfma_f32_16x16x32_bf16 v[32:35], a[76:79], v[176:179], v[32:35]
ds_read_b64_tr_b16 a[102:103], v117 offset:6144
v_cvt_pk_bf16_f32 v70, v76, v77
v_mfma_f32_16x16x32_bf16 v[32:35], a[80:83], v[192:195], v[32:35]
s_waitcnt lgkmcnt(8)
ds_read_b64_tr_b16 a[104:105], v117 offset:8192
v_cvt_pk_bf16_f32 v71, v78, v79
v_mfma_f32_16x16x32_bf16 v[32:35], a[84:87], v[208:211], v[32:35]
s_waitcnt lgkmcnt(7)
buffer_store_dwordx4 v[68:71], v1, s[4:7], s12 offen offset:2048 sc1
ds_read_b64_tr_b16 a[106:107], v117 offset:10240
v_mfma_f32_16x16x32_bf16 v[32:35], a[88:91], v[224:227], v[32:35]
s_waitcnt lgkmcnt(6)
ds_read_b64_tr_b16 a[108:109], v117 offset:12288
v_mul_f32 v80, v80, v24
v_mfma_f32_16x16x32_bf16 v[32:35], a[92:95], v[240:243], v[32:35]
ds_read_b64_tr_b16 a[110:111], v117 offset:14336
v_mul_f32 v81, v81, v24
v_mfma_f32_16x16x32_bf16 v[36:39], a[64:67], v[132:135], 0
buffer_load_dwordx4 v113, s[36:39], s81 offen offset:1024 lds
ds_read_b64_tr_b16 a[112:113], v117 offset:16384
v_mfma_f32_16x16x32_bf16 v[36:39], a[68:71], v[148:151], v[36:39]
ds_read_b64_tr_b16 a[114:115], v117 offset:18432
v_mul_f32 v82, v82, v24
v_mfma_f32_16x16x32_bf16 v[36:39], a[72:75], v[164:167], v[36:39]
ds_read_b64_tr_b16 a[116:117], v117 offset:20480
v_mul_f32 v83, v83, v24
v_mfma_f32_16x16x32_bf16 v[36:39], a[76:79], v[180:183], v[36:39]
ds_read_b64_tr_b16 a[118:119], v117 offset:22528
v_mul_f32 v88, v88, v24
v_mfma_f32_16x16x32_bf16 v[36:39], a[80:83], v[196:199], v[36:39]
ds_read_b64_tr_b16 a[120:121], v117 offset:24576
v_mul_f32 v89, v89, v24
v_mfma_f32_16x16x32_bf16 v[36:39], a[84:87], v[212:215], v[36:39]
ds_read_b64_tr_b16 a[122:123], v117 offset:26624
v_mul_f32 v90, v90, v24
v_mfma_f32_16x16x32_bf16 v[36:39], a[88:91], v[228:231], v[36:39]
ds_read_b64_tr_b16 a[124:125], v117 offset:28672
v_mul_f32 v91, v91, v24
v_mfma_f32_16x16x32_bf16 v[36:39], a[92:95], v[244:247], v[36:39]
s_waitcnt lgkmcnt(8)
ds_read_b64_tr_b16 a[126:127], v117 offset:30720
v_add_u32 v117, 4294901760, v117
v_mfma_f32_16x16x32_bf16 v[40:43], a[96:99], v[128:131], 0
buffer_load_dwordx4 v114, s[36:39], s81 offen offset:2048 lds
ds_read_b64_tr_b16 a[64:65], v118 offset:0
v_mfma_f32_16x16x32_bf16 v[40:43], a[100:103], v[144:147], v[40:43]
ds_read_b64_tr_b16 a[66:67], v118 offset:2048
v_cvt_pk_bf16_f32 v80, v80, v81
v_mfma_f32_16x16x32_bf16 v[40:43], a[104:107], v[160:163], v[40:43]
s_waitcnt lgkmcnt(8)
ds_read_b64_tr_b16 a[68:69], v118 offset:4096
v_cvt_pk_bf16_f32 v81, v82, v83
v_mfma_f32_16x16x32_bf16 v[40:43], a[108:111], v[176:179], v[40:43]
ds_read_b64_tr_b16 a[70:71], v118 offset:6144
v_cvt_pk_bf16_f32 v82, v88, v89
v_mfma_f32_16x16x32_bf16 v[40:43], a[112:115], v[192:195], v[40:43]
s_waitcnt lgkmcnt(8)
ds_read_b64_tr_b16 a[72:73], v118 offset:8192
v_cvt_pk_bf16_f32 v83, v90, v91
v_mfma_f32_16x16x32_bf16 v[40:43], a[116:119], v[208:211], v[40:43]
s_waitcnt lgkmcnt(7)
buffer_store_dwordx4 v[80:83], v1, s[4:7], s8 offen offset:3072 sc1
ds_read_b64_tr_b16 a[74:75], v118 offset:10240
v_mfma_f32_16x16x32_bf16 v[40:43], a[120:123], v[224:227], v[40:43]
s_waitcnt lgkmcnt(6)
ds_read_b64_tr_b16 a[76:77], v118 offset:12288
v_mul_f32 v84, v84, v25
v_mfma_f32_16x16x32_bf16 v[40:43], a[124:127], v[240:243], v[40:43]
buffer_load_dwordx4 v115, s[36:39], s81 offen offset:3072 lds
ds_read_b64_tr_b16 a[78:79], v118 offset:14336
v_mfma_f32_16x16x32_bf16 v[44:47], a[96:99], v[132:135], 0
ds_read_b64_tr_b16 a[80:81], v118 offset:16384
v_mul_f32 v85, v85, v25
v_mfma_f32_16x16x32_bf16 v[44:47], a[100:103], v[148:151], v[44:47]
ds_read_b64_tr_b16 a[82:83], v118 offset:18432
v_mul_f32 v86, v86, v25
v_mfma_f32_16x16x32_bf16 v[44:47], a[104:107], v[164:167], v[44:47]
ds_read_b64_tr_b16 a[84:85], v118 offset:20480
v_mul_f32 v87, v87, v25
v_mfma_f32_16x16x32_bf16 v[44:47], a[108:111], v[180:183], v[44:47]
ds_read_b64_tr_b16 a[86:87], v118 offset:22528
v_mul_f32 v92, v92, v25
v_mfma_f32_16x16x32_bf16 v[44:47], a[112:115], v[196:199], v[44:47]
ds_read_b64_tr_b16 a[88:89], v118 offset:24576
v_mul_f32 v93, v93, v25
v_mfma_f32_16x16x32_bf16 v[44:47], a[116:119], v[212:215], v[44:47]
s_add_u32 s81, s81, 28672
s_add_u32 m0, s18, 36864
ds_read_b64_tr_b16 a[90:91], v118 offset:26624
v_mfma_f32_16x16x32_bf16 v[44:47], a[120:123], v[228:231], v[44:47]
buffer_load_dwordx4 v112, s[36:39], s81 offen offset:0 lds
ds_read_b64_tr_b16 a[92:93], v118 offset:28672
v_mfma_f32_16x16x32_bf16 v[44:47], a[124:127], v[244:247], v[44:47]
s_waitcnt lgkmcnt(8)
ds_read_b64_tr_b16 a[94:95], v118 offset:30720
v_add_u32 v118, 4294901760, v118
v_mfma_f32_16x16x32_bf16 v[48:51], a[64:67], v[128:131], 0
ds_read_b64_tr_b16 a[96:97], v119 offset:0
v_mul_f32 v94, v94, v25
v_mfma_f32_16x16x32_bf16 v[48:51], a[68:71], v[144:147], v[48:51]
ds_read_b64_tr_b16 a[98:99], v119 offset:2048
v_mul_f32 v95, v95, v25
v_mfma_f32_16x16x32_bf16 v[48:51], a[72:75], v[160:163], v[48:51]
s_waitcnt lgkmcnt(8)
ds_read_b64_tr_b16 a[100:101], v119 offset:4096
v_cvt_pk_bf16_f32 v84, v84, v85
v_mfma_f32_16x16x32_bf16 v[48:51], a[76:79], v[176:179], v[48:51]
ds_read_b64_tr_b16 a[102:103], v119 offset:6144
v_cvt_pk_bf16_f32 v85, v86, v87
v_mfma_f32_16x16x32_bf16 v[48:51], a[80:83], v[192:195], v[48:51]
s_waitcnt lgkmcnt(8)
ds_read_b64_tr_b16 a[104:105], v119 offset:8192
v_cvt_pk_bf16_f32 v86, v92, v93
v_mfma_f32_16x16x32_bf16 v[48:51], a[84:87], v[208:211], v[48:51]
s_waitcnt lgkmcnt(7)
buffer_load_dwordx4 v113, s[36:39], s81 offen offset:1024 lds
ds_read_b64_tr_b16 a[106:107], v119 offset:10240
v_mfma_f32_16x16x32_bf16 v[48:51], a[88:91], v[224:227], v[48:51]
s_waitcnt lgkmcnt(6)
ds_read_b64_tr_b16 a[108:109], v119 offset:12288
v_cvt_pk_bf16_f32 v87, v94, v95
v_mfma_f32_16x16x32_bf16 v[48:51], a[92:95], v[240:243], v[48:51]
buffer_store_dwordx4 v[84:87], v1, s[4:7], s12 offen offset:3072 sc1
ds_read_b64_tr_b16 a[110:111], v119 offset:14336
v_mfma_f32_16x16x32_bf16 v[52:55], a[64:67], v[132:135], 0
s_add_u32 s8, s8, 4096
s_add_u32 s12, s12, 4096
ds_read_b64_tr_b16 a[112:113], v119 offset:16384
v_mfma_f32_16x16x32_bf16 v[52:55], a[68:71], v[148:151], v[52:55]
ds_read_b64_tr_b16 a[114:115], v119 offset:18432
v_mul_f32 v32, v32, v24
v_mfma_f32_16x16x32_bf16 v[52:55], a[72:75], v[164:167], v[52:55]
ds_read_b64_tr_b16 a[116:117], v119 offset:20480
v_mul_f32 v33, v33, v24
v_mfma_f32_16x16x32_bf16 v[52:55], a[76:79], v[180:183], v[52:55]
ds_read_b64_tr_b16 a[118:119], v119 offset:22528
v_mul_f32 v34, v34, v24
v_mfma_f32_16x16x32_bf16 v[52:55], a[80:83], v[196:199], v[52:55]
buffer_load_dwordx4 v114, s[36:39], s81 offen offset:2048 lds
ds_read_b64_tr_b16 a[120:121], v119 offset:24576
v_mfma_f32_16x16x32_bf16 v[52:55], a[84:87], v[212:215], v[52:55]
ds_read_b64_tr_b16 a[122:123], v119 offset:26624
v_mul_f32 v35, v35, v24
v_mfma_f32_16x16x32_bf16 v[52:55], a[88:91], v[228:231], v[52:55]
ds_read_b64_tr_b16 a[124:125], v119 offset:28672
ds_read_b64_tr_b16 a[126:127], v119 offset:30720
v_mfma_f32_16x16x32_bf16 v[52:55], a[92:95], v[244:247], v[52:55]
s_waitcnt vmcnt(23) lgkmcnt(9)
s_barrier
v_add_u32 v119, 4294901760, v119
v_mfma_f32_16x16x32_bf16 v[56:59], a[96:99], v[128:131], 0
ds_read_b64_tr_b16 a[64:65], v116 offset:0
v_mul_f32 v40, v40, v24
v_mfma_f32_16x16x32_bf16 v[56:59], a[100:103], v[144:147], v[56:59]
ds_read_b64_tr_b16 a[66:67], v116 offset:2048
v_mul_f32 v41, v41, v24
v_mfma_f32_16x16x32_bf16 v[56:59], a[104:107], v[160:163], v[56:59]
s_waitcnt lgkmcnt(8)
ds_read_b64_tr_b16 a[68:69], v116 offset:4096
v_mul_f32 v42, v42, v24
v_mfma_f32_16x16x32_bf16 v[56:59], a[108:111], v[176:179], v[56:59]
buffer_load_dwordx4 v115, s[36:39], s81 offen offset:3072 lds
ds_read_b64_tr_b16 a[70:71], v116 offset:6144
v_mfma_f32_16x16x32_bf16 v[56:59], a[112:115], v[192:195], v[56:59]
s_waitcnt lgkmcnt(8)
ds_read_b64_tr_b16 a[72:73], v116 offset:8192
v_mul_f32 v43, v43, v24
v_mfma_f32_16x16x32_bf16 v[56:59], a[116:119], v[208:211], v[56:59]
s_waitcnt lgkmcnt(7)
ds_read_b64_tr_b16 a[74:75], v116 offset:10240
v_cvt_pk_bf16_f32 v32, v32, v33
v_mfma_f32_16x16x32_bf16 v[56:59], a[120:123], v[224:227], v[56:59]
s_waitcnt lgkmcnt(6)
ds_read_b64_tr_b16 a[76:77], v116 offset:12288
v_cvt_pk_bf16_f32 v33, v34, v35
v_mfma_f32_16x16x32_bf16 v[56:59], a[124:127], v[240:243], v[56:59]
ds_read_b64_tr_b16 a[78:79], v116 offset:14336
v_cvt_pk_bf16_f32 v34, v40, v41
v_mfma_f32_16x16x32_bf16 v[60:63], a[96:99], v[132:135], 0
ds_read_b64_tr_b16 a[80:81], v116 offset:16384
v_cvt_pk_bf16_f32 v35, v42, v43
v_mfma_f32_16x16x32_bf16 v[60:63], a[100:103], v[148:151], v[60:63]
s_sub_u32 s81, s81, 28544
buffer_store_dwordx4 v[32:35], v1, s[4:7], s8 offen offset:0 sc1
ds_read_b64_tr_b16 a[82:83], v116 offset:18432
v_mfma_f32_16x16x32_bf16 v[60:63], a[104:107], v[164:167], v[60:63]
ds_read_b64_tr_b16 a[84:85], v116 offset:20480
v_mul_f32 v36, v36, v25
v_mfma_f32_16x16x32_bf16 v[60:63], a[108:111], v[180:183], v[60:63]
ds_read_b64_tr_b16 a[86:87], v116 offset:22528
v_mul_f32 v37, v37, v25
v_mfma_f32_16x16x32_bf16 v[60:63], a[112:115], v[196:199], v[60:63]
ds_read_b64_tr_b16 a[88:89], v116 offset:24576
v_mul_f32 v38, v38, v25
v_mfma_f32_16x16x32_bf16 v[60:63], a[116:119], v[212:215], v[60:63]
ds_read_b64_tr_b16 a[90:91], v116 offset:26624
v_mul_f32 v39, v39, v25
v_mfma_f32_16x16x32_bf16 v[60:63], a[120:123], v[228:231], v[60:63]
ds_read_b64_tr_b16 a[92:93], v116 offset:28672
v_mul_f32 v44, v44, v25
v_mfma_f32_16x16x32_bf16 v[60:63], a[124:127], v[244:247], v[60:63]
s_waitcnt lgkmcnt(8)
ds_read_b64_tr_b16 a[94:95], v116 offset:30720
v_add_u32 v116, 4294901760, v116
v_mfma_f32_16x16x32_bf16 v[64:67], a[64:67], v[128:131], 0
s_add_u32 m0, s18, 98304
ds_read_b64_tr_b16 a[96:97], v117 offset:0
v_mul_f32 v45, v45, v25
v_mfma_f32_16x16x32_bf16 v[64:67], a[68:71], v[144:147], v[64:67]
PAD_15:
s_cbranch_execz M_tret
buffer_load_dwordx4 v112, s[36:39], s81 offen offset:0 lds
ds_read_b64_tr_b16 a[98:99], v117 offset:2048
v_mfma_f32_16x16x32_bf16 v[64:67], a[72:75], v[160:163], v[64:67]
s_waitcnt lgkmcnt(8)
ds_read_b64_tr_b16 a[100:101], v117 offset:4096
v_mul_f32 v46, v46, v25
v_mfma_f32_16x16x32_bf16 v[64:67], a[76:79], v[176:179], v[64:67]
ds_read_b64_tr_b16 a[102:103], v117 offset:6144
v_mul_f32 v47, v47, v25
v_mfma_f32_16x16x32_bf16 v[64:67], a[80:83], v[192:195], v[64:67]
s_waitcnt lgkmcnt(8)
ds_read_b64_tr_b16 a[104:105], v117 offset:8192
v_cvt_pk_bf16_f32 v36, v36, v37
v_mfma_f32_16x16x32_bf16 v[64:67], a[84:87], v[208:211], v[64:67]
s_waitcnt lgkmcnt(7)
ds_read_b64_tr_b16 a[106:107], v117 offset:10240
v_cvt_pk_bf16_f32 v37, v38, v39
v_mfma_f32_16x16x32_bf16 v[64:67], a[88:91], v[224:227], v[64:67]
s_waitcnt lgkmcnt(6)
ds_read_b64_tr_b16 a[108:109], v117 offset:12288
v_cvt_pk_bf16_f32 v38, v44, v45
v_mfma_f32_16x16x32_bf16 v[64:67], a[92:95], v[240:243], v[64:67]
ds_read_b64_tr_b16 a[110:111], v117 offset:14336
v_cvt_pk_bf16_f32 v39, v46, v47
v_mfma_f32_16x16x32_bf16 v[68:71], a[64:67], v[132:135], 0
buffer_load_dwordx4 v113, s[36:39], s81 offen offset:1024 lds
ds_read_b64_tr_b16 a[112:113], v117 offset:16384
v_mfma_f32_16x16x32_bf16 v[68:71], a[68:71], v[148:151], v[68:71]
buffer_store_dwordx4 v[36:39], v1, s[4:7], s12 offen offset:0 sc1
ds_read_b64_tr_b16 a[114:115], v117 offset:18432
v_mfma_f32_16x16x32_bf16 v[68:71], a[72:75], v[164:167], v[68:71]
ds_read_b64_tr_b16 a[116:117], v117 offset:20480
v_mul_f32 v48, v48, v24
v_mfma_f32_16x16x32_bf16 v[68:71], a[76:79], v[180:183], v[68:71]
ds_read_b64_tr_b16 a[118:119], v117 offset:22528
v_mul_f32 v49, v49, v24
v_mfma_f32_16x16x32_bf16 v[68:71], a[80:83], v[196:199], v[68:71]
ds_read_b64_tr_b16 a[120:121], v117 offset:24576
v_mul_f32 v50, v50, v24
v_mfma_f32_16x16x32_bf16 v[68:71], a[84:87], v[212:215], v[68:71]
ds_read_b64_tr_b16 a[122:123], v117 offset:26624
v_mul_f32 v51, v51, v24
v_mfma_f32_16x16x32_bf16 v[68:71], a[88:91], v[228:231], v[68:71]
ds_read_b64_tr_b16 a[124:125], v117 offset:28672
v_mul_f32 v56, v56, v24
v_mfma_f32_16x16x32_bf16 v[68:71], a[92:95], v[244:247], v[68:71]
s_waitcnt lgkmcnt(8)
ds_read_b64_tr_b16 a[126:127], v117 offset:30720
v_add_u32 v117, 4294901760, v117
v_mfma_f32_16x16x32_bf16 v[72:75], a[96:99], v[128:131], 0
buffer_load_dwordx4 v114, s[36:39], s81 offen offset:2048 lds
ds_read_b64_tr_b16 a[64:65], v118 offset:0
v_mfma_f32_16x16x32_bf16 v[72:75], a[100:103], v[144:147], v[72:75]
ds_read_b64_tr_b16 a[66:67], v118 offset:2048
v_mul_f32 v57, v57, v24
v_mfma_f32_16x16x32_bf16 v[72:75], a[104:107], v[160:163], v[72:75]
s_waitcnt lgkmcnt(8)
ds_read_b64_tr_b16 a[68:69], v118 offset:4096
v_mul_f32 v58, v58, v24
v_mfma_f32_16x16x32_bf16 v[72:75], a[108:111], v[176:179], v[72:75]
ds_read_b64_tr_b16 a[70:71], v118 offset:6144
v_mul_f32 v59, v59, v24
v_mfma_f32_16x16x32_bf16 v[72:75], a[112:115], v[192:195], v[72:75]
s_waitcnt lgkmcnt(8)
ds_read_b64_tr_b16 a[72:73], v118 offset:8192
v_cvt_pk_bf16_f32 v48, v48, v49
v_mfma_f32_16x16x32_bf16 v[72:75], a[116:119], v[208:211], v[72:75]
s_waitcnt lgkmcnt(7)
ds_read_b64_tr_b16 a[74:75], v118 offset:10240
v_cvt_pk_bf16_f32 v49, v50, v51
v_mfma_f32_16x16x32_bf16 v[72:75], a[120:123], v[224:227], v[72:75]
s_waitcnt lgkmcnt(6)
ds_read_b64_tr_b16 a[76:77], v118 offset:12288
v_cvt_pk_bf16_f32 v50, v56, v57
v_mfma_f32_16x16x32_bf16 v[72:75], a[124:127], v[240:243], v[72:75]
buffer_load_dwordx4 v115, s[36:39], s81 offen offset:3072 lds
ds_read_b64_tr_b16 a[78:79], v118 offset:14336
v_mfma_f32_16x16x32_bf16 v[76:79], a[96:99], v[132:135], 0
ds_read_b64_tr_b16 a[80:81], v118 offset:16384
v_cvt_pk_bf16_f32 v51, v58, v59
v_mfma_f32_16x16x32_bf16 v[76:79], a[100:103], v[148:151], v[76:79]
buffer_store_dwordx4 v[48:51], v1, s[4:7], s8 offen offset:1024 sc1
ds_read_b64_tr_b16 a[82:83], v118 offset:18432
v_mfma_f32_16x16x32_bf16 v[76:79], a[104:107], v[164:167], v[76:79]
ds_read_b64_tr_b16 a[84:85], v118 offset:20480
v_mul_f32 v52, v52, v25
v_mfma_f32_16x16x32_bf16 v[76:79], a[108:111], v[180:183], v[76:79]
ds_read_b64_tr_b16 a[86:87], v118 offset:22528
v_mul_f32 v53, v53, v25
v_mfma_f32_16x16x32_bf16 v[76:79], a[112:115], v[196:199], v[76:79]
ds_read_b64_tr_b16 a[88:89], v118 offset:24576
v_mul_f32 v54, v54, v25
v_mfma_f32_16x16x32_bf16 v[76:79], a[116:119], v[212:215], v[76:79]
s_add_u32 s81, s81, 28672
s_add_u32 m0, s18, 102400
ds_read_b64_tr_b16 a[90:91], v118 offset:26624
v_mfma_f32_16x16x32_bf16 v[76:79], a[120:123], v[228:231], v[76:79]
buffer_load_dwordx4 v112, s[36:39], s81 offen offset:0 lds
ds_read_b64_tr_b16 a[92:93], v118 offset:28672
v_mfma_f32_16x16x32_bf16 v[76:79], a[124:127], v[244:247], v[76:79]
s_waitcnt lgkmcnt(8)
ds_read_b64_tr_b16 a[94:95], v118 offset:30720
v_add_u32 v118, 4294901760, v118
v_mfma_f32_16x16x32_bf16 v[80:83], a[64:67], v[128:131], 0
ds_read_b64_tr_b16 a[96:97], v119 offset:0
v_mul_f32 v55, v55, v25
v_mfma_f32_16x16x32_bf16 v[80:83], a[68:71], v[144:147], v[80:83]
ds_read_b64_tr_b16 a[98:99], v119 offset:2048
v_mul_f32 v60, v60, v25
v_mfma_f32_16x16x32_bf16 v[80:83], a[72:75], v[160:163], v[80:83]
s_waitcnt lgkmcnt(8)
ds_read_b64_tr_b16 a[100:101], v119 offset:4096
v_mul_f32 v61, v61, v25
v_mfma_f32_16x16x32_bf16 v[80:83], a[76:79], v[176:179], v[80:83]
ds_read_b64_tr_b16 a[102:103], v119 offset:6144
v_mul_f32 v62, v62, v25
v_mfma_f32_16x16x32_bf16 v[80:83], a[80:83], v[192:195], v[80:83]
s_waitcnt lgkmcnt(8)
ds_read_b64_tr_b16 a[104:105], v119 offset:8192
v_mul_f32 v63, v63, v25
v_mfma_f32_16x16x32_bf16 v[80:83], a[84:87], v[208:211], v[80:83]
s_waitcnt lgkmcnt(7)
buffer_load_dwordx4 v113, s[36:39], s81 offen offset:1024 lds
ds_read_b64_tr_b16 a[106:107], v119 offset:10240
v_mfma_f32_16x16x32_bf16 v[80:83], a[88:91], v[224:227], v[80:83]
s_waitcnt lgkmcnt(6)
ds_read_b64_tr_b16 a[108:109], v119 offset:12288
v_cvt_pk_bf16_f32 v52, v52, v53
v_mfma_f32_16x16x32_bf16 v[80:83], a[92:95], v[240:243], v[80:83]
ds_read_b64_tr_b16 a[110:111], v119 offset:14336
v_cvt_pk_bf16_f32 v53, v54, v55
v_mfma_f32_16x16x32_bf16 v[84:87], a[64:67], v[132:135], 0
ds_read_b64_tr_b16 a[112:113], v119 offset:16384
v_cvt_pk_bf16_f32 v54, v60, v61
v_mfma_f32_16x16x32_bf16 v[84:87], a[68:71], v[148:151], v[84:87]
ds_read_b64_tr_b16 a[114:115], v119 offset:18432
v_cvt_pk_bf16_f32 v55, v62, v63
v_mfma_f32_16x16x32_bf16 v[84:87], a[72:75], v[164:167], v[84:87]
buffer_store_dwordx4 v[52:55], v1, s[4:7], s12 offen offset:1024 sc1
ds_read_b64_tr_b16 a[116:117], v119 offset:20480
v_mfma_f32_16x16x32_bf16 v[84:87], a[76:79], v[180:183], v[84:87]
ds_read_b64_tr_b16 a[118:119], v119 offset:22528
v_mfma_f32_16x16x32_bf16 v[84:87], a[80:83], v[196:199], v[84:87]
buffer_load_dwordx4 v114, s[36:39], s81 offen offset:2048 lds
ds_read_b64_tr_b16 a[120:121], v119 offset:24576
v_mfma_f32_16x16x32_bf16 v[84:87], a[84:87], v[212:215], v[84:87]
ds_read_b64_tr_b16 a[122:123], v119 offset:26624
v_mul_f32 v64, v64, v24
v_mfma_f32_16x16x32_bf16 v[84:87], a[88:91], v[228:231], v[84:87]
ds_read_b64_tr_b16 a[124:125], v119 offset:28672
ds_read_b64_tr_b16 a[126:127], v119 offset:30720
v_mfma_f32_16x16x32_bf16 v[84:87], a[92:95], v[244:247], v[84:87]
s_waitcnt vmcnt(23) lgkmcnt(9)
s_barrier
v_add_u32 v119, 4294901760, v119
v_mfma_f32_16x16x32_bf16 v[88:91], a[96:99], v[128:131], 0
ds_read_b64_tr_b16 a[64:65], v116 offset:0
v_mul_f32 v65, v65, v24
v_mfma_f32_16x16x32_bf16 v[88:91], a[100:103], v[144:147], v[88:91]
ds_read_b64_tr_b16 a[66:67], v116 offset:2048
v_mul_f32 v66, v66, v24
v_mfma_f32_16x16x32_bf16 v[88:91], a[104:107], v[160:163], v[88:91]
s_waitcnt lgkmcnt(8)
ds_read_b64_tr_b16 a[68:69], v116 offset:4096
v_mul_f32 v67, v67, v24
v_mfma_f32_16x16x32_bf16 v[88:91], a[108:111], v[176:179], v[88:91]
buffer_load_dwordx4 v115, s[36:39], s81 offen offset:3072 lds
ds_read_b64_tr_b16 a[70:71], v116 offset:6144
v_mfma_f32_16x16x32_bf16 v[88:91], a[112:115], v[192:195], v[88:91]
s_waitcnt lgkmcnt(8)
ds_read_b64_tr_b16 a[72:73], v116 offset:8192
v_mul_f32 v72, v72, v24
v_mfma_f32_16x16x32_bf16 v[88:91], a[116:119], v[208:211], v[88:91]
s_waitcnt lgkmcnt(7)
ds_read_b64_tr_b16 a[74:75], v116 offset:10240
v_mul_f32 v73, v73, v24
v_mfma_f32_16x16x32_bf16 v[88:91], a[120:123], v[224:227], v[88:91]
s_waitcnt lgkmcnt(6)
ds_read_b64_tr_b16 a[76:77], v116 offset:12288
v_mul_f32 v74, v74, v24
v_mfma_f32_16x16x32_bf16 v[88:91], a[124:127], v[240:243], v[88:91]
ds_read_b64_tr_b16 a[78:79], v116 offset:14336
v_mul_f32 v75, v75, v24
v_mfma_f32_16x16x32_bf16 v[92:95], a[96:99], v[132:135], 0
ds_read_b64_tr_b16 a[80:81], v116 offset:16384
v_cvt_pk_bf16_f32 v64, v64, v65
v_mfma_f32_16x16x32_bf16 v[92:95], a[100:103], v[148:151], v[92:95]
s_sub_u32 s81, s81, 28544
ds_read_b64_tr_b16 a[82:83], v116 offset:18432
v_cvt_pk_bf16_f32 v65, v66, v67
v_mfma_f32_16x16x32_bf16 v[92:95], a[104:107], v[164:167], v[92:95]
ds_read_b64_tr_b16 a[84:85], v116 offset:20480
v_cvt_pk_bf16_f32 v66, v72, v73
v_mfma_f32_16x16x32_bf16 v[92:95], a[108:111], v[180:183], v[92:95]
ds_read_b64_tr_b16 a[86:87], v116 offset:22528
v_cvt_pk_bf16_f32 v67, v74, v75
v_mfma_f32_16x16x32_bf16 v[92:95], a[112:115], v[196:199], v[92:95]
buffer_store_dwordx4 v[64:67], v1, s[4:7], s8 offen offset:2048 sc1
ds_read_b64_tr_b16 a[88:89], v116 offset:24576
v_mfma_f32_16x16x32_bf16 v[92:95], a[116:119], v[212:215], v[92:95]
ds_read_b64_tr_b16 a[90:91], v116 offset:26624
v_mul_f32 v68, v68, v25
v_mfma_f32_16x16x32_bf16 v[92:95], a[120:123], v[228:231], v[92:95]
ds_read_b64_tr_b16 a[92:93], v116 offset:28672
v_mul_f32 v69, v69, v25
v_mfma_f32_16x16x32_bf16 v[92:95], a[124:127], v[244:247], v[92:95]
s_waitcnt lgkmcnt(8)
ds_read_b64_tr_b16 a[94:95], v116 offset:30720
v_add_u32 v116, 32768, v116
v_mfma_f32_16x16x32_bf16 v[32:35], a[64:67], v[128:131], 0
ds_read_b64_tr_b16 a[96:97], v117 offset:0
v_mul_f32 v70, v70, v25
v_mfma_f32_16x16x32_bf16 v[32:35], a[68:71], v[144:147], v[32:35]
ds_read_b64_tr_b16 a[98:99], v117 offset:2048
v_mul_f32 v71, v71, v25
v_mfma_f32_16x16x32_bf16 v[32:35], a[72:75], v[160:163], v[32:35]
s_waitcnt lgkmcnt(8)
ds_read_b64_tr_b16 a[100:101], v117 offset:4096
v_mul_f32 v76, v76, v25
v_mfma_f32_16x16x32_bf16 v[32:35], a[76:79], v[176:179], v[32:35]
ds_read_b64_tr_b16 a[102:103], v117 offset:6144
v_mul_f32 v77, v77, v25
v_mfma_f32_16x16x32_bf16 v[32:35], a[80:83], v[192:195], v[32:35]
s_waitcnt lgkmcnt(8)
ds_read_b64_tr_b16 a[104:105], v117 offset:8192
v_mul_f32 v78, v78, v25
v_mfma_f32_16x16x32_bf16 v[32:35], a[84:87], v[208:211], v[32:35]
s_waitcnt lgkmcnt(7)
ds_read_b64_tr_b16 a[106:107], v117 offset:10240
v_mul_f32 v79, v79, v25
v_mfma_f32_16x16x32_bf16 v[32:35], a[88:91], v[224:227], v[32:35]
s_waitcnt lgkmcnt(6)
ds_read_b64_tr_b16 a[108:109], v117 offset:12288
v_cvt_pk_bf16_f32 v68, v68, v69
v_mfma_f32_16x16x32_bf16 v[32:35], a[92:95], v[240:243], v[32:35]
ds_read_b64_tr_b16 a[110:111], v117 offset:14336
v_cvt_pk_bf16_f32 v69, v70, v71
v_mfma_f32_16x16x32_bf16 v[36:39], a[64:67], v[132:135], 0
ds_read_b64_tr_b16 a[112:113], v117 offset:16384
v_cvt_pk_bf16_f32 v70, v76, v77
v_mfma_f32_16x16x32_bf16 v[36:39], a[68:71], v[148:151], v[36:39]
ds_read_b64_tr_b16 a[114:115], v117 offset:18432
v_cvt_pk_bf16_f32 v71, v78, v79
v_mfma_f32_16x16x32_bf16 v[36:39], a[72:75], v[164:167], v[36:39]
buffer_store_dwordx4 v[68:71], v1, s[4:7], s12 offen offset:2048 sc1
ds_read_b64_tr_b16 a[116:117], v117 offset:20480
v_mfma_f32_16x16x32_bf16 v[36:39], a[76:79], v[180:183], v[36:39]
ds_read_b64_tr_b16 a[118:119], v117 offset:22528
v_mul_f32 v80, v80, v24
v_mfma_f32_16x16x32_bf16 v[36:39], a[80:83], v[196:199], v[36:39]
ds_read_b64_tr_b16 a[120:121], v117 offset:24576
v_mul_f32 v81, v81, v24
v_mfma_f32_16x16x32_bf16 v[36:39], a[84:87], v[212:215], v[36:39]
ds_read_b64_tr_b16 a[122:123], v117 offset:26624
v_mul_f32 v82, v82, v24
v_mfma_f32_16x16x32_bf16 v[36:39], a[88:91], v[228:231], v[36:39]
ds_read_b64_tr_b16 a[124:125], v117 offset:28672
v_mul_f32 v83, v83, v24
v_mfma_f32_16x16x32_bf16 v[36:39], a[92:95], v[244:247], v[36:39]
s_waitcnt lgkmcnt(8)
ds_read_b64_tr_b16 a[126:127], v117 offset:30720
v_add_u32 v117, 32768, v117
v_mfma_f32_16x16x32_bf16 v[40:43], a[96:99], v[128:131], 0
ds_read_b64_tr_b16 a[64:65], v118 offset:0
v_mul_f32 v88, v88, v24
v_mfma_f32_16x16x32_bf16 v[40:43], a[100:103], v[144:147], v[40:43]
ds_read_b64_tr_b16 a[66:67], v118 offset:2048
v_mul_f32 v89, v89, v24
v_mfma_f32_16x16x32_bf16 v[40:43], a[104:107], v[160:163], v[40:43]
s_waitcnt lgkmcnt(8)
ds_read_b64_tr_b16 a[68:69], v118 offset:4096
v_mul_f32 v90, v90, v24
v_mfma_f32_16x16x32_bf16 v[40:43], a[108:111], v[176:179], v[40:43]
ds_read_b64_tr_b16 a[70:71], v118 offset:6144
v_mul_f32 v91, v91, v24
v_mfma_f32_16x16x32_bf16 v[40:43], a[112:115], v[192:195], v[40:43]
s_waitcnt lgkmcnt(8)
ds_read_b64_tr_b16 a[72:73], v118 offset:8192
v_cvt_pk_bf16_f32 v80, v80, v81
v_mfma_f32_16x16x32_bf16 v[40:43], a[116:119], v[208:211], v[40:43]
s_waitcnt lgkmcnt(7)
ds_read_b64_tr_b16 a[74:75], v118 offset:10240
v_cvt_pk_bf16_f32 v81, v82, v83
v_mfma_f32_16x16x32_bf16 v[40:43], a[120:123], v[224:227], v[40:43]
s_waitcnt lgkmcnt(6)
ds_read_b64_tr_b16 a[76:77], v118 offset:12288
v_cvt_pk_bf16_f32 v82, v88, v89
v_mfma_f32_16x16x32_bf16 v[40:43], a[124:127], v[240:243], v[40:43]
ds_read_b64_tr_b16 a[78:79], v118 offset:14336
v_cvt_pk_bf16_f32 v83, v90, v91
v_mfma_f32_16x16x32_bf16 v[44:47], a[96:99], v[132:135], 0
buffer_store_dwordx4 v[80:83], v1, s[4:7], s8 offen offset:3072 sc1
ds_read_b64_tr_b16 a[80:81], v118 offset:16384
v_mfma_f32_16x16x32_bf16 v[44:47], a[100:103], v[148:151], v[44:47]
ds_read_b64_tr_b16 a[82:83], v118 offset:18432
v_mul_f32 v84, v84, v25
v_mfma_f32_16x16x32_bf16 v[44:47], a[104:107], v[164:167], v[44:47]
ds_read_b64_tr_b16 a[84:85], v118 offset:20480
v_mul_f32 v85, v85, v25
v_mfma_f32_16x16x32_bf16 v[44:47], a[108:111], v[180:183], v[44:47]
ds_read_b64_tr_b16 a[86:87], v118 offset:22528
v_mul_f32 v86, v86, v25
v_mfma_f32_16x16x32_bf16 v[44:47], a[112:115], v[196:199], v[44:47]
ds_read_b64_tr_b16 a[88:89], v118 offset:24576
v_mul_f32 v87, v87, v25
v_mfma_f32_16x16x32_bf16 v[44:47], a[116:119], v[212:215], v[44:47]
ds_read_b64_tr_b16 a[90:91], v118 offset:26624
v_mul_f32 v92, v92, v25
v_mfma_f32_16x16x32_bf16 v[44:47], a[120:123], v[228:231], v[44:47]
ds_read_b64_tr_b16 a[92:93], v118 offset:28672
v_mul_f32 v93, v93, v25
v_mfma_f32_16x16x32_bf16 v[44:47], a[124:127], v[244:247], v[44:47]
s_waitcnt lgkmcnt(8)
ds_read_b64_tr_b16 a[94:95], v118 offset:30720
v_add_u32 v118, 32768, v118
v_mfma_f32_16x16x32_bf16 v[48:51], a[64:67], v[128:131], 0
ds_read_b64_tr_b16 a[96:97], v119 offset:0
v_mul_f32 v94, v94, v25
v_mfma_f32_16x16x32_bf16 v[48:51], a[68:71], v[144:147], v[48:51]
ds_read_b64_tr_b16 a[98:99], v119 offset:2048
v_mul_f32 v95, v95, v25
v_mfma_f32_16x16x32_bf16 v[48:51], a[72:75], v[160:163], v[48:51]
s_waitcnt lgkmcnt(8)
ds_read_b64_tr_b16 a[100:101], v119 offset:4096
v_cvt_pk_bf16_f32 v84, v84, v85
v_mfma_f32_16x16x32_bf16 v[48:51], a[76:79], v[176:179], v[48:51]
ds_read_b64_tr_b16 a[102:103], v119 offset:6144
v_cvt_pk_bf16_f32 v85, v86, v87
v_mfma_f32_16x16x32_bf16 v[48:51], a[80:83], v[192:195], v[48:51]
s_waitcnt lgkmcnt(8)
ds_read_b64_tr_b16 a[104:105], v119 offset:8192
v_cvt_pk_bf16_f32 v86, v92, v93
v_mfma_f32_16x16x32_bf16 v[48:51], a[84:87], v[208:211], v[48:51]
s_waitcnt lgkmcnt(7)
ds_read_b64_tr_b16 a[106:107], v119 offset:10240
v_cvt_pk_bf16_f32 v87, v94, v95
v_mfma_f32_16x16x32_bf16 v[48:51], a[88:91], v[224:227], v[48:51]
s_waitcnt lgkmcnt(6)
buffer_store_dwordx4 v[84:87], v1, s[4:7], s12 offen offset:3072 sc1
ds_read_b64_tr_b16 a[108:109], v119 offset:12288
v_mfma_f32_16x16x32_bf16 v[48:51], a[92:95], v[240:243], v[48:51]
s_add_u32 s8, s8, 4096
s_add_u32 s12, s12, 4096
ds_read_b64_tr_b16 a[110:111], v119 offset:14336
v_mfma_f32_16x16x32_bf16 v[52:55], a[64:67], v[132:135], 0
ds_read_b64_tr_b16 a[112:113], v119 offset:16384
v_mul_f32 v32, v32, v24
v_mfma_f32_16x16x32_bf16 v[52:55], a[68:71], v[148:151], v[52:55]
ds_read_b64_tr_b16 a[114:115], v119 offset:18432
v_mul_f32 v33, v33, v24
v_mfma_f32_16x16x32_bf16 v[52:55], a[72:75], v[164:167], v[52:55]
ds_read_b64_tr_b16 a[116:117], v119 offset:20480
v_mul_f32 v34, v34, v24
v_mfma_f32_16x16x32_bf16 v[52:55], a[76:79], v[180:183], v[52:55]
ds_read_b64_tr_b16 a[118:119], v119 offset:22528
v_mul_f32 v35, v35, v24
v_mfma_f32_16x16x32_bf16 v[52:55], a[80:83], v[196:199], v[52:55]
ds_read_b64_tr_b16 a[120:121], v119 offset:24576
v_mul_f32 v40, v40, v24
v_mfma_f32_16x16x32_bf16 v[52:55], a[84:87], v[212:215], v[52:55]
ds_read_b64_tr_b16 a[122:123], v119 offset:26624
v_mul_f32 v41, v41, v24
v_mfma_f32_16x16x32_bf16 v[52:55], a[88:91], v[228:231], v[52:55]
ds_read_b64_tr_b16 a[124:125], v119 offset:28672
ds_read_b64_tr_b16 a[126:127], v119 offset:30720
v_mfma_f32_16x16x32_bf16 v[52:55], a[92:95], v[244:247], v[52:55]
s_waitcnt vmcnt(16) lgkmcnt(9)
s_barrier
v_add_u32 v119, 32768, v119
v_mfma_f32_16x16x32_bf16 v[56:59], a[96:99], v[128:131], 0
ds_read_b64_tr_b16 a[64:65], v116 offset:0
v_mul_f32 v42, v42, v24
v_mfma_f32_16x16x32_bf16 v[56:59], a[100:103], v[144:147], v[56:59]
ds_read_b64_tr_b16 a[66:67], v116 offset:2048
v_mul_f32 v43, v43, v24
v_mfma_f32_16x16x32_bf16 v[56:59], a[104:107], v[160:163], v[56:59]
s_waitcnt lgkmcnt(8)
ds_read_b64_tr_b16 a[68:69], v116 offset:4096
v_cvt_pk_bf16_f32 v32, v32, v33
v_mfma_f32_16x16x32_bf16 v[56:59], a[108:111], v[176:179], v[56:59]
ds_read_b64_tr_b16 a[70:71], v116 offset:6144
v_cvt_pk_bf16_f32 v33, v34, v35
v_mfma_f32_16x16x32_bf16 v[56:59], a[112:115], v[192:195], v[56:59]
s_waitcnt lgkmcnt(8)
ds_read_b64_tr_b16 a[72:73], v116 offset:8192
v_cvt_pk_bf16_f32 v34, v40, v41
v_mfma_f32_16x16x32_bf16 v[56:59], a[116:119], v[208:211], v[56:59]
s_waitcnt lgkmcnt(7)
ds_read_b64_tr_b16 a[74:75], v116 offset:10240
v_cvt_pk_bf16_f32 v35, v42, v43
v_mfma_f32_16x16x32_bf16 v[56:59], a[120:123], v[224:227], v[56:59]
s_waitcnt lgkmcnt(6)
buffer_store_dwordx4 v[32:35], v1, s[4:7], s8 offen offset:0 sc1
ds_read_b64_tr_b16 a[76:77], v116 offset:12288
v_mfma_f32_16x16x32_bf16 v[56:59], a[124:127], v[240:243], v[56:59]
ds_read_b64_tr_b16 a[78:79], v116 offset:14336
v_mul_f32 v36, v36, v25
v_mfma_f32_16x16x32_bf16 v[60:63], a[96:99], v[132:135], 0
ds_read_b64_tr_b16 a[80:81], v116 offset:16384
v_mul_f32 v37, v37, v25
v_mfma_f32_16x16x32_bf16 v[60:63], a[100:103], v[148:151], v[60:63]
ds_read_b64_tr_b16 a[82:83], v116 offset:18432
v_mul_f32 v38, v38, v25
v_mfma_f32_16x16x32_bf16 v[60:63], a[104:107], v[164:167], v[60:63]
ds_read_b64_tr_b16 a[84:85], v116 offset:20480
v_mul_f32 v39, v39, v25
v_mfma_f32_16x16x32_bf16 v[60:63], a[108:111], v[180:183], v[60:63]
ds_read_b64_tr_b16 a[86:87], v116 offset:22528
v_mul_f32 v44, v44, v25
v_mfma_f32_16x16x32_bf16 v[60:63], a[112:115], v[196:199], v[60:63]
ds_read_b64_tr_b16 a[88:89], v116 offset:24576
v_mul_f32 v45, v45, v25
v_mfma_f32_16x16x32_bf16 v[60:63], a[116:119], v[212:215], v[60:63]
ds_read_b64_tr_b16 a[90:91], v116 offset:26624
v_mul_f32 v46, v46, v25
v_mfma_f32_16x16x32_bf16 v[60:63], a[120:123], v[228:231], v[60:63]
ds_read_b64_tr_b16 a[92:93], v116 offset:28672
v_mul_f32 v47, v47, v25
v_mfma_f32_16x16x32_bf16 v[60:63], a[124:127], v[244:247], v[60:63]
s_waitcnt lgkmcnt(8)
ds_read_b64_tr_b16 a[94:95], v116 offset:30720
v_add_u32 v116, 65536, v116
v_mfma_f32_16x16x32_bf16 v[64:67], a[64:67], v[128:131], 0
ds_read_b64_tr_b16 a[96:97], v117 offset:0
v_cvt_pk_bf16_f32 v36, v36, v37
v_mfma_f32_16x16x32_bf16 v[64:67], a[68:71], v[144:147], v[64:67]
ds_read_b64_tr_b16 a[98:99], v117 offset:2048
v_cvt_pk_bf16_f32 v37, v38, v39
v_mfma_f32_16x16x32_bf16 v[64:67], a[72:75], v[160:163], v[64:67]
s_waitcnt lgkmcnt(8)
ds_read_b64_tr_b16 a[100:101], v117 offset:4096
v_cvt_pk_bf16_f32 v38, v44, v45
v_mfma_f32_16x16x32_bf16 v[64:67], a[76:79], v[176:179], v[64:67]
ds_read_b64_tr_b16 a[102:103], v117 offset:6144
v_cvt_pk_bf16_f32 v39, v46, v47
v_mfma_f32_16x16x32_bf16 v[64:67], a[80:83], v[192:195], v[64:67]
s_waitcnt lgkmcnt(8)
buffer_store_dwordx4 v[36:39], v1, s[4:7], s12 offen offset:0 sc1
ds_read_b64_tr_b16 a[104:105], v117 offset:8192
v_mfma_f32_16x16x32_bf16 v[64:67], a[84:87], v[208:211], v[64:67]
s_waitcnt lgkmcnt(7)
ds_read_b64_tr_b16 a[106:107], v117 offset:10240
v_mul_f32 v48, v48, v24
v_mfma_f32_16x16x32_bf16 v[64:67], a[88:91], v[224:227], v[64:67]
s_waitcnt lgkmcnt(6)
ds_read_b64_tr_b16 a[108:109], v117 offset:12288
v_mul_f32 v49, v49, v24
v_mfma_f32_16x16x32_bf16 v[64:67], a[92:95], v[240:243], v[64:67]
ds_read_b64_tr_b16 a[110:111], v117 offset:14336
v_mul_f32 v50, v50, v24
v_mfma_f32_16x16x32_bf16 v[68:71], a[64:67], v[132:135], 0
ds_read_b64_tr_b16 a[112:113], v117 offset:16384
v_mul_f32 v51, v51, v24
v_mfma_f32_16x16x32_bf16 v[68:71], a[68:71], v[148:151], v[68:71]
ds_read_b64_tr_b16 a[114:115], v117 offset:18432
v_mul_f32 v56, v56, v24
v_mfma_f32_16x16x32_bf16 v[68:71], a[72:75], v[164:167], v[68:71]
ds_read_b64_tr_b16 a[116:117], v117 offset:20480
v_mul_f32 v57, v57, v24
v_mfma_f32_16x16x32_bf16 v[68:71], a[76:79], v[180:183], v[68:71]
ds_read_b64_tr_b16 a[118:119], v117 offset:22528
v_mul_f32 v58, v58, v24
v_mfma_f32_16x16x32_bf16 v[68:71], a[80:83], v[196:199], v[68:71]
ds_read_b64_tr_b16 a[120:121], v117 offset:24576
v_mul_f32 v59, v59, v24
v_mfma_f32_16x16x32_bf16 v[68:71], a[84:87], v[212:215], v[68:71]
ds_read_b64_tr_b16 a[122:123], v117 offset:26624
v_cvt_pk_bf16_f32 v48, v48, v49
v_mfma_f32_16x16x32_bf16 v[68:71], a[88:91], v[228:231], v[68:71]
ds_read_b64_tr_b16 a[124:125], v117 offset:28672
v_cvt_pk_bf16_f32 v49, v50, v51
v_mfma_f32_16x16x32_bf16 v[68:71], a[92:95], v[244:247], v[68:71]
s_waitcnt lgkmcnt(8)
ds_read_b64_tr_b16 a[126:127], v117 offset:30720
v_add_u32 v117, 65536, v117
v_mfma_f32_16x16x32_bf16 v[72:75], a[96:99], v[128:131], 0
ds_read_b64_tr_b16 a[64:65], v118 offset:0
v_cvt_pk_bf16_f32 v50, v56, v57
v_mfma_f32_16x16x32_bf16 v[72:75], a[100:103], v[144:147], v[72:75]
ds_read_b64_tr_b16 a[66:67], v118 offset:2048
v_cvt_pk_bf16_f32 v51, v58, v59
v_mfma_f32_16x16x32_bf16 v[72:75], a[104:107], v[160:163], v[72:75]
s_waitcnt lgkmcnt(8)
buffer_store_dwordx4 v[48:51], v1, s[4:7], s8 offen offset:1024 sc1
ds_read_b64_tr_b16 a[68:69], v118 offset:4096
v_mfma_f32_16x16x32_bf16 v[72:75], a[108:111], v[176:179], v[72:75]
ds_read_b64_tr_b16 a[70:71], v118 offset:6144
v_mul_f32 v52, v52, v25
v_mfma_f32_16x16x32_bf16 v[72:75], a[112:115], v[192:195], v[72:75]
s_waitcnt lgkmcnt(8)
ds_read_b64_tr_b16 a[72:73], v118 offset:8192
v_mul_f32 v53, v53, v25
v_mfma_f32_16x16x32_bf16 v[72:75], a[116:119], v[208:211], v[72:75]
s_waitcnt lgkmcnt(7)
ds_read_b64_tr_b16 a[74:75], v118 offset:10240
v_mul_f32 v54, v54, v25
v_mfma_f32_16x16x32_bf16 v[72:75], a[120:123], v[224:227], v[72:75]
s_waitcnt lgkmcnt(6)
ds_read_b64_tr_b16 a[76:77], v118 offset:12288
v_mul_f32 v55, v55, v25
v_mfma_f32_16x16x32_bf16 v[72:75], a[124:127], v[240:243], v[72:75]
ds_read_b64_tr_b16 a[78:79], v118 offset:14336
v_mul_f32 v60, v60, v25
v_mfma_f32_16x16x32_bf16 v[76:79], a[96:99], v[132:135], 0
ds_read_b64_tr_b16 a[80:81], v118 offset:16384
v_mul_f32 v61, v61, v25
v_mfma_f32_16x16x32_bf16 v[76:79], a[100:103], v[148:151], v[76:79]
ds_read_b64_tr_b16 a[82:83], v118 offset:18432
v_mul_f32 v62, v62, v25
v_mfma_f32_16x16x32_bf16 v[76:79], a[104:107], v[164:167], v[76:79]
ds_read_b64_tr_b16 a[84:85], v118 offset:20480
v_mul_f32 v63, v63, v25
v_mfma_f32_16x16x32_bf16 v[76:79], a[108:111], v[180:183], v[76:79]
ds_read_b64_tr_b16 a[86:87], v118 offset:22528
v_cvt_pk_bf16_f32 v52, v52, v53
v_mfma_f32_16x16x32_bf16 v[76:79], a[112:115], v[196:199], v[76:79]
ds_read_b64_tr_b16 a[88:89], v118 offset:24576
v_cvt_pk_bf16_f32 v53, v54, v55
v_mfma_f32_16x16x32_bf16 v[76:79], a[116:119], v[212:215], v[76:79]
ds_read_b64_tr_b16 a[90:91], v118 offset:26624
v_cvt_pk_bf16_f32 v54, v60, v61
v_mfma_f32_16x16x32_bf16 v[76:79], a[120:123], v[228:231], v[76:79]
ds_read_b64_tr_b16 a[92:93], v118 offset:28672
v_cvt_pk_bf16_f32 v55, v62, v63
v_mfma_f32_16x16x32_bf16 v[76:79], a[124:127], v[244:247], v[76:79]
s_waitcnt lgkmcnt(8)
ds_read_b64_tr_b16 a[94:95], v118 offset:30720
v_add_u32 v118, 65536, v118
v_mfma_f32_16x16x32_bf16 v[80:83], a[64:67], v[128:131], 0
buffer_store_dwordx4 v[52:55], v1, s[4:7], s12 offen offset:1024 sc1
ds_read_b64_tr_b16 a[96:97], v119 offset:0
v_mfma_f32_16x16x32_bf16 v[80:83], a[68:71], v[144:147], v[80:83]
ds_read_b64_tr_b16 a[98:99], v119 offset:2048
v_mul_u32_u24 v21, 1792, v19
v_mfma_f32_16x16x32_bf16 v[80:83], a[72:75], v[160:163], v[80:83]
s_waitcnt lgkmcnt(8)
ds_read_b64_tr_b16 a[100:101], v119 offset:4096
v_mul_f32 v64, v64, v24
v_mfma_f32_16x16x32_bf16 v[80:83], a[76:79], v[176:179], v[80:83]
ds_read_b64_tr_b16 a[102:103], v119 offset:6144
v_mul_f32 v65, v65, v24
v_mfma_f32_16x16x32_bf16 v[80:83], a[80:83], v[192:195], v[80:83]
s_waitcnt lgkmcnt(8)
ds_read_b64_tr_b16 a[104:105], v119 offset:8192
v_mul_f32 v66, v66, v24
v_mfma_f32_16x16x32_bf16 v[80:83], a[84:87], v[208:211], v[80:83]
s_waitcnt lgkmcnt(7)
ds_read_b64_tr_b16 a[106:107], v119 offset:10240
v_mul_f32 v67, v67, v24
v_mfma_f32_16x16x32_bf16 v[80:83], a[88:91], v[224:227], v[80:83]
s_waitcnt lgkmcnt(6)
ds_read_b64_tr_b16 a[108:109], v119 offset:12288
v_mul_f32 v72, v72, v24
v_mfma_f32_16x16x32_bf16 v[80:83], a[92:95], v[240:243], v[80:83]
ds_read_b64_tr_b16 a[110:111], v119 offset:14336
v_mul_f32 v73, v73, v24
v_mfma_f32_16x16x32_bf16 v[84:87], a[64:67], v[132:135], 0
ds_read_b64_tr_b16 a[112:113], v119 offset:16384
v_mul_f32 v74, v74, v24
v_mfma_f32_16x16x32_bf16 v[84:87], a[68:71], v[148:151], v[84:87]
ds_read_b64_tr_b16 a[114:115], v119 offset:18432
v_mul_f32 v75, v75, v24
v_mfma_f32_16x16x32_bf16 v[84:87], a[72:75], v[164:167], v[84:87]
ds_read_b64_tr_b16 a[116:117], v119 offset:20480
v_cvt_pk_bf16_f32 v64, v64, v65
v_mfma_f32_16x16x32_bf16 v[84:87], a[76:79], v[180:183], v[84:87]
ds_read_b64_tr_b16 a[118:119], v119 offset:22528
v_cvt_pk_bf16_f32 v65, v66, v67
v_mfma_f32_16x16x32_bf16 v[84:87], a[80:83], v[196:199], v[84:87]
ds_read_b64_tr_b16 a[120:121], v119 offset:24576
v_cvt_pk_bf16_f32 v66, v72, v73
v_mfma_f32_16x16x32_bf16 v[84:87], a[84:87], v[212:215], v[84:87]
ds_read_b64_tr_b16 a[122:123], v119 offset:26624
v_cvt_pk_bf16_f32 v67, v74, v75
v_mfma_f32_16x16x32_bf16 v[84:87], a[88:91], v[228:231], v[84:87]
ds_read_b64_tr_b16 a[124:125], v119 offset:28672
ds_read_b64_tr_b16 a[126:127], v119 offset:30720
v_mfma_f32_16x16x32_bf16 v[84:87], a[92:95], v[244:247], v[84:87]
s_waitcnt vmcnt(6) lgkmcnt(9)
s_barrier
v_add_u32 v119, 65536, v119
v_mfma_f32_16x16x32_bf16 v[88:91], a[96:99], v[128:131], 0
buffer_store_dwordx4 v[64:67], v1, s[4:7], s8 offen offset:2048 sc1
ds_read_b64_tr_b16 a[64:65], v116 offset:0
v_mfma_f32_16x16x32_bf16 v[88:91], a[100:103], v[144:147], v[88:91]
PAD_16:
s_cbranch_execz M_tret
buffer_store_dword v6, v5, s[4:7], s34 offen sc1
ds_read_b64_tr_b16 a[66:67], v116 offset:2048
v_mfma_f32_16x16x32_bf16 v[88:91], a[104:107], v[160:163], v[88:91]
s_waitcnt lgkmcnt(8)
ds_read_b64_tr_b16 a[68:69], v116 offset:4096
v_mul_f32 v68, v68, v25
v_mfma_f32_16x16x32_bf16 v[88:91], a[108:111], v[176:179], v[88:91]
ds_read_b64_tr_b16 a[70:71], v116 offset:6144
v_mul_f32 v69, v69, v25
v_mfma_f32_16x16x32_bf16 v[88:91], a[112:115], v[192:195], v[88:91]
s_waitcnt lgkmcnt(8)
ds_read_b64_tr_b16 a[72:73], v116 offset:8192
v_mul_f32 v70, v70, v25
v_mfma_f32_16x16x32_bf16 v[88:91], a[116:119], v[208:211], v[88:91]
s_waitcnt lgkmcnt(7)
ds_read_b64_tr_b16 a[74:75], v116 offset:10240
v_mul_f32 v71, v71, v25
v_mfma_f32_16x16x32_bf16 v[88:91], a[120:123], v[224:227], v[88:91]
s_waitcnt lgkmcnt(6)
ds_read_b64_tr_b16 a[76:77], v116 offset:12288
v_mul_f32 v76, v76, v25
v_mfma_f32_16x16x32_bf16 v[88:91], a[124:127], v[240:243], v[88:91]
ds_read_b64_tr_b16 a[78:79], v116 offset:14336
v_mul_f32 v77, v77, v25
v_mfma_f32_16x16x32_bf16 v[92:95], a[96:99], v[132:135], 0
ds_read_b64_tr_b16 a[80:81], v116 offset:16384
v_mul_f32 v78, v78, v25
v_mfma_f32_16x16x32_bf16 v[92:95], a[100:103], v[148:151], v[92:95]
ds_read_b64_tr_b16 a[82:83], v116 offset:18432
v_mul_f32 v79, v79, v25
v_mfma_f32_16x16x32_bf16 v[92:95], a[104:107], v[164:167], v[92:95]
ds_read_b64_tr_b16 a[84:85], v116 offset:20480
v_cvt_pk_bf16_f32 v68, v68, v69
v_mfma_f32_16x16x32_bf16 v[92:95], a[108:111], v[180:183], v[92:95]
ds_read_b64_tr_b16 a[86:87], v116 offset:22528
v_cvt_pk_bf16_f32 v69, v70, v71
v_mfma_f32_16x16x32_bf16 v[92:95], a[112:115], v[196:199], v[92:95]
ds_read_b64_tr_b16 a[88:89], v116 offset:24576
v_cvt_pk_bf16_f32 v70, v76, v77
v_mfma_f32_16x16x32_bf16 v[92:95], a[116:119], v[212:215], v[92:95]
ds_read_b64_tr_b16 a[90:91], v116 offset:26624
v_cvt_pk_bf16_f32 v71, v78, v79
v_mfma_f32_16x16x32_bf16 v[92:95], a[120:123], v[228:231], v[92:95]
buffer_store_dwordx4 v[68:71], v1, s[4:7], s12 offen offset:2048 sc1
ds_read_b64_tr_b16 a[92:93], v116 offset:28672
v_mfma_f32_16x16x32_bf16 v[92:95], a[124:127], v[244:247], v[92:95]
s_waitcnt lgkmcnt(8)
ds_read_b64_tr_b16 a[94:95], v116 offset:30720
v_mfma_f32_16x16x32_bf16 v[32:35], a[64:67], v[128:131], 0
ds_read_b64_tr_b16 a[96:97], v117 offset:0
v_mul_f32 v80, v80, v24
v_mfma_f32_16x16x32_bf16 v[32:35], a[68:71], v[144:147], v[32:35]
ds_read_b64_tr_b16 a[98:99], v117 offset:2048
v_mul_f32 v81, v81, v24
v_mfma_f32_16x16x32_bf16 v[32:35], a[72:75], v[160:163], v[32:35]
s_waitcnt lgkmcnt(8)
ds_read_b64_tr_b16 a[100:101], v117 offset:4096
v_mul_f32 v82, v82, v24
v_mfma_f32_16x16x32_bf16 v[32:35], a[76:79], v[176:179], v[32:35]
ds_read_b64_tr_b16 a[102:103], v117 offset:6144
v_mul_f32 v83, v83, v24
v_mfma_f32_16x16x32_bf16 v[32:35], a[80:83], v[192:195], v[32:35]
s_waitcnt lgkmcnt(8)
ds_read_b64_tr_b16 a[104:105], v117 offset:8192
v_mul_f32 v88, v88, v24
v_mfma_f32_16x16x32_bf16 v[32:35], a[84:87], v[208:211], v[32:35]
s_waitcnt lgkmcnt(7)
ds_read_b64_tr_b16 a[106:107], v117 offset:10240
v_mul_f32 v89, v89, v24
v_mfma_f32_16x16x32_bf16 v[32:35], a[88:91], v[224:227], v[32:35]
s_waitcnt lgkmcnt(6)
ds_read_b64_tr_b16 a[108:109], v117 offset:12288
v_mul_f32 v90, v90, v24
v_mfma_f32_16x16x32_bf16 v[32:35], a[92:95], v[240:243], v[32:35]
ds_read_b64_tr_b16 a[110:111], v117 offset:14336
v_mul_f32 v91, v91, v24
v_mfma_f32_16x16x32_bf16 v[36:39], a[64:67], v[132:135], 0
ds_read_b64_tr_b16 a[112:113], v117 offset:16384
v_cvt_pk_bf16_f32 v80, v80, v81
v_mfma_f32_16x16x32_bf16 v[36:39], a[68:71], v[148:151], v[36:39]
ds_read_b64_tr_b16 a[114:115], v117 offset:18432
v_cvt_pk_bf16_f32 v81, v82, v83
v_mfma_f32_16x16x32_bf16 v[36:39], a[72:75], v[164:167], v[36:39]
ds_read_b64_tr_b16 a[116:117], v117 offset:20480
v_cvt_pk_bf16_f32 v82, v88, v89
v_mfma_f32_16x16x32_bf16 v[36:39], a[76:79], v[180:183], v[36:39]
ds_read_b64_tr_b16 a[118:119], v117 offset:22528
v_cvt_pk_bf16_f32 v83, v90, v91
v_mfma_f32_16x16x32_bf16 v[36:39], a[80:83], v[196:199], v[36:39]
buffer_store_dwordx4 v[80:83], v1, s[4:7], s8 offen offset:3072 sc1
ds_read_b64_tr_b16 a[120:121], v117 offset:24576
v_mfma_f32_16x16x32_bf16 v[36:39], a[84:87], v[212:215], v[36:39]
ds_read_b64_tr_b16 a[122:123], v117 offset:26624
v_mul_f32 v84, v84, v25
v_mfma_f32_16x16x32_bf16 v[36:39], a[88:91], v[228:231], v[36:39]
ds_read_b64_tr_b16 a[124:125], v117 offset:28672
v_mul_f32 v85, v85, v25
v_mfma_f32_16x16x32_bf16 v[36:39], a[92:95], v[244:247], v[36:39]
s_waitcnt lgkmcnt(8)
ds_read_b64_tr_b16 a[126:127], v117 offset:30720
v_mul_f32 v86, v86, v25
v_mfma_f32_16x16x32_bf16 v[40:43], a[96:99], v[128:131], 0
ds_read_b64_tr_b16 a[64:65], v118 offset:0
v_mul_f32 v87, v87, v25
v_mfma_f32_16x16x32_bf16 v[40:43], a[100:103], v[144:147], v[40:43]
ds_read_b64_tr_b16 a[66:67], v118 offset:2048
v_mul_f32 v92, v92, v25
v_mfma_f32_16x16x32_bf16 v[40:43], a[104:107], v[160:163], v[40:43]
s_waitcnt lgkmcnt(8)
ds_read_b64_tr_b16 a[68:69], v118 offset:4096
v_mul_f32 v93, v93, v25
v_mfma_f32_16x16x32_bf16 v[40:43], a[108:111], v[176:179], v[40:43]
ds_read_b64_tr_b16 a[70:71], v118 offset:6144
v_mul_f32 v94, v94, v25
v_mfma_f32_16x16x32_bf16 v[40:43], a[112:115], v[192:195], v[40:43]
s_waitcnt lgkmcnt(8)
ds_read_b64_tr_b16 a[72:73], v118 offset:8192
v_mul_f32 v95, v95, v25
v_mfma_f32_16x16x32_bf16 v[40:43], a[116:119], v[208:211], v[40:43]
s_waitcnt lgkmcnt(7)
ds_read_b64_tr_b16 a[74:75], v118 offset:10240
v_cvt_pk_bf16_f32 v84, v84, v85
v_mfma_f32_16x16x32_bf16 v[40:43], a[120:123], v[224:227], v[40:43]
s_waitcnt lgkmcnt(6)
ds_read_b64_tr_b16 a[76:77], v118 offset:12288
v_cvt_pk_bf16_f32 v85, v86, v87
v_mfma_f32_16x16x32_bf16 v[40:43], a[124:127], v[240:243], v[40:43]
ds_read_b64_tr_b16 a[78:79], v118 offset:14336
v_cvt_pk_bf16_f32 v86, v92, v93
v_mfma_f32_16x16x32_bf16 v[44:47], a[96:99], v[132:135], 0
ds_read_b64_tr_b16 a[80:81], v118 offset:16384
v_cvt_pk_bf16_f32 v87, v94, v95
v_mfma_f32_16x16x32_bf16 v[44:47], a[100:103], v[148:151], v[44:47]
buffer_store_dwordx4 v[84:87], v1, s[4:7], s12 offen offset:3072 sc1
ds_read_b64_tr_b16 a[82:83], v118 offset:18432
v_mfma_f32_16x16x32_bf16 v[44:47], a[104:107], v[164:167], v[44:47]
s_add_u32 s8, s8, 4096
s_add_u32 s12, s12, 4096
ds_read_b64_tr_b16 a[84:85], v118 offset:20480
v_mfma_f32_16x16x32_bf16 v[44:47], a[108:111], v[180:183], v[44:47]
ds_read_b64_tr_b16 a[86:87], v118 offset:22528
v_lshlrev_b32 v19, 2, v19
v_mfma_f32_16x16x32_bf16 v[44:47], a[112:115], v[196:199], v[44:47]
ds_read_b64_tr_b16 a[88:89], v118 offset:24576
v_mul_f32 v32, v32, v24
v_mfma_f32_16x16x32_bf16 v[44:47], a[116:119], v[212:215], v[44:47]
ds_read_b64_tr_b16 a[90:91], v118 offset:26624
v_mul_f32 v33, v33, v24
v_mfma_f32_16x16x32_bf16 v[44:47], a[120:123], v[228:231], v[44:47]
ds_read_b64_tr_b16 a[92:93], v118 offset:28672
v_mul_f32 v34, v34, v24
v_mfma_f32_16x16x32_bf16 v[44:47], a[124:127], v[244:247], v[44:47]
s_waitcnt lgkmcnt(8)
ds_read_b64_tr_b16 a[94:95], v118 offset:30720
v_mul_f32 v35, v35, v24
v_mfma_f32_16x16x32_bf16 v[48:51], a[64:67], v[128:131], 0
ds_read_b64_tr_b16 a[96:97], v119 offset:0
v_mul_f32 v40, v40, v24
v_mfma_f32_16x16x32_bf16 v[48:51], a[68:71], v[144:147], v[48:51]
ds_read_b64_tr_b16 a[98:99], v119 offset:2048
v_mul_f32 v41, v41, v24
v_mfma_f32_16x16x32_bf16 v[48:51], a[72:75], v[160:163], v[48:51]
s_waitcnt lgkmcnt(8)
ds_read_b64_tr_b16 a[100:101], v119 offset:4096
v_mul_f32 v42, v42, v24
v_mfma_f32_16x16x32_bf16 v[48:51], a[76:79], v[176:179], v[48:51]
ds_read_b64_tr_b16 a[102:103], v119 offset:6144
v_mul_f32 v43, v43, v24
v_mfma_f32_16x16x32_bf16 v[48:51], a[80:83], v[192:195], v[48:51]
s_waitcnt lgkmcnt(8)
ds_read_b64_tr_b16 a[104:105], v119 offset:8192
v_cvt_pk_bf16_f32 v32, v32, v33
v_mfma_f32_16x16x32_bf16 v[48:51], a[84:87], v[208:211], v[48:51]
s_waitcnt lgkmcnt(7)
ds_read_b64_tr_b16 a[106:107], v119 offset:10240
v_cvt_pk_bf16_f32 v33, v34, v35
v_mfma_f32_16x16x32_bf16 v[48:51], a[88:91], v[224:227], v[48:51]
s_waitcnt lgkmcnt(6)
ds_read_b64_tr_b16 a[108:109], v119 offset:12288
v_cvt_pk_bf16_f32 v34, v40, v41
v_mfma_f32_16x16x32_bf16 v[48:51], a[92:95], v[240:243], v[48:51]
ds_read_b64_tr_b16 a[110:111], v119 offset:14336
v_cvt_pk_bf16_f32 v35, v42, v43
v_mfma_f32_16x16x32_bf16 v[52:55], a[64:67], v[132:135], 0
buffer_store_dwordx4 v[32:35], v1, s[4:7], s8 offen offset:0 sc1
ds_read_b64_tr_b16 a[112:113], v119 offset:16384
v_mfma_f32_16x16x32_bf16 v[52:55], a[68:71], v[148:151], v[52:55]
ds_read_b64_tr_b16 a[114:115], v119 offset:18432
v_mul_f32 v36, v36, v25
v_mfma_f32_16x16x32_bf16 v[52:55], a[72:75], v[164:167], v[52:55]
ds_read_b64_tr_b16 a[116:117], v119 offset:20480
v_mul_f32 v37, v37, v25
v_mfma_f32_16x16x32_bf16 v[52:55], a[76:79], v[180:183], v[52:55]
ds_read_b64_tr_b16 a[118:119], v119 offset:22528
v_mul_f32 v38, v38, v25
v_mfma_f32_16x16x32_bf16 v[52:55], a[80:83], v[196:199], v[52:55]
ds_read_b64_tr_b16 a[120:121], v119 offset:24576
v_mul_f32 v39, v39, v25
v_mfma_f32_16x16x32_bf16 v[52:55], a[84:87], v[212:215], v[52:55]
ds_read_b64_tr_b16 a[122:123], v119 offset:26624
v_mul_f32 v44, v44, v25
v_mfma_f32_16x16x32_bf16 v[52:55], a[88:91], v[228:231], v[52:55]
ds_read_b64_tr_b16 a[124:125], v119 offset:28672
ds_read_b64_tr_b16 a[126:127], v119 offset:30720
v_mfma_f32_16x16x32_bf16 v[52:55], a[92:95], v[244:247], v[52:55]
s_waitcnt lgkmcnt(9)
v_mul_f32 v45, v45, v25
v_mul_f32 v46, v46, v25
v_mfma_f32_16x16x32_bf16 v[56:59], a[96:99], v[128:131], 0
v_mul_f32 v47, v47, v25
v_cvt_pk_bf16_f32 v36, v36, v37
v_mfma_f32_16x16x32_bf16 v[56:59], a[100:103], v[144:147], v[56:59]
v_cvt_pk_bf16_f32 v37, v38, v39
v_cvt_pk_bf16_f32 v38, v44, v45
v_mfma_f32_16x16x32_bf16 v[56:59], a[104:107], v[160:163], v[56:59]
s_waitcnt lgkmcnt(6)
v_cvt_pk_bf16_f32 v39, v46, v47
v_lshrrev_b32 v22, 4, v20
v_mfma_f32_16x16x32_bf16 v[56:59], a[108:111], v[176:179], v[56:59]
buffer_store_dwordx4 v[36:39], v1, s[4:7], s12 offen offset:0 sc1
v_mfma_f32_16x16x32_bf16 v[56:59], a[112:115], v[192:195], v[56:59]
s_waitcnt lgkmcnt(4)
v_lshl_add_u32 v21, v22, 3, v21
v_mfma_f32_16x16x32_bf16 v[56:59], a[116:119], v[208:211], v[56:59]
s_waitcnt lgkmcnt(2)
v_mfma_f32_16x16x32_bf16 v[56:59], a[120:123], v[224:227], v[56:59]
s_waitcnt lgkmcnt(0)
v_mfma_f32_16x16x32_bf16 v[56:59], a[124:127], v[240:243], v[56:59]
v_mfma_f32_16x16x32_bf16 v[60:63], a[96:99], v[132:135], 0
v_mfma_f32_16x16x32_bf16 v[60:63], a[100:103], v[148:151], v[60:63]
v_mfma_f32_16x16x32_bf16 v[60:63], a[104:107], v[164:167], v[60:63]
v_mfma_f32_16x16x32_bf16 v[60:63], a[108:111], v[180:183], v[60:63]
v_mfma_f32_16x16x32_bf16 v[60:63], a[112:115], v[196:199], v[60:63]
buffer_load_dword v18, v19, s[4:7], s33 offen offset:0 sc1
v_mfma_f32_16x16x32_bf16 v[60:63], a[116:119], v[212:215], v[60:63]
v_mfma_f32_16x16x32_bf16 v[60:63], a[120:123], v[228:231], v[60:63]
v_mfma_f32_16x16x32_bf16 v[60:63], a[124:127], v[244:247], v[60:63]
v_mul_f32 v48, v48, v24
v_mul_f32 v49, v49, v24
v_mul_f32 v50, v50, v24
v_mul_f32 v51, v51, v24
v_mul_f32 v56, v56, v24
v_mul_f32 v57, v57, v24
v_mul_f32 v58, v58, v24
v_mul_f32 v59, v59, v24
v_cvt_pk_bf16_f32 v48, v48, v49
v_cvt_pk_bf16_f32 v49, v50, v51
v_cvt_pk_bf16_f32 v50, v56, v57
v_cvt_pk_bf16_f32 v51, v58, v59
buffer_store_dwordx4 v[48:51], v1, s[4:7], s8 offen offset:1024 sc1
v_mul_f32 v52, v52, v25
v_mul_f32 v53, v53, v25
v_mul_f32 v54, v54, v25
v_mul_f32 v55, v55, v25
v_mul_f32 v60, v60, v25
v_mul_f32 v61, v61, v25
v_mul_f32 v62, v62, v25
v_mul_f32 v63, v63, v25
v_cvt_pk_bf16_f32 v52, v52, v53
v_cvt_pk_bf16_f32 v53, v54, v55
v_cvt_pk_bf16_f32 v54, v60, v61
v_cvt_pk_bf16_f32 v55, v62, v63
buffer_store_dwordx4 v[52:55], v1, s[4:7], s12 offen offset:1024 sc1
s_and_b32 s22, s2, 224
s_cmp_eq_u32 s22, 224
s_cbranch_scc1 M_final
s_waitcnt vmcnt(0)
s_barrier
buffer_store_dword v6, v5, s[4:7], s35 offen sc1
s_bitcmp1_b32 s79, 4
s_cbranch_scc1 M_rA
v_cmp_gt_u32 vcc, 1, v18
s_cbranch_vccnz M_rslow
M_rjoin:
buffer_load_dwordx4 v[128:131], v1, s[4:7], s26 offen sc1
s_add_u32 s26, s26, 14336
buffer_load_dwordx4 v[132:135], v1, s[4:7], s26 offen sc1
s_add_u32 s26, s26, 14336
buffer_load_dwordx4 v[136:139], v1, s[4:7], s26 offen sc1
s_add_u32 s26, s26, 14336
buffer_load_dwordx4 v[140:143], v1, s[4:7], s26 offen sc1
s_add_u32 s26, s26, 14336
buffer_load_dwordx4 v[144:147], v1, s[4:7], s26 offen sc1
s_add_u32 s26, s26, 14336
buffer_load_dwordx4 v[148:151], v1, s[4:7], s26 offen sc1
s_add_u32 s26, s26, 14336
buffer_load_dwordx4 v[152:155], v1, s[4:7], s26 offen sc1
s_add_u32 s26, s26, 14336
buffer_load_dwordx4 v[156:159], v1, s[4:7], s26 offen sc1
s_add_u32 s26, s26, 14336
buffer_load_dwordx4 v[160:163], v1, s[4:7], s26 offen sc1
s_add_u32 s26, s26, 14336
buffer_load_dwordx4 v[164:167], v1, s[4:7], s26 offen sc1
s_add_u32 s26, s26, 14336
buffer_load_dwordx4 v[168:171], v1, s[4:7], s26 offen sc1
s_add_u32 s26, s26, 14336
buffer_load_dwordx4 v[172:175], v1, s[4:7], s26 offen sc1
s_add_u32 s26, s26, 14336
buffer_load_dwordx4 v[176:179], v1, s[4:7], s26 offen sc1
s_add_u32 s26, s26, 14336
buffer_load_dwordx4 v[180:183], v1, s[4:7], s26 offen sc1
s_add_u32 s26, s26, 14336
buffer_load_dwordx4 v[184:187], v1, s[4:7], s26 offen sc1
s_add_u32 s26, s26, 14336
buffer_load_dwordx4 v[188:191], v1, s[4:7], s26 offen sc1
Lp_9201:
buffer_load_dword v18, v19, s[4:7], s33 offen offset:2048 sc1
s_waitcnt vmcnt(0)
v_cmp_gt_u32 vcc, 1, v18
s_cbranch_vccz Lpd_9202
s_sleep 8
s_sub_u32 s101, s101, 1
s_cbranch_scc0 Lp_9201
s_mov_b32 s101, 0
Lpd_9202:
s_sub_u32 s26, s26, 207872
buffer_load_dwordx4 v[192:195], v1, s[4:7], s26 offen sc1
s_add_u32 s26, s26, 14336
buffer_load_dwordx4 v[196:199], v1, s[4:7], s26 offen sc1
s_add_u32 s26, s26, 14336
buffer_load_dwordx4 v[200:203], v1, s[4:7], s26 offen sc1
s_add_u32 s26, s26, 14336
buffer_load_dwordx4 v[204:207], v1, s[4:7], s26 offen sc1
s_add_u32 s26, s26, 14336
buffer_load_dwordx4 v[208:211], v1, s[4:7], s26 offen sc1
s_add_u32 s26, s26, 14336
buffer_load_dwordx4 v[212:215], v1, s[4:7], s26 offen sc1
s_add_u32 s26, s26, 14336
buffer_load_dwordx4 v[216:219], v1, s[4:7], s26 offen sc1
s_add_u32 s26, s26, 14336
buffer_load_dwordx4 v[220:223], v1, s[4:7], s26 offen sc1
s_add_u32 s26, s26, 14336
buffer_load_dwordx4 v[224:227], v1, s[4:7], s26 offen sc1
s_add_u32 s26, s26, 14336
buffer_load_dwordx4 v[228:231], v1, s[4:7], s26 offen sc1
s_add_u32 s26, s26, 14336
buffer_load_dwordx4 v[232:235], v1, s[4:7], s26 offen sc1
s_add_u32 s26, s26, 14336
buffer_load_dwordx4 v[236:239], v1, s[4:7], s26 offen sc1
s_add_u32 s26, s26, 14336
buffer_load_dwordx4 v[240:243], v1, s[4:7], s26 offen sc1
s_add_u32 s26, s26, 14336
buffer_load_dwordx4 v[244:247], v1, s[4:7], s26 offen sc1
s_add_u32 s26, s26, 14336
buffer_load_dwordx4 v[248:251], v1, s[4:7], s26 offen sc1
s_add_u32 s26, s26, 14336
buffer_load_dwordx4 v[252:255], v1, s[4:7], s26 offen sc1
v_lshlrev_b32 v96, 16, v128
v_and_b32 v97, 0xffff0000, v128
v_lshlrev_b32 v98, 16, v129
v_and_b32 v99, 0xffff0000, v129
v_lshlrev_b32 v100, 16, v130
v_and_b32 v101, 0xffff0000, v130
v_lshlrev_b32 v102, 16, v131
v_and_b32 v103, 0xffff0000, v131
v_lshlrev_b32 v10, 16, v132
v_and_b32 v11, 0xffff0000, v132
v_lshlrev_b32 v12, 16, v133
v_and_b32 v13, 0xffff0000, v133
v_lshlrev_b32 v14, 16, v134
v_and_b32 v15, 0xffff0000, v134
v_lshlrev_b32 v16, 16, v135
v_and_b32 v17, 0xffff0000, v135
v_pk_add_f32 v[96:97], v[96:97], v[10:11]
v_pk_add_f32 v[98:99], v[98:99], v[12:13]
v_pk_add_f32 v[100:101], v[100:101], v[14:15]
v_pk_add_f32 v[102:103], v[102:103], v[16:17]
v_lshlrev_b32 v10, 16, v136
v_and_b32 v11, 0xffff0000, v136
v_lshlrev_b32 v12, 16, v137
v_and_b32 v13, 0xffff0000, v137
v_lshlrev_b32 v14, 16, v138
v_and_b32 v15, 0xffff0000, v138
v_lshlrev_b32 v16, 16, v139
v_and_b32 v17, 0xffff0000, v139
v_pk_add_f32 v[96:97], v[96:97], v[10:11]
v_pk_add_f32 v[98:99], v[98:99], v[12:13]
v_pk_add_f32 v[100:101], v[100:101], v[14:15]
v_pk_add_f32 v[102:103], v[102:103], v[16:17]
v_lshlrev_b32 v10, 16, v140
v_and_b32 v11, 0xffff0000, v140
v_lshlrev_b32 v12, 16, v141
v_and_b32 v13, 0xffff0000, v141
v_lshlrev_b32 v14, 16, v142
v_and_b32 v15, 0xffff0000, v142
v_lshlrev_b32 v16, 16, v143
v_and_b32 v17, 0xffff0000, v143
v_pk_add_f32 v[96:97], v[96:97], v[10:11]
v_pk_add_f32 v[98:99], v[98:99], v[12:13]
v_pk_add_f32 v[100:101], v[100:101], v[14:15]
v_pk_add_f32 v[102:103], v[102:103], v[16:17]
v_lshlrev_b32 v10, 16, v144
v_and_b32 v11, 0xffff0000, v144
v_lshlrev_b32 v12, 16, v145
v_and_b32 v13, 0xffff0000, v145
v_lshlrev_b32 v14, 16, v146
v_and_b32 v15, 0xffff0000, v146
v_lshlrev_b32 v16, 16, v147
v_and_b32 v17, 0xffff0000, v147
v_pk_add_f32 v[96:97], v[96:97], v[10:11]
v_pk_add_f32 v[98:99], v[98:99], v[12:13]
v_pk_add_f32 v[100:101], v[100:101], v[14:15]
v_pk_add_f32 v[102:103], v[102:103], v[16:17]
v_lshlrev_b32 v10, 16, v148
v_and_b32 v11, 0xffff0000, v148
v_lshlrev_b32 v12, 16, v149
v_and_b32 v13, 0xffff0000, v149
v_lshlrev_b32 v14, 16, v150
v_and_b32 v15, 0xffff0000, v150
v_lshlrev_b32 v16, 16, v151
v_and_b32 v17, 0xffff0000, v151
v_pk_add_f32 v[96:97], v[96:97], v[10:11]
v_pk_add_f32 v[98:99], v[98:99], v[12:13]
v_pk_add_f32 v[100:101], v[100:101], v[14:15]
v_pk_add_f32 v[102:103], v[102:103], v[16:17]
v_lshlrev_b32 v10, 16, v152
v_and_b32 v11, 0xffff0000, v152
v_lshlrev_b32 v12, 16, v153
v_and_b32 v13, 0xffff0000, v153
v_lshlrev_b32 v14, 16, v154
v_and_b32 v15, 0xffff0000, v154
v_lshlrev_b32 v16, 16, v155
v_and_b32 v17, 0xffff0000, v155
v_pk_add_f32 v[96:97], v[96:97], v[10:11]
v_pk_add_f32 v[98:99], v[98:99], v[12:13]
v_pk_add_f32 v[100:101], v[100:101], v[14:15]
v_pk_add_f32 v[102:103], v[102:103], v[16:17]
v_lshlrev_b32 v10, 16, v156
v_and_b32 v11, 0xffff0000, v156
v_lshlrev_b32 v12, 16, v157
v_and_b32 v13, 0xffff0000, v157
v_lshlrev_b32 v14, 16, v158
v_and_b32 v15, 0xffff0000, v158
v_lshlrev_b32 v16, 16, v159
v_and_b32 v17, 0xffff0000, v159
v_pk_add_f32 v[96:97], v[96:97], v[10:11]
v_pk_add_f32 v[98:99], v[98:99], v[12:13]
v_pk_add_f32 v[100:101], v[100:101], v[14:15]
v_pk_add_f32 v[102:103], v[102:103], v[16:17]
v_lshlrev_b32 v10, 16, v160
v_and_b32 v11, 0xffff0000, v160
v_lshlrev_b32 v12, 16, v161
v_and_b32 v13, 0xffff0000, v161
v_lshlrev_b32 v14, 16, v162
v_and_b32 v15, 0xffff0000, v162
v_lshlrev_b32 v16, 16, v163
v_and_b32 v17, 0xffff0000, v163
v_pk_add_f32 v[96:97], v[96:97], v[10:11]
v_pk_add_f32 v[98:99], v[98:99], v[12:13]
v_pk_add_f32 v[100:101], v[100:101], v[14:15]
v_pk_add_f32 v[102:103], v[102:103], v[16:17]
v_lshlrev_b32 v10, 16, v164
v_and_b32 v11, 0xffff0000, v164
v_lshlrev_b32 v12, 16, v165
v_and_b32 v13, 0xffff0000, v165
v_lshlrev_b32 v14, 16, v166
v_and_b32 v15, 0xffff0000, v166
v_lshlrev_b32 v16, 16, v167
v_and_b32 v17, 0xffff0000, v167
v_pk_add_f32 v[96:97], v[96:97], v[10:11]
v_pk_add_f32 v[98:99], v[98:99], v[12:13]
v_pk_add_f32 v[100:101], v[100:101], v[14:15]
v_pk_add_f32 v[102:103], v[102:103], v[16:17]
v_lshlrev_b32 v10, 16, v168
v_and_b32 v11, 0xffff0000, v168
v_lshlrev_b32 v12, 16, v169
v_and_b32 v13, 0xffff0000, v169
v_lshlrev_b32 v14, 16, v170
v_and_b32 v15, 0xffff0000, v170
v_lshlrev_b32 v16, 16, v171
v_and_b32 v17, 0xffff0000, v171
v_pk_add_f32 v[96:97], v[96:97], v[10:11]
v_pk_add_f32 v[98:99], v[98:99], v[12:13]
v_pk_add_f32 v[100:101], v[100:101], v[14:15]
v_pk_add_f32 v[102:103], v[102:103], v[16:17]
v_lshlrev_b32 v10, 16, v172
v_and_b32 v11, 0xffff0000, v172
v_lshlrev_b32 v12, 16, v173
v_and_b32 v13, 0xffff0000, v173
v_lshlrev_b32 v14, 16, v174
v_and_b32 v15, 0xffff0000, v174
v_lshlrev_b32 v16, 16, v175
v_and_b32 v17, 0xffff0000, v175
v_pk_add_f32 v[96:97], v[96:97], v[10:11]
v_pk_add_f32 v[98:99], v[98:99], v[12:13]
v_pk_add_f32 v[100:101], v[100:101], v[14:15]
v_pk_add_f32 v[102:103], v[102:103], v[16:17]
v_lshlrev_b32 v10, 16, v176
v_and_b32 v11, 0xffff0000, v176
v_lshlrev_b32 v12, 16, v177
v_and_b32 v13, 0xffff0000, v177
v_lshlrev_b32 v14, 16, v178
v_and_b32 v15, 0xffff0000, v178
v_lshlrev_b32 v16, 16, v179
v_and_b32 v17, 0xffff0000, v179
v_pk_add_f32 v[96:97], v[96:97], v[10:11]
v_pk_add_f32 v[98:99], v[98:99], v[12:13]
v_pk_add_f32 v[100:101], v[100:101], v[14:15]
v_pk_add_f32 v[102:103], v[102:103], v[16:17]
v_lshlrev_b32 v10, 16, v180
v_and_b32 v11, 0xffff0000, v180
v_lshlrev_b32 v12, 16, v181
v_and_b32 v13, 0xffff0000, v181
v_lshlrev_b32 v14, 16, v182
v_and_b32 v15, 0xffff0000, v182
v_lshlrev_b32 v16, 16, v183
v_and_b32 v17, 0xffff0000, v183
v_pk_add_f32 v[96:97], v[96:97], v[10:11]
v_pk_add_f32 v[98:99], v[98:99], v[12:13]
v_pk_add_f32 v[100:101], v[100:101], v[14:15]
v_pk_add_f32 v[102:103], v[102:103], v[16:17]
v_lshlrev_b32 v10, 16, v184
v_and_b32 v11, 0xffff0000, v184
v_lshlrev_b32 v12, 16, v185
v_and_b32 v13, 0xffff0000, v185
v_lshlrev_b32 v14, 16, v186
v_and_b32 v15, 0xffff0000, v186
v_lshlrev_b32 v16, 16, v187
v_and_b32 v17, 0xffff0000, v187
v_pk_add_f32 v[96:97], v[96:97], v[10:11]
v_pk_add_f32 v[98:99], v[98:99], v[12:13]
v_pk_add_f32 v[100:101], v[100:101], v[14:15]
v_pk_add_f32 v[102:103], v[102:103], v[16:17]
v_lshlrev_b32 v10, 16, v188
v_and_b32 v11, 0xffff0000, v188
v_lshlrev_b32 v12, 16, v189
v_and_b32 v13, 0xffff0000, v189
v_lshlrev_b32 v14, 16, v190
v_and_b32 v15, 0xffff0000, v190
v_lshlrev_b32 v16, 16, v191
v_and_b32 v17, 0xffff0000, v191
v_pk_add_f32 v[96:97], v[96:97], v[10:11]
v_pk_add_f32 v[98:99], v[98:99], v[12:13]
v_pk_add_f32 v[100:101], v[100:101], v[14:15]
v_pk_add_f32 v[102:103], v[102:103], v[16:17]
v_cvt_pk_bf16_f32 v96, v96, v97
v_cvt_pk_bf16_f32 v97, v98, v99
v_cvt_pk_bf16_f32 v98, v100, v101
v_cvt_pk_bf16_f32 v99, v102, v103
buffer_store_dwordx2 v[96:97], v21, s[40:43], s25 offen offset:896
buffer_store_dwordx2 v[98:99], v21, s[40:43], s25 offen offset:928
s_waitcnt vmcnt(17)
v_lshlrev_b32 v104, 16, v192
v_and_b32 v105, 0xffff0000, v192
v_lshlrev_b32 v106, 16, v193
v_and_b32 v107, 0xffff0000, v193
v_lshlrev_b32 v108, 16, v194
v_and_b32 v109, 0xffff0000, v194
v_lshlrev_b32 v110, 16, v195
v_and_b32 v111, 0xffff0000, v195
s_waitcnt vmcnt(16)
v_lshlrev_b32 v10, 16, v196
v_and_b32 v11, 0xffff0000, v196
v_lshlrev_b32 v12, 16, v197
v_and_b32 v13, 0xffff0000, v197
v_lshlrev_b32 v14, 16, v198
v_and_b32 v15, 0xffff0000, v198
v_lshlrev_b32 v16, 16, v199
v_and_b32 v17, 0xffff0000, v199
v_pk_add_f32 v[104:105], v[104:105], v[10:11]
v_pk_add_f32 v[106:107], v[106:107], v[12:13]
v_pk_add_f32 v[108:109], v[108:109], v[14:15]
v_pk_add_f32 v[110:111], v[110:111], v[16:17]
s_waitcnt vmcnt(15)
v_lshlrev_b32 v10, 16, v200
v_and_b32 v11, 0xffff0000, v200
v_lshlrev_b32 v12, 16, v201
v_and_b32 v13, 0xffff0000, v201
v_lshlrev_b32 v14, 16, v202
v_and_b32 v15, 0xffff0000, v202
v_lshlrev_b32 v16, 16, v203
v_and_b32 v17, 0xffff0000, v203
v_pk_add_f32 v[104:105], v[104:105], v[10:11]
v_pk_add_f32 v[106:107], v[106:107], v[12:13]
v_pk_add_f32 v[108:109], v[108:109], v[14:15]
v_pk_add_f32 v[110:111], v[110:111], v[16:17]
s_waitcnt vmcnt(14)
v_lshlrev_b32 v10, 16, v204
v_and_b32 v11, 0xffff0000, v204
v_lshlrev_b32 v12, 16, v205
v_and_b32 v13, 0xffff0000, v205
v_lshlrev_b32 v14, 16, v206
v_and_b32 v15, 0xffff0000, v206
v_lshlrev_b32 v16, 16, v207
v_and_b32 v17, 0xffff0000, v207
v_pk_add_f32 v[104:105], v[104:105], v[10:11]
v_pk_add_f32 v[106:107], v[106:107], v[12:13]
v_pk_add_f32 v[108:109], v[108:109], v[14:15]
v_pk_add_f32 v[110:111], v[110:111], v[16:17]
s_waitcnt vmcnt(13)
v_lshlrev_b32 v10, 16, v208
v_and_b32 v11, 0xffff0000, v208
v_lshlrev_b32 v12, 16, v209
v_and_b32 v13, 0xffff0000, v209
v_lshlrev_b32 v14, 16, v210
v_and_b32 v15, 0xffff0000, v210
v_lshlrev_b32 v16, 16, v211
v_and_b32 v17, 0xffff0000, v211
v_pk_add_f32 v[104:105], v[104:105], v[10:11]
v_pk_add_f32 v[106:107], v[106:107], v[12:13]
v_pk_add_f32 v[108:109], v[108:109], v[14:15]
v_pk_add_f32 v[110:111], v[110:111], v[16:17]
s_waitcnt vmcnt(12)
v_lshlrev_b32 v10, 16, v212
v_and_b32 v11, 0xffff0000, v212
v_lshlrev_b32 v12, 16, v213
v_and_b32 v13, 0xffff0000, v213
PAD_17:
s_cbranch_execz M_tret
v_lshlrev_b32 v14, 16, v214
v_and_b32 v15, 0xffff0000, v214
v_lshlrev_b32 v16, 16, v215
v_and_b32 v17, 0xffff0000, v215
v_pk_add_f32 v[104:105], v[104:105], v[10:11]
v_pk_add_f32 v[106:107], v[106:107], v[12:13]
v_pk_add_f32 v[108:109], v[108:109], v[14:15]
v_pk_add_f32 v[110:111], v[110:111], v[16:17]
s_waitcnt vmcnt(11)
v_lshlrev_b32 v10, 16, v216
v_and_b32 v11, 0xffff0000, v216
v_lshlrev_b32 v12, 16, v217
v_and_b32 v13, 0xffff0000, v217
v_lshlrev_b32 v14, 16, v218
v_and_b32 v15, 0xffff0000, v218
v_lshlrev_b32 v16, 16, v219
v_and_b32 v17, 0xffff0000, v219
v_pk_add_f32 v[104:105], v[104:105], v[10:11]
v_pk_add_f32 v[106:107], v[106:107], v[12:13]
v_pk_add_f32 v[108:109], v[108:109], v[14:15]
v_pk_add_f32 v[110:111], v[110:111], v[16:17]
s_waitcnt vmcnt(10)
v_lshlrev_b32 v10, 16, v220
v_and_b32 v11, 0xffff0000, v220
v_lshlrev_b32 v12, 16, v221
v_and_b32 v13, 0xffff0000, v221
v_lshlrev_b32 v14, 16, v222
v_and_b32 v15, 0xffff0000, v222
v_lshlrev_b32 v16, 16, v223
v_and_b32 v17, 0xffff0000, v223
v_pk_add_f32 v[104:105], v[104:105], v[10:11]
v_pk_add_f32 v[106:107], v[106:107], v[12:13]
v_pk_add_f32 v[108:109], v[108:109], v[14:15]
v_pk_add_f32 v[110:111], v[110:111], v[16:17]
s_waitcnt vmcnt(9)
v_lshlrev_b32 v10, 16, v224
v_and_b32 v11, 0xffff0000, v224
v_lshlrev_b32 v12, 16, v225
v_and_b32 v13, 0xffff0000, v225
v_lshlrev_b32 v14, 16, v226
v_and_b32 v15, 0xffff0000, v226
v_lshlrev_b32 v16, 16, v227
v_and_b32 v17, 0xffff0000, v227
v_pk_add_f32 v[104:105], v[104:105], v[10:11]
v_pk_add_f32 v[106:107], v[106:107], v[12:13]
v_pk_add_f32 v[108:109], v[108:109], v[14:15]
v_pk_add_f32 v[110:111], v[110:111], v[16:17]
s_waitcnt vmcnt(8)
v_lshlrev_b32 v10, 16, v228
v_and_b32 v11, 0xffff0000, v228
v_lshlrev_b32 v12, 16, v229
v_and_b32 v13, 0xffff0000, v229
v_lshlrev_b32 v14, 16, v230
v_and_b32 v15, 0xffff0000, v230
v_lshlrev_b32 v16, 16, v231
v_and_b32 v17, 0xffff0000, v231
v_pk_add_f32 v[104:105], v[104:105], v[10:11]
v_pk_add_f32 v[106:107], v[106:107], v[12:13]
v_pk_add_f32 v[108:109], v[108:109], v[14:15]
v_pk_add_f32 v[110:111], v[110:111], v[16:17]
s_waitcnt vmcnt(7)
v_lshlrev_b32 v10, 16, v232
v_and_b32 v11, 0xffff0000, v232
v_lshlrev_b32 v12, 16, v233
v_and_b32 v13, 0xffff0000, v233
v_lshlrev_b32 v14, 16, v234
v_and_b32 v15, 0xffff0000, v234
v_lshlrev_b32 v16, 16, v235
v_and_b32 v17, 0xffff0000, v235
v_pk_add_f32 v[104:105], v[104:105], v[10:11]
v_pk_add_f32 v[106:107], v[106:107], v[12:13]
v_pk_add_f32 v[108:109], v[108:109], v[14:15]
v_pk_add_f32 v[110:111], v[110:111], v[16:17]
s_waitcnt vmcnt(6)
v_lshlrev_b32 v10, 16, v236
v_and_b32 v11, 0xffff0000, v236
v_lshlrev_b32 v12, 16, v237
v_and_b32 v13, 0xffff0000, v237
v_lshlrev_b32 v14, 16, v238
v_and_b32 v15, 0xffff0000, v238
v_lshlrev_b32 v16, 16, v239
v_and_b32 v17, 0xffff0000, v239
v_pk_add_f32 v[104:105], v[104:105], v[10:11]
v_pk_add_f32 v[106:107], v[106:107], v[12:13]
v_pk_add_f32 v[108:109], v[108:109], v[14:15]
v_pk_add_f32 v[110:111], v[110:111], v[16:17]
s_waitcnt vmcnt(5)
v_lshlrev_b32 v10, 16, v240
v_and_b32 v11, 0xffff0000, v240
v_lshlrev_b32 v12, 16, v241
v_and_b32 v13, 0xffff0000, v241
v_lshlrev_b32 v14, 16, v242
v_and_b32 v15, 0xffff0000, v242
v_lshlrev_b32 v16, 16, v243
v_and_b32 v17, 0xffff0000, v243
v_pk_add_f32 v[104:105], v[104:105], v[10:11]
v_pk_add_f32 v[106:107], v[106:107], v[12:13]
v_pk_add_f32 v[108:109], v[108:109], v[14:15]
v_pk_add_f32 v[110:111], v[110:111], v[16:17]
s_waitcnt vmcnt(4)
v_lshlrev_b32 v10, 16, v244
v_and_b32 v11, 0xffff0000, v244
v_lshlrev_b32 v12, 16, v245
v_and_b32 v13, 0xffff0000, v245
v_lshlrev_b32 v14, 16, v246
v_and_b32 v15, 0xffff0000, v246
v_lshlrev_b32 v16, 16, v247
v_and_b32 v17, 0xffff0000, v247
v_pk_add_f32 v[104:105], v[104:105], v[10:11]
v_pk_add_f32 v[106:107], v[106:107], v[12:13]
v_pk_add_f32 v[108:109], v[108:109], v[14:15]
v_pk_add_f32 v[110:111], v[110:111], v[16:17]
s_waitcnt vmcnt(3)
v_lshlrev_b32 v10, 16, v248
v_and_b32 v11, 0xffff0000, v248
v_lshlrev_b32 v12, 16, v249
v_and_b32 v13, 0xffff0000, v249
v_lshlrev_b32 v14, 16, v250
v_and_b32 v15, 0xffff0000, v250
v_lshlrev_b32 v16, 16, v251
v_and_b32 v17, 0xffff0000, v251
v_pk_add_f32 v[104:105], v[104:105], v[10:11]
v_pk_add_f32 v[106:107], v[106:107], v[12:13]
v_pk_add_f32 v[108:109], v[108:109], v[14:15]
v_pk_add_f32 v[110:111], v[110:111], v[16:17]
s_waitcnt vmcnt(2)
v_lshlrev_b32 v10, 16, v252
v_and_b32 v11, 0xffff0000, v252
v_lshlrev_b32 v12, 16, v253
v_and_b32 v13, 0xffff0000, v253
v_lshlrev_b32 v14, 16, v254
v_and_b32 v15, 0xffff0000, v254
v_lshlrev_b32 v16, 16, v255
v_and_b32 v17, 0xffff0000, v255
v_pk_add_f32 v[104:105], v[104:105], v[10:11]
v_pk_add_f32 v[106:107], v[106:107], v[12:13]
v_pk_add_f32 v[108:109], v[108:109], v[14:15]
v_pk_add_f32 v[110:111], v[110:111], v[16:17]
v_cvt_pk_bf16_f32 v104, v104, v105
v_cvt_pk_bf16_f32 v105, v106, v107
v_cvt_pk_bf16_f32 v106, v108, v109
v_cvt_pk_bf16_f32 v107, v110, v111
buffer_store_dwordx2 v[104:105], v21, s[40:43], s25 offen offset:1344
buffer_store_dwordx2 v[106:107], v21, s[40:43], s25 offen offset:1376
s_add_u32 s25, s25, 1835008
s_add_u32 s26, s26, 14457856
s_add_u32 s33, s33, 1024
s_branch M_r1
PAD_18:
s_cbranch_execz M_tret
M_rA:
s_add_u32 s25, s25, 448
s_add_u32 s26, s26, 7168
s_add_u32 s33, s33, 2048
M_r1:
Lp_9203:
buffer_load_dword v18, v19, s[4:7], s33 offen offset:0 sc1
s_waitcnt vmcnt(0)
v_cmp_gt_u32 vcc, 1, v18
s_cbranch_vccz Lpd_9204
s_sleep 8
s_sub_u32 s101, s101, 1
s_cbranch_scc0 Lp_9203
s_mov_b32 s101, 0
Lpd_9204:
buffer_load_dwordx4 v[128:131], v1, s[4:7], s26 offen sc1
s_add_u32 s26, s26, 14336
buffer_load_dwordx4 v[132:135], v1, s[4:7], s26 offen sc1
s_add_u32 s26, s26, 14336
buffer_load_dwordx4 v[136:139], v1, s[4:7], s26 offen sc1
s_add_u32 s26, s26, 14336
buffer_load_dwordx4 v[140:143], v1, s[4:7], s26 offen sc1
s_add_u32 s26, s26, 14336
buffer_load_dwordx4 v[144:147], v1, s[4:7], s26 offen sc1
s_add_u32 s26, s26, 14336
buffer_load_dwordx4 v[148:151], v1, s[4:7], s26 offen sc1
s_add_u32 s26, s26, 14336
buffer_load_dwordx4 v[152:155], v1, s[4:7], s26 offen sc1
s_add_u32 s26, s26, 14336
buffer_load_dwordx4 v[156:159], v1, s[4:7], s26 offen sc1
s_add_u32 s26, s26, 14336
buffer_load_dwordx4 v[160:163], v1, s[4:7], s26 offen sc1
s_add_u32 s26, s26, 14336
buffer_load_dwordx4 v[164:167], v1, s[4:7], s26 offen sc1
s_add_u32 s26, s26, 14336
buffer_load_dwordx4 v[168:171], v1, s[4:7], s26 offen sc1
s_add_u32 s26, s26, 14336
buffer_load_dwordx4 v[172:175], v1, s[4:7], s26 offen sc1
s_add_u32 s26, s26, 14336
buffer_load_dwordx4 v[176:179], v1, s[4:7], s26 offen sc1
s_add_u32 s26, s26, 14336
buffer_load_dwordx4 v[180:183], v1, s[4:7], s26 offen sc1
s_add_u32 s26, s26, 14336
buffer_load_dwordx4 v[184:187], v1, s[4:7], s26 offen sc1
s_add_u32 s26, s26, 14336
buffer_load_dwordx4 v[188:191], v1, s[4:7], s26 offen sc1
s_waitcnt vmcnt(15)
v_lshlrev_b32 v96, 16, v128
v_and_b32 v97, 0xffff0000, v128
v_lshlrev_b32 v98, 16, v129
v_and_b32 v99, 0xffff0000, v129
v_lshlrev_b32 v100, 16, v130
v_and_b32 v101, 0xffff0000, v130
v_lshlrev_b32 v102, 16, v131
v_and_b32 v103, 0xffff0000, v131
s_waitcnt vmcnt(14)
v_lshlrev_b32 v10, 16, v132
v_and_b32 v11, 0xffff0000, v132
v_lshlrev_b32 v12, 16, v133
v_and_b32 v13, 0xffff0000, v133
v_lshlrev_b32 v14, 16, v134
v_and_b32 v15, 0xffff0000, v134
v_lshlrev_b32 v16, 16, v135
v_and_b32 v17, 0xffff0000, v135
v_pk_add_f32 v[96:97], v[96:97], v[10:11]
v_pk_add_f32 v[98:99], v[98:99], v[12:13]
v_pk_add_f32 v[100:101], v[100:101], v[14:15]
v_pk_add_f32 v[102:103], v[102:103], v[16:17]
s_waitcnt vmcnt(13)
v_lshlrev_b32 v10, 16, v136
v_and_b32 v11, 0xffff0000, v136
v_lshlrev_b32 v12, 16, v137
v_and_b32 v13, 0xffff0000, v137
v_lshlrev_b32 v14, 16, v138
v_and_b32 v15, 0xffff0000, v138
v_lshlrev_b32 v16, 16, v139
v_and_b32 v17, 0xffff0000, v139
v_pk_add_f32 v[96:97], v[96:97], v[10:11]
v_pk_add_f32 v[98:99], v[98:99], v[12:13]
v_pk_add_f32 v[100:101], v[100:101], v[14:15]
v_pk_add_f32 v[102:103], v[102:103], v[16:17]
s_waitcnt vmcnt(12)
v_lshlrev_b32 v10, 16, v140
v_and_b32 v11, 0xffff0000, v140
v_lshlrev_b32 v12, 16, v141
v_and_b32 v13, 0xffff0000, v141
v_lshlrev_b32 v14, 16, v142
v_and_b32 v15, 0xffff0000, v142
v_lshlrev_b32 v16, 16, v143
v_and_b32 v17, 0xffff0000, v143
v_pk_add_f32 v[96:97], v[96:97], v[10:11]
v_pk_add_f32 v[98:99], v[98:99], v[12:13]
v_pk_add_f32 v[100:101], v[100:101], v[14:15]
v_pk_add_f32 v[102:103], v[102:103], v[16:17]
s_waitcnt vmcnt(11)
v_lshlrev_b32 v10, 16, v144
v_and_b32 v11, 0xffff0000, v144
v_lshlrev_b32 v12, 16, v145
v_and_b32 v13, 0xffff0000, v145
v_lshlrev_b32 v14, 16, v146
v_and_b32 v15, 0xffff0000, v146
v_lshlrev_b32 v16, 16, v147
v_and_b32 v17, 0xffff0000, v147
v_pk_add_f32 v[96:97], v[96:97], v[10:11]
v_pk_add_f32 v[98:99], v[98:99], v[12:13]
v_pk_add_f32 v[100:101], v[100:101], v[14:15]
v_pk_add_f32 v[102:103], v[102:103], v[16:17]
s_waitcnt vmcnt(10)
v_lshlrev_b32 v10, 16, v148
v_and_b32 v11, 0xffff0000, v148
v_lshlrev_b32 v12, 16, v149
v_and_b32 v13, 0xffff0000, v149
v_lshlrev_b32 v14, 16, v150
v_and_b32 v15, 0xffff0000, v150
v_lshlrev_b32 v16, 16, v151
v_and_b32 v17, 0xffff0000, v151
v_pk_add_f32 v[96:97], v[96:97], v[10:11]
v_pk_add_f32 v[98:99], v[98:99], v[12:13]
v_pk_add_f32 v[100:101], v[100:101], v[14:15]
v_pk_add_f32 v[102:103], v[102:103], v[16:17]
s_waitcnt vmcnt(9)
v_lshlrev_b32 v10, 16, v152
v_and_b32 v11, 0xffff0000, v152
v_lshlrev_b32 v12, 16, v153
v_and_b32 v13, 0xffff0000, v153
v_lshlrev_b32 v14, 16, v154
v_and_b32 v15, 0xffff0000, v154
v_lshlrev_b32 v16, 16, v155
v_and_b32 v17, 0xffff0000, v155
v_pk_add_f32 v[96:97], v[96:97], v[10:11]
v_pk_add_f32 v[98:99], v[98:99], v[12:13]
v_pk_add_f32 v[100:101], v[100:101], v[14:15]
v_pk_add_f32 v[102:103], v[102:103], v[16:17]
s_waitcnt vmcnt(8)
v_lshlrev_b32 v10, 16, v156
v_and_b32 v11, 0xffff0000, v156
v_lshlrev_b32 v12, 16, v157
v_and_b32 v13, 0xffff0000, v157
v_lshlrev_b32 v14, 16, v158
v_and_b32 v15, 0xffff0000, v158
v_lshlrev_b32 v16, 16, v159
v_and_b32 v17, 0xffff0000, v159
v_pk_add_f32 v[96:97], v[96:97], v[10:11]
v_pk_add_f32 v[98:99], v[98:99], v[12:13]
v_pk_add_f32 v[100:101], v[100:101], v[14:15]
v_pk_add_f32 v[102:103], v[102:103], v[16:17]
s_waitcnt vmcnt(7)
v_lshlrev_b32 v10, 16, v160
v_and_b32 v11, 0xffff0000, v160
v_lshlrev_b32 v12, 16, v161
v_and_b32 v13, 0xffff0000, v161
v_lshlrev_b32 v14, 16, v162
v_and_b32 v15, 0xffff0000, v162
v_lshlrev_b32 v16, 16, v163
v_and_b32 v17, 0xffff0000, v163
v_pk_add_f32 v[96:97], v[96:97], v[10:11]
v_pk_add_f32 v[98:99], v[98:99], v[12:13]
v_pk_add_f32 v[100:101], v[100:101], v[14:15]
v_pk_add_f32 v[102:103], v[102:103], v[16:17]
s_waitcnt vmcnt(6)
v_lshlrev_b32 v10, 16, v164
v_and_b32 v11, 0xffff0000, v164
v_lshlrev_b32 v12, 16, v165
v_and_b32 v13, 0xffff0000, v165
v_lshlrev_b32 v14, 16, v166
v_and_b32 v15, 0xffff0000, v166
v_lshlrev_b32 v16, 16, v167
v_and_b32 v17, 0xffff0000, v167
v_pk_add_f32 v[96:97], v[96:97], v[10:11]
v_pk_add_f32 v[98:99], v[98:99], v[12:13]
v_pk_add_f32 v[100:101], v[100:101], v[14:15]
v_pk_add_f32 v[102:103], v[102:103], v[16:17]
s_waitcnt vmcnt(5)
v_lshlrev_b32 v10, 16, v168
v_and_b32 v11, 0xffff0000, v168
v_lshlrev_b32 v12, 16, v169
v_and_b32 v13, 0xffff0000, v169
v_lshlrev_b32 v14, 16, v170
v_and_b32 v15, 0xffff0000, v170
v_lshlrev_b32 v16, 16, v171
v_and_b32 v17, 0xffff0000, v171
v_pk_add_f32 v[96:97], v[96:97], v[10:11]
v_pk_add_f32 v[98:99], v[98:99], v[12:13]
v_pk_add_f32 v[100:101], v[100:101], v[14:15]
v_pk_add_f32 v[102:103], v[102:103], v[16:17]
s_waitcnt vmcnt(4)
v_lshlrev_b32 v10, 16, v172
v_and_b32 v11, 0xffff0000, v172
v_lshlrev_b32 v12, 16, v173
v_and_b32 v13, 0xffff0000, v173
v_lshlrev_b32 v14, 16, v174
v_and_b32 v15, 0xffff0000, v174
v_lshlrev_b32 v16, 16, v175
v_and_b32 v17, 0xffff0000, v175
v_pk_add_f32 v[96:97], v[96:97], v[10:11]
v_pk_add_f32 v[98:99], v[98:99], v[12:13]
v_pk_add_f32 v[100:101], v[100:101], v[14:15]
v_pk_add_f32 v[102:103], v[102:103], v[16:17]
s_waitcnt vmcnt(3)
v_lshlrev_b32 v10, 16, v176
v_and_b32 v11, 0xffff0000, v176
v_lshlrev_b32 v12, 16, v177
v_and_b32 v13, 0xffff0000, v177
v_lshlrev_b32 v14, 16, v178
v_and_b32 v15, 0xffff0000, v178
v_lshlrev_b32 v16, 16, v179
v_and_b32 v17, 0xffff0000, v179
v_pk_add_f32 v[96:97], v[96:97], v[10:11]
v_pk_add_f32 v[98:99], v[98:99], v[12:13]
v_pk_add_f32 v[100:101], v[100:101], v[14:15]
v_pk_add_f32 v[102:103], v[102:103], v[16:17]
s_waitcnt vmcnt(2)
v_lshlrev_b32 v10, 16, v180
v_and_b32 v11, 0xffff0000, v180
v_lshlrev_b32 v12, 16, v181
v_and_b32 v13, 0xffff0000, v181
v_lshlrev_b32 v14, 16, v182
v_and_b32 v15, 0xffff0000, v182
v_lshlrev_b32 v16, 16, v183
v_and_b32 v17, 0xffff0000, v183
v_pk_add_f32 v[96:97], v[96:97], v[10:11]
v_pk_add_f32 v[98:99], v[98:99], v[12:13]
v_pk_add_f32 v[100:101], v[100:101], v[14:15]
v_pk_add_f32 v[102:103], v[102:103], v[16:17]
s_waitcnt vmcnt(1)
v_lshlrev_b32 v10, 16, v184
v_and_b32 v11, 0xffff0000, v184
v_lshlrev_b32 v12, 16, v185
v_and_b32 v13, 0xffff0000, v185
v_lshlrev_b32 v14, 16, v186
v_and_b32 v15, 0xffff0000, v186
v_lshlrev_b32 v16, 16, v187
v_and_b32 v17, 0xffff0000, v187
v_pk_add_f32 v[96:97], v[96:97], v[10:11]
v_pk_add_f32 v[98:99], v[98:99], v[12:13]
v_pk_add_f32 v[100:101], v[100:101], v[14:15]
v_pk_add_f32 v[102:103], v[102:103], v[16:17]
s_waitcnt vmcnt(0)
v_lshlrev_b32 v10, 16, v188
v_and_b32 v11, 0xffff0000, v188
v_lshlrev_b32 v12, 16, v189
v_and_b32 v13, 0xffff0000, v189
v_lshlrev_b32 v14, 16, v190
v_and_b32 v15, 0xffff0000, v190
v_lshlrev_b32 v16, 16, v191
v_and_b32 v17, 0xffff0000, v191
v_pk_add_f32 v[96:97], v[96:97], v[10:11]
v_pk_add_f32 v[98:99], v[98:99], v[12:13]
v_pk_add_f32 v[100:101], v[100:101], v[14:15]
v_pk_add_f32 v[102:103], v[102:103], v[16:17]
v_cvt_pk_bf16_f32 v96, v96, v97
v_cvt_pk_bf16_f32 v97, v98, v99
v_cvt_pk_bf16_f32 v98, v100, v101
v_cvt_pk_bf16_f32 v99, v102, v103
buffer_store_dwordx2 v[96:97], v21, s[40:43], s25 offen offset:896
buffer_store_dwordx2 v[98:99], v21, s[40:43], s25 offen offset:928
M_fin:
s_endpgm
PAD_19:
s_cbranch_execz M_tret
M_final:
s_mov_b32 s8, s64
s_mov_b32 s9, s65
s_mov_b32 s10, 1835008
s_mov_b32 s11, 0x20000
s_mov_b32 s12, s88
s_mov_b32 s13, s89
s_mov_b32 s14, 3670016
s_mov_b32 s15, 0x20000
s_lshr_b32 s24, s2, 0
s_and_b32 s24, s24, 16
s_add_u32 s24, s24, s20
v_lshrrev_b32 v20, 4, v1
v_and_b32 v21, 15, v20
v_lshrrev_b32 v22, 4, v20
v_mul_u32_u24 v2, 896, v21
v_lshlrev_b32 v9, 1, v2
v_lshl_add_u32 v2, v22, 4, v2
v_lshl_add_u32 v9, v22, 4, v9
s_lshl_b32 s22, s24, 2
s_add_u32 s22, s22, s3
s_mul_i32 s25, s22, 14336
s_lshl_b32 s26, s25, 1
v_lshlrev_b32 v10, 5, v22
v_add3_u32 v10, v10, v21, 16
v_lshlrev_b32 v10, 2, v10
v_min_u32 v11, 380, v10
v_add_u32 v11, 512, v11
s_mov_b32 s27, 94384128
Lfp:
buffer_load_dword v3, v10, s[4:7], s27 offen sc1
buffer_load_dword v4, v11, s[4:7], s27 offen sc1
s_waitcnt vmcnt(0)
v_and_b32 v3, v3, v4
v_cmp_gt_u32 vcc, 1, v3
s_cbranch_vccz Lfpd
s_sleep 2
s_sub_u32 s101, s101, 1
s_cbranch_scc0 Lfp
s_mov_b32 s101, 0
Lfpd:
s_barrier
buffer_store_dword v6, v5, s[4:7], s35 offen sc1
Lfg:
v_lshrrev_b32 v3, 3, v20
v_and_b32 v4, 7, v20
v_lshlrev_b32 v4, 4, v4
v_lshl_add_u32 v3, v3, 12, v4
s_mul_i32 s27, s3, 458752
s_lshl_b32 s22, s24, 7
s_add_u32 s27, s27, s22
s_add_u32 s27, s27, 88080384
s_mul_i32 s28, s3, 14336
s_add_u32 m0, s28, 0
s_nop 0
buffer_load_dwordx4 v3, s[4:7], s27 offen sc1 lds
s_add_u32 s27, s27, 32768
s_add_u32 m0, s28, 1024
s_nop 0
buffer_load_dwordx4 v3, s[4:7], s27 offen sc1 lds
s_add_u32 s27, s27, 32768
s_add_u32 m0, s28, 2048
s_nop 0
buffer_load_dwordx4 v3, s[4:7], s27 offen sc1 lds
s_add_u32 s27, s27, 32768
s_add_u32 m0, s28, 3072
s_nop 0
buffer_load_dwordx4 v3, s[4:7], s27 offen sc1 lds
s_add_u32 s27, s27, 32768
s_add_u32 m0, s28, 4096
s_nop 0
buffer_load_dwordx4 v3, s[4:7], s27 offen sc1 lds
s_add_u32 s27, s27, 32768
s_add_u32 m0, s28, 5120
s_nop 0
buffer_load_dwordx4 v3, s[4:7], s27 offen sc1 lds
s_add_u32 s27, s27, 32768
s_add_u32 m0, s28, 6144
s_nop 0
buffer_load_dwordx4 v3, s[4:7], s27 offen sc1 lds
s_add_u32 s27, s27, 32768
s_add_u32 m0, s28, 7168
s_nop 0
buffer_load_dwordx4 v3, s[4:7], s27 offen sc1 lds
s_add_u32 s27, s27, 32768
s_add_u32 m0, s28, 8192
s_nop 0
buffer_load_dwordx4 v3, s[4:7], s27 offen sc1 lds
s_add_u32 s27, s27, 32768
s_add_u32 m0, s28, 9216
s_nop 0
buffer_load_dwordx4 v3, s[4:7], s27 offen sc1 lds
s_add_u32 s27, s27, 32768
s_add_u32 m0, s28, 10240
s_nop 0
buffer_load_dwordx4 v3, s[4:7], s27 offen sc1 lds
s_add_u32 s27, s27, 32768
s_add_u32 m0, s28, 11264
s_nop 0
buffer_load_dwordx4 v3, s[4:7], s27 offen sc1 lds
s_add_u32 s27, s27, 32768
s_add_u32 m0, s28, 12288
s_nop 0
buffer_load_dwordx4 v3, s[4:7], s27 offen sc1 lds
s_add_u32 s27, s27, 32768
s_add_u32 m0, s28, 13312
s_nop 0
buffer_load_dwordx4 v3, s[4:7], s27 offen sc1 lds
s_add_u32 s27, s27, 32768
buffer_load_dwordx4 v[160:163], v2, s[8:11], s25 offen offset:0
buffer_load_dwordx4 v[164:167], v2, s[8:11], s25 offen offset:64
buffer_load_dwordx4 v[168:171], v2, s[8:11], s25 offen offset:128
buffer_load_dwordx4 v[172:175], v2, s[8:11], s25 offen offset:192
buffer_load_dwordx4 v[176:179], v2, s[8:11], s25 offen offset:256
buffer_load_dwordx4 v[180:183], v2, s[8:11], s25 offen offset:320
buffer_load_dwordx4 v[184:187], v2, s[8:11], s25 offen offset:384
buffer_load_dwordx4 v[188:191], v2, s[8:11], s25 offen offset:448
buffer_load_dwordx4 v[192:195], v2, s[8:11], s25 offen offset:512
buffer_load_dwordx4 v[196:199], v2, s[8:11], s25 offen offset:576
buffer_load_dwordx4 v[200:203], v2, s[8:11], s25 offen offset:640
buffer_load_dwordx4 v[204:207], v2, s[8:11], s25 offen offset:704
buffer_load_dwordx4 v[208:211], v2, s[8:11], s25 offen offset:768
buffer_load_dwordx4 v[212:215], v2, s[8:11], s25 offen offset:832
v_lshrrev_b32 v3, 2, v21
v_lshl_add_u32 v3, v22, 3, v3
v_lshlrev_b32 v3, 7, v3
v_and_b32 v4, 3, v20
v_lshl_add_u32 v3, v4, 3, v3
s_lshl_b32 s22, s3, 5
v_add_u32 v3, s22, v3
s_waitcnt vmcnt(14)
s_barrier
ds_read_b64_tr_b16 v[96:97], v3 offset:0
ds_read_b64_tr_b16 v[98:99], v3 offset:512
ds_read_b64_tr_b16 v[100:101], v3 offset:4096
ds_read_b64_tr_b16 v[102:103], v3 offset:4608
ds_read_b64_tr_b16 v[104:105], v3 offset:8192
ds_read_b64_tr_b16 v[106:107], v3 offset:8704
ds_read_b64_tr_b16 v[108:109], v3 offset:12288
ds_read_b64_tr_b16 v[110:111], v3 offset:12800
ds_read_b64_tr_b16 v[112:113], v3 offset:16384
ds_read_b64_tr_b16 v[114:115], v3 offset:16896
ds_read_b64_tr_b16 v[116:117], v3 offset:20480
ds_read_b64_tr_b16 v[118:119], v3 offset:20992
ds_read_b64_tr_b16 v[120:121], v3 offset:24576
ds_read_b64_tr_b16 v[122:123], v3 offset:25088
s_waitcnt lgkmcnt(0)
ds_read_b64_tr_b16 v[124:125], v3 offset:28672
ds_read_b64_tr_b16 v[126:127], v3 offset:29184
ds_read_b64_tr_b16 v[128:129], v3 offset:32768
ds_read_b64_tr_b16 v[130:131], v3 offset:33280
ds_read_b64_tr_b16 v[132:133], v3 offset:36864
ds_read_b64_tr_b16 v[134:135], v3 offset:37376
ds_read_b64_tr_b16 v[136:137], v3 offset:40960
ds_read_b64_tr_b16 v[138:139], v3 offset:41472
ds_read_b64_tr_b16 v[140:141], v3 offset:45056
ds_read_b64_tr_b16 v[142:143], v3 offset:45568
ds_read_b64_tr_b16 v[144:145], v3 offset:49152
ds_read_b64_tr_b16 v[146:147], v3 offset:49664
ds_read_b64_tr_b16 v[148:149], v3 offset:53248
ds_read_b64_tr_b16 v[150:151], v3 offset:53760
s_waitcnt vmcnt(13)
v_lshlrev_b32 v10, 16, v160
v_and_b32 v11, 0xffff0000, v160
v_lshlrev_b32 v12, 16, v96
v_and_b32 v13, 0xffff0000, v96
v_pk_mul_f32 v[10:11], v[10:11], v[12:13]
v_cvt_pk_bf16_f32 v160, v10, v11
v_lshlrev_b32 v10, 16, v161
v_and_b32 v11, 0xffff0000, v161
v_lshlrev_b32 v12, 16, v97
v_and_b32 v13, 0xffff0000, v97
v_pk_mul_f32 v[10:11], v[10:11], v[12:13]
v_cvt_pk_bf16_f32 v161, v10, v11
v_lshlrev_b32 v10, 16, v162
v_and_b32 v11, 0xffff0000, v162
v_lshlrev_b32 v12, 16, v98
v_and_b32 v13, 0xffff0000, v98
v_pk_mul_f32 v[10:11], v[10:11], v[12:13]
v_cvt_pk_bf16_f32 v162, v10, v11
v_lshlrev_b32 v10, 16, v163
v_and_b32 v11, 0xffff0000, v163
v_lshlrev_b32 v12, 16, v99
v_and_b32 v13, 0xffff0000, v99
v_pk_mul_f32 v[10:11], v[10:11], v[12:13]
v_cvt_pk_bf16_f32 v163, v10, v11
buffer_store_dwordx4 v[160:163], v9, s[12:15], s26 offen offset:0
s_waitcnt vmcnt(13)
v_lshlrev_b32 v10, 16, v164
v_and_b32 v11, 0xffff0000, v164
v_lshlrev_b32 v12, 16, v100
v_and_b32 v13, 0xffff0000, v100
v_pk_mul_f32 v[10:11], v[10:11], v[12:13]
v_cvt_pk_bf16_f32 v164, v10, v11
v_lshlrev_b32 v10, 16, v165
v_and_b32 v11, 0xffff0000, v165
v_lshlrev_b32 v12, 16, v101
v_and_b32 v13, 0xffff0000, v101
v_pk_mul_f32 v[10:11], v[10:11], v[12:13]
v_cvt_pk_bf16_f32 v165, v10, v11
v_lshlrev_b32 v10, 16, v166
v_and_b32 v11, 0xffff0000, v166
v_lshlrev_b32 v12, 16, v102
v_and_b32 v13, 0xffff0000, v102
v_pk_mul_f32 v[10:11], v[10:11], v[12:13]
v_cvt_pk_bf16_f32 v166, v10, v11
v_lshlrev_b32 v10, 16, v167
v_and_b32 v11, 0xffff0000, v167
v_lshlrev_b32 v12, 16, v103
v_and_b32 v13, 0xffff0000, v103
v_pk_mul_f32 v[10:11], v[10:11], v[12:13]
v_cvt_pk_bf16_f32 v167, v10, v11
buffer_store_dwordx4 v[164:167], v9, s[12:15], s26 offen offset:64
s_waitcnt vmcnt(13)
v_lshlrev_b32 v10, 16, v168
v_and_b32 v11, 0xffff0000, v168
v_lshlrev_b32 v12, 16, v104
v_and_b32 v13, 0xffff0000, v104
v_pk_mul_f32 v[10:11], v[10:11], v[12:13]
v_cvt_pk_bf16_f32 v168, v10, v11
v_lshlrev_b32 v10, 16, v169
PAD_20:
s_cbranch_execz M_tret
v_and_b32 v11, 0xffff0000, v169
v_lshlrev_b32 v12, 16, v105
v_and_b32 v13, 0xffff0000, v105
v_pk_mul_f32 v[10:11], v[10:11], v[12:13]
v_cvt_pk_bf16_f32 v169, v10, v11
v_lshlrev_b32 v10, 16, v170
v_and_b32 v11, 0xffff0000, v170
v_lshlrev_b32 v12, 16, v106
v_and_b32 v13, 0xffff0000, v106
v_pk_mul_f32 v[10:11], v[10:11], v[12:13]
v_cvt_pk_bf16_f32 v170, v10, v11
v_lshlrev_b32 v10, 16, v171
v_and_b32 v11, 0xffff0000, v171
v_lshlrev_b32 v12, 16, v107
v_and_b32 v13, 0xffff0000, v107
v_pk_mul_f32 v[10:11], v[10:11], v[12:13]
v_cvt_pk_bf16_f32 v171, v10, v11
buffer_store_dwordx4 v[168:171], v9, s[12:15], s26 offen offset:128
s_waitcnt vmcnt(13)
v_lshlrev_b32 v10, 16, v172
v_and_b32 v11, 0xffff0000, v172
v_lshlrev_b32 v12, 16, v108
v_and_b32 v13, 0xffff0000, v108
v_pk_mul_f32 v[10:11], v[10:11], v[12:13]
v_cvt_pk_bf16_f32 v172, v10, v11
v_lshlrev_b32 v10, 16, v173
v_and_b32 v11, 0xffff0000, v173
v_lshlrev_b32 v12, 16, v109
v_and_b32 v13, 0xffff0000, v109
v_pk_mul_f32 v[10:11], v[10:11], v[12:13]
v_cvt_pk_bf16_f32 v173, v10, v11
v_lshlrev_b32 v10, 16, v174
v_and_b32 v11, 0xffff0000, v174
v_lshlrev_b32 v12, 16, v110
v_and_b32 v13, 0xffff0000, v110
v_pk_mul_f32 v[10:11], v[10:11], v[12:13]
v_cvt_pk_bf16_f32 v174, v10, v11
v_lshlrev_b32 v10, 16, v175
v_and_b32 v11, 0xffff0000, v175
v_lshlrev_b32 v12, 16, v111
v_and_b32 v13, 0xffff0000, v111
v_pk_mul_f32 v[10:11], v[10:11], v[12:13]
v_cvt_pk_bf16_f32 v175, v10, v11
buffer_store_dwordx4 v[172:175], v9, s[12:15], s26 offen offset:192
s_waitcnt vmcnt(13)
v_lshlrev_b32 v10, 16, v176
v_and_b32 v11, 0xffff0000, v176
v_lshlrev_b32 v12, 16, v112
v_and_b32 v13, 0xffff0000, v112
v_pk_mul_f32 v[10:11], v[10:11], v[12:13]
v_cvt_pk_bf16_f32 v176, v10, v11
v_lshlrev_b32 v10, 16, v177
v_and_b32 v11, 0xffff0000, v177
v_lshlrev_b32 v12, 16, v113
v_and_b32 v13, 0xffff0000, v113
v_pk_mul_f32 v[10:11], v[10:11], v[12:13]
v_cvt_pk_bf16_f32 v177, v10, v11
v_lshlrev_b32 v10, 16, v178
v_and_b32 v11, 0xffff0000, v178
v_lshlrev_b32 v12, 16, v114
v_and_b32 v13, 0xffff0000, v114
v_pk_mul_f32 v[10:11], v[10:11], v[12:13]
v_cvt_pk_bf16_f32 v178, v10, v11
v_lshlrev_b32 v10, 16, v179
v_and_b32 v11, 0xffff0000, v179
v_lshlrev_b32 v12, 16, v115
v_and_b32 v13, 0xffff0000, v115
v_pk_mul_f32 v[10:11], v[10:11], v[12:13]
v_cvt_pk_bf16_f32 v179, v10, v11
buffer_store_dwordx4 v[176:179], v9, s[12:15], s26 offen offset:256
s_waitcnt vmcnt(13)
v_lshlrev_b32 v10, 16, v180
v_and_b32 v11, 0xffff0000, v180
v_lshlrev_b32 v12, 16, v116
v_and_b32 v13, 0xffff0000, v116
v_pk_mul_f32 v[10:11], v[10:11], v[12:13]
v_cvt_pk_bf16_f32 v180, v10, v11
v_lshlrev_b32 v10, 16, v181
v_and_b32 v11, 0xffff0000, v181
v_lshlrev_b32 v12, 16, v117
v_and_b32 v13, 0xffff0000, v117
v_pk_mul_f32 v[10:11], v[10:11], v[12:13]
v_cvt_pk_bf16_f32 v181, v10, v11
v_lshlrev_b32 v10, 16, v182
v_and_b32 v11, 0xffff0000, v182
v_lshlrev_b32 v12, 16, v118
v_and_b32 v13, 0xffff0000, v118
v_pk_mul_f32 v[10:11], v[10:11], v[12:13]
v_cvt_pk_bf16_f32 v182, v10, v11
v_lshlrev_b32 v10, 16, v183
v_and_b32 v11, 0xffff0000, v183
v_lshlrev_b32 v12, 16, v119
v_and_b32 v13, 0xffff0000, v119
v_pk_mul_f32 v[10:11], v[10:11], v[12:13]
v_cvt_pk_bf16_f32 v183, v10, v11
buffer_store_dwordx4 v[180:183], v9, s[12:15], s26 offen offset:320
s_waitcnt vmcnt(13)
v_lshlrev_b32 v10, 16, v184
v_and_b32 v11, 0xffff0000, v184
v_lshlrev_b32 v12, 16, v120
v_and_b32 v13, 0xffff0000, v120
v_pk_mul_f32 v[10:11], v[10:11], v[12:13]
v_cvt_pk_bf16_f32 v184, v10, v11
v_lshlrev_b32 v10, 16, v185
v_and_b32 v11, 0xffff0000, v185
v_lshlrev_b32 v12, 16, v121
v_and_b32 v13, 0xffff0000, v121
v_pk_mul_f32 v[10:11], v[10:11], v[12:13]
v_cvt_pk_bf16_f32 v185, v10, v11
v_lshlrev_b32 v10, 16, v186
v_and_b32 v11, 0xffff0000, v186
v_lshlrev_b32 v12, 16, v122
v_and_b32 v13, 0xffff0000, v122
v_pk_mul_f32 v[10:11], v[10:11], v[12:13]
v_cvt_pk_bf16_f32 v186, v10, v11
v_lshlrev_b32 v10, 16, v187
v_and_b32 v11, 0xffff0000, v187
v_lshlrev_b32 v12, 16, v123
v_and_b32 v13, 0xffff0000, v123
v_pk_mul_f32 v[10:11], v[10:11], v[12:13]
v_cvt_pk_bf16_f32 v187, v10, v11
buffer_store_dwordx4 v[184:187], v9, s[12:15], s26 offen offset:384
s_waitcnt lgkmcnt(0)
s_waitcnt vmcnt(13)
v_lshlrev_b32 v10, 16, v188
v_and_b32 v11, 0xffff0000, v188
v_lshlrev_b32 v12, 16, v124
v_and_b32 v13, 0xffff0000, v124
v_pk_mul_f32 v[10:11], v[10:11], v[12:13]
v_cvt_pk_bf16_f32 v188, v10, v11
v_lshlrev_b32 v10, 16, v189
v_and_b32 v11, 0xffff0000, v189
v_lshlrev_b32 v12, 16, v125
v_and_b32 v13, 0xffff0000, v125
v_pk_mul_f32 v[10:11], v[10:11], v[12:13]
v_cvt_pk_bf16_f32 v189, v10, v11
v_lshlrev_b32 v10, 16, v190
v_and_b32 v11, 0xffff0000, v190
v_lshlrev_b32 v12, 16, v126
v_and_b32 v13, 0xffff0000, v126
v_pk_mul_f32 v[10:11], v[10:11], v[12:13]
v_cvt_pk_bf16_f32 v190, v10, v11
v_lshlrev_b32 v10, 16, v191
v_and_b32 v11, 0xffff0000, v191
v_lshlrev_b32 v12, 16, v127
v_and_b32 v13, 0xffff0000, v127
v_pk_mul_f32 v[10:11], v[10:11], v[12:13]
v_cvt_pk_bf16_f32 v191, v10, v11
buffer_store_dwordx4 v[188:191], v9, s[12:15], s26 offen offset:448
s_waitcnt vmcnt(13)
v_lshlrev_b32 v10, 16, v192
v_and_b32 v11, 0xffff0000, v192
v_lshlrev_b32 v12, 16, v128
v_and_b32 v13, 0xffff0000, v128
v_pk_mul_f32 v[10:11], v[10:11], v[12:13]
v_cvt_pk_bf16_f32 v192, v10, v11
v_lshlrev_b32 v10, 16, v193
v_and_b32 v11, 0xffff0000, v193
v_lshlrev_b32 v12, 16, v129
v_and_b32 v13, 0xffff0000, v129
v_pk_mul_f32 v[10:11], v[10:11], v[12:13]
v_cvt_pk_bf16_f32 v193, v10, v11
v_lshlrev_b32 v10, 16, v194
v_and_b32 v11, 0xffff0000, v194
v_lshlrev_b32 v12, 16, v130
v_and_b32 v13, 0xffff0000, v130
v_pk_mul_f32 v[10:11], v[10:11], v[12:13]
v_cvt_pk_bf16_f32 v194, v10, v11
v_lshlrev_b32 v10, 16, v195
v_and_b32 v11, 0xffff0000, v195
v_lshlrev_b32 v12, 16, v131
v_and_b32 v13, 0xffff0000, v131
v_pk_mul_f32 v[10:11], v[10:11], v[12:13]
v_cvt_pk_bf16_f32 v195, v10, v11
buffer_store_dwordx4 v[192:195], v9, s[12:15], s26 offen offset:512
s_waitcnt vmcnt(13)
v_lshlrev_b32 v10, 16, v196
v_and_b32 v11, 0xffff0000, v196
v_lshlrev_b32 v12, 16, v132
v_and_b32 v13, 0xffff0000, v132
v_pk_mul_f32 v[10:11], v[10:11], v[12:13]
v_cvt_pk_bf16_f32 v196, v10, v11
v_lshlrev_b32 v10, 16, v197
v_and_b32 v11, 0xffff0000, v197
v_lshlrev_b32 v12, 16, v133
v_and_b32 v13, 0xffff0000, v133
v_pk_mul_f32 v[10:11], v[10:11], v[12:13]
v_cvt_pk_bf16_f32 v197, v10, v11
v_lshlrev_b32 v10, 16, v198
v_and_b32 v11, 0xffff0000, v198
v_lshlrev_b32 v12, 16, v134
v_and_b32 v13, 0xffff0000, v134
v_pk_mul_f32 v[10:11], v[10:11], v[12:13]
v_cvt_pk_bf16_f32 v198, v10, v11
v_lshlrev_b32 v10, 16, v199
v_and_b32 v11, 0xffff0000, v199
v_lshlrev_b32 v12, 16, v135
v_and_b32 v13, 0xffff0000, v135
v_pk_mul_f32 v[10:11], v[10:11], v[12:13]
v_cvt_pk_bf16_f32 v199, v10, v11
buffer_store_dwordx4 v[196:199], v9, s[12:15], s26 offen offset:576
s_waitcnt vmcnt(13)
v_lshlrev_b32 v10, 16, v200
v_and_b32 v11, 0xffff0000, v200
v_lshlrev_b32 v12, 16, v136
v_and_b32 v13, 0xffff0000, v136
v_pk_mul_f32 v[10:11], v[10:11], v[12:13]
v_cvt_pk_bf16_f32 v200, v10, v11
v_lshlrev_b32 v10, 16, v201
v_and_b32 v11, 0xffff0000, v201
v_lshlrev_b32 v12, 16, v137
v_and_b32 v13, 0xffff0000, v137
v_pk_mul_f32 v[10:11], v[10:11], v[12:13]
v_cvt_pk_bf16_f32 v201, v10, v11
v_lshlrev_b32 v10, 16, v202
v_and_b32 v11, 0xffff0000, v202
v_lshlrev_b32 v12, 16, v138
v_and_b32 v13, 0xffff0000, v138
v_pk_mul_f32 v[10:11], v[10:11], v[12:13]
v_cvt_pk_bf16_f32 v202, v10, v11
v_lshlrev_b32 v10, 16, v203
v_and_b32 v11, 0xffff0000, v203
v_lshlrev_b32 v12, 16, v139
v_and_b32 v13, 0xffff0000, v139
v_pk_mul_f32 v[10:11], v[10:11], v[12:13]
v_cvt_pk_bf16_f32 v203, v10, v11
buffer_store_dwordx4 v[200:203], v9, s[12:15], s26 offen offset:640
s_waitcnt vmcnt(13)
v_lshlrev_b32 v10, 16, v204
v_and_b32 v11, 0xffff0000, v204
v_lshlrev_b32 v12, 16, v140
v_and_b32 v13, 0xffff0000, v140
v_pk_mul_f32 v[10:11], v[10:11], v[12:13]
v_cvt_pk_bf16_f32 v204, v10, v11
v_lshlrev_b32 v10, 16, v205
v_and_b32 v11, 0xffff0000, v205
v_lshlrev_b32 v12, 16, v141
v_and_b32 v13, 0xffff0000, v141
v_pk_mul_f32 v[10:11], v[10:11], v[12:13]
v_cvt_pk_bf16_f32 v205, v10, v11
v_lshlrev_b32 v10, 16, v206
v_and_b32 v11, 0xffff0000, v206
v_lshlrev_b32 v12, 16, v142
v_and_b32 v13, 0xffff0000, v142
v_pk_mul_f32 v[10:11], v[10:11], v[12:13]
v_cvt_pk_bf16_f32 v206, v10, v11
v_lshlrev_b32 v10, 16, v207
v_and_b32 v11, 0xffff0000, v207
v_lshlrev_b32 v12, 16, v143
v_and_b32 v13, 0xffff0000, v143
v_pk_mul_f32 v[10:11], v[10:11], v[12:13]
v_cvt_pk_bf16_f32 v207, v10, v11
buffer_store_dwordx4 v[204:207], v9, s[12:15], s26 offen offset:704
s_waitcnt vmcnt(13)
v_lshlrev_b32 v10, 16, v208
v_and_b32 v11, 0xffff0000, v208
v_lshlrev_b32 v12, 16, v144
v_and_b32 v13, 0xffff0000, v144
v_pk_mul_f32 v[10:11], v[10:11], v[12:13]
v_cvt_pk_bf16_f32 v208, v10, v11
v_lshlrev_b32 v10, 16, v209
v_and_b32 v11, 0xffff0000, v209
v_lshlrev_b32 v12, 16, v145
v_and_b32 v13, 0xffff0000, v145
v_pk_mul_f32 v[10:11], v[10:11], v[12:13]
v_cvt_pk_bf16_f32 v209, v10, v11
v_lshlrev_b32 v10, 16, v210
v_and_b32 v11, 0xffff0000, v210
v_lshlrev_b32 v12, 16, v146
v_and_b32 v13, 0xffff0000, v146
v_pk_mul_f32 v[10:11], v[10:11], v[12:13]
v_cvt_pk_bf16_f32 v210, v10, v11
v_lshlrev_b32 v10, 16, v211
v_and_b32 v11, 0xffff0000, v211
v_lshlrev_b32 v12, 16, v147
v_and_b32 v13, 0xffff0000, v147
v_pk_mul_f32 v[10:11], v[10:11], v[12:13]
v_cvt_pk_bf16_f32 v211, v10, v11
buffer_store_dwordx4 v[208:211], v9, s[12:15], s26 offen offset:768
s_waitcnt vmcnt(13)
v_lshlrev_b32 v10, 16, v212
v_and_b32 v11, 0xffff0000, v212
v_lshlrev_b32 v12, 16, v148
v_and_b32 v13, 0xffff0000, v148
v_pk_mul_f32 v[10:11], v[10:11], v[12:13]
v_cvt_pk_bf16_f32 v212, v10, v11
v_lshlrev_b32 v10, 16, v213
v_and_b32 v11, 0xffff0000, v213
v_lshlrev_b32 v12, 16, v149
v_and_b32 v13, 0xffff0000, v149
v_pk_mul_f32 v[10:11], v[10:11], v[12:13]
v_cvt_pk_bf16_f32 v213, v10, v11
v_lshlrev_b32 v10, 16, v214
v_and_b32 v11, 0xffff0000, v214
v_lshlrev_b32 v12, 16, v150
v_and_b32 v13, 0xffff0000, v150
v_pk_mul_f32 v[10:11], v[10:11], v[12:13]
v_cvt_pk_bf16_f32 v214, v10, v11
v_lshlrev_b32 v10, 16, v215
v_and_b32 v11, 0xffff0000, v215
v_lshlrev_b32 v12, 16, v151
v_and_b32 v13, 0xffff0000, v151
v_pk_mul_f32 v[10:11], v[10:11], v[12:13]
v_cvt_pk_bf16_f32 v215, v10, v11
buffer_store_dwordx4 v[212:215], v9, s[12:15], s26 offen offset:832
s_branch M_fin
M_fend:
M_rslow:
Lp_9251:
buffer_load_dword v18, v19, s[4:7], s33 offen offset:0 sc1
s_waitcnt vmcnt(0)
v_cmp_gt_u32 vcc, 1, v18
s_cbranch_vccz Lpd_9252
s_sleep 8
s_sub_u32 s101, s101, 1
s_cbranch_scc0 Lp_9251
s_mov_b32 s101, 0
Lpd_9252:
s_branch M_rjoin
PAD_21:
s_cbranch_execz PAD_25
M_V:
v_mfma_f32_16x16x32_bf16 v[32:35], a[0:3], a[128:131], 0
s_add_u32 m0, s29, 98304
ds_read_b64_tr_b16 a[136:137], v5 offset:0
v_mfma_f32_16x16x32_bf16 v[32:35], a[4:7], a[132:135], v[32:35]
s_mov_b32 s32, 1024
buffer_load_dwordx4 v16, s[12:15], s26 offen offset:0 lds
v_mfma_f32_16x16x32_bf16 v[36:39], a[8:11], a[128:131], 0
s_mov_b32 s33, 31744
ds_read_b64_tr_b16 a[138:139], v5 offset:2048
v_mfma_f32_16x16x32_bf16 v[36:39], a[12:15], a[132:135], v[36:39]
s_mov_b32 s34, 4294935552
v_mfma_f32_16x16x32_bf16 v[40:43], a[16:19], a[128:131], 0
s_mov_b32 s35, 4294935552
ds_read_b64_tr_b16 a[140:141], v5 offset:16384
v_mfma_f32_16x16x32_bf16 v[40:43], a[20:23], a[132:135], v[40:43]
s_mov_b32 s36, 4294935552
buffer_load_dwordx4 v17, s[12:15], s26 offen offset:1024 lds
v_mfma_f32_16x16x32_bf16 v[44:47], a[24:27], a[128:131], 0
s_mov_b32 s30, 8
ds_read_b64_tr_b16 a[142:143], v5 offset:18432
v_mfma_f32_16x16x32_bf16 v[44:47], a[28:31], a[132:135], v[44:47]
s_mov_b32 s82, 3221225472
v_mfma_f32_16x16x32_bf16 v[48:51], a[32:35], a[128:131], 0
s_mul_hi_u32 s38, s2, 613566757
v_mfma_f32_16x16x32_bf16 v[48:51], a[36:39], a[132:135], v[48:51]
s_mul_i32 s39, s38, 7
buffer_load_dwordx4 v18, s[12:15], s26 offen offset:2048 lds
v_mfma_f32_16x16x32_bf16 v[52:55], a[40:43], a[128:131], 0
s_sub_u32 s39, s2, s39
v_mov_b32 v246, 0
v_mov_b32 v229, 0
v_mfma_f32_16x16x32_bf16 v[52:55], a[44:47], a[132:135], v[52:55]
v_mov_b32 v231, 0
v_mfma_f32_16x16x32_bf16 v[56:59], a[48:51], a[128:131], 0
s_mov_b32 s60, s90
v_mfma_f32_16x16x32_bf16 v[56:59], a[52:55], a[132:135], v[56:59]
s_mov_b32 s61, s91
buffer_load_dwordx4 v19, s[12:15], s26 offen offset:3072 lds
v_mfma_f32_16x16x32_bf16 v[60:63], a[56:59], a[128:131], 0
s_add_u32 s26, s26, 524288
v_mfma_f32_16x16x32_bf16 v[60:63], a[60:63], a[132:135], v[60:63]
s_waitcnt lgkmcnt(0)
s_mov_b32 s62, 256
v_mfma_f32_16x16x32_bf16 v[64:67], a[0:3], a[136:139], 0
s_add_u32 m0, s29, 114688
ds_read_b64_tr_b16 a[128:129], v6 offset:0
v_mfma_f32_16x16x32_bf16 v[64:67], a[4:7], a[140:143], v[64:67]
s_mov_b32 s63, 0x20000
buffer_load_dwordx4 v16, s[12:15], s27 offen offset:0 lds
v_mfma_f32_16x16x32_bf16 v[68:71], a[8:11], a[136:139], 0
s_mul_hi_u32 s55, s2, 1431655766
ds_read_b64_tr_b16 a[130:131], v6 offset:2048
v_mfma_f32_16x16x32_bf16 v[68:71], a[12:15], a[140:143], v[68:71]
s_mul_i32 s55, s55, 3
v_mfma_f32_16x16x32_bf16 v[72:75], a[16:19], a[136:139], 0
s_sub_u32 s55, s2, s55
ds_read_b64_tr_b16 a[132:133], v6 offset:16384
v_mfma_f32_16x16x32_bf16 v[72:75], a[20:23], a[140:143], v[72:75]
s_add_u32 s55, s55, 5
buffer_load_dwordx4 v17, s[12:15], s27 offen offset:1024 lds
v_mfma_f32_16x16x32_bf16 v[76:79], a[24:27], a[136:139], 0
s_lshr_b32 s22, s2, 4
ds_read_b64_tr_b16 a[134:135], v6 offset:18432
v_mfma_f32_16x16x32_bf16 v[76:79], a[28:31], a[140:143], v[76:79]
s_lshl_b32 s23, s20, 5
v_mfma_f32_16x16x32_bf16 v[80:83], a[32:35], a[136:139], 0
s_add_u32 s23, s23, s22
v_mfma_f32_16x16x32_bf16 v[80:83], a[36:39], a[140:143], v[80:83]
s_lshl_b32 s23, s23, 2
buffer_load_dwordx4 v18, s[12:15], s27 offen offset:2048 lds
v_mfma_f32_16x16x32_bf16 v[84:87], a[40:43], a[136:139], 0
s_and_b32 s22, s2, 16
v_mfma_f32_16x16x32_bf16 v[84:87], a[44:47], a[140:143], v[84:87]
s_lshl_b32 s22, s22, 7
v_mfma_f32_16x16x32_bf16 v[88:91], a[48:51], a[136:139], 0
s_add_u32 s23, s23, s22
v_mov_b32 v28, 3221225472
v_writelane_b32 v28, s23, 0
v_mfma_f32_16x16x32_bf16 v[88:91], a[52:55], a[140:143], v[88:91]
s_add_u32 s56, s23, 16384
buffer_load_dwordx4 v19, s[12:15], s27 offen offset:3072 lds
v_mfma_f32_16x16x32_bf16 v[92:95], a[56:59], a[136:139], 0
s_add_u32 s27, s27, 524288
v_writelane_b32 v28, s56, 1
v_mfma_f32_16x16x32_bf16 v[92:95], a[60:63], a[140:143], v[92:95]
s_waitcnt lgkmcnt(0)
s_add_u32 s56, s23, 4096
v_writelane_b32 v28, s56, 2
v_mfma_f32_16x16x32_bf16 v[96:99], a[0:3], a[128:131], 0
s_add_u32 m0, s28, 0
ds_read_b64_tr_b16 a[136:137], v7 offset:0
v_mfma_f32_16x16x32_bf16 v[96:99], a[4:7], a[132:135], v[96:99]
s_sub_u32 s37, 15, s21
buffer_load_dwordx4 v12, s[8:11], s24 offen offset:0 lds
v_mfma_f32_16x16x32_bf16 v[100:103], a[8:11], a[128:131], 0
ds_read_b64_tr_b16 a[138:139], v7 offset:2048
v_mfma_f32_16x16x32_bf16 v[100:103], a[12:15], a[132:135], v[100:103]
v_mfma_f32_16x16x32_bf16 v[104:107], a[16:19], a[128:131], 0
ds_read_b64_tr_b16 a[140:141], v7 offset:16384
v_mfma_f32_16x16x32_bf16 v[104:107], a[20:23], a[132:135], v[104:107]
buffer_load_dwordx4 v13, s[8:11], s24 offen offset:1024 lds
v_mfma_f32_16x16x32_bf16 v[108:111], a[24:27], a[128:131], 0
ds_read_b64_tr_b16 a[142:143], v7 offset:18432
v_mfma_f32_16x16x32_bf16 v[108:111], a[28:31], a[132:135], v[108:111]
v_mfma_f32_16x16x32_bf16 v[112:115], a[32:35], a[128:131], 0
v_mfma_f32_16x16x32_bf16 v[112:115], a[36:39], a[132:135], v[112:115]
buffer_load_dwordx4 v14, s[8:11], s24 offen offset:2048 lds
v_mfma_f32_16x16x32_bf16 v[116:119], a[40:43], a[128:131], 0
v_mfma_f32_16x16x32_bf16 v[116:119], a[44:47], a[132:135], v[116:119]
v_mfma_f32_16x16x32_bf16 v[120:123], a[48:51], a[128:131], 0
v_mfma_f32_16x16x32_bf16 v[120:123], a[52:55], a[132:135], v[120:123]
buffer_load_dwordx4 v15, s[8:11], s24 offen offset:3072 lds
v_mfma_f32_16x16x32_bf16 v[124:127], a[56:59], a[128:131], 0
s_add_u32 s24, s24, 128
v_mfma_f32_16x16x32_bf16 v[124:127], a[60:63], a[132:135], v[124:127]
s_waitcnt vmcnt(12) lgkmcnt(0)
s_barrier
v_mfma_f32_16x16x32_bf16 v[128:131], a[0:3], a[136:139], 0
s_add_u32 m0, s28, 4096
ds_read_b64_tr_b16 a[128:129], v8 offset:0
v_mfma_f32_16x16x32_bf16 v[128:131], a[4:7], a[140:143], v[128:131]
buffer_load_dwordx4 v12, s[8:11], s25 offen offset:0 lds
v_mfma_f32_16x16x32_bf16 v[132:135], a[8:11], a[136:139], 0
ds_read_b64_tr_b16 a[130:131], v8 offset:2048
v_mfma_f32_16x16x32_bf16 v[132:135], a[12:15], a[140:143], v[132:135]
v_mfma_f32_16x16x32_bf16 v[136:139], a[16:19], a[136:139], 0
ds_read_b64_tr_b16 a[132:133], v8 offset:16384
v_mfma_f32_16x16x32_bf16 v[136:139], a[20:23], a[140:143], v[136:139]
buffer_load_dwordx4 v13, s[8:11], s25 offen offset:1024 lds
v_mfma_f32_16x16x32_bf16 v[140:143], a[24:27], a[136:139], 0
ds_read_b64_tr_b16 a[134:135], v8 offset:18432
v_mfma_f32_16x16x32_bf16 v[140:143], a[28:31], a[140:143], v[140:143]
v_mfma_f32_16x16x32_bf16 v[144:147], a[32:35], a[136:139], 0
ds_read_b128 a[64:67], v2 offset:32768
v_mfma_f32_16x16x32_bf16 v[144:147], a[36:39], a[140:143], v[144:147]
buffer_load_dwordx4 v14, s[8:11], s25 offen offset:2048 lds
v_mfma_f32_16x16x32_bf16 v[148:151], a[40:43], a[136:139], 0
ds_read_b128 a[68:71], v3 offset:32768
v_mfma_f32_16x16x32_bf16 v[148:151], a[44:47], a[140:143], v[148:151]
ds_read_b128 a[72:75], v2 offset:34816
v_mfma_f32_16x16x32_bf16 v[152:155], a[48:51], a[136:139], 0
ds_read_b128 a[76:79], v3 offset:34816
v_mfma_f32_16x16x32_bf16 v[152:155], a[52:55], a[140:143], v[152:155]
buffer_load_dwordx4 v15, s[8:11], s25 offen offset:3072 lds
v_mfma_f32_16x16x32_bf16 v[156:159], a[56:59], a[136:139], 0
s_add_u32 s25, s25, 128
ds_read_b128 a[80:83], v2 offset:36864
v_mfma_f32_16x16x32_bf16 v[156:159], a[60:63], a[140:143], v[156:159]
s_waitcnt lgkmcnt(5)
ds_read_b128 a[84:87], v3 offset:36864
v_mfma_f32_16x16x32_bf16 v[160:163], a[0:3], a[128:131], 0
s_bitcmp1_b32 s2, 4
s_cselect_b32 s37, s21, s37
ds_read_b64_tr_b16 a[136:137], v9 offset:0
v_mfma_f32_16x16x32_bf16 v[160:163], a[4:7], a[132:135], v[160:163]
s_lshl_b32 s56, s37, 5
s_add_u32 s56, s56, s20
s_lshl_b32 s56, s56, 2
v_mfma_f32_16x16x32_bf16 v[164:167], a[8:11], a[128:131], 0
s_add_u32 s56, s56, 8192
ds_read_b64_tr_b16 a[138:139], v9 offset:2048
v_writelane_b32 v28, s56, 3
v_mfma_f32_16x16x32_bf16 v[164:167], a[12:15], a[132:135], v[164:167]
s_add_u32 s56, s56, 2048
v_writelane_b32 v28, s56, 6
v_mfma_f32_16x16x32_bf16 v[168:171], a[16:19], a[128:131], 0
s_add_u32 s56, s56, 4096
ds_read_b64_tr_b16 a[140:141], v9 offset:16384
v_writelane_b32 v28, s56, 5
v_mfma_f32_16x16x32_bf16 v[168:171], a[20:23], a[132:135], v[168:171]
s_lshl_b32 s56, s2, 2
s_add_u32 s56, s56, 12288
v_writelane_b32 v28, s56, 4
v_mfma_f32_16x16x32_bf16 v[172:175], a[24:27], a[128:131], 0
s_lshl_b32 s56, s39, 5
s_add_u32 s56, s56, s38
ds_read_b64_tr_b16 a[142:143], v9 offset:18432
v_mfma_f32_16x16x32_bf16 v[172:175], a[28:31], a[132:135], v[172:175]
s_lshl_b32 s56, s56, 2
s_add_u32 s56, s56, 20480
s_cmp_lt_u32 s2, 224
v_mfma_f32_16x16x32_bf16 v[176:179], a[32:35], a[128:131], 0
s_cselect_b32 s56, s56, 3221225472
v_writelane_b32 v28, s56, 7
v_mfma_f32_16x16x32_bf16 v[176:179], a[36:39], a[132:135], v[176:179]
s_cmp_eq_u32 s3, 0
s_cselect_b32 s56, 94371840, 3221225472
v_mfma_f32_16x16x32_bf16 v[180:183], a[40:43], a[128:131], 0
ds_read_b128 a[88:91], v2 offset:38912
v_mfma_f32_16x16x32_bf16 v[180:183], a[44:47], a[132:135], v[180:183]
ds_read_b128 a[92:95], v3 offset:38912
v_mfma_f32_16x16x32_bf16 v[184:187], a[48:51], a[128:131], 0
ds_read_b128 a[96:99], v2 offset:40960
v_mfma_f32_16x16x32_bf16 v[184:187], a[52:55], a[132:135], v[184:187]
buffer_store_dword v246, v28, s[4:7], s56 offen sc1
v_mfma_f32_16x16x32_bf16 v[188:191], a[56:59], a[128:131], 0
ds_read_b128 a[100:103], v3 offset:40960
v_mov_b32 v27, 1
v_mfma_f32_16x16x32_bf16 v[188:191], a[60:63], a[132:135], v[188:191]
s_waitcnt lgkmcnt(4)
ds_read_b128 a[104:107], v2 offset:43008
v_cmp_eq_u32 vcc, 0, v0
v_mfma_f32_16x16x32_bf16 v[192:195], a[0:3], a[136:139], 0
ds_read_b64_tr_b16 a[128:129], v10 offset:0
v_mov_b32 v26, 3221225472
v_mfma_f32_16x16x32_bf16 v[192:195], a[4:7], a[140:143], v[192:195]
s_lshl_b32 s31, s20, 20
s_lshl_b32 s22, s21, 17
v_cndmask_b32 v26, v26, v246, vcc
v_mfma_f32_16x16x32_bf16 v[196:199], a[8:11], a[136:139], 0
s_add_u32 s31, s31, s22
s_lshr_b32 s22, s3, 1
ds_read_b64_tr_b16 a[130:131], v10 offset:2048
v_mfma_f32_16x16x32_bf16 v[196:199], a[12:15], a[140:143], v[196:199]
s_lshl_b32 s22, s22, 16
s_add_u32 s31, s31, s22
s_and_b32 s22, s3, 1
v_mfma_f32_16x16x32_bf16 v[200:203], a[16:19], a[136:139], 0
s_lshl_b32 s22, s22, 14
s_add_u32 s31, s31, s22
ds_read_b64_tr_b16 a[132:133], v10 offset:16384
v_mfma_f32_16x16x32_bf16 v[200:203], a[20:23], a[140:143], v[200:203]
s_add_u32 s31, s31, 16777216
v_mfma_f32_16x16x32_bf16 v[204:207], a[24:27], a[136:139], 0
ds_read_b64_tr_b16 a[134:135], v10 offset:18432
v_mfma_f32_16x16x32_bf16 v[204:207], a[28:31], a[140:143], v[204:207]
v_mfma_f32_16x16x32_bf16 v[208:211], a[32:35], a[136:139], 0
v_mfma_f32_16x16x32_bf16 v[208:211], a[36:39], a[140:143], v[208:211]
v_mfma_f32_16x16x32_bf16 v[212:215], a[40:43], a[136:139], 0
ds_read_b128 a[108:111], v3 offset:43008
v_mfma_f32_16x16x32_bf16 v[212:215], a[44:47], a[140:143], v[212:215]
ds_read_b128 a[112:115], v2 offset:45056
v_mfma_f32_16x16x32_bf16 v[216:219], a[48:51], a[136:139], 0
ds_read_b128 a[116:119], v3 offset:45056
v_mfma_f32_16x16x32_bf16 v[216:219], a[52:55], a[140:143], v[216:219]
v_mfma_f32_16x16x32_bf16 v[220:223], a[56:59], a[136:139], 0
ds_read_b128 a[120:123], v2 offset:47104
v_mfma_f32_16x16x32_bf16 v[220:223], a[60:63], a[140:143], v[220:223]
s_waitcnt lgkmcnt(4)
ds_read_b128 a[124:127], v3 offset:47104
v_mfma_f32_16x16x32_bf16 a[192:195], a[0:3], a[128:131], 0
ds_read_b64_tr_b16 a[136:137], v11 offset:0
v_mfma_f32_16x16x32_bf16 a[192:195], a[4:7], a[132:135], a[192:195]
v_mfma_f32_16x16x32_bf16 a[196:199], a[8:11], a[128:131], 0
ds_read_b64_tr_b16 a[138:139], v11 offset:2048
v_mfma_f32_16x16x32_bf16 a[196:199], a[12:15], a[132:135], a[196:199]
v_mfma_f32_16x16x32_bf16 a[200:203], a[16:19], a[128:131], 0
ds_read_b64_tr_b16 a[140:141], v11 offset:16384
v_mfma_f32_16x16x32_bf16 a[200:203], a[20:23], a[132:135], a[200:203]
v_mfma_f32_16x16x32_bf16 a[204:207], a[24:27], a[128:131], 0
ds_read_b64_tr_b16 a[142:143], v11 offset:18432
v_mfma_f32_16x16x32_bf16 a[204:207], a[28:31], a[132:135], a[204:207]
v_mfma_f32_16x16x32_bf16 a[208:211], a[32:35], a[128:131], 0
v_mfma_f32_16x16x32_bf16 a[208:211], a[36:39], a[132:135], a[208:211]
v_mfma_f32_16x16x32_bf16 a[212:215], a[40:43], a[128:131], 0
v_mfma_f32_16x16x32_bf16 a[212:215], a[44:47], a[132:135], a[212:215]
v_mfma_f32_16x16x32_bf16 a[216:219], a[48:51], a[128:131], 0
v_mfma_f32_16x16x32_bf16 a[216:219], a[52:55], a[132:135], a[216:219]
v_mfma_f32_16x16x32_bf16 a[220:223], a[56:59], a[128:131], 0
s_waitcnt vmcnt(1) lgkmcnt(0)
v_mfma_f32_16x16x32_bf16 a[220:223], a[60:63], a[132:135], a[220:223]
s_barrier
v_mfma_f32_16x16x32_bf16 a[224:227], a[0:3], a[136:139], 0
s_add_u32 m0, s29, 65536
ds_read_b64_tr_b16 a[128:129], v4 offset:32768
v_mfma_f32_16x16x32_bf16 a[224:227], a[4:7], a[140:143], a[224:227]
buffer_load_dwordx4 v16, s[12:15], s26 offen offset:0 lds
v_mfma_f32_16x16x32_bf16 a[228:231], a[8:11], a[136:139], 0
ds_read_b64_tr_b16 a[130:131], v4 offset:34816
v_mfma_f32_16x16x32_bf16 a[228:231], a[12:15], a[140:143], a[228:231]
v_mfma_f32_16x16x32_bf16 a[232:235], a[16:19], a[136:139], 0
ds_read_b64_tr_b16 a[132:133], v4 offset:49152
v_mfma_f32_16x16x32_bf16 a[232:235], a[20:23], a[140:143], a[232:235]
buffer_load_dwordx4 v17, s[12:15], s26 offen offset:1024 lds
v_mfma_f32_16x16x32_bf16 a[236:239], a[24:27], a[136:139], 0
ds_read_b64_tr_b16 a[134:135], v4 offset:51200
v_mfma_f32_16x16x32_bf16 a[236:239], a[28:31], a[140:143], a[236:239]
v_mfma_f32_16x16x32_bf16 a[240:243], a[32:35], a[136:139], 0
v_mfma_f32_16x16x32_bf16 a[240:243], a[36:39], a[140:143], a[240:243]
buffer_load_dwordx4 v18, s[12:15], s26 offen offset:2048 lds
v_mfma_f32_16x16x32_bf16 a[244:247], a[40:43], a[136:139], 0
PAD_22:
s_cbranch_execz PAD_26
v_mfma_f32_16x16x32_bf16 a[244:247], a[44:47], a[140:143], a[244:247]
v_mfma_f32_16x16x32_bf16 a[248:251], a[48:51], a[136:139], 0
v_mfma_f32_16x16x32_bf16 a[248:251], a[52:55], a[140:143], a[248:251]
buffer_load_dwordx4 v19, s[12:15], s26 offen offset:3072 lds
v_mfma_f32_16x16x32_bf16 a[252:255], a[56:59], a[136:139], 0
s_add_u32 s26, s26, 524288
v_mfma_f32_16x16x32_bf16 a[252:255], a[60:63], a[140:143], a[252:255]
s_waitcnt lgkmcnt(0)
Lg_501:
v_mfma_f32_16x16x32_bf16 v[32:35], a[64:67], a[128:131], v[32:35]
s_add_u32 m0, s29, 81920
ds_read_b64_tr_b16 a[136:137], v5 offset:32768
v_mfma_f32_16x16x32_bf16 v[32:35], a[68:71], a[132:135], v[32:35]
buffer_load_dwordx4 v16, s[12:15], s27 offen offset:0 lds
v_mfma_f32_16x16x32_bf16 v[36:39], a[72:75], a[128:131], v[36:39]
ds_read_b64_tr_b16 a[138:139], v5 offset:34816
v_mfma_f32_16x16x32_bf16 v[36:39], a[76:79], a[132:135], v[36:39]
v_mfma_f32_16x16x32_bf16 v[40:43], a[80:83], a[128:131], v[40:43]
ds_read_b64_tr_b16 a[140:141], v5 offset:49152
v_mfma_f32_16x16x32_bf16 v[40:43], a[84:87], a[132:135], v[40:43]
buffer_load_dwordx4 v17, s[12:15], s27 offen offset:1024 lds
v_mfma_f32_16x16x32_bf16 v[44:47], a[88:91], a[128:131], v[44:47]
ds_read_b64_tr_b16 a[142:143], v5 offset:51200
v_mfma_f32_16x16x32_bf16 v[44:47], a[92:95], a[132:135], v[44:47]
v_mfma_f32_16x16x32_bf16 v[48:51], a[96:99], a[128:131], v[48:51]
ds_read_b128 a[0:3], v2 offset:0
v_mfma_f32_16x16x32_bf16 v[48:51], a[100:103], a[132:135], v[48:51]
buffer_load_dwordx4 v18, s[12:15], s27 offen offset:2048 lds
v_mfma_f32_16x16x32_bf16 v[52:55], a[104:107], a[128:131], v[52:55]
ds_read_b128 a[4:7], v3 offset:0
v_mfma_f32_16x16x32_bf16 v[52:55], a[108:111], a[132:135], v[52:55]
v_mfma_f32_16x16x32_bf16 v[56:59], a[112:115], a[128:131], v[56:59]
v_mfma_f32_16x16x32_bf16 v[56:59], a[116:119], a[132:135], v[56:59]
buffer_load_dwordx4 v19, s[12:15], s27 offen offset:3072 lds
v_mfma_f32_16x16x32_bf16 v[60:63], a[120:123], a[128:131], v[60:63]
s_add_u32 s27, s27, 524288
ds_read_b128 a[8:11], v2 offset:2048
v_mfma_f32_16x16x32_bf16 v[60:63], a[124:127], a[132:135], v[60:63]
s_waitcnt lgkmcnt(3)
v_mfma_f32_16x16x32_bf16 v[64:67], a[64:67], a[136:139], v[64:67]
s_add_u32 m0, s28, 32768
ds_read_b64_tr_b16 a[128:129], v6 offset:32768
v_mfma_f32_16x16x32_bf16 v[64:67], a[68:71], a[140:143], v[64:67]
buffer_load_dwordx4 v12, s[8:11], s24 offen offset:0 lds
v_mfma_f32_16x16x32_bf16 v[68:71], a[72:75], a[136:139], v[68:71]
ds_read_b64_tr_b16 a[130:131], v6 offset:34816
v_mfma_f32_16x16x32_bf16 v[68:71], a[76:79], a[140:143], v[68:71]
v_mfma_f32_16x16x32_bf16 v[72:75], a[80:83], a[136:139], v[72:75]
ds_read_b64_tr_b16 a[132:133], v6 offset:49152
v_mfma_f32_16x16x32_bf16 v[72:75], a[84:87], a[140:143], v[72:75]
buffer_load_dwordx4 v13, s[8:11], s24 offen offset:1024 lds
v_mfma_f32_16x16x32_bf16 v[76:79], a[88:91], a[136:139], v[76:79]
ds_read_b64_tr_b16 a[134:135], v6 offset:51200
v_mfma_f32_16x16x32_bf16 v[76:79], a[92:95], a[140:143], v[76:79]
v_mfma_f32_16x16x32_bf16 v[80:83], a[96:99], a[136:139], v[80:83]
ds_read_b128 a[12:15], v3 offset:2048
v_mfma_f32_16x16x32_bf16 v[80:83], a[100:103], a[140:143], v[80:83]
buffer_load_dwordx4 v14, s[8:11], s24 offen offset:2048 lds
v_mfma_f32_16x16x32_bf16 v[84:87], a[104:107], a[136:139], v[84:87]
v_mfma_f32_16x16x32_bf16 v[84:87], a[108:111], a[140:143], v[84:87]
v_mfma_f32_16x16x32_bf16 v[88:91], a[112:115], a[136:139], v[88:91]
ds_read_b128 a[16:19], v2 offset:4096
v_mfma_f32_16x16x32_bf16 v[88:91], a[116:119], a[140:143], v[88:91]
buffer_load_dwordx4 v15, s[8:11], s24 offen offset:3072 lds
v_mfma_f32_16x16x32_bf16 v[92:95], a[120:123], a[136:139], v[92:95]
s_add_u32 s24, s24, 128
ds_read_b128 a[20:23], v3 offset:4096
v_mfma_f32_16x16x32_bf16 v[92:95], a[124:127], a[140:143], v[92:95]
s_waitcnt lgkmcnt(3)
v_mfma_f32_16x16x32_bf16 v[96:99], a[64:67], a[128:131], v[96:99]
s_add_u32 m0, s28, 36864
ds_read_b64_tr_b16 a[136:137], v7 offset:32768
v_mfma_f32_16x16x32_bf16 v[96:99], a[68:71], a[132:135], v[96:99]
buffer_load_dwordx4 v12, s[8:11], s25 offen offset:0 lds
v_mfma_f32_16x16x32_bf16 v[100:103], a[72:75], a[128:131], v[100:103]
ds_read_b64_tr_b16 a[138:139], v7 offset:34816
v_mfma_f32_16x16x32_bf16 v[100:103], a[76:79], a[132:135], v[100:103]
v_mfma_f32_16x16x32_bf16 v[104:107], a[80:83], a[128:131], v[104:107]
ds_read_b64_tr_b16 a[140:141], v7 offset:49152
v_mfma_f32_16x16x32_bf16 v[104:107], a[84:87], a[132:135], v[104:107]
buffer_load_dwordx4 v13, s[8:11], s25 offen offset:1024 lds
v_mfma_f32_16x16x32_bf16 v[108:111], a[88:91], a[128:131], v[108:111]
ds_read_b64_tr_b16 a[142:143], v7 offset:51200
v_mfma_f32_16x16x32_bf16 v[108:111], a[92:95], a[132:135], v[108:111]
v_mfma_f32_16x16x32_bf16 v[112:115], a[96:99], a[128:131], v[112:115]
v_mfma_f32_16x16x32_bf16 v[112:115], a[100:103], a[132:135], v[112:115]
buffer_load_dwordx4 v14, s[8:11], s25 offen offset:2048 lds
v_mfma_f32_16x16x32_bf16 v[116:119], a[104:107], a[128:131], v[116:119]
ds_read_b128 a[24:27], v2 offset:6144
v_mfma_f32_16x16x32_bf16 v[116:119], a[108:111], a[132:135], v[116:119]
v_mfma_f32_16x16x32_bf16 v[120:123], a[112:115], a[128:131], v[120:123]
ds_read_b128 a[28:31], v3 offset:6144
v_mfma_f32_16x16x32_bf16 v[120:123], a[116:119], a[132:135], v[120:123]
buffer_load_dwordx4 v15, s[8:11], s25 offen offset:3072 lds
v_mfma_f32_16x16x32_bf16 v[124:127], a[120:123], a[128:131], v[124:127]
s_add_u32 s25, s25, 128
v_mfma_f32_16x16x32_bf16 v[124:127], a[124:127], a[132:135], v[124:127]
s_waitcnt lgkmcnt(2)
v_mfma_f32_16x16x32_bf16 v[128:131], a[64:67], a[136:139], v[128:131]
ds_read_b64_tr_b16 a[128:129], v8 offset:32768
v_mfma_f32_16x16x32_bf16 v[128:131], a[68:71], a[140:143], v[128:131]
buffer_load_dword v21, v20, s[16:19], s43 offen
v_mfma_f32_16x16x32_bf16 v[132:135], a[72:75], a[136:139], v[132:135]
s_add_u32 s43, s43, s47
ds_read_b64_tr_b16 a[130:131], v8 offset:34816
v_mfma_f32_16x16x32_bf16 v[132:135], a[76:79], a[140:143], v[132:135]
s_cmp_ge_u32 s43, s51
v_mfma_f32_16x16x32_bf16 v[136:139], a[80:83], a[136:139], v[136:139]
s_cselect_b32 s43, 0, s43
ds_read_b64_tr_b16 a[132:133], v8 offset:49152
v_mfma_f32_16x16x32_bf16 v[136:139], a[84:87], a[140:143], v[136:139]
s_cselect_b32 s51, s42, s51
v_mfma_f32_16x16x32_bf16 v[140:143], a[88:91], a[136:139], v[140:143]
s_cselect_b64 s[16:17], s[40:41], s[16:17]
ds_read_b64_tr_b16 a[134:135], v8 offset:51200
v_mfma_f32_16x16x32_bf16 v[140:143], a[92:95], a[140:143], v[140:143]
s_cselect_b32 s18, s42, s18
v_mfma_f32_16x16x32_bf16 v[144:147], a[96:99], a[136:139], v[144:147]
s_cselect_b64 s[40:41], s[44:45], s[40:41]
ds_read_b128 a[32:35], v2 offset:8192
v_mfma_f32_16x16x32_bf16 v[144:147], a[100:103], a[140:143], v[144:147]
s_cselect_b32 s42, s46, s42
v_mfma_f32_16x16x32_bf16 v[148:151], a[104:107], a[136:139], v[148:151]
s_cselect_b32 s46, 0, s46
v_mfma_f32_16x16x32_bf16 v[148:151], a[108:111], a[140:143], v[148:151]
s_cmp_eq_u32 s30, s55
v_mfma_f32_16x16x32_bf16 v[152:155], a[112:115], a[136:139], v[152:155]
s_cselect_b32 s22, 0, 3221225472
ds_read_b128 a[36:39], v3 offset:8192
v_mfma_f32_16x16x32_bf16 v[152:155], a[116:119], a[140:143], v[152:155]
s_sub_u32 s30, s30, 1
buffer_atomic_add v27, v26, s[60:63], s22 offen sc1
v_mfma_f32_16x16x32_bf16 v[156:159], a[120:123], a[136:139], v[156:159]
ds_read_b128 a[40:43], v2 offset:10240
v_mfma_f32_16x16x32_bf16 v[156:159], a[124:127], a[140:143], v[156:159]
s_waitcnt lgkmcnt(3)
v_mfma_f32_16x16x32_bf16 v[160:163], a[64:67], a[128:131], v[160:163]
ds_read_b64_tr_b16 a[136:137], v9 offset:32768
v_mfma_f32_16x16x32_bf16 v[160:163], a[68:71], a[132:135], v[160:163]
v_mfma_f32_16x16x32_bf16 v[164:167], a[72:75], a[128:131], v[164:167]
ds_read_b64_tr_b16 a[138:139], v9 offset:34816
v_mfma_f32_16x16x32_bf16 v[164:167], a[76:79], a[132:135], v[164:167]
v_mfma_f32_16x16x32_bf16 v[168:171], a[80:83], a[128:131], v[168:171]
ds_read_b64_tr_b16 a[140:141], v9 offset:49152
v_mfma_f32_16x16x32_bf16 v[168:171], a[84:87], a[132:135], v[168:171]
v_mfma_f32_16x16x32_bf16 v[172:175], a[88:91], a[128:131], v[172:175]
ds_read_b64_tr_b16 a[142:143], v9 offset:51200
v_mfma_f32_16x16x32_bf16 v[172:175], a[92:95], a[132:135], v[172:175]
v_mfma_f32_16x16x32_bf16 v[176:179], a[96:99], a[128:131], v[176:179]
v_mfma_f32_16x16x32_bf16 v[176:179], a[100:103], a[132:135], v[176:179]
v_mfma_f32_16x16x32_bf16 v[180:183], a[104:107], a[128:131], v[180:183]
ds_read_b128 a[44:47], v3 offset:10240
v_mfma_f32_16x16x32_bf16 v[180:183], a[108:111], a[132:135], v[180:183]
v_mfma_f32_16x16x32_bf16 v[184:187], a[112:115], a[128:131], v[184:187]
ds_read_b128 a[48:51], v2 offset:12288
v_mfma_f32_16x16x32_bf16 v[184:187], a[116:119], a[132:135], v[184:187]
v_mfma_f32_16x16x32_bf16 v[188:191], a[120:123], a[128:131], v[188:191]
v_mfma_f32_16x16x32_bf16 v[188:191], a[124:127], a[132:135], v[188:191]
s_waitcnt lgkmcnt(2)
v_mfma_f32_16x16x32_bf16 v[192:195], a[64:67], a[136:139], v[192:195]
ds_read_b64_tr_b16 a[128:129], v10 offset:32768
v_mfma_f32_16x16x32_bf16 v[192:195], a[68:71], a[140:143], v[192:195]
v_mfma_f32_16x16x32_bf16 v[196:199], a[72:75], a[136:139], v[196:199]
ds_read_b64_tr_b16 a[130:131], v10 offset:34816
v_mfma_f32_16x16x32_bf16 v[196:199], a[76:79], a[140:143], v[196:199]
v_mfma_f32_16x16x32_bf16 v[200:203], a[80:83], a[136:139], v[200:203]
ds_read_b64_tr_b16 a[132:133], v10 offset:49152
v_mfma_f32_16x16x32_bf16 v[200:203], a[84:87], a[140:143], v[200:203]
v_mfma_f32_16x16x32_bf16 v[204:207], a[88:91], a[136:139], v[204:207]
ds_read_b64_tr_b16 a[134:135], v10 offset:51200
v_mfma_f32_16x16x32_bf16 v[204:207], a[92:95], a[140:143], v[204:207]
v_mfma_f32_16x16x32_bf16 v[208:211], a[96:99], a[136:139], v[208:211]
ds_read_b128 a[52:55], v3 offset:12288
v_mfma_f32_16x16x32_bf16 v[208:211], a[100:103], a[140:143], v[208:211]
v_mfma_f32_16x16x32_bf16 v[212:215], a[104:107], a[136:139], v[212:215]
ds_read_b128 a[56:59], v2 offset:14336
v_mfma_f32_16x16x32_bf16 v[212:215], a[108:111], a[140:143], v[212:215]
v_mfma_f32_16x16x32_bf16 v[216:219], a[112:115], a[136:139], v[216:219]
v_mfma_f32_16x16x32_bf16 v[216:219], a[116:119], a[140:143], v[216:219]
v_mfma_f32_16x16x32_bf16 v[220:223], a[120:123], a[136:139], v[220:223]
ds_read_b128 a[60:63], v3 offset:14336
v_mfma_f32_16x16x32_bf16 v[220:223], a[124:127], a[140:143], v[220:223]
s_waitcnt lgkmcnt(3)
v_mfma_f32_16x16x32_bf16 a[192:195], a[64:67], a[128:131], a[192:195]
ds_read_b64_tr_b16 a[136:137], v11 offset:32768
v_mfma_f32_16x16x32_bf16 a[192:195], a[68:71], a[132:135], a[192:195]
v_mfma_f32_16x16x32_bf16 a[196:199], a[72:75], a[128:131], a[196:199]
ds_read_b64_tr_b16 a[138:139], v11 offset:34816
v_mfma_f32_16x16x32_bf16 a[196:199], a[76:79], a[132:135], a[196:199]
v_mfma_f32_16x16x32_bf16 a[200:203], a[80:83], a[128:131], a[200:203]
ds_read_b64_tr_b16 a[140:141], v11 offset:49152
v_mfma_f32_16x16x32_bf16 a[200:203], a[84:87], a[132:135], a[200:203]
v_mfma_f32_16x16x32_bf16 a[204:207], a[88:91], a[128:131], a[204:207]
ds_read_b64_tr_b16 a[142:143], v11 offset:51200
v_mfma_f32_16x16x32_bf16 a[204:207], a[92:95], a[132:135], a[204:207]
v_mfma_f32_16x16x32_bf16 a[208:211], a[96:99], a[128:131], a[208:211]
v_mfma_f32_16x16x32_bf16 a[208:211], a[100:103], a[132:135], a[208:211]
v_mfma_f32_16x16x32_bf16 a[212:215], a[104:107], a[128:131], a[212:215]
v_mfma_f32_16x16x32_bf16 a[212:215], a[108:111], a[132:135], a[212:215]
v_mfma_f32_16x16x32_bf16 a[216:219], a[112:115], a[128:131], a[216:219]
v_mfma_f32_16x16x32_bf16 a[216:219], a[116:119], a[132:135], a[216:219]
v_mfma_f32_16x16x32_bf16 a[220:223], a[120:123], a[128:131], a[220:223]
s_waitcnt vmcnt(2) lgkmcnt(0)
v_mfma_f32_16x16x32_bf16 a[220:223], a[124:127], a[132:135], a[220:223]
s_barrier
v_mfma_f32_16x16x32_bf16 a[224:227], a[64:67], a[136:139], a[224:227]
s_add_u32 m0, s29, 98304
ds_read_b64_tr_b16 a[128:129], v4 offset:0
v_mfma_f32_16x16x32_bf16 a[224:227], a[68:71], a[140:143], a[224:227]
buffer_load_dwordx4 v16, s[12:15], s26 offen offset:0 lds
v_mfma_f32_16x16x32_bf16 a[228:231], a[72:75], a[136:139], a[228:231]
ds_read_b64_tr_b16 a[130:131], v4 offset:2048
v_mfma_f32_16x16x32_bf16 a[228:231], a[76:79], a[140:143], a[228:231]
v_mfma_f32_16x16x32_bf16 a[232:235], a[80:83], a[136:139], a[232:235]
ds_read_b64_tr_b16 a[132:133], v4 offset:16384
v_mfma_f32_16x16x32_bf16 a[232:235], a[84:87], a[140:143], a[232:235]
buffer_load_dwordx4 v17, s[12:15], s26 offen offset:1024 lds
v_mfma_f32_16x16x32_bf16 a[236:239], a[88:91], a[136:139], a[236:239]
ds_read_b64_tr_b16 a[134:135], v4 offset:18432
v_mfma_f32_16x16x32_bf16 a[236:239], a[92:95], a[140:143], a[236:239]
v_mfma_f32_16x16x32_bf16 a[240:243], a[96:99], a[136:139], a[240:243]
v_mfma_f32_16x16x32_bf16 a[240:243], a[100:103], a[140:143], a[240:243]
buffer_load_dwordx4 v18, s[12:15], s26 offen offset:2048 lds
v_mfma_f32_16x16x32_bf16 a[244:247], a[104:107], a[136:139], a[244:247]
v_mfma_f32_16x16x32_bf16 a[244:247], a[108:111], a[140:143], a[244:247]
v_mfma_f32_16x16x32_bf16 a[248:251], a[112:115], a[136:139], a[248:251]
v_mfma_f32_16x16x32_bf16 a[248:251], a[116:119], a[140:143], a[248:251]
buffer_load_dwordx4 v19, s[12:15], s26 offen offset:3072 lds
v_mfma_f32_16x16x32_bf16 a[252:255], a[120:123], a[136:139], a[252:255]
s_add_u32 s26, s26, 524288
v_mfma_f32_16x16x32_bf16 a[252:255], a[124:127], a[140:143], a[252:255]
s_waitcnt lgkmcnt(0)
buffer_store_dword v27, v26, s[4:7], s82 offen sc1
v_mfma_f32_16x16x32_bf16 v[32:35], a[0:3], a[128:131], v[32:35]
s_add_u32 m0, s29, 114688
ds_read_b64_tr_b16 a[136:137], v5 offset:0
v_mfma_f32_16x16x32_bf16 v[32:35], a[4:7], a[132:135], v[32:35]
buffer_load_dwordx4 v16, s[12:15], s27 offen offset:0 lds
v_mfma_f32_16x16x32_bf16 v[36:39], a[8:11], a[128:131], v[36:39]
ds_read_b64_tr_b16 a[138:139], v5 offset:2048
v_mfma_f32_16x16x32_bf16 v[36:39], a[12:15], a[132:135], v[36:39]
v_mfma_f32_16x16x32_bf16 v[40:43], a[16:19], a[128:131], v[40:43]
ds_read_b64_tr_b16 a[140:141], v5 offset:16384
v_mfma_f32_16x16x32_bf16 v[40:43], a[20:23], a[132:135], v[40:43]
buffer_load_dwordx4 v17, s[12:15], s27 offen offset:1024 lds
v_mfma_f32_16x16x32_bf16 v[44:47], a[24:27], a[128:131], v[44:47]
ds_read_b64_tr_b16 a[142:143], v5 offset:18432
v_mfma_f32_16x16x32_bf16 v[44:47], a[28:31], a[132:135], v[44:47]
v_mfma_f32_16x16x32_bf16 v[48:51], a[32:35], a[128:131], v[48:51]
ds_read_b128 a[64:67], v2 offset:32768
v_mfma_f32_16x16x32_bf16 v[48:51], a[36:39], a[132:135], v[48:51]
buffer_load_dwordx4 v18, s[12:15], s27 offen offset:2048 lds
v_mfma_f32_16x16x32_bf16 v[52:55], a[40:43], a[128:131], v[52:55]
ds_read_b128 a[68:71], v3 offset:32768
v_mfma_f32_16x16x32_bf16 v[52:55], a[44:47], a[132:135], v[52:55]
v_mfma_f32_16x16x32_bf16 v[56:59], a[48:51], a[128:131], v[56:59]
v_mfma_f32_16x16x32_bf16 v[56:59], a[52:55], a[132:135], v[56:59]
buffer_load_dwordx4 v19, s[12:15], s27 offen offset:3072 lds
v_mfma_f32_16x16x32_bf16 v[60:63], a[56:59], a[128:131], v[60:63]
s_add_u32 s27, s27, 524288
ds_read_b128 a[72:75], v2 offset:34816
v_mfma_f32_16x16x32_bf16 v[60:63], a[60:63], a[132:135], v[60:63]
s_waitcnt lgkmcnt(3)
v_mfma_f32_16x16x32_bf16 v[64:67], a[0:3], a[136:139], v[64:67]
s_add_u32 m0, s28, 0
ds_read_b64_tr_b16 a[128:129], v6 offset:0
v_mfma_f32_16x16x32_bf16 v[64:67], a[4:7], a[140:143], v[64:67]
buffer_load_dwordx4 v12, s[8:11], s24 offen offset:0 lds
v_mfma_f32_16x16x32_bf16 v[68:71], a[8:11], a[136:139], v[68:71]
ds_read_b64_tr_b16 a[130:131], v6 offset:2048
v_mfma_f32_16x16x32_bf16 v[68:71], a[12:15], a[140:143], v[68:71]
v_mfma_f32_16x16x32_bf16 v[72:75], a[16:19], a[136:139], v[72:75]
ds_read_b64_tr_b16 a[132:133], v6 offset:16384
v_mfma_f32_16x16x32_bf16 v[72:75], a[20:23], a[140:143], v[72:75]
buffer_load_dwordx4 v13, s[8:11], s24 offen offset:1024 lds
v_mfma_f32_16x16x32_bf16 v[76:79], a[24:27], a[136:139], v[76:79]
ds_read_b64_tr_b16 a[134:135], v6 offset:18432
v_mfma_f32_16x16x32_bf16 v[76:79], a[28:31], a[140:143], v[76:79]
v_mfma_f32_16x16x32_bf16 v[80:83], a[32:35], a[136:139], v[80:83]
ds_read_b128 a[76:79], v3 offset:34816
v_mfma_f32_16x16x32_bf16 v[80:83], a[36:39], a[140:143], v[80:83]
buffer_load_dwordx4 v14, s[8:11], s24 offen offset:2048 lds
v_mfma_f32_16x16x32_bf16 v[84:87], a[40:43], a[136:139], v[84:87]
v_mfma_f32_16x16x32_bf16 v[84:87], a[44:47], a[140:143], v[84:87]
v_mfma_f32_16x16x32_bf16 v[88:91], a[48:51], a[136:139], v[88:91]
ds_read_b128 a[80:83], v2 offset:36864
v_mfma_f32_16x16x32_bf16 v[88:91], a[52:55], a[140:143], v[88:91]
buffer_load_dwordx4 v15, s[8:11], s24 offen offset:3072 lds
v_mfma_f32_16x16x32_bf16 v[92:95], a[56:59], a[136:139], v[92:95]
s_add_u32 s24, s24, 128
ds_read_b128 a[84:87], v3 offset:36864
v_mfma_f32_16x16x32_bf16 v[92:95], a[60:63], a[140:143], v[92:95]
s_waitcnt lgkmcnt(3)
v_mfma_f32_16x16x32_bf16 v[96:99], a[0:3], a[128:131], v[96:99]
s_add_u32 m0, s28, 4096
ds_read_b64_tr_b16 a[136:137], v7 offset:0
v_mfma_f32_16x16x32_bf16 v[96:99], a[4:7], a[132:135], v[96:99]
buffer_load_dwordx4 v12, s[8:11], s25 offen offset:0 lds
v_mfma_f32_16x16x32_bf16 v[100:103], a[8:11], a[128:131], v[100:103]
ds_read_b64_tr_b16 a[138:139], v7 offset:2048
v_mfma_f32_16x16x32_bf16 v[100:103], a[12:15], a[132:135], v[100:103]
v_mfma_f32_16x16x32_bf16 v[104:107], a[16:19], a[128:131], v[104:107]
ds_read_b64_tr_b16 a[140:141], v7 offset:16384
v_mfma_f32_16x16x32_bf16 v[104:107], a[20:23], a[132:135], v[104:107]
buffer_load_dwordx4 v13, s[8:11], s25 offen offset:1024 lds
v_mfma_f32_16x16x32_bf16 v[108:111], a[24:27], a[128:131], v[108:111]
ds_read_b64_tr_b16 a[142:143], v7 offset:18432
v_mfma_f32_16x16x32_bf16 v[108:111], a[28:31], a[132:135], v[108:111]
v_mfma_f32_16x16x32_bf16 v[112:115], a[32:35], a[128:131], v[112:115]
v_mfma_f32_16x16x32_bf16 v[112:115], a[36:39], a[132:135], v[112:115]
buffer_load_dwordx4 v14, s[8:11], s25 offen offset:2048 lds
v_mfma_f32_16x16x32_bf16 v[116:119], a[40:43], a[128:131], v[116:119]
ds_read_b128 a[88:91], v2 offset:38912
v_mfma_f32_16x16x32_bf16 v[116:119], a[44:47], a[132:135], v[116:119]
v_mfma_f32_16x16x32_bf16 v[120:123], a[48:51], a[128:131], v[120:123]
ds_read_b128 a[92:95], v3 offset:38912
v_mfma_f32_16x16x32_bf16 v[120:123], a[52:55], a[132:135], v[120:123]
buffer_load_dwordx4 v15, s[8:11], s25 offen offset:3072 lds
v_mfma_f32_16x16x32_bf16 v[124:127], a[56:59], a[128:131], v[124:127]
s_add_u32 s25, s25, 128
v_mfma_f32_16x16x32_bf16 v[124:127], a[60:63], a[132:135], v[124:127]
s_waitcnt lgkmcnt(2)
v_mfma_f32_16x16x32_bf16 v[128:131], a[0:3], a[136:139], v[128:131]
ds_read_b64_tr_b16 a[128:129], v8 offset:0
v_mfma_f32_16x16x32_bf16 v[128:131], a[4:7], a[140:143], v[128:131]
buffer_load_dword v21, v20, s[16:19], s43 offen
v_mfma_f32_16x16x32_bf16 v[132:135], a[8:11], a[136:139], v[132:135]
s_add_u32 s43, s43, s47
ds_read_b64_tr_b16 a[130:131], v8 offset:2048
v_mfma_f32_16x16x32_bf16 v[132:135], a[12:15], a[140:143], v[132:135]
s_cmp_ge_u32 s43, s51
v_mfma_f32_16x16x32_bf16 v[136:139], a[16:19], a[136:139], v[136:139]
s_cselect_b32 s43, 0, s43
ds_read_b64_tr_b16 a[132:133], v8 offset:16384
v_mfma_f32_16x16x32_bf16 v[136:139], a[20:23], a[140:143], v[136:139]
s_cselect_b32 s51, s42, s51
v_mfma_f32_16x16x32_bf16 v[140:143], a[24:27], a[136:139], v[140:143]
s_cselect_b64 s[16:17], s[40:41], s[16:17]
ds_read_b64_tr_b16 a[134:135], v8 offset:18432
v_mfma_f32_16x16x32_bf16 v[140:143], a[28:31], a[140:143], v[140:143]
s_cselect_b32 s18, s42, s18
v_mfma_f32_16x16x32_bf16 v[144:147], a[32:35], a[136:139], v[144:147]
s_cselect_b64 s[40:41], s[44:45], s[40:41]
ds_read_b128 a[96:99], v2 offset:40960
v_mfma_f32_16x16x32_bf16 v[144:147], a[36:39], a[140:143], v[144:147]
s_cselect_b32 s42, s46, s42
v_mfma_f32_16x16x32_bf16 v[148:151], a[40:43], a[136:139], v[148:151]
s_cselect_b32 s46, 0, s46
v_mfma_f32_16x16x32_bf16 v[148:151], a[44:47], a[140:143], v[148:151]
s_cmp_eq_u32 s30, s55
v_mfma_f32_16x16x32_bf16 v[152:155], a[48:51], a[136:139], v[152:155]
s_cselect_b32 s22, 0, 3221225472
ds_read_b128 a[100:103], v3 offset:40960
v_mfma_f32_16x16x32_bf16 v[152:155], a[52:55], a[140:143], v[152:155]
s_sub_u32 s30, s30, 1
buffer_atomic_add v27, v26, s[60:63], s22 offen sc1
v_mfma_f32_16x16x32_bf16 v[156:159], a[56:59], a[136:139], v[156:159]
ds_read_b128 a[104:107], v2 offset:43008
v_mfma_f32_16x16x32_bf16 v[156:159], a[60:63], a[140:143], v[156:159]
s_waitcnt lgkmcnt(3)
v_mfma_f32_16x16x32_bf16 v[160:163], a[0:3], a[128:131], v[160:163]
ds_read_b64_tr_b16 a[136:137], v9 offset:0
v_mfma_f32_16x16x32_bf16 v[160:163], a[4:7], a[132:135], v[160:163]
v_mfma_f32_16x16x32_bf16 v[164:167], a[8:11], a[128:131], v[164:167]
ds_read_b64_tr_b16 a[138:139], v9 offset:2048
v_mfma_f32_16x16x32_bf16 v[164:167], a[12:15], a[132:135], v[164:167]
v_mfma_f32_16x16x32_bf16 v[168:171], a[16:19], a[128:131], v[168:171]
ds_read_b64_tr_b16 a[140:141], v9 offset:16384
v_mfma_f32_16x16x32_bf16 v[168:171], a[20:23], a[132:135], v[168:171]
v_mfma_f32_16x16x32_bf16 v[172:175], a[24:27], a[128:131], v[172:175]
ds_read_b64_tr_b16 a[142:143], v9 offset:18432
v_mfma_f32_16x16x32_bf16 v[172:175], a[28:31], a[132:135], v[172:175]
v_mfma_f32_16x16x32_bf16 v[176:179], a[32:35], a[128:131], v[176:179]
v_mfma_f32_16x16x32_bf16 v[176:179], a[36:39], a[132:135], v[176:179]
v_mfma_f32_16x16x32_bf16 v[180:183], a[40:43], a[128:131], v[180:183]
ds_read_b128 a[108:111], v3 offset:43008
v_mfma_f32_16x16x32_bf16 v[180:183], a[44:47], a[132:135], v[180:183]
v_mfma_f32_16x16x32_bf16 v[184:187], a[48:51], a[128:131], v[184:187]
ds_read_b128 a[112:115], v2 offset:45056
v_mfma_f32_16x16x32_bf16 v[184:187], a[52:55], a[132:135], v[184:187]
v_mfma_f32_16x16x32_bf16 v[188:191], a[56:59], a[128:131], v[188:191]
v_mfma_f32_16x16x32_bf16 v[188:191], a[60:63], a[132:135], v[188:191]
s_waitcnt lgkmcnt(2)
v_mfma_f32_16x16x32_bf16 v[192:195], a[0:3], a[136:139], v[192:195]
ds_read_b64_tr_b16 a[128:129], v10 offset:0
v_mfma_f32_16x16x32_bf16 v[192:195], a[4:7], a[140:143], v[192:195]
v_mfma_f32_16x16x32_bf16 v[196:199], a[8:11], a[136:139], v[196:199]
ds_read_b64_tr_b16 a[130:131], v10 offset:2048
v_mfma_f32_16x16x32_bf16 v[196:199], a[12:15], a[140:143], v[196:199]
v_mfma_f32_16x16x32_bf16 v[200:203], a[16:19], a[136:139], v[200:203]
ds_read_b64_tr_b16 a[132:133], v10 offset:16384
v_mfma_f32_16x16x32_bf16 v[200:203], a[20:23], a[140:143], v[200:203]
v_mfma_f32_16x16x32_bf16 v[204:207], a[24:27], a[136:139], v[204:207]
ds_read_b64_tr_b16 a[134:135], v10 offset:18432
v_mfma_f32_16x16x32_bf16 v[204:207], a[28:31], a[140:143], v[204:207]
v_mfma_f32_16x16x32_bf16 v[208:211], a[32:35], a[136:139], v[208:211]
ds_read_b128 a[116:119], v3 offset:45056
v_mfma_f32_16x16x32_bf16 v[208:211], a[36:39], a[140:143], v[208:211]
v_mfma_f32_16x16x32_bf16 v[212:215], a[40:43], a[136:139], v[212:215]
ds_read_b128 a[120:123], v2 offset:47104
v_mfma_f32_16x16x32_bf16 v[212:215], a[44:47], a[140:143], v[212:215]
v_mfma_f32_16x16x32_bf16 v[216:219], a[48:51], a[136:139], v[216:219]
v_mfma_f32_16x16x32_bf16 v[216:219], a[52:55], a[140:143], v[216:219]
v_mfma_f32_16x16x32_bf16 v[220:223], a[56:59], a[136:139], v[220:223]
ds_read_b128 a[124:127], v3 offset:47104
v_mfma_f32_16x16x32_bf16 v[220:223], a[60:63], a[140:143], v[220:223]
s_waitcnt lgkmcnt(3)
v_mfma_f32_16x16x32_bf16 a[192:195], a[0:3], a[128:131], a[192:195]
ds_read_b64_tr_b16 a[136:137], v11 offset:0
v_mfma_f32_16x16x32_bf16 a[192:195], a[4:7], a[132:135], a[192:195]
v_mfma_f32_16x16x32_bf16 a[196:199], a[8:11], a[128:131], a[196:199]
ds_read_b64_tr_b16 a[138:139], v11 offset:2048
v_mfma_f32_16x16x32_bf16 a[196:199], a[12:15], a[132:135], a[196:199]
v_mfma_f32_16x16x32_bf16 a[200:203], a[16:19], a[128:131], a[200:203]
ds_read_b64_tr_b16 a[140:141], v11 offset:16384
v_mfma_f32_16x16x32_bf16 a[200:203], a[20:23], a[132:135], a[200:203]
v_mfma_f32_16x16x32_bf16 a[204:207], a[24:27], a[128:131], a[204:207]
ds_read_b64_tr_b16 a[142:143], v11 offset:18432
v_mfma_f32_16x16x32_bf16 a[204:207], a[28:31], a[132:135], a[204:207]
v_mfma_f32_16x16x32_bf16 a[208:211], a[32:35], a[128:131], a[208:211]
v_mfma_f32_16x16x32_bf16 a[208:211], a[36:39], a[132:135], a[208:211]
v_mfma_f32_16x16x32_bf16 a[212:215], a[40:43], a[128:131], a[212:215]
v_mfma_f32_16x16x32_bf16 a[212:215], a[44:47], a[132:135], a[212:215]
v_mfma_f32_16x16x32_bf16 a[216:219], a[48:51], a[128:131], a[216:219]
v_mfma_f32_16x16x32_bf16 a[216:219], a[52:55], a[132:135], a[216:219]
v_mfma_f32_16x16x32_bf16 a[220:223], a[56:59], a[128:131], a[220:223]
s_waitcnt vmcnt(2) lgkmcnt(0)
v_mfma_f32_16x16x32_bf16 a[220:223], a[60:63], a[132:135], a[220:223]
s_barrier
v_mfma_f32_16x16x32_bf16 a[224:227], a[0:3], a[136:139], a[224:227]
s_add_u32 m0, s29, 65536
ds_read_b64_tr_b16 a[128:129], v4 offset:32768
v_mfma_f32_16x16x32_bf16 a[224:227], a[4:7], a[140:143], a[224:227]
buffer_load_dwordx4 v16, s[12:15], s26 offen offset:0 lds
v_mfma_f32_16x16x32_bf16 a[228:231], a[8:11], a[136:139], a[228:231]
ds_read_b64_tr_b16 a[130:131], v4 offset:34816
v_mfma_f32_16x16x32_bf16 a[228:231], a[12:15], a[140:143], a[228:231]
v_mfma_f32_16x16x32_bf16 a[232:235], a[16:19], a[136:139], a[232:235]
ds_read_b64_tr_b16 a[132:133], v4 offset:49152
v_mfma_f32_16x16x32_bf16 a[232:235], a[20:23], a[140:143], a[232:235]
buffer_load_dwordx4 v17, s[12:15], s26 offen offset:1024 lds
v_mfma_f32_16x16x32_bf16 a[236:239], a[24:27], a[136:139], a[236:239]
ds_read_b64_tr_b16 a[134:135], v4 offset:51200
v_mfma_f32_16x16x32_bf16 a[236:239], a[28:31], a[140:143], a[236:239]
v_mfma_f32_16x16x32_bf16 a[240:243], a[32:35], a[136:139], a[240:243]
v_mfma_f32_16x16x32_bf16 a[240:243], a[36:39], a[140:143], a[240:243]
buffer_load_dwordx4 v18, s[12:15], s26 offen offset:2048 lds
v_mfma_f32_16x16x32_bf16 a[244:247], a[40:43], a[136:139], a[244:247]
v_mfma_f32_16x16x32_bf16 a[244:247], a[44:47], a[140:143], a[244:247]
v_mfma_f32_16x16x32_bf16 a[248:251], a[48:51], a[136:139], a[248:251]
v_mfma_f32_16x16x32_bf16 a[248:251], a[52:55], a[140:143], a[248:251]
s_waitcnt lgkmcnt(0)
buffer_load_dwordx4 v19, s[12:15], s26 offen offset:3072 lds
v_mfma_f32_16x16x32_bf16 a[252:255], a[56:59], a[136:139], a[252:255]
s_add_u32 s26, s26, 524288
s_bitcmp1_b32 s30, 1
v_mfma_f32_16x16x32_bf16 a[252:255], a[60:63], a[140:143], a[252:255]
s_cbranch_scc1 Lg_501
s_cmp_eq_u32 s30, 0
s_cbranch_scc1 Lg_501t
v_mfma_f32_16x16x32_bf16 v[32:35], a[64:67], a[128:131], v[32:35]
s_add_u32 m0, s29, 81920
ds_read_b64_tr_b16 a[136:137], v5 offset:32768
v_mfma_f32_16x16x32_bf16 v[32:35], a[68:71], a[132:135], v[32:35]
buffer_load_dwordx4 v16, s[12:15], s27 offen offset:0 lds
v_mfma_f32_16x16x32_bf16 v[36:39], a[72:75], a[128:131], v[36:39]
s_lshl_b32 s22, s38, 3
ds_read_b64_tr_b16 a[138:139], v5 offset:34816
v_mfma_f32_16x16x32_bf16 v[36:39], a[76:79], a[132:135], v[36:39]
s_lshl_b32 s23, s39, 5
v_and_b32 v252, 31, v0
v_lshrrev_b32 v253, 5, v0
v_mfma_f32_16x16x32_bf16 v[40:43], a[80:83], a[128:131], v[40:43]
ds_read_b64_tr_b16 a[140:141], v5 offset:49152
v_add_u32 v253, s22, v253
v_mfma_f32_16x16x32_bf16 v[40:43], a[84:87], a[132:135], v[40:43]
buffer_load_dwordx4 v17, s[12:15], s27 offen offset:1024 lds
v_mfma_f32_16x16x32_bf16 v[44:47], a[88:91], a[128:131], v[44:47]
ds_read_b64_tr_b16 a[142:143], v5 offset:51200
v_add_u32 v252, s23, v252
v_mfma_f32_16x16x32_bf16 v[44:47], a[92:95], a[132:135], v[44:47]
v_mul_u32_u24 v254, 7168, v253
v_lshl_add_u32 v254, v252, 2, v254
v_mfma_f32_16x16x32_bf16 v[48:51], a[96:99], a[128:131], v[48:51]
ds_read_b128 a[0:3], v2 offset:0
v_lshlrev_b32 v252, 4, v252
v_mfma_f32_16x16x32_bf16 v[48:51], a[100:103], a[132:135], v[48:51]
buffer_load_dwordx4 v18, s[12:15], s27 offen offset:2048 lds
v_mfma_f32_16x16x32_bf16 v[52:55], a[104:107], a[128:131], v[52:55]
ds_read_b128 a[4:7], v3 offset:0
v_add_u32 v255, 3584, v254
v_mfma_f32_16x16x32_bf16 v[52:55], a[108:111], a[132:135], v[52:55]
v_subrev_u32 v22, 3584, v254
v_subrev_u32 v23, 2688, v254
v_mfma_f32_16x16x32_bf16 v[56:59], a[112:115], a[128:131], v[56:59]
v_subrev_u32 v24, 1792, v254
v_subrev_u32 v25, 896, v254
v_mfma_f32_16x16x32_bf16 v[56:59], a[116:119], a[132:135], v[56:59]
buffer_load_dwordx4 v19, s[12:15], s27 offen offset:3072 lds
v_mfma_f32_16x16x32_bf16 v[60:63], a[120:123], a[128:131], v[60:63]
s_add_u32 s27, s27, 524288
ds_read_b128 a[8:11], v2 offset:2048
v_mfma_f32_16x16x32_bf16 v[60:63], a[124:127], a[132:135], v[60:63]
s_waitcnt lgkmcnt(3)
v_mfma_f32_16x16x32_bf16 v[64:67], a[64:67], a[136:139], v[64:67]
s_add_u32 m0, s28, 32768
ds_read_b64_tr_b16 a[128:129], v6 offset:32768
v_mfma_f32_16x16x32_bf16 v[64:67], a[68:71], a[140:143], v[64:67]
buffer_load_dwordx4 v12, s[8:11], s24 offen offset:0 lds
v_mfma_f32_16x16x32_bf16 v[68:71], a[72:75], a[136:139], v[68:71]
ds_read_b64_tr_b16 a[130:131], v6 offset:34816
v_mfma_f32_16x16x32_bf16 v[68:71], a[76:79], a[140:143], v[68:71]
v_mfma_f32_16x16x32_bf16 v[72:75], a[80:83], a[136:139], v[72:75]
ds_read_b64_tr_b16 a[132:133], v6 offset:49152
v_mfma_f32_16x16x32_bf16 v[72:75], a[84:87], a[140:143], v[72:75]
buffer_load_dwordx4 v13, s[8:11], s24 offen offset:1024 lds
v_mfma_f32_16x16x32_bf16 v[76:79], a[88:91], a[136:139], v[76:79]
ds_read_b64_tr_b16 a[134:135], v6 offset:51200
v_mfma_f32_16x16x32_bf16 v[76:79], a[92:95], a[140:143], v[76:79]
v_mfma_f32_16x16x32_bf16 v[80:83], a[96:99], a[136:139], v[80:83]
ds_read_b128 a[12:15], v3 offset:2048
v_mfma_f32_16x16x32_bf16 v[80:83], a[100:103], a[140:143], v[80:83]
buffer_load_dwordx4 v14, s[8:11], s24 offen offset:2048 lds
v_mfma_f32_16x16x32_bf16 v[84:87], a[104:107], a[136:139], v[84:87]
v_mfma_f32_16x16x32_bf16 v[84:87], a[108:111], a[140:143], v[84:87]
v_mfma_f32_16x16x32_bf16 v[88:91], a[112:115], a[136:139], v[88:91]
ds_read_b128 a[16:19], v2 offset:4096
v_mfma_f32_16x16x32_bf16 v[88:91], a[116:119], a[140:143], v[88:91]
buffer_load_dwordx4 v15, s[8:11], s24 offen offset:3072 lds
v_mfma_f32_16x16x32_bf16 v[92:95], a[120:123], a[136:139], v[92:95]
s_add_u32 s24, s24, 128
ds_read_b128 a[20:23], v3 offset:4096
v_mfma_f32_16x16x32_bf16 v[92:95], a[124:127], a[140:143], v[92:95]
s_waitcnt lgkmcnt(3)
v_mfma_f32_16x16x32_bf16 v[96:99], a[64:67], a[128:131], v[96:99]
s_add_u32 m0, s28, 36864
ds_read_b64_tr_b16 a[136:137], v7 offset:32768
v_mfma_f32_16x16x32_bf16 v[96:99], a[68:71], a[132:135], v[96:99]
buffer_load_dwordx4 v12, s[8:11], s25 offen offset:0 lds
v_mfma_f32_16x16x32_bf16 v[100:103], a[72:75], a[128:131], v[100:103]
ds_read_b64_tr_b16 a[138:139], v7 offset:34816
v_mfma_f32_16x16x32_bf16 v[100:103], a[76:79], a[132:135], v[100:103]
PAD_23:
s_cbranch_execz PAD_27
v_mfma_f32_16x16x32_bf16 v[104:107], a[80:83], a[128:131], v[104:107]
ds_read_b64_tr_b16 a[140:141], v7 offset:49152
v_mfma_f32_16x16x32_bf16 v[104:107], a[84:87], a[132:135], v[104:107]
buffer_load_dwordx4 v13, s[8:11], s25 offen offset:1024 lds
v_mfma_f32_16x16x32_bf16 v[108:111], a[88:91], a[128:131], v[108:111]
ds_read_b64_tr_b16 a[142:143], v7 offset:51200
v_mfma_f32_16x16x32_bf16 v[108:111], a[92:95], a[132:135], v[108:111]
v_mfma_f32_16x16x32_bf16 v[112:115], a[96:99], a[128:131], v[112:115]
v_mfma_f32_16x16x32_bf16 v[112:115], a[100:103], a[132:135], v[112:115]
buffer_load_dwordx4 v14, s[8:11], s25 offen offset:2048 lds
v_mfma_f32_16x16x32_bf16 v[116:119], a[104:107], a[128:131], v[116:119]
ds_read_b128 a[24:27], v2 offset:6144
v_mfma_f32_16x16x32_bf16 v[116:119], a[108:111], a[132:135], v[116:119]
v_mfma_f32_16x16x32_bf16 v[120:123], a[112:115], a[128:131], v[120:123]
ds_read_b128 a[28:31], v3 offset:6144
v_mfma_f32_16x16x32_bf16 v[120:123], a[116:119], a[132:135], v[120:123]
buffer_load_dwordx4 v15, s[8:11], s25 offen offset:3072 lds
v_mfma_f32_16x16x32_bf16 v[124:127], a[120:123], a[128:131], v[124:127]
s_add_u32 s25, s25, 128
v_mfma_f32_16x16x32_bf16 v[124:127], a[124:127], a[132:135], v[124:127]
s_waitcnt lgkmcnt(2)
v_mfma_f32_16x16x32_bf16 v[128:131], a[64:67], a[136:139], v[128:131]
s_mov_b64 s[56:57], s[70:71]
s_mov_b32 s58, 3584
s_mov_b32 s59, 0x20000
ds_read_b64_tr_b16 a[128:129], v8 offset:32768
v_mfma_f32_16x16x32_bf16 v[128:131], a[68:71], a[140:143], v[128:131]
buffer_load_dwordx4 v[248:251], v252, s[56:59], 0 offen
v_mfma_f32_16x16x32_bf16 v[132:135], a[72:75], a[136:139], v[132:135]
s_mov_b64 s[56:57], s[66:67]
s_mov_b32 s58, 1835008
ds_read_b64_tr_b16 a[130:131], v8 offset:34816
v_mfma_f32_16x16x32_bf16 v[132:135], a[76:79], a[140:143], v[132:135]
buffer_load_dword v224, v22, s[56:59], 0 offen nt
v_mfma_f32_16x16x32_bf16 v[136:139], a[80:83], a[136:139], v[136:139]
ds_read_b64_tr_b16 a[132:133], v8 offset:49152
v_mfma_f32_16x16x32_bf16 v[136:139], a[84:87], a[140:143], v[136:139]
buffer_load_dword v225, v23, s[56:59], 0 offen nt
v_mfma_f32_16x16x32_bf16 v[140:143], a[88:91], a[136:139], v[140:143]
ds_read_b64_tr_b16 a[134:135], v8 offset:51200
v_mfma_f32_16x16x32_bf16 v[140:143], a[92:95], a[140:143], v[140:143]
buffer_load_dword v226, v24, s[56:59], 0 offen nt
v_mfma_f32_16x16x32_bf16 v[144:147], a[96:99], a[136:139], v[144:147]
ds_read_b128 a[32:35], v2 offset:8192
v_mfma_f32_16x16x32_bf16 v[144:147], a[100:103], a[140:143], v[144:147]
buffer_load_dword v227, v25, s[56:59], 0 offen nt
v_mfma_f32_16x16x32_bf16 v[148:151], a[104:107], a[136:139], v[148:151]
buffer_load_dword v228, v254, s[56:59], 0 offen offset:0 nt
v_mfma_f32_16x16x32_bf16 v[148:151], a[108:111], a[140:143], v[148:151]
buffer_load_dword v229, v254, s[56:59], 0 offen offset:896 nt
v_mfma_f32_16x16x32_bf16 v[152:155], a[112:115], a[136:139], v[152:155]
ds_read_b128 a[36:39], v3 offset:8192
v_mfma_f32_16x16x32_bf16 v[152:155], a[116:119], a[140:143], v[152:155]
buffer_load_dword v230, v254, s[56:59], 0 offen offset:1792 nt
v_mfma_f32_16x16x32_bf16 v[156:159], a[120:123], a[136:139], v[156:159]
ds_read_b128 a[40:43], v2 offset:10240
v_mfma_f32_16x16x32_bf16 v[156:159], a[124:127], a[140:143], v[156:159]
s_waitcnt lgkmcnt(3)
buffer_load_dword v231, v254, s[56:59], 0 offen offset:2688 nt
v_mfma_f32_16x16x32_bf16 v[160:163], a[64:67], a[128:131], v[160:163]
ds_read_b64_tr_b16 a[136:137], v9 offset:32768
v_mfma_f32_16x16x32_bf16 v[160:163], a[68:71], a[132:135], v[160:163]
buffer_load_dword v232, v255, s[56:59], 0 offen offset:0 nt
v_mfma_f32_16x16x32_bf16 v[164:167], a[72:75], a[128:131], v[164:167]
ds_read_b64_tr_b16 a[138:139], v9 offset:34816
v_mfma_f32_16x16x32_bf16 v[164:167], a[76:79], a[132:135], v[164:167]
buffer_load_dword v233, v255, s[56:59], 0 offen offset:896 nt
v_mfma_f32_16x16x32_bf16 v[168:171], a[80:83], a[128:131], v[168:171]
ds_read_b64_tr_b16 a[140:141], v9 offset:49152
v_mfma_f32_16x16x32_bf16 v[168:171], a[84:87], a[132:135], v[168:171]
buffer_load_dword v234, v255, s[56:59], 0 offen offset:1792 nt
v_mfma_f32_16x16x32_bf16 v[172:175], a[88:91], a[128:131], v[172:175]
ds_read_b64_tr_b16 a[142:143], v9 offset:51200
v_mfma_f32_16x16x32_bf16 v[172:175], a[92:95], a[132:135], v[172:175]
buffer_load_dword v235, v255, s[56:59], 0 offen offset:2688 nt
v_mfma_f32_16x16x32_bf16 v[176:179], a[96:99], a[128:131], v[176:179]
s_mov_b64 s[56:57], s[68:69]
buffer_load_dword v236, v25, s[56:59], 0 offen nt
v_mfma_f32_16x16x32_bf16 v[176:179], a[100:103], a[132:135], v[176:179]
buffer_load_dword v237, v254, s[56:59], 0 offen offset:0 nt
v_mfma_f32_16x16x32_bf16 v[180:183], a[104:107], a[128:131], v[180:183]
ds_read_b128 a[44:47], v3 offset:10240
v_mfma_f32_16x16x32_bf16 v[180:183], a[108:111], a[132:135], v[180:183]
buffer_load_dword v238, v254, s[56:59], 0 offen offset:896 nt
v_mfma_f32_16x16x32_bf16 v[184:187], a[112:115], a[128:131], v[184:187]
ds_read_b128 a[48:51], v2 offset:12288
v_mfma_f32_16x16x32_bf16 v[184:187], a[116:119], a[132:135], v[184:187]
buffer_load_dword v239, v254, s[56:59], 0 offen offset:1792 nt
v_mfma_f32_16x16x32_bf16 v[188:191], a[120:123], a[128:131], v[188:191]
buffer_load_dword v240, v254, s[56:59], 0 offen offset:2688 nt
v_mfma_f32_16x16x32_bf16 v[188:191], a[124:127], a[132:135], v[188:191]
s_waitcnt lgkmcnt(2)
buffer_load_dword v241, v255, s[56:59], 0 offen offset:0 nt
v_mfma_f32_16x16x32_bf16 v[192:195], a[64:67], a[136:139], v[192:195]
ds_read_b64_tr_b16 a[128:129], v10 offset:32768
v_mfma_f32_16x16x32_bf16 v[192:195], a[68:71], a[140:143], v[192:195]
buffer_load_dword v242, v255, s[56:59], 0 offen offset:896 nt
v_mfma_f32_16x16x32_bf16 v[196:199], a[72:75], a[136:139], v[196:199]
ds_read_b64_tr_b16 a[130:131], v10 offset:34816
v_mfma_f32_16x16x32_bf16 v[196:199], a[76:79], a[140:143], v[196:199]
buffer_load_dword v243, v255, s[56:59], 0 offen offset:1792 nt
v_mfma_f32_16x16x32_bf16 v[200:203], a[80:83], a[136:139], v[200:203]
ds_read_b64_tr_b16 a[132:133], v10 offset:49152
v_mfma_f32_16x16x32_bf16 v[200:203], a[84:87], a[140:143], v[200:203]
buffer_load_dword v244, v255, s[56:59], 0 offen offset:2688 nt
v_mfma_f32_16x16x32_bf16 v[204:207], a[88:91], a[136:139], v[204:207]
ds_read_b64_tr_b16 a[134:135], v10 offset:51200
v_mfma_f32_16x16x32_bf16 v[204:207], a[92:95], a[140:143], v[204:207]
v_mfma_f32_16x16x32_bf16 v[208:211], a[96:99], a[136:139], v[208:211]
ds_read_b128 a[52:55], v3 offset:12288
v_mfma_f32_16x16x32_bf16 v[208:211], a[100:103], a[140:143], v[208:211]
v_mfma_f32_16x16x32_bf16 v[212:215], a[104:107], a[136:139], v[212:215]
ds_read_b128 a[56:59], v2 offset:14336
v_mfma_f32_16x16x32_bf16 v[212:215], a[108:111], a[140:143], v[212:215]
v_mfma_f32_16x16x32_bf16 v[216:219], a[112:115], a[136:139], v[216:219]
v_mfma_f32_16x16x32_bf16 v[216:219], a[116:119], a[140:143], v[216:219]
v_mfma_f32_16x16x32_bf16 v[220:223], a[120:123], a[136:139], v[220:223]
ds_read_b128 a[60:63], v3 offset:14336
v_mfma_f32_16x16x32_bf16 v[220:223], a[124:127], a[140:143], v[220:223]
s_waitcnt lgkmcnt(3)
v_mfma_f32_16x16x32_bf16 a[192:195], a[64:67], a[128:131], a[192:195]
ds_read_b64_tr_b16 a[136:137], v11 offset:32768
v_mfma_f32_16x16x32_bf16 a[192:195], a[68:71], a[132:135], a[192:195]
v_mfma_f32_16x16x32_bf16 a[196:199], a[72:75], a[128:131], a[196:199]
ds_read_b64_tr_b16 a[138:139], v11 offset:34816
v_mfma_f32_16x16x32_bf16 a[196:199], a[76:79], a[132:135], a[196:199]
v_mfma_f32_16x16x32_bf16 a[200:203], a[80:83], a[128:131], a[200:203]
ds_read_b64_tr_b16 a[140:141], v11 offset:49152
v_mfma_f32_16x16x32_bf16 a[200:203], a[84:87], a[132:135], a[200:203]
v_mfma_f32_16x16x32_bf16 a[204:207], a[88:91], a[128:131], a[204:207]
ds_read_b64_tr_b16 a[142:143], v11 offset:51200
v_mfma_f32_16x16x32_bf16 a[204:207], a[92:95], a[132:135], a[204:207]
v_mfma_f32_16x16x32_bf16 a[208:211], a[96:99], a[128:131], a[208:211]
v_mfma_f32_16x16x32_bf16 a[208:211], a[100:103], a[132:135], a[208:211]
v_mfma_f32_16x16x32_bf16 a[212:215], a[104:107], a[128:131], a[212:215]
v_mfma_f32_16x16x32_bf16 a[212:215], a[108:111], a[132:135], a[212:215]
v_mfma_f32_16x16x32_bf16 a[216:219], a[112:115], a[128:131], a[216:219]
v_mfma_f32_16x16x32_bf16 a[216:219], a[116:119], a[132:135], a[216:219]
v_mfma_f32_16x16x32_bf16 a[220:223], a[120:123], a[128:131], a[220:223]
s_waitcnt vmcnt(22) lgkmcnt(0)
v_mfma_f32_16x16x32_bf16 a[220:223], a[124:127], a[132:135], a[220:223]
s_barrier
v_mfma_f32_16x16x32_bf16 a[224:227], a[64:67], a[136:139], a[224:227]
s_add_u32 m0, s29, 98304
ds_read_b64_tr_b16 a[128:129], v4 offset:0
v_mfma_f32_16x16x32_bf16 a[224:227], a[68:71], a[140:143], a[224:227]
buffer_load_dwordx4 v16, s[12:15], s26 offen offset:0 lds
v_mfma_f32_16x16x32_bf16 a[228:231], a[72:75], a[136:139], a[228:231]
ds_read_b64_tr_b16 a[130:131], v4 offset:2048
v_mfma_f32_16x16x32_bf16 a[228:231], a[76:79], a[140:143], a[228:231]
v_mfma_f32_16x16x32_bf16 a[232:235], a[80:83], a[136:139], a[232:235]
ds_read_b64_tr_b16 a[132:133], v4 offset:16384
v_mfma_f32_16x16x32_bf16 a[232:235], a[84:87], a[140:143], a[232:235]
buffer_load_dwordx4 v17, s[12:15], s26 offen offset:1024 lds
v_mfma_f32_16x16x32_bf16 a[236:239], a[88:91], a[136:139], a[236:239]
ds_read_b64_tr_b16 a[134:135], v4 offset:18432
v_mfma_f32_16x16x32_bf16 a[236:239], a[92:95], a[140:143], a[236:239]
v_mfma_f32_16x16x32_bf16 a[240:243], a[96:99], a[136:139], a[240:243]
v_mfma_f32_16x16x32_bf16 a[240:243], a[100:103], a[140:143], a[240:243]
buffer_load_dwordx4 v18, s[12:15], s26 offen offset:2048 lds
v_mfma_f32_16x16x32_bf16 a[244:247], a[104:107], a[136:139], a[244:247]
v_mfma_f32_16x16x32_bf16 a[244:247], a[108:111], a[140:143], a[244:247]
v_mfma_f32_16x16x32_bf16 a[248:251], a[112:115], a[136:139], a[248:251]
v_mfma_f32_16x16x32_bf16 a[248:251], a[116:119], a[140:143], a[248:251]
buffer_load_dwordx4 v19, s[12:15], s26 offen offset:3072 lds
v_mfma_f32_16x16x32_bf16 a[252:255], a[120:123], a[136:139], a[252:255]
s_add_u32 s26, s26, 524288
v_mfma_f32_16x16x32_bf16 a[252:255], a[124:127], a[140:143], a[252:255]
s_waitcnt lgkmcnt(0)
v_mfma_f32_16x16x32_bf16 v[32:35], a[0:3], a[128:131], v[32:35]
s_add_u32 m0, s29, 114688
ds_read_b64_tr_b16 a[136:137], v5 offset:0
v_mfma_f32_16x16x32_bf16 v[32:35], a[4:7], a[132:135], v[32:35]
buffer_load_dwordx4 v16, s[12:15], s27 offen offset:0 lds
v_mfma_f32_16x16x32_bf16 v[36:39], a[8:11], a[128:131], v[36:39]
ds_read_b64_tr_b16 a[138:139], v5 offset:2048
v_mfma_f32_16x16x32_bf16 v[36:39], a[12:15], a[132:135], v[36:39]
v_mfma_f32_16x16x32_bf16 v[40:43], a[16:19], a[128:131], v[40:43]
ds_read_b64_tr_b16 a[140:141], v5 offset:16384
v_mfma_f32_16x16x32_bf16 v[40:43], a[20:23], a[132:135], v[40:43]
buffer_load_dwordx4 v17, s[12:15], s27 offen offset:1024 lds
v_mfma_f32_16x16x32_bf16 v[44:47], a[24:27], a[128:131], v[44:47]
ds_read_b64_tr_b16 a[142:143], v5 offset:18432
v_mfma_f32_16x16x32_bf16 v[44:47], a[28:31], a[132:135], v[44:47]
v_mfma_f32_16x16x32_bf16 v[48:51], a[32:35], a[128:131], v[48:51]
ds_read_b128 a[64:67], v2 offset:32768
v_mfma_f32_16x16x32_bf16 v[48:51], a[36:39], a[132:135], v[48:51]
buffer_load_dwordx4 v18, s[12:15], s27 offen offset:2048 lds
v_mfma_f32_16x16x32_bf16 v[52:55], a[40:43], a[128:131], v[52:55]
ds_read_b128 a[68:71], v3 offset:32768
v_mfma_f32_16x16x32_bf16 v[52:55], a[44:47], a[132:135], v[52:55]
v_mfma_f32_16x16x32_bf16 v[56:59], a[48:51], a[128:131], v[56:59]
v_mfma_f32_16x16x32_bf16 v[56:59], a[52:55], a[132:135], v[56:59]
buffer_load_dwordx4 v19, s[12:15], s27 offen offset:3072 lds
v_mfma_f32_16x16x32_bf16 v[60:63], a[56:59], a[128:131], v[60:63]
s_add_u32 s27, s27, 524288
ds_read_b128 a[72:75], v2 offset:34816
v_mfma_f32_16x16x32_bf16 v[60:63], a[60:63], a[132:135], v[60:63]
s_waitcnt lgkmcnt(3)
v_mfma_f32_16x16x32_bf16 v[64:67], a[0:3], a[136:139], v[64:67]
s_add_u32 m0, s28, 0
ds_read_b64_tr_b16 a[128:129], v6 offset:0
v_mfma_f32_16x16x32_bf16 v[64:67], a[4:7], a[140:143], v[64:67]
buffer_load_dwordx4 v12, s[8:11], s24 offen offset:0 lds
v_mfma_f32_16x16x32_bf16 v[68:71], a[8:11], a[136:139], v[68:71]
ds_read_b64_tr_b16 a[130:131], v6 offset:2048
v_mfma_f32_16x16x32_bf16 v[68:71], a[12:15], a[140:143], v[68:71]
v_mfma_f32_16x16x32_bf16 v[72:75], a[16:19], a[136:139], v[72:75]
ds_read_b64_tr_b16 a[132:133], v6 offset:16384
v_mfma_f32_16x16x32_bf16 v[72:75], a[20:23], a[140:143], v[72:75]
buffer_load_dwordx4 v13, s[8:11], s24 offen offset:1024 lds
v_mfma_f32_16x16x32_bf16 v[76:79], a[24:27], a[136:139], v[76:79]
ds_read_b64_tr_b16 a[134:135], v6 offset:18432
v_mfma_f32_16x16x32_bf16 v[76:79], a[28:31], a[140:143], v[76:79]
v_mfma_f32_16x16x32_bf16 v[80:83], a[32:35], a[136:139], v[80:83]
ds_read_b128 a[76:79], v3 offset:34816
v_mfma_f32_16x16x32_bf16 v[80:83], a[36:39], a[140:143], v[80:83]
buffer_load_dwordx4 v14, s[8:11], s24 offen offset:2048 lds
v_mfma_f32_16x16x32_bf16 v[84:87], a[40:43], a[136:139], v[84:87]
v_mfma_f32_16x16x32_bf16 v[84:87], a[44:47], a[140:143], v[84:87]
v_mfma_f32_16x16x32_bf16 v[88:91], a[48:51], a[136:139], v[88:91]
ds_read_b128 a[80:83], v2 offset:36864
v_mfma_f32_16x16x32_bf16 v[88:91], a[52:55], a[140:143], v[88:91]
buffer_load_dwordx4 v15, s[8:11], s24 offen offset:3072 lds
v_mfma_f32_16x16x32_bf16 v[92:95], a[56:59], a[136:139], v[92:95]
s_add_u32 s24, s24, 128
ds_read_b128 a[84:87], v3 offset:36864
v_mfma_f32_16x16x32_bf16 v[92:95], a[60:63], a[140:143], v[92:95]
s_waitcnt lgkmcnt(3)
v_mfma_f32_16x16x32_bf16 v[96:99], a[0:3], a[128:131], v[96:99]
s_add_u32 m0, s28, 4096
ds_read_b64_tr_b16 a[136:137], v7 offset:0
v_mfma_f32_16x16x32_bf16 v[96:99], a[4:7], a[132:135], v[96:99]
buffer_load_dwordx4 v12, s[8:11], s25 offen offset:0 lds
v_mfma_f32_16x16x32_bf16 v[100:103], a[8:11], a[128:131], v[100:103]
ds_read_b64_tr_b16 a[138:139], v7 offset:2048
v_mfma_f32_16x16x32_bf16 v[100:103], a[12:15], a[132:135], v[100:103]
v_mfma_f32_16x16x32_bf16 v[104:107], a[16:19], a[128:131], v[104:107]
ds_read_b64_tr_b16 a[140:141], v7 offset:16384
v_mfma_f32_16x16x32_bf16 v[104:107], a[20:23], a[132:135], v[104:107]
buffer_load_dwordx4 v13, s[8:11], s25 offen offset:1024 lds
v_mfma_f32_16x16x32_bf16 v[108:111], a[24:27], a[128:131], v[108:111]
ds_read_b64_tr_b16 a[142:143], v7 offset:18432
v_mfma_f32_16x16x32_bf16 v[108:111], a[28:31], a[132:135], v[108:111]
v_mfma_f32_16x16x32_bf16 v[112:115], a[32:35], a[128:131], v[112:115]
v_mfma_f32_16x16x32_bf16 v[112:115], a[36:39], a[132:135], v[112:115]
buffer_load_dwordx4 v14, s[8:11], s25 offen offset:2048 lds
v_mfma_f32_16x16x32_bf16 v[116:119], a[40:43], a[128:131], v[116:119]
ds_read_b128 a[88:91], v2 offset:38912
v_mfma_f32_16x16x32_bf16 v[116:119], a[44:47], a[132:135], v[116:119]
v_mfma_f32_16x16x32_bf16 v[120:123], a[48:51], a[128:131], v[120:123]
ds_read_b128 a[92:95], v3 offset:38912
v_mfma_f32_16x16x32_bf16 v[120:123], a[52:55], a[132:135], v[120:123]
buffer_load_dwordx4 v15, s[8:11], s25 offen offset:3072 lds
v_mfma_f32_16x16x32_bf16 v[124:127], a[56:59], a[128:131], v[124:127]
s_add_u32 s25, s25, 128
v_mfma_f32_16x16x32_bf16 v[124:127], a[60:63], a[132:135], v[124:127]
s_waitcnt lgkmcnt(2)
v_mfma_f32_16x16x32_bf16 v[128:131], a[0:3], a[136:139], v[128:131]
ds_read_b64_tr_b16 a[128:129], v8 offset:0
v_mfma_f32_16x16x32_bf16 v[128:131], a[4:7], a[140:143], v[128:131]
buffer_load_dword v21, v20, s[16:19], s43 offen
v_mfma_f32_16x16x32_bf16 v[132:135], a[8:11], a[136:139], v[132:135]
s_add_u32 s43, s43, s47
ds_read_b64_tr_b16 a[130:131], v8 offset:2048
v_mfma_f32_16x16x32_bf16 v[132:135], a[12:15], a[140:143], v[132:135]
s_cmp_ge_u32 s43, s51
v_mfma_f32_16x16x32_bf16 v[136:139], a[16:19], a[136:139], v[136:139]
s_cselect_b32 s43, 0, s43
ds_read_b64_tr_b16 a[132:133], v8 offset:16384
v_mfma_f32_16x16x32_bf16 v[136:139], a[20:23], a[140:143], v[136:139]
s_cselect_b32 s51, s42, s51
v_mfma_f32_16x16x32_bf16 v[140:143], a[24:27], a[136:139], v[140:143]
s_cselect_b64 s[16:17], s[40:41], s[16:17]
ds_read_b64_tr_b16 a[134:135], v8 offset:18432
v_mfma_f32_16x16x32_bf16 v[140:143], a[28:31], a[140:143], v[140:143]
s_cselect_b32 s18, s42, s18
v_mfma_f32_16x16x32_bf16 v[144:147], a[32:35], a[136:139], v[144:147]
s_cselect_b64 s[40:41], s[44:45], s[40:41]
ds_read_b128 a[96:99], v2 offset:40960
v_mfma_f32_16x16x32_bf16 v[144:147], a[36:39], a[140:143], v[144:147]
s_cselect_b32 s42, s46, s42
v_mfma_f32_16x16x32_bf16 v[148:151], a[40:43], a[136:139], v[148:151]
s_cselect_b32 s46, 0, s46
v_mfma_f32_16x16x32_bf16 v[148:151], a[44:47], a[140:143], v[148:151]
s_lshl_b32 s59, s39, 5
v_mfma_f32_16x16x32_bf16 v[152:155], a[48:51], a[136:139], v[152:155]
s_add_u32 s59, s59, s38
ds_read_b128 a[100:103], v3 offset:40960
v_mfma_f32_16x16x32_bf16 v[152:155], a[52:55], a[140:143], v[152:155]
s_lshl_b32 s59, s59, 2
v_mfma_f32_16x16x32_bf16 v[156:159], a[56:59], a[136:139], v[156:159]
s_add_u32 s59, s59, 94392320
ds_read_b128 a[104:107], v2 offset:43008
v_mfma_f32_16x16x32_bf16 v[156:159], a[60:63], a[140:143], v[156:159]
s_waitcnt lgkmcnt(3)
s_cmp_lt_u32 s2, 224
v_mfma_f32_16x16x32_bf16 v[160:163], a[0:3], a[128:131], v[160:163]
s_cselect_b32 s59, s59, 3221225472
ds_read_b64_tr_b16 a[136:137], v9 offset:0
v_mfma_f32_16x16x32_bf16 v[160:163], a[4:7], a[132:135], v[160:163]
s_mov_b32 s58, 0xffff0000
v_mfma_f32_16x16x32_bf16 v[164:167], a[8:11], a[128:131], v[164:167]
s_cmp_lt_u32 s3, 1
ds_read_b64_tr_b16 a[138:139], v9 offset:2048
v_mfma_f32_16x16x32_bf16 v[164:167], a[12:15], a[132:135], v[164:167]
s_cselect_b32 s54, 0, 3221225472
v_mfma_f32_16x16x32_bf16 v[168:171], a[16:19], a[128:131], v[168:171]
s_cselect_b32 s50, 0x100, 0
ds_read_b64_tr_b16 a[140:141], v9 offset:16384
v_mfma_f32_16x16x32_bf16 v[168:171], a[20:23], a[132:135], v[168:171]
v_mfma_f32_16x16x32_bf16 v[172:175], a[24:27], a[128:131], v[172:175]
ds_read_b64_tr_b16 a[142:143], v9 offset:18432
v_mfma_f32_16x16x32_bf16 v[172:175], a[28:31], a[132:135], v[172:175]
v_mfma_f32_16x16x32_bf16 v[176:179], a[32:35], a[128:131], v[176:179]
v_mfma_f32_16x16x32_bf16 v[176:179], a[36:39], a[132:135], v[176:179]
v_mfma_f32_16x16x32_bf16 v[180:183], a[40:43], a[128:131], v[180:183]
ds_read_b128 a[108:111], v3 offset:43008
v_mfma_f32_16x16x32_bf16 v[180:183], a[44:47], a[132:135], v[180:183]
v_mfma_f32_16x16x32_bf16 v[184:187], a[48:51], a[128:131], v[184:187]
ds_read_b128 a[112:115], v2 offset:45056
v_mfma_f32_16x16x32_bf16 v[184:187], a[52:55], a[132:135], v[184:187]
v_mfma_f32_16x16x32_bf16 v[188:191], a[56:59], a[128:131], v[188:191]
v_mfma_f32_16x16x32_bf16 v[188:191], a[60:63], a[132:135], v[188:191]
s_waitcnt lgkmcnt(2)
v_mfma_f32_16x16x32_bf16 v[192:195], a[0:3], a[136:139], v[192:195]
ds_read_b64_tr_b16 a[128:129], v10 offset:0
v_mfma_f32_16x16x32_bf16 v[192:195], a[4:7], a[140:143], v[192:195]
v_mfma_f32_16x16x32_bf16 v[196:199], a[8:11], a[136:139], v[196:199]
ds_read_b64_tr_b16 a[130:131], v10 offset:2048
v_mfma_f32_16x16x32_bf16 v[196:199], a[12:15], a[140:143], v[196:199]
v_mfma_f32_16x16x32_bf16 v[200:203], a[16:19], a[136:139], v[200:203]
ds_read_b64_tr_b16 a[132:133], v10 offset:16384
v_mfma_f32_16x16x32_bf16 v[200:203], a[20:23], a[140:143], v[200:203]
v_mfma_f32_16x16x32_bf16 v[204:207], a[24:27], a[136:139], v[204:207]
ds_read_b64_tr_b16 a[134:135], v10 offset:18432
v_mfma_f32_16x16x32_bf16 v[204:207], a[28:31], a[140:143], v[204:207]
v_mfma_f32_16x16x32_bf16 v[208:211], a[32:35], a[136:139], v[208:211]
ds_read_b128 a[116:119], v3 offset:45056
v_mfma_f32_16x16x32_bf16 v[208:211], a[36:39], a[140:143], v[208:211]
v_mfma_f32_16x16x32_bf16 v[212:215], a[40:43], a[136:139], v[212:215]
ds_read_b128 a[120:123], v2 offset:47104
v_and_b32 v252, 31, v0
v_mfma_f32_16x16x32_bf16 v[212:215], a[44:47], a[140:143], v[212:215]
v_lshrrev_b32 v253, 5, v0
v_xor_b32 v253, v253, v252
v_mfma_f32_16x16x32_bf16 v[216:219], a[48:51], a[136:139], v[216:219]
v_and_b32 v253, 7, v253
v_lshlrev_b32 v252, 8, v252
v_mfma_f32_16x16x32_bf16 v[216:219], a[52:55], a[140:143], v[216:219]
v_lshl_add_u32 v252, v253, 4, v252
v_add_u32 v252, 147456, v252
v_mfma_f32_16x16x32_bf16 v[220:223], a[56:59], a[136:139], v[220:223]
ds_read_b128 a[124:127], v3 offset:47104
v_mfma_f32_16x16x32_bf16 v[220:223], a[60:63], a[140:143], v[220:223]
s_waitcnt lgkmcnt(3)
v_mfma_f32_16x16x32_bf16 a[192:195], a[0:3], a[128:131], a[192:195]
ds_read_b64_tr_b16 a[136:137], v11 offset:0
v_mfma_f32_16x16x32_bf16 a[192:195], a[4:7], a[132:135], a[192:195]
v_mfma_f32_16x16x32_bf16 a[196:199], a[8:11], a[128:131], a[196:199]
ds_read_b64_tr_b16 a[138:139], v11 offset:2048
v_mfma_f32_16x16x32_bf16 a[196:199], a[12:15], a[132:135], a[196:199]
v_mfma_f32_16x16x32_bf16 a[200:203], a[16:19], a[128:131], a[200:203]
ds_read_b64_tr_b16 a[140:141], v11 offset:16384
v_mfma_f32_16x16x32_bf16 a[200:203], a[20:23], a[132:135], a[200:203]
v_mfma_f32_16x16x32_bf16 a[204:207], a[24:27], a[128:131], a[204:207]
ds_read_b64_tr_b16 a[142:143], v11 offset:18432
v_mfma_f32_16x16x32_bf16 a[204:207], a[28:31], a[132:135], a[204:207]
v_mfma_f32_16x16x32_bf16 a[208:211], a[32:35], a[128:131], a[208:211]
v_mfma_f32_16x16x32_bf16 a[208:211], a[36:39], a[132:135], a[208:211]
v_mfma_f32_16x16x32_bf16 a[212:215], a[40:43], a[128:131], a[212:215]
v_mfma_f32_16x16x32_bf16 a[212:215], a[44:47], a[132:135], a[212:215]
v_mfma_f32_16x16x32_bf16 a[216:219], a[48:51], a[128:131], a[216:219]
v_mfma_f32_16x16x32_bf16 a[216:219], a[52:55], a[132:135], a[216:219]
v_mfma_f32_16x16x32_bf16 a[220:223], a[56:59], a[128:131], a[220:223]
s_waitcnt vmcnt(1) lgkmcnt(0)
v_mfma_f32_16x16x32_bf16 a[220:223], a[60:63], a[132:135], a[220:223]
s_barrier
v_mfma_f32_16x16x32_bf16 a[224:227], a[0:3], a[136:139], a[224:227]
s_add_u32 m0, s29, 65536
ds_read_b64_tr_b16 a[128:129], v4 offset:32768
v_lshlrev_b32 v28, 16, v248
v_mfma_f32_16x16x32_bf16 a[224:227], a[4:7], a[140:143], a[224:227]
buffer_load_dwordx4 v16, s[12:15], s26 offen offset:0 lds
v_mfma_f32_16x16x32_bf16 a[228:231], a[8:11], a[136:139], a[228:231]
ds_read_b64_tr_b16 a[130:131], v4 offset:34816
v_and_b32 v29, s58, v248
v_mfma_f32_16x16x32_bf16 a[228:231], a[12:15], a[140:143], a[228:231]
v_lshlrev_b32 v30, 16, v249
v_and_b32 v253, s58, v249
v_mfma_f32_16x16x32_bf16 a[232:235], a[16:19], a[136:139], a[232:235]
ds_read_b64_tr_b16 a[132:133], v4 offset:49152
v_lshlrev_b32 v22, 16, v224
v_mfma_f32_16x16x32_bf16 a[232:235], a[20:23], a[140:143], a[232:235]
buffer_load_dwordx4 v17, s[12:15], s26 offen offset:1024 lds
v_mfma_f32_16x16x32_bf16 a[236:239], a[24:27], a[136:139], a[236:239]
ds_read_b64_tr_b16 a[134:135], v4 offset:51200
v_lshlrev_b32 v23, 16, v225
v_mfma_f32_16x16x32_bf16 a[236:239], a[28:31], a[140:143], a[236:239]
v_lshlrev_b32 v24, 16, v226
v_mul_f32 v254, v22, v253
v_mfma_f32_16x16x32_bf16 a[240:243], a[32:35], a[136:139], a[240:243]
v_lshlrev_b32 v25, 16, v227
v_lshlrev_b32 v247, 16, v236
v_mfma_f32_16x16x32_bf16 a[240:243], a[36:39], a[140:143], a[240:243]
buffer_load_dwordx4 v18, s[12:15], s26 offen offset:2048 lds
v_mfma_f32_16x16x32_bf16 a[244:247], a[40:43], a[136:139], a[244:247]
v_fmac_f32 v254, v23, v30
v_fmac_f32 v254, v24, v29
v_mfma_f32_16x16x32_bf16 a[244:247], a[44:47], a[140:143], a[244:247]
v_fmac_f32 v254, v25, v28
v_mul_f32 v254, v254, v247
v_mfma_f32_16x16x32_bf16 a[248:251], a[48:51], a[136:139], a[248:251]
v_mul_f32 v255, v23, v253
v_lshlrev_b32 v22, 16, v228
v_mfma_f32_16x16x32_bf16 a[248:251], a[52:55], a[140:143], a[248:251]
buffer_load_dwordx4 v19, s[12:15], s26 offen offset:3072 lds
v_mfma_f32_16x16x32_bf16 a[252:255], a[56:59], a[136:139], a[252:255]
s_add_u32 s26, s26, 524288
v_lshlrev_b32 v247, 16, v237
v_fmac_f32 v255, v24, v30
v_mfma_f32_16x16x32_bf16 a[252:255], a[60:63], a[140:143], a[252:255]
s_waitcnt lgkmcnt(0)
v_fmac_f32 v255, v25, v29
v_fmac_f32 v255, v22, v28
v_mfma_f32_16x16x32_bf16 v[32:35], a[64:67], a[128:131], v[32:35]
s_add_u32 m0, s29, 81920
ds_read_b64_tr_b16 a[136:137], v5 offset:32768
v_mul_f32 v255, v255, v247
v_mfma_f32_16x16x32_bf16 v[32:35], a[68:71], a[132:135], v[32:35]
buffer_load_dwordx4 v16, s[12:15], s27 offen offset:0 lds
v_mfma_f32_16x16x32_bf16 v[36:39], a[72:75], a[128:131], v[36:39]
ds_read_b64_tr_b16 a[138:139], v5 offset:34816
v_cvt_pk_bf16_f32 v246, v254, v255
v_mfma_f32_16x16x32_bf16 v[36:39], a[76:79], a[132:135], v[36:39]
v_accvgpr_write_b32 a180, v246
v_mul_f32 v254, v24, v253
v_mfma_f32_16x16x32_bf16 v[40:43], a[80:83], a[128:131], v[40:43]
ds_read_b64_tr_b16 a[140:141], v5 offset:49152
v_lshlrev_b32 v23, 16, v229
v_mfma_f32_16x16x32_bf16 v[40:43], a[84:87], a[132:135], v[40:43]
buffer_load_dwordx4 v17, s[12:15], s27 offen offset:1024 lds
v_mfma_f32_16x16x32_bf16 v[44:47], a[88:91], a[128:131], v[44:47]
ds_read_b64_tr_b16 a[142:143], v5 offset:51200
v_lshlrev_b32 v247, 16, v238
v_mfma_f32_16x16x32_bf16 v[44:47], a[92:95], a[132:135], v[44:47]
v_fmac_f32 v254, v25, v30
v_fmac_f32 v254, v22, v29
v_fmac_f32 v254, v23, v28
v_mfma_f32_16x16x32_bf16 v[48:51], a[96:99], a[128:131], v[48:51]
ds_read_b128 a[0:3], v2 offset:0
v_mul_f32 v254, v254, v247
v_mfma_f32_16x16x32_bf16 v[48:51], a[100:103], a[132:135], v[48:51]
buffer_load_dwordx4 v18, s[12:15], s27 offen offset:2048 lds
v_mfma_f32_16x16x32_bf16 v[52:55], a[104:107], a[128:131], v[52:55]
ds_read_b128 a[4:7], v3 offset:0
v_cvt_pk_bf16_f32 v246, v255, v254
v_mfma_f32_16x16x32_bf16 v[52:55], a[108:111], a[132:135], v[52:55]
v_accvgpr_write_b32 a176, v246
v_mul_f32 v255, v25, v253
v_mfma_f32_16x16x32_bf16 v[56:59], a[112:115], a[128:131], v[56:59]
v_lshlrev_b32 v24, 16, v230
v_lshlrev_b32 v247, 16, v239
v_mfma_f32_16x16x32_bf16 v[56:59], a[116:119], a[132:135], v[56:59]
buffer_load_dwordx4 v19, s[12:15], s27 offen offset:3072 lds
v_mfma_f32_16x16x32_bf16 v[60:63], a[120:123], a[128:131], v[60:63]
s_add_u32 s27, s27, 524288
ds_read_b128 a[8:11], v2 offset:2048
v_fmac_f32 v255, v22, v30
v_mfma_f32_16x16x32_bf16 v[60:63], a[124:127], a[132:135], v[60:63]
s_waitcnt lgkmcnt(3)
v_fmac_f32 v255, v23, v29
v_fmac_f32 v255, v24, v28
v_mul_f32 v255, v255, v247
v_mfma_f32_16x16x32_bf16 v[64:67], a[64:67], a[136:139], v[64:67]
s_add_u32 m0, s28, 32768
ds_read_b64_tr_b16 a[128:129], v6 offset:32768
v_cvt_pk_bf16_f32 v246, v254, v255
v_mfma_f32_16x16x32_bf16 v[64:67], a[68:71], a[140:143], v[64:67]
buffer_load_dwordx4 v12, s[8:11], s24 offen offset:0 lds
v_mfma_f32_16x16x32_bf16 v[68:71], a[72:75], a[136:139], v[68:71]
ds_read_b64_tr_b16 a[130:131], v6 offset:34816
v_accvgpr_write_b32 a181, v246
v_mfma_f32_16x16x32_bf16 v[68:71], a[76:79], a[140:143], v[68:71]
v_mul_f32 v254, v22, v253
v_lshlrev_b32 v25, 16, v231
v_mfma_f32_16x16x32_bf16 v[72:75], a[80:83], a[136:139], v[72:75]
ds_read_b64_tr_b16 a[132:133], v6 offset:49152
v_lshlrev_b32 v247, 16, v240
v_mfma_f32_16x16x32_bf16 v[72:75], a[84:87], a[140:143], v[72:75]
buffer_load_dwordx4 v13, s[8:11], s24 offen offset:1024 lds
v_mfma_f32_16x16x32_bf16 v[76:79], a[88:91], a[136:139], v[76:79]
ds_read_b64_tr_b16 a[134:135], v6 offset:51200
v_fmac_f32 v254, v23, v30
v_fmac_f32 v254, v24, v29
v_mfma_f32_16x16x32_bf16 v[76:79], a[92:95], a[140:143], v[76:79]
v_fmac_f32 v254, v25, v28
v_mul_f32 v254, v254, v247
v_mfma_f32_16x16x32_bf16 v[80:83], a[96:99], a[136:139], v[80:83]
ds_read_b128 a[12:15], v3 offset:2048
v_cvt_pk_bf16_f32 v246, v255, v254
v_mfma_f32_16x16x32_bf16 v[80:83], a[100:103], a[140:143], v[80:83]
buffer_load_dwordx4 v14, s[8:11], s24 offen offset:2048 lds
v_mfma_f32_16x16x32_bf16 v[84:87], a[104:107], a[136:139], v[84:87]
v_accvgpr_write_b32 a177, v246
v_mul_f32 v255, v23, v253
v_mfma_f32_16x16x32_bf16 v[84:87], a[108:111], a[140:143], v[84:87]
v_lshlrev_b32 v22, 16, v232
v_lshlrev_b32 v247, 16, v241
v_mfma_f32_16x16x32_bf16 v[88:91], a[112:115], a[136:139], v[88:91]
ds_read_b128 a[16:19], v2 offset:4096
v_fmac_f32 v255, v24, v30
v_mfma_f32_16x16x32_bf16 v[88:91], a[116:119], a[140:143], v[88:91]
buffer_load_dwordx4 v15, s[8:11], s24 offen offset:3072 lds
v_mfma_f32_16x16x32_bf16 v[92:95], a[120:123], a[136:139], v[92:95]
s_add_u32 s24, s24, 128
ds_read_b128 a[20:23], v3 offset:4096
v_fmac_f32 v255, v25, v29
v_fmac_f32 v255, v22, v28
v_mfma_f32_16x16x32_bf16 v[92:95], a[124:127], a[140:143], v[92:95]
s_waitcnt lgkmcnt(3)
v_mul_f32 v255, v255, v247
v_cvt_pk_bf16_f32 v246, v254, v255
v_mfma_f32_16x16x32_bf16 v[96:99], a[64:67], a[128:131], v[96:99]
s_add_u32 m0, s28, 36864
ds_read_b64_tr_b16 a[136:137], v7 offset:32768
v_accvgpr_write_b32 a182, v246
v_mfma_f32_16x16x32_bf16 v[96:99], a[68:71], a[132:135], v[96:99]
buffer_load_dwordx4 v12, s[8:11], s25 offen offset:0 lds
v_mfma_f32_16x16x32_bf16 v[100:103], a[72:75], a[128:131], v[100:103]
ds_read_b64_tr_b16 a[138:139], v7 offset:34816
v_mul_f32 v254, v24, v253
v_mfma_f32_16x16x32_bf16 v[100:103], a[76:79], a[132:135], v[100:103]
v_lshlrev_b32 v23, 16, v233
v_lshlrev_b32 v247, 16, v242
v_mfma_f32_16x16x32_bf16 v[104:107], a[80:83], a[128:131], v[104:107]
ds_read_b64_tr_b16 a[140:141], v7 offset:49152
v_fmac_f32 v254, v25, v30
v_mfma_f32_16x16x32_bf16 v[104:107], a[84:87], a[132:135], v[104:107]
buffer_load_dwordx4 v13, s[8:11], s25 offen offset:1024 lds
v_fmac_f32 v254, v22, v29
v_mfma_f32_16x16x32_bf16 v[108:111], a[88:91], a[128:131], v[108:111]
ds_read_b64_tr_b16 a[142:143], v7 offset:51200
v_fmac_f32 v254, v23, v28
v_mfma_f32_16x16x32_bf16 v[108:111], a[92:95], a[132:135], v[108:111]
v_mul_f32 v254, v254, v247
v_cvt_pk_bf16_f32 v246, v255, v254
v_mfma_f32_16x16x32_bf16 v[112:115], a[96:99], a[128:131], v[112:115]
v_accvgpr_write_b32 a178, v246
v_mul_f32 v255, v25, v253
v_mfma_f32_16x16x32_bf16 v[112:115], a[100:103], a[132:135], v[112:115]
buffer_load_dwordx4 v14, s[8:11], s25 offen offset:2048 lds
v_mfma_f32_16x16x32_bf16 v[116:119], a[104:107], a[128:131], v[116:119]
ds_read_b128 a[24:27], v2 offset:6144
v_lshlrev_b32 v24, 16, v234
v_mfma_f32_16x16x32_bf16 v[116:119], a[108:111], a[132:135], v[116:119]
v_lshlrev_b32 v247, 16, v243
v_fmac_f32 v255, v22, v30
v_mfma_f32_16x16x32_bf16 v[120:123], a[112:115], a[128:131], v[120:123]
ds_read_b128 a[28:31], v3 offset:6144
v_fmac_f32 v255, v23, v29
v_mfma_f32_16x16x32_bf16 v[120:123], a[116:119], a[132:135], v[120:123]
PAD_24:
s_cbranch_execz PAD_28
buffer_load_dwordx4 v15, s[8:11], s25 offen offset:3072 lds
v_fmac_f32 v255, v24, v28
v_mfma_f32_16x16x32_bf16 v[124:127], a[120:123], a[128:131], v[124:127]
s_add_u32 s25, s25, 128
v_mul_f32 v255, v255, v247
v_cvt_pk_bf16_f32 v246, v254, v255
v_mfma_f32_16x16x32_bf16 v[124:127], a[124:127], a[132:135], v[124:127]
s_waitcnt lgkmcnt(2)
v_accvgpr_write_b32 a183, v246
v_mul_f32 v254, v22, v253
v_mfma_f32_16x16x32_bf16 v[128:131], a[64:67], a[136:139], v[128:131]
ds_read_b64_tr_b16 a[128:129], v8 offset:32768
v_lshlrev_b32 v25, 16, v235
v_mfma_f32_16x16x32_bf16 v[128:131], a[68:71], a[140:143], v[128:131]
buffer_load_dword v21, v20, s[16:19], s43 offen
v_mfma_f32_16x16x32_bf16 v[132:135], a[72:75], a[136:139], v[132:135]
s_add_u32 s43, s43, s47
ds_read_b64_tr_b16 a[130:131], v8 offset:34816
v_lshlrev_b32 v247, 16, v244
v_mfma_f32_16x16x32_bf16 v[132:135], a[76:79], a[140:143], v[132:135]
s_cmp_ge_u32 s43, s51
v_fmac_f32 v254, v23, v30
v_fmac_f32 v254, v24, v29
v_mfma_f32_16x16x32_bf16 v[136:139], a[80:83], a[136:139], v[136:139]
s_cselect_b32 s43, 0, s43
ds_read_b64_tr_b16 a[132:133], v8 offset:49152
v_fmac_f32 v254, v25, v28
v_mul_f32 v254, v254, v247
v_mfma_f32_16x16x32_bf16 v[136:139], a[84:87], a[140:143], v[136:139]
s_cselect_b32 s51, s42, s51
v_cvt_pk_bf16_f32 v246, v255, v254
v_accvgpr_write_b32 a179, v246
v_mfma_f32_16x16x32_bf16 v[140:143], a[88:91], a[136:139], v[140:143]
s_cselect_b64 s[16:17], s[40:41], s[16:17]
ds_read_b64_tr_b16 a[134:135], v8 offset:51200
v_lshlrev_b32 v28, 16, v250
v_mfma_f32_16x16x32_bf16 v[140:143], a[92:95], a[140:143], v[140:143]
s_cselect_b32 s18, s42, s18
v_and_b32 v29, s58, v250
v_lshlrev_b32 v30, 16, v251
v_mfma_f32_16x16x32_bf16 v[144:147], a[96:99], a[136:139], v[144:147]
s_cselect_b64 s[40:41], s[44:45], s[40:41]
ds_read_b128 a[32:35], v2 offset:8192
v_and_b32 v253, s58, v251
v_mfma_f32_16x16x32_bf16 v[144:147], a[100:103], a[140:143], v[144:147]
s_cselect_b32 s42, s46, s42
v_and_b32 v22, s58, v224
v_and_b32 v23, s58, v225
v_mfma_f32_16x16x32_bf16 v[148:151], a[104:107], a[136:139], v[148:151]
s_cselect_b32 s46, 0, s46
v_and_b32 v24, s58, v226
v_mul_f32 v254, v22, v253
v_mfma_f32_16x16x32_bf16 v[148:151], a[108:111], a[140:143], v[148:151]
buffer_load_dword v21, off, s[60:63], s54 sc1
v_mfma_f32_16x16x32_bf16 v[152:155], a[112:115], a[136:139], v[152:155]
ds_read_b128 a[36:39], v3 offset:8192
v_and_b32 v25, s58, v227
v_and_b32 v247, s58, v236
v_mfma_f32_16x16x32_bf16 v[152:155], a[116:119], a[140:143], v[152:155]
v_fmac_f32 v254, v23, v30
v_fmac_f32 v254, v24, v29
v_mfma_f32_16x16x32_bf16 v[156:159], a[120:123], a[136:139], v[156:159]
ds_read_b128 a[40:43], v2 offset:10240
v_fmac_f32 v254, v25, v28
v_mfma_f32_16x16x32_bf16 v[156:159], a[124:127], a[140:143], v[156:159]
s_waitcnt lgkmcnt(3)
v_mul_f32 v254, v254, v247
v_mul_f32 v255, v23, v253
v_mfma_f32_16x16x32_bf16 v[160:163], a[64:67], a[128:131], v[160:163]
ds_read_b64_tr_b16 a[136:137], v9 offset:32768
v_and_b32 v22, s58, v228
v_mfma_f32_16x16x32_bf16 v[160:163], a[68:71], a[132:135], v[160:163]
v_and_b32 v247, s58, v237
v_fmac_f32 v255, v24, v30
v_mfma_f32_16x16x32_bf16 v[164:167], a[72:75], a[128:131], v[164:167]
ds_read_b64_tr_b16 a[138:139], v9 offset:34816
v_fmac_f32 v255, v25, v29
v_mfma_f32_16x16x32_bf16 v[164:167], a[76:79], a[132:135], v[164:167]
v_fmac_f32 v255, v22, v28
v_mul_f32 v255, v255, v247
v_mfma_f32_16x16x32_bf16 v[168:171], a[80:83], a[128:131], v[168:171]
ds_read_b64_tr_b16 a[140:141], v9 offset:49152
v_cvt_pk_bf16_f32 v246, v254, v255
v_accvgpr_write_b32 a188, v246
v_mfma_f32_16x16x32_bf16 v[168:171], a[84:87], a[132:135], v[168:171]
v_mul_f32 v254, v24, v253
v_and_b32 v23, s58, v229
v_mfma_f32_16x16x32_bf16 v[172:175], a[88:91], a[128:131], v[172:175]
ds_read_b64_tr_b16 a[142:143], v9 offset:51200
v_and_b32 v247, s58, v238
v_mfma_f32_16x16x32_bf16 v[172:175], a[92:95], a[132:135], v[172:175]
v_fmac_f32 v254, v25, v30
v_fmac_f32 v254, v22, v29
v_mfma_f32_16x16x32_bf16 v[176:179], a[96:99], a[128:131], v[176:179]
v_fmac_f32 v254, v23, v28
v_mul_f32 v254, v254, v247
v_mfma_f32_16x16x32_bf16 v[176:179], a[100:103], a[132:135], v[176:179]
v_cvt_pk_bf16_f32 v246, v255, v254
v_accvgpr_write_b32 a184, v246
v_mfma_f32_16x16x32_bf16 v[180:183], a[104:107], a[128:131], v[180:183]
ds_read_b128 a[44:47], v3 offset:10240
v_mul_f32 v255, v25, v253
v_mfma_f32_16x16x32_bf16 v[180:183], a[108:111], a[132:135], v[180:183]
v_and_b32 v24, s58, v230
v_and_b32 v247, s58, v239
v_fmac_f32 v255, v22, v30
v_mfma_f32_16x16x32_bf16 v[184:187], a[112:115], a[128:131], v[184:187]
ds_read_b128 a[48:51], v2 offset:12288
v_fmac_f32 v255, v23, v29
v_mfma_f32_16x16x32_bf16 v[184:187], a[116:119], a[132:135], v[184:187]
v_fmac_f32 v255, v24, v28
v_mul_f32 v255, v255, v247
v_mfma_f32_16x16x32_bf16 v[188:191], a[120:123], a[128:131], v[188:191]
v_cvt_pk_bf16_f32 v246, v254, v255
v_accvgpr_write_b32 a189, v246
v_mfma_f32_16x16x32_bf16 v[188:191], a[124:127], a[132:135], v[188:191]
s_waitcnt lgkmcnt(2)
v_mul_f32 v254, v22, v253
v_and_b32 v25, s58, v231
v_mfma_f32_16x16x32_bf16 v[192:195], a[64:67], a[136:139], v[192:195]
ds_read_b64_tr_b16 a[128:129], v10 offset:32768
v_and_b32 v247, s58, v240
v_mfma_f32_16x16x32_bf16 v[192:195], a[68:71], a[140:143], v[192:195]
v_fmac_f32 v254, v23, v30
v_fmac_f32 v254, v24, v29
v_mfma_f32_16x16x32_bf16 v[196:199], a[72:75], a[136:139], v[196:199]
ds_read_b64_tr_b16 a[130:131], v10 offset:34816
v_fmac_f32 v254, v25, v28
v_mfma_f32_16x16x32_bf16 v[196:199], a[76:79], a[140:143], v[196:199]
v_mul_f32 v254, v254, v247
v_cvt_pk_bf16_f32 v246, v255, v254
v_accvgpr_write_b32 a185, v246
v_mfma_f32_16x16x32_bf16 v[200:203], a[80:83], a[136:139], v[200:203]
s_lshr_b32 s22, s3, 1
ds_read_b64_tr_b16 a[132:133], v10 offset:49152
v_mul_f32 v255, v23, v253
v_mfma_f32_16x16x32_bf16 v[200:203], a[84:87], a[140:143], v[200:203]
s_mul_i32 s22, s22, 2097152
v_and_b32 v22, s58, v232
v_and_b32 v247, s58, v241
v_mfma_f32_16x16x32_bf16 v[204:207], a[88:91], a[136:139], v[204:207]
s_and_b32 s23, s3, 1
ds_read_b64_tr_b16 a[134:135], v10 offset:51200
v_fmac_f32 v255, v24, v30
v_mfma_f32_16x16x32_bf16 v[204:207], a[92:95], a[140:143], v[204:207]
s_lshl_b32 s23, s23, 5
v_fmac_f32 v255, v25, v29
v_fmac_f32 v255, v22, v28
v_mfma_f32_16x16x32_bf16 v[208:211], a[96:99], a[136:139], v[208:211]
s_lshl_b32 s56, s39, 6
ds_read_b128 a[52:55], v3 offset:12288
v_mul_f32 v255, v255, v247
v_mfma_f32_16x16x32_bf16 v[208:211], a[100:103], a[140:143], v[208:211]
s_add_u32 s23, s23, s56
v_cvt_pk_bf16_f32 v246, v254, v255
v_accvgpr_write_b32 a190, v246
v_mfma_f32_16x16x32_bf16 v[212:215], a[104:107], a[136:139], v[212:215]
s_mul_i32 s23, s23, 4224
ds_read_b128 a[56:59], v2 offset:14336
v_mul_f32 v254, v24, v253
v_and_b32 v23, s58, v233
v_mfma_f32_16x16x32_bf16 v[212:215], a[108:111], a[140:143], v[212:215]
s_add_u32 s22, s22, s23
v_and_b32 v247, s58, v242
v_fmac_f32 v254, v25, v30
v_mfma_f32_16x16x32_bf16 v[216:219], a[112:115], a[136:139], v[216:219]
s_add_u32 s57, s22, 83886200
v_fmac_f32 v254, v22, v29
v_fmac_f32 v254, v23, v28
v_mfma_f32_16x16x32_bf16 v[216:219], a[116:119], a[140:143], v[216:219]
s_lshl_b32 s23, s38, 7
v_mul_f32 v254, v254, v247
v_cvt_pk_bf16_f32 v246, v255, v254
v_mfma_f32_16x16x32_bf16 v[220:223], a[120:123], a[136:139], v[220:223]
s_add_u32 s22, s22, s23
ds_read_b128 a[60:63], v3 offset:14336
v_accvgpr_write_b32 a186, v246
v_mfma_f32_16x16x32_bf16 v[220:223], a[124:127], a[140:143], v[220:223]
s_waitcnt lgkmcnt(3)
s_add_u32 s56, s22, 83886208
v_mul_f32 v255, v25, v253
v_and_b32 v24, s58, v234
v_mfma_f32_16x16x32_bf16 a[192:195], a[64:67], a[128:131], a[192:195]
s_cmp_lt_u32 s2, 224
ds_read_b64_tr_b16 a[136:137], v11 offset:32768
v_and_b32 v247, s58, v243
v_mfma_f32_16x16x32_bf16 a[192:195], a[68:71], a[132:135], a[192:195]
s_cselect_b32 s56, s56, 3221225472
v_fmac_f32 v255, v22, v30
v_fmac_f32 v255, v23, v29
v_mfma_f32_16x16x32_bf16 a[196:199], a[72:75], a[128:131], a[196:199]
s_cmp_eq_u32 s38, 0
ds_read_b64_tr_b16 a[138:139], v11 offset:34816
v_fmac_f32 v255, v24, v28
v_mul_f32 v255, v255, v247
v_mfma_f32_16x16x32_bf16 a[196:199], a[76:79], a[132:135], a[196:199]
s_cselect_b32 s57, s57, 3221225472
v_cvt_pk_bf16_f32 v246, v254, v255
v_accvgpr_write_b32 a191, v246
v_mfma_f32_16x16x32_bf16 a[200:203], a[80:83], a[128:131], a[200:203]
ds_read_b64_tr_b16 a[140:141], v11 offset:49152
v_mul_f32 v254, v22, v253
v_mfma_f32_16x16x32_bf16 a[200:203], a[84:87], a[132:135], a[200:203]
v_and_b32 v25, s58, v235
v_and_b32 v247, s58, v244
v_mfma_f32_16x16x32_bf16 a[204:207], a[88:91], a[128:131], a[204:207]
ds_read_b64_tr_b16 a[142:143], v11 offset:51200
v_fmac_f32 v254, v23, v30
v_mfma_f32_16x16x32_bf16 a[204:207], a[92:95], a[132:135], a[204:207]
ds_write_b128 v252, a[176:179] offset:0
v_fmac_f32 v254, v24, v29
v_mfma_f32_16x16x32_bf16 a[208:211], a[96:99], a[128:131], a[208:211]
v_fmac_f32 v254, v25, v28
v_mul_f32 v254, v254, v247
v_mfma_f32_16x16x32_bf16 a[208:211], a[100:103], a[132:135], a[208:211]
ds_write_b128 v252, a[180:183] offset:8192
v_cvt_pk_bf16_f32 v246, v255, v254
v_accvgpr_write_b32 a187, v246
v_mfma_f32_16x16x32_bf16 a[212:215], a[104:107], a[128:131], a[212:215]
v_mfma_f32_16x16x32_bf16 a[212:215], a[108:111], a[132:135], a[212:215]
ds_write_b128 v252, a[184:187] offset:128
v_mfma_f32_16x16x32_bf16 a[216:219], a[112:115], a[128:131], a[216:219]
v_mfma_f32_16x16x32_bf16 a[216:219], a[116:119], a[132:135], a[216:219]
ds_write_b128 v252, a[188:191] offset:8320
v_mfma_f32_16x16x32_bf16 a[220:223], a[120:123], a[128:131], a[220:223]
s_waitcnt vmcnt(2) lgkmcnt(0)
v_mfma_f32_16x16x32_bf16 a[220:223], a[124:127], a[132:135], a[220:223]
s_barrier
v_mfma_f32_16x16x32_bf16 a[224:227], a[64:67], a[136:139], a[224:227]
s_add_u32 m0, s29, 98304
ds_read_b64_tr_b16 a[128:129], v4 offset:0
v_lshrrev_b32 v22, 8, v1
v_mfma_f32_16x16x32_bf16 a[224:227], a[68:71], a[140:143], a[224:227]
buffer_load_dwordx4 v16, s[12:15], s26 offen offset:0 lds
v_mfma_f32_16x16x32_bf16 a[228:231], a[72:75], a[136:139], a[228:231]
ds_read_b64_tr_b16 a[130:131], v4 offset:2048
v_lshlrev_b32 v22, 4, v22
v_mfma_f32_16x16x32_bf16 a[228:231], a[76:79], a[140:143], a[228:231]
v_xor_b32 v22, v22, v1
v_add_u32 v22, s29, v22
v_mfma_f32_16x16x32_bf16 a[232:235], a[80:83], a[136:139], a[232:235]
ds_read_b64_tr_b16 a[132:133], v4 offset:16384
v_add_u32 v22, 147456, v22
v_mfma_f32_16x16x32_bf16 a[232:235], a[84:87], a[140:143], a[232:235]
buffer_load_dwordx4 v17, s[12:15], s26 offen offset:1024 lds
v_mfma_f32_16x16x32_bf16 a[236:239], a[88:91], a[136:139], a[236:239]
ds_read_b64_tr_b16 a[134:135], v4 offset:18432
v_xor_b32 v23, 64, v22
v_mfma_f32_16x16x32_bf16 a[236:239], a[92:95], a[140:143], a[236:239]
v_lshrrev_b32 v224, 7, v1
v_mul_u32_u24 v224, 4224, v224
v_mfma_f32_16x16x32_bf16 a[240:243], a[96:99], a[136:139], a[240:243]
v_and_b32 v225, 0x70, v1
v_add_u32 v224, v224, v225
v_mfma_f32_16x16x32_bf16 a[240:243], a[100:103], a[140:143], a[240:243]
buffer_load_dwordx4 v18, s[12:15], s26 offen offset:2048 lds
v_mfma_f32_16x16x32_bf16 a[244:247], a[104:107], a[136:139], a[244:247]
v_bfe_u32 v225, v1, 4, 5
v_mul_u32_u24 v225, 4224, v225
v_mfma_f32_16x16x32_bf16 a[244:247], a[108:111], a[140:143], a[244:247]
v_mov_b32 v226, 0
v_mov_b32 v227, 0
v_mfma_f32_16x16x32_bf16 a[248:251], a[112:115], a[136:139], a[248:251]
v_mfma_f32_16x16x32_bf16 a[248:251], a[116:119], a[140:143], a[248:251]
buffer_load_dwordx4 v19, s[12:15], s26 offen offset:3072 lds
v_mfma_f32_16x16x32_bf16 a[252:255], a[120:123], a[136:139], a[252:255]
s_add_u32 s26, s26, 524288
v_mfma_f32_16x16x32_bf16 a[252:255], a[124:127], a[140:143], a[252:255]
s_waitcnt lgkmcnt(0)
v_mfma_f32_16x16x32_bf16 v[32:35], a[0:3], a[128:131], v[32:35]
s_add_u32 m0, s29, 114688
ds_read_b64_tr_b16 a[136:137], v5 offset:0
v_mfma_f32_16x16x32_bf16 v[32:35], a[4:7], a[132:135], v[32:35]
buffer_load_dwordx4 v16, s[12:15], s27 offen offset:0 lds
v_mfma_f32_16x16x32_bf16 v[36:39], a[8:11], a[128:131], v[36:39]
s_mul_i32 s52, s20, 7
ds_read_b64_tr_b16 a[138:139], v5 offset:2048
v_mfma_f32_16x16x32_bf16 v[36:39], a[12:15], a[132:135], v[36:39]
s_add_u32 s52, s52, s21
buffer_store_dwordx2 v[226:227], v225, s[4:7], s57 offen sc1
v_mfma_f32_16x16x32_bf16 v[40:43], a[16:19], a[128:131], v[40:43]
s_lshl_b32 s53, s52, 2
ds_read_b64_tr_b16 a[140:141], v5 offset:16384
v_mfma_f32_16x16x32_bf16 v[40:43], a[20:23], a[132:135], v[40:43]
s_add_u32 s53, s53, s3
buffer_load_dwordx4 v17, s[12:15], s27 offen offset:1024 lds
v_mfma_f32_16x16x32_bf16 v[44:47], a[24:27], a[128:131], v[44:47]
s_lshl_b32 s49, s53, 12
ds_read_b64_tr_b16 a[142:143], v5 offset:18432
v_mfma_f32_16x16x32_bf16 v[44:47], a[28:31], a[132:135], v[44:47]
s_mul_i32 s53, s53, 4224
v_mfma_f32_16x16x32_bf16 v[48:51], a[32:35], a[128:131], v[48:51]
s_add_u32 s53, s53, 83886080
ds_read_b128 a[64:67], v2 offset:32768
v_mfma_f32_16x16x32_bf16 v[48:51], a[36:39], a[132:135], v[48:51]
s_lshr_b32 s52, s52, 4
buffer_load_dwordx4 v18, s[12:15], s27 offen offset:2048 lds
v_mfma_f32_16x16x32_bf16 v[52:55], a[40:43], a[128:131], v[52:55]
s_min_u32 s52, s52, 6
ds_read_b128 a[68:71], v3 offset:32768
v_mfma_f32_16x16x32_bf16 v[52:55], a[44:47], a[132:135], v[52:55]
s_lshl_b32 s52, s52, 7
ds_read_b128 a[176:179], v22 offset:0
v_mfma_f32_16x16x32_bf16 v[56:59], a[48:51], a[128:131], v[56:59]
s_add_u32 s52, s52, 94392320
ds_read_b128 a[180:183], v23 offset:1024
v_mfma_f32_16x16x32_bf16 v[56:59], a[52:55], a[132:135], v[56:59]
buffer_load_dwordx4 v19, s[12:15], s27 offen offset:3072 lds
v_mfma_f32_16x16x32_bf16 v[60:63], a[56:59], a[128:131], v[60:63]
s_add_u32 s27, s27, 524288
ds_read_b128 a[72:75], v2 offset:34816
v_mfma_f32_16x16x32_bf16 v[60:63], a[60:63], a[132:135], v[60:63]
s_waitcnt lgkmcnt(5)
ds_read_b128 a[184:187], v22 offset:2048
v_mfma_f32_16x16x32_bf16 v[64:67], a[0:3], a[136:139], v[64:67]
s_add_u32 m0, s28, 0
ds_read_b64_tr_b16 a[128:129], v6 offset:0
v_mfma_f32_16x16x32_bf16 v[64:67], a[4:7], a[140:143], v[64:67]
buffer_load_dwordx4 v12, s[8:11], s24 offen offset:0 lds
v_mfma_f32_16x16x32_bf16 v[68:71], a[8:11], a[136:139], v[68:71]
ds_read_b64_tr_b16 a[130:131], v6 offset:2048
v_mfma_f32_16x16x32_bf16 v[68:71], a[12:15], a[140:143], v[68:71]
ds_read_b128 a[188:191], v23 offset:3072
v_mfma_f32_16x16x32_bf16 v[72:75], a[16:19], a[136:139], v[72:75]
ds_read_b64_tr_b16 a[132:133], v6 offset:16384
v_bfe_u32 v231, v1, 4, 5
v_mfma_f32_16x16x32_bf16 v[72:75], a[20:23], a[140:143], v[72:75]
buffer_load_dwordx4 v13, s[8:11], s24 offen offset:1024 lds
v_mfma_f32_16x16x32_bf16 v[76:79], a[24:27], a[136:139], v[76:79]
ds_read_b64_tr_b16 a[134:135], v6 offset:18432
v_lshlrev_b32 v231, 2, v231
v_mfma_f32_16x16x32_bf16 v[76:79], a[28:31], a[140:143], v[76:79]
v_lshlrev_b32 v229, 3, v1
v_min_u32 v229, 4096, v229
v_mfma_f32_16x16x32_bf16 v[80:83], a[32:35], a[136:139], v[80:83]
ds_read_b128 a[76:79], v3 offset:34816
v_mfma_f32_16x16x32_bf16 v[80:83], a[36:39], a[140:143], v[80:83]
buffer_load_dwordx4 v14, s[8:11], s24 offen offset:2048 lds
v_mfma_f32_16x16x32_bf16 v[84:87], a[40:43], a[136:139], v[84:87]
v_mfma_f32_16x16x32_bf16 v[84:87], a[44:47], a[140:143], v[84:87]
v_mfma_f32_16x16x32_bf16 v[88:91], a[48:51], a[136:139], v[88:91]
ds_read_b128 a[80:83], v2 offset:36864
v_mfma_f32_16x16x32_bf16 v[88:91], a[52:55], a[140:143], v[88:91]
buffer_load_dwordx4 v15, s[8:11], s24 offen offset:3072 lds
v_mfma_f32_16x16x32_bf16 v[92:95], a[56:59], a[136:139], v[92:95]
s_add_u32 s24, s24, 128
ds_read_b128 a[84:87], v3 offset:36864
v_mfma_f32_16x16x32_bf16 v[92:95], a[60:63], a[140:143], v[92:95]
s_waitcnt lgkmcnt(3)
v_mfma_f32_16x16x32_bf16 v[96:99], a[0:3], a[128:131], v[96:99]
s_add_u32 m0, s28, 4096
ds_read_b64_tr_b16 a[136:137], v7 offset:0
v_mfma_f32_16x16x32_bf16 v[96:99], a[4:7], a[132:135], v[96:99]
buffer_load_dwordx4 v12, s[8:11], s25 offen offset:0 lds
v_mfma_f32_16x16x32_bf16 v[100:103], a[8:11], a[128:131], v[100:103]
ds_read_b64_tr_b16 a[138:139], v7 offset:2048
v_mfma_f32_16x16x32_bf16 v[100:103], a[12:15], a[132:135], v[100:103]
v_mfma_f32_16x16x32_bf16 v[104:107], a[16:19], a[128:131], v[104:107]
ds_read_b64_tr_b16 a[140:141], v7 offset:16384
v_mfma_f32_16x16x32_bf16 v[104:107], a[20:23], a[132:135], v[104:107]
buffer_load_dwordx4 v13, s[8:11], s25 offen offset:1024 lds
v_mfma_f32_16x16x32_bf16 v[108:111], a[24:27], a[128:131], v[108:111]
ds_read_b64_tr_b16 a[142:143], v7 offset:18432
v_mfma_f32_16x16x32_bf16 v[108:111], a[28:31], a[132:135], v[108:111]
v_mfma_f32_16x16x32_bf16 v[112:115], a[32:35], a[128:131], v[112:115]
v_mfma_f32_16x16x32_bf16 v[112:115], a[36:39], a[132:135], v[112:115]
buffer_load_dwordx4 v14, s[8:11], s25 offen offset:2048 lds
v_mfma_f32_16x16x32_bf16 v[116:119], a[40:43], a[128:131], v[116:119]
ds_read_b128 a[88:91], v2 offset:38912
v_mfma_f32_16x16x32_bf16 v[116:119], a[44:47], a[132:135], v[116:119]
v_mfma_f32_16x16x32_bf16 v[120:123], a[48:51], a[128:131], v[120:123]
ds_read_b128 a[92:95], v3 offset:38912
v_mfma_f32_16x16x32_bf16 v[120:123], a[52:55], a[132:135], v[120:123]
buffer_load_dwordx4 v15, s[8:11], s25 offen offset:3072 lds
v_mfma_f32_16x16x32_bf16 v[124:127], a[56:59], a[128:131], v[124:127]
s_add_u32 s25, s25, 128
v_mfma_f32_16x16x32_bf16 v[124:127], a[60:63], a[132:135], v[124:127]
s_waitcnt lgkmcnt(2)
v_mfma_f32_16x16x32_bf16 v[128:131], a[0:3], a[136:139], v[128:131]
ds_read_b64_tr_b16 a[128:129], v8 offset:0
v_mfma_f32_16x16x32_bf16 v[128:131], a[4:7], a[140:143], v[128:131]
buffer_store_dwordx4 a[176:179], v224, s[4:7], s56 offen sc1
v_mfma_f32_16x16x32_bf16 v[132:135], a[8:11], a[136:139], v[132:135]
s_add_u32 s56, s56, 33792
ds_read_b64_tr_b16 a[130:131], v8 offset:2048
v_mfma_f32_16x16x32_bf16 v[132:135], a[12:15], a[140:143], v[132:135]
v_mfma_f32_16x16x32_bf16 v[136:139], a[16:19], a[136:139], v[136:139]
ds_read_b64_tr_b16 a[132:133], v8 offset:16384
v_mfma_f32_16x16x32_bf16 v[136:139], a[20:23], a[140:143], v[136:139]
v_mfma_f32_16x16x32_bf16 v[140:143], a[24:27], a[136:139], v[140:143]
s_cmp_lt_u32 s21, 7
ds_read_b64_tr_b16 a[134:135], v8 offset:18432
v_mfma_f32_16x16x32_bf16 v[140:143], a[28:31], a[140:143], v[140:143]
s_cselect_b32 s53, s53, 3221225472
v_mfma_f32_16x16x32_bf16 v[144:147], a[32:35], a[136:139], v[144:147]
s_cselect_b32 s49, s49, 3221225472
ds_read_b128 a[96:99], v2 offset:40960
v_mfma_f32_16x16x32_bf16 v[144:147], a[36:39], a[140:143], v[144:147]
s_add_u32 s48, s53, 2097152
v_mfma_f32_16x16x32_bf16 v[148:151], a[40:43], a[136:139], v[148:151]
v_mfma_f32_16x16x32_bf16 v[148:151], a[44:47], a[140:143], v[148:151]
v_mfma_f32_16x16x32_bf16 v[152:155], a[48:51], a[136:139], v[152:155]
ds_read_b128 a[100:103], v3 offset:40960
v_mfma_f32_16x16x32_bf16 v[152:155], a[52:55], a[140:143], v[152:155]
v_mfma_f32_16x16x32_bf16 v[156:159], a[56:59], a[136:139], v[156:159]
ds_read_b128 a[104:107], v2 offset:43008
v_mfma_f32_16x16x32_bf16 v[156:159], a[60:63], a[140:143], v[156:159]
s_waitcnt lgkmcnt(3)
v_mfma_f32_16x16x32_bf16 v[160:163], a[0:3], a[128:131], v[160:163]
ds_read_b64_tr_b16 a[136:137], v9 offset:0
v_mfma_f32_16x16x32_bf16 v[160:163], a[4:7], a[132:135], v[160:163]
v_mfma_f32_16x16x32_bf16 v[164:167], a[8:11], a[128:131], v[164:167]
ds_read_b64_tr_b16 a[138:139], v9 offset:2048
v_mfma_f32_16x16x32_bf16 v[164:167], a[12:15], a[132:135], v[164:167]
buffer_store_dwordx4 a[180:183], v224, s[4:7], s56 offen sc1
v_mfma_f32_16x16x32_bf16 v[168:171], a[16:19], a[128:131], v[168:171]
s_add_u32 s56, s56, 33792
ds_read_b64_tr_b16 a[140:141], v9 offset:16384
v_mfma_f32_16x16x32_bf16 v[168:171], a[20:23], a[132:135], v[168:171]
v_mfma_f32_16x16x32_bf16 v[172:175], a[24:27], a[128:131], v[172:175]
s_lshl_b32 s22, s2, 14
ds_read_b64_tr_b16 a[142:143], v9 offset:18432
v_mfma_f32_16x16x32_bf16 v[172:175], a[28:31], a[132:135], v[172:175]
s_cmp_eq_u32 s3, 2
v_mfma_f32_16x16x32_bf16 v[176:179], a[32:35], a[128:131], v[176:179]
s_cselect_b32 s47, 512, s47
v_mfma_f32_16x16x32_bf16 v[176:179], a[36:39], a[132:135], v[176:179]
s_cselect_b32 vcc_lo, -1, 0
v_mfma_f32_16x16x32_bf16 v[180:183], a[40:43], a[128:131], v[180:183]
s_mov_b32 vcc_hi, 0
ds_read_b128 a[108:111], v3 offset:43008
v_bfe_u32 v232, v1, 6, 3
v_mfma_f32_16x16x32_bf16 v[180:183], a[44:47], a[132:135], v[180:183]
v_lshl_add_u32 v232, v232, 11, s22
v_bfe_u32 v233, v1, 4, 2
v_mfma_f32_16x16x32_bf16 v[184:187], a[48:51], a[128:131], v[184:187]
ds_read_b128 a[112:115], v2 offset:45056
v_lshl_add_u32 v232, v233, 7, v232
v_mfma_f32_16x16x32_bf16 v[184:187], a[52:55], a[132:135], v[184:187]
v_cndmask_b32 v20, v20, v232, vcc
v_mfma_f32_16x16x32_bf16 v[188:191], a[56:59], a[128:131], v[188:191]
v_mfma_f32_16x16x32_bf16 v[188:191], a[60:63], a[132:135], v[188:191]
s_waitcnt lgkmcnt(2)
v_mfma_f32_16x16x32_bf16 v[192:195], a[0:3], a[136:139], v[192:195]
ds_read_b64_tr_b16 a[128:129], v10 offset:0
v_mfma_f32_16x16x32_bf16 v[192:195], a[4:7], a[140:143], v[192:195]
v_mfma_f32_16x16x32_bf16 v[196:199], a[8:11], a[136:139], v[196:199]
ds_read_b64_tr_b16 a[130:131], v10 offset:2048
v_mfma_f32_16x16x32_bf16 v[196:199], a[12:15], a[140:143], v[196:199]
v_mfma_f32_16x16x32_bf16 v[200:203], a[16:19], a[136:139], v[200:203]
ds_read_b64_tr_b16 a[132:133], v10 offset:16384
v_mfma_f32_16x16x32_bf16 v[200:203], a[20:23], a[140:143], v[200:203]
buffer_store_dwordx4 a[184:187], v224, s[4:7], s56 offen sc1
v_mfma_f32_16x16x32_bf16 v[204:207], a[24:27], a[136:139], v[204:207]
s_add_u32 s56, s56, 33792
ds_read_b64_tr_b16 a[134:135], v10 offset:18432
v_mfma_f32_16x16x32_bf16 v[204:207], a[28:31], a[140:143], v[204:207]
v_mfma_f32_16x16x32_bf16 v[208:211], a[32:35], a[136:139], v[208:211]
ds_read_b128 a[116:119], v3 offset:45056
v_mfma_f32_16x16x32_bf16 v[208:211], a[36:39], a[140:143], v[208:211]
v_mfma_f32_16x16x32_bf16 v[212:215], a[40:43], a[136:139], v[212:215]
ds_read_b128 a[120:123], v2 offset:47104
v_mfma_f32_16x16x32_bf16 v[212:215], a[44:47], a[140:143], v[212:215]
v_mfma_f32_16x16x32_bf16 v[216:219], a[48:51], a[136:139], v[216:219]
v_mfma_f32_16x16x32_bf16 v[216:219], a[52:55], a[140:143], v[216:219]
v_mfma_f32_16x16x32_bf16 v[220:223], a[56:59], a[136:139], v[220:223]
ds_read_b128 a[124:127], v3 offset:47104
v_mfma_f32_16x16x32_bf16 v[220:223], a[60:63], a[140:143], v[220:223]
s_waitcnt lgkmcnt(3)
v_mfma_f32_16x16x32_bf16 a[192:195], a[0:3], a[128:131], a[192:195]
ds_read_b64_tr_b16 a[136:137], v11 offset:0
v_mfma_f32_16x16x32_bf16 a[192:195], a[4:7], a[132:135], a[192:195]
v_mfma_f32_16x16x32_bf16 a[196:199], a[8:11], a[128:131], a[196:199]
ds_read_b64_tr_b16 a[138:139], v11 offset:2048
v_mfma_f32_16x16x32_bf16 a[196:199], a[12:15], a[132:135], a[196:199]
v_mfma_f32_16x16x32_bf16 a[200:203], a[16:19], a[128:131], a[200:203]
ds_read_b64_tr_b16 a[140:141], v11 offset:16384
v_mfma_f32_16x16x32_bf16 a[200:203], a[20:23], a[132:135], a[200:203]
v_mfma_f32_16x16x32_bf16 a[204:207], a[24:27], a[128:131], a[204:207]
ds_read_b64_tr_b16 a[142:143], v11 offset:18432
v_mfma_f32_16x16x32_bf16 a[204:207], a[28:31], a[132:135], a[204:207]
buffer_store_dwordx4 a[188:191], v224, s[4:7], s56 offen sc1
v_mfma_f32_16x16x32_bf16 a[208:211], a[32:35], a[128:131], a[208:211]
s_add_u32 s56, s56, 33792
v_mfma_f32_16x16x32_bf16 a[208:211], a[36:39], a[132:135], a[208:211]
v_mfma_f32_16x16x32_bf16 a[212:215], a[40:43], a[128:131], a[212:215]
v_mfma_f32_16x16x32_bf16 a[212:215], a[44:47], a[132:135], a[212:215]
v_mfma_f32_16x16x32_bf16 a[216:219], a[48:51], a[128:131], a[216:219]
v_mfma_f32_16x16x32_bf16 a[216:219], a[52:55], a[132:135], a[216:219]
v_mfma_f32_16x16x32_bf16 a[220:223], a[56:59], a[128:131], a[220:223]
s_waitcnt vmcnt(4) lgkmcnt(0)
v_mfma_f32_16x16x32_bf16 a[220:223], a[60:63], a[132:135], a[220:223]
s_barrier
v_mfma_f32_16x16x32_bf16 a[224:227], a[0:3], a[136:139], a[224:227]
s_add_u32 m0, s29, 65536
ds_read_b64_tr_b16 a[128:129], v4 offset:32768
v_mfma_f32_16x16x32_bf16 a[224:227], a[4:7], a[140:143], a[224:227]
buffer_load_dwordx4 v16, s[12:15], s26 offen offset:0 lds
v_mfma_f32_16x16x32_bf16 a[228:231], a[8:11], a[136:139], a[228:231]
ds_read_b64_tr_b16 a[130:131], v4 offset:34816
v_cmp_gt_u32 vcc, s50, v21
v_mfma_f32_16x16x32_bf16 a[228:231], a[12:15], a[140:143], a[228:231]
v_mfma_f32_16x16x32_bf16 a[232:235], a[16:19], a[136:139], a[232:235]
ds_read_b64_tr_b16 a[132:133], v4 offset:49152
v_mfma_f32_16x16x32_bf16 a[232:235], a[20:23], a[140:143], a[232:235]
buffer_load_dwordx4 v17, s[12:15], s26 offen offset:1024 lds
v_mfma_f32_16x16x32_bf16 a[236:239], a[24:27], a[136:139], a[236:239]
ds_read_b64_tr_b16 a[134:135], v4 offset:51200
v_mfma_f32_16x16x32_bf16 a[236:239], a[28:31], a[140:143], a[236:239]
v_mfma_f32_16x16x32_bf16 a[240:243], a[32:35], a[136:139], a[240:243]
v_mfma_f32_16x16x32_bf16 a[240:243], a[36:39], a[140:143], a[240:243]
buffer_load_dwordx4 v18, s[12:15], s26 offen offset:2048 lds
v_mfma_f32_16x16x32_bf16 a[244:247], a[40:43], a[136:139], a[244:247]
v_mfma_f32_16x16x32_bf16 a[244:247], a[44:47], a[140:143], a[244:247]
v_mfma_f32_16x16x32_bf16 a[248:251], a[48:51], a[136:139], a[248:251]
v_mfma_f32_16x16x32_bf16 a[248:251], a[52:55], a[140:143], a[248:251]
buffer_load_dwordx4 v19, s[12:15], s26 offen offset:3072 lds
v_mfma_f32_16x16x32_bf16 a[252:255], a[56:59], a[136:139], a[252:255]
s_add_u32 s26, s26, 524288
v_mfma_f32_16x16x32_bf16 a[252:255], a[60:63], a[140:143], a[252:255]
s_waitcnt lgkmcnt(0)
s_mov_b32 s82, s59
s_cbranch_vccnz M_cntspinV
s_branch Lg_501
PAD_25:
s_cbranch_execz PAD_29
Lg_501t:
buffer_load_dword v230, v231, s[4:7], s52 offen sc1
v_mfma_f32_16x16x32_bf16 v[32:35], a[64:67], a[128:131], v[32:35]
s_add_u32 m0, s29, 81920
ds_read_b64_tr_b16 a[136:137], v5 offset:32768
v_mfma_f32_16x16x32_bf16 v[32:35], a[68:71], a[132:135], v[32:35]
buffer_load_dwordx4 v16, s[12:15], s27 offen offset:0 lds
v_mfma_f32_16x16x32_bf16 v[36:39], a[72:75], a[128:131], v[36:39]
s_and_b32 s44, s3, 1
ds_read_b64_tr_b16 a[138:139], v5 offset:34816
v_mfma_f32_16x16x32_bf16 v[36:39], a[76:79], a[132:135], v[36:39]
s_lshl_b32 s44, s44, 8
v_mfma_f32_16x16x32_bf16 v[40:43], a[80:83], a[128:131], v[40:43]
s_lshl_b32 s45, s3, 7
ds_read_b64_tr_b16 a[140:141], v5 offset:49152
v_mfma_f32_16x16x32_bf16 v[40:43], a[84:87], a[132:135], v[40:43]
s_xor_b32 s44, s44, s45
buffer_load_dwordx4 v17, s[12:15], s27 offen offset:1024 lds
v_mfma_f32_16x16x32_bf16 v[44:47], a[88:91], a[128:131], v[44:47]
s_xor_b32 s44, s44, 196608
ds_read_b64_tr_b16 a[142:143], v5 offset:51200
v_mfma_f32_16x16x32_bf16 v[44:47], a[92:95], a[132:135], v[44:47]
v_mfma_f32_16x16x32_bf16 v[48:51], a[96:99], a[128:131], v[48:51]
ds_read_b128 a[0:3], v2 offset:0
v_mfma_f32_16x16x32_bf16 v[48:51], a[100:103], a[132:135], v[48:51]
buffer_load_dwordx4 v18, s[12:15], s27 offen offset:2048 lds
v_mfma_f32_16x16x32_bf16 v[52:55], a[104:107], a[128:131], v[52:55]
ds_read_b128 a[4:7], v3 offset:0
v_mfma_f32_16x16x32_bf16 v[52:55], a[108:111], a[132:135], v[52:55]
v_mfma_f32_16x16x32_bf16 v[56:59], a[112:115], a[128:131], v[56:59]
v_mfma_f32_16x16x32_bf16 v[56:59], a[116:119], a[132:135], v[56:59]
buffer_load_dwordx4 v19, s[12:15], s27 offen offset:3072 lds
v_mfma_f32_16x16x32_bf16 v[60:63], a[120:123], a[128:131], v[60:63]
s_add_u32 s27, s27, 524288
ds_read_b128 a[8:11], v2 offset:2048
v_mfma_f32_16x16x32_bf16 v[60:63], a[124:127], a[132:135], v[60:63]
s_waitcnt lgkmcnt(3)
v_mfma_f32_16x16x32_bf16 v[64:67], a[64:67], a[136:139], v[64:67]
s_add_u32 m0, s28, 32768
ds_read_b64_tr_b16 a[128:129], v6 offset:32768
v_mfma_f32_16x16x32_bf16 v[64:67], a[68:71], a[140:143], v[64:67]
buffer_load_dwordx4 v12, s[8:11], s24 offen offset:0 lds
v_mfma_f32_16x16x32_bf16 v[68:71], a[72:75], a[136:139], v[68:71]
ds_read_b64_tr_b16 a[130:131], v6 offset:34816
v_mfma_f32_16x16x32_bf16 v[68:71], a[76:79], a[140:143], v[68:71]
v_mfma_f32_16x16x32_bf16 v[72:75], a[80:83], a[136:139], v[72:75]
s_mov_b64 s[56:57], s[72:73]
ds_read_b64_tr_b16 a[132:133], v6 offset:49152
v_mfma_f32_16x16x32_bf16 v[72:75], a[84:87], a[140:143], v[72:75]
s_mov_b32 s58, 1835008
buffer_load_dwordx4 v13, s[8:11], s24 offen offset:1024 lds
v_mfma_f32_16x16x32_bf16 v[76:79], a[88:91], a[136:139], v[76:79]
s_mov_b32 s59, 0x20000
ds_read_b64_tr_b16 a[134:135], v6 offset:51200
v_mfma_f32_16x16x32_bf16 v[76:79], a[92:95], a[140:143], v[76:79]
v_mfma_f32_16x16x32_bf16 v[80:83], a[96:99], a[136:139], v[80:83]
ds_read_b128 a[12:15], v3 offset:2048
v_mfma_f32_16x16x32_bf16 v[80:83], a[100:103], a[140:143], v[80:83]
buffer_load_dwordx4 v14, s[8:11], s24 offen offset:2048 lds
v_mfma_f32_16x16x32_bf16 v[84:87], a[104:107], a[136:139], v[84:87]
v_mfma_f32_16x16x32_bf16 v[84:87], a[108:111], a[140:143], v[84:87]
v_mfma_f32_16x16x32_bf16 v[88:91], a[112:115], a[136:139], v[88:91]
ds_read_b128 a[16:19], v2 offset:4096
v_mfma_f32_16x16x32_bf16 v[88:91], a[116:119], a[140:143], v[88:91]
buffer_load_dwordx4 v15, s[8:11], s24 offen offset:3072 lds
v_mfma_f32_16x16x32_bf16 v[92:95], a[120:123], a[136:139], v[92:95]
s_add_u32 s24, s24, 128
ds_read_b128 a[20:23], v3 offset:4096
v_mfma_f32_16x16x32_bf16 v[92:95], a[124:127], a[140:143], v[92:95]
PAD_26:
s_cbranch_execz PAD_30
s_waitcnt lgkmcnt(3)
v_mfma_f32_16x16x32_bf16 v[96:99], a[64:67], a[128:131], v[96:99]
s_add_u32 m0, s28, 36864
ds_read_b64_tr_b16 a[136:137], v7 offset:32768
v_mfma_f32_16x16x32_bf16 v[96:99], a[68:71], a[132:135], v[96:99]
buffer_load_dwordx4 v12, s[8:11], s25 offen offset:0 lds
v_mfma_f32_16x16x32_bf16 v[100:103], a[72:75], a[128:131], v[100:103]
ds_read_b64_tr_b16 a[138:139], v7 offset:34816
v_mfma_f32_16x16x32_bf16 v[100:103], a[76:79], a[132:135], v[100:103]
v_mfma_f32_16x16x32_bf16 v[104:107], a[80:83], a[128:131], v[104:107]
ds_read_b64_tr_b16 a[140:141], v7 offset:49152
v_mfma_f32_16x16x32_bf16 v[104:107], a[84:87], a[132:135], v[104:107]
buffer_load_dwordx4 v13, s[8:11], s25 offen offset:1024 lds
v_mfma_f32_16x16x32_bf16 v[108:111], a[88:91], a[128:131], v[108:111]
ds_read_b64_tr_b16 a[142:143], v7 offset:51200
v_mfma_f32_16x16x32_bf16 v[108:111], a[92:95], a[132:135], v[108:111]
v_mfma_f32_16x16x32_bf16 v[112:115], a[96:99], a[128:131], v[112:115]
v_mfma_f32_16x16x32_bf16 v[112:115], a[100:103], a[132:135], v[112:115]
buffer_load_dwordx4 v14, s[8:11], s25 offen offset:2048 lds
v_mfma_f32_16x16x32_bf16 v[116:119], a[104:107], a[128:131], v[116:119]
ds_read_b128 a[24:27], v2 offset:6144
v_mfma_f32_16x16x32_bf16 v[116:119], a[108:111], a[132:135], v[116:119]
v_mfma_f32_16x16x32_bf16 v[120:123], a[112:115], a[128:131], v[120:123]
ds_read_b128 a[28:31], v3 offset:6144
v_mfma_f32_16x16x32_bf16 v[120:123], a[116:119], a[132:135], v[120:123]
buffer_load_dwordx4 v15, s[8:11], s25 offen offset:3072 lds
v_mfma_f32_16x16x32_bf16 v[124:127], a[120:123], a[128:131], v[124:127]
s_add_u32 s25, s25, 128
s_waitcnt vmcnt(12)
v_mfma_f32_16x16x32_bf16 v[124:127], a[124:127], a[132:135], v[124:127]
s_waitcnt lgkmcnt(2)
v_cmp_gt_u32 vcc, 1, v230
v_mfma_f32_16x16x32_bf16 v[128:131], a[64:67], a[136:139], v[128:131]
s_cbranch_vccnz M_ppspinV
M_ppokV:
ds_read_b64_tr_b16 a[128:129], v8 offset:32768
v_mfma_f32_16x16x32_bf16 v[128:131], a[68:71], a[140:143], v[128:131]
buffer_load_dword v230, v229, s[4:7], s53 offen sc1
v_mfma_f32_16x16x32_bf16 v[132:135], a[72:75], a[136:139], v[132:135]
s_mov_b64 s[8:9], s[76:77]
ds_read_b64_tr_b16 a[130:131], v8 offset:34816
v_mfma_f32_16x16x32_bf16 v[132:135], a[76:79], a[140:143], v[132:135]
s_mov_b32 s10, 1835008
buffer_load_dword v230, v229, s[4:7], s48 offen sc1
v_mfma_f32_16x16x32_bf16 v[136:139], a[80:83], a[136:139], v[136:139]
s_lshl_b32 s24, s37, 2
ds_read_b64_tr_b16 a[132:133], v8 offset:49152
v_mfma_f32_16x16x32_bf16 v[136:139], a[84:87], a[140:143], v[136:139]
s_add_u32 s24, s24, s3
buffer_load_dword v230, v229, s[56:59], s49 offen
v_mfma_f32_16x16x32_bf16 v[140:143], a[88:91], a[136:139], v[140:143]
s_mul_i32 s24, s24, 28672
ds_read_b64_tr_b16 a[134:135], v8 offset:51200
v_mfma_f32_16x16x32_bf16 v[140:143], a[92:95], a[140:143], v[140:143]
s_mov_b32 s28, s29
v_mfma_f32_16x16x32_bf16 v[144:147], a[96:99], a[136:139], v[144:147]
ds_read_b128 a[32:35], v2 offset:8192
v_mfma_f32_16x16x32_bf16 v[144:147], a[100:103], a[140:143], v[144:147]
v_mfma_f32_16x16x32_bf16 v[148:151], a[104:107], a[136:139], v[148:151]
v_mfma_f32_16x16x32_bf16 v[148:151], a[108:111], a[140:143], v[148:151]
v_mfma_f32_16x16x32_bf16 v[152:155], a[112:115], a[136:139], v[152:155]
ds_read_b128 a[36:39], v3 offset:8192
v_lshrrev_b32 v28, 7, v1
v_mfma_f32_16x16x32_bf16 v[152:155], a[116:119], a[140:143], v[152:155]
v_lshrrev_b32 v29, 1, v28
v_lshlrev_b32 v29, 4, v29
v_mfma_f32_16x16x32_bf16 v[156:159], a[120:123], a[136:139], v[156:159]
ds_read_b128 a[40:43], v2 offset:10240
v_and_b32 v30, 0x70, v1
v_mfma_f32_16x16x32_bf16 v[156:159], a[124:127], a[140:143], v[156:159]
s_waitcnt lgkmcnt(3)
v_xor_b32 v29, v29, v30
v_mul_u32_u24 v28, 896, v28
v_mfma_f32_16x16x32_bf16 v[160:163], a[64:67], a[128:131], v[160:163]
ds_read_b64_tr_b16 a[136:137], v9 offset:32768
v_add_u32 v12, v28, v29
v_mfma_f32_16x16x32_bf16 v[160:163], a[68:71], a[132:135], v[160:163]
v_xor_b32 v29, 64, v29
v_add_u32 v28, v28, v29
v_mfma_f32_16x16x32_bf16 v[164:167], a[72:75], a[128:131], v[164:167]
ds_read_b64_tr_b16 a[138:139], v9 offset:34816
v_add_u32 v13, 6144, v28
v_mfma_f32_16x16x32_bf16 v[164:167], a[76:79], a[132:135], v[164:167]
v_add_u32 v14, 12288, v12
v_add_u32 v15, 18432, v28
v_mfma_f32_16x16x32_bf16 v[168:171], a[80:83], a[128:131], v[168:171]
ds_read_b64_tr_b16 a[140:141], v9 offset:49152
v_xor_b32 v22, s44, v4
v_mfma_f32_16x16x32_bf16 v[168:171], a[84:87], a[132:135], v[168:171]
v_xor_b32 v23, 32, v22
v_xor_b32 v24, 64, v22
v_mfma_f32_16x16x32_bf16 v[172:175], a[88:91], a[128:131], v[172:175]
ds_read_b64_tr_b16 a[142:143], v9 offset:51200
v_xor_b32 v25, 96, v22
v_mfma_f32_16x16x32_bf16 v[172:175], a[92:95], a[132:135], v[172:175]
v_mfma_f32_16x16x32_bf16 v[176:179], a[96:99], a[128:131], v[176:179]
v_mfma_f32_16x16x32_bf16 v[176:179], a[100:103], a[132:135], v[176:179]
v_mfma_f32_16x16x32_bf16 v[180:183], a[104:107], a[128:131], v[180:183]
ds_read_b128 a[44:47], v3 offset:10240
v_mfma_f32_16x16x32_bf16 v[180:183], a[108:111], a[132:135], v[180:183]
v_mfma_f32_16x16x32_bf16 v[184:187], a[112:115], a[128:131], v[184:187]
ds_read_b128 a[48:51], v2 offset:12288
v_mfma_f32_16x16x32_bf16 v[184:187], a[116:119], a[132:135], v[184:187]
v_mfma_f32_16x16x32_bf16 v[188:191], a[120:123], a[128:131], v[188:191]
v_mfma_f32_16x16x32_bf16 v[188:191], a[124:127], a[132:135], v[188:191]
s_waitcnt lgkmcnt(2)
v_mfma_f32_16x16x32_bf16 v[192:195], a[64:67], a[136:139], v[192:195]
ds_read_b64_tr_b16 a[128:129], v10 offset:32768
v_mfma_f32_16x16x32_bf16 v[192:195], a[68:71], a[140:143], v[192:195]
v_mfma_f32_16x16x32_bf16 v[196:199], a[72:75], a[136:139], v[196:199]
ds_read_b64_tr_b16 a[130:131], v10 offset:34816
v_mfma_f32_16x16x32_bf16 v[196:199], a[76:79], a[140:143], v[196:199]
v_mfma_f32_16x16x32_bf16 v[200:203], a[80:83], a[136:139], v[200:203]
ds_read_b64_tr_b16 a[132:133], v10 offset:49152
v_mfma_f32_16x16x32_bf16 v[200:203], a[84:87], a[140:143], v[200:203]
v_mfma_f32_16x16x32_bf16 v[204:207], a[88:91], a[136:139], v[204:207]
ds_read_b64_tr_b16 a[134:135], v10 offset:51200
v_mfma_f32_16x16x32_bf16 v[204:207], a[92:95], a[140:143], v[204:207]
v_mfma_f32_16x16x32_bf16 v[208:211], a[96:99], a[136:139], v[208:211]
ds_read_b128 a[52:55], v3 offset:12288
v_mfma_f32_16x16x32_bf16 v[208:211], a[100:103], a[140:143], v[208:211]
v_mfma_f32_16x16x32_bf16 v[212:215], a[104:107], a[136:139], v[212:215]
ds_read_b128 a[56:59], v2 offset:14336
v_mfma_f32_16x16x32_bf16 v[212:215], a[108:111], a[140:143], v[212:215]
v_mfma_f32_16x16x32_bf16 v[216:219], a[112:115], a[136:139], v[216:219]
v_mfma_f32_16x16x32_bf16 v[216:219], a[116:119], a[140:143], v[216:219]
v_mfma_f32_16x16x32_bf16 v[220:223], a[120:123], a[136:139], v[220:223]
ds_read_b128 a[60:63], v3 offset:14336
v_mfma_f32_16x16x32_bf16 v[220:223], a[124:127], a[140:143], v[220:223]
s_waitcnt lgkmcnt(3)
v_mfma_f32_16x16x32_bf16 a[192:195], a[64:67], a[128:131], a[192:195]
ds_read_b64_tr_b16 a[136:137], v11 offset:32768
v_mfma_f32_16x16x32_bf16 a[192:195], a[68:71], a[132:135], a[192:195]
v_mfma_f32_16x16x32_bf16 a[196:199], a[72:75], a[128:131], a[196:199]
ds_read_b64_tr_b16 a[138:139], v11 offset:34816
v_mfma_f32_16x16x32_bf16 a[196:199], a[76:79], a[132:135], a[196:199]
v_mfma_f32_16x16x32_bf16 a[200:203], a[80:83], a[128:131], a[200:203]
ds_read_b64_tr_b16 a[140:141], v11 offset:49152
v_mfma_f32_16x16x32_bf16 a[200:203], a[84:87], a[132:135], a[200:203]
v_mfma_f32_16x16x32_bf16 a[204:207], a[88:91], a[128:131], a[204:207]
ds_read_b64_tr_b16 a[142:143], v11 offset:51200
v_mfma_f32_16x16x32_bf16 a[204:207], a[92:95], a[132:135], a[204:207]
v_mfma_f32_16x16x32_bf16 a[208:211], a[96:99], a[128:131], a[208:211]
v_mfma_f32_16x16x32_bf16 a[208:211], a[100:103], a[132:135], a[208:211]
v_mfma_f32_16x16x32_bf16 a[212:215], a[104:107], a[128:131], a[212:215]
v_mfma_f32_16x16x32_bf16 a[212:215], a[108:111], a[132:135], a[212:215]
v_mfma_f32_16x16x32_bf16 a[216:219], a[112:115], a[128:131], a[216:219]
v_mfma_f32_16x16x32_bf16 a[216:219], a[116:119], a[132:135], a[216:219]
v_mfma_f32_16x16x32_bf16 a[220:223], a[120:123], a[128:131], a[220:223]
s_waitcnt vmcnt(3) lgkmcnt(0)
v_mfma_f32_16x16x32_bf16 a[220:223], a[124:127], a[132:135], a[220:223]
s_barrier
v_mfma_f32_16x16x32_bf16 a[224:227], a[64:67], a[136:139], a[224:227]
s_add_u32 m0, s29, 98304
ds_read_b64_tr_b16 a[128:129], v4 offset:0
v_mfma_f32_16x16x32_bf16 a[224:227], a[68:71], a[140:143], a[224:227]
buffer_load_dwordx4 v16, s[12:15], s26 offen offset:0 lds
v_mfma_f32_16x16x32_bf16 a[228:231], a[72:75], a[136:139], a[228:231]
ds_read_b64_tr_b16 a[130:131], v4 offset:2048
v_mfma_f32_16x16x32_bf16 a[228:231], a[76:79], a[140:143], a[228:231]
v_mfma_f32_16x16x32_bf16 a[232:235], a[80:83], a[136:139], a[232:235]
ds_read_b64_tr_b16 a[132:133], v4 offset:16384
v_mfma_f32_16x16x32_bf16 a[232:235], a[84:87], a[140:143], a[232:235]
buffer_load_dwordx4 v17, s[12:15], s26 offen offset:1024 lds
v_mfma_f32_16x16x32_bf16 a[236:239], a[88:91], a[136:139], a[236:239]
ds_read_b64_tr_b16 a[134:135], v4 offset:18432
v_mfma_f32_16x16x32_bf16 a[236:239], a[92:95], a[140:143], a[236:239]
v_mfma_f32_16x16x32_bf16 a[240:243], a[96:99], a[136:139], a[240:243]
v_mfma_f32_16x16x32_bf16 a[240:243], a[100:103], a[140:143], a[240:243]
buffer_load_dwordx4 v18, s[12:15], s26 offen offset:2048 lds
v_mfma_f32_16x16x32_bf16 a[244:247], a[104:107], a[136:139], a[244:247]
v_mfma_f32_16x16x32_bf16 a[244:247], a[108:111], a[140:143], a[244:247]
v_mfma_f32_16x16x32_bf16 a[248:251], a[112:115], a[136:139], a[248:251]
v_mfma_f32_16x16x32_bf16 a[248:251], a[116:119], a[140:143], a[248:251]
buffer_load_dwordx4 v19, s[12:15], s26 offen offset:3072 lds
v_mfma_f32_16x16x32_bf16 a[252:255], a[120:123], a[136:139], a[252:255]
s_add_u32 s26, s26, 524288
v_mfma_f32_16x16x32_bf16 a[252:255], a[124:127], a[140:143], a[252:255]
s_waitcnt lgkmcnt(0)
v_mfma_f32_16x16x32_bf16 v[32:35], a[0:3], a[128:131], v[32:35]
s_add_u32 m0, s29, 114688
ds_read_b64_tr_b16 a[136:137], v5 offset:0
v_mfma_f32_16x16x32_bf16 v[32:35], a[4:7], a[132:135], v[32:35]
buffer_load_dwordx4 v16, s[12:15], s27 offen offset:0 lds
v_mfma_f32_16x16x32_bf16 v[36:39], a[8:11], a[128:131], v[36:39]
ds_read_b64_tr_b16 a[138:139], v5 offset:2048
v_mfma_f32_16x16x32_bf16 v[36:39], a[12:15], a[132:135], v[36:39]
v_mfma_f32_16x16x32_bf16 v[40:43], a[16:19], a[128:131], v[40:43]
ds_read_b64_tr_b16 a[140:141], v5 offset:16384
v_mfma_f32_16x16x32_bf16 v[40:43], a[20:23], a[132:135], v[40:43]
buffer_load_dwordx4 v17, s[12:15], s27 offen offset:1024 lds
v_mfma_f32_16x16x32_bf16 v[44:47], a[24:27], a[128:131], v[44:47]
ds_read_b64_tr_b16 a[142:143], v5 offset:18432
v_mfma_f32_16x16x32_bf16 v[44:47], a[28:31], a[132:135], v[44:47]
v_mfma_f32_16x16x32_bf16 v[48:51], a[32:35], a[128:131], v[48:51]
ds_read_b128 a[64:67], v2 offset:32768
v_mfma_f32_16x16x32_bf16 v[48:51], a[36:39], a[132:135], v[48:51]
buffer_load_dwordx4 v18, s[12:15], s27 offen offset:2048 lds
v_mfma_f32_16x16x32_bf16 v[52:55], a[40:43], a[128:131], v[52:55]
ds_read_b128 a[68:71], v3 offset:32768
v_mfma_f32_16x16x32_bf16 v[52:55], a[44:47], a[132:135], v[52:55]
v_mfma_f32_16x16x32_bf16 v[56:59], a[48:51], a[128:131], v[56:59]
v_mfma_f32_16x16x32_bf16 v[56:59], a[52:55], a[132:135], v[56:59]
buffer_load_dwordx4 v19, s[12:15], s27 offen offset:3072 lds
v_mfma_f32_16x16x32_bf16 v[60:63], a[56:59], a[128:131], v[60:63]
s_add_u32 s27, s27, 524288
ds_read_b128 a[72:75], v2 offset:34816
v_mfma_f32_16x16x32_bf16 v[60:63], a[60:63], a[132:135], v[60:63]
s_waitcnt lgkmcnt(3)
v_mfma_f32_16x16x32_bf16 v[64:67], a[0:3], a[136:139], v[64:67]
s_add_u32 m0, s28, 0
ds_read_b64_tr_b16 a[128:129], v6 offset:0
v_mfma_f32_16x16x32_bf16 v[64:67], a[4:7], a[140:143], v[64:67]
buffer_load_dwordx4 v12, s[8:11], s24 offen offset:0 lds
v_mfma_f32_16x16x32_bf16 v[68:71], a[8:11], a[136:139], v[68:71]
ds_read_b64_tr_b16 a[130:131], v6 offset:2048
v_mfma_f32_16x16x32_bf16 v[68:71], a[12:15], a[140:143], v[68:71]
v_mfma_f32_16x16x32_bf16 v[72:75], a[16:19], a[136:139], v[72:75]
ds_read_b64_tr_b16 a[132:133], v6 offset:16384
v_mfma_f32_16x16x32_bf16 v[72:75], a[20:23], a[140:143], v[72:75]
buffer_load_dwordx4 v13, s[8:11], s24 offen offset:1024 lds
v_mfma_f32_16x16x32_bf16 v[76:79], a[24:27], a[136:139], v[76:79]
ds_read_b64_tr_b16 a[134:135], v6 offset:18432
v_mfma_f32_16x16x32_bf16 v[76:79], a[28:31], a[140:143], v[76:79]
v_mfma_f32_16x16x32_bf16 v[80:83], a[32:35], a[136:139], v[80:83]
ds_read_b128 a[76:79], v3 offset:34816
v_mfma_f32_16x16x32_bf16 v[80:83], a[36:39], a[140:143], v[80:83]
buffer_load_dwordx4 v14, s[8:11], s24 offen offset:2048 lds
v_mfma_f32_16x16x32_bf16 v[84:87], a[40:43], a[136:139], v[84:87]
v_mfma_f32_16x16x32_bf16 v[84:87], a[44:47], a[140:143], v[84:87]
v_mfma_f32_16x16x32_bf16 v[88:91], a[48:51], a[136:139], v[88:91]
ds_read_b128 a[80:83], v2 offset:36864
v_mfma_f32_16x16x32_bf16 v[88:91], a[52:55], a[140:143], v[88:91]
buffer_load_dwordx4 v15, s[8:11], s24 offen offset:3072 lds
v_mfma_f32_16x16x32_bf16 v[92:95], a[56:59], a[136:139], v[92:95]
s_add_u32 s24, s24, 128
ds_read_b128 a[84:87], v3 offset:36864
v_mfma_f32_16x16x32_bf16 v[92:95], a[60:63], a[140:143], v[92:95]
s_waitcnt lgkmcnt(3)
s_mov_b64 s[12:13], s[80:81]
v_mfma_f32_16x16x32_bf16 v[96:99], a[0:3], a[128:131], v[96:99]
s_mov_b32 s14, 3670016
s_add_u32 m0, s28, 16384
ds_read_b64_tr_b16 a[136:137], v7 offset:0
v_mfma_f32_16x16x32_bf16 v[96:99], a[4:7], a[132:135], v[96:99]
buffer_load_dwordx4 v12, s[8:11], s24 offen offset:0 lds
v_mfma_f32_16x16x32_bf16 v[100:103], a[8:11], a[128:131], v[100:103]
ds_read_b64_tr_b16 a[138:139], v7 offset:2048
v_mfma_f32_16x16x32_bf16 v[100:103], a[12:15], a[132:135], v[100:103]
v_mfma_f32_16x16x32_bf16 v[104:107], a[16:19], a[128:131], v[104:107]
ds_read_b64_tr_b16 a[140:141], v7 offset:16384
v_mfma_f32_16x16x32_bf16 v[104:107], a[20:23], a[132:135], v[104:107]
buffer_load_dwordx4 v13, s[8:11], s24 offen offset:1024 lds
v_mfma_f32_16x16x32_bf16 v[108:111], a[24:27], a[128:131], v[108:111]
ds_read_b64_tr_b16 a[142:143], v7 offset:18432
v_mfma_f32_16x16x32_bf16 v[108:111], a[28:31], a[132:135], v[108:111]
v_mfma_f32_16x16x32_bf16 v[112:115], a[32:35], a[128:131], v[112:115]
v_mfma_f32_16x16x32_bf16 v[112:115], a[36:39], a[132:135], v[112:115]
buffer_load_dwordx4 v14, s[8:11], s24 offen offset:2048 lds
v_mfma_f32_16x16x32_bf16 v[116:119], a[40:43], a[128:131], v[116:119]
ds_read_b128 a[88:91], v2 offset:38912
v_mfma_f32_16x16x32_bf16 v[116:119], a[44:47], a[132:135], v[116:119]
v_mfma_f32_16x16x32_bf16 v[120:123], a[48:51], a[128:131], v[120:123]
ds_read_b128 a[92:95], v3 offset:38912
v_mfma_f32_16x16x32_bf16 v[120:123], a[52:55], a[132:135], v[120:123]
buffer_load_dwordx4 v15, s[8:11], s24 offen offset:3072 lds
v_mfma_f32_16x16x32_bf16 v[124:127], a[56:59], a[128:131], v[124:127]
s_add_u32 s24, s24, 128
v_mfma_f32_16x16x32_bf16 v[124:127], a[60:63], a[132:135], v[124:127]
s_waitcnt lgkmcnt(2)
s_sub_u32 s26, s26, 8388608
v_mfma_f32_16x16x32_bf16 v[128:131], a[0:3], a[136:139], v[128:131]
s_sub_u32 s27, s27, 8388608
s_add_u32 m0, s29, 131072
ds_read_b64_tr_b16 a[128:129], v8 offset:0
v_mfma_f32_16x16x32_bf16 v[128:131], a[4:7], a[140:143], v[128:131]
buffer_load_dwordx4 v16, s[12:15], s26 offen offset:0 lds
v_mfma_f32_16x16x32_bf16 v[132:135], a[8:11], a[136:139], v[132:135]
ds_read_b64_tr_b16 a[130:131], v8 offset:2048
v_mfma_f32_16x16x32_bf16 v[132:135], a[12:15], a[140:143], v[132:135]
v_mfma_f32_16x16x32_bf16 v[136:139], a[16:19], a[136:139], v[136:139]
ds_read_b64_tr_b16 a[132:133], v8 offset:16384
v_mfma_f32_16x16x32_bf16 v[136:139], a[20:23], a[140:143], v[136:139]
buffer_load_dwordx4 v17, s[12:15], s26 offen offset:1024 lds
v_mfma_f32_16x16x32_bf16 v[140:143], a[24:27], a[136:139], v[140:143]
ds_read_b64_tr_b16 a[134:135], v8 offset:18432
v_mfma_f32_16x16x32_bf16 v[140:143], a[28:31], a[140:143], v[140:143]
v_mfma_f32_16x16x32_bf16 v[144:147], a[32:35], a[136:139], v[144:147]
ds_read_b128 a[96:99], v2 offset:40960
v_mfma_f32_16x16x32_bf16 v[144:147], a[36:39], a[140:143], v[144:147]
buffer_load_dwordx4 v18, s[12:15], s26 offen offset:2048 lds
v_mfma_f32_16x16x32_bf16 v[148:151], a[40:43], a[136:139], v[148:151]
v_mfma_f32_16x16x32_bf16 v[148:151], a[44:47], a[140:143], v[148:151]
v_mfma_f32_16x16x32_bf16 v[152:155], a[48:51], a[136:139], v[152:155]
ds_read_b128 a[100:103], v3 offset:40960
v_mfma_f32_16x16x32_bf16 v[152:155], a[52:55], a[140:143], v[152:155]
buffer_load_dwordx4 v19, s[12:15], s26 offen offset:3072 lds
v_mfma_f32_16x16x32_bf16 v[156:159], a[56:59], a[136:139], v[156:159]
s_add_u32 s26, s26, 524288
ds_read_b128 a[104:107], v2 offset:43008
v_mfma_f32_16x16x32_bf16 v[156:159], a[60:63], a[140:143], v[156:159]
s_waitcnt lgkmcnt(3)
v_mfma_f32_16x16x32_bf16 v[160:163], a[0:3], a[128:131], v[160:163]
s_add_u32 m0, s29, 147456
ds_read_b64_tr_b16 a[136:137], v9 offset:0
v_mfma_f32_16x16x32_bf16 v[160:163], a[4:7], a[132:135], v[160:163]
buffer_load_dwordx4 v16, s[12:15], s27 offen offset:0 lds
v_mfma_f32_16x16x32_bf16 v[164:167], a[8:11], a[128:131], v[164:167]
ds_read_b64_tr_b16 a[138:139], v9 offset:2048
v_mfma_f32_16x16x32_bf16 v[164:167], a[12:15], a[132:135], v[164:167]
v_mfma_f32_16x16x32_bf16 v[168:171], a[16:19], a[128:131], v[168:171]
ds_read_b64_tr_b16 a[140:141], v9 offset:16384
v_mfma_f32_16x16x32_bf16 v[168:171], a[20:23], a[132:135], v[168:171]
buffer_load_dwordx4 v17, s[12:15], s27 offen offset:1024 lds
v_mfma_f32_16x16x32_bf16 v[172:175], a[24:27], a[128:131], v[172:175]
ds_read_b64_tr_b16 a[142:143], v9 offset:18432
v_mfma_f32_16x16x32_bf16 v[172:175], a[28:31], a[132:135], v[172:175]
v_mfma_f32_16x16x32_bf16 v[176:179], a[32:35], a[128:131], v[176:179]
v_mfma_f32_16x16x32_bf16 v[176:179], a[36:39], a[132:135], v[176:179]
buffer_load_dwordx4 v18, s[12:15], s27 offen offset:2048 lds
v_mfma_f32_16x16x32_bf16 v[180:183], a[40:43], a[128:131], v[180:183]
ds_read_b128 a[108:111], v3 offset:43008
v_mfma_f32_16x16x32_bf16 v[180:183], a[44:47], a[132:135], v[180:183]
v_mfma_f32_16x16x32_bf16 v[184:187], a[48:51], a[128:131], v[184:187]
ds_read_b128 a[112:115], v2 offset:45056
v_mfma_f32_16x16x32_bf16 v[184:187], a[52:55], a[132:135], v[184:187]
buffer_load_dwordx4 v19, s[12:15], s27 offen offset:3072 lds
v_mfma_f32_16x16x32_bf16 v[188:191], a[56:59], a[128:131], v[188:191]
s_add_u32 s27, s27, 524288
v_mfma_f32_16x16x32_bf16 v[188:191], a[60:63], a[132:135], v[188:191]
s_waitcnt lgkmcnt(2)
v_mfma_f32_16x16x32_bf16 v[192:195], a[0:3], a[136:139], v[192:195]
ds_read_b64_tr_b16 a[128:129], v10 offset:0
v_mfma_f32_16x16x32_bf16 v[192:195], a[4:7], a[140:143], v[192:195]
v_mfma_f32_16x16x32_bf16 v[196:199], a[8:11], a[136:139], v[196:199]
ds_read_b64_tr_b16 a[130:131], v10 offset:2048
v_mfma_f32_16x16x32_bf16 v[196:199], a[12:15], a[140:143], v[196:199]
v_mfma_f32_16x16x32_bf16 v[200:203], a[16:19], a[136:139], v[200:203]
ds_read_b64_tr_b16 a[132:133], v10 offset:16384
v_mfma_f32_16x16x32_bf16 v[200:203], a[20:23], a[140:143], v[200:203]
v_mfma_f32_16x16x32_bf16 v[204:207], a[24:27], a[136:139], v[204:207]
ds_read_b64_tr_b16 a[134:135], v10 offset:18432
v_mfma_f32_16x16x32_bf16 v[204:207], a[28:31], a[140:143], v[204:207]
v_mfma_f32_16x16x32_bf16 v[208:211], a[32:35], a[136:139], v[208:211]
ds_read_b128 a[116:119], v3 offset:45056
v_mfma_f32_16x16x32_bf16 v[208:211], a[36:39], a[140:143], v[208:211]
v_mfma_f32_16x16x32_bf16 v[212:215], a[40:43], a[136:139], v[212:215]
ds_read_b128 a[120:123], v2 offset:47104
v_mfma_f32_16x16x32_bf16 v[212:215], a[44:47], a[140:143], v[212:215]
v_mfma_f32_16x16x32_bf16 v[216:219], a[48:51], a[136:139], v[216:219]
v_mfma_f32_16x16x32_bf16 v[216:219], a[52:55], a[140:143], v[216:219]
v_mfma_f32_16x16x32_bf16 v[220:223], a[56:59], a[136:139], v[220:223]
ds_read_b128 a[124:127], v3 offset:47104
v_mfma_f32_16x16x32_bf16 v[220:223], a[60:63], a[140:143], v[220:223]
s_waitcnt lgkmcnt(3)
v_mfma_f32_16x16x32_bf16 a[192:195], a[0:3], a[128:131], a[192:195]
ds_read_b64_tr_b16 a[136:137], v11 offset:0
v_mfma_f32_16x16x32_bf16 a[192:195], a[4:7], a[132:135], a[192:195]
v_mfma_f32_16x16x32_bf16 a[196:199], a[8:11], a[128:131], a[196:199]
ds_read_b64_tr_b16 a[138:139], v11 offset:2048
v_mfma_f32_16x16x32_bf16 a[196:199], a[12:15], a[132:135], a[196:199]
v_mfma_f32_16x16x32_bf16 a[200:203], a[16:19], a[128:131], a[200:203]
ds_read_b64_tr_b16 a[140:141], v11 offset:16384
v_mfma_f32_16x16x32_bf16 a[200:203], a[20:23], a[132:135], a[200:203]
v_mfma_f32_16x16x32_bf16 a[204:207], a[24:27], a[128:131], a[204:207]
ds_read_b64_tr_b16 a[142:143], v11 offset:18432
v_mfma_f32_16x16x32_bf16 a[204:207], a[28:31], a[132:135], a[204:207]
v_mfma_f32_16x16x32_bf16 a[208:211], a[32:35], a[128:131], a[208:211]
v_mfma_f32_16x16x32_bf16 a[208:211], a[36:39], a[132:135], a[208:211]
v_mfma_f32_16x16x32_bf16 a[212:215], a[40:43], a[128:131], a[212:215]
v_mfma_f32_16x16x32_bf16 a[212:215], a[44:47], a[132:135], a[212:215]
v_mfma_f32_16x16x32_bf16 a[216:219], a[48:51], a[128:131], a[216:219]
v_mfma_f32_16x16x32_bf16 a[216:219], a[52:55], a[132:135], a[216:219]
v_mfma_f32_16x16x32_bf16 a[220:223], a[56:59], a[128:131], a[220:223]
s_waitcnt vmcnt(12) lgkmcnt(0)
v_mfma_f32_16x16x32_bf16 a[220:223], a[60:63], a[132:135], a[220:223]
s_barrier
v_mfma_f32_16x16x32_bf16 a[224:227], a[0:3], a[136:139], a[224:227]
s_add_u32 m0, s28, 32768
ds_read_b64_tr_b16 a[128:129], v4 offset:32768
v_mfma_f32_16x16x32_bf16 a[224:227], a[4:7], a[140:143], a[224:227]
s_lshr_b32 s22, s3, 1
buffer_load_dwordx4 v12, s[8:11], s24 offen offset:0 lds
v_mfma_f32_16x16x32_bf16 a[228:231], a[8:11], a[136:139], a[228:231]
s_lshl_b32 s22, s22, 14
ds_read_b64_tr_b16 a[130:131], v4 offset:34816
v_subrev_u32 v2, s22, v2
v_mfma_f32_16x16x32_bf16 a[228:231], a[12:15], a[140:143], a[228:231]
v_subrev_u32 v3, s22, v3
v_mfma_f32_16x16x32_bf16 a[232:235], a[16:19], a[136:139], a[232:235]
ds_read_b64_tr_b16 a[132:133], v4 offset:49152
v_mfma_f32_16x16x32_bf16 a[232:235], a[20:23], a[140:143], a[232:235]
buffer_load_dwordx4 v13, s[8:11], s24 offen offset:1024 lds
v_mfma_f32_16x16x32_bf16 a[236:239], a[24:27], a[136:139], a[236:239]
ds_read_b64_tr_b16 a[134:135], v4 offset:51200
v_mfma_f32_16x16x32_bf16 a[236:239], a[28:31], a[140:143], a[236:239]
v_mfma_f32_16x16x32_bf16 a[240:243], a[32:35], a[136:139], a[240:243]
v_mfma_f32_16x16x32_bf16 a[240:243], a[36:39], a[140:143], a[240:243]
buffer_load_dwordx4 v14, s[8:11], s24 offen offset:2048 lds
v_mfma_f32_16x16x32_bf16 a[244:247], a[40:43], a[136:139], a[244:247]
v_mfma_f32_16x16x32_bf16 a[244:247], a[44:47], a[140:143], a[244:247]
v_mfma_f32_16x16x32_bf16 a[248:251], a[48:51], a[136:139], a[248:251]
v_mfma_f32_16x16x32_bf16 a[248:251], a[52:55], a[140:143], a[248:251]
buffer_load_dwordx4 v15, s[8:11], s24 offen offset:3072 lds
v_mfma_f32_16x16x32_bf16 a[252:255], a[56:59], a[136:139], a[252:255]
s_add_u32 s24, s24, 128
v_mfma_f32_16x16x32_bf16 a[252:255], a[60:63], a[140:143], a[252:255]
s_waitcnt lgkmcnt(0)
v_mfma_f32_16x16x32_bf16 v[32:35], a[64:67], a[128:131], v[32:35]
s_add_u32 m0, s29, 65536
ds_read_b64_tr_b16 a[136:137], v5 offset:32768
v_mfma_f32_16x16x32_bf16 v[32:35], a[68:71], a[132:135], v[32:35]
buffer_load_dwordx4 v16, s[12:15], s26 offen offset:0 lds
v_mfma_f32_16x16x32_bf16 v[36:39], a[72:75], a[128:131], v[36:39]
ds_read_b64_tr_b16 a[138:139], v5 offset:34816
v_mfma_f32_16x16x32_bf16 v[36:39], a[76:79], a[132:135], v[36:39]
v_mfma_f32_16x16x32_bf16 v[40:43], a[80:83], a[128:131], v[40:43]
ds_read_b64_tr_b16 a[140:141], v5 offset:49152
v_mfma_f32_16x16x32_bf16 v[40:43], a[84:87], a[132:135], v[40:43]
buffer_load_dwordx4 v17, s[12:15], s26 offen offset:1024 lds
v_mfma_f32_16x16x32_bf16 v[44:47], a[88:91], a[128:131], v[44:47]
ds_read_b64_tr_b16 a[142:143], v5 offset:51200
v_mfma_f32_16x16x32_bf16 v[44:47], a[92:95], a[132:135], v[44:47]
v_mfma_f32_16x16x32_bf16 v[48:51], a[96:99], a[128:131], v[48:51]
ds_read_b128 a[0:3], v2 offset:0
v_cvt_pk_bf16_f32 v32, v32, v33
v_mfma_f32_16x16x32_bf16 v[48:51], a[100:103], a[132:135], v[48:51]
buffer_load_dwordx4 v18, s[12:15], s26 offen offset:2048 lds
v_mfma_f32_16x16x32_bf16 v[52:55], a[104:107], a[128:131], v[52:55]
ds_read_b128 a[4:7], v3 offset:0
v_cvt_pk_bf16_f32 v33, v34, v35
v_mfma_f32_16x16x32_bf16 v[52:55], a[108:111], a[132:135], v[52:55]
v_cvt_pk_bf16_f32 v34, v36, v37
v_cvt_pk_bf16_f32 v35, v38, v39
v_mfma_f32_16x16x32_bf16 v[56:59], a[112:115], a[128:131], v[56:59]
v_cvt_pk_bf16_f32 v40, v40, v41
v_cvt_pk_bf16_f32 v41, v42, v43
v_mfma_f32_16x16x32_bf16 v[56:59], a[116:119], a[132:135], v[56:59]
buffer_load_dwordx4 v19, s[12:15], s26 offen offset:3072 lds
v_mfma_f32_16x16x32_bf16 v[60:63], a[120:123], a[128:131], v[60:63]
s_add_u32 s26, s26, 524288
ds_read_b128 a[8:11], v2 offset:2048
v_cvt_pk_bf16_f32 v42, v44, v45
v_mfma_f32_16x16x32_bf16 v[60:63], a[124:127], a[132:135], v[60:63]
s_waitcnt lgkmcnt(3)
v_cvt_pk_bf16_f32 v43, v46, v47
v_mfma_f32_16x16x32_bf16 v[64:67], a[64:67], a[136:139], v[64:67]
s_add_u32 m0, s29, 81920
ds_read_b64_tr_b16 a[128:129], v6 offset:32768
v_cvt_pk_bf16_f32 v48, v48, v49
v_mfma_f32_16x16x32_bf16 v[64:67], a[68:71], a[140:143], v[64:67]
buffer_load_dwordx4 v16, s[12:15], s27 offen offset:0 lds
v_mfma_f32_16x16x32_bf16 v[68:71], a[72:75], a[136:139], v[68:71]
ds_read_b64_tr_b16 a[130:131], v6 offset:34816
v_cvt_pk_bf16_f32 v49, v50, v51
v_mfma_f32_16x16x32_bf16 v[68:71], a[76:79], a[140:143], v[68:71]
v_cvt_pk_bf16_f32 v50, v52, v53
v_cvt_pk_bf16_f32 v51, v54, v55
v_mfma_f32_16x16x32_bf16 v[72:75], a[80:83], a[136:139], v[72:75]
ds_read_b64_tr_b16 a[132:133], v6 offset:49152
v_cvt_pk_bf16_f32 v56, v56, v57
v_mfma_f32_16x16x32_bf16 v[72:75], a[84:87], a[140:143], v[72:75]
buffer_load_dwordx4 v17, s[12:15], s27 offen offset:1024 lds
v_mfma_f32_16x16x32_bf16 v[76:79], a[88:91], a[136:139], v[76:79]
ds_read_b64_tr_b16 a[134:135], v6 offset:51200
v_cvt_pk_bf16_f32 v57, v58, v59
v_mfma_f32_16x16x32_bf16 v[76:79], a[92:95], a[140:143], v[76:79]
v_cvt_pk_bf16_f32 v58, v60, v61
v_cvt_pk_bf16_f32 v59, v62, v63
v_mfma_f32_16x16x32_bf16 v[80:83], a[96:99], a[136:139], v[80:83]
ds_read_b128 a[12:15], v3 offset:2048
v_cvt_pk_bf16_f32 v64, v64, v65
v_mfma_f32_16x16x32_bf16 v[80:83], a[100:103], a[140:143], v[80:83]
buffer_load_dwordx4 v18, s[12:15], s27 offen offset:2048 lds
v_mfma_f32_16x16x32_bf16 v[84:87], a[104:107], a[136:139], v[84:87]
v_cvt_pk_bf16_f32 v65, v66, v67
v_cvt_pk_bf16_f32 v66, v68, v69
v_mfma_f32_16x16x32_bf16 v[84:87], a[108:111], a[140:143], v[84:87]
v_cvt_pk_bf16_f32 v67, v70, v71
v_mfma_f32_16x16x32_bf16 v[88:91], a[112:115], a[136:139], v[88:91]
ds_read_b128 a[16:19], v2 offset:4096
v_cvt_pk_bf16_f32 v72, v72, v73
v_mfma_f32_16x16x32_bf16 v[88:91], a[116:119], a[140:143], v[88:91]
buffer_load_dwordx4 v19, s[12:15], s27 offen offset:3072 lds
v_mfma_f32_16x16x32_bf16 v[92:95], a[120:123], a[136:139], v[92:95]
s_add_u32 s27, s27, 524288
ds_read_b128 a[20:23], v3 offset:4096
v_cvt_pk_bf16_f32 v73, v74, v75
v_mfma_f32_16x16x32_bf16 v[92:95], a[124:127], a[140:143], v[92:95]
s_waitcnt lgkmcnt(3)
v_cvt_pk_bf16_f32 v74, v76, v77
v_cvt_pk_bf16_f32 v75, v78, v79
v_mfma_f32_16x16x32_bf16 v[96:99], a[64:67], a[128:131], v[96:99]
s_add_u32 m0, s28, 49152
ds_read_b64_tr_b16 a[136:137], v7 offset:32768
v_cvt_pk_bf16_f32 v80, v80, v81
v_mfma_f32_16x16x32_bf16 v[96:99], a[68:71], a[132:135], v[96:99]
buffer_load_dwordx4 v12, s[8:11], s24 offen offset:0 lds
v_mfma_f32_16x16x32_bf16 v[100:103], a[72:75], a[128:131], v[100:103]
ds_read_b64_tr_b16 a[138:139], v7 offset:34816
v_cvt_pk_bf16_f32 v81, v82, v83
v_mfma_f32_16x16x32_bf16 v[100:103], a[76:79], a[132:135], v[100:103]
v_cvt_pk_bf16_f32 v82, v84, v85
v_cvt_pk_bf16_f32 v83, v86, v87
v_mfma_f32_16x16x32_bf16 v[104:107], a[80:83], a[128:131], v[104:107]
ds_read_b64_tr_b16 a[140:141], v7 offset:49152
v_cvt_pk_bf16_f32 v88, v88, v89
v_mfma_f32_16x16x32_bf16 v[104:107], a[84:87], a[132:135], v[104:107]
buffer_load_dwordx4 v13, s[8:11], s24 offen offset:1024 lds
v_mfma_f32_16x16x32_bf16 v[108:111], a[88:91], a[128:131], v[108:111]
ds_read_b64_tr_b16 a[142:143], v7 offset:51200
v_cvt_pk_bf16_f32 v89, v90, v91
v_mfma_f32_16x16x32_bf16 v[108:111], a[92:95], a[132:135], v[108:111]
v_cvt_pk_bf16_f32 v90, v92, v93
v_cvt_pk_bf16_f32 v91, v94, v95
v_mfma_f32_16x16x32_bf16 v[112:115], a[96:99], a[128:131], v[112:115]
v_cvt_pk_bf16_f32 v96, v96, v97
v_cvt_pk_bf16_f32 v97, v98, v99
v_mfma_f32_16x16x32_bf16 v[112:115], a[100:103], a[132:135], v[112:115]
buffer_load_dwordx4 v14, s[8:11], s24 offen offset:2048 lds
v_mfma_f32_16x16x32_bf16 v[116:119], a[104:107], a[128:131], v[116:119]
ds_read_b128 a[24:27], v2 offset:6144
v_cvt_pk_bf16_f32 v98, v100, v101
v_mfma_f32_16x16x32_bf16 v[116:119], a[108:111], a[132:135], v[116:119]
buffer_store_dwordx4 v[32:35], v1, s[4:7], s31 offen sc1
v_mfma_f32_16x16x32_bf16 v[120:123], a[112:115], a[128:131], v[120:123]
s_add_u32 s31, s31, s32
ds_read_b128 a[28:31], v3 offset:6144
v_cvt_pk_bf16_f32 v99, v102, v103
v_mfma_f32_16x16x32_bf16 v[120:123], a[116:119], a[132:135], v[120:123]
PAD_27:
s_cbranch_execz PAD_31
buffer_load_dwordx4 v15, s[8:11], s24 offen offset:3072 lds
v_mfma_f32_16x16x32_bf16 v[124:127], a[120:123], a[128:131], v[124:127]
s_add_u32 s24, s24, 128
v_cvt_pk_bf16_f32 v104, v104, v105
v_cvt_pk_bf16_f32 v105, v106, v107
v_mfma_f32_16x16x32_bf16 v[124:127], a[124:127], a[132:135], v[124:127]
s_waitcnt lgkmcnt(2)
v_cvt_pk_bf16_f32 v106, v108, v109
v_cvt_pk_bf16_f32 v107, v110, v111
v_mfma_f32_16x16x32_bf16 v[128:131], a[64:67], a[136:139], v[128:131]
ds_read_b64_tr_b16 a[128:129], v8 offset:32768
v_cvt_pk_bf16_f32 v112, v112, v113
v_mfma_f32_16x16x32_bf16 v[128:131], a[68:71], a[140:143], v[128:131]
v_cvt_pk_bf16_f32 v113, v114, v115
v_cvt_pk_bf16_f32 v114, v116, v117
v_mfma_f32_16x16x32_bf16 v[132:135], a[72:75], a[136:139], v[132:135]
ds_read_b64_tr_b16 a[130:131], v8 offset:34816
v_cvt_pk_bf16_f32 v115, v118, v119
v_mfma_f32_16x16x32_bf16 v[132:135], a[76:79], a[140:143], v[132:135]
buffer_store_dwordx4 v[40:43], v1, s[4:7], s31 offen sc1
v_mfma_f32_16x16x32_bf16 v[136:139], a[80:83], a[136:139], v[136:139]
s_add_u32 s31, s31, s33
ds_read_b64_tr_b16 a[132:133], v8 offset:49152
v_cvt_pk_bf16_f32 v120, v120, v121
v_mfma_f32_16x16x32_bf16 v[136:139], a[84:87], a[140:143], v[136:139]
v_cvt_pk_bf16_f32 v121, v122, v123
v_cvt_pk_bf16_f32 v122, v124, v125
v_mfma_f32_16x16x32_bf16 v[140:143], a[88:91], a[136:139], v[140:143]
ds_read_b64_tr_b16 a[134:135], v8 offset:51200
v_cvt_pk_bf16_f32 v123, v126, v127
v_mfma_f32_16x16x32_bf16 v[140:143], a[92:95], a[140:143], v[140:143]
v_mfma_f32_16x16x32_bf16 v[144:147], a[96:99], a[136:139], v[144:147]
ds_read_b128 a[32:35], v2 offset:8192
v_cvt_pk_bf16_f32 v128, v128, v129
v_mfma_f32_16x16x32_bf16 v[144:147], a[100:103], a[140:143], v[144:147]
v_cvt_pk_bf16_f32 v129, v130, v131
v_cvt_pk_bf16_f32 v130, v132, v133
v_mfma_f32_16x16x32_bf16 v[148:151], a[104:107], a[136:139], v[148:151]
v_cvt_pk_bf16_f32 v131, v134, v135
v_mfma_f32_16x16x32_bf16 v[148:151], a[108:111], a[140:143], v[148:151]
v_mfma_f32_16x16x32_bf16 v[152:155], a[112:115], a[136:139], v[152:155]
ds_read_b128 a[36:39], v3 offset:8192
v_cvt_pk_bf16_f32 v136, v136, v137
v_mfma_f32_16x16x32_bf16 v[152:155], a[116:119], a[140:143], v[152:155]
v_cvt_pk_bf16_f32 v137, v138, v139
v_cvt_pk_bf16_f32 v138, v140, v141
v_mfma_f32_16x16x32_bf16 v[156:159], a[120:123], a[136:139], v[156:159]
ds_read_b128 a[40:43], v2 offset:10240
v_cvt_pk_bf16_f32 v139, v142, v143
v_mfma_f32_16x16x32_bf16 v[156:159], a[124:127], a[140:143], v[156:159]
s_waitcnt lgkmcnt(3)
buffer_store_dwordx4 v[48:51], v1, s[4:7], s31 offen sc1
v_mfma_f32_16x16x32_bf16 v[160:163], a[64:67], a[128:131], v[160:163]
s_add_u32 s31, s31, s32
ds_read_b64_tr_b16 a[136:137], v9 offset:32768
v_cvt_pk_bf16_f32 v144, v144, v145
v_mfma_f32_16x16x32_bf16 v[160:163], a[68:71], a[132:135], v[160:163]
v_cvt_pk_bf16_f32 v145, v146, v147
v_cvt_pk_bf16_f32 v146, v148, v149
v_mfma_f32_16x16x32_bf16 v[164:167], a[72:75], a[128:131], v[164:167]
ds_read_b64_tr_b16 a[138:139], v9 offset:34816
v_cvt_pk_bf16_f32 v147, v150, v151
v_mfma_f32_16x16x32_bf16 v[164:167], a[76:79], a[132:135], v[164:167]
v_mfma_f32_16x16x32_bf16 v[168:171], a[80:83], a[128:131], v[168:171]
ds_read_b64_tr_b16 a[140:141], v9 offset:49152
v_cvt_pk_bf16_f32 v152, v152, v153
v_mfma_f32_16x16x32_bf16 v[168:171], a[84:87], a[132:135], v[168:171]
v_cvt_pk_bf16_f32 v153, v154, v155
v_cvt_pk_bf16_f32 v154, v156, v157
v_mfma_f32_16x16x32_bf16 v[172:175], a[88:91], a[128:131], v[172:175]
ds_read_b64_tr_b16 a[142:143], v9 offset:51200
v_cvt_pk_bf16_f32 v155, v158, v159
v_mfma_f32_16x16x32_bf16 v[172:175], a[92:95], a[132:135], v[172:175]
v_mfma_f32_16x16x32_bf16 v[176:179], a[96:99], a[128:131], v[176:179]
buffer_store_dwordx4 v[56:59], v1, s[4:7], s31 offen sc1
v_mfma_f32_16x16x32_bf16 v[176:179], a[100:103], a[132:135], v[176:179]
s_add_u32 s31, s31, s34
v_cvt_pk_bf16_f32 v160, v160, v161
v_cvt_pk_bf16_f32 v161, v162, v163
v_mfma_f32_16x16x32_bf16 v[180:183], a[104:107], a[128:131], v[180:183]
ds_read_b128 a[44:47], v3 offset:10240
v_cvt_pk_bf16_f32 v162, v164, v165
v_mfma_f32_16x16x32_bf16 v[180:183], a[108:111], a[132:135], v[180:183]
v_cvt_pk_bf16_f32 v163, v166, v167
v_mfma_f32_16x16x32_bf16 v[184:187], a[112:115], a[128:131], v[184:187]
ds_read_b128 a[48:51], v2 offset:12288
v_cvt_pk_bf16_f32 v168, v168, v169
v_mfma_f32_16x16x32_bf16 v[184:187], a[116:119], a[132:135], v[184:187]
v_cvt_pk_bf16_f32 v169, v170, v171
v_cvt_pk_bf16_f32 v170, v172, v173
v_mfma_f32_16x16x32_bf16 v[188:191], a[120:123], a[128:131], v[188:191]
v_cvt_pk_bf16_f32 v171, v174, v175
v_mfma_f32_16x16x32_bf16 v[188:191], a[124:127], a[132:135], v[188:191]
s_waitcnt lgkmcnt(2)
v_mfma_f32_16x16x32_bf16 v[192:195], a[64:67], a[136:139], v[192:195]
ds_read_b64_tr_b16 a[128:129], v10 offset:32768
v_cvt_pk_bf16_f32 v176, v176, v177
v_mfma_f32_16x16x32_bf16 v[192:195], a[68:71], a[140:143], v[192:195]
v_cvt_pk_bf16_f32 v177, v178, v179
v_cvt_pk_bf16_f32 v178, v180, v181
v_mfma_f32_16x16x32_bf16 v[196:199], a[72:75], a[136:139], v[196:199]
ds_read_b64_tr_b16 a[130:131], v10 offset:34816
v_cvt_pk_bf16_f32 v179, v182, v183
v_mfma_f32_16x16x32_bf16 v[196:199], a[76:79], a[140:143], v[196:199]
buffer_store_dwordx4 v[64:67], v1, s[4:7], s31 offen sc1
v_mfma_f32_16x16x32_bf16 v[200:203], a[80:83], a[136:139], v[200:203]
s_add_u32 s31, s31, s32
ds_read_b64_tr_b16 a[132:133], v10 offset:49152
v_cvt_pk_bf16_f32 v184, v184, v185
v_mfma_f32_16x16x32_bf16 v[200:203], a[84:87], a[140:143], v[200:203]
v_cvt_pk_bf16_f32 v185, v186, v187
v_cvt_pk_bf16_f32 v186, v188, v189
v_mfma_f32_16x16x32_bf16 v[204:207], a[88:91], a[136:139], v[204:207]
ds_read_b64_tr_b16 a[134:135], v10 offset:51200
v_cvt_pk_bf16_f32 v187, v190, v191
v_mfma_f32_16x16x32_bf16 v[204:207], a[92:95], a[140:143], v[204:207]
v_mfma_f32_16x16x32_bf16 v[208:211], a[96:99], a[136:139], v[208:211]
ds_read_b128 a[52:55], v3 offset:12288
v_cvt_pk_bf16_f32 v192, v192, v193
v_mfma_f32_16x16x32_bf16 v[208:211], a[100:103], a[140:143], v[208:211]
v_cvt_pk_bf16_f32 v193, v194, v195
v_cvt_pk_bf16_f32 v194, v196, v197
v_mfma_f32_16x16x32_bf16 v[212:215], a[104:107], a[136:139], v[212:215]
ds_read_b128 a[56:59], v2 offset:14336
v_cvt_pk_bf16_f32 v195, v198, v199
v_mfma_f32_16x16x32_bf16 v[212:215], a[108:111], a[140:143], v[212:215]
v_mfma_f32_16x16x32_bf16 v[216:219], a[112:115], a[136:139], v[216:219]
v_cvt_pk_bf16_f32 v200, v200, v201
v_cvt_pk_bf16_f32 v201, v202, v203
v_mfma_f32_16x16x32_bf16 v[216:219], a[116:119], a[140:143], v[216:219]
buffer_store_dwordx4 v[72:75], v1, s[4:7], s31 offen sc1
v_mfma_f32_16x16x32_bf16 v[220:223], a[120:123], a[136:139], v[220:223]
s_add_u32 s31, s31, s33
ds_read_b128 a[60:63], v3 offset:14336
v_cvt_pk_bf16_f32 v202, v204, v205
v_mfma_f32_16x16x32_bf16 v[220:223], a[124:127], a[140:143], v[220:223]
s_waitcnt lgkmcnt(3)
v_cvt_pk_bf16_f32 v203, v206, v207
v_mfma_f32_16x16x32_bf16 a[192:195], a[64:67], a[128:131], a[192:195]
ds_read_b64_tr_b16 a[136:137], v11 offset:32768
v_cvt_pk_bf16_f32 v208, v208, v209
v_mfma_f32_16x16x32_bf16 a[192:195], a[68:71], a[132:135], a[192:195]
v_cvt_pk_bf16_f32 v209, v210, v211
v_cvt_pk_bf16_f32 v210, v212, v213
v_mfma_f32_16x16x32_bf16 a[196:199], a[72:75], a[128:131], a[196:199]
ds_read_b64_tr_b16 a[138:139], v11 offset:34816
v_cvt_pk_bf16_f32 v211, v214, v215
v_mfma_f32_16x16x32_bf16 a[196:199], a[76:79], a[132:135], a[196:199]
v_mfma_f32_16x16x32_bf16 a[200:203], a[80:83], a[128:131], a[200:203]
ds_read_b64_tr_b16 a[140:141], v11 offset:49152
v_cvt_pk_bf16_f32 v216, v216, v217
v_mfma_f32_16x16x32_bf16 a[200:203], a[84:87], a[132:135], a[200:203]
v_cvt_pk_bf16_f32 v217, v218, v219
v_cvt_pk_bf16_f32 v218, v220, v221
v_mfma_f32_16x16x32_bf16 a[204:207], a[88:91], a[128:131], a[204:207]
ds_read_b64_tr_b16 a[142:143], v11 offset:51200
v_cvt_pk_bf16_f32 v219, v222, v223
v_mfma_f32_16x16x32_bf16 a[204:207], a[92:95], a[132:135], a[204:207]
v_mfma_f32_16x16x32_bf16 a[208:211], a[96:99], a[128:131], a[208:211]
buffer_store_dwordx4 v[80:83], v1, s[4:7], s31 offen sc1
v_mfma_f32_16x16x32_bf16 a[208:211], a[100:103], a[132:135], a[208:211]
s_add_u32 s31, s31, s32
v_mfma_f32_16x16x32_bf16 a[212:215], a[104:107], a[128:131], a[212:215]
v_mfma_f32_16x16x32_bf16 a[212:215], a[108:111], a[132:135], a[212:215]
v_mfma_f32_16x16x32_bf16 a[216:219], a[112:115], a[128:131], a[216:219]
v_mfma_f32_16x16x32_bf16 a[216:219], a[116:119], a[132:135], a[216:219]
v_mfma_f32_16x16x32_bf16 a[220:223], a[120:123], a[128:131], a[220:223]
s_waitcnt vmcnt(23) lgkmcnt(0)
v_mfma_f32_16x16x32_bf16 a[220:223], a[124:127], a[132:135], a[220:223]
s_barrier
v_mfma_f32_16x16x32_bf16 a[224:227], a[64:67], a[136:139], a[224:227]
s_add_u32 m0, s29, 98304
ds_read_b64_tr_b16 a[128:129], v22 offset:0
v_mfma_f32_16x16x32_bf16 a[224:227], a[68:71], a[140:143], a[224:227]
buffer_load_dwordx4 v16, s[12:15], s26 offen offset:0 lds
v_mfma_f32_16x16x32_bf16 a[228:231], a[72:75], a[136:139], a[228:231]
ds_read_b64_tr_b16 a[130:131], v22 offset:2048
v_mfma_f32_16x16x32_bf16 a[228:231], a[76:79], a[140:143], a[228:231]
buffer_store_dwordx4 v[88:91], v1, s[4:7], s31 offen sc1
v_mfma_f32_16x16x32_bf16 a[232:235], a[80:83], a[136:139], a[232:235]
s_add_u32 s31, s31, s35
ds_read_b64_tr_b16 a[132:133], v22 offset:16384
v_mfma_f32_16x16x32_bf16 a[232:235], a[84:87], a[140:143], a[232:235]
buffer_load_dwordx4 v17, s[12:15], s26 offen offset:1024 lds
v_mfma_f32_16x16x32_bf16 a[236:239], a[88:91], a[136:139], a[236:239]
ds_read_b64_tr_b16 a[134:135], v22 offset:18432
v_add_u32 v22, 4294901760, v22
v_mfma_f32_16x16x32_bf16 a[236:239], a[92:95], a[140:143], a[236:239]
v_mfma_f32_16x16x32_bf16 a[240:243], a[96:99], a[136:139], a[240:243]
v_mfma_f32_16x16x32_bf16 a[240:243], a[100:103], a[140:143], a[240:243]
buffer_load_dwordx4 v18, s[12:15], s26 offen offset:2048 lds
v_mfma_f32_16x16x32_bf16 a[244:247], a[104:107], a[136:139], a[244:247]
v_mfma_f32_16x16x32_bf16 a[244:247], a[108:111], a[140:143], a[244:247]
v_mfma_f32_16x16x32_bf16 a[248:251], a[112:115], a[136:139], a[248:251]
v_mfma_f32_16x16x32_bf16 a[248:251], a[116:119], a[140:143], a[248:251]
buffer_load_dwordx4 v19, s[12:15], s26 offen offset:3072 lds
v_mfma_f32_16x16x32_bf16 a[252:255], a[120:123], a[136:139], a[252:255]
s_add_u32 s26, s26, 524288
v_mfma_f32_16x16x32_bf16 a[252:255], a[124:127], a[140:143], a[252:255]
s_waitcnt lgkmcnt(0)
s_cmp_ge_u32 s21, 7
s_cbranch_scc1 M_Q
M_conv:
v_mfma_f32_16x16x32_bf16 v[36:39], a[128:131], a[0:3], 0
s_add_u32 m0, s29, 114688
ds_read_b64_tr_b16 a[136:137], v23 offset:0
v_mfma_f32_16x16x32_bf16 v[36:39], a[132:135], a[4:7], v[36:39]
buffer_load_dwordx4 v16, s[12:15], s27 offen offset:0 lds
v_mfma_f32_16x16x32_bf16 v[44:47], a[128:131], a[8:11], 0
ds_read_b64_tr_b16 a[138:139], v23 offset:2048
v_mfma_f32_16x16x32_bf16 v[44:47], a[132:135], a[12:15], v[44:47]
ds_read_b128 a[64:67], v2 offset:16384
ds_read_b128 a[68:71], v3 offset:16384
v_mfma_f32_16x16x32_bf16 v[52:55], a[128:131], a[16:19], 0
ds_read_b64_tr_b16 a[140:141], v23 offset:16384
v_mfma_f32_16x16x32_bf16 v[52:55], a[132:135], a[20:23], v[52:55]
buffer_load_dwordx4 v17, s[12:15], s27 offen offset:1024 lds
v_mfma_f32_16x16x32_bf16 v[60:63], a[128:131], a[24:27], 0
ds_read_b64_tr_b16 a[142:143], v23 offset:18432
v_add_u32 v23, 4294901760, v23
v_mfma_f32_16x16x32_bf16 v[60:63], a[132:135], a[28:31], v[60:63]
buffer_store_dwordx4 v[96:99], v1, s[4:7], s31 offen sc1
v_mfma_f32_16x16x32_bf16 v[68:71], a[128:131], a[32:35], 0
s_add_u32 s31, s31, s32
ds_read_b128 a[72:75], v2 offset:18432
v_mfma_f32_16x16x32_bf16 v[68:71], a[132:135], a[36:39], v[68:71]
buffer_load_dwordx4 v18, s[12:15], s27 offen offset:2048 lds
v_mfma_f32_16x16x32_bf16 v[76:79], a[128:131], a[40:43], 0
ds_read_b128 a[76:79], v3 offset:18432
v_mfma_f32_16x16x32_bf16 v[76:79], a[132:135], a[44:47], v[76:79]
ds_read_b128 a[80:83], v2 offset:20480
v_mfma_f32_16x16x32_bf16 v[84:87], a[128:131], a[48:51], 0
ds_read_b128 a[84:87], v3 offset:20480
v_mfma_f32_16x16x32_bf16 v[84:87], a[132:135], a[52:55], v[84:87]
buffer_load_dwordx4 v19, s[12:15], s27 offen offset:3072 lds
v_mfma_f32_16x16x32_bf16 v[92:95], a[128:131], a[56:59], 0
s_add_u32 s27, s27, 524288
ds_read_b128 a[88:91], v2 offset:22528
v_mfma_f32_16x16x32_bf16 v[92:95], a[132:135], a[60:63], v[92:95]
s_waitcnt lgkmcnt(5)
buffer_store_dwordx4 v[104:107], v1, s[4:7], s31 offen sc1
v_mfma_f32_16x16x32_bf16 v[100:103], a[136:139], a[0:3], 0
s_add_u32 m0, s28, 0
ds_read_b64_tr_b16 a[128:129], v24 offset:0
v_mfma_f32_16x16x32_bf16 v[100:103], a[140:143], a[4:7], v[100:103]
s_add_u32 s31, s31, s33
buffer_load_dwordx4 v12, s[8:11], s24 offen offset:0 lds
v_mfma_f32_16x16x32_bf16 v[108:111], a[136:139], a[8:11], 0
ds_read_b64_tr_b16 a[130:131], v24 offset:2048
v_mfma_f32_16x16x32_bf16 v[108:111], a[140:143], a[12:15], v[108:111]
ds_read_b128 a[92:95], v3 offset:22528
v_mfma_f32_16x16x32_bf16 v[116:119], a[136:139], a[16:19], 0
ds_read_b64_tr_b16 a[132:133], v24 offset:16384
v_mfma_f32_16x16x32_bf16 v[116:119], a[140:143], a[20:23], v[116:119]
buffer_load_dwordx4 v13, s[8:11], s24 offen offset:1024 lds
v_mfma_f32_16x16x32_bf16 v[124:127], a[136:139], a[24:27], 0
ds_read_b64_tr_b16 a[134:135], v24 offset:18432
v_add_u32 v24, 4294901760, v24
v_mfma_f32_16x16x32_bf16 v[124:127], a[140:143], a[28:31], v[124:127]
v_mfma_f32_16x16x32_bf16 v[132:135], a[136:139], a[32:35], 0
ds_read_b128 a[96:99], v2 offset:24576
v_mfma_f32_16x16x32_bf16 v[132:135], a[140:143], a[36:39], v[132:135]
buffer_load_dwordx4 v14, s[8:11], s24 offen offset:2048 lds
v_mfma_f32_16x16x32_bf16 v[140:143], a[136:139], a[40:43], 0
ds_read_b128 a[100:103], v3 offset:24576
v_mfma_f32_16x16x32_bf16 v[140:143], a[140:143], a[44:47], v[140:143]
ds_read_b128 a[104:107], v2 offset:26624
v_mfma_f32_16x16x32_bf16 v[148:151], a[136:139], a[48:51], 0
ds_read_b128 a[108:111], v3 offset:26624
v_mfma_f32_16x16x32_bf16 v[148:151], a[140:143], a[52:55], v[148:151]
buffer_load_dwordx4 v15, s[8:11], s24 offen offset:3072 lds
v_mfma_f32_16x16x32_bf16 v[156:159], a[136:139], a[56:59], 0
s_add_u32 s24, s24, 128
ds_read_b128 a[112:115], v2 offset:28672
v_mfma_f32_16x16x32_bf16 v[156:159], a[140:143], a[60:63], v[156:159]
s_waitcnt lgkmcnt(5)
buffer_store_dwordx4 v[112:115], v1, s[4:7], s31 offen sc1
v_mfma_f32_16x16x32_bf16 v[164:167], a[128:131], a[0:3], 0
s_add_u32 s31, s31, s32
ds_read_b64_tr_b16 a[136:137], v25 offset:0
v_mfma_f32_16x16x32_bf16 v[164:167], a[132:135], a[4:7], v[164:167]
v_mfma_f32_16x16x32_bf16 v[172:175], a[128:131], a[8:11], 0
ds_read_b64_tr_b16 a[138:139], v25 offset:2048
v_mfma_f32_16x16x32_bf16 v[172:175], a[132:135], a[12:15], v[172:175]
ds_read_b128 a[116:119], v3 offset:28672
v_mfma_f32_16x16x32_bf16 v[180:183], a[128:131], a[16:19], 0
ds_read_b64_tr_b16 a[140:141], v25 offset:16384
v_mfma_f32_16x16x32_bf16 v[180:183], a[132:135], a[20:23], v[180:183]
v_mfma_f32_16x16x32_bf16 v[188:191], a[128:131], a[24:27], 0
ds_read_b64_tr_b16 a[142:143], v25 offset:18432
v_add_u32 v25, 4294901760, v25
v_mfma_f32_16x16x32_bf16 v[188:191], a[132:135], a[28:31], v[188:191]
v_mfma_f32_16x16x32_bf16 v[196:199], a[128:131], a[32:35], 0
ds_read_b128 a[120:123], v2 offset:30720
v_mfma_f32_16x16x32_bf16 v[196:199], a[132:135], a[36:39], v[196:199]
v_mfma_f32_16x16x32_bf16 v[204:207], a[128:131], a[40:43], 0
ds_read_b128 a[124:127], v3 offset:30720
v_mfma_f32_16x16x32_bf16 v[204:207], a[132:135], a[44:47], v[204:207]
v_mfma_f32_16x16x32_bf16 v[212:215], a[128:131], a[48:51], 0
v_mfma_f32_16x16x32_bf16 v[212:215], a[132:135], a[52:55], v[212:215]
buffer_store_dwordx4 v[120:123], v1, s[4:7], s31 offen sc1
v_mfma_f32_16x16x32_bf16 v[220:223], a[128:131], a[56:59], 0
s_add_u32 s31, s31, s34
v_mfma_f32_16x16x32_bf16 v[220:223], a[132:135], a[60:63], v[220:223]
s_waitcnt vmcnt(28) lgkmcnt(0)
s_barrier
v_mfma_f32_16x16x32_bf16 v[224:227], a[136:139], a[0:3], 0
s_add_u32 m0, s29, 131072
ds_read_b64_tr_b16 a[128:129], v22 offset:0
v_mfma_f32_16x16x32_bf16 v[224:227], a[140:143], a[4:7], v[224:227]
buffer_load_dwordx4 v16, s[12:15], s26 offen offset:0 lds
v_mfma_f32_16x16x32_bf16 v[228:231], a[136:139], a[8:11], 0
ds_read_b64_tr_b16 a[130:131], v22 offset:2048
v_mfma_f32_16x16x32_bf16 v[228:231], a[140:143], a[12:15], v[228:231]
v_mfma_f32_16x16x32_bf16 v[232:235], a[136:139], a[16:19], 0
ds_read_b64_tr_b16 a[132:133], v22 offset:16384
v_mfma_f32_16x16x32_bf16 v[232:235], a[140:143], a[20:23], v[232:235]
buffer_load_dwordx4 v17, s[12:15], s26 offen offset:1024 lds
v_mfma_f32_16x16x32_bf16 v[236:239], a[136:139], a[24:27], 0
ds_read_b64_tr_b16 a[134:135], v22 offset:18432
v_add_u32 v22, 32768, v22
v_mfma_f32_16x16x32_bf16 v[236:239], a[140:143], a[28:31], v[236:239]
v_mfma_f32_16x16x32_bf16 v[240:243], a[136:139], a[32:35], 0
v_mfma_f32_16x16x32_bf16 v[240:243], a[140:143], a[36:39], v[240:243]
buffer_load_dwordx4 v18, s[12:15], s26 offen offset:2048 lds
v_mfma_f32_16x16x32_bf16 v[244:247], a[136:139], a[40:43], 0
v_mfma_f32_16x16x32_bf16 v[244:247], a[140:143], a[44:47], v[244:247]
v_mfma_f32_16x16x32_bf16 v[248:251], a[136:139], a[48:51], 0
v_mfma_f32_16x16x32_bf16 v[248:251], a[140:143], a[52:55], v[248:251]
buffer_load_dwordx4 v19, s[12:15], s26 offen offset:3072 lds
v_mfma_f32_16x16x32_bf16 v[252:255], a[136:139], a[56:59], 0
s_add_u32 s26, s26, 524288
v_mfma_f32_16x16x32_bf16 v[252:255], a[140:143], a[60:63], v[252:255]
s_waitcnt lgkmcnt(0)
v_mfma_f32_16x16x32_bf16 v[36:39], a[128:131], a[64:67], v[36:39]
s_add_u32 m0, s29, 147456
ds_read_b64_tr_b16 a[136:137], v23 offset:0
v_mfma_f32_16x16x32_bf16 v[36:39], a[132:135], a[68:71], v[36:39]
buffer_load_dwordx4 v16, s[12:15], s27 offen offset:0 lds
v_mfma_f32_16x16x32_bf16 v[44:47], a[128:131], a[72:75], v[44:47]
ds_read_b64_tr_b16 a[138:139], v23 offset:2048
v_mfma_f32_16x16x32_bf16 v[44:47], a[132:135], a[76:79], v[44:47]
ds_read_b128 a[0:3], v2 offset:32768
ds_read_b128 a[4:7], v3 offset:32768
v_mfma_f32_16x16x32_bf16 v[52:55], a[128:131], a[80:83], v[52:55]
ds_read_b64_tr_b16 a[140:141], v23 offset:16384
v_mfma_f32_16x16x32_bf16 v[52:55], a[132:135], a[84:87], v[52:55]
buffer_load_dwordx4 v17, s[12:15], s27 offen offset:1024 lds
v_mfma_f32_16x16x32_bf16 v[60:63], a[128:131], a[88:91], v[60:63]
ds_read_b64_tr_b16 a[142:143], v23 offset:18432
v_add_u32 v23, 32768, v23
v_mfma_f32_16x16x32_bf16 v[60:63], a[132:135], a[92:95], v[60:63]
buffer_store_dwordx4 v[128:131], v1, s[4:7], s31 offen sc1
v_mfma_f32_16x16x32_bf16 v[68:71], a[128:131], a[96:99], v[68:71]
s_add_u32 s31, s31, s32
ds_read_b128 a[8:11], v2 offset:34816
v_accvgpr_read_b32 v32, a192
v_mfma_f32_16x16x32_bf16 v[68:71], a[132:135], a[100:103], v[68:71]
buffer_load_dwordx4 v18, s[12:15], s27 offen offset:2048 lds
v_mfma_f32_16x16x32_bf16 v[76:79], a[128:131], a[104:107], v[76:79]
ds_read_b128 a[12:15], v3 offset:34816
v_accvgpr_read_b32 v33, a193
v_mfma_f32_16x16x32_bf16 v[76:79], a[132:135], a[108:111], v[76:79]
ds_read_b128 a[16:19], v2 offset:36864
v_accvgpr_read_b32 v34, a194
v_mfma_f32_16x16x32_bf16 v[84:87], a[128:131], a[112:115], v[84:87]
ds_read_b128 a[20:23], v3 offset:36864
v_accvgpr_read_b32 v35, a195
v_mfma_f32_16x16x32_bf16 v[84:87], a[132:135], a[116:119], v[84:87]
buffer_load_dwordx4 v19, s[12:15], s27 offen offset:3072 lds
v_mfma_f32_16x16x32_bf16 v[92:95], a[128:131], a[120:123], v[92:95]
s_add_u32 s27, s27, 524288
ds_read_b128 a[24:27], v2 offset:38912
v_accvgpr_read_b32 v96, a196
v_mfma_f32_16x16x32_bf16 v[92:95], a[132:135], a[124:127], v[92:95]
s_waitcnt lgkmcnt(5)
buffer_store_dwordx4 v[136:139], v1, s[4:7], s31 offen sc1
v_mfma_f32_16x16x32_bf16 v[100:103], a[136:139], a[64:67], v[100:103]
s_add_u32 m0, s28, 16384
ds_read_b64_tr_b16 a[128:129], v24 offset:0
v_accvgpr_read_b32 v97, a197
v_mfma_f32_16x16x32_bf16 v[100:103], a[140:143], a[68:71], v[100:103]
s_add_u32 s31, s31, s33
buffer_load_dwordx4 v12, s[8:11], s24 offen offset:0 lds
v_mfma_f32_16x16x32_bf16 v[108:111], a[136:139], a[72:75], v[108:111]
ds_read_b64_tr_b16 a[130:131], v24 offset:2048
v_accvgpr_read_b32 v98, a198
v_mfma_f32_16x16x32_bf16 v[108:111], a[140:143], a[76:79], v[108:111]
ds_read_b128 a[28:31], v3 offset:38912
v_accvgpr_read_b32 v99, a199
v_mfma_f32_16x16x32_bf16 v[116:119], a[136:139], a[80:83], v[116:119]
ds_read_b64_tr_b16 a[132:133], v24 offset:16384
v_cvt_pk_bf16_f32 v32, v32, v33
v_mfma_f32_16x16x32_bf16 v[116:119], a[140:143], a[84:87], v[116:119]
buffer_load_dwordx4 v13, s[8:11], s24 offen offset:1024 lds
v_mfma_f32_16x16x32_bf16 v[124:127], a[136:139], a[88:91], v[124:127]
ds_read_b64_tr_b16 a[134:135], v24 offset:18432
v_add_u32 v24, 32768, v24
v_mfma_f32_16x16x32_bf16 v[124:127], a[140:143], a[92:95], v[124:127]
v_cvt_pk_bf16_f32 v33, v34, v35
v_cvt_pk_bf16_f32 v34, v96, v97
v_mfma_f32_16x16x32_bf16 v[132:135], a[136:139], a[96:99], v[132:135]
ds_read_b128 a[32:35], v2 offset:40960
v_cvt_pk_bf16_f32 v35, v98, v99
v_mfma_f32_16x16x32_bf16 v[132:135], a[140:143], a[100:103], v[132:135]
buffer_load_dwordx4 v14, s[8:11], s24 offen offset:2048 lds
v_mfma_f32_16x16x32_bf16 v[140:143], a[136:139], a[104:107], v[140:143]
ds_read_b128 a[36:39], v3 offset:40960
v_accvgpr_read_b32 v40, a200
v_mfma_f32_16x16x32_bf16 v[140:143], a[140:143], a[108:111], v[140:143]
ds_read_b128 a[40:43], v2 offset:43008
v_accvgpr_read_b32 v41, a201
v_mfma_f32_16x16x32_bf16 v[148:151], a[136:139], a[112:115], v[148:151]
ds_read_b128 a[44:47], v3 offset:43008
v_accvgpr_read_b32 v42, a202
v_mfma_f32_16x16x32_bf16 v[148:151], a[140:143], a[116:119], v[148:151]
buffer_load_dwordx4 v15, s[8:11], s24 offen offset:3072 lds
v_mfma_f32_16x16x32_bf16 v[156:159], a[136:139], a[120:123], v[156:159]
s_add_u32 s24, s24, 128
ds_read_b128 a[48:51], v2 offset:45056
v_accvgpr_read_b32 v43, a203
v_mfma_f32_16x16x32_bf16 v[156:159], a[140:143], a[124:127], v[156:159]
s_waitcnt lgkmcnt(5)
buffer_store_dwordx4 v[144:147], v1, s[4:7], s31 offen sc1
v_mfma_f32_16x16x32_bf16 v[164:167], a[128:131], a[64:67], v[164:167]
s_add_u32 s31, s31, s32
ds_read_b64_tr_b16 a[136:137], v25 offset:0
v_accvgpr_read_b32 v96, a204
v_mfma_f32_16x16x32_bf16 v[164:167], a[132:135], a[68:71], v[164:167]
v_accvgpr_read_b32 v97, a205
v_accvgpr_read_b32 v98, a206
v_mfma_f32_16x16x32_bf16 v[172:175], a[128:131], a[72:75], v[172:175]
ds_read_b64_tr_b16 a[138:139], v25 offset:2048
v_accvgpr_read_b32 v99, a207
v_mfma_f32_16x16x32_bf16 v[172:175], a[132:135], a[76:79], v[172:175]
ds_read_b128 a[52:55], v3 offset:45056
v_cvt_pk_bf16_f32 v40, v40, v41
v_mfma_f32_16x16x32_bf16 v[180:183], a[128:131], a[80:83], v[180:183]
ds_read_b64_tr_b16 a[140:141], v25 offset:16384
v_cvt_pk_bf16_f32 v41, v42, v43
v_mfma_f32_16x16x32_bf16 v[180:183], a[132:135], a[84:87], v[180:183]
v_cvt_pk_bf16_f32 v42, v96, v97
v_cvt_pk_bf16_f32 v43, v98, v99
v_mfma_f32_16x16x32_bf16 v[188:191], a[128:131], a[88:91], v[188:191]
ds_read_b64_tr_b16 a[142:143], v25 offset:18432
v_add_u32 v25, 32768, v25
v_mfma_f32_16x16x32_bf16 v[188:191], a[132:135], a[92:95], v[188:191]
v_accvgpr_read_b32 v48, a208
v_accvgpr_read_b32 v49, a209
v_mfma_f32_16x16x32_bf16 v[196:199], a[128:131], a[96:99], v[196:199]
ds_read_b128 a[56:59], v2 offset:47104
v_accvgpr_read_b32 v50, a210
v_mfma_f32_16x16x32_bf16 v[196:199], a[132:135], a[100:103], v[196:199]
v_accvgpr_read_b32 v51, a211
v_accvgpr_read_b32 v96, a212
v_mfma_f32_16x16x32_bf16 v[204:207], a[128:131], a[104:107], v[204:207]
ds_read_b128 a[60:63], v3 offset:47104
v_accvgpr_read_b32 v97, a213
v_mfma_f32_16x16x32_bf16 v[204:207], a[132:135], a[108:111], v[204:207]
v_accvgpr_read_b32 v98, a214
v_accvgpr_read_b32 v99, a215
v_mfma_f32_16x16x32_bf16 v[212:215], a[128:131], a[112:115], v[212:215]
v_cvt_pk_bf16_f32 v48, v48, v49
v_cvt_pk_bf16_f32 v49, v50, v51
v_mfma_f32_16x16x32_bf16 v[212:215], a[132:135], a[116:119], v[212:215]
buffer_store_dwordx4 v[152:155], v1, s[4:7], s31 offen sc1
v_mfma_f32_16x16x32_bf16 v[220:223], a[128:131], a[120:123], v[220:223]
s_add_u32 s31, s31, s36
v_cvt_pk_bf16_f32 v50, v96, v97
v_cvt_pk_bf16_f32 v51, v98, v99
v_mfma_f32_16x16x32_bf16 v[220:223], a[132:135], a[124:127], v[220:223]
s_waitcnt vmcnt(23) lgkmcnt(0)
s_barrier
v_accvgpr_read_b32 v56, a216
v_mfma_f32_16x16x32_bf16 v[224:227], a[136:139], a[64:67], v[224:227]
s_add_u32 m0, s29, 65536
ds_read_b64_tr_b16 a[128:129], v22 offset:0
v_accvgpr_read_b32 v57, a217
v_mfma_f32_16x16x32_bf16 v[224:227], a[140:143], a[68:71], v[224:227]
buffer_load_dwordx4 v16, s[12:15], s26 offen offset:0 lds
v_mfma_f32_16x16x32_bf16 v[228:231], a[136:139], a[72:75], v[228:231]
ds_read_b64_tr_b16 a[130:131], v22 offset:2048
v_accvgpr_read_b32 v58, a218
v_mfma_f32_16x16x32_bf16 v[228:231], a[140:143], a[76:79], v[228:231]
v_accvgpr_read_b32 v59, a219
v_accvgpr_read_b32 v96, a220
v_mfma_f32_16x16x32_bf16 v[232:235], a[136:139], a[80:83], v[232:235]
ds_read_b64_tr_b16 a[132:133], v22 offset:16384
v_accvgpr_read_b32 v97, a221
v_mfma_f32_16x16x32_bf16 v[232:235], a[140:143], a[84:87], v[232:235]
buffer_load_dwordx4 v17, s[12:15], s26 offen offset:1024 lds
v_mfma_f32_16x16x32_bf16 v[236:239], a[136:139], a[88:91], v[236:239]
ds_read_b64_tr_b16 a[134:135], v22 offset:18432
v_add_u32 v22, 32768, v22
v_mfma_f32_16x16x32_bf16 v[236:239], a[140:143], a[92:95], v[236:239]
v_accvgpr_read_b32 v98, a222
v_accvgpr_read_b32 v99, a223
v_mfma_f32_16x16x32_bf16 v[240:243], a[136:139], a[96:99], v[240:243]
v_cvt_pk_bf16_f32 v56, v56, v57
v_cvt_pk_bf16_f32 v57, v58, v59
v_mfma_f32_16x16x32_bf16 v[240:243], a[140:143], a[100:103], v[240:243]
buffer_load_dwordx4 v18, s[12:15], s26 offen offset:2048 lds
v_mfma_f32_16x16x32_bf16 v[244:247], a[136:139], a[104:107], v[244:247]
v_cvt_pk_bf16_f32 v58, v96, v97
v_cvt_pk_bf16_f32 v59, v98, v99
v_mfma_f32_16x16x32_bf16 v[244:247], a[140:143], a[108:111], v[244:247]
v_accvgpr_read_b32 v64, a224
v_accvgpr_read_b32 v65, a225
v_mfma_f32_16x16x32_bf16 v[248:251], a[136:139], a[112:115], v[248:251]
v_accvgpr_read_b32 v66, a226
v_accvgpr_read_b32 v67, a227
v_mfma_f32_16x16x32_bf16 v[248:251], a[140:143], a[116:119], v[248:251]
buffer_load_dwordx4 v19, s[12:15], s26 offen offset:3072 lds
v_mfma_f32_16x16x32_bf16 v[252:255], a[136:139], a[120:123], v[252:255]
s_add_u32 s26, s26, 524288
v_accvgpr_read_b32 v96, a228
v_accvgpr_read_b32 v97, a229
v_mfma_f32_16x16x32_bf16 v[252:255], a[140:143], a[124:127], v[252:255]
s_waitcnt lgkmcnt(0)
v_accvgpr_read_b32 v98, a230
v_accvgpr_read_b32 v99, a231
v_mfma_f32_16x16x32_bf16 v[36:39], a[128:131], a[0:3], v[36:39]
s_add_u32 m0, s29, 81920
ds_read_b64_tr_b16 a[136:137], v23 offset:0
v_cvt_pk_bf16_f32 v64, v64, v65
v_mfma_f32_16x16x32_bf16 v[36:39], a[132:135], a[4:7], v[36:39]
buffer_load_dwordx4 v16, s[12:15], s27 offen offset:0 lds
v_mfma_f32_16x16x32_bf16 v[44:47], a[128:131], a[8:11], v[44:47]
ds_read_b64_tr_b16 a[138:139], v23 offset:2048
v_cvt_pk_bf16_f32 v65, v66, v67
v_mfma_f32_16x16x32_bf16 v[44:47], a[132:135], a[12:15], v[44:47]
PAD_28:
s_cbranch_execz M_tret
ds_read_b128 a[64:67], v2 offset:49152
ds_read_b128 a[68:71], v3 offset:49152
v_mfma_f32_16x16x32_bf16 v[52:55], a[128:131], a[16:19], v[52:55]
ds_read_b64_tr_b16 a[140:141], v23 offset:16384
v_cvt_pk_bf16_f32 v66, v96, v97
v_mfma_f32_16x16x32_bf16 v[52:55], a[132:135], a[20:23], v[52:55]
buffer_load_dwordx4 v17, s[12:15], s27 offen offset:1024 lds
v_mfma_f32_16x16x32_bf16 v[60:63], a[128:131], a[24:27], v[60:63]
ds_read_b64_tr_b16 a[142:143], v23 offset:18432
v_add_u32 v23, 32768, v23
v_mfma_f32_16x16x32_bf16 v[60:63], a[132:135], a[28:31], v[60:63]
buffer_store_dwordx4 v[160:163], v1, s[4:7], s31 offen sc1
v_mfma_f32_16x16x32_bf16 v[68:71], a[128:131], a[32:35], v[68:71]
s_add_u32 s31, s31, s32
ds_read_b128 a[72:75], v2 offset:51200
v_cvt_pk_bf16_f32 v67, v98, v99
v_mfma_f32_16x16x32_bf16 v[68:71], a[132:135], a[36:39], v[68:71]
buffer_load_dwordx4 v18, s[12:15], s27 offen offset:2048 lds
v_mfma_f32_16x16x32_bf16 v[76:79], a[128:131], a[40:43], v[76:79]
ds_read_b128 a[76:79], v3 offset:51200
v_accvgpr_read_b32 v72, a232
v_mfma_f32_16x16x32_bf16 v[76:79], a[132:135], a[44:47], v[76:79]
ds_read_b128 a[80:83], v2 offset:53248
v_accvgpr_read_b32 v73, a233
v_mfma_f32_16x16x32_bf16 v[84:87], a[128:131], a[48:51], v[84:87]
ds_read_b128 a[84:87], v3 offset:53248
v_accvgpr_read_b32 v74, a234
v_mfma_f32_16x16x32_bf16 v[84:87], a[132:135], a[52:55], v[84:87]
buffer_load_dwordx4 v19, s[12:15], s27 offen offset:3072 lds
v_mfma_f32_16x16x32_bf16 v[92:95], a[128:131], a[56:59], v[92:95]
s_add_u32 s27, s27, 524288
ds_read_b128 a[88:91], v2 offset:55296
v_accvgpr_read_b32 v75, a235
v_mfma_f32_16x16x32_bf16 v[92:95], a[132:135], a[60:63], v[92:95]
s_waitcnt lgkmcnt(5)
buffer_store_dwordx4 v[168:171], v1, s[4:7], s31 offen sc1
v_mfma_f32_16x16x32_bf16 v[100:103], a[136:139], a[0:3], v[100:103]
s_add_u32 m0, s28, 32768
ds_read_b64_tr_b16 a[128:129], v24 offset:0
v_accvgpr_read_b32 v96, a236
v_mfma_f32_16x16x32_bf16 v[100:103], a[140:143], a[4:7], v[100:103]
s_add_u32 s31, s31, s33
buffer_load_dwordx4 v12, s[8:11], s24 offen offset:0 lds
v_mfma_f32_16x16x32_bf16 v[108:111], a[136:139], a[8:11], v[108:111]
ds_read_b64_tr_b16 a[130:131], v24 offset:2048
v_accvgpr_read_b32 v97, a237
v_mfma_f32_16x16x32_bf16 v[108:111], a[140:143], a[12:15], v[108:111]
ds_read_b128 a[92:95], v3 offset:55296
v_accvgpr_read_b32 v98, a238
v_mfma_f32_16x16x32_bf16 v[116:119], a[136:139], a[16:19], v[116:119]
ds_read_b64_tr_b16 a[132:133], v24 offset:16384
v_accvgpr_read_b32 v99, a239
v_mfma_f32_16x16x32_bf16 v[116:119], a[140:143], a[20:23], v[116:119]
buffer_load_dwordx4 v13, s[8:11], s24 offen offset:1024 lds
v_mfma_f32_16x16x32_bf16 v[124:127], a[136:139], a[24:27], v[124:127]
ds_read_b64_tr_b16 a[134:135], v24 offset:18432
v_add_u32 v24, 32768, v24
v_mfma_f32_16x16x32_bf16 v[124:127], a[140:143], a[28:31], v[124:127]
v_cvt_pk_bf16_f32 v72, v72, v73
v_cvt_pk_bf16_f32 v73, v74, v75
v_mfma_f32_16x16x32_bf16 v[132:135], a[136:139], a[32:35], v[132:135]
ds_read_b128 a[96:99], v2 offset:57344
v_cvt_pk_bf16_f32 v74, v96, v97
v_mfma_f32_16x16x32_bf16 v[132:135], a[140:143], a[36:39], v[132:135]
buffer_load_dwordx4 v14, s[8:11], s24 offen offset:2048 lds
v_mfma_f32_16x16x32_bf16 v[140:143], a[136:139], a[40:43], v[140:143]
ds_read_b128 a[100:103], v3 offset:57344
v_cvt_pk_bf16_f32 v75, v98, v99
v_mfma_f32_16x16x32_bf16 v[140:143], a[140:143], a[44:47], v[140:143]
ds_read_b128 a[104:107], v2 offset:59392
v_accvgpr_read_b32 v80, a240
v_mfma_f32_16x16x32_bf16 v[148:151], a[136:139], a[48:51], v[148:151]
ds_read_b128 a[108:111], v3 offset:59392
v_accvgpr_read_b32 v81, a241
v_mfma_f32_16x16x32_bf16 v[148:151], a[140:143], a[52:55], v[148:151]
buffer_load_dwordx4 v15, s[8:11], s24 offen offset:3072 lds
v_mfma_f32_16x16x32_bf16 v[156:159], a[136:139], a[56:59], v[156:159]
s_add_u32 s24, s24, 128
ds_read_b128 a[112:115], v2 offset:61440
v_accvgpr_read_b32 v82, a242
v_mfma_f32_16x16x32_bf16 v[156:159], a[140:143], a[60:63], v[156:159]
s_waitcnt lgkmcnt(5)
buffer_store_dwordx4 v[176:179], v1, s[4:7], s31 offen sc1
v_mfma_f32_16x16x32_bf16 v[164:167], a[128:131], a[0:3], v[164:167]
s_add_u32 s31, s31, s32
ds_read_b64_tr_b16 a[136:137], v25 offset:0
v_accvgpr_read_b32 v83, a243
v_mfma_f32_16x16x32_bf16 v[164:167], a[132:135], a[4:7], v[164:167]
v_accvgpr_read_b32 v96, a244
v_accvgpr_read_b32 v97, a245
v_mfma_f32_16x16x32_bf16 v[172:175], a[128:131], a[8:11], v[172:175]
ds_read_b64_tr_b16 a[138:139], v25 offset:2048
v_accvgpr_read_b32 v98, a246
v_mfma_f32_16x16x32_bf16 v[172:175], a[132:135], a[12:15], v[172:175]
ds_read_b128 a[116:119], v3 offset:61440
v_accvgpr_read_b32 v99, a247
v_mfma_f32_16x16x32_bf16 v[180:183], a[128:131], a[16:19], v[180:183]
ds_read_b64_tr_b16 a[140:141], v25 offset:16384
v_cvt_pk_bf16_f32 v80, v80, v81
v_mfma_f32_16x16x32_bf16 v[180:183], a[132:135], a[20:23], v[180:183]
buffer_store_dwordx4 v[184:187], v1, s[4:7], s31 offen sc1
v_mfma_f32_16x16x32_bf16 v[188:191], a[128:131], a[24:27], v[188:191]
s_add_u32 s31, s31, s34
ds_read_b64_tr_b16 a[142:143], v25 offset:18432
v_add_u32 v25, 32768, v25
v_mfma_f32_16x16x32_bf16 v[188:191], a[132:135], a[28:31], v[188:191]
v_cvt_pk_bf16_f32 v81, v82, v83
v_cvt_pk_bf16_f32 v82, v96, v97
v_mfma_f32_16x16x32_bf16 v[196:199], a[128:131], a[32:35], v[196:199]
ds_read_b128 a[120:123], v2 offset:63488
v_cvt_pk_bf16_f32 v83, v98, v99
v_mfma_f32_16x16x32_bf16 v[196:199], a[132:135], a[36:39], v[196:199]
v_accvgpr_read_b32 v88, a248
v_accvgpr_read_b32 v89, a249
v_mfma_f32_16x16x32_bf16 v[204:207], a[128:131], a[40:43], v[204:207]
ds_read_b128 a[124:127], v3 offset:63488
v_accvgpr_read_b32 v90, a250
v_mfma_f32_16x16x32_bf16 v[204:207], a[132:135], a[44:47], v[204:207]
v_accvgpr_read_b32 v91, a251
v_accvgpr_read_b32 v96, a252
v_mfma_f32_16x16x32_bf16 v[212:215], a[128:131], a[48:51], v[212:215]
v_accvgpr_read_b32 v97, a253
v_accvgpr_read_b32 v98, a254
v_mfma_f32_16x16x32_bf16 v[212:215], a[132:135], a[52:55], v[212:215]
v_accvgpr_read_b32 v99, a255
v_cvt_pk_bf16_f32 v88, v88, v89
v_mfma_f32_16x16x32_bf16 v[220:223], a[128:131], a[56:59], v[220:223]
v_cvt_pk_bf16_f32 v89, v90, v91
v_cvt_pk_bf16_f32 v90, v96, v97
v_mfma_f32_16x16x32_bf16 v[220:223], a[132:135], a[60:63], v[220:223]
s_waitcnt vmcnt(23) lgkmcnt(0)
s_barrier
v_cvt_pk_bf16_f32 v91, v98, v99
v_mfma_f32_16x16x32_bf16 v[224:227], a[136:139], a[0:3], v[224:227]
s_add_u32 m0, s29, 98304
ds_read_b64_tr_b16 a[128:129], v22 offset:0
v_mfma_f32_16x16x32_bf16 v[224:227], a[140:143], a[4:7], v[224:227]
buffer_load_dwordx4 v16, s[12:15], s26 offen offset:0 lds
v_mfma_f32_16x16x32_bf16 v[228:231], a[136:139], a[8:11], v[228:231]
ds_read_b64_tr_b16 a[130:131], v22 offset:2048
v_mfma_f32_16x16x32_bf16 v[228:231], a[140:143], a[12:15], v[228:231]
buffer_store_dwordx4 v[192:195], v1, s[4:7], s31 offen sc1
v_mfma_f32_16x16x32_bf16 v[232:235], a[136:139], a[16:19], v[232:235]
s_add_u32 s31, s31, s32
ds_read_b64_tr_b16 a[132:133], v22 offset:16384
v_mfma_f32_16x16x32_bf16 v[232:235], a[140:143], a[20:23], v[232:235]
buffer_load_dwordx4 v17, s[12:15], s26 offen offset:1024 lds
v_mfma_f32_16x16x32_bf16 v[236:239], a[136:139], a[24:27], v[236:239]
ds_read_b64_tr_b16 a[134:135], v22 offset:18432
v_add_u32 v22, 4294901760, v22
v_mfma_f32_16x16x32_bf16 v[236:239], a[140:143], a[28:31], v[236:239]
v_mfma_f32_16x16x32_bf16 v[240:243], a[136:139], a[32:35], v[240:243]
v_mfma_f32_16x16x32_bf16 v[240:243], a[140:143], a[36:39], v[240:243]
buffer_load_dwordx4 v18, s[12:15], s26 offen offset:2048 lds
v_mfma_f32_16x16x32_bf16 v[244:247], a[136:139], a[40:43], v[244:247]
v_mfma_f32_16x16x32_bf16 v[244:247], a[140:143], a[44:47], v[244:247]
v_mfma_f32_16x16x32_bf16 v[248:251], a[136:139], a[48:51], v[248:251]
v_mfma_f32_16x16x32_bf16 v[248:251], a[140:143], a[52:55], v[248:251]
buffer_load_dwordx4 v19, s[12:15], s26 offen offset:3072 lds
v_mfma_f32_16x16x32_bf16 v[252:255], a[136:139], a[56:59], v[252:255]
s_add_u32 s26, s26, 524288
v_mfma_f32_16x16x32_bf16 v[252:255], a[140:143], a[60:63], v[252:255]
s_waitcnt lgkmcnt(0)
v_mfma_f32_16x16x32_bf16 v[36:39], a[128:131], a[64:67], v[36:39]
s_add_u32 m0, s29, 114688
ds_read_b64_tr_b16 a[136:137], v23 offset:0
v_mfma_f32_16x16x32_bf16 v[36:39], a[132:135], a[68:71], v[36:39]
buffer_load_dwordx4 v16, s[12:15], s27 offen offset:0 lds
v_mfma_f32_16x16x32_bf16 v[44:47], a[128:131], a[72:75], v[44:47]
ds_read_b64_tr_b16 a[138:139], v23 offset:2048
v_mfma_f32_16x16x32_bf16 v[44:47], a[132:135], a[76:79], v[44:47]
ds_read_b128 a[0:3], v2 offset:0
ds_read_b128 a[4:7], v3 offset:0
v_mfma_f32_16x16x32_bf16 v[52:55], a[128:131], a[80:83], v[52:55]
ds_read_b64_tr_b16 a[140:141], v23 offset:16384
v_mfma_f32_16x16x32_bf16 v[52:55], a[132:135], a[84:87], v[52:55]
buffer_load_dwordx4 v17, s[12:15], s27 offen offset:1024 lds
v_mfma_f32_16x16x32_bf16 v[60:63], a[128:131], a[88:91], v[60:63]
ds_read_b64_tr_b16 a[142:143], v23 offset:18432
v_add_u32 v23, 4294901760, v23
v_mfma_f32_16x16x32_bf16 v[60:63], a[132:135], a[92:95], v[60:63]
buffer_store_dwordx4 v[200:203], v1, s[4:7], s31 offen sc1
v_mfma_f32_16x16x32_bf16 v[68:71], a[128:131], a[96:99], v[68:71]
s_add_u32 s31, s31, s33
ds_read_b128 a[8:11], v2 offset:2048
v_mfma_f32_16x16x32_bf16 v[68:71], a[132:135], a[100:103], v[68:71]
buffer_load_dwordx4 v18, s[12:15], s27 offen offset:2048 lds
v_mfma_f32_16x16x32_bf16 v[76:79], a[128:131], a[104:107], v[76:79]
ds_read_b128 a[12:15], v3 offset:2048
v_mfma_f32_16x16x32_bf16 v[76:79], a[132:135], a[108:111], v[76:79]
ds_read_b128 a[16:19], v2 offset:4096
v_mfma_f32_16x16x32_bf16 v[84:87], a[128:131], a[112:115], v[84:87]
ds_read_b128 a[20:23], v3 offset:4096
v_mfma_f32_16x16x32_bf16 v[84:87], a[132:135], a[116:119], v[84:87]
buffer_load_dwordx4 v19, s[12:15], s27 offen offset:3072 lds
v_mfma_f32_16x16x32_bf16 v[92:95], a[128:131], a[120:123], v[92:95]
s_add_u32 s27, s27, 524288
ds_read_b128 a[24:27], v2 offset:6144
v_mfma_f32_16x16x32_bf16 v[92:95], a[132:135], a[124:127], v[92:95]
s_waitcnt lgkmcnt(5)
buffer_store_dwordx4 v[208:211], v1, s[4:7], s31 offen sc1
v_mfma_f32_16x16x32_bf16 v[100:103], a[136:139], a[64:67], v[100:103]
s_add_u32 s31, s31, s32
ds_read_b64_tr_b16 a[128:129], v24 offset:0
v_mfma_f32_16x16x32_bf16 v[100:103], a[140:143], a[68:71], v[100:103]
v_mfma_f32_16x16x32_bf16 v[108:111], a[136:139], a[72:75], v[108:111]
ds_read_b64_tr_b16 a[130:131], v24 offset:2048
v_mfma_f32_16x16x32_bf16 v[108:111], a[140:143], a[76:79], v[108:111]
ds_read_b128 a[28:31], v3 offset:6144
v_mfma_f32_16x16x32_bf16 v[116:119], a[136:139], a[80:83], v[116:119]
ds_read_b64_tr_b16 a[132:133], v24 offset:16384
v_mfma_f32_16x16x32_bf16 v[116:119], a[140:143], a[84:87], v[116:119]
v_mfma_f32_16x16x32_bf16 v[124:127], a[136:139], a[88:91], v[124:127]
ds_read_b64_tr_b16 a[134:135], v24 offset:18432
v_add_u32 v24, 4294901760, v24
v_mfma_f32_16x16x32_bf16 v[124:127], a[140:143], a[92:95], v[124:127]
v_mfma_f32_16x16x32_bf16 v[132:135], a[136:139], a[96:99], v[132:135]
ds_read_b128 a[32:35], v2 offset:8192
v_mfma_f32_16x16x32_bf16 v[132:135], a[140:143], a[100:103], v[132:135]
buffer_store_dwordx4 v[216:219], v1, s[4:7], s31 offen sc1
v_mfma_f32_16x16x32_bf16 v[140:143], a[136:139], a[104:107], v[140:143]
s_add_u32 s31, s31, s35
ds_read_b128 a[36:39], v3 offset:8192
v_mfma_f32_16x16x32_bf16 v[140:143], a[140:143], a[108:111], v[140:143]
ds_read_b128 a[40:43], v2 offset:10240
v_mfma_f32_16x16x32_bf16 v[148:151], a[136:139], a[112:115], v[148:151]
ds_read_b128 a[44:47], v3 offset:10240
v_mfma_f32_16x16x32_bf16 v[148:151], a[140:143], a[116:119], v[148:151]
v_mfma_f32_16x16x32_bf16 v[156:159], a[136:139], a[120:123], v[156:159]
ds_read_b128 a[48:51], v2 offset:12288
v_mfma_f32_16x16x32_bf16 v[156:159], a[140:143], a[124:127], v[156:159]
s_waitcnt lgkmcnt(5)
v_mfma_f32_16x16x32_bf16 v[164:167], a[128:131], a[64:67], v[164:167]
ds_read_b64_tr_b16 a[136:137], v25 offset:0
v_mfma_f32_16x16x32_bf16 v[164:167], a[132:135], a[68:71], v[164:167]
v_mfma_f32_16x16x32_bf16 v[172:175], a[128:131], a[72:75], v[172:175]
ds_read_b64_tr_b16 a[138:139], v25 offset:2048
v_mfma_f32_16x16x32_bf16 v[172:175], a[132:135], a[76:79], v[172:175]
ds_read_b128 a[52:55], v3 offset:12288
v_mfma_f32_16x16x32_bf16 v[180:183], a[128:131], a[80:83], v[180:183]
ds_read_b64_tr_b16 a[140:141], v25 offset:16384
v_mfma_f32_16x16x32_bf16 v[180:183], a[132:135], a[84:87], v[180:183]
buffer_store_dwordx4 v[32:35], v1, s[4:7], s31 offen sc1
v_mfma_f32_16x16x32_bf16 v[188:191], a[128:131], a[88:91], v[188:191]
s_add_u32 s31, s31, s32
ds_read_b64_tr_b16 a[142:143], v25 offset:18432
v_add_u32 v25, 4294901760, v25
v_mfma_f32_16x16x32_bf16 v[188:191], a[132:135], a[92:95], v[188:191]
v_mfma_f32_16x16x32_bf16 v[196:199], a[128:131], a[96:99], v[196:199]
ds_read_b128 a[56:59], v2 offset:14336
v_mfma_f32_16x16x32_bf16 v[196:199], a[132:135], a[100:103], v[196:199]
v_mfma_f32_16x16x32_bf16 v[204:207], a[128:131], a[104:107], v[204:207]
ds_read_b128 a[60:63], v3 offset:14336
v_mfma_f32_16x16x32_bf16 v[204:207], a[132:135], a[108:111], v[204:207]
v_mfma_f32_16x16x32_bf16 v[212:215], a[128:131], a[112:115], v[212:215]
v_mfma_f32_16x16x32_bf16 v[212:215], a[132:135], a[116:119], v[212:215]
v_mfma_f32_16x16x32_bf16 v[220:223], a[128:131], a[120:123], v[220:223]
v_mfma_f32_16x16x32_bf16 v[220:223], a[132:135], a[124:127], v[220:223]
s_waitcnt vmcnt(20) lgkmcnt(0)
s_barrier
v_mfma_f32_16x16x32_bf16 v[224:227], a[136:139], a[64:67], v[224:227]
s_add_u32 m0, s29, 131072
ds_read_b64_tr_b16 a[128:129], v22 offset:0
v_mfma_f32_16x16x32_bf16 v[224:227], a[140:143], a[68:71], v[224:227]
buffer_load_dwordx4 v16, s[12:15], s26 offen offset:0 lds
v_mfma_f32_16x16x32_bf16 v[228:231], a[136:139], a[72:75], v[228:231]
ds_read_b64_tr_b16 a[130:131], v22 offset:2048
v_mfma_f32_16x16x32_bf16 v[228:231], a[140:143], a[76:79], v[228:231]
buffer_store_dwordx4 v[40:43], v1, s[4:7], s31 offen sc1
v_mfma_f32_16x16x32_bf16 v[232:235], a[136:139], a[80:83], v[232:235]
s_add_u32 s31, s31, s33
ds_read_b64_tr_b16 a[132:133], v22 offset:16384
v_mfma_f32_16x16x32_bf16 v[232:235], a[140:143], a[84:87], v[232:235]
buffer_load_dwordx4 v17, s[12:15], s26 offen offset:1024 lds
v_mfma_f32_16x16x32_bf16 v[236:239], a[136:139], a[88:91], v[236:239]
ds_read_b64_tr_b16 a[134:135], v22 offset:18432
v_add_u32 v22, 32768, v22
v_mfma_f32_16x16x32_bf16 v[236:239], a[140:143], a[92:95], v[236:239]
v_mfma_f32_16x16x32_bf16 v[240:243], a[136:139], a[96:99], v[240:243]
v_mfma_f32_16x16x32_bf16 v[240:243], a[140:143], a[100:103], v[240:243]
buffer_load_dwordx4 v18, s[12:15], s26 offen offset:2048 lds
v_mfma_f32_16x16x32_bf16 v[244:247], a[136:139], a[104:107], v[244:247]
v_mfma_f32_16x16x32_bf16 v[244:247], a[140:143], a[108:111], v[244:247]
v_mfma_f32_16x16x32_bf16 v[248:251], a[136:139], a[112:115], v[248:251]
v_mfma_f32_16x16x32_bf16 v[248:251], a[140:143], a[116:119], v[248:251]
buffer_load_dwordx4 v19, s[12:15], s26 offen offset:3072 lds
v_mfma_f32_16x16x32_bf16 v[252:255], a[136:139], a[120:123], v[252:255]
s_add_u32 s26, s26, 524288
v_mfma_f32_16x16x32_bf16 v[252:255], a[140:143], a[124:127], v[252:255]
s_waitcnt lgkmcnt(0)
v_mfma_f32_16x16x32_bf16 v[36:39], a[128:131], a[0:3], v[36:39]
s_add_u32 m0, s29, 147456
ds_read_b64_tr_b16 a[136:137], v23 offset:0
v_mfma_f32_16x16x32_bf16 v[36:39], a[132:135], a[4:7], v[36:39]
buffer_load_dwordx4 v16, s[12:15], s27 offen offset:0 lds
v_mfma_f32_16x16x32_bf16 v[44:47], a[128:131], a[8:11], v[44:47]
s_lshl_b32 s22, s20, 7
ds_read_b64_tr_b16 a[138:139], v23 offset:2048
v_bfe_u32 v20, v1, 4, 3
v_mfma_f32_16x16x32_bf16 v[44:47], a[132:135], a[12:15], v[44:47]
s_add_u32 s70, s22, 94371840
ds_read_b128 a[64:67], v2 offset:16384
ds_read_b128 a[68:71], v3 offset:16384
v_mfma_f32_16x16x32_bf16 v[52:55], a[128:131], a[16:19], v[52:55]
s_lshr_b32 s22, s2, 4
ds_read_b64_tr_b16 a[140:141], v23 offset:16384
v_lshlrev_b32 v20, 3, v20
v_mfma_f32_16x16x32_bf16 v[52:55], a[132:135], a[20:23], v[52:55]
s_lshl_b32 s22, s22, 2
buffer_load_dwordx4 v17, s[12:15], s27 offen offset:1024 lds
v_mfma_f32_16x16x32_bf16 v[60:63], a[128:131], a[24:27], v[60:63]
s_add_u32 s66, s70, s22
ds_read_b64_tr_b16 a[142:143], v23 offset:18432
v_add_u32 v23, 32768, v23
v_mfma_f32_16x16x32_bf16 v[60:63], a[132:135], a[28:31], v[60:63]
s_and_b32 s22, s2, 16
buffer_store_dwordx4 v[48:51], v1, s[4:7], s31 offen sc1
v_mfma_f32_16x16x32_bf16 v[68:71], a[128:131], a[32:35], v[68:71]
s_add_u32 s31, s31, s32
ds_read_b128 a[72:75], v2 offset:18432
v_add_u32 v15, 2052, v20
v_mfma_f32_16x16x32_bf16 v[68:71], a[132:135], a[36:39], v[68:71]
s_lshl_b32 s22, s22, 7
buffer_load_dwordx4 v18, s[12:15], s27 offen offset:2048 lds
v_mfma_f32_16x16x32_bf16 v[76:79], a[128:131], a[40:43], v[76:79]
s_add_u32 s66, s66, s22
ds_read_b128 a[76:79], v3 offset:18432
v_mfma_f32_16x16x32_bf16 v[76:79], a[132:135], a[44:47], v[76:79]
s_lshl_b32 s67, s20, 20
ds_read_b128 a[80:83], v2 offset:20480
v_mfma_f32_16x16x32_bf16 v[84:87], a[128:131], a[48:51], v[84:87]
s_lshl_b32 s22, s37, 16
ds_read_b128 a[84:87], v3 offset:20480
v_mfma_f32_16x16x32_bf16 v[84:87], a[132:135], a[52:55], v[84:87]
s_add_u32 s67, s67, s22
buffer_load_dwordx4 v19, s[12:15], s27 offen offset:3072 lds
v_mfma_f32_16x16x32_bf16 v[92:95], a[128:131], a[56:59], v[92:95]
s_waitcnt lgkmcnt(5)
s_add_u32 s27, s27, 524288
ds_read_b128 a[88:91], v2 offset:22528
v_mfma_f32_16x16x32_bf16 v[92:95], a[132:135], a[60:63], v[92:95]
s_lshl_b32 s22, s3, 11
buffer_store_dwordx4 v[56:59], v1, s[4:7], s31 offen sc1
v_mfma_f32_16x16x32_bf16 v[100:103], a[136:139], a[0:3], v[100:103]
s_waitcnt lgkmcnt(5)
s_add_u32 s31, s31, s34
ds_read_b64_tr_b16 a[128:129], v24 offset:0
v_mfma_f32_16x16x32_bf16 v[100:103], a[140:143], a[4:7], v[100:103]
s_add_u32 s67, s67, s22
v_mfma_f32_16x16x32_bf16 v[108:111], a[136:139], a[8:11], v[108:111]
s_add_u32 s67, s67, 33554432
ds_read_b64_tr_b16 a[130:131], v24 offset:2048
v_mfma_f32_16x16x32_bf16 v[108:111], a[140:143], a[12:15], v[108:111]
s_mov_b32 s68, 1035512379
ds_read_b128 a[92:95], v3 offset:22528
v_mfma_f32_16x16x32_bf16 v[116:119], a[136:139], a[16:19], v[116:119]
s_mov_b32 s69, 1035512379
ds_read_b64_tr_b16 a[132:133], v24 offset:16384
v_mfma_f32_16x16x32_bf16 v[116:119], a[140:143], a[20:23], v[116:119]
buffer_store_dwordx4 v[64:67], v1, s[4:7], s31 offen sc1
v_mfma_f32_16x16x32_bf16 v[124:127], a[136:139], a[24:27], v[124:127]
s_add_u32 s31, s31, s32
ds_read_b64_tr_b16 a[134:135], v24 offset:18432
v_add_u32 v24, 32768, v24
v_mfma_f32_16x16x32_bf16 v[124:127], a[140:143], a[28:31], v[124:127]
v_mfma_f32_16x16x32_bf16 v[132:135], a[136:139], a[32:35], v[132:135]
ds_read_b128 a[96:99], v2 offset:24576
v_mfma_f32_16x16x32_bf16 v[132:135], a[140:143], a[36:39], v[132:135]
v_mfma_f32_16x16x32_bf16 v[140:143], a[136:139], a[40:43], v[140:143]
ds_read_b128 a[100:103], v3 offset:24576
v_mfma_f32_16x16x32_bf16 v[140:143], a[140:143], a[44:47], v[140:143]
ds_read_b128 a[104:107], v2 offset:26624
v_mfma_f32_16x16x32_bf16 v[148:151], a[136:139], a[48:51], v[148:151]
ds_read_b128 a[108:111], v3 offset:26624
v_mfma_f32_16x16x32_bf16 v[148:151], a[140:143], a[52:55], v[148:151]
v_mfma_f32_16x16x32_bf16 v[156:159], a[136:139], a[56:59], v[156:159]
ds_read_b128 a[112:115], v2 offset:28672
v_mfma_f32_16x16x32_bf16 v[156:159], a[140:143], a[60:63], v[156:159]
s_waitcnt lgkmcnt(5)
buffer_store_dwordx4 v[72:75], v1, s[4:7], s31 offen sc1
v_mfma_f32_16x16x32_bf16 v[164:167], a[128:131], a[0:3], v[164:167]
s_add_u32 s31, s31, s33
ds_read_b64_tr_b16 a[136:137], v25 offset:0
v_mfma_f32_16x16x32_bf16 v[164:167], a[132:135], a[4:7], v[164:167]
v_mfma_f32_16x16x32_bf16 v[172:175], a[128:131], a[8:11], v[172:175]
ds_read_b64_tr_b16 a[138:139], v25 offset:2048
v_mfma_f32_16x16x32_bf16 v[172:175], a[132:135], a[12:15], v[172:175]
ds_read_b128 a[116:119], v3 offset:28672
v_mfma_f32_16x16x32_bf16 v[180:183], a[128:131], a[16:19], v[180:183]
ds_read_b64_tr_b16 a[140:141], v25 offset:16384
v_mfma_f32_16x16x32_bf16 v[180:183], a[132:135], a[20:23], v[180:183]
v_mfma_f32_16x16x32_bf16 v[188:191], a[128:131], a[24:27], v[188:191]
ds_read_b64_tr_b16 a[142:143], v25 offset:18432
v_add_u32 v25, 32768, v25
v_mfma_f32_16x16x32_bf16 v[188:191], a[132:135], a[28:31], v[188:191]
v_mfma_f32_16x16x32_bf16 v[196:199], a[128:131], a[32:35], v[196:199]
ds_read_b128 a[120:123], v2 offset:30720
v_mfma_f32_16x16x32_bf16 v[196:199], a[132:135], a[36:39], v[196:199]
buffer_store_dwordx4 v[80:83], v1, s[4:7], s31 offen sc1
v_mfma_f32_16x16x32_bf16 v[204:207], a[128:131], a[40:43], v[204:207]
s_add_u32 s31, s31, s32
ds_read_b128 a[124:127], v3 offset:30720
v_mfma_f32_16x16x32_bf16 v[204:207], a[132:135], a[44:47], v[204:207]
v_mfma_f32_16x16x32_bf16 v[212:215], a[128:131], a[48:51], v[212:215]
v_mfma_f32_16x16x32_bf16 v[212:215], a[132:135], a[52:55], v[212:215]
v_mfma_f32_16x16x32_bf16 v[220:223], a[128:131], a[56:59], v[220:223]
v_mfma_f32_16x16x32_bf16 v[220:223], a[132:135], a[60:63], v[220:223]
s_waitcnt vmcnt(17) lgkmcnt(0)
s_barrier
v_mfma_f32_16x16x32_bf16 v[224:227], a[136:139], a[0:3], v[224:227]
ds_read_b64_tr_b16 a[128:129], v22 offset:0
v_mfma_f32_16x16x32_bf16 v[224:227], a[140:143], a[4:7], v[224:227]
v_mfma_f32_16x16x32_bf16 v[228:231], a[136:139], a[8:11], v[228:231]
ds_read_b64_tr_b16 a[130:131], v22 offset:2048
v_mfma_f32_16x16x32_bf16 v[228:231], a[140:143], a[12:15], v[228:231]
buffer_store_dwordx4 v[88:91], v1, s[4:7], s31 offen sc1
v_mfma_f32_16x16x32_bf16 v[232:235], a[136:139], a[16:19], v[232:235]
ds_read_b64_tr_b16 a[132:133], v22 offset:16384
v_mfma_f32_16x16x32_bf16 v[232:235], a[140:143], a[20:23], v[232:235]
v_mfma_f32_16x16x32_bf16 v[236:239], a[136:139], a[24:27], v[236:239]
ds_read_b64_tr_b16 a[134:135], v22 offset:18432
v_add_u32 v22, 32768, v22
v_mfma_f32_16x16x32_bf16 v[236:239], a[140:143], a[28:31], v[236:239]
v_mfma_f32_16x16x32_bf16 v[240:243], a[136:139], a[32:35], v[240:243]
v_mfma_f32_16x16x32_bf16 v[240:243], a[140:143], a[36:39], v[240:243]
v_mfma_f32_16x16x32_bf16 v[244:247], a[136:139], a[40:43], v[244:247]
v_mfma_f32_16x16x32_bf16 v[244:247], a[140:143], a[44:47], v[244:247]
v_mfma_f32_16x16x32_bf16 v[248:251], a[136:139], a[48:51], v[248:251]
v_mfma_f32_16x16x32_bf16 v[248:251], a[140:143], a[52:55], v[248:251]
v_mfma_f32_16x16x32_bf16 v[252:255], a[136:139], a[56:59], v[252:255]
v_mfma_f32_16x16x32_bf16 v[252:255], a[140:143], a[60:63], v[252:255]
s_waitcnt lgkmcnt(0)
v_mfma_f32_16x16x32_bf16 v[36:39], a[128:131], a[64:67], v[36:39]
ds_read_b64_tr_b16 a[136:137], v23 offset:0
v_and_b32 v14, 128, v1
v_mfma_f32_16x16x32_bf16 v[36:39], a[132:135], a[68:71], v[36:39]
v_mul_u32_u24 v14, 2, v14
v_add_u32 v20, v14, v20
v_mfma_f32_16x16x32_bf16 v[44:47], a[128:131], a[72:75], v[44:47]
s_mul_i32 s85, s20, 7
ds_read_b64_tr_b16 a[138:139], v23 offset:2048
v_add_u32 v15, v14, v15
v_mfma_f32_16x16x32_bf16 v[44:47], a[132:135], a[76:79], v[44:47]
s_add_u32 s85, s85, s21
ds_read_b128 a[0:3], v2 offset:32768
ds_read_b128 a[4:7], v3 offset:32768
v_mfma_f32_16x16x32_bf16 v[52:55], a[128:131], a[80:83], v[52:55]
s_lshl_b32 s85, s85, 2
ds_read_b64_tr_b16 a[140:141], v23 offset:16384
v_mfma_f32_16x16x32_bf16 v[52:55], a[132:135], a[84:87], v[52:55]
s_add_u32 s85, s85, s3
v_mfma_f32_16x16x32_bf16 v[60:63], a[128:131], a[88:91], v[60:63]
s_mul_i32 s82, s85, 4224
ds_read_b64_tr_b16 a[142:143], v23 offset:18432
v_add_u32 v23, 32768, v23
v_mfma_f32_16x16x32_bf16 v[60:63], a[132:135], a[92:95], v[60:63]
s_add_u32 s82, s82, 83886208
v_mfma_f32_16x16x32_bf16 v[68:71], a[128:131], a[96:99], v[68:71]
s_lshl_b32 s83, s85, 12
ds_read_b128 a[8:11], v2 offset:34816
v_mfma_f32_16x16x32_bf16 v[68:71], a[132:135], a[100:103], v[68:71]
s_mul_i32 s84, s3, 21248
v_mfma_f32_16x16x32_bf16 v[76:79], a[128:131], a[104:107], v[76:79]
s_add_u32 s84, s84, 46080
ds_read_b128 a[12:15], v3 offset:34816
v_mfma_f32_16x16x32_bf16 v[76:79], a[132:135], a[108:111], v[76:79]
s_mov_b64 s[60:61], s[72:73]
ds_read_b128 a[16:19], v2 offset:36864
v_mfma_f32_16x16x32_bf16 v[84:87], a[128:131], a[112:115], v[84:87]
s_mov_b32 s62, 1835008
ds_read_b128 a[20:23], v3 offset:36864
v_mfma_f32_16x16x32_bf16 v[84:87], a[132:135], a[116:119], v[84:87]
v_mfma_f32_16x16x32_bf16 v[92:95], a[128:131], a[120:123], v[92:95]
ds_read_b128 a[24:27], v2 offset:38912
v_mfma_f32_16x16x32_bf16 v[92:95], a[132:135], a[124:127], v[92:95]
s_waitcnt lgkmcnt(5)
v_mfma_f32_16x16x32_bf16 v[100:103], a[136:139], a[64:67], v[100:103]
ds_read_b64_tr_b16 a[128:129], v24 offset:0
v_mfma_f32_16x16x32_bf16 v[100:103], a[140:143], a[68:71], v[100:103]
v_mfma_f32_16x16x32_bf16 v[108:111], a[136:139], a[72:75], v[108:111]
ds_read_b64_tr_b16 a[130:131], v24 offset:2048
v_mfma_f32_16x16x32_bf16 v[108:111], a[140:143], a[76:79], v[108:111]
ds_read_b128 a[28:31], v3 offset:38912
v_mfma_f32_16x16x32_bf16 v[116:119], a[136:139], a[80:83], v[116:119]
ds_read_b64_tr_b16 a[132:133], v24 offset:16384
v_mfma_f32_16x16x32_bf16 v[116:119], a[140:143], a[84:87], v[116:119]
v_mfma_f32_16x16x32_bf16 v[124:127], a[136:139], a[88:91], v[124:127]
ds_read_b64_tr_b16 a[134:135], v24 offset:18432
v_add_u32 v24, 32768, v24
v_mfma_f32_16x16x32_bf16 v[124:127], a[140:143], a[92:95], v[124:127]
v_mfma_f32_16x16x32_bf16 v[132:135], a[136:139], a[96:99], v[132:135]
ds_read_b128 a[32:35], v2 offset:40960
v_mfma_f32_16x16x32_bf16 v[132:135], a[140:143], a[100:103], v[132:135]
v_mfma_f32_16x16x32_bf16 v[140:143], a[136:139], a[104:107], v[140:143]
ds_read_b128 a[36:39], v3 offset:40960
v_mfma_f32_16x16x32_bf16 v[140:143], a[140:143], a[108:111], v[140:143]
ds_read_b128 a[40:43], v2 offset:43008
v_mfma_f32_16x16x32_bf16 v[148:151], a[136:139], a[112:115], v[148:151]
ds_read_b128 a[44:47], v3 offset:43008
v_mfma_f32_16x16x32_bf16 v[148:151], a[140:143], a[116:119], v[148:151]
v_mfma_f32_16x16x32_bf16 v[156:159], a[136:139], a[120:123], v[156:159]
s_andn2_b32 s31, s70, 256
ds_read_b128 a[48:51], v2 offset:45056
v_mfma_f32_16x16x32_bf16 v[156:159], a[140:143], a[124:127], v[156:159]
s_waitcnt lgkmcnt(5)
v_mfma_f32_16x16x32_bf16 v[164:167], a[128:131], a[64:67], v[164:167]
ds_read_b64_tr_b16 a[136:137], v25 offset:0
v_mfma_f32_16x16x32_bf16 v[164:167], a[132:135], a[68:71], v[164:167]
v_mfma_f32_16x16x32_bf16 v[172:175], a[128:131], a[72:75], v[172:175]
ds_read_b64_tr_b16 a[138:139], v25 offset:2048
v_mfma_f32_16x16x32_bf16 v[172:175], a[132:135], a[76:79], v[172:175]
ds_read_b128 a[52:55], v3 offset:45056
v_mfma_f32_16x16x32_bf16 v[180:183], a[128:131], a[80:83], v[180:183]
ds_read_b64_tr_b16 a[140:141], v25 offset:16384
v_mfma_f32_16x16x32_bf16 v[180:183], a[132:135], a[84:87], v[180:183]
v_mfma_f32_16x16x32_bf16 v[188:191], a[128:131], a[88:91], v[188:191]
ds_read_b64_tr_b16 a[142:143], v25 offset:18432
v_add_u32 v25, 32768, v25
v_mfma_f32_16x16x32_bf16 v[188:191], a[132:135], a[92:95], v[188:191]
v_mfma_f32_16x16x32_bf16 v[196:199], a[128:131], a[96:99], v[196:199]
ds_read_b128 a[56:59], v2 offset:47104
v_mfma_f32_16x16x32_bf16 v[196:199], a[132:135], a[100:103], v[196:199]
v_mfma_f32_16x16x32_bf16 v[204:207], a[128:131], a[104:107], v[204:207]
ds_read_b128 a[60:63], v3 offset:47104
v_mfma_f32_16x16x32_bf16 v[204:207], a[132:135], a[108:111], v[204:207]
v_mfma_f32_16x16x32_bf16 v[212:215], a[128:131], a[112:115], v[212:215]
v_mfma_f32_16x16x32_bf16 v[212:215], a[132:135], a[116:119], v[212:215]
v_mfma_f32_16x16x32_bf16 v[220:223], a[128:131], a[120:123], v[220:223]
v_mfma_f32_16x16x32_bf16 v[220:223], a[132:135], a[124:127], v[220:223]
s_waitcnt vmcnt(0) lgkmcnt(0)
s_barrier
v_mfma_f32_16x16x32_bf16 v[224:227], a[136:139], a[64:67], v[224:227]
ds_read_b64_tr_b16 a[128:129], v22 offset:0
v_mfma_f32_16x16x32_bf16 v[224:227], a[140:143], a[68:71], v[224:227]
buffer_store_dword v27, v26, s[4:7], s66 offen sc1
v_mfma_f32_16x16x32_bf16 v[228:231], a[136:139], a[72:75], v[228:231]
ds_read_b64_tr_b16 a[130:131], v22 offset:2048
v_mfma_f32_16x16x32_bf16 v[228:231], a[140:143], a[76:79], v[228:231]
PAD_29:
s_cbranch_execz M_tret
v_mfma_f32_16x16x32_bf16 v[232:235], a[136:139], a[80:83], v[232:235]
ds_read_b64_tr_b16 a[132:133], v22 offset:16384
v_mfma_f32_16x16x32_bf16 v[232:235], a[140:143], a[84:87], v[232:235]
v_mfma_f32_16x16x32_bf16 v[236:239], a[136:139], a[88:91], v[236:239]
ds_read_b64_tr_b16 a[134:135], v22 offset:18432
v_mfma_f32_16x16x32_bf16 v[236:239], a[140:143], a[92:95], v[236:239]
v_mfma_f32_16x16x32_bf16 v[240:243], a[136:139], a[96:99], v[240:243]
v_mfma_f32_16x16x32_bf16 v[240:243], a[140:143], a[100:103], v[240:243]
v_mfma_f32_16x16x32_bf16 v[244:247], a[136:139], a[104:107], v[244:247]
v_mfma_f32_16x16x32_bf16 v[244:247], a[140:143], a[108:111], v[244:247]
v_mfma_f32_16x16x32_bf16 v[248:251], a[136:139], a[112:115], v[248:251]
v_mfma_f32_16x16x32_bf16 v[248:251], a[140:143], a[116:119], v[248:251]
v_mfma_f32_16x16x32_bf16 v[252:255], a[136:139], a[120:123], v[252:255]
v_mfma_f32_16x16x32_bf16 v[252:255], a[140:143], a[124:127], v[252:255]
s_waitcnt lgkmcnt(0)
v_mfma_f32_16x16x32_bf16 v[36:39], a[128:131], a[0:3], v[36:39]
s_add_u32 m0, s84, 17152
ds_read_b64_tr_b16 a[136:137], v23 offset:0
v_lshrrev_b32 v9, 4, v1
v_mfma_f32_16x16x32_bf16 v[36:39], a[132:135], a[4:7], v[36:39]
buffer_load_dwordx4 v1, s[60:63], s83 offen offset:0 lds
v_mfma_f32_16x16x32_bf16 v[44:47], a[128:131], a[8:11], v[44:47]
ds_read_b64_tr_b16 a[138:139], v23 offset:2048
v_and_b32 v10, 15, v9
v_mfma_f32_16x16x32_bf16 v[44:47], a[132:135], a[12:15], v[44:47]
buffer_load_dwordx4 v1, s[60:63], s83 offen offset:1024 lds
v_mfma_f32_16x16x32_bf16 v[52:55], a[128:131], a[16:19], v[52:55]
ds_read_b64_tr_b16 a[140:141], v23 offset:16384
v_lshrrev_b32 v11, 4, v9
v_mfma_f32_16x16x32_bf16 v[52:55], a[132:135], a[20:23], v[52:55]
buffer_load_dwordx4 v1, s[60:63], s83 offen offset:2048 lds
v_mfma_f32_16x16x32_bf16 v[60:63], a[128:131], a[24:27], v[60:63]
ds_read_b64_tr_b16 a[142:143], v23 offset:18432
v_lshrrev_b32 v12, 2, v10
v_mfma_f32_16x16x32_bf16 v[60:63], a[132:135], a[28:31], v[60:63]
buffer_load_dwordx4 v1, s[60:63], s83 offen offset:3072 lds
v_mfma_f32_16x16x32_bf16 v[68:71], a[128:131], a[32:35], v[68:71]
s_add_u32 m0, s84, 64
v_mul_u32_u24 v12, 4160, v12
v_and_b32 v13, 3, v9
v_mfma_f32_16x16x32_bf16 v[68:71], a[132:135], a[36:39], v[68:71]
buffer_load_dwordx4 v1, s[4:7], s82 offen offset:0 sc1 lds
v_mfma_f32_16x16x32_bf16 v[76:79], a[128:131], a[40:43], v[76:79]
buffer_load_dwordx4 v1, s[4:7], s82 offen offset:1024 sc1 lds
v_mfma_f32_16x16x32_bf16 v[76:79], a[132:135], a[44:47], v[76:79]
buffer_load_dwordx4 v1, s[4:7], s82 offen offset:2048 sc1 lds
v_mfma_f32_16x16x32_bf16 v[84:87], a[128:131], a[48:51], v[84:87]
buffer_load_dwordx4 v1, s[4:7], s82 offen offset:3072 sc1 lds
v_mfma_f32_16x16x32_bf16 v[84:87], a[132:135], a[52:55], v[84:87]
s_add_u32 s82, s82, 2097152
v_lshl_add_u32 v12, v13, 3, v12
v_lshlrev_b32 v13, 4, v11
v_mfma_f32_16x16x32_bf16 v[92:95], a[128:131], a[56:59], v[92:95]
s_add_u32 m0, s84, 4224
v_sub_u32 v12, v12, v13
v_add_u32 v12, 88, v12
v_mfma_f32_16x16x32_bf16 v[92:95], a[132:135], a[60:63], v[92:95]
s_waitcnt lgkmcnt(0)
buffer_load_dwordx4 v1, s[4:7], s82 offen offset:0 sc1 lds
v_mfma_f32_16x16x32_bf16 v[100:103], a[136:139], a[0:3], v[100:103]
ds_read_b64_tr_b16 a[128:129], v24 offset:0
v_add_u32 v16, s84, v12
v_mfma_f32_16x16x32_bf16 v[100:103], a[140:143], a[4:7], v[100:103]
buffer_load_dwordx4 v1, s[4:7], s82 offen offset:1024 sc1 lds
v_mfma_f32_16x16x32_bf16 v[108:111], a[136:139], a[8:11], v[108:111]
ds_read_b64_tr_b16 a[130:131], v24 offset:2048
v_lshl_add_u32 v12, v10, 5, v13
v_mfma_f32_16x16x32_bf16 v[108:111], a[140:143], a[12:15], v[108:111]
buffer_load_dwordx4 v1, s[4:7], s82 offen offset:2048 sc1 lds
v_mfma_f32_16x16x32_bf16 v[116:119], a[136:139], a[16:19], v[116:119]
ds_read_b64_tr_b16 a[132:133], v24 offset:16384
v_add_u32 v12, 16672, v12
v_mfma_f32_16x16x32_bf16 v[116:119], a[140:143], a[20:23], v[116:119]
buffer_load_dwordx4 v1, s[4:7], s82 offen offset:3072 sc1 lds
v_mfma_f32_16x16x32_bf16 v[124:127], a[136:139], a[24:27], v[124:127]
s_add_u32 s82, s82, 4292870140
ds_read_b64_tr_b16 a[134:135], v24 offset:18432
v_add_u32 v17, s84, v12
v_mfma_f32_16x16x32_bf16 v[124:127], a[140:143], a[28:31], v[124:127]
s_add_u32 m0, s84, 8384
v_lshlrev_b32 v12, 5, v10
v_lshl_add_u32 v8, v11, 3, v12
v_mfma_f32_16x16x32_bf16 v[132:135], a[136:139], a[32:35], v[132:135]
buffer_load_dwordx4 v1, s[4:7], s82 offen offset:0 sc1 lds
v_mfma_f32_16x16x32_bf16 v[132:135], a[140:143], a[36:39], v[132:135]
buffer_load_dwordx4 v1, s[4:7], s82 offen offset:1024 sc1 lds
v_mfma_f32_16x16x32_bf16 v[140:143], a[136:139], a[40:43], v[140:143]
buffer_load_dwordx4 v1, s[4:7], s82 offen offset:2048 sc1 lds
v_mfma_f32_16x16x32_bf16 v[140:143], a[140:143], a[44:47], v[140:143]
buffer_load_dwordx4 v1, s[4:7], s82 offen offset:3072 sc1 lds
v_mfma_f32_16x16x32_bf16 v[148:151], a[136:139], a[48:51], v[148:151]
s_add_u32 s82, s82, 2097152
v_add3_u32 v18, s84, 64, v8
v_mov_b32 v19, 0
v_mfma_f32_16x16x32_bf16 v[148:151], a[140:143], a[52:55], v[148:151]
s_add_u32 m0, s84, 12544
v_mov_b32 v12, 0
v_mov_b32 v13, 0
v_mfma_f32_16x16x32_bf16 v[156:159], a[136:139], a[56:59], v[156:159]
buffer_load_dwordx4 v1, s[4:7], s82 offen offset:0 sc1 lds
v_mfma_f32_16x16x32_bf16 v[156:159], a[140:143], a[60:63], v[156:159]
s_waitcnt lgkmcnt(0)
buffer_load_dwordx4 v1, s[4:7], s82 offen offset:1024 sc1 lds
v_mfma_f32_16x16x32_bf16 v[164:167], a[128:131], a[0:3], v[164:167]
ds_read_b64_tr_b16 a[136:137], v25 offset:0
v_lshl_add_u32 v14, v9, 3, s84
v_mfma_f32_16x16x32_bf16 v[164:167], a[132:135], a[4:7], v[164:167]
buffer_load_dwordx4 v1, s[4:7], s82 offen offset:2048 sc1 lds
v_mfma_f32_16x16x32_bf16 v[172:175], a[128:131], a[8:11], v[172:175]
ds_read_b64_tr_b16 a[138:139], v25 offset:2048
v_mfma_f32_16x16x32_bf16 v[172:175], a[132:135], a[12:15], v[172:175]
buffer_load_dwordx4 v1, s[4:7], s82 offen offset:3072 sc1 lds
v_mfma_f32_16x16x32_bf16 v[180:183], a[128:131], a[16:19], v[180:183]
ds_read_b64_tr_b16 a[140:141], v25 offset:16384
v_mfma_f32_16x16x32_bf16 v[180:183], a[132:135], a[20:23], v[180:183]
ds_write_b64 v14, v[12:13] offset:16640
v_mul_u32_u24 v14, 4160, v11
v_mfma_f32_16x16x32_bf16 v[188:191], a[128:131], a[24:27], v[188:191]
ds_read_b64_tr_b16 a[142:143], v25 offset:18432
v_lshl_add_u32 v14, v10, 2, v14
v_mfma_f32_16x16x32_bf16 v[188:191], a[132:135], a[28:31], v[188:191]
v_add_u32 v14, s84, v14
v_mfma_f32_16x16x32_bf16 v[196:199], a[128:131], a[32:35], v[196:199]
ds_write_b32 v14, v12
v_lshrrev_b32 v30, 6, v0
v_mfma_f32_16x16x32_bf16 v[196:199], a[132:135], a[36:39], v[196:199]
v_lshl_add_u32 v28, v30, 11, v1
v_add_u32 v29, 0x20000, v28
v_mfma_f32_16x16x32_bf16 v[204:207], a[128:131], a[40:43], v[204:207]
v_lshl_add_u32 v30, v30, 13, v1
v_add_u32 v31, 0x20000, v30
v_mfma_f32_16x16x32_bf16 v[204:207], a[132:135], a[44:47], v[204:207]
v_mul_f32 v36, s68, v36
v_mul_f32 v37, s68, v37
v_mfma_f32_16x16x32_bf16 v[212:215], a[128:131], a[48:51], v[212:215]
v_mul_f32 v38, s68, v38
v_mul_f32 v39, s68, v39
v_mfma_f32_16x16x32_bf16 v[212:215], a[132:135], a[52:55], v[212:215]
v_mul_f32 v100, s68, v100
v_mul_f32 v101, s68, v101
v_mfma_f32_16x16x32_bf16 v[220:223], a[128:131], a[56:59], v[220:223]
v_mul_f32 v102, s68, v102
v_mul_f32 v103, s68, v103
v_mfma_f32_16x16x32_bf16 v[220:223], a[132:135], a[60:63], v[220:223]
s_waitcnt lgkmcnt(0)
s_waitcnt lgkmcnt(0)
s_barrier
v_mfma_f32_16x16x32_bf16 v[224:227], a[136:139], a[0:3], v[224:227]
v_cvt_pk_bf16_f32 v36, v36, v37
v_cvt_pk_bf16_f32 v37, v38, v39
v_mfma_f32_16x16x32_bf16 v[224:227], a[140:143], a[4:7], v[224:227]
v_cvt_pk_bf16_f32 v38, v100, v101
v_cvt_pk_bf16_f32 v39, v102, v103
v_mfma_f32_16x16x32_bf16 v[228:231], a[136:139], a[8:11], v[228:231]
v_mul_f32 v44, s68, v44
v_mul_f32 v45, s68, v45
v_mfma_f32_16x16x32_bf16 v[228:231], a[140:143], a[12:15], v[228:231]
v_mul_f32 v46, s68, v46
v_mul_f32 v47, s68, v47
v_mfma_f32_16x16x32_bf16 v[232:235], a[136:139], a[16:19], v[232:235]
v_mul_f32 v108, s68, v108
v_mul_f32 v109, s68, v109
v_mfma_f32_16x16x32_bf16 v[232:235], a[140:143], a[20:23], v[232:235]
v_mul_f32 v110, s68, v110
v_mul_f32 v111, s68, v111
v_mfma_f32_16x16x32_bf16 v[236:239], a[136:139], a[24:27], v[236:239]
v_cvt_pk_bf16_f32 v44, v44, v45
v_cvt_pk_bf16_f32 v45, v46, v47
v_mfma_f32_16x16x32_bf16 v[236:239], a[140:143], a[28:31], v[236:239]
v_cvt_pk_bf16_f32 v46, v108, v109
v_cvt_pk_bf16_f32 v47, v110, v111
v_mfma_f32_16x16x32_bf16 v[240:243], a[136:139], a[32:35], v[240:243]
v_mul_f32 v52, s68, v52
v_mul_f32 v53, s68, v53
v_mfma_f32_16x16x32_bf16 v[240:243], a[140:143], a[36:39], v[240:243]
v_mul_f32 v54, s68, v54
v_mul_f32 v55, s68, v55
v_mfma_f32_16x16x32_bf16 v[244:247], a[136:139], a[40:43], v[244:247]
v_mul_f32 v116, s68, v116
v_mul_f32 v117, s68, v117
v_mfma_f32_16x16x32_bf16 v[244:247], a[140:143], a[44:47], v[244:247]
v_mul_f32 v118, s68, v118
v_mul_f32 v119, s68, v119
v_mfma_f32_16x16x32_bf16 v[248:251], a[136:139], a[48:51], v[248:251]
v_cvt_pk_bf16_f32 v52, v52, v53
v_cvt_pk_bf16_f32 v53, v54, v55
v_mfma_f32_16x16x32_bf16 v[248:251], a[140:143], a[52:55], v[248:251]
v_cvt_pk_bf16_f32 v54, v116, v117
v_cvt_pk_bf16_f32 v55, v118, v119
v_mfma_f32_16x16x32_bf16 v[252:255], a[136:139], a[56:59], v[252:255]
v_mfma_f32_16x16x32_bf16 v[252:255], a[140:143], a[60:63], v[252:255]
s_mov_b64 s[60:61], s[74:75]
s_mov_b32 s62, 896
s_lshl_b32 s79, s85, 1
buffer_load_short_d16_hi v19, off, s[60:63], s79
s_lshl_b32 s83, s85, 12
s_add_u32 s83, s83, 88080384
ds_write_b128 v28, v[36:39] offset:0
ds_write_b128 v28, v[44:47] offset:8192
ds_write_b128 v28, v[52:55] offset:16384
v_pk_mul_f32 v[60:61], v[60:61], s[68:69]
v_pk_mul_f32 v[62:63], v[62:63], s[68:69]
v_pk_mul_f32 v[124:125], v[124:125], s[68:69]
v_pk_mul_f32 v[126:127], v[126:127], s[68:69]
v_cvt_pk_bf16_f32 v60, v60, v61
v_cvt_pk_bf16_f32 v61, v62, v63
v_cvt_pk_bf16_f32 v62, v124, v125
v_cvt_pk_bf16_f32 v63, v126, v127
ds_write_b128 v28, v[60:63] offset:24576
v_pk_mul_f32 v[68:69], v[68:69], s[68:69]
v_pk_mul_f32 v[70:71], v[70:71], s[68:69]
v_pk_mul_f32 v[132:133], v[132:133], s[68:69]
v_pk_mul_f32 v[134:135], v[134:135], s[68:69]
v_cvt_pk_bf16_f32 v68, v68, v69
v_cvt_pk_bf16_f32 v69, v70, v71
v_cvt_pk_bf16_f32 v70, v132, v133
v_cvt_pk_bf16_f32 v71, v134, v135
ds_write_b128 v29, v[68:71] offset:0
v_pk_mul_f32 v[76:77], v[76:77], s[68:69]
v_pk_mul_f32 v[78:79], v[78:79], s[68:69]
v_pk_mul_f32 v[140:141], v[140:141], s[68:69]
v_pk_mul_f32 v[142:143], v[142:143], s[68:69]
v_cvt_pk_bf16_f32 v76, v76, v77
v_cvt_pk_bf16_f32 v77, v78, v79
v_cvt_pk_bf16_f32 v78, v140, v141
v_cvt_pk_bf16_f32 v79, v142, v143
ds_write_b128 v29, v[76:79] offset:8192
v_pk_mul_f32 v[84:85], v[84:85], s[68:69]
v_pk_mul_f32 v[86:87], v[86:87], s[68:69]
v_pk_mul_f32 v[148:149], v[148:149], s[68:69]
v_pk_mul_f32 v[150:151], v[150:151], s[68:69]
v_cvt_pk_bf16_f32 v84, v84, v85
v_cvt_pk_bf16_f32 v85, v86, v87
v_cvt_pk_bf16_f32 v86, v148, v149
v_cvt_pk_bf16_f32 v87, v150, v151
ds_write_b128 v29, v[84:87] offset:16384
v_pk_mul_f32 v[92:93], v[92:93], s[68:69]
v_pk_mul_f32 v[94:95], v[94:95], s[68:69]
v_pk_mul_f32 v[156:157], v[156:157], s[68:69]
v_pk_mul_f32 v[158:159], v[158:159], s[68:69]
v_cvt_pk_bf16_f32 v92, v92, v93
v_cvt_pk_bf16_f32 v93, v94, v95
v_cvt_pk_bf16_f32 v94, v156, v157
v_cvt_pk_bf16_f32 v95, v158, v159
ds_write_b128 v29, v[92:95] offset:24576
v_pk_mul_f32 v[164:165], v[164:165], s[68:69]
v_pk_mul_f32 v[166:167], v[166:167], s[68:69]
v_pk_mul_f32 v[224:225], v[224:225], s[68:69]
v_pk_mul_f32 v[226:227], v[226:227], s[68:69]
v_cvt_pk_bf16_f32 v164, v164, v165
v_cvt_pk_bf16_f32 v165, v166, v167
v_cvt_pk_bf16_f32 v166, v224, v225
v_cvt_pk_bf16_f32 v167, v226, v227
ds_write_b128 v28, v[164:167] offset:1024
v_pk_mul_f32 v[172:173], v[172:173], s[68:69]
v_pk_mul_f32 v[174:175], v[174:175], s[68:69]
v_pk_mul_f32 v[228:229], v[228:229], s[68:69]
v_pk_mul_f32 v[230:231], v[230:231], s[68:69]
v_cvt_pk_bf16_f32 v172, v172, v173
v_cvt_pk_bf16_f32 v173, v174, v175
v_cvt_pk_bf16_f32 v174, v228, v229
v_cvt_pk_bf16_f32 v175, v230, v231
ds_write_b128 v28, v[172:175] offset:9216
v_pk_mul_f32 v[180:181], v[180:181], s[68:69]
v_pk_mul_f32 v[182:183], v[182:183], s[68:69]
v_pk_mul_f32 v[232:233], v[232:233], s[68:69]
v_pk_mul_f32 v[234:235], v[234:235], s[68:69]
v_cvt_pk_bf16_f32 v180, v180, v181
v_cvt_pk_bf16_f32 v181, v182, v183
v_cvt_pk_bf16_f32 v182, v232, v233
v_cvt_pk_bf16_f32 v183, v234, v235
ds_write_b128 v28, v[180:183] offset:17408
v_pk_mul_f32 v[188:189], v[188:189], s[68:69]
v_pk_mul_f32 v[190:191], v[190:191], s[68:69]
v_pk_mul_f32 v[236:237], v[236:237], s[68:69]
v_pk_mul_f32 v[238:239], v[238:239], s[68:69]
v_cvt_pk_bf16_f32 v188, v188, v189
v_cvt_pk_bf16_f32 v189, v190, v191
v_cvt_pk_bf16_f32 v190, v236, v237
v_cvt_pk_bf16_f32 v191, v238, v239
ds_write_b128 v28, v[188:191] offset:25600
v_pk_mul_f32 v[196:197], v[196:197], s[68:69]
v_pk_mul_f32 v[198:199], v[198:199], s[68:69]
v_pk_mul_f32 v[240:241], v[240:241], s[68:69]
v_pk_mul_f32 v[242:243], v[242:243], s[68:69]
v_cvt_pk_bf16_f32 v196, v196, v197
v_cvt_pk_bf16_f32 v197, v198, v199
v_cvt_pk_bf16_f32 v198, v240, v241
v_cvt_pk_bf16_f32 v199, v242, v243
ds_write_b128 v29, v[196:199] offset:1024
v_pk_mul_f32 v[204:205], v[204:205], s[68:69]
v_pk_mul_f32 v[206:207], v[206:207], s[68:69]
v_pk_mul_f32 v[244:245], v[244:245], s[68:69]
v_pk_mul_f32 v[246:247], v[246:247], s[68:69]
v_cvt_pk_bf16_f32 v204, v204, v205
v_cvt_pk_bf16_f32 v205, v206, v207
v_cvt_pk_bf16_f32 v206, v244, v245
v_cvt_pk_bf16_f32 v207, v246, v247
ds_write_b128 v29, v[204:207] offset:9216
v_pk_mul_f32 v[212:213], v[212:213], s[68:69]
v_pk_mul_f32 v[214:215], v[214:215], s[68:69]
v_pk_mul_f32 v[248:249], v[248:249], s[68:69]
v_pk_mul_f32 v[250:251], v[250:251], s[68:69]
v_cvt_pk_bf16_f32 v212, v212, v213
v_cvt_pk_bf16_f32 v213, v214, v215
v_cvt_pk_bf16_f32 v214, v248, v249
v_cvt_pk_bf16_f32 v215, v250, v251
ds_write_b128 v29, v[212:215] offset:17408
v_pk_mul_f32 v[220:221], v[220:221], s[68:69]
v_pk_mul_f32 v[222:223], v[222:223], s[68:69]
v_pk_mul_f32 v[252:253], v[252:253], s[68:69]
v_pk_mul_f32 v[254:255], v[254:255], s[68:69]
v_cvt_pk_bf16_f32 v220, v220, v221
v_cvt_pk_bf16_f32 v221, v222, v223
v_cvt_pk_bf16_f32 v222, v252, v253
v_cvt_pk_bf16_f32 v223, v254, v255
ds_write_b128 v29, v[220:223] offset:25600
s_waitcnt vmcnt(1) lgkmcnt(0)
s_barrier
buffer_load_dword v21, v20, s[4:7], s31 offen sc1
ds_read_b64_tr_b16 a[64:65], v16 offset:8
ds_read_b64_tr_b16 a[66:67], v16 offset:0
ds_read_b128 a[96:99], v17 offset:448
ds_read_b64_tr_b16 a[68:69], v16 offset:520
ds_read_b64_tr_b16 a[70:71], v16 offset:512
ds_read_b128 a[100:103], v17 offset:960
ds_read_b64_tr_b16 a[72:73], v16 offset:1032
ds_read_b64_tr_b16 a[74:75], v16 offset:1024
ds_read_b128 a[104:107], v17 offset:1472
ds_read_b64_tr_b16 a[76:77], v16 offset:1544
ds_read_b64_tr_b16 a[78:79], v16 offset:1536
ds_read_b128 a[108:111], v17 offset:1984
ds_read_b64_tr_b16 a[80:81], v16 offset:2056
ds_read_b64_tr_b16 a[82:83], v16 offset:2048
ds_read_b128 a[112:115], v17 offset:2496
ds_read_b64_tr_b16 a[84:85], v16 offset:2568
ds_read_b64_tr_b16 a[86:87], v16 offset:2560
ds_read_b128 a[116:119], v17 offset:3008
ds_read_b64_tr_b16 a[88:89], v16 offset:3080
ds_read_b64_tr_b16 a[90:91], v16 offset:3072
ds_read_b128 a[120:123], v17 offset:3520
ds_read_b64_tr_b16 a[92:93], v16 offset:3592
ds_read_b64_tr_b16 a[94:95], v16 offset:3584
ds_read_b128 a[124:127], v17 offset:4032
s_waitcnt lgkmcnt(15)
v_mfma_f32_16x16x32_bf16 v[96:99], a[64:67], a[96:99], 0
s_waitcnt lgkmcnt(12)
s_lshl_b32 s18, s3, 13
ds_read_b64_tr_b16 a[128:129], v16 offset:72
v_mov_b32 v24, 0
v_mfma_f32_16x16x32_bf16 v[100:103], a[64:67], a[100:103], 0
s_lshl_b32 s30, s20, 20
ds_read_b64_tr_b16 a[130:131], v16 offset:64
v_lshrrev_b32 v3, 6, v0
v_mfma_f32_16x16x32_bf16 v[100:103], a[68:71], a[96:99], v[100:103]
s_add_u32 s30, s30, s18
ds_read_b128 a[160:163], v17 offset:384
v_and_b32 v4, 63, v0
v_mfma_f32_16x16x32_bf16 v[104:107], a[64:67], a[104:107], 0
s_lshl_b32 s22, s21, 1
ds_read_b128 a[192:195], v30 offset:0
v_add_u32 v2, 0x10000, v1
v_mfma_f32_16x16x32_bf16 v[104:107], a[68:71], a[100:103], v[104:107]
s_and_b32 s84, s2, 1
ds_read_b64_tr_b16 a[132:133], v16 offset:584
v_and_b32 v5, 15, v4
v_mfma_f32_16x16x32_bf16 v[104:107], a[72:75], a[96:99], v[104:107]
s_mul_i32 s84, s84, 0
ds_read_b64_tr_b16 a[134:135], v16 offset:576
v_lshrrev_b32 v6, 4, v4
v_mfma_f32_16x16x32_bf16 v[108:111], a[64:67], a[108:111], 0
s_add_u32 s84, s84, 2386092
ds_read_b128 a[164:167], v17 offset:896
v_lshlrev_b32 v6, 2, v6
v_mfma_f32_16x16x32_bf16 v[108:111], a[68:71], a[104:107], v[108:111]
s_lshl_b32 s85, s21, 2
ds_read_b128 a[196:199], v30 offset:1024
v_sub_u32 v5, v5, v6
v_mfma_f32_16x16x32_bf16 v[108:111], a[72:75], a[100:103], v[108:111]
s_lshr_b32 s85, s84, s85
ds_read_b64_tr_b16 a[136:137], v16 offset:1096
v_lshl_add_u32 v5, v3, 4, v5
v_mfma_f32_16x16x32_bf16 v[108:111], a[76:79], a[96:99], v[108:111]
s_waitcnt lgkmcnt(8)
s_and_b32 s9, s85, 15
ds_read_b64_tr_b16 a[138:139], v16 offset:1088
v_cmp_gt_i32 s[32:33], 0, v5
v_mfma_f32_16x16x32_bf16 v[112:115], a[64:67], a[112:115], 0
s_and_b32 s84, s85, 1
ds_read_b128 a[168:171], v17 offset:1408
v_cmp_gt_i32 s[34:35], 1, v5
v_mfma_f32_16x16x32_bf16 v[112:115], a[68:71], a[108:111], v[112:115]
s_lshl_b32 s84, s84, 17
ds_read_b128 a[200:203], v30 offset:2048
v_cmp_gt_i32 s[36:37], 2, v5
v_mfma_f32_16x16x32_bf16 v[112:115], a[72:75], a[104:107], v[112:115]
s_add_u32 s84, s84, s18
ds_read_b64_tr_b16 a[140:141], v16 offset:1608
v_cmp_gt_i32 s[38:39], 3, v5
v_mfma_f32_16x16x32_bf16 v[112:115], a[76:79], a[100:103], v[112:115]
s_xor_b32 s85, s84, 0x20000
ds_read_b64_tr_b16 a[142:143], v16 offset:1600
v_cmp_gt_i32 s[40:41], 16, v5
v_mfma_f32_16x16x32_bf16 v[112:115], a[80:83], a[96:99], v[112:115]
s_sub_u32 s29, 15, s21
ds_read_b128 a[172:175], v17 offset:1920
v_cmp_gt_i32 s[42:43], 17, v5
v_mfma_f32_16x16x32_bf16 v[116:119], a[64:67], a[116:119], 0
s_xor_b32 s8, s30, 2097152
ds_read_b128 a[204:207], v30 offset:3072
v_cmp_gt_i32 s[44:45], 18, v5
v_mfma_f32_16x16x32_bf16 v[116:119], a[68:71], a[112:115], v[116:119]
s_add_u32 s11, s22, 2
ds_read_b64_tr_b16 a[144:145], v16 offset:2120
v_cmp_gt_i32 s[46:47], 19, v5
v_mfma_f32_16x16x32_bf16 v[116:119], a[72:75], a[108:111], v[116:119]
s_add_u32 s14, s30, 16777216
ds_read_b64_tr_b16 a[146:147], v16 offset:2112
v_cmp_gt_i32 s[48:49], 32, v5
v_mfma_f32_16x16x32_bf16 v[116:119], a[76:79], a[104:107], v[116:119]
s_lshr_b32 s19, s9, 1
ds_read_b128 a[176:179], v17 offset:2432
v_cmp_gt_i32 s[50:51], 33, v5
v_mfma_f32_16x16x32_bf16 v[116:119], a[80:83], a[100:103], v[116:119]
s_cmp_lg_u32 s9, 0
ds_read_b128 a[208:211], v30 offset:4096
v_cmp_gt_i32 s[52:53], 34, v5
v_mfma_f32_16x16x32_bf16 v[116:119], a[84:87], a[96:99], v[116:119]
s_cselect_b32 s10, s30, 3221225472
ds_read_b64_tr_b16 a[148:149], v16 offset:2632
v_cmp_gt_i32 s[54:55], 35, v5
v_mfma_f32_16x16x32_bf16 v[120:123], a[64:67], a[120:123], 0
s_cselect_b32 s8, s8, s30
ds_read_b64_tr_b16 a[150:151], v16 offset:2624
v_cmp_gt_i32 s[56:57], 48, v5
v_mfma_f32_16x16x32_bf16 v[120:123], a[68:71], a[116:119], v[120:123]
s_cselect_b32 s14, s14, 3221225472
ds_read_b128 a[180:183], v17 offset:2944
v_cmp_gt_i32 s[58:59], 49, v5
v_mfma_f32_16x16x32_bf16 v[120:123], a[72:75], a[112:115], v[120:123]
s_cselect_b32 s9, s9, s11
ds_read_b128 a[212:215], v30 offset:5120
v_cmp_gt_i32 s[60:61], 50, v5
v_mfma_f32_16x16x32_bf16 v[120:123], a[76:79], a[108:111], v[120:123]
s_cselect_b32 s19, s19, s21
ds_read_b64_tr_b16 a[152:153], v16 offset:3144
v_cmp_gt_i32 s[62:63], 51, v5
v_mfma_f32_16x16x32_bf16 v[120:123], a[80:83], a[104:107], v[120:123]
s_cselect_b32 s29, s29, s21
ds_read_b64_tr_b16 a[154:155], v16 offset:3136
v_mov_b32 v7, 0xff800000
v_mfma_f32_16x16x32_bf16 v[120:123], a[84:87], a[100:103], v[120:123]
s_cselect_b32 s24, 2, 0
ds_read_b128 a[184:187], v17 offset:3456
v_mov_b32 v6, 1
v_mfma_f32_16x16x32_bf16 v[120:123], a[88:91], a[96:99], v[120:123]
s_add_u32 s12, s8, 16777216
ds_read_b128 a[216:219], v30 offset:6144
v_mov_b32 v5, v26
v_mfma_f32_16x16x32_bf16 v[124:127], a[64:67], a[124:127], 0
s_mov_b32 s13, s9
ds_read_b64_tr_b16 a[156:157], v16 offset:3656
v_add_u32 v4, 0x20000, v1
v_mfma_f32_16x16x32_bf16 v[124:127], a[68:71], a[120:123], v[124:127]
s_mov_b32 s15, s11
ds_read_b64_tr_b16 a[158:159], v16 offset:3648
v_mfma_f32_16x16x32_bf16 v[124:127], a[72:75], a[116:119], v[124:127]
s_mov_b32 s25, 1266679808
ds_read_b128 a[188:191], v17 offset:3968
v_mfma_f32_16x16x32_bf16 v[124:127], a[76:79], a[112:115], v[124:127]
s_lshl_b32 s22, s21, 3
ds_read_b128 a[220:223], v30 offset:7168
v_mfma_f32_16x16x32_bf16 v[124:127], a[80:83], a[108:111], v[124:127]
s_xor_b32 s28, s70, 0
ds_read_b128 a[224:227], v31 offset:0
v_mfma_f32_16x16x32_bf16 v[124:127], a[84:87], a[104:107], v[124:127]
s_add_u32 s28, s28, s22
ds_read_b128 a[228:231], v31 offset:1024
v_mfma_f32_16x16x32_bf16 v[124:127], a[88:91], a[100:103], v[124:127]
s_add_u32 s28, s28, 6148
ds_read_b128 a[232:235], v31 offset:2048
v_mfma_f32_16x16x32_bf16 v[124:127], a[92:95], a[96:99], v[124:127]
s_waitcnt lgkmcnt(8)
s_lshl_b32 s26, s21, 16
ds_read_b128 a[236:239], v31 offset:3072
v_mfma_f32_16x16x32_bf16 v[96:99], a[128:131], a[160:163], v[96:99]
s_add_u32 s26, s26, s30
ds_read_b64_tr_b16 a[64:65], v16 offset:136
v_mfma_f32_16x16x32_bf16 v[100:103], a[128:131], a[164:167], v[100:103]
s_add_u32 s26, s26, 33554432
ds_read_b64_tr_b16 a[66:67], v16 offset:128
v_mfma_f32_16x16x32_bf16 v[100:103], a[132:135], a[160:163], v[100:103]
s_xor_b32 s76, s20, 2
ds_read_b128 a[96:99], v17 offset:320
v_mfma_f32_16x16x32_bf16 v[104:107], a[128:131], a[168:171], v[104:107]
s_lshl_b32 s76, s76, 3
ds_read_b128 a[240:243], v31 offset:4096
v_mfma_f32_16x16x32_bf16 v[104:107], a[132:135], a[164:167], v[104:107]
s_add_u32 s76, s76, s21
ds_read_b64_tr_b16 a[68:69], v16 offset:648
v_mfma_f32_16x16x32_bf16 v[104:107], a[136:139], a[160:163], v[104:107]
s_lshl_b32 s76, s76, 2
ds_read_b64_tr_b16 a[70:71], v16 offset:640
v_mfma_f32_16x16x32_bf16 v[108:111], a[128:131], a[172:175], v[108:111]
s_add_u32 s76, s76, s3
ds_read_b128 a[100:103], v17 offset:832
v_mfma_f32_16x16x32_bf16 v[108:111], a[132:135], a[168:171], v[108:111]
s_lshl_b32 s27, s76, 10
ds_read_b128 a[244:247], v31 offset:5120
v_mfma_f32_16x16x32_bf16 v[108:111], a[136:139], a[164:167], v[108:111]
s_add_u32 s27, s27, 75497472
ds_read_b64_tr_b16 a[72:73], v16 offset:1160
v_mfma_f32_16x16x32_bf16 v[108:111], a[140:143], a[160:163], v[108:111]
s_lshl_b32 s76, s76, 14
ds_read_b64_tr_b16 a[74:75], v16 offset:1152
v_mfma_f32_16x16x32_bf16 v[112:115], a[128:131], a[176:179], v[112:115]
s_add_u32 s76, s76, 67108864
ds_read_b128 a[104:107], v17 offset:1344
v_mfma_f32_16x16x32_bf16 v[112:115], a[132:135], a[172:175], v[112:115]
s_lshl_b32 s81, s20, 2
ds_read_b128 a[248:251], v31 offset:6144
v_mfma_f32_16x16x32_bf16 v[112:115], a[136:139], a[168:171], v[112:115]
s_add_u32 s81, s81, s3
ds_read_b64_tr_b16 a[76:77], v16 offset:1672
v_mfma_f32_16x16x32_bf16 v[112:115], a[140:143], a[164:167], v[112:115]
s_mul_i32 s81, s81, 57344
ds_read_b64_tr_b16 a[78:79], v16 offset:1664
v_mfma_f32_16x16x32_bf16 v[112:115], a[144:147], a[160:163], v[112:115]
s_cmp_eq_u32 s24, 1
ds_read_b128 a[108:111], v17 offset:1856
v_mfma_f32_16x16x32_bf16 v[116:119], a[128:131], a[180:183], v[116:119]
s_cselect_b32 s80, s28, s70
ds_read_b128 a[252:255], v31 offset:7168
v_mfma_f32_16x16x32_bf16 v[116:119], a[132:135], a[176:179], v[116:119]
s_add_u32 s77, s76, 8192
ds_read_b64_tr_b16 a[80:81], v16 offset:2184
v_mfma_f32_16x16x32_bf16 v[116:119], a[136:139], a[172:175], v[116:119]
s_lshl_b32 s71, s2, 2
ds_read_b64_tr_b16 a[82:83], v16 offset:2176
v_mfma_f32_16x16x32_bf16 v[116:119], a[140:143], a[168:171], v[116:119]
s_add_u32 s71, s71, 94384128
ds_read_b128 a[112:115], v17 offset:2368
v_mfma_f32_16x16x32_bf16 v[116:119], a[144:147], a[164:167], v[116:119]
s_lshl_b32 s78, s29, 16
v_mfma_f32_16x16x32_bf16 v[116:119], a[148:151], a[160:163], v[116:119]
s_add_u32 s78, s78, s8
ds_read_b64_tr_b16 a[84:85], v16 offset:2696
v_mfma_f32_16x16x32_bf16 v[120:123], a[128:131], a[184:187], v[120:123]
s_add_u32 s78, s78, 33554432
ds_read_b64_tr_b16 a[86:87], v16 offset:2688
v_mfma_f32_16x16x32_bf16 v[120:123], a[132:135], a[180:183], v[120:123]
s_cmp_eq_u32 s24, 0
ds_read_b128 a[116:119], v17 offset:2880
v_mfma_f32_16x16x32_bf16 v[120:123], a[136:139], a[176:179], v[120:123]
s_cselect_b32 s78, 3221225472, s78
v_mfma_f32_16x16x32_bf16 v[120:123], a[140:143], a[172:175], v[120:123]
s_lshl_b32 s22, s21, 3
ds_read_b64_tr_b16 a[88:89], v16 offset:3208
v_mfma_f32_16x16x32_bf16 v[120:123], a[144:147], a[168:171], v[120:123]
s_add_u32 s22, s22, 16384
ds_read_b64_tr_b16 a[90:91], v16 offset:3200
v_mfma_f32_16x16x32_bf16 v[120:123], a[148:151], a[164:167], v[120:123]
s_andn2_b32 s23, 256, s70
ds_read_b128 a[120:123], v17 offset:3392
v_mfma_f32_16x16x32_bf16 v[120:123], a[152:155], a[160:163], v[120:123]
s_waitcnt lgkmcnt(6)
s_add_u32 s22, s22, s23
v_mfma_f32_16x16x32_bf16 v[124:127], a[128:131], a[188:191], v[124:127]
s_waitcnt vmcnt(0) lgkmcnt(9)
s_barrier
ds_read_b64_tr_b16 a[92:93], v16 offset:3720
v_writelane_b32 v15, s22, 63
v_cmp_gt_u32 vcc, 1, v21
v_mfma_f32_16x16x32_bf16 v[124:127], a[132:135], a[184:187], v[124:127]
PAD_30:
s_cbranch_execz M_tret
s_cbranch_vccnz M_kspin2
M_kok2:
ds_read_b64_tr_b16 a[94:95], v16 offset:3712
v_mov_b32 v25, 0
v_mfma_f32_16x16x32_bf16 v[124:127], a[136:139], a[180:183], v[124:127]
s_mov_b32 m0, s84
ds_read_b128 a[124:127], v17 offset:3904
v_mov_b32 v128, 0
v_mfma_f32_16x16x32_bf16 v[124:127], a[140:143], a[176:179], v[124:127]
buffer_load_dwordx4 v1, s[4:7], s8 offen offset:0 sc1 lds
v_mfma_f32_16x16x32_bf16 v[124:127], a[144:147], a[172:175], v[124:127]
buffer_load_dwordx4 v1, s[4:7], s8 offen offset:1024 sc1 lds
v_mfma_f32_16x16x32_bf16 v[124:127], a[148:151], a[168:171], v[124:127]
buffer_load_dwordx4 v1, s[4:7], s8 offen offset:2048 sc1 lds
v_mfma_f32_16x16x32_bf16 v[124:127], a[152:155], a[164:167], v[124:127]
buffer_load_dwordx4 v1, s[4:7], s8 offen offset:3072 sc1 lds
v_mfma_f32_16x16x32_bf16 v[124:127], a[156:159], a[160:163], v[124:127]
s_add_u32 s8, s8, 4096
v_mov_b32 v129, 0
v_mov_b32 v130, 0
v_mfma_f32_16x16x32_bf16 v[96:99], a[64:67], a[96:99], v[96:99]
s_add_u32 m0, s84, 4096
ds_read_b64_tr_b16 a[128:129], v16 offset:200
v_mov_b32 v131, 0
v_mfma_f32_16x16x32_bf16 v[100:103], a[64:67], a[100:103], v[100:103]
ds_read_b64_tr_b16 a[130:131], v16 offset:192
v_mov_b32 v132, 0
v_mfma_f32_16x16x32_bf16 v[100:103], a[68:71], a[96:99], v[100:103]
ds_read_b128 a[160:163], v17 offset:256
v_mov_b32 v133, 0
v_mfma_f32_16x16x32_bf16 v[104:107], a[64:67], a[104:107], v[104:107]
buffer_load_dwordx4 v1, s[4:7], s8 offen offset:0 sc1 lds
v_mfma_f32_16x16x32_bf16 v[104:107], a[68:71], a[100:103], v[104:107]
ds_read_b64_tr_b16 a[132:133], v16 offset:712
v_mov_b32 v134, 0
v_mfma_f32_16x16x32_bf16 v[104:107], a[72:75], a[96:99], v[104:107]
ds_read_b64_tr_b16 a[134:135], v16 offset:704
v_mov_b32 v135, 0
v_mfma_f32_16x16x32_bf16 v[108:111], a[64:67], a[108:111], v[108:111]
ds_read_b128 a[164:167], v17 offset:768
v_mov_b32 v136, 0
v_mfma_f32_16x16x32_bf16 v[108:111], a[68:71], a[104:107], v[108:111]
buffer_load_dwordx4 v1, s[4:7], s8 offen offset:1024 sc1 lds
v_mfma_f32_16x16x32_bf16 v[108:111], a[72:75], a[100:103], v[108:111]
ds_read_b64_tr_b16 a[136:137], v16 offset:1224
v_mov_b32 v137, 0
v_mfma_f32_16x16x32_bf16 v[108:111], a[76:79], a[96:99], v[108:111]
ds_read_b64_tr_b16 a[138:139], v16 offset:1216
v_mov_b32 v138, 0
v_mfma_f32_16x16x32_bf16 v[112:115], a[64:67], a[112:115], v[112:115]
ds_read_b128 a[168:171], v17 offset:1280
v_mov_b32 v139, 0
v_mfma_f32_16x16x32_bf16 v[112:115], a[68:71], a[108:111], v[112:115]
buffer_load_dwordx4 v1, s[4:7], s8 offen offset:2048 sc1 lds
v_mfma_f32_16x16x32_bf16 v[112:115], a[72:75], a[104:107], v[112:115]
ds_read_b64_tr_b16 a[140:141], v16 offset:1736
v_mov_b32 v140, 0
v_mfma_f32_16x16x32_bf16 v[112:115], a[76:79], a[100:103], v[112:115]
ds_read_b64_tr_b16 a[142:143], v16 offset:1728
v_mov_b32 v141, 0
v_mfma_f32_16x16x32_bf16 v[112:115], a[80:83], a[96:99], v[112:115]
s_waitcnt lgkmcnt(6)
ds_read_b128 a[172:175], v17 offset:1792
v_mov_b32 v142, 0
v_mfma_f32_16x16x32_bf16 v[116:119], a[64:67], a[116:119], v[116:119]
buffer_load_dwordx4 v1, s[4:7], s8 offen offset:3072 sc1 lds
v_mfma_f32_16x16x32_bf16 v[116:119], a[68:71], a[112:115], v[116:119]
s_add_u32 s8, s8, 28672
ds_read_b64_tr_b16 a[144:145], v16 offset:2248
v_mov_b32 v143, 0
v_mfma_f32_16x16x32_bf16 v[116:119], a[72:75], a[108:111], v[116:119]
s_sub_u32 s9, s9, 1
ds_read_b64_tr_b16 a[146:147], v16 offset:2240
v_mov_b32 v144, 0
v_mfma_f32_16x16x32_bf16 v[116:119], a[76:79], a[104:107], v[116:119]
s_cmp_eq_u32 s9, 0
ds_read_b128 a[176:179], v17 offset:2304
v_mov_b32 v145, 0
v_mfma_f32_16x16x32_bf16 v[116:119], a[80:83], a[100:103], v[116:119]
s_cselect_b32 s8, s10, s8
v_mov_b32 v146, 0
v_mov_b32 v147, 0
v_mfma_f32_16x16x32_bf16 v[116:119], a[84:87], a[96:99], v[116:119]
s_cselect_b32 s9, s11, s9
ds_read_b64_tr_b16 a[148:149], v16 offset:2760
v_mov_b32 v148, 0
v_mfma_f32_16x16x32_bf16 v[120:123], a[64:67], a[120:123], v[120:123]
s_cselect_b32 s10, 3221225472, s10
ds_read_b64_tr_b16 a[150:151], v16 offset:2752
v_mov_b32 v149, 0
v_mfma_f32_16x16x32_bf16 v[120:123], a[68:71], a[116:119], v[120:123]
s_mov_b32 m0, s85
ds_read_b128 a[180:183], v17 offset:2816
v_mov_b32 v150, 0
v_mfma_f32_16x16x32_bf16 v[120:123], a[72:75], a[112:115], v[120:123]
buffer_load_dwordx4 v1, s[4:7], s8 offen offset:0 sc1 lds
v_mfma_f32_16x16x32_bf16 v[120:123], a[76:79], a[108:111], v[120:123]
ds_read_b64_tr_b16 a[152:153], v16 offset:3272
v_mov_b32 v151, 0
v_mfma_f32_16x16x32_bf16 v[120:123], a[80:83], a[104:107], v[120:123]
ds_read_b64_tr_b16 a[154:155], v16 offset:3264
v_mov_b32 v152, 0
v_mfma_f32_16x16x32_bf16 v[120:123], a[84:87], a[100:103], v[120:123]
ds_read_b128 a[184:187], v17 offset:3328
v_mov_b32 v153, 0
v_mfma_f32_16x16x32_bf16 v[120:123], a[88:91], a[96:99], v[120:123]
buffer_load_dwordx4 v1, s[4:7], s8 offen offset:1024 sc1 lds
v_mfma_f32_16x16x32_bf16 v[124:127], a[64:67], a[124:127], v[124:127]
ds_read_b64_tr_b16 a[156:157], v16 offset:3784
v_mov_b32 v154, 0
v_mfma_f32_16x16x32_bf16 v[124:127], a[68:71], a[120:123], v[124:127]
ds_read_b64_tr_b16 a[158:159], v16 offset:3776
v_mov_b32 v155, 0
v_mfma_f32_16x16x32_bf16 v[124:127], a[72:75], a[116:119], v[124:127]
ds_read_b128 a[188:191], v17 offset:3840
v_mov_b32 v156, 0
v_mfma_f32_16x16x32_bf16 v[124:127], a[76:79], a[112:115], v[124:127]
buffer_load_dwordx4 v1, s[4:7], s8 offen offset:2048 sc1 lds
v_mfma_f32_16x16x32_bf16 v[124:127], a[80:83], a[108:111], v[124:127]
buffer_load_dwordx4 v1, s[4:7], s8 offen offset:3072 sc1 lds
v_mfma_f32_16x16x32_bf16 v[124:127], a[84:87], a[104:107], v[124:127]
s_add_u32 s8, s8, 4096
v_mov_b32 v157, 0
v_mov_b32 v158, 0
v_mfma_f32_16x16x32_bf16 v[124:127], a[88:91], a[100:103], v[124:127]
s_add_u32 m0, s85, 4096
v_mov_b32 v159, 0
v_mov_b32 v160, 0
v_mfma_f32_16x16x32_bf16 v[124:127], a[92:95], a[96:99], v[124:127]
buffer_load_dwordx4 v1, s[4:7], s8 offen offset:0 sc1 lds
v_mfma_f32_16x16x32_bf16 v[96:99], a[128:131], a[160:163], v[96:99]
s_waitcnt lgkmcnt(3)
ds_read_b64_tr_b16 a[64:65], v16 offset:264
v_mov_b32 v161, 0
v_mfma_f32_16x16x32_bf16 v[100:103], a[128:131], a[164:167], v[100:103]
ds_read_b64_tr_b16 a[66:67], v16 offset:256
v_mov_b32 v162, 0
v_mfma_f32_16x16x32_bf16 v[100:103], a[132:135], a[160:163], v[100:103]
ds_read_b128 a[96:99], v17 offset:192
v_mov_b32 v163, 0
v_mfma_f32_16x16x32_bf16 v[104:107], a[128:131], a[168:171], v[104:107]
buffer_load_dwordx4 v1, s[4:7], s8 offen offset:1024 sc1 lds
v_mfma_f32_16x16x32_bf16 v[104:107], a[132:135], a[164:167], v[104:107]
ds_read_b64_tr_b16 a[68:69], v16 offset:776
v_mov_b32 v164, 0
v_mfma_f32_16x16x32_bf16 v[104:107], a[136:139], a[160:163], v[104:107]
ds_read_b64_tr_b16 a[70:71], v16 offset:768
v_mov_b32 v165, 0
v_mfma_f32_16x16x32_bf16 v[108:111], a[128:131], a[172:175], v[108:111]
ds_read_b128 a[100:103], v17 offset:704
v_mov_b32 v166, 0
v_mfma_f32_16x16x32_bf16 v[108:111], a[132:135], a[168:171], v[108:111]
buffer_load_dwordx4 v1, s[4:7], s8 offen offset:2048 sc1 lds
v_mfma_f32_16x16x32_bf16 v[108:111], a[136:139], a[164:167], v[108:111]
ds_read_b64_tr_b16 a[72:73], v16 offset:1288
v_mov_b32 v167, 0
v_mfma_f32_16x16x32_bf16 v[108:111], a[140:143], a[160:163], v[108:111]
ds_read_b64_tr_b16 a[74:75], v16 offset:1280
v_mov_b32 v168, 0
v_mfma_f32_16x16x32_bf16 v[112:115], a[128:131], a[176:179], v[112:115]
ds_read_b128 a[104:107], v17 offset:1216
v_mov_b32 v169, 0
v_mfma_f32_16x16x32_bf16 v[112:115], a[132:135], a[172:175], v[112:115]
buffer_load_dwordx4 v1, s[4:7], s8 offen offset:3072 sc1 lds
v_mfma_f32_16x16x32_bf16 v[112:115], a[136:139], a[168:171], v[112:115]
s_add_u32 s8, s8, 28672
ds_read_b64_tr_b16 a[76:77], v16 offset:1800
v_mov_b32 v170, 0
v_mfma_f32_16x16x32_bf16 v[112:115], a[140:143], a[164:167], v[112:115]
s_sub_u32 s9, s9, 1
ds_read_b64_tr_b16 a[78:79], v16 offset:1792
v_mov_b32 v171, 0
v_mfma_f32_16x16x32_bf16 v[112:115], a[144:147], a[160:163], v[112:115]
s_cmp_eq_u32 s9, 0
ds_read_b128 a[108:111], v17 offset:1728
v_mov_b32 v172, 0
v_mfma_f32_16x16x32_bf16 v[116:119], a[128:131], a[180:183], v[116:119]
s_cselect_b32 s8, s10, s8
buffer_load_dword v14, v15, s[4:7], s31 offen sc1
v_mfma_f32_16x16x32_bf16 v[116:119], a[132:135], a[176:179], v[116:119]
s_cselect_b32 s9, s11, s9
ds_read_b64_tr_b16 a[80:81], v16 offset:2312
v_mov_b32 v173, 0
v_mfma_f32_16x16x32_bf16 v[116:119], a[136:139], a[172:175], v[116:119]
s_cselect_b32 s10, 3221225472, s10
ds_read_b64_tr_b16 a[82:83], v16 offset:2304
v_mov_b32 v174, 0
v_mfma_f32_16x16x32_bf16 v[116:119], a[140:143], a[168:171], v[116:119]
ds_read_b128 a[112:115], v17 offset:2240
v_mov_b32 v175, 0
v_mfma_f32_16x16x32_bf16 v[116:119], a[144:147], a[164:167], v[116:119]
v_mov_b32 v176, 0
v_mov_b32 v177, 0
v_mfma_f32_16x16x32_bf16 v[116:119], a[148:151], a[160:163], v[116:119]
ds_read_b64_tr_b16 a[84:85], v16 offset:2824
v_mov_b32 v178, 0
v_mfma_f32_16x16x32_bf16 v[120:123], a[128:131], a[184:187], v[120:123]
ds_read_b64_tr_b16 a[86:87], v16 offset:2816
v_mov_b32 v179, 0
v_mfma_f32_16x16x32_bf16 v[120:123], a[132:135], a[180:183], v[120:123]
ds_read_b128 a[116:119], v17 offset:2752
v_mov_b32 v180, 0
v_mfma_f32_16x16x32_bf16 v[120:123], a[136:139], a[176:179], v[120:123]
v_mov_b32 v181, 0
v_mov_b32 v182, 0
v_mfma_f32_16x16x32_bf16 v[120:123], a[140:143], a[172:175], v[120:123]
ds_read_b64_tr_b16 a[88:89], v16 offset:3336
v_mov_b32 v183, 0
v_mfma_f32_16x16x32_bf16 v[120:123], a[144:147], a[168:171], v[120:123]
ds_read_b64_tr_b16 a[90:91], v16 offset:3328
v_mov_b32 v184, 0
v_mfma_f32_16x16x32_bf16 v[120:123], a[148:151], a[164:167], v[120:123]
ds_read_b128 a[120:123], v17 offset:3264
v_mov_b32 v185, 0
v_mfma_f32_16x16x32_bf16 v[120:123], a[152:155], a[160:163], v[120:123]
s_waitcnt lgkmcnt(6)
v_mov_b32 v186, 0
v_mov_b32 v187, 0
v_mfma_f32_16x16x32_bf16 v[124:127], a[128:131], a[188:191], v[124:127]
ds_read_b64_tr_b16 a[92:93], v16 offset:3848
v_mov_b32 v188, 0
v_mfma_f32_16x16x32_bf16 v[124:127], a[132:135], a[184:187], v[124:127]
ds_read_b64_tr_b16 a[94:95], v16 offset:3840
v_mov_b32 v189, 0
v_mfma_f32_16x16x32_bf16 v[124:127], a[136:139], a[180:183], v[124:127]
ds_read_b128 a[124:127], v17 offset:3776
v_mov_b32 v190, 0
v_mfma_f32_16x16x32_bf16 v[124:127], a[140:143], a[176:179], v[124:127]
v_mov_b32 v191, 0
v_mov_b32 v192, 0
v_mfma_f32_16x16x32_bf16 v[124:127], a[144:147], a[172:175], v[124:127]
v_mov_b32 v193, 0
v_mov_b32 v194, 0
v_mfma_f32_16x16x32_bf16 v[124:127], a[148:151], a[168:171], v[124:127]
v_mov_b32 v195, 0
v_mov_b32 v196, 0
v_mfma_f32_16x16x32_bf16 v[124:127], a[152:155], a[164:167], v[124:127]
v_mov_b32 v197, 0
v_mov_b32 v198, 0
v_mfma_f32_16x16x32_bf16 v[124:127], a[156:159], a[160:163], v[124:127]
v_mov_b32 v199, 0
v_mov_b32 v200, 0
s_waitcnt vmcnt(0)
v_cmp_gt_u32 vcc, 1, v14
s_cbranch_vccnz M_cspin
M_cok:
v_mfma_f32_16x16x32_bf16 v[96:99], a[64:67], a[96:99], v[96:99]
s_add_u32 s22, s78, 0
ds_read_b64_tr_b16 a[128:129], v16 offset:328
v_mov_b32 v201, 0
v_mfma_f32_16x16x32_bf16 v[100:103], a[64:67], a[100:103], v[100:103]
ds_read_b64_tr_b16 a[130:131], v16 offset:320
v_mov_b32 v202, 0
v_mfma_f32_16x16x32_bf16 v[100:103], a[68:71], a[96:99], v[100:103]
ds_read_b128 a[160:163], v17 offset:128
v_mov_b32 v203, 0
v_mfma_f32_16x16x32_bf16 v[104:107], a[64:67], a[104:107], v[104:107]
buffer_load_dwordx4 a[0:3], v1, s[4:7], s22 offen offset:0 sc1
v_mfma_f32_16x16x32_bf16 v[104:107], a[68:71], a[100:103], v[104:107]
ds_read_b64_tr_b16 a[132:133], v16 offset:840
v_mov_b32 v204, 0
v_mfma_f32_16x16x32_bf16 v[104:107], a[72:75], a[96:99], v[104:107]
ds_read_b64_tr_b16 a[134:135], v16 offset:832
v_mov_b32 v205, 0
v_mfma_f32_16x16x32_bf16 v[108:111], a[64:67], a[108:111], v[108:111]
ds_read_b128 a[164:167], v17 offset:640
v_mov_b32 v206, 0
v_mfma_f32_16x16x32_bf16 v[108:111], a[68:71], a[104:107], v[108:111]
buffer_load_dwordx4 a[4:7], v1, s[4:7], s22 offen offset:1024 sc1
v_mfma_f32_16x16x32_bf16 v[108:111], a[72:75], a[100:103], v[108:111]
ds_read_b64_tr_b16 a[136:137], v16 offset:1352
v_mov_b32 v207, 0
v_mfma_f32_16x16x32_bf16 v[108:111], a[76:79], a[96:99], v[108:111]
ds_read_b64_tr_b16 a[138:139], v16 offset:1344
v_mov_b32 v208, 0
v_mfma_f32_16x16x32_bf16 v[112:115], a[64:67], a[112:115], v[112:115]
ds_read_b128 a[168:171], v17 offset:1152
v_mov_b32 v209, 0
v_mfma_f32_16x16x32_bf16 v[112:115], a[68:71], a[108:111], v[112:115]
buffer_load_dwordx4 a[8:11], v1, s[4:7], s22 offen offset:2048 sc1
v_mfma_f32_16x16x32_bf16 v[112:115], a[72:75], a[104:107], v[112:115]
ds_read_b64_tr_b16 a[140:141], v16 offset:1864
v_mov_b32 v210, 0
v_mfma_f32_16x16x32_bf16 v[112:115], a[76:79], a[100:103], v[112:115]
ds_read_b64_tr_b16 a[142:143], v16 offset:1856
v_mov_b32 v211, 0
v_mfma_f32_16x16x32_bf16 v[112:115], a[80:83], a[96:99], v[112:115]
s_waitcnt lgkmcnt(6)
ds_read_b128 a[172:175], v17 offset:1664
v_mov_b32 v212, 0
v_mfma_f32_16x16x32_bf16 v[116:119], a[64:67], a[116:119], v[116:119]
buffer_load_dwordx4 a[12:15], v1, s[4:7], s22 offen offset:3072 sc1
v_mfma_f32_16x16x32_bf16 v[116:119], a[68:71], a[112:115], v[116:119]
s_add_u32 s22, s78, 4096
ds_read_b64_tr_b16 a[144:145], v16 offset:2376
v_mov_b32 v213, 0
v_mfma_f32_16x16x32_bf16 v[116:119], a[72:75], a[108:111], v[116:119]
ds_read_b64_tr_b16 a[146:147], v16 offset:2368
v_mov_b32 v214, 0
v_mfma_f32_16x16x32_bf16 v[116:119], a[76:79], a[104:107], v[116:119]
ds_read_b128 a[176:179], v17 offset:2176
v_mov_b32 v215, 0
v_mfma_f32_16x16x32_bf16 v[116:119], a[80:83], a[100:103], v[116:119]
buffer_load_dwordx4 a[16:19], v1, s[4:7], s22 offen offset:0 sc1
v_mfma_f32_16x16x32_bf16 v[116:119], a[84:87], a[96:99], v[116:119]
ds_read_b64_tr_b16 a[148:149], v16 offset:2888
v_mov_b32 v216, 0
v_mfma_f32_16x16x32_bf16 v[120:123], a[64:67], a[120:123], v[120:123]
ds_read_b64_tr_b16 a[150:151], v16 offset:2880
v_mov_b32 v217, 0
v_mfma_f32_16x16x32_bf16 v[120:123], a[68:71], a[116:119], v[120:123]
ds_read_b128 a[180:183], v17 offset:2688
v_mov_b32 v218, 0
v_mfma_f32_16x16x32_bf16 v[120:123], a[72:75], a[112:115], v[120:123]
buffer_load_dwordx4 a[20:23], v1, s[4:7], s22 offen offset:1024 sc1
v_mfma_f32_16x16x32_bf16 v[120:123], a[76:79], a[108:111], v[120:123]
ds_read_b64_tr_b16 a[152:153], v16 offset:3400
v_mov_b32 v219, 0
v_mfma_f32_16x16x32_bf16 v[120:123], a[80:83], a[104:107], v[120:123]
ds_read_b64_tr_b16 a[154:155], v16 offset:3392
v_mov_b32 v220, 0
v_mfma_f32_16x16x32_bf16 v[120:123], a[84:87], a[100:103], v[120:123]
ds_read_b128 a[184:187], v17 offset:3200
v_mov_b32 v221, 0
v_mfma_f32_16x16x32_bf16 v[120:123], a[88:91], a[96:99], v[120:123]
buffer_load_dwordx4 a[24:27], v1, s[4:7], s22 offen offset:2048 sc1
v_mfma_f32_16x16x32_bf16 v[124:127], a[64:67], a[124:127], v[124:127]
ds_read_b64_tr_b16 a[156:157], v16 offset:3912
v_mov_b32 v222, 0
v_mfma_f32_16x16x32_bf16 v[124:127], a[68:71], a[120:123], v[124:127]
ds_read_b64_tr_b16 a[158:159], v16 offset:3904
v_mov_b32 v223, 0
v_mfma_f32_16x16x32_bf16 v[124:127], a[72:75], a[116:119], v[124:127]
ds_read_b128 a[188:191], v17 offset:3712
v_mov_b32 v224, 0
v_mfma_f32_16x16x32_bf16 v[124:127], a[76:79], a[112:115], v[124:127]
buffer_load_dwordx4 a[28:31], v1, s[4:7], s22 offen offset:3072 sc1
v_mfma_f32_16x16x32_bf16 v[124:127], a[80:83], a[108:111], v[124:127]
s_add_u32 s22, s78, 32768
buffer_load_dwordx4 a[32:35], v1, s[4:7], s22 offen offset:0 sc1
v_mfma_f32_16x16x32_bf16 v[124:127], a[84:87], a[104:107], v[124:127]
buffer_load_dwordx4 a[36:39], v1, s[4:7], s22 offen offset:1024 sc1
v_mfma_f32_16x16x32_bf16 v[124:127], a[88:91], a[100:103], v[124:127]
buffer_load_dwordx4 a[40:43], v1, s[4:7], s22 offen offset:2048 sc1
v_mfma_f32_16x16x32_bf16 v[124:127], a[92:95], a[96:99], v[124:127]
s_waitcnt lgkmcnt(3)
buffer_load_dwordx4 a[44:47], v1, s[4:7], s22 offen offset:3072 sc1
v_mfma_f32_16x16x32_bf16 v[96:99], a[128:131], a[160:163], v[96:99]
s_add_u32 s22, s78, 36864
ds_read_b64_tr_b16 a[64:65], v16 offset:392
v_mov_b32 v225, 0
v_mfma_f32_16x16x32_bf16 v[100:103], a[128:131], a[164:167], v[100:103]
ds_read_b64_tr_b16 a[66:67], v16 offset:384
v_mov_b32 v226, 0
v_mfma_f32_16x16x32_bf16 v[100:103], a[132:135], a[160:163], v[100:103]
ds_read_b128 a[96:99], v17 offset:64
v_mov_b32 v227, 0
v_mfma_f32_16x16x32_bf16 v[104:107], a[128:131], a[168:171], v[104:107]
ds_read_b64 v[36:37], v18 offset:0
v_mov_b32 v228, 0
v_mfma_f32_16x16x32_bf16 v[104:107], a[132:135], a[164:167], v[104:107]
ds_read_b64_tr_b16 a[68:69], v16 offset:904
v_mov_b32 v229, 0
v_mfma_f32_16x16x32_bf16 v[104:107], a[136:139], a[160:163], v[104:107]
ds_read_b64_tr_b16 a[70:71], v16 offset:896
v_mov_b32 v230, 0
v_mfma_f32_16x16x32_bf16 v[108:111], a[128:131], a[172:175], v[108:111]
ds_read_b128 a[100:103], v17 offset:576
v_mov_b32 v231, 0
v_mfma_f32_16x16x32_bf16 v[108:111], a[132:135], a[168:171], v[108:111]
ds_read_b64 v[38:39], v18 offset:512
v_mov_b32 v232, 0
v_mfma_f32_16x16x32_bf16 v[108:111], a[136:139], a[164:167], v[108:111]
ds_read_b64_tr_b16 a[72:73], v16 offset:1416
v_mov_b32 v233, 0
v_mfma_f32_16x16x32_bf16 v[108:111], a[140:143], a[160:163], v[108:111]
ds_read_b64_tr_b16 a[74:75], v16 offset:1408
v_mov_b32 v234, 0
v_mfma_f32_16x16x32_bf16 v[112:115], a[128:131], a[176:179], v[112:115]
ds_read_b128 a[104:107], v17 offset:1088
v_mov_b32 v235, 0
v_mfma_f32_16x16x32_bf16 v[112:115], a[132:135], a[172:175], v[112:115]
ds_read_b64 v[44:45], v18 offset:1024
v_mov_b32 v236, 0
v_mfma_f32_16x16x32_bf16 v[112:115], a[136:139], a[168:171], v[112:115]
ds_read_b64_tr_b16 a[76:77], v16 offset:1928
v_mov_b32 v237, 0
v_mfma_f32_16x16x32_bf16 v[112:115], a[140:143], a[164:167], v[112:115]
ds_read_b64_tr_b16 a[78:79], v16 offset:1920
v_mov_b32 v238, 0
v_mfma_f32_16x16x32_bf16 v[112:115], a[144:147], a[160:163], v[112:115]
ds_read_b128 a[108:111], v17 offset:1600
v_mov_b32 v239, 0
v_mfma_f32_16x16x32_bf16 v[116:119], a[128:131], a[180:183], v[116:119]
ds_read_b64 v[46:47], v18 offset:1536
v_mov_b32 v240, 0
v_mfma_f32_16x16x32_bf16 v[116:119], a[132:135], a[176:179], v[116:119]
ds_read_b64_tr_b16 a[80:81], v16 offset:2440
v_mov_b32 v241, 0
v_mfma_f32_16x16x32_bf16 v[116:119], a[136:139], a[172:175], v[116:119]
ds_read_b64_tr_b16 a[82:83], v16 offset:2432
v_mov_b32 v242, 0
v_mfma_f32_16x16x32_bf16 v[116:119], a[140:143], a[168:171], v[116:119]
ds_read_b128 a[112:115], v17 offset:2112
v_mov_b32 v243, 0
v_mfma_f32_16x16x32_bf16 v[116:119], a[144:147], a[164:167], v[116:119]
ds_read_b64 v[52:53], v18 offset:2048
v_mov_b32 v244, 0
v_mfma_f32_16x16x32_bf16 v[116:119], a[148:151], a[160:163], v[116:119]
ds_read_b64_tr_b16 a[84:85], v16 offset:2952
v_mov_b32 v245, 0
v_mfma_f32_16x16x32_bf16 v[120:123], a[128:131], a[184:187], v[120:123]
ds_read_b64_tr_b16 a[86:87], v16 offset:2944
v_mov_b32 v246, 0
v_mfma_f32_16x16x32_bf16 v[120:123], a[132:135], a[180:183], v[120:123]
ds_read_b128 a[116:119], v17 offset:2624
v_mov_b32 v247, 0
v_mfma_f32_16x16x32_bf16 v[120:123], a[136:139], a[176:179], v[120:123]
ds_read_b64 v[54:55], v18 offset:2560
v_mov_b32 v248, 0
v_mfma_f32_16x16x32_bf16 v[120:123], a[140:143], a[172:175], v[120:123]
ds_read_b64_tr_b16 a[88:89], v16 offset:3464
v_mov_b32 v249, 0
v_mfma_f32_16x16x32_bf16 v[120:123], a[144:147], a[168:171], v[120:123]
ds_read_b64_tr_b16 a[90:91], v16 offset:3456
v_mov_b32 v250, 0
v_mfma_f32_16x16x32_bf16 v[120:123], a[148:151], a[164:167], v[120:123]
ds_read_b128 a[120:123], v17 offset:3136
v_mov_b32 v251, 0
v_mfma_f32_16x16x32_bf16 v[120:123], a[152:155], a[160:163], v[120:123]
s_waitcnt lgkmcnt(8)
ds_read_b64 v[60:61], v18 offset:3072
v_mov_b32 v252, 0
v_mfma_f32_16x16x32_bf16 v[124:127], a[128:131], a[188:191], v[124:127]
ds_read_b64_tr_b16 a[92:93], v16 offset:3976
v_mov_b32 v253, 0
v_mfma_f32_16x16x32_bf16 v[124:127], a[132:135], a[184:187], v[124:127]
ds_read_b64_tr_b16 a[94:95], v16 offset:3968
v_mov_b32 v254, 0
v_mfma_f32_16x16x32_bf16 v[124:127], a[136:139], a[180:183], v[124:127]
ds_read_b128 a[124:127], v17 offset:3648
v_mov_b32 v255, 0
v_mfma_f32_16x16x32_bf16 v[124:127], a[140:143], a[176:179], v[124:127]
ds_read_b64 v[62:63], v18 offset:3584
v_mfma_f32_16x16x32_bf16 v[124:127], a[144:147], a[172:175], v[124:127]
buffer_load_dwordx4 a[48:51], v1, s[4:7], s22 offen offset:0 sc1
v_mfma_f32_16x16x32_bf16 v[124:127], a[148:151], a[168:171], v[124:127]
buffer_load_dwordx4 a[52:55], v1, s[4:7], s22 offen offset:1024 sc1
v_mfma_f32_16x16x32_bf16 v[124:127], a[152:155], a[164:167], v[124:127]
buffer_load_dwordx4 a[56:59], v1, s[4:7], s22 offen offset:2048 sc1
v_mfma_f32_16x16x32_bf16 v[124:127], a[156:159], a[160:163], v[124:127]
buffer_load_dwordx4 a[60:63], v1, s[4:7], s22 offen offset:3072 sc1
v_mfma_f32_16x16x32_bf16 v[96:99], a[64:67], a[96:99], v[96:99]
ds_read_b64_tr_b16 a[128:129], v16 offset:456
v_mfma_f32_16x16x32_bf16 v[100:103], a[64:67], a[100:103], v[100:103]
ds_read_b64_tr_b16 a[130:131], v16 offset:448
v_mfma_f32_16x16x32_bf16 v[100:103], a[68:71], a[96:99], v[100:103]
ds_read_b128 a[160:163], v17 offset:0
v_mfma_f32_16x16x32_bf16 v[104:107], a[64:67], a[104:107], v[104:107]
v_mfma_f32_16x16x32_bf16 v[104:107], a[68:71], a[100:103], v[104:107]
ds_read_b64_tr_b16 a[132:133], v16 offset:968
v_mfma_f32_16x16x32_bf16 v[104:107], a[72:75], a[96:99], v[104:107]
ds_read_b64_tr_b16 a[134:135], v16 offset:960
v_mfma_f32_16x16x32_bf16 v[108:111], a[64:67], a[108:111], v[108:111]
ds_read_b128 a[164:167], v17 offset:512
v_mfma_f32_16x16x32_bf16 v[108:111], a[68:71], a[104:107], v[108:111]
v_mfma_f32_16x16x32_bf16 v[108:111], a[72:75], a[100:103], v[108:111]
ds_read_b64_tr_b16 a[136:137], v16 offset:1480
v_mfma_f32_16x16x32_bf16 v[108:111], a[76:79], a[96:99], v[108:111]
ds_read_b64_tr_b16 a[138:139], v16 offset:1472
v_mfma_f32_16x16x32_bf16 v[112:115], a[64:67], a[112:115], v[112:115]
ds_read_b128 a[168:171], v17 offset:1024
v_mfma_f32_16x16x32_bf16 v[112:115], a[68:71], a[108:111], v[112:115]
v_mfma_f32_16x16x32_bf16 v[112:115], a[72:75], a[104:107], v[112:115]
ds_read_b64_tr_b16 a[140:141], v16 offset:1992
v_mfma_f32_16x16x32_bf16 v[112:115], a[76:79], a[100:103], v[112:115]
ds_read_b64_tr_b16 a[142:143], v16 offset:1984
v_mfma_f32_16x16x32_bf16 v[112:115], a[80:83], a[96:99], v[112:115]
s_waitcnt lgkmcnt(6)
ds_read_b128 a[172:175], v17 offset:1536
v_mfma_f32_16x16x32_bf16 v[116:119], a[64:67], a[116:119], v[116:119]
v_mfma_f32_16x16x32_bf16 v[116:119], a[68:71], a[112:115], v[116:119]
ds_read_b64_tr_b16 a[144:145], v16 offset:2504
v_mfma_f32_16x16x32_bf16 v[116:119], a[72:75], a[108:111], v[116:119]
ds_read_b64_tr_b16 a[146:147], v16 offset:2496
v_mfma_f32_16x16x32_bf16 v[116:119], a[76:79], a[104:107], v[116:119]
ds_read_b128 a[176:179], v17 offset:2048
v_mfma_f32_16x16x32_bf16 v[116:119], a[80:83], a[100:103], v[116:119]
v_mfma_f32_16x16x32_bf16 v[116:119], a[84:87], a[96:99], v[116:119]
ds_read_b64_tr_b16 a[148:149], v16 offset:3016
v_mfma_f32_16x16x32_bf16 v[120:123], a[64:67], a[120:123], v[120:123]
ds_read_b64_tr_b16 a[150:151], v16 offset:3008
v_mfma_f32_16x16x32_bf16 v[120:123], a[68:71], a[116:119], v[120:123]
ds_read_b128 a[180:183], v17 offset:2560
v_mfma_f32_16x16x32_bf16 v[120:123], a[72:75], a[112:115], v[120:123]
v_mfma_f32_16x16x32_bf16 v[120:123], a[76:79], a[108:111], v[120:123]
ds_read_b64_tr_b16 a[152:153], v16 offset:3528
v_mfma_f32_16x16x32_bf16 v[120:123], a[80:83], a[104:107], v[120:123]
ds_read_b64_tr_b16 a[154:155], v16 offset:3520
v_mfma_f32_16x16x32_bf16 v[120:123], a[84:87], a[100:103], v[120:123]
ds_read_b128 a[184:187], v17 offset:3072
v_mfma_f32_16x16x32_bf16 v[120:123], a[88:91], a[96:99], v[120:123]
v_mfma_f32_16x16x32_bf16 v[124:127], a[64:67], a[124:127], v[124:127]
ds_read_b64_tr_b16 a[156:157], v16 offset:4040
v_mfma_f32_16x16x32_bf16 v[124:127], a[68:71], a[120:123], v[124:127]
ds_read_b64_tr_b16 a[158:159], v16 offset:4032
v_mfma_f32_16x16x32_bf16 v[124:127], a[72:75], a[116:119], v[124:127]
ds_read_b128 a[188:191], v17 offset:3584
v_mfma_f32_16x16x32_bf16 v[124:127], a[76:79], a[112:115], v[124:127]
v_mfma_f32_16x16x32_bf16 v[124:127], a[80:83], a[108:111], v[124:127]
v_mfma_f32_16x16x32_bf16 v[124:127], a[84:87], a[104:107], v[124:127]
v_mfma_f32_16x16x32_bf16 v[124:127], a[88:91], a[100:103], v[124:127]
v_mfma_f32_16x16x32_bf16 v[124:127], a[92:95], a[96:99], v[124:127]
v_mfma_f32_16x16x32_bf16 v[96:99], a[128:131], a[160:163], v[96:99]
s_waitcnt lgkmcnt(3)
v_mfma_f32_16x16x32_bf16 v[100:103], a[128:131], a[164:167], v[100:103]
v_mfma_f32_16x16x32_bf16 v[100:103], a[132:135], a[160:163], v[100:103]
v_mfma_f32_16x16x32_bf16 v[104:107], a[128:131], a[168:171], v[104:107]
v_mfma_f32_16x16x32_bf16 v[104:107], a[132:135], a[164:167], v[104:107]
v_mfma_f32_16x16x32_bf16 v[104:107], a[136:139], a[160:163], v[104:107]
v_mfma_f32_16x16x32_bf16 v[108:111], a[128:131], a[172:175], v[108:111]
v_mfma_f32_16x16x32_bf16 v[108:111], a[132:135], a[168:171], v[108:111]
v_mfma_f32_16x16x32_bf16 v[108:111], a[136:139], a[164:167], v[108:111]
v_lshlrev_b32 v10, 16, v36
v_fmac_f32 v96, v19, v10
v_mfma_f32_16x16x32_bf16 v[108:111], a[140:143], a[160:163], v[108:111]
v_and_b32 v11, 0xffff0000, v36
v_fmac_f32 v97, v19, v11
v_mfma_f32_16x16x32_bf16 v[112:115], a[128:131], a[176:179], v[112:115]
v_lshlrev_b32 v12, 16, v37
v_fmac_f32 v98, v19, v12
v_mfma_f32_16x16x32_bf16 v[112:115], a[132:135], a[172:175], v[112:115]
v_and_b32 v13, 0xffff0000, v37
v_fmac_f32 v99, v19, v13
v_mfma_f32_16x16x32_bf16 v[112:115], a[136:139], a[168:171], v[112:115]
v_cvt_pk_bf16_f32 v96, v96, v97
v_cvt_pk_bf16_f32 v97, v98, v99
v_mfma_f32_16x16x32_bf16 v[112:115], a[140:143], a[164:167], v[112:115]
buffer_store_dwordx2 v[96:97], v8, s[4:7], s83 offen offset:0 sc1
v_mfma_f32_16x16x32_bf16 v[112:115], a[144:147], a[160:163], v[112:115]
v_lshlrev_b32 v10, 16, v38
v_fmac_f32 v100, v19, v10
v_mfma_f32_16x16x32_bf16 v[116:119], a[128:131], a[180:183], v[116:119]
v_and_b32 v11, 0xffff0000, v38
v_fmac_f32 v101, v19, v11
v_mfma_f32_16x16x32_bf16 v[116:119], a[132:135], a[176:179], v[116:119]
v_lshlrev_b32 v12, 16, v39
v_fmac_f32 v102, v19, v12
v_mfma_f32_16x16x32_bf16 v[116:119], a[136:139], a[172:175], v[116:119]
v_and_b32 v13, 0xffff0000, v39
v_fmac_f32 v103, v19, v13
v_mfma_f32_16x16x32_bf16 v[116:119], a[140:143], a[168:171], v[116:119]
v_cvt_pk_bf16_f32 v100, v100, v101
v_cvt_pk_bf16_f32 v101, v102, v103
v_mfma_f32_16x16x32_bf16 v[116:119], a[144:147], a[164:167], v[116:119]
buffer_store_dwordx2 v[100:101], v8, s[4:7], s83 offen offset:512 sc1
v_mfma_f32_16x16x32_bf16 v[116:119], a[148:151], a[160:163], v[116:119]
v_lshlrev_b32 v10, 16, v44
v_fmac_f32 v104, v19, v10
v_mfma_f32_16x16x32_bf16 v[120:123], a[128:131], a[184:187], v[120:123]
v_and_b32 v11, 0xffff0000, v44
v_fmac_f32 v105, v19, v11
v_mfma_f32_16x16x32_bf16 v[120:123], a[132:135], a[180:183], v[120:123]
v_lshlrev_b32 v12, 16, v45
v_fmac_f32 v106, v19, v12
v_mfma_f32_16x16x32_bf16 v[120:123], a[136:139], a[176:179], v[120:123]
v_and_b32 v13, 0xffff0000, v45
v_fmac_f32 v107, v19, v13
v_mfma_f32_16x16x32_bf16 v[120:123], a[140:143], a[172:175], v[120:123]
v_cvt_pk_bf16_f32 v104, v104, v105
v_cvt_pk_bf16_f32 v105, v106, v107
v_mfma_f32_16x16x32_bf16 v[120:123], a[144:147], a[168:171], v[120:123]
buffer_store_dwordx2 v[104:105], v8, s[4:7], s83 offen offset:1024 sc1
v_mfma_f32_16x16x32_bf16 v[120:123], a[148:151], a[164:167], v[120:123]
v_lshlrev_b32 v10, 16, v46
v_fmac_f32 v108, v19, v10
v_mfma_f32_16x16x32_bf16 v[120:123], a[152:155], a[160:163], v[120:123]
s_waitcnt lgkmcnt(0)
v_and_b32 v11, 0xffff0000, v46
v_fmac_f32 v109, v19, v11
v_mfma_f32_16x16x32_bf16 v[124:127], a[128:131], a[188:191], v[124:127]
v_lshlrev_b32 v12, 16, v47
v_fmac_f32 v110, v19, v12
v_mfma_f32_16x16x32_bf16 v[124:127], a[132:135], a[184:187], v[124:127]
v_and_b32 v13, 0xffff0000, v47
v_fmac_f32 v111, v19, v13
v_mfma_f32_16x16x32_bf16 v[124:127], a[136:139], a[180:183], v[124:127]
v_cvt_pk_bf16_f32 v108, v108, v109
v_cvt_pk_bf16_f32 v109, v110, v111
v_mfma_f32_16x16x32_bf16 v[124:127], a[140:143], a[176:179], v[124:127]
buffer_store_dwordx2 v[108:109], v8, s[4:7], s83 offen offset:1536 sc1
v_mfma_f32_16x16x32_bf16 v[124:127], a[144:147], a[172:175], v[124:127]
v_lshlrev_b32 v10, 16, v52
v_fmac_f32 v112, v19, v10
v_mfma_f32_16x16x32_bf16 v[124:127], a[148:151], a[168:171], v[124:127]
v_and_b32 v11, 0xffff0000, v52
v_fmac_f32 v113, v19, v11
v_mfma_f32_16x16x32_bf16 v[124:127], a[152:155], a[164:167], v[124:127]
v_lshlrev_b32 v12, 16, v53
v_fmac_f32 v114, v19, v12
v_mfma_f32_16x16x32_bf16 v[124:127], a[156:159], a[160:163], v[124:127]
PAD_31:
s_cbranch_execz M_tret
v_and_b32 v13, 0xffff0000, v53
v_fmac_f32 v115, v19, v13
v_cvt_pk_bf16_f32 v112, v112, v113
v_cvt_pk_bf16_f32 v113, v114, v115
buffer_store_dwordx2 v[112:113], v8, s[4:7], s83 offen offset:2048 sc1
v_lshlrev_b32 v10, 16, v54
v_fmac_f32 v116, v19, v10
v_and_b32 v11, 0xffff0000, v54
v_fmac_f32 v117, v19, v11
v_lshlrev_b32 v12, 16, v55
v_fmac_f32 v118, v19, v12
v_and_b32 v13, 0xffff0000, v55
v_fmac_f32 v119, v19, v13
v_cvt_pk_bf16_f32 v116, v116, v117
v_cvt_pk_bf16_f32 v117, v118, v119
buffer_store_dwordx2 v[116:117], v8, s[4:7], s83 offen offset:2560 sc1
v_lshlrev_b32 v10, 16, v60
v_fmac_f32 v120, v19, v10
v_and_b32 v11, 0xffff0000, v60
v_fmac_f32 v121, v19, v11
v_lshlrev_b32 v12, 16, v61
v_fmac_f32 v122, v19, v12
v_and_b32 v13, 0xffff0000, v61
v_fmac_f32 v123, v19, v13
v_cvt_pk_bf16_f32 v120, v120, v121
v_cvt_pk_bf16_f32 v121, v122, v123
buffer_store_dwordx2 v[120:121], v8, s[4:7], s83 offen offset:3072 sc1
v_lshlrev_b32 v10, 16, v62
v_fmac_f32 v124, v19, v10
v_and_b32 v11, 0xffff0000, v62
v_fmac_f32 v125, v19, v11
v_lshlrev_b32 v12, 16, v63
v_fmac_f32 v126, v19, v12
v_and_b32 v13, 0xffff0000, v63
v_fmac_f32 v127, v19, v13
v_cvt_pk_bf16_f32 v124, v124, v125
v_cvt_pk_bf16_f32 v125, v126, v127
buffer_store_dwordx2 v[124:125], v8, s[4:7], s83 offen offset:3584 sc1
v_lshrrev_b32 v8, 7, v1
v_and_b32 v9, 6, v8
v_lshlrev_b32 v9, 4, v9
v_and_b32 v10, 0x70, v1
v_xor_b32 v9, v9, v10
v_mul_u32_u24 v8, 896, v8
v_add_u32 v8, v8, v9
v_accvgpr_write_b32 a184, v8
v_add_u32 v8, 6144, v8
v_accvgpr_write_b32 a185, v8
v_add_u32 v8, 6144, v8
v_accvgpr_write_b32 a186, v8
v_add_u32 v8, 6144, v8
v_accvgpr_write_b32 a187, v8
v_lshrrev_b32 v8, 6, v1
v_bfe_u32 v9, v1, 7, 2
v_lshlrev_b32 v9, 5, v9
v_lshl_add_u32 v8, v8, 7, v9
v_bfe_u32 v9, v1, 4, 2
v_lshl_add_u32 v8, v9, 3, v8
v_add_u32 v8, 32768, v8
v_accvgpr_write_b32 a188, v8
v_xor_b32 v9, 32, v8
v_accvgpr_write_b32 a189, v9
v_xor_b32 v9, 64, v8
v_accvgpr_write_b32 a190, v9
v_xor_b32 v9, 96, v8
v_accvgpr_write_b32 a191, v9
s_branch M_t2B
M_t2Br:
s_waitcnt vmcnt(8)
s_barrier
s_cmp_lg_u32 s24, 0
s_cbranch_scc1 K2_item
v_accvgpr_mov_b32 a0, a192
v_accvgpr_mov_b32 a1, a193
v_accvgpr_mov_b32 a2, a194
v_accvgpr_mov_b32 a3, a195
v_accvgpr_mov_b32 a4, a196
v_accvgpr_mov_b32 a5, a197
v_accvgpr_mov_b32 a6, a198
v_accvgpr_mov_b32 a7, a199
v_accvgpr_mov_b32 a8, a200
v_accvgpr_mov_b32 a9, a201
v_accvgpr_mov_b32 a10, a202
v_accvgpr_mov_b32 a11, a203
v_accvgpr_mov_b32 a12, a204
v_accvgpr_mov_b32 a13, a205
v_accvgpr_mov_b32 a14, a206
v_accvgpr_mov_b32 a15, a207
v_accvgpr_mov_b32 a16, a208
v_accvgpr_mov_b32 a17, a209
v_accvgpr_mov_b32 a18, a210
v_accvgpr_mov_b32 a19, a211
v_accvgpr_mov_b32 a20, a212
v_accvgpr_mov_b32 a21, a213
v_accvgpr_mov_b32 a22, a214
v_accvgpr_mov_b32 a23, a215
v_accvgpr_mov_b32 a24, a216
v_accvgpr_mov_b32 a25, a217
v_accvgpr_mov_b32 a26, a218
v_accvgpr_mov_b32 a27, a219
v_accvgpr_mov_b32 a28, a220
v_accvgpr_mov_b32 a29, a221
v_accvgpr_mov_b32 a30, a222
v_accvgpr_mov_b32 a31, a223
v_accvgpr_mov_b32 a32, a224
v_accvgpr_mov_b32 a33, a225
v_accvgpr_mov_b32 a34, a226
v_accvgpr_mov_b32 a35, a227
v_accvgpr_mov_b32 a36, a228
v_accvgpr_mov_b32 a37, a229
v_accvgpr_mov_b32 a38, a230
v_accvgpr_mov_b32 a39, a231
v_accvgpr_mov_b32 a40, a232
v_accvgpr_mov_b32 a41, a233
v_accvgpr_mov_b32 a42, a234
v_accvgpr_mov_b32 a43, a235
v_accvgpr_mov_b32 a44, a236
v_accvgpr_mov_b32 a45, a237
v_accvgpr_mov_b32 a46, a238
v_accvgpr_mov_b32 a47, a239
v_accvgpr_mov_b32 a48, a240
v_accvgpr_mov_b32 a49, a241
v_accvgpr_mov_b32 a50, a242
v_accvgpr_mov_b32 a51, a243
v_accvgpr_mov_b32 a52, a244
v_accvgpr_mov_b32 a53, a245
v_accvgpr_mov_b32 a54, a246
v_accvgpr_mov_b32 a55, a247
v_accvgpr_mov_b32 a56, a248
v_accvgpr_mov_b32 a57, a249
v_accvgpr_mov_b32 a58, a250
v_accvgpr_mov_b32 a59, a251
v_accvgpr_mov_b32 a60, a252
v_accvgpr_mov_b32 a61, a253
v_accvgpr_mov_b32 a62, a254
v_accvgpr_mov_b32 a63, a255
s_branch K2_item
M_cend:
M_cspin:
Lp_16:
buffer_load_dword v14, v15, s[4:7], s31 offen sc1
s_waitcnt vmcnt(0)
v_cmp_gt_u32 vcc, 1, v14
s_cbranch_vccz Lpd_17
s_sleep 8
s_sub_u32 s101, s101, 1
s_cbranch_scc0 Lp_16
s_mov_b32 s101, 0
Lpd_17:
s_branch M_cok
M_kspin:
Lp_18:
buffer_load_dword v21, v20, s[4:7], s70 offen sc1
s_waitcnt vmcnt(0)
v_cmp_gt_u32 vcc, 1, v21
s_cbranch_vccz Lpd_19
s_sleep 8
s_sub_u32 s101, s101, 1
s_cbranch_scc0 Lp_18
s_mov_b32 s101, 0
Lpd_19:
s_branch M_kok
M_kspin2:
Lp_20:
buffer_load_dword v21, v20, s[4:7], s31 offen sc1
s_waitcnt vmcnt(0)
v_cmp_gt_u32 vcc, 1, v21
s_cbranch_vccz Lpd_21
s_sleep 8
s_sub_u32 s101, s101, 1
s_cbranch_scc0 Lp_20
s_mov_b32 s101, 0
Lpd_21:
s_branch M_kok2
M_vspin:
Lp_22:
buffer_load_dword v21, v15, s[4:7], s70 offen sc1
s_waitcnt vmcnt(0)
v_cmp_gt_u32 vcc, 1, v21
s_cbranch_vccz Lpd_23
s_sleep 8
s_sub_u32 s101, s101, 1
s_cbranch_scc0 Lp_22
s_mov_b32 s101, 0
Lpd_23:
s_branch M_vok
PAD_32:
s_cbranch_execz M_tret
K2_plain:
v_mfma_f32_16x16x32_bf16 v[128:131], a[64:67], v[96:99], v[128:131]
s_waitcnt lgkmcnt(6)
ds_read_b128 a[96:99], v2 offset:8192
v_add_f32 v24, v24, v26
v_mfma_f32_16x16x32_bf16 v[128:131], a[68:71], v[100:103], v[128:131]
s_waitcnt lgkmcnt(5)
v_mfma_f32_16x16x32_bf16 v[132:135], a[68:71], v[108:111], v[132:135]
s_mov_b64 s[36:37], s[86:87]
ds_read_b128 a[100:103], v2 offset:9216
v_add_f32 v25, v25, v27
v_mfma_f32_16x16x32_bf16 v[132:135], a[64:67], v[104:107], v[132:135]
s_mov_b32 s38, 3670016
v_exp_f32 v8, v68
v_mfma_f32_16x16x32_bf16 v[136:139], a[72:75], v[96:99], v[136:139]
s_mov_b32 s39, 0x20000
ds_read_b128 a[104:107], v2 offset:10240
v_accvgpr_read_b32 v112, a184
v_mfma_f32_16x16x32_bf16 v[136:139], a[76:79], v[100:103], v[136:139]
v_accvgpr_read_b32 v113, a185
v_accvgpr_read_b32 v114, a186
v_mfma_f32_16x16x32_bf16 v[140:143], a[76:79], v[108:111], v[140:143]
ds_read_b128 a[108:111], v2 offset:11264
v_accvgpr_read_b32 v115, a187
v_mfma_f32_16x16x32_bf16 v[140:143], a[72:75], v[104:107], v[140:143]
s_waitcnt lgkmcnt(5)
v_accvgpr_read_b32 v116, a188
v_accvgpr_read_b32 v117, a189
v_mfma_f32_16x16x32_bf16 v[144:147], a[80:83], v[96:99], v[144:147]
ds_read_b128 a[112:115], v2 offset:12288
v_accvgpr_read_b32 v118, a190
v_mfma_f32_16x16x32_bf16 v[144:147], a[84:87], v[100:103], v[144:147]
v_accvgpr_read_b32 v119, a191
v_mfma_f32_16x16x32_bf16 v[148:151], a[84:87], v[108:111], v[148:151]
s_add_u32 m0, s18, 32768
ds_read_b128 a[116:119], v2 offset:13312
v_cvt_pk_bf16_f32 v128, v128, v129
v_mfma_f32_16x16x32_bf16 v[148:151], a[80:83], v[104:107], v[148:151]
buffer_load_dwordx4 v112, s[36:39], s81 offen offset:0 lds
v_mfma_f32_16x16x32_bf16 v[152:155], a[88:91], v[96:99], v[152:155]
s_waitcnt lgkmcnt(4)
ds_read_b128 a[120:123], v2 offset:14336
v_cvt_pk_bf16_f32 v129, v130, v131
v_mfma_f32_16x16x32_bf16 v[152:155], a[92:95], v[100:103], v[152:155]
v_exp_f32 v9, v69
v_mfma_f32_16x16x32_bf16 v[156:159], a[92:95], v[108:111], v[156:159]
ds_read_b128 a[124:127], v2 offset:15360
v_add_f32 v27, v8, v9
v_mfma_f32_16x16x32_bf16 v[156:159], a[88:91], v[104:107], v[156:159]
buffer_load_dwordx4 v113, s[36:39], s81 offen offset:1024 lds
v_mfma_f32_16x16x32_bf16 v[160:163], a[96:99], v[96:99], v[160:163]
ds_read_b128 a[64:67], v2 offset:16384
v_cvt_pk_bf16_f32 v120, v8, v9
v_mfma_f32_16x16x32_bf16 v[160:163], a[100:103], v[100:103], v[160:163]
v_exp_f32 v10, v70
v_mfma_f32_16x16x32_bf16 v[164:167], a[100:103], v[108:111], v[164:167]
ds_read_b128 a[68:71], v2 offset:17408
v_add_f32 v27, v27, v10
v_mfma_f32_16x16x32_bf16 v[164:167], a[96:99], v[104:107], v[164:167]
s_waitcnt lgkmcnt(4)
buffer_load_dwordx4 v114, s[36:39], s81 offen offset:2048 lds
v_mfma_f32_16x16x32_bf16 v[168:171], a[104:107], v[96:99], v[168:171]
ds_read_b128 a[72:75], v2 offset:18432
v_cvt_pk_bf16_f32 v130, v136, v137
v_mfma_f32_16x16x32_bf16 v[168:171], a[108:111], v[100:103], v[168:171]
v_exp_f32 v11, v71
v_mfma_f32_16x16x32_bf16 v[172:175], a[108:111], v[108:111], v[172:175]
ds_read_b128 a[76:79], v2 offset:19456
v_add_f32 v27, v27, v11
v_mfma_f32_16x16x32_bf16 v[172:175], a[104:107], v[104:107], v[172:175]
buffer_load_dwordx4 v115, s[36:39], s81 offen offset:3072 lds
v_mfma_f32_16x16x32_bf16 v[176:179], a[112:115], v[96:99], v[176:179]
ds_read_b128 a[80:83], v2 offset:20480
v_cvt_pk_bf16_f32 v121, v10, v11
v_mfma_f32_16x16x32_bf16 v[176:179], a[116:119], v[100:103], v[176:179]
s_waitcnt lgkmcnt(4)
v_exp_f32 v12, v76
v_mfma_f32_16x16x32_bf16 v[180:183], a[116:119], v[108:111], v[180:183]
s_add_u32 s81, s81, 28672
ds_read_b128 a[84:87], v2 offset:21504
v_add_f32 v27, v27, v12
v_mfma_f32_16x16x32_bf16 v[180:183], a[112:115], v[104:107], v[180:183]
s_add_u32 m0, s18, 36864
v_exp_f32 v13, v77
v_mfma_f32_16x16x32_bf16 v[184:187], a[120:123], v[96:99], v[184:187]
ds_read_b128 a[88:91], v2 offset:22528
v_add_f32 v27, v27, v13
v_mfma_f32_16x16x32_bf16 v[184:187], a[124:127], v[100:103], v[184:187]
buffer_load_dwordx4 v112, s[36:39], s81 offen offset:0 lds
v_mfma_f32_16x16x32_bf16 v[188:191], a[124:127], v[108:111], v[188:191]
ds_read_b128 a[92:95], v2 offset:23552
v_cvt_pk_bf16_f32 v122, v12, v13
v_mfma_f32_16x16x32_bf16 v[188:191], a[120:123], v[104:107], v[188:191]
v_exp_f32 v14, v78
v_mfma_f32_16x16x32_bf16 v[192:195], a[64:67], v[96:99], v[192:195]
s_waitcnt lgkmcnt(4)
ds_read_b128 a[96:99], v2 offset:24576
v_add_f32 v27, v27, v14
v_mfma_f32_16x16x32_bf16 v[192:195], a[68:71], v[100:103], v[192:195]
buffer_load_dwordx4 v113, s[36:39], s81 offen offset:1024 lds
v_mfma_f32_16x16x32_bf16 v[196:199], a[68:71], v[108:111], v[196:199]
ds_read_b128 a[100:103], v2 offset:25600
v_cvt_pk_bf16_f32 v131, v138, v139
v_mfma_f32_16x16x32_bf16 v[196:199], a[64:67], v[104:107], v[196:199]
v_exp_f32 v15, v79
v_mfma_f32_16x16x32_bf16 v[200:203], a[72:75], v[96:99], v[200:203]
ds_read_b128 a[104:107], v2 offset:26624
v_add_f32 v27, v27, v15
v_mfma_f32_16x16x32_bf16 v[200:203], a[76:79], v[100:103], v[200:203]
buffer_load_dwordx4 v114, s[36:39], s81 offen offset:2048 lds
v_mfma_f32_16x16x32_bf16 v[204:207], a[76:79], v[108:111], v[204:207]
ds_read_b128 a[108:111], v2 offset:27648
v_cvt_pk_bf16_f32 v123, v14, v15
v_mfma_f32_16x16x32_bf16 v[204:207], a[72:75], v[104:107], v[204:207]
s_waitcnt lgkmcnt(4)
v_exp_f32 v8, v84
v_mfma_f32_16x16x32_bf16 v[208:211], a[80:83], v[96:99], v[208:211]
ds_read_b128 a[112:115], v2 offset:28672
v_add_f32 v27, v27, v8
v_mfma_f32_16x16x32_bf16 v[208:211], a[84:87], v[100:103], v[208:211]
buffer_load_dwordx4 v115, s[36:39], s81 offen offset:3072 lds
v_mfma_f32_16x16x32_bf16 v[212:215], a[84:87], v[108:111], v[212:215]
ds_read_b128 a[116:119], v2 offset:29696
v_cvt_pk_bf16_f32 v144, v144, v145
v_mfma_f32_16x16x32_bf16 v[212:215], a[80:83], v[104:107], v[212:215]
v_exp_f32 v9, v85
v_mfma_f32_16x16x32_bf16 v[216:219], a[88:91], v[96:99], v[216:219]
s_sub_u32 s81, s81, 28544
ds_read_b128 a[120:123], v2 offset:30720
v_add_f32 v27, v27, v9
v_mfma_f32_16x16x32_bf16 v[216:219], a[92:95], v[100:103], v[216:219]
v_exp_f32 v10, v86
v_mfma_f32_16x16x32_bf16 v[220:223], a[92:95], v[108:111], v[220:223]
s_waitcnt vmcnt(8) lgkmcnt(4)
ds_read_b128 a[124:127], v2 offset:31744
v_cvt_pk_bf16_f32 v124, v8, v9
v_mfma_f32_16x16x32_bf16 v[220:223], a[88:91], v[104:107], v[220:223]
s_barrier
v_mfma_f32_16x16x32_bf16 v[224:227], a[96:99], v[96:99], v[224:227]
ds_read_b128 a[64:67], v1 offset:0
v_add_f32 v27, v27, v10
v_mfma_f32_16x16x32_bf16 v[224:227], a[100:103], v[100:103], v[224:227]
v_exp_f32 v11, v87
v_mfma_f32_16x16x32_bf16 v[228:231], a[100:103], v[108:111], v[228:231]
ds_read_b128 a[68:71], v1 offset:1024
v_add_f32 v27, v27, v11
v_mfma_f32_16x16x32_bf16 v[228:231], a[96:99], v[104:107], v[228:231]
v_exp_f32 v12, v92
v_mfma_f32_16x16x32_bf16 v[232:235], a[104:107], v[96:99], v[232:235]
s_waitcnt lgkmcnt(4)
ds_read_b128 a[72:75], v1 offset:2048
v_cvt_pk_bf16_f32 v125, v10, v11
v_mfma_f32_16x16x32_bf16 v[232:235], a[108:111], v[100:103], v[232:235]
v_exp_f32 v13, v93
v_mfma_f32_16x16x32_bf16 v[236:239], a[108:111], v[108:111], v[236:239]
ds_read_b128 a[76:79], v1 offset:3072
v_add_f32 v27, v27, v12
v_mfma_f32_16x16x32_bf16 v[236:239], a[104:107], v[104:107], v[236:239]
v_exp_f32 v14, v94
v_mfma_f32_16x16x32_bf16 v[240:243], a[112:115], v[96:99], v[240:243]
ds_read_b128 a[80:83], v1 offset:4096
v_add_f32 v27, v27, v13
v_mfma_f32_16x16x32_bf16 v[240:243], a[116:119], v[100:103], v[240:243]
v_exp_f32 v15, v95
v_mfma_f32_16x16x32_bf16 v[244:247], a[116:119], v[108:111], v[244:247]
ds_read_b128 a[84:87], v1 offset:5120
v_cvt_pk_bf16_f32 v126, v12, v13
v_mfma_f32_16x16x32_bf16 v[244:247], a[112:115], v[104:107], v[244:247]
s_waitcnt lgkmcnt(4)
v_add_f32 v27, v27, v14
v_add_f32 v27, v27, v15
v_mfma_f32_16x16x32_bf16 v[248:251], a[120:123], v[96:99], v[248:251]
ds_read_b128 a[88:91], v1 offset:6144
v_cvt_pk_bf16_f32 v127, v14, v15
v_mfma_f32_16x16x32_bf16 v[248:251], a[124:127], v[100:103], v[248:251]
v_cmp_nge_f32 vcc, s25, v27
v_cvt_pk_bf16_f32 v145, v146, v147
v_mfma_f32_16x16x32_bf16 v[252:255], a[124:127], v[108:111], v[252:255]
ds_read_b128 a[92:95], v1 offset:7168
v_cvt_pk_bf16_f32 v146, v152, v153
v_mfma_f32_16x16x32_bf16 v[252:255], a[120:123], v[104:107], v[252:255]
s_waitcnt lgkmcnt(2)
v_cvt_pk_bf16_f32 v147, v154, v155
v_cvt_pk_bf16_f32 v160, v160, v161
s_cbranch_vccnz Lstub_12
Lback_13:
v_mfma_f32_16x16x32_bf16 v[132:135], a[64:67], v[120:123], v[132:135]
s_lshl_b32 s8, s29, 3
ds_read_b128 a[96:99], v1 offset:8192
v_add_f32 v25, v25, v27
v_mfma_f32_16x16x32_bf16 v[132:135], a[68:71], v[124:127], v[132:135]
s_add_u32 s8, s8, s3
ds_read_b128 a[100:103], v1 offset:9216
v_cvt_pk_bf16_f32 v161, v162, v163
v_mfma_f32_16x16x32_bf16 v[140:143], a[72:75], v[120:123], v[140:143]
s_lshl_b32 s8, s8, 4
ds_read_b128 a[104:107], v1 offset:10240
v_cvt_pk_bf16_f32 v162, v168, v169
v_mfma_f32_16x16x32_bf16 v[140:143], a[76:79], v[124:127], v[140:143]
s_add_u32 s8, s8, s20
ds_read_b128 a[108:111], v1 offset:11264
v_cvt_pk_bf16_f32 v163, v170, v171
v_mfma_f32_16x16x32_bf16 v[148:151], a[80:83], v[120:123], v[148:151]
s_mul_i32 s8, s8, 14336
ds_read_b128 a[112:115], v1 offset:12288
v_cvt_pk_bf16_f32 v176, v176, v177
v_mfma_f32_16x16x32_bf16 v[148:151], a[84:87], v[124:127], v[148:151]
s_waitcnt lgkmcnt(5)
s_add_u32 s8, s8, 104857600
ds_read_b128 a[116:119], v1 offset:13312
v_cvt_pk_bf16_f32 v177, v178, v179
v_mfma_f32_16x16x32_bf16 v[156:159], a[88:91], v[120:123], v[156:159]
s_add_u32 s12, s8, 917504
ds_read_b128 a[120:123], v1 offset:14336
v_cvt_pk_bf16_f32 v178, v184, v185
v_mfma_f32_16x16x32_bf16 v[156:159], a[92:95], v[124:127], v[156:159]
s_waitcnt lgkmcnt(6)
ds_read_b128 a[124:127], v1 offset:15360
v_cvt_pk_bf16_f32 v179, v186, v187
v_mfma_f32_16x16x32_bf16 v[164:167], a[96:99], v[120:123], v[164:167]
s_waitcnt lgkmcnt(6)
ds_read_b128 a[64:67], v1 offset:16384
v_cvt_pk_bf16_f32 v192, v192, v193
v_mfma_f32_16x16x32_bf16 v[164:167], a[100:103], v[124:127], v[164:167]
s_waitcnt lgkmcnt(6)
ds_read_b128 a[68:71], v1 offset:17408
v_cvt_pk_bf16_f32 v193, v194, v195
v_mfma_f32_16x16x32_bf16 v[172:175], a[104:107], v[120:123], v[172:175]
s_waitcnt lgkmcnt(6)
ds_read_b128 a[72:75], v1 offset:18432
v_cvt_pk_bf16_f32 v194, v200, v201
v_mfma_f32_16x16x32_bf16 v[172:175], a[108:111], v[124:127], v[172:175]
s_waitcnt lgkmcnt(6)
ds_read_b128 a[76:79], v1 offset:19456
v_cvt_pk_bf16_f32 v195, v202, v203
v_mfma_f32_16x16x32_bf16 v[180:183], a[112:115], v[120:123], v[180:183]
s_waitcnt lgkmcnt(6)
ds_read_b128 a[80:83], v1 offset:20480
v_cvt_pk_bf16_f32 v208, v208, v209
v_mfma_f32_16x16x32_bf16 v[180:183], a[116:119], v[124:127], v[180:183]
s_waitcnt lgkmcnt(6)
ds_read_b128 a[84:87], v1 offset:21504
v_cvt_pk_bf16_f32 v209, v210, v211
v_mfma_f32_16x16x32_bf16 v[188:191], a[120:123], v[120:123], v[188:191]
s_waitcnt lgkmcnt(6)
ds_read_b128 a[88:91], v1 offset:22528
v_cvt_pk_bf16_f32 v210, v216, v217
v_mfma_f32_16x16x32_bf16 v[188:191], a[124:127], v[124:127], v[188:191]
s_waitcnt lgkmcnt(6)
ds_read_b128 a[92:95], v1 offset:23552
v_cvt_pk_bf16_f32 v211, v218, v219
v_mfma_f32_16x16x32_bf16 v[196:199], a[64:67], v[120:123], v[196:199]
s_waitcnt lgkmcnt(6)
ds_read_b128 a[96:99], v1 offset:24576
v_cvt_pk_bf16_f32 v224, v224, v225
v_mfma_f32_16x16x32_bf16 v[196:199], a[68:71], v[124:127], v[196:199]
s_waitcnt lgkmcnt(6)
ds_read_b128 a[100:103], v1 offset:25600
v_cvt_pk_bf16_f32 v225, v226, v227
v_mfma_f32_16x16x32_bf16 v[204:207], a[72:75], v[120:123], v[204:207]
s_waitcnt lgkmcnt(6)
ds_read_b128 a[104:107], v1 offset:26624
v_cvt_pk_bf16_f32 v226, v232, v233
v_mfma_f32_16x16x32_bf16 v[204:207], a[76:79], v[124:127], v[204:207]
s_waitcnt lgkmcnt(6)
ds_read_b128 a[108:111], v1 offset:27648
v_cvt_pk_bf16_f32 v227, v234, v235
v_mfma_f32_16x16x32_bf16 v[212:215], a[80:83], v[120:123], v[212:215]
s_waitcnt lgkmcnt(6)
ds_read_b128 a[112:115], v1 offset:28672
v_cvt_pk_bf16_f32 v240, v240, v241
v_mfma_f32_16x16x32_bf16 v[212:215], a[84:87], v[124:127], v[212:215]
s_waitcnt lgkmcnt(5)
ds_read_b128 a[116:119], v1 offset:29696
v_cvt_pk_bf16_f32 v241, v242, v243
v_mfma_f32_16x16x32_bf16 v[220:223], a[88:91], v[120:123], v[220:223]
s_add_u32 m0, s18, 98304
ds_read_b128 a[120:123], v1 offset:30720
v_cvt_pk_bf16_f32 v242, v248, v249
v_mfma_f32_16x16x32_bf16 v[220:223], a[92:95], v[124:127], v[220:223]
s_waitcnt lgkmcnt(6)
ds_read_b128 a[124:127], v1 offset:31744
v_cvt_pk_bf16_f32 v243, v250, v251
v_mfma_f32_16x16x32_bf16 v[228:231], a[96:99], v[120:123], v[228:231]
s_waitcnt lgkmcnt(6)
buffer_load_dwordx4 v112, s[36:39], s81 offen offset:0 lds
v_mfma_f32_16x16x32_bf16 v[228:231], a[100:103], v[124:127], v[228:231]
s_waitcnt lgkmcnt(5)
buffer_load_dwordx4 v113, s[36:39], s81 offen offset:1024 lds
v_mfma_f32_16x16x32_bf16 v[236:239], a[104:107], v[120:123], v[236:239]
s_waitcnt lgkmcnt(4)
buffer_load_dwordx4 v114, s[36:39], s81 offen offset:2048 lds
v_mfma_f32_16x16x32_bf16 v[236:239], a[108:111], v[124:127], v[236:239]
s_waitcnt lgkmcnt(1)
buffer_load_dwordx4 v115, s[36:39], s81 offen offset:3072 lds
v_mfma_f32_16x16x32_bf16 v[244:247], a[112:115], v[120:123], v[244:247]
s_add_u32 s81, s81, 28672
v_cvt_pk_bf16_f32 v132, v132, v133
v_cvt_pk_bf16_f32 v133, v134, v135
v_mfma_f32_16x16x32_bf16 v[244:247], a[116:119], v[124:127], v[244:247]
s_add_u32 m0, s18, 102400
v_cvt_pk_bf16_f32 v134, v140, v141
v_cvt_pk_bf16_f32 v135, v142, v143
v_mfma_f32_16x16x32_bf16 v[252:255], a[120:123], v[120:123], v[252:255]
s_waitcnt lgkmcnt(0)
buffer_load_dwordx4 v112, s[36:39], s81 offen offset:0 lds
v_mfma_f32_16x16x32_bf16 v[252:255], a[124:127], v[124:127], v[252:255]
buffer_load_dwordx4 v113, s[36:39], s81 offen offset:1024 lds
buffer_load_dwordx4 v114, s[36:39], s81 offen offset:2048 lds
buffer_load_dwordx4 v115, s[36:39], s81 offen offset:3072 lds
s_sub_u32 s81, s81, 28544
s_waitcnt vmcnt(8)
s_barrier
ds_read_b64_tr_b16 a[64:65], v116 offset:0
ds_read_b64_tr_b16 a[66:67], v116 offset:2048
ds_read_b64_tr_b16 a[68:69], v116 offset:4096
ds_read_b64_tr_b16 a[70:71], v116 offset:6144
v_cvt_pk_bf16_f32 v148, v148, v149
v_cvt_pk_bf16_f32 v149, v150, v151
v_cvt_pk_bf16_f32 v150, v156, v157
v_cvt_pk_bf16_f32 v151, v158, v159
ds_read_b64_tr_b16 a[72:73], v116 offset:8192
ds_read_b64_tr_b16 a[74:75], v116 offset:10240
ds_read_b64_tr_b16 a[76:77], v116 offset:12288
ds_read_b64_tr_b16 a[78:79], v116 offset:14336
v_cvt_pk_bf16_f32 v164, v164, v165
v_cvt_pk_bf16_f32 v165, v166, v167
v_cvt_pk_bf16_f32 v166, v172, v173
v_cvt_pk_bf16_f32 v167, v174, v175
ds_read_b64_tr_b16 a[80:81], v116 offset:16384
ds_read_b64_tr_b16 a[82:83], v116 offset:18432
ds_read_b64_tr_b16 a[84:85], v116 offset:20480
ds_read_b64_tr_b16 a[86:87], v116 offset:22528
v_cvt_pk_bf16_f32 v180, v180, v181
v_cvt_pk_bf16_f32 v181, v182, v183
v_cvt_pk_bf16_f32 v182, v188, v189
v_cvt_pk_bf16_f32 v183, v190, v191
ds_read_b64_tr_b16 a[88:89], v116 offset:24576
ds_read_b64_tr_b16 a[90:91], v116 offset:26624
ds_read_b64_tr_b16 a[92:93], v116 offset:28672
ds_read_b64_tr_b16 a[94:95], v116 offset:30720
v_cvt_pk_bf16_f32 v196, v196, v197
v_cvt_pk_bf16_f32 v197, v198, v199
v_cvt_pk_bf16_f32 v198, v204, v205
v_cvt_pk_bf16_f32 v199, v206, v207
v_cvt_pk_bf16_f32 v212, v212, v213
v_cvt_pk_bf16_f32 v213, v214, v215
v_cvt_pk_bf16_f32 v214, v220, v221
v_cvt_pk_bf16_f32 v215, v222, v223
v_cvt_pk_bf16_f32 v228, v228, v229
v_cvt_pk_bf16_f32 v229, v230, v231
v_cvt_pk_bf16_f32 v230, v236, v237
v_cvt_pk_bf16_f32 v231, v238, v239
v_cvt_pk_bf16_f32 v244, v244, v245
v_cvt_pk_bf16_f32 v245, v246, v247
v_cvt_pk_bf16_f32 v246, v252, v253
v_cvt_pk_bf16_f32 v247, v254, v255
v_add_u32 v116, 65536, v116
s_branch K2_done
K2_cfix:
s_nop 7
v_max_f32 v12, 0, v8
v_exp_f32 v13, -v12
v_sub_f32 v8, v8, v12
v_mul_f32 v24, v24, v13
v_mul_f32 v128, v128, v13
v_mul_f32 v129, v129, v13
v_mul_f32 v130, v130, v13
v_mul_f32 v131, v131, v13
v_mul_f32 v136, v136, v13
v_mul_f32 v137, v137, v13
v_mul_f32 v138, v138, v13
v_mul_f32 v139, v139, v13
v_mul_f32 v144, v144, v13
v_mul_f32 v145, v145, v13
v_mul_f32 v146, v146, v13
v_mul_f32 v147, v147, v13
v_mul_f32 v152, v152, v13
v_mul_f32 v153, v153, v13
v_mul_f32 v154, v154, v13
v_mul_f32 v155, v155, v13
v_mul_f32 v160, v160, v13
v_mul_f32 v161, v161, v13
v_mul_f32 v162, v162, v13
v_mul_f32 v163, v163, v13
v_mul_f32 v168, v168, v13
v_mul_f32 v169, v169, v13
v_mul_f32 v170, v170, v13
v_mul_f32 v171, v171, v13
v_mul_f32 v176, v176, v13
v_mul_f32 v177, v177, v13
v_mul_f32 v178, v178, v13
v_mul_f32 v179, v179, v13
v_mul_f32 v184, v184, v13
v_mul_f32 v185, v185, v13
v_mul_f32 v186, v186, v13
v_mul_f32 v187, v187, v13
v_mul_f32 v192, v192, v13
v_mul_f32 v193, v193, v13
v_mul_f32 v194, v194, v13
v_mul_f32 v195, v195, v13
v_mul_f32 v200, v200, v13
v_mul_f32 v201, v201, v13
v_mul_f32 v202, v202, v13
v_mul_f32 v203, v203, v13
v_mul_f32 v208, v208, v13
v_mul_f32 v209, v209, v13
v_mul_f32 v210, v210, v13
v_mul_f32 v211, v211, v13
v_mul_f32 v216, v216, v13
v_mul_f32 v217, v217, v13
v_mul_f32 v218, v218, v13
v_mul_f32 v219, v219, v13
v_mul_f32 v224, v224, v13
v_mul_f32 v225, v225, v13
v_mul_f32 v226, v226, v13
v_mul_f32 v227, v227, v13
v_mul_f32 v232, v232, v13
v_mul_f32 v233, v233, v13
v_mul_f32 v234, v234, v13
v_mul_f32 v235, v235, v13
v_mul_f32 v240, v240, v13
v_mul_f32 v241, v241, v13
v_mul_f32 v242, v242, v13
v_mul_f32 v243, v243, v13
v_mul_f32 v248, v248, v13
v_mul_f32 v249, v249, v13
v_mul_f32 v250, v250, v13
v_mul_f32 v251, v251, v13
v_max_f32 v12, 0, v10
v_exp_f32 v13, -v12
v_sub_f32 v10, v10, v12
v_mul_f32 v25, v25, v13
v_mul_f32 v132, v132, v13
v_mul_f32 v133, v133, v13
v_mul_f32 v134, v134, v13
v_mul_f32 v135, v135, v13
v_mul_f32 v140, v140, v13
v_mul_f32 v141, v141, v13
v_mul_f32 v142, v142, v13
v_mul_f32 v143, v143, v13
v_mul_f32 v148, v148, v13
v_mul_f32 v149, v149, v13
v_mul_f32 v150, v150, v13
v_mul_f32 v151, v151, v13
v_mul_f32 v156, v156, v13
v_mul_f32 v157, v157, v13
v_mul_f32 v158, v158, v13
v_mul_f32 v159, v159, v13
v_mul_f32 v164, v164, v13
v_mul_f32 v165, v165, v13
v_mul_f32 v166, v166, v13
v_mul_f32 v167, v167, v13
v_mul_f32 v172, v172, v13
v_mul_f32 v173, v173, v13
v_mul_f32 v174, v174, v13
v_mul_f32 v175, v175, v13
v_mul_f32 v180, v180, v13
v_mul_f32 v181, v181, v13
v_mul_f32 v182, v182, v13
v_mul_f32 v183, v183, v13
v_mul_f32 v188, v188, v13
v_mul_f32 v189, v189, v13
v_mul_f32 v190, v190, v13
v_mul_f32 v191, v191, v13
v_mul_f32 v196, v196, v13
v_mul_f32 v197, v197, v13
v_mul_f32 v198, v198, v13
v_mul_f32 v199, v199, v13
v_mul_f32 v204, v204, v13
v_mul_f32 v205, v205, v13
v_mul_f32 v206, v206, v13
v_mul_f32 v207, v207, v13
v_mul_f32 v212, v212, v13
v_mul_f32 v213, v213, v13
v_mul_f32 v214, v214, v13
v_mul_f32 v215, v215, v13
v_mul_f32 v220, v220, v13
v_mul_f32 v221, v221, v13
v_mul_f32 v222, v222, v13
v_mul_f32 v223, v223, v13
v_mul_f32 v228, v228, v13
v_mul_f32 v229, v229, v13
v_mul_f32 v230, v230, v13
v_mul_f32 v231, v231, v13
v_mul_f32 v236, v236, v13
v_mul_f32 v237, v237, v13
v_mul_f32 v238, v238, v13
v_mul_f32 v239, v239, v13
v_mul_f32 v244, v244, v13
v_mul_f32 v245, v245, v13
v_mul_f32 v246, v246, v13
v_mul_f32 v247, v247, v13
v_mul_f32 v252, v252, v13
v_mul_f32 v253, v253, v13
v_mul_f32 v254, v254, v13
v_mul_f32 v255, v255, v13
s_branch K2_cok
K2_tspin:
Lp_9101:
buffer_load_dword v3, off, s[4:7], s80 sc1
s_waitcnt vmcnt(0)
v_cmp_gt_u32 vcc, 1, v3
s_cbranch_vccz Lpd_9102
s_sleep 8
s_sub_u32 s101, s101, 1
s_cbranch_scc0 Lp_9101
s_mov_b32 s101, 0
Lpd_9102:
s_branch K2_tok
K2_p0d:
ds_read_b128 a[64:67], v1 offset:0
ds_read_b128 a[68:71], v1 offset:1024
ds_read_b128 a[72:75], v1 offset:2048
ds_read_b128 a[76:79], v1 offset:3072
ds_read_b128 a[80:83], v1 offset:4096
ds_read_b128 a[84:87], v1 offset:5120
ds_read_b128 a[88:91], v1 offset:6144
ds_read_b128 a[92:95], v1 offset:7168
v_cndmask_b32 v32, 0, v7, s[32:33]
v_cndmask_b32 v33, 0, v7, s[34:35]
v_cndmask_b32 v34, 0, v7, s[36:37]
v_cndmask_b32 v35, 0, v7, s[38:39]
v_cndmask_b32 v40, 0, v7, s[40:41]
v_cndmask_b32 v41, 0, v7, s[42:43]
v_cndmask_b32 v42, 0, v7, s[44:45]
v_cndmask_b32 v43, 0, v7, s[46:47]
s_waitcnt lgkmcnt(7)
v_mfma_f32_16x16x32_bf16 v[32:35], a[64:67], a[0:3], v[32:35]
s_waitcnt lgkmcnt(6)
s_add_u32 m0, s18, 65536
ds_read_b128 a[96:99], v1 offset:8192
v_mfma_f32_16x16x32_bf16 v[32:35], a[68:71], a[4:7], v[32:35]
s_waitcnt lgkmcnt(6)
buffer_load_dwordx4 v1, s[4:7], s12 offen offset:0 sc1 lds
v_mfma_f32_16x16x32_bf16 v[32:35], a[72:75], a[8:11], v[32:35]
s_waitcnt lgkmcnt(5)
ds_read_b128 a[100:103], v1 offset:9216
v_mfma_f32_16x16x32_bf16 v[32:35], a[76:79], a[12:15], v[32:35]
s_waitcnt lgkmcnt(5)
buffer_load_dwordx4 v1, s[4:7], s12 offen offset:1024 sc1 lds
v_mfma_f32_16x16x32_bf16 v[32:35], a[80:83], a[16:19], v[32:35]
s_waitcnt lgkmcnt(4)
ds_read_b128 a[104:107], v1 offset:10240
v_mfma_f32_16x16x32_bf16 v[32:35], a[84:87], a[20:23], v[32:35]
s_waitcnt lgkmcnt(4)
buffer_load_dwordx4 v1, s[4:7], s12 offen offset:2048 sc1 lds
v_mfma_f32_16x16x32_bf16 v[32:35], a[88:91], a[24:27], v[32:35]
s_waitcnt lgkmcnt(3)
ds_read_b128 a[108:111], v1 offset:11264
v_mfma_f32_16x16x32_bf16 v[32:35], a[92:95], a[28:31], v[32:35]
buffer_load_dwordx4 v1, s[4:7], s12 offen offset:3072 sc1 lds
v_mfma_f32_16x16x32_bf16 v[36:39], a[64:67], a[32:35], 0
s_add_u32 s12, s12, 4096
s_add_u32 m0, s18, 69632
ds_read_b128 a[112:115], v1 offset:12288
v_mfma_f32_16x16x32_bf16 v[36:39], a[68:71], a[36:39], v[36:39]
buffer_load_dwordx4 v1, s[4:7], s12 offen offset:0 sc1 lds
v_mfma_f32_16x16x32_bf16 v[36:39], a[72:75], a[40:43], v[36:39]
ds_read_b128 a[116:119], v1 offset:13312
v_mfma_f32_16x16x32_bf16 v[36:39], a[76:79], a[44:47], v[36:39]
buffer_load_dwordx4 v1, s[4:7], s12 offen offset:1024 sc1 lds
v_mfma_f32_16x16x32_bf16 v[36:39], a[80:83], a[48:51], v[36:39]
ds_read_b128 a[120:123], v1 offset:14336
v_max3_f32 v28, v32, v33, v34
v_mfma_f32_16x16x32_bf16 v[36:39], a[84:87], a[52:55], v[36:39]
buffer_load_dwordx4 v1, s[4:7], s12 offen offset:2048 sc1 lds
v_mfma_f32_16x16x32_bf16 v[36:39], a[88:91], a[56:59], v[36:39]
ds_read_b128 a[124:127], v1 offset:15360
v_max_f32 v28, v28, v35
v_mfma_f32_16x16x32_bf16 v[36:39], a[92:95], a[60:63], v[36:39]
s_waitcnt lgkmcnt(4)
buffer_load_dwordx4 v1, s[4:7], s12 offen offset:3072 sc1 lds
v_mfma_f32_16x16x32_bf16 v[40:43], a[96:99], a[0:3], v[40:43]
s_add_u32 s12, s12, 28672
ds_read_b128 a[64:67], v1 offset:16384
v_mov_b32 v30, v28
v_mfma_f32_16x16x32_bf16 v[40:43], a[100:103], a[4:7], v[40:43]
s_waitcnt lgkmcnt(2)
s_sub_u32 s13, s13, 1
v_mfma_f32_16x16x32_bf16 v[40:43], a[104:107], a[8:11], v[40:43]
s_cmp_eq_u32 s13, 0
ds_read_b128 a[68:71], v1 offset:17408
v_permlane16_swap_b32 v28, v30
v_mfma_f32_16x16x32_bf16 v[40:43], a[108:111], a[12:15], v[40:43]
s_cselect_b32 s12, s14, s12
v_max_f32 v28, v28, v30
v_mov_b32 v30, v28
v_mfma_f32_16x16x32_bf16 v[40:43], a[112:115], a[16:19], v[40:43]
s_cselect_b32 s13, s15, s13
ds_read_b128 a[72:75], v1 offset:18432
v_max3_f32 v29, v36, v37, v38
v_mfma_f32_16x16x32_bf16 v[40:43], a[116:119], a[20:23], v[40:43]
s_cselect_b32 s14, 3221225472, s14
v_permlane32_swap_b32 v28, v30
v_max_f32 v28, v28, v30
v_mfma_f32_16x16x32_bf16 v[40:43], a[120:123], a[24:27], v[40:43]
s_waitcnt lgkmcnt(3)
ds_read_b128 a[76:79], v1 offset:19456
v_sub_f32 v16, 0, v28
v_mfma_f32_16x16x32_bf16 v[40:43], a[124:127], a[28:31], v[40:43]
v_sub_f32 v17, 0, v28
v_sub_f32 v18, 0, v28
v_mfma_f32_16x16x32_bf16 v[44:47], a[96:99], a[32:35], 0
ds_read_b128 a[80:83], v1 offset:20480
v_sub_f32 v19, 0, v28
v_mfma_f32_16x16x32_bf16 v[44:47], a[100:103], a[36:39], v[44:47]
v_max_f32 v29, v29, v39
v_mov_b32 v31, v29
v_cndmask_b32 v48, v16, v7, s[48:49]
v_mfma_f32_16x16x32_bf16 v[44:47], a[104:107], a[40:43], v[44:47]
ds_read_b128 a[84:87], v1 offset:21504
v_cndmask_b32 v49, v16, v7, s[50:51]
v_mfma_f32_16x16x32_bf16 v[44:47], a[108:111], a[44:47], v[44:47]
v_permlane16_swap_b32 v29, v31
v_max_f32 v29, v29, v31
v_cndmask_b32 v50, v16, v7, s[52:53]
v_mfma_f32_16x16x32_bf16 v[44:47], a[112:115], a[48:51], v[44:47]
ds_read_b128 a[88:91], v1 offset:22528
v_mov_b32 v31, v29
v_cndmask_b32 v51, v16, v7, s[54:55]
v_mfma_f32_16x16x32_bf16 v[44:47], a[116:119], a[52:55], v[44:47]
v_cndmask_b32 v56, v16, v7, s[56:57]
v_cndmask_b32 v57, v16, v7, s[58:59]
v_mfma_f32_16x16x32_bf16 v[44:47], a[120:123], a[56:59], v[44:47]
ds_read_b128 a[92:95], v1 offset:23552
v_permlane32_swap_b32 v29, v31
v_mfma_f32_16x16x32_bf16 v[44:47], a[124:127], a[60:63], v[44:47]
s_waitcnt lgkmcnt(4)
v_max_f32 v29, v29, v31
v_sub_f32 v20, 0, v29
v_mfma_f32_16x16x32_bf16 v[48:51], a[64:67], a[0:3], v[48:51]
ds_read_b128 a[96:99], v1 offset:24576
v_sub_f32 v21, 0, v29
v_mfma_f32_16x16x32_bf16 v[48:51], a[68:71], a[4:7], v[48:51]
v_sub_f32 v22, 0, v29
v_sub_f32 v23, 0, v29
v_mfma_f32_16x16x32_bf16 v[48:51], a[72:75], a[8:11], v[48:51]
ds_read_b128 a[100:103], v1 offset:25600
v_cndmask_b32 v58, v16, v7, s[60:61]
v_mfma_f32_16x16x32_bf16 v[48:51], a[76:79], a[12:15], v[48:51]
s_waitcnt lgkmcnt(4)
v_cndmask_b32 v59, v16, v7, s[62:63]
v_mfma_f32_16x16x32_bf16 v[48:51], a[80:83], a[16:19], v[48:51]
ds_read_b128 a[104:107], v1 offset:26624
v_mfma_f32_16x16x32_bf16 v[48:51], a[84:87], a[20:23], v[48:51]
s_waitcnt lgkmcnt(4)
v_add_f32 v32, v32, v16
v_add_f32 v33, v33, v16
v_add_f32 v34, v34, v16
v_add_f32 v35, v35, v16
v_mfma_f32_16x16x32_bf16 v[48:51], a[88:91], a[24:27], v[48:51]
s_waitcnt lgkmcnt(3)
ds_read_b128 a[108:111], v1 offset:27648
v_add_f32 v36, v36, v20
v_add_f32 v37, v37, v20
v_add_f32 v38, v38, v20
v_add_f32 v39, v39, v20
v_mfma_f32_16x16x32_bf16 v[48:51], a[92:95], a[28:31], v[48:51]
v_add_f32 v40, v40, v16
v_add_f32 v41, v41, v16
v_add_f32 v42, v42, v16
v_add_f32 v43, v43, v16
v_mfma_f32_16x16x32_bf16 v[52:55], a[64:67], a[32:35], v[20:23]
ds_read_b128 a[112:115], v1 offset:28672
v_add_f32 v44, v44, v20
v_add_f32 v45, v45, v20
v_add_f32 v46, v46, v20
v_add_f32 v47, v47, v20
v_mfma_f32_16x16x32_bf16 v[52:55], a[68:71], a[36:39], v[52:55]
v_exp_f32 v8, v32
v_mfma_f32_16x16x32_bf16 v[52:55], a[72:75], a[40:43], v[52:55]
ds_read_b128 a[116:119], v1 offset:29696
v_exp_f32 v9, v33
v_exp_f32 v10, v34
v_mfma_f32_16x16x32_bf16 v[52:55], a[76:79], a[44:47], v[52:55]
v_exp_f32 v11, v35
v_add_f32 v26, v8, v9
v_cvt_pk_bf16_f32 v96, v8, v9
v_add_f32 v26, v26, v10
v_mfma_f32_16x16x32_bf16 v[52:55], a[80:83], a[48:51], v[52:55]
ds_read_b128 a[120:123], v1 offset:30720
v_exp_f32 v12, v36
v_add_f32 v26, v26, v11
v_cvt_pk_bf16_f32 v97, v10, v11
v_mfma_f32_16x16x32_bf16 v[52:55], a[84:87], a[52:55], v[52:55]
v_exp_f32 v13, v37
v_mfma_f32_16x16x32_bf16 v[52:55], a[88:91], a[56:59], v[52:55]
s_waitcnt vmcnt(8) lgkmcnt(4)
ds_read_b128 a[124:127], v1 offset:31744
v_exp_f32 v14, v38
v_add_f32 v27, v12, v13
v_cvt_pk_bf16_f32 v104, v12, v13
v_mfma_f32_16x16x32_bf16 v[52:55], a[92:95], a[60:63], v[52:55]
s_barrier
v_add_f32 v27, v27, v14
v_mfma_f32_16x16x32_bf16 v[56:59], a[96:99], a[0:3], v[56:59]
ds_read_b128 a[64:67], v4 offset:0
v_exp_f32 v15, v39
v_mfma_f32_16x16x32_bf16 v[56:59], a[100:103], a[4:7], v[56:59]
buffer_store_dword v6, v5, s[4:7], s71 offen sc1
v_add_f32 v27, v27, v15
v_cvt_pk_bf16_f32 v105, v14, v15
v_mfma_f32_16x16x32_bf16 v[56:59], a[104:107], a[8:11], v[56:59]
s_waitcnt lgkmcnt(4)
ds_read_b128 a[68:71], v4 offset:1024
v_exp_f32 v8, v40
v_mfma_f32_16x16x32_bf16 v[56:59], a[108:111], a[12:15], v[56:59]
v_exp_f32 v9, v41
v_add_f32 v26, v26, v8
v_mfma_f32_16x16x32_bf16 v[56:59], a[112:115], a[16:19], v[56:59]
s_waitcnt lgkmcnt(4)
ds_read_b128 a[72:75], v4 offset:2048
v_exp_f32 v10, v42
v_exp_f32 v11, v43
v_add_f32 v26, v26, v9
v_cvt_pk_bf16_f32 v98, v8, v9
v_mfma_f32_16x16x32_bf16 v[56:59], a[116:119], a[20:23], v[56:59]
s_waitcnt lgkmcnt(4)
v_exp_f32 v12, v44
v_add_f32 v26, v26, v10
v_add_f32 v26, v26, v11
v_cvt_pk_bf16_f32 v99, v10, v11
v_mfma_f32_16x16x32_bf16 v[56:59], a[120:123], a[24:27], v[56:59]
s_waitcnt lgkmcnt(3)
ds_read_b128 a[76:79], v4 offset:3072
v_exp_f32 v13, v45
v_add_f32 v27, v27, v12
v_mfma_f32_16x16x32_bf16 v[56:59], a[124:127], a[28:31], v[56:59]
v_exp_f32 v14, v46
v_add_f32 v27, v27, v13
v_cvt_pk_bf16_f32 v106, v12, v13
v_mfma_f32_16x16x32_bf16 v[60:63], a[96:99], a[32:35], v[20:23]
ds_read_b128 a[80:83], v4 offset:4096
v_exp_f32 v15, v47
v_add_f32 v27, v27, v14
v_mfma_f32_16x16x32_bf16 v[60:63], a[100:103], a[36:39], v[60:63]
v_exp_f32 v8, v48
v_mfma_f32_16x16x32_bf16 v[60:63], a[104:107], a[40:43], v[60:63]
ds_read_b128 a[84:87], v4 offset:5120
v_exp_f32 v9, v49
v_mfma_f32_16x16x32_bf16 v[60:63], a[108:111], a[44:47], v[60:63]
v_exp_f32 v10, v50
v_mfma_f32_16x16x32_bf16 v[60:63], a[112:115], a[48:51], v[60:63]
ds_read_b128 a[88:91], v4 offset:6144
v_exp_f32 v11, v51
v_mfma_f32_16x16x32_bf16 v[60:63], a[116:119], a[52:55], v[60:63]
v_add_f32 v27, v27, v15
v_cvt_pk_bf16_f32 v107, v14, v15
v_add_f32 v26, v26, v8
v_mfma_f32_16x16x32_bf16 v[60:63], a[120:123], a[56:59], v[60:63]
s_waitcnt lgkmcnt(7)
s_barrier
ds_read_b128 a[92:95], v4 offset:7168
v_mfma_f32_16x16x32_bf16 v[60:63], a[124:127], a[60:63], v[60:63]
s_waitcnt lgkmcnt(4)
v_add_f32 v26, v26, v9
v_cvt_pk_bf16_f32 v100, v8, v9
v_add_f32 v26, v26, v10
v_add_f32 v26, v26, v11
v_cvt_pk_bf16_f32 v101, v10, v11
s_branch K2_dx1
PAD_33:
s_cbranch_execz M_tret
K2_ntail:
v_mfma_f32_16x16x32_bf16 v[128:131], a[64:67], v[96:99], v[128:131]
s_add_u32 m0, s18, 98304
ds_read_b128 a[96:99], v2 offset:8192
v_add_f32 v24, v24, v26
v_mfma_f32_16x16x32_bf16 v[128:131], a[68:71], v[100:103], v[128:131]
buffer_load_dwordx4 v1, s[4:7], s12 offen offset:0 sc1 lds
v_mfma_f32_16x16x32_bf16 v[132:135], a[68:71], v[108:111], v[132:135]
ds_read_b128 a[100:103], v2 offset:9216
v_add_f32 v25, v25, v27
v_mfma_f32_16x16x32_bf16 v[132:135], a[64:67], v[104:107], v[132:135]
buffer_load_dwordx4 v1, s[4:7], s12 offen offset:1024 sc1 lds
v_mfma_f32_16x16x32_bf16 v[136:139], a[72:75], v[96:99], v[136:139]
ds_read_b128 a[104:107], v2 offset:10240
v_exp_f32 v8, v64
v_mfma_f32_16x16x32_bf16 v[136:139], a[76:79], v[100:103], v[136:139]
buffer_load_dwordx4 v1, s[4:7], s12 offen offset:2048 sc1 lds
v_mfma_f32_16x16x32_bf16 v[140:143], a[76:79], v[108:111], v[140:143]
ds_read_b128 a[108:111], v2 offset:11264
v_mfma_f32_16x16x32_bf16 v[140:143], a[72:75], v[104:107], v[140:143]
s_waitcnt lgkmcnt(4)
buffer_load_dwordx4 v1, s[4:7], s12 offen offset:3072 sc1 lds
v_mfma_f32_16x16x32_bf16 v[144:147], a[80:83], v[96:99], v[144:147]
s_add_u32 s12, s12, 4096
s_add_u32 m0, s18, 102400
ds_read_b128 a[112:115], v2 offset:12288
v_mfma_f32_16x16x32_bf16 v[144:147], a[84:87], v[100:103], v[144:147]
buffer_load_dwordx4 v1, s[4:7], s12 offen offset:0 sc1 lds
v_mfma_f32_16x16x32_bf16 v[148:151], a[84:87], v[108:111], v[148:151]
ds_read_b128 a[116:119], v2 offset:13312
v_exp_f32 v9, v65
v_mfma_f32_16x16x32_bf16 v[148:151], a[80:83], v[104:107], v[148:151]
buffer_load_dwordx4 v1, s[4:7], s12 offen offset:1024 sc1 lds
v_mfma_f32_16x16x32_bf16 v[152:155], a[88:91], v[96:99], v[152:155]
ds_read_b128 a[120:123], v2 offset:14336
v_add_f32 v26, v8, v9
v_cvt_pk_bf16_f32 v112, v8, v9
v_mfma_f32_16x16x32_bf16 v[152:155], a[92:95], v[100:103], v[152:155]
buffer_load_dwordx4 v1, s[4:7], s12 offen offset:2048 sc1 lds
v_mfma_f32_16x16x32_bf16 v[156:159], a[92:95], v[108:111], v[156:159]
ds_read_b128 a[124:127], v2 offset:15360
v_exp_f32 v10, v66
v_mfma_f32_16x16x32_bf16 v[156:159], a[88:91], v[104:107], v[156:159]
s_waitcnt lgkmcnt(4)
buffer_load_dwordx4 v1, s[4:7], s12 offen offset:3072 sc1 lds
v_mfma_f32_16x16x32_bf16 v[160:163], a[96:99], v[96:99], v[160:163]
s_add_u32 s12, s12, 28672
ds_read_b128 a[64:67], v2 offset:16384
v_add_f32 v26, v26, v10
v_mfma_f32_16x16x32_bf16 v[160:163], a[100:103], v[100:103], v[160:163]
s_sub_u32 s13, s13, 1
v_exp_f32 v11, v67
v_mfma_f32_16x16x32_bf16 v[164:167], a[100:103], v[108:111], v[164:167]
s_cmp_eq_u32 s13, 0
ds_read_b128 a[68:71], v2 offset:17408
v_exp_f32 v12, v68
v_mfma_f32_16x16x32_bf16 v[164:167], a[96:99], v[104:107], v[164:167]
s_cselect_b32 s12, s14, s12
v_exp_f32 v13, v69
v_mfma_f32_16x16x32_bf16 v[168:171], a[104:107], v[96:99], v[168:171]
s_cselect_b32 s13, s15, s13
ds_read_b128 a[72:75], v2 offset:18432
v_add_f32 v26, v26, v11
v_cvt_pk_bf16_f32 v113, v10, v11
v_mfma_f32_16x16x32_bf16 v[168:171], a[108:111], v[100:103], v[168:171]
s_cselect_b32 s14, 3221225472, s14
v_exp_f32 v14, v70
v_mfma_f32_16x16x32_bf16 v[172:175], a[108:111], v[108:111], v[172:175]
ds_read_b128 a[76:79], v2 offset:19456
v_exp_f32 v15, v71
v_mfma_f32_16x16x32_bf16 v[172:175], a[104:107], v[104:107], v[172:175]
s_waitcnt lgkmcnt(4)
v_exp_f32 v8, v72
v_mfma_f32_16x16x32_bf16 v[176:179], a[112:115], v[96:99], v[176:179]
ds_read_b128 a[80:83], v2 offset:20480
v_add_f32 v27, v12, v13
v_cvt_pk_bf16_f32 v120, v12, v13
v_add_f32 v27, v27, v14
v_add_f32 v27, v27, v15
v_cvt_pk_bf16_f32 v121, v14, v15
v_mfma_f32_16x16x32_bf16 v[176:179], a[116:119], v[100:103], v[176:179]
v_exp_f32 v9, v73
v_mfma_f32_16x16x32_bf16 v[180:183], a[116:119], v[108:111], v[180:183]
ds_read_b128 a[84:87], v2 offset:21504
v_exp_f32 v10, v74
v_mfma_f32_16x16x32_bf16 v[180:183], a[112:115], v[104:107], v[180:183]
v_exp_f32 v11, v75
v_mfma_f32_16x16x32_bf16 v[184:187], a[120:123], v[96:99], v[184:187]
ds_read_b128 a[88:91], v2 offset:22528
v_add_f32 v26, v26, v8
v_mfma_f32_16x16x32_bf16 v[184:187], a[124:127], v[100:103], v[184:187]
v_exp_f32 v12, v76
v_mfma_f32_16x16x32_bf16 v[188:191], a[124:127], v[108:111], v[188:191]
ds_read_b128 a[92:95], v2 offset:23552
v_add_f32 v26, v26, v9
v_cvt_pk_bf16_f32 v114, v8, v9
v_add_f32 v26, v26, v10
v_add_f32 v26, v26, v11
v_cvt_pk_bf16_f32 v115, v10, v11
v_mfma_f32_16x16x32_bf16 v[188:191], a[120:123], v[104:107], v[188:191]
s_waitcnt lgkmcnt(4)
v_exp_f32 v13, v77
v_mfma_f32_16x16x32_bf16 v[192:195], a[64:67], v[96:99], v[192:195]
ds_read_b128 a[96:99], v2 offset:24576
v_exp_f32 v14, v78
v_mfma_f32_16x16x32_bf16 v[192:195], a[68:71], v[100:103], v[192:195]
v_exp_f32 v15, v79
v_mfma_f32_16x16x32_bf16 v[196:199], a[68:71], v[108:111], v[196:199]
ds_read_b128 a[100:103], v2 offset:25600
v_add_f32 v27, v27, v12
v_add_f32 v27, v27, v13
v_cvt_pk_bf16_f32 v122, v12, v13
v_add_f32 v27, v27, v14
v_mfma_f32_16x16x32_bf16 v[196:199], a[64:67], v[104:107], v[196:199]
v_exp_f32 v8, v80
v_mfma_f32_16x16x32_bf16 v[200:203], a[72:75], v[96:99], v[200:203]
ds_read_b128 a[104:107], v2 offset:26624
v_exp_f32 v9, v81
v_mfma_f32_16x16x32_bf16 v[200:203], a[76:79], v[100:103], v[200:203]
v_exp_f32 v10, v82
v_mfma_f32_16x16x32_bf16 v[204:207], a[76:79], v[108:111], v[204:207]
ds_read_b128 a[108:111], v2 offset:27648
v_add_f32 v27, v27, v15
v_cvt_pk_bf16_f32 v123, v14, v15
v_add_f32 v26, v26, v8
v_add_f32 v26, v26, v9
v_cvt_pk_bf16_f32 v116, v8, v9
v_mfma_f32_16x16x32_bf16 v[204:207], a[72:75], v[104:107], v[204:207]
s_waitcnt lgkmcnt(4)
v_exp_f32 v11, v83
v_mfma_f32_16x16x32_bf16 v[208:211], a[80:83], v[96:99], v[208:211]
ds_read_b128 a[112:115], v2 offset:28672
v_exp_f32 v12, v84
v_mfma_f32_16x16x32_bf16 v[208:211], a[84:87], v[100:103], v[208:211]
v_exp_f32 v13, v85
v_mfma_f32_16x16x32_bf16 v[212:215], a[84:87], v[108:111], v[212:215]
ds_read_b128 a[116:119], v2 offset:29696
v_add_f32 v26, v26, v10
v_add_f32 v26, v26, v11
v_cvt_pk_bf16_f32 v117, v10, v11
v_add_f32 v27, v27, v12
v_mfma_f32_16x16x32_bf16 v[212:215], a[80:83], v[104:107], v[212:215]
v_exp_f32 v14, v86
v_mfma_f32_16x16x32_bf16 v[216:219], a[88:91], v[96:99], v[216:219]
ds_read_b128 a[120:123], v2 offset:30720
v_exp_f32 v15, v87
v_mfma_f32_16x16x32_bf16 v[216:219], a[92:95], v[100:103], v[216:219]
v_exp_f32 v8, v88
v_mfma_f32_16x16x32_bf16 v[220:223], a[92:95], v[108:111], v[220:223]
s_waitcnt vmcnt(0) lgkmcnt(4)
ds_read_b128 a[124:127], v2 offset:31744
v_add_f32 v27, v27, v13
v_cvt_pk_bf16_f32 v124, v12, v13
v_add_f32 v27, v27, v14
v_add_f32 v27, v27, v15
v_cvt_pk_bf16_f32 v125, v14, v15
v_mfma_f32_16x16x32_bf16 v[220:223], a[88:91], v[104:107], v[220:223]
s_barrier
v_mfma_f32_16x16x32_bf16 v[224:227], a[96:99], v[96:99], v[224:227]
ds_read_b128 a[64:67], v2 offset:32768
v_exp_f32 v9, v89
v_mfma_f32_16x16x32_bf16 v[224:227], a[100:103], v[100:103], v[224:227]
v_exp_f32 v10, v90
v_mfma_f32_16x16x32_bf16 v[228:231], a[100:103], v[108:111], v[228:231]
ds_read_b128 a[68:71], v2 offset:33792
v_add_f32 v26, v26, v8
v_add_f32 v26, v26, v9
v_cvt_pk_bf16_f32 v118, v8, v9
v_mfma_f32_16x16x32_bf16 v[228:231], a[96:99], v[104:107], v[228:231]
v_exp_f32 v11, v91
v_mfma_f32_16x16x32_bf16 v[232:235], a[104:107], v[96:99], v[232:235]
s_waitcnt lgkmcnt(4)
ds_read_b128 a[72:75], v2 offset:34816
v_exp_f32 v12, v92
v_mfma_f32_16x16x32_bf16 v[232:235], a[108:111], v[100:103], v[232:235]
v_exp_f32 v13, v93
v_mfma_f32_16x16x32_bf16 v[236:239], a[108:111], v[108:111], v[236:239]
ds_read_b128 a[76:79], v2 offset:35840
v_add_f32 v26, v26, v10
v_mfma_f32_16x16x32_bf16 v[236:239], a[104:107], v[104:107], v[236:239]
v_exp_f32 v14, v94
v_mfma_f32_16x16x32_bf16 v[240:243], a[112:115], v[96:99], v[240:243]
ds_read_b128 a[80:83], v2 offset:36864
v_add_f32 v26, v26, v11
v_cvt_pk_bf16_f32 v119, v10, v11
v_add_f32 v27, v27, v12
v_mfma_f32_16x16x32_bf16 v[240:243], a[116:119], v[100:103], v[240:243]
v_exp_f32 v15, v95
v_mfma_f32_16x16x32_bf16 v[244:247], a[116:119], v[108:111], v[244:247]
ds_read_b128 a[84:87], v2 offset:37888
v_add_f32 v27, v27, v13
v_cvt_pk_bf16_f32 v126, v12, v13
v_mfma_f32_16x16x32_bf16 v[244:247], a[112:115], v[104:107], v[244:247]
s_waitcnt lgkmcnt(4)
v_add_f32 v27, v27, v14
v_add_f32 v27, v27, v15
v_mfma_f32_16x16x32_bf16 v[248:251], a[120:123], v[96:99], v[248:251]
ds_read_b128 a[88:91], v2 offset:38912
v_cvt_pk_bf16_f32 v127, v14, v15
v_mfma_f32_16x16x32_bf16 v[248:251], a[124:127], v[100:103], v[248:251]
v_add_f32 v28, v26, v27
v_cmp_nge_f32 vcc, s25, v28
v_mfma_f32_16x16x32_bf16 v[252:255], a[124:127], v[108:111], v[252:255]
ds_read_b128 a[92:95], v2 offset:39936
v_mfma_f32_16x16x32_bf16 v[252:255], a[120:123], v[104:107], v[252:255]
s_cbranch_vccnz Lstub_14
Lback_15:
v_mfma_f32_16x16x32_bf16 v[128:131], a[64:67], v[112:115], v[128:131]
s_add_u32 m0, s18, 131072
ds_read_b128 a[96:99], v2 offset:40960
v_add_f32 v24, v24, v26
v_mfma_f32_16x16x32_bf16 v[128:131], a[68:71], v[116:119], v[128:131]
buffer_load_dwordx4 v1, s[4:7], s8 offen offset:0 sc1 lds
v_mfma_f32_16x16x32_bf16 v[132:135], a[68:71], v[124:127], v[132:135]
ds_read_b128 a[100:103], v2 offset:41984
v_add_f32 v25, v25, v27
v_mfma_f32_16x16x32_bf16 v[132:135], a[64:67], v[120:123], v[132:135]
s_waitcnt lgkmcnt(4)
buffer_load_dwordx4 v1, s[4:7], s8 offen offset:1024 sc1 lds
v_mfma_f32_16x16x32_bf16 v[136:139], a[72:75], v[112:115], v[136:139]
ds_read_b128 a[104:107], v2 offset:43008
v_mov_b32 v8, v16
v_mfma_f32_16x16x32_bf16 v[136:139], a[76:79], v[116:119], v[136:139]
buffer_load_dwordx4 v1, s[4:7], s8 offen offset:2048 sc1 lds
v_mfma_f32_16x16x32_bf16 v[140:143], a[76:79], v[124:127], v[140:143]
ds_read_b128 a[108:111], v2 offset:44032
v_mov_b32 v9, v24
v_mfma_f32_16x16x32_bf16 v[140:143], a[72:75], v[120:123], v[140:143]
buffer_load_dwordx4 v1, s[4:7], s8 offen offset:3072 sc1 lds
v_mfma_f32_16x16x32_bf16 v[144:147], a[80:83], v[112:115], v[144:147]
s_add_u32 s8, s8, 4096
s_add_u32 m0, s18, 135168
ds_read_b128 a[112:115], v2 offset:45056
v_mfma_f32_16x16x32_bf16 v[144:147], a[84:87], v[116:119], v[144:147]
buffer_load_dwordx4 v1, s[4:7], s8 offen offset:0 sc1 lds
v_mfma_f32_16x16x32_bf16 v[148:151], a[84:87], v[124:127], v[148:151]
ds_read_b128 a[116:119], v2 offset:46080
v_mov_b32 v10, v20
v_mfma_f32_16x16x32_bf16 v[148:151], a[80:83], v[120:123], v[148:151]
s_waitcnt lgkmcnt(4)
buffer_load_dwordx4 v1, s[4:7], s8 offen offset:1024 sc1 lds
v_mfma_f32_16x16x32_bf16 v[152:155], a[88:91], v[112:115], v[152:155]
ds_read_b128 a[120:123], v2 offset:47104
v_mov_b32 v11, v25
v_mfma_f32_16x16x32_bf16 v[152:155], a[92:95], v[116:119], v[152:155]
buffer_load_dwordx4 v1, s[4:7], s8 offen offset:2048 sc1 lds
v_mfma_f32_16x16x32_bf16 v[156:159], a[92:95], v[124:127], v[156:159]
ds_read_b128 a[124:127], v2 offset:48128
v_cvt_pk_bf16_f32 v128, v128, v129
v_mfma_f32_16x16x32_bf16 v[156:159], a[88:91], v[120:123], v[156:159]
s_waitcnt lgkmcnt(4)
buffer_load_dwordx4 v1, s[4:7], s8 offen offset:3072 sc1 lds
v_mfma_f32_16x16x32_bf16 v[160:163], a[96:99], v[112:115], v[160:163]
s_add_u32 s8, s8, 28672
ds_read_b128 a[64:67], v2 offset:49152
v_cvt_pk_bf16_f32 v129, v130, v131
v_mfma_f32_16x16x32_bf16 v[160:163], a[100:103], v[116:119], v[160:163]
s_sub_u32 s9, s9, 1
buffer_store_dwordx4 v[8:11], v1, s[4:7], s27 offen sc1
v_mfma_f32_16x16x32_bf16 v[164:167], a[100:103], v[124:127], v[164:167]
s_cmp_eq_u32 s9, 0
ds_read_b128 a[68:71], v2 offset:50176
v_cvt_pk_bf16_f32 v130, v136, v137
v_mfma_f32_16x16x32_bf16 v[164:167], a[96:99], v[120:123], v[164:167]
s_cselect_b32 s8, s10, s8
v_cvt_pk_bf16_f32 v131, v138, v139
v_accvgpr_mov_b32 a0, a192
v_mfma_f32_16x16x32_bf16 v[168:171], a[104:107], v[112:115], v[168:171]
s_cselect_b32 s9, s11, s9
ds_read_b128 a[72:75], v2 offset:51200
v_accvgpr_mov_b32 a1, a193
v_mfma_f32_16x16x32_bf16 v[168:171], a[108:111], v[116:119], v[168:171]
s_cselect_b32 s10, 3221225472, s10
buffer_store_dwordx4 v[128:131], v1, s[4:7], s76 offen offset:0 sc1
v_mfma_f32_16x16x32_bf16 v[172:175], a[108:111], v[124:127], v[172:175]
ds_read_b128 a[76:79], v2 offset:52224
v_cvt_pk_bf16_f32 v132, v132, v133
v_mfma_f32_16x16x32_bf16 v[172:175], a[104:107], v[120:123], v[172:175]
s_waitcnt lgkmcnt(4)
v_cvt_pk_bf16_f32 v133, v134, v135
v_cvt_pk_bf16_f32 v134, v140, v141
v_mfma_f32_16x16x32_bf16 v[176:179], a[112:115], v[112:115], v[176:179]
ds_read_b128 a[80:83], v2 offset:53248
v_cvt_pk_bf16_f32 v135, v142, v143
v_mfma_f32_16x16x32_bf16 v[176:179], a[116:119], v[116:119], v[176:179]
buffer_store_dwordx4 v[132:135], v1, s[4:7], s77 offen offset:0 sc1
v_mfma_f32_16x16x32_bf16 v[180:183], a[116:119], v[124:127], v[180:183]
ds_read_b128 a[84:87], v2 offset:54272
v_cvt_pk_bf16_f32 v144, v144, v145
v_mfma_f32_16x16x32_bf16 v[180:183], a[112:115], v[120:123], v[180:183]
v_cvt_pk_bf16_f32 v145, v146, v147
v_cvt_pk_bf16_f32 v146, v152, v153
v_mfma_f32_16x16x32_bf16 v[184:187], a[120:123], v[112:115], v[184:187]
ds_read_b128 a[88:91], v2 offset:55296
v_cvt_pk_bf16_f32 v147, v154, v155
v_mfma_f32_16x16x32_bf16 v[184:187], a[124:127], v[116:119], v[184:187]
buffer_store_dwordx4 v[144:147], v1, s[4:7], s76 offen offset:1024 sc1
v_mfma_f32_16x16x32_bf16 v[188:191], a[124:127], v[124:127], v[188:191]
ds_read_b128 a[92:95], v2 offset:56320
v_cvt_pk_bf16_f32 v148, v148, v149
v_mfma_f32_16x16x32_bf16 v[188:191], a[120:123], v[120:123], v[188:191]
s_waitcnt lgkmcnt(4)
v_cvt_pk_bf16_f32 v149, v150, v151
v_cvt_pk_bf16_f32 v150, v156, v157
v_mfma_f32_16x16x32_bf16 v[192:195], a[64:67], v[112:115], v[192:195]
ds_read_b128 a[96:99], v2 offset:57344
v_cvt_pk_bf16_f32 v151, v158, v159
v_mfma_f32_16x16x32_bf16 v[192:195], a[68:71], v[116:119], v[192:195]
buffer_store_dwordx4 v[148:151], v1, s[4:7], s77 offen offset:1024 sc1
v_mfma_f32_16x16x32_bf16 v[196:199], a[68:71], v[124:127], v[196:199]
ds_read_b128 a[100:103], v2 offset:58368
v_cvt_pk_bf16_f32 v160, v160, v161
v_mfma_f32_16x16x32_bf16 v[196:199], a[64:67], v[120:123], v[196:199]
v_cvt_pk_bf16_f32 v161, v162, v163
v_cvt_pk_bf16_f32 v162, v168, v169
v_mfma_f32_16x16x32_bf16 v[200:203], a[72:75], v[112:115], v[200:203]
ds_read_b128 a[104:107], v2 offset:59392
v_cvt_pk_bf16_f32 v163, v170, v171
v_mfma_f32_16x16x32_bf16 v[200:203], a[76:79], v[116:119], v[200:203]
buffer_store_dwordx4 v[160:163], v1, s[4:7], s76 offen offset:2048 sc1
v_mfma_f32_16x16x32_bf16 v[204:207], a[76:79], v[124:127], v[204:207]
ds_read_b128 a[108:111], v2 offset:60416
v_cvt_pk_bf16_f32 v164, v164, v165
v_mfma_f32_16x16x32_bf16 v[204:207], a[72:75], v[120:123], v[204:207]
s_waitcnt lgkmcnt(4)
v_cvt_pk_bf16_f32 v165, v166, v167
v_cvt_pk_bf16_f32 v166, v172, v173
v_mfma_f32_16x16x32_bf16 v[208:211], a[80:83], v[112:115], v[208:211]
ds_read_b128 a[112:115], v2 offset:61440
v_cvt_pk_bf16_f32 v167, v174, v175
v_mfma_f32_16x16x32_bf16 v[208:211], a[84:87], v[116:119], v[208:211]
buffer_store_dwordx4 v[164:167], v1, s[4:7], s77 offen offset:2048 sc1
v_mfma_f32_16x16x32_bf16 v[212:215], a[84:87], v[124:127], v[212:215]
ds_read_b128 a[116:119], v2 offset:62464
v_cvt_pk_bf16_f32 v176, v176, v177
v_mfma_f32_16x16x32_bf16 v[212:215], a[80:83], v[120:123], v[212:215]
v_cvt_pk_bf16_f32 v177, v178, v179
v_cvt_pk_bf16_f32 v178, v184, v185
v_mfma_f32_16x16x32_bf16 v[216:219], a[88:91], v[112:115], v[216:219]
ds_read_b128 a[120:123], v2 offset:63488
v_cvt_pk_bf16_f32 v179, v186, v187
v_mfma_f32_16x16x32_bf16 v[216:219], a[92:95], v[116:119], v[216:219]
buffer_store_dwordx4 v[176:179], v1, s[4:7], s76 offen offset:3072 sc1
v_mfma_f32_16x16x32_bf16 v[220:223], a[92:95], v[124:127], v[220:223]
ds_read_b128 a[124:127], v2 offset:64512
v_cvt_pk_bf16_f32 v180, v180, v181
v_mfma_f32_16x16x32_bf16 v[220:223], a[88:91], v[120:123], v[220:223]
s_waitcnt lgkmcnt(4)
v_cvt_pk_bf16_f32 v181, v182, v183
v_cvt_pk_bf16_f32 v182, v188, v189
v_mfma_f32_16x16x32_bf16 v[224:227], a[96:99], v[112:115], v[224:227]
v_cvt_pk_bf16_f32 v183, v190, v191
v_accvgpr_mov_b32 a2, a194
v_mfma_f32_16x16x32_bf16 v[224:227], a[100:103], v[116:119], v[224:227]
buffer_store_dwordx4 v[180:183], v1, s[4:7], s77 offen offset:3072 sc1
v_mfma_f32_16x16x32_bf16 v[228:231], a[100:103], v[124:127], v[228:231]
s_add_u32 s76, s76, 4096
v_accvgpr_mov_b32 a3, a195
v_accvgpr_mov_b32 a4, a196
v_mfma_f32_16x16x32_bf16 v[228:231], a[96:99], v[120:123], v[228:231]
s_add_u32 s77, s77, 4096
v_cvt_pk_bf16_f32 v192, v192, v193
v_cvt_pk_bf16_f32 v193, v194, v195
v_mfma_f32_16x16x32_bf16 v[232:235], a[104:107], v[112:115], v[232:235]
v_cvt_pk_bf16_f32 v194, v200, v201
v_cvt_pk_bf16_f32 v195, v202, v203
v_mfma_f32_16x16x32_bf16 v[232:235], a[108:111], v[116:119], v[232:235]
buffer_store_dwordx4 v[192:195], v1, s[4:7], s76 offen offset:0 sc1
v_mfma_f32_16x16x32_bf16 v[236:239], a[108:111], v[124:127], v[236:239]
v_cvt_pk_bf16_f32 v196, v196, v197
v_cvt_pk_bf16_f32 v197, v198, v199
v_mfma_f32_16x16x32_bf16 v[236:239], a[104:107], v[120:123], v[236:239]
s_waitcnt lgkmcnt(0)
v_cvt_pk_bf16_f32 v198, v204, v205
v_cvt_pk_bf16_f32 v199, v206, v207
v_mfma_f32_16x16x32_bf16 v[240:243], a[112:115], v[112:115], v[240:243]
buffer_store_dwordx4 v[196:199], v1, s[4:7], s77 offen offset:0 sc1
v_mfma_f32_16x16x32_bf16 v[240:243], a[116:119], v[116:119], v[240:243]
v_cvt_pk_bf16_f32 v208, v208, v209
v_cvt_pk_bf16_f32 v209, v210, v211
v_mfma_f32_16x16x32_bf16 v[244:247], a[116:119], v[124:127], v[244:247]
PAD_34:
s_cbranch_execz M_tret
v_cvt_pk_bf16_f32 v210, v216, v217
v_cvt_pk_bf16_f32 v211, v218, v219
v_mfma_f32_16x16x32_bf16 v[244:247], a[112:115], v[120:123], v[244:247]
buffer_store_dwordx4 v[208:211], v1, s[4:7], s76 offen offset:1024 sc1
v_mfma_f32_16x16x32_bf16 v[248:251], a[120:123], v[112:115], v[248:251]
v_cvt_pk_bf16_f32 v212, v212, v213
v_cvt_pk_bf16_f32 v213, v214, v215
v_mfma_f32_16x16x32_bf16 v[248:251], a[124:127], v[116:119], v[248:251]
v_cvt_pk_bf16_f32 v214, v220, v221
v_cvt_pk_bf16_f32 v215, v222, v223
v_mfma_f32_16x16x32_bf16 v[252:255], a[124:127], v[124:127], v[252:255]
buffer_store_dwordx4 v[212:215], v1, s[4:7], s77 offen offset:1024 sc1
v_mfma_f32_16x16x32_bf16 v[252:255], a[120:123], v[120:123], v[252:255]
v_cvt_pk_bf16_f32 v224, v224, v225
v_cvt_pk_bf16_f32 v225, v226, v227
v_accvgpr_mov_b32 a5, a197
v_accvgpr_mov_b32 a6, a198
v_accvgpr_mov_b32 a7, a199
v_accvgpr_mov_b32 a8, a200
v_accvgpr_mov_b32 a9, a201
v_accvgpr_mov_b32 a10, a202
v_accvgpr_mov_b32 a11, a203
v_accvgpr_mov_b32 a12, a204
v_cvt_pk_bf16_f32 v226, v232, v233
v_cvt_pk_bf16_f32 v227, v234, v235
buffer_store_dwordx4 v[224:227], v1, s[4:7], s76 offen offset:2048 sc1
v_cvt_pk_bf16_f32 v228, v228, v229
v_cvt_pk_bf16_f32 v229, v230, v231
v_cvt_pk_bf16_f32 v230, v236, v237
v_cvt_pk_bf16_f32 v231, v238, v239
buffer_store_dwordx4 v[228:231], v1, s[4:7], s77 offen offset:2048 sc1
v_cvt_pk_bf16_f32 v240, v240, v241
v_cvt_pk_bf16_f32 v241, v242, v243
v_cvt_pk_bf16_f32 v242, v248, v249
v_cvt_pk_bf16_f32 v243, v250, v251
buffer_store_dwordx4 v[240:243], v1, s[4:7], s76 offen offset:3072 sc1
v_cvt_pk_bf16_f32 v244, v244, v245
v_cvt_pk_bf16_f32 v245, v246, v247
v_cvt_pk_bf16_f32 v246, v252, v253
v_cvt_pk_bf16_f32 v247, v254, v255
buffer_store_dwordx4 v[244:247], v1, s[4:7], s77 offen offset:3072 sc1
v_accvgpr_mov_b32 a13, a205
v_accvgpr_mov_b32 a14, a206
v_accvgpr_mov_b32 a15, a207
v_accvgpr_mov_b32 a16, a208
v_accvgpr_mov_b32 a17, a209
v_accvgpr_mov_b32 a18, a210
v_accvgpr_mov_b32 a19, a211
v_accvgpr_mov_b32 a20, a212
v_accvgpr_mov_b32 a21, a213
v_accvgpr_mov_b32 a22, a214
v_accvgpr_mov_b32 a23, a215
v_accvgpr_mov_b32 a24, a216
v_accvgpr_mov_b32 a25, a217
v_accvgpr_mov_b32 a26, a218
v_accvgpr_mov_b32 a27, a219
v_accvgpr_mov_b32 a28, a220
v_accvgpr_mov_b32 a29, a221
v_accvgpr_mov_b32 a30, a222
v_accvgpr_mov_b32 a31, a223
v_accvgpr_mov_b32 a32, a224
v_accvgpr_mov_b32 a33, a225
v_accvgpr_mov_b32 a34, a226
v_accvgpr_mov_b32 a35, a227
v_accvgpr_mov_b32 a36, a228
v_accvgpr_mov_b32 a37, a229
v_accvgpr_mov_b32 a38, a230
v_accvgpr_mov_b32 a39, a231
v_accvgpr_mov_b32 a40, a232
v_accvgpr_mov_b32 a41, a233
v_accvgpr_mov_b32 a42, a234
v_accvgpr_mov_b32 a43, a235
v_accvgpr_mov_b32 a44, a236
v_accvgpr_mov_b32 a45, a237
v_accvgpr_mov_b32 a46, a238
v_accvgpr_mov_b32 a47, a239
v_accvgpr_mov_b32 a48, a240
v_accvgpr_mov_b32 a49, a241
v_accvgpr_mov_b32 a50, a242
v_accvgpr_mov_b32 a51, a243
v_accvgpr_mov_b32 a52, a244
v_accvgpr_mov_b32 a53, a245
v_accvgpr_mov_b32 a54, a246
v_accvgpr_mov_b32 a55, a247
v_accvgpr_mov_b32 a56, a248
v_accvgpr_mov_b32 a57, a249
v_accvgpr_mov_b32 a58, a250
v_accvgpr_mov_b32 a59, a251
v_accvgpr_mov_b32 a60, a252
v_accvgpr_mov_b32 a61, a253
v_accvgpr_mov_b32 a62, a254
v_accvgpr_mov_b32 a63, a255
s_mov_b32 s24, 0
s_mov_b32 s29, s21
s_mov_b32 s19, s21
v_mov_b64 v[128:129], 0
v_mov_b64 v[130:131], 0
v_mov_b64 v[132:133], 0
v_mov_b64 v[134:135], 0
v_mov_b64 v[136:137], 0
v_mov_b64 v[138:139], 0
v_mov_b64 v[140:141], 0
v_mov_b64 v[142:143], 0
v_mov_b64 v[144:145], 0
v_mov_b64 v[146:147], 0
v_mov_b64 v[148:149], 0
v_mov_b64 v[150:151], 0
v_mov_b64 v[152:153], 0
v_mov_b64 v[154:155], 0
v_mov_b64 v[156:157], 0
v_mov_b64 v[158:159], 0
v_mov_b64 v[160:161], 0
v_mov_b64 v[162:163], 0
v_mov_b64 v[164:165], 0
v_mov_b64 v[166:167], 0
v_mov_b64 v[168:169], 0
v_mov_b64 v[170:171], 0
v_mov_b64 v[172:173], 0
v_mov_b64 v[174:175], 0
v_mov_b64 v[176:177], 0
v_mov_b64 v[178:179], 0
v_mov_b64 v[180:181], 0
v_mov_b64 v[182:183], 0
v_mov_b64 v[184:185], 0
v_mov_b64 v[186:187], 0
v_mov_b64 v[188:189], 0
v_mov_b64 v[190:191], 0
v_mov_b64 v[192:193], 0
v_mov_b64 v[194:195], 0
v_mov_b64 v[196:197], 0
v_mov_b64 v[198:199], 0
v_mov_b64 v[200:201], 0
v_mov_b64 v[202:203], 0
v_mov_b64 v[204:205], 0
v_mov_b64 v[206:207], 0
v_mov_b64 v[208:209], 0
v_mov_b64 v[210:211], 0
v_mov_b64 v[212:213], 0
v_mov_b64 v[214:215], 0
v_mov_b64 v[216:217], 0
v_mov_b64 v[218:219], 0
v_mov_b64 v[220:221], 0
v_mov_b64 v[222:223], 0
v_mov_b64 v[224:225], 0
v_mov_b64 v[226:227], 0
v_mov_b64 v[228:229], 0
v_mov_b64 v[230:231], 0
v_mov_b64 v[232:233], 0
v_mov_b64 v[234:235], 0
v_mov_b64 v[236:237], 0
v_mov_b64 v[238:239], 0
v_mov_b64 v[240:241], 0
v_mov_b64 v[242:243], 0
v_mov_b64 v[244:245], 0
v_mov_b64 v[246:247], 0
v_mov_b64 v[248:249], 0
v_mov_b64 v[250:251], 0
v_mov_b64 v[252:253], 0
v_mov_b64 v[254:255], 0
v_mov_b64 v[24:25], 0
s_mov_b32 s71, s28
s_mov_b32 s84, 0
s_barrier
s_branch K2_item
K2_nend:
Lstub_2:
s_call_b64 s[16:17], K2_slow1
s_branch Lback_3
Lstub_4:
s_call_b64 s[16:17], K2_slow0
s_branch Lback_5
Lstub_6:
s_call_b64 s[16:17], K2_slow1
s_branch Lback_7
Lstub_8:
s_call_b64 s[16:17], K2_slow0
s_branch Lback_9
Lstub_10:
s_call_b64 s[16:17], K2_slow2
s_branch Lback_11
Lstub_12:
s_call_b64 s[16:17], K2_slow2
s_branch Lback_13
Lstub_14:
s_call_b64 s[16:17], K2_slow1
s_branch Lback_15
K2_slow0:
s_nop 7
s_nop 7
v_max3_f32 v8, v32, v33, 0
v_max3_f32 v8, v34, v35, v8
v_max3_f32 v8, v40, v41, v8
v_max3_f32 v8, v42, v43, v8
v_max3_f32 v8, v48, v49, v8
v_max3_f32 v8, v50, v51, v8
v_max3_f32 v8, v56, v57, v8
v_max3_f32 v8, v58, v59, v8
v_mov_b32 v9, v8
s_nop 1
v_permlane16_swap_b32 v8, v9
v_max_f32 v8, v8, v9
v_mov_b32 v9, v8
s_nop 1
v_permlane32_swap_b32 v8, v9
v_max_f32 v8, v8, v9
v_exp_f32 v9, -v8
v_sub_f32 v16, v16, v8
v_sub_f32 v17, v17, v8
v_sub_f32 v18, v18, v8
v_sub_f32 v19, v19, v8
v_mul_f32 v24, v24, v9
v_mul_f32 v128, v128, v9
v_mul_f32 v129, v129, v9
v_mul_f32 v130, v130, v9
v_mul_f32 v131, v131, v9
v_mul_f32 v136, v136, v9
v_mul_f32 v137, v137, v9
v_mul_f32 v138, v138, v9
v_mul_f32 v139, v139, v9
v_mul_f32 v144, v144, v9
v_mul_f32 v145, v145, v9
v_mul_f32 v146, v146, v9
v_mul_f32 v147, v147, v9
v_mul_f32 v152, v152, v9
v_mul_f32 v153, v153, v9
v_mul_f32 v154, v154, v9
v_mul_f32 v155, v155, v9
v_mul_f32 v160, v160, v9
v_mul_f32 v161, v161, v9
v_mul_f32 v162, v162, v9
v_mul_f32 v163, v163, v9
v_mul_f32 v168, v168, v9
v_mul_f32 v169, v169, v9
v_mul_f32 v170, v170, v9
v_mul_f32 v171, v171, v9
v_mul_f32 v176, v176, v9
v_mul_f32 v177, v177, v9
v_mul_f32 v178, v178, v9
v_mul_f32 v179, v179, v9
v_mul_f32 v184, v184, v9
v_mul_f32 v185, v185, v9
v_mul_f32 v186, v186, v9
v_mul_f32 v187, v187, v9
v_mul_f32 v192, v192, v9
v_mul_f32 v193, v193, v9
v_mul_f32 v194, v194, v9
v_mul_f32 v195, v195, v9
v_mul_f32 v200, v200, v9
v_mul_f32 v201, v201, v9
v_mul_f32 v202, v202, v9
v_mul_f32 v203, v203, v9
v_mul_f32 v208, v208, v9
v_mul_f32 v209, v209, v9
v_mul_f32 v210, v210, v9
v_mul_f32 v211, v211, v9
v_mul_f32 v216, v216, v9
v_mul_f32 v217, v217, v9
v_mul_f32 v218, v218, v9
v_mul_f32 v219, v219, v9
v_mul_f32 v224, v224, v9
v_mul_f32 v225, v225, v9
v_mul_f32 v226, v226, v9
v_mul_f32 v227, v227, v9
v_mul_f32 v232, v232, v9
v_mul_f32 v233, v233, v9
v_mul_f32 v234, v234, v9
v_mul_f32 v235, v235, v9
v_mul_f32 v240, v240, v9
v_mul_f32 v241, v241, v9
v_mul_f32 v242, v242, v9
v_mul_f32 v243, v243, v9
v_mul_f32 v248, v248, v9
v_mul_f32 v249, v249, v9
v_mul_f32 v250, v250, v9
v_mul_f32 v251, v251, v9
v_sub_f32 v32, v32, v8
v_sub_f32 v33, v33, v8
v_sub_f32 v34, v34, v8
v_sub_f32 v35, v35, v8
v_sub_f32 v40, v40, v8
v_sub_f32 v41, v41, v8
v_sub_f32 v42, v42, v8
v_sub_f32 v43, v43, v8
v_sub_f32 v48, v48, v8
v_sub_f32 v49, v49, v8
v_sub_f32 v50, v50, v8
v_sub_f32 v51, v51, v8
v_sub_f32 v56, v56, v8
v_sub_f32 v57, v57, v8
v_sub_f32 v58, v58, v8
v_sub_f32 v59, v59, v8
v_sub_f32 v64, v64, v8
v_sub_f32 v65, v65, v8
v_sub_f32 v66, v66, v8
v_sub_f32 v67, v67, v8
v_sub_f32 v72, v72, v8
v_sub_f32 v73, v73, v8
v_sub_f32 v74, v74, v8
v_sub_f32 v75, v75, v8
v_sub_f32 v80, v80, v8
v_sub_f32 v81, v81, v8
v_sub_f32 v82, v82, v8
v_sub_f32 v83, v83, v8
v_sub_f32 v88, v88, v8
v_sub_f32 v89, v89, v8
v_sub_f32 v90, v90, v8
v_sub_f32 v91, v91, v8
v_max3_f32 v8, v36, v37, 0
v_max3_f32 v8, v38, v39, v8
v_max3_f32 v8, v44, v45, v8
v_max3_f32 v8, v46, v47, v8
v_max3_f32 v8, v52, v53, v8
v_max3_f32 v8, v54, v55, v8
v_max3_f32 v8, v60, v61, v8
v_max3_f32 v8, v62, v63, v8
v_mov_b32 v9, v8
s_nop 1
v_permlane16_swap_b32 v8, v9
v_max_f32 v8, v8, v9
v_mov_b32 v9, v8
s_nop 1
v_permlane32_swap_b32 v8, v9
v_max_f32 v8, v8, v9
v_exp_f32 v9, -v8
v_sub_f32 v20, v20, v8
v_sub_f32 v21, v21, v8
v_sub_f32 v22, v22, v8
v_sub_f32 v23, v23, v8
v_mul_f32 v25, v25, v9
v_mul_f32 v132, v132, v9
v_mul_f32 v133, v133, v9
v_mul_f32 v134, v134, v9
v_mul_f32 v135, v135, v9
v_mul_f32 v140, v140, v9
v_mul_f32 v141, v141, v9
v_mul_f32 v142, v142, v9
v_mul_f32 v143, v143, v9
v_mul_f32 v148, v148, v9
v_mul_f32 v149, v149, v9
v_mul_f32 v150, v150, v9
v_mul_f32 v151, v151, v9
v_mul_f32 v156, v156, v9
v_mul_f32 v157, v157, v9
v_mul_f32 v158, v158, v9
v_mul_f32 v159, v159, v9
v_mul_f32 v164, v164, v9
v_mul_f32 v165, v165, v9
v_mul_f32 v166, v166, v9
v_mul_f32 v167, v167, v9
v_mul_f32 v172, v172, v9
v_mul_f32 v173, v173, v9
v_mul_f32 v174, v174, v9
v_mul_f32 v175, v175, v9
v_mul_f32 v180, v180, v9
v_mul_f32 v181, v181, v9
v_mul_f32 v182, v182, v9
v_mul_f32 v183, v183, v9
v_mul_f32 v188, v188, v9
v_mul_f32 v189, v189, v9
v_mul_f32 v190, v190, v9
v_mul_f32 v191, v191, v9
v_mul_f32 v196, v196, v9
v_mul_f32 v197, v197, v9
v_mul_f32 v198, v198, v9
v_mul_f32 v199, v199, v9
v_mul_f32 v204, v204, v9
v_mul_f32 v205, v205, v9
v_mul_f32 v206, v206, v9
v_mul_f32 v207, v207, v9
v_mul_f32 v212, v212, v9
v_mul_f32 v213, v213, v9
v_mul_f32 v214, v214, v9
v_mul_f32 v215, v215, v9
v_mul_f32 v220, v220, v9
v_mul_f32 v221, v221, v9
v_mul_f32 v222, v222, v9
v_mul_f32 v223, v223, v9
v_mul_f32 v228, v228, v9
v_mul_f32 v229, v229, v9
v_mul_f32 v230, v230, v9
v_mul_f32 v231, v231, v9
v_mul_f32 v236, v236, v9
v_mul_f32 v237, v237, v9
v_mul_f32 v238, v238, v9
v_mul_f32 v239, v239, v9
v_mul_f32 v244, v244, v9
v_mul_f32 v245, v245, v9
v_mul_f32 v246, v246, v9
v_mul_f32 v247, v247, v9
v_mul_f32 v252, v252, v9
v_mul_f32 v253, v253, v9
v_mul_f32 v254, v254, v9
v_mul_f32 v255, v255, v9
v_sub_f32 v36, v36, v8
v_sub_f32 v37, v37, v8
v_sub_f32 v38, v38, v8
v_sub_f32 v39, v39, v8
v_sub_f32 v44, v44, v8
v_sub_f32 v45, v45, v8
v_sub_f32 v46, v46, v8
v_sub_f32 v47, v47, v8
v_sub_f32 v52, v52, v8
v_sub_f32 v53, v53, v8
v_sub_f32 v54, v54, v8
v_sub_f32 v55, v55, v8
v_sub_f32 v60, v60, v8
v_sub_f32 v61, v61, v8
v_sub_f32 v62, v62, v8
v_sub_f32 v63, v63, v8
v_sub_f32 v68, v68, v8
v_sub_f32 v69, v69, v8
v_sub_f32 v70, v70, v8
v_sub_f32 v71, v71, v8
v_sub_f32 v76, v76, v8
v_sub_f32 v77, v77, v8
v_sub_f32 v78, v78, v8
v_sub_f32 v79, v79, v8
v_sub_f32 v84, v84, v8
v_sub_f32 v85, v85, v8
v_sub_f32 v86, v86, v8
v_sub_f32 v87, v87, v8
v_sub_f32 v92, v92, v8
v_sub_f32 v93, v93, v8
v_sub_f32 v94, v94, v8
v_sub_f32 v95, v95, v8
v_exp_f32 v8, v32
v_exp_f32 v9, v33
v_exp_f32 v10, v34
v_exp_f32 v11, v35
s_nop 0
v_add_f32 v26, v8, v9
v_cvt_pk_bf16_f32 v96, v8, v9
v_add_f32 v26, v26, v10
v_add_f32 v26, v26, v11
v_cvt_pk_bf16_f32 v97, v10, v11
v_exp_f32 v12, v36
v_exp_f32 v13, v37
v_exp_f32 v14, v38
v_exp_f32 v15, v39
s_nop 0
v_add_f32 v27, v12, v13
v_cvt_pk_bf16_f32 v104, v12, v13
v_add_f32 v27, v27, v14
v_add_f32 v27, v27, v15
v_cvt_pk_bf16_f32 v105, v14, v15
v_exp_f32 v8, v40
v_exp_f32 v9, v41
v_exp_f32 v10, v42
v_exp_f32 v11, v43
s_nop 0
v_add_f32 v26, v26, v8
v_add_f32 v26, v26, v9
v_cvt_pk_bf16_f32 v98, v8, v9
v_add_f32 v26, v26, v10
v_add_f32 v26, v26, v11
v_cvt_pk_bf16_f32 v99, v10, v11
v_exp_f32 v12, v44
v_exp_f32 v13, v45
v_exp_f32 v14, v46
v_exp_f32 v15, v47
s_nop 0
v_add_f32 v27, v27, v12
v_add_f32 v27, v27, v13
v_cvt_pk_bf16_f32 v106, v12, v13
v_add_f32 v27, v27, v14
v_add_f32 v27, v27, v15
v_cvt_pk_bf16_f32 v107, v14, v15
v_exp_f32 v8, v48
v_exp_f32 v9, v49
v_exp_f32 v10, v50
v_exp_f32 v11, v51
s_nop 0
v_add_f32 v26, v26, v8
v_add_f32 v26, v26, v9
v_cvt_pk_bf16_f32 v100, v8, v9
v_add_f32 v26, v26, v10
v_add_f32 v26, v26, v11
v_cvt_pk_bf16_f32 v101, v10, v11
v_exp_f32 v12, v52
v_exp_f32 v13, v53
v_exp_f32 v14, v54
v_exp_f32 v15, v55
s_nop 0
v_add_f32 v27, v27, v12
v_add_f32 v27, v27, v13
v_cvt_pk_bf16_f32 v108, v12, v13
v_add_f32 v27, v27, v14
v_add_f32 v27, v27, v15
v_cvt_pk_bf16_f32 v109, v14, v15
v_exp_f32 v8, v56
v_exp_f32 v9, v57
v_exp_f32 v10, v58
v_exp_f32 v11, v59
s_nop 0
v_add_f32 v26, v26, v8
v_add_f32 v26, v26, v9
v_cvt_pk_bf16_f32 v102, v8, v9
v_add_f32 v26, v26, v10
v_add_f32 v26, v26, v11
v_cvt_pk_bf16_f32 v103, v10, v11
v_exp_f32 v12, v60
v_exp_f32 v13, v61
v_exp_f32 v14, v62
v_exp_f32 v15, v63
s_nop 0
v_add_f32 v27, v27, v12
v_add_f32 v27, v27, v13
v_cvt_pk_bf16_f32 v110, v12, v13
v_add_f32 v27, v27, v14
v_add_f32 v27, v27, v15
v_cvt_pk_bf16_f32 v111, v14, v15
s_nop 1
s_setpc_b64 s[16:17]
K2_slow1:
s_nop 7
s_nop 7
v_max3_f32 v8, v64, v65, 0
v_max3_f32 v8, v66, v67, v8
v_max3_f32 v8, v72, v73, v8
v_max3_f32 v8, v74, v75, v8
v_max3_f32 v8, v80, v81, v8
v_max3_f32 v8, v82, v83, v8
v_max3_f32 v8, v88, v89, v8
v_max3_f32 v8, v90, v91, v8
v_mov_b32 v9, v8
s_nop 1
v_permlane16_swap_b32 v8, v9
v_max_f32 v8, v8, v9
v_mov_b32 v9, v8
s_nop 1
v_permlane32_swap_b32 v8, v9
v_max_f32 v8, v8, v9
v_exp_f32 v9, -v8
v_sub_f32 v16, v16, v8
v_sub_f32 v17, v17, v8
v_sub_f32 v18, v18, v8
v_sub_f32 v19, v19, v8
v_mul_f32 v24, v24, v9
v_mul_f32 v128, v128, v9
v_mul_f32 v129, v129, v9
v_mul_f32 v130, v130, v9
v_mul_f32 v131, v131, v9
v_mul_f32 v136, v136, v9
v_mul_f32 v137, v137, v9
v_mul_f32 v138, v138, v9
v_mul_f32 v139, v139, v9
v_mul_f32 v144, v144, v9
v_mul_f32 v145, v145, v9
v_mul_f32 v146, v146, v9
v_mul_f32 v147, v147, v9
v_mul_f32 v152, v152, v9
v_mul_f32 v153, v153, v9
v_mul_f32 v154, v154, v9
v_mul_f32 v155, v155, v9
v_mul_f32 v160, v160, v9
v_mul_f32 v161, v161, v9
v_mul_f32 v162, v162, v9
v_mul_f32 v163, v163, v9
v_mul_f32 v168, v168, v9
v_mul_f32 v169, v169, v9
v_mul_f32 v170, v170, v9
v_mul_f32 v171, v171, v9
v_mul_f32 v176, v176, v9
v_mul_f32 v177, v177, v9
v_mul_f32 v178, v178, v9
v_mul_f32 v179, v179, v9
v_mul_f32 v184, v184, v9
v_mul_f32 v185, v185, v9
v_mul_f32 v186, v186, v9
v_mul_f32 v187, v187, v9
v_mul_f32 v192, v192, v9
v_mul_f32 v193, v193, v9
v_mul_f32 v194, v194, v9
v_mul_f32 v195, v195, v9
v_mul_f32 v200, v200, v9
v_mul_f32 v201, v201, v9
v_mul_f32 v202, v202, v9
v_mul_f32 v203, v203, v9
v_mul_f32 v208, v208, v9
v_mul_f32 v209, v209, v9
v_mul_f32 v210, v210, v9
v_mul_f32 v211, v211, v9
v_mul_f32 v216, v216, v9
v_mul_f32 v217, v217, v9
v_mul_f32 v218, v218, v9
v_mul_f32 v219, v219, v9
v_mul_f32 v224, v224, v9
v_mul_f32 v225, v225, v9
v_mul_f32 v226, v226, v9
v_mul_f32 v227, v227, v9
v_mul_f32 v232, v232, v9
v_mul_f32 v233, v233, v9
v_mul_f32 v234, v234, v9
v_mul_f32 v235, v235, v9
v_mul_f32 v240, v240, v9
v_mul_f32 v241, v241, v9
v_mul_f32 v242, v242, v9
v_mul_f32 v243, v243, v9
v_mul_f32 v248, v248, v9
v_mul_f32 v249, v249, v9
v_mul_f32 v250, v250, v9
v_mul_f32 v251, v251, v9
v_sub_f32 v32, v32, v8
v_sub_f32 v33, v33, v8
v_sub_f32 v34, v34, v8
v_sub_f32 v35, v35, v8
v_sub_f32 v40, v40, v8
v_sub_f32 v41, v41, v8
v_sub_f32 v42, v42, v8
v_sub_f32 v43, v43, v8
v_sub_f32 v48, v48, v8
v_sub_f32 v49, v49, v8
v_sub_f32 v50, v50, v8
v_sub_f32 v51, v51, v8
v_sub_f32 v56, v56, v8
v_sub_f32 v57, v57, v8
v_sub_f32 v58, v58, v8
v_sub_f32 v59, v59, v8
v_sub_f32 v64, v64, v8
v_sub_f32 v65, v65, v8
v_sub_f32 v66, v66, v8
v_sub_f32 v67, v67, v8
v_sub_f32 v72, v72, v8
v_sub_f32 v73, v73, v8
v_sub_f32 v74, v74, v8
v_sub_f32 v75, v75, v8
v_sub_f32 v80, v80, v8
v_sub_f32 v81, v81, v8
v_sub_f32 v82, v82, v8
v_sub_f32 v83, v83, v8
v_sub_f32 v88, v88, v8
v_sub_f32 v89, v89, v8
v_sub_f32 v90, v90, v8
v_sub_f32 v91, v91, v8
v_max3_f32 v8, v68, v69, 0
v_max3_f32 v8, v70, v71, v8
v_max3_f32 v8, v76, v77, v8
v_max3_f32 v8, v78, v79, v8
v_max3_f32 v8, v84, v85, v8
v_max3_f32 v8, v86, v87, v8
v_max3_f32 v8, v92, v93, v8
v_max3_f32 v8, v94, v95, v8
v_mov_b32 v9, v8
s_nop 1
v_permlane16_swap_b32 v8, v9
v_max_f32 v8, v8, v9
v_mov_b32 v9, v8
s_nop 1
v_permlane32_swap_b32 v8, v9
v_max_f32 v8, v8, v9
v_exp_f32 v9, -v8
v_sub_f32 v20, v20, v8
v_sub_f32 v21, v21, v8
v_sub_f32 v22, v22, v8
v_sub_f32 v23, v23, v8
v_mul_f32 v25, v25, v9
v_mul_f32 v132, v132, v9
v_mul_f32 v133, v133, v9
v_mul_f32 v134, v134, v9
v_mul_f32 v135, v135, v9
v_mul_f32 v140, v140, v9
v_mul_f32 v141, v141, v9
v_mul_f32 v142, v142, v9
v_mul_f32 v143, v143, v9
v_mul_f32 v148, v148, v9
v_mul_f32 v149, v149, v9
v_mul_f32 v150, v150, v9
v_mul_f32 v151, v151, v9
v_mul_f32 v156, v156, v9
v_mul_f32 v157, v157, v9
v_mul_f32 v158, v158, v9
v_mul_f32 v159, v159, v9
v_mul_f32 v164, v164, v9
v_mul_f32 v165, v165, v9
v_mul_f32 v166, v166, v9
v_mul_f32 v167, v167, v9
v_mul_f32 v172, v172, v9
v_mul_f32 v173, v173, v9
v_mul_f32 v174, v174, v9
v_mul_f32 v175, v175, v9
v_mul_f32 v180, v180, v9
v_mul_f32 v181, v181, v9
v_mul_f32 v182, v182, v9
v_mul_f32 v183, v183, v9
v_mul_f32 v188, v188, v9
v_mul_f32 v189, v189, v9
v_mul_f32 v190, v190, v9
v_mul_f32 v191, v191, v9
v_mul_f32 v196, v196, v9
v_mul_f32 v197, v197, v9
v_mul_f32 v198, v198, v9
v_mul_f32 v199, v199, v9
v_mul_f32 v204, v204, v9
v_mul_f32 v205, v205, v9
v_mul_f32 v206, v206, v9
v_mul_f32 v207, v207, v9
v_mul_f32 v212, v212, v9
v_mul_f32 v213, v213, v9
v_mul_f32 v214, v214, v9
v_mul_f32 v215, v215, v9
v_mul_f32 v220, v220, v9
v_mul_f32 v221, v221, v9
v_mul_f32 v222, v222, v9
v_mul_f32 v223, v223, v9
v_mul_f32 v228, v228, v9
v_mul_f32 v229, v229, v9
v_mul_f32 v230, v230, v9
v_mul_f32 v231, v231, v9
v_mul_f32 v236, v236, v9
v_mul_f32 v237, v237, v9
v_mul_f32 v238, v238, v9
v_mul_f32 v239, v239, v9
v_mul_f32 v244, v244, v9
v_mul_f32 v245, v245, v9
v_mul_f32 v246, v246, v9
v_mul_f32 v247, v247, v9
v_mul_f32 v252, v252, v9
v_mul_f32 v253, v253, v9
v_mul_f32 v254, v254, v9
v_mul_f32 v255, v255, v9
v_sub_f32 v36, v36, v8
v_sub_f32 v37, v37, v8
v_sub_f32 v38, v38, v8
v_sub_f32 v39, v39, v8
v_sub_f32 v44, v44, v8
v_sub_f32 v45, v45, v8
v_sub_f32 v46, v46, v8
v_sub_f32 v47, v47, v8
v_sub_f32 v52, v52, v8
v_sub_f32 v53, v53, v8
v_sub_f32 v54, v54, v8
v_sub_f32 v55, v55, v8
v_sub_f32 v60, v60, v8
v_sub_f32 v61, v61, v8
v_sub_f32 v62, v62, v8
v_sub_f32 v63, v63, v8
v_sub_f32 v68, v68, v8
v_sub_f32 v69, v69, v8
v_sub_f32 v70, v70, v8
v_sub_f32 v71, v71, v8
v_sub_f32 v76, v76, v8
v_sub_f32 v77, v77, v8
v_sub_f32 v78, v78, v8
v_sub_f32 v79, v79, v8
v_sub_f32 v84, v84, v8
v_sub_f32 v85, v85, v8
v_sub_f32 v86, v86, v8
v_sub_f32 v87, v87, v8
v_sub_f32 v92, v92, v8
v_sub_f32 v93, v93, v8
v_sub_f32 v94, v94, v8
v_sub_f32 v95, v95, v8
v_exp_f32 v8, v64
v_exp_f32 v9, v65
v_exp_f32 v10, v66
v_exp_f32 v11, v67
s_nop 0
v_add_f32 v26, v8, v9
v_cvt_pk_bf16_f32 v112, v8, v9
v_add_f32 v26, v26, v10
v_add_f32 v26, v26, v11
v_cvt_pk_bf16_f32 v113, v10, v11
v_exp_f32 v12, v68
v_exp_f32 v13, v69
v_exp_f32 v14, v70
v_exp_f32 v15, v71
s_nop 0
v_add_f32 v27, v12, v13
v_cvt_pk_bf16_f32 v120, v12, v13
v_add_f32 v27, v27, v14
v_add_f32 v27, v27, v15
v_cvt_pk_bf16_f32 v121, v14, v15
v_exp_f32 v8, v72
v_exp_f32 v9, v73
v_exp_f32 v10, v74
v_exp_f32 v11, v75
s_nop 0
v_add_f32 v26, v26, v8
v_add_f32 v26, v26, v9
v_cvt_pk_bf16_f32 v114, v8, v9
v_add_f32 v26, v26, v10
v_add_f32 v26, v26, v11
v_cvt_pk_bf16_f32 v115, v10, v11
v_exp_f32 v12, v76
v_exp_f32 v13, v77
v_exp_f32 v14, v78
v_exp_f32 v15, v79
s_nop 0
v_add_f32 v27, v27, v12
v_add_f32 v27, v27, v13
v_cvt_pk_bf16_f32 v122, v12, v13
v_add_f32 v27, v27, v14
v_add_f32 v27, v27, v15
v_cvt_pk_bf16_f32 v123, v14, v15
v_exp_f32 v8, v80
v_exp_f32 v9, v81
v_exp_f32 v10, v82
v_exp_f32 v11, v83
s_nop 0
v_add_f32 v26, v26, v8
v_add_f32 v26, v26, v9
v_cvt_pk_bf16_f32 v116, v8, v9
v_add_f32 v26, v26, v10
v_add_f32 v26, v26, v11
v_cvt_pk_bf16_f32 v117, v10, v11
v_exp_f32 v12, v84
v_exp_f32 v13, v85
v_exp_f32 v14, v86
v_exp_f32 v15, v87
s_nop 0
v_add_f32 v27, v27, v12
v_add_f32 v27, v27, v13
v_cvt_pk_bf16_f32 v124, v12, v13
v_add_f32 v27, v27, v14
v_add_f32 v27, v27, v15
v_cvt_pk_bf16_f32 v125, v14, v15
v_exp_f32 v8, v88
v_exp_f32 v9, v89
v_exp_f32 v10, v90
v_exp_f32 v11, v91
s_nop 0
v_add_f32 v26, v26, v8
v_add_f32 v26, v26, v9
v_cvt_pk_bf16_f32 v118, v8, v9
v_add_f32 v26, v26, v10
v_add_f32 v26, v26, v11
v_cvt_pk_bf16_f32 v119, v10, v11
v_exp_f32 v12, v92
v_exp_f32 v13, v93
v_exp_f32 v14, v94
v_exp_f32 v15, v95
s_nop 0
v_add_f32 v27, v27, v12
v_add_f32 v27, v27, v13
v_cvt_pk_bf16_f32 v126, v12, v13
v_add_f32 v27, v27, v14
v_add_f32 v27, v27, v15
v_cvt_pk_bf16_f32 v127, v14, v15
s_nop 1
s_setpc_b64 s[16:17]
K2_slow2:
s_nop 7
s_nop 7
v_max3_f32 v8, v68, v69, 0
v_max3_f32 v8, v70, v71, v8
v_max3_f32 v8, v76, v77, v8
v_max3_f32 v8, v78, v79, v8
v_max3_f32 v8, v84, v85, v8
v_max3_f32 v8, v86, v87, v8
v_max3_f32 v8, v92, v93, v8
v_max3_f32 v8, v94, v95, v8
v_mov_b32 v9, v8
s_nop 1
v_permlane16_swap_b32 v8, v9
v_max_f32 v8, v8, v9
v_mov_b32 v9, v8
s_nop 1
v_permlane32_swap_b32 v8, v9
v_max_f32 v8, v8, v9
v_exp_f32 v9, -v8
v_sub_f32 v20, v20, v8
v_sub_f32 v21, v21, v8
v_sub_f32 v22, v22, v8
v_sub_f32 v23, v23, v8
v_mul_f32 v25, v25, v9
v_mul_f32 v132, v132, v9
v_mul_f32 v133, v133, v9
v_mul_f32 v134, v134, v9
v_mul_f32 v135, v135, v9
v_mul_f32 v140, v140, v9
v_mul_f32 v141, v141, v9
v_mul_f32 v142, v142, v9
v_mul_f32 v143, v143, v9
v_mul_f32 v148, v148, v9
v_mul_f32 v149, v149, v9
v_mul_f32 v150, v150, v9
v_mul_f32 v151, v151, v9
v_mul_f32 v156, v156, v9
v_mul_f32 v157, v157, v9
v_mul_f32 v158, v158, v9
v_mul_f32 v159, v159, v9
v_mul_f32 v164, v164, v9
v_mul_f32 v165, v165, v9
v_mul_f32 v166, v166, v9
v_mul_f32 v167, v167, v9
v_mul_f32 v172, v172, v9
v_mul_f32 v173, v173, v9
v_mul_f32 v174, v174, v9
v_mul_f32 v175, v175, v9
v_mul_f32 v180, v180, v9
v_mul_f32 v181, v181, v9
v_mul_f32 v182, v182, v9
v_mul_f32 v183, v183, v9
v_mul_f32 v188, v188, v9
v_mul_f32 v189, v189, v9
v_mul_f32 v190, v190, v9
v_mul_f32 v191, v191, v9
v_mul_f32 v196, v196, v9
v_mul_f32 v197, v197, v9
v_mul_f32 v198, v198, v9
v_mul_f32 v199, v199, v9
v_mul_f32 v204, v204, v9
v_mul_f32 v205, v205, v9
v_mul_f32 v206, v206, v9
v_mul_f32 v207, v207, v9
v_mul_f32 v212, v212, v9
v_mul_f32 v213, v213, v9
v_mul_f32 v214, v214, v9
v_mul_f32 v215, v215, v9
v_mul_f32 v220, v220, v9
v_mul_f32 v221, v221, v9
v_mul_f32 v222, v222, v9
v_mul_f32 v223, v223, v9
v_mul_f32 v228, v228, v9
v_mul_f32 v229, v229, v9
v_mul_f32 v230, v230, v9
v_mul_f32 v231, v231, v9
v_mul_f32 v236, v236, v9
v_mul_f32 v237, v237, v9
v_mul_f32 v238, v238, v9
v_mul_f32 v239, v239, v9
v_mul_f32 v244, v244, v9
v_mul_f32 v245, v245, v9
v_mul_f32 v246, v246, v9
v_mul_f32 v247, v247, v9
v_mul_f32 v252, v252, v9
v_mul_f32 v253, v253, v9
v_mul_f32 v254, v254, v9
v_mul_f32 v255, v255, v9
v_sub_f32 v68, v68, v8
v_sub_f32 v69, v69, v8
v_sub_f32 v70, v70, v8
v_sub_f32 v71, v71, v8
v_sub_f32 v76, v76, v8
v_sub_f32 v77, v77, v8
v_sub_f32 v78, v78, v8
v_sub_f32 v79, v79, v8
v_sub_f32 v84, v84, v8
v_sub_f32 v85, v85, v8
v_sub_f32 v86, v86, v8
v_sub_f32 v87, v87, v8
v_sub_f32 v92, v92, v8
v_sub_f32 v93, v93, v8
v_sub_f32 v94, v94, v8
v_sub_f32 v95, v95, v8
v_exp_f32 v8, v68
v_exp_f32 v9, v69
v_exp_f32 v10, v70
v_exp_f32 v11, v71
s_nop 0
v_add_f32 v27, v8, v9
v_cvt_pk_bf16_f32 v120, v8, v9
v_add_f32 v27, v27, v10
v_add_f32 v27, v27, v11
v_cvt_pk_bf16_f32 v121, v10, v11
v_exp_f32 v12, v76
v_exp_f32 v13, v77
v_exp_f32 v14, v78
v_exp_f32 v15, v79
s_nop 0
v_add_f32 v27, v27, v12
v_add_f32 v27, v27, v13
v_cvt_pk_bf16_f32 v122, v12, v13
v_add_f32 v27, v27, v14
v_add_f32 v27, v27, v15
v_cvt_pk_bf16_f32 v123, v14, v15
v_exp_f32 v8, v84
v_exp_f32 v9, v85
v_exp_f32 v10, v86
v_exp_f32 v11, v87
s_nop 0
v_add_f32 v27, v27, v8
v_add_f32 v27, v27, v9
v_cvt_pk_bf16_f32 v124, v8, v9
v_add_f32 v27, v27, v10
v_add_f32 v27, v27, v11
v_cvt_pk_bf16_f32 v125, v10, v11
v_exp_f32 v12, v92
v_exp_f32 v13, v93
v_exp_f32 v14, v94
v_exp_f32 v15, v95
s_nop 0
v_add_f32 v27, v27, v12
v_add_f32 v27, v27, v13
v_cvt_pk_bf16_f32 v126, v12, v13
v_add_f32 v27, v27, v14
v_add_f32 v27, v27, v15
v_cvt_pk_bf16_f32 v127, v14, v15
s_nop 1
s_setpc_b64 s[16:17]
M_cntspinK:
Lp_9801:
buffer_load_dword v21, off, s[60:63], s54 sc1
s_waitcnt vmcnt(0)
v_cmp_gt_u32 vcc, s50, v21
s_cbranch_vccz Lpd_9802
s_sleep 8
s_sub_u32 s101, s101, 1
s_cbranch_scc0 Lp_9801
s_mov_b32 s101, 0
Lpd_9802:
s_branch Lg_1
M_cntspinV:
Lp_9803:
buffer_load_dword v21, off, s[60:63], s54 sc1
s_waitcnt vmcnt(0)
v_cmp_gt_u32 vcc, s50, v21
s_cbranch_vccz Lpd_9804
s_sleep 8
s_sub_u32 s101, s101, 1
s_cbranch_scc0 Lp_9803
s_mov_b32 s101, 0
Lpd_9804:
s_branch Lg_501
M_ppspinV:
Lp_9805:
buffer_load_dword v230, v231, s[4:7], s52 offen sc1
s_waitcnt vmcnt(0)
v_cmp_gt_u32 vcc, 1, v230
s_cbranch_vccz Lpd_9806
s_sleep 8
s_sub_u32 s101, s101, 1
s_cbranch_scc0 Lp_9805
s_mov_b32 s101, 0
Lpd_9806:
s_branch M_ppokV
M_end:
s_endpgm
.section .rodata,"a"
.p2align 6
.amdhsa_kernel concat_heads__ssm_conv_h3__compressed_kv_cla__prompt_kernel
  .amdhsa_next_free_vgpr 512
  .amdhsa_next_free_sgpr 102
  .amdhsa_accum_offset 256
  .amdhsa_group_segment_fixed_size 0
  .amdhsa_kernarg_size 120
  .amdhsa_user_sgpr_count 2
  .amdhsa_user_sgpr_kernarg_segment_ptr 1
  .amdhsa_system_sgpr_workgroup_id_x 1
  .amdhsa_float_denorm_mode_32 3
  .amdhsa_float_denorm_mode_16_64 3
  .amdhsa_ieee_mode 0
  .amdhsa_dx10_clamp 0
.end_amdhsa_kernel
```
